```python
import torch

def _softmax(x, axis=-1):
    return torch.softmax(x, dim=axis)
def _gelu(x):
    return torch.nn.functional.gelu(x, approximate="tanh")
def _silu(x):
    return torch.nn.functional.silu(x)
def _sigmoid(x):
    return torch.sigmoid(x)
def _layernorm(x, axis=-1, eps=1e-5):
    m = x.mean(dim=axis, keepdim=True)
    v = x.var(dim=axis, keepdim=True, unbiased=False)
    return (x - m) / torch.sqrt(v + eps)
def _scatter_add(tgt, idx, src, axis=0):
    return tgt.clone().index_add_(axis, idx, src)
def _segment_sum(src, seg, n):
    out = torch.zeros((n,) + src.shape[1:], dtype=src.dtype)
    return out.index_add_(0, seg, src)
def _pad(x, pw):
    flat = tuple(v for pair in reversed(pw) for v in pair)
    return torch.nn.functional.pad(x, flat)

kernel_name = 'gated_mix__compressed_kv_cla__sliding_local_dilated__prompt'

def setup_inputs():

    _w = (lambda a: (lambda t: t.to(torch.bfloat16) if t.is_floating_point() else t)(torch.as_tensor(a)))
    def _A_setup():
        B, H, Sq, Sk, D, M = 1, 32, 2048, 2048, 128, 1024
        Dc = 4 * D
        return {
            "x": _w((lambda *s: torch.randn(*s, dtype=torch.bfloat16) * 0.05)(B, Sq, M)),
            "c_kv": _w((lambda *s: torch.randn(*s, dtype=torch.bfloat16) * 1.6)(B, Sk, Dc)),
            "w_q": _w((lambda *s: torch.randn(*s, dtype=torch.bfloat16) * 6.4)(M, H, D) * (M ** -0.5)),
            "w_uk": _w((lambda *s: torch.randn(*s, dtype=torch.bfloat16) * 6.4)(Dc, H, D) * (Dc ** -0.5)),
            "w_uv": _w((lambda *s: torch.randn(*s, dtype=torch.bfloat16) * 1.6)(Dc, H, D) * (Dc ** -0.5)),
            "w_o": _w((lambda *s: torch.randn(*s, dtype=torch.bfloat16) * 1.6)(H, D, M) * ((H * D) ** -0.5)),
        }
    _A_in = _A_setup()

    def _B_setup():
        B, S, D = 1, 2048, 1024
        return {
            "x": _w((lambda *s: torch.randn(*s, dtype=torch.bfloat16) * 0.05)(B, S, D)),
            "wqkv": _w((lambda *s: torch.randn(*s, dtype=torch.bfloat16) * 0.8)(D, 3 * D)),
            "wo": _w((lambda *s: torch.randn(*s, dtype=torch.bfloat16) * 0.05)(D, D)),
        }
    _B_in = _B_setup()

    return {
        "A_x": _A_in["x"],
        "A_c_kv": _A_in["c_kv"],
        "A_w_q": _A_in["w_q"],
        "A_w_uk": _A_in["w_uk"],
        "A_w_uv": _A_in["w_uv"],
        "A_w_o": _A_in["w_o"],
        "B_x": _B_in["x"],
        "B_wqkv": _B_in["wqkv"],
        "B_wo": _B_in["wo"],
        "gate_w": _w((lambda *s: torch.randn(*s, dtype=torch.bfloat16) * 0.05)(1024) * 16.0),
    }

def reference(A_x, A_c_kv, A_w_q, A_w_uk, A_w_uv, A_w_o, B_x, B_wqkv, B_wo, gate_w):
    def _A_ref(x, c_kv, w_q, w_uk, w_uv, w_o):
        B, Sq, M = x.shape[0], x.shape[1], x.shape[2]
        Sk = c_kv.shape[1]
        H, D = w_q.shape[1], w_q.shape[2]
        q = torch.einsum("bqm,mhd->bhqd", x, w_q)
        k = torch.einsum("bkc,chd->bhkd", c_kv, w_uk)
        v = torch.einsum("bkc,chd->bhkd", c_kv, w_uv)
        scores = torch.einsum("bhqd,bhkd->bhqk", q, k) * (D ** -0.5)
        off = Sk - Sq
        qi = torch.arange(Sq)[:, None]
        kj = torch.arange(Sk)[None, :]
        cmask = kj <= (qi + off)
        scores = torch.where(cmask[None, None], scores, -1e9)
        p = _softmax(scores, axis=-1)
        ctx = torch.einsum("bhqk,bhkd->bhqd", p, v)
        return torch.einsum("bhqd,hdm->bqm", ctx, w_o)

    def _B_ref(x, wqkv, wo):
        B, S, D = x.shape
        H = 32; Dh = D // H
        W, dil = 8, 2
        qkv = (lambda x, *d: x.permute(*d))((x @ wqkv).reshape(B, S, 3, H, Dh), 2, 0, 3, 1, 4)
        q, k, v = qkv[0], qkv[1], qkv[2]
        scale = Dh ** -0.5
        pos = torch.arange(S)
        off = torch.arange(W) * dil
        idx = pos[:, None] - off[None, :]
        mask = idx >= 0
        idx_c = torch.where(mask, idx, 0).reshape(-1)
        kg = k[:, :, idx_c, :].reshape(B, H, S, W, Dh)
        vg = v[:, :, idx_c, :].reshape(B, H, S, W, Dh)
        logits = torch.einsum("bhsd,bhswd->bhsw", q, kg) * scale
        logits = torch.where(mask[None, None, :, :], logits, -1e9)
        attn = _softmax(logits, axis=-1)
        o = torch.einsum("bhsw,bhswd->bhsd", attn, vg)
        return (lambda x, *d: x.permute(*d))(o, 0, 2, 1, 3).reshape(B, S, D) @ wo

    x = A_x
    g = _sigmoid((x * gate_w).sum(-1, keepdims=True))
    a = _A_ref(x, A_c_kv, A_w_q, A_w_uk, A_w_uv, A_w_o)
    b = _B_ref(x, B_wqkv, B_wo)
    return g * a + (1 - g) * b
```

```asm
; @launch kernel=kv_kernel grid=(256,1,1) block=(256,1,1) lds=163840
; @launch kernel=att_kernel grid=(256,1,1) block=(256,1,1) lds=163840
; @launch kernel=out_kernel grid=(256,1,1) block=(256,1,1) lds=163840
.amdgcn_target "amdgcn-amd-amdhsa--gfx950"
.text
.globl kv_kernel
.p2align 8
.type kv_kernel,@function
kv_kernel:
s_cmp_ge_u32 s2, 256
s_cbranch_scc1 L_k1_end
s_load_dwordx2 s[44:45], s[0:1], 0
s_load_dwordx2 s[48:49], s[0:1], 8
s_load_dwordx2 s[56:57], s[0:1], 24
s_load_dwordx2 s[60:61], s[0:1], 32
s_load_dwordx2 s[76:77], s[0:1], 72
s_load_dwordx2 s[88:89], s[0:1], 96
v_lshrrev_b32 v1, 6, v0
v_and_b32 v0, 63, v0
v_readfirstlane_b32 s4, v1
s_mov_b32 s46, 0x400000
s_mov_b32 s47, 0x20000
s_mov_b32 s50, 0x200000
s_mov_b32 s51, 0x20000
s_mov_b32 s58, 0x400000
s_mov_b32 s59, 0x20000
s_mov_b32 s62, 0x400000
s_mov_b32 s63, 0x20000
s_mov_b32 s78, 0x800
s_mov_b32 s79, 0x20000
s_mov_b32 s90, 0x10000000
s_mov_b32 s91, 0x20000
s_and_b32 s5, s2, 7
s_lshl_b32 s5, s5, 2
s_bfe_u32 s3, s2, 0x20003
s_add_u32 s5, s5, s3
s_lshr_b32 s6, s2, 5
s_mov_b32 s12, 0x4000
s_mov_b32 s13, 0x8000
s_mov_b32 s14, 0xc000
s_mov_b32 s25, 0x800
s_mov_b32 s26, 0x1000
s_waitcnt lgkmcnt(0)
v_lshlrev_b32 v16, 4, v0
v_lshrrev_b32 v17, 4, v0
v_xor_b32 v17, v17, v0
v_and_b32 v17, 7, v17
v_lshlrev_b32 v17, 4, v17
v_lshrrev_b32 v18, 3, v0
v_lshl_add_u32 v2, v18, 10, v17
s_lshl_b32 s8, s6, 18
s_lshl_b32 s9, s4, 16
s_add_u32 s8, s8, s9
v_add_u32 v2, s8, v2
v_xor_b32 v3, 64, v2
v_add_u32 v3, 0x2000, v3
s_lshl_b32 s16, s4, 13
s_add_u32 s16, s16, 0x10000
s_lshl_b32 s17, s4, 12
v_bfe_u32 v17, v0, 2, 2
s_lshl_b32 s8, s4, 4
v_add_u32 v17, s8, v17
v_lshlrev_b32 v17, 13, v17
v_lshrrev_b32 v18, 4, v0
v_lshl_add_u32 v17, v18, 6, v17
v_and_b32 v18, 3, v0
v_lshl_add_u32 v17, v18, 4, v17
s_lshl_b32 s8, s5, 8
v_add_u32 v5, s8, v17
v_xor_b32 v6, 32, v5
v_add_u32 v6, 0x10000, v6
s_lshl_b32 s8, s2, 3
s_lshl_b32 s9, s4, 1
s_add_u32 s8, s8, s9
s_lshl_b32 s9, s8, 11
s_lshl_b32 s10, s8, 2
s_add_u32 s10, s10, 0x3600000
buffer_load_dwordx4 v[24:27], v16, s[44:47], s9 offen offset:0
buffer_load_dwordx4 v[28:31], v16, s[44:47], s9 offen offset:1024
buffer_load_dwordx4 v[32:35], v16, s[44:47], s9 offen offset:2048
buffer_load_dwordx4 v[36:39], v16, s[44:47], s9 offen offset:3072
buffer_load_dwordx4 v[40:43], v16, s[76:79], 0 offen offset:0
buffer_load_dwordx4 v[44:47], v16, s[76:79], 0 offen offset:1024
s_add_u32 m0, s17, 0x0
s_nop 0
buffer_load_dwordx4 v5, s[56:59], 0 offen lds
s_add_u32 m0, s17, 0x4000
s_nop 0
buffer_load_dwordx4 v5, s[60:63], 0 offen lds
s_add_u32 m0, s17, 0x400
s_nop 0
buffer_load_dwordx4 v5, s[56:59], s13 offen lds
s_add_u32 m0, s17, 0x4400
s_nop 0
buffer_load_dwordx4 v5, s[60:63], s13 offen lds
s_add_u32 m0, s17, 0x800
s_nop 0
buffer_load_dwordx4 v6, s[56:59], 0 offen lds
s_add_u32 m0, s17, 0x4800
s_nop 0
buffer_load_dwordx4 v6, s[60:63], 0 offen lds
s_add_u32 m0, s17, 0xc00
s_nop 0
buffer_load_dwordx4 v6, s[56:59], s13 offen lds
s_add_u32 m0, s17, 0x4c00
s_nop 0
buffer_load_dwordx4 v6, s[60:63], s13 offen lds
s_add_u32 m0, s16, 0x0
s_nop 0
buffer_load_dwordx4 v2, s[48:51], 0 offen lds
s_add_u32 m0, s16, 0x400
s_nop 0
buffer_load_dwordx4 v3, s[48:51], 0 offen lds
s_add_u32 m0, s16, 0x800
s_nop 0
buffer_load_dwordx4 v2, s[48:51], s12 offen lds
s_add_u32 m0, s16, 0xc00
s_nop 0
buffer_load_dwordx4 v3, s[48:51], s12 offen lds
s_add_u32 m0, s16, 0x1000
s_nop 0
buffer_load_dwordx4 v2, s[48:51], s13 offen lds
s_add_u32 m0, s16, 0x1400
s_nop 0
buffer_load_dwordx4 v3, s[48:51], s13 offen lds
s_add_u32 m0, s16, 0x1800
s_nop 0
buffer_load_dwordx4 v2, s[48:51], s14 offen lds
s_add_u32 m0, s16, 0x1c00
s_nop 0
buffer_load_dwordx4 v3, s[48:51], s14 offen lds
v_add_u32 v2, 0x80, v2
v_add_u32 v3, 0x80, v3
v_add_u32 v5, 0x80000, v5
v_add_u32 v6, 0x80000, v6
s_add_u32 m0, s17, 0x8000
s_nop 0
buffer_load_dwordx4 v5, s[56:59], 0 offen lds
s_add_u32 m0, s17, 0xc000
s_nop 0
buffer_load_dwordx4 v5, s[60:63], 0 offen lds
s_add_u32 m0, s17, 0x8400
s_nop 0
buffer_load_dwordx4 v5, s[56:59], s13 offen lds
s_add_u32 m0, s17, 0xc400
s_nop 0
buffer_load_dwordx4 v5, s[60:63], s13 offen lds
s_add_u32 m0, s17, 0x8800
s_nop 0
buffer_load_dwordx4 v6, s[56:59], 0 offen lds
s_add_u32 m0, s17, 0xc800
s_nop 0
buffer_load_dwordx4 v6, s[60:63], 0 offen lds
s_add_u32 m0, s17, 0x8c00
s_nop 0
buffer_load_dwordx4 v6, s[56:59], s13 offen lds
s_add_u32 m0, s17, 0xcc00
s_nop 0
buffer_load_dwordx4 v6, s[60:63], s13 offen lds
s_add_u32 m0, s16, 0x8000
s_nop 0
buffer_load_dwordx4 v2, s[48:51], 0 offen lds
s_add_u32 m0, s16, 0x8400
s_nop 0
buffer_load_dwordx4 v3, s[48:51], 0 offen lds
s_add_u32 m0, s16, 0x8800
s_nop 0
buffer_load_dwordx4 v2, s[48:51], s12 offen lds
s_add_u32 m0, s16, 0x8c00
s_nop 0
buffer_load_dwordx4 v3, s[48:51], s12 offen lds
s_add_u32 m0, s16, 0x9000
s_nop 0
buffer_load_dwordx4 v2, s[48:51], s13 offen lds
s_add_u32 m0, s16, 0x9400
s_nop 0
buffer_load_dwordx4 v3, s[48:51], s13 offen lds
s_add_u32 m0, s16, 0x9800
s_nop 0
buffer_load_dwordx4 v2, s[48:51], s14 offen lds
s_add_u32 m0, s16, 0x9c00
s_nop 0
buffer_load_dwordx4 v3, s[48:51], s14 offen lds
v_add_u32 v2, 0x80, v2
v_add_u32 v3, 0x80, v3
v_add_u32 v5, 0x80000, v5
v_add_u32 v6, 0x80000, v6
v_and_b32 v17, 15, v0
v_lshrrev_b32 v18, 1, v17
v_lshrrev_b32 v19, 4, v0
v_xor_b32 v18, v18, v19
v_lshlrev_b32 v18, 4, v18
v_lshl_add_u32 v8, v17, 7, v18
s_lshr_b32 s8, s4, 1
s_lshl_b32 s8, s8, 14
s_add_u32 s8, s8, 0x10000
v_add_u32 v8, s8, v8
v_xor_b32 v9, 64, v8
v_lshrrev_b32 v17, 4, v0
v_lshlrev_b32 v18, 11, v17
v_and_b32 v17, 1, v17
v_lshl_add_u32 v18, v17, 5, v18
v_bfe_u32 v17, v0, 2, 2
v_lshl_add_u32 v18, v17, 6, v18
v_and_b32 v17, 3, v0
v_lshl_add_u32 v12, v17, 3, v18
s_and_b32 s8, s4, 1
s_lshl_b32 s8, s8, 9
v_add_u32 v12, s8, v12
v_xor_b32 v13, 32, v12
s_waitcnt vmcnt(32)
v_mov_b32 v48, 0
v_mov_b32 v49, 0
v_lshlrev_b32 v50, 16, v40
v_and_b32 v51, 0xffff0000, v40
v_lshlrev_b32 v52, 16, v24
v_and_b32 v53, 0xffff0000, v24
v_fmac_f32 v48, v50, v52
v_fmac_f32 v48, v51, v53
v_lshlrev_b32 v52, 16, v32
v_and_b32 v53, 0xffff0000, v32
v_fmac_f32 v49, v50, v52
v_fmac_f32 v49, v51, v53
v_lshlrev_b32 v50, 16, v41
v_and_b32 v51, 0xffff0000, v41
v_lshlrev_b32 v52, 16, v25
v_and_b32 v53, 0xffff0000, v25
v_fmac_f32 v48, v50, v52
v_fmac_f32 v48, v51, v53
v_lshlrev_b32 v52, 16, v33
v_and_b32 v53, 0xffff0000, v33
v_fmac_f32 v49, v50, v52
v_fmac_f32 v49, v51, v53
v_lshlrev_b32 v50, 16, v42
v_and_b32 v51, 0xffff0000, v42
v_lshlrev_b32 v52, 16, v26
v_and_b32 v53, 0xffff0000, v26
v_fmac_f32 v48, v50, v52
v_fmac_f32 v48, v51, v53
v_lshlrev_b32 v52, 16, v34
v_and_b32 v53, 0xffff0000, v34
v_fmac_f32 v49, v50, v52
v_fmac_f32 v49, v51, v53
v_lshlrev_b32 v50, 16, v43
v_and_b32 v51, 0xffff0000, v43
v_lshlrev_b32 v52, 16, v27
v_and_b32 v53, 0xffff0000, v27
v_fmac_f32 v48, v50, v52
v_fmac_f32 v48, v51, v53
v_lshlrev_b32 v52, 16, v35
v_and_b32 v53, 0xffff0000, v35
v_fmac_f32 v49, v50, v52
v_fmac_f32 v49, v51, v53
v_lshlrev_b32 v50, 16, v44
v_and_b32 v51, 0xffff0000, v44
v_lshlrev_b32 v52, 16, v28
v_and_b32 v53, 0xffff0000, v28
v_fmac_f32 v48, v50, v52
v_fmac_f32 v48, v51, v53
v_lshlrev_b32 v52, 16, v36
v_and_b32 v53, 0xffff0000, v36
v_fmac_f32 v49, v50, v52
v_fmac_f32 v49, v51, v53
v_lshlrev_b32 v50, 16, v45
v_and_b32 v51, 0xffff0000, v45
v_lshlrev_b32 v52, 16, v29
v_and_b32 v53, 0xffff0000, v29
v_fmac_f32 v48, v50, v52
v_fmac_f32 v48, v51, v53
v_lshlrev_b32 v52, 16, v37
v_and_b32 v53, 0xffff0000, v37
v_fmac_f32 v49, v50, v52
v_fmac_f32 v49, v51, v53
v_lshlrev_b32 v50, 16, v46
v_and_b32 v51, 0xffff0000, v46
v_lshlrev_b32 v52, 16, v30
v_and_b32 v53, 0xffff0000, v30
v_fmac_f32 v48, v50, v52
v_fmac_f32 v48, v51, v53
v_lshlrev_b32 v52, 16, v38
v_and_b32 v53, 0xffff0000, v38
v_fmac_f32 v49, v50, v52
v_fmac_f32 v49, v51, v53
v_lshlrev_b32 v50, 16, v47
v_and_b32 v51, 0xffff0000, v47
v_lshlrev_b32 v52, 16, v31
v_and_b32 v53, 0xffff0000, v31
v_fmac_f32 v48, v50, v52
v_fmac_f32 v48, v51, v53
v_lshlrev_b32 v52, 16, v39
v_and_b32 v53, 0xffff0000, v39
v_fmac_f32 v49, v50, v52
v_fmac_f32 v49, v51, v53
s_nop 1
v_add_f32_dpp v48, v48, v48 row_ror:8 row_mask:0xf bank_mask:0xf
v_add_f32_dpp v49, v49, v49 row_ror:8 row_mask:0xf bank_mask:0xf
s_nop 1
v_add_f32_dpp v48, v48, v48 row_ror:4 row_mask:0xf bank_mask:0xf
v_add_f32_dpp v49, v49, v49 row_ror:4 row_mask:0xf bank_mask:0xf
s_nop 1
v_add_f32_dpp v48, v48, v48 row_ror:2 row_mask:0xf bank_mask:0xf
v_add_f32_dpp v49, v49, v49 row_ror:2 row_mask:0xf bank_mask:0xf
s_nop 1
v_add_f32_dpp v48, v48, v48 row_ror:1 row_mask:0xf bank_mask:0xf
v_add_f32_dpp v49, v49, v49 row_ror:1 row_mask:0xf bank_mask:0xf
v_mov_b32 v50, v48
v_mov_b32 v51, v49
s_nop 1
v_permlane16_swap_b32 v50, v48
v_permlane16_swap_b32 v51, v49
v_add_f32 v48, v48, v50
v_add_f32 v49, v49, v51
v_mov_b32 v50, v48
v_mov_b32 v51, v49
s_nop 1
v_permlane32_swap_b32 v50, v48
v_permlane32_swap_b32 v51, v49
v_add_f32 v48, v48, v50
v_add_f32 v49, v49, v51
v_mul_f32 v48, 0xbfb8aa3b, v48
v_mul_f32 v49, 0xbfb8aa3b, v49
v_exp_f32 v48, v48
v_exp_f32 v49, v49
s_nop 0
v_add_f32 v48, 1.0, v48
v_add_f32 v49, 1.0, v49
v_rcp_f32 v48, v48
v_rcp_f32 v49, v49
v_cmp_eq_u32 vcc, 0, v0
s_nop 1
s_and_saveexec_b64 s[92:93], vcc
buffer_store_dwordx2 v[48:49], v0, s[88:91], s10 offen
s_mov_b64 exec, s[92:93]
s_waitcnt vmcnt(17)
s_barrier
ds_read_b128 a[0:3], v8 offset:0
ds_read_b64_tr_b16 a[32:33], v12 offset:0
ds_read_b64_tr_b16 a[34:35], v12 offset:1024
ds_read_b64_tr_b16 a[36:37], v13 offset:0
ds_read_b64_tr_b16 a[38:39], v13 offset:1024
ds_read_b64_tr_b16 a[40:41], v12 offset:256
ds_read_b64_tr_b16 a[42:43], v12 offset:1280
ds_read_b64_tr_b16 a[44:45], v13 offset:256
ds_read_b64_tr_b16 a[46:47], v13 offset:1280
ds_read_b64_tr_b16 a[48:49], v12 offset:16384
ds_read_b64_tr_b16 a[50:51], v12 offset:17408
ds_read_b64_tr_b16 a[52:53], v13 offset:16384
ds_read_b64_tr_b16 a[54:55], v13 offset:17408
ds_read_b64_tr_b16 a[56:57], v12 offset:16640
ds_read_b64_tr_b16 a[58:59], v12 offset:17664
ds_read_b64_tr_b16 a[60:61], v13 offset:16640
ds_read_b64_tr_b16 a[62:63], v13 offset:17664
ds_read_b128 a[4:7], v8 offset:2048
ds_read_b128 a[8:11], v8 offset:4096
ds_read_b128 a[12:15], v8 offset:6144
ds_read_b128 a[16:19], v8 offset:8192
ds_read_b128 a[20:23], v8 offset:10240
ds_read_b128 a[24:27], v8 offset:12288
ds_read_b128 a[28:31], v8 offset:14336
s_waitcnt lgkmcnt(0)
v_mfma_f32_16x16x32_bf16 v[24:27], a[32:35], a[0:3], 0
ds_read_b128 a[64:67], v9 offset:0
v_mfma_f32_16x16x32_bf16 v[28:31], a[36:39], a[0:3], 0
v_mfma_f32_16x16x32_bf16 v[32:35], a[40:43], a[0:3], 0
ds_read_b64_tr_b16 a[96:97], v12 offset:8192
v_mfma_f32_16x16x32_bf16 v[36:39], a[44:47], a[0:3], 0
v_mfma_f32_16x16x32_bf16 v[152:155], a[0:3], a[48:51], 0
ds_read_b64_tr_b16 a[98:99], v12 offset:9216
v_mfma_f32_16x16x32_bf16 v[160:163], a[0:3], a[52:55], 0
v_mfma_f32_16x16x32_bf16 v[168:171], a[0:3], a[56:59], 0
v_mfma_f32_16x16x32_bf16 v[176:179], a[0:3], a[60:63], 0
ds_read_b64_tr_b16 a[100:101], v13 offset:8192
v_mfma_f32_16x16x32_bf16 v[180:183], a[4:7], a[60:63], 0
v_mfma_f32_16x16x32_bf16 v[172:175], a[4:7], a[56:59], 0
ds_read_b64_tr_b16 a[102:103], v13 offset:9216
v_mfma_f32_16x16x32_bf16 v[164:167], a[4:7], a[52:55], 0
v_mfma_f32_16x16x32_bf16 v[156:159], a[4:7], a[48:51], 0
ds_read_b64_tr_b16 a[104:105], v12 offset:8448
v_mfma_f32_16x16x32_bf16 v[52:55], a[44:47], a[4:7], 0
v_mfma_f32_16x16x32_bf16 v[48:51], a[40:43], a[4:7], 0
v_mfma_f32_16x16x32_bf16 v[44:47], a[36:39], a[4:7], 0
ds_read_b64_tr_b16 a[106:107], v12 offset:9472
v_mfma_f32_16x16x32_bf16 v[40:43], a[32:35], a[4:7], 0
v_mfma_f32_16x16x32_bf16 v[56:59], a[32:35], a[8:11], 0
ds_read_b64_tr_b16 a[108:109], v13 offset:8448
v_mfma_f32_16x16x32_bf16 v[60:63], a[36:39], a[8:11], 0
v_mfma_f32_16x16x32_bf16 v[64:67], a[40:43], a[8:11], 0
ds_read_b64_tr_b16 a[110:111], v13 offset:9472
v_mfma_f32_16x16x32_bf16 v[68:71], a[44:47], a[8:11], 0
v_mfma_f32_16x16x32_bf16 v[184:187], a[8:11], a[48:51], 0
v_mfma_f32_16x16x32_bf16 v[192:195], a[8:11], a[52:55], 0
ds_read_b64_tr_b16 a[112:113], v12 offset:24576
v_mfma_f32_16x16x32_bf16 v[200:203], a[8:11], a[56:59], 0
v_mfma_f32_16x16x32_bf16 v[208:211], a[8:11], a[60:63], 0
ds_read_b64_tr_b16 a[114:115], v12 offset:25600
v_mfma_f32_16x16x32_bf16 v[212:215], a[12:15], a[60:63], 0
v_mfma_f32_16x16x32_bf16 v[204:207], a[12:15], a[56:59], 0
ds_read_b64_tr_b16 a[116:117], v13 offset:24576
v_mfma_f32_16x16x32_bf16 v[196:199], a[12:15], a[52:55], 0
v_mfma_f32_16x16x32_bf16 v[188:191], a[12:15], a[48:51], 0
v_mfma_f32_16x16x32_bf16 v[84:87], a[44:47], a[12:15], 0
ds_read_b64_tr_b16 a[118:119], v13 offset:25600
v_mfma_f32_16x16x32_bf16 v[80:83], a[40:43], a[12:15], 0
v_mfma_f32_16x16x32_bf16 v[76:79], a[36:39], a[12:15], 0
ds_read_b64_tr_b16 a[120:121], v12 offset:24832
v_mfma_f32_16x16x32_bf16 v[72:75], a[32:35], a[12:15], 0
v_mfma_f32_16x16x32_bf16 v[88:91], a[32:35], a[16:19], 0
ds_read_b64_tr_b16 a[122:123], v12 offset:25856
v_mfma_f32_16x16x32_bf16 v[92:95], a[36:39], a[16:19], 0
v_mfma_f32_16x16x32_bf16 v[96:99], a[40:43], a[16:19], 0
v_mfma_f32_16x16x32_bf16 v[100:103], a[44:47], a[16:19], 0
ds_read_b64_tr_b16 a[124:125], v13 offset:24832
v_mfma_f32_16x16x32_bf16 v[216:219], a[16:19], a[48:51], 0
v_mfma_f32_16x16x32_bf16 v[224:227], a[16:19], a[52:55], 0
ds_read_b64_tr_b16 a[126:127], v13 offset:25856
v_mfma_f32_16x16x32_bf16 v[232:235], a[16:19], a[56:59], 0
v_mfma_f32_16x16x32_bf16 v[240:243], a[16:19], a[60:63], 0
ds_read_b128 a[68:71], v9 offset:2048
v_mfma_f32_16x16x32_bf16 v[244:247], a[20:23], a[60:63], 0
v_mfma_f32_16x16x32_bf16 v[236:239], a[20:23], a[56:59], 0
v_mfma_f32_16x16x32_bf16 v[228:231], a[20:23], a[52:55], 0
ds_read_b128 a[72:75], v9 offset:4096
v_mfma_f32_16x16x32_bf16 v[220:223], a[20:23], a[48:51], 0
v_mfma_f32_16x16x32_bf16 v[116:119], a[44:47], a[20:23], 0
ds_read_b128 a[76:79], v9 offset:6144
v_mfma_f32_16x16x32_bf16 v[112:115], a[40:43], a[20:23], 0
v_mfma_f32_16x16x32_bf16 v[108:111], a[36:39], a[20:23], 0
ds_read_b128 a[80:83], v9 offset:8192
v_mfma_f32_16x16x32_bf16 v[104:107], a[32:35], a[20:23], 0
v_mfma_f32_16x16x32_bf16 v[120:123], a[32:35], a[24:27], 0
v_mfma_f32_16x16x32_bf16 v[124:127], a[36:39], a[24:27], 0
ds_read_b128 a[84:87], v9 offset:10240
v_mfma_f32_16x16x32_bf16 v[128:131], a[40:43], a[24:27], 0
v_mfma_f32_16x16x32_bf16 v[132:135], a[44:47], a[24:27], 0
ds_read_b128 a[88:91], v9 offset:12288
v_mfma_f32_16x16x32_bf16 v[248:251], a[24:27], a[48:51], 0
v_mfma_f32_16x16x32_bf16 a[128:131], a[24:27], a[52:55], 0
ds_read_b128 a[92:95], v9 offset:14336
v_mfma_f32_16x16x32_bf16 a[136:139], a[24:27], a[56:59], 0
v_mfma_f32_16x16x32_bf16 a[144:147], a[24:27], a[60:63], 0
v_mfma_f32_16x16x32_bf16 a[148:151], a[28:31], a[60:63], 0
v_mfma_f32_16x16x32_bf16 a[140:143], a[28:31], a[56:59], 0
v_mfma_f32_16x16x32_bf16 a[132:135], a[28:31], a[52:55], 0
v_mfma_f32_16x16x32_bf16 v[252:255], a[28:31], a[48:51], 0
v_mfma_f32_16x16x32_bf16 v[148:151], a[44:47], a[28:31], 0
v_mfma_f32_16x16x32_bf16 v[144:147], a[40:43], a[28:31], 0
v_mfma_f32_16x16x32_bf16 v[140:143], a[36:39], a[28:31], 0
v_mfma_f32_16x16x32_bf16 v[136:139], a[32:35], a[28:31], 0
s_mov_b32 s15, 3
L_p1_loop:
s_waitcnt vmcnt(0) lgkmcnt(0)
s_barrier
v_mfma_f32_16x16x32_bf16 v[24:27], a[96:99], a[64:67], v[24:27]
s_add_u32 m0, s17, 0x0
ds_read_b128 a[0:3], v8 offset:32768
v_mfma_f32_16x16x32_bf16 v[28:31], a[100:103], a[64:67], v[28:31]
buffer_load_dwordx4 v5, s[56:59], 0 offen lds
v_mfma_f32_16x16x32_bf16 v[32:35], a[104:107], a[64:67], v[32:35]
ds_read_b64_tr_b16 a[32:33], v12 offset:32768
v_mfma_f32_16x16x32_bf16 v[36:39], a[108:111], a[64:67], v[36:39]
s_add_u32 m0, s17, 0x4000
v_mfma_f32_16x16x32_bf16 v[152:155], a[64:67], a[112:115], v[152:155]
buffer_load_dwordx4 v5, s[60:63], 0 offen lds
v_mfma_f32_16x16x32_bf16 v[160:163], a[64:67], a[116:119], v[160:163]
ds_read_b64_tr_b16 a[34:35], v12 offset:33792
v_mfma_f32_16x16x32_bf16 v[168:171], a[64:67], a[120:123], v[168:171]
s_add_u32 m0, s17, 0x400
v_mfma_f32_16x16x32_bf16 v[176:179], a[64:67], a[124:127], v[176:179]
buffer_load_dwordx4 v5, s[56:59], s13 offen lds
v_mfma_f32_16x16x32_bf16 v[180:183], a[68:71], a[124:127], v[180:183]
ds_read_b64_tr_b16 a[36:37], v13 offset:32768
v_mfma_f32_16x16x32_bf16 v[172:175], a[68:71], a[120:123], v[172:175]
s_add_u32 m0, s17, 0x4400
ds_read_b64_tr_b16 a[38:39], v13 offset:33792
v_mfma_f32_16x16x32_bf16 v[164:167], a[68:71], a[116:119], v[164:167]
buffer_load_dwordx4 v5, s[60:63], s13 offen lds
v_mfma_f32_16x16x32_bf16 v[156:159], a[68:71], a[112:115], v[156:159]
v_mfma_f32_16x16x32_bf16 v[52:55], a[108:111], a[68:71], v[52:55]
s_add_u32 m0, s17, 0x800
ds_read_b64_tr_b16 a[40:41], v12 offset:33024
v_mfma_f32_16x16x32_bf16 v[48:51], a[104:107], a[68:71], v[48:51]
buffer_load_dwordx4 v6, s[56:59], 0 offen lds
v_mfma_f32_16x16x32_bf16 v[44:47], a[100:103], a[68:71], v[44:47]
v_mfma_f32_16x16x32_bf16 v[40:43], a[96:99], a[68:71], v[40:43]
s_add_u32 m0, s17, 0x4800
ds_read_b64_tr_b16 a[42:43], v12 offset:34048
v_mfma_f32_16x16x32_bf16 v[56:59], a[96:99], a[72:75], v[56:59]
buffer_load_dwordx4 v6, s[60:63], 0 offen lds
v_mfma_f32_16x16x32_bf16 v[60:63], a[100:103], a[72:75], v[60:63]
ds_read_b64_tr_b16 a[44:45], v13 offset:33024
v_mfma_f32_16x16x32_bf16 v[64:67], a[104:107], a[72:75], v[64:67]
s_add_u32 m0, s17, 0xc00
v_mfma_f32_16x16x32_bf16 v[68:71], a[108:111], a[72:75], v[68:71]
buffer_load_dwordx4 v6, s[56:59], s13 offen lds
v_mfma_f32_16x16x32_bf16 v[184:187], a[72:75], a[112:115], v[184:187]
ds_read_b64_tr_b16 a[46:47], v13 offset:34048
v_mfma_f32_16x16x32_bf16 v[192:195], a[72:75], a[116:119], v[192:195]
s_add_u32 m0, s17, 0x4c00
v_mfma_f32_16x16x32_bf16 v[200:203], a[72:75], a[120:123], v[200:203]
buffer_load_dwordx4 v6, s[60:63], s13 offen lds
v_mfma_f32_16x16x32_bf16 v[208:211], a[72:75], a[124:127], v[208:211]
ds_read_b64_tr_b16 a[48:49], v12 offset:49152
v_mfma_f32_16x16x32_bf16 v[212:215], a[76:79], a[124:127], v[212:215]
s_add_u32 m0, s16, 0x0
ds_read_b64_tr_b16 a[50:51], v12 offset:50176
v_mfma_f32_16x16x32_bf16 v[204:207], a[76:79], a[120:123], v[204:207]
buffer_load_dwordx4 v2, s[48:51], 0 offen lds
v_mfma_f32_16x16x32_bf16 v[196:199], a[76:79], a[116:119], v[196:199]
v_mfma_f32_16x16x32_bf16 v[188:191], a[76:79], a[112:115], v[188:191]
s_add_u32 m0, s16, 0x400
ds_read_b64_tr_b16 a[52:53], v13 offset:49152
v_mfma_f32_16x16x32_bf16 v[84:87], a[108:111], a[76:79], v[84:87]
buffer_load_dwordx4 v3, s[48:51], 0 offen lds
v_mfma_f32_16x16x32_bf16 v[80:83], a[104:107], a[76:79], v[80:83]
v_mfma_f32_16x16x32_bf16 v[76:79], a[100:103], a[76:79], v[76:79]
s_add_u32 m0, s16, 0x800
ds_read_b64_tr_b16 a[54:55], v13 offset:50176
v_mfma_f32_16x16x32_bf16 v[72:75], a[96:99], a[76:79], v[72:75]
buffer_load_dwordx4 v2, s[48:51], s12 offen lds
v_mfma_f32_16x16x32_bf16 v[88:91], a[96:99], a[80:83], v[88:91]
ds_read_b64_tr_b16 a[56:57], v12 offset:49408
v_mfma_f32_16x16x32_bf16 v[92:95], a[100:103], a[80:83], v[92:95]
s_add_u32 m0, s16, 0xc00
v_mfma_f32_16x16x32_bf16 v[96:99], a[104:107], a[80:83], v[96:99]
buffer_load_dwordx4 v3, s[48:51], s12 offen lds
v_mfma_f32_16x16x32_bf16 v[100:103], a[108:111], a[80:83], v[100:103]
ds_read_b64_tr_b16 a[58:59], v12 offset:50432
v_mfma_f32_16x16x32_bf16 v[216:219], a[80:83], a[112:115], v[216:219]
s_add_u32 m0, s16, 0x1000
v_mfma_f32_16x16x32_bf16 v[224:227], a[80:83], a[116:119], v[224:227]
buffer_load_dwordx4 v2, s[48:51], s13 offen lds
v_mfma_f32_16x16x32_bf16 v[232:235], a[80:83], a[120:123], v[232:235]
ds_read_b64_tr_b16 a[60:61], v13 offset:49408
v_mfma_f32_16x16x32_bf16 v[240:243], a[80:83], a[124:127], v[240:243]
s_add_u32 m0, s16, 0x1400
ds_read_b64_tr_b16 a[62:63], v13 offset:50432
v_mfma_f32_16x16x32_bf16 v[244:247], a[84:87], a[124:127], v[244:247]
buffer_load_dwordx4 v3, s[48:51], s13 offen lds
v_mfma_f32_16x16x32_bf16 v[236:239], a[84:87], a[120:123], v[236:239]
v_mfma_f32_16x16x32_bf16 v[228:231], a[84:87], a[116:119], v[228:231]
s_add_u32 m0, s16, 0x1800
ds_read_b128 a[4:7], v8 offset:34816
v_mfma_f32_16x16x32_bf16 v[220:223], a[84:87], a[112:115], v[220:223]
buffer_load_dwordx4 v2, s[48:51], s14 offen lds
v_mfma_f32_16x16x32_bf16 v[116:119], a[108:111], a[84:87], v[116:119]
v_mfma_f32_16x16x32_bf16 v[112:115], a[104:107], a[84:87], v[112:115]
s_add_u32 m0, s16, 0x1c00
ds_read_b128 a[8:11], v8 offset:36864
v_mfma_f32_16x16x32_bf16 v[108:111], a[100:103], a[84:87], v[108:111]
buffer_load_dwordx4 v3, s[48:51], s14 offen lds
v_mfma_f32_16x16x32_bf16 v[104:107], a[96:99], a[84:87], v[104:107]
ds_read_b128 a[12:15], v8 offset:38912
v_mfma_f32_16x16x32_bf16 v[120:123], a[96:99], a[88:91], v[120:123]
v_mfma_f32_16x16x32_bf16 v[124:127], a[100:103], a[88:91], v[124:127]
ds_read_b128 a[16:19], v8 offset:40960
v_mfma_f32_16x16x32_bf16 v[128:131], a[104:107], a[88:91], v[128:131]
v_mfma_f32_16x16x32_bf16 v[132:135], a[108:111], a[88:91], v[132:135]
ds_read_b128 a[20:23], v8 offset:43008
v_mfma_f32_16x16x32_bf16 v[248:251], a[88:91], a[112:115], v[248:251]
ds_read_b128 a[24:27], v8 offset:45056
v_mfma_f32_16x16x32_bf16 a[128:131], a[88:91], a[116:119], a[128:131]
v_mfma_f32_16x16x32_bf16 a[136:139], a[88:91], a[120:123], a[136:139]
ds_read_b128 a[28:31], v8 offset:47104
v_mfma_f32_16x16x32_bf16 a[144:147], a[88:91], a[124:127], a[144:147]
v_mfma_f32_16x16x32_bf16 a[148:151], a[92:95], a[124:127], a[148:151]
v_mfma_f32_16x16x32_bf16 a[140:143], a[92:95], a[120:123], a[140:143]
v_mfma_f32_16x16x32_bf16 a[132:135], a[92:95], a[116:119], a[132:135]
v_mfma_f32_16x16x32_bf16 v[252:255], a[92:95], a[112:115], v[252:255]
v_mfma_f32_16x16x32_bf16 v[148:151], a[108:111], a[92:95], v[148:151]
v_mfma_f32_16x16x32_bf16 v[144:147], a[104:107], a[92:95], v[144:147]
v_mfma_f32_16x16x32_bf16 v[140:143], a[100:103], a[92:95], v[140:143]
v_add_u32 v2, 0x80, v2
v_add_u32 v3, 0x80, v3
v_mfma_f32_16x16x32_bf16 v[136:139], a[96:99], a[92:95], v[136:139]
v_add_u32 v5, 0x80000, v5
v_add_u32 v6, 0x80000, v6
s_waitcnt lgkmcnt(0)
v_mfma_f32_16x16x32_bf16 v[24:27], a[32:35], a[0:3], v[24:27]
ds_read_b128 a[64:67], v9 offset:32768
v_mfma_f32_16x16x32_bf16 v[28:31], a[36:39], a[0:3], v[28:31]
v_mfma_f32_16x16x32_bf16 v[32:35], a[40:43], a[0:3], v[32:35]
ds_read_b64_tr_b16 a[96:97], v12 offset:40960
v_mfma_f32_16x16x32_bf16 v[36:39], a[44:47], a[0:3], v[36:39]
v_mfma_f32_16x16x32_bf16 v[152:155], a[0:3], a[48:51], v[152:155]
ds_read_b64_tr_b16 a[98:99], v12 offset:41984
v_mfma_f32_16x16x32_bf16 v[160:163], a[0:3], a[52:55], v[160:163]
v_mfma_f32_16x16x32_bf16 v[168:171], a[0:3], a[56:59], v[168:171]
v_mfma_f32_16x16x32_bf16 v[176:179], a[0:3], a[60:63], v[176:179]
ds_read_b64_tr_b16 a[100:101], v13 offset:40960
v_mfma_f32_16x16x32_bf16 v[180:183], a[4:7], a[60:63], v[180:183]
v_mfma_f32_16x16x32_bf16 v[172:175], a[4:7], a[56:59], v[172:175]
ds_read_b64_tr_b16 a[102:103], v13 offset:41984
v_mfma_f32_16x16x32_bf16 v[164:167], a[4:7], a[52:55], v[164:167]
v_mfma_f32_16x16x32_bf16 v[156:159], a[4:7], a[48:51], v[156:159]
ds_read_b64_tr_b16 a[104:105], v12 offset:41216
v_mfma_f32_16x16x32_bf16 v[52:55], a[44:47], a[4:7], v[52:55]
v_mfma_f32_16x16x32_bf16 v[48:51], a[40:43], a[4:7], v[48:51]
v_mfma_f32_16x16x32_bf16 v[44:47], a[36:39], a[4:7], v[44:47]
ds_read_b64_tr_b16 a[106:107], v12 offset:42240
v_mfma_f32_16x16x32_bf16 v[40:43], a[32:35], a[4:7], v[40:43]
v_mfma_f32_16x16x32_bf16 v[56:59], a[32:35], a[8:11], v[56:59]
ds_read_b64_tr_b16 a[108:109], v13 offset:41216
v_mfma_f32_16x16x32_bf16 v[60:63], a[36:39], a[8:11], v[60:63]
v_mfma_f32_16x16x32_bf16 v[64:67], a[40:43], a[8:11], v[64:67]
ds_read_b64_tr_b16 a[110:111], v13 offset:42240
v_mfma_f32_16x16x32_bf16 v[68:71], a[44:47], a[8:11], v[68:71]
v_mfma_f32_16x16x32_bf16 v[184:187], a[8:11], a[48:51], v[184:187]
v_mfma_f32_16x16x32_bf16 v[192:195], a[8:11], a[52:55], v[192:195]
ds_read_b64_tr_b16 a[112:113], v12 offset:57344
v_mfma_f32_16x16x32_bf16 v[200:203], a[8:11], a[56:59], v[200:203]
v_mfma_f32_16x16x32_bf16 v[208:211], a[8:11], a[60:63], v[208:211]
ds_read_b64_tr_b16 a[114:115], v12 offset:58368
v_mfma_f32_16x16x32_bf16 v[212:215], a[12:15], a[60:63], v[212:215]
v_mfma_f32_16x16x32_bf16 v[204:207], a[12:15], a[56:59], v[204:207]
ds_read_b64_tr_b16 a[116:117], v13 offset:57344
v_mfma_f32_16x16x32_bf16 v[196:199], a[12:15], a[52:55], v[196:199]
v_mfma_f32_16x16x32_bf16 v[188:191], a[12:15], a[48:51], v[188:191]
v_mfma_f32_16x16x32_bf16 v[84:87], a[44:47], a[12:15], v[84:87]
ds_read_b64_tr_b16 a[118:119], v13 offset:58368
v_mfma_f32_16x16x32_bf16 v[80:83], a[40:43], a[12:15], v[80:83]
v_mfma_f32_16x16x32_bf16 v[76:79], a[36:39], a[12:15], v[76:79]
ds_read_b64_tr_b16 a[120:121], v12 offset:57600
v_mfma_f32_16x16x32_bf16 v[72:75], a[32:35], a[12:15], v[72:75]
v_mfma_f32_16x16x32_bf16 v[88:91], a[32:35], a[16:19], v[88:91]
ds_read_b64_tr_b16 a[122:123], v12 offset:58624
v_mfma_f32_16x16x32_bf16 v[92:95], a[36:39], a[16:19], v[92:95]
v_mfma_f32_16x16x32_bf16 v[96:99], a[40:43], a[16:19], v[96:99]
v_mfma_f32_16x16x32_bf16 v[100:103], a[44:47], a[16:19], v[100:103]
ds_read_b64_tr_b16 a[124:125], v13 offset:57600
v_mfma_f32_16x16x32_bf16 v[216:219], a[16:19], a[48:51], v[216:219]
v_mfma_f32_16x16x32_bf16 v[224:227], a[16:19], a[52:55], v[224:227]
ds_read_b64_tr_b16 a[126:127], v13 offset:58624
v_mfma_f32_16x16x32_bf16 v[232:235], a[16:19], a[56:59], v[232:235]
v_mfma_f32_16x16x32_bf16 v[240:243], a[16:19], a[60:63], v[240:243]
ds_read_b128 a[68:71], v9 offset:34816
v_mfma_f32_16x16x32_bf16 v[244:247], a[20:23], a[60:63], v[244:247]
v_mfma_f32_16x16x32_bf16 v[236:239], a[20:23], a[56:59], v[236:239]
v_mfma_f32_16x16x32_bf16 v[228:231], a[20:23], a[52:55], v[228:231]
ds_read_b128 a[72:75], v9 offset:36864
v_mfma_f32_16x16x32_bf16 v[220:223], a[20:23], a[48:51], v[220:223]
v_mfma_f32_16x16x32_bf16 v[116:119], a[44:47], a[20:23], v[116:119]
ds_read_b128 a[76:79], v9 offset:38912
v_mfma_f32_16x16x32_bf16 v[112:115], a[40:43], a[20:23], v[112:115]
v_mfma_f32_16x16x32_bf16 v[108:111], a[36:39], a[20:23], v[108:111]
ds_read_b128 a[80:83], v9 offset:40960
v_mfma_f32_16x16x32_bf16 v[104:107], a[32:35], a[20:23], v[104:107]
v_mfma_f32_16x16x32_bf16 v[120:123], a[32:35], a[24:27], v[120:123]
v_mfma_f32_16x16x32_bf16 v[124:127], a[36:39], a[24:27], v[124:127]
ds_read_b128 a[84:87], v9 offset:43008
v_mfma_f32_16x16x32_bf16 v[128:131], a[40:43], a[24:27], v[128:131]
v_mfma_f32_16x16x32_bf16 v[132:135], a[44:47], a[24:27], v[132:135]
ds_read_b128 a[88:91], v9 offset:45056
v_mfma_f32_16x16x32_bf16 v[248:251], a[24:27], a[48:51], v[248:251]
v_mfma_f32_16x16x32_bf16 a[128:131], a[24:27], a[52:55], a[128:131]
ds_read_b128 a[92:95], v9 offset:47104
v_mfma_f32_16x16x32_bf16 a[136:139], a[24:27], a[56:59], a[136:139]
v_mfma_f32_16x16x32_bf16 a[144:147], a[24:27], a[60:63], a[144:147]
v_mfma_f32_16x16x32_bf16 a[148:151], a[28:31], a[60:63], a[148:151]
v_mfma_f32_16x16x32_bf16 a[140:143], a[28:31], a[56:59], a[140:143]
v_mfma_f32_16x16x32_bf16 a[132:135], a[28:31], a[52:55], a[132:135]
v_mfma_f32_16x16x32_bf16 v[252:255], a[28:31], a[48:51], v[252:255]
v_mfma_f32_16x16x32_bf16 v[148:151], a[44:47], a[28:31], v[148:151]
v_mfma_f32_16x16x32_bf16 v[144:147], a[40:43], a[28:31], v[144:147]
v_mfma_f32_16x16x32_bf16 v[140:143], a[36:39], a[28:31], v[140:143]
v_mfma_f32_16x16x32_bf16 v[136:139], a[32:35], a[28:31], v[136:139]
s_waitcnt vmcnt(0) lgkmcnt(0)
s_barrier
v_mfma_f32_16x16x32_bf16 v[24:27], a[96:99], a[64:67], v[24:27]
s_add_u32 m0, s17, 0x8000
ds_read_b128 a[0:3], v8 offset:0
v_mfma_f32_16x16x32_bf16 v[28:31], a[100:103], a[64:67], v[28:31]
buffer_load_dwordx4 v5, s[56:59], 0 offen lds
v_mfma_f32_16x16x32_bf16 v[32:35], a[104:107], a[64:67], v[32:35]
ds_read_b64_tr_b16 a[32:33], v12 offset:0
v_mfma_f32_16x16x32_bf16 v[36:39], a[108:111], a[64:67], v[36:39]
s_add_u32 m0, s17, 0xc000
v_mfma_f32_16x16x32_bf16 v[152:155], a[64:67], a[112:115], v[152:155]
buffer_load_dwordx4 v5, s[60:63], 0 offen lds
v_mfma_f32_16x16x32_bf16 v[160:163], a[64:67], a[116:119], v[160:163]
ds_read_b64_tr_b16 a[34:35], v12 offset:1024
v_mfma_f32_16x16x32_bf16 v[168:171], a[64:67], a[120:123], v[168:171]
s_add_u32 m0, s17, 0x8400
v_mfma_f32_16x16x32_bf16 v[176:179], a[64:67], a[124:127], v[176:179]
buffer_load_dwordx4 v5, s[56:59], s13 offen lds
v_mfma_f32_16x16x32_bf16 v[180:183], a[68:71], a[124:127], v[180:183]
ds_read_b64_tr_b16 a[36:37], v13 offset:0
v_mfma_f32_16x16x32_bf16 v[172:175], a[68:71], a[120:123], v[172:175]
s_add_u32 m0, s17, 0xc400
ds_read_b64_tr_b16 a[38:39], v13 offset:1024
v_mfma_f32_16x16x32_bf16 v[164:167], a[68:71], a[116:119], v[164:167]
buffer_load_dwordx4 v5, s[60:63], s13 offen lds
v_mfma_f32_16x16x32_bf16 v[156:159], a[68:71], a[112:115], v[156:159]
v_mfma_f32_16x16x32_bf16 v[52:55], a[108:111], a[68:71], v[52:55]
s_add_u32 m0, s17, 0x8800
ds_read_b64_tr_b16 a[40:41], v12 offset:256
v_mfma_f32_16x16x32_bf16 v[48:51], a[104:107], a[68:71], v[48:51]
buffer_load_dwordx4 v6, s[56:59], 0 offen lds
v_mfma_f32_16x16x32_bf16 v[44:47], a[100:103], a[68:71], v[44:47]
v_mfma_f32_16x16x32_bf16 v[40:43], a[96:99], a[68:71], v[40:43]
s_add_u32 m0, s17, 0xc800
ds_read_b64_tr_b16 a[42:43], v12 offset:1280
v_mfma_f32_16x16x32_bf16 v[56:59], a[96:99], a[72:75], v[56:59]
buffer_load_dwordx4 v6, s[60:63], 0 offen lds
v_mfma_f32_16x16x32_bf16 v[60:63], a[100:103], a[72:75], v[60:63]
ds_read_b64_tr_b16 a[44:45], v13 offset:256
v_mfma_f32_16x16x32_bf16 v[64:67], a[104:107], a[72:75], v[64:67]
s_add_u32 m0, s17, 0x8c00
v_mfma_f32_16x16x32_bf16 v[68:71], a[108:111], a[72:75], v[68:71]
buffer_load_dwordx4 v6, s[56:59], s13 offen lds
v_mfma_f32_16x16x32_bf16 v[184:187], a[72:75], a[112:115], v[184:187]
ds_read_b64_tr_b16 a[46:47], v13 offset:1280
v_mfma_f32_16x16x32_bf16 v[192:195], a[72:75], a[116:119], v[192:195]
s_add_u32 m0, s17, 0xcc00
v_mfma_f32_16x16x32_bf16 v[200:203], a[72:75], a[120:123], v[200:203]
buffer_load_dwordx4 v6, s[60:63], s13 offen lds
v_mfma_f32_16x16x32_bf16 v[208:211], a[72:75], a[124:127], v[208:211]
ds_read_b64_tr_b16 a[48:49], v12 offset:16384
v_mfma_f32_16x16x32_bf16 v[212:215], a[76:79], a[124:127], v[212:215]
s_add_u32 m0, s16, 0x8000
ds_read_b64_tr_b16 a[50:51], v12 offset:17408
v_mfma_f32_16x16x32_bf16 v[204:207], a[76:79], a[120:123], v[204:207]
buffer_load_dwordx4 v2, s[48:51], 0 offen lds
v_mfma_f32_16x16x32_bf16 v[196:199], a[76:79], a[116:119], v[196:199]
v_mfma_f32_16x16x32_bf16 v[188:191], a[76:79], a[112:115], v[188:191]
s_add_u32 m0, s16, 0x8400
ds_read_b64_tr_b16 a[52:53], v13 offset:16384
v_mfma_f32_16x16x32_bf16 v[84:87], a[108:111], a[76:79], v[84:87]
buffer_load_dwordx4 v3, s[48:51], 0 offen lds
v_mfma_f32_16x16x32_bf16 v[80:83], a[104:107], a[76:79], v[80:83]
v_mfma_f32_16x16x32_bf16 v[76:79], a[100:103], a[76:79], v[76:79]
s_add_u32 m0, s16, 0x8800
ds_read_b64_tr_b16 a[54:55], v13 offset:17408
v_mfma_f32_16x16x32_bf16 v[72:75], a[96:99], a[76:79], v[72:75]
buffer_load_dwordx4 v2, s[48:51], s12 offen lds
v_mfma_f32_16x16x32_bf16 v[88:91], a[96:99], a[80:83], v[88:91]
ds_read_b64_tr_b16 a[56:57], v12 offset:16640
v_mfma_f32_16x16x32_bf16 v[92:95], a[100:103], a[80:83], v[92:95]
s_add_u32 m0, s16, 0x8c00
v_mfma_f32_16x16x32_bf16 v[96:99], a[104:107], a[80:83], v[96:99]
buffer_load_dwordx4 v3, s[48:51], s12 offen lds
v_mfma_f32_16x16x32_bf16 v[100:103], a[108:111], a[80:83], v[100:103]
ds_read_b64_tr_b16 a[58:59], v12 offset:17664
v_mfma_f32_16x16x32_bf16 v[216:219], a[80:83], a[112:115], v[216:219]
s_add_u32 m0, s16, 0x9000
v_mfma_f32_16x16x32_bf16 v[224:227], a[80:83], a[116:119], v[224:227]
buffer_load_dwordx4 v2, s[48:51], s13 offen lds
v_mfma_f32_16x16x32_bf16 v[232:235], a[80:83], a[120:123], v[232:235]
ds_read_b64_tr_b16 a[60:61], v13 offset:16640
v_mfma_f32_16x16x32_bf16 v[240:243], a[80:83], a[124:127], v[240:243]
s_add_u32 m0, s16, 0x9400
ds_read_b64_tr_b16 a[62:63], v13 offset:17664
v_mfma_f32_16x16x32_bf16 v[244:247], a[84:87], a[124:127], v[244:247]
buffer_load_dwordx4 v3, s[48:51], s13 offen lds
v_mfma_f32_16x16x32_bf16 v[236:239], a[84:87], a[120:123], v[236:239]
v_mfma_f32_16x16x32_bf16 v[228:231], a[84:87], a[116:119], v[228:231]
s_add_u32 m0, s16, 0x9800
ds_read_b128 a[4:7], v8 offset:2048
v_mfma_f32_16x16x32_bf16 v[220:223], a[84:87], a[112:115], v[220:223]
buffer_load_dwordx4 v2, s[48:51], s14 offen lds
v_mfma_f32_16x16x32_bf16 v[116:119], a[108:111], a[84:87], v[116:119]
v_mfma_f32_16x16x32_bf16 v[112:115], a[104:107], a[84:87], v[112:115]
s_add_u32 m0, s16, 0x9c00
ds_read_b128 a[8:11], v8 offset:4096
v_mfma_f32_16x16x32_bf16 v[108:111], a[100:103], a[84:87], v[108:111]
buffer_load_dwordx4 v3, s[48:51], s14 offen lds
v_mfma_f32_16x16x32_bf16 v[104:107], a[96:99], a[84:87], v[104:107]
ds_read_b128 a[12:15], v8 offset:6144
v_mfma_f32_16x16x32_bf16 v[120:123], a[96:99], a[88:91], v[120:123]
v_mfma_f32_16x16x32_bf16 v[124:127], a[100:103], a[88:91], v[124:127]
ds_read_b128 a[16:19], v8 offset:8192
v_mfma_f32_16x16x32_bf16 v[128:131], a[104:107], a[88:91], v[128:131]
v_mfma_f32_16x16x32_bf16 v[132:135], a[108:111], a[88:91], v[132:135]
ds_read_b128 a[20:23], v8 offset:10240
v_mfma_f32_16x16x32_bf16 v[248:251], a[88:91], a[112:115], v[248:251]
ds_read_b128 a[24:27], v8 offset:12288
v_mfma_f32_16x16x32_bf16 a[128:131], a[88:91], a[116:119], a[128:131]
v_mfma_f32_16x16x32_bf16 a[136:139], a[88:91], a[120:123], a[136:139]
ds_read_b128 a[28:31], v8 offset:14336
v_mfma_f32_16x16x32_bf16 a[144:147], a[88:91], a[124:127], a[144:147]
v_mfma_f32_16x16x32_bf16 a[148:151], a[92:95], a[124:127], a[148:151]
v_mfma_f32_16x16x32_bf16 a[140:143], a[92:95], a[120:123], a[140:143]
v_mfma_f32_16x16x32_bf16 a[132:135], a[92:95], a[116:119], a[132:135]
v_mfma_f32_16x16x32_bf16 v[252:255], a[92:95], a[112:115], v[252:255]
v_mfma_f32_16x16x32_bf16 v[148:151], a[108:111], a[92:95], v[148:151]
v_mfma_f32_16x16x32_bf16 v[144:147], a[104:107], a[92:95], v[144:147]
v_mfma_f32_16x16x32_bf16 v[140:143], a[100:103], a[92:95], v[140:143]
v_add_u32 v2, 0x80, v2
v_add_u32 v3, 0x80, v3
v_mfma_f32_16x16x32_bf16 v[136:139], a[96:99], a[92:95], v[136:139]
v_add_u32 v5, 0x80000, v5
v_add_u32 v6, 0x80000, v6
s_waitcnt lgkmcnt(0)
v_mfma_f32_16x16x32_bf16 v[24:27], a[32:35], a[0:3], v[24:27]
ds_read_b128 a[64:67], v9 offset:0
v_mfma_f32_16x16x32_bf16 v[28:31], a[36:39], a[0:3], v[28:31]
v_mfma_f32_16x16x32_bf16 v[32:35], a[40:43], a[0:3], v[32:35]
ds_read_b64_tr_b16 a[96:97], v12 offset:8192
v_mfma_f32_16x16x32_bf16 v[36:39], a[44:47], a[0:3], v[36:39]
v_mfma_f32_16x16x32_bf16 v[152:155], a[0:3], a[48:51], v[152:155]
ds_read_b64_tr_b16 a[98:99], v12 offset:9216
v_mfma_f32_16x16x32_bf16 v[160:163], a[0:3], a[52:55], v[160:163]
v_mfma_f32_16x16x32_bf16 v[168:171], a[0:3], a[56:59], v[168:171]
v_mfma_f32_16x16x32_bf16 v[176:179], a[0:3], a[60:63], v[176:179]
ds_read_b64_tr_b16 a[100:101], v13 offset:8192
v_mfma_f32_16x16x32_bf16 v[180:183], a[4:7], a[60:63], v[180:183]
v_mfma_f32_16x16x32_bf16 v[172:175], a[4:7], a[56:59], v[172:175]
ds_read_b64_tr_b16 a[102:103], v13 offset:9216
v_mfma_f32_16x16x32_bf16 v[164:167], a[4:7], a[52:55], v[164:167]
v_mfma_f32_16x16x32_bf16 v[156:159], a[4:7], a[48:51], v[156:159]
ds_read_b64_tr_b16 a[104:105], v12 offset:8448
v_mfma_f32_16x16x32_bf16 v[52:55], a[44:47], a[4:7], v[52:55]
v_mfma_f32_16x16x32_bf16 v[48:51], a[40:43], a[4:7], v[48:51]
v_mfma_f32_16x16x32_bf16 v[44:47], a[36:39], a[4:7], v[44:47]
ds_read_b64_tr_b16 a[106:107], v12 offset:9472
v_mfma_f32_16x16x32_bf16 v[40:43], a[32:35], a[4:7], v[40:43]
v_mfma_f32_16x16x32_bf16 v[56:59], a[32:35], a[8:11], v[56:59]
ds_read_b64_tr_b16 a[108:109], v13 offset:8448
v_mfma_f32_16x16x32_bf16 v[60:63], a[36:39], a[8:11], v[60:63]
v_mfma_f32_16x16x32_bf16 v[64:67], a[40:43], a[8:11], v[64:67]
ds_read_b64_tr_b16 a[110:111], v13 offset:9472
v_mfma_f32_16x16x32_bf16 v[68:71], a[44:47], a[8:11], v[68:71]
v_mfma_f32_16x16x32_bf16 v[184:187], a[8:11], a[48:51], v[184:187]
v_mfma_f32_16x16x32_bf16 v[192:195], a[8:11], a[52:55], v[192:195]
ds_read_b64_tr_b16 a[112:113], v12 offset:24576
v_mfma_f32_16x16x32_bf16 v[200:203], a[8:11], a[56:59], v[200:203]
v_mfma_f32_16x16x32_bf16 v[208:211], a[8:11], a[60:63], v[208:211]
ds_read_b64_tr_b16 a[114:115], v12 offset:25600
v_mfma_f32_16x16x32_bf16 v[212:215], a[12:15], a[60:63], v[212:215]
v_mfma_f32_16x16x32_bf16 v[204:207], a[12:15], a[56:59], v[204:207]
ds_read_b64_tr_b16 a[116:117], v13 offset:24576
v_mfma_f32_16x16x32_bf16 v[196:199], a[12:15], a[52:55], v[196:199]
v_mfma_f32_16x16x32_bf16 v[188:191], a[12:15], a[48:51], v[188:191]
v_mfma_f32_16x16x32_bf16 v[84:87], a[44:47], a[12:15], v[84:87]
ds_read_b64_tr_b16 a[118:119], v13 offset:25600
v_mfma_f32_16x16x32_bf16 v[80:83], a[40:43], a[12:15], v[80:83]
v_mfma_f32_16x16x32_bf16 v[76:79], a[36:39], a[12:15], v[76:79]
ds_read_b64_tr_b16 a[120:121], v12 offset:24832
v_mfma_f32_16x16x32_bf16 v[72:75], a[32:35], a[12:15], v[72:75]
v_mfma_f32_16x16x32_bf16 v[88:91], a[32:35], a[16:19], v[88:91]
ds_read_b64_tr_b16 a[122:123], v12 offset:25856
v_mfma_f32_16x16x32_bf16 v[92:95], a[36:39], a[16:19], v[92:95]
v_mfma_f32_16x16x32_bf16 v[96:99], a[40:43], a[16:19], v[96:99]
v_mfma_f32_16x16x32_bf16 v[100:103], a[44:47], a[16:19], v[100:103]
ds_read_b64_tr_b16 a[124:125], v13 offset:24832
v_mfma_f32_16x16x32_bf16 v[216:219], a[16:19], a[48:51], v[216:219]
v_mfma_f32_16x16x32_bf16 v[224:227], a[16:19], a[52:55], v[224:227]
ds_read_b64_tr_b16 a[126:127], v13 offset:25856
v_mfma_f32_16x16x32_bf16 v[232:235], a[16:19], a[56:59], v[232:235]
v_mfma_f32_16x16x32_bf16 v[240:243], a[16:19], a[60:63], v[240:243]
ds_read_b128 a[68:71], v9 offset:2048
v_mfma_f32_16x16x32_bf16 v[244:247], a[20:23], a[60:63], v[244:247]
v_mfma_f32_16x16x32_bf16 v[236:239], a[20:23], a[56:59], v[236:239]
v_mfma_f32_16x16x32_bf16 v[228:231], a[20:23], a[52:55], v[228:231]
ds_read_b128 a[72:75], v9 offset:4096
v_mfma_f32_16x16x32_bf16 v[220:223], a[20:23], a[48:51], v[220:223]
v_mfma_f32_16x16x32_bf16 v[116:119], a[44:47], a[20:23], v[116:119]
ds_read_b128 a[76:79], v9 offset:6144
v_mfma_f32_16x16x32_bf16 v[112:115], a[40:43], a[20:23], v[112:115]
v_mfma_f32_16x16x32_bf16 v[108:111], a[36:39], a[20:23], v[108:111]
ds_read_b128 a[80:83], v9 offset:8192
v_mfma_f32_16x16x32_bf16 v[104:107], a[32:35], a[20:23], v[104:107]
v_mfma_f32_16x16x32_bf16 v[120:123], a[32:35], a[24:27], v[120:123]
v_mfma_f32_16x16x32_bf16 v[124:127], a[36:39], a[24:27], v[124:127]
ds_read_b128 a[84:87], v9 offset:10240
v_mfma_f32_16x16x32_bf16 v[128:131], a[40:43], a[24:27], v[128:131]
v_mfma_f32_16x16x32_bf16 v[132:135], a[44:47], a[24:27], v[132:135]
ds_read_b128 a[88:91], v9 offset:12288
v_mfma_f32_16x16x32_bf16 v[248:251], a[24:27], a[48:51], v[248:251]
v_mfma_f32_16x16x32_bf16 a[128:131], a[24:27], a[52:55], a[128:131]
ds_read_b128 a[92:95], v9 offset:14336
v_mfma_f32_16x16x32_bf16 a[136:139], a[24:27], a[56:59], a[136:139]
v_mfma_f32_16x16x32_bf16 a[144:147], a[24:27], a[60:63], a[144:147]
v_mfma_f32_16x16x32_bf16 a[148:151], a[28:31], a[60:63], a[148:151]
v_mfma_f32_16x16x32_bf16 a[140:143], a[28:31], a[56:59], a[140:143]
v_mfma_f32_16x16x32_bf16 a[132:135], a[28:31], a[52:55], a[132:135]
v_mfma_f32_16x16x32_bf16 v[252:255], a[28:31], a[48:51], v[252:255]
v_mfma_f32_16x16x32_bf16 v[148:151], a[44:47], a[28:31], v[148:151]
v_mfma_f32_16x16x32_bf16 v[144:147], a[40:43], a[28:31], v[144:147]
v_mfma_f32_16x16x32_bf16 v[140:143], a[36:39], a[28:31], v[140:143]
v_mfma_f32_16x16x32_bf16 v[136:139], a[32:35], a[28:31], v[136:139]
s_sub_u32 s15, s15, 1
s_cmp_lg_u32 s15, 0
s_cbranch_scc1 L_p1_loop
s_waitcnt vmcnt(0) lgkmcnt(0)
s_barrier
v_mfma_f32_16x16x32_bf16 v[24:27], a[96:99], a[64:67], v[24:27]
ds_read_b128 a[0:3], v8 offset:32768
v_mfma_f32_16x16x32_bf16 v[28:31], a[100:103], a[64:67], v[28:31]
v_mfma_f32_16x16x32_bf16 v[32:35], a[104:107], a[64:67], v[32:35]
ds_read_b64_tr_b16 a[32:33], v12 offset:32768
v_mfma_f32_16x16x32_bf16 v[36:39], a[108:111], a[64:67], v[36:39]
v_mfma_f32_16x16x32_bf16 v[152:155], a[64:67], a[112:115], v[152:155]
ds_read_b64_tr_b16 a[34:35], v12 offset:33792
v_mfma_f32_16x16x32_bf16 v[160:163], a[64:67], a[116:119], v[160:163]
v_mfma_f32_16x16x32_bf16 v[168:171], a[64:67], a[120:123], v[168:171]
v_mfma_f32_16x16x32_bf16 v[176:179], a[64:67], a[124:127], v[176:179]
ds_read_b64_tr_b16 a[36:37], v13 offset:32768
v_mfma_f32_16x16x32_bf16 v[180:183], a[68:71], a[124:127], v[180:183]
v_mfma_f32_16x16x32_bf16 v[172:175], a[68:71], a[120:123], v[172:175]
ds_read_b64_tr_b16 a[38:39], v13 offset:33792
v_mfma_f32_16x16x32_bf16 v[164:167], a[68:71], a[116:119], v[164:167]
v_mfma_f32_16x16x32_bf16 v[156:159], a[68:71], a[112:115], v[156:159]
ds_read_b64_tr_b16 a[40:41], v12 offset:33024
v_mfma_f32_16x16x32_bf16 v[52:55], a[108:111], a[68:71], v[52:55]
v_mfma_f32_16x16x32_bf16 v[48:51], a[104:107], a[68:71], v[48:51]
v_mfma_f32_16x16x32_bf16 v[44:47], a[100:103], a[68:71], v[44:47]
ds_read_b64_tr_b16 a[42:43], v12 offset:34048
v_mfma_f32_16x16x32_bf16 v[40:43], a[96:99], a[68:71], v[40:43]
v_mfma_f32_16x16x32_bf16 v[56:59], a[96:99], a[72:75], v[56:59]
ds_read_b64_tr_b16 a[44:45], v13 offset:33024
v_mfma_f32_16x16x32_bf16 v[60:63], a[100:103], a[72:75], v[60:63]
v_mfma_f32_16x16x32_bf16 v[64:67], a[104:107], a[72:75], v[64:67]
ds_read_b64_tr_b16 a[46:47], v13 offset:34048
v_mfma_f32_16x16x32_bf16 v[68:71], a[108:111], a[72:75], v[68:71]
v_mfma_f32_16x16x32_bf16 v[184:187], a[72:75], a[112:115], v[184:187]
v_mfma_f32_16x16x32_bf16 v[192:195], a[72:75], a[116:119], v[192:195]
ds_read_b64_tr_b16 a[48:49], v12 offset:49152
v_mfma_f32_16x16x32_bf16 v[200:203], a[72:75], a[120:123], v[200:203]
v_mfma_f32_16x16x32_bf16 v[208:211], a[72:75], a[124:127], v[208:211]
ds_read_b64_tr_b16 a[50:51], v12 offset:50176
v_mfma_f32_16x16x32_bf16 v[212:215], a[76:79], a[124:127], v[212:215]
v_mfma_f32_16x16x32_bf16 v[204:207], a[76:79], a[120:123], v[204:207]
ds_read_b64_tr_b16 a[52:53], v13 offset:49152
v_mfma_f32_16x16x32_bf16 v[196:199], a[76:79], a[116:119], v[196:199]
v_mfma_f32_16x16x32_bf16 v[188:191], a[76:79], a[112:115], v[188:191]
v_mfma_f32_16x16x32_bf16 v[84:87], a[108:111], a[76:79], v[84:87]
ds_read_b64_tr_b16 a[54:55], v13 offset:50176
v_mfma_f32_16x16x32_bf16 v[80:83], a[104:107], a[76:79], v[80:83]
v_mfma_f32_16x16x32_bf16 v[76:79], a[100:103], a[76:79], v[76:79]
ds_read_b64_tr_b16 a[56:57], v12 offset:49408
v_mfma_f32_16x16x32_bf16 v[72:75], a[96:99], a[76:79], v[72:75]
v_mfma_f32_16x16x32_bf16 v[88:91], a[96:99], a[80:83], v[88:91]
ds_read_b64_tr_b16 a[58:59], v12 offset:50432
v_mfma_f32_16x16x32_bf16 v[92:95], a[100:103], a[80:83], v[92:95]
v_mfma_f32_16x16x32_bf16 v[96:99], a[104:107], a[80:83], v[96:99]
v_mfma_f32_16x16x32_bf16 v[100:103], a[108:111], a[80:83], v[100:103]
ds_read_b64_tr_b16 a[60:61], v13 offset:49408
v_mfma_f32_16x16x32_bf16 v[216:219], a[80:83], a[112:115], v[216:219]
v_mfma_f32_16x16x32_bf16 v[224:227], a[80:83], a[116:119], v[224:227]
ds_read_b64_tr_b16 a[62:63], v13 offset:50432
v_mfma_f32_16x16x32_bf16 v[232:235], a[80:83], a[120:123], v[232:235]
v_mfma_f32_16x16x32_bf16 v[240:243], a[80:83], a[124:127], v[240:243]
ds_read_b128 a[4:7], v8 offset:34816
v_mfma_f32_16x16x32_bf16 v[244:247], a[84:87], a[124:127], v[244:247]
v_mfma_f32_16x16x32_bf16 v[236:239], a[84:87], a[120:123], v[236:239]
v_mfma_f32_16x16x32_bf16 v[228:231], a[84:87], a[116:119], v[228:231]
ds_read_b128 a[8:11], v8 offset:36864
v_mfma_f32_16x16x32_bf16 v[220:223], a[84:87], a[112:115], v[220:223]
v_mfma_f32_16x16x32_bf16 v[116:119], a[108:111], a[84:87], v[116:119]
ds_read_b128 a[12:15], v8 offset:38912
v_mfma_f32_16x16x32_bf16 v[112:115], a[104:107], a[84:87], v[112:115]
v_mfma_f32_16x16x32_bf16 v[108:111], a[100:103], a[84:87], v[108:111]
ds_read_b128 a[16:19], v8 offset:40960
v_mfma_f32_16x16x32_bf16 v[104:107], a[96:99], a[84:87], v[104:107]
v_mfma_f32_16x16x32_bf16 v[120:123], a[96:99], a[88:91], v[120:123]
v_mfma_f32_16x16x32_bf16 v[124:127], a[100:103], a[88:91], v[124:127]
ds_read_b128 a[20:23], v8 offset:43008
v_mfma_f32_16x16x32_bf16 v[128:131], a[104:107], a[88:91], v[128:131]
v_mfma_f32_16x16x32_bf16 v[132:135], a[108:111], a[88:91], v[132:135]
ds_read_b128 a[24:27], v8 offset:45056
v_mfma_f32_16x16x32_bf16 v[248:251], a[88:91], a[112:115], v[248:251]
v_mfma_f32_16x16x32_bf16 a[128:131], a[88:91], a[116:119], a[128:131]
ds_read_b128 a[28:31], v8 offset:47104
v_mfma_f32_16x16x32_bf16 a[136:139], a[88:91], a[120:123], a[136:139]
v_mfma_f32_16x16x32_bf16 a[144:147], a[88:91], a[124:127], a[144:147]
v_mfma_f32_16x16x32_bf16 a[148:151], a[92:95], a[124:127], a[148:151]
v_mfma_f32_16x16x32_bf16 a[140:143], a[92:95], a[120:123], a[140:143]
v_mfma_f32_16x16x32_bf16 a[132:135], a[92:95], a[116:119], a[132:135]
v_mfma_f32_16x16x32_bf16 v[252:255], a[92:95], a[112:115], v[252:255]
v_mfma_f32_16x16x32_bf16 v[148:151], a[108:111], a[92:95], v[148:151]
v_mfma_f32_16x16x32_bf16 v[144:147], a[104:107], a[92:95], v[144:147]
v_mfma_f32_16x16x32_bf16 v[140:143], a[100:103], a[92:95], v[140:143]
v_mfma_f32_16x16x32_bf16 v[136:139], a[96:99], a[92:95], v[136:139]
s_waitcnt lgkmcnt(0)
v_mfma_f32_16x16x32_bf16 v[24:27], a[32:35], a[0:3], v[24:27]
ds_read_b128 a[64:67], v9 offset:32768
v_mfma_f32_16x16x32_bf16 v[28:31], a[36:39], a[0:3], v[28:31]
v_mfma_f32_16x16x32_bf16 v[32:35], a[40:43], a[0:3], v[32:35]
ds_read_b64_tr_b16 a[96:97], v12 offset:40960
v_mfma_f32_16x16x32_bf16 v[36:39], a[44:47], a[0:3], v[36:39]
v_mfma_f32_16x16x32_bf16 v[152:155], a[0:3], a[48:51], v[152:155]
ds_read_b64_tr_b16 a[98:99], v12 offset:41984
v_mfma_f32_16x16x32_bf16 v[160:163], a[0:3], a[52:55], v[160:163]
v_mfma_f32_16x16x32_bf16 v[168:171], a[0:3], a[56:59], v[168:171]
v_mfma_f32_16x16x32_bf16 v[176:179], a[0:3], a[60:63], v[176:179]
ds_read_b64_tr_b16 a[100:101], v13 offset:40960
v_mfma_f32_16x16x32_bf16 v[180:183], a[4:7], a[60:63], v[180:183]
v_mfma_f32_16x16x32_bf16 v[172:175], a[4:7], a[56:59], v[172:175]
ds_read_b64_tr_b16 a[102:103], v13 offset:41984
v_mfma_f32_16x16x32_bf16 v[164:167], a[4:7], a[52:55], v[164:167]
v_mfma_f32_16x16x32_bf16 v[156:159], a[4:7], a[48:51], v[156:159]
ds_read_b64_tr_b16 a[104:105], v12 offset:41216
v_mfma_f32_16x16x32_bf16 v[52:55], a[44:47], a[4:7], v[52:55]
v_mfma_f32_16x16x32_bf16 v[48:51], a[40:43], a[4:7], v[48:51]
v_mfma_f32_16x16x32_bf16 v[44:47], a[36:39], a[4:7], v[44:47]
ds_read_b64_tr_b16 a[106:107], v12 offset:42240
v_mfma_f32_16x16x32_bf16 v[40:43], a[32:35], a[4:7], v[40:43]
v_mfma_f32_16x16x32_bf16 v[56:59], a[32:35], a[8:11], v[56:59]
ds_read_b64_tr_b16 a[108:109], v13 offset:41216
v_mfma_f32_16x16x32_bf16 v[60:63], a[36:39], a[8:11], v[60:63]
v_mfma_f32_16x16x32_bf16 v[64:67], a[40:43], a[8:11], v[64:67]
ds_read_b64_tr_b16 a[110:111], v13 offset:42240
v_mfma_f32_16x16x32_bf16 v[68:71], a[44:47], a[8:11], v[68:71]
v_mfma_f32_16x16x32_bf16 v[184:187], a[8:11], a[48:51], v[184:187]
v_mfma_f32_16x16x32_bf16 v[192:195], a[8:11], a[52:55], v[192:195]
ds_read_b64_tr_b16 a[112:113], v12 offset:57344
v_mfma_f32_16x16x32_bf16 v[200:203], a[8:11], a[56:59], v[200:203]
v_mfma_f32_16x16x32_bf16 v[208:211], a[8:11], a[60:63], v[208:211]
ds_read_b64_tr_b16 a[114:115], v12 offset:58368
v_mfma_f32_16x16x32_bf16 v[212:215], a[12:15], a[60:63], v[212:215]
v_mfma_f32_16x16x32_bf16 v[204:207], a[12:15], a[56:59], v[204:207]
ds_read_b64_tr_b16 a[116:117], v13 offset:57344
v_mfma_f32_16x16x32_bf16 v[196:199], a[12:15], a[52:55], v[196:199]
v_mfma_f32_16x16x32_bf16 v[188:191], a[12:15], a[48:51], v[188:191]
v_mfma_f32_16x16x32_bf16 v[84:87], a[44:47], a[12:15], v[84:87]
ds_read_b64_tr_b16 a[118:119], v13 offset:58368
v_mfma_f32_16x16x32_bf16 v[80:83], a[40:43], a[12:15], v[80:83]
v_mfma_f32_16x16x32_bf16 v[76:79], a[36:39], a[12:15], v[76:79]
ds_read_b64_tr_b16 a[120:121], v12 offset:57600
v_mfma_f32_16x16x32_bf16 v[72:75], a[32:35], a[12:15], v[72:75]
v_mfma_f32_16x16x32_bf16 v[88:91], a[32:35], a[16:19], v[88:91]
ds_read_b64_tr_b16 a[122:123], v12 offset:58624
v_mfma_f32_16x16x32_bf16 v[92:95], a[36:39], a[16:19], v[92:95]
v_mfma_f32_16x16x32_bf16 v[96:99], a[40:43], a[16:19], v[96:99]
v_mfma_f32_16x16x32_bf16 v[100:103], a[44:47], a[16:19], v[100:103]
ds_read_b64_tr_b16 a[124:125], v13 offset:57600
v_mfma_f32_16x16x32_bf16 v[216:219], a[16:19], a[48:51], v[216:219]
v_mfma_f32_16x16x32_bf16 v[224:227], a[16:19], a[52:55], v[224:227]
ds_read_b64_tr_b16 a[126:127], v13 offset:58624
v_mfma_f32_16x16x32_bf16 v[232:235], a[16:19], a[56:59], v[232:235]
v_mfma_f32_16x16x32_bf16 v[240:243], a[16:19], a[60:63], v[240:243]
ds_read_b128 a[68:71], v9 offset:34816
v_mfma_f32_16x16x32_bf16 v[244:247], a[20:23], a[60:63], v[244:247]
v_mfma_f32_16x16x32_bf16 v[236:239], a[20:23], a[56:59], v[236:239]
v_mfma_f32_16x16x32_bf16 v[228:231], a[20:23], a[52:55], v[228:231]
ds_read_b128 a[72:75], v9 offset:36864
v_mfma_f32_16x16x32_bf16 v[220:223], a[20:23], a[48:51], v[220:223]
v_mfma_f32_16x16x32_bf16 v[116:119], a[44:47], a[20:23], v[116:119]
ds_read_b128 a[76:79], v9 offset:38912
v_mfma_f32_16x16x32_bf16 v[112:115], a[40:43], a[20:23], v[112:115]
v_mfma_f32_16x16x32_bf16 v[108:111], a[36:39], a[20:23], v[108:111]
ds_read_b128 a[80:83], v9 offset:40960
v_mfma_f32_16x16x32_bf16 v[104:107], a[32:35], a[20:23], v[104:107]
v_mfma_f32_16x16x32_bf16 v[120:123], a[32:35], a[24:27], v[120:123]
v_mfma_f32_16x16x32_bf16 v[124:127], a[36:39], a[24:27], v[124:127]
ds_read_b128 a[84:87], v9 offset:43008
v_mfma_f32_16x16x32_bf16 v[128:131], a[40:43], a[24:27], v[128:131]
v_mfma_f32_16x16x32_bf16 v[132:135], a[44:47], a[24:27], v[132:135]
ds_read_b128 a[88:91], v9 offset:45056
v_mfma_f32_16x16x32_bf16 v[248:251], a[24:27], a[48:51], v[248:251]
v_mfma_f32_16x16x32_bf16 a[128:131], a[24:27], a[52:55], a[128:131]
ds_read_b128 a[92:95], v9 offset:47104
v_mfma_f32_16x16x32_bf16 a[136:139], a[24:27], a[56:59], a[136:139]
v_mfma_f32_16x16x32_bf16 a[144:147], a[24:27], a[60:63], a[144:147]
v_mfma_f32_16x16x32_bf16 a[148:151], a[28:31], a[60:63], a[148:151]
v_mfma_f32_16x16x32_bf16 a[140:143], a[28:31], a[56:59], a[140:143]
v_mfma_f32_16x16x32_bf16 a[132:135], a[28:31], a[52:55], a[132:135]
v_mfma_f32_16x16x32_bf16 v[252:255], a[28:31], a[48:51], v[252:255]
v_mfma_f32_16x16x32_bf16 v[148:151], a[44:47], a[28:31], v[148:151]
v_mfma_f32_16x16x32_bf16 v[144:147], a[40:43], a[28:31], v[144:147]
v_mfma_f32_16x16x32_bf16 v[140:143], a[36:39], a[28:31], v[140:143]
v_mfma_f32_16x16x32_bf16 v[136:139], a[32:35], a[28:31], v[136:139]
s_waitcnt vmcnt(0) lgkmcnt(0)
s_barrier
v_mfma_f32_16x16x32_bf16 v[24:27], a[96:99], a[64:67], v[24:27]
v_mfma_f32_16x16x32_bf16 v[28:31], a[100:103], a[64:67], v[28:31]
v_mfma_f32_16x16x32_bf16 v[32:35], a[104:107], a[64:67], v[32:35]
v_mfma_f32_16x16x32_bf16 v[36:39], a[108:111], a[64:67], v[36:39]
v_mfma_f32_16x16x32_bf16 v[152:155], a[64:67], a[112:115], v[152:155]
v_mfma_f32_16x16x32_bf16 v[160:163], a[64:67], a[116:119], v[160:163]
v_mfma_f32_16x16x32_bf16 v[168:171], a[64:67], a[120:123], v[168:171]
v_mfma_f32_16x16x32_bf16 v[176:179], a[64:67], a[124:127], v[176:179]
v_mfma_f32_16x16x32_bf16 v[180:183], a[68:71], a[124:127], v[180:183]
v_mfma_f32_16x16x32_bf16 v[172:175], a[68:71], a[120:123], v[172:175]
v_mfma_f32_16x16x32_bf16 v[164:167], a[68:71], a[116:119], v[164:167]
v_mfma_f32_16x16x32_bf16 v[156:159], a[68:71], a[112:115], v[156:159]
v_mfma_f32_16x16x32_bf16 v[52:55], a[108:111], a[68:71], v[52:55]
v_mfma_f32_16x16x32_bf16 v[48:51], a[104:107], a[68:71], v[48:51]
v_mfma_f32_16x16x32_bf16 v[44:47], a[100:103], a[68:71], v[44:47]
v_mfma_f32_16x16x32_bf16 v[40:43], a[96:99], a[68:71], v[40:43]
v_mfma_f32_16x16x32_bf16 v[56:59], a[96:99], a[72:75], v[56:59]
v_mfma_f32_16x16x32_bf16 v[60:63], a[100:103], a[72:75], v[60:63]
v_mfma_f32_16x16x32_bf16 v[64:67], a[104:107], a[72:75], v[64:67]
v_mfma_f32_16x16x32_bf16 v[68:71], a[108:111], a[72:75], v[68:71]
v_mfma_f32_16x16x32_bf16 v[184:187], a[72:75], a[112:115], v[184:187]
v_mfma_f32_16x16x32_bf16 v[192:195], a[72:75], a[116:119], v[192:195]
v_mfma_f32_16x16x32_bf16 v[200:203], a[72:75], a[120:123], v[200:203]
v_mfma_f32_16x16x32_bf16 v[208:211], a[72:75], a[124:127], v[208:211]
v_mfma_f32_16x16x32_bf16 v[212:215], a[76:79], a[124:127], v[212:215]
v_mfma_f32_16x16x32_bf16 v[204:207], a[76:79], a[120:123], v[204:207]
v_mfma_f32_16x16x32_bf16 v[196:199], a[76:79], a[116:119], v[196:199]
v_mfma_f32_16x16x32_bf16 v[188:191], a[76:79], a[112:115], v[188:191]
v_mfma_f32_16x16x32_bf16 v[84:87], a[108:111], a[76:79], v[84:87]
v_mfma_f32_16x16x32_bf16 v[80:83], a[104:107], a[76:79], v[80:83]
v_mfma_f32_16x16x32_bf16 v[76:79], a[100:103], a[76:79], v[76:79]
v_mfma_f32_16x16x32_bf16 v[72:75], a[96:99], a[76:79], v[72:75]
v_mfma_f32_16x16x32_bf16 v[88:91], a[96:99], a[80:83], v[88:91]
v_mfma_f32_16x16x32_bf16 v[92:95], a[100:103], a[80:83], v[92:95]
v_mfma_f32_16x16x32_bf16 v[96:99], a[104:107], a[80:83], v[96:99]
v_mfma_f32_16x16x32_bf16 v[100:103], a[108:111], a[80:83], v[100:103]
v_mfma_f32_16x16x32_bf16 v[216:219], a[80:83], a[112:115], v[216:219]
v_mfma_f32_16x16x32_bf16 v[224:227], a[80:83], a[116:119], v[224:227]
v_mfma_f32_16x16x32_bf16 v[232:235], a[80:83], a[120:123], v[232:235]
v_mfma_f32_16x16x32_bf16 v[240:243], a[80:83], a[124:127], v[240:243]
v_mfma_f32_16x16x32_bf16 v[244:247], a[84:87], a[124:127], v[244:247]
v_mfma_f32_16x16x32_bf16 v[236:239], a[84:87], a[120:123], v[236:239]
v_mfma_f32_16x16x32_bf16 v[228:231], a[84:87], a[116:119], v[228:231]
v_mfma_f32_16x16x32_bf16 v[220:223], a[84:87], a[112:115], v[220:223]
v_mfma_f32_16x16x32_bf16 v[116:119], a[108:111], a[84:87], v[116:119]
v_mfma_f32_16x16x32_bf16 v[112:115], a[104:107], a[84:87], v[112:115]
v_mfma_f32_16x16x32_bf16 v[108:111], a[100:103], a[84:87], v[108:111]
v_mfma_f32_16x16x32_bf16 v[104:107], a[96:99], a[84:87], v[104:107]
v_mfma_f32_16x16x32_bf16 v[120:123], a[96:99], a[88:91], v[120:123]
v_mfma_f32_16x16x32_bf16 v[124:127], a[100:103], a[88:91], v[124:127]
v_mfma_f32_16x16x32_bf16 v[128:131], a[104:107], a[88:91], v[128:131]
v_mfma_f32_16x16x32_bf16 v[132:135], a[108:111], a[88:91], v[132:135]
v_mfma_f32_16x16x32_bf16 v[248:251], a[88:91], a[112:115], v[248:251]
v_mfma_f32_16x16x32_bf16 a[128:131], a[88:91], a[116:119], a[128:131]
v_mfma_f32_16x16x32_bf16 a[136:139], a[88:91], a[120:123], a[136:139]
v_mfma_f32_16x16x32_bf16 a[144:147], a[88:91], a[124:127], a[144:147]
v_mfma_f32_16x16x32_bf16 a[148:151], a[92:95], a[124:127], a[148:151]
v_mfma_f32_16x16x32_bf16 a[140:143], a[92:95], a[120:123], a[140:143]
v_mfma_f32_16x16x32_bf16 a[132:135], a[92:95], a[116:119], a[132:135]
v_mfma_f32_16x16x32_bf16 v[252:255], a[92:95], a[112:115], v[252:255]
v_mfma_f32_16x16x32_bf16 v[148:151], a[108:111], a[92:95], v[148:151]
v_mfma_f32_16x16x32_bf16 v[144:147], a[104:107], a[92:95], v[144:147]
v_mfma_f32_16x16x32_bf16 v[140:143], a[100:103], a[92:95], v[140:143]
v_mfma_f32_16x16x32_bf16 v[136:139], a[96:99], a[92:95], v[136:139]
s_nop 7
s_mul_i32 s8, s5, 0x108000
s_lshl_b32 s9, s6, 17
s_add_u32 s8, s8, s9
s_lshr_b32 s9, s4, 1
s_lshl_b32 s9, s9, 16
s_add_u32 s8, s8, s9
s_and_b32 s9, s4, 1
s_lshl_b32 s10, s9, 11
s_add_u32 s28, s8, s10
s_lshl_b32 s10, s9, 12
s_add_u32 s29, s8, s10
s_add_u32 s29, s29, 0x6000
s_add_u32 s8, s28, 0x0
v_cvt_pk_bf16_f32 v24, v24, v25
v_cvt_pk_bf16_f32 v25, v26, v27
v_cvt_pk_bf16_f32 v26, v28, v29
v_cvt_pk_bf16_f32 v27, v30, v31
buffer_store_dwordx4 v[24:27], v16, s[88:91], s8 offen offset:0
v_cvt_pk_bf16_f32 v32, v32, v33
v_cvt_pk_bf16_f32 v33, v34, v35
v_cvt_pk_bf16_f32 v34, v36, v37
v_cvt_pk_bf16_f32 v35, v38, v39
buffer_store_dwordx4 v[32:35], v16, s[88:91], s8 offen offset:1024
s_add_u32 s8, s28, 0x1000
v_cvt_pk_bf16_f32 v40, v40, v41
v_cvt_pk_bf16_f32 v41, v42, v43
v_cvt_pk_bf16_f32 v42, v44, v45
v_cvt_pk_bf16_f32 v43, v46, v47
buffer_store_dwordx4 v[40:43], v16, s[88:91], s8 offen offset:0
v_cvt_pk_bf16_f32 v48, v48, v49
v_cvt_pk_bf16_f32 v49, v50, v51
v_cvt_pk_bf16_f32 v50, v52, v53
v_cvt_pk_bf16_f32 v51, v54, v55
buffer_store_dwordx4 v[48:51], v16, s[88:91], s8 offen offset:1024
s_add_u32 s8, s28, 0x4000
v_cvt_pk_bf16_f32 v56, v56, v57
v_cvt_pk_bf16_f32 v57, v58, v59
v_cvt_pk_bf16_f32 v58, v60, v61
v_cvt_pk_bf16_f32 v59, v62, v63
buffer_store_dwordx4 v[56:59], v16, s[88:91], s8 offen offset:0
v_cvt_pk_bf16_f32 v64, v64, v65
v_cvt_pk_bf16_f32 v65, v66, v67
v_cvt_pk_bf16_f32 v66, v68, v69
v_cvt_pk_bf16_f32 v67, v70, v71
buffer_store_dwordx4 v[64:67], v16, s[88:91], s8 offen offset:1024
s_add_u32 s8, s28, 0x5000
v_cvt_pk_bf16_f32 v72, v72, v73
v_cvt_pk_bf16_f32 v73, v74, v75
v_cvt_pk_bf16_f32 v74, v76, v77
v_cvt_pk_bf16_f32 v75, v78, v79
buffer_store_dwordx4 v[72:75], v16, s[88:91], s8 offen offset:0
v_cvt_pk_bf16_f32 v80, v80, v81
v_cvt_pk_bf16_f32 v81, v82, v83
v_cvt_pk_bf16_f32 v82, v84, v85
v_cvt_pk_bf16_f32 v83, v86, v87
buffer_store_dwordx4 v[80:83], v16, s[88:91], s8 offen offset:1024
s_add_u32 s8, s28, 0x8000
v_cvt_pk_bf16_f32 v88, v88, v89
v_cvt_pk_bf16_f32 v89, v90, v91
v_cvt_pk_bf16_f32 v90, v92, v93
v_cvt_pk_bf16_f32 v91, v94, v95
buffer_store_dwordx4 v[88:91], v16, s[88:91], s8 offen offset:0
v_cvt_pk_bf16_f32 v96, v96, v97
v_cvt_pk_bf16_f32 v97, v98, v99
v_cvt_pk_bf16_f32 v98, v100, v101
v_cvt_pk_bf16_f32 v99, v102, v103
buffer_store_dwordx4 v[96:99], v16, s[88:91], s8 offen offset:1024
s_add_u32 s8, s28, 0x9000
v_cvt_pk_bf16_f32 v104, v104, v105
v_cvt_pk_bf16_f32 v105, v106, v107
v_cvt_pk_bf16_f32 v106, v108, v109
v_cvt_pk_bf16_f32 v107, v110, v111
buffer_store_dwordx4 v[104:107], v16, s[88:91], s8 offen offset:0
v_cvt_pk_bf16_f32 v112, v112, v113
v_cvt_pk_bf16_f32 v113, v114, v115
v_cvt_pk_bf16_f32 v114, v116, v117
v_cvt_pk_bf16_f32 v115, v118, v119
buffer_store_dwordx4 v[112:115], v16, s[88:91], s8 offen offset:1024
s_add_u32 s8, s28, 0xc000
v_cvt_pk_bf16_f32 v120, v120, v121
v_cvt_pk_bf16_f32 v121, v122, v123
v_cvt_pk_bf16_f32 v122, v124, v125
v_cvt_pk_bf16_f32 v123, v126, v127
buffer_store_dwordx4 v[120:123], v16, s[88:91], s8 offen offset:0
v_cvt_pk_bf16_f32 v128, v128, v129
v_cvt_pk_bf16_f32 v129, v130, v131
v_cvt_pk_bf16_f32 v130, v132, v133
v_cvt_pk_bf16_f32 v131, v134, v135
buffer_store_dwordx4 v[128:131], v16, s[88:91], s8 offen offset:1024
s_add_u32 s8, s28, 0xd000
v_cvt_pk_bf16_f32 v136, v136, v137
v_cvt_pk_bf16_f32 v137, v138, v139
v_cvt_pk_bf16_f32 v138, v140, v141
v_cvt_pk_bf16_f32 v139, v142, v143
buffer_store_dwordx4 v[136:139], v16, s[88:91], s8 offen offset:0
v_cvt_pk_bf16_f32 v144, v144, v145
v_cvt_pk_bf16_f32 v145, v146, v147
v_cvt_pk_bf16_f32 v146, v148, v149
v_cvt_pk_bf16_f32 v147, v150, v151
buffer_store_dwordx4 v[144:147], v16, s[88:91], s8 offen offset:1024
s_add_u32 s8, s29, 0x0
v_cvt_pk_bf16_f32 v152, v152, v153
v_cvt_pk_bf16_f32 v153, v154, v155
v_cvt_pk_bf16_f32 v154, v156, v157
v_cvt_pk_bf16_f32 v155, v158, v159
buffer_store_dwordx4 v[152:155], v16, s[88:91], s8 offen offset:0
v_cvt_pk_bf16_f32 v160, v160, v161
v_cvt_pk_bf16_f32 v161, v162, v163
v_cvt_pk_bf16_f32 v162, v164, v165
v_cvt_pk_bf16_f32 v163, v166, v167
buffer_store_dwordx4 v[160:163], v16, s[88:91], s8 offen offset:1024
v_cvt_pk_bf16_f32 v168, v168, v169
v_cvt_pk_bf16_f32 v169, v170, v171
v_cvt_pk_bf16_f32 v170, v172, v173
v_cvt_pk_bf16_f32 v171, v174, v175
buffer_store_dwordx4 v[168:171], v16, s[88:91], s8 offen offset:2048
v_cvt_pk_bf16_f32 v176, v176, v177
v_cvt_pk_bf16_f32 v177, v178, v179
v_cvt_pk_bf16_f32 v178, v180, v181
v_cvt_pk_bf16_f32 v179, v182, v183
buffer_store_dwordx4 v[176:179], v16, s[88:91], s8 offen offset:3072
s_add_u32 s8, s29, 0x4000
v_cvt_pk_bf16_f32 v184, v184, v185
v_cvt_pk_bf16_f32 v185, v186, v187
v_cvt_pk_bf16_f32 v186, v188, v189
v_cvt_pk_bf16_f32 v187, v190, v191
buffer_store_dwordx4 v[184:187], v16, s[88:91], s8 offen offset:0
v_cvt_pk_bf16_f32 v192, v192, v193
v_cvt_pk_bf16_f32 v193, v194, v195
v_cvt_pk_bf16_f32 v194, v196, v197
v_cvt_pk_bf16_f32 v195, v198, v199
buffer_store_dwordx4 v[192:195], v16, s[88:91], s8 offen offset:1024
v_cvt_pk_bf16_f32 v200, v200, v201
v_cvt_pk_bf16_f32 v201, v202, v203
v_cvt_pk_bf16_f32 v202, v204, v205
v_cvt_pk_bf16_f32 v203, v206, v207
buffer_store_dwordx4 v[200:203], v16, s[88:91], s8 offen offset:2048
v_cvt_pk_bf16_f32 v208, v208, v209
v_cvt_pk_bf16_f32 v209, v210, v211
v_cvt_pk_bf16_f32 v210, v212, v213
v_cvt_pk_bf16_f32 v211, v214, v215
buffer_store_dwordx4 v[208:211], v16, s[88:91], s8 offen offset:3072
s_add_u32 s8, s29, 0x8000
v_cvt_pk_bf16_f32 v216, v216, v217
v_cvt_pk_bf16_f32 v217, v218, v219
v_cvt_pk_bf16_f32 v218, v220, v221
v_cvt_pk_bf16_f32 v219, v222, v223
buffer_store_dwordx4 v[216:219], v16, s[88:91], s8 offen offset:0
v_cvt_pk_bf16_f32 v224, v224, v225
v_cvt_pk_bf16_f32 v225, v226, v227
v_cvt_pk_bf16_f32 v226, v228, v229
v_cvt_pk_bf16_f32 v227, v230, v231
buffer_store_dwordx4 v[224:227], v16, s[88:91], s8 offen offset:1024
v_cvt_pk_bf16_f32 v232, v232, v233
v_cvt_pk_bf16_f32 v233, v234, v235
v_cvt_pk_bf16_f32 v234, v236, v237
v_cvt_pk_bf16_f32 v235, v238, v239
buffer_store_dwordx4 v[232:235], v16, s[88:91], s8 offen offset:2048
v_cvt_pk_bf16_f32 v240, v240, v241
v_cvt_pk_bf16_f32 v241, v242, v243
v_cvt_pk_bf16_f32 v242, v244, v245
v_cvt_pk_bf16_f32 v243, v246, v247
buffer_store_dwordx4 v[240:243], v16, s[88:91], s8 offen offset:3072
s_add_u32 s8, s29, 0xc000
v_cvt_pk_bf16_f32 v248, v248, v249
v_cvt_pk_bf16_f32 v249, v250, v251
v_cvt_pk_bf16_f32 v250, v252, v253
v_cvt_pk_bf16_f32 v251, v254, v255
buffer_store_dwordx4 v[248:251], v16, s[88:91], s8 offen offset:0
v_accvgpr_read_b32 v32, a128
v_accvgpr_read_b32 v33, a129
v_accvgpr_read_b32 v34, a130
v_accvgpr_read_b32 v35, a131
v_accvgpr_read_b32 v36, a132
v_accvgpr_read_b32 v37, a133
v_accvgpr_read_b32 v38, a134
v_accvgpr_read_b32 v39, a135
v_cvt_pk_bf16_f32 v32, v32, v33
v_cvt_pk_bf16_f32 v33, v34, v35
v_cvt_pk_bf16_f32 v34, v36, v37
v_cvt_pk_bf16_f32 v35, v38, v39
buffer_store_dwordx4 v[32:35], v16, s[88:91], s8 offen offset:1024
v_accvgpr_read_b32 v40, a136
v_accvgpr_read_b32 v41, a137
v_accvgpr_read_b32 v42, a138
v_accvgpr_read_b32 v43, a139
v_accvgpr_read_b32 v44, a140
v_accvgpr_read_b32 v45, a141
v_accvgpr_read_b32 v46, a142
v_accvgpr_read_b32 v47, a143
v_cvt_pk_bf16_f32 v40, v40, v41
v_cvt_pk_bf16_f32 v41, v42, v43
v_cvt_pk_bf16_f32 v42, v44, v45
v_cvt_pk_bf16_f32 v43, v46, v47
buffer_store_dwordx4 v[40:43], v16, s[88:91], s8 offen offset:2048
v_accvgpr_read_b32 v48, a144
v_accvgpr_read_b32 v49, a145
v_accvgpr_read_b32 v50, a146
v_accvgpr_read_b32 v51, a147
v_accvgpr_read_b32 v52, a148
v_accvgpr_read_b32 v53, a149
v_accvgpr_read_b32 v54, a150
v_accvgpr_read_b32 v55, a151
v_cvt_pk_bf16_f32 v48, v48, v49
v_cvt_pk_bf16_f32 v49, v50, v51
v_cvt_pk_bf16_f32 v50, v52, v53
v_cvt_pk_bf16_f32 v51, v54, v55
buffer_store_dwordx4 v[48:51], v16, s[88:91], s8 offen offset:3072
L_k1_end:
s_endpgm
.globl att_kernel
.p2align 8
.type att_kernel,@function
att_kernel:
s_cmp_ge_u32 s2, 256
s_cbranch_scc1 L_k2_end
s_load_dwordx2 s[44:45], s[0:1], 0
s_load_dwordx2 s[52:53], s[0:1], 16
s_load_dwordx2 s[68:69], s[0:1], 56
s_load_dwordx2 s[88:89], s[0:1], 96
v_lshrrev_b32 v1, 6, v0
v_and_b32 v0, 63, v0
v_readfirstlane_b32 s4, v1
s_mov_b32 s46, 0x400000
s_mov_b32 s47, 0x20000
s_mov_b32 s54, 0x800000
s_mov_b32 s55, 0x20000
s_mov_b32 s70, 0x600000
s_mov_b32 s71, 0x20000
s_mov_b32 s90, 0x10000000
s_mov_b32 s91, 0x20000
s_and_b32 s5, s2, 7
s_lshl_b32 s5, s5, 2
s_bfe_u32 s3, s2, 0x20003
s_add_u32 s5, s5, s3
s_lshr_b32 s6, s2, 5
s_mov_b32 s12, 0x4000
s_mov_b32 s13, 0x8000
s_mov_b32 s14, 0xc000
s_mov_b32 s25, 0x800
s_mov_b32 s26, 0x1000
s_waitcnt lgkmcnt(0)
v_lshlrev_b32 v16, 4, v0
v_lshrrev_b32 v17, 4, v0
v_xor_b32 v17, v17, v0
v_and_b32 v17, 7, v17
v_lshlrev_b32 v17, 4, v17
v_lshrrev_b32 v18, 3, v0
v_lshl_add_u32 v2, v18, 11, v17
v_xor_b32 v3, 64, v2
v_add_u32 v3, 0x4000, v3
s_and_b32 s8, s4, 1
s_lshl_b32 s9, s8, 6
s_lshl_b32 s8, s8, 14
v_xor_b32 v4, s9, v2
v_add_u32 v4, s8, v4
s_lshl_b32 s8, s6, 18
s_sub_u32 s9, 15, s6
s_lshl_b32 s9, s9, 18
s_lshl_b32 s10, s4, 15
s_sub_u32 s11, 0x38000, s10
s_add_u32 s20, s8, s10
s_add_u32 s21, s8, s11
s_add_u32 s22, s9, s10
s_add_u32 s23, s9, s11
s_cmp_lt_u32 s4, 2
s_cselect_b32 s24, s8, s9
s_max_u32 s24, s24, 0x8000
s_sub_u32 s24, s24, 0x8000
s_lshl_b32 s16, s4, 13
s_add_u32 s16, s16, 0x10000
s_lshl_b32 s17, s4, 12
s_lshl_b32 s18, s4, 10
v_bfe_u32 v17, v0, 2, 2
s_lshl_b32 s8, s4, 4
v_add_u32 v17, s8, v17
v_lshlrev_b32 v17, 13, v17
v_lshrrev_b32 v18, 4, v0
v_lshl_add_u32 v17, v18, 6, v17
v_and_b32 v18, 3, v0
v_lshl_add_u32 v17, v18, 4, v17
s_lshl_b32 s8, s5, 8
v_add_u32 v5, s8, v17
v_xor_b32 v6, 32, v5
v_add_u32 v6, 0x10000, v6
v_lshrrev_b32 v17, 2, v0
s_lshl_b32 s8, s4, 4
v_add_u32 v17, s8, v17
v_mul_u32_u24 v17, 0x1800, v17
v_and_b32 v18, 3, v0
v_lshlrev_b32 v18, 4, v18
v_and_b32 v19, 32, v0
v_xor_b32 v18, v18, v19
s_lshl_b32 s8, s5, 6
v_add3_u32 v7, v17, v18, s8
s_add_u32 m0, s17, 0x0
s_nop 0
buffer_load_dwordx4 v5, s[52:55], 0 offen lds
s_add_u32 m0, s17, 0x400
s_nop 0
buffer_load_dwordx4 v5, s[52:55], s13 offen lds
s_add_u32 m0, s17, 0x800
s_nop 0
buffer_load_dwordx4 v6, s[52:55], 0 offen lds
s_add_u32 m0, s17, 0xc00
s_nop 0
buffer_load_dwordx4 v6, s[52:55], s13 offen lds
s_add_u32 m0, s18, 0x4000
s_nop 0
buffer_load_dwordx4 v7, s[68:71], 0 offen lds
s_add_u32 m0, s18, 0x5000
s_nop 0
buffer_load_dwordx4 v7, s[68:71], s25 offen lds
s_add_u32 m0, s18, 0x6000
s_nop 0
buffer_load_dwordx4 v7, s[68:71], s26 offen lds
s_add_u32 m0, s16, 0x0
s_nop 0
buffer_load_dwordx4 v2, s[44:47], s20 offen lds
s_add_u32 m0, s16, 0x400
s_nop 0
buffer_load_dwordx4 v3, s[44:47], s20 offen lds
s_add_u32 m0, s16, 0x800
s_nop 0
buffer_load_dwordx4 v2, s[44:47], s21 offen lds
s_add_u32 m0, s16, 0xc00
s_nop 0
buffer_load_dwordx4 v3, s[44:47], s21 offen lds
s_add_u32 m0, s16, 0x1000
s_nop 0
buffer_load_dwordx4 v2, s[44:47], s22 offen lds
s_add_u32 m0, s16, 0x1400
s_nop 0
buffer_load_dwordx4 v3, s[44:47], s22 offen lds
s_add_u32 m0, s16, 0x1800
s_nop 0
buffer_load_dwordx4 v2, s[44:47], s23 offen lds
s_add_u32 m0, s16, 0x1c00
s_nop 0
buffer_load_dwordx4 v3, s[44:47], s23 offen lds
s_add_u32 m0, s18, 0x7000
s_nop 0
buffer_load_dwordx4 v4, s[44:47], s24 offen lds
v_add_u32 v2, 0x80, v2
v_add_u32 v3, 0x80, v3
v_add_u32 v4, 0x80, v4
v_add_u32 v5, 0x80000, v5
v_add_u32 v6, 0x80000, v6
v_add_u32 v7, 0x60000, v7
s_add_u32 m0, s17, 0x8000
s_nop 0
buffer_load_dwordx4 v5, s[52:55], 0 offen lds
s_add_u32 m0, s17, 0x8400
s_nop 0
buffer_load_dwordx4 v5, s[52:55], s13 offen lds
s_add_u32 m0, s17, 0x8800
s_nop 0
buffer_load_dwordx4 v6, s[52:55], 0 offen lds
s_add_u32 m0, s17, 0x8c00
s_nop 0
buffer_load_dwordx4 v6, s[52:55], s13 offen lds
s_add_u32 m0, s18, 0xc000
s_nop 0
buffer_load_dwordx4 v7, s[68:71], 0 offen lds
s_add_u32 m0, s18, 0xd000
s_nop 0
buffer_load_dwordx4 v7, s[68:71], s25 offen lds
s_add_u32 m0, s18, 0xe000
s_nop 0
buffer_load_dwordx4 v7, s[68:71], s26 offen lds
s_add_u32 m0, s16, 0x8000
s_nop 0
buffer_load_dwordx4 v2, s[44:47], s20 offen lds
s_add_u32 m0, s16, 0x8400
s_nop 0
buffer_load_dwordx4 v3, s[44:47], s20 offen lds
s_add_u32 m0, s16, 0x8800
s_nop 0
buffer_load_dwordx4 v2, s[44:47], s21 offen lds
s_add_u32 m0, s16, 0x8c00
s_nop 0
buffer_load_dwordx4 v3, s[44:47], s21 offen lds
s_add_u32 m0, s16, 0x9000
s_nop 0
buffer_load_dwordx4 v2, s[44:47], s22 offen lds
s_add_u32 m0, s16, 0x9400
s_nop 0
buffer_load_dwordx4 v3, s[44:47], s22 offen lds
s_add_u32 m0, s16, 0x9800
s_nop 0
buffer_load_dwordx4 v2, s[44:47], s23 offen lds
s_add_u32 m0, s16, 0x9c00
s_nop 0
buffer_load_dwordx4 v3, s[44:47], s23 offen lds
s_add_u32 m0, s18, 0xf000
s_nop 0
buffer_load_dwordx4 v4, s[44:47], s24 offen lds
v_add_u32 v2, 0x80, v2
v_add_u32 v3, 0x80, v3
v_add_u32 v4, 0x80, v4
v_add_u32 v5, 0x80000, v5
v_add_u32 v6, 0x80000, v6
v_add_u32 v7, 0x60000, v7
v_and_b32 v17, 15, v0
v_lshrrev_b32 v18, 1, v17
v_lshrrev_b32 v19, 4, v0
v_xor_b32 v18, v18, v19
v_lshlrev_b32 v18, 4, v18
v_lshl_add_u32 v10, v17, 7, v18
v_add_u32 v8, s16, v10
v_xor_b32 v9, 64, v8
s_lshr_b32 s8, s4, 1
s_lshl_b32 s8, s8, 11
s_add_u32 s8, s8, 28672
v_add_u32 v10, s8, v10
v_xor_b32 v11, 64, v10
v_lshrrev_b32 v17, 4, v0
v_lshlrev_b32 v18, 11, v17
v_and_b32 v17, 1, v17
v_lshl_add_u32 v18, v17, 5, v18
v_bfe_u32 v17, v0, 2, 2
v_lshl_add_u32 v18, v17, 6, v18
v_and_b32 v17, 3, v0
v_lshl_add_u32 v12, v17, 3, v18
v_xor_b32 v13, 32, v12
v_lshrrev_b32 v17, 4, v0
v_lshlrev_b32 v18, 9, v17
v_and_b32 v17, 1, v17
v_lshl_add_u32 v18, v17, 5, v18
v_bfe_u32 v17, v0, 2, 2
v_lshl_add_u32 v18, v17, 6, v18
v_and_b32 v17, 3, v0
v_lshl_add_u32 v14, v17, 3, v18
v_add_u32 v14, 16384, v14
v_xor_b32 v15, 32, v14
s_waitcnt vmcnt(16)
s_barrier
s_bitcmp1_b32 s4, 0
s_cbranch_scc1 L_p2_odd
ds_read_b64_tr_b16 a[20:21], v12 offset:0
ds_read_b64_tr_b16 a[22:23], v12 offset:1024
ds_read_b128 a[0:3], v8 offset:0
ds_read_b128 a[4:7], v8 offset:2048
ds_read_b128 a[8:11], v8 offset:4096
ds_read_b128 a[12:15], v8 offset:6144
ds_read_b64_tr_b16 a[24:25], v13 offset:0
ds_read_b64_tr_b16 a[26:27], v13 offset:1024
ds_read_b64_tr_b16 a[28:29], v12 offset:256
ds_read_b64_tr_b16 a[30:31], v12 offset:1280
ds_read_b64_tr_b16 a[32:33], v13 offset:256
ds_read_b64_tr_b16 a[34:35], v13 offset:1280
ds_read_b64_tr_b16 a[36:37], v12 offset:512
ds_read_b64_tr_b16 a[38:39], v12 offset:1536
ds_read_b64_tr_b16 a[40:41], v13 offset:512
ds_read_b64_tr_b16 a[42:43], v13 offset:1536
ds_read_b64_tr_b16 a[44:45], v12 offset:768
ds_read_b64_tr_b16 a[46:47], v12 offset:1792
ds_read_b64_tr_b16 a[48:49], v13 offset:768
ds_read_b64_tr_b16 a[50:51], v13 offset:1792
ds_read_b64_tr_b16 a[52:53], v14 offset:0
ds_read_b64_tr_b16 a[54:55], v14 offset:256
ds_read_b64_tr_b16 a[56:57], v15 offset:0
ds_read_b64_tr_b16 a[58:59], v15 offset:256
ds_read_b64_tr_b16 a[60:61], v14 offset:4096
ds_read_b64_tr_b16 a[62:63], v14 offset:4352
ds_read_b64_tr_b16 a[64:65], v15 offset:4096
ds_read_b64_tr_b16 a[66:67], v15 offset:4352
ds_read_b64_tr_b16 a[68:69], v14 offset:8192
ds_read_b64_tr_b16 a[70:71], v14 offset:8448
ds_read_b64_tr_b16 a[72:73], v15 offset:8192
ds_read_b64_tr_b16 a[74:75], v15 offset:8448
ds_read_b128 a[16:19], v10 offset:0
s_waitcnt lgkmcnt(0)
v_mfma_f32_16x16x32_bf16 v[24:27], a[20:23], a[0:3], 0
ds_read_b64_tr_b16 a[96:97], v12 offset:8192
v_mfma_f32_16x16x32_bf16 v[56:59], a[20:23], a[4:7], 0
ds_read_b64_tr_b16 a[98:99], v12 offset:9216
v_mfma_f32_16x16x32_bf16 v[88:91], a[20:23], a[8:11], 0
v_mfma_f32_16x16x32_bf16 v[120:123], a[20:23], a[12:15], 0
ds_read_b128 a[76:79], v9 offset:0
v_mfma_f32_16x16x32_bf16 v[124:127], a[24:27], a[12:15], 0
ds_read_b128 a[80:83], v9 offset:2048
v_mfma_f32_16x16x32_bf16 v[92:95], a[24:27], a[8:11], 0
v_mfma_f32_16x16x32_bf16 v[60:63], a[24:27], a[4:7], 0
ds_read_b128 a[84:87], v9 offset:4096
v_mfma_f32_16x16x32_bf16 v[28:31], a[24:27], a[0:3], 0
ds_read_b128 a[88:91], v9 offset:6144
v_mfma_f32_16x16x32_bf16 v[32:35], a[28:31], a[0:3], 0
v_mfma_f32_16x16x32_bf16 v[64:67], a[28:31], a[4:7], 0
ds_read_b64_tr_b16 a[100:101], v13 offset:8192
v_mfma_f32_16x16x32_bf16 v[96:99], a[28:31], a[8:11], 0
ds_read_b64_tr_b16 a[102:103], v13 offset:9216
v_mfma_f32_16x16x32_bf16 v[128:131], a[28:31], a[12:15], 0
v_mfma_f32_16x16x32_bf16 v[132:135], a[32:35], a[12:15], 0
ds_read_b64_tr_b16 a[104:105], v12 offset:8448
v_mfma_f32_16x16x32_bf16 v[100:103], a[32:35], a[8:11], 0
ds_read_b64_tr_b16 a[106:107], v12 offset:9472
v_mfma_f32_16x16x32_bf16 v[68:71], a[32:35], a[4:7], 0
v_mfma_f32_16x16x32_bf16 v[36:39], a[32:35], a[0:3], 0
ds_read_b64_tr_b16 a[108:109], v13 offset:8448
v_mfma_f32_16x16x32_bf16 v[40:43], a[36:39], a[0:3], 0
ds_read_b64_tr_b16 a[110:111], v13 offset:9472
v_mfma_f32_16x16x32_bf16 v[72:75], a[36:39], a[4:7], 0
v_mfma_f32_16x16x32_bf16 v[104:107], a[36:39], a[8:11], 0
ds_read_b64_tr_b16 a[112:113], v12 offset:8704
v_mfma_f32_16x16x32_bf16 v[136:139], a[36:39], a[12:15], 0
ds_read_b64_tr_b16 a[114:115], v12 offset:9728
v_mfma_f32_16x16x32_bf16 v[140:143], a[40:43], a[12:15], 0
v_mfma_f32_16x16x32_bf16 v[108:111], a[40:43], a[8:11], 0
ds_read_b64_tr_b16 a[116:117], v13 offset:8704
v_mfma_f32_16x16x32_bf16 v[76:79], a[40:43], a[4:7], 0
ds_read_b64_tr_b16 a[118:119], v13 offset:9728
v_mfma_f32_16x16x32_bf16 v[44:47], a[40:43], a[0:3], 0
v_mfma_f32_16x16x32_bf16 v[48:51], a[44:47], a[0:3], 0
ds_read_b64_tr_b16 a[120:121], v12 offset:8960
v_mfma_f32_16x16x32_bf16 v[80:83], a[44:47], a[4:7], 0
ds_read_b64_tr_b16 a[122:123], v12 offset:9984
v_mfma_f32_16x16x32_bf16 v[112:115], a[44:47], a[8:11], 0
v_mfma_f32_16x16x32_bf16 v[144:147], a[44:47], a[12:15], 0
ds_read_b64_tr_b16 a[124:125], v13 offset:8960
v_mfma_f32_16x16x32_bf16 v[148:151], a[48:51], a[12:15], 0
ds_read_b64_tr_b16 a[126:127], v13 offset:9984
v_mfma_f32_16x16x32_bf16 v[116:119], a[48:51], a[8:11], 0
v_mfma_f32_16x16x32_bf16 v[84:87], a[48:51], a[4:7], 0
ds_read_b64_tr_b16 a[128:129], v14 offset:2048
v_mfma_f32_16x16x32_bf16 v[52:55], a[48:51], a[0:3], 0
ds_read_b64_tr_b16 a[130:131], v14 offset:2304
v_mfma_f32_16x16x32_bf16 v[152:155], a[52:55], a[0:3], 0
v_mfma_f32_16x16x32_bf16 v[160:163], a[52:55], a[4:7], 0
ds_read_b64_tr_b16 a[132:133], v15 offset:2048
v_mfma_f32_16x16x32_bf16 v[168:171], a[52:55], a[8:11], 0
ds_read_b64_tr_b16 a[134:135], v15 offset:2304
v_mfma_f32_16x16x32_bf16 v[176:179], a[52:55], a[12:15], 0
v_mfma_f32_16x16x32_bf16 v[180:183], a[56:59], a[12:15], 0
ds_read_b64_tr_b16 a[136:137], v14 offset:6144
v_mfma_f32_16x16x32_bf16 v[172:175], a[56:59], a[8:11], 0
ds_read_b64_tr_b16 a[138:139], v14 offset:6400
v_mfma_f32_16x16x32_bf16 v[164:167], a[56:59], a[4:7], 0
v_mfma_f32_16x16x32_bf16 v[156:159], a[56:59], a[0:3], 0
ds_read_b64_tr_b16 a[140:141], v15 offset:6144
v_mfma_f32_16x16x32_bf16 v[184:187], a[60:63], a[0:3], 0
ds_read_b64_tr_b16 a[142:143], v15 offset:6400
v_mfma_f32_16x16x32_bf16 v[192:195], a[60:63], a[4:7], 0
v_mfma_f32_16x16x32_bf16 v[200:203], a[60:63], a[8:11], 0
ds_read_b64_tr_b16 a[144:145], v14 offset:10240
v_mfma_f32_16x16x32_bf16 v[208:211], a[60:63], a[12:15], 0
ds_read_b64_tr_b16 a[146:147], v14 offset:10496
v_mfma_f32_16x16x32_bf16 v[248:251], a[60:63], a[16:19], 0
v_mfma_f32_16x16x32_bf16 v[252:255], a[64:67], a[16:19], 0
ds_read_b64_tr_b16 a[148:149], v15 offset:10240
v_mfma_f32_16x16x32_bf16 v[212:215], a[64:67], a[12:15], 0
ds_read_b64_tr_b16 a[150:151], v15 offset:10496
v_mfma_f32_16x16x32_bf16 v[204:207], a[64:67], a[8:11], 0
v_mfma_f32_16x16x32_bf16 v[196:199], a[64:67], a[4:7], 0
ds_read_b128 a[92:95], v11 offset:0
v_mfma_f32_16x16x32_bf16 v[188:191], a[64:67], a[0:3], 0
v_mfma_f32_16x16x32_bf16 v[216:219], a[0:3], a[68:71], 0
v_mfma_f32_16x16x32_bf16 v[224:227], a[4:7], a[68:71], 0
v_mfma_f32_16x16x32_bf16 v[232:235], a[8:11], a[68:71], 0
v_mfma_f32_16x16x32_bf16 v[240:243], a[12:15], a[68:71], 0
v_mfma_f32_16x16x32_bf16 v[244:247], a[12:15], a[72:75], 0
v_mfma_f32_16x16x32_bf16 v[236:239], a[8:11], a[72:75], 0
v_mfma_f32_16x16x32_bf16 v[228:231], a[4:7], a[72:75], 0
v_mfma_f32_16x16x32_bf16 v[220:223], a[0:3], a[72:75], 0
s_mov_b32 s15, 7
L_p2e_loop:
s_waitcnt vmcnt(0) lgkmcnt(0)
s_barrier
v_mfma_f32_16x16x32_bf16 v[24:27], a[96:99], a[76:79], v[24:27]
s_add_u32 m0, s17, 0x0
ds_read_b64_tr_b16 a[20:21], v12 offset:32768
v_mfma_f32_16x16x32_bf16 v[56:59], a[96:99], a[80:83], v[56:59]
buffer_load_dwordx4 v5, s[52:55], 0 offen lds
v_mfma_f32_16x16x32_bf16 v[88:91], a[96:99], a[84:87], v[88:91]
ds_read_b64_tr_b16 a[22:23], v12 offset:33792
v_mfma_f32_16x16x32_bf16 v[120:123], a[96:99], a[88:91], v[120:123]
s_add_u32 m0, s17, 0x400
ds_read_b128 a[0:3], v8 offset:32768
v_mfma_f32_16x16x32_bf16 v[124:127], a[100:103], a[88:91], v[124:127]
buffer_load_dwordx4 v5, s[52:55], s13 offen lds
v_mfma_f32_16x16x32_bf16 v[92:95], a[100:103], a[84:87], v[92:95]
ds_read_b128 a[4:7], v8 offset:34816
v_mfma_f32_16x16x32_bf16 v[60:63], a[100:103], a[80:83], v[60:63]
s_add_u32 m0, s17, 0x800
ds_read_b128 a[8:11], v8 offset:36864
v_mfma_f32_16x16x32_bf16 v[28:31], a[100:103], a[76:79], v[28:31]
buffer_load_dwordx4 v6, s[52:55], 0 offen lds
v_mfma_f32_16x16x32_bf16 v[32:35], a[104:107], a[76:79], v[32:35]
ds_read_b128 a[12:15], v8 offset:38912
v_mfma_f32_16x16x32_bf16 v[64:67], a[104:107], a[80:83], v[64:67]
s_add_u32 m0, s17, 0xc00
ds_read_b64_tr_b16 a[24:25], v13 offset:32768
v_mfma_f32_16x16x32_bf16 v[96:99], a[104:107], a[84:87], v[96:99]
buffer_load_dwordx4 v6, s[52:55], s13 offen lds
v_mfma_f32_16x16x32_bf16 v[128:131], a[104:107], a[88:91], v[128:131]
ds_read_b64_tr_b16 a[26:27], v13 offset:33792
v_mfma_f32_16x16x32_bf16 v[132:135], a[108:111], a[88:91], v[132:135]
s_add_u32 m0, s18, 0x4000
ds_read_b64_tr_b16 a[28:29], v12 offset:33024
v_mfma_f32_16x16x32_bf16 v[100:103], a[108:111], a[84:87], v[100:103]
buffer_load_dwordx4 v7, s[68:71], 0 offen lds
v_mfma_f32_16x16x32_bf16 v[68:71], a[108:111], a[80:83], v[68:71]
ds_read_b64_tr_b16 a[30:31], v12 offset:34048
v_mfma_f32_16x16x32_bf16 v[36:39], a[108:111], a[76:79], v[36:39]
s_add_u32 m0, s18, 0x5000
ds_read_b64_tr_b16 a[32:33], v13 offset:33024
v_mfma_f32_16x16x32_bf16 v[40:43], a[112:115], a[76:79], v[40:43]
buffer_load_dwordx4 v7, s[68:71], s25 offen lds
v_mfma_f32_16x16x32_bf16 v[72:75], a[112:115], a[80:83], v[72:75]
ds_read_b64_tr_b16 a[34:35], v13 offset:34048
v_mfma_f32_16x16x32_bf16 v[104:107], a[112:115], a[84:87], v[104:107]
s_add_u32 m0, s18, 0x6000
ds_read_b64_tr_b16 a[36:37], v12 offset:33280
v_mfma_f32_16x16x32_bf16 v[136:139], a[112:115], a[88:91], v[136:139]
buffer_load_dwordx4 v7, s[68:71], s26 offen lds
v_mfma_f32_16x16x32_bf16 v[140:143], a[116:119], a[88:91], v[140:143]
ds_read_b64_tr_b16 a[38:39], v12 offset:34304
v_mfma_f32_16x16x32_bf16 v[108:111], a[116:119], a[84:87], v[108:111]
s_add_u32 m0, s16, 0x0
ds_read_b64_tr_b16 a[40:41], v13 offset:33280
v_mfma_f32_16x16x32_bf16 v[76:79], a[116:119], a[80:83], v[76:79]
buffer_load_dwordx4 v2, s[44:47], s20 offen lds
v_mfma_f32_16x16x32_bf16 v[44:47], a[116:119], a[76:79], v[44:47]
ds_read_b64_tr_b16 a[42:43], v13 offset:34304
v_mfma_f32_16x16x32_bf16 v[48:51], a[120:123], a[76:79], v[48:51]
s_add_u32 m0, s16, 0x400
ds_read_b64_tr_b16 a[44:45], v12 offset:33536
v_mfma_f32_16x16x32_bf16 v[80:83], a[120:123], a[80:83], v[80:83]
buffer_load_dwordx4 v3, s[44:47], s20 offen lds
v_mfma_f32_16x16x32_bf16 v[112:115], a[120:123], a[84:87], v[112:115]
ds_read_b64_tr_b16 a[46:47], v12 offset:34560
v_mfma_f32_16x16x32_bf16 v[144:147], a[120:123], a[88:91], v[144:147]
s_add_u32 m0, s16, 0x800
ds_read_b64_tr_b16 a[48:49], v13 offset:33536
v_mfma_f32_16x16x32_bf16 v[148:151], a[124:127], a[88:91], v[148:151]
buffer_load_dwordx4 v2, s[44:47], s21 offen lds
v_mfma_f32_16x16x32_bf16 v[116:119], a[124:127], a[84:87], v[116:119]
ds_read_b64_tr_b16 a[50:51], v13 offset:34560
v_mfma_f32_16x16x32_bf16 v[84:87], a[124:127], a[80:83], v[84:87]
s_add_u32 m0, s16, 0xc00
ds_read_b64_tr_b16 a[52:53], v14 offset:32768
v_mfma_f32_16x16x32_bf16 v[52:55], a[124:127], a[76:79], v[52:55]
buffer_load_dwordx4 v3, s[44:47], s21 offen lds
v_mfma_f32_16x16x32_bf16 v[152:155], a[128:131], a[76:79], v[152:155]
ds_read_b64_tr_b16 a[54:55], v14 offset:33024
v_mfma_f32_16x16x32_bf16 v[160:163], a[128:131], a[80:83], v[160:163]
s_add_u32 m0, s16, 0x1000
ds_read_b64_tr_b16 a[56:57], v15 offset:32768
v_mfma_f32_16x16x32_bf16 v[168:171], a[128:131], a[84:87], v[168:171]
buffer_load_dwordx4 v2, s[44:47], s22 offen lds
v_mfma_f32_16x16x32_bf16 v[176:179], a[128:131], a[88:91], v[176:179]
ds_read_b64_tr_b16 a[58:59], v15 offset:33024
v_mfma_f32_16x16x32_bf16 v[180:183], a[132:135], a[88:91], v[180:183]
s_add_u32 m0, s16, 0x1400
ds_read_b64_tr_b16 a[60:61], v14 offset:36864
v_mfma_f32_16x16x32_bf16 v[172:175], a[132:135], a[84:87], v[172:175]
buffer_load_dwordx4 v3, s[44:47], s22 offen lds
v_mfma_f32_16x16x32_bf16 v[164:167], a[132:135], a[80:83], v[164:167]
ds_read_b64_tr_b16 a[62:63], v14 offset:37120
v_mfma_f32_16x16x32_bf16 v[156:159], a[132:135], a[76:79], v[156:159]
s_add_u32 m0, s16, 0x1800
ds_read_b64_tr_b16 a[64:65], v15 offset:36864
v_mfma_f32_16x16x32_bf16 v[184:187], a[136:139], a[76:79], v[184:187]
buffer_load_dwordx4 v2, s[44:47], s23 offen lds
v_mfma_f32_16x16x32_bf16 v[192:195], a[136:139], a[80:83], v[192:195]
ds_read_b64_tr_b16 a[66:67], v15 offset:37120
v_mfma_f32_16x16x32_bf16 v[200:203], a[136:139], a[84:87], v[200:203]
s_add_u32 m0, s16, 0x1c00
ds_read_b64_tr_b16 a[68:69], v14 offset:40960
v_mfma_f32_16x16x32_bf16 v[208:211], a[136:139], a[88:91], v[208:211]
buffer_load_dwordx4 v3, s[44:47], s23 offen lds
v_mfma_f32_16x16x32_bf16 v[248:251], a[136:139], a[92:95], v[248:251]
ds_read_b64_tr_b16 a[70:71], v14 offset:41216
v_mfma_f32_16x16x32_bf16 v[252:255], a[140:143], a[92:95], v[252:255]
s_add_u32 m0, s18, 0x7000
ds_read_b64_tr_b16 a[72:73], v15 offset:40960
v_mfma_f32_16x16x32_bf16 v[212:215], a[140:143], a[88:91], v[212:215]
buffer_load_dwordx4 v4, s[44:47], s24 offen lds
v_mfma_f32_16x16x32_bf16 v[204:207], a[140:143], a[84:87], v[204:207]
ds_read_b64_tr_b16 a[74:75], v15 offset:41216
v_mfma_f32_16x16x32_bf16 v[196:199], a[140:143], a[80:83], v[196:199]
ds_read_b128 a[16:19], v10 offset:32768
v_mfma_f32_16x16x32_bf16 v[188:191], a[140:143], a[76:79], v[188:191]
v_mfma_f32_16x16x32_bf16 v[216:219], a[76:79], a[144:147], v[216:219]
v_mfma_f32_16x16x32_bf16 v[224:227], a[80:83], a[144:147], v[224:227]
v_mfma_f32_16x16x32_bf16 v[232:235], a[84:87], a[144:147], v[232:235]
v_mfma_f32_16x16x32_bf16 v[240:243], a[88:91], a[144:147], v[240:243]
v_mfma_f32_16x16x32_bf16 v[244:247], a[88:91], a[148:151], v[244:247]
v_mfma_f32_16x16x32_bf16 v[236:239], a[84:87], a[148:151], v[236:239]
v_mfma_f32_16x16x32_bf16 v[228:231], a[80:83], a[148:151], v[228:231]
v_add_u32 v2, 0x80, v2
v_add_u32 v3, 0x80, v3
v_add_u32 v4, 0x80, v4
v_mfma_f32_16x16x32_bf16 v[220:223], a[76:79], a[148:151], v[220:223]
v_add_u32 v5, 0x80000, v5
v_add_u32 v6, 0x80000, v6
v_add_u32 v7, 0x60000, v7
s_waitcnt lgkmcnt(0)
v_mfma_f32_16x16x32_bf16 v[24:27], a[20:23], a[0:3], v[24:27]
ds_read_b64_tr_b16 a[96:97], v12 offset:40960
v_mfma_f32_16x16x32_bf16 v[56:59], a[20:23], a[4:7], v[56:59]
ds_read_b64_tr_b16 a[98:99], v12 offset:41984
v_mfma_f32_16x16x32_bf16 v[88:91], a[20:23], a[8:11], v[88:91]
v_mfma_f32_16x16x32_bf16 v[120:123], a[20:23], a[12:15], v[120:123]
ds_read_b128 a[76:79], v9 offset:32768
v_mfma_f32_16x16x32_bf16 v[124:127], a[24:27], a[12:15], v[124:127]
ds_read_b128 a[80:83], v9 offset:34816
v_mfma_f32_16x16x32_bf16 v[92:95], a[24:27], a[8:11], v[92:95]
v_mfma_f32_16x16x32_bf16 v[60:63], a[24:27], a[4:7], v[60:63]
ds_read_b128 a[84:87], v9 offset:36864
v_mfma_f32_16x16x32_bf16 v[28:31], a[24:27], a[0:3], v[28:31]
ds_read_b128 a[88:91], v9 offset:38912
v_mfma_f32_16x16x32_bf16 v[32:35], a[28:31], a[0:3], v[32:35]
v_mfma_f32_16x16x32_bf16 v[64:67], a[28:31], a[4:7], v[64:67]
ds_read_b64_tr_b16 a[100:101], v13 offset:40960
v_mfma_f32_16x16x32_bf16 v[96:99], a[28:31], a[8:11], v[96:99]
ds_read_b64_tr_b16 a[102:103], v13 offset:41984
v_mfma_f32_16x16x32_bf16 v[128:131], a[28:31], a[12:15], v[128:131]
v_mfma_f32_16x16x32_bf16 v[132:135], a[32:35], a[12:15], v[132:135]
ds_read_b64_tr_b16 a[104:105], v12 offset:41216
v_mfma_f32_16x16x32_bf16 v[100:103], a[32:35], a[8:11], v[100:103]
ds_read_b64_tr_b16 a[106:107], v12 offset:42240
v_mfma_f32_16x16x32_bf16 v[68:71], a[32:35], a[4:7], v[68:71]
v_mfma_f32_16x16x32_bf16 v[36:39], a[32:35], a[0:3], v[36:39]
ds_read_b64_tr_b16 a[108:109], v13 offset:41216
v_mfma_f32_16x16x32_bf16 v[40:43], a[36:39], a[0:3], v[40:43]
ds_read_b64_tr_b16 a[110:111], v13 offset:42240
v_mfma_f32_16x16x32_bf16 v[72:75], a[36:39], a[4:7], v[72:75]
v_mfma_f32_16x16x32_bf16 v[104:107], a[36:39], a[8:11], v[104:107]
ds_read_b64_tr_b16 a[112:113], v12 offset:41472
v_mfma_f32_16x16x32_bf16 v[136:139], a[36:39], a[12:15], v[136:139]
ds_read_b64_tr_b16 a[114:115], v12 offset:42496
v_mfma_f32_16x16x32_bf16 v[140:143], a[40:43], a[12:15], v[140:143]
v_mfma_f32_16x16x32_bf16 v[108:111], a[40:43], a[8:11], v[108:111]
ds_read_b64_tr_b16 a[116:117], v13 offset:41472
v_mfma_f32_16x16x32_bf16 v[76:79], a[40:43], a[4:7], v[76:79]
ds_read_b64_tr_b16 a[118:119], v13 offset:42496
v_mfma_f32_16x16x32_bf16 v[44:47], a[40:43], a[0:3], v[44:47]
v_mfma_f32_16x16x32_bf16 v[48:51], a[44:47], a[0:3], v[48:51]
ds_read_b64_tr_b16 a[120:121], v12 offset:41728
v_mfma_f32_16x16x32_bf16 v[80:83], a[44:47], a[4:7], v[80:83]
ds_read_b64_tr_b16 a[122:123], v12 offset:42752
v_mfma_f32_16x16x32_bf16 v[112:115], a[44:47], a[8:11], v[112:115]
v_mfma_f32_16x16x32_bf16 v[144:147], a[44:47], a[12:15], v[144:147]
ds_read_b64_tr_b16 a[124:125], v13 offset:41728
v_mfma_f32_16x16x32_bf16 v[148:151], a[48:51], a[12:15], v[148:151]
ds_read_b64_tr_b16 a[126:127], v13 offset:42752
v_mfma_f32_16x16x32_bf16 v[116:119], a[48:51], a[8:11], v[116:119]
v_mfma_f32_16x16x32_bf16 v[84:87], a[48:51], a[4:7], v[84:87]
ds_read_b64_tr_b16 a[128:129], v14 offset:34816
v_mfma_f32_16x16x32_bf16 v[52:55], a[48:51], a[0:3], v[52:55]
ds_read_b64_tr_b16 a[130:131], v14 offset:35072
v_mfma_f32_16x16x32_bf16 v[152:155], a[52:55], a[0:3], v[152:155]
v_mfma_f32_16x16x32_bf16 v[160:163], a[52:55], a[4:7], v[160:163]
ds_read_b64_tr_b16 a[132:133], v15 offset:34816
v_mfma_f32_16x16x32_bf16 v[168:171], a[52:55], a[8:11], v[168:171]
ds_read_b64_tr_b16 a[134:135], v15 offset:35072
v_mfma_f32_16x16x32_bf16 v[176:179], a[52:55], a[12:15], v[176:179]
v_mfma_f32_16x16x32_bf16 v[180:183], a[56:59], a[12:15], v[180:183]
ds_read_b64_tr_b16 a[136:137], v14 offset:38912
v_mfma_f32_16x16x32_bf16 v[172:175], a[56:59], a[8:11], v[172:175]
ds_read_b64_tr_b16 a[138:139], v14 offset:39168
v_mfma_f32_16x16x32_bf16 v[164:167], a[56:59], a[4:7], v[164:167]
v_mfma_f32_16x16x32_bf16 v[156:159], a[56:59], a[0:3], v[156:159]
ds_read_b64_tr_b16 a[140:141], v15 offset:38912
v_mfma_f32_16x16x32_bf16 v[184:187], a[60:63], a[0:3], v[184:187]
ds_read_b64_tr_b16 a[142:143], v15 offset:39168
v_mfma_f32_16x16x32_bf16 v[192:195], a[60:63], a[4:7], v[192:195]
v_mfma_f32_16x16x32_bf16 v[200:203], a[60:63], a[8:11], v[200:203]
ds_read_b64_tr_b16 a[144:145], v14 offset:43008
v_mfma_f32_16x16x32_bf16 v[208:211], a[60:63], a[12:15], v[208:211]
ds_read_b64_tr_b16 a[146:147], v14 offset:43264
v_mfma_f32_16x16x32_bf16 v[248:251], a[60:63], a[16:19], v[248:251]
v_mfma_f32_16x16x32_bf16 v[252:255], a[64:67], a[16:19], v[252:255]
ds_read_b64_tr_b16 a[148:149], v15 offset:43008
v_mfma_f32_16x16x32_bf16 v[212:215], a[64:67], a[12:15], v[212:215]
ds_read_b64_tr_b16 a[150:151], v15 offset:43264
v_mfma_f32_16x16x32_bf16 v[204:207], a[64:67], a[8:11], v[204:207]
v_mfma_f32_16x16x32_bf16 v[196:199], a[64:67], a[4:7], v[196:199]
ds_read_b128 a[92:95], v11 offset:32768
v_mfma_f32_16x16x32_bf16 v[188:191], a[64:67], a[0:3], v[188:191]
v_mfma_f32_16x16x32_bf16 v[216:219], a[0:3], a[68:71], v[216:219]
v_mfma_f32_16x16x32_bf16 v[224:227], a[4:7], a[68:71], v[224:227]
v_mfma_f32_16x16x32_bf16 v[232:235], a[8:11], a[68:71], v[232:235]
v_mfma_f32_16x16x32_bf16 v[240:243], a[12:15], a[68:71], v[240:243]
v_mfma_f32_16x16x32_bf16 v[244:247], a[12:15], a[72:75], v[244:247]
v_mfma_f32_16x16x32_bf16 v[236:239], a[8:11], a[72:75], v[236:239]
v_mfma_f32_16x16x32_bf16 v[228:231], a[4:7], a[72:75], v[228:231]
v_mfma_f32_16x16x32_bf16 v[220:223], a[0:3], a[72:75], v[220:223]
s_waitcnt vmcnt(0) lgkmcnt(0)
s_barrier
v_mfma_f32_16x16x32_bf16 v[24:27], a[96:99], a[76:79], v[24:27]
s_add_u32 m0, s17, 0x8000
ds_read_b64_tr_b16 a[20:21], v12 offset:0
v_mfma_f32_16x16x32_bf16 v[56:59], a[96:99], a[80:83], v[56:59]
buffer_load_dwordx4 v5, s[52:55], 0 offen lds
v_mfma_f32_16x16x32_bf16 v[88:91], a[96:99], a[84:87], v[88:91]
ds_read_b64_tr_b16 a[22:23], v12 offset:1024
v_mfma_f32_16x16x32_bf16 v[120:123], a[96:99], a[88:91], v[120:123]
s_add_u32 m0, s17, 0x8400
ds_read_b128 a[0:3], v8 offset:0
v_mfma_f32_16x16x32_bf16 v[124:127], a[100:103], a[88:91], v[124:127]
buffer_load_dwordx4 v5, s[52:55], s13 offen lds
v_mfma_f32_16x16x32_bf16 v[92:95], a[100:103], a[84:87], v[92:95]
ds_read_b128 a[4:7], v8 offset:2048
v_mfma_f32_16x16x32_bf16 v[60:63], a[100:103], a[80:83], v[60:63]
s_add_u32 m0, s17, 0x8800
ds_read_b128 a[8:11], v8 offset:4096
v_mfma_f32_16x16x32_bf16 v[28:31], a[100:103], a[76:79], v[28:31]
buffer_load_dwordx4 v6, s[52:55], 0 offen lds
v_mfma_f32_16x16x32_bf16 v[32:35], a[104:107], a[76:79], v[32:35]
ds_read_b128 a[12:15], v8 offset:6144
v_mfma_f32_16x16x32_bf16 v[64:67], a[104:107], a[80:83], v[64:67]
s_add_u32 m0, s17, 0x8c00
ds_read_b64_tr_b16 a[24:25], v13 offset:0
v_mfma_f32_16x16x32_bf16 v[96:99], a[104:107], a[84:87], v[96:99]
buffer_load_dwordx4 v6, s[52:55], s13 offen lds
v_mfma_f32_16x16x32_bf16 v[128:131], a[104:107], a[88:91], v[128:131]
ds_read_b64_tr_b16 a[26:27], v13 offset:1024
v_mfma_f32_16x16x32_bf16 v[132:135], a[108:111], a[88:91], v[132:135]
s_add_u32 m0, s18, 0xc000
ds_read_b64_tr_b16 a[28:29], v12 offset:256
v_mfma_f32_16x16x32_bf16 v[100:103], a[108:111], a[84:87], v[100:103]
buffer_load_dwordx4 v7, s[68:71], 0 offen lds
v_mfma_f32_16x16x32_bf16 v[68:71], a[108:111], a[80:83], v[68:71]
ds_read_b64_tr_b16 a[30:31], v12 offset:1280
v_mfma_f32_16x16x32_bf16 v[36:39], a[108:111], a[76:79], v[36:39]
s_add_u32 m0, s18, 0xd000
ds_read_b64_tr_b16 a[32:33], v13 offset:256
v_mfma_f32_16x16x32_bf16 v[40:43], a[112:115], a[76:79], v[40:43]
buffer_load_dwordx4 v7, s[68:71], s25 offen lds
v_mfma_f32_16x16x32_bf16 v[72:75], a[112:115], a[80:83], v[72:75]
ds_read_b64_tr_b16 a[34:35], v13 offset:1280
v_mfma_f32_16x16x32_bf16 v[104:107], a[112:115], a[84:87], v[104:107]
s_add_u32 m0, s18, 0xe000
ds_read_b64_tr_b16 a[36:37], v12 offset:512
v_mfma_f32_16x16x32_bf16 v[136:139], a[112:115], a[88:91], v[136:139]
buffer_load_dwordx4 v7, s[68:71], s26 offen lds
v_mfma_f32_16x16x32_bf16 v[140:143], a[116:119], a[88:91], v[140:143]
ds_read_b64_tr_b16 a[38:39], v12 offset:1536
v_mfma_f32_16x16x32_bf16 v[108:111], a[116:119], a[84:87], v[108:111]
s_add_u32 m0, s16, 0x8000
ds_read_b64_tr_b16 a[40:41], v13 offset:512
v_mfma_f32_16x16x32_bf16 v[76:79], a[116:119], a[80:83], v[76:79]
buffer_load_dwordx4 v2, s[44:47], s20 offen lds
v_mfma_f32_16x16x32_bf16 v[44:47], a[116:119], a[76:79], v[44:47]
ds_read_b64_tr_b16 a[42:43], v13 offset:1536
v_mfma_f32_16x16x32_bf16 v[48:51], a[120:123], a[76:79], v[48:51]
s_add_u32 m0, s16, 0x8400
ds_read_b64_tr_b16 a[44:45], v12 offset:768
v_mfma_f32_16x16x32_bf16 v[80:83], a[120:123], a[80:83], v[80:83]
buffer_load_dwordx4 v3, s[44:47], s20 offen lds
v_mfma_f32_16x16x32_bf16 v[112:115], a[120:123], a[84:87], v[112:115]
ds_read_b64_tr_b16 a[46:47], v12 offset:1792
v_mfma_f32_16x16x32_bf16 v[144:147], a[120:123], a[88:91], v[144:147]
s_add_u32 m0, s16, 0x8800
ds_read_b64_tr_b16 a[48:49], v13 offset:768
v_mfma_f32_16x16x32_bf16 v[148:151], a[124:127], a[88:91], v[148:151]
buffer_load_dwordx4 v2, s[44:47], s21 offen lds
v_mfma_f32_16x16x32_bf16 v[116:119], a[124:127], a[84:87], v[116:119]
ds_read_b64_tr_b16 a[50:51], v13 offset:1792
v_mfma_f32_16x16x32_bf16 v[84:87], a[124:127], a[80:83], v[84:87]
s_add_u32 m0, s16, 0x8c00
ds_read_b64_tr_b16 a[52:53], v14 offset:0
v_mfma_f32_16x16x32_bf16 v[52:55], a[124:127], a[76:79], v[52:55]
buffer_load_dwordx4 v3, s[44:47], s21 offen lds
v_mfma_f32_16x16x32_bf16 v[152:155], a[128:131], a[76:79], v[152:155]
ds_read_b64_tr_b16 a[54:55], v14 offset:256
v_mfma_f32_16x16x32_bf16 v[160:163], a[128:131], a[80:83], v[160:163]
s_add_u32 m0, s16, 0x9000
ds_read_b64_tr_b16 a[56:57], v15 offset:0
v_mfma_f32_16x16x32_bf16 v[168:171], a[128:131], a[84:87], v[168:171]
buffer_load_dwordx4 v2, s[44:47], s22 offen lds
v_mfma_f32_16x16x32_bf16 v[176:179], a[128:131], a[88:91], v[176:179]
ds_read_b64_tr_b16 a[58:59], v15 offset:256
v_mfma_f32_16x16x32_bf16 v[180:183], a[132:135], a[88:91], v[180:183]
s_add_u32 m0, s16, 0x9400
ds_read_b64_tr_b16 a[60:61], v14 offset:4096
v_mfma_f32_16x16x32_bf16 v[172:175], a[132:135], a[84:87], v[172:175]
buffer_load_dwordx4 v3, s[44:47], s22 offen lds
v_mfma_f32_16x16x32_bf16 v[164:167], a[132:135], a[80:83], v[164:167]
ds_read_b64_tr_b16 a[62:63], v14 offset:4352
v_mfma_f32_16x16x32_bf16 v[156:159], a[132:135], a[76:79], v[156:159]
s_add_u32 m0, s16, 0x9800
ds_read_b64_tr_b16 a[64:65], v15 offset:4096
v_mfma_f32_16x16x32_bf16 v[184:187], a[136:139], a[76:79], v[184:187]
buffer_load_dwordx4 v2, s[44:47], s23 offen lds
v_mfma_f32_16x16x32_bf16 v[192:195], a[136:139], a[80:83], v[192:195]
ds_read_b64_tr_b16 a[66:67], v15 offset:4352
v_mfma_f32_16x16x32_bf16 v[200:203], a[136:139], a[84:87], v[200:203]
s_add_u32 m0, s16, 0x9c00
ds_read_b64_tr_b16 a[68:69], v14 offset:8192
v_mfma_f32_16x16x32_bf16 v[208:211], a[136:139], a[88:91], v[208:211]
buffer_load_dwordx4 v3, s[44:47], s23 offen lds
v_mfma_f32_16x16x32_bf16 v[248:251], a[136:139], a[92:95], v[248:251]
ds_read_b64_tr_b16 a[70:71], v14 offset:8448
v_mfma_f32_16x16x32_bf16 v[252:255], a[140:143], a[92:95], v[252:255]
s_add_u32 m0, s18, 0xf000
ds_read_b64_tr_b16 a[72:73], v15 offset:8192
v_mfma_f32_16x16x32_bf16 v[212:215], a[140:143], a[88:91], v[212:215]
buffer_load_dwordx4 v4, s[44:47], s24 offen lds
v_mfma_f32_16x16x32_bf16 v[204:207], a[140:143], a[84:87], v[204:207]
ds_read_b64_tr_b16 a[74:75], v15 offset:8448
v_mfma_f32_16x16x32_bf16 v[196:199], a[140:143], a[80:83], v[196:199]
ds_read_b128 a[16:19], v10 offset:0
v_mfma_f32_16x16x32_bf16 v[188:191], a[140:143], a[76:79], v[188:191]
v_mfma_f32_16x16x32_bf16 v[216:219], a[76:79], a[144:147], v[216:219]
v_mfma_f32_16x16x32_bf16 v[224:227], a[80:83], a[144:147], v[224:227]
v_mfma_f32_16x16x32_bf16 v[232:235], a[84:87], a[144:147], v[232:235]
v_mfma_f32_16x16x32_bf16 v[240:243], a[88:91], a[144:147], v[240:243]
v_mfma_f32_16x16x32_bf16 v[244:247], a[88:91], a[148:151], v[244:247]
v_mfma_f32_16x16x32_bf16 v[236:239], a[84:87], a[148:151], v[236:239]
v_mfma_f32_16x16x32_bf16 v[228:231], a[80:83], a[148:151], v[228:231]
v_add_u32 v2, 0x80, v2
v_add_u32 v3, 0x80, v3
v_add_u32 v4, 0x80, v4
v_mfma_f32_16x16x32_bf16 v[220:223], a[76:79], a[148:151], v[220:223]
v_add_u32 v5, 0x80000, v5
v_add_u32 v6, 0x80000, v6
v_add_u32 v7, 0x60000, v7
s_waitcnt lgkmcnt(0)
v_mfma_f32_16x16x32_bf16 v[24:27], a[20:23], a[0:3], v[24:27]
ds_read_b64_tr_b16 a[96:97], v12 offset:8192
v_mfma_f32_16x16x32_bf16 v[56:59], a[20:23], a[4:7], v[56:59]
ds_read_b64_tr_b16 a[98:99], v12 offset:9216
v_mfma_f32_16x16x32_bf16 v[88:91], a[20:23], a[8:11], v[88:91]
v_mfma_f32_16x16x32_bf16 v[120:123], a[20:23], a[12:15], v[120:123]
ds_read_b128 a[76:79], v9 offset:0
v_mfma_f32_16x16x32_bf16 v[124:127], a[24:27], a[12:15], v[124:127]
ds_read_b128 a[80:83], v9 offset:2048
v_mfma_f32_16x16x32_bf16 v[92:95], a[24:27], a[8:11], v[92:95]
v_mfma_f32_16x16x32_bf16 v[60:63], a[24:27], a[4:7], v[60:63]
ds_read_b128 a[84:87], v9 offset:4096
v_mfma_f32_16x16x32_bf16 v[28:31], a[24:27], a[0:3], v[28:31]
ds_read_b128 a[88:91], v9 offset:6144
v_mfma_f32_16x16x32_bf16 v[32:35], a[28:31], a[0:3], v[32:35]
v_mfma_f32_16x16x32_bf16 v[64:67], a[28:31], a[4:7], v[64:67]
ds_read_b64_tr_b16 a[100:101], v13 offset:8192
v_mfma_f32_16x16x32_bf16 v[96:99], a[28:31], a[8:11], v[96:99]
ds_read_b64_tr_b16 a[102:103], v13 offset:9216
v_mfma_f32_16x16x32_bf16 v[128:131], a[28:31], a[12:15], v[128:131]
v_mfma_f32_16x16x32_bf16 v[132:135], a[32:35], a[12:15], v[132:135]
ds_read_b64_tr_b16 a[104:105], v12 offset:8448
v_mfma_f32_16x16x32_bf16 v[100:103], a[32:35], a[8:11], v[100:103]
ds_read_b64_tr_b16 a[106:107], v12 offset:9472
v_mfma_f32_16x16x32_bf16 v[68:71], a[32:35], a[4:7], v[68:71]
v_mfma_f32_16x16x32_bf16 v[36:39], a[32:35], a[0:3], v[36:39]
ds_read_b64_tr_b16 a[108:109], v13 offset:8448
v_mfma_f32_16x16x32_bf16 v[40:43], a[36:39], a[0:3], v[40:43]
ds_read_b64_tr_b16 a[110:111], v13 offset:9472
v_mfma_f32_16x16x32_bf16 v[72:75], a[36:39], a[4:7], v[72:75]
v_mfma_f32_16x16x32_bf16 v[104:107], a[36:39], a[8:11], v[104:107]
ds_read_b64_tr_b16 a[112:113], v12 offset:8704
v_mfma_f32_16x16x32_bf16 v[136:139], a[36:39], a[12:15], v[136:139]
ds_read_b64_tr_b16 a[114:115], v12 offset:9728
v_mfma_f32_16x16x32_bf16 v[140:143], a[40:43], a[12:15], v[140:143]
v_mfma_f32_16x16x32_bf16 v[108:111], a[40:43], a[8:11], v[108:111]
ds_read_b64_tr_b16 a[116:117], v13 offset:8704
v_mfma_f32_16x16x32_bf16 v[76:79], a[40:43], a[4:7], v[76:79]
ds_read_b64_tr_b16 a[118:119], v13 offset:9728
v_mfma_f32_16x16x32_bf16 v[44:47], a[40:43], a[0:3], v[44:47]
v_mfma_f32_16x16x32_bf16 v[48:51], a[44:47], a[0:3], v[48:51]
ds_read_b64_tr_b16 a[120:121], v12 offset:8960
v_mfma_f32_16x16x32_bf16 v[80:83], a[44:47], a[4:7], v[80:83]
ds_read_b64_tr_b16 a[122:123], v12 offset:9984
v_mfma_f32_16x16x32_bf16 v[112:115], a[44:47], a[8:11], v[112:115]
v_mfma_f32_16x16x32_bf16 v[144:147], a[44:47], a[12:15], v[144:147]
ds_read_b64_tr_b16 a[124:125], v13 offset:8960
v_mfma_f32_16x16x32_bf16 v[148:151], a[48:51], a[12:15], v[148:151]
ds_read_b64_tr_b16 a[126:127], v13 offset:9984
v_mfma_f32_16x16x32_bf16 v[116:119], a[48:51], a[8:11], v[116:119]
v_mfma_f32_16x16x32_bf16 v[84:87], a[48:51], a[4:7], v[84:87]
ds_read_b64_tr_b16 a[128:129], v14 offset:2048
v_mfma_f32_16x16x32_bf16 v[52:55], a[48:51], a[0:3], v[52:55]
ds_read_b64_tr_b16 a[130:131], v14 offset:2304
v_mfma_f32_16x16x32_bf16 v[152:155], a[52:55], a[0:3], v[152:155]
v_mfma_f32_16x16x32_bf16 v[160:163], a[52:55], a[4:7], v[160:163]
ds_read_b64_tr_b16 a[132:133], v15 offset:2048
v_mfma_f32_16x16x32_bf16 v[168:171], a[52:55], a[8:11], v[168:171]
ds_read_b64_tr_b16 a[134:135], v15 offset:2304
v_mfma_f32_16x16x32_bf16 v[176:179], a[52:55], a[12:15], v[176:179]
v_mfma_f32_16x16x32_bf16 v[180:183], a[56:59], a[12:15], v[180:183]
ds_read_b64_tr_b16 a[136:137], v14 offset:6144
v_mfma_f32_16x16x32_bf16 v[172:175], a[56:59], a[8:11], v[172:175]
ds_read_b64_tr_b16 a[138:139], v14 offset:6400
v_mfma_f32_16x16x32_bf16 v[164:167], a[56:59], a[4:7], v[164:167]
v_mfma_f32_16x16x32_bf16 v[156:159], a[56:59], a[0:3], v[156:159]
ds_read_b64_tr_b16 a[140:141], v15 offset:6144
v_mfma_f32_16x16x32_bf16 v[184:187], a[60:63], a[0:3], v[184:187]
ds_read_b64_tr_b16 a[142:143], v15 offset:6400
v_mfma_f32_16x16x32_bf16 v[192:195], a[60:63], a[4:7], v[192:195]
v_mfma_f32_16x16x32_bf16 v[200:203], a[60:63], a[8:11], v[200:203]
ds_read_b64_tr_b16 a[144:145], v14 offset:10240
v_mfma_f32_16x16x32_bf16 v[208:211], a[60:63], a[12:15], v[208:211]
ds_read_b64_tr_b16 a[146:147], v14 offset:10496
v_mfma_f32_16x16x32_bf16 v[248:251], a[60:63], a[16:19], v[248:251]
v_mfma_f32_16x16x32_bf16 v[252:255], a[64:67], a[16:19], v[252:255]
ds_read_b64_tr_b16 a[148:149], v15 offset:10240
v_mfma_f32_16x16x32_bf16 v[212:215], a[64:67], a[12:15], v[212:215]
ds_read_b64_tr_b16 a[150:151], v15 offset:10496
v_mfma_f32_16x16x32_bf16 v[204:207], a[64:67], a[8:11], v[204:207]
v_mfma_f32_16x16x32_bf16 v[196:199], a[64:67], a[4:7], v[196:199]
ds_read_b128 a[92:95], v11 offset:0
v_mfma_f32_16x16x32_bf16 v[188:191], a[64:67], a[0:3], v[188:191]
v_mfma_f32_16x16x32_bf16 v[216:219], a[0:3], a[68:71], v[216:219]
v_mfma_f32_16x16x32_bf16 v[224:227], a[4:7], a[68:71], v[224:227]
v_mfma_f32_16x16x32_bf16 v[232:235], a[8:11], a[68:71], v[232:235]
v_mfma_f32_16x16x32_bf16 v[240:243], a[12:15], a[68:71], v[240:243]
v_mfma_f32_16x16x32_bf16 v[244:247], a[12:15], a[72:75], v[244:247]
v_mfma_f32_16x16x32_bf16 v[236:239], a[8:11], a[72:75], v[236:239]
v_mfma_f32_16x16x32_bf16 v[228:231], a[4:7], a[72:75], v[228:231]
v_mfma_f32_16x16x32_bf16 v[220:223], a[0:3], a[72:75], v[220:223]
s_sub_u32 s15, s15, 1
s_cmp_lg_u32 s15, 0
s_cbranch_scc1 L_p2e_loop
s_waitcnt vmcnt(0) lgkmcnt(0)
s_barrier
v_mfma_f32_16x16x32_bf16 v[24:27], a[96:99], a[76:79], v[24:27]
ds_read_b64_tr_b16 a[20:21], v12 offset:32768
v_mfma_f32_16x16x32_bf16 v[56:59], a[96:99], a[80:83], v[56:59]
ds_read_b64_tr_b16 a[22:23], v12 offset:33792
v_mfma_f32_16x16x32_bf16 v[88:91], a[96:99], a[84:87], v[88:91]
v_mfma_f32_16x16x32_bf16 v[120:123], a[96:99], a[88:91], v[120:123]
ds_read_b128 a[0:3], v8 offset:32768
v_mfma_f32_16x16x32_bf16 v[124:127], a[100:103], a[88:91], v[124:127]
ds_read_b128 a[4:7], v8 offset:34816
v_mfma_f32_16x16x32_bf16 v[92:95], a[100:103], a[84:87], v[92:95]
v_mfma_f32_16x16x32_bf16 v[60:63], a[100:103], a[80:83], v[60:63]
ds_read_b128 a[8:11], v8 offset:36864
v_mfma_f32_16x16x32_bf16 v[28:31], a[100:103], a[76:79], v[28:31]
ds_read_b128 a[12:15], v8 offset:38912
v_mfma_f32_16x16x32_bf16 v[32:35], a[104:107], a[76:79], v[32:35]
v_mfma_f32_16x16x32_bf16 v[64:67], a[104:107], a[80:83], v[64:67]
ds_read_b64_tr_b16 a[24:25], v13 offset:32768
v_mfma_f32_16x16x32_bf16 v[96:99], a[104:107], a[84:87], v[96:99]
ds_read_b64_tr_b16 a[26:27], v13 offset:33792
v_mfma_f32_16x16x32_bf16 v[128:131], a[104:107], a[88:91], v[128:131]
v_mfma_f32_16x16x32_bf16 v[132:135], a[108:111], a[88:91], v[132:135]
ds_read_b64_tr_b16 a[28:29], v12 offset:33024
v_mfma_f32_16x16x32_bf16 v[100:103], a[108:111], a[84:87], v[100:103]
ds_read_b64_tr_b16 a[30:31], v12 offset:34048
v_mfma_f32_16x16x32_bf16 v[68:71], a[108:111], a[80:83], v[68:71]
v_mfma_f32_16x16x32_bf16 v[36:39], a[108:111], a[76:79], v[36:39]
ds_read_b64_tr_b16 a[32:33], v13 offset:33024
v_mfma_f32_16x16x32_bf16 v[40:43], a[112:115], a[76:79], v[40:43]
ds_read_b64_tr_b16 a[34:35], v13 offset:34048
v_mfma_f32_16x16x32_bf16 v[72:75], a[112:115], a[80:83], v[72:75]
v_mfma_f32_16x16x32_bf16 v[104:107], a[112:115], a[84:87], v[104:107]
ds_read_b64_tr_b16 a[36:37], v12 offset:33280
v_mfma_f32_16x16x32_bf16 v[136:139], a[112:115], a[88:91], v[136:139]
ds_read_b64_tr_b16 a[38:39], v12 offset:34304
v_mfma_f32_16x16x32_bf16 v[140:143], a[116:119], a[88:91], v[140:143]
v_mfma_f32_16x16x32_bf16 v[108:111], a[116:119], a[84:87], v[108:111]
ds_read_b64_tr_b16 a[40:41], v13 offset:33280
v_mfma_f32_16x16x32_bf16 v[76:79], a[116:119], a[80:83], v[76:79]
ds_read_b64_tr_b16 a[42:43], v13 offset:34304
v_mfma_f32_16x16x32_bf16 v[44:47], a[116:119], a[76:79], v[44:47]
v_mfma_f32_16x16x32_bf16 v[48:51], a[120:123], a[76:79], v[48:51]
ds_read_b64_tr_b16 a[44:45], v12 offset:33536
v_mfma_f32_16x16x32_bf16 v[80:83], a[120:123], a[80:83], v[80:83]
ds_read_b64_tr_b16 a[46:47], v12 offset:34560
v_mfma_f32_16x16x32_bf16 v[112:115], a[120:123], a[84:87], v[112:115]
v_mfma_f32_16x16x32_bf16 v[144:147], a[120:123], a[88:91], v[144:147]
ds_read_b64_tr_b16 a[48:49], v13 offset:33536
v_mfma_f32_16x16x32_bf16 v[148:151], a[124:127], a[88:91], v[148:151]
ds_read_b64_tr_b16 a[50:51], v13 offset:34560
v_mfma_f32_16x16x32_bf16 v[116:119], a[124:127], a[84:87], v[116:119]
v_mfma_f32_16x16x32_bf16 v[84:87], a[124:127], a[80:83], v[84:87]
ds_read_b64_tr_b16 a[52:53], v14 offset:32768
v_mfma_f32_16x16x32_bf16 v[52:55], a[124:127], a[76:79], v[52:55]
ds_read_b64_tr_b16 a[54:55], v14 offset:33024
v_mfma_f32_16x16x32_bf16 v[152:155], a[128:131], a[76:79], v[152:155]
v_mfma_f32_16x16x32_bf16 v[160:163], a[128:131], a[80:83], v[160:163]
ds_read_b64_tr_b16 a[56:57], v15 offset:32768
v_mfma_f32_16x16x32_bf16 v[168:171], a[128:131], a[84:87], v[168:171]
ds_read_b64_tr_b16 a[58:59], v15 offset:33024
v_mfma_f32_16x16x32_bf16 v[176:179], a[128:131], a[88:91], v[176:179]
v_mfma_f32_16x16x32_bf16 v[180:183], a[132:135], a[88:91], v[180:183]
ds_read_b64_tr_b16 a[60:61], v14 offset:36864
v_mfma_f32_16x16x32_bf16 v[172:175], a[132:135], a[84:87], v[172:175]
ds_read_b64_tr_b16 a[62:63], v14 offset:37120
v_mfma_f32_16x16x32_bf16 v[164:167], a[132:135], a[80:83], v[164:167]
v_mfma_f32_16x16x32_bf16 v[156:159], a[132:135], a[76:79], v[156:159]
ds_read_b64_tr_b16 a[64:65], v15 offset:36864
v_mfma_f32_16x16x32_bf16 v[184:187], a[136:139], a[76:79], v[184:187]
ds_read_b64_tr_b16 a[66:67], v15 offset:37120
v_mfma_f32_16x16x32_bf16 v[192:195], a[136:139], a[80:83], v[192:195]
v_mfma_f32_16x16x32_bf16 v[200:203], a[136:139], a[84:87], v[200:203]
ds_read_b64_tr_b16 a[68:69], v14 offset:40960
v_mfma_f32_16x16x32_bf16 v[208:211], a[136:139], a[88:91], v[208:211]
ds_read_b64_tr_b16 a[70:71], v14 offset:41216
v_mfma_f32_16x16x32_bf16 v[248:251], a[136:139], a[92:95], v[248:251]
v_mfma_f32_16x16x32_bf16 v[252:255], a[140:143], a[92:95], v[252:255]
ds_read_b64_tr_b16 a[72:73], v15 offset:40960
v_mfma_f32_16x16x32_bf16 v[212:215], a[140:143], a[88:91], v[212:215]
ds_read_b64_tr_b16 a[74:75], v15 offset:41216
v_mfma_f32_16x16x32_bf16 v[204:207], a[140:143], a[84:87], v[204:207]
v_mfma_f32_16x16x32_bf16 v[196:199], a[140:143], a[80:83], v[196:199]
ds_read_b128 a[16:19], v10 offset:32768
v_mfma_f32_16x16x32_bf16 v[188:191], a[140:143], a[76:79], v[188:191]
v_mfma_f32_16x16x32_bf16 v[216:219], a[76:79], a[144:147], v[216:219]
v_mfma_f32_16x16x32_bf16 v[224:227], a[80:83], a[144:147], v[224:227]
v_mfma_f32_16x16x32_bf16 v[232:235], a[84:87], a[144:147], v[232:235]
v_mfma_f32_16x16x32_bf16 v[240:243], a[88:91], a[144:147], v[240:243]
v_mfma_f32_16x16x32_bf16 v[244:247], a[88:91], a[148:151], v[244:247]
v_mfma_f32_16x16x32_bf16 v[236:239], a[84:87], a[148:151], v[236:239]
v_mfma_f32_16x16x32_bf16 v[228:231], a[80:83], a[148:151], v[228:231]
v_mfma_f32_16x16x32_bf16 v[220:223], a[76:79], a[148:151], v[220:223]
s_waitcnt lgkmcnt(0)
v_mfma_f32_16x16x32_bf16 v[24:27], a[20:23], a[0:3], v[24:27]
ds_read_b64_tr_b16 a[96:97], v12 offset:40960
v_mfma_f32_16x16x32_bf16 v[56:59], a[20:23], a[4:7], v[56:59]
ds_read_b64_tr_b16 a[98:99], v12 offset:41984
v_mfma_f32_16x16x32_bf16 v[88:91], a[20:23], a[8:11], v[88:91]
v_mfma_f32_16x16x32_bf16 v[120:123], a[20:23], a[12:15], v[120:123]
ds_read_b128 a[76:79], v9 offset:32768
v_mfma_f32_16x16x32_bf16 v[124:127], a[24:27], a[12:15], v[124:127]
ds_read_b128 a[80:83], v9 offset:34816
v_mfma_f32_16x16x32_bf16 v[92:95], a[24:27], a[8:11], v[92:95]
v_mfma_f32_16x16x32_bf16 v[60:63], a[24:27], a[4:7], v[60:63]
ds_read_b128 a[84:87], v9 offset:36864
v_mfma_f32_16x16x32_bf16 v[28:31], a[24:27], a[0:3], v[28:31]
ds_read_b128 a[88:91], v9 offset:38912
v_mfma_f32_16x16x32_bf16 v[32:35], a[28:31], a[0:3], v[32:35]
v_mfma_f32_16x16x32_bf16 v[64:67], a[28:31], a[4:7], v[64:67]
ds_read_b64_tr_b16 a[100:101], v13 offset:40960
v_mfma_f32_16x16x32_bf16 v[96:99], a[28:31], a[8:11], v[96:99]
ds_read_b64_tr_b16 a[102:103], v13 offset:41984
v_mfma_f32_16x16x32_bf16 v[128:131], a[28:31], a[12:15], v[128:131]
v_mfma_f32_16x16x32_bf16 v[132:135], a[32:35], a[12:15], v[132:135]
ds_read_b64_tr_b16 a[104:105], v12 offset:41216
v_mfma_f32_16x16x32_bf16 v[100:103], a[32:35], a[8:11], v[100:103]
ds_read_b64_tr_b16 a[106:107], v12 offset:42240
v_mfma_f32_16x16x32_bf16 v[68:71], a[32:35], a[4:7], v[68:71]
v_mfma_f32_16x16x32_bf16 v[36:39], a[32:35], a[0:3], v[36:39]
ds_read_b64_tr_b16 a[108:109], v13 offset:41216
v_mfma_f32_16x16x32_bf16 v[40:43], a[36:39], a[0:3], v[40:43]
ds_read_b64_tr_b16 a[110:111], v13 offset:42240
v_mfma_f32_16x16x32_bf16 v[72:75], a[36:39], a[4:7], v[72:75]
v_mfma_f32_16x16x32_bf16 v[104:107], a[36:39], a[8:11], v[104:107]
ds_read_b64_tr_b16 a[112:113], v12 offset:41472
v_mfma_f32_16x16x32_bf16 v[136:139], a[36:39], a[12:15], v[136:139]
ds_read_b64_tr_b16 a[114:115], v12 offset:42496
v_mfma_f32_16x16x32_bf16 v[140:143], a[40:43], a[12:15], v[140:143]
v_mfma_f32_16x16x32_bf16 v[108:111], a[40:43], a[8:11], v[108:111]
ds_read_b64_tr_b16 a[116:117], v13 offset:41472
v_mfma_f32_16x16x32_bf16 v[76:79], a[40:43], a[4:7], v[76:79]
ds_read_b64_tr_b16 a[118:119], v13 offset:42496
v_mfma_f32_16x16x32_bf16 v[44:47], a[40:43], a[0:3], v[44:47]
v_mfma_f32_16x16x32_bf16 v[48:51], a[44:47], a[0:3], v[48:51]
ds_read_b64_tr_b16 a[120:121], v12 offset:41728
v_mfma_f32_16x16x32_bf16 v[80:83], a[44:47], a[4:7], v[80:83]
ds_read_b64_tr_b16 a[122:123], v12 offset:42752
v_mfma_f32_16x16x32_bf16 v[112:115], a[44:47], a[8:11], v[112:115]
v_mfma_f32_16x16x32_bf16 v[144:147], a[44:47], a[12:15], v[144:147]
ds_read_b64_tr_b16 a[124:125], v13 offset:41728
v_mfma_f32_16x16x32_bf16 v[148:151], a[48:51], a[12:15], v[148:151]
ds_read_b64_tr_b16 a[126:127], v13 offset:42752
v_mfma_f32_16x16x32_bf16 v[116:119], a[48:51], a[8:11], v[116:119]
v_mfma_f32_16x16x32_bf16 v[84:87], a[48:51], a[4:7], v[84:87]
ds_read_b64_tr_b16 a[128:129], v14 offset:34816
v_mfma_f32_16x16x32_bf16 v[52:55], a[48:51], a[0:3], v[52:55]
ds_read_b64_tr_b16 a[130:131], v14 offset:35072
v_mfma_f32_16x16x32_bf16 v[152:155], a[52:55], a[0:3], v[152:155]
v_mfma_f32_16x16x32_bf16 v[160:163], a[52:55], a[4:7], v[160:163]
ds_read_b64_tr_b16 a[132:133], v15 offset:34816
v_mfma_f32_16x16x32_bf16 v[168:171], a[52:55], a[8:11], v[168:171]
ds_read_b64_tr_b16 a[134:135], v15 offset:35072
v_mfma_f32_16x16x32_bf16 v[176:179], a[52:55], a[12:15], v[176:179]
v_mfma_f32_16x16x32_bf16 v[180:183], a[56:59], a[12:15], v[180:183]
ds_read_b64_tr_b16 a[136:137], v14 offset:38912
v_mfma_f32_16x16x32_bf16 v[172:175], a[56:59], a[8:11], v[172:175]
ds_read_b64_tr_b16 a[138:139], v14 offset:39168
v_mfma_f32_16x16x32_bf16 v[164:167], a[56:59], a[4:7], v[164:167]
v_mfma_f32_16x16x32_bf16 v[156:159], a[56:59], a[0:3], v[156:159]
ds_read_b64_tr_b16 a[140:141], v15 offset:38912
v_mfma_f32_16x16x32_bf16 v[184:187], a[60:63], a[0:3], v[184:187]
ds_read_b64_tr_b16 a[142:143], v15 offset:39168
v_mfma_f32_16x16x32_bf16 v[192:195], a[60:63], a[4:7], v[192:195]
v_mfma_f32_16x16x32_bf16 v[200:203], a[60:63], a[8:11], v[200:203]
ds_read_b64_tr_b16 a[144:145], v14 offset:43008
v_mfma_f32_16x16x32_bf16 v[208:211], a[60:63], a[12:15], v[208:211]
ds_read_b64_tr_b16 a[146:147], v14 offset:43264
v_mfma_f32_16x16x32_bf16 v[248:251], a[60:63], a[16:19], v[248:251]
v_mfma_f32_16x16x32_bf16 v[252:255], a[64:67], a[16:19], v[252:255]
ds_read_b64_tr_b16 a[148:149], v15 offset:43008
v_mfma_f32_16x16x32_bf16 v[212:215], a[64:67], a[12:15], v[212:215]
ds_read_b64_tr_b16 a[150:151], v15 offset:43264
v_mfma_f32_16x16x32_bf16 v[204:207], a[64:67], a[8:11], v[204:207]
v_mfma_f32_16x16x32_bf16 v[196:199], a[64:67], a[4:7], v[196:199]
ds_read_b128 a[92:95], v11 offset:32768
v_mfma_f32_16x16x32_bf16 v[188:191], a[64:67], a[0:3], v[188:191]
v_mfma_f32_16x16x32_bf16 v[216:219], a[0:3], a[68:71], v[216:219]
v_mfma_f32_16x16x32_bf16 v[224:227], a[4:7], a[68:71], v[224:227]
v_mfma_f32_16x16x32_bf16 v[232:235], a[8:11], a[68:71], v[232:235]
v_mfma_f32_16x16x32_bf16 v[240:243], a[12:15], a[68:71], v[240:243]
v_mfma_f32_16x16x32_bf16 v[244:247], a[12:15], a[72:75], v[244:247]
v_mfma_f32_16x16x32_bf16 v[236:239], a[8:11], a[72:75], v[236:239]
v_mfma_f32_16x16x32_bf16 v[228:231], a[4:7], a[72:75], v[228:231]
v_mfma_f32_16x16x32_bf16 v[220:223], a[0:3], a[72:75], v[220:223]
s_waitcnt vmcnt(0) lgkmcnt(0)
s_barrier
v_mfma_f32_16x16x32_bf16 v[24:27], a[96:99], a[76:79], v[24:27]
v_mfma_f32_16x16x32_bf16 v[56:59], a[96:99], a[80:83], v[56:59]
v_mfma_f32_16x16x32_bf16 v[88:91], a[96:99], a[84:87], v[88:91]
v_mfma_f32_16x16x32_bf16 v[120:123], a[96:99], a[88:91], v[120:123]
v_mfma_f32_16x16x32_bf16 v[124:127], a[100:103], a[88:91], v[124:127]
v_mfma_f32_16x16x32_bf16 v[92:95], a[100:103], a[84:87], v[92:95]
v_mfma_f32_16x16x32_bf16 v[60:63], a[100:103], a[80:83], v[60:63]
v_mfma_f32_16x16x32_bf16 v[28:31], a[100:103], a[76:79], v[28:31]
v_mfma_f32_16x16x32_bf16 v[32:35], a[104:107], a[76:79], v[32:35]
v_mfma_f32_16x16x32_bf16 v[64:67], a[104:107], a[80:83], v[64:67]
v_mfma_f32_16x16x32_bf16 v[96:99], a[104:107], a[84:87], v[96:99]
v_mfma_f32_16x16x32_bf16 v[128:131], a[104:107], a[88:91], v[128:131]
v_mfma_f32_16x16x32_bf16 v[132:135], a[108:111], a[88:91], v[132:135]
v_mfma_f32_16x16x32_bf16 v[100:103], a[108:111], a[84:87], v[100:103]
v_mfma_f32_16x16x32_bf16 v[68:71], a[108:111], a[80:83], v[68:71]
v_mfma_f32_16x16x32_bf16 v[36:39], a[108:111], a[76:79], v[36:39]
v_mfma_f32_16x16x32_bf16 v[40:43], a[112:115], a[76:79], v[40:43]
v_mfma_f32_16x16x32_bf16 v[72:75], a[112:115], a[80:83], v[72:75]
v_mfma_f32_16x16x32_bf16 v[104:107], a[112:115], a[84:87], v[104:107]
v_mfma_f32_16x16x32_bf16 v[136:139], a[112:115], a[88:91], v[136:139]
v_mfma_f32_16x16x32_bf16 v[140:143], a[116:119], a[88:91], v[140:143]
v_mfma_f32_16x16x32_bf16 v[108:111], a[116:119], a[84:87], v[108:111]
v_mfma_f32_16x16x32_bf16 v[76:79], a[116:119], a[80:83], v[76:79]
v_mfma_f32_16x16x32_bf16 v[44:47], a[116:119], a[76:79], v[44:47]
v_mfma_f32_16x16x32_bf16 v[48:51], a[120:123], a[76:79], v[48:51]
v_mfma_f32_16x16x32_bf16 v[80:83], a[120:123], a[80:83], v[80:83]
v_mfma_f32_16x16x32_bf16 v[112:115], a[120:123], a[84:87], v[112:115]
v_mfma_f32_16x16x32_bf16 v[144:147], a[120:123], a[88:91], v[144:147]
v_mfma_f32_16x16x32_bf16 v[148:151], a[124:127], a[88:91], v[148:151]
v_mfma_f32_16x16x32_bf16 v[116:119], a[124:127], a[84:87], v[116:119]
v_mfma_f32_16x16x32_bf16 v[84:87], a[124:127], a[80:83], v[84:87]
v_mfma_f32_16x16x32_bf16 v[52:55], a[124:127], a[76:79], v[52:55]
v_mfma_f32_16x16x32_bf16 v[152:155], a[128:131], a[76:79], v[152:155]
v_mfma_f32_16x16x32_bf16 v[160:163], a[128:131], a[80:83], v[160:163]
v_mfma_f32_16x16x32_bf16 v[168:171], a[128:131], a[84:87], v[168:171]
v_mfma_f32_16x16x32_bf16 v[176:179], a[128:131], a[88:91], v[176:179]
v_mfma_f32_16x16x32_bf16 v[180:183], a[132:135], a[88:91], v[180:183]
v_mfma_f32_16x16x32_bf16 v[172:175], a[132:135], a[84:87], v[172:175]
v_mfma_f32_16x16x32_bf16 v[164:167], a[132:135], a[80:83], v[164:167]
v_mfma_f32_16x16x32_bf16 v[156:159], a[132:135], a[76:79], v[156:159]
v_mfma_f32_16x16x32_bf16 v[184:187], a[136:139], a[76:79], v[184:187]
v_mfma_f32_16x16x32_bf16 v[192:195], a[136:139], a[80:83], v[192:195]
v_mfma_f32_16x16x32_bf16 v[200:203], a[136:139], a[84:87], v[200:203]
v_mfma_f32_16x16x32_bf16 v[208:211], a[136:139], a[88:91], v[208:211]
v_mfma_f32_16x16x32_bf16 v[248:251], a[136:139], a[92:95], v[248:251]
v_mfma_f32_16x16x32_bf16 v[252:255], a[140:143], a[92:95], v[252:255]
v_mfma_f32_16x16x32_bf16 v[212:215], a[140:143], a[88:91], v[212:215]
v_mfma_f32_16x16x32_bf16 v[204:207], a[140:143], a[84:87], v[204:207]
v_mfma_f32_16x16x32_bf16 v[196:199], a[140:143], a[80:83], v[196:199]
v_mfma_f32_16x16x32_bf16 v[188:191], a[140:143], a[76:79], v[188:191]
v_mfma_f32_16x16x32_bf16 v[216:219], a[76:79], a[144:147], v[216:219]
v_mfma_f32_16x16x32_bf16 v[224:227], a[80:83], a[144:147], v[224:227]
v_mfma_f32_16x16x32_bf16 v[232:235], a[84:87], a[144:147], v[232:235]
v_mfma_f32_16x16x32_bf16 v[240:243], a[88:91], a[144:147], v[240:243]
v_mfma_f32_16x16x32_bf16 v[244:247], a[88:91], a[148:151], v[244:247]
v_mfma_f32_16x16x32_bf16 v[236:239], a[84:87], a[148:151], v[236:239]
v_mfma_f32_16x16x32_bf16 v[228:231], a[80:83], a[148:151], v[228:231]
v_mfma_f32_16x16x32_bf16 v[220:223], a[76:79], a[148:151], v[220:223]
s_branch L_p2_join
L_p2_odd:
ds_read_b64_tr_b16 a[20:21], v12 offset:0
ds_read_b64_tr_b16 a[22:23], v12 offset:1024
ds_read_b128 a[0:3], v8 offset:0
ds_read_b128 a[4:7], v8 offset:2048
ds_read_b128 a[8:11], v8 offset:4096
ds_read_b128 a[12:15], v8 offset:6144
ds_read_b64_tr_b16 a[24:25], v13 offset:0
ds_read_b64_tr_b16 a[26:27], v13 offset:1024
ds_read_b64_tr_b16 a[28:29], v12 offset:256
ds_read_b64_tr_b16 a[30:31], v12 offset:1280
ds_read_b64_tr_b16 a[32:33], v13 offset:256
ds_read_b64_tr_b16 a[34:35], v13 offset:1280
ds_read_b64_tr_b16 a[36:37], v12 offset:512
ds_read_b64_tr_b16 a[38:39], v12 offset:1536
ds_read_b64_tr_b16 a[40:41], v13 offset:512
ds_read_b64_tr_b16 a[42:43], v13 offset:1536
ds_read_b64_tr_b16 a[44:45], v12 offset:768
ds_read_b64_tr_b16 a[46:47], v12 offset:1792
ds_read_b64_tr_b16 a[48:49], v13 offset:768
ds_read_b64_tr_b16 a[50:51], v13 offset:1792
ds_read_b64_tr_b16 a[52:53], v14 offset:0
ds_read_b64_tr_b16 a[54:55], v14 offset:256
ds_read_b64_tr_b16 a[56:57], v15 offset:0
ds_read_b64_tr_b16 a[58:59], v15 offset:256
ds_read_b64_tr_b16 a[60:61], v14 offset:4096
ds_read_b64_tr_b16 a[62:63], v14 offset:4352
ds_read_b64_tr_b16 a[64:65], v15 offset:4096
ds_read_b64_tr_b16 a[66:67], v15 offset:4352
ds_read_b64_tr_b16 a[68:69], v14 offset:8192
ds_read_b64_tr_b16 a[70:71], v14 offset:8448
ds_read_b64_tr_b16 a[72:73], v15 offset:8192
ds_read_b64_tr_b16 a[74:75], v15 offset:8448
ds_read_b128 a[16:19], v10 offset:0
s_waitcnt lgkmcnt(0)
v_mfma_f32_16x16x32_bf16 v[24:27], a[20:23], a[0:3], 0
ds_read_b64_tr_b16 a[96:97], v12 offset:8192
v_mfma_f32_16x16x32_bf16 v[56:59], a[20:23], a[4:7], 0
ds_read_b64_tr_b16 a[98:99], v12 offset:9216
v_mfma_f32_16x16x32_bf16 v[88:91], a[20:23], a[8:11], 0
v_mfma_f32_16x16x32_bf16 v[120:123], a[20:23], a[12:15], 0
ds_read_b128 a[76:79], v9 offset:0
v_mfma_f32_16x16x32_bf16 v[124:127], a[24:27], a[12:15], 0
ds_read_b128 a[80:83], v9 offset:2048
v_mfma_f32_16x16x32_bf16 v[92:95], a[24:27], a[8:11], 0
v_mfma_f32_16x16x32_bf16 v[60:63], a[24:27], a[4:7], 0
ds_read_b128 a[84:87], v9 offset:4096
v_mfma_f32_16x16x32_bf16 v[28:31], a[24:27], a[0:3], 0
ds_read_b128 a[88:91], v9 offset:6144
v_mfma_f32_16x16x32_bf16 v[32:35], a[28:31], a[0:3], 0
v_mfma_f32_16x16x32_bf16 v[64:67], a[28:31], a[4:7], 0
ds_read_b64_tr_b16 a[100:101], v13 offset:8192
v_mfma_f32_16x16x32_bf16 v[96:99], a[28:31], a[8:11], 0
ds_read_b64_tr_b16 a[102:103], v13 offset:9216
v_mfma_f32_16x16x32_bf16 v[128:131], a[28:31], a[12:15], 0
v_mfma_f32_16x16x32_bf16 v[132:135], a[32:35], a[12:15], 0
ds_read_b64_tr_b16 a[104:105], v12 offset:8448
v_mfma_f32_16x16x32_bf16 v[100:103], a[32:35], a[8:11], 0
ds_read_b64_tr_b16 a[106:107], v12 offset:9472
v_mfma_f32_16x16x32_bf16 v[68:71], a[32:35], a[4:7], 0
v_mfma_f32_16x16x32_bf16 v[36:39], a[32:35], a[0:3], 0
ds_read_b64_tr_b16 a[108:109], v13 offset:8448
v_mfma_f32_16x16x32_bf16 v[40:43], a[36:39], a[0:3], 0
ds_read_b64_tr_b16 a[110:111], v13 offset:9472
v_mfma_f32_16x16x32_bf16 v[72:75], a[36:39], a[4:7], 0
v_mfma_f32_16x16x32_bf16 v[104:107], a[36:39], a[8:11], 0
ds_read_b64_tr_b16 a[112:113], v12 offset:8704
v_mfma_f32_16x16x32_bf16 v[136:139], a[36:39], a[12:15], 0
ds_read_b64_tr_b16 a[114:115], v12 offset:9728
v_mfma_f32_16x16x32_bf16 v[140:143], a[40:43], a[12:15], 0
v_mfma_f32_16x16x32_bf16 v[108:111], a[40:43], a[8:11], 0
ds_read_b64_tr_b16 a[116:117], v13 offset:8704
v_mfma_f32_16x16x32_bf16 v[76:79], a[40:43], a[4:7], 0
ds_read_b64_tr_b16 a[118:119], v13 offset:9728
v_mfma_f32_16x16x32_bf16 v[44:47], a[40:43], a[0:3], 0
v_mfma_f32_16x16x32_bf16 v[48:51], a[44:47], a[0:3], 0
ds_read_b64_tr_b16 a[120:121], v12 offset:8960
v_mfma_f32_16x16x32_bf16 v[80:83], a[44:47], a[4:7], 0
ds_read_b64_tr_b16 a[122:123], v12 offset:9984
v_mfma_f32_16x16x32_bf16 v[112:115], a[44:47], a[8:11], 0
v_mfma_f32_16x16x32_bf16 v[144:147], a[44:47], a[12:15], 0
ds_read_b64_tr_b16 a[124:125], v13 offset:8960
v_mfma_f32_16x16x32_bf16 v[148:151], a[48:51], a[12:15], 0
ds_read_b64_tr_b16 a[126:127], v13 offset:9984
v_mfma_f32_16x16x32_bf16 v[116:119], a[48:51], a[8:11], 0
v_mfma_f32_16x16x32_bf16 v[84:87], a[48:51], a[4:7], 0
ds_read_b64_tr_b16 a[128:129], v14 offset:2048
v_mfma_f32_16x16x32_bf16 v[52:55], a[48:51], a[0:3], 0
ds_read_b64_tr_b16 a[130:131], v14 offset:2304
v_mfma_f32_16x16x32_bf16 v[152:155], a[52:55], a[0:3], 0
v_mfma_f32_16x16x32_bf16 v[160:163], a[52:55], a[4:7], 0
ds_read_b64_tr_b16 a[132:133], v15 offset:2048
v_mfma_f32_16x16x32_bf16 v[168:171], a[52:55], a[8:11], 0
ds_read_b64_tr_b16 a[134:135], v15 offset:2304
v_mfma_f32_16x16x32_bf16 v[176:179], a[52:55], a[12:15], 0
v_mfma_f32_16x16x32_bf16 v[180:183], a[56:59], a[12:15], 0
ds_read_b64_tr_b16 a[136:137], v14 offset:6144
v_mfma_f32_16x16x32_bf16 v[172:175], a[56:59], a[8:11], 0
ds_read_b64_tr_b16 a[138:139], v14 offset:6400
v_mfma_f32_16x16x32_bf16 v[164:167], a[56:59], a[4:7], 0
v_mfma_f32_16x16x32_bf16 v[156:159], a[56:59], a[0:3], 0
ds_read_b64_tr_b16 a[140:141], v15 offset:6144
v_mfma_f32_16x16x32_bf16 v[184:187], a[60:63], a[0:3], 0
ds_read_b64_tr_b16 a[142:143], v15 offset:6400
v_mfma_f32_16x16x32_bf16 v[192:195], a[60:63], a[4:7], 0
v_mfma_f32_16x16x32_bf16 v[200:203], a[60:63], a[8:11], 0
ds_read_b64_tr_b16 a[144:145], v14 offset:10240
v_mfma_f32_16x16x32_bf16 v[208:211], a[60:63], a[12:15], 0
ds_read_b64_tr_b16 a[146:147], v14 offset:10496
v_mfma_f32_16x16x32_bf16 v[212:215], a[64:67], a[12:15], 0
v_mfma_f32_16x16x32_bf16 v[204:207], a[64:67], a[8:11], 0
ds_read_b64_tr_b16 a[148:149], v15 offset:10240
v_mfma_f32_16x16x32_bf16 v[196:199], a[64:67], a[4:7], 0
ds_read_b64_tr_b16 a[150:151], v15 offset:10496
v_mfma_f32_16x16x32_bf16 v[188:191], a[64:67], a[0:3], 0
v_mfma_f32_16x16x32_bf16 v[216:219], a[0:3], a[68:71], 0
ds_read_b128 a[92:95], v11 offset:0
v_mfma_f32_16x16x32_bf16 v[224:227], a[4:7], a[68:71], 0
v_mfma_f32_16x16x32_bf16 v[232:235], a[8:11], a[68:71], 0
v_mfma_f32_16x16x32_bf16 v[240:243], a[12:15], a[68:71], 0
v_mfma_f32_16x16x32_bf16 v[248:251], a[16:19], a[68:71], 0
v_mfma_f32_16x16x32_bf16 v[252:255], a[16:19], a[72:75], 0
v_mfma_f32_16x16x32_bf16 v[244:247], a[12:15], a[72:75], 0
v_mfma_f32_16x16x32_bf16 v[236:239], a[8:11], a[72:75], 0
v_mfma_f32_16x16x32_bf16 v[228:231], a[4:7], a[72:75], 0
v_mfma_f32_16x16x32_bf16 v[220:223], a[0:3], a[72:75], 0
s_mov_b32 s15, 7
L_p2o_loop:
s_waitcnt vmcnt(0) lgkmcnt(0)
s_barrier
v_mfma_f32_16x16x32_bf16 v[24:27], a[96:99], a[76:79], v[24:27]
s_add_u32 m0, s17, 0x0
ds_read_b64_tr_b16 a[20:21], v12 offset:32768
v_mfma_f32_16x16x32_bf16 v[56:59], a[96:99], a[80:83], v[56:59]
buffer_load_dwordx4 v5, s[52:55], 0 offen lds
v_mfma_f32_16x16x32_bf16 v[88:91], a[96:99], a[84:87], v[88:91]
ds_read_b64_tr_b16 a[22:23], v12 offset:33792
v_mfma_f32_16x16x32_bf16 v[120:123], a[96:99], a[88:91], v[120:123]
s_add_u32 m0, s17, 0x400
ds_read_b128 a[0:3], v8 offset:32768
v_mfma_f32_16x16x32_bf16 v[124:127], a[100:103], a[88:91], v[124:127]
buffer_load_dwordx4 v5, s[52:55], s13 offen lds
v_mfma_f32_16x16x32_bf16 v[92:95], a[100:103], a[84:87], v[92:95]
ds_read_b128 a[4:7], v8 offset:34816
v_mfma_f32_16x16x32_bf16 v[60:63], a[100:103], a[80:83], v[60:63]
s_add_u32 m0, s17, 0x800
ds_read_b128 a[8:11], v8 offset:36864
v_mfma_f32_16x16x32_bf16 v[28:31], a[100:103], a[76:79], v[28:31]
buffer_load_dwordx4 v6, s[52:55], 0 offen lds
v_mfma_f32_16x16x32_bf16 v[32:35], a[104:107], a[76:79], v[32:35]
ds_read_b128 a[12:15], v8 offset:38912
v_mfma_f32_16x16x32_bf16 v[64:67], a[104:107], a[80:83], v[64:67]
s_add_u32 m0, s17, 0xc00
ds_read_b64_tr_b16 a[24:25], v13 offset:32768
v_mfma_f32_16x16x32_bf16 v[96:99], a[104:107], a[84:87], v[96:99]
buffer_load_dwordx4 v6, s[52:55], s13 offen lds
v_mfma_f32_16x16x32_bf16 v[128:131], a[104:107], a[88:91], v[128:131]
ds_read_b64_tr_b16 a[26:27], v13 offset:33792
v_mfma_f32_16x16x32_bf16 v[132:135], a[108:111], a[88:91], v[132:135]
s_add_u32 m0, s18, 0x4000
ds_read_b64_tr_b16 a[28:29], v12 offset:33024
v_mfma_f32_16x16x32_bf16 v[100:103], a[108:111], a[84:87], v[100:103]
buffer_load_dwordx4 v7, s[68:71], 0 offen lds
v_mfma_f32_16x16x32_bf16 v[68:71], a[108:111], a[80:83], v[68:71]
ds_read_b64_tr_b16 a[30:31], v12 offset:34048
v_mfma_f32_16x16x32_bf16 v[36:39], a[108:111], a[76:79], v[36:39]
s_add_u32 m0, s18, 0x5000
ds_read_b64_tr_b16 a[32:33], v13 offset:33024
v_mfma_f32_16x16x32_bf16 v[40:43], a[112:115], a[76:79], v[40:43]
buffer_load_dwordx4 v7, s[68:71], s25 offen lds
v_mfma_f32_16x16x32_bf16 v[72:75], a[112:115], a[80:83], v[72:75]
ds_read_b64_tr_b16 a[34:35], v13 offset:34048
v_mfma_f32_16x16x32_bf16 v[104:107], a[112:115], a[84:87], v[104:107]
s_add_u32 m0, s18, 0x6000
ds_read_b64_tr_b16 a[36:37], v12 offset:33280
v_mfma_f32_16x16x32_bf16 v[136:139], a[112:115], a[88:91], v[136:139]
buffer_load_dwordx4 v7, s[68:71], s26 offen lds
v_mfma_f32_16x16x32_bf16 v[140:143], a[116:119], a[88:91], v[140:143]
ds_read_b64_tr_b16 a[38:39], v12 offset:34304
v_mfma_f32_16x16x32_bf16 v[108:111], a[116:119], a[84:87], v[108:111]
s_add_u32 m0, s16, 0x0
ds_read_b64_tr_b16 a[40:41], v13 offset:33280
v_mfma_f32_16x16x32_bf16 v[76:79], a[116:119], a[80:83], v[76:79]
buffer_load_dwordx4 v2, s[44:47], s20 offen lds
v_mfma_f32_16x16x32_bf16 v[44:47], a[116:119], a[76:79], v[44:47]
ds_read_b64_tr_b16 a[42:43], v13 offset:34304
v_mfma_f32_16x16x32_bf16 v[48:51], a[120:123], a[76:79], v[48:51]
s_add_u32 m0, s16, 0x400
ds_read_b64_tr_b16 a[44:45], v12 offset:33536
v_mfma_f32_16x16x32_bf16 v[80:83], a[120:123], a[80:83], v[80:83]
buffer_load_dwordx4 v3, s[44:47], s20 offen lds
v_mfma_f32_16x16x32_bf16 v[112:115], a[120:123], a[84:87], v[112:115]
ds_read_b64_tr_b16 a[46:47], v12 offset:34560
v_mfma_f32_16x16x32_bf16 v[144:147], a[120:123], a[88:91], v[144:147]
s_add_u32 m0, s16, 0x800
ds_read_b64_tr_b16 a[48:49], v13 offset:33536
v_mfma_f32_16x16x32_bf16 v[148:151], a[124:127], a[88:91], v[148:151]
buffer_load_dwordx4 v2, s[44:47], s21 offen lds
v_mfma_f32_16x16x32_bf16 v[116:119], a[124:127], a[84:87], v[116:119]
ds_read_b64_tr_b16 a[50:51], v13 offset:34560
v_mfma_f32_16x16x32_bf16 v[84:87], a[124:127], a[80:83], v[84:87]
s_add_u32 m0, s16, 0xc00
ds_read_b64_tr_b16 a[52:53], v14 offset:32768
v_mfma_f32_16x16x32_bf16 v[52:55], a[124:127], a[76:79], v[52:55]
buffer_load_dwordx4 v3, s[44:47], s21 offen lds
v_mfma_f32_16x16x32_bf16 v[152:155], a[128:131], a[76:79], v[152:155]
ds_read_b64_tr_b16 a[54:55], v14 offset:33024
v_mfma_f32_16x16x32_bf16 v[160:163], a[128:131], a[80:83], v[160:163]
s_add_u32 m0, s16, 0x1000
ds_read_b64_tr_b16 a[56:57], v15 offset:32768
v_mfma_f32_16x16x32_bf16 v[168:171], a[128:131], a[84:87], v[168:171]
buffer_load_dwordx4 v2, s[44:47], s22 offen lds
v_mfma_f32_16x16x32_bf16 v[176:179], a[128:131], a[88:91], v[176:179]
ds_read_b64_tr_b16 a[58:59], v15 offset:33024
v_mfma_f32_16x16x32_bf16 v[180:183], a[132:135], a[88:91], v[180:183]
s_add_u32 m0, s16, 0x1400
ds_read_b64_tr_b16 a[60:61], v14 offset:36864
v_mfma_f32_16x16x32_bf16 v[172:175], a[132:135], a[84:87], v[172:175]
buffer_load_dwordx4 v3, s[44:47], s22 offen lds
v_mfma_f32_16x16x32_bf16 v[164:167], a[132:135], a[80:83], v[164:167]
ds_read_b64_tr_b16 a[62:63], v14 offset:37120
v_mfma_f32_16x16x32_bf16 v[156:159], a[132:135], a[76:79], v[156:159]
s_add_u32 m0, s16, 0x1800
ds_read_b64_tr_b16 a[64:65], v15 offset:36864
v_mfma_f32_16x16x32_bf16 v[184:187], a[136:139], a[76:79], v[184:187]
buffer_load_dwordx4 v2, s[44:47], s23 offen lds
v_mfma_f32_16x16x32_bf16 v[192:195], a[136:139], a[80:83], v[192:195]
ds_read_b64_tr_b16 a[66:67], v15 offset:37120
v_mfma_f32_16x16x32_bf16 v[200:203], a[136:139], a[84:87], v[200:203]
s_add_u32 m0, s16, 0x1c00
ds_read_b64_tr_b16 a[68:69], v14 offset:40960
v_mfma_f32_16x16x32_bf16 v[208:211], a[136:139], a[88:91], v[208:211]
buffer_load_dwordx4 v3, s[44:47], s23 offen lds
v_mfma_f32_16x16x32_bf16 v[212:215], a[140:143], a[88:91], v[212:215]
ds_read_b64_tr_b16 a[70:71], v14 offset:41216
v_mfma_f32_16x16x32_bf16 v[204:207], a[140:143], a[84:87], v[204:207]
s_add_u32 m0, s18, 0x7000
ds_read_b64_tr_b16 a[72:73], v15 offset:40960
v_mfma_f32_16x16x32_bf16 v[196:199], a[140:143], a[80:83], v[196:199]
buffer_load_dwordx4 v4, s[44:47], s24 offen lds
v_mfma_f32_16x16x32_bf16 v[188:191], a[140:143], a[76:79], v[188:191]
ds_read_b64_tr_b16 a[74:75], v15 offset:41216
v_mfma_f32_16x16x32_bf16 v[216:219], a[76:79], a[144:147], v[216:219]
ds_read_b128 a[16:19], v10 offset:32768
v_mfma_f32_16x16x32_bf16 v[224:227], a[80:83], a[144:147], v[224:227]
v_mfma_f32_16x16x32_bf16 v[232:235], a[84:87], a[144:147], v[232:235]
v_mfma_f32_16x16x32_bf16 v[240:243], a[88:91], a[144:147], v[240:243]
v_mfma_f32_16x16x32_bf16 v[248:251], a[92:95], a[144:147], v[248:251]
v_mfma_f32_16x16x32_bf16 v[252:255], a[92:95], a[148:151], v[252:255]
v_mfma_f32_16x16x32_bf16 v[244:247], a[88:91], a[148:151], v[244:247]
v_mfma_f32_16x16x32_bf16 v[236:239], a[84:87], a[148:151], v[236:239]
v_mfma_f32_16x16x32_bf16 v[228:231], a[80:83], a[148:151], v[228:231]
v_add_u32 v2, 0x80, v2
v_add_u32 v3, 0x80, v3
v_add_u32 v4, 0x80, v4
v_mfma_f32_16x16x32_bf16 v[220:223], a[76:79], a[148:151], v[220:223]
v_add_u32 v5, 0x80000, v5
v_add_u32 v6, 0x80000, v6
v_add_u32 v7, 0x60000, v7
s_waitcnt lgkmcnt(0)
v_mfma_f32_16x16x32_bf16 v[24:27], a[20:23], a[0:3], v[24:27]
ds_read_b64_tr_b16 a[96:97], v12 offset:40960
v_mfma_f32_16x16x32_bf16 v[56:59], a[20:23], a[4:7], v[56:59]
ds_read_b64_tr_b16 a[98:99], v12 offset:41984
v_mfma_f32_16x16x32_bf16 v[88:91], a[20:23], a[8:11], v[88:91]
v_mfma_f32_16x16x32_bf16 v[120:123], a[20:23], a[12:15], v[120:123]
ds_read_b128 a[76:79], v9 offset:32768
v_mfma_f32_16x16x32_bf16 v[124:127], a[24:27], a[12:15], v[124:127]
ds_read_b128 a[80:83], v9 offset:34816
v_mfma_f32_16x16x32_bf16 v[92:95], a[24:27], a[8:11], v[92:95]
v_mfma_f32_16x16x32_bf16 v[60:63], a[24:27], a[4:7], v[60:63]
ds_read_b128 a[84:87], v9 offset:36864
v_mfma_f32_16x16x32_bf16 v[28:31], a[24:27], a[0:3], v[28:31]
ds_read_b128 a[88:91], v9 offset:38912
v_mfma_f32_16x16x32_bf16 v[32:35], a[28:31], a[0:3], v[32:35]
v_mfma_f32_16x16x32_bf16 v[64:67], a[28:31], a[4:7], v[64:67]
ds_read_b64_tr_b16 a[100:101], v13 offset:40960
v_mfma_f32_16x16x32_bf16 v[96:99], a[28:31], a[8:11], v[96:99]
ds_read_b64_tr_b16 a[102:103], v13 offset:41984
v_mfma_f32_16x16x32_bf16 v[128:131], a[28:31], a[12:15], v[128:131]
v_mfma_f32_16x16x32_bf16 v[132:135], a[32:35], a[12:15], v[132:135]
ds_read_b64_tr_b16 a[104:105], v12 offset:41216
v_mfma_f32_16x16x32_bf16 v[100:103], a[32:35], a[8:11], v[100:103]
ds_read_b64_tr_b16 a[106:107], v12 offset:42240
v_mfma_f32_16x16x32_bf16 v[68:71], a[32:35], a[4:7], v[68:71]
v_mfma_f32_16x16x32_bf16 v[36:39], a[32:35], a[0:3], v[36:39]
ds_read_b64_tr_b16 a[108:109], v13 offset:41216
v_mfma_f32_16x16x32_bf16 v[40:43], a[36:39], a[0:3], v[40:43]
ds_read_b64_tr_b16 a[110:111], v13 offset:42240
v_mfma_f32_16x16x32_bf16 v[72:75], a[36:39], a[4:7], v[72:75]
v_mfma_f32_16x16x32_bf16 v[104:107], a[36:39], a[8:11], v[104:107]
ds_read_b64_tr_b16 a[112:113], v12 offset:41472
v_mfma_f32_16x16x32_bf16 v[136:139], a[36:39], a[12:15], v[136:139]
ds_read_b64_tr_b16 a[114:115], v12 offset:42496
v_mfma_f32_16x16x32_bf16 v[140:143], a[40:43], a[12:15], v[140:143]
v_mfma_f32_16x16x32_bf16 v[108:111], a[40:43], a[8:11], v[108:111]
ds_read_b64_tr_b16 a[116:117], v13 offset:41472
v_mfma_f32_16x16x32_bf16 v[76:79], a[40:43], a[4:7], v[76:79]
ds_read_b64_tr_b16 a[118:119], v13 offset:42496
v_mfma_f32_16x16x32_bf16 v[44:47], a[40:43], a[0:3], v[44:47]
v_mfma_f32_16x16x32_bf16 v[48:51], a[44:47], a[0:3], v[48:51]
ds_read_b64_tr_b16 a[120:121], v12 offset:41728
v_mfma_f32_16x16x32_bf16 v[80:83], a[44:47], a[4:7], v[80:83]
ds_read_b64_tr_b16 a[122:123], v12 offset:42752
v_mfma_f32_16x16x32_bf16 v[112:115], a[44:47], a[8:11], v[112:115]
v_mfma_f32_16x16x32_bf16 v[144:147], a[44:47], a[12:15], v[144:147]
ds_read_b64_tr_b16 a[124:125], v13 offset:41728
v_mfma_f32_16x16x32_bf16 v[148:151], a[48:51], a[12:15], v[148:151]
ds_read_b64_tr_b16 a[126:127], v13 offset:42752
v_mfma_f32_16x16x32_bf16 v[116:119], a[48:51], a[8:11], v[116:119]
v_mfma_f32_16x16x32_bf16 v[84:87], a[48:51], a[4:7], v[84:87]
ds_read_b64_tr_b16 a[128:129], v14 offset:34816
v_mfma_f32_16x16x32_bf16 v[52:55], a[48:51], a[0:3], v[52:55]
ds_read_b64_tr_b16 a[130:131], v14 offset:35072
v_mfma_f32_16x16x32_bf16 v[152:155], a[52:55], a[0:3], v[152:155]
v_mfma_f32_16x16x32_bf16 v[160:163], a[52:55], a[4:7], v[160:163]
ds_read_b64_tr_b16 a[132:133], v15 offset:34816
v_mfma_f32_16x16x32_bf16 v[168:171], a[52:55], a[8:11], v[168:171]
ds_read_b64_tr_b16 a[134:135], v15 offset:35072
v_mfma_f32_16x16x32_bf16 v[176:179], a[52:55], a[12:15], v[176:179]
v_mfma_f32_16x16x32_bf16 v[180:183], a[56:59], a[12:15], v[180:183]
ds_read_b64_tr_b16 a[136:137], v14 offset:38912
v_mfma_f32_16x16x32_bf16 v[172:175], a[56:59], a[8:11], v[172:175]
ds_read_b64_tr_b16 a[138:139], v14 offset:39168
v_mfma_f32_16x16x32_bf16 v[164:167], a[56:59], a[4:7], v[164:167]
v_mfma_f32_16x16x32_bf16 v[156:159], a[56:59], a[0:3], v[156:159]
ds_read_b64_tr_b16 a[140:141], v15 offset:38912
v_mfma_f32_16x16x32_bf16 v[184:187], a[60:63], a[0:3], v[184:187]
ds_read_b64_tr_b16 a[142:143], v15 offset:39168
v_mfma_f32_16x16x32_bf16 v[192:195], a[60:63], a[4:7], v[192:195]
v_mfma_f32_16x16x32_bf16 v[200:203], a[60:63], a[8:11], v[200:203]
ds_read_b64_tr_b16 a[144:145], v14 offset:43008
v_mfma_f32_16x16x32_bf16 v[208:211], a[60:63], a[12:15], v[208:211]
ds_read_b64_tr_b16 a[146:147], v14 offset:43264
v_mfma_f32_16x16x32_bf16 v[212:215], a[64:67], a[12:15], v[212:215]
v_mfma_f32_16x16x32_bf16 v[204:207], a[64:67], a[8:11], v[204:207]
ds_read_b64_tr_b16 a[148:149], v15 offset:43008
v_mfma_f32_16x16x32_bf16 v[196:199], a[64:67], a[4:7], v[196:199]
ds_read_b64_tr_b16 a[150:151], v15 offset:43264
v_mfma_f32_16x16x32_bf16 v[188:191], a[64:67], a[0:3], v[188:191]
v_mfma_f32_16x16x32_bf16 v[216:219], a[0:3], a[68:71], v[216:219]
ds_read_b128 a[92:95], v11 offset:32768
v_mfma_f32_16x16x32_bf16 v[224:227], a[4:7], a[68:71], v[224:227]
v_mfma_f32_16x16x32_bf16 v[232:235], a[8:11], a[68:71], v[232:235]
v_mfma_f32_16x16x32_bf16 v[240:243], a[12:15], a[68:71], v[240:243]
v_mfma_f32_16x16x32_bf16 v[248:251], a[16:19], a[68:71], v[248:251]
v_mfma_f32_16x16x32_bf16 v[252:255], a[16:19], a[72:75], v[252:255]
v_mfma_f32_16x16x32_bf16 v[244:247], a[12:15], a[72:75], v[244:247]
v_mfma_f32_16x16x32_bf16 v[236:239], a[8:11], a[72:75], v[236:239]
v_mfma_f32_16x16x32_bf16 v[228:231], a[4:7], a[72:75], v[228:231]
v_mfma_f32_16x16x32_bf16 v[220:223], a[0:3], a[72:75], v[220:223]
s_waitcnt vmcnt(0) lgkmcnt(0)
s_barrier
v_mfma_f32_16x16x32_bf16 v[24:27], a[96:99], a[76:79], v[24:27]
s_add_u32 m0, s17, 0x8000
ds_read_b64_tr_b16 a[20:21], v12 offset:0
v_mfma_f32_16x16x32_bf16 v[56:59], a[96:99], a[80:83], v[56:59]
buffer_load_dwordx4 v5, s[52:55], 0 offen lds
v_mfma_f32_16x16x32_bf16 v[88:91], a[96:99], a[84:87], v[88:91]
ds_read_b64_tr_b16 a[22:23], v12 offset:1024
v_mfma_f32_16x16x32_bf16 v[120:123], a[96:99], a[88:91], v[120:123]
s_add_u32 m0, s17, 0x8400
ds_read_b128 a[0:3], v8 offset:0
v_mfma_f32_16x16x32_bf16 v[124:127], a[100:103], a[88:91], v[124:127]
buffer_load_dwordx4 v5, s[52:55], s13 offen lds
v_mfma_f32_16x16x32_bf16 v[92:95], a[100:103], a[84:87], v[92:95]
ds_read_b128 a[4:7], v8 offset:2048
v_mfma_f32_16x16x32_bf16 v[60:63], a[100:103], a[80:83], v[60:63]
s_add_u32 m0, s17, 0x8800
ds_read_b128 a[8:11], v8 offset:4096
v_mfma_f32_16x16x32_bf16 v[28:31], a[100:103], a[76:79], v[28:31]
buffer_load_dwordx4 v6, s[52:55], 0 offen lds
v_mfma_f32_16x16x32_bf16 v[32:35], a[104:107], a[76:79], v[32:35]
ds_read_b128 a[12:15], v8 offset:6144
v_mfma_f32_16x16x32_bf16 v[64:67], a[104:107], a[80:83], v[64:67]
s_add_u32 m0, s17, 0x8c00
ds_read_b64_tr_b16 a[24:25], v13 offset:0
v_mfma_f32_16x16x32_bf16 v[96:99], a[104:107], a[84:87], v[96:99]
buffer_load_dwordx4 v6, s[52:55], s13 offen lds
v_mfma_f32_16x16x32_bf16 v[128:131], a[104:107], a[88:91], v[128:131]
ds_read_b64_tr_b16 a[26:27], v13 offset:1024
v_mfma_f32_16x16x32_bf16 v[132:135], a[108:111], a[88:91], v[132:135]
s_add_u32 m0, s18, 0xc000
ds_read_b64_tr_b16 a[28:29], v12 offset:256
v_mfma_f32_16x16x32_bf16 v[100:103], a[108:111], a[84:87], v[100:103]
buffer_load_dwordx4 v7, s[68:71], 0 offen lds
v_mfma_f32_16x16x32_bf16 v[68:71], a[108:111], a[80:83], v[68:71]
ds_read_b64_tr_b16 a[30:31], v12 offset:1280
v_mfma_f32_16x16x32_bf16 v[36:39], a[108:111], a[76:79], v[36:39]
s_add_u32 m0, s18, 0xd000
ds_read_b64_tr_b16 a[32:33], v13 offset:256
v_mfma_f32_16x16x32_bf16 v[40:43], a[112:115], a[76:79], v[40:43]
buffer_load_dwordx4 v7, s[68:71], s25 offen lds
v_mfma_f32_16x16x32_bf16 v[72:75], a[112:115], a[80:83], v[72:75]
ds_read_b64_tr_b16 a[34:35], v13 offset:1280
v_mfma_f32_16x16x32_bf16 v[104:107], a[112:115], a[84:87], v[104:107]
s_add_u32 m0, s18, 0xe000
ds_read_b64_tr_b16 a[36:37], v12 offset:512
v_mfma_f32_16x16x32_bf16 v[136:139], a[112:115], a[88:91], v[136:139]
buffer_load_dwordx4 v7, s[68:71], s26 offen lds
v_mfma_f32_16x16x32_bf16 v[140:143], a[116:119], a[88:91], v[140:143]
ds_read_b64_tr_b16 a[38:39], v12 offset:1536
v_mfma_f32_16x16x32_bf16 v[108:111], a[116:119], a[84:87], v[108:111]
s_add_u32 m0, s16, 0x8000
ds_read_b64_tr_b16 a[40:41], v13 offset:512
v_mfma_f32_16x16x32_bf16 v[76:79], a[116:119], a[80:83], v[76:79]
buffer_load_dwordx4 v2, s[44:47], s20 offen lds
v_mfma_f32_16x16x32_bf16 v[44:47], a[116:119], a[76:79], v[44:47]
ds_read_b64_tr_b16 a[42:43], v13 offset:1536
v_mfma_f32_16x16x32_bf16 v[48:51], a[120:123], a[76:79], v[48:51]
s_add_u32 m0, s16, 0x8400
ds_read_b64_tr_b16 a[44:45], v12 offset:768
v_mfma_f32_16x16x32_bf16 v[80:83], a[120:123], a[80:83], v[80:83]
buffer_load_dwordx4 v3, s[44:47], s20 offen lds
v_mfma_f32_16x16x32_bf16 v[112:115], a[120:123], a[84:87], v[112:115]
ds_read_b64_tr_b16 a[46:47], v12 offset:1792
v_mfma_f32_16x16x32_bf16 v[144:147], a[120:123], a[88:91], v[144:147]
s_add_u32 m0, s16, 0x8800
ds_read_b64_tr_b16 a[48:49], v13 offset:768
v_mfma_f32_16x16x32_bf16 v[148:151], a[124:127], a[88:91], v[148:151]
buffer_load_dwordx4 v2, s[44:47], s21 offen lds
v_mfma_f32_16x16x32_bf16 v[116:119], a[124:127], a[84:87], v[116:119]
ds_read_b64_tr_b16 a[50:51], v13 offset:1792
v_mfma_f32_16x16x32_bf16 v[84:87], a[124:127], a[80:83], v[84:87]
s_add_u32 m0, s16, 0x8c00
ds_read_b64_tr_b16 a[52:53], v14 offset:0
v_mfma_f32_16x16x32_bf16 v[52:55], a[124:127], a[76:79], v[52:55]
buffer_load_dwordx4 v3, s[44:47], s21 offen lds
v_mfma_f32_16x16x32_bf16 v[152:155], a[128:131], a[76:79], v[152:155]
ds_read_b64_tr_b16 a[54:55], v14 offset:256
v_mfma_f32_16x16x32_bf16 v[160:163], a[128:131], a[80:83], v[160:163]
s_add_u32 m0, s16, 0x9000
ds_read_b64_tr_b16 a[56:57], v15 offset:0
v_mfma_f32_16x16x32_bf16 v[168:171], a[128:131], a[84:87], v[168:171]
buffer_load_dwordx4 v2, s[44:47], s22 offen lds
v_mfma_f32_16x16x32_bf16 v[176:179], a[128:131], a[88:91], v[176:179]
ds_read_b64_tr_b16 a[58:59], v15 offset:256
v_mfma_f32_16x16x32_bf16 v[180:183], a[132:135], a[88:91], v[180:183]
s_add_u32 m0, s16, 0x9400
ds_read_b64_tr_b16 a[60:61], v14 offset:4096
v_mfma_f32_16x16x32_bf16 v[172:175], a[132:135], a[84:87], v[172:175]
buffer_load_dwordx4 v3, s[44:47], s22 offen lds
v_mfma_f32_16x16x32_bf16 v[164:167], a[132:135], a[80:83], v[164:167]
ds_read_b64_tr_b16 a[62:63], v14 offset:4352
v_mfma_f32_16x16x32_bf16 v[156:159], a[132:135], a[76:79], v[156:159]
s_add_u32 m0, s16, 0x9800
ds_read_b64_tr_b16 a[64:65], v15 offset:4096
v_mfma_f32_16x16x32_bf16 v[184:187], a[136:139], a[76:79], v[184:187]
buffer_load_dwordx4 v2, s[44:47], s23 offen lds
v_mfma_f32_16x16x32_bf16 v[192:195], a[136:139], a[80:83], v[192:195]
ds_read_b64_tr_b16 a[66:67], v15 offset:4352
v_mfma_f32_16x16x32_bf16 v[200:203], a[136:139], a[84:87], v[200:203]
s_add_u32 m0, s16, 0x9c00
ds_read_b64_tr_b16 a[68:69], v14 offset:8192
v_mfma_f32_16x16x32_bf16 v[208:211], a[136:139], a[88:91], v[208:211]
buffer_load_dwordx4 v3, s[44:47], s23 offen lds
v_mfma_f32_16x16x32_bf16 v[212:215], a[140:143], a[88:91], v[212:215]
ds_read_b64_tr_b16 a[70:71], v14 offset:8448
v_mfma_f32_16x16x32_bf16 v[204:207], a[140:143], a[84:87], v[204:207]
s_add_u32 m0, s18, 0xf000
ds_read_b64_tr_b16 a[72:73], v15 offset:8192
v_mfma_f32_16x16x32_bf16 v[196:199], a[140:143], a[80:83], v[196:199]
buffer_load_dwordx4 v4, s[44:47], s24 offen lds
v_mfma_f32_16x16x32_bf16 v[188:191], a[140:143], a[76:79], v[188:191]
ds_read_b64_tr_b16 a[74:75], v15 offset:8448
v_mfma_f32_16x16x32_bf16 v[216:219], a[76:79], a[144:147], v[216:219]
ds_read_b128 a[16:19], v10 offset:0
v_mfma_f32_16x16x32_bf16 v[224:227], a[80:83], a[144:147], v[224:227]
v_mfma_f32_16x16x32_bf16 v[232:235], a[84:87], a[144:147], v[232:235]
v_mfma_f32_16x16x32_bf16 v[240:243], a[88:91], a[144:147], v[240:243]
v_mfma_f32_16x16x32_bf16 v[248:251], a[92:95], a[144:147], v[248:251]
v_mfma_f32_16x16x32_bf16 v[252:255], a[92:95], a[148:151], v[252:255]
v_mfma_f32_16x16x32_bf16 v[244:247], a[88:91], a[148:151], v[244:247]
v_mfma_f32_16x16x32_bf16 v[236:239], a[84:87], a[148:151], v[236:239]
v_mfma_f32_16x16x32_bf16 v[228:231], a[80:83], a[148:151], v[228:231]
v_add_u32 v2, 0x80, v2
v_add_u32 v3, 0x80, v3
v_add_u32 v4, 0x80, v4
v_mfma_f32_16x16x32_bf16 v[220:223], a[76:79], a[148:151], v[220:223]
v_add_u32 v5, 0x80000, v5
v_add_u32 v6, 0x80000, v6
v_add_u32 v7, 0x60000, v7
s_waitcnt lgkmcnt(0)
v_mfma_f32_16x16x32_bf16 v[24:27], a[20:23], a[0:3], v[24:27]
ds_read_b64_tr_b16 a[96:97], v12 offset:8192
v_mfma_f32_16x16x32_bf16 v[56:59], a[20:23], a[4:7], v[56:59]
ds_read_b64_tr_b16 a[98:99], v12 offset:9216
v_mfma_f32_16x16x32_bf16 v[88:91], a[20:23], a[8:11], v[88:91]
v_mfma_f32_16x16x32_bf16 v[120:123], a[20:23], a[12:15], v[120:123]
ds_read_b128 a[76:79], v9 offset:0
v_mfma_f32_16x16x32_bf16 v[124:127], a[24:27], a[12:15], v[124:127]
ds_read_b128 a[80:83], v9 offset:2048
v_mfma_f32_16x16x32_bf16 v[92:95], a[24:27], a[8:11], v[92:95]
v_mfma_f32_16x16x32_bf16 v[60:63], a[24:27], a[4:7], v[60:63]
ds_read_b128 a[84:87], v9 offset:4096
v_mfma_f32_16x16x32_bf16 v[28:31], a[24:27], a[0:3], v[28:31]
ds_read_b128 a[88:91], v9 offset:6144
v_mfma_f32_16x16x32_bf16 v[32:35], a[28:31], a[0:3], v[32:35]
v_mfma_f32_16x16x32_bf16 v[64:67], a[28:31], a[4:7], v[64:67]
ds_read_b64_tr_b16 a[100:101], v13 offset:8192
v_mfma_f32_16x16x32_bf16 v[96:99], a[28:31], a[8:11], v[96:99]
ds_read_b64_tr_b16 a[102:103], v13 offset:9216
v_mfma_f32_16x16x32_bf16 v[128:131], a[28:31], a[12:15], v[128:131]
v_mfma_f32_16x16x32_bf16 v[132:135], a[32:35], a[12:15], v[132:135]
ds_read_b64_tr_b16 a[104:105], v12 offset:8448
v_mfma_f32_16x16x32_bf16 v[100:103], a[32:35], a[8:11], v[100:103]
ds_read_b64_tr_b16 a[106:107], v12 offset:9472
v_mfma_f32_16x16x32_bf16 v[68:71], a[32:35], a[4:7], v[68:71]
v_mfma_f32_16x16x32_bf16 v[36:39], a[32:35], a[0:3], v[36:39]
ds_read_b64_tr_b16 a[108:109], v13 offset:8448
v_mfma_f32_16x16x32_bf16 v[40:43], a[36:39], a[0:3], v[40:43]
ds_read_b64_tr_b16 a[110:111], v13 offset:9472
v_mfma_f32_16x16x32_bf16 v[72:75], a[36:39], a[4:7], v[72:75]
v_mfma_f32_16x16x32_bf16 v[104:107], a[36:39], a[8:11], v[104:107]
ds_read_b64_tr_b16 a[112:113], v12 offset:8704
v_mfma_f32_16x16x32_bf16 v[136:139], a[36:39], a[12:15], v[136:139]
ds_read_b64_tr_b16 a[114:115], v12 offset:9728
v_mfma_f32_16x16x32_bf16 v[140:143], a[40:43], a[12:15], v[140:143]
v_mfma_f32_16x16x32_bf16 v[108:111], a[40:43], a[8:11], v[108:111]
ds_read_b64_tr_b16 a[116:117], v13 offset:8704
v_mfma_f32_16x16x32_bf16 v[76:79], a[40:43], a[4:7], v[76:79]
ds_read_b64_tr_b16 a[118:119], v13 offset:9728
v_mfma_f32_16x16x32_bf16 v[44:47], a[40:43], a[0:3], v[44:47]
v_mfma_f32_16x16x32_bf16 v[48:51], a[44:47], a[0:3], v[48:51]
ds_read_b64_tr_b16 a[120:121], v12 offset:8960
v_mfma_f32_16x16x32_bf16 v[80:83], a[44:47], a[4:7], v[80:83]
ds_read_b64_tr_b16 a[122:123], v12 offset:9984
v_mfma_f32_16x16x32_bf16 v[112:115], a[44:47], a[8:11], v[112:115]
v_mfma_f32_16x16x32_bf16 v[144:147], a[44:47], a[12:15], v[144:147]
ds_read_b64_tr_b16 a[124:125], v13 offset:8960
v_mfma_f32_16x16x32_bf16 v[148:151], a[48:51], a[12:15], v[148:151]
ds_read_b64_tr_b16 a[126:127], v13 offset:9984
v_mfma_f32_16x16x32_bf16 v[116:119], a[48:51], a[8:11], v[116:119]
v_mfma_f32_16x16x32_bf16 v[84:87], a[48:51], a[4:7], v[84:87]
ds_read_b64_tr_b16 a[128:129], v14 offset:2048
v_mfma_f32_16x16x32_bf16 v[52:55], a[48:51], a[0:3], v[52:55]
ds_read_b64_tr_b16 a[130:131], v14 offset:2304
v_mfma_f32_16x16x32_bf16 v[152:155], a[52:55], a[0:3], v[152:155]
v_mfma_f32_16x16x32_bf16 v[160:163], a[52:55], a[4:7], v[160:163]
ds_read_b64_tr_b16 a[132:133], v15 offset:2048
v_mfma_f32_16x16x32_bf16 v[168:171], a[52:55], a[8:11], v[168:171]
ds_read_b64_tr_b16 a[134:135], v15 offset:2304
v_mfma_f32_16x16x32_bf16 v[176:179], a[52:55], a[12:15], v[176:179]
v_mfma_f32_16x16x32_bf16 v[180:183], a[56:59], a[12:15], v[180:183]
ds_read_b64_tr_b16 a[136:137], v14 offset:6144
v_mfma_f32_16x16x32_bf16 v[172:175], a[56:59], a[8:11], v[172:175]
ds_read_b64_tr_b16 a[138:139], v14 offset:6400
v_mfma_f32_16x16x32_bf16 v[164:167], a[56:59], a[4:7], v[164:167]
v_mfma_f32_16x16x32_bf16 v[156:159], a[56:59], a[0:3], v[156:159]
ds_read_b64_tr_b16 a[140:141], v15 offset:6144
v_mfma_f32_16x16x32_bf16 v[184:187], a[60:63], a[0:3], v[184:187]
ds_read_b64_tr_b16 a[142:143], v15 offset:6400
v_mfma_f32_16x16x32_bf16 v[192:195], a[60:63], a[4:7], v[192:195]
v_mfma_f32_16x16x32_bf16 v[200:203], a[60:63], a[8:11], v[200:203]
ds_read_b64_tr_b16 a[144:145], v14 offset:10240
v_mfma_f32_16x16x32_bf16 v[208:211], a[60:63], a[12:15], v[208:211]
ds_read_b64_tr_b16 a[146:147], v14 offset:10496
v_mfma_f32_16x16x32_bf16 v[212:215], a[64:67], a[12:15], v[212:215]
v_mfma_f32_16x16x32_bf16 v[204:207], a[64:67], a[8:11], v[204:207]
ds_read_b64_tr_b16 a[148:149], v15 offset:10240
v_mfma_f32_16x16x32_bf16 v[196:199], a[64:67], a[4:7], v[196:199]
ds_read_b64_tr_b16 a[150:151], v15 offset:10496
v_mfma_f32_16x16x32_bf16 v[188:191], a[64:67], a[0:3], v[188:191]
v_mfma_f32_16x16x32_bf16 v[216:219], a[0:3], a[68:71], v[216:219]
ds_read_b128 a[92:95], v11 offset:0
v_mfma_f32_16x16x32_bf16 v[224:227], a[4:7], a[68:71], v[224:227]
v_mfma_f32_16x16x32_bf16 v[232:235], a[8:11], a[68:71], v[232:235]
v_mfma_f32_16x16x32_bf16 v[240:243], a[12:15], a[68:71], v[240:243]
v_mfma_f32_16x16x32_bf16 v[248:251], a[16:19], a[68:71], v[248:251]
v_mfma_f32_16x16x32_bf16 v[252:255], a[16:19], a[72:75], v[252:255]
v_mfma_f32_16x16x32_bf16 v[244:247], a[12:15], a[72:75], v[244:247]
v_mfma_f32_16x16x32_bf16 v[236:239], a[8:11], a[72:75], v[236:239]
v_mfma_f32_16x16x32_bf16 v[228:231], a[4:7], a[72:75], v[228:231]
v_mfma_f32_16x16x32_bf16 v[220:223], a[0:3], a[72:75], v[220:223]
s_sub_u32 s15, s15, 1
s_cmp_lg_u32 s15, 0
s_cbranch_scc1 L_p2o_loop
s_waitcnt vmcnt(0) lgkmcnt(0)
s_barrier
v_mfma_f32_16x16x32_bf16 v[24:27], a[96:99], a[76:79], v[24:27]
ds_read_b64_tr_b16 a[20:21], v12 offset:32768
v_mfma_f32_16x16x32_bf16 v[56:59], a[96:99], a[80:83], v[56:59]
ds_read_b64_tr_b16 a[22:23], v12 offset:33792
v_mfma_f32_16x16x32_bf16 v[88:91], a[96:99], a[84:87], v[88:91]
v_mfma_f32_16x16x32_bf16 v[120:123], a[96:99], a[88:91], v[120:123]
ds_read_b128 a[0:3], v8 offset:32768
v_mfma_f32_16x16x32_bf16 v[124:127], a[100:103], a[88:91], v[124:127]
ds_read_b128 a[4:7], v8 offset:34816
v_mfma_f32_16x16x32_bf16 v[92:95], a[100:103], a[84:87], v[92:95]
v_mfma_f32_16x16x32_bf16 v[60:63], a[100:103], a[80:83], v[60:63]
ds_read_b128 a[8:11], v8 offset:36864
v_mfma_f32_16x16x32_bf16 v[28:31], a[100:103], a[76:79], v[28:31]
ds_read_b128 a[12:15], v8 offset:38912
v_mfma_f32_16x16x32_bf16 v[32:35], a[104:107], a[76:79], v[32:35]
v_mfma_f32_16x16x32_bf16 v[64:67], a[104:107], a[80:83], v[64:67]
ds_read_b64_tr_b16 a[24:25], v13 offset:32768
v_mfma_f32_16x16x32_bf16 v[96:99], a[104:107], a[84:87], v[96:99]
ds_read_b64_tr_b16 a[26:27], v13 offset:33792
v_mfma_f32_16x16x32_bf16 v[128:131], a[104:107], a[88:91], v[128:131]
v_mfma_f32_16x16x32_bf16 v[132:135], a[108:111], a[88:91], v[132:135]
ds_read_b64_tr_b16 a[28:29], v12 offset:33024
v_mfma_f32_16x16x32_bf16 v[100:103], a[108:111], a[84:87], v[100:103]
ds_read_b64_tr_b16 a[30:31], v12 offset:34048
v_mfma_f32_16x16x32_bf16 v[68:71], a[108:111], a[80:83], v[68:71]
v_mfma_f32_16x16x32_bf16 v[36:39], a[108:111], a[76:79], v[36:39]
ds_read_b64_tr_b16 a[32:33], v13 offset:33024
v_mfma_f32_16x16x32_bf16 v[40:43], a[112:115], a[76:79], v[40:43]
ds_read_b64_tr_b16 a[34:35], v13 offset:34048
v_mfma_f32_16x16x32_bf16 v[72:75], a[112:115], a[80:83], v[72:75]
v_mfma_f32_16x16x32_bf16 v[104:107], a[112:115], a[84:87], v[104:107]
ds_read_b64_tr_b16 a[36:37], v12 offset:33280
v_mfma_f32_16x16x32_bf16 v[136:139], a[112:115], a[88:91], v[136:139]
ds_read_b64_tr_b16 a[38:39], v12 offset:34304
v_mfma_f32_16x16x32_bf16 v[140:143], a[116:119], a[88:91], v[140:143]
v_mfma_f32_16x16x32_bf16 v[108:111], a[116:119], a[84:87], v[108:111]
ds_read_b64_tr_b16 a[40:41], v13 offset:33280
v_mfma_f32_16x16x32_bf16 v[76:79], a[116:119], a[80:83], v[76:79]
ds_read_b64_tr_b16 a[42:43], v13 offset:34304
v_mfma_f32_16x16x32_bf16 v[44:47], a[116:119], a[76:79], v[44:47]
v_mfma_f32_16x16x32_bf16 v[48:51], a[120:123], a[76:79], v[48:51]
ds_read_b64_tr_b16 a[44:45], v12 offset:33536
v_mfma_f32_16x16x32_bf16 v[80:83], a[120:123], a[80:83], v[80:83]
ds_read_b64_tr_b16 a[46:47], v12 offset:34560
v_mfma_f32_16x16x32_bf16 v[112:115], a[120:123], a[84:87], v[112:115]
v_mfma_f32_16x16x32_bf16 v[144:147], a[120:123], a[88:91], v[144:147]
ds_read_b64_tr_b16 a[48:49], v13 offset:33536
v_mfma_f32_16x16x32_bf16 v[148:151], a[124:127], a[88:91], v[148:151]
ds_read_b64_tr_b16 a[50:51], v13 offset:34560
v_mfma_f32_16x16x32_bf16 v[116:119], a[124:127], a[84:87], v[116:119]
v_mfma_f32_16x16x32_bf16 v[84:87], a[124:127], a[80:83], v[84:87]
ds_read_b64_tr_b16 a[52:53], v14 offset:32768
v_mfma_f32_16x16x32_bf16 v[52:55], a[124:127], a[76:79], v[52:55]
ds_read_b64_tr_b16 a[54:55], v14 offset:33024
v_mfma_f32_16x16x32_bf16 v[152:155], a[128:131], a[76:79], v[152:155]
v_mfma_f32_16x16x32_bf16 v[160:163], a[128:131], a[80:83], v[160:163]
ds_read_b64_tr_b16 a[56:57], v15 offset:32768
v_mfma_f32_16x16x32_bf16 v[168:171], a[128:131], a[84:87], v[168:171]
ds_read_b64_tr_b16 a[58:59], v15 offset:33024
v_mfma_f32_16x16x32_bf16 v[176:179], a[128:131], a[88:91], v[176:179]
v_mfma_f32_16x16x32_bf16 v[180:183], a[132:135], a[88:91], v[180:183]
ds_read_b64_tr_b16 a[60:61], v14 offset:36864
v_mfma_f32_16x16x32_bf16 v[172:175], a[132:135], a[84:87], v[172:175]
ds_read_b64_tr_b16 a[62:63], v14 offset:37120
v_mfma_f32_16x16x32_bf16 v[164:167], a[132:135], a[80:83], v[164:167]
v_mfma_f32_16x16x32_bf16 v[156:159], a[132:135], a[76:79], v[156:159]
ds_read_b64_tr_b16 a[64:65], v15 offset:36864
v_mfma_f32_16x16x32_bf16 v[184:187], a[136:139], a[76:79], v[184:187]
ds_read_b64_tr_b16 a[66:67], v15 offset:37120
v_mfma_f32_16x16x32_bf16 v[192:195], a[136:139], a[80:83], v[192:195]
v_mfma_f32_16x16x32_bf16 v[200:203], a[136:139], a[84:87], v[200:203]
ds_read_b64_tr_b16 a[68:69], v14 offset:40960
v_mfma_f32_16x16x32_bf16 v[208:211], a[136:139], a[88:91], v[208:211]
ds_read_b64_tr_b16 a[70:71], v14 offset:41216
v_mfma_f32_16x16x32_bf16 v[212:215], a[140:143], a[88:91], v[212:215]
v_mfma_f32_16x16x32_bf16 v[204:207], a[140:143], a[84:87], v[204:207]
ds_read_b64_tr_b16 a[72:73], v15 offset:40960
v_mfma_f32_16x16x32_bf16 v[196:199], a[140:143], a[80:83], v[196:199]
ds_read_b64_tr_b16 a[74:75], v15 offset:41216
v_mfma_f32_16x16x32_bf16 v[188:191], a[140:143], a[76:79], v[188:191]
v_mfma_f32_16x16x32_bf16 v[216:219], a[76:79], a[144:147], v[216:219]
ds_read_b128 a[16:19], v10 offset:32768
v_mfma_f32_16x16x32_bf16 v[224:227], a[80:83], a[144:147], v[224:227]
v_mfma_f32_16x16x32_bf16 v[232:235], a[84:87], a[144:147], v[232:235]
v_mfma_f32_16x16x32_bf16 v[240:243], a[88:91], a[144:147], v[240:243]
v_mfma_f32_16x16x32_bf16 v[248:251], a[92:95], a[144:147], v[248:251]
v_mfma_f32_16x16x32_bf16 v[252:255], a[92:95], a[148:151], v[252:255]
v_mfma_f32_16x16x32_bf16 v[244:247], a[88:91], a[148:151], v[244:247]
v_mfma_f32_16x16x32_bf16 v[236:239], a[84:87], a[148:151], v[236:239]
v_mfma_f32_16x16x32_bf16 v[228:231], a[80:83], a[148:151], v[228:231]
v_mfma_f32_16x16x32_bf16 v[220:223], a[76:79], a[148:151], v[220:223]
s_waitcnt lgkmcnt(0)
v_mfma_f32_16x16x32_bf16 v[24:27], a[20:23], a[0:3], v[24:27]
ds_read_b64_tr_b16 a[96:97], v12 offset:40960
v_mfma_f32_16x16x32_bf16 v[56:59], a[20:23], a[4:7], v[56:59]
ds_read_b64_tr_b16 a[98:99], v12 offset:41984
v_mfma_f32_16x16x32_bf16 v[88:91], a[20:23], a[8:11], v[88:91]
v_mfma_f32_16x16x32_bf16 v[120:123], a[20:23], a[12:15], v[120:123]
ds_read_b128 a[76:79], v9 offset:32768
v_mfma_f32_16x16x32_bf16 v[124:127], a[24:27], a[12:15], v[124:127]
ds_read_b128 a[80:83], v9 offset:34816
v_mfma_f32_16x16x32_bf16 v[92:95], a[24:27], a[8:11], v[92:95]
v_mfma_f32_16x16x32_bf16 v[60:63], a[24:27], a[4:7], v[60:63]
ds_read_b128 a[84:87], v9 offset:36864
v_mfma_f32_16x16x32_bf16 v[28:31], a[24:27], a[0:3], v[28:31]
ds_read_b128 a[88:91], v9 offset:38912
v_mfma_f32_16x16x32_bf16 v[32:35], a[28:31], a[0:3], v[32:35]
v_mfma_f32_16x16x32_bf16 v[64:67], a[28:31], a[4:7], v[64:67]
ds_read_b64_tr_b16 a[100:101], v13 offset:40960
v_mfma_f32_16x16x32_bf16 v[96:99], a[28:31], a[8:11], v[96:99]
ds_read_b64_tr_b16 a[102:103], v13 offset:41984
v_mfma_f32_16x16x32_bf16 v[128:131], a[28:31], a[12:15], v[128:131]
v_mfma_f32_16x16x32_bf16 v[132:135], a[32:35], a[12:15], v[132:135]
ds_read_b64_tr_b16 a[104:105], v12 offset:41216
v_mfma_f32_16x16x32_bf16 v[100:103], a[32:35], a[8:11], v[100:103]
ds_read_b64_tr_b16 a[106:107], v12 offset:42240
v_mfma_f32_16x16x32_bf16 v[68:71], a[32:35], a[4:7], v[68:71]
v_mfma_f32_16x16x32_bf16 v[36:39], a[32:35], a[0:3], v[36:39]
ds_read_b64_tr_b16 a[108:109], v13 offset:41216
v_mfma_f32_16x16x32_bf16 v[40:43], a[36:39], a[0:3], v[40:43]
ds_read_b64_tr_b16 a[110:111], v13 offset:42240
v_mfma_f32_16x16x32_bf16 v[72:75], a[36:39], a[4:7], v[72:75]
v_mfma_f32_16x16x32_bf16 v[104:107], a[36:39], a[8:11], v[104:107]
ds_read_b64_tr_b16 a[112:113], v12 offset:41472
v_mfma_f32_16x16x32_bf16 v[136:139], a[36:39], a[12:15], v[136:139]
ds_read_b64_tr_b16 a[114:115], v12 offset:42496
v_mfma_f32_16x16x32_bf16 v[140:143], a[40:43], a[12:15], v[140:143]
v_mfma_f32_16x16x32_bf16 v[108:111], a[40:43], a[8:11], v[108:111]
ds_read_b64_tr_b16 a[116:117], v13 offset:41472
v_mfma_f32_16x16x32_bf16 v[76:79], a[40:43], a[4:7], v[76:79]
ds_read_b64_tr_b16 a[118:119], v13 offset:42496
v_mfma_f32_16x16x32_bf16 v[44:47], a[40:43], a[0:3], v[44:47]
v_mfma_f32_16x16x32_bf16 v[48:51], a[44:47], a[0:3], v[48:51]
ds_read_b64_tr_b16 a[120:121], v12 offset:41728
v_mfma_f32_16x16x32_bf16 v[80:83], a[44:47], a[4:7], v[80:83]
ds_read_b64_tr_b16 a[122:123], v12 offset:42752
v_mfma_f32_16x16x32_bf16 v[112:115], a[44:47], a[8:11], v[112:115]
v_mfma_f32_16x16x32_bf16 v[144:147], a[44:47], a[12:15], v[144:147]
ds_read_b64_tr_b16 a[124:125], v13 offset:41728
v_mfma_f32_16x16x32_bf16 v[148:151], a[48:51], a[12:15], v[148:151]
ds_read_b64_tr_b16 a[126:127], v13 offset:42752
v_mfma_f32_16x16x32_bf16 v[116:119], a[48:51], a[8:11], v[116:119]
v_mfma_f32_16x16x32_bf16 v[84:87], a[48:51], a[4:7], v[84:87]
ds_read_b64_tr_b16 a[128:129], v14 offset:34816
v_mfma_f32_16x16x32_bf16 v[52:55], a[48:51], a[0:3], v[52:55]
ds_read_b64_tr_b16 a[130:131], v14 offset:35072
v_mfma_f32_16x16x32_bf16 v[152:155], a[52:55], a[0:3], v[152:155]
v_mfma_f32_16x16x32_bf16 v[160:163], a[52:55], a[4:7], v[160:163]
ds_read_b64_tr_b16 a[132:133], v15 offset:34816
v_mfma_f32_16x16x32_bf16 v[168:171], a[52:55], a[8:11], v[168:171]
ds_read_b64_tr_b16 a[134:135], v15 offset:35072
v_mfma_f32_16x16x32_bf16 v[176:179], a[52:55], a[12:15], v[176:179]
v_mfma_f32_16x16x32_bf16 v[180:183], a[56:59], a[12:15], v[180:183]
ds_read_b64_tr_b16 a[136:137], v14 offset:38912
v_mfma_f32_16x16x32_bf16 v[172:175], a[56:59], a[8:11], v[172:175]
ds_read_b64_tr_b16 a[138:139], v14 offset:39168
v_mfma_f32_16x16x32_bf16 v[164:167], a[56:59], a[4:7], v[164:167]
v_mfma_f32_16x16x32_bf16 v[156:159], a[56:59], a[0:3], v[156:159]
ds_read_b64_tr_b16 a[140:141], v15 offset:38912
v_mfma_f32_16x16x32_bf16 v[184:187], a[60:63], a[0:3], v[184:187]
ds_read_b64_tr_b16 a[142:143], v15 offset:39168
v_mfma_f32_16x16x32_bf16 v[192:195], a[60:63], a[4:7], v[192:195]
v_mfma_f32_16x16x32_bf16 v[200:203], a[60:63], a[8:11], v[200:203]
ds_read_b64_tr_b16 a[144:145], v14 offset:43008
v_mfma_f32_16x16x32_bf16 v[208:211], a[60:63], a[12:15], v[208:211]
ds_read_b64_tr_b16 a[146:147], v14 offset:43264
v_mfma_f32_16x16x32_bf16 v[212:215], a[64:67], a[12:15], v[212:215]
v_mfma_f32_16x16x32_bf16 v[204:207], a[64:67], a[8:11], v[204:207]
ds_read_b64_tr_b16 a[148:149], v15 offset:43008
v_mfma_f32_16x16x32_bf16 v[196:199], a[64:67], a[4:7], v[196:199]
ds_read_b64_tr_b16 a[150:151], v15 offset:43264
v_mfma_f32_16x16x32_bf16 v[188:191], a[64:67], a[0:3], v[188:191]
v_mfma_f32_16x16x32_bf16 v[216:219], a[0:3], a[68:71], v[216:219]
ds_read_b128 a[92:95], v11 offset:32768
v_mfma_f32_16x16x32_bf16 v[224:227], a[4:7], a[68:71], v[224:227]
v_mfma_f32_16x16x32_bf16 v[232:235], a[8:11], a[68:71], v[232:235]
v_mfma_f32_16x16x32_bf16 v[240:243], a[12:15], a[68:71], v[240:243]
v_mfma_f32_16x16x32_bf16 v[248:251], a[16:19], a[68:71], v[248:251]
v_mfma_f32_16x16x32_bf16 v[252:255], a[16:19], a[72:75], v[252:255]
v_mfma_f32_16x16x32_bf16 v[244:247], a[12:15], a[72:75], v[244:247]
v_mfma_f32_16x16x32_bf16 v[236:239], a[8:11], a[72:75], v[236:239]
v_mfma_f32_16x16x32_bf16 v[228:231], a[4:7], a[72:75], v[228:231]
v_mfma_f32_16x16x32_bf16 v[220:223], a[0:3], a[72:75], v[220:223]
s_waitcnt vmcnt(0) lgkmcnt(0)
s_barrier
v_mfma_f32_16x16x32_bf16 v[24:27], a[96:99], a[76:79], v[24:27]
v_mfma_f32_16x16x32_bf16 v[56:59], a[96:99], a[80:83], v[56:59]
v_mfma_f32_16x16x32_bf16 v[88:91], a[96:99], a[84:87], v[88:91]
v_mfma_f32_16x16x32_bf16 v[120:123], a[96:99], a[88:91], v[120:123]
v_mfma_f32_16x16x32_bf16 v[124:127], a[100:103], a[88:91], v[124:127]
v_mfma_f32_16x16x32_bf16 v[92:95], a[100:103], a[84:87], v[92:95]
v_mfma_f32_16x16x32_bf16 v[60:63], a[100:103], a[80:83], v[60:63]
v_mfma_f32_16x16x32_bf16 v[28:31], a[100:103], a[76:79], v[28:31]
v_mfma_f32_16x16x32_bf16 v[32:35], a[104:107], a[76:79], v[32:35]
v_mfma_f32_16x16x32_bf16 v[64:67], a[104:107], a[80:83], v[64:67]
v_mfma_f32_16x16x32_bf16 v[96:99], a[104:107], a[84:87], v[96:99]
v_mfma_f32_16x16x32_bf16 v[128:131], a[104:107], a[88:91], v[128:131]
v_mfma_f32_16x16x32_bf16 v[132:135], a[108:111], a[88:91], v[132:135]
v_mfma_f32_16x16x32_bf16 v[100:103], a[108:111], a[84:87], v[100:103]
v_mfma_f32_16x16x32_bf16 v[68:71], a[108:111], a[80:83], v[68:71]
v_mfma_f32_16x16x32_bf16 v[36:39], a[108:111], a[76:79], v[36:39]
v_mfma_f32_16x16x32_bf16 v[40:43], a[112:115], a[76:79], v[40:43]
v_mfma_f32_16x16x32_bf16 v[72:75], a[112:115], a[80:83], v[72:75]
v_mfma_f32_16x16x32_bf16 v[104:107], a[112:115], a[84:87], v[104:107]
v_mfma_f32_16x16x32_bf16 v[136:139], a[112:115], a[88:91], v[136:139]
v_mfma_f32_16x16x32_bf16 v[140:143], a[116:119], a[88:91], v[140:143]
v_mfma_f32_16x16x32_bf16 v[108:111], a[116:119], a[84:87], v[108:111]
v_mfma_f32_16x16x32_bf16 v[76:79], a[116:119], a[80:83], v[76:79]
v_mfma_f32_16x16x32_bf16 v[44:47], a[116:119], a[76:79], v[44:47]
v_mfma_f32_16x16x32_bf16 v[48:51], a[120:123], a[76:79], v[48:51]
v_mfma_f32_16x16x32_bf16 v[80:83], a[120:123], a[80:83], v[80:83]
v_mfma_f32_16x16x32_bf16 v[112:115], a[120:123], a[84:87], v[112:115]
v_mfma_f32_16x16x32_bf16 v[144:147], a[120:123], a[88:91], v[144:147]
v_mfma_f32_16x16x32_bf16 v[148:151], a[124:127], a[88:91], v[148:151]
v_mfma_f32_16x16x32_bf16 v[116:119], a[124:127], a[84:87], v[116:119]
v_mfma_f32_16x16x32_bf16 v[84:87], a[124:127], a[80:83], v[84:87]
v_mfma_f32_16x16x32_bf16 v[52:55], a[124:127], a[76:79], v[52:55]
v_mfma_f32_16x16x32_bf16 v[152:155], a[128:131], a[76:79], v[152:155]
v_mfma_f32_16x16x32_bf16 v[160:163], a[128:131], a[80:83], v[160:163]
v_mfma_f32_16x16x32_bf16 v[168:171], a[128:131], a[84:87], v[168:171]
v_mfma_f32_16x16x32_bf16 v[176:179], a[128:131], a[88:91], v[176:179]
v_mfma_f32_16x16x32_bf16 v[180:183], a[132:135], a[88:91], v[180:183]
v_mfma_f32_16x16x32_bf16 v[172:175], a[132:135], a[84:87], v[172:175]
v_mfma_f32_16x16x32_bf16 v[164:167], a[132:135], a[80:83], v[164:167]
v_mfma_f32_16x16x32_bf16 v[156:159], a[132:135], a[76:79], v[156:159]
v_mfma_f32_16x16x32_bf16 v[184:187], a[136:139], a[76:79], v[184:187]
v_mfma_f32_16x16x32_bf16 v[192:195], a[136:139], a[80:83], v[192:195]
v_mfma_f32_16x16x32_bf16 v[200:203], a[136:139], a[84:87], v[200:203]
v_mfma_f32_16x16x32_bf16 v[208:211], a[136:139], a[88:91], v[208:211]
v_mfma_f32_16x16x32_bf16 v[212:215], a[140:143], a[88:91], v[212:215]
v_mfma_f32_16x16x32_bf16 v[204:207], a[140:143], a[84:87], v[204:207]
v_mfma_f32_16x16x32_bf16 v[196:199], a[140:143], a[80:83], v[196:199]
v_mfma_f32_16x16x32_bf16 v[188:191], a[140:143], a[76:79], v[188:191]
v_mfma_f32_16x16x32_bf16 v[216:219], a[76:79], a[144:147], v[216:219]
v_mfma_f32_16x16x32_bf16 v[224:227], a[80:83], a[144:147], v[224:227]
v_mfma_f32_16x16x32_bf16 v[232:235], a[84:87], a[144:147], v[232:235]
v_mfma_f32_16x16x32_bf16 v[240:243], a[88:91], a[144:147], v[240:243]
v_mfma_f32_16x16x32_bf16 v[248:251], a[92:95], a[144:147], v[248:251]
v_mfma_f32_16x16x32_bf16 v[252:255], a[92:95], a[148:151], v[252:255]
v_mfma_f32_16x16x32_bf16 v[244:247], a[88:91], a[148:151], v[244:247]
v_mfma_f32_16x16x32_bf16 v[236:239], a[84:87], a[148:151], v[236:239]
v_mfma_f32_16x16x32_bf16 v[228:231], a[80:83], a[148:151], v[228:231]
v_mfma_f32_16x16x32_bf16 v[220:223], a[76:79], a[148:151], v[220:223]
L_p2_join:
s_nop 7
s_lshl_b32 s8, s4, 11
s_add_u32 s9, s8, 131072
v_add_u32 v17, s9, v16
s_sub_u32 s9, 145408, s8
v_add_u32 v18, s9, v16
s_lshr_b32 s8, s4, 1
s_lshl_b32 s8, s8, 14
s_and_b32 s9, s4, 1
s_lshl_b32 s9, s9, 10
s_add_u32 s8, s8, s9
s_add_u32 s8, s8, 131072
v_add_u32 v19, s8, v16
v_cvt_pk_bf16_f32 v248, v248, v249
v_cvt_pk_bf16_f32 v249, v250, v251
v_cvt_pk_bf16_f32 v250, v252, v253
v_cvt_pk_bf16_f32 v251, v254, v255
ds_write_b128 v19, v[248:251]
v_cvt_pk_bf16_f32 v184, v184, v185
v_cvt_pk_bf16_f32 v185, v186, v187
v_cvt_pk_bf16_f32 v186, v188, v189
v_cvt_pk_bf16_f32 v187, v190, v191
v_cvt_pk_bf16_f32 v216, v216, v217
v_cvt_pk_bf16_f32 v217, v218, v219
v_cvt_pk_bf16_f32 v218, v220, v221
v_cvt_pk_bf16_f32 v219, v222, v223
v_cvt_pk_bf16_f32 v192, v192, v193
v_cvt_pk_bf16_f32 v193, v194, v195
v_cvt_pk_bf16_f32 v194, v196, v197
v_cvt_pk_bf16_f32 v195, v198, v199
v_cvt_pk_bf16_f32 v224, v224, v225
v_cvt_pk_bf16_f32 v225, v226, v227
v_cvt_pk_bf16_f32 v226, v228, v229
v_cvt_pk_bf16_f32 v227, v230, v231
v_cvt_pk_bf16_f32 v200, v200, v201
v_cvt_pk_bf16_f32 v201, v202, v203
v_cvt_pk_bf16_f32 v202, v204, v205
v_cvt_pk_bf16_f32 v203, v206, v207
v_cvt_pk_bf16_f32 v232, v232, v233
v_cvt_pk_bf16_f32 v233, v234, v235
v_cvt_pk_bf16_f32 v234, v236, v237
v_cvt_pk_bf16_f32 v235, v238, v239
v_cvt_pk_bf16_f32 v208, v208, v209
v_cvt_pk_bf16_f32 v209, v210, v211
v_cvt_pk_bf16_f32 v210, v212, v213
v_cvt_pk_bf16_f32 v211, v214, v215
v_cvt_pk_bf16_f32 v240, v240, v241
v_cvt_pk_bf16_f32 v241, v242, v243
v_cvt_pk_bf16_f32 v242, v244, v245
v_cvt_pk_bf16_f32 v243, v246, v247
ds_write_b128 v17, v[184:187] offset:2048
ds_write_b128 v17, v[216:219] offset:3072
ds_write_b128 v17, v[200:203] offset:18432
ds_write_b128 v17, v[232:235] offset:19456
s_cmp_eq_u32 s4, 0
s_cbranch_scc1 L_bx_skip
ds_write_b128 v18, v[192:195] offset:2048
ds_write_b128 v18, v[224:227] offset:3072
ds_write_b128 v18, v[208:211] offset:18432
ds_write_b128 v18, v[240:243] offset:19456
L_bx_skip:
v_cvt_pk_bf16_f32 v152, v152, v153
v_cvt_pk_bf16_f32 v153, v154, v155
v_cvt_pk_bf16_f32 v154, v156, v157
v_cvt_pk_bf16_f32 v155, v158, v159
v_cvt_pk_bf16_f32 v160, v160, v161
v_cvt_pk_bf16_f32 v161, v162, v163
v_cvt_pk_bf16_f32 v162, v164, v165
v_cvt_pk_bf16_f32 v163, v166, v167
v_cvt_pk_bf16_f32 v168, v168, v169
v_cvt_pk_bf16_f32 v169, v170, v171
v_cvt_pk_bf16_f32 v170, v172, v173
v_cvt_pk_bf16_f32 v171, v174, v175
v_cvt_pk_bf16_f32 v176, v176, v177
v_cvt_pk_bf16_f32 v177, v178, v179
v_cvt_pk_bf16_f32 v178, v180, v181
v_cvt_pk_bf16_f32 v179, v182, v183
s_mov_b32 s8, 0x3e0293ee
s_mov_b32 s9, 0x3e0293ee
v_pk_mul_f32 v[24:25], v[24:25], s[8:9]
v_pk_mul_f32 v[26:27], v[26:27], s[8:9]
v_pk_mul_f32 v[28:29], v[28:29], s[8:9]
v_pk_mul_f32 v[30:31], v[30:31], s[8:9]
v_cvt_pk_bf16_f32 v24, v24, v25
v_cvt_pk_bf16_f32 v25, v26, v27
v_cvt_pk_bf16_f32 v26, v28, v29
v_cvt_pk_bf16_f32 v27, v30, v31
v_accvgpr_write_b32 a160, v24
v_accvgpr_write_b32 a161, v25
v_accvgpr_write_b32 a162, v26
v_accvgpr_write_b32 a163, v27
v_pk_mul_f32 v[32:33], v[32:33], s[8:9]
v_pk_mul_f32 v[34:35], v[34:35], s[8:9]
v_pk_mul_f32 v[36:37], v[36:37], s[8:9]
v_pk_mul_f32 v[38:39], v[38:39], s[8:9]
v_cvt_pk_bf16_f32 v32, v32, v33
v_cvt_pk_bf16_f32 v33, v34, v35
v_cvt_pk_bf16_f32 v34, v36, v37
v_cvt_pk_bf16_f32 v35, v38, v39
v_accvgpr_write_b32 a164, v32
v_accvgpr_write_b32 a165, v33
v_accvgpr_write_b32 a166, v34
v_accvgpr_write_b32 a167, v35
v_pk_mul_f32 v[40:41], v[40:41], s[8:9]
v_pk_mul_f32 v[42:43], v[42:43], s[8:9]
v_pk_mul_f32 v[44:45], v[44:45], s[8:9]
v_pk_mul_f32 v[46:47], v[46:47], s[8:9]
v_cvt_pk_bf16_f32 v40, v40, v41
v_cvt_pk_bf16_f32 v41, v42, v43
v_cvt_pk_bf16_f32 v42, v44, v45
v_cvt_pk_bf16_f32 v43, v46, v47
v_accvgpr_write_b32 a168, v40
v_accvgpr_write_b32 a169, v41
v_accvgpr_write_b32 a170, v42
v_accvgpr_write_b32 a171, v43
v_pk_mul_f32 v[48:49], v[48:49], s[8:9]
v_pk_mul_f32 v[50:51], v[50:51], s[8:9]
v_pk_mul_f32 v[52:53], v[52:53], s[8:9]
v_pk_mul_f32 v[54:55], v[54:55], s[8:9]
v_cvt_pk_bf16_f32 v48, v48, v49
v_cvt_pk_bf16_f32 v49, v50, v51
v_cvt_pk_bf16_f32 v50, v52, v53
v_cvt_pk_bf16_f32 v51, v54, v55
v_accvgpr_write_b32 a172, v48
v_accvgpr_write_b32 a173, v49
v_accvgpr_write_b32 a174, v50
v_accvgpr_write_b32 a175, v51
v_pk_mul_f32 v[56:57], v[56:57], s[8:9]
v_pk_mul_f32 v[58:59], v[58:59], s[8:9]
v_pk_mul_f32 v[60:61], v[60:61], s[8:9]
v_pk_mul_f32 v[62:63], v[62:63], s[8:9]
v_cvt_pk_bf16_f32 v56, v56, v57
v_cvt_pk_bf16_f32 v57, v58, v59
v_cvt_pk_bf16_f32 v58, v60, v61
v_cvt_pk_bf16_f32 v59, v62, v63
v_accvgpr_write_b32 a176, v56
v_accvgpr_write_b32 a177, v57
v_accvgpr_write_b32 a178, v58
v_accvgpr_write_b32 a179, v59
v_pk_mul_f32 v[64:65], v[64:65], s[8:9]
v_pk_mul_f32 v[66:67], v[66:67], s[8:9]
v_pk_mul_f32 v[68:69], v[68:69], s[8:9]
v_pk_mul_f32 v[70:71], v[70:71], s[8:9]
v_cvt_pk_bf16_f32 v64, v64, v65
v_cvt_pk_bf16_f32 v65, v66, v67
v_cvt_pk_bf16_f32 v66, v68, v69
v_cvt_pk_bf16_f32 v67, v70, v71
v_accvgpr_write_b32 a180, v64
v_accvgpr_write_b32 a181, v65
v_accvgpr_write_b32 a182, v66
v_accvgpr_write_b32 a183, v67
v_pk_mul_f32 v[72:73], v[72:73], s[8:9]
v_pk_mul_f32 v[74:75], v[74:75], s[8:9]
v_pk_mul_f32 v[76:77], v[76:77], s[8:9]
v_pk_mul_f32 v[78:79], v[78:79], s[8:9]
v_cvt_pk_bf16_f32 v72, v72, v73
v_cvt_pk_bf16_f32 v73, v74, v75
v_cvt_pk_bf16_f32 v74, v76, v77
v_cvt_pk_bf16_f32 v75, v78, v79
v_accvgpr_write_b32 a184, v72
v_accvgpr_write_b32 a185, v73
v_accvgpr_write_b32 a186, v74
v_accvgpr_write_b32 a187, v75
v_pk_mul_f32 v[80:81], v[80:81], s[8:9]
v_pk_mul_f32 v[82:83], v[82:83], s[8:9]
v_pk_mul_f32 v[84:85], v[84:85], s[8:9]
v_pk_mul_f32 v[86:87], v[86:87], s[8:9]
v_cvt_pk_bf16_f32 v80, v80, v81
v_cvt_pk_bf16_f32 v81, v82, v83
v_cvt_pk_bf16_f32 v82, v84, v85
v_cvt_pk_bf16_f32 v83, v86, v87
v_accvgpr_write_b32 a188, v80
v_accvgpr_write_b32 a189, v81
v_accvgpr_write_b32 a190, v82
v_accvgpr_write_b32 a191, v83
v_pk_mul_f32 v[88:89], v[88:89], s[8:9]
v_pk_mul_f32 v[90:91], v[90:91], s[8:9]
v_pk_mul_f32 v[92:93], v[92:93], s[8:9]
v_pk_mul_f32 v[94:95], v[94:95], s[8:9]
v_cvt_pk_bf16_f32 v88, v88, v89
v_cvt_pk_bf16_f32 v89, v90, v91
v_cvt_pk_bf16_f32 v90, v92, v93
v_cvt_pk_bf16_f32 v91, v94, v95
v_accvgpr_write_b32 a192, v88
v_accvgpr_write_b32 a193, v89
v_accvgpr_write_b32 a194, v90
v_accvgpr_write_b32 a195, v91
v_pk_mul_f32 v[96:97], v[96:97], s[8:9]
v_pk_mul_f32 v[98:99], v[98:99], s[8:9]
v_pk_mul_f32 v[100:101], v[100:101], s[8:9]
v_pk_mul_f32 v[102:103], v[102:103], s[8:9]
v_cvt_pk_bf16_f32 v96, v96, v97
v_cvt_pk_bf16_f32 v97, v98, v99
v_cvt_pk_bf16_f32 v98, v100, v101
v_cvt_pk_bf16_f32 v99, v102, v103
v_accvgpr_write_b32 a196, v96
v_accvgpr_write_b32 a197, v97
v_accvgpr_write_b32 a198, v98
v_accvgpr_write_b32 a199, v99
v_pk_mul_f32 v[104:105], v[104:105], s[8:9]
v_pk_mul_f32 v[106:107], v[106:107], s[8:9]
v_pk_mul_f32 v[108:109], v[108:109], s[8:9]
v_pk_mul_f32 v[110:111], v[110:111], s[8:9]
v_cvt_pk_bf16_f32 v104, v104, v105
v_cvt_pk_bf16_f32 v105, v106, v107
v_cvt_pk_bf16_f32 v106, v108, v109
v_cvt_pk_bf16_f32 v107, v110, v111
v_accvgpr_write_b32 a200, v104
v_accvgpr_write_b32 a201, v105
v_accvgpr_write_b32 a202, v106
v_accvgpr_write_b32 a203, v107
v_pk_mul_f32 v[112:113], v[112:113], s[8:9]
v_pk_mul_f32 v[114:115], v[114:115], s[8:9]
v_pk_mul_f32 v[116:117], v[116:117], s[8:9]
v_pk_mul_f32 v[118:119], v[118:119], s[8:9]
v_cvt_pk_bf16_f32 v112, v112, v113
v_cvt_pk_bf16_f32 v113, v114, v115
v_cvt_pk_bf16_f32 v114, v116, v117
v_cvt_pk_bf16_f32 v115, v118, v119
v_accvgpr_write_b32 a204, v112
v_accvgpr_write_b32 a205, v113
v_accvgpr_write_b32 a206, v114
v_accvgpr_write_b32 a207, v115
v_pk_mul_f32 v[120:121], v[120:121], s[8:9]
v_pk_mul_f32 v[122:123], v[122:123], s[8:9]
v_pk_mul_f32 v[124:125], v[124:125], s[8:9]
v_pk_mul_f32 v[126:127], v[126:127], s[8:9]
v_cvt_pk_bf16_f32 v120, v120, v121
v_cvt_pk_bf16_f32 v121, v122, v123
v_cvt_pk_bf16_f32 v122, v124, v125
v_cvt_pk_bf16_f32 v123, v126, v127
v_accvgpr_write_b32 a208, v120
v_accvgpr_write_b32 a209, v121
v_accvgpr_write_b32 a210, v122
v_accvgpr_write_b32 a211, v123
v_pk_mul_f32 v[128:129], v[128:129], s[8:9]
v_pk_mul_f32 v[130:131], v[130:131], s[8:9]
v_pk_mul_f32 v[132:133], v[132:133], s[8:9]
v_pk_mul_f32 v[134:135], v[134:135], s[8:9]
v_cvt_pk_bf16_f32 v128, v128, v129
v_cvt_pk_bf16_f32 v129, v130, v131
v_cvt_pk_bf16_f32 v130, v132, v133
v_cvt_pk_bf16_f32 v131, v134, v135
v_accvgpr_write_b32 a212, v128
v_accvgpr_write_b32 a213, v129
v_accvgpr_write_b32 a214, v130
v_accvgpr_write_b32 a215, v131
v_pk_mul_f32 v[136:137], v[136:137], s[8:9]
v_pk_mul_f32 v[138:139], v[138:139], s[8:9]
v_pk_mul_f32 v[140:141], v[140:141], s[8:9]
v_pk_mul_f32 v[142:143], v[142:143], s[8:9]
v_cvt_pk_bf16_f32 v136, v136, v137
v_cvt_pk_bf16_f32 v137, v138, v139
v_cvt_pk_bf16_f32 v138, v140, v141
v_cvt_pk_bf16_f32 v139, v142, v143
v_accvgpr_write_b32 a216, v136
v_accvgpr_write_b32 a217, v137
v_accvgpr_write_b32 a218, v138
v_accvgpr_write_b32 a219, v139
v_pk_mul_f32 v[144:145], v[144:145], s[8:9]
v_pk_mul_f32 v[146:147], v[146:147], s[8:9]
v_pk_mul_f32 v[148:149], v[148:149], s[8:9]
v_pk_mul_f32 v[150:151], v[150:151], s[8:9]
v_cvt_pk_bf16_f32 v144, v144, v145
v_cvt_pk_bf16_f32 v145, v146, v147
v_cvt_pk_bf16_f32 v146, v148, v149
v_cvt_pk_bf16_f32 v147, v150, v151
v_accvgpr_write_b32 a220, v144
v_accvgpr_write_b32 a221, v145
v_accvgpr_write_b32 a222, v146
v_accvgpr_write_b32 a223, v147
s_waitcnt lgkmcnt(0)
s_barrier
ds_read_b128 v[188:191], v17 offset:0
ds_read_b64 v[24:25], v17 offset:1024
ds_read_b64 v[28:29], v17 offset:1032
ds_read_b128 v[196:199], v18 offset:0
ds_read_b64 v[32:33], v18 offset:1024
ds_read_b64 v[36:37], v18 offset:1032
ds_read_b128 v[204:207], v17 offset:16384
ds_read_b64 v[40:41], v17 offset:17408
ds_read_b64 v[44:45], v17 offset:17416
ds_read_b128 v[212:215], v18 offset:16384
ds_read_b64 v[48:49], v18 offset:17408
ds_read_b64 v[52:53], v18 offset:17416
v_and_b32 v104, 15, v0
v_lshrrev_b32 v105, 4, v0
v_lshlrev_b32 v105, 2, v105
v_sub_u32 v104, v104, v105
v_mov_b32 v107, 0xf149f2ca
s_or_b32 s8, s6, s4
s_cmp_eq_u32 s8, 0
s_cselect_b32 s8, 0xf149f2ca, 0
v_add_u32 v105, 16, v104
v_and_b32 v105, 0xfffffff1, v105
v_cmp_eq_u32 s[36:37], 0, v105
v_add_u32 v105, 15, v104
v_and_b32 v105, 0xfffffff1, v105
v_cmp_eq_u32 s[38:39], 0, v105
v_add_u32 v105, 14, v104
v_and_b32 v105, 0xfffffff1, v105
v_cmp_eq_u32 s[40:41], 0, v105
v_add_u32 v105, 13, v104
v_and_b32 v105, 0xfffffff1, v105
v_cmp_eq_u32 s[42:43], 0, v105
s_nop 1
v_cndmask_b32 v92, v107, 0, s[36:37]
v_cndmask_b32 v93, v107, 0, s[38:39]
v_cndmask_b32 v94, v107, 0, s[40:41]
v_cndmask_b32 v95, v107, 0, s[42:43]
v_add_u32 v105, 0, v104
v_and_b32 v105, 0xfffffff1, v105
v_cmp_eq_u32 s[36:37], 0, v105
v_add_u32 v105, -1, v104
v_and_b32 v105, 0xfffffff1, v105
v_cmp_eq_u32 s[38:39], 0, v105
v_add_u32 v105, -2, v104
v_and_b32 v105, 0xfffffff1, v105
v_cmp_eq_u32 s[40:41], 0, v105
v_add_u32 v105, -3, v104
v_and_b32 v105, 0xfffffff1, v105
v_cmp_eq_u32 s[42:43], 0, v105
s_nop 1
v_cndmask_b32 v96, v107, 0, s[36:37]
v_cndmask_b32 v97, v107, 0, s[38:39]
v_cndmask_b32 v98, v107, 0, s[40:41]
v_cndmask_b32 v99, v107, 0, s[42:43]
v_min_f32 v88, s8, v92
v_mov_b32 v140, 0x3f803f80
v_min_f32 v89, s8, v93
v_mov_b32 v141, 0x3f803f80
v_min_f32 v90, s8, v94
v_mov_b32 v142, 0x3f803f80
v_min_f32 v91, s8, v95
v_mov_b32 v143, 0x3f803f80
v_mov_b32 v26, v216
v_mov_b32 v27, v217
v_mov_b32 v30, v218
v_mov_b32 v31, v219
v_mov_b32 v34, v224
v_mov_b32 v35, v225
v_mov_b32 v38, v226
v_mov_b32 v39, v227
v_mov_b32 v42, v232
v_mov_b32 v43, v233
v_mov_b32 v46, v234
v_mov_b32 v47, v235
v_mov_b32 v50, v240
v_mov_b32 v51, v241
v_mov_b32 v54, v242
v_mov_b32 v55, v243
v_mfma_f32_16x16x32_bf16 v[60:63], v[184:187], v[152:155], v[96:99]
v_mfma_f32_16x16x32_bf16 v[68:71], v[192:195], v[160:163], v[96:99]
v_mfma_f32_16x16x32_bf16 v[76:79], v[200:203], v[168:171], v[96:99]
v_mfma_f32_16x16x32_bf16 v[84:87], v[208:211], v[176:179], v[96:99]
s_waitcnt lgkmcnt(11)
v_mfma_f32_16x16x32_bf16 v[56:59], v[188:191], v[152:155], v[88:91]
s_waitcnt lgkmcnt(8)
v_mfma_f32_16x16x32_bf16 v[64:67], v[196:199], v[160:163], v[92:95]
s_waitcnt lgkmcnt(5)
v_mfma_f32_16x16x32_bf16 v[72:75], v[204:207], v[168:171], v[92:95]
s_waitcnt lgkmcnt(2)
v_mfma_f32_16x16x32_bf16 v[80:83], v[212:215], v[176:179], v[92:95]
s_mov_b32 s8, 0x3e8293ee
s_mul_i32 s9, s6, 0x140000
s_sub_u32 s10, 0x12c0000, s9
s_lshl_b32 s11, s5, 13
s_add_u32 s11, s11, 0x2200000
s_add_u32 s9, s9, s11
s_add_u32 s10, s10, s11
s_lshl_b32 s11, s4, 10
s_add_u32 s28, s9, s11
s_add_u32 s30, s10, s11
s_sub_u32 s11, 0x1c00, s11
s_add_u32 s29, s9, s11
s_add_u32 s31, s10, s11
v_max3_f32 v100, v56, v57, v58
v_max3_f32 v100, v100, v59, v60
v_max3_f32 v100, v100, v61, v62
v_max_f32 v100, v100, v63
v_max3_f32 v101, v64, v65, v66
v_max3_f32 v101, v101, v67, v68
v_max3_f32 v101, v101, v69, v70
v_max_f32 v101, v101, v71
v_max3_f32 v102, v72, v73, v74
v_max3_f32 v102, v102, v75, v76
v_max3_f32 v102, v102, v77, v78
v_max_f32 v102, v102, v79
v_max3_f32 v103, v80, v81, v82
v_max3_f32 v103, v103, v83, v84
v_max3_f32 v103, v103, v85, v86
v_max_f32 v103, v103, v87
v_mov_b32 v104, v100
v_mov_b32 v105, v101
v_mov_b32 v106, v102
v_mov_b32 v107, v103
s_nop 1
v_permlane16_swap_b32 v104, v100
v_permlane16_swap_b32 v105, v101
v_permlane16_swap_b32 v106, v102
v_permlane16_swap_b32 v107, v103
v_max_f32 v100, v100, v104
v_max_f32 v101, v101, v105
v_max_f32 v102, v102, v106
v_max_f32 v103, v103, v107
v_mov_b32 v104, v100
v_mov_b32 v105, v101
v_mov_b32 v106, v102
v_mov_b32 v107, v103
s_nop 1
v_permlane32_swap_b32 v104, v100
v_permlane32_swap_b32 v105, v101
v_permlane32_swap_b32 v106, v102
v_permlane32_swap_b32 v107, v103
v_max_f32 v100, v100, v104
v_max_f32 v101, v101, v105
v_max_f32 v102, v102, v106
v_max_f32 v103, v103, v107
v_mul_f32 v100, s8, v100
v_mul_f32 v101, s8, v101
v_mul_f32 v102, s8, v102
v_mul_f32 v103, s8, v103
v_fma_f32 v56, v56, s8, -v100
v_fma_f32 v57, v57, s8, -v100
v_fma_f32 v58, v58, s8, -v100
v_fma_f32 v59, v59, s8, -v100
v_fma_f32 v60, v60, s8, -v100
v_fma_f32 v61, v61, s8, -v100
v_fma_f32 v62, v62, s8, -v100
v_fma_f32 v63, v63, s8, -v100
v_exp_f32 v56, v56
v_exp_f32 v57, v57
v_exp_f32 v58, v58
v_exp_f32 v59, v59
v_exp_f32 v60, v60
v_exp_f32 v61, v61
v_exp_f32 v62, v62
v_exp_f32 v63, v63
v_fma_f32 v64, v64, s8, -v101
v_fma_f32 v65, v65, s8, -v101
v_fma_f32 v66, v66, s8, -v101
v_fma_f32 v67, v67, s8, -v101
v_fma_f32 v68, v68, s8, -v101
v_fma_f32 v69, v69, s8, -v101
v_fma_f32 v70, v70, s8, -v101
v_fma_f32 v71, v71, s8, -v101
v_exp_f32 v64, v64
v_exp_f32 v65, v65
v_exp_f32 v66, v66
v_exp_f32 v67, v67
v_exp_f32 v68, v68
v_exp_f32 v69, v69
v_exp_f32 v70, v70
v_exp_f32 v71, v71
v_fma_f32 v72, v72, s8, -v102
v_fma_f32 v73, v73, s8, -v102
v_fma_f32 v74, v74, s8, -v102
v_fma_f32 v75, v75, s8, -v102
v_fma_f32 v76, v76, s8, -v102
v_fma_f32 v77, v77, s8, -v102
v_fma_f32 v78, v78, s8, -v102
v_fma_f32 v79, v79, s8, -v102
v_exp_f32 v72, v72
v_exp_f32 v73, v73
v_exp_f32 v74, v74
v_exp_f32 v75, v75
v_exp_f32 v76, v76
v_exp_f32 v77, v77
v_exp_f32 v78, v78
v_exp_f32 v79, v79
v_fma_f32 v80, v80, s8, -v103
v_fma_f32 v81, v81, s8, -v103
v_fma_f32 v82, v82, s8, -v103
v_fma_f32 v83, v83, s8, -v103
v_fma_f32 v84, v84, s8, -v103
v_fma_f32 v85, v85, s8, -v103
v_fma_f32 v86, v86, s8, -v103
v_fma_f32 v87, v87, s8, -v103
v_exp_f32 v80, v80
v_exp_f32 v81, v81
v_exp_f32 v82, v82
v_exp_f32 v83, v83
v_exp_f32 v84, v84
v_exp_f32 v85, v85
v_exp_f32 v86, v86
v_exp_f32 v87, v87
v_cvt_pk_bf16_f32 v56, v56, v57
v_cvt_pk_bf16_f32 v57, v58, v59
v_cvt_pk_bf16_f32 v58, v60, v61
v_cvt_pk_bf16_f32 v59, v62, v63
v_cvt_pk_bf16_f32 v64, v64, v65
v_cvt_pk_bf16_f32 v65, v66, v67
v_cvt_pk_bf16_f32 v66, v68, v69
v_cvt_pk_bf16_f32 v67, v70, v71
v_cvt_pk_bf16_f32 v72, v72, v73
v_cvt_pk_bf16_f32 v73, v74, v75
v_cvt_pk_bf16_f32 v74, v76, v77
v_cvt_pk_bf16_f32 v75, v78, v79
v_cvt_pk_bf16_f32 v80, v80, v81
v_cvt_pk_bf16_f32 v81, v82, v83
v_cvt_pk_bf16_f32 v82, v84, v85
v_cvt_pk_bf16_f32 v83, v86, v87
s_nop 0
v_mfma_f32_16x16x32_bf16 v[156:159], v[140:143], v[56:59], 0
v_mfma_f32_16x16x32_bf16 v[164:167], v[140:143], v[64:67], 0
v_mfma_f32_16x16x32_bf16 v[172:175], v[140:143], v[72:75], 0
v_mfma_f32_16x16x32_bf16 v[180:183], v[140:143], v[80:83], 0
v_mfma_f32_16x16x32_bf16 v[108:111], v[24:27], v[56:59], 0
v_mfma_f32_16x16x32_bf16 v[112:115], v[28:31], v[56:59], 0
v_mfma_f32_16x16x32_bf16 v[116:119], v[32:35], v[64:67], 0
v_mfma_f32_16x16x32_bf16 v[120:123], v[36:39], v[64:67], 0
v_mfma_f32_16x16x32_bf16 v[124:127], v[40:43], v[72:75], 0
v_mfma_f32_16x16x32_bf16 v[128:131], v[44:47], v[72:75], 0
s_waitcnt lgkmcnt(1)
v_mfma_f32_16x16x32_bf16 v[132:135], v[48:51], v[80:83], 0
s_waitcnt lgkmcnt(0)
v_mfma_f32_16x16x32_bf16 v[136:139], v[52:55], v[80:83], 0
v_rcp_f32 v100, v156
v_rcp_f32 v101, v164
v_rcp_f32 v102, v172
v_rcp_f32 v103, v180
s_nop 3
v_mul_f32 v108, v100, v108
v_mul_f32 v109, v100, v109
v_mul_f32 v110, v100, v110
v_mul_f32 v111, v100, v111
v_mul_f32 v112, v100, v112
v_mul_f32 v113, v100, v113
v_mul_f32 v114, v100, v114
v_mul_f32 v115, v100, v115
v_cvt_pk_bf16_f32 v108, v108, v109
v_cvt_pk_bf16_f32 v109, v110, v111
v_cvt_pk_bf16_f32 v110, v112, v113
v_cvt_pk_bf16_f32 v111, v114, v115
buffer_store_dwordx4 v[108:111], v16, s[88:91], s28 offen
v_mul_f32 v116, v101, v116
v_mul_f32 v117, v101, v117
v_mul_f32 v118, v101, v118
v_mul_f32 v119, v101, v119
v_mul_f32 v120, v101, v120
v_mul_f32 v121, v101, v121
v_mul_f32 v122, v101, v122
v_mul_f32 v123, v101, v123
v_cvt_pk_bf16_f32 v116, v116, v117
v_cvt_pk_bf16_f32 v117, v118, v119
v_cvt_pk_bf16_f32 v118, v120, v121
v_cvt_pk_bf16_f32 v119, v122, v123
buffer_store_dwordx4 v[116:119], v16, s[88:91], s29 offen
v_mul_f32 v124, v102, v124
v_mul_f32 v125, v102, v125
v_mul_f32 v126, v102, v126
v_mul_f32 v127, v102, v127
v_mul_f32 v128, v102, v128
v_mul_f32 v129, v102, v129
v_mul_f32 v130, v102, v130
v_mul_f32 v131, v102, v131
v_cvt_pk_bf16_f32 v124, v124, v125
v_cvt_pk_bf16_f32 v125, v126, v127
v_cvt_pk_bf16_f32 v126, v128, v129
v_cvt_pk_bf16_f32 v127, v130, v131
buffer_store_dwordx4 v[124:127], v16, s[88:91], s30 offen
v_mul_f32 v132, v103, v132
v_mul_f32 v133, v103, v133
v_mul_f32 v134, v103, v134
v_mul_f32 v135, v103, v135
v_mul_f32 v136, v103, v136
v_mul_f32 v137, v103, v137
v_mul_f32 v138, v103, v138
v_mul_f32 v139, v103, v139
v_cvt_pk_bf16_f32 v132, v132, v133
v_cvt_pk_bf16_f32 v133, v134, v135
v_cvt_pk_bf16_f32 v134, v136, v137
v_cvt_pk_bf16_f32 v135, v138, v139
buffer_store_dwordx4 v[132:135], v16, s[88:91], s31 offen
s_mul_i32 s8, s5, 0x6000
s_add_u32 s8, s8, 0x40000
s_add_u32 s28, s28, s8
s_add_u32 s29, s29, s8
s_add_u32 s30, s30, s8
s_add_u32 s31, s31, s8
v_mov_b32 v3, v16
s_mov_b32 s33, 0
L_att_start:
s_mul_i32 s32, s5, 0x108000
s_lshl_b32 s18, s4, 13
s_add_u32 s32, s32, s18
s_add_u32 s11, s32, 0x1000
s_add_u32 m0, s18, 0x0
s_nop 0
buffer_load_dwordx4 v3, s[88:91], s32 offen offset:0 lds
buffer_load_dwordx4 v3, s[88:91], s32 offen offset:1024 lds
buffer_load_dwordx4 v3, s[88:91], s32 offen offset:2048 lds
buffer_load_dwordx4 v3, s[88:91], s32 offen offset:3072 lds
s_add_u32 m0, s18, 0x1000
s_nop 0
buffer_load_dwordx4 v3, s[88:91], s11 offen offset:0 lds
buffer_load_dwordx4 v3, s[88:91], s11 offen offset:1024 lds
buffer_load_dwordx4 v3, s[88:91], s11 offen offset:2048 lds
buffer_load_dwordx4 v3, s[88:91], s11 offen offset:3072 lds
s_add_u32 s32, s32, 0x8000
s_add_u32 s11, s11, 0x8000
s_add_u32 m0, s18, 0x10000
s_nop 0
buffer_load_dwordx4 v3, s[88:91], s32 offen offset:0 lds
buffer_load_dwordx4 v3, s[88:91], s32 offen offset:1024 lds
buffer_load_dwordx4 v3, s[88:91], s32 offen offset:2048 lds
buffer_load_dwordx4 v3, s[88:91], s32 offen offset:3072 lds
s_add_u32 m0, s18, 0x11000
s_nop 0
buffer_load_dwordx4 v3, s[88:91], s11 offen offset:0 lds
buffer_load_dwordx4 v3, s[88:91], s11 offen offset:1024 lds
buffer_load_dwordx4 v3, s[88:91], s11 offen offset:2048 lds
buffer_load_dwordx4 v3, s[88:91], s11 offen offset:3072 lds
s_add_u32 s32, s32, 0x8000
s_add_u32 s11, s11, 0x8000
s_add_u32 m0, s18, 0x8000
s_nop 0
buffer_load_dwordx4 v3, s[88:91], s32 offen offset:0 lds
buffer_load_dwordx4 v3, s[88:91], s32 offen offset:1024 lds
buffer_load_dwordx4 v3, s[88:91], s32 offen offset:2048 lds
buffer_load_dwordx4 v3, s[88:91], s32 offen offset:3072 lds
s_add_u32 m0, s18, 0x9000
s_nop 0
buffer_load_dwordx4 v3, s[88:91], s11 offen offset:0 lds
buffer_load_dwordx4 v3, s[88:91], s11 offen offset:1024 lds
buffer_load_dwordx4 v3, s[88:91], s11 offen offset:2048 lds
buffer_load_dwordx4 v3, s[88:91], s11 offen offset:3072 lds
s_add_u32 s32, s32, 0x8000
s_add_u32 s11, s11, 0x8000
s_xor_b32 s18, s18, 0x8000
s_mov_b64 s[34:35], 0
v_mov_b32 v1, v3
v_add_u32 v2, 0x10000, v3
v_mov_b32 v4, 0x3f803f80
v_accvgpr_write_b32 a240, v4
v_accvgpr_write_b32 a241, v4
v_accvgpr_write_b32 a242, v4
v_accvgpr_write_b32 a243, v4
v_accvgpr_write_b32 a224, 0
v_accvgpr_write_b32 a225, 0
v_accvgpr_write_b32 a226, 0
v_accvgpr_write_b32 a227, 0
v_accvgpr_write_b32 a228, 0
v_accvgpr_write_b32 a229, 0
v_accvgpr_write_b32 a230, 0
v_accvgpr_write_b32 a231, 0
v_accvgpr_write_b32 a232, 0
v_accvgpr_write_b32 a233, 0
v_accvgpr_write_b32 a234, 0
v_accvgpr_write_b32 a235, 0
v_accvgpr_write_b32 a236, 0
v_accvgpr_write_b32 a237, 0
v_accvgpr_write_b32 a238, 0
v_accvgpr_write_b32 a239, 0
v_mov_b32 v128, 0
v_mov_b32 v129, 0
v_mov_b32 v130, 0
v_mov_b32 v131, 0
v_mov_b32 v132, 0
v_mov_b32 v133, 0
v_mov_b32 v134, 0
v_mov_b32 v135, 0
v_mov_b32 v136, 0
v_mov_b32 v137, 0
v_mov_b32 v138, 0
v_mov_b32 v139, 0
v_mov_b32 v140, 0
v_mov_b32 v141, 0
v_mov_b32 v142, 0
v_mov_b32 v143, 0
v_mov_b32 v144, 0
v_mov_b32 v145, 0
v_mov_b32 v146, 0
v_mov_b32 v147, 0
v_mov_b32 v148, 0
v_mov_b32 v149, 0
v_mov_b32 v150, 0
v_mov_b32 v151, 0
v_mov_b32 v152, 0
v_mov_b32 v153, 0
v_mov_b32 v154, 0
v_mov_b32 v155, 0
v_mov_b32 v156, 0
v_mov_b32 v157, 0
v_mov_b32 v158, 0
v_mov_b32 v159, 0
v_mov_b32 v160, 0
v_mov_b32 v161, 0
v_mov_b32 v162, 0
v_mov_b32 v163, 0
v_mov_b32 v164, 0
v_mov_b32 v165, 0
v_mov_b32 v166, 0
v_mov_b32 v167, 0
v_mov_b32 v168, 0
v_mov_b32 v169, 0
v_mov_b32 v170, 0
v_mov_b32 v171, 0
v_mov_b32 v172, 0
v_mov_b32 v173, 0
v_mov_b32 v174, 0
v_mov_b32 v175, 0
v_mov_b32 v176, 0
v_mov_b32 v177, 0
v_mov_b32 v178, 0
v_mov_b32 v179, 0
v_mov_b32 v180, 0
v_mov_b32 v181, 0
v_mov_b32 v182, 0
v_mov_b32 v183, 0
v_mov_b32 v184, 0
v_mov_b32 v185, 0
v_mov_b32 v186, 0
v_mov_b32 v187, 0
v_mov_b32 v188, 0
v_mov_b32 v189, 0
v_mov_b32 v190, 0
v_mov_b32 v191, 0
v_mov_b32 v192, 0
v_mov_b32 v193, 0
v_mov_b32 v194, 0
v_mov_b32 v195, 0
v_mov_b32 v196, 0
v_mov_b32 v197, 0
v_mov_b32 v198, 0
v_mov_b32 v199, 0
v_mov_b32 v200, 0
v_mov_b32 v201, 0
v_mov_b32 v202, 0
v_mov_b32 v203, 0
v_mov_b32 v204, 0
v_mov_b32 v205, 0
v_mov_b32 v206, 0
v_mov_b32 v207, 0
v_mov_b32 v208, 0
v_mov_b32 v209, 0
v_mov_b32 v210, 0
v_mov_b32 v211, 0
v_mov_b32 v212, 0
v_mov_b32 v213, 0
v_mov_b32 v214, 0
v_mov_b32 v215, 0
v_mov_b32 v216, 0
v_mov_b32 v217, 0
v_mov_b32 v218, 0
v_mov_b32 v219, 0
v_mov_b32 v220, 0
v_mov_b32 v221, 0
v_mov_b32 v222, 0
v_mov_b32 v223, 0
v_mov_b32 v224, 0
v_mov_b32 v225, 0
v_mov_b32 v226, 0
v_mov_b32 v227, 0
v_mov_b32 v228, 0
v_mov_b32 v229, 0
v_mov_b32 v230, 0
v_mov_b32 v231, 0
v_mov_b32 v232, 0
v_mov_b32 v233, 0
v_mov_b32 v234, 0
v_mov_b32 v235, 0
v_mov_b32 v236, 0
v_mov_b32 v237, 0
v_mov_b32 v238, 0
v_mov_b32 v239, 0
v_mov_b32 v240, 0
v_mov_b32 v241, 0
v_mov_b32 v242, 0
v_mov_b32 v243, 0
v_mov_b32 v244, 0
v_mov_b32 v245, 0
v_mov_b32 v246, 0
v_mov_b32 v247, 0
v_mov_b32 v248, 0
v_mov_b32 v249, 0
v_mov_b32 v250, 0
v_mov_b32 v251, 0
v_mov_b32 v252, 0
v_mov_b32 v253, 0
v_mov_b32 v254, 0
v_mov_b32 v255, 0
v_and_b32 v5, 15, v0
v_lshrrev_b32 v6, 4, v0
v_lshlrev_b32 v6, 2, v6
v_sub_u32 v5, v5, v6
v_mov_b32 v6, 0xf149f2ca
s_or_b32 s8, s6, s4
s_lshl_b32 s8, s8, 4
v_add_u32 v7, s8, v5
v_cmp_le_i32 s[36:37], 0, v7
v_cmp_le_i32 s[38:39], 1, v7
v_cmp_le_i32 s[40:41], 2, v7
v_cmp_le_i32 s[42:43], 3, v7
s_nop 1
v_cndmask_b32 v48, v6, 0, s[36:37]
v_cndmask_b32 v49, v6, 0, s[38:39]
v_cndmask_b32 v50, v6, 0, s[40:41]
v_cndmask_b32 v51, v6, 0, s[42:43]
s_waitcnt vmcnt(16)
s_barrier
ds_read_b128 a[0:3], v1 offset:0
ds_read_b128 a[4:7], v1 offset:1024
ds_read_b128 a[8:11], v1 offset:2048
ds_read_b128 a[12:15], v1 offset:3072
ds_read_b128 a[16:19], v1 offset:4096
ds_read_b128 a[20:23], v1 offset:5120
ds_read_b128 a[24:27], v1 offset:6144
ds_read_b128 a[28:31], v1 offset:7168
s_cmp_lg_u32 s33, 0
s_cbranch_scc1 L_att_havemax
s_waitcnt lgkmcnt(7)
v_mfma_f32_16x16x32_bf16 v[16:19], a[0:3], a[160:163], v[48:51]
s_waitcnt lgkmcnt(6)
v_mfma_f32_16x16x32_bf16 v[16:19], a[4:7], a[164:167], v[16:19]
s_waitcnt lgkmcnt(5)
v_mfma_f32_16x16x32_bf16 v[16:19], a[8:11], a[168:171], v[16:19]
s_waitcnt lgkmcnt(4)
v_mfma_f32_16x16x32_bf16 v[16:19], a[12:15], a[172:175], v[16:19]
v_mfma_f32_16x16x32_bf16 v[20:23], a[0:3], a[176:179], 0
v_mfma_f32_16x16x32_bf16 v[20:23], a[4:7], a[180:183], v[20:23]
v_mfma_f32_16x16x32_bf16 v[20:23], a[8:11], a[184:187], v[20:23]
v_mfma_f32_16x16x32_bf16 v[20:23], a[12:15], a[188:191], v[20:23]
v_mfma_f32_16x16x32_bf16 v[24:27], a[0:3], a[192:195], 0
v_mfma_f32_16x16x32_bf16 v[24:27], a[4:7], a[196:199], v[24:27]
v_mfma_f32_16x16x32_bf16 v[24:27], a[8:11], a[200:203], v[24:27]
v_mfma_f32_16x16x32_bf16 v[24:27], a[12:15], a[204:207], v[24:27]
v_mfma_f32_16x16x32_bf16 v[28:31], a[0:3], a[208:211], 0
v_mfma_f32_16x16x32_bf16 v[28:31], a[4:7], a[212:215], v[28:31]
v_mfma_f32_16x16x32_bf16 v[28:31], a[8:11], a[216:219], v[28:31]
v_mfma_f32_16x16x32_bf16 v[28:31], a[12:15], a[220:223], v[28:31]
s_nop 7
v_max3_f32 v8, v16, v17, v18
v_max_f32 v8, v8, v19
v_max3_f32 v9, v20, v21, v22
v_max_f32 v9, v9, v23
v_max3_f32 v10, v24, v25, v26
v_max_f32 v10, v10, v27
v_max3_f32 v11, v28, v29, v30
v_max_f32 v11, v11, v31
v_mov_b32 v12, v8
v_mov_b32 v13, v9
v_mov_b32 v14, v10
v_mov_b32 v15, v11
s_nop 1
v_permlane16_swap_b32 v12, v8
v_permlane16_swap_b32 v13, v9
v_permlane16_swap_b32 v14, v10
v_permlane16_swap_b32 v15, v11
v_max_f32 v8, v8, v12
v_max_f32 v9, v9, v13
v_max_f32 v10, v10, v14
v_max_f32 v11, v11, v15
v_mov_b32 v12, v8
v_mov_b32 v13, v9
v_mov_b32 v14, v10
v_mov_b32 v15, v11
s_nop 1
v_permlane32_swap_b32 v12, v8
v_permlane32_swap_b32 v13, v9
v_permlane32_swap_b32 v14, v10
v_permlane32_swap_b32 v15, v11
v_max_f32 v8, v8, v12
v_max_f32 v9, v9, v13
v_max_f32 v10, v10, v14
v_max_f32 v11, v11, v15
L_att_havemax:
v_sub_f32 v80, 0, v8
v_sub_f32 v81, 0, v8
v_sub_f32 v82, 0, v8
v_sub_f32 v83, 0, v8
v_sub_f32 v84, 0, v9
v_sub_f32 v85, 0, v9
v_sub_f32 v86, 0, v9
v_sub_f32 v87, 0, v9
v_sub_f32 v88, 0, v10
v_sub_f32 v89, 0, v10
v_sub_f32 v90, 0, v10
v_sub_f32 v91, 0, v10
v_sub_f32 v92, 0, v11
v_sub_f32 v93, 0, v11
v_sub_f32 v94, 0, v11
v_sub_f32 v95, 0, v11
s_and_b32 s8, s4, 1
s_lshl_b32 s8, s8, 4
v_add_u32 v7, s8, v5
v_cmp_le_i32 s[36:37], 0, v7
v_cmp_le_i32 s[38:39], 1, v7
v_cmp_le_i32 s[40:41], 2, v7
v_cmp_le_i32 s[42:43], 3, v7
s_nop 1
v_cndmask_b32 v96, v6, v80, s[36:37]
v_cndmask_b32 v97, v6, v80, s[38:39]
v_cndmask_b32 v98, v6, v80, s[40:41]
v_cndmask_b32 v99, v6, v80, s[42:43]
v_cndmask_b32 v112, v6, v88, s[36:37]
v_cndmask_b32 v113, v6, v88, s[38:39]
v_cndmask_b32 v114, v6, v88, s[40:41]
v_cndmask_b32 v115, v6, v88, s[42:43]
v_cmp_le_i32 s[36:37], 16, v7
v_cmp_le_i32 s[38:39], 17, v7
v_cmp_le_i32 s[40:41], 18, v7
v_cmp_le_i32 s[42:43], 19, v7
s_nop 1
v_cndmask_b32 v100, v6, v80, s[36:37]
v_cndmask_b32 v101, v6, v80, s[38:39]
v_cndmask_b32 v102, v6, v80, s[40:41]
v_cndmask_b32 v103, v6, v80, s[42:43]
v_cndmask_b32 v116, v6, v88, s[36:37]
v_cndmask_b32 v117, v6, v88, s[38:39]
v_cndmask_b32 v118, v6, v88, s[40:41]
v_cndmask_b32 v119, v6, v88, s[42:43]
s_and_b32 s8, s4, 1
s_xor_b32 s8, s8, 1
s_lshl_b32 s8, s8, 4
v_add_u32 v7, s8, v5
v_cmp_le_i32 s[36:37], 0, v7
v_cmp_le_i32 s[38:39], 1, v7
v_cmp_le_i32 s[40:41], 2, v7
v_cmp_le_i32 s[42:43], 3, v7
s_nop 1
v_cndmask_b32 v104, v6, v84, s[36:37]
v_cndmask_b32 v105, v6, v84, s[38:39]
v_cndmask_b32 v106, v6, v84, s[40:41]
v_cndmask_b32 v107, v6, v84, s[42:43]
v_cndmask_b32 v120, v6, v92, s[36:37]
v_cndmask_b32 v121, v6, v92, s[38:39]
v_cndmask_b32 v122, v6, v92, s[40:41]
v_cndmask_b32 v123, v6, v92, s[42:43]
v_cmp_le_i32 s[36:37], 16, v7
v_cmp_le_i32 s[38:39], 17, v7
v_cmp_le_i32 s[40:41], 18, v7
v_cmp_le_i32 s[42:43], 19, v7
s_nop 1
v_cndmask_b32 v108, v6, v84, s[36:37]
v_cndmask_b32 v109, v6, v84, s[38:39]
v_cndmask_b32 v110, v6, v84, s[40:41]
v_cndmask_b32 v111, v6, v84, s[42:43]
v_cndmask_b32 v124, v6, v92, s[36:37]
v_cndmask_b32 v125, v6, v92, s[38:39]
v_cndmask_b32 v126, v6, v92, s[40:41]
v_cndmask_b32 v127, v6, v92, s[42:43]
s_waitcnt lgkmcnt(0)
s_mov_b32 s15, s6
s_cmp_eq_u32 s6, 0
s_cbranch_scc1 L_att_j0
v_mfma_f32_16x16x32_bf16 v[16:19], a[0:3], a[160:163], v[80:83]
v_mfma_f32_16x16x32_bf16 v[16:19], a[4:7], a[164:167], v[16:19]
v_mfma_f32_16x16x32_bf16 v[16:19], a[8:11], a[168:171], v[16:19]
v_mfma_f32_16x16x32_bf16 v[16:19], a[12:15], a[172:175], v[16:19]
s_add_u32 m0, s18, 0x10000
v_mfma_f32_16x16x32_bf16 v[20:23], a[0:3], a[176:179], v[84:87]
buffer_load_dwordx4 v3, s[88:91], s32 offen offset:0 lds
v_mfma_f32_16x16x32_bf16 v[20:23], a[4:7], a[180:183], v[20:23]
v_mfma_f32_16x16x32_bf16 v[20:23], a[8:11], a[184:187], v[20:23]
v_mfma_f32_16x16x32_bf16 v[20:23], a[12:15], a[188:191], v[20:23]
v_mfma_f32_16x16x32_bf16 v[24:27], a[0:3], a[192:195], v[88:91]
s_nop 0
v_exp_f32 v16, v16
v_mfma_f32_16x16x32_bf16 v[24:27], a[4:7], a[196:199], v[24:27]
v_exp_f32 v17, v17
v_mfma_f32_16x16x32_bf16 v[24:27], a[8:11], a[200:203], v[24:27]
v_exp_f32 v18, v18
v_mfma_f32_16x16x32_bf16 v[24:27], a[12:15], a[204:207], v[24:27]
v_exp_f32 v19, v19
v_mfma_f32_16x16x32_bf16 v[28:31], a[0:3], a[208:211], v[92:95]
buffer_load_dwordx4 v3, s[88:91], s32 offen offset:1024 lds
v_mfma_f32_16x16x32_bf16 v[28:31], a[4:7], a[212:215], v[28:31]
v_cvt_pk_bf16_f32 v48, v16, v17
v_cvt_pk_bf16_f32 v49, v18, v19
v_mfma_f32_16x16x32_bf16 v[28:31], a[8:11], a[216:219], v[28:31]
v_exp_f32 v20, v20
v_mfma_f32_16x16x32_bf16 v[28:31], a[12:15], a[220:223], v[28:31]
v_exp_f32 v21, v21
v_mfma_f32_16x16x32_bf16 v[32:35], a[16:19], a[160:163], v[80:83]
v_exp_f32 v22, v22
v_mfma_f32_16x16x32_bf16 v[32:35], a[20:23], a[164:167], v[32:35]
v_exp_f32 v23, v23
v_mfma_f32_16x16x32_bf16 v[32:35], a[24:27], a[168:171], v[32:35]
v_mfma_f32_16x16x32_bf16 v[32:35], a[28:31], a[172:175], v[32:35]
v_cvt_pk_bf16_f32 v52, v20, v21
v_cvt_pk_bf16_f32 v53, v22, v23
v_mfma_f32_16x16x32_bf16 v[36:39], a[16:19], a[176:179], v[84:87]
buffer_load_dwordx4 v3, s[88:91], s32 offen offset:2048 lds
v_mfma_f32_16x16x32_bf16 v[36:39], a[20:23], a[180:183], v[36:39]
v_mfma_f32_16x16x32_bf16 v[36:39], a[24:27], a[184:187], v[36:39]
v_exp_f32 v24, v24
v_mfma_f32_16x16x32_bf16 v[36:39], a[28:31], a[188:191], v[36:39]
v_mfma_f32_16x16x32_bf16 v[40:43], a[16:19], a[192:195], v[88:91]
v_exp_f32 v25, v25
v_mfma_f32_16x16x32_bf16 v[40:43], a[20:23], a[196:199], v[40:43]
v_mfma_f32_16x16x32_bf16 v[40:43], a[24:27], a[200:203], v[40:43]
v_exp_f32 v26, v26
v_mfma_f32_16x16x32_bf16 v[40:43], a[28:31], a[204:207], v[40:43]
v_mfma_f32_16x16x32_bf16 v[44:47], a[16:19], a[208:211], v[92:95]
buffer_load_dwordx4 v3, s[88:91], s32 offen offset:3072 lds
v_mfma_f32_16x16x32_bf16 v[44:47], a[20:23], a[212:215], v[44:47]
v_exp_f32 v27, v27
v_mfma_f32_16x16x32_bf16 v[44:47], a[24:27], a[216:219], v[44:47]
v_mfma_f32_16x16x32_bf16 v[44:47], a[28:31], a[220:223], v[44:47]
v_cvt_pk_bf16_f32 v56, v24, v25
v_cvt_pk_bf16_f32 v57, v26, v27
s_waitcnt lgkmcnt(0)
ds_read_b128 a[0:3], v1 offset:16384
ds_read_b128 a[4:7], v1 offset:17408
ds_read_b128 a[8:11], v1 offset:18432
ds_read_b128 a[12:15], v1 offset:19456
ds_read_b128 a[16:19], v1 offset:20480
ds_read_b128 a[20:23], v1 offset:21504
ds_read_b128 a[24:27], v1 offset:22528
ds_read_b128 a[28:31], v1 offset:23552
s_waitcnt lgkmcnt(7)
v_mfma_f32_16x16x32_bf16 v[16:19], a[0:3], a[160:163], v[80:83]
ds_read_b128 a[32:35], v1 offset:24576
v_exp_f32 v28, v28
s_waitcnt lgkmcnt(7)
v_mfma_f32_16x16x32_bf16 v[16:19], a[4:7], a[164:167], v[16:19]
v_exp_f32 v29, v29
s_waitcnt lgkmcnt(6)
v_mfma_f32_16x16x32_bf16 v[16:19], a[8:11], a[168:171], v[16:19]
v_exp_f32 v30, v30
s_waitcnt lgkmcnt(5)
v_mfma_f32_16x16x32_bf16 v[16:19], a[12:15], a[172:175], v[16:19]
s_add_u32 m0, s18, 0x11000
ds_read_b128 a[36:39], v1 offset:25600
v_exp_f32 v31, v31
v_mfma_f32_16x16x32_bf16 v[20:23], a[0:3], a[176:179], v[84:87]
buffer_load_dwordx4 v3, s[88:91], s11 offen offset:0 lds
v_mfma_f32_16x16x32_bf16 v[20:23], a[4:7], a[180:183], v[20:23]
v_cvt_pk_bf16_f32 v60, v28, v29
v_cvt_pk_bf16_f32 v61, v30, v31
v_mfma_f32_16x16x32_bf16 v[20:23], a[8:11], a[184:187], v[20:23]
v_exp_f32 v32, v32
v_mfma_f32_16x16x32_bf16 v[20:23], a[12:15], a[188:191], v[20:23]
ds_read_b128 a[40:43], v1 offset:26624
v_exp_f32 v33, v33
v_mfma_f32_16x16x32_bf16 v[24:27], a[0:3], a[192:195], v[88:91]
v_exp_f32 v34, v34
v_mfma_f32_16x16x32_bf16 v[24:27], a[4:7], a[196:199], v[24:27]
v_exp_f32 v35, v35
v_mfma_f32_16x16x32_bf16 v[24:27], a[8:11], a[200:203], v[24:27]
ds_read_b128 a[44:47], v1 offset:27648
v_cvt_pk_bf16_f32 v50, v32, v33
v_cvt_pk_bf16_f32 v51, v34, v35
v_mfma_f32_16x16x32_bf16 v[24:27], a[12:15], a[204:207], v[24:27]
v_exp_f32 v36, v36
v_mfma_f32_16x16x32_bf16 v[28:31], a[0:3], a[208:211], v[92:95]
buffer_load_dwordx4 v3, s[88:91], s11 offen offset:1024 lds
v_mfma_f32_16x16x32_bf16 v[28:31], a[4:7], a[212:215], v[28:31]
v_exp_f32 v37, v37
v_mfma_f32_16x16x32_bf16 v[28:31], a[8:11], a[216:219], v[28:31]
ds_read_b128 a[48:51], v1 offset:28672
v_exp_f32 v38, v38
v_mfma_f32_16x16x32_bf16 v[28:31], a[12:15], a[220:223], v[28:31]
v_exp_f32 v39, v39
s_waitcnt lgkmcnt(8)
v_mfma_f32_16x16x32_bf16 v[32:35], a[16:19], a[160:163], v[80:83]
v_cvt_pk_bf16_f32 v54, v36, v37
v_cvt_pk_bf16_f32 v55, v38, v39
s_waitcnt lgkmcnt(7)
v_mfma_f32_16x16x32_bf16 v[32:35], a[20:23], a[164:167], v[32:35]
ds_read_b128 a[52:55], v1 offset:29696
v_exp_f32 v40, v40
s_waitcnt lgkmcnt(7)
v_mfma_f32_16x16x32_bf16 v[32:35], a[24:27], a[168:171], v[32:35]
v_exp_f32 v41, v41
s_waitcnt lgkmcnt(6)
v_mfma_f32_16x16x32_bf16 v[32:35], a[28:31], a[172:175], v[32:35]
v_exp_f32 v42, v42
v_mfma_f32_16x16x32_bf16 v[36:39], a[16:19], a[176:179], v[84:87]
buffer_load_dwordx4 v3, s[88:91], s11 offen offset:2048 lds
v_mfma_f32_16x16x32_bf16 v[36:39], a[20:23], a[180:183], v[36:39]
ds_read_b128 a[56:59], v1 offset:30720
v_exp_f32 v43, v43
v_mfma_f32_16x16x32_bf16 v[36:39], a[24:27], a[184:187], v[36:39]
v_cvt_pk_bf16_f32 v58, v40, v41
v_cvt_pk_bf16_f32 v59, v42, v43
v_mfma_f32_16x16x32_bf16 v[36:39], a[28:31], a[188:191], v[36:39]
v_exp_f32 v44, v44
v_mfma_f32_16x16x32_bf16 v[40:43], a[16:19], a[192:195], v[88:91]
ds_read_b128 a[60:63], v1 offset:31744
v_exp_f32 v45, v45
v_mfma_f32_16x16x32_bf16 v[40:43], a[20:23], a[196:199], v[40:43]
v_exp_f32 v46, v46
v_mfma_f32_16x16x32_bf16 v[40:43], a[24:27], a[200:203], v[40:43]
v_exp_f32 v47, v47
v_mfma_f32_16x16x32_bf16 v[40:43], a[28:31], a[204:207], v[40:43]
v_cvt_pk_bf16_f32 v62, v44, v45
v_cvt_pk_bf16_f32 v63, v46, v47
v_mfma_f32_16x16x32_bf16 v[44:47], a[16:19], a[208:211], v[92:95]
buffer_load_dwordx4 v3, s[88:91], s11 offen offset:3072 lds
v_mfma_f32_16x16x32_bf16 v[44:47], a[20:23], a[212:215], v[44:47]
v_exp_f32 v16, v16
v_mfma_f32_16x16x32_bf16 v[44:47], a[24:27], a[216:219], v[44:47]
v_exp_f32 v17, v17
v_mfma_f32_16x16x32_bf16 v[44:47], a[28:31], a[220:223], v[44:47]
v_exp_f32 v18, v18
s_nop 7
v_exp_f32 v19, v19
s_nop 0
v_cvt_pk_bf16_f32 v64, v16, v17
v_cvt_pk_bf16_f32 v65, v18, v19
s_nop 0
v_exp_f32 v20, v20
s_nop 0
v_exp_f32 v21, v21
s_nop 0
v_exp_f32 v22, v22
s_nop 0
v_exp_f32 v23, v23
s_nop 0
v_cvt_pk_bf16_f32 v68, v20, v21
v_cvt_pk_bf16_f32 v69, v22, v23
s_nop 0
v_exp_f32 v24, v24
s_nop 0
v_exp_f32 v25, v25
s_nop 0
v_exp_f32 v26, v26
s_nop 0
v_exp_f32 v27, v27
s_nop 0
v_cvt_pk_bf16_f32 v72, v24, v25
v_cvt_pk_bf16_f32 v73, v26, v27
s_nop 0
s_add_u32 s32, s32, 0x8000
s_add_u32 s11, s11, 0x8000
s_xor_b32 s18, s18, 0x8000
v_xor_b32 v1, 0x8000, v1
s_branch L_att_dodd
L_att_deven:
s_waitcnt vmcnt(16) lgkmcnt(0)
s_barrier
v_mfma_f32_16x16x32_bf16 v[128:131], a[32:35], v[48:51], v[128:131]
ds_read_b128 a[0:3], v1 offset:0
v_exp_f32 v28, v28
v_mfma_f32_16x16x32_bf16 v[160:163], a[32:35], v[52:55], v[160:163]
v_mfma_f32_16x16x32_bf16 v[192:195], a[32:35], v[56:59], v[192:195]
v_exp_f32 v29, v29
v_mfma_f32_16x16x32_bf16 v[224:227], a[32:35], v[60:63], v[224:227]
ds_read_b128 a[4:7], v1 offset:1024
v_mfma_f32_16x16x32_bf16 v[228:231], a[36:39], v[60:63], v[228:231]
v_exp_f32 v30, v30
v_mfma_f32_16x16x32_bf16 v[196:199], a[36:39], v[56:59], v[196:199]
v_exp_f32 v31, v31
v_mfma_f32_16x16x32_bf16 v[164:167], a[36:39], v[52:55], v[164:167]
v_mfma_f32_16x16x32_bf16 v[132:135], a[36:39], v[48:51], v[132:135]
s_add_u32 m0, s18, 0x10000
ds_read_b128 a[8:11], v1 offset:2048
v_cvt_pk_bf16_f32 v76, v28, v29
v_cvt_pk_bf16_f32 v77, v30, v31
v_mfma_f32_16x16x32_bf16 v[136:139], a[40:43], v[48:51], v[136:139]
buffer_load_dwordx4 v3, s[88:91], s32 offen offset:0 lds
v_mfma_f32_16x16x32_bf16 v[168:171], a[40:43], v[52:55], v[168:171]
v_exp_f32 v32, v32
v_mfma_f32_16x16x32_bf16 v[200:203], a[40:43], v[56:59], v[200:203]
v_mfma_f32_16x16x32_bf16 v[232:235], a[40:43], v[60:63], v[232:235]
v_exp_f32 v33, v33
v_mfma_f32_16x16x32_bf16 v[236:239], a[44:47], v[60:63], v[236:239]
ds_read_b128 a[12:15], v1 offset:3072
v_mfma_f32_16x16x32_bf16 v[204:207], a[44:47], v[56:59], v[204:207]
v_exp_f32 v34, v34
v_mfma_f32_16x16x32_bf16 v[172:175], a[44:47], v[52:55], v[172:175]
v_exp_f32 v35, v35
v_mfma_f32_16x16x32_bf16 v[140:143], a[44:47], v[48:51], v[140:143]
v_mfma_f32_16x16x32_bf16 v[144:147], a[48:51], v[48:51], v[144:147]
ds_read_b128 a[16:19], v1 offset:4096
v_cvt_pk_bf16_f32 v66, v32, v33
v_cvt_pk_bf16_f32 v67, v34, v35
v_mfma_f32_16x16x32_bf16 v[176:179], a[48:51], v[52:55], v[176:179]
v_exp_f32 v36, v36
v_mfma_f32_16x16x32_bf16 v[208:211], a[48:51], v[56:59], v[208:211]
v_mfma_f32_16x16x32_bf16 v[240:243], a[48:51], v[60:63], v[240:243]
ds_read_b128 a[20:23], v1 offset:5120
v_exp_f32 v37, v37
v_mfma_f32_16x16x32_bf16 v[244:247], a[52:55], v[60:63], v[244:247]
v_mfma_f32_16x16x32_bf16 v[212:215], a[52:55], v[56:59], v[212:215]
v_exp_f32 v38, v38
v_mfma_f32_16x16x32_bf16 v[180:183], a[52:55], v[52:55], v[180:183]
v_exp_f32 v39, v39
v_mfma_f32_16x16x32_bf16 v[148:151], a[52:55], v[48:51], v[148:151]
ds_read_b128 a[24:27], v1 offset:6144
v_mfma_f32_16x16x32_bf16 v[152:155], a[56:59], v[48:51], v[152:155]
v_cvt_pk_bf16_f32 v70, v36, v37
v_cvt_pk_bf16_f32 v71, v38, v39
v_mfma_f32_16x16x32_bf16 v[184:187], a[56:59], v[52:55], v[184:187]
buffer_load_dwordx4 v3, s[88:91], s32 offen offset:1024 lds
v_mfma_f32_16x16x32_bf16 v[216:219], a[56:59], v[56:59], v[216:219]
v_exp_f32 v40, v40
v_mfma_f32_16x16x32_bf16 v[248:251], a[56:59], v[60:63], v[248:251]
v_mfma_f32_16x16x32_bf16 v[252:255], a[60:63], v[60:63], v[252:255]
ds_read_b128 a[28:31], v1 offset:7168
v_exp_f32 v41, v41
v_mfma_f32_16x16x32_bf16 v[220:223], a[60:63], v[56:59], v[220:223]
v_mfma_f32_16x16x32_bf16 v[188:191], a[60:63], v[52:55], v[188:191]
v_exp_f32 v42, v42
v_mfma_f32_16x16x32_bf16 v[156:159], a[60:63], v[48:51], v[156:159]
v_exp_f32 v43, v43
v_mfma_f32_16x16x32_bf16 a[224:227], a[240:243], v[48:51], a[224:227]
v_mfma_f32_16x16x32_bf16 a[228:231], a[240:243], v[52:55], a[228:231]
v_cvt_pk_bf16_f32 v74, v40, v41
v_cvt_pk_bf16_f32 v75, v42, v43
v_mfma_f32_16x16x32_bf16 a[232:235], a[240:243], v[56:59], a[232:235]
v_exp_f32 v44, v44
v_mfma_f32_16x16x32_bf16 a[236:239], a[240:243], v[60:63], a[236:239]
s_waitcnt lgkmcnt(7)
v_mfma_f32_16x16x32_bf16 v[16:19], a[0:3], a[160:163], v[80:83]
ds_read_b128 a[32:35], v1 offset:8192
v_exp_f32 v45, v45
s_waitcnt lgkmcnt(7)
v_mfma_f32_16x16x32_bf16 v[16:19], a[4:7], a[164:167], v[16:19]
s_waitcnt lgkmcnt(6)
v_mfma_f32_16x16x32_bf16 v[16:19], a[8:11], a[168:171], v[16:19]
v_exp_f32 v46, v46
s_waitcnt lgkmcnt(5)
v_mfma_f32_16x16x32_bf16 v[16:19], a[12:15], a[172:175], v[16:19]
ds_read_b128 a[36:39], v1 offset:9216
v_exp_f32 v47, v47
v_mfma_f32_16x16x32_bf16 v[20:23], a[0:3], a[176:179], v[84:87]
v_mfma_f32_16x16x32_bf16 v[20:23], a[4:7], a[180:183], v[20:23]
v_cvt_pk_bf16_f32 v78, v44, v45
v_cvt_pk_bf16_f32 v79, v46, v47
v_mfma_f32_16x16x32_bf16 v[20:23], a[8:11], a[184:187], v[20:23]
buffer_load_dwordx4 v3, s[88:91], s32 offen offset:2048 lds
v_mfma_f32_16x16x32_bf16 v[20:23], a[12:15], a[188:191], v[20:23]
ds_read_b128 a[40:43], v1 offset:10240
v_mfma_f32_16x16x32_bf16 v[24:27], a[0:3], a[192:195], v[88:91]
v_exp_f32 v16, v16
v_mfma_f32_16x16x32_bf16 v[24:27], a[4:7], a[196:199], v[24:27]
v_exp_f32 v17, v17
v_mfma_f32_16x16x32_bf16 v[24:27], a[8:11], a[200:203], v[24:27]
v_mfma_f32_16x16x32_bf16 v[24:27], a[12:15], a[204:207], v[24:27]
ds_read_b128 a[44:47], v1 offset:11264
v_exp_f32 v18, v18
v_mfma_f32_16x16x32_bf16 v[28:31], a[0:3], a[208:211], v[92:95]
v_exp_f32 v19, v19
v_mfma_f32_16x16x32_bf16 v[28:31], a[4:7], a[212:215], v[28:31]
v_mfma_f32_16x16x32_bf16 v[28:31], a[8:11], a[216:219], v[28:31]
ds_read_b128 a[48:51], v1 offset:12288
v_cvt_pk_bf16_f32 v48, v16, v17
v_cvt_pk_bf16_f32 v49, v18, v19
v_mfma_f32_16x16x32_bf16 v[28:31], a[12:15], a[220:223], v[28:31]
v_exp_f32 v20, v20
s_waitcnt lgkmcnt(8)
v_mfma_f32_16x16x32_bf16 v[32:35], a[16:19], a[160:163], v[80:83]
s_waitcnt lgkmcnt(7)
v_mfma_f32_16x16x32_bf16 v[32:35], a[20:23], a[164:167], v[32:35]
ds_read_b128 a[52:55], v1 offset:13312
v_exp_f32 v21, v21
s_waitcnt lgkmcnt(7)
v_mfma_f32_16x16x32_bf16 v[32:35], a[24:27], a[168:171], v[32:35]
s_waitcnt lgkmcnt(6)
v_mfma_f32_16x16x32_bf16 v[32:35], a[28:31], a[172:175], v[32:35]
v_exp_f32 v22, v22
v_mfma_f32_16x16x32_bf16 v[36:39], a[16:19], a[176:179], v[84:87]
v_exp_f32 v23, v23
v_mfma_f32_16x16x32_bf16 v[36:39], a[20:23], a[180:183], v[36:39]
ds_read_b128 a[56:59], v1 offset:14336
v_mfma_f32_16x16x32_bf16 v[36:39], a[24:27], a[184:187], v[36:39]
v_cvt_pk_bf16_f32 v52, v20, v21
v_cvt_pk_bf16_f32 v53, v22, v23
v_mfma_f32_16x16x32_bf16 v[36:39], a[28:31], a[188:191], v[36:39]
buffer_load_dwordx4 v3, s[88:91], s32 offen offset:3072 lds
v_mfma_f32_16x16x32_bf16 v[40:43], a[16:19], a[192:195], v[88:91]
v_exp_f32 v24, v24
v_mfma_f32_16x16x32_bf16 v[40:43], a[20:23], a[196:199], v[40:43]
ds_read_b128 a[60:63], v1 offset:15360
v_mfma_f32_16x16x32_bf16 v[40:43], a[24:27], a[200:203], v[40:43]
v_exp_f32 v25, v25
v_mfma_f32_16x16x32_bf16 v[40:43], a[28:31], a[204:207], v[40:43]
v_mfma_f32_16x16x32_bf16 v[44:47], a[16:19], a[208:211], v[92:95]
v_exp_f32 v26, v26
v_mfma_f32_16x16x32_bf16 v[44:47], a[20:23], a[212:215], v[44:47]
v_exp_f32 v27, v27
v_mfma_f32_16x16x32_bf16 v[44:47], a[24:27], a[216:219], v[44:47]
v_mfma_f32_16x16x32_bf16 v[44:47], a[28:31], a[220:223], v[44:47]
v_cvt_pk_bf16_f32 v56, v24, v25
v_cvt_pk_bf16_f32 v57, v26, v27
s_waitcnt lgkmcnt(0)
v_mfma_f32_16x16x32_bf16 v[128:131], a[32:35], v[64:67], v[128:131]
ds_read_b128 a[0:3], v1 offset:16384
v_exp_f32 v28, v28
v_mfma_f32_16x16x32_bf16 v[160:163], a[32:35], v[68:71], v[160:163]
v_mfma_f32_16x16x32_bf16 v[192:195], a[32:35], v[72:75], v[192:195]
v_exp_f32 v29, v29
v_mfma_f32_16x16x32_bf16 v[224:227], a[32:35], v[76:79], v[224:227]
ds_read_b128 a[4:7], v1 offset:17408
v_mfma_f32_16x16x32_bf16 v[228:231], a[36:39], v[76:79], v[228:231]
v_exp_f32 v30, v30
v_mfma_f32_16x16x32_bf16 v[196:199], a[36:39], v[72:75], v[196:199]
v_exp_f32 v31, v31
v_mfma_f32_16x16x32_bf16 v[164:167], a[36:39], v[68:71], v[164:167]
v_mfma_f32_16x16x32_bf16 v[132:135], a[36:39], v[64:67], v[132:135]
s_add_u32 m0, s18, 0x11000
ds_read_b128 a[8:11], v1 offset:18432
v_cvt_pk_bf16_f32 v60, v28, v29
v_cvt_pk_bf16_f32 v61, v30, v31
v_mfma_f32_16x16x32_bf16 v[136:139], a[40:43], v[64:67], v[136:139]
buffer_load_dwordx4 v3, s[88:91], s11 offen offset:0 lds
v_mfma_f32_16x16x32_bf16 v[168:171], a[40:43], v[68:71], v[168:171]
v_exp_f32 v32, v32
v_mfma_f32_16x16x32_bf16 v[200:203], a[40:43], v[72:75], v[200:203]
v_mfma_f32_16x16x32_bf16 v[232:235], a[40:43], v[76:79], v[232:235]
v_exp_f32 v33, v33
v_mfma_f32_16x16x32_bf16 v[236:239], a[44:47], v[76:79], v[236:239]
ds_read_b128 a[12:15], v1 offset:19456
v_mfma_f32_16x16x32_bf16 v[204:207], a[44:47], v[72:75], v[204:207]
v_exp_f32 v34, v34
v_mfma_f32_16x16x32_bf16 v[172:175], a[44:47], v[68:71], v[172:175]
v_exp_f32 v35, v35
v_mfma_f32_16x16x32_bf16 v[140:143], a[44:47], v[64:67], v[140:143]
v_mfma_f32_16x16x32_bf16 v[144:147], a[48:51], v[64:67], v[144:147]
ds_read_b128 a[16:19], v1 offset:20480
v_cvt_pk_bf16_f32 v50, v32, v33
v_cvt_pk_bf16_f32 v51, v34, v35
v_mfma_f32_16x16x32_bf16 v[176:179], a[48:51], v[68:71], v[176:179]
v_exp_f32 v36, v36
v_mfma_f32_16x16x32_bf16 v[208:211], a[48:51], v[72:75], v[208:211]
v_mfma_f32_16x16x32_bf16 v[240:243], a[48:51], v[76:79], v[240:243]
ds_read_b128 a[20:23], v1 offset:21504
v_exp_f32 v37, v37
v_mfma_f32_16x16x32_bf16 v[244:247], a[52:55], v[76:79], v[244:247]
v_mfma_f32_16x16x32_bf16 v[212:215], a[52:55], v[72:75], v[212:215]
v_exp_f32 v38, v38
v_mfma_f32_16x16x32_bf16 v[180:183], a[52:55], v[68:71], v[180:183]
v_exp_f32 v39, v39
v_mfma_f32_16x16x32_bf16 v[148:151], a[52:55], v[64:67], v[148:151]
ds_read_b128 a[24:27], v1 offset:22528
v_mfma_f32_16x16x32_bf16 v[152:155], a[56:59], v[64:67], v[152:155]
v_cvt_pk_bf16_f32 v54, v36, v37
v_cvt_pk_bf16_f32 v55, v38, v39
v_mfma_f32_16x16x32_bf16 v[184:187], a[56:59], v[68:71], v[184:187]
buffer_load_dwordx4 v3, s[88:91], s11 offen offset:1024 lds
v_mfma_f32_16x16x32_bf16 v[216:219], a[56:59], v[72:75], v[216:219]
v_exp_f32 v40, v40
v_mfma_f32_16x16x32_bf16 v[248:251], a[56:59], v[76:79], v[248:251]
v_mfma_f32_16x16x32_bf16 v[252:255], a[60:63], v[76:79], v[252:255]
ds_read_b128 a[28:31], v1 offset:23552
v_exp_f32 v41, v41
v_mfma_f32_16x16x32_bf16 v[220:223], a[60:63], v[72:75], v[220:223]
v_mfma_f32_16x16x32_bf16 v[188:191], a[60:63], v[68:71], v[188:191]
v_exp_f32 v42, v42
v_mfma_f32_16x16x32_bf16 v[156:159], a[60:63], v[64:67], v[156:159]
v_exp_f32 v43, v43
v_mfma_f32_16x16x32_bf16 a[224:227], a[240:243], v[64:67], a[224:227]
v_mfma_f32_16x16x32_bf16 a[228:231], a[240:243], v[68:71], a[228:231]
v_cvt_pk_bf16_f32 v58, v40, v41
v_cvt_pk_bf16_f32 v59, v42, v43
v_mfma_f32_16x16x32_bf16 a[232:235], a[240:243], v[72:75], a[232:235]
v_exp_f32 v44, v44
v_mfma_f32_16x16x32_bf16 a[236:239], a[240:243], v[76:79], a[236:239]
s_waitcnt lgkmcnt(7)
v_mfma_f32_16x16x32_bf16 v[16:19], a[0:3], a[160:163], v[80:83]
ds_read_b128 a[32:35], v1 offset:24576
v_exp_f32 v45, v45
s_waitcnt lgkmcnt(7)
v_mfma_f32_16x16x32_bf16 v[16:19], a[4:7], a[164:167], v[16:19]
s_waitcnt lgkmcnt(6)
v_mfma_f32_16x16x32_bf16 v[16:19], a[8:11], a[168:171], v[16:19]
v_exp_f32 v46, v46
s_waitcnt lgkmcnt(5)
v_mfma_f32_16x16x32_bf16 v[16:19], a[12:15], a[172:175], v[16:19]
ds_read_b128 a[36:39], v1 offset:25600
v_exp_f32 v47, v47
v_mfma_f32_16x16x32_bf16 v[20:23], a[0:3], a[176:179], v[84:87]
v_mfma_f32_16x16x32_bf16 v[20:23], a[4:7], a[180:183], v[20:23]
v_cvt_pk_bf16_f32 v62, v44, v45
v_cvt_pk_bf16_f32 v63, v46, v47
v_mfma_f32_16x16x32_bf16 v[20:23], a[8:11], a[184:187], v[20:23]
buffer_load_dwordx4 v3, s[88:91], s11 offen offset:2048 lds
v_mfma_f32_16x16x32_bf16 v[20:23], a[12:15], a[188:191], v[20:23]
ds_read_b128 a[40:43], v1 offset:26624
v_mfma_f32_16x16x32_bf16 v[24:27], a[0:3], a[192:195], v[88:91]
v_exp_f32 v16, v16
v_mfma_f32_16x16x32_bf16 v[24:27], a[4:7], a[196:199], v[24:27]
v_exp_f32 v17, v17
v_mfma_f32_16x16x32_bf16 v[24:27], a[8:11], a[200:203], v[24:27]
v_mfma_f32_16x16x32_bf16 v[24:27], a[12:15], a[204:207], v[24:27]
ds_read_b128 a[44:47], v1 offset:27648
v_exp_f32 v18, v18
v_mfma_f32_16x16x32_bf16 v[28:31], a[0:3], a[208:211], v[92:95]
v_exp_f32 v19, v19
v_mfma_f32_16x16x32_bf16 v[28:31], a[4:7], a[212:215], v[28:31]
v_mfma_f32_16x16x32_bf16 v[28:31], a[8:11], a[216:219], v[28:31]
ds_read_b128 a[48:51], v1 offset:28672
v_cvt_pk_bf16_f32 v64, v16, v17
v_cvt_pk_bf16_f32 v65, v18, v19
v_mfma_f32_16x16x32_bf16 v[28:31], a[12:15], a[220:223], v[28:31]
v_exp_f32 v20, v20
s_waitcnt lgkmcnt(8)
v_mfma_f32_16x16x32_bf16 v[32:35], a[16:19], a[160:163], v[80:83]
s_waitcnt lgkmcnt(7)
v_mfma_f32_16x16x32_bf16 v[32:35], a[20:23], a[164:167], v[32:35]
ds_read_b128 a[52:55], v1 offset:29696
v_exp_f32 v21, v21
s_waitcnt lgkmcnt(7)
v_mfma_f32_16x16x32_bf16 v[32:35], a[24:27], a[168:171], v[32:35]
s_waitcnt lgkmcnt(6)
v_mfma_f32_16x16x32_bf16 v[32:35], a[28:31], a[172:175], v[32:35]
v_exp_f32 v22, v22
v_mfma_f32_16x16x32_bf16 v[36:39], a[16:19], a[176:179], v[84:87]
v_exp_f32 v23, v23
v_mfma_f32_16x16x32_bf16 v[36:39], a[20:23], a[180:183], v[36:39]
ds_read_b128 a[56:59], v1 offset:30720
v_mfma_f32_16x16x32_bf16 v[36:39], a[24:27], a[184:187], v[36:39]
v_cvt_pk_bf16_f32 v68, v20, v21
v_cvt_pk_bf16_f32 v69, v22, v23
v_mfma_f32_16x16x32_bf16 v[36:39], a[28:31], a[188:191], v[36:39]
buffer_load_dwordx4 v3, s[88:91], s11 offen offset:3072 lds
v_mfma_f32_16x16x32_bf16 v[40:43], a[16:19], a[192:195], v[88:91]
v_exp_f32 v24, v24
v_mfma_f32_16x16x32_bf16 v[40:43], a[20:23], a[196:199], v[40:43]
ds_read_b128 a[60:63], v1 offset:31744
v_mfma_f32_16x16x32_bf16 v[40:43], a[24:27], a[200:203], v[40:43]
v_exp_f32 v25, v25
v_mfma_f32_16x16x32_bf16 v[40:43], a[28:31], a[204:207], v[40:43]
v_mfma_f32_16x16x32_bf16 v[44:47], a[16:19], a[208:211], v[92:95]
v_exp_f32 v26, v26
v_mfma_f32_16x16x32_bf16 v[44:47], a[20:23], a[212:215], v[44:47]
v_exp_f32 v27, v27
v_mfma_f32_16x16x32_bf16 v[44:47], a[24:27], a[216:219], v[44:47]
v_mfma_f32_16x16x32_bf16 v[44:47], a[28:31], a[220:223], v[44:47]
v_cvt_pk_bf16_f32 v72, v24, v25
v_cvt_pk_bf16_f32 v73, v26, v27
s_add_u32 s32, s32, 0x8000
s_add_u32 s11, s11, 0x8000
s_xor_b32 s18, s18, 0x8000
v_xor_b32 v1, 0x8000, v1
L_att_dodd:
s_waitcnt vmcnt(16) lgkmcnt(0)
s_barrier
v_mfma_f32_16x16x32_bf16 v[128:131], a[32:35], v[48:51], v[128:131]
ds_read_b128 a[0:3], v2 offset:0
v_exp_f32 v28, v28
v_mfma_f32_16x16x32_bf16 v[160:163], a[32:35], v[52:55], v[160:163]
v_mfma_f32_16x16x32_bf16 v[192:195], a[32:35], v[56:59], v[192:195]
v_exp_f32 v29, v29
v_mfma_f32_16x16x32_bf16 v[224:227], a[32:35], v[60:63], v[224:227]
ds_read_b128 a[4:7], v2 offset:1024
v_mfma_f32_16x16x32_bf16 v[228:231], a[36:39], v[60:63], v[228:231]
v_exp_f32 v30, v30
v_mfma_f32_16x16x32_bf16 v[196:199], a[36:39], v[56:59], v[196:199]
v_exp_f32 v31, v31
v_mfma_f32_16x16x32_bf16 v[164:167], a[36:39], v[52:55], v[164:167]
v_mfma_f32_16x16x32_bf16 v[132:135], a[36:39], v[48:51], v[132:135]
s_add_u32 m0, s18, 0x0
ds_read_b128 a[8:11], v2 offset:2048
v_cvt_pk_bf16_f32 v76, v28, v29
v_cvt_pk_bf16_f32 v77, v30, v31
v_mfma_f32_16x16x32_bf16 v[136:139], a[40:43], v[48:51], v[136:139]
buffer_load_dwordx4 v3, s[88:91], s32 offen offset:0 lds
v_mfma_f32_16x16x32_bf16 v[168:171], a[40:43], v[52:55], v[168:171]
v_exp_f32 v32, v32
v_mfma_f32_16x16x32_bf16 v[200:203], a[40:43], v[56:59], v[200:203]
v_mfma_f32_16x16x32_bf16 v[232:235], a[40:43], v[60:63], v[232:235]
v_exp_f32 v33, v33
v_mfma_f32_16x16x32_bf16 v[236:239], a[44:47], v[60:63], v[236:239]
ds_read_b128 a[12:15], v2 offset:3072
v_mfma_f32_16x16x32_bf16 v[204:207], a[44:47], v[56:59], v[204:207]
v_exp_f32 v34, v34
v_mfma_f32_16x16x32_bf16 v[172:175], a[44:47], v[52:55], v[172:175]
v_exp_f32 v35, v35
v_mfma_f32_16x16x32_bf16 v[140:143], a[44:47], v[48:51], v[140:143]
v_mfma_f32_16x16x32_bf16 v[144:147], a[48:51], v[48:51], v[144:147]
ds_read_b128 a[16:19], v2 offset:4096
v_cvt_pk_bf16_f32 v66, v32, v33
v_cvt_pk_bf16_f32 v67, v34, v35
v_mfma_f32_16x16x32_bf16 v[176:179], a[48:51], v[52:55], v[176:179]
v_exp_f32 v36, v36
v_mfma_f32_16x16x32_bf16 v[208:211], a[48:51], v[56:59], v[208:211]
v_mfma_f32_16x16x32_bf16 v[240:243], a[48:51], v[60:63], v[240:243]
ds_read_b128 a[20:23], v2 offset:5120
v_exp_f32 v37, v37
v_mfma_f32_16x16x32_bf16 v[244:247], a[52:55], v[60:63], v[244:247]
v_mfma_f32_16x16x32_bf16 v[212:215], a[52:55], v[56:59], v[212:215]
v_exp_f32 v38, v38
v_mfma_f32_16x16x32_bf16 v[180:183], a[52:55], v[52:55], v[180:183]
v_exp_f32 v39, v39
v_mfma_f32_16x16x32_bf16 v[148:151], a[52:55], v[48:51], v[148:151]
ds_read_b128 a[24:27], v2 offset:6144
v_mfma_f32_16x16x32_bf16 v[152:155], a[56:59], v[48:51], v[152:155]
v_cvt_pk_bf16_f32 v70, v36, v37
v_cvt_pk_bf16_f32 v71, v38, v39
v_mfma_f32_16x16x32_bf16 v[184:187], a[56:59], v[52:55], v[184:187]
buffer_load_dwordx4 v3, s[88:91], s32 offen offset:1024 lds
v_mfma_f32_16x16x32_bf16 v[216:219], a[56:59], v[56:59], v[216:219]
v_exp_f32 v40, v40
v_mfma_f32_16x16x32_bf16 v[248:251], a[56:59], v[60:63], v[248:251]
v_mfma_f32_16x16x32_bf16 v[252:255], a[60:63], v[60:63], v[252:255]
ds_read_b128 a[28:31], v2 offset:7168
v_exp_f32 v41, v41
v_mfma_f32_16x16x32_bf16 v[220:223], a[60:63], v[56:59], v[220:223]
v_mfma_f32_16x16x32_bf16 v[188:191], a[60:63], v[52:55], v[188:191]
v_exp_f32 v42, v42
v_mfma_f32_16x16x32_bf16 v[156:159], a[60:63], v[48:51], v[156:159]
v_exp_f32 v43, v43
v_mfma_f32_16x16x32_bf16 a[224:227], a[240:243], v[48:51], a[224:227]
v_mfma_f32_16x16x32_bf16 a[228:231], a[240:243], v[52:55], a[228:231]
v_cvt_pk_bf16_f32 v74, v40, v41
v_cvt_pk_bf16_f32 v75, v42, v43
v_mfma_f32_16x16x32_bf16 a[232:235], a[240:243], v[56:59], a[232:235]
v_exp_f32 v44, v44
v_mfma_f32_16x16x32_bf16 a[236:239], a[240:243], v[60:63], a[236:239]
s_waitcnt lgkmcnt(7)
v_mfma_f32_16x16x32_bf16 v[16:19], a[0:3], a[160:163], v[80:83]
ds_read_b128 a[32:35], v2 offset:8192
v_exp_f32 v45, v45
s_waitcnt lgkmcnt(7)
v_mfma_f32_16x16x32_bf16 v[16:19], a[4:7], a[164:167], v[16:19]
s_waitcnt lgkmcnt(6)
v_mfma_f32_16x16x32_bf16 v[16:19], a[8:11], a[168:171], v[16:19]
v_exp_f32 v46, v46
s_waitcnt lgkmcnt(5)
v_mfma_f32_16x16x32_bf16 v[16:19], a[12:15], a[172:175], v[16:19]
ds_read_b128 a[36:39], v2 offset:9216
v_exp_f32 v47, v47
v_mfma_f32_16x16x32_bf16 v[20:23], a[0:3], a[176:179], v[84:87]
v_mfma_f32_16x16x32_bf16 v[20:23], a[4:7], a[180:183], v[20:23]
v_cvt_pk_bf16_f32 v78, v44, v45
v_cvt_pk_bf16_f32 v79, v46, v47
v_mfma_f32_16x16x32_bf16 v[20:23], a[8:11], a[184:187], v[20:23]
buffer_load_dwordx4 v3, s[88:91], s32 offen offset:2048 lds
v_mfma_f32_16x16x32_bf16 v[20:23], a[12:15], a[188:191], v[20:23]
ds_read_b128 a[40:43], v2 offset:10240
v_mfma_f32_16x16x32_bf16 v[24:27], a[0:3], a[192:195], v[88:91]
v_exp_f32 v16, v16
v_mfma_f32_16x16x32_bf16 v[24:27], a[4:7], a[196:199], v[24:27]
v_exp_f32 v17, v17
v_mfma_f32_16x16x32_bf16 v[24:27], a[8:11], a[200:203], v[24:27]
v_mfma_f32_16x16x32_bf16 v[24:27], a[12:15], a[204:207], v[24:27]
ds_read_b128 a[44:47], v2 offset:11264
v_exp_f32 v18, v18
v_mfma_f32_16x16x32_bf16 v[28:31], a[0:3], a[208:211], v[92:95]
v_exp_f32 v19, v19
v_mfma_f32_16x16x32_bf16 v[28:31], a[4:7], a[212:215], v[28:31]
v_mfma_f32_16x16x32_bf16 v[28:31], a[8:11], a[216:219], v[28:31]
ds_read_b128 a[48:51], v2 offset:12288
v_cvt_pk_bf16_f32 v48, v16, v17
v_cvt_pk_bf16_f32 v49, v18, v19
v_mfma_f32_16x16x32_bf16 v[28:31], a[12:15], a[220:223], v[28:31]
v_exp_f32 v20, v20
s_waitcnt lgkmcnt(8)
v_mfma_f32_16x16x32_bf16 v[32:35], a[16:19], a[160:163], v[80:83]
s_waitcnt lgkmcnt(7)
v_mfma_f32_16x16x32_bf16 v[32:35], a[20:23], a[164:167], v[32:35]
ds_read_b128 a[52:55], v2 offset:13312
v_exp_f32 v21, v21
s_waitcnt lgkmcnt(7)
v_mfma_f32_16x16x32_bf16 v[32:35], a[24:27], a[168:171], v[32:35]
s_waitcnt lgkmcnt(6)
v_mfma_f32_16x16x32_bf16 v[32:35], a[28:31], a[172:175], v[32:35]
v_exp_f32 v22, v22
v_mfma_f32_16x16x32_bf16 v[36:39], a[16:19], a[176:179], v[84:87]
v_exp_f32 v23, v23
v_mfma_f32_16x16x32_bf16 v[36:39], a[20:23], a[180:183], v[36:39]
ds_read_b128 a[56:59], v2 offset:14336
v_mfma_f32_16x16x32_bf16 v[36:39], a[24:27], a[184:187], v[36:39]
v_cvt_pk_bf16_f32 v52, v20, v21
v_cvt_pk_bf16_f32 v53, v22, v23
v_mfma_f32_16x16x32_bf16 v[36:39], a[28:31], a[188:191], v[36:39]
buffer_load_dwordx4 v3, s[88:91], s32 offen offset:3072 lds
v_mfma_f32_16x16x32_bf16 v[40:43], a[16:19], a[192:195], v[88:91]
v_exp_f32 v24, v24
v_mfma_f32_16x16x32_bf16 v[40:43], a[20:23], a[196:199], v[40:43]
ds_read_b128 a[60:63], v2 offset:15360
v_mfma_f32_16x16x32_bf16 v[40:43], a[24:27], a[200:203], v[40:43]
v_exp_f32 v25, v25
v_mfma_f32_16x16x32_bf16 v[40:43], a[28:31], a[204:207], v[40:43]
v_mfma_f32_16x16x32_bf16 v[44:47], a[16:19], a[208:211], v[92:95]
v_exp_f32 v26, v26
v_mfma_f32_16x16x32_bf16 v[44:47], a[20:23], a[212:215], v[44:47]
v_exp_f32 v27, v27
v_mfma_f32_16x16x32_bf16 v[44:47], a[24:27], a[216:219], v[44:47]
v_mfma_f32_16x16x32_bf16 v[44:47], a[28:31], a[220:223], v[44:47]
v_cvt_pk_bf16_f32 v56, v24, v25
v_cvt_pk_bf16_f32 v57, v26, v27
s_waitcnt lgkmcnt(0)
v_mfma_f32_16x16x32_bf16 v[128:131], a[32:35], v[64:67], v[128:131]
ds_read_b128 a[0:3], v2 offset:16384
v_exp_f32 v28, v28
v_mfma_f32_16x16x32_bf16 v[160:163], a[32:35], v[68:71], v[160:163]
v_mfma_f32_16x16x32_bf16 v[192:195], a[32:35], v[72:75], v[192:195]
v_exp_f32 v29, v29
v_mfma_f32_16x16x32_bf16 v[224:227], a[32:35], v[76:79], v[224:227]
ds_read_b128 a[4:7], v2 offset:17408
v_mfma_f32_16x16x32_bf16 v[228:231], a[36:39], v[76:79], v[228:231]
v_exp_f32 v30, v30
v_mfma_f32_16x16x32_bf16 v[196:199], a[36:39], v[72:75], v[196:199]
v_exp_f32 v31, v31
v_mfma_f32_16x16x32_bf16 v[164:167], a[36:39], v[68:71], v[164:167]
v_mfma_f32_16x16x32_bf16 v[132:135], a[36:39], v[64:67], v[132:135]
s_add_u32 m0, s18, 0x1000
ds_read_b128 a[8:11], v2 offset:18432
v_cvt_pk_bf16_f32 v60, v28, v29
v_cvt_pk_bf16_f32 v61, v30, v31
v_mfma_f32_16x16x32_bf16 v[136:139], a[40:43], v[64:67], v[136:139]
buffer_load_dwordx4 v3, s[88:91], s11 offen offset:0 lds
v_mfma_f32_16x16x32_bf16 v[168:171], a[40:43], v[68:71], v[168:171]
v_exp_f32 v32, v32
v_mfma_f32_16x16x32_bf16 v[200:203], a[40:43], v[72:75], v[200:203]
v_mfma_f32_16x16x32_bf16 v[232:235], a[40:43], v[76:79], v[232:235]
v_exp_f32 v33, v33
v_mfma_f32_16x16x32_bf16 v[236:239], a[44:47], v[76:79], v[236:239]
ds_read_b128 a[12:15], v2 offset:19456
v_mfma_f32_16x16x32_bf16 v[204:207], a[44:47], v[72:75], v[204:207]
v_exp_f32 v34, v34
v_mfma_f32_16x16x32_bf16 v[172:175], a[44:47], v[68:71], v[172:175]
v_exp_f32 v35, v35
v_mfma_f32_16x16x32_bf16 v[140:143], a[44:47], v[64:67], v[140:143]
v_mfma_f32_16x16x32_bf16 v[144:147], a[48:51], v[64:67], v[144:147]
ds_read_b128 a[16:19], v2 offset:20480
v_cvt_pk_bf16_f32 v50, v32, v33
v_cvt_pk_bf16_f32 v51, v34, v35
v_mfma_f32_16x16x32_bf16 v[176:179], a[48:51], v[68:71], v[176:179]
v_exp_f32 v36, v36
v_mfma_f32_16x16x32_bf16 v[208:211], a[48:51], v[72:75], v[208:211]
v_mfma_f32_16x16x32_bf16 v[240:243], a[48:51], v[76:79], v[240:243]
ds_read_b128 a[20:23], v2 offset:21504
v_exp_f32 v37, v37
v_mfma_f32_16x16x32_bf16 v[244:247], a[52:55], v[76:79], v[244:247]
v_mfma_f32_16x16x32_bf16 v[212:215], a[52:55], v[72:75], v[212:215]
v_exp_f32 v38, v38
v_mfma_f32_16x16x32_bf16 v[180:183], a[52:55], v[68:71], v[180:183]
v_exp_f32 v39, v39
v_mfma_f32_16x16x32_bf16 v[148:151], a[52:55], v[64:67], v[148:151]
ds_read_b128 a[24:27], v2 offset:22528
v_mfma_f32_16x16x32_bf16 v[152:155], a[56:59], v[64:67], v[152:155]
v_cvt_pk_bf16_f32 v54, v36, v37
v_cvt_pk_bf16_f32 v55, v38, v39
v_mfma_f32_16x16x32_bf16 v[184:187], a[56:59], v[68:71], v[184:187]
buffer_load_dwordx4 v3, s[88:91], s11 offen offset:1024 lds
v_mfma_f32_16x16x32_bf16 v[216:219], a[56:59], v[72:75], v[216:219]
v_exp_f32 v40, v40
v_mfma_f32_16x16x32_bf16 v[248:251], a[56:59], v[76:79], v[248:251]
v_mfma_f32_16x16x32_bf16 v[252:255], a[60:63], v[76:79], v[252:255]
ds_read_b128 a[28:31], v2 offset:23552
v_exp_f32 v41, v41
v_mfma_f32_16x16x32_bf16 v[220:223], a[60:63], v[72:75], v[220:223]
v_mfma_f32_16x16x32_bf16 v[188:191], a[60:63], v[68:71], v[188:191]
v_exp_f32 v42, v42
v_mfma_f32_16x16x32_bf16 v[156:159], a[60:63], v[64:67], v[156:159]
v_exp_f32 v43, v43
v_mfma_f32_16x16x32_bf16 a[224:227], a[240:243], v[64:67], a[224:227]
v_mfma_f32_16x16x32_bf16 a[228:231], a[240:243], v[68:71], a[228:231]
v_cvt_pk_bf16_f32 v58, v40, v41
v_cvt_pk_bf16_f32 v59, v42, v43
v_mfma_f32_16x16x32_bf16 a[232:235], a[240:243], v[72:75], a[232:235]
v_exp_f32 v44, v44
v_mfma_f32_16x16x32_bf16 a[236:239], a[240:243], v[76:79], a[236:239]
s_waitcnt lgkmcnt(7)
v_mfma_f32_16x16x32_bf16 v[16:19], a[0:3], a[160:163], v[80:83]
ds_read_b128 a[32:35], v2 offset:24576
v_exp_f32 v45, v45
s_waitcnt lgkmcnt(7)
v_mfma_f32_16x16x32_bf16 v[16:19], a[4:7], a[164:167], v[16:19]
s_waitcnt lgkmcnt(6)
v_mfma_f32_16x16x32_bf16 v[16:19], a[8:11], a[168:171], v[16:19]
v_exp_f32 v46, v46
s_waitcnt lgkmcnt(5)
v_mfma_f32_16x16x32_bf16 v[16:19], a[12:15], a[172:175], v[16:19]
ds_read_b128 a[36:39], v2 offset:25600
v_exp_f32 v47, v47
v_mfma_f32_16x16x32_bf16 v[20:23], a[0:3], a[176:179], v[84:87]
v_mfma_f32_16x16x32_bf16 v[20:23], a[4:7], a[180:183], v[20:23]
v_cvt_pk_bf16_f32 v62, v44, v45
v_cvt_pk_bf16_f32 v63, v46, v47
v_mfma_f32_16x16x32_bf16 v[20:23], a[8:11], a[184:187], v[20:23]
buffer_load_dwordx4 v3, s[88:91], s11 offen offset:2048 lds
v_mfma_f32_16x16x32_bf16 v[20:23], a[12:15], a[188:191], v[20:23]
ds_read_b128 a[40:43], v2 offset:26624
v_mfma_f32_16x16x32_bf16 v[24:27], a[0:3], a[192:195], v[88:91]
v_exp_f32 v16, v16
v_mfma_f32_16x16x32_bf16 v[24:27], a[4:7], a[196:199], v[24:27]
v_exp_f32 v17, v17
v_mfma_f32_16x16x32_bf16 v[24:27], a[8:11], a[200:203], v[24:27]
v_mfma_f32_16x16x32_bf16 v[24:27], a[12:15], a[204:207], v[24:27]
ds_read_b128 a[44:47], v2 offset:27648
v_exp_f32 v18, v18
v_mfma_f32_16x16x32_bf16 v[28:31], a[0:3], a[208:211], v[92:95]
v_exp_f32 v19, v19
v_mfma_f32_16x16x32_bf16 v[28:31], a[4:7], a[212:215], v[28:31]
v_mfma_f32_16x16x32_bf16 v[28:31], a[8:11], a[216:219], v[28:31]
ds_read_b128 a[48:51], v2 offset:28672
v_cvt_pk_bf16_f32 v64, v16, v17
v_cvt_pk_bf16_f32 v65, v18, v19
v_mfma_f32_16x16x32_bf16 v[28:31], a[12:15], a[220:223], v[28:31]
v_exp_f32 v20, v20
s_waitcnt lgkmcnt(8)
v_mfma_f32_16x16x32_bf16 v[32:35], a[16:19], a[160:163], v[80:83]
s_waitcnt lgkmcnt(7)
v_mfma_f32_16x16x32_bf16 v[32:35], a[20:23], a[164:167], v[32:35]
ds_read_b128 a[52:55], v2 offset:29696
v_exp_f32 v21, v21
s_waitcnt lgkmcnt(7)
v_mfma_f32_16x16x32_bf16 v[32:35], a[24:27], a[168:171], v[32:35]
s_waitcnt lgkmcnt(6)
v_mfma_f32_16x16x32_bf16 v[32:35], a[28:31], a[172:175], v[32:35]
v_exp_f32 v22, v22
v_mfma_f32_16x16x32_bf16 v[36:39], a[16:19], a[176:179], v[84:87]
v_exp_f32 v23, v23
v_mfma_f32_16x16x32_bf16 v[36:39], a[20:23], a[180:183], v[36:39]
ds_read_b128 a[56:59], v2 offset:30720
v_mfma_f32_16x16x32_bf16 v[36:39], a[24:27], a[184:187], v[36:39]
v_cvt_pk_bf16_f32 v68, v20, v21
v_cvt_pk_bf16_f32 v69, v22, v23
v_mfma_f32_16x16x32_bf16 v[36:39], a[28:31], a[188:191], v[36:39]
buffer_load_dwordx4 v3, s[88:91], s11 offen offset:3072 lds
v_mfma_f32_16x16x32_bf16 v[40:43], a[16:19], a[192:195], v[88:91]
v_exp_f32 v24, v24
v_mfma_f32_16x16x32_bf16 v[40:43], a[20:23], a[196:199], v[40:43]
ds_read_b128 a[60:63], v2 offset:31744
v_mfma_f32_16x16x32_bf16 v[40:43], a[24:27], a[200:203], v[40:43]
v_exp_f32 v25, v25
v_mfma_f32_16x16x32_bf16 v[40:43], a[28:31], a[204:207], v[40:43]
v_mfma_f32_16x16x32_bf16 v[44:47], a[16:19], a[208:211], v[92:95]
v_exp_f32 v26, v26
v_mfma_f32_16x16x32_bf16 v[44:47], a[20:23], a[212:215], v[44:47]
v_exp_f32 v27, v27
v_mfma_f32_16x16x32_bf16 v[44:47], a[24:27], a[216:219], v[44:47]
v_mfma_f32_16x16x32_bf16 v[44:47], a[28:31], a[220:223], v[44:47]
v_cvt_pk_bf16_f32 v72, v24, v25
v_cvt_pk_bf16_f32 v73, v26, v27
s_add_u32 s32, s32, 0x8000
s_add_u32 s11, s11, 0x8000
v_xor_b32 v2, 0x8000, v2
s_sub_u32 s15, s15, 1
s_cmp_lg_u32 s15, 0
s_cbranch_scc1 L_att_deven
s_cmp_ge_u32 s4, 2
s_cbranch_scc1 L_att_dl0_1
L_att_dl0_0:
s_waitcnt vmcnt(16) lgkmcnt(0)
s_barrier
v_mfma_f32_16x16x32_bf16 v[128:131], a[32:35], v[48:51], v[128:131]
ds_read_b128 a[0:3], v1 offset:0
v_exp_f32 v28, v28
v_mfma_f32_16x16x32_bf16 v[160:163], a[32:35], v[52:55], v[160:163]
v_mfma_f32_16x16x32_bf16 v[192:195], a[32:35], v[56:59], v[192:195]
v_exp_f32 v29, v29
v_mfma_f32_16x16x32_bf16 v[224:227], a[32:35], v[60:63], v[224:227]
ds_read_b128 a[4:7], v1 offset:1024
v_mfma_f32_16x16x32_bf16 v[228:231], a[36:39], v[60:63], v[228:231]
v_exp_f32 v30, v30
v_mfma_f32_16x16x32_bf16 v[196:199], a[36:39], v[56:59], v[196:199]
v_exp_f32 v31, v31
v_mfma_f32_16x16x32_bf16 v[164:167], a[36:39], v[52:55], v[164:167]
v_mfma_f32_16x16x32_bf16 v[132:135], a[36:39], v[48:51], v[132:135]
s_add_u32 m0, s18, 0x10000
ds_read_b128 a[8:11], v1 offset:2048
v_cvt_pk_bf16_f32 v76, v28, v29
v_cvt_pk_bf16_f32 v77, v30, v31
v_mfma_f32_16x16x32_bf16 v[136:139], a[40:43], v[48:51], v[136:139]
buffer_load_dwordx4 v3, s[88:91], s32 offen offset:0 lds
v_mfma_f32_16x16x32_bf16 v[168:171], a[40:43], v[52:55], v[168:171]
v_exp_f32 v32, v32
v_mfma_f32_16x16x32_bf16 v[200:203], a[40:43], v[56:59], v[200:203]
v_mfma_f32_16x16x32_bf16 v[232:235], a[40:43], v[60:63], v[232:235]
v_exp_f32 v33, v33
v_mfma_f32_16x16x32_bf16 v[236:239], a[44:47], v[60:63], v[236:239]
ds_read_b128 a[12:15], v1 offset:3072
v_mfma_f32_16x16x32_bf16 v[204:207], a[44:47], v[56:59], v[204:207]
v_exp_f32 v34, v34
v_mfma_f32_16x16x32_bf16 v[172:175], a[44:47], v[52:55], v[172:175]
v_exp_f32 v35, v35
v_mfma_f32_16x16x32_bf16 v[140:143], a[44:47], v[48:51], v[140:143]
v_mfma_f32_16x16x32_bf16 v[144:147], a[48:51], v[48:51], v[144:147]
ds_read_b128 a[16:19], v1 offset:4096
v_cvt_pk_bf16_f32 v66, v32, v33
v_cvt_pk_bf16_f32 v67, v34, v35
v_mfma_f32_16x16x32_bf16 v[176:179], a[48:51], v[52:55], v[176:179]
v_exp_f32 v36, v36
v_mfma_f32_16x16x32_bf16 v[208:211], a[48:51], v[56:59], v[208:211]
v_mfma_f32_16x16x32_bf16 v[240:243], a[48:51], v[60:63], v[240:243]
ds_read_b128 a[20:23], v1 offset:5120
v_exp_f32 v37, v37
v_mfma_f32_16x16x32_bf16 v[244:247], a[52:55], v[60:63], v[244:247]
v_mfma_f32_16x16x32_bf16 v[212:215], a[52:55], v[56:59], v[212:215]
v_exp_f32 v38, v38
v_mfma_f32_16x16x32_bf16 v[180:183], a[52:55], v[52:55], v[180:183]
v_exp_f32 v39, v39
v_mfma_f32_16x16x32_bf16 v[148:151], a[52:55], v[48:51], v[148:151]
ds_read_b128 a[24:27], v1 offset:6144
v_mfma_f32_16x16x32_bf16 v[152:155], a[56:59], v[48:51], v[152:155]
v_cvt_pk_bf16_f32 v70, v36, v37
v_cvt_pk_bf16_f32 v71, v38, v39
v_mfma_f32_16x16x32_bf16 v[184:187], a[56:59], v[52:55], v[184:187]
buffer_load_dwordx4 v3, s[88:91], s32 offen offset:1024 lds
v_mfma_f32_16x16x32_bf16 v[216:219], a[56:59], v[56:59], v[216:219]
v_exp_f32 v40, v40
v_mfma_f32_16x16x32_bf16 v[248:251], a[56:59], v[60:63], v[248:251]
v_mfma_f32_16x16x32_bf16 v[252:255], a[60:63], v[60:63], v[252:255]
ds_read_b128 a[28:31], v1 offset:7168
v_exp_f32 v41, v41
v_mfma_f32_16x16x32_bf16 v[220:223], a[60:63], v[56:59], v[220:223]
v_mfma_f32_16x16x32_bf16 v[188:191], a[60:63], v[52:55], v[188:191]
v_exp_f32 v42, v42
v_mfma_f32_16x16x32_bf16 v[156:159], a[60:63], v[48:51], v[156:159]
v_exp_f32 v43, v43
v_mfma_f32_16x16x32_bf16 a[224:227], a[240:243], v[48:51], a[224:227]
v_mfma_f32_16x16x32_bf16 a[228:231], a[240:243], v[52:55], a[228:231]
v_cvt_pk_bf16_f32 v74, v40, v41
v_cvt_pk_bf16_f32 v75, v42, v43
v_mfma_f32_16x16x32_bf16 a[232:235], a[240:243], v[56:59], a[232:235]
v_exp_f32 v44, v44
v_mfma_f32_16x16x32_bf16 a[236:239], a[240:243], v[60:63], a[236:239]
s_waitcnt lgkmcnt(7)
v_mfma_f32_16x16x32_bf16 v[16:19], a[0:3], a[160:163], v[96:99]
ds_read_b128 a[32:35], v1 offset:8192
v_exp_f32 v45, v45
s_waitcnt lgkmcnt(7)
v_mfma_f32_16x16x32_bf16 v[16:19], a[4:7], a[164:167], v[16:19]
s_waitcnt lgkmcnt(6)
v_mfma_f32_16x16x32_bf16 v[16:19], a[8:11], a[168:171], v[16:19]
v_exp_f32 v46, v46
s_waitcnt lgkmcnt(5)
v_mfma_f32_16x16x32_bf16 v[16:19], a[12:15], a[172:175], v[16:19]
ds_read_b128 a[36:39], v1 offset:9216
v_exp_f32 v47, v47
v_mfma_f32_16x16x32_bf16 v[20:23], a[0:3], a[176:179], v[84:87]
v_mfma_f32_16x16x32_bf16 v[20:23], a[4:7], a[180:183], v[20:23]
v_cvt_pk_bf16_f32 v78, v44, v45
v_cvt_pk_bf16_f32 v79, v46, v47
v_mfma_f32_16x16x32_bf16 v[20:23], a[8:11], a[184:187], v[20:23]
buffer_load_dwordx4 v3, s[88:91], s32 offen offset:2048 lds
v_mfma_f32_16x16x32_bf16 v[20:23], a[12:15], a[188:191], v[20:23]
ds_read_b128 a[40:43], v1 offset:10240
v_mfma_f32_16x16x32_bf16 v[24:27], a[0:3], a[192:195], v[88:91]
v_exp_f32 v16, v16
v_mfma_f32_16x16x32_bf16 v[24:27], a[4:7], a[196:199], v[24:27]
v_exp_f32 v17, v17
v_mfma_f32_16x16x32_bf16 v[24:27], a[8:11], a[200:203], v[24:27]
v_mfma_f32_16x16x32_bf16 v[24:27], a[12:15], a[204:207], v[24:27]
ds_read_b128 a[44:47], v1 offset:11264
v_exp_f32 v18, v18
v_mfma_f32_16x16x32_bf16 v[28:31], a[0:3], a[208:211], v[92:95]
v_exp_f32 v19, v19
v_mfma_f32_16x16x32_bf16 v[28:31], a[4:7], a[212:215], v[28:31]
v_mfma_f32_16x16x32_bf16 v[28:31], a[8:11], a[216:219], v[28:31]
ds_read_b128 a[48:51], v1 offset:12288
v_cvt_pk_bf16_f32 v48, v16, v17
v_cvt_pk_bf16_f32 v49, v18, v19
v_mfma_f32_16x16x32_bf16 v[28:31], a[12:15], a[220:223], v[28:31]
v_exp_f32 v20, v20
s_waitcnt lgkmcnt(8)
v_mfma_f32_16x16x32_bf16 v[32:35], a[16:19], a[160:163], v[100:103]
s_waitcnt lgkmcnt(7)
v_mfma_f32_16x16x32_bf16 v[32:35], a[20:23], a[164:167], v[32:35]
ds_read_b128 a[52:55], v1 offset:13312
v_exp_f32 v21, v21
s_waitcnt lgkmcnt(7)
v_mfma_f32_16x16x32_bf16 v[32:35], a[24:27], a[168:171], v[32:35]
s_waitcnt lgkmcnt(6)
v_mfma_f32_16x16x32_bf16 v[32:35], a[28:31], a[172:175], v[32:35]
v_exp_f32 v22, v22
v_mfma_f32_16x16x32_bf16 v[36:39], a[16:19], a[176:179], v[84:87]
v_exp_f32 v23, v23
v_mfma_f32_16x16x32_bf16 v[36:39], a[20:23], a[180:183], v[36:39]
ds_read_b128 a[56:59], v1 offset:14336
v_mfma_f32_16x16x32_bf16 v[36:39], a[24:27], a[184:187], v[36:39]
v_cvt_pk_bf16_f32 v52, v20, v21
v_cvt_pk_bf16_f32 v53, v22, v23
v_mfma_f32_16x16x32_bf16 v[36:39], a[28:31], a[188:191], v[36:39]
buffer_load_dwordx4 v3, s[88:91], s32 offen offset:3072 lds
v_mfma_f32_16x16x32_bf16 v[40:43], a[16:19], a[192:195], v[88:91]
v_exp_f32 v24, v24
v_mfma_f32_16x16x32_bf16 v[40:43], a[20:23], a[196:199], v[40:43]
ds_read_b128 a[60:63], v1 offset:15360
v_mfma_f32_16x16x32_bf16 v[40:43], a[24:27], a[200:203], v[40:43]
v_exp_f32 v25, v25
v_mfma_f32_16x16x32_bf16 v[40:43], a[28:31], a[204:207], v[40:43]
v_mfma_f32_16x16x32_bf16 v[44:47], a[16:19], a[208:211], v[92:95]
v_exp_f32 v26, v26
v_mfma_f32_16x16x32_bf16 v[44:47], a[20:23], a[212:215], v[44:47]
v_exp_f32 v27, v27
v_mfma_f32_16x16x32_bf16 v[44:47], a[24:27], a[216:219], v[44:47]
v_mfma_f32_16x16x32_bf16 v[44:47], a[28:31], a[220:223], v[44:47]
v_cvt_pk_bf16_f32 v56, v24, v25
v_cvt_pk_bf16_f32 v57, v26, v27
s_waitcnt lgkmcnt(0)
v_mfma_f32_16x16x32_bf16 v[128:131], a[32:35], v[64:67], v[128:131]
ds_read_b128 a[0:3], v1 offset:16384
v_exp_f32 v28, v28
v_mfma_f32_16x16x32_bf16 v[160:163], a[32:35], v[68:71], v[160:163]
v_mfma_f32_16x16x32_bf16 v[192:195], a[32:35], v[72:75], v[192:195]
v_exp_f32 v29, v29
v_mfma_f32_16x16x32_bf16 v[224:227], a[32:35], v[76:79], v[224:227]
ds_read_b128 a[4:7], v1 offset:17408
v_mfma_f32_16x16x32_bf16 v[228:231], a[36:39], v[76:79], v[228:231]
v_exp_f32 v30, v30
v_mfma_f32_16x16x32_bf16 v[196:199], a[36:39], v[72:75], v[196:199]
v_exp_f32 v31, v31
v_mfma_f32_16x16x32_bf16 v[164:167], a[36:39], v[68:71], v[164:167]
s_add_u32 m0, s18, 0x11000
v_mfma_f32_16x16x32_bf16 v[132:135], a[36:39], v[64:67], v[132:135]
buffer_load_dwordx4 v3, s[88:91], s11 offen offset:0 lds
v_mfma_f32_16x16x32_bf16 v[136:139], a[40:43], v[64:67], v[136:139]
ds_read_b128 a[8:11], v1 offset:18432
v_cvt_pk_bf16_f32 v60, v28, v29
v_cvt_pk_bf16_f32 v61, v30, v31
v_mfma_f32_16x16x32_bf16 v[168:171], a[40:43], v[68:71], v[168:171]
v_exp_f32 v32, v32
v_mfma_f32_16x16x32_bf16 v[200:203], a[40:43], v[72:75], v[200:203]
v_mfma_f32_16x16x32_bf16 v[232:235], a[40:43], v[76:79], v[232:235]
v_exp_f32 v33, v33
v_mfma_f32_16x16x32_bf16 v[236:239], a[44:47], v[76:79], v[236:239]
ds_read_b128 a[12:15], v1 offset:19456
v_mfma_f32_16x16x32_bf16 v[204:207], a[44:47], v[72:75], v[204:207]
v_exp_f32 v34, v34
v_mfma_f32_16x16x32_bf16 v[172:175], a[44:47], v[68:71], v[172:175]
v_exp_f32 v35, v35
v_mfma_f32_16x16x32_bf16 v[140:143], a[44:47], v[64:67], v[140:143]
v_mfma_f32_16x16x32_bf16 v[144:147], a[48:51], v[64:67], v[144:147]
ds_read_b128 a[16:19], v1 offset:20480
v_cvt_pk_bf16_f32 v50, v32, v33
v_cvt_pk_bf16_f32 v51, v34, v35
v_mfma_f32_16x16x32_bf16 v[176:179], a[48:51], v[68:71], v[176:179]
v_exp_f32 v36, v36
v_mfma_f32_16x16x32_bf16 v[208:211], a[48:51], v[72:75], v[208:211]
v_mfma_f32_16x16x32_bf16 v[240:243], a[48:51], v[76:79], v[240:243]
ds_read_b128 a[20:23], v1 offset:21504
v_exp_f32 v37, v37
v_mfma_f32_16x16x32_bf16 v[244:247], a[52:55], v[76:79], v[244:247]
v_mfma_f32_16x16x32_bf16 v[212:215], a[52:55], v[72:75], v[212:215]
v_exp_f32 v38, v38
v_mfma_f32_16x16x32_bf16 v[180:183], a[52:55], v[68:71], v[180:183]
buffer_load_dwordx4 v3, s[88:91], s11 offen offset:1024 lds
v_mfma_f32_16x16x32_bf16 v[148:151], a[52:55], v[64:67], v[148:151]
v_exp_f32 v39, v39
v_mfma_f32_16x16x32_bf16 v[152:155], a[56:59], v[64:67], v[152:155]
ds_read_b128 a[24:27], v1 offset:22528
v_mfma_f32_16x16x32_bf16 v[184:187], a[56:59], v[68:71], v[184:187]
v_cvt_pk_bf16_f32 v54, v36, v37
v_cvt_pk_bf16_f32 v55, v38, v39
v_mfma_f32_16x16x32_bf16 v[216:219], a[56:59], v[72:75], v[216:219]
v_exp_f32 v40, v40
v_mfma_f32_16x16x32_bf16 v[248:251], a[56:59], v[76:79], v[248:251]
v_mfma_f32_16x16x32_bf16 v[252:255], a[60:63], v[76:79], v[252:255]
ds_read_b128 a[28:31], v1 offset:23552
v_exp_f32 v41, v41
v_mfma_f32_16x16x32_bf16 v[220:223], a[60:63], v[72:75], v[220:223]
v_mfma_f32_16x16x32_bf16 v[188:191], a[60:63], v[68:71], v[188:191]
v_exp_f32 v42, v42
v_mfma_f32_16x16x32_bf16 v[156:159], a[60:63], v[64:67], v[156:159]
v_exp_f32 v43, v43
v_mfma_f32_16x16x32_bf16 a[224:227], a[240:243], v[64:67], a[224:227]
v_mfma_f32_16x16x32_bf16 a[228:231], a[240:243], v[68:71], a[228:231]
v_cvt_pk_bf16_f32 v58, v40, v41
v_cvt_pk_bf16_f32 v59, v42, v43
v_mfma_f32_16x16x32_bf16 a[232:235], a[240:243], v[72:75], a[232:235]
v_exp_f32 v44, v44
v_mfma_f32_16x16x32_bf16 a[236:239], a[240:243], v[76:79], a[236:239]
s_waitcnt lgkmcnt(7)
v_mfma_f32_16x16x32_bf16 v[20:23], a[0:3], a[176:179], v[84:87]
ds_read_b128 a[32:35], v1 offset:24576
v_exp_f32 v45, v45
s_waitcnt lgkmcnt(7)
v_mfma_f32_16x16x32_bf16 v[20:23], a[4:7], a[180:183], v[20:23]
buffer_load_dwordx4 v3, s[88:91], s11 offen offset:2048 lds
s_waitcnt lgkmcnt(6)
v_mfma_f32_16x16x32_bf16 v[20:23], a[8:11], a[184:187], v[20:23]
s_waitcnt lgkmcnt(5)
v_mfma_f32_16x16x32_bf16 v[20:23], a[12:15], a[188:191], v[20:23]
ds_read_b128 a[36:39], v1 offset:25600
v_exp_f32 v46, v46
v_mfma_f32_16x16x32_bf16 v[24:27], a[0:3], a[192:195], v[88:91]
v_exp_f32 v47, v47
v_mfma_f32_16x16x32_bf16 v[24:27], a[4:7], a[196:199], v[24:27]
ds_read_b128 a[40:43], v1 offset:26624
v_mfma_f32_16x16x32_bf16 v[24:27], a[8:11], a[200:203], v[24:27]
v_cvt_pk_bf16_f32 v62, v44, v45
v_cvt_pk_bf16_f32 v63, v46, v47
v_mfma_f32_16x16x32_bf16 v[24:27], a[12:15], a[204:207], v[24:27]
v_mfma_f32_16x16x32_bf16 v[28:31], a[0:3], a[208:211], v[92:95]
ds_read_b128 a[44:47], v1 offset:27648
v_exp_f32 v20, v20
v_mfma_f32_16x16x32_bf16 v[28:31], a[4:7], a[212:215], v[28:31]
v_exp_f32 v21, v21
v_mfma_f32_16x16x32_bf16 v[28:31], a[8:11], a[216:219], v[28:31]
ds_read_b128 a[48:51], v1 offset:28672
v_mfma_f32_16x16x32_bf16 v[28:31], a[12:15], a[220:223], v[28:31]
v_exp_f32 v22, v22
s_waitcnt lgkmcnt(8)
v_mfma_f32_16x16x32_bf16 v[36:39], a[16:19], a[176:179], v[84:87]
ds_read_b128 a[52:55], v1 offset:29696
v_exp_f32 v23, v23
s_waitcnt lgkmcnt(8)
v_mfma_f32_16x16x32_bf16 v[36:39], a[20:23], a[180:183], v[36:39]
s_waitcnt lgkmcnt(7)
v_mfma_f32_16x16x32_bf16 v[36:39], a[24:27], a[184:187], v[36:39]
v_cvt_pk_bf16_f32 v68, v20, v21
v_cvt_pk_bf16_f32 v69, v22, v23
s_waitcnt lgkmcnt(6)
v_mfma_f32_16x16x32_bf16 v[36:39], a[28:31], a[188:191], v[36:39]
ds_read_b128 a[56:59], v1 offset:30720
v_exp_f32 v24, v24
v_mfma_f32_16x16x32_bf16 v[40:43], a[16:19], a[192:195], v[88:91]
buffer_load_dwordx4 v3, s[88:91], s11 offen offset:3072 lds
v_mfma_f32_16x16x32_bf16 v[40:43], a[20:23], a[196:199], v[40:43]
v_mfma_f32_16x16x32_bf16 v[40:43], a[24:27], a[200:203], v[40:43]
ds_read_b128 a[60:63], v1 offset:31744
v_exp_f32 v25, v25
v_mfma_f32_16x16x32_bf16 v[40:43], a[28:31], a[204:207], v[40:43]
v_mfma_f32_16x16x32_bf16 v[44:47], a[16:19], a[208:211], v[92:95]
v_exp_f32 v26, v26
v_mfma_f32_16x16x32_bf16 v[44:47], a[20:23], a[212:215], v[44:47]
v_exp_f32 v27, v27
v_mfma_f32_16x16x32_bf16 v[44:47], a[24:27], a[216:219], v[44:47]
v_mfma_f32_16x16x32_bf16 v[44:47], a[28:31], a[220:223], v[44:47]
v_cvt_pk_bf16_f32 v72, v24, v25
v_cvt_pk_bf16_f32 v73, v26, v27
s_add_u32 s32, s32, 0x8000
s_add_u32 s11, s11, 0x8000
s_xor_b32 s18, s18, 0x8000
v_xor_b32 v1, 0x8000, v1
L_att_l1_0:
s_waitcnt vmcnt(16) lgkmcnt(0)
s_barrier
v_mfma_f32_16x16x32_bf16 v[128:131], a[32:35], v[48:51], v[128:131]
ds_read_b128 a[0:3], v2 offset:0
v_exp_f32 v28, v28
v_mfma_f32_16x16x32_bf16 v[160:163], a[32:35], v[52:55], v[160:163]
v_mfma_f32_16x16x32_bf16 v[192:195], a[32:35], v[56:59], v[192:195]
v_exp_f32 v29, v29
v_mfma_f32_16x16x32_bf16 v[224:227], a[32:35], v[60:63], v[224:227]
ds_read_b128 a[4:7], v2 offset:1024
v_mfma_f32_16x16x32_bf16 v[228:231], a[36:39], v[60:63], v[228:231]
v_exp_f32 v30, v30
v_mfma_f32_16x16x32_bf16 v[196:199], a[36:39], v[56:59], v[196:199]
v_mfma_f32_16x16x32_bf16 v[164:167], a[36:39], v[52:55], v[164:167]
s_add_u32 m0, s18, 0x0
v_exp_f32 v31, v31
v_mfma_f32_16x16x32_bf16 v[132:135], a[36:39], v[48:51], v[132:135]
buffer_load_dwordx4 v3, s[88:91], s32 offen offset:0 lds
v_mfma_f32_16x16x32_bf16 v[136:139], a[40:43], v[48:51], v[136:139]
ds_read_b128 a[8:11], v2 offset:2048
v_mfma_f32_16x16x32_bf16 v[168:171], a[40:43], v[52:55], v[168:171]
v_cvt_pk_bf16_f32 v76, v28, v29
v_cvt_pk_bf16_f32 v77, v30, v31
v_mfma_f32_16x16x32_bf16 v[200:203], a[40:43], v[56:59], v[200:203]
v_mfma_f32_16x16x32_bf16 v[232:235], a[40:43], v[60:63], v[232:235]
v_exp_f32 v36, v36
v_mfma_f32_16x16x32_bf16 v[236:239], a[44:47], v[60:63], v[236:239]
ds_read_b128 a[12:15], v2 offset:3072
v_mfma_f32_16x16x32_bf16 v[204:207], a[44:47], v[56:59], v[204:207]
v_exp_f32 v37, v37
v_mfma_f32_16x16x32_bf16 v[172:175], a[44:47], v[52:55], v[172:175]
v_mfma_f32_16x16x32_bf16 v[140:143], a[44:47], v[48:51], v[140:143]
v_exp_f32 v38, v38
v_mfma_f32_16x16x32_bf16 v[144:147], a[48:51], v[48:51], v[144:147]
ds_read_b128 a[16:19], v2 offset:4096
v_exp_f32 v39, v39
v_mfma_f32_16x16x32_bf16 v[176:179], a[48:51], v[52:55], v[176:179]
v_mfma_f32_16x16x32_bf16 v[208:211], a[48:51], v[56:59], v[208:211]
v_cvt_pk_bf16_f32 v70, v36, v37
v_cvt_pk_bf16_f32 v71, v38, v39
v_mfma_f32_16x16x32_bf16 v[240:243], a[48:51], v[60:63], v[240:243]
ds_read_b128 a[20:23], v2 offset:5120
v_mfma_f32_16x16x32_bf16 v[244:247], a[52:55], v[60:63], v[244:247]
v_exp_f32 v40, v40
v_mfma_f32_16x16x32_bf16 v[212:215], a[52:55], v[56:59], v[212:215]
v_mfma_f32_16x16x32_bf16 v[180:183], a[52:55], v[52:55], v[180:183]
buffer_load_dwordx4 v3, s[88:91], s32 offen offset:1024 lds
v_mfma_f32_16x16x32_bf16 v[148:151], a[52:55], v[48:51], v[148:151]
v_exp_f32 v41, v41
v_mfma_f32_16x16x32_bf16 v[152:155], a[56:59], v[48:51], v[152:155]
ds_read_b128 a[24:27], v2 offset:6144
v_mfma_f32_16x16x32_bf16 v[184:187], a[56:59], v[52:55], v[184:187]
v_exp_f32 v42, v42
v_mfma_f32_16x16x32_bf16 v[216:219], a[56:59], v[56:59], v[216:219]
v_mfma_f32_16x16x32_bf16 v[248:251], a[56:59], v[60:63], v[248:251]
v_exp_f32 v43, v43
v_mfma_f32_16x16x32_bf16 v[252:255], a[60:63], v[60:63], v[252:255]
ds_read_b128 a[28:31], v2 offset:7168
v_mfma_f32_16x16x32_bf16 v[220:223], a[60:63], v[56:59], v[220:223]
v_cvt_pk_bf16_f32 v74, v40, v41
v_cvt_pk_bf16_f32 v75, v42, v43
v_mfma_f32_16x16x32_bf16 v[188:191], a[60:63], v[52:55], v[188:191]
v_exp_f32 v44, v44
v_mfma_f32_16x16x32_bf16 v[156:159], a[60:63], v[48:51], v[156:159]
v_mfma_f32_16x16x32_bf16 a[224:227], a[240:243], v[48:51], a[224:227]
v_exp_f32 v45, v45
v_mfma_f32_16x16x32_bf16 a[228:231], a[240:243], v[52:55], a[228:231]
v_mfma_f32_16x16x32_bf16 a[232:235], a[240:243], v[56:59], a[232:235]
v_exp_f32 v46, v46
v_mfma_f32_16x16x32_bf16 a[236:239], a[240:243], v[60:63], a[236:239]
s_waitcnt lgkmcnt(7)
v_mfma_f32_16x16x32_bf16 v[20:23], a[0:3], a[176:179], v[84:87]
ds_read_b128 a[32:35], v2 offset:8192
v_exp_f32 v47, v47
s_waitcnt lgkmcnt(7)
v_mfma_f32_16x16x32_bf16 v[20:23], a[4:7], a[180:183], v[20:23]
buffer_load_dwordx4 v3, s[88:91], s32 offen offset:2048 lds
s_waitcnt lgkmcnt(6)
v_mfma_f32_16x16x32_bf16 v[20:23], a[8:11], a[184:187], v[20:23]
s_waitcnt lgkmcnt(5)
v_mfma_f32_16x16x32_bf16 v[20:23], a[12:15], a[188:191], v[20:23]
ds_read_b128 a[36:39], v2 offset:9216
v_cvt_pk_bf16_f32 v78, v44, v45
v_cvt_pk_bf16_f32 v79, v46, v47
v_mfma_f32_16x16x32_bf16 v[24:27], a[0:3], a[192:195], v[88:91]
v_mfma_f32_16x16x32_bf16 v[24:27], a[4:7], a[196:199], v[24:27]
ds_read_b128 a[40:43], v2 offset:10240
v_mfma_f32_16x16x32_bf16 v[24:27], a[8:11], a[200:203], v[24:27]
v_mfma_f32_16x16x32_bf16 v[24:27], a[12:15], a[204:207], v[24:27]
v_mfma_f32_16x16x32_bf16 v[28:31], a[0:3], a[208:211], v[92:95]
ds_read_b128 a[44:47], v2 offset:11264
v_exp_f32 v20, v20
v_mfma_f32_16x16x32_bf16 v[28:31], a[4:7], a[212:215], v[28:31]
v_exp_f32 v21, v21
v_mfma_f32_16x16x32_bf16 v[28:31], a[8:11], a[216:219], v[28:31]
ds_read_b128 a[48:51], v2 offset:12288
v_exp_f32 v22, v22
v_mfma_f32_16x16x32_bf16 v[28:31], a[12:15], a[220:223], v[28:31]
v_exp_f32 v23, v23
s_waitcnt lgkmcnt(8)
v_mfma_f32_16x16x32_bf16 v[36:39], a[16:19], a[176:179], v[84:87]
ds_read_b128 a[52:55], v2 offset:13312
v_cvt_pk_bf16_f32 v52, v20, v21
v_cvt_pk_bf16_f32 v53, v22, v23
s_waitcnt lgkmcnt(8)
v_mfma_f32_16x16x32_bf16 v[36:39], a[20:23], a[180:183], v[36:39]
s_waitcnt lgkmcnt(7)
v_mfma_f32_16x16x32_bf16 v[36:39], a[24:27], a[184:187], v[36:39]
v_exp_f32 v24, v24
s_waitcnt lgkmcnt(6)
v_mfma_f32_16x16x32_bf16 v[36:39], a[28:31], a[188:191], v[36:39]
ds_read_b128 a[56:59], v2 offset:14336
v_mfma_f32_16x16x32_bf16 v[40:43], a[16:19], a[192:195], v[88:91]
buffer_load_dwordx4 v3, s[88:91], s32 offen offset:3072 lds
v_mfma_f32_16x16x32_bf16 v[40:43], a[20:23], a[196:199], v[40:43]
v_exp_f32 v25, v25
v_mfma_f32_16x16x32_bf16 v[40:43], a[24:27], a[200:203], v[40:43]
ds_read_b128 a[60:63], v2 offset:15360
v_mfma_f32_16x16x32_bf16 v[40:43], a[28:31], a[204:207], v[40:43]
v_exp_f32 v26, v26
v_mfma_f32_16x16x32_bf16 v[44:47], a[16:19], a[208:211], v[92:95]
v_mfma_f32_16x16x32_bf16 v[44:47], a[20:23], a[212:215], v[44:47]
v_exp_f32 v27, v27
v_mfma_f32_16x16x32_bf16 v[44:47], a[24:27], a[216:219], v[44:47]
v_mfma_f32_16x16x32_bf16 v[44:47], a[28:31], a[220:223], v[44:47]
v_cvt_pk_bf16_f32 v56, v24, v25
v_cvt_pk_bf16_f32 v57, v26, v27
s_waitcnt lgkmcnt(0)
v_mfma_f32_16x16x32_bf16 v[160:163], a[32:35], v[68:71], v[160:163]
ds_read_b128 a[0:3], v2 offset:16384
v_exp_f32 v28, v28
v_mfma_f32_16x16x32_bf16 v[192:195], a[32:35], v[72:75], v[192:195]
v_mfma_f32_16x16x32_bf16 v[224:227], a[32:35], v[76:79], v[224:227]
ds_read_b128 a[4:7], v2 offset:17408
v_exp_f32 v29, v29
v_mfma_f32_16x16x32_bf16 v[228:231], a[36:39], v[76:79], v[228:231]
v_mfma_f32_16x16x32_bf16 v[196:199], a[36:39], v[72:75], v[196:199]
v_exp_f32 v30, v30
v_mfma_f32_16x16x32_bf16 v[164:167], a[36:39], v[68:71], v[164:167]
s_add_u32 m0, s18, 0x1000
ds_read_b128 a[8:11], v2 offset:18432
v_exp_f32 v31, v31
v_mfma_f32_16x16x32_bf16 v[168:171], a[40:43], v[68:71], v[168:171]
buffer_load_dwordx4 v3, s[88:91], s11 offen offset:0 lds
v_mfma_f32_16x16x32_bf16 v[200:203], a[40:43], v[72:75], v[200:203]
v_mfma_f32_16x16x32_bf16 v[232:235], a[40:43], v[76:79], v[232:235]
ds_read_b128 a[12:15], v2 offset:19456
v_cvt_pk_bf16_f32 v60, v28, v29
v_cvt_pk_bf16_f32 v61, v30, v31
v_mfma_f32_16x16x32_bf16 v[236:239], a[44:47], v[76:79], v[236:239]
v_exp_f32 v36, v36
v_mfma_f32_16x16x32_bf16 v[204:207], a[44:47], v[72:75], v[204:207]
v_mfma_f32_16x16x32_bf16 v[172:175], a[44:47], v[68:71], v[172:175]
ds_read_b128 a[16:19], v2 offset:20480
v_exp_f32 v37, v37
v_mfma_f32_16x16x32_bf16 v[176:179], a[48:51], v[68:71], v[176:179]
v_exp_f32 v38, v38
v_mfma_f32_16x16x32_bf16 v[208:211], a[48:51], v[72:75], v[208:211]
v_mfma_f32_16x16x32_bf16 v[240:243], a[48:51], v[76:79], v[240:243]
ds_read_b128 a[20:23], v2 offset:21504
v_exp_f32 v39, v39
v_mfma_f32_16x16x32_bf16 v[244:247], a[52:55], v[76:79], v[244:247]
v_mfma_f32_16x16x32_bf16 v[212:215], a[52:55], v[72:75], v[212:215]
ds_read_b128 a[24:27], v2 offset:22528
v_cvt_pk_bf16_f32 v54, v36, v37
v_cvt_pk_bf16_f32 v55, v38, v39
v_mfma_f32_16x16x32_bf16 v[180:183], a[52:55], v[68:71], v[180:183]
v_exp_f32 v40, v40
v_mfma_f32_16x16x32_bf16 v[184:187], a[56:59], v[68:71], v[184:187]
buffer_load_dwordx4 v3, s[88:91], s11 offen offset:1024 lds
v_mfma_f32_16x16x32_bf16 v[216:219], a[56:59], v[72:75], v[216:219]
v_mfma_f32_16x16x32_bf16 v[248:251], a[56:59], v[76:79], v[248:251]
ds_read_b128 a[28:31], v2 offset:23552
v_exp_f32 v41, v41
v_mfma_f32_16x16x32_bf16 v[252:255], a[60:63], v[76:79], v[252:255]
v_exp_f32 v42, v42
v_mfma_f32_16x16x32_bf16 v[220:223], a[60:63], v[72:75], v[220:223]
v_mfma_f32_16x16x32_bf16 v[188:191], a[60:63], v[68:71], v[188:191]
v_exp_f32 v43, v43
v_mfma_f32_16x16x32_bf16 a[228:231], a[240:243], v[68:71], a[228:231]
v_cvt_pk_bf16_f32 v58, v40, v41
v_cvt_pk_bf16_f32 v59, v42, v43
v_mfma_f32_16x16x32_bf16 a[232:235], a[240:243], v[72:75], a[232:235]
v_mfma_f32_16x16x32_bf16 a[236:239], a[240:243], v[76:79], a[236:239]
v_exp_f32 v44, v44
s_waitcnt lgkmcnt(7)
v_mfma_f32_16x16x32_bf16 v[20:23], a[0:3], a[176:179], v[104:107]
ds_read_b128 a[32:35], v2 offset:24576
s_waitcnt lgkmcnt(7)
v_mfma_f32_16x16x32_bf16 v[20:23], a[4:7], a[180:183], v[20:23]
v_exp_f32 v45, v45
s_waitcnt lgkmcnt(6)
v_mfma_f32_16x16x32_bf16 v[20:23], a[8:11], a[184:187], v[20:23]
ds_read_b128 a[36:39], v2 offset:25600
v_exp_f32 v46, v46
s_waitcnt lgkmcnt(6)
v_mfma_f32_16x16x32_bf16 v[20:23], a[12:15], a[188:191], v[20:23]
buffer_load_dwordx4 v3, s[88:91], s11 offen offset:2048 lds
v_mfma_f32_16x16x32_bf16 v[24:27], a[0:3], a[192:195], v[88:91]
v_mfma_f32_16x16x32_bf16 v[24:27], a[4:7], a[196:199], v[24:27]
ds_read_b128 a[40:43], v2 offset:26624
v_exp_f32 v47, v47
v_mfma_f32_16x16x32_bf16 v[24:27], a[8:11], a[200:203], v[24:27]
v_cvt_pk_bf16_f32 v62, v44, v45
v_cvt_pk_bf16_f32 v63, v46, v47
v_mfma_f32_16x16x32_bf16 v[24:27], a[12:15], a[204:207], v[24:27]
v_mfma_f32_16x16x32_bf16 v[28:31], a[0:3], a[208:211], v[92:95]
ds_read_b128 a[44:47], v2 offset:27648
v_exp_f32 v20, v20
v_mfma_f32_16x16x32_bf16 v[28:31], a[4:7], a[212:215], v[28:31]
v_exp_f32 v21, v21
v_mfma_f32_16x16x32_bf16 v[28:31], a[8:11], a[216:219], v[28:31]
ds_read_b128 a[48:51], v2 offset:28672
v_mfma_f32_16x16x32_bf16 v[28:31], a[12:15], a[220:223], v[28:31]
v_exp_f32 v22, v22
s_waitcnt lgkmcnt(8)
v_mfma_f32_16x16x32_bf16 v[36:39], a[16:19], a[176:179], v[108:111]
ds_read_b128 a[52:55], v2 offset:29696
s_waitcnt lgkmcnt(8)
v_mfma_f32_16x16x32_bf16 v[36:39], a[20:23], a[180:183], v[36:39]
v_exp_f32 v23, v23
s_waitcnt lgkmcnt(7)
v_mfma_f32_16x16x32_bf16 v[36:39], a[24:27], a[184:187], v[36:39]
v_cvt_pk_bf16_f32 v68, v20, v21
v_cvt_pk_bf16_f32 v69, v22, v23
s_waitcnt lgkmcnt(6)
v_mfma_f32_16x16x32_bf16 v[36:39], a[28:31], a[188:191], v[36:39]
buffer_load_dwordx4 v3, s[88:91], s11 offen offset:3072 lds
v_mfma_f32_16x16x32_bf16 v[40:43], a[16:19], a[192:195], v[88:91]
ds_read_b128 a[56:59], v2 offset:30720
v_mfma_f32_16x16x32_bf16 v[40:43], a[20:23], a[196:199], v[40:43]
v_exp_f32 v24, v24
v_mfma_f32_16x16x32_bf16 v[40:43], a[24:27], a[200:203], v[40:43]
ds_read_b128 a[60:63], v2 offset:31744
v_exp_f32 v25, v25
v_mfma_f32_16x16x32_bf16 v[40:43], a[28:31], a[204:207], v[40:43]
v_mfma_f32_16x16x32_bf16 v[44:47], a[16:19], a[208:211], v[92:95]
v_exp_f32 v26, v26
v_mfma_f32_16x16x32_bf16 v[44:47], a[20:23], a[212:215], v[44:47]
v_exp_f32 v27, v27
v_mfma_f32_16x16x32_bf16 v[44:47], a[24:27], a[216:219], v[44:47]
v_mfma_f32_16x16x32_bf16 v[44:47], a[28:31], a[220:223], v[44:47]
v_cvt_pk_bf16_f32 v72, v24, v25
v_cvt_pk_bf16_f32 v73, v26, v27
s_add_u32 s32, s32, 0x8000
s_add_u32 s11, s11, 0x8000
v_xor_b32 v2, 0x8000, v2
s_sub_u32 s15, 7, s6
s_lshl_b32 s15, s15, 1
s_cbranch_scc0 L_att_lh0_0
s_waitcnt vmcnt(16) lgkmcnt(0)
s_barrier
v_mfma_f32_16x16x32_bf16 v[160:163], a[32:35], v[52:55], v[160:163]
ds_read_b128 a[0:3], v1 offset:0
v_exp_f32 v28, v28
v_mfma_f32_16x16x32_bf16 v[192:195], a[32:35], v[56:59], v[192:195]
v_mfma_f32_16x16x32_bf16 v[224:227], a[32:35], v[60:63], v[224:227]
ds_read_b128 a[4:7], v1 offset:1024
v_exp_f32 v29, v29
v_mfma_f32_16x16x32_bf16 v[228:231], a[36:39], v[60:63], v[228:231]
v_mfma_f32_16x16x32_bf16 v[196:199], a[36:39], v[56:59], v[196:199]
s_add_u32 m0, s18, 0x10000
v_exp_f32 v30, v30
v_mfma_f32_16x16x32_bf16 v[164:167], a[36:39], v[52:55], v[164:167]
buffer_load_dwordx4 v3, s[88:91], s32 offen offset:0 lds
v_mfma_f32_16x16x32_bf16 v[168:171], a[40:43], v[52:55], v[168:171]
ds_read_b128 a[8:11], v1 offset:2048
v_exp_f32 v31, v31
v_mfma_f32_16x16x32_bf16 v[200:203], a[40:43], v[56:59], v[200:203]
v_mfma_f32_16x16x32_bf16 v[232:235], a[40:43], v[60:63], v[232:235]
ds_read_b128 a[12:15], v1 offset:3072
v_cvt_pk_bf16_f32 v76, v28, v29
v_cvt_pk_bf16_f32 v77, v30, v31
v_mfma_f32_16x16x32_bf16 v[236:239], a[44:47], v[60:63], v[236:239]
v_exp_f32 v36, v36
v_mfma_f32_16x16x32_bf16 v[204:207], a[44:47], v[56:59], v[204:207]
v_mfma_f32_16x16x32_bf16 v[172:175], a[44:47], v[52:55], v[172:175]
ds_read_b128 a[16:19], v1 offset:4096
v_exp_f32 v37, v37
v_mfma_f32_16x16x32_bf16 v[176:179], a[48:51], v[52:55], v[176:179]
v_exp_f32 v38, v38
v_mfma_f32_16x16x32_bf16 v[208:211], a[48:51], v[56:59], v[208:211]
v_mfma_f32_16x16x32_bf16 v[240:243], a[48:51], v[60:63], v[240:243]
ds_read_b128 a[20:23], v1 offset:5120
v_exp_f32 v39, v39
v_mfma_f32_16x16x32_bf16 v[244:247], a[52:55], v[60:63], v[244:247]
buffer_load_dwordx4 v3, s[88:91], s32 offen offset:1024 lds
v_mfma_f32_16x16x32_bf16 v[212:215], a[52:55], v[56:59], v[212:215]
v_mfma_f32_16x16x32_bf16 v[180:183], a[52:55], v[52:55], v[180:183]
ds_read_b128 a[24:27], v1 offset:6144
v_cvt_pk_bf16_f32 v70, v36, v37
v_cvt_pk_bf16_f32 v71, v38, v39
v_mfma_f32_16x16x32_bf16 v[184:187], a[56:59], v[52:55], v[184:187]
v_exp_f32 v40, v40
v_mfma_f32_16x16x32_bf16 v[216:219], a[56:59], v[56:59], v[216:219]
v_mfma_f32_16x16x32_bf16 v[248:251], a[56:59], v[60:63], v[248:251]
ds_read_b128 a[28:31], v1 offset:7168
v_exp_f32 v41, v41
v_mfma_f32_16x16x32_bf16 v[252:255], a[60:63], v[60:63], v[252:255]
v_exp_f32 v42, v42
v_mfma_f32_16x16x32_bf16 v[220:223], a[60:63], v[56:59], v[220:223]
v_mfma_f32_16x16x32_bf16 v[188:191], a[60:63], v[52:55], v[188:191]
v_exp_f32 v43, v43
v_mfma_f32_16x16x32_bf16 a[228:231], a[240:243], v[52:55], a[228:231]
v_cvt_pk_bf16_f32 v74, v40, v41
v_cvt_pk_bf16_f32 v75, v42, v43
v_mfma_f32_16x16x32_bf16 a[232:235], a[240:243], v[56:59], a[232:235]
buffer_load_dwordx4 v3, s[88:91], s32 offen offset:2048 lds
v_mfma_f32_16x16x32_bf16 a[236:239], a[240:243], v[60:63], a[236:239]
s_waitcnt lgkmcnt(7)
v_mfma_f32_16x16x32_bf16 v[24:27], a[0:3], a[192:195], v[88:91]
ds_read_b128 a[32:35], v1 offset:8192
v_exp_f32 v44, v44
s_waitcnt lgkmcnt(7)
v_mfma_f32_16x16x32_bf16 v[24:27], a[4:7], a[196:199], v[24:27]
ds_read_b128 a[36:39], v1 offset:9216
v_exp_f32 v45, v45
s_waitcnt lgkmcnt(7)
v_mfma_f32_16x16x32_bf16 v[24:27], a[8:11], a[200:203], v[24:27]
s_waitcnt lgkmcnt(6)
v_mfma_f32_16x16x32_bf16 v[24:27], a[12:15], a[204:207], v[24:27]
ds_read_b128 a[40:43], v1 offset:10240
v_exp_f32 v46, v46
v_mfma_f32_16x16x32_bf16 v[28:31], a[0:3], a[208:211], v[92:95]
ds_read_b128 a[44:47], v1 offset:11264
v_mfma_f32_16x16x32_bf16 v[28:31], a[4:7], a[212:215], v[28:31]
v_exp_f32 v47, v47
v_mfma_f32_16x16x32_bf16 v[28:31], a[8:11], a[216:219], v[28:31]
ds_read_b128 a[48:51], v1 offset:12288
v_cvt_pk_bf16_f32 v78, v44, v45
v_cvt_pk_bf16_f32 v79, v46, v47
v_mfma_f32_16x16x32_bf16 v[28:31], a[12:15], a[220:223], v[28:31]
ds_read_b128 a[52:55], v1 offset:13312
s_waitcnt lgkmcnt(9)
v_mfma_f32_16x16x32_bf16 v[40:43], a[16:19], a[192:195], v[88:91]
buffer_load_dwordx4 v3, s[88:91], s32 offen offset:3072 lds
s_waitcnt lgkmcnt(8)
v_mfma_f32_16x16x32_bf16 v[40:43], a[20:23], a[196:199], v[40:43]
v_exp_f32 v24, v24
s_waitcnt lgkmcnt(7)
v_mfma_f32_16x16x32_bf16 v[40:43], a[24:27], a[200:203], v[40:43]
ds_read_b128 a[56:59], v1 offset:14336
v_exp_f32 v25, v25
s_waitcnt lgkmcnt(7)
v_mfma_f32_16x16x32_bf16 v[40:43], a[28:31], a[204:207], v[40:43]
ds_read_b128 a[60:63], v1 offset:15360
v_mfma_f32_16x16x32_bf16 v[44:47], a[16:19], a[208:211], v[92:95]
v_exp_f32 v26, v26
v_mfma_f32_16x16x32_bf16 v[44:47], a[20:23], a[212:215], v[44:47]
v_exp_f32 v27, v27
v_mfma_f32_16x16x32_bf16 v[44:47], a[24:27], a[216:219], v[44:47]
v_mfma_f32_16x16x32_bf16 v[44:47], a[28:31], a[220:223], v[44:47]
v_cvt_pk_bf16_f32 v56, v24, v25
v_cvt_pk_bf16_f32 v57, v26, v27
s_waitcnt lgkmcnt(0)
v_mfma_f32_16x16x32_bf16 v[160:163], a[32:35], v[68:71], v[160:163]
ds_read_b128 a[0:3], v1 offset:16384
v_exp_f32 v28, v28
v_mfma_f32_16x16x32_bf16 v[192:195], a[32:35], v[72:75], v[192:195]
v_mfma_f32_16x16x32_bf16 v[224:227], a[32:35], v[76:79], v[224:227]
ds_read_b128 a[4:7], v1 offset:17408
v_exp_f32 v29, v29
v_mfma_f32_16x16x32_bf16 v[228:231], a[36:39], v[76:79], v[228:231]
v_mfma_f32_16x16x32_bf16 v[196:199], a[36:39], v[72:75], v[196:199]
s_add_u32 m0, s18, 0x11000
v_exp_f32 v30, v30
v_mfma_f32_16x16x32_bf16 v[164:167], a[36:39], v[68:71], v[164:167]
buffer_load_dwordx4 v3, s[88:91], s11 offen offset:0 lds
v_mfma_f32_16x16x32_bf16 v[168:171], a[40:43], v[68:71], v[168:171]
ds_read_b128 a[8:11], v1 offset:18432
v_mfma_f32_16x16x32_bf16 v[200:203], a[40:43], v[72:75], v[200:203]
v_exp_f32 v31, v31
v_mfma_f32_16x16x32_bf16 v[232:235], a[40:43], v[76:79], v[232:235]
ds_read_b128 a[12:15], v1 offset:19456
v_mfma_f32_16x16x32_bf16 v[236:239], a[44:47], v[76:79], v[236:239]
v_cvt_pk_bf16_f32 v60, v28, v29
v_cvt_pk_bf16_f32 v61, v30, v31
v_mfma_f32_16x16x32_bf16 v[204:207], a[44:47], v[72:75], v[204:207]
v_mfma_f32_16x16x32_bf16 v[172:175], a[44:47], v[68:71], v[172:175]
ds_read_b128 a[16:19], v1 offset:20480
v_exp_f32 v40, v40
v_mfma_f32_16x16x32_bf16 v[176:179], a[48:51], v[68:71], v[176:179]
v_mfma_f32_16x16x32_bf16 v[208:211], a[48:51], v[72:75], v[208:211]
v_exp_f32 v41, v41
v_mfma_f32_16x16x32_bf16 v[240:243], a[48:51], v[76:79], v[240:243]
ds_read_b128 a[20:23], v1 offset:21504
v_mfma_f32_16x16x32_bf16 v[244:247], a[52:55], v[76:79], v[244:247]
buffer_load_dwordx4 v3, s[88:91], s11 offen offset:1024 lds
v_mfma_f32_16x16x32_bf16 v[212:215], a[52:55], v[72:75], v[212:215]
v_exp_f32 v42, v42
v_mfma_f32_16x16x32_bf16 v[180:183], a[52:55], v[68:71], v[180:183]
ds_read_b128 a[24:27], v1 offset:22528
v_mfma_f32_16x16x32_bf16 v[184:187], a[56:59], v[68:71], v[184:187]
v_exp_f32 v43, v43
v_mfma_f32_16x16x32_bf16 v[216:219], a[56:59], v[72:75], v[216:219]
v_mfma_f32_16x16x32_bf16 v[248:251], a[56:59], v[76:79], v[248:251]
ds_read_b128 a[28:31], v1 offset:23552
v_cvt_pk_bf16_f32 v58, v40, v41
v_cvt_pk_bf16_f32 v59, v42, v43
v_mfma_f32_16x16x32_bf16 v[252:255], a[60:63], v[76:79], v[252:255]
v_mfma_f32_16x16x32_bf16 v[220:223], a[60:63], v[72:75], v[220:223]
v_exp_f32 v44, v44
v_mfma_f32_16x16x32_bf16 v[188:191], a[60:63], v[68:71], v[188:191]
v_mfma_f32_16x16x32_bf16 a[228:231], a[240:243], v[68:71], a[228:231]
v_exp_f32 v45, v45
v_mfma_f32_16x16x32_bf16 a[232:235], a[240:243], v[72:75], a[232:235]
buffer_load_dwordx4 v3, s[88:91], s11 offen offset:2048 lds
v_mfma_f32_16x16x32_bf16 a[236:239], a[240:243], v[76:79], a[236:239]
s_waitcnt lgkmcnt(7)
v_mfma_f32_16x16x32_bf16 v[24:27], a[0:3], a[192:195], v[88:91]
ds_read_b128 a[32:35], v1 offset:24576
v_exp_f32 v46, v46
s_waitcnt lgkmcnt(7)
v_mfma_f32_16x16x32_bf16 v[24:27], a[4:7], a[196:199], v[24:27]
ds_read_b128 a[36:39], v1 offset:25600
s_waitcnt lgkmcnt(7)
v_mfma_f32_16x16x32_bf16 v[24:27], a[8:11], a[200:203], v[24:27]
v_exp_f32 v47, v47
s_waitcnt lgkmcnt(6)
v_mfma_f32_16x16x32_bf16 v[24:27], a[12:15], a[204:207], v[24:27]
ds_read_b128 a[40:43], v1 offset:26624
v_mfma_f32_16x16x32_bf16 v[28:31], a[0:3], a[208:211], v[92:95]
ds_read_b128 a[44:47], v1 offset:27648
v_cvt_pk_bf16_f32 v62, v44, v45
v_cvt_pk_bf16_f32 v63, v46, v47
v_mfma_f32_16x16x32_bf16 v[28:31], a[4:7], a[212:215], v[28:31]
v_mfma_f32_16x16x32_bf16 v[28:31], a[8:11], a[216:219], v[28:31]
ds_read_b128 a[48:51], v1 offset:28672
v_mfma_f32_16x16x32_bf16 v[28:31], a[12:15], a[220:223], v[28:31]
ds_read_b128 a[52:55], v1 offset:29696
s_waitcnt lgkmcnt(9)
v_mfma_f32_16x16x32_bf16 v[40:43], a[16:19], a[192:195], v[88:91]
buffer_load_dwordx4 v3, s[88:91], s11 offen offset:3072 lds
s_waitcnt lgkmcnt(8)
v_mfma_f32_16x16x32_bf16 v[40:43], a[20:23], a[196:199], v[40:43]
v_exp_f32 v24, v24
s_waitcnt lgkmcnt(7)
v_mfma_f32_16x16x32_bf16 v[40:43], a[24:27], a[200:203], v[40:43]
ds_read_b128 a[56:59], v1 offset:30720
v_exp_f32 v25, v25
s_waitcnt lgkmcnt(7)
v_mfma_f32_16x16x32_bf16 v[40:43], a[28:31], a[204:207], v[40:43]
ds_read_b128 a[60:63], v1 offset:31744
v_exp_f32 v26, v26
v_mfma_f32_16x16x32_bf16 v[44:47], a[16:19], a[208:211], v[92:95]
v_mfma_f32_16x16x32_bf16 v[44:47], a[20:23], a[212:215], v[44:47]
v_exp_f32 v27, v27
v_mfma_f32_16x16x32_bf16 v[44:47], a[24:27], a[216:219], v[44:47]
v_mfma_f32_16x16x32_bf16 v[44:47], a[28:31], a[220:223], v[44:47]
v_cvt_pk_bf16_f32 v72, v24, v25
v_cvt_pk_bf16_f32 v73, v26, v27
s_add_u32 s32, s32, 0x8000
s_add_u32 s11, s11, 0x8000
s_xor_b32 s18, s18, 0x8000
v_xor_b32 v1, 0x8000, v1
s_nop 7
v_accvgpr_read_b32 v4, a224
v_accvgpr_read_b32 v6, a228
s_mov_b32 s8, 0x5f800000
v_cmp_nge_f32 s[36:37], s8, v4
v_cmp_nge_f32 s[38:39], s8, v6
v_rcp_f32 v4, v4
v_rcp_f32 v6, v6
s_or_b64 s[34:35], s[34:35], s[36:37]
s_or_b64 s[34:35], s[34:35], s[38:39]
v_pk_mul_f32 v[128:129], v[128:129], v[4:5] op_sel_hi:[1,0]
v_pk_mul_f32 v[130:131], v[130:131], v[4:5] op_sel_hi:[1,0]
v_pk_mul_f32 v[132:133], v[132:133], v[4:5] op_sel_hi:[1,0]
v_pk_mul_f32 v[134:135], v[134:135], v[4:5] op_sel_hi:[1,0]
v_cvt_pk_bf16_f32 v128, v128, v129
v_cvt_pk_bf16_f32 v129, v130, v131
v_cvt_pk_bf16_f32 v130, v132, v133
v_cvt_pk_bf16_f32 v131, v134, v135
s_add_u32 s8, s28, 0x0
buffer_store_dwordx4 v[128:131], v3, s[88:91], s8 offen
v_pk_mul_f32 v[136:137], v[136:137], v[4:5] op_sel_hi:[1,0]
v_pk_mul_f32 v[138:139], v[138:139], v[4:5] op_sel_hi:[1,0]
v_pk_mul_f32 v[140:141], v[140:141], v[4:5] op_sel_hi:[1,0]
v_pk_mul_f32 v[142:143], v[142:143], v[4:5] op_sel_hi:[1,0]
v_cvt_pk_bf16_f32 v136, v136, v137
v_cvt_pk_bf16_f32 v137, v138, v139
v_cvt_pk_bf16_f32 v138, v140, v141
v_cvt_pk_bf16_f32 v139, v142, v143
s_add_u32 s8, s28, 0x2000
buffer_store_dwordx4 v[136:139], v3, s[88:91], s8 offen
v_pk_mul_f32 v[144:145], v[144:145], v[4:5] op_sel_hi:[1,0]
v_pk_mul_f32 v[146:147], v[146:147], v[4:5] op_sel_hi:[1,0]
v_pk_mul_f32 v[148:149], v[148:149], v[4:5] op_sel_hi:[1,0]
v_pk_mul_f32 v[150:151], v[150:151], v[4:5] op_sel_hi:[1,0]
v_cvt_pk_bf16_f32 v144, v144, v145
v_cvt_pk_bf16_f32 v145, v146, v147
v_cvt_pk_bf16_f32 v146, v148, v149
v_cvt_pk_bf16_f32 v147, v150, v151
s_add_u32 s8, s28, 0x4000
buffer_store_dwordx4 v[144:147], v3, s[88:91], s8 offen
v_pk_mul_f32 v[152:153], v[152:153], v[4:5] op_sel_hi:[1,0]
v_pk_mul_f32 v[154:155], v[154:155], v[4:5] op_sel_hi:[1,0]
v_pk_mul_f32 v[156:157], v[156:157], v[4:5] op_sel_hi:[1,0]
v_pk_mul_f32 v[158:159], v[158:159], v[4:5] op_sel_hi:[1,0]
v_cvt_pk_bf16_f32 v152, v152, v153
v_cvt_pk_bf16_f32 v153, v154, v155
v_cvt_pk_bf16_f32 v154, v156, v157
v_cvt_pk_bf16_f32 v155, v158, v159
s_add_u32 s8, s28, 0x6000
buffer_store_dwordx4 v[152:155], v3, s[88:91], s8 offen
v_pk_mul_f32 v[160:161], v[160:161], v[6:7] op_sel_hi:[1,0]
v_pk_mul_f32 v[162:163], v[162:163], v[6:7] op_sel_hi:[1,0]
v_pk_mul_f32 v[164:165], v[164:165], v[6:7] op_sel_hi:[1,0]
v_pk_mul_f32 v[166:167], v[166:167], v[6:7] op_sel_hi:[1,0]
v_cvt_pk_bf16_f32 v160, v160, v161
v_cvt_pk_bf16_f32 v161, v162, v163
v_cvt_pk_bf16_f32 v162, v164, v165
v_cvt_pk_bf16_f32 v163, v166, v167
s_add_u32 s8, s29, 0x0
buffer_store_dwordx4 v[160:163], v3, s[88:91], s8 offen
v_pk_mul_f32 v[168:169], v[168:169], v[6:7] op_sel_hi:[1,0]
v_pk_mul_f32 v[170:171], v[170:171], v[6:7] op_sel_hi:[1,0]
v_pk_mul_f32 v[172:173], v[172:173], v[6:7] op_sel_hi:[1,0]
v_pk_mul_f32 v[174:175], v[174:175], v[6:7] op_sel_hi:[1,0]
v_cvt_pk_bf16_f32 v168, v168, v169
v_cvt_pk_bf16_f32 v169, v170, v171
v_cvt_pk_bf16_f32 v170, v172, v173
v_cvt_pk_bf16_f32 v171, v174, v175
s_add_u32 s8, s29, 0x2000
buffer_store_dwordx4 v[168:171], v3, s[88:91], s8 offen
v_pk_mul_f32 v[176:177], v[176:177], v[6:7] op_sel_hi:[1,0]
v_pk_mul_f32 v[178:179], v[178:179], v[6:7] op_sel_hi:[1,0]
v_pk_mul_f32 v[180:181], v[180:181], v[6:7] op_sel_hi:[1,0]
v_pk_mul_f32 v[182:183], v[182:183], v[6:7] op_sel_hi:[1,0]
v_cvt_pk_bf16_f32 v176, v176, v177
v_cvt_pk_bf16_f32 v177, v178, v179
v_cvt_pk_bf16_f32 v178, v180, v181
v_cvt_pk_bf16_f32 v179, v182, v183
s_add_u32 s8, s29, 0x4000
buffer_store_dwordx4 v[176:179], v3, s[88:91], s8 offen
v_pk_mul_f32 v[184:185], v[184:185], v[6:7] op_sel_hi:[1,0]
v_pk_mul_f32 v[186:187], v[186:187], v[6:7] op_sel_hi:[1,0]
v_pk_mul_f32 v[188:189], v[188:189], v[6:7] op_sel_hi:[1,0]
v_pk_mul_f32 v[190:191], v[190:191], v[6:7] op_sel_hi:[1,0]
v_cvt_pk_bf16_f32 v184, v184, v185
v_cvt_pk_bf16_f32 v185, v186, v187
v_cvt_pk_bf16_f32 v186, v188, v189
v_cvt_pk_bf16_f32 v187, v190, v191
s_add_u32 s8, s29, 0x6000
buffer_store_dwordx4 v[184:187], v3, s[88:91], s8 offen
s_branch L_att_sodd
L_att_lh0_0:
s_waitcnt vmcnt(16) lgkmcnt(0)
s_barrier
v_mfma_f32_16x16x32_bf16 v[160:163], a[32:35], v[52:55], v[160:163]
ds_read_b128 a[0:3], v1 offset:0
v_exp_f32 v28, v28
v_mfma_f32_16x16x32_bf16 v[192:195], a[32:35], v[56:59], v[192:195]
v_mfma_f32_16x16x32_bf16 v[224:227], a[32:35], v[60:63], v[224:227]
ds_read_b128 a[4:7], v1 offset:1024
v_exp_f32 v29, v29
v_mfma_f32_16x16x32_bf16 v[228:231], a[36:39], v[60:63], v[228:231]
v_mfma_f32_16x16x32_bf16 v[196:199], a[36:39], v[56:59], v[196:199]
v_exp_f32 v30, v30
v_mfma_f32_16x16x32_bf16 v[164:167], a[36:39], v[52:55], v[164:167]
ds_read_b128 a[8:11], v1 offset:2048
v_mfma_f32_16x16x32_bf16 v[168:171], a[40:43], v[52:55], v[168:171]
v_exp_f32 v31, v31
v_mfma_f32_16x16x32_bf16 v[200:203], a[40:43], v[56:59], v[200:203]
v_cvt_pk_bf16_f32 v76, v28, v29
v_cvt_pk_bf16_f32 v77, v30, v31
v_mfma_f32_16x16x32_bf16 v[232:235], a[40:43], v[60:63], v[232:235]
ds_read_b128 a[12:15], v1 offset:3072
v_mfma_f32_16x16x32_bf16 v[236:239], a[44:47], v[60:63], v[236:239]
v_exp_f32 v36, v36
v_mfma_f32_16x16x32_bf16 v[204:207], a[44:47], v[56:59], v[204:207]
v_mfma_f32_16x16x32_bf16 v[172:175], a[44:47], v[52:55], v[172:175]
ds_read_b128 a[16:19], v1 offset:4096
v_exp_f32 v37, v37
v_mfma_f32_16x16x32_bf16 v[176:179], a[48:51], v[52:55], v[176:179]
v_mfma_f32_16x16x32_bf16 v[208:211], a[48:51], v[56:59], v[208:211]
v_exp_f32 v38, v38
v_mfma_f32_16x16x32_bf16 v[240:243], a[48:51], v[60:63], v[240:243]
ds_read_b128 a[20:23], v1 offset:5120
v_exp_f32 v39, v39
v_mfma_f32_16x16x32_bf16 v[244:247], a[52:55], v[60:63], v[244:247]
v_mfma_f32_16x16x32_bf16 v[212:215], a[52:55], v[56:59], v[212:215]
v_cvt_pk_bf16_f32 v70, v36, v37
v_cvt_pk_bf16_f32 v71, v38, v39
v_mfma_f32_16x16x32_bf16 v[180:183], a[52:55], v[52:55], v[180:183]
ds_read_b128 a[24:27], v1 offset:6144
v_mfma_f32_16x16x32_bf16 v[184:187], a[56:59], v[52:55], v[184:187]
v_exp_f32 v40, v40
v_mfma_f32_16x16x32_bf16 v[216:219], a[56:59], v[56:59], v[216:219]
v_exp_f32 v41, v41
v_mfma_f32_16x16x32_bf16 v[248:251], a[56:59], v[60:63], v[248:251]
ds_read_b128 a[28:31], v1 offset:7168
v_mfma_f32_16x16x32_bf16 v[252:255], a[60:63], v[60:63], v[252:255]
v_exp_f32 v42, v42
v_mfma_f32_16x16x32_bf16 v[220:223], a[60:63], v[56:59], v[220:223]
v_mfma_f32_16x16x32_bf16 v[188:191], a[60:63], v[52:55], v[188:191]
v_exp_f32 v43, v43
v_mfma_f32_16x16x32_bf16 a[228:231], a[240:243], v[52:55], a[228:231]
v_mfma_f32_16x16x32_bf16 a[232:235], a[240:243], v[56:59], a[232:235]
v_cvt_pk_bf16_f32 v74, v40, v41
v_cvt_pk_bf16_f32 v75, v42, v43
v_mfma_f32_16x16x32_bf16 a[236:239], a[240:243], v[60:63], a[236:239]
v_exp_f32 v44, v44
s_waitcnt lgkmcnt(7)
v_mfma_f32_16x16x32_bf16 v[24:27], a[0:3], a[192:195], v[112:115]
ds_read_b128 a[32:35], v1 offset:8192
s_waitcnt lgkmcnt(7)
v_mfma_f32_16x16x32_bf16 v[24:27], a[4:7], a[196:199], v[24:27]
ds_read_b128 a[36:39], v1 offset:9216
v_exp_f32 v45, v45
s_waitcnt lgkmcnt(7)
v_mfma_f32_16x16x32_bf16 v[24:27], a[8:11], a[200:203], v[24:27]
s_waitcnt lgkmcnt(6)
v_mfma_f32_16x16x32_bf16 v[24:27], a[12:15], a[204:207], v[24:27]
ds_read_b128 a[40:43], v1 offset:10240
v_exp_f32 v46, v46
v_mfma_f32_16x16x32_bf16 v[28:31], a[0:3], a[208:211], v[92:95]
ds_read_b128 a[44:47], v1 offset:11264
v_exp_f32 v47, v47
v_mfma_f32_16x16x32_bf16 v[28:31], a[4:7], a[212:215], v[28:31]
v_mfma_f32_16x16x32_bf16 v[28:31], a[8:11], a[216:219], v[28:31]
ds_read_b128 a[48:51], v1 offset:12288
v_cvt_pk_bf16_f32 v78, v44, v45
v_cvt_pk_bf16_f32 v79, v46, v47
v_mfma_f32_16x16x32_bf16 v[28:31], a[12:15], a[220:223], v[28:31]
s_waitcnt lgkmcnt(8)
v_mfma_f32_16x16x32_bf16 v[40:43], a[16:19], a[192:195], v[116:119]
ds_read_b128 a[52:55], v1 offset:13312
v_exp_f32 v24, v24
s_waitcnt lgkmcnt(8)
v_mfma_f32_16x16x32_bf16 v[40:43], a[20:23], a[196:199], v[40:43]
ds_read_b128 a[56:59], v1 offset:14336
s_waitcnt lgkmcnt(8)
v_mfma_f32_16x16x32_bf16 v[40:43], a[24:27], a[200:203], v[40:43]
v_exp_f32 v25, v25
s_waitcnt lgkmcnt(7)
v_mfma_f32_16x16x32_bf16 v[40:43], a[28:31], a[204:207], v[40:43]
ds_read_b128 a[60:63], v1 offset:15360
v_exp_f32 v26, v26
v_mfma_f32_16x16x32_bf16 v[44:47], a[16:19], a[208:211], v[92:95]
v_mfma_f32_16x16x32_bf16 v[44:47], a[20:23], a[212:215], v[44:47]
v_exp_f32 v27, v27
v_mfma_f32_16x16x32_bf16 v[44:47], a[24:27], a[216:219], v[44:47]
v_mfma_f32_16x16x32_bf16 v[44:47], a[28:31], a[220:223], v[44:47]
v_cvt_pk_bf16_f32 v56, v24, v25
v_cvt_pk_bf16_f32 v57, v26, v27
s_waitcnt lgkmcnt(0)
v_mfma_f32_16x16x32_bf16 v[160:163], a[32:35], v[68:71], v[160:163]
ds_read_b128 a[0:3], v1 offset:16384
v_exp_f32 v28, v28
v_mfma_f32_16x16x32_bf16 v[192:195], a[32:35], v[72:75], v[192:195]
v_mfma_f32_16x16x32_bf16 v[224:227], a[32:35], v[76:79], v[224:227]
ds_read_b128 a[4:7], v1 offset:17408
v_mfma_f32_16x16x32_bf16 v[228:231], a[36:39], v[76:79], v[228:231]
v_exp_f32 v29, v29
v_mfma_f32_16x16x32_bf16 v[196:199], a[36:39], v[72:75], v[196:199]
v_mfma_f32_16x16x32_bf16 v[164:167], a[36:39], v[68:71], v[164:167]
ds_read_b128 a[8:11], v1 offset:18432
v_exp_f32 v30, v30
v_mfma_f32_16x16x32_bf16 v[168:171], a[40:43], v[68:71], v[168:171]
v_mfma_f32_16x16x32_bf16 v[200:203], a[40:43], v[72:75], v[200:203]
v_exp_f32 v31, v31
v_mfma_f32_16x16x32_bf16 v[232:235], a[40:43], v[76:79], v[232:235]
ds_read_b128 a[12:15], v1 offset:19456
v_mfma_f32_16x16x32_bf16 v[236:239], a[44:47], v[76:79], v[236:239]
v_mfma_f32_16x16x32_bf16 v[204:207], a[44:47], v[72:75], v[204:207]
v_cvt_pk_bf16_f32 v60, v28, v29
v_cvt_pk_bf16_f32 v61, v30, v31
v_mfma_f32_16x16x32_bf16 v[172:175], a[44:47], v[68:71], v[172:175]
ds_read_b128 a[16:19], v1 offset:20480
v_mfma_f32_16x16x32_bf16 v[176:179], a[48:51], v[68:71], v[176:179]
v_exp_f32 v40, v40
v_mfma_f32_16x16x32_bf16 v[208:211], a[48:51], v[72:75], v[208:211]
v_mfma_f32_16x16x32_bf16 v[240:243], a[48:51], v[76:79], v[240:243]
ds_read_b128 a[20:23], v1 offset:21504
v_exp_f32 v41, v41
v_mfma_f32_16x16x32_bf16 v[244:247], a[52:55], v[76:79], v[244:247]
v_mfma_f32_16x16x32_bf16 v[212:215], a[52:55], v[72:75], v[212:215]
v_mfma_f32_16x16x32_bf16 v[180:183], a[52:55], v[68:71], v[180:183]
ds_read_b128 a[24:27], v1 offset:22528
v_exp_f32 v42, v42
v_mfma_f32_16x16x32_bf16 v[184:187], a[56:59], v[68:71], v[184:187]
v_mfma_f32_16x16x32_bf16 v[216:219], a[56:59], v[72:75], v[216:219]
v_exp_f32 v43, v43
v_mfma_f32_16x16x32_bf16 v[248:251], a[56:59], v[76:79], v[248:251]
ds_read_b128 a[28:31], v1 offset:23552
v_mfma_f32_16x16x32_bf16 v[252:255], a[60:63], v[76:79], v[252:255]
v_cvt_pk_bf16_f32 v58, v40, v41
v_cvt_pk_bf16_f32 v59, v42, v43
v_mfma_f32_16x16x32_bf16 v[220:223], a[60:63], v[72:75], v[220:223]
v_mfma_f32_16x16x32_bf16 v[188:191], a[60:63], v[68:71], v[188:191]
v_mfma_f32_16x16x32_bf16 a[228:231], a[240:243], v[68:71], a[228:231]
v_exp_f32 v44, v44
v_mfma_f32_16x16x32_bf16 a[232:235], a[240:243], v[72:75], a[232:235]
v_mfma_f32_16x16x32_bf16 a[236:239], a[240:243], v[76:79], a[236:239]
v_exp_f32 v45, v45
s_waitcnt lgkmcnt(7)
v_mfma_f32_16x16x32_bf16 v[28:31], a[0:3], a[208:211], v[92:95]
s_waitcnt lgkmcnt(6)
v_mfma_f32_16x16x32_bf16 v[28:31], a[4:7], a[212:215], v[28:31]
v_exp_f32 v46, v46
s_waitcnt lgkmcnt(5)
v_mfma_f32_16x16x32_bf16 v[28:31], a[8:11], a[216:219], v[28:31]
v_exp_f32 v47, v47
s_waitcnt lgkmcnt(4)
v_mfma_f32_16x16x32_bf16 v[28:31], a[12:15], a[220:223], v[28:31]
v_cvt_pk_bf16_f32 v62, v44, v45
v_cvt_pk_bf16_f32 v63, v46, v47
s_waitcnt lgkmcnt(3)
v_mfma_f32_16x16x32_bf16 v[44:47], a[16:19], a[208:211], v[92:95]
s_waitcnt lgkmcnt(2)
v_mfma_f32_16x16x32_bf16 v[44:47], a[20:23], a[212:215], v[44:47]
s_waitcnt lgkmcnt(1)
v_mfma_f32_16x16x32_bf16 v[44:47], a[24:27], a[216:219], v[44:47]
s_waitcnt lgkmcnt(0)
v_mfma_f32_16x16x32_bf16 v[44:47], a[28:31], a[220:223], v[44:47]
ds_read_b128 a[32:35], v1 offset:24576
ds_read_b128 a[36:39], v1 offset:25600
ds_read_b128 a[40:43], v1 offset:26624
ds_read_b128 a[44:47], v1 offset:27648
ds_read_b128 a[48:51], v1 offset:28672
ds_read_b128 a[52:55], v1 offset:29696
ds_read_b128 a[56:59], v1 offset:30720
ds_read_b128 a[60:63], v1 offset:31744
v_xor_b32 v1, 0x8000, v1
s_nop 7
v_accvgpr_read_b32 v4, a224
v_accvgpr_read_b32 v6, a228
s_mov_b32 s8, 0x5f800000
v_cmp_nge_f32 s[36:37], s8, v4
v_cmp_nge_f32 s[38:39], s8, v6
v_rcp_f32 v4, v4
v_rcp_f32 v6, v6
s_or_b64 s[34:35], s[34:35], s[36:37]
s_or_b64 s[34:35], s[34:35], s[38:39]
v_pk_mul_f32 v[128:129], v[128:129], v[4:5] op_sel_hi:[1,0]
v_pk_mul_f32 v[130:131], v[130:131], v[4:5] op_sel_hi:[1,0]
v_pk_mul_f32 v[132:133], v[132:133], v[4:5] op_sel_hi:[1,0]
v_pk_mul_f32 v[134:135], v[134:135], v[4:5] op_sel_hi:[1,0]
v_cvt_pk_bf16_f32 v128, v128, v129
v_cvt_pk_bf16_f32 v129, v130, v131
v_cvt_pk_bf16_f32 v130, v132, v133
v_cvt_pk_bf16_f32 v131, v134, v135
s_add_u32 s8, s28, 0x0
buffer_store_dwordx4 v[128:131], v3, s[88:91], s8 offen
v_pk_mul_f32 v[136:137], v[136:137], v[4:5] op_sel_hi:[1,0]
v_pk_mul_f32 v[138:139], v[138:139], v[4:5] op_sel_hi:[1,0]
v_pk_mul_f32 v[140:141], v[140:141], v[4:5] op_sel_hi:[1,0]
v_pk_mul_f32 v[142:143], v[142:143], v[4:5] op_sel_hi:[1,0]
v_cvt_pk_bf16_f32 v136, v136, v137
v_cvt_pk_bf16_f32 v137, v138, v139
v_cvt_pk_bf16_f32 v138, v140, v141
v_cvt_pk_bf16_f32 v139, v142, v143
s_add_u32 s8, s28, 0x2000
buffer_store_dwordx4 v[136:139], v3, s[88:91], s8 offen
v_pk_mul_f32 v[144:145], v[144:145], v[4:5] op_sel_hi:[1,0]
v_pk_mul_f32 v[146:147], v[146:147], v[4:5] op_sel_hi:[1,0]
v_pk_mul_f32 v[148:149], v[148:149], v[4:5] op_sel_hi:[1,0]
v_pk_mul_f32 v[150:151], v[150:151], v[4:5] op_sel_hi:[1,0]
v_cvt_pk_bf16_f32 v144, v144, v145
v_cvt_pk_bf16_f32 v145, v146, v147
v_cvt_pk_bf16_f32 v146, v148, v149
v_cvt_pk_bf16_f32 v147, v150, v151
s_add_u32 s8, s28, 0x4000
buffer_store_dwordx4 v[144:147], v3, s[88:91], s8 offen
v_pk_mul_f32 v[152:153], v[152:153], v[4:5] op_sel_hi:[1,0]
v_pk_mul_f32 v[154:155], v[154:155], v[4:5] op_sel_hi:[1,0]
v_pk_mul_f32 v[156:157], v[156:157], v[4:5] op_sel_hi:[1,0]
v_pk_mul_f32 v[158:159], v[158:159], v[4:5] op_sel_hi:[1,0]
v_cvt_pk_bf16_f32 v152, v152, v153
v_cvt_pk_bf16_f32 v153, v154, v155
v_cvt_pk_bf16_f32 v154, v156, v157
v_cvt_pk_bf16_f32 v155, v158, v159
s_add_u32 s8, s28, 0x6000
buffer_store_dwordx4 v[152:155], v3, s[88:91], s8 offen
v_pk_mul_f32 v[160:161], v[160:161], v[6:7] op_sel_hi:[1,0]
v_pk_mul_f32 v[162:163], v[162:163], v[6:7] op_sel_hi:[1,0]
v_pk_mul_f32 v[164:165], v[164:165], v[6:7] op_sel_hi:[1,0]
v_pk_mul_f32 v[166:167], v[166:167], v[6:7] op_sel_hi:[1,0]
v_cvt_pk_bf16_f32 v160, v160, v161
v_cvt_pk_bf16_f32 v161, v162, v163
v_cvt_pk_bf16_f32 v162, v164, v165
v_cvt_pk_bf16_f32 v163, v166, v167
s_add_u32 s8, s29, 0x0
buffer_store_dwordx4 v[160:163], v3, s[88:91], s8 offen
v_pk_mul_f32 v[168:169], v[168:169], v[6:7] op_sel_hi:[1,0]
v_pk_mul_f32 v[170:171], v[170:171], v[6:7] op_sel_hi:[1,0]
v_pk_mul_f32 v[172:173], v[172:173], v[6:7] op_sel_hi:[1,0]
v_pk_mul_f32 v[174:175], v[174:175], v[6:7] op_sel_hi:[1,0]
v_cvt_pk_bf16_f32 v168, v168, v169
v_cvt_pk_bf16_f32 v169, v170, v171
v_cvt_pk_bf16_f32 v170, v172, v173
v_cvt_pk_bf16_f32 v171, v174, v175
s_add_u32 s8, s29, 0x2000
buffer_store_dwordx4 v[168:171], v3, s[88:91], s8 offen
v_pk_mul_f32 v[176:177], v[176:177], v[6:7] op_sel_hi:[1,0]
v_pk_mul_f32 v[178:179], v[178:179], v[6:7] op_sel_hi:[1,0]
v_pk_mul_f32 v[180:181], v[180:181], v[6:7] op_sel_hi:[1,0]
v_pk_mul_f32 v[182:183], v[182:183], v[6:7] op_sel_hi:[1,0]
v_cvt_pk_bf16_f32 v176, v176, v177
v_cvt_pk_bf16_f32 v177, v178, v179
v_cvt_pk_bf16_f32 v178, v180, v181
v_cvt_pk_bf16_f32 v179, v182, v183
s_add_u32 s8, s29, 0x4000
buffer_store_dwordx4 v[176:179], v3, s[88:91], s8 offen
v_pk_mul_f32 v[184:185], v[184:185], v[6:7] op_sel_hi:[1,0]
v_pk_mul_f32 v[186:187], v[186:187], v[6:7] op_sel_hi:[1,0]
v_pk_mul_f32 v[188:189], v[188:189], v[6:7] op_sel_hi:[1,0]
v_pk_mul_f32 v[190:191], v[190:191], v[6:7] op_sel_hi:[1,0]
v_cvt_pk_bf16_f32 v184, v184, v185
v_cvt_pk_bf16_f32 v185, v186, v187
v_cvt_pk_bf16_f32 v186, v188, v189
v_cvt_pk_bf16_f32 v187, v190, v191
s_add_u32 s8, s29, 0x6000
buffer_store_dwordx4 v[184:187], v3, s[88:91], s8 offen
s_branch L_att_h1_0
L_att_dl0_1:
s_waitcnt vmcnt(16) lgkmcnt(0)
s_barrier
v_mfma_f32_16x16x32_bf16 v[128:131], a[32:35], v[48:51], v[128:131]
ds_read_b128 a[0:3], v1 offset:0
v_exp_f32 v28, v28
v_mfma_f32_16x16x32_bf16 v[160:163], a[32:35], v[52:55], v[160:163]
v_mfma_f32_16x16x32_bf16 v[192:195], a[32:35], v[56:59], v[192:195]
v_exp_f32 v29, v29
v_mfma_f32_16x16x32_bf16 v[224:227], a[32:35], v[60:63], v[224:227]
ds_read_b128 a[4:7], v1 offset:1024
v_mfma_f32_16x16x32_bf16 v[228:231], a[36:39], v[60:63], v[228:231]
v_exp_f32 v30, v30
v_mfma_f32_16x16x32_bf16 v[196:199], a[36:39], v[56:59], v[196:199]
v_exp_f32 v31, v31
v_mfma_f32_16x16x32_bf16 v[164:167], a[36:39], v[52:55], v[164:167]
v_mfma_f32_16x16x32_bf16 v[132:135], a[36:39], v[48:51], v[132:135]
s_add_u32 m0, s18, 0x10000
ds_read_b128 a[8:11], v1 offset:2048
v_cvt_pk_bf16_f32 v76, v28, v29
v_cvt_pk_bf16_f32 v77, v30, v31
v_mfma_f32_16x16x32_bf16 v[136:139], a[40:43], v[48:51], v[136:139]
buffer_load_dwordx4 v3, s[88:91], s32 offen offset:0 lds
v_mfma_f32_16x16x32_bf16 v[168:171], a[40:43], v[52:55], v[168:171]
v_exp_f32 v32, v32
v_mfma_f32_16x16x32_bf16 v[200:203], a[40:43], v[56:59], v[200:203]
v_mfma_f32_16x16x32_bf16 v[232:235], a[40:43], v[60:63], v[232:235]
v_exp_f32 v33, v33
v_mfma_f32_16x16x32_bf16 v[236:239], a[44:47], v[60:63], v[236:239]
ds_read_b128 a[12:15], v1 offset:3072
v_mfma_f32_16x16x32_bf16 v[204:207], a[44:47], v[56:59], v[204:207]
v_exp_f32 v34, v34
v_mfma_f32_16x16x32_bf16 v[172:175], a[44:47], v[52:55], v[172:175]
v_exp_f32 v35, v35
v_mfma_f32_16x16x32_bf16 v[140:143], a[44:47], v[48:51], v[140:143]
v_mfma_f32_16x16x32_bf16 v[144:147], a[48:51], v[48:51], v[144:147]
ds_read_b128 a[16:19], v1 offset:4096
v_cvt_pk_bf16_f32 v66, v32, v33
v_cvt_pk_bf16_f32 v67, v34, v35
v_mfma_f32_16x16x32_bf16 v[176:179], a[48:51], v[52:55], v[176:179]
v_exp_f32 v36, v36
v_mfma_f32_16x16x32_bf16 v[208:211], a[48:51], v[56:59], v[208:211]
v_mfma_f32_16x16x32_bf16 v[240:243], a[48:51], v[60:63], v[240:243]
ds_read_b128 a[20:23], v1 offset:5120
v_exp_f32 v37, v37
v_mfma_f32_16x16x32_bf16 v[244:247], a[52:55], v[60:63], v[244:247]
v_mfma_f32_16x16x32_bf16 v[212:215], a[52:55], v[56:59], v[212:215]
v_exp_f32 v38, v38
v_mfma_f32_16x16x32_bf16 v[180:183], a[52:55], v[52:55], v[180:183]
v_exp_f32 v39, v39
v_mfma_f32_16x16x32_bf16 v[148:151], a[52:55], v[48:51], v[148:151]
ds_read_b128 a[24:27], v1 offset:6144
v_mfma_f32_16x16x32_bf16 v[152:155], a[56:59], v[48:51], v[152:155]
v_cvt_pk_bf16_f32 v70, v36, v37
v_cvt_pk_bf16_f32 v71, v38, v39
v_mfma_f32_16x16x32_bf16 v[184:187], a[56:59], v[52:55], v[184:187]
buffer_load_dwordx4 v3, s[88:91], s32 offen offset:1024 lds
v_mfma_f32_16x16x32_bf16 v[216:219], a[56:59], v[56:59], v[216:219]
v_exp_f32 v40, v40
v_mfma_f32_16x16x32_bf16 v[248:251], a[56:59], v[60:63], v[248:251]
v_mfma_f32_16x16x32_bf16 v[252:255], a[60:63], v[60:63], v[252:255]
ds_read_b128 a[28:31], v1 offset:7168
v_exp_f32 v41, v41
v_mfma_f32_16x16x32_bf16 v[220:223], a[60:63], v[56:59], v[220:223]
v_mfma_f32_16x16x32_bf16 v[188:191], a[60:63], v[52:55], v[188:191]
v_exp_f32 v42, v42
v_mfma_f32_16x16x32_bf16 v[156:159], a[60:63], v[48:51], v[156:159]
v_exp_f32 v43, v43
v_mfma_f32_16x16x32_bf16 a[224:227], a[240:243], v[48:51], a[224:227]
v_mfma_f32_16x16x32_bf16 a[228:231], a[240:243], v[52:55], a[228:231]
v_cvt_pk_bf16_f32 v74, v40, v41
v_cvt_pk_bf16_f32 v75, v42, v43
v_mfma_f32_16x16x32_bf16 a[232:235], a[240:243], v[56:59], a[232:235]
v_exp_f32 v44, v44
v_mfma_f32_16x16x32_bf16 a[236:239], a[240:243], v[60:63], a[236:239]
s_waitcnt lgkmcnt(7)
v_mfma_f32_16x16x32_bf16 v[16:19], a[0:3], a[160:163], v[80:83]
ds_read_b128 a[32:35], v1 offset:8192
v_exp_f32 v45, v45
s_waitcnt lgkmcnt(7)
v_mfma_f32_16x16x32_bf16 v[16:19], a[4:7], a[164:167], v[16:19]
s_waitcnt lgkmcnt(6)
v_mfma_f32_16x16x32_bf16 v[16:19], a[8:11], a[168:171], v[16:19]
v_exp_f32 v46, v46
s_waitcnt lgkmcnt(5)
v_mfma_f32_16x16x32_bf16 v[16:19], a[12:15], a[172:175], v[16:19]
ds_read_b128 a[36:39], v1 offset:9216
v_exp_f32 v47, v47
v_mfma_f32_16x16x32_bf16 v[20:23], a[0:3], a[176:179], v[84:87]
v_mfma_f32_16x16x32_bf16 v[20:23], a[4:7], a[180:183], v[20:23]
v_cvt_pk_bf16_f32 v78, v44, v45
v_cvt_pk_bf16_f32 v79, v46, v47
v_mfma_f32_16x16x32_bf16 v[20:23], a[8:11], a[184:187], v[20:23]
buffer_load_dwordx4 v3, s[88:91], s32 offen offset:2048 lds
v_mfma_f32_16x16x32_bf16 v[20:23], a[12:15], a[188:191], v[20:23]
ds_read_b128 a[40:43], v1 offset:10240
v_mfma_f32_16x16x32_bf16 v[24:27], a[0:3], a[192:195], v[88:91]
v_exp_f32 v16, v16
v_mfma_f32_16x16x32_bf16 v[24:27], a[4:7], a[196:199], v[24:27]
v_exp_f32 v17, v17
v_mfma_f32_16x16x32_bf16 v[24:27], a[8:11], a[200:203], v[24:27]
v_mfma_f32_16x16x32_bf16 v[24:27], a[12:15], a[204:207], v[24:27]
ds_read_b128 a[44:47], v1 offset:11264
v_exp_f32 v18, v18
v_mfma_f32_16x16x32_bf16 v[28:31], a[0:3], a[208:211], v[92:95]
v_exp_f32 v19, v19
v_mfma_f32_16x16x32_bf16 v[28:31], a[4:7], a[212:215], v[28:31]
v_mfma_f32_16x16x32_bf16 v[28:31], a[8:11], a[216:219], v[28:31]
ds_read_b128 a[48:51], v1 offset:12288
v_cvt_pk_bf16_f32 v48, v16, v17
v_cvt_pk_bf16_f32 v49, v18, v19
v_mfma_f32_16x16x32_bf16 v[28:31], a[12:15], a[220:223], v[28:31]
v_exp_f32 v20, v20
s_waitcnt lgkmcnt(8)
v_mfma_f32_16x16x32_bf16 v[32:35], a[16:19], a[160:163], v[80:83]
s_waitcnt lgkmcnt(7)
v_mfma_f32_16x16x32_bf16 v[32:35], a[20:23], a[164:167], v[32:35]
ds_read_b128 a[52:55], v1 offset:13312
v_exp_f32 v21, v21
s_waitcnt lgkmcnt(7)
v_mfma_f32_16x16x32_bf16 v[32:35], a[24:27], a[168:171], v[32:35]
s_waitcnt lgkmcnt(6)
v_mfma_f32_16x16x32_bf16 v[32:35], a[28:31], a[172:175], v[32:35]
v_exp_f32 v22, v22
v_mfma_f32_16x16x32_bf16 v[36:39], a[16:19], a[176:179], v[84:87]
v_exp_f32 v23, v23
v_mfma_f32_16x16x32_bf16 v[36:39], a[20:23], a[180:183], v[36:39]
ds_read_b128 a[56:59], v1 offset:14336
v_mfma_f32_16x16x32_bf16 v[36:39], a[24:27], a[184:187], v[36:39]
v_cvt_pk_bf16_f32 v52, v20, v21
v_cvt_pk_bf16_f32 v53, v22, v23
v_mfma_f32_16x16x32_bf16 v[36:39], a[28:31], a[188:191], v[36:39]
buffer_load_dwordx4 v3, s[88:91], s32 offen offset:3072 lds
v_mfma_f32_16x16x32_bf16 v[40:43], a[16:19], a[192:195], v[88:91]
v_exp_f32 v24, v24
v_mfma_f32_16x16x32_bf16 v[40:43], a[20:23], a[196:199], v[40:43]
ds_read_b128 a[60:63], v1 offset:15360
v_mfma_f32_16x16x32_bf16 v[40:43], a[24:27], a[200:203], v[40:43]
v_exp_f32 v25, v25
v_mfma_f32_16x16x32_bf16 v[40:43], a[28:31], a[204:207], v[40:43]
v_mfma_f32_16x16x32_bf16 v[44:47], a[16:19], a[208:211], v[92:95]
v_exp_f32 v26, v26
v_mfma_f32_16x16x32_bf16 v[44:47], a[20:23], a[212:215], v[44:47]
v_exp_f32 v27, v27
v_mfma_f32_16x16x32_bf16 v[44:47], a[24:27], a[216:219], v[44:47]
v_mfma_f32_16x16x32_bf16 v[44:47], a[28:31], a[220:223], v[44:47]
v_cvt_pk_bf16_f32 v56, v24, v25
v_cvt_pk_bf16_f32 v57, v26, v27
s_waitcnt lgkmcnt(0)
v_mfma_f32_16x16x32_bf16 v[128:131], a[32:35], v[64:67], v[128:131]
ds_read_b128 a[0:3], v1 offset:16384
v_exp_f32 v28, v28
v_mfma_f32_16x16x32_bf16 v[160:163], a[32:35], v[68:71], v[160:163]
v_mfma_f32_16x16x32_bf16 v[192:195], a[32:35], v[72:75], v[192:195]
v_exp_f32 v29, v29
v_mfma_f32_16x16x32_bf16 v[224:227], a[32:35], v[76:79], v[224:227]
ds_read_b128 a[4:7], v1 offset:17408
v_mfma_f32_16x16x32_bf16 v[228:231], a[36:39], v[76:79], v[228:231]
v_exp_f32 v30, v30
v_mfma_f32_16x16x32_bf16 v[196:199], a[36:39], v[72:75], v[196:199]
v_exp_f32 v31, v31
v_mfma_f32_16x16x32_bf16 v[164:167], a[36:39], v[68:71], v[164:167]
v_mfma_f32_16x16x32_bf16 v[132:135], a[36:39], v[64:67], v[132:135]
s_add_u32 m0, s18, 0x11000
ds_read_b128 a[8:11], v1 offset:18432
v_cvt_pk_bf16_f32 v60, v28, v29
v_cvt_pk_bf16_f32 v61, v30, v31
v_mfma_f32_16x16x32_bf16 v[136:139], a[40:43], v[64:67], v[136:139]
buffer_load_dwordx4 v3, s[88:91], s11 offen offset:0 lds
v_mfma_f32_16x16x32_bf16 v[168:171], a[40:43], v[68:71], v[168:171]
v_exp_f32 v32, v32
v_mfma_f32_16x16x32_bf16 v[200:203], a[40:43], v[72:75], v[200:203]
v_mfma_f32_16x16x32_bf16 v[232:235], a[40:43], v[76:79], v[232:235]
v_exp_f32 v33, v33
v_mfma_f32_16x16x32_bf16 v[236:239], a[44:47], v[76:79], v[236:239]
ds_read_b128 a[12:15], v1 offset:19456
v_mfma_f32_16x16x32_bf16 v[204:207], a[44:47], v[72:75], v[204:207]
v_exp_f32 v34, v34
v_mfma_f32_16x16x32_bf16 v[172:175], a[44:47], v[68:71], v[172:175]
v_exp_f32 v35, v35
v_mfma_f32_16x16x32_bf16 v[140:143], a[44:47], v[64:67], v[140:143]
v_mfma_f32_16x16x32_bf16 v[144:147], a[48:51], v[64:67], v[144:147]
ds_read_b128 a[16:19], v1 offset:20480
v_cvt_pk_bf16_f32 v50, v32, v33
v_cvt_pk_bf16_f32 v51, v34, v35
v_mfma_f32_16x16x32_bf16 v[176:179], a[48:51], v[68:71], v[176:179]
v_exp_f32 v36, v36
v_mfma_f32_16x16x32_bf16 v[208:211], a[48:51], v[72:75], v[208:211]
v_mfma_f32_16x16x32_bf16 v[240:243], a[48:51], v[76:79], v[240:243]
ds_read_b128 a[20:23], v1 offset:21504
v_exp_f32 v37, v37
v_mfma_f32_16x16x32_bf16 v[244:247], a[52:55], v[76:79], v[244:247]
v_mfma_f32_16x16x32_bf16 v[212:215], a[52:55], v[72:75], v[212:215]
v_exp_f32 v38, v38
v_mfma_f32_16x16x32_bf16 v[180:183], a[52:55], v[68:71], v[180:183]
v_exp_f32 v39, v39
v_mfma_f32_16x16x32_bf16 v[148:151], a[52:55], v[64:67], v[148:151]
ds_read_b128 a[24:27], v1 offset:22528
v_mfma_f32_16x16x32_bf16 v[152:155], a[56:59], v[64:67], v[152:155]
v_cvt_pk_bf16_f32 v54, v36, v37
v_cvt_pk_bf16_f32 v55, v38, v39
v_mfma_f32_16x16x32_bf16 v[184:187], a[56:59], v[68:71], v[184:187]
buffer_load_dwordx4 v3, s[88:91], s11 offen offset:1024 lds
v_mfma_f32_16x16x32_bf16 v[216:219], a[56:59], v[72:75], v[216:219]
v_exp_f32 v40, v40
v_mfma_f32_16x16x32_bf16 v[248:251], a[56:59], v[76:79], v[248:251]
v_mfma_f32_16x16x32_bf16 v[252:255], a[60:63], v[76:79], v[252:255]
ds_read_b128 a[28:31], v1 offset:23552
v_exp_f32 v41, v41
v_mfma_f32_16x16x32_bf16 v[220:223], a[60:63], v[72:75], v[220:223]
v_mfma_f32_16x16x32_bf16 v[188:191], a[60:63], v[68:71], v[188:191]
v_exp_f32 v42, v42
v_mfma_f32_16x16x32_bf16 v[156:159], a[60:63], v[64:67], v[156:159]
v_exp_f32 v43, v43
v_mfma_f32_16x16x32_bf16 a[224:227], a[240:243], v[64:67], a[224:227]
v_mfma_f32_16x16x32_bf16 a[228:231], a[240:243], v[68:71], a[228:231]
v_cvt_pk_bf16_f32 v58, v40, v41
v_cvt_pk_bf16_f32 v59, v42, v43
v_mfma_f32_16x16x32_bf16 a[232:235], a[240:243], v[72:75], a[232:235]
v_exp_f32 v44, v44
v_mfma_f32_16x16x32_bf16 a[236:239], a[240:243], v[76:79], a[236:239]
s_waitcnt lgkmcnt(7)
v_mfma_f32_16x16x32_bf16 v[16:19], a[0:3], a[160:163], v[96:99]
ds_read_b128 a[32:35], v1 offset:24576
v_exp_f32 v45, v45
s_waitcnt lgkmcnt(7)
v_mfma_f32_16x16x32_bf16 v[16:19], a[4:7], a[164:167], v[16:19]
s_waitcnt lgkmcnt(6)
v_mfma_f32_16x16x32_bf16 v[16:19], a[8:11], a[168:171], v[16:19]
v_exp_f32 v46, v46
s_waitcnt lgkmcnt(5)
v_mfma_f32_16x16x32_bf16 v[16:19], a[12:15], a[172:175], v[16:19]
ds_read_b128 a[36:39], v1 offset:25600
v_exp_f32 v47, v47
v_mfma_f32_16x16x32_bf16 v[20:23], a[0:3], a[176:179], v[84:87]
v_mfma_f32_16x16x32_bf16 v[20:23], a[4:7], a[180:183], v[20:23]
v_cvt_pk_bf16_f32 v62, v44, v45
v_cvt_pk_bf16_f32 v63, v46, v47
v_mfma_f32_16x16x32_bf16 v[20:23], a[8:11], a[184:187], v[20:23]
buffer_load_dwordx4 v3, s[88:91], s11 offen offset:2048 lds
v_mfma_f32_16x16x32_bf16 v[20:23], a[12:15], a[188:191], v[20:23]
ds_read_b128 a[40:43], v1 offset:26624
v_mfma_f32_16x16x32_bf16 v[24:27], a[0:3], a[192:195], v[88:91]
v_exp_f32 v16, v16
v_mfma_f32_16x16x32_bf16 v[24:27], a[4:7], a[196:199], v[24:27]
v_exp_f32 v17, v17
v_mfma_f32_16x16x32_bf16 v[24:27], a[8:11], a[200:203], v[24:27]
v_mfma_f32_16x16x32_bf16 v[24:27], a[12:15], a[204:207], v[24:27]
ds_read_b128 a[44:47], v1 offset:27648
v_exp_f32 v18, v18
v_mfma_f32_16x16x32_bf16 v[28:31], a[0:3], a[208:211], v[92:95]
v_exp_f32 v19, v19
v_mfma_f32_16x16x32_bf16 v[28:31], a[4:7], a[212:215], v[28:31]
v_mfma_f32_16x16x32_bf16 v[28:31], a[8:11], a[216:219], v[28:31]
ds_read_b128 a[48:51], v1 offset:28672
v_cvt_pk_bf16_f32 v64, v16, v17
v_cvt_pk_bf16_f32 v65, v18, v19
v_mfma_f32_16x16x32_bf16 v[28:31], a[12:15], a[220:223], v[28:31]
v_exp_f32 v20, v20
s_waitcnt lgkmcnt(8)
v_mfma_f32_16x16x32_bf16 v[32:35], a[16:19], a[160:163], v[100:103]
s_waitcnt lgkmcnt(7)
v_mfma_f32_16x16x32_bf16 v[32:35], a[20:23], a[164:167], v[32:35]
ds_read_b128 a[52:55], v1 offset:29696
v_exp_f32 v21, v21
s_waitcnt lgkmcnt(7)
v_mfma_f32_16x16x32_bf16 v[32:35], a[24:27], a[168:171], v[32:35]
s_waitcnt lgkmcnt(6)
v_mfma_f32_16x16x32_bf16 v[32:35], a[28:31], a[172:175], v[32:35]
v_exp_f32 v22, v22
v_mfma_f32_16x16x32_bf16 v[36:39], a[16:19], a[176:179], v[84:87]
v_exp_f32 v23, v23
v_mfma_f32_16x16x32_bf16 v[36:39], a[20:23], a[180:183], v[36:39]
ds_read_b128 a[56:59], v1 offset:30720
v_mfma_f32_16x16x32_bf16 v[36:39], a[24:27], a[184:187], v[36:39]
v_cvt_pk_bf16_f32 v68, v20, v21
v_cvt_pk_bf16_f32 v69, v22, v23
v_mfma_f32_16x16x32_bf16 v[36:39], a[28:31], a[188:191], v[36:39]
buffer_load_dwordx4 v3, s[88:91], s11 offen offset:3072 lds
v_mfma_f32_16x16x32_bf16 v[40:43], a[16:19], a[192:195], v[88:91]
v_exp_f32 v24, v24
v_mfma_f32_16x16x32_bf16 v[40:43], a[20:23], a[196:199], v[40:43]
ds_read_b128 a[60:63], v1 offset:31744
v_mfma_f32_16x16x32_bf16 v[40:43], a[24:27], a[200:203], v[40:43]
v_exp_f32 v25, v25
v_mfma_f32_16x16x32_bf16 v[40:43], a[28:31], a[204:207], v[40:43]
v_mfma_f32_16x16x32_bf16 v[44:47], a[16:19], a[208:211], v[92:95]
v_exp_f32 v26, v26
v_mfma_f32_16x16x32_bf16 v[44:47], a[20:23], a[212:215], v[44:47]
v_exp_f32 v27, v27
v_mfma_f32_16x16x32_bf16 v[44:47], a[24:27], a[216:219], v[44:47]
v_mfma_f32_16x16x32_bf16 v[44:47], a[28:31], a[220:223], v[44:47]
v_cvt_pk_bf16_f32 v72, v24, v25
v_cvt_pk_bf16_f32 v73, v26, v27
s_add_u32 s32, s32, 0x8000
s_add_u32 s11, s11, 0x8000
s_xor_b32 s18, s18, 0x8000
v_xor_b32 v1, 0x8000, v1
L_att_l1_1:
s_waitcnt vmcnt(16) lgkmcnt(0)
s_barrier
v_mfma_f32_16x16x32_bf16 v[128:131], a[32:35], v[48:51], v[128:131]
ds_read_b128 a[0:3], v2 offset:0
v_exp_f32 v28, v28
v_mfma_f32_16x16x32_bf16 v[160:163], a[32:35], v[52:55], v[160:163]
v_mfma_f32_16x16x32_bf16 v[192:195], a[32:35], v[56:59], v[192:195]
v_exp_f32 v29, v29
v_mfma_f32_16x16x32_bf16 v[224:227], a[32:35], v[60:63], v[224:227]
ds_read_b128 a[4:7], v2 offset:1024
v_mfma_f32_16x16x32_bf16 v[228:231], a[36:39], v[60:63], v[228:231]
v_exp_f32 v30, v30
v_mfma_f32_16x16x32_bf16 v[196:199], a[36:39], v[56:59], v[196:199]
v_exp_f32 v31, v31
v_mfma_f32_16x16x32_bf16 v[164:167], a[36:39], v[52:55], v[164:167]
s_add_u32 m0, s18, 0x0
v_mfma_f32_16x16x32_bf16 v[132:135], a[36:39], v[48:51], v[132:135]
buffer_load_dwordx4 v3, s[88:91], s32 offen offset:0 lds
v_mfma_f32_16x16x32_bf16 v[136:139], a[40:43], v[48:51], v[136:139]
ds_read_b128 a[8:11], v2 offset:2048
v_cvt_pk_bf16_f32 v76, v28, v29
v_cvt_pk_bf16_f32 v77, v30, v31
v_mfma_f32_16x16x32_bf16 v[168:171], a[40:43], v[52:55], v[168:171]
v_exp_f32 v32, v32
v_mfma_f32_16x16x32_bf16 v[200:203], a[40:43], v[56:59], v[200:203]
v_mfma_f32_16x16x32_bf16 v[232:235], a[40:43], v[60:63], v[232:235]
v_exp_f32 v33, v33
v_mfma_f32_16x16x32_bf16 v[236:239], a[44:47], v[60:63], v[236:239]
ds_read_b128 a[12:15], v2 offset:3072
v_mfma_f32_16x16x32_bf16 v[204:207], a[44:47], v[56:59], v[204:207]
v_exp_f32 v34, v34
v_mfma_f32_16x16x32_bf16 v[172:175], a[44:47], v[52:55], v[172:175]
v_exp_f32 v35, v35
v_mfma_f32_16x16x32_bf16 v[140:143], a[44:47], v[48:51], v[140:143]
v_mfma_f32_16x16x32_bf16 v[144:147], a[48:51], v[48:51], v[144:147]
ds_read_b128 a[16:19], v2 offset:4096
v_cvt_pk_bf16_f32 v66, v32, v33
v_cvt_pk_bf16_f32 v67, v34, v35
v_mfma_f32_16x16x32_bf16 v[176:179], a[48:51], v[52:55], v[176:179]
v_exp_f32 v36, v36
v_mfma_f32_16x16x32_bf16 v[208:211], a[48:51], v[56:59], v[208:211]
v_mfma_f32_16x16x32_bf16 v[240:243], a[48:51], v[60:63], v[240:243]
ds_read_b128 a[20:23], v2 offset:5120
v_exp_f32 v37, v37
v_mfma_f32_16x16x32_bf16 v[244:247], a[52:55], v[60:63], v[244:247]
v_mfma_f32_16x16x32_bf16 v[212:215], a[52:55], v[56:59], v[212:215]
v_exp_f32 v38, v38
v_mfma_f32_16x16x32_bf16 v[180:183], a[52:55], v[52:55], v[180:183]
buffer_load_dwordx4 v3, s[88:91], s32 offen offset:1024 lds
v_mfma_f32_16x16x32_bf16 v[148:151], a[52:55], v[48:51], v[148:151]
v_exp_f32 v39, v39
v_mfma_f32_16x16x32_bf16 v[152:155], a[56:59], v[48:51], v[152:155]
ds_read_b128 a[24:27], v2 offset:6144
v_mfma_f32_16x16x32_bf16 v[184:187], a[56:59], v[52:55], v[184:187]
v_cvt_pk_bf16_f32 v70, v36, v37
v_cvt_pk_bf16_f32 v71, v38, v39
v_mfma_f32_16x16x32_bf16 v[216:219], a[56:59], v[56:59], v[216:219]
v_exp_f32 v40, v40
v_mfma_f32_16x16x32_bf16 v[248:251], a[56:59], v[60:63], v[248:251]
v_mfma_f32_16x16x32_bf16 v[252:255], a[60:63], v[60:63], v[252:255]
ds_read_b128 a[28:31], v2 offset:7168
v_exp_f32 v41, v41
v_mfma_f32_16x16x32_bf16 v[220:223], a[60:63], v[56:59], v[220:223]
v_mfma_f32_16x16x32_bf16 v[188:191], a[60:63], v[52:55], v[188:191]
v_exp_f32 v42, v42
v_mfma_f32_16x16x32_bf16 v[156:159], a[60:63], v[48:51], v[156:159]
v_exp_f32 v43, v43
v_mfma_f32_16x16x32_bf16 a[224:227], a[240:243], v[48:51], a[224:227]
v_mfma_f32_16x16x32_bf16 a[228:231], a[240:243], v[52:55], a[228:231]
v_cvt_pk_bf16_f32 v74, v40, v41
v_cvt_pk_bf16_f32 v75, v42, v43
v_mfma_f32_16x16x32_bf16 a[232:235], a[240:243], v[56:59], a[232:235]
v_exp_f32 v44, v44
v_mfma_f32_16x16x32_bf16 a[236:239], a[240:243], v[60:63], a[236:239]
s_waitcnt lgkmcnt(7)
v_mfma_f32_16x16x32_bf16 v[20:23], a[0:3], a[176:179], v[104:107]
ds_read_b128 a[32:35], v2 offset:8192
v_exp_f32 v45, v45
s_waitcnt lgkmcnt(7)
v_mfma_f32_16x16x32_bf16 v[20:23], a[4:7], a[180:183], v[20:23]
buffer_load_dwordx4 v3, s[88:91], s32 offen offset:2048 lds
s_waitcnt lgkmcnt(6)
v_mfma_f32_16x16x32_bf16 v[20:23], a[8:11], a[184:187], v[20:23]
s_waitcnt lgkmcnt(5)
v_mfma_f32_16x16x32_bf16 v[20:23], a[12:15], a[188:191], v[20:23]
ds_read_b128 a[36:39], v2 offset:9216
v_exp_f32 v46, v46
v_mfma_f32_16x16x32_bf16 v[24:27], a[0:3], a[192:195], v[88:91]
v_exp_f32 v47, v47
v_mfma_f32_16x16x32_bf16 v[24:27], a[4:7], a[196:199], v[24:27]
ds_read_b128 a[40:43], v2 offset:10240
v_mfma_f32_16x16x32_bf16 v[24:27], a[8:11], a[200:203], v[24:27]
v_cvt_pk_bf16_f32 v78, v44, v45
v_cvt_pk_bf16_f32 v79, v46, v47
v_mfma_f32_16x16x32_bf16 v[24:27], a[12:15], a[204:207], v[24:27]
v_mfma_f32_16x16x32_bf16 v[28:31], a[0:3], a[208:211], v[92:95]
ds_read_b128 a[44:47], v2 offset:11264
v_exp_f32 v20, v20
v_mfma_f32_16x16x32_bf16 v[28:31], a[4:7], a[212:215], v[28:31]
v_exp_f32 v21, v21
v_mfma_f32_16x16x32_bf16 v[28:31], a[8:11], a[216:219], v[28:31]
ds_read_b128 a[48:51], v2 offset:12288
v_mfma_f32_16x16x32_bf16 v[28:31], a[12:15], a[220:223], v[28:31]
v_exp_f32 v22, v22
s_waitcnt lgkmcnt(8)
v_mfma_f32_16x16x32_bf16 v[36:39], a[16:19], a[176:179], v[108:111]
ds_read_b128 a[52:55], v2 offset:13312
v_exp_f32 v23, v23
s_waitcnt lgkmcnt(8)
v_mfma_f32_16x16x32_bf16 v[36:39], a[20:23], a[180:183], v[36:39]
s_waitcnt lgkmcnt(7)
v_mfma_f32_16x16x32_bf16 v[36:39], a[24:27], a[184:187], v[36:39]
v_cvt_pk_bf16_f32 v52, v20, v21
v_cvt_pk_bf16_f32 v53, v22, v23
s_waitcnt lgkmcnt(6)
v_mfma_f32_16x16x32_bf16 v[36:39], a[28:31], a[188:191], v[36:39]
ds_read_b128 a[56:59], v2 offset:14336
v_exp_f32 v24, v24
v_mfma_f32_16x16x32_bf16 v[40:43], a[16:19], a[192:195], v[88:91]
buffer_load_dwordx4 v3, s[88:91], s32 offen offset:3072 lds
v_mfma_f32_16x16x32_bf16 v[40:43], a[20:23], a[196:199], v[40:43]
v_mfma_f32_16x16x32_bf16 v[40:43], a[24:27], a[200:203], v[40:43]
ds_read_b128 a[60:63], v2 offset:15360
v_exp_f32 v25, v25
v_mfma_f32_16x16x32_bf16 v[40:43], a[28:31], a[204:207], v[40:43]
v_mfma_f32_16x16x32_bf16 v[44:47], a[16:19], a[208:211], v[92:95]
v_exp_f32 v26, v26
v_mfma_f32_16x16x32_bf16 v[44:47], a[20:23], a[212:215], v[44:47]
v_exp_f32 v27, v27
v_mfma_f32_16x16x32_bf16 v[44:47], a[24:27], a[216:219], v[44:47]
v_mfma_f32_16x16x32_bf16 v[44:47], a[28:31], a[220:223], v[44:47]
v_cvt_pk_bf16_f32 v56, v24, v25
v_cvt_pk_bf16_f32 v57, v26, v27
s_waitcnt lgkmcnt(0)
v_mfma_f32_16x16x32_bf16 v[128:131], a[32:35], v[64:67], v[128:131]
ds_read_b128 a[0:3], v2 offset:16384
v_exp_f32 v28, v28
v_mfma_f32_16x16x32_bf16 v[160:163], a[32:35], v[68:71], v[160:163]
v_mfma_f32_16x16x32_bf16 v[192:195], a[32:35], v[72:75], v[192:195]
v_exp_f32 v29, v29
v_mfma_f32_16x16x32_bf16 v[224:227], a[32:35], v[76:79], v[224:227]
ds_read_b128 a[4:7], v2 offset:17408
v_mfma_f32_16x16x32_bf16 v[228:231], a[36:39], v[76:79], v[228:231]
v_exp_f32 v30, v30
v_mfma_f32_16x16x32_bf16 v[196:199], a[36:39], v[72:75], v[196:199]
s_add_u32 m0, s18, 0x1000
v_mfma_f32_16x16x32_bf16 v[164:167], a[36:39], v[68:71], v[164:167]
buffer_load_dwordx4 v3, s[88:91], s11 offen offset:0 lds
v_mfma_f32_16x16x32_bf16 v[132:135], a[36:39], v[64:67], v[132:135]
v_exp_f32 v31, v31
v_mfma_f32_16x16x32_bf16 v[136:139], a[40:43], v[64:67], v[136:139]
ds_read_b128 a[8:11], v2 offset:18432
v_mfma_f32_16x16x32_bf16 v[168:171], a[40:43], v[68:71], v[168:171]
v_cvt_pk_bf16_f32 v60, v28, v29
v_cvt_pk_bf16_f32 v61, v30, v31
v_mfma_f32_16x16x32_bf16 v[200:203], a[40:43], v[72:75], v[200:203]
v_mfma_f32_16x16x32_bf16 v[232:235], a[40:43], v[76:79], v[232:235]
v_exp_f32 v36, v36
v_mfma_f32_16x16x32_bf16 v[236:239], a[44:47], v[76:79], v[236:239]
ds_read_b128 a[12:15], v2 offset:19456
v_mfma_f32_16x16x32_bf16 v[204:207], a[44:47], v[72:75], v[204:207]
v_exp_f32 v37, v37
v_mfma_f32_16x16x32_bf16 v[172:175], a[44:47], v[68:71], v[172:175]
v_mfma_f32_16x16x32_bf16 v[140:143], a[44:47], v[64:67], v[140:143]
v_exp_f32 v38, v38
v_mfma_f32_16x16x32_bf16 v[144:147], a[48:51], v[64:67], v[144:147]
ds_read_b128 a[16:19], v2 offset:20480
v_mfma_f32_16x16x32_bf16 v[176:179], a[48:51], v[68:71], v[176:179]
v_exp_f32 v39, v39
v_mfma_f32_16x16x32_bf16 v[208:211], a[48:51], v[72:75], v[208:211]
v_mfma_f32_16x16x32_bf16 v[240:243], a[48:51], v[76:79], v[240:243]
buffer_load_dwordx4 v3, s[88:91], s11 offen offset:1024 lds
v_mfma_f32_16x16x32_bf16 v[244:247], a[52:55], v[76:79], v[244:247]
ds_read_b128 a[20:23], v2 offset:21504
v_cvt_pk_bf16_f32 v54, v36, v37
v_cvt_pk_bf16_f32 v55, v38, v39
v_mfma_f32_16x16x32_bf16 v[212:215], a[52:55], v[72:75], v[212:215]
v_mfma_f32_16x16x32_bf16 v[180:183], a[52:55], v[68:71], v[180:183]
v_exp_f32 v40, v40
v_mfma_f32_16x16x32_bf16 v[148:151], a[52:55], v[64:67], v[148:151]
v_mfma_f32_16x16x32_bf16 v[152:155], a[56:59], v[64:67], v[152:155]
ds_read_b128 a[24:27], v2 offset:22528
v_exp_f32 v41, v41
v_mfma_f32_16x16x32_bf16 v[184:187], a[56:59], v[68:71], v[184:187]
v_mfma_f32_16x16x32_bf16 v[216:219], a[56:59], v[72:75], v[216:219]
v_exp_f32 v42, v42
v_mfma_f32_16x16x32_bf16 v[248:251], a[56:59], v[76:79], v[248:251]
v_exp_f32 v43, v43
v_mfma_f32_16x16x32_bf16 v[252:255], a[60:63], v[76:79], v[252:255]
ds_read_b128 a[28:31], v2 offset:23552
v_mfma_f32_16x16x32_bf16 v[220:223], a[60:63], v[72:75], v[220:223]
v_cvt_pk_bf16_f32 v58, v40, v41
v_cvt_pk_bf16_f32 v59, v42, v43
v_mfma_f32_16x16x32_bf16 v[188:191], a[60:63], v[68:71], v[188:191]
v_mfma_f32_16x16x32_bf16 v[156:159], a[60:63], v[64:67], v[156:159]
v_exp_f32 v44, v44
v_mfma_f32_16x16x32_bf16 a[224:227], a[240:243], v[64:67], a[224:227]
buffer_load_dwordx4 v3, s[88:91], s11 offen offset:2048 lds
v_mfma_f32_16x16x32_bf16 a[228:231], a[240:243], v[68:71], a[228:231]
v_mfma_f32_16x16x32_bf16 a[232:235], a[240:243], v[72:75], a[232:235]
v_exp_f32 v45, v45
v_mfma_f32_16x16x32_bf16 a[236:239], a[240:243], v[76:79], a[236:239]
s_waitcnt lgkmcnt(7)
v_mfma_f32_16x16x32_bf16 v[24:27], a[0:3], a[192:195], v[88:91]
ds_read_b128 a[32:35], v2 offset:24576
v_exp_f32 v46, v46
s_waitcnt lgkmcnt(7)
v_mfma_f32_16x16x32_bf16 v[24:27], a[4:7], a[196:199], v[24:27]
ds_read_b128 a[36:39], v2 offset:25600
s_waitcnt lgkmcnt(7)
v_mfma_f32_16x16x32_bf16 v[24:27], a[8:11], a[200:203], v[24:27]
v_exp_f32 v47, v47
s_waitcnt lgkmcnt(6)
v_mfma_f32_16x16x32_bf16 v[24:27], a[12:15], a[204:207], v[24:27]
ds_read_b128 a[40:43], v2 offset:26624
v_mfma_f32_16x16x32_bf16 v[28:31], a[0:3], a[208:211], v[92:95]
ds_read_b128 a[44:47], v2 offset:27648
v_cvt_pk_bf16_f32 v62, v44, v45
v_cvt_pk_bf16_f32 v63, v46, v47
v_mfma_f32_16x16x32_bf16 v[28:31], a[4:7], a[212:215], v[28:31]
v_mfma_f32_16x16x32_bf16 v[28:31], a[8:11], a[216:219], v[28:31]
ds_read_b128 a[48:51], v2 offset:28672
v_mfma_f32_16x16x32_bf16 v[28:31], a[12:15], a[220:223], v[28:31]
ds_read_b128 a[52:55], v2 offset:29696
s_waitcnt lgkmcnt(9)
v_mfma_f32_16x16x32_bf16 v[40:43], a[16:19], a[192:195], v[88:91]
v_exp_f32 v24, v24
s_waitcnt lgkmcnt(8)
v_mfma_f32_16x16x32_bf16 v[40:43], a[20:23], a[196:199], v[40:43]
buffer_load_dwordx4 v3, s[88:91], s11 offen offset:3072 lds
s_waitcnt lgkmcnt(7)
v_mfma_f32_16x16x32_bf16 v[40:43], a[24:27], a[200:203], v[40:43]
ds_read_b128 a[56:59], v2 offset:30720
v_exp_f32 v25, v25
s_waitcnt lgkmcnt(7)
v_mfma_f32_16x16x32_bf16 v[40:43], a[28:31], a[204:207], v[40:43]
ds_read_b128 a[60:63], v2 offset:31744
v_exp_f32 v26, v26
v_mfma_f32_16x16x32_bf16 v[44:47], a[16:19], a[208:211], v[92:95]
v_mfma_f32_16x16x32_bf16 v[44:47], a[20:23], a[212:215], v[44:47]
v_exp_f32 v27, v27
v_mfma_f32_16x16x32_bf16 v[44:47], a[24:27], a[216:219], v[44:47]
v_mfma_f32_16x16x32_bf16 v[44:47], a[28:31], a[220:223], v[44:47]
v_cvt_pk_bf16_f32 v72, v24, v25
v_cvt_pk_bf16_f32 v73, v26, v27
s_add_u32 s32, s32, 0x8000
s_add_u32 s11, s11, 0x8000
v_xor_b32 v2, 0x8000, v2
s_sub_u32 s15, 7, s6
s_lshl_b32 s15, s15, 1
s_cbranch_scc0 L_att_lh0_1
s_waitcnt vmcnt(16) lgkmcnt(0)
s_barrier
v_mfma_f32_16x16x32_bf16 v[160:163], a[32:35], v[52:55], v[160:163]
ds_read_b128 a[0:3], v1 offset:0
v_exp_f32 v28, v28
v_mfma_f32_16x16x32_bf16 v[192:195], a[32:35], v[56:59], v[192:195]
v_mfma_f32_16x16x32_bf16 v[224:227], a[32:35], v[60:63], v[224:227]
ds_read_b128 a[4:7], v1 offset:1024
v_exp_f32 v29, v29
v_mfma_f32_16x16x32_bf16 v[228:231], a[36:39], v[60:63], v[228:231]
v_mfma_f32_16x16x32_bf16 v[196:199], a[36:39], v[56:59], v[196:199]
s_add_u32 m0, s18, 0x10000
v_exp_f32 v30, v30
v_mfma_f32_16x16x32_bf16 v[164:167], a[36:39], v[52:55], v[164:167]
buffer_load_dwordx4 v3, s[88:91], s32 offen offset:0 lds
v_mfma_f32_16x16x32_bf16 v[168:171], a[40:43], v[52:55], v[168:171]
ds_read_b128 a[8:11], v1 offset:2048
v_mfma_f32_16x16x32_bf16 v[200:203], a[40:43], v[56:59], v[200:203]
v_exp_f32 v31, v31
v_mfma_f32_16x16x32_bf16 v[232:235], a[40:43], v[60:63], v[232:235]
ds_read_b128 a[12:15], v1 offset:3072
v_mfma_f32_16x16x32_bf16 v[236:239], a[44:47], v[60:63], v[236:239]
v_cvt_pk_bf16_f32 v76, v28, v29
v_cvt_pk_bf16_f32 v77, v30, v31
v_mfma_f32_16x16x32_bf16 v[204:207], a[44:47], v[56:59], v[204:207]
v_mfma_f32_16x16x32_bf16 v[172:175], a[44:47], v[52:55], v[172:175]
ds_read_b128 a[16:19], v1 offset:4096
v_exp_f32 v40, v40
v_mfma_f32_16x16x32_bf16 v[176:179], a[48:51], v[52:55], v[176:179]
v_mfma_f32_16x16x32_bf16 v[208:211], a[48:51], v[56:59], v[208:211]
v_exp_f32 v41, v41
v_mfma_f32_16x16x32_bf16 v[240:243], a[48:51], v[60:63], v[240:243]
ds_read_b128 a[20:23], v1 offset:5120
v_mfma_f32_16x16x32_bf16 v[244:247], a[52:55], v[60:63], v[244:247]
buffer_load_dwordx4 v3, s[88:91], s32 offen offset:1024 lds
v_mfma_f32_16x16x32_bf16 v[212:215], a[52:55], v[56:59], v[212:215]
v_exp_f32 v42, v42
v_mfma_f32_16x16x32_bf16 v[180:183], a[52:55], v[52:55], v[180:183]
ds_read_b128 a[24:27], v1 offset:6144
v_mfma_f32_16x16x32_bf16 v[184:187], a[56:59], v[52:55], v[184:187]
v_exp_f32 v43, v43
v_mfma_f32_16x16x32_bf16 v[216:219], a[56:59], v[56:59], v[216:219]
v_mfma_f32_16x16x32_bf16 v[248:251], a[56:59], v[60:63], v[248:251]
ds_read_b128 a[28:31], v1 offset:7168
v_cvt_pk_bf16_f32 v74, v40, v41
v_cvt_pk_bf16_f32 v75, v42, v43
v_mfma_f32_16x16x32_bf16 v[252:255], a[60:63], v[60:63], v[252:255]
v_mfma_f32_16x16x32_bf16 v[220:223], a[60:63], v[56:59], v[220:223]
v_exp_f32 v44, v44
v_mfma_f32_16x16x32_bf16 v[188:191], a[60:63], v[52:55], v[188:191]
v_mfma_f32_16x16x32_bf16 a[228:231], a[240:243], v[52:55], a[228:231]
v_exp_f32 v45, v45
v_mfma_f32_16x16x32_bf16 a[232:235], a[240:243], v[56:59], a[232:235]
buffer_load_dwordx4 v3, s[88:91], s32 offen offset:2048 lds
v_mfma_f32_16x16x32_bf16 a[236:239], a[240:243], v[60:63], a[236:239]
s_waitcnt lgkmcnt(7)
v_mfma_f32_16x16x32_bf16 v[24:27], a[0:3], a[192:195], v[88:91]
ds_read_b128 a[32:35], v1 offset:8192
v_exp_f32 v46, v46
s_waitcnt lgkmcnt(7)
v_mfma_f32_16x16x32_bf16 v[24:27], a[4:7], a[196:199], v[24:27]
ds_read_b128 a[36:39], v1 offset:9216
s_waitcnt lgkmcnt(7)
v_mfma_f32_16x16x32_bf16 v[24:27], a[8:11], a[200:203], v[24:27]
v_exp_f32 v47, v47
s_waitcnt lgkmcnt(6)
v_mfma_f32_16x16x32_bf16 v[24:27], a[12:15], a[204:207], v[24:27]
ds_read_b128 a[40:43], v1 offset:10240
v_mfma_f32_16x16x32_bf16 v[28:31], a[0:3], a[208:211], v[92:95]
ds_read_b128 a[44:47], v1 offset:11264
v_cvt_pk_bf16_f32 v78, v44, v45
v_cvt_pk_bf16_f32 v79, v46, v47
v_mfma_f32_16x16x32_bf16 v[28:31], a[4:7], a[212:215], v[28:31]
v_mfma_f32_16x16x32_bf16 v[28:31], a[8:11], a[216:219], v[28:31]
ds_read_b128 a[48:51], v1 offset:12288
v_mfma_f32_16x16x32_bf16 v[28:31], a[12:15], a[220:223], v[28:31]
ds_read_b128 a[52:55], v1 offset:13312
s_waitcnt lgkmcnt(9)
v_mfma_f32_16x16x32_bf16 v[40:43], a[16:19], a[192:195], v[88:91]
buffer_load_dwordx4 v3, s[88:91], s32 offen offset:3072 lds
s_waitcnt lgkmcnt(8)
v_mfma_f32_16x16x32_bf16 v[40:43], a[20:23], a[196:199], v[40:43]
v_exp_f32 v24, v24
s_waitcnt lgkmcnt(7)
v_mfma_f32_16x16x32_bf16 v[40:43], a[24:27], a[200:203], v[40:43]
ds_read_b128 a[56:59], v1 offset:14336
v_exp_f32 v25, v25
s_waitcnt lgkmcnt(7)
v_mfma_f32_16x16x32_bf16 v[40:43], a[28:31], a[204:207], v[40:43]
ds_read_b128 a[60:63], v1 offset:15360
v_exp_f32 v26, v26
v_mfma_f32_16x16x32_bf16 v[44:47], a[16:19], a[208:211], v[92:95]
v_mfma_f32_16x16x32_bf16 v[44:47], a[20:23], a[212:215], v[44:47]
v_exp_f32 v27, v27
v_mfma_f32_16x16x32_bf16 v[44:47], a[24:27], a[216:219], v[44:47]
v_mfma_f32_16x16x32_bf16 v[44:47], a[28:31], a[220:223], v[44:47]
v_cvt_pk_bf16_f32 v56, v24, v25
v_cvt_pk_bf16_f32 v57, v26, v27
s_waitcnt lgkmcnt(0)
v_mfma_f32_16x16x32_bf16 v[192:195], a[32:35], v[72:75], v[192:195]
ds_read_b128 a[0:3], v1 offset:16384
v_exp_f32 v28, v28
v_mfma_f32_16x16x32_bf16 v[224:227], a[32:35], v[76:79], v[224:227]
ds_read_b128 a[4:7], v1 offset:17408
v_mfma_f32_16x16x32_bf16 v[228:231], a[36:39], v[76:79], v[228:231]
v_exp_f32 v29, v29
v_mfma_f32_16x16x32_bf16 v[196:199], a[36:39], v[72:75], v[196:199]
s_add_u32 m0, s18, 0x11000
ds_read_b128 a[8:11], v1 offset:18432
v_exp_f32 v30, v30
v_mfma_f32_16x16x32_bf16 v[200:203], a[40:43], v[72:75], v[200:203]
buffer_load_dwordx4 v3, s[88:91], s11 offen offset:0 lds
v_mfma_f32_16x16x32_bf16 v[232:235], a[40:43], v[76:79], v[232:235]
ds_read_b128 a[12:15], v1 offset:19456
v_mfma_f32_16x16x32_bf16 v[236:239], a[44:47], v[76:79], v[236:239]
v_exp_f32 v31, v31
v_mfma_f32_16x16x32_bf16 v[204:207], a[44:47], v[72:75], v[204:207]
ds_read_b128 a[16:19], v1 offset:20480
v_cvt_pk_bf16_f32 v60, v28, v29
v_cvt_pk_bf16_f32 v61, v30, v31
v_mfma_f32_16x16x32_bf16 v[208:211], a[48:51], v[72:75], v[208:211]
ds_read_b128 a[20:23], v1 offset:21504
v_mfma_f32_16x16x32_bf16 v[240:243], a[48:51], v[76:79], v[240:243]
v_exp_f32 v40, v40
v_mfma_f32_16x16x32_bf16 v[244:247], a[52:55], v[76:79], v[244:247]
ds_read_b128 a[24:27], v1 offset:22528
v_exp_f32 v41, v41
v_mfma_f32_16x16x32_bf16 v[212:215], a[52:55], v[72:75], v[212:215]
ds_read_b128 a[28:31], v1 offset:23552
v_mfma_f32_16x16x32_bf16 v[216:219], a[56:59], v[72:75], v[216:219]
buffer_load_dwordx4 v3, s[88:91], s11 offen offset:1024 lds
v_mfma_f32_16x16x32_bf16 v[248:251], a[56:59], v[76:79], v[248:251]
v_exp_f32 v42, v42
v_mfma_f32_16x16x32_bf16 v[252:255], a[60:63], v[76:79], v[252:255]
v_exp_f32 v43, v43
v_mfma_f32_16x16x32_bf16 v[220:223], a[60:63], v[72:75], v[220:223]
v_mfma_f32_16x16x32_bf16 a[232:235], a[240:243], v[72:75], a[232:235]
v_cvt_pk_bf16_f32 v58, v40, v41
v_cvt_pk_bf16_f32 v59, v42, v43
v_mfma_f32_16x16x32_bf16 a[236:239], a[240:243], v[76:79], a[236:239]
v_exp_f32 v44, v44
s_waitcnt lgkmcnt(7)
v_mfma_f32_16x16x32_bf16 v[24:27], a[0:3], a[192:195], v[88:91]
ds_read_b128 a[32:35], v1 offset:24576
s_waitcnt lgkmcnt(7)
v_mfma_f32_16x16x32_bf16 v[24:27], a[4:7], a[196:199], v[24:27]
ds_read_b128 a[36:39], v1 offset:25600
v_exp_f32 v45, v45
s_waitcnt lgkmcnt(7)
v_mfma_f32_16x16x32_bf16 v[24:27], a[8:11], a[200:203], v[24:27]
buffer_load_dwordx4 v3, s[88:91], s11 offen offset:2048 lds
s_waitcnt lgkmcnt(6)
v_mfma_f32_16x16x32_bf16 v[24:27], a[12:15], a[204:207], v[24:27]
ds_read_b128 a[40:43], v1 offset:26624
v_exp_f32 v46, v46
v_mfma_f32_16x16x32_bf16 v[28:31], a[0:3], a[208:211], v[92:95]
v_mfma_f32_16x16x32_bf16 v[28:31], a[4:7], a[212:215], v[28:31]
ds_read_b128 a[44:47], v1 offset:27648
v_exp_f32 v47, v47
v_mfma_f32_16x16x32_bf16 v[28:31], a[8:11], a[216:219], v[28:31]
ds_read_b128 a[48:51], v1 offset:28672
v_cvt_pk_bf16_f32 v62, v44, v45
v_cvt_pk_bf16_f32 v63, v46, v47
v_mfma_f32_16x16x32_bf16 v[28:31], a[12:15], a[220:223], v[28:31]
ds_read_b128 a[52:55], v1 offset:29696
s_waitcnt lgkmcnt(9)
v_mfma_f32_16x16x32_bf16 v[40:43], a[16:19], a[192:195], v[88:91]
v_exp_f32 v24, v24
s_waitcnt lgkmcnt(8)
v_mfma_f32_16x16x32_bf16 v[40:43], a[20:23], a[196:199], v[40:43]
ds_read_b128 a[56:59], v1 offset:30720
v_exp_f32 v25, v25
s_waitcnt lgkmcnt(8)
v_mfma_f32_16x16x32_bf16 v[40:43], a[24:27], a[200:203], v[40:43]
buffer_load_dwordx4 v3, s[88:91], s11 offen offset:3072 lds
s_waitcnt lgkmcnt(7)
v_mfma_f32_16x16x32_bf16 v[40:43], a[28:31], a[204:207], v[40:43]
ds_read_b128 a[60:63], v1 offset:31744
v_mfma_f32_16x16x32_bf16 v[44:47], a[16:19], a[208:211], v[92:95]
v_exp_f32 v26, v26
v_mfma_f32_16x16x32_bf16 v[44:47], a[20:23], a[212:215], v[44:47]
v_exp_f32 v27, v27
v_mfma_f32_16x16x32_bf16 v[44:47], a[24:27], a[216:219], v[44:47]
v_mfma_f32_16x16x32_bf16 v[44:47], a[28:31], a[220:223], v[44:47]
v_cvt_pk_bf16_f32 v72, v24, v25
v_cvt_pk_bf16_f32 v73, v26, v27
s_add_u32 s32, s32, 0x8000
s_add_u32 s11, s11, 0x8000
s_xor_b32 s18, s18, 0x8000
v_xor_b32 v1, 0x8000, v1
s_nop 7
v_accvgpr_read_b32 v4, a224
v_accvgpr_read_b32 v6, a228
s_mov_b32 s8, 0x5f800000
v_cmp_nge_f32 s[36:37], s8, v4
v_cmp_nge_f32 s[38:39], s8, v6
v_rcp_f32 v4, v4
v_rcp_f32 v6, v6
s_or_b64 s[34:35], s[34:35], s[36:37]
s_or_b64 s[34:35], s[34:35], s[38:39]
v_pk_mul_f32 v[128:129], v[128:129], v[4:5] op_sel_hi:[1,0]
v_pk_mul_f32 v[130:131], v[130:131], v[4:5] op_sel_hi:[1,0]
v_pk_mul_f32 v[132:133], v[132:133], v[4:5] op_sel_hi:[1,0]
v_pk_mul_f32 v[134:135], v[134:135], v[4:5] op_sel_hi:[1,0]
v_cvt_pk_bf16_f32 v128, v128, v129
v_cvt_pk_bf16_f32 v129, v130, v131
v_cvt_pk_bf16_f32 v130, v132, v133
v_cvt_pk_bf16_f32 v131, v134, v135
s_add_u32 s8, s28, 0x0
buffer_store_dwordx4 v[128:131], v3, s[88:91], s8 offen
v_pk_mul_f32 v[136:137], v[136:137], v[4:5] op_sel_hi:[1,0]
v_pk_mul_f32 v[138:139], v[138:139], v[4:5] op_sel_hi:[1,0]
v_pk_mul_f32 v[140:141], v[140:141], v[4:5] op_sel_hi:[1,0]
v_pk_mul_f32 v[142:143], v[142:143], v[4:5] op_sel_hi:[1,0]
v_cvt_pk_bf16_f32 v136, v136, v137
v_cvt_pk_bf16_f32 v137, v138, v139
v_cvt_pk_bf16_f32 v138, v140, v141
v_cvt_pk_bf16_f32 v139, v142, v143
s_add_u32 s8, s28, 0x2000
buffer_store_dwordx4 v[136:139], v3, s[88:91], s8 offen
v_pk_mul_f32 v[144:145], v[144:145], v[4:5] op_sel_hi:[1,0]
v_pk_mul_f32 v[146:147], v[146:147], v[4:5] op_sel_hi:[1,0]
v_pk_mul_f32 v[148:149], v[148:149], v[4:5] op_sel_hi:[1,0]
v_pk_mul_f32 v[150:151], v[150:151], v[4:5] op_sel_hi:[1,0]
v_cvt_pk_bf16_f32 v144, v144, v145
v_cvt_pk_bf16_f32 v145, v146, v147
v_cvt_pk_bf16_f32 v146, v148, v149
v_cvt_pk_bf16_f32 v147, v150, v151
s_add_u32 s8, s28, 0x4000
buffer_store_dwordx4 v[144:147], v3, s[88:91], s8 offen
v_pk_mul_f32 v[152:153], v[152:153], v[4:5] op_sel_hi:[1,0]
v_pk_mul_f32 v[154:155], v[154:155], v[4:5] op_sel_hi:[1,0]
v_pk_mul_f32 v[156:157], v[156:157], v[4:5] op_sel_hi:[1,0]
v_pk_mul_f32 v[158:159], v[158:159], v[4:5] op_sel_hi:[1,0]
v_cvt_pk_bf16_f32 v152, v152, v153
v_cvt_pk_bf16_f32 v153, v154, v155
v_cvt_pk_bf16_f32 v154, v156, v157
v_cvt_pk_bf16_f32 v155, v158, v159
s_add_u32 s8, s28, 0x6000
buffer_store_dwordx4 v[152:155], v3, s[88:91], s8 offen
v_pk_mul_f32 v[160:161], v[160:161], v[6:7] op_sel_hi:[1,0]
v_pk_mul_f32 v[162:163], v[162:163], v[6:7] op_sel_hi:[1,0]
v_pk_mul_f32 v[164:165], v[164:165], v[6:7] op_sel_hi:[1,0]
v_pk_mul_f32 v[166:167], v[166:167], v[6:7] op_sel_hi:[1,0]
v_cvt_pk_bf16_f32 v160, v160, v161
v_cvt_pk_bf16_f32 v161, v162, v163
v_cvt_pk_bf16_f32 v162, v164, v165
v_cvt_pk_bf16_f32 v163, v166, v167
s_add_u32 s8, s29, 0x0
buffer_store_dwordx4 v[160:163], v3, s[88:91], s8 offen
v_pk_mul_f32 v[168:169], v[168:169], v[6:7] op_sel_hi:[1,0]
v_pk_mul_f32 v[170:171], v[170:171], v[6:7] op_sel_hi:[1,0]
v_pk_mul_f32 v[172:173], v[172:173], v[6:7] op_sel_hi:[1,0]
v_pk_mul_f32 v[174:175], v[174:175], v[6:7] op_sel_hi:[1,0]
v_cvt_pk_bf16_f32 v168, v168, v169
v_cvt_pk_bf16_f32 v169, v170, v171
v_cvt_pk_bf16_f32 v170, v172, v173
v_cvt_pk_bf16_f32 v171, v174, v175
s_add_u32 s8, s29, 0x2000
buffer_store_dwordx4 v[168:171], v3, s[88:91], s8 offen
v_pk_mul_f32 v[176:177], v[176:177], v[6:7] op_sel_hi:[1,0]
v_pk_mul_f32 v[178:179], v[178:179], v[6:7] op_sel_hi:[1,0]
v_pk_mul_f32 v[180:181], v[180:181], v[6:7] op_sel_hi:[1,0]
v_pk_mul_f32 v[182:183], v[182:183], v[6:7] op_sel_hi:[1,0]
v_cvt_pk_bf16_f32 v176, v176, v177
v_cvt_pk_bf16_f32 v177, v178, v179
v_cvt_pk_bf16_f32 v178, v180, v181
v_cvt_pk_bf16_f32 v179, v182, v183
s_add_u32 s8, s29, 0x4000
buffer_store_dwordx4 v[176:179], v3, s[88:91], s8 offen
v_pk_mul_f32 v[184:185], v[184:185], v[6:7] op_sel_hi:[1,0]
v_pk_mul_f32 v[186:187], v[186:187], v[6:7] op_sel_hi:[1,0]
v_pk_mul_f32 v[188:189], v[188:189], v[6:7] op_sel_hi:[1,0]
v_pk_mul_f32 v[190:191], v[190:191], v[6:7] op_sel_hi:[1,0]
v_cvt_pk_bf16_f32 v184, v184, v185
v_cvt_pk_bf16_f32 v185, v186, v187
v_cvt_pk_bf16_f32 v186, v188, v189
v_cvt_pk_bf16_f32 v187, v190, v191
s_add_u32 s8, s29, 0x6000
buffer_store_dwordx4 v[184:187], v3, s[88:91], s8 offen
s_branch L_att_sodd
L_att_lh0_1:
s_waitcnt vmcnt(16) lgkmcnt(0)
s_barrier
v_mfma_f32_16x16x32_bf16 v[160:163], a[32:35], v[52:55], v[160:163]
ds_read_b128 a[0:3], v1 offset:0
v_exp_f32 v28, v28
v_mfma_f32_16x16x32_bf16 v[192:195], a[32:35], v[56:59], v[192:195]
v_mfma_f32_16x16x32_bf16 v[224:227], a[32:35], v[60:63], v[224:227]
ds_read_b128 a[4:7], v1 offset:1024
v_mfma_f32_16x16x32_bf16 v[228:231], a[36:39], v[60:63], v[228:231]
v_exp_f32 v29, v29
v_mfma_f32_16x16x32_bf16 v[196:199], a[36:39], v[56:59], v[196:199]
v_mfma_f32_16x16x32_bf16 v[164:167], a[36:39], v[52:55], v[164:167]
ds_read_b128 a[8:11], v1 offset:2048
v_exp_f32 v30, v30
v_mfma_f32_16x16x32_bf16 v[168:171], a[40:43], v[52:55], v[168:171]
v_mfma_f32_16x16x32_bf16 v[200:203], a[40:43], v[56:59], v[200:203]
v_exp_f32 v31, v31
v_mfma_f32_16x16x32_bf16 v[232:235], a[40:43], v[60:63], v[232:235]
ds_read_b128 a[12:15], v1 offset:3072
v_mfma_f32_16x16x32_bf16 v[236:239], a[44:47], v[60:63], v[236:239]
v_cvt_pk_bf16_f32 v76, v28, v29
v_cvt_pk_bf16_f32 v77, v30, v31
v_mfma_f32_16x16x32_bf16 v[204:207], a[44:47], v[56:59], v[204:207]
v_mfma_f32_16x16x32_bf16 v[172:175], a[44:47], v[52:55], v[172:175]
ds_read_b128 a[16:19], v1 offset:4096
v_exp_f32 v40, v40
v_mfma_f32_16x16x32_bf16 v[176:179], a[48:51], v[52:55], v[176:179]
v_mfma_f32_16x16x32_bf16 v[208:211], a[48:51], v[56:59], v[208:211]
v_exp_f32 v41, v41
v_mfma_f32_16x16x32_bf16 v[240:243], a[48:51], v[60:63], v[240:243]
ds_read_b128 a[20:23], v1 offset:5120
v_mfma_f32_16x16x32_bf16 v[244:247], a[52:55], v[60:63], v[244:247]
v_mfma_f32_16x16x32_bf16 v[212:215], a[52:55], v[56:59], v[212:215]
v_exp_f32 v42, v42
v_mfma_f32_16x16x32_bf16 v[180:183], a[52:55], v[52:55], v[180:183]
ds_read_b128 a[24:27], v1 offset:6144
v_mfma_f32_16x16x32_bf16 v[184:187], a[56:59], v[52:55], v[184:187]
v_exp_f32 v43, v43
v_mfma_f32_16x16x32_bf16 v[216:219], a[56:59], v[56:59], v[216:219]
v_mfma_f32_16x16x32_bf16 v[248:251], a[56:59], v[60:63], v[248:251]
ds_read_b128 a[28:31], v1 offset:7168
v_cvt_pk_bf16_f32 v74, v40, v41
v_cvt_pk_bf16_f32 v75, v42, v43
v_mfma_f32_16x16x32_bf16 v[252:255], a[60:63], v[60:63], v[252:255]
v_mfma_f32_16x16x32_bf16 v[220:223], a[60:63], v[56:59], v[220:223]
v_exp_f32 v44, v44
v_mfma_f32_16x16x32_bf16 v[188:191], a[60:63], v[52:55], v[188:191]
v_mfma_f32_16x16x32_bf16 a[228:231], a[240:243], v[52:55], a[228:231]
v_exp_f32 v45, v45
v_mfma_f32_16x16x32_bf16 a[232:235], a[240:243], v[56:59], a[232:235]
v_mfma_f32_16x16x32_bf16 a[236:239], a[240:243], v[60:63], a[236:239]
v_exp_f32 v46, v46
s_waitcnt lgkmcnt(7)
v_mfma_f32_16x16x32_bf16 v[24:27], a[0:3], a[192:195], v[88:91]
ds_read_b128 a[32:35], v1 offset:8192
s_waitcnt lgkmcnt(7)
v_mfma_f32_16x16x32_bf16 v[24:27], a[4:7], a[196:199], v[24:27]
ds_read_b128 a[36:39], v1 offset:9216
v_exp_f32 v47, v47
s_waitcnt lgkmcnt(7)
v_mfma_f32_16x16x32_bf16 v[24:27], a[8:11], a[200:203], v[24:27]
s_waitcnt lgkmcnt(6)
v_mfma_f32_16x16x32_bf16 v[24:27], a[12:15], a[204:207], v[24:27]
ds_read_b128 a[40:43], v1 offset:10240
v_mfma_f32_16x16x32_bf16 v[28:31], a[0:3], a[208:211], v[92:95]
ds_read_b128 a[44:47], v1 offset:11264
v_cvt_pk_bf16_f32 v78, v44, v45
v_cvt_pk_bf16_f32 v79, v46, v47
v_mfma_f32_16x16x32_bf16 v[28:31], a[4:7], a[212:215], v[28:31]
v_mfma_f32_16x16x32_bf16 v[28:31], a[8:11], a[216:219], v[28:31]
ds_read_b128 a[48:51], v1 offset:12288
v_mfma_f32_16x16x32_bf16 v[28:31], a[12:15], a[220:223], v[28:31]
s_waitcnt lgkmcnt(8)
v_mfma_f32_16x16x32_bf16 v[40:43], a[16:19], a[192:195], v[88:91]
ds_read_b128 a[52:55], v1 offset:13312
v_exp_f32 v24, v24
s_waitcnt lgkmcnt(8)
v_mfma_f32_16x16x32_bf16 v[40:43], a[20:23], a[196:199], v[40:43]
ds_read_b128 a[56:59], v1 offset:14336
v_exp_f32 v25, v25
s_waitcnt lgkmcnt(8)
v_mfma_f32_16x16x32_bf16 v[40:43], a[24:27], a[200:203], v[40:43]
v_exp_f32 v26, v26
s_waitcnt lgkmcnt(7)
v_mfma_f32_16x16x32_bf16 v[40:43], a[28:31], a[204:207], v[40:43]
ds_read_b128 a[60:63], v1 offset:15360
v_mfma_f32_16x16x32_bf16 v[44:47], a[16:19], a[208:211], v[92:95]
v_exp_f32 v27, v27
v_mfma_f32_16x16x32_bf16 v[44:47], a[20:23], a[212:215], v[44:47]
v_mfma_f32_16x16x32_bf16 v[44:47], a[24:27], a[216:219], v[44:47]
v_cvt_pk_bf16_f32 v56, v24, v25
v_cvt_pk_bf16_f32 v57, v26, v27
v_mfma_f32_16x16x32_bf16 v[44:47], a[28:31], a[220:223], v[44:47]
s_waitcnt lgkmcnt(0)
v_mfma_f32_16x16x32_bf16 v[192:195], a[32:35], v[72:75], v[192:195]
ds_read_b128 a[0:3], v1 offset:16384
v_exp_f32 v28, v28
v_mfma_f32_16x16x32_bf16 v[224:227], a[32:35], v[76:79], v[224:227]
ds_read_b128 a[4:7], v1 offset:17408
v_mfma_f32_16x16x32_bf16 v[228:231], a[36:39], v[76:79], v[228:231]
v_exp_f32 v29, v29
v_mfma_f32_16x16x32_bf16 v[196:199], a[36:39], v[72:75], v[196:199]
ds_read_b128 a[8:11], v1 offset:18432
v_mfma_f32_16x16x32_bf16 v[200:203], a[40:43], v[72:75], v[200:203]
v_exp_f32 v30, v30
v_mfma_f32_16x16x32_bf16 v[232:235], a[40:43], v[76:79], v[232:235]
ds_read_b128 a[12:15], v1 offset:19456
v_mfma_f32_16x16x32_bf16 v[236:239], a[44:47], v[76:79], v[236:239]
v_exp_f32 v31, v31
v_mfma_f32_16x16x32_bf16 v[204:207], a[44:47], v[72:75], v[204:207]
ds_read_b128 a[16:19], v1 offset:20480
v_cvt_pk_bf16_f32 v60, v28, v29
v_cvt_pk_bf16_f32 v61, v30, v31
v_mfma_f32_16x16x32_bf16 v[208:211], a[48:51], v[72:75], v[208:211]
ds_read_b128 a[20:23], v1 offset:21504
v_mfma_f32_16x16x32_bf16 v[240:243], a[48:51], v[76:79], v[240:243]
v_exp_f32 v40, v40
v_mfma_f32_16x16x32_bf16 v[244:247], a[52:55], v[76:79], v[244:247]
ds_read_b128 a[24:27], v1 offset:22528
v_mfma_f32_16x16x32_bf16 v[212:215], a[52:55], v[72:75], v[212:215]
v_exp_f32 v41, v41
v_mfma_f32_16x16x32_bf16 v[216:219], a[56:59], v[72:75], v[216:219]
ds_read_b128 a[28:31], v1 offset:23552
v_exp_f32 v42, v42
v_mfma_f32_16x16x32_bf16 v[248:251], a[56:59], v[76:79], v[248:251]
v_mfma_f32_16x16x32_bf16 v[252:255], a[60:63], v[76:79], v[252:255]
v_exp_f32 v43, v43
v_mfma_f32_16x16x32_bf16 v[220:223], a[60:63], v[72:75], v[220:223]
v_mfma_f32_16x16x32_bf16 a[232:235], a[240:243], v[72:75], a[232:235]
v_cvt_pk_bf16_f32 v58, v40, v41
v_cvt_pk_bf16_f32 v59, v42, v43
v_mfma_f32_16x16x32_bf16 a[236:239], a[240:243], v[76:79], a[236:239]
v_exp_f32 v44, v44
s_waitcnt lgkmcnt(7)
v_mfma_f32_16x16x32_bf16 v[24:27], a[0:3], a[192:195], v[112:115]
ds_read_b128 a[32:35], v1 offset:24576
s_waitcnt lgkmcnt(7)
v_mfma_f32_16x16x32_bf16 v[24:27], a[4:7], a[196:199], v[24:27]
ds_read_b128 a[36:39], v1 offset:25600
v_exp_f32 v45, v45
s_waitcnt lgkmcnt(7)
v_mfma_f32_16x16x32_bf16 v[24:27], a[8:11], a[200:203], v[24:27]
s_waitcnt lgkmcnt(6)
v_mfma_f32_16x16x32_bf16 v[24:27], a[12:15], a[204:207], v[24:27]
ds_read_b128 a[40:43], v1 offset:26624
v_exp_f32 v46, v46
v_mfma_f32_16x16x32_bf16 v[28:31], a[0:3], a[208:211], v[92:95]
ds_read_b128 a[44:47], v1 offset:27648
v_mfma_f32_16x16x32_bf16 v[28:31], a[4:7], a[212:215], v[28:31]
v_exp_f32 v47, v47
v_mfma_f32_16x16x32_bf16 v[28:31], a[8:11], a[216:219], v[28:31]
ds_read_b128 a[48:51], v1 offset:28672
v_cvt_pk_bf16_f32 v62, v44, v45
v_cvt_pk_bf16_f32 v63, v46, v47
v_mfma_f32_16x16x32_bf16 v[28:31], a[12:15], a[220:223], v[28:31]
s_waitcnt lgkmcnt(8)
v_mfma_f32_16x16x32_bf16 v[40:43], a[16:19], a[192:195], v[116:119]
ds_read_b128 a[52:55], v1 offset:29696
v_exp_f32 v24, v24
s_waitcnt lgkmcnt(8)
v_mfma_f32_16x16x32_bf16 v[40:43], a[20:23], a[196:199], v[40:43]
ds_read_b128 a[56:59], v1 offset:30720
s_waitcnt lgkmcnt(8)
v_mfma_f32_16x16x32_bf16 v[40:43], a[24:27], a[200:203], v[40:43]
v_exp_f32 v25, v25
s_waitcnt lgkmcnt(7)
v_mfma_f32_16x16x32_bf16 v[40:43], a[28:31], a[204:207], v[40:43]
ds_read_b128 a[60:63], v1 offset:31744
v_exp_f32 v26, v26
v_mfma_f32_16x16x32_bf16 v[44:47], a[16:19], a[208:211], v[92:95]
v_mfma_f32_16x16x32_bf16 v[44:47], a[20:23], a[212:215], v[44:47]
v_exp_f32 v27, v27
v_mfma_f32_16x16x32_bf16 v[44:47], a[24:27], a[216:219], v[44:47]
v_mfma_f32_16x16x32_bf16 v[44:47], a[28:31], a[220:223], v[44:47]
v_cvt_pk_bf16_f32 v72, v24, v25
v_cvt_pk_bf16_f32 v73, v26, v27
v_xor_b32 v1, 0x8000, v1
s_nop 7
v_accvgpr_read_b32 v4, a224
v_accvgpr_read_b32 v6, a228
s_mov_b32 s8, 0x5f800000
v_cmp_nge_f32 s[36:37], s8, v4
v_cmp_nge_f32 s[38:39], s8, v6
v_rcp_f32 v4, v4
v_rcp_f32 v6, v6
s_or_b64 s[34:35], s[34:35], s[36:37]
s_or_b64 s[34:35], s[34:35], s[38:39]
v_pk_mul_f32 v[128:129], v[128:129], v[4:5] op_sel_hi:[1,0]
v_pk_mul_f32 v[130:131], v[130:131], v[4:5] op_sel_hi:[1,0]
v_pk_mul_f32 v[132:133], v[132:133], v[4:5] op_sel_hi:[1,0]
v_pk_mul_f32 v[134:135], v[134:135], v[4:5] op_sel_hi:[1,0]
v_cvt_pk_bf16_f32 v128, v128, v129
v_cvt_pk_bf16_f32 v129, v130, v131
v_cvt_pk_bf16_f32 v130, v132, v133
v_cvt_pk_bf16_f32 v131, v134, v135
s_add_u32 s8, s28, 0x0
buffer_store_dwordx4 v[128:131], v3, s[88:91], s8 offen
v_pk_mul_f32 v[136:137], v[136:137], v[4:5] op_sel_hi:[1,0]
v_pk_mul_f32 v[138:139], v[138:139], v[4:5] op_sel_hi:[1,0]
v_pk_mul_f32 v[140:141], v[140:141], v[4:5] op_sel_hi:[1,0]
v_pk_mul_f32 v[142:143], v[142:143], v[4:5] op_sel_hi:[1,0]
v_cvt_pk_bf16_f32 v136, v136, v137
v_cvt_pk_bf16_f32 v137, v138, v139
v_cvt_pk_bf16_f32 v138, v140, v141
v_cvt_pk_bf16_f32 v139, v142, v143
s_add_u32 s8, s28, 0x2000
buffer_store_dwordx4 v[136:139], v3, s[88:91], s8 offen
v_pk_mul_f32 v[144:145], v[144:145], v[4:5] op_sel_hi:[1,0]
v_pk_mul_f32 v[146:147], v[146:147], v[4:5] op_sel_hi:[1,0]
v_pk_mul_f32 v[148:149], v[148:149], v[4:5] op_sel_hi:[1,0]
v_pk_mul_f32 v[150:151], v[150:151], v[4:5] op_sel_hi:[1,0]
v_cvt_pk_bf16_f32 v144, v144, v145
v_cvt_pk_bf16_f32 v145, v146, v147
v_cvt_pk_bf16_f32 v146, v148, v149
v_cvt_pk_bf16_f32 v147, v150, v151
s_add_u32 s8, s28, 0x4000
buffer_store_dwordx4 v[144:147], v3, s[88:91], s8 offen
v_pk_mul_f32 v[152:153], v[152:153], v[4:5] op_sel_hi:[1,0]
v_pk_mul_f32 v[154:155], v[154:155], v[4:5] op_sel_hi:[1,0]
v_pk_mul_f32 v[156:157], v[156:157], v[4:5] op_sel_hi:[1,0]
v_pk_mul_f32 v[158:159], v[158:159], v[4:5] op_sel_hi:[1,0]
v_cvt_pk_bf16_f32 v152, v152, v153
v_cvt_pk_bf16_f32 v153, v154, v155
v_cvt_pk_bf16_f32 v154, v156, v157
v_cvt_pk_bf16_f32 v155, v158, v159
s_add_u32 s8, s28, 0x6000
buffer_store_dwordx4 v[152:155], v3, s[88:91], s8 offen
v_pk_mul_f32 v[160:161], v[160:161], v[6:7] op_sel_hi:[1,0]
v_pk_mul_f32 v[162:163], v[162:163], v[6:7] op_sel_hi:[1,0]
v_pk_mul_f32 v[164:165], v[164:165], v[6:7] op_sel_hi:[1,0]
v_pk_mul_f32 v[166:167], v[166:167], v[6:7] op_sel_hi:[1,0]
v_cvt_pk_bf16_f32 v160, v160, v161
v_cvt_pk_bf16_f32 v161, v162, v163
v_cvt_pk_bf16_f32 v162, v164, v165
v_cvt_pk_bf16_f32 v163, v166, v167
s_add_u32 s8, s29, 0x0
buffer_store_dwordx4 v[160:163], v3, s[88:91], s8 offen
v_pk_mul_f32 v[168:169], v[168:169], v[6:7] op_sel_hi:[1,0]
v_pk_mul_f32 v[170:171], v[170:171], v[6:7] op_sel_hi:[1,0]
v_pk_mul_f32 v[172:173], v[172:173], v[6:7] op_sel_hi:[1,0]
v_pk_mul_f32 v[174:175], v[174:175], v[6:7] op_sel_hi:[1,0]
v_cvt_pk_bf16_f32 v168, v168, v169
v_cvt_pk_bf16_f32 v169, v170, v171
v_cvt_pk_bf16_f32 v170, v172, v173
v_cvt_pk_bf16_f32 v171, v174, v175
s_add_u32 s8, s29, 0x2000
buffer_store_dwordx4 v[168:171], v3, s[88:91], s8 offen
v_pk_mul_f32 v[176:177], v[176:177], v[6:7] op_sel_hi:[1,0]
v_pk_mul_f32 v[178:179], v[178:179], v[6:7] op_sel_hi:[1,0]
v_pk_mul_f32 v[180:181], v[180:181], v[6:7] op_sel_hi:[1,0]
v_pk_mul_f32 v[182:183], v[182:183], v[6:7] op_sel_hi:[1,0]
v_cvt_pk_bf16_f32 v176, v176, v177
v_cvt_pk_bf16_f32 v177, v178, v179
v_cvt_pk_bf16_f32 v178, v180, v181
v_cvt_pk_bf16_f32 v179, v182, v183
s_add_u32 s8, s29, 0x4000
buffer_store_dwordx4 v[176:179], v3, s[88:91], s8 offen
v_pk_mul_f32 v[184:185], v[184:185], v[6:7] op_sel_hi:[1,0]
v_pk_mul_f32 v[186:187], v[186:187], v[6:7] op_sel_hi:[1,0]
v_pk_mul_f32 v[188:189], v[188:189], v[6:7] op_sel_hi:[1,0]
v_pk_mul_f32 v[190:191], v[190:191], v[6:7] op_sel_hi:[1,0]
v_cvt_pk_bf16_f32 v184, v184, v185
v_cvt_pk_bf16_f32 v185, v186, v187
v_cvt_pk_bf16_f32 v186, v188, v189
v_cvt_pk_bf16_f32 v187, v190, v191
s_add_u32 s8, s29, 0x6000
buffer_store_dwordx4 v[184:187], v3, s[88:91], s8 offen
s_branch L_att_h1_1
L_att_j0:
s_cmp_ge_u32 s4, 2
s_cbranch_scc1 L_att_nl0_1
L_att_nl0_0:
v_mfma_f32_16x16x32_bf16 v[16:19], a[0:3], a[160:163], v[96:99]
v_mfma_f32_16x16x32_bf16 v[16:19], a[4:7], a[164:167], v[16:19]
v_mfma_f32_16x16x32_bf16 v[16:19], a[8:11], a[168:171], v[16:19]
v_mfma_f32_16x16x32_bf16 v[16:19], a[12:15], a[172:175], v[16:19]
s_add_u32 m0, s18, 0x10000
v_mfma_f32_16x16x32_bf16 v[20:23], a[0:3], a[176:179], v[84:87]
buffer_load_dwordx4 v3, s[88:91], s32 offen offset:0 lds
v_mfma_f32_16x16x32_bf16 v[20:23], a[4:7], a[180:183], v[20:23]
v_mfma_f32_16x16x32_bf16 v[20:23], a[8:11], a[184:187], v[20:23]
v_mfma_f32_16x16x32_bf16 v[20:23], a[12:15], a[188:191], v[20:23]
v_mfma_f32_16x16x32_bf16 v[24:27], a[0:3], a[192:195], v[88:91]
s_nop 0
v_exp_f32 v16, v16
v_mfma_f32_16x16x32_bf16 v[24:27], a[4:7], a[196:199], v[24:27]
v_exp_f32 v17, v17
v_mfma_f32_16x16x32_bf16 v[24:27], a[8:11], a[200:203], v[24:27]
v_exp_f32 v18, v18
v_mfma_f32_16x16x32_bf16 v[24:27], a[12:15], a[204:207], v[24:27]
v_exp_f32 v19, v19
v_mfma_f32_16x16x32_bf16 v[28:31], a[0:3], a[208:211], v[92:95]
buffer_load_dwordx4 v3, s[88:91], s32 offen offset:1024 lds
v_mfma_f32_16x16x32_bf16 v[28:31], a[4:7], a[212:215], v[28:31]
v_cvt_pk_bf16_f32 v48, v16, v17
v_cvt_pk_bf16_f32 v49, v18, v19
v_mfma_f32_16x16x32_bf16 v[28:31], a[8:11], a[216:219], v[28:31]
v_exp_f32 v20, v20
v_mfma_f32_16x16x32_bf16 v[28:31], a[12:15], a[220:223], v[28:31]
v_exp_f32 v21, v21
v_mfma_f32_16x16x32_bf16 v[32:35], a[16:19], a[160:163], v[100:103]
v_exp_f32 v22, v22
v_mfma_f32_16x16x32_bf16 v[32:35], a[20:23], a[164:167], v[32:35]
v_exp_f32 v23, v23
v_mfma_f32_16x16x32_bf16 v[32:35], a[24:27], a[168:171], v[32:35]
v_mfma_f32_16x16x32_bf16 v[32:35], a[28:31], a[172:175], v[32:35]
v_cvt_pk_bf16_f32 v52, v20, v21
v_cvt_pk_bf16_f32 v53, v22, v23
v_mfma_f32_16x16x32_bf16 v[36:39], a[16:19], a[176:179], v[84:87]
buffer_load_dwordx4 v3, s[88:91], s32 offen offset:2048 lds
v_mfma_f32_16x16x32_bf16 v[36:39], a[20:23], a[180:183], v[36:39]
v_mfma_f32_16x16x32_bf16 v[36:39], a[24:27], a[184:187], v[36:39]
v_exp_f32 v24, v24
v_mfma_f32_16x16x32_bf16 v[36:39], a[28:31], a[188:191], v[36:39]
v_mfma_f32_16x16x32_bf16 v[40:43], a[16:19], a[192:195], v[88:91]
v_exp_f32 v25, v25
v_mfma_f32_16x16x32_bf16 v[40:43], a[20:23], a[196:199], v[40:43]
v_mfma_f32_16x16x32_bf16 v[40:43], a[24:27], a[200:203], v[40:43]
v_exp_f32 v26, v26
v_mfma_f32_16x16x32_bf16 v[40:43], a[28:31], a[204:207], v[40:43]
v_mfma_f32_16x16x32_bf16 v[44:47], a[16:19], a[208:211], v[92:95]
buffer_load_dwordx4 v3, s[88:91], s32 offen offset:3072 lds
v_mfma_f32_16x16x32_bf16 v[44:47], a[20:23], a[212:215], v[44:47]
v_exp_f32 v27, v27
v_mfma_f32_16x16x32_bf16 v[44:47], a[24:27], a[216:219], v[44:47]
v_mfma_f32_16x16x32_bf16 v[44:47], a[28:31], a[220:223], v[44:47]
v_cvt_pk_bf16_f32 v56, v24, v25
v_cvt_pk_bf16_f32 v57, v26, v27
s_waitcnt lgkmcnt(0)
ds_read_b128 a[0:3], v1 offset:16384
ds_read_b128 a[4:7], v1 offset:17408
ds_read_b128 a[8:11], v1 offset:18432
ds_read_b128 a[12:15], v1 offset:19456
ds_read_b128 a[16:19], v1 offset:20480
ds_read_b128 a[20:23], v1 offset:21504
ds_read_b128 a[24:27], v1 offset:22528
ds_read_b128 a[28:31], v1 offset:23552
s_waitcnt lgkmcnt(7)
v_mfma_f32_16x16x32_bf16 v[20:23], a[0:3], a[176:179], v[84:87]
ds_read_b128 a[32:35], v1 offset:24576
v_exp_f32 v28, v28
s_waitcnt lgkmcnt(7)
v_mfma_f32_16x16x32_bf16 v[20:23], a[4:7], a[180:183], v[20:23]
v_exp_f32 v29, v29
s_waitcnt lgkmcnt(6)
v_mfma_f32_16x16x32_bf16 v[20:23], a[8:11], a[184:187], v[20:23]
s_add_u32 m0, s18, 0x11000
ds_read_b128 a[36:39], v1 offset:25600
v_exp_f32 v30, v30
s_waitcnt lgkmcnt(6)
v_mfma_f32_16x16x32_bf16 v[20:23], a[12:15], a[188:191], v[20:23]
buffer_load_dwordx4 v3, s[88:91], s11 offen offset:0 lds
v_mfma_f32_16x16x32_bf16 v[24:27], a[0:3], a[192:195], v[88:91]
v_exp_f32 v31, v31
v_mfma_f32_16x16x32_bf16 v[24:27], a[4:7], a[196:199], v[24:27]
ds_read_b128 a[40:43], v1 offset:26624
v_cvt_pk_bf16_f32 v60, v28, v29
v_cvt_pk_bf16_f32 v61, v30, v31
v_mfma_f32_16x16x32_bf16 v[24:27], a[8:11], a[200:203], v[24:27]
v_exp_f32 v32, v32
v_mfma_f32_16x16x32_bf16 v[24:27], a[12:15], a[204:207], v[24:27]
ds_read_b128 a[44:47], v1 offset:27648
v_exp_f32 v33, v33
v_mfma_f32_16x16x32_bf16 v[28:31], a[0:3], a[208:211], v[92:95]
v_exp_f32 v34, v34
v_mfma_f32_16x16x32_bf16 v[28:31], a[4:7], a[212:215], v[28:31]
buffer_load_dwordx4 v3, s[88:91], s11 offen offset:1024 lds
v_mfma_f32_16x16x32_bf16 v[28:31], a[8:11], a[216:219], v[28:31]
v_exp_f32 v35, v35
v_mfma_f32_16x16x32_bf16 v[28:31], a[12:15], a[220:223], v[28:31]
ds_read_b128 a[48:51], v1 offset:28672
v_cvt_pk_bf16_f32 v50, v32, v33
v_cvt_pk_bf16_f32 v51, v34, v35
v_exp_f32 v36, v36
s_nop 0
v_exp_f32 v37, v37
s_nop 0
v_exp_f32 v38, v38
s_nop 0
v_exp_f32 v39, v39
s_nop 0
v_cvt_pk_bf16_f32 v54, v36, v37
v_cvt_pk_bf16_f32 v55, v38, v39
s_nop 0
s_waitcnt lgkmcnt(8)
v_mfma_f32_16x16x32_bf16 v[36:39], a[16:19], a[176:179], v[84:87]
v_exp_f32 v40, v40
s_waitcnt lgkmcnt(7)
v_mfma_f32_16x16x32_bf16 v[36:39], a[20:23], a[180:183], v[36:39]
ds_read_b128 a[52:55], v1 offset:29696
v_exp_f32 v41, v41
s_waitcnt lgkmcnt(7)
v_mfma_f32_16x16x32_bf16 v[36:39], a[24:27], a[184:187], v[36:39]
v_exp_f32 v42, v42
s_waitcnt lgkmcnt(6)
v_mfma_f32_16x16x32_bf16 v[36:39], a[28:31], a[188:191], v[36:39]
buffer_load_dwordx4 v3, s[88:91], s11 offen offset:2048 lds
v_exp_f32 v43, v43
s_nop 0
v_cvt_pk_bf16_f32 v58, v40, v41
v_cvt_pk_bf16_f32 v59, v42, v43
s_nop 0
v_mfma_f32_16x16x32_bf16 v[40:43], a[16:19], a[192:195], v[88:91]
ds_read_b128 a[56:59], v1 offset:30720
v_exp_f32 v44, v44
v_mfma_f32_16x16x32_bf16 v[40:43], a[20:23], a[196:199], v[40:43]
v_exp_f32 v45, v45
v_mfma_f32_16x16x32_bf16 v[40:43], a[24:27], a[200:203], v[40:43]
ds_read_b128 a[60:63], v1 offset:31744
v_exp_f32 v46, v46
v_mfma_f32_16x16x32_bf16 v[40:43], a[28:31], a[204:207], v[40:43]
v_exp_f32 v47, v47
v_cvt_pk_bf16_f32 v62, v44, v45
v_cvt_pk_bf16_f32 v63, v46, v47
s_nop 0
v_mfma_f32_16x16x32_bf16 v[44:47], a[16:19], a[208:211], v[92:95]
v_exp_f32 v20, v20
v_mfma_f32_16x16x32_bf16 v[44:47], a[20:23], a[212:215], v[44:47]
buffer_load_dwordx4 v3, s[88:91], s11 offen offset:3072 lds
v_mfma_f32_16x16x32_bf16 v[44:47], a[24:27], a[216:219], v[44:47]
v_exp_f32 v21, v21
v_mfma_f32_16x16x32_bf16 v[44:47], a[28:31], a[220:223], v[44:47]
v_exp_f32 v22, v22
s_nop 7
v_exp_f32 v23, v23
s_nop 0
v_cvt_pk_bf16_f32 v68, v20, v21
v_cvt_pk_bf16_f32 v69, v22, v23
s_nop 0
v_exp_f32 v24, v24
s_nop 0
v_exp_f32 v25, v25
s_nop 0
v_exp_f32 v26, v26
s_nop 0
v_exp_f32 v27, v27
s_nop 0
v_cvt_pk_bf16_f32 v72, v24, v25
v_cvt_pk_bf16_f32 v73, v26, v27
s_nop 0
s_add_u32 s32, s32, 0x8000
s_add_u32 s11, s11, 0x8000
s_xor_b32 s18, s18, 0x8000
v_xor_b32 v1, 0x8000, v1
s_branch L_att_l1_0
L_att_nl0_1:
v_mfma_f32_16x16x32_bf16 v[16:19], a[0:3], a[160:163], v[80:83]
v_mfma_f32_16x16x32_bf16 v[16:19], a[4:7], a[164:167], v[16:19]
v_mfma_f32_16x16x32_bf16 v[16:19], a[8:11], a[168:171], v[16:19]
v_mfma_f32_16x16x32_bf16 v[16:19], a[12:15], a[172:175], v[16:19]
s_add_u32 m0, s18, 0x10000
v_mfma_f32_16x16x32_bf16 v[20:23], a[0:3], a[176:179], v[84:87]
buffer_load_dwordx4 v3, s[88:91], s32 offen offset:0 lds
v_mfma_f32_16x16x32_bf16 v[20:23], a[4:7], a[180:183], v[20:23]
v_mfma_f32_16x16x32_bf16 v[20:23], a[8:11], a[184:187], v[20:23]
v_mfma_f32_16x16x32_bf16 v[20:23], a[12:15], a[188:191], v[20:23]
v_mfma_f32_16x16x32_bf16 v[24:27], a[0:3], a[192:195], v[88:91]
s_nop 0
v_exp_f32 v16, v16
v_mfma_f32_16x16x32_bf16 v[24:27], a[4:7], a[196:199], v[24:27]
v_exp_f32 v17, v17
v_mfma_f32_16x16x32_bf16 v[24:27], a[8:11], a[200:203], v[24:27]
v_exp_f32 v18, v18
v_mfma_f32_16x16x32_bf16 v[24:27], a[12:15], a[204:207], v[24:27]
v_exp_f32 v19, v19
v_mfma_f32_16x16x32_bf16 v[28:31], a[0:3], a[208:211], v[92:95]
buffer_load_dwordx4 v3, s[88:91], s32 offen offset:1024 lds
v_mfma_f32_16x16x32_bf16 v[28:31], a[4:7], a[212:215], v[28:31]
v_cvt_pk_bf16_f32 v48, v16, v17
v_cvt_pk_bf16_f32 v49, v18, v19
v_mfma_f32_16x16x32_bf16 v[28:31], a[8:11], a[216:219], v[28:31]
v_exp_f32 v20, v20
v_mfma_f32_16x16x32_bf16 v[28:31], a[12:15], a[220:223], v[28:31]
v_exp_f32 v21, v21
v_mfma_f32_16x16x32_bf16 v[32:35], a[16:19], a[160:163], v[80:83]
v_exp_f32 v22, v22
v_mfma_f32_16x16x32_bf16 v[32:35], a[20:23], a[164:167], v[32:35]
v_exp_f32 v23, v23
v_mfma_f32_16x16x32_bf16 v[32:35], a[24:27], a[168:171], v[32:35]
v_mfma_f32_16x16x32_bf16 v[32:35], a[28:31], a[172:175], v[32:35]
v_cvt_pk_bf16_f32 v52, v20, v21
v_cvt_pk_bf16_f32 v53, v22, v23
v_mfma_f32_16x16x32_bf16 v[36:39], a[16:19], a[176:179], v[84:87]
buffer_load_dwordx4 v3, s[88:91], s32 offen offset:2048 lds
v_mfma_f32_16x16x32_bf16 v[36:39], a[20:23], a[180:183], v[36:39]
v_mfma_f32_16x16x32_bf16 v[36:39], a[24:27], a[184:187], v[36:39]
v_exp_f32 v24, v24
v_mfma_f32_16x16x32_bf16 v[36:39], a[28:31], a[188:191], v[36:39]
v_mfma_f32_16x16x32_bf16 v[40:43], a[16:19], a[192:195], v[88:91]
v_exp_f32 v25, v25
v_mfma_f32_16x16x32_bf16 v[40:43], a[20:23], a[196:199], v[40:43]
v_mfma_f32_16x16x32_bf16 v[40:43], a[24:27], a[200:203], v[40:43]
v_exp_f32 v26, v26
v_mfma_f32_16x16x32_bf16 v[40:43], a[28:31], a[204:207], v[40:43]
v_mfma_f32_16x16x32_bf16 v[44:47], a[16:19], a[208:211], v[92:95]
buffer_load_dwordx4 v3, s[88:91], s32 offen offset:3072 lds
v_mfma_f32_16x16x32_bf16 v[44:47], a[20:23], a[212:215], v[44:47]
v_exp_f32 v27, v27
v_mfma_f32_16x16x32_bf16 v[44:47], a[24:27], a[216:219], v[44:47]
v_mfma_f32_16x16x32_bf16 v[44:47], a[28:31], a[220:223], v[44:47]
v_cvt_pk_bf16_f32 v56, v24, v25
v_cvt_pk_bf16_f32 v57, v26, v27
s_waitcnt lgkmcnt(0)
ds_read_b128 a[0:3], v1 offset:16384
ds_read_b128 a[4:7], v1 offset:17408
ds_read_b128 a[8:11], v1 offset:18432
ds_read_b128 a[12:15], v1 offset:19456
ds_read_b128 a[16:19], v1 offset:20480
ds_read_b128 a[20:23], v1 offset:21504
ds_read_b128 a[24:27], v1 offset:22528
ds_read_b128 a[28:31], v1 offset:23552
s_waitcnt lgkmcnt(7)
v_mfma_f32_16x16x32_bf16 v[16:19], a[0:3], a[160:163], v[96:99]
ds_read_b128 a[32:35], v1 offset:24576
v_exp_f32 v28, v28
s_waitcnt lgkmcnt(7)
v_mfma_f32_16x16x32_bf16 v[16:19], a[4:7], a[164:167], v[16:19]
v_exp_f32 v29, v29
s_waitcnt lgkmcnt(6)
v_mfma_f32_16x16x32_bf16 v[16:19], a[8:11], a[168:171], v[16:19]
v_exp_f32 v30, v30
s_waitcnt lgkmcnt(5)
v_mfma_f32_16x16x32_bf16 v[16:19], a[12:15], a[172:175], v[16:19]
s_add_u32 m0, s18, 0x11000
ds_read_b128 a[36:39], v1 offset:25600
v_exp_f32 v31, v31
v_mfma_f32_16x16x32_bf16 v[20:23], a[0:3], a[176:179], v[84:87]
buffer_load_dwordx4 v3, s[88:91], s11 offen offset:0 lds
v_mfma_f32_16x16x32_bf16 v[20:23], a[4:7], a[180:183], v[20:23]
v_cvt_pk_bf16_f32 v60, v28, v29
v_cvt_pk_bf16_f32 v61, v30, v31
v_mfma_f32_16x16x32_bf16 v[20:23], a[8:11], a[184:187], v[20:23]
v_exp_f32 v32, v32
v_mfma_f32_16x16x32_bf16 v[20:23], a[12:15], a[188:191], v[20:23]
ds_read_b128 a[40:43], v1 offset:26624
v_exp_f32 v33, v33
v_mfma_f32_16x16x32_bf16 v[24:27], a[0:3], a[192:195], v[88:91]
v_exp_f32 v34, v34
v_mfma_f32_16x16x32_bf16 v[24:27], a[4:7], a[196:199], v[24:27]
v_exp_f32 v35, v35
v_mfma_f32_16x16x32_bf16 v[24:27], a[8:11], a[200:203], v[24:27]
ds_read_b128 a[44:47], v1 offset:27648
v_cvt_pk_bf16_f32 v50, v32, v33
v_cvt_pk_bf16_f32 v51, v34, v35
v_mfma_f32_16x16x32_bf16 v[24:27], a[12:15], a[204:207], v[24:27]
v_exp_f32 v36, v36
v_mfma_f32_16x16x32_bf16 v[28:31], a[0:3], a[208:211], v[92:95]
buffer_load_dwordx4 v3, s[88:91], s11 offen offset:1024 lds
v_mfma_f32_16x16x32_bf16 v[28:31], a[4:7], a[212:215], v[28:31]
v_exp_f32 v37, v37
v_mfma_f32_16x16x32_bf16 v[28:31], a[8:11], a[216:219], v[28:31]
ds_read_b128 a[48:51], v1 offset:28672
v_exp_f32 v38, v38
v_mfma_f32_16x16x32_bf16 v[28:31], a[12:15], a[220:223], v[28:31]
v_exp_f32 v39, v39
s_waitcnt lgkmcnt(8)
v_mfma_f32_16x16x32_bf16 v[32:35], a[16:19], a[160:163], v[100:103]
v_cvt_pk_bf16_f32 v54, v36, v37
v_cvt_pk_bf16_f32 v55, v38, v39
s_waitcnt lgkmcnt(7)
v_mfma_f32_16x16x32_bf16 v[32:35], a[20:23], a[164:167], v[32:35]
ds_read_b128 a[52:55], v1 offset:29696
v_exp_f32 v40, v40
s_waitcnt lgkmcnt(7)
v_mfma_f32_16x16x32_bf16 v[32:35], a[24:27], a[168:171], v[32:35]
v_exp_f32 v41, v41
s_waitcnt lgkmcnt(6)
v_mfma_f32_16x16x32_bf16 v[32:35], a[28:31], a[172:175], v[32:35]
v_exp_f32 v42, v42
v_mfma_f32_16x16x32_bf16 v[36:39], a[16:19], a[176:179], v[84:87]
buffer_load_dwordx4 v3, s[88:91], s11 offen offset:2048 lds
v_mfma_f32_16x16x32_bf16 v[36:39], a[20:23], a[180:183], v[36:39]
ds_read_b128 a[56:59], v1 offset:30720
v_exp_f32 v43, v43
v_mfma_f32_16x16x32_bf16 v[36:39], a[24:27], a[184:187], v[36:39]
v_cvt_pk_bf16_f32 v58, v40, v41
v_cvt_pk_bf16_f32 v59, v42, v43
v_mfma_f32_16x16x32_bf16 v[36:39], a[28:31], a[188:191], v[36:39]
v_exp_f32 v44, v44
v_mfma_f32_16x16x32_bf16 v[40:43], a[16:19], a[192:195], v[88:91]
ds_read_b128 a[60:63], v1 offset:31744
v_exp_f32 v45, v45
v_mfma_f32_16x16x32_bf16 v[40:43], a[20:23], a[196:199], v[40:43]
v_exp_f32 v46, v46
v_mfma_f32_16x16x32_bf16 v[40:43], a[24:27], a[200:203], v[40:43]
v_exp_f32 v47, v47
v_mfma_f32_16x16x32_bf16 v[40:43], a[28:31], a[204:207], v[40:43]
v_cvt_pk_bf16_f32 v62, v44, v45
v_cvt_pk_bf16_f32 v63, v46, v47
v_mfma_f32_16x16x32_bf16 v[44:47], a[16:19], a[208:211], v[92:95]
buffer_load_dwordx4 v3, s[88:91], s11 offen offset:3072 lds
v_mfma_f32_16x16x32_bf16 v[44:47], a[20:23], a[212:215], v[44:47]
v_exp_f32 v16, v16
v_mfma_f32_16x16x32_bf16 v[44:47], a[24:27], a[216:219], v[44:47]
v_exp_f32 v17, v17
v_mfma_f32_16x16x32_bf16 v[44:47], a[28:31], a[220:223], v[44:47]
v_exp_f32 v18, v18
s_nop 7
v_exp_f32 v19, v19
s_nop 0
v_cvt_pk_bf16_f32 v64, v16, v17
v_cvt_pk_bf16_f32 v65, v18, v19
s_nop 0
v_exp_f32 v20, v20
s_nop 0
v_exp_f32 v21, v21
s_nop 0
v_exp_f32 v22, v22
s_nop 0
v_exp_f32 v23, v23
s_nop 0
v_cvt_pk_bf16_f32 v68, v20, v21
v_cvt_pk_bf16_f32 v69, v22, v23
s_nop 0
v_exp_f32 v24, v24
s_nop 0
v_exp_f32 v25, v25
s_nop 0
v_exp_f32 v26, v26
s_nop 0
v_exp_f32 v27, v27
s_nop 0
v_cvt_pk_bf16_f32 v72, v24, v25
v_cvt_pk_bf16_f32 v73, v26, v27
s_nop 0
s_add_u32 s32, s32, 0x8000
s_add_u32 s11, s11, 0x8000
s_xor_b32 s18, s18, 0x8000
v_xor_b32 v1, 0x8000, v1
s_branch L_att_l1_1
L_att_seven:
s_waitcnt vmcnt(16) lgkmcnt(0)
s_barrier
v_mfma_f32_16x16x32_bf16 v[192:195], a[32:35], v[56:59], v[192:195]
ds_read_b128 a[0:3], v1 offset:0
v_exp_f32 v28, v28
v_mfma_f32_16x16x32_bf16 v[224:227], a[32:35], v[60:63], v[224:227]
ds_read_b128 a[4:7], v1 offset:1024
v_mfma_f32_16x16x32_bf16 v[228:231], a[36:39], v[60:63], v[228:231]
v_exp_f32 v29, v29
v_mfma_f32_16x16x32_bf16 v[196:199], a[36:39], v[56:59], v[196:199]
s_add_u32 m0, s18, 0x10000
ds_read_b128 a[8:11], v1 offset:2048
v_exp_f32 v30, v30
v_mfma_f32_16x16x32_bf16 v[200:203], a[40:43], v[56:59], v[200:203]
buffer_load_dwordx4 v3, s[88:91], s32 offen offset:0 lds
v_mfma_f32_16x16x32_bf16 v[232:235], a[40:43], v[60:63], v[232:235]
ds_read_b128 a[12:15], v1 offset:3072
v_mfma_f32_16x16x32_bf16 v[236:239], a[44:47], v[60:63], v[236:239]
v_exp_f32 v31, v31
v_mfma_f32_16x16x32_bf16 v[204:207], a[44:47], v[56:59], v[204:207]
ds_read_b128 a[16:19], v1 offset:4096
v_cvt_pk_bf16_f32 v76, v28, v29
v_cvt_pk_bf16_f32 v77, v30, v31
v_mfma_f32_16x16x32_bf16 v[208:211], a[48:51], v[56:59], v[208:211]
ds_read_b128 a[20:23], v1 offset:5120
v_mfma_f32_16x16x32_bf16 v[240:243], a[48:51], v[60:63], v[240:243]
v_exp_f32 v40, v40
v_mfma_f32_16x16x32_bf16 v[244:247], a[52:55], v[60:63], v[244:247]
ds_read_b128 a[24:27], v1 offset:6144
v_exp_f32 v41, v41
v_mfma_f32_16x16x32_bf16 v[212:215], a[52:55], v[56:59], v[212:215]
ds_read_b128 a[28:31], v1 offset:7168
v_mfma_f32_16x16x32_bf16 v[216:219], a[56:59], v[56:59], v[216:219]
buffer_load_dwordx4 v3, s[88:91], s32 offen offset:1024 lds
v_mfma_f32_16x16x32_bf16 v[248:251], a[56:59], v[60:63], v[248:251]
v_exp_f32 v42, v42
v_mfma_f32_16x16x32_bf16 v[252:255], a[60:63], v[60:63], v[252:255]
v_exp_f32 v43, v43
v_mfma_f32_16x16x32_bf16 v[220:223], a[60:63], v[56:59], v[220:223]
v_mfma_f32_16x16x32_bf16 a[232:235], a[240:243], v[56:59], a[232:235]
v_cvt_pk_bf16_f32 v74, v40, v41
v_cvt_pk_bf16_f32 v75, v42, v43
v_mfma_f32_16x16x32_bf16 a[236:239], a[240:243], v[60:63], a[236:239]
v_exp_f32 v44, v44
s_waitcnt lgkmcnt(7)
v_mfma_f32_16x16x32_bf16 v[24:27], a[0:3], a[192:195], v[88:91]
ds_read_b128 a[32:35], v1 offset:8192
s_waitcnt lgkmcnt(7)
v_mfma_f32_16x16x32_bf16 v[24:27], a[4:7], a[196:199], v[24:27]
ds_read_b128 a[36:39], v1 offset:9216
v_exp_f32 v45, v45
s_waitcnt lgkmcnt(7)
v_mfma_f32_16x16x32_bf16 v[24:27], a[8:11], a[200:203], v[24:27]
buffer_load_dwordx4 v3, s[88:91], s32 offen offset:2048 lds
s_waitcnt lgkmcnt(6)
v_mfma_f32_16x16x32_bf16 v[24:27], a[12:15], a[204:207], v[24:27]
ds_read_b128 a[40:43], v1 offset:10240
v_exp_f32 v46, v46
v_mfma_f32_16x16x32_bf16 v[28:31], a[0:3], a[208:211], v[92:95]
v_mfma_f32_16x16x32_bf16 v[28:31], a[4:7], a[212:215], v[28:31]
ds_read_b128 a[44:47], v1 offset:11264
v_exp_f32 v47, v47
v_mfma_f32_16x16x32_bf16 v[28:31], a[8:11], a[216:219], v[28:31]
ds_read_b128 a[48:51], v1 offset:12288
v_cvt_pk_bf16_f32 v78, v44, v45
v_cvt_pk_bf16_f32 v79, v46, v47
v_mfma_f32_16x16x32_bf16 v[28:31], a[12:15], a[220:223], v[28:31]
ds_read_b128 a[52:55], v1 offset:13312
s_waitcnt lgkmcnt(9)
v_mfma_f32_16x16x32_bf16 v[40:43], a[16:19], a[192:195], v[88:91]
v_exp_f32 v24, v24
s_waitcnt lgkmcnt(8)
v_mfma_f32_16x16x32_bf16 v[40:43], a[20:23], a[196:199], v[40:43]
ds_read_b128 a[56:59], v1 offset:14336
v_exp_f32 v25, v25
s_waitcnt lgkmcnt(8)
v_mfma_f32_16x16x32_bf16 v[40:43], a[24:27], a[200:203], v[40:43]
buffer_load_dwordx4 v3, s[88:91], s32 offen offset:3072 lds
s_waitcnt lgkmcnt(7)
v_mfma_f32_16x16x32_bf16 v[40:43], a[28:31], a[204:207], v[40:43]
ds_read_b128 a[60:63], v1 offset:15360
v_mfma_f32_16x16x32_bf16 v[44:47], a[16:19], a[208:211], v[92:95]
v_exp_f32 v26, v26
v_mfma_f32_16x16x32_bf16 v[44:47], a[20:23], a[212:215], v[44:47]
v_exp_f32 v27, v27
v_mfma_f32_16x16x32_bf16 v[44:47], a[24:27], a[216:219], v[44:47]
v_mfma_f32_16x16x32_bf16 v[44:47], a[28:31], a[220:223], v[44:47]
v_cvt_pk_bf16_f32 v56, v24, v25
v_cvt_pk_bf16_f32 v57, v26, v27
s_waitcnt lgkmcnt(0)
v_mfma_f32_16x16x32_bf16 v[192:195], a[32:35], v[72:75], v[192:195]
ds_read_b128 a[0:3], v1 offset:16384
v_exp_f32 v28, v28
v_mfma_f32_16x16x32_bf16 v[224:227], a[32:35], v[76:79], v[224:227]
ds_read_b128 a[4:7], v1 offset:17408
v_mfma_f32_16x16x32_bf16 v[228:231], a[36:39], v[76:79], v[228:231]
v_exp_f32 v29, v29
v_mfma_f32_16x16x32_bf16 v[196:199], a[36:39], v[72:75], v[196:199]
s_add_u32 m0, s18, 0x11000
ds_read_b128 a[8:11], v1 offset:18432
v_exp_f32 v30, v30
v_mfma_f32_16x16x32_bf16 v[200:203], a[40:43], v[72:75], v[200:203]
buffer_load_dwordx4 v3, s[88:91], s11 offen offset:0 lds
v_mfma_f32_16x16x32_bf16 v[232:235], a[40:43], v[76:79], v[232:235]
ds_read_b128 a[12:15], v1 offset:19456
v_mfma_f32_16x16x32_bf16 v[236:239], a[44:47], v[76:79], v[236:239]
v_exp_f32 v31, v31
v_mfma_f32_16x16x32_bf16 v[204:207], a[44:47], v[72:75], v[204:207]
ds_read_b128 a[16:19], v1 offset:20480
v_cvt_pk_bf16_f32 v60, v28, v29
v_cvt_pk_bf16_f32 v61, v30, v31
v_mfma_f32_16x16x32_bf16 v[208:211], a[48:51], v[72:75], v[208:211]
ds_read_b128 a[20:23], v1 offset:21504
v_mfma_f32_16x16x32_bf16 v[240:243], a[48:51], v[76:79], v[240:243]
v_exp_f32 v40, v40
v_mfma_f32_16x16x32_bf16 v[244:247], a[52:55], v[76:79], v[244:247]
ds_read_b128 a[24:27], v1 offset:22528
v_exp_f32 v41, v41
v_mfma_f32_16x16x32_bf16 v[212:215], a[52:55], v[72:75], v[212:215]
ds_read_b128 a[28:31], v1 offset:23552
v_mfma_f32_16x16x32_bf16 v[216:219], a[56:59], v[72:75], v[216:219]
buffer_load_dwordx4 v3, s[88:91], s11 offen offset:1024 lds
v_mfma_f32_16x16x32_bf16 v[248:251], a[56:59], v[76:79], v[248:251]
v_exp_f32 v42, v42
v_mfma_f32_16x16x32_bf16 v[252:255], a[60:63], v[76:79], v[252:255]
v_exp_f32 v43, v43
v_mfma_f32_16x16x32_bf16 v[220:223], a[60:63], v[72:75], v[220:223]
v_mfma_f32_16x16x32_bf16 a[232:235], a[240:243], v[72:75], a[232:235]
v_cvt_pk_bf16_f32 v58, v40, v41
v_cvt_pk_bf16_f32 v59, v42, v43
v_mfma_f32_16x16x32_bf16 a[236:239], a[240:243], v[76:79], a[236:239]
v_exp_f32 v44, v44
s_waitcnt lgkmcnt(7)
v_mfma_f32_16x16x32_bf16 v[24:27], a[0:3], a[192:195], v[88:91]
ds_read_b128 a[32:35], v1 offset:24576
s_waitcnt lgkmcnt(7)
v_mfma_f32_16x16x32_bf16 v[24:27], a[4:7], a[196:199], v[24:27]
ds_read_b128 a[36:39], v1 offset:25600
v_exp_f32 v45, v45
s_waitcnt lgkmcnt(7)
v_mfma_f32_16x16x32_bf16 v[24:27], a[8:11], a[200:203], v[24:27]
buffer_load_dwordx4 v3, s[88:91], s11 offen offset:2048 lds
s_waitcnt lgkmcnt(6)
v_mfma_f32_16x16x32_bf16 v[24:27], a[12:15], a[204:207], v[24:27]
ds_read_b128 a[40:43], v1 offset:26624
v_exp_f32 v46, v46
v_mfma_f32_16x16x32_bf16 v[28:31], a[0:3], a[208:211], v[92:95]
v_mfma_f32_16x16x32_bf16 v[28:31], a[4:7], a[212:215], v[28:31]
ds_read_b128 a[44:47], v1 offset:27648
v_exp_f32 v47, v47
v_mfma_f32_16x16x32_bf16 v[28:31], a[8:11], a[216:219], v[28:31]
ds_read_b128 a[48:51], v1 offset:28672
v_cvt_pk_bf16_f32 v62, v44, v45
v_cvt_pk_bf16_f32 v63, v46, v47
v_mfma_f32_16x16x32_bf16 v[28:31], a[12:15], a[220:223], v[28:31]
ds_read_b128 a[52:55], v1 offset:29696
s_waitcnt lgkmcnt(9)
v_mfma_f32_16x16x32_bf16 v[40:43], a[16:19], a[192:195], v[88:91]
v_exp_f32 v24, v24
s_waitcnt lgkmcnt(8)
v_mfma_f32_16x16x32_bf16 v[40:43], a[20:23], a[196:199], v[40:43]
ds_read_b128 a[56:59], v1 offset:30720
v_exp_f32 v25, v25
s_waitcnt lgkmcnt(8)
v_mfma_f32_16x16x32_bf16 v[40:43], a[24:27], a[200:203], v[40:43]
buffer_load_dwordx4 v3, s[88:91], s11 offen offset:3072 lds
s_waitcnt lgkmcnt(7)
v_mfma_f32_16x16x32_bf16 v[40:43], a[28:31], a[204:207], v[40:43]
ds_read_b128 a[60:63], v1 offset:31744
v_mfma_f32_16x16x32_bf16 v[44:47], a[16:19], a[208:211], v[92:95]
v_exp_f32 v26, v26
v_mfma_f32_16x16x32_bf16 v[44:47], a[20:23], a[212:215], v[44:47]
v_exp_f32 v27, v27
v_mfma_f32_16x16x32_bf16 v[44:47], a[24:27], a[216:219], v[44:47]
v_mfma_f32_16x16x32_bf16 v[44:47], a[28:31], a[220:223], v[44:47]
v_cvt_pk_bf16_f32 v72, v24, v25
v_cvt_pk_bf16_f32 v73, v26, v27
s_add_u32 s32, s32, 0x8000
s_add_u32 s11, s11, 0x8000
s_xor_b32 s18, s18, 0x8000
v_xor_b32 v1, 0x8000, v1
L_att_sodd:
s_waitcnt vmcnt(16) lgkmcnt(0)
s_barrier
v_mfma_f32_16x16x32_bf16 v[192:195], a[32:35], v[56:59], v[192:195]
ds_read_b128 a[0:3], v2 offset:0
v_exp_f32 v28, v28
v_mfma_f32_16x16x32_bf16 v[224:227], a[32:35], v[60:63], v[224:227]
ds_read_b128 a[4:7], v2 offset:1024
v_mfma_f32_16x16x32_bf16 v[228:231], a[36:39], v[60:63], v[228:231]
v_exp_f32 v29, v29
v_mfma_f32_16x16x32_bf16 v[196:199], a[36:39], v[56:59], v[196:199]
s_add_u32 m0, s18, 0x0
ds_read_b128 a[8:11], v2 offset:2048
v_exp_f32 v30, v30
v_mfma_f32_16x16x32_bf16 v[200:203], a[40:43], v[56:59], v[200:203]
buffer_load_dwordx4 v3, s[88:91], s32 offen offset:0 lds
v_mfma_f32_16x16x32_bf16 v[232:235], a[40:43], v[60:63], v[232:235]
ds_read_b128 a[12:15], v2 offset:3072
v_mfma_f32_16x16x32_bf16 v[236:239], a[44:47], v[60:63], v[236:239]
v_exp_f32 v31, v31
v_mfma_f32_16x16x32_bf16 v[204:207], a[44:47], v[56:59], v[204:207]
ds_read_b128 a[16:19], v2 offset:4096
v_cvt_pk_bf16_f32 v76, v28, v29
v_cvt_pk_bf16_f32 v77, v30, v31
v_mfma_f32_16x16x32_bf16 v[208:211], a[48:51], v[56:59], v[208:211]
ds_read_b128 a[20:23], v2 offset:5120
v_mfma_f32_16x16x32_bf16 v[240:243], a[48:51], v[60:63], v[240:243]
v_exp_f32 v40, v40
v_mfma_f32_16x16x32_bf16 v[244:247], a[52:55], v[60:63], v[244:247]
ds_read_b128 a[24:27], v2 offset:6144
v_exp_f32 v41, v41
v_mfma_f32_16x16x32_bf16 v[212:215], a[52:55], v[56:59], v[212:215]
ds_read_b128 a[28:31], v2 offset:7168
v_mfma_f32_16x16x32_bf16 v[216:219], a[56:59], v[56:59], v[216:219]
buffer_load_dwordx4 v3, s[88:91], s32 offen offset:1024 lds
v_mfma_f32_16x16x32_bf16 v[248:251], a[56:59], v[60:63], v[248:251]
v_exp_f32 v42, v42
v_mfma_f32_16x16x32_bf16 v[252:255], a[60:63], v[60:63], v[252:255]
v_exp_f32 v43, v43
v_mfma_f32_16x16x32_bf16 v[220:223], a[60:63], v[56:59], v[220:223]
v_mfma_f32_16x16x32_bf16 a[232:235], a[240:243], v[56:59], a[232:235]
v_cvt_pk_bf16_f32 v74, v40, v41
v_cvt_pk_bf16_f32 v75, v42, v43
v_mfma_f32_16x16x32_bf16 a[236:239], a[240:243], v[60:63], a[236:239]
v_exp_f32 v44, v44
s_waitcnt lgkmcnt(7)
v_mfma_f32_16x16x32_bf16 v[24:27], a[0:3], a[192:195], v[88:91]
ds_read_b128 a[32:35], v2 offset:8192
s_waitcnt lgkmcnt(7)
v_mfma_f32_16x16x32_bf16 v[24:27], a[4:7], a[196:199], v[24:27]
ds_read_b128 a[36:39], v2 offset:9216
v_exp_f32 v45, v45
s_waitcnt lgkmcnt(7)
v_mfma_f32_16x16x32_bf16 v[24:27], a[8:11], a[200:203], v[24:27]
buffer_load_dwordx4 v3, s[88:91], s32 offen offset:2048 lds
s_waitcnt lgkmcnt(6)
v_mfma_f32_16x16x32_bf16 v[24:27], a[12:15], a[204:207], v[24:27]
ds_read_b128 a[40:43], v2 offset:10240
v_exp_f32 v46, v46
v_mfma_f32_16x16x32_bf16 v[28:31], a[0:3], a[208:211], v[92:95]
v_mfma_f32_16x16x32_bf16 v[28:31], a[4:7], a[212:215], v[28:31]
ds_read_b128 a[44:47], v2 offset:11264
v_exp_f32 v47, v47
v_mfma_f32_16x16x32_bf16 v[28:31], a[8:11], a[216:219], v[28:31]
ds_read_b128 a[48:51], v2 offset:12288
v_cvt_pk_bf16_f32 v78, v44, v45
v_cvt_pk_bf16_f32 v79, v46, v47
v_mfma_f32_16x16x32_bf16 v[28:31], a[12:15], a[220:223], v[28:31]
ds_read_b128 a[52:55], v2 offset:13312
s_waitcnt lgkmcnt(9)
v_mfma_f32_16x16x32_bf16 v[40:43], a[16:19], a[192:195], v[88:91]
v_exp_f32 v24, v24
s_waitcnt lgkmcnt(8)
v_mfma_f32_16x16x32_bf16 v[40:43], a[20:23], a[196:199], v[40:43]
ds_read_b128 a[56:59], v2 offset:14336
v_exp_f32 v25, v25
s_waitcnt lgkmcnt(8)
v_mfma_f32_16x16x32_bf16 v[40:43], a[24:27], a[200:203], v[40:43]
buffer_load_dwordx4 v3, s[88:91], s32 offen offset:3072 lds
s_waitcnt lgkmcnt(7)
v_mfma_f32_16x16x32_bf16 v[40:43], a[28:31], a[204:207], v[40:43]
ds_read_b128 a[60:63], v2 offset:15360
v_mfma_f32_16x16x32_bf16 v[44:47], a[16:19], a[208:211], v[92:95]
v_exp_f32 v26, v26
v_mfma_f32_16x16x32_bf16 v[44:47], a[20:23], a[212:215], v[44:47]
v_exp_f32 v27, v27
v_mfma_f32_16x16x32_bf16 v[44:47], a[24:27], a[216:219], v[44:47]
v_mfma_f32_16x16x32_bf16 v[44:47], a[28:31], a[220:223], v[44:47]
v_cvt_pk_bf16_f32 v56, v24, v25
v_cvt_pk_bf16_f32 v57, v26, v27
s_waitcnt lgkmcnt(0)
v_mfma_f32_16x16x32_bf16 v[192:195], a[32:35], v[72:75], v[192:195]
ds_read_b128 a[0:3], v2 offset:16384
v_exp_f32 v28, v28
v_mfma_f32_16x16x32_bf16 v[224:227], a[32:35], v[76:79], v[224:227]
ds_read_b128 a[4:7], v2 offset:17408
v_mfma_f32_16x16x32_bf16 v[228:231], a[36:39], v[76:79], v[228:231]
v_exp_f32 v29, v29
v_mfma_f32_16x16x32_bf16 v[196:199], a[36:39], v[72:75], v[196:199]
s_add_u32 m0, s18, 0x1000
ds_read_b128 a[8:11], v2 offset:18432
v_exp_f32 v30, v30
v_mfma_f32_16x16x32_bf16 v[200:203], a[40:43], v[72:75], v[200:203]
buffer_load_dwordx4 v3, s[88:91], s11 offen offset:0 lds
v_mfma_f32_16x16x32_bf16 v[232:235], a[40:43], v[76:79], v[232:235]
ds_read_b128 a[12:15], v2 offset:19456
v_mfma_f32_16x16x32_bf16 v[236:239], a[44:47], v[76:79], v[236:239]
v_exp_f32 v31, v31
v_mfma_f32_16x16x32_bf16 v[204:207], a[44:47], v[72:75], v[204:207]
ds_read_b128 a[16:19], v2 offset:20480
v_cvt_pk_bf16_f32 v60, v28, v29
v_cvt_pk_bf16_f32 v61, v30, v31
v_mfma_f32_16x16x32_bf16 v[208:211], a[48:51], v[72:75], v[208:211]
ds_read_b128 a[20:23], v2 offset:21504
v_mfma_f32_16x16x32_bf16 v[240:243], a[48:51], v[76:79], v[240:243]
v_exp_f32 v40, v40
v_mfma_f32_16x16x32_bf16 v[244:247], a[52:55], v[76:79], v[244:247]
ds_read_b128 a[24:27], v2 offset:22528
v_exp_f32 v41, v41
v_mfma_f32_16x16x32_bf16 v[212:215], a[52:55], v[72:75], v[212:215]
ds_read_b128 a[28:31], v2 offset:23552
v_mfma_f32_16x16x32_bf16 v[216:219], a[56:59], v[72:75], v[216:219]
buffer_load_dwordx4 v3, s[88:91], s11 offen offset:1024 lds
v_mfma_f32_16x16x32_bf16 v[248:251], a[56:59], v[76:79], v[248:251]
v_exp_f32 v42, v42
v_mfma_f32_16x16x32_bf16 v[252:255], a[60:63], v[76:79], v[252:255]
v_exp_f32 v43, v43
v_mfma_f32_16x16x32_bf16 v[220:223], a[60:63], v[72:75], v[220:223]
v_mfma_f32_16x16x32_bf16 a[232:235], a[240:243], v[72:75], a[232:235]
v_cvt_pk_bf16_f32 v58, v40, v41
v_cvt_pk_bf16_f32 v59, v42, v43
v_mfma_f32_16x16x32_bf16 a[236:239], a[240:243], v[76:79], a[236:239]
v_exp_f32 v44, v44
s_waitcnt lgkmcnt(7)
v_mfma_f32_16x16x32_bf16 v[24:27], a[0:3], a[192:195], v[88:91]
ds_read_b128 a[32:35], v2 offset:24576
s_waitcnt lgkmcnt(7)
v_mfma_f32_16x16x32_bf16 v[24:27], a[4:7], a[196:199], v[24:27]
ds_read_b128 a[36:39], v2 offset:25600
v_exp_f32 v45, v45
s_waitcnt lgkmcnt(7)
v_mfma_f32_16x16x32_bf16 v[24:27], a[8:11], a[200:203], v[24:27]
buffer_load_dwordx4 v3, s[88:91], s11 offen offset:2048 lds
s_waitcnt lgkmcnt(6)
v_mfma_f32_16x16x32_bf16 v[24:27], a[12:15], a[204:207], v[24:27]
ds_read_b128 a[40:43], v2 offset:26624
v_exp_f32 v46, v46
v_mfma_f32_16x16x32_bf16 v[28:31], a[0:3], a[208:211], v[92:95]
v_mfma_f32_16x16x32_bf16 v[28:31], a[4:7], a[212:215], v[28:31]
ds_read_b128 a[44:47], v2 offset:27648
v_exp_f32 v47, v47
v_mfma_f32_16x16x32_bf16 v[28:31], a[8:11], a[216:219], v[28:31]
ds_read_b128 a[48:51], v2 offset:28672
v_cvt_pk_bf16_f32 v62, v44, v45
v_cvt_pk_bf16_f32 v63, v46, v47
v_mfma_f32_16x16x32_bf16 v[28:31], a[12:15], a[220:223], v[28:31]
ds_read_b128 a[52:55], v2 offset:29696
s_waitcnt lgkmcnt(9)
v_mfma_f32_16x16x32_bf16 v[40:43], a[16:19], a[192:195], v[88:91]
v_exp_f32 v24, v24
s_waitcnt lgkmcnt(8)
v_mfma_f32_16x16x32_bf16 v[40:43], a[20:23], a[196:199], v[40:43]
ds_read_b128 a[56:59], v2 offset:30720
v_exp_f32 v25, v25
s_waitcnt lgkmcnt(8)
v_mfma_f32_16x16x32_bf16 v[40:43], a[24:27], a[200:203], v[40:43]
buffer_load_dwordx4 v3, s[88:91], s11 offen offset:3072 lds
s_waitcnt lgkmcnt(7)
v_mfma_f32_16x16x32_bf16 v[40:43], a[28:31], a[204:207], v[40:43]
ds_read_b128 a[60:63], v2 offset:31744
v_mfma_f32_16x16x32_bf16 v[44:47], a[16:19], a[208:211], v[92:95]
v_exp_f32 v26, v26
v_mfma_f32_16x16x32_bf16 v[44:47], a[20:23], a[212:215], v[44:47]
v_exp_f32 v27, v27
v_mfma_f32_16x16x32_bf16 v[44:47], a[24:27], a[216:219], v[44:47]
v_mfma_f32_16x16x32_bf16 v[44:47], a[28:31], a[220:223], v[44:47]
v_cvt_pk_bf16_f32 v72, v24, v25
v_cvt_pk_bf16_f32 v73, v26, v27
s_add_u32 s32, s32, 0x8000
s_add_u32 s11, s11, 0x8000
v_xor_b32 v2, 0x8000, v2
s_sub_u32 s15, s15, 1
s_cmp_lg_u32 s15, 0
s_cbranch_scc1 L_att_seven
s_cmp_ge_u32 s4, 2
s_cbranch_scc1 L_att_sh0_1
L_att_sh0_0:
s_waitcnt vmcnt(16) lgkmcnt(0)
s_barrier
v_mfma_f32_16x16x32_bf16 v[192:195], a[32:35], v[56:59], v[192:195]
ds_read_b128 a[0:3], v1 offset:0
v_exp_f32 v28, v28
v_mfma_f32_16x16x32_bf16 v[224:227], a[32:35], v[60:63], v[224:227]
ds_read_b128 a[4:7], v1 offset:1024
v_mfma_f32_16x16x32_bf16 v[228:231], a[36:39], v[60:63], v[228:231]
v_exp_f32 v29, v29
v_mfma_f32_16x16x32_bf16 v[196:199], a[36:39], v[56:59], v[196:199]
ds_read_b128 a[8:11], v1 offset:2048
v_mfma_f32_16x16x32_bf16 v[200:203], a[40:43], v[56:59], v[200:203]
v_exp_f32 v30, v30
v_mfma_f32_16x16x32_bf16 v[232:235], a[40:43], v[60:63], v[232:235]
ds_read_b128 a[12:15], v1 offset:3072
v_mfma_f32_16x16x32_bf16 v[236:239], a[44:47], v[60:63], v[236:239]
v_exp_f32 v31, v31
v_mfma_f32_16x16x32_bf16 v[204:207], a[44:47], v[56:59], v[204:207]
ds_read_b128 a[16:19], v1 offset:4096
v_cvt_pk_bf16_f32 v76, v28, v29
v_cvt_pk_bf16_f32 v77, v30, v31
v_mfma_f32_16x16x32_bf16 v[208:211], a[48:51], v[56:59], v[208:211]
ds_read_b128 a[20:23], v1 offset:5120
v_mfma_f32_16x16x32_bf16 v[240:243], a[48:51], v[60:63], v[240:243]
v_exp_f32 v40, v40
v_mfma_f32_16x16x32_bf16 v[244:247], a[52:55], v[60:63], v[244:247]
ds_read_b128 a[24:27], v1 offset:6144
v_mfma_f32_16x16x32_bf16 v[212:215], a[52:55], v[56:59], v[212:215]
v_exp_f32 v41, v41
v_mfma_f32_16x16x32_bf16 v[216:219], a[56:59], v[56:59], v[216:219]
ds_read_b128 a[28:31], v1 offset:7168
v_exp_f32 v42, v42
v_mfma_f32_16x16x32_bf16 v[248:251], a[56:59], v[60:63], v[248:251]
v_mfma_f32_16x16x32_bf16 v[252:255], a[60:63], v[60:63], v[252:255]
v_exp_f32 v43, v43
v_mfma_f32_16x16x32_bf16 v[220:223], a[60:63], v[56:59], v[220:223]
v_mfma_f32_16x16x32_bf16 a[232:235], a[240:243], v[56:59], a[232:235]
v_cvt_pk_bf16_f32 v74, v40, v41
v_cvt_pk_bf16_f32 v75, v42, v43
v_mfma_f32_16x16x32_bf16 a[236:239], a[240:243], v[60:63], a[236:239]
v_exp_f32 v44, v44
s_waitcnt lgkmcnt(7)
v_mfma_f32_16x16x32_bf16 v[24:27], a[0:3], a[192:195], v[112:115]
ds_read_b128 a[32:35], v1 offset:8192
s_waitcnt lgkmcnt(7)
v_mfma_f32_16x16x32_bf16 v[24:27], a[4:7], a[196:199], v[24:27]
ds_read_b128 a[36:39], v1 offset:9216
v_exp_f32 v45, v45
s_waitcnt lgkmcnt(7)
v_mfma_f32_16x16x32_bf16 v[24:27], a[8:11], a[200:203], v[24:27]
s_waitcnt lgkmcnt(6)
v_mfma_f32_16x16x32_bf16 v[24:27], a[12:15], a[204:207], v[24:27]
ds_read_b128 a[40:43], v1 offset:10240
v_exp_f32 v46, v46
v_mfma_f32_16x16x32_bf16 v[28:31], a[0:3], a[208:211], v[92:95]
ds_read_b128 a[44:47], v1 offset:11264
v_mfma_f32_16x16x32_bf16 v[28:31], a[4:7], a[212:215], v[28:31]
v_exp_f32 v47, v47
v_mfma_f32_16x16x32_bf16 v[28:31], a[8:11], a[216:219], v[28:31]
ds_read_b128 a[48:51], v1 offset:12288
v_cvt_pk_bf16_f32 v78, v44, v45
v_cvt_pk_bf16_f32 v79, v46, v47
v_mfma_f32_16x16x32_bf16 v[28:31], a[12:15], a[220:223], v[28:31]
s_waitcnt lgkmcnt(8)
v_mfma_f32_16x16x32_bf16 v[40:43], a[16:19], a[192:195], v[116:119]
ds_read_b128 a[52:55], v1 offset:13312
v_exp_f32 v24, v24
s_waitcnt lgkmcnt(8)
v_mfma_f32_16x16x32_bf16 v[40:43], a[20:23], a[196:199], v[40:43]
ds_read_b128 a[56:59], v1 offset:14336
s_waitcnt lgkmcnt(8)
v_mfma_f32_16x16x32_bf16 v[40:43], a[24:27], a[200:203], v[40:43]
v_exp_f32 v25, v25
s_waitcnt lgkmcnt(7)
v_mfma_f32_16x16x32_bf16 v[40:43], a[28:31], a[204:207], v[40:43]
ds_read_b128 a[60:63], v1 offset:15360
v_exp_f32 v26, v26
v_mfma_f32_16x16x32_bf16 v[44:47], a[16:19], a[208:211], v[92:95]
v_mfma_f32_16x16x32_bf16 v[44:47], a[20:23], a[212:215], v[44:47]
v_exp_f32 v27, v27
v_mfma_f32_16x16x32_bf16 v[44:47], a[24:27], a[216:219], v[44:47]
v_mfma_f32_16x16x32_bf16 v[44:47], a[28:31], a[220:223], v[44:47]
v_cvt_pk_bf16_f32 v56, v24, v25
v_cvt_pk_bf16_f32 v57, v26, v27
s_waitcnt lgkmcnt(0)
v_mfma_f32_16x16x32_bf16 v[192:195], a[32:35], v[72:75], v[192:195]
ds_read_b128 a[0:3], v1 offset:16384
v_exp_f32 v28, v28
v_mfma_f32_16x16x32_bf16 v[224:227], a[32:35], v[76:79], v[224:227]
ds_read_b128 a[4:7], v1 offset:17408
v_mfma_f32_16x16x32_bf16 v[228:231], a[36:39], v[76:79], v[228:231]
v_exp_f32 v29, v29
v_mfma_f32_16x16x32_bf16 v[196:199], a[36:39], v[72:75], v[196:199]
ds_read_b128 a[8:11], v1 offset:18432
v_mfma_f32_16x16x32_bf16 v[200:203], a[40:43], v[72:75], v[200:203]
v_exp_f32 v30, v30
v_mfma_f32_16x16x32_bf16 v[232:235], a[40:43], v[76:79], v[232:235]
ds_read_b128 a[12:15], v1 offset:19456
v_mfma_f32_16x16x32_bf16 v[236:239], a[44:47], v[76:79], v[236:239]
v_exp_f32 v31, v31
v_mfma_f32_16x16x32_bf16 v[204:207], a[44:47], v[72:75], v[204:207]
ds_read_b128 a[16:19], v1 offset:20480
v_cvt_pk_bf16_f32 v60, v28, v29
v_cvt_pk_bf16_f32 v61, v30, v31
v_mfma_f32_16x16x32_bf16 v[208:211], a[48:51], v[72:75], v[208:211]
ds_read_b128 a[20:23], v1 offset:21504
v_mfma_f32_16x16x32_bf16 v[240:243], a[48:51], v[76:79], v[240:243]
v_exp_f32 v40, v40
v_mfma_f32_16x16x32_bf16 v[244:247], a[52:55], v[76:79], v[244:247]
ds_read_b128 a[24:27], v1 offset:22528
v_mfma_f32_16x16x32_bf16 v[212:215], a[52:55], v[72:75], v[212:215]
v_exp_f32 v41, v41
v_mfma_f32_16x16x32_bf16 v[216:219], a[56:59], v[72:75], v[216:219]
ds_read_b128 a[28:31], v1 offset:23552
v_mfma_f32_16x16x32_bf16 v[248:251], a[56:59], v[76:79], v[248:251]
v_exp_f32 v42, v42
v_mfma_f32_16x16x32_bf16 v[252:255], a[60:63], v[76:79], v[252:255]
v_exp_f32 v43, v43
v_mfma_f32_16x16x32_bf16 v[220:223], a[60:63], v[72:75], v[220:223]
v_mfma_f32_16x16x32_bf16 a[232:235], a[240:243], v[72:75], a[232:235]
v_cvt_pk_bf16_f32 v58, v40, v41
v_cvt_pk_bf16_f32 v59, v42, v43
v_mfma_f32_16x16x32_bf16 a[236:239], a[240:243], v[76:79], a[236:239]
v_exp_f32 v44, v44
s_waitcnt lgkmcnt(7)
v_mfma_f32_16x16x32_bf16 v[28:31], a[0:3], a[208:211], v[92:95]
v_exp_f32 v45, v45
s_waitcnt lgkmcnt(6)
v_mfma_f32_16x16x32_bf16 v[28:31], a[4:7], a[212:215], v[28:31]
v_exp_f32 v46, v46
s_waitcnt lgkmcnt(5)
v_mfma_f32_16x16x32_bf16 v[28:31], a[8:11], a[216:219], v[28:31]
v_exp_f32 v47, v47
s_waitcnt lgkmcnt(4)
v_mfma_f32_16x16x32_bf16 v[28:31], a[12:15], a[220:223], v[28:31]
v_cvt_pk_bf16_f32 v62, v44, v45
v_cvt_pk_bf16_f32 v63, v46, v47
s_waitcnt lgkmcnt(3)
v_mfma_f32_16x16x32_bf16 v[44:47], a[16:19], a[208:211], v[92:95]
s_waitcnt lgkmcnt(2)
v_mfma_f32_16x16x32_bf16 v[44:47], a[20:23], a[212:215], v[44:47]
s_waitcnt lgkmcnt(1)
v_mfma_f32_16x16x32_bf16 v[44:47], a[24:27], a[216:219], v[44:47]
s_waitcnt lgkmcnt(0)
v_mfma_f32_16x16x32_bf16 v[44:47], a[28:31], a[220:223], v[44:47]
ds_read_b128 a[32:35], v1 offset:24576
ds_read_b128 a[36:39], v1 offset:25600
ds_read_b128 a[40:43], v1 offset:26624
ds_read_b128 a[44:47], v1 offset:27648
ds_read_b128 a[48:51], v1 offset:28672
ds_read_b128 a[52:55], v1 offset:29696
ds_read_b128 a[56:59], v1 offset:30720
ds_read_b128 a[60:63], v1 offset:31744
v_xor_b32 v1, 0x8000, v1
L_att_h1_0:
s_waitcnt vmcnt(8) lgkmcnt(0)
s_barrier
v_mfma_f32_16x16x32_bf16 v[192:195], a[32:35], v[56:59], v[192:195]
ds_read_b128 a[0:3], v2 offset:0
v_exp_f32 v28, v28
v_mfma_f32_16x16x32_bf16 v[224:227], a[32:35], v[60:63], v[224:227]
ds_read_b128 a[4:7], v2 offset:1024
v_mfma_f32_16x16x32_bf16 v[228:231], a[36:39], v[60:63], v[228:231]
v_mfma_f32_16x16x32_bf16 v[196:199], a[36:39], v[56:59], v[196:199]
ds_read_b128 a[8:11], v2 offset:2048
v_exp_f32 v29, v29
v_mfma_f32_16x16x32_bf16 v[200:203], a[40:43], v[56:59], v[200:203]
v_mfma_f32_16x16x32_bf16 v[232:235], a[40:43], v[60:63], v[232:235]
ds_read_b128 a[12:15], v2 offset:3072
v_mfma_f32_16x16x32_bf16 v[236:239], a[44:47], v[60:63], v[236:239]
v_exp_f32 v30, v30
v_mfma_f32_16x16x32_bf16 v[204:207], a[44:47], v[56:59], v[204:207]
ds_read_b128 a[16:19], v2 offset:4096
v_mfma_f32_16x16x32_bf16 v[208:211], a[48:51], v[56:59], v[208:211]
ds_read_b128 a[20:23], v2 offset:5120
v_exp_f32 v31, v31
v_mfma_f32_16x16x32_bf16 v[240:243], a[48:51], v[60:63], v[240:243]
v_mfma_f32_16x16x32_bf16 v[244:247], a[52:55], v[60:63], v[244:247]
ds_read_b128 a[24:27], v2 offset:6144
v_mfma_f32_16x16x32_bf16 v[212:215], a[52:55], v[56:59], v[212:215]
v_cvt_pk_bf16_f32 v76, v28, v29
v_cvt_pk_bf16_f32 v77, v30, v31
v_mfma_f32_16x16x32_bf16 v[216:219], a[56:59], v[56:59], v[216:219]
ds_read_b128 a[28:31], v2 offset:7168
v_mfma_f32_16x16x32_bf16 v[248:251], a[56:59], v[60:63], v[248:251]
v_exp_f32 v44, v44
v_mfma_f32_16x16x32_bf16 v[252:255], a[60:63], v[60:63], v[252:255]
v_mfma_f32_16x16x32_bf16 v[220:223], a[60:63], v[56:59], v[220:223]
v_mfma_f32_16x16x32_bf16 a[232:235], a[240:243], v[56:59], a[232:235]
v_exp_f32 v45, v45
v_mfma_f32_16x16x32_bf16 a[236:239], a[240:243], v[60:63], a[236:239]
s_waitcnt lgkmcnt(7)
v_mfma_f32_16x16x32_bf16 v[28:31], a[0:3], a[208:211], v[92:95]
s_waitcnt lgkmcnt(6)
v_mfma_f32_16x16x32_bf16 v[28:31], a[4:7], a[212:215], v[28:31]
v_exp_f32 v46, v46
s_waitcnt lgkmcnt(5)
v_mfma_f32_16x16x32_bf16 v[28:31], a[8:11], a[216:219], v[28:31]
v_exp_f32 v47, v47
s_waitcnt lgkmcnt(4)
v_mfma_f32_16x16x32_bf16 v[28:31], a[12:15], a[220:223], v[28:31]
v_cvt_pk_bf16_f32 v78, v44, v45
v_cvt_pk_bf16_f32 v79, v46, v47
s_waitcnt lgkmcnt(3)
v_mfma_f32_16x16x32_bf16 v[44:47], a[16:19], a[208:211], v[92:95]
s_waitcnt lgkmcnt(2)
v_mfma_f32_16x16x32_bf16 v[44:47], a[20:23], a[212:215], v[44:47]
s_waitcnt lgkmcnt(1)
v_mfma_f32_16x16x32_bf16 v[44:47], a[24:27], a[216:219], v[44:47]
s_waitcnt lgkmcnt(0)
v_mfma_f32_16x16x32_bf16 v[44:47], a[28:31], a[220:223], v[44:47]
ds_read_b128 a[32:35], v2 offset:8192
ds_read_b128 a[36:39], v2 offset:9216
ds_read_b128 a[40:43], v2 offset:10240
ds_read_b128 a[44:47], v2 offset:11264
ds_read_b128 a[48:51], v2 offset:12288
ds_read_b128 a[52:55], v2 offset:13312
ds_read_b128 a[56:59], v2 offset:14336
ds_read_b128 a[60:63], v2 offset:15360
s_waitcnt lgkmcnt(0)
v_mfma_f32_16x16x32_bf16 v[224:227], a[32:35], v[76:79], v[224:227]
ds_read_b128 a[0:3], v2 offset:16384
v_exp_f32 v28, v28
v_mfma_f32_16x16x32_bf16 v[228:231], a[36:39], v[76:79], v[228:231]
ds_read_b128 a[4:7], v2 offset:17408
v_mfma_f32_16x16x32_bf16 v[232:235], a[40:43], v[76:79], v[232:235]
ds_read_b128 a[8:11], v2 offset:18432
v_exp_f32 v29, v29
v_mfma_f32_16x16x32_bf16 v[236:239], a[44:47], v[76:79], v[236:239]
ds_read_b128 a[12:15], v2 offset:19456
v_mfma_f32_16x16x32_bf16 v[240:243], a[48:51], v[76:79], v[240:243]
ds_read_b128 a[16:19], v2 offset:20480
v_exp_f32 v30, v30
v_mfma_f32_16x16x32_bf16 v[244:247], a[52:55], v[76:79], v[244:247]
ds_read_b128 a[20:23], v2 offset:21504
v_mfma_f32_16x16x32_bf16 v[248:251], a[56:59], v[76:79], v[248:251]
ds_read_b128 a[24:27], v2 offset:22528
v_exp_f32 v31, v31
v_mfma_f32_16x16x32_bf16 v[252:255], a[60:63], v[76:79], v[252:255]
ds_read_b128 a[28:31], v2 offset:23552
v_cvt_pk_bf16_f32 v60, v28, v29
v_cvt_pk_bf16_f32 v61, v30, v31
v_mfma_f32_16x16x32_bf16 a[236:239], a[240:243], v[76:79], a[236:239]
v_exp_f32 v44, v44
s_waitcnt lgkmcnt(7)
v_mfma_f32_16x16x32_bf16 v[28:31], a[0:3], a[208:211], v[120:123]
v_exp_f32 v45, v45
s_waitcnt lgkmcnt(6)
v_mfma_f32_16x16x32_bf16 v[28:31], a[4:7], a[212:215], v[28:31]
v_exp_f32 v46, v46
s_waitcnt lgkmcnt(5)
v_mfma_f32_16x16x32_bf16 v[28:31], a[8:11], a[216:219], v[28:31]
v_exp_f32 v47, v47
s_waitcnt lgkmcnt(4)
v_mfma_f32_16x16x32_bf16 v[28:31], a[12:15], a[220:223], v[28:31]
v_cvt_pk_bf16_f32 v62, v44, v45
v_cvt_pk_bf16_f32 v63, v46, v47
s_waitcnt lgkmcnt(3)
v_mfma_f32_16x16x32_bf16 v[44:47], a[16:19], a[208:211], v[124:127]
s_waitcnt lgkmcnt(2)
v_mfma_f32_16x16x32_bf16 v[44:47], a[20:23], a[212:215], v[44:47]
s_waitcnt lgkmcnt(1)
v_mfma_f32_16x16x32_bf16 v[44:47], a[24:27], a[216:219], v[44:47]
s_waitcnt lgkmcnt(0)
v_mfma_f32_16x16x32_bf16 v[44:47], a[28:31], a[220:223], v[44:47]
ds_read_b128 a[32:35], v2 offset:24576
ds_read_b128 a[36:39], v2 offset:25600
ds_read_b128 a[40:43], v2 offset:26624
ds_read_b128 a[44:47], v2 offset:27648
ds_read_b128 a[48:51], v2 offset:28672
ds_read_b128 a[52:55], v2 offset:29696
ds_read_b128 a[56:59], v2 offset:30720
ds_read_b128 a[60:63], v2 offset:31744
v_xor_b32 v2, 0x8000, v2
s_waitcnt vmcnt(0) lgkmcnt(0)
s_barrier
s_nop 7
v_exp_f32 v28, v28
s_nop 0
v_exp_f32 v29, v29
s_nop 0
v_exp_f32 v30, v30
s_nop 0
v_exp_f32 v31, v31
s_nop 0
v_cvt_pk_bf16_f32 v76, v28, v29
v_cvt_pk_bf16_f32 v77, v30, v31
s_nop 0
v_exp_f32 v44, v44
s_nop 0
v_exp_f32 v45, v45
s_nop 0
v_exp_f32 v46, v46
s_nop 0
v_exp_f32 v47, v47
s_nop 0
v_cvt_pk_bf16_f32 v78, v44, v45
v_cvt_pk_bf16_f32 v79, v46, v47
s_nop 0
v_mfma_f32_16x16x32_bf16 v[224:227], a[32:35], v[60:63], v[224:227]
v_mfma_f32_16x16x32_bf16 v[228:231], a[36:39], v[60:63], v[228:231]
v_mfma_f32_16x16x32_bf16 v[232:235], a[40:43], v[60:63], v[232:235]
v_mfma_f32_16x16x32_bf16 v[236:239], a[44:47], v[60:63], v[236:239]
v_mfma_f32_16x16x32_bf16 v[240:243], a[48:51], v[60:63], v[240:243]
v_mfma_f32_16x16x32_bf16 v[244:247], a[52:55], v[60:63], v[244:247]
v_mfma_f32_16x16x32_bf16 v[248:251], a[56:59], v[60:63], v[248:251]
v_mfma_f32_16x16x32_bf16 v[252:255], a[60:63], v[60:63], v[252:255]
v_mfma_f32_16x16x32_bf16 a[236:239], a[240:243], v[60:63], a[236:239]
ds_read_b128 a[32:35], v1 offset:8192
ds_read_b128 a[36:39], v1 offset:9216
ds_read_b128 a[40:43], v1 offset:10240
ds_read_b128 a[44:47], v1 offset:11264
ds_read_b128 a[48:51], v1 offset:12288
ds_read_b128 a[52:55], v1 offset:13312
ds_read_b128 a[56:59], v1 offset:14336
ds_read_b128 a[60:63], v1 offset:15360
s_waitcnt lgkmcnt(0)
s_nop 7
v_mfma_f32_16x16x32_bf16 v[224:227], a[32:35], v[76:79], v[224:227]
v_mfma_f32_16x16x32_bf16 v[228:231], a[36:39], v[76:79], v[228:231]
v_mfma_f32_16x16x32_bf16 v[232:235], a[40:43], v[76:79], v[232:235]
v_mfma_f32_16x16x32_bf16 v[236:239], a[44:47], v[76:79], v[236:239]
v_mfma_f32_16x16x32_bf16 v[240:243], a[48:51], v[76:79], v[240:243]
v_mfma_f32_16x16x32_bf16 v[244:247], a[52:55], v[76:79], v[244:247]
v_mfma_f32_16x16x32_bf16 v[248:251], a[56:59], v[76:79], v[248:251]
v_mfma_f32_16x16x32_bf16 v[252:255], a[60:63], v[76:79], v[252:255]
v_mfma_f32_16x16x32_bf16 a[236:239], a[240:243], v[76:79], a[236:239]
v_xor_b32 v1, 0x8000, v1
s_branch L_att_fin
L_att_sh0_1:
s_waitcnt vmcnt(16) lgkmcnt(0)
s_barrier
v_mfma_f32_16x16x32_bf16 v[192:195], a[32:35], v[56:59], v[192:195]
ds_read_b128 a[0:3], v1 offset:0
v_exp_f32 v28, v28
v_mfma_f32_16x16x32_bf16 v[224:227], a[32:35], v[60:63], v[224:227]
ds_read_b128 a[4:7], v1 offset:1024
v_mfma_f32_16x16x32_bf16 v[228:231], a[36:39], v[60:63], v[228:231]
v_exp_f32 v29, v29
v_mfma_f32_16x16x32_bf16 v[196:199], a[36:39], v[56:59], v[196:199]
ds_read_b128 a[8:11], v1 offset:2048
v_mfma_f32_16x16x32_bf16 v[200:203], a[40:43], v[56:59], v[200:203]
v_exp_f32 v30, v30
v_mfma_f32_16x16x32_bf16 v[232:235], a[40:43], v[60:63], v[232:235]
ds_read_b128 a[12:15], v1 offset:3072
v_mfma_f32_16x16x32_bf16 v[236:239], a[44:47], v[60:63], v[236:239]
v_exp_f32 v31, v31
v_mfma_f32_16x16x32_bf16 v[204:207], a[44:47], v[56:59], v[204:207]
ds_read_b128 a[16:19], v1 offset:4096
v_cvt_pk_bf16_f32 v76, v28, v29
v_cvt_pk_bf16_f32 v77, v30, v31
v_mfma_f32_16x16x32_bf16 v[208:211], a[48:51], v[56:59], v[208:211]
ds_read_b128 a[20:23], v1 offset:5120
v_mfma_f32_16x16x32_bf16 v[240:243], a[48:51], v[60:63], v[240:243]
v_exp_f32 v40, v40
v_mfma_f32_16x16x32_bf16 v[244:247], a[52:55], v[60:63], v[244:247]
ds_read_b128 a[24:27], v1 offset:6144
v_mfma_f32_16x16x32_bf16 v[212:215], a[52:55], v[56:59], v[212:215]
v_exp_f32 v41, v41
v_mfma_f32_16x16x32_bf16 v[216:219], a[56:59], v[56:59], v[216:219]
ds_read_b128 a[28:31], v1 offset:7168
v_exp_f32 v42, v42
v_mfma_f32_16x16x32_bf16 v[248:251], a[56:59], v[60:63], v[248:251]
v_mfma_f32_16x16x32_bf16 v[252:255], a[60:63], v[60:63], v[252:255]
v_exp_f32 v43, v43
v_mfma_f32_16x16x32_bf16 v[220:223], a[60:63], v[56:59], v[220:223]
v_mfma_f32_16x16x32_bf16 a[232:235], a[240:243], v[56:59], a[232:235]
v_cvt_pk_bf16_f32 v74, v40, v41
v_cvt_pk_bf16_f32 v75, v42, v43
v_mfma_f32_16x16x32_bf16 a[236:239], a[240:243], v[60:63], a[236:239]
v_exp_f32 v44, v44
s_waitcnt lgkmcnt(7)
v_mfma_f32_16x16x32_bf16 v[24:27], a[0:3], a[192:195], v[88:91]
ds_read_b128 a[32:35], v1 offset:8192
s_waitcnt lgkmcnt(7)
v_mfma_f32_16x16x32_bf16 v[24:27], a[4:7], a[196:199], v[24:27]
ds_read_b128 a[36:39], v1 offset:9216
v_exp_f32 v45, v45
s_waitcnt lgkmcnt(7)
v_mfma_f32_16x16x32_bf16 v[24:27], a[8:11], a[200:203], v[24:27]
s_waitcnt lgkmcnt(6)
v_mfma_f32_16x16x32_bf16 v[24:27], a[12:15], a[204:207], v[24:27]
ds_read_b128 a[40:43], v1 offset:10240
v_exp_f32 v46, v46
v_mfma_f32_16x16x32_bf16 v[28:31], a[0:3], a[208:211], v[92:95]
ds_read_b128 a[44:47], v1 offset:11264
v_mfma_f32_16x16x32_bf16 v[28:31], a[4:7], a[212:215], v[28:31]
v_exp_f32 v47, v47
v_mfma_f32_16x16x32_bf16 v[28:31], a[8:11], a[216:219], v[28:31]
ds_read_b128 a[48:51], v1 offset:12288
v_cvt_pk_bf16_f32 v78, v44, v45
v_cvt_pk_bf16_f32 v79, v46, v47
v_mfma_f32_16x16x32_bf16 v[28:31], a[12:15], a[220:223], v[28:31]
s_waitcnt lgkmcnt(8)
v_mfma_f32_16x16x32_bf16 v[40:43], a[16:19], a[192:195], v[88:91]
ds_read_b128 a[52:55], v1 offset:13312
v_exp_f32 v24, v24
s_waitcnt lgkmcnt(8)
v_mfma_f32_16x16x32_bf16 v[40:43], a[20:23], a[196:199], v[40:43]
ds_read_b128 a[56:59], v1 offset:14336
s_waitcnt lgkmcnt(8)
v_mfma_f32_16x16x32_bf16 v[40:43], a[24:27], a[200:203], v[40:43]
v_exp_f32 v25, v25
s_waitcnt lgkmcnt(7)
v_mfma_f32_16x16x32_bf16 v[40:43], a[28:31], a[204:207], v[40:43]
ds_read_b128 a[60:63], v1 offset:15360
v_exp_f32 v26, v26
v_mfma_f32_16x16x32_bf16 v[44:47], a[16:19], a[208:211], v[92:95]
v_mfma_f32_16x16x32_bf16 v[44:47], a[20:23], a[212:215], v[44:47]
v_exp_f32 v27, v27
v_mfma_f32_16x16x32_bf16 v[44:47], a[24:27], a[216:219], v[44:47]
v_mfma_f32_16x16x32_bf16 v[44:47], a[28:31], a[220:223], v[44:47]
v_cvt_pk_bf16_f32 v56, v24, v25
v_cvt_pk_bf16_f32 v57, v26, v27
s_waitcnt lgkmcnt(0)
v_mfma_f32_16x16x32_bf16 v[192:195], a[32:35], v[72:75], v[192:195]
ds_read_b128 a[0:3], v1 offset:16384
v_exp_f32 v28, v28
v_mfma_f32_16x16x32_bf16 v[224:227], a[32:35], v[76:79], v[224:227]
ds_read_b128 a[4:7], v1 offset:17408
v_mfma_f32_16x16x32_bf16 v[228:231], a[36:39], v[76:79], v[228:231]
v_exp_f32 v29, v29
v_mfma_f32_16x16x32_bf16 v[196:199], a[36:39], v[72:75], v[196:199]
ds_read_b128 a[8:11], v1 offset:18432
v_mfma_f32_16x16x32_bf16 v[200:203], a[40:43], v[72:75], v[200:203]
v_exp_f32 v30, v30
v_mfma_f32_16x16x32_bf16 v[232:235], a[40:43], v[76:79], v[232:235]
ds_read_b128 a[12:15], v1 offset:19456
v_mfma_f32_16x16x32_bf16 v[236:239], a[44:47], v[76:79], v[236:239]
v_exp_f32 v31, v31
v_mfma_f32_16x16x32_bf16 v[204:207], a[44:47], v[72:75], v[204:207]
ds_read_b128 a[16:19], v1 offset:20480
v_cvt_pk_bf16_f32 v60, v28, v29
v_cvt_pk_bf16_f32 v61, v30, v31
v_mfma_f32_16x16x32_bf16 v[208:211], a[48:51], v[72:75], v[208:211]
ds_read_b128 a[20:23], v1 offset:21504
v_mfma_f32_16x16x32_bf16 v[240:243], a[48:51], v[76:79], v[240:243]
v_exp_f32 v40, v40
v_mfma_f32_16x16x32_bf16 v[244:247], a[52:55], v[76:79], v[244:247]
ds_read_b128 a[24:27], v1 offset:22528
v_mfma_f32_16x16x32_bf16 v[212:215], a[52:55], v[72:75], v[212:215]
v_exp_f32 v41, v41
v_mfma_f32_16x16x32_bf16 v[216:219], a[56:59], v[72:75], v[216:219]
ds_read_b128 a[28:31], v1 offset:23552
v_exp_f32 v42, v42
v_mfma_f32_16x16x32_bf16 v[248:251], a[56:59], v[76:79], v[248:251]
v_mfma_f32_16x16x32_bf16 v[252:255], a[60:63], v[76:79], v[252:255]
v_exp_f32 v43, v43
v_mfma_f32_16x16x32_bf16 v[220:223], a[60:63], v[72:75], v[220:223]
v_mfma_f32_16x16x32_bf16 a[232:235], a[240:243], v[72:75], a[232:235]
v_cvt_pk_bf16_f32 v58, v40, v41
v_cvt_pk_bf16_f32 v59, v42, v43
v_mfma_f32_16x16x32_bf16 a[236:239], a[240:243], v[76:79], a[236:239]
v_exp_f32 v44, v44
s_waitcnt lgkmcnt(7)
v_mfma_f32_16x16x32_bf16 v[24:27], a[0:3], a[192:195], v[112:115]
ds_read_b128 a[32:35], v1 offset:24576
s_waitcnt lgkmcnt(7)
v_mfma_f32_16x16x32_bf16 v[24:27], a[4:7], a[196:199], v[24:27]
ds_read_b128 a[36:39], v1 offset:25600
v_exp_f32 v45, v45
s_waitcnt lgkmcnt(7)
v_mfma_f32_16x16x32_bf16 v[24:27], a[8:11], a[200:203], v[24:27]
s_waitcnt lgkmcnt(6)
v_mfma_f32_16x16x32_bf16 v[24:27], a[12:15], a[204:207], v[24:27]
ds_read_b128 a[40:43], v1 offset:26624
v_exp_f32 v46, v46
v_mfma_f32_16x16x32_bf16 v[28:31], a[0:3], a[208:211], v[92:95]
ds_read_b128 a[44:47], v1 offset:27648
v_mfma_f32_16x16x32_bf16 v[28:31], a[4:7], a[212:215], v[28:31]
v_exp_f32 v47, v47
v_mfma_f32_16x16x32_bf16 v[28:31], a[8:11], a[216:219], v[28:31]
ds_read_b128 a[48:51], v1 offset:28672
v_cvt_pk_bf16_f32 v62, v44, v45
v_cvt_pk_bf16_f32 v63, v46, v47
v_mfma_f32_16x16x32_bf16 v[28:31], a[12:15], a[220:223], v[28:31]
s_waitcnt lgkmcnt(8)
v_mfma_f32_16x16x32_bf16 v[40:43], a[16:19], a[192:195], v[116:119]
ds_read_b128 a[52:55], v1 offset:29696
v_exp_f32 v24, v24
s_waitcnt lgkmcnt(8)
v_mfma_f32_16x16x32_bf16 v[40:43], a[20:23], a[196:199], v[40:43]
ds_read_b128 a[56:59], v1 offset:30720
s_waitcnt lgkmcnt(8)
v_mfma_f32_16x16x32_bf16 v[40:43], a[24:27], a[200:203], v[40:43]
v_exp_f32 v25, v25
s_waitcnt lgkmcnt(7)
v_mfma_f32_16x16x32_bf16 v[40:43], a[28:31], a[204:207], v[40:43]
ds_read_b128 a[60:63], v1 offset:31744
v_exp_f32 v26, v26
v_mfma_f32_16x16x32_bf16 v[44:47], a[16:19], a[208:211], v[92:95]
v_mfma_f32_16x16x32_bf16 v[44:47], a[20:23], a[212:215], v[44:47]
v_exp_f32 v27, v27
v_mfma_f32_16x16x32_bf16 v[44:47], a[24:27], a[216:219], v[44:47]
v_mfma_f32_16x16x32_bf16 v[44:47], a[28:31], a[220:223], v[44:47]
v_cvt_pk_bf16_f32 v72, v24, v25
v_cvt_pk_bf16_f32 v73, v26, v27
v_xor_b32 v1, 0x8000, v1
L_att_h1_1:
s_waitcnt vmcnt(8) lgkmcnt(0)
s_barrier
v_mfma_f32_16x16x32_bf16 v[192:195], a[32:35], v[56:59], v[192:195]
ds_read_b128 a[0:3], v2 offset:0
v_exp_f32 v28, v28
v_mfma_f32_16x16x32_bf16 v[224:227], a[32:35], v[60:63], v[224:227]
ds_read_b128 a[4:7], v2 offset:1024
v_mfma_f32_16x16x32_bf16 v[228:231], a[36:39], v[60:63], v[228:231]
v_exp_f32 v29, v29
v_mfma_f32_16x16x32_bf16 v[196:199], a[36:39], v[56:59], v[196:199]
ds_read_b128 a[8:11], v2 offset:2048
v_mfma_f32_16x16x32_bf16 v[200:203], a[40:43], v[56:59], v[200:203]
v_exp_f32 v30, v30
v_mfma_f32_16x16x32_bf16 v[232:235], a[40:43], v[60:63], v[232:235]
ds_read_b128 a[12:15], v2 offset:3072
v_mfma_f32_16x16x32_bf16 v[236:239], a[44:47], v[60:63], v[236:239]
v_exp_f32 v31, v31
v_mfma_f32_16x16x32_bf16 v[204:207], a[44:47], v[56:59], v[204:207]
ds_read_b128 a[16:19], v2 offset:4096
v_cvt_pk_bf16_f32 v76, v28, v29
v_cvt_pk_bf16_f32 v77, v30, v31
v_mfma_f32_16x16x32_bf16 v[208:211], a[48:51], v[56:59], v[208:211]
ds_read_b128 a[20:23], v2 offset:5120
v_mfma_f32_16x16x32_bf16 v[240:243], a[48:51], v[60:63], v[240:243]
v_exp_f32 v40, v40
v_mfma_f32_16x16x32_bf16 v[244:247], a[52:55], v[60:63], v[244:247]
ds_read_b128 a[24:27], v2 offset:6144
v_mfma_f32_16x16x32_bf16 v[212:215], a[52:55], v[56:59], v[212:215]
v_exp_f32 v41, v41
v_mfma_f32_16x16x32_bf16 v[216:219], a[56:59], v[56:59], v[216:219]
ds_read_b128 a[28:31], v2 offset:7168
v_mfma_f32_16x16x32_bf16 v[248:251], a[56:59], v[60:63], v[248:251]
v_exp_f32 v42, v42
v_mfma_f32_16x16x32_bf16 v[252:255], a[60:63], v[60:63], v[252:255]
v_exp_f32 v43, v43
v_mfma_f32_16x16x32_bf16 v[220:223], a[60:63], v[56:59], v[220:223]
v_mfma_f32_16x16x32_bf16 a[232:235], a[240:243], v[56:59], a[232:235]
v_cvt_pk_bf16_f32 v74, v40, v41
v_cvt_pk_bf16_f32 v75, v42, v43
v_mfma_f32_16x16x32_bf16 a[236:239], a[240:243], v[60:63], a[236:239]
v_exp_f32 v44, v44
s_waitcnt lgkmcnt(7)
v_mfma_f32_16x16x32_bf16 v[28:31], a[0:3], a[208:211], v[120:123]
v_exp_f32 v45, v45
s_waitcnt lgkmcnt(6)
v_mfma_f32_16x16x32_bf16 v[28:31], a[4:7], a[212:215], v[28:31]
v_exp_f32 v46, v46
s_waitcnt lgkmcnt(5)
v_mfma_f32_16x16x32_bf16 v[28:31], a[8:11], a[216:219], v[28:31]
v_exp_f32 v47, v47
s_waitcnt lgkmcnt(4)
v_mfma_f32_16x16x32_bf16 v[28:31], a[12:15], a[220:223], v[28:31]
v_cvt_pk_bf16_f32 v78, v44, v45
v_cvt_pk_bf16_f32 v79, v46, v47
s_waitcnt lgkmcnt(3)
v_mfma_f32_16x16x32_bf16 v[44:47], a[16:19], a[208:211], v[124:127]
s_waitcnt lgkmcnt(2)
v_mfma_f32_16x16x32_bf16 v[44:47], a[20:23], a[212:215], v[44:47]
s_waitcnt lgkmcnt(1)
v_mfma_f32_16x16x32_bf16 v[44:47], a[24:27], a[216:219], v[44:47]
s_waitcnt lgkmcnt(0)
v_mfma_f32_16x16x32_bf16 v[44:47], a[28:31], a[220:223], v[44:47]
ds_read_b128 a[32:35], v2 offset:8192
ds_read_b128 a[36:39], v2 offset:9216
ds_read_b128 a[40:43], v2 offset:10240
ds_read_b128 a[44:47], v2 offset:11264
ds_read_b128 a[48:51], v2 offset:12288
ds_read_b128 a[52:55], v2 offset:13312
ds_read_b128 a[56:59], v2 offset:14336
ds_read_b128 a[60:63], v2 offset:15360
s_waitcnt lgkmcnt(0)
v_mfma_f32_16x16x32_bf16 v[192:195], a[32:35], v[72:75], v[192:195]
v_exp_f32 v28, v28
v_mfma_f32_16x16x32_bf16 v[224:227], a[32:35], v[76:79], v[224:227]
v_mfma_f32_16x16x32_bf16 v[228:231], a[36:39], v[76:79], v[228:231]
v_exp_f32 v29, v29
v_mfma_f32_16x16x32_bf16 v[196:199], a[36:39], v[72:75], v[196:199]
v_mfma_f32_16x16x32_bf16 v[200:203], a[40:43], v[72:75], v[200:203]
v_exp_f32 v30, v30
v_mfma_f32_16x16x32_bf16 v[232:235], a[40:43], v[76:79], v[232:235]
v_mfma_f32_16x16x32_bf16 v[236:239], a[44:47], v[76:79], v[236:239]
v_exp_f32 v31, v31
v_mfma_f32_16x16x32_bf16 v[204:207], a[44:47], v[72:75], v[204:207]
v_mfma_f32_16x16x32_bf16 v[208:211], a[48:51], v[72:75], v[208:211]
v_cvt_pk_bf16_f32 v60, v28, v29
v_cvt_pk_bf16_f32 v61, v30, v31
v_mfma_f32_16x16x32_bf16 v[240:243], a[48:51], v[76:79], v[240:243]
v_exp_f32 v44, v44
v_mfma_f32_16x16x32_bf16 v[244:247], a[52:55], v[76:79], v[244:247]
v_mfma_f32_16x16x32_bf16 v[212:215], a[52:55], v[72:75], v[212:215]
v_exp_f32 v45, v45
v_mfma_f32_16x16x32_bf16 v[216:219], a[56:59], v[72:75], v[216:219]
v_mfma_f32_16x16x32_bf16 v[248:251], a[56:59], v[76:79], v[248:251]
v_exp_f32 v46, v46
v_mfma_f32_16x16x32_bf16 v[252:255], a[60:63], v[76:79], v[252:255]
v_mfma_f32_16x16x32_bf16 v[220:223], a[60:63], v[72:75], v[220:223]
v_exp_f32 v47, v47
v_mfma_f32_16x16x32_bf16 a[232:235], a[240:243], v[72:75], a[232:235]
v_mfma_f32_16x16x32_bf16 a[236:239], a[240:243], v[76:79], a[236:239]
ds_read_b128 a[32:35], v2 offset:24576
ds_read_b128 a[36:39], v2 offset:25600
ds_read_b128 a[40:43], v2 offset:26624
ds_read_b128 a[44:47], v2 offset:27648
ds_read_b128 a[48:51], v2 offset:28672
ds_read_b128 a[52:55], v2 offset:29696
ds_read_b128 a[56:59], v2 offset:30720
ds_read_b128 a[60:63], v2 offset:31744
v_cvt_pk_bf16_f32 v62, v44, v45
v_cvt_pk_bf16_f32 v63, v46, v47
v_xor_b32 v2, 0x8000, v2
s_waitcnt vmcnt(0) lgkmcnt(0)
s_barrier
s_nop 7
v_mfma_f32_16x16x32_bf16 v[224:227], a[32:35], v[60:63], v[224:227]
v_mfma_f32_16x16x32_bf16 v[228:231], a[36:39], v[60:63], v[228:231]
v_mfma_f32_16x16x32_bf16 v[232:235], a[40:43], v[60:63], v[232:235]
v_mfma_f32_16x16x32_bf16 v[236:239], a[44:47], v[60:63], v[236:239]
v_mfma_f32_16x16x32_bf16 v[240:243], a[48:51], v[60:63], v[240:243]
v_mfma_f32_16x16x32_bf16 v[244:247], a[52:55], v[60:63], v[244:247]
v_mfma_f32_16x16x32_bf16 v[248:251], a[56:59], v[60:63], v[248:251]
v_mfma_f32_16x16x32_bf16 v[252:255], a[60:63], v[60:63], v[252:255]
v_mfma_f32_16x16x32_bf16 a[236:239], a[240:243], v[60:63], a[236:239]
s_waitcnt lgkmcnt(0)
s_nop 7
v_xor_b32 v1, 0x8000, v1
L_att_fin:
s_nop 7
v_accvgpr_read_b32 v4, a232
v_accvgpr_read_b32 v6, a236
s_mov_b32 s8, 0x5f800000
v_cmp_nge_f32 s[36:37], s8, v4
v_cmp_nge_f32 s[38:39], s8, v6
v_rcp_f32 v4, v4
v_rcp_f32 v6, v6
s_or_b64 s[34:35], s[34:35], s[36:37]
s_or_b64 s[34:35], s[34:35], s[38:39]
v_pk_mul_f32 v[192:193], v[192:193], v[4:5] op_sel_hi:[1,0]
v_pk_mul_f32 v[194:195], v[194:195], v[4:5] op_sel_hi:[1,0]
v_pk_mul_f32 v[196:197], v[196:197], v[4:5] op_sel_hi:[1,0]
v_pk_mul_f32 v[198:199], v[198:199], v[4:5] op_sel_hi:[1,0]
v_cvt_pk_bf16_f32 v192, v192, v193
v_cvt_pk_bf16_f32 v193, v194, v195
v_cvt_pk_bf16_f32 v194, v196, v197
v_cvt_pk_bf16_f32 v195, v198, v199
s_add_u32 s8, s30, 0x0
buffer_store_dwordx4 v[192:195], v3, s[88:91], s8 offen
v_pk_mul_f32 v[200:201], v[200:201], v[4:5] op_sel_hi:[1,0]
v_pk_mul_f32 v[202:203], v[202:203], v[4:5] op_sel_hi:[1,0]
v_pk_mul_f32 v[204:205], v[204:205], v[4:5] op_sel_hi:[1,0]
v_pk_mul_f32 v[206:207], v[206:207], v[4:5] op_sel_hi:[1,0]
v_cvt_pk_bf16_f32 v200, v200, v201
v_cvt_pk_bf16_f32 v201, v202, v203
v_cvt_pk_bf16_f32 v202, v204, v205
v_cvt_pk_bf16_f32 v203, v206, v207
s_add_u32 s8, s30, 0x2000
buffer_store_dwordx4 v[200:203], v3, s[88:91], s8 offen
v_pk_mul_f32 v[208:209], v[208:209], v[4:5] op_sel_hi:[1,0]
v_pk_mul_f32 v[210:211], v[210:211], v[4:5] op_sel_hi:[1,0]
v_pk_mul_f32 v[212:213], v[212:213], v[4:5] op_sel_hi:[1,0]
v_pk_mul_f32 v[214:215], v[214:215], v[4:5] op_sel_hi:[1,0]
v_cvt_pk_bf16_f32 v208, v208, v209
v_cvt_pk_bf16_f32 v209, v210, v211
v_cvt_pk_bf16_f32 v210, v212, v213
v_cvt_pk_bf16_f32 v211, v214, v215
s_add_u32 s8, s30, 0x4000
buffer_store_dwordx4 v[208:211], v3, s[88:91], s8 offen
v_pk_mul_f32 v[216:217], v[216:217], v[4:5] op_sel_hi:[1,0]
v_pk_mul_f32 v[218:219], v[218:219], v[4:5] op_sel_hi:[1,0]
v_pk_mul_f32 v[220:221], v[220:221], v[4:5] op_sel_hi:[1,0]
v_pk_mul_f32 v[222:223], v[222:223], v[4:5] op_sel_hi:[1,0]
v_cvt_pk_bf16_f32 v216, v216, v217
v_cvt_pk_bf16_f32 v217, v218, v219
v_cvt_pk_bf16_f32 v218, v220, v221
v_cvt_pk_bf16_f32 v219, v222, v223
s_add_u32 s8, s30, 0x6000
buffer_store_dwordx4 v[216:219], v3, s[88:91], s8 offen
v_pk_mul_f32 v[224:225], v[224:225], v[6:7] op_sel_hi:[1,0]
v_pk_mul_f32 v[226:227], v[226:227], v[6:7] op_sel_hi:[1,0]
v_pk_mul_f32 v[228:229], v[228:229], v[6:7] op_sel_hi:[1,0]
v_pk_mul_f32 v[230:231], v[230:231], v[6:7] op_sel_hi:[1,0]
v_cvt_pk_bf16_f32 v224, v224, v225
v_cvt_pk_bf16_f32 v225, v226, v227
v_cvt_pk_bf16_f32 v226, v228, v229
v_cvt_pk_bf16_f32 v227, v230, v231
s_add_u32 s8, s31, 0x0
buffer_store_dwordx4 v[224:227], v3, s[88:91], s8 offen
v_pk_mul_f32 v[232:233], v[232:233], v[6:7] op_sel_hi:[1,0]
v_pk_mul_f32 v[234:235], v[234:235], v[6:7] op_sel_hi:[1,0]
v_pk_mul_f32 v[236:237], v[236:237], v[6:7] op_sel_hi:[1,0]
v_pk_mul_f32 v[238:239], v[238:239], v[6:7] op_sel_hi:[1,0]
v_cvt_pk_bf16_f32 v232, v232, v233
v_cvt_pk_bf16_f32 v233, v234, v235
v_cvt_pk_bf16_f32 v234, v236, v237
v_cvt_pk_bf16_f32 v235, v238, v239
s_add_u32 s8, s31, 0x2000
buffer_store_dwordx4 v[232:235], v3, s[88:91], s8 offen
v_pk_mul_f32 v[240:241], v[240:241], v[6:7] op_sel_hi:[1,0]
v_pk_mul_f32 v[242:243], v[242:243], v[6:7] op_sel_hi:[1,0]
v_pk_mul_f32 v[244:245], v[244:245], v[6:7] op_sel_hi:[1,0]
v_pk_mul_f32 v[246:247], v[246:247], v[6:7] op_sel_hi:[1,0]
v_cvt_pk_bf16_f32 v240, v240, v241
v_cvt_pk_bf16_f32 v241, v242, v243
v_cvt_pk_bf16_f32 v242, v244, v245
v_cvt_pk_bf16_f32 v243, v246, v247
s_add_u32 s8, s31, 0x4000
buffer_store_dwordx4 v[240:243], v3, s[88:91], s8 offen
v_pk_mul_f32 v[248:249], v[248:249], v[6:7] op_sel_hi:[1,0]
v_pk_mul_f32 v[250:251], v[250:251], v[6:7] op_sel_hi:[1,0]
v_pk_mul_f32 v[252:253], v[252:253], v[6:7] op_sel_hi:[1,0]
v_pk_mul_f32 v[254:255], v[254:255], v[6:7] op_sel_hi:[1,0]
v_cvt_pk_bf16_f32 v248, v248, v249
v_cvt_pk_bf16_f32 v249, v250, v251
v_cvt_pk_bf16_f32 v250, v252, v253
v_cvt_pk_bf16_f32 v251, v254, v255
s_add_u32 s8, s31, 0x6000
buffer_store_dwordx4 v[248:251], v3, s[88:91], s8 offen
s_cmp_lg_u64 s[34:35], 0
s_cselect_b32 s8, 1, 0
s_lshl_b32 s9, s4, 2
s_add_u32 s9, s9, 131072
v_mov_b32 v4, s9
v_mov_b32 v5, s8
ds_write_b32 v4, v5
v_and_b32 v4, 3, v0
v_lshlrev_b32 v4, 2, v4
v_add_u32 v4, 131072, v4
s_waitcnt vmcnt(0) lgkmcnt(0)
s_barrier
ds_read_b32 v5, v4
s_waitcnt lgkmcnt(0)
v_cmp_ne_u32 vcc, 0, v5
s_cmp_lg_u32 s33, 0
s_cbranch_scc1 L_att_done
s_nop 4
s_cbranch_vccz L_att_done
s_mov_b32 s33, 1
s_mul_i32 s32, s5, 0x108000
s_lshl_b32 s18, s4, 13
s_add_u32 s32, s32, s18
s_add_u32 s11, s32, 0x1000
v_and_b32 v5, 15, v0
v_lshrrev_b32 v6, 4, v0
v_lshlrev_b32 v6, 2, v6
v_sub_u32 v5, v5, v6
v_mov_b32 v6, 0xf149f2ca
s_lshr_b32 s8, s20, 11
v_add_u32 v80, s8, v5
v_mov_b32 v8, v6
s_lshr_b32 s8, s21, 11
v_add_u32 v84, s8, v5
v_mov_b32 v9, v6
s_lshr_b32 s8, s22, 11
v_add_u32 v88, s8, v5
v_mov_b32 v10, v6
s_lshr_b32 s8, s23, 11
v_add_u32 v92, s8, v5
v_mov_b32 v11, v6
s_sub_u32 s15, 16, s6
s_lshl_b32 s15, s15, 1
L_fb_loop:
s_waitcnt lgkmcnt(0)
s_barrier
s_add_u32 m0, s18, 0x0
s_nop 0
buffer_load_dwordx4 v3, s[88:91], s32 offen offset:0 lds
buffer_load_dwordx4 v3, s[88:91], s32 offen offset:1024 lds
buffer_load_dwordx4 v3, s[88:91], s32 offen offset:2048 lds
buffer_load_dwordx4 v3, s[88:91], s32 offen offset:3072 lds
s_add_u32 m0, s18, 0x1000
s_nop 0
buffer_load_dwordx4 v3, s[88:91], s11 offen offset:0 lds
buffer_load_dwordx4 v3, s[88:91], s11 offen offset:1024 lds
buffer_load_dwordx4 v3, s[88:91], s11 offen offset:2048 lds
buffer_load_dwordx4 v3, s[88:91], s11 offen offset:3072 lds
s_add_u32 s32, s32, 0x8000
s_add_u32 s11, s11, 0x8000
s_waitcnt vmcnt(0)
s_barrier
ds_read_b128 a[0:3], v3 offset:0
ds_read_b128 a[4:7], v3 offset:1024
ds_read_b128 a[8:11], v3 offset:2048
ds_read_b128 a[12:15], v3 offset:3072
ds_read_b128 a[16:19], v3 offset:4096
ds_read_b128 a[20:23], v3 offset:5120
ds_read_b128 a[24:27], v3 offset:6144
ds_read_b128 a[28:31], v3 offset:7168
s_waitcnt lgkmcnt(0)
v_mfma_f32_16x16x32_bf16 v[16:19], a[0:3], a[160:163], 0
v_mfma_f32_16x16x32_bf16 v[16:19], a[4:7], a[164:167], v[16:19]
v_mfma_f32_16x16x32_bf16 v[16:19], a[8:11], a[168:171], v[16:19]
v_mfma_f32_16x16x32_bf16 v[16:19], a[12:15], a[172:175], v[16:19]
v_mfma_f32_16x16x32_bf16 v[20:23], a[0:3], a[176:179], 0
v_mfma_f32_16x16x32_bf16 v[20:23], a[4:7], a[180:183], v[20:23]
v_mfma_f32_16x16x32_bf16 v[20:23], a[8:11], a[184:187], v[20:23]
v_mfma_f32_16x16x32_bf16 v[20:23], a[12:15], a[188:191], v[20:23]
v_mfma_f32_16x16x32_bf16 v[24:27], a[0:3], a[192:195], 0
v_mfma_f32_16x16x32_bf16 v[24:27], a[4:7], a[196:199], v[24:27]
v_mfma_f32_16x16x32_bf16 v[24:27], a[8:11], a[200:203], v[24:27]
v_mfma_f32_16x16x32_bf16 v[24:27], a[12:15], a[204:207], v[24:27]
v_mfma_f32_16x16x32_bf16 v[28:31], a[0:3], a[208:211], 0
v_mfma_f32_16x16x32_bf16 v[28:31], a[4:7], a[212:215], v[28:31]
v_mfma_f32_16x16x32_bf16 v[28:31], a[8:11], a[216:219], v[28:31]
v_mfma_f32_16x16x32_bf16 v[28:31], a[12:15], a[220:223], v[28:31]
v_mfma_f32_16x16x32_bf16 v[32:35], a[16:19], a[160:163], 0
v_mfma_f32_16x16x32_bf16 v[32:35], a[20:23], a[164:167], v[32:35]
v_mfma_f32_16x16x32_bf16 v[32:35], a[24:27], a[168:171], v[32:35]
v_mfma_f32_16x16x32_bf16 v[32:35], a[28:31], a[172:175], v[32:35]
v_mfma_f32_16x16x32_bf16 v[36:39], a[16:19], a[176:179], 0
v_mfma_f32_16x16x32_bf16 v[36:39], a[20:23], a[180:183], v[36:39]
v_mfma_f32_16x16x32_bf16 v[36:39], a[24:27], a[184:187], v[36:39]
v_mfma_f32_16x16x32_bf16 v[36:39], a[28:31], a[188:191], v[36:39]
v_mfma_f32_16x16x32_bf16 v[40:43], a[16:19], a[192:195], 0
v_mfma_f32_16x16x32_bf16 v[40:43], a[20:23], a[196:199], v[40:43]
v_mfma_f32_16x16x32_bf16 v[40:43], a[24:27], a[200:203], v[40:43]
v_mfma_f32_16x16x32_bf16 v[40:43], a[28:31], a[204:207], v[40:43]
v_mfma_f32_16x16x32_bf16 v[44:47], a[16:19], a[208:211], 0
v_mfma_f32_16x16x32_bf16 v[44:47], a[20:23], a[212:215], v[44:47]
v_mfma_f32_16x16x32_bf16 v[44:47], a[24:27], a[216:219], v[44:47]
v_mfma_f32_16x16x32_bf16 v[44:47], a[28:31], a[220:223], v[44:47]
s_nop 7
v_cmp_le_i32 s[36:37], 0, v80
v_cmp_le_i32 s[38:39], 1, v80
v_cmp_le_i32 s[40:41], 2, v80
v_cmp_le_i32 s[42:43], 3, v80
s_nop 1
v_cndmask_b32 v16, v6, v16, s[36:37]
v_cndmask_b32 v17, v6, v17, s[38:39]
v_cndmask_b32 v18, v6, v18, s[40:41]
v_cndmask_b32 v19, v6, v19, s[42:43]
v_max3_f32 v8, v8, v16, v17
v_max3_f32 v8, v8, v18, v19
v_cmp_le_i32 s[36:37], 0, v84
v_cmp_le_i32 s[38:39], 1, v84
v_cmp_le_i32 s[40:41], 2, v84
v_cmp_le_i32 s[42:43], 3, v84
s_nop 1
v_cndmask_b32 v20, v6, v20, s[36:37]
v_cndmask_b32 v21, v6, v21, s[38:39]
v_cndmask_b32 v22, v6, v22, s[40:41]
v_cndmask_b32 v23, v6, v23, s[42:43]
v_max3_f32 v9, v9, v20, v21
v_max3_f32 v9, v9, v22, v23
v_cmp_le_i32 s[36:37], 0, v88
v_cmp_le_i32 s[38:39], 1, v88
v_cmp_le_i32 s[40:41], 2, v88
v_cmp_le_i32 s[42:43], 3, v88
s_nop 1
v_cndmask_b32 v24, v6, v24, s[36:37]
v_cndmask_b32 v25, v6, v25, s[38:39]
v_cndmask_b32 v26, v6, v26, s[40:41]
v_cndmask_b32 v27, v6, v27, s[42:43]
v_max3_f32 v10, v10, v24, v25
v_max3_f32 v10, v10, v26, v27
v_cmp_le_i32 s[36:37], 0, v92
v_cmp_le_i32 s[38:39], 1, v92
v_cmp_le_i32 s[40:41], 2, v92
v_cmp_le_i32 s[42:43], 3, v92
s_nop 1
v_cndmask_b32 v28, v6, v28, s[36:37]
v_cndmask_b32 v29, v6, v29, s[38:39]
v_cndmask_b32 v30, v6, v30, s[40:41]
v_cndmask_b32 v31, v6, v31, s[42:43]
v_max3_f32 v11, v11, v28, v29
v_max3_f32 v11, v11, v30, v31
v_cmp_le_i32 s[36:37], 16, v80
v_cmp_le_i32 s[38:39], 17, v80
v_cmp_le_i32 s[40:41], 18, v80
v_cmp_le_i32 s[42:43], 19, v80
s_nop 1
v_cndmask_b32 v32, v6, v32, s[36:37]
v_cndmask_b32 v33, v6, v33, s[38:39]
v_cndmask_b32 v34, v6, v34, s[40:41]
v_cndmask_b32 v35, v6, v35, s[42:43]
v_max3_f32 v8, v8, v32, v33
v_max3_f32 v8, v8, v34, v35
v_cmp_le_i32 s[36:37], 16, v84
v_cmp_le_i32 s[38:39], 17, v84
v_cmp_le_i32 s[40:41], 18, v84
v_cmp_le_i32 s[42:43], 19, v84
s_nop 1
v_cndmask_b32 v36, v6, v36, s[36:37]
v_cndmask_b32 v37, v6, v37, s[38:39]
v_cndmask_b32 v38, v6, v38, s[40:41]
v_cndmask_b32 v39, v6, v39, s[42:43]
v_max3_f32 v9, v9, v36, v37
v_max3_f32 v9, v9, v38, v39
v_cmp_le_i32 s[36:37], 16, v88
v_cmp_le_i32 s[38:39], 17, v88
v_cmp_le_i32 s[40:41], 18, v88
v_cmp_le_i32 s[42:43], 19, v88
s_nop 1
v_cndmask_b32 v40, v6, v40, s[36:37]
v_cndmask_b32 v41, v6, v41, s[38:39]
v_cndmask_b32 v42, v6, v42, s[40:41]
v_cndmask_b32 v43, v6, v43, s[42:43]
v_max3_f32 v10, v10, v40, v41
v_max3_f32 v10, v10, v42, v43
v_cmp_le_i32 s[36:37], 16, v92
v_cmp_le_i32 s[38:39], 17, v92
v_cmp_le_i32 s[40:41], 18, v92
v_cmp_le_i32 s[42:43], 19, v92
s_nop 1
v_cndmask_b32 v44, v6, v44, s[36:37]
v_cndmask_b32 v45, v6, v45, s[38:39]
v_cndmask_b32 v46, v6, v46, s[40:41]
v_cndmask_b32 v47, v6, v47, s[42:43]
v_max3_f32 v11, v11, v44, v45
v_max3_f32 v11, v11, v46, v47
ds_read_b128 a[0:3], v3 offset:16384
ds_read_b128 a[4:7], v3 offset:17408
ds_read_b128 a[8:11], v3 offset:18432
ds_read_b128 a[12:15], v3 offset:19456
ds_read_b128 a[16:19], v3 offset:20480
ds_read_b128 a[20:23], v3 offset:21504
ds_read_b128 a[24:27], v3 offset:22528
ds_read_b128 a[28:31], v3 offset:23552
s_waitcnt lgkmcnt(0)
v_mfma_f32_16x16x32_bf16 v[16:19], a[0:3], a[160:163], 0
v_mfma_f32_16x16x32_bf16 v[16:19], a[4:7], a[164:167], v[16:19]
v_mfma_f32_16x16x32_bf16 v[16:19], a[8:11], a[168:171], v[16:19]
v_mfma_f32_16x16x32_bf16 v[16:19], a[12:15], a[172:175], v[16:19]
v_mfma_f32_16x16x32_bf16 v[20:23], a[0:3], a[176:179], 0
v_mfma_f32_16x16x32_bf16 v[20:23], a[4:7], a[180:183], v[20:23]
v_mfma_f32_16x16x32_bf16 v[20:23], a[8:11], a[184:187], v[20:23]
v_mfma_f32_16x16x32_bf16 v[20:23], a[12:15], a[188:191], v[20:23]
v_mfma_f32_16x16x32_bf16 v[24:27], a[0:3], a[192:195], 0
v_mfma_f32_16x16x32_bf16 v[24:27], a[4:7], a[196:199], v[24:27]
v_mfma_f32_16x16x32_bf16 v[24:27], a[8:11], a[200:203], v[24:27]
v_mfma_f32_16x16x32_bf16 v[24:27], a[12:15], a[204:207], v[24:27]
v_mfma_f32_16x16x32_bf16 v[28:31], a[0:3], a[208:211], 0
v_mfma_f32_16x16x32_bf16 v[28:31], a[4:7], a[212:215], v[28:31]
v_mfma_f32_16x16x32_bf16 v[28:31], a[8:11], a[216:219], v[28:31]
v_mfma_f32_16x16x32_bf16 v[28:31], a[12:15], a[220:223], v[28:31]
v_mfma_f32_16x16x32_bf16 v[32:35], a[16:19], a[160:163], 0
v_mfma_f32_16x16x32_bf16 v[32:35], a[20:23], a[164:167], v[32:35]
v_mfma_f32_16x16x32_bf16 v[32:35], a[24:27], a[168:171], v[32:35]
v_mfma_f32_16x16x32_bf16 v[32:35], a[28:31], a[172:175], v[32:35]
v_mfma_f32_16x16x32_bf16 v[36:39], a[16:19], a[176:179], 0
v_mfma_f32_16x16x32_bf16 v[36:39], a[20:23], a[180:183], v[36:39]
v_mfma_f32_16x16x32_bf16 v[36:39], a[24:27], a[184:187], v[36:39]
v_mfma_f32_16x16x32_bf16 v[36:39], a[28:31], a[188:191], v[36:39]
v_mfma_f32_16x16x32_bf16 v[40:43], a[16:19], a[192:195], 0
v_mfma_f32_16x16x32_bf16 v[40:43], a[20:23], a[196:199], v[40:43]
v_mfma_f32_16x16x32_bf16 v[40:43], a[24:27], a[200:203], v[40:43]
v_mfma_f32_16x16x32_bf16 v[40:43], a[28:31], a[204:207], v[40:43]
v_mfma_f32_16x16x32_bf16 v[44:47], a[16:19], a[208:211], 0
v_mfma_f32_16x16x32_bf16 v[44:47], a[20:23], a[212:215], v[44:47]
v_mfma_f32_16x16x32_bf16 v[44:47], a[24:27], a[216:219], v[44:47]
v_mfma_f32_16x16x32_bf16 v[44:47], a[28:31], a[220:223], v[44:47]
s_nop 7
v_cmp_le_i32 s[36:37], 32, v80
v_cmp_le_i32 s[38:39], 33, v80
v_cmp_le_i32 s[40:41], 34, v80
v_cmp_le_i32 s[42:43], 35, v80
s_nop 1
v_cndmask_b32 v16, v6, v16, s[36:37]
v_cndmask_b32 v17, v6, v17, s[38:39]
v_cndmask_b32 v18, v6, v18, s[40:41]
v_cndmask_b32 v19, v6, v19, s[42:43]
v_max3_f32 v8, v8, v16, v17
v_max3_f32 v8, v8, v18, v19
v_cmp_le_i32 s[36:37], 32, v84
v_cmp_le_i32 s[38:39], 33, v84
v_cmp_le_i32 s[40:41], 34, v84
v_cmp_le_i32 s[42:43], 35, v84
s_nop 1
v_cndmask_b32 v20, v6, v20, s[36:37]
v_cndmask_b32 v21, v6, v21, s[38:39]
v_cndmask_b32 v22, v6, v22, s[40:41]
v_cndmask_b32 v23, v6, v23, s[42:43]
v_max3_f32 v9, v9, v20, v21
v_max3_f32 v9, v9, v22, v23
v_cmp_le_i32 s[36:37], 32, v88
v_cmp_le_i32 s[38:39], 33, v88
v_cmp_le_i32 s[40:41], 34, v88
v_cmp_le_i32 s[42:43], 35, v88
s_nop 1
v_cndmask_b32 v24, v6, v24, s[36:37]
v_cndmask_b32 v25, v6, v25, s[38:39]
v_cndmask_b32 v26, v6, v26, s[40:41]
v_cndmask_b32 v27, v6, v27, s[42:43]
v_max3_f32 v10, v10, v24, v25
v_max3_f32 v10, v10, v26, v27
v_cmp_le_i32 s[36:37], 32, v92
v_cmp_le_i32 s[38:39], 33, v92
v_cmp_le_i32 s[40:41], 34, v92
v_cmp_le_i32 s[42:43], 35, v92
s_nop 1
v_cndmask_b32 v28, v6, v28, s[36:37]
v_cndmask_b32 v29, v6, v29, s[38:39]
v_cndmask_b32 v30, v6, v30, s[40:41]
v_cndmask_b32 v31, v6, v31, s[42:43]
v_max3_f32 v11, v11, v28, v29
v_max3_f32 v11, v11, v30, v31
v_cmp_le_i32 s[36:37], 48, v80
v_cmp_le_i32 s[38:39], 49, v80
v_cmp_le_i32 s[40:41], 50, v80
v_cmp_le_i32 s[42:43], 51, v80
s_nop 1
v_cndmask_b32 v32, v6, v32, s[36:37]
v_cndmask_b32 v33, v6, v33, s[38:39]
v_cndmask_b32 v34, v6, v34, s[40:41]
v_cndmask_b32 v35, v6, v35, s[42:43]
v_max3_f32 v8, v8, v32, v33
v_max3_f32 v8, v8, v34, v35
v_cmp_le_i32 s[36:37], 48, v84
v_cmp_le_i32 s[38:39], 49, v84
v_cmp_le_i32 s[40:41], 50, v84
v_cmp_le_i32 s[42:43], 51, v84
s_nop 1
v_cndmask_b32 v36, v6, v36, s[36:37]
v_cndmask_b32 v37, v6, v37, s[38:39]
v_cndmask_b32 v38, v6, v38, s[40:41]
v_cndmask_b32 v39, v6, v39, s[42:43]
v_max3_f32 v9, v9, v36, v37
v_max3_f32 v9, v9, v38, v39
v_cmp_le_i32 s[36:37], 48, v88
v_cmp_le_i32 s[38:39], 49, v88
v_cmp_le_i32 s[40:41], 50, v88
v_cmp_le_i32 s[42:43], 51, v88
s_nop 1
v_cndmask_b32 v40, v6, v40, s[36:37]
v_cndmask_b32 v41, v6, v41, s[38:39]
v_cndmask_b32 v42, v6, v42, s[40:41]
v_cndmask_b32 v43, v6, v43, s[42:43]
v_max3_f32 v10, v10, v40, v41
v_max3_f32 v10, v10, v42, v43
v_cmp_le_i32 s[36:37], 48, v92
v_cmp_le_i32 s[38:39], 49, v92
v_cmp_le_i32 s[40:41], 50, v92
v_cmp_le_i32 s[42:43], 51, v92
s_nop 1
v_cndmask_b32 v44, v6, v44, s[36:37]
v_cndmask_b32 v45, v6, v45, s[38:39]
v_cndmask_b32 v46, v6, v46, s[40:41]
v_cndmask_b32 v47, v6, v47, s[42:43]
v_max3_f32 v11, v11, v44, v45
v_max3_f32 v11, v11, v46, v47
v_subrev_u32 v80, 64, v80
v_subrev_u32 v84, 64, v84
v_subrev_u32 v88, 64, v88
v_subrev_u32 v92, 64, v92
s_sub_u32 s15, s15, 1
s_cmp_lg_u32 s15, 0
s_cbranch_scc1 L_fb_loop
v_mov_b32 v12, v8
v_mov_b32 v13, v9
v_mov_b32 v14, v10
v_mov_b32 v15, v11
s_nop 1
v_permlane16_swap_b32 v12, v8
v_permlane16_swap_b32 v13, v9
v_permlane16_swap_b32 v14, v10
v_permlane16_swap_b32 v15, v11
v_max_f32 v8, v8, v12
v_max_f32 v9, v9, v13
v_max_f32 v10, v10, v14
v_max_f32 v11, v11, v15
v_mov_b32 v12, v8
v_mov_b32 v13, v9
v_mov_b32 v14, v10
v_mov_b32 v15, v11
s_nop 1
v_permlane32_swap_b32 v12, v8
v_permlane32_swap_b32 v13, v9
v_permlane32_swap_b32 v14, v10
v_permlane32_swap_b32 v15, v11
v_max_f32 v8, v8, v12
v_max_f32 v9, v9, v13
v_max_f32 v10, v10, v14
v_max_f32 v11, v11, v15
s_barrier
s_branch L_att_start
L_att_done:
L_k2_end:
s_endpgm
.globl out_kernel
.p2align 8
.type out_kernel,@function
out_kernel:
s_cmp_ge_u32 s2, 256
s_cbranch_scc1 L_k3_end
s_load_dwordx2 s[64:65], s[0:1], 40
s_load_dwordx2 s[72:73], s[0:1], 64
s_load_dwordx2 s[80:81], s[0:1], 80
s_load_dwordx2 s[88:89], s[0:1], 96
v_lshrrev_b32 v1, 6, v0
v_and_b32 v0, 63, v0
v_readfirstlane_b32 s4, v1
s_mov_b32 s66, 0x800000
s_mov_b32 s67, 0x20000
s_mov_b32 s74, 0x200000
s_mov_b32 s75, 0x20000
s_mov_b32 s82, 0x400000
s_mov_b32 s83, 0x20000
s_mov_b32 s90, 0x10000000
s_mov_b32 s91, 0x20000
s_and_b32 s5, s2, 7
s_lshl_b32 s5, s5, 2
s_bfe_u32 s3, s2, 0x20003
s_add_u32 s5, s5, s3
s_lshr_b32 s6, s2, 5
s_mov_b32 s12, 0x4000
s_mov_b32 s13, 0x8000
s_mov_b32 s14, 0xc000
s_mov_b32 s25, 0x800
s_mov_b32 s26, 0x1000
s_waitcnt lgkmcnt(0)
s_and_b32 s8, s2, 7
s_lshr_b32 s9, s2, 3
s_lshr_b32 s20, s8, 1
s_lshl_b32 s20, s20, 2
s_lshr_b32 s10, s9, 3
s_add_u32 s20, s20, s10
s_and_b32 s21, s8, 1
s_lshl_b32 s21, s21, 3
s_and_b32 s10, s9, 7
s_add_u32 s21, s21, s10
s_mov_b32 s28, 15360
s_mov_b32 s29, 30720
s_mov_b32 s30, 46080
s_lshl_b32 s17, s4, 12
v_lshrrev_b32 v17, 4, v0
v_bfe_u32 v18, v0, 1, 2
v_xor_b32 v17, v17, v18
v_lshlrev_b32 v17, 5, v17
v_and_b32 v18, 1, v0
v_lshl_add_u32 v17, v18, 4, v17
v_lshrrev_b32 v18, 3, v0
v_lshl_add_u32 v17, v18, 11, v17
s_lshl_b32 s8, s4, 16
s_lshl_b32 s9, s21, 7
s_add_u32 s8, s8, s9
v_add_u32 v2, s8, v17
s_mul_i32 s32, s20, 0x140000
s_add_u32 s32, s32, 0x2200000
s_lshl_b32 s8, s4, 11
v_lshl_add_u32 v3, v0, 4, s8
s_add_u32 m0, s17, 0x0
s_nop 0
buffer_load_dwordx4 v2, s[72:75], 0 offen lds
buffer_load_dwordx4 v2, s[72:75], s28 offen offset:1024 lds
buffer_load_dwordx4 v2, s[72:75], s29 offen offset:2048 lds
buffer_load_dwordx4 v2, s[72:75], s30 offen offset:3072 lds
v_add_u32 v2, 0x40000, v2
s_nop 0
buffer_load_dwordx4 v[128:131], v3, s[88:91], s32 offen
buffer_load_dwordx4 v[132:135], v3, s[88:91], s32 offen offset:1024
s_add_u32 s32, s32, 0x2000
s_nop 0
buffer_load_dwordx4 v[136:139], v3, s[88:91], s32 offen
buffer_load_dwordx4 v[140:143], v3, s[88:91], s32 offen offset:1024
s_add_u32 s32, s32, 0x2000
s_nop 0
buffer_load_dwordx4 v[144:147], v3, s[88:91], s32 offen
buffer_load_dwordx4 v[148:151], v3, s[88:91], s32 offen offset:1024
s_add_u32 s32, s32, 0x2000
s_nop 0
buffer_load_dwordx4 v[152:155], v3, s[88:91], s32 offen
buffer_load_dwordx4 v[156:159], v3, s[88:91], s32 offen offset:1024
s_add_u32 s32, s32, 0x2000
s_add_u32 m0, s17, 0x4000
s_nop 0
buffer_load_dwordx4 v2, s[72:75], 0 offen lds
buffer_load_dwordx4 v2, s[72:75], s28 offen offset:1024 lds
buffer_load_dwordx4 v2, s[72:75], s29 offen offset:2048 lds
buffer_load_dwordx4 v2, s[72:75], s30 offen offset:3072 lds
v_add_u32 v2, 0x40000, v2
s_nop 0
buffer_load_dwordx4 v[160:163], v3, s[88:91], s32 offen
buffer_load_dwordx4 v[164:167], v3, s[88:91], s32 offen offset:1024
s_add_u32 s32, s32, 0x2000
s_nop 0
buffer_load_dwordx4 v[168:171], v3, s[88:91], s32 offen
buffer_load_dwordx4 v[172:175], v3, s[88:91], s32 offen offset:1024
s_add_u32 s32, s32, 0x2000
s_nop 0
buffer_load_dwordx4 v[176:179], v3, s[88:91], s32 offen
buffer_load_dwordx4 v[180:183], v3, s[88:91], s32 offen offset:1024
s_add_u32 s32, s32, 0x2000
s_nop 0
buffer_load_dwordx4 v[184:187], v3, s[88:91], s32 offen
buffer_load_dwordx4 v[188:191], v3, s[88:91], s32 offen offset:1024
s_add_u32 s32, s32, 0x2000
s_add_u32 m0, s17, 0x8000
s_nop 0
buffer_load_dwordx4 v2, s[72:75], 0 offen lds
buffer_load_dwordx4 v2, s[72:75], s28 offen offset:1024 lds
buffer_load_dwordx4 v2, s[72:75], s29 offen offset:2048 lds
buffer_load_dwordx4 v2, s[72:75], s30 offen offset:3072 lds
v_add_u32 v2, 0x40000, v2
s_nop 0
buffer_load_dwordx4 v[192:195], v3, s[88:91], s32 offen
buffer_load_dwordx4 v[196:199], v3, s[88:91], s32 offen offset:1024
s_add_u32 s32, s32, 0x2000
s_nop 0
buffer_load_dwordx4 v[200:203], v3, s[88:91], s32 offen
buffer_load_dwordx4 v[204:207], v3, s[88:91], s32 offen offset:1024
s_add_u32 s32, s32, 0x2000
s_nop 0
buffer_load_dwordx4 v[208:211], v3, s[88:91], s32 offen
buffer_load_dwordx4 v[212:215], v3, s[88:91], s32 offen offset:1024
s_add_u32 s32, s32, 0x2000
s_nop 0
buffer_load_dwordx4 v[216:219], v3, s[88:91], s32 offen
buffer_load_dwordx4 v[220:223], v3, s[88:91], s32 offen offset:1024
s_add_u32 s32, s32, 0x2000
v_lshrrev_b32 v17, 2, v0
v_bfe_u32 v18, v0, 3, 2
v_lshlrev_b32 v18, 5, v18
v_lshl_add_u32 v17, v17, 7, v18
v_and_b32 v18, 3, v0
v_lshl_add_u32 v4, v18, 3, v17
v_xor_b32 v5, 32, v4
v_xor_b32 v6, 64, v4
v_xor_b32 v7, 0x60, v4
s_waitcnt vmcnt(24) lgkmcnt(0)
s_barrier
ds_read_b64_tr_b16 v[88:89], v4 offset:0
ds_read_b64_tr_b16 v[90:91], v4 offset:2048
ds_read_b64_tr_b16 v[92:93], v5 offset:0
ds_read_b64_tr_b16 v[94:95], v5 offset:2048
ds_read_b64_tr_b16 v[96:97], v6 offset:0
ds_read_b64_tr_b16 v[98:99], v6 offset:2048
ds_read_b64_tr_b16 v[100:101], v7 offset:0
ds_read_b64_tr_b16 v[102:103], v7 offset:2048
s_add_u32 m0, s17, 0xc000
s_nop 0
buffer_load_dwordx4 v2, s[72:75], 0 offen lds
s_nop 0
buffer_load_dwordx4 v2, s[72:75], s28 offen offset:1024 lds
s_nop 0
buffer_load_dwordx4 v2, s[72:75], s29 offen offset:2048 lds
s_waitcnt lgkmcnt(0)
v_mfma_f32_16x16x32_bf16 v[24:27], v[88:91], v[128:131], 0
ds_read_b64_tr_b16 v[104:105], v4 offset:4096
ds_read_b64_tr_b16 v[106:107], v4 offset:6144
v_mfma_f32_16x16x32_bf16 v[40:43], v[88:91], v[132:135], 0
ds_read_b64_tr_b16 v[108:109], v5 offset:4096
ds_read_b64_tr_b16 v[110:111], v5 offset:6144
v_mfma_f32_16x16x32_bf16 v[44:47], v[92:95], v[132:135], 0
ds_read_b64_tr_b16 v[112:113], v6 offset:4096
ds_read_b64_tr_b16 v[114:115], v6 offset:6144
v_mfma_f32_16x16x32_bf16 v[28:31], v[92:95], v[128:131], 0
ds_read_b64_tr_b16 v[116:117], v7 offset:4096
ds_read_b64_tr_b16 v[118:119], v7 offset:6144
v_mfma_f32_16x16x32_bf16 v[32:35], v[96:99], v[128:131], 0
buffer_load_dwordx4 v2, s[72:75], s30 offen offset:3072 lds
v_add_u32 v2, 0x40000, v2
v_mfma_f32_16x16x32_bf16 v[48:51], v[96:99], v[132:135], 0
buffer_load_dwordx4 v[224:227], v3, s[88:91], s32 offen
v_mfma_f32_16x16x32_bf16 v[52:55], v[100:103], v[132:135], 0
buffer_load_dwordx4 v[228:231], v3, s[88:91], s32 offen offset:1024
v_mfma_f32_16x16x32_bf16 v[36:39], v[100:103], v[128:131], 0
s_waitcnt lgkmcnt(0)
v_mfma_f32_16x16x32_bf16 v[24:27], v[104:107], v[136:139], v[24:27]
ds_read_b64_tr_b16 v[88:89], v4 offset:8192
ds_read_b64_tr_b16 v[90:91], v4 offset:10240
v_mfma_f32_16x16x32_bf16 v[40:43], v[104:107], v[140:143], v[40:43]
ds_read_b64_tr_b16 v[92:93], v5 offset:8192
ds_read_b64_tr_b16 v[94:95], v5 offset:10240
v_mfma_f32_16x16x32_bf16 v[44:47], v[108:111], v[140:143], v[44:47]
ds_read_b64_tr_b16 v[96:97], v6 offset:8192
ds_read_b64_tr_b16 v[98:99], v6 offset:10240
v_mfma_f32_16x16x32_bf16 v[28:31], v[108:111], v[136:139], v[28:31]
ds_read_b64_tr_b16 v[100:101], v7 offset:8192
ds_read_b64_tr_b16 v[102:103], v7 offset:10240
s_add_u32 s32, s32, 0x2000
v_mfma_f32_16x16x32_bf16 v[32:35], v[112:115], v[136:139], v[32:35]
buffer_load_dwordx4 v[232:235], v3, s[88:91], s32 offen
v_mfma_f32_16x16x32_bf16 v[48:51], v[112:115], v[140:143], v[48:51]
buffer_load_dwordx4 v[236:239], v3, s[88:91], s32 offen offset:1024
s_add_u32 s32, s32, 0x2000
v_mfma_f32_16x16x32_bf16 v[52:55], v[116:119], v[140:143], v[52:55]
buffer_load_dwordx4 v[240:243], v3, s[88:91], s32 offen
v_mfma_f32_16x16x32_bf16 v[36:39], v[116:119], v[136:139], v[36:39]
s_waitcnt lgkmcnt(0)
v_mfma_f32_16x16x32_bf16 v[24:27], v[88:91], v[144:147], v[24:27]
ds_read_b64_tr_b16 v[104:105], v4 offset:12288
ds_read_b64_tr_b16 v[106:107], v4 offset:14336
v_mfma_f32_16x16x32_bf16 v[40:43], v[88:91], v[148:151], v[40:43]
ds_read_b64_tr_b16 v[108:109], v5 offset:12288
ds_read_b64_tr_b16 v[110:111], v5 offset:14336
v_mfma_f32_16x16x32_bf16 v[44:47], v[92:95], v[148:151], v[44:47]
ds_read_b64_tr_b16 v[112:113], v6 offset:12288
ds_read_b64_tr_b16 v[114:115], v6 offset:14336
v_mfma_f32_16x16x32_bf16 v[28:31], v[92:95], v[144:147], v[28:31]
ds_read_b64_tr_b16 v[116:117], v7 offset:12288
ds_read_b64_tr_b16 v[118:119], v7 offset:14336
v_mfma_f32_16x16x32_bf16 v[32:35], v[96:99], v[144:147], v[32:35]
buffer_load_dwordx4 v[244:247], v3, s[88:91], s32 offen offset:1024
s_add_u32 s32, s32, 0x2000
v_mfma_f32_16x16x32_bf16 v[48:51], v[96:99], v[148:151], v[48:51]
buffer_load_dwordx4 v[248:251], v3, s[88:91], s32 offen
v_mfma_f32_16x16x32_bf16 v[52:55], v[100:103], v[148:151], v[52:55]
buffer_load_dwordx4 v[252:255], v3, s[88:91], s32 offen offset:1024
v_mfma_f32_16x16x32_bf16 v[36:39], v[100:103], v[144:147], v[36:39]
s_add_u32 s32, s32, 0x2000
s_waitcnt vmcnt(24) lgkmcnt(0)
s_barrier
v_mfma_f32_16x16x32_bf16 v[24:27], v[104:107], v[152:155], v[24:27]
ds_read_b64_tr_b16 v[88:89], v4 offset:16384
ds_read_b64_tr_b16 v[90:91], v4 offset:18432
v_mfma_f32_16x16x32_bf16 v[40:43], v[104:107], v[156:159], v[40:43]
ds_read_b64_tr_b16 v[92:93], v5 offset:16384
ds_read_b64_tr_b16 v[94:95], v5 offset:18432
v_mfma_f32_16x16x32_bf16 v[44:47], v[108:111], v[156:159], v[44:47]
ds_read_b64_tr_b16 v[96:97], v6 offset:16384
ds_read_b64_tr_b16 v[98:99], v6 offset:18432
v_mfma_f32_16x16x32_bf16 v[28:31], v[108:111], v[152:155], v[28:31]
ds_read_b64_tr_b16 v[100:101], v7 offset:16384
ds_read_b64_tr_b16 v[102:103], v7 offset:18432
s_add_u32 m0, s17, 0x0
v_mfma_f32_16x16x32_bf16 v[32:35], v[112:115], v[152:155], v[32:35]
buffer_load_dwordx4 v2, s[72:75], 0 offen lds
v_mfma_f32_16x16x32_bf16 v[48:51], v[112:115], v[156:159], v[48:51]
buffer_load_dwordx4 v2, s[72:75], s28 offen offset:1024 lds
v_mfma_f32_16x16x32_bf16 v[52:55], v[116:119], v[156:159], v[52:55]
buffer_load_dwordx4 v2, s[72:75], s29 offen offset:2048 lds
v_mfma_f32_16x16x32_bf16 v[36:39], v[116:119], v[152:155], v[36:39]
s_waitcnt lgkmcnt(0)
v_mfma_f32_16x16x32_bf16 v[24:27], v[88:91], v[160:163], v[24:27]
ds_read_b64_tr_b16 v[104:105], v4 offset:20480
ds_read_b64_tr_b16 v[106:107], v4 offset:22528
v_mfma_f32_16x16x32_bf16 v[40:43], v[88:91], v[164:167], v[40:43]
ds_read_b64_tr_b16 v[108:109], v5 offset:20480
ds_read_b64_tr_b16 v[110:111], v5 offset:22528
v_mfma_f32_16x16x32_bf16 v[44:47], v[92:95], v[164:167], v[44:47]
ds_read_b64_tr_b16 v[112:113], v6 offset:20480
ds_read_b64_tr_b16 v[114:115], v6 offset:22528
v_mfma_f32_16x16x32_bf16 v[28:31], v[92:95], v[160:163], v[28:31]
ds_read_b64_tr_b16 v[116:117], v7 offset:20480
ds_read_b64_tr_b16 v[118:119], v7 offset:22528
v_mfma_f32_16x16x32_bf16 v[32:35], v[96:99], v[160:163], v[32:35]
buffer_load_dwordx4 v2, s[72:75], s30 offen offset:3072 lds
v_add_u32 v2, 0x40000, v2
v_mfma_f32_16x16x32_bf16 v[48:51], v[96:99], v[164:167], v[48:51]
buffer_load_dwordx4 v[128:131], v3, s[88:91], s32 offen
v_mfma_f32_16x16x32_bf16 v[52:55], v[100:103], v[164:167], v[52:55]
buffer_load_dwordx4 v[132:135], v3, s[88:91], s32 offen offset:1024
v_mfma_f32_16x16x32_bf16 v[36:39], v[100:103], v[160:163], v[36:39]
s_waitcnt lgkmcnt(0)
v_mfma_f32_16x16x32_bf16 v[24:27], v[104:107], v[168:171], v[24:27]
ds_read_b64_tr_b16 v[88:89], v4 offset:24576
ds_read_b64_tr_b16 v[90:91], v4 offset:26624
v_mfma_f32_16x16x32_bf16 v[40:43], v[104:107], v[172:175], v[40:43]
ds_read_b64_tr_b16 v[92:93], v5 offset:24576
ds_read_b64_tr_b16 v[94:95], v5 offset:26624
v_mfma_f32_16x16x32_bf16 v[44:47], v[108:111], v[172:175], v[44:47]
ds_read_b64_tr_b16 v[96:97], v6 offset:24576
ds_read_b64_tr_b16 v[98:99], v6 offset:26624
v_mfma_f32_16x16x32_bf16 v[28:31], v[108:111], v[168:171], v[28:31]
ds_read_b64_tr_b16 v[100:101], v7 offset:24576
ds_read_b64_tr_b16 v[102:103], v7 offset:26624
s_add_u32 s32, s32, 0x2000
v_mfma_f32_16x16x32_bf16 v[32:35], v[112:115], v[168:171], v[32:35]
buffer_load_dwordx4 v[136:139], v3, s[88:91], s32 offen
v_mfma_f32_16x16x32_bf16 v[48:51], v[112:115], v[172:175], v[48:51]
buffer_load_dwordx4 v[140:143], v3, s[88:91], s32 offen offset:1024
s_add_u32 s32, s32, 0x2000
v_mfma_f32_16x16x32_bf16 v[52:55], v[116:119], v[172:175], v[52:55]
buffer_load_dwordx4 v[144:147], v3, s[88:91], s32 offen
v_mfma_f32_16x16x32_bf16 v[36:39], v[116:119], v[168:171], v[36:39]
s_waitcnt lgkmcnt(0)
v_mfma_f32_16x16x32_bf16 v[24:27], v[88:91], v[176:179], v[24:27]
ds_read_b64_tr_b16 v[104:105], v4 offset:28672
ds_read_b64_tr_b16 v[106:107], v4 offset:30720
v_mfma_f32_16x16x32_bf16 v[40:43], v[88:91], v[180:183], v[40:43]
ds_read_b64_tr_b16 v[108:109], v5 offset:28672
ds_read_b64_tr_b16 v[110:111], v5 offset:30720
v_mfma_f32_16x16x32_bf16 v[44:47], v[92:95], v[180:183], v[44:47]
ds_read_b64_tr_b16 v[112:113], v6 offset:28672
ds_read_b64_tr_b16 v[114:115], v6 offset:30720
v_mfma_f32_16x16x32_bf16 v[28:31], v[92:95], v[176:179], v[28:31]
ds_read_b64_tr_b16 v[116:117], v7 offset:28672
ds_read_b64_tr_b16 v[118:119], v7 offset:30720
v_mfma_f32_16x16x32_bf16 v[32:35], v[96:99], v[176:179], v[32:35]
buffer_load_dwordx4 v[148:151], v3, s[88:91], s32 offen offset:1024
s_add_u32 s32, s32, 0x2000
v_mfma_f32_16x16x32_bf16 v[48:51], v[96:99], v[180:183], v[48:51]
buffer_load_dwordx4 v[152:155], v3, s[88:91], s32 offen
v_mfma_f32_16x16x32_bf16 v[52:55], v[100:103], v[180:183], v[52:55]
buffer_load_dwordx4 v[156:159], v3, s[88:91], s32 offen offset:1024
v_mfma_f32_16x16x32_bf16 v[36:39], v[100:103], v[176:179], v[36:39]
s_add_u32 s32, s32, 0x2000
s_waitcnt vmcnt(24) lgkmcnt(0)
s_barrier
v_mfma_f32_16x16x32_bf16 v[24:27], v[104:107], v[184:187], v[24:27]
ds_read_b64_tr_b16 v[88:89], v4 offset:32768
ds_read_b64_tr_b16 v[90:91], v4 offset:34816
v_mfma_f32_16x16x32_bf16 v[40:43], v[104:107], v[188:191], v[40:43]
ds_read_b64_tr_b16 v[92:93], v5 offset:32768
ds_read_b64_tr_b16 v[94:95], v5 offset:34816
v_mfma_f32_16x16x32_bf16 v[44:47], v[108:111], v[188:191], v[44:47]
ds_read_b64_tr_b16 v[96:97], v6 offset:32768
ds_read_b64_tr_b16 v[98:99], v6 offset:34816
v_mfma_f32_16x16x32_bf16 v[28:31], v[108:111], v[184:187], v[28:31]
ds_read_b64_tr_b16 v[100:101], v7 offset:32768
ds_read_b64_tr_b16 v[102:103], v7 offset:34816
s_add_u32 m0, s17, 0x4000
v_mfma_f32_16x16x32_bf16 v[32:35], v[112:115], v[184:187], v[32:35]
buffer_load_dwordx4 v2, s[72:75], 0 offen lds
v_mfma_f32_16x16x32_bf16 v[48:51], v[112:115], v[188:191], v[48:51]
buffer_load_dwordx4 v2, s[72:75], s28 offen offset:1024 lds
v_mfma_f32_16x16x32_bf16 v[52:55], v[116:119], v[188:191], v[52:55]
buffer_load_dwordx4 v2, s[72:75], s29 offen offset:2048 lds
v_mfma_f32_16x16x32_bf16 v[36:39], v[116:119], v[184:187], v[36:39]
s_waitcnt lgkmcnt(0)
v_mfma_f32_16x16x32_bf16 v[24:27], v[88:91], v[192:195], v[24:27]
ds_read_b64_tr_b16 v[104:105], v4 offset:36864
ds_read_b64_tr_b16 v[106:107], v4 offset:38912
v_mfma_f32_16x16x32_bf16 v[40:43], v[88:91], v[196:199], v[40:43]
ds_read_b64_tr_b16 v[108:109], v5 offset:36864
ds_read_b64_tr_b16 v[110:111], v5 offset:38912
v_mfma_f32_16x16x32_bf16 v[44:47], v[92:95], v[196:199], v[44:47]
ds_read_b64_tr_b16 v[112:113], v6 offset:36864
ds_read_b64_tr_b16 v[114:115], v6 offset:38912
v_mfma_f32_16x16x32_bf16 v[28:31], v[92:95], v[192:195], v[28:31]
ds_read_b64_tr_b16 v[116:117], v7 offset:36864
ds_read_b64_tr_b16 v[118:119], v7 offset:38912
v_mfma_f32_16x16x32_bf16 v[32:35], v[96:99], v[192:195], v[32:35]
buffer_load_dwordx4 v2, s[72:75], s30 offen offset:3072 lds
v_add_u32 v2, 0x40000, v2
v_mfma_f32_16x16x32_bf16 v[48:51], v[96:99], v[196:199], v[48:51]
buffer_load_dwordx4 v[160:163], v3, s[88:91], s32 offen
v_mfma_f32_16x16x32_bf16 v[52:55], v[100:103], v[196:199], v[52:55]
buffer_load_dwordx4 v[164:167], v3, s[88:91], s32 offen offset:1024
v_mfma_f32_16x16x32_bf16 v[36:39], v[100:103], v[192:195], v[36:39]
s_waitcnt lgkmcnt(0)
v_mfma_f32_16x16x32_bf16 v[24:27], v[104:107], v[200:203], v[24:27]
ds_read_b64_tr_b16 v[88:89], v4 offset:40960
ds_read_b64_tr_b16 v[90:91], v4 offset:43008
v_mfma_f32_16x16x32_bf16 v[40:43], v[104:107], v[204:207], v[40:43]
ds_read_b64_tr_b16 v[92:93], v5 offset:40960
ds_read_b64_tr_b16 v[94:95], v5 offset:43008
v_mfma_f32_16x16x32_bf16 v[44:47], v[108:111], v[204:207], v[44:47]
ds_read_b64_tr_b16 v[96:97], v6 offset:40960
ds_read_b64_tr_b16 v[98:99], v6 offset:43008
v_mfma_f32_16x16x32_bf16 v[28:31], v[108:111], v[200:203], v[28:31]
ds_read_b64_tr_b16 v[100:101], v7 offset:40960
ds_read_b64_tr_b16 v[102:103], v7 offset:43008
s_add_u32 s32, s32, 0x2000
v_mfma_f32_16x16x32_bf16 v[32:35], v[112:115], v[200:203], v[32:35]
buffer_load_dwordx4 v[168:171], v3, s[88:91], s32 offen
v_mfma_f32_16x16x32_bf16 v[48:51], v[112:115], v[204:207], v[48:51]
buffer_load_dwordx4 v[172:175], v3, s[88:91], s32 offen offset:1024
s_add_u32 s32, s32, 0x2000
v_mfma_f32_16x16x32_bf16 v[52:55], v[116:119], v[204:207], v[52:55]
buffer_load_dwordx4 v[176:179], v3, s[88:91], s32 offen
v_mfma_f32_16x16x32_bf16 v[36:39], v[116:119], v[200:203], v[36:39]
s_waitcnt lgkmcnt(0)
v_mfma_f32_16x16x32_bf16 v[24:27], v[88:91], v[208:211], v[24:27]
ds_read_b64_tr_b16 v[104:105], v4 offset:45056
ds_read_b64_tr_b16 v[106:107], v4 offset:47104
v_mfma_f32_16x16x32_bf16 v[40:43], v[88:91], v[212:215], v[40:43]
ds_read_b64_tr_b16 v[108:109], v5 offset:45056
ds_read_b64_tr_b16 v[110:111], v5 offset:47104
v_mfma_f32_16x16x32_bf16 v[44:47], v[92:95], v[212:215], v[44:47]
ds_read_b64_tr_b16 v[112:113], v6 offset:45056
ds_read_b64_tr_b16 v[114:115], v6 offset:47104
v_mfma_f32_16x16x32_bf16 v[28:31], v[92:95], v[208:211], v[28:31]
ds_read_b64_tr_b16 v[116:117], v7 offset:45056
ds_read_b64_tr_b16 v[118:119], v7 offset:47104
v_mfma_f32_16x16x32_bf16 v[32:35], v[96:99], v[208:211], v[32:35]
buffer_load_dwordx4 v[180:183], v3, s[88:91], s32 offen offset:1024
s_add_u32 s32, s32, 0x2000
v_mfma_f32_16x16x32_bf16 v[48:51], v[96:99], v[212:215], v[48:51]
buffer_load_dwordx4 v[184:187], v3, s[88:91], s32 offen
v_mfma_f32_16x16x32_bf16 v[52:55], v[100:103], v[212:215], v[52:55]
buffer_load_dwordx4 v[188:191], v3, s[88:91], s32 offen offset:1024
v_mfma_f32_16x16x32_bf16 v[36:39], v[100:103], v[208:211], v[36:39]
s_add_u32 s32, s32, 0x2000
s_waitcnt vmcnt(24) lgkmcnt(0)
s_barrier
v_mfma_f32_16x16x32_bf16 v[24:27], v[104:107], v[216:219], v[24:27]
ds_read_b64_tr_b16 v[88:89], v4 offset:49152
ds_read_b64_tr_b16 v[90:91], v4 offset:51200
v_mfma_f32_16x16x32_bf16 v[40:43], v[104:107], v[220:223], v[40:43]
ds_read_b64_tr_b16 v[92:93], v5 offset:49152
ds_read_b64_tr_b16 v[94:95], v5 offset:51200
v_mfma_f32_16x16x32_bf16 v[44:47], v[108:111], v[220:223], v[44:47]
ds_read_b64_tr_b16 v[96:97], v6 offset:49152
ds_read_b64_tr_b16 v[98:99], v6 offset:51200
v_mfma_f32_16x16x32_bf16 v[28:31], v[108:111], v[216:219], v[28:31]
ds_read_b64_tr_b16 v[100:101], v7 offset:49152
ds_read_b64_tr_b16 v[102:103], v7 offset:51200
s_add_u32 m0, s17, 0x8000
v_mfma_f32_16x16x32_bf16 v[32:35], v[112:115], v[216:219], v[32:35]
buffer_load_dwordx4 v2, s[72:75], 0 offen lds
v_mfma_f32_16x16x32_bf16 v[48:51], v[112:115], v[220:223], v[48:51]
buffer_load_dwordx4 v2, s[72:75], s28 offen offset:1024 lds
v_mfma_f32_16x16x32_bf16 v[52:55], v[116:119], v[220:223], v[52:55]
buffer_load_dwordx4 v2, s[72:75], s29 offen offset:2048 lds
v_mfma_f32_16x16x32_bf16 v[36:39], v[116:119], v[216:219], v[36:39]
s_waitcnt lgkmcnt(0)
v_mfma_f32_16x16x32_bf16 v[24:27], v[88:91], v[224:227], v[24:27]
ds_read_b64_tr_b16 v[104:105], v4 offset:53248
ds_read_b64_tr_b16 v[106:107], v4 offset:55296
v_mfma_f32_16x16x32_bf16 v[40:43], v[88:91], v[228:231], v[40:43]
ds_read_b64_tr_b16 v[108:109], v5 offset:53248
ds_read_b64_tr_b16 v[110:111], v5 offset:55296
v_mfma_f32_16x16x32_bf16 v[44:47], v[92:95], v[228:231], v[44:47]
ds_read_b64_tr_b16 v[112:113], v6 offset:53248
ds_read_b64_tr_b16 v[114:115], v6 offset:55296
v_mfma_f32_16x16x32_bf16 v[28:31], v[92:95], v[224:227], v[28:31]
ds_read_b64_tr_b16 v[116:117], v7 offset:53248
ds_read_b64_tr_b16 v[118:119], v7 offset:55296
v_mfma_f32_16x16x32_bf16 v[32:35], v[96:99], v[224:227], v[32:35]
buffer_load_dwordx4 v2, s[72:75], s30 offen offset:3072 lds
v_add_u32 v2, 0x40000, v2
v_mfma_f32_16x16x32_bf16 v[48:51], v[96:99], v[228:231], v[48:51]
buffer_load_dwordx4 v[192:195], v3, s[88:91], s32 offen
v_mfma_f32_16x16x32_bf16 v[52:55], v[100:103], v[228:231], v[52:55]
buffer_load_dwordx4 v[196:199], v3, s[88:91], s32 offen offset:1024
v_mfma_f32_16x16x32_bf16 v[36:39], v[100:103], v[224:227], v[36:39]
s_waitcnt lgkmcnt(0)
v_mfma_f32_16x16x32_bf16 v[24:27], v[104:107], v[232:235], v[24:27]
ds_read_b64_tr_b16 v[88:89], v4 offset:57344
ds_read_b64_tr_b16 v[90:91], v4 offset:59392
v_mfma_f32_16x16x32_bf16 v[40:43], v[104:107], v[236:239], v[40:43]
ds_read_b64_tr_b16 v[92:93], v5 offset:57344
ds_read_b64_tr_b16 v[94:95], v5 offset:59392
v_mfma_f32_16x16x32_bf16 v[44:47], v[108:111], v[236:239], v[44:47]
ds_read_b64_tr_b16 v[96:97], v6 offset:57344
ds_read_b64_tr_b16 v[98:99], v6 offset:59392
v_mfma_f32_16x16x32_bf16 v[28:31], v[108:111], v[232:235], v[28:31]
ds_read_b64_tr_b16 v[100:101], v7 offset:57344
ds_read_b64_tr_b16 v[102:103], v7 offset:59392
s_add_u32 s32, s32, 0x2000
v_mfma_f32_16x16x32_bf16 v[32:35], v[112:115], v[232:235], v[32:35]
buffer_load_dwordx4 v[200:203], v3, s[88:91], s32 offen
v_mfma_f32_16x16x32_bf16 v[48:51], v[112:115], v[236:239], v[48:51]
buffer_load_dwordx4 v[204:207], v3, s[88:91], s32 offen offset:1024
s_add_u32 s32, s32, 0x2000
v_mfma_f32_16x16x32_bf16 v[52:55], v[116:119], v[236:239], v[52:55]
buffer_load_dwordx4 v[208:211], v3, s[88:91], s32 offen
v_mfma_f32_16x16x32_bf16 v[36:39], v[116:119], v[232:235], v[36:39]
s_waitcnt lgkmcnt(0)
v_mfma_f32_16x16x32_bf16 v[24:27], v[88:91], v[240:243], v[24:27]
ds_read_b64_tr_b16 v[104:105], v4 offset:61440
ds_read_b64_tr_b16 v[106:107], v4 offset:63488
v_mfma_f32_16x16x32_bf16 v[40:43], v[88:91], v[244:247], v[40:43]
ds_read_b64_tr_b16 v[108:109], v5 offset:61440
ds_read_b64_tr_b16 v[110:111], v5 offset:63488
v_mfma_f32_16x16x32_bf16 v[44:47], v[92:95], v[244:247], v[44:47]
ds_read_b64_tr_b16 v[112:113], v6 offset:61440
ds_read_b64_tr_b16 v[114:115], v6 offset:63488
v_mfma_f32_16x16x32_bf16 v[28:31], v[92:95], v[240:243], v[28:31]
ds_read_b64_tr_b16 v[116:117], v7 offset:61440
ds_read_b64_tr_b16 v[118:119], v7 offset:63488
v_mfma_f32_16x16x32_bf16 v[32:35], v[96:99], v[240:243], v[32:35]
buffer_load_dwordx4 v[212:215], v3, s[88:91], s32 offen offset:1024
s_add_u32 s32, s32, 0x2000
v_mfma_f32_16x16x32_bf16 v[48:51], v[96:99], v[244:247], v[48:51]
buffer_load_dwordx4 v[216:219], v3, s[88:91], s32 offen
v_mfma_f32_16x16x32_bf16 v[52:55], v[100:103], v[244:247], v[52:55]
buffer_load_dwordx4 v[220:223], v3, s[88:91], s32 offen offset:1024
v_mfma_f32_16x16x32_bf16 v[36:39], v[100:103], v[240:243], v[36:39]
s_add_u32 s32, s32, 0x2000
s_waitcnt vmcnt(24) lgkmcnt(0)
s_barrier
v_mfma_f32_16x16x32_bf16 v[24:27], v[104:107], v[248:251], v[24:27]
ds_read_b64_tr_b16 v[88:89], v4 offset:0
ds_read_b64_tr_b16 v[90:91], v4 offset:2048
v_mfma_f32_16x16x32_bf16 v[40:43], v[104:107], v[252:255], v[40:43]
ds_read_b64_tr_b16 v[92:93], v5 offset:0
ds_read_b64_tr_b16 v[94:95], v5 offset:2048
v_mfma_f32_16x16x32_bf16 v[44:47], v[108:111], v[252:255], v[44:47]
ds_read_b64_tr_b16 v[96:97], v6 offset:0
ds_read_b64_tr_b16 v[98:99], v6 offset:2048
v_mfma_f32_16x16x32_bf16 v[28:31], v[108:111], v[248:251], v[28:31]
ds_read_b64_tr_b16 v[100:101], v7 offset:0
ds_read_b64_tr_b16 v[102:103], v7 offset:2048
s_add_u32 m0, s17, 0xc000
v_mfma_f32_16x16x32_bf16 v[32:35], v[112:115], v[248:251], v[32:35]
buffer_load_dwordx4 v2, s[72:75], 0 offen lds
v_mfma_f32_16x16x32_bf16 v[48:51], v[112:115], v[252:255], v[48:51]
buffer_load_dwordx4 v2, s[72:75], s28 offen offset:1024 lds
v_mfma_f32_16x16x32_bf16 v[52:55], v[116:119], v[252:255], v[52:55]
buffer_load_dwordx4 v2, s[72:75], s29 offen offset:2048 lds
v_mfma_f32_16x16x32_bf16 v[36:39], v[116:119], v[248:251], v[36:39]
s_waitcnt lgkmcnt(0)
v_mfma_f32_16x16x32_bf16 v[24:27], v[88:91], v[128:131], v[24:27]
ds_read_b64_tr_b16 v[104:105], v4 offset:4096
ds_read_b64_tr_b16 v[106:107], v4 offset:6144
v_mfma_f32_16x16x32_bf16 v[40:43], v[88:91], v[132:135], v[40:43]
ds_read_b64_tr_b16 v[108:109], v5 offset:4096
ds_read_b64_tr_b16 v[110:111], v5 offset:6144
v_mfma_f32_16x16x32_bf16 v[44:47], v[92:95], v[132:135], v[44:47]
ds_read_b64_tr_b16 v[112:113], v6 offset:4096
ds_read_b64_tr_b16 v[114:115], v6 offset:6144
v_mfma_f32_16x16x32_bf16 v[28:31], v[92:95], v[128:131], v[28:31]
ds_read_b64_tr_b16 v[116:117], v7 offset:4096
ds_read_b64_tr_b16 v[118:119], v7 offset:6144
v_mfma_f32_16x16x32_bf16 v[32:35], v[96:99], v[128:131], v[32:35]
buffer_load_dwordx4 v2, s[72:75], s30 offen offset:3072 lds
v_add_u32 v2, 0xffe40000, v2
v_mfma_f32_16x16x32_bf16 v[48:51], v[96:99], v[132:135], v[48:51]
buffer_load_dwordx4 v[224:227], v3, s[88:91], s32 offen
v_mfma_f32_16x16x32_bf16 v[52:55], v[100:103], v[132:135], v[52:55]
buffer_load_dwordx4 v[228:231], v3, s[88:91], s32 offen offset:1024
v_mfma_f32_16x16x32_bf16 v[36:39], v[100:103], v[128:131], v[36:39]
s_waitcnt lgkmcnt(0)
v_mfma_f32_16x16x32_bf16 v[24:27], v[104:107], v[136:139], v[24:27]
ds_read_b64_tr_b16 v[88:89], v4 offset:8192
ds_read_b64_tr_b16 v[90:91], v4 offset:10240
v_mfma_f32_16x16x32_bf16 v[40:43], v[104:107], v[140:143], v[40:43]
ds_read_b64_tr_b16 v[92:93], v5 offset:8192
ds_read_b64_tr_b16 v[94:95], v5 offset:10240
v_mfma_f32_16x16x32_bf16 v[44:47], v[108:111], v[140:143], v[44:47]
ds_read_b64_tr_b16 v[96:97], v6 offset:8192
ds_read_b64_tr_b16 v[98:99], v6 offset:10240
v_mfma_f32_16x16x32_bf16 v[28:31], v[108:111], v[136:139], v[28:31]
ds_read_b64_tr_b16 v[100:101], v7 offset:8192
ds_read_b64_tr_b16 v[102:103], v7 offset:10240
s_add_u32 s32, s32, 0x2000
v_mfma_f32_16x16x32_bf16 v[32:35], v[112:115], v[136:139], v[32:35]
buffer_load_dwordx4 v[232:235], v3, s[88:91], s32 offen
v_mfma_f32_16x16x32_bf16 v[48:51], v[112:115], v[140:143], v[48:51]
buffer_load_dwordx4 v[236:239], v3, s[88:91], s32 offen offset:1024
s_add_u32 s32, s32, 0x2000
v_mfma_f32_16x16x32_bf16 v[52:55], v[116:119], v[140:143], v[52:55]
buffer_load_dwordx4 v[240:243], v3, s[88:91], s32 offen
v_mfma_f32_16x16x32_bf16 v[36:39], v[116:119], v[136:139], v[36:39]
s_waitcnt lgkmcnt(0)
v_mfma_f32_16x16x32_bf16 v[24:27], v[88:91], v[144:147], v[24:27]
ds_read_b64_tr_b16 v[104:105], v4 offset:12288
ds_read_b64_tr_b16 v[106:107], v4 offset:14336
v_mfma_f32_16x16x32_bf16 v[40:43], v[88:91], v[148:151], v[40:43]
ds_read_b64_tr_b16 v[108:109], v5 offset:12288
ds_read_b64_tr_b16 v[110:111], v5 offset:14336
v_mfma_f32_16x16x32_bf16 v[44:47], v[92:95], v[148:151], v[44:47]
ds_read_b64_tr_b16 v[112:113], v6 offset:12288
ds_read_b64_tr_b16 v[114:115], v6 offset:14336
v_mfma_f32_16x16x32_bf16 v[28:31], v[92:95], v[144:147], v[28:31]
ds_read_b64_tr_b16 v[116:117], v7 offset:12288
ds_read_b64_tr_b16 v[118:119], v7 offset:14336
v_mfma_f32_16x16x32_bf16 v[32:35], v[96:99], v[144:147], v[32:35]
buffer_load_dwordx4 v[244:247], v3, s[88:91], s32 offen offset:1024
s_add_u32 s32, s32, 0x2000
v_mfma_f32_16x16x32_bf16 v[48:51], v[96:99], v[148:151], v[48:51]
buffer_load_dwordx4 v[248:251], v3, s[88:91], s32 offen
v_mfma_f32_16x16x32_bf16 v[52:55], v[100:103], v[148:151], v[52:55]
buffer_load_dwordx4 v[252:255], v3, s[88:91], s32 offen offset:1024
v_mfma_f32_16x16x32_bf16 v[36:39], v[100:103], v[144:147], v[36:39]
s_add_u32 s32, s32, 0x2000
s_waitcnt vmcnt(24) lgkmcnt(0)
s_barrier
v_mfma_f32_16x16x32_bf16 v[24:27], v[104:107], v[152:155], v[24:27]
ds_read_b64_tr_b16 v[88:89], v4 offset:16384
ds_read_b64_tr_b16 v[90:91], v4 offset:18432
v_mfma_f32_16x16x32_bf16 v[40:43], v[104:107], v[156:159], v[40:43]
ds_read_b64_tr_b16 v[92:93], v5 offset:16384
ds_read_b64_tr_b16 v[94:95], v5 offset:18432
v_mfma_f32_16x16x32_bf16 v[44:47], v[108:111], v[156:159], v[44:47]
ds_read_b64_tr_b16 v[96:97], v6 offset:16384
ds_read_b64_tr_b16 v[98:99], v6 offset:18432
v_mfma_f32_16x16x32_bf16 v[28:31], v[108:111], v[152:155], v[28:31]
ds_read_b64_tr_b16 v[100:101], v7 offset:16384
ds_read_b64_tr_b16 v[102:103], v7 offset:18432
s_add_u32 m0, s17, 0x0
v_mfma_f32_16x16x32_bf16 v[32:35], v[112:115], v[152:155], v[32:35]
buffer_load_dwordx4 v2, s[64:67], 0 offen lds
v_mfma_f32_16x16x32_bf16 v[48:51], v[112:115], v[156:159], v[48:51]
buffer_load_dwordx4 v2, s[64:67], s28 offen offset:1024 lds
v_mfma_f32_16x16x32_bf16 v[52:55], v[116:119], v[156:159], v[52:55]
buffer_load_dwordx4 v2, s[64:67], s29 offen offset:2048 lds
v_mfma_f32_16x16x32_bf16 v[36:39], v[116:119], v[152:155], v[36:39]
s_waitcnt lgkmcnt(0)
v_mfma_f32_16x16x32_bf16 v[24:27], v[88:91], v[160:163], v[24:27]
ds_read_b64_tr_b16 v[104:105], v4 offset:20480
ds_read_b64_tr_b16 v[106:107], v4 offset:22528
v_mfma_f32_16x16x32_bf16 v[40:43], v[88:91], v[164:167], v[40:43]
ds_read_b64_tr_b16 v[108:109], v5 offset:20480
ds_read_b64_tr_b16 v[110:111], v5 offset:22528
v_mfma_f32_16x16x32_bf16 v[44:47], v[92:95], v[164:167], v[44:47]
ds_read_b64_tr_b16 v[112:113], v6 offset:20480
ds_read_b64_tr_b16 v[114:115], v6 offset:22528
v_mfma_f32_16x16x32_bf16 v[28:31], v[92:95], v[160:163], v[28:31]
ds_read_b64_tr_b16 v[116:117], v7 offset:20480
ds_read_b64_tr_b16 v[118:119], v7 offset:22528
v_mfma_f32_16x16x32_bf16 v[32:35], v[96:99], v[160:163], v[32:35]
buffer_load_dwordx4 v2, s[64:67], s30 offen offset:3072 lds
v_add_u32 v2, 0x40000, v2
v_mfma_f32_16x16x32_bf16 v[48:51], v[96:99], v[164:167], v[48:51]
buffer_load_dwordx4 v[128:131], v3, s[88:91], s32 offen
v_mfma_f32_16x16x32_bf16 v[52:55], v[100:103], v[164:167], v[52:55]
buffer_load_dwordx4 v[132:135], v3, s[88:91], s32 offen offset:1024
v_mfma_f32_16x16x32_bf16 v[36:39], v[100:103], v[160:163], v[36:39]
s_waitcnt lgkmcnt(0)
v_mfma_f32_16x16x32_bf16 v[24:27], v[104:107], v[168:171], v[24:27]
ds_read_b64_tr_b16 v[88:89], v4 offset:24576
ds_read_b64_tr_b16 v[90:91], v4 offset:26624
v_mfma_f32_16x16x32_bf16 v[40:43], v[104:107], v[172:175], v[40:43]
ds_read_b64_tr_b16 v[92:93], v5 offset:24576
ds_read_b64_tr_b16 v[94:95], v5 offset:26624
v_mfma_f32_16x16x32_bf16 v[44:47], v[108:111], v[172:175], v[44:47]
ds_read_b64_tr_b16 v[96:97], v6 offset:24576
ds_read_b64_tr_b16 v[98:99], v6 offset:26624
v_mfma_f32_16x16x32_bf16 v[28:31], v[108:111], v[168:171], v[28:31]
ds_read_b64_tr_b16 v[100:101], v7 offset:24576
ds_read_b64_tr_b16 v[102:103], v7 offset:26624
s_add_u32 s32, s32, 0x2000
v_mfma_f32_16x16x32_bf16 v[32:35], v[112:115], v[168:171], v[32:35]
buffer_load_dwordx4 v[136:139], v3, s[88:91], s32 offen
v_mfma_f32_16x16x32_bf16 v[48:51], v[112:115], v[172:175], v[48:51]
buffer_load_dwordx4 v[140:143], v3, s[88:91], s32 offen offset:1024
s_add_u32 s32, s32, 0x2000
v_mfma_f32_16x16x32_bf16 v[52:55], v[116:119], v[172:175], v[52:55]
buffer_load_dwordx4 v[144:147], v3, s[88:91], s32 offen
v_mfma_f32_16x16x32_bf16 v[36:39], v[116:119], v[168:171], v[36:39]
s_waitcnt lgkmcnt(0)
v_mfma_f32_16x16x32_bf16 v[24:27], v[88:91], v[176:179], v[24:27]
ds_read_b64_tr_b16 v[104:105], v4 offset:28672
ds_read_b64_tr_b16 v[106:107], v4 offset:30720
v_mfma_f32_16x16x32_bf16 v[40:43], v[88:91], v[180:183], v[40:43]
ds_read_b64_tr_b16 v[108:109], v5 offset:28672
ds_read_b64_tr_b16 v[110:111], v5 offset:30720
v_mfma_f32_16x16x32_bf16 v[44:47], v[92:95], v[180:183], v[44:47]
ds_read_b64_tr_b16 v[112:113], v6 offset:28672
ds_read_b64_tr_b16 v[114:115], v6 offset:30720
v_mfma_f32_16x16x32_bf16 v[28:31], v[92:95], v[176:179], v[28:31]
ds_read_b64_tr_b16 v[116:117], v7 offset:28672
ds_read_b64_tr_b16 v[118:119], v7 offset:30720
v_mfma_f32_16x16x32_bf16 v[32:35], v[96:99], v[176:179], v[32:35]
buffer_load_dwordx4 v[148:151], v3, s[88:91], s32 offen offset:1024
s_add_u32 s32, s32, 0x2000
v_mfma_f32_16x16x32_bf16 v[48:51], v[96:99], v[180:183], v[48:51]
buffer_load_dwordx4 v[152:155], v3, s[88:91], s32 offen
v_mfma_f32_16x16x32_bf16 v[52:55], v[100:103], v[180:183], v[52:55]
buffer_load_dwordx4 v[156:159], v3, s[88:91], s32 offen offset:1024
v_mfma_f32_16x16x32_bf16 v[36:39], v[100:103], v[176:179], v[36:39]
s_add_u32 s32, s32, 0x2000
s_waitcnt vmcnt(24) lgkmcnt(0)
s_barrier
v_mfma_f32_16x16x32_bf16 v[24:27], v[104:107], v[184:187], v[24:27]
ds_read_b64_tr_b16 v[88:89], v4 offset:32768
ds_read_b64_tr_b16 v[90:91], v4 offset:34816
v_mfma_f32_16x16x32_bf16 v[40:43], v[104:107], v[188:191], v[40:43]
ds_read_b64_tr_b16 v[92:93], v5 offset:32768
ds_read_b64_tr_b16 v[94:95], v5 offset:34816
v_mfma_f32_16x16x32_bf16 v[44:47], v[108:111], v[188:191], v[44:47]
ds_read_b64_tr_b16 v[96:97], v6 offset:32768
ds_read_b64_tr_b16 v[98:99], v6 offset:34816
v_mfma_f32_16x16x32_bf16 v[28:31], v[108:111], v[184:187], v[28:31]
ds_read_b64_tr_b16 v[100:101], v7 offset:32768
ds_read_b64_tr_b16 v[102:103], v7 offset:34816
s_add_u32 m0, s17, 0x4000
v_mfma_f32_16x16x32_bf16 v[32:35], v[112:115], v[184:187], v[32:35]
buffer_load_dwordx4 v2, s[64:67], 0 offen lds
v_mfma_f32_16x16x32_bf16 v[48:51], v[112:115], v[188:191], v[48:51]
buffer_load_dwordx4 v2, s[64:67], s28 offen offset:1024 lds
v_mfma_f32_16x16x32_bf16 v[52:55], v[116:119], v[188:191], v[52:55]
buffer_load_dwordx4 v2, s[64:67], s29 offen offset:2048 lds
v_mfma_f32_16x16x32_bf16 v[36:39], v[116:119], v[184:187], v[36:39]
s_waitcnt lgkmcnt(0)
v_mfma_f32_16x16x32_bf16 v[24:27], v[88:91], v[192:195], v[24:27]
ds_read_b64_tr_b16 v[104:105], v4 offset:36864
ds_read_b64_tr_b16 v[106:107], v4 offset:38912
v_mfma_f32_16x16x32_bf16 v[40:43], v[88:91], v[196:199], v[40:43]
ds_read_b64_tr_b16 v[108:109], v5 offset:36864
ds_read_b64_tr_b16 v[110:111], v5 offset:38912
v_mfma_f32_16x16x32_bf16 v[44:47], v[92:95], v[196:199], v[44:47]
ds_read_b64_tr_b16 v[112:113], v6 offset:36864
ds_read_b64_tr_b16 v[114:115], v6 offset:38912
v_mfma_f32_16x16x32_bf16 v[28:31], v[92:95], v[192:195], v[28:31]
ds_read_b64_tr_b16 v[116:117], v7 offset:36864
ds_read_b64_tr_b16 v[118:119], v7 offset:38912
v_mfma_f32_16x16x32_bf16 v[32:35], v[96:99], v[192:195], v[32:35]
buffer_load_dwordx4 v2, s[64:67], s30 offen offset:3072 lds
v_add_u32 v2, 0x40000, v2
v_mfma_f32_16x16x32_bf16 v[48:51], v[96:99], v[196:199], v[48:51]
buffer_load_dwordx4 v[160:163], v3, s[88:91], s32 offen
v_mfma_f32_16x16x32_bf16 v[52:55], v[100:103], v[196:199], v[52:55]
buffer_load_dwordx4 v[164:167], v3, s[88:91], s32 offen offset:1024
v_mfma_f32_16x16x32_bf16 v[36:39], v[100:103], v[192:195], v[36:39]
s_waitcnt lgkmcnt(0)
v_mfma_f32_16x16x32_bf16 v[24:27], v[104:107], v[200:203], v[24:27]
ds_read_b64_tr_b16 v[88:89], v4 offset:40960
ds_read_b64_tr_b16 v[90:91], v4 offset:43008
v_mfma_f32_16x16x32_bf16 v[40:43], v[104:107], v[204:207], v[40:43]
ds_read_b64_tr_b16 v[92:93], v5 offset:40960
ds_read_b64_tr_b16 v[94:95], v5 offset:43008
v_mfma_f32_16x16x32_bf16 v[44:47], v[108:111], v[204:207], v[44:47]
ds_read_b64_tr_b16 v[96:97], v6 offset:40960
ds_read_b64_tr_b16 v[98:99], v6 offset:43008
v_mfma_f32_16x16x32_bf16 v[28:31], v[108:111], v[200:203], v[28:31]
ds_read_b64_tr_b16 v[100:101], v7 offset:40960
ds_read_b64_tr_b16 v[102:103], v7 offset:43008
s_add_u32 s32, s32, 0x2000
v_mfma_f32_16x16x32_bf16 v[32:35], v[112:115], v[200:203], v[32:35]
buffer_load_dwordx4 v[168:171], v3, s[88:91], s32 offen
v_mfma_f32_16x16x32_bf16 v[48:51], v[112:115], v[204:207], v[48:51]
buffer_load_dwordx4 v[172:175], v3, s[88:91], s32 offen offset:1024
s_add_u32 s32, s32, 0x2000
v_mfma_f32_16x16x32_bf16 v[52:55], v[116:119], v[204:207], v[52:55]
buffer_load_dwordx4 v[176:179], v3, s[88:91], s32 offen
v_mfma_f32_16x16x32_bf16 v[36:39], v[116:119], v[200:203], v[36:39]
s_waitcnt lgkmcnt(0)
v_mfma_f32_16x16x32_bf16 v[24:27], v[88:91], v[208:211], v[24:27]
ds_read_b64_tr_b16 v[104:105], v4 offset:45056
ds_read_b64_tr_b16 v[106:107], v4 offset:47104
v_mfma_f32_16x16x32_bf16 v[40:43], v[88:91], v[212:215], v[40:43]
ds_read_b64_tr_b16 v[108:109], v5 offset:45056
ds_read_b64_tr_b16 v[110:111], v5 offset:47104
v_mfma_f32_16x16x32_bf16 v[44:47], v[92:95], v[212:215], v[44:47]
ds_read_b64_tr_b16 v[112:113], v6 offset:45056
ds_read_b64_tr_b16 v[114:115], v6 offset:47104
v_mfma_f32_16x16x32_bf16 v[28:31], v[92:95], v[208:211], v[28:31]
ds_read_b64_tr_b16 v[116:117], v7 offset:45056
ds_read_b64_tr_b16 v[118:119], v7 offset:47104
v_mfma_f32_16x16x32_bf16 v[32:35], v[96:99], v[208:211], v[32:35]
buffer_load_dwordx4 v[180:183], v3, s[88:91], s32 offen offset:1024
s_add_u32 s32, s32, 0x2000
v_mfma_f32_16x16x32_bf16 v[48:51], v[96:99], v[212:215], v[48:51]
buffer_load_dwordx4 v[184:187], v3, s[88:91], s32 offen
v_mfma_f32_16x16x32_bf16 v[52:55], v[100:103], v[212:215], v[52:55]
buffer_load_dwordx4 v[188:191], v3, s[88:91], s32 offen offset:1024
v_mfma_f32_16x16x32_bf16 v[36:39], v[100:103], v[208:211], v[36:39]
s_add_u32 s32, s32, 0x2000
s_waitcnt vmcnt(24) lgkmcnt(0)
s_barrier
v_mfma_f32_16x16x32_bf16 v[24:27], v[104:107], v[216:219], v[24:27]
ds_read_b64_tr_b16 v[88:89], v4 offset:49152
ds_read_b64_tr_b16 v[90:91], v4 offset:51200
v_mfma_f32_16x16x32_bf16 v[40:43], v[104:107], v[220:223], v[40:43]
ds_read_b64_tr_b16 v[92:93], v5 offset:49152
ds_read_b64_tr_b16 v[94:95], v5 offset:51200
v_mfma_f32_16x16x32_bf16 v[44:47], v[108:111], v[220:223], v[44:47]
ds_read_b64_tr_b16 v[96:97], v6 offset:49152
ds_read_b64_tr_b16 v[98:99], v6 offset:51200
v_mfma_f32_16x16x32_bf16 v[28:31], v[108:111], v[216:219], v[28:31]
ds_read_b64_tr_b16 v[100:101], v7 offset:49152
ds_read_b64_tr_b16 v[102:103], v7 offset:51200
s_add_u32 m0, s17, 0x8000
v_mfma_f32_16x16x32_bf16 v[32:35], v[112:115], v[216:219], v[32:35]
buffer_load_dwordx4 v2, s[64:67], 0 offen lds
v_mfma_f32_16x16x32_bf16 v[48:51], v[112:115], v[220:223], v[48:51]
buffer_load_dwordx4 v2, s[64:67], s28 offen offset:1024 lds
v_mfma_f32_16x16x32_bf16 v[52:55], v[116:119], v[220:223], v[52:55]
buffer_load_dwordx4 v2, s[64:67], s29 offen offset:2048 lds
v_mfma_f32_16x16x32_bf16 v[36:39], v[116:119], v[216:219], v[36:39]
s_waitcnt lgkmcnt(0)
v_mfma_f32_16x16x32_bf16 v[24:27], v[88:91], v[224:227], v[24:27]
ds_read_b64_tr_b16 v[104:105], v4 offset:53248
ds_read_b64_tr_b16 v[106:107], v4 offset:55296
v_mfma_f32_16x16x32_bf16 v[40:43], v[88:91], v[228:231], v[40:43]
ds_read_b64_tr_b16 v[108:109], v5 offset:53248
ds_read_b64_tr_b16 v[110:111], v5 offset:55296
v_mfma_f32_16x16x32_bf16 v[44:47], v[92:95], v[228:231], v[44:47]
ds_read_b64_tr_b16 v[112:113], v6 offset:53248
ds_read_b64_tr_b16 v[114:115], v6 offset:55296
v_mfma_f32_16x16x32_bf16 v[28:31], v[92:95], v[224:227], v[28:31]
ds_read_b64_tr_b16 v[116:117], v7 offset:53248
ds_read_b64_tr_b16 v[118:119], v7 offset:55296
v_mfma_f32_16x16x32_bf16 v[32:35], v[96:99], v[224:227], v[32:35]
buffer_load_dwordx4 v2, s[64:67], s30 offen offset:3072 lds
v_add_u32 v2, 0x40000, v2
v_mfma_f32_16x16x32_bf16 v[48:51], v[96:99], v[228:231], v[48:51]
buffer_load_dwordx4 v[192:195], v3, s[88:91], s32 offen
v_mfma_f32_16x16x32_bf16 v[52:55], v[100:103], v[228:231], v[52:55]
buffer_load_dwordx4 v[196:199], v3, s[88:91], s32 offen offset:1024
v_mfma_f32_16x16x32_bf16 v[36:39], v[100:103], v[224:227], v[36:39]
s_waitcnt lgkmcnt(0)
v_mfma_f32_16x16x32_bf16 v[24:27], v[104:107], v[232:235], v[24:27]
ds_read_b64_tr_b16 v[88:89], v4 offset:57344
ds_read_b64_tr_b16 v[90:91], v4 offset:59392
v_mfma_f32_16x16x32_bf16 v[40:43], v[104:107], v[236:239], v[40:43]
ds_read_b64_tr_b16 v[92:93], v5 offset:57344
ds_read_b64_tr_b16 v[94:95], v5 offset:59392
v_mfma_f32_16x16x32_bf16 v[44:47], v[108:111], v[236:239], v[44:47]
ds_read_b64_tr_b16 v[96:97], v6 offset:57344
ds_read_b64_tr_b16 v[98:99], v6 offset:59392
v_mfma_f32_16x16x32_bf16 v[28:31], v[108:111], v[232:235], v[28:31]
ds_read_b64_tr_b16 v[100:101], v7 offset:57344
ds_read_b64_tr_b16 v[102:103], v7 offset:59392
s_add_u32 s32, s32, 0x2000
v_mfma_f32_16x16x32_bf16 v[32:35], v[112:115], v[232:235], v[32:35]
buffer_load_dwordx4 v[200:203], v3, s[88:91], s32 offen
v_mfma_f32_16x16x32_bf16 v[48:51], v[112:115], v[236:239], v[48:51]
buffer_load_dwordx4 v[204:207], v3, s[88:91], s32 offen offset:1024
s_add_u32 s32, s32, 0x2000
v_mfma_f32_16x16x32_bf16 v[52:55], v[116:119], v[236:239], v[52:55]
buffer_load_dwordx4 v[208:211], v3, s[88:91], s32 offen
v_mfma_f32_16x16x32_bf16 v[36:39], v[116:119], v[232:235], v[36:39]
s_waitcnt lgkmcnt(0)
v_mfma_f32_16x16x32_bf16 v[24:27], v[88:91], v[240:243], v[24:27]
ds_read_b64_tr_b16 v[104:105], v4 offset:61440
ds_read_b64_tr_b16 v[106:107], v4 offset:63488
v_mfma_f32_16x16x32_bf16 v[40:43], v[88:91], v[244:247], v[40:43]
ds_read_b64_tr_b16 v[108:109], v5 offset:61440
ds_read_b64_tr_b16 v[110:111], v5 offset:63488
v_mfma_f32_16x16x32_bf16 v[44:47], v[92:95], v[244:247], v[44:47]
ds_read_b64_tr_b16 v[112:113], v6 offset:61440
ds_read_b64_tr_b16 v[114:115], v6 offset:63488
v_mfma_f32_16x16x32_bf16 v[28:31], v[92:95], v[240:243], v[28:31]
ds_read_b64_tr_b16 v[116:117], v7 offset:61440
ds_read_b64_tr_b16 v[118:119], v7 offset:63488
v_mfma_f32_16x16x32_bf16 v[32:35], v[96:99], v[240:243], v[32:35]
buffer_load_dwordx4 v[212:215], v3, s[88:91], s32 offen offset:1024
s_add_u32 s32, s32, 0x2000
v_mfma_f32_16x16x32_bf16 v[48:51], v[96:99], v[244:247], v[48:51]
buffer_load_dwordx4 v[216:219], v3, s[88:91], s32 offen
v_mfma_f32_16x16x32_bf16 v[52:55], v[100:103], v[244:247], v[52:55]
buffer_load_dwordx4 v[220:223], v3, s[88:91], s32 offen offset:1024
v_mfma_f32_16x16x32_bf16 v[36:39], v[100:103], v[240:243], v[36:39]
s_add_u32 s32, s32, 0x2000
s_waitcnt vmcnt(24) lgkmcnt(0)
s_barrier
v_mfma_f32_16x16x32_bf16 v[24:27], v[104:107], v[248:251], v[24:27]
ds_read_b64_tr_b16 v[88:89], v4 offset:0
ds_read_b64_tr_b16 v[90:91], v4 offset:2048
v_mfma_f32_16x16x32_bf16 v[40:43], v[104:107], v[252:255], v[40:43]
ds_read_b64_tr_b16 v[92:93], v5 offset:0
ds_read_b64_tr_b16 v[94:95], v5 offset:2048
v_mfma_f32_16x16x32_bf16 v[44:47], v[108:111], v[252:255], v[44:47]
ds_read_b64_tr_b16 v[96:97], v6 offset:0
ds_read_b64_tr_b16 v[98:99], v6 offset:2048
v_mfma_f32_16x16x32_bf16 v[28:31], v[108:111], v[248:251], v[28:31]
ds_read_b64_tr_b16 v[100:101], v7 offset:0
ds_read_b64_tr_b16 v[102:103], v7 offset:2048
s_add_u32 m0, s17, 0xc000
v_mfma_f32_16x16x32_bf16 v[32:35], v[112:115], v[248:251], v[32:35]
buffer_load_dwordx4 v2, s[64:67], 0 offen lds
v_mfma_f32_16x16x32_bf16 v[48:51], v[112:115], v[252:255], v[48:51]
buffer_load_dwordx4 v2, s[64:67], s28 offen offset:1024 lds
v_mfma_f32_16x16x32_bf16 v[52:55], v[116:119], v[252:255], v[52:55]
buffer_load_dwordx4 v2, s[64:67], s29 offen offset:2048 lds
v_mfma_f32_16x16x32_bf16 v[36:39], v[116:119], v[248:251], v[36:39]
s_waitcnt lgkmcnt(0)
v_mfma_f32_16x16x32_bf16 v[56:59], v[88:91], v[128:131], 0
ds_read_b64_tr_b16 v[104:105], v4 offset:4096
ds_read_b64_tr_b16 v[106:107], v4 offset:6144
v_mfma_f32_16x16x32_bf16 v[72:75], v[88:91], v[132:135], 0
ds_read_b64_tr_b16 v[108:109], v5 offset:4096
ds_read_b64_tr_b16 v[110:111], v5 offset:6144
v_mfma_f32_16x16x32_bf16 v[76:79], v[92:95], v[132:135], 0
ds_read_b64_tr_b16 v[112:113], v6 offset:4096
ds_read_b64_tr_b16 v[114:115], v6 offset:6144
v_mfma_f32_16x16x32_bf16 v[60:63], v[92:95], v[128:131], 0
ds_read_b64_tr_b16 v[116:117], v7 offset:4096
ds_read_b64_tr_b16 v[118:119], v7 offset:6144
v_mfma_f32_16x16x32_bf16 v[64:67], v[96:99], v[128:131], 0
buffer_load_dwordx4 v2, s[64:67], s30 offen offset:3072 lds
v_add_u32 v2, 0x40000, v2
v_mfma_f32_16x16x32_bf16 v[80:83], v[96:99], v[132:135], 0
buffer_load_dwordx4 v[224:227], v3, s[88:91], s32 offen
v_mfma_f32_16x16x32_bf16 v[84:87], v[100:103], v[132:135], 0
buffer_load_dwordx4 v[228:231], v3, s[88:91], s32 offen offset:1024
v_mfma_f32_16x16x32_bf16 v[68:71], v[100:103], v[128:131], 0
s_waitcnt lgkmcnt(0)
v_mfma_f32_16x16x32_bf16 v[56:59], v[104:107], v[136:139], v[56:59]
ds_read_b64_tr_b16 v[88:89], v4 offset:8192
ds_read_b64_tr_b16 v[90:91], v4 offset:10240
v_mfma_f32_16x16x32_bf16 v[72:75], v[104:107], v[140:143], v[72:75]
ds_read_b64_tr_b16 v[92:93], v5 offset:8192
ds_read_b64_tr_b16 v[94:95], v5 offset:10240
v_mfma_f32_16x16x32_bf16 v[76:79], v[108:111], v[140:143], v[76:79]
ds_read_b64_tr_b16 v[96:97], v6 offset:8192
ds_read_b64_tr_b16 v[98:99], v6 offset:10240
v_mfma_f32_16x16x32_bf16 v[60:63], v[108:111], v[136:139], v[60:63]
ds_read_b64_tr_b16 v[100:101], v7 offset:8192
ds_read_b64_tr_b16 v[102:103], v7 offset:10240
s_add_u32 s32, s32, 0x2000
v_mfma_f32_16x16x32_bf16 v[64:67], v[112:115], v[136:139], v[64:67]
buffer_load_dwordx4 v[232:235], v3, s[88:91], s32 offen
v_mfma_f32_16x16x32_bf16 v[80:83], v[112:115], v[140:143], v[80:83]
buffer_load_dwordx4 v[236:239], v3, s[88:91], s32 offen offset:1024
s_add_u32 s32, s32, 0x2000
v_mfma_f32_16x16x32_bf16 v[84:87], v[116:119], v[140:143], v[84:87]
buffer_load_dwordx4 v[240:243], v3, s[88:91], s32 offen
v_mfma_f32_16x16x32_bf16 v[68:71], v[116:119], v[136:139], v[68:71]
s_waitcnt lgkmcnt(0)
v_mfma_f32_16x16x32_bf16 v[56:59], v[88:91], v[144:147], v[56:59]
ds_read_b64_tr_b16 v[104:105], v4 offset:12288
ds_read_b64_tr_b16 v[106:107], v4 offset:14336
v_mfma_f32_16x16x32_bf16 v[72:75], v[88:91], v[148:151], v[72:75]
ds_read_b64_tr_b16 v[108:109], v5 offset:12288
ds_read_b64_tr_b16 v[110:111], v5 offset:14336
v_mfma_f32_16x16x32_bf16 v[76:79], v[92:95], v[148:151], v[76:79]
ds_read_b64_tr_b16 v[112:113], v6 offset:12288
ds_read_b64_tr_b16 v[114:115], v6 offset:14336
v_mfma_f32_16x16x32_bf16 v[60:63], v[92:95], v[144:147], v[60:63]
ds_read_b64_tr_b16 v[116:117], v7 offset:12288
ds_read_b64_tr_b16 v[118:119], v7 offset:14336
v_mfma_f32_16x16x32_bf16 v[64:67], v[96:99], v[144:147], v[64:67]
buffer_load_dwordx4 v[244:247], v3, s[88:91], s32 offen offset:1024
s_add_u32 s32, s32, 0x2000
v_mfma_f32_16x16x32_bf16 v[80:83], v[96:99], v[148:151], v[80:83]
buffer_load_dwordx4 v[248:251], v3, s[88:91], s32 offen
v_mfma_f32_16x16x32_bf16 v[84:87], v[100:103], v[148:151], v[84:87]
buffer_load_dwordx4 v[252:255], v3, s[88:91], s32 offen offset:1024
v_mfma_f32_16x16x32_bf16 v[68:71], v[100:103], v[144:147], v[68:71]
s_add_u32 s32, s32, 0x2000
s_mov_b32 s15, 7
L_p4_loop:
s_waitcnt vmcnt(24) lgkmcnt(0)
s_barrier
v_mfma_f32_16x16x32_bf16 v[56:59], v[104:107], v[152:155], v[56:59]
ds_read_b64_tr_b16 v[88:89], v4 offset:16384
ds_read_b64_tr_b16 v[90:91], v4 offset:18432
v_mfma_f32_16x16x32_bf16 v[72:75], v[104:107], v[156:159], v[72:75]
ds_read_b64_tr_b16 v[92:93], v5 offset:16384
ds_read_b64_tr_b16 v[94:95], v5 offset:18432
v_mfma_f32_16x16x32_bf16 v[76:79], v[108:111], v[156:159], v[76:79]
ds_read_b64_tr_b16 v[96:97], v6 offset:16384
ds_read_b64_tr_b16 v[98:99], v6 offset:18432
v_mfma_f32_16x16x32_bf16 v[60:63], v[108:111], v[152:155], v[60:63]
ds_read_b64_tr_b16 v[100:101], v7 offset:16384
ds_read_b64_tr_b16 v[102:103], v7 offset:18432
s_add_u32 m0, s17, 0x0
v_mfma_f32_16x16x32_bf16 v[64:67], v[112:115], v[152:155], v[64:67]
buffer_load_dwordx4 v2, s[64:67], 0 offen lds
v_mfma_f32_16x16x32_bf16 v[80:83], v[112:115], v[156:159], v[80:83]
buffer_load_dwordx4 v2, s[64:67], s28 offen offset:1024 lds
v_mfma_f32_16x16x32_bf16 v[84:87], v[116:119], v[156:159], v[84:87]
buffer_load_dwordx4 v2, s[64:67], s29 offen offset:2048 lds
v_mfma_f32_16x16x32_bf16 v[68:71], v[116:119], v[152:155], v[68:71]
s_waitcnt lgkmcnt(0)
v_mfma_f32_16x16x32_bf16 v[56:59], v[88:91], v[160:163], v[56:59]
ds_read_b64_tr_b16 v[104:105], v4 offset:20480
ds_read_b64_tr_b16 v[106:107], v4 offset:22528
v_mfma_f32_16x16x32_bf16 v[72:75], v[88:91], v[164:167], v[72:75]
ds_read_b64_tr_b16 v[108:109], v5 offset:20480
ds_read_b64_tr_b16 v[110:111], v5 offset:22528
v_mfma_f32_16x16x32_bf16 v[76:79], v[92:95], v[164:167], v[76:79]
ds_read_b64_tr_b16 v[112:113], v6 offset:20480
ds_read_b64_tr_b16 v[114:115], v6 offset:22528
v_mfma_f32_16x16x32_bf16 v[60:63], v[92:95], v[160:163], v[60:63]
ds_read_b64_tr_b16 v[116:117], v7 offset:20480
ds_read_b64_tr_b16 v[118:119], v7 offset:22528
v_mfma_f32_16x16x32_bf16 v[64:67], v[96:99], v[160:163], v[64:67]
buffer_load_dwordx4 v2, s[64:67], s30 offen offset:3072 lds
v_add_u32 v2, 0x40000, v2
v_mfma_f32_16x16x32_bf16 v[80:83], v[96:99], v[164:167], v[80:83]
buffer_load_dwordx4 v[128:131], v3, s[88:91], s32 offen
v_mfma_f32_16x16x32_bf16 v[84:87], v[100:103], v[164:167], v[84:87]
buffer_load_dwordx4 v[132:135], v3, s[88:91], s32 offen offset:1024
v_mfma_f32_16x16x32_bf16 v[68:71], v[100:103], v[160:163], v[68:71]
s_waitcnt lgkmcnt(0)
v_mfma_f32_16x16x32_bf16 v[56:59], v[104:107], v[168:171], v[56:59]
ds_read_b64_tr_b16 v[88:89], v4 offset:24576
ds_read_b64_tr_b16 v[90:91], v4 offset:26624
v_mfma_f32_16x16x32_bf16 v[72:75], v[104:107], v[172:175], v[72:75]
ds_read_b64_tr_b16 v[92:93], v5 offset:24576
ds_read_b64_tr_b16 v[94:95], v5 offset:26624
v_mfma_f32_16x16x32_bf16 v[76:79], v[108:111], v[172:175], v[76:79]
ds_read_b64_tr_b16 v[96:97], v6 offset:24576
ds_read_b64_tr_b16 v[98:99], v6 offset:26624
v_mfma_f32_16x16x32_bf16 v[60:63], v[108:111], v[168:171], v[60:63]
ds_read_b64_tr_b16 v[100:101], v7 offset:24576
ds_read_b64_tr_b16 v[102:103], v7 offset:26624
s_add_u32 s32, s32, 0x2000
v_mfma_f32_16x16x32_bf16 v[64:67], v[112:115], v[168:171], v[64:67]
buffer_load_dwordx4 v[136:139], v3, s[88:91], s32 offen
v_mfma_f32_16x16x32_bf16 v[80:83], v[112:115], v[172:175], v[80:83]
buffer_load_dwordx4 v[140:143], v3, s[88:91], s32 offen offset:1024
s_add_u32 s32, s32, 0x2000
v_mfma_f32_16x16x32_bf16 v[84:87], v[116:119], v[172:175], v[84:87]
buffer_load_dwordx4 v[144:147], v3, s[88:91], s32 offen
v_mfma_f32_16x16x32_bf16 v[68:71], v[116:119], v[168:171], v[68:71]
s_waitcnt lgkmcnt(0)
v_mfma_f32_16x16x32_bf16 v[56:59], v[88:91], v[176:179], v[56:59]
ds_read_b64_tr_b16 v[104:105], v4 offset:28672
ds_read_b64_tr_b16 v[106:107], v4 offset:30720
v_mfma_f32_16x16x32_bf16 v[72:75], v[88:91], v[180:183], v[72:75]
ds_read_b64_tr_b16 v[108:109], v5 offset:28672
ds_read_b64_tr_b16 v[110:111], v5 offset:30720
v_mfma_f32_16x16x32_bf16 v[76:79], v[92:95], v[180:183], v[76:79]
ds_read_b64_tr_b16 v[112:113], v6 offset:28672
ds_read_b64_tr_b16 v[114:115], v6 offset:30720
v_mfma_f32_16x16x32_bf16 v[60:63], v[92:95], v[176:179], v[60:63]
ds_read_b64_tr_b16 v[116:117], v7 offset:28672
ds_read_b64_tr_b16 v[118:119], v7 offset:30720
v_mfma_f32_16x16x32_bf16 v[64:67], v[96:99], v[176:179], v[64:67]
buffer_load_dwordx4 v[148:151], v3, s[88:91], s32 offen offset:1024
s_add_u32 s32, s32, 0x2000
v_mfma_f32_16x16x32_bf16 v[80:83], v[96:99], v[180:183], v[80:83]
buffer_load_dwordx4 v[152:155], v3, s[88:91], s32 offen
v_mfma_f32_16x16x32_bf16 v[84:87], v[100:103], v[180:183], v[84:87]
buffer_load_dwordx4 v[156:159], v3, s[88:91], s32 offen offset:1024
v_mfma_f32_16x16x32_bf16 v[68:71], v[100:103], v[176:179], v[68:71]
s_add_u32 s32, s32, 0x2000
s_waitcnt vmcnt(24) lgkmcnt(0)
s_barrier
v_mfma_f32_16x16x32_bf16 v[56:59], v[104:107], v[184:187], v[56:59]
ds_read_b64_tr_b16 v[88:89], v4 offset:32768
ds_read_b64_tr_b16 v[90:91], v4 offset:34816
v_mfma_f32_16x16x32_bf16 v[72:75], v[104:107], v[188:191], v[72:75]
ds_read_b64_tr_b16 v[92:93], v5 offset:32768
ds_read_b64_tr_b16 v[94:95], v5 offset:34816
v_mfma_f32_16x16x32_bf16 v[76:79], v[108:111], v[188:191], v[76:79]
ds_read_b64_tr_b16 v[96:97], v6 offset:32768
ds_read_b64_tr_b16 v[98:99], v6 offset:34816
v_mfma_f32_16x16x32_bf16 v[60:63], v[108:111], v[184:187], v[60:63]
ds_read_b64_tr_b16 v[100:101], v7 offset:32768
ds_read_b64_tr_b16 v[102:103], v7 offset:34816
s_add_u32 m0, s17, 0x4000
v_mfma_f32_16x16x32_bf16 v[64:67], v[112:115], v[184:187], v[64:67]
buffer_load_dwordx4 v2, s[64:67], 0 offen lds
v_mfma_f32_16x16x32_bf16 v[80:83], v[112:115], v[188:191], v[80:83]
buffer_load_dwordx4 v2, s[64:67], s28 offen offset:1024 lds
v_mfma_f32_16x16x32_bf16 v[84:87], v[116:119], v[188:191], v[84:87]
buffer_load_dwordx4 v2, s[64:67], s29 offen offset:2048 lds
v_mfma_f32_16x16x32_bf16 v[68:71], v[116:119], v[184:187], v[68:71]
s_waitcnt lgkmcnt(0)
v_mfma_f32_16x16x32_bf16 v[56:59], v[88:91], v[192:195], v[56:59]
ds_read_b64_tr_b16 v[104:105], v4 offset:36864
ds_read_b64_tr_b16 v[106:107], v4 offset:38912
v_mfma_f32_16x16x32_bf16 v[72:75], v[88:91], v[196:199], v[72:75]
ds_read_b64_tr_b16 v[108:109], v5 offset:36864
ds_read_b64_tr_b16 v[110:111], v5 offset:38912
v_mfma_f32_16x16x32_bf16 v[76:79], v[92:95], v[196:199], v[76:79]
ds_read_b64_tr_b16 v[112:113], v6 offset:36864
ds_read_b64_tr_b16 v[114:115], v6 offset:38912
v_mfma_f32_16x16x32_bf16 v[60:63], v[92:95], v[192:195], v[60:63]
ds_read_b64_tr_b16 v[116:117], v7 offset:36864
ds_read_b64_tr_b16 v[118:119], v7 offset:38912
v_mfma_f32_16x16x32_bf16 v[64:67], v[96:99], v[192:195], v[64:67]
buffer_load_dwordx4 v2, s[64:67], s30 offen offset:3072 lds
v_add_u32 v2, 0x40000, v2
v_mfma_f32_16x16x32_bf16 v[80:83], v[96:99], v[196:199], v[80:83]
buffer_load_dwordx4 v[160:163], v3, s[88:91], s32 offen
v_mfma_f32_16x16x32_bf16 v[84:87], v[100:103], v[196:199], v[84:87]
buffer_load_dwordx4 v[164:167], v3, s[88:91], s32 offen offset:1024
v_mfma_f32_16x16x32_bf16 v[68:71], v[100:103], v[192:195], v[68:71]
s_waitcnt lgkmcnt(0)
v_mfma_f32_16x16x32_bf16 v[56:59], v[104:107], v[200:203], v[56:59]
ds_read_b64_tr_b16 v[88:89], v4 offset:40960
ds_read_b64_tr_b16 v[90:91], v4 offset:43008
v_mfma_f32_16x16x32_bf16 v[72:75], v[104:107], v[204:207], v[72:75]
ds_read_b64_tr_b16 v[92:93], v5 offset:40960
ds_read_b64_tr_b16 v[94:95], v5 offset:43008
v_mfma_f32_16x16x32_bf16 v[76:79], v[108:111], v[204:207], v[76:79]
ds_read_b64_tr_b16 v[96:97], v6 offset:40960
ds_read_b64_tr_b16 v[98:99], v6 offset:43008
v_mfma_f32_16x16x32_bf16 v[60:63], v[108:111], v[200:203], v[60:63]
ds_read_b64_tr_b16 v[100:101], v7 offset:40960
ds_read_b64_tr_b16 v[102:103], v7 offset:43008
s_add_u32 s32, s32, 0x2000
v_mfma_f32_16x16x32_bf16 v[64:67], v[112:115], v[200:203], v[64:67]
buffer_load_dwordx4 v[168:171], v3, s[88:91], s32 offen
v_mfma_f32_16x16x32_bf16 v[80:83], v[112:115], v[204:207], v[80:83]
buffer_load_dwordx4 v[172:175], v3, s[88:91], s32 offen offset:1024
s_add_u32 s32, s32, 0x2000
v_mfma_f32_16x16x32_bf16 v[84:87], v[116:119], v[204:207], v[84:87]
buffer_load_dwordx4 v[176:179], v3, s[88:91], s32 offen
v_mfma_f32_16x16x32_bf16 v[68:71], v[116:119], v[200:203], v[68:71]
s_waitcnt lgkmcnt(0)
v_mfma_f32_16x16x32_bf16 v[56:59], v[88:91], v[208:211], v[56:59]
ds_read_b64_tr_b16 v[104:105], v4 offset:45056
ds_read_b64_tr_b16 v[106:107], v4 offset:47104
v_mfma_f32_16x16x32_bf16 v[72:75], v[88:91], v[212:215], v[72:75]
ds_read_b64_tr_b16 v[108:109], v5 offset:45056
ds_read_b64_tr_b16 v[110:111], v5 offset:47104
v_mfma_f32_16x16x32_bf16 v[76:79], v[92:95], v[212:215], v[76:79]
ds_read_b64_tr_b16 v[112:113], v6 offset:45056
ds_read_b64_tr_b16 v[114:115], v6 offset:47104
v_mfma_f32_16x16x32_bf16 v[60:63], v[92:95], v[208:211], v[60:63]
ds_read_b64_tr_b16 v[116:117], v7 offset:45056
ds_read_b64_tr_b16 v[118:119], v7 offset:47104
v_mfma_f32_16x16x32_bf16 v[64:67], v[96:99], v[208:211], v[64:67]
buffer_load_dwordx4 v[180:183], v3, s[88:91], s32 offen offset:1024
s_add_u32 s32, s32, 0x2000
v_mfma_f32_16x16x32_bf16 v[80:83], v[96:99], v[212:215], v[80:83]
buffer_load_dwordx4 v[184:187], v3, s[88:91], s32 offen
v_mfma_f32_16x16x32_bf16 v[84:87], v[100:103], v[212:215], v[84:87]
buffer_load_dwordx4 v[188:191], v3, s[88:91], s32 offen offset:1024
v_mfma_f32_16x16x32_bf16 v[68:71], v[100:103], v[208:211], v[68:71]
s_add_u32 s32, s32, 0x2000
s_waitcnt vmcnt(24) lgkmcnt(0)
s_barrier
v_mfma_f32_16x16x32_bf16 v[56:59], v[104:107], v[216:219], v[56:59]
ds_read_b64_tr_b16 v[88:89], v4 offset:49152
ds_read_b64_tr_b16 v[90:91], v4 offset:51200
v_mfma_f32_16x16x32_bf16 v[72:75], v[104:107], v[220:223], v[72:75]
ds_read_b64_tr_b16 v[92:93], v5 offset:49152
ds_read_b64_tr_b16 v[94:95], v5 offset:51200
v_mfma_f32_16x16x32_bf16 v[76:79], v[108:111], v[220:223], v[76:79]
ds_read_b64_tr_b16 v[96:97], v6 offset:49152
ds_read_b64_tr_b16 v[98:99], v6 offset:51200
v_mfma_f32_16x16x32_bf16 v[60:63], v[108:111], v[216:219], v[60:63]
ds_read_b64_tr_b16 v[100:101], v7 offset:49152
ds_read_b64_tr_b16 v[102:103], v7 offset:51200
s_add_u32 m0, s17, 0x8000
v_mfma_f32_16x16x32_bf16 v[64:67], v[112:115], v[216:219], v[64:67]
buffer_load_dwordx4 v2, s[64:67], 0 offen lds
v_mfma_f32_16x16x32_bf16 v[80:83], v[112:115], v[220:223], v[80:83]
buffer_load_dwordx4 v2, s[64:67], s28 offen offset:1024 lds
v_mfma_f32_16x16x32_bf16 v[84:87], v[116:119], v[220:223], v[84:87]
buffer_load_dwordx4 v2, s[64:67], s29 offen offset:2048 lds
v_mfma_f32_16x16x32_bf16 v[68:71], v[116:119], v[216:219], v[68:71]
s_waitcnt lgkmcnt(0)
v_mfma_f32_16x16x32_bf16 v[56:59], v[88:91], v[224:227], v[56:59]
ds_read_b64_tr_b16 v[104:105], v4 offset:53248
ds_read_b64_tr_b16 v[106:107], v4 offset:55296
v_mfma_f32_16x16x32_bf16 v[72:75], v[88:91], v[228:231], v[72:75]
ds_read_b64_tr_b16 v[108:109], v5 offset:53248
ds_read_b64_tr_b16 v[110:111], v5 offset:55296
v_mfma_f32_16x16x32_bf16 v[76:79], v[92:95], v[228:231], v[76:79]
ds_read_b64_tr_b16 v[112:113], v6 offset:53248
ds_read_b64_tr_b16 v[114:115], v6 offset:55296
v_mfma_f32_16x16x32_bf16 v[60:63], v[92:95], v[224:227], v[60:63]
ds_read_b64_tr_b16 v[116:117], v7 offset:53248
ds_read_b64_tr_b16 v[118:119], v7 offset:55296
v_mfma_f32_16x16x32_bf16 v[64:67], v[96:99], v[224:227], v[64:67]
buffer_load_dwordx4 v2, s[64:67], s30 offen offset:3072 lds
v_add_u32 v2, 0x40000, v2
v_mfma_f32_16x16x32_bf16 v[80:83], v[96:99], v[228:231], v[80:83]
buffer_load_dwordx4 v[192:195], v3, s[88:91], s32 offen
v_mfma_f32_16x16x32_bf16 v[84:87], v[100:103], v[228:231], v[84:87]
buffer_load_dwordx4 v[196:199], v3, s[88:91], s32 offen offset:1024
v_mfma_f32_16x16x32_bf16 v[68:71], v[100:103], v[224:227], v[68:71]
s_waitcnt lgkmcnt(0)
v_mfma_f32_16x16x32_bf16 v[56:59], v[104:107], v[232:235], v[56:59]
ds_read_b64_tr_b16 v[88:89], v4 offset:57344
ds_read_b64_tr_b16 v[90:91], v4 offset:59392
v_mfma_f32_16x16x32_bf16 v[72:75], v[104:107], v[236:239], v[72:75]
ds_read_b64_tr_b16 v[92:93], v5 offset:57344
ds_read_b64_tr_b16 v[94:95], v5 offset:59392
v_mfma_f32_16x16x32_bf16 v[76:79], v[108:111], v[236:239], v[76:79]
ds_read_b64_tr_b16 v[96:97], v6 offset:57344
ds_read_b64_tr_b16 v[98:99], v6 offset:59392
v_mfma_f32_16x16x32_bf16 v[60:63], v[108:111], v[232:235], v[60:63]
ds_read_b64_tr_b16 v[100:101], v7 offset:57344
ds_read_b64_tr_b16 v[102:103], v7 offset:59392
s_add_u32 s32, s32, 0x2000
v_mfma_f32_16x16x32_bf16 v[64:67], v[112:115], v[232:235], v[64:67]
buffer_load_dwordx4 v[200:203], v3, s[88:91], s32 offen
v_mfma_f32_16x16x32_bf16 v[80:83], v[112:115], v[236:239], v[80:83]
buffer_load_dwordx4 v[204:207], v3, s[88:91], s32 offen offset:1024
s_add_u32 s32, s32, 0x2000
v_mfma_f32_16x16x32_bf16 v[84:87], v[116:119], v[236:239], v[84:87]
buffer_load_dwordx4 v[208:211], v3, s[88:91], s32 offen
v_mfma_f32_16x16x32_bf16 v[68:71], v[116:119], v[232:235], v[68:71]
s_waitcnt lgkmcnt(0)
v_mfma_f32_16x16x32_bf16 v[56:59], v[88:91], v[240:243], v[56:59]
ds_read_b64_tr_b16 v[104:105], v4 offset:61440
ds_read_b64_tr_b16 v[106:107], v4 offset:63488
v_mfma_f32_16x16x32_bf16 v[72:75], v[88:91], v[244:247], v[72:75]
ds_read_b64_tr_b16 v[108:109], v5 offset:61440
ds_read_b64_tr_b16 v[110:111], v5 offset:63488
v_mfma_f32_16x16x32_bf16 v[76:79], v[92:95], v[244:247], v[76:79]
ds_read_b64_tr_b16 v[112:113], v6 offset:61440
ds_read_b64_tr_b16 v[114:115], v6 offset:63488
v_mfma_f32_16x16x32_bf16 v[60:63], v[92:95], v[240:243], v[60:63]
ds_read_b64_tr_b16 v[116:117], v7 offset:61440
ds_read_b64_tr_b16 v[118:119], v7 offset:63488
v_mfma_f32_16x16x32_bf16 v[64:67], v[96:99], v[240:243], v[64:67]
buffer_load_dwordx4 v[212:215], v3, s[88:91], s32 offen offset:1024
s_add_u32 s32, s32, 0x2000
v_mfma_f32_16x16x32_bf16 v[80:83], v[96:99], v[244:247], v[80:83]
buffer_load_dwordx4 v[216:219], v3, s[88:91], s32 offen
v_mfma_f32_16x16x32_bf16 v[84:87], v[100:103], v[244:247], v[84:87]
buffer_load_dwordx4 v[220:223], v3, s[88:91], s32 offen offset:1024
v_mfma_f32_16x16x32_bf16 v[68:71], v[100:103], v[240:243], v[68:71]
s_add_u32 s32, s32, 0x2000
s_waitcnt vmcnt(24) lgkmcnt(0)
s_barrier
v_mfma_f32_16x16x32_bf16 v[56:59], v[104:107], v[248:251], v[56:59]
ds_read_b64_tr_b16 v[88:89], v4 offset:0
ds_read_b64_tr_b16 v[90:91], v4 offset:2048
v_mfma_f32_16x16x32_bf16 v[72:75], v[104:107], v[252:255], v[72:75]
ds_read_b64_tr_b16 v[92:93], v5 offset:0
ds_read_b64_tr_b16 v[94:95], v5 offset:2048
v_mfma_f32_16x16x32_bf16 v[76:79], v[108:111], v[252:255], v[76:79]
ds_read_b64_tr_b16 v[96:97], v6 offset:0
ds_read_b64_tr_b16 v[98:99], v6 offset:2048
v_mfma_f32_16x16x32_bf16 v[60:63], v[108:111], v[248:251], v[60:63]
ds_read_b64_tr_b16 v[100:101], v7 offset:0
ds_read_b64_tr_b16 v[102:103], v7 offset:2048
s_add_u32 m0, s17, 0xc000
v_mfma_f32_16x16x32_bf16 v[64:67], v[112:115], v[248:251], v[64:67]
buffer_load_dwordx4 v2, s[64:67], 0 offen lds
v_mfma_f32_16x16x32_bf16 v[80:83], v[112:115], v[252:255], v[80:83]
buffer_load_dwordx4 v2, s[64:67], s28 offen offset:1024 lds
v_mfma_f32_16x16x32_bf16 v[84:87], v[116:119], v[252:255], v[84:87]
buffer_load_dwordx4 v2, s[64:67], s29 offen offset:2048 lds
v_mfma_f32_16x16x32_bf16 v[68:71], v[116:119], v[248:251], v[68:71]
s_waitcnt lgkmcnt(0)
v_mfma_f32_16x16x32_bf16 v[56:59], v[88:91], v[128:131], v[56:59]
ds_read_b64_tr_b16 v[104:105], v4 offset:4096
ds_read_b64_tr_b16 v[106:107], v4 offset:6144
v_mfma_f32_16x16x32_bf16 v[72:75], v[88:91], v[132:135], v[72:75]
ds_read_b64_tr_b16 v[108:109], v5 offset:4096
ds_read_b64_tr_b16 v[110:111], v5 offset:6144
v_mfma_f32_16x16x32_bf16 v[76:79], v[92:95], v[132:135], v[76:79]
ds_read_b64_tr_b16 v[112:113], v6 offset:4096
ds_read_b64_tr_b16 v[114:115], v6 offset:6144
v_mfma_f32_16x16x32_bf16 v[60:63], v[92:95], v[128:131], v[60:63]
ds_read_b64_tr_b16 v[116:117], v7 offset:4096
ds_read_b64_tr_b16 v[118:119], v7 offset:6144
v_mfma_f32_16x16x32_bf16 v[64:67], v[96:99], v[128:131], v[64:67]
buffer_load_dwordx4 v2, s[64:67], s30 offen offset:3072 lds
v_add_u32 v2, 0x40000, v2
v_mfma_f32_16x16x32_bf16 v[80:83], v[96:99], v[132:135], v[80:83]
buffer_load_dwordx4 v[224:227], v3, s[88:91], s32 offen
v_mfma_f32_16x16x32_bf16 v[84:87], v[100:103], v[132:135], v[84:87]
buffer_load_dwordx4 v[228:231], v3, s[88:91], s32 offen offset:1024
v_mfma_f32_16x16x32_bf16 v[68:71], v[100:103], v[128:131], v[68:71]
s_waitcnt lgkmcnt(0)
v_mfma_f32_16x16x32_bf16 v[56:59], v[104:107], v[136:139], v[56:59]
ds_read_b64_tr_b16 v[88:89], v4 offset:8192
ds_read_b64_tr_b16 v[90:91], v4 offset:10240
v_mfma_f32_16x16x32_bf16 v[72:75], v[104:107], v[140:143], v[72:75]
ds_read_b64_tr_b16 v[92:93], v5 offset:8192
ds_read_b64_tr_b16 v[94:95], v5 offset:10240
v_mfma_f32_16x16x32_bf16 v[76:79], v[108:111], v[140:143], v[76:79]
ds_read_b64_tr_b16 v[96:97], v6 offset:8192
ds_read_b64_tr_b16 v[98:99], v6 offset:10240
v_mfma_f32_16x16x32_bf16 v[60:63], v[108:111], v[136:139], v[60:63]
ds_read_b64_tr_b16 v[100:101], v7 offset:8192
ds_read_b64_tr_b16 v[102:103], v7 offset:10240
s_add_u32 s32, s32, 0x2000
v_mfma_f32_16x16x32_bf16 v[64:67], v[112:115], v[136:139], v[64:67]
buffer_load_dwordx4 v[232:235], v3, s[88:91], s32 offen
v_mfma_f32_16x16x32_bf16 v[80:83], v[112:115], v[140:143], v[80:83]
buffer_load_dwordx4 v[236:239], v3, s[88:91], s32 offen offset:1024
s_add_u32 s32, s32, 0x2000
v_mfma_f32_16x16x32_bf16 v[84:87], v[116:119], v[140:143], v[84:87]
buffer_load_dwordx4 v[240:243], v3, s[88:91], s32 offen
v_mfma_f32_16x16x32_bf16 v[68:71], v[116:119], v[136:139], v[68:71]
s_waitcnt lgkmcnt(0)
v_mfma_f32_16x16x32_bf16 v[56:59], v[88:91], v[144:147], v[56:59]
ds_read_b64_tr_b16 v[104:105], v4 offset:12288
ds_read_b64_tr_b16 v[106:107], v4 offset:14336
v_mfma_f32_16x16x32_bf16 v[72:75], v[88:91], v[148:151], v[72:75]
ds_read_b64_tr_b16 v[108:109], v5 offset:12288
ds_read_b64_tr_b16 v[110:111], v5 offset:14336
v_mfma_f32_16x16x32_bf16 v[76:79], v[92:95], v[148:151], v[76:79]
ds_read_b64_tr_b16 v[112:113], v6 offset:12288
ds_read_b64_tr_b16 v[114:115], v6 offset:14336
v_mfma_f32_16x16x32_bf16 v[60:63], v[92:95], v[144:147], v[60:63]
ds_read_b64_tr_b16 v[116:117], v7 offset:12288
ds_read_b64_tr_b16 v[118:119], v7 offset:14336
v_mfma_f32_16x16x32_bf16 v[64:67], v[96:99], v[144:147], v[64:67]
buffer_load_dwordx4 v[244:247], v3, s[88:91], s32 offen offset:1024
s_add_u32 s32, s32, 0x2000
v_mfma_f32_16x16x32_bf16 v[80:83], v[96:99], v[148:151], v[80:83]
buffer_load_dwordx4 v[248:251], v3, s[88:91], s32 offen
v_mfma_f32_16x16x32_bf16 v[84:87], v[100:103], v[148:151], v[84:87]
buffer_load_dwordx4 v[252:255], v3, s[88:91], s32 offen offset:1024
v_mfma_f32_16x16x32_bf16 v[68:71], v[100:103], v[144:147], v[68:71]
s_add_u32 s32, s32, 0x2000
s_sub_u32 s15, s15, 1
s_cmp_lg_u32 s15, 0
s_cbranch_scc1 L_p4_loop
s_waitcnt vmcnt(24) lgkmcnt(0)
s_barrier
v_mfma_f32_16x16x32_bf16 v[56:59], v[104:107], v[152:155], v[56:59]
ds_read_b64_tr_b16 v[88:89], v4 offset:16384
ds_read_b64_tr_b16 v[90:91], v4 offset:18432
v_mfma_f32_16x16x32_bf16 v[72:75], v[104:107], v[156:159], v[72:75]
ds_read_b64_tr_b16 v[92:93], v5 offset:16384
ds_read_b64_tr_b16 v[94:95], v5 offset:18432
v_mfma_f32_16x16x32_bf16 v[76:79], v[108:111], v[156:159], v[76:79]
ds_read_b64_tr_b16 v[96:97], v6 offset:16384
ds_read_b64_tr_b16 v[98:99], v6 offset:18432
v_mfma_f32_16x16x32_bf16 v[60:63], v[108:111], v[152:155], v[60:63]
ds_read_b64_tr_b16 v[100:101], v7 offset:16384
ds_read_b64_tr_b16 v[102:103], v7 offset:18432
v_mfma_f32_16x16x32_bf16 v[64:67], v[112:115], v[152:155], v[64:67]
v_mfma_f32_16x16x32_bf16 v[80:83], v[112:115], v[156:159], v[80:83]
v_mfma_f32_16x16x32_bf16 v[84:87], v[116:119], v[156:159], v[84:87]
v_mfma_f32_16x16x32_bf16 v[68:71], v[116:119], v[152:155], v[68:71]
s_waitcnt lgkmcnt(0)
v_mfma_f32_16x16x32_bf16 v[56:59], v[88:91], v[160:163], v[56:59]
ds_read_b64_tr_b16 v[104:105], v4 offset:20480
ds_read_b64_tr_b16 v[106:107], v4 offset:22528
v_mfma_f32_16x16x32_bf16 v[72:75], v[88:91], v[164:167], v[72:75]
ds_read_b64_tr_b16 v[108:109], v5 offset:20480
ds_read_b64_tr_b16 v[110:111], v5 offset:22528
v_mfma_f32_16x16x32_bf16 v[76:79], v[92:95], v[164:167], v[76:79]
ds_read_b64_tr_b16 v[112:113], v6 offset:20480
ds_read_b64_tr_b16 v[114:115], v6 offset:22528
v_mfma_f32_16x16x32_bf16 v[60:63], v[92:95], v[160:163], v[60:63]
ds_read_b64_tr_b16 v[116:117], v7 offset:20480
ds_read_b64_tr_b16 v[118:119], v7 offset:22528
v_mfma_f32_16x16x32_bf16 v[64:67], v[96:99], v[160:163], v[64:67]
v_mfma_f32_16x16x32_bf16 v[80:83], v[96:99], v[164:167], v[80:83]
v_mfma_f32_16x16x32_bf16 v[84:87], v[100:103], v[164:167], v[84:87]
v_mfma_f32_16x16x32_bf16 v[68:71], v[100:103], v[160:163], v[68:71]
s_waitcnt lgkmcnt(0)
v_mfma_f32_16x16x32_bf16 v[56:59], v[104:107], v[168:171], v[56:59]
ds_read_b64_tr_b16 v[88:89], v4 offset:24576
ds_read_b64_tr_b16 v[90:91], v4 offset:26624
v_mfma_f32_16x16x32_bf16 v[72:75], v[104:107], v[172:175], v[72:75]
ds_read_b64_tr_b16 v[92:93], v5 offset:24576
ds_read_b64_tr_b16 v[94:95], v5 offset:26624
v_mfma_f32_16x16x32_bf16 v[76:79], v[108:111], v[172:175], v[76:79]
ds_read_b64_tr_b16 v[96:97], v6 offset:24576
ds_read_b64_tr_b16 v[98:99], v6 offset:26624
v_mfma_f32_16x16x32_bf16 v[60:63], v[108:111], v[168:171], v[60:63]
ds_read_b64_tr_b16 v[100:101], v7 offset:24576
ds_read_b64_tr_b16 v[102:103], v7 offset:26624
v_mfma_f32_16x16x32_bf16 v[64:67], v[112:115], v[168:171], v[64:67]
v_mfma_f32_16x16x32_bf16 v[80:83], v[112:115], v[172:175], v[80:83]
v_mfma_f32_16x16x32_bf16 v[84:87], v[116:119], v[172:175], v[84:87]
v_mfma_f32_16x16x32_bf16 v[68:71], v[116:119], v[168:171], v[68:71]
s_waitcnt lgkmcnt(0)
v_mfma_f32_16x16x32_bf16 v[56:59], v[88:91], v[176:179], v[56:59]
ds_read_b64_tr_b16 v[104:105], v4 offset:28672
ds_read_b64_tr_b16 v[106:107], v4 offset:30720
v_mfma_f32_16x16x32_bf16 v[72:75], v[88:91], v[180:183], v[72:75]
ds_read_b64_tr_b16 v[108:109], v5 offset:28672
ds_read_b64_tr_b16 v[110:111], v5 offset:30720
v_mfma_f32_16x16x32_bf16 v[76:79], v[92:95], v[180:183], v[76:79]
ds_read_b64_tr_b16 v[112:113], v6 offset:28672
ds_read_b64_tr_b16 v[114:115], v6 offset:30720
v_mfma_f32_16x16x32_bf16 v[60:63], v[92:95], v[176:179], v[60:63]
ds_read_b64_tr_b16 v[116:117], v7 offset:28672
ds_read_b64_tr_b16 v[118:119], v7 offset:30720
v_mfma_f32_16x16x32_bf16 v[64:67], v[96:99], v[176:179], v[64:67]
v_mfma_f32_16x16x32_bf16 v[80:83], v[96:99], v[180:183], v[80:83]
v_mfma_f32_16x16x32_bf16 v[84:87], v[100:103], v[180:183], v[84:87]
v_mfma_f32_16x16x32_bf16 v[68:71], v[100:103], v[176:179], v[68:71]
s_lshl_b32 s8, s20, 7
s_lshl_b32 s9, s4, 5
s_add_u32 s8, s8, s9
s_lshl_b32 s9, s8, 2
s_add_u32 s9, s9, 0x3600000
v_and_b32 v17, 15, v0
v_lshlrev_b32 v18, 2, v17
buffer_load_dword v8, v18, s[88:91], s9 offen
buffer_load_dword v9, v18, s[88:91], s9 offen offset:64
v_lshrrev_b32 v18, 4, v0
v_lshlrev_b32 v18, 3, v18
v_lshl_add_u32 v17, v17, 11, v18
s_lshl_b32 s8, s8, 11
s_lshl_b32 s9, s21, 7
s_add_u32 s8, s8, s9
s_add_u32 s9, s8, 0x8000
s_waitcnt vmcnt(14) lgkmcnt(0)
s_barrier
v_mfma_f32_16x16x32_bf16 v[56:59], v[104:107], v[184:187], v[56:59]
ds_read_b64_tr_b16 v[88:89], v4 offset:32768
ds_read_b64_tr_b16 v[90:91], v4 offset:34816
v_mfma_f32_16x16x32_bf16 v[72:75], v[104:107], v[188:191], v[72:75]
ds_read_b64_tr_b16 v[92:93], v5 offset:32768
ds_read_b64_tr_b16 v[94:95], v5 offset:34816
v_mfma_f32_16x16x32_bf16 v[76:79], v[108:111], v[188:191], v[76:79]
ds_read_b64_tr_b16 v[96:97], v6 offset:32768
ds_read_b64_tr_b16 v[98:99], v6 offset:34816
v_mfma_f32_16x16x32_bf16 v[60:63], v[108:111], v[184:187], v[60:63]
ds_read_b64_tr_b16 v[100:101], v7 offset:32768
ds_read_b64_tr_b16 v[102:103], v7 offset:34816
v_mfma_f32_16x16x32_bf16 v[64:67], v[112:115], v[184:187], v[64:67]
v_mfma_f32_16x16x32_bf16 v[80:83], v[112:115], v[188:191], v[80:83]
v_mfma_f32_16x16x32_bf16 v[84:87], v[116:119], v[188:191], v[84:87]
v_mfma_f32_16x16x32_bf16 v[68:71], v[116:119], v[184:187], v[68:71]
s_waitcnt lgkmcnt(0)
v_mfma_f32_16x16x32_bf16 v[56:59], v[88:91], v[192:195], v[56:59]
ds_read_b64_tr_b16 v[104:105], v4 offset:36864
ds_read_b64_tr_b16 v[106:107], v4 offset:38912
v_mfma_f32_16x16x32_bf16 v[72:75], v[88:91], v[196:199], v[72:75]
ds_read_b64_tr_b16 v[108:109], v5 offset:36864
ds_read_b64_tr_b16 v[110:111], v5 offset:38912
v_mfma_f32_16x16x32_bf16 v[76:79], v[92:95], v[196:199], v[76:79]
ds_read_b64_tr_b16 v[112:113], v6 offset:36864
ds_read_b64_tr_b16 v[114:115], v6 offset:38912
v_mfma_f32_16x16x32_bf16 v[60:63], v[92:95], v[192:195], v[60:63]
ds_read_b64_tr_b16 v[116:117], v7 offset:36864
ds_read_b64_tr_b16 v[118:119], v7 offset:38912
v_mfma_f32_16x16x32_bf16 v[64:67], v[96:99], v[192:195], v[64:67]
v_mfma_f32_16x16x32_bf16 v[80:83], v[96:99], v[196:199], v[80:83]
v_mfma_f32_16x16x32_bf16 v[84:87], v[100:103], v[196:199], v[84:87]
v_mfma_f32_16x16x32_bf16 v[68:71], v[100:103], v[192:195], v[68:71]
s_waitcnt lgkmcnt(0)
v_mfma_f32_16x16x32_bf16 v[56:59], v[104:107], v[200:203], v[56:59]
ds_read_b64_tr_b16 v[88:89], v4 offset:40960
ds_read_b64_tr_b16 v[90:91], v4 offset:43008
v_mfma_f32_16x16x32_bf16 v[72:75], v[104:107], v[204:207], v[72:75]
ds_read_b64_tr_b16 v[92:93], v5 offset:40960
ds_read_b64_tr_b16 v[94:95], v5 offset:43008
v_mfma_f32_16x16x32_bf16 v[76:79], v[108:111], v[204:207], v[76:79]
ds_read_b64_tr_b16 v[96:97], v6 offset:40960
ds_read_b64_tr_b16 v[98:99], v6 offset:43008
v_mfma_f32_16x16x32_bf16 v[60:63], v[108:111], v[200:203], v[60:63]
ds_read_b64_tr_b16 v[100:101], v7 offset:40960
ds_read_b64_tr_b16 v[102:103], v7 offset:43008
v_mfma_f32_16x16x32_bf16 v[64:67], v[112:115], v[200:203], v[64:67]
v_mfma_f32_16x16x32_bf16 v[80:83], v[112:115], v[204:207], v[80:83]
v_mfma_f32_16x16x32_bf16 v[84:87], v[116:119], v[204:207], v[84:87]
v_mfma_f32_16x16x32_bf16 v[68:71], v[116:119], v[200:203], v[68:71]
s_waitcnt lgkmcnt(0)
v_mfma_f32_16x16x32_bf16 v[56:59], v[88:91], v[208:211], v[56:59]
ds_read_b64_tr_b16 v[104:105], v4 offset:45056
ds_read_b64_tr_b16 v[106:107], v4 offset:47104
v_mfma_f32_16x16x32_bf16 v[72:75], v[88:91], v[212:215], v[72:75]
ds_read_b64_tr_b16 v[108:109], v5 offset:45056
ds_read_b64_tr_b16 v[110:111], v5 offset:47104
v_mfma_f32_16x16x32_bf16 v[76:79], v[92:95], v[212:215], v[76:79]
ds_read_b64_tr_b16 v[112:113], v6 offset:45056
ds_read_b64_tr_b16 v[114:115], v6 offset:47104
v_mfma_f32_16x16x32_bf16 v[60:63], v[92:95], v[208:211], v[60:63]
ds_read_b64_tr_b16 v[116:117], v7 offset:45056
ds_read_b64_tr_b16 v[118:119], v7 offset:47104
v_mfma_f32_16x16x32_bf16 v[64:67], v[96:99], v[208:211], v[64:67]
v_mfma_f32_16x16x32_bf16 v[80:83], v[96:99], v[212:215], v[80:83]
v_mfma_f32_16x16x32_bf16 v[84:87], v[100:103], v[212:215], v[84:87]
v_mfma_f32_16x16x32_bf16 v[68:71], v[100:103], v[208:211], v[68:71]
s_waitcnt vmcnt(2) lgkmcnt(0)
s_barrier
v_mfma_f32_16x16x32_bf16 v[56:59], v[104:107], v[216:219], v[56:59]
ds_read_b64_tr_b16 v[88:89], v4 offset:49152
ds_read_b64_tr_b16 v[90:91], v4 offset:51200
v_mfma_f32_16x16x32_bf16 v[72:75], v[104:107], v[220:223], v[72:75]
ds_read_b64_tr_b16 v[92:93], v5 offset:49152
ds_read_b64_tr_b16 v[94:95], v5 offset:51200
v_mfma_f32_16x16x32_bf16 v[76:79], v[108:111], v[220:223], v[76:79]
ds_read_b64_tr_b16 v[96:97], v6 offset:49152
ds_read_b64_tr_b16 v[98:99], v6 offset:51200
v_mfma_f32_16x16x32_bf16 v[60:63], v[108:111], v[216:219], v[60:63]
ds_read_b64_tr_b16 v[100:101], v7 offset:49152
ds_read_b64_tr_b16 v[102:103], v7 offset:51200
v_mfma_f32_16x16x32_bf16 v[64:67], v[112:115], v[216:219], v[64:67]
v_mfma_f32_16x16x32_bf16 v[80:83], v[112:115], v[220:223], v[80:83]
v_mfma_f32_16x16x32_bf16 v[84:87], v[116:119], v[220:223], v[84:87]
v_mfma_f32_16x16x32_bf16 v[68:71], v[116:119], v[216:219], v[68:71]
s_waitcnt lgkmcnt(0)
v_mfma_f32_16x16x32_bf16 v[56:59], v[88:91], v[224:227], v[56:59]
ds_read_b64_tr_b16 v[104:105], v4 offset:53248
ds_read_b64_tr_b16 v[106:107], v4 offset:55296
v_mfma_f32_16x16x32_bf16 v[72:75], v[88:91], v[228:231], v[72:75]
ds_read_b64_tr_b16 v[108:109], v5 offset:53248
ds_read_b64_tr_b16 v[110:111], v5 offset:55296
v_mfma_f32_16x16x32_bf16 v[76:79], v[92:95], v[228:231], v[76:79]
ds_read_b64_tr_b16 v[112:113], v6 offset:53248
ds_read_b64_tr_b16 v[114:115], v6 offset:55296
v_mfma_f32_16x16x32_bf16 v[60:63], v[92:95], v[224:227], v[60:63]
ds_read_b64_tr_b16 v[116:117], v7 offset:53248
ds_read_b64_tr_b16 v[118:119], v7 offset:55296
v_mfma_f32_16x16x32_bf16 v[64:67], v[96:99], v[224:227], v[64:67]
v_mfma_f32_16x16x32_bf16 v[80:83], v[96:99], v[228:231], v[80:83]
v_mfma_f32_16x16x32_bf16 v[84:87], v[100:103], v[228:231], v[84:87]
v_mfma_f32_16x16x32_bf16 v[68:71], v[100:103], v[224:227], v[68:71]
s_waitcnt lgkmcnt(0)
v_mfma_f32_16x16x32_bf16 v[56:59], v[104:107], v[232:235], v[56:59]
ds_read_b64_tr_b16 v[88:89], v4 offset:57344
ds_read_b64_tr_b16 v[90:91], v4 offset:59392
v_mfma_f32_16x16x32_bf16 v[72:75], v[104:107], v[236:239], v[72:75]
ds_read_b64_tr_b16 v[92:93], v5 offset:57344
ds_read_b64_tr_b16 v[94:95], v5 offset:59392
v_mfma_f32_16x16x32_bf16 v[76:79], v[108:111], v[236:239], v[76:79]
ds_read_b64_tr_b16 v[96:97], v6 offset:57344
ds_read_b64_tr_b16 v[98:99], v6 offset:59392
v_mfma_f32_16x16x32_bf16 v[60:63], v[108:111], v[232:235], v[60:63]
ds_read_b64_tr_b16 v[100:101], v7 offset:57344
ds_read_b64_tr_b16 v[102:103], v7 offset:59392
v_mfma_f32_16x16x32_bf16 v[64:67], v[112:115], v[232:235], v[64:67]
v_mfma_f32_16x16x32_bf16 v[80:83], v[112:115], v[236:239], v[80:83]
v_mfma_f32_16x16x32_bf16 v[84:87], v[116:119], v[236:239], v[84:87]
v_mfma_f32_16x16x32_bf16 v[68:71], v[116:119], v[232:235], v[68:71]
s_waitcnt lgkmcnt(0)
v_mfma_f32_16x16x32_bf16 v[56:59], v[88:91], v[240:243], v[56:59]
ds_read_b64_tr_b16 v[104:105], v4 offset:61440
ds_read_b64_tr_b16 v[106:107], v4 offset:63488
v_mfma_f32_16x16x32_bf16 v[72:75], v[88:91], v[244:247], v[72:75]
ds_read_b64_tr_b16 v[108:109], v5 offset:61440
ds_read_b64_tr_b16 v[110:111], v5 offset:63488
v_mfma_f32_16x16x32_bf16 v[76:79], v[92:95], v[244:247], v[76:79]
ds_read_b64_tr_b16 v[112:113], v6 offset:61440
ds_read_b64_tr_b16 v[114:115], v6 offset:63488
v_mfma_f32_16x16x32_bf16 v[60:63], v[92:95], v[240:243], v[60:63]
ds_read_b64_tr_b16 v[116:117], v7 offset:61440
ds_read_b64_tr_b16 v[118:119], v7 offset:63488
v_mfma_f32_16x16x32_bf16 v[64:67], v[96:99], v[240:243], v[64:67]
v_mfma_f32_16x16x32_bf16 v[80:83], v[96:99], v[244:247], v[80:83]
v_mfma_f32_16x16x32_bf16 v[84:87], v[100:103], v[244:247], v[84:87]
v_mfma_f32_16x16x32_bf16 v[68:71], v[100:103], v[240:243], v[68:71]
s_waitcnt vmcnt(0) lgkmcnt(0)
v_mfma_f32_16x16x32_bf16 v[56:59], v[104:107], v[248:251], v[56:59]
v_mfma_f32_16x16x32_bf16 v[72:75], v[104:107], v[252:255], v[72:75]
v_mfma_f32_16x16x32_bf16 v[76:79], v[108:111], v[252:255], v[76:79]
v_mfma_f32_16x16x32_bf16 v[60:63], v[108:111], v[248:251], v[60:63]
v_mfma_f32_16x16x32_bf16 v[64:67], v[112:115], v[248:251], v[64:67]
v_mfma_f32_16x16x32_bf16 v[80:83], v[112:115], v[252:255], v[80:83]
v_mfma_f32_16x16x32_bf16 v[84:87], v[116:119], v[252:255], v[84:87]
v_mfma_f32_16x16x32_bf16 v[68:71], v[116:119], v[248:251], v[68:71]
v_sub_f32 v10, 1.0, v8
v_sub_f32 v11, 1.0, v9
v_mul_f32 v24, v10, v24
v_mul_f32 v25, v10, v25
v_mul_f32 v26, v10, v26
v_mul_f32 v27, v10, v27
v_mul_f32 v28, v10, v28
v_mul_f32 v29, v10, v29
v_mul_f32 v30, v10, v30
v_mul_f32 v31, v10, v31
v_mul_f32 v32, v10, v32
v_mul_f32 v33, v10, v33
v_mul_f32 v34, v10, v34
v_mul_f32 v35, v10, v35
v_mul_f32 v36, v10, v36
v_mul_f32 v37, v10, v37
v_mul_f32 v38, v10, v38
v_mul_f32 v39, v10, v39
v_mul_f32 v40, v11, v40
v_mul_f32 v41, v11, v41
v_mul_f32 v42, v11, v42
v_mul_f32 v43, v11, v43
v_mul_f32 v44, v11, v44
v_mul_f32 v45, v11, v45
v_mul_f32 v46, v11, v46
v_mul_f32 v47, v11, v47
v_mul_f32 v48, v11, v48
v_mul_f32 v49, v11, v49
v_mul_f32 v50, v11, v50
v_mul_f32 v51, v11, v51
v_mul_f32 v52, v11, v52
v_mul_f32 v53, v11, v53
v_mul_f32 v54, v11, v54
v_mul_f32 v55, v11, v55
v_fmac_f32 v24, v8, v56
v_fmac_f32 v25, v8, v57
v_fmac_f32 v26, v8, v58
v_fmac_f32 v27, v8, v59
v_fmac_f32 v28, v8, v60
v_fmac_f32 v29, v8, v61
v_fmac_f32 v30, v8, v62
v_fmac_f32 v31, v8, v63
v_fmac_f32 v32, v8, v64
v_fmac_f32 v33, v8, v65
v_fmac_f32 v34, v8, v66
v_fmac_f32 v35, v8, v67
v_fmac_f32 v36, v8, v68
v_fmac_f32 v37, v8, v69
v_fmac_f32 v38, v8, v70
v_fmac_f32 v39, v8, v71
v_cvt_pk_bf16_f32 v24, v24, v25
v_cvt_pk_bf16_f32 v25, v26, v27
buffer_store_dwordx2 v[24:25], v17, s[80:83], s8 offen offset:0
v_cvt_pk_bf16_f32 v28, v28, v29
v_cvt_pk_bf16_f32 v29, v30, v31
buffer_store_dwordx2 v[28:29], v17, s[80:83], s8 offen offset:32
v_cvt_pk_bf16_f32 v32, v32, v33
v_cvt_pk_bf16_f32 v33, v34, v35
buffer_store_dwordx2 v[32:33], v17, s[80:83], s8 offen offset:64
v_cvt_pk_bf16_f32 v36, v36, v37
v_cvt_pk_bf16_f32 v37, v38, v39
buffer_store_dwordx2 v[36:37], v17, s[80:83], s8 offen offset:96
v_fmac_f32 v40, v9, v72
v_fmac_f32 v41, v9, v73
v_fmac_f32 v42, v9, v74
v_fmac_f32 v43, v9, v75
v_fmac_f32 v44, v9, v76
v_fmac_f32 v45, v9, v77
v_fmac_f32 v46, v9, v78
v_fmac_f32 v47, v9, v79
v_fmac_f32 v48, v9, v80
v_fmac_f32 v49, v9, v81
v_fmac_f32 v50, v9, v82
v_fmac_f32 v51, v9, v83
v_fmac_f32 v52, v9, v84
v_fmac_f32 v53, v9, v85
v_fmac_f32 v54, v9, v86
v_fmac_f32 v55, v9, v87
v_cvt_pk_bf16_f32 v40, v40, v41
v_cvt_pk_bf16_f32 v41, v42, v43
buffer_store_dwordx2 v[40:41], v17, s[80:83], s9 offen offset:0
v_cvt_pk_bf16_f32 v44, v44, v45
v_cvt_pk_bf16_f32 v45, v46, v47
buffer_store_dwordx2 v[44:45], v17, s[80:83], s9 offen offset:32
v_cvt_pk_bf16_f32 v48, v48, v49
v_cvt_pk_bf16_f32 v49, v50, v51
buffer_store_dwordx2 v[48:49], v17, s[80:83], s9 offen offset:64
v_cvt_pk_bf16_f32 v52, v52, v53
v_cvt_pk_bf16_f32 v53, v54, v55
buffer_store_dwordx2 v[52:53], v17, s[80:83], s9 offen offset:96
L_k3_end:
s_endpgm
.section .rodata,"a"
.p2align 6
.amdhsa_kernel kv_kernel
  .amdhsa_next_free_vgpr 512
  .amdhsa_next_free_sgpr 102
  .amdhsa_accum_offset 256
  .amdhsa_group_segment_fixed_size 0
  .amdhsa_kernarg_size 104
  .amdhsa_user_sgpr_count 2
  .amdhsa_user_sgpr_kernarg_segment_ptr 1
  .amdhsa_system_sgpr_workgroup_id_x 1
.end_amdhsa_kernel
.p2align 6
.amdhsa_kernel att_kernel
  .amdhsa_next_free_vgpr 512
  .amdhsa_next_free_sgpr 102
  .amdhsa_accum_offset 256
  .amdhsa_group_segment_fixed_size 0
  .amdhsa_kernarg_size 104
  .amdhsa_user_sgpr_count 2
  .amdhsa_user_sgpr_kernarg_segment_ptr 1
  .amdhsa_system_sgpr_workgroup_id_x 1
.end_amdhsa_kernel
.p2align 6
.amdhsa_kernel out_kernel
  .amdhsa_next_free_vgpr 512
  .amdhsa_next_free_sgpr 102
  .amdhsa_accum_offset 256
  .amdhsa_group_segment_fixed_size 0
  .amdhsa_kernarg_size 104
  .amdhsa_user_sgpr_count 2
  .amdhsa_user_sgpr_kernarg_segment_ptr 1
  .amdhsa_system_sgpr_workgroup_id_x 1
.end_amdhsa_kernel
```

```asm
; @launch grid=(256,1,1) block=(256,1,1) lds=163840
.amdgcn_target "amdgcn-amd-amdhsa--gfx950"
.text
.globl gated_mix__compressed_kv_cla__sliding_local_dilated__prompt_kernel
.p2align 8
.type gated_mix__compressed_kv_cla__sliding_local_dilated__prompt_kernel,@function
gated_mix__compressed_kv_cla__sliding_local_dilated__prompt_kernel:
s_cmp_ge_u32 s2, 256
s_cbranch_scc1 L_end
s_load_dwordx2 s[44:45], s[0:1], 0
s_load_dwordx2 s[48:49], s[0:1], 8
s_load_dwordx2 s[52:53], s[0:1], 16
s_load_dwordx2 s[56:57], s[0:1], 24
s_load_dwordx2 s[60:61], s[0:1], 32
s_load_dwordx2 s[64:65], s[0:1], 40
s_load_dwordx2 s[68:69], s[0:1], 56
s_load_dwordx2 s[72:73], s[0:1], 64
s_load_dwordx2 s[76:77], s[0:1], 72
s_load_dwordx2 s[80:81], s[0:1], 80
s_load_dwordx2 s[84:85], s[0:1], 88
s_load_dwordx2 s[88:89], s[0:1], 96
v_lshrrev_b32 v1, 6, v0
v_and_b32 v0, 63, v0
v_readfirstlane_b32 s4, v1
s_mov_b32 s46, 0x400000
s_mov_b32 s47, 0x20000
s_mov_b32 s50, 0x200000
s_mov_b32 s51, 0x20000
s_mov_b32 s54, 0x800000
s_mov_b32 s55, 0x20000
s_mov_b32 s58, 0x400000
s_mov_b32 s59, 0x20000
s_mov_b32 s62, 0x400000
s_mov_b32 s63, 0x20000
s_mov_b32 s66, 0x800000
s_mov_b32 s67, 0x20000
s_mov_b32 s70, 0x600000
s_mov_b32 s71, 0x20000
s_mov_b32 s74, 0x200000
s_mov_b32 s75, 0x20000
s_mov_b32 s78, 0x800
s_mov_b32 s79, 0x20000
s_mov_b32 s82, 0x400000
s_mov_b32 s83, 0x20000
s_mov_b32 s86, 0x100
s_mov_b32 s87, 0x20000
s_mov_b32 s90, 0x10000000
s_mov_b32 s91, 0x20000
s_and_b32 s5, s2, 7
s_lshl_b32 s5, s5, 2
s_bfe_u32 s3, s2, 0x20003
s_add_u32 s5, s5, s3
s_lshr_b32 s6, s2, 5
s_mov_b32 s12, 0x4000
s_mov_b32 s13, 0x8000
s_mov_b32 s14, 0xc000
s_mov_b32 s25, 0x800
s_mov_b32 s26, 0x1000
s_waitcnt lgkmcnt(0)
v_lshlrev_b32 v16, 4, v0
v_bfe_u32 v17, v0, 2, 2
s_lshl_b32 s8, s4, 4
v_add_u32 v17, s8, v17
v_lshlrev_b32 v17, 13, v17
v_lshrrev_b32 v18, 4, v0
v_lshl_add_u32 v17, v18, 6, v17
v_and_b32 v18, 3, v0
v_lshl_add_u32 v17, v18, 4, v17
s_lshl_b32 s8, s5, 8
v_add_u32 v5, s8, v17
v_xor_b32 v6, 32, v5
v_add_u32 v6, 0x10000, v6
v_lshrrev_b32 v17, 4, v0
v_xor_b32 v17, v17, v0
v_and_b32 v17, 7, v17
v_lshlrev_b32 v17, 4, v17
v_lshrrev_b32 v18, 3, v0
v_lshl_add_u32 v2, v18, 10, v17
s_lshl_b32 s8, s6, 18
s_lshl_b32 s9, s4, 16
s_add_u32 s8, s8, s9
v_add_u32 v2, s8, v2
v_xor_b32 v3, 64, v2
v_add_u32 v3, 0x2000, v3
s_lshl_b32 s16, s4, 13
s_add_u32 s16, s16, 0x18000
s_lshl_b32 s17, s4, 12
s_lshl_b32 s18, s4, 10
s_sub_u32 s8, 15, s6
s_cmp_lt_u32 s5, 16
s_cselect_b32 s8, s6, s8
s_lshl_b32 s8, s8, 4
s_and_b32 s9, s5, 15
s_add_u32 s8, s8, s9
s_lshl_b32 s8, s8, 3
s_lshl_b32 s9, s4, 1
s_add_u32 s8, s8, s9
s_lshl_b32 s9, s8, 11
s_lshl_b32 s28, s8, 2
s_add_u32 s28, s28, 0x3600000
buffer_load_dwordx4 v[24:27], v16, s[44:47], s9 offen offset:0
buffer_load_dwordx4 v[28:31], v16, s[44:47], s9 offen offset:1024
buffer_load_dwordx4 v[32:35], v16, s[44:47], s9 offen offset:2048
buffer_load_dwordx4 v[36:39], v16, s[44:47], s9 offen offset:3072
buffer_load_dwordx4 v[40:43], v16, s[76:79], 0 offen offset:0
buffer_load_dwordx4 v[44:47], v16, s[76:79], 0 offen offset:1024
s_add_u32 m0, s17, 0x0
s_nop 0
buffer_load_dwordx4 v5, s[56:59], 0 offen lds
s_add_u32 m0, s17, 0x4000
s_nop 0
buffer_load_dwordx4 v5, s[60:63], 0 offen lds
s_add_u32 m0, s17, 0x400
s_nop 0
buffer_load_dwordx4 v5, s[56:59], s13 offen lds
s_add_u32 m0, s17, 0x4400
s_nop 0
buffer_load_dwordx4 v5, s[60:63], s13 offen lds
s_add_u32 m0, s17, 0x800
s_nop 0
buffer_load_dwordx4 v6, s[56:59], 0 offen lds
s_add_u32 m0, s17, 0x4800
s_nop 0
buffer_load_dwordx4 v6, s[60:63], 0 offen lds
s_add_u32 m0, s17, 0xc00
s_nop 0
buffer_load_dwordx4 v6, s[56:59], s13 offen lds
s_add_u32 m0, s17, 0x4c00
s_nop 0
buffer_load_dwordx4 v6, s[60:63], s13 offen lds
v_add_u32 v5, 0x80000, v5
v_add_u32 v6, 0x80000, v6
s_add_u32 m0, s16, 0x0
s_nop 0
buffer_load_dwordx4 v2, s[48:51], 0 offen lds
s_add_u32 m0, s16, 0x400
s_nop 0
buffer_load_dwordx4 v3, s[48:51], 0 offen lds
s_add_u32 m0, s16, 0x800
s_nop 0
buffer_load_dwordx4 v2, s[48:51], s12 offen lds
s_add_u32 m0, s16, 0xc00
s_nop 0
buffer_load_dwordx4 v3, s[48:51], s12 offen lds
s_add_u32 m0, s16, 0x1000
s_nop 0
buffer_load_dwordx4 v2, s[48:51], s13 offen lds
s_add_u32 m0, s16, 0x1400
s_nop 0
buffer_load_dwordx4 v3, s[48:51], s13 offen lds
s_add_u32 m0, s16, 0x1800
s_nop 0
buffer_load_dwordx4 v2, s[48:51], s14 offen lds
s_add_u32 m0, s16, 0x1c00
s_nop 0
buffer_load_dwordx4 v3, s[48:51], s14 offen lds
v_add_u32 v2, 0x80, v2
v_add_u32 v3, 0x80, v3
s_add_u32 m0, s17, 0x8000
s_nop 0
buffer_load_dwordx4 v5, s[56:59], 0 offen lds
s_add_u32 m0, s17, 0xc000
s_nop 0
buffer_load_dwordx4 v5, s[60:63], 0 offen lds
s_add_u32 m0, s17, 0x8400
s_nop 0
buffer_load_dwordx4 v5, s[56:59], s13 offen lds
s_add_u32 m0, s17, 0xc400
s_nop 0
buffer_load_dwordx4 v5, s[60:63], s13 offen lds
s_add_u32 m0, s17, 0x8800
s_nop 0
buffer_load_dwordx4 v6, s[56:59], 0 offen lds
s_add_u32 m0, s17, 0xc800
s_nop 0
buffer_load_dwordx4 v6, s[60:63], 0 offen lds
s_add_u32 m0, s17, 0x8c00
s_nop 0
buffer_load_dwordx4 v6, s[56:59], s13 offen lds
s_add_u32 m0, s17, 0xcc00
s_nop 0
buffer_load_dwordx4 v6, s[60:63], s13 offen lds
v_add_u32 v5, 0x80000, v5
v_add_u32 v6, 0x80000, v6
s_add_u32 m0, s16, 0x8000
s_nop 0
buffer_load_dwordx4 v2, s[48:51], 0 offen lds
s_add_u32 m0, s16, 0x8400
s_nop 0
buffer_load_dwordx4 v3, s[48:51], 0 offen lds
s_add_u32 m0, s16, 0x8800
s_nop 0
buffer_load_dwordx4 v2, s[48:51], s12 offen lds
s_add_u32 m0, s16, 0x8c00
s_nop 0
buffer_load_dwordx4 v3, s[48:51], s12 offen lds
s_add_u32 m0, s16, 0x9000
s_nop 0
buffer_load_dwordx4 v2, s[48:51], s13 offen lds
s_add_u32 m0, s16, 0x9400
s_nop 0
buffer_load_dwordx4 v3, s[48:51], s13 offen lds
s_add_u32 m0, s16, 0x9800
s_nop 0
buffer_load_dwordx4 v2, s[48:51], s14 offen lds
s_add_u32 m0, s16, 0x9c00
s_nop 0
buffer_load_dwordx4 v3, s[48:51], s14 offen lds
v_add_u32 v2, 0x80, v2
v_add_u32 v3, 0x80, v3
s_add_u32 m0, s17, 0x10000
s_nop 0
buffer_load_dwordx4 v5, s[56:59], 0 offen lds
s_add_u32 m0, s17, 0x14000
s_nop 0
buffer_load_dwordx4 v5, s[60:63], 0 offen lds
s_add_u32 m0, s17, 0x10400
s_nop 0
buffer_load_dwordx4 v5, s[56:59], s13 offen lds
s_add_u32 m0, s17, 0x14400
s_nop 0
buffer_load_dwordx4 v5, s[60:63], s13 offen lds
s_add_u32 m0, s17, 0x10800
s_nop 0
buffer_load_dwordx4 v6, s[56:59], 0 offen lds
s_add_u32 m0, s17, 0x14800
s_nop 0
buffer_load_dwordx4 v6, s[60:63], 0 offen lds
s_add_u32 m0, s17, 0x10c00
s_nop 0
buffer_load_dwordx4 v6, s[56:59], s13 offen lds
s_add_u32 m0, s17, 0x14c00
s_nop 0
buffer_load_dwordx4 v6, s[60:63], s13 offen lds
v_add_u32 v5, 0x80000, v5
v_add_u32 v6, 0x80000, v6
v_lshrrev_b32 v17, 4, v0
v_xor_b32 v17, v17, v0
v_and_b32 v17, 7, v17
v_lshlrev_b32 v17, 4, v17
v_lshrrev_b32 v18, 3, v0
v_lshl_add_u32 v22, v18, 11, v17
v_xor_b32 v23, 64, v22
v_add_u32 v23, 0x4000, v23
s_and_b32 s8, s4, 1
s_lshl_b32 s9, s8, 6
s_lshl_b32 s8, s8, 14
v_xor_b32 v4, s9, v22
v_add_u32 v4, s8, v4
s_lshl_b32 s8, s6, 18
s_sub_u32 s9, 15, s6
s_lshl_b32 s9, s9, 18
s_lshl_b32 s10, s4, 15
s_sub_u32 s11, 0x38000, s10
s_add_u32 s20, s8, s10
s_add_u32 s21, s8, s11
s_add_u32 s22, s9, s10
s_add_u32 s23, s9, s11
s_cmp_lt_u32 s4, 2
s_cselect_b32 s24, s8, s9
s_max_u32 s24, s24, 0x8000
s_sub_u32 s24, s24, 0x8000
v_lshrrev_b32 v17, 2, v0
s_lshl_b32 s8, s4, 4
v_add_u32 v17, s8, v17
v_mul_u32_u24 v17, 0x1800, v17
v_and_b32 v18, 3, v0
v_lshlrev_b32 v18, 4, v18
v_and_b32 v19, 32, v0
v_xor_b32 v18, v18, v19
s_lshl_b32 s8, s5, 6
v_add3_u32 v7, v17, v18, s8
v_and_b32 v17, 15, v0
v_lshrrev_b32 v18, 1, v17
v_lshrrev_b32 v19, 4, v0
v_xor_b32 v18, v18, v19
v_lshlrev_b32 v18, 4, v18
v_lshl_add_u32 v10, v17, 7, v18
v_add_u32 v8, s16, v10
v_xor_b32 v9, 64, v8
s_lshr_b32 s8, s4, 1
s_lshl_b32 s8, s8, 11
s_add_u32 s8, s8, 94208
v_add_u32 v10, s8, v10
v_xor_b32 v11, 64, v10
v_lshrrev_b32 v17, 4, v0
v_lshlrev_b32 v18, 11, v17
v_and_b32 v17, 1, v17
v_lshl_add_u32 v18, v17, 5, v18
v_bfe_u32 v17, v0, 2, 2
v_lshl_add_u32 v18, v17, 6, v18
v_and_b32 v17, 3, v0
v_lshl_add_u32 v12, v17, 3, v18
v_xor_b32 v13, 32, v12
v_lshrrev_b32 v17, 4, v0
v_lshlrev_b32 v18, 9, v17
v_and_b32 v17, 1, v17
v_lshl_add_u32 v18, v17, 5, v18
v_bfe_u32 v17, v0, 2, 2
v_lshl_add_u32 v18, v17, 6, v18
v_and_b32 v17, 3, v0
v_lshl_add_u32 v14, v17, 3, v18
s_and_b32 s8, s4, 1
s_lshl_b32 s8, s8, 5
v_xor_b32 v14, s8, v14
v_add_u32 v14, 81920, v14
v_xor_b32 v15, 32, v14
s_mul_i32 s32, s5, 0x108000
s_lshl_b32 s19, s4, 13
s_add_u32 s32, s32, s19
s_add_u32 s7, s32, 0x1000
s_add_u32 s27, s19, 131072
s_cmp_lg_u32 s4, 0
s_cbranch_scc1 L_flag_clr
s_lshl_b32 s8, s6, 5
s_add_u32 s8, s8, s5
s_lshl_b32 s8, s8, 2
s_add_u32 s8, s8, 0x3604000
v_mov_b32 v17, 0
s_mov_b64 exec, 1
buffer_store_dword v17, off, s[88:91], s8 sc1
s_mov_b64 exec, -1
L_flag_clr:
s_waitcnt vmcnt(40)
v_mov_b32 v48, 0
v_mov_b32 v49, 0
v_lshlrev_b32 v50, 16, v40
v_and_b32 v51, 0xffff0000, v40
v_lshlrev_b32 v52, 16, v24
v_and_b32 v53, 0xffff0000, v24
v_fmac_f32 v48, v50, v52
v_fmac_f32 v48, v51, v53
v_lshlrev_b32 v52, 16, v32
v_and_b32 v53, 0xffff0000, v32
v_fmac_f32 v49, v50, v52
v_fmac_f32 v49, v51, v53
v_lshlrev_b32 v50, 16, v41
v_and_b32 v51, 0xffff0000, v41
v_lshlrev_b32 v52, 16, v25
v_and_b32 v53, 0xffff0000, v25
v_fmac_f32 v48, v50, v52
v_fmac_f32 v48, v51, v53
v_lshlrev_b32 v52, 16, v33
v_and_b32 v53, 0xffff0000, v33
v_fmac_f32 v49, v50, v52
v_fmac_f32 v49, v51, v53
v_lshlrev_b32 v50, 16, v42
v_and_b32 v51, 0xffff0000, v42
v_lshlrev_b32 v52, 16, v26
v_and_b32 v53, 0xffff0000, v26
v_fmac_f32 v48, v50, v52
v_fmac_f32 v48, v51, v53
v_lshlrev_b32 v52, 16, v34
v_and_b32 v53, 0xffff0000, v34
v_fmac_f32 v49, v50, v52
v_fmac_f32 v49, v51, v53
v_lshlrev_b32 v50, 16, v43
v_and_b32 v51, 0xffff0000, v43
v_lshlrev_b32 v52, 16, v27
v_and_b32 v53, 0xffff0000, v27
v_fmac_f32 v48, v50, v52
v_fmac_f32 v48, v51, v53
v_lshlrev_b32 v52, 16, v35
v_and_b32 v53, 0xffff0000, v35
v_fmac_f32 v49, v50, v52
v_fmac_f32 v49, v51, v53
v_lshlrev_b32 v50, 16, v44
v_and_b32 v51, 0xffff0000, v44
v_lshlrev_b32 v52, 16, v28
v_and_b32 v53, 0xffff0000, v28
v_fmac_f32 v48, v50, v52
v_fmac_f32 v48, v51, v53
v_lshlrev_b32 v52, 16, v36
v_and_b32 v53, 0xffff0000, v36
v_fmac_f32 v49, v50, v52
v_fmac_f32 v49, v51, v53
v_lshlrev_b32 v50, 16, v45
v_and_b32 v51, 0xffff0000, v45
v_lshlrev_b32 v52, 16, v29
v_and_b32 v53, 0xffff0000, v29
v_fmac_f32 v48, v50, v52
v_fmac_f32 v48, v51, v53
v_lshlrev_b32 v52, 16, v37
v_and_b32 v53, 0xffff0000, v37
v_fmac_f32 v49, v50, v52
v_fmac_f32 v49, v51, v53
v_lshlrev_b32 v50, 16, v46
v_and_b32 v51, 0xffff0000, v46
v_lshlrev_b32 v52, 16, v30
v_and_b32 v53, 0xffff0000, v30
v_fmac_f32 v48, v50, v52
v_fmac_f32 v48, v51, v53
v_lshlrev_b32 v52, 16, v38
v_and_b32 v53, 0xffff0000, v38
v_fmac_f32 v49, v50, v52
v_fmac_f32 v49, v51, v53
v_lshlrev_b32 v50, 16, v47
v_and_b32 v51, 0xffff0000, v47
v_lshlrev_b32 v52, 16, v31
v_and_b32 v53, 0xffff0000, v31
v_fmac_f32 v48, v50, v52
v_fmac_f32 v48, v51, v53
v_lshlrev_b32 v52, 16, v39
v_and_b32 v53, 0xffff0000, v39
v_fmac_f32 v49, v50, v52
v_fmac_f32 v49, v51, v53
s_nop 1
v_add_f32_dpp v48, v48, v48 row_ror:8 row_mask:0xf bank_mask:0xf
v_add_f32_dpp v49, v49, v49 row_ror:8 row_mask:0xf bank_mask:0xf
s_nop 1
v_add_f32_dpp v48, v48, v48 row_ror:4 row_mask:0xf bank_mask:0xf
v_add_f32_dpp v49, v49, v49 row_ror:4 row_mask:0xf bank_mask:0xf
s_nop 1
v_add_f32_dpp v48, v48, v48 row_ror:2 row_mask:0xf bank_mask:0xf
v_add_f32_dpp v49, v49, v49 row_ror:2 row_mask:0xf bank_mask:0xf
s_nop 1
v_add_f32_dpp v48, v48, v48 row_ror:1 row_mask:0xf bank_mask:0xf
v_add_f32_dpp v49, v49, v49 row_ror:1 row_mask:0xf bank_mask:0xf
v_mov_b32 v50, v48
v_mov_b32 v51, v49
s_nop 1
v_permlane16_swap_b32 v50, v48
v_permlane16_swap_b32 v51, v49
v_add_f32 v48, v48, v50
v_add_f32 v49, v49, v51
v_mov_b32 v50, v48
v_mov_b32 v51, v49
s_nop 1
v_permlane32_swap_b32 v50, v48
v_permlane32_swap_b32 v51, v49
v_add_f32 v48, v48, v50
v_add_f32 v49, v49, v51
v_mul_f32 v48, 0xbfb8aa3b, v48
v_mul_f32 v49, 0xbfb8aa3b, v49
v_exp_f32 v48, v48
v_exp_f32 v49, v49
s_nop 0
v_add_f32 v48, 1.0, v48
v_add_f32 v49, 1.0, v49
v_rcp_f32 v48, v48
v_rcp_f32 v49, v49
v_cmp_eq_u32 vcc, 0, v0
s_nop 1
s_and_saveexec_b64 s[92:93], vcc
buffer_store_dwordx2 v[48:49], v0, s[88:91], s28 offen sc1
s_mov_b64 exec, s[92:93]
s_waitcnt vmcnt(25)
s_barrier
ds_read_b128 a[0:3], v8 offset:0
ds_read_b128 a[4:7], v8 offset:2048
ds_read_b128 a[8:11], v8 offset:4096
ds_read_b128 a[12:15], v8 offset:6144
ds_read_b64_tr_b16 a[40:41], v12 offset:0
ds_read_b64_tr_b16 a[42:43], v12 offset:1024
ds_read_b64_tr_b16 a[44:45], v13 offset:0
ds_read_b64_tr_b16 a[46:47], v13 offset:1024
ds_read_b64_tr_b16 a[48:49], v12 offset:256
ds_read_b64_tr_b16 a[50:51], v12 offset:1280
ds_read_b64_tr_b16 a[52:53], v13 offset:256
ds_read_b64_tr_b16 a[54:55], v13 offset:1280
ds_read_b64_tr_b16 a[56:57], v12 offset:512
ds_read_b64_tr_b16 a[58:59], v12 offset:1536
ds_read_b64_tr_b16 a[60:61], v13 offset:512
ds_read_b64_tr_b16 a[62:63], v13 offset:1536
ds_read_b64_tr_b16 a[64:65], v12 offset:768
ds_read_b64_tr_b16 a[66:67], v12 offset:1792
ds_read_b64_tr_b16 a[68:69], v13 offset:768
ds_read_b64_tr_b16 a[70:71], v13 offset:1792
ds_read_b64_tr_b16 a[72:73], v12 offset:16384
ds_read_b64_tr_b16 a[74:75], v12 offset:17408
ds_read_b64_tr_b16 a[76:77], v13 offset:16384
ds_read_b64_tr_b16 a[78:79], v13 offset:17408
ds_read_b64_tr_b16 a[80:81], v12 offset:16640
ds_read_b64_tr_b16 a[82:83], v12 offset:17664
ds_read_b64_tr_b16 a[84:85], v13 offset:16640
ds_read_b64_tr_b16 a[86:87], v13 offset:17664
ds_read_b64_tr_b16 a[88:89], v12 offset:16896
ds_read_b64_tr_b16 a[90:91], v12 offset:17920
ds_read_b64_tr_b16 a[92:93], v13 offset:16896
ds_read_b64_tr_b16 a[94:95], v13 offset:17920
ds_read_b64_tr_b16 a[96:97], v12 offset:17152
ds_read_b64_tr_b16 a[98:99], v12 offset:18176
ds_read_b64_tr_b16 a[100:101], v13 offset:17152
ds_read_b64_tr_b16 a[102:103], v13 offset:18176
s_waitcnt lgkmcnt(0)
v_mfma_f32_16x16x32_bf16 v[24:27], a[40:43], a[0:3], 0
ds_read_b128 a[20:23], v9 offset:0
ds_read_b128 a[24:27], v9 offset:2048
v_mfma_f32_16x16x32_bf16 v[56:59], a[40:43], a[4:7], 0
ds_read_b128 a[28:31], v9 offset:4096
ds_read_b128 a[32:35], v9 offset:6144
v_mfma_f32_16x16x32_bf16 v[88:91], a[40:43], a[8:11], 0
ds_read_b64_tr_b16 a[104:105], v13 offset:25088
ds_read_b64_tr_b16 a[106:107], v13 offset:26112
v_mfma_f32_16x16x32_bf16 v[120:123], a[40:43], a[12:15], 0
ds_read_b64_tr_b16 a[108:109], v12 offset:25344
ds_read_b64_tr_b16 a[110:111], v12 offset:26368
v_mfma_f32_16x16x32_bf16 v[124:127], a[44:47], a[12:15], 0
ds_read_b64_tr_b16 a[112:113], v13 offset:25344
ds_read_b64_tr_b16 a[114:115], v13 offset:26368
v_mfma_f32_16x16x32_bf16 v[92:95], a[44:47], a[8:11], 0
ds_read_b64_tr_b16 a[40:41], v12 offset:8192
v_mfma_f32_16x16x32_bf16 v[60:63], a[44:47], a[4:7], 0
ds_read_b64_tr_b16 a[42:43], v12 offset:9216
v_mfma_f32_16x16x32_bf16 v[28:31], a[44:47], a[0:3], 0
ds_read_b64_tr_b16 a[44:45], v13 offset:8192
v_mfma_f32_16x16x32_bf16 v[32:35], a[48:51], a[0:3], 0
ds_read_b64_tr_b16 a[46:47], v13 offset:9216
v_mfma_f32_16x16x32_bf16 v[64:67], a[48:51], a[4:7], 0
s_add_u32 m0, s16, 0x0
s_waitcnt lgkmcnt(10)
v_mfma_f32_16x16x32_bf16 v[96:99], a[48:51], a[8:11], 0
buffer_load_dwordx4 v2, s[48:51], 0 offen lds
v_mfma_f32_16x16x32_bf16 v[128:131], a[48:51], a[12:15], 0
ds_read_b64_tr_b16 a[48:49], v12 offset:8448
v_mfma_f32_16x16x32_bf16 v[132:135], a[52:55], a[12:15], 0
ds_read_b64_tr_b16 a[50:51], v12 offset:9472
v_mfma_f32_16x16x32_bf16 v[100:103], a[52:55], a[8:11], 0
v_mfma_f32_16x16x32_bf16 v[68:71], a[52:55], a[4:7], 0
v_mfma_f32_16x16x32_bf16 v[36:39], a[52:55], a[0:3], 0
s_add_u32 m0, s16, 0x400
ds_read_b64_tr_b16 a[52:53], v13 offset:8448
v_mfma_f32_16x16x32_bf16 v[40:43], a[56:59], a[0:3], 0
buffer_load_dwordx4 v3, s[48:51], 0 offen lds
v_mfma_f32_16x16x32_bf16 v[72:75], a[56:59], a[4:7], 0
ds_read_b64_tr_b16 a[54:55], v13 offset:9472
v_mfma_f32_16x16x32_bf16 v[104:107], a[56:59], a[8:11], 0
v_mfma_f32_16x16x32_bf16 v[136:139], a[56:59], a[12:15], 0
ds_read_b64_tr_b16 a[56:57], v12 offset:8704
v_mfma_f32_16x16x32_bf16 v[140:143], a[60:63], a[12:15], 0
ds_read_b64_tr_b16 a[58:59], v12 offset:9728
v_mfma_f32_16x16x32_bf16 v[108:111], a[60:63], a[8:11], 0
v_mfma_f32_16x16x32_bf16 v[76:79], a[60:63], a[4:7], 0
s_add_u32 m0, s16, 0x800
v_mfma_f32_16x16x32_bf16 v[44:47], a[60:63], a[0:3], 0
buffer_load_dwordx4 v2, s[48:51], s12 offen lds
v_mfma_f32_16x16x32_bf16 v[48:51], a[64:67], a[0:3], 0
ds_read_b64_tr_b16 a[60:61], v13 offset:8704
v_mfma_f32_16x16x32_bf16 v[80:83], a[64:67], a[4:7], 0
ds_read_b64_tr_b16 a[62:63], v13 offset:9728
v_mfma_f32_16x16x32_bf16 v[112:115], a[64:67], a[8:11], 0
v_mfma_f32_16x16x32_bf16 v[144:147], a[64:67], a[12:15], 0
ds_read_b64_tr_b16 a[64:65], v12 offset:8960
v_mfma_f32_16x16x32_bf16 v[148:151], a[68:71], a[12:15], 0
s_add_u32 m0, s16, 0xc00
ds_read_b64_tr_b16 a[66:67], v12 offset:9984
v_mfma_f32_16x16x32_bf16 v[116:119], a[68:71], a[8:11], 0
buffer_load_dwordx4 v3, s[48:51], s12 offen lds
v_mfma_f32_16x16x32_bf16 v[84:87], a[68:71], a[4:7], 0
v_mfma_f32_16x16x32_bf16 v[52:55], a[68:71], a[0:3], 0
ds_read_b64_tr_b16 a[68:69], v13 offset:8960
v_mfma_f32_16x16x32_bf16 v[152:155], a[0:3], a[72:75], 0
ds_read_b64_tr_b16 a[70:71], v13 offset:9984
v_mfma_f32_16x16x32_bf16 v[156:159], a[4:7], a[72:75], 0
v_mfma_f32_16x16x32_bf16 v[216:219], a[8:11], a[72:75], 0
v_mfma_f32_16x16x32_bf16 v[220:223], a[12:15], a[72:75], 0
s_add_u32 m0, s16, 0x1000
ds_read_b64_tr_b16 a[72:73], v12 offset:24576
v_mfma_f32_16x16x32_bf16 v[228:231], a[12:15], a[76:79], 0
buffer_load_dwordx4 v2, s[48:51], s13 offen lds
v_mfma_f32_16x16x32_bf16 v[224:227], a[8:11], a[76:79], 0
ds_read_b64_tr_b16 a[74:75], v12 offset:25600
v_mfma_f32_16x16x32_bf16 v[164:167], a[4:7], a[76:79], 0
v_mfma_f32_16x16x32_bf16 v[160:163], a[0:3], a[76:79], 0
ds_read_b64_tr_b16 a[76:77], v13 offset:24576
v_mfma_f32_16x16x32_bf16 v[168:171], a[0:3], a[80:83], 0
ds_read_b64_tr_b16 a[78:79], v13 offset:25600
v_mfma_f32_16x16x32_bf16 v[172:175], a[4:7], a[80:83], 0
s_add_u32 m0, s16, 0x1400
v_mfma_f32_16x16x32_bf16 v[232:235], a[8:11], a[80:83], 0
buffer_load_dwordx4 v3, s[48:51], s13 offen lds
v_mfma_f32_16x16x32_bf16 v[236:239], a[12:15], a[80:83], 0
ds_read_b64_tr_b16 a[80:81], v12 offset:24832
v_mfma_f32_16x16x32_bf16 v[244:247], a[12:15], a[84:87], 0
ds_read_b64_tr_b16 a[82:83], v12 offset:25856
v_mfma_f32_16x16x32_bf16 v[240:243], a[8:11], a[84:87], 0
v_mfma_f32_16x16x32_bf16 v[180:183], a[4:7], a[84:87], 0
v_mfma_f32_16x16x32_bf16 v[176:179], a[0:3], a[84:87], 0
ds_read_b64_tr_b16 a[84:85], v13 offset:24832
v_mfma_f32_16x16x32_bf16 v[184:187], a[0:3], a[88:91], 0
s_add_u32 m0, s16, 0x1800
ds_read_b64_tr_b16 a[86:87], v13 offset:25856
v_mfma_f32_16x16x32_bf16 v[188:191], a[4:7], a[88:91], 0
buffer_load_dwordx4 v2, s[48:51], s14 offen lds
v_mfma_f32_16x16x32_bf16 v[248:251], a[8:11], a[88:91], 0
v_mfma_f32_16x16x32_bf16 v[252:255], a[12:15], a[88:91], 0
ds_read_b64_tr_b16 a[88:89], v12 offset:25088
v_mfma_f32_16x16x32_bf16 a[236:239], a[12:15], a[92:95], 0
ds_read_b64_tr_b16 a[90:91], v12 offset:26112
v_mfma_f32_16x16x32_bf16 a[232:235], a[8:11], a[92:95], 0
v_mfma_f32_16x16x32_bf16 v[196:199], a[4:7], a[92:95], 0
s_add_u32 m0, s16, 0x1c00
v_mfma_f32_16x16x32_bf16 v[192:195], a[0:3], a[92:95], 0
buffer_load_dwordx4 v3, s[48:51], s14 offen lds
v_mfma_f32_16x16x32_bf16 v[200:203], a[0:3], a[96:99], 0
v_mfma_f32_16x16x32_bf16 v[204:207], a[4:7], a[96:99], 0
v_mfma_f32_16x16x32_bf16 a[240:243], a[8:11], a[96:99], 0
v_mfma_f32_16x16x32_bf16 a[244:247], a[12:15], a[96:99], 0
v_mfma_f32_16x16x32_bf16 a[252:255], a[12:15], a[100:103], 0
v_mfma_f32_16x16x32_bf16 a[248:251], a[8:11], a[100:103], 0
v_add_u32 v12, 0x8000, v12
v_mfma_f32_16x16x32_bf16 v[212:215], a[4:7], a[100:103], 0
v_add_u32 v13, 0x8000, v13
v_mfma_f32_16x16x32_bf16 v[208:211], a[0:3], a[100:103], 0
s_waitcnt vmcnt(17) lgkmcnt(0)
s_barrier
v_mfma_f32_16x16x32_bf16 v[24:27], a[40:43], a[20:23], v[24:27]
s_add_u32 m0, s17, 0x0
v_add_u32 v2, 0x80, v2
v_add_u32 v3, 0x80, v3
ds_read_b128 a[0:3], v8 offset:32768
v_mfma_f32_16x16x32_bf16 v[56:59], a[40:43], a[24:27], v[56:59]
buffer_load_dwordx4 v5, s[56:59], 0 offen lds
v_mfma_f32_16x16x32_bf16 v[88:91], a[40:43], a[28:31], v[88:91]
ds_read_b128 a[4:7], v8 offset:34816
ds_read_b128 a[8:11], v8 offset:36864
v_mfma_f32_16x16x32_bf16 v[120:123], a[40:43], a[32:35], v[120:123]
ds_read_b128 a[12:15], v8 offset:38912
ds_read_b64_tr_b16 a[92:93], v13 offset:16896
v_mfma_f32_16x16x32_bf16 v[124:127], a[44:47], a[32:35], v[124:127]
ds_read_b64_tr_b16 a[94:95], v13 offset:17920
ds_read_b64_tr_b16 a[96:97], v12 offset:17152
v_mfma_f32_16x16x32_bf16 v[92:95], a[44:47], a[28:31], v[92:95]
ds_read_b64_tr_b16 a[98:99], v12 offset:18176
ds_read_b64_tr_b16 a[100:101], v13 offset:17152
v_mfma_f32_16x16x32_bf16 v[60:63], a[44:47], a[24:27], v[60:63]
ds_read_b64_tr_b16 a[102:103], v13 offset:18176
v_mfma_f32_16x16x32_bf16 v[28:31], a[44:47], a[20:23], v[28:31]
s_add_u32 m0, s17, 0x4000
ds_read_b64_tr_b16 a[40:41], v12 offset:0
ds_read_b64_tr_b16 a[42:43], v12 offset:1024
v_mfma_f32_16x16x32_bf16 v[32:35], a[48:51], a[20:23], v[32:35]
buffer_load_dwordx4 v5, s[60:63], 0 offen lds
v_mfma_f32_16x16x32_bf16 v[64:67], a[48:51], a[24:27], v[64:67]
ds_read_b64_tr_b16 a[44:45], v13 offset:0
v_mfma_f32_16x16x32_bf16 v[96:99], a[48:51], a[28:31], v[96:99]
ds_read_b64_tr_b16 a[46:47], v13 offset:1024
v_mfma_f32_16x16x32_bf16 v[128:131], a[48:51], a[32:35], v[128:131]
ds_read_b64_tr_b16 a[48:49], v12 offset:256
v_mfma_f32_16x16x32_bf16 v[132:135], a[52:55], a[32:35], v[132:135]
ds_read_b64_tr_b16 a[50:51], v12 offset:1280
v_mfma_f32_16x16x32_bf16 v[100:103], a[52:55], a[28:31], v[100:103]
v_mfma_f32_16x16x32_bf16 v[68:71], a[52:55], a[24:27], v[68:71]
v_mfma_f32_16x16x32_bf16 v[36:39], a[52:55], a[20:23], v[36:39]
s_add_u32 m0, s17, 0x400
ds_read_b64_tr_b16 a[52:53], v13 offset:256
v_mfma_f32_16x16x32_bf16 v[40:43], a[56:59], a[20:23], v[40:43]
buffer_load_dwordx4 v5, s[56:59], s13 offen lds
v_mfma_f32_16x16x32_bf16 v[72:75], a[56:59], a[24:27], v[72:75]
ds_read_b64_tr_b16 a[54:55], v13 offset:1280
v_mfma_f32_16x16x32_bf16 v[104:107], a[56:59], a[28:31], v[104:107]
v_mfma_f32_16x16x32_bf16 v[136:139], a[56:59], a[32:35], v[136:139]
ds_read_b64_tr_b16 a[56:57], v12 offset:512
v_mfma_f32_16x16x32_bf16 v[140:143], a[60:63], a[32:35], v[140:143]
ds_read_b64_tr_b16 a[58:59], v12 offset:1536
v_mfma_f32_16x16x32_bf16 v[108:111], a[60:63], a[28:31], v[108:111]
v_mfma_f32_16x16x32_bf16 v[76:79], a[60:63], a[24:27], v[76:79]
s_add_u32 m0, s17, 0x4400
v_mfma_f32_16x16x32_bf16 v[44:47], a[60:63], a[20:23], v[44:47]
buffer_load_dwordx4 v5, s[60:63], s13 offen lds
v_mfma_f32_16x16x32_bf16 v[48:51], a[64:67], a[20:23], v[48:51]
ds_read_b64_tr_b16 a[60:61], v13 offset:512
v_mfma_f32_16x16x32_bf16 v[80:83], a[64:67], a[24:27], v[80:83]
ds_read_b64_tr_b16 a[62:63], v13 offset:1536
v_mfma_f32_16x16x32_bf16 v[112:115], a[64:67], a[28:31], v[112:115]
v_mfma_f32_16x16x32_bf16 v[144:147], a[64:67], a[32:35], v[144:147]
ds_read_b64_tr_b16 a[64:65], v12 offset:768
v_mfma_f32_16x16x32_bf16 v[148:151], a[68:71], a[32:35], v[148:151]
ds_read_b64_tr_b16 a[66:67], v12 offset:1792
v_mfma_f32_16x16x32_bf16 v[116:119], a[68:71], a[28:31], v[116:119]
v_mfma_f32_16x16x32_bf16 v[84:87], a[68:71], a[24:27], v[84:87]
s_add_u32 m0, s17, 0x800
v_mfma_f32_16x16x32_bf16 v[52:55], a[68:71], a[20:23], v[52:55]
buffer_load_dwordx4 v6, s[56:59], 0 offen lds
v_mfma_f32_16x16x32_bf16 v[152:155], a[20:23], a[72:75], v[152:155]
ds_read_b64_tr_b16 a[68:69], v13 offset:768
v_mfma_f32_16x16x32_bf16 v[156:159], a[24:27], a[72:75], v[156:159]
ds_read_b64_tr_b16 a[70:71], v13 offset:1792
v_mfma_f32_16x16x32_bf16 v[216:219], a[28:31], a[72:75], v[216:219]
v_mfma_f32_16x16x32_bf16 v[220:223], a[32:35], a[72:75], v[220:223]
ds_read_b64_tr_b16 a[72:73], v12 offset:16384
v_mfma_f32_16x16x32_bf16 v[228:231], a[32:35], a[76:79], v[228:231]
ds_read_b64_tr_b16 a[74:75], v12 offset:17408
v_mfma_f32_16x16x32_bf16 v[224:227], a[28:31], a[76:79], v[224:227]
v_mfma_f32_16x16x32_bf16 v[164:167], a[24:27], a[76:79], v[164:167]
s_add_u32 m0, s17, 0x4800
v_mfma_f32_16x16x32_bf16 v[160:163], a[20:23], a[76:79], v[160:163]
buffer_load_dwordx4 v6, s[60:63], 0 offen lds
v_mfma_f32_16x16x32_bf16 v[168:171], a[20:23], a[80:83], v[168:171]
ds_read_b64_tr_b16 a[76:77], v13 offset:16384
v_mfma_f32_16x16x32_bf16 v[172:175], a[24:27], a[80:83], v[172:175]
ds_read_b64_tr_b16 a[78:79], v13 offset:17408
v_mfma_f32_16x16x32_bf16 v[232:235], a[28:31], a[80:83], v[232:235]
v_mfma_f32_16x16x32_bf16 v[236:239], a[32:35], a[80:83], v[236:239]
ds_read_b64_tr_b16 a[80:81], v12 offset:16640
v_mfma_f32_16x16x32_bf16 v[244:247], a[32:35], a[84:87], v[244:247]
ds_read_b64_tr_b16 a[82:83], v12 offset:17664
v_mfma_f32_16x16x32_bf16 v[240:243], a[28:31], a[84:87], v[240:243]
s_add_u32 m0, s17, 0xc00
v_mfma_f32_16x16x32_bf16 v[180:183], a[24:27], a[84:87], v[180:183]
buffer_load_dwordx4 v6, s[56:59], s13 offen lds
v_mfma_f32_16x16x32_bf16 v[176:179], a[20:23], a[84:87], v[176:179]
ds_read_b64_tr_b16 a[84:85], v13 offset:16640
v_mfma_f32_16x16x32_bf16 v[184:187], a[20:23], a[88:91], v[184:187]
ds_read_b64_tr_b16 a[86:87], v13 offset:17664
v_mfma_f32_16x16x32_bf16 v[188:191], a[24:27], a[88:91], v[188:191]
v_mfma_f32_16x16x32_bf16 v[248:251], a[28:31], a[88:91], v[248:251]
v_mfma_f32_16x16x32_bf16 v[252:255], a[32:35], a[88:91], v[252:255]
ds_read_b64_tr_b16 a[88:89], v12 offset:16896
v_mfma_f32_16x16x32_bf16 a[236:239], a[32:35], a[104:107], a[236:239]
ds_read_b64_tr_b16 a[90:91], v12 offset:17920
v_mfma_f32_16x16x32_bf16 a[232:235], a[28:31], a[104:107], a[232:235]
s_add_u32 m0, s17, 0x4c00
v_mfma_f32_16x16x32_bf16 v[196:199], a[24:27], a[104:107], v[196:199]
buffer_load_dwordx4 v6, s[60:63], s13 offen lds
v_mfma_f32_16x16x32_bf16 v[192:195], a[20:23], a[104:107], v[192:195]
v_mfma_f32_16x16x32_bf16 v[200:203], a[20:23], a[108:111], v[200:203]
v_mfma_f32_16x16x32_bf16 v[204:207], a[24:27], a[108:111], v[204:207]
v_mfma_f32_16x16x32_bf16 a[240:243], a[28:31], a[108:111], a[240:243]
v_mfma_f32_16x16x32_bf16 a[244:247], a[32:35], a[108:111], a[244:247]
v_mfma_f32_16x16x32_bf16 a[252:255], a[32:35], a[112:115], a[252:255]
v_mfma_f32_16x16x32_bf16 a[248:251], a[28:31], a[112:115], a[248:251]
v_mfma_f32_16x16x32_bf16 v[212:215], a[24:27], a[112:115], v[212:215]
v_mfma_f32_16x16x32_bf16 v[208:211], a[20:23], a[112:115], v[208:211]
s_waitcnt lgkmcnt(0)
v_mfma_f32_16x16x32_bf16 v[24:27], a[40:43], a[0:3], v[24:27]
v_add_u32 v5, 0x80000, v5
v_add_u32 v6, 0x80000, v6
ds_read_b128 a[20:23], v9 offset:32768
v_mfma_f32_16x16x32_bf16 v[56:59], a[40:43], a[4:7], v[56:59]
ds_read_b128 a[24:27], v9 offset:34816
ds_read_b128 a[28:31], v9 offset:36864
v_mfma_f32_16x16x32_bf16 v[88:91], a[40:43], a[8:11], v[88:91]
ds_read_b128 a[32:35], v9 offset:38912
ds_read_b64_tr_b16 a[104:105], v13 offset:25088
v_mfma_f32_16x16x32_bf16 v[120:123], a[40:43], a[12:15], v[120:123]
ds_read_b64_tr_b16 a[106:107], v13 offset:26112
ds_read_b64_tr_b16 a[108:109], v12 offset:25344
v_mfma_f32_16x16x32_bf16 v[124:127], a[44:47], a[12:15], v[124:127]
ds_read_b64_tr_b16 a[110:111], v12 offset:26368
ds_read_b64_tr_b16 a[112:113], v13 offset:25344
v_mfma_f32_16x16x32_bf16 v[92:95], a[44:47], a[8:11], v[92:95]
ds_read_b64_tr_b16 a[114:115], v13 offset:26368
v_mfma_f32_16x16x32_bf16 v[60:63], a[44:47], a[4:7], v[60:63]
ds_read_b64_tr_b16 a[40:41], v12 offset:8192
v_mfma_f32_16x16x32_bf16 v[28:31], a[44:47], a[0:3], v[28:31]
ds_read_b64_tr_b16 a[42:43], v12 offset:9216
v_mfma_f32_16x16x32_bf16 v[32:35], a[48:51], a[0:3], v[32:35]
ds_read_b64_tr_b16 a[44:45], v13 offset:8192
v_mfma_f32_16x16x32_bf16 v[64:67], a[48:51], a[4:7], v[64:67]
s_add_u32 m0, s16, 0x8000
ds_read_b64_tr_b16 a[46:47], v13 offset:9216
s_waitcnt lgkmcnt(10)
v_mfma_f32_16x16x32_bf16 v[96:99], a[48:51], a[8:11], v[96:99]
buffer_load_dwordx4 v2, s[48:51], 0 offen lds
v_mfma_f32_16x16x32_bf16 v[128:131], a[48:51], a[12:15], v[128:131]
ds_read_b64_tr_b16 a[48:49], v12 offset:8448
v_mfma_f32_16x16x32_bf16 v[132:135], a[52:55], a[12:15], v[132:135]
ds_read_b64_tr_b16 a[50:51], v12 offset:9472
v_mfma_f32_16x16x32_bf16 v[100:103], a[52:55], a[8:11], v[100:103]
v_mfma_f32_16x16x32_bf16 v[68:71], a[52:55], a[4:7], v[68:71]
v_mfma_f32_16x16x32_bf16 v[36:39], a[52:55], a[0:3], v[36:39]
s_add_u32 m0, s16, 0x8400
ds_read_b64_tr_b16 a[52:53], v13 offset:8448
v_mfma_f32_16x16x32_bf16 v[40:43], a[56:59], a[0:3], v[40:43]
buffer_load_dwordx4 v3, s[48:51], 0 offen lds
v_mfma_f32_16x16x32_bf16 v[72:75], a[56:59], a[4:7], v[72:75]
ds_read_b64_tr_b16 a[54:55], v13 offset:9472
v_mfma_f32_16x16x32_bf16 v[104:107], a[56:59], a[8:11], v[104:107]
v_mfma_f32_16x16x32_bf16 v[136:139], a[56:59], a[12:15], v[136:139]
ds_read_b64_tr_b16 a[56:57], v12 offset:8704
v_mfma_f32_16x16x32_bf16 v[140:143], a[60:63], a[12:15], v[140:143]
ds_read_b64_tr_b16 a[58:59], v12 offset:9728
v_mfma_f32_16x16x32_bf16 v[108:111], a[60:63], a[8:11], v[108:111]
v_mfma_f32_16x16x32_bf16 v[76:79], a[60:63], a[4:7], v[76:79]
s_add_u32 m0, s16, 0x8800
v_mfma_f32_16x16x32_bf16 v[44:47], a[60:63], a[0:3], v[44:47]
buffer_load_dwordx4 v2, s[48:51], s12 offen lds
v_mfma_f32_16x16x32_bf16 v[48:51], a[64:67], a[0:3], v[48:51]
ds_read_b64_tr_b16 a[60:61], v13 offset:8704
v_mfma_f32_16x16x32_bf16 v[80:83], a[64:67], a[4:7], v[80:83]
ds_read_b64_tr_b16 a[62:63], v13 offset:9728
v_mfma_f32_16x16x32_bf16 v[112:115], a[64:67], a[8:11], v[112:115]
v_mfma_f32_16x16x32_bf16 v[144:147], a[64:67], a[12:15], v[144:147]
ds_read_b64_tr_b16 a[64:65], v12 offset:8960
v_mfma_f32_16x16x32_bf16 v[148:151], a[68:71], a[12:15], v[148:151]
s_add_u32 m0, s16, 0x8c00
ds_read_b64_tr_b16 a[66:67], v12 offset:9984
v_mfma_f32_16x16x32_bf16 v[116:119], a[68:71], a[8:11], v[116:119]
buffer_load_dwordx4 v3, s[48:51], s12 offen lds
v_mfma_f32_16x16x32_bf16 v[84:87], a[68:71], a[4:7], v[84:87]
v_mfma_f32_16x16x32_bf16 v[52:55], a[68:71], a[0:3], v[52:55]
ds_read_b64_tr_b16 a[68:69], v13 offset:8960
v_mfma_f32_16x16x32_bf16 v[152:155], a[0:3], a[72:75], v[152:155]
ds_read_b64_tr_b16 a[70:71], v13 offset:9984
v_mfma_f32_16x16x32_bf16 v[156:159], a[4:7], a[72:75], v[156:159]
v_mfma_f32_16x16x32_bf16 v[216:219], a[8:11], a[72:75], v[216:219]
v_mfma_f32_16x16x32_bf16 v[220:223], a[12:15], a[72:75], v[220:223]
s_add_u32 m0, s16, 0x9000
ds_read_b64_tr_b16 a[72:73], v12 offset:24576
v_mfma_f32_16x16x32_bf16 v[228:231], a[12:15], a[76:79], v[228:231]
buffer_load_dwordx4 v2, s[48:51], s13 offen lds
v_mfma_f32_16x16x32_bf16 v[224:227], a[8:11], a[76:79], v[224:227]
ds_read_b64_tr_b16 a[74:75], v12 offset:25600
v_mfma_f32_16x16x32_bf16 v[164:167], a[4:7], a[76:79], v[164:167]
v_mfma_f32_16x16x32_bf16 v[160:163], a[0:3], a[76:79], v[160:163]
ds_read_b64_tr_b16 a[76:77], v13 offset:24576
v_mfma_f32_16x16x32_bf16 v[168:171], a[0:3], a[80:83], v[168:171]
ds_read_b64_tr_b16 a[78:79], v13 offset:25600
v_mfma_f32_16x16x32_bf16 v[172:175], a[4:7], a[80:83], v[172:175]
s_add_u32 m0, s16, 0x9400
v_mfma_f32_16x16x32_bf16 v[232:235], a[8:11], a[80:83], v[232:235]
buffer_load_dwordx4 v3, s[48:51], s13 offen lds
v_mfma_f32_16x16x32_bf16 v[236:239], a[12:15], a[80:83], v[236:239]
ds_read_b64_tr_b16 a[80:81], v12 offset:24832
v_mfma_f32_16x16x32_bf16 v[244:247], a[12:15], a[84:87], v[244:247]
ds_read_b64_tr_b16 a[82:83], v12 offset:25856
v_mfma_f32_16x16x32_bf16 v[240:243], a[8:11], a[84:87], v[240:243]
v_mfma_f32_16x16x32_bf16 v[180:183], a[4:7], a[84:87], v[180:183]
v_mfma_f32_16x16x32_bf16 v[176:179], a[0:3], a[84:87], v[176:179]
ds_read_b64_tr_b16 a[84:85], v13 offset:24832
v_mfma_f32_16x16x32_bf16 v[184:187], a[0:3], a[88:91], v[184:187]
s_add_u32 m0, s16, 0x9800
ds_read_b64_tr_b16 a[86:87], v13 offset:25856
v_mfma_f32_16x16x32_bf16 v[188:191], a[4:7], a[88:91], v[188:191]
buffer_load_dwordx4 v2, s[48:51], s14 offen lds
v_mfma_f32_16x16x32_bf16 v[248:251], a[8:11], a[88:91], v[248:251]
v_mfma_f32_16x16x32_bf16 v[252:255], a[12:15], a[88:91], v[252:255]
ds_read_b64_tr_b16 a[88:89], v12 offset:25088
v_mfma_f32_16x16x32_bf16 a[236:239], a[12:15], a[92:95], a[236:239]
ds_read_b64_tr_b16 a[90:91], v12 offset:26112
v_mfma_f32_16x16x32_bf16 a[232:235], a[8:11], a[92:95], a[232:235]
v_mfma_f32_16x16x32_bf16 v[196:199], a[4:7], a[92:95], v[196:199]
s_add_u32 m0, s16, 0x9c00
v_mfma_f32_16x16x32_bf16 v[192:195], a[0:3], a[92:95], v[192:195]
buffer_load_dwordx4 v3, s[48:51], s14 offen lds
v_mfma_f32_16x16x32_bf16 v[200:203], a[0:3], a[96:99], v[200:203]
v_mfma_f32_16x16x32_bf16 v[204:207], a[4:7], a[96:99], v[204:207]
v_mfma_f32_16x16x32_bf16 a[240:243], a[8:11], a[96:99], a[240:243]
v_mfma_f32_16x16x32_bf16 a[244:247], a[12:15], a[96:99], a[244:247]
v_mfma_f32_16x16x32_bf16 a[252:255], a[12:15], a[100:103], a[252:255]
v_mfma_f32_16x16x32_bf16 a[248:251], a[8:11], a[100:103], a[248:251]
v_add_u32 v12, 0x8000, v12
v_mfma_f32_16x16x32_bf16 v[212:215], a[4:7], a[100:103], v[212:215]
v_add_u32 v13, 0x8000, v13
v_mfma_f32_16x16x32_bf16 v[208:211], a[0:3], a[100:103], v[208:211]
s_waitcnt vmcnt(16) lgkmcnt(0)
s_barrier
v_mfma_f32_16x16x32_bf16 v[24:27], a[40:43], a[20:23], v[24:27]
s_add_u32 m0, s17, 0x8000
v_add_u32 v2, 0x80, v2
v_add_u32 v3, 0x80, v3
ds_read_b128 a[0:3], v8 offset:0
v_mfma_f32_16x16x32_bf16 v[56:59], a[40:43], a[24:27], v[56:59]
buffer_load_dwordx4 v5, s[56:59], 0 offen lds
v_mfma_f32_16x16x32_bf16 v[88:91], a[40:43], a[28:31], v[88:91]
ds_read_b128 a[4:7], v8 offset:2048
ds_read_b128 a[8:11], v8 offset:4096
v_mfma_f32_16x16x32_bf16 v[120:123], a[40:43], a[32:35], v[120:123]
ds_read_b128 a[12:15], v8 offset:6144
ds_read_b64_tr_b16 a[92:93], v13 offset:16896
v_mfma_f32_16x16x32_bf16 v[124:127], a[44:47], a[32:35], v[124:127]
ds_read_b64_tr_b16 a[94:95], v13 offset:17920
ds_read_b64_tr_b16 a[96:97], v12 offset:17152
v_mfma_f32_16x16x32_bf16 v[92:95], a[44:47], a[28:31], v[92:95]
ds_read_b64_tr_b16 a[98:99], v12 offset:18176
ds_read_b64_tr_b16 a[100:101], v13 offset:17152
v_mfma_f32_16x16x32_bf16 v[60:63], a[44:47], a[24:27], v[60:63]
ds_read_b64_tr_b16 a[102:103], v13 offset:18176
v_mfma_f32_16x16x32_bf16 v[28:31], a[44:47], a[20:23], v[28:31]
s_add_u32 m0, s17, 0xc000
ds_read_b64_tr_b16 a[40:41], v12 offset:0
ds_read_b64_tr_b16 a[42:43], v12 offset:1024
v_mfma_f32_16x16x32_bf16 v[32:35], a[48:51], a[20:23], v[32:35]
buffer_load_dwordx4 v5, s[60:63], 0 offen lds
v_mfma_f32_16x16x32_bf16 v[64:67], a[48:51], a[24:27], v[64:67]
ds_read_b64_tr_b16 a[44:45], v13 offset:0
v_mfma_f32_16x16x32_bf16 v[96:99], a[48:51], a[28:31], v[96:99]
ds_read_b64_tr_b16 a[46:47], v13 offset:1024
v_mfma_f32_16x16x32_bf16 v[128:131], a[48:51], a[32:35], v[128:131]
ds_read_b64_tr_b16 a[48:49], v12 offset:256
v_mfma_f32_16x16x32_bf16 v[132:135], a[52:55], a[32:35], v[132:135]
ds_read_b64_tr_b16 a[50:51], v12 offset:1280
v_mfma_f32_16x16x32_bf16 v[100:103], a[52:55], a[28:31], v[100:103]
v_mfma_f32_16x16x32_bf16 v[68:71], a[52:55], a[24:27], v[68:71]
v_mfma_f32_16x16x32_bf16 v[36:39], a[52:55], a[20:23], v[36:39]
s_add_u32 m0, s17, 0x8400
ds_read_b64_tr_b16 a[52:53], v13 offset:256
v_mfma_f32_16x16x32_bf16 v[40:43], a[56:59], a[20:23], v[40:43]
buffer_load_dwordx4 v5, s[56:59], s13 offen lds
v_mfma_f32_16x16x32_bf16 v[72:75], a[56:59], a[24:27], v[72:75]
ds_read_b64_tr_b16 a[54:55], v13 offset:1280
v_mfma_f32_16x16x32_bf16 v[104:107], a[56:59], a[28:31], v[104:107]
v_mfma_f32_16x16x32_bf16 v[136:139], a[56:59], a[32:35], v[136:139]
ds_read_b64_tr_b16 a[56:57], v12 offset:512
v_mfma_f32_16x16x32_bf16 v[140:143], a[60:63], a[32:35], v[140:143]
ds_read_b64_tr_b16 a[58:59], v12 offset:1536
v_mfma_f32_16x16x32_bf16 v[108:111], a[60:63], a[28:31], v[108:111]
v_mfma_f32_16x16x32_bf16 v[76:79], a[60:63], a[24:27], v[76:79]
s_add_u32 m0, s17, 0xc400
v_mfma_f32_16x16x32_bf16 v[44:47], a[60:63], a[20:23], v[44:47]
buffer_load_dwordx4 v5, s[60:63], s13 offen lds
v_mfma_f32_16x16x32_bf16 v[48:51], a[64:67], a[20:23], v[48:51]
ds_read_b64_tr_b16 a[60:61], v13 offset:512
v_mfma_f32_16x16x32_bf16 v[80:83], a[64:67], a[24:27], v[80:83]
ds_read_b64_tr_b16 a[62:63], v13 offset:1536
v_mfma_f32_16x16x32_bf16 v[112:115], a[64:67], a[28:31], v[112:115]
v_mfma_f32_16x16x32_bf16 v[144:147], a[64:67], a[32:35], v[144:147]
ds_read_b64_tr_b16 a[64:65], v12 offset:768
v_mfma_f32_16x16x32_bf16 v[148:151], a[68:71], a[32:35], v[148:151]
ds_read_b64_tr_b16 a[66:67], v12 offset:1792
v_mfma_f32_16x16x32_bf16 v[116:119], a[68:71], a[28:31], v[116:119]
v_mfma_f32_16x16x32_bf16 v[84:87], a[68:71], a[24:27], v[84:87]
s_add_u32 m0, s17, 0x8800
v_mfma_f32_16x16x32_bf16 v[52:55], a[68:71], a[20:23], v[52:55]
buffer_load_dwordx4 v6, s[56:59], 0 offen lds
v_mfma_f32_16x16x32_bf16 v[152:155], a[20:23], a[72:75], v[152:155]
ds_read_b64_tr_b16 a[68:69], v13 offset:768
v_mfma_f32_16x16x32_bf16 v[156:159], a[24:27], a[72:75], v[156:159]
ds_read_b64_tr_b16 a[70:71], v13 offset:1792
v_mfma_f32_16x16x32_bf16 v[216:219], a[28:31], a[72:75], v[216:219]
v_mfma_f32_16x16x32_bf16 v[220:223], a[32:35], a[72:75], v[220:223]
ds_read_b64_tr_b16 a[72:73], v12 offset:16384
v_mfma_f32_16x16x32_bf16 v[228:231], a[32:35], a[76:79], v[228:231]
ds_read_b64_tr_b16 a[74:75], v12 offset:17408
v_mfma_f32_16x16x32_bf16 v[224:227], a[28:31], a[76:79], v[224:227]
v_mfma_f32_16x16x32_bf16 v[164:167], a[24:27], a[76:79], v[164:167]
s_add_u32 m0, s17, 0xc800
v_mfma_f32_16x16x32_bf16 v[160:163], a[20:23], a[76:79], v[160:163]
buffer_load_dwordx4 v6, s[60:63], 0 offen lds
v_mfma_f32_16x16x32_bf16 v[168:171], a[20:23], a[80:83], v[168:171]
ds_read_b64_tr_b16 a[76:77], v13 offset:16384
v_mfma_f32_16x16x32_bf16 v[172:175], a[24:27], a[80:83], v[172:175]
ds_read_b64_tr_b16 a[78:79], v13 offset:17408
v_mfma_f32_16x16x32_bf16 v[232:235], a[28:31], a[80:83], v[232:235]
v_mfma_f32_16x16x32_bf16 v[236:239], a[32:35], a[80:83], v[236:239]
ds_read_b64_tr_b16 a[80:81], v12 offset:16640
v_mfma_f32_16x16x32_bf16 v[244:247], a[32:35], a[84:87], v[244:247]
ds_read_b64_tr_b16 a[82:83], v12 offset:17664
v_mfma_f32_16x16x32_bf16 v[240:243], a[28:31], a[84:87], v[240:243]
s_add_u32 m0, s17, 0x8c00
v_mfma_f32_16x16x32_bf16 v[180:183], a[24:27], a[84:87], v[180:183]
buffer_load_dwordx4 v6, s[56:59], s13 offen lds
v_mfma_f32_16x16x32_bf16 v[176:179], a[20:23], a[84:87], v[176:179]
ds_read_b64_tr_b16 a[84:85], v13 offset:16640
v_mfma_f32_16x16x32_bf16 v[184:187], a[20:23], a[88:91], v[184:187]
ds_read_b64_tr_b16 a[86:87], v13 offset:17664
v_mfma_f32_16x16x32_bf16 v[188:191], a[24:27], a[88:91], v[188:191]
v_mfma_f32_16x16x32_bf16 v[248:251], a[28:31], a[88:91], v[248:251]
v_mfma_f32_16x16x32_bf16 v[252:255], a[32:35], a[88:91], v[252:255]
ds_read_b64_tr_b16 a[88:89], v12 offset:16896
v_mfma_f32_16x16x32_bf16 a[236:239], a[32:35], a[104:107], a[236:239]
ds_read_b64_tr_b16 a[90:91], v12 offset:17920
v_mfma_f32_16x16x32_bf16 a[232:235], a[28:31], a[104:107], a[232:235]
s_add_u32 m0, s17, 0xcc00
v_mfma_f32_16x16x32_bf16 v[196:199], a[24:27], a[104:107], v[196:199]
buffer_load_dwordx4 v6, s[60:63], s13 offen lds
v_mfma_f32_16x16x32_bf16 v[192:195], a[20:23], a[104:107], v[192:195]
v_mfma_f32_16x16x32_bf16 v[200:203], a[20:23], a[108:111], v[200:203]
v_mfma_f32_16x16x32_bf16 v[204:207], a[24:27], a[108:111], v[204:207]
v_mfma_f32_16x16x32_bf16 a[240:243], a[28:31], a[108:111], a[240:243]
v_mfma_f32_16x16x32_bf16 a[244:247], a[32:35], a[108:111], a[244:247]
v_mfma_f32_16x16x32_bf16 a[252:255], a[32:35], a[112:115], a[252:255]
v_mfma_f32_16x16x32_bf16 a[248:251], a[28:31], a[112:115], a[248:251]
v_mfma_f32_16x16x32_bf16 v[212:215], a[24:27], a[112:115], v[212:215]
v_mfma_f32_16x16x32_bf16 v[208:211], a[20:23], a[112:115], v[208:211]
s_waitcnt lgkmcnt(0)
v_mfma_f32_16x16x32_bf16 v[24:27], a[40:43], a[0:3], v[24:27]
v_add_u32 v5, 0x80000, v5
v_add_u32 v6, 0x80000, v6
ds_read_b128 a[20:23], v9 offset:0
v_mfma_f32_16x16x32_bf16 v[56:59], a[40:43], a[4:7], v[56:59]
ds_read_b128 a[24:27], v9 offset:2048
ds_read_b128 a[28:31], v9 offset:4096
v_mfma_f32_16x16x32_bf16 v[88:91], a[40:43], a[8:11], v[88:91]
ds_read_b128 a[32:35], v9 offset:6144
ds_read_b64_tr_b16 a[104:105], v13 offset:25088
v_mfma_f32_16x16x32_bf16 v[120:123], a[40:43], a[12:15], v[120:123]
ds_read_b64_tr_b16 a[106:107], v13 offset:26112
ds_read_b64_tr_b16 a[108:109], v12 offset:25344
v_mfma_f32_16x16x32_bf16 v[124:127], a[44:47], a[12:15], v[124:127]
ds_read_b64_tr_b16 a[110:111], v12 offset:26368
ds_read_b64_tr_b16 a[112:113], v13 offset:25344
v_mfma_f32_16x16x32_bf16 v[92:95], a[44:47], a[8:11], v[92:95]
ds_read_b64_tr_b16 a[114:115], v13 offset:26368
v_mfma_f32_16x16x32_bf16 v[60:63], a[44:47], a[4:7], v[60:63]
ds_read_b64_tr_b16 a[40:41], v12 offset:8192
v_mfma_f32_16x16x32_bf16 v[28:31], a[44:47], a[0:3], v[28:31]
ds_read_b64_tr_b16 a[42:43], v12 offset:9216
v_mfma_f32_16x16x32_bf16 v[32:35], a[48:51], a[0:3], v[32:35]
ds_read_b64_tr_b16 a[44:45], v13 offset:8192
v_mfma_f32_16x16x32_bf16 v[64:67], a[48:51], a[4:7], v[64:67]
s_add_u32 m0, s16, 0x0
ds_read_b64_tr_b16 a[46:47], v13 offset:9216
s_waitcnt lgkmcnt(10)
v_mfma_f32_16x16x32_bf16 v[96:99], a[48:51], a[8:11], v[96:99]
buffer_load_dwordx4 v2, s[48:51], 0 offen lds
v_mfma_f32_16x16x32_bf16 v[128:131], a[48:51], a[12:15], v[128:131]
ds_read_b64_tr_b16 a[48:49], v12 offset:8448
v_mfma_f32_16x16x32_bf16 v[132:135], a[52:55], a[12:15], v[132:135]
ds_read_b64_tr_b16 a[50:51], v12 offset:9472
v_mfma_f32_16x16x32_bf16 v[100:103], a[52:55], a[8:11], v[100:103]
v_mfma_f32_16x16x32_bf16 v[68:71], a[52:55], a[4:7], v[68:71]
v_mfma_f32_16x16x32_bf16 v[36:39], a[52:55], a[0:3], v[36:39]
s_add_u32 m0, s16, 0x400
ds_read_b64_tr_b16 a[52:53], v13 offset:8448
v_mfma_f32_16x16x32_bf16 v[40:43], a[56:59], a[0:3], v[40:43]
buffer_load_dwordx4 v3, s[48:51], 0 offen lds
v_mfma_f32_16x16x32_bf16 v[72:75], a[56:59], a[4:7], v[72:75]
ds_read_b64_tr_b16 a[54:55], v13 offset:9472
v_mfma_f32_16x16x32_bf16 v[104:107], a[56:59], a[8:11], v[104:107]
v_mfma_f32_16x16x32_bf16 v[136:139], a[56:59], a[12:15], v[136:139]
ds_read_b64_tr_b16 a[56:57], v12 offset:8704
v_mfma_f32_16x16x32_bf16 v[140:143], a[60:63], a[12:15], v[140:143]
ds_read_b64_tr_b16 a[58:59], v12 offset:9728
v_mfma_f32_16x16x32_bf16 v[108:111], a[60:63], a[8:11], v[108:111]
v_mfma_f32_16x16x32_bf16 v[76:79], a[60:63], a[4:7], v[76:79]
s_add_u32 m0, s16, 0x800
v_mfma_f32_16x16x32_bf16 v[44:47], a[60:63], a[0:3], v[44:47]
buffer_load_dwordx4 v2, s[48:51], s12 offen lds
v_mfma_f32_16x16x32_bf16 v[48:51], a[64:67], a[0:3], v[48:51]
ds_read_b64_tr_b16 a[60:61], v13 offset:8704
v_mfma_f32_16x16x32_bf16 v[80:83], a[64:67], a[4:7], v[80:83]
ds_read_b64_tr_b16 a[62:63], v13 offset:9728
v_mfma_f32_16x16x32_bf16 v[112:115], a[64:67], a[8:11], v[112:115]
v_mfma_f32_16x16x32_bf16 v[144:147], a[64:67], a[12:15], v[144:147]
ds_read_b64_tr_b16 a[64:65], v12 offset:8960
v_mfma_f32_16x16x32_bf16 v[148:151], a[68:71], a[12:15], v[148:151]
s_add_u32 m0, s16, 0xc00
ds_read_b64_tr_b16 a[66:67], v12 offset:9984
v_mfma_f32_16x16x32_bf16 v[116:119], a[68:71], a[8:11], v[116:119]
buffer_load_dwordx4 v3, s[48:51], s12 offen lds
v_mfma_f32_16x16x32_bf16 v[84:87], a[68:71], a[4:7], v[84:87]
v_mfma_f32_16x16x32_bf16 v[52:55], a[68:71], a[0:3], v[52:55]
ds_read_b64_tr_b16 a[68:69], v13 offset:8960
v_mfma_f32_16x16x32_bf16 v[152:155], a[0:3], a[72:75], v[152:155]
ds_read_b64_tr_b16 a[70:71], v13 offset:9984
v_mfma_f32_16x16x32_bf16 v[156:159], a[4:7], a[72:75], v[156:159]
v_mfma_f32_16x16x32_bf16 v[216:219], a[8:11], a[72:75], v[216:219]
v_mfma_f32_16x16x32_bf16 v[220:223], a[12:15], a[72:75], v[220:223]
s_add_u32 m0, s16, 0x1000
ds_read_b64_tr_b16 a[72:73], v12 offset:24576
v_mfma_f32_16x16x32_bf16 v[228:231], a[12:15], a[76:79], v[228:231]
buffer_load_dwordx4 v2, s[48:51], s13 offen lds
v_mfma_f32_16x16x32_bf16 v[224:227], a[8:11], a[76:79], v[224:227]
ds_read_b64_tr_b16 a[74:75], v12 offset:25600
v_mfma_f32_16x16x32_bf16 v[164:167], a[4:7], a[76:79], v[164:167]
v_mfma_f32_16x16x32_bf16 v[160:163], a[0:3], a[76:79], v[160:163]
ds_read_b64_tr_b16 a[76:77], v13 offset:24576
v_mfma_f32_16x16x32_bf16 v[168:171], a[0:3], a[80:83], v[168:171]
ds_read_b64_tr_b16 a[78:79], v13 offset:25600
v_mfma_f32_16x16x32_bf16 v[172:175], a[4:7], a[80:83], v[172:175]
s_add_u32 m0, s16, 0x1400
v_mfma_f32_16x16x32_bf16 v[232:235], a[8:11], a[80:83], v[232:235]
buffer_load_dwordx4 v3, s[48:51], s13 offen lds
v_mfma_f32_16x16x32_bf16 v[236:239], a[12:15], a[80:83], v[236:239]
ds_read_b64_tr_b16 a[80:81], v12 offset:24832
v_mfma_f32_16x16x32_bf16 v[244:247], a[12:15], a[84:87], v[244:247]
ds_read_b64_tr_b16 a[82:83], v12 offset:25856
v_mfma_f32_16x16x32_bf16 v[240:243], a[8:11], a[84:87], v[240:243]
v_mfma_f32_16x16x32_bf16 v[180:183], a[4:7], a[84:87], v[180:183]
v_mfma_f32_16x16x32_bf16 v[176:179], a[0:3], a[84:87], v[176:179]
ds_read_b64_tr_b16 a[84:85], v13 offset:24832
v_mfma_f32_16x16x32_bf16 v[184:187], a[0:3], a[88:91], v[184:187]
s_add_u32 m0, s16, 0x1800
ds_read_b64_tr_b16 a[86:87], v13 offset:25856
v_mfma_f32_16x16x32_bf16 v[188:191], a[4:7], a[88:91], v[188:191]
buffer_load_dwordx4 v2, s[48:51], s14 offen lds
v_mfma_f32_16x16x32_bf16 v[248:251], a[8:11], a[88:91], v[248:251]
v_mfma_f32_16x16x32_bf16 v[252:255], a[12:15], a[88:91], v[252:255]
ds_read_b64_tr_b16 a[88:89], v12 offset:25088
v_mfma_f32_16x16x32_bf16 a[236:239], a[12:15], a[92:95], a[236:239]
ds_read_b64_tr_b16 a[90:91], v12 offset:26112
v_mfma_f32_16x16x32_bf16 a[232:235], a[8:11], a[92:95], a[232:235]
v_mfma_f32_16x16x32_bf16 v[196:199], a[4:7], a[92:95], v[196:199]
s_add_u32 m0, s16, 0x1c00
v_mfma_f32_16x16x32_bf16 v[192:195], a[0:3], a[92:95], v[192:195]
buffer_load_dwordx4 v3, s[48:51], s14 offen lds
v_mfma_f32_16x16x32_bf16 v[200:203], a[0:3], a[96:99], v[200:203]
v_mfma_f32_16x16x32_bf16 v[204:207], a[4:7], a[96:99], v[204:207]
v_mfma_f32_16x16x32_bf16 a[240:243], a[8:11], a[96:99], a[240:243]
v_mfma_f32_16x16x32_bf16 a[244:247], a[12:15], a[96:99], a[244:247]
v_mfma_f32_16x16x32_bf16 a[252:255], a[12:15], a[100:103], a[252:255]
v_mfma_f32_16x16x32_bf16 a[248:251], a[8:11], a[100:103], a[248:251]
v_add_u32 v12, 0xffff0000, v12
v_mfma_f32_16x16x32_bf16 v[212:215], a[4:7], a[100:103], v[212:215]
v_add_u32 v13, 0xffff0000, v13
v_mfma_f32_16x16x32_bf16 v[208:211], a[0:3], a[100:103], v[208:211]
s_waitcnt vmcnt(16) lgkmcnt(0)
s_barrier
v_mfma_f32_16x16x32_bf16 v[24:27], a[40:43], a[20:23], v[24:27]
s_add_u32 m0, s17, 0x10000
v_add_u32 v2, 0x80, v2
v_add_u32 v3, 0x80, v3
ds_read_b128 a[0:3], v8 offset:32768
v_mfma_f32_16x16x32_bf16 v[56:59], a[40:43], a[24:27], v[56:59]
buffer_load_dwordx4 v5, s[56:59], 0 offen lds
v_mfma_f32_16x16x32_bf16 v[88:91], a[40:43], a[28:31], v[88:91]
ds_read_b128 a[4:7], v8 offset:34816
ds_read_b128 a[8:11], v8 offset:36864
v_mfma_f32_16x16x32_bf16 v[120:123], a[40:43], a[32:35], v[120:123]
ds_read_b128 a[12:15], v8 offset:38912
ds_read_b64_tr_b16 a[92:93], v13 offset:16896
v_mfma_f32_16x16x32_bf16 v[124:127], a[44:47], a[32:35], v[124:127]
ds_read_b64_tr_b16 a[94:95], v13 offset:17920
ds_read_b64_tr_b16 a[96:97], v12 offset:17152
v_mfma_f32_16x16x32_bf16 v[92:95], a[44:47], a[28:31], v[92:95]
ds_read_b64_tr_b16 a[98:99], v12 offset:18176
ds_read_b64_tr_b16 a[100:101], v13 offset:17152
v_mfma_f32_16x16x32_bf16 v[60:63], a[44:47], a[24:27], v[60:63]
ds_read_b64_tr_b16 a[102:103], v13 offset:18176
v_mfma_f32_16x16x32_bf16 v[28:31], a[44:47], a[20:23], v[28:31]
s_add_u32 m0, s17, 0x14000
ds_read_b64_tr_b16 a[40:41], v12 offset:0
ds_read_b64_tr_b16 a[42:43], v12 offset:1024
v_mfma_f32_16x16x32_bf16 v[32:35], a[48:51], a[20:23], v[32:35]
buffer_load_dwordx4 v5, s[60:63], 0 offen lds
v_mfma_f32_16x16x32_bf16 v[64:67], a[48:51], a[24:27], v[64:67]
ds_read_b64_tr_b16 a[44:45], v13 offset:0
v_mfma_f32_16x16x32_bf16 v[96:99], a[48:51], a[28:31], v[96:99]
ds_read_b64_tr_b16 a[46:47], v13 offset:1024
v_mfma_f32_16x16x32_bf16 v[128:131], a[48:51], a[32:35], v[128:131]
ds_read_b64_tr_b16 a[48:49], v12 offset:256
v_mfma_f32_16x16x32_bf16 v[132:135], a[52:55], a[32:35], v[132:135]
ds_read_b64_tr_b16 a[50:51], v12 offset:1280
v_mfma_f32_16x16x32_bf16 v[100:103], a[52:55], a[28:31], v[100:103]
v_mfma_f32_16x16x32_bf16 v[68:71], a[52:55], a[24:27], v[68:71]
v_mfma_f32_16x16x32_bf16 v[36:39], a[52:55], a[20:23], v[36:39]
s_add_u32 m0, s17, 0x10400
ds_read_b64_tr_b16 a[52:53], v13 offset:256
v_mfma_f32_16x16x32_bf16 v[40:43], a[56:59], a[20:23], v[40:43]
buffer_load_dwordx4 v5, s[56:59], s13 offen lds
v_mfma_f32_16x16x32_bf16 v[72:75], a[56:59], a[24:27], v[72:75]
ds_read_b64_tr_b16 a[54:55], v13 offset:1280
v_mfma_f32_16x16x32_bf16 v[104:107], a[56:59], a[28:31], v[104:107]
v_mfma_f32_16x16x32_bf16 v[136:139], a[56:59], a[32:35], v[136:139]
ds_read_b64_tr_b16 a[56:57], v12 offset:512
v_mfma_f32_16x16x32_bf16 v[140:143], a[60:63], a[32:35], v[140:143]
ds_read_b64_tr_b16 a[58:59], v12 offset:1536
v_mfma_f32_16x16x32_bf16 v[108:111], a[60:63], a[28:31], v[108:111]
v_mfma_f32_16x16x32_bf16 v[76:79], a[60:63], a[24:27], v[76:79]
s_add_u32 m0, s17, 0x14400
v_mfma_f32_16x16x32_bf16 v[44:47], a[60:63], a[20:23], v[44:47]
buffer_load_dwordx4 v5, s[60:63], s13 offen lds
v_mfma_f32_16x16x32_bf16 v[48:51], a[64:67], a[20:23], v[48:51]
ds_read_b64_tr_b16 a[60:61], v13 offset:512
v_mfma_f32_16x16x32_bf16 v[80:83], a[64:67], a[24:27], v[80:83]
ds_read_b64_tr_b16 a[62:63], v13 offset:1536
v_mfma_f32_16x16x32_bf16 v[112:115], a[64:67], a[28:31], v[112:115]
v_mfma_f32_16x16x32_bf16 v[144:147], a[64:67], a[32:35], v[144:147]
ds_read_b64_tr_b16 a[64:65], v12 offset:768
v_mfma_f32_16x16x32_bf16 v[148:151], a[68:71], a[32:35], v[148:151]
ds_read_b64_tr_b16 a[66:67], v12 offset:1792
v_mfma_f32_16x16x32_bf16 v[116:119], a[68:71], a[28:31], v[116:119]
v_mfma_f32_16x16x32_bf16 v[84:87], a[68:71], a[24:27], v[84:87]
s_add_u32 m0, s17, 0x10800
v_mfma_f32_16x16x32_bf16 v[52:55], a[68:71], a[20:23], v[52:55]
buffer_load_dwordx4 v6, s[56:59], 0 offen lds
v_mfma_f32_16x16x32_bf16 v[152:155], a[20:23], a[72:75], v[152:155]
ds_read_b64_tr_b16 a[68:69], v13 offset:768
v_mfma_f32_16x16x32_bf16 v[156:159], a[24:27], a[72:75], v[156:159]
ds_read_b64_tr_b16 a[70:71], v13 offset:1792
v_mfma_f32_16x16x32_bf16 v[216:219], a[28:31], a[72:75], v[216:219]
v_mfma_f32_16x16x32_bf16 v[220:223], a[32:35], a[72:75], v[220:223]
ds_read_b64_tr_b16 a[72:73], v12 offset:16384
v_mfma_f32_16x16x32_bf16 v[228:231], a[32:35], a[76:79], v[228:231]
ds_read_b64_tr_b16 a[74:75], v12 offset:17408
v_mfma_f32_16x16x32_bf16 v[224:227], a[28:31], a[76:79], v[224:227]
v_mfma_f32_16x16x32_bf16 v[164:167], a[24:27], a[76:79], v[164:167]
s_add_u32 m0, s17, 0x14800
v_mfma_f32_16x16x32_bf16 v[160:163], a[20:23], a[76:79], v[160:163]
buffer_load_dwordx4 v6, s[60:63], 0 offen lds
v_mfma_f32_16x16x32_bf16 v[168:171], a[20:23], a[80:83], v[168:171]
ds_read_b64_tr_b16 a[76:77], v13 offset:16384
v_mfma_f32_16x16x32_bf16 v[172:175], a[24:27], a[80:83], v[172:175]
ds_read_b64_tr_b16 a[78:79], v13 offset:17408
v_mfma_f32_16x16x32_bf16 v[232:235], a[28:31], a[80:83], v[232:235]
v_mfma_f32_16x16x32_bf16 v[236:239], a[32:35], a[80:83], v[236:239]
ds_read_b64_tr_b16 a[80:81], v12 offset:16640
v_mfma_f32_16x16x32_bf16 v[244:247], a[32:35], a[84:87], v[244:247]
ds_read_b64_tr_b16 a[82:83], v12 offset:17664
v_mfma_f32_16x16x32_bf16 v[240:243], a[28:31], a[84:87], v[240:243]
s_add_u32 m0, s17, 0x10c00
v_mfma_f32_16x16x32_bf16 v[180:183], a[24:27], a[84:87], v[180:183]
buffer_load_dwordx4 v6, s[56:59], s13 offen lds
v_mfma_f32_16x16x32_bf16 v[176:179], a[20:23], a[84:87], v[176:179]
ds_read_b64_tr_b16 a[84:85], v13 offset:16640
v_mfma_f32_16x16x32_bf16 v[184:187], a[20:23], a[88:91], v[184:187]
ds_read_b64_tr_b16 a[86:87], v13 offset:17664
v_mfma_f32_16x16x32_bf16 v[188:191], a[24:27], a[88:91], v[188:191]
v_mfma_f32_16x16x32_bf16 v[248:251], a[28:31], a[88:91], v[248:251]
v_mfma_f32_16x16x32_bf16 v[252:255], a[32:35], a[88:91], v[252:255]
ds_read_b64_tr_b16 a[88:89], v12 offset:16896
v_mfma_f32_16x16x32_bf16 a[236:239], a[32:35], a[104:107], a[236:239]
ds_read_b64_tr_b16 a[90:91], v12 offset:17920
v_mfma_f32_16x16x32_bf16 a[232:235], a[28:31], a[104:107], a[232:235]
s_add_u32 m0, s17, 0x14c00
v_mfma_f32_16x16x32_bf16 v[196:199], a[24:27], a[104:107], v[196:199]
buffer_load_dwordx4 v6, s[60:63], s13 offen lds
v_mfma_f32_16x16x32_bf16 v[192:195], a[20:23], a[104:107], v[192:195]
v_mfma_f32_16x16x32_bf16 v[200:203], a[20:23], a[108:111], v[200:203]
v_mfma_f32_16x16x32_bf16 v[204:207], a[24:27], a[108:111], v[204:207]
v_mfma_f32_16x16x32_bf16 a[240:243], a[28:31], a[108:111], a[240:243]
v_mfma_f32_16x16x32_bf16 a[244:247], a[32:35], a[108:111], a[244:247]
v_mfma_f32_16x16x32_bf16 a[252:255], a[32:35], a[112:115], a[252:255]
v_mfma_f32_16x16x32_bf16 a[248:251], a[28:31], a[112:115], a[248:251]
v_mfma_f32_16x16x32_bf16 v[212:215], a[24:27], a[112:115], v[212:215]
v_mfma_f32_16x16x32_bf16 v[208:211], a[20:23], a[112:115], v[208:211]
s_waitcnt lgkmcnt(0)
v_mfma_f32_16x16x32_bf16 v[24:27], a[40:43], a[0:3], v[24:27]
v_add_u32 v5, 0x80000, v5
v_add_u32 v6, 0x80000, v6
ds_read_b128 a[20:23], v9 offset:32768
v_mfma_f32_16x16x32_bf16 v[56:59], a[40:43], a[4:7], v[56:59]
ds_read_b128 a[24:27], v9 offset:34816
ds_read_b128 a[28:31], v9 offset:36864
v_mfma_f32_16x16x32_bf16 v[88:91], a[40:43], a[8:11], v[88:91]
ds_read_b128 a[32:35], v9 offset:38912
ds_read_b64_tr_b16 a[104:105], v13 offset:25088
v_mfma_f32_16x16x32_bf16 v[120:123], a[40:43], a[12:15], v[120:123]
ds_read_b64_tr_b16 a[106:107], v13 offset:26112
ds_read_b64_tr_b16 a[108:109], v12 offset:25344
v_mfma_f32_16x16x32_bf16 v[124:127], a[44:47], a[12:15], v[124:127]
ds_read_b64_tr_b16 a[110:111], v12 offset:26368
ds_read_b64_tr_b16 a[112:113], v13 offset:25344
v_mfma_f32_16x16x32_bf16 v[92:95], a[44:47], a[8:11], v[92:95]
ds_read_b64_tr_b16 a[114:115], v13 offset:26368
v_mfma_f32_16x16x32_bf16 v[60:63], a[44:47], a[4:7], v[60:63]
ds_read_b64_tr_b16 a[40:41], v12 offset:8192
v_mfma_f32_16x16x32_bf16 v[28:31], a[44:47], a[0:3], v[28:31]
ds_read_b64_tr_b16 a[42:43], v12 offset:9216
v_mfma_f32_16x16x32_bf16 v[32:35], a[48:51], a[0:3], v[32:35]
ds_read_b64_tr_b16 a[44:45], v13 offset:8192
v_mfma_f32_16x16x32_bf16 v[64:67], a[48:51], a[4:7], v[64:67]
s_add_u32 m0, s16, 0x8000
ds_read_b64_tr_b16 a[46:47], v13 offset:9216
s_waitcnt lgkmcnt(10)
v_mfma_f32_16x16x32_bf16 v[96:99], a[48:51], a[8:11], v[96:99]
buffer_load_dwordx4 v2, s[48:51], 0 offen lds
v_mfma_f32_16x16x32_bf16 v[128:131], a[48:51], a[12:15], v[128:131]
ds_read_b64_tr_b16 a[48:49], v12 offset:8448
v_mfma_f32_16x16x32_bf16 v[132:135], a[52:55], a[12:15], v[132:135]
ds_read_b64_tr_b16 a[50:51], v12 offset:9472
v_mfma_f32_16x16x32_bf16 v[100:103], a[52:55], a[8:11], v[100:103]
v_mfma_f32_16x16x32_bf16 v[68:71], a[52:55], a[4:7], v[68:71]
v_mfma_f32_16x16x32_bf16 v[36:39], a[52:55], a[0:3], v[36:39]
s_add_u32 m0, s16, 0x8400
ds_read_b64_tr_b16 a[52:53], v13 offset:8448
v_mfma_f32_16x16x32_bf16 v[40:43], a[56:59], a[0:3], v[40:43]
buffer_load_dwordx4 v3, s[48:51], 0 offen lds
v_mfma_f32_16x16x32_bf16 v[72:75], a[56:59], a[4:7], v[72:75]
ds_read_b64_tr_b16 a[54:55], v13 offset:9472
v_mfma_f32_16x16x32_bf16 v[104:107], a[56:59], a[8:11], v[104:107]
v_mfma_f32_16x16x32_bf16 v[136:139], a[56:59], a[12:15], v[136:139]
ds_read_b64_tr_b16 a[56:57], v12 offset:8704
v_mfma_f32_16x16x32_bf16 v[140:143], a[60:63], a[12:15], v[140:143]
ds_read_b64_tr_b16 a[58:59], v12 offset:9728
v_mfma_f32_16x16x32_bf16 v[108:111], a[60:63], a[8:11], v[108:111]
v_mfma_f32_16x16x32_bf16 v[76:79], a[60:63], a[4:7], v[76:79]
s_add_u32 m0, s16, 0x8800
v_mfma_f32_16x16x32_bf16 v[44:47], a[60:63], a[0:3], v[44:47]
buffer_load_dwordx4 v2, s[48:51], s12 offen lds
v_mfma_f32_16x16x32_bf16 v[48:51], a[64:67], a[0:3], v[48:51]
ds_read_b64_tr_b16 a[60:61], v13 offset:8704
v_mfma_f32_16x16x32_bf16 v[80:83], a[64:67], a[4:7], v[80:83]
ds_read_b64_tr_b16 a[62:63], v13 offset:9728
v_mfma_f32_16x16x32_bf16 v[112:115], a[64:67], a[8:11], v[112:115]
v_mfma_f32_16x16x32_bf16 v[144:147], a[64:67], a[12:15], v[144:147]
ds_read_b64_tr_b16 a[64:65], v12 offset:8960
v_mfma_f32_16x16x32_bf16 v[148:151], a[68:71], a[12:15], v[148:151]
s_add_u32 m0, s16, 0x8c00
ds_read_b64_tr_b16 a[66:67], v12 offset:9984
v_mfma_f32_16x16x32_bf16 v[116:119], a[68:71], a[8:11], v[116:119]
buffer_load_dwordx4 v3, s[48:51], s12 offen lds
v_mfma_f32_16x16x32_bf16 v[84:87], a[68:71], a[4:7], v[84:87]
v_mfma_f32_16x16x32_bf16 v[52:55], a[68:71], a[0:3], v[52:55]
ds_read_b64_tr_b16 a[68:69], v13 offset:8960
v_mfma_f32_16x16x32_bf16 v[152:155], a[0:3], a[72:75], v[152:155]
ds_read_b64_tr_b16 a[70:71], v13 offset:9984
v_mfma_f32_16x16x32_bf16 v[156:159], a[4:7], a[72:75], v[156:159]
v_mfma_f32_16x16x32_bf16 v[216:219], a[8:11], a[72:75], v[216:219]
v_mfma_f32_16x16x32_bf16 v[220:223], a[12:15], a[72:75], v[220:223]
s_add_u32 m0, s16, 0x9000
ds_read_b64_tr_b16 a[72:73], v12 offset:24576
v_mfma_f32_16x16x32_bf16 v[228:231], a[12:15], a[76:79], v[228:231]
buffer_load_dwordx4 v2, s[48:51], s13 offen lds
v_mfma_f32_16x16x32_bf16 v[224:227], a[8:11], a[76:79], v[224:227]
ds_read_b64_tr_b16 a[74:75], v12 offset:25600
v_mfma_f32_16x16x32_bf16 v[164:167], a[4:7], a[76:79], v[164:167]
v_mfma_f32_16x16x32_bf16 v[160:163], a[0:3], a[76:79], v[160:163]
ds_read_b64_tr_b16 a[76:77], v13 offset:24576
v_mfma_f32_16x16x32_bf16 v[168:171], a[0:3], a[80:83], v[168:171]
ds_read_b64_tr_b16 a[78:79], v13 offset:25600
v_mfma_f32_16x16x32_bf16 v[172:175], a[4:7], a[80:83], v[172:175]
s_add_u32 m0, s16, 0x9400
v_mfma_f32_16x16x32_bf16 v[232:235], a[8:11], a[80:83], v[232:235]
buffer_load_dwordx4 v3, s[48:51], s13 offen lds
v_mfma_f32_16x16x32_bf16 v[236:239], a[12:15], a[80:83], v[236:239]
ds_read_b64_tr_b16 a[80:81], v12 offset:24832
v_mfma_f32_16x16x32_bf16 v[244:247], a[12:15], a[84:87], v[244:247]
ds_read_b64_tr_b16 a[82:83], v12 offset:25856
v_mfma_f32_16x16x32_bf16 v[240:243], a[8:11], a[84:87], v[240:243]
v_mfma_f32_16x16x32_bf16 v[180:183], a[4:7], a[84:87], v[180:183]
v_mfma_f32_16x16x32_bf16 v[176:179], a[0:3], a[84:87], v[176:179]
ds_read_b64_tr_b16 a[84:85], v13 offset:24832
v_mfma_f32_16x16x32_bf16 v[184:187], a[0:3], a[88:91], v[184:187]
s_add_u32 m0, s16, 0x9800
ds_read_b64_tr_b16 a[86:87], v13 offset:25856
v_mfma_f32_16x16x32_bf16 v[188:191], a[4:7], a[88:91], v[188:191]
buffer_load_dwordx4 v2, s[48:51], s14 offen lds
v_mfma_f32_16x16x32_bf16 v[248:251], a[8:11], a[88:91], v[248:251]
v_mfma_f32_16x16x32_bf16 v[252:255], a[12:15], a[88:91], v[252:255]
ds_read_b64_tr_b16 a[88:89], v12 offset:25088
v_mfma_f32_16x16x32_bf16 a[236:239], a[12:15], a[92:95], a[236:239]
ds_read_b64_tr_b16 a[90:91], v12 offset:26112
v_mfma_f32_16x16x32_bf16 a[232:235], a[8:11], a[92:95], a[232:235]
v_mfma_f32_16x16x32_bf16 v[196:199], a[4:7], a[92:95], v[196:199]
s_add_u32 m0, s16, 0x9c00
v_mfma_f32_16x16x32_bf16 v[192:195], a[0:3], a[92:95], v[192:195]
buffer_load_dwordx4 v3, s[48:51], s14 offen lds
v_mfma_f32_16x16x32_bf16 v[200:203], a[0:3], a[96:99], v[200:203]
v_mfma_f32_16x16x32_bf16 v[204:207], a[4:7], a[96:99], v[204:207]
v_mfma_f32_16x16x32_bf16 a[240:243], a[8:11], a[96:99], a[240:243]
v_mfma_f32_16x16x32_bf16 a[244:247], a[12:15], a[96:99], a[244:247]
v_mfma_f32_16x16x32_bf16 a[252:255], a[12:15], a[100:103], a[252:255]
v_mfma_f32_16x16x32_bf16 a[248:251], a[8:11], a[100:103], a[248:251]
v_add_u32 v12, 0x8000, v12
v_mfma_f32_16x16x32_bf16 v[212:215], a[4:7], a[100:103], v[212:215]
v_add_u32 v13, 0x8000, v13
v_mfma_f32_16x16x32_bf16 v[208:211], a[0:3], a[100:103], v[208:211]
s_waitcnt vmcnt(16) lgkmcnt(0)
s_barrier
v_mfma_f32_16x16x32_bf16 v[24:27], a[40:43], a[20:23], v[24:27]
s_add_u32 m0, s17, 0x0
v_add_u32 v2, 0x80, v2
v_add_u32 v3, 0x80, v3
ds_read_b128 a[0:3], v8 offset:0
v_mfma_f32_16x16x32_bf16 v[56:59], a[40:43], a[24:27], v[56:59]
buffer_load_dwordx4 v5, s[56:59], 0 offen lds
v_mfma_f32_16x16x32_bf16 v[88:91], a[40:43], a[28:31], v[88:91]
ds_read_b128 a[4:7], v8 offset:2048
ds_read_b128 a[8:11], v8 offset:4096
v_mfma_f32_16x16x32_bf16 v[120:123], a[40:43], a[32:35], v[120:123]
ds_read_b128 a[12:15], v8 offset:6144
ds_read_b64_tr_b16 a[92:93], v13 offset:16896
v_mfma_f32_16x16x32_bf16 v[124:127], a[44:47], a[32:35], v[124:127]
ds_read_b64_tr_b16 a[94:95], v13 offset:17920
ds_read_b64_tr_b16 a[96:97], v12 offset:17152
v_mfma_f32_16x16x32_bf16 v[92:95], a[44:47], a[28:31], v[92:95]
ds_read_b64_tr_b16 a[98:99], v12 offset:18176
ds_read_b64_tr_b16 a[100:101], v13 offset:17152
v_mfma_f32_16x16x32_bf16 v[60:63], a[44:47], a[24:27], v[60:63]
ds_read_b64_tr_b16 a[102:103], v13 offset:18176
v_mfma_f32_16x16x32_bf16 v[28:31], a[44:47], a[20:23], v[28:31]
s_add_u32 m0, s17, 0x4000
ds_read_b64_tr_b16 a[40:41], v12 offset:0
ds_read_b64_tr_b16 a[42:43], v12 offset:1024
v_mfma_f32_16x16x32_bf16 v[32:35], a[48:51], a[20:23], v[32:35]
buffer_load_dwordx4 v5, s[60:63], 0 offen lds
v_mfma_f32_16x16x32_bf16 v[64:67], a[48:51], a[24:27], v[64:67]
ds_read_b64_tr_b16 a[44:45], v13 offset:0
v_mfma_f32_16x16x32_bf16 v[96:99], a[48:51], a[28:31], v[96:99]
ds_read_b64_tr_b16 a[46:47], v13 offset:1024
v_mfma_f32_16x16x32_bf16 v[128:131], a[48:51], a[32:35], v[128:131]
ds_read_b64_tr_b16 a[48:49], v12 offset:256
v_mfma_f32_16x16x32_bf16 v[132:135], a[52:55], a[32:35], v[132:135]
ds_read_b64_tr_b16 a[50:51], v12 offset:1280
v_mfma_f32_16x16x32_bf16 v[100:103], a[52:55], a[28:31], v[100:103]
v_mfma_f32_16x16x32_bf16 v[68:71], a[52:55], a[24:27], v[68:71]
v_mfma_f32_16x16x32_bf16 v[36:39], a[52:55], a[20:23], v[36:39]
s_add_u32 m0, s17, 0x400
ds_read_b64_tr_b16 a[52:53], v13 offset:256
v_mfma_f32_16x16x32_bf16 v[40:43], a[56:59], a[20:23], v[40:43]
buffer_load_dwordx4 v5, s[56:59], s13 offen lds
v_mfma_f32_16x16x32_bf16 v[72:75], a[56:59], a[24:27], v[72:75]
ds_read_b64_tr_b16 a[54:55], v13 offset:1280
v_mfma_f32_16x16x32_bf16 v[104:107], a[56:59], a[28:31], v[104:107]
v_mfma_f32_16x16x32_bf16 v[136:139], a[56:59], a[32:35], v[136:139]
ds_read_b64_tr_b16 a[56:57], v12 offset:512
v_mfma_f32_16x16x32_bf16 v[140:143], a[60:63], a[32:35], v[140:143]
ds_read_b64_tr_b16 a[58:59], v12 offset:1536
v_mfma_f32_16x16x32_bf16 v[108:111], a[60:63], a[28:31], v[108:111]
v_mfma_f32_16x16x32_bf16 v[76:79], a[60:63], a[24:27], v[76:79]
s_add_u32 m0, s17, 0x4400
v_mfma_f32_16x16x32_bf16 v[44:47], a[60:63], a[20:23], v[44:47]
buffer_load_dwordx4 v5, s[60:63], s13 offen lds
v_mfma_f32_16x16x32_bf16 v[48:51], a[64:67], a[20:23], v[48:51]
ds_read_b64_tr_b16 a[60:61], v13 offset:512
v_mfma_f32_16x16x32_bf16 v[80:83], a[64:67], a[24:27], v[80:83]
ds_read_b64_tr_b16 a[62:63], v13 offset:1536
v_mfma_f32_16x16x32_bf16 v[112:115], a[64:67], a[28:31], v[112:115]
v_mfma_f32_16x16x32_bf16 v[144:147], a[64:67], a[32:35], v[144:147]
ds_read_b64_tr_b16 a[64:65], v12 offset:768
v_mfma_f32_16x16x32_bf16 v[148:151], a[68:71], a[32:35], v[148:151]
ds_read_b64_tr_b16 a[66:67], v12 offset:1792
v_mfma_f32_16x16x32_bf16 v[116:119], a[68:71], a[28:31], v[116:119]
v_mfma_f32_16x16x32_bf16 v[84:87], a[68:71], a[24:27], v[84:87]
s_add_u32 m0, s17, 0x800
v_mfma_f32_16x16x32_bf16 v[52:55], a[68:71], a[20:23], v[52:55]
buffer_load_dwordx4 v6, s[56:59], 0 offen lds
v_mfma_f32_16x16x32_bf16 v[152:155], a[20:23], a[72:75], v[152:155]
ds_read_b64_tr_b16 a[68:69], v13 offset:768
v_mfma_f32_16x16x32_bf16 v[156:159], a[24:27], a[72:75], v[156:159]
ds_read_b64_tr_b16 a[70:71], v13 offset:1792
v_mfma_f32_16x16x32_bf16 v[216:219], a[28:31], a[72:75], v[216:219]
v_mfma_f32_16x16x32_bf16 v[220:223], a[32:35], a[72:75], v[220:223]
ds_read_b64_tr_b16 a[72:73], v12 offset:16384
v_mfma_f32_16x16x32_bf16 v[228:231], a[32:35], a[76:79], v[228:231]
ds_read_b64_tr_b16 a[74:75], v12 offset:17408
v_mfma_f32_16x16x32_bf16 v[224:227], a[28:31], a[76:79], v[224:227]
v_mfma_f32_16x16x32_bf16 v[164:167], a[24:27], a[76:79], v[164:167]
s_add_u32 m0, s17, 0x4800
v_mfma_f32_16x16x32_bf16 v[160:163], a[20:23], a[76:79], v[160:163]
buffer_load_dwordx4 v6, s[60:63], 0 offen lds
v_mfma_f32_16x16x32_bf16 v[168:171], a[20:23], a[80:83], v[168:171]
ds_read_b64_tr_b16 a[76:77], v13 offset:16384
v_mfma_f32_16x16x32_bf16 v[172:175], a[24:27], a[80:83], v[172:175]
ds_read_b64_tr_b16 a[78:79], v13 offset:17408
v_mfma_f32_16x16x32_bf16 v[232:235], a[28:31], a[80:83], v[232:235]
v_mfma_f32_16x16x32_bf16 v[236:239], a[32:35], a[80:83], v[236:239]
ds_read_b64_tr_b16 a[80:81], v12 offset:16640
v_mfma_f32_16x16x32_bf16 v[244:247], a[32:35], a[84:87], v[244:247]
ds_read_b64_tr_b16 a[82:83], v12 offset:17664
v_mfma_f32_16x16x32_bf16 v[240:243], a[28:31], a[84:87], v[240:243]
s_add_u32 m0, s17, 0xc00
v_mfma_f32_16x16x32_bf16 v[180:183], a[24:27], a[84:87], v[180:183]
buffer_load_dwordx4 v6, s[56:59], s13 offen lds
v_mfma_f32_16x16x32_bf16 v[176:179], a[20:23], a[84:87], v[176:179]
ds_read_b64_tr_b16 a[84:85], v13 offset:16640
v_mfma_f32_16x16x32_bf16 v[184:187], a[20:23], a[88:91], v[184:187]
ds_read_b64_tr_b16 a[86:87], v13 offset:17664
v_mfma_f32_16x16x32_bf16 v[188:191], a[24:27], a[88:91], v[188:191]
v_mfma_f32_16x16x32_bf16 v[248:251], a[28:31], a[88:91], v[248:251]
v_mfma_f32_16x16x32_bf16 v[252:255], a[32:35], a[88:91], v[252:255]
ds_read_b64_tr_b16 a[88:89], v12 offset:16896
v_mfma_f32_16x16x32_bf16 a[236:239], a[32:35], a[104:107], a[236:239]
ds_read_b64_tr_b16 a[90:91], v12 offset:17920
v_mfma_f32_16x16x32_bf16 a[232:235], a[28:31], a[104:107], a[232:235]
s_add_u32 m0, s17, 0x4c00
v_mfma_f32_16x16x32_bf16 v[196:199], a[24:27], a[104:107], v[196:199]
buffer_load_dwordx4 v6, s[60:63], s13 offen lds
v_mfma_f32_16x16x32_bf16 v[192:195], a[20:23], a[104:107], v[192:195]
v_mfma_f32_16x16x32_bf16 v[200:203], a[20:23], a[108:111], v[200:203]
v_mfma_f32_16x16x32_bf16 v[204:207], a[24:27], a[108:111], v[204:207]
v_mfma_f32_16x16x32_bf16 a[240:243], a[28:31], a[108:111], a[240:243]
v_mfma_f32_16x16x32_bf16 a[244:247], a[32:35], a[108:111], a[244:247]
v_mfma_f32_16x16x32_bf16 a[252:255], a[32:35], a[112:115], a[252:255]
v_mfma_f32_16x16x32_bf16 a[248:251], a[28:31], a[112:115], a[248:251]
v_mfma_f32_16x16x32_bf16 v[212:215], a[24:27], a[112:115], v[212:215]
v_mfma_f32_16x16x32_bf16 v[208:211], a[20:23], a[112:115], v[208:211]
s_waitcnt lgkmcnt(0)
v_mfma_f32_16x16x32_bf16 v[24:27], a[40:43], a[0:3], v[24:27]
v_add_u32 v5, 0x80000, v5
v_add_u32 v6, 0x80000, v6
ds_read_b128 a[20:23], v9 offset:0
v_mfma_f32_16x16x32_bf16 v[56:59], a[40:43], a[4:7], v[56:59]
ds_read_b128 a[24:27], v9 offset:2048
ds_read_b128 a[28:31], v9 offset:4096
v_mfma_f32_16x16x32_bf16 v[88:91], a[40:43], a[8:11], v[88:91]
ds_read_b128 a[32:35], v9 offset:6144
ds_read_b64_tr_b16 a[104:105], v13 offset:25088
v_mfma_f32_16x16x32_bf16 v[120:123], a[40:43], a[12:15], v[120:123]
ds_read_b64_tr_b16 a[106:107], v13 offset:26112
ds_read_b64_tr_b16 a[108:109], v12 offset:25344
v_mfma_f32_16x16x32_bf16 v[124:127], a[44:47], a[12:15], v[124:127]
ds_read_b64_tr_b16 a[110:111], v12 offset:26368
ds_read_b64_tr_b16 a[112:113], v13 offset:25344
v_mfma_f32_16x16x32_bf16 v[92:95], a[44:47], a[8:11], v[92:95]
ds_read_b64_tr_b16 a[114:115], v13 offset:26368
v_mfma_f32_16x16x32_bf16 v[60:63], a[44:47], a[4:7], v[60:63]
ds_read_b64_tr_b16 a[40:41], v12 offset:8192
v_mfma_f32_16x16x32_bf16 v[28:31], a[44:47], a[0:3], v[28:31]
ds_read_b64_tr_b16 a[42:43], v12 offset:9216
v_mfma_f32_16x16x32_bf16 v[32:35], a[48:51], a[0:3], v[32:35]
ds_read_b64_tr_b16 a[44:45], v13 offset:8192
v_mfma_f32_16x16x32_bf16 v[64:67], a[48:51], a[4:7], v[64:67]
s_add_u32 m0, s16, 0x0
ds_read_b64_tr_b16 a[46:47], v13 offset:9216
s_waitcnt lgkmcnt(10)
v_mfma_f32_16x16x32_bf16 v[96:99], a[48:51], a[8:11], v[96:99]
buffer_load_dwordx4 v2, s[48:51], 0 offen lds
v_mfma_f32_16x16x32_bf16 v[128:131], a[48:51], a[12:15], v[128:131]
ds_read_b64_tr_b16 a[48:49], v12 offset:8448
v_mfma_f32_16x16x32_bf16 v[132:135], a[52:55], a[12:15], v[132:135]
ds_read_b64_tr_b16 a[50:51], v12 offset:9472
v_mfma_f32_16x16x32_bf16 v[100:103], a[52:55], a[8:11], v[100:103]
v_mfma_f32_16x16x32_bf16 v[68:71], a[52:55], a[4:7], v[68:71]
v_mfma_f32_16x16x32_bf16 v[36:39], a[52:55], a[0:3], v[36:39]
s_add_u32 m0, s16, 0x400
ds_read_b64_tr_b16 a[52:53], v13 offset:8448
v_mfma_f32_16x16x32_bf16 v[40:43], a[56:59], a[0:3], v[40:43]
buffer_load_dwordx4 v3, s[48:51], 0 offen lds
v_mfma_f32_16x16x32_bf16 v[72:75], a[56:59], a[4:7], v[72:75]
ds_read_b64_tr_b16 a[54:55], v13 offset:9472
v_mfma_f32_16x16x32_bf16 v[104:107], a[56:59], a[8:11], v[104:107]
v_mfma_f32_16x16x32_bf16 v[136:139], a[56:59], a[12:15], v[136:139]
ds_read_b64_tr_b16 a[56:57], v12 offset:8704
v_mfma_f32_16x16x32_bf16 v[140:143], a[60:63], a[12:15], v[140:143]
ds_read_b64_tr_b16 a[58:59], v12 offset:9728
v_mfma_f32_16x16x32_bf16 v[108:111], a[60:63], a[8:11], v[108:111]
v_mfma_f32_16x16x32_bf16 v[76:79], a[60:63], a[4:7], v[76:79]
s_add_u32 m0, s16, 0x800
v_mfma_f32_16x16x32_bf16 v[44:47], a[60:63], a[0:3], v[44:47]
buffer_load_dwordx4 v2, s[48:51], s12 offen lds
v_mfma_f32_16x16x32_bf16 v[48:51], a[64:67], a[0:3], v[48:51]
ds_read_b64_tr_b16 a[60:61], v13 offset:8704
v_mfma_f32_16x16x32_bf16 v[80:83], a[64:67], a[4:7], v[80:83]
ds_read_b64_tr_b16 a[62:63], v13 offset:9728
v_mfma_f32_16x16x32_bf16 v[112:115], a[64:67], a[8:11], v[112:115]
v_mfma_f32_16x16x32_bf16 v[144:147], a[64:67], a[12:15], v[144:147]
ds_read_b64_tr_b16 a[64:65], v12 offset:8960
v_mfma_f32_16x16x32_bf16 v[148:151], a[68:71], a[12:15], v[148:151]
s_add_u32 m0, s16, 0xc00
ds_read_b64_tr_b16 a[66:67], v12 offset:9984
v_mfma_f32_16x16x32_bf16 v[116:119], a[68:71], a[8:11], v[116:119]
buffer_load_dwordx4 v3, s[48:51], s12 offen lds
v_mfma_f32_16x16x32_bf16 v[84:87], a[68:71], a[4:7], v[84:87]
v_mfma_f32_16x16x32_bf16 v[52:55], a[68:71], a[0:3], v[52:55]
ds_read_b64_tr_b16 a[68:69], v13 offset:8960
v_mfma_f32_16x16x32_bf16 v[152:155], a[0:3], a[72:75], v[152:155]
ds_read_b64_tr_b16 a[70:71], v13 offset:9984
v_mfma_f32_16x16x32_bf16 v[156:159], a[4:7], a[72:75], v[156:159]
v_mfma_f32_16x16x32_bf16 v[216:219], a[8:11], a[72:75], v[216:219]
v_mfma_f32_16x16x32_bf16 v[220:223], a[12:15], a[72:75], v[220:223]
s_add_u32 m0, s16, 0x1000
ds_read_b64_tr_b16 a[72:73], v12 offset:24576
v_mfma_f32_16x16x32_bf16 v[228:231], a[12:15], a[76:79], v[228:231]
buffer_load_dwordx4 v2, s[48:51], s13 offen lds
v_mfma_f32_16x16x32_bf16 v[224:227], a[8:11], a[76:79], v[224:227]
ds_read_b64_tr_b16 a[74:75], v12 offset:25600
v_mfma_f32_16x16x32_bf16 v[164:167], a[4:7], a[76:79], v[164:167]
v_mfma_f32_16x16x32_bf16 v[160:163], a[0:3], a[76:79], v[160:163]
ds_read_b64_tr_b16 a[76:77], v13 offset:24576
v_mfma_f32_16x16x32_bf16 v[168:171], a[0:3], a[80:83], v[168:171]
ds_read_b64_tr_b16 a[78:79], v13 offset:25600
v_mfma_f32_16x16x32_bf16 v[172:175], a[4:7], a[80:83], v[172:175]
s_add_u32 m0, s16, 0x1400
v_mfma_f32_16x16x32_bf16 v[232:235], a[8:11], a[80:83], v[232:235]
buffer_load_dwordx4 v3, s[48:51], s13 offen lds
v_mfma_f32_16x16x32_bf16 v[236:239], a[12:15], a[80:83], v[236:239]
ds_read_b64_tr_b16 a[80:81], v12 offset:24832
v_mfma_f32_16x16x32_bf16 v[244:247], a[12:15], a[84:87], v[244:247]
ds_read_b64_tr_b16 a[82:83], v12 offset:25856
v_mfma_f32_16x16x32_bf16 v[240:243], a[8:11], a[84:87], v[240:243]
v_mfma_f32_16x16x32_bf16 v[180:183], a[4:7], a[84:87], v[180:183]
v_mfma_f32_16x16x32_bf16 v[176:179], a[0:3], a[84:87], v[176:179]
ds_read_b64_tr_b16 a[84:85], v13 offset:24832
v_mfma_f32_16x16x32_bf16 v[184:187], a[0:3], a[88:91], v[184:187]
s_add_u32 m0, s16, 0x1800
ds_read_b64_tr_b16 a[86:87], v13 offset:25856
v_mfma_f32_16x16x32_bf16 v[188:191], a[4:7], a[88:91], v[188:191]
buffer_load_dwordx4 v2, s[48:51], s14 offen lds
v_mfma_f32_16x16x32_bf16 v[248:251], a[8:11], a[88:91], v[248:251]
v_mfma_f32_16x16x32_bf16 v[252:255], a[12:15], a[88:91], v[252:255]
ds_read_b64_tr_b16 a[88:89], v12 offset:25088
v_mfma_f32_16x16x32_bf16 a[236:239], a[12:15], a[92:95], a[236:239]
ds_read_b64_tr_b16 a[90:91], v12 offset:26112
v_mfma_f32_16x16x32_bf16 a[232:235], a[8:11], a[92:95], a[232:235]
v_mfma_f32_16x16x32_bf16 v[196:199], a[4:7], a[92:95], v[196:199]
s_add_u32 m0, s16, 0x1c00
v_mfma_f32_16x16x32_bf16 v[192:195], a[0:3], a[92:95], v[192:195]
buffer_load_dwordx4 v3, s[48:51], s14 offen lds
v_mfma_f32_16x16x32_bf16 v[200:203], a[0:3], a[96:99], v[200:203]
v_mfma_f32_16x16x32_bf16 v[204:207], a[4:7], a[96:99], v[204:207]
v_mfma_f32_16x16x32_bf16 a[240:243], a[8:11], a[96:99], a[240:243]
v_mfma_f32_16x16x32_bf16 a[244:247], a[12:15], a[96:99], a[244:247]
v_mfma_f32_16x16x32_bf16 a[252:255], a[12:15], a[100:103], a[252:255]
v_mfma_f32_16x16x32_bf16 a[248:251], a[8:11], a[100:103], a[248:251]
v_add_u32 v12, 0x8000, v12
v_mfma_f32_16x16x32_bf16 v[212:215], a[4:7], a[100:103], v[212:215]
v_add_u32 v13, 0x8000, v13
v_mfma_f32_16x16x32_bf16 v[208:211], a[0:3], a[100:103], v[208:211]
s_waitcnt vmcnt(16) lgkmcnt(0)
s_barrier
v_mfma_f32_16x16x32_bf16 v[24:27], a[40:43], a[20:23], v[24:27]
s_add_u32 m0, s17, 0x8000
v_add_u32 v2, 0x80, v2
v_add_u32 v3, 0x80, v3
ds_read_b128 a[0:3], v8 offset:32768
v_mfma_f32_16x16x32_bf16 v[56:59], a[40:43], a[24:27], v[56:59]
buffer_load_dwordx4 v5, s[56:59], 0 offen lds
v_mfma_f32_16x16x32_bf16 v[88:91], a[40:43], a[28:31], v[88:91]
ds_read_b128 a[4:7], v8 offset:34816
ds_read_b128 a[8:11], v8 offset:36864
v_mfma_f32_16x16x32_bf16 v[120:123], a[40:43], a[32:35], v[120:123]
ds_read_b128 a[12:15], v8 offset:38912
ds_read_b64_tr_b16 a[92:93], v13 offset:16896
v_mfma_f32_16x16x32_bf16 v[124:127], a[44:47], a[32:35], v[124:127]
ds_read_b64_tr_b16 a[94:95], v13 offset:17920
ds_read_b64_tr_b16 a[96:97], v12 offset:17152
v_mfma_f32_16x16x32_bf16 v[92:95], a[44:47], a[28:31], v[92:95]
ds_read_b64_tr_b16 a[98:99], v12 offset:18176
ds_read_b64_tr_b16 a[100:101], v13 offset:17152
v_mfma_f32_16x16x32_bf16 v[60:63], a[44:47], a[24:27], v[60:63]
ds_read_b64_tr_b16 a[102:103], v13 offset:18176
v_mfma_f32_16x16x32_bf16 v[28:31], a[44:47], a[20:23], v[28:31]
s_add_u32 m0, s17, 0xc000
ds_read_b64_tr_b16 a[40:41], v12 offset:0
ds_read_b64_tr_b16 a[42:43], v12 offset:1024
v_mfma_f32_16x16x32_bf16 v[32:35], a[48:51], a[20:23], v[32:35]
buffer_load_dwordx4 v5, s[60:63], 0 offen lds
v_mfma_f32_16x16x32_bf16 v[64:67], a[48:51], a[24:27], v[64:67]
ds_read_b64_tr_b16 a[44:45], v13 offset:0
v_mfma_f32_16x16x32_bf16 v[96:99], a[48:51], a[28:31], v[96:99]
ds_read_b64_tr_b16 a[46:47], v13 offset:1024
v_mfma_f32_16x16x32_bf16 v[128:131], a[48:51], a[32:35], v[128:131]
ds_read_b64_tr_b16 a[48:49], v12 offset:256
v_mfma_f32_16x16x32_bf16 v[132:135], a[52:55], a[32:35], v[132:135]
ds_read_b64_tr_b16 a[50:51], v12 offset:1280
v_mfma_f32_16x16x32_bf16 v[100:103], a[52:55], a[28:31], v[100:103]
v_mfma_f32_16x16x32_bf16 v[68:71], a[52:55], a[24:27], v[68:71]
v_mfma_f32_16x16x32_bf16 v[36:39], a[52:55], a[20:23], v[36:39]
s_add_u32 m0, s17, 0x8400
ds_read_b64_tr_b16 a[52:53], v13 offset:256
v_mfma_f32_16x16x32_bf16 v[40:43], a[56:59], a[20:23], v[40:43]
buffer_load_dwordx4 v5, s[56:59], s13 offen lds
v_mfma_f32_16x16x32_bf16 v[72:75], a[56:59], a[24:27], v[72:75]
ds_read_b64_tr_b16 a[54:55], v13 offset:1280
v_mfma_f32_16x16x32_bf16 v[104:107], a[56:59], a[28:31], v[104:107]
v_mfma_f32_16x16x32_bf16 v[136:139], a[56:59], a[32:35], v[136:139]
ds_read_b64_tr_b16 a[56:57], v12 offset:512
v_mfma_f32_16x16x32_bf16 v[140:143], a[60:63], a[32:35], v[140:143]
ds_read_b64_tr_b16 a[58:59], v12 offset:1536
v_mfma_f32_16x16x32_bf16 v[108:111], a[60:63], a[28:31], v[108:111]
v_mfma_f32_16x16x32_bf16 v[76:79], a[60:63], a[24:27], v[76:79]
s_add_u32 m0, s17, 0xc400
v_mfma_f32_16x16x32_bf16 v[44:47], a[60:63], a[20:23], v[44:47]
buffer_load_dwordx4 v5, s[60:63], s13 offen lds
v_mfma_f32_16x16x32_bf16 v[48:51], a[64:67], a[20:23], v[48:51]
ds_read_b64_tr_b16 a[60:61], v13 offset:512
v_mfma_f32_16x16x32_bf16 v[80:83], a[64:67], a[24:27], v[80:83]
ds_read_b64_tr_b16 a[62:63], v13 offset:1536
v_mfma_f32_16x16x32_bf16 v[112:115], a[64:67], a[28:31], v[112:115]
v_mfma_f32_16x16x32_bf16 v[144:147], a[64:67], a[32:35], v[144:147]
ds_read_b64_tr_b16 a[64:65], v12 offset:768
v_mfma_f32_16x16x32_bf16 v[148:151], a[68:71], a[32:35], v[148:151]
ds_read_b64_tr_b16 a[66:67], v12 offset:1792
v_mfma_f32_16x16x32_bf16 v[116:119], a[68:71], a[28:31], v[116:119]
v_mfma_f32_16x16x32_bf16 v[84:87], a[68:71], a[24:27], v[84:87]
s_add_u32 m0, s17, 0x8800
v_mfma_f32_16x16x32_bf16 v[52:55], a[68:71], a[20:23], v[52:55]
buffer_load_dwordx4 v6, s[56:59], 0 offen lds
v_mfma_f32_16x16x32_bf16 v[152:155], a[20:23], a[72:75], v[152:155]
ds_read_b64_tr_b16 a[68:69], v13 offset:768
v_mfma_f32_16x16x32_bf16 v[156:159], a[24:27], a[72:75], v[156:159]
ds_read_b64_tr_b16 a[70:71], v13 offset:1792
v_mfma_f32_16x16x32_bf16 v[216:219], a[28:31], a[72:75], v[216:219]
v_mfma_f32_16x16x32_bf16 v[220:223], a[32:35], a[72:75], v[220:223]
ds_read_b64_tr_b16 a[72:73], v12 offset:16384
v_mfma_f32_16x16x32_bf16 v[228:231], a[32:35], a[76:79], v[228:231]
ds_read_b64_tr_b16 a[74:75], v12 offset:17408
v_mfma_f32_16x16x32_bf16 v[224:227], a[28:31], a[76:79], v[224:227]
v_mfma_f32_16x16x32_bf16 v[164:167], a[24:27], a[76:79], v[164:167]
s_add_u32 m0, s17, 0xc800
v_mfma_f32_16x16x32_bf16 v[160:163], a[20:23], a[76:79], v[160:163]
buffer_load_dwordx4 v6, s[60:63], 0 offen lds
v_mfma_f32_16x16x32_bf16 v[168:171], a[20:23], a[80:83], v[168:171]
ds_read_b64_tr_b16 a[76:77], v13 offset:16384
v_mfma_f32_16x16x32_bf16 v[172:175], a[24:27], a[80:83], v[172:175]
ds_read_b64_tr_b16 a[78:79], v13 offset:17408
v_mfma_f32_16x16x32_bf16 v[232:235], a[28:31], a[80:83], v[232:235]
v_mfma_f32_16x16x32_bf16 v[236:239], a[32:35], a[80:83], v[236:239]
ds_read_b64_tr_b16 a[80:81], v12 offset:16640
v_mfma_f32_16x16x32_bf16 v[244:247], a[32:35], a[84:87], v[244:247]
ds_read_b64_tr_b16 a[82:83], v12 offset:17664
v_mfma_f32_16x16x32_bf16 v[240:243], a[28:31], a[84:87], v[240:243]
s_add_u32 m0, s17, 0x8c00
v_mfma_f32_16x16x32_bf16 v[180:183], a[24:27], a[84:87], v[180:183]
buffer_load_dwordx4 v6, s[56:59], s13 offen lds
v_mfma_f32_16x16x32_bf16 v[176:179], a[20:23], a[84:87], v[176:179]
ds_read_b64_tr_b16 a[84:85], v13 offset:16640
v_mfma_f32_16x16x32_bf16 v[184:187], a[20:23], a[88:91], v[184:187]
ds_read_b64_tr_b16 a[86:87], v13 offset:17664
v_mfma_f32_16x16x32_bf16 v[188:191], a[24:27], a[88:91], v[188:191]
v_mfma_f32_16x16x32_bf16 v[248:251], a[28:31], a[88:91], v[248:251]
v_mfma_f32_16x16x32_bf16 v[252:255], a[32:35], a[88:91], v[252:255]
ds_read_b64_tr_b16 a[88:89], v12 offset:16896
v_mfma_f32_16x16x32_bf16 a[236:239], a[32:35], a[104:107], a[236:239]
ds_read_b64_tr_b16 a[90:91], v12 offset:17920
v_mfma_f32_16x16x32_bf16 a[232:235], a[28:31], a[104:107], a[232:235]
s_add_u32 m0, s17, 0xcc00
v_mfma_f32_16x16x32_bf16 v[196:199], a[24:27], a[104:107], v[196:199]
buffer_load_dwordx4 v6, s[60:63], s13 offen lds
v_mfma_f32_16x16x32_bf16 v[192:195], a[20:23], a[104:107], v[192:195]
v_mfma_f32_16x16x32_bf16 v[200:203], a[20:23], a[108:111], v[200:203]
v_mfma_f32_16x16x32_bf16 v[204:207], a[24:27], a[108:111], v[204:207]
v_mfma_f32_16x16x32_bf16 a[240:243], a[28:31], a[108:111], a[240:243]
v_mfma_f32_16x16x32_bf16 a[244:247], a[32:35], a[108:111], a[244:247]
v_mfma_f32_16x16x32_bf16 a[252:255], a[32:35], a[112:115], a[252:255]
v_mfma_f32_16x16x32_bf16 a[248:251], a[28:31], a[112:115], a[248:251]
v_mfma_f32_16x16x32_bf16 v[212:215], a[24:27], a[112:115], v[212:215]
v_mfma_f32_16x16x32_bf16 v[208:211], a[20:23], a[112:115], v[208:211]
s_waitcnt lgkmcnt(0)
v_mfma_f32_16x16x32_bf16 v[24:27], a[40:43], a[0:3], v[24:27]
v_add_u32 v5, 0xffc80000, v5
v_add_u32 v6, 0xffc80000, v6
ds_read_b128 a[20:23], v9 offset:32768
v_mfma_f32_16x16x32_bf16 v[56:59], a[40:43], a[4:7], v[56:59]
ds_read_b128 a[24:27], v9 offset:34816
ds_read_b128 a[28:31], v9 offset:36864
v_mfma_f32_16x16x32_bf16 v[88:91], a[40:43], a[8:11], v[88:91]
ds_read_b128 a[32:35], v9 offset:38912
ds_read_b64_tr_b16 a[104:105], v13 offset:25088
v_mfma_f32_16x16x32_bf16 v[120:123], a[40:43], a[12:15], v[120:123]
ds_read_b64_tr_b16 a[106:107], v13 offset:26112
ds_read_b64_tr_b16 a[108:109], v12 offset:25344
v_mfma_f32_16x16x32_bf16 v[124:127], a[44:47], a[12:15], v[124:127]
ds_read_b64_tr_b16 a[110:111], v12 offset:26368
ds_read_b64_tr_b16 a[112:113], v13 offset:25344
v_mfma_f32_16x16x32_bf16 v[92:95], a[44:47], a[8:11], v[92:95]
ds_read_b64_tr_b16 a[114:115], v13 offset:26368
v_mfma_f32_16x16x32_bf16 v[60:63], a[44:47], a[4:7], v[60:63]
ds_read_b64_tr_b16 a[40:41], v12 offset:8192
v_mfma_f32_16x16x32_bf16 v[28:31], a[44:47], a[0:3], v[28:31]
ds_read_b64_tr_b16 a[42:43], v12 offset:9216
v_mfma_f32_16x16x32_bf16 v[32:35], a[48:51], a[0:3], v[32:35]
ds_read_b64_tr_b16 a[44:45], v13 offset:8192
v_mfma_f32_16x16x32_bf16 v[64:67], a[48:51], a[4:7], v[64:67]
s_add_u32 m0, s16, 0x8000
ds_read_b64_tr_b16 a[46:47], v13 offset:9216
s_waitcnt lgkmcnt(10)
v_mfma_f32_16x16x32_bf16 v[96:99], a[48:51], a[8:11], v[96:99]
buffer_load_dwordx4 v2, s[48:51], 0 offen lds
v_mfma_f32_16x16x32_bf16 v[128:131], a[48:51], a[12:15], v[128:131]
ds_read_b64_tr_b16 a[48:49], v12 offset:8448
v_mfma_f32_16x16x32_bf16 v[132:135], a[52:55], a[12:15], v[132:135]
ds_read_b64_tr_b16 a[50:51], v12 offset:9472
v_mfma_f32_16x16x32_bf16 v[100:103], a[52:55], a[8:11], v[100:103]
v_mfma_f32_16x16x32_bf16 v[68:71], a[52:55], a[4:7], v[68:71]
v_mfma_f32_16x16x32_bf16 v[36:39], a[52:55], a[0:3], v[36:39]
s_add_u32 m0, s16, 0x8400
ds_read_b64_tr_b16 a[52:53], v13 offset:8448
v_mfma_f32_16x16x32_bf16 v[40:43], a[56:59], a[0:3], v[40:43]
buffer_load_dwordx4 v3, s[48:51], 0 offen lds
v_mfma_f32_16x16x32_bf16 v[72:75], a[56:59], a[4:7], v[72:75]
ds_read_b64_tr_b16 a[54:55], v13 offset:9472
v_mfma_f32_16x16x32_bf16 v[104:107], a[56:59], a[8:11], v[104:107]
v_mfma_f32_16x16x32_bf16 v[136:139], a[56:59], a[12:15], v[136:139]
ds_read_b64_tr_b16 a[56:57], v12 offset:8704
v_mfma_f32_16x16x32_bf16 v[140:143], a[60:63], a[12:15], v[140:143]
ds_read_b64_tr_b16 a[58:59], v12 offset:9728
v_mfma_f32_16x16x32_bf16 v[108:111], a[60:63], a[8:11], v[108:111]
v_mfma_f32_16x16x32_bf16 v[76:79], a[60:63], a[4:7], v[76:79]
s_add_u32 m0, s16, 0x8800
v_mfma_f32_16x16x32_bf16 v[44:47], a[60:63], a[0:3], v[44:47]
buffer_load_dwordx4 v2, s[48:51], s12 offen lds
v_mfma_f32_16x16x32_bf16 v[48:51], a[64:67], a[0:3], v[48:51]
ds_read_b64_tr_b16 a[60:61], v13 offset:8704
v_mfma_f32_16x16x32_bf16 v[80:83], a[64:67], a[4:7], v[80:83]
ds_read_b64_tr_b16 a[62:63], v13 offset:9728
v_mfma_f32_16x16x32_bf16 v[112:115], a[64:67], a[8:11], v[112:115]
v_mfma_f32_16x16x32_bf16 v[144:147], a[64:67], a[12:15], v[144:147]
ds_read_b64_tr_b16 a[64:65], v12 offset:8960
v_mfma_f32_16x16x32_bf16 v[148:151], a[68:71], a[12:15], v[148:151]
s_add_u32 m0, s16, 0x8c00
ds_read_b64_tr_b16 a[66:67], v12 offset:9984
v_mfma_f32_16x16x32_bf16 v[116:119], a[68:71], a[8:11], v[116:119]
buffer_load_dwordx4 v3, s[48:51], s12 offen lds
v_mfma_f32_16x16x32_bf16 v[84:87], a[68:71], a[4:7], v[84:87]
v_mfma_f32_16x16x32_bf16 v[52:55], a[68:71], a[0:3], v[52:55]
ds_read_b64_tr_b16 a[68:69], v13 offset:8960
v_mfma_f32_16x16x32_bf16 v[152:155], a[0:3], a[72:75], v[152:155]
ds_read_b64_tr_b16 a[70:71], v13 offset:9984
v_mfma_f32_16x16x32_bf16 v[156:159], a[4:7], a[72:75], v[156:159]
v_mfma_f32_16x16x32_bf16 v[216:219], a[8:11], a[72:75], v[216:219]
v_mfma_f32_16x16x32_bf16 v[220:223], a[12:15], a[72:75], v[220:223]
s_add_u32 m0, s16, 0x9000
ds_read_b64_tr_b16 a[72:73], v12 offset:24576
v_mfma_f32_16x16x32_bf16 v[228:231], a[12:15], a[76:79], v[228:231]
buffer_load_dwordx4 v2, s[48:51], s13 offen lds
v_mfma_f32_16x16x32_bf16 v[224:227], a[8:11], a[76:79], v[224:227]
ds_read_b64_tr_b16 a[74:75], v12 offset:25600
v_mfma_f32_16x16x32_bf16 v[164:167], a[4:7], a[76:79], v[164:167]
v_mfma_f32_16x16x32_bf16 v[160:163], a[0:3], a[76:79], v[160:163]
ds_read_b64_tr_b16 a[76:77], v13 offset:24576
v_mfma_f32_16x16x32_bf16 v[168:171], a[0:3], a[80:83], v[168:171]
ds_read_b64_tr_b16 a[78:79], v13 offset:25600
v_mfma_f32_16x16x32_bf16 v[172:175], a[4:7], a[80:83], v[172:175]
s_add_u32 m0, s16, 0x9400
v_mfma_f32_16x16x32_bf16 v[232:235], a[8:11], a[80:83], v[232:235]
buffer_load_dwordx4 v3, s[48:51], s13 offen lds
v_mfma_f32_16x16x32_bf16 v[236:239], a[12:15], a[80:83], v[236:239]
ds_read_b64_tr_b16 a[80:81], v12 offset:24832
v_mfma_f32_16x16x32_bf16 v[244:247], a[12:15], a[84:87], v[244:247]
ds_read_b64_tr_b16 a[82:83], v12 offset:25856
v_mfma_f32_16x16x32_bf16 v[240:243], a[8:11], a[84:87], v[240:243]
v_mfma_f32_16x16x32_bf16 v[180:183], a[4:7], a[84:87], v[180:183]
v_mfma_f32_16x16x32_bf16 v[176:179], a[0:3], a[84:87], v[176:179]
ds_read_b64_tr_b16 a[84:85], v13 offset:24832
v_mfma_f32_16x16x32_bf16 v[184:187], a[0:3], a[88:91], v[184:187]
s_add_u32 m0, s16, 0x9800
ds_read_b64_tr_b16 a[86:87], v13 offset:25856
v_mfma_f32_16x16x32_bf16 v[188:191], a[4:7], a[88:91], v[188:191]
buffer_load_dwordx4 v2, s[48:51], s14 offen lds
v_mfma_f32_16x16x32_bf16 v[248:251], a[8:11], a[88:91], v[248:251]
v_mfma_f32_16x16x32_bf16 v[252:255], a[12:15], a[88:91], v[252:255]
ds_read_b64_tr_b16 a[88:89], v12 offset:25088
v_mfma_f32_16x16x32_bf16 a[236:239], a[12:15], a[92:95], a[236:239]
ds_read_b64_tr_b16 a[90:91], v12 offset:26112
v_mfma_f32_16x16x32_bf16 a[232:235], a[8:11], a[92:95], a[232:235]
v_mfma_f32_16x16x32_bf16 v[196:199], a[4:7], a[92:95], v[196:199]
s_add_u32 m0, s16, 0x9c00
v_mfma_f32_16x16x32_bf16 v[192:195], a[0:3], a[92:95], v[192:195]
buffer_load_dwordx4 v3, s[48:51], s14 offen lds
v_mfma_f32_16x16x32_bf16 v[200:203], a[0:3], a[96:99], v[200:203]
v_mfma_f32_16x16x32_bf16 v[204:207], a[4:7], a[96:99], v[204:207]
v_mfma_f32_16x16x32_bf16 a[240:243], a[8:11], a[96:99], a[240:243]
v_mfma_f32_16x16x32_bf16 a[244:247], a[12:15], a[96:99], a[244:247]
v_mfma_f32_16x16x32_bf16 a[252:255], a[12:15], a[100:103], a[252:255]
v_mfma_f32_16x16x32_bf16 a[248:251], a[8:11], a[100:103], a[248:251]
v_add_u32 v12, 0xffff0000, v12
v_mfma_f32_16x16x32_bf16 v[212:215], a[4:7], a[100:103], v[212:215]
v_add_u32 v13, 0xffff0000, v13
v_mfma_f32_16x16x32_bf16 v[208:211], a[0:3], a[100:103], v[208:211]
s_waitcnt vmcnt(16) lgkmcnt(0)
s_barrier
v_mfma_f32_16x16x32_bf16 v[24:27], a[40:43], a[20:23], v[24:27]
s_add_u32 m0, s17, 0x10000
v_add_u32 v2, 0x80, v2
v_add_u32 v3, 0x80, v3
ds_read_b128 a[0:3], v8 offset:0
v_mfma_f32_16x16x32_bf16 v[56:59], a[40:43], a[24:27], v[56:59]
buffer_load_dwordx4 v5, s[52:55], 0 offen lds
v_mfma_f32_16x16x32_bf16 v[88:91], a[40:43], a[28:31], v[88:91]
ds_read_b128 a[4:7], v8 offset:2048
ds_read_b128 a[8:11], v8 offset:4096
v_mfma_f32_16x16x32_bf16 v[120:123], a[40:43], a[32:35], v[120:123]
ds_read_b128 a[12:15], v8 offset:6144
ds_read_b64_tr_b16 a[92:93], v13 offset:16896
v_mfma_f32_16x16x32_bf16 v[124:127], a[44:47], a[32:35], v[124:127]
ds_read_b64_tr_b16 a[94:95], v13 offset:17920
ds_read_b64_tr_b16 a[96:97], v12 offset:17152
v_mfma_f32_16x16x32_bf16 v[92:95], a[44:47], a[28:31], v[92:95]
ds_read_b64_tr_b16 a[98:99], v12 offset:18176
ds_read_b64_tr_b16 a[100:101], v13 offset:17152
v_mfma_f32_16x16x32_bf16 v[60:63], a[44:47], a[24:27], v[60:63]
ds_read_b64_tr_b16 a[102:103], v13 offset:18176
v_mfma_f32_16x16x32_bf16 v[28:31], a[44:47], a[20:23], v[28:31]
s_add_u32 m0, s17, 0x10400
ds_read_b64_tr_b16 a[40:41], v12 offset:0
ds_read_b64_tr_b16 a[42:43], v12 offset:1024
v_mfma_f32_16x16x32_bf16 v[32:35], a[48:51], a[20:23], v[32:35]
buffer_load_dwordx4 v5, s[52:55], s13 offen lds
v_mfma_f32_16x16x32_bf16 v[64:67], a[48:51], a[24:27], v[64:67]
ds_read_b64_tr_b16 a[44:45], v13 offset:0
v_mfma_f32_16x16x32_bf16 v[96:99], a[48:51], a[28:31], v[96:99]
ds_read_b64_tr_b16 a[46:47], v13 offset:1024
v_mfma_f32_16x16x32_bf16 v[128:131], a[48:51], a[32:35], v[128:131]
ds_read_b64_tr_b16 a[48:49], v12 offset:256
v_mfma_f32_16x16x32_bf16 v[132:135], a[52:55], a[32:35], v[132:135]
ds_read_b64_tr_b16 a[50:51], v12 offset:1280
v_mfma_f32_16x16x32_bf16 v[100:103], a[52:55], a[28:31], v[100:103]
v_mfma_f32_16x16x32_bf16 v[68:71], a[52:55], a[24:27], v[68:71]
v_mfma_f32_16x16x32_bf16 v[36:39], a[52:55], a[20:23], v[36:39]
s_add_u32 m0, s17, 0x10800
ds_read_b64_tr_b16 a[52:53], v13 offset:256
v_mfma_f32_16x16x32_bf16 v[40:43], a[56:59], a[20:23], v[40:43]
buffer_load_dwordx4 v6, s[52:55], 0 offen lds
v_mfma_f32_16x16x32_bf16 v[72:75], a[56:59], a[24:27], v[72:75]
ds_read_b64_tr_b16 a[54:55], v13 offset:1280
v_mfma_f32_16x16x32_bf16 v[104:107], a[56:59], a[28:31], v[104:107]
v_mfma_f32_16x16x32_bf16 v[136:139], a[56:59], a[32:35], v[136:139]
ds_read_b64_tr_b16 a[56:57], v12 offset:512
v_mfma_f32_16x16x32_bf16 v[140:143], a[60:63], a[32:35], v[140:143]
ds_read_b64_tr_b16 a[58:59], v12 offset:1536
v_mfma_f32_16x16x32_bf16 v[108:111], a[60:63], a[28:31], v[108:111]
v_mfma_f32_16x16x32_bf16 v[76:79], a[60:63], a[24:27], v[76:79]
s_add_u32 m0, s17, 0x10c00
v_mfma_f32_16x16x32_bf16 v[44:47], a[60:63], a[20:23], v[44:47]
buffer_load_dwordx4 v6, s[52:55], s13 offen lds
v_mfma_f32_16x16x32_bf16 v[48:51], a[64:67], a[20:23], v[48:51]
ds_read_b64_tr_b16 a[60:61], v13 offset:512
v_mfma_f32_16x16x32_bf16 v[80:83], a[64:67], a[24:27], v[80:83]
ds_read_b64_tr_b16 a[62:63], v13 offset:1536
v_mfma_f32_16x16x32_bf16 v[112:115], a[64:67], a[28:31], v[112:115]
v_mfma_f32_16x16x32_bf16 v[144:147], a[64:67], a[32:35], v[144:147]
ds_read_b64_tr_b16 a[64:65], v12 offset:768
v_mfma_f32_16x16x32_bf16 v[148:151], a[68:71], a[32:35], v[148:151]
ds_read_b64_tr_b16 a[66:67], v12 offset:1792
v_mfma_f32_16x16x32_bf16 v[116:119], a[68:71], a[28:31], v[116:119]
v_mfma_f32_16x16x32_bf16 v[84:87], a[68:71], a[24:27], v[84:87]
s_add_u32 m0, s18, 0x14000
v_mfma_f32_16x16x32_bf16 v[52:55], a[68:71], a[20:23], v[52:55]
buffer_load_dwordx4 v7, s[68:71], 0 offen lds
v_mfma_f32_16x16x32_bf16 v[152:155], a[20:23], a[72:75], v[152:155]
ds_read_b64_tr_b16 a[68:69], v13 offset:768
v_mfma_f32_16x16x32_bf16 v[156:159], a[24:27], a[72:75], v[156:159]
ds_read_b64_tr_b16 a[70:71], v13 offset:1792
v_mfma_f32_16x16x32_bf16 v[216:219], a[28:31], a[72:75], v[216:219]
v_mfma_f32_16x16x32_bf16 v[220:223], a[32:35], a[72:75], v[220:223]
ds_read_b64_tr_b16 a[72:73], v12 offset:16384
v_mfma_f32_16x16x32_bf16 v[228:231], a[32:35], a[76:79], v[228:231]
ds_read_b64_tr_b16 a[74:75], v12 offset:17408
v_mfma_f32_16x16x32_bf16 v[224:227], a[28:31], a[76:79], v[224:227]
v_mfma_f32_16x16x32_bf16 v[164:167], a[24:27], a[76:79], v[164:167]
s_add_u32 m0, s18, 0x15000
v_mfma_f32_16x16x32_bf16 v[160:163], a[20:23], a[76:79], v[160:163]
buffer_load_dwordx4 v7, s[68:71], s25 offen lds
v_mfma_f32_16x16x32_bf16 v[168:171], a[20:23], a[80:83], v[168:171]
ds_read_b64_tr_b16 a[76:77], v13 offset:16384
v_mfma_f32_16x16x32_bf16 v[172:175], a[24:27], a[80:83], v[172:175]
ds_read_b64_tr_b16 a[78:79], v13 offset:17408
v_mfma_f32_16x16x32_bf16 v[232:235], a[28:31], a[80:83], v[232:235]
v_mfma_f32_16x16x32_bf16 v[236:239], a[32:35], a[80:83], v[236:239]
ds_read_b64_tr_b16 a[80:81], v12 offset:16640
v_mfma_f32_16x16x32_bf16 v[244:247], a[32:35], a[84:87], v[244:247]
ds_read_b64_tr_b16 a[82:83], v12 offset:17664
v_mfma_f32_16x16x32_bf16 v[240:243], a[28:31], a[84:87], v[240:243]
s_add_u32 m0, s18, 0x16000
v_mfma_f32_16x16x32_bf16 v[180:183], a[24:27], a[84:87], v[180:183]
buffer_load_dwordx4 v7, s[68:71], s26 offen lds
v_mfma_f32_16x16x32_bf16 v[176:179], a[20:23], a[84:87], v[176:179]
ds_read_b64_tr_b16 a[84:85], v13 offset:16640
v_mfma_f32_16x16x32_bf16 v[184:187], a[20:23], a[88:91], v[184:187]
ds_read_b64_tr_b16 a[86:87], v13 offset:17664
v_mfma_f32_16x16x32_bf16 v[188:191], a[24:27], a[88:91], v[188:191]
v_mfma_f32_16x16x32_bf16 v[248:251], a[28:31], a[88:91], v[248:251]
v_mfma_f32_16x16x32_bf16 v[252:255], a[32:35], a[88:91], v[252:255]
ds_read_b64_tr_b16 a[88:89], v12 offset:16896
v_mfma_f32_16x16x32_bf16 a[236:239], a[32:35], a[104:107], a[236:239]
ds_read_b64_tr_b16 a[90:91], v12 offset:17920
v_mfma_f32_16x16x32_bf16 a[232:235], a[28:31], a[104:107], a[232:235]
s_add_u32 m0, s18, 0x17000
v_mfma_f32_16x16x32_bf16 v[196:199], a[24:27], a[104:107], v[196:199]
buffer_load_dwordx4 v4, s[44:47], s24 offen lds
v_mfma_f32_16x16x32_bf16 v[192:195], a[20:23], a[104:107], v[192:195]
v_mfma_f32_16x16x32_bf16 v[200:203], a[20:23], a[108:111], v[200:203]
v_mfma_f32_16x16x32_bf16 v[204:207], a[24:27], a[108:111], v[204:207]
v_mfma_f32_16x16x32_bf16 a[240:243], a[28:31], a[108:111], a[240:243]
v_mfma_f32_16x16x32_bf16 a[244:247], a[32:35], a[108:111], a[244:247]
v_mfma_f32_16x16x32_bf16 a[252:255], a[32:35], a[112:115], a[252:255]
v_mfma_f32_16x16x32_bf16 a[248:251], a[28:31], a[112:115], a[248:251]
v_mfma_f32_16x16x32_bf16 v[212:215], a[24:27], a[112:115], v[212:215]
v_mfma_f32_16x16x32_bf16 v[208:211], a[20:23], a[112:115], v[208:211]
s_waitcnt lgkmcnt(0)
v_mfma_f32_16x16x32_bf16 v[24:27], a[40:43], a[0:3], v[24:27]
v_add_u32 v5, 0x80000, v5
v_add_u32 v6, 0x80000, v6
ds_read_b128 a[20:23], v9 offset:0
v_mfma_f32_16x16x32_bf16 v[56:59], a[40:43], a[4:7], v[56:59]
v_add_u32 v7, 0x60000, v7
v_add_u32 v4, 0x80, v4
ds_read_b128 a[24:27], v9 offset:2048
v_mfma_f32_16x16x32_bf16 v[88:91], a[40:43], a[8:11], v[88:91]
ds_read_b128 a[28:31], v9 offset:4096
ds_read_b128 a[32:35], v9 offset:6144
v_mfma_f32_16x16x32_bf16 v[120:123], a[40:43], a[12:15], v[120:123]
ds_read_b64_tr_b16 a[104:105], v13 offset:25088
ds_read_b64_tr_b16 a[106:107], v13 offset:26112
v_mfma_f32_16x16x32_bf16 v[124:127], a[44:47], a[12:15], v[124:127]
ds_read_b64_tr_b16 a[108:109], v12 offset:25344
ds_read_b64_tr_b16 a[110:111], v12 offset:26368
v_mfma_f32_16x16x32_bf16 v[92:95], a[44:47], a[8:11], v[92:95]
ds_read_b64_tr_b16 a[112:113], v13 offset:25344
ds_read_b64_tr_b16 a[114:115], v13 offset:26368
v_mfma_f32_16x16x32_bf16 v[60:63], a[44:47], a[4:7], v[60:63]
ds_read_b64_tr_b16 a[40:41], v12 offset:8192
v_mfma_f32_16x16x32_bf16 v[28:31], a[44:47], a[0:3], v[28:31]
ds_read_b64_tr_b16 a[42:43], v12 offset:9216
v_mfma_f32_16x16x32_bf16 v[32:35], a[48:51], a[0:3], v[32:35]
ds_read_b64_tr_b16 a[44:45], v13 offset:8192
v_mfma_f32_16x16x32_bf16 v[64:67], a[48:51], a[4:7], v[64:67]
s_add_u32 m0, s16, 0x0
ds_read_b64_tr_b16 a[46:47], v13 offset:9216
s_waitcnt lgkmcnt(10)
v_mfma_f32_16x16x32_bf16 v[96:99], a[48:51], a[8:11], v[96:99]
buffer_load_dwordx4 v22, s[44:47], s20 offen lds
v_mfma_f32_16x16x32_bf16 v[128:131], a[48:51], a[12:15], v[128:131]
ds_read_b64_tr_b16 a[48:49], v12 offset:8448
v_mfma_f32_16x16x32_bf16 v[132:135], a[52:55], a[12:15], v[132:135]
ds_read_b64_tr_b16 a[50:51], v12 offset:9472
v_mfma_f32_16x16x32_bf16 v[100:103], a[52:55], a[8:11], v[100:103]
v_mfma_f32_16x16x32_bf16 v[68:71], a[52:55], a[4:7], v[68:71]
v_mfma_f32_16x16x32_bf16 v[36:39], a[52:55], a[0:3], v[36:39]
s_add_u32 m0, s16, 0x400
ds_read_b64_tr_b16 a[52:53], v13 offset:8448
v_mfma_f32_16x16x32_bf16 v[40:43], a[56:59], a[0:3], v[40:43]
buffer_load_dwordx4 v23, s[44:47], s20 offen lds
v_mfma_f32_16x16x32_bf16 v[72:75], a[56:59], a[4:7], v[72:75]
ds_read_b64_tr_b16 a[54:55], v13 offset:9472
v_mfma_f32_16x16x32_bf16 v[104:107], a[56:59], a[8:11], v[104:107]
v_mfma_f32_16x16x32_bf16 v[136:139], a[56:59], a[12:15], v[136:139]
ds_read_b64_tr_b16 a[56:57], v12 offset:8704
v_mfma_f32_16x16x32_bf16 v[140:143], a[60:63], a[12:15], v[140:143]
ds_read_b64_tr_b16 a[58:59], v12 offset:9728
v_mfma_f32_16x16x32_bf16 v[108:111], a[60:63], a[8:11], v[108:111]
v_mfma_f32_16x16x32_bf16 v[76:79], a[60:63], a[4:7], v[76:79]
s_add_u32 m0, s16, 0x800
v_mfma_f32_16x16x32_bf16 v[44:47], a[60:63], a[0:3], v[44:47]
buffer_load_dwordx4 v22, s[44:47], s21 offen lds
v_mfma_f32_16x16x32_bf16 v[48:51], a[64:67], a[0:3], v[48:51]
ds_read_b64_tr_b16 a[60:61], v13 offset:8704
v_mfma_f32_16x16x32_bf16 v[80:83], a[64:67], a[4:7], v[80:83]
ds_read_b64_tr_b16 a[62:63], v13 offset:9728
v_mfma_f32_16x16x32_bf16 v[112:115], a[64:67], a[8:11], v[112:115]
v_mfma_f32_16x16x32_bf16 v[144:147], a[64:67], a[12:15], v[144:147]
ds_read_b64_tr_b16 a[64:65], v12 offset:8960
v_mfma_f32_16x16x32_bf16 v[148:151], a[68:71], a[12:15], v[148:151]
s_add_u32 m0, s16, 0xc00
ds_read_b64_tr_b16 a[66:67], v12 offset:9984
v_mfma_f32_16x16x32_bf16 v[116:119], a[68:71], a[8:11], v[116:119]
buffer_load_dwordx4 v23, s[44:47], s21 offen lds
v_mfma_f32_16x16x32_bf16 v[84:87], a[68:71], a[4:7], v[84:87]
v_mfma_f32_16x16x32_bf16 v[52:55], a[68:71], a[0:3], v[52:55]
ds_read_b64_tr_b16 a[68:69], v13 offset:8960
v_mfma_f32_16x16x32_bf16 v[152:155], a[0:3], a[72:75], v[152:155]
ds_read_b64_tr_b16 a[70:71], v13 offset:9984
v_mfma_f32_16x16x32_bf16 v[156:159], a[4:7], a[72:75], v[156:159]
v_mfma_f32_16x16x32_bf16 v[216:219], a[8:11], a[72:75], v[216:219]
v_mfma_f32_16x16x32_bf16 v[220:223], a[12:15], a[72:75], v[220:223]
s_add_u32 m0, s16, 0x1000
ds_read_b64_tr_b16 a[72:73], v12 offset:24576
v_mfma_f32_16x16x32_bf16 v[228:231], a[12:15], a[76:79], v[228:231]
buffer_load_dwordx4 v22, s[44:47], s22 offen lds
v_mfma_f32_16x16x32_bf16 v[224:227], a[8:11], a[76:79], v[224:227]
ds_read_b64_tr_b16 a[74:75], v12 offset:25600
v_mfma_f32_16x16x32_bf16 v[164:167], a[4:7], a[76:79], v[164:167]
v_mfma_f32_16x16x32_bf16 v[160:163], a[0:3], a[76:79], v[160:163]
ds_read_b64_tr_b16 a[76:77], v13 offset:24576
v_mfma_f32_16x16x32_bf16 v[168:171], a[0:3], a[80:83], v[168:171]
ds_read_b64_tr_b16 a[78:79], v13 offset:25600
v_mfma_f32_16x16x32_bf16 v[172:175], a[4:7], a[80:83], v[172:175]
s_add_u32 m0, s16, 0x1400
v_mfma_f32_16x16x32_bf16 v[232:235], a[8:11], a[80:83], v[232:235]
buffer_load_dwordx4 v23, s[44:47], s22 offen lds
v_mfma_f32_16x16x32_bf16 v[236:239], a[12:15], a[80:83], v[236:239]
ds_read_b64_tr_b16 a[80:81], v12 offset:24832
v_mfma_f32_16x16x32_bf16 v[244:247], a[12:15], a[84:87], v[244:247]
ds_read_b64_tr_b16 a[82:83], v12 offset:25856
v_mfma_f32_16x16x32_bf16 v[240:243], a[8:11], a[84:87], v[240:243]
v_mfma_f32_16x16x32_bf16 v[180:183], a[4:7], a[84:87], v[180:183]
v_mfma_f32_16x16x32_bf16 v[176:179], a[0:3], a[84:87], v[176:179]
ds_read_b64_tr_b16 a[84:85], v13 offset:24832
v_mfma_f32_16x16x32_bf16 v[184:187], a[0:3], a[88:91], v[184:187]
s_add_u32 m0, s16, 0x1800
ds_read_b64_tr_b16 a[86:87], v13 offset:25856
v_mfma_f32_16x16x32_bf16 v[188:191], a[4:7], a[88:91], v[188:191]
buffer_load_dwordx4 v22, s[44:47], s23 offen lds
v_mfma_f32_16x16x32_bf16 v[248:251], a[8:11], a[88:91], v[248:251]
v_mfma_f32_16x16x32_bf16 v[252:255], a[12:15], a[88:91], v[252:255]
ds_read_b64_tr_b16 a[88:89], v12 offset:25088
v_mfma_f32_16x16x32_bf16 a[236:239], a[12:15], a[92:95], a[236:239]
ds_read_b64_tr_b16 a[90:91], v12 offset:26112
v_mfma_f32_16x16x32_bf16 a[232:235], a[8:11], a[92:95], a[232:235]
v_mfma_f32_16x16x32_bf16 v[196:199], a[4:7], a[92:95], v[196:199]
s_add_u32 m0, s16, 0x1c00
v_mfma_f32_16x16x32_bf16 v[192:195], a[0:3], a[92:95], v[192:195]
buffer_load_dwordx4 v23, s[44:47], s23 offen lds
v_mfma_f32_16x16x32_bf16 v[200:203], a[0:3], a[96:99], v[200:203]
v_mfma_f32_16x16x32_bf16 v[204:207], a[4:7], a[96:99], v[204:207]
v_mfma_f32_16x16x32_bf16 a[240:243], a[8:11], a[96:99], a[240:243]
v_mfma_f32_16x16x32_bf16 a[244:247], a[12:15], a[96:99], a[244:247]
v_mfma_f32_16x16x32_bf16 a[252:255], a[12:15], a[100:103], a[252:255]
v_mfma_f32_16x16x32_bf16 a[248:251], a[8:11], a[100:103], a[248:251]
v_add_u32 v12, 0x8000, v12
v_mfma_f32_16x16x32_bf16 v[212:215], a[4:7], a[100:103], v[212:215]
v_add_u32 v13, 0x8000, v13
v_mfma_f32_16x16x32_bf16 v[208:211], a[0:3], a[100:103], v[208:211]
s_waitcnt vmcnt(16) lgkmcnt(0)
s_barrier
v_mfma_f32_16x16x32_bf16 v[24:27], a[40:43], a[20:23], v[24:27]
s_add_u32 m0, s17, 0x0
v_add_u32 v22, 0x80, v22
v_add_u32 v23, 0x80, v23
ds_read_b128 a[0:3], v8 offset:32768
v_mfma_f32_16x16x32_bf16 v[56:59], a[40:43], a[24:27], v[56:59]
buffer_load_dwordx4 v5, s[52:55], 0 offen lds
v_mfma_f32_16x16x32_bf16 v[88:91], a[40:43], a[28:31], v[88:91]
ds_read_b128 a[4:7], v8 offset:34816
ds_read_b128 a[8:11], v8 offset:36864
v_mfma_f32_16x16x32_bf16 v[120:123], a[40:43], a[32:35], v[120:123]
ds_read_b128 a[12:15], v8 offset:38912
ds_read_b64_tr_b16 a[92:93], v13 offset:16896
v_mfma_f32_16x16x32_bf16 v[124:127], a[44:47], a[32:35], v[124:127]
ds_read_b64_tr_b16 a[94:95], v13 offset:17920
ds_read_b64_tr_b16 a[96:97], v12 offset:17152
v_mfma_f32_16x16x32_bf16 v[92:95], a[44:47], a[28:31], v[92:95]
ds_read_b64_tr_b16 a[98:99], v12 offset:18176
ds_read_b64_tr_b16 a[100:101], v13 offset:17152
v_mfma_f32_16x16x32_bf16 v[60:63], a[44:47], a[24:27], v[60:63]
ds_read_b64_tr_b16 a[102:103], v13 offset:18176
v_mfma_f32_16x16x32_bf16 v[28:31], a[44:47], a[20:23], v[28:31]
s_add_u32 m0, s17, 0x400
ds_read_b64_tr_b16 a[40:41], v12 offset:0
ds_read_b64_tr_b16 a[42:43], v12 offset:1024
v_mfma_f32_16x16x32_bf16 v[32:35], a[48:51], a[20:23], v[32:35]
buffer_load_dwordx4 v5, s[52:55], s13 offen lds
v_mfma_f32_16x16x32_bf16 v[64:67], a[48:51], a[24:27], v[64:67]
ds_read_b64_tr_b16 a[44:45], v13 offset:0
v_mfma_f32_16x16x32_bf16 v[96:99], a[48:51], a[28:31], v[96:99]
ds_read_b64_tr_b16 a[46:47], v13 offset:1024
v_mfma_f32_16x16x32_bf16 v[128:131], a[48:51], a[32:35], v[128:131]
ds_read_b64_tr_b16 a[48:49], v12 offset:256
v_mfma_f32_16x16x32_bf16 v[132:135], a[52:55], a[32:35], v[132:135]
ds_read_b64_tr_b16 a[50:51], v12 offset:1280
v_mfma_f32_16x16x32_bf16 v[100:103], a[52:55], a[28:31], v[100:103]
v_mfma_f32_16x16x32_bf16 v[68:71], a[52:55], a[24:27], v[68:71]
v_mfma_f32_16x16x32_bf16 v[36:39], a[52:55], a[20:23], v[36:39]
s_add_u32 m0, s17, 0x800
ds_read_b64_tr_b16 a[52:53], v13 offset:256
v_mfma_f32_16x16x32_bf16 v[40:43], a[56:59], a[20:23], v[40:43]
buffer_load_dwordx4 v6, s[52:55], 0 offen lds
v_mfma_f32_16x16x32_bf16 v[72:75], a[56:59], a[24:27], v[72:75]
ds_read_b64_tr_b16 a[54:55], v13 offset:1280
v_mfma_f32_16x16x32_bf16 v[104:107], a[56:59], a[28:31], v[104:107]
v_mfma_f32_16x16x32_bf16 v[136:139], a[56:59], a[32:35], v[136:139]
ds_read_b64_tr_b16 a[56:57], v12 offset:512
v_mfma_f32_16x16x32_bf16 v[140:143], a[60:63], a[32:35], v[140:143]
ds_read_b64_tr_b16 a[58:59], v12 offset:1536
v_mfma_f32_16x16x32_bf16 v[108:111], a[60:63], a[28:31], v[108:111]
v_mfma_f32_16x16x32_bf16 v[76:79], a[60:63], a[24:27], v[76:79]
s_add_u32 m0, s17, 0xc00
v_mfma_f32_16x16x32_bf16 v[44:47], a[60:63], a[20:23], v[44:47]
buffer_load_dwordx4 v6, s[52:55], s13 offen lds
v_mfma_f32_16x16x32_bf16 v[48:51], a[64:67], a[20:23], v[48:51]
ds_read_b64_tr_b16 a[60:61], v13 offset:512
v_mfma_f32_16x16x32_bf16 v[80:83], a[64:67], a[24:27], v[80:83]
ds_read_b64_tr_b16 a[62:63], v13 offset:1536
v_mfma_f32_16x16x32_bf16 v[112:115], a[64:67], a[28:31], v[112:115]
v_mfma_f32_16x16x32_bf16 v[144:147], a[64:67], a[32:35], v[144:147]
ds_read_b64_tr_b16 a[64:65], v12 offset:768
v_mfma_f32_16x16x32_bf16 v[148:151], a[68:71], a[32:35], v[148:151]
ds_read_b64_tr_b16 a[66:67], v12 offset:1792
v_mfma_f32_16x16x32_bf16 v[116:119], a[68:71], a[28:31], v[116:119]
v_mfma_f32_16x16x32_bf16 v[84:87], a[68:71], a[24:27], v[84:87]
s_add_u32 m0, s18, 0x4000
v_mfma_f32_16x16x32_bf16 v[52:55], a[68:71], a[20:23], v[52:55]
buffer_load_dwordx4 v7, s[68:71], 0 offen lds
v_mfma_f32_16x16x32_bf16 v[152:155], a[20:23], a[72:75], v[152:155]
ds_read_b64_tr_b16 a[68:69], v13 offset:768
v_mfma_f32_16x16x32_bf16 v[156:159], a[24:27], a[72:75], v[156:159]
ds_read_b64_tr_b16 a[70:71], v13 offset:1792
v_mfma_f32_16x16x32_bf16 v[216:219], a[28:31], a[72:75], v[216:219]
v_mfma_f32_16x16x32_bf16 v[220:223], a[32:35], a[72:75], v[220:223]
ds_read_b64_tr_b16 a[72:73], v12 offset:16384
v_mfma_f32_16x16x32_bf16 v[228:231], a[32:35], a[76:79], v[228:231]
ds_read_b64_tr_b16 a[74:75], v12 offset:17408
v_mfma_f32_16x16x32_bf16 v[224:227], a[28:31], a[76:79], v[224:227]
v_mfma_f32_16x16x32_bf16 v[164:167], a[24:27], a[76:79], v[164:167]
s_add_u32 m0, s18, 0x5000
v_mfma_f32_16x16x32_bf16 v[160:163], a[20:23], a[76:79], v[160:163]
buffer_load_dwordx4 v7, s[68:71], s25 offen lds
v_mfma_f32_16x16x32_bf16 v[168:171], a[20:23], a[80:83], v[168:171]
ds_read_b64_tr_b16 a[76:77], v13 offset:16384
v_mfma_f32_16x16x32_bf16 v[172:175], a[24:27], a[80:83], v[172:175]
ds_read_b64_tr_b16 a[78:79], v13 offset:17408
v_mfma_f32_16x16x32_bf16 v[232:235], a[28:31], a[80:83], v[232:235]
v_mfma_f32_16x16x32_bf16 v[236:239], a[32:35], a[80:83], v[236:239]
ds_read_b64_tr_b16 a[80:81], v12 offset:16640
v_mfma_f32_16x16x32_bf16 v[244:247], a[32:35], a[84:87], v[244:247]
ds_read_b64_tr_b16 a[82:83], v12 offset:17664
v_mfma_f32_16x16x32_bf16 v[240:243], a[28:31], a[84:87], v[240:243]
s_add_u32 m0, s18, 0x6000
v_mfma_f32_16x16x32_bf16 v[180:183], a[24:27], a[84:87], v[180:183]
buffer_load_dwordx4 v7, s[68:71], s26 offen lds
v_mfma_f32_16x16x32_bf16 v[176:179], a[20:23], a[84:87], v[176:179]
ds_read_b64_tr_b16 a[84:85], v13 offset:16640
v_mfma_f32_16x16x32_bf16 v[184:187], a[20:23], a[88:91], v[184:187]
ds_read_b64_tr_b16 a[86:87], v13 offset:17664
v_mfma_f32_16x16x32_bf16 v[188:191], a[24:27], a[88:91], v[188:191]
v_mfma_f32_16x16x32_bf16 v[248:251], a[28:31], a[88:91], v[248:251]
v_mfma_f32_16x16x32_bf16 v[252:255], a[32:35], a[88:91], v[252:255]
ds_read_b64_tr_b16 a[88:89], v12 offset:16896
v_mfma_f32_16x16x32_bf16 a[236:239], a[32:35], a[104:107], a[236:239]
ds_read_b64_tr_b16 a[90:91], v12 offset:17920
v_mfma_f32_16x16x32_bf16 a[232:235], a[28:31], a[104:107], a[232:235]
s_add_u32 m0, s18, 0x7000
v_mfma_f32_16x16x32_bf16 v[196:199], a[24:27], a[104:107], v[196:199]
buffer_load_dwordx4 v4, s[44:47], s24 offen lds
v_mfma_f32_16x16x32_bf16 v[192:195], a[20:23], a[104:107], v[192:195]
v_mfma_f32_16x16x32_bf16 v[200:203], a[20:23], a[108:111], v[200:203]
v_mfma_f32_16x16x32_bf16 v[204:207], a[24:27], a[108:111], v[204:207]
v_mfma_f32_16x16x32_bf16 a[240:243], a[28:31], a[108:111], a[240:243]
v_mfma_f32_16x16x32_bf16 a[244:247], a[32:35], a[108:111], a[244:247]
v_mfma_f32_16x16x32_bf16 a[252:255], a[32:35], a[112:115], a[252:255]
v_mfma_f32_16x16x32_bf16 a[248:251], a[28:31], a[112:115], a[248:251]
v_mfma_f32_16x16x32_bf16 v[212:215], a[24:27], a[112:115], v[212:215]
v_mfma_f32_16x16x32_bf16 v[208:211], a[20:23], a[112:115], v[208:211]
s_waitcnt lgkmcnt(0)
v_mfma_f32_16x16x32_bf16 v[24:27], a[40:43], a[0:3], v[24:27]
v_add_u32 v5, 0x80000, v5
v_add_u32 v6, 0x80000, v6
ds_read_b128 a[20:23], v9 offset:32768
v_mfma_f32_16x16x32_bf16 v[56:59], a[40:43], a[4:7], v[56:59]
v_add_u32 v7, 0x60000, v7
v_add_u32 v4, 0x80, v4
ds_read_b128 a[24:27], v9 offset:34816
v_mfma_f32_16x16x32_bf16 v[88:91], a[40:43], a[8:11], v[88:91]
ds_read_b128 a[28:31], v9 offset:36864
ds_read_b128 a[32:35], v9 offset:38912
v_mfma_f32_16x16x32_bf16 v[120:123], a[40:43], a[12:15], v[120:123]
ds_read_b64_tr_b16 a[104:105], v13 offset:25088
ds_read_b64_tr_b16 a[106:107], v13 offset:26112
v_mfma_f32_16x16x32_bf16 v[124:127], a[44:47], a[12:15], v[124:127]
ds_read_b64_tr_b16 a[108:109], v12 offset:25344
ds_read_b64_tr_b16 a[110:111], v12 offset:26368
v_mfma_f32_16x16x32_bf16 v[92:95], a[44:47], a[8:11], v[92:95]
ds_read_b64_tr_b16 a[112:113], v13 offset:25344
ds_read_b64_tr_b16 a[114:115], v13 offset:26368
v_mfma_f32_16x16x32_bf16 v[60:63], a[44:47], a[4:7], v[60:63]
ds_read_b64_tr_b16 a[40:41], v12 offset:8192
v_mfma_f32_16x16x32_bf16 v[28:31], a[44:47], a[0:3], v[28:31]
ds_read_b64_tr_b16 a[42:43], v12 offset:9216
v_mfma_f32_16x16x32_bf16 v[32:35], a[48:51], a[0:3], v[32:35]
ds_read_b64_tr_b16 a[44:45], v13 offset:8192
v_mfma_f32_16x16x32_bf16 v[64:67], a[48:51], a[4:7], v[64:67]
s_add_u32 m0, s16, 0x8000
ds_read_b64_tr_b16 a[46:47], v13 offset:9216
s_waitcnt lgkmcnt(10)
v_mfma_f32_16x16x32_bf16 v[96:99], a[48:51], a[8:11], v[96:99]
buffer_load_dwordx4 v22, s[44:47], s20 offen lds
v_mfma_f32_16x16x32_bf16 v[128:131], a[48:51], a[12:15], v[128:131]
ds_read_b64_tr_b16 a[48:49], v12 offset:8448
v_mfma_f32_16x16x32_bf16 v[132:135], a[52:55], a[12:15], v[132:135]
ds_read_b64_tr_b16 a[50:51], v12 offset:9472
v_mfma_f32_16x16x32_bf16 v[100:103], a[52:55], a[8:11], v[100:103]
v_mfma_f32_16x16x32_bf16 v[68:71], a[52:55], a[4:7], v[68:71]
v_mfma_f32_16x16x32_bf16 v[36:39], a[52:55], a[0:3], v[36:39]
s_add_u32 m0, s16, 0x8400
ds_read_b64_tr_b16 a[52:53], v13 offset:8448
v_mfma_f32_16x16x32_bf16 v[40:43], a[56:59], a[0:3], v[40:43]
buffer_load_dwordx4 v23, s[44:47], s20 offen lds
v_mfma_f32_16x16x32_bf16 v[72:75], a[56:59], a[4:7], v[72:75]
ds_read_b64_tr_b16 a[54:55], v13 offset:9472
v_mfma_f32_16x16x32_bf16 v[104:107], a[56:59], a[8:11], v[104:107]
v_mfma_f32_16x16x32_bf16 v[136:139], a[56:59], a[12:15], v[136:139]
ds_read_b64_tr_b16 a[56:57], v12 offset:8704
v_mfma_f32_16x16x32_bf16 v[140:143], a[60:63], a[12:15], v[140:143]
ds_read_b64_tr_b16 a[58:59], v12 offset:9728
v_mfma_f32_16x16x32_bf16 v[108:111], a[60:63], a[8:11], v[108:111]
v_mfma_f32_16x16x32_bf16 v[76:79], a[60:63], a[4:7], v[76:79]
s_add_u32 m0, s16, 0x8800
v_mfma_f32_16x16x32_bf16 v[44:47], a[60:63], a[0:3], v[44:47]
buffer_load_dwordx4 v22, s[44:47], s21 offen lds
v_mfma_f32_16x16x32_bf16 v[48:51], a[64:67], a[0:3], v[48:51]
ds_read_b64_tr_b16 a[60:61], v13 offset:8704
v_mfma_f32_16x16x32_bf16 v[80:83], a[64:67], a[4:7], v[80:83]
ds_read_b64_tr_b16 a[62:63], v13 offset:9728
v_mfma_f32_16x16x32_bf16 v[112:115], a[64:67], a[8:11], v[112:115]
v_mfma_f32_16x16x32_bf16 v[144:147], a[64:67], a[12:15], v[144:147]
ds_read_b64_tr_b16 a[64:65], v12 offset:8960
v_mfma_f32_16x16x32_bf16 v[148:151], a[68:71], a[12:15], v[148:151]
s_add_u32 m0, s16, 0x8c00
ds_read_b64_tr_b16 a[66:67], v12 offset:9984
v_mfma_f32_16x16x32_bf16 v[116:119], a[68:71], a[8:11], v[116:119]
buffer_load_dwordx4 v23, s[44:47], s21 offen lds
v_mfma_f32_16x16x32_bf16 v[84:87], a[68:71], a[4:7], v[84:87]
v_mfma_f32_16x16x32_bf16 v[52:55], a[68:71], a[0:3], v[52:55]
ds_read_b64_tr_b16 a[68:69], v13 offset:8960
v_mfma_f32_16x16x32_bf16 v[152:155], a[0:3], a[72:75], v[152:155]
ds_read_b64_tr_b16 a[70:71], v13 offset:9984
v_mfma_f32_16x16x32_bf16 v[156:159], a[4:7], a[72:75], v[156:159]
v_mfma_f32_16x16x32_bf16 v[216:219], a[8:11], a[72:75], v[216:219]
v_mfma_f32_16x16x32_bf16 v[220:223], a[12:15], a[72:75], v[220:223]
s_add_u32 m0, s16, 0x9000
ds_read_b64_tr_b16 a[72:73], v12 offset:24576
v_mfma_f32_16x16x32_bf16 v[228:231], a[12:15], a[76:79], v[228:231]
buffer_load_dwordx4 v22, s[44:47], s22 offen lds
v_mfma_f32_16x16x32_bf16 v[224:227], a[8:11], a[76:79], v[224:227]
ds_read_b64_tr_b16 a[74:75], v12 offset:25600
v_mfma_f32_16x16x32_bf16 v[164:167], a[4:7], a[76:79], v[164:167]
v_mfma_f32_16x16x32_bf16 v[160:163], a[0:3], a[76:79], v[160:163]
ds_read_b64_tr_b16 a[76:77], v13 offset:24576
v_mfma_f32_16x16x32_bf16 v[168:171], a[0:3], a[80:83], v[168:171]
ds_read_b64_tr_b16 a[78:79], v13 offset:25600
v_mfma_f32_16x16x32_bf16 v[172:175], a[4:7], a[80:83], v[172:175]
s_add_u32 m0, s16, 0x9400
v_mfma_f32_16x16x32_bf16 v[232:235], a[8:11], a[80:83], v[232:235]
buffer_load_dwordx4 v23, s[44:47], s22 offen lds
v_mfma_f32_16x16x32_bf16 v[236:239], a[12:15], a[80:83], v[236:239]
ds_read_b64_tr_b16 a[80:81], v12 offset:24832
v_mfma_f32_16x16x32_bf16 v[244:247], a[12:15], a[84:87], v[244:247]
ds_read_b64_tr_b16 a[82:83], v12 offset:25856
v_mfma_f32_16x16x32_bf16 v[240:243], a[8:11], a[84:87], v[240:243]
v_mfma_f32_16x16x32_bf16 v[180:183], a[4:7], a[84:87], v[180:183]
v_mfma_f32_16x16x32_bf16 v[176:179], a[0:3], a[84:87], v[176:179]
ds_read_b64_tr_b16 a[84:85], v13 offset:24832
v_mfma_f32_16x16x32_bf16 v[184:187], a[0:3], a[88:91], v[184:187]
s_add_u32 m0, s16, 0x9800
ds_read_b64_tr_b16 a[86:87], v13 offset:25856
v_mfma_f32_16x16x32_bf16 v[188:191], a[4:7], a[88:91], v[188:191]
buffer_load_dwordx4 v22, s[44:47], s23 offen lds
v_mfma_f32_16x16x32_bf16 v[248:251], a[8:11], a[88:91], v[248:251]
v_mfma_f32_16x16x32_bf16 v[252:255], a[12:15], a[88:91], v[252:255]
ds_read_b64_tr_b16 a[88:89], v12 offset:25088
v_mfma_f32_16x16x32_bf16 a[236:239], a[12:15], a[92:95], a[236:239]
ds_read_b64_tr_b16 a[90:91], v12 offset:26112
v_mfma_f32_16x16x32_bf16 a[232:235], a[8:11], a[92:95], a[232:235]
v_mfma_f32_16x16x32_bf16 v[196:199], a[4:7], a[92:95], v[196:199]
s_add_u32 m0, s16, 0x9c00
v_mfma_f32_16x16x32_bf16 v[192:195], a[0:3], a[92:95], v[192:195]
buffer_load_dwordx4 v23, s[44:47], s23 offen lds
v_mfma_f32_16x16x32_bf16 v[200:203], a[0:3], a[96:99], v[200:203]
v_mfma_f32_16x16x32_bf16 v[204:207], a[4:7], a[96:99], v[204:207]
v_mfma_f32_16x16x32_bf16 a[240:243], a[8:11], a[96:99], a[240:243]
v_mfma_f32_16x16x32_bf16 a[244:247], a[12:15], a[96:99], a[244:247]
v_mfma_f32_16x16x32_bf16 a[252:255], a[12:15], a[100:103], a[252:255]
v_mfma_f32_16x16x32_bf16 a[248:251], a[8:11], a[100:103], a[248:251]
v_add_u32 v12, 0x8000, v12
v_mfma_f32_16x16x32_bf16 v[212:215], a[4:7], a[100:103], v[212:215]
v_add_u32 v13, 0x8000, v13
v_mfma_f32_16x16x32_bf16 v[208:211], a[0:3], a[100:103], v[208:211]
s_waitcnt vmcnt(16) lgkmcnt(0)
s_barrier
v_mfma_f32_16x16x32_bf16 v[24:27], a[40:43], a[20:23], v[24:27]
s_add_u32 m0, s17, 0x8000
v_add_u32 v22, 0x80, v22
v_add_u32 v23, 0x80, v23
ds_read_b128 a[0:3], v8 offset:0
v_mfma_f32_16x16x32_bf16 v[56:59], a[40:43], a[24:27], v[56:59]
buffer_load_dwordx4 v5, s[52:55], 0 offen lds
v_mfma_f32_16x16x32_bf16 v[88:91], a[40:43], a[28:31], v[88:91]
ds_read_b128 a[4:7], v8 offset:2048
ds_read_b128 a[8:11], v8 offset:4096
v_mfma_f32_16x16x32_bf16 v[120:123], a[40:43], a[32:35], v[120:123]
ds_read_b128 a[12:15], v8 offset:6144
ds_read_b128 a[16:19], v10
v_mfma_f32_16x16x32_bf16 v[124:127], a[44:47], a[32:35], v[124:127]
ds_read_b64_tr_b16 a[92:93], v15 offset:8192
ds_read_b64_tr_b16 a[94:95], v15 offset:8448
v_mfma_f32_16x16x32_bf16 v[92:95], a[44:47], a[28:31], v[92:95]
ds_read_b64_tr_b16 a[40:41], v12 offset:0
v_mfma_f32_16x16x32_bf16 v[60:63], a[44:47], a[24:27], v[60:63]
ds_read_b64_tr_b16 a[42:43], v12 offset:1024
v_mfma_f32_16x16x32_bf16 v[28:31], a[44:47], a[20:23], v[28:31]
s_add_u32 m0, s17, 0x8400
ds_read_b64_tr_b16 a[44:45], v13 offset:0
v_mfma_f32_16x16x32_bf16 v[32:35], a[48:51], a[20:23], v[32:35]
buffer_load_dwordx4 v5, s[52:55], s13 offen lds
v_mfma_f32_16x16x32_bf16 v[64:67], a[48:51], a[24:27], v[64:67]
ds_read_b64_tr_b16 a[46:47], v13 offset:1024
v_mfma_f32_16x16x32_bf16 v[96:99], a[48:51], a[28:31], v[96:99]
v_mfma_f32_16x16x32_bf16 v[128:131], a[48:51], a[32:35], v[128:131]
ds_read_b64_tr_b16 a[48:49], v12 offset:256
v_mfma_f32_16x16x32_bf16 v[132:135], a[52:55], a[32:35], v[132:135]
ds_read_b64_tr_b16 a[50:51], v12 offset:1280
v_mfma_f32_16x16x32_bf16 v[100:103], a[52:55], a[28:31], v[100:103]
v_mfma_f32_16x16x32_bf16 v[68:71], a[52:55], a[24:27], v[68:71]
v_mfma_f32_16x16x32_bf16 v[36:39], a[52:55], a[20:23], v[36:39]
s_add_u32 m0, s17, 0x8800
ds_read_b64_tr_b16 a[52:53], v13 offset:256
v_mfma_f32_16x16x32_bf16 v[40:43], a[56:59], a[20:23], v[40:43]
buffer_load_dwordx4 v6, s[52:55], 0 offen lds
v_mfma_f32_16x16x32_bf16 v[72:75], a[56:59], a[24:27], v[72:75]
ds_read_b64_tr_b16 a[54:55], v13 offset:1280
v_mfma_f32_16x16x32_bf16 v[104:107], a[56:59], a[28:31], v[104:107]
v_mfma_f32_16x16x32_bf16 v[136:139], a[56:59], a[32:35], v[136:139]
ds_read_b64_tr_b16 a[56:57], v12 offset:512
v_mfma_f32_16x16x32_bf16 v[140:143], a[60:63], a[32:35], v[140:143]
ds_read_b64_tr_b16 a[58:59], v12 offset:1536
v_mfma_f32_16x16x32_bf16 v[108:111], a[60:63], a[28:31], v[108:111]
v_mfma_f32_16x16x32_bf16 v[76:79], a[60:63], a[24:27], v[76:79]
s_add_u32 m0, s17, 0x8c00
v_mfma_f32_16x16x32_bf16 v[44:47], a[60:63], a[20:23], v[44:47]
buffer_load_dwordx4 v6, s[52:55], s13 offen lds
v_mfma_f32_16x16x32_bf16 v[48:51], a[64:67], a[20:23], v[48:51]
ds_read_b64_tr_b16 a[60:61], v13 offset:512
v_mfma_f32_16x16x32_bf16 v[80:83], a[64:67], a[24:27], v[80:83]
ds_read_b64_tr_b16 a[62:63], v13 offset:1536
v_mfma_f32_16x16x32_bf16 v[112:115], a[64:67], a[28:31], v[112:115]
v_mfma_f32_16x16x32_bf16 v[144:147], a[64:67], a[32:35], v[144:147]
ds_read_b64_tr_b16 a[64:65], v12 offset:768
v_mfma_f32_16x16x32_bf16 v[148:151], a[68:71], a[32:35], v[148:151]
ds_read_b64_tr_b16 a[66:67], v12 offset:1792
v_mfma_f32_16x16x32_bf16 v[116:119], a[68:71], a[28:31], v[116:119]
v_mfma_f32_16x16x32_bf16 v[84:87], a[68:71], a[24:27], v[84:87]
s_add_u32 m0, s18, 0xc000
v_mfma_f32_16x16x32_bf16 v[52:55], a[68:71], a[20:23], v[52:55]
buffer_load_dwordx4 v7, s[68:71], 0 offen lds
v_mfma_f32_16x16x32_bf16 v[152:155], a[20:23], a[72:75], v[152:155]
ds_read_b64_tr_b16 a[68:69], v13 offset:768
v_mfma_f32_16x16x32_bf16 v[156:159], a[24:27], a[72:75], v[156:159]
ds_read_b64_tr_b16 a[70:71], v13 offset:1792
v_mfma_f32_16x16x32_bf16 v[216:219], a[28:31], a[72:75], v[216:219]
v_mfma_f32_16x16x32_bf16 v[220:223], a[32:35], a[72:75], v[220:223]
ds_read_b64_tr_b16 a[72:73], v14 offset:0
v_mfma_f32_16x16x32_bf16 v[228:231], a[32:35], a[76:79], v[228:231]
ds_read_b64_tr_b16 a[74:75], v14 offset:256
v_mfma_f32_16x16x32_bf16 v[224:227], a[28:31], a[76:79], v[224:227]
v_mfma_f32_16x16x32_bf16 v[164:167], a[24:27], a[76:79], v[164:167]
s_add_u32 m0, s18, 0xd000
v_mfma_f32_16x16x32_bf16 v[160:163], a[20:23], a[76:79], v[160:163]
buffer_load_dwordx4 v7, s[68:71], s25 offen lds
v_mfma_f32_16x16x32_bf16 v[168:171], a[20:23], a[80:83], v[168:171]
ds_read_b64_tr_b16 a[76:77], v15 offset:0
v_mfma_f32_16x16x32_bf16 v[172:175], a[24:27], a[80:83], v[172:175]
ds_read_b64_tr_b16 a[78:79], v15 offset:256
v_mfma_f32_16x16x32_bf16 v[232:235], a[28:31], a[80:83], v[232:235]
v_mfma_f32_16x16x32_bf16 v[236:239], a[32:35], a[80:83], v[236:239]
ds_read_b64_tr_b16 a[80:81], v14 offset:4096
v_mfma_f32_16x16x32_bf16 v[244:247], a[32:35], a[84:87], v[244:247]
ds_read_b64_tr_b16 a[82:83], v14 offset:4352
v_mfma_f32_16x16x32_bf16 v[240:243], a[28:31], a[84:87], v[240:243]
s_add_u32 m0, s18, 0xe000
v_mfma_f32_16x16x32_bf16 v[180:183], a[24:27], a[84:87], v[180:183]
buffer_load_dwordx4 v7, s[68:71], s26 offen lds
v_mfma_f32_16x16x32_bf16 v[176:179], a[20:23], a[84:87], v[176:179]
ds_read_b64_tr_b16 a[84:85], v15 offset:4096
v_mfma_f32_16x16x32_bf16 v[184:187], a[20:23], a[88:91], v[184:187]
ds_read_b64_tr_b16 a[86:87], v15 offset:4352
v_mfma_f32_16x16x32_bf16 v[188:191], a[24:27], a[88:91], v[188:191]
v_mfma_f32_16x16x32_bf16 v[248:251], a[28:31], a[88:91], v[248:251]
v_mfma_f32_16x16x32_bf16 v[252:255], a[32:35], a[88:91], v[252:255]
ds_read_b64_tr_b16 a[88:89], v14 offset:8192
v_mfma_f32_16x16x32_bf16 a[236:239], a[32:35], a[104:107], a[236:239]
ds_read_b64_tr_b16 a[90:91], v14 offset:8448
v_mfma_f32_16x16x32_bf16 a[232:235], a[28:31], a[104:107], a[232:235]
s_add_u32 m0, s18, 0xf000
v_mfma_f32_16x16x32_bf16 v[196:199], a[24:27], a[104:107], v[196:199]
buffer_load_dwordx4 v4, s[44:47], s24 offen lds
v_mfma_f32_16x16x32_bf16 v[192:195], a[20:23], a[104:107], v[192:195]
v_mfma_f32_16x16x32_bf16 v[200:203], a[20:23], a[108:111], v[200:203]
v_mfma_f32_16x16x32_bf16 v[204:207], a[24:27], a[108:111], v[204:207]
v_mfma_f32_16x16x32_bf16 a[240:243], a[28:31], a[108:111], a[240:243]
v_mfma_f32_16x16x32_bf16 a[244:247], a[32:35], a[108:111], a[244:247]
v_mfma_f32_16x16x32_bf16 a[252:255], a[32:35], a[112:115], a[252:255]
v_mfma_f32_16x16x32_bf16 a[248:251], a[28:31], a[112:115], a[248:251]
v_mfma_f32_16x16x32_bf16 v[212:215], a[24:27], a[112:115], v[212:215]
v_mfma_f32_16x16x32_bf16 v[208:211], a[20:23], a[112:115], v[208:211]
s_mul_i32 s28, s5, 0x108000
s_lshl_b32 s9, s6, 17
s_add_u32 s28, s28, s9
s_lshl_b32 s9, s4, 15
s_add_u32 s28, s28, s9
v_cvt_pk_bf16_f32 v24, v24, v25
v_cvt_pk_bf16_f32 v25, v26, v27
v_cvt_pk_bf16_f32 v26, v28, v29
v_cvt_pk_bf16_f32 v27, v30, v31
v_accvgpr_write_b32 a128, v24
v_accvgpr_write_b32 a129, v25
v_accvgpr_write_b32 a130, v26
v_accvgpr_write_b32 a131, v27
v_cvt_pk_bf16_f32 v32, v32, v33
v_cvt_pk_bf16_f32 v33, v34, v35
v_cvt_pk_bf16_f32 v34, v36, v37
v_cvt_pk_bf16_f32 v35, v38, v39
v_accvgpr_write_b32 a132, v32
v_accvgpr_write_b32 a133, v33
v_accvgpr_write_b32 a134, v34
v_accvgpr_write_b32 a135, v35
v_cvt_pk_bf16_f32 v40, v40, v41
v_cvt_pk_bf16_f32 v41, v42, v43
v_cvt_pk_bf16_f32 v42, v44, v45
v_cvt_pk_bf16_f32 v43, v46, v47
v_accvgpr_write_b32 a136, v40
v_accvgpr_write_b32 a137, v41
v_accvgpr_write_b32 a138, v42
v_accvgpr_write_b32 a139, v43
v_cvt_pk_bf16_f32 v48, v48, v49
v_cvt_pk_bf16_f32 v49, v50, v51
v_cvt_pk_bf16_f32 v50, v52, v53
v_cvt_pk_bf16_f32 v51, v54, v55
v_accvgpr_write_b32 a140, v48
v_accvgpr_write_b32 a141, v49
v_accvgpr_write_b32 a142, v50
v_accvgpr_write_b32 a143, v51
v_cvt_pk_bf16_f32 v56, v56, v57
v_cvt_pk_bf16_f32 v57, v58, v59
v_cvt_pk_bf16_f32 v58, v60, v61
v_cvt_pk_bf16_f32 v59, v62, v63
v_accvgpr_write_b32 a144, v56
v_accvgpr_write_b32 a145, v57
v_accvgpr_write_b32 a146, v58
v_accvgpr_write_b32 a147, v59
v_cvt_pk_bf16_f32 v64, v64, v65
v_cvt_pk_bf16_f32 v65, v66, v67
v_cvt_pk_bf16_f32 v66, v68, v69
v_cvt_pk_bf16_f32 v67, v70, v71
v_accvgpr_write_b32 a148, v64
v_accvgpr_write_b32 a149, v65
v_accvgpr_write_b32 a150, v66
v_accvgpr_write_b32 a151, v67
v_cvt_pk_bf16_f32 v72, v72, v73
v_cvt_pk_bf16_f32 v73, v74, v75
v_cvt_pk_bf16_f32 v74, v76, v77
v_cvt_pk_bf16_f32 v75, v78, v79
v_accvgpr_write_b32 a152, v72
v_accvgpr_write_b32 a153, v73
v_accvgpr_write_b32 a154, v74
v_accvgpr_write_b32 a155, v75
v_cvt_pk_bf16_f32 v80, v80, v81
v_cvt_pk_bf16_f32 v81, v82, v83
v_cvt_pk_bf16_f32 v82, v84, v85
v_cvt_pk_bf16_f32 v83, v86, v87
v_accvgpr_write_b32 a156, v80
v_accvgpr_write_b32 a157, v81
v_accvgpr_write_b32 a158, v82
v_accvgpr_write_b32 a159, v83
v_cvt_pk_bf16_f32 v88, v88, v89
v_cvt_pk_bf16_f32 v89, v90, v91
v_cvt_pk_bf16_f32 v90, v92, v93
v_cvt_pk_bf16_f32 v91, v94, v95
v_accvgpr_write_b32 a160, v88
v_accvgpr_write_b32 a161, v89
v_accvgpr_write_b32 a162, v90
v_accvgpr_write_b32 a163, v91
v_cvt_pk_bf16_f32 v96, v96, v97
v_cvt_pk_bf16_f32 v97, v98, v99
v_cvt_pk_bf16_f32 v98, v100, v101
v_cvt_pk_bf16_f32 v99, v102, v103
v_accvgpr_write_b32 a164, v96
v_accvgpr_write_b32 a165, v97
v_accvgpr_write_b32 a166, v98
v_accvgpr_write_b32 a167, v99
v_cvt_pk_bf16_f32 v104, v104, v105
v_cvt_pk_bf16_f32 v105, v106, v107
v_cvt_pk_bf16_f32 v106, v108, v109
v_cvt_pk_bf16_f32 v107, v110, v111
v_accvgpr_write_b32 a168, v104
v_accvgpr_write_b32 a169, v105
v_accvgpr_write_b32 a170, v106
v_accvgpr_write_b32 a171, v107
v_cvt_pk_bf16_f32 v112, v112, v113
v_cvt_pk_bf16_f32 v113, v114, v115
v_cvt_pk_bf16_f32 v114, v116, v117
v_cvt_pk_bf16_f32 v115, v118, v119
v_accvgpr_write_b32 a172, v112
v_accvgpr_write_b32 a173, v113
v_accvgpr_write_b32 a174, v114
v_accvgpr_write_b32 a175, v115
v_cvt_pk_bf16_f32 v120, v120, v121
v_cvt_pk_bf16_f32 v121, v122, v123
v_cvt_pk_bf16_f32 v122, v124, v125
v_cvt_pk_bf16_f32 v123, v126, v127
v_accvgpr_write_b32 a176, v120
v_accvgpr_write_b32 a177, v121
v_accvgpr_write_b32 a178, v122
v_accvgpr_write_b32 a179, v123
v_cvt_pk_bf16_f32 v128, v128, v129
v_cvt_pk_bf16_f32 v129, v130, v131
v_cvt_pk_bf16_f32 v130, v132, v133
v_cvt_pk_bf16_f32 v131, v134, v135
v_accvgpr_write_b32 a180, v128
v_accvgpr_write_b32 a181, v129
v_accvgpr_write_b32 a182, v130
v_accvgpr_write_b32 a183, v131
v_cvt_pk_bf16_f32 v136, v136, v137
v_cvt_pk_bf16_f32 v137, v138, v139
v_cvt_pk_bf16_f32 v138, v140, v141
v_cvt_pk_bf16_f32 v139, v142, v143
v_accvgpr_write_b32 a184, v136
v_accvgpr_write_b32 a185, v137
v_accvgpr_write_b32 a186, v138
v_accvgpr_write_b32 a187, v139
v_cvt_pk_bf16_f32 v144, v144, v145
v_cvt_pk_bf16_f32 v145, v146, v147
v_cvt_pk_bf16_f32 v146, v148, v149
v_cvt_pk_bf16_f32 v147, v150, v151
v_accvgpr_write_b32 a188, v144
v_accvgpr_write_b32 a189, v145
v_accvgpr_write_b32 a190, v146
v_accvgpr_write_b32 a191, v147
v_accvgpr_read_b32 v24, a232
v_accvgpr_read_b32 v25, a233
v_accvgpr_read_b32 v26, a234
v_accvgpr_read_b32 v27, a235
v_accvgpr_read_b32 v28, a236
v_accvgpr_read_b32 v29, a237
v_accvgpr_read_b32 v30, a238
v_accvgpr_read_b32 v31, a239
v_accvgpr_read_b32 v32, a240
v_accvgpr_read_b32 v33, a241
v_accvgpr_read_b32 v34, a242
v_accvgpr_read_b32 v35, a243
v_accvgpr_read_b32 v36, a244
v_accvgpr_read_b32 v37, a245
v_accvgpr_read_b32 v38, a246
v_accvgpr_read_b32 v39, a247
v_accvgpr_read_b32 v40, a248
v_accvgpr_read_b32 v41, a249
v_accvgpr_read_b32 v42, a250
v_accvgpr_read_b32 v43, a251
v_accvgpr_read_b32 v44, a252
v_accvgpr_read_b32 v45, a253
v_accvgpr_read_b32 v46, a254
v_accvgpr_read_b32 v47, a255
v_cvt_pk_bf16_f32 v152, v152, v153
v_cvt_pk_bf16_f32 v153, v154, v155
v_cvt_pk_bf16_f32 v154, v156, v157
v_cvt_pk_bf16_f32 v155, v158, v159
v_accvgpr_write_b32 a192, v152
v_accvgpr_write_b32 a193, v153
v_accvgpr_write_b32 a194, v154
v_accvgpr_write_b32 a195, v155
v_cvt_pk_bf16_f32 v160, v160, v161
v_cvt_pk_bf16_f32 v161, v162, v163
v_cvt_pk_bf16_f32 v162, v164, v165
v_cvt_pk_bf16_f32 v163, v166, v167
v_accvgpr_write_b32 a196, v160
v_accvgpr_write_b32 a197, v161
v_accvgpr_write_b32 a198, v162
v_accvgpr_write_b32 a199, v163
v_cvt_pk_bf16_f32 v168, v168, v169
v_cvt_pk_bf16_f32 v169, v170, v171
v_cvt_pk_bf16_f32 v170, v172, v173
v_cvt_pk_bf16_f32 v171, v174, v175
v_accvgpr_write_b32 a200, v168
v_accvgpr_write_b32 a201, v169
v_accvgpr_write_b32 a202, v170
v_accvgpr_write_b32 a203, v171
v_cvt_pk_bf16_f32 v176, v176, v177
v_cvt_pk_bf16_f32 v177, v178, v179
v_cvt_pk_bf16_f32 v178, v180, v181
v_cvt_pk_bf16_f32 v179, v182, v183
v_accvgpr_write_b32 a204, v176
v_accvgpr_write_b32 a205, v177
v_accvgpr_write_b32 a206, v178
v_accvgpr_write_b32 a207, v179
v_cvt_pk_bf16_f32 v184, v184, v185
v_cvt_pk_bf16_f32 v185, v186, v187
v_cvt_pk_bf16_f32 v186, v188, v189
v_cvt_pk_bf16_f32 v187, v190, v191
v_accvgpr_write_b32 a208, v184
v_accvgpr_write_b32 a209, v185
v_accvgpr_write_b32 a210, v186
v_accvgpr_write_b32 a211, v187
v_cvt_pk_bf16_f32 v192, v192, v193
v_cvt_pk_bf16_f32 v193, v194, v195
v_cvt_pk_bf16_f32 v194, v196, v197
v_cvt_pk_bf16_f32 v195, v198, v199
v_accvgpr_write_b32 a212, v192
v_accvgpr_write_b32 a213, v193
v_accvgpr_write_b32 a214, v194
v_accvgpr_write_b32 a215, v195
v_cvt_pk_bf16_f32 v200, v200, v201
v_cvt_pk_bf16_f32 v201, v202, v203
v_cvt_pk_bf16_f32 v202, v204, v205
v_cvt_pk_bf16_f32 v203, v206, v207
v_accvgpr_write_b32 a216, v200
v_accvgpr_write_b32 a217, v201
v_accvgpr_write_b32 a218, v202
v_accvgpr_write_b32 a219, v203
v_cvt_pk_bf16_f32 v208, v208, v209
v_cvt_pk_bf16_f32 v209, v210, v211
v_cvt_pk_bf16_f32 v210, v212, v213
v_cvt_pk_bf16_f32 v211, v214, v215
v_accvgpr_write_b32 a220, v208
v_accvgpr_write_b32 a221, v209
v_accvgpr_write_b32 a222, v210
v_accvgpr_write_b32 a223, v211
v_cvt_pk_bf16_f32 v216, v216, v217
v_cvt_pk_bf16_f32 v217, v218, v219
v_cvt_pk_bf16_f32 v218, v220, v221
v_cvt_pk_bf16_f32 v219, v222, v223
v_accvgpr_write_b32 a224, v216
v_accvgpr_write_b32 a225, v217
v_accvgpr_write_b32 a226, v218
v_accvgpr_write_b32 a227, v219
v_cvt_pk_bf16_f32 v224, v224, v225
v_cvt_pk_bf16_f32 v225, v226, v227
v_cvt_pk_bf16_f32 v226, v228, v229
v_cvt_pk_bf16_f32 v227, v230, v231
v_accvgpr_write_b32 a228, v224
v_accvgpr_write_b32 a229, v225
v_accvgpr_write_b32 a230, v226
v_accvgpr_write_b32 a231, v227
v_cvt_pk_bf16_f32 v232, v232, v233
v_cvt_pk_bf16_f32 v233, v234, v235
v_cvt_pk_bf16_f32 v234, v236, v237
v_cvt_pk_bf16_f32 v235, v238, v239
v_accvgpr_write_b32 a232, v232
v_accvgpr_write_b32 a233, v233
v_accvgpr_write_b32 a234, v234
v_accvgpr_write_b32 a235, v235
v_cvt_pk_bf16_f32 v240, v240, v241
v_cvt_pk_bf16_f32 v241, v242, v243
v_cvt_pk_bf16_f32 v242, v244, v245
v_cvt_pk_bf16_f32 v243, v246, v247
v_accvgpr_write_b32 a236, v240
v_accvgpr_write_b32 a237, v241
v_accvgpr_write_b32 a238, v242
v_accvgpr_write_b32 a239, v243
v_cvt_pk_bf16_f32 v248, v248, v249
v_cvt_pk_bf16_f32 v249, v250, v251
v_cvt_pk_bf16_f32 v250, v252, v253
v_cvt_pk_bf16_f32 v251, v254, v255
v_accvgpr_write_b32 a240, v248
v_accvgpr_write_b32 a241, v249
v_accvgpr_write_b32 a242, v250
v_accvgpr_write_b32 a243, v251
v_cvt_pk_bf16_f32 v24, v24, v25
v_cvt_pk_bf16_f32 v25, v26, v27
v_cvt_pk_bf16_f32 v26, v28, v29
v_cvt_pk_bf16_f32 v27, v30, v31
v_accvgpr_write_b32 a244, v24
v_accvgpr_write_b32 a245, v25
v_accvgpr_write_b32 a246, v26
v_accvgpr_write_b32 a247, v27
v_cvt_pk_bf16_f32 v32, v32, v33
v_cvt_pk_bf16_f32 v33, v34, v35
v_cvt_pk_bf16_f32 v34, v36, v37
v_cvt_pk_bf16_f32 v35, v38, v39
v_accvgpr_write_b32 a248, v32
v_accvgpr_write_b32 a249, v33
v_accvgpr_write_b32 a250, v34
v_accvgpr_write_b32 a251, v35
v_cvt_pk_bf16_f32 v40, v40, v41
v_cvt_pk_bf16_f32 v41, v42, v43
v_cvt_pk_bf16_f32 v42, v44, v45
v_cvt_pk_bf16_f32 v43, v46, v47
v_accvgpr_write_b32 a252, v40
v_accvgpr_write_b32 a253, v41
v_accvgpr_write_b32 a254, v42
v_accvgpr_write_b32 a255, v43
s_waitcnt lgkmcnt(0)
v_mfma_f32_16x16x32_bf16 v[24:27], a[40:43], a[0:3], 0
v_add_u32 v5, 0x80000, v5
v_add_u32 v6, 0x80000, v6
ds_read_b128 a[20:23], v9 offset:0
v_mfma_f32_16x16x32_bf16 v[56:59], a[40:43], a[4:7], 0
v_add_u32 v7, 0x60000, v7
v_add_u32 v4, 0x80, v4
ds_read_b128 a[24:27], v9 offset:2048
v_mfma_f32_16x16x32_bf16 v[88:91], a[40:43], a[8:11], 0
ds_read_b128 a[28:31], v9 offset:4096
ds_read_b128 a[32:35], v9 offset:6144
v_mfma_f32_16x16x32_bf16 v[120:123], a[40:43], a[12:15], 0
ds_read_b128 a[36:39], v11
ds_read_b64_tr_b16 a[104:105], v15 offset:6144
v_mfma_f32_16x16x32_bf16 v[124:127], a[44:47], a[12:15], 0
ds_read_b64_tr_b16 a[106:107], v15 offset:6400
ds_read_b64_tr_b16 a[108:109], v14 offset:10240
v_mfma_f32_16x16x32_bf16 v[92:95], a[44:47], a[8:11], 0
ds_read_b64_tr_b16 a[110:111], v14 offset:10496
ds_read_b64_tr_b16 a[112:113], v15 offset:10240
v_mfma_f32_16x16x32_bf16 v[60:63], a[44:47], a[4:7], 0
ds_read_b64_tr_b16 a[114:115], v15 offset:10496
v_mfma_f32_16x16x32_bf16 v[28:31], a[44:47], a[0:3], 0
ds_read_b64_tr_b16 a[40:41], v12 offset:8192
ds_read_b64_tr_b16 a[42:43], v12 offset:9216
v_mfma_f32_16x16x32_bf16 v[32:35], a[48:51], a[0:3], 0
ds_read_b64_tr_b16 a[44:45], v13 offset:8192
v_mfma_f32_16x16x32_bf16 v[64:67], a[48:51], a[4:7], 0
s_add_u32 m0, s16, 0x0
ds_read_b64_tr_b16 a[46:47], v13 offset:9216
s_waitcnt lgkmcnt(11)
v_mfma_f32_16x16x32_bf16 v[96:99], a[48:51], a[8:11], 0
buffer_load_dwordx4 v22, s[44:47], s20 offen lds
v_mfma_f32_16x16x32_bf16 v[128:131], a[48:51], a[12:15], 0
ds_read_b64_tr_b16 a[48:49], v12 offset:8448
v_mfma_f32_16x16x32_bf16 v[132:135], a[52:55], a[12:15], 0
ds_read_b64_tr_b16 a[50:51], v12 offset:9472
v_mfma_f32_16x16x32_bf16 v[100:103], a[52:55], a[8:11], 0
s_add_u32 m0, s16, 0x400
v_mfma_f32_16x16x32_bf16 v[68:71], a[52:55], a[4:7], 0
buffer_load_dwordx4 v23, s[44:47], s20 offen lds
v_mfma_f32_16x16x32_bf16 v[36:39], a[52:55], a[0:3], 0
ds_read_b64_tr_b16 a[52:53], v13 offset:8448
v_mfma_f32_16x16x32_bf16 v[40:43], a[56:59], a[0:3], 0
ds_read_b64_tr_b16 a[54:55], v13 offset:9472
v_mfma_f32_16x16x32_bf16 v[72:75], a[56:59], a[4:7], 0
v_mfma_f32_16x16x32_bf16 v[104:107], a[56:59], a[8:11], 0
s_add_u32 m0, s16, 0x800
v_mfma_f32_16x16x32_bf16 v[136:139], a[56:59], a[12:15], 0
buffer_load_dwordx4 v22, s[44:47], s21 offen lds
v_mfma_f32_16x16x32_bf16 v[140:143], a[60:63], a[12:15], 0
ds_read_b64_tr_b16 a[56:57], v12 offset:8704
v_mfma_f32_16x16x32_bf16 v[108:111], a[60:63], a[8:11], 0
ds_read_b64_tr_b16 a[58:59], v12 offset:9728
v_mfma_f32_16x16x32_bf16 v[76:79], a[60:63], a[4:7], 0
s_add_u32 m0, s16, 0xc00
v_mfma_f32_16x16x32_bf16 v[44:47], a[60:63], a[0:3], 0
buffer_load_dwordx4 v23, s[44:47], s21 offen lds
v_mfma_f32_16x16x32_bf16 v[48:51], a[64:67], a[0:3], 0
ds_read_b64_tr_b16 a[60:61], v13 offset:8704
v_mfma_f32_16x16x32_bf16 v[80:83], a[64:67], a[4:7], 0
ds_read_b64_tr_b16 a[62:63], v13 offset:9728
v_mfma_f32_16x16x32_bf16 v[112:115], a[64:67], a[8:11], 0
v_mfma_f32_16x16x32_bf16 v[144:147], a[64:67], a[12:15], 0
s_add_u32 s8, s28, 0x0
ds_read_b64_tr_b16 a[64:65], v12 offset:8960
v_mfma_f32_16x16x32_bf16 v[148:151], a[68:71], a[12:15], 0
buffer_store_dwordx4 a[128:131], v16, s[88:91], s8 offen sc1
v_mfma_f32_16x16x32_bf16 v[116:119], a[68:71], a[8:11], 0
ds_read_b64_tr_b16 a[66:67], v12 offset:9984
v_mfma_f32_16x16x32_bf16 v[84:87], a[68:71], a[4:7], 0
v_mfma_f32_16x16x32_bf16 v[52:55], a[68:71], a[0:3], 0
ds_read_b64_tr_b16 a[68:69], v13 offset:8960
v_mfma_f32_16x16x32_bf16 v[152:155], a[72:75], a[0:3], 0
s_add_u32 m0, s16, 0x1000
ds_read_b64_tr_b16 a[70:71], v13 offset:9984
v_mfma_f32_16x16x32_bf16 v[160:163], a[72:75], a[4:7], 0
buffer_load_dwordx4 v22, s[44:47], s22 offen lds
v_mfma_f32_16x16x32_bf16 v[168:171], a[72:75], a[8:11], 0
v_mfma_f32_16x16x32_bf16 v[176:179], a[72:75], a[12:15], 0
ds_read_b64_tr_b16 a[72:73], v14 offset:2048
v_mfma_f32_16x16x32_bf16 v[180:183], a[76:79], a[12:15], 0
s_add_u32 m0, s16, 0x1400
ds_read_b64_tr_b16 a[74:75], v14 offset:2304
v_mfma_f32_16x16x32_bf16 v[172:175], a[76:79], a[8:11], 0
buffer_load_dwordx4 v23, s[44:47], s22 offen lds
v_mfma_f32_16x16x32_bf16 v[164:167], a[76:79], a[4:7], 0
v_mfma_f32_16x16x32_bf16 v[156:159], a[76:79], a[0:3], 0
ds_read_b64_tr_b16 a[76:77], v15 offset:2048
v_mfma_f32_16x16x32_bf16 v[184:187], a[80:83], a[0:3], 0
ds_read_b64_tr_b16 a[78:79], v15 offset:2304
v_mfma_f32_16x16x32_bf16 v[192:195], a[80:83], a[4:7], 0
s_add_u32 m0, s16, 0x1800
v_mfma_f32_16x16x32_bf16 v[200:203], a[80:83], a[8:11], 0
buffer_load_dwordx4 v22, s[44:47], s23 offen lds
v_mfma_f32_16x16x32_bf16 v[208:211], a[80:83], a[12:15], 0
v_mfma_f32_16x16x32_bf16 v[248:251], a[80:83], a[16:19], 0
ds_read_b64_tr_b16 a[80:81], v14 offset:6144
v_mfma_f32_16x16x32_bf16 v[212:215], a[84:87], a[12:15], 0
s_add_u32 m0, s16, 0x1c00
ds_read_b64_tr_b16 a[82:83], v14 offset:6400
v_mfma_f32_16x16x32_bf16 v[204:207], a[84:87], a[8:11], 0
buffer_load_dwordx4 v23, s[44:47], s23 offen lds
v_mfma_f32_16x16x32_bf16 v[196:199], a[84:87], a[4:7], 0
v_mfma_f32_16x16x32_bf16 v[188:191], a[84:87], a[0:3], 0
v_mfma_f32_16x16x32_bf16 v[216:219], a[0:3], a[88:91], 0
v_mfma_f32_16x16x32_bf16 v[224:227], a[4:7], a[88:91], 0
s_add_u32 s8, s28, 0x400
v_mfma_f32_16x16x32_bf16 v[232:235], a[8:11], a[88:91], 0
buffer_store_dwordx4 a[132:135], v16, s[88:91], s8 offen sc1
v_mfma_f32_16x16x32_bf16 v[240:243], a[12:15], a[88:91], 0
v_mfma_f32_16x16x32_bf16 v[252:255], a[16:19], a[88:91], 0
v_mfma_f32_16x16x32_bf16 v[244:247], a[12:15], a[92:95], 0
v_mfma_f32_16x16x32_bf16 v[236:239], a[8:11], a[92:95], 0
v_add_u32 v12, 0xffff0000, v12
v_add_u32 v13, 0xffff0000, v13
v_mfma_f32_16x16x32_bf16 v[228:231], a[4:7], a[92:95], 0
v_add_u32 v14, 0xffff0000, v14
v_add_u32 v15, 0xffff0000, v15
v_mfma_f32_16x16x32_bf16 v[220:223], a[0:3], a[92:95], 0
v_add_u32 v10, 0xffff0000, v10
v_add_u32 v11, 0xffff0000, v11
s_waitcnt vmcnt(18) lgkmcnt(0)
s_barrier
v_mfma_f32_16x16x32_bf16 v[24:27], a[40:43], a[20:23], v[24:27]
s_add_u32 m0, s17, 0x10000
v_add_u32 v22, 0x80, v22
v_add_u32 v23, 0x80, v23
ds_read_b128 a[0:3], v8 offset:32768
v_mfma_f32_16x16x32_bf16 v[56:59], a[40:43], a[24:27], v[56:59]
buffer_load_dwordx4 v5, s[52:55], 0 offen lds
v_mfma_f32_16x16x32_bf16 v[88:91], a[40:43], a[28:31], v[88:91]
ds_read_b128 a[4:7], v8 offset:34816
ds_read_b128 a[8:11], v8 offset:36864
v_mfma_f32_16x16x32_bf16 v[120:123], a[40:43], a[32:35], v[120:123]
ds_read_b128 a[12:15], v8 offset:38912
ds_read_b128 a[16:19], v10
v_mfma_f32_16x16x32_bf16 v[124:127], a[44:47], a[32:35], v[124:127]
ds_read_b64_tr_b16 a[84:85], v15 offset:4096
ds_read_b64_tr_b16 a[86:87], v15 offset:4352
v_mfma_f32_16x16x32_bf16 v[92:95], a[44:47], a[28:31], v[92:95]
s_add_u32 m0, s17, 0x10400
ds_read_b64_tr_b16 a[88:89], v14 offset:8192
ds_read_b64_tr_b16 a[90:91], v14 offset:8448
v_mfma_f32_16x16x32_bf16 v[60:63], a[44:47], a[24:27], v[60:63]
buffer_load_dwordx4 v5, s[52:55], s13 offen lds
v_mfma_f32_16x16x32_bf16 v[28:31], a[44:47], a[20:23], v[28:31]
ds_read_b64_tr_b16 a[92:93], v15 offset:8192
ds_read_b64_tr_b16 a[94:95], v15 offset:8448
v_mfma_f32_16x16x32_bf16 v[32:35], a[48:51], a[20:23], v[32:35]
ds_read_b64_tr_b16 a[40:41], v12 offset:0
ds_read_b64_tr_b16 a[42:43], v12 offset:1024
v_mfma_f32_16x16x32_bf16 v[64:67], a[48:51], a[24:27], v[64:67]
ds_read_b64_tr_b16 a[44:45], v13 offset:0
v_mfma_f32_16x16x32_bf16 v[96:99], a[48:51], a[28:31], v[96:99]
ds_read_b64_tr_b16 a[46:47], v13 offset:1024
v_mfma_f32_16x16x32_bf16 v[128:131], a[48:51], a[32:35], v[128:131]
s_add_u32 m0, s17, 0x10800
ds_read_b64_tr_b16 a[48:49], v12 offset:256
v_mfma_f32_16x16x32_bf16 v[132:135], a[52:55], a[32:35], v[132:135]
buffer_load_dwordx4 v6, s[52:55], 0 offen lds
v_mfma_f32_16x16x32_bf16 v[100:103], a[52:55], a[28:31], v[100:103]
ds_read_b64_tr_b16 a[50:51], v12 offset:1280
v_mfma_f32_16x16x32_bf16 v[68:71], a[52:55], a[24:27], v[68:71]
v_mfma_f32_16x16x32_bf16 v[36:39], a[52:55], a[20:23], v[36:39]
ds_read_b64_tr_b16 a[52:53], v13 offset:256
v_mfma_f32_16x16x32_bf16 v[40:43], a[56:59], a[20:23], v[40:43]
s_add_u32 m0, s17, 0x10c00
ds_read_b64_tr_b16 a[54:55], v13 offset:1280
v_mfma_f32_16x16x32_bf16 v[72:75], a[56:59], a[24:27], v[72:75]
buffer_load_dwordx4 v6, s[52:55], s13 offen lds
v_mfma_f32_16x16x32_bf16 v[104:107], a[56:59], a[28:31], v[104:107]
v_mfma_f32_16x16x32_bf16 v[136:139], a[56:59], a[32:35], v[136:139]
ds_read_b64_tr_b16 a[56:57], v12 offset:512
v_mfma_f32_16x16x32_bf16 v[140:143], a[60:63], a[32:35], v[140:143]
ds_read_b64_tr_b16 a[58:59], v12 offset:1536
v_mfma_f32_16x16x32_bf16 v[108:111], a[60:63], a[28:31], v[108:111]
v_mfma_f32_16x16x32_bf16 v[76:79], a[60:63], a[24:27], v[76:79]
s_add_u32 s8, s28, 0x800
v_mfma_f32_16x16x32_bf16 v[44:47], a[60:63], a[20:23], v[44:47]
buffer_store_dwordx4 a[136:139], v16, s[88:91], s8 offen sc1
v_mfma_f32_16x16x32_bf16 v[48:51], a[64:67], a[20:23], v[48:51]
ds_read_b64_tr_b16 a[60:61], v13 offset:512
v_mfma_f32_16x16x32_bf16 v[80:83], a[64:67], a[24:27], v[80:83]
ds_read_b64_tr_b16 a[62:63], v13 offset:1536
v_mfma_f32_16x16x32_bf16 v[112:115], a[64:67], a[28:31], v[112:115]
v_mfma_f32_16x16x32_bf16 v[144:147], a[64:67], a[32:35], v[144:147]
s_add_u32 m0, s18, 0x14000
ds_read_b64_tr_b16 a[64:65], v12 offset:768
v_mfma_f32_16x16x32_bf16 v[148:151], a[68:71], a[32:35], v[148:151]
buffer_load_dwordx4 v7, s[68:71], 0 offen lds
v_mfma_f32_16x16x32_bf16 v[116:119], a[68:71], a[28:31], v[116:119]
ds_read_b64_tr_b16 a[66:67], v12 offset:1792
v_mfma_f32_16x16x32_bf16 v[84:87], a[68:71], a[24:27], v[84:87]
v_mfma_f32_16x16x32_bf16 v[52:55], a[68:71], a[20:23], v[52:55]
ds_read_b64_tr_b16 a[68:69], v13 offset:768
v_mfma_f32_16x16x32_bf16 v[152:155], a[72:75], a[20:23], v[152:155]
ds_read_b64_tr_b16 a[70:71], v13 offset:1792
v_mfma_f32_16x16x32_bf16 v[160:163], a[72:75], a[24:27], v[160:163]
s_add_u32 m0, s18, 0x15000
v_mfma_f32_16x16x32_bf16 v[168:171], a[72:75], a[28:31], v[168:171]
buffer_load_dwordx4 v7, s[68:71], s25 offen lds
v_mfma_f32_16x16x32_bf16 v[176:179], a[72:75], a[32:35], v[176:179]
ds_read_b64_tr_b16 a[72:73], v14 offset:0
v_mfma_f32_16x16x32_bf16 v[180:183], a[76:79], a[32:35], v[180:183]
ds_read_b64_tr_b16 a[74:75], v14 offset:256
v_mfma_f32_16x16x32_bf16 v[172:175], a[76:79], a[28:31], v[172:175]
v_mfma_f32_16x16x32_bf16 v[164:167], a[76:79], a[24:27], v[164:167]
s_add_u32 m0, s18, 0x16000
v_mfma_f32_16x16x32_bf16 v[156:159], a[76:79], a[20:23], v[156:159]
buffer_load_dwordx4 v7, s[68:71], s26 offen lds
v_mfma_f32_16x16x32_bf16 v[184:187], a[80:83], a[20:23], v[184:187]
ds_read_b64_tr_b16 a[76:77], v15 offset:0
v_mfma_f32_16x16x32_bf16 v[192:195], a[80:83], a[24:27], v[192:195]
ds_read_b64_tr_b16 a[78:79], v15 offset:256
v_mfma_f32_16x16x32_bf16 v[200:203], a[80:83], a[28:31], v[200:203]
v_mfma_f32_16x16x32_bf16 v[208:211], a[80:83], a[32:35], v[208:211]
v_mfma_f32_16x16x32_bf16 v[248:251], a[80:83], a[36:39], v[248:251]
s_add_u32 m0, s18, 0x17000
ds_read_b64_tr_b16 a[80:81], v14 offset:4096
v_mfma_f32_16x16x32_bf16 v[212:215], a[104:107], a[32:35], v[212:215]
buffer_load_dwordx4 v4, s[44:47], s24 offen lds
v_mfma_f32_16x16x32_bf16 v[204:207], a[104:107], a[28:31], v[204:207]
ds_read_b64_tr_b16 a[82:83], v14 offset:4352
v_mfma_f32_16x16x32_bf16 v[196:199], a[104:107], a[24:27], v[196:199]
v_mfma_f32_16x16x32_bf16 v[188:191], a[104:107], a[20:23], v[188:191]
v_mfma_f32_16x16x32_bf16 v[216:219], a[20:23], a[108:111], v[216:219]
s_add_u32 s8, s28, 0xc00
v_mfma_f32_16x16x32_bf16 v[224:227], a[24:27], a[108:111], v[224:227]
buffer_store_dwordx4 a[140:143], v16, s[88:91], s8 offen sc1
v_mfma_f32_16x16x32_bf16 v[232:235], a[28:31], a[108:111], v[232:235]
v_mfma_f32_16x16x32_bf16 v[240:243], a[32:35], a[108:111], v[240:243]
v_mfma_f32_16x16x32_bf16 v[252:255], a[36:39], a[108:111], v[252:255]
v_mfma_f32_16x16x32_bf16 v[244:247], a[32:35], a[112:115], v[244:247]
v_mfma_f32_16x16x32_bf16 v[236:239], a[28:31], a[112:115], v[236:239]
v_mfma_f32_16x16x32_bf16 v[228:231], a[24:27], a[112:115], v[228:231]
v_mfma_f32_16x16x32_bf16 v[220:223], a[20:23], a[112:115], v[220:223]
s_waitcnt lgkmcnt(0)
v_mfma_f32_16x16x32_bf16 v[24:27], a[40:43], a[0:3], v[24:27]
v_add_u32 v5, 0x80000, v5
v_add_u32 v6, 0x80000, v6
ds_read_b128 a[20:23], v9 offset:32768
v_mfma_f32_16x16x32_bf16 v[56:59], a[40:43], a[4:7], v[56:59]
v_add_u32 v7, 0x60000, v7
v_add_u32 v4, 0x80, v4
ds_read_b128 a[24:27], v9 offset:34816
v_mfma_f32_16x16x32_bf16 v[88:91], a[40:43], a[8:11], v[88:91]
ds_read_b128 a[28:31], v9 offset:36864
ds_read_b128 a[32:35], v9 offset:38912
v_mfma_f32_16x16x32_bf16 v[120:123], a[40:43], a[12:15], v[120:123]
ds_read_b128 a[36:39], v11
ds_read_b64_tr_b16 a[104:105], v15 offset:6144
v_mfma_f32_16x16x32_bf16 v[124:127], a[44:47], a[12:15], v[124:127]
ds_read_b64_tr_b16 a[106:107], v15 offset:6400
ds_read_b64_tr_b16 a[108:109], v14 offset:10240
v_mfma_f32_16x16x32_bf16 v[92:95], a[44:47], a[8:11], v[92:95]
ds_read_b64_tr_b16 a[110:111], v14 offset:10496
ds_read_b64_tr_b16 a[112:113], v15 offset:10240
v_mfma_f32_16x16x32_bf16 v[60:63], a[44:47], a[4:7], v[60:63]
ds_read_b64_tr_b16 a[114:115], v15 offset:10496
v_mfma_f32_16x16x32_bf16 v[28:31], a[44:47], a[0:3], v[28:31]
ds_read_b64_tr_b16 a[40:41], v12 offset:8192
ds_read_b64_tr_b16 a[42:43], v12 offset:9216
v_mfma_f32_16x16x32_bf16 v[32:35], a[48:51], a[0:3], v[32:35]
ds_read_b64_tr_b16 a[44:45], v13 offset:8192
v_mfma_f32_16x16x32_bf16 v[64:67], a[48:51], a[4:7], v[64:67]
s_add_u32 m0, s16, 0x8000
ds_read_b64_tr_b16 a[46:47], v13 offset:9216
s_waitcnt lgkmcnt(11)
v_mfma_f32_16x16x32_bf16 v[96:99], a[48:51], a[8:11], v[96:99]
buffer_load_dwordx4 v22, s[44:47], s20 offen lds
v_mfma_f32_16x16x32_bf16 v[128:131], a[48:51], a[12:15], v[128:131]
ds_read_b64_tr_b16 a[48:49], v12 offset:8448
v_mfma_f32_16x16x32_bf16 v[132:135], a[52:55], a[12:15], v[132:135]
ds_read_b64_tr_b16 a[50:51], v12 offset:9472
v_mfma_f32_16x16x32_bf16 v[100:103], a[52:55], a[8:11], v[100:103]
s_add_u32 m0, s16, 0x8400
v_mfma_f32_16x16x32_bf16 v[68:71], a[52:55], a[4:7], v[68:71]
buffer_load_dwordx4 v23, s[44:47], s20 offen lds
v_mfma_f32_16x16x32_bf16 v[36:39], a[52:55], a[0:3], v[36:39]
ds_read_b64_tr_b16 a[52:53], v13 offset:8448
v_mfma_f32_16x16x32_bf16 v[40:43], a[56:59], a[0:3], v[40:43]
ds_read_b64_tr_b16 a[54:55], v13 offset:9472
v_mfma_f32_16x16x32_bf16 v[72:75], a[56:59], a[4:7], v[72:75]
v_mfma_f32_16x16x32_bf16 v[104:107], a[56:59], a[8:11], v[104:107]
s_add_u32 m0, s16, 0x8800
v_mfma_f32_16x16x32_bf16 v[136:139], a[56:59], a[12:15], v[136:139]
buffer_load_dwordx4 v22, s[44:47], s21 offen lds
v_mfma_f32_16x16x32_bf16 v[140:143], a[60:63], a[12:15], v[140:143]
ds_read_b64_tr_b16 a[56:57], v12 offset:8704
v_mfma_f32_16x16x32_bf16 v[108:111], a[60:63], a[8:11], v[108:111]
ds_read_b64_tr_b16 a[58:59], v12 offset:9728
v_mfma_f32_16x16x32_bf16 v[76:79], a[60:63], a[4:7], v[76:79]
s_add_u32 m0, s16, 0x8c00
v_mfma_f32_16x16x32_bf16 v[44:47], a[60:63], a[0:3], v[44:47]
buffer_load_dwordx4 v23, s[44:47], s21 offen lds
v_mfma_f32_16x16x32_bf16 v[48:51], a[64:67], a[0:3], v[48:51]
ds_read_b64_tr_b16 a[60:61], v13 offset:8704
v_mfma_f32_16x16x32_bf16 v[80:83], a[64:67], a[4:7], v[80:83]
ds_read_b64_tr_b16 a[62:63], v13 offset:9728
v_mfma_f32_16x16x32_bf16 v[112:115], a[64:67], a[8:11], v[112:115]
v_mfma_f32_16x16x32_bf16 v[144:147], a[64:67], a[12:15], v[144:147]
s_add_u32 s8, s28, 0x1000
ds_read_b64_tr_b16 a[64:65], v12 offset:8960
v_mfma_f32_16x16x32_bf16 v[148:151], a[68:71], a[12:15], v[148:151]
buffer_store_dwordx4 a[144:147], v16, s[88:91], s8 offen sc1
v_mfma_f32_16x16x32_bf16 v[116:119], a[68:71], a[8:11], v[116:119]
ds_read_b64_tr_b16 a[66:67], v12 offset:9984
v_mfma_f32_16x16x32_bf16 v[84:87], a[68:71], a[4:7], v[84:87]
v_mfma_f32_16x16x32_bf16 v[52:55], a[68:71], a[0:3], v[52:55]
ds_read_b64_tr_b16 a[68:69], v13 offset:8960
v_mfma_f32_16x16x32_bf16 v[152:155], a[72:75], a[0:3], v[152:155]
s_add_u32 m0, s16, 0x9000
ds_read_b64_tr_b16 a[70:71], v13 offset:9984
v_mfma_f32_16x16x32_bf16 v[160:163], a[72:75], a[4:7], v[160:163]
buffer_load_dwordx4 v22, s[44:47], s22 offen lds
v_mfma_f32_16x16x32_bf16 v[168:171], a[72:75], a[8:11], v[168:171]
v_mfma_f32_16x16x32_bf16 v[176:179], a[72:75], a[12:15], v[176:179]
ds_read_b64_tr_b16 a[72:73], v14 offset:2048
v_mfma_f32_16x16x32_bf16 v[180:183], a[76:79], a[12:15], v[180:183]
s_add_u32 m0, s16, 0x9400
ds_read_b64_tr_b16 a[74:75], v14 offset:2304
v_mfma_f32_16x16x32_bf16 v[172:175], a[76:79], a[8:11], v[172:175]
buffer_load_dwordx4 v23, s[44:47], s22 offen lds
v_mfma_f32_16x16x32_bf16 v[164:167], a[76:79], a[4:7], v[164:167]
v_mfma_f32_16x16x32_bf16 v[156:159], a[76:79], a[0:3], v[156:159]
ds_read_b64_tr_b16 a[76:77], v15 offset:2048
v_mfma_f32_16x16x32_bf16 v[184:187], a[80:83], a[0:3], v[184:187]
ds_read_b64_tr_b16 a[78:79], v15 offset:2304
v_mfma_f32_16x16x32_bf16 v[192:195], a[80:83], a[4:7], v[192:195]
s_add_u32 m0, s16, 0x9800
v_mfma_f32_16x16x32_bf16 v[200:203], a[80:83], a[8:11], v[200:203]
buffer_load_dwordx4 v22, s[44:47], s23 offen lds
v_mfma_f32_16x16x32_bf16 v[208:211], a[80:83], a[12:15], v[208:211]
v_mfma_f32_16x16x32_bf16 v[248:251], a[80:83], a[16:19], v[248:251]
ds_read_b64_tr_b16 a[80:81], v14 offset:6144
v_mfma_f32_16x16x32_bf16 v[212:215], a[84:87], a[12:15], v[212:215]
s_add_u32 m0, s16, 0x9c00
ds_read_b64_tr_b16 a[82:83], v14 offset:6400
v_mfma_f32_16x16x32_bf16 v[204:207], a[84:87], a[8:11], v[204:207]
buffer_load_dwordx4 v23, s[44:47], s23 offen lds
v_mfma_f32_16x16x32_bf16 v[196:199], a[84:87], a[4:7], v[196:199]
v_mfma_f32_16x16x32_bf16 v[188:191], a[84:87], a[0:3], v[188:191]
v_mfma_f32_16x16x32_bf16 v[216:219], a[0:3], a[88:91], v[216:219]
v_mfma_f32_16x16x32_bf16 v[224:227], a[4:7], a[88:91], v[224:227]
s_add_u32 s8, s28, 0x1400
v_mfma_f32_16x16x32_bf16 v[232:235], a[8:11], a[88:91], v[232:235]
buffer_store_dwordx4 a[148:151], v16, s[88:91], s8 offen sc1
v_mfma_f32_16x16x32_bf16 v[240:243], a[12:15], a[88:91], v[240:243]
v_mfma_f32_16x16x32_bf16 v[252:255], a[16:19], a[88:91], v[252:255]
v_mfma_f32_16x16x32_bf16 v[244:247], a[12:15], a[92:95], v[244:247]
v_mfma_f32_16x16x32_bf16 v[236:239], a[8:11], a[92:95], v[236:239]
v_add_u32 v12, 0x8000, v12
v_add_u32 v13, 0x8000, v13
v_mfma_f32_16x16x32_bf16 v[228:231], a[4:7], a[92:95], v[228:231]
v_add_u32 v14, 0x8000, v14
v_add_u32 v15, 0x8000, v15
v_mfma_f32_16x16x32_bf16 v[220:223], a[0:3], a[92:95], v[220:223]
v_add_u32 v10, 0x8000, v10
v_add_u32 v11, 0x8000, v11
s_waitcnt vmcnt(21) lgkmcnt(0)
s_barrier
v_mfma_f32_16x16x32_bf16 v[24:27], a[40:43], a[20:23], v[24:27]
s_add_u32 m0, s17, 0x0
v_add_u32 v22, 0x80, v22
v_add_u32 v23, 0x80, v23
ds_read_b128 a[0:3], v8 offset:0
v_mfma_f32_16x16x32_bf16 v[56:59], a[40:43], a[24:27], v[56:59]
buffer_load_dwordx4 v5, s[52:55], 0 offen lds
v_mfma_f32_16x16x32_bf16 v[88:91], a[40:43], a[28:31], v[88:91]
ds_read_b128 a[4:7], v8 offset:2048
ds_read_b128 a[8:11], v8 offset:4096
v_mfma_f32_16x16x32_bf16 v[120:123], a[40:43], a[32:35], v[120:123]
ds_read_b128 a[12:15], v8 offset:6144
ds_read_b128 a[16:19], v10
v_mfma_f32_16x16x32_bf16 v[124:127], a[44:47], a[32:35], v[124:127]
ds_read_b64_tr_b16 a[84:85], v15 offset:4096
ds_read_b64_tr_b16 a[86:87], v15 offset:4352
v_mfma_f32_16x16x32_bf16 v[92:95], a[44:47], a[28:31], v[92:95]
s_add_u32 m0, s17, 0x400
ds_read_b64_tr_b16 a[88:89], v14 offset:8192
ds_read_b64_tr_b16 a[90:91], v14 offset:8448
v_mfma_f32_16x16x32_bf16 v[60:63], a[44:47], a[24:27], v[60:63]
buffer_load_dwordx4 v5, s[52:55], s13 offen lds
v_mfma_f32_16x16x32_bf16 v[28:31], a[44:47], a[20:23], v[28:31]
ds_read_b64_tr_b16 a[92:93], v15 offset:8192
ds_read_b64_tr_b16 a[94:95], v15 offset:8448
v_mfma_f32_16x16x32_bf16 v[32:35], a[48:51], a[20:23], v[32:35]
ds_read_b64_tr_b16 a[40:41], v12 offset:0
ds_read_b64_tr_b16 a[42:43], v12 offset:1024
v_mfma_f32_16x16x32_bf16 v[64:67], a[48:51], a[24:27], v[64:67]
ds_read_b64_tr_b16 a[44:45], v13 offset:0
v_mfma_f32_16x16x32_bf16 v[96:99], a[48:51], a[28:31], v[96:99]
ds_read_b64_tr_b16 a[46:47], v13 offset:1024
v_mfma_f32_16x16x32_bf16 v[128:131], a[48:51], a[32:35], v[128:131]
s_add_u32 m0, s17, 0x800
ds_read_b64_tr_b16 a[48:49], v12 offset:256
v_mfma_f32_16x16x32_bf16 v[132:135], a[52:55], a[32:35], v[132:135]
buffer_load_dwordx4 v6, s[52:55], 0 offen lds
v_mfma_f32_16x16x32_bf16 v[100:103], a[52:55], a[28:31], v[100:103]
ds_read_b64_tr_b16 a[50:51], v12 offset:1280
v_mfma_f32_16x16x32_bf16 v[68:71], a[52:55], a[24:27], v[68:71]
v_mfma_f32_16x16x32_bf16 v[36:39], a[52:55], a[20:23], v[36:39]
ds_read_b64_tr_b16 a[52:53], v13 offset:256
v_mfma_f32_16x16x32_bf16 v[40:43], a[56:59], a[20:23], v[40:43]
s_add_u32 m0, s17, 0xc00
ds_read_b64_tr_b16 a[54:55], v13 offset:1280
v_mfma_f32_16x16x32_bf16 v[72:75], a[56:59], a[24:27], v[72:75]
buffer_load_dwordx4 v6, s[52:55], s13 offen lds
v_mfma_f32_16x16x32_bf16 v[104:107], a[56:59], a[28:31], v[104:107]
v_mfma_f32_16x16x32_bf16 v[136:139], a[56:59], a[32:35], v[136:139]
ds_read_b64_tr_b16 a[56:57], v12 offset:512
v_mfma_f32_16x16x32_bf16 v[140:143], a[60:63], a[32:35], v[140:143]
ds_read_b64_tr_b16 a[58:59], v12 offset:1536
v_mfma_f32_16x16x32_bf16 v[108:111], a[60:63], a[28:31], v[108:111]
v_mfma_f32_16x16x32_bf16 v[76:79], a[60:63], a[24:27], v[76:79]
s_add_u32 s8, s28, 0x1800
v_mfma_f32_16x16x32_bf16 v[44:47], a[60:63], a[20:23], v[44:47]
buffer_store_dwordx4 a[152:155], v16, s[88:91], s8 offen sc1
v_mfma_f32_16x16x32_bf16 v[48:51], a[64:67], a[20:23], v[48:51]
ds_read_b64_tr_b16 a[60:61], v13 offset:512
v_mfma_f32_16x16x32_bf16 v[80:83], a[64:67], a[24:27], v[80:83]
ds_read_b64_tr_b16 a[62:63], v13 offset:1536
v_mfma_f32_16x16x32_bf16 v[112:115], a[64:67], a[28:31], v[112:115]
v_mfma_f32_16x16x32_bf16 v[144:147], a[64:67], a[32:35], v[144:147]
s_add_u32 m0, s18, 0x4000
ds_read_b64_tr_b16 a[64:65], v12 offset:768
v_mfma_f32_16x16x32_bf16 v[148:151], a[68:71], a[32:35], v[148:151]
buffer_load_dwordx4 v7, s[68:71], 0 offen lds
v_mfma_f32_16x16x32_bf16 v[116:119], a[68:71], a[28:31], v[116:119]
ds_read_b64_tr_b16 a[66:67], v12 offset:1792
v_mfma_f32_16x16x32_bf16 v[84:87], a[68:71], a[24:27], v[84:87]
v_mfma_f32_16x16x32_bf16 v[52:55], a[68:71], a[20:23], v[52:55]
ds_read_b64_tr_b16 a[68:69], v13 offset:768
v_mfma_f32_16x16x32_bf16 v[152:155], a[72:75], a[20:23], v[152:155]
ds_read_b64_tr_b16 a[70:71], v13 offset:1792
v_mfma_f32_16x16x32_bf16 v[160:163], a[72:75], a[24:27], v[160:163]
s_add_u32 m0, s18, 0x5000
v_mfma_f32_16x16x32_bf16 v[168:171], a[72:75], a[28:31], v[168:171]
buffer_load_dwordx4 v7, s[68:71], s25 offen lds
v_mfma_f32_16x16x32_bf16 v[176:179], a[72:75], a[32:35], v[176:179]
ds_read_b64_tr_b16 a[72:73], v14 offset:0
v_mfma_f32_16x16x32_bf16 v[180:183], a[76:79], a[32:35], v[180:183]
ds_read_b64_tr_b16 a[74:75], v14 offset:256
v_mfma_f32_16x16x32_bf16 v[172:175], a[76:79], a[28:31], v[172:175]
v_mfma_f32_16x16x32_bf16 v[164:167], a[76:79], a[24:27], v[164:167]
s_add_u32 m0, s18, 0x6000
v_mfma_f32_16x16x32_bf16 v[156:159], a[76:79], a[20:23], v[156:159]
buffer_load_dwordx4 v7, s[68:71], s26 offen lds
v_mfma_f32_16x16x32_bf16 v[184:187], a[80:83], a[20:23], v[184:187]
ds_read_b64_tr_b16 a[76:77], v15 offset:0
v_mfma_f32_16x16x32_bf16 v[192:195], a[80:83], a[24:27], v[192:195]
ds_read_b64_tr_b16 a[78:79], v15 offset:256
v_mfma_f32_16x16x32_bf16 v[200:203], a[80:83], a[28:31], v[200:203]
v_mfma_f32_16x16x32_bf16 v[208:211], a[80:83], a[32:35], v[208:211]
v_mfma_f32_16x16x32_bf16 v[248:251], a[80:83], a[36:39], v[248:251]
s_add_u32 m0, s18, 0x7000
ds_read_b64_tr_b16 a[80:81], v14 offset:4096
v_mfma_f32_16x16x32_bf16 v[212:215], a[104:107], a[32:35], v[212:215]
buffer_load_dwordx4 v4, s[44:47], s24 offen lds
v_mfma_f32_16x16x32_bf16 v[204:207], a[104:107], a[28:31], v[204:207]
ds_read_b64_tr_b16 a[82:83], v14 offset:4352
v_mfma_f32_16x16x32_bf16 v[196:199], a[104:107], a[24:27], v[196:199]
v_mfma_f32_16x16x32_bf16 v[188:191], a[104:107], a[20:23], v[188:191]
v_mfma_f32_16x16x32_bf16 v[216:219], a[20:23], a[108:111], v[216:219]
s_add_u32 s8, s28, 0x1c00
v_mfma_f32_16x16x32_bf16 v[224:227], a[24:27], a[108:111], v[224:227]
buffer_store_dwordx4 a[156:159], v16, s[88:91], s8 offen sc1
v_mfma_f32_16x16x32_bf16 v[232:235], a[28:31], a[108:111], v[232:235]
v_mfma_f32_16x16x32_bf16 v[240:243], a[32:35], a[108:111], v[240:243]
v_mfma_f32_16x16x32_bf16 v[252:255], a[36:39], a[108:111], v[252:255]
v_mfma_f32_16x16x32_bf16 v[244:247], a[32:35], a[112:115], v[244:247]
v_mfma_f32_16x16x32_bf16 v[236:239], a[28:31], a[112:115], v[236:239]
v_mfma_f32_16x16x32_bf16 v[228:231], a[24:27], a[112:115], v[228:231]
v_mfma_f32_16x16x32_bf16 v[220:223], a[20:23], a[112:115], v[220:223]
s_waitcnt lgkmcnt(0)
v_mfma_f32_16x16x32_bf16 v[24:27], a[40:43], a[0:3], v[24:27]
v_add_u32 v5, 0x80000, v5
v_add_u32 v6, 0x80000, v6
ds_read_b128 a[20:23], v9 offset:0
v_mfma_f32_16x16x32_bf16 v[56:59], a[40:43], a[4:7], v[56:59]
v_add_u32 v7, 0x60000, v7
v_add_u32 v4, 0x80, v4
ds_read_b128 a[24:27], v9 offset:2048
v_mfma_f32_16x16x32_bf16 v[88:91], a[40:43], a[8:11], v[88:91]
ds_read_b128 a[28:31], v9 offset:4096
ds_read_b128 a[32:35], v9 offset:6144
v_mfma_f32_16x16x32_bf16 v[120:123], a[40:43], a[12:15], v[120:123]
ds_read_b128 a[36:39], v11
ds_read_b64_tr_b16 a[104:105], v15 offset:6144
v_mfma_f32_16x16x32_bf16 v[124:127], a[44:47], a[12:15], v[124:127]
ds_read_b64_tr_b16 a[106:107], v15 offset:6400
ds_read_b64_tr_b16 a[108:109], v14 offset:10240
v_mfma_f32_16x16x32_bf16 v[92:95], a[44:47], a[8:11], v[92:95]
ds_read_b64_tr_b16 a[110:111], v14 offset:10496
ds_read_b64_tr_b16 a[112:113], v15 offset:10240
v_mfma_f32_16x16x32_bf16 v[60:63], a[44:47], a[4:7], v[60:63]
ds_read_b64_tr_b16 a[114:115], v15 offset:10496
v_mfma_f32_16x16x32_bf16 v[28:31], a[44:47], a[0:3], v[28:31]
ds_read_b64_tr_b16 a[40:41], v12 offset:8192
ds_read_b64_tr_b16 a[42:43], v12 offset:9216
v_mfma_f32_16x16x32_bf16 v[32:35], a[48:51], a[0:3], v[32:35]
ds_read_b64_tr_b16 a[44:45], v13 offset:8192
v_mfma_f32_16x16x32_bf16 v[64:67], a[48:51], a[4:7], v[64:67]
s_add_u32 m0, s16, 0x0
ds_read_b64_tr_b16 a[46:47], v13 offset:9216
s_waitcnt lgkmcnt(11)
v_mfma_f32_16x16x32_bf16 v[96:99], a[48:51], a[8:11], v[96:99]
buffer_load_dwordx4 v22, s[44:47], s20 offen lds
v_mfma_f32_16x16x32_bf16 v[128:131], a[48:51], a[12:15], v[128:131]
ds_read_b64_tr_b16 a[48:49], v12 offset:8448
v_mfma_f32_16x16x32_bf16 v[132:135], a[52:55], a[12:15], v[132:135]
ds_read_b64_tr_b16 a[50:51], v12 offset:9472
v_mfma_f32_16x16x32_bf16 v[100:103], a[52:55], a[8:11], v[100:103]
s_add_u32 m0, s16, 0x400
v_mfma_f32_16x16x32_bf16 v[68:71], a[52:55], a[4:7], v[68:71]
buffer_load_dwordx4 v23, s[44:47], s20 offen lds
v_mfma_f32_16x16x32_bf16 v[36:39], a[52:55], a[0:3], v[36:39]
ds_read_b64_tr_b16 a[52:53], v13 offset:8448
v_mfma_f32_16x16x32_bf16 v[40:43], a[56:59], a[0:3], v[40:43]
ds_read_b64_tr_b16 a[54:55], v13 offset:9472
v_mfma_f32_16x16x32_bf16 v[72:75], a[56:59], a[4:7], v[72:75]
v_mfma_f32_16x16x32_bf16 v[104:107], a[56:59], a[8:11], v[104:107]
s_add_u32 m0, s16, 0x800
v_mfma_f32_16x16x32_bf16 v[136:139], a[56:59], a[12:15], v[136:139]
buffer_load_dwordx4 v22, s[44:47], s21 offen lds
v_mfma_f32_16x16x32_bf16 v[140:143], a[60:63], a[12:15], v[140:143]
ds_read_b64_tr_b16 a[56:57], v12 offset:8704
v_mfma_f32_16x16x32_bf16 v[108:111], a[60:63], a[8:11], v[108:111]
ds_read_b64_tr_b16 a[58:59], v12 offset:9728
v_mfma_f32_16x16x32_bf16 v[76:79], a[60:63], a[4:7], v[76:79]
s_add_u32 m0, s16, 0xc00
v_mfma_f32_16x16x32_bf16 v[44:47], a[60:63], a[0:3], v[44:47]
buffer_load_dwordx4 v23, s[44:47], s21 offen lds
v_mfma_f32_16x16x32_bf16 v[48:51], a[64:67], a[0:3], v[48:51]
ds_read_b64_tr_b16 a[60:61], v13 offset:8704
v_mfma_f32_16x16x32_bf16 v[80:83], a[64:67], a[4:7], v[80:83]
ds_read_b64_tr_b16 a[62:63], v13 offset:9728
v_mfma_f32_16x16x32_bf16 v[112:115], a[64:67], a[8:11], v[112:115]
v_mfma_f32_16x16x32_bf16 v[144:147], a[64:67], a[12:15], v[144:147]
s_add_u32 s8, s28, 0x4000
ds_read_b64_tr_b16 a[64:65], v12 offset:8960
v_mfma_f32_16x16x32_bf16 v[148:151], a[68:71], a[12:15], v[148:151]
buffer_store_dwordx4 a[160:163], v16, s[88:91], s8 offen sc1
v_mfma_f32_16x16x32_bf16 v[116:119], a[68:71], a[8:11], v[116:119]
ds_read_b64_tr_b16 a[66:67], v12 offset:9984
v_mfma_f32_16x16x32_bf16 v[84:87], a[68:71], a[4:7], v[84:87]
v_mfma_f32_16x16x32_bf16 v[52:55], a[68:71], a[0:3], v[52:55]
ds_read_b64_tr_b16 a[68:69], v13 offset:8960
v_mfma_f32_16x16x32_bf16 v[152:155], a[72:75], a[0:3], v[152:155]
s_add_u32 m0, s16, 0x1000
ds_read_b64_tr_b16 a[70:71], v13 offset:9984
v_mfma_f32_16x16x32_bf16 v[160:163], a[72:75], a[4:7], v[160:163]
buffer_load_dwordx4 v22, s[44:47], s22 offen lds
v_mfma_f32_16x16x32_bf16 v[168:171], a[72:75], a[8:11], v[168:171]
v_mfma_f32_16x16x32_bf16 v[176:179], a[72:75], a[12:15], v[176:179]
ds_read_b64_tr_b16 a[72:73], v14 offset:2048
v_mfma_f32_16x16x32_bf16 v[180:183], a[76:79], a[12:15], v[180:183]
s_add_u32 m0, s16, 0x1400
ds_read_b64_tr_b16 a[74:75], v14 offset:2304
v_mfma_f32_16x16x32_bf16 v[172:175], a[76:79], a[8:11], v[172:175]
buffer_load_dwordx4 v23, s[44:47], s22 offen lds
v_mfma_f32_16x16x32_bf16 v[164:167], a[76:79], a[4:7], v[164:167]
v_mfma_f32_16x16x32_bf16 v[156:159], a[76:79], a[0:3], v[156:159]
ds_read_b64_tr_b16 a[76:77], v15 offset:2048
v_mfma_f32_16x16x32_bf16 v[184:187], a[80:83], a[0:3], v[184:187]
ds_read_b64_tr_b16 a[78:79], v15 offset:2304
v_mfma_f32_16x16x32_bf16 v[192:195], a[80:83], a[4:7], v[192:195]
s_add_u32 m0, s16, 0x1800
v_mfma_f32_16x16x32_bf16 v[200:203], a[80:83], a[8:11], v[200:203]
buffer_load_dwordx4 v22, s[44:47], s23 offen lds
v_mfma_f32_16x16x32_bf16 v[208:211], a[80:83], a[12:15], v[208:211]
v_mfma_f32_16x16x32_bf16 v[248:251], a[80:83], a[16:19], v[248:251]
ds_read_b64_tr_b16 a[80:81], v14 offset:6144
v_mfma_f32_16x16x32_bf16 v[212:215], a[84:87], a[12:15], v[212:215]
s_add_u32 m0, s16, 0x1c00
ds_read_b64_tr_b16 a[82:83], v14 offset:6400
v_mfma_f32_16x16x32_bf16 v[204:207], a[84:87], a[8:11], v[204:207]
buffer_load_dwordx4 v23, s[44:47], s23 offen lds
v_mfma_f32_16x16x32_bf16 v[196:199], a[84:87], a[4:7], v[196:199]
v_mfma_f32_16x16x32_bf16 v[188:191], a[84:87], a[0:3], v[188:191]
v_mfma_f32_16x16x32_bf16 v[216:219], a[0:3], a[88:91], v[216:219]
v_mfma_f32_16x16x32_bf16 v[224:227], a[4:7], a[88:91], v[224:227]
s_add_u32 s8, s28, 0x4400
v_mfma_f32_16x16x32_bf16 v[232:235], a[8:11], a[88:91], v[232:235]
buffer_store_dwordx4 a[164:167], v16, s[88:91], s8 offen sc1
v_mfma_f32_16x16x32_bf16 v[240:243], a[12:15], a[88:91], v[240:243]
v_mfma_f32_16x16x32_bf16 v[252:255], a[16:19], a[88:91], v[252:255]
v_mfma_f32_16x16x32_bf16 v[244:247], a[12:15], a[92:95], v[244:247]
v_mfma_f32_16x16x32_bf16 v[236:239], a[8:11], a[92:95], v[236:239]
v_add_u32 v12, 0x8000, v12
v_add_u32 v13, 0x8000, v13
v_mfma_f32_16x16x32_bf16 v[228:231], a[4:7], a[92:95], v[228:231]
v_add_u32 v14, 0x8000, v14
v_add_u32 v15, 0x8000, v15
v_mfma_f32_16x16x32_bf16 v[220:223], a[0:3], a[92:95], v[220:223]
v_add_u32 v10, 0x8000, v10
v_add_u32 v11, 0x8000, v11
s_waitcnt vmcnt(21) lgkmcnt(0)
s_barrier
v_mfma_f32_16x16x32_bf16 v[24:27], a[40:43], a[20:23], v[24:27]
s_add_u32 m0, s17, 0x8000
v_add_u32 v22, 0x80, v22
v_add_u32 v23, 0x80, v23
ds_read_b128 a[0:3], v8 offset:32768
v_mfma_f32_16x16x32_bf16 v[56:59], a[40:43], a[24:27], v[56:59]
buffer_load_dwordx4 v5, s[52:55], 0 offen lds
v_mfma_f32_16x16x32_bf16 v[88:91], a[40:43], a[28:31], v[88:91]
ds_read_b128 a[4:7], v8 offset:34816
ds_read_b128 a[8:11], v8 offset:36864
v_mfma_f32_16x16x32_bf16 v[120:123], a[40:43], a[32:35], v[120:123]
ds_read_b128 a[12:15], v8 offset:38912
ds_read_b128 a[16:19], v10
v_mfma_f32_16x16x32_bf16 v[124:127], a[44:47], a[32:35], v[124:127]
ds_read_b64_tr_b16 a[84:85], v15 offset:4096
ds_read_b64_tr_b16 a[86:87], v15 offset:4352
v_mfma_f32_16x16x32_bf16 v[92:95], a[44:47], a[28:31], v[92:95]
s_add_u32 m0, s17, 0x8400
ds_read_b64_tr_b16 a[88:89], v14 offset:8192
ds_read_b64_tr_b16 a[90:91], v14 offset:8448
v_mfma_f32_16x16x32_bf16 v[60:63], a[44:47], a[24:27], v[60:63]
buffer_load_dwordx4 v5, s[52:55], s13 offen lds
v_mfma_f32_16x16x32_bf16 v[28:31], a[44:47], a[20:23], v[28:31]
ds_read_b64_tr_b16 a[92:93], v15 offset:8192
ds_read_b64_tr_b16 a[94:95], v15 offset:8448
v_mfma_f32_16x16x32_bf16 v[32:35], a[48:51], a[20:23], v[32:35]
ds_read_b64_tr_b16 a[40:41], v12 offset:0
ds_read_b64_tr_b16 a[42:43], v12 offset:1024
v_mfma_f32_16x16x32_bf16 v[64:67], a[48:51], a[24:27], v[64:67]
ds_read_b64_tr_b16 a[44:45], v13 offset:0
v_mfma_f32_16x16x32_bf16 v[96:99], a[48:51], a[28:31], v[96:99]
ds_read_b64_tr_b16 a[46:47], v13 offset:1024
v_mfma_f32_16x16x32_bf16 v[128:131], a[48:51], a[32:35], v[128:131]
s_add_u32 m0, s17, 0x8800
ds_read_b64_tr_b16 a[48:49], v12 offset:256
v_mfma_f32_16x16x32_bf16 v[132:135], a[52:55], a[32:35], v[132:135]
buffer_load_dwordx4 v6, s[52:55], 0 offen lds
v_mfma_f32_16x16x32_bf16 v[100:103], a[52:55], a[28:31], v[100:103]
ds_read_b64_tr_b16 a[50:51], v12 offset:1280
v_mfma_f32_16x16x32_bf16 v[68:71], a[52:55], a[24:27], v[68:71]
v_mfma_f32_16x16x32_bf16 v[36:39], a[52:55], a[20:23], v[36:39]
ds_read_b64_tr_b16 a[52:53], v13 offset:256
v_mfma_f32_16x16x32_bf16 v[40:43], a[56:59], a[20:23], v[40:43]
s_add_u32 m0, s17, 0x8c00
ds_read_b64_tr_b16 a[54:55], v13 offset:1280
v_mfma_f32_16x16x32_bf16 v[72:75], a[56:59], a[24:27], v[72:75]
buffer_load_dwordx4 v6, s[52:55], s13 offen lds
v_mfma_f32_16x16x32_bf16 v[104:107], a[56:59], a[28:31], v[104:107]
v_mfma_f32_16x16x32_bf16 v[136:139], a[56:59], a[32:35], v[136:139]
ds_read_b64_tr_b16 a[56:57], v12 offset:512
v_mfma_f32_16x16x32_bf16 v[140:143], a[60:63], a[32:35], v[140:143]
ds_read_b64_tr_b16 a[58:59], v12 offset:1536
v_mfma_f32_16x16x32_bf16 v[108:111], a[60:63], a[28:31], v[108:111]
v_mfma_f32_16x16x32_bf16 v[76:79], a[60:63], a[24:27], v[76:79]
s_add_u32 s8, s28, 0x4800
v_mfma_f32_16x16x32_bf16 v[44:47], a[60:63], a[20:23], v[44:47]
buffer_store_dwordx4 a[168:171], v16, s[88:91], s8 offen sc1
v_mfma_f32_16x16x32_bf16 v[48:51], a[64:67], a[20:23], v[48:51]
ds_read_b64_tr_b16 a[60:61], v13 offset:512
v_mfma_f32_16x16x32_bf16 v[80:83], a[64:67], a[24:27], v[80:83]
ds_read_b64_tr_b16 a[62:63], v13 offset:1536
v_mfma_f32_16x16x32_bf16 v[112:115], a[64:67], a[28:31], v[112:115]
v_mfma_f32_16x16x32_bf16 v[144:147], a[64:67], a[32:35], v[144:147]
s_add_u32 m0, s18, 0xc000
ds_read_b64_tr_b16 a[64:65], v12 offset:768
v_mfma_f32_16x16x32_bf16 v[148:151], a[68:71], a[32:35], v[148:151]
buffer_load_dwordx4 v7, s[68:71], 0 offen lds
v_mfma_f32_16x16x32_bf16 v[116:119], a[68:71], a[28:31], v[116:119]
ds_read_b64_tr_b16 a[66:67], v12 offset:1792
v_mfma_f32_16x16x32_bf16 v[84:87], a[68:71], a[24:27], v[84:87]
v_mfma_f32_16x16x32_bf16 v[52:55], a[68:71], a[20:23], v[52:55]
ds_read_b64_tr_b16 a[68:69], v13 offset:768
v_mfma_f32_16x16x32_bf16 v[152:155], a[72:75], a[20:23], v[152:155]
ds_read_b64_tr_b16 a[70:71], v13 offset:1792
v_mfma_f32_16x16x32_bf16 v[160:163], a[72:75], a[24:27], v[160:163]
s_add_u32 m0, s18, 0xd000
v_mfma_f32_16x16x32_bf16 v[168:171], a[72:75], a[28:31], v[168:171]
buffer_load_dwordx4 v7, s[68:71], s25 offen lds
v_mfma_f32_16x16x32_bf16 v[176:179], a[72:75], a[32:35], v[176:179]
ds_read_b64_tr_b16 a[72:73], v14 offset:0
v_mfma_f32_16x16x32_bf16 v[180:183], a[76:79], a[32:35], v[180:183]
ds_read_b64_tr_b16 a[74:75], v14 offset:256
v_mfma_f32_16x16x32_bf16 v[172:175], a[76:79], a[28:31], v[172:175]
v_mfma_f32_16x16x32_bf16 v[164:167], a[76:79], a[24:27], v[164:167]
s_add_u32 m0, s18, 0xe000
v_mfma_f32_16x16x32_bf16 v[156:159], a[76:79], a[20:23], v[156:159]
buffer_load_dwordx4 v7, s[68:71], s26 offen lds
v_mfma_f32_16x16x32_bf16 v[184:187], a[80:83], a[20:23], v[184:187]
ds_read_b64_tr_b16 a[76:77], v15 offset:0
v_mfma_f32_16x16x32_bf16 v[192:195], a[80:83], a[24:27], v[192:195]
ds_read_b64_tr_b16 a[78:79], v15 offset:256
v_mfma_f32_16x16x32_bf16 v[200:203], a[80:83], a[28:31], v[200:203]
v_mfma_f32_16x16x32_bf16 v[208:211], a[80:83], a[32:35], v[208:211]
v_mfma_f32_16x16x32_bf16 v[248:251], a[80:83], a[36:39], v[248:251]
s_add_u32 m0, s18, 0xf000
ds_read_b64_tr_b16 a[80:81], v14 offset:4096
v_mfma_f32_16x16x32_bf16 v[212:215], a[104:107], a[32:35], v[212:215]
buffer_load_dwordx4 v4, s[44:47], s24 offen lds
v_mfma_f32_16x16x32_bf16 v[204:207], a[104:107], a[28:31], v[204:207]
ds_read_b64_tr_b16 a[82:83], v14 offset:4352
v_mfma_f32_16x16x32_bf16 v[196:199], a[104:107], a[24:27], v[196:199]
v_mfma_f32_16x16x32_bf16 v[188:191], a[104:107], a[20:23], v[188:191]
v_mfma_f32_16x16x32_bf16 v[216:219], a[20:23], a[108:111], v[216:219]
s_add_u32 s8, s28, 0x4c00
v_mfma_f32_16x16x32_bf16 v[224:227], a[24:27], a[108:111], v[224:227]
buffer_store_dwordx4 a[172:175], v16, s[88:91], s8 offen sc1
v_mfma_f32_16x16x32_bf16 v[232:235], a[28:31], a[108:111], v[232:235]
v_mfma_f32_16x16x32_bf16 v[240:243], a[32:35], a[108:111], v[240:243]
v_mfma_f32_16x16x32_bf16 v[252:255], a[36:39], a[108:111], v[252:255]
v_mfma_f32_16x16x32_bf16 v[244:247], a[32:35], a[112:115], v[244:247]
v_mfma_f32_16x16x32_bf16 v[236:239], a[28:31], a[112:115], v[236:239]
v_mfma_f32_16x16x32_bf16 v[228:231], a[24:27], a[112:115], v[228:231]
v_mfma_f32_16x16x32_bf16 v[220:223], a[20:23], a[112:115], v[220:223]
s_waitcnt lgkmcnt(0)
v_mfma_f32_16x16x32_bf16 v[24:27], a[40:43], a[0:3], v[24:27]
v_add_u32 v5, 0x80000, v5
v_add_u32 v6, 0x80000, v6
ds_read_b128 a[20:23], v9 offset:32768
v_mfma_f32_16x16x32_bf16 v[56:59], a[40:43], a[4:7], v[56:59]
v_add_u32 v7, 0x60000, v7
v_add_u32 v4, 0x80, v4
ds_read_b128 a[24:27], v9 offset:34816
v_mfma_f32_16x16x32_bf16 v[88:91], a[40:43], a[8:11], v[88:91]
ds_read_b128 a[28:31], v9 offset:36864
ds_read_b128 a[32:35], v9 offset:38912
v_mfma_f32_16x16x32_bf16 v[120:123], a[40:43], a[12:15], v[120:123]
ds_read_b128 a[36:39], v11
ds_read_b64_tr_b16 a[104:105], v15 offset:6144
v_mfma_f32_16x16x32_bf16 v[124:127], a[44:47], a[12:15], v[124:127]
ds_read_b64_tr_b16 a[106:107], v15 offset:6400
ds_read_b64_tr_b16 a[108:109], v14 offset:10240
v_mfma_f32_16x16x32_bf16 v[92:95], a[44:47], a[8:11], v[92:95]
ds_read_b64_tr_b16 a[110:111], v14 offset:10496
ds_read_b64_tr_b16 a[112:113], v15 offset:10240
v_mfma_f32_16x16x32_bf16 v[60:63], a[44:47], a[4:7], v[60:63]
ds_read_b64_tr_b16 a[114:115], v15 offset:10496
v_mfma_f32_16x16x32_bf16 v[28:31], a[44:47], a[0:3], v[28:31]
ds_read_b64_tr_b16 a[40:41], v12 offset:8192
ds_read_b64_tr_b16 a[42:43], v12 offset:9216
v_mfma_f32_16x16x32_bf16 v[32:35], a[48:51], a[0:3], v[32:35]
ds_read_b64_tr_b16 a[44:45], v13 offset:8192
v_mfma_f32_16x16x32_bf16 v[64:67], a[48:51], a[4:7], v[64:67]
s_add_u32 m0, s16, 0x8000
ds_read_b64_tr_b16 a[46:47], v13 offset:9216
s_waitcnt lgkmcnt(11)
v_mfma_f32_16x16x32_bf16 v[96:99], a[48:51], a[8:11], v[96:99]
buffer_load_dwordx4 v22, s[44:47], s20 offen lds
v_mfma_f32_16x16x32_bf16 v[128:131], a[48:51], a[12:15], v[128:131]
ds_read_b64_tr_b16 a[48:49], v12 offset:8448
v_mfma_f32_16x16x32_bf16 v[132:135], a[52:55], a[12:15], v[132:135]
ds_read_b64_tr_b16 a[50:51], v12 offset:9472
v_mfma_f32_16x16x32_bf16 v[100:103], a[52:55], a[8:11], v[100:103]
s_add_u32 m0, s16, 0x8400
v_mfma_f32_16x16x32_bf16 v[68:71], a[52:55], a[4:7], v[68:71]
buffer_load_dwordx4 v23, s[44:47], s20 offen lds
v_mfma_f32_16x16x32_bf16 v[36:39], a[52:55], a[0:3], v[36:39]
ds_read_b64_tr_b16 a[52:53], v13 offset:8448
v_mfma_f32_16x16x32_bf16 v[40:43], a[56:59], a[0:3], v[40:43]
ds_read_b64_tr_b16 a[54:55], v13 offset:9472
v_mfma_f32_16x16x32_bf16 v[72:75], a[56:59], a[4:7], v[72:75]
v_mfma_f32_16x16x32_bf16 v[104:107], a[56:59], a[8:11], v[104:107]
s_add_u32 m0, s16, 0x8800
v_mfma_f32_16x16x32_bf16 v[136:139], a[56:59], a[12:15], v[136:139]
buffer_load_dwordx4 v22, s[44:47], s21 offen lds
v_mfma_f32_16x16x32_bf16 v[140:143], a[60:63], a[12:15], v[140:143]
ds_read_b64_tr_b16 a[56:57], v12 offset:8704
v_mfma_f32_16x16x32_bf16 v[108:111], a[60:63], a[8:11], v[108:111]
ds_read_b64_tr_b16 a[58:59], v12 offset:9728
v_mfma_f32_16x16x32_bf16 v[76:79], a[60:63], a[4:7], v[76:79]
s_add_u32 m0, s16, 0x8c00
v_mfma_f32_16x16x32_bf16 v[44:47], a[60:63], a[0:3], v[44:47]
buffer_load_dwordx4 v23, s[44:47], s21 offen lds
v_mfma_f32_16x16x32_bf16 v[48:51], a[64:67], a[0:3], v[48:51]
ds_read_b64_tr_b16 a[60:61], v13 offset:8704
v_mfma_f32_16x16x32_bf16 v[80:83], a[64:67], a[4:7], v[80:83]
ds_read_b64_tr_b16 a[62:63], v13 offset:9728
v_mfma_f32_16x16x32_bf16 v[112:115], a[64:67], a[8:11], v[112:115]
v_mfma_f32_16x16x32_bf16 v[144:147], a[64:67], a[12:15], v[144:147]
s_add_u32 s8, s28, 0x5000
ds_read_b64_tr_b16 a[64:65], v12 offset:8960
v_mfma_f32_16x16x32_bf16 v[148:151], a[68:71], a[12:15], v[148:151]
buffer_store_dwordx4 a[176:179], v16, s[88:91], s8 offen sc1
v_mfma_f32_16x16x32_bf16 v[116:119], a[68:71], a[8:11], v[116:119]
ds_read_b64_tr_b16 a[66:67], v12 offset:9984
v_mfma_f32_16x16x32_bf16 v[84:87], a[68:71], a[4:7], v[84:87]
v_mfma_f32_16x16x32_bf16 v[52:55], a[68:71], a[0:3], v[52:55]
ds_read_b64_tr_b16 a[68:69], v13 offset:8960
v_mfma_f32_16x16x32_bf16 v[152:155], a[72:75], a[0:3], v[152:155]
s_add_u32 m0, s16, 0x9000
ds_read_b64_tr_b16 a[70:71], v13 offset:9984
v_mfma_f32_16x16x32_bf16 v[160:163], a[72:75], a[4:7], v[160:163]
buffer_load_dwordx4 v22, s[44:47], s22 offen lds
v_mfma_f32_16x16x32_bf16 v[168:171], a[72:75], a[8:11], v[168:171]
v_mfma_f32_16x16x32_bf16 v[176:179], a[72:75], a[12:15], v[176:179]
ds_read_b64_tr_b16 a[72:73], v14 offset:2048
v_mfma_f32_16x16x32_bf16 v[180:183], a[76:79], a[12:15], v[180:183]
s_add_u32 m0, s16, 0x9400
ds_read_b64_tr_b16 a[74:75], v14 offset:2304
v_mfma_f32_16x16x32_bf16 v[172:175], a[76:79], a[8:11], v[172:175]
buffer_load_dwordx4 v23, s[44:47], s22 offen lds
v_mfma_f32_16x16x32_bf16 v[164:167], a[76:79], a[4:7], v[164:167]
v_mfma_f32_16x16x32_bf16 v[156:159], a[76:79], a[0:3], v[156:159]
ds_read_b64_tr_b16 a[76:77], v15 offset:2048
v_mfma_f32_16x16x32_bf16 v[184:187], a[80:83], a[0:3], v[184:187]
ds_read_b64_tr_b16 a[78:79], v15 offset:2304
v_mfma_f32_16x16x32_bf16 v[192:195], a[80:83], a[4:7], v[192:195]
s_add_u32 m0, s16, 0x9800
v_mfma_f32_16x16x32_bf16 v[200:203], a[80:83], a[8:11], v[200:203]
buffer_load_dwordx4 v22, s[44:47], s23 offen lds
v_mfma_f32_16x16x32_bf16 v[208:211], a[80:83], a[12:15], v[208:211]
v_mfma_f32_16x16x32_bf16 v[248:251], a[80:83], a[16:19], v[248:251]
ds_read_b64_tr_b16 a[80:81], v14 offset:6144
v_mfma_f32_16x16x32_bf16 v[212:215], a[84:87], a[12:15], v[212:215]
s_add_u32 m0, s16, 0x9c00
ds_read_b64_tr_b16 a[82:83], v14 offset:6400
v_mfma_f32_16x16x32_bf16 v[204:207], a[84:87], a[8:11], v[204:207]
buffer_load_dwordx4 v23, s[44:47], s23 offen lds
v_mfma_f32_16x16x32_bf16 v[196:199], a[84:87], a[4:7], v[196:199]
v_mfma_f32_16x16x32_bf16 v[188:191], a[84:87], a[0:3], v[188:191]
v_mfma_f32_16x16x32_bf16 v[216:219], a[0:3], a[88:91], v[216:219]
v_mfma_f32_16x16x32_bf16 v[224:227], a[4:7], a[88:91], v[224:227]
s_add_u32 s8, s28, 0x5400
v_mfma_f32_16x16x32_bf16 v[232:235], a[8:11], a[88:91], v[232:235]
buffer_store_dwordx4 a[180:183], v16, s[88:91], s8 offen sc1
v_mfma_f32_16x16x32_bf16 v[240:243], a[12:15], a[88:91], v[240:243]
v_mfma_f32_16x16x32_bf16 v[252:255], a[16:19], a[88:91], v[252:255]
v_mfma_f32_16x16x32_bf16 v[244:247], a[12:15], a[92:95], v[244:247]
v_mfma_f32_16x16x32_bf16 v[236:239], a[8:11], a[92:95], v[236:239]
v_add_u32 v12, 0xffff0000, v12
v_add_u32 v13, 0xffff0000, v13
v_mfma_f32_16x16x32_bf16 v[228:231], a[4:7], a[92:95], v[228:231]
v_add_u32 v14, 0xffff0000, v14
v_add_u32 v15, 0xffff0000, v15
v_mfma_f32_16x16x32_bf16 v[220:223], a[0:3], a[92:95], v[220:223]
v_add_u32 v10, 0xffff0000, v10
v_add_u32 v11, 0xffff0000, v11
s_waitcnt vmcnt(21) lgkmcnt(0)
s_barrier
v_mfma_f32_16x16x32_bf16 v[24:27], a[40:43], a[20:23], v[24:27]
s_add_u32 m0, s17, 0x10000
v_add_u32 v22, 0x80, v22
v_add_u32 v23, 0x80, v23
ds_read_b128 a[0:3], v8 offset:0
v_mfma_f32_16x16x32_bf16 v[56:59], a[40:43], a[24:27], v[56:59]
buffer_load_dwordx4 v5, s[52:55], 0 offen lds
v_mfma_f32_16x16x32_bf16 v[88:91], a[40:43], a[28:31], v[88:91]
ds_read_b128 a[4:7], v8 offset:2048
ds_read_b128 a[8:11], v8 offset:4096
v_mfma_f32_16x16x32_bf16 v[120:123], a[40:43], a[32:35], v[120:123]
ds_read_b128 a[12:15], v8 offset:6144
ds_read_b128 a[16:19], v10
v_mfma_f32_16x16x32_bf16 v[124:127], a[44:47], a[32:35], v[124:127]
ds_read_b64_tr_b16 a[84:85], v15 offset:4096
ds_read_b64_tr_b16 a[86:87], v15 offset:4352
v_mfma_f32_16x16x32_bf16 v[92:95], a[44:47], a[28:31], v[92:95]
s_add_u32 m0, s17, 0x10400
ds_read_b64_tr_b16 a[88:89], v14 offset:8192
ds_read_b64_tr_b16 a[90:91], v14 offset:8448
v_mfma_f32_16x16x32_bf16 v[60:63], a[44:47], a[24:27], v[60:63]
buffer_load_dwordx4 v5, s[52:55], s13 offen lds
v_mfma_f32_16x16x32_bf16 v[28:31], a[44:47], a[20:23], v[28:31]
ds_read_b64_tr_b16 a[92:93], v15 offset:8192
ds_read_b64_tr_b16 a[94:95], v15 offset:8448
v_mfma_f32_16x16x32_bf16 v[32:35], a[48:51], a[20:23], v[32:35]
ds_read_b64_tr_b16 a[40:41], v12 offset:0
ds_read_b64_tr_b16 a[42:43], v12 offset:1024
v_mfma_f32_16x16x32_bf16 v[64:67], a[48:51], a[24:27], v[64:67]
ds_read_b64_tr_b16 a[44:45], v13 offset:0
v_mfma_f32_16x16x32_bf16 v[96:99], a[48:51], a[28:31], v[96:99]
ds_read_b64_tr_b16 a[46:47], v13 offset:1024
v_mfma_f32_16x16x32_bf16 v[128:131], a[48:51], a[32:35], v[128:131]
s_add_u32 m0, s17, 0x10800
ds_read_b64_tr_b16 a[48:49], v12 offset:256
v_mfma_f32_16x16x32_bf16 v[132:135], a[52:55], a[32:35], v[132:135]
buffer_load_dwordx4 v6, s[52:55], 0 offen lds
v_mfma_f32_16x16x32_bf16 v[100:103], a[52:55], a[28:31], v[100:103]
ds_read_b64_tr_b16 a[50:51], v12 offset:1280
v_mfma_f32_16x16x32_bf16 v[68:71], a[52:55], a[24:27], v[68:71]
v_mfma_f32_16x16x32_bf16 v[36:39], a[52:55], a[20:23], v[36:39]
ds_read_b64_tr_b16 a[52:53], v13 offset:256
v_mfma_f32_16x16x32_bf16 v[40:43], a[56:59], a[20:23], v[40:43]
s_add_u32 m0, s17, 0x10c00
ds_read_b64_tr_b16 a[54:55], v13 offset:1280
v_mfma_f32_16x16x32_bf16 v[72:75], a[56:59], a[24:27], v[72:75]
buffer_load_dwordx4 v6, s[52:55], s13 offen lds
v_mfma_f32_16x16x32_bf16 v[104:107], a[56:59], a[28:31], v[104:107]
v_mfma_f32_16x16x32_bf16 v[136:139], a[56:59], a[32:35], v[136:139]
ds_read_b64_tr_b16 a[56:57], v12 offset:512
v_mfma_f32_16x16x32_bf16 v[140:143], a[60:63], a[32:35], v[140:143]
ds_read_b64_tr_b16 a[58:59], v12 offset:1536
v_mfma_f32_16x16x32_bf16 v[108:111], a[60:63], a[28:31], v[108:111]
v_mfma_f32_16x16x32_bf16 v[76:79], a[60:63], a[24:27], v[76:79]
s_add_u32 s8, s28, 0x5800
v_mfma_f32_16x16x32_bf16 v[44:47], a[60:63], a[20:23], v[44:47]
buffer_store_dwordx4 a[184:187], v16, s[88:91], s8 offen sc1
v_mfma_f32_16x16x32_bf16 v[48:51], a[64:67], a[20:23], v[48:51]
ds_read_b64_tr_b16 a[60:61], v13 offset:512
v_mfma_f32_16x16x32_bf16 v[80:83], a[64:67], a[24:27], v[80:83]
ds_read_b64_tr_b16 a[62:63], v13 offset:1536
v_mfma_f32_16x16x32_bf16 v[112:115], a[64:67], a[28:31], v[112:115]
v_mfma_f32_16x16x32_bf16 v[144:147], a[64:67], a[32:35], v[144:147]
s_add_u32 m0, s18, 0x14000
ds_read_b64_tr_b16 a[64:65], v12 offset:768
v_mfma_f32_16x16x32_bf16 v[148:151], a[68:71], a[32:35], v[148:151]
buffer_load_dwordx4 v7, s[68:71], 0 offen lds
v_mfma_f32_16x16x32_bf16 v[116:119], a[68:71], a[28:31], v[116:119]
ds_read_b64_tr_b16 a[66:67], v12 offset:1792
v_mfma_f32_16x16x32_bf16 v[84:87], a[68:71], a[24:27], v[84:87]
v_mfma_f32_16x16x32_bf16 v[52:55], a[68:71], a[20:23], v[52:55]
ds_read_b64_tr_b16 a[68:69], v13 offset:768
v_mfma_f32_16x16x32_bf16 v[152:155], a[72:75], a[20:23], v[152:155]
ds_read_b64_tr_b16 a[70:71], v13 offset:1792
v_mfma_f32_16x16x32_bf16 v[160:163], a[72:75], a[24:27], v[160:163]
s_add_u32 m0, s18, 0x15000
v_mfma_f32_16x16x32_bf16 v[168:171], a[72:75], a[28:31], v[168:171]
buffer_load_dwordx4 v7, s[68:71], s25 offen lds
v_mfma_f32_16x16x32_bf16 v[176:179], a[72:75], a[32:35], v[176:179]
ds_read_b64_tr_b16 a[72:73], v14 offset:0
v_mfma_f32_16x16x32_bf16 v[180:183], a[76:79], a[32:35], v[180:183]
ds_read_b64_tr_b16 a[74:75], v14 offset:256
v_mfma_f32_16x16x32_bf16 v[172:175], a[76:79], a[28:31], v[172:175]
v_mfma_f32_16x16x32_bf16 v[164:167], a[76:79], a[24:27], v[164:167]
s_add_u32 m0, s18, 0x16000
v_mfma_f32_16x16x32_bf16 v[156:159], a[76:79], a[20:23], v[156:159]
buffer_load_dwordx4 v7, s[68:71], s26 offen lds
v_mfma_f32_16x16x32_bf16 v[184:187], a[80:83], a[20:23], v[184:187]
ds_read_b64_tr_b16 a[76:77], v15 offset:0
v_mfma_f32_16x16x32_bf16 v[192:195], a[80:83], a[24:27], v[192:195]
ds_read_b64_tr_b16 a[78:79], v15 offset:256
v_mfma_f32_16x16x32_bf16 v[200:203], a[80:83], a[28:31], v[200:203]
v_mfma_f32_16x16x32_bf16 v[208:211], a[80:83], a[32:35], v[208:211]
v_mfma_f32_16x16x32_bf16 v[248:251], a[80:83], a[36:39], v[248:251]
s_add_u32 m0, s18, 0x17000
ds_read_b64_tr_b16 a[80:81], v14 offset:4096
v_mfma_f32_16x16x32_bf16 v[212:215], a[104:107], a[32:35], v[212:215]
buffer_load_dwordx4 v4, s[44:47], s24 offen lds
v_mfma_f32_16x16x32_bf16 v[204:207], a[104:107], a[28:31], v[204:207]
ds_read_b64_tr_b16 a[82:83], v14 offset:4352
v_mfma_f32_16x16x32_bf16 v[196:199], a[104:107], a[24:27], v[196:199]
v_mfma_f32_16x16x32_bf16 v[188:191], a[104:107], a[20:23], v[188:191]
v_mfma_f32_16x16x32_bf16 v[216:219], a[20:23], a[108:111], v[216:219]
s_add_u32 s8, s28, 0x5c00
v_mfma_f32_16x16x32_bf16 v[224:227], a[24:27], a[108:111], v[224:227]
buffer_store_dwordx4 a[188:191], v16, s[88:91], s8 offen sc1
v_mfma_f32_16x16x32_bf16 v[232:235], a[28:31], a[108:111], v[232:235]
v_mfma_f32_16x16x32_bf16 v[240:243], a[32:35], a[108:111], v[240:243]
v_mfma_f32_16x16x32_bf16 v[252:255], a[36:39], a[108:111], v[252:255]
v_mfma_f32_16x16x32_bf16 v[244:247], a[32:35], a[112:115], v[244:247]
v_mfma_f32_16x16x32_bf16 v[236:239], a[28:31], a[112:115], v[236:239]
v_mfma_f32_16x16x32_bf16 v[228:231], a[24:27], a[112:115], v[228:231]
v_mfma_f32_16x16x32_bf16 v[220:223], a[20:23], a[112:115], v[220:223]
s_waitcnt lgkmcnt(0)
v_mfma_f32_16x16x32_bf16 v[24:27], a[40:43], a[0:3], v[24:27]
v_add_u32 v5, 0x80000, v5
v_add_u32 v6, 0x80000, v6
ds_read_b128 a[20:23], v9 offset:0
v_mfma_f32_16x16x32_bf16 v[56:59], a[40:43], a[4:7], v[56:59]
v_add_u32 v7, 0x60000, v7
v_add_u32 v4, 0x80, v4
ds_read_b128 a[24:27], v9 offset:2048
v_mfma_f32_16x16x32_bf16 v[88:91], a[40:43], a[8:11], v[88:91]
ds_read_b128 a[28:31], v9 offset:4096
ds_read_b128 a[32:35], v9 offset:6144
v_mfma_f32_16x16x32_bf16 v[120:123], a[40:43], a[12:15], v[120:123]
ds_read_b128 a[36:39], v11
ds_read_b64_tr_b16 a[104:105], v15 offset:6144
v_mfma_f32_16x16x32_bf16 v[124:127], a[44:47], a[12:15], v[124:127]
ds_read_b64_tr_b16 a[106:107], v15 offset:6400
ds_read_b64_tr_b16 a[108:109], v14 offset:10240
v_mfma_f32_16x16x32_bf16 v[92:95], a[44:47], a[8:11], v[92:95]
ds_read_b64_tr_b16 a[110:111], v14 offset:10496
ds_read_b64_tr_b16 a[112:113], v15 offset:10240
v_mfma_f32_16x16x32_bf16 v[60:63], a[44:47], a[4:7], v[60:63]
ds_read_b64_tr_b16 a[114:115], v15 offset:10496
v_mfma_f32_16x16x32_bf16 v[28:31], a[44:47], a[0:3], v[28:31]
ds_read_b64_tr_b16 a[40:41], v12 offset:8192
ds_read_b64_tr_b16 a[42:43], v12 offset:9216
v_mfma_f32_16x16x32_bf16 v[32:35], a[48:51], a[0:3], v[32:35]
ds_read_b64_tr_b16 a[44:45], v13 offset:8192
v_mfma_f32_16x16x32_bf16 v[64:67], a[48:51], a[4:7], v[64:67]
s_add_u32 m0, s16, 0x0
ds_read_b64_tr_b16 a[46:47], v13 offset:9216
s_waitcnt lgkmcnt(11)
v_mfma_f32_16x16x32_bf16 v[96:99], a[48:51], a[8:11], v[96:99]
buffer_load_dwordx4 v22, s[44:47], s20 offen lds
v_mfma_f32_16x16x32_bf16 v[128:131], a[48:51], a[12:15], v[128:131]
ds_read_b64_tr_b16 a[48:49], v12 offset:8448
v_mfma_f32_16x16x32_bf16 v[132:135], a[52:55], a[12:15], v[132:135]
ds_read_b64_tr_b16 a[50:51], v12 offset:9472
v_mfma_f32_16x16x32_bf16 v[100:103], a[52:55], a[8:11], v[100:103]
s_add_u32 m0, s16, 0x400
v_mfma_f32_16x16x32_bf16 v[68:71], a[52:55], a[4:7], v[68:71]
buffer_load_dwordx4 v23, s[44:47], s20 offen lds
v_mfma_f32_16x16x32_bf16 v[36:39], a[52:55], a[0:3], v[36:39]
ds_read_b64_tr_b16 a[52:53], v13 offset:8448
v_mfma_f32_16x16x32_bf16 v[40:43], a[56:59], a[0:3], v[40:43]
ds_read_b64_tr_b16 a[54:55], v13 offset:9472
v_mfma_f32_16x16x32_bf16 v[72:75], a[56:59], a[4:7], v[72:75]
v_mfma_f32_16x16x32_bf16 v[104:107], a[56:59], a[8:11], v[104:107]
s_add_u32 m0, s16, 0x800
v_mfma_f32_16x16x32_bf16 v[136:139], a[56:59], a[12:15], v[136:139]
buffer_load_dwordx4 v22, s[44:47], s21 offen lds
v_mfma_f32_16x16x32_bf16 v[140:143], a[60:63], a[12:15], v[140:143]
ds_read_b64_tr_b16 a[56:57], v12 offset:8704
v_mfma_f32_16x16x32_bf16 v[108:111], a[60:63], a[8:11], v[108:111]
ds_read_b64_tr_b16 a[58:59], v12 offset:9728
v_mfma_f32_16x16x32_bf16 v[76:79], a[60:63], a[4:7], v[76:79]
s_add_u32 m0, s16, 0xc00
v_mfma_f32_16x16x32_bf16 v[44:47], a[60:63], a[0:3], v[44:47]
buffer_load_dwordx4 v23, s[44:47], s21 offen lds
v_mfma_f32_16x16x32_bf16 v[48:51], a[64:67], a[0:3], v[48:51]
ds_read_b64_tr_b16 a[60:61], v13 offset:8704
v_mfma_f32_16x16x32_bf16 v[80:83], a[64:67], a[4:7], v[80:83]
ds_read_b64_tr_b16 a[62:63], v13 offset:9728
v_mfma_f32_16x16x32_bf16 v[112:115], a[64:67], a[8:11], v[112:115]
v_mfma_f32_16x16x32_bf16 v[144:147], a[64:67], a[12:15], v[144:147]
s_add_u32 s8, s28, 0x6000
ds_read_b64_tr_b16 a[64:65], v12 offset:8960
v_mfma_f32_16x16x32_bf16 v[148:151], a[68:71], a[12:15], v[148:151]
buffer_store_dwordx4 a[192:195], v16, s[88:91], s8 offen sc1
v_mfma_f32_16x16x32_bf16 v[116:119], a[68:71], a[8:11], v[116:119]
ds_read_b64_tr_b16 a[66:67], v12 offset:9984
v_mfma_f32_16x16x32_bf16 v[84:87], a[68:71], a[4:7], v[84:87]
v_mfma_f32_16x16x32_bf16 v[52:55], a[68:71], a[0:3], v[52:55]
ds_read_b64_tr_b16 a[68:69], v13 offset:8960
v_mfma_f32_16x16x32_bf16 v[152:155], a[72:75], a[0:3], v[152:155]
s_add_u32 m0, s16, 0x1000
ds_read_b64_tr_b16 a[70:71], v13 offset:9984
v_mfma_f32_16x16x32_bf16 v[160:163], a[72:75], a[4:7], v[160:163]
buffer_load_dwordx4 v22, s[44:47], s22 offen lds
v_mfma_f32_16x16x32_bf16 v[168:171], a[72:75], a[8:11], v[168:171]
v_mfma_f32_16x16x32_bf16 v[176:179], a[72:75], a[12:15], v[176:179]
ds_read_b64_tr_b16 a[72:73], v14 offset:2048
v_mfma_f32_16x16x32_bf16 v[180:183], a[76:79], a[12:15], v[180:183]
s_add_u32 m0, s16, 0x1400
ds_read_b64_tr_b16 a[74:75], v14 offset:2304
v_mfma_f32_16x16x32_bf16 v[172:175], a[76:79], a[8:11], v[172:175]
buffer_load_dwordx4 v23, s[44:47], s22 offen lds
v_mfma_f32_16x16x32_bf16 v[164:167], a[76:79], a[4:7], v[164:167]
v_mfma_f32_16x16x32_bf16 v[156:159], a[76:79], a[0:3], v[156:159]
ds_read_b64_tr_b16 a[76:77], v15 offset:2048
v_mfma_f32_16x16x32_bf16 v[184:187], a[80:83], a[0:3], v[184:187]
ds_read_b64_tr_b16 a[78:79], v15 offset:2304
v_mfma_f32_16x16x32_bf16 v[192:195], a[80:83], a[4:7], v[192:195]
s_add_u32 m0, s16, 0x1800
v_mfma_f32_16x16x32_bf16 v[200:203], a[80:83], a[8:11], v[200:203]
buffer_load_dwordx4 v22, s[44:47], s23 offen lds
v_mfma_f32_16x16x32_bf16 v[208:211], a[80:83], a[12:15], v[208:211]
v_mfma_f32_16x16x32_bf16 v[248:251], a[80:83], a[16:19], v[248:251]
ds_read_b64_tr_b16 a[80:81], v14 offset:6144
v_mfma_f32_16x16x32_bf16 v[212:215], a[84:87], a[12:15], v[212:215]
s_add_u32 m0, s16, 0x1c00
ds_read_b64_tr_b16 a[82:83], v14 offset:6400
v_mfma_f32_16x16x32_bf16 v[204:207], a[84:87], a[8:11], v[204:207]
buffer_load_dwordx4 v23, s[44:47], s23 offen lds
v_mfma_f32_16x16x32_bf16 v[196:199], a[84:87], a[4:7], v[196:199]
v_mfma_f32_16x16x32_bf16 v[188:191], a[84:87], a[0:3], v[188:191]
v_mfma_f32_16x16x32_bf16 v[216:219], a[0:3], a[88:91], v[216:219]
v_mfma_f32_16x16x32_bf16 v[224:227], a[4:7], a[88:91], v[224:227]
s_add_u32 s8, s28, 0x6400
v_mfma_f32_16x16x32_bf16 v[232:235], a[8:11], a[88:91], v[232:235]
buffer_store_dwordx4 a[196:199], v16, s[88:91], s8 offen sc1
v_mfma_f32_16x16x32_bf16 v[240:243], a[12:15], a[88:91], v[240:243]
v_mfma_f32_16x16x32_bf16 v[252:255], a[16:19], a[88:91], v[252:255]
v_mfma_f32_16x16x32_bf16 v[244:247], a[12:15], a[92:95], v[244:247]
v_mfma_f32_16x16x32_bf16 v[236:239], a[8:11], a[92:95], v[236:239]
v_add_u32 v12, 0x8000, v12
v_add_u32 v13, 0x8000, v13
v_mfma_f32_16x16x32_bf16 v[228:231], a[4:7], a[92:95], v[228:231]
v_add_u32 v14, 0x8000, v14
v_add_u32 v15, 0x8000, v15
v_mfma_f32_16x16x32_bf16 v[220:223], a[0:3], a[92:95], v[220:223]
v_add_u32 v10, 0x8000, v10
v_add_u32 v11, 0x8000, v11
s_waitcnt vmcnt(21) lgkmcnt(0)
s_barrier
v_mfma_f32_16x16x32_bf16 v[24:27], a[40:43], a[20:23], v[24:27]
s_add_u32 m0, s17, 0x0
v_add_u32 v22, 0x80, v22
v_add_u32 v23, 0x80, v23
ds_read_b128 a[0:3], v8 offset:32768
v_mfma_f32_16x16x32_bf16 v[56:59], a[40:43], a[24:27], v[56:59]
buffer_load_dwordx4 v5, s[52:55], 0 offen lds
v_mfma_f32_16x16x32_bf16 v[88:91], a[40:43], a[28:31], v[88:91]
ds_read_b128 a[4:7], v8 offset:34816
ds_read_b128 a[8:11], v8 offset:36864
v_mfma_f32_16x16x32_bf16 v[120:123], a[40:43], a[32:35], v[120:123]
ds_read_b128 a[12:15], v8 offset:38912
ds_read_b128 a[16:19], v10
v_mfma_f32_16x16x32_bf16 v[124:127], a[44:47], a[32:35], v[124:127]
ds_read_b64_tr_b16 a[84:85], v15 offset:4096
ds_read_b64_tr_b16 a[86:87], v15 offset:4352
v_mfma_f32_16x16x32_bf16 v[92:95], a[44:47], a[28:31], v[92:95]
s_add_u32 m0, s17, 0x400
ds_read_b64_tr_b16 a[88:89], v14 offset:8192
ds_read_b64_tr_b16 a[90:91], v14 offset:8448
v_mfma_f32_16x16x32_bf16 v[60:63], a[44:47], a[24:27], v[60:63]
buffer_load_dwordx4 v5, s[52:55], s13 offen lds
v_mfma_f32_16x16x32_bf16 v[28:31], a[44:47], a[20:23], v[28:31]
ds_read_b64_tr_b16 a[92:93], v15 offset:8192
ds_read_b64_tr_b16 a[94:95], v15 offset:8448
v_mfma_f32_16x16x32_bf16 v[32:35], a[48:51], a[20:23], v[32:35]
ds_read_b64_tr_b16 a[40:41], v12 offset:0
ds_read_b64_tr_b16 a[42:43], v12 offset:1024
v_mfma_f32_16x16x32_bf16 v[64:67], a[48:51], a[24:27], v[64:67]
ds_read_b64_tr_b16 a[44:45], v13 offset:0
v_mfma_f32_16x16x32_bf16 v[96:99], a[48:51], a[28:31], v[96:99]
ds_read_b64_tr_b16 a[46:47], v13 offset:1024
v_mfma_f32_16x16x32_bf16 v[128:131], a[48:51], a[32:35], v[128:131]
s_add_u32 m0, s17, 0x800
ds_read_b64_tr_b16 a[48:49], v12 offset:256
v_mfma_f32_16x16x32_bf16 v[132:135], a[52:55], a[32:35], v[132:135]
buffer_load_dwordx4 v6, s[52:55], 0 offen lds
v_mfma_f32_16x16x32_bf16 v[100:103], a[52:55], a[28:31], v[100:103]
ds_read_b64_tr_b16 a[50:51], v12 offset:1280
v_mfma_f32_16x16x32_bf16 v[68:71], a[52:55], a[24:27], v[68:71]
v_mfma_f32_16x16x32_bf16 v[36:39], a[52:55], a[20:23], v[36:39]
ds_read_b64_tr_b16 a[52:53], v13 offset:256
v_mfma_f32_16x16x32_bf16 v[40:43], a[56:59], a[20:23], v[40:43]
s_add_u32 m0, s17, 0xc00
ds_read_b64_tr_b16 a[54:55], v13 offset:1280
v_mfma_f32_16x16x32_bf16 v[72:75], a[56:59], a[24:27], v[72:75]
buffer_load_dwordx4 v6, s[52:55], s13 offen lds
v_mfma_f32_16x16x32_bf16 v[104:107], a[56:59], a[28:31], v[104:107]
v_mfma_f32_16x16x32_bf16 v[136:139], a[56:59], a[32:35], v[136:139]
ds_read_b64_tr_b16 a[56:57], v12 offset:512
v_mfma_f32_16x16x32_bf16 v[140:143], a[60:63], a[32:35], v[140:143]
ds_read_b64_tr_b16 a[58:59], v12 offset:1536
v_mfma_f32_16x16x32_bf16 v[108:111], a[60:63], a[28:31], v[108:111]
v_mfma_f32_16x16x32_bf16 v[76:79], a[60:63], a[24:27], v[76:79]
s_add_u32 s8, s28, 0x6800
v_mfma_f32_16x16x32_bf16 v[44:47], a[60:63], a[20:23], v[44:47]
buffer_store_dwordx4 a[200:203], v16, s[88:91], s8 offen sc1
v_mfma_f32_16x16x32_bf16 v[48:51], a[64:67], a[20:23], v[48:51]
ds_read_b64_tr_b16 a[60:61], v13 offset:512
v_mfma_f32_16x16x32_bf16 v[80:83], a[64:67], a[24:27], v[80:83]
ds_read_b64_tr_b16 a[62:63], v13 offset:1536
v_mfma_f32_16x16x32_bf16 v[112:115], a[64:67], a[28:31], v[112:115]
v_mfma_f32_16x16x32_bf16 v[144:147], a[64:67], a[32:35], v[144:147]
s_add_u32 m0, s18, 0x4000
ds_read_b64_tr_b16 a[64:65], v12 offset:768
v_mfma_f32_16x16x32_bf16 v[148:151], a[68:71], a[32:35], v[148:151]
buffer_load_dwordx4 v7, s[68:71], 0 offen lds
v_mfma_f32_16x16x32_bf16 v[116:119], a[68:71], a[28:31], v[116:119]
ds_read_b64_tr_b16 a[66:67], v12 offset:1792
v_mfma_f32_16x16x32_bf16 v[84:87], a[68:71], a[24:27], v[84:87]
v_mfma_f32_16x16x32_bf16 v[52:55], a[68:71], a[20:23], v[52:55]
ds_read_b64_tr_b16 a[68:69], v13 offset:768
v_mfma_f32_16x16x32_bf16 v[152:155], a[72:75], a[20:23], v[152:155]
ds_read_b64_tr_b16 a[70:71], v13 offset:1792
v_mfma_f32_16x16x32_bf16 v[160:163], a[72:75], a[24:27], v[160:163]
s_add_u32 m0, s18, 0x5000
v_mfma_f32_16x16x32_bf16 v[168:171], a[72:75], a[28:31], v[168:171]
buffer_load_dwordx4 v7, s[68:71], s25 offen lds
v_mfma_f32_16x16x32_bf16 v[176:179], a[72:75], a[32:35], v[176:179]
ds_read_b64_tr_b16 a[72:73], v14 offset:0
v_mfma_f32_16x16x32_bf16 v[180:183], a[76:79], a[32:35], v[180:183]
ds_read_b64_tr_b16 a[74:75], v14 offset:256
v_mfma_f32_16x16x32_bf16 v[172:175], a[76:79], a[28:31], v[172:175]
v_mfma_f32_16x16x32_bf16 v[164:167], a[76:79], a[24:27], v[164:167]
s_add_u32 m0, s18, 0x6000
v_mfma_f32_16x16x32_bf16 v[156:159], a[76:79], a[20:23], v[156:159]
buffer_load_dwordx4 v7, s[68:71], s26 offen lds
v_mfma_f32_16x16x32_bf16 v[184:187], a[80:83], a[20:23], v[184:187]
ds_read_b64_tr_b16 a[76:77], v15 offset:0
v_mfma_f32_16x16x32_bf16 v[192:195], a[80:83], a[24:27], v[192:195]
ds_read_b64_tr_b16 a[78:79], v15 offset:256
v_mfma_f32_16x16x32_bf16 v[200:203], a[80:83], a[28:31], v[200:203]
v_mfma_f32_16x16x32_bf16 v[208:211], a[80:83], a[32:35], v[208:211]
v_mfma_f32_16x16x32_bf16 v[248:251], a[80:83], a[36:39], v[248:251]
s_add_u32 m0, s18, 0x7000
ds_read_b64_tr_b16 a[80:81], v14 offset:4096
v_mfma_f32_16x16x32_bf16 v[212:215], a[104:107], a[32:35], v[212:215]
buffer_load_dwordx4 v4, s[44:47], s24 offen lds
v_mfma_f32_16x16x32_bf16 v[204:207], a[104:107], a[28:31], v[204:207]
ds_read_b64_tr_b16 a[82:83], v14 offset:4352
v_mfma_f32_16x16x32_bf16 v[196:199], a[104:107], a[24:27], v[196:199]
v_mfma_f32_16x16x32_bf16 v[188:191], a[104:107], a[20:23], v[188:191]
v_mfma_f32_16x16x32_bf16 v[216:219], a[20:23], a[108:111], v[216:219]
s_add_u32 s8, s28, 0x6c00
v_mfma_f32_16x16x32_bf16 v[224:227], a[24:27], a[108:111], v[224:227]
buffer_store_dwordx4 a[204:207], v16, s[88:91], s8 offen sc1
v_mfma_f32_16x16x32_bf16 v[232:235], a[28:31], a[108:111], v[232:235]
v_mfma_f32_16x16x32_bf16 v[240:243], a[32:35], a[108:111], v[240:243]
v_mfma_f32_16x16x32_bf16 v[252:255], a[36:39], a[108:111], v[252:255]
v_mfma_f32_16x16x32_bf16 v[244:247], a[32:35], a[112:115], v[244:247]
v_mfma_f32_16x16x32_bf16 v[236:239], a[28:31], a[112:115], v[236:239]
v_mfma_f32_16x16x32_bf16 v[228:231], a[24:27], a[112:115], v[228:231]
v_mfma_f32_16x16x32_bf16 v[220:223], a[20:23], a[112:115], v[220:223]
s_waitcnt lgkmcnt(0)
v_mfma_f32_16x16x32_bf16 v[24:27], a[40:43], a[0:3], v[24:27]
v_add_u32 v5, 0x80000, v5
v_add_u32 v6, 0x80000, v6
ds_read_b128 a[20:23], v9 offset:32768
v_mfma_f32_16x16x32_bf16 v[56:59], a[40:43], a[4:7], v[56:59]
v_add_u32 v7, 0x60000, v7
v_add_u32 v4, 0x80, v4
ds_read_b128 a[24:27], v9 offset:34816
v_mfma_f32_16x16x32_bf16 v[88:91], a[40:43], a[8:11], v[88:91]
ds_read_b128 a[28:31], v9 offset:36864
ds_read_b128 a[32:35], v9 offset:38912
v_mfma_f32_16x16x32_bf16 v[120:123], a[40:43], a[12:15], v[120:123]
ds_read_b128 a[36:39], v11
ds_read_b64_tr_b16 a[104:105], v15 offset:6144
v_mfma_f32_16x16x32_bf16 v[124:127], a[44:47], a[12:15], v[124:127]
ds_read_b64_tr_b16 a[106:107], v15 offset:6400
ds_read_b64_tr_b16 a[108:109], v14 offset:10240
v_mfma_f32_16x16x32_bf16 v[92:95], a[44:47], a[8:11], v[92:95]
ds_read_b64_tr_b16 a[110:111], v14 offset:10496
ds_read_b64_tr_b16 a[112:113], v15 offset:10240
v_mfma_f32_16x16x32_bf16 v[60:63], a[44:47], a[4:7], v[60:63]
ds_read_b64_tr_b16 a[114:115], v15 offset:10496
v_mfma_f32_16x16x32_bf16 v[28:31], a[44:47], a[0:3], v[28:31]
ds_read_b64_tr_b16 a[40:41], v12 offset:8192
ds_read_b64_tr_b16 a[42:43], v12 offset:9216
v_mfma_f32_16x16x32_bf16 v[32:35], a[48:51], a[0:3], v[32:35]
ds_read_b64_tr_b16 a[44:45], v13 offset:8192
v_mfma_f32_16x16x32_bf16 v[64:67], a[48:51], a[4:7], v[64:67]
s_add_u32 m0, s16, 0x8000
ds_read_b64_tr_b16 a[46:47], v13 offset:9216
s_waitcnt lgkmcnt(11)
v_mfma_f32_16x16x32_bf16 v[96:99], a[48:51], a[8:11], v[96:99]
buffer_load_dwordx4 v22, s[44:47], s20 offen lds
v_mfma_f32_16x16x32_bf16 v[128:131], a[48:51], a[12:15], v[128:131]
ds_read_b64_tr_b16 a[48:49], v12 offset:8448
v_mfma_f32_16x16x32_bf16 v[132:135], a[52:55], a[12:15], v[132:135]
ds_read_b64_tr_b16 a[50:51], v12 offset:9472
v_mfma_f32_16x16x32_bf16 v[100:103], a[52:55], a[8:11], v[100:103]
s_add_u32 m0, s16, 0x8400
v_mfma_f32_16x16x32_bf16 v[68:71], a[52:55], a[4:7], v[68:71]
buffer_load_dwordx4 v23, s[44:47], s20 offen lds
v_mfma_f32_16x16x32_bf16 v[36:39], a[52:55], a[0:3], v[36:39]
ds_read_b64_tr_b16 a[52:53], v13 offset:8448
v_mfma_f32_16x16x32_bf16 v[40:43], a[56:59], a[0:3], v[40:43]
ds_read_b64_tr_b16 a[54:55], v13 offset:9472
v_mfma_f32_16x16x32_bf16 v[72:75], a[56:59], a[4:7], v[72:75]
v_mfma_f32_16x16x32_bf16 v[104:107], a[56:59], a[8:11], v[104:107]
s_add_u32 m0, s16, 0x8800
v_mfma_f32_16x16x32_bf16 v[136:139], a[56:59], a[12:15], v[136:139]
buffer_load_dwordx4 v22, s[44:47], s21 offen lds
v_mfma_f32_16x16x32_bf16 v[140:143], a[60:63], a[12:15], v[140:143]
ds_read_b64_tr_b16 a[56:57], v12 offset:8704
v_mfma_f32_16x16x32_bf16 v[108:111], a[60:63], a[8:11], v[108:111]
ds_read_b64_tr_b16 a[58:59], v12 offset:9728
v_mfma_f32_16x16x32_bf16 v[76:79], a[60:63], a[4:7], v[76:79]
s_add_u32 m0, s16, 0x8c00
v_mfma_f32_16x16x32_bf16 v[44:47], a[60:63], a[0:3], v[44:47]
buffer_load_dwordx4 v23, s[44:47], s21 offen lds
v_mfma_f32_16x16x32_bf16 v[48:51], a[64:67], a[0:3], v[48:51]
ds_read_b64_tr_b16 a[60:61], v13 offset:8704
v_mfma_f32_16x16x32_bf16 v[80:83], a[64:67], a[4:7], v[80:83]
ds_read_b64_tr_b16 a[62:63], v13 offset:9728
v_mfma_f32_16x16x32_bf16 v[112:115], a[64:67], a[8:11], v[112:115]
v_mfma_f32_16x16x32_bf16 v[144:147], a[64:67], a[12:15], v[144:147]
s_add_u32 s8, s28, 0x7000
ds_read_b64_tr_b16 a[64:65], v12 offset:8960
v_mfma_f32_16x16x32_bf16 v[148:151], a[68:71], a[12:15], v[148:151]
buffer_store_dwordx4 a[208:211], v16, s[88:91], s8 offen sc1
v_mfma_f32_16x16x32_bf16 v[116:119], a[68:71], a[8:11], v[116:119]
ds_read_b64_tr_b16 a[66:67], v12 offset:9984
v_mfma_f32_16x16x32_bf16 v[84:87], a[68:71], a[4:7], v[84:87]
v_mfma_f32_16x16x32_bf16 v[52:55], a[68:71], a[0:3], v[52:55]
ds_read_b64_tr_b16 a[68:69], v13 offset:8960
v_mfma_f32_16x16x32_bf16 v[152:155], a[72:75], a[0:3], v[152:155]
s_add_u32 m0, s16, 0x9000
ds_read_b64_tr_b16 a[70:71], v13 offset:9984
v_mfma_f32_16x16x32_bf16 v[160:163], a[72:75], a[4:7], v[160:163]
buffer_load_dwordx4 v22, s[44:47], s22 offen lds
v_mfma_f32_16x16x32_bf16 v[168:171], a[72:75], a[8:11], v[168:171]
v_mfma_f32_16x16x32_bf16 v[176:179], a[72:75], a[12:15], v[176:179]
ds_read_b64_tr_b16 a[72:73], v14 offset:2048
v_mfma_f32_16x16x32_bf16 v[180:183], a[76:79], a[12:15], v[180:183]
s_add_u32 m0, s16, 0x9400
ds_read_b64_tr_b16 a[74:75], v14 offset:2304
v_mfma_f32_16x16x32_bf16 v[172:175], a[76:79], a[8:11], v[172:175]
buffer_load_dwordx4 v23, s[44:47], s22 offen lds
v_mfma_f32_16x16x32_bf16 v[164:167], a[76:79], a[4:7], v[164:167]
v_mfma_f32_16x16x32_bf16 v[156:159], a[76:79], a[0:3], v[156:159]
ds_read_b64_tr_b16 a[76:77], v15 offset:2048
v_mfma_f32_16x16x32_bf16 v[184:187], a[80:83], a[0:3], v[184:187]
ds_read_b64_tr_b16 a[78:79], v15 offset:2304
v_mfma_f32_16x16x32_bf16 v[192:195], a[80:83], a[4:7], v[192:195]
s_add_u32 m0, s16, 0x9800
v_mfma_f32_16x16x32_bf16 v[200:203], a[80:83], a[8:11], v[200:203]
buffer_load_dwordx4 v22, s[44:47], s23 offen lds
v_mfma_f32_16x16x32_bf16 v[208:211], a[80:83], a[12:15], v[208:211]
v_mfma_f32_16x16x32_bf16 v[248:251], a[80:83], a[16:19], v[248:251]
ds_read_b64_tr_b16 a[80:81], v14 offset:6144
v_mfma_f32_16x16x32_bf16 v[212:215], a[84:87], a[12:15], v[212:215]
s_add_u32 m0, s16, 0x9c00
ds_read_b64_tr_b16 a[82:83], v14 offset:6400
v_mfma_f32_16x16x32_bf16 v[204:207], a[84:87], a[8:11], v[204:207]
buffer_load_dwordx4 v23, s[44:47], s23 offen lds
v_mfma_f32_16x16x32_bf16 v[196:199], a[84:87], a[4:7], v[196:199]
v_mfma_f32_16x16x32_bf16 v[188:191], a[84:87], a[0:3], v[188:191]
v_mfma_f32_16x16x32_bf16 v[216:219], a[0:3], a[88:91], v[216:219]
v_mfma_f32_16x16x32_bf16 v[224:227], a[4:7], a[88:91], v[224:227]
s_add_u32 s8, s28, 0x7400
v_mfma_f32_16x16x32_bf16 v[232:235], a[8:11], a[88:91], v[232:235]
buffer_store_dwordx4 a[212:215], v16, s[88:91], s8 offen sc1
v_mfma_f32_16x16x32_bf16 v[240:243], a[12:15], a[88:91], v[240:243]
v_mfma_f32_16x16x32_bf16 v[252:255], a[16:19], a[88:91], v[252:255]
v_mfma_f32_16x16x32_bf16 v[244:247], a[12:15], a[92:95], v[244:247]
v_mfma_f32_16x16x32_bf16 v[236:239], a[8:11], a[92:95], v[236:239]
v_add_u32 v12, 0x8000, v12
v_add_u32 v13, 0x8000, v13
v_mfma_f32_16x16x32_bf16 v[228:231], a[4:7], a[92:95], v[228:231]
v_add_u32 v14, 0x8000, v14
v_add_u32 v15, 0x8000, v15
v_mfma_f32_16x16x32_bf16 v[220:223], a[0:3], a[92:95], v[220:223]
v_add_u32 v10, 0x8000, v10
v_add_u32 v11, 0x8000, v11
s_waitcnt vmcnt(21) lgkmcnt(0)
s_barrier
v_mfma_f32_16x16x32_bf16 v[24:27], a[40:43], a[20:23], v[24:27]
s_add_u32 m0, s17, 0x8000
v_add_u32 v22, 0x80, v22
v_add_u32 v23, 0x80, v23
ds_read_b128 a[0:3], v8 offset:0
v_mfma_f32_16x16x32_bf16 v[56:59], a[40:43], a[24:27], v[56:59]
buffer_load_dwordx4 v5, s[52:55], 0 offen lds
v_mfma_f32_16x16x32_bf16 v[88:91], a[40:43], a[28:31], v[88:91]
ds_read_b128 a[4:7], v8 offset:2048
ds_read_b128 a[8:11], v8 offset:4096
v_mfma_f32_16x16x32_bf16 v[120:123], a[40:43], a[32:35], v[120:123]
ds_read_b128 a[12:15], v8 offset:6144
ds_read_b128 a[16:19], v10
v_mfma_f32_16x16x32_bf16 v[124:127], a[44:47], a[32:35], v[124:127]
ds_read_b64_tr_b16 a[84:85], v15 offset:4096
ds_read_b64_tr_b16 a[86:87], v15 offset:4352
v_mfma_f32_16x16x32_bf16 v[92:95], a[44:47], a[28:31], v[92:95]
s_add_u32 m0, s17, 0x8400
ds_read_b64_tr_b16 a[88:89], v14 offset:8192
ds_read_b64_tr_b16 a[90:91], v14 offset:8448
v_mfma_f32_16x16x32_bf16 v[60:63], a[44:47], a[24:27], v[60:63]
buffer_load_dwordx4 v5, s[52:55], s13 offen lds
v_mfma_f32_16x16x32_bf16 v[28:31], a[44:47], a[20:23], v[28:31]
ds_read_b64_tr_b16 a[92:93], v15 offset:8192
ds_read_b64_tr_b16 a[94:95], v15 offset:8448
v_mfma_f32_16x16x32_bf16 v[32:35], a[48:51], a[20:23], v[32:35]
ds_read_b64_tr_b16 a[40:41], v12 offset:0
ds_read_b64_tr_b16 a[42:43], v12 offset:1024
v_mfma_f32_16x16x32_bf16 v[64:67], a[48:51], a[24:27], v[64:67]
ds_read_b64_tr_b16 a[44:45], v13 offset:0
v_mfma_f32_16x16x32_bf16 v[96:99], a[48:51], a[28:31], v[96:99]
ds_read_b64_tr_b16 a[46:47], v13 offset:1024
v_mfma_f32_16x16x32_bf16 v[128:131], a[48:51], a[32:35], v[128:131]
s_add_u32 m0, s17, 0x8800
ds_read_b64_tr_b16 a[48:49], v12 offset:256
v_mfma_f32_16x16x32_bf16 v[132:135], a[52:55], a[32:35], v[132:135]
buffer_load_dwordx4 v6, s[52:55], 0 offen lds
v_mfma_f32_16x16x32_bf16 v[100:103], a[52:55], a[28:31], v[100:103]
ds_read_b64_tr_b16 a[50:51], v12 offset:1280
v_mfma_f32_16x16x32_bf16 v[68:71], a[52:55], a[24:27], v[68:71]
v_mfma_f32_16x16x32_bf16 v[36:39], a[52:55], a[20:23], v[36:39]
ds_read_b64_tr_b16 a[52:53], v13 offset:256
v_mfma_f32_16x16x32_bf16 v[40:43], a[56:59], a[20:23], v[40:43]
s_add_u32 m0, s17, 0x8c00
ds_read_b64_tr_b16 a[54:55], v13 offset:1280
v_mfma_f32_16x16x32_bf16 v[72:75], a[56:59], a[24:27], v[72:75]
buffer_load_dwordx4 v6, s[52:55], s13 offen lds
v_mfma_f32_16x16x32_bf16 v[104:107], a[56:59], a[28:31], v[104:107]
v_mfma_f32_16x16x32_bf16 v[136:139], a[56:59], a[32:35], v[136:139]
ds_read_b64_tr_b16 a[56:57], v12 offset:512
v_mfma_f32_16x16x32_bf16 v[140:143], a[60:63], a[32:35], v[140:143]
ds_read_b64_tr_b16 a[58:59], v12 offset:1536
v_mfma_f32_16x16x32_bf16 v[108:111], a[60:63], a[28:31], v[108:111]
v_mfma_f32_16x16x32_bf16 v[76:79], a[60:63], a[24:27], v[76:79]
s_add_u32 s8, s28, 0x7800
v_mfma_f32_16x16x32_bf16 v[44:47], a[60:63], a[20:23], v[44:47]
buffer_store_dwordx4 a[216:219], v16, s[88:91], s8 offen sc1
v_mfma_f32_16x16x32_bf16 v[48:51], a[64:67], a[20:23], v[48:51]
ds_read_b64_tr_b16 a[60:61], v13 offset:512
v_mfma_f32_16x16x32_bf16 v[80:83], a[64:67], a[24:27], v[80:83]
ds_read_b64_tr_b16 a[62:63], v13 offset:1536
v_mfma_f32_16x16x32_bf16 v[112:115], a[64:67], a[28:31], v[112:115]
v_mfma_f32_16x16x32_bf16 v[144:147], a[64:67], a[32:35], v[144:147]
s_add_u32 m0, s18, 0xc000
ds_read_b64_tr_b16 a[64:65], v12 offset:768
v_mfma_f32_16x16x32_bf16 v[148:151], a[68:71], a[32:35], v[148:151]
buffer_load_dwordx4 v7, s[68:71], 0 offen lds
v_mfma_f32_16x16x32_bf16 v[116:119], a[68:71], a[28:31], v[116:119]
ds_read_b64_tr_b16 a[66:67], v12 offset:1792
v_mfma_f32_16x16x32_bf16 v[84:87], a[68:71], a[24:27], v[84:87]
v_mfma_f32_16x16x32_bf16 v[52:55], a[68:71], a[20:23], v[52:55]
ds_read_b64_tr_b16 a[68:69], v13 offset:768
v_mfma_f32_16x16x32_bf16 v[152:155], a[72:75], a[20:23], v[152:155]
ds_read_b64_tr_b16 a[70:71], v13 offset:1792
v_mfma_f32_16x16x32_bf16 v[160:163], a[72:75], a[24:27], v[160:163]
s_add_u32 m0, s18, 0xd000
v_mfma_f32_16x16x32_bf16 v[168:171], a[72:75], a[28:31], v[168:171]
buffer_load_dwordx4 v7, s[68:71], s25 offen lds
v_mfma_f32_16x16x32_bf16 v[176:179], a[72:75], a[32:35], v[176:179]
ds_read_b64_tr_b16 a[72:73], v14 offset:0
v_mfma_f32_16x16x32_bf16 v[180:183], a[76:79], a[32:35], v[180:183]
ds_read_b64_tr_b16 a[74:75], v14 offset:256
v_mfma_f32_16x16x32_bf16 v[172:175], a[76:79], a[28:31], v[172:175]
v_mfma_f32_16x16x32_bf16 v[164:167], a[76:79], a[24:27], v[164:167]
s_add_u32 m0, s18, 0xe000
v_mfma_f32_16x16x32_bf16 v[156:159], a[76:79], a[20:23], v[156:159]
buffer_load_dwordx4 v7, s[68:71], s26 offen lds
v_mfma_f32_16x16x32_bf16 v[184:187], a[80:83], a[20:23], v[184:187]
ds_read_b64_tr_b16 a[76:77], v15 offset:0
v_mfma_f32_16x16x32_bf16 v[192:195], a[80:83], a[24:27], v[192:195]
ds_read_b64_tr_b16 a[78:79], v15 offset:256
v_mfma_f32_16x16x32_bf16 v[200:203], a[80:83], a[28:31], v[200:203]
v_mfma_f32_16x16x32_bf16 v[208:211], a[80:83], a[32:35], v[208:211]
v_mfma_f32_16x16x32_bf16 v[248:251], a[80:83], a[36:39], v[248:251]
s_add_u32 m0, s18, 0xf000
ds_read_b64_tr_b16 a[80:81], v14 offset:4096
v_mfma_f32_16x16x32_bf16 v[212:215], a[104:107], a[32:35], v[212:215]
buffer_load_dwordx4 v4, s[44:47], s24 offen lds
v_mfma_f32_16x16x32_bf16 v[204:207], a[104:107], a[28:31], v[204:207]
ds_read_b64_tr_b16 a[82:83], v14 offset:4352
v_mfma_f32_16x16x32_bf16 v[196:199], a[104:107], a[24:27], v[196:199]
v_mfma_f32_16x16x32_bf16 v[188:191], a[104:107], a[20:23], v[188:191]
v_mfma_f32_16x16x32_bf16 v[216:219], a[20:23], a[108:111], v[216:219]
s_add_u32 s8, s28, 0x7c00
v_mfma_f32_16x16x32_bf16 v[224:227], a[24:27], a[108:111], v[224:227]
buffer_store_dwordx4 a[220:223], v16, s[88:91], s8 offen sc1
v_mfma_f32_16x16x32_bf16 v[232:235], a[28:31], a[108:111], v[232:235]
v_mfma_f32_16x16x32_bf16 v[240:243], a[32:35], a[108:111], v[240:243]
v_mfma_f32_16x16x32_bf16 v[252:255], a[36:39], a[108:111], v[252:255]
v_mfma_f32_16x16x32_bf16 v[244:247], a[32:35], a[112:115], v[244:247]
v_mfma_f32_16x16x32_bf16 v[236:239], a[28:31], a[112:115], v[236:239]
v_mfma_f32_16x16x32_bf16 v[228:231], a[24:27], a[112:115], v[228:231]
v_mfma_f32_16x16x32_bf16 v[220:223], a[20:23], a[112:115], v[220:223]
s_waitcnt lgkmcnt(0)
v_mfma_f32_16x16x32_bf16 v[24:27], a[40:43], a[0:3], v[24:27]
v_add_u32 v5, 0x80000, v5
v_add_u32 v6, 0x80000, v6
ds_read_b128 a[20:23], v9 offset:0
v_mfma_f32_16x16x32_bf16 v[56:59], a[40:43], a[4:7], v[56:59]
v_add_u32 v7, 0x60000, v7
v_add_u32 v4, 0x80, v4
ds_read_b128 a[24:27], v9 offset:2048
v_mfma_f32_16x16x32_bf16 v[88:91], a[40:43], a[8:11], v[88:91]
ds_read_b128 a[28:31], v9 offset:4096
ds_read_b128 a[32:35], v9 offset:6144
v_mfma_f32_16x16x32_bf16 v[120:123], a[40:43], a[12:15], v[120:123]
ds_read_b128 a[36:39], v11
ds_read_b64_tr_b16 a[104:105], v15 offset:6144
v_mfma_f32_16x16x32_bf16 v[124:127], a[44:47], a[12:15], v[124:127]
ds_read_b64_tr_b16 a[106:107], v15 offset:6400
ds_read_b64_tr_b16 a[108:109], v14 offset:10240
v_mfma_f32_16x16x32_bf16 v[92:95], a[44:47], a[8:11], v[92:95]
ds_read_b64_tr_b16 a[110:111], v14 offset:10496
ds_read_b64_tr_b16 a[112:113], v15 offset:10240
v_mfma_f32_16x16x32_bf16 v[60:63], a[44:47], a[4:7], v[60:63]
ds_read_b64_tr_b16 a[114:115], v15 offset:10496
v_mfma_f32_16x16x32_bf16 v[28:31], a[44:47], a[0:3], v[28:31]
ds_read_b64_tr_b16 a[40:41], v12 offset:8192
ds_read_b64_tr_b16 a[42:43], v12 offset:9216
v_mfma_f32_16x16x32_bf16 v[32:35], a[48:51], a[0:3], v[32:35]
ds_read_b64_tr_b16 a[44:45], v13 offset:8192
v_mfma_f32_16x16x32_bf16 v[64:67], a[48:51], a[4:7], v[64:67]
s_add_u32 m0, s16, 0x0
ds_read_b64_tr_b16 a[46:47], v13 offset:9216
s_waitcnt lgkmcnt(11)
v_mfma_f32_16x16x32_bf16 v[96:99], a[48:51], a[8:11], v[96:99]
buffer_load_dwordx4 v22, s[44:47], s20 offen lds
v_mfma_f32_16x16x32_bf16 v[128:131], a[48:51], a[12:15], v[128:131]
ds_read_b64_tr_b16 a[48:49], v12 offset:8448
v_mfma_f32_16x16x32_bf16 v[132:135], a[52:55], a[12:15], v[132:135]
ds_read_b64_tr_b16 a[50:51], v12 offset:9472
v_mfma_f32_16x16x32_bf16 v[100:103], a[52:55], a[8:11], v[100:103]
s_add_u32 m0, s16, 0x400
v_mfma_f32_16x16x32_bf16 v[68:71], a[52:55], a[4:7], v[68:71]
buffer_load_dwordx4 v23, s[44:47], s20 offen lds
v_mfma_f32_16x16x32_bf16 v[36:39], a[52:55], a[0:3], v[36:39]
ds_read_b64_tr_b16 a[52:53], v13 offset:8448
v_mfma_f32_16x16x32_bf16 v[40:43], a[56:59], a[0:3], v[40:43]
ds_read_b64_tr_b16 a[54:55], v13 offset:9472
v_mfma_f32_16x16x32_bf16 v[72:75], a[56:59], a[4:7], v[72:75]
v_mfma_f32_16x16x32_bf16 v[104:107], a[56:59], a[8:11], v[104:107]
s_add_u32 m0, s16, 0x800
v_mfma_f32_16x16x32_bf16 v[136:139], a[56:59], a[12:15], v[136:139]
buffer_load_dwordx4 v22, s[44:47], s21 offen lds
v_mfma_f32_16x16x32_bf16 v[140:143], a[60:63], a[12:15], v[140:143]
ds_read_b64_tr_b16 a[56:57], v12 offset:8704
v_mfma_f32_16x16x32_bf16 v[108:111], a[60:63], a[8:11], v[108:111]
ds_read_b64_tr_b16 a[58:59], v12 offset:9728
v_mfma_f32_16x16x32_bf16 v[76:79], a[60:63], a[4:7], v[76:79]
s_add_u32 m0, s16, 0xc00
v_mfma_f32_16x16x32_bf16 v[44:47], a[60:63], a[0:3], v[44:47]
buffer_load_dwordx4 v23, s[44:47], s21 offen lds
v_mfma_f32_16x16x32_bf16 v[48:51], a[64:67], a[0:3], v[48:51]
ds_read_b64_tr_b16 a[60:61], v13 offset:8704
v_mfma_f32_16x16x32_bf16 v[80:83], a[64:67], a[4:7], v[80:83]
ds_read_b64_tr_b16 a[62:63], v13 offset:9728
v_mfma_f32_16x16x32_bf16 v[112:115], a[64:67], a[8:11], v[112:115]
v_mfma_f32_16x16x32_bf16 v[144:147], a[64:67], a[12:15], v[144:147]
s_add_u32 s8, s28, 0xa000
ds_read_b64_tr_b16 a[64:65], v12 offset:8960
v_mfma_f32_16x16x32_bf16 v[148:151], a[68:71], a[12:15], v[148:151]
buffer_store_dwordx4 a[224:227], v16, s[88:91], s8 offen sc1
v_mfma_f32_16x16x32_bf16 v[116:119], a[68:71], a[8:11], v[116:119]
ds_read_b64_tr_b16 a[66:67], v12 offset:9984
v_mfma_f32_16x16x32_bf16 v[84:87], a[68:71], a[4:7], v[84:87]
v_mfma_f32_16x16x32_bf16 v[52:55], a[68:71], a[0:3], v[52:55]
ds_read_b64_tr_b16 a[68:69], v13 offset:8960
v_mfma_f32_16x16x32_bf16 v[152:155], a[72:75], a[0:3], v[152:155]
s_add_u32 m0, s16, 0x1000
ds_read_b64_tr_b16 a[70:71], v13 offset:9984
v_mfma_f32_16x16x32_bf16 v[160:163], a[72:75], a[4:7], v[160:163]
buffer_load_dwordx4 v22, s[44:47], s22 offen lds
v_mfma_f32_16x16x32_bf16 v[168:171], a[72:75], a[8:11], v[168:171]
v_mfma_f32_16x16x32_bf16 v[176:179], a[72:75], a[12:15], v[176:179]
ds_read_b64_tr_b16 a[72:73], v14 offset:2048
v_mfma_f32_16x16x32_bf16 v[180:183], a[76:79], a[12:15], v[180:183]
s_add_u32 m0, s16, 0x1400
ds_read_b64_tr_b16 a[74:75], v14 offset:2304
v_mfma_f32_16x16x32_bf16 v[172:175], a[76:79], a[8:11], v[172:175]
buffer_load_dwordx4 v23, s[44:47], s22 offen lds
v_mfma_f32_16x16x32_bf16 v[164:167], a[76:79], a[4:7], v[164:167]
v_mfma_f32_16x16x32_bf16 v[156:159], a[76:79], a[0:3], v[156:159]
ds_read_b64_tr_b16 a[76:77], v15 offset:2048
v_mfma_f32_16x16x32_bf16 v[184:187], a[80:83], a[0:3], v[184:187]
ds_read_b64_tr_b16 a[78:79], v15 offset:2304
v_mfma_f32_16x16x32_bf16 v[192:195], a[80:83], a[4:7], v[192:195]
s_add_u32 m0, s16, 0x1800
v_mfma_f32_16x16x32_bf16 v[200:203], a[80:83], a[8:11], v[200:203]
buffer_load_dwordx4 v22, s[44:47], s23 offen lds
v_mfma_f32_16x16x32_bf16 v[208:211], a[80:83], a[12:15], v[208:211]
v_mfma_f32_16x16x32_bf16 v[248:251], a[80:83], a[16:19], v[248:251]
ds_read_b64_tr_b16 a[80:81], v14 offset:6144
v_mfma_f32_16x16x32_bf16 v[212:215], a[84:87], a[12:15], v[212:215]
s_add_u32 m0, s16, 0x1c00
ds_read_b64_tr_b16 a[82:83], v14 offset:6400
v_mfma_f32_16x16x32_bf16 v[204:207], a[84:87], a[8:11], v[204:207]
buffer_load_dwordx4 v23, s[44:47], s23 offen lds
v_mfma_f32_16x16x32_bf16 v[196:199], a[84:87], a[4:7], v[196:199]
v_mfma_f32_16x16x32_bf16 v[188:191], a[84:87], a[0:3], v[188:191]
v_mfma_f32_16x16x32_bf16 v[216:219], a[0:3], a[88:91], v[216:219]
v_mfma_f32_16x16x32_bf16 v[224:227], a[4:7], a[88:91], v[224:227]
s_add_u32 s8, s28, 0xa400
v_mfma_f32_16x16x32_bf16 v[232:235], a[8:11], a[88:91], v[232:235]
buffer_store_dwordx4 a[228:231], v16, s[88:91], s8 offen sc1
v_mfma_f32_16x16x32_bf16 v[240:243], a[12:15], a[88:91], v[240:243]
v_mfma_f32_16x16x32_bf16 v[252:255], a[16:19], a[88:91], v[252:255]
v_mfma_f32_16x16x32_bf16 v[244:247], a[12:15], a[92:95], v[244:247]
v_mfma_f32_16x16x32_bf16 v[236:239], a[8:11], a[92:95], v[236:239]
v_add_u32 v12, 0xffff0000, v12
v_add_u32 v13, 0xffff0000, v13
v_mfma_f32_16x16x32_bf16 v[228:231], a[4:7], a[92:95], v[228:231]
v_add_u32 v14, 0xffff0000, v14
v_add_u32 v15, 0xffff0000, v15
v_mfma_f32_16x16x32_bf16 v[220:223], a[0:3], a[92:95], v[220:223]
v_add_u32 v10, 0xffff0000, v10
v_add_u32 v11, 0xffff0000, v11
s_waitcnt vmcnt(21) lgkmcnt(0)
s_barrier
v_mfma_f32_16x16x32_bf16 v[24:27], a[40:43], a[20:23], v[24:27]
s_add_u32 m0, s17, 0x10000
v_add_u32 v22, 0x80, v22
v_add_u32 v23, 0x80, v23
ds_read_b128 a[0:3], v8 offset:32768
v_mfma_f32_16x16x32_bf16 v[56:59], a[40:43], a[24:27], v[56:59]
buffer_load_dwordx4 v5, s[52:55], 0 offen lds
v_mfma_f32_16x16x32_bf16 v[88:91], a[40:43], a[28:31], v[88:91]
ds_read_b128 a[4:7], v8 offset:34816
ds_read_b128 a[8:11], v8 offset:36864
v_mfma_f32_16x16x32_bf16 v[120:123], a[40:43], a[32:35], v[120:123]
ds_read_b128 a[12:15], v8 offset:38912
ds_read_b128 a[16:19], v10
v_mfma_f32_16x16x32_bf16 v[124:127], a[44:47], a[32:35], v[124:127]
ds_read_b64_tr_b16 a[84:85], v15 offset:4096
ds_read_b64_tr_b16 a[86:87], v15 offset:4352
v_mfma_f32_16x16x32_bf16 v[92:95], a[44:47], a[28:31], v[92:95]
s_add_u32 m0, s17, 0x10400
ds_read_b64_tr_b16 a[88:89], v14 offset:8192
ds_read_b64_tr_b16 a[90:91], v14 offset:8448
v_mfma_f32_16x16x32_bf16 v[60:63], a[44:47], a[24:27], v[60:63]
buffer_load_dwordx4 v5, s[52:55], s13 offen lds
v_mfma_f32_16x16x32_bf16 v[28:31], a[44:47], a[20:23], v[28:31]
ds_read_b64_tr_b16 a[92:93], v15 offset:8192
ds_read_b64_tr_b16 a[94:95], v15 offset:8448
v_mfma_f32_16x16x32_bf16 v[32:35], a[48:51], a[20:23], v[32:35]
ds_read_b64_tr_b16 a[40:41], v12 offset:0
ds_read_b64_tr_b16 a[42:43], v12 offset:1024
v_mfma_f32_16x16x32_bf16 v[64:67], a[48:51], a[24:27], v[64:67]
ds_read_b64_tr_b16 a[44:45], v13 offset:0
v_mfma_f32_16x16x32_bf16 v[96:99], a[48:51], a[28:31], v[96:99]
ds_read_b64_tr_b16 a[46:47], v13 offset:1024
v_mfma_f32_16x16x32_bf16 v[128:131], a[48:51], a[32:35], v[128:131]
s_add_u32 m0, s17, 0x10800
ds_read_b64_tr_b16 a[48:49], v12 offset:256
v_mfma_f32_16x16x32_bf16 v[132:135], a[52:55], a[32:35], v[132:135]
buffer_load_dwordx4 v6, s[52:55], 0 offen lds
v_mfma_f32_16x16x32_bf16 v[100:103], a[52:55], a[28:31], v[100:103]
ds_read_b64_tr_b16 a[50:51], v12 offset:1280
v_mfma_f32_16x16x32_bf16 v[68:71], a[52:55], a[24:27], v[68:71]
v_mfma_f32_16x16x32_bf16 v[36:39], a[52:55], a[20:23], v[36:39]
ds_read_b64_tr_b16 a[52:53], v13 offset:256
v_mfma_f32_16x16x32_bf16 v[40:43], a[56:59], a[20:23], v[40:43]
s_add_u32 m0, s17, 0x10c00
ds_read_b64_tr_b16 a[54:55], v13 offset:1280
v_mfma_f32_16x16x32_bf16 v[72:75], a[56:59], a[24:27], v[72:75]
buffer_load_dwordx4 v6, s[52:55], s13 offen lds
v_mfma_f32_16x16x32_bf16 v[104:107], a[56:59], a[28:31], v[104:107]
v_mfma_f32_16x16x32_bf16 v[136:139], a[56:59], a[32:35], v[136:139]
ds_read_b64_tr_b16 a[56:57], v12 offset:512
v_mfma_f32_16x16x32_bf16 v[140:143], a[60:63], a[32:35], v[140:143]
ds_read_b64_tr_b16 a[58:59], v12 offset:1536
v_mfma_f32_16x16x32_bf16 v[108:111], a[60:63], a[28:31], v[108:111]
v_mfma_f32_16x16x32_bf16 v[76:79], a[60:63], a[24:27], v[76:79]
s_add_u32 s8, s28, 0xa800
v_mfma_f32_16x16x32_bf16 v[44:47], a[60:63], a[20:23], v[44:47]
buffer_store_dwordx4 a[232:235], v16, s[88:91], s8 offen sc1
v_mfma_f32_16x16x32_bf16 v[48:51], a[64:67], a[20:23], v[48:51]
ds_read_b64_tr_b16 a[60:61], v13 offset:512
v_mfma_f32_16x16x32_bf16 v[80:83], a[64:67], a[24:27], v[80:83]
ds_read_b64_tr_b16 a[62:63], v13 offset:1536
v_mfma_f32_16x16x32_bf16 v[112:115], a[64:67], a[28:31], v[112:115]
v_mfma_f32_16x16x32_bf16 v[144:147], a[64:67], a[32:35], v[144:147]
s_add_u32 m0, s18, 0x14000
ds_read_b64_tr_b16 a[64:65], v12 offset:768
v_mfma_f32_16x16x32_bf16 v[148:151], a[68:71], a[32:35], v[148:151]
buffer_load_dwordx4 v7, s[68:71], 0 offen lds
v_mfma_f32_16x16x32_bf16 v[116:119], a[68:71], a[28:31], v[116:119]
ds_read_b64_tr_b16 a[66:67], v12 offset:1792
v_mfma_f32_16x16x32_bf16 v[84:87], a[68:71], a[24:27], v[84:87]
v_mfma_f32_16x16x32_bf16 v[52:55], a[68:71], a[20:23], v[52:55]
ds_read_b64_tr_b16 a[68:69], v13 offset:768
v_mfma_f32_16x16x32_bf16 v[152:155], a[72:75], a[20:23], v[152:155]
ds_read_b64_tr_b16 a[70:71], v13 offset:1792
v_mfma_f32_16x16x32_bf16 v[160:163], a[72:75], a[24:27], v[160:163]
s_add_u32 m0, s18, 0x15000
v_mfma_f32_16x16x32_bf16 v[168:171], a[72:75], a[28:31], v[168:171]
buffer_load_dwordx4 v7, s[68:71], s25 offen lds
v_mfma_f32_16x16x32_bf16 v[176:179], a[72:75], a[32:35], v[176:179]
ds_read_b64_tr_b16 a[72:73], v14 offset:0
v_mfma_f32_16x16x32_bf16 v[180:183], a[76:79], a[32:35], v[180:183]
ds_read_b64_tr_b16 a[74:75], v14 offset:256
v_mfma_f32_16x16x32_bf16 v[172:175], a[76:79], a[28:31], v[172:175]
v_mfma_f32_16x16x32_bf16 v[164:167], a[76:79], a[24:27], v[164:167]
s_add_u32 m0, s18, 0x16000
v_mfma_f32_16x16x32_bf16 v[156:159], a[76:79], a[20:23], v[156:159]
buffer_load_dwordx4 v7, s[68:71], s26 offen lds
v_mfma_f32_16x16x32_bf16 v[184:187], a[80:83], a[20:23], v[184:187]
ds_read_b64_tr_b16 a[76:77], v15 offset:0
v_mfma_f32_16x16x32_bf16 v[192:195], a[80:83], a[24:27], v[192:195]
ds_read_b64_tr_b16 a[78:79], v15 offset:256
v_mfma_f32_16x16x32_bf16 v[200:203], a[80:83], a[28:31], v[200:203]
v_mfma_f32_16x16x32_bf16 v[208:211], a[80:83], a[32:35], v[208:211]
v_mfma_f32_16x16x32_bf16 v[248:251], a[80:83], a[36:39], v[248:251]
s_add_u32 m0, s18, 0x17000
ds_read_b64_tr_b16 a[80:81], v14 offset:4096
v_mfma_f32_16x16x32_bf16 v[212:215], a[104:107], a[32:35], v[212:215]
buffer_load_dwordx4 v4, s[44:47], s24 offen lds
v_mfma_f32_16x16x32_bf16 v[204:207], a[104:107], a[28:31], v[204:207]
ds_read_b64_tr_b16 a[82:83], v14 offset:4352
v_mfma_f32_16x16x32_bf16 v[196:199], a[104:107], a[24:27], v[196:199]
v_mfma_f32_16x16x32_bf16 v[188:191], a[104:107], a[20:23], v[188:191]
v_mfma_f32_16x16x32_bf16 v[216:219], a[20:23], a[108:111], v[216:219]
s_add_u32 s8, s28, 0xac00
v_mfma_f32_16x16x32_bf16 v[224:227], a[24:27], a[108:111], v[224:227]
buffer_store_dwordx4 a[236:239], v16, s[88:91], s8 offen sc1
v_mfma_f32_16x16x32_bf16 v[232:235], a[28:31], a[108:111], v[232:235]
v_mfma_f32_16x16x32_bf16 v[240:243], a[32:35], a[108:111], v[240:243]
v_mfma_f32_16x16x32_bf16 v[252:255], a[36:39], a[108:111], v[252:255]
v_mfma_f32_16x16x32_bf16 v[244:247], a[32:35], a[112:115], v[244:247]
v_mfma_f32_16x16x32_bf16 v[236:239], a[28:31], a[112:115], v[236:239]
v_mfma_f32_16x16x32_bf16 v[228:231], a[24:27], a[112:115], v[228:231]
v_mfma_f32_16x16x32_bf16 v[220:223], a[20:23], a[112:115], v[220:223]
s_waitcnt lgkmcnt(0)
v_mfma_f32_16x16x32_bf16 v[24:27], a[40:43], a[0:3], v[24:27]
v_add_u32 v5, 0x80000, v5
v_add_u32 v6, 0x80000, v6
ds_read_b128 a[20:23], v9 offset:32768
v_mfma_f32_16x16x32_bf16 v[56:59], a[40:43], a[4:7], v[56:59]
v_add_u32 v7, 0x60000, v7
v_add_u32 v4, 0x80, v4
ds_read_b128 a[24:27], v9 offset:34816
v_mfma_f32_16x16x32_bf16 v[88:91], a[40:43], a[8:11], v[88:91]
ds_read_b128 a[28:31], v9 offset:36864
ds_read_b128 a[32:35], v9 offset:38912
v_mfma_f32_16x16x32_bf16 v[120:123], a[40:43], a[12:15], v[120:123]
ds_read_b128 a[36:39], v11
ds_read_b64_tr_b16 a[104:105], v15 offset:6144
v_mfma_f32_16x16x32_bf16 v[124:127], a[44:47], a[12:15], v[124:127]
ds_read_b64_tr_b16 a[106:107], v15 offset:6400
ds_read_b64_tr_b16 a[108:109], v14 offset:10240
v_mfma_f32_16x16x32_bf16 v[92:95], a[44:47], a[8:11], v[92:95]
ds_read_b64_tr_b16 a[110:111], v14 offset:10496
ds_read_b64_tr_b16 a[112:113], v15 offset:10240
v_mfma_f32_16x16x32_bf16 v[60:63], a[44:47], a[4:7], v[60:63]
ds_read_b64_tr_b16 a[114:115], v15 offset:10496
v_mfma_f32_16x16x32_bf16 v[28:31], a[44:47], a[0:3], v[28:31]
ds_read_b64_tr_b16 a[40:41], v12 offset:8192
ds_read_b64_tr_b16 a[42:43], v12 offset:9216
v_mfma_f32_16x16x32_bf16 v[32:35], a[48:51], a[0:3], v[32:35]
ds_read_b64_tr_b16 a[44:45], v13 offset:8192
v_mfma_f32_16x16x32_bf16 v[64:67], a[48:51], a[4:7], v[64:67]
s_add_u32 m0, s16, 0x8000
ds_read_b64_tr_b16 a[46:47], v13 offset:9216
s_waitcnt lgkmcnt(11)
v_mfma_f32_16x16x32_bf16 v[96:99], a[48:51], a[8:11], v[96:99]
buffer_load_dwordx4 v22, s[44:47], s20 offen lds
v_mfma_f32_16x16x32_bf16 v[128:131], a[48:51], a[12:15], v[128:131]
ds_read_b64_tr_b16 a[48:49], v12 offset:8448
v_mfma_f32_16x16x32_bf16 v[132:135], a[52:55], a[12:15], v[132:135]
ds_read_b64_tr_b16 a[50:51], v12 offset:9472
v_mfma_f32_16x16x32_bf16 v[100:103], a[52:55], a[8:11], v[100:103]
s_add_u32 m0, s16, 0x8400
v_mfma_f32_16x16x32_bf16 v[68:71], a[52:55], a[4:7], v[68:71]
buffer_load_dwordx4 v23, s[44:47], s20 offen lds
v_mfma_f32_16x16x32_bf16 v[36:39], a[52:55], a[0:3], v[36:39]
ds_read_b64_tr_b16 a[52:53], v13 offset:8448
v_mfma_f32_16x16x32_bf16 v[40:43], a[56:59], a[0:3], v[40:43]
ds_read_b64_tr_b16 a[54:55], v13 offset:9472
v_mfma_f32_16x16x32_bf16 v[72:75], a[56:59], a[4:7], v[72:75]
v_mfma_f32_16x16x32_bf16 v[104:107], a[56:59], a[8:11], v[104:107]
s_add_u32 m0, s16, 0x8800
v_mfma_f32_16x16x32_bf16 v[136:139], a[56:59], a[12:15], v[136:139]
buffer_load_dwordx4 v22, s[44:47], s21 offen lds
v_mfma_f32_16x16x32_bf16 v[140:143], a[60:63], a[12:15], v[140:143]
ds_read_b64_tr_b16 a[56:57], v12 offset:8704
v_mfma_f32_16x16x32_bf16 v[108:111], a[60:63], a[8:11], v[108:111]
ds_read_b64_tr_b16 a[58:59], v12 offset:9728
v_mfma_f32_16x16x32_bf16 v[76:79], a[60:63], a[4:7], v[76:79]
s_add_u32 m0, s16, 0x8c00
v_mfma_f32_16x16x32_bf16 v[44:47], a[60:63], a[0:3], v[44:47]
buffer_load_dwordx4 v23, s[44:47], s21 offen lds
v_mfma_f32_16x16x32_bf16 v[48:51], a[64:67], a[0:3], v[48:51]
ds_read_b64_tr_b16 a[60:61], v13 offset:8704
v_mfma_f32_16x16x32_bf16 v[80:83], a[64:67], a[4:7], v[80:83]
ds_read_b64_tr_b16 a[62:63], v13 offset:9728
v_mfma_f32_16x16x32_bf16 v[112:115], a[64:67], a[8:11], v[112:115]
v_mfma_f32_16x16x32_bf16 v[144:147], a[64:67], a[12:15], v[144:147]
s_add_u32 s8, s28, 0xb000
ds_read_b64_tr_b16 a[64:65], v12 offset:8960
v_mfma_f32_16x16x32_bf16 v[148:151], a[68:71], a[12:15], v[148:151]
buffer_store_dwordx4 a[240:243], v16, s[88:91], s8 offen sc1
v_mfma_f32_16x16x32_bf16 v[116:119], a[68:71], a[8:11], v[116:119]
ds_read_b64_tr_b16 a[66:67], v12 offset:9984
v_mfma_f32_16x16x32_bf16 v[84:87], a[68:71], a[4:7], v[84:87]
v_mfma_f32_16x16x32_bf16 v[52:55], a[68:71], a[0:3], v[52:55]
ds_read_b64_tr_b16 a[68:69], v13 offset:8960
v_mfma_f32_16x16x32_bf16 v[152:155], a[72:75], a[0:3], v[152:155]
s_add_u32 m0, s16, 0x9000
ds_read_b64_tr_b16 a[70:71], v13 offset:9984
v_mfma_f32_16x16x32_bf16 v[160:163], a[72:75], a[4:7], v[160:163]
buffer_load_dwordx4 v22, s[44:47], s22 offen lds
v_mfma_f32_16x16x32_bf16 v[168:171], a[72:75], a[8:11], v[168:171]
v_mfma_f32_16x16x32_bf16 v[176:179], a[72:75], a[12:15], v[176:179]
ds_read_b64_tr_b16 a[72:73], v14 offset:2048
v_mfma_f32_16x16x32_bf16 v[180:183], a[76:79], a[12:15], v[180:183]
s_add_u32 m0, s16, 0x9400
ds_read_b64_tr_b16 a[74:75], v14 offset:2304
v_mfma_f32_16x16x32_bf16 v[172:175], a[76:79], a[8:11], v[172:175]
buffer_load_dwordx4 v23, s[44:47], s22 offen lds
v_mfma_f32_16x16x32_bf16 v[164:167], a[76:79], a[4:7], v[164:167]
v_mfma_f32_16x16x32_bf16 v[156:159], a[76:79], a[0:3], v[156:159]
ds_read_b64_tr_b16 a[76:77], v15 offset:2048
v_mfma_f32_16x16x32_bf16 v[184:187], a[80:83], a[0:3], v[184:187]
ds_read_b64_tr_b16 a[78:79], v15 offset:2304
v_mfma_f32_16x16x32_bf16 v[192:195], a[80:83], a[4:7], v[192:195]
s_add_u32 m0, s16, 0x9800
v_mfma_f32_16x16x32_bf16 v[200:203], a[80:83], a[8:11], v[200:203]
buffer_load_dwordx4 v22, s[44:47], s23 offen lds
v_mfma_f32_16x16x32_bf16 v[208:211], a[80:83], a[12:15], v[208:211]
v_mfma_f32_16x16x32_bf16 v[248:251], a[80:83], a[16:19], v[248:251]
ds_read_b64_tr_b16 a[80:81], v14 offset:6144
v_mfma_f32_16x16x32_bf16 v[212:215], a[84:87], a[12:15], v[212:215]
s_add_u32 m0, s16, 0x9c00
ds_read_b64_tr_b16 a[82:83], v14 offset:6400
v_mfma_f32_16x16x32_bf16 v[204:207], a[84:87], a[8:11], v[204:207]
buffer_load_dwordx4 v23, s[44:47], s23 offen lds
v_mfma_f32_16x16x32_bf16 v[196:199], a[84:87], a[4:7], v[196:199]
v_mfma_f32_16x16x32_bf16 v[188:191], a[84:87], a[0:3], v[188:191]
v_mfma_f32_16x16x32_bf16 v[216:219], a[0:3], a[88:91], v[216:219]
v_mfma_f32_16x16x32_bf16 v[224:227], a[4:7], a[88:91], v[224:227]
s_add_u32 s8, s28, 0xb400
v_mfma_f32_16x16x32_bf16 v[232:235], a[8:11], a[88:91], v[232:235]
buffer_store_dwordx4 a[244:247], v16, s[88:91], s8 offen sc1
v_mfma_f32_16x16x32_bf16 v[240:243], a[12:15], a[88:91], v[240:243]
v_mfma_f32_16x16x32_bf16 v[252:255], a[16:19], a[88:91], v[252:255]
v_mfma_f32_16x16x32_bf16 v[244:247], a[12:15], a[92:95], v[244:247]
v_mfma_f32_16x16x32_bf16 v[236:239], a[8:11], a[92:95], v[236:239]
v_add_u32 v12, 0x8000, v12
v_add_u32 v13, 0x8000, v13
v_mfma_f32_16x16x32_bf16 v[228:231], a[4:7], a[92:95], v[228:231]
v_add_u32 v14, 0x8000, v14
v_add_u32 v15, 0x8000, v15
v_mfma_f32_16x16x32_bf16 v[220:223], a[0:3], a[92:95], v[220:223]
v_add_u32 v10, 0x8000, v10
v_add_u32 v11, 0x8000, v11
s_waitcnt vmcnt(21) lgkmcnt(0)
s_barrier
v_mfma_f32_16x16x32_bf16 v[24:27], a[40:43], a[20:23], v[24:27]
s_add_u32 m0, s17, 0x0
v_add_u32 v22, 0x80, v22
v_add_u32 v23, 0x80, v23
ds_read_b128 a[0:3], v8 offset:0
v_mfma_f32_16x16x32_bf16 v[56:59], a[40:43], a[24:27], v[56:59]
buffer_load_dwordx4 v5, s[52:55], 0 offen lds
v_mfma_f32_16x16x32_bf16 v[88:91], a[40:43], a[28:31], v[88:91]
ds_read_b128 a[4:7], v8 offset:2048
ds_read_b128 a[8:11], v8 offset:4096
v_mfma_f32_16x16x32_bf16 v[120:123], a[40:43], a[32:35], v[120:123]
ds_read_b128 a[12:15], v8 offset:6144
ds_read_b128 a[16:19], v10
v_mfma_f32_16x16x32_bf16 v[124:127], a[44:47], a[32:35], v[124:127]
ds_read_b64_tr_b16 a[84:85], v15 offset:4096
ds_read_b64_tr_b16 a[86:87], v15 offset:4352
v_mfma_f32_16x16x32_bf16 v[92:95], a[44:47], a[28:31], v[92:95]
s_add_u32 m0, s17, 0x400
ds_read_b64_tr_b16 a[88:89], v14 offset:8192
ds_read_b64_tr_b16 a[90:91], v14 offset:8448
v_mfma_f32_16x16x32_bf16 v[60:63], a[44:47], a[24:27], v[60:63]
buffer_load_dwordx4 v5, s[52:55], s13 offen lds
v_mfma_f32_16x16x32_bf16 v[28:31], a[44:47], a[20:23], v[28:31]
ds_read_b64_tr_b16 a[92:93], v15 offset:8192
ds_read_b64_tr_b16 a[94:95], v15 offset:8448
v_mfma_f32_16x16x32_bf16 v[32:35], a[48:51], a[20:23], v[32:35]
ds_read_b64_tr_b16 a[40:41], v12 offset:0
ds_read_b64_tr_b16 a[42:43], v12 offset:1024
v_mfma_f32_16x16x32_bf16 v[64:67], a[48:51], a[24:27], v[64:67]
ds_read_b64_tr_b16 a[44:45], v13 offset:0
v_mfma_f32_16x16x32_bf16 v[96:99], a[48:51], a[28:31], v[96:99]
ds_read_b64_tr_b16 a[46:47], v13 offset:1024
v_mfma_f32_16x16x32_bf16 v[128:131], a[48:51], a[32:35], v[128:131]
s_add_u32 m0, s17, 0x800
ds_read_b64_tr_b16 a[48:49], v12 offset:256
v_mfma_f32_16x16x32_bf16 v[132:135], a[52:55], a[32:35], v[132:135]
buffer_load_dwordx4 v6, s[52:55], 0 offen lds
v_mfma_f32_16x16x32_bf16 v[100:103], a[52:55], a[28:31], v[100:103]
ds_read_b64_tr_b16 a[50:51], v12 offset:1280
v_mfma_f32_16x16x32_bf16 v[68:71], a[52:55], a[24:27], v[68:71]
v_mfma_f32_16x16x32_bf16 v[36:39], a[52:55], a[20:23], v[36:39]
ds_read_b64_tr_b16 a[52:53], v13 offset:256
v_mfma_f32_16x16x32_bf16 v[40:43], a[56:59], a[20:23], v[40:43]
s_add_u32 m0, s17, 0xc00
ds_read_b64_tr_b16 a[54:55], v13 offset:1280
v_mfma_f32_16x16x32_bf16 v[72:75], a[56:59], a[24:27], v[72:75]
buffer_load_dwordx4 v6, s[52:55], s13 offen lds
v_mfma_f32_16x16x32_bf16 v[104:107], a[56:59], a[28:31], v[104:107]
v_mfma_f32_16x16x32_bf16 v[136:139], a[56:59], a[32:35], v[136:139]
ds_read_b64_tr_b16 a[56:57], v12 offset:512
v_mfma_f32_16x16x32_bf16 v[140:143], a[60:63], a[32:35], v[140:143]
ds_read_b64_tr_b16 a[58:59], v12 offset:1536
v_mfma_f32_16x16x32_bf16 v[108:111], a[60:63], a[28:31], v[108:111]
v_mfma_f32_16x16x32_bf16 v[76:79], a[60:63], a[24:27], v[76:79]
s_add_u32 s8, s28, 0xb800
v_mfma_f32_16x16x32_bf16 v[44:47], a[60:63], a[20:23], v[44:47]
buffer_store_dwordx4 a[248:251], v16, s[88:91], s8 offen sc1
v_mfma_f32_16x16x32_bf16 v[48:51], a[64:67], a[20:23], v[48:51]
ds_read_b64_tr_b16 a[60:61], v13 offset:512
v_mfma_f32_16x16x32_bf16 v[80:83], a[64:67], a[24:27], v[80:83]
ds_read_b64_tr_b16 a[62:63], v13 offset:1536
v_mfma_f32_16x16x32_bf16 v[112:115], a[64:67], a[28:31], v[112:115]
v_mfma_f32_16x16x32_bf16 v[144:147], a[64:67], a[32:35], v[144:147]
s_add_u32 m0, s18, 0x4000
ds_read_b64_tr_b16 a[64:65], v12 offset:768
v_mfma_f32_16x16x32_bf16 v[148:151], a[68:71], a[32:35], v[148:151]
buffer_load_dwordx4 v7, s[68:71], 0 offen lds
v_mfma_f32_16x16x32_bf16 v[116:119], a[68:71], a[28:31], v[116:119]
ds_read_b64_tr_b16 a[66:67], v12 offset:1792
v_mfma_f32_16x16x32_bf16 v[84:87], a[68:71], a[24:27], v[84:87]
v_mfma_f32_16x16x32_bf16 v[52:55], a[68:71], a[20:23], v[52:55]
ds_read_b64_tr_b16 a[68:69], v13 offset:768
v_mfma_f32_16x16x32_bf16 v[152:155], a[72:75], a[20:23], v[152:155]
ds_read_b64_tr_b16 a[70:71], v13 offset:1792
v_mfma_f32_16x16x32_bf16 v[160:163], a[72:75], a[24:27], v[160:163]
s_add_u32 m0, s18, 0x5000
v_mfma_f32_16x16x32_bf16 v[168:171], a[72:75], a[28:31], v[168:171]
buffer_load_dwordx4 v7, s[68:71], s25 offen lds
v_mfma_f32_16x16x32_bf16 v[176:179], a[72:75], a[32:35], v[176:179]
ds_read_b64_tr_b16 a[72:73], v14 offset:0
v_mfma_f32_16x16x32_bf16 v[180:183], a[76:79], a[32:35], v[180:183]
ds_read_b64_tr_b16 a[74:75], v14 offset:256
v_mfma_f32_16x16x32_bf16 v[172:175], a[76:79], a[28:31], v[172:175]
v_mfma_f32_16x16x32_bf16 v[164:167], a[76:79], a[24:27], v[164:167]
s_add_u32 m0, s18, 0x6000
v_mfma_f32_16x16x32_bf16 v[156:159], a[76:79], a[20:23], v[156:159]
buffer_load_dwordx4 v7, s[68:71], s26 offen lds
v_mfma_f32_16x16x32_bf16 v[184:187], a[80:83], a[20:23], v[184:187]
ds_read_b64_tr_b16 a[76:77], v15 offset:0
v_mfma_f32_16x16x32_bf16 v[192:195], a[80:83], a[24:27], v[192:195]
ds_read_b64_tr_b16 a[78:79], v15 offset:256
v_mfma_f32_16x16x32_bf16 v[200:203], a[80:83], a[28:31], v[200:203]
v_mfma_f32_16x16x32_bf16 v[208:211], a[80:83], a[32:35], v[208:211]
v_mfma_f32_16x16x32_bf16 v[248:251], a[80:83], a[36:39], v[248:251]
s_add_u32 m0, s18, 0x7000
ds_read_b64_tr_b16 a[80:81], v14 offset:4096
v_mfma_f32_16x16x32_bf16 v[212:215], a[104:107], a[32:35], v[212:215]
buffer_load_dwordx4 v4, s[44:47], s24 offen lds
v_mfma_f32_16x16x32_bf16 v[204:207], a[104:107], a[28:31], v[204:207]
ds_read_b64_tr_b16 a[82:83], v14 offset:4352
v_mfma_f32_16x16x32_bf16 v[196:199], a[104:107], a[24:27], v[196:199]
v_mfma_f32_16x16x32_bf16 v[188:191], a[104:107], a[20:23], v[188:191]
v_mfma_f32_16x16x32_bf16 v[216:219], a[20:23], a[108:111], v[216:219]
s_add_u32 s8, s28, 0xbc00
v_mfma_f32_16x16x32_bf16 v[224:227], a[24:27], a[108:111], v[224:227]
buffer_store_dwordx4 a[252:255], v16, s[88:91], s8 offen sc1
v_mfma_f32_16x16x32_bf16 v[232:235], a[28:31], a[108:111], v[232:235]
v_mfma_f32_16x16x32_bf16 v[240:243], a[32:35], a[108:111], v[240:243]
v_mfma_f32_16x16x32_bf16 v[252:255], a[36:39], a[108:111], v[252:255]
v_mfma_f32_16x16x32_bf16 v[244:247], a[32:35], a[112:115], v[244:247]
v_mfma_f32_16x16x32_bf16 v[236:239], a[28:31], a[112:115], v[236:239]
v_mfma_f32_16x16x32_bf16 v[228:231], a[24:27], a[112:115], v[228:231]
v_mfma_f32_16x16x32_bf16 v[220:223], a[20:23], a[112:115], v[220:223]
s_waitcnt lgkmcnt(0)
v_mfma_f32_16x16x32_bf16 v[24:27], a[40:43], a[0:3], v[24:27]
v_add_u32 v5, 0x80000, v5
v_add_u32 v6, 0x80000, v6
ds_read_b128 a[20:23], v9 offset:0
v_mfma_f32_16x16x32_bf16 v[56:59], a[40:43], a[4:7], v[56:59]
v_add_u32 v7, 0x60000, v7
v_add_u32 v4, 0x80, v4
ds_read_b128 a[24:27], v9 offset:2048
v_mfma_f32_16x16x32_bf16 v[88:91], a[40:43], a[8:11], v[88:91]
ds_read_b128 a[28:31], v9 offset:4096
ds_read_b128 a[32:35], v9 offset:6144
v_mfma_f32_16x16x32_bf16 v[120:123], a[40:43], a[12:15], v[120:123]
ds_read_b128 a[36:39], v11
ds_read_b64_tr_b16 a[104:105], v15 offset:6144
v_mfma_f32_16x16x32_bf16 v[124:127], a[44:47], a[12:15], v[124:127]
ds_read_b64_tr_b16 a[106:107], v15 offset:6400
ds_read_b64_tr_b16 a[108:109], v14 offset:10240
v_mfma_f32_16x16x32_bf16 v[92:95], a[44:47], a[8:11], v[92:95]
ds_read_b64_tr_b16 a[110:111], v14 offset:10496
ds_read_b64_tr_b16 a[112:113], v15 offset:10240
v_mfma_f32_16x16x32_bf16 v[60:63], a[44:47], a[4:7], v[60:63]
ds_read_b64_tr_b16 a[114:115], v15 offset:10496
v_mfma_f32_16x16x32_bf16 v[28:31], a[44:47], a[0:3], v[28:31]
ds_read_b64_tr_b16 a[40:41], v12 offset:8192
ds_read_b64_tr_b16 a[42:43], v12 offset:9216
v_mfma_f32_16x16x32_bf16 v[32:35], a[48:51], a[0:3], v[32:35]
ds_read_b64_tr_b16 a[44:45], v13 offset:8192
v_mfma_f32_16x16x32_bf16 v[64:67], a[48:51], a[4:7], v[64:67]
s_add_u32 m0, s16, 0x0
ds_read_b64_tr_b16 a[46:47], v13 offset:9216
s_waitcnt lgkmcnt(11)
v_mfma_f32_16x16x32_bf16 v[96:99], a[48:51], a[8:11], v[96:99]
buffer_load_dwordx4 v22, s[44:47], s20 offen lds
v_mfma_f32_16x16x32_bf16 v[128:131], a[48:51], a[12:15], v[128:131]
ds_read_b64_tr_b16 a[48:49], v12 offset:8448
v_mfma_f32_16x16x32_bf16 v[132:135], a[52:55], a[12:15], v[132:135]
ds_read_b64_tr_b16 a[50:51], v12 offset:9472
v_mfma_f32_16x16x32_bf16 v[100:103], a[52:55], a[8:11], v[100:103]
v_mfma_f32_16x16x32_bf16 v[68:71], a[52:55], a[4:7], v[68:71]
s_add_u32 m0, s16, 0x400
v_mfma_f32_16x16x32_bf16 v[36:39], a[52:55], a[0:3], v[36:39]
buffer_load_dwordx4 v23, s[44:47], s20 offen lds
v_mfma_f32_16x16x32_bf16 v[40:43], a[56:59], a[0:3], v[40:43]
ds_read_b64_tr_b16 a[52:53], v13 offset:8448
v_mfma_f32_16x16x32_bf16 v[72:75], a[56:59], a[4:7], v[72:75]
ds_read_b64_tr_b16 a[54:55], v13 offset:9472
v_mfma_f32_16x16x32_bf16 v[104:107], a[56:59], a[8:11], v[104:107]
v_mfma_f32_16x16x32_bf16 v[136:139], a[56:59], a[12:15], v[136:139]
ds_read_b64_tr_b16 a[56:57], v12 offset:8704
v_mfma_f32_16x16x32_bf16 v[140:143], a[60:63], a[12:15], v[140:143]
s_add_u32 m0, s16, 0x800
ds_read_b64_tr_b16 a[58:59], v12 offset:9728
v_mfma_f32_16x16x32_bf16 v[108:111], a[60:63], a[8:11], v[108:111]
buffer_load_dwordx4 v22, s[44:47], s21 offen lds
v_mfma_f32_16x16x32_bf16 v[76:79], a[60:63], a[4:7], v[76:79]
v_mfma_f32_16x16x32_bf16 v[44:47], a[60:63], a[0:3], v[44:47]
ds_read_b64_tr_b16 a[60:61], v13 offset:8704
v_mfma_f32_16x16x32_bf16 v[48:51], a[64:67], a[0:3], v[48:51]
ds_read_b64_tr_b16 a[62:63], v13 offset:9728
v_mfma_f32_16x16x32_bf16 v[80:83], a[64:67], a[4:7], v[80:83]
v_mfma_f32_16x16x32_bf16 v[112:115], a[64:67], a[8:11], v[112:115]
s_add_u32 m0, s16, 0xc00
v_mfma_f32_16x16x32_bf16 v[144:147], a[64:67], a[12:15], v[144:147]
buffer_load_dwordx4 v23, s[44:47], s21 offen lds
v_mfma_f32_16x16x32_bf16 v[148:151], a[68:71], a[12:15], v[148:151]
ds_read_b64_tr_b16 a[64:65], v12 offset:8960
v_mfma_f32_16x16x32_bf16 v[116:119], a[68:71], a[8:11], v[116:119]
ds_read_b64_tr_b16 a[66:67], v12 offset:9984
v_mfma_f32_16x16x32_bf16 v[84:87], a[68:71], a[4:7], v[84:87]
v_mfma_f32_16x16x32_bf16 v[52:55], a[68:71], a[0:3], v[52:55]
ds_read_b64_tr_b16 a[68:69], v13 offset:8960
v_mfma_f32_16x16x32_bf16 v[152:155], a[72:75], a[0:3], v[152:155]
s_add_u32 m0, s16, 0x1000
ds_read_b64_tr_b16 a[70:71], v13 offset:9984
v_mfma_f32_16x16x32_bf16 v[160:163], a[72:75], a[4:7], v[160:163]
buffer_load_dwordx4 v22, s[44:47], s22 offen lds
v_mfma_f32_16x16x32_bf16 v[168:171], a[72:75], a[8:11], v[168:171]
v_mfma_f32_16x16x32_bf16 v[176:179], a[72:75], a[12:15], v[176:179]
ds_read_b64_tr_b16 a[72:73], v14 offset:2048
v_mfma_f32_16x16x32_bf16 v[180:183], a[76:79], a[12:15], v[180:183]
ds_read_b64_tr_b16 a[74:75], v14 offset:2304
v_mfma_f32_16x16x32_bf16 v[172:175], a[76:79], a[8:11], v[172:175]
s_add_u32 m0, s16, 0x1400
v_mfma_f32_16x16x32_bf16 v[164:167], a[76:79], a[4:7], v[164:167]
buffer_load_dwordx4 v23, s[44:47], s22 offen lds
v_mfma_f32_16x16x32_bf16 v[156:159], a[76:79], a[0:3], v[156:159]
ds_read_b64_tr_b16 a[76:77], v15 offset:2048
v_mfma_f32_16x16x32_bf16 v[184:187], a[80:83], a[0:3], v[184:187]
ds_read_b64_tr_b16 a[78:79], v15 offset:2304
v_mfma_f32_16x16x32_bf16 v[192:195], a[80:83], a[4:7], v[192:195]
v_mfma_f32_16x16x32_bf16 v[200:203], a[80:83], a[8:11], v[200:203]
v_mfma_f32_16x16x32_bf16 v[208:211], a[80:83], a[12:15], v[208:211]
s_add_u32 m0, s16, 0x1800
v_mfma_f32_16x16x32_bf16 v[248:251], a[80:83], a[16:19], v[248:251]
buffer_load_dwordx4 v22, s[44:47], s23 offen lds
v_mfma_f32_16x16x32_bf16 v[212:215], a[84:87], a[12:15], v[212:215]
ds_read_b64_tr_b16 a[80:81], v14 offset:6144
v_mfma_f32_16x16x32_bf16 v[204:207], a[84:87], a[8:11], v[204:207]
ds_read_b64_tr_b16 a[82:83], v14 offset:6400
v_mfma_f32_16x16x32_bf16 v[196:199], a[84:87], a[4:7], v[196:199]
v_mfma_f32_16x16x32_bf16 v[188:191], a[84:87], a[0:3], v[188:191]
v_mfma_f32_16x16x32_bf16 v[216:219], a[0:3], a[88:91], v[216:219]
s_add_u32 m0, s16, 0x1c00
v_mfma_f32_16x16x32_bf16 v[224:227], a[4:7], a[88:91], v[224:227]
buffer_load_dwordx4 v23, s[44:47], s23 offen lds
v_mfma_f32_16x16x32_bf16 v[232:235], a[8:11], a[88:91], v[232:235]
v_mfma_f32_16x16x32_bf16 v[240:243], a[12:15], a[88:91], v[240:243]
v_mfma_f32_16x16x32_bf16 v[252:255], a[16:19], a[88:91], v[252:255]
v_mfma_f32_16x16x32_bf16 v[244:247], a[12:15], a[92:95], v[244:247]
v_mfma_f32_16x16x32_bf16 v[236:239], a[8:11], a[92:95], v[236:239]
v_add_u32 v12, 0x8000, v12
v_add_u32 v13, 0x8000, v13
v_mfma_f32_16x16x32_bf16 v[228:231], a[4:7], a[92:95], v[228:231]
v_add_u32 v14, 0x8000, v14
v_add_u32 v15, 0x8000, v15
v_mfma_f32_16x16x32_bf16 v[220:223], a[0:3], a[92:95], v[220:223]
v_add_u32 v10, 0x8000, v10
v_add_u32 v11, 0x8000, v11
s_waitcnt vmcnt(19) lgkmcnt(0)
s_barrier
v_mfma_f32_16x16x32_bf16 v[24:27], a[40:43], a[20:23], v[24:27]
s_add_u32 m0, s17, 0x8000
v_add_u32 v22, 0x80, v22
v_add_u32 v23, 0x80, v23
ds_read_b128 a[0:3], v8 offset:32768
v_mfma_f32_16x16x32_bf16 v[56:59], a[40:43], a[24:27], v[56:59]
buffer_load_dwordx4 v5, s[52:55], 0 offen lds
v_mfma_f32_16x16x32_bf16 v[88:91], a[40:43], a[28:31], v[88:91]
ds_read_b128 a[4:7], v8 offset:34816
ds_read_b128 a[8:11], v8 offset:36864
v_mfma_f32_16x16x32_bf16 v[120:123], a[40:43], a[32:35], v[120:123]
ds_read_b128 a[12:15], v8 offset:38912
ds_read_b128 a[16:19], v10
v_mfma_f32_16x16x32_bf16 v[124:127], a[44:47], a[32:35], v[124:127]
ds_read_b64_tr_b16 a[84:85], v15 offset:4096
ds_read_b64_tr_b16 a[86:87], v15 offset:4352
v_mfma_f32_16x16x32_bf16 v[92:95], a[44:47], a[28:31], v[92:95]
ds_read_b64_tr_b16 a[88:89], v14 offset:8192
ds_read_b64_tr_b16 a[90:91], v14 offset:8448
v_mfma_f32_16x16x32_bf16 v[60:63], a[44:47], a[24:27], v[60:63]
s_add_u32 m0, s17, 0x8400
ds_read_b64_tr_b16 a[92:93], v15 offset:8192
ds_read_b64_tr_b16 a[94:95], v15 offset:8448
v_mfma_f32_16x16x32_bf16 v[28:31], a[44:47], a[20:23], v[28:31]
buffer_load_dwordx4 v5, s[52:55], s13 offen lds
v_mfma_f32_16x16x32_bf16 v[32:35], a[48:51], a[20:23], v[32:35]
ds_read_b64_tr_b16 a[40:41], v12 offset:0
ds_read_b64_tr_b16 a[42:43], v12 offset:1024
v_mfma_f32_16x16x32_bf16 v[64:67], a[48:51], a[24:27], v[64:67]
ds_read_b64_tr_b16 a[44:45], v13 offset:0
v_mfma_f32_16x16x32_bf16 v[96:99], a[48:51], a[28:31], v[96:99]
ds_read_b64_tr_b16 a[46:47], v13 offset:1024
v_mfma_f32_16x16x32_bf16 v[128:131], a[48:51], a[32:35], v[128:131]
ds_read_b64_tr_b16 a[48:49], v12 offset:256
v_mfma_f32_16x16x32_bf16 v[132:135], a[52:55], a[32:35], v[132:135]
ds_read_b64_tr_b16 a[50:51], v12 offset:1280
v_mfma_f32_16x16x32_bf16 v[100:103], a[52:55], a[28:31], v[100:103]
s_add_u32 m0, s17, 0x8800
v_mfma_f32_16x16x32_bf16 v[68:71], a[52:55], a[24:27], v[68:71]
buffer_load_dwordx4 v6, s[52:55], 0 offen lds
v_mfma_f32_16x16x32_bf16 v[36:39], a[52:55], a[20:23], v[36:39]
ds_read_b64_tr_b16 a[52:53], v13 offset:256
v_mfma_f32_16x16x32_bf16 v[40:43], a[56:59], a[20:23], v[40:43]
ds_read_b64_tr_b16 a[54:55], v13 offset:1280
v_mfma_f32_16x16x32_bf16 v[72:75], a[56:59], a[24:27], v[72:75]
v_mfma_f32_16x16x32_bf16 v[104:107], a[56:59], a[28:31], v[104:107]
v_mfma_f32_16x16x32_bf16 v[136:139], a[56:59], a[32:35], v[136:139]
ds_read_b64_tr_b16 a[56:57], v12 offset:512
v_mfma_f32_16x16x32_bf16 v[140:143], a[60:63], a[32:35], v[140:143]
s_add_u32 m0, s17, 0x8c00
ds_read_b64_tr_b16 a[58:59], v12 offset:1536
v_mfma_f32_16x16x32_bf16 v[108:111], a[60:63], a[28:31], v[108:111]
buffer_load_dwordx4 v6, s[52:55], s13 offen lds
v_mfma_f32_16x16x32_bf16 v[76:79], a[60:63], a[24:27], v[76:79]
v_mfma_f32_16x16x32_bf16 v[44:47], a[60:63], a[20:23], v[44:47]
ds_read_b64_tr_b16 a[60:61], v13 offset:512
v_mfma_f32_16x16x32_bf16 v[48:51], a[64:67], a[20:23], v[48:51]
ds_read_b64_tr_b16 a[62:63], v13 offset:1536
v_mfma_f32_16x16x32_bf16 v[80:83], a[64:67], a[24:27], v[80:83]
v_mfma_f32_16x16x32_bf16 v[112:115], a[64:67], a[28:31], v[112:115]
v_mfma_f32_16x16x32_bf16 v[144:147], a[64:67], a[32:35], v[144:147]
s_add_u32 m0, s18, 0xc000
ds_read_b64_tr_b16 a[64:65], v12 offset:768
v_mfma_f32_16x16x32_bf16 v[148:151], a[68:71], a[32:35], v[148:151]
buffer_load_dwordx4 v7, s[68:71], 0 offen lds
v_mfma_f32_16x16x32_bf16 v[116:119], a[68:71], a[28:31], v[116:119]
ds_read_b64_tr_b16 a[66:67], v12 offset:1792
v_mfma_f32_16x16x32_bf16 v[84:87], a[68:71], a[24:27], v[84:87]
v_mfma_f32_16x16x32_bf16 v[52:55], a[68:71], a[20:23], v[52:55]
ds_read_b64_tr_b16 a[68:69], v13 offset:768
v_mfma_f32_16x16x32_bf16 v[152:155], a[72:75], a[20:23], v[152:155]
ds_read_b64_tr_b16 a[70:71], v13 offset:1792
v_mfma_f32_16x16x32_bf16 v[160:163], a[72:75], a[24:27], v[160:163]
v_mfma_f32_16x16x32_bf16 v[168:171], a[72:75], a[28:31], v[168:171]
s_add_u32 m0, s18, 0xd000
v_mfma_f32_16x16x32_bf16 v[176:179], a[72:75], a[32:35], v[176:179]
buffer_load_dwordx4 v7, s[68:71], s25 offen lds
v_mfma_f32_16x16x32_bf16 v[180:183], a[76:79], a[32:35], v[180:183]
ds_read_b64_tr_b16 a[72:73], v14 offset:0
v_mfma_f32_16x16x32_bf16 v[172:175], a[76:79], a[28:31], v[172:175]
ds_read_b64_tr_b16 a[74:75], v14 offset:256
v_mfma_f32_16x16x32_bf16 v[164:167], a[76:79], a[24:27], v[164:167]
v_mfma_f32_16x16x32_bf16 v[156:159], a[76:79], a[20:23], v[156:159]
ds_read_b64_tr_b16 a[76:77], v15 offset:0
v_mfma_f32_16x16x32_bf16 v[184:187], a[80:83], a[20:23], v[184:187]
ds_read_b64_tr_b16 a[78:79], v15 offset:256
v_mfma_f32_16x16x32_bf16 v[192:195], a[80:83], a[24:27], v[192:195]
s_add_u32 m0, s18, 0xe000
v_mfma_f32_16x16x32_bf16 v[200:203], a[80:83], a[28:31], v[200:203]
buffer_load_dwordx4 v7, s[68:71], s26 offen lds
v_mfma_f32_16x16x32_bf16 v[208:211], a[80:83], a[32:35], v[208:211]
v_mfma_f32_16x16x32_bf16 v[248:251], a[80:83], a[36:39], v[248:251]
ds_read_b64_tr_b16 a[80:81], v14 offset:4096
v_mfma_f32_16x16x32_bf16 v[212:215], a[104:107], a[32:35], v[212:215]
ds_read_b64_tr_b16 a[82:83], v14 offset:4352
v_mfma_f32_16x16x32_bf16 v[204:207], a[104:107], a[28:31], v[204:207]
v_mfma_f32_16x16x32_bf16 v[196:199], a[104:107], a[24:27], v[196:199]
v_mfma_f32_16x16x32_bf16 v[188:191], a[104:107], a[20:23], v[188:191]
s_add_u32 m0, s18, 0xf000
v_mfma_f32_16x16x32_bf16 v[216:219], a[20:23], a[108:111], v[216:219]
buffer_load_dwordx4 v4, s[44:47], s24 offen lds
v_mfma_f32_16x16x32_bf16 v[224:227], a[24:27], a[108:111], v[224:227]
v_mfma_f32_16x16x32_bf16 v[232:235], a[28:31], a[108:111], v[232:235]
v_mfma_f32_16x16x32_bf16 v[240:243], a[32:35], a[108:111], v[240:243]
v_mfma_f32_16x16x32_bf16 v[252:255], a[36:39], a[108:111], v[252:255]
v_mfma_f32_16x16x32_bf16 v[244:247], a[32:35], a[112:115], v[244:247]
v_mfma_f32_16x16x32_bf16 v[236:239], a[28:31], a[112:115], v[236:239]
v_mfma_f32_16x16x32_bf16 v[228:231], a[24:27], a[112:115], v[228:231]
v_mfma_f32_16x16x32_bf16 v[220:223], a[20:23], a[112:115], v[220:223]
s_waitcnt lgkmcnt(0)
v_mfma_f32_16x16x32_bf16 v[24:27], a[40:43], a[0:3], v[24:27]
v_add_u32 v5, 0x80000, v5
v_add_u32 v6, 0x80000, v6
ds_read_b128 a[20:23], v9 offset:32768
v_mfma_f32_16x16x32_bf16 v[56:59], a[40:43], a[4:7], v[56:59]
v_add_u32 v7, 0x60000, v7
v_add_u32 v4, 0x80, v4
ds_read_b128 a[24:27], v9 offset:34816
v_mfma_f32_16x16x32_bf16 v[88:91], a[40:43], a[8:11], v[88:91]
ds_read_b128 a[28:31], v9 offset:36864
ds_read_b128 a[32:35], v9 offset:38912
v_mfma_f32_16x16x32_bf16 v[120:123], a[40:43], a[12:15], v[120:123]
ds_read_b128 a[36:39], v11
ds_read_b64_tr_b16 a[104:105], v15 offset:6144
v_mfma_f32_16x16x32_bf16 v[124:127], a[44:47], a[12:15], v[124:127]
ds_read_b64_tr_b16 a[106:107], v15 offset:6400
ds_read_b64_tr_b16 a[108:109], v14 offset:10240
v_mfma_f32_16x16x32_bf16 v[92:95], a[44:47], a[8:11], v[92:95]
ds_read_b64_tr_b16 a[110:111], v14 offset:10496
ds_read_b64_tr_b16 a[112:113], v15 offset:10240
v_mfma_f32_16x16x32_bf16 v[60:63], a[44:47], a[4:7], v[60:63]
ds_read_b64_tr_b16 a[114:115], v15 offset:10496
v_mfma_f32_16x16x32_bf16 v[28:31], a[44:47], a[0:3], v[28:31]
ds_read_b64_tr_b16 a[40:41], v12 offset:8192
ds_read_b64_tr_b16 a[42:43], v12 offset:9216
v_mfma_f32_16x16x32_bf16 v[32:35], a[48:51], a[0:3], v[32:35]
ds_read_b64_tr_b16 a[44:45], v13 offset:8192
v_mfma_f32_16x16x32_bf16 v[64:67], a[48:51], a[4:7], v[64:67]
s_add_u32 m0, s16, 0x8000
ds_read_b64_tr_b16 a[46:47], v13 offset:9216
s_waitcnt lgkmcnt(11)
v_mfma_f32_16x16x32_bf16 v[96:99], a[48:51], a[8:11], v[96:99]
buffer_load_dwordx4 v22, s[44:47], s20 offen lds
v_mfma_f32_16x16x32_bf16 v[128:131], a[48:51], a[12:15], v[128:131]
ds_read_b64_tr_b16 a[48:49], v12 offset:8448
v_mfma_f32_16x16x32_bf16 v[132:135], a[52:55], a[12:15], v[132:135]
ds_read_b64_tr_b16 a[50:51], v12 offset:9472
v_mfma_f32_16x16x32_bf16 v[100:103], a[52:55], a[8:11], v[100:103]
v_mfma_f32_16x16x32_bf16 v[68:71], a[52:55], a[4:7], v[68:71]
s_add_u32 m0, s16, 0x8400
v_mfma_f32_16x16x32_bf16 v[36:39], a[52:55], a[0:3], v[36:39]
buffer_load_dwordx4 v23, s[44:47], s20 offen lds
v_mfma_f32_16x16x32_bf16 v[40:43], a[56:59], a[0:3], v[40:43]
ds_read_b64_tr_b16 a[52:53], v13 offset:8448
v_mfma_f32_16x16x32_bf16 v[72:75], a[56:59], a[4:7], v[72:75]
ds_read_b64_tr_b16 a[54:55], v13 offset:9472
v_mfma_f32_16x16x32_bf16 v[104:107], a[56:59], a[8:11], v[104:107]
v_mfma_f32_16x16x32_bf16 v[136:139], a[56:59], a[12:15], v[136:139]
ds_read_b64_tr_b16 a[56:57], v12 offset:8704
v_mfma_f32_16x16x32_bf16 v[140:143], a[60:63], a[12:15], v[140:143]
s_add_u32 m0, s16, 0x8800
ds_read_b64_tr_b16 a[58:59], v12 offset:9728
v_mfma_f32_16x16x32_bf16 v[108:111], a[60:63], a[8:11], v[108:111]
buffer_load_dwordx4 v22, s[44:47], s21 offen lds
v_mfma_f32_16x16x32_bf16 v[76:79], a[60:63], a[4:7], v[76:79]
v_mfma_f32_16x16x32_bf16 v[44:47], a[60:63], a[0:3], v[44:47]
ds_read_b64_tr_b16 a[60:61], v13 offset:8704
v_mfma_f32_16x16x32_bf16 v[48:51], a[64:67], a[0:3], v[48:51]
ds_read_b64_tr_b16 a[62:63], v13 offset:9728
v_mfma_f32_16x16x32_bf16 v[80:83], a[64:67], a[4:7], v[80:83]
v_mfma_f32_16x16x32_bf16 v[112:115], a[64:67], a[8:11], v[112:115]
s_add_u32 m0, s16, 0x8c00
v_mfma_f32_16x16x32_bf16 v[144:147], a[64:67], a[12:15], v[144:147]
buffer_load_dwordx4 v23, s[44:47], s21 offen lds
v_mfma_f32_16x16x32_bf16 v[148:151], a[68:71], a[12:15], v[148:151]
ds_read_b64_tr_b16 a[64:65], v12 offset:8960
v_mfma_f32_16x16x32_bf16 v[116:119], a[68:71], a[8:11], v[116:119]
ds_read_b64_tr_b16 a[66:67], v12 offset:9984
v_mfma_f32_16x16x32_bf16 v[84:87], a[68:71], a[4:7], v[84:87]
v_mfma_f32_16x16x32_bf16 v[52:55], a[68:71], a[0:3], v[52:55]
ds_read_b64_tr_b16 a[68:69], v13 offset:8960
v_mfma_f32_16x16x32_bf16 v[152:155], a[72:75], a[0:3], v[152:155]
s_add_u32 m0, s16, 0x9000
ds_read_b64_tr_b16 a[70:71], v13 offset:9984
v_mfma_f32_16x16x32_bf16 v[160:163], a[72:75], a[4:7], v[160:163]
buffer_load_dwordx4 v22, s[44:47], s22 offen lds
v_mfma_f32_16x16x32_bf16 v[168:171], a[72:75], a[8:11], v[168:171]
v_mfma_f32_16x16x32_bf16 v[176:179], a[72:75], a[12:15], v[176:179]
ds_read_b64_tr_b16 a[72:73], v14 offset:2048
v_mfma_f32_16x16x32_bf16 v[180:183], a[76:79], a[12:15], v[180:183]
ds_read_b64_tr_b16 a[74:75], v14 offset:2304
v_mfma_f32_16x16x32_bf16 v[172:175], a[76:79], a[8:11], v[172:175]
s_add_u32 m0, s16, 0x9400
v_mfma_f32_16x16x32_bf16 v[164:167], a[76:79], a[4:7], v[164:167]
buffer_load_dwordx4 v23, s[44:47], s22 offen lds
v_mfma_f32_16x16x32_bf16 v[156:159], a[76:79], a[0:3], v[156:159]
ds_read_b64_tr_b16 a[76:77], v15 offset:2048
v_mfma_f32_16x16x32_bf16 v[184:187], a[80:83], a[0:3], v[184:187]
ds_read_b64_tr_b16 a[78:79], v15 offset:2304
v_mfma_f32_16x16x32_bf16 v[192:195], a[80:83], a[4:7], v[192:195]
v_mfma_f32_16x16x32_bf16 v[200:203], a[80:83], a[8:11], v[200:203]
v_mfma_f32_16x16x32_bf16 v[208:211], a[80:83], a[12:15], v[208:211]
s_add_u32 m0, s16, 0x9800
v_mfma_f32_16x16x32_bf16 v[248:251], a[80:83], a[16:19], v[248:251]
buffer_load_dwordx4 v22, s[44:47], s23 offen lds
v_mfma_f32_16x16x32_bf16 v[212:215], a[84:87], a[12:15], v[212:215]
ds_read_b64_tr_b16 a[80:81], v14 offset:6144
v_mfma_f32_16x16x32_bf16 v[204:207], a[84:87], a[8:11], v[204:207]
ds_read_b64_tr_b16 a[82:83], v14 offset:6400
v_mfma_f32_16x16x32_bf16 v[196:199], a[84:87], a[4:7], v[196:199]
v_mfma_f32_16x16x32_bf16 v[188:191], a[84:87], a[0:3], v[188:191]
v_mfma_f32_16x16x32_bf16 v[216:219], a[0:3], a[88:91], v[216:219]
s_add_u32 m0, s16, 0x9c00
v_mfma_f32_16x16x32_bf16 v[224:227], a[4:7], a[88:91], v[224:227]
buffer_load_dwordx4 v23, s[44:47], s23 offen lds
v_mfma_f32_16x16x32_bf16 v[232:235], a[8:11], a[88:91], v[232:235]
v_mfma_f32_16x16x32_bf16 v[240:243], a[12:15], a[88:91], v[240:243]
v_mfma_f32_16x16x32_bf16 v[252:255], a[16:19], a[88:91], v[252:255]
v_mfma_f32_16x16x32_bf16 v[244:247], a[12:15], a[92:95], v[244:247]
v_mfma_f32_16x16x32_bf16 v[236:239], a[8:11], a[92:95], v[236:239]
v_add_u32 v12, 0xffff0000, v12
v_add_u32 v13, 0xffff0000, v13
v_mfma_f32_16x16x32_bf16 v[228:231], a[4:7], a[92:95], v[228:231]
v_add_u32 v14, 0xffff0000, v14
v_add_u32 v15, 0xffff0000, v15
v_mfma_f32_16x16x32_bf16 v[220:223], a[0:3], a[92:95], v[220:223]
v_add_u32 v10, 0xffff0000, v10
v_add_u32 v11, 0xffff0000, v11
s_waitcnt vmcnt(16) lgkmcnt(0)
s_barrier
s_lshl_b32 s10, s5, 2
s_cmp_lg_u32 s4, 0
s_cbranch_scc1 L_sig_kv
v_mov_b32 v17, 1
s_mov_b64 exec, 1
buffer_atomic_add v17, off, s[84:87], s10 sc1
s_mov_b64 exec, -1
L_sig_kv:
v_mfma_f32_16x16x32_bf16 v[24:27], a[40:43], a[20:23], v[24:27]
s_add_u32 m0, s17, 0x10000
v_add_u32 v22, 0x80, v22
v_add_u32 v23, 0x80, v23
ds_read_b128 a[0:3], v8 offset:0
v_mfma_f32_16x16x32_bf16 v[56:59], a[40:43], a[24:27], v[56:59]
buffer_load_dwordx4 v5, s[52:55], 0 offen lds
v_mfma_f32_16x16x32_bf16 v[88:91], a[40:43], a[28:31], v[88:91]
ds_read_b128 a[4:7], v8 offset:2048
ds_read_b128 a[8:11], v8 offset:4096
v_mfma_f32_16x16x32_bf16 v[120:123], a[40:43], a[32:35], v[120:123]
ds_read_b128 a[12:15], v8 offset:6144
ds_read_b128 a[16:19], v10
v_mfma_f32_16x16x32_bf16 v[124:127], a[44:47], a[32:35], v[124:127]
ds_read_b64_tr_b16 a[84:85], v15 offset:4096
ds_read_b64_tr_b16 a[86:87], v15 offset:4352
v_mfma_f32_16x16x32_bf16 v[92:95], a[44:47], a[28:31], v[92:95]
ds_read_b64_tr_b16 a[88:89], v14 offset:8192
ds_read_b64_tr_b16 a[90:91], v14 offset:8448
v_mfma_f32_16x16x32_bf16 v[60:63], a[44:47], a[24:27], v[60:63]
s_add_u32 m0, s17, 0x10400
ds_read_b64_tr_b16 a[92:93], v15 offset:8192
ds_read_b64_tr_b16 a[94:95], v15 offset:8448
v_mfma_f32_16x16x32_bf16 v[28:31], a[44:47], a[20:23], v[28:31]
buffer_load_dwordx4 v5, s[52:55], s13 offen lds
v_mfma_f32_16x16x32_bf16 v[32:35], a[48:51], a[20:23], v[32:35]
ds_read_b64_tr_b16 a[40:41], v12 offset:0
ds_read_b64_tr_b16 a[42:43], v12 offset:1024
v_mfma_f32_16x16x32_bf16 v[64:67], a[48:51], a[24:27], v[64:67]
ds_read_b64_tr_b16 a[44:45], v13 offset:0
v_mfma_f32_16x16x32_bf16 v[96:99], a[48:51], a[28:31], v[96:99]
ds_read_b64_tr_b16 a[46:47], v13 offset:1024
v_mfma_f32_16x16x32_bf16 v[128:131], a[48:51], a[32:35], v[128:131]
ds_read_b64_tr_b16 a[48:49], v12 offset:256
v_mfma_f32_16x16x32_bf16 v[132:135], a[52:55], a[32:35], v[132:135]
ds_read_b64_tr_b16 a[50:51], v12 offset:1280
v_mfma_f32_16x16x32_bf16 v[100:103], a[52:55], a[28:31], v[100:103]
s_add_u32 m0, s17, 0x10800
v_mfma_f32_16x16x32_bf16 v[68:71], a[52:55], a[24:27], v[68:71]
buffer_load_dwordx4 v6, s[52:55], 0 offen lds
v_mfma_f32_16x16x32_bf16 v[36:39], a[52:55], a[20:23], v[36:39]
ds_read_b64_tr_b16 a[52:53], v13 offset:256
v_mfma_f32_16x16x32_bf16 v[40:43], a[56:59], a[20:23], v[40:43]
ds_read_b64_tr_b16 a[54:55], v13 offset:1280
v_mfma_f32_16x16x32_bf16 v[72:75], a[56:59], a[24:27], v[72:75]
v_mfma_f32_16x16x32_bf16 v[104:107], a[56:59], a[28:31], v[104:107]
v_mfma_f32_16x16x32_bf16 v[136:139], a[56:59], a[32:35], v[136:139]
ds_read_b64_tr_b16 a[56:57], v12 offset:512
v_mfma_f32_16x16x32_bf16 v[140:143], a[60:63], a[32:35], v[140:143]
s_add_u32 m0, s17, 0x10c00
ds_read_b64_tr_b16 a[58:59], v12 offset:1536
v_mfma_f32_16x16x32_bf16 v[108:111], a[60:63], a[28:31], v[108:111]
buffer_load_dwordx4 v6, s[52:55], s13 offen lds
v_mfma_f32_16x16x32_bf16 v[76:79], a[60:63], a[24:27], v[76:79]
v_mfma_f32_16x16x32_bf16 v[44:47], a[60:63], a[20:23], v[44:47]
ds_read_b64_tr_b16 a[60:61], v13 offset:512
v_mfma_f32_16x16x32_bf16 v[48:51], a[64:67], a[20:23], v[48:51]
ds_read_b64_tr_b16 a[62:63], v13 offset:1536
v_mfma_f32_16x16x32_bf16 v[80:83], a[64:67], a[24:27], v[80:83]
v_mfma_f32_16x16x32_bf16 v[112:115], a[64:67], a[28:31], v[112:115]
v_mfma_f32_16x16x32_bf16 v[144:147], a[64:67], a[32:35], v[144:147]
s_add_u32 m0, s18, 0x14000
ds_read_b64_tr_b16 a[64:65], v12 offset:768
v_mfma_f32_16x16x32_bf16 v[148:151], a[68:71], a[32:35], v[148:151]
buffer_load_dwordx4 v7, s[68:71], 0 offen lds
v_mfma_f32_16x16x32_bf16 v[116:119], a[68:71], a[28:31], v[116:119]
ds_read_b64_tr_b16 a[66:67], v12 offset:1792
v_mfma_f32_16x16x32_bf16 v[84:87], a[68:71], a[24:27], v[84:87]
v_mfma_f32_16x16x32_bf16 v[52:55], a[68:71], a[20:23], v[52:55]
ds_read_b64_tr_b16 a[68:69], v13 offset:768
v_mfma_f32_16x16x32_bf16 v[152:155], a[72:75], a[20:23], v[152:155]
ds_read_b64_tr_b16 a[70:71], v13 offset:1792
v_mfma_f32_16x16x32_bf16 v[160:163], a[72:75], a[24:27], v[160:163]
v_mfma_f32_16x16x32_bf16 v[168:171], a[72:75], a[28:31], v[168:171]
s_add_u32 m0, s18, 0x15000
v_mfma_f32_16x16x32_bf16 v[176:179], a[72:75], a[32:35], v[176:179]
buffer_load_dwordx4 v7, s[68:71], s25 offen lds
v_mfma_f32_16x16x32_bf16 v[180:183], a[76:79], a[32:35], v[180:183]
ds_read_b64_tr_b16 a[72:73], v14 offset:0
v_mfma_f32_16x16x32_bf16 v[172:175], a[76:79], a[28:31], v[172:175]
ds_read_b64_tr_b16 a[74:75], v14 offset:256
v_mfma_f32_16x16x32_bf16 v[164:167], a[76:79], a[24:27], v[164:167]
v_mfma_f32_16x16x32_bf16 v[156:159], a[76:79], a[20:23], v[156:159]
ds_read_b64_tr_b16 a[76:77], v15 offset:0
v_mfma_f32_16x16x32_bf16 v[184:187], a[80:83], a[20:23], v[184:187]
ds_read_b64_tr_b16 a[78:79], v15 offset:256
v_mfma_f32_16x16x32_bf16 v[192:195], a[80:83], a[24:27], v[192:195]
s_add_u32 m0, s18, 0x16000
v_mfma_f32_16x16x32_bf16 v[200:203], a[80:83], a[28:31], v[200:203]
buffer_load_dwordx4 v7, s[68:71], s26 offen lds
v_mfma_f32_16x16x32_bf16 v[208:211], a[80:83], a[32:35], v[208:211]
v_mfma_f32_16x16x32_bf16 v[248:251], a[80:83], a[36:39], v[248:251]
ds_read_b64_tr_b16 a[80:81], v14 offset:4096
v_mfma_f32_16x16x32_bf16 v[212:215], a[104:107], a[32:35], v[212:215]
ds_read_b64_tr_b16 a[82:83], v14 offset:4352
v_mfma_f32_16x16x32_bf16 v[204:207], a[104:107], a[28:31], v[204:207]
v_mfma_f32_16x16x32_bf16 v[196:199], a[104:107], a[24:27], v[196:199]
v_mfma_f32_16x16x32_bf16 v[188:191], a[104:107], a[20:23], v[188:191]
s_add_u32 m0, s18, 0x17000
v_mfma_f32_16x16x32_bf16 v[216:219], a[20:23], a[108:111], v[216:219]
buffer_load_dwordx4 v4, s[44:47], s24 offen lds
v_mfma_f32_16x16x32_bf16 v[224:227], a[24:27], a[108:111], v[224:227]
v_mfma_f32_16x16x32_bf16 v[232:235], a[28:31], a[108:111], v[232:235]
v_mfma_f32_16x16x32_bf16 v[240:243], a[32:35], a[108:111], v[240:243]
v_mfma_f32_16x16x32_bf16 v[252:255], a[36:39], a[108:111], v[252:255]
v_mfma_f32_16x16x32_bf16 v[244:247], a[32:35], a[112:115], v[244:247]
v_mfma_f32_16x16x32_bf16 v[236:239], a[28:31], a[112:115], v[236:239]
v_mfma_f32_16x16x32_bf16 v[228:231], a[24:27], a[112:115], v[228:231]
v_mfma_f32_16x16x32_bf16 v[220:223], a[20:23], a[112:115], v[220:223]
s_waitcnt lgkmcnt(0)
v_mfma_f32_16x16x32_bf16 v[24:27], a[40:43], a[0:3], v[24:27]
v_add_u32 v5, 0x80000, v5
v_add_u32 v6, 0x80000, v6
ds_read_b128 a[20:23], v9 offset:0
v_mfma_f32_16x16x32_bf16 v[56:59], a[40:43], a[4:7], v[56:59]
v_add_u32 v7, 0x60000, v7
v_add_u32 v4, 0x80, v4
ds_read_b128 a[24:27], v9 offset:2048
v_mfma_f32_16x16x32_bf16 v[88:91], a[40:43], a[8:11], v[88:91]
ds_read_b128 a[28:31], v9 offset:4096
ds_read_b128 a[32:35], v9 offset:6144
v_mfma_f32_16x16x32_bf16 v[120:123], a[40:43], a[12:15], v[120:123]
ds_read_b128 a[36:39], v11
ds_read_b64_tr_b16 a[104:105], v15 offset:6144
v_mfma_f32_16x16x32_bf16 v[124:127], a[44:47], a[12:15], v[124:127]
ds_read_b64_tr_b16 a[106:107], v15 offset:6400
ds_read_b64_tr_b16 a[108:109], v14 offset:10240
v_mfma_f32_16x16x32_bf16 v[92:95], a[44:47], a[8:11], v[92:95]
ds_read_b64_tr_b16 a[110:111], v14 offset:10496
ds_read_b64_tr_b16 a[112:113], v15 offset:10240
v_mfma_f32_16x16x32_bf16 v[60:63], a[44:47], a[4:7], v[60:63]
ds_read_b64_tr_b16 a[114:115], v15 offset:10496
v_mfma_f32_16x16x32_bf16 v[28:31], a[44:47], a[0:3], v[28:31]
ds_read_b64_tr_b16 a[40:41], v12 offset:8192
ds_read_b64_tr_b16 a[42:43], v12 offset:9216
v_mfma_f32_16x16x32_bf16 v[32:35], a[48:51], a[0:3], v[32:35]
ds_read_b64_tr_b16 a[44:45], v13 offset:8192
v_mfma_f32_16x16x32_bf16 v[64:67], a[48:51], a[4:7], v[64:67]
s_add_u32 m0, s16, 0x0
ds_read_b64_tr_b16 a[46:47], v13 offset:9216
s_waitcnt lgkmcnt(11)
v_mfma_f32_16x16x32_bf16 v[96:99], a[48:51], a[8:11], v[96:99]
buffer_load_dwordx4 v22, s[44:47], s20 offen lds
v_mfma_f32_16x16x32_bf16 v[128:131], a[48:51], a[12:15], v[128:131]
ds_read_b64_tr_b16 a[48:49], v12 offset:8448
v_mfma_f32_16x16x32_bf16 v[132:135], a[52:55], a[12:15], v[132:135]
ds_read_b64_tr_b16 a[50:51], v12 offset:9472
v_mfma_f32_16x16x32_bf16 v[100:103], a[52:55], a[8:11], v[100:103]
v_mfma_f32_16x16x32_bf16 v[68:71], a[52:55], a[4:7], v[68:71]
s_add_u32 m0, s16, 0x400
v_mfma_f32_16x16x32_bf16 v[36:39], a[52:55], a[0:3], v[36:39]
buffer_load_dwordx4 v23, s[44:47], s20 offen lds
v_mfma_f32_16x16x32_bf16 v[40:43], a[56:59], a[0:3], v[40:43]
ds_read_b64_tr_b16 a[52:53], v13 offset:8448
v_mfma_f32_16x16x32_bf16 v[72:75], a[56:59], a[4:7], v[72:75]
ds_read_b64_tr_b16 a[54:55], v13 offset:9472
v_mfma_f32_16x16x32_bf16 v[104:107], a[56:59], a[8:11], v[104:107]
v_mfma_f32_16x16x32_bf16 v[136:139], a[56:59], a[12:15], v[136:139]
ds_read_b64_tr_b16 a[56:57], v12 offset:8704
v_mfma_f32_16x16x32_bf16 v[140:143], a[60:63], a[12:15], v[140:143]
s_add_u32 m0, s16, 0x800
ds_read_b64_tr_b16 a[58:59], v12 offset:9728
v_mfma_f32_16x16x32_bf16 v[108:111], a[60:63], a[8:11], v[108:111]
buffer_load_dwordx4 v22, s[44:47], s21 offen lds
v_mfma_f32_16x16x32_bf16 v[76:79], a[60:63], a[4:7], v[76:79]
v_mfma_f32_16x16x32_bf16 v[44:47], a[60:63], a[0:3], v[44:47]
ds_read_b64_tr_b16 a[60:61], v13 offset:8704
v_mfma_f32_16x16x32_bf16 v[48:51], a[64:67], a[0:3], v[48:51]
ds_read_b64_tr_b16 a[62:63], v13 offset:9728
v_mfma_f32_16x16x32_bf16 v[80:83], a[64:67], a[4:7], v[80:83]
v_mfma_f32_16x16x32_bf16 v[112:115], a[64:67], a[8:11], v[112:115]
s_add_u32 m0, s16, 0xc00
v_mfma_f32_16x16x32_bf16 v[144:147], a[64:67], a[12:15], v[144:147]
buffer_load_dwordx4 v23, s[44:47], s21 offen lds
v_mfma_f32_16x16x32_bf16 v[148:151], a[68:71], a[12:15], v[148:151]
ds_read_b64_tr_b16 a[64:65], v12 offset:8960
v_mfma_f32_16x16x32_bf16 v[116:119], a[68:71], a[8:11], v[116:119]
ds_read_b64_tr_b16 a[66:67], v12 offset:9984
v_mfma_f32_16x16x32_bf16 v[84:87], a[68:71], a[4:7], v[84:87]
v_mfma_f32_16x16x32_bf16 v[52:55], a[68:71], a[0:3], v[52:55]
ds_read_b64_tr_b16 a[68:69], v13 offset:8960
v_mfma_f32_16x16x32_bf16 v[152:155], a[72:75], a[0:3], v[152:155]
s_add_u32 m0, s16, 0x1000
ds_read_b64_tr_b16 a[70:71], v13 offset:9984
v_mfma_f32_16x16x32_bf16 v[160:163], a[72:75], a[4:7], v[160:163]
buffer_load_dwordx4 v22, s[44:47], s22 offen lds
v_mfma_f32_16x16x32_bf16 v[168:171], a[72:75], a[8:11], v[168:171]
v_mfma_f32_16x16x32_bf16 v[176:179], a[72:75], a[12:15], v[176:179]
ds_read_b64_tr_b16 a[72:73], v14 offset:2048
v_mfma_f32_16x16x32_bf16 v[180:183], a[76:79], a[12:15], v[180:183]
ds_read_b64_tr_b16 a[74:75], v14 offset:2304
v_mfma_f32_16x16x32_bf16 v[172:175], a[76:79], a[8:11], v[172:175]
s_add_u32 m0, s16, 0x1400
v_mfma_f32_16x16x32_bf16 v[164:167], a[76:79], a[4:7], v[164:167]
buffer_load_dwordx4 v23, s[44:47], s22 offen lds
v_mfma_f32_16x16x32_bf16 v[156:159], a[76:79], a[0:3], v[156:159]
ds_read_b64_tr_b16 a[76:77], v15 offset:2048
v_mfma_f32_16x16x32_bf16 v[184:187], a[80:83], a[0:3], v[184:187]
ds_read_b64_tr_b16 a[78:79], v15 offset:2304
v_mfma_f32_16x16x32_bf16 v[192:195], a[80:83], a[4:7], v[192:195]
v_mfma_f32_16x16x32_bf16 v[200:203], a[80:83], a[8:11], v[200:203]
v_mfma_f32_16x16x32_bf16 v[208:211], a[80:83], a[12:15], v[208:211]
s_add_u32 m0, s16, 0x1800
v_mfma_f32_16x16x32_bf16 v[248:251], a[80:83], a[16:19], v[248:251]
buffer_load_dwordx4 v22, s[44:47], s23 offen lds
v_mfma_f32_16x16x32_bf16 v[212:215], a[84:87], a[12:15], v[212:215]
ds_read_b64_tr_b16 a[80:81], v14 offset:6144
v_mfma_f32_16x16x32_bf16 v[204:207], a[84:87], a[8:11], v[204:207]
ds_read_b64_tr_b16 a[82:83], v14 offset:6400
v_mfma_f32_16x16x32_bf16 v[196:199], a[84:87], a[4:7], v[196:199]
v_mfma_f32_16x16x32_bf16 v[188:191], a[84:87], a[0:3], v[188:191]
v_mfma_f32_16x16x32_bf16 v[216:219], a[0:3], a[88:91], v[216:219]
s_add_u32 m0, s16, 0x1c00
v_mfma_f32_16x16x32_bf16 v[224:227], a[4:7], a[88:91], v[224:227]
buffer_load_dwordx4 v23, s[44:47], s23 offen lds
v_mfma_f32_16x16x32_bf16 v[232:235], a[8:11], a[88:91], v[232:235]
v_mfma_f32_16x16x32_bf16 v[240:243], a[12:15], a[88:91], v[240:243]
v_mfma_f32_16x16x32_bf16 v[252:255], a[16:19], a[88:91], v[252:255]
v_mfma_f32_16x16x32_bf16 v[244:247], a[12:15], a[92:95], v[244:247]
v_mfma_f32_16x16x32_bf16 v[236:239], a[8:11], a[92:95], v[236:239]
v_add_u32 v12, 0x8000, v12
v_add_u32 v13, 0x8000, v13
v_mfma_f32_16x16x32_bf16 v[228:231], a[4:7], a[92:95], v[228:231]
v_add_u32 v14, 0x8000, v14
v_add_u32 v15, 0x8000, v15
v_mfma_f32_16x16x32_bf16 v[220:223], a[0:3], a[92:95], v[220:223]
v_add_u32 v10, 0x8000, v10
v_add_u32 v11, 0x8000, v11
s_waitcnt vmcnt(16) lgkmcnt(0)
s_barrier
v_mfma_f32_16x16x32_bf16 v[24:27], a[40:43], a[20:23], v[24:27]
s_add_u32 m0, s17, 0x0
v_add_u32 v22, 0x80, v22
v_add_u32 v23, 0x80, v23
ds_read_b128 a[0:3], v8 offset:32768
v_mfma_f32_16x16x32_bf16 v[56:59], a[40:43], a[24:27], v[56:59]
buffer_load_dwordx4 v5, s[52:55], 0 offen lds
v_mfma_f32_16x16x32_bf16 v[88:91], a[40:43], a[28:31], v[88:91]
ds_read_b128 a[4:7], v8 offset:34816
ds_read_b128 a[8:11], v8 offset:36864
v_mfma_f32_16x16x32_bf16 v[120:123], a[40:43], a[32:35], v[120:123]
ds_read_b128 a[12:15], v8 offset:38912
ds_read_b128 a[16:19], v10
v_mfma_f32_16x16x32_bf16 v[124:127], a[44:47], a[32:35], v[124:127]
ds_read_b64_tr_b16 a[84:85], v15 offset:4096
ds_read_b64_tr_b16 a[86:87], v15 offset:4352
v_mfma_f32_16x16x32_bf16 v[92:95], a[44:47], a[28:31], v[92:95]
ds_read_b64_tr_b16 a[88:89], v14 offset:8192
ds_read_b64_tr_b16 a[90:91], v14 offset:8448
v_mfma_f32_16x16x32_bf16 v[60:63], a[44:47], a[24:27], v[60:63]
s_add_u32 m0, s17, 0x400
ds_read_b64_tr_b16 a[92:93], v15 offset:8192
ds_read_b64_tr_b16 a[94:95], v15 offset:8448
v_mfma_f32_16x16x32_bf16 v[28:31], a[44:47], a[20:23], v[28:31]
buffer_load_dwordx4 v5, s[52:55], s13 offen lds
v_mfma_f32_16x16x32_bf16 v[32:35], a[48:51], a[20:23], v[32:35]
ds_read_b64_tr_b16 a[40:41], v12 offset:0
ds_read_b64_tr_b16 a[42:43], v12 offset:1024
v_mfma_f32_16x16x32_bf16 v[64:67], a[48:51], a[24:27], v[64:67]
ds_read_b64_tr_b16 a[44:45], v13 offset:0
v_mfma_f32_16x16x32_bf16 v[96:99], a[48:51], a[28:31], v[96:99]
ds_read_b64_tr_b16 a[46:47], v13 offset:1024
v_mfma_f32_16x16x32_bf16 v[128:131], a[48:51], a[32:35], v[128:131]
ds_read_b64_tr_b16 a[48:49], v12 offset:256
v_mfma_f32_16x16x32_bf16 v[132:135], a[52:55], a[32:35], v[132:135]
ds_read_b64_tr_b16 a[50:51], v12 offset:1280
v_mfma_f32_16x16x32_bf16 v[100:103], a[52:55], a[28:31], v[100:103]
s_add_u32 m0, s17, 0x800
v_mfma_f32_16x16x32_bf16 v[68:71], a[52:55], a[24:27], v[68:71]
buffer_load_dwordx4 v6, s[52:55], 0 offen lds
v_mfma_f32_16x16x32_bf16 v[36:39], a[52:55], a[20:23], v[36:39]
ds_read_b64_tr_b16 a[52:53], v13 offset:256
v_mfma_f32_16x16x32_bf16 v[40:43], a[56:59], a[20:23], v[40:43]
ds_read_b64_tr_b16 a[54:55], v13 offset:1280
v_mfma_f32_16x16x32_bf16 v[72:75], a[56:59], a[24:27], v[72:75]
v_mfma_f32_16x16x32_bf16 v[104:107], a[56:59], a[28:31], v[104:107]
v_mfma_f32_16x16x32_bf16 v[136:139], a[56:59], a[32:35], v[136:139]
ds_read_b64_tr_b16 a[56:57], v12 offset:512
v_mfma_f32_16x16x32_bf16 v[140:143], a[60:63], a[32:35], v[140:143]
s_add_u32 m0, s17, 0xc00
ds_read_b64_tr_b16 a[58:59], v12 offset:1536
v_mfma_f32_16x16x32_bf16 v[108:111], a[60:63], a[28:31], v[108:111]
buffer_load_dwordx4 v6, s[52:55], s13 offen lds
v_mfma_f32_16x16x32_bf16 v[76:79], a[60:63], a[24:27], v[76:79]
v_mfma_f32_16x16x32_bf16 v[44:47], a[60:63], a[20:23], v[44:47]
ds_read_b64_tr_b16 a[60:61], v13 offset:512
v_mfma_f32_16x16x32_bf16 v[48:51], a[64:67], a[20:23], v[48:51]
ds_read_b64_tr_b16 a[62:63], v13 offset:1536
v_mfma_f32_16x16x32_bf16 v[80:83], a[64:67], a[24:27], v[80:83]
v_mfma_f32_16x16x32_bf16 v[112:115], a[64:67], a[28:31], v[112:115]
v_mfma_f32_16x16x32_bf16 v[144:147], a[64:67], a[32:35], v[144:147]
s_add_u32 m0, s18, 0x4000
ds_read_b64_tr_b16 a[64:65], v12 offset:768
v_mfma_f32_16x16x32_bf16 v[148:151], a[68:71], a[32:35], v[148:151]
buffer_load_dwordx4 v7, s[68:71], 0 offen lds
v_mfma_f32_16x16x32_bf16 v[116:119], a[68:71], a[28:31], v[116:119]
ds_read_b64_tr_b16 a[66:67], v12 offset:1792
v_mfma_f32_16x16x32_bf16 v[84:87], a[68:71], a[24:27], v[84:87]
v_mfma_f32_16x16x32_bf16 v[52:55], a[68:71], a[20:23], v[52:55]
ds_read_b64_tr_b16 a[68:69], v13 offset:768
v_mfma_f32_16x16x32_bf16 v[152:155], a[72:75], a[20:23], v[152:155]
ds_read_b64_tr_b16 a[70:71], v13 offset:1792
v_mfma_f32_16x16x32_bf16 v[160:163], a[72:75], a[24:27], v[160:163]
v_mfma_f32_16x16x32_bf16 v[168:171], a[72:75], a[28:31], v[168:171]
s_add_u32 m0, s18, 0x5000
v_mfma_f32_16x16x32_bf16 v[176:179], a[72:75], a[32:35], v[176:179]
buffer_load_dwordx4 v7, s[68:71], s25 offen lds
v_mfma_f32_16x16x32_bf16 v[180:183], a[76:79], a[32:35], v[180:183]
ds_read_b64_tr_b16 a[72:73], v14 offset:0
v_mfma_f32_16x16x32_bf16 v[172:175], a[76:79], a[28:31], v[172:175]
ds_read_b64_tr_b16 a[74:75], v14 offset:256
v_mfma_f32_16x16x32_bf16 v[164:167], a[76:79], a[24:27], v[164:167]
v_mfma_f32_16x16x32_bf16 v[156:159], a[76:79], a[20:23], v[156:159]
ds_read_b64_tr_b16 a[76:77], v15 offset:0
v_mfma_f32_16x16x32_bf16 v[184:187], a[80:83], a[20:23], v[184:187]
ds_read_b64_tr_b16 a[78:79], v15 offset:256
v_mfma_f32_16x16x32_bf16 v[192:195], a[80:83], a[24:27], v[192:195]
s_add_u32 m0, s18, 0x6000
v_mfma_f32_16x16x32_bf16 v[200:203], a[80:83], a[28:31], v[200:203]
buffer_load_dwordx4 v7, s[68:71], s26 offen lds
v_mfma_f32_16x16x32_bf16 v[208:211], a[80:83], a[32:35], v[208:211]
v_mfma_f32_16x16x32_bf16 v[248:251], a[80:83], a[36:39], v[248:251]
ds_read_b64_tr_b16 a[80:81], v14 offset:4096
v_mfma_f32_16x16x32_bf16 v[212:215], a[104:107], a[32:35], v[212:215]
ds_read_b64_tr_b16 a[82:83], v14 offset:4352
v_mfma_f32_16x16x32_bf16 v[204:207], a[104:107], a[28:31], v[204:207]
v_mfma_f32_16x16x32_bf16 v[196:199], a[104:107], a[24:27], v[196:199]
v_mfma_f32_16x16x32_bf16 v[188:191], a[104:107], a[20:23], v[188:191]
s_add_u32 m0, s18, 0x7000
v_mfma_f32_16x16x32_bf16 v[216:219], a[20:23], a[108:111], v[216:219]
buffer_load_dwordx4 v4, s[44:47], s24 offen lds
v_mfma_f32_16x16x32_bf16 v[224:227], a[24:27], a[108:111], v[224:227]
v_mfma_f32_16x16x32_bf16 v[232:235], a[28:31], a[108:111], v[232:235]
v_mfma_f32_16x16x32_bf16 v[240:243], a[32:35], a[108:111], v[240:243]
v_mfma_f32_16x16x32_bf16 v[252:255], a[36:39], a[108:111], v[252:255]
v_mfma_f32_16x16x32_bf16 v[244:247], a[32:35], a[112:115], v[244:247]
v_mfma_f32_16x16x32_bf16 v[236:239], a[28:31], a[112:115], v[236:239]
v_mfma_f32_16x16x32_bf16 v[228:231], a[24:27], a[112:115], v[228:231]
v_mfma_f32_16x16x32_bf16 v[220:223], a[20:23], a[112:115], v[220:223]
s_waitcnt lgkmcnt(0)
v_mfma_f32_16x16x32_bf16 v[24:27], a[40:43], a[0:3], v[24:27]
v_add_u32 v5, 0x80000, v5
v_add_u32 v6, 0x80000, v6
ds_read_b128 a[20:23], v9 offset:32768
v_mfma_f32_16x16x32_bf16 v[56:59], a[40:43], a[4:7], v[56:59]
v_add_u32 v7, 0x60000, v7
v_add_u32 v4, 0x80, v4
ds_read_b128 a[24:27], v9 offset:34816
v_mfma_f32_16x16x32_bf16 v[88:91], a[40:43], a[8:11], v[88:91]
ds_read_b128 a[28:31], v9 offset:36864
ds_read_b128 a[32:35], v9 offset:38912
v_mfma_f32_16x16x32_bf16 v[120:123], a[40:43], a[12:15], v[120:123]
ds_read_b128 a[36:39], v11
ds_read_b64_tr_b16 a[104:105], v15 offset:6144
v_mfma_f32_16x16x32_bf16 v[124:127], a[44:47], a[12:15], v[124:127]
ds_read_b64_tr_b16 a[106:107], v15 offset:6400
ds_read_b64_tr_b16 a[108:109], v14 offset:10240
v_mfma_f32_16x16x32_bf16 v[92:95], a[44:47], a[8:11], v[92:95]
ds_read_b64_tr_b16 a[110:111], v14 offset:10496
ds_read_b64_tr_b16 a[112:113], v15 offset:10240
v_mfma_f32_16x16x32_bf16 v[60:63], a[44:47], a[4:7], v[60:63]
ds_read_b64_tr_b16 a[114:115], v15 offset:10496
v_mfma_f32_16x16x32_bf16 v[28:31], a[44:47], a[0:3], v[28:31]
ds_read_b64_tr_b16 a[40:41], v12 offset:8192
ds_read_b64_tr_b16 a[42:43], v12 offset:9216
v_mfma_f32_16x16x32_bf16 v[32:35], a[48:51], a[0:3], v[32:35]
ds_read_b64_tr_b16 a[44:45], v13 offset:8192
v_mfma_f32_16x16x32_bf16 v[64:67], a[48:51], a[4:7], v[64:67]
s_add_u32 m0, s16, 0x8000
ds_read_b64_tr_b16 a[46:47], v13 offset:9216
s_waitcnt lgkmcnt(11)
v_mfma_f32_16x16x32_bf16 v[96:99], a[48:51], a[8:11], v[96:99]
buffer_load_dwordx4 v22, s[44:47], s20 offen lds
v_mfma_f32_16x16x32_bf16 v[128:131], a[48:51], a[12:15], v[128:131]
ds_read_b64_tr_b16 a[48:49], v12 offset:8448
v_mfma_f32_16x16x32_bf16 v[132:135], a[52:55], a[12:15], v[132:135]
ds_read_b64_tr_b16 a[50:51], v12 offset:9472
v_mfma_f32_16x16x32_bf16 v[100:103], a[52:55], a[8:11], v[100:103]
v_mfma_f32_16x16x32_bf16 v[68:71], a[52:55], a[4:7], v[68:71]
s_add_u32 m0, s16, 0x8400
v_mfma_f32_16x16x32_bf16 v[36:39], a[52:55], a[0:3], v[36:39]
buffer_load_dwordx4 v23, s[44:47], s20 offen lds
v_mfma_f32_16x16x32_bf16 v[40:43], a[56:59], a[0:3], v[40:43]
ds_read_b64_tr_b16 a[52:53], v13 offset:8448
v_mfma_f32_16x16x32_bf16 v[72:75], a[56:59], a[4:7], v[72:75]
ds_read_b64_tr_b16 a[54:55], v13 offset:9472
v_mfma_f32_16x16x32_bf16 v[104:107], a[56:59], a[8:11], v[104:107]
v_mfma_f32_16x16x32_bf16 v[136:139], a[56:59], a[12:15], v[136:139]
ds_read_b64_tr_b16 a[56:57], v12 offset:8704
v_mfma_f32_16x16x32_bf16 v[140:143], a[60:63], a[12:15], v[140:143]
s_add_u32 m0, s16, 0x8800
ds_read_b64_tr_b16 a[58:59], v12 offset:9728
v_mfma_f32_16x16x32_bf16 v[108:111], a[60:63], a[8:11], v[108:111]
buffer_load_dwordx4 v22, s[44:47], s21 offen lds
v_mfma_f32_16x16x32_bf16 v[76:79], a[60:63], a[4:7], v[76:79]
v_mfma_f32_16x16x32_bf16 v[44:47], a[60:63], a[0:3], v[44:47]
ds_read_b64_tr_b16 a[60:61], v13 offset:8704
v_mfma_f32_16x16x32_bf16 v[48:51], a[64:67], a[0:3], v[48:51]
ds_read_b64_tr_b16 a[62:63], v13 offset:9728
v_mfma_f32_16x16x32_bf16 v[80:83], a[64:67], a[4:7], v[80:83]
v_mfma_f32_16x16x32_bf16 v[112:115], a[64:67], a[8:11], v[112:115]
s_add_u32 m0, s16, 0x8c00
v_mfma_f32_16x16x32_bf16 v[144:147], a[64:67], a[12:15], v[144:147]
buffer_load_dwordx4 v23, s[44:47], s21 offen lds
v_mfma_f32_16x16x32_bf16 v[148:151], a[68:71], a[12:15], v[148:151]
ds_read_b64_tr_b16 a[64:65], v12 offset:8960
v_mfma_f32_16x16x32_bf16 v[116:119], a[68:71], a[8:11], v[116:119]
ds_read_b64_tr_b16 a[66:67], v12 offset:9984
v_mfma_f32_16x16x32_bf16 v[84:87], a[68:71], a[4:7], v[84:87]
v_mfma_f32_16x16x32_bf16 v[52:55], a[68:71], a[0:3], v[52:55]
ds_read_b64_tr_b16 a[68:69], v13 offset:8960
v_mfma_f32_16x16x32_bf16 v[152:155], a[72:75], a[0:3], v[152:155]
s_add_u32 m0, s16, 0x9000
ds_read_b64_tr_b16 a[70:71], v13 offset:9984
v_mfma_f32_16x16x32_bf16 v[160:163], a[72:75], a[4:7], v[160:163]
buffer_load_dwordx4 v22, s[44:47], s22 offen lds
v_mfma_f32_16x16x32_bf16 v[168:171], a[72:75], a[8:11], v[168:171]
v_mfma_f32_16x16x32_bf16 v[176:179], a[72:75], a[12:15], v[176:179]
ds_read_b64_tr_b16 a[72:73], v14 offset:2048
v_mfma_f32_16x16x32_bf16 v[180:183], a[76:79], a[12:15], v[180:183]
ds_read_b64_tr_b16 a[74:75], v14 offset:2304
v_mfma_f32_16x16x32_bf16 v[172:175], a[76:79], a[8:11], v[172:175]
s_add_u32 m0, s16, 0x9400
v_mfma_f32_16x16x32_bf16 v[164:167], a[76:79], a[4:7], v[164:167]
buffer_load_dwordx4 v23, s[44:47], s22 offen lds
v_mfma_f32_16x16x32_bf16 v[156:159], a[76:79], a[0:3], v[156:159]
ds_read_b64_tr_b16 a[76:77], v15 offset:2048
v_mfma_f32_16x16x32_bf16 v[184:187], a[80:83], a[0:3], v[184:187]
ds_read_b64_tr_b16 a[78:79], v15 offset:2304
v_mfma_f32_16x16x32_bf16 v[192:195], a[80:83], a[4:7], v[192:195]
v_mfma_f32_16x16x32_bf16 v[200:203], a[80:83], a[8:11], v[200:203]
v_mfma_f32_16x16x32_bf16 v[208:211], a[80:83], a[12:15], v[208:211]
s_add_u32 m0, s16, 0x9800
v_mfma_f32_16x16x32_bf16 v[248:251], a[80:83], a[16:19], v[248:251]
buffer_load_dwordx4 v22, s[44:47], s23 offen lds
v_mfma_f32_16x16x32_bf16 v[212:215], a[84:87], a[12:15], v[212:215]
ds_read_b64_tr_b16 a[80:81], v14 offset:6144
v_mfma_f32_16x16x32_bf16 v[204:207], a[84:87], a[8:11], v[204:207]
ds_read_b64_tr_b16 a[82:83], v14 offset:6400
v_mfma_f32_16x16x32_bf16 v[196:199], a[84:87], a[4:7], v[196:199]
v_mfma_f32_16x16x32_bf16 v[188:191], a[84:87], a[0:3], v[188:191]
v_mfma_f32_16x16x32_bf16 v[216:219], a[0:3], a[88:91], v[216:219]
s_add_u32 m0, s16, 0x9c00
v_mfma_f32_16x16x32_bf16 v[224:227], a[4:7], a[88:91], v[224:227]
buffer_load_dwordx4 v23, s[44:47], s23 offen lds
v_mfma_f32_16x16x32_bf16 v[232:235], a[8:11], a[88:91], v[232:235]
v_mfma_f32_16x16x32_bf16 v[240:243], a[12:15], a[88:91], v[240:243]
v_mfma_f32_16x16x32_bf16 v[252:255], a[16:19], a[88:91], v[252:255]
v_mfma_f32_16x16x32_bf16 v[244:247], a[12:15], a[92:95], v[244:247]
v_mfma_f32_16x16x32_bf16 v[236:239], a[8:11], a[92:95], v[236:239]
v_add_u32 v12, 0x8000, v12
v_add_u32 v13, 0x8000, v13
v_mfma_f32_16x16x32_bf16 v[228:231], a[4:7], a[92:95], v[228:231]
v_add_u32 v14, 0x8000, v14
v_add_u32 v15, 0x8000, v15
v_mfma_f32_16x16x32_bf16 v[220:223], a[0:3], a[92:95], v[220:223]
v_add_u32 v10, 0x8000, v10
v_add_u32 v11, 0x8000, v11
s_waitcnt vmcnt(16) lgkmcnt(0)
s_barrier
v_mfma_f32_16x16x32_bf16 v[24:27], a[40:43], a[20:23], v[24:27]
s_add_u32 m0, s17, 0x8000
v_add_u32 v22, 0x80, v22
v_add_u32 v23, 0x80, v23
ds_read_b128 a[0:3], v8 offset:0
v_mfma_f32_16x16x32_bf16 v[56:59], a[40:43], a[24:27], v[56:59]
buffer_load_dwordx4 v5, s[52:55], 0 offen lds
v_mfma_f32_16x16x32_bf16 v[88:91], a[40:43], a[28:31], v[88:91]
ds_read_b128 a[4:7], v8 offset:2048
ds_read_b128 a[8:11], v8 offset:4096
v_mfma_f32_16x16x32_bf16 v[120:123], a[40:43], a[32:35], v[120:123]
ds_read_b128 a[12:15], v8 offset:6144
ds_read_b128 a[16:19], v10
v_mfma_f32_16x16x32_bf16 v[124:127], a[44:47], a[32:35], v[124:127]
ds_read_b64_tr_b16 a[84:85], v15 offset:4096
ds_read_b64_tr_b16 a[86:87], v15 offset:4352
v_mfma_f32_16x16x32_bf16 v[92:95], a[44:47], a[28:31], v[92:95]
ds_read_b64_tr_b16 a[88:89], v14 offset:8192
ds_read_b64_tr_b16 a[90:91], v14 offset:8448
v_mfma_f32_16x16x32_bf16 v[60:63], a[44:47], a[24:27], v[60:63]
s_add_u32 m0, s17, 0x8400
ds_read_b64_tr_b16 a[92:93], v15 offset:8192
ds_read_b64_tr_b16 a[94:95], v15 offset:8448
v_mfma_f32_16x16x32_bf16 v[28:31], a[44:47], a[20:23], v[28:31]
buffer_load_dwordx4 v5, s[52:55], s13 offen lds
v_mfma_f32_16x16x32_bf16 v[32:35], a[48:51], a[20:23], v[32:35]
ds_read_b64_tr_b16 a[40:41], v12 offset:0
ds_read_b64_tr_b16 a[42:43], v12 offset:1024
v_mfma_f32_16x16x32_bf16 v[64:67], a[48:51], a[24:27], v[64:67]
ds_read_b64_tr_b16 a[44:45], v13 offset:0
v_mfma_f32_16x16x32_bf16 v[96:99], a[48:51], a[28:31], v[96:99]
ds_read_b64_tr_b16 a[46:47], v13 offset:1024
v_mfma_f32_16x16x32_bf16 v[128:131], a[48:51], a[32:35], v[128:131]
ds_read_b64_tr_b16 a[48:49], v12 offset:256
v_mfma_f32_16x16x32_bf16 v[132:135], a[52:55], a[32:35], v[132:135]
ds_read_b64_tr_b16 a[50:51], v12 offset:1280
v_mfma_f32_16x16x32_bf16 v[100:103], a[52:55], a[28:31], v[100:103]
s_add_u32 m0, s17, 0x8800
v_mfma_f32_16x16x32_bf16 v[68:71], a[52:55], a[24:27], v[68:71]
buffer_load_dwordx4 v6, s[52:55], 0 offen lds
v_mfma_f32_16x16x32_bf16 v[36:39], a[52:55], a[20:23], v[36:39]
ds_read_b64_tr_b16 a[52:53], v13 offset:256
v_mfma_f32_16x16x32_bf16 v[40:43], a[56:59], a[20:23], v[40:43]
ds_read_b64_tr_b16 a[54:55], v13 offset:1280
v_mfma_f32_16x16x32_bf16 v[72:75], a[56:59], a[24:27], v[72:75]
v_mfma_f32_16x16x32_bf16 v[104:107], a[56:59], a[28:31], v[104:107]
v_mfma_f32_16x16x32_bf16 v[136:139], a[56:59], a[32:35], v[136:139]
ds_read_b64_tr_b16 a[56:57], v12 offset:512
v_mfma_f32_16x16x32_bf16 v[140:143], a[60:63], a[32:35], v[140:143]
s_add_u32 m0, s17, 0x8c00
ds_read_b64_tr_b16 a[58:59], v12 offset:1536
v_mfma_f32_16x16x32_bf16 v[108:111], a[60:63], a[28:31], v[108:111]
buffer_load_dwordx4 v6, s[52:55], s13 offen lds
v_mfma_f32_16x16x32_bf16 v[76:79], a[60:63], a[24:27], v[76:79]
v_mfma_f32_16x16x32_bf16 v[44:47], a[60:63], a[20:23], v[44:47]
ds_read_b64_tr_b16 a[60:61], v13 offset:512
v_mfma_f32_16x16x32_bf16 v[48:51], a[64:67], a[20:23], v[48:51]
ds_read_b64_tr_b16 a[62:63], v13 offset:1536
v_mfma_f32_16x16x32_bf16 v[80:83], a[64:67], a[24:27], v[80:83]
v_mfma_f32_16x16x32_bf16 v[112:115], a[64:67], a[28:31], v[112:115]
v_mfma_f32_16x16x32_bf16 v[144:147], a[64:67], a[32:35], v[144:147]
s_add_u32 m0, s18, 0xc000
ds_read_b64_tr_b16 a[64:65], v12 offset:768
v_mfma_f32_16x16x32_bf16 v[148:151], a[68:71], a[32:35], v[148:151]
buffer_load_dwordx4 v7, s[68:71], 0 offen lds
v_mfma_f32_16x16x32_bf16 v[116:119], a[68:71], a[28:31], v[116:119]
ds_read_b64_tr_b16 a[66:67], v12 offset:1792
v_mfma_f32_16x16x32_bf16 v[84:87], a[68:71], a[24:27], v[84:87]
v_mfma_f32_16x16x32_bf16 v[52:55], a[68:71], a[20:23], v[52:55]
ds_read_b64_tr_b16 a[68:69], v13 offset:768
v_mfma_f32_16x16x32_bf16 v[152:155], a[72:75], a[20:23], v[152:155]
ds_read_b64_tr_b16 a[70:71], v13 offset:1792
v_mfma_f32_16x16x32_bf16 v[160:163], a[72:75], a[24:27], v[160:163]
v_mfma_f32_16x16x32_bf16 v[168:171], a[72:75], a[28:31], v[168:171]
s_add_u32 m0, s18, 0xd000
v_mfma_f32_16x16x32_bf16 v[176:179], a[72:75], a[32:35], v[176:179]
buffer_load_dwordx4 v7, s[68:71], s25 offen lds
v_mfma_f32_16x16x32_bf16 v[180:183], a[76:79], a[32:35], v[180:183]
ds_read_b64_tr_b16 a[72:73], v14 offset:0
v_mfma_f32_16x16x32_bf16 v[172:175], a[76:79], a[28:31], v[172:175]
ds_read_b64_tr_b16 a[74:75], v14 offset:256
v_mfma_f32_16x16x32_bf16 v[164:167], a[76:79], a[24:27], v[164:167]
v_mfma_f32_16x16x32_bf16 v[156:159], a[76:79], a[20:23], v[156:159]
ds_read_b64_tr_b16 a[76:77], v15 offset:0
v_mfma_f32_16x16x32_bf16 v[184:187], a[80:83], a[20:23], v[184:187]
ds_read_b64_tr_b16 a[78:79], v15 offset:256
v_mfma_f32_16x16x32_bf16 v[192:195], a[80:83], a[24:27], v[192:195]
s_add_u32 m0, s18, 0xe000
v_mfma_f32_16x16x32_bf16 v[200:203], a[80:83], a[28:31], v[200:203]
buffer_load_dwordx4 v7, s[68:71], s26 offen lds
v_mfma_f32_16x16x32_bf16 v[208:211], a[80:83], a[32:35], v[208:211]
v_mfma_f32_16x16x32_bf16 v[248:251], a[80:83], a[36:39], v[248:251]
ds_read_b64_tr_b16 a[80:81], v14 offset:4096
v_mfma_f32_16x16x32_bf16 v[212:215], a[104:107], a[32:35], v[212:215]
ds_read_b64_tr_b16 a[82:83], v14 offset:4352
v_mfma_f32_16x16x32_bf16 v[204:207], a[104:107], a[28:31], v[204:207]
v_mfma_f32_16x16x32_bf16 v[196:199], a[104:107], a[24:27], v[196:199]
v_mfma_f32_16x16x32_bf16 v[188:191], a[104:107], a[20:23], v[188:191]
s_add_u32 m0, s18, 0xf000
v_mfma_f32_16x16x32_bf16 v[216:219], a[20:23], a[108:111], v[216:219]
buffer_load_dwordx4 v4, s[44:47], s24 offen lds
v_mfma_f32_16x16x32_bf16 v[224:227], a[24:27], a[108:111], v[224:227]
v_mfma_f32_16x16x32_bf16 v[232:235], a[28:31], a[108:111], v[232:235]
v_mfma_f32_16x16x32_bf16 v[240:243], a[32:35], a[108:111], v[240:243]
v_mfma_f32_16x16x32_bf16 v[252:255], a[36:39], a[108:111], v[252:255]
v_mfma_f32_16x16x32_bf16 v[244:247], a[32:35], a[112:115], v[244:247]
v_mfma_f32_16x16x32_bf16 v[236:239], a[28:31], a[112:115], v[236:239]
v_mfma_f32_16x16x32_bf16 v[228:231], a[24:27], a[112:115], v[228:231]
v_mfma_f32_16x16x32_bf16 v[220:223], a[20:23], a[112:115], v[220:223]
s_waitcnt lgkmcnt(0)
v_mfma_f32_16x16x32_bf16 v[24:27], a[40:43], a[0:3], v[24:27]
v_add_u32 v5, 0x80000, v5
v_add_u32 v6, 0x80000, v6
ds_read_b128 a[20:23], v9 offset:0
v_mfma_f32_16x16x32_bf16 v[56:59], a[40:43], a[4:7], v[56:59]
v_add_u32 v7, 0x60000, v7
v_add_u32 v4, 0x80, v4
ds_read_b128 a[24:27], v9 offset:2048
v_mfma_f32_16x16x32_bf16 v[88:91], a[40:43], a[8:11], v[88:91]
ds_read_b128 a[28:31], v9 offset:4096
ds_read_b128 a[32:35], v9 offset:6144
v_mfma_f32_16x16x32_bf16 v[120:123], a[40:43], a[12:15], v[120:123]
ds_read_b128 a[36:39], v11
ds_read_b64_tr_b16 a[104:105], v15 offset:6144
v_mfma_f32_16x16x32_bf16 v[124:127], a[44:47], a[12:15], v[124:127]
ds_read_b64_tr_b16 a[106:107], v15 offset:6400
ds_read_b64_tr_b16 a[108:109], v14 offset:10240
v_mfma_f32_16x16x32_bf16 v[92:95], a[44:47], a[8:11], v[92:95]
ds_read_b64_tr_b16 a[110:111], v14 offset:10496
ds_read_b64_tr_b16 a[112:113], v15 offset:10240
v_mfma_f32_16x16x32_bf16 v[60:63], a[44:47], a[4:7], v[60:63]
ds_read_b64_tr_b16 a[114:115], v15 offset:10496
v_mfma_f32_16x16x32_bf16 v[28:31], a[44:47], a[0:3], v[28:31]
ds_read_b64_tr_b16 a[40:41], v12 offset:8192
ds_read_b64_tr_b16 a[42:43], v12 offset:9216
v_mfma_f32_16x16x32_bf16 v[32:35], a[48:51], a[0:3], v[32:35]
ds_read_b64_tr_b16 a[44:45], v13 offset:8192
v_mfma_f32_16x16x32_bf16 v[64:67], a[48:51], a[4:7], v[64:67]
s_add_u32 m0, s16, 0x0
ds_read_b64_tr_b16 a[46:47], v13 offset:9216
s_waitcnt lgkmcnt(11)
v_mfma_f32_16x16x32_bf16 v[96:99], a[48:51], a[8:11], v[96:99]
buffer_load_dwordx4 v22, s[44:47], s20 offen lds
v_mfma_f32_16x16x32_bf16 v[128:131], a[48:51], a[12:15], v[128:131]
ds_read_b64_tr_b16 a[48:49], v12 offset:8448
v_mfma_f32_16x16x32_bf16 v[132:135], a[52:55], a[12:15], v[132:135]
ds_read_b64_tr_b16 a[50:51], v12 offset:9472
v_mfma_f32_16x16x32_bf16 v[100:103], a[52:55], a[8:11], v[100:103]
v_mfma_f32_16x16x32_bf16 v[68:71], a[52:55], a[4:7], v[68:71]
s_add_u32 m0, s16, 0x400
v_mfma_f32_16x16x32_bf16 v[36:39], a[52:55], a[0:3], v[36:39]
buffer_load_dwordx4 v23, s[44:47], s20 offen lds
v_mfma_f32_16x16x32_bf16 v[40:43], a[56:59], a[0:3], v[40:43]
ds_read_b64_tr_b16 a[52:53], v13 offset:8448
v_mfma_f32_16x16x32_bf16 v[72:75], a[56:59], a[4:7], v[72:75]
ds_read_b64_tr_b16 a[54:55], v13 offset:9472
v_mfma_f32_16x16x32_bf16 v[104:107], a[56:59], a[8:11], v[104:107]
v_mfma_f32_16x16x32_bf16 v[136:139], a[56:59], a[12:15], v[136:139]
s_add_u32 m0, s16, 0x800
ds_read_b64_tr_b16 a[56:57], v12 offset:8704
v_mfma_f32_16x16x32_bf16 v[140:143], a[60:63], a[12:15], v[140:143]
buffer_load_dwordx4 v22, s[44:47], s21 offen lds
v_mfma_f32_16x16x32_bf16 v[108:111], a[60:63], a[8:11], v[108:111]
ds_read_b64_tr_b16 a[58:59], v12 offset:9728
v_mfma_f32_16x16x32_bf16 v[76:79], a[60:63], a[4:7], v[76:79]
v_mfma_f32_16x16x32_bf16 v[44:47], a[60:63], a[0:3], v[44:47]
ds_read_b64_tr_b16 a[60:61], v13 offset:8704
v_mfma_f32_16x16x32_bf16 v[48:51], a[64:67], a[0:3], v[48:51]
s_add_u32 m0, s16, 0xc00
ds_read_b64_tr_b16 a[62:63], v13 offset:9728
v_mfma_f32_16x16x32_bf16 v[80:83], a[64:67], a[4:7], v[80:83]
buffer_load_dwordx4 v23, s[44:47], s21 offen lds
v_mfma_f32_16x16x32_bf16 v[112:115], a[64:67], a[8:11], v[112:115]
v_mfma_f32_16x16x32_bf16 v[144:147], a[64:67], a[12:15], v[144:147]
ds_read_b64_tr_b16 a[64:65], v12 offset:8960
v_mfma_f32_16x16x32_bf16 v[148:151], a[68:71], a[12:15], v[148:151]
ds_read_b64_tr_b16 a[66:67], v12 offset:9984
v_mfma_f32_16x16x32_bf16 v[116:119], a[68:71], a[8:11], v[116:119]
s_add_u32 m0, s16, 0x1000
v_mfma_f32_16x16x32_bf16 v[84:87], a[68:71], a[4:7], v[84:87]
buffer_load_dwordx4 v22, s[44:47], s22 offen lds
v_mfma_f32_16x16x32_bf16 v[52:55], a[68:71], a[0:3], v[52:55]
ds_read_b64_tr_b16 a[68:69], v13 offset:8960
v_mfma_f32_16x16x32_bf16 v[152:155], a[72:75], a[0:3], v[152:155]
ds_read_b64_tr_b16 a[70:71], v13 offset:9984
v_mfma_f32_16x16x32_bf16 v[160:163], a[72:75], a[4:7], v[160:163]
v_mfma_f32_16x16x32_bf16 v[168:171], a[72:75], a[8:11], v[168:171]
s_add_u32 m0, s16, 0x1400
v_mfma_f32_16x16x32_bf16 v[176:179], a[72:75], a[12:15], v[176:179]
buffer_load_dwordx4 v23, s[44:47], s22 offen lds
v_mfma_f32_16x16x32_bf16 v[180:183], a[76:79], a[12:15], v[180:183]
ds_read_b64_tr_b16 a[72:73], v14 offset:2048
v_mfma_f32_16x16x32_bf16 v[172:175], a[76:79], a[8:11], v[172:175]
ds_read_b64_tr_b16 a[74:75], v14 offset:2304
v_mfma_f32_16x16x32_bf16 v[164:167], a[76:79], a[4:7], v[164:167]
v_mfma_f32_16x16x32_bf16 v[156:159], a[76:79], a[0:3], v[156:159]
s_add_u32 m0, s16, 0x1800
ds_read_b64_tr_b16 a[76:77], v15 offset:2048
v_mfma_f32_16x16x32_bf16 v[184:187], a[80:83], a[0:3], v[184:187]
buffer_load_dwordx4 v22, s[44:47], s23 offen lds
v_mfma_f32_16x16x32_bf16 v[192:195], a[80:83], a[4:7], v[192:195]
ds_read_b64_tr_b16 a[78:79], v15 offset:2304
v_mfma_f32_16x16x32_bf16 v[200:203], a[80:83], a[8:11], v[200:203]
v_mfma_f32_16x16x32_bf16 v[208:211], a[80:83], a[12:15], v[208:211]
v_mfma_f32_16x16x32_bf16 v[248:251], a[80:83], a[16:19], v[248:251]
s_add_u32 m0, s16, 0x1c00
ds_read_b64_tr_b16 a[80:81], v14 offset:6144
v_mfma_f32_16x16x32_bf16 v[212:215], a[84:87], a[12:15], v[212:215]
buffer_load_dwordx4 v23, s[44:47], s23 offen lds
v_mfma_f32_16x16x32_bf16 v[204:207], a[84:87], a[8:11], v[204:207]
ds_read_b64_tr_b16 a[82:83], v14 offset:6400
v_mfma_f32_16x16x32_bf16 v[196:199], a[84:87], a[4:7], v[196:199]
v_mfma_f32_16x16x32_bf16 v[188:191], a[84:87], a[0:3], v[188:191]
v_mfma_f32_16x16x32_bf16 v[216:219], a[0:3], a[88:91], v[216:219]
v_mfma_f32_16x16x32_bf16 v[224:227], a[4:7], a[88:91], v[224:227]
buffer_load_dword v1, off, s[84:87], s10 sc1
v_mfma_f32_16x16x32_bf16 v[232:235], a[8:11], a[88:91], v[232:235]
v_mfma_f32_16x16x32_bf16 v[240:243], a[12:15], a[88:91], v[240:243]
v_mfma_f32_16x16x32_bf16 v[252:255], a[16:19], a[88:91], v[252:255]
v_mfma_f32_16x16x32_bf16 v[244:247], a[12:15], a[92:95], v[244:247]
v_mfma_f32_16x16x32_bf16 v[236:239], a[8:11], a[92:95], v[236:239]
v_add_u32 v12, 0xffff0000, v12
v_add_u32 v13, 0xffff0000, v13
v_mfma_f32_16x16x32_bf16 v[228:231], a[4:7], a[92:95], v[228:231]
v_add_u32 v14, 0xffff0000, v14
v_add_u32 v15, 0xffff0000, v15
v_mfma_f32_16x16x32_bf16 v[220:223], a[0:3], a[92:95], v[220:223]
v_add_u32 v10, 0xffff0000, v10
v_add_u32 v11, 0xffff0000, v11
s_waitcnt vmcnt(17) lgkmcnt(0)
s_barrier
v_mfma_f32_16x16x32_bf16 v[24:27], a[40:43], a[20:23], v[24:27]
s_add_u32 m0, s17, 0x10000
v_add_u32 v22, 0x80, v22
v_add_u32 v23, 0x80, v23
ds_read_b128 a[0:3], v8 offset:32768
v_mfma_f32_16x16x32_bf16 v[56:59], a[40:43], a[24:27], v[56:59]
buffer_load_dwordx4 v5, s[52:55], 0 offen lds
v_mfma_f32_16x16x32_bf16 v[88:91], a[40:43], a[28:31], v[88:91]
ds_read_b128 a[4:7], v8 offset:34816
ds_read_b128 a[8:11], v8 offset:36864
v_mfma_f32_16x16x32_bf16 v[120:123], a[40:43], a[32:35], v[120:123]
ds_read_b128 a[12:15], v8 offset:38912
ds_read_b128 a[16:19], v10
v_mfma_f32_16x16x32_bf16 v[124:127], a[44:47], a[32:35], v[124:127]
ds_read_b64_tr_b16 a[84:85], v15 offset:4096
ds_read_b64_tr_b16 a[86:87], v15 offset:4352
v_mfma_f32_16x16x32_bf16 v[92:95], a[44:47], a[28:31], v[92:95]
ds_read_b64_tr_b16 a[88:89], v14 offset:8192
ds_read_b64_tr_b16 a[90:91], v14 offset:8448
v_mfma_f32_16x16x32_bf16 v[60:63], a[44:47], a[24:27], v[60:63]
s_add_u32 m0, s17, 0x10400
ds_read_b64_tr_b16 a[92:93], v15 offset:8192
ds_read_b64_tr_b16 a[94:95], v15 offset:8448
v_mfma_f32_16x16x32_bf16 v[28:31], a[44:47], a[20:23], v[28:31]
buffer_load_dwordx4 v5, s[52:55], s13 offen lds
v_mfma_f32_16x16x32_bf16 v[32:35], a[48:51], a[20:23], v[32:35]
ds_read_b64_tr_b16 a[40:41], v12 offset:0
ds_read_b64_tr_b16 a[42:43], v12 offset:1024
v_mfma_f32_16x16x32_bf16 v[64:67], a[48:51], a[24:27], v[64:67]
ds_read_b64_tr_b16 a[44:45], v13 offset:0
v_mfma_f32_16x16x32_bf16 v[96:99], a[48:51], a[28:31], v[96:99]
ds_read_b64_tr_b16 a[46:47], v13 offset:1024
v_mfma_f32_16x16x32_bf16 v[128:131], a[48:51], a[32:35], v[128:131]
ds_read_b64_tr_b16 a[48:49], v12 offset:256
v_mfma_f32_16x16x32_bf16 v[132:135], a[52:55], a[32:35], v[132:135]
ds_read_b64_tr_b16 a[50:51], v12 offset:1280
v_mfma_f32_16x16x32_bf16 v[100:103], a[52:55], a[28:31], v[100:103]
s_add_u32 m0, s17, 0x10800
v_mfma_f32_16x16x32_bf16 v[68:71], a[52:55], a[24:27], v[68:71]
buffer_load_dwordx4 v6, s[52:55], 0 offen lds
v_mfma_f32_16x16x32_bf16 v[36:39], a[52:55], a[20:23], v[36:39]
ds_read_b64_tr_b16 a[52:53], v13 offset:256
v_mfma_f32_16x16x32_bf16 v[40:43], a[56:59], a[20:23], v[40:43]
ds_read_b64_tr_b16 a[54:55], v13 offset:1280
v_mfma_f32_16x16x32_bf16 v[72:75], a[56:59], a[24:27], v[72:75]
v_mfma_f32_16x16x32_bf16 v[104:107], a[56:59], a[28:31], v[104:107]
v_mfma_f32_16x16x32_bf16 v[136:139], a[56:59], a[32:35], v[136:139]
ds_read_b64_tr_b16 a[56:57], v12 offset:512
v_mfma_f32_16x16x32_bf16 v[140:143], a[60:63], a[32:35], v[140:143]
s_add_u32 m0, s17, 0x10c00
ds_read_b64_tr_b16 a[58:59], v12 offset:1536
v_mfma_f32_16x16x32_bf16 v[108:111], a[60:63], a[28:31], v[108:111]
buffer_load_dwordx4 v6, s[52:55], s13 offen lds
v_mfma_f32_16x16x32_bf16 v[76:79], a[60:63], a[24:27], v[76:79]
v_mfma_f32_16x16x32_bf16 v[44:47], a[60:63], a[20:23], v[44:47]
ds_read_b64_tr_b16 a[60:61], v13 offset:512
v_mfma_f32_16x16x32_bf16 v[48:51], a[64:67], a[20:23], v[48:51]
ds_read_b64_tr_b16 a[62:63], v13 offset:1536
v_mfma_f32_16x16x32_bf16 v[80:83], a[64:67], a[24:27], v[80:83]
v_mfma_f32_16x16x32_bf16 v[112:115], a[64:67], a[28:31], v[112:115]
v_mfma_f32_16x16x32_bf16 v[144:147], a[64:67], a[32:35], v[144:147]
s_add_u32 m0, s18, 0x14000
ds_read_b64_tr_b16 a[64:65], v12 offset:768
v_mfma_f32_16x16x32_bf16 v[148:151], a[68:71], a[32:35], v[148:151]
buffer_load_dwordx4 v7, s[68:71], 0 offen lds
v_mfma_f32_16x16x32_bf16 v[116:119], a[68:71], a[28:31], v[116:119]
ds_read_b64_tr_b16 a[66:67], v12 offset:1792
v_mfma_f32_16x16x32_bf16 v[84:87], a[68:71], a[24:27], v[84:87]
v_mfma_f32_16x16x32_bf16 v[52:55], a[68:71], a[20:23], v[52:55]
ds_read_b64_tr_b16 a[68:69], v13 offset:768
v_mfma_f32_16x16x32_bf16 v[152:155], a[72:75], a[20:23], v[152:155]
ds_read_b64_tr_b16 a[70:71], v13 offset:1792
v_mfma_f32_16x16x32_bf16 v[160:163], a[72:75], a[24:27], v[160:163]
v_mfma_f32_16x16x32_bf16 v[168:171], a[72:75], a[28:31], v[168:171]
s_add_u32 m0, s18, 0x15000
v_mfma_f32_16x16x32_bf16 v[176:179], a[72:75], a[32:35], v[176:179]
buffer_load_dwordx4 v7, s[68:71], s25 offen lds
v_mfma_f32_16x16x32_bf16 v[180:183], a[76:79], a[32:35], v[180:183]
ds_read_b64_tr_b16 a[72:73], v14 offset:0
v_mfma_f32_16x16x32_bf16 v[172:175], a[76:79], a[28:31], v[172:175]
ds_read_b64_tr_b16 a[74:75], v14 offset:256
v_mfma_f32_16x16x32_bf16 v[164:167], a[76:79], a[24:27], v[164:167]
v_mfma_f32_16x16x32_bf16 v[156:159], a[76:79], a[20:23], v[156:159]
ds_read_b64_tr_b16 a[76:77], v15 offset:0
v_mfma_f32_16x16x32_bf16 v[184:187], a[80:83], a[20:23], v[184:187]
ds_read_b64_tr_b16 a[78:79], v15 offset:256
v_mfma_f32_16x16x32_bf16 v[192:195], a[80:83], a[24:27], v[192:195]
s_add_u32 m0, s18, 0x16000
v_mfma_f32_16x16x32_bf16 v[200:203], a[80:83], a[28:31], v[200:203]
buffer_load_dwordx4 v7, s[68:71], s26 offen lds
v_mfma_f32_16x16x32_bf16 v[208:211], a[80:83], a[32:35], v[208:211]
v_mfma_f32_16x16x32_bf16 v[248:251], a[80:83], a[36:39], v[248:251]
ds_read_b64_tr_b16 a[80:81], v14 offset:4096
v_mfma_f32_16x16x32_bf16 v[212:215], a[104:107], a[32:35], v[212:215]
ds_read_b64_tr_b16 a[82:83], v14 offset:4352
v_mfma_f32_16x16x32_bf16 v[204:207], a[104:107], a[28:31], v[204:207]
v_mfma_f32_16x16x32_bf16 v[196:199], a[104:107], a[24:27], v[196:199]
v_mfma_f32_16x16x32_bf16 v[188:191], a[104:107], a[20:23], v[188:191]
s_add_u32 m0, s18, 0x17000
v_mfma_f32_16x16x32_bf16 v[216:219], a[20:23], a[108:111], v[216:219]
buffer_load_dwordx4 v4, s[44:47], s24 offen lds
v_mfma_f32_16x16x32_bf16 v[224:227], a[24:27], a[108:111], v[224:227]
v_mfma_f32_16x16x32_bf16 v[232:235], a[28:31], a[108:111], v[232:235]
v_mfma_f32_16x16x32_bf16 v[240:243], a[32:35], a[108:111], v[240:243]
v_mfma_f32_16x16x32_bf16 v[252:255], a[36:39], a[108:111], v[252:255]
v_mfma_f32_16x16x32_bf16 v[244:247], a[32:35], a[112:115], v[244:247]
v_mfma_f32_16x16x32_bf16 v[236:239], a[28:31], a[112:115], v[236:239]
v_mfma_f32_16x16x32_bf16 v[228:231], a[24:27], a[112:115], v[228:231]
v_mfma_f32_16x16x32_bf16 v[220:223], a[20:23], a[112:115], v[220:223]
s_waitcnt lgkmcnt(0)
v_mfma_f32_16x16x32_bf16 v[24:27], a[40:43], a[0:3], v[24:27]
v_add_u32 v5, 0x80000, v5
v_add_u32 v6, 0x80000, v6
ds_read_b128 a[20:23], v9 offset:32768
v_mfma_f32_16x16x32_bf16 v[56:59], a[40:43], a[4:7], v[56:59]
v_add_u32 v7, 0x60000, v7
v_add_u32 v4, 0x80, v4
ds_read_b128 a[24:27], v9 offset:34816
v_mfma_f32_16x16x32_bf16 v[88:91], a[40:43], a[8:11], v[88:91]
ds_read_b128 a[28:31], v9 offset:36864
ds_read_b128 a[32:35], v9 offset:38912
v_mfma_f32_16x16x32_bf16 v[120:123], a[40:43], a[12:15], v[120:123]
ds_read_b128 a[36:39], v11
ds_read_b64_tr_b16 a[104:105], v15 offset:6144
v_mfma_f32_16x16x32_bf16 v[124:127], a[44:47], a[12:15], v[124:127]
ds_read_b64_tr_b16 a[106:107], v15 offset:6400
ds_read_b64_tr_b16 a[108:109], v14 offset:10240
v_mfma_f32_16x16x32_bf16 v[92:95], a[44:47], a[8:11], v[92:95]
ds_read_b64_tr_b16 a[110:111], v14 offset:10496
ds_read_b64_tr_b16 a[112:113], v15 offset:10240
v_mfma_f32_16x16x32_bf16 v[60:63], a[44:47], a[4:7], v[60:63]
ds_read_b64_tr_b16 a[114:115], v15 offset:10496
v_mfma_f32_16x16x32_bf16 v[28:31], a[44:47], a[0:3], v[28:31]
ds_read_b64_tr_b16 a[40:41], v12 offset:8192
ds_read_b64_tr_b16 a[42:43], v12 offset:9216
v_mfma_f32_16x16x32_bf16 v[32:35], a[48:51], a[0:3], v[32:35]
ds_read_b64_tr_b16 a[44:45], v13 offset:8192
v_mfma_f32_16x16x32_bf16 v[64:67], a[48:51], a[4:7], v[64:67]
s_add_u32 m0, s16, 0x8000
ds_read_b64_tr_b16 a[46:47], v13 offset:9216
s_waitcnt lgkmcnt(11)
v_mfma_f32_16x16x32_bf16 v[96:99], a[48:51], a[8:11], v[96:99]
buffer_load_dwordx4 v22, s[44:47], s20 offen lds
v_mfma_f32_16x16x32_bf16 v[128:131], a[48:51], a[12:15], v[128:131]
ds_read_b64_tr_b16 a[48:49], v12 offset:8448
v_mfma_f32_16x16x32_bf16 v[132:135], a[52:55], a[12:15], v[132:135]
ds_read_b64_tr_b16 a[50:51], v12 offset:9472
v_mfma_f32_16x16x32_bf16 v[100:103], a[52:55], a[8:11], v[100:103]
v_mfma_f32_16x16x32_bf16 v[68:71], a[52:55], a[4:7], v[68:71]
s_add_u32 m0, s16, 0x8400
v_mfma_f32_16x16x32_bf16 v[36:39], a[52:55], a[0:3], v[36:39]
buffer_load_dwordx4 v23, s[44:47], s20 offen lds
v_mfma_f32_16x16x32_bf16 v[40:43], a[56:59], a[0:3], v[40:43]
ds_read_b64_tr_b16 a[52:53], v13 offset:8448
v_mfma_f32_16x16x32_bf16 v[72:75], a[56:59], a[4:7], v[72:75]
ds_read_b64_tr_b16 a[54:55], v13 offset:9472
v_mfma_f32_16x16x32_bf16 v[104:107], a[56:59], a[8:11], v[104:107]
v_mfma_f32_16x16x32_bf16 v[136:139], a[56:59], a[12:15], v[136:139]
ds_read_b64_tr_b16 a[56:57], v12 offset:8704
v_mfma_f32_16x16x32_bf16 v[140:143], a[60:63], a[12:15], v[140:143]
s_add_u32 m0, s16, 0x8800
ds_read_b64_tr_b16 a[58:59], v12 offset:9728
v_mfma_f32_16x16x32_bf16 v[108:111], a[60:63], a[8:11], v[108:111]
buffer_load_dwordx4 v22, s[44:47], s21 offen lds
v_mfma_f32_16x16x32_bf16 v[76:79], a[60:63], a[4:7], v[76:79]
v_mfma_f32_16x16x32_bf16 v[44:47], a[60:63], a[0:3], v[44:47]
ds_read_b64_tr_b16 a[60:61], v13 offset:8704
v_mfma_f32_16x16x32_bf16 v[48:51], a[64:67], a[0:3], v[48:51]
ds_read_b64_tr_b16 a[62:63], v13 offset:9728
v_mfma_f32_16x16x32_bf16 v[80:83], a[64:67], a[4:7], v[80:83]
v_mfma_f32_16x16x32_bf16 v[112:115], a[64:67], a[8:11], v[112:115]
s_add_u32 m0, s16, 0x8c00
v_mfma_f32_16x16x32_bf16 v[144:147], a[64:67], a[12:15], v[144:147]
buffer_load_dwordx4 v23, s[44:47], s21 offen lds
v_mfma_f32_16x16x32_bf16 v[148:151], a[68:71], a[12:15], v[148:151]
ds_read_b64_tr_b16 a[64:65], v12 offset:8960
v_mfma_f32_16x16x32_bf16 v[116:119], a[68:71], a[8:11], v[116:119]
ds_read_b64_tr_b16 a[66:67], v12 offset:9984
v_mfma_f32_16x16x32_bf16 v[84:87], a[68:71], a[4:7], v[84:87]
v_mfma_f32_16x16x32_bf16 v[52:55], a[68:71], a[0:3], v[52:55]
ds_read_b64_tr_b16 a[68:69], v13 offset:8960
v_mfma_f32_16x16x32_bf16 v[152:155], a[72:75], a[0:3], v[152:155]
s_add_u32 m0, s16, 0x9000
ds_read_b64_tr_b16 a[70:71], v13 offset:9984
v_mfma_f32_16x16x32_bf16 v[160:163], a[72:75], a[4:7], v[160:163]
buffer_load_dwordx4 v22, s[44:47], s22 offen lds
v_mfma_f32_16x16x32_bf16 v[168:171], a[72:75], a[8:11], v[168:171]
v_mfma_f32_16x16x32_bf16 v[176:179], a[72:75], a[12:15], v[176:179]
ds_read_b64_tr_b16 a[72:73], v14 offset:2048
v_mfma_f32_16x16x32_bf16 v[180:183], a[76:79], a[12:15], v[180:183]
ds_read_b64_tr_b16 a[74:75], v14 offset:2304
v_mfma_f32_16x16x32_bf16 v[172:175], a[76:79], a[8:11], v[172:175]
s_add_u32 m0, s16, 0x9400
v_mfma_f32_16x16x32_bf16 v[164:167], a[76:79], a[4:7], v[164:167]
buffer_load_dwordx4 v23, s[44:47], s22 offen lds
v_mfma_f32_16x16x32_bf16 v[156:159], a[76:79], a[0:3], v[156:159]
ds_read_b64_tr_b16 a[76:77], v15 offset:2048
v_mfma_f32_16x16x32_bf16 v[184:187], a[80:83], a[0:3], v[184:187]
ds_read_b64_tr_b16 a[78:79], v15 offset:2304
v_mfma_f32_16x16x32_bf16 v[192:195], a[80:83], a[4:7], v[192:195]
v_mfma_f32_16x16x32_bf16 v[200:203], a[80:83], a[8:11], v[200:203]
v_mfma_f32_16x16x32_bf16 v[208:211], a[80:83], a[12:15], v[208:211]
s_add_u32 m0, s16, 0x9800
v_mfma_f32_16x16x32_bf16 v[248:251], a[80:83], a[16:19], v[248:251]
buffer_load_dwordx4 v22, s[44:47], s23 offen lds
v_mfma_f32_16x16x32_bf16 v[212:215], a[84:87], a[12:15], v[212:215]
ds_read_b64_tr_b16 a[80:81], v14 offset:6144
v_mfma_f32_16x16x32_bf16 v[204:207], a[84:87], a[8:11], v[204:207]
ds_read_b64_tr_b16 a[82:83], v14 offset:6400
v_mfma_f32_16x16x32_bf16 v[196:199], a[84:87], a[4:7], v[196:199]
v_mfma_f32_16x16x32_bf16 v[188:191], a[84:87], a[0:3], v[188:191]
v_mfma_f32_16x16x32_bf16 v[216:219], a[0:3], a[88:91], v[216:219]
s_add_u32 m0, s16, 0x9c00
v_mfma_f32_16x16x32_bf16 v[224:227], a[4:7], a[88:91], v[224:227]
buffer_load_dwordx4 v23, s[44:47], s23 offen lds
v_mfma_f32_16x16x32_bf16 v[232:235], a[8:11], a[88:91], v[232:235]
v_mfma_f32_16x16x32_bf16 v[240:243], a[12:15], a[88:91], v[240:243]
v_mfma_f32_16x16x32_bf16 v[252:255], a[16:19], a[88:91], v[252:255]
v_mfma_f32_16x16x32_bf16 v[244:247], a[12:15], a[92:95], v[244:247]
v_mfma_f32_16x16x32_bf16 v[236:239], a[8:11], a[92:95], v[236:239]
v_add_u32 v12, 0x8000, v12
v_add_u32 v13, 0x8000, v13
v_mfma_f32_16x16x32_bf16 v[228:231], a[4:7], a[92:95], v[228:231]
v_add_u32 v14, 0x8000, v14
v_add_u32 v15, 0x8000, v15
v_mfma_f32_16x16x32_bf16 v[220:223], a[0:3], a[92:95], v[220:223]
v_add_u32 v10, 0x8000, v10
v_add_u32 v11, 0x8000, v11
s_waitcnt vmcnt(16) lgkmcnt(0)
s_mov_b32 s92, 200000
L_spin_kv:
v_readfirstlane_b32 s93, v1
s_nop 1
s_cmp_ge_u32 s93, 8
s_cbranch_scc1 L_spun_kv
s_sub_u32 s92, s92, 1
s_cbranch_scc1 L_spun_kv
s_sleep 4
buffer_load_dword v1, off, s[84:87], s10 sc1
s_waitcnt vmcnt(0)
s_branch L_spin_kv
L_spun_kv:
s_barrier
v_mfma_f32_16x16x32_bf16 v[24:27], a[40:43], a[20:23], v[24:27]
s_add_u32 m0, s19, 0x0
v_add_u32 v22, 0x80, v22
v_add_u32 v23, 0x80, v23
ds_read_b128 a[0:3], v8 offset:0
v_mfma_f32_16x16x32_bf16 v[56:59], a[40:43], a[24:27], v[56:59]
buffer_load_dwordx4 v16, s[88:91], s32 offen offset:0 sc1 lds
v_mfma_f32_16x16x32_bf16 v[88:91], a[40:43], a[28:31], v[88:91]
ds_read_b128 a[4:7], v8 offset:2048
ds_read_b128 a[8:11], v8 offset:4096
v_mfma_f32_16x16x32_bf16 v[120:123], a[40:43], a[32:35], v[120:123]
ds_read_b128 a[12:15], v8 offset:6144
ds_read_b128 a[16:19], v10
v_mfma_f32_16x16x32_bf16 v[124:127], a[44:47], a[32:35], v[124:127]
ds_read_b64_tr_b16 a[84:85], v15 offset:4096
ds_read_b64_tr_b16 a[86:87], v15 offset:4352
v_mfma_f32_16x16x32_bf16 v[92:95], a[44:47], a[28:31], v[92:95]
ds_read_b64_tr_b16 a[88:89], v14 offset:8192
ds_read_b64_tr_b16 a[90:91], v14 offset:8448
v_mfma_f32_16x16x32_bf16 v[60:63], a[44:47], a[24:27], v[60:63]
ds_read_b64_tr_b16 a[92:93], v15 offset:8192
ds_read_b64_tr_b16 a[94:95], v15 offset:8448
v_mfma_f32_16x16x32_bf16 v[28:31], a[44:47], a[20:23], v[28:31]
buffer_load_dwordx4 v16, s[88:91], s32 offen offset:1024 sc1 lds
v_mfma_f32_16x16x32_bf16 v[32:35], a[48:51], a[20:23], v[32:35]
ds_read_b64_tr_b16 a[40:41], v12 offset:0
ds_read_b64_tr_b16 a[42:43], v12 offset:1024
v_mfma_f32_16x16x32_bf16 v[64:67], a[48:51], a[24:27], v[64:67]
ds_read_b64_tr_b16 a[44:45], v13 offset:0
v_mfma_f32_16x16x32_bf16 v[96:99], a[48:51], a[28:31], v[96:99]
ds_read_b64_tr_b16 a[46:47], v13 offset:1024
v_mfma_f32_16x16x32_bf16 v[128:131], a[48:51], a[32:35], v[128:131]
ds_read_b64_tr_b16 a[48:49], v12 offset:256
v_mfma_f32_16x16x32_bf16 v[132:135], a[52:55], a[32:35], v[132:135]
ds_read_b64_tr_b16 a[50:51], v12 offset:1280
v_mfma_f32_16x16x32_bf16 v[100:103], a[52:55], a[28:31], v[100:103]
v_mfma_f32_16x16x32_bf16 v[68:71], a[52:55], a[24:27], v[68:71]
buffer_load_dwordx4 v16, s[88:91], s32 offen offset:2048 sc1 lds
v_mfma_f32_16x16x32_bf16 v[36:39], a[52:55], a[20:23], v[36:39]
ds_read_b64_tr_b16 a[52:53], v13 offset:256
v_mfma_f32_16x16x32_bf16 v[40:43], a[56:59], a[20:23], v[40:43]
ds_read_b64_tr_b16 a[54:55], v13 offset:1280
v_mfma_f32_16x16x32_bf16 v[72:75], a[56:59], a[24:27], v[72:75]
v_mfma_f32_16x16x32_bf16 v[104:107], a[56:59], a[28:31], v[104:107]
v_mfma_f32_16x16x32_bf16 v[136:139], a[56:59], a[32:35], v[136:139]
ds_read_b64_tr_b16 a[56:57], v12 offset:512
v_mfma_f32_16x16x32_bf16 v[140:143], a[60:63], a[32:35], v[140:143]
ds_read_b64_tr_b16 a[58:59], v12 offset:1536
v_mfma_f32_16x16x32_bf16 v[108:111], a[60:63], a[28:31], v[108:111]
buffer_load_dwordx4 v16, s[88:91], s32 offen offset:3072 sc1 lds
v_mfma_f32_16x16x32_bf16 v[76:79], a[60:63], a[24:27], v[76:79]
v_mfma_f32_16x16x32_bf16 v[44:47], a[60:63], a[20:23], v[44:47]
ds_read_b64_tr_b16 a[60:61], v13 offset:512
v_mfma_f32_16x16x32_bf16 v[48:51], a[64:67], a[20:23], v[48:51]
ds_read_b64_tr_b16 a[62:63], v13 offset:1536
v_mfma_f32_16x16x32_bf16 v[80:83], a[64:67], a[24:27], v[80:83]
v_mfma_f32_16x16x32_bf16 v[112:115], a[64:67], a[28:31], v[112:115]
v_mfma_f32_16x16x32_bf16 v[144:147], a[64:67], a[32:35], v[144:147]
s_add_u32 m0, s19, 0x1000
ds_read_b64_tr_b16 a[64:65], v12 offset:768
v_mfma_f32_16x16x32_bf16 v[148:151], a[68:71], a[32:35], v[148:151]
buffer_load_dwordx4 v16, s[88:91], s7 offen offset:0 sc1 lds
v_mfma_f32_16x16x32_bf16 v[116:119], a[68:71], a[28:31], v[116:119]
ds_read_b64_tr_b16 a[66:67], v12 offset:1792
v_mfma_f32_16x16x32_bf16 v[84:87], a[68:71], a[24:27], v[84:87]
v_mfma_f32_16x16x32_bf16 v[52:55], a[68:71], a[20:23], v[52:55]
ds_read_b64_tr_b16 a[68:69], v13 offset:768
v_mfma_f32_16x16x32_bf16 v[152:155], a[72:75], a[20:23], v[152:155]
ds_read_b64_tr_b16 a[70:71], v13 offset:1792
v_mfma_f32_16x16x32_bf16 v[160:163], a[72:75], a[24:27], v[160:163]
v_mfma_f32_16x16x32_bf16 v[168:171], a[72:75], a[28:31], v[168:171]
v_mfma_f32_16x16x32_bf16 v[176:179], a[72:75], a[32:35], v[176:179]
buffer_load_dwordx4 v16, s[88:91], s7 offen offset:1024 sc1 lds
v_mfma_f32_16x16x32_bf16 v[180:183], a[76:79], a[32:35], v[180:183]
ds_read_b64_tr_b16 a[72:73], v14 offset:0
v_mfma_f32_16x16x32_bf16 v[172:175], a[76:79], a[28:31], v[172:175]
ds_read_b64_tr_b16 a[74:75], v14 offset:256
v_mfma_f32_16x16x32_bf16 v[164:167], a[76:79], a[24:27], v[164:167]
v_mfma_f32_16x16x32_bf16 v[156:159], a[76:79], a[20:23], v[156:159]
ds_read_b64_tr_b16 a[76:77], v15 offset:0
v_mfma_f32_16x16x32_bf16 v[184:187], a[80:83], a[20:23], v[184:187]
ds_read_b64_tr_b16 a[78:79], v15 offset:256
v_mfma_f32_16x16x32_bf16 v[192:195], a[80:83], a[24:27], v[192:195]
v_mfma_f32_16x16x32_bf16 v[200:203], a[80:83], a[28:31], v[200:203]
buffer_load_dwordx4 v16, s[88:91], s7 offen offset:2048 sc1 lds
v_mfma_f32_16x16x32_bf16 v[208:211], a[80:83], a[32:35], v[208:211]
v_mfma_f32_16x16x32_bf16 v[248:251], a[80:83], a[36:39], v[248:251]
ds_read_b64_tr_b16 a[80:81], v14 offset:4096
v_mfma_f32_16x16x32_bf16 v[212:215], a[104:107], a[32:35], v[212:215]
ds_read_b64_tr_b16 a[82:83], v14 offset:4352
v_mfma_f32_16x16x32_bf16 v[204:207], a[104:107], a[28:31], v[204:207]
v_mfma_f32_16x16x32_bf16 v[196:199], a[104:107], a[24:27], v[196:199]
v_mfma_f32_16x16x32_bf16 v[188:191], a[104:107], a[20:23], v[188:191]
v_mfma_f32_16x16x32_bf16 v[216:219], a[20:23], a[108:111], v[216:219]
buffer_load_dwordx4 v16, s[88:91], s7 offen offset:3072 sc1 lds
v_mfma_f32_16x16x32_bf16 v[224:227], a[24:27], a[108:111], v[224:227]
v_mfma_f32_16x16x32_bf16 v[232:235], a[28:31], a[108:111], v[232:235]
v_mfma_f32_16x16x32_bf16 v[240:243], a[32:35], a[108:111], v[240:243]
v_mfma_f32_16x16x32_bf16 v[252:255], a[36:39], a[108:111], v[252:255]
v_mfma_f32_16x16x32_bf16 v[244:247], a[32:35], a[112:115], v[244:247]
v_mfma_f32_16x16x32_bf16 v[236:239], a[28:31], a[112:115], v[236:239]
v_mfma_f32_16x16x32_bf16 v[228:231], a[24:27], a[112:115], v[228:231]
v_mfma_f32_16x16x32_bf16 v[220:223], a[20:23], a[112:115], v[220:223]
s_waitcnt lgkmcnt(0)
v_mfma_f32_16x16x32_bf16 v[24:27], a[40:43], a[0:3], v[24:27]
s_add_u32 s32, s32, 0x8000
s_add_u32 s7, s7, 0x8000
ds_read_b128 a[20:23], v9 offset:0
v_mfma_f32_16x16x32_bf16 v[56:59], a[40:43], a[4:7], v[56:59]
ds_read_b128 a[24:27], v9 offset:2048
ds_read_b128 a[28:31], v9 offset:4096
v_mfma_f32_16x16x32_bf16 v[88:91], a[40:43], a[8:11], v[88:91]
ds_read_b128 a[32:35], v9 offset:6144
ds_read_b128 a[36:39], v11
v_mfma_f32_16x16x32_bf16 v[120:123], a[40:43], a[12:15], v[120:123]
ds_read_b64_tr_b16 a[104:105], v15 offset:6144
ds_read_b64_tr_b16 a[106:107], v15 offset:6400
v_mfma_f32_16x16x32_bf16 v[124:127], a[44:47], a[12:15], v[124:127]
ds_read_b64_tr_b16 a[108:109], v14 offset:10240
ds_read_b64_tr_b16 a[110:111], v14 offset:10496
v_mfma_f32_16x16x32_bf16 v[92:95], a[44:47], a[8:11], v[92:95]
ds_read_b64_tr_b16 a[112:113], v15 offset:10240
ds_read_b64_tr_b16 a[114:115], v15 offset:10496
v_mfma_f32_16x16x32_bf16 v[60:63], a[44:47], a[4:7], v[60:63]
ds_read_b64_tr_b16 a[40:41], v12 offset:8192
v_mfma_f32_16x16x32_bf16 v[28:31], a[44:47], a[0:3], v[28:31]
ds_read_b64_tr_b16 a[42:43], v12 offset:9216
v_mfma_f32_16x16x32_bf16 v[32:35], a[48:51], a[0:3], v[32:35]
ds_read_b64_tr_b16 a[44:45], v13 offset:8192
v_mfma_f32_16x16x32_bf16 v[64:67], a[48:51], a[4:7], v[64:67]
s_add_u32 m0, s19, 0x18000
ds_read_b64_tr_b16 a[46:47], v13 offset:9216
s_waitcnt lgkmcnt(11)
v_mfma_f32_16x16x32_bf16 v[96:99], a[48:51], a[8:11], v[96:99]
buffer_load_dwordx4 v16, s[88:91], s32 offen offset:0 sc1 lds
v_mfma_f32_16x16x32_bf16 v[128:131], a[48:51], a[12:15], v[128:131]
ds_read_b64_tr_b16 a[48:49], v12 offset:8448
v_mfma_f32_16x16x32_bf16 v[132:135], a[52:55], a[12:15], v[132:135]
ds_read_b64_tr_b16 a[50:51], v12 offset:9472
v_mfma_f32_16x16x32_bf16 v[100:103], a[52:55], a[8:11], v[100:103]
v_mfma_f32_16x16x32_bf16 v[68:71], a[52:55], a[4:7], v[68:71]
v_mfma_f32_16x16x32_bf16 v[36:39], a[52:55], a[0:3], v[36:39]
buffer_load_dwordx4 v16, s[88:91], s32 offen offset:1024 sc1 lds
v_mfma_f32_16x16x32_bf16 v[40:43], a[56:59], a[0:3], v[40:43]
ds_read_b64_tr_b16 a[52:53], v13 offset:8448
v_mfma_f32_16x16x32_bf16 v[72:75], a[56:59], a[4:7], v[72:75]
ds_read_b64_tr_b16 a[54:55], v13 offset:9472
v_mfma_f32_16x16x32_bf16 v[104:107], a[56:59], a[8:11], v[104:107]
v_mfma_f32_16x16x32_bf16 v[136:139], a[56:59], a[12:15], v[136:139]
ds_read_b64_tr_b16 a[56:57], v12 offset:8704
v_mfma_f32_16x16x32_bf16 v[140:143], a[60:63], a[12:15], v[140:143]
ds_read_b64_tr_b16 a[58:59], v12 offset:9728
v_mfma_f32_16x16x32_bf16 v[108:111], a[60:63], a[8:11], v[108:111]
buffer_load_dwordx4 v16, s[88:91], s32 offen offset:2048 sc1 lds
v_mfma_f32_16x16x32_bf16 v[76:79], a[60:63], a[4:7], v[76:79]
v_mfma_f32_16x16x32_bf16 v[44:47], a[60:63], a[0:3], v[44:47]
ds_read_b64_tr_b16 a[60:61], v13 offset:8704
v_mfma_f32_16x16x32_bf16 v[48:51], a[64:67], a[0:3], v[48:51]
ds_read_b64_tr_b16 a[62:63], v13 offset:9728
v_mfma_f32_16x16x32_bf16 v[80:83], a[64:67], a[4:7], v[80:83]
v_mfma_f32_16x16x32_bf16 v[112:115], a[64:67], a[8:11], v[112:115]
v_mfma_f32_16x16x32_bf16 v[144:147], a[64:67], a[12:15], v[144:147]
buffer_load_dwordx4 v16, s[88:91], s32 offen offset:3072 sc1 lds
v_mfma_f32_16x16x32_bf16 v[148:151], a[68:71], a[12:15], v[148:151]
ds_read_b64_tr_b16 a[64:65], v12 offset:8960
v_mfma_f32_16x16x32_bf16 v[116:119], a[68:71], a[8:11], v[116:119]
ds_read_b64_tr_b16 a[66:67], v12 offset:9984
v_mfma_f32_16x16x32_bf16 v[84:87], a[68:71], a[4:7], v[84:87]
v_mfma_f32_16x16x32_bf16 v[52:55], a[68:71], a[0:3], v[52:55]
ds_read_b64_tr_b16 a[68:69], v13 offset:8960
v_mfma_f32_16x16x32_bf16 v[152:155], a[72:75], a[0:3], v[152:155]
s_add_u32 m0, s19, 0x19000
ds_read_b64_tr_b16 a[70:71], v13 offset:9984
v_mfma_f32_16x16x32_bf16 v[160:163], a[72:75], a[4:7], v[160:163]
buffer_load_dwordx4 v16, s[88:91], s7 offen offset:0 sc1 lds
v_mfma_f32_16x16x32_bf16 v[168:171], a[72:75], a[8:11], v[168:171]
v_mfma_f32_16x16x32_bf16 v[176:179], a[72:75], a[12:15], v[176:179]
ds_read_b64_tr_b16 a[72:73], v14 offset:2048
v_mfma_f32_16x16x32_bf16 v[180:183], a[76:79], a[12:15], v[180:183]
ds_read_b64_tr_b16 a[74:75], v14 offset:2304
v_mfma_f32_16x16x32_bf16 v[172:175], a[76:79], a[8:11], v[172:175]
v_mfma_f32_16x16x32_bf16 v[164:167], a[76:79], a[4:7], v[164:167]
buffer_load_dwordx4 v16, s[88:91], s7 offen offset:1024 sc1 lds
v_mfma_f32_16x16x32_bf16 v[156:159], a[76:79], a[0:3], v[156:159]
ds_read_b64_tr_b16 a[76:77], v15 offset:2048
v_mfma_f32_16x16x32_bf16 v[184:187], a[80:83], a[0:3], v[184:187]
ds_read_b64_tr_b16 a[78:79], v15 offset:2304
v_mfma_f32_16x16x32_bf16 v[192:195], a[80:83], a[4:7], v[192:195]
v_mfma_f32_16x16x32_bf16 v[200:203], a[80:83], a[8:11], v[200:203]
v_mfma_f32_16x16x32_bf16 v[208:211], a[80:83], a[12:15], v[208:211]
v_mfma_f32_16x16x32_bf16 v[248:251], a[80:83], a[16:19], v[248:251]
buffer_load_dwordx4 v16, s[88:91], s7 offen offset:2048 sc1 lds
v_mfma_f32_16x16x32_bf16 v[212:215], a[84:87], a[12:15], v[212:215]
ds_read_b64_tr_b16 a[80:81], v14 offset:6144
v_mfma_f32_16x16x32_bf16 v[204:207], a[84:87], a[8:11], v[204:207]
ds_read_b64_tr_b16 a[82:83], v14 offset:6400
v_mfma_f32_16x16x32_bf16 v[196:199], a[84:87], a[4:7], v[196:199]
v_mfma_f32_16x16x32_bf16 v[188:191], a[84:87], a[0:3], v[188:191]
v_mfma_f32_16x16x32_bf16 v[216:219], a[0:3], a[88:91], v[216:219]
v_mfma_f32_16x16x32_bf16 v[224:227], a[4:7], a[88:91], v[224:227]
buffer_load_dwordx4 v16, s[88:91], s7 offen offset:3072 sc1 lds
v_mfma_f32_16x16x32_bf16 v[232:235], a[8:11], a[88:91], v[232:235]
v_mfma_f32_16x16x32_bf16 v[240:243], a[12:15], a[88:91], v[240:243]
v_mfma_f32_16x16x32_bf16 v[252:255], a[16:19], a[88:91], v[252:255]
v_mfma_f32_16x16x32_bf16 v[244:247], a[12:15], a[92:95], v[244:247]
v_mfma_f32_16x16x32_bf16 v[236:239], a[8:11], a[92:95], v[236:239]
v_add_u32 v12, 0x8000, v12
v_add_u32 v13, 0x8000, v13
v_mfma_f32_16x16x32_bf16 v[228:231], a[4:7], a[92:95], v[228:231]
v_add_u32 v14, 0x8000, v14
v_add_u32 v15, 0x8000, v15
v_mfma_f32_16x16x32_bf16 v[220:223], a[0:3], a[92:95], v[220:223]
v_add_u32 v10, 0x8000, v10
v_add_u32 v11, 0x8000, v11
s_waitcnt vmcnt(16) lgkmcnt(0)
s_barrier
v_mfma_f32_16x16x32_bf16 v[24:27], a[40:43], a[20:23], v[24:27]
s_add_u32 m0, s19, 0x8000
s_add_u32 s32, s32, 0x8000
s_add_u32 s7, s7, 0x8000
ds_read_b128 a[0:3], v8 offset:32768
v_mfma_f32_16x16x32_bf16 v[56:59], a[40:43], a[24:27], v[56:59]
buffer_load_dwordx4 v16, s[88:91], s32 offen offset:0 sc1 lds
v_mfma_f32_16x16x32_bf16 v[88:91], a[40:43], a[28:31], v[88:91]
ds_read_b128 a[4:7], v8 offset:34816
ds_read_b128 a[8:11], v8 offset:36864
v_mfma_f32_16x16x32_bf16 v[120:123], a[40:43], a[32:35], v[120:123]
ds_read_b128 a[12:15], v8 offset:38912
ds_read_b128 a[16:19], v10
v_mfma_f32_16x16x32_bf16 v[124:127], a[44:47], a[32:35], v[124:127]
ds_read_b64_tr_b16 a[84:85], v15 offset:4096
ds_read_b64_tr_b16 a[86:87], v15 offset:4352
v_mfma_f32_16x16x32_bf16 v[92:95], a[44:47], a[28:31], v[92:95]
ds_read_b64_tr_b16 a[88:89], v14 offset:8192
ds_read_b64_tr_b16 a[90:91], v14 offset:8448
v_mfma_f32_16x16x32_bf16 v[60:63], a[44:47], a[24:27], v[60:63]
ds_read_b64_tr_b16 a[92:93], v15 offset:8192
ds_read_b64_tr_b16 a[94:95], v15 offset:8448
v_mfma_f32_16x16x32_bf16 v[28:31], a[44:47], a[20:23], v[28:31]
buffer_load_dwordx4 v16, s[88:91], s32 offen offset:1024 sc1 lds
v_mfma_f32_16x16x32_bf16 v[32:35], a[48:51], a[20:23], v[32:35]
ds_read_b64_tr_b16 a[40:41], v12 offset:0
ds_read_b64_tr_b16 a[42:43], v12 offset:1024
v_mfma_f32_16x16x32_bf16 v[64:67], a[48:51], a[24:27], v[64:67]
ds_read_b64_tr_b16 a[44:45], v13 offset:0
v_mfma_f32_16x16x32_bf16 v[96:99], a[48:51], a[28:31], v[96:99]
ds_read_b64_tr_b16 a[46:47], v13 offset:1024
v_mfma_f32_16x16x32_bf16 v[128:131], a[48:51], a[32:35], v[128:131]
ds_read_b64_tr_b16 a[48:49], v12 offset:256
v_mfma_f32_16x16x32_bf16 v[132:135], a[52:55], a[32:35], v[132:135]
ds_read_b64_tr_b16 a[50:51], v12 offset:1280
v_mfma_f32_16x16x32_bf16 v[100:103], a[52:55], a[28:31], v[100:103]
v_mfma_f32_16x16x32_bf16 v[68:71], a[52:55], a[24:27], v[68:71]
buffer_load_dwordx4 v16, s[88:91], s32 offen offset:2048 sc1 lds
v_mfma_f32_16x16x32_bf16 v[36:39], a[52:55], a[20:23], v[36:39]
ds_read_b64_tr_b16 a[52:53], v13 offset:256
v_mfma_f32_16x16x32_bf16 v[40:43], a[56:59], a[20:23], v[40:43]
ds_read_b64_tr_b16 a[54:55], v13 offset:1280
v_mfma_f32_16x16x32_bf16 v[72:75], a[56:59], a[24:27], v[72:75]
v_mfma_f32_16x16x32_bf16 v[104:107], a[56:59], a[28:31], v[104:107]
v_mfma_f32_16x16x32_bf16 v[136:139], a[56:59], a[32:35], v[136:139]
ds_read_b64_tr_b16 a[56:57], v12 offset:512
v_mfma_f32_16x16x32_bf16 v[140:143], a[60:63], a[32:35], v[140:143]
ds_read_b64_tr_b16 a[58:59], v12 offset:1536
v_mfma_f32_16x16x32_bf16 v[108:111], a[60:63], a[28:31], v[108:111]
buffer_load_dwordx4 v16, s[88:91], s32 offen offset:3072 sc1 lds
v_mfma_f32_16x16x32_bf16 v[76:79], a[60:63], a[24:27], v[76:79]
v_mfma_f32_16x16x32_bf16 v[44:47], a[60:63], a[20:23], v[44:47]
ds_read_b64_tr_b16 a[60:61], v13 offset:512
v_mfma_f32_16x16x32_bf16 v[48:51], a[64:67], a[20:23], v[48:51]
ds_read_b64_tr_b16 a[62:63], v13 offset:1536
v_mfma_f32_16x16x32_bf16 v[80:83], a[64:67], a[24:27], v[80:83]
v_mfma_f32_16x16x32_bf16 v[112:115], a[64:67], a[28:31], v[112:115]
v_mfma_f32_16x16x32_bf16 v[144:147], a[64:67], a[32:35], v[144:147]
s_add_u32 m0, s19, 0x9000
ds_read_b64_tr_b16 a[64:65], v12 offset:768
v_mfma_f32_16x16x32_bf16 v[148:151], a[68:71], a[32:35], v[148:151]
buffer_load_dwordx4 v16, s[88:91], s7 offen offset:0 sc1 lds
v_mfma_f32_16x16x32_bf16 v[116:119], a[68:71], a[28:31], v[116:119]
ds_read_b64_tr_b16 a[66:67], v12 offset:1792
v_mfma_f32_16x16x32_bf16 v[84:87], a[68:71], a[24:27], v[84:87]
v_mfma_f32_16x16x32_bf16 v[52:55], a[68:71], a[20:23], v[52:55]
ds_read_b64_tr_b16 a[68:69], v13 offset:768
v_mfma_f32_16x16x32_bf16 v[152:155], a[72:75], a[20:23], v[152:155]
ds_read_b64_tr_b16 a[70:71], v13 offset:1792
v_mfma_f32_16x16x32_bf16 v[160:163], a[72:75], a[24:27], v[160:163]
v_mfma_f32_16x16x32_bf16 v[168:171], a[72:75], a[28:31], v[168:171]
v_mfma_f32_16x16x32_bf16 v[176:179], a[72:75], a[32:35], v[176:179]
buffer_load_dwordx4 v16, s[88:91], s7 offen offset:1024 sc1 lds
v_mfma_f32_16x16x32_bf16 v[180:183], a[76:79], a[32:35], v[180:183]
ds_read_b64_tr_b16 a[72:73], v14 offset:0
v_mfma_f32_16x16x32_bf16 v[172:175], a[76:79], a[28:31], v[172:175]
ds_read_b64_tr_b16 a[74:75], v14 offset:256
v_mfma_f32_16x16x32_bf16 v[164:167], a[76:79], a[24:27], v[164:167]
v_mfma_f32_16x16x32_bf16 v[156:159], a[76:79], a[20:23], v[156:159]
ds_read_b64_tr_b16 a[76:77], v15 offset:0
v_mfma_f32_16x16x32_bf16 v[184:187], a[80:83], a[20:23], v[184:187]
ds_read_b64_tr_b16 a[78:79], v15 offset:256
v_mfma_f32_16x16x32_bf16 v[192:195], a[80:83], a[24:27], v[192:195]
v_mfma_f32_16x16x32_bf16 v[200:203], a[80:83], a[28:31], v[200:203]
buffer_load_dwordx4 v16, s[88:91], s7 offen offset:2048 sc1 lds
v_mfma_f32_16x16x32_bf16 v[208:211], a[80:83], a[32:35], v[208:211]
v_mfma_f32_16x16x32_bf16 v[248:251], a[80:83], a[36:39], v[248:251]
ds_read_b64_tr_b16 a[80:81], v14 offset:4096
v_mfma_f32_16x16x32_bf16 v[212:215], a[104:107], a[32:35], v[212:215]
ds_read_b64_tr_b16 a[82:83], v14 offset:4352
v_mfma_f32_16x16x32_bf16 v[204:207], a[104:107], a[28:31], v[204:207]
v_mfma_f32_16x16x32_bf16 v[196:199], a[104:107], a[24:27], v[196:199]
v_mfma_f32_16x16x32_bf16 v[188:191], a[104:107], a[20:23], v[188:191]
v_mfma_f32_16x16x32_bf16 v[216:219], a[20:23], a[108:111], v[216:219]
buffer_load_dwordx4 v16, s[88:91], s7 offen offset:3072 sc1 lds
v_mfma_f32_16x16x32_bf16 v[224:227], a[24:27], a[108:111], v[224:227]
v_mfma_f32_16x16x32_bf16 v[232:235], a[28:31], a[108:111], v[232:235]
v_mfma_f32_16x16x32_bf16 v[240:243], a[32:35], a[108:111], v[240:243]
v_mfma_f32_16x16x32_bf16 v[252:255], a[36:39], a[108:111], v[252:255]
v_mfma_f32_16x16x32_bf16 v[244:247], a[32:35], a[112:115], v[244:247]
v_mfma_f32_16x16x32_bf16 v[236:239], a[28:31], a[112:115], v[236:239]
v_mfma_f32_16x16x32_bf16 v[228:231], a[24:27], a[112:115], v[228:231]
v_mfma_f32_16x16x32_bf16 v[220:223], a[20:23], a[112:115], v[220:223]
s_waitcnt lgkmcnt(0)
v_mfma_f32_16x16x32_bf16 v[24:27], a[40:43], a[0:3], v[24:27]
s_add_u32 s32, s32, 0x8000
s_add_u32 s7, s7, 0x8000
ds_read_b128 a[20:23], v9 offset:32768
v_mfma_f32_16x16x32_bf16 v[56:59], a[40:43], a[4:7], v[56:59]
ds_read_b128 a[24:27], v9 offset:34816
ds_read_b128 a[28:31], v9 offset:36864
v_mfma_f32_16x16x32_bf16 v[88:91], a[40:43], a[8:11], v[88:91]
ds_read_b128 a[32:35], v9 offset:38912
ds_read_b128 a[36:39], v11
v_mfma_f32_16x16x32_bf16 v[120:123], a[40:43], a[12:15], v[120:123]
ds_read_b64_tr_b16 a[104:105], v15 offset:6144
ds_read_b64_tr_b16 a[106:107], v15 offset:6400
v_mfma_f32_16x16x32_bf16 v[124:127], a[44:47], a[12:15], v[124:127]
ds_read_b64_tr_b16 a[108:109], v14 offset:10240
ds_read_b64_tr_b16 a[110:111], v14 offset:10496
v_mfma_f32_16x16x32_bf16 v[92:95], a[44:47], a[8:11], v[92:95]
ds_read_b64_tr_b16 a[112:113], v15 offset:10240
ds_read_b64_tr_b16 a[114:115], v15 offset:10496
v_mfma_f32_16x16x32_bf16 v[60:63], a[44:47], a[4:7], v[60:63]
ds_read_b64_tr_b16 a[40:41], v12 offset:8192
v_mfma_f32_16x16x32_bf16 v[28:31], a[44:47], a[0:3], v[28:31]
ds_read_b64_tr_b16 a[42:43], v12 offset:9216
v_mfma_f32_16x16x32_bf16 v[32:35], a[48:51], a[0:3], v[32:35]
ds_read_b64_tr_b16 a[44:45], v13 offset:8192
v_mfma_f32_16x16x32_bf16 v[64:67], a[48:51], a[4:7], v[64:67]
ds_read_b64_tr_b16 a[46:47], v13 offset:9216
v_mfma_f32_16x16x32_bf16 v[96:99], a[48:51], a[8:11], v[96:99]
v_mfma_f32_16x16x32_bf16 v[128:131], a[48:51], a[12:15], v[128:131]
ds_read_b64_tr_b16 a[48:49], v12 offset:8448
v_mfma_f32_16x16x32_bf16 v[132:135], a[52:55], a[12:15], v[132:135]
ds_read_b64_tr_b16 a[50:51], v12 offset:9472
v_mfma_f32_16x16x32_bf16 v[100:103], a[52:55], a[8:11], v[100:103]
v_mfma_f32_16x16x32_bf16 v[68:71], a[52:55], a[4:7], v[68:71]
v_mfma_f32_16x16x32_bf16 v[36:39], a[52:55], a[0:3], v[36:39]
ds_read_b64_tr_b16 a[52:53], v13 offset:8448
v_mfma_f32_16x16x32_bf16 v[40:43], a[56:59], a[0:3], v[40:43]
ds_read_b64_tr_b16 a[54:55], v13 offset:9472
v_mfma_f32_16x16x32_bf16 v[72:75], a[56:59], a[4:7], v[72:75]
v_mfma_f32_16x16x32_bf16 v[104:107], a[56:59], a[8:11], v[104:107]
v_mfma_f32_16x16x32_bf16 v[136:139], a[56:59], a[12:15], v[136:139]
ds_read_b64_tr_b16 a[56:57], v12 offset:8704
v_mfma_f32_16x16x32_bf16 v[140:143], a[60:63], a[12:15], v[140:143]
ds_read_b64_tr_b16 a[58:59], v12 offset:9728
v_mfma_f32_16x16x32_bf16 v[108:111], a[60:63], a[8:11], v[108:111]
v_mfma_f32_16x16x32_bf16 v[76:79], a[60:63], a[4:7], v[76:79]
v_mfma_f32_16x16x32_bf16 v[44:47], a[60:63], a[0:3], v[44:47]
ds_read_b64_tr_b16 a[60:61], v13 offset:8704
v_mfma_f32_16x16x32_bf16 v[48:51], a[64:67], a[0:3], v[48:51]
ds_read_b64_tr_b16 a[62:63], v13 offset:9728
v_mfma_f32_16x16x32_bf16 v[80:83], a[64:67], a[4:7], v[80:83]
v_mfma_f32_16x16x32_bf16 v[112:115], a[64:67], a[8:11], v[112:115]
v_mfma_f32_16x16x32_bf16 v[144:147], a[64:67], a[12:15], v[144:147]
ds_read_b64_tr_b16 a[64:65], v12 offset:8960
v_mfma_f32_16x16x32_bf16 v[148:151], a[68:71], a[12:15], v[148:151]
ds_read_b64_tr_b16 a[66:67], v12 offset:9984
v_mfma_f32_16x16x32_bf16 v[116:119], a[68:71], a[8:11], v[116:119]
v_mfma_f32_16x16x32_bf16 v[84:87], a[68:71], a[4:7], v[84:87]
v_mfma_f32_16x16x32_bf16 v[52:55], a[68:71], a[0:3], v[52:55]
ds_read_b64_tr_b16 a[68:69], v13 offset:8960
v_mfma_f32_16x16x32_bf16 v[152:155], a[72:75], a[0:3], v[152:155]
ds_read_b64_tr_b16 a[70:71], v13 offset:9984
v_mfma_f32_16x16x32_bf16 v[160:163], a[72:75], a[4:7], v[160:163]
v_mfma_f32_16x16x32_bf16 v[168:171], a[72:75], a[8:11], v[168:171]
v_mfma_f32_16x16x32_bf16 v[176:179], a[72:75], a[12:15], v[176:179]
ds_read_b64_tr_b16 a[72:73], v14 offset:2048
v_mfma_f32_16x16x32_bf16 v[180:183], a[76:79], a[12:15], v[180:183]
ds_read_b64_tr_b16 a[74:75], v14 offset:2304
v_mfma_f32_16x16x32_bf16 v[172:175], a[76:79], a[8:11], v[172:175]
v_mfma_f32_16x16x32_bf16 v[164:167], a[76:79], a[4:7], v[164:167]
v_mfma_f32_16x16x32_bf16 v[156:159], a[76:79], a[0:3], v[156:159]
ds_read_b64_tr_b16 a[76:77], v15 offset:2048
v_mfma_f32_16x16x32_bf16 v[184:187], a[80:83], a[0:3], v[184:187]
ds_read_b64_tr_b16 a[78:79], v15 offset:2304
v_mfma_f32_16x16x32_bf16 v[192:195], a[80:83], a[4:7], v[192:195]
v_mfma_f32_16x16x32_bf16 v[200:203], a[80:83], a[8:11], v[200:203]
v_mfma_f32_16x16x32_bf16 v[208:211], a[80:83], a[12:15], v[208:211]
v_mfma_f32_16x16x32_bf16 v[248:251], a[80:83], a[16:19], v[248:251]
ds_read_b64_tr_b16 a[80:81], v14 offset:6144
v_mfma_f32_16x16x32_bf16 v[212:215], a[84:87], a[12:15], v[212:215]
ds_read_b64_tr_b16 a[82:83], v14 offset:6400
v_mfma_f32_16x16x32_bf16 v[204:207], a[84:87], a[8:11], v[204:207]
v_mfma_f32_16x16x32_bf16 v[196:199], a[84:87], a[4:7], v[196:199]
v_mfma_f32_16x16x32_bf16 v[188:191], a[84:87], a[0:3], v[188:191]
v_mfma_f32_16x16x32_bf16 v[216:219], a[0:3], a[88:91], v[216:219]
v_mfma_f32_16x16x32_bf16 v[224:227], a[4:7], a[88:91], v[224:227]
v_mfma_f32_16x16x32_bf16 v[232:235], a[8:11], a[88:91], v[232:235]
v_mfma_f32_16x16x32_bf16 v[240:243], a[12:15], a[88:91], v[240:243]
v_mfma_f32_16x16x32_bf16 v[252:255], a[16:19], a[88:91], v[252:255]
v_mfma_f32_16x16x32_bf16 v[244:247], a[12:15], a[92:95], v[244:247]
v_mfma_f32_16x16x32_bf16 v[236:239], a[8:11], a[92:95], v[236:239]
v_add_u32 v12, 0xffff0000, v12
v_add_u32 v13, 0xffff0000, v13
v_mfma_f32_16x16x32_bf16 v[228:231], a[4:7], a[92:95], v[228:231]
v_add_u32 v14, 0xffff0000, v14
v_add_u32 v15, 0xffff0000, v15
v_mfma_f32_16x16x32_bf16 v[220:223], a[0:3], a[92:95], v[220:223]
v_add_u32 v10, 0xffff0000, v10
v_add_u32 v11, 0xffff0000, v11
s_waitcnt lgkmcnt(0)
s_barrier
v_mfma_f32_16x16x32_bf16 v[24:27], a[40:43], a[20:23], v[24:27]
v_mfma_f32_16x16x32_bf16 v[56:59], a[40:43], a[24:27], v[56:59]
v_mfma_f32_16x16x32_bf16 v[88:91], a[40:43], a[28:31], v[88:91]
v_mfma_f32_16x16x32_bf16 v[120:123], a[40:43], a[32:35], v[120:123]
v_mfma_f32_16x16x32_bf16 v[124:127], a[44:47], a[32:35], v[124:127]
v_mfma_f32_16x16x32_bf16 v[92:95], a[44:47], a[28:31], v[92:95]
v_mfma_f32_16x16x32_bf16 v[60:63], a[44:47], a[24:27], v[60:63]
v_mfma_f32_16x16x32_bf16 v[28:31], a[44:47], a[20:23], v[28:31]
v_mfma_f32_16x16x32_bf16 v[32:35], a[48:51], a[20:23], v[32:35]
v_mfma_f32_16x16x32_bf16 v[64:67], a[48:51], a[24:27], v[64:67]
v_mfma_f32_16x16x32_bf16 v[96:99], a[48:51], a[28:31], v[96:99]
v_mfma_f32_16x16x32_bf16 v[128:131], a[48:51], a[32:35], v[128:131]
v_mfma_f32_16x16x32_bf16 v[132:135], a[52:55], a[32:35], v[132:135]
v_mfma_f32_16x16x32_bf16 v[100:103], a[52:55], a[28:31], v[100:103]
v_mfma_f32_16x16x32_bf16 v[68:71], a[52:55], a[24:27], v[68:71]
v_mfma_f32_16x16x32_bf16 v[36:39], a[52:55], a[20:23], v[36:39]
v_mfma_f32_16x16x32_bf16 v[40:43], a[56:59], a[20:23], v[40:43]
v_mfma_f32_16x16x32_bf16 v[72:75], a[56:59], a[24:27], v[72:75]
v_mfma_f32_16x16x32_bf16 v[104:107], a[56:59], a[28:31], v[104:107]
v_mfma_f32_16x16x32_bf16 v[136:139], a[56:59], a[32:35], v[136:139]
v_mfma_f32_16x16x32_bf16 v[140:143], a[60:63], a[32:35], v[140:143]
v_mfma_f32_16x16x32_bf16 v[108:111], a[60:63], a[28:31], v[108:111]
v_mfma_f32_16x16x32_bf16 v[76:79], a[60:63], a[24:27], v[76:79]
v_mfma_f32_16x16x32_bf16 v[44:47], a[60:63], a[20:23], v[44:47]
v_mfma_f32_16x16x32_bf16 v[48:51], a[64:67], a[20:23], v[48:51]
v_mfma_f32_16x16x32_bf16 v[80:83], a[64:67], a[24:27], v[80:83]
v_mfma_f32_16x16x32_bf16 v[112:115], a[64:67], a[28:31], v[112:115]
v_mfma_f32_16x16x32_bf16 v[144:147], a[64:67], a[32:35], v[144:147]
v_mfma_f32_16x16x32_bf16 v[148:151], a[68:71], a[32:35], v[148:151]
v_mfma_f32_16x16x32_bf16 v[116:119], a[68:71], a[28:31], v[116:119]
v_mfma_f32_16x16x32_bf16 v[84:87], a[68:71], a[24:27], v[84:87]
v_mfma_f32_16x16x32_bf16 v[52:55], a[68:71], a[20:23], v[52:55]
v_mfma_f32_16x16x32_bf16 v[152:155], a[72:75], a[20:23], v[152:155]
v_mfma_f32_16x16x32_bf16 v[160:163], a[72:75], a[24:27], v[160:163]
v_mfma_f32_16x16x32_bf16 v[168:171], a[72:75], a[28:31], v[168:171]
v_mfma_f32_16x16x32_bf16 v[176:179], a[72:75], a[32:35], v[176:179]
v_mfma_f32_16x16x32_bf16 v[180:183], a[76:79], a[32:35], v[180:183]
v_mfma_f32_16x16x32_bf16 v[172:175], a[76:79], a[28:31], v[172:175]
v_mfma_f32_16x16x32_bf16 v[164:167], a[76:79], a[24:27], v[164:167]
v_mfma_f32_16x16x32_bf16 v[156:159], a[76:79], a[20:23], v[156:159]
v_mfma_f32_16x16x32_bf16 v[184:187], a[80:83], a[20:23], v[184:187]
v_mfma_f32_16x16x32_bf16 v[192:195], a[80:83], a[24:27], v[192:195]
v_mfma_f32_16x16x32_bf16 v[200:203], a[80:83], a[28:31], v[200:203]
v_mfma_f32_16x16x32_bf16 v[208:211], a[80:83], a[32:35], v[208:211]
v_mfma_f32_16x16x32_bf16 v[248:251], a[80:83], a[36:39], v[248:251]
v_mfma_f32_16x16x32_bf16 v[212:215], a[104:107], a[32:35], v[212:215]
v_mfma_f32_16x16x32_bf16 v[204:207], a[104:107], a[28:31], v[204:207]
v_mfma_f32_16x16x32_bf16 v[196:199], a[104:107], a[24:27], v[196:199]
v_mfma_f32_16x16x32_bf16 v[188:191], a[104:107], a[20:23], v[188:191]
v_mfma_f32_16x16x32_bf16 v[216:219], a[20:23], a[108:111], v[216:219]
v_mfma_f32_16x16x32_bf16 v[224:227], a[24:27], a[108:111], v[224:227]
v_mfma_f32_16x16x32_bf16 v[232:235], a[28:31], a[108:111], v[232:235]
v_mfma_f32_16x16x32_bf16 v[240:243], a[32:35], a[108:111], v[240:243]
v_mfma_f32_16x16x32_bf16 v[252:255], a[36:39], a[108:111], v[252:255]
v_mfma_f32_16x16x32_bf16 v[244:247], a[32:35], a[112:115], v[244:247]
v_mfma_f32_16x16x32_bf16 v[236:239], a[28:31], a[112:115], v[236:239]
v_mfma_f32_16x16x32_bf16 v[228:231], a[24:27], a[112:115], v[228:231]
v_mfma_f32_16x16x32_bf16 v[220:223], a[20:23], a[112:115], v[220:223]
s_lshl_b32 s8, s4, 11
s_add_u32 s9, s8, 65536
v_add_u32 v17, s9, v16
s_sub_u32 s9, 79872, s8
v_add_u32 v18, s9, v16
s_lshr_b32 s8, s4, 1
s_lshl_b32 s8, s8, 14
s_and_b32 s9, s4, 1
s_lshl_b32 s9, s9, 3
s_add_u32 s8, s8, s9
s_add_u32 s8, s8, 65536
v_add_u32 v19, s8, v16
v_cvt_pk_bf16_f32 v248, v248, v249
v_cvt_pk_bf16_f32 v249, v250, v251
v_cvt_pk_bf16_f32 v250, v252, v253
v_cvt_pk_bf16_f32 v251, v254, v255
ds_write_b64 v19, v[248:249]
ds_write_b64 v19, v[250:251] offset:1024
s_bitcmp1_b32 s4, 0
s_cbranch_scc1 L_bx_odd
v_cvt_pk_bf16_f32 v184, v184, v185
v_cvt_pk_bf16_f32 v185, v186, v187
v_cvt_pk_bf16_f32 v186, v188, v189
v_cvt_pk_bf16_f32 v187, v190, v191
v_cvt_pk_bf16_f32 v192, v192, v193
v_cvt_pk_bf16_f32 v193, v194, v195
v_cvt_pk_bf16_f32 v194, v196, v197
v_cvt_pk_bf16_f32 v195, v198, v199
v_cvt_pk_bf16_f32 v200, v200, v201
v_cvt_pk_bf16_f32 v201, v202, v203
v_cvt_pk_bf16_f32 v202, v204, v205
v_cvt_pk_bf16_f32 v203, v206, v207
v_cvt_pk_bf16_f32 v208, v208, v209
v_cvt_pk_bf16_f32 v209, v210, v211
v_cvt_pk_bf16_f32 v210, v212, v213
v_cvt_pk_bf16_f32 v211, v214, v215
v_cvt_pk_bf16_f32 v216, v216, v217
v_cvt_pk_bf16_f32 v217, v218, v219
v_cvt_pk_bf16_f32 v218, v220, v221
v_cvt_pk_bf16_f32 v219, v222, v223
v_cvt_pk_bf16_f32 v224, v224, v225
v_cvt_pk_bf16_f32 v225, v226, v227
v_cvt_pk_bf16_f32 v226, v228, v229
v_cvt_pk_bf16_f32 v227, v230, v231
v_cvt_pk_bf16_f32 v232, v232, v233
v_cvt_pk_bf16_f32 v233, v234, v235
v_cvt_pk_bf16_f32 v234, v236, v237
v_cvt_pk_bf16_f32 v235, v238, v239
v_cvt_pk_bf16_f32 v240, v240, v241
v_cvt_pk_bf16_f32 v241, v242, v243
v_cvt_pk_bf16_f32 v242, v244, v245
v_cvt_pk_bf16_f32 v243, v246, v247
v_cvt_pk_bf16_f32 v152, v152, v153
v_cvt_pk_bf16_f32 v153, v154, v155
v_cvt_pk_bf16_f32 v154, v156, v157
v_cvt_pk_bf16_f32 v155, v158, v159
v_cvt_pk_bf16_f32 v160, v160, v161
v_cvt_pk_bf16_f32 v161, v162, v163
v_cvt_pk_bf16_f32 v162, v164, v165
v_cvt_pk_bf16_f32 v163, v166, v167
v_cvt_pk_bf16_f32 v168, v168, v169
v_cvt_pk_bf16_f32 v169, v170, v171
v_cvt_pk_bf16_f32 v170, v172, v173
v_cvt_pk_bf16_f32 v171, v174, v175
v_cvt_pk_bf16_f32 v176, v176, v177
v_cvt_pk_bf16_f32 v177, v178, v179
v_cvt_pk_bf16_f32 v178, v180, v181
v_cvt_pk_bf16_f32 v179, v182, v183
s_branch L_bx_packed
L_bx_odd:
v_cvt_pk_bf16_f32 v187, v186, v187
v_cvt_pk_bf16_f32 v186, v184, v185
v_cvt_pk_bf16_f32 v184, v188, v189
v_cvt_pk_bf16_f32 v185, v190, v191
v_cvt_pk_bf16_f32 v195, v194, v195
v_cvt_pk_bf16_f32 v194, v192, v193
v_cvt_pk_bf16_f32 v192, v196, v197
v_cvt_pk_bf16_f32 v193, v198, v199
v_cvt_pk_bf16_f32 v203, v202, v203
v_cvt_pk_bf16_f32 v202, v200, v201
v_cvt_pk_bf16_f32 v200, v204, v205
v_cvt_pk_bf16_f32 v201, v206, v207
v_cvt_pk_bf16_f32 v211, v210, v211
v_cvt_pk_bf16_f32 v210, v208, v209
v_cvt_pk_bf16_f32 v208, v212, v213
v_cvt_pk_bf16_f32 v209, v214, v215
v_cvt_pk_bf16_f32 v219, v218, v219
v_cvt_pk_bf16_f32 v218, v216, v217
v_cvt_pk_bf16_f32 v216, v220, v221
v_cvt_pk_bf16_f32 v217, v222, v223
v_cvt_pk_bf16_f32 v227, v226, v227
v_cvt_pk_bf16_f32 v226, v224, v225
v_cvt_pk_bf16_f32 v224, v228, v229
v_cvt_pk_bf16_f32 v225, v230, v231
v_cvt_pk_bf16_f32 v235, v234, v235
v_cvt_pk_bf16_f32 v234, v232, v233
v_cvt_pk_bf16_f32 v232, v236, v237
v_cvt_pk_bf16_f32 v233, v238, v239
v_cvt_pk_bf16_f32 v243, v242, v243
v_cvt_pk_bf16_f32 v242, v240, v241
v_cvt_pk_bf16_f32 v240, v244, v245
v_cvt_pk_bf16_f32 v241, v246, v247
v_cvt_pk_bf16_f32 v155, v154, v155
v_cvt_pk_bf16_f32 v154, v152, v153
v_cvt_pk_bf16_f32 v152, v156, v157
v_cvt_pk_bf16_f32 v153, v158, v159
v_cvt_pk_bf16_f32 v163, v162, v163
v_cvt_pk_bf16_f32 v162, v160, v161
v_cvt_pk_bf16_f32 v160, v164, v165
v_cvt_pk_bf16_f32 v161, v166, v167
v_cvt_pk_bf16_f32 v171, v170, v171
v_cvt_pk_bf16_f32 v170, v168, v169
v_cvt_pk_bf16_f32 v168, v172, v173
v_cvt_pk_bf16_f32 v169, v174, v175
v_cvt_pk_bf16_f32 v179, v178, v179
v_cvt_pk_bf16_f32 v178, v176, v177
v_cvt_pk_bf16_f32 v176, v180, v181
v_cvt_pk_bf16_f32 v177, v182, v183
L_bx_packed:
ds_write_b128 v17, v[184:187] offset:2048
ds_write_b128 v17, v[216:219] offset:3072
ds_write_b128 v17, v[200:203] offset:18432
ds_write_b128 v17, v[232:235] offset:19456
s_cmp_eq_u32 s4, 0
s_cbranch_scc1 L_bx_skip
ds_write_b128 v18, v[192:195] offset:2048
ds_write_b128 v18, v[224:227] offset:3072
ds_write_b128 v18, v[208:211] offset:18432
ds_write_b128 v18, v[240:243] offset:19456
L_bx_skip:
s_mov_b32 s8, 0x3e0293ee
s_mov_b32 s9, 0x3e0293ee
v_pk_mul_f32 v[24:25], v[24:25], s[8:9]
v_pk_mul_f32 v[26:27], v[26:27], s[8:9]
v_pk_mul_f32 v[28:29], v[28:29], s[8:9]
v_pk_mul_f32 v[30:31], v[30:31], s[8:9]
v_cvt_pk_bf16_f32 v24, v24, v25
v_cvt_pk_bf16_f32 v25, v26, v27
v_cvt_pk_bf16_f32 v26, v28, v29
v_cvt_pk_bf16_f32 v27, v30, v31
v_accvgpr_write_b32 a160, v24
v_accvgpr_write_b32 a161, v25
v_accvgpr_write_b32 a162, v26
v_accvgpr_write_b32 a163, v27
v_pk_mul_f32 v[32:33], v[32:33], s[8:9]
v_pk_mul_f32 v[34:35], v[34:35], s[8:9]
v_pk_mul_f32 v[36:37], v[36:37], s[8:9]
v_pk_mul_f32 v[38:39], v[38:39], s[8:9]
v_cvt_pk_bf16_f32 v32, v32, v33
v_cvt_pk_bf16_f32 v33, v34, v35
v_cvt_pk_bf16_f32 v34, v36, v37
v_cvt_pk_bf16_f32 v35, v38, v39
v_accvgpr_write_b32 a164, v32
v_accvgpr_write_b32 a165, v33
v_accvgpr_write_b32 a166, v34
v_accvgpr_write_b32 a167, v35
v_pk_mul_f32 v[40:41], v[40:41], s[8:9]
v_pk_mul_f32 v[42:43], v[42:43], s[8:9]
v_pk_mul_f32 v[44:45], v[44:45], s[8:9]
v_pk_mul_f32 v[46:47], v[46:47], s[8:9]
v_cvt_pk_bf16_f32 v40, v40, v41
v_cvt_pk_bf16_f32 v41, v42, v43
v_cvt_pk_bf16_f32 v42, v44, v45
v_cvt_pk_bf16_f32 v43, v46, v47
v_accvgpr_write_b32 a168, v40
v_accvgpr_write_b32 a169, v41
v_accvgpr_write_b32 a170, v42
v_accvgpr_write_b32 a171, v43
v_pk_mul_f32 v[48:49], v[48:49], s[8:9]
v_pk_mul_f32 v[50:51], v[50:51], s[8:9]
v_pk_mul_f32 v[52:53], v[52:53], s[8:9]
v_pk_mul_f32 v[54:55], v[54:55], s[8:9]
v_cvt_pk_bf16_f32 v48, v48, v49
v_cvt_pk_bf16_f32 v49, v50, v51
v_cvt_pk_bf16_f32 v50, v52, v53
v_cvt_pk_bf16_f32 v51, v54, v55
v_accvgpr_write_b32 a172, v48
v_accvgpr_write_b32 a173, v49
v_accvgpr_write_b32 a174, v50
v_accvgpr_write_b32 a175, v51
v_pk_mul_f32 v[56:57], v[56:57], s[8:9]
v_pk_mul_f32 v[58:59], v[58:59], s[8:9]
v_pk_mul_f32 v[60:61], v[60:61], s[8:9]
v_pk_mul_f32 v[62:63], v[62:63], s[8:9]
v_cvt_pk_bf16_f32 v56, v56, v57
v_cvt_pk_bf16_f32 v57, v58, v59
v_cvt_pk_bf16_f32 v58, v60, v61
v_cvt_pk_bf16_f32 v59, v62, v63
v_accvgpr_write_b32 a176, v56
v_accvgpr_write_b32 a177, v57
v_accvgpr_write_b32 a178, v58
v_accvgpr_write_b32 a179, v59
v_pk_mul_f32 v[64:65], v[64:65], s[8:9]
v_pk_mul_f32 v[66:67], v[66:67], s[8:9]
v_pk_mul_f32 v[68:69], v[68:69], s[8:9]
v_pk_mul_f32 v[70:71], v[70:71], s[8:9]
v_cvt_pk_bf16_f32 v64, v64, v65
v_cvt_pk_bf16_f32 v65, v66, v67
v_cvt_pk_bf16_f32 v66, v68, v69
v_cvt_pk_bf16_f32 v67, v70, v71
v_accvgpr_write_b32 a180, v64
v_accvgpr_write_b32 a181, v65
v_accvgpr_write_b32 a182, v66
v_accvgpr_write_b32 a183, v67
v_pk_mul_f32 v[72:73], v[72:73], s[8:9]
v_pk_mul_f32 v[74:75], v[74:75], s[8:9]
v_pk_mul_f32 v[76:77], v[76:77], s[8:9]
v_pk_mul_f32 v[78:79], v[78:79], s[8:9]
v_cvt_pk_bf16_f32 v72, v72, v73
v_cvt_pk_bf16_f32 v73, v74, v75
v_cvt_pk_bf16_f32 v74, v76, v77
v_cvt_pk_bf16_f32 v75, v78, v79
v_accvgpr_write_b32 a184, v72
v_accvgpr_write_b32 a185, v73
v_accvgpr_write_b32 a186, v74
v_accvgpr_write_b32 a187, v75
v_pk_mul_f32 v[80:81], v[80:81], s[8:9]
v_pk_mul_f32 v[82:83], v[82:83], s[8:9]
v_pk_mul_f32 v[84:85], v[84:85], s[8:9]
v_pk_mul_f32 v[86:87], v[86:87], s[8:9]
v_cvt_pk_bf16_f32 v80, v80, v81
v_cvt_pk_bf16_f32 v81, v82, v83
v_cvt_pk_bf16_f32 v82, v84, v85
v_cvt_pk_bf16_f32 v83, v86, v87
v_accvgpr_write_b32 a188, v80
v_accvgpr_write_b32 a189, v81
v_accvgpr_write_b32 a190, v82
v_accvgpr_write_b32 a191, v83
v_pk_mul_f32 v[88:89], v[88:89], s[8:9]
v_pk_mul_f32 v[90:91], v[90:91], s[8:9]
v_pk_mul_f32 v[92:93], v[92:93], s[8:9]
v_pk_mul_f32 v[94:95], v[94:95], s[8:9]
v_cvt_pk_bf16_f32 v88, v88, v89
v_cvt_pk_bf16_f32 v89, v90, v91
v_cvt_pk_bf16_f32 v90, v92, v93
v_cvt_pk_bf16_f32 v91, v94, v95
v_accvgpr_write_b32 a192, v88
v_accvgpr_write_b32 a193, v89
v_accvgpr_write_b32 a194, v90
v_accvgpr_write_b32 a195, v91
v_pk_mul_f32 v[96:97], v[96:97], s[8:9]
v_pk_mul_f32 v[98:99], v[98:99], s[8:9]
v_pk_mul_f32 v[100:101], v[100:101], s[8:9]
v_pk_mul_f32 v[102:103], v[102:103], s[8:9]
v_cvt_pk_bf16_f32 v96, v96, v97
v_cvt_pk_bf16_f32 v97, v98, v99
v_cvt_pk_bf16_f32 v98, v100, v101
v_cvt_pk_bf16_f32 v99, v102, v103
v_accvgpr_write_b32 a196, v96
v_accvgpr_write_b32 a197, v97
v_accvgpr_write_b32 a198, v98
v_accvgpr_write_b32 a199, v99
v_pk_mul_f32 v[104:105], v[104:105], s[8:9]
v_pk_mul_f32 v[106:107], v[106:107], s[8:9]
v_pk_mul_f32 v[108:109], v[108:109], s[8:9]
v_pk_mul_f32 v[110:111], v[110:111], s[8:9]
v_cvt_pk_bf16_f32 v104, v104, v105
v_cvt_pk_bf16_f32 v105, v106, v107
v_cvt_pk_bf16_f32 v106, v108, v109
v_cvt_pk_bf16_f32 v107, v110, v111
v_accvgpr_write_b32 a200, v104
v_accvgpr_write_b32 a201, v105
v_accvgpr_write_b32 a202, v106
v_accvgpr_write_b32 a203, v107
v_pk_mul_f32 v[112:113], v[112:113], s[8:9]
v_pk_mul_f32 v[114:115], v[114:115], s[8:9]
v_pk_mul_f32 v[116:117], v[116:117], s[8:9]
v_pk_mul_f32 v[118:119], v[118:119], s[8:9]
v_cvt_pk_bf16_f32 v112, v112, v113
v_cvt_pk_bf16_f32 v113, v114, v115
v_cvt_pk_bf16_f32 v114, v116, v117
v_cvt_pk_bf16_f32 v115, v118, v119
v_accvgpr_write_b32 a204, v112
v_accvgpr_write_b32 a205, v113
v_accvgpr_write_b32 a206, v114
v_accvgpr_write_b32 a207, v115
v_pk_mul_f32 v[120:121], v[120:121], s[8:9]
v_pk_mul_f32 v[122:123], v[122:123], s[8:9]
v_pk_mul_f32 v[124:125], v[124:125], s[8:9]
v_pk_mul_f32 v[126:127], v[126:127], s[8:9]
v_cvt_pk_bf16_f32 v120, v120, v121
v_cvt_pk_bf16_f32 v121, v122, v123
v_cvt_pk_bf16_f32 v122, v124, v125
v_cvt_pk_bf16_f32 v123, v126, v127
v_accvgpr_write_b32 a208, v120
v_accvgpr_write_b32 a209, v121
v_accvgpr_write_b32 a210, v122
v_accvgpr_write_b32 a211, v123
v_pk_mul_f32 v[128:129], v[128:129], s[8:9]
v_pk_mul_f32 v[130:131], v[130:131], s[8:9]
v_pk_mul_f32 v[132:133], v[132:133], s[8:9]
v_pk_mul_f32 v[134:135], v[134:135], s[8:9]
v_cvt_pk_bf16_f32 v128, v128, v129
v_cvt_pk_bf16_f32 v129, v130, v131
v_cvt_pk_bf16_f32 v130, v132, v133
v_cvt_pk_bf16_f32 v131, v134, v135
v_accvgpr_write_b32 a212, v128
v_accvgpr_write_b32 a213, v129
v_accvgpr_write_b32 a214, v130
v_accvgpr_write_b32 a215, v131
v_pk_mul_f32 v[136:137], v[136:137], s[8:9]
v_pk_mul_f32 v[138:139], v[138:139], s[8:9]
v_pk_mul_f32 v[140:141], v[140:141], s[8:9]
v_pk_mul_f32 v[142:143], v[142:143], s[8:9]
v_cvt_pk_bf16_f32 v136, v136, v137
v_cvt_pk_bf16_f32 v137, v138, v139
v_cvt_pk_bf16_f32 v138, v140, v141
v_cvt_pk_bf16_f32 v139, v142, v143
v_accvgpr_write_b32 a216, v136
v_accvgpr_write_b32 a217, v137
v_accvgpr_write_b32 a218, v138
v_accvgpr_write_b32 a219, v139
v_pk_mul_f32 v[144:145], v[144:145], s[8:9]
v_pk_mul_f32 v[146:147], v[146:147], s[8:9]
v_pk_mul_f32 v[148:149], v[148:149], s[8:9]
v_pk_mul_f32 v[150:151], v[150:151], s[8:9]
v_cvt_pk_bf16_f32 v144, v144, v145
v_cvt_pk_bf16_f32 v145, v146, v147
v_cvt_pk_bf16_f32 v146, v148, v149
v_cvt_pk_bf16_f32 v147, v150, v151
v_accvgpr_write_b32 a220, v144
v_accvgpr_write_b32 a221, v145
v_accvgpr_write_b32 a222, v146
v_accvgpr_write_b32 a223, v147
s_waitcnt lgkmcnt(0)
s_barrier
ds_read_b128 v[188:191], v17 offset:0
ds_read_b64 v[24:25], v17 offset:1024
ds_read_b64 v[28:29], v17 offset:1032
ds_read_b128 v[196:199], v18 offset:0
ds_read_b64 v[32:33], v18 offset:1024
ds_read_b64 v[36:37], v18 offset:1032
ds_read_b128 v[204:207], v17 offset:16384
ds_read_b64 v[40:41], v17 offset:17408
ds_read_b64 v[44:45], v17 offset:17416
ds_read_b128 v[212:215], v18 offset:16384
ds_read_b64 v[48:49], v18 offset:17408
ds_read_b64 v[52:53], v18 offset:17416
v_and_b32 v104, 15, v0
v_lshrrev_b32 v105, 4, v0
v_lshlrev_b32 v105, 2, v105
v_sub_u32 v104, v104, v105
v_mov_b32 v107, 0xf149f2ca
s_or_b32 s8, s6, s4
s_cmp_eq_u32 s8, 0
s_cselect_b32 s8, 0xf149f2ca, 0
v_add_u32 v105, 16, v104
v_and_b32 v105, 0xfffffff1, v105
v_cmp_eq_u32 s[36:37], 0, v105
v_add_u32 v105, 15, v104
v_and_b32 v105, 0xfffffff1, v105
v_cmp_eq_u32 s[38:39], 0, v105
v_add_u32 v105, 14, v104
v_and_b32 v105, 0xfffffff1, v105
v_cmp_eq_u32 s[40:41], 0, v105
v_add_u32 v105, 13, v104
v_and_b32 v105, 0xfffffff1, v105
v_cmp_eq_u32 s[42:43], 0, v105
s_nop 1
v_cndmask_b32 v92, v107, 0, s[36:37]
v_cndmask_b32 v93, v107, 0, s[38:39]
v_cndmask_b32 v94, v107, 0, s[40:41]
v_cndmask_b32 v95, v107, 0, s[42:43]
v_add_u32 v105, 0, v104
v_and_b32 v105, 0xfffffff1, v105
v_cmp_eq_u32 s[36:37], 0, v105
v_add_u32 v105, -1, v104
v_and_b32 v105, 0xfffffff1, v105
v_cmp_eq_u32 s[38:39], 0, v105
v_add_u32 v105, -2, v104
v_and_b32 v105, 0xfffffff1, v105
v_cmp_eq_u32 s[40:41], 0, v105
v_add_u32 v105, -3, v104
v_and_b32 v105, 0xfffffff1, v105
v_cmp_eq_u32 s[42:43], 0, v105
s_nop 1
v_cndmask_b32 v96, v107, 0, s[36:37]
v_cndmask_b32 v97, v107, 0, s[38:39]
v_cndmask_b32 v98, v107, 0, s[40:41]
v_cndmask_b32 v99, v107, 0, s[42:43]
v_min_f32 v88, s8, v92
v_mov_b32 v140, 0x3f803f80
v_min_f32 v89, s8, v93
v_mov_b32 v141, 0x3f803f80
v_min_f32 v90, s8, v94
v_mov_b32 v142, 0x3f803f80
v_min_f32 v91, s8, v95
v_mov_b32 v143, 0x3f803f80
v_mov_b32 v26, v216
v_mov_b32 v27, v217
v_mov_b32 v30, v218
v_mov_b32 v31, v219
v_mov_b32 v34, v224
v_mov_b32 v35, v225
v_mov_b32 v38, v226
v_mov_b32 v39, v227
v_mov_b32 v42, v232
v_mov_b32 v43, v233
v_mov_b32 v46, v234
v_mov_b32 v47, v235
v_mov_b32 v50, v240
v_mov_b32 v51, v241
v_mov_b32 v54, v242
v_mov_b32 v55, v243
v_mfma_f32_16x16x32_bf16 v[60:63], v[184:187], v[152:155], v[96:99]
v_mfma_f32_16x16x32_bf16 v[68:71], v[192:195], v[160:163], v[96:99]
v_mfma_f32_16x16x32_bf16 v[76:79], v[200:203], v[168:171], v[96:99]
v_mfma_f32_16x16x32_bf16 v[84:87], v[208:211], v[176:179], v[96:99]
s_waitcnt lgkmcnt(11)
v_mfma_f32_16x16x32_bf16 v[56:59], v[188:191], v[152:155], v[88:91]
s_waitcnt lgkmcnt(8)
v_mfma_f32_16x16x32_bf16 v[64:67], v[196:199], v[160:163], v[92:95]
s_waitcnt lgkmcnt(5)
v_mfma_f32_16x16x32_bf16 v[72:75], v[204:207], v[168:171], v[92:95]
s_waitcnt lgkmcnt(2)
v_mfma_f32_16x16x32_bf16 v[80:83], v[212:215], v[176:179], v[92:95]
s_mov_b32 s8, 0x3e8293ee
s_mul_i32 s9, s6, 0x140000
s_sub_u32 s10, 0x12c0000, s9
s_lshl_b32 s11, s5, 13
s_add_u32 s11, s11, 0x2200000
s_add_u32 s9, s9, s11
s_add_u32 s10, s10, s11
s_lshl_b32 s11, s4, 10
s_add_u32 s28, s9, s11
s_add_u32 s30, s10, s11
s_sub_u32 s11, 0x1c00, s11
s_add_u32 s29, s9, s11
s_add_u32 s31, s10, s11
v_max3_f32 v100, v56, v57, v58
v_max3_f32 v100, v100, v59, v60
v_max3_f32 v100, v100, v61, v62
v_max_f32 v100, v100, v63
v_max3_f32 v101, v64, v65, v66
v_max3_f32 v101, v101, v67, v68
v_max3_f32 v101, v101, v69, v70
v_max_f32 v101, v101, v71
v_max3_f32 v102, v72, v73, v74
v_max3_f32 v102, v102, v75, v76
v_max3_f32 v102, v102, v77, v78
v_max_f32 v102, v102, v79
v_max3_f32 v103, v80, v81, v82
v_max3_f32 v103, v103, v83, v84
v_max3_f32 v103, v103, v85, v86
v_max_f32 v103, v103, v87
v_mov_b32 v104, v100
v_mov_b32 v105, v101
v_mov_b32 v106, v102
v_mov_b32 v107, v103
s_nop 1
v_permlane16_swap_b32 v104, v100
v_permlane16_swap_b32 v105, v101
v_permlane16_swap_b32 v106, v102
v_permlane16_swap_b32 v107, v103
v_max_f32 v100, v100, v104
v_max_f32 v101, v101, v105
v_max_f32 v102, v102, v106
v_max_f32 v103, v103, v107
v_mov_b32 v104, v100
v_mov_b32 v105, v101
v_mov_b32 v106, v102
v_mov_b32 v107, v103
s_nop 1
v_permlane32_swap_b32 v104, v100
v_permlane32_swap_b32 v105, v101
v_permlane32_swap_b32 v106, v102
v_permlane32_swap_b32 v107, v103
v_max_f32 v100, v100, v104
v_max_f32 v101, v101, v105
v_max_f32 v102, v102, v106
v_max_f32 v103, v103, v107
v_mul_f32 v100, s8, v100
v_mul_f32 v101, s8, v101
v_mul_f32 v102, s8, v102
v_mul_f32 v103, s8, v103
v_fma_f32 v56, v56, s8, -v100
v_fma_f32 v57, v57, s8, -v100
v_fma_f32 v58, v58, s8, -v100
v_fma_f32 v59, v59, s8, -v100
v_fma_f32 v60, v60, s8, -v100
v_fma_f32 v61, v61, s8, -v100
v_fma_f32 v62, v62, s8, -v100
v_fma_f32 v63, v63, s8, -v100
v_exp_f32 v56, v56
v_exp_f32 v57, v57
v_exp_f32 v58, v58
v_exp_f32 v59, v59
v_exp_f32 v60, v60
v_exp_f32 v61, v61
v_exp_f32 v62, v62
v_exp_f32 v63, v63
v_fma_f32 v64, v64, s8, -v101
v_fma_f32 v65, v65, s8, -v101
v_fma_f32 v66, v66, s8, -v101
v_fma_f32 v67, v67, s8, -v101
v_fma_f32 v68, v68, s8, -v101
v_fma_f32 v69, v69, s8, -v101
v_fma_f32 v70, v70, s8, -v101
v_fma_f32 v71, v71, s8, -v101
v_exp_f32 v64, v64
v_exp_f32 v65, v65
v_exp_f32 v66, v66
v_exp_f32 v67, v67
v_exp_f32 v68, v68
v_exp_f32 v69, v69
v_exp_f32 v70, v70
v_exp_f32 v71, v71
v_fma_f32 v72, v72, s8, -v102
v_fma_f32 v73, v73, s8, -v102
v_fma_f32 v74, v74, s8, -v102
v_fma_f32 v75, v75, s8, -v102
v_fma_f32 v76, v76, s8, -v102
v_fma_f32 v77, v77, s8, -v102
v_fma_f32 v78, v78, s8, -v102
v_fma_f32 v79, v79, s8, -v102
v_exp_f32 v72, v72
v_exp_f32 v73, v73
v_exp_f32 v74, v74
v_exp_f32 v75, v75
v_exp_f32 v76, v76
v_exp_f32 v77, v77
v_exp_f32 v78, v78
v_exp_f32 v79, v79
v_fma_f32 v80, v80, s8, -v103
v_fma_f32 v81, v81, s8, -v103
v_fma_f32 v82, v82, s8, -v103
v_fma_f32 v83, v83, s8, -v103
v_fma_f32 v84, v84, s8, -v103
v_fma_f32 v85, v85, s8, -v103
v_fma_f32 v86, v86, s8, -v103
v_fma_f32 v87, v87, s8, -v103
v_exp_f32 v80, v80
v_exp_f32 v81, v81
v_exp_f32 v82, v82
v_exp_f32 v83, v83
v_exp_f32 v84, v84
v_exp_f32 v85, v85
v_exp_f32 v86, v86
v_exp_f32 v87, v87
v_cvt_pk_bf16_f32 v56, v56, v57
v_cvt_pk_bf16_f32 v57, v58, v59
v_cvt_pk_bf16_f32 v58, v60, v61
v_cvt_pk_bf16_f32 v59, v62, v63
v_cvt_pk_bf16_f32 v64, v64, v65
v_cvt_pk_bf16_f32 v65, v66, v67
v_cvt_pk_bf16_f32 v66, v68, v69
v_cvt_pk_bf16_f32 v67, v70, v71
v_cvt_pk_bf16_f32 v72, v72, v73
v_cvt_pk_bf16_f32 v73, v74, v75
v_cvt_pk_bf16_f32 v74, v76, v77
v_cvt_pk_bf16_f32 v75, v78, v79
v_cvt_pk_bf16_f32 v80, v80, v81
v_cvt_pk_bf16_f32 v81, v82, v83
v_cvt_pk_bf16_f32 v82, v84, v85
v_cvt_pk_bf16_f32 v83, v86, v87
s_nop 0
v_mfma_f32_16x16x32_bf16 v[156:159], v[140:143], v[56:59], 0
v_mfma_f32_16x16x32_bf16 v[164:167], v[140:143], v[64:67], 0
v_mfma_f32_16x16x32_bf16 v[172:175], v[140:143], v[72:75], 0
v_mfma_f32_16x16x32_bf16 v[180:183], v[140:143], v[80:83], 0
v_mfma_f32_16x16x32_bf16 v[108:111], v[24:27], v[56:59], 0
v_mfma_f32_16x16x32_bf16 v[112:115], v[28:31], v[56:59], 0
v_mfma_f32_16x16x32_bf16 v[116:119], v[32:35], v[64:67], 0
v_mfma_f32_16x16x32_bf16 v[120:123], v[36:39], v[64:67], 0
v_mfma_f32_16x16x32_bf16 v[124:127], v[40:43], v[72:75], 0
v_mfma_f32_16x16x32_bf16 v[128:131], v[44:47], v[72:75], 0
s_waitcnt lgkmcnt(1)
v_mfma_f32_16x16x32_bf16 v[132:135], v[48:51], v[80:83], 0
s_waitcnt lgkmcnt(0)
v_mfma_f32_16x16x32_bf16 v[136:139], v[52:55], v[80:83], 0
v_rcp_f32 v100, v156
v_rcp_f32 v101, v164
v_rcp_f32 v102, v172
v_rcp_f32 v103, v180
s_nop 3
v_mul_f32 v108, v100, v108
v_mul_f32 v109, v100, v109
v_mul_f32 v110, v100, v110
v_mul_f32 v111, v100, v111
v_mul_f32 v112, v100, v112
v_mul_f32 v113, v100, v113
v_mul_f32 v114, v100, v114
v_mul_f32 v115, v100, v115
v_cvt_pk_bf16_f32 v108, v108, v109
v_cvt_pk_bf16_f32 v109, v110, v111
v_cvt_pk_bf16_f32 v110, v112, v113
v_cvt_pk_bf16_f32 v111, v114, v115
buffer_store_dwordx4 v[108:111], v16, s[88:91], s28 offen sc1
v_mul_f32 v116, v101, v116
v_mul_f32 v117, v101, v117
v_mul_f32 v118, v101, v118
v_mul_f32 v119, v101, v119
v_mul_f32 v120, v101, v120
v_mul_f32 v121, v101, v121
v_mul_f32 v122, v101, v122
v_mul_f32 v123, v101, v123
v_cvt_pk_bf16_f32 v116, v116, v117
v_cvt_pk_bf16_f32 v117, v118, v119
v_cvt_pk_bf16_f32 v118, v120, v121
v_cvt_pk_bf16_f32 v119, v122, v123
buffer_store_dwordx4 v[116:119], v16, s[88:91], s29 offen sc1
v_mul_f32 v124, v102, v124
v_mul_f32 v125, v102, v125
v_mul_f32 v126, v102, v126
v_mul_f32 v127, v102, v127
v_mul_f32 v128, v102, v128
v_mul_f32 v129, v102, v129
v_mul_f32 v130, v102, v130
v_mul_f32 v131, v102, v131
v_cvt_pk_bf16_f32 v124, v124, v125
v_cvt_pk_bf16_f32 v125, v126, v127
v_cvt_pk_bf16_f32 v126, v128, v129
v_cvt_pk_bf16_f32 v127, v130, v131
buffer_store_dwordx4 v[124:127], v16, s[88:91], s30 offen sc1
v_mul_f32 v132, v103, v132
v_mul_f32 v133, v103, v133
v_mul_f32 v134, v103, v134
v_mul_f32 v135, v103, v135
v_mul_f32 v136, v103, v136
v_mul_f32 v137, v103, v137
v_mul_f32 v138, v103, v138
v_mul_f32 v139, v103, v139
v_cvt_pk_bf16_f32 v132, v132, v133
v_cvt_pk_bf16_f32 v133, v134, v135
v_cvt_pk_bf16_f32 v134, v136, v137
v_cvt_pk_bf16_f32 v135, v138, v139
buffer_store_dwordx4 v[132:135], v16, s[88:91], s31 offen sc1
s_mul_i32 s8, s5, 0x6000
s_add_u32 s8, s8, 0x40000
s_add_u32 s28, s28, s8
s_add_u32 s29, s29, s8
s_add_u32 s30, s30, s8
s_add_u32 s31, s31, s8
v_mov_b32 v3, v16
s_mov_b32 s33, 0
L_att_start:
s_mov_b64 s[34:35], 0
v_mov_b32 v1, v3
v_add_u32 v2, 98304, v3
v_mov_b32 v4, 0x3f803f80
v_accvgpr_write_b32 a240, v4
v_accvgpr_write_b32 a241, v4
v_accvgpr_write_b32 a242, v4
v_accvgpr_write_b32 a243, v4
v_accvgpr_write_b32 a224, 0
v_accvgpr_write_b32 a225, 0
v_accvgpr_write_b32 a226, 0
v_accvgpr_write_b32 a227, 0
v_accvgpr_write_b32 a228, 0
v_accvgpr_write_b32 a229, 0
v_accvgpr_write_b32 a230, 0
v_accvgpr_write_b32 a231, 0
v_accvgpr_write_b32 a232, 0
v_accvgpr_write_b32 a233, 0
v_accvgpr_write_b32 a234, 0
v_accvgpr_write_b32 a235, 0
v_accvgpr_write_b32 a236, 0
v_accvgpr_write_b32 a237, 0
v_accvgpr_write_b32 a238, 0
v_accvgpr_write_b32 a239, 0
v_mov_b32 v128, 0
v_mov_b32 v129, 0
v_mov_b32 v130, 0
v_mov_b32 v131, 0
v_mov_b32 v132, 0
v_mov_b32 v133, 0
v_mov_b32 v134, 0
v_mov_b32 v135, 0
v_mov_b32 v136, 0
v_mov_b32 v137, 0
v_mov_b32 v138, 0
v_mov_b32 v139, 0
v_mov_b32 v140, 0
v_mov_b32 v141, 0
v_mov_b32 v142, 0
v_mov_b32 v143, 0
v_mov_b32 v144, 0
v_mov_b32 v145, 0
v_mov_b32 v146, 0
v_mov_b32 v147, 0
v_mov_b32 v148, 0
v_mov_b32 v149, 0
v_mov_b32 v150, 0
v_mov_b32 v151, 0
v_mov_b32 v152, 0
v_mov_b32 v153, 0
v_mov_b32 v154, 0
v_mov_b32 v155, 0
v_mov_b32 v156, 0
v_mov_b32 v157, 0
v_mov_b32 v158, 0
v_mov_b32 v159, 0
v_mov_b32 v160, 0
v_mov_b32 v161, 0
v_mov_b32 v162, 0
v_mov_b32 v163, 0
v_mov_b32 v164, 0
v_mov_b32 v165, 0
v_mov_b32 v166, 0
v_mov_b32 v167, 0
v_mov_b32 v168, 0
v_mov_b32 v169, 0
v_mov_b32 v170, 0
v_mov_b32 v171, 0
v_mov_b32 v172, 0
v_mov_b32 v173, 0
v_mov_b32 v174, 0
v_mov_b32 v175, 0
v_mov_b32 v176, 0
v_mov_b32 v177, 0
v_mov_b32 v178, 0
v_mov_b32 v179, 0
v_mov_b32 v180, 0
v_mov_b32 v181, 0
v_mov_b32 v182, 0
v_mov_b32 v183, 0
v_mov_b32 v184, 0
v_mov_b32 v185, 0
v_mov_b32 v186, 0
v_mov_b32 v187, 0
v_mov_b32 v188, 0
v_mov_b32 v189, 0
v_mov_b32 v190, 0
v_mov_b32 v191, 0
v_mov_b32 v192, 0
v_mov_b32 v193, 0
v_mov_b32 v194, 0
v_mov_b32 v195, 0
v_mov_b32 v196, 0
v_mov_b32 v197, 0
v_mov_b32 v198, 0
v_mov_b32 v199, 0
v_mov_b32 v200, 0
v_mov_b32 v201, 0
v_mov_b32 v202, 0
v_mov_b32 v203, 0
v_mov_b32 v204, 0
v_mov_b32 v205, 0
v_mov_b32 v206, 0
v_mov_b32 v207, 0
v_mov_b32 v208, 0
v_mov_b32 v209, 0
v_mov_b32 v210, 0
v_mov_b32 v211, 0
v_mov_b32 v212, 0
v_mov_b32 v213, 0
v_mov_b32 v214, 0
v_mov_b32 v215, 0
v_mov_b32 v216, 0
v_mov_b32 v217, 0
v_mov_b32 v218, 0
v_mov_b32 v219, 0
v_mov_b32 v220, 0
v_mov_b32 v221, 0
v_mov_b32 v222, 0
v_mov_b32 v223, 0
v_mov_b32 v224, 0
v_mov_b32 v225, 0
v_mov_b32 v226, 0
v_mov_b32 v227, 0
v_mov_b32 v228, 0
v_mov_b32 v229, 0
v_mov_b32 v230, 0
v_mov_b32 v231, 0
v_mov_b32 v232, 0
v_mov_b32 v233, 0
v_mov_b32 v234, 0
v_mov_b32 v235, 0
v_mov_b32 v236, 0
v_mov_b32 v237, 0
v_mov_b32 v238, 0
v_mov_b32 v239, 0
v_mov_b32 v240, 0
v_mov_b32 v241, 0
v_mov_b32 v242, 0
v_mov_b32 v243, 0
v_mov_b32 v244, 0
v_mov_b32 v245, 0
v_mov_b32 v246, 0
v_mov_b32 v247, 0
v_mov_b32 v248, 0
v_mov_b32 v249, 0
v_mov_b32 v250, 0
v_mov_b32 v251, 0
v_mov_b32 v252, 0
v_mov_b32 v253, 0
v_mov_b32 v254, 0
v_mov_b32 v255, 0
v_and_b32 v5, 15, v0
v_lshrrev_b32 v6, 4, v0
v_lshlrev_b32 v6, 2, v6
v_sub_u32 v5, v5, v6
v_mov_b32 v6, 0xf149f2ca
s_or_b32 s8, s6, s4
s_lshl_b32 s8, s8, 4
v_add_u32 v7, s8, v5
v_cmp_le_i32 s[36:37], 0, v7
v_cmp_le_i32 s[38:39], 1, v7
v_cmp_le_i32 s[40:41], 2, v7
v_cmp_le_i32 s[42:43], 3, v7
s_nop 1
v_cndmask_b32 v48, v6, 0, s[36:37]
v_cndmask_b32 v49, v6, 0, s[38:39]
v_cndmask_b32 v50, v6, 0, s[40:41]
v_cndmask_b32 v51, v6, 0, s[42:43]
s_waitcnt vmcnt(16)
s_barrier
ds_read_b128 a[0:3], v1 offset:0
ds_read_b128 a[4:7], v1 offset:1024
ds_read_b128 a[8:11], v1 offset:2048
ds_read_b128 a[12:15], v1 offset:3072
ds_read_b128 a[16:19], v1 offset:4096
ds_read_b128 a[20:23], v1 offset:5120
ds_read_b128 a[24:27], v1 offset:6144
ds_read_b128 a[28:31], v1 offset:7168
s_cmp_lg_u32 s33, 0
s_cbranch_scc1 L_att_havemax
s_waitcnt lgkmcnt(7)
v_mfma_f32_16x16x32_bf16 v[16:19], a[0:3], a[160:163], v[48:51]
s_waitcnt lgkmcnt(6)
v_mfma_f32_16x16x32_bf16 v[16:19], a[4:7], a[164:167], v[16:19]
s_waitcnt lgkmcnt(5)
v_mfma_f32_16x16x32_bf16 v[16:19], a[8:11], a[168:171], v[16:19]
s_waitcnt lgkmcnt(4)
v_mfma_f32_16x16x32_bf16 v[16:19], a[12:15], a[172:175], v[16:19]
v_mfma_f32_16x16x32_bf16 v[20:23], a[0:3], a[176:179], 0
v_mfma_f32_16x16x32_bf16 v[20:23], a[4:7], a[180:183], v[20:23]
v_mfma_f32_16x16x32_bf16 v[20:23], a[8:11], a[184:187], v[20:23]
v_mfma_f32_16x16x32_bf16 v[20:23], a[12:15], a[188:191], v[20:23]
v_mfma_f32_16x16x32_bf16 v[24:27], a[0:3], a[192:195], 0
v_mfma_f32_16x16x32_bf16 v[24:27], a[4:7], a[196:199], v[24:27]
v_mfma_f32_16x16x32_bf16 v[24:27], a[8:11], a[200:203], v[24:27]
v_mfma_f32_16x16x32_bf16 v[24:27], a[12:15], a[204:207], v[24:27]
v_mfma_f32_16x16x32_bf16 v[28:31], a[0:3], a[208:211], 0
v_mfma_f32_16x16x32_bf16 v[28:31], a[4:7], a[212:215], v[28:31]
v_mfma_f32_16x16x32_bf16 v[28:31], a[8:11], a[216:219], v[28:31]
v_mfma_f32_16x16x32_bf16 v[28:31], a[12:15], a[220:223], v[28:31]
s_nop 7
v_max3_f32 v8, v16, v17, v18
v_max_f32 v8, v8, v19
v_max3_f32 v9, v20, v21, v22
v_max_f32 v9, v9, v23
v_max3_f32 v10, v24, v25, v26
v_max_f32 v10, v10, v27
v_max3_f32 v11, v28, v29, v30
v_max_f32 v11, v11, v31
v_mov_b32 v12, v8
v_mov_b32 v13, v9
v_mov_b32 v14, v10
v_mov_b32 v15, v11
s_nop 1
v_permlane16_swap_b32 v12, v8
v_permlane16_swap_b32 v13, v9
v_permlane16_swap_b32 v14, v10
v_permlane16_swap_b32 v15, v11
v_max_f32 v8, v8, v12
v_max_f32 v9, v9, v13
v_max_f32 v10, v10, v14
v_max_f32 v11, v11, v15
v_mov_b32 v12, v8
v_mov_b32 v13, v9
v_mov_b32 v14, v10
v_mov_b32 v15, v11
s_nop 1
v_permlane32_swap_b32 v12, v8
v_permlane32_swap_b32 v13, v9
v_permlane32_swap_b32 v14, v10
v_permlane32_swap_b32 v15, v11
v_max_f32 v8, v8, v12
v_max_f32 v9, v9, v13
v_max_f32 v10, v10, v14
v_max_f32 v11, v11, v15
L_att_havemax:
v_sub_f32 v80, 0, v8
v_sub_f32 v81, 0, v8
v_sub_f32 v82, 0, v8
v_sub_f32 v83, 0, v8
v_sub_f32 v84, 0, v9
v_sub_f32 v85, 0, v9
v_sub_f32 v86, 0, v9
v_sub_f32 v87, 0, v9
v_sub_f32 v88, 0, v10
v_sub_f32 v89, 0, v10
v_sub_f32 v90, 0, v10
v_sub_f32 v91, 0, v10
v_sub_f32 v92, 0, v11
v_sub_f32 v93, 0, v11
v_sub_f32 v94, 0, v11
v_sub_f32 v95, 0, v11
s_and_b32 s8, s4, 1
s_lshl_b32 s8, s8, 4
v_add_u32 v7, s8, v5
v_cmp_le_i32 s[36:37], 0, v7
v_cmp_le_i32 s[38:39], 1, v7
v_cmp_le_i32 s[40:41], 2, v7
v_cmp_le_i32 s[42:43], 3, v7
s_nop 1
v_cndmask_b32 v96, v6, v80, s[36:37]
v_cndmask_b32 v97, v6, v80, s[38:39]
v_cndmask_b32 v98, v6, v80, s[40:41]
v_cndmask_b32 v99, v6, v80, s[42:43]
v_cndmask_b32 v112, v6, v88, s[36:37]
v_cndmask_b32 v113, v6, v88, s[38:39]
v_cndmask_b32 v114, v6, v88, s[40:41]
v_cndmask_b32 v115, v6, v88, s[42:43]
v_cmp_le_i32 s[36:37], 16, v7
v_cmp_le_i32 s[38:39], 17, v7
v_cmp_le_i32 s[40:41], 18, v7
v_cmp_le_i32 s[42:43], 19, v7
s_nop 1
v_cndmask_b32 v100, v6, v80, s[36:37]
v_cndmask_b32 v101, v6, v80, s[38:39]
v_cndmask_b32 v102, v6, v80, s[40:41]
v_cndmask_b32 v103, v6, v80, s[42:43]
v_cndmask_b32 v116, v6, v88, s[36:37]
v_cndmask_b32 v117, v6, v88, s[38:39]
v_cndmask_b32 v118, v6, v88, s[40:41]
v_cndmask_b32 v119, v6, v88, s[42:43]
s_and_b32 s8, s4, 1
s_xor_b32 s8, s8, 1
s_lshl_b32 s8, s8, 4
v_add_u32 v7, s8, v5
v_cmp_le_i32 s[36:37], 0, v7
v_cmp_le_i32 s[38:39], 1, v7
v_cmp_le_i32 s[40:41], 2, v7
v_cmp_le_i32 s[42:43], 3, v7
s_nop 1
v_cndmask_b32 v104, v6, v84, s[36:37]
v_cndmask_b32 v105, v6, v84, s[38:39]
v_cndmask_b32 v106, v6, v84, s[40:41]
v_cndmask_b32 v107, v6, v84, s[42:43]
v_cndmask_b32 v120, v6, v92, s[36:37]
v_cndmask_b32 v121, v6, v92, s[38:39]
v_cndmask_b32 v122, v6, v92, s[40:41]
v_cndmask_b32 v123, v6, v92, s[42:43]
v_cmp_le_i32 s[36:37], 16, v7
v_cmp_le_i32 s[38:39], 17, v7
v_cmp_le_i32 s[40:41], 18, v7
v_cmp_le_i32 s[42:43], 19, v7
s_nop 1
v_cndmask_b32 v108, v6, v84, s[36:37]
v_cndmask_b32 v109, v6, v84, s[38:39]
v_cndmask_b32 v110, v6, v84, s[40:41]
v_cndmask_b32 v111, v6, v84, s[42:43]
v_cndmask_b32 v124, v6, v92, s[36:37]
v_cndmask_b32 v125, v6, v92, s[38:39]
v_cndmask_b32 v126, v6, v92, s[40:41]
v_cndmask_b32 v127, v6, v92, s[42:43]
s_waitcnt lgkmcnt(0)
s_mov_b32 s15, s6
s_cmp_eq_u32 s6, 0
s_cbranch_scc1 L_att_j0
v_mfma_f32_16x16x32_bf16 v[16:19], a[0:3], a[160:163], v[80:83]
v_mfma_f32_16x16x32_bf16 v[16:19], a[4:7], a[164:167], v[16:19]
v_mfma_f32_16x16x32_bf16 v[16:19], a[8:11], a[168:171], v[16:19]
v_mfma_f32_16x16x32_bf16 v[16:19], a[12:15], a[172:175], v[16:19]
s_add_u32 m0, s27, 0x0
v_mfma_f32_16x16x32_bf16 v[20:23], a[0:3], a[176:179], v[84:87]
buffer_load_dwordx4 v3, s[88:91], s32 offen offset:0 sc1 lds
v_mfma_f32_16x16x32_bf16 v[20:23], a[4:7], a[180:183], v[20:23]
v_mfma_f32_16x16x32_bf16 v[20:23], a[8:11], a[184:187], v[20:23]
v_mfma_f32_16x16x32_bf16 v[20:23], a[12:15], a[188:191], v[20:23]
v_mfma_f32_16x16x32_bf16 v[24:27], a[0:3], a[192:195], v[88:91]
s_nop 0
v_exp_f32 v16, v16
v_mfma_f32_16x16x32_bf16 v[24:27], a[4:7], a[196:199], v[24:27]
v_exp_f32 v17, v17
v_mfma_f32_16x16x32_bf16 v[24:27], a[8:11], a[200:203], v[24:27]
v_exp_f32 v18, v18
v_mfma_f32_16x16x32_bf16 v[24:27], a[12:15], a[204:207], v[24:27]
v_exp_f32 v19, v19
v_mfma_f32_16x16x32_bf16 v[28:31], a[0:3], a[208:211], v[92:95]
buffer_load_dwordx4 v3, s[88:91], s32 offen offset:1024 sc1 lds
v_mfma_f32_16x16x32_bf16 v[28:31], a[4:7], a[212:215], v[28:31]
v_cvt_pk_bf16_f32 v48, v16, v17
v_cvt_pk_bf16_f32 v49, v18, v19
v_mfma_f32_16x16x32_bf16 v[28:31], a[8:11], a[216:219], v[28:31]
v_exp_f32 v20, v20
v_mfma_f32_16x16x32_bf16 v[28:31], a[12:15], a[220:223], v[28:31]
v_exp_f32 v21, v21
v_mfma_f32_16x16x32_bf16 v[32:35], a[16:19], a[160:163], v[80:83]
v_exp_f32 v22, v22
v_mfma_f32_16x16x32_bf16 v[32:35], a[20:23], a[164:167], v[32:35]
v_exp_f32 v23, v23
v_mfma_f32_16x16x32_bf16 v[32:35], a[24:27], a[168:171], v[32:35]
v_mfma_f32_16x16x32_bf16 v[32:35], a[28:31], a[172:175], v[32:35]
v_cvt_pk_bf16_f32 v52, v20, v21
v_cvt_pk_bf16_f32 v53, v22, v23
v_mfma_f32_16x16x32_bf16 v[36:39], a[16:19], a[176:179], v[84:87]
buffer_load_dwordx4 v3, s[88:91], s32 offen offset:2048 sc1 lds
v_mfma_f32_16x16x32_bf16 v[36:39], a[20:23], a[180:183], v[36:39]
v_mfma_f32_16x16x32_bf16 v[36:39], a[24:27], a[184:187], v[36:39]
v_exp_f32 v24, v24
v_mfma_f32_16x16x32_bf16 v[36:39], a[28:31], a[188:191], v[36:39]
v_mfma_f32_16x16x32_bf16 v[40:43], a[16:19], a[192:195], v[88:91]
v_exp_f32 v25, v25
v_mfma_f32_16x16x32_bf16 v[40:43], a[20:23], a[196:199], v[40:43]
v_mfma_f32_16x16x32_bf16 v[40:43], a[24:27], a[200:203], v[40:43]
v_exp_f32 v26, v26
v_mfma_f32_16x16x32_bf16 v[40:43], a[28:31], a[204:207], v[40:43]
v_mfma_f32_16x16x32_bf16 v[44:47], a[16:19], a[208:211], v[92:95]
buffer_load_dwordx4 v3, s[88:91], s32 offen offset:3072 sc1 lds
v_mfma_f32_16x16x32_bf16 v[44:47], a[20:23], a[212:215], v[44:47]
v_exp_f32 v27, v27
v_mfma_f32_16x16x32_bf16 v[44:47], a[24:27], a[216:219], v[44:47]
v_mfma_f32_16x16x32_bf16 v[44:47], a[28:31], a[220:223], v[44:47]
v_cvt_pk_bf16_f32 v56, v24, v25
v_cvt_pk_bf16_f32 v57, v26, v27
s_waitcnt lgkmcnt(0)
ds_read_b128 a[0:3], v1 offset:16384
ds_read_b128 a[4:7], v1 offset:17408
ds_read_b128 a[8:11], v1 offset:18432
ds_read_b128 a[12:15], v1 offset:19456
ds_read_b128 a[16:19], v1 offset:20480
ds_read_b128 a[20:23], v1 offset:21504
ds_read_b128 a[24:27], v1 offset:22528
ds_read_b128 a[28:31], v1 offset:23552
s_waitcnt lgkmcnt(7)
v_mfma_f32_16x16x32_bf16 v[16:19], a[0:3], a[160:163], v[80:83]
ds_read_b128 a[32:35], v1 offset:24576
v_exp_f32 v28, v28
s_waitcnt lgkmcnt(7)
v_mfma_f32_16x16x32_bf16 v[16:19], a[4:7], a[164:167], v[16:19]
v_exp_f32 v29, v29
s_waitcnt lgkmcnt(6)
v_mfma_f32_16x16x32_bf16 v[16:19], a[8:11], a[168:171], v[16:19]
v_exp_f32 v30, v30
s_waitcnt lgkmcnt(5)
v_mfma_f32_16x16x32_bf16 v[16:19], a[12:15], a[172:175], v[16:19]
s_add_u32 m0, s27, 0x1000
ds_read_b128 a[36:39], v1 offset:25600
v_exp_f32 v31, v31
v_mfma_f32_16x16x32_bf16 v[20:23], a[0:3], a[176:179], v[84:87]
buffer_load_dwordx4 v3, s[88:91], s7 offen offset:0 sc1 lds
v_mfma_f32_16x16x32_bf16 v[20:23], a[4:7], a[180:183], v[20:23]
v_cvt_pk_bf16_f32 v60, v28, v29
v_cvt_pk_bf16_f32 v61, v30, v31
v_mfma_f32_16x16x32_bf16 v[20:23], a[8:11], a[184:187], v[20:23]
v_exp_f32 v32, v32
v_mfma_f32_16x16x32_bf16 v[20:23], a[12:15], a[188:191], v[20:23]
ds_read_b128 a[40:43], v1 offset:26624
v_exp_f32 v33, v33
v_mfma_f32_16x16x32_bf16 v[24:27], a[0:3], a[192:195], v[88:91]
v_exp_f32 v34, v34
v_mfma_f32_16x16x32_bf16 v[24:27], a[4:7], a[196:199], v[24:27]
v_exp_f32 v35, v35
v_mfma_f32_16x16x32_bf16 v[24:27], a[8:11], a[200:203], v[24:27]
ds_read_b128 a[44:47], v1 offset:27648
v_cvt_pk_bf16_f32 v50, v32, v33
v_cvt_pk_bf16_f32 v51, v34, v35
v_mfma_f32_16x16x32_bf16 v[24:27], a[12:15], a[204:207], v[24:27]
v_exp_f32 v36, v36
v_mfma_f32_16x16x32_bf16 v[28:31], a[0:3], a[208:211], v[92:95]
buffer_load_dwordx4 v3, s[88:91], s7 offen offset:1024 sc1 lds
v_mfma_f32_16x16x32_bf16 v[28:31], a[4:7], a[212:215], v[28:31]
v_exp_f32 v37, v37
v_mfma_f32_16x16x32_bf16 v[28:31], a[8:11], a[216:219], v[28:31]
ds_read_b128 a[48:51], v1 offset:28672
v_exp_f32 v38, v38
v_mfma_f32_16x16x32_bf16 v[28:31], a[12:15], a[220:223], v[28:31]
v_exp_f32 v39, v39
s_waitcnt lgkmcnt(8)
v_mfma_f32_16x16x32_bf16 v[32:35], a[16:19], a[160:163], v[80:83]
v_cvt_pk_bf16_f32 v54, v36, v37
v_cvt_pk_bf16_f32 v55, v38, v39
s_waitcnt lgkmcnt(7)
v_mfma_f32_16x16x32_bf16 v[32:35], a[20:23], a[164:167], v[32:35]
ds_read_b128 a[52:55], v1 offset:29696
v_exp_f32 v40, v40
s_waitcnt lgkmcnt(7)
v_mfma_f32_16x16x32_bf16 v[32:35], a[24:27], a[168:171], v[32:35]
v_exp_f32 v41, v41
s_waitcnt lgkmcnt(6)
v_mfma_f32_16x16x32_bf16 v[32:35], a[28:31], a[172:175], v[32:35]
v_exp_f32 v42, v42
v_mfma_f32_16x16x32_bf16 v[36:39], a[16:19], a[176:179], v[84:87]
buffer_load_dwordx4 v3, s[88:91], s7 offen offset:2048 sc1 lds
v_mfma_f32_16x16x32_bf16 v[36:39], a[20:23], a[180:183], v[36:39]
ds_read_b128 a[56:59], v1 offset:30720
v_exp_f32 v43, v43
v_mfma_f32_16x16x32_bf16 v[36:39], a[24:27], a[184:187], v[36:39]
v_cvt_pk_bf16_f32 v58, v40, v41
v_cvt_pk_bf16_f32 v59, v42, v43
v_mfma_f32_16x16x32_bf16 v[36:39], a[28:31], a[188:191], v[36:39]
v_exp_f32 v44, v44
v_mfma_f32_16x16x32_bf16 v[40:43], a[16:19], a[192:195], v[88:91]
ds_read_b128 a[60:63], v1 offset:31744
v_exp_f32 v45, v45
v_mfma_f32_16x16x32_bf16 v[40:43], a[20:23], a[196:199], v[40:43]
v_exp_f32 v46, v46
v_mfma_f32_16x16x32_bf16 v[40:43], a[24:27], a[200:203], v[40:43]
v_exp_f32 v47, v47
v_mfma_f32_16x16x32_bf16 v[40:43], a[28:31], a[204:207], v[40:43]
v_cvt_pk_bf16_f32 v62, v44, v45
v_cvt_pk_bf16_f32 v63, v46, v47
v_mfma_f32_16x16x32_bf16 v[44:47], a[16:19], a[208:211], v[92:95]
buffer_load_dwordx4 v3, s[88:91], s7 offen offset:3072 sc1 lds
v_mfma_f32_16x16x32_bf16 v[44:47], a[20:23], a[212:215], v[44:47]
v_exp_f32 v16, v16
v_mfma_f32_16x16x32_bf16 v[44:47], a[24:27], a[216:219], v[44:47]
v_exp_f32 v17, v17
v_mfma_f32_16x16x32_bf16 v[44:47], a[28:31], a[220:223], v[44:47]
v_exp_f32 v18, v18
s_nop 7
v_exp_f32 v19, v19
s_nop 0
v_cvt_pk_bf16_f32 v64, v16, v17
v_cvt_pk_bf16_f32 v65, v18, v19
s_nop 0
v_exp_f32 v20, v20
s_nop 0
v_exp_f32 v21, v21
s_nop 0
v_exp_f32 v22, v22
s_nop 0
v_exp_f32 v23, v23
s_nop 0
v_cvt_pk_bf16_f32 v68, v20, v21
v_cvt_pk_bf16_f32 v69, v22, v23
s_nop 0
v_exp_f32 v24, v24
s_nop 0
v_exp_f32 v25, v25
s_nop 0
v_exp_f32 v26, v26
s_nop 0
v_exp_f32 v27, v27
s_nop 0
v_cvt_pk_bf16_f32 v72, v24, v25
v_cvt_pk_bf16_f32 v73, v26, v27
s_nop 0
s_add_u32 s32, s32, 0x8000
s_add_u32 s7, s7, 0x8000
s_xor_b32 s27, s27, 0x38000
v_xor_b32 v1, 0x8000, v1
s_waitcnt vmcnt(8)
s_barrier
s_cmp_lg_u32 s33, 0
s_cbranch_scc1 L_sig_bd
s_lshl_b32 s8, s6, 2
s_add_u32 s8, s8, 128
s_cmp_lg_u32 s4, 0
s_cbranch_scc1 L_sig_bd
v_mov_b32 v4, 1
s_mov_b64 exec, 1
buffer_atomic_add v4, off, s[84:87], s8 sc1
s_mov_b64 exec, -1
L_sig_bd:
s_branch L_att_dodd
L_att_deven:
s_waitcnt vmcnt(16) lgkmcnt(0)
s_barrier
v_mfma_f32_16x16x32_bf16 v[128:131], a[32:35], v[48:51], v[128:131]
ds_read_b128 a[0:3], v1 offset:0
v_exp_f32 v28, v28
v_mfma_f32_16x16x32_bf16 v[160:163], a[32:35], v[52:55], v[160:163]
v_mfma_f32_16x16x32_bf16 v[192:195], a[32:35], v[56:59], v[192:195]
v_exp_f32 v29, v29
v_mfma_f32_16x16x32_bf16 v[224:227], a[32:35], v[60:63], v[224:227]
ds_read_b128 a[4:7], v1 offset:1024
v_mfma_f32_16x16x32_bf16 v[228:231], a[36:39], v[60:63], v[228:231]
v_exp_f32 v30, v30
v_mfma_f32_16x16x32_bf16 v[196:199], a[36:39], v[56:59], v[196:199]
v_exp_f32 v31, v31
v_mfma_f32_16x16x32_bf16 v[164:167], a[36:39], v[52:55], v[164:167]
v_mfma_f32_16x16x32_bf16 v[132:135], a[36:39], v[48:51], v[132:135]
s_add_u32 m0, s27, 0x0
ds_read_b128 a[8:11], v1 offset:2048
v_cvt_pk_bf16_f32 v76, v28, v29
v_cvt_pk_bf16_f32 v77, v30, v31
v_mfma_f32_16x16x32_bf16 v[136:139], a[40:43], v[48:51], v[136:139]
buffer_load_dwordx4 v3, s[88:91], s32 offen offset:0 sc1 lds
v_mfma_f32_16x16x32_bf16 v[168:171], a[40:43], v[52:55], v[168:171]
v_exp_f32 v32, v32
v_mfma_f32_16x16x32_bf16 v[200:203], a[40:43], v[56:59], v[200:203]
v_mfma_f32_16x16x32_bf16 v[232:235], a[40:43], v[60:63], v[232:235]
v_exp_f32 v33, v33
v_mfma_f32_16x16x32_bf16 v[236:239], a[44:47], v[60:63], v[236:239]
ds_read_b128 a[12:15], v1 offset:3072
v_mfma_f32_16x16x32_bf16 v[204:207], a[44:47], v[56:59], v[204:207]
v_exp_f32 v34, v34
v_mfma_f32_16x16x32_bf16 v[172:175], a[44:47], v[52:55], v[172:175]
v_exp_f32 v35, v35
v_mfma_f32_16x16x32_bf16 v[140:143], a[44:47], v[48:51], v[140:143]
v_mfma_f32_16x16x32_bf16 v[144:147], a[48:51], v[48:51], v[144:147]
ds_read_b128 a[16:19], v1 offset:4096
v_cvt_pk_bf16_f32 v66, v32, v33
v_cvt_pk_bf16_f32 v67, v34, v35
v_mfma_f32_16x16x32_bf16 v[176:179], a[48:51], v[52:55], v[176:179]
v_exp_f32 v36, v36
v_mfma_f32_16x16x32_bf16 v[208:211], a[48:51], v[56:59], v[208:211]
v_mfma_f32_16x16x32_bf16 v[240:243], a[48:51], v[60:63], v[240:243]
ds_read_b128 a[20:23], v1 offset:5120
v_exp_f32 v37, v37
v_mfma_f32_16x16x32_bf16 v[244:247], a[52:55], v[60:63], v[244:247]
v_mfma_f32_16x16x32_bf16 v[212:215], a[52:55], v[56:59], v[212:215]
v_exp_f32 v38, v38
v_mfma_f32_16x16x32_bf16 v[180:183], a[52:55], v[52:55], v[180:183]
v_exp_f32 v39, v39
v_mfma_f32_16x16x32_bf16 v[148:151], a[52:55], v[48:51], v[148:151]
ds_read_b128 a[24:27], v1 offset:6144
v_mfma_f32_16x16x32_bf16 v[152:155], a[56:59], v[48:51], v[152:155]
v_cvt_pk_bf16_f32 v70, v36, v37
v_cvt_pk_bf16_f32 v71, v38, v39
v_mfma_f32_16x16x32_bf16 v[184:187], a[56:59], v[52:55], v[184:187]
buffer_load_dwordx4 v3, s[88:91], s32 offen offset:1024 sc1 lds
v_mfma_f32_16x16x32_bf16 v[216:219], a[56:59], v[56:59], v[216:219]
v_exp_f32 v40, v40
v_mfma_f32_16x16x32_bf16 v[248:251], a[56:59], v[60:63], v[248:251]
v_mfma_f32_16x16x32_bf16 v[252:255], a[60:63], v[60:63], v[252:255]
ds_read_b128 a[28:31], v1 offset:7168
v_exp_f32 v41, v41
v_mfma_f32_16x16x32_bf16 v[220:223], a[60:63], v[56:59], v[220:223]
v_mfma_f32_16x16x32_bf16 v[188:191], a[60:63], v[52:55], v[188:191]
v_exp_f32 v42, v42
v_mfma_f32_16x16x32_bf16 v[156:159], a[60:63], v[48:51], v[156:159]
v_exp_f32 v43, v43
v_mfma_f32_16x16x32_bf16 a[224:227], a[240:243], v[48:51], a[224:227]
v_mfma_f32_16x16x32_bf16 a[228:231], a[240:243], v[52:55], a[228:231]
v_cvt_pk_bf16_f32 v74, v40, v41
v_cvt_pk_bf16_f32 v75, v42, v43
v_mfma_f32_16x16x32_bf16 a[232:235], a[240:243], v[56:59], a[232:235]
v_exp_f32 v44, v44
v_mfma_f32_16x16x32_bf16 a[236:239], a[240:243], v[60:63], a[236:239]
s_waitcnt lgkmcnt(7)
v_mfma_f32_16x16x32_bf16 v[16:19], a[0:3], a[160:163], v[80:83]
ds_read_b128 a[32:35], v1 offset:8192
v_exp_f32 v45, v45
s_waitcnt lgkmcnt(7)
v_mfma_f32_16x16x32_bf16 v[16:19], a[4:7], a[164:167], v[16:19]
s_waitcnt lgkmcnt(6)
v_mfma_f32_16x16x32_bf16 v[16:19], a[8:11], a[168:171], v[16:19]
v_exp_f32 v46, v46
s_waitcnt lgkmcnt(5)
v_mfma_f32_16x16x32_bf16 v[16:19], a[12:15], a[172:175], v[16:19]
ds_read_b128 a[36:39], v1 offset:9216
v_exp_f32 v47, v47
v_mfma_f32_16x16x32_bf16 v[20:23], a[0:3], a[176:179], v[84:87]
v_mfma_f32_16x16x32_bf16 v[20:23], a[4:7], a[180:183], v[20:23]
v_cvt_pk_bf16_f32 v78, v44, v45
v_cvt_pk_bf16_f32 v79, v46, v47
v_mfma_f32_16x16x32_bf16 v[20:23], a[8:11], a[184:187], v[20:23]
buffer_load_dwordx4 v3, s[88:91], s32 offen offset:2048 sc1 lds
v_mfma_f32_16x16x32_bf16 v[20:23], a[12:15], a[188:191], v[20:23]
ds_read_b128 a[40:43], v1 offset:10240
v_mfma_f32_16x16x32_bf16 v[24:27], a[0:3], a[192:195], v[88:91]
v_exp_f32 v16, v16
v_mfma_f32_16x16x32_bf16 v[24:27], a[4:7], a[196:199], v[24:27]
v_exp_f32 v17, v17
v_mfma_f32_16x16x32_bf16 v[24:27], a[8:11], a[200:203], v[24:27]
v_mfma_f32_16x16x32_bf16 v[24:27], a[12:15], a[204:207], v[24:27]
ds_read_b128 a[44:47], v1 offset:11264
v_exp_f32 v18, v18
v_mfma_f32_16x16x32_bf16 v[28:31], a[0:3], a[208:211], v[92:95]
v_exp_f32 v19, v19
v_mfma_f32_16x16x32_bf16 v[28:31], a[4:7], a[212:215], v[28:31]
v_mfma_f32_16x16x32_bf16 v[28:31], a[8:11], a[216:219], v[28:31]
ds_read_b128 a[48:51], v1 offset:12288
v_cvt_pk_bf16_f32 v48, v16, v17
v_cvt_pk_bf16_f32 v49, v18, v19
v_mfma_f32_16x16x32_bf16 v[28:31], a[12:15], a[220:223], v[28:31]
v_exp_f32 v20, v20
s_waitcnt lgkmcnt(8)
v_mfma_f32_16x16x32_bf16 v[32:35], a[16:19], a[160:163], v[80:83]
s_waitcnt lgkmcnt(7)
v_mfma_f32_16x16x32_bf16 v[32:35], a[20:23], a[164:167], v[32:35]
ds_read_b128 a[52:55], v1 offset:13312
v_exp_f32 v21, v21
s_waitcnt lgkmcnt(7)
v_mfma_f32_16x16x32_bf16 v[32:35], a[24:27], a[168:171], v[32:35]
s_waitcnt lgkmcnt(6)
v_mfma_f32_16x16x32_bf16 v[32:35], a[28:31], a[172:175], v[32:35]
v_exp_f32 v22, v22
v_mfma_f32_16x16x32_bf16 v[36:39], a[16:19], a[176:179], v[84:87]
v_exp_f32 v23, v23
v_mfma_f32_16x16x32_bf16 v[36:39], a[20:23], a[180:183], v[36:39]
ds_read_b128 a[56:59], v1 offset:14336
v_mfma_f32_16x16x32_bf16 v[36:39], a[24:27], a[184:187], v[36:39]
v_cvt_pk_bf16_f32 v52, v20, v21
v_cvt_pk_bf16_f32 v53, v22, v23
v_mfma_f32_16x16x32_bf16 v[36:39], a[28:31], a[188:191], v[36:39]
buffer_load_dwordx4 v3, s[88:91], s32 offen offset:3072 sc1 lds
v_mfma_f32_16x16x32_bf16 v[40:43], a[16:19], a[192:195], v[88:91]
v_exp_f32 v24, v24
v_mfma_f32_16x16x32_bf16 v[40:43], a[20:23], a[196:199], v[40:43]
ds_read_b128 a[60:63], v1 offset:15360
v_mfma_f32_16x16x32_bf16 v[40:43], a[24:27], a[200:203], v[40:43]
v_exp_f32 v25, v25
v_mfma_f32_16x16x32_bf16 v[40:43], a[28:31], a[204:207], v[40:43]
v_mfma_f32_16x16x32_bf16 v[44:47], a[16:19], a[208:211], v[92:95]
v_exp_f32 v26, v26
v_mfma_f32_16x16x32_bf16 v[44:47], a[20:23], a[212:215], v[44:47]
v_exp_f32 v27, v27
v_mfma_f32_16x16x32_bf16 v[44:47], a[24:27], a[216:219], v[44:47]
v_mfma_f32_16x16x32_bf16 v[44:47], a[28:31], a[220:223], v[44:47]
v_cvt_pk_bf16_f32 v56, v24, v25
v_cvt_pk_bf16_f32 v57, v26, v27
s_waitcnt lgkmcnt(0)
v_mfma_f32_16x16x32_bf16 v[128:131], a[32:35], v[64:67], v[128:131]
ds_read_b128 a[0:3], v1 offset:16384
v_exp_f32 v28, v28
v_mfma_f32_16x16x32_bf16 v[160:163], a[32:35], v[68:71], v[160:163]
v_mfma_f32_16x16x32_bf16 v[192:195], a[32:35], v[72:75], v[192:195]
v_exp_f32 v29, v29
v_mfma_f32_16x16x32_bf16 v[224:227], a[32:35], v[76:79], v[224:227]
ds_read_b128 a[4:7], v1 offset:17408
v_mfma_f32_16x16x32_bf16 v[228:231], a[36:39], v[76:79], v[228:231]
v_exp_f32 v30, v30
v_mfma_f32_16x16x32_bf16 v[196:199], a[36:39], v[72:75], v[196:199]
v_exp_f32 v31, v31
v_mfma_f32_16x16x32_bf16 v[164:167], a[36:39], v[68:71], v[164:167]
v_mfma_f32_16x16x32_bf16 v[132:135], a[36:39], v[64:67], v[132:135]
s_add_u32 m0, s27, 0x1000
ds_read_b128 a[8:11], v1 offset:18432
v_cvt_pk_bf16_f32 v60, v28, v29
v_cvt_pk_bf16_f32 v61, v30, v31
v_mfma_f32_16x16x32_bf16 v[136:139], a[40:43], v[64:67], v[136:139]
buffer_load_dwordx4 v3, s[88:91], s7 offen offset:0 sc1 lds
v_mfma_f32_16x16x32_bf16 v[168:171], a[40:43], v[68:71], v[168:171]
v_exp_f32 v32, v32
v_mfma_f32_16x16x32_bf16 v[200:203], a[40:43], v[72:75], v[200:203]
v_mfma_f32_16x16x32_bf16 v[232:235], a[40:43], v[76:79], v[232:235]
v_exp_f32 v33, v33
v_mfma_f32_16x16x32_bf16 v[236:239], a[44:47], v[76:79], v[236:239]
ds_read_b128 a[12:15], v1 offset:19456
v_mfma_f32_16x16x32_bf16 v[204:207], a[44:47], v[72:75], v[204:207]
v_exp_f32 v34, v34
v_mfma_f32_16x16x32_bf16 v[172:175], a[44:47], v[68:71], v[172:175]
v_exp_f32 v35, v35
v_mfma_f32_16x16x32_bf16 v[140:143], a[44:47], v[64:67], v[140:143]
v_mfma_f32_16x16x32_bf16 v[144:147], a[48:51], v[64:67], v[144:147]
ds_read_b128 a[16:19], v1 offset:20480
v_cvt_pk_bf16_f32 v50, v32, v33
v_cvt_pk_bf16_f32 v51, v34, v35
v_mfma_f32_16x16x32_bf16 v[176:179], a[48:51], v[68:71], v[176:179]
v_exp_f32 v36, v36
v_mfma_f32_16x16x32_bf16 v[208:211], a[48:51], v[72:75], v[208:211]
v_mfma_f32_16x16x32_bf16 v[240:243], a[48:51], v[76:79], v[240:243]
ds_read_b128 a[20:23], v1 offset:21504
v_exp_f32 v37, v37
v_mfma_f32_16x16x32_bf16 v[244:247], a[52:55], v[76:79], v[244:247]
v_mfma_f32_16x16x32_bf16 v[212:215], a[52:55], v[72:75], v[212:215]
v_exp_f32 v38, v38
v_mfma_f32_16x16x32_bf16 v[180:183], a[52:55], v[68:71], v[180:183]
v_exp_f32 v39, v39
v_mfma_f32_16x16x32_bf16 v[148:151], a[52:55], v[64:67], v[148:151]
ds_read_b128 a[24:27], v1 offset:22528
v_mfma_f32_16x16x32_bf16 v[152:155], a[56:59], v[64:67], v[152:155]
v_cvt_pk_bf16_f32 v54, v36, v37
v_cvt_pk_bf16_f32 v55, v38, v39
v_mfma_f32_16x16x32_bf16 v[184:187], a[56:59], v[68:71], v[184:187]
buffer_load_dwordx4 v3, s[88:91], s7 offen offset:1024 sc1 lds
v_mfma_f32_16x16x32_bf16 v[216:219], a[56:59], v[72:75], v[216:219]
v_exp_f32 v40, v40
v_mfma_f32_16x16x32_bf16 v[248:251], a[56:59], v[76:79], v[248:251]
v_mfma_f32_16x16x32_bf16 v[252:255], a[60:63], v[76:79], v[252:255]
ds_read_b128 a[28:31], v1 offset:23552
v_exp_f32 v41, v41
v_mfma_f32_16x16x32_bf16 v[220:223], a[60:63], v[72:75], v[220:223]
v_mfma_f32_16x16x32_bf16 v[188:191], a[60:63], v[68:71], v[188:191]
v_exp_f32 v42, v42
v_mfma_f32_16x16x32_bf16 v[156:159], a[60:63], v[64:67], v[156:159]
v_exp_f32 v43, v43
v_mfma_f32_16x16x32_bf16 a[224:227], a[240:243], v[64:67], a[224:227]
v_mfma_f32_16x16x32_bf16 a[228:231], a[240:243], v[68:71], a[228:231]
v_cvt_pk_bf16_f32 v58, v40, v41
v_cvt_pk_bf16_f32 v59, v42, v43
v_mfma_f32_16x16x32_bf16 a[232:235], a[240:243], v[72:75], a[232:235]
v_exp_f32 v44, v44
v_mfma_f32_16x16x32_bf16 a[236:239], a[240:243], v[76:79], a[236:239]
s_waitcnt lgkmcnt(7)
v_mfma_f32_16x16x32_bf16 v[16:19], a[0:3], a[160:163], v[80:83]
ds_read_b128 a[32:35], v1 offset:24576
v_exp_f32 v45, v45
s_waitcnt lgkmcnt(7)
v_mfma_f32_16x16x32_bf16 v[16:19], a[4:7], a[164:167], v[16:19]
s_waitcnt lgkmcnt(6)
v_mfma_f32_16x16x32_bf16 v[16:19], a[8:11], a[168:171], v[16:19]
v_exp_f32 v46, v46
s_waitcnt lgkmcnt(5)
v_mfma_f32_16x16x32_bf16 v[16:19], a[12:15], a[172:175], v[16:19]
ds_read_b128 a[36:39], v1 offset:25600
v_exp_f32 v47, v47
v_mfma_f32_16x16x32_bf16 v[20:23], a[0:3], a[176:179], v[84:87]
v_mfma_f32_16x16x32_bf16 v[20:23], a[4:7], a[180:183], v[20:23]
v_cvt_pk_bf16_f32 v62, v44, v45
v_cvt_pk_bf16_f32 v63, v46, v47
v_mfma_f32_16x16x32_bf16 v[20:23], a[8:11], a[184:187], v[20:23]
buffer_load_dwordx4 v3, s[88:91], s7 offen offset:2048 sc1 lds
v_mfma_f32_16x16x32_bf16 v[20:23], a[12:15], a[188:191], v[20:23]
ds_read_b128 a[40:43], v1 offset:26624
v_mfma_f32_16x16x32_bf16 v[24:27], a[0:3], a[192:195], v[88:91]
v_exp_f32 v16, v16
v_mfma_f32_16x16x32_bf16 v[24:27], a[4:7], a[196:199], v[24:27]
v_exp_f32 v17, v17
v_mfma_f32_16x16x32_bf16 v[24:27], a[8:11], a[200:203], v[24:27]
v_mfma_f32_16x16x32_bf16 v[24:27], a[12:15], a[204:207], v[24:27]
ds_read_b128 a[44:47], v1 offset:27648
v_exp_f32 v18, v18
v_mfma_f32_16x16x32_bf16 v[28:31], a[0:3], a[208:211], v[92:95]
v_exp_f32 v19, v19
v_mfma_f32_16x16x32_bf16 v[28:31], a[4:7], a[212:215], v[28:31]
v_mfma_f32_16x16x32_bf16 v[28:31], a[8:11], a[216:219], v[28:31]
ds_read_b128 a[48:51], v1 offset:28672
v_cvt_pk_bf16_f32 v64, v16, v17
v_cvt_pk_bf16_f32 v65, v18, v19
v_mfma_f32_16x16x32_bf16 v[28:31], a[12:15], a[220:223], v[28:31]
v_exp_f32 v20, v20
s_waitcnt lgkmcnt(8)
v_mfma_f32_16x16x32_bf16 v[32:35], a[16:19], a[160:163], v[80:83]
s_waitcnt lgkmcnt(7)
v_mfma_f32_16x16x32_bf16 v[32:35], a[20:23], a[164:167], v[32:35]
ds_read_b128 a[52:55], v1 offset:29696
v_exp_f32 v21, v21
s_waitcnt lgkmcnt(7)
v_mfma_f32_16x16x32_bf16 v[32:35], a[24:27], a[168:171], v[32:35]
s_waitcnt lgkmcnt(6)
v_mfma_f32_16x16x32_bf16 v[32:35], a[28:31], a[172:175], v[32:35]
v_exp_f32 v22, v22
v_mfma_f32_16x16x32_bf16 v[36:39], a[16:19], a[176:179], v[84:87]
v_exp_f32 v23, v23
v_mfma_f32_16x16x32_bf16 v[36:39], a[20:23], a[180:183], v[36:39]
ds_read_b128 a[56:59], v1 offset:30720
v_mfma_f32_16x16x32_bf16 v[36:39], a[24:27], a[184:187], v[36:39]
v_cvt_pk_bf16_f32 v68, v20, v21
v_cvt_pk_bf16_f32 v69, v22, v23
v_mfma_f32_16x16x32_bf16 v[36:39], a[28:31], a[188:191], v[36:39]
buffer_load_dwordx4 v3, s[88:91], s7 offen offset:3072 sc1 lds
v_mfma_f32_16x16x32_bf16 v[40:43], a[16:19], a[192:195], v[88:91]
v_exp_f32 v24, v24
v_mfma_f32_16x16x32_bf16 v[40:43], a[20:23], a[196:199], v[40:43]
ds_read_b128 a[60:63], v1 offset:31744
v_mfma_f32_16x16x32_bf16 v[40:43], a[24:27], a[200:203], v[40:43]
v_exp_f32 v25, v25
v_mfma_f32_16x16x32_bf16 v[40:43], a[28:31], a[204:207], v[40:43]
v_mfma_f32_16x16x32_bf16 v[44:47], a[16:19], a[208:211], v[92:95]
v_exp_f32 v26, v26
v_mfma_f32_16x16x32_bf16 v[44:47], a[20:23], a[212:215], v[44:47]
v_exp_f32 v27, v27
v_mfma_f32_16x16x32_bf16 v[44:47], a[24:27], a[216:219], v[44:47]
v_mfma_f32_16x16x32_bf16 v[44:47], a[28:31], a[220:223], v[44:47]
v_cvt_pk_bf16_f32 v72, v24, v25
v_cvt_pk_bf16_f32 v73, v26, v27
s_add_u32 s32, s32, 0x8000
s_add_u32 s7, s7, 0x8000
s_xor_b32 s27, s27, 0x38000
v_xor_b32 v1, 0x8000, v1
L_att_dodd:
s_waitcnt vmcnt(16) lgkmcnt(0)
s_barrier
v_mfma_f32_16x16x32_bf16 v[128:131], a[32:35], v[48:51], v[128:131]
ds_read_b128 a[0:3], v2 offset:0
v_exp_f32 v28, v28
v_mfma_f32_16x16x32_bf16 v[160:163], a[32:35], v[52:55], v[160:163]
v_mfma_f32_16x16x32_bf16 v[192:195], a[32:35], v[56:59], v[192:195]
v_exp_f32 v29, v29
v_mfma_f32_16x16x32_bf16 v[224:227], a[32:35], v[60:63], v[224:227]
ds_read_b128 a[4:7], v2 offset:1024
v_mfma_f32_16x16x32_bf16 v[228:231], a[36:39], v[60:63], v[228:231]
v_exp_f32 v30, v30
v_mfma_f32_16x16x32_bf16 v[196:199], a[36:39], v[56:59], v[196:199]
v_exp_f32 v31, v31
v_mfma_f32_16x16x32_bf16 v[164:167], a[36:39], v[52:55], v[164:167]
v_mfma_f32_16x16x32_bf16 v[132:135], a[36:39], v[48:51], v[132:135]
s_add_u32 m0, s19, 0x0
ds_read_b128 a[8:11], v2 offset:2048
v_cvt_pk_bf16_f32 v76, v28, v29
v_cvt_pk_bf16_f32 v77, v30, v31
v_mfma_f32_16x16x32_bf16 v[136:139], a[40:43], v[48:51], v[136:139]
buffer_load_dwordx4 v3, s[88:91], s32 offen offset:0 sc1 lds
v_mfma_f32_16x16x32_bf16 v[168:171], a[40:43], v[52:55], v[168:171]
v_exp_f32 v32, v32
v_mfma_f32_16x16x32_bf16 v[200:203], a[40:43], v[56:59], v[200:203]
v_mfma_f32_16x16x32_bf16 v[232:235], a[40:43], v[60:63], v[232:235]
v_exp_f32 v33, v33
v_mfma_f32_16x16x32_bf16 v[236:239], a[44:47], v[60:63], v[236:239]
ds_read_b128 a[12:15], v2 offset:3072
v_mfma_f32_16x16x32_bf16 v[204:207], a[44:47], v[56:59], v[204:207]
v_exp_f32 v34, v34
v_mfma_f32_16x16x32_bf16 v[172:175], a[44:47], v[52:55], v[172:175]
v_exp_f32 v35, v35
v_mfma_f32_16x16x32_bf16 v[140:143], a[44:47], v[48:51], v[140:143]
v_mfma_f32_16x16x32_bf16 v[144:147], a[48:51], v[48:51], v[144:147]
ds_read_b128 a[16:19], v2 offset:4096
v_cvt_pk_bf16_f32 v66, v32, v33
v_cvt_pk_bf16_f32 v67, v34, v35
v_mfma_f32_16x16x32_bf16 v[176:179], a[48:51], v[52:55], v[176:179]
v_exp_f32 v36, v36
v_mfma_f32_16x16x32_bf16 v[208:211], a[48:51], v[56:59], v[208:211]
v_mfma_f32_16x16x32_bf16 v[240:243], a[48:51], v[60:63], v[240:243]
ds_read_b128 a[20:23], v2 offset:5120
v_exp_f32 v37, v37
v_mfma_f32_16x16x32_bf16 v[244:247], a[52:55], v[60:63], v[244:247]
v_mfma_f32_16x16x32_bf16 v[212:215], a[52:55], v[56:59], v[212:215]
v_exp_f32 v38, v38
v_mfma_f32_16x16x32_bf16 v[180:183], a[52:55], v[52:55], v[180:183]
v_exp_f32 v39, v39
v_mfma_f32_16x16x32_bf16 v[148:151], a[52:55], v[48:51], v[148:151]
ds_read_b128 a[24:27], v2 offset:6144
v_mfma_f32_16x16x32_bf16 v[152:155], a[56:59], v[48:51], v[152:155]
v_cvt_pk_bf16_f32 v70, v36, v37
v_cvt_pk_bf16_f32 v71, v38, v39
v_mfma_f32_16x16x32_bf16 v[184:187], a[56:59], v[52:55], v[184:187]
buffer_load_dwordx4 v3, s[88:91], s32 offen offset:1024 sc1 lds
v_mfma_f32_16x16x32_bf16 v[216:219], a[56:59], v[56:59], v[216:219]
v_exp_f32 v40, v40
v_mfma_f32_16x16x32_bf16 v[248:251], a[56:59], v[60:63], v[248:251]
v_mfma_f32_16x16x32_bf16 v[252:255], a[60:63], v[60:63], v[252:255]
ds_read_b128 a[28:31], v2 offset:7168
v_exp_f32 v41, v41
v_mfma_f32_16x16x32_bf16 v[220:223], a[60:63], v[56:59], v[220:223]
v_mfma_f32_16x16x32_bf16 v[188:191], a[60:63], v[52:55], v[188:191]
v_exp_f32 v42, v42
v_mfma_f32_16x16x32_bf16 v[156:159], a[60:63], v[48:51], v[156:159]
v_exp_f32 v43, v43
v_mfma_f32_16x16x32_bf16 a[224:227], a[240:243], v[48:51], a[224:227]
v_mfma_f32_16x16x32_bf16 a[228:231], a[240:243], v[52:55], a[228:231]
v_cvt_pk_bf16_f32 v74, v40, v41
v_cvt_pk_bf16_f32 v75, v42, v43
v_mfma_f32_16x16x32_bf16 a[232:235], a[240:243], v[56:59], a[232:235]
v_exp_f32 v44, v44
v_mfma_f32_16x16x32_bf16 a[236:239], a[240:243], v[60:63], a[236:239]
s_waitcnt lgkmcnt(7)
v_mfma_f32_16x16x32_bf16 v[16:19], a[0:3], a[160:163], v[80:83]
ds_read_b128 a[32:35], v2 offset:8192
v_exp_f32 v45, v45
s_waitcnt lgkmcnt(7)
v_mfma_f32_16x16x32_bf16 v[16:19], a[4:7], a[164:167], v[16:19]
s_waitcnt lgkmcnt(6)
v_mfma_f32_16x16x32_bf16 v[16:19], a[8:11], a[168:171], v[16:19]
v_exp_f32 v46, v46
s_waitcnt lgkmcnt(5)
v_mfma_f32_16x16x32_bf16 v[16:19], a[12:15], a[172:175], v[16:19]
ds_read_b128 a[36:39], v2 offset:9216
v_exp_f32 v47, v47
v_mfma_f32_16x16x32_bf16 v[20:23], a[0:3], a[176:179], v[84:87]
v_mfma_f32_16x16x32_bf16 v[20:23], a[4:7], a[180:183], v[20:23]
v_cvt_pk_bf16_f32 v78, v44, v45
v_cvt_pk_bf16_f32 v79, v46, v47
v_mfma_f32_16x16x32_bf16 v[20:23], a[8:11], a[184:187], v[20:23]
buffer_load_dwordx4 v3, s[88:91], s32 offen offset:2048 sc1 lds
v_mfma_f32_16x16x32_bf16 v[20:23], a[12:15], a[188:191], v[20:23]
ds_read_b128 a[40:43], v2 offset:10240
v_mfma_f32_16x16x32_bf16 v[24:27], a[0:3], a[192:195], v[88:91]
v_exp_f32 v16, v16
v_mfma_f32_16x16x32_bf16 v[24:27], a[4:7], a[196:199], v[24:27]
v_exp_f32 v17, v17
v_mfma_f32_16x16x32_bf16 v[24:27], a[8:11], a[200:203], v[24:27]
v_mfma_f32_16x16x32_bf16 v[24:27], a[12:15], a[204:207], v[24:27]
ds_read_b128 a[44:47], v2 offset:11264
v_exp_f32 v18, v18
v_mfma_f32_16x16x32_bf16 v[28:31], a[0:3], a[208:211], v[92:95]
v_exp_f32 v19, v19
v_mfma_f32_16x16x32_bf16 v[28:31], a[4:7], a[212:215], v[28:31]
v_mfma_f32_16x16x32_bf16 v[28:31], a[8:11], a[216:219], v[28:31]
ds_read_b128 a[48:51], v2 offset:12288
v_cvt_pk_bf16_f32 v48, v16, v17
v_cvt_pk_bf16_f32 v49, v18, v19
v_mfma_f32_16x16x32_bf16 v[28:31], a[12:15], a[220:223], v[28:31]
v_exp_f32 v20, v20
s_waitcnt lgkmcnt(8)
v_mfma_f32_16x16x32_bf16 v[32:35], a[16:19], a[160:163], v[80:83]
s_waitcnt lgkmcnt(7)
v_mfma_f32_16x16x32_bf16 v[32:35], a[20:23], a[164:167], v[32:35]
ds_read_b128 a[52:55], v2 offset:13312
v_exp_f32 v21, v21
s_waitcnt lgkmcnt(7)
v_mfma_f32_16x16x32_bf16 v[32:35], a[24:27], a[168:171], v[32:35]
s_waitcnt lgkmcnt(6)
v_mfma_f32_16x16x32_bf16 v[32:35], a[28:31], a[172:175], v[32:35]
v_exp_f32 v22, v22
v_mfma_f32_16x16x32_bf16 v[36:39], a[16:19], a[176:179], v[84:87]
v_exp_f32 v23, v23
v_mfma_f32_16x16x32_bf16 v[36:39], a[20:23], a[180:183], v[36:39]
ds_read_b128 a[56:59], v2 offset:14336
v_mfma_f32_16x16x32_bf16 v[36:39], a[24:27], a[184:187], v[36:39]
v_cvt_pk_bf16_f32 v52, v20, v21
v_cvt_pk_bf16_f32 v53, v22, v23
v_mfma_f32_16x16x32_bf16 v[36:39], a[28:31], a[188:191], v[36:39]
buffer_load_dwordx4 v3, s[88:91], s32 offen offset:3072 sc1 lds
v_mfma_f32_16x16x32_bf16 v[40:43], a[16:19], a[192:195], v[88:91]
v_exp_f32 v24, v24
v_mfma_f32_16x16x32_bf16 v[40:43], a[20:23], a[196:199], v[40:43]
ds_read_b128 a[60:63], v2 offset:15360
v_mfma_f32_16x16x32_bf16 v[40:43], a[24:27], a[200:203], v[40:43]
v_exp_f32 v25, v25
v_mfma_f32_16x16x32_bf16 v[40:43], a[28:31], a[204:207], v[40:43]
v_mfma_f32_16x16x32_bf16 v[44:47], a[16:19], a[208:211], v[92:95]
v_exp_f32 v26, v26
v_mfma_f32_16x16x32_bf16 v[44:47], a[20:23], a[212:215], v[44:47]
v_exp_f32 v27, v27
v_mfma_f32_16x16x32_bf16 v[44:47], a[24:27], a[216:219], v[44:47]
v_mfma_f32_16x16x32_bf16 v[44:47], a[28:31], a[220:223], v[44:47]
v_cvt_pk_bf16_f32 v56, v24, v25
v_cvt_pk_bf16_f32 v57, v26, v27
s_waitcnt lgkmcnt(0)
v_mfma_f32_16x16x32_bf16 v[128:131], a[32:35], v[64:67], v[128:131]
ds_read_b128 a[0:3], v2 offset:16384
v_exp_f32 v28, v28
v_mfma_f32_16x16x32_bf16 v[160:163], a[32:35], v[68:71], v[160:163]
v_mfma_f32_16x16x32_bf16 v[192:195], a[32:35], v[72:75], v[192:195]
v_exp_f32 v29, v29
v_mfma_f32_16x16x32_bf16 v[224:227], a[32:35], v[76:79], v[224:227]
ds_read_b128 a[4:7], v2 offset:17408
v_mfma_f32_16x16x32_bf16 v[228:231], a[36:39], v[76:79], v[228:231]
v_exp_f32 v30, v30
v_mfma_f32_16x16x32_bf16 v[196:199], a[36:39], v[72:75], v[196:199]
v_exp_f32 v31, v31
v_mfma_f32_16x16x32_bf16 v[164:167], a[36:39], v[68:71], v[164:167]
v_mfma_f32_16x16x32_bf16 v[132:135], a[36:39], v[64:67], v[132:135]
s_add_u32 m0, s19, 0x1000
ds_read_b128 a[8:11], v2 offset:18432
v_cvt_pk_bf16_f32 v60, v28, v29
v_cvt_pk_bf16_f32 v61, v30, v31
v_mfma_f32_16x16x32_bf16 v[136:139], a[40:43], v[64:67], v[136:139]
buffer_load_dwordx4 v3, s[88:91], s7 offen offset:0 sc1 lds
v_mfma_f32_16x16x32_bf16 v[168:171], a[40:43], v[68:71], v[168:171]
v_exp_f32 v32, v32
v_mfma_f32_16x16x32_bf16 v[200:203], a[40:43], v[72:75], v[200:203]
v_mfma_f32_16x16x32_bf16 v[232:235], a[40:43], v[76:79], v[232:235]
v_exp_f32 v33, v33
v_mfma_f32_16x16x32_bf16 v[236:239], a[44:47], v[76:79], v[236:239]
ds_read_b128 a[12:15], v2 offset:19456
v_mfma_f32_16x16x32_bf16 v[204:207], a[44:47], v[72:75], v[204:207]
v_exp_f32 v34, v34
v_mfma_f32_16x16x32_bf16 v[172:175], a[44:47], v[68:71], v[172:175]
v_exp_f32 v35, v35
v_mfma_f32_16x16x32_bf16 v[140:143], a[44:47], v[64:67], v[140:143]
v_mfma_f32_16x16x32_bf16 v[144:147], a[48:51], v[64:67], v[144:147]
ds_read_b128 a[16:19], v2 offset:20480
v_cvt_pk_bf16_f32 v50, v32, v33
v_cvt_pk_bf16_f32 v51, v34, v35
v_mfma_f32_16x16x32_bf16 v[176:179], a[48:51], v[68:71], v[176:179]
v_exp_f32 v36, v36
v_mfma_f32_16x16x32_bf16 v[208:211], a[48:51], v[72:75], v[208:211]
v_mfma_f32_16x16x32_bf16 v[240:243], a[48:51], v[76:79], v[240:243]
ds_read_b128 a[20:23], v2 offset:21504
v_exp_f32 v37, v37
v_mfma_f32_16x16x32_bf16 v[244:247], a[52:55], v[76:79], v[244:247]
v_mfma_f32_16x16x32_bf16 v[212:215], a[52:55], v[72:75], v[212:215]
v_exp_f32 v38, v38
v_mfma_f32_16x16x32_bf16 v[180:183], a[52:55], v[68:71], v[180:183]
v_exp_f32 v39, v39
v_mfma_f32_16x16x32_bf16 v[148:151], a[52:55], v[64:67], v[148:151]
ds_read_b128 a[24:27], v2 offset:22528
v_mfma_f32_16x16x32_bf16 v[152:155], a[56:59], v[64:67], v[152:155]
v_cvt_pk_bf16_f32 v54, v36, v37
v_cvt_pk_bf16_f32 v55, v38, v39
v_mfma_f32_16x16x32_bf16 v[184:187], a[56:59], v[68:71], v[184:187]
buffer_load_dwordx4 v3, s[88:91], s7 offen offset:1024 sc1 lds
v_mfma_f32_16x16x32_bf16 v[216:219], a[56:59], v[72:75], v[216:219]
v_exp_f32 v40, v40
v_mfma_f32_16x16x32_bf16 v[248:251], a[56:59], v[76:79], v[248:251]
v_mfma_f32_16x16x32_bf16 v[252:255], a[60:63], v[76:79], v[252:255]
ds_read_b128 a[28:31], v2 offset:23552
v_exp_f32 v41, v41
v_mfma_f32_16x16x32_bf16 v[220:223], a[60:63], v[72:75], v[220:223]
v_mfma_f32_16x16x32_bf16 v[188:191], a[60:63], v[68:71], v[188:191]
v_exp_f32 v42, v42
v_mfma_f32_16x16x32_bf16 v[156:159], a[60:63], v[64:67], v[156:159]
v_exp_f32 v43, v43
v_mfma_f32_16x16x32_bf16 a[224:227], a[240:243], v[64:67], a[224:227]
v_mfma_f32_16x16x32_bf16 a[228:231], a[240:243], v[68:71], a[228:231]
v_cvt_pk_bf16_f32 v58, v40, v41
v_cvt_pk_bf16_f32 v59, v42, v43
v_mfma_f32_16x16x32_bf16 a[232:235], a[240:243], v[72:75], a[232:235]
v_exp_f32 v44, v44
v_mfma_f32_16x16x32_bf16 a[236:239], a[240:243], v[76:79], a[236:239]
s_waitcnt lgkmcnt(7)
v_mfma_f32_16x16x32_bf16 v[16:19], a[0:3], a[160:163], v[80:83]
ds_read_b128 a[32:35], v2 offset:24576
v_exp_f32 v45, v45
s_waitcnt lgkmcnt(7)
v_mfma_f32_16x16x32_bf16 v[16:19], a[4:7], a[164:167], v[16:19]
s_waitcnt lgkmcnt(6)
v_mfma_f32_16x16x32_bf16 v[16:19], a[8:11], a[168:171], v[16:19]
v_exp_f32 v46, v46
s_waitcnt lgkmcnt(5)
v_mfma_f32_16x16x32_bf16 v[16:19], a[12:15], a[172:175], v[16:19]
ds_read_b128 a[36:39], v2 offset:25600
v_exp_f32 v47, v47
v_mfma_f32_16x16x32_bf16 v[20:23], a[0:3], a[176:179], v[84:87]
v_mfma_f32_16x16x32_bf16 v[20:23], a[4:7], a[180:183], v[20:23]
v_cvt_pk_bf16_f32 v62, v44, v45
v_cvt_pk_bf16_f32 v63, v46, v47
v_mfma_f32_16x16x32_bf16 v[20:23], a[8:11], a[184:187], v[20:23]
buffer_load_dwordx4 v3, s[88:91], s7 offen offset:2048 sc1 lds
v_mfma_f32_16x16x32_bf16 v[20:23], a[12:15], a[188:191], v[20:23]
ds_read_b128 a[40:43], v2 offset:26624
v_mfma_f32_16x16x32_bf16 v[24:27], a[0:3], a[192:195], v[88:91]
v_exp_f32 v16, v16
v_mfma_f32_16x16x32_bf16 v[24:27], a[4:7], a[196:199], v[24:27]
v_exp_f32 v17, v17
v_mfma_f32_16x16x32_bf16 v[24:27], a[8:11], a[200:203], v[24:27]
v_mfma_f32_16x16x32_bf16 v[24:27], a[12:15], a[204:207], v[24:27]
ds_read_b128 a[44:47], v2 offset:27648
v_exp_f32 v18, v18
v_mfma_f32_16x16x32_bf16 v[28:31], a[0:3], a[208:211], v[92:95]
v_exp_f32 v19, v19
v_mfma_f32_16x16x32_bf16 v[28:31], a[4:7], a[212:215], v[28:31]
v_mfma_f32_16x16x32_bf16 v[28:31], a[8:11], a[216:219], v[28:31]
ds_read_b128 a[48:51], v2 offset:28672
v_cvt_pk_bf16_f32 v64, v16, v17
v_cvt_pk_bf16_f32 v65, v18, v19
v_mfma_f32_16x16x32_bf16 v[28:31], a[12:15], a[220:223], v[28:31]
v_exp_f32 v20, v20
s_waitcnt lgkmcnt(8)
v_mfma_f32_16x16x32_bf16 v[32:35], a[16:19], a[160:163], v[80:83]
s_waitcnt lgkmcnt(7)
v_mfma_f32_16x16x32_bf16 v[32:35], a[20:23], a[164:167], v[32:35]
ds_read_b128 a[52:55], v2 offset:29696
v_exp_f32 v21, v21
s_waitcnt lgkmcnt(7)
v_mfma_f32_16x16x32_bf16 v[32:35], a[24:27], a[168:171], v[32:35]
s_waitcnt lgkmcnt(6)
v_mfma_f32_16x16x32_bf16 v[32:35], a[28:31], a[172:175], v[32:35]
v_exp_f32 v22, v22
v_mfma_f32_16x16x32_bf16 v[36:39], a[16:19], a[176:179], v[84:87]
v_exp_f32 v23, v23
v_mfma_f32_16x16x32_bf16 v[36:39], a[20:23], a[180:183], v[36:39]
ds_read_b128 a[56:59], v2 offset:30720
v_mfma_f32_16x16x32_bf16 v[36:39], a[24:27], a[184:187], v[36:39]
v_cvt_pk_bf16_f32 v68, v20, v21
v_cvt_pk_bf16_f32 v69, v22, v23
v_mfma_f32_16x16x32_bf16 v[36:39], a[28:31], a[188:191], v[36:39]
buffer_load_dwordx4 v3, s[88:91], s7 offen offset:3072 sc1 lds
v_mfma_f32_16x16x32_bf16 v[40:43], a[16:19], a[192:195], v[88:91]
v_exp_f32 v24, v24
v_mfma_f32_16x16x32_bf16 v[40:43], a[20:23], a[196:199], v[40:43]
ds_read_b128 a[60:63], v2 offset:31744
v_mfma_f32_16x16x32_bf16 v[40:43], a[24:27], a[200:203], v[40:43]
v_exp_f32 v25, v25
v_mfma_f32_16x16x32_bf16 v[40:43], a[28:31], a[204:207], v[40:43]
v_mfma_f32_16x16x32_bf16 v[44:47], a[16:19], a[208:211], v[92:95]
v_exp_f32 v26, v26
v_mfma_f32_16x16x32_bf16 v[44:47], a[20:23], a[212:215], v[44:47]
v_exp_f32 v27, v27
v_mfma_f32_16x16x32_bf16 v[44:47], a[24:27], a[216:219], v[44:47]
v_mfma_f32_16x16x32_bf16 v[44:47], a[28:31], a[220:223], v[44:47]
v_cvt_pk_bf16_f32 v72, v24, v25
v_cvt_pk_bf16_f32 v73, v26, v27
s_add_u32 s32, s32, 0x8000
s_add_u32 s7, s7, 0x8000
s_xor_b32 s19, s19, 0x8000
v_xor_b32 v2, 0x38000, v2
s_sub_u32 s15, s15, 1
s_cmp_lg_u32 s15, 0
s_cbranch_scc1 L_att_deven
s_cmp_ge_u32 s4, 2
s_cbranch_scc1 L_att_dl0_1
L_att_dl0_0:
s_waitcnt vmcnt(16) lgkmcnt(0)
s_barrier
v_mfma_f32_16x16x32_bf16 v[128:131], a[32:35], v[48:51], v[128:131]
ds_read_b128 a[0:3], v1 offset:0
v_exp_f32 v28, v28
v_mfma_f32_16x16x32_bf16 v[160:163], a[32:35], v[52:55], v[160:163]
v_mfma_f32_16x16x32_bf16 v[192:195], a[32:35], v[56:59], v[192:195]
v_exp_f32 v29, v29
v_mfma_f32_16x16x32_bf16 v[224:227], a[32:35], v[60:63], v[224:227]
ds_read_b128 a[4:7], v1 offset:1024
v_mfma_f32_16x16x32_bf16 v[228:231], a[36:39], v[60:63], v[228:231]
v_exp_f32 v30, v30
v_mfma_f32_16x16x32_bf16 v[196:199], a[36:39], v[56:59], v[196:199]
v_exp_f32 v31, v31
v_mfma_f32_16x16x32_bf16 v[164:167], a[36:39], v[52:55], v[164:167]
v_mfma_f32_16x16x32_bf16 v[132:135], a[36:39], v[48:51], v[132:135]
s_add_u32 m0, s27, 0x0
ds_read_b128 a[8:11], v1 offset:2048
v_cvt_pk_bf16_f32 v76, v28, v29
v_cvt_pk_bf16_f32 v77, v30, v31
v_mfma_f32_16x16x32_bf16 v[136:139], a[40:43], v[48:51], v[136:139]
buffer_load_dwordx4 v3, s[88:91], s32 offen offset:0 sc1 lds
v_mfma_f32_16x16x32_bf16 v[168:171], a[40:43], v[52:55], v[168:171]
v_exp_f32 v32, v32
v_mfma_f32_16x16x32_bf16 v[200:203], a[40:43], v[56:59], v[200:203]
v_mfma_f32_16x16x32_bf16 v[232:235], a[40:43], v[60:63], v[232:235]
v_exp_f32 v33, v33
v_mfma_f32_16x16x32_bf16 v[236:239], a[44:47], v[60:63], v[236:239]
ds_read_b128 a[12:15], v1 offset:3072
v_mfma_f32_16x16x32_bf16 v[204:207], a[44:47], v[56:59], v[204:207]
v_exp_f32 v34, v34
v_mfma_f32_16x16x32_bf16 v[172:175], a[44:47], v[52:55], v[172:175]
v_exp_f32 v35, v35
v_mfma_f32_16x16x32_bf16 v[140:143], a[44:47], v[48:51], v[140:143]
v_mfma_f32_16x16x32_bf16 v[144:147], a[48:51], v[48:51], v[144:147]
ds_read_b128 a[16:19], v1 offset:4096
v_cvt_pk_bf16_f32 v66, v32, v33
v_cvt_pk_bf16_f32 v67, v34, v35
v_mfma_f32_16x16x32_bf16 v[176:179], a[48:51], v[52:55], v[176:179]
v_exp_f32 v36, v36
v_mfma_f32_16x16x32_bf16 v[208:211], a[48:51], v[56:59], v[208:211]
v_mfma_f32_16x16x32_bf16 v[240:243], a[48:51], v[60:63], v[240:243]
ds_read_b128 a[20:23], v1 offset:5120
v_exp_f32 v37, v37
v_mfma_f32_16x16x32_bf16 v[244:247], a[52:55], v[60:63], v[244:247]
v_mfma_f32_16x16x32_bf16 v[212:215], a[52:55], v[56:59], v[212:215]
v_exp_f32 v38, v38
v_mfma_f32_16x16x32_bf16 v[180:183], a[52:55], v[52:55], v[180:183]
v_exp_f32 v39, v39
v_mfma_f32_16x16x32_bf16 v[148:151], a[52:55], v[48:51], v[148:151]
ds_read_b128 a[24:27], v1 offset:6144
v_mfma_f32_16x16x32_bf16 v[152:155], a[56:59], v[48:51], v[152:155]
v_cvt_pk_bf16_f32 v70, v36, v37
v_cvt_pk_bf16_f32 v71, v38, v39
v_mfma_f32_16x16x32_bf16 v[184:187], a[56:59], v[52:55], v[184:187]
buffer_load_dwordx4 v3, s[88:91], s32 offen offset:1024 sc1 lds
v_mfma_f32_16x16x32_bf16 v[216:219], a[56:59], v[56:59], v[216:219]
v_exp_f32 v40, v40
v_mfma_f32_16x16x32_bf16 v[248:251], a[56:59], v[60:63], v[248:251]
v_mfma_f32_16x16x32_bf16 v[252:255], a[60:63], v[60:63], v[252:255]
ds_read_b128 a[28:31], v1 offset:7168
v_exp_f32 v41, v41
v_mfma_f32_16x16x32_bf16 v[220:223], a[60:63], v[56:59], v[220:223]
v_mfma_f32_16x16x32_bf16 v[188:191], a[60:63], v[52:55], v[188:191]
v_exp_f32 v42, v42
v_mfma_f32_16x16x32_bf16 v[156:159], a[60:63], v[48:51], v[156:159]
v_exp_f32 v43, v43
v_mfma_f32_16x16x32_bf16 a[224:227], a[240:243], v[48:51], a[224:227]
v_mfma_f32_16x16x32_bf16 a[228:231], a[240:243], v[52:55], a[228:231]
v_cvt_pk_bf16_f32 v74, v40, v41
v_cvt_pk_bf16_f32 v75, v42, v43
v_mfma_f32_16x16x32_bf16 a[232:235], a[240:243], v[56:59], a[232:235]
v_exp_f32 v44, v44
v_mfma_f32_16x16x32_bf16 a[236:239], a[240:243], v[60:63], a[236:239]
s_waitcnt lgkmcnt(7)
v_mfma_f32_16x16x32_bf16 v[16:19], a[0:3], a[160:163], v[96:99]
ds_read_b128 a[32:35], v1 offset:8192
v_exp_f32 v45, v45
s_waitcnt lgkmcnt(7)
v_mfma_f32_16x16x32_bf16 v[16:19], a[4:7], a[164:167], v[16:19]
s_waitcnt lgkmcnt(6)
v_mfma_f32_16x16x32_bf16 v[16:19], a[8:11], a[168:171], v[16:19]
v_exp_f32 v46, v46
s_waitcnt lgkmcnt(5)
v_mfma_f32_16x16x32_bf16 v[16:19], a[12:15], a[172:175], v[16:19]
ds_read_b128 a[36:39], v1 offset:9216
v_exp_f32 v47, v47
v_mfma_f32_16x16x32_bf16 v[20:23], a[0:3], a[176:179], v[84:87]
v_mfma_f32_16x16x32_bf16 v[20:23], a[4:7], a[180:183], v[20:23]
v_cvt_pk_bf16_f32 v78, v44, v45
v_cvt_pk_bf16_f32 v79, v46, v47
v_mfma_f32_16x16x32_bf16 v[20:23], a[8:11], a[184:187], v[20:23]
buffer_load_dwordx4 v3, s[88:91], s32 offen offset:2048 sc1 lds
v_mfma_f32_16x16x32_bf16 v[20:23], a[12:15], a[188:191], v[20:23]
ds_read_b128 a[40:43], v1 offset:10240
v_mfma_f32_16x16x32_bf16 v[24:27], a[0:3], a[192:195], v[88:91]
v_exp_f32 v16, v16
v_mfma_f32_16x16x32_bf16 v[24:27], a[4:7], a[196:199], v[24:27]
v_exp_f32 v17, v17
v_mfma_f32_16x16x32_bf16 v[24:27], a[8:11], a[200:203], v[24:27]
v_mfma_f32_16x16x32_bf16 v[24:27], a[12:15], a[204:207], v[24:27]
ds_read_b128 a[44:47], v1 offset:11264
v_exp_f32 v18, v18
v_mfma_f32_16x16x32_bf16 v[28:31], a[0:3], a[208:211], v[92:95]
v_exp_f32 v19, v19
v_mfma_f32_16x16x32_bf16 v[28:31], a[4:7], a[212:215], v[28:31]
v_mfma_f32_16x16x32_bf16 v[28:31], a[8:11], a[216:219], v[28:31]
ds_read_b128 a[48:51], v1 offset:12288
v_cvt_pk_bf16_f32 v48, v16, v17
v_cvt_pk_bf16_f32 v49, v18, v19
v_mfma_f32_16x16x32_bf16 v[28:31], a[12:15], a[220:223], v[28:31]
v_exp_f32 v20, v20
s_waitcnt lgkmcnt(8)
v_mfma_f32_16x16x32_bf16 v[32:35], a[16:19], a[160:163], v[100:103]
s_waitcnt lgkmcnt(7)
v_mfma_f32_16x16x32_bf16 v[32:35], a[20:23], a[164:167], v[32:35]
ds_read_b128 a[52:55], v1 offset:13312
v_exp_f32 v21, v21
s_waitcnt lgkmcnt(7)
v_mfma_f32_16x16x32_bf16 v[32:35], a[24:27], a[168:171], v[32:35]
s_waitcnt lgkmcnt(6)
v_mfma_f32_16x16x32_bf16 v[32:35], a[28:31], a[172:175], v[32:35]
v_exp_f32 v22, v22
v_mfma_f32_16x16x32_bf16 v[36:39], a[16:19], a[176:179], v[84:87]
v_exp_f32 v23, v23
v_mfma_f32_16x16x32_bf16 v[36:39], a[20:23], a[180:183], v[36:39]
ds_read_b128 a[56:59], v1 offset:14336
v_mfma_f32_16x16x32_bf16 v[36:39], a[24:27], a[184:187], v[36:39]
v_cvt_pk_bf16_f32 v52, v20, v21
v_cvt_pk_bf16_f32 v53, v22, v23
v_mfma_f32_16x16x32_bf16 v[36:39], a[28:31], a[188:191], v[36:39]
buffer_load_dwordx4 v3, s[88:91], s32 offen offset:3072 sc1 lds
v_mfma_f32_16x16x32_bf16 v[40:43], a[16:19], a[192:195], v[88:91]
v_exp_f32 v24, v24
v_mfma_f32_16x16x32_bf16 v[40:43], a[20:23], a[196:199], v[40:43]
ds_read_b128 a[60:63], v1 offset:15360
v_mfma_f32_16x16x32_bf16 v[40:43], a[24:27], a[200:203], v[40:43]
v_exp_f32 v25, v25
v_mfma_f32_16x16x32_bf16 v[40:43], a[28:31], a[204:207], v[40:43]
v_mfma_f32_16x16x32_bf16 v[44:47], a[16:19], a[208:211], v[92:95]
v_exp_f32 v26, v26
v_mfma_f32_16x16x32_bf16 v[44:47], a[20:23], a[212:215], v[44:47]
v_exp_f32 v27, v27
v_mfma_f32_16x16x32_bf16 v[44:47], a[24:27], a[216:219], v[44:47]
v_mfma_f32_16x16x32_bf16 v[44:47], a[28:31], a[220:223], v[44:47]
v_cvt_pk_bf16_f32 v56, v24, v25
v_cvt_pk_bf16_f32 v57, v26, v27
s_waitcnt lgkmcnt(0)
v_mfma_f32_16x16x32_bf16 v[128:131], a[32:35], v[64:67], v[128:131]
ds_read_b128 a[0:3], v1 offset:16384
v_exp_f32 v28, v28
v_mfma_f32_16x16x32_bf16 v[160:163], a[32:35], v[68:71], v[160:163]
v_mfma_f32_16x16x32_bf16 v[192:195], a[32:35], v[72:75], v[192:195]
v_exp_f32 v29, v29
v_mfma_f32_16x16x32_bf16 v[224:227], a[32:35], v[76:79], v[224:227]
ds_read_b128 a[4:7], v1 offset:17408
v_mfma_f32_16x16x32_bf16 v[228:231], a[36:39], v[76:79], v[228:231]
v_exp_f32 v30, v30
v_mfma_f32_16x16x32_bf16 v[196:199], a[36:39], v[72:75], v[196:199]
v_exp_f32 v31, v31
v_mfma_f32_16x16x32_bf16 v[164:167], a[36:39], v[68:71], v[164:167]
s_add_u32 m0, s27, 0x1000
v_mfma_f32_16x16x32_bf16 v[132:135], a[36:39], v[64:67], v[132:135]
buffer_load_dwordx4 v3, s[88:91], s7 offen offset:0 sc1 lds
v_mfma_f32_16x16x32_bf16 v[136:139], a[40:43], v[64:67], v[136:139]
ds_read_b128 a[8:11], v1 offset:18432
v_cvt_pk_bf16_f32 v60, v28, v29
v_cvt_pk_bf16_f32 v61, v30, v31
v_mfma_f32_16x16x32_bf16 v[168:171], a[40:43], v[68:71], v[168:171]
v_exp_f32 v32, v32
v_mfma_f32_16x16x32_bf16 v[200:203], a[40:43], v[72:75], v[200:203]
v_mfma_f32_16x16x32_bf16 v[232:235], a[40:43], v[76:79], v[232:235]
v_exp_f32 v33, v33
v_mfma_f32_16x16x32_bf16 v[236:239], a[44:47], v[76:79], v[236:239]
ds_read_b128 a[12:15], v1 offset:19456
v_mfma_f32_16x16x32_bf16 v[204:207], a[44:47], v[72:75], v[204:207]
v_exp_f32 v34, v34
v_mfma_f32_16x16x32_bf16 v[172:175], a[44:47], v[68:71], v[172:175]
v_exp_f32 v35, v35
v_mfma_f32_16x16x32_bf16 v[140:143], a[44:47], v[64:67], v[140:143]
v_mfma_f32_16x16x32_bf16 v[144:147], a[48:51], v[64:67], v[144:147]
ds_read_b128 a[16:19], v1 offset:20480
v_cvt_pk_bf16_f32 v50, v32, v33
v_cvt_pk_bf16_f32 v51, v34, v35
v_mfma_f32_16x16x32_bf16 v[176:179], a[48:51], v[68:71], v[176:179]
v_exp_f32 v36, v36
v_mfma_f32_16x16x32_bf16 v[208:211], a[48:51], v[72:75], v[208:211]
v_mfma_f32_16x16x32_bf16 v[240:243], a[48:51], v[76:79], v[240:243]
ds_read_b128 a[20:23], v1 offset:21504
v_exp_f32 v37, v37
v_mfma_f32_16x16x32_bf16 v[244:247], a[52:55], v[76:79], v[244:247]
v_mfma_f32_16x16x32_bf16 v[212:215], a[52:55], v[72:75], v[212:215]
v_exp_f32 v38, v38
v_mfma_f32_16x16x32_bf16 v[180:183], a[52:55], v[68:71], v[180:183]
buffer_load_dwordx4 v3, s[88:91], s7 offen offset:1024 sc1 lds
v_mfma_f32_16x16x32_bf16 v[148:151], a[52:55], v[64:67], v[148:151]
v_exp_f32 v39, v39
v_mfma_f32_16x16x32_bf16 v[152:155], a[56:59], v[64:67], v[152:155]
ds_read_b128 a[24:27], v1 offset:22528
v_mfma_f32_16x16x32_bf16 v[184:187], a[56:59], v[68:71], v[184:187]
v_cvt_pk_bf16_f32 v54, v36, v37
v_cvt_pk_bf16_f32 v55, v38, v39
v_mfma_f32_16x16x32_bf16 v[216:219], a[56:59], v[72:75], v[216:219]
v_exp_f32 v40, v40
v_mfma_f32_16x16x32_bf16 v[248:251], a[56:59], v[76:79], v[248:251]
v_mfma_f32_16x16x32_bf16 v[252:255], a[60:63], v[76:79], v[252:255]
ds_read_b128 a[28:31], v1 offset:23552
v_exp_f32 v41, v41
v_mfma_f32_16x16x32_bf16 v[220:223], a[60:63], v[72:75], v[220:223]
v_mfma_f32_16x16x32_bf16 v[188:191], a[60:63], v[68:71], v[188:191]
v_exp_f32 v42, v42
v_mfma_f32_16x16x32_bf16 v[156:159], a[60:63], v[64:67], v[156:159]
v_exp_f32 v43, v43
v_mfma_f32_16x16x32_bf16 a[224:227], a[240:243], v[64:67], a[224:227]
v_mfma_f32_16x16x32_bf16 a[228:231], a[240:243], v[68:71], a[228:231]
v_cvt_pk_bf16_f32 v58, v40, v41
v_cvt_pk_bf16_f32 v59, v42, v43
v_mfma_f32_16x16x32_bf16 a[232:235], a[240:243], v[72:75], a[232:235]
v_exp_f32 v44, v44
v_mfma_f32_16x16x32_bf16 a[236:239], a[240:243], v[76:79], a[236:239]
s_waitcnt lgkmcnt(7)
v_mfma_f32_16x16x32_bf16 v[20:23], a[0:3], a[176:179], v[84:87]
ds_read_b128 a[32:35], v1 offset:24576
v_exp_f32 v45, v45
s_waitcnt lgkmcnt(7)
v_mfma_f32_16x16x32_bf16 v[20:23], a[4:7], a[180:183], v[20:23]
buffer_load_dwordx4 v3, s[88:91], s7 offen offset:2048 sc1 lds
s_waitcnt lgkmcnt(6)
v_mfma_f32_16x16x32_bf16 v[20:23], a[8:11], a[184:187], v[20:23]
s_waitcnt lgkmcnt(5)
v_mfma_f32_16x16x32_bf16 v[20:23], a[12:15], a[188:191], v[20:23]
ds_read_b128 a[36:39], v1 offset:25600
v_exp_f32 v46, v46
v_mfma_f32_16x16x32_bf16 v[24:27], a[0:3], a[192:195], v[88:91]
v_exp_f32 v47, v47
v_mfma_f32_16x16x32_bf16 v[24:27], a[4:7], a[196:199], v[24:27]
ds_read_b128 a[40:43], v1 offset:26624
v_mfma_f32_16x16x32_bf16 v[24:27], a[8:11], a[200:203], v[24:27]
v_cvt_pk_bf16_f32 v62, v44, v45
v_cvt_pk_bf16_f32 v63, v46, v47
v_mfma_f32_16x16x32_bf16 v[24:27], a[12:15], a[204:207], v[24:27]
v_mfma_f32_16x16x32_bf16 v[28:31], a[0:3], a[208:211], v[92:95]
ds_read_b128 a[44:47], v1 offset:27648
v_exp_f32 v20, v20
v_mfma_f32_16x16x32_bf16 v[28:31], a[4:7], a[212:215], v[28:31]
v_exp_f32 v21, v21
v_mfma_f32_16x16x32_bf16 v[28:31], a[8:11], a[216:219], v[28:31]
ds_read_b128 a[48:51], v1 offset:28672
v_mfma_f32_16x16x32_bf16 v[28:31], a[12:15], a[220:223], v[28:31]
v_exp_f32 v22, v22
s_waitcnt lgkmcnt(8)
v_mfma_f32_16x16x32_bf16 v[36:39], a[16:19], a[176:179], v[84:87]
ds_read_b128 a[52:55], v1 offset:29696
v_exp_f32 v23, v23
s_waitcnt lgkmcnt(8)
v_mfma_f32_16x16x32_bf16 v[36:39], a[20:23], a[180:183], v[36:39]
s_waitcnt lgkmcnt(7)
v_mfma_f32_16x16x32_bf16 v[36:39], a[24:27], a[184:187], v[36:39]
v_cvt_pk_bf16_f32 v68, v20, v21
v_cvt_pk_bf16_f32 v69, v22, v23
s_waitcnt lgkmcnt(6)
v_mfma_f32_16x16x32_bf16 v[36:39], a[28:31], a[188:191], v[36:39]
ds_read_b128 a[56:59], v1 offset:30720
v_exp_f32 v24, v24
v_mfma_f32_16x16x32_bf16 v[40:43], a[16:19], a[192:195], v[88:91]
buffer_load_dwordx4 v3, s[88:91], s7 offen offset:3072 sc1 lds
v_mfma_f32_16x16x32_bf16 v[40:43], a[20:23], a[196:199], v[40:43]
v_mfma_f32_16x16x32_bf16 v[40:43], a[24:27], a[200:203], v[40:43]
ds_read_b128 a[60:63], v1 offset:31744
v_exp_f32 v25, v25
v_mfma_f32_16x16x32_bf16 v[40:43], a[28:31], a[204:207], v[40:43]
v_mfma_f32_16x16x32_bf16 v[44:47], a[16:19], a[208:211], v[92:95]
v_exp_f32 v26, v26
v_mfma_f32_16x16x32_bf16 v[44:47], a[20:23], a[212:215], v[44:47]
v_exp_f32 v27, v27
v_mfma_f32_16x16x32_bf16 v[44:47], a[24:27], a[216:219], v[44:47]
v_mfma_f32_16x16x32_bf16 v[44:47], a[28:31], a[220:223], v[44:47]
v_cvt_pk_bf16_f32 v72, v24, v25
v_cvt_pk_bf16_f32 v73, v26, v27
s_add_u32 s32, s32, 0x8000
s_add_u32 s7, s7, 0x8000
s_xor_b32 s27, s27, 0x38000
v_xor_b32 v1, 0x8000, v1
L_att_l1_0:
s_waitcnt vmcnt(16) lgkmcnt(0)
s_barrier
v_mfma_f32_16x16x32_bf16 v[128:131], a[32:35], v[48:51], v[128:131]
ds_read_b128 a[0:3], v2 offset:0
v_exp_f32 v28, v28
v_mfma_f32_16x16x32_bf16 v[160:163], a[32:35], v[52:55], v[160:163]
v_mfma_f32_16x16x32_bf16 v[192:195], a[32:35], v[56:59], v[192:195]
v_exp_f32 v29, v29
v_mfma_f32_16x16x32_bf16 v[224:227], a[32:35], v[60:63], v[224:227]
ds_read_b128 a[4:7], v2 offset:1024
v_mfma_f32_16x16x32_bf16 v[228:231], a[36:39], v[60:63], v[228:231]
v_exp_f32 v30, v30
v_mfma_f32_16x16x32_bf16 v[196:199], a[36:39], v[56:59], v[196:199]
v_mfma_f32_16x16x32_bf16 v[164:167], a[36:39], v[52:55], v[164:167]
s_add_u32 m0, s19, 0x0
v_exp_f32 v31, v31
v_mfma_f32_16x16x32_bf16 v[132:135], a[36:39], v[48:51], v[132:135]
buffer_load_dwordx4 v3, s[88:91], s32 offen offset:0 sc1 lds
v_mfma_f32_16x16x32_bf16 v[136:139], a[40:43], v[48:51], v[136:139]
ds_read_b128 a[8:11], v2 offset:2048
v_mfma_f32_16x16x32_bf16 v[168:171], a[40:43], v[52:55], v[168:171]
v_cvt_pk_bf16_f32 v76, v28, v29
v_cvt_pk_bf16_f32 v77, v30, v31
v_mfma_f32_16x16x32_bf16 v[200:203], a[40:43], v[56:59], v[200:203]
v_mfma_f32_16x16x32_bf16 v[232:235], a[40:43], v[60:63], v[232:235]
v_exp_f32 v36, v36
v_mfma_f32_16x16x32_bf16 v[236:239], a[44:47], v[60:63], v[236:239]
ds_read_b128 a[12:15], v2 offset:3072
v_mfma_f32_16x16x32_bf16 v[204:207], a[44:47], v[56:59], v[204:207]
v_exp_f32 v37, v37
v_mfma_f32_16x16x32_bf16 v[172:175], a[44:47], v[52:55], v[172:175]
v_mfma_f32_16x16x32_bf16 v[140:143], a[44:47], v[48:51], v[140:143]
v_exp_f32 v38, v38
v_mfma_f32_16x16x32_bf16 v[144:147], a[48:51], v[48:51], v[144:147]
ds_read_b128 a[16:19], v2 offset:4096
v_exp_f32 v39, v39
v_mfma_f32_16x16x32_bf16 v[176:179], a[48:51], v[52:55], v[176:179]
v_mfma_f32_16x16x32_bf16 v[208:211], a[48:51], v[56:59], v[208:211]
v_cvt_pk_bf16_f32 v70, v36, v37
v_cvt_pk_bf16_f32 v71, v38, v39
v_mfma_f32_16x16x32_bf16 v[240:243], a[48:51], v[60:63], v[240:243]
ds_read_b128 a[20:23], v2 offset:5120
v_mfma_f32_16x16x32_bf16 v[244:247], a[52:55], v[60:63], v[244:247]
v_exp_f32 v40, v40
v_mfma_f32_16x16x32_bf16 v[212:215], a[52:55], v[56:59], v[212:215]
v_mfma_f32_16x16x32_bf16 v[180:183], a[52:55], v[52:55], v[180:183]
buffer_load_dwordx4 v3, s[88:91], s32 offen offset:1024 sc1 lds
v_mfma_f32_16x16x32_bf16 v[148:151], a[52:55], v[48:51], v[148:151]
v_exp_f32 v41, v41
v_mfma_f32_16x16x32_bf16 v[152:155], a[56:59], v[48:51], v[152:155]
ds_read_b128 a[24:27], v2 offset:6144
v_mfma_f32_16x16x32_bf16 v[184:187], a[56:59], v[52:55], v[184:187]
v_exp_f32 v42, v42
v_mfma_f32_16x16x32_bf16 v[216:219], a[56:59], v[56:59], v[216:219]
v_mfma_f32_16x16x32_bf16 v[248:251], a[56:59], v[60:63], v[248:251]
v_exp_f32 v43, v43
v_mfma_f32_16x16x32_bf16 v[252:255], a[60:63], v[60:63], v[252:255]
ds_read_b128 a[28:31], v2 offset:7168
v_mfma_f32_16x16x32_bf16 v[220:223], a[60:63], v[56:59], v[220:223]
v_cvt_pk_bf16_f32 v74, v40, v41
v_cvt_pk_bf16_f32 v75, v42, v43
v_mfma_f32_16x16x32_bf16 v[188:191], a[60:63], v[52:55], v[188:191]
v_exp_f32 v44, v44
v_mfma_f32_16x16x32_bf16 v[156:159], a[60:63], v[48:51], v[156:159]
v_mfma_f32_16x16x32_bf16 a[224:227], a[240:243], v[48:51], a[224:227]
v_exp_f32 v45, v45
v_mfma_f32_16x16x32_bf16 a[228:231], a[240:243], v[52:55], a[228:231]
v_mfma_f32_16x16x32_bf16 a[232:235], a[240:243], v[56:59], a[232:235]
v_exp_f32 v46, v46
v_mfma_f32_16x16x32_bf16 a[236:239], a[240:243], v[60:63], a[236:239]
s_waitcnt lgkmcnt(7)
v_mfma_f32_16x16x32_bf16 v[20:23], a[0:3], a[176:179], v[84:87]
ds_read_b128 a[32:35], v2 offset:8192
v_exp_f32 v47, v47
s_waitcnt lgkmcnt(7)
v_mfma_f32_16x16x32_bf16 v[20:23], a[4:7], a[180:183], v[20:23]
buffer_load_dwordx4 v3, s[88:91], s32 offen offset:2048 sc1 lds
s_waitcnt lgkmcnt(6)
v_mfma_f32_16x16x32_bf16 v[20:23], a[8:11], a[184:187], v[20:23]
s_waitcnt lgkmcnt(5)
v_mfma_f32_16x16x32_bf16 v[20:23], a[12:15], a[188:191], v[20:23]
ds_read_b128 a[36:39], v2 offset:9216
v_cvt_pk_bf16_f32 v78, v44, v45
v_cvt_pk_bf16_f32 v79, v46, v47
v_mfma_f32_16x16x32_bf16 v[24:27], a[0:3], a[192:195], v[88:91]
v_mfma_f32_16x16x32_bf16 v[24:27], a[4:7], a[196:199], v[24:27]
ds_read_b128 a[40:43], v2 offset:10240
v_mfma_f32_16x16x32_bf16 v[24:27], a[8:11], a[200:203], v[24:27]
v_mfma_f32_16x16x32_bf16 v[24:27], a[12:15], a[204:207], v[24:27]
v_mfma_f32_16x16x32_bf16 v[28:31], a[0:3], a[208:211], v[92:95]
ds_read_b128 a[44:47], v2 offset:11264
v_exp_f32 v20, v20
v_mfma_f32_16x16x32_bf16 v[28:31], a[4:7], a[212:215], v[28:31]
v_exp_f32 v21, v21
v_mfma_f32_16x16x32_bf16 v[28:31], a[8:11], a[216:219], v[28:31]
ds_read_b128 a[48:51], v2 offset:12288
v_exp_f32 v22, v22
v_mfma_f32_16x16x32_bf16 v[28:31], a[12:15], a[220:223], v[28:31]
v_exp_f32 v23, v23
s_waitcnt lgkmcnt(8)
v_mfma_f32_16x16x32_bf16 v[36:39], a[16:19], a[176:179], v[84:87]
ds_read_b128 a[52:55], v2 offset:13312
v_cvt_pk_bf16_f32 v52, v20, v21
v_cvt_pk_bf16_f32 v53, v22, v23
s_waitcnt lgkmcnt(8)
v_mfma_f32_16x16x32_bf16 v[36:39], a[20:23], a[180:183], v[36:39]
s_waitcnt lgkmcnt(7)
v_mfma_f32_16x16x32_bf16 v[36:39], a[24:27], a[184:187], v[36:39]
v_exp_f32 v24, v24
s_waitcnt lgkmcnt(6)
v_mfma_f32_16x16x32_bf16 v[36:39], a[28:31], a[188:191], v[36:39]
ds_read_b128 a[56:59], v2 offset:14336
v_mfma_f32_16x16x32_bf16 v[40:43], a[16:19], a[192:195], v[88:91]
buffer_load_dwordx4 v3, s[88:91], s32 offen offset:3072 sc1 lds
v_mfma_f32_16x16x32_bf16 v[40:43], a[20:23], a[196:199], v[40:43]
v_exp_f32 v25, v25
v_mfma_f32_16x16x32_bf16 v[40:43], a[24:27], a[200:203], v[40:43]
ds_read_b128 a[60:63], v2 offset:15360
v_mfma_f32_16x16x32_bf16 v[40:43], a[28:31], a[204:207], v[40:43]
v_exp_f32 v26, v26
v_mfma_f32_16x16x32_bf16 v[44:47], a[16:19], a[208:211], v[92:95]
v_mfma_f32_16x16x32_bf16 v[44:47], a[20:23], a[212:215], v[44:47]
v_exp_f32 v27, v27
v_mfma_f32_16x16x32_bf16 v[44:47], a[24:27], a[216:219], v[44:47]
v_mfma_f32_16x16x32_bf16 v[44:47], a[28:31], a[220:223], v[44:47]
v_cvt_pk_bf16_f32 v56, v24, v25
v_cvt_pk_bf16_f32 v57, v26, v27
s_waitcnt lgkmcnt(0)
v_mfma_f32_16x16x32_bf16 v[160:163], a[32:35], v[68:71], v[160:163]
ds_read_b128 a[0:3], v2 offset:16384
v_exp_f32 v28, v28
v_mfma_f32_16x16x32_bf16 v[192:195], a[32:35], v[72:75], v[192:195]
v_mfma_f32_16x16x32_bf16 v[224:227], a[32:35], v[76:79], v[224:227]
ds_read_b128 a[4:7], v2 offset:17408
v_exp_f32 v29, v29
v_mfma_f32_16x16x32_bf16 v[228:231], a[36:39], v[76:79], v[228:231]
v_mfma_f32_16x16x32_bf16 v[196:199], a[36:39], v[72:75], v[196:199]
v_exp_f32 v30, v30
v_mfma_f32_16x16x32_bf16 v[164:167], a[36:39], v[68:71], v[164:167]
s_add_u32 m0, s19, 0x1000
ds_read_b128 a[8:11], v2 offset:18432
v_exp_f32 v31, v31
v_mfma_f32_16x16x32_bf16 v[168:171], a[40:43], v[68:71], v[168:171]
buffer_load_dwordx4 v3, s[88:91], s7 offen offset:0 sc1 lds
v_mfma_f32_16x16x32_bf16 v[200:203], a[40:43], v[72:75], v[200:203]
v_mfma_f32_16x16x32_bf16 v[232:235], a[40:43], v[76:79], v[232:235]
ds_read_b128 a[12:15], v2 offset:19456
v_cvt_pk_bf16_f32 v60, v28, v29
v_cvt_pk_bf16_f32 v61, v30, v31
v_mfma_f32_16x16x32_bf16 v[236:239], a[44:47], v[76:79], v[236:239]
v_exp_f32 v36, v36
v_mfma_f32_16x16x32_bf16 v[204:207], a[44:47], v[72:75], v[204:207]
v_mfma_f32_16x16x32_bf16 v[172:175], a[44:47], v[68:71], v[172:175]
ds_read_b128 a[16:19], v2 offset:20480
v_exp_f32 v37, v37
v_mfma_f32_16x16x32_bf16 v[176:179], a[48:51], v[68:71], v[176:179]
v_exp_f32 v38, v38
v_mfma_f32_16x16x32_bf16 v[208:211], a[48:51], v[72:75], v[208:211]
v_mfma_f32_16x16x32_bf16 v[240:243], a[48:51], v[76:79], v[240:243]
ds_read_b128 a[20:23], v2 offset:21504
v_exp_f32 v39, v39
v_mfma_f32_16x16x32_bf16 v[244:247], a[52:55], v[76:79], v[244:247]
v_mfma_f32_16x16x32_bf16 v[212:215], a[52:55], v[72:75], v[212:215]
ds_read_b128 a[24:27], v2 offset:22528
v_cvt_pk_bf16_f32 v54, v36, v37
v_cvt_pk_bf16_f32 v55, v38, v39
v_mfma_f32_16x16x32_bf16 v[180:183], a[52:55], v[68:71], v[180:183]
v_exp_f32 v40, v40
v_mfma_f32_16x16x32_bf16 v[184:187], a[56:59], v[68:71], v[184:187]
buffer_load_dwordx4 v3, s[88:91], s7 offen offset:1024 sc1 lds
v_mfma_f32_16x16x32_bf16 v[216:219], a[56:59], v[72:75], v[216:219]
v_mfma_f32_16x16x32_bf16 v[248:251], a[56:59], v[76:79], v[248:251]
ds_read_b128 a[28:31], v2 offset:23552
v_exp_f32 v41, v41
v_mfma_f32_16x16x32_bf16 v[252:255], a[60:63], v[76:79], v[252:255]
v_exp_f32 v42, v42
v_mfma_f32_16x16x32_bf16 v[220:223], a[60:63], v[72:75], v[220:223]
v_mfma_f32_16x16x32_bf16 v[188:191], a[60:63], v[68:71], v[188:191]
v_exp_f32 v43, v43
v_mfma_f32_16x16x32_bf16 a[228:231], a[240:243], v[68:71], a[228:231]
v_cvt_pk_bf16_f32 v58, v40, v41
v_cvt_pk_bf16_f32 v59, v42, v43
v_mfma_f32_16x16x32_bf16 a[232:235], a[240:243], v[72:75], a[232:235]
v_mfma_f32_16x16x32_bf16 a[236:239], a[240:243], v[76:79], a[236:239]
v_exp_f32 v44, v44
s_waitcnt lgkmcnt(7)
v_mfma_f32_16x16x32_bf16 v[20:23], a[0:3], a[176:179], v[104:107]
ds_read_b128 a[32:35], v2 offset:24576
s_waitcnt lgkmcnt(7)
v_mfma_f32_16x16x32_bf16 v[20:23], a[4:7], a[180:183], v[20:23]
v_exp_f32 v45, v45
s_waitcnt lgkmcnt(6)
v_mfma_f32_16x16x32_bf16 v[20:23], a[8:11], a[184:187], v[20:23]
ds_read_b128 a[36:39], v2 offset:25600
v_exp_f32 v46, v46
s_waitcnt lgkmcnt(6)
v_mfma_f32_16x16x32_bf16 v[20:23], a[12:15], a[188:191], v[20:23]
buffer_load_dwordx4 v3, s[88:91], s7 offen offset:2048 sc1 lds
v_mfma_f32_16x16x32_bf16 v[24:27], a[0:3], a[192:195], v[88:91]
v_mfma_f32_16x16x32_bf16 v[24:27], a[4:7], a[196:199], v[24:27]
ds_read_b128 a[40:43], v2 offset:26624
v_exp_f32 v47, v47
v_mfma_f32_16x16x32_bf16 v[24:27], a[8:11], a[200:203], v[24:27]
v_cvt_pk_bf16_f32 v62, v44, v45
v_cvt_pk_bf16_f32 v63, v46, v47
v_mfma_f32_16x16x32_bf16 v[24:27], a[12:15], a[204:207], v[24:27]
v_mfma_f32_16x16x32_bf16 v[28:31], a[0:3], a[208:211], v[92:95]
ds_read_b128 a[44:47], v2 offset:27648
v_exp_f32 v20, v20
v_mfma_f32_16x16x32_bf16 v[28:31], a[4:7], a[212:215], v[28:31]
v_exp_f32 v21, v21
v_mfma_f32_16x16x32_bf16 v[28:31], a[8:11], a[216:219], v[28:31]
ds_read_b128 a[48:51], v2 offset:28672
v_mfma_f32_16x16x32_bf16 v[28:31], a[12:15], a[220:223], v[28:31]
v_exp_f32 v22, v22
s_waitcnt lgkmcnt(8)
v_mfma_f32_16x16x32_bf16 v[36:39], a[16:19], a[176:179], v[108:111]
ds_read_b128 a[52:55], v2 offset:29696
s_waitcnt lgkmcnt(8)
v_mfma_f32_16x16x32_bf16 v[36:39], a[20:23], a[180:183], v[36:39]
v_exp_f32 v23, v23
s_waitcnt lgkmcnt(7)
v_mfma_f32_16x16x32_bf16 v[36:39], a[24:27], a[184:187], v[36:39]
v_cvt_pk_bf16_f32 v68, v20, v21
v_cvt_pk_bf16_f32 v69, v22, v23
s_waitcnt lgkmcnt(6)
v_mfma_f32_16x16x32_bf16 v[36:39], a[28:31], a[188:191], v[36:39]
buffer_load_dwordx4 v3, s[88:91], s7 offen offset:3072 sc1 lds
v_mfma_f32_16x16x32_bf16 v[40:43], a[16:19], a[192:195], v[88:91]
ds_read_b128 a[56:59], v2 offset:30720
v_mfma_f32_16x16x32_bf16 v[40:43], a[20:23], a[196:199], v[40:43]
v_exp_f32 v24, v24
v_mfma_f32_16x16x32_bf16 v[40:43], a[24:27], a[200:203], v[40:43]
ds_read_b128 a[60:63], v2 offset:31744
v_exp_f32 v25, v25
v_mfma_f32_16x16x32_bf16 v[40:43], a[28:31], a[204:207], v[40:43]
v_mfma_f32_16x16x32_bf16 v[44:47], a[16:19], a[208:211], v[92:95]
v_exp_f32 v26, v26
v_mfma_f32_16x16x32_bf16 v[44:47], a[20:23], a[212:215], v[44:47]
v_exp_f32 v27, v27
v_mfma_f32_16x16x32_bf16 v[44:47], a[24:27], a[216:219], v[44:47]
v_mfma_f32_16x16x32_bf16 v[44:47], a[28:31], a[220:223], v[44:47]
v_cvt_pk_bf16_f32 v72, v24, v25
v_cvt_pk_bf16_f32 v73, v26, v27
s_add_u32 s32, s32, 0x8000
s_add_u32 s7, s7, 0x8000
s_xor_b32 s19, s19, 0x8000
v_xor_b32 v2, 0x38000, v2
s_sub_u32 s15, 7, s6
s_lshl_b32 s15, s15, 1
s_cbranch_scc0 L_att_lh0_0
s_waitcnt vmcnt(16) lgkmcnt(0)
s_barrier
v_mfma_f32_16x16x32_bf16 v[160:163], a[32:35], v[52:55], v[160:163]
ds_read_b128 a[0:3], v1 offset:0
v_exp_f32 v28, v28
v_mfma_f32_16x16x32_bf16 v[192:195], a[32:35], v[56:59], v[192:195]
v_mfma_f32_16x16x32_bf16 v[224:227], a[32:35], v[60:63], v[224:227]
ds_read_b128 a[4:7], v1 offset:1024
v_exp_f32 v29, v29
v_mfma_f32_16x16x32_bf16 v[228:231], a[36:39], v[60:63], v[228:231]
v_mfma_f32_16x16x32_bf16 v[196:199], a[36:39], v[56:59], v[196:199]
s_add_u32 m0, s27, 0x0
v_exp_f32 v30, v30
v_mfma_f32_16x16x32_bf16 v[164:167], a[36:39], v[52:55], v[164:167]
buffer_load_dwordx4 v3, s[88:91], s32 offen offset:0 sc1 lds
v_mfma_f32_16x16x32_bf16 v[168:171], a[40:43], v[52:55], v[168:171]
ds_read_b128 a[8:11], v1 offset:2048
v_exp_f32 v31, v31
v_mfma_f32_16x16x32_bf16 v[200:203], a[40:43], v[56:59], v[200:203]
v_mfma_f32_16x16x32_bf16 v[232:235], a[40:43], v[60:63], v[232:235]
ds_read_b128 a[12:15], v1 offset:3072
v_cvt_pk_bf16_f32 v76, v28, v29
v_cvt_pk_bf16_f32 v77, v30, v31
v_mfma_f32_16x16x32_bf16 v[236:239], a[44:47], v[60:63], v[236:239]
v_exp_f32 v36, v36
v_mfma_f32_16x16x32_bf16 v[204:207], a[44:47], v[56:59], v[204:207]
v_mfma_f32_16x16x32_bf16 v[172:175], a[44:47], v[52:55], v[172:175]
ds_read_b128 a[16:19], v1 offset:4096
v_exp_f32 v37, v37
v_mfma_f32_16x16x32_bf16 v[176:179], a[48:51], v[52:55], v[176:179]
v_exp_f32 v38, v38
v_mfma_f32_16x16x32_bf16 v[208:211], a[48:51], v[56:59], v[208:211]
v_mfma_f32_16x16x32_bf16 v[240:243], a[48:51], v[60:63], v[240:243]
ds_read_b128 a[20:23], v1 offset:5120
v_exp_f32 v39, v39
v_mfma_f32_16x16x32_bf16 v[244:247], a[52:55], v[60:63], v[244:247]
buffer_load_dwordx4 v3, s[88:91], s32 offen offset:1024 sc1 lds
v_mfma_f32_16x16x32_bf16 v[212:215], a[52:55], v[56:59], v[212:215]
v_mfma_f32_16x16x32_bf16 v[180:183], a[52:55], v[52:55], v[180:183]
ds_read_b128 a[24:27], v1 offset:6144
v_cvt_pk_bf16_f32 v70, v36, v37
v_cvt_pk_bf16_f32 v71, v38, v39
v_mfma_f32_16x16x32_bf16 v[184:187], a[56:59], v[52:55], v[184:187]
v_exp_f32 v40, v40
v_mfma_f32_16x16x32_bf16 v[216:219], a[56:59], v[56:59], v[216:219]
v_mfma_f32_16x16x32_bf16 v[248:251], a[56:59], v[60:63], v[248:251]
ds_read_b128 a[28:31], v1 offset:7168
v_exp_f32 v41, v41
v_mfma_f32_16x16x32_bf16 v[252:255], a[60:63], v[60:63], v[252:255]
v_exp_f32 v42, v42
v_mfma_f32_16x16x32_bf16 v[220:223], a[60:63], v[56:59], v[220:223]
v_mfma_f32_16x16x32_bf16 v[188:191], a[60:63], v[52:55], v[188:191]
v_exp_f32 v43, v43
v_mfma_f32_16x16x32_bf16 a[228:231], a[240:243], v[52:55], a[228:231]
v_cvt_pk_bf16_f32 v74, v40, v41
v_cvt_pk_bf16_f32 v75, v42, v43
v_mfma_f32_16x16x32_bf16 a[232:235], a[240:243], v[56:59], a[232:235]
buffer_load_dwordx4 v3, s[88:91], s32 offen offset:2048 sc1 lds
v_mfma_f32_16x16x32_bf16 a[236:239], a[240:243], v[60:63], a[236:239]
s_waitcnt lgkmcnt(7)
v_mfma_f32_16x16x32_bf16 v[24:27], a[0:3], a[192:195], v[88:91]
ds_read_b128 a[32:35], v1 offset:8192
v_exp_f32 v44, v44
s_waitcnt lgkmcnt(7)
v_mfma_f32_16x16x32_bf16 v[24:27], a[4:7], a[196:199], v[24:27]
ds_read_b128 a[36:39], v1 offset:9216
v_exp_f32 v45, v45
s_waitcnt lgkmcnt(7)
v_mfma_f32_16x16x32_bf16 v[24:27], a[8:11], a[200:203], v[24:27]
s_waitcnt lgkmcnt(6)
v_mfma_f32_16x16x32_bf16 v[24:27], a[12:15], a[204:207], v[24:27]
ds_read_b128 a[40:43], v1 offset:10240
v_exp_f32 v46, v46
v_mfma_f32_16x16x32_bf16 v[28:31], a[0:3], a[208:211], v[92:95]
ds_read_b128 a[44:47], v1 offset:11264
v_mfma_f32_16x16x32_bf16 v[28:31], a[4:7], a[212:215], v[28:31]
v_exp_f32 v47, v47
v_mfma_f32_16x16x32_bf16 v[28:31], a[8:11], a[216:219], v[28:31]
ds_read_b128 a[48:51], v1 offset:12288
v_cvt_pk_bf16_f32 v78, v44, v45
v_cvt_pk_bf16_f32 v79, v46, v47
v_mfma_f32_16x16x32_bf16 v[28:31], a[12:15], a[220:223], v[28:31]
ds_read_b128 a[52:55], v1 offset:13312
s_waitcnt lgkmcnt(9)
v_mfma_f32_16x16x32_bf16 v[40:43], a[16:19], a[192:195], v[88:91]
buffer_load_dwordx4 v3, s[88:91], s32 offen offset:3072 sc1 lds
s_waitcnt lgkmcnt(8)
v_mfma_f32_16x16x32_bf16 v[40:43], a[20:23], a[196:199], v[40:43]
v_exp_f32 v24, v24
s_waitcnt lgkmcnt(7)
v_mfma_f32_16x16x32_bf16 v[40:43], a[24:27], a[200:203], v[40:43]
ds_read_b128 a[56:59], v1 offset:14336
v_exp_f32 v25, v25
s_waitcnt lgkmcnt(7)
v_mfma_f32_16x16x32_bf16 v[40:43], a[28:31], a[204:207], v[40:43]
ds_read_b128 a[60:63], v1 offset:15360
v_mfma_f32_16x16x32_bf16 v[44:47], a[16:19], a[208:211], v[92:95]
v_exp_f32 v26, v26
v_mfma_f32_16x16x32_bf16 v[44:47], a[20:23], a[212:215], v[44:47]
v_exp_f32 v27, v27
v_mfma_f32_16x16x32_bf16 v[44:47], a[24:27], a[216:219], v[44:47]
v_mfma_f32_16x16x32_bf16 v[44:47], a[28:31], a[220:223], v[44:47]
v_cvt_pk_bf16_f32 v56, v24, v25
v_cvt_pk_bf16_f32 v57, v26, v27
s_waitcnt lgkmcnt(0)
v_mfma_f32_16x16x32_bf16 v[160:163], a[32:35], v[68:71], v[160:163]
ds_read_b128 a[0:3], v1 offset:16384
v_exp_f32 v28, v28
v_mfma_f32_16x16x32_bf16 v[192:195], a[32:35], v[72:75], v[192:195]
v_mfma_f32_16x16x32_bf16 v[224:227], a[32:35], v[76:79], v[224:227]
ds_read_b128 a[4:7], v1 offset:17408
v_exp_f32 v29, v29
v_mfma_f32_16x16x32_bf16 v[228:231], a[36:39], v[76:79], v[228:231]
v_mfma_f32_16x16x32_bf16 v[196:199], a[36:39], v[72:75], v[196:199]
s_add_u32 m0, s27, 0x1000
v_exp_f32 v30, v30
v_mfma_f32_16x16x32_bf16 v[164:167], a[36:39], v[68:71], v[164:167]
buffer_load_dwordx4 v3, s[88:91], s7 offen offset:0 sc1 lds
v_mfma_f32_16x16x32_bf16 v[168:171], a[40:43], v[68:71], v[168:171]
ds_read_b128 a[8:11], v1 offset:18432
v_mfma_f32_16x16x32_bf16 v[200:203], a[40:43], v[72:75], v[200:203]
v_exp_f32 v31, v31
v_mfma_f32_16x16x32_bf16 v[232:235], a[40:43], v[76:79], v[232:235]
ds_read_b128 a[12:15], v1 offset:19456
v_mfma_f32_16x16x32_bf16 v[236:239], a[44:47], v[76:79], v[236:239]
v_cvt_pk_bf16_f32 v60, v28, v29
v_cvt_pk_bf16_f32 v61, v30, v31
v_mfma_f32_16x16x32_bf16 v[204:207], a[44:47], v[72:75], v[204:207]
v_mfma_f32_16x16x32_bf16 v[172:175], a[44:47], v[68:71], v[172:175]
ds_read_b128 a[16:19], v1 offset:20480
v_exp_f32 v40, v40
v_mfma_f32_16x16x32_bf16 v[176:179], a[48:51], v[68:71], v[176:179]
v_mfma_f32_16x16x32_bf16 v[208:211], a[48:51], v[72:75], v[208:211]
v_exp_f32 v41, v41
v_mfma_f32_16x16x32_bf16 v[240:243], a[48:51], v[76:79], v[240:243]
ds_read_b128 a[20:23], v1 offset:21504
v_mfma_f32_16x16x32_bf16 v[244:247], a[52:55], v[76:79], v[244:247]
buffer_load_dwordx4 v3, s[88:91], s7 offen offset:1024 sc1 lds
v_mfma_f32_16x16x32_bf16 v[212:215], a[52:55], v[72:75], v[212:215]
v_exp_f32 v42, v42
v_mfma_f32_16x16x32_bf16 v[180:183], a[52:55], v[68:71], v[180:183]
ds_read_b128 a[24:27], v1 offset:22528
v_mfma_f32_16x16x32_bf16 v[184:187], a[56:59], v[68:71], v[184:187]
v_exp_f32 v43, v43
v_mfma_f32_16x16x32_bf16 v[216:219], a[56:59], v[72:75], v[216:219]
v_mfma_f32_16x16x32_bf16 v[248:251], a[56:59], v[76:79], v[248:251]
ds_read_b128 a[28:31], v1 offset:23552
v_cvt_pk_bf16_f32 v58, v40, v41
v_cvt_pk_bf16_f32 v59, v42, v43
v_mfma_f32_16x16x32_bf16 v[252:255], a[60:63], v[76:79], v[252:255]
v_mfma_f32_16x16x32_bf16 v[220:223], a[60:63], v[72:75], v[220:223]
v_exp_f32 v44, v44
v_mfma_f32_16x16x32_bf16 v[188:191], a[60:63], v[68:71], v[188:191]
v_mfma_f32_16x16x32_bf16 a[228:231], a[240:243], v[68:71], a[228:231]
v_exp_f32 v45, v45
v_mfma_f32_16x16x32_bf16 a[232:235], a[240:243], v[72:75], a[232:235]
buffer_load_dwordx4 v3, s[88:91], s7 offen offset:2048 sc1 lds
v_mfma_f32_16x16x32_bf16 a[236:239], a[240:243], v[76:79], a[236:239]
s_waitcnt lgkmcnt(7)
v_mfma_f32_16x16x32_bf16 v[24:27], a[0:3], a[192:195], v[88:91]
ds_read_b128 a[32:35], v1 offset:24576
v_exp_f32 v46, v46
s_waitcnt lgkmcnt(7)
v_mfma_f32_16x16x32_bf16 v[24:27], a[4:7], a[196:199], v[24:27]
ds_read_b128 a[36:39], v1 offset:25600
s_waitcnt lgkmcnt(7)
v_mfma_f32_16x16x32_bf16 v[24:27], a[8:11], a[200:203], v[24:27]
v_exp_f32 v47, v47
s_waitcnt lgkmcnt(6)
v_mfma_f32_16x16x32_bf16 v[24:27], a[12:15], a[204:207], v[24:27]
ds_read_b128 a[40:43], v1 offset:26624
v_mfma_f32_16x16x32_bf16 v[28:31], a[0:3], a[208:211], v[92:95]
ds_read_b128 a[44:47], v1 offset:27648
v_cvt_pk_bf16_f32 v62, v44, v45
v_cvt_pk_bf16_f32 v63, v46, v47
v_mfma_f32_16x16x32_bf16 v[28:31], a[4:7], a[212:215], v[28:31]
v_mfma_f32_16x16x32_bf16 v[28:31], a[8:11], a[216:219], v[28:31]
ds_read_b128 a[48:51], v1 offset:28672
v_mfma_f32_16x16x32_bf16 v[28:31], a[12:15], a[220:223], v[28:31]
ds_read_b128 a[52:55], v1 offset:29696
s_waitcnt lgkmcnt(9)
v_mfma_f32_16x16x32_bf16 v[40:43], a[16:19], a[192:195], v[88:91]
buffer_load_dwordx4 v3, s[88:91], s7 offen offset:3072 sc1 lds
s_waitcnt lgkmcnt(8)
v_mfma_f32_16x16x32_bf16 v[40:43], a[20:23], a[196:199], v[40:43]
v_exp_f32 v24, v24
s_waitcnt lgkmcnt(7)
v_mfma_f32_16x16x32_bf16 v[40:43], a[24:27], a[200:203], v[40:43]
ds_read_b128 a[56:59], v1 offset:30720
v_exp_f32 v25, v25
s_waitcnt lgkmcnt(7)
v_mfma_f32_16x16x32_bf16 v[40:43], a[28:31], a[204:207], v[40:43]
ds_read_b128 a[60:63], v1 offset:31744
v_exp_f32 v26, v26
v_mfma_f32_16x16x32_bf16 v[44:47], a[16:19], a[208:211], v[92:95]
v_mfma_f32_16x16x32_bf16 v[44:47], a[20:23], a[212:215], v[44:47]
v_exp_f32 v27, v27
v_mfma_f32_16x16x32_bf16 v[44:47], a[24:27], a[216:219], v[44:47]
v_mfma_f32_16x16x32_bf16 v[44:47], a[28:31], a[220:223], v[44:47]
v_cvt_pk_bf16_f32 v72, v24, v25
v_cvt_pk_bf16_f32 v73, v26, v27
s_add_u32 s32, s32, 0x8000
s_add_u32 s7, s7, 0x8000
s_xor_b32 s27, s27, 0x38000
v_xor_b32 v1, 0x8000, v1
s_nop 7
v_accvgpr_read_b32 v4, a224
v_accvgpr_read_b32 v6, a228
s_mov_b32 s8, 0x5f800000
v_cmp_nge_f32 s[36:37], s8, v4
v_cmp_nge_f32 s[38:39], s8, v6
v_rcp_f32 v4, v4
v_rcp_f32 v6, v6
s_or_b64 s[34:35], s[34:35], s[36:37]
s_or_b64 s[34:35], s[34:35], s[38:39]
v_pk_mul_f32 v[128:129], v[128:129], v[4:5] op_sel_hi:[1,0]
v_pk_mul_f32 v[130:131], v[130:131], v[4:5] op_sel_hi:[1,0]
v_pk_mul_f32 v[132:133], v[132:133], v[4:5] op_sel_hi:[1,0]
v_pk_mul_f32 v[134:135], v[134:135], v[4:5] op_sel_hi:[1,0]
v_cvt_pk_bf16_f32 v128, v128, v129
v_cvt_pk_bf16_f32 v129, v130, v131
v_cvt_pk_bf16_f32 v130, v132, v133
v_cvt_pk_bf16_f32 v131, v134, v135
s_add_u32 s8, s28, 0x0
buffer_store_dwordx4 v[128:131], v3, s[88:91], s8 offen sc1
v_pk_mul_f32 v[136:137], v[136:137], v[4:5] op_sel_hi:[1,0]
v_pk_mul_f32 v[138:139], v[138:139], v[4:5] op_sel_hi:[1,0]
v_pk_mul_f32 v[140:141], v[140:141], v[4:5] op_sel_hi:[1,0]
v_pk_mul_f32 v[142:143], v[142:143], v[4:5] op_sel_hi:[1,0]
v_cvt_pk_bf16_f32 v136, v136, v137
v_cvt_pk_bf16_f32 v137, v138, v139
v_cvt_pk_bf16_f32 v138, v140, v141
v_cvt_pk_bf16_f32 v139, v142, v143
s_add_u32 s8, s28, 0x2000
buffer_store_dwordx4 v[136:139], v3, s[88:91], s8 offen sc1
v_pk_mul_f32 v[144:145], v[144:145], v[4:5] op_sel_hi:[1,0]
v_pk_mul_f32 v[146:147], v[146:147], v[4:5] op_sel_hi:[1,0]
v_pk_mul_f32 v[148:149], v[148:149], v[4:5] op_sel_hi:[1,0]
v_pk_mul_f32 v[150:151], v[150:151], v[4:5] op_sel_hi:[1,0]
v_cvt_pk_bf16_f32 v144, v144, v145
v_cvt_pk_bf16_f32 v145, v146, v147
v_cvt_pk_bf16_f32 v146, v148, v149
v_cvt_pk_bf16_f32 v147, v150, v151
s_add_u32 s8, s28, 0x4000
buffer_store_dwordx4 v[144:147], v3, s[88:91], s8 offen sc1
v_pk_mul_f32 v[152:153], v[152:153], v[4:5] op_sel_hi:[1,0]
v_pk_mul_f32 v[154:155], v[154:155], v[4:5] op_sel_hi:[1,0]
v_pk_mul_f32 v[156:157], v[156:157], v[4:5] op_sel_hi:[1,0]
v_pk_mul_f32 v[158:159], v[158:159], v[4:5] op_sel_hi:[1,0]
v_cvt_pk_bf16_f32 v152, v152, v153
v_cvt_pk_bf16_f32 v153, v154, v155
v_cvt_pk_bf16_f32 v154, v156, v157
v_cvt_pk_bf16_f32 v155, v158, v159
s_add_u32 s8, s28, 0x6000
buffer_store_dwordx4 v[152:155], v3, s[88:91], s8 offen sc1
v_pk_mul_f32 v[160:161], v[160:161], v[6:7] op_sel_hi:[1,0]
v_pk_mul_f32 v[162:163], v[162:163], v[6:7] op_sel_hi:[1,0]
v_pk_mul_f32 v[164:165], v[164:165], v[6:7] op_sel_hi:[1,0]
v_pk_mul_f32 v[166:167], v[166:167], v[6:7] op_sel_hi:[1,0]
v_cvt_pk_bf16_f32 v160, v160, v161
v_cvt_pk_bf16_f32 v161, v162, v163
v_cvt_pk_bf16_f32 v162, v164, v165
v_cvt_pk_bf16_f32 v163, v166, v167
s_add_u32 s8, s29, 0x0
buffer_store_dwordx4 v[160:163], v3, s[88:91], s8 offen sc1
v_pk_mul_f32 v[168:169], v[168:169], v[6:7] op_sel_hi:[1,0]
v_pk_mul_f32 v[170:171], v[170:171], v[6:7] op_sel_hi:[1,0]
v_pk_mul_f32 v[172:173], v[172:173], v[6:7] op_sel_hi:[1,0]
v_pk_mul_f32 v[174:175], v[174:175], v[6:7] op_sel_hi:[1,0]
v_cvt_pk_bf16_f32 v168, v168, v169
v_cvt_pk_bf16_f32 v169, v170, v171
v_cvt_pk_bf16_f32 v170, v172, v173
v_cvt_pk_bf16_f32 v171, v174, v175
s_add_u32 s8, s29, 0x2000
buffer_store_dwordx4 v[168:171], v3, s[88:91], s8 offen sc1
v_pk_mul_f32 v[176:177], v[176:177], v[6:7] op_sel_hi:[1,0]
v_pk_mul_f32 v[178:179], v[178:179], v[6:7] op_sel_hi:[1,0]
v_pk_mul_f32 v[180:181], v[180:181], v[6:7] op_sel_hi:[1,0]
v_pk_mul_f32 v[182:183], v[182:183], v[6:7] op_sel_hi:[1,0]
v_cvt_pk_bf16_f32 v176, v176, v177
v_cvt_pk_bf16_f32 v177, v178, v179
v_cvt_pk_bf16_f32 v178, v180, v181
v_cvt_pk_bf16_f32 v179, v182, v183
s_add_u32 s8, s29, 0x4000
buffer_store_dwordx4 v[176:179], v3, s[88:91], s8 offen sc1
v_pk_mul_f32 v[184:185], v[184:185], v[6:7] op_sel_hi:[1,0]
v_pk_mul_f32 v[186:187], v[186:187], v[6:7] op_sel_hi:[1,0]
v_pk_mul_f32 v[188:189], v[188:189], v[6:7] op_sel_hi:[1,0]
v_pk_mul_f32 v[190:191], v[190:191], v[6:7] op_sel_hi:[1,0]
v_cvt_pk_bf16_f32 v184, v184, v185
v_cvt_pk_bf16_f32 v185, v186, v187
v_cvt_pk_bf16_f32 v186, v188, v189
v_cvt_pk_bf16_f32 v187, v190, v191
s_add_u32 s8, s29, 0x6000
buffer_store_dwordx4 v[184:187], v3, s[88:91], s8 offen sc1
s_branch L_att_sodd
L_att_lh0_0:
s_waitcnt vmcnt(16) lgkmcnt(0)
s_barrier
s_and_b32 s8, s2, 7
s_lshr_b32 s9, s2, 3
s_lshr_b32 s99, s8, 1
s_lshl_b32 s99, s99, 2
s_lshr_b32 s10, s9, 3
s_add_u32 s99, s99, s10
s_and_b32 s100, s8, 1
s_lshl_b32 s100, s100, 3
s_and_b32 s10, s9, 7
s_add_u32 s100, s100, s10
s_sub_u32 s10, 15, s99
s_min_u32 s10, s10, s99
s_lshl_b32 s11, s10, 7
s_add_u32 s11, s11, 0x3604000
s_lshl_b32 s10, s10, 2
s_add_u32 s10, s10, 128
buffer_load_dword v13, off, s[84:87], s10 sc1
s_mov_b32 s12, 15360
s_mov_b32 s13, 30720
s_mov_b32 s14, 46080
v_lshrrev_b32 v14, 4, v0
v_bfe_u32 v15, v0, 1, 2
v_xor_b32 v14, v14, v15
v_lshlrev_b32 v14, 5, v14
v_and_b32 v15, 1, v0
v_lshl_add_u32 v14, v15, 4, v14
v_lshrrev_b32 v15, 3, v0
v_lshl_add_u32 v14, v15, 11, v14
s_lshl_b32 s8, s4, 16
s_lshl_b32 s9, s100, 7
s_add_u32 s8, s8, s9
v_add_u32 v12, s8, v14
s_mul_i32 s101, s99, 0x140000
s_lshl_b32 s8, s4, 11
s_add_u32 s101, s101, s8
s_add_u32 s101, s101, 0x21fe000
v_mfma_f32_16x16x32_bf16 v[160:163], a[32:35], v[52:55], v[160:163]
ds_read_b128 a[0:3], v1 offset:0
v_exp_f32 v28, v28
v_mfma_f32_16x16x32_bf16 v[192:195], a[32:35], v[56:59], v[192:195]
v_mfma_f32_16x16x32_bf16 v[224:227], a[32:35], v[60:63], v[224:227]
ds_read_b128 a[4:7], v1 offset:1024
v_exp_f32 v29, v29
v_mfma_f32_16x16x32_bf16 v[228:231], a[36:39], v[60:63], v[228:231]
v_mfma_f32_16x16x32_bf16 v[196:199], a[36:39], v[56:59], v[196:199]
s_add_u32 m0, s17, 0x10000
v_exp_f32 v30, v30
v_mfma_f32_16x16x32_bf16 v[164:167], a[36:39], v[52:55], v[164:167]
buffer_load_dwordx4 v12, s[72:75], 0 offen lds
v_mfma_f32_16x16x32_bf16 v[168:171], a[40:43], v[52:55], v[168:171]
ds_read_b128 a[8:11], v1 offset:2048
v_exp_f32 v31, v31
v_mfma_f32_16x16x32_bf16 v[200:203], a[40:43], v[56:59], v[200:203]
v_mfma_f32_16x16x32_bf16 v[232:235], a[40:43], v[60:63], v[232:235]
ds_read_b128 a[12:15], v1 offset:3072
v_cvt_pk_bf16_f32 v76, v28, v29
v_cvt_pk_bf16_f32 v77, v30, v31
v_mfma_f32_16x16x32_bf16 v[236:239], a[44:47], v[60:63], v[236:239]
v_exp_f32 v36, v36
v_mfma_f32_16x16x32_bf16 v[204:207], a[44:47], v[56:59], v[204:207]
v_mfma_f32_16x16x32_bf16 v[172:175], a[44:47], v[52:55], v[172:175]
ds_read_b128 a[16:19], v1 offset:4096
v_exp_f32 v37, v37
v_mfma_f32_16x16x32_bf16 v[176:179], a[48:51], v[52:55], v[176:179]
v_exp_f32 v38, v38
v_mfma_f32_16x16x32_bf16 v[208:211], a[48:51], v[56:59], v[208:211]
v_mfma_f32_16x16x32_bf16 v[240:243], a[48:51], v[60:63], v[240:243]
ds_read_b128 a[20:23], v1 offset:5120
v_exp_f32 v39, v39
v_mfma_f32_16x16x32_bf16 v[244:247], a[52:55], v[60:63], v[244:247]
buffer_load_dwordx4 v12, s[72:75], s12 offen offset:1024 lds
v_mfma_f32_16x16x32_bf16 v[212:215], a[52:55], v[56:59], v[212:215]
v_mfma_f32_16x16x32_bf16 v[180:183], a[52:55], v[52:55], v[180:183]
ds_read_b128 a[24:27], v1 offset:6144
v_cvt_pk_bf16_f32 v70, v36, v37
v_cvt_pk_bf16_f32 v71, v38, v39
v_mfma_f32_16x16x32_bf16 v[184:187], a[56:59], v[52:55], v[184:187]
v_exp_f32 v40, v40
v_mfma_f32_16x16x32_bf16 v[216:219], a[56:59], v[56:59], v[216:219]
v_mfma_f32_16x16x32_bf16 v[248:251], a[56:59], v[60:63], v[248:251]
ds_read_b128 a[28:31], v1 offset:7168
v_exp_f32 v41, v41
v_mfma_f32_16x16x32_bf16 v[252:255], a[60:63], v[60:63], v[252:255]
v_exp_f32 v42, v42
v_mfma_f32_16x16x32_bf16 v[220:223], a[60:63], v[56:59], v[220:223]
v_mfma_f32_16x16x32_bf16 v[188:191], a[60:63], v[52:55], v[188:191]
v_exp_f32 v43, v43
v_mfma_f32_16x16x32_bf16 a[228:231], a[240:243], v[52:55], a[228:231]
v_cvt_pk_bf16_f32 v74, v40, v41
v_cvt_pk_bf16_f32 v75, v42, v43
v_mfma_f32_16x16x32_bf16 a[232:235], a[240:243], v[56:59], a[232:235]
buffer_load_dwordx4 v12, s[72:75], s13 offen offset:2048 lds
v_mfma_f32_16x16x32_bf16 a[236:239], a[240:243], v[60:63], a[236:239]
s_waitcnt lgkmcnt(7)
v_mfma_f32_16x16x32_bf16 v[24:27], a[0:3], a[192:195], v[112:115]
ds_read_b128 a[32:35], v1 offset:8192
v_exp_f32 v44, v44
s_waitcnt lgkmcnt(7)
v_mfma_f32_16x16x32_bf16 v[24:27], a[4:7], a[196:199], v[24:27]
ds_read_b128 a[36:39], v1 offset:9216
v_exp_f32 v45, v45
s_waitcnt lgkmcnt(7)
v_mfma_f32_16x16x32_bf16 v[24:27], a[8:11], a[200:203], v[24:27]
s_waitcnt lgkmcnt(6)
v_mfma_f32_16x16x32_bf16 v[24:27], a[12:15], a[204:207], v[24:27]
ds_read_b128 a[40:43], v1 offset:10240
v_exp_f32 v46, v46
v_mfma_f32_16x16x32_bf16 v[28:31], a[0:3], a[208:211], v[92:95]
ds_read_b128 a[44:47], v1 offset:11264
v_mfma_f32_16x16x32_bf16 v[28:31], a[4:7], a[212:215], v[28:31]
v_exp_f32 v47, v47
v_mfma_f32_16x16x32_bf16 v[28:31], a[8:11], a[216:219], v[28:31]
ds_read_b128 a[48:51], v1 offset:12288
v_cvt_pk_bf16_f32 v78, v44, v45
v_cvt_pk_bf16_f32 v79, v46, v47
v_mfma_f32_16x16x32_bf16 v[28:31], a[12:15], a[220:223], v[28:31]
ds_read_b128 a[52:55], v1 offset:13312
s_waitcnt lgkmcnt(9)
v_mfma_f32_16x16x32_bf16 v[40:43], a[16:19], a[192:195], v[116:119]
buffer_load_dwordx4 v12, s[72:75], s14 offen offset:3072 lds
s_waitcnt lgkmcnt(8)
v_mfma_f32_16x16x32_bf16 v[40:43], a[20:23], a[196:199], v[40:43]
v_exp_f32 v24, v24
s_waitcnt lgkmcnt(7)
v_mfma_f32_16x16x32_bf16 v[40:43], a[24:27], a[200:203], v[40:43]
ds_read_b128 a[56:59], v1 offset:14336
v_exp_f32 v25, v25
s_waitcnt lgkmcnt(7)
v_mfma_f32_16x16x32_bf16 v[40:43], a[28:31], a[204:207], v[40:43]
ds_read_b128 a[60:63], v1 offset:15360
v_mfma_f32_16x16x32_bf16 v[44:47], a[16:19], a[208:211], v[92:95]
v_exp_f32 v26, v26
v_mfma_f32_16x16x32_bf16 v[44:47], a[20:23], a[212:215], v[44:47]
v_exp_f32 v27, v27
v_mfma_f32_16x16x32_bf16 v[44:47], a[24:27], a[216:219], v[44:47]
v_mfma_f32_16x16x32_bf16 v[44:47], a[28:31], a[220:223], v[44:47]
v_cvt_pk_bf16_f32 v56, v24, v25
v_cvt_pk_bf16_f32 v57, v26, v27
s_waitcnt lgkmcnt(0)
v_mfma_f32_16x16x32_bf16 v[160:163], a[32:35], v[68:71], v[160:163]
ds_read_b128 a[0:3], v1 offset:16384
v_exp_f32 v28, v28
v_mfma_f32_16x16x32_bf16 v[192:195], a[32:35], v[72:75], v[192:195]
v_mfma_f32_16x16x32_bf16 v[224:227], a[32:35], v[76:79], v[224:227]
ds_read_b128 a[4:7], v1 offset:17408
v_mfma_f32_16x16x32_bf16 v[228:231], a[36:39], v[76:79], v[228:231]
s_add_u32 m0, s17, 0x14000
v_add_u32 v12, 0x40000, v12
v_exp_f32 v29, v29
v_mfma_f32_16x16x32_bf16 v[196:199], a[36:39], v[72:75], v[196:199]
buffer_load_dwordx4 v12, s[72:75], 0 offen lds
v_mfma_f32_16x16x32_bf16 v[164:167], a[36:39], v[68:71], v[164:167]
v_mfma_f32_16x16x32_bf16 v[168:171], a[40:43], v[68:71], v[168:171]
ds_read_b128 a[8:11], v1 offset:18432
v_exp_f32 v30, v30
v_mfma_f32_16x16x32_bf16 v[200:203], a[40:43], v[72:75], v[200:203]
v_mfma_f32_16x16x32_bf16 v[232:235], a[40:43], v[76:79], v[232:235]
ds_read_b128 a[12:15], v1 offset:19456
v_exp_f32 v31, v31
v_mfma_f32_16x16x32_bf16 v[236:239], a[44:47], v[76:79], v[236:239]
v_mfma_f32_16x16x32_bf16 v[204:207], a[44:47], v[72:75], v[204:207]
v_cvt_pk_bf16_f32 v60, v28, v29
v_cvt_pk_bf16_f32 v61, v30, v31
v_mfma_f32_16x16x32_bf16 v[172:175], a[44:47], v[68:71], v[172:175]
ds_read_b128 a[16:19], v1 offset:20480
v_mfma_f32_16x16x32_bf16 v[176:179], a[48:51], v[68:71], v[176:179]
buffer_load_dwordx4 v12, s[72:75], s12 offen offset:1024 lds
v_mfma_f32_16x16x32_bf16 v[208:211], a[48:51], v[72:75], v[208:211]
v_exp_f32 v40, v40
v_mfma_f32_16x16x32_bf16 v[240:243], a[48:51], v[76:79], v[240:243]
ds_read_b128 a[20:23], v1 offset:21504
v_mfma_f32_16x16x32_bf16 v[244:247], a[52:55], v[76:79], v[244:247]
v_exp_f32 v41, v41
v_mfma_f32_16x16x32_bf16 v[212:215], a[52:55], v[72:75], v[212:215]
v_mfma_f32_16x16x32_bf16 v[180:183], a[52:55], v[68:71], v[180:183]
ds_read_b128 a[24:27], v1 offset:22528
v_exp_f32 v42, v42
v_mfma_f32_16x16x32_bf16 v[184:187], a[56:59], v[68:71], v[184:187]
v_mfma_f32_16x16x32_bf16 v[216:219], a[56:59], v[72:75], v[216:219]
ds_read_b128 a[28:31], v1 offset:23552
v_exp_f32 v43, v43
v_mfma_f32_16x16x32_bf16 v[248:251], a[56:59], v[76:79], v[248:251]
buffer_load_dwordx4 v12, s[72:75], s13 offen offset:2048 lds
v_mfma_f32_16x16x32_bf16 v[252:255], a[60:63], v[76:79], v[252:255]
v_mfma_f32_16x16x32_bf16 v[220:223], a[60:63], v[72:75], v[220:223]
v_cvt_pk_bf16_f32 v58, v40, v41
v_cvt_pk_bf16_f32 v59, v42, v43
v_mfma_f32_16x16x32_bf16 v[188:191], a[60:63], v[68:71], v[188:191]
v_mfma_f32_16x16x32_bf16 a[228:231], a[240:243], v[68:71], a[228:231]
v_exp_f32 v44, v44
v_mfma_f32_16x16x32_bf16 a[232:235], a[240:243], v[72:75], a[232:235]
v_mfma_f32_16x16x32_bf16 a[236:239], a[240:243], v[76:79], a[236:239]
v_exp_f32 v45, v45
s_waitcnt lgkmcnt(7)
v_mfma_f32_16x16x32_bf16 v[28:31], a[0:3], a[208:211], v[92:95]
v_exp_f32 v46, v46
s_waitcnt lgkmcnt(6)
v_mfma_f32_16x16x32_bf16 v[28:31], a[4:7], a[212:215], v[28:31]
buffer_load_dwordx4 v12, s[72:75], s14 offen offset:3072 lds
s_waitcnt lgkmcnt(5)
v_mfma_f32_16x16x32_bf16 v[28:31], a[8:11], a[216:219], v[28:31]
v_exp_f32 v47, v47
s_waitcnt lgkmcnt(4)
v_mfma_f32_16x16x32_bf16 v[28:31], a[12:15], a[220:223], v[28:31]
v_cvt_pk_bf16_f32 v62, v44, v45
v_cvt_pk_bf16_f32 v63, v46, v47
s_waitcnt lgkmcnt(3)
v_mfma_f32_16x16x32_bf16 v[44:47], a[16:19], a[208:211], v[92:95]
s_waitcnt lgkmcnt(2)
v_mfma_f32_16x16x32_bf16 v[44:47], a[20:23], a[212:215], v[44:47]
s_waitcnt lgkmcnt(1)
v_mfma_f32_16x16x32_bf16 v[44:47], a[24:27], a[216:219], v[44:47]
s_waitcnt lgkmcnt(0)
v_mfma_f32_16x16x32_bf16 v[44:47], a[28:31], a[220:223], v[44:47]
ds_read_b128 a[32:35], v1 offset:24576
ds_read_b128 a[36:39], v1 offset:25600
ds_read_b128 a[40:43], v1 offset:26624
ds_read_b128 a[44:47], v1 offset:27648
ds_read_b128 a[48:51], v1 offset:28672
ds_read_b128 a[52:55], v1 offset:29696
ds_read_b128 a[56:59], v1 offset:30720
ds_read_b128 a[60:63], v1 offset:31744
v_xor_b32 v1, 0x8000, v1
s_nop 7
v_accvgpr_read_b32 v4, a224
v_accvgpr_read_b32 v6, a228
s_mov_b32 s8, 0x5f800000
v_cmp_nge_f32 s[36:37], s8, v4
v_cmp_nge_f32 s[38:39], s8, v6
v_rcp_f32 v4, v4
v_rcp_f32 v6, v6
s_or_b64 s[34:35], s[34:35], s[36:37]
s_or_b64 s[34:35], s[34:35], s[38:39]
v_pk_mul_f32 v[128:129], v[128:129], v[4:5] op_sel_hi:[1,0]
v_pk_mul_f32 v[130:131], v[130:131], v[4:5] op_sel_hi:[1,0]
v_pk_mul_f32 v[132:133], v[132:133], v[4:5] op_sel_hi:[1,0]
v_pk_mul_f32 v[134:135], v[134:135], v[4:5] op_sel_hi:[1,0]
v_cvt_pk_bf16_f32 v128, v128, v129
v_cvt_pk_bf16_f32 v129, v130, v131
v_cvt_pk_bf16_f32 v130, v132, v133
v_cvt_pk_bf16_f32 v131, v134, v135
s_add_u32 s8, s28, 0x0
buffer_store_dwordx4 v[128:131], v3, s[88:91], s8 offen sc1
v_pk_mul_f32 v[136:137], v[136:137], v[4:5] op_sel_hi:[1,0]
v_pk_mul_f32 v[138:139], v[138:139], v[4:5] op_sel_hi:[1,0]
v_pk_mul_f32 v[140:141], v[140:141], v[4:5] op_sel_hi:[1,0]
v_pk_mul_f32 v[142:143], v[142:143], v[4:5] op_sel_hi:[1,0]
v_cvt_pk_bf16_f32 v136, v136, v137
v_cvt_pk_bf16_f32 v137, v138, v139
v_cvt_pk_bf16_f32 v138, v140, v141
v_cvt_pk_bf16_f32 v139, v142, v143
s_add_u32 s8, s28, 0x2000
buffer_store_dwordx4 v[136:139], v3, s[88:91], s8 offen sc1
v_pk_mul_f32 v[144:145], v[144:145], v[4:5] op_sel_hi:[1,0]
v_pk_mul_f32 v[146:147], v[146:147], v[4:5] op_sel_hi:[1,0]
v_pk_mul_f32 v[148:149], v[148:149], v[4:5] op_sel_hi:[1,0]
v_pk_mul_f32 v[150:151], v[150:151], v[4:5] op_sel_hi:[1,0]
v_cvt_pk_bf16_f32 v144, v144, v145
v_cvt_pk_bf16_f32 v145, v146, v147
v_cvt_pk_bf16_f32 v146, v148, v149
v_cvt_pk_bf16_f32 v147, v150, v151
s_add_u32 s8, s28, 0x4000
buffer_store_dwordx4 v[144:147], v3, s[88:91], s8 offen sc1
v_pk_mul_f32 v[152:153], v[152:153], v[4:5] op_sel_hi:[1,0]
v_pk_mul_f32 v[154:155], v[154:155], v[4:5] op_sel_hi:[1,0]
v_pk_mul_f32 v[156:157], v[156:157], v[4:5] op_sel_hi:[1,0]
v_pk_mul_f32 v[158:159], v[158:159], v[4:5] op_sel_hi:[1,0]
v_cvt_pk_bf16_f32 v152, v152, v153
v_cvt_pk_bf16_f32 v153, v154, v155
v_cvt_pk_bf16_f32 v154, v156, v157
v_cvt_pk_bf16_f32 v155, v158, v159
s_add_u32 s8, s28, 0x6000
buffer_store_dwordx4 v[152:155], v3, s[88:91], s8 offen sc1
v_pk_mul_f32 v[160:161], v[160:161], v[6:7] op_sel_hi:[1,0]
v_pk_mul_f32 v[162:163], v[162:163], v[6:7] op_sel_hi:[1,0]
v_pk_mul_f32 v[164:165], v[164:165], v[6:7] op_sel_hi:[1,0]
v_pk_mul_f32 v[166:167], v[166:167], v[6:7] op_sel_hi:[1,0]
v_cvt_pk_bf16_f32 v160, v160, v161
v_cvt_pk_bf16_f32 v161, v162, v163
v_cvt_pk_bf16_f32 v162, v164, v165
v_cvt_pk_bf16_f32 v163, v166, v167
s_add_u32 s8, s29, 0x0
buffer_store_dwordx4 v[160:163], v3, s[88:91], s8 offen sc1
v_pk_mul_f32 v[168:169], v[168:169], v[6:7] op_sel_hi:[1,0]
v_pk_mul_f32 v[170:171], v[170:171], v[6:7] op_sel_hi:[1,0]
v_pk_mul_f32 v[172:173], v[172:173], v[6:7] op_sel_hi:[1,0]
v_pk_mul_f32 v[174:175], v[174:175], v[6:7] op_sel_hi:[1,0]
v_cvt_pk_bf16_f32 v168, v168, v169
v_cvt_pk_bf16_f32 v169, v170, v171
v_cvt_pk_bf16_f32 v170, v172, v173
v_cvt_pk_bf16_f32 v171, v174, v175
s_add_u32 s8, s29, 0x2000
buffer_store_dwordx4 v[168:171], v3, s[88:91], s8 offen sc1
v_pk_mul_f32 v[176:177], v[176:177], v[6:7] op_sel_hi:[1,0]
v_pk_mul_f32 v[178:179], v[178:179], v[6:7] op_sel_hi:[1,0]
v_pk_mul_f32 v[180:181], v[180:181], v[6:7] op_sel_hi:[1,0]
v_pk_mul_f32 v[182:183], v[182:183], v[6:7] op_sel_hi:[1,0]
v_cvt_pk_bf16_f32 v176, v176, v177
v_cvt_pk_bf16_f32 v177, v178, v179
v_cvt_pk_bf16_f32 v178, v180, v181
v_cvt_pk_bf16_f32 v179, v182, v183
s_add_u32 s8, s29, 0x4000
buffer_store_dwordx4 v[176:179], v3, s[88:91], s8 offen sc1
v_pk_mul_f32 v[184:185], v[184:185], v[6:7] op_sel_hi:[1,0]
v_pk_mul_f32 v[186:187], v[186:187], v[6:7] op_sel_hi:[1,0]
v_pk_mul_f32 v[188:189], v[188:189], v[6:7] op_sel_hi:[1,0]
v_pk_mul_f32 v[190:191], v[190:191], v[6:7] op_sel_hi:[1,0]
v_cvt_pk_bf16_f32 v184, v184, v185
v_cvt_pk_bf16_f32 v185, v186, v187
v_cvt_pk_bf16_f32 v186, v188, v189
v_cvt_pk_bf16_f32 v187, v190, v191
s_add_u32 s8, s29, 0x6000
buffer_store_dwordx4 v[184:187], v3, s[88:91], s8 offen sc1
s_branch L_att_h1_0
L_att_dl0_1:
s_waitcnt vmcnt(16) lgkmcnt(0)
s_barrier
v_mfma_f32_16x16x32_bf16 v[128:131], a[32:35], v[48:51], v[128:131]
ds_read_b128 a[0:3], v1 offset:0
v_exp_f32 v28, v28
v_mfma_f32_16x16x32_bf16 v[160:163], a[32:35], v[52:55], v[160:163]
v_mfma_f32_16x16x32_bf16 v[192:195], a[32:35], v[56:59], v[192:195]
v_exp_f32 v29, v29
v_mfma_f32_16x16x32_bf16 v[224:227], a[32:35], v[60:63], v[224:227]
ds_read_b128 a[4:7], v1 offset:1024
v_mfma_f32_16x16x32_bf16 v[228:231], a[36:39], v[60:63], v[228:231]
v_exp_f32 v30, v30
v_mfma_f32_16x16x32_bf16 v[196:199], a[36:39], v[56:59], v[196:199]
v_exp_f32 v31, v31
v_mfma_f32_16x16x32_bf16 v[164:167], a[36:39], v[52:55], v[164:167]
v_mfma_f32_16x16x32_bf16 v[132:135], a[36:39], v[48:51], v[132:135]
s_add_u32 m0, s27, 0x0
ds_read_b128 a[8:11], v1 offset:2048
v_cvt_pk_bf16_f32 v76, v28, v29
v_cvt_pk_bf16_f32 v77, v30, v31
v_mfma_f32_16x16x32_bf16 v[136:139], a[40:43], v[48:51], v[136:139]
buffer_load_dwordx4 v3, s[88:91], s32 offen offset:0 sc1 lds
v_mfma_f32_16x16x32_bf16 v[168:171], a[40:43], v[52:55], v[168:171]
v_exp_f32 v32, v32
v_mfma_f32_16x16x32_bf16 v[200:203], a[40:43], v[56:59], v[200:203]
v_mfma_f32_16x16x32_bf16 v[232:235], a[40:43], v[60:63], v[232:235]
v_exp_f32 v33, v33
v_mfma_f32_16x16x32_bf16 v[236:239], a[44:47], v[60:63], v[236:239]
ds_read_b128 a[12:15], v1 offset:3072
v_mfma_f32_16x16x32_bf16 v[204:207], a[44:47], v[56:59], v[204:207]
v_exp_f32 v34, v34
v_mfma_f32_16x16x32_bf16 v[172:175], a[44:47], v[52:55], v[172:175]
v_exp_f32 v35, v35
v_mfma_f32_16x16x32_bf16 v[140:143], a[44:47], v[48:51], v[140:143]
v_mfma_f32_16x16x32_bf16 v[144:147], a[48:51], v[48:51], v[144:147]
ds_read_b128 a[16:19], v1 offset:4096
v_cvt_pk_bf16_f32 v66, v32, v33
v_cvt_pk_bf16_f32 v67, v34, v35
v_mfma_f32_16x16x32_bf16 v[176:179], a[48:51], v[52:55], v[176:179]
v_exp_f32 v36, v36
v_mfma_f32_16x16x32_bf16 v[208:211], a[48:51], v[56:59], v[208:211]
v_mfma_f32_16x16x32_bf16 v[240:243], a[48:51], v[60:63], v[240:243]
ds_read_b128 a[20:23], v1 offset:5120
v_exp_f32 v37, v37
v_mfma_f32_16x16x32_bf16 v[244:247], a[52:55], v[60:63], v[244:247]
v_mfma_f32_16x16x32_bf16 v[212:215], a[52:55], v[56:59], v[212:215]
v_exp_f32 v38, v38
v_mfma_f32_16x16x32_bf16 v[180:183], a[52:55], v[52:55], v[180:183]
v_exp_f32 v39, v39
v_mfma_f32_16x16x32_bf16 v[148:151], a[52:55], v[48:51], v[148:151]
ds_read_b128 a[24:27], v1 offset:6144
v_mfma_f32_16x16x32_bf16 v[152:155], a[56:59], v[48:51], v[152:155]
v_cvt_pk_bf16_f32 v70, v36, v37
v_cvt_pk_bf16_f32 v71, v38, v39
v_mfma_f32_16x16x32_bf16 v[184:187], a[56:59], v[52:55], v[184:187]
buffer_load_dwordx4 v3, s[88:91], s32 offen offset:1024 sc1 lds
v_mfma_f32_16x16x32_bf16 v[216:219], a[56:59], v[56:59], v[216:219]
v_exp_f32 v40, v40
v_mfma_f32_16x16x32_bf16 v[248:251], a[56:59], v[60:63], v[248:251]
v_mfma_f32_16x16x32_bf16 v[252:255], a[60:63], v[60:63], v[252:255]
ds_read_b128 a[28:31], v1 offset:7168
v_exp_f32 v41, v41
v_mfma_f32_16x16x32_bf16 v[220:223], a[60:63], v[56:59], v[220:223]
v_mfma_f32_16x16x32_bf16 v[188:191], a[60:63], v[52:55], v[188:191]
v_exp_f32 v42, v42
v_mfma_f32_16x16x32_bf16 v[156:159], a[60:63], v[48:51], v[156:159]
v_exp_f32 v43, v43
v_mfma_f32_16x16x32_bf16 a[224:227], a[240:243], v[48:51], a[224:227]
v_mfma_f32_16x16x32_bf16 a[228:231], a[240:243], v[52:55], a[228:231]
v_cvt_pk_bf16_f32 v74, v40, v41
v_cvt_pk_bf16_f32 v75, v42, v43
v_mfma_f32_16x16x32_bf16 a[232:235], a[240:243], v[56:59], a[232:235]
v_exp_f32 v44, v44
v_mfma_f32_16x16x32_bf16 a[236:239], a[240:243], v[60:63], a[236:239]
s_waitcnt lgkmcnt(7)
v_mfma_f32_16x16x32_bf16 v[16:19], a[0:3], a[160:163], v[80:83]
ds_read_b128 a[32:35], v1 offset:8192
v_exp_f32 v45, v45
s_waitcnt lgkmcnt(7)
v_mfma_f32_16x16x32_bf16 v[16:19], a[4:7], a[164:167], v[16:19]
s_waitcnt lgkmcnt(6)
v_mfma_f32_16x16x32_bf16 v[16:19], a[8:11], a[168:171], v[16:19]
v_exp_f32 v46, v46
s_waitcnt lgkmcnt(5)
v_mfma_f32_16x16x32_bf16 v[16:19], a[12:15], a[172:175], v[16:19]
ds_read_b128 a[36:39], v1 offset:9216
v_exp_f32 v47, v47
v_mfma_f32_16x16x32_bf16 v[20:23], a[0:3], a[176:179], v[84:87]
v_mfma_f32_16x16x32_bf16 v[20:23], a[4:7], a[180:183], v[20:23]
v_cvt_pk_bf16_f32 v78, v44, v45
v_cvt_pk_bf16_f32 v79, v46, v47
v_mfma_f32_16x16x32_bf16 v[20:23], a[8:11], a[184:187], v[20:23]
buffer_load_dwordx4 v3, s[88:91], s32 offen offset:2048 sc1 lds
v_mfma_f32_16x16x32_bf16 v[20:23], a[12:15], a[188:191], v[20:23]
ds_read_b128 a[40:43], v1 offset:10240
v_mfma_f32_16x16x32_bf16 v[24:27], a[0:3], a[192:195], v[88:91]
v_exp_f32 v16, v16
v_mfma_f32_16x16x32_bf16 v[24:27], a[4:7], a[196:199], v[24:27]
v_exp_f32 v17, v17
v_mfma_f32_16x16x32_bf16 v[24:27], a[8:11], a[200:203], v[24:27]
v_mfma_f32_16x16x32_bf16 v[24:27], a[12:15], a[204:207], v[24:27]
ds_read_b128 a[44:47], v1 offset:11264
v_exp_f32 v18, v18
v_mfma_f32_16x16x32_bf16 v[28:31], a[0:3], a[208:211], v[92:95]
v_exp_f32 v19, v19
v_mfma_f32_16x16x32_bf16 v[28:31], a[4:7], a[212:215], v[28:31]
v_mfma_f32_16x16x32_bf16 v[28:31], a[8:11], a[216:219], v[28:31]
ds_read_b128 a[48:51], v1 offset:12288
v_cvt_pk_bf16_f32 v48, v16, v17
v_cvt_pk_bf16_f32 v49, v18, v19
v_mfma_f32_16x16x32_bf16 v[28:31], a[12:15], a[220:223], v[28:31]
v_exp_f32 v20, v20
s_waitcnt lgkmcnt(8)
v_mfma_f32_16x16x32_bf16 v[32:35], a[16:19], a[160:163], v[80:83]
s_waitcnt lgkmcnt(7)
v_mfma_f32_16x16x32_bf16 v[32:35], a[20:23], a[164:167], v[32:35]
ds_read_b128 a[52:55], v1 offset:13312
v_exp_f32 v21, v21
s_waitcnt lgkmcnt(7)
v_mfma_f32_16x16x32_bf16 v[32:35], a[24:27], a[168:171], v[32:35]
s_waitcnt lgkmcnt(6)
v_mfma_f32_16x16x32_bf16 v[32:35], a[28:31], a[172:175], v[32:35]
v_exp_f32 v22, v22
v_mfma_f32_16x16x32_bf16 v[36:39], a[16:19], a[176:179], v[84:87]
v_exp_f32 v23, v23
v_mfma_f32_16x16x32_bf16 v[36:39], a[20:23], a[180:183], v[36:39]
ds_read_b128 a[56:59], v1 offset:14336
v_mfma_f32_16x16x32_bf16 v[36:39], a[24:27], a[184:187], v[36:39]
v_cvt_pk_bf16_f32 v52, v20, v21
v_cvt_pk_bf16_f32 v53, v22, v23
v_mfma_f32_16x16x32_bf16 v[36:39], a[28:31], a[188:191], v[36:39]
buffer_load_dwordx4 v3, s[88:91], s32 offen offset:3072 sc1 lds
v_mfma_f32_16x16x32_bf16 v[40:43], a[16:19], a[192:195], v[88:91]
v_exp_f32 v24, v24
v_mfma_f32_16x16x32_bf16 v[40:43], a[20:23], a[196:199], v[40:43]
ds_read_b128 a[60:63], v1 offset:15360
v_mfma_f32_16x16x32_bf16 v[40:43], a[24:27], a[200:203], v[40:43]
v_exp_f32 v25, v25
v_mfma_f32_16x16x32_bf16 v[40:43], a[28:31], a[204:207], v[40:43]
v_mfma_f32_16x16x32_bf16 v[44:47], a[16:19], a[208:211], v[92:95]
v_exp_f32 v26, v26
v_mfma_f32_16x16x32_bf16 v[44:47], a[20:23], a[212:215], v[44:47]
v_exp_f32 v27, v27
v_mfma_f32_16x16x32_bf16 v[44:47], a[24:27], a[216:219], v[44:47]
v_mfma_f32_16x16x32_bf16 v[44:47], a[28:31], a[220:223], v[44:47]
v_cvt_pk_bf16_f32 v56, v24, v25
v_cvt_pk_bf16_f32 v57, v26, v27
s_waitcnt lgkmcnt(0)
v_mfma_f32_16x16x32_bf16 v[128:131], a[32:35], v[64:67], v[128:131]
ds_read_b128 a[0:3], v1 offset:16384
v_exp_f32 v28, v28
v_mfma_f32_16x16x32_bf16 v[160:163], a[32:35], v[68:71], v[160:163]
v_mfma_f32_16x16x32_bf16 v[192:195], a[32:35], v[72:75], v[192:195]
v_exp_f32 v29, v29
v_mfma_f32_16x16x32_bf16 v[224:227], a[32:35], v[76:79], v[224:227]
ds_read_b128 a[4:7], v1 offset:17408
v_mfma_f32_16x16x32_bf16 v[228:231], a[36:39], v[76:79], v[228:231]
v_exp_f32 v30, v30
v_mfma_f32_16x16x32_bf16 v[196:199], a[36:39], v[72:75], v[196:199]
v_exp_f32 v31, v31
v_mfma_f32_16x16x32_bf16 v[164:167], a[36:39], v[68:71], v[164:167]
v_mfma_f32_16x16x32_bf16 v[132:135], a[36:39], v[64:67], v[132:135]
s_add_u32 m0, s27, 0x1000
ds_read_b128 a[8:11], v1 offset:18432
v_cvt_pk_bf16_f32 v60, v28, v29
v_cvt_pk_bf16_f32 v61, v30, v31
v_mfma_f32_16x16x32_bf16 v[136:139], a[40:43], v[64:67], v[136:139]
buffer_load_dwordx4 v3, s[88:91], s7 offen offset:0 sc1 lds
v_mfma_f32_16x16x32_bf16 v[168:171], a[40:43], v[68:71], v[168:171]
v_exp_f32 v32, v32
v_mfma_f32_16x16x32_bf16 v[200:203], a[40:43], v[72:75], v[200:203]
v_mfma_f32_16x16x32_bf16 v[232:235], a[40:43], v[76:79], v[232:235]
v_exp_f32 v33, v33
v_mfma_f32_16x16x32_bf16 v[236:239], a[44:47], v[76:79], v[236:239]
ds_read_b128 a[12:15], v1 offset:19456
v_mfma_f32_16x16x32_bf16 v[204:207], a[44:47], v[72:75], v[204:207]
v_exp_f32 v34, v34
v_mfma_f32_16x16x32_bf16 v[172:175], a[44:47], v[68:71], v[172:175]
v_exp_f32 v35, v35
v_mfma_f32_16x16x32_bf16 v[140:143], a[44:47], v[64:67], v[140:143]
v_mfma_f32_16x16x32_bf16 v[144:147], a[48:51], v[64:67], v[144:147]
ds_read_b128 a[16:19], v1 offset:20480
v_cvt_pk_bf16_f32 v50, v32, v33
v_cvt_pk_bf16_f32 v51, v34, v35
v_mfma_f32_16x16x32_bf16 v[176:179], a[48:51], v[68:71], v[176:179]
v_exp_f32 v36, v36
v_mfma_f32_16x16x32_bf16 v[208:211], a[48:51], v[72:75], v[208:211]
v_mfma_f32_16x16x32_bf16 v[240:243], a[48:51], v[76:79], v[240:243]
ds_read_b128 a[20:23], v1 offset:21504
v_exp_f32 v37, v37
v_mfma_f32_16x16x32_bf16 v[244:247], a[52:55], v[76:79], v[244:247]
v_mfma_f32_16x16x32_bf16 v[212:215], a[52:55], v[72:75], v[212:215]
v_exp_f32 v38, v38
v_mfma_f32_16x16x32_bf16 v[180:183], a[52:55], v[68:71], v[180:183]
v_exp_f32 v39, v39
v_mfma_f32_16x16x32_bf16 v[148:151], a[52:55], v[64:67], v[148:151]
ds_read_b128 a[24:27], v1 offset:22528
v_mfma_f32_16x16x32_bf16 v[152:155], a[56:59], v[64:67], v[152:155]
v_cvt_pk_bf16_f32 v54, v36, v37
v_cvt_pk_bf16_f32 v55, v38, v39
v_mfma_f32_16x16x32_bf16 v[184:187], a[56:59], v[68:71], v[184:187]
buffer_load_dwordx4 v3, s[88:91], s7 offen offset:1024 sc1 lds
v_mfma_f32_16x16x32_bf16 v[216:219], a[56:59], v[72:75], v[216:219]
v_exp_f32 v40, v40
v_mfma_f32_16x16x32_bf16 v[248:251], a[56:59], v[76:79], v[248:251]
v_mfma_f32_16x16x32_bf16 v[252:255], a[60:63], v[76:79], v[252:255]
ds_read_b128 a[28:31], v1 offset:23552
v_exp_f32 v41, v41
v_mfma_f32_16x16x32_bf16 v[220:223], a[60:63], v[72:75], v[220:223]
v_mfma_f32_16x16x32_bf16 v[188:191], a[60:63], v[68:71], v[188:191]
v_exp_f32 v42, v42
v_mfma_f32_16x16x32_bf16 v[156:159], a[60:63], v[64:67], v[156:159]
v_exp_f32 v43, v43
v_mfma_f32_16x16x32_bf16 a[224:227], a[240:243], v[64:67], a[224:227]
v_mfma_f32_16x16x32_bf16 a[228:231], a[240:243], v[68:71], a[228:231]
v_cvt_pk_bf16_f32 v58, v40, v41
v_cvt_pk_bf16_f32 v59, v42, v43
v_mfma_f32_16x16x32_bf16 a[232:235], a[240:243], v[72:75], a[232:235]
v_exp_f32 v44, v44
v_mfma_f32_16x16x32_bf16 a[236:239], a[240:243], v[76:79], a[236:239]
s_waitcnt lgkmcnt(7)
v_mfma_f32_16x16x32_bf16 v[16:19], a[0:3], a[160:163], v[96:99]
ds_read_b128 a[32:35], v1 offset:24576
v_exp_f32 v45, v45
s_waitcnt lgkmcnt(7)
v_mfma_f32_16x16x32_bf16 v[16:19], a[4:7], a[164:167], v[16:19]
s_waitcnt lgkmcnt(6)
v_mfma_f32_16x16x32_bf16 v[16:19], a[8:11], a[168:171], v[16:19]
v_exp_f32 v46, v46
s_waitcnt lgkmcnt(5)
v_mfma_f32_16x16x32_bf16 v[16:19], a[12:15], a[172:175], v[16:19]
ds_read_b128 a[36:39], v1 offset:25600
v_exp_f32 v47, v47
v_mfma_f32_16x16x32_bf16 v[20:23], a[0:3], a[176:179], v[84:87]
v_mfma_f32_16x16x32_bf16 v[20:23], a[4:7], a[180:183], v[20:23]
v_cvt_pk_bf16_f32 v62, v44, v45
v_cvt_pk_bf16_f32 v63, v46, v47
v_mfma_f32_16x16x32_bf16 v[20:23], a[8:11], a[184:187], v[20:23]
buffer_load_dwordx4 v3, s[88:91], s7 offen offset:2048 sc1 lds
v_mfma_f32_16x16x32_bf16 v[20:23], a[12:15], a[188:191], v[20:23]
ds_read_b128 a[40:43], v1 offset:26624
v_mfma_f32_16x16x32_bf16 v[24:27], a[0:3], a[192:195], v[88:91]
v_exp_f32 v16, v16
v_mfma_f32_16x16x32_bf16 v[24:27], a[4:7], a[196:199], v[24:27]
v_exp_f32 v17, v17
v_mfma_f32_16x16x32_bf16 v[24:27], a[8:11], a[200:203], v[24:27]
v_mfma_f32_16x16x32_bf16 v[24:27], a[12:15], a[204:207], v[24:27]
ds_read_b128 a[44:47], v1 offset:27648
v_exp_f32 v18, v18
v_mfma_f32_16x16x32_bf16 v[28:31], a[0:3], a[208:211], v[92:95]
v_exp_f32 v19, v19
v_mfma_f32_16x16x32_bf16 v[28:31], a[4:7], a[212:215], v[28:31]
v_mfma_f32_16x16x32_bf16 v[28:31], a[8:11], a[216:219], v[28:31]
ds_read_b128 a[48:51], v1 offset:28672
v_cvt_pk_bf16_f32 v64, v16, v17
v_cvt_pk_bf16_f32 v65, v18, v19
v_mfma_f32_16x16x32_bf16 v[28:31], a[12:15], a[220:223], v[28:31]
v_exp_f32 v20, v20
s_waitcnt lgkmcnt(8)
v_mfma_f32_16x16x32_bf16 v[32:35], a[16:19], a[160:163], v[100:103]
s_waitcnt lgkmcnt(7)
v_mfma_f32_16x16x32_bf16 v[32:35], a[20:23], a[164:167], v[32:35]
ds_read_b128 a[52:55], v1 offset:29696
v_exp_f32 v21, v21
s_waitcnt lgkmcnt(7)
v_mfma_f32_16x16x32_bf16 v[32:35], a[24:27], a[168:171], v[32:35]
s_waitcnt lgkmcnt(6)
v_mfma_f32_16x16x32_bf16 v[32:35], a[28:31], a[172:175], v[32:35]
v_exp_f32 v22, v22
v_mfma_f32_16x16x32_bf16 v[36:39], a[16:19], a[176:179], v[84:87]
v_exp_f32 v23, v23
v_mfma_f32_16x16x32_bf16 v[36:39], a[20:23], a[180:183], v[36:39]
ds_read_b128 a[56:59], v1 offset:30720
v_mfma_f32_16x16x32_bf16 v[36:39], a[24:27], a[184:187], v[36:39]
v_cvt_pk_bf16_f32 v68, v20, v21
v_cvt_pk_bf16_f32 v69, v22, v23
v_mfma_f32_16x16x32_bf16 v[36:39], a[28:31], a[188:191], v[36:39]
buffer_load_dwordx4 v3, s[88:91], s7 offen offset:3072 sc1 lds
v_mfma_f32_16x16x32_bf16 v[40:43], a[16:19], a[192:195], v[88:91]
v_exp_f32 v24, v24
v_mfma_f32_16x16x32_bf16 v[40:43], a[20:23], a[196:199], v[40:43]
ds_read_b128 a[60:63], v1 offset:31744
v_mfma_f32_16x16x32_bf16 v[40:43], a[24:27], a[200:203], v[40:43]
v_exp_f32 v25, v25
v_mfma_f32_16x16x32_bf16 v[40:43], a[28:31], a[204:207], v[40:43]
v_mfma_f32_16x16x32_bf16 v[44:47], a[16:19], a[208:211], v[92:95]
v_exp_f32 v26, v26
v_mfma_f32_16x16x32_bf16 v[44:47], a[20:23], a[212:215], v[44:47]
v_exp_f32 v27, v27
v_mfma_f32_16x16x32_bf16 v[44:47], a[24:27], a[216:219], v[44:47]
v_mfma_f32_16x16x32_bf16 v[44:47], a[28:31], a[220:223], v[44:47]
v_cvt_pk_bf16_f32 v72, v24, v25
v_cvt_pk_bf16_f32 v73, v26, v27
s_add_u32 s32, s32, 0x8000
s_add_u32 s7, s7, 0x8000
s_xor_b32 s27, s27, 0x38000
v_xor_b32 v1, 0x8000, v1
L_att_l1_1:
s_waitcnt vmcnt(16) lgkmcnt(0)
s_barrier
v_mfma_f32_16x16x32_bf16 v[128:131], a[32:35], v[48:51], v[128:131]
ds_read_b128 a[0:3], v2 offset:0
v_exp_f32 v28, v28
v_mfma_f32_16x16x32_bf16 v[160:163], a[32:35], v[52:55], v[160:163]
v_mfma_f32_16x16x32_bf16 v[192:195], a[32:35], v[56:59], v[192:195]
v_exp_f32 v29, v29
v_mfma_f32_16x16x32_bf16 v[224:227], a[32:35], v[60:63], v[224:227]
ds_read_b128 a[4:7], v2 offset:1024
v_mfma_f32_16x16x32_bf16 v[228:231], a[36:39], v[60:63], v[228:231]
v_exp_f32 v30, v30
v_mfma_f32_16x16x32_bf16 v[196:199], a[36:39], v[56:59], v[196:199]
v_exp_f32 v31, v31
v_mfma_f32_16x16x32_bf16 v[164:167], a[36:39], v[52:55], v[164:167]
s_add_u32 m0, s19, 0x0
v_mfma_f32_16x16x32_bf16 v[132:135], a[36:39], v[48:51], v[132:135]
buffer_load_dwordx4 v3, s[88:91], s32 offen offset:0 sc1 lds
v_mfma_f32_16x16x32_bf16 v[136:139], a[40:43], v[48:51], v[136:139]
ds_read_b128 a[8:11], v2 offset:2048
v_cvt_pk_bf16_f32 v76, v28, v29
v_cvt_pk_bf16_f32 v77, v30, v31
v_mfma_f32_16x16x32_bf16 v[168:171], a[40:43], v[52:55], v[168:171]
v_exp_f32 v32, v32
v_mfma_f32_16x16x32_bf16 v[200:203], a[40:43], v[56:59], v[200:203]
v_mfma_f32_16x16x32_bf16 v[232:235], a[40:43], v[60:63], v[232:235]
v_exp_f32 v33, v33
v_mfma_f32_16x16x32_bf16 v[236:239], a[44:47], v[60:63], v[236:239]
ds_read_b128 a[12:15], v2 offset:3072
v_mfma_f32_16x16x32_bf16 v[204:207], a[44:47], v[56:59], v[204:207]
v_exp_f32 v34, v34
v_mfma_f32_16x16x32_bf16 v[172:175], a[44:47], v[52:55], v[172:175]
v_exp_f32 v35, v35
v_mfma_f32_16x16x32_bf16 v[140:143], a[44:47], v[48:51], v[140:143]
v_mfma_f32_16x16x32_bf16 v[144:147], a[48:51], v[48:51], v[144:147]
ds_read_b128 a[16:19], v2 offset:4096
v_cvt_pk_bf16_f32 v66, v32, v33
v_cvt_pk_bf16_f32 v67, v34, v35
v_mfma_f32_16x16x32_bf16 v[176:179], a[48:51], v[52:55], v[176:179]
v_exp_f32 v36, v36
v_mfma_f32_16x16x32_bf16 v[208:211], a[48:51], v[56:59], v[208:211]
v_mfma_f32_16x16x32_bf16 v[240:243], a[48:51], v[60:63], v[240:243]
ds_read_b128 a[20:23], v2 offset:5120
v_exp_f32 v37, v37
v_mfma_f32_16x16x32_bf16 v[244:247], a[52:55], v[60:63], v[244:247]
v_mfma_f32_16x16x32_bf16 v[212:215], a[52:55], v[56:59], v[212:215]
v_exp_f32 v38, v38
v_mfma_f32_16x16x32_bf16 v[180:183], a[52:55], v[52:55], v[180:183]
buffer_load_dwordx4 v3, s[88:91], s32 offen offset:1024 sc1 lds
v_mfma_f32_16x16x32_bf16 v[148:151], a[52:55], v[48:51], v[148:151]
v_exp_f32 v39, v39
v_mfma_f32_16x16x32_bf16 v[152:155], a[56:59], v[48:51], v[152:155]
ds_read_b128 a[24:27], v2 offset:6144
v_mfma_f32_16x16x32_bf16 v[184:187], a[56:59], v[52:55], v[184:187]
v_cvt_pk_bf16_f32 v70, v36, v37
v_cvt_pk_bf16_f32 v71, v38, v39
v_mfma_f32_16x16x32_bf16 v[216:219], a[56:59], v[56:59], v[216:219]
v_exp_f32 v40, v40
v_mfma_f32_16x16x32_bf16 v[248:251], a[56:59], v[60:63], v[248:251]
v_mfma_f32_16x16x32_bf16 v[252:255], a[60:63], v[60:63], v[252:255]
ds_read_b128 a[28:31], v2 offset:7168
v_exp_f32 v41, v41
v_mfma_f32_16x16x32_bf16 v[220:223], a[60:63], v[56:59], v[220:223]
v_mfma_f32_16x16x32_bf16 v[188:191], a[60:63], v[52:55], v[188:191]
v_exp_f32 v42, v42
v_mfma_f32_16x16x32_bf16 v[156:159], a[60:63], v[48:51], v[156:159]
v_exp_f32 v43, v43
v_mfma_f32_16x16x32_bf16 a[224:227], a[240:243], v[48:51], a[224:227]
v_mfma_f32_16x16x32_bf16 a[228:231], a[240:243], v[52:55], a[228:231]
v_cvt_pk_bf16_f32 v74, v40, v41
v_cvt_pk_bf16_f32 v75, v42, v43
v_mfma_f32_16x16x32_bf16 a[232:235], a[240:243], v[56:59], a[232:235]
v_exp_f32 v44, v44
v_mfma_f32_16x16x32_bf16 a[236:239], a[240:243], v[60:63], a[236:239]
s_waitcnt lgkmcnt(7)
v_mfma_f32_16x16x32_bf16 v[20:23], a[0:3], a[176:179], v[104:107]
ds_read_b128 a[32:35], v2 offset:8192
v_exp_f32 v45, v45
s_waitcnt lgkmcnt(7)
v_mfma_f32_16x16x32_bf16 v[20:23], a[4:7], a[180:183], v[20:23]
buffer_load_dwordx4 v3, s[88:91], s32 offen offset:2048 sc1 lds
s_waitcnt lgkmcnt(6)
v_mfma_f32_16x16x32_bf16 v[20:23], a[8:11], a[184:187], v[20:23]
s_waitcnt lgkmcnt(5)
v_mfma_f32_16x16x32_bf16 v[20:23], a[12:15], a[188:191], v[20:23]
ds_read_b128 a[36:39], v2 offset:9216
v_exp_f32 v46, v46
v_mfma_f32_16x16x32_bf16 v[24:27], a[0:3], a[192:195], v[88:91]
v_exp_f32 v47, v47
v_mfma_f32_16x16x32_bf16 v[24:27], a[4:7], a[196:199], v[24:27]
ds_read_b128 a[40:43], v2 offset:10240
v_mfma_f32_16x16x32_bf16 v[24:27], a[8:11], a[200:203], v[24:27]
v_cvt_pk_bf16_f32 v78, v44, v45
v_cvt_pk_bf16_f32 v79, v46, v47
v_mfma_f32_16x16x32_bf16 v[24:27], a[12:15], a[204:207], v[24:27]
v_mfma_f32_16x16x32_bf16 v[28:31], a[0:3], a[208:211], v[92:95]
ds_read_b128 a[44:47], v2 offset:11264
v_exp_f32 v20, v20
v_mfma_f32_16x16x32_bf16 v[28:31], a[4:7], a[212:215], v[28:31]
v_exp_f32 v21, v21
v_mfma_f32_16x16x32_bf16 v[28:31], a[8:11], a[216:219], v[28:31]
ds_read_b128 a[48:51], v2 offset:12288
v_mfma_f32_16x16x32_bf16 v[28:31], a[12:15], a[220:223], v[28:31]
v_exp_f32 v22, v22
s_waitcnt lgkmcnt(8)
v_mfma_f32_16x16x32_bf16 v[36:39], a[16:19], a[176:179], v[108:111]
ds_read_b128 a[52:55], v2 offset:13312
v_exp_f32 v23, v23
s_waitcnt lgkmcnt(8)
v_mfma_f32_16x16x32_bf16 v[36:39], a[20:23], a[180:183], v[36:39]
s_waitcnt lgkmcnt(7)
v_mfma_f32_16x16x32_bf16 v[36:39], a[24:27], a[184:187], v[36:39]
v_cvt_pk_bf16_f32 v52, v20, v21
v_cvt_pk_bf16_f32 v53, v22, v23
s_waitcnt lgkmcnt(6)
v_mfma_f32_16x16x32_bf16 v[36:39], a[28:31], a[188:191], v[36:39]
ds_read_b128 a[56:59], v2 offset:14336
v_exp_f32 v24, v24
v_mfma_f32_16x16x32_bf16 v[40:43], a[16:19], a[192:195], v[88:91]
buffer_load_dwordx4 v3, s[88:91], s32 offen offset:3072 sc1 lds
v_mfma_f32_16x16x32_bf16 v[40:43], a[20:23], a[196:199], v[40:43]
v_mfma_f32_16x16x32_bf16 v[40:43], a[24:27], a[200:203], v[40:43]
ds_read_b128 a[60:63], v2 offset:15360
v_exp_f32 v25, v25
v_mfma_f32_16x16x32_bf16 v[40:43], a[28:31], a[204:207], v[40:43]
v_mfma_f32_16x16x32_bf16 v[44:47], a[16:19], a[208:211], v[92:95]
v_exp_f32 v26, v26
v_mfma_f32_16x16x32_bf16 v[44:47], a[20:23], a[212:215], v[44:47]
v_exp_f32 v27, v27
v_mfma_f32_16x16x32_bf16 v[44:47], a[24:27], a[216:219], v[44:47]
v_mfma_f32_16x16x32_bf16 v[44:47], a[28:31], a[220:223], v[44:47]
v_cvt_pk_bf16_f32 v56, v24, v25
v_cvt_pk_bf16_f32 v57, v26, v27
s_waitcnt lgkmcnt(0)
v_mfma_f32_16x16x32_bf16 v[128:131], a[32:35], v[64:67], v[128:131]
ds_read_b128 a[0:3], v2 offset:16384
v_exp_f32 v28, v28
v_mfma_f32_16x16x32_bf16 v[160:163], a[32:35], v[68:71], v[160:163]
v_mfma_f32_16x16x32_bf16 v[192:195], a[32:35], v[72:75], v[192:195]
v_exp_f32 v29, v29
v_mfma_f32_16x16x32_bf16 v[224:227], a[32:35], v[76:79], v[224:227]
ds_read_b128 a[4:7], v2 offset:17408
v_mfma_f32_16x16x32_bf16 v[228:231], a[36:39], v[76:79], v[228:231]
v_exp_f32 v30, v30
v_mfma_f32_16x16x32_bf16 v[196:199], a[36:39], v[72:75], v[196:199]
s_add_u32 m0, s19, 0x1000
v_mfma_f32_16x16x32_bf16 v[164:167], a[36:39], v[68:71], v[164:167]
buffer_load_dwordx4 v3, s[88:91], s7 offen offset:0 sc1 lds
v_mfma_f32_16x16x32_bf16 v[132:135], a[36:39], v[64:67], v[132:135]
v_exp_f32 v31, v31
v_mfma_f32_16x16x32_bf16 v[136:139], a[40:43], v[64:67], v[136:139]
ds_read_b128 a[8:11], v2 offset:18432
v_mfma_f32_16x16x32_bf16 v[168:171], a[40:43], v[68:71], v[168:171]
v_cvt_pk_bf16_f32 v60, v28, v29
v_cvt_pk_bf16_f32 v61, v30, v31
v_mfma_f32_16x16x32_bf16 v[200:203], a[40:43], v[72:75], v[200:203]
v_mfma_f32_16x16x32_bf16 v[232:235], a[40:43], v[76:79], v[232:235]
v_exp_f32 v36, v36
v_mfma_f32_16x16x32_bf16 v[236:239], a[44:47], v[76:79], v[236:239]
ds_read_b128 a[12:15], v2 offset:19456
v_mfma_f32_16x16x32_bf16 v[204:207], a[44:47], v[72:75], v[204:207]
v_exp_f32 v37, v37
v_mfma_f32_16x16x32_bf16 v[172:175], a[44:47], v[68:71], v[172:175]
v_mfma_f32_16x16x32_bf16 v[140:143], a[44:47], v[64:67], v[140:143]
v_exp_f32 v38, v38
v_mfma_f32_16x16x32_bf16 v[144:147], a[48:51], v[64:67], v[144:147]
ds_read_b128 a[16:19], v2 offset:20480
v_mfma_f32_16x16x32_bf16 v[176:179], a[48:51], v[68:71], v[176:179]
v_exp_f32 v39, v39
v_mfma_f32_16x16x32_bf16 v[208:211], a[48:51], v[72:75], v[208:211]
v_mfma_f32_16x16x32_bf16 v[240:243], a[48:51], v[76:79], v[240:243]
buffer_load_dwordx4 v3, s[88:91], s7 offen offset:1024 sc1 lds
v_mfma_f32_16x16x32_bf16 v[244:247], a[52:55], v[76:79], v[244:247]
ds_read_b128 a[20:23], v2 offset:21504
v_cvt_pk_bf16_f32 v54, v36, v37
v_cvt_pk_bf16_f32 v55, v38, v39
v_mfma_f32_16x16x32_bf16 v[212:215], a[52:55], v[72:75], v[212:215]
v_mfma_f32_16x16x32_bf16 v[180:183], a[52:55], v[68:71], v[180:183]
v_exp_f32 v40, v40
v_mfma_f32_16x16x32_bf16 v[148:151], a[52:55], v[64:67], v[148:151]
v_mfma_f32_16x16x32_bf16 v[152:155], a[56:59], v[64:67], v[152:155]
ds_read_b128 a[24:27], v2 offset:22528
v_exp_f32 v41, v41
v_mfma_f32_16x16x32_bf16 v[184:187], a[56:59], v[68:71], v[184:187]
v_mfma_f32_16x16x32_bf16 v[216:219], a[56:59], v[72:75], v[216:219]
v_exp_f32 v42, v42
v_mfma_f32_16x16x32_bf16 v[248:251], a[56:59], v[76:79], v[248:251]
v_exp_f32 v43, v43
v_mfma_f32_16x16x32_bf16 v[252:255], a[60:63], v[76:79], v[252:255]
ds_read_b128 a[28:31], v2 offset:23552
v_mfma_f32_16x16x32_bf16 v[220:223], a[60:63], v[72:75], v[220:223]
v_cvt_pk_bf16_f32 v58, v40, v41
v_cvt_pk_bf16_f32 v59, v42, v43
v_mfma_f32_16x16x32_bf16 v[188:191], a[60:63], v[68:71], v[188:191]
v_mfma_f32_16x16x32_bf16 v[156:159], a[60:63], v[64:67], v[156:159]
v_exp_f32 v44, v44
v_mfma_f32_16x16x32_bf16 a[224:227], a[240:243], v[64:67], a[224:227]
buffer_load_dwordx4 v3, s[88:91], s7 offen offset:2048 sc1 lds
v_mfma_f32_16x16x32_bf16 a[228:231], a[240:243], v[68:71], a[228:231]
v_mfma_f32_16x16x32_bf16 a[232:235], a[240:243], v[72:75], a[232:235]
v_exp_f32 v45, v45
v_mfma_f32_16x16x32_bf16 a[236:239], a[240:243], v[76:79], a[236:239]
s_waitcnt lgkmcnt(7)
v_mfma_f32_16x16x32_bf16 v[24:27], a[0:3], a[192:195], v[88:91]
ds_read_b128 a[32:35], v2 offset:24576
v_exp_f32 v46, v46
s_waitcnt lgkmcnt(7)
v_mfma_f32_16x16x32_bf16 v[24:27], a[4:7], a[196:199], v[24:27]
ds_read_b128 a[36:39], v2 offset:25600
s_waitcnt lgkmcnt(7)
v_mfma_f32_16x16x32_bf16 v[24:27], a[8:11], a[200:203], v[24:27]
v_exp_f32 v47, v47
s_waitcnt lgkmcnt(6)
v_mfma_f32_16x16x32_bf16 v[24:27], a[12:15], a[204:207], v[24:27]
ds_read_b128 a[40:43], v2 offset:26624
v_mfma_f32_16x16x32_bf16 v[28:31], a[0:3], a[208:211], v[92:95]
ds_read_b128 a[44:47], v2 offset:27648
v_cvt_pk_bf16_f32 v62, v44, v45
v_cvt_pk_bf16_f32 v63, v46, v47
v_mfma_f32_16x16x32_bf16 v[28:31], a[4:7], a[212:215], v[28:31]
v_mfma_f32_16x16x32_bf16 v[28:31], a[8:11], a[216:219], v[28:31]
ds_read_b128 a[48:51], v2 offset:28672
v_mfma_f32_16x16x32_bf16 v[28:31], a[12:15], a[220:223], v[28:31]
ds_read_b128 a[52:55], v2 offset:29696
s_waitcnt lgkmcnt(9)
v_mfma_f32_16x16x32_bf16 v[40:43], a[16:19], a[192:195], v[88:91]
v_exp_f32 v24, v24
s_waitcnt lgkmcnt(8)
v_mfma_f32_16x16x32_bf16 v[40:43], a[20:23], a[196:199], v[40:43]
buffer_load_dwordx4 v3, s[88:91], s7 offen offset:3072 sc1 lds
s_waitcnt lgkmcnt(7)
v_mfma_f32_16x16x32_bf16 v[40:43], a[24:27], a[200:203], v[40:43]
ds_read_b128 a[56:59], v2 offset:30720
v_exp_f32 v25, v25
s_waitcnt lgkmcnt(7)
v_mfma_f32_16x16x32_bf16 v[40:43], a[28:31], a[204:207], v[40:43]
ds_read_b128 a[60:63], v2 offset:31744
v_exp_f32 v26, v26
v_mfma_f32_16x16x32_bf16 v[44:47], a[16:19], a[208:211], v[92:95]
v_mfma_f32_16x16x32_bf16 v[44:47], a[20:23], a[212:215], v[44:47]
v_exp_f32 v27, v27
v_mfma_f32_16x16x32_bf16 v[44:47], a[24:27], a[216:219], v[44:47]
v_mfma_f32_16x16x32_bf16 v[44:47], a[28:31], a[220:223], v[44:47]
v_cvt_pk_bf16_f32 v72, v24, v25
v_cvt_pk_bf16_f32 v73, v26, v27
s_add_u32 s32, s32, 0x8000
s_add_u32 s7, s7, 0x8000
s_xor_b32 s19, s19, 0x8000
v_xor_b32 v2, 0x38000, v2
s_sub_u32 s15, 7, s6
s_lshl_b32 s15, s15, 1
s_cbranch_scc0 L_att_lh0_1
s_waitcnt vmcnt(16) lgkmcnt(0)
s_barrier
v_mfma_f32_16x16x32_bf16 v[160:163], a[32:35], v[52:55], v[160:163]
ds_read_b128 a[0:3], v1 offset:0
v_exp_f32 v28, v28
v_mfma_f32_16x16x32_bf16 v[192:195], a[32:35], v[56:59], v[192:195]
v_mfma_f32_16x16x32_bf16 v[224:227], a[32:35], v[60:63], v[224:227]
ds_read_b128 a[4:7], v1 offset:1024
v_exp_f32 v29, v29
v_mfma_f32_16x16x32_bf16 v[228:231], a[36:39], v[60:63], v[228:231]
v_mfma_f32_16x16x32_bf16 v[196:199], a[36:39], v[56:59], v[196:199]
s_add_u32 m0, s27, 0x0
v_exp_f32 v30, v30
v_mfma_f32_16x16x32_bf16 v[164:167], a[36:39], v[52:55], v[164:167]
buffer_load_dwordx4 v3, s[88:91], s32 offen offset:0 sc1 lds
v_mfma_f32_16x16x32_bf16 v[168:171], a[40:43], v[52:55], v[168:171]
ds_read_b128 a[8:11], v1 offset:2048
v_mfma_f32_16x16x32_bf16 v[200:203], a[40:43], v[56:59], v[200:203]
v_exp_f32 v31, v31
v_mfma_f32_16x16x32_bf16 v[232:235], a[40:43], v[60:63], v[232:235]
ds_read_b128 a[12:15], v1 offset:3072
v_mfma_f32_16x16x32_bf16 v[236:239], a[44:47], v[60:63], v[236:239]
v_cvt_pk_bf16_f32 v76, v28, v29
v_cvt_pk_bf16_f32 v77, v30, v31
v_mfma_f32_16x16x32_bf16 v[204:207], a[44:47], v[56:59], v[204:207]
v_mfma_f32_16x16x32_bf16 v[172:175], a[44:47], v[52:55], v[172:175]
ds_read_b128 a[16:19], v1 offset:4096
v_exp_f32 v40, v40
v_mfma_f32_16x16x32_bf16 v[176:179], a[48:51], v[52:55], v[176:179]
v_mfma_f32_16x16x32_bf16 v[208:211], a[48:51], v[56:59], v[208:211]
v_exp_f32 v41, v41
v_mfma_f32_16x16x32_bf16 v[240:243], a[48:51], v[60:63], v[240:243]
ds_read_b128 a[20:23], v1 offset:5120
v_mfma_f32_16x16x32_bf16 v[244:247], a[52:55], v[60:63], v[244:247]
buffer_load_dwordx4 v3, s[88:91], s32 offen offset:1024 sc1 lds
v_mfma_f32_16x16x32_bf16 v[212:215], a[52:55], v[56:59], v[212:215]
v_exp_f32 v42, v42
v_mfma_f32_16x16x32_bf16 v[180:183], a[52:55], v[52:55], v[180:183]
ds_read_b128 a[24:27], v1 offset:6144
v_mfma_f32_16x16x32_bf16 v[184:187], a[56:59], v[52:55], v[184:187]
v_exp_f32 v43, v43
v_mfma_f32_16x16x32_bf16 v[216:219], a[56:59], v[56:59], v[216:219]
v_mfma_f32_16x16x32_bf16 v[248:251], a[56:59], v[60:63], v[248:251]
ds_read_b128 a[28:31], v1 offset:7168
v_cvt_pk_bf16_f32 v74, v40, v41
v_cvt_pk_bf16_f32 v75, v42, v43
v_mfma_f32_16x16x32_bf16 v[252:255], a[60:63], v[60:63], v[252:255]
v_mfma_f32_16x16x32_bf16 v[220:223], a[60:63], v[56:59], v[220:223]
v_exp_f32 v44, v44
v_mfma_f32_16x16x32_bf16 v[188:191], a[60:63], v[52:55], v[188:191]
v_mfma_f32_16x16x32_bf16 a[228:231], a[240:243], v[52:55], a[228:231]
v_exp_f32 v45, v45
v_mfma_f32_16x16x32_bf16 a[232:235], a[240:243], v[56:59], a[232:235]
buffer_load_dwordx4 v3, s[88:91], s32 offen offset:2048 sc1 lds
v_mfma_f32_16x16x32_bf16 a[236:239], a[240:243], v[60:63], a[236:239]
s_waitcnt lgkmcnt(7)
v_mfma_f32_16x16x32_bf16 v[24:27], a[0:3], a[192:195], v[88:91]
ds_read_b128 a[32:35], v1 offset:8192
v_exp_f32 v46, v46
s_waitcnt lgkmcnt(7)
v_mfma_f32_16x16x32_bf16 v[24:27], a[4:7], a[196:199], v[24:27]
ds_read_b128 a[36:39], v1 offset:9216
s_waitcnt lgkmcnt(7)
v_mfma_f32_16x16x32_bf16 v[24:27], a[8:11], a[200:203], v[24:27]
v_exp_f32 v47, v47
s_waitcnt lgkmcnt(6)
v_mfma_f32_16x16x32_bf16 v[24:27], a[12:15], a[204:207], v[24:27]
ds_read_b128 a[40:43], v1 offset:10240
v_mfma_f32_16x16x32_bf16 v[28:31], a[0:3], a[208:211], v[92:95]
ds_read_b128 a[44:47], v1 offset:11264
v_cvt_pk_bf16_f32 v78, v44, v45
v_cvt_pk_bf16_f32 v79, v46, v47
v_mfma_f32_16x16x32_bf16 v[28:31], a[4:7], a[212:215], v[28:31]
v_mfma_f32_16x16x32_bf16 v[28:31], a[8:11], a[216:219], v[28:31]
ds_read_b128 a[48:51], v1 offset:12288
v_mfma_f32_16x16x32_bf16 v[28:31], a[12:15], a[220:223], v[28:31]
ds_read_b128 a[52:55], v1 offset:13312
s_waitcnt lgkmcnt(9)
v_mfma_f32_16x16x32_bf16 v[40:43], a[16:19], a[192:195], v[88:91]
buffer_load_dwordx4 v3, s[88:91], s32 offen offset:3072 sc1 lds
s_waitcnt lgkmcnt(8)
v_mfma_f32_16x16x32_bf16 v[40:43], a[20:23], a[196:199], v[40:43]
v_exp_f32 v24, v24
s_waitcnt lgkmcnt(7)
v_mfma_f32_16x16x32_bf16 v[40:43], a[24:27], a[200:203], v[40:43]
ds_read_b128 a[56:59], v1 offset:14336
v_exp_f32 v25, v25
s_waitcnt lgkmcnt(7)
v_mfma_f32_16x16x32_bf16 v[40:43], a[28:31], a[204:207], v[40:43]
ds_read_b128 a[60:63], v1 offset:15360
v_exp_f32 v26, v26
v_mfma_f32_16x16x32_bf16 v[44:47], a[16:19], a[208:211], v[92:95]
v_mfma_f32_16x16x32_bf16 v[44:47], a[20:23], a[212:215], v[44:47]
v_exp_f32 v27, v27
v_mfma_f32_16x16x32_bf16 v[44:47], a[24:27], a[216:219], v[44:47]
v_mfma_f32_16x16x32_bf16 v[44:47], a[28:31], a[220:223], v[44:47]
v_cvt_pk_bf16_f32 v56, v24, v25
v_cvt_pk_bf16_f32 v57, v26, v27
s_waitcnt lgkmcnt(0)
v_mfma_f32_16x16x32_bf16 v[192:195], a[32:35], v[72:75], v[192:195]
ds_read_b128 a[0:3], v1 offset:16384
v_exp_f32 v28, v28
v_mfma_f32_16x16x32_bf16 v[224:227], a[32:35], v[76:79], v[224:227]
ds_read_b128 a[4:7], v1 offset:17408
v_mfma_f32_16x16x32_bf16 v[228:231], a[36:39], v[76:79], v[228:231]
v_exp_f32 v29, v29
v_mfma_f32_16x16x32_bf16 v[196:199], a[36:39], v[72:75], v[196:199]
s_add_u32 m0, s27, 0x1000
ds_read_b128 a[8:11], v1 offset:18432
v_exp_f32 v30, v30
v_mfma_f32_16x16x32_bf16 v[200:203], a[40:43], v[72:75], v[200:203]
buffer_load_dwordx4 v3, s[88:91], s7 offen offset:0 sc1 lds
v_mfma_f32_16x16x32_bf16 v[232:235], a[40:43], v[76:79], v[232:235]
ds_read_b128 a[12:15], v1 offset:19456
v_mfma_f32_16x16x32_bf16 v[236:239], a[44:47], v[76:79], v[236:239]
v_exp_f32 v31, v31
v_mfma_f32_16x16x32_bf16 v[204:207], a[44:47], v[72:75], v[204:207]
ds_read_b128 a[16:19], v1 offset:20480
v_cvt_pk_bf16_f32 v60, v28, v29
v_cvt_pk_bf16_f32 v61, v30, v31
v_mfma_f32_16x16x32_bf16 v[208:211], a[48:51], v[72:75], v[208:211]
ds_read_b128 a[20:23], v1 offset:21504
v_mfma_f32_16x16x32_bf16 v[240:243], a[48:51], v[76:79], v[240:243]
v_exp_f32 v40, v40
v_mfma_f32_16x16x32_bf16 v[244:247], a[52:55], v[76:79], v[244:247]
ds_read_b128 a[24:27], v1 offset:22528
v_exp_f32 v41, v41
v_mfma_f32_16x16x32_bf16 v[212:215], a[52:55], v[72:75], v[212:215]
ds_read_b128 a[28:31], v1 offset:23552
v_mfma_f32_16x16x32_bf16 v[216:219], a[56:59], v[72:75], v[216:219]
buffer_load_dwordx4 v3, s[88:91], s7 offen offset:1024 sc1 lds
v_mfma_f32_16x16x32_bf16 v[248:251], a[56:59], v[76:79], v[248:251]
v_exp_f32 v42, v42
v_mfma_f32_16x16x32_bf16 v[252:255], a[60:63], v[76:79], v[252:255]
v_exp_f32 v43, v43
v_mfma_f32_16x16x32_bf16 v[220:223], a[60:63], v[72:75], v[220:223]
v_mfma_f32_16x16x32_bf16 a[232:235], a[240:243], v[72:75], a[232:235]
v_cvt_pk_bf16_f32 v58, v40, v41
v_cvt_pk_bf16_f32 v59, v42, v43
v_mfma_f32_16x16x32_bf16 a[236:239], a[240:243], v[76:79], a[236:239]
v_exp_f32 v44, v44
s_waitcnt lgkmcnt(7)
v_mfma_f32_16x16x32_bf16 v[24:27], a[0:3], a[192:195], v[88:91]
ds_read_b128 a[32:35], v1 offset:24576
s_waitcnt lgkmcnt(7)
v_mfma_f32_16x16x32_bf16 v[24:27], a[4:7], a[196:199], v[24:27]
ds_read_b128 a[36:39], v1 offset:25600
v_exp_f32 v45, v45
s_waitcnt lgkmcnt(7)
v_mfma_f32_16x16x32_bf16 v[24:27], a[8:11], a[200:203], v[24:27]
buffer_load_dwordx4 v3, s[88:91], s7 offen offset:2048 sc1 lds
s_waitcnt lgkmcnt(6)
v_mfma_f32_16x16x32_bf16 v[24:27], a[12:15], a[204:207], v[24:27]
ds_read_b128 a[40:43], v1 offset:26624
v_exp_f32 v46, v46
v_mfma_f32_16x16x32_bf16 v[28:31], a[0:3], a[208:211], v[92:95]
v_mfma_f32_16x16x32_bf16 v[28:31], a[4:7], a[212:215], v[28:31]
ds_read_b128 a[44:47], v1 offset:27648
v_exp_f32 v47, v47
v_mfma_f32_16x16x32_bf16 v[28:31], a[8:11], a[216:219], v[28:31]
ds_read_b128 a[48:51], v1 offset:28672
v_cvt_pk_bf16_f32 v62, v44, v45
v_cvt_pk_bf16_f32 v63, v46, v47
v_mfma_f32_16x16x32_bf16 v[28:31], a[12:15], a[220:223], v[28:31]
ds_read_b128 a[52:55], v1 offset:29696
s_waitcnt lgkmcnt(9)
v_mfma_f32_16x16x32_bf16 v[40:43], a[16:19], a[192:195], v[88:91]
v_exp_f32 v24, v24
s_waitcnt lgkmcnt(8)
v_mfma_f32_16x16x32_bf16 v[40:43], a[20:23], a[196:199], v[40:43]
ds_read_b128 a[56:59], v1 offset:30720
v_exp_f32 v25, v25
s_waitcnt lgkmcnt(8)
v_mfma_f32_16x16x32_bf16 v[40:43], a[24:27], a[200:203], v[40:43]
buffer_load_dwordx4 v3, s[88:91], s7 offen offset:3072 sc1 lds
s_waitcnt lgkmcnt(7)
v_mfma_f32_16x16x32_bf16 v[40:43], a[28:31], a[204:207], v[40:43]
ds_read_b128 a[60:63], v1 offset:31744
v_mfma_f32_16x16x32_bf16 v[44:47], a[16:19], a[208:211], v[92:95]
v_exp_f32 v26, v26
v_mfma_f32_16x16x32_bf16 v[44:47], a[20:23], a[212:215], v[44:47]
v_exp_f32 v27, v27
v_mfma_f32_16x16x32_bf16 v[44:47], a[24:27], a[216:219], v[44:47]
v_mfma_f32_16x16x32_bf16 v[44:47], a[28:31], a[220:223], v[44:47]
v_cvt_pk_bf16_f32 v72, v24, v25
v_cvt_pk_bf16_f32 v73, v26, v27
s_add_u32 s32, s32, 0x8000
s_add_u32 s7, s7, 0x8000
s_xor_b32 s27, s27, 0x38000
v_xor_b32 v1, 0x8000, v1
s_nop 7
v_accvgpr_read_b32 v4, a224
v_accvgpr_read_b32 v6, a228
s_mov_b32 s8, 0x5f800000
v_cmp_nge_f32 s[36:37], s8, v4
v_cmp_nge_f32 s[38:39], s8, v6
v_rcp_f32 v4, v4
v_rcp_f32 v6, v6
s_or_b64 s[34:35], s[34:35], s[36:37]
s_or_b64 s[34:35], s[34:35], s[38:39]
v_pk_mul_f32 v[128:129], v[128:129], v[4:5] op_sel_hi:[1,0]
v_pk_mul_f32 v[130:131], v[130:131], v[4:5] op_sel_hi:[1,0]
v_pk_mul_f32 v[132:133], v[132:133], v[4:5] op_sel_hi:[1,0]
v_pk_mul_f32 v[134:135], v[134:135], v[4:5] op_sel_hi:[1,0]
v_cvt_pk_bf16_f32 v128, v128, v129
v_cvt_pk_bf16_f32 v129, v130, v131
v_cvt_pk_bf16_f32 v130, v132, v133
v_cvt_pk_bf16_f32 v131, v134, v135
s_add_u32 s8, s28, 0x0
buffer_store_dwordx4 v[128:131], v3, s[88:91], s8 offen sc1
v_pk_mul_f32 v[136:137], v[136:137], v[4:5] op_sel_hi:[1,0]
v_pk_mul_f32 v[138:139], v[138:139], v[4:5] op_sel_hi:[1,0]
v_pk_mul_f32 v[140:141], v[140:141], v[4:5] op_sel_hi:[1,0]
v_pk_mul_f32 v[142:143], v[142:143], v[4:5] op_sel_hi:[1,0]
v_cvt_pk_bf16_f32 v136, v136, v137
v_cvt_pk_bf16_f32 v137, v138, v139
v_cvt_pk_bf16_f32 v138, v140, v141
v_cvt_pk_bf16_f32 v139, v142, v143
s_add_u32 s8, s28, 0x2000
buffer_store_dwordx4 v[136:139], v3, s[88:91], s8 offen sc1
v_pk_mul_f32 v[144:145], v[144:145], v[4:5] op_sel_hi:[1,0]
v_pk_mul_f32 v[146:147], v[146:147], v[4:5] op_sel_hi:[1,0]
v_pk_mul_f32 v[148:149], v[148:149], v[4:5] op_sel_hi:[1,0]
v_pk_mul_f32 v[150:151], v[150:151], v[4:5] op_sel_hi:[1,0]
v_cvt_pk_bf16_f32 v144, v144, v145
v_cvt_pk_bf16_f32 v145, v146, v147
v_cvt_pk_bf16_f32 v146, v148, v149
v_cvt_pk_bf16_f32 v147, v150, v151
s_add_u32 s8, s28, 0x4000
buffer_store_dwordx4 v[144:147], v3, s[88:91], s8 offen sc1
v_pk_mul_f32 v[152:153], v[152:153], v[4:5] op_sel_hi:[1,0]
v_pk_mul_f32 v[154:155], v[154:155], v[4:5] op_sel_hi:[1,0]
v_pk_mul_f32 v[156:157], v[156:157], v[4:5] op_sel_hi:[1,0]
v_pk_mul_f32 v[158:159], v[158:159], v[4:5] op_sel_hi:[1,0]
v_cvt_pk_bf16_f32 v152, v152, v153
v_cvt_pk_bf16_f32 v153, v154, v155
v_cvt_pk_bf16_f32 v154, v156, v157
v_cvt_pk_bf16_f32 v155, v158, v159
s_add_u32 s8, s28, 0x6000
buffer_store_dwordx4 v[152:155], v3, s[88:91], s8 offen sc1
v_pk_mul_f32 v[160:161], v[160:161], v[6:7] op_sel_hi:[1,0]
v_pk_mul_f32 v[162:163], v[162:163], v[6:7] op_sel_hi:[1,0]
v_pk_mul_f32 v[164:165], v[164:165], v[6:7] op_sel_hi:[1,0]
v_pk_mul_f32 v[166:167], v[166:167], v[6:7] op_sel_hi:[1,0]
v_cvt_pk_bf16_f32 v160, v160, v161
v_cvt_pk_bf16_f32 v161, v162, v163
v_cvt_pk_bf16_f32 v162, v164, v165
v_cvt_pk_bf16_f32 v163, v166, v167
s_add_u32 s8, s29, 0x0
buffer_store_dwordx4 v[160:163], v3, s[88:91], s8 offen sc1
v_pk_mul_f32 v[168:169], v[168:169], v[6:7] op_sel_hi:[1,0]
v_pk_mul_f32 v[170:171], v[170:171], v[6:7] op_sel_hi:[1,0]
v_pk_mul_f32 v[172:173], v[172:173], v[6:7] op_sel_hi:[1,0]
v_pk_mul_f32 v[174:175], v[174:175], v[6:7] op_sel_hi:[1,0]
v_cvt_pk_bf16_f32 v168, v168, v169
v_cvt_pk_bf16_f32 v169, v170, v171
v_cvt_pk_bf16_f32 v170, v172, v173
v_cvt_pk_bf16_f32 v171, v174, v175
s_add_u32 s8, s29, 0x2000
buffer_store_dwordx4 v[168:171], v3, s[88:91], s8 offen sc1
v_pk_mul_f32 v[176:177], v[176:177], v[6:7] op_sel_hi:[1,0]
v_pk_mul_f32 v[178:179], v[178:179], v[6:7] op_sel_hi:[1,0]
v_pk_mul_f32 v[180:181], v[180:181], v[6:7] op_sel_hi:[1,0]
v_pk_mul_f32 v[182:183], v[182:183], v[6:7] op_sel_hi:[1,0]
v_cvt_pk_bf16_f32 v176, v176, v177
v_cvt_pk_bf16_f32 v177, v178, v179
v_cvt_pk_bf16_f32 v178, v180, v181
v_cvt_pk_bf16_f32 v179, v182, v183
s_add_u32 s8, s29, 0x4000
buffer_store_dwordx4 v[176:179], v3, s[88:91], s8 offen sc1
v_pk_mul_f32 v[184:185], v[184:185], v[6:7] op_sel_hi:[1,0]
v_pk_mul_f32 v[186:187], v[186:187], v[6:7] op_sel_hi:[1,0]
v_pk_mul_f32 v[188:189], v[188:189], v[6:7] op_sel_hi:[1,0]
v_pk_mul_f32 v[190:191], v[190:191], v[6:7] op_sel_hi:[1,0]
v_cvt_pk_bf16_f32 v184, v184, v185
v_cvt_pk_bf16_f32 v185, v186, v187
v_cvt_pk_bf16_f32 v186, v188, v189
v_cvt_pk_bf16_f32 v187, v190, v191
s_add_u32 s8, s29, 0x6000
buffer_store_dwordx4 v[184:187], v3, s[88:91], s8 offen sc1
s_branch L_att_sodd
L_att_lh0_1:
s_waitcnt vmcnt(16) lgkmcnt(0)
s_barrier
s_and_b32 s8, s2, 7
s_lshr_b32 s9, s2, 3
s_lshr_b32 s99, s8, 1
s_lshl_b32 s99, s99, 2
s_lshr_b32 s10, s9, 3
s_add_u32 s99, s99, s10
s_and_b32 s100, s8, 1
s_lshl_b32 s100, s100, 3
s_and_b32 s10, s9, 7
s_add_u32 s100, s100, s10
s_sub_u32 s10, 15, s99
s_min_u32 s10, s10, s99
s_lshl_b32 s11, s10, 7
s_add_u32 s11, s11, 0x3604000
s_lshl_b32 s10, s10, 2
s_add_u32 s10, s10, 128
buffer_load_dword v13, off, s[84:87], s10 sc1
s_mov_b32 s12, 15360
s_mov_b32 s13, 30720
s_mov_b32 s14, 46080
v_lshrrev_b32 v14, 4, v0
v_bfe_u32 v15, v0, 1, 2
v_xor_b32 v14, v14, v15
v_lshlrev_b32 v14, 5, v14
v_and_b32 v15, 1, v0
v_lshl_add_u32 v14, v15, 4, v14
v_lshrrev_b32 v15, 3, v0
v_lshl_add_u32 v14, v15, 11, v14
s_lshl_b32 s8, s4, 16
s_lshl_b32 s9, s100, 7
s_add_u32 s8, s8, s9
v_add_u32 v12, s8, v14
s_mul_i32 s101, s99, 0x140000
s_lshl_b32 s8, s4, 11
s_add_u32 s101, s101, s8
s_add_u32 s101, s101, 0x21fe000
v_mfma_f32_16x16x32_bf16 v[160:163], a[32:35], v[52:55], v[160:163]
ds_read_b128 a[0:3], v1 offset:0
v_exp_f32 v28, v28
v_mfma_f32_16x16x32_bf16 v[192:195], a[32:35], v[56:59], v[192:195]
v_mfma_f32_16x16x32_bf16 v[224:227], a[32:35], v[60:63], v[224:227]
ds_read_b128 a[4:7], v1 offset:1024
v_exp_f32 v29, v29
v_mfma_f32_16x16x32_bf16 v[228:231], a[36:39], v[60:63], v[228:231]
v_mfma_f32_16x16x32_bf16 v[196:199], a[36:39], v[56:59], v[196:199]
s_add_u32 m0, s17, 0x10000
v_exp_f32 v30, v30
v_mfma_f32_16x16x32_bf16 v[164:167], a[36:39], v[52:55], v[164:167]
buffer_load_dwordx4 v12, s[72:75], 0 offen lds
v_mfma_f32_16x16x32_bf16 v[168:171], a[40:43], v[52:55], v[168:171]
ds_read_b128 a[8:11], v1 offset:2048
v_mfma_f32_16x16x32_bf16 v[200:203], a[40:43], v[56:59], v[200:203]
v_exp_f32 v31, v31
v_mfma_f32_16x16x32_bf16 v[232:235], a[40:43], v[60:63], v[232:235]
ds_read_b128 a[12:15], v1 offset:3072
v_mfma_f32_16x16x32_bf16 v[236:239], a[44:47], v[60:63], v[236:239]
v_cvt_pk_bf16_f32 v76, v28, v29
v_cvt_pk_bf16_f32 v77, v30, v31
v_mfma_f32_16x16x32_bf16 v[204:207], a[44:47], v[56:59], v[204:207]
v_mfma_f32_16x16x32_bf16 v[172:175], a[44:47], v[52:55], v[172:175]
ds_read_b128 a[16:19], v1 offset:4096
v_exp_f32 v40, v40
v_mfma_f32_16x16x32_bf16 v[176:179], a[48:51], v[52:55], v[176:179]
v_mfma_f32_16x16x32_bf16 v[208:211], a[48:51], v[56:59], v[208:211]
v_exp_f32 v41, v41
v_mfma_f32_16x16x32_bf16 v[240:243], a[48:51], v[60:63], v[240:243]
ds_read_b128 a[20:23], v1 offset:5120
v_mfma_f32_16x16x32_bf16 v[244:247], a[52:55], v[60:63], v[244:247]
buffer_load_dwordx4 v12, s[72:75], s12 offen offset:1024 lds
v_mfma_f32_16x16x32_bf16 v[212:215], a[52:55], v[56:59], v[212:215]
v_exp_f32 v42, v42
v_mfma_f32_16x16x32_bf16 v[180:183], a[52:55], v[52:55], v[180:183]
ds_read_b128 a[24:27], v1 offset:6144
v_mfma_f32_16x16x32_bf16 v[184:187], a[56:59], v[52:55], v[184:187]
v_exp_f32 v43, v43
v_mfma_f32_16x16x32_bf16 v[216:219], a[56:59], v[56:59], v[216:219]
v_mfma_f32_16x16x32_bf16 v[248:251], a[56:59], v[60:63], v[248:251]
ds_read_b128 a[28:31], v1 offset:7168
v_cvt_pk_bf16_f32 v74, v40, v41
v_cvt_pk_bf16_f32 v75, v42, v43
v_mfma_f32_16x16x32_bf16 v[252:255], a[60:63], v[60:63], v[252:255]
v_mfma_f32_16x16x32_bf16 v[220:223], a[60:63], v[56:59], v[220:223]
v_exp_f32 v44, v44
v_mfma_f32_16x16x32_bf16 v[188:191], a[60:63], v[52:55], v[188:191]
v_mfma_f32_16x16x32_bf16 a[228:231], a[240:243], v[52:55], a[228:231]
v_exp_f32 v45, v45
v_mfma_f32_16x16x32_bf16 a[232:235], a[240:243], v[56:59], a[232:235]
buffer_load_dwordx4 v12, s[72:75], s13 offen offset:2048 lds
v_mfma_f32_16x16x32_bf16 a[236:239], a[240:243], v[60:63], a[236:239]
s_waitcnt lgkmcnt(7)
v_mfma_f32_16x16x32_bf16 v[24:27], a[0:3], a[192:195], v[88:91]
ds_read_b128 a[32:35], v1 offset:8192
v_exp_f32 v46, v46
s_waitcnt lgkmcnt(7)
v_mfma_f32_16x16x32_bf16 v[24:27], a[4:7], a[196:199], v[24:27]
ds_read_b128 a[36:39], v1 offset:9216
s_waitcnt lgkmcnt(7)
v_mfma_f32_16x16x32_bf16 v[24:27], a[8:11], a[200:203], v[24:27]
v_exp_f32 v47, v47
s_waitcnt lgkmcnt(6)
v_mfma_f32_16x16x32_bf16 v[24:27], a[12:15], a[204:207], v[24:27]
ds_read_b128 a[40:43], v1 offset:10240
v_mfma_f32_16x16x32_bf16 v[28:31], a[0:3], a[208:211], v[92:95]
ds_read_b128 a[44:47], v1 offset:11264
v_cvt_pk_bf16_f32 v78, v44, v45
v_cvt_pk_bf16_f32 v79, v46, v47
v_mfma_f32_16x16x32_bf16 v[28:31], a[4:7], a[212:215], v[28:31]
v_mfma_f32_16x16x32_bf16 v[28:31], a[8:11], a[216:219], v[28:31]
ds_read_b128 a[48:51], v1 offset:12288
v_mfma_f32_16x16x32_bf16 v[28:31], a[12:15], a[220:223], v[28:31]
ds_read_b128 a[52:55], v1 offset:13312
s_waitcnt lgkmcnt(9)
v_mfma_f32_16x16x32_bf16 v[40:43], a[16:19], a[192:195], v[88:91]
buffer_load_dwordx4 v12, s[72:75], s14 offen offset:3072 lds
s_waitcnt lgkmcnt(8)
v_mfma_f32_16x16x32_bf16 v[40:43], a[20:23], a[196:199], v[40:43]
v_exp_f32 v24, v24
s_waitcnt lgkmcnt(7)
v_mfma_f32_16x16x32_bf16 v[40:43], a[24:27], a[200:203], v[40:43]
ds_read_b128 a[56:59], v1 offset:14336
v_exp_f32 v25, v25
s_waitcnt lgkmcnt(7)
v_mfma_f32_16x16x32_bf16 v[40:43], a[28:31], a[204:207], v[40:43]
ds_read_b128 a[60:63], v1 offset:15360
v_exp_f32 v26, v26
v_mfma_f32_16x16x32_bf16 v[44:47], a[16:19], a[208:211], v[92:95]
v_mfma_f32_16x16x32_bf16 v[44:47], a[20:23], a[212:215], v[44:47]
v_exp_f32 v27, v27
v_mfma_f32_16x16x32_bf16 v[44:47], a[24:27], a[216:219], v[44:47]
v_mfma_f32_16x16x32_bf16 v[44:47], a[28:31], a[220:223], v[44:47]
v_cvt_pk_bf16_f32 v56, v24, v25
v_cvt_pk_bf16_f32 v57, v26, v27
s_waitcnt lgkmcnt(0)
v_mfma_f32_16x16x32_bf16 v[192:195], a[32:35], v[72:75], v[192:195]
ds_read_b128 a[0:3], v1 offset:16384
v_exp_f32 v28, v28
v_mfma_f32_16x16x32_bf16 v[224:227], a[32:35], v[76:79], v[224:227]
ds_read_b128 a[4:7], v1 offset:17408
v_mfma_f32_16x16x32_bf16 v[228:231], a[36:39], v[76:79], v[228:231]
v_exp_f32 v29, v29
v_mfma_f32_16x16x32_bf16 v[196:199], a[36:39], v[72:75], v[196:199]
s_add_u32 m0, s17, 0x14000
v_add_u32 v12, 0x40000, v12
ds_read_b128 a[8:11], v1 offset:18432
v_exp_f32 v30, v30
v_mfma_f32_16x16x32_bf16 v[200:203], a[40:43], v[72:75], v[200:203]
buffer_load_dwordx4 v12, s[72:75], 0 offen lds
v_mfma_f32_16x16x32_bf16 v[232:235], a[40:43], v[76:79], v[232:235]
ds_read_b128 a[12:15], v1 offset:19456
v_mfma_f32_16x16x32_bf16 v[236:239], a[44:47], v[76:79], v[236:239]
v_exp_f32 v31, v31
v_mfma_f32_16x16x32_bf16 v[204:207], a[44:47], v[72:75], v[204:207]
ds_read_b128 a[16:19], v1 offset:20480
v_cvt_pk_bf16_f32 v60, v28, v29
v_cvt_pk_bf16_f32 v61, v30, v31
v_mfma_f32_16x16x32_bf16 v[208:211], a[48:51], v[72:75], v[208:211]
ds_read_b128 a[20:23], v1 offset:21504
v_mfma_f32_16x16x32_bf16 v[240:243], a[48:51], v[76:79], v[240:243]
v_exp_f32 v40, v40
v_mfma_f32_16x16x32_bf16 v[244:247], a[52:55], v[76:79], v[244:247]
ds_read_b128 a[24:27], v1 offset:22528
v_exp_f32 v41, v41
v_mfma_f32_16x16x32_bf16 v[212:215], a[52:55], v[72:75], v[212:215]
ds_read_b128 a[28:31], v1 offset:23552
v_mfma_f32_16x16x32_bf16 v[216:219], a[56:59], v[72:75], v[216:219]
buffer_load_dwordx4 v12, s[72:75], s12 offen offset:1024 lds
v_mfma_f32_16x16x32_bf16 v[248:251], a[56:59], v[76:79], v[248:251]
v_exp_f32 v42, v42
v_mfma_f32_16x16x32_bf16 v[252:255], a[60:63], v[76:79], v[252:255]
v_exp_f32 v43, v43
v_mfma_f32_16x16x32_bf16 v[220:223], a[60:63], v[72:75], v[220:223]
v_mfma_f32_16x16x32_bf16 a[232:235], a[240:243], v[72:75], a[232:235]
v_cvt_pk_bf16_f32 v58, v40, v41
v_cvt_pk_bf16_f32 v59, v42, v43
v_mfma_f32_16x16x32_bf16 a[236:239], a[240:243], v[76:79], a[236:239]
v_exp_f32 v44, v44
s_waitcnt lgkmcnt(7)
v_mfma_f32_16x16x32_bf16 v[24:27], a[0:3], a[192:195], v[112:115]
ds_read_b128 a[32:35], v1 offset:24576
s_waitcnt lgkmcnt(7)
v_mfma_f32_16x16x32_bf16 v[24:27], a[4:7], a[196:199], v[24:27]
ds_read_b128 a[36:39], v1 offset:25600
v_exp_f32 v45, v45
s_waitcnt lgkmcnt(7)
v_mfma_f32_16x16x32_bf16 v[24:27], a[8:11], a[200:203], v[24:27]
buffer_load_dwordx4 v12, s[72:75], s13 offen offset:2048 lds
s_waitcnt lgkmcnt(6)
v_mfma_f32_16x16x32_bf16 v[24:27], a[12:15], a[204:207], v[24:27]
ds_read_b128 a[40:43], v1 offset:26624
v_exp_f32 v46, v46
v_mfma_f32_16x16x32_bf16 v[28:31], a[0:3], a[208:211], v[92:95]
v_mfma_f32_16x16x32_bf16 v[28:31], a[4:7], a[212:215], v[28:31]
ds_read_b128 a[44:47], v1 offset:27648
v_exp_f32 v47, v47
v_mfma_f32_16x16x32_bf16 v[28:31], a[8:11], a[216:219], v[28:31]
ds_read_b128 a[48:51], v1 offset:28672
v_cvt_pk_bf16_f32 v62, v44, v45
v_cvt_pk_bf16_f32 v63, v46, v47
v_mfma_f32_16x16x32_bf16 v[28:31], a[12:15], a[220:223], v[28:31]
ds_read_b128 a[52:55], v1 offset:29696
s_waitcnt lgkmcnt(9)
v_mfma_f32_16x16x32_bf16 v[40:43], a[16:19], a[192:195], v[116:119]
v_exp_f32 v24, v24
s_waitcnt lgkmcnt(8)
v_mfma_f32_16x16x32_bf16 v[40:43], a[20:23], a[196:199], v[40:43]
ds_read_b128 a[56:59], v1 offset:30720
v_exp_f32 v25, v25
s_waitcnt lgkmcnt(8)
v_mfma_f32_16x16x32_bf16 v[40:43], a[24:27], a[200:203], v[40:43]
buffer_load_dwordx4 v12, s[72:75], s14 offen offset:3072 lds
s_waitcnt lgkmcnt(7)
v_mfma_f32_16x16x32_bf16 v[40:43], a[28:31], a[204:207], v[40:43]
ds_read_b128 a[60:63], v1 offset:31744
v_mfma_f32_16x16x32_bf16 v[44:47], a[16:19], a[208:211], v[92:95]
v_exp_f32 v26, v26
v_mfma_f32_16x16x32_bf16 v[44:47], a[20:23], a[212:215], v[44:47]
v_exp_f32 v27, v27
v_mfma_f32_16x16x32_bf16 v[44:47], a[24:27], a[216:219], v[44:47]
v_mfma_f32_16x16x32_bf16 v[44:47], a[28:31], a[220:223], v[44:47]
v_cvt_pk_bf16_f32 v72, v24, v25
v_cvt_pk_bf16_f32 v73, v26, v27
v_xor_b32 v1, 0x8000, v1
s_nop 7
v_accvgpr_read_b32 v4, a224
v_accvgpr_read_b32 v6, a228
s_mov_b32 s8, 0x5f800000
v_cmp_nge_f32 s[36:37], s8, v4
v_cmp_nge_f32 s[38:39], s8, v6
v_rcp_f32 v4, v4
v_rcp_f32 v6, v6
s_or_b64 s[34:35], s[34:35], s[36:37]
s_or_b64 s[34:35], s[34:35], s[38:39]
v_pk_mul_f32 v[128:129], v[128:129], v[4:5] op_sel_hi:[1,0]
v_pk_mul_f32 v[130:131], v[130:131], v[4:5] op_sel_hi:[1,0]
v_pk_mul_f32 v[132:133], v[132:133], v[4:5] op_sel_hi:[1,0]
v_pk_mul_f32 v[134:135], v[134:135], v[4:5] op_sel_hi:[1,0]
v_cvt_pk_bf16_f32 v128, v128, v129
v_cvt_pk_bf16_f32 v129, v130, v131
v_cvt_pk_bf16_f32 v130, v132, v133
v_cvt_pk_bf16_f32 v131, v134, v135
s_add_u32 s8, s28, 0x0
buffer_store_dwordx4 v[128:131], v3, s[88:91], s8 offen sc1
v_pk_mul_f32 v[136:137], v[136:137], v[4:5] op_sel_hi:[1,0]
v_pk_mul_f32 v[138:139], v[138:139], v[4:5] op_sel_hi:[1,0]
v_pk_mul_f32 v[140:141], v[140:141], v[4:5] op_sel_hi:[1,0]
v_pk_mul_f32 v[142:143], v[142:143], v[4:5] op_sel_hi:[1,0]
v_cvt_pk_bf16_f32 v136, v136, v137
v_cvt_pk_bf16_f32 v137, v138, v139
v_cvt_pk_bf16_f32 v138, v140, v141
v_cvt_pk_bf16_f32 v139, v142, v143
s_add_u32 s8, s28, 0x2000
buffer_store_dwordx4 v[136:139], v3, s[88:91], s8 offen sc1
v_pk_mul_f32 v[144:145], v[144:145], v[4:5] op_sel_hi:[1,0]
v_pk_mul_f32 v[146:147], v[146:147], v[4:5] op_sel_hi:[1,0]
v_pk_mul_f32 v[148:149], v[148:149], v[4:5] op_sel_hi:[1,0]
v_pk_mul_f32 v[150:151], v[150:151], v[4:5] op_sel_hi:[1,0]
v_cvt_pk_bf16_f32 v144, v144, v145
v_cvt_pk_bf16_f32 v145, v146, v147
v_cvt_pk_bf16_f32 v146, v148, v149
v_cvt_pk_bf16_f32 v147, v150, v151
s_add_u32 s8, s28, 0x4000
buffer_store_dwordx4 v[144:147], v3, s[88:91], s8 offen sc1
v_pk_mul_f32 v[152:153], v[152:153], v[4:5] op_sel_hi:[1,0]
v_pk_mul_f32 v[154:155], v[154:155], v[4:5] op_sel_hi:[1,0]
v_pk_mul_f32 v[156:157], v[156:157], v[4:5] op_sel_hi:[1,0]
v_pk_mul_f32 v[158:159], v[158:159], v[4:5] op_sel_hi:[1,0]
v_cvt_pk_bf16_f32 v152, v152, v153
v_cvt_pk_bf16_f32 v153, v154, v155
v_cvt_pk_bf16_f32 v154, v156, v157
v_cvt_pk_bf16_f32 v155, v158, v159
s_add_u32 s8, s28, 0x6000
buffer_store_dwordx4 v[152:155], v3, s[88:91], s8 offen sc1
v_pk_mul_f32 v[160:161], v[160:161], v[6:7] op_sel_hi:[1,0]
v_pk_mul_f32 v[162:163], v[162:163], v[6:7] op_sel_hi:[1,0]
v_pk_mul_f32 v[164:165], v[164:165], v[6:7] op_sel_hi:[1,0]
v_pk_mul_f32 v[166:167], v[166:167], v[6:7] op_sel_hi:[1,0]
v_cvt_pk_bf16_f32 v160, v160, v161
v_cvt_pk_bf16_f32 v161, v162, v163
v_cvt_pk_bf16_f32 v162, v164, v165
v_cvt_pk_bf16_f32 v163, v166, v167
s_add_u32 s8, s29, 0x0
buffer_store_dwordx4 v[160:163], v3, s[88:91], s8 offen sc1
v_pk_mul_f32 v[168:169], v[168:169], v[6:7] op_sel_hi:[1,0]
v_pk_mul_f32 v[170:171], v[170:171], v[6:7] op_sel_hi:[1,0]
v_pk_mul_f32 v[172:173], v[172:173], v[6:7] op_sel_hi:[1,0]
v_pk_mul_f32 v[174:175], v[174:175], v[6:7] op_sel_hi:[1,0]
v_cvt_pk_bf16_f32 v168, v168, v169
v_cvt_pk_bf16_f32 v169, v170, v171
v_cvt_pk_bf16_f32 v170, v172, v173
v_cvt_pk_bf16_f32 v171, v174, v175
s_add_u32 s8, s29, 0x2000
buffer_store_dwordx4 v[168:171], v3, s[88:91], s8 offen sc1
v_pk_mul_f32 v[176:177], v[176:177], v[6:7] op_sel_hi:[1,0]
v_pk_mul_f32 v[178:179], v[178:179], v[6:7] op_sel_hi:[1,0]
v_pk_mul_f32 v[180:181], v[180:181], v[6:7] op_sel_hi:[1,0]
v_pk_mul_f32 v[182:183], v[182:183], v[6:7] op_sel_hi:[1,0]
v_cvt_pk_bf16_f32 v176, v176, v177
v_cvt_pk_bf16_f32 v177, v178, v179
v_cvt_pk_bf16_f32 v178, v180, v181
v_cvt_pk_bf16_f32 v179, v182, v183
s_add_u32 s8, s29, 0x4000
buffer_store_dwordx4 v[176:179], v3, s[88:91], s8 offen sc1
v_pk_mul_f32 v[184:185], v[184:185], v[6:7] op_sel_hi:[1,0]
v_pk_mul_f32 v[186:187], v[186:187], v[6:7] op_sel_hi:[1,0]
v_pk_mul_f32 v[188:189], v[188:189], v[6:7] op_sel_hi:[1,0]
v_pk_mul_f32 v[190:191], v[190:191], v[6:7] op_sel_hi:[1,0]
v_cvt_pk_bf16_f32 v184, v184, v185
v_cvt_pk_bf16_f32 v185, v186, v187
v_cvt_pk_bf16_f32 v186, v188, v189
v_cvt_pk_bf16_f32 v187, v190, v191
s_add_u32 s8, s29, 0x6000
buffer_store_dwordx4 v[184:187], v3, s[88:91], s8 offen sc1
s_branch L_att_h1_1
L_att_j0:
s_cmp_ge_u32 s4, 2
s_cbranch_scc1 L_att_nl0_1
L_att_nl0_0:
v_mfma_f32_16x16x32_bf16 v[16:19], a[0:3], a[160:163], v[96:99]
v_mfma_f32_16x16x32_bf16 v[16:19], a[4:7], a[164:167], v[16:19]
v_mfma_f32_16x16x32_bf16 v[16:19], a[8:11], a[168:171], v[16:19]
v_mfma_f32_16x16x32_bf16 v[16:19], a[12:15], a[172:175], v[16:19]
s_add_u32 m0, s27, 0x0
v_mfma_f32_16x16x32_bf16 v[20:23], a[0:3], a[176:179], v[84:87]
buffer_load_dwordx4 v3, s[88:91], s32 offen offset:0 sc1 lds
v_mfma_f32_16x16x32_bf16 v[20:23], a[4:7], a[180:183], v[20:23]
v_mfma_f32_16x16x32_bf16 v[20:23], a[8:11], a[184:187], v[20:23]
v_mfma_f32_16x16x32_bf16 v[20:23], a[12:15], a[188:191], v[20:23]
v_mfma_f32_16x16x32_bf16 v[24:27], a[0:3], a[192:195], v[88:91]
s_nop 0
v_exp_f32 v16, v16
v_mfma_f32_16x16x32_bf16 v[24:27], a[4:7], a[196:199], v[24:27]
v_exp_f32 v17, v17
v_mfma_f32_16x16x32_bf16 v[24:27], a[8:11], a[200:203], v[24:27]
v_exp_f32 v18, v18
v_mfma_f32_16x16x32_bf16 v[24:27], a[12:15], a[204:207], v[24:27]
v_exp_f32 v19, v19
v_mfma_f32_16x16x32_bf16 v[28:31], a[0:3], a[208:211], v[92:95]
buffer_load_dwordx4 v3, s[88:91], s32 offen offset:1024 sc1 lds
v_mfma_f32_16x16x32_bf16 v[28:31], a[4:7], a[212:215], v[28:31]
v_cvt_pk_bf16_f32 v48, v16, v17
v_cvt_pk_bf16_f32 v49, v18, v19
v_mfma_f32_16x16x32_bf16 v[28:31], a[8:11], a[216:219], v[28:31]
v_exp_f32 v20, v20
v_mfma_f32_16x16x32_bf16 v[28:31], a[12:15], a[220:223], v[28:31]
v_exp_f32 v21, v21
v_mfma_f32_16x16x32_bf16 v[32:35], a[16:19], a[160:163], v[100:103]
v_exp_f32 v22, v22
v_mfma_f32_16x16x32_bf16 v[32:35], a[20:23], a[164:167], v[32:35]
v_exp_f32 v23, v23
v_mfma_f32_16x16x32_bf16 v[32:35], a[24:27], a[168:171], v[32:35]
v_mfma_f32_16x16x32_bf16 v[32:35], a[28:31], a[172:175], v[32:35]
v_cvt_pk_bf16_f32 v52, v20, v21
v_cvt_pk_bf16_f32 v53, v22, v23
v_mfma_f32_16x16x32_bf16 v[36:39], a[16:19], a[176:179], v[84:87]
buffer_load_dwordx4 v3, s[88:91], s32 offen offset:2048 sc1 lds
v_mfma_f32_16x16x32_bf16 v[36:39], a[20:23], a[180:183], v[36:39]
v_mfma_f32_16x16x32_bf16 v[36:39], a[24:27], a[184:187], v[36:39]
v_exp_f32 v24, v24
v_mfma_f32_16x16x32_bf16 v[36:39], a[28:31], a[188:191], v[36:39]
v_mfma_f32_16x16x32_bf16 v[40:43], a[16:19], a[192:195], v[88:91]
v_exp_f32 v25, v25
v_mfma_f32_16x16x32_bf16 v[40:43], a[20:23], a[196:199], v[40:43]
v_mfma_f32_16x16x32_bf16 v[40:43], a[24:27], a[200:203], v[40:43]
v_exp_f32 v26, v26
v_mfma_f32_16x16x32_bf16 v[40:43], a[28:31], a[204:207], v[40:43]
v_mfma_f32_16x16x32_bf16 v[44:47], a[16:19], a[208:211], v[92:95]
buffer_load_dwordx4 v3, s[88:91], s32 offen offset:3072 sc1 lds
v_mfma_f32_16x16x32_bf16 v[44:47], a[20:23], a[212:215], v[44:47]
v_exp_f32 v27, v27
v_mfma_f32_16x16x32_bf16 v[44:47], a[24:27], a[216:219], v[44:47]
v_mfma_f32_16x16x32_bf16 v[44:47], a[28:31], a[220:223], v[44:47]
v_cvt_pk_bf16_f32 v56, v24, v25
v_cvt_pk_bf16_f32 v57, v26, v27
s_waitcnt lgkmcnt(0)
ds_read_b128 a[0:3], v1 offset:16384
ds_read_b128 a[4:7], v1 offset:17408
ds_read_b128 a[8:11], v1 offset:18432
ds_read_b128 a[12:15], v1 offset:19456
ds_read_b128 a[16:19], v1 offset:20480
ds_read_b128 a[20:23], v1 offset:21504
ds_read_b128 a[24:27], v1 offset:22528
ds_read_b128 a[28:31], v1 offset:23552
s_waitcnt lgkmcnt(7)
v_mfma_f32_16x16x32_bf16 v[20:23], a[0:3], a[176:179], v[84:87]
ds_read_b128 a[32:35], v1 offset:24576
v_exp_f32 v28, v28
s_waitcnt lgkmcnt(7)
v_mfma_f32_16x16x32_bf16 v[20:23], a[4:7], a[180:183], v[20:23]
v_exp_f32 v29, v29
s_waitcnt lgkmcnt(6)
v_mfma_f32_16x16x32_bf16 v[20:23], a[8:11], a[184:187], v[20:23]
s_add_u32 m0, s27, 0x1000
ds_read_b128 a[36:39], v1 offset:25600
v_exp_f32 v30, v30
s_waitcnt lgkmcnt(6)
v_mfma_f32_16x16x32_bf16 v[20:23], a[12:15], a[188:191], v[20:23]
buffer_load_dwordx4 v3, s[88:91], s7 offen offset:0 sc1 lds
v_mfma_f32_16x16x32_bf16 v[24:27], a[0:3], a[192:195], v[88:91]
v_exp_f32 v31, v31
v_mfma_f32_16x16x32_bf16 v[24:27], a[4:7], a[196:199], v[24:27]
ds_read_b128 a[40:43], v1 offset:26624
v_cvt_pk_bf16_f32 v60, v28, v29
v_cvt_pk_bf16_f32 v61, v30, v31
v_mfma_f32_16x16x32_bf16 v[24:27], a[8:11], a[200:203], v[24:27]
v_exp_f32 v32, v32
v_mfma_f32_16x16x32_bf16 v[24:27], a[12:15], a[204:207], v[24:27]
ds_read_b128 a[44:47], v1 offset:27648
v_exp_f32 v33, v33
v_mfma_f32_16x16x32_bf16 v[28:31], a[0:3], a[208:211], v[92:95]
v_exp_f32 v34, v34
v_mfma_f32_16x16x32_bf16 v[28:31], a[4:7], a[212:215], v[28:31]
buffer_load_dwordx4 v3, s[88:91], s7 offen offset:1024 sc1 lds
v_mfma_f32_16x16x32_bf16 v[28:31], a[8:11], a[216:219], v[28:31]
v_exp_f32 v35, v35
v_mfma_f32_16x16x32_bf16 v[28:31], a[12:15], a[220:223], v[28:31]
ds_read_b128 a[48:51], v1 offset:28672
v_cvt_pk_bf16_f32 v50, v32, v33
v_cvt_pk_bf16_f32 v51, v34, v35
v_exp_f32 v36, v36
s_nop 0
v_exp_f32 v37, v37
s_nop 0
v_exp_f32 v38, v38
s_nop 0
v_exp_f32 v39, v39
s_nop 0
v_cvt_pk_bf16_f32 v54, v36, v37
v_cvt_pk_bf16_f32 v55, v38, v39
s_nop 0
s_waitcnt lgkmcnt(8)
v_mfma_f32_16x16x32_bf16 v[36:39], a[16:19], a[176:179], v[84:87]
v_exp_f32 v40, v40
s_waitcnt lgkmcnt(7)
v_mfma_f32_16x16x32_bf16 v[36:39], a[20:23], a[180:183], v[36:39]
ds_read_b128 a[52:55], v1 offset:29696
v_exp_f32 v41, v41
s_waitcnt lgkmcnt(7)
v_mfma_f32_16x16x32_bf16 v[36:39], a[24:27], a[184:187], v[36:39]
v_exp_f32 v42, v42
s_waitcnt lgkmcnt(6)
v_mfma_f32_16x16x32_bf16 v[36:39], a[28:31], a[188:191], v[36:39]
buffer_load_dwordx4 v3, s[88:91], s7 offen offset:2048 sc1 lds
v_exp_f32 v43, v43
s_nop 0
v_cvt_pk_bf16_f32 v58, v40, v41
v_cvt_pk_bf16_f32 v59, v42, v43
s_nop 0
v_mfma_f32_16x16x32_bf16 v[40:43], a[16:19], a[192:195], v[88:91]
ds_read_b128 a[56:59], v1 offset:30720
v_exp_f32 v44, v44
v_mfma_f32_16x16x32_bf16 v[40:43], a[20:23], a[196:199], v[40:43]
v_exp_f32 v45, v45
v_mfma_f32_16x16x32_bf16 v[40:43], a[24:27], a[200:203], v[40:43]
ds_read_b128 a[60:63], v1 offset:31744
v_exp_f32 v46, v46
v_mfma_f32_16x16x32_bf16 v[40:43], a[28:31], a[204:207], v[40:43]
v_exp_f32 v47, v47
v_cvt_pk_bf16_f32 v62, v44, v45
v_cvt_pk_bf16_f32 v63, v46, v47
s_nop 0
v_mfma_f32_16x16x32_bf16 v[44:47], a[16:19], a[208:211], v[92:95]
v_exp_f32 v20, v20
v_mfma_f32_16x16x32_bf16 v[44:47], a[20:23], a[212:215], v[44:47]
buffer_load_dwordx4 v3, s[88:91], s7 offen offset:3072 sc1 lds
v_mfma_f32_16x16x32_bf16 v[44:47], a[24:27], a[216:219], v[44:47]
v_exp_f32 v21, v21
v_mfma_f32_16x16x32_bf16 v[44:47], a[28:31], a[220:223], v[44:47]
v_exp_f32 v22, v22
s_nop 7
v_exp_f32 v23, v23
s_nop 0
v_cvt_pk_bf16_f32 v68, v20, v21
v_cvt_pk_bf16_f32 v69, v22, v23
s_nop 0
v_exp_f32 v24, v24
s_nop 0
v_exp_f32 v25, v25
s_nop 0
v_exp_f32 v26, v26
s_nop 0
v_exp_f32 v27, v27
s_nop 0
v_cvt_pk_bf16_f32 v72, v24, v25
v_cvt_pk_bf16_f32 v73, v26, v27
s_nop 0
s_add_u32 s32, s32, 0x8000
s_add_u32 s7, s7, 0x8000
s_xor_b32 s27, s27, 0x38000
v_xor_b32 v1, 0x8000, v1
s_waitcnt vmcnt(8)
s_barrier
s_cmp_lg_u32 s33, 0
s_cbranch_scc1 L_sig_bl0
s_lshl_b32 s8, s6, 2
s_add_u32 s8, s8, 128
s_cmp_lg_u32 s4, 0
s_cbranch_scc1 L_sig_bl0
v_mov_b32 v4, 1
s_mov_b64 exec, 1
buffer_atomic_add v4, off, s[84:87], s8 sc1
s_mov_b64 exec, -1
L_sig_bl0:
s_branch L_att_l1_0
L_att_nl0_1:
v_mfma_f32_16x16x32_bf16 v[16:19], a[0:3], a[160:163], v[80:83]
v_mfma_f32_16x16x32_bf16 v[16:19], a[4:7], a[164:167], v[16:19]
v_mfma_f32_16x16x32_bf16 v[16:19], a[8:11], a[168:171], v[16:19]
v_mfma_f32_16x16x32_bf16 v[16:19], a[12:15], a[172:175], v[16:19]
s_add_u32 m0, s27, 0x0
v_mfma_f32_16x16x32_bf16 v[20:23], a[0:3], a[176:179], v[84:87]
buffer_load_dwordx4 v3, s[88:91], s32 offen offset:0 sc1 lds
v_mfma_f32_16x16x32_bf16 v[20:23], a[4:7], a[180:183], v[20:23]
v_mfma_f32_16x16x32_bf16 v[20:23], a[8:11], a[184:187], v[20:23]
v_mfma_f32_16x16x32_bf16 v[20:23], a[12:15], a[188:191], v[20:23]
v_mfma_f32_16x16x32_bf16 v[24:27], a[0:3], a[192:195], v[88:91]
s_nop 0
v_exp_f32 v16, v16
v_mfma_f32_16x16x32_bf16 v[24:27], a[4:7], a[196:199], v[24:27]
v_exp_f32 v17, v17
v_mfma_f32_16x16x32_bf16 v[24:27], a[8:11], a[200:203], v[24:27]
v_exp_f32 v18, v18
v_mfma_f32_16x16x32_bf16 v[24:27], a[12:15], a[204:207], v[24:27]
v_exp_f32 v19, v19
v_mfma_f32_16x16x32_bf16 v[28:31], a[0:3], a[208:211], v[92:95]
buffer_load_dwordx4 v3, s[88:91], s32 offen offset:1024 sc1 lds
v_mfma_f32_16x16x32_bf16 v[28:31], a[4:7], a[212:215], v[28:31]
v_cvt_pk_bf16_f32 v48, v16, v17
v_cvt_pk_bf16_f32 v49, v18, v19
v_mfma_f32_16x16x32_bf16 v[28:31], a[8:11], a[216:219], v[28:31]
v_exp_f32 v20, v20
v_mfma_f32_16x16x32_bf16 v[28:31], a[12:15], a[220:223], v[28:31]
v_exp_f32 v21, v21
v_mfma_f32_16x16x32_bf16 v[32:35], a[16:19], a[160:163], v[80:83]
v_exp_f32 v22, v22
v_mfma_f32_16x16x32_bf16 v[32:35], a[20:23], a[164:167], v[32:35]
v_exp_f32 v23, v23
v_mfma_f32_16x16x32_bf16 v[32:35], a[24:27], a[168:171], v[32:35]
v_mfma_f32_16x16x32_bf16 v[32:35], a[28:31], a[172:175], v[32:35]
v_cvt_pk_bf16_f32 v52, v20, v21
v_cvt_pk_bf16_f32 v53, v22, v23
v_mfma_f32_16x16x32_bf16 v[36:39], a[16:19], a[176:179], v[84:87]
buffer_load_dwordx4 v3, s[88:91], s32 offen offset:2048 sc1 lds
v_mfma_f32_16x16x32_bf16 v[36:39], a[20:23], a[180:183], v[36:39]
v_mfma_f32_16x16x32_bf16 v[36:39], a[24:27], a[184:187], v[36:39]
v_exp_f32 v24, v24
v_mfma_f32_16x16x32_bf16 v[36:39], a[28:31], a[188:191], v[36:39]
v_mfma_f32_16x16x32_bf16 v[40:43], a[16:19], a[192:195], v[88:91]
v_exp_f32 v25, v25
v_mfma_f32_16x16x32_bf16 v[40:43], a[20:23], a[196:199], v[40:43]
v_mfma_f32_16x16x32_bf16 v[40:43], a[24:27], a[200:203], v[40:43]
v_exp_f32 v26, v26
v_mfma_f32_16x16x32_bf16 v[40:43], a[28:31], a[204:207], v[40:43]
v_mfma_f32_16x16x32_bf16 v[44:47], a[16:19], a[208:211], v[92:95]
buffer_load_dwordx4 v3, s[88:91], s32 offen offset:3072 sc1 lds
v_mfma_f32_16x16x32_bf16 v[44:47], a[20:23], a[212:215], v[44:47]
v_exp_f32 v27, v27
v_mfma_f32_16x16x32_bf16 v[44:47], a[24:27], a[216:219], v[44:47]
v_mfma_f32_16x16x32_bf16 v[44:47], a[28:31], a[220:223], v[44:47]
v_cvt_pk_bf16_f32 v56, v24, v25
v_cvt_pk_bf16_f32 v57, v26, v27
s_waitcnt lgkmcnt(0)
ds_read_b128 a[0:3], v1 offset:16384
ds_read_b128 a[4:7], v1 offset:17408
ds_read_b128 a[8:11], v1 offset:18432
ds_read_b128 a[12:15], v1 offset:19456
ds_read_b128 a[16:19], v1 offset:20480
ds_read_b128 a[20:23], v1 offset:21504
ds_read_b128 a[24:27], v1 offset:22528
ds_read_b128 a[28:31], v1 offset:23552
s_waitcnt lgkmcnt(7)
v_mfma_f32_16x16x32_bf16 v[16:19], a[0:3], a[160:163], v[96:99]
ds_read_b128 a[32:35], v1 offset:24576
v_exp_f32 v28, v28
s_waitcnt lgkmcnt(7)
v_mfma_f32_16x16x32_bf16 v[16:19], a[4:7], a[164:167], v[16:19]
v_exp_f32 v29, v29
s_waitcnt lgkmcnt(6)
v_mfma_f32_16x16x32_bf16 v[16:19], a[8:11], a[168:171], v[16:19]
v_exp_f32 v30, v30
s_waitcnt lgkmcnt(5)
v_mfma_f32_16x16x32_bf16 v[16:19], a[12:15], a[172:175], v[16:19]
s_add_u32 m0, s27, 0x1000
ds_read_b128 a[36:39], v1 offset:25600
v_exp_f32 v31, v31
v_mfma_f32_16x16x32_bf16 v[20:23], a[0:3], a[176:179], v[84:87]
buffer_load_dwordx4 v3, s[88:91], s7 offen offset:0 sc1 lds
v_mfma_f32_16x16x32_bf16 v[20:23], a[4:7], a[180:183], v[20:23]
v_cvt_pk_bf16_f32 v60, v28, v29
v_cvt_pk_bf16_f32 v61, v30, v31
v_mfma_f32_16x16x32_bf16 v[20:23], a[8:11], a[184:187], v[20:23]
v_exp_f32 v32, v32
v_mfma_f32_16x16x32_bf16 v[20:23], a[12:15], a[188:191], v[20:23]
ds_read_b128 a[40:43], v1 offset:26624
v_exp_f32 v33, v33
v_mfma_f32_16x16x32_bf16 v[24:27], a[0:3], a[192:195], v[88:91]
v_exp_f32 v34, v34
v_mfma_f32_16x16x32_bf16 v[24:27], a[4:7], a[196:199], v[24:27]
v_exp_f32 v35, v35
v_mfma_f32_16x16x32_bf16 v[24:27], a[8:11], a[200:203], v[24:27]
ds_read_b128 a[44:47], v1 offset:27648
v_cvt_pk_bf16_f32 v50, v32, v33
v_cvt_pk_bf16_f32 v51, v34, v35
v_mfma_f32_16x16x32_bf16 v[24:27], a[12:15], a[204:207], v[24:27]
v_exp_f32 v36, v36
v_mfma_f32_16x16x32_bf16 v[28:31], a[0:3], a[208:211], v[92:95]
buffer_load_dwordx4 v3, s[88:91], s7 offen offset:1024 sc1 lds
v_mfma_f32_16x16x32_bf16 v[28:31], a[4:7], a[212:215], v[28:31]
v_exp_f32 v37, v37
v_mfma_f32_16x16x32_bf16 v[28:31], a[8:11], a[216:219], v[28:31]
ds_read_b128 a[48:51], v1 offset:28672
v_exp_f32 v38, v38
v_mfma_f32_16x16x32_bf16 v[28:31], a[12:15], a[220:223], v[28:31]
v_exp_f32 v39, v39
s_waitcnt lgkmcnt(8)
v_mfma_f32_16x16x32_bf16 v[32:35], a[16:19], a[160:163], v[100:103]
v_cvt_pk_bf16_f32 v54, v36, v37
v_cvt_pk_bf16_f32 v55, v38, v39
s_waitcnt lgkmcnt(7)
v_mfma_f32_16x16x32_bf16 v[32:35], a[20:23], a[164:167], v[32:35]
ds_read_b128 a[52:55], v1 offset:29696
v_exp_f32 v40, v40
s_waitcnt lgkmcnt(7)
v_mfma_f32_16x16x32_bf16 v[32:35], a[24:27], a[168:171], v[32:35]
v_exp_f32 v41, v41
s_waitcnt lgkmcnt(6)
v_mfma_f32_16x16x32_bf16 v[32:35], a[28:31], a[172:175], v[32:35]
v_exp_f32 v42, v42
v_mfma_f32_16x16x32_bf16 v[36:39], a[16:19], a[176:179], v[84:87]
buffer_load_dwordx4 v3, s[88:91], s7 offen offset:2048 sc1 lds
v_mfma_f32_16x16x32_bf16 v[36:39], a[20:23], a[180:183], v[36:39]
ds_read_b128 a[56:59], v1 offset:30720
v_exp_f32 v43, v43
v_mfma_f32_16x16x32_bf16 v[36:39], a[24:27], a[184:187], v[36:39]
v_cvt_pk_bf16_f32 v58, v40, v41
v_cvt_pk_bf16_f32 v59, v42, v43
v_mfma_f32_16x16x32_bf16 v[36:39], a[28:31], a[188:191], v[36:39]
v_exp_f32 v44, v44
v_mfma_f32_16x16x32_bf16 v[40:43], a[16:19], a[192:195], v[88:91]
ds_read_b128 a[60:63], v1 offset:31744
v_exp_f32 v45, v45
v_mfma_f32_16x16x32_bf16 v[40:43], a[20:23], a[196:199], v[40:43]
v_exp_f32 v46, v46
v_mfma_f32_16x16x32_bf16 v[40:43], a[24:27], a[200:203], v[40:43]
v_exp_f32 v47, v47
v_mfma_f32_16x16x32_bf16 v[40:43], a[28:31], a[204:207], v[40:43]
v_cvt_pk_bf16_f32 v62, v44, v45
v_cvt_pk_bf16_f32 v63, v46, v47
v_mfma_f32_16x16x32_bf16 v[44:47], a[16:19], a[208:211], v[92:95]
buffer_load_dwordx4 v3, s[88:91], s7 offen offset:3072 sc1 lds
v_mfma_f32_16x16x32_bf16 v[44:47], a[20:23], a[212:215], v[44:47]
v_exp_f32 v16, v16
v_mfma_f32_16x16x32_bf16 v[44:47], a[24:27], a[216:219], v[44:47]
v_exp_f32 v17, v17
v_mfma_f32_16x16x32_bf16 v[44:47], a[28:31], a[220:223], v[44:47]
v_exp_f32 v18, v18
s_nop 7
v_exp_f32 v19, v19
s_nop 0
v_cvt_pk_bf16_f32 v64, v16, v17
v_cvt_pk_bf16_f32 v65, v18, v19
s_nop 0
v_exp_f32 v20, v20
s_nop 0
v_exp_f32 v21, v21
s_nop 0
v_exp_f32 v22, v22
s_nop 0
v_exp_f32 v23, v23
s_nop 0
v_cvt_pk_bf16_f32 v68, v20, v21
v_cvt_pk_bf16_f32 v69, v22, v23
s_nop 0
v_exp_f32 v24, v24
s_nop 0
v_exp_f32 v25, v25
s_nop 0
v_exp_f32 v26, v26
s_nop 0
v_exp_f32 v27, v27
s_nop 0
v_cvt_pk_bf16_f32 v72, v24, v25
v_cvt_pk_bf16_f32 v73, v26, v27
s_nop 0
s_add_u32 s32, s32, 0x8000
s_add_u32 s7, s7, 0x8000
s_xor_b32 s27, s27, 0x38000
v_xor_b32 v1, 0x8000, v1
s_waitcnt vmcnt(8)
s_barrier
s_cmp_lg_u32 s33, 0
s_cbranch_scc1 L_sig_bl1
s_lshl_b32 s8, s6, 2
s_add_u32 s8, s8, 128
s_cmp_lg_u32 s4, 0
s_cbranch_scc1 L_sig_bl1
v_mov_b32 v4, 1
s_mov_b64 exec, 1
buffer_atomic_add v4, off, s[84:87], s8 sc1
s_mov_b64 exec, -1
L_sig_bl1:
s_branch L_att_l1_1
L_att_seven:
s_waitcnt vmcnt(16) lgkmcnt(0)
s_barrier
v_mfma_f32_16x16x32_bf16 v[192:195], a[32:35], v[56:59], v[192:195]
ds_read_b128 a[0:3], v1 offset:0
v_exp_f32 v28, v28
v_mfma_f32_16x16x32_bf16 v[224:227], a[32:35], v[60:63], v[224:227]
ds_read_b128 a[4:7], v1 offset:1024
v_mfma_f32_16x16x32_bf16 v[228:231], a[36:39], v[60:63], v[228:231]
v_exp_f32 v29, v29
v_mfma_f32_16x16x32_bf16 v[196:199], a[36:39], v[56:59], v[196:199]
s_add_u32 m0, s27, 0x0
ds_read_b128 a[8:11], v1 offset:2048
v_exp_f32 v30, v30
v_mfma_f32_16x16x32_bf16 v[200:203], a[40:43], v[56:59], v[200:203]
buffer_load_dwordx4 v3, s[88:91], s32 offen offset:0 sc1 lds
v_mfma_f32_16x16x32_bf16 v[232:235], a[40:43], v[60:63], v[232:235]
ds_read_b128 a[12:15], v1 offset:3072
v_mfma_f32_16x16x32_bf16 v[236:239], a[44:47], v[60:63], v[236:239]
v_exp_f32 v31, v31
v_mfma_f32_16x16x32_bf16 v[204:207], a[44:47], v[56:59], v[204:207]
ds_read_b128 a[16:19], v1 offset:4096
v_cvt_pk_bf16_f32 v76, v28, v29
v_cvt_pk_bf16_f32 v77, v30, v31
v_mfma_f32_16x16x32_bf16 v[208:211], a[48:51], v[56:59], v[208:211]
ds_read_b128 a[20:23], v1 offset:5120
v_mfma_f32_16x16x32_bf16 v[240:243], a[48:51], v[60:63], v[240:243]
v_exp_f32 v40, v40
v_mfma_f32_16x16x32_bf16 v[244:247], a[52:55], v[60:63], v[244:247]
ds_read_b128 a[24:27], v1 offset:6144
v_exp_f32 v41, v41
v_mfma_f32_16x16x32_bf16 v[212:215], a[52:55], v[56:59], v[212:215]
ds_read_b128 a[28:31], v1 offset:7168
v_mfma_f32_16x16x32_bf16 v[216:219], a[56:59], v[56:59], v[216:219]
buffer_load_dwordx4 v3, s[88:91], s32 offen offset:1024 sc1 lds
v_mfma_f32_16x16x32_bf16 v[248:251], a[56:59], v[60:63], v[248:251]
v_exp_f32 v42, v42
v_mfma_f32_16x16x32_bf16 v[252:255], a[60:63], v[60:63], v[252:255]
v_exp_f32 v43, v43
v_mfma_f32_16x16x32_bf16 v[220:223], a[60:63], v[56:59], v[220:223]
v_mfma_f32_16x16x32_bf16 a[232:235], a[240:243], v[56:59], a[232:235]
v_cvt_pk_bf16_f32 v74, v40, v41
v_cvt_pk_bf16_f32 v75, v42, v43
v_mfma_f32_16x16x32_bf16 a[236:239], a[240:243], v[60:63], a[236:239]
v_exp_f32 v44, v44
s_waitcnt lgkmcnt(7)
v_mfma_f32_16x16x32_bf16 v[24:27], a[0:3], a[192:195], v[88:91]
ds_read_b128 a[32:35], v1 offset:8192
s_waitcnt lgkmcnt(7)
v_mfma_f32_16x16x32_bf16 v[24:27], a[4:7], a[196:199], v[24:27]
ds_read_b128 a[36:39], v1 offset:9216
v_exp_f32 v45, v45
s_waitcnt lgkmcnt(7)
v_mfma_f32_16x16x32_bf16 v[24:27], a[8:11], a[200:203], v[24:27]
buffer_load_dwordx4 v3, s[88:91], s32 offen offset:2048 sc1 lds
s_waitcnt lgkmcnt(6)
v_mfma_f32_16x16x32_bf16 v[24:27], a[12:15], a[204:207], v[24:27]
ds_read_b128 a[40:43], v1 offset:10240
v_exp_f32 v46, v46
v_mfma_f32_16x16x32_bf16 v[28:31], a[0:3], a[208:211], v[92:95]
v_mfma_f32_16x16x32_bf16 v[28:31], a[4:7], a[212:215], v[28:31]
ds_read_b128 a[44:47], v1 offset:11264
v_exp_f32 v47, v47
v_mfma_f32_16x16x32_bf16 v[28:31], a[8:11], a[216:219], v[28:31]
ds_read_b128 a[48:51], v1 offset:12288
v_cvt_pk_bf16_f32 v78, v44, v45
v_cvt_pk_bf16_f32 v79, v46, v47
v_mfma_f32_16x16x32_bf16 v[28:31], a[12:15], a[220:223], v[28:31]
ds_read_b128 a[52:55], v1 offset:13312
s_waitcnt lgkmcnt(9)
v_mfma_f32_16x16x32_bf16 v[40:43], a[16:19], a[192:195], v[88:91]
v_exp_f32 v24, v24
s_waitcnt lgkmcnt(8)
v_mfma_f32_16x16x32_bf16 v[40:43], a[20:23], a[196:199], v[40:43]
ds_read_b128 a[56:59], v1 offset:14336
v_exp_f32 v25, v25
s_waitcnt lgkmcnt(8)
v_mfma_f32_16x16x32_bf16 v[40:43], a[24:27], a[200:203], v[40:43]
buffer_load_dwordx4 v3, s[88:91], s32 offen offset:3072 sc1 lds
s_waitcnt lgkmcnt(7)
v_mfma_f32_16x16x32_bf16 v[40:43], a[28:31], a[204:207], v[40:43]
ds_read_b128 a[60:63], v1 offset:15360
v_mfma_f32_16x16x32_bf16 v[44:47], a[16:19], a[208:211], v[92:95]
v_exp_f32 v26, v26
v_mfma_f32_16x16x32_bf16 v[44:47], a[20:23], a[212:215], v[44:47]
v_exp_f32 v27, v27
v_mfma_f32_16x16x32_bf16 v[44:47], a[24:27], a[216:219], v[44:47]
v_mfma_f32_16x16x32_bf16 v[44:47], a[28:31], a[220:223], v[44:47]
v_cvt_pk_bf16_f32 v56, v24, v25
v_cvt_pk_bf16_f32 v57, v26, v27
s_waitcnt lgkmcnt(0)
v_mfma_f32_16x16x32_bf16 v[192:195], a[32:35], v[72:75], v[192:195]
ds_read_b128 a[0:3], v1 offset:16384
v_exp_f32 v28, v28
v_mfma_f32_16x16x32_bf16 v[224:227], a[32:35], v[76:79], v[224:227]
ds_read_b128 a[4:7], v1 offset:17408
v_mfma_f32_16x16x32_bf16 v[228:231], a[36:39], v[76:79], v[228:231]
v_exp_f32 v29, v29
v_mfma_f32_16x16x32_bf16 v[196:199], a[36:39], v[72:75], v[196:199]
s_add_u32 m0, s27, 0x1000
ds_read_b128 a[8:11], v1 offset:18432
v_exp_f32 v30, v30
v_mfma_f32_16x16x32_bf16 v[200:203], a[40:43], v[72:75], v[200:203]
buffer_load_dwordx4 v3, s[88:91], s7 offen offset:0 sc1 lds
v_mfma_f32_16x16x32_bf16 v[232:235], a[40:43], v[76:79], v[232:235]
ds_read_b128 a[12:15], v1 offset:19456
v_mfma_f32_16x16x32_bf16 v[236:239], a[44:47], v[76:79], v[236:239]
v_exp_f32 v31, v31
v_mfma_f32_16x16x32_bf16 v[204:207], a[44:47], v[72:75], v[204:207]
ds_read_b128 a[16:19], v1 offset:20480
v_cvt_pk_bf16_f32 v60, v28, v29
v_cvt_pk_bf16_f32 v61, v30, v31
v_mfma_f32_16x16x32_bf16 v[208:211], a[48:51], v[72:75], v[208:211]
ds_read_b128 a[20:23], v1 offset:21504
v_mfma_f32_16x16x32_bf16 v[240:243], a[48:51], v[76:79], v[240:243]
v_exp_f32 v40, v40
v_mfma_f32_16x16x32_bf16 v[244:247], a[52:55], v[76:79], v[244:247]
ds_read_b128 a[24:27], v1 offset:22528
v_exp_f32 v41, v41
v_mfma_f32_16x16x32_bf16 v[212:215], a[52:55], v[72:75], v[212:215]
ds_read_b128 a[28:31], v1 offset:23552
v_mfma_f32_16x16x32_bf16 v[216:219], a[56:59], v[72:75], v[216:219]
buffer_load_dwordx4 v3, s[88:91], s7 offen offset:1024 sc1 lds
v_mfma_f32_16x16x32_bf16 v[248:251], a[56:59], v[76:79], v[248:251]
v_exp_f32 v42, v42
v_mfma_f32_16x16x32_bf16 v[252:255], a[60:63], v[76:79], v[252:255]
v_exp_f32 v43, v43
v_mfma_f32_16x16x32_bf16 v[220:223], a[60:63], v[72:75], v[220:223]
v_mfma_f32_16x16x32_bf16 a[232:235], a[240:243], v[72:75], a[232:235]
v_cvt_pk_bf16_f32 v58, v40, v41
v_cvt_pk_bf16_f32 v59, v42, v43
v_mfma_f32_16x16x32_bf16 a[236:239], a[240:243], v[76:79], a[236:239]
v_exp_f32 v44, v44
s_waitcnt lgkmcnt(7)
v_mfma_f32_16x16x32_bf16 v[24:27], a[0:3], a[192:195], v[88:91]
ds_read_b128 a[32:35], v1 offset:24576
s_waitcnt lgkmcnt(7)
v_mfma_f32_16x16x32_bf16 v[24:27], a[4:7], a[196:199], v[24:27]
ds_read_b128 a[36:39], v1 offset:25600
v_exp_f32 v45, v45
s_waitcnt lgkmcnt(7)
v_mfma_f32_16x16x32_bf16 v[24:27], a[8:11], a[200:203], v[24:27]
buffer_load_dwordx4 v3, s[88:91], s7 offen offset:2048 sc1 lds
s_waitcnt lgkmcnt(6)
v_mfma_f32_16x16x32_bf16 v[24:27], a[12:15], a[204:207], v[24:27]
ds_read_b128 a[40:43], v1 offset:26624
v_exp_f32 v46, v46
v_mfma_f32_16x16x32_bf16 v[28:31], a[0:3], a[208:211], v[92:95]
v_mfma_f32_16x16x32_bf16 v[28:31], a[4:7], a[212:215], v[28:31]
ds_read_b128 a[44:47], v1 offset:27648
v_exp_f32 v47, v47
v_mfma_f32_16x16x32_bf16 v[28:31], a[8:11], a[216:219], v[28:31]
ds_read_b128 a[48:51], v1 offset:28672
v_cvt_pk_bf16_f32 v62, v44, v45
v_cvt_pk_bf16_f32 v63, v46, v47
v_mfma_f32_16x16x32_bf16 v[28:31], a[12:15], a[220:223], v[28:31]
ds_read_b128 a[52:55], v1 offset:29696
s_waitcnt lgkmcnt(9)
v_mfma_f32_16x16x32_bf16 v[40:43], a[16:19], a[192:195], v[88:91]
v_exp_f32 v24, v24
s_waitcnt lgkmcnt(8)
v_mfma_f32_16x16x32_bf16 v[40:43], a[20:23], a[196:199], v[40:43]
ds_read_b128 a[56:59], v1 offset:30720
v_exp_f32 v25, v25
s_waitcnt lgkmcnt(8)
v_mfma_f32_16x16x32_bf16 v[40:43], a[24:27], a[200:203], v[40:43]
buffer_load_dwordx4 v3, s[88:91], s7 offen offset:3072 sc1 lds
s_waitcnt lgkmcnt(7)
v_mfma_f32_16x16x32_bf16 v[40:43], a[28:31], a[204:207], v[40:43]
ds_read_b128 a[60:63], v1 offset:31744
v_mfma_f32_16x16x32_bf16 v[44:47], a[16:19], a[208:211], v[92:95]
v_exp_f32 v26, v26
v_mfma_f32_16x16x32_bf16 v[44:47], a[20:23], a[212:215], v[44:47]
v_exp_f32 v27, v27
v_mfma_f32_16x16x32_bf16 v[44:47], a[24:27], a[216:219], v[44:47]
v_mfma_f32_16x16x32_bf16 v[44:47], a[28:31], a[220:223], v[44:47]
v_cvt_pk_bf16_f32 v72, v24, v25
v_cvt_pk_bf16_f32 v73, v26, v27
s_add_u32 s32, s32, 0x8000
s_add_u32 s7, s7, 0x8000
s_xor_b32 s27, s27, 0x38000
v_xor_b32 v1, 0x8000, v1
L_att_sodd:
s_waitcnt vmcnt(16) lgkmcnt(0)
s_barrier
v_mfma_f32_16x16x32_bf16 v[192:195], a[32:35], v[56:59], v[192:195]
ds_read_b128 a[0:3], v2 offset:0
v_exp_f32 v28, v28
v_mfma_f32_16x16x32_bf16 v[224:227], a[32:35], v[60:63], v[224:227]
ds_read_b128 a[4:7], v2 offset:1024
v_mfma_f32_16x16x32_bf16 v[228:231], a[36:39], v[60:63], v[228:231]
v_exp_f32 v29, v29
v_mfma_f32_16x16x32_bf16 v[196:199], a[36:39], v[56:59], v[196:199]
s_add_u32 m0, s19, 0x0
ds_read_b128 a[8:11], v2 offset:2048
v_exp_f32 v30, v30
v_mfma_f32_16x16x32_bf16 v[200:203], a[40:43], v[56:59], v[200:203]
buffer_load_dwordx4 v3, s[88:91], s32 offen offset:0 sc1 lds
v_mfma_f32_16x16x32_bf16 v[232:235], a[40:43], v[60:63], v[232:235]
ds_read_b128 a[12:15], v2 offset:3072
v_mfma_f32_16x16x32_bf16 v[236:239], a[44:47], v[60:63], v[236:239]
v_exp_f32 v31, v31
v_mfma_f32_16x16x32_bf16 v[204:207], a[44:47], v[56:59], v[204:207]
ds_read_b128 a[16:19], v2 offset:4096
v_cvt_pk_bf16_f32 v76, v28, v29
v_cvt_pk_bf16_f32 v77, v30, v31
v_mfma_f32_16x16x32_bf16 v[208:211], a[48:51], v[56:59], v[208:211]
ds_read_b128 a[20:23], v2 offset:5120
v_mfma_f32_16x16x32_bf16 v[240:243], a[48:51], v[60:63], v[240:243]
v_exp_f32 v40, v40
v_mfma_f32_16x16x32_bf16 v[244:247], a[52:55], v[60:63], v[244:247]
ds_read_b128 a[24:27], v2 offset:6144
v_exp_f32 v41, v41
v_mfma_f32_16x16x32_bf16 v[212:215], a[52:55], v[56:59], v[212:215]
ds_read_b128 a[28:31], v2 offset:7168
v_mfma_f32_16x16x32_bf16 v[216:219], a[56:59], v[56:59], v[216:219]
buffer_load_dwordx4 v3, s[88:91], s32 offen offset:1024 sc1 lds
v_mfma_f32_16x16x32_bf16 v[248:251], a[56:59], v[60:63], v[248:251]
v_exp_f32 v42, v42
v_mfma_f32_16x16x32_bf16 v[252:255], a[60:63], v[60:63], v[252:255]
v_exp_f32 v43, v43
v_mfma_f32_16x16x32_bf16 v[220:223], a[60:63], v[56:59], v[220:223]
v_mfma_f32_16x16x32_bf16 a[232:235], a[240:243], v[56:59], a[232:235]
v_cvt_pk_bf16_f32 v74, v40, v41
v_cvt_pk_bf16_f32 v75, v42, v43
v_mfma_f32_16x16x32_bf16 a[236:239], a[240:243], v[60:63], a[236:239]
v_exp_f32 v44, v44
s_waitcnt lgkmcnt(7)
v_mfma_f32_16x16x32_bf16 v[24:27], a[0:3], a[192:195], v[88:91]
ds_read_b128 a[32:35], v2 offset:8192
s_waitcnt lgkmcnt(7)
v_mfma_f32_16x16x32_bf16 v[24:27], a[4:7], a[196:199], v[24:27]
ds_read_b128 a[36:39], v2 offset:9216
v_exp_f32 v45, v45
s_waitcnt lgkmcnt(7)
v_mfma_f32_16x16x32_bf16 v[24:27], a[8:11], a[200:203], v[24:27]
buffer_load_dwordx4 v3, s[88:91], s32 offen offset:2048 sc1 lds
s_waitcnt lgkmcnt(6)
v_mfma_f32_16x16x32_bf16 v[24:27], a[12:15], a[204:207], v[24:27]
ds_read_b128 a[40:43], v2 offset:10240
v_exp_f32 v46, v46
v_mfma_f32_16x16x32_bf16 v[28:31], a[0:3], a[208:211], v[92:95]
v_mfma_f32_16x16x32_bf16 v[28:31], a[4:7], a[212:215], v[28:31]
ds_read_b128 a[44:47], v2 offset:11264
v_exp_f32 v47, v47
v_mfma_f32_16x16x32_bf16 v[28:31], a[8:11], a[216:219], v[28:31]
ds_read_b128 a[48:51], v2 offset:12288
v_cvt_pk_bf16_f32 v78, v44, v45
v_cvt_pk_bf16_f32 v79, v46, v47
v_mfma_f32_16x16x32_bf16 v[28:31], a[12:15], a[220:223], v[28:31]
ds_read_b128 a[52:55], v2 offset:13312
s_waitcnt lgkmcnt(9)
v_mfma_f32_16x16x32_bf16 v[40:43], a[16:19], a[192:195], v[88:91]
v_exp_f32 v24, v24
s_waitcnt lgkmcnt(8)
v_mfma_f32_16x16x32_bf16 v[40:43], a[20:23], a[196:199], v[40:43]
ds_read_b128 a[56:59], v2 offset:14336
v_exp_f32 v25, v25
s_waitcnt lgkmcnt(8)
v_mfma_f32_16x16x32_bf16 v[40:43], a[24:27], a[200:203], v[40:43]
buffer_load_dwordx4 v3, s[88:91], s32 offen offset:3072 sc1 lds
s_waitcnt lgkmcnt(7)
v_mfma_f32_16x16x32_bf16 v[40:43], a[28:31], a[204:207], v[40:43]
ds_read_b128 a[60:63], v2 offset:15360
v_mfma_f32_16x16x32_bf16 v[44:47], a[16:19], a[208:211], v[92:95]
v_exp_f32 v26, v26
v_mfma_f32_16x16x32_bf16 v[44:47], a[20:23], a[212:215], v[44:47]
v_exp_f32 v27, v27
v_mfma_f32_16x16x32_bf16 v[44:47], a[24:27], a[216:219], v[44:47]
v_mfma_f32_16x16x32_bf16 v[44:47], a[28:31], a[220:223], v[44:47]
v_cvt_pk_bf16_f32 v56, v24, v25
v_cvt_pk_bf16_f32 v57, v26, v27
s_waitcnt lgkmcnt(0)
v_mfma_f32_16x16x32_bf16 v[192:195], a[32:35], v[72:75], v[192:195]
ds_read_b128 a[0:3], v2 offset:16384
v_exp_f32 v28, v28
v_mfma_f32_16x16x32_bf16 v[224:227], a[32:35], v[76:79], v[224:227]
ds_read_b128 a[4:7], v2 offset:17408
v_mfma_f32_16x16x32_bf16 v[228:231], a[36:39], v[76:79], v[228:231]
v_exp_f32 v29, v29
v_mfma_f32_16x16x32_bf16 v[196:199], a[36:39], v[72:75], v[196:199]
s_add_u32 m0, s19, 0x1000
ds_read_b128 a[8:11], v2 offset:18432
v_exp_f32 v30, v30
v_mfma_f32_16x16x32_bf16 v[200:203], a[40:43], v[72:75], v[200:203]
buffer_load_dwordx4 v3, s[88:91], s7 offen offset:0 sc1 lds
v_mfma_f32_16x16x32_bf16 v[232:235], a[40:43], v[76:79], v[232:235]
ds_read_b128 a[12:15], v2 offset:19456
v_mfma_f32_16x16x32_bf16 v[236:239], a[44:47], v[76:79], v[236:239]
v_exp_f32 v31, v31
v_mfma_f32_16x16x32_bf16 v[204:207], a[44:47], v[72:75], v[204:207]
ds_read_b128 a[16:19], v2 offset:20480
v_cvt_pk_bf16_f32 v60, v28, v29
v_cvt_pk_bf16_f32 v61, v30, v31
v_mfma_f32_16x16x32_bf16 v[208:211], a[48:51], v[72:75], v[208:211]
ds_read_b128 a[20:23], v2 offset:21504
v_mfma_f32_16x16x32_bf16 v[240:243], a[48:51], v[76:79], v[240:243]
v_exp_f32 v40, v40
v_mfma_f32_16x16x32_bf16 v[244:247], a[52:55], v[76:79], v[244:247]
ds_read_b128 a[24:27], v2 offset:22528
v_exp_f32 v41, v41
v_mfma_f32_16x16x32_bf16 v[212:215], a[52:55], v[72:75], v[212:215]
ds_read_b128 a[28:31], v2 offset:23552
v_mfma_f32_16x16x32_bf16 v[216:219], a[56:59], v[72:75], v[216:219]
buffer_load_dwordx4 v3, s[88:91], s7 offen offset:1024 sc1 lds
v_mfma_f32_16x16x32_bf16 v[248:251], a[56:59], v[76:79], v[248:251]
v_exp_f32 v42, v42
v_mfma_f32_16x16x32_bf16 v[252:255], a[60:63], v[76:79], v[252:255]
v_exp_f32 v43, v43
v_mfma_f32_16x16x32_bf16 v[220:223], a[60:63], v[72:75], v[220:223]
v_mfma_f32_16x16x32_bf16 a[232:235], a[240:243], v[72:75], a[232:235]
v_cvt_pk_bf16_f32 v58, v40, v41
v_cvt_pk_bf16_f32 v59, v42, v43
v_mfma_f32_16x16x32_bf16 a[236:239], a[240:243], v[76:79], a[236:239]
v_exp_f32 v44, v44
s_waitcnt lgkmcnt(7)
v_mfma_f32_16x16x32_bf16 v[24:27], a[0:3], a[192:195], v[88:91]
ds_read_b128 a[32:35], v2 offset:24576
s_waitcnt lgkmcnt(7)
v_mfma_f32_16x16x32_bf16 v[24:27], a[4:7], a[196:199], v[24:27]
ds_read_b128 a[36:39], v2 offset:25600
v_exp_f32 v45, v45
s_waitcnt lgkmcnt(7)
v_mfma_f32_16x16x32_bf16 v[24:27], a[8:11], a[200:203], v[24:27]
buffer_load_dwordx4 v3, s[88:91], s7 offen offset:2048 sc1 lds
s_waitcnt lgkmcnt(6)
v_mfma_f32_16x16x32_bf16 v[24:27], a[12:15], a[204:207], v[24:27]
ds_read_b128 a[40:43], v2 offset:26624
v_exp_f32 v46, v46
v_mfma_f32_16x16x32_bf16 v[28:31], a[0:3], a[208:211], v[92:95]
v_mfma_f32_16x16x32_bf16 v[28:31], a[4:7], a[212:215], v[28:31]
ds_read_b128 a[44:47], v2 offset:27648
v_exp_f32 v47, v47
v_mfma_f32_16x16x32_bf16 v[28:31], a[8:11], a[216:219], v[28:31]
ds_read_b128 a[48:51], v2 offset:28672
v_cvt_pk_bf16_f32 v62, v44, v45
v_cvt_pk_bf16_f32 v63, v46, v47
v_mfma_f32_16x16x32_bf16 v[28:31], a[12:15], a[220:223], v[28:31]
ds_read_b128 a[52:55], v2 offset:29696
s_waitcnt lgkmcnt(9)
v_mfma_f32_16x16x32_bf16 v[40:43], a[16:19], a[192:195], v[88:91]
v_exp_f32 v24, v24
s_waitcnt lgkmcnt(8)
v_mfma_f32_16x16x32_bf16 v[40:43], a[20:23], a[196:199], v[40:43]
ds_read_b128 a[56:59], v2 offset:30720
v_exp_f32 v25, v25
s_waitcnt lgkmcnt(8)
v_mfma_f32_16x16x32_bf16 v[40:43], a[24:27], a[200:203], v[40:43]
buffer_load_dwordx4 v3, s[88:91], s7 offen offset:3072 sc1 lds
s_waitcnt lgkmcnt(7)
v_mfma_f32_16x16x32_bf16 v[40:43], a[28:31], a[204:207], v[40:43]
ds_read_b128 a[60:63], v2 offset:31744
v_mfma_f32_16x16x32_bf16 v[44:47], a[16:19], a[208:211], v[92:95]
v_exp_f32 v26, v26
v_mfma_f32_16x16x32_bf16 v[44:47], a[20:23], a[212:215], v[44:47]
v_exp_f32 v27, v27
v_mfma_f32_16x16x32_bf16 v[44:47], a[24:27], a[216:219], v[44:47]
v_mfma_f32_16x16x32_bf16 v[44:47], a[28:31], a[220:223], v[44:47]
v_cvt_pk_bf16_f32 v72, v24, v25
v_cvt_pk_bf16_f32 v73, v26, v27
s_add_u32 s32, s32, 0x8000
s_add_u32 s7, s7, 0x8000
s_xor_b32 s19, s19, 0x8000
v_xor_b32 v2, 0x38000, v2
s_sub_u32 s15, s15, 1
s_cmp_lg_u32 s15, 0
s_cbranch_scc1 L_att_seven
s_cmp_ge_u32 s4, 2
s_cbranch_scc1 L_att_sh0_1
L_att_sh0_0:
s_waitcnt vmcnt(16) lgkmcnt(0)
s_barrier
s_and_b32 s8, s2, 7
s_lshr_b32 s9, s2, 3
s_lshr_b32 s99, s8, 1
s_lshl_b32 s99, s99, 2
s_lshr_b32 s10, s9, 3
s_add_u32 s99, s99, s10
s_and_b32 s100, s8, 1
s_lshl_b32 s100, s100, 3
s_and_b32 s10, s9, 7
s_add_u32 s100, s100, s10
s_sub_u32 s10, 15, s99
s_min_u32 s10, s10, s99
s_lshl_b32 s11, s10, 7
s_add_u32 s11, s11, 0x3604000
s_lshl_b32 s10, s10, 2
s_add_u32 s10, s10, 128
buffer_load_dword v13, off, s[84:87], s10 sc1
s_mov_b32 s12, 15360
s_mov_b32 s13, 30720
s_mov_b32 s14, 46080
v_lshrrev_b32 v14, 4, v0
v_bfe_u32 v15, v0, 1, 2
v_xor_b32 v14, v14, v15
v_lshlrev_b32 v14, 5, v14
v_and_b32 v15, 1, v0
v_lshl_add_u32 v14, v15, 4, v14
v_lshrrev_b32 v15, 3, v0
v_lshl_add_u32 v14, v15, 11, v14
s_lshl_b32 s8, s4, 16
s_lshl_b32 s9, s100, 7
s_add_u32 s8, s8, s9
v_add_u32 v12, s8, v14
s_mul_i32 s101, s99, 0x140000
s_lshl_b32 s8, s4, 11
s_add_u32 s101, s101, s8
s_add_u32 s101, s101, 0x21fe000
v_mfma_f32_16x16x32_bf16 v[192:195], a[32:35], v[56:59], v[192:195]
ds_read_b128 a[0:3], v1 offset:0
v_exp_f32 v28, v28
v_mfma_f32_16x16x32_bf16 v[224:227], a[32:35], v[60:63], v[224:227]
ds_read_b128 a[4:7], v1 offset:1024
v_mfma_f32_16x16x32_bf16 v[228:231], a[36:39], v[60:63], v[228:231]
v_exp_f32 v29, v29
v_mfma_f32_16x16x32_bf16 v[196:199], a[36:39], v[56:59], v[196:199]
s_add_u32 m0, s17, 0x10000
ds_read_b128 a[8:11], v1 offset:2048
v_exp_f32 v30, v30
v_mfma_f32_16x16x32_bf16 v[200:203], a[40:43], v[56:59], v[200:203]
buffer_load_dwordx4 v12, s[72:75], 0 offen lds
v_mfma_f32_16x16x32_bf16 v[232:235], a[40:43], v[60:63], v[232:235]
ds_read_b128 a[12:15], v1 offset:3072
v_mfma_f32_16x16x32_bf16 v[236:239], a[44:47], v[60:63], v[236:239]
v_exp_f32 v31, v31
v_mfma_f32_16x16x32_bf16 v[204:207], a[44:47], v[56:59], v[204:207]
ds_read_b128 a[16:19], v1 offset:4096
v_cvt_pk_bf16_f32 v76, v28, v29
v_cvt_pk_bf16_f32 v77, v30, v31
v_mfma_f32_16x16x32_bf16 v[208:211], a[48:51], v[56:59], v[208:211]
ds_read_b128 a[20:23], v1 offset:5120
v_mfma_f32_16x16x32_bf16 v[240:243], a[48:51], v[60:63], v[240:243]
v_exp_f32 v40, v40
v_mfma_f32_16x16x32_bf16 v[244:247], a[52:55], v[60:63], v[244:247]
ds_read_b128 a[24:27], v1 offset:6144
v_exp_f32 v41, v41
v_mfma_f32_16x16x32_bf16 v[212:215], a[52:55], v[56:59], v[212:215]
ds_read_b128 a[28:31], v1 offset:7168
v_mfma_f32_16x16x32_bf16 v[216:219], a[56:59], v[56:59], v[216:219]
buffer_load_dwordx4 v12, s[72:75], s12 offen offset:1024 lds
v_mfma_f32_16x16x32_bf16 v[248:251], a[56:59], v[60:63], v[248:251]
v_exp_f32 v42, v42
v_mfma_f32_16x16x32_bf16 v[252:255], a[60:63], v[60:63], v[252:255]
v_exp_f32 v43, v43
v_mfma_f32_16x16x32_bf16 v[220:223], a[60:63], v[56:59], v[220:223]
v_mfma_f32_16x16x32_bf16 a[232:235], a[240:243], v[56:59], a[232:235]
v_cvt_pk_bf16_f32 v74, v40, v41
v_cvt_pk_bf16_f32 v75, v42, v43
v_mfma_f32_16x16x32_bf16 a[236:239], a[240:243], v[60:63], a[236:239]
v_exp_f32 v44, v44
s_waitcnt lgkmcnt(7)
v_mfma_f32_16x16x32_bf16 v[24:27], a[0:3], a[192:195], v[112:115]
ds_read_b128 a[32:35], v1 offset:8192
s_waitcnt lgkmcnt(7)
v_mfma_f32_16x16x32_bf16 v[24:27], a[4:7], a[196:199], v[24:27]
ds_read_b128 a[36:39], v1 offset:9216
v_exp_f32 v45, v45
s_waitcnt lgkmcnt(7)
v_mfma_f32_16x16x32_bf16 v[24:27], a[8:11], a[200:203], v[24:27]
buffer_load_dwordx4 v12, s[72:75], s13 offen offset:2048 lds
s_waitcnt lgkmcnt(6)
v_mfma_f32_16x16x32_bf16 v[24:27], a[12:15], a[204:207], v[24:27]
ds_read_b128 a[40:43], v1 offset:10240
v_exp_f32 v46, v46
v_mfma_f32_16x16x32_bf16 v[28:31], a[0:3], a[208:211], v[92:95]
v_mfma_f32_16x16x32_bf16 v[28:31], a[4:7], a[212:215], v[28:31]
ds_read_b128 a[44:47], v1 offset:11264
v_exp_f32 v47, v47
v_mfma_f32_16x16x32_bf16 v[28:31], a[8:11], a[216:219], v[28:31]
ds_read_b128 a[48:51], v1 offset:12288
v_cvt_pk_bf16_f32 v78, v44, v45
v_cvt_pk_bf16_f32 v79, v46, v47
v_mfma_f32_16x16x32_bf16 v[28:31], a[12:15], a[220:223], v[28:31]
ds_read_b128 a[52:55], v1 offset:13312
s_waitcnt lgkmcnt(9)
v_mfma_f32_16x16x32_bf16 v[40:43], a[16:19], a[192:195], v[116:119]
v_exp_f32 v24, v24
s_waitcnt lgkmcnt(8)
v_mfma_f32_16x16x32_bf16 v[40:43], a[20:23], a[196:199], v[40:43]
ds_read_b128 a[56:59], v1 offset:14336
v_exp_f32 v25, v25
s_waitcnt lgkmcnt(8)
v_mfma_f32_16x16x32_bf16 v[40:43], a[24:27], a[200:203], v[40:43]
buffer_load_dwordx4 v12, s[72:75], s14 offen offset:3072 lds
s_waitcnt lgkmcnt(7)
v_mfma_f32_16x16x32_bf16 v[40:43], a[28:31], a[204:207], v[40:43]
ds_read_b128 a[60:63], v1 offset:15360
v_mfma_f32_16x16x32_bf16 v[44:47], a[16:19], a[208:211], v[92:95]
v_exp_f32 v26, v26
v_mfma_f32_16x16x32_bf16 v[44:47], a[20:23], a[212:215], v[44:47]
v_exp_f32 v27, v27
v_mfma_f32_16x16x32_bf16 v[44:47], a[24:27], a[216:219], v[44:47]
v_mfma_f32_16x16x32_bf16 v[44:47], a[28:31], a[220:223], v[44:47]
v_cvt_pk_bf16_f32 v56, v24, v25
v_cvt_pk_bf16_f32 v57, v26, v27
s_waitcnt lgkmcnt(0)
v_mfma_f32_16x16x32_bf16 v[192:195], a[32:35], v[72:75], v[192:195]
ds_read_b128 a[0:3], v1 offset:16384
v_exp_f32 v28, v28
v_mfma_f32_16x16x32_bf16 v[224:227], a[32:35], v[76:79], v[224:227]
ds_read_b128 a[4:7], v1 offset:17408
v_mfma_f32_16x16x32_bf16 v[228:231], a[36:39], v[76:79], v[228:231]
s_add_u32 m0, s17, 0x14000
v_add_u32 v12, 0x40000, v12
v_exp_f32 v29, v29
v_mfma_f32_16x16x32_bf16 v[196:199], a[36:39], v[72:75], v[196:199]
buffer_load_dwordx4 v12, s[72:75], 0 offen lds
v_mfma_f32_16x16x32_bf16 v[200:203], a[40:43], v[72:75], v[200:203]
ds_read_b128 a[8:11], v1 offset:18432
v_exp_f32 v30, v30
v_mfma_f32_16x16x32_bf16 v[232:235], a[40:43], v[76:79], v[232:235]
ds_read_b128 a[12:15], v1 offset:19456
v_mfma_f32_16x16x32_bf16 v[236:239], a[44:47], v[76:79], v[236:239]
v_exp_f32 v31, v31
v_mfma_f32_16x16x32_bf16 v[204:207], a[44:47], v[72:75], v[204:207]
ds_read_b128 a[16:19], v1 offset:20480
v_cvt_pk_bf16_f32 v60, v28, v29
v_cvt_pk_bf16_f32 v61, v30, v31
v_mfma_f32_16x16x32_bf16 v[208:211], a[48:51], v[72:75], v[208:211]
ds_read_b128 a[20:23], v1 offset:21504
v_mfma_f32_16x16x32_bf16 v[240:243], a[48:51], v[76:79], v[240:243]
buffer_load_dwordx4 v12, s[72:75], s12 offen offset:1024 lds
v_mfma_f32_16x16x32_bf16 v[244:247], a[52:55], v[76:79], v[244:247]
v_exp_f32 v40, v40
v_mfma_f32_16x16x32_bf16 v[212:215], a[52:55], v[72:75], v[212:215]
ds_read_b128 a[24:27], v1 offset:22528
v_exp_f32 v41, v41
v_mfma_f32_16x16x32_bf16 v[216:219], a[56:59], v[72:75], v[216:219]
ds_read_b128 a[28:31], v1 offset:23552
v_exp_f32 v42, v42
v_mfma_f32_16x16x32_bf16 v[248:251], a[56:59], v[76:79], v[248:251]
v_exp_f32 v43, v43
v_mfma_f32_16x16x32_bf16 v[252:255], a[60:63], v[76:79], v[252:255]
v_cvt_pk_bf16_f32 v58, v40, v41
v_cvt_pk_bf16_f32 v59, v42, v43
v_mfma_f32_16x16x32_bf16 v[220:223], a[60:63], v[72:75], v[220:223]
buffer_load_dwordx4 v12, s[72:75], s13 offen offset:2048 lds
v_mfma_f32_16x16x32_bf16 a[232:235], a[240:243], v[72:75], a[232:235]
v_exp_f32 v44, v44
v_mfma_f32_16x16x32_bf16 a[236:239], a[240:243], v[76:79], a[236:239]
v_exp_f32 v45, v45
s_waitcnt lgkmcnt(7)
v_mfma_f32_16x16x32_bf16 v[28:31], a[0:3], a[208:211], v[92:95]
v_exp_f32 v46, v46
s_waitcnt lgkmcnt(6)
v_mfma_f32_16x16x32_bf16 v[28:31], a[4:7], a[212:215], v[28:31]
v_exp_f32 v47, v47
s_waitcnt lgkmcnt(5)
v_mfma_f32_16x16x32_bf16 v[28:31], a[8:11], a[216:219], v[28:31]
v_cvt_pk_bf16_f32 v62, v44, v45
v_cvt_pk_bf16_f32 v63, v46, v47
s_waitcnt lgkmcnt(4)
v_mfma_f32_16x16x32_bf16 v[28:31], a[12:15], a[220:223], v[28:31]
buffer_load_dwordx4 v12, s[72:75], s14 offen offset:3072 lds
s_waitcnt lgkmcnt(3)
v_mfma_f32_16x16x32_bf16 v[44:47], a[16:19], a[208:211], v[92:95]
s_waitcnt lgkmcnt(2)
v_mfma_f32_16x16x32_bf16 v[44:47], a[20:23], a[212:215], v[44:47]
s_waitcnt lgkmcnt(1)
v_mfma_f32_16x16x32_bf16 v[44:47], a[24:27], a[216:219], v[44:47]
s_waitcnt lgkmcnt(0)
v_mfma_f32_16x16x32_bf16 v[44:47], a[28:31], a[220:223], v[44:47]
ds_read_b128 a[32:35], v1 offset:24576
ds_read_b128 a[36:39], v1 offset:25600
ds_read_b128 a[40:43], v1 offset:26624
ds_read_b128 a[44:47], v1 offset:27648
ds_read_b128 a[48:51], v1 offset:28672
ds_read_b128 a[52:55], v1 offset:29696
ds_read_b128 a[56:59], v1 offset:30720
ds_read_b128 a[60:63], v1 offset:31744
v_xor_b32 v1, 0x8000, v1
L_att_h1_0:
s_waitcnt vmcnt(8) lgkmcnt(0)
s_mov_b32 s92, 200000
L_spin_b0:
v_readfirstlane_b32 s93, v13
s_nop 1
s_cmp_ge_u32 s93, 32
s_cbranch_scc1 L_spun_b0
s_sub_u32 s92, s92, 1
s_cbranch_scc1 L_spun_b0
s_sleep 4
buffer_load_dword v13, off, s[84:87], s10 sc1
s_waitcnt vmcnt(0)
s_branch L_spin_b0
L_spun_b0:
s_barrier
v_mfma_f32_16x16x32_bf16 v[192:195], a[32:35], v[56:59], v[192:195]
s_add_u32 s101, s101, 0x2000
ds_read_b128 a[0:3], v2 offset:0
v_exp_f32 v28, v28
v_mfma_f32_16x16x32_bf16 v[224:227], a[32:35], v[60:63], v[224:227]
buffer_load_dwordx4 a[64:67], v3, s[88:91], s101 offen sc1
v_mfma_f32_16x16x32_bf16 v[228:231], a[36:39], v[60:63], v[228:231]
ds_read_b128 a[4:7], v2 offset:1024
v_mfma_f32_16x16x32_bf16 v[196:199], a[36:39], v[56:59], v[196:199]
ds_read_b128 a[8:11], v2 offset:2048
v_exp_f32 v29, v29
v_mfma_f32_16x16x32_bf16 v[200:203], a[40:43], v[56:59], v[200:203]
buffer_load_dwordx4 a[68:71], v3, s[88:91], s101 offen offset:1024 sc1
v_mfma_f32_16x16x32_bf16 v[232:235], a[40:43], v[60:63], v[232:235]
ds_read_b128 a[12:15], v2 offset:3072
v_mfma_f32_16x16x32_bf16 v[236:239], a[44:47], v[60:63], v[236:239]
s_add_u32 s101, s101, 0x2000
ds_read_b128 a[16:19], v2 offset:4096
v_exp_f32 v30, v30
v_mfma_f32_16x16x32_bf16 v[204:207], a[44:47], v[56:59], v[204:207]
buffer_load_dwordx4 a[72:75], v3, s[88:91], s101 offen sc1
v_mfma_f32_16x16x32_bf16 v[208:211], a[48:51], v[56:59], v[208:211]
ds_read_b128 a[20:23], v2 offset:5120
v_mfma_f32_16x16x32_bf16 v[240:243], a[48:51], v[60:63], v[240:243]
ds_read_b128 a[24:27], v2 offset:6144
v_exp_f32 v31, v31
v_mfma_f32_16x16x32_bf16 v[244:247], a[52:55], v[60:63], v[244:247]
buffer_load_dwordx4 a[76:79], v3, s[88:91], s101 offen offset:1024 sc1
v_mfma_f32_16x16x32_bf16 v[212:215], a[52:55], v[56:59], v[212:215]
ds_read_b128 a[28:31], v2 offset:7168
v_mfma_f32_16x16x32_bf16 v[216:219], a[56:59], v[56:59], v[216:219]
s_add_u32 s101, s101, 0x2000
v_cvt_pk_bf16_f32 v76, v28, v29
v_cvt_pk_bf16_f32 v77, v30, v31
v_mfma_f32_16x16x32_bf16 v[248:251], a[56:59], v[60:63], v[248:251]
buffer_load_dwordx4 a[80:83], v3, s[88:91], s101 offen sc1
v_mfma_f32_16x16x32_bf16 v[252:255], a[60:63], v[60:63], v[252:255]
v_exp_f32 v44, v44
v_mfma_f32_16x16x32_bf16 v[220:223], a[60:63], v[56:59], v[220:223]
v_mfma_f32_16x16x32_bf16 a[232:235], a[240:243], v[56:59], a[232:235]
buffer_load_dwordx4 a[84:87], v3, s[88:91], s101 offen offset:1024 sc1
v_mfma_f32_16x16x32_bf16 a[236:239], a[240:243], v[60:63], a[236:239]
v_exp_f32 v45, v45
s_waitcnt lgkmcnt(7)
v_mfma_f32_16x16x32_bf16 v[28:31], a[0:3], a[208:211], v[92:95]
s_add_u32 s101, s101, 0x2000
v_exp_f32 v46, v46
s_waitcnt lgkmcnt(6)
v_mfma_f32_16x16x32_bf16 v[28:31], a[4:7], a[212:215], v[28:31]
buffer_load_dwordx4 a[88:91], v3, s[88:91], s101 offen sc1
s_waitcnt lgkmcnt(5)
v_mfma_f32_16x16x32_bf16 v[28:31], a[8:11], a[216:219], v[28:31]
v_exp_f32 v47, v47
s_waitcnt lgkmcnt(4)
v_mfma_f32_16x16x32_bf16 v[28:31], a[12:15], a[220:223], v[28:31]
v_cvt_pk_bf16_f32 v78, v44, v45
v_cvt_pk_bf16_f32 v79, v46, v47
s_waitcnt lgkmcnt(3)
v_mfma_f32_16x16x32_bf16 v[44:47], a[16:19], a[208:211], v[92:95]
buffer_load_dwordx4 a[92:95], v3, s[88:91], s101 offen offset:1024 sc1
s_waitcnt lgkmcnt(2)
v_mfma_f32_16x16x32_bf16 v[44:47], a[20:23], a[212:215], v[44:47]
s_waitcnt lgkmcnt(1)
v_mfma_f32_16x16x32_bf16 v[44:47], a[24:27], a[216:219], v[44:47]
s_waitcnt lgkmcnt(0)
v_mfma_f32_16x16x32_bf16 v[44:47], a[28:31], a[220:223], v[44:47]
ds_read_b128 a[32:35], v2 offset:8192
ds_read_b128 a[36:39], v2 offset:9216
ds_read_b128 a[40:43], v2 offset:10240
ds_read_b128 a[44:47], v2 offset:11264
ds_read_b128 a[48:51], v2 offset:12288
ds_read_b128 a[52:55], v2 offset:13312
ds_read_b128 a[56:59], v2 offset:14336
ds_read_b128 a[60:63], v2 offset:15360
s_waitcnt lgkmcnt(0)
v_mfma_f32_16x16x32_bf16 v[224:227], a[32:35], v[76:79], v[224:227]
s_add_u32 s101, s101, 0x2000
ds_read_b128 a[0:3], v2 offset:16384
ds_read_b128 a[4:7], v2 offset:17408
v_exp_f32 v28, v28
v_mfma_f32_16x16x32_bf16 v[228:231], a[36:39], v[76:79], v[228:231]
buffer_load_dwordx4 a[96:99], v3, s[88:91], s101 offen sc1
v_mfma_f32_16x16x32_bf16 v[232:235], a[40:43], v[76:79], v[232:235]
ds_read_b128 a[8:11], v2 offset:18432
ds_read_b128 a[12:15], v2 offset:19456
v_exp_f32 v29, v29
v_mfma_f32_16x16x32_bf16 v[236:239], a[44:47], v[76:79], v[236:239]
buffer_load_dwordx4 a[100:103], v3, s[88:91], s101 offen offset:1024 sc1
v_mfma_f32_16x16x32_bf16 v[240:243], a[48:51], v[76:79], v[240:243]
s_add_u32 s101, s101, 0x2000
ds_read_b128 a[16:19], v2 offset:20480
v_exp_f32 v30, v30
v_mfma_f32_16x16x32_bf16 v[244:247], a[52:55], v[76:79], v[244:247]
buffer_load_dwordx4 a[104:107], v3, s[88:91], s101 offen sc1
v_mfma_f32_16x16x32_bf16 v[248:251], a[56:59], v[76:79], v[248:251]
ds_read_b128 a[20:23], v2 offset:21504
ds_read_b128 a[24:27], v2 offset:22528
v_exp_f32 v31, v31
v_mfma_f32_16x16x32_bf16 v[252:255], a[60:63], v[76:79], v[252:255]
buffer_load_dwordx4 a[108:111], v3, s[88:91], s101 offen offset:1024 sc1
v_mfma_f32_16x16x32_bf16 a[236:239], a[240:243], v[76:79], a[236:239]
s_add_u32 s101, s101, 0x2000
ds_read_b128 a[28:31], v2 offset:23552
v_cvt_pk_bf16_f32 v60, v28, v29
v_cvt_pk_bf16_f32 v61, v30, v31
s_waitcnt lgkmcnt(7)
v_mfma_f32_16x16x32_bf16 v[28:31], a[0:3], a[208:211], v[120:123]
buffer_load_dwordx4 a[112:115], v3, s[88:91], s101 offen sc1
s_waitcnt lgkmcnt(6)
v_mfma_f32_16x16x32_bf16 v[28:31], a[4:7], a[212:215], v[28:31]
v_exp_f32 v44, v44
s_waitcnt lgkmcnt(5)
v_mfma_f32_16x16x32_bf16 v[28:31], a[8:11], a[216:219], v[28:31]
buffer_load_dwordx4 a[116:119], v3, s[88:91], s101 offen offset:1024 sc1
s_waitcnt lgkmcnt(4)
v_mfma_f32_16x16x32_bf16 v[28:31], a[12:15], a[220:223], v[28:31]
s_add_u32 s101, s101, 0x2000
v_exp_f32 v45, v45
v_exp_f32 v46, v46
s_nop 0
v_exp_f32 v47, v47
s_nop 0
v_cvt_pk_bf16_f32 v62, v44, v45
v_cvt_pk_bf16_f32 v63, v46, v47
s_nop 0
s_waitcnt lgkmcnt(3)
v_mfma_f32_16x16x32_bf16 v[44:47], a[16:19], a[208:211], v[124:127]
buffer_load_dwordx4 a[120:123], v3, s[88:91], s101 offen sc1
s_waitcnt lgkmcnt(2)
v_mfma_f32_16x16x32_bf16 v[44:47], a[20:23], a[212:215], v[44:47]
s_waitcnt lgkmcnt(1)
v_mfma_f32_16x16x32_bf16 v[44:47], a[24:27], a[216:219], v[44:47]
buffer_load_dwordx4 a[124:127], v3, s[88:91], s101 offen offset:1024 sc1
s_waitcnt lgkmcnt(0)
v_mfma_f32_16x16x32_bf16 v[44:47], a[28:31], a[220:223], v[44:47]
ds_read_b128 a[32:35], v2 offset:24576
ds_read_b128 a[36:39], v2 offset:25600
ds_read_b128 a[40:43], v2 offset:26624
ds_read_b128 a[44:47], v2 offset:27648
ds_read_b128 a[48:51], v2 offset:28672
ds_read_b128 a[52:55], v2 offset:29696
ds_read_b128 a[56:59], v2 offset:30720
ds_read_b128 a[60:63], v2 offset:31744
v_xor_b32 v2, 0x38000, v2
s_waitcnt  lgkmcnt(0)
s_barrier
s_nop 7
v_exp_f32 v28, v28
s_nop 0
v_exp_f32 v29, v29
s_nop 0
v_exp_f32 v30, v30
s_nop 0
v_exp_f32 v31, v31
s_nop 0
v_cvt_pk_bf16_f32 v76, v28, v29
v_cvt_pk_bf16_f32 v77, v30, v31
s_nop 0
v_exp_f32 v44, v44
s_nop 0
v_exp_f32 v45, v45
s_nop 0
v_exp_f32 v46, v46
s_nop 0
v_exp_f32 v47, v47
s_nop 0
v_cvt_pk_bf16_f32 v78, v44, v45
v_cvt_pk_bf16_f32 v79, v46, v47
s_nop 0
s_add_u32 m0, s17, 0x18000
v_add_u32 v12, 0x40000, v12
s_nop 0
buffer_load_dwordx4 v12, s[72:75], 0 offen lds
buffer_load_dwordx4 v12, s[72:75], s12 offen offset:1024 lds
buffer_load_dwordx4 v12, s[72:75], s13 offen offset:2048 lds
buffer_load_dwordx4 v12, s[72:75], s14 offen offset:3072 lds
s_add_u32 s101, s101, 0x2000
s_nop 0
buffer_load_dwordx4 a[128:131], v3, s[88:91], s101 offen sc1
buffer_load_dwordx4 a[132:135], v3, s[88:91], s101 offen offset:1024 sc1
v_mfma_f32_16x16x32_bf16 v[224:227], a[32:35], v[60:63], v[224:227]
v_mfma_f32_16x16x32_bf16 v[228:231], a[36:39], v[60:63], v[228:231]
v_mfma_f32_16x16x32_bf16 v[232:235], a[40:43], v[60:63], v[232:235]
v_mfma_f32_16x16x32_bf16 v[236:239], a[44:47], v[60:63], v[236:239]
v_mfma_f32_16x16x32_bf16 v[240:243], a[48:51], v[60:63], v[240:243]
v_mfma_f32_16x16x32_bf16 v[244:247], a[52:55], v[60:63], v[244:247]
v_mfma_f32_16x16x32_bf16 v[248:251], a[56:59], v[60:63], v[248:251]
v_mfma_f32_16x16x32_bf16 v[252:255], a[60:63], v[60:63], v[252:255]
v_mfma_f32_16x16x32_bf16 a[236:239], a[240:243], v[60:63], a[236:239]
ds_read_b128 a[32:35], v1 offset:8192
ds_read_b128 a[36:39], v1 offset:9216
ds_read_b128 a[40:43], v1 offset:10240
ds_read_b128 a[44:47], v1 offset:11264
ds_read_b128 a[48:51], v1 offset:12288
ds_read_b128 a[52:55], v1 offset:13312
ds_read_b128 a[56:59], v1 offset:14336
ds_read_b128 a[60:63], v1 offset:15360
s_waitcnt lgkmcnt(0)
s_nop 7
s_add_u32 s101, s101, 0x2000
s_nop 0
buffer_load_dwordx4 a[136:139], v3, s[88:91], s101 offen sc1
buffer_load_dwordx4 a[140:143], v3, s[88:91], s101 offen offset:1024 sc1
s_add_u32 s101, s101, 0x2000
s_nop 0
buffer_load_dwordx4 a[144:147], v3, s[88:91], s101 offen sc1
buffer_load_dwordx4 a[148:151], v3, s[88:91], s101 offen offset:1024 sc1
s_add_u32 s101, s101, 0x2000
s_nop 0
buffer_load_dwordx4 a[152:155], v3, s[88:91], s101 offen sc1
buffer_load_dwordx4 a[156:159], v3, s[88:91], s101 offen offset:1024 sc1
v_mfma_f32_16x16x32_bf16 v[224:227], a[32:35], v[76:79], v[224:227]
v_mfma_f32_16x16x32_bf16 v[228:231], a[36:39], v[76:79], v[228:231]
v_mfma_f32_16x16x32_bf16 v[232:235], a[40:43], v[76:79], v[232:235]
v_mfma_f32_16x16x32_bf16 v[236:239], a[44:47], v[76:79], v[236:239]
v_mfma_f32_16x16x32_bf16 v[240:243], a[48:51], v[76:79], v[240:243]
v_mfma_f32_16x16x32_bf16 v[244:247], a[52:55], v[76:79], v[244:247]
v_mfma_f32_16x16x32_bf16 v[248:251], a[56:59], v[76:79], v[248:251]
v_mfma_f32_16x16x32_bf16 v[252:255], a[60:63], v[76:79], v[252:255]
v_mfma_f32_16x16x32_bf16 a[236:239], a[240:243], v[76:79], a[236:239]
v_xor_b32 v1, 0x8000, v1
s_branch L_att_fin
L_att_sh0_1:
s_waitcnt vmcnt(16) lgkmcnt(0)
s_barrier
s_and_b32 s8, s2, 7
s_lshr_b32 s9, s2, 3
s_lshr_b32 s99, s8, 1
s_lshl_b32 s99, s99, 2
s_lshr_b32 s10, s9, 3
s_add_u32 s99, s99, s10
s_and_b32 s100, s8, 1
s_lshl_b32 s100, s100, 3
s_and_b32 s10, s9, 7
s_add_u32 s100, s100, s10
s_sub_u32 s10, 15, s99
s_min_u32 s10, s10, s99
s_lshl_b32 s11, s10, 7
s_add_u32 s11, s11, 0x3604000
s_lshl_b32 s10, s10, 2
s_add_u32 s10, s10, 128
buffer_load_dword v13, off, s[84:87], s10 sc1
s_mov_b32 s12, 15360
s_mov_b32 s13, 30720
s_mov_b32 s14, 46080
v_lshrrev_b32 v14, 4, v0
v_bfe_u32 v15, v0, 1, 2
v_xor_b32 v14, v14, v15
v_lshlrev_b32 v14, 5, v14
v_and_b32 v15, 1, v0
v_lshl_add_u32 v14, v15, 4, v14
v_lshrrev_b32 v15, 3, v0
v_lshl_add_u32 v14, v15, 11, v14
s_lshl_b32 s8, s4, 16
s_lshl_b32 s9, s100, 7
s_add_u32 s8, s8, s9
v_add_u32 v12, s8, v14
s_mul_i32 s101, s99, 0x140000
s_lshl_b32 s8, s4, 11
s_add_u32 s101, s101, s8
s_add_u32 s101, s101, 0x21fe000
v_mfma_f32_16x16x32_bf16 v[192:195], a[32:35], v[56:59], v[192:195]
ds_read_b128 a[0:3], v1 offset:0
v_exp_f32 v28, v28
v_mfma_f32_16x16x32_bf16 v[224:227], a[32:35], v[60:63], v[224:227]
ds_read_b128 a[4:7], v1 offset:1024
v_mfma_f32_16x16x32_bf16 v[228:231], a[36:39], v[60:63], v[228:231]
v_exp_f32 v29, v29
v_mfma_f32_16x16x32_bf16 v[196:199], a[36:39], v[56:59], v[196:199]
s_add_u32 m0, s17, 0x10000
ds_read_b128 a[8:11], v1 offset:2048
v_exp_f32 v30, v30
v_mfma_f32_16x16x32_bf16 v[200:203], a[40:43], v[56:59], v[200:203]
buffer_load_dwordx4 v12, s[72:75], 0 offen lds
v_mfma_f32_16x16x32_bf16 v[232:235], a[40:43], v[60:63], v[232:235]
ds_read_b128 a[12:15], v1 offset:3072
v_mfma_f32_16x16x32_bf16 v[236:239], a[44:47], v[60:63], v[236:239]
v_exp_f32 v31, v31
v_mfma_f32_16x16x32_bf16 v[204:207], a[44:47], v[56:59], v[204:207]
ds_read_b128 a[16:19], v1 offset:4096
v_cvt_pk_bf16_f32 v76, v28, v29
v_cvt_pk_bf16_f32 v77, v30, v31
v_mfma_f32_16x16x32_bf16 v[208:211], a[48:51], v[56:59], v[208:211]
ds_read_b128 a[20:23], v1 offset:5120
v_mfma_f32_16x16x32_bf16 v[240:243], a[48:51], v[60:63], v[240:243]
v_exp_f32 v40, v40
v_mfma_f32_16x16x32_bf16 v[244:247], a[52:55], v[60:63], v[244:247]
ds_read_b128 a[24:27], v1 offset:6144
v_exp_f32 v41, v41
v_mfma_f32_16x16x32_bf16 v[212:215], a[52:55], v[56:59], v[212:215]
ds_read_b128 a[28:31], v1 offset:7168
v_mfma_f32_16x16x32_bf16 v[216:219], a[56:59], v[56:59], v[216:219]
buffer_load_dwordx4 v12, s[72:75], s12 offen offset:1024 lds
v_mfma_f32_16x16x32_bf16 v[248:251], a[56:59], v[60:63], v[248:251]
v_exp_f32 v42, v42
v_mfma_f32_16x16x32_bf16 v[252:255], a[60:63], v[60:63], v[252:255]
v_exp_f32 v43, v43
v_mfma_f32_16x16x32_bf16 v[220:223], a[60:63], v[56:59], v[220:223]
v_mfma_f32_16x16x32_bf16 a[232:235], a[240:243], v[56:59], a[232:235]
v_cvt_pk_bf16_f32 v74, v40, v41
v_cvt_pk_bf16_f32 v75, v42, v43
v_mfma_f32_16x16x32_bf16 a[236:239], a[240:243], v[60:63], a[236:239]
v_exp_f32 v44, v44
s_waitcnt lgkmcnt(7)
v_mfma_f32_16x16x32_bf16 v[24:27], a[0:3], a[192:195], v[88:91]
ds_read_b128 a[32:35], v1 offset:8192
s_waitcnt lgkmcnt(7)
v_mfma_f32_16x16x32_bf16 v[24:27], a[4:7], a[196:199], v[24:27]
ds_read_b128 a[36:39], v1 offset:9216
v_exp_f32 v45, v45
s_waitcnt lgkmcnt(7)
v_mfma_f32_16x16x32_bf16 v[24:27], a[8:11], a[200:203], v[24:27]
buffer_load_dwordx4 v12, s[72:75], s13 offen offset:2048 lds
s_waitcnt lgkmcnt(6)
v_mfma_f32_16x16x32_bf16 v[24:27], a[12:15], a[204:207], v[24:27]
ds_read_b128 a[40:43], v1 offset:10240
v_exp_f32 v46, v46
v_mfma_f32_16x16x32_bf16 v[28:31], a[0:3], a[208:211], v[92:95]
v_mfma_f32_16x16x32_bf16 v[28:31], a[4:7], a[212:215], v[28:31]
ds_read_b128 a[44:47], v1 offset:11264
v_exp_f32 v47, v47
v_mfma_f32_16x16x32_bf16 v[28:31], a[8:11], a[216:219], v[28:31]
ds_read_b128 a[48:51], v1 offset:12288
v_cvt_pk_bf16_f32 v78, v44, v45
v_cvt_pk_bf16_f32 v79, v46, v47
v_mfma_f32_16x16x32_bf16 v[28:31], a[12:15], a[220:223], v[28:31]
ds_read_b128 a[52:55], v1 offset:13312
s_waitcnt lgkmcnt(9)
v_mfma_f32_16x16x32_bf16 v[40:43], a[16:19], a[192:195], v[88:91]
v_exp_f32 v24, v24
s_waitcnt lgkmcnt(8)
v_mfma_f32_16x16x32_bf16 v[40:43], a[20:23], a[196:199], v[40:43]
ds_read_b128 a[56:59], v1 offset:14336
v_exp_f32 v25, v25
s_waitcnt lgkmcnt(8)
v_mfma_f32_16x16x32_bf16 v[40:43], a[24:27], a[200:203], v[40:43]
buffer_load_dwordx4 v12, s[72:75], s14 offen offset:3072 lds
s_waitcnt lgkmcnt(7)
v_mfma_f32_16x16x32_bf16 v[40:43], a[28:31], a[204:207], v[40:43]
ds_read_b128 a[60:63], v1 offset:15360
v_mfma_f32_16x16x32_bf16 v[44:47], a[16:19], a[208:211], v[92:95]
v_exp_f32 v26, v26
v_mfma_f32_16x16x32_bf16 v[44:47], a[20:23], a[212:215], v[44:47]
v_exp_f32 v27, v27
v_mfma_f32_16x16x32_bf16 v[44:47], a[24:27], a[216:219], v[44:47]
v_mfma_f32_16x16x32_bf16 v[44:47], a[28:31], a[220:223], v[44:47]
v_cvt_pk_bf16_f32 v56, v24, v25
v_cvt_pk_bf16_f32 v57, v26, v27
s_waitcnt lgkmcnt(0)
v_mfma_f32_16x16x32_bf16 v[192:195], a[32:35], v[72:75], v[192:195]
ds_read_b128 a[0:3], v1 offset:16384
v_exp_f32 v28, v28
v_mfma_f32_16x16x32_bf16 v[224:227], a[32:35], v[76:79], v[224:227]
ds_read_b128 a[4:7], v1 offset:17408
v_mfma_f32_16x16x32_bf16 v[228:231], a[36:39], v[76:79], v[228:231]
v_exp_f32 v29, v29
v_mfma_f32_16x16x32_bf16 v[196:199], a[36:39], v[72:75], v[196:199]
s_add_u32 m0, s17, 0x14000
v_add_u32 v12, 0x40000, v12
ds_read_b128 a[8:11], v1 offset:18432
v_exp_f32 v30, v30
v_mfma_f32_16x16x32_bf16 v[200:203], a[40:43], v[72:75], v[200:203]
buffer_load_dwordx4 v12, s[72:75], 0 offen lds
v_mfma_f32_16x16x32_bf16 v[232:235], a[40:43], v[76:79], v[232:235]
ds_read_b128 a[12:15], v1 offset:19456
v_mfma_f32_16x16x32_bf16 v[236:239], a[44:47], v[76:79], v[236:239]
v_exp_f32 v31, v31
v_mfma_f32_16x16x32_bf16 v[204:207], a[44:47], v[72:75], v[204:207]
ds_read_b128 a[16:19], v1 offset:20480
v_cvt_pk_bf16_f32 v60, v28, v29
v_cvt_pk_bf16_f32 v61, v30, v31
v_mfma_f32_16x16x32_bf16 v[208:211], a[48:51], v[72:75], v[208:211]
ds_read_b128 a[20:23], v1 offset:21504
v_mfma_f32_16x16x32_bf16 v[240:243], a[48:51], v[76:79], v[240:243]
v_exp_f32 v40, v40
v_mfma_f32_16x16x32_bf16 v[244:247], a[52:55], v[76:79], v[244:247]
ds_read_b128 a[24:27], v1 offset:22528
v_exp_f32 v41, v41
v_mfma_f32_16x16x32_bf16 v[212:215], a[52:55], v[72:75], v[212:215]
ds_read_b128 a[28:31], v1 offset:23552
v_mfma_f32_16x16x32_bf16 v[216:219], a[56:59], v[72:75], v[216:219]
buffer_load_dwordx4 v12, s[72:75], s12 offen offset:1024 lds
v_mfma_f32_16x16x32_bf16 v[248:251], a[56:59], v[76:79], v[248:251]
v_exp_f32 v42, v42
v_mfma_f32_16x16x32_bf16 v[252:255], a[60:63], v[76:79], v[252:255]
v_exp_f32 v43, v43
v_mfma_f32_16x16x32_bf16 v[220:223], a[60:63], v[72:75], v[220:223]
v_mfma_f32_16x16x32_bf16 a[232:235], a[240:243], v[72:75], a[232:235]
v_cvt_pk_bf16_f32 v58, v40, v41
v_cvt_pk_bf16_f32 v59, v42, v43
v_mfma_f32_16x16x32_bf16 a[236:239], a[240:243], v[76:79], a[236:239]
v_exp_f32 v44, v44
s_waitcnt lgkmcnt(7)
v_mfma_f32_16x16x32_bf16 v[24:27], a[0:3], a[192:195], v[112:115]
ds_read_b128 a[32:35], v1 offset:24576
s_waitcnt lgkmcnt(7)
v_mfma_f32_16x16x32_bf16 v[24:27], a[4:7], a[196:199], v[24:27]
ds_read_b128 a[36:39], v1 offset:25600
v_exp_f32 v45, v45
s_waitcnt lgkmcnt(7)
v_mfma_f32_16x16x32_bf16 v[24:27], a[8:11], a[200:203], v[24:27]
buffer_load_dwordx4 v12, s[72:75], s13 offen offset:2048 lds
s_waitcnt lgkmcnt(6)
v_mfma_f32_16x16x32_bf16 v[24:27], a[12:15], a[204:207], v[24:27]
ds_read_b128 a[40:43], v1 offset:26624
v_exp_f32 v46, v46
v_mfma_f32_16x16x32_bf16 v[28:31], a[0:3], a[208:211], v[92:95]
v_mfma_f32_16x16x32_bf16 v[28:31], a[4:7], a[212:215], v[28:31]
ds_read_b128 a[44:47], v1 offset:27648
v_exp_f32 v47, v47
v_mfma_f32_16x16x32_bf16 v[28:31], a[8:11], a[216:219], v[28:31]
ds_read_b128 a[48:51], v1 offset:28672
v_cvt_pk_bf16_f32 v62, v44, v45
v_cvt_pk_bf16_f32 v63, v46, v47
v_mfma_f32_16x16x32_bf16 v[28:31], a[12:15], a[220:223], v[28:31]
ds_read_b128 a[52:55], v1 offset:29696
s_waitcnt lgkmcnt(9)
v_mfma_f32_16x16x32_bf16 v[40:43], a[16:19], a[192:195], v[116:119]
v_exp_f32 v24, v24
s_waitcnt lgkmcnt(8)
v_mfma_f32_16x16x32_bf16 v[40:43], a[20:23], a[196:199], v[40:43]
ds_read_b128 a[56:59], v1 offset:30720
v_exp_f32 v25, v25
s_waitcnt lgkmcnt(8)
v_mfma_f32_16x16x32_bf16 v[40:43], a[24:27], a[200:203], v[40:43]
buffer_load_dwordx4 v12, s[72:75], s14 offen offset:3072 lds
s_waitcnt lgkmcnt(7)
v_mfma_f32_16x16x32_bf16 v[40:43], a[28:31], a[204:207], v[40:43]
ds_read_b128 a[60:63], v1 offset:31744
v_mfma_f32_16x16x32_bf16 v[44:47], a[16:19], a[208:211], v[92:95]
v_exp_f32 v26, v26
v_mfma_f32_16x16x32_bf16 v[44:47], a[20:23], a[212:215], v[44:47]
v_exp_f32 v27, v27
v_mfma_f32_16x16x32_bf16 v[44:47], a[24:27], a[216:219], v[44:47]
v_mfma_f32_16x16x32_bf16 v[44:47], a[28:31], a[220:223], v[44:47]
v_cvt_pk_bf16_f32 v72, v24, v25
v_cvt_pk_bf16_f32 v73, v26, v27
v_xor_b32 v1, 0x8000, v1
L_att_h1_1:
s_waitcnt vmcnt(8) lgkmcnt(0)
s_mov_b32 s92, 200000
L_spin_b1:
v_readfirstlane_b32 s93, v13
s_nop 1
s_cmp_ge_u32 s93, 32
s_cbranch_scc1 L_spun_b1
s_sub_u32 s92, s92, 1
s_cbranch_scc1 L_spun_b1
s_sleep 4
buffer_load_dword v13, off, s[84:87], s10 sc1
s_waitcnt vmcnt(0)
s_branch L_spin_b1
L_spun_b1:
s_barrier
v_mfma_f32_16x16x32_bf16 v[192:195], a[32:35], v[56:59], v[192:195]
s_add_u32 s101, s101, 0x2000
ds_read_b128 a[0:3], v2 offset:0
v_exp_f32 v28, v28
v_mfma_f32_16x16x32_bf16 v[224:227], a[32:35], v[60:63], v[224:227]
buffer_load_dwordx4 a[64:67], v3, s[88:91], s101 offen sc1
v_mfma_f32_16x16x32_bf16 v[228:231], a[36:39], v[60:63], v[228:231]
ds_read_b128 a[4:7], v2 offset:1024
v_exp_f32 v29, v29
v_mfma_f32_16x16x32_bf16 v[196:199], a[36:39], v[56:59], v[196:199]
ds_read_b128 a[8:11], v2 offset:2048
v_exp_f32 v30, v30
v_mfma_f32_16x16x32_bf16 v[200:203], a[40:43], v[56:59], v[200:203]
buffer_load_dwordx4 a[68:71], v3, s[88:91], s101 offen offset:1024 sc1
v_mfma_f32_16x16x32_bf16 v[232:235], a[40:43], v[60:63], v[232:235]
ds_read_b128 a[12:15], v2 offset:3072
v_exp_f32 v31, v31
v_mfma_f32_16x16x32_bf16 v[236:239], a[44:47], v[60:63], v[236:239]
s_add_u32 s101, s101, 0x2000
ds_read_b128 a[16:19], v2 offset:4096
v_cvt_pk_bf16_f32 v76, v28, v29
v_cvt_pk_bf16_f32 v77, v30, v31
v_mfma_f32_16x16x32_bf16 v[204:207], a[44:47], v[56:59], v[204:207]
buffer_load_dwordx4 a[72:75], v3, s[88:91], s101 offen sc1
v_mfma_f32_16x16x32_bf16 v[208:211], a[48:51], v[56:59], v[208:211]
ds_read_b128 a[20:23], v2 offset:5120
v_exp_f32 v40, v40
v_mfma_f32_16x16x32_bf16 v[240:243], a[48:51], v[60:63], v[240:243]
ds_read_b128 a[24:27], v2 offset:6144
v_exp_f32 v41, v41
v_mfma_f32_16x16x32_bf16 v[244:247], a[52:55], v[60:63], v[244:247]
buffer_load_dwordx4 a[76:79], v3, s[88:91], s101 offen offset:1024 sc1
v_mfma_f32_16x16x32_bf16 v[212:215], a[52:55], v[56:59], v[212:215]
ds_read_b128 a[28:31], v2 offset:7168
v_exp_f32 v42, v42
v_mfma_f32_16x16x32_bf16 v[216:219], a[56:59], v[56:59], v[216:219]
s_add_u32 s101, s101, 0x2000
v_exp_f32 v43, v43
v_mfma_f32_16x16x32_bf16 v[248:251], a[56:59], v[60:63], v[248:251]
buffer_load_dwordx4 a[80:83], v3, s[88:91], s101 offen sc1
v_mfma_f32_16x16x32_bf16 v[252:255], a[60:63], v[60:63], v[252:255]
v_cvt_pk_bf16_f32 v74, v40, v41
v_cvt_pk_bf16_f32 v75, v42, v43
v_mfma_f32_16x16x32_bf16 v[220:223], a[60:63], v[56:59], v[220:223]
v_exp_f32 v44, v44
v_mfma_f32_16x16x32_bf16 a[232:235], a[240:243], v[56:59], a[232:235]
buffer_load_dwordx4 a[84:87], v3, s[88:91], s101 offen offset:1024 sc1
v_mfma_f32_16x16x32_bf16 a[236:239], a[240:243], v[60:63], a[236:239]
v_exp_f32 v45, v45
s_waitcnt lgkmcnt(7)
v_mfma_f32_16x16x32_bf16 v[28:31], a[0:3], a[208:211], v[120:123]
s_add_u32 s101, s101, 0x2000
v_exp_f32 v46, v46
s_waitcnt lgkmcnt(6)
v_mfma_f32_16x16x32_bf16 v[28:31], a[4:7], a[212:215], v[28:31]
buffer_load_dwordx4 a[88:91], v3, s[88:91], s101 offen sc1
s_waitcnt lgkmcnt(5)
v_mfma_f32_16x16x32_bf16 v[28:31], a[8:11], a[216:219], v[28:31]
v_exp_f32 v47, v47
s_waitcnt lgkmcnt(4)
v_mfma_f32_16x16x32_bf16 v[28:31], a[12:15], a[220:223], v[28:31]
v_cvt_pk_bf16_f32 v78, v44, v45
v_cvt_pk_bf16_f32 v79, v46, v47
s_waitcnt lgkmcnt(3)
v_mfma_f32_16x16x32_bf16 v[44:47], a[16:19], a[208:211], v[124:127]
buffer_load_dwordx4 a[92:95], v3, s[88:91], s101 offen offset:1024 sc1
s_waitcnt lgkmcnt(2)
v_mfma_f32_16x16x32_bf16 v[44:47], a[20:23], a[212:215], v[44:47]
s_waitcnt lgkmcnt(1)
v_mfma_f32_16x16x32_bf16 v[44:47], a[24:27], a[216:219], v[44:47]
s_waitcnt lgkmcnt(0)
v_mfma_f32_16x16x32_bf16 v[44:47], a[28:31], a[220:223], v[44:47]
ds_read_b128 a[32:35], v2 offset:8192
ds_read_b128 a[36:39], v2 offset:9216
ds_read_b128 a[40:43], v2 offset:10240
ds_read_b128 a[44:47], v2 offset:11264
ds_read_b128 a[48:51], v2 offset:12288
ds_read_b128 a[52:55], v2 offset:13312
ds_read_b128 a[56:59], v2 offset:14336
ds_read_b128 a[60:63], v2 offset:15360
s_waitcnt lgkmcnt(0)
v_mfma_f32_16x16x32_bf16 v[192:195], a[32:35], v[72:75], v[192:195]
s_add_u32 s101, s101, 0x2000
v_exp_f32 v28, v28
v_mfma_f32_16x16x32_bf16 v[224:227], a[32:35], v[76:79], v[224:227]
buffer_load_dwordx4 a[96:99], v3, s[88:91], s101 offen sc1
v_mfma_f32_16x16x32_bf16 v[228:231], a[36:39], v[76:79], v[228:231]
v_exp_f32 v29, v29
v_mfma_f32_16x16x32_bf16 v[196:199], a[36:39], v[72:75], v[196:199]
buffer_load_dwordx4 a[100:103], v3, s[88:91], s101 offen offset:1024 sc1
v_mfma_f32_16x16x32_bf16 v[200:203], a[40:43], v[72:75], v[200:203]
s_add_u32 s101, s101, 0x2000
v_exp_f32 v30, v30
v_mfma_f32_16x16x32_bf16 v[232:235], a[40:43], v[76:79], v[232:235]
buffer_load_dwordx4 a[104:107], v3, s[88:91], s101 offen sc1
v_mfma_f32_16x16x32_bf16 v[236:239], a[44:47], v[76:79], v[236:239]
v_exp_f32 v31, v31
v_mfma_f32_16x16x32_bf16 v[204:207], a[44:47], v[72:75], v[204:207]
buffer_load_dwordx4 a[108:111], v3, s[88:91], s101 offen offset:1024 sc1
v_mfma_f32_16x16x32_bf16 v[208:211], a[48:51], v[72:75], v[208:211]
s_add_u32 s101, s101, 0x2000
v_cvt_pk_bf16_f32 v60, v28, v29
v_cvt_pk_bf16_f32 v61, v30, v31
v_mfma_f32_16x16x32_bf16 v[240:243], a[48:51], v[76:79], v[240:243]
buffer_load_dwordx4 a[112:115], v3, s[88:91], s101 offen sc1
v_mfma_f32_16x16x32_bf16 v[244:247], a[52:55], v[76:79], v[244:247]
v_exp_f32 v44, v44
v_mfma_f32_16x16x32_bf16 v[212:215], a[52:55], v[72:75], v[212:215]
buffer_load_dwordx4 a[116:119], v3, s[88:91], s101 offen offset:1024 sc1
v_mfma_f32_16x16x32_bf16 v[216:219], a[56:59], v[72:75], v[216:219]
s_add_u32 s101, s101, 0x2000
v_exp_f32 v45, v45
v_mfma_f32_16x16x32_bf16 v[248:251], a[56:59], v[76:79], v[248:251]
buffer_load_dwordx4 a[120:123], v3, s[88:91], s101 offen sc1
v_mfma_f32_16x16x32_bf16 v[252:255], a[60:63], v[76:79], v[252:255]
v_exp_f32 v46, v46
v_mfma_f32_16x16x32_bf16 v[220:223], a[60:63], v[72:75], v[220:223]
buffer_load_dwordx4 a[124:127], v3, s[88:91], s101 offen offset:1024 sc1
v_mfma_f32_16x16x32_bf16 a[232:235], a[240:243], v[72:75], a[232:235]
v_exp_f32 v47, v47
v_mfma_f32_16x16x32_bf16 a[236:239], a[240:243], v[76:79], a[236:239]
ds_read_b128 a[32:35], v2 offset:24576
ds_read_b128 a[36:39], v2 offset:25600
ds_read_b128 a[40:43], v2 offset:26624
ds_read_b128 a[44:47], v2 offset:27648
ds_read_b128 a[48:51], v2 offset:28672
ds_read_b128 a[52:55], v2 offset:29696
ds_read_b128 a[56:59], v2 offset:30720
ds_read_b128 a[60:63], v2 offset:31744
v_cvt_pk_bf16_f32 v62, v44, v45
v_cvt_pk_bf16_f32 v63, v46, v47
v_xor_b32 v2, 0x38000, v2
s_waitcnt  lgkmcnt(0)
s_barrier
s_nop 7
s_add_u32 m0, s17, 0x18000
v_add_u32 v12, 0x40000, v12
s_nop 0
buffer_load_dwordx4 v12, s[72:75], 0 offen lds
buffer_load_dwordx4 v12, s[72:75], s12 offen offset:1024 lds
buffer_load_dwordx4 v12, s[72:75], s13 offen offset:2048 lds
buffer_load_dwordx4 v12, s[72:75], s14 offen offset:3072 lds
s_add_u32 s101, s101, 0x2000
s_nop 0
buffer_load_dwordx4 a[128:131], v3, s[88:91], s101 offen sc1
buffer_load_dwordx4 a[132:135], v3, s[88:91], s101 offen offset:1024 sc1
v_mfma_f32_16x16x32_bf16 v[224:227], a[32:35], v[60:63], v[224:227]
v_mfma_f32_16x16x32_bf16 v[228:231], a[36:39], v[60:63], v[228:231]
v_mfma_f32_16x16x32_bf16 v[232:235], a[40:43], v[60:63], v[232:235]
v_mfma_f32_16x16x32_bf16 v[236:239], a[44:47], v[60:63], v[236:239]
v_mfma_f32_16x16x32_bf16 v[240:243], a[48:51], v[60:63], v[240:243]
v_mfma_f32_16x16x32_bf16 v[244:247], a[52:55], v[60:63], v[244:247]
v_mfma_f32_16x16x32_bf16 v[248:251], a[56:59], v[60:63], v[248:251]
v_mfma_f32_16x16x32_bf16 v[252:255], a[60:63], v[60:63], v[252:255]
v_mfma_f32_16x16x32_bf16 a[236:239], a[240:243], v[60:63], a[236:239]
s_waitcnt lgkmcnt(0)
s_nop 7
s_add_u32 s101, s101, 0x2000
s_nop 0
buffer_load_dwordx4 a[136:139], v3, s[88:91], s101 offen sc1
buffer_load_dwordx4 a[140:143], v3, s[88:91], s101 offen offset:1024 sc1
s_add_u32 s101, s101, 0x2000
s_nop 0
buffer_load_dwordx4 a[144:147], v3, s[88:91], s101 offen sc1
buffer_load_dwordx4 a[148:151], v3, s[88:91], s101 offen offset:1024 sc1
s_add_u32 s101, s101, 0x2000
s_nop 0
buffer_load_dwordx4 a[152:155], v3, s[88:91], s101 offen sc1
buffer_load_dwordx4 a[156:159], v3, s[88:91], s101 offen offset:1024 sc1
v_xor_b32 v1, 0x8000, v1
L_att_fin:
s_nop 7
v_accvgpr_read_b32 v4, a232
v_accvgpr_read_b32 v6, a236
s_mov_b32 s8, 0x5f800000
v_cmp_nge_f32 s[36:37], s8, v4
v_cmp_nge_f32 s[38:39], s8, v6
v_rcp_f32 v4, v4
v_rcp_f32 v6, v6
s_or_b64 s[34:35], s[34:35], s[36:37]
s_or_b64 s[34:35], s[34:35], s[38:39]
v_pk_mul_f32 v[192:193], v[192:193], v[4:5] op_sel_hi:[1,0]
v_pk_mul_f32 v[194:195], v[194:195], v[4:5] op_sel_hi:[1,0]
v_pk_mul_f32 v[196:197], v[196:197], v[4:5] op_sel_hi:[1,0]
v_pk_mul_f32 v[198:199], v[198:199], v[4:5] op_sel_hi:[1,0]
v_cvt_pk_bf16_f32 v192, v192, v193
v_cvt_pk_bf16_f32 v193, v194, v195
v_cvt_pk_bf16_f32 v194, v196, v197
v_cvt_pk_bf16_f32 v195, v198, v199
s_add_u32 s8, s30, 0x0
buffer_store_dwordx4 v[192:195], v3, s[88:91], s8 offen sc1
v_pk_mul_f32 v[200:201], v[200:201], v[4:5] op_sel_hi:[1,0]
v_pk_mul_f32 v[202:203], v[202:203], v[4:5] op_sel_hi:[1,0]
v_pk_mul_f32 v[204:205], v[204:205], v[4:5] op_sel_hi:[1,0]
v_pk_mul_f32 v[206:207], v[206:207], v[4:5] op_sel_hi:[1,0]
v_cvt_pk_bf16_f32 v200, v200, v201
v_cvt_pk_bf16_f32 v201, v202, v203
v_cvt_pk_bf16_f32 v202, v204, v205
v_cvt_pk_bf16_f32 v203, v206, v207
s_add_u32 s8, s30, 0x2000
buffer_store_dwordx4 v[200:203], v3, s[88:91], s8 offen sc1
v_pk_mul_f32 v[208:209], v[208:209], v[4:5] op_sel_hi:[1,0]
v_pk_mul_f32 v[210:211], v[210:211], v[4:5] op_sel_hi:[1,0]
v_pk_mul_f32 v[212:213], v[212:213], v[4:5] op_sel_hi:[1,0]
v_pk_mul_f32 v[214:215], v[214:215], v[4:5] op_sel_hi:[1,0]
v_cvt_pk_bf16_f32 v208, v208, v209
v_cvt_pk_bf16_f32 v209, v210, v211
v_cvt_pk_bf16_f32 v210, v212, v213
v_cvt_pk_bf16_f32 v211, v214, v215
s_add_u32 s8, s30, 0x4000
buffer_store_dwordx4 v[208:211], v3, s[88:91], s8 offen sc1
v_pk_mul_f32 v[216:217], v[216:217], v[4:5] op_sel_hi:[1,0]
v_pk_mul_f32 v[218:219], v[218:219], v[4:5] op_sel_hi:[1,0]
v_pk_mul_f32 v[220:221], v[220:221], v[4:5] op_sel_hi:[1,0]
v_pk_mul_f32 v[222:223], v[222:223], v[4:5] op_sel_hi:[1,0]
v_cvt_pk_bf16_f32 v216, v216, v217
v_cvt_pk_bf16_f32 v217, v218, v219
v_cvt_pk_bf16_f32 v218, v220, v221
v_cvt_pk_bf16_f32 v219, v222, v223
s_add_u32 s8, s30, 0x6000
buffer_store_dwordx4 v[216:219], v3, s[88:91], s8 offen sc1
v_pk_mul_f32 v[224:225], v[224:225], v[6:7] op_sel_hi:[1,0]
v_pk_mul_f32 v[226:227], v[226:227], v[6:7] op_sel_hi:[1,0]
v_pk_mul_f32 v[228:229], v[228:229], v[6:7] op_sel_hi:[1,0]
v_pk_mul_f32 v[230:231], v[230:231], v[6:7] op_sel_hi:[1,0]
v_cvt_pk_bf16_f32 v224, v224, v225
v_cvt_pk_bf16_f32 v225, v226, v227
v_cvt_pk_bf16_f32 v226, v228, v229
v_cvt_pk_bf16_f32 v227, v230, v231
s_add_u32 s8, s31, 0x0
buffer_store_dwordx4 v[224:227], v3, s[88:91], s8 offen sc1
v_pk_mul_f32 v[232:233], v[232:233], v[6:7] op_sel_hi:[1,0]
v_pk_mul_f32 v[234:235], v[234:235], v[6:7] op_sel_hi:[1,0]
v_pk_mul_f32 v[236:237], v[236:237], v[6:7] op_sel_hi:[1,0]
v_pk_mul_f32 v[238:239], v[238:239], v[6:7] op_sel_hi:[1,0]
v_cvt_pk_bf16_f32 v232, v232, v233
v_cvt_pk_bf16_f32 v233, v234, v235
v_cvt_pk_bf16_f32 v234, v236, v237
v_cvt_pk_bf16_f32 v235, v238, v239
s_add_u32 s8, s31, 0x2000
buffer_store_dwordx4 v[232:235], v3, s[88:91], s8 offen sc1
v_pk_mul_f32 v[240:241], v[240:241], v[6:7] op_sel_hi:[1,0]
v_pk_mul_f32 v[242:243], v[242:243], v[6:7] op_sel_hi:[1,0]
v_pk_mul_f32 v[244:245], v[244:245], v[6:7] op_sel_hi:[1,0]
v_pk_mul_f32 v[246:247], v[246:247], v[6:7] op_sel_hi:[1,0]
v_cvt_pk_bf16_f32 v240, v240, v241
v_cvt_pk_bf16_f32 v241, v242, v243
v_cvt_pk_bf16_f32 v242, v244, v245
v_cvt_pk_bf16_f32 v243, v246, v247
s_add_u32 s8, s31, 0x4000
buffer_store_dwordx4 v[240:243], v3, s[88:91], s8 offen sc1
v_pk_mul_f32 v[248:249], v[248:249], v[6:7] op_sel_hi:[1,0]
v_pk_mul_f32 v[250:251], v[250:251], v[6:7] op_sel_hi:[1,0]
v_pk_mul_f32 v[252:253], v[252:253], v[6:7] op_sel_hi:[1,0]
v_pk_mul_f32 v[254:255], v[254:255], v[6:7] op_sel_hi:[1,0]
v_cvt_pk_bf16_f32 v248, v248, v249
v_cvt_pk_bf16_f32 v249, v250, v251
v_cvt_pk_bf16_f32 v250, v252, v253
v_cvt_pk_bf16_f32 v251, v254, v255
s_add_u32 s8, s31, 0x6000
buffer_store_dwordx4 v[248:251], v3, s[88:91], s8 offen sc1
s_cmp_lg_u64 s[34:35], 0
s_cselect_b32 s8, 1, 0
s_lshl_b32 s9, s4, 2
s_add_u32 s9, s9, 131072
v_mov_b32 v4, s9
v_mov_b32 v5, s8
ds_write_b32 v4, v5
v_lshrrev_b32 v17, 2, v0
v_bfe_u32 v18, v0, 3, 2
v_lshlrev_b32 v18, 5, v18
v_lshl_add_u32 v17, v17, 7, v18
v_and_b32 v18, 3, v0
v_lshl_add_u32 v17, v18, 3, v17
v_add_u32 v4, 65536, v17
v_xor_b32 v5, 32, v4
v_xor_b32 v6, 64, v4
v_xor_b32 v7, 0x60, v4
v_and_b32 v20, 31, v0
v_lshlrev_b32 v20, 2, v20
s_waitcnt vmcnt(28) lgkmcnt(0)
s_barrier
v_and_b32 v17, 3, v0
v_lshlrev_b32 v17, 2, v17
v_add_u32 v17, 131072, v17
ds_read_b32 v18, v17
s_waitcnt lgkmcnt(0)
v_cmp_ne_u32 vcc, 0, v18
s_cmp_lg_u32 s33, 0
s_cbranch_scc1 L_att_done
s_nop 4
s_cbranch_vccnz L_att_fallback
L_att_done:
ds_read_b64_tr_b16 v[88:89], v4 offset:0
ds_read_b64_tr_b16 v[90:91], v4 offset:2048
ds_read_b64_tr_b16 v[92:93], v5 offset:0
ds_read_b64_tr_b16 v[94:95], v5 offset:2048
ds_read_b64_tr_b16 v[96:97], v6 offset:0
ds_read_b64_tr_b16 v[98:99], v6 offset:2048
ds_read_b64_tr_b16 v[100:101], v7 offset:0
ds_read_b64_tr_b16 v[102:103], v7 offset:2048
s_add_u32 m0, s17, 0x1c000
v_add_u32 v12, 0x40000, v12
s_nop 0
buffer_load_dwordx4 v12, s[72:75], 0 offen lds
buffer_load_dwordx4 v12, s[72:75], s12 offen offset:1024 lds
buffer_load_dwordx4 v12, s[72:75], s13 offen offset:2048 lds
s_waitcnt lgkmcnt(0)
v_mfma_f32_16x16x32_bf16 v[24:27], v[88:91], a[64:67], 0
ds_read_b64_tr_b16 v[104:105], v4 offset:4096
ds_read_b64_tr_b16 v[106:107], v4 offset:6144
v_mfma_f32_16x16x32_bf16 v[40:43], v[88:91], a[68:71], 0
ds_read_b64_tr_b16 v[108:109], v5 offset:4096
ds_read_b64_tr_b16 v[110:111], v5 offset:6144
v_mfma_f32_16x16x32_bf16 v[44:47], v[92:95], a[68:71], 0
ds_read_b64_tr_b16 v[112:113], v6 offset:4096
ds_read_b64_tr_b16 v[114:115], v6 offset:6144
v_mfma_f32_16x16x32_bf16 v[28:31], v[92:95], a[64:67], 0
ds_read_b64_tr_b16 v[116:117], v7 offset:4096
ds_read_b64_tr_b16 v[118:119], v7 offset:6144
v_mfma_f32_16x16x32_bf16 v[32:35], v[96:99], a[64:67], 0
buffer_load_dwordx4 v12, s[72:75], s14 offen offset:3072 lds
s_add_u32 s101, s101, 0x2000
v_mfma_f32_16x16x32_bf16 v[48:51], v[96:99], a[68:71], 0
buffer_load_dwordx4 a[160:163], v3, s[88:91], s101 offen sc1
v_mfma_f32_16x16x32_bf16 v[52:55], v[100:103], a[68:71], 0
buffer_load_dwordx4 a[164:167], v3, s[88:91], s101 offen offset:1024 sc1
v_mfma_f32_16x16x32_bf16 v[36:39], v[100:103], a[64:67], 0
s_waitcnt lgkmcnt(0)
v_mfma_f32_16x16x32_bf16 v[24:27], v[104:107], a[72:75], v[24:27]
ds_read_b64_tr_b16 v[88:89], v4 offset:8192
ds_read_b64_tr_b16 v[90:91], v4 offset:10240
v_mfma_f32_16x16x32_bf16 v[40:43], v[104:107], a[76:79], v[40:43]
ds_read_b64_tr_b16 v[92:93], v5 offset:8192
ds_read_b64_tr_b16 v[94:95], v5 offset:10240
v_mfma_f32_16x16x32_bf16 v[44:47], v[108:111], a[76:79], v[44:47]
ds_read_b64_tr_b16 v[96:97], v6 offset:8192
ds_read_b64_tr_b16 v[98:99], v6 offset:10240
v_mfma_f32_16x16x32_bf16 v[28:31], v[108:111], a[72:75], v[28:31]
ds_read_b64_tr_b16 v[100:101], v7 offset:8192
ds_read_b64_tr_b16 v[102:103], v7 offset:10240
s_add_u32 s101, s101, 0x2000
v_mfma_f32_16x16x32_bf16 v[32:35], v[112:115], a[72:75], v[32:35]
buffer_load_dwordx4 a[168:171], v3, s[88:91], s101 offen sc1
v_mfma_f32_16x16x32_bf16 v[48:51], v[112:115], a[76:79], v[48:51]
buffer_load_dwordx4 a[172:175], v3, s[88:91], s101 offen offset:1024 sc1
s_add_u32 s101, s101, 0x2000
v_mfma_f32_16x16x32_bf16 v[52:55], v[116:119], a[76:79], v[52:55]
buffer_load_dwordx4 a[176:179], v3, s[88:91], s101 offen sc1
v_mfma_f32_16x16x32_bf16 v[36:39], v[116:119], a[72:75], v[36:39]
s_waitcnt lgkmcnt(0)
v_mfma_f32_16x16x32_bf16 v[24:27], v[88:91], a[80:83], v[24:27]
ds_read_b64_tr_b16 v[104:105], v4 offset:12288
ds_read_b64_tr_b16 v[106:107], v4 offset:14336
v_mfma_f32_16x16x32_bf16 v[40:43], v[88:91], a[84:87], v[40:43]
ds_read_b64_tr_b16 v[108:109], v5 offset:12288
ds_read_b64_tr_b16 v[110:111], v5 offset:14336
v_mfma_f32_16x16x32_bf16 v[44:47], v[92:95], a[84:87], v[44:47]
ds_read_b64_tr_b16 v[112:113], v6 offset:12288
ds_read_b64_tr_b16 v[114:115], v6 offset:14336
v_mfma_f32_16x16x32_bf16 v[28:31], v[92:95], a[80:83], v[28:31]
ds_read_b64_tr_b16 v[116:117], v7 offset:12288
ds_read_b64_tr_b16 v[118:119], v7 offset:14336
v_mfma_f32_16x16x32_bf16 v[32:35], v[96:99], a[80:83], v[32:35]
buffer_load_dwordx4 a[180:183], v3, s[88:91], s101 offen offset:1024 sc1
s_add_u32 s101, s101, 0x2000
v_mfma_f32_16x16x32_bf16 v[48:51], v[96:99], a[84:87], v[48:51]
buffer_load_dwordx4 a[184:187], v3, s[88:91], s101 offen sc1
v_mfma_f32_16x16x32_bf16 v[52:55], v[100:103], a[84:87], v[52:55]
buffer_load_dwordx4 a[188:191], v3, s[88:91], s101 offen offset:1024 sc1
v_mfma_f32_16x16x32_bf16 v[36:39], v[100:103], a[80:83], v[36:39]
s_waitcnt vmcnt(12) lgkmcnt(0)
s_barrier
s_cmp_lg_u32 s4, 0
s_cbranch_scc1 L_flag_set
s_lshl_b32 s8, s6, 5
s_add_u32 s8, s8, s5
s_lshl_b32 s8, s8, 2
s_add_u32 s8, s8, 0x3604000
v_mov_b32 v17, 1
s_mov_b64 exec, 1
buffer_store_dword v17, off, s[88:91], s8 sc1
s_mov_b64 exec, -1
L_flag_set:
v_mfma_f32_16x16x32_bf16 v[24:27], v[104:107], a[88:91], v[24:27]
ds_read_b64_tr_b16 v[88:89], v4 offset:16384
ds_read_b64_tr_b16 v[90:91], v4 offset:18432
v_mfma_f32_16x16x32_bf16 v[40:43], v[104:107], a[92:95], v[40:43]
ds_read_b64_tr_b16 v[92:93], v5 offset:16384
ds_read_b64_tr_b16 v[94:95], v5 offset:18432
v_mfma_f32_16x16x32_bf16 v[44:47], v[108:111], a[92:95], v[44:47]
ds_read_b64_tr_b16 v[96:97], v6 offset:16384
ds_read_b64_tr_b16 v[98:99], v6 offset:18432
v_mfma_f32_16x16x32_bf16 v[28:31], v[108:111], a[88:91], v[28:31]
ds_read_b64_tr_b16 v[100:101], v7 offset:16384
ds_read_b64_tr_b16 v[102:103], v7 offset:18432
s_add_u32 m0, s17, 0x10000
v_add_u32 v12, 0x40000, v12
v_mfma_f32_16x16x32_bf16 v[32:35], v[112:115], a[88:91], v[32:35]
buffer_load_dwordx4 v12, s[72:75], 0 offen lds
v_mfma_f32_16x16x32_bf16 v[48:51], v[112:115], a[92:95], v[48:51]
buffer_load_dwordx4 v12, s[72:75], s12 offen offset:1024 lds
v_mfma_f32_16x16x32_bf16 v[52:55], v[116:119], a[92:95], v[52:55]
buffer_load_dwordx4 v12, s[72:75], s13 offen offset:2048 lds
v_mfma_f32_16x16x32_bf16 v[36:39], v[116:119], a[88:91], v[36:39]
s_waitcnt lgkmcnt(0)
v_mfma_f32_16x16x32_bf16 v[24:27], v[88:91], a[96:99], v[24:27]
ds_read_b64_tr_b16 v[104:105], v4 offset:20480
ds_read_b64_tr_b16 v[106:107], v4 offset:22528
v_mfma_f32_16x16x32_bf16 v[40:43], v[88:91], a[100:103], v[40:43]
ds_read_b64_tr_b16 v[108:109], v5 offset:20480
ds_read_b64_tr_b16 v[110:111], v5 offset:22528
v_mfma_f32_16x16x32_bf16 v[44:47], v[92:95], a[100:103], v[44:47]
ds_read_b64_tr_b16 v[112:113], v6 offset:20480
ds_read_b64_tr_b16 v[114:115], v6 offset:22528
v_mfma_f32_16x16x32_bf16 v[28:31], v[92:95], a[96:99], v[28:31]
ds_read_b64_tr_b16 v[116:117], v7 offset:20480
ds_read_b64_tr_b16 v[118:119], v7 offset:22528
v_mfma_f32_16x16x32_bf16 v[32:35], v[96:99], a[96:99], v[32:35]
buffer_load_dwordx4 v12, s[72:75], s14 offen offset:3072 lds
s_add_u32 s101, s101, 0x2000
v_mfma_f32_16x16x32_bf16 v[48:51], v[96:99], a[100:103], v[48:51]
buffer_load_dwordx4 a[64:67], v3, s[88:91], s101 offen sc1
v_mfma_f32_16x16x32_bf16 v[52:55], v[100:103], a[100:103], v[52:55]
buffer_load_dwordx4 a[68:71], v3, s[88:91], s101 offen offset:1024 sc1
v_mfma_f32_16x16x32_bf16 v[36:39], v[100:103], a[96:99], v[36:39]
s_waitcnt lgkmcnt(0)
v_mfma_f32_16x16x32_bf16 v[24:27], v[104:107], a[104:107], v[24:27]
ds_read_b64_tr_b16 v[88:89], v4 offset:24576
ds_read_b64_tr_b16 v[90:91], v4 offset:26624
v_mfma_f32_16x16x32_bf16 v[40:43], v[104:107], a[108:111], v[40:43]
ds_read_b64_tr_b16 v[92:93], v5 offset:24576
ds_read_b64_tr_b16 v[94:95], v5 offset:26624
v_mfma_f32_16x16x32_bf16 v[44:47], v[108:111], a[108:111], v[44:47]
ds_read_b64_tr_b16 v[96:97], v6 offset:24576
ds_read_b64_tr_b16 v[98:99], v6 offset:26624
v_mfma_f32_16x16x32_bf16 v[28:31], v[108:111], a[104:107], v[28:31]
ds_read_b64_tr_b16 v[100:101], v7 offset:24576
ds_read_b64_tr_b16 v[102:103], v7 offset:26624
s_add_u32 s101, s101, 0x2000
v_mfma_f32_16x16x32_bf16 v[32:35], v[112:115], a[104:107], v[32:35]
buffer_load_dwordx4 a[72:75], v3, s[88:91], s101 offen sc1
v_mfma_f32_16x16x32_bf16 v[48:51], v[112:115], a[108:111], v[48:51]
buffer_load_dwordx4 a[76:79], v3, s[88:91], s101 offen offset:1024 sc1
s_add_u32 s101, s101, 0x2000
v_mfma_f32_16x16x32_bf16 v[52:55], v[116:119], a[108:111], v[52:55]
buffer_load_dwordx4 a[80:83], v3, s[88:91], s101 offen sc1
v_mfma_f32_16x16x32_bf16 v[36:39], v[116:119], a[104:107], v[36:39]
s_waitcnt lgkmcnt(0)
v_mfma_f32_16x16x32_bf16 v[24:27], v[88:91], a[112:115], v[24:27]
ds_read_b64_tr_b16 v[104:105], v4 offset:28672
ds_read_b64_tr_b16 v[106:107], v4 offset:30720
v_mfma_f32_16x16x32_bf16 v[40:43], v[88:91], a[116:119], v[40:43]
ds_read_b64_tr_b16 v[108:109], v5 offset:28672
ds_read_b64_tr_b16 v[110:111], v5 offset:30720
v_mfma_f32_16x16x32_bf16 v[44:47], v[92:95], a[116:119], v[44:47]
ds_read_b64_tr_b16 v[112:113], v6 offset:28672
ds_read_b64_tr_b16 v[114:115], v6 offset:30720
v_mfma_f32_16x16x32_bf16 v[28:31], v[92:95], a[112:115], v[28:31]
ds_read_b64_tr_b16 v[116:117], v7 offset:28672
ds_read_b64_tr_b16 v[118:119], v7 offset:30720
v_mfma_f32_16x16x32_bf16 v[32:35], v[96:99], a[112:115], v[32:35]
buffer_load_dwordx4 a[84:87], v3, s[88:91], s101 offen offset:1024 sc1
s_add_u32 s101, s101, 0x2000
v_mfma_f32_16x16x32_bf16 v[48:51], v[96:99], a[116:119], v[48:51]
buffer_load_dwordx4 a[88:91], v3, s[88:91], s101 offen sc1
v_mfma_f32_16x16x32_bf16 v[52:55], v[100:103], a[116:119], v[52:55]
buffer_load_dwordx4 a[92:95], v3, s[88:91], s101 offen offset:1024 sc1
v_mfma_f32_16x16x32_bf16 v[36:39], v[100:103], a[112:115], v[36:39]
s_waitcnt vmcnt(32) lgkmcnt(0)
s_barrier
v_mfma_f32_16x16x32_bf16 v[24:27], v[104:107], a[120:123], v[24:27]
ds_read_b64_tr_b16 v[88:89], v4 offset:32768
ds_read_b64_tr_b16 v[90:91], v4 offset:34816
v_mfma_f32_16x16x32_bf16 v[40:43], v[104:107], a[124:127], v[40:43]
ds_read_b64_tr_b16 v[92:93], v5 offset:32768
ds_read_b64_tr_b16 v[94:95], v5 offset:34816
v_mfma_f32_16x16x32_bf16 v[44:47], v[108:111], a[124:127], v[44:47]
ds_read_b64_tr_b16 v[96:97], v6 offset:32768
ds_read_b64_tr_b16 v[98:99], v6 offset:34816
v_mfma_f32_16x16x32_bf16 v[28:31], v[108:111], a[120:123], v[28:31]
ds_read_b64_tr_b16 v[100:101], v7 offset:32768
ds_read_b64_tr_b16 v[102:103], v7 offset:34816
s_add_u32 m0, s17, 0x14000
v_add_u32 v12, 0x40000, v12
v_mfma_f32_16x16x32_bf16 v[32:35], v[112:115], a[120:123], v[32:35]
buffer_load_dwordx4 v12, s[72:75], 0 offen lds
v_mfma_f32_16x16x32_bf16 v[48:51], v[112:115], a[124:127], v[48:51]
buffer_load_dwordx4 v12, s[72:75], s12 offen offset:1024 lds
v_mfma_f32_16x16x32_bf16 v[52:55], v[116:119], a[124:127], v[52:55]
buffer_load_dwordx4 v12, s[72:75], s13 offen offset:2048 lds
v_mfma_f32_16x16x32_bf16 v[36:39], v[116:119], a[120:123], v[36:39]
s_waitcnt lgkmcnt(0)
v_mfma_f32_16x16x32_bf16 v[24:27], v[88:91], a[128:131], v[24:27]
ds_read_b64_tr_b16 v[104:105], v4 offset:36864
ds_read_b64_tr_b16 v[106:107], v4 offset:38912
v_mfma_f32_16x16x32_bf16 v[40:43], v[88:91], a[132:135], v[40:43]
ds_read_b64_tr_b16 v[108:109], v5 offset:36864
ds_read_b64_tr_b16 v[110:111], v5 offset:38912
v_mfma_f32_16x16x32_bf16 v[44:47], v[92:95], a[132:135], v[44:47]
ds_read_b64_tr_b16 v[112:113], v6 offset:36864
ds_read_b64_tr_b16 v[114:115], v6 offset:38912
v_mfma_f32_16x16x32_bf16 v[28:31], v[92:95], a[128:131], v[28:31]
ds_read_b64_tr_b16 v[116:117], v7 offset:36864
ds_read_b64_tr_b16 v[118:119], v7 offset:38912
v_mfma_f32_16x16x32_bf16 v[32:35], v[96:99], a[128:131], v[32:35]
buffer_load_dwordx4 v12, s[72:75], s14 offen offset:3072 lds
s_add_u32 s101, s101, 0x2000
v_mfma_f32_16x16x32_bf16 v[48:51], v[96:99], a[132:135], v[48:51]
buffer_load_dwordx4 a[96:99], v3, s[88:91], s101 offen sc1
v_mfma_f32_16x16x32_bf16 v[52:55], v[100:103], a[132:135], v[52:55]
buffer_load_dwordx4 a[100:103], v3, s[88:91], s101 offen offset:1024 sc1
v_mfma_f32_16x16x32_bf16 v[36:39], v[100:103], a[128:131], v[36:39]
s_waitcnt lgkmcnt(0)
v_mfma_f32_16x16x32_bf16 v[24:27], v[104:107], a[136:139], v[24:27]
ds_read_b64_tr_b16 v[88:89], v4 offset:40960
ds_read_b64_tr_b16 v[90:91], v4 offset:43008
v_mfma_f32_16x16x32_bf16 v[40:43], v[104:107], a[140:143], v[40:43]
ds_read_b64_tr_b16 v[92:93], v5 offset:40960
ds_read_b64_tr_b16 v[94:95], v5 offset:43008
v_mfma_f32_16x16x32_bf16 v[44:47], v[108:111], a[140:143], v[44:47]
ds_read_b64_tr_b16 v[96:97], v6 offset:40960
ds_read_b64_tr_b16 v[98:99], v6 offset:43008
v_mfma_f32_16x16x32_bf16 v[28:31], v[108:111], a[136:139], v[28:31]
ds_read_b64_tr_b16 v[100:101], v7 offset:40960
ds_read_b64_tr_b16 v[102:103], v7 offset:43008
s_add_u32 s101, s101, 0x2000
v_mfma_f32_16x16x32_bf16 v[32:35], v[112:115], a[136:139], v[32:35]
buffer_load_dwordx4 a[104:107], v3, s[88:91], s101 offen sc1
v_mfma_f32_16x16x32_bf16 v[48:51], v[112:115], a[140:143], v[48:51]
buffer_load_dwordx4 a[108:111], v3, s[88:91], s101 offen offset:1024 sc1
s_add_u32 s101, s101, 0x2000
v_mfma_f32_16x16x32_bf16 v[52:55], v[116:119], a[140:143], v[52:55]
buffer_load_dwordx4 a[112:115], v3, s[88:91], s101 offen sc1
v_mfma_f32_16x16x32_bf16 v[36:39], v[116:119], a[136:139], v[36:39]
s_waitcnt lgkmcnt(0)
v_mfma_f32_16x16x32_bf16 v[24:27], v[88:91], a[144:147], v[24:27]
ds_read_b64_tr_b16 v[104:105], v4 offset:45056
ds_read_b64_tr_b16 v[106:107], v4 offset:47104
v_mfma_f32_16x16x32_bf16 v[40:43], v[88:91], a[148:151], v[40:43]
ds_read_b64_tr_b16 v[108:109], v5 offset:45056
ds_read_b64_tr_b16 v[110:111], v5 offset:47104
v_mfma_f32_16x16x32_bf16 v[44:47], v[92:95], a[148:151], v[44:47]
ds_read_b64_tr_b16 v[112:113], v6 offset:45056
ds_read_b64_tr_b16 v[114:115], v6 offset:47104
v_mfma_f32_16x16x32_bf16 v[28:31], v[92:95], a[144:147], v[28:31]
ds_read_b64_tr_b16 v[116:117], v7 offset:45056
ds_read_b64_tr_b16 v[118:119], v7 offset:47104
v_mfma_f32_16x16x32_bf16 v[32:35], v[96:99], a[144:147], v[32:35]
buffer_load_dwordx4 a[116:119], v3, s[88:91], s101 offen offset:1024 sc1
s_add_u32 s101, s101, 0x2000
v_mfma_f32_16x16x32_bf16 v[48:51], v[96:99], a[148:151], v[48:51]
buffer_load_dwordx4 a[120:123], v3, s[88:91], s101 offen sc1
v_mfma_f32_16x16x32_bf16 v[52:55], v[100:103], a[148:151], v[52:55]
buffer_load_dwordx4 a[124:127], v3, s[88:91], s101 offen offset:1024 sc1
v_mfma_f32_16x16x32_bf16 v[36:39], v[100:103], a[144:147], v[36:39]
s_waitcnt vmcnt(24) lgkmcnt(0)
s_barrier
v_mfma_f32_16x16x32_bf16 v[24:27], v[104:107], a[152:155], v[24:27]
ds_read_b64_tr_b16 v[88:89], v4 offset:49152
ds_read_b64_tr_b16 v[90:91], v4 offset:51200
v_mfma_f32_16x16x32_bf16 v[40:43], v[104:107], a[156:159], v[40:43]
ds_read_b64_tr_b16 v[92:93], v5 offset:49152
ds_read_b64_tr_b16 v[94:95], v5 offset:51200
v_mfma_f32_16x16x32_bf16 v[44:47], v[108:111], a[156:159], v[44:47]
ds_read_b64_tr_b16 v[96:97], v6 offset:49152
ds_read_b64_tr_b16 v[98:99], v6 offset:51200
v_mfma_f32_16x16x32_bf16 v[28:31], v[108:111], a[152:155], v[28:31]
ds_read_b64_tr_b16 v[100:101], v7 offset:49152
ds_read_b64_tr_b16 v[102:103], v7 offset:51200
s_add_u32 m0, s17, 0x18000
v_add_u32 v12, 0x40000, v12
v_mfma_f32_16x16x32_bf16 v[32:35], v[112:115], a[152:155], v[32:35]
buffer_load_dwordx4 v12, s[72:75], 0 offen lds
v_mfma_f32_16x16x32_bf16 v[48:51], v[112:115], a[156:159], v[48:51]
buffer_load_dwordx4 v12, s[72:75], s12 offen offset:1024 lds
v_mfma_f32_16x16x32_bf16 v[52:55], v[116:119], a[156:159], v[52:55]
buffer_load_dwordx4 v12, s[72:75], s13 offen offset:2048 lds
v_mfma_f32_16x16x32_bf16 v[36:39], v[116:119], a[152:155], v[36:39]
s_waitcnt lgkmcnt(0)
v_mfma_f32_16x16x32_bf16 v[24:27], v[88:91], a[160:163], v[24:27]
ds_read_b64_tr_b16 v[104:105], v4 offset:53248
ds_read_b64_tr_b16 v[106:107], v4 offset:55296
v_mfma_f32_16x16x32_bf16 v[40:43], v[88:91], a[164:167], v[40:43]
ds_read_b64_tr_b16 v[108:109], v5 offset:53248
ds_read_b64_tr_b16 v[110:111], v5 offset:55296
v_mfma_f32_16x16x32_bf16 v[44:47], v[92:95], a[164:167], v[44:47]
ds_read_b64_tr_b16 v[112:113], v6 offset:53248
ds_read_b64_tr_b16 v[114:115], v6 offset:55296
v_mfma_f32_16x16x32_bf16 v[28:31], v[92:95], a[160:163], v[28:31]
ds_read_b64_tr_b16 v[116:117], v7 offset:53248
ds_read_b64_tr_b16 v[118:119], v7 offset:55296
v_mfma_f32_16x16x32_bf16 v[32:35], v[96:99], a[160:163], v[32:35]
buffer_load_dwordx4 v12, s[72:75], s14 offen offset:3072 lds
s_add_u32 s101, s101, 0x2000
v_mfma_f32_16x16x32_bf16 v[48:51], v[96:99], a[164:167], v[48:51]
buffer_load_dwordx4 a[128:131], v3, s[88:91], s101 offen sc1
v_mfma_f32_16x16x32_bf16 v[52:55], v[100:103], a[164:167], v[52:55]
buffer_load_dwordx4 a[132:135], v3, s[88:91], s101 offen offset:1024 sc1
v_mfma_f32_16x16x32_bf16 v[36:39], v[100:103], a[160:163], v[36:39]
s_waitcnt lgkmcnt(0)
v_mfma_f32_16x16x32_bf16 v[24:27], v[104:107], a[168:171], v[24:27]
ds_read_b64_tr_b16 v[88:89], v4 offset:57344
ds_read_b64_tr_b16 v[90:91], v4 offset:59392
v_mfma_f32_16x16x32_bf16 v[40:43], v[104:107], a[172:175], v[40:43]
ds_read_b64_tr_b16 v[92:93], v5 offset:57344
ds_read_b64_tr_b16 v[94:95], v5 offset:59392
v_mfma_f32_16x16x32_bf16 v[44:47], v[108:111], a[172:175], v[44:47]
ds_read_b64_tr_b16 v[96:97], v6 offset:57344
ds_read_b64_tr_b16 v[98:99], v6 offset:59392
v_mfma_f32_16x16x32_bf16 v[28:31], v[108:111], a[168:171], v[28:31]
ds_read_b64_tr_b16 v[100:101], v7 offset:57344
ds_read_b64_tr_b16 v[102:103], v7 offset:59392
s_add_u32 s101, s101, 0x2000
v_mfma_f32_16x16x32_bf16 v[32:35], v[112:115], a[168:171], v[32:35]
buffer_load_dwordx4 a[136:139], v3, s[88:91], s101 offen sc1
v_mfma_f32_16x16x32_bf16 v[48:51], v[112:115], a[172:175], v[48:51]
buffer_load_dwordx4 a[140:143], v3, s[88:91], s101 offen offset:1024 sc1
s_add_u32 s101, s101, 0x2000
v_mfma_f32_16x16x32_bf16 v[52:55], v[116:119], a[172:175], v[52:55]
buffer_load_dwordx4 a[144:147], v3, s[88:91], s101 offen sc1
v_mfma_f32_16x16x32_bf16 v[36:39], v[116:119], a[168:171], v[36:39]
s_waitcnt lgkmcnt(0)
v_mfma_f32_16x16x32_bf16 v[24:27], v[88:91], a[176:179], v[24:27]
ds_read_b64_tr_b16 v[104:105], v4 offset:61440
ds_read_b64_tr_b16 v[106:107], v4 offset:63488
v_mfma_f32_16x16x32_bf16 v[40:43], v[88:91], a[180:183], v[40:43]
ds_read_b64_tr_b16 v[108:109], v5 offset:61440
ds_read_b64_tr_b16 v[110:111], v5 offset:63488
v_mfma_f32_16x16x32_bf16 v[44:47], v[92:95], a[180:183], v[44:47]
ds_read_b64_tr_b16 v[112:113], v6 offset:61440
ds_read_b64_tr_b16 v[114:115], v6 offset:63488
v_mfma_f32_16x16x32_bf16 v[28:31], v[92:95], a[176:179], v[28:31]
ds_read_b64_tr_b16 v[116:117], v7 offset:61440
ds_read_b64_tr_b16 v[118:119], v7 offset:63488
v_mfma_f32_16x16x32_bf16 v[32:35], v[96:99], a[176:179], v[32:35]
buffer_load_dwordx4 a[148:151], v3, s[88:91], s101 offen offset:1024 sc1
s_add_u32 s101, s101, 0x2000
v_mfma_f32_16x16x32_bf16 v[48:51], v[96:99], a[180:183], v[48:51]
buffer_load_dwordx4 a[152:155], v3, s[88:91], s101 offen sc1
v_mfma_f32_16x16x32_bf16 v[52:55], v[100:103], a[180:183], v[52:55]
buffer_load_dwordx4 a[156:159], v3, s[88:91], s101 offen offset:1024 sc1
v_mfma_f32_16x16x32_bf16 v[36:39], v[100:103], a[176:179], v[36:39]
s_waitcnt vmcnt(24) lgkmcnt(0)
s_barrier
buffer_load_dword v13, v20, s[88:91], s11 offen sc1
v_mfma_f32_16x16x32_bf16 v[24:27], v[104:107], a[184:187], v[24:27]
ds_read_b64_tr_b16 v[88:89], v4 offset:0
ds_read_b64_tr_b16 v[90:91], v4 offset:2048
v_mfma_f32_16x16x32_bf16 v[40:43], v[104:107], a[188:191], v[40:43]
ds_read_b64_tr_b16 v[92:93], v5 offset:0
ds_read_b64_tr_b16 v[94:95], v5 offset:2048
v_mfma_f32_16x16x32_bf16 v[44:47], v[108:111], a[188:191], v[44:47]
ds_read_b64_tr_b16 v[96:97], v6 offset:0
ds_read_b64_tr_b16 v[98:99], v6 offset:2048
v_mfma_f32_16x16x32_bf16 v[28:31], v[108:111], a[184:187], v[28:31]
ds_read_b64_tr_b16 v[100:101], v7 offset:0
ds_read_b64_tr_b16 v[102:103], v7 offset:2048
s_add_u32 m0, s17, 0x1c000
v_add_u32 v12, 0x40000, v12
v_mfma_f32_16x16x32_bf16 v[32:35], v[112:115], a[184:187], v[32:35]
buffer_load_dwordx4 v12, s[72:75], 0 offen lds
v_mfma_f32_16x16x32_bf16 v[48:51], v[112:115], a[188:191], v[48:51]
buffer_load_dwordx4 v12, s[72:75], s12 offen offset:1024 lds
v_mfma_f32_16x16x32_bf16 v[52:55], v[116:119], a[188:191], v[52:55]
buffer_load_dwordx4 v12, s[72:75], s13 offen offset:2048 lds
v_mfma_f32_16x16x32_bf16 v[36:39], v[116:119], a[184:187], v[36:39]
s_waitcnt lgkmcnt(0)
v_mfma_f32_16x16x32_bf16 v[24:27], v[88:91], a[64:67], v[24:27]
ds_read_b64_tr_b16 v[104:105], v4 offset:4096
ds_read_b64_tr_b16 v[106:107], v4 offset:6144
v_mfma_f32_16x16x32_bf16 v[40:43], v[88:91], a[68:71], v[40:43]
ds_read_b64_tr_b16 v[108:109], v5 offset:4096
ds_read_b64_tr_b16 v[110:111], v5 offset:6144
v_mfma_f32_16x16x32_bf16 v[44:47], v[92:95], a[68:71], v[44:47]
ds_read_b64_tr_b16 v[112:113], v6 offset:4096
ds_read_b64_tr_b16 v[114:115], v6 offset:6144
v_mfma_f32_16x16x32_bf16 v[28:31], v[92:95], a[64:67], v[28:31]
ds_read_b64_tr_b16 v[116:117], v7 offset:4096
ds_read_b64_tr_b16 v[118:119], v7 offset:6144
v_mfma_f32_16x16x32_bf16 v[32:35], v[96:99], a[64:67], v[32:35]
buffer_load_dwordx4 v12, s[72:75], s14 offen offset:3072 lds
s_add_u32 s101, s101, 0x2000
v_mfma_f32_16x16x32_bf16 v[48:51], v[96:99], a[68:71], v[48:51]
buffer_load_dwordx4 a[160:163], v3, s[88:91], s101 offen sc1
v_mfma_f32_16x16x32_bf16 v[52:55], v[100:103], a[68:71], v[52:55]
buffer_load_dwordx4 a[164:167], v3, s[88:91], s101 offen offset:1024 sc1
v_mfma_f32_16x16x32_bf16 v[36:39], v[100:103], a[64:67], v[36:39]
s_waitcnt lgkmcnt(0)
v_mfma_f32_16x16x32_bf16 v[24:27], v[104:107], a[72:75], v[24:27]
ds_read_b64_tr_b16 v[88:89], v4 offset:8192
ds_read_b64_tr_b16 v[90:91], v4 offset:10240
v_mfma_f32_16x16x32_bf16 v[40:43], v[104:107], a[76:79], v[40:43]
ds_read_b64_tr_b16 v[92:93], v5 offset:8192
ds_read_b64_tr_b16 v[94:95], v5 offset:10240
v_mfma_f32_16x16x32_bf16 v[44:47], v[108:111], a[76:79], v[44:47]
ds_read_b64_tr_b16 v[96:97], v6 offset:8192
ds_read_b64_tr_b16 v[98:99], v6 offset:10240
v_mfma_f32_16x16x32_bf16 v[28:31], v[108:111], a[72:75], v[28:31]
ds_read_b64_tr_b16 v[100:101], v7 offset:8192
ds_read_b64_tr_b16 v[102:103], v7 offset:10240
s_add_u32 s101, s101, 0x2000
v_mfma_f32_16x16x32_bf16 v[32:35], v[112:115], a[72:75], v[32:35]
buffer_load_dwordx4 a[168:171], v3, s[88:91], s101 offen sc1
v_mfma_f32_16x16x32_bf16 v[48:51], v[112:115], a[76:79], v[48:51]
buffer_load_dwordx4 a[172:175], v3, s[88:91], s101 offen offset:1024 sc1
s_add_u32 s101, s101, 0x2000
v_mfma_f32_16x16x32_bf16 v[52:55], v[116:119], a[76:79], v[52:55]
buffer_load_dwordx4 a[176:179], v3, s[88:91], s101 offen sc1
v_mfma_f32_16x16x32_bf16 v[36:39], v[116:119], a[72:75], v[36:39]
s_waitcnt lgkmcnt(0)
v_mfma_f32_16x16x32_bf16 v[24:27], v[88:91], a[80:83], v[24:27]
ds_read_b64_tr_b16 v[104:105], v4 offset:12288
ds_read_b64_tr_b16 v[106:107], v4 offset:14336
v_mfma_f32_16x16x32_bf16 v[40:43], v[88:91], a[84:87], v[40:43]
ds_read_b64_tr_b16 v[108:109], v5 offset:12288
ds_read_b64_tr_b16 v[110:111], v5 offset:14336
v_mfma_f32_16x16x32_bf16 v[44:47], v[92:95], a[84:87], v[44:47]
ds_read_b64_tr_b16 v[112:113], v6 offset:12288
ds_read_b64_tr_b16 v[114:115], v6 offset:14336
v_mfma_f32_16x16x32_bf16 v[28:31], v[92:95], a[80:83], v[28:31]
ds_read_b64_tr_b16 v[116:117], v7 offset:12288
ds_read_b64_tr_b16 v[118:119], v7 offset:14336
v_mfma_f32_16x16x32_bf16 v[32:35], v[96:99], a[80:83], v[32:35]
buffer_load_dwordx4 a[180:183], v3, s[88:91], s101 offen offset:1024 sc1
s_add_u32 s101, s101, 0x2000
v_mfma_f32_16x16x32_bf16 v[48:51], v[96:99], a[84:87], v[48:51]
buffer_load_dwordx4 a[184:187], v3, s[88:91], s101 offen sc1
v_mfma_f32_16x16x32_bf16 v[52:55], v[100:103], a[84:87], v[52:55]
buffer_load_dwordx4 a[188:191], v3, s[88:91], s101 offen offset:1024 sc1
v_mfma_f32_16x16x32_bf16 v[36:39], v[100:103], a[80:83], v[36:39]
s_waitcnt vmcnt(12) lgkmcnt(0)
s_mov_b32 s92, 200000
L_spin_c:
v_cmp_ne_u32 vcc, 1, v13
s_nop 4
s_cbranch_vccz L_spun_c
s_sub_u32 s92, s92, 1
s_cbranch_scc1 L_spun_c
s_sleep 4
buffer_load_dword v13, v20, s[88:91], s11 offen sc1
s_waitcnt vmcnt(0)
s_branch L_spin_c
L_spun_c:
s_barrier
v_mfma_f32_16x16x32_bf16 v[24:27], v[104:107], a[88:91], v[24:27]
ds_read_b64_tr_b16 v[88:89], v4 offset:16384
ds_read_b64_tr_b16 v[90:91], v4 offset:18432
v_mfma_f32_16x16x32_bf16 v[40:43], v[104:107], a[92:95], v[40:43]
ds_read_b64_tr_b16 v[92:93], v5 offset:16384
ds_read_b64_tr_b16 v[94:95], v5 offset:18432
v_mfma_f32_16x16x32_bf16 v[44:47], v[108:111], a[92:95], v[44:47]
ds_read_b64_tr_b16 v[96:97], v6 offset:16384
ds_read_b64_tr_b16 v[98:99], v6 offset:18432
v_mfma_f32_16x16x32_bf16 v[28:31], v[108:111], a[88:91], v[28:31]
ds_read_b64_tr_b16 v[100:101], v7 offset:16384
ds_read_b64_tr_b16 v[102:103], v7 offset:18432
s_add_u32 m0, s17, 0x10000
v_add_u32 v12, 0xffe40000, v12
v_mfma_f32_16x16x32_bf16 v[32:35], v[112:115], a[88:91], v[32:35]
buffer_load_dwordx4 v12, s[64:67], 0 offen lds
v_mfma_f32_16x16x32_bf16 v[48:51], v[112:115], a[92:95], v[48:51]
buffer_load_dwordx4 v12, s[64:67], s12 offen offset:1024 lds
v_mfma_f32_16x16x32_bf16 v[52:55], v[116:119], a[92:95], v[52:55]
buffer_load_dwordx4 v12, s[64:67], s13 offen offset:2048 lds
v_mfma_f32_16x16x32_bf16 v[36:39], v[116:119], a[88:91], v[36:39]
s_waitcnt lgkmcnt(0)
v_mfma_f32_16x16x32_bf16 v[24:27], v[88:91], a[96:99], v[24:27]
ds_read_b64_tr_b16 v[104:105], v4 offset:20480
ds_read_b64_tr_b16 v[106:107], v4 offset:22528
v_mfma_f32_16x16x32_bf16 v[40:43], v[88:91], a[100:103], v[40:43]
ds_read_b64_tr_b16 v[108:109], v5 offset:20480
ds_read_b64_tr_b16 v[110:111], v5 offset:22528
v_mfma_f32_16x16x32_bf16 v[44:47], v[92:95], a[100:103], v[44:47]
ds_read_b64_tr_b16 v[112:113], v6 offset:20480
ds_read_b64_tr_b16 v[114:115], v6 offset:22528
v_mfma_f32_16x16x32_bf16 v[28:31], v[92:95], a[96:99], v[28:31]
ds_read_b64_tr_b16 v[116:117], v7 offset:20480
ds_read_b64_tr_b16 v[118:119], v7 offset:22528
v_mfma_f32_16x16x32_bf16 v[32:35], v[96:99], a[96:99], v[32:35]
buffer_load_dwordx4 v12, s[64:67], s14 offen offset:3072 lds
s_add_u32 s101, s101, 0x2000
v_mfma_f32_16x16x32_bf16 v[48:51], v[96:99], a[100:103], v[48:51]
buffer_load_dwordx4 a[64:67], v3, s[88:91], s101 offen sc1
v_mfma_f32_16x16x32_bf16 v[52:55], v[100:103], a[100:103], v[52:55]
buffer_load_dwordx4 a[68:71], v3, s[88:91], s101 offen offset:1024 sc1
v_mfma_f32_16x16x32_bf16 v[36:39], v[100:103], a[96:99], v[36:39]
s_waitcnt lgkmcnt(0)
v_mfma_f32_16x16x32_bf16 v[24:27], v[104:107], a[104:107], v[24:27]
ds_read_b64_tr_b16 v[88:89], v4 offset:24576
ds_read_b64_tr_b16 v[90:91], v4 offset:26624
v_mfma_f32_16x16x32_bf16 v[40:43], v[104:107], a[108:111], v[40:43]
ds_read_b64_tr_b16 v[92:93], v5 offset:24576
ds_read_b64_tr_b16 v[94:95], v5 offset:26624
v_mfma_f32_16x16x32_bf16 v[44:47], v[108:111], a[108:111], v[44:47]
ds_read_b64_tr_b16 v[96:97], v6 offset:24576
ds_read_b64_tr_b16 v[98:99], v6 offset:26624
v_mfma_f32_16x16x32_bf16 v[28:31], v[108:111], a[104:107], v[28:31]
ds_read_b64_tr_b16 v[100:101], v7 offset:24576
ds_read_b64_tr_b16 v[102:103], v7 offset:26624
s_add_u32 s101, s101, 0x2000
v_mfma_f32_16x16x32_bf16 v[32:35], v[112:115], a[104:107], v[32:35]
buffer_load_dwordx4 a[72:75], v3, s[88:91], s101 offen sc1
v_mfma_f32_16x16x32_bf16 v[48:51], v[112:115], a[108:111], v[48:51]
buffer_load_dwordx4 a[76:79], v3, s[88:91], s101 offen offset:1024 sc1
s_add_u32 s101, s101, 0x2000
v_mfma_f32_16x16x32_bf16 v[52:55], v[116:119], a[108:111], v[52:55]
buffer_load_dwordx4 a[80:83], v3, s[88:91], s101 offen sc1
v_mfma_f32_16x16x32_bf16 v[36:39], v[116:119], a[104:107], v[36:39]
s_waitcnt lgkmcnt(0)
v_mfma_f32_16x16x32_bf16 v[24:27], v[88:91], a[112:115], v[24:27]
ds_read_b64_tr_b16 v[104:105], v4 offset:28672
ds_read_b64_tr_b16 v[106:107], v4 offset:30720
v_mfma_f32_16x16x32_bf16 v[40:43], v[88:91], a[116:119], v[40:43]
ds_read_b64_tr_b16 v[108:109], v5 offset:28672
ds_read_b64_tr_b16 v[110:111], v5 offset:30720
v_mfma_f32_16x16x32_bf16 v[44:47], v[92:95], a[116:119], v[44:47]
ds_read_b64_tr_b16 v[112:113], v6 offset:28672
ds_read_b64_tr_b16 v[114:115], v6 offset:30720
v_mfma_f32_16x16x32_bf16 v[28:31], v[92:95], a[112:115], v[28:31]
ds_read_b64_tr_b16 v[116:117], v7 offset:28672
ds_read_b64_tr_b16 v[118:119], v7 offset:30720
v_mfma_f32_16x16x32_bf16 v[32:35], v[96:99], a[112:115], v[32:35]
buffer_load_dwordx4 a[84:87], v3, s[88:91], s101 offen offset:1024 sc1
s_add_u32 s101, s101, 0x2000
v_mfma_f32_16x16x32_bf16 v[48:51], v[96:99], a[116:119], v[48:51]
buffer_load_dwordx4 a[88:91], v3, s[88:91], s101 offen sc1
v_mfma_f32_16x16x32_bf16 v[52:55], v[100:103], a[116:119], v[52:55]
buffer_load_dwordx4 a[92:95], v3, s[88:91], s101 offen offset:1024 sc1
v_mfma_f32_16x16x32_bf16 v[36:39], v[100:103], a[112:115], v[36:39]
s_waitcnt vmcnt(25) lgkmcnt(0)
s_barrier
v_mfma_f32_16x16x32_bf16 v[24:27], v[104:107], a[120:123], v[24:27]
ds_read_b64_tr_b16 v[88:89], v4 offset:32768
ds_read_b64_tr_b16 v[90:91], v4 offset:34816
v_mfma_f32_16x16x32_bf16 v[40:43], v[104:107], a[124:127], v[40:43]
ds_read_b64_tr_b16 v[92:93], v5 offset:32768
ds_read_b64_tr_b16 v[94:95], v5 offset:34816
v_mfma_f32_16x16x32_bf16 v[44:47], v[108:111], a[124:127], v[44:47]
ds_read_b64_tr_b16 v[96:97], v6 offset:32768
ds_read_b64_tr_b16 v[98:99], v6 offset:34816
v_mfma_f32_16x16x32_bf16 v[28:31], v[108:111], a[120:123], v[28:31]
ds_read_b64_tr_b16 v[100:101], v7 offset:32768
ds_read_b64_tr_b16 v[102:103], v7 offset:34816
s_add_u32 m0, s17, 0x14000
v_add_u32 v12, 0x40000, v12
v_mfma_f32_16x16x32_bf16 v[32:35], v[112:115], a[120:123], v[32:35]
buffer_load_dwordx4 v12, s[64:67], 0 offen lds
v_mfma_f32_16x16x32_bf16 v[48:51], v[112:115], a[124:127], v[48:51]
buffer_load_dwordx4 v12, s[64:67], s12 offen offset:1024 lds
v_mfma_f32_16x16x32_bf16 v[52:55], v[116:119], a[124:127], v[52:55]
buffer_load_dwordx4 v12, s[64:67], s13 offen offset:2048 lds
v_mfma_f32_16x16x32_bf16 v[36:39], v[116:119], a[120:123], v[36:39]
s_waitcnt lgkmcnt(0)
v_mfma_f32_16x16x32_bf16 v[24:27], v[88:91], a[128:131], v[24:27]
ds_read_b64_tr_b16 v[104:105], v4 offset:36864
ds_read_b64_tr_b16 v[106:107], v4 offset:38912
v_mfma_f32_16x16x32_bf16 v[40:43], v[88:91], a[132:135], v[40:43]
ds_read_b64_tr_b16 v[108:109], v5 offset:36864
ds_read_b64_tr_b16 v[110:111], v5 offset:38912
v_mfma_f32_16x16x32_bf16 v[44:47], v[92:95], a[132:135], v[44:47]
ds_read_b64_tr_b16 v[112:113], v6 offset:36864
ds_read_b64_tr_b16 v[114:115], v6 offset:38912
v_mfma_f32_16x16x32_bf16 v[28:31], v[92:95], a[128:131], v[28:31]
ds_read_b64_tr_b16 v[116:117], v7 offset:36864
ds_read_b64_tr_b16 v[118:119], v7 offset:38912
v_mfma_f32_16x16x32_bf16 v[32:35], v[96:99], a[128:131], v[32:35]
buffer_load_dwordx4 v12, s[64:67], s14 offen offset:3072 lds
s_add_u32 s101, s101, 0x2000
v_mfma_f32_16x16x32_bf16 v[48:51], v[96:99], a[132:135], v[48:51]
buffer_load_dwordx4 a[96:99], v3, s[88:91], s101 offen sc1
v_mfma_f32_16x16x32_bf16 v[52:55], v[100:103], a[132:135], v[52:55]
buffer_load_dwordx4 a[100:103], v3, s[88:91], s101 offen offset:1024 sc1
v_mfma_f32_16x16x32_bf16 v[36:39], v[100:103], a[128:131], v[36:39]
s_waitcnt lgkmcnt(0)
v_mfma_f32_16x16x32_bf16 v[24:27], v[104:107], a[136:139], v[24:27]
ds_read_b64_tr_b16 v[88:89], v4 offset:40960
ds_read_b64_tr_b16 v[90:91], v4 offset:43008
v_mfma_f32_16x16x32_bf16 v[40:43], v[104:107], a[140:143], v[40:43]
ds_read_b64_tr_b16 v[92:93], v5 offset:40960
ds_read_b64_tr_b16 v[94:95], v5 offset:43008
v_mfma_f32_16x16x32_bf16 v[44:47], v[108:111], a[140:143], v[44:47]
ds_read_b64_tr_b16 v[96:97], v6 offset:40960
ds_read_b64_tr_b16 v[98:99], v6 offset:43008
v_mfma_f32_16x16x32_bf16 v[28:31], v[108:111], a[136:139], v[28:31]
ds_read_b64_tr_b16 v[100:101], v7 offset:40960
ds_read_b64_tr_b16 v[102:103], v7 offset:43008
s_add_u32 s101, s101, 0x2000
v_mfma_f32_16x16x32_bf16 v[32:35], v[112:115], a[136:139], v[32:35]
buffer_load_dwordx4 a[104:107], v3, s[88:91], s101 offen sc1
v_mfma_f32_16x16x32_bf16 v[48:51], v[112:115], a[140:143], v[48:51]
buffer_load_dwordx4 a[108:111], v3, s[88:91], s101 offen offset:1024 sc1
s_add_u32 s101, s101, 0x2000
v_mfma_f32_16x16x32_bf16 v[52:55], v[116:119], a[140:143], v[52:55]
buffer_load_dwordx4 a[112:115], v3, s[88:91], s101 offen sc1
v_mfma_f32_16x16x32_bf16 v[36:39], v[116:119], a[136:139], v[36:39]
s_waitcnt lgkmcnt(0)
v_mfma_f32_16x16x32_bf16 v[24:27], v[88:91], a[144:147], v[24:27]
ds_read_b64_tr_b16 v[104:105], v4 offset:45056
ds_read_b64_tr_b16 v[106:107], v4 offset:47104
v_mfma_f32_16x16x32_bf16 v[40:43], v[88:91], a[148:151], v[40:43]
ds_read_b64_tr_b16 v[108:109], v5 offset:45056
ds_read_b64_tr_b16 v[110:111], v5 offset:47104
v_mfma_f32_16x16x32_bf16 v[44:47], v[92:95], a[148:151], v[44:47]
ds_read_b64_tr_b16 v[112:113], v6 offset:45056
ds_read_b64_tr_b16 v[114:115], v6 offset:47104
v_mfma_f32_16x16x32_bf16 v[28:31], v[92:95], a[144:147], v[28:31]
ds_read_b64_tr_b16 v[116:117], v7 offset:45056
ds_read_b64_tr_b16 v[118:119], v7 offset:47104
v_mfma_f32_16x16x32_bf16 v[32:35], v[96:99], a[144:147], v[32:35]
buffer_load_dwordx4 a[116:119], v3, s[88:91], s101 offen offset:1024 sc1
s_add_u32 s101, s101, 0x2000
v_mfma_f32_16x16x32_bf16 v[48:51], v[96:99], a[148:151], v[48:51]
buffer_load_dwordx4 a[120:123], v3, s[88:91], s101 offen sc1
v_mfma_f32_16x16x32_bf16 v[52:55], v[100:103], a[148:151], v[52:55]
buffer_load_dwordx4 a[124:127], v3, s[88:91], s101 offen offset:1024 sc1
v_mfma_f32_16x16x32_bf16 v[36:39], v[100:103], a[144:147], v[36:39]
s_waitcnt vmcnt(24) lgkmcnt(0)
s_barrier
v_mfma_f32_16x16x32_bf16 v[24:27], v[104:107], a[152:155], v[24:27]
ds_read_b64_tr_b16 v[88:89], v4 offset:49152
ds_read_b64_tr_b16 v[90:91], v4 offset:51200
v_mfma_f32_16x16x32_bf16 v[40:43], v[104:107], a[156:159], v[40:43]
ds_read_b64_tr_b16 v[92:93], v5 offset:49152
ds_read_b64_tr_b16 v[94:95], v5 offset:51200
v_mfma_f32_16x16x32_bf16 v[44:47], v[108:111], a[156:159], v[44:47]
ds_read_b64_tr_b16 v[96:97], v6 offset:49152
ds_read_b64_tr_b16 v[98:99], v6 offset:51200
v_mfma_f32_16x16x32_bf16 v[28:31], v[108:111], a[152:155], v[28:31]
ds_read_b64_tr_b16 v[100:101], v7 offset:49152
ds_read_b64_tr_b16 v[102:103], v7 offset:51200
s_add_u32 m0, s17, 0x18000
v_add_u32 v12, 0x40000, v12
v_mfma_f32_16x16x32_bf16 v[32:35], v[112:115], a[152:155], v[32:35]
buffer_load_dwordx4 v12, s[64:67], 0 offen lds
v_mfma_f32_16x16x32_bf16 v[48:51], v[112:115], a[156:159], v[48:51]
buffer_load_dwordx4 v12, s[64:67], s12 offen offset:1024 lds
v_mfma_f32_16x16x32_bf16 v[52:55], v[116:119], a[156:159], v[52:55]
buffer_load_dwordx4 v12, s[64:67], s13 offen offset:2048 lds
v_mfma_f32_16x16x32_bf16 v[36:39], v[116:119], a[152:155], v[36:39]
s_waitcnt lgkmcnt(0)
v_mfma_f32_16x16x32_bf16 v[24:27], v[88:91], a[160:163], v[24:27]
ds_read_b64_tr_b16 v[104:105], v4 offset:53248
ds_read_b64_tr_b16 v[106:107], v4 offset:55296
v_mfma_f32_16x16x32_bf16 v[40:43], v[88:91], a[164:167], v[40:43]
ds_read_b64_tr_b16 v[108:109], v5 offset:53248
ds_read_b64_tr_b16 v[110:111], v5 offset:55296
v_mfma_f32_16x16x32_bf16 v[44:47], v[92:95], a[164:167], v[44:47]
ds_read_b64_tr_b16 v[112:113], v6 offset:53248
ds_read_b64_tr_b16 v[114:115], v6 offset:55296
v_mfma_f32_16x16x32_bf16 v[28:31], v[92:95], a[160:163], v[28:31]
ds_read_b64_tr_b16 v[116:117], v7 offset:53248
ds_read_b64_tr_b16 v[118:119], v7 offset:55296
v_mfma_f32_16x16x32_bf16 v[32:35], v[96:99], a[160:163], v[32:35]
buffer_load_dwordx4 v12, s[64:67], s14 offen offset:3072 lds
s_add_u32 s101, s101, 0x2000
v_mfma_f32_16x16x32_bf16 v[48:51], v[96:99], a[164:167], v[48:51]
buffer_load_dwordx4 a[128:131], v3, s[88:91], s101 offen sc1
v_mfma_f32_16x16x32_bf16 v[52:55], v[100:103], a[164:167], v[52:55]
buffer_load_dwordx4 a[132:135], v3, s[88:91], s101 offen offset:1024 sc1
v_mfma_f32_16x16x32_bf16 v[36:39], v[100:103], a[160:163], v[36:39]
s_waitcnt lgkmcnt(0)
v_mfma_f32_16x16x32_bf16 v[24:27], v[104:107], a[168:171], v[24:27]
ds_read_b64_tr_b16 v[88:89], v4 offset:57344
ds_read_b64_tr_b16 v[90:91], v4 offset:59392
v_mfma_f32_16x16x32_bf16 v[40:43], v[104:107], a[172:175], v[40:43]
ds_read_b64_tr_b16 v[92:93], v5 offset:57344
ds_read_b64_tr_b16 v[94:95], v5 offset:59392
v_mfma_f32_16x16x32_bf16 v[44:47], v[108:111], a[172:175], v[44:47]
ds_read_b64_tr_b16 v[96:97], v6 offset:57344
ds_read_b64_tr_b16 v[98:99], v6 offset:59392
v_mfma_f32_16x16x32_bf16 v[28:31], v[108:111], a[168:171], v[28:31]
ds_read_b64_tr_b16 v[100:101], v7 offset:57344
ds_read_b64_tr_b16 v[102:103], v7 offset:59392
s_add_u32 s101, s101, 0x2000
v_mfma_f32_16x16x32_bf16 v[32:35], v[112:115], a[168:171], v[32:35]
buffer_load_dwordx4 a[136:139], v3, s[88:91], s101 offen sc1
v_mfma_f32_16x16x32_bf16 v[48:51], v[112:115], a[172:175], v[48:51]
buffer_load_dwordx4 a[140:143], v3, s[88:91], s101 offen offset:1024 sc1
s_add_u32 s101, s101, 0x2000
v_mfma_f32_16x16x32_bf16 v[52:55], v[116:119], a[172:175], v[52:55]
buffer_load_dwordx4 a[144:147], v3, s[88:91], s101 offen sc1
v_mfma_f32_16x16x32_bf16 v[36:39], v[116:119], a[168:171], v[36:39]
s_waitcnt lgkmcnt(0)
v_mfma_f32_16x16x32_bf16 v[24:27], v[88:91], a[176:179], v[24:27]
ds_read_b64_tr_b16 v[104:105], v4 offset:61440
ds_read_b64_tr_b16 v[106:107], v4 offset:63488
v_mfma_f32_16x16x32_bf16 v[40:43], v[88:91], a[180:183], v[40:43]
ds_read_b64_tr_b16 v[108:109], v5 offset:61440
ds_read_b64_tr_b16 v[110:111], v5 offset:63488
v_mfma_f32_16x16x32_bf16 v[44:47], v[92:95], a[180:183], v[44:47]
ds_read_b64_tr_b16 v[112:113], v6 offset:61440
ds_read_b64_tr_b16 v[114:115], v6 offset:63488
v_mfma_f32_16x16x32_bf16 v[28:31], v[92:95], a[176:179], v[28:31]
ds_read_b64_tr_b16 v[116:117], v7 offset:61440
ds_read_b64_tr_b16 v[118:119], v7 offset:63488
v_mfma_f32_16x16x32_bf16 v[32:35], v[96:99], a[176:179], v[32:35]
buffer_load_dwordx4 a[148:151], v3, s[88:91], s101 offen offset:1024 sc1
s_add_u32 s101, s101, 0x2000
v_mfma_f32_16x16x32_bf16 v[48:51], v[96:99], a[180:183], v[48:51]
buffer_load_dwordx4 a[152:155], v3, s[88:91], s101 offen sc1
v_mfma_f32_16x16x32_bf16 v[52:55], v[100:103], a[180:183], v[52:55]
buffer_load_dwordx4 a[156:159], v3, s[88:91], s101 offen offset:1024 sc1
v_mfma_f32_16x16x32_bf16 v[36:39], v[100:103], a[176:179], v[36:39]
s_waitcnt vmcnt(24) lgkmcnt(0)
s_barrier
v_mfma_f32_16x16x32_bf16 v[24:27], v[104:107], a[184:187], v[24:27]
ds_read_b64_tr_b16 v[88:89], v4 offset:0
ds_read_b64_tr_b16 v[90:91], v4 offset:2048
v_mfma_f32_16x16x32_bf16 v[40:43], v[104:107], a[188:191], v[40:43]
ds_read_b64_tr_b16 v[92:93], v5 offset:0
ds_read_b64_tr_b16 v[94:95], v5 offset:2048
v_mfma_f32_16x16x32_bf16 v[44:47], v[108:111], a[188:191], v[44:47]
ds_read_b64_tr_b16 v[96:97], v6 offset:0
ds_read_b64_tr_b16 v[98:99], v6 offset:2048
v_mfma_f32_16x16x32_bf16 v[28:31], v[108:111], a[184:187], v[28:31]
ds_read_b64_tr_b16 v[100:101], v7 offset:0
ds_read_b64_tr_b16 v[102:103], v7 offset:2048
s_add_u32 m0, s17, 0x1c000
v_add_u32 v12, 0x40000, v12
v_mfma_f32_16x16x32_bf16 v[32:35], v[112:115], a[184:187], v[32:35]
buffer_load_dwordx4 v12, s[64:67], 0 offen lds
v_mfma_f32_16x16x32_bf16 v[48:51], v[112:115], a[188:191], v[48:51]
buffer_load_dwordx4 v12, s[64:67], s12 offen offset:1024 lds
v_mfma_f32_16x16x32_bf16 v[52:55], v[116:119], a[188:191], v[52:55]
buffer_load_dwordx4 v12, s[64:67], s13 offen offset:2048 lds
v_mfma_f32_16x16x32_bf16 v[36:39], v[116:119], a[184:187], v[36:39]
s_waitcnt lgkmcnt(0)
v_mfma_f32_16x16x32_bf16 v[56:59], v[88:91], a[64:67], 0
ds_read_b64_tr_b16 v[104:105], v4 offset:4096
ds_read_b64_tr_b16 v[106:107], v4 offset:6144
v_mfma_f32_16x16x32_bf16 v[72:75], v[88:91], a[68:71], 0
ds_read_b64_tr_b16 v[108:109], v5 offset:4096
ds_read_b64_tr_b16 v[110:111], v5 offset:6144
v_mfma_f32_16x16x32_bf16 v[76:79], v[92:95], a[68:71], 0
ds_read_b64_tr_b16 v[112:113], v6 offset:4096
ds_read_b64_tr_b16 v[114:115], v6 offset:6144
v_mfma_f32_16x16x32_bf16 v[60:63], v[92:95], a[64:67], 0
ds_read_b64_tr_b16 v[116:117], v7 offset:4096
ds_read_b64_tr_b16 v[118:119], v7 offset:6144
v_mfma_f32_16x16x32_bf16 v[64:67], v[96:99], a[64:67], 0
buffer_load_dwordx4 v12, s[64:67], s14 offen offset:3072 lds
s_add_u32 s101, s101, 0x2000
v_mfma_f32_16x16x32_bf16 v[80:83], v[96:99], a[68:71], 0
buffer_load_dwordx4 a[160:163], v3, s[88:91], s101 offen sc1
v_mfma_f32_16x16x32_bf16 v[84:87], v[100:103], a[68:71], 0
buffer_load_dwordx4 a[164:167], v3, s[88:91], s101 offen offset:1024 sc1
v_mfma_f32_16x16x32_bf16 v[68:71], v[100:103], a[64:67], 0
s_waitcnt lgkmcnt(0)
v_mfma_f32_16x16x32_bf16 v[56:59], v[104:107], a[72:75], v[56:59]
ds_read_b64_tr_b16 v[88:89], v4 offset:8192
ds_read_b64_tr_b16 v[90:91], v4 offset:10240
v_mfma_f32_16x16x32_bf16 v[72:75], v[104:107], a[76:79], v[72:75]
ds_read_b64_tr_b16 v[92:93], v5 offset:8192
ds_read_b64_tr_b16 v[94:95], v5 offset:10240
v_mfma_f32_16x16x32_bf16 v[76:79], v[108:111], a[76:79], v[76:79]
ds_read_b64_tr_b16 v[96:97], v6 offset:8192
ds_read_b64_tr_b16 v[98:99], v6 offset:10240
v_mfma_f32_16x16x32_bf16 v[60:63], v[108:111], a[72:75], v[60:63]
ds_read_b64_tr_b16 v[100:101], v7 offset:8192
ds_read_b64_tr_b16 v[102:103], v7 offset:10240
s_add_u32 s101, s101, 0x2000
v_mfma_f32_16x16x32_bf16 v[64:67], v[112:115], a[72:75], v[64:67]
buffer_load_dwordx4 a[168:171], v3, s[88:91], s101 offen sc1
v_mfma_f32_16x16x32_bf16 v[80:83], v[112:115], a[76:79], v[80:83]
buffer_load_dwordx4 a[172:175], v3, s[88:91], s101 offen offset:1024 sc1
s_add_u32 s101, s101, 0x2000
v_mfma_f32_16x16x32_bf16 v[84:87], v[116:119], a[76:79], v[84:87]
buffer_load_dwordx4 a[176:179], v3, s[88:91], s101 offen sc1
v_mfma_f32_16x16x32_bf16 v[68:71], v[116:119], a[72:75], v[68:71]
s_waitcnt lgkmcnt(0)
v_mfma_f32_16x16x32_bf16 v[56:59], v[88:91], a[80:83], v[56:59]
ds_read_b64_tr_b16 v[104:105], v4 offset:12288
ds_read_b64_tr_b16 v[106:107], v4 offset:14336
v_mfma_f32_16x16x32_bf16 v[72:75], v[88:91], a[84:87], v[72:75]
ds_read_b64_tr_b16 v[108:109], v5 offset:12288
ds_read_b64_tr_b16 v[110:111], v5 offset:14336
v_mfma_f32_16x16x32_bf16 v[76:79], v[92:95], a[84:87], v[76:79]
ds_read_b64_tr_b16 v[112:113], v6 offset:12288
ds_read_b64_tr_b16 v[114:115], v6 offset:14336
v_mfma_f32_16x16x32_bf16 v[60:63], v[92:95], a[80:83], v[60:63]
ds_read_b64_tr_b16 v[116:117], v7 offset:12288
ds_read_b64_tr_b16 v[118:119], v7 offset:14336
v_mfma_f32_16x16x32_bf16 v[64:67], v[96:99], a[80:83], v[64:67]
buffer_load_dwordx4 a[180:183], v3, s[88:91], s101 offen offset:1024 sc1
s_add_u32 s101, s101, 0x2000
v_mfma_f32_16x16x32_bf16 v[80:83], v[96:99], a[84:87], v[80:83]
buffer_load_dwordx4 a[184:187], v3, s[88:91], s101 offen sc1
v_mfma_f32_16x16x32_bf16 v[84:87], v[100:103], a[84:87], v[84:87]
buffer_load_dwordx4 a[188:191], v3, s[88:91], s101 offen offset:1024 sc1
v_mfma_f32_16x16x32_bf16 v[68:71], v[100:103], a[80:83], v[68:71]
s_mov_b32 s15, 7
L_p4_loop:
s_waitcnt vmcnt(24) lgkmcnt(0)
s_barrier
v_mfma_f32_16x16x32_bf16 v[56:59], v[104:107], a[88:91], v[56:59]
ds_read_b64_tr_b16 v[88:89], v4 offset:16384
ds_read_b64_tr_b16 v[90:91], v4 offset:18432
v_mfma_f32_16x16x32_bf16 v[72:75], v[104:107], a[92:95], v[72:75]
ds_read_b64_tr_b16 v[92:93], v5 offset:16384
ds_read_b64_tr_b16 v[94:95], v5 offset:18432
v_mfma_f32_16x16x32_bf16 v[76:79], v[108:111], a[92:95], v[76:79]
ds_read_b64_tr_b16 v[96:97], v6 offset:16384
ds_read_b64_tr_b16 v[98:99], v6 offset:18432
v_mfma_f32_16x16x32_bf16 v[60:63], v[108:111], a[88:91], v[60:63]
ds_read_b64_tr_b16 v[100:101], v7 offset:16384
ds_read_b64_tr_b16 v[102:103], v7 offset:18432
s_add_u32 m0, s17, 0x10000
v_add_u32 v12, 0x40000, v12
v_mfma_f32_16x16x32_bf16 v[64:67], v[112:115], a[88:91], v[64:67]
buffer_load_dwordx4 v12, s[64:67], 0 offen lds
v_mfma_f32_16x16x32_bf16 v[80:83], v[112:115], a[92:95], v[80:83]
buffer_load_dwordx4 v12, s[64:67], s12 offen offset:1024 lds
v_mfma_f32_16x16x32_bf16 v[84:87], v[116:119], a[92:95], v[84:87]
buffer_load_dwordx4 v12, s[64:67], s13 offen offset:2048 lds
v_mfma_f32_16x16x32_bf16 v[68:71], v[116:119], a[88:91], v[68:71]
s_waitcnt lgkmcnt(0)
v_mfma_f32_16x16x32_bf16 v[56:59], v[88:91], a[96:99], v[56:59]
ds_read_b64_tr_b16 v[104:105], v4 offset:20480
ds_read_b64_tr_b16 v[106:107], v4 offset:22528
v_mfma_f32_16x16x32_bf16 v[72:75], v[88:91], a[100:103], v[72:75]
ds_read_b64_tr_b16 v[108:109], v5 offset:20480
ds_read_b64_tr_b16 v[110:111], v5 offset:22528
v_mfma_f32_16x16x32_bf16 v[76:79], v[92:95], a[100:103], v[76:79]
ds_read_b64_tr_b16 v[112:113], v6 offset:20480
ds_read_b64_tr_b16 v[114:115], v6 offset:22528
v_mfma_f32_16x16x32_bf16 v[60:63], v[92:95], a[96:99], v[60:63]
ds_read_b64_tr_b16 v[116:117], v7 offset:20480
ds_read_b64_tr_b16 v[118:119], v7 offset:22528
v_mfma_f32_16x16x32_bf16 v[64:67], v[96:99], a[96:99], v[64:67]
buffer_load_dwordx4 v12, s[64:67], s14 offen offset:3072 lds
s_add_u32 s101, s101, 0x2000
v_mfma_f32_16x16x32_bf16 v[80:83], v[96:99], a[100:103], v[80:83]
buffer_load_dwordx4 a[64:67], v3, s[88:91], s101 offen sc1
v_mfma_f32_16x16x32_bf16 v[84:87], v[100:103], a[100:103], v[84:87]
buffer_load_dwordx4 a[68:71], v3, s[88:91], s101 offen offset:1024 sc1
v_mfma_f32_16x16x32_bf16 v[68:71], v[100:103], a[96:99], v[68:71]
s_waitcnt lgkmcnt(0)
v_mfma_f32_16x16x32_bf16 v[56:59], v[104:107], a[104:107], v[56:59]
ds_read_b64_tr_b16 v[88:89], v4 offset:24576
ds_read_b64_tr_b16 v[90:91], v4 offset:26624
v_mfma_f32_16x16x32_bf16 v[72:75], v[104:107], a[108:111], v[72:75]
ds_read_b64_tr_b16 v[92:93], v5 offset:24576
ds_read_b64_tr_b16 v[94:95], v5 offset:26624
v_mfma_f32_16x16x32_bf16 v[76:79], v[108:111], a[108:111], v[76:79]
ds_read_b64_tr_b16 v[96:97], v6 offset:24576
ds_read_b64_tr_b16 v[98:99], v6 offset:26624
v_mfma_f32_16x16x32_bf16 v[60:63], v[108:111], a[104:107], v[60:63]
ds_read_b64_tr_b16 v[100:101], v7 offset:24576
ds_read_b64_tr_b16 v[102:103], v7 offset:26624
s_add_u32 s101, s101, 0x2000
v_mfma_f32_16x16x32_bf16 v[64:67], v[112:115], a[104:107], v[64:67]
buffer_load_dwordx4 a[72:75], v3, s[88:91], s101 offen sc1
v_mfma_f32_16x16x32_bf16 v[80:83], v[112:115], a[108:111], v[80:83]
buffer_load_dwordx4 a[76:79], v3, s[88:91], s101 offen offset:1024 sc1
s_add_u32 s101, s101, 0x2000
v_mfma_f32_16x16x32_bf16 v[84:87], v[116:119], a[108:111], v[84:87]
buffer_load_dwordx4 a[80:83], v3, s[88:91], s101 offen sc1
v_mfma_f32_16x16x32_bf16 v[68:71], v[116:119], a[104:107], v[68:71]
s_waitcnt lgkmcnt(0)
v_mfma_f32_16x16x32_bf16 v[56:59], v[88:91], a[112:115], v[56:59]
ds_read_b64_tr_b16 v[104:105], v4 offset:28672
ds_read_b64_tr_b16 v[106:107], v4 offset:30720
v_mfma_f32_16x16x32_bf16 v[72:75], v[88:91], a[116:119], v[72:75]
ds_read_b64_tr_b16 v[108:109], v5 offset:28672
ds_read_b64_tr_b16 v[110:111], v5 offset:30720
v_mfma_f32_16x16x32_bf16 v[76:79], v[92:95], a[116:119], v[76:79]
ds_read_b64_tr_b16 v[112:113], v6 offset:28672
ds_read_b64_tr_b16 v[114:115], v6 offset:30720
v_mfma_f32_16x16x32_bf16 v[60:63], v[92:95], a[112:115], v[60:63]
ds_read_b64_tr_b16 v[116:117], v7 offset:28672
ds_read_b64_tr_b16 v[118:119], v7 offset:30720
v_mfma_f32_16x16x32_bf16 v[64:67], v[96:99], a[112:115], v[64:67]
buffer_load_dwordx4 a[84:87], v3, s[88:91], s101 offen offset:1024 sc1
s_add_u32 s101, s101, 0x2000
v_mfma_f32_16x16x32_bf16 v[80:83], v[96:99], a[116:119], v[80:83]
buffer_load_dwordx4 a[88:91], v3, s[88:91], s101 offen sc1
v_mfma_f32_16x16x32_bf16 v[84:87], v[100:103], a[116:119], v[84:87]
buffer_load_dwordx4 a[92:95], v3, s[88:91], s101 offen offset:1024 sc1
v_mfma_f32_16x16x32_bf16 v[68:71], v[100:103], a[112:115], v[68:71]
s_waitcnt vmcnt(24) lgkmcnt(0)
s_barrier
v_mfma_f32_16x16x32_bf16 v[56:59], v[104:107], a[120:123], v[56:59]
ds_read_b64_tr_b16 v[88:89], v4 offset:32768
ds_read_b64_tr_b16 v[90:91], v4 offset:34816
v_mfma_f32_16x16x32_bf16 v[72:75], v[104:107], a[124:127], v[72:75]
ds_read_b64_tr_b16 v[92:93], v5 offset:32768
ds_read_b64_tr_b16 v[94:95], v5 offset:34816
v_mfma_f32_16x16x32_bf16 v[76:79], v[108:111], a[124:127], v[76:79]
ds_read_b64_tr_b16 v[96:97], v6 offset:32768
ds_read_b64_tr_b16 v[98:99], v6 offset:34816
v_mfma_f32_16x16x32_bf16 v[60:63], v[108:111], a[120:123], v[60:63]
ds_read_b64_tr_b16 v[100:101], v7 offset:32768
ds_read_b64_tr_b16 v[102:103], v7 offset:34816
s_add_u32 m0, s17, 0x14000
v_add_u32 v12, 0x40000, v12
v_mfma_f32_16x16x32_bf16 v[64:67], v[112:115], a[120:123], v[64:67]
buffer_load_dwordx4 v12, s[64:67], 0 offen lds
v_mfma_f32_16x16x32_bf16 v[80:83], v[112:115], a[124:127], v[80:83]
buffer_load_dwordx4 v12, s[64:67], s12 offen offset:1024 lds
v_mfma_f32_16x16x32_bf16 v[84:87], v[116:119], a[124:127], v[84:87]
buffer_load_dwordx4 v12, s[64:67], s13 offen offset:2048 lds
v_mfma_f32_16x16x32_bf16 v[68:71], v[116:119], a[120:123], v[68:71]
s_waitcnt lgkmcnt(0)
v_mfma_f32_16x16x32_bf16 v[56:59], v[88:91], a[128:131], v[56:59]
ds_read_b64_tr_b16 v[104:105], v4 offset:36864
ds_read_b64_tr_b16 v[106:107], v4 offset:38912
v_mfma_f32_16x16x32_bf16 v[72:75], v[88:91], a[132:135], v[72:75]
ds_read_b64_tr_b16 v[108:109], v5 offset:36864
ds_read_b64_tr_b16 v[110:111], v5 offset:38912
v_mfma_f32_16x16x32_bf16 v[76:79], v[92:95], a[132:135], v[76:79]
ds_read_b64_tr_b16 v[112:113], v6 offset:36864
ds_read_b64_tr_b16 v[114:115], v6 offset:38912
v_mfma_f32_16x16x32_bf16 v[60:63], v[92:95], a[128:131], v[60:63]
ds_read_b64_tr_b16 v[116:117], v7 offset:36864
ds_read_b64_tr_b16 v[118:119], v7 offset:38912
v_mfma_f32_16x16x32_bf16 v[64:67], v[96:99], a[128:131], v[64:67]
buffer_load_dwordx4 v12, s[64:67], s14 offen offset:3072 lds
s_add_u32 s101, s101, 0x2000
v_mfma_f32_16x16x32_bf16 v[80:83], v[96:99], a[132:135], v[80:83]
buffer_load_dwordx4 a[96:99], v3, s[88:91], s101 offen sc1
v_mfma_f32_16x16x32_bf16 v[84:87], v[100:103], a[132:135], v[84:87]
buffer_load_dwordx4 a[100:103], v3, s[88:91], s101 offen offset:1024 sc1
v_mfma_f32_16x16x32_bf16 v[68:71], v[100:103], a[128:131], v[68:71]
s_waitcnt lgkmcnt(0)
v_mfma_f32_16x16x32_bf16 v[56:59], v[104:107], a[136:139], v[56:59]
ds_read_b64_tr_b16 v[88:89], v4 offset:40960
ds_read_b64_tr_b16 v[90:91], v4 offset:43008
v_mfma_f32_16x16x32_bf16 v[72:75], v[104:107], a[140:143], v[72:75]
ds_read_b64_tr_b16 v[92:93], v5 offset:40960
ds_read_b64_tr_b16 v[94:95], v5 offset:43008
v_mfma_f32_16x16x32_bf16 v[76:79], v[108:111], a[140:143], v[76:79]
ds_read_b64_tr_b16 v[96:97], v6 offset:40960
ds_read_b64_tr_b16 v[98:99], v6 offset:43008
v_mfma_f32_16x16x32_bf16 v[60:63], v[108:111], a[136:139], v[60:63]
ds_read_b64_tr_b16 v[100:101], v7 offset:40960
ds_read_b64_tr_b16 v[102:103], v7 offset:43008
s_add_u32 s101, s101, 0x2000
v_mfma_f32_16x16x32_bf16 v[64:67], v[112:115], a[136:139], v[64:67]
buffer_load_dwordx4 a[104:107], v3, s[88:91], s101 offen sc1
v_mfma_f32_16x16x32_bf16 v[80:83], v[112:115], a[140:143], v[80:83]
buffer_load_dwordx4 a[108:111], v3, s[88:91], s101 offen offset:1024 sc1
s_add_u32 s101, s101, 0x2000
v_mfma_f32_16x16x32_bf16 v[84:87], v[116:119], a[140:143], v[84:87]
buffer_load_dwordx4 a[112:115], v3, s[88:91], s101 offen sc1
v_mfma_f32_16x16x32_bf16 v[68:71], v[116:119], a[136:139], v[68:71]
s_waitcnt lgkmcnt(0)
v_mfma_f32_16x16x32_bf16 v[56:59], v[88:91], a[144:147], v[56:59]
ds_read_b64_tr_b16 v[104:105], v4 offset:45056
ds_read_b64_tr_b16 v[106:107], v4 offset:47104
v_mfma_f32_16x16x32_bf16 v[72:75], v[88:91], a[148:151], v[72:75]
ds_read_b64_tr_b16 v[108:109], v5 offset:45056
ds_read_b64_tr_b16 v[110:111], v5 offset:47104
v_mfma_f32_16x16x32_bf16 v[76:79], v[92:95], a[148:151], v[76:79]
ds_read_b64_tr_b16 v[112:113], v6 offset:45056
ds_read_b64_tr_b16 v[114:115], v6 offset:47104
v_mfma_f32_16x16x32_bf16 v[60:63], v[92:95], a[144:147], v[60:63]
ds_read_b64_tr_b16 v[116:117], v7 offset:45056
ds_read_b64_tr_b16 v[118:119], v7 offset:47104
v_mfma_f32_16x16x32_bf16 v[64:67], v[96:99], a[144:147], v[64:67]
buffer_load_dwordx4 a[116:119], v3, s[88:91], s101 offen offset:1024 sc1
s_add_u32 s101, s101, 0x2000
v_mfma_f32_16x16x32_bf16 v[80:83], v[96:99], a[148:151], v[80:83]
buffer_load_dwordx4 a[120:123], v3, s[88:91], s101 offen sc1
v_mfma_f32_16x16x32_bf16 v[84:87], v[100:103], a[148:151], v[84:87]
buffer_load_dwordx4 a[124:127], v3, s[88:91], s101 offen offset:1024 sc1
v_mfma_f32_16x16x32_bf16 v[68:71], v[100:103], a[144:147], v[68:71]
s_waitcnt vmcnt(24) lgkmcnt(0)
s_barrier
v_mfma_f32_16x16x32_bf16 v[56:59], v[104:107], a[152:155], v[56:59]
ds_read_b64_tr_b16 v[88:89], v4 offset:49152
ds_read_b64_tr_b16 v[90:91], v4 offset:51200
v_mfma_f32_16x16x32_bf16 v[72:75], v[104:107], a[156:159], v[72:75]
ds_read_b64_tr_b16 v[92:93], v5 offset:49152
ds_read_b64_tr_b16 v[94:95], v5 offset:51200
v_mfma_f32_16x16x32_bf16 v[76:79], v[108:111], a[156:159], v[76:79]
ds_read_b64_tr_b16 v[96:97], v6 offset:49152
ds_read_b64_tr_b16 v[98:99], v6 offset:51200
v_mfma_f32_16x16x32_bf16 v[60:63], v[108:111], a[152:155], v[60:63]
ds_read_b64_tr_b16 v[100:101], v7 offset:49152
ds_read_b64_tr_b16 v[102:103], v7 offset:51200
s_add_u32 m0, s17, 0x18000
v_add_u32 v12, 0x40000, v12
v_mfma_f32_16x16x32_bf16 v[64:67], v[112:115], a[152:155], v[64:67]
buffer_load_dwordx4 v12, s[64:67], 0 offen lds
v_mfma_f32_16x16x32_bf16 v[80:83], v[112:115], a[156:159], v[80:83]
buffer_load_dwordx4 v12, s[64:67], s12 offen offset:1024 lds
v_mfma_f32_16x16x32_bf16 v[84:87], v[116:119], a[156:159], v[84:87]
buffer_load_dwordx4 v12, s[64:67], s13 offen offset:2048 lds
v_mfma_f32_16x16x32_bf16 v[68:71], v[116:119], a[152:155], v[68:71]
s_waitcnt lgkmcnt(0)
v_mfma_f32_16x16x32_bf16 v[56:59], v[88:91], a[160:163], v[56:59]
ds_read_b64_tr_b16 v[104:105], v4 offset:53248
ds_read_b64_tr_b16 v[106:107], v4 offset:55296
v_mfma_f32_16x16x32_bf16 v[72:75], v[88:91], a[164:167], v[72:75]
ds_read_b64_tr_b16 v[108:109], v5 offset:53248
ds_read_b64_tr_b16 v[110:111], v5 offset:55296
v_mfma_f32_16x16x32_bf16 v[76:79], v[92:95], a[164:167], v[76:79]
ds_read_b64_tr_b16 v[112:113], v6 offset:53248
ds_read_b64_tr_b16 v[114:115], v6 offset:55296
v_mfma_f32_16x16x32_bf16 v[60:63], v[92:95], a[160:163], v[60:63]
ds_read_b64_tr_b16 v[116:117], v7 offset:53248
ds_read_b64_tr_b16 v[118:119], v7 offset:55296
v_mfma_f32_16x16x32_bf16 v[64:67], v[96:99], a[160:163], v[64:67]
buffer_load_dwordx4 v12, s[64:67], s14 offen offset:3072 lds
s_add_u32 s101, s101, 0x2000
v_mfma_f32_16x16x32_bf16 v[80:83], v[96:99], a[164:167], v[80:83]
buffer_load_dwordx4 a[128:131], v3, s[88:91], s101 offen sc1
v_mfma_f32_16x16x32_bf16 v[84:87], v[100:103], a[164:167], v[84:87]
buffer_load_dwordx4 a[132:135], v3, s[88:91], s101 offen offset:1024 sc1
v_mfma_f32_16x16x32_bf16 v[68:71], v[100:103], a[160:163], v[68:71]
s_waitcnt lgkmcnt(0)
v_mfma_f32_16x16x32_bf16 v[56:59], v[104:107], a[168:171], v[56:59]
ds_read_b64_tr_b16 v[88:89], v4 offset:57344
ds_read_b64_tr_b16 v[90:91], v4 offset:59392
v_mfma_f32_16x16x32_bf16 v[72:75], v[104:107], a[172:175], v[72:75]
ds_read_b64_tr_b16 v[92:93], v5 offset:57344
ds_read_b64_tr_b16 v[94:95], v5 offset:59392
v_mfma_f32_16x16x32_bf16 v[76:79], v[108:111], a[172:175], v[76:79]
ds_read_b64_tr_b16 v[96:97], v6 offset:57344
ds_read_b64_tr_b16 v[98:99], v6 offset:59392
v_mfma_f32_16x16x32_bf16 v[60:63], v[108:111], a[168:171], v[60:63]
ds_read_b64_tr_b16 v[100:101], v7 offset:57344
ds_read_b64_tr_b16 v[102:103], v7 offset:59392
s_add_u32 s101, s101, 0x2000
v_mfma_f32_16x16x32_bf16 v[64:67], v[112:115], a[168:171], v[64:67]
buffer_load_dwordx4 a[136:139], v3, s[88:91], s101 offen sc1
v_mfma_f32_16x16x32_bf16 v[80:83], v[112:115], a[172:175], v[80:83]
buffer_load_dwordx4 a[140:143], v3, s[88:91], s101 offen offset:1024 sc1
s_add_u32 s101, s101, 0x2000
v_mfma_f32_16x16x32_bf16 v[84:87], v[116:119], a[172:175], v[84:87]
buffer_load_dwordx4 a[144:147], v3, s[88:91], s101 offen sc1
v_mfma_f32_16x16x32_bf16 v[68:71], v[116:119], a[168:171], v[68:71]
s_waitcnt lgkmcnt(0)
v_mfma_f32_16x16x32_bf16 v[56:59], v[88:91], a[176:179], v[56:59]
ds_read_b64_tr_b16 v[104:105], v4 offset:61440
ds_read_b64_tr_b16 v[106:107], v4 offset:63488
v_mfma_f32_16x16x32_bf16 v[72:75], v[88:91], a[180:183], v[72:75]
ds_read_b64_tr_b16 v[108:109], v5 offset:61440
ds_read_b64_tr_b16 v[110:111], v5 offset:63488
v_mfma_f32_16x16x32_bf16 v[76:79], v[92:95], a[180:183], v[76:79]
ds_read_b64_tr_b16 v[112:113], v6 offset:61440
ds_read_b64_tr_b16 v[114:115], v6 offset:63488
v_mfma_f32_16x16x32_bf16 v[60:63], v[92:95], a[176:179], v[60:63]
ds_read_b64_tr_b16 v[116:117], v7 offset:61440
ds_read_b64_tr_b16 v[118:119], v7 offset:63488
v_mfma_f32_16x16x32_bf16 v[64:67], v[96:99], a[176:179], v[64:67]
buffer_load_dwordx4 a[148:151], v3, s[88:91], s101 offen offset:1024 sc1
s_add_u32 s101, s101, 0x2000
v_mfma_f32_16x16x32_bf16 v[80:83], v[96:99], a[180:183], v[80:83]
buffer_load_dwordx4 a[152:155], v3, s[88:91], s101 offen sc1
v_mfma_f32_16x16x32_bf16 v[84:87], v[100:103], a[180:183], v[84:87]
buffer_load_dwordx4 a[156:159], v3, s[88:91], s101 offen offset:1024 sc1
v_mfma_f32_16x16x32_bf16 v[68:71], v[100:103], a[176:179], v[68:71]
s_waitcnt vmcnt(24) lgkmcnt(0)
s_barrier
v_mfma_f32_16x16x32_bf16 v[56:59], v[104:107], a[184:187], v[56:59]
ds_read_b64_tr_b16 v[88:89], v4 offset:0
ds_read_b64_tr_b16 v[90:91], v4 offset:2048
v_mfma_f32_16x16x32_bf16 v[72:75], v[104:107], a[188:191], v[72:75]
ds_read_b64_tr_b16 v[92:93], v5 offset:0
ds_read_b64_tr_b16 v[94:95], v5 offset:2048
v_mfma_f32_16x16x32_bf16 v[76:79], v[108:111], a[188:191], v[76:79]
ds_read_b64_tr_b16 v[96:97], v6 offset:0
ds_read_b64_tr_b16 v[98:99], v6 offset:2048
v_mfma_f32_16x16x32_bf16 v[60:63], v[108:111], a[184:187], v[60:63]
ds_read_b64_tr_b16 v[100:101], v7 offset:0
ds_read_b64_tr_b16 v[102:103], v7 offset:2048
s_add_u32 m0, s17, 0x1c000
v_add_u32 v12, 0x40000, v12
v_mfma_f32_16x16x32_bf16 v[64:67], v[112:115], a[184:187], v[64:67]
buffer_load_dwordx4 v12, s[64:67], 0 offen lds
v_mfma_f32_16x16x32_bf16 v[80:83], v[112:115], a[188:191], v[80:83]
buffer_load_dwordx4 v12, s[64:67], s12 offen offset:1024 lds
v_mfma_f32_16x16x32_bf16 v[84:87], v[116:119], a[188:191], v[84:87]
buffer_load_dwordx4 v12, s[64:67], s13 offen offset:2048 lds
v_mfma_f32_16x16x32_bf16 v[68:71], v[116:119], a[184:187], v[68:71]
s_waitcnt lgkmcnt(0)
v_mfma_f32_16x16x32_bf16 v[56:59], v[88:91], a[64:67], v[56:59]
ds_read_b64_tr_b16 v[104:105], v4 offset:4096
ds_read_b64_tr_b16 v[106:107], v4 offset:6144
v_mfma_f32_16x16x32_bf16 v[72:75], v[88:91], a[68:71], v[72:75]
ds_read_b64_tr_b16 v[108:109], v5 offset:4096
ds_read_b64_tr_b16 v[110:111], v5 offset:6144
v_mfma_f32_16x16x32_bf16 v[76:79], v[92:95], a[68:71], v[76:79]
ds_read_b64_tr_b16 v[112:113], v6 offset:4096
ds_read_b64_tr_b16 v[114:115], v6 offset:6144
v_mfma_f32_16x16x32_bf16 v[60:63], v[92:95], a[64:67], v[60:63]
ds_read_b64_tr_b16 v[116:117], v7 offset:4096
ds_read_b64_tr_b16 v[118:119], v7 offset:6144
v_mfma_f32_16x16x32_bf16 v[64:67], v[96:99], a[64:67], v[64:67]
buffer_load_dwordx4 v12, s[64:67], s14 offen offset:3072 lds
s_add_u32 s101, s101, 0x2000
v_mfma_f32_16x16x32_bf16 v[80:83], v[96:99], a[68:71], v[80:83]
buffer_load_dwordx4 a[160:163], v3, s[88:91], s101 offen sc1
v_mfma_f32_16x16x32_bf16 v[84:87], v[100:103], a[68:71], v[84:87]
buffer_load_dwordx4 a[164:167], v3, s[88:91], s101 offen offset:1024 sc1
v_mfma_f32_16x16x32_bf16 v[68:71], v[100:103], a[64:67], v[68:71]
s_waitcnt lgkmcnt(0)
v_mfma_f32_16x16x32_bf16 v[56:59], v[104:107], a[72:75], v[56:59]
ds_read_b64_tr_b16 v[88:89], v4 offset:8192
ds_read_b64_tr_b16 v[90:91], v4 offset:10240
v_mfma_f32_16x16x32_bf16 v[72:75], v[104:107], a[76:79], v[72:75]
ds_read_b64_tr_b16 v[92:93], v5 offset:8192
ds_read_b64_tr_b16 v[94:95], v5 offset:10240
v_mfma_f32_16x16x32_bf16 v[76:79], v[108:111], a[76:79], v[76:79]
ds_read_b64_tr_b16 v[96:97], v6 offset:8192
ds_read_b64_tr_b16 v[98:99], v6 offset:10240
v_mfma_f32_16x16x32_bf16 v[60:63], v[108:111], a[72:75], v[60:63]
ds_read_b64_tr_b16 v[100:101], v7 offset:8192
ds_read_b64_tr_b16 v[102:103], v7 offset:10240
s_add_u32 s101, s101, 0x2000
v_mfma_f32_16x16x32_bf16 v[64:67], v[112:115], a[72:75], v[64:67]
buffer_load_dwordx4 a[168:171], v3, s[88:91], s101 offen sc1
v_mfma_f32_16x16x32_bf16 v[80:83], v[112:115], a[76:79], v[80:83]
buffer_load_dwordx4 a[172:175], v3, s[88:91], s101 offen offset:1024 sc1
s_add_u32 s101, s101, 0x2000
v_mfma_f32_16x16x32_bf16 v[84:87], v[116:119], a[76:79], v[84:87]
buffer_load_dwordx4 a[176:179], v3, s[88:91], s101 offen sc1
v_mfma_f32_16x16x32_bf16 v[68:71], v[116:119], a[72:75], v[68:71]
s_waitcnt lgkmcnt(0)
v_mfma_f32_16x16x32_bf16 v[56:59], v[88:91], a[80:83], v[56:59]
ds_read_b64_tr_b16 v[104:105], v4 offset:12288
ds_read_b64_tr_b16 v[106:107], v4 offset:14336
v_mfma_f32_16x16x32_bf16 v[72:75], v[88:91], a[84:87], v[72:75]
ds_read_b64_tr_b16 v[108:109], v5 offset:12288
ds_read_b64_tr_b16 v[110:111], v5 offset:14336
v_mfma_f32_16x16x32_bf16 v[76:79], v[92:95], a[84:87], v[76:79]
ds_read_b64_tr_b16 v[112:113], v6 offset:12288
ds_read_b64_tr_b16 v[114:115], v6 offset:14336
v_mfma_f32_16x16x32_bf16 v[60:63], v[92:95], a[80:83], v[60:63]
ds_read_b64_tr_b16 v[116:117], v7 offset:12288
ds_read_b64_tr_b16 v[118:119], v7 offset:14336
v_mfma_f32_16x16x32_bf16 v[64:67], v[96:99], a[80:83], v[64:67]
buffer_load_dwordx4 a[180:183], v3, s[88:91], s101 offen offset:1024 sc1
s_add_u32 s101, s101, 0x2000
v_mfma_f32_16x16x32_bf16 v[80:83], v[96:99], a[84:87], v[80:83]
buffer_load_dwordx4 a[184:187], v3, s[88:91], s101 offen sc1
v_mfma_f32_16x16x32_bf16 v[84:87], v[100:103], a[84:87], v[84:87]
buffer_load_dwordx4 a[188:191], v3, s[88:91], s101 offen offset:1024 sc1
v_mfma_f32_16x16x32_bf16 v[68:71], v[100:103], a[80:83], v[68:71]
s_sub_u32 s15, s15, 1
s_cmp_lg_u32 s15, 0
s_cbranch_scc1 L_p4_loop
s_waitcnt vmcnt(24) lgkmcnt(0)
s_barrier
v_mfma_f32_16x16x32_bf16 v[56:59], v[104:107], a[88:91], v[56:59]
ds_read_b64_tr_b16 v[88:89], v4 offset:16384
ds_read_b64_tr_b16 v[90:91], v4 offset:18432
v_mfma_f32_16x16x32_bf16 v[72:75], v[104:107], a[92:95], v[72:75]
ds_read_b64_tr_b16 v[92:93], v5 offset:16384
ds_read_b64_tr_b16 v[94:95], v5 offset:18432
v_mfma_f32_16x16x32_bf16 v[76:79], v[108:111], a[92:95], v[76:79]
ds_read_b64_tr_b16 v[96:97], v6 offset:16384
ds_read_b64_tr_b16 v[98:99], v6 offset:18432
v_mfma_f32_16x16x32_bf16 v[60:63], v[108:111], a[88:91], v[60:63]
ds_read_b64_tr_b16 v[100:101], v7 offset:16384
ds_read_b64_tr_b16 v[102:103], v7 offset:18432
v_mfma_f32_16x16x32_bf16 v[64:67], v[112:115], a[88:91], v[64:67]
v_mfma_f32_16x16x32_bf16 v[80:83], v[112:115], a[92:95], v[80:83]
v_mfma_f32_16x16x32_bf16 v[84:87], v[116:119], a[92:95], v[84:87]
v_mfma_f32_16x16x32_bf16 v[68:71], v[116:119], a[88:91], v[68:71]
s_waitcnt lgkmcnt(0)
v_mfma_f32_16x16x32_bf16 v[56:59], v[88:91], a[96:99], v[56:59]
ds_read_b64_tr_b16 v[104:105], v4 offset:20480
ds_read_b64_tr_b16 v[106:107], v4 offset:22528
v_mfma_f32_16x16x32_bf16 v[72:75], v[88:91], a[100:103], v[72:75]
ds_read_b64_tr_b16 v[108:109], v5 offset:20480
ds_read_b64_tr_b16 v[110:111], v5 offset:22528
v_mfma_f32_16x16x32_bf16 v[76:79], v[92:95], a[100:103], v[76:79]
ds_read_b64_tr_b16 v[112:113], v6 offset:20480
ds_read_b64_tr_b16 v[114:115], v6 offset:22528
v_mfma_f32_16x16x32_bf16 v[60:63], v[92:95], a[96:99], v[60:63]
ds_read_b64_tr_b16 v[116:117], v7 offset:20480
ds_read_b64_tr_b16 v[118:119], v7 offset:22528
v_mfma_f32_16x16x32_bf16 v[64:67], v[96:99], a[96:99], v[64:67]
v_mfma_f32_16x16x32_bf16 v[80:83], v[96:99], a[100:103], v[80:83]
v_mfma_f32_16x16x32_bf16 v[84:87], v[100:103], a[100:103], v[84:87]
v_mfma_f32_16x16x32_bf16 v[68:71], v[100:103], a[96:99], v[68:71]
s_waitcnt lgkmcnt(0)
v_mfma_f32_16x16x32_bf16 v[56:59], v[104:107], a[104:107], v[56:59]
ds_read_b64_tr_b16 v[88:89], v4 offset:24576
ds_read_b64_tr_b16 v[90:91], v4 offset:26624
v_mfma_f32_16x16x32_bf16 v[72:75], v[104:107], a[108:111], v[72:75]
ds_read_b64_tr_b16 v[92:93], v5 offset:24576
ds_read_b64_tr_b16 v[94:95], v5 offset:26624
v_mfma_f32_16x16x32_bf16 v[76:79], v[108:111], a[108:111], v[76:79]
ds_read_b64_tr_b16 v[96:97], v6 offset:24576
ds_read_b64_tr_b16 v[98:99], v6 offset:26624
v_mfma_f32_16x16x32_bf16 v[60:63], v[108:111], a[104:107], v[60:63]
ds_read_b64_tr_b16 v[100:101], v7 offset:24576
ds_read_b64_tr_b16 v[102:103], v7 offset:26624
v_mfma_f32_16x16x32_bf16 v[64:67], v[112:115], a[104:107], v[64:67]
v_mfma_f32_16x16x32_bf16 v[80:83], v[112:115], a[108:111], v[80:83]
v_mfma_f32_16x16x32_bf16 v[84:87], v[116:119], a[108:111], v[84:87]
v_mfma_f32_16x16x32_bf16 v[68:71], v[116:119], a[104:107], v[68:71]
s_waitcnt lgkmcnt(0)
v_mfma_f32_16x16x32_bf16 v[56:59], v[88:91], a[112:115], v[56:59]
ds_read_b64_tr_b16 v[104:105], v4 offset:28672
ds_read_b64_tr_b16 v[106:107], v4 offset:30720
v_mfma_f32_16x16x32_bf16 v[72:75], v[88:91], a[116:119], v[72:75]
ds_read_b64_tr_b16 v[108:109], v5 offset:28672
ds_read_b64_tr_b16 v[110:111], v5 offset:30720
v_mfma_f32_16x16x32_bf16 v[76:79], v[92:95], a[116:119], v[76:79]
ds_read_b64_tr_b16 v[112:113], v6 offset:28672
ds_read_b64_tr_b16 v[114:115], v6 offset:30720
v_mfma_f32_16x16x32_bf16 v[60:63], v[92:95], a[112:115], v[60:63]
ds_read_b64_tr_b16 v[116:117], v7 offset:28672
ds_read_b64_tr_b16 v[118:119], v7 offset:30720
v_mfma_f32_16x16x32_bf16 v[64:67], v[96:99], a[112:115], v[64:67]
v_mfma_f32_16x16x32_bf16 v[80:83], v[96:99], a[116:119], v[80:83]
v_mfma_f32_16x16x32_bf16 v[84:87], v[100:103], a[116:119], v[84:87]
v_mfma_f32_16x16x32_bf16 v[68:71], v[100:103], a[112:115], v[68:71]
s_lshl_b32 s8, s99, 7
s_lshl_b32 s9, s4, 5
s_add_u32 s8, s8, s9
s_lshl_b32 s9, s8, 2
s_add_u32 s9, s9, 0x3600000
v_and_b32 v17, 15, v0
v_lshlrev_b32 v18, 2, v17
buffer_load_dword v8, v18, s[88:91], s9 offen sc1
buffer_load_dword v9, v18, s[88:91], s9 offen offset:64 sc1
v_lshrrev_b32 v18, 4, v0
v_lshlrev_b32 v18, 3, v18
v_lshl_add_u32 v17, v17, 11, v18
s_lshl_b32 s8, s8, 11
s_lshl_b32 s9, s100, 7
s_add_u32 s8, s8, s9
s_add_u32 s9, s8, 0x8000
s_waitcnt vmcnt(14) lgkmcnt(0)
s_barrier
v_mfma_f32_16x16x32_bf16 v[56:59], v[104:107], a[120:123], v[56:59]
ds_read_b64_tr_b16 v[88:89], v4 offset:32768
ds_read_b64_tr_b16 v[90:91], v4 offset:34816
v_mfma_f32_16x16x32_bf16 v[72:75], v[104:107], a[124:127], v[72:75]
ds_read_b64_tr_b16 v[92:93], v5 offset:32768
ds_read_b64_tr_b16 v[94:95], v5 offset:34816
v_mfma_f32_16x16x32_bf16 v[76:79], v[108:111], a[124:127], v[76:79]
ds_read_b64_tr_b16 v[96:97], v6 offset:32768
ds_read_b64_tr_b16 v[98:99], v6 offset:34816
v_mfma_f32_16x16x32_bf16 v[60:63], v[108:111], a[120:123], v[60:63]
ds_read_b64_tr_b16 v[100:101], v7 offset:32768
ds_read_b64_tr_b16 v[102:103], v7 offset:34816
v_mfma_f32_16x16x32_bf16 v[64:67], v[112:115], a[120:123], v[64:67]
v_mfma_f32_16x16x32_bf16 v[80:83], v[112:115], a[124:127], v[80:83]
v_mfma_f32_16x16x32_bf16 v[84:87], v[116:119], a[124:127], v[84:87]
v_mfma_f32_16x16x32_bf16 v[68:71], v[116:119], a[120:123], v[68:71]
s_waitcnt lgkmcnt(0)
v_mfma_f32_16x16x32_bf16 v[56:59], v[88:91], a[128:131], v[56:59]
ds_read_b64_tr_b16 v[104:105], v4 offset:36864
ds_read_b64_tr_b16 v[106:107], v4 offset:38912
v_mfma_f32_16x16x32_bf16 v[72:75], v[88:91], a[132:135], v[72:75]
ds_read_b64_tr_b16 v[108:109], v5 offset:36864
ds_read_b64_tr_b16 v[110:111], v5 offset:38912
v_mfma_f32_16x16x32_bf16 v[76:79], v[92:95], a[132:135], v[76:79]
ds_read_b64_tr_b16 v[112:113], v6 offset:36864
ds_read_b64_tr_b16 v[114:115], v6 offset:38912
v_mfma_f32_16x16x32_bf16 v[60:63], v[92:95], a[128:131], v[60:63]
ds_read_b64_tr_b16 v[116:117], v7 offset:36864
ds_read_b64_tr_b16 v[118:119], v7 offset:38912
v_mfma_f32_16x16x32_bf16 v[64:67], v[96:99], a[128:131], v[64:67]
v_mfma_f32_16x16x32_bf16 v[80:83], v[96:99], a[132:135], v[80:83]
v_mfma_f32_16x16x32_bf16 v[84:87], v[100:103], a[132:135], v[84:87]
v_mfma_f32_16x16x32_bf16 v[68:71], v[100:103], a[128:131], v[68:71]
s_waitcnt lgkmcnt(0)
v_mfma_f32_16x16x32_bf16 v[56:59], v[104:107], a[136:139], v[56:59]
ds_read_b64_tr_b16 v[88:89], v4 offset:40960
ds_read_b64_tr_b16 v[90:91], v4 offset:43008
v_mfma_f32_16x16x32_bf16 v[72:75], v[104:107], a[140:143], v[72:75]
ds_read_b64_tr_b16 v[92:93], v5 offset:40960
ds_read_b64_tr_b16 v[94:95], v5 offset:43008
v_mfma_f32_16x16x32_bf16 v[76:79], v[108:111], a[140:143], v[76:79]
ds_read_b64_tr_b16 v[96:97], v6 offset:40960
ds_read_b64_tr_b16 v[98:99], v6 offset:43008
v_mfma_f32_16x16x32_bf16 v[60:63], v[108:111], a[136:139], v[60:63]
ds_read_b64_tr_b16 v[100:101], v7 offset:40960
ds_read_b64_tr_b16 v[102:103], v7 offset:43008
v_mfma_f32_16x16x32_bf16 v[64:67], v[112:115], a[136:139], v[64:67]
v_mfma_f32_16x16x32_bf16 v[80:83], v[112:115], a[140:143], v[80:83]
v_mfma_f32_16x16x32_bf16 v[84:87], v[116:119], a[140:143], v[84:87]
v_mfma_f32_16x16x32_bf16 v[68:71], v[116:119], a[136:139], v[68:71]
s_waitcnt lgkmcnt(0)
v_mfma_f32_16x16x32_bf16 v[56:59], v[88:91], a[144:147], v[56:59]
ds_read_b64_tr_b16 v[104:105], v4 offset:45056
ds_read_b64_tr_b16 v[106:107], v4 offset:47104
v_mfma_f32_16x16x32_bf16 v[72:75], v[88:91], a[148:151], v[72:75]
ds_read_b64_tr_b16 v[108:109], v5 offset:45056
ds_read_b64_tr_b16 v[110:111], v5 offset:47104
v_mfma_f32_16x16x32_bf16 v[76:79], v[92:95], a[148:151], v[76:79]
ds_read_b64_tr_b16 v[112:113], v6 offset:45056
ds_read_b64_tr_b16 v[114:115], v6 offset:47104
v_mfma_f32_16x16x32_bf16 v[60:63], v[92:95], a[144:147], v[60:63]
ds_read_b64_tr_b16 v[116:117], v7 offset:45056
ds_read_b64_tr_b16 v[118:119], v7 offset:47104
v_mfma_f32_16x16x32_bf16 v[64:67], v[96:99], a[144:147], v[64:67]
v_mfma_f32_16x16x32_bf16 v[80:83], v[96:99], a[148:151], v[80:83]
v_mfma_f32_16x16x32_bf16 v[84:87], v[100:103], a[148:151], v[84:87]
v_mfma_f32_16x16x32_bf16 v[68:71], v[100:103], a[144:147], v[68:71]
s_waitcnt vmcnt(2) lgkmcnt(0)
s_barrier
v_mfma_f32_16x16x32_bf16 v[56:59], v[104:107], a[152:155], v[56:59]
ds_read_b64_tr_b16 v[88:89], v4 offset:49152
ds_read_b64_tr_b16 v[90:91], v4 offset:51200
v_mfma_f32_16x16x32_bf16 v[72:75], v[104:107], a[156:159], v[72:75]
ds_read_b64_tr_b16 v[92:93], v5 offset:49152
ds_read_b64_tr_b16 v[94:95], v5 offset:51200
v_mfma_f32_16x16x32_bf16 v[76:79], v[108:111], a[156:159], v[76:79]
ds_read_b64_tr_b16 v[96:97], v6 offset:49152
ds_read_b64_tr_b16 v[98:99], v6 offset:51200
v_mfma_f32_16x16x32_bf16 v[60:63], v[108:111], a[152:155], v[60:63]
ds_read_b64_tr_b16 v[100:101], v7 offset:49152
ds_read_b64_tr_b16 v[102:103], v7 offset:51200
v_mfma_f32_16x16x32_bf16 v[64:67], v[112:115], a[152:155], v[64:67]
v_mfma_f32_16x16x32_bf16 v[80:83], v[112:115], a[156:159], v[80:83]
v_mfma_f32_16x16x32_bf16 v[84:87], v[116:119], a[156:159], v[84:87]
v_mfma_f32_16x16x32_bf16 v[68:71], v[116:119], a[152:155], v[68:71]
s_waitcnt lgkmcnt(0)
v_mfma_f32_16x16x32_bf16 v[56:59], v[88:91], a[160:163], v[56:59]
ds_read_b64_tr_b16 v[104:105], v4 offset:53248
ds_read_b64_tr_b16 v[106:107], v4 offset:55296
v_mfma_f32_16x16x32_bf16 v[72:75], v[88:91], a[164:167], v[72:75]
ds_read_b64_tr_b16 v[108:109], v5 offset:53248
ds_read_b64_tr_b16 v[110:111], v5 offset:55296
v_mfma_f32_16x16x32_bf16 v[76:79], v[92:95], a[164:167], v[76:79]
ds_read_b64_tr_b16 v[112:113], v6 offset:53248
ds_read_b64_tr_b16 v[114:115], v6 offset:55296
v_mfma_f32_16x16x32_bf16 v[60:63], v[92:95], a[160:163], v[60:63]
ds_read_b64_tr_b16 v[116:117], v7 offset:53248
ds_read_b64_tr_b16 v[118:119], v7 offset:55296
v_mfma_f32_16x16x32_bf16 v[64:67], v[96:99], a[160:163], v[64:67]
v_mfma_f32_16x16x32_bf16 v[80:83], v[96:99], a[164:167], v[80:83]
v_mfma_f32_16x16x32_bf16 v[84:87], v[100:103], a[164:167], v[84:87]
v_mfma_f32_16x16x32_bf16 v[68:71], v[100:103], a[160:163], v[68:71]
s_waitcnt lgkmcnt(0)
v_mfma_f32_16x16x32_bf16 v[56:59], v[104:107], a[168:171], v[56:59]
ds_read_b64_tr_b16 v[88:89], v4 offset:57344
ds_read_b64_tr_b16 v[90:91], v4 offset:59392
v_mfma_f32_16x16x32_bf16 v[72:75], v[104:107], a[172:175], v[72:75]
ds_read_b64_tr_b16 v[92:93], v5 offset:57344
ds_read_b64_tr_b16 v[94:95], v5 offset:59392
v_mfma_f32_16x16x32_bf16 v[76:79], v[108:111], a[172:175], v[76:79]
ds_read_b64_tr_b16 v[96:97], v6 offset:57344
ds_read_b64_tr_b16 v[98:99], v6 offset:59392
v_mfma_f32_16x16x32_bf16 v[60:63], v[108:111], a[168:171], v[60:63]
ds_read_b64_tr_b16 v[100:101], v7 offset:57344
ds_read_b64_tr_b16 v[102:103], v7 offset:59392
v_mfma_f32_16x16x32_bf16 v[64:67], v[112:115], a[168:171], v[64:67]
v_mfma_f32_16x16x32_bf16 v[80:83], v[112:115], a[172:175], v[80:83]
v_mfma_f32_16x16x32_bf16 v[84:87], v[116:119], a[172:175], v[84:87]
v_mfma_f32_16x16x32_bf16 v[68:71], v[116:119], a[168:171], v[68:71]
s_waitcnt lgkmcnt(0)
v_mfma_f32_16x16x32_bf16 v[56:59], v[88:91], a[176:179], v[56:59]
ds_read_b64_tr_b16 v[104:105], v4 offset:61440
ds_read_b64_tr_b16 v[106:107], v4 offset:63488
v_mfma_f32_16x16x32_bf16 v[72:75], v[88:91], a[180:183], v[72:75]
ds_read_b64_tr_b16 v[108:109], v5 offset:61440
ds_read_b64_tr_b16 v[110:111], v5 offset:63488
v_mfma_f32_16x16x32_bf16 v[76:79], v[92:95], a[180:183], v[76:79]
ds_read_b64_tr_b16 v[112:113], v6 offset:61440
ds_read_b64_tr_b16 v[114:115], v6 offset:63488
v_mfma_f32_16x16x32_bf16 v[60:63], v[92:95], a[176:179], v[60:63]
ds_read_b64_tr_b16 v[116:117], v7 offset:61440
ds_read_b64_tr_b16 v[118:119], v7 offset:63488
v_mfma_f32_16x16x32_bf16 v[64:67], v[96:99], a[176:179], v[64:67]
v_mfma_f32_16x16x32_bf16 v[80:83], v[96:99], a[180:183], v[80:83]
v_mfma_f32_16x16x32_bf16 v[84:87], v[100:103], a[180:183], v[84:87]
v_mfma_f32_16x16x32_bf16 v[68:71], v[100:103], a[176:179], v[68:71]
s_waitcnt vmcnt(0) lgkmcnt(0)
v_mfma_f32_16x16x32_bf16 v[56:59], v[104:107], a[184:187], v[56:59]
v_mfma_f32_16x16x32_bf16 v[72:75], v[104:107], a[188:191], v[72:75]
v_mfma_f32_16x16x32_bf16 v[76:79], v[108:111], a[188:191], v[76:79]
v_mfma_f32_16x16x32_bf16 v[60:63], v[108:111], a[184:187], v[60:63]
v_mfma_f32_16x16x32_bf16 v[64:67], v[112:115], a[184:187], v[64:67]
v_mfma_f32_16x16x32_bf16 v[80:83], v[112:115], a[188:191], v[80:83]
v_mfma_f32_16x16x32_bf16 v[84:87], v[116:119], a[188:191], v[84:87]
v_mfma_f32_16x16x32_bf16 v[68:71], v[116:119], a[184:187], v[68:71]
v_sub_f32 v10, 1.0, v8
v_sub_f32 v11, 1.0, v9
v_mul_f32 v24, v10, v24
v_mul_f32 v25, v10, v25
v_mul_f32 v26, v10, v26
v_mul_f32 v27, v10, v27
v_mul_f32 v28, v10, v28
v_mul_f32 v29, v10, v29
v_mul_f32 v30, v10, v30
v_mul_f32 v31, v10, v31
v_mul_f32 v32, v10, v32
v_mul_f32 v33, v10, v33
v_mul_f32 v34, v10, v34
v_mul_f32 v35, v10, v35
v_mul_f32 v36, v10, v36
v_mul_f32 v37, v10, v37
v_mul_f32 v38, v10, v38
v_mul_f32 v39, v10, v39
v_mul_f32 v40, v11, v40
v_mul_f32 v41, v11, v41
v_mul_f32 v42, v11, v42
v_mul_f32 v43, v11, v43
v_mul_f32 v44, v11, v44
v_mul_f32 v45, v11, v45
v_mul_f32 v46, v11, v46
v_mul_f32 v47, v11, v47
v_mul_f32 v48, v11, v48
v_mul_f32 v49, v11, v49
v_mul_f32 v50, v11, v50
v_mul_f32 v51, v11, v51
v_mul_f32 v52, v11, v52
v_mul_f32 v53, v11, v53
v_mul_f32 v54, v11, v54
v_mul_f32 v55, v11, v55
v_fmac_f32 v24, v8, v56
v_fmac_f32 v25, v8, v57
v_fmac_f32 v26, v8, v58
v_fmac_f32 v27, v8, v59
v_fmac_f32 v28, v8, v60
v_fmac_f32 v29, v8, v61
v_fmac_f32 v30, v8, v62
v_fmac_f32 v31, v8, v63
v_fmac_f32 v32, v8, v64
v_fmac_f32 v33, v8, v65
v_fmac_f32 v34, v8, v66
v_fmac_f32 v35, v8, v67
v_fmac_f32 v36, v8, v68
v_fmac_f32 v37, v8, v69
v_fmac_f32 v38, v8, v70
v_fmac_f32 v39, v8, v71
v_cvt_pk_bf16_f32 v24, v24, v25
v_cvt_pk_bf16_f32 v25, v26, v27
buffer_store_dwordx2 v[24:25], v17, s[80:83], s8 offen offset:0
v_cvt_pk_bf16_f32 v28, v28, v29
v_cvt_pk_bf16_f32 v29, v30, v31
buffer_store_dwordx2 v[28:29], v17, s[80:83], s8 offen offset:32
v_cvt_pk_bf16_f32 v32, v32, v33
v_cvt_pk_bf16_f32 v33, v34, v35
buffer_store_dwordx2 v[32:33], v17, s[80:83], s8 offen offset:64
v_cvt_pk_bf16_f32 v36, v36, v37
v_cvt_pk_bf16_f32 v37, v38, v39
buffer_store_dwordx2 v[36:37], v17, s[80:83], s8 offen offset:96
v_fmac_f32 v40, v9, v72
v_fmac_f32 v41, v9, v73
v_fmac_f32 v42, v9, v74
v_fmac_f32 v43, v9, v75
v_fmac_f32 v44, v9, v76
v_fmac_f32 v45, v9, v77
v_fmac_f32 v46, v9, v78
v_fmac_f32 v47, v9, v79
v_fmac_f32 v48, v9, v80
v_fmac_f32 v49, v9, v81
v_fmac_f32 v50, v9, v82
v_fmac_f32 v51, v9, v83
v_fmac_f32 v52, v9, v84
v_fmac_f32 v53, v9, v85
v_fmac_f32 v54, v9, v86
v_fmac_f32 v55, v9, v87
v_cvt_pk_bf16_f32 v40, v40, v41
v_cvt_pk_bf16_f32 v41, v42, v43
buffer_store_dwordx2 v[40:41], v17, s[80:83], s9 offen offset:0
v_cvt_pk_bf16_f32 v44, v44, v45
v_cvt_pk_bf16_f32 v45, v46, v47
buffer_store_dwordx2 v[44:45], v17, s[80:83], s9 offen offset:32
v_cvt_pk_bf16_f32 v48, v48, v49
v_cvt_pk_bf16_f32 v49, v50, v51
buffer_store_dwordx2 v[48:49], v17, s[80:83], s9 offen offset:64
v_cvt_pk_bf16_f32 v52, v52, v53
v_cvt_pk_bf16_f32 v53, v54, v55
buffer_store_dwordx2 v[52:53], v17, s[80:83], s9 offen offset:96
L_end:
s_endpgm
L_att_fallback:
s_waitcnt vmcnt(0)
s_mov_b32 s33, 1
s_mul_i32 s32, s5, 0x108000
s_lshl_b32 s19, s4, 13
s_add_u32 s32, s32, s19
s_add_u32 s7, s32, 0x1000
s_add_u32 s27, s19, 131072
v_and_b32 v5, 15, v0
v_lshrrev_b32 v6, 4, v0
v_lshlrev_b32 v6, 2, v6
v_sub_u32 v5, v5, v6
v_mov_b32 v6, 0xf149f2ca
s_lshr_b32 s8, s20, 11
v_add_u32 v80, s8, v5
v_mov_b32 v8, v6
s_lshr_b32 s8, s21, 11
v_add_u32 v84, s8, v5
v_mov_b32 v9, v6
s_lshr_b32 s8, s22, 11
v_add_u32 v88, s8, v5
v_mov_b32 v10, v6
s_lshr_b32 s8, s23, 11
v_add_u32 v92, s8, v5
v_mov_b32 v11, v6
s_sub_u32 s15, 16, s6
s_lshl_b32 s15, s15, 1
L_fb_loop:
s_waitcnt lgkmcnt(0)
s_barrier
s_add_u32 m0, s19, 0x0
s_nop 0
buffer_load_dwordx4 v3, s[88:91], s32 offen offset:0 sc1 lds
buffer_load_dwordx4 v3, s[88:91], s32 offen offset:1024 sc1 lds
buffer_load_dwordx4 v3, s[88:91], s32 offen offset:2048 sc1 lds
buffer_load_dwordx4 v3, s[88:91], s32 offen offset:3072 sc1 lds
s_add_u32 m0, s19, 0x1000
s_nop 0
buffer_load_dwordx4 v3, s[88:91], s7 offen offset:0 sc1 lds
buffer_load_dwordx4 v3, s[88:91], s7 offen offset:1024 sc1 lds
buffer_load_dwordx4 v3, s[88:91], s7 offen offset:2048 sc1 lds
buffer_load_dwordx4 v3, s[88:91], s7 offen offset:3072 sc1 lds
s_add_u32 s32, s32, 0x8000
s_add_u32 s7, s7, 0x8000
s_waitcnt vmcnt(0)
s_barrier
ds_read_b128 a[0:3], v3 offset:0
ds_read_b128 a[4:7], v3 offset:1024
ds_read_b128 a[8:11], v3 offset:2048
ds_read_b128 a[12:15], v3 offset:3072
ds_read_b128 a[16:19], v3 offset:4096
ds_read_b128 a[20:23], v3 offset:5120
ds_read_b128 a[24:27], v3 offset:6144
ds_read_b128 a[28:31], v3 offset:7168
s_waitcnt lgkmcnt(0)
v_mfma_f32_16x16x32_bf16 v[16:19], a[0:3], a[160:163], 0
v_mfma_f32_16x16x32_bf16 v[16:19], a[4:7], a[164:167], v[16:19]
v_mfma_f32_16x16x32_bf16 v[16:19], a[8:11], a[168:171], v[16:19]
v_mfma_f32_16x16x32_bf16 v[16:19], a[12:15], a[172:175], v[16:19]
v_mfma_f32_16x16x32_bf16 v[20:23], a[0:3], a[176:179], 0
v_mfma_f32_16x16x32_bf16 v[20:23], a[4:7], a[180:183], v[20:23]
v_mfma_f32_16x16x32_bf16 v[20:23], a[8:11], a[184:187], v[20:23]
v_mfma_f32_16x16x32_bf16 v[20:23], a[12:15], a[188:191], v[20:23]
v_mfma_f32_16x16x32_bf16 v[24:27], a[0:3], a[192:195], 0
v_mfma_f32_16x16x32_bf16 v[24:27], a[4:7], a[196:199], v[24:27]
v_mfma_f32_16x16x32_bf16 v[24:27], a[8:11], a[200:203], v[24:27]
v_mfma_f32_16x16x32_bf16 v[24:27], a[12:15], a[204:207], v[24:27]
v_mfma_f32_16x16x32_bf16 v[28:31], a[0:3], a[208:211], 0
v_mfma_f32_16x16x32_bf16 v[28:31], a[4:7], a[212:215], v[28:31]
v_mfma_f32_16x16x32_bf16 v[28:31], a[8:11], a[216:219], v[28:31]
v_mfma_f32_16x16x32_bf16 v[28:31], a[12:15], a[220:223], v[28:31]
v_mfma_f32_16x16x32_bf16 v[32:35], a[16:19], a[160:163], 0
v_mfma_f32_16x16x32_bf16 v[32:35], a[20:23], a[164:167], v[32:35]
v_mfma_f32_16x16x32_bf16 v[32:35], a[24:27], a[168:171], v[32:35]
v_mfma_f32_16x16x32_bf16 v[32:35], a[28:31], a[172:175], v[32:35]
v_mfma_f32_16x16x32_bf16 v[36:39], a[16:19], a[176:179], 0
v_mfma_f32_16x16x32_bf16 v[36:39], a[20:23], a[180:183], v[36:39]
v_mfma_f32_16x16x32_bf16 v[36:39], a[24:27], a[184:187], v[36:39]
v_mfma_f32_16x16x32_bf16 v[36:39], a[28:31], a[188:191], v[36:39]
v_mfma_f32_16x16x32_bf16 v[40:43], a[16:19], a[192:195], 0
v_mfma_f32_16x16x32_bf16 v[40:43], a[20:23], a[196:199], v[40:43]
v_mfma_f32_16x16x32_bf16 v[40:43], a[24:27], a[200:203], v[40:43]
v_mfma_f32_16x16x32_bf16 v[40:43], a[28:31], a[204:207], v[40:43]
v_mfma_f32_16x16x32_bf16 v[44:47], a[16:19], a[208:211], 0
v_mfma_f32_16x16x32_bf16 v[44:47], a[20:23], a[212:215], v[44:47]
v_mfma_f32_16x16x32_bf16 v[44:47], a[24:27], a[216:219], v[44:47]
v_mfma_f32_16x16x32_bf16 v[44:47], a[28:31], a[220:223], v[44:47]
s_nop 7
v_cmp_le_i32 s[36:37], 0, v80
v_cmp_le_i32 s[38:39], 1, v80
v_cmp_le_i32 s[40:41], 2, v80
v_cmp_le_i32 s[42:43], 3, v80
s_nop 1
v_cndmask_b32 v16, v6, v16, s[36:37]
v_cndmask_b32 v17, v6, v17, s[38:39]
v_cndmask_b32 v18, v6, v18, s[40:41]
v_cndmask_b32 v19, v6, v19, s[42:43]
v_max3_f32 v8, v8, v16, v17
v_max3_f32 v8, v8, v18, v19
v_cmp_le_i32 s[36:37], 0, v84
v_cmp_le_i32 s[38:39], 1, v84
v_cmp_le_i32 s[40:41], 2, v84
v_cmp_le_i32 s[42:43], 3, v84
s_nop 1
v_cndmask_b32 v20, v6, v20, s[36:37]
v_cndmask_b32 v21, v6, v21, s[38:39]
v_cndmask_b32 v22, v6, v22, s[40:41]
v_cndmask_b32 v23, v6, v23, s[42:43]
v_max3_f32 v9, v9, v20, v21
v_max3_f32 v9, v9, v22, v23
v_cmp_le_i32 s[36:37], 0, v88
v_cmp_le_i32 s[38:39], 1, v88
v_cmp_le_i32 s[40:41], 2, v88
v_cmp_le_i32 s[42:43], 3, v88
s_nop 1
v_cndmask_b32 v24, v6, v24, s[36:37]
v_cndmask_b32 v25, v6, v25, s[38:39]
v_cndmask_b32 v26, v6, v26, s[40:41]
v_cndmask_b32 v27, v6, v27, s[42:43]
v_max3_f32 v10, v10, v24, v25
v_max3_f32 v10, v10, v26, v27
v_cmp_le_i32 s[36:37], 0, v92
v_cmp_le_i32 s[38:39], 1, v92
v_cmp_le_i32 s[40:41], 2, v92
v_cmp_le_i32 s[42:43], 3, v92
s_nop 1
v_cndmask_b32 v28, v6, v28, s[36:37]
v_cndmask_b32 v29, v6, v29, s[38:39]
v_cndmask_b32 v30, v6, v30, s[40:41]
v_cndmask_b32 v31, v6, v31, s[42:43]
v_max3_f32 v11, v11, v28, v29
v_max3_f32 v11, v11, v30, v31
v_cmp_le_i32 s[36:37], 16, v80
v_cmp_le_i32 s[38:39], 17, v80
v_cmp_le_i32 s[40:41], 18, v80
v_cmp_le_i32 s[42:43], 19, v80
s_nop 1
v_cndmask_b32 v32, v6, v32, s[36:37]
v_cndmask_b32 v33, v6, v33, s[38:39]
v_cndmask_b32 v34, v6, v34, s[40:41]
v_cndmask_b32 v35, v6, v35, s[42:43]
v_max3_f32 v8, v8, v32, v33
v_max3_f32 v8, v8, v34, v35
v_cmp_le_i32 s[36:37], 16, v84
v_cmp_le_i32 s[38:39], 17, v84
v_cmp_le_i32 s[40:41], 18, v84
v_cmp_le_i32 s[42:43], 19, v84
s_nop 1
v_cndmask_b32 v36, v6, v36, s[36:37]
v_cndmask_b32 v37, v6, v37, s[38:39]
v_cndmask_b32 v38, v6, v38, s[40:41]
v_cndmask_b32 v39, v6, v39, s[42:43]
v_max3_f32 v9, v9, v36, v37
v_max3_f32 v9, v9, v38, v39
v_cmp_le_i32 s[36:37], 16, v88
v_cmp_le_i32 s[38:39], 17, v88
v_cmp_le_i32 s[40:41], 18, v88
v_cmp_le_i32 s[42:43], 19, v88
s_nop 1
v_cndmask_b32 v40, v6, v40, s[36:37]
v_cndmask_b32 v41, v6, v41, s[38:39]
v_cndmask_b32 v42, v6, v42, s[40:41]
v_cndmask_b32 v43, v6, v43, s[42:43]
v_max3_f32 v10, v10, v40, v41
v_max3_f32 v10, v10, v42, v43
v_cmp_le_i32 s[36:37], 16, v92
v_cmp_le_i32 s[38:39], 17, v92
v_cmp_le_i32 s[40:41], 18, v92
v_cmp_le_i32 s[42:43], 19, v92
s_nop 1
v_cndmask_b32 v44, v6, v44, s[36:37]
v_cndmask_b32 v45, v6, v45, s[38:39]
v_cndmask_b32 v46, v6, v46, s[40:41]
v_cndmask_b32 v47, v6, v47, s[42:43]
v_max3_f32 v11, v11, v44, v45
v_max3_f32 v11, v11, v46, v47
ds_read_b128 a[0:3], v3 offset:16384
ds_read_b128 a[4:7], v3 offset:17408
ds_read_b128 a[8:11], v3 offset:18432
ds_read_b128 a[12:15], v3 offset:19456
ds_read_b128 a[16:19], v3 offset:20480
ds_read_b128 a[20:23], v3 offset:21504
ds_read_b128 a[24:27], v3 offset:22528
ds_read_b128 a[28:31], v3 offset:23552
s_waitcnt lgkmcnt(0)
v_mfma_f32_16x16x32_bf16 v[16:19], a[0:3], a[160:163], 0
v_mfma_f32_16x16x32_bf16 v[16:19], a[4:7], a[164:167], v[16:19]
v_mfma_f32_16x16x32_bf16 v[16:19], a[8:11], a[168:171], v[16:19]
v_mfma_f32_16x16x32_bf16 v[16:19], a[12:15], a[172:175], v[16:19]
v_mfma_f32_16x16x32_bf16 v[20:23], a[0:3], a[176:179], 0
v_mfma_f32_16x16x32_bf16 v[20:23], a[4:7], a[180:183], v[20:23]
v_mfma_f32_16x16x32_bf16 v[20:23], a[8:11], a[184:187], v[20:23]
v_mfma_f32_16x16x32_bf16 v[20:23], a[12:15], a[188:191], v[20:23]
v_mfma_f32_16x16x32_bf16 v[24:27], a[0:3], a[192:195], 0
v_mfma_f32_16x16x32_bf16 v[24:27], a[4:7], a[196:199], v[24:27]
v_mfma_f32_16x16x32_bf16 v[24:27], a[8:11], a[200:203], v[24:27]
v_mfma_f32_16x16x32_bf16 v[24:27], a[12:15], a[204:207], v[24:27]
v_mfma_f32_16x16x32_bf16 v[28:31], a[0:3], a[208:211], 0
v_mfma_f32_16x16x32_bf16 v[28:31], a[4:7], a[212:215], v[28:31]
v_mfma_f32_16x16x32_bf16 v[28:31], a[8:11], a[216:219], v[28:31]
v_mfma_f32_16x16x32_bf16 v[28:31], a[12:15], a[220:223], v[28:31]
v_mfma_f32_16x16x32_bf16 v[32:35], a[16:19], a[160:163], 0
v_mfma_f32_16x16x32_bf16 v[32:35], a[20:23], a[164:167], v[32:35]
v_mfma_f32_16x16x32_bf16 v[32:35], a[24:27], a[168:171], v[32:35]
v_mfma_f32_16x16x32_bf16 v[32:35], a[28:31], a[172:175], v[32:35]
v_mfma_f32_16x16x32_bf16 v[36:39], a[16:19], a[176:179], 0
v_mfma_f32_16x16x32_bf16 v[36:39], a[20:23], a[180:183], v[36:39]
v_mfma_f32_16x16x32_bf16 v[36:39], a[24:27], a[184:187], v[36:39]
v_mfma_f32_16x16x32_bf16 v[36:39], a[28:31], a[188:191], v[36:39]
v_mfma_f32_16x16x32_bf16 v[40:43], a[16:19], a[192:195], 0
v_mfma_f32_16x16x32_bf16 v[40:43], a[20:23], a[196:199], v[40:43]
v_mfma_f32_16x16x32_bf16 v[40:43], a[24:27], a[200:203], v[40:43]
v_mfma_f32_16x16x32_bf16 v[40:43], a[28:31], a[204:207], v[40:43]
v_mfma_f32_16x16x32_bf16 v[44:47], a[16:19], a[208:211], 0
v_mfma_f32_16x16x32_bf16 v[44:47], a[20:23], a[212:215], v[44:47]
v_mfma_f32_16x16x32_bf16 v[44:47], a[24:27], a[216:219], v[44:47]
v_mfma_f32_16x16x32_bf16 v[44:47], a[28:31], a[220:223], v[44:47]
s_nop 7
v_cmp_le_i32 s[36:37], 32, v80
v_cmp_le_i32 s[38:39], 33, v80
v_cmp_le_i32 s[40:41], 34, v80
v_cmp_le_i32 s[42:43], 35, v80
s_nop 1
v_cndmask_b32 v16, v6, v16, s[36:37]
v_cndmask_b32 v17, v6, v17, s[38:39]
v_cndmask_b32 v18, v6, v18, s[40:41]
v_cndmask_b32 v19, v6, v19, s[42:43]
v_max3_f32 v8, v8, v16, v17
v_max3_f32 v8, v8, v18, v19
v_cmp_le_i32 s[36:37], 32, v84
v_cmp_le_i32 s[38:39], 33, v84
v_cmp_le_i32 s[40:41], 34, v84
v_cmp_le_i32 s[42:43], 35, v84
s_nop 1
v_cndmask_b32 v20, v6, v20, s[36:37]
v_cndmask_b32 v21, v6, v21, s[38:39]
v_cndmask_b32 v22, v6, v22, s[40:41]
v_cndmask_b32 v23, v6, v23, s[42:43]
v_max3_f32 v9, v9, v20, v21
v_max3_f32 v9, v9, v22, v23
v_cmp_le_i32 s[36:37], 32, v88
v_cmp_le_i32 s[38:39], 33, v88
v_cmp_le_i32 s[40:41], 34, v88
v_cmp_le_i32 s[42:43], 35, v88
s_nop 1
v_cndmask_b32 v24, v6, v24, s[36:37]
v_cndmask_b32 v25, v6, v25, s[38:39]
v_cndmask_b32 v26, v6, v26, s[40:41]
v_cndmask_b32 v27, v6, v27, s[42:43]
v_max3_f32 v10, v10, v24, v25
v_max3_f32 v10, v10, v26, v27
v_cmp_le_i32 s[36:37], 32, v92
v_cmp_le_i32 s[38:39], 33, v92
v_cmp_le_i32 s[40:41], 34, v92
v_cmp_le_i32 s[42:43], 35, v92
s_nop 1
v_cndmask_b32 v28, v6, v28, s[36:37]
v_cndmask_b32 v29, v6, v29, s[38:39]
v_cndmask_b32 v30, v6, v30, s[40:41]
v_cndmask_b32 v31, v6, v31, s[42:43]
v_max3_f32 v11, v11, v28, v29
v_max3_f32 v11, v11, v30, v31
v_cmp_le_i32 s[36:37], 48, v80
v_cmp_le_i32 s[38:39], 49, v80
v_cmp_le_i32 s[40:41], 50, v80
v_cmp_le_i32 s[42:43], 51, v80
s_nop 1
v_cndmask_b32 v32, v6, v32, s[36:37]
v_cndmask_b32 v33, v6, v33, s[38:39]
v_cndmask_b32 v34, v6, v34, s[40:41]
v_cndmask_b32 v35, v6, v35, s[42:43]
v_max3_f32 v8, v8, v32, v33
v_max3_f32 v8, v8, v34, v35
v_cmp_le_i32 s[36:37], 48, v84
v_cmp_le_i32 s[38:39], 49, v84
v_cmp_le_i32 s[40:41], 50, v84
v_cmp_le_i32 s[42:43], 51, v84
s_nop 1
v_cndmask_b32 v36, v6, v36, s[36:37]
v_cndmask_b32 v37, v6, v37, s[38:39]
v_cndmask_b32 v38, v6, v38, s[40:41]
v_cndmask_b32 v39, v6, v39, s[42:43]
v_max3_f32 v9, v9, v36, v37
v_max3_f32 v9, v9, v38, v39
v_cmp_le_i32 s[36:37], 48, v88
v_cmp_le_i32 s[38:39], 49, v88
v_cmp_le_i32 s[40:41], 50, v88
v_cmp_le_i32 s[42:43], 51, v88
s_nop 1
v_cndmask_b32 v40, v6, v40, s[36:37]
v_cndmask_b32 v41, v6, v41, s[38:39]
v_cndmask_b32 v42, v6, v42, s[40:41]
v_cndmask_b32 v43, v6, v43, s[42:43]
v_max3_f32 v10, v10, v40, v41
v_max3_f32 v10, v10, v42, v43
v_cmp_le_i32 s[36:37], 48, v92
v_cmp_le_i32 s[38:39], 49, v92
v_cmp_le_i32 s[40:41], 50, v92
v_cmp_le_i32 s[42:43], 51, v92
s_nop 1
v_cndmask_b32 v44, v6, v44, s[36:37]
v_cndmask_b32 v45, v6, v45, s[38:39]
v_cndmask_b32 v46, v6, v46, s[40:41]
v_cndmask_b32 v47, v6, v47, s[42:43]
v_max3_f32 v11, v11, v44, v45
v_max3_f32 v11, v11, v46, v47
v_subrev_u32 v80, 64, v80
v_subrev_u32 v84, 64, v84
v_subrev_u32 v88, 64, v88
v_subrev_u32 v92, 64, v92
s_sub_u32 s15, s15, 1
s_cmp_lg_u32 s15, 0
s_cbranch_scc1 L_fb_loop
v_mov_b32 v12, v8
v_mov_b32 v13, v9
v_mov_b32 v14, v10
v_mov_b32 v15, v11
s_nop 1
v_permlane16_swap_b32 v12, v8
v_permlane16_swap_b32 v13, v9
v_permlane16_swap_b32 v14, v10
v_permlane16_swap_b32 v15, v11
v_max_f32 v8, v8, v12
v_max_f32 v9, v9, v13
v_max_f32 v10, v10, v14
v_max_f32 v11, v11, v15
v_mov_b32 v12, v8
v_mov_b32 v13, v9
v_mov_b32 v14, v10
v_mov_b32 v15, v11
s_nop 1
v_permlane32_swap_b32 v12, v8
v_permlane32_swap_b32 v13, v9
v_permlane32_swap_b32 v14, v10
v_permlane32_swap_b32 v15, v11
v_max_f32 v8, v8, v12
v_max_f32 v9, v9, v13
v_max_f32 v10, v10, v14
v_max_f32 v11, v11, v15
s_barrier
s_mul_i32 s32, s5, 0x108000
s_lshl_b32 s19, s4, 13
s_add_u32 s32, s32, s19
s_add_u32 s7, s32, 0x1000
s_add_u32 s27, s19, 131072
s_add_u32 m0, s19, 0x0
s_nop 0
buffer_load_dwordx4 v3, s[88:91], s32 offen offset:0 sc1 lds
buffer_load_dwordx4 v3, s[88:91], s32 offen offset:1024 sc1 lds
buffer_load_dwordx4 v3, s[88:91], s32 offen offset:2048 sc1 lds
buffer_load_dwordx4 v3, s[88:91], s32 offen offset:3072 sc1 lds
s_add_u32 m0, s19, 0x1000
s_nop 0
buffer_load_dwordx4 v3, s[88:91], s7 offen offset:0 sc1 lds
buffer_load_dwordx4 v3, s[88:91], s7 offen offset:1024 sc1 lds
buffer_load_dwordx4 v3, s[88:91], s7 offen offset:2048 sc1 lds
buffer_load_dwordx4 v3, s[88:91], s7 offen offset:3072 sc1 lds
s_add_u32 s32, s32, 0x8000
s_add_u32 s7, s7, 0x8000
s_add_u32 m0, s19, 0x18000
s_nop 0
buffer_load_dwordx4 v3, s[88:91], s32 offen offset:0 sc1 lds
buffer_load_dwordx4 v3, s[88:91], s32 offen offset:1024 sc1 lds
buffer_load_dwordx4 v3, s[88:91], s32 offen offset:2048 sc1 lds
buffer_load_dwordx4 v3, s[88:91], s32 offen offset:3072 sc1 lds
s_add_u32 m0, s19, 0x19000
s_nop 0
buffer_load_dwordx4 v3, s[88:91], s7 offen offset:0 sc1 lds
buffer_load_dwordx4 v3, s[88:91], s7 offen offset:1024 sc1 lds
buffer_load_dwordx4 v3, s[88:91], s7 offen offset:2048 sc1 lds
buffer_load_dwordx4 v3, s[88:91], s7 offen offset:3072 sc1 lds
s_add_u32 s32, s32, 0x8000
s_add_u32 s7, s7, 0x8000
s_add_u32 m0, s19, 0x8000
s_nop 0
buffer_load_dwordx4 v3, s[88:91], s32 offen offset:0 sc1 lds
buffer_load_dwordx4 v3, s[88:91], s32 offen offset:1024 sc1 lds
buffer_load_dwordx4 v3, s[88:91], s32 offen offset:2048 sc1 lds
buffer_load_dwordx4 v3, s[88:91], s32 offen offset:3072 sc1 lds
s_add_u32 m0, s19, 0x9000
s_nop 0
buffer_load_dwordx4 v3, s[88:91], s7 offen offset:0 sc1 lds
buffer_load_dwordx4 v3, s[88:91], s7 offen offset:1024 sc1 lds
buffer_load_dwordx4 v3, s[88:91], s7 offen offset:2048 sc1 lds
buffer_load_dwordx4 v3, s[88:91], s7 offen offset:3072 sc1 lds
s_add_u32 s32, s32, 0x8000
s_add_u32 s7, s7, 0x8000
s_branch L_att_start
.section .rodata,"a"
.p2align 6
.amdhsa_kernel gated_mix__compressed_kv_cla__sliding_local_dilated__prompt_kernel
  .amdhsa_next_free_vgpr 512
  .amdhsa_next_free_sgpr 102
  .amdhsa_accum_offset 256
  .amdhsa_group_segment_fixed_size 0
  .amdhsa_kernarg_size 104
  .amdhsa_user_sgpr_count 2
  .amdhsa_user_sgpr_kernarg_segment_ptr 1
  .amdhsa_system_sgpr_workgroup_id_x 1
.end_amdhsa_kernel
```

```asm
; @launch grid=(256,1,1) block=(256,1,1) lds=163840
.amdgcn_target "amdgcn-amd-amdhsa--gfx950"
.text
.globl gated_mix__compressed_kv_cla__sliding_local_dilated__prompt_kernel
.p2align 8
.type gated_mix__compressed_kv_cla__sliding_local_dilated__prompt_kernel,@function
gated_mix__compressed_kv_cla__sliding_local_dilated__prompt_kernel:
s_cmp_ge_u32 s2, 256
s_cbranch_scc1 L_end
s_load_dwordx2 s[44:45], s[0:1], 0
s_load_dwordx2 s[48:49], s[0:1], 8
s_load_dwordx2 s[52:53], s[0:1], 16
s_load_dwordx2 s[56:57], s[0:1], 24
s_load_dwordx2 s[60:61], s[0:1], 32
s_load_dwordx2 s[64:65], s[0:1], 40
s_load_dwordx2 s[68:69], s[0:1], 56
s_load_dwordx2 s[72:73], s[0:1], 64
s_load_dwordx2 s[76:77], s[0:1], 72
s_load_dwordx2 s[80:81], s[0:1], 80
s_load_dwordx2 s[84:85], s[0:1], 88
s_load_dwordx2 s[88:89], s[0:1], 96
v_lshrrev_b32 v1, 6, v0
v_and_b32 v0, 63, v0
v_readfirstlane_b32 s4, v1
s_mov_b32 s46, 0x400000
s_mov_b32 s47, 0x20000
s_mov_b32 s50, 0x200000
s_mov_b32 s51, 0x20000
s_mov_b32 s54, 0x800000
s_mov_b32 s55, 0x20000
s_mov_b32 s58, 0x400000
s_mov_b32 s59, 0x20000
s_mov_b32 s62, 0x400000
s_mov_b32 s63, 0x20000
s_mov_b32 s66, 0x800000
s_mov_b32 s67, 0x20000
s_mov_b32 s70, 0x600000
s_mov_b32 s71, 0x20000
s_mov_b32 s74, 0x200000
s_mov_b32 s75, 0x20000
s_mov_b32 s78, 0x800
s_mov_b32 s79, 0x20000
s_mov_b32 s82, 0x400000
s_mov_b32 s83, 0x20000
s_mov_b32 s86, 0x100
s_mov_b32 s87, 0x20000
s_mov_b32 s90, 0x10000000
s_mov_b32 s91, 0x20000
s_and_b32 s5, s2, 7
s_lshl_b32 s5, s5, 2
s_bfe_u32 s3, s2, 0x20003
s_add_u32 s5, s5, s3
s_lshr_b32 s6, s2, 5
s_mov_b32 s12, 0x4000
s_mov_b32 s13, 0x8000
s_mov_b32 s14, 0xc000
s_mov_b32 s25, 0x800
s_mov_b32 s26, 0x1000
s_mov_b32 s3, 0
s_waitcnt lgkmcnt(0)
v_lshlrev_b32 v16, 4, v0
v_bfe_u32 v17, v0, 2, 2
s_lshl_b32 s8, s4, 4
v_add_u32 v17, s8, v17
v_lshlrev_b32 v17, 13, v17
v_lshrrev_b32 v18, 4, v0
v_lshl_add_u32 v17, v18, 6, v17
v_and_b32 v18, 3, v0
v_lshl_add_u32 v17, v18, 4, v17
s_lshl_b32 s8, s5, 8
v_add_u32 v5, s8, v17
v_xor_b32 v6, 32, v5
v_add_u32 v6, 0x10000, v6
v_lshrrev_b32 v17, 4, v0
v_xor_b32 v17, v17, v0
v_and_b32 v17, 7, v17
v_lshlrev_b32 v17, 4, v17
v_lshrrev_b32 v18, 3, v0
v_lshl_add_u32 v2, v18, 10, v17
s_lshl_b32 s8, s6, 18
s_lshl_b32 s9, s4, 16
s_add_u32 s8, s8, s9
v_add_u32 v2, s8, v2
v_xor_b32 v3, 64, v2
v_add_u32 v3, 0x2000, v3
s_lshl_b32 s16, s4, 13
s_add_u32 s16, s16, 0x18000
s_lshl_b32 s17, s4, 12
s_lshl_b32 s18, s4, 10
s_sub_u32 s8, 15, s6
s_cmp_lt_u32 s5, 16
s_cselect_b32 s8, s6, s8
s_lshl_b32 s8, s8, 4
s_and_b32 s9, s5, 15
s_add_u32 s8, s8, s9
s_lshl_b32 s8, s8, 3
s_lshl_b32 s9, s4, 1
s_add_u32 s8, s8, s9
s_lshl_b32 s9, s8, 11
s_lshl_b32 s28, s8, 2
s_add_u32 s28, s28, 0x3600000
buffer_load_dwordx4 v[24:27], v16, s[44:47], s9 offen offset:0
buffer_load_dwordx4 v[28:31], v16, s[44:47], s9 offen offset:1024
buffer_load_dwordx4 v[32:35], v16, s[44:47], s9 offen offset:2048
buffer_load_dwordx4 v[36:39], v16, s[44:47], s9 offen offset:3072
buffer_load_dwordx4 v[40:43], v16, s[76:79], 0 offen offset:0
buffer_load_dwordx4 v[44:47], v16, s[76:79], 0 offen offset:1024
s_add_u32 m0, s17, 0x0
s_nop 0
buffer_load_dwordx4 v5, s[56:59], 0 offen nt lds
s_add_u32 m0, s17, 0x4000
s_nop 0
buffer_load_dwordx4 v5, s[60:63], 0 offen nt lds
s_add_u32 m0, s17, 0x400
s_nop 0
buffer_load_dwordx4 v5, s[56:59], s13 offen nt lds
s_add_u32 m0, s17, 0x4400
s_nop 0
buffer_load_dwordx4 v5, s[60:63], s13 offen nt lds
s_add_u32 m0, s17, 0x800
s_nop 0
buffer_load_dwordx4 v6, s[56:59], 0 offen nt lds
s_add_u32 m0, s17, 0x4800
s_nop 0
buffer_load_dwordx4 v6, s[60:63], 0 offen nt lds
s_add_u32 m0, s17, 0xc00
s_nop 0
buffer_load_dwordx4 v6, s[56:59], s13 offen nt lds
s_add_u32 m0, s17, 0x4c00
s_nop 0
buffer_load_dwordx4 v6, s[60:63], s13 offen nt lds
v_add_u32 v5, 0x80000, v5
v_add_u32 v6, 0x80000, v6
s_add_u32 m0, s16, 0x0
s_nop 0
buffer_load_dwordx4 v2, s[48:51], 0 offen lds
s_add_u32 m0, s16, 0x400
s_nop 0
buffer_load_dwordx4 v3, s[48:51], 0 offen lds
s_add_u32 m0, s16, 0x800
s_nop 0
buffer_load_dwordx4 v2, s[48:51], s12 offen lds
s_add_u32 m0, s16, 0xc00
s_nop 0
buffer_load_dwordx4 v3, s[48:51], s12 offen lds
s_add_u32 m0, s16, 0x1000
s_nop 0
buffer_load_dwordx4 v2, s[48:51], s13 offen lds
s_add_u32 m0, s16, 0x1400
s_nop 0
buffer_load_dwordx4 v3, s[48:51], s13 offen lds
s_add_u32 m0, s16, 0x1800
s_nop 0
buffer_load_dwordx4 v2, s[48:51], s14 offen lds
s_add_u32 m0, s16, 0x1c00
s_nop 0
buffer_load_dwordx4 v3, s[48:51], s14 offen lds
v_add_u32 v2, 0x80, v2
v_add_u32 v3, 0x80, v3
s_add_u32 m0, s17, 0x8000
s_nop 0
buffer_load_dwordx4 v5, s[56:59], 0 offen nt lds
s_add_u32 m0, s17, 0xc000
s_nop 0
buffer_load_dwordx4 v5, s[60:63], 0 offen nt lds
s_add_u32 m0, s17, 0x8400
s_nop 0
buffer_load_dwordx4 v5, s[56:59], s13 offen nt lds
s_add_u32 m0, s17, 0xc400
s_nop 0
buffer_load_dwordx4 v5, s[60:63], s13 offen nt lds
s_add_u32 m0, s17, 0x8800
s_nop 0
buffer_load_dwordx4 v6, s[56:59], 0 offen nt lds
s_add_u32 m0, s17, 0xc800
s_nop 0
buffer_load_dwordx4 v6, s[60:63], 0 offen nt lds
s_add_u32 m0, s17, 0x8c00
s_nop 0
buffer_load_dwordx4 v6, s[56:59], s13 offen nt lds
s_add_u32 m0, s17, 0xcc00
s_nop 0
buffer_load_dwordx4 v6, s[60:63], s13 offen nt lds
v_add_u32 v5, 0x80000, v5
v_add_u32 v6, 0x80000, v6
s_add_u32 m0, s16, 0x8000
s_nop 0
buffer_load_dwordx4 v2, s[48:51], 0 offen lds
s_add_u32 m0, s16, 0x8400
s_nop 0
buffer_load_dwordx4 v3, s[48:51], 0 offen lds
s_add_u32 m0, s16, 0x8800
s_nop 0
buffer_load_dwordx4 v2, s[48:51], s12 offen lds
s_add_u32 m0, s16, 0x8c00
s_nop 0
buffer_load_dwordx4 v3, s[48:51], s12 offen lds
s_add_u32 m0, s16, 0x9000
s_nop 0
buffer_load_dwordx4 v2, s[48:51], s13 offen lds
s_add_u32 m0, s16, 0x9400
s_nop 0
buffer_load_dwordx4 v3, s[48:51], s13 offen lds
s_add_u32 m0, s16, 0x9800
s_nop 0
buffer_load_dwordx4 v2, s[48:51], s14 offen lds
s_add_u32 m0, s16, 0x9c00
s_nop 0
buffer_load_dwordx4 v3, s[48:51], s14 offen lds
v_add_u32 v2, 0x80, v2
v_add_u32 v3, 0x80, v3
s_add_u32 m0, s17, 0x10000
s_nop 0
buffer_load_dwordx4 v5, s[56:59], 0 offen nt lds
s_add_u32 m0, s17, 0x14000
s_nop 0
buffer_load_dwordx4 v5, s[60:63], 0 offen nt lds
s_add_u32 m0, s17, 0x10400
s_nop 0
buffer_load_dwordx4 v5, s[56:59], s13 offen nt lds
s_add_u32 m0, s17, 0x14400
s_nop 0
buffer_load_dwordx4 v5, s[60:63], s13 offen nt lds
s_add_u32 m0, s17, 0x10800
s_nop 0
buffer_load_dwordx4 v6, s[56:59], 0 offen nt lds
s_add_u32 m0, s17, 0x14800
s_nop 0
buffer_load_dwordx4 v6, s[60:63], 0 offen nt lds
s_add_u32 m0, s17, 0x10c00
s_nop 0
buffer_load_dwordx4 v6, s[56:59], s13 offen nt lds
s_add_u32 m0, s17, 0x14c00
s_nop 0
buffer_load_dwordx4 v6, s[60:63], s13 offen nt lds
v_add_u32 v5, 0x80000, v5
v_add_u32 v6, 0x80000, v6
v_lshrrev_b32 v17, 4, v0
v_xor_b32 v17, v17, v0
v_and_b32 v17, 7, v17
v_lshlrev_b32 v17, 4, v17
v_lshrrev_b32 v18, 3, v0
v_lshl_add_u32 v22, v18, 11, v17
v_xor_b32 v23, 64, v22
v_add_u32 v23, 0x4000, v23
s_and_b32 s8, s4, 1
s_lshl_b32 s9, s8, 6
s_lshl_b32 s8, s8, 14
v_xor_b32 v4, s9, v22
v_add_u32 v4, s8, v4
s_lshl_b32 s8, s6, 18
s_sub_u32 s9, 15, s6
s_lshl_b32 s9, s9, 18
s_lshl_b32 s10, s4, 15
s_sub_u32 s11, 0x38000, s10
s_add_u32 s20, s8, s10
s_add_u32 s21, s8, s11
s_add_u32 s22, s9, s10
s_add_u32 s23, s9, s11
s_cmp_lt_u32 s4, 2
s_cselect_b32 s24, s8, s9
s_max_u32 s24, s24, 0x8000
s_sub_u32 s24, s24, 0x8000
v_lshrrev_b32 v17, 2, v0
s_lshl_b32 s8, s4, 4
v_add_u32 v17, s8, v17
v_mul_u32_u24 v17, 0x1800, v17
v_and_b32 v18, 3, v0
v_lshlrev_b32 v18, 4, v18
v_and_b32 v19, 32, v0
v_xor_b32 v18, v18, v19
s_lshl_b32 s8, s5, 6
v_add3_u32 v7, v17, v18, s8
v_and_b32 v17, 15, v0
v_lshrrev_b32 v18, 1, v17
v_lshrrev_b32 v19, 4, v0
v_xor_b32 v18, v18, v19
v_lshlrev_b32 v18, 4, v18
v_lshl_add_u32 v10, v17, 7, v18
v_add_u32 v8, s16, v10
v_xor_b32 v9, 64, v8
s_lshr_b32 s8, s4, 1
s_lshl_b32 s8, s8, 11
s_add_u32 s8, s8, 94208
v_add_u32 v10, s8, v10
v_xor_b32 v11, 64, v10
v_lshrrev_b32 v17, 4, v0
v_lshlrev_b32 v18, 11, v17
v_and_b32 v17, 1, v17
v_lshl_add_u32 v18, v17, 5, v18
v_bfe_u32 v17, v0, 2, 2
v_lshl_add_u32 v18, v17, 6, v18
v_and_b32 v17, 3, v0
v_lshl_add_u32 v12, v17, 3, v18
v_xor_b32 v13, 32, v12
v_lshrrev_b32 v17, 4, v0
v_lshlrev_b32 v18, 9, v17
v_and_b32 v17, 1, v17
v_lshl_add_u32 v18, v17, 5, v18
v_bfe_u32 v17, v0, 2, 2
v_lshl_add_u32 v18, v17, 6, v18
v_and_b32 v17, 3, v0
v_lshl_add_u32 v14, v17, 3, v18
s_and_b32 s8, s4, 1
s_lshl_b32 s8, s8, 5
v_xor_b32 v14, s8, v14
v_add_u32 v14, 81920, v14
v_xor_b32 v15, 32, v14
s_mul_i32 s32, s5, 0x108000
s_lshl_b32 s19, s4, 13
s_add_u32 s32, s32, s19
s_cmp_eq_u32 s4, 0
s_cselect_b32 s99, 0x200000, 0
s_add_u32 s32, s32, s99
s_sub_u32 s99, 0x8000, s99
s_add_u32 s7, s32, 0x1000
s_add_u32 s27, s19, 131072
v_accvgpr_write_b32 a116, -1
v_accvgpr_write_b32 a117, -1
v_accvgpr_write_b32 a118, -1
v_accvgpr_write_b32 a119, -1
s_lshl_b32 s8, s2, 2
s_add_u32 s8, s8, s4
s_lshl_b32 s8, s8, 11
v_lshrrev_b32 v19, 2, v0
v_lshl_add_u32 v19, v19, 7, s8
s_mov_b32 s9, 0x0
s_nop 0
buffer_load_dword v18, v19, s[48:51], s9 offen
s_getpc_b64 s[76:77]
s_and_b32 s76, s76, 0xfffffc00
s_lshr_b32 s8, s2, 3
s_lshl_b32 s8, s8, 2
s_add_u32 s8, s8, s4
s_min_u32 s8, s8, 92
s_lshl_b32 s8, s8, 10
s_add_u32 s76, s76, s8
s_addc_u32 s77, s77, 0
v_add_u32 v60, s76, v16
v_mov_b32 v61, s77
s_nop 0
global_load_dword v18, v[60:61], off sc1
s_cmp_lg_u32 s4, 0
s_cbranch_scc1 L_flag_clr
s_lshl_b32 s8, s6, 5
s_add_u32 s8, s8, s5
s_lshl_b32 s8, s8, 2
s_add_u32 s8, s8, 0x3604000
v_mov_b32 v17, 0
s_mov_b64 exec, 1
buffer_store_dword v17, off, s[88:91], s8 sc1
s_mov_b64 exec, -1
L_flag_clr:
s_waitcnt vmcnt(42)
v_mov_b32 v48, 0
v_mov_b32 v49, 0
v_lshlrev_b32 v50, 16, v40
v_and_b32 v51, 0xffff0000, v40
v_lshlrev_b32 v52, 16, v24
v_and_b32 v53, 0xffff0000, v24
v_fmac_f32 v48, v50, v52
v_fmac_f32 v48, v51, v53
v_lshlrev_b32 v52, 16, v32
v_and_b32 v53, 0xffff0000, v32
v_fmac_f32 v49, v50, v52
v_fmac_f32 v49, v51, v53
v_lshlrev_b32 v50, 16, v41
v_and_b32 v51, 0xffff0000, v41
v_lshlrev_b32 v52, 16, v25
v_and_b32 v53, 0xffff0000, v25
v_fmac_f32 v48, v50, v52
v_fmac_f32 v48, v51, v53
v_lshlrev_b32 v52, 16, v33
v_and_b32 v53, 0xffff0000, v33
v_fmac_f32 v49, v50, v52
v_fmac_f32 v49, v51, v53
v_lshlrev_b32 v50, 16, v42
v_and_b32 v51, 0xffff0000, v42
v_lshlrev_b32 v52, 16, v26
v_and_b32 v53, 0xffff0000, v26
v_fmac_f32 v48, v50, v52
v_fmac_f32 v48, v51, v53
v_lshlrev_b32 v52, 16, v34
v_and_b32 v53, 0xffff0000, v34
v_fmac_f32 v49, v50, v52
v_fmac_f32 v49, v51, v53
v_lshlrev_b32 v50, 16, v43
v_and_b32 v51, 0xffff0000, v43
v_lshlrev_b32 v52, 16, v27
v_and_b32 v53, 0xffff0000, v27
v_fmac_f32 v48, v50, v52
v_fmac_f32 v48, v51, v53
v_lshlrev_b32 v52, 16, v35
v_and_b32 v53, 0xffff0000, v35
v_fmac_f32 v49, v50, v52
v_fmac_f32 v49, v51, v53
v_lshlrev_b32 v50, 16, v44
v_and_b32 v51, 0xffff0000, v44
v_lshlrev_b32 v52, 16, v28
v_and_b32 v53, 0xffff0000, v28
v_fmac_f32 v48, v50, v52
v_fmac_f32 v48, v51, v53
v_lshlrev_b32 v52, 16, v36
v_and_b32 v53, 0xffff0000, v36
v_fmac_f32 v49, v50, v52
v_fmac_f32 v49, v51, v53
v_lshlrev_b32 v50, 16, v45
v_and_b32 v51, 0xffff0000, v45
v_lshlrev_b32 v52, 16, v29
v_and_b32 v53, 0xffff0000, v29
v_fmac_f32 v48, v50, v52
v_fmac_f32 v48, v51, v53
v_lshlrev_b32 v52, 16, v37
v_and_b32 v53, 0xffff0000, v37
v_fmac_f32 v49, v50, v52
v_fmac_f32 v49, v51, v53
v_lshlrev_b32 v50, 16, v46
v_and_b32 v51, 0xffff0000, v46
v_lshlrev_b32 v52, 16, v30
v_and_b32 v53, 0xffff0000, v30
v_fmac_f32 v48, v50, v52
v_fmac_f32 v48, v51, v53
v_lshlrev_b32 v52, 16, v38
v_and_b32 v53, 0xffff0000, v38
v_fmac_f32 v49, v50, v52
v_fmac_f32 v49, v51, v53
v_lshlrev_b32 v50, 16, v47
v_and_b32 v51, 0xffff0000, v47
v_lshlrev_b32 v52, 16, v31
v_and_b32 v53, 0xffff0000, v31
v_fmac_f32 v48, v50, v52
v_fmac_f32 v48, v51, v53
v_lshlrev_b32 v52, 16, v39
v_and_b32 v53, 0xffff0000, v39
v_fmac_f32 v49, v50, v52
v_fmac_f32 v49, v51, v53
s_nop 1
v_add_f32_dpp v48, v48, v48 row_ror:8 row_mask:0xf bank_mask:0xf
v_add_f32_dpp v49, v49, v49 row_ror:8 row_mask:0xf bank_mask:0xf
s_nop 1
v_add_f32_dpp v48, v48, v48 row_ror:4 row_mask:0xf bank_mask:0xf
v_add_f32_dpp v49, v49, v49 row_ror:4 row_mask:0xf bank_mask:0xf
s_nop 1
v_add_f32_dpp v48, v48, v48 row_ror:2 row_mask:0xf bank_mask:0xf
v_add_f32_dpp v49, v49, v49 row_ror:2 row_mask:0xf bank_mask:0xf
s_nop 1
v_add_f32_dpp v48, v48, v48 row_ror:1 row_mask:0xf bank_mask:0xf
v_add_f32_dpp v49, v49, v49 row_ror:1 row_mask:0xf bank_mask:0xf
v_mov_b32 v50, v48
v_mov_b32 v51, v49
s_nop 1
v_permlane16_swap_b32 v50, v48
v_permlane16_swap_b32 v51, v49
v_add_f32 v48, v48, v50
v_add_f32 v49, v49, v51
v_mov_b32 v50, v48
v_mov_b32 v51, v49
s_nop 1
v_permlane32_swap_b32 v50, v48
v_permlane32_swap_b32 v51, v49
v_add_f32 v48, v48, v50
v_add_f32 v49, v49, v51
v_mul_f32 v48, 0xbfb8aa3b, v48
v_mul_f32 v49, 0xbfb8aa3b, v49
v_exp_f32 v48, v48
v_exp_f32 v49, v49
s_nop 0
v_add_f32 v48, 1.0, v48
v_add_f32 v49, 1.0, v49
v_rcp_f32 v48, v48
v_rcp_f32 v49, v49
v_cmp_eq_u32 vcc, 0, v0
s_nop 1
s_and_saveexec_b64 s[92:93], vcc
buffer_store_dwordx2 v[48:49], v0, s[88:91], s28 offen sc1
s_mov_b64 exec, s[92:93]
s_waitcnt vmcnt(27)
s_barrier
ds_read_b128 a[0:3], v8 offset:0
ds_read_b128 a[4:7], v8 offset:2048
ds_read_b128 a[8:11], v8 offset:4096
ds_read_b128 a[12:15], v8 offset:6144
ds_read_b64_tr_b16 a[40:41], v12 offset:0
ds_read_b64_tr_b16 a[42:43], v12 offset:1024
ds_read_b64_tr_b16 a[44:45], v13 offset:0
ds_read_b64_tr_b16 a[46:47], v13 offset:1024
ds_read_b64_tr_b16 a[48:49], v12 offset:256
ds_read_b64_tr_b16 a[50:51], v12 offset:1280
ds_read_b64_tr_b16 a[52:53], v13 offset:256
ds_read_b64_tr_b16 a[54:55], v13 offset:1280
ds_read_b64_tr_b16 a[56:57], v12 offset:512
ds_read_b64_tr_b16 a[58:59], v12 offset:1536
ds_read_b64_tr_b16 a[60:61], v13 offset:512
ds_read_b64_tr_b16 a[62:63], v13 offset:1536
ds_read_b64_tr_b16 a[64:65], v12 offset:768
ds_read_b64_tr_b16 a[66:67], v12 offset:1792
ds_read_b64_tr_b16 a[68:69], v13 offset:768
ds_read_b64_tr_b16 a[70:71], v13 offset:1792
ds_read_b64_tr_b16 a[72:73], v12 offset:16384
ds_read_b64_tr_b16 a[74:75], v12 offset:17408
ds_read_b64_tr_b16 a[76:77], v13 offset:16384
ds_read_b64_tr_b16 a[78:79], v13 offset:17408
ds_read_b64_tr_b16 a[80:81], v12 offset:16640
ds_read_b64_tr_b16 a[82:83], v12 offset:17664
ds_read_b64_tr_b16 a[84:85], v13 offset:16640
ds_read_b64_tr_b16 a[86:87], v13 offset:17664
ds_read_b64_tr_b16 a[88:89], v12 offset:16896
ds_read_b64_tr_b16 a[90:91], v12 offset:17920
ds_read_b64_tr_b16 a[92:93], v13 offset:16896
ds_read_b64_tr_b16 a[94:95], v13 offset:17920
ds_read_b64_tr_b16 a[96:97], v12 offset:17152
ds_read_b64_tr_b16 a[98:99], v12 offset:18176
ds_read_b64_tr_b16 a[100:101], v13 offset:17152
ds_read_b64_tr_b16 a[102:103], v13 offset:18176
s_waitcnt lgkmcnt(0)
v_mfma_f32_16x16x32_bf16 v[24:27], a[40:43], a[0:3], 0
ds_read_b128 a[20:23], v9 offset:0
v_mfma_f32_16x16x32_bf16 v[56:59], a[40:43], a[4:7], 0
ds_read_b128 a[24:27], v9 offset:2048
v_mfma_f32_16x16x32_bf16 v[88:91], a[40:43], a[8:11], 0
ds_read_b128 a[28:31], v9 offset:4096
v_mfma_f32_16x16x32_bf16 v[120:123], a[40:43], a[12:15], 0
ds_read_b128 a[32:35], v9 offset:6144
v_mfma_f32_16x16x32_bf16 v[124:127], a[44:47], a[12:15], 0
ds_read_b64_tr_b16 a[104:105], v13 offset:25088
v_mfma_f32_16x16x32_bf16 v[92:95], a[44:47], a[8:11], 0
ds_read_b64_tr_b16 a[106:107], v13 offset:26112
v_mfma_f32_16x16x32_bf16 v[60:63], a[44:47], a[4:7], 0
ds_read_b64_tr_b16 a[108:109], v12 offset:25344
v_mfma_f32_16x16x32_bf16 v[28:31], a[44:47], a[0:3], 0
ds_read_b64_tr_b16 a[110:111], v12 offset:26368
v_mfma_f32_16x16x32_bf16 v[32:35], a[48:51], a[0:3], 0
ds_read_b64_tr_b16 a[112:113], v13 offset:25344
s_waitcnt lgkmcnt(5)
v_mfma_f32_16x16x32_bf16 v[64:67], a[48:51], a[4:7], 0
ds_read_b64_tr_b16 a[114:115], v13 offset:26368
s_add_u32 m0, s16, 0x0
v_mfma_f32_16x16x32_bf16 v[96:99], a[48:51], a[8:11], 0
buffer_load_dwordx4 v2, s[48:51], 0 offen lds
v_mfma_f32_16x16x32_bf16 v[128:131], a[48:51], a[12:15], 0
ds_read_b64_tr_b16 a[40:41], v12 offset:8192
v_mfma_f32_16x16x32_bf16 v[132:135], a[52:55], a[12:15], 0
ds_read_b64_tr_b16 a[42:43], v12 offset:9216
v_mfma_f32_16x16x32_bf16 v[100:103], a[52:55], a[8:11], 0
ds_read_b64_tr_b16 a[44:45], v13 offset:8192
v_mfma_f32_16x16x32_bf16 v[68:71], a[52:55], a[4:7], 0
ds_read_b64_tr_b16 a[46:47], v13 offset:9216
v_mfma_f32_16x16x32_bf16 v[36:39], a[52:55], a[0:3], 0
ds_read_b64_tr_b16 a[48:49], v12 offset:8448
s_add_u32 m0, s16, 0x400
v_mfma_f32_16x16x32_bf16 v[40:43], a[56:59], a[0:3], 0
buffer_load_dwordx4 v3, s[48:51], 0 offen lds
v_mfma_f32_16x16x32_bf16 v[72:75], a[56:59], a[4:7], 0
ds_read_b64_tr_b16 a[50:51], v12 offset:9472
v_mfma_f32_16x16x32_bf16 v[104:107], a[56:59], a[8:11], 0
ds_read_b64_tr_b16 a[52:53], v13 offset:8448
v_mfma_f32_16x16x32_bf16 v[136:139], a[56:59], a[12:15], 0
ds_read_b64_tr_b16 a[54:55], v13 offset:9472
v_mfma_f32_16x16x32_bf16 v[140:143], a[60:63], a[12:15], 0
ds_read_b64_tr_b16 a[56:57], v12 offset:8704
v_mfma_f32_16x16x32_bf16 v[108:111], a[60:63], a[8:11], 0
ds_read_b64_tr_b16 a[58:59], v12 offset:9728
v_mfma_f32_16x16x32_bf16 v[76:79], a[60:63], a[4:7], 0
s_add_u32 m0, s16, 0x800
v_mfma_f32_16x16x32_bf16 v[44:47], a[60:63], a[0:3], 0
buffer_load_dwordx4 v2, s[48:51], s12 offen lds
v_mfma_f32_16x16x32_bf16 v[48:51], a[64:67], a[0:3], 0
ds_read_b64_tr_b16 a[60:61], v13 offset:8704
v_mfma_f32_16x16x32_bf16 v[80:83], a[64:67], a[4:7], 0
ds_read_b64_tr_b16 a[62:63], v13 offset:9728
v_mfma_f32_16x16x32_bf16 v[112:115], a[64:67], a[8:11], 0
v_mfma_f32_16x16x32_bf16 v[144:147], a[64:67], a[12:15], 0
ds_read_b64_tr_b16 a[64:65], v12 offset:8960
v_mfma_f32_16x16x32_bf16 v[148:151], a[68:71], a[12:15], 0
ds_read_b64_tr_b16 a[66:67], v12 offset:9984
s_add_u32 m0, s16, 0xc00
v_mfma_f32_16x16x32_bf16 v[116:119], a[68:71], a[8:11], 0
buffer_load_dwordx4 v3, s[48:51], s12 offen lds
v_mfma_f32_16x16x32_bf16 v[84:87], a[68:71], a[4:7], 0
v_mfma_f32_16x16x32_bf16 v[52:55], a[68:71], a[0:3], 0
ds_read_b64_tr_b16 a[68:69], v13 offset:8960
v_mfma_f32_16x16x32_bf16 v[152:155], a[0:3], a[72:75], 0
ds_read_b64_tr_b16 a[70:71], v13 offset:9984
v_mfma_f32_16x16x32_bf16 v[156:159], a[4:7], a[72:75], 0
v_mfma_f32_16x16x32_bf16 v[216:219], a[8:11], a[72:75], 0
v_mfma_f32_16x16x32_bf16 v[220:223], a[12:15], a[72:75], 0
ds_read_b64_tr_b16 a[72:73], v12 offset:24576
s_add_u32 m0, s16, 0x1000
v_mfma_f32_16x16x32_bf16 v[228:231], a[12:15], a[76:79], 0
buffer_load_dwordx4 v2, s[48:51], s13 offen lds
v_mfma_f32_16x16x32_bf16 v[224:227], a[8:11], a[76:79], 0
ds_read_b64_tr_b16 a[74:75], v12 offset:25600
v_mfma_f32_16x16x32_bf16 v[164:167], a[4:7], a[76:79], 0
v_mfma_f32_16x16x32_bf16 v[160:163], a[0:3], a[76:79], 0
ds_read_b64_tr_b16 a[76:77], v13 offset:24576
v_mfma_f32_16x16x32_bf16 v[168:171], a[0:3], a[80:83], 0
ds_read_b64_tr_b16 a[78:79], v13 offset:25600
v_mfma_f32_16x16x32_bf16 v[172:175], a[4:7], a[80:83], 0
s_add_u32 m0, s16, 0x1400
v_mfma_f32_16x16x32_bf16 v[232:235], a[8:11], a[80:83], 0
buffer_load_dwordx4 v3, s[48:51], s13 offen lds
v_mfma_f32_16x16x32_bf16 v[236:239], a[12:15], a[80:83], 0
ds_read_b64_tr_b16 a[80:81], v12 offset:24832
v_mfma_f32_16x16x32_bf16 v[244:247], a[12:15], a[84:87], 0
ds_read_b64_tr_b16 a[82:83], v12 offset:25856
v_mfma_f32_16x16x32_bf16 v[240:243], a[8:11], a[84:87], 0
v_mfma_f32_16x16x32_bf16 v[180:183], a[4:7], a[84:87], 0
v_mfma_f32_16x16x32_bf16 v[176:179], a[0:3], a[84:87], 0
ds_read_b64_tr_b16 a[84:85], v13 offset:24832
v_mfma_f32_16x16x32_bf16 v[184:187], a[0:3], a[88:91], 0
ds_read_b64_tr_b16 a[86:87], v13 offset:25856
s_add_u32 m0, s16, 0x1800
v_mfma_f32_16x16x32_bf16 v[188:191], a[4:7], a[88:91], 0
buffer_load_dwordx4 v2, s[48:51], s14 offen lds
v_mfma_f32_16x16x32_bf16 v[248:251], a[8:11], a[88:91], 0
v_mfma_f32_16x16x32_bf16 v[252:255], a[12:15], a[88:91], 0
ds_read_b64_tr_b16 a[88:89], v12 offset:25088
v_mfma_f32_16x16x32_bf16 a[236:239], a[12:15], a[92:95], 0
ds_read_b64_tr_b16 a[90:91], v12 offset:26112
v_add_u32 v12, 0x8000, v12
v_mfma_f32_16x16x32_bf16 a[232:235], a[8:11], a[92:95], 0
v_add_u32 v13, 0x8000, v13
v_mfma_f32_16x16x32_bf16 v[196:199], a[4:7], a[92:95], 0
s_add_u32 m0, s16, 0x1c00
v_mfma_f32_16x16x32_bf16 v[192:195], a[0:3], a[92:95], 0
buffer_load_dwordx4 v3, s[48:51], s14 offen lds
v_mfma_f32_16x16x32_bf16 v[200:203], a[0:3], a[96:99], 0
v_mfma_f32_16x16x32_bf16 v[204:207], a[4:7], a[96:99], 0
v_mfma_f32_16x16x32_bf16 a[240:243], a[8:11], a[96:99], 0
v_mfma_f32_16x16x32_bf16 a[244:247], a[12:15], a[96:99], 0
v_mfma_f32_16x16x32_bf16 a[252:255], a[12:15], a[100:103], 0
v_mfma_f32_16x16x32_bf16 a[248:251], a[8:11], a[100:103], 0
v_mfma_f32_16x16x32_bf16 v[212:215], a[4:7], a[100:103], 0
v_mfma_f32_16x16x32_bf16 v[208:211], a[0:3], a[100:103], 0
s_waitcnt vmcnt(19) lgkmcnt(0)
s_barrier
v_mfma_f32_16x16x32_bf16 v[24:27], a[40:43], a[20:23], v[24:27]
ds_read_b128 a[0:3], v8 offset:32768
s_add_u32 m0, s17, 0x0
v_mfma_f32_16x16x32_bf16 v[56:59], a[40:43], a[24:27], v[56:59]
buffer_load_dwordx4 v5, s[56:59], 0 offen nt lds
v_mfma_f32_16x16x32_bf16 v[88:91], a[40:43], a[28:31], v[88:91]
ds_read_b128 a[4:7], v8 offset:34816
v_add_u32 v2, 0x80, v2
v_mfma_f32_16x16x32_bf16 v[120:123], a[40:43], a[32:35], v[120:123]
ds_read_b128 a[8:11], v8 offset:36864
v_add_u32 v3, 0x80, v3
v_mfma_f32_16x16x32_bf16 v[124:127], a[44:47], a[32:35], v[124:127]
ds_read_b128 a[12:15], v8 offset:38912
v_mfma_f32_16x16x32_bf16 v[92:95], a[44:47], a[28:31], v[92:95]
ds_read_b64_tr_b16 a[92:93], v13 offset:16896
v_mfma_f32_16x16x32_bf16 v[60:63], a[44:47], a[24:27], v[60:63]
ds_read_b64_tr_b16 a[94:95], v13 offset:17920
s_add_u32 m0, s17, 0x4000
v_mfma_f32_16x16x32_bf16 v[28:31], a[44:47], a[20:23], v[28:31]
buffer_load_dwordx4 v5, s[60:63], 0 offen nt lds
v_mfma_f32_16x16x32_bf16 v[32:35], a[48:51], a[20:23], v[32:35]
ds_read_b64_tr_b16 a[96:97], v12 offset:17152
v_mfma_f32_16x16x32_bf16 v[64:67], a[48:51], a[24:27], v[64:67]
ds_read_b64_tr_b16 a[98:99], v12 offset:18176
v_mfma_f32_16x16x32_bf16 v[96:99], a[48:51], a[28:31], v[96:99]
ds_read_b64_tr_b16 a[100:101], v13 offset:17152
v_mfma_f32_16x16x32_bf16 v[128:131], a[48:51], a[32:35], v[128:131]
ds_read_b64_tr_b16 a[102:103], v13 offset:18176
v_mfma_f32_16x16x32_bf16 v[132:135], a[52:55], a[32:35], v[132:135]
ds_read_b64_tr_b16 a[40:41], v12 offset:0
v_mfma_f32_16x16x32_bf16 v[100:103], a[52:55], a[28:31], v[100:103]
ds_read_b64_tr_b16 a[42:43], v12 offset:1024
s_add_u32 m0, s17, 0x400
v_mfma_f32_16x16x32_bf16 v[68:71], a[52:55], a[24:27], v[68:71]
buffer_load_dwordx4 v5, s[56:59], s13 offen nt lds
v_mfma_f32_16x16x32_bf16 v[36:39], a[52:55], a[20:23], v[36:39]
ds_read_b64_tr_b16 a[44:45], v13 offset:0
v_mfma_f32_16x16x32_bf16 v[40:43], a[56:59], a[20:23], v[40:43]
ds_read_b64_tr_b16 a[46:47], v13 offset:1024
v_mfma_f32_16x16x32_bf16 v[72:75], a[56:59], a[24:27], v[72:75]
ds_read_b64_tr_b16 a[48:49], v12 offset:256
v_mfma_f32_16x16x32_bf16 v[104:107], a[56:59], a[28:31], v[104:107]
ds_read_b64_tr_b16 a[50:51], v12 offset:1280
v_mfma_f32_16x16x32_bf16 v[136:139], a[56:59], a[32:35], v[136:139]
ds_read_b64_tr_b16 a[52:53], v13 offset:256
v_mfma_f32_16x16x32_bf16 v[140:143], a[60:63], a[32:35], v[140:143]
ds_read_b64_tr_b16 a[54:55], v13 offset:1280
s_add_u32 m0, s17, 0x4400
v_mfma_f32_16x16x32_bf16 v[108:111], a[60:63], a[28:31], v[108:111]
buffer_load_dwordx4 v5, s[60:63], s13 offen nt lds
v_mfma_f32_16x16x32_bf16 v[76:79], a[60:63], a[24:27], v[76:79]
ds_read_b64_tr_b16 a[56:57], v12 offset:512
v_mfma_f32_16x16x32_bf16 v[44:47], a[60:63], a[20:23], v[44:47]
ds_read_b64_tr_b16 a[58:59], v12 offset:1536
v_mfma_f32_16x16x32_bf16 v[48:51], a[64:67], a[20:23], v[48:51]
ds_read_b64_tr_b16 a[60:61], v13 offset:512
v_mfma_f32_16x16x32_bf16 v[80:83], a[64:67], a[24:27], v[80:83]
ds_read_b64_tr_b16 a[62:63], v13 offset:1536
v_mfma_f32_16x16x32_bf16 v[112:115], a[64:67], a[28:31], v[112:115]
v_mfma_f32_16x16x32_bf16 v[144:147], a[64:67], a[32:35], v[144:147]
ds_read_b64_tr_b16 a[64:65], v12 offset:768
s_add_u32 m0, s17, 0x800
v_mfma_f32_16x16x32_bf16 v[148:151], a[68:71], a[32:35], v[148:151]
buffer_load_dwordx4 v6, s[56:59], 0 offen nt lds
v_mfma_f32_16x16x32_bf16 v[116:119], a[68:71], a[28:31], v[116:119]
ds_read_b64_tr_b16 a[66:67], v12 offset:1792
v_mfma_f32_16x16x32_bf16 v[84:87], a[68:71], a[24:27], v[84:87]
v_mfma_f32_16x16x32_bf16 v[52:55], a[68:71], a[20:23], v[52:55]
ds_read_b64_tr_b16 a[68:69], v13 offset:768
v_mfma_f32_16x16x32_bf16 v[152:155], a[20:23], a[72:75], v[152:155]
ds_read_b64_tr_b16 a[70:71], v13 offset:1792
v_mfma_f32_16x16x32_bf16 v[156:159], a[24:27], a[72:75], v[156:159]
s_add_u32 m0, s17, 0x4800
v_mfma_f32_16x16x32_bf16 v[216:219], a[28:31], a[72:75], v[216:219]
buffer_load_dwordx4 v6, s[60:63], 0 offen nt lds
v_mfma_f32_16x16x32_bf16 v[220:223], a[32:35], a[72:75], v[220:223]
ds_read_b64_tr_b16 a[72:73], v12 offset:16384
v_mfma_f32_16x16x32_bf16 v[228:231], a[32:35], a[76:79], v[228:231]
ds_read_b64_tr_b16 a[74:75], v12 offset:17408
v_mfma_f32_16x16x32_bf16 v[224:227], a[28:31], a[76:79], v[224:227]
v_mfma_f32_16x16x32_bf16 v[164:167], a[24:27], a[76:79], v[164:167]
v_mfma_f32_16x16x32_bf16 v[160:163], a[20:23], a[76:79], v[160:163]
ds_read_b64_tr_b16 a[76:77], v13 offset:16384
v_mfma_f32_16x16x32_bf16 v[168:171], a[20:23], a[80:83], v[168:171]
ds_read_b64_tr_b16 a[78:79], v13 offset:17408
s_add_u32 m0, s17, 0xc00
v_mfma_f32_16x16x32_bf16 v[172:175], a[24:27], a[80:83], v[172:175]
buffer_load_dwordx4 v6, s[56:59], s13 offen nt lds
v_mfma_f32_16x16x32_bf16 v[232:235], a[28:31], a[80:83], v[232:235]
v_mfma_f32_16x16x32_bf16 v[236:239], a[32:35], a[80:83], v[236:239]
ds_read_b64_tr_b16 a[80:81], v12 offset:16640
v_mfma_f32_16x16x32_bf16 v[244:247], a[32:35], a[84:87], v[244:247]
ds_read_b64_tr_b16 a[82:83], v12 offset:17664
v_mfma_f32_16x16x32_bf16 v[240:243], a[28:31], a[84:87], v[240:243]
v_mfma_f32_16x16x32_bf16 v[180:183], a[24:27], a[84:87], v[180:183]
v_mfma_f32_16x16x32_bf16 v[176:179], a[20:23], a[84:87], v[176:179]
ds_read_b64_tr_b16 a[84:85], v13 offset:16640
s_add_u32 m0, s17, 0x4c00
v_mfma_f32_16x16x32_bf16 v[184:187], a[20:23], a[88:91], v[184:187]
buffer_load_dwordx4 v6, s[60:63], s13 offen nt lds
v_mfma_f32_16x16x32_bf16 v[188:191], a[24:27], a[88:91], v[188:191]
ds_read_b64_tr_b16 a[86:87], v13 offset:17664
v_mfma_f32_16x16x32_bf16 v[248:251], a[28:31], a[88:91], v[248:251]
v_mfma_f32_16x16x32_bf16 v[252:255], a[32:35], a[88:91], v[252:255]
ds_read_b64_tr_b16 a[88:89], v12 offset:16896
v_mfma_f32_16x16x32_bf16 a[236:239], a[32:35], a[104:107], a[236:239]
ds_read_b64_tr_b16 a[90:91], v12 offset:17920
v_mfma_f32_16x16x32_bf16 a[232:235], a[28:31], a[104:107], a[232:235]
v_mfma_f32_16x16x32_bf16 v[196:199], a[24:27], a[104:107], v[196:199]
s_mov_b32 s9, 0x0
v_mfma_f32_16x16x32_bf16 v[192:195], a[20:23], a[104:107], v[192:195]
buffer_load_dword v18, v19, s[44:47], s9 offen
v_mfma_f32_16x16x32_bf16 v[200:203], a[20:23], a[108:111], v[200:203]
v_mfma_f32_16x16x32_bf16 v[204:207], a[24:27], a[108:111], v[204:207]
v_mfma_f32_16x16x32_bf16 a[240:243], a[28:31], a[108:111], a[240:243]
v_mfma_f32_16x16x32_bf16 a[244:247], a[32:35], a[108:111], a[244:247]
v_mfma_f32_16x16x32_bf16 a[252:255], a[32:35], a[112:115], a[252:255]
v_mfma_f32_16x16x32_bf16 a[248:251], a[28:31], a[112:115], a[248:251]
v_mfma_f32_16x16x32_bf16 v[212:215], a[24:27], a[112:115], v[212:215]
v_mfma_f32_16x16x32_bf16 v[208:211], a[20:23], a[112:115], v[208:211]
s_waitcnt lgkmcnt(0)
v_mfma_f32_16x16x32_bf16 v[24:27], a[40:43], a[0:3], v[24:27]
ds_read_b128 a[20:23], v9 offset:32768
v_add_u32 v5, 0x80000, v5
v_mfma_f32_16x16x32_bf16 v[56:59], a[40:43], a[4:7], v[56:59]
ds_read_b128 a[24:27], v9 offset:34816
v_add_u32 v6, 0x80000, v6
v_mfma_f32_16x16x32_bf16 v[88:91], a[40:43], a[8:11], v[88:91]
ds_read_b128 a[28:31], v9 offset:36864
v_mfma_f32_16x16x32_bf16 v[120:123], a[40:43], a[12:15], v[120:123]
ds_read_b128 a[32:35], v9 offset:38912
v_mfma_f32_16x16x32_bf16 v[124:127], a[44:47], a[12:15], v[124:127]
ds_read_b64_tr_b16 a[104:105], v13 offset:25088
v_mfma_f32_16x16x32_bf16 v[92:95], a[44:47], a[8:11], v[92:95]
ds_read_b64_tr_b16 a[106:107], v13 offset:26112
v_mfma_f32_16x16x32_bf16 v[60:63], a[44:47], a[4:7], v[60:63]
ds_read_b64_tr_b16 a[108:109], v12 offset:25344
v_mfma_f32_16x16x32_bf16 v[28:31], a[44:47], a[0:3], v[28:31]
ds_read_b64_tr_b16 a[110:111], v12 offset:26368
v_mfma_f32_16x16x32_bf16 v[32:35], a[48:51], a[0:3], v[32:35]
ds_read_b64_tr_b16 a[112:113], v13 offset:25344
s_waitcnt lgkmcnt(5)
v_mfma_f32_16x16x32_bf16 v[64:67], a[48:51], a[4:7], v[64:67]
ds_read_b64_tr_b16 a[114:115], v13 offset:26368
s_add_u32 m0, s16, 0x8000
v_mfma_f32_16x16x32_bf16 v[96:99], a[48:51], a[8:11], v[96:99]
buffer_load_dwordx4 v2, s[48:51], 0 offen lds
v_mfma_f32_16x16x32_bf16 v[128:131], a[48:51], a[12:15], v[128:131]
ds_read_b64_tr_b16 a[40:41], v12 offset:8192
v_mfma_f32_16x16x32_bf16 v[132:135], a[52:55], a[12:15], v[132:135]
ds_read_b64_tr_b16 a[42:43], v12 offset:9216
v_mfma_f32_16x16x32_bf16 v[100:103], a[52:55], a[8:11], v[100:103]
ds_read_b64_tr_b16 a[44:45], v13 offset:8192
v_mfma_f32_16x16x32_bf16 v[68:71], a[52:55], a[4:7], v[68:71]
ds_read_b64_tr_b16 a[46:47], v13 offset:9216
s_add_u32 m0, s16, 0x8400
v_mfma_f32_16x16x32_bf16 v[36:39], a[52:55], a[0:3], v[36:39]
buffer_load_dwordx4 v3, s[48:51], 0 offen lds
v_mfma_f32_16x16x32_bf16 v[40:43], a[56:59], a[0:3], v[40:43]
ds_read_b64_tr_b16 a[48:49], v12 offset:8448
v_mfma_f32_16x16x32_bf16 v[72:75], a[56:59], a[4:7], v[72:75]
ds_read_b64_tr_b16 a[50:51], v12 offset:9472
v_mfma_f32_16x16x32_bf16 v[104:107], a[56:59], a[8:11], v[104:107]
ds_read_b64_tr_b16 a[52:53], v13 offset:8448
v_mfma_f32_16x16x32_bf16 v[136:139], a[56:59], a[12:15], v[136:139]
ds_read_b64_tr_b16 a[54:55], v13 offset:9472
v_mfma_f32_16x16x32_bf16 v[140:143], a[60:63], a[12:15], v[140:143]
ds_read_b64_tr_b16 a[56:57], v12 offset:8704
s_add_u32 m0, s16, 0x8800
v_mfma_f32_16x16x32_bf16 v[108:111], a[60:63], a[8:11], v[108:111]
buffer_load_dwordx4 v2, s[48:51], s12 offen lds
v_mfma_f32_16x16x32_bf16 v[76:79], a[60:63], a[4:7], v[76:79]
ds_read_b64_tr_b16 a[58:59], v12 offset:9728
v_mfma_f32_16x16x32_bf16 v[44:47], a[60:63], a[0:3], v[44:47]
ds_read_b64_tr_b16 a[60:61], v13 offset:8704
v_mfma_f32_16x16x32_bf16 v[48:51], a[64:67], a[0:3], v[48:51]
ds_read_b64_tr_b16 a[62:63], v13 offset:9728
v_mfma_f32_16x16x32_bf16 v[80:83], a[64:67], a[4:7], v[80:83]
v_mfma_f32_16x16x32_bf16 v[112:115], a[64:67], a[8:11], v[112:115]
s_add_u32 m0, s16, 0x8c00
v_mfma_f32_16x16x32_bf16 v[144:147], a[64:67], a[12:15], v[144:147]
buffer_load_dwordx4 v3, s[48:51], s12 offen lds
v_mfma_f32_16x16x32_bf16 v[148:151], a[68:71], a[12:15], v[148:151]
ds_read_b64_tr_b16 a[64:65], v12 offset:8960
v_mfma_f32_16x16x32_bf16 v[116:119], a[68:71], a[8:11], v[116:119]
ds_read_b64_tr_b16 a[66:67], v12 offset:9984
v_mfma_f32_16x16x32_bf16 v[84:87], a[68:71], a[4:7], v[84:87]
v_mfma_f32_16x16x32_bf16 v[52:55], a[68:71], a[0:3], v[52:55]
ds_read_b64_tr_b16 a[68:69], v13 offset:8960
v_mfma_f32_16x16x32_bf16 v[152:155], a[0:3], a[72:75], v[152:155]
ds_read_b64_tr_b16 a[70:71], v13 offset:9984
s_add_u32 m0, s16, 0x9000
v_mfma_f32_16x16x32_bf16 v[156:159], a[4:7], a[72:75], v[156:159]
buffer_load_dwordx4 v2, s[48:51], s13 offen lds
v_mfma_f32_16x16x32_bf16 v[216:219], a[8:11], a[72:75], v[216:219]
v_mfma_f32_16x16x32_bf16 v[220:223], a[12:15], a[72:75], v[220:223]
ds_read_b64_tr_b16 a[72:73], v12 offset:24576
v_mfma_f32_16x16x32_bf16 v[228:231], a[12:15], a[76:79], v[228:231]
ds_read_b64_tr_b16 a[74:75], v12 offset:25600
v_mfma_f32_16x16x32_bf16 v[224:227], a[8:11], a[76:79], v[224:227]
s_add_u32 m0, s16, 0x9400
v_mfma_f32_16x16x32_bf16 v[164:167], a[4:7], a[76:79], v[164:167]
buffer_load_dwordx4 v3, s[48:51], s13 offen lds
v_mfma_f32_16x16x32_bf16 v[160:163], a[0:3], a[76:79], v[160:163]
ds_read_b64_tr_b16 a[76:77], v13 offset:24576
v_mfma_f32_16x16x32_bf16 v[168:171], a[0:3], a[80:83], v[168:171]
ds_read_b64_tr_b16 a[78:79], v13 offset:25600
v_mfma_f32_16x16x32_bf16 v[172:175], a[4:7], a[80:83], v[172:175]
v_mfma_f32_16x16x32_bf16 v[232:235], a[8:11], a[80:83], v[232:235]
v_mfma_f32_16x16x32_bf16 v[236:239], a[12:15], a[80:83], v[236:239]
ds_read_b64_tr_b16 a[80:81], v12 offset:24832
s_add_u32 m0, s16, 0x9800
v_mfma_f32_16x16x32_bf16 v[244:247], a[12:15], a[84:87], v[244:247]
buffer_load_dwordx4 v2, s[48:51], s14 offen lds
v_mfma_f32_16x16x32_bf16 v[240:243], a[8:11], a[84:87], v[240:243]
ds_read_b64_tr_b16 a[82:83], v12 offset:25856
v_mfma_f32_16x16x32_bf16 v[180:183], a[4:7], a[84:87], v[180:183]
v_mfma_f32_16x16x32_bf16 v[176:179], a[0:3], a[84:87], v[176:179]
ds_read_b64_tr_b16 a[84:85], v13 offset:24832
v_mfma_f32_16x16x32_bf16 v[184:187], a[0:3], a[88:91], v[184:187]
ds_read_b64_tr_b16 a[86:87], v13 offset:25856
v_mfma_f32_16x16x32_bf16 v[188:191], a[4:7], a[88:91], v[188:191]
s_add_u32 m0, s16, 0x9c00
v_mfma_f32_16x16x32_bf16 v[248:251], a[8:11], a[88:91], v[248:251]
buffer_load_dwordx4 v3, s[48:51], s14 offen lds
v_mfma_f32_16x16x32_bf16 v[252:255], a[12:15], a[88:91], v[252:255]
ds_read_b64_tr_b16 a[88:89], v12 offset:25088
v_mfma_f32_16x16x32_bf16 a[236:239], a[12:15], a[92:95], a[236:239]
ds_read_b64_tr_b16 a[90:91], v12 offset:26112
v_add_u32 v12, 0x8000, v12
v_mfma_f32_16x16x32_bf16 a[232:235], a[8:11], a[92:95], a[232:235]
v_add_u32 v13, 0x8000, v13
v_mfma_f32_16x16x32_bf16 v[196:199], a[4:7], a[92:95], v[196:199]
v_mfma_f32_16x16x32_bf16 v[192:195], a[0:3], a[92:95], v[192:195]
s_mov_b32 s9, 0x200000
v_mfma_f32_16x16x32_bf16 v[200:203], a[0:3], a[96:99], v[200:203]
buffer_load_dword v18, v19, s[44:47], s9 offen
v_mfma_f32_16x16x32_bf16 v[204:207], a[4:7], a[96:99], v[204:207]
v_mfma_f32_16x16x32_bf16 a[240:243], a[8:11], a[96:99], a[240:243]
v_mfma_f32_16x16x32_bf16 a[244:247], a[12:15], a[96:99], a[244:247]
v_mfma_f32_16x16x32_bf16 a[252:255], a[12:15], a[100:103], a[252:255]
v_mfma_f32_16x16x32_bf16 a[248:251], a[8:11], a[100:103], a[248:251]
v_mfma_f32_16x16x32_bf16 v[212:215], a[4:7], a[100:103], v[212:215]
v_mfma_f32_16x16x32_bf16 v[208:211], a[0:3], a[100:103], v[208:211]
s_waitcnt vmcnt(18) lgkmcnt(0)
s_barrier
v_mfma_f32_16x16x32_bf16 v[24:27], a[40:43], a[20:23], v[24:27]
ds_read_b128 a[0:3], v8 offset:0
s_add_u32 m0, s17, 0x8000
v_mfma_f32_16x16x32_bf16 v[56:59], a[40:43], a[24:27], v[56:59]
buffer_load_dwordx4 v5, s[56:59], 0 offen nt lds
v_mfma_f32_16x16x32_bf16 v[88:91], a[40:43], a[28:31], v[88:91]
ds_read_b128 a[4:7], v8 offset:2048
v_add_u32 v2, 0x80, v2
v_mfma_f32_16x16x32_bf16 v[120:123], a[40:43], a[32:35], v[120:123]
ds_read_b128 a[8:11], v8 offset:4096
v_add_u32 v3, 0x80, v3
v_mfma_f32_16x16x32_bf16 v[124:127], a[44:47], a[32:35], v[124:127]
ds_read_b128 a[12:15], v8 offset:6144
v_mfma_f32_16x16x32_bf16 v[92:95], a[44:47], a[28:31], v[92:95]
ds_read_b64_tr_b16 a[92:93], v13 offset:16896
v_mfma_f32_16x16x32_bf16 v[60:63], a[44:47], a[24:27], v[60:63]
ds_read_b64_tr_b16 a[94:95], v13 offset:17920
s_add_u32 m0, s17, 0xc000
v_mfma_f32_16x16x32_bf16 v[28:31], a[44:47], a[20:23], v[28:31]
buffer_load_dwordx4 v5, s[60:63], 0 offen nt lds
v_mfma_f32_16x16x32_bf16 v[32:35], a[48:51], a[20:23], v[32:35]
ds_read_b64_tr_b16 a[96:97], v12 offset:17152
v_mfma_f32_16x16x32_bf16 v[64:67], a[48:51], a[24:27], v[64:67]
ds_read_b64_tr_b16 a[98:99], v12 offset:18176
v_mfma_f32_16x16x32_bf16 v[96:99], a[48:51], a[28:31], v[96:99]
ds_read_b64_tr_b16 a[100:101], v13 offset:17152
v_mfma_f32_16x16x32_bf16 v[128:131], a[48:51], a[32:35], v[128:131]
ds_read_b64_tr_b16 a[102:103], v13 offset:18176
v_mfma_f32_16x16x32_bf16 v[132:135], a[52:55], a[32:35], v[132:135]
ds_read_b64_tr_b16 a[40:41], v12 offset:0
v_mfma_f32_16x16x32_bf16 v[100:103], a[52:55], a[28:31], v[100:103]
ds_read_b64_tr_b16 a[42:43], v12 offset:1024
s_add_u32 m0, s17, 0x8400
v_mfma_f32_16x16x32_bf16 v[68:71], a[52:55], a[24:27], v[68:71]
buffer_load_dwordx4 v5, s[56:59], s13 offen nt lds
v_mfma_f32_16x16x32_bf16 v[36:39], a[52:55], a[20:23], v[36:39]
ds_read_b64_tr_b16 a[44:45], v13 offset:0
v_mfma_f32_16x16x32_bf16 v[40:43], a[56:59], a[20:23], v[40:43]
ds_read_b64_tr_b16 a[46:47], v13 offset:1024
v_mfma_f32_16x16x32_bf16 v[72:75], a[56:59], a[24:27], v[72:75]
ds_read_b64_tr_b16 a[48:49], v12 offset:256
v_mfma_f32_16x16x32_bf16 v[104:107], a[56:59], a[28:31], v[104:107]
ds_read_b64_tr_b16 a[50:51], v12 offset:1280
v_mfma_f32_16x16x32_bf16 v[136:139], a[56:59], a[32:35], v[136:139]
ds_read_b64_tr_b16 a[52:53], v13 offset:256
v_mfma_f32_16x16x32_bf16 v[140:143], a[60:63], a[32:35], v[140:143]
ds_read_b64_tr_b16 a[54:55], v13 offset:1280
s_add_u32 m0, s17, 0xc400
v_mfma_f32_16x16x32_bf16 v[108:111], a[60:63], a[28:31], v[108:111]
buffer_load_dwordx4 v5, s[60:63], s13 offen nt lds
v_mfma_f32_16x16x32_bf16 v[76:79], a[60:63], a[24:27], v[76:79]
ds_read_b64_tr_b16 a[56:57], v12 offset:512
v_mfma_f32_16x16x32_bf16 v[44:47], a[60:63], a[20:23], v[44:47]
ds_read_b64_tr_b16 a[58:59], v12 offset:1536
v_mfma_f32_16x16x32_bf16 v[48:51], a[64:67], a[20:23], v[48:51]
ds_read_b64_tr_b16 a[60:61], v13 offset:512
v_mfma_f32_16x16x32_bf16 v[80:83], a[64:67], a[24:27], v[80:83]
ds_read_b64_tr_b16 a[62:63], v13 offset:1536
v_mfma_f32_16x16x32_bf16 v[112:115], a[64:67], a[28:31], v[112:115]
v_mfma_f32_16x16x32_bf16 v[144:147], a[64:67], a[32:35], v[144:147]
ds_read_b64_tr_b16 a[64:65], v12 offset:768
s_add_u32 m0, s17, 0x8800
v_mfma_f32_16x16x32_bf16 v[148:151], a[68:71], a[32:35], v[148:151]
buffer_load_dwordx4 v6, s[56:59], 0 offen nt lds
v_mfma_f32_16x16x32_bf16 v[116:119], a[68:71], a[28:31], v[116:119]
ds_read_b64_tr_b16 a[66:67], v12 offset:1792
v_mfma_f32_16x16x32_bf16 v[84:87], a[68:71], a[24:27], v[84:87]
v_mfma_f32_16x16x32_bf16 v[52:55], a[68:71], a[20:23], v[52:55]
ds_read_b64_tr_b16 a[68:69], v13 offset:768
v_mfma_f32_16x16x32_bf16 v[152:155], a[20:23], a[72:75], v[152:155]
ds_read_b64_tr_b16 a[70:71], v13 offset:1792
v_mfma_f32_16x16x32_bf16 v[156:159], a[24:27], a[72:75], v[156:159]
s_add_u32 m0, s17, 0xc800
v_mfma_f32_16x16x32_bf16 v[216:219], a[28:31], a[72:75], v[216:219]
buffer_load_dwordx4 v6, s[60:63], 0 offen nt lds
v_mfma_f32_16x16x32_bf16 v[220:223], a[32:35], a[72:75], v[220:223]
ds_read_b64_tr_b16 a[72:73], v12 offset:16384
v_mfma_f32_16x16x32_bf16 v[228:231], a[32:35], a[76:79], v[228:231]
ds_read_b64_tr_b16 a[74:75], v12 offset:17408
v_mfma_f32_16x16x32_bf16 v[224:227], a[28:31], a[76:79], v[224:227]
v_mfma_f32_16x16x32_bf16 v[164:167], a[24:27], a[76:79], v[164:167]
v_mfma_f32_16x16x32_bf16 v[160:163], a[20:23], a[76:79], v[160:163]
ds_read_b64_tr_b16 a[76:77], v13 offset:16384
v_mfma_f32_16x16x32_bf16 v[168:171], a[20:23], a[80:83], v[168:171]
ds_read_b64_tr_b16 a[78:79], v13 offset:17408
s_add_u32 m0, s17, 0x8c00
v_mfma_f32_16x16x32_bf16 v[172:175], a[24:27], a[80:83], v[172:175]
buffer_load_dwordx4 v6, s[56:59], s13 offen nt lds
v_mfma_f32_16x16x32_bf16 v[232:235], a[28:31], a[80:83], v[232:235]
v_mfma_f32_16x16x32_bf16 v[236:239], a[32:35], a[80:83], v[236:239]
ds_read_b64_tr_b16 a[80:81], v12 offset:16640
v_mfma_f32_16x16x32_bf16 v[244:247], a[32:35], a[84:87], v[244:247]
ds_read_b64_tr_b16 a[82:83], v12 offset:17664
v_mfma_f32_16x16x32_bf16 v[240:243], a[28:31], a[84:87], v[240:243]
v_mfma_f32_16x16x32_bf16 v[180:183], a[24:27], a[84:87], v[180:183]
v_mfma_f32_16x16x32_bf16 v[176:179], a[20:23], a[84:87], v[176:179]
ds_read_b64_tr_b16 a[84:85], v13 offset:16640
s_add_u32 m0, s17, 0xcc00
v_mfma_f32_16x16x32_bf16 v[184:187], a[20:23], a[88:91], v[184:187]
buffer_load_dwordx4 v6, s[60:63], s13 offen nt lds
v_mfma_f32_16x16x32_bf16 v[188:191], a[24:27], a[88:91], v[188:191]
ds_read_b64_tr_b16 a[86:87], v13 offset:17664
v_mfma_f32_16x16x32_bf16 v[248:251], a[28:31], a[88:91], v[248:251]
v_mfma_f32_16x16x32_bf16 v[252:255], a[32:35], a[88:91], v[252:255]
ds_read_b64_tr_b16 a[88:89], v12 offset:16896
v_mfma_f32_16x16x32_bf16 a[236:239], a[32:35], a[104:107], a[236:239]
ds_read_b64_tr_b16 a[90:91], v12 offset:17920
v_mfma_f32_16x16x32_bf16 a[232:235], a[28:31], a[104:107], a[232:235]
v_mfma_f32_16x16x32_bf16 v[196:199], a[24:27], a[104:107], v[196:199]
s_mov_b32 s9, 0x0
v_mfma_f32_16x16x32_bf16 v[192:195], a[20:23], a[104:107], v[192:195]
buffer_load_dword v18, v19, s[52:55], s9 offen
v_mfma_f32_16x16x32_bf16 v[200:203], a[20:23], a[108:111], v[200:203]
v_mfma_f32_16x16x32_bf16 v[204:207], a[24:27], a[108:111], v[204:207]
v_mfma_f32_16x16x32_bf16 a[240:243], a[28:31], a[108:111], a[240:243]
v_mfma_f32_16x16x32_bf16 a[244:247], a[32:35], a[108:111], a[244:247]
v_mfma_f32_16x16x32_bf16 a[252:255], a[32:35], a[112:115], a[252:255]
v_mfma_f32_16x16x32_bf16 a[248:251], a[28:31], a[112:115], a[248:251]
v_mfma_f32_16x16x32_bf16 v[212:215], a[24:27], a[112:115], v[212:215]
v_mfma_f32_16x16x32_bf16 v[208:211], a[20:23], a[112:115], v[208:211]
s_waitcnt lgkmcnt(0)
v_mfma_f32_16x16x32_bf16 v[24:27], a[40:43], a[0:3], v[24:27]
ds_read_b128 a[20:23], v9 offset:0
v_add_u32 v5, 0x80000, v5
v_mfma_f32_16x16x32_bf16 v[56:59], a[40:43], a[4:7], v[56:59]
ds_read_b128 a[24:27], v9 offset:2048
v_add_u32 v6, 0x80000, v6
v_mfma_f32_16x16x32_bf16 v[88:91], a[40:43], a[8:11], v[88:91]
ds_read_b128 a[28:31], v9 offset:4096
v_mfma_f32_16x16x32_bf16 v[120:123], a[40:43], a[12:15], v[120:123]
ds_read_b128 a[32:35], v9 offset:6144
v_mfma_f32_16x16x32_bf16 v[124:127], a[44:47], a[12:15], v[124:127]
ds_read_b64_tr_b16 a[104:105], v13 offset:25088
v_mfma_f32_16x16x32_bf16 v[92:95], a[44:47], a[8:11], v[92:95]
ds_read_b64_tr_b16 a[106:107], v13 offset:26112
v_mfma_f32_16x16x32_bf16 v[60:63], a[44:47], a[4:7], v[60:63]
ds_read_b64_tr_b16 a[108:109], v12 offset:25344
v_mfma_f32_16x16x32_bf16 v[28:31], a[44:47], a[0:3], v[28:31]
ds_read_b64_tr_b16 a[110:111], v12 offset:26368
v_mfma_f32_16x16x32_bf16 v[32:35], a[48:51], a[0:3], v[32:35]
ds_read_b64_tr_b16 a[112:113], v13 offset:25344
s_waitcnt lgkmcnt(5)
v_mfma_f32_16x16x32_bf16 v[64:67], a[48:51], a[4:7], v[64:67]
ds_read_b64_tr_b16 a[114:115], v13 offset:26368
s_add_u32 m0, s16, 0x0
v_mfma_f32_16x16x32_bf16 v[96:99], a[48:51], a[8:11], v[96:99]
buffer_load_dwordx4 v2, s[48:51], 0 offen lds
v_mfma_f32_16x16x32_bf16 v[128:131], a[48:51], a[12:15], v[128:131]
ds_read_b64_tr_b16 a[40:41], v12 offset:8192
v_mfma_f32_16x16x32_bf16 v[132:135], a[52:55], a[12:15], v[132:135]
ds_read_b64_tr_b16 a[42:43], v12 offset:9216
v_mfma_f32_16x16x32_bf16 v[100:103], a[52:55], a[8:11], v[100:103]
ds_read_b64_tr_b16 a[44:45], v13 offset:8192
v_mfma_f32_16x16x32_bf16 v[68:71], a[52:55], a[4:7], v[68:71]
ds_read_b64_tr_b16 a[46:47], v13 offset:9216
v_mfma_f32_16x16x32_bf16 v[36:39], a[52:55], a[0:3], v[36:39]
ds_read_b64_tr_b16 a[48:49], v12 offset:8448
s_add_u32 m0, s16, 0x400
v_mfma_f32_16x16x32_bf16 v[40:43], a[56:59], a[0:3], v[40:43]
buffer_load_dwordx4 v3, s[48:51], 0 offen lds
v_mfma_f32_16x16x32_bf16 v[72:75], a[56:59], a[4:7], v[72:75]
ds_read_b64_tr_b16 a[50:51], v12 offset:9472
v_mfma_f32_16x16x32_bf16 v[104:107], a[56:59], a[8:11], v[104:107]
ds_read_b64_tr_b16 a[52:53], v13 offset:8448
v_mfma_f32_16x16x32_bf16 v[136:139], a[56:59], a[12:15], v[136:139]
ds_read_b64_tr_b16 a[54:55], v13 offset:9472
v_mfma_f32_16x16x32_bf16 v[140:143], a[60:63], a[12:15], v[140:143]
ds_read_b64_tr_b16 a[56:57], v12 offset:8704
v_mfma_f32_16x16x32_bf16 v[108:111], a[60:63], a[8:11], v[108:111]
ds_read_b64_tr_b16 a[58:59], v12 offset:9728
v_mfma_f32_16x16x32_bf16 v[76:79], a[60:63], a[4:7], v[76:79]
s_add_u32 m0, s16, 0x800
v_mfma_f32_16x16x32_bf16 v[44:47], a[60:63], a[0:3], v[44:47]
buffer_load_dwordx4 v2, s[48:51], s12 offen lds
v_mfma_f32_16x16x32_bf16 v[48:51], a[64:67], a[0:3], v[48:51]
ds_read_b64_tr_b16 a[60:61], v13 offset:8704
v_mfma_f32_16x16x32_bf16 v[80:83], a[64:67], a[4:7], v[80:83]
ds_read_b64_tr_b16 a[62:63], v13 offset:9728
v_mfma_f32_16x16x32_bf16 v[112:115], a[64:67], a[8:11], v[112:115]
v_mfma_f32_16x16x32_bf16 v[144:147], a[64:67], a[12:15], v[144:147]
ds_read_b64_tr_b16 a[64:65], v12 offset:8960
v_mfma_f32_16x16x32_bf16 v[148:151], a[68:71], a[12:15], v[148:151]
ds_read_b64_tr_b16 a[66:67], v12 offset:9984
s_add_u32 m0, s16, 0xc00
v_mfma_f32_16x16x32_bf16 v[116:119], a[68:71], a[8:11], v[116:119]
buffer_load_dwordx4 v3, s[48:51], s12 offen lds
v_mfma_f32_16x16x32_bf16 v[84:87], a[68:71], a[4:7], v[84:87]
v_mfma_f32_16x16x32_bf16 v[52:55], a[68:71], a[0:3], v[52:55]
ds_read_b64_tr_b16 a[68:69], v13 offset:8960
v_mfma_f32_16x16x32_bf16 v[152:155], a[0:3], a[72:75], v[152:155]
ds_read_b64_tr_b16 a[70:71], v13 offset:9984
v_mfma_f32_16x16x32_bf16 v[156:159], a[4:7], a[72:75], v[156:159]
v_mfma_f32_16x16x32_bf16 v[216:219], a[8:11], a[72:75], v[216:219]
v_mfma_f32_16x16x32_bf16 v[220:223], a[12:15], a[72:75], v[220:223]
ds_read_b64_tr_b16 a[72:73], v12 offset:24576
s_add_u32 m0, s16, 0x1000
v_mfma_f32_16x16x32_bf16 v[228:231], a[12:15], a[76:79], v[228:231]
buffer_load_dwordx4 v2, s[48:51], s13 offen lds
v_mfma_f32_16x16x32_bf16 v[224:227], a[8:11], a[76:79], v[224:227]
ds_read_b64_tr_b16 a[74:75], v12 offset:25600
v_mfma_f32_16x16x32_bf16 v[164:167], a[4:7], a[76:79], v[164:167]
v_mfma_f32_16x16x32_bf16 v[160:163], a[0:3], a[76:79], v[160:163]
ds_read_b64_tr_b16 a[76:77], v13 offset:24576
v_mfma_f32_16x16x32_bf16 v[168:171], a[0:3], a[80:83], v[168:171]
ds_read_b64_tr_b16 a[78:79], v13 offset:25600
v_mfma_f32_16x16x32_bf16 v[172:175], a[4:7], a[80:83], v[172:175]
s_add_u32 m0, s16, 0x1400
v_mfma_f32_16x16x32_bf16 v[232:235], a[8:11], a[80:83], v[232:235]
buffer_load_dwordx4 v3, s[48:51], s13 offen lds
v_mfma_f32_16x16x32_bf16 v[236:239], a[12:15], a[80:83], v[236:239]
ds_read_b64_tr_b16 a[80:81], v12 offset:24832
v_mfma_f32_16x16x32_bf16 v[244:247], a[12:15], a[84:87], v[244:247]
ds_read_b64_tr_b16 a[82:83], v12 offset:25856
v_mfma_f32_16x16x32_bf16 v[240:243], a[8:11], a[84:87], v[240:243]
v_mfma_f32_16x16x32_bf16 v[180:183], a[4:7], a[84:87], v[180:183]
v_mfma_f32_16x16x32_bf16 v[176:179], a[0:3], a[84:87], v[176:179]
ds_read_b64_tr_b16 a[84:85], v13 offset:24832
v_mfma_f32_16x16x32_bf16 v[184:187], a[0:3], a[88:91], v[184:187]
ds_read_b64_tr_b16 a[86:87], v13 offset:25856
s_add_u32 m0, s16, 0x1800
v_mfma_f32_16x16x32_bf16 v[188:191], a[4:7], a[88:91], v[188:191]
buffer_load_dwordx4 v2, s[48:51], s14 offen lds
v_mfma_f32_16x16x32_bf16 v[248:251], a[8:11], a[88:91], v[248:251]
v_mfma_f32_16x16x32_bf16 v[252:255], a[12:15], a[88:91], v[252:255]
ds_read_b64_tr_b16 a[88:89], v12 offset:25088
v_mfma_f32_16x16x32_bf16 a[236:239], a[12:15], a[92:95], a[236:239]
ds_read_b64_tr_b16 a[90:91], v12 offset:26112
v_add_u32 v12, 0xffff0000, v12
v_mfma_f32_16x16x32_bf16 a[232:235], a[8:11], a[92:95], a[232:235]
v_add_u32 v13, 0xffff0000, v13
v_mfma_f32_16x16x32_bf16 v[196:199], a[4:7], a[92:95], v[196:199]
s_add_u32 m0, s16, 0x1c00
v_mfma_f32_16x16x32_bf16 v[192:195], a[0:3], a[92:95], v[192:195]
buffer_load_dwordx4 v3, s[48:51], s14 offen lds
v_mfma_f32_16x16x32_bf16 v[200:203], a[0:3], a[96:99], v[200:203]
v_mfma_f32_16x16x32_bf16 v[204:207], a[4:7], a[96:99], v[204:207]
v_mfma_f32_16x16x32_bf16 a[240:243], a[8:11], a[96:99], a[240:243]
v_mfma_f32_16x16x32_bf16 a[244:247], a[12:15], a[96:99], a[244:247]
v_mfma_f32_16x16x32_bf16 a[252:255], a[12:15], a[100:103], a[252:255]
v_mfma_f32_16x16x32_bf16 a[248:251], a[8:11], a[100:103], a[248:251]
v_mfma_f32_16x16x32_bf16 v[212:215], a[4:7], a[100:103], v[212:215]
v_mfma_f32_16x16x32_bf16 v[208:211], a[0:3], a[100:103], v[208:211]
s_waitcnt vmcnt(18) lgkmcnt(0)
s_barrier
v_mfma_f32_16x16x32_bf16 v[24:27], a[40:43], a[20:23], v[24:27]
ds_read_b128 a[0:3], v8 offset:32768
s_add_u32 m0, s17, 0x10000
v_mfma_f32_16x16x32_bf16 v[56:59], a[40:43], a[24:27], v[56:59]
buffer_load_dwordx4 v5, s[56:59], 0 offen nt lds
v_mfma_f32_16x16x32_bf16 v[88:91], a[40:43], a[28:31], v[88:91]
ds_read_b128 a[4:7], v8 offset:34816
v_add_u32 v2, 0x80, v2
v_mfma_f32_16x16x32_bf16 v[120:123], a[40:43], a[32:35], v[120:123]
ds_read_b128 a[8:11], v8 offset:36864
v_add_u32 v3, 0x80, v3
v_mfma_f32_16x16x32_bf16 v[124:127], a[44:47], a[32:35], v[124:127]
ds_read_b128 a[12:15], v8 offset:38912
v_mfma_f32_16x16x32_bf16 v[92:95], a[44:47], a[28:31], v[92:95]
ds_read_b64_tr_b16 a[92:93], v13 offset:16896
v_mfma_f32_16x16x32_bf16 v[60:63], a[44:47], a[24:27], v[60:63]
ds_read_b64_tr_b16 a[94:95], v13 offset:17920
s_add_u32 m0, s17, 0x14000
v_mfma_f32_16x16x32_bf16 v[28:31], a[44:47], a[20:23], v[28:31]
buffer_load_dwordx4 v5, s[60:63], 0 offen nt lds
v_mfma_f32_16x16x32_bf16 v[32:35], a[48:51], a[20:23], v[32:35]
ds_read_b64_tr_b16 a[96:97], v12 offset:17152
v_mfma_f32_16x16x32_bf16 v[64:67], a[48:51], a[24:27], v[64:67]
ds_read_b64_tr_b16 a[98:99], v12 offset:18176
v_mfma_f32_16x16x32_bf16 v[96:99], a[48:51], a[28:31], v[96:99]
ds_read_b64_tr_b16 a[100:101], v13 offset:17152
v_mfma_f32_16x16x32_bf16 v[128:131], a[48:51], a[32:35], v[128:131]
ds_read_b64_tr_b16 a[102:103], v13 offset:18176
v_mfma_f32_16x16x32_bf16 v[132:135], a[52:55], a[32:35], v[132:135]
ds_read_b64_tr_b16 a[40:41], v12 offset:0
v_mfma_f32_16x16x32_bf16 v[100:103], a[52:55], a[28:31], v[100:103]
ds_read_b64_tr_b16 a[42:43], v12 offset:1024
s_add_u32 m0, s17, 0x10400
v_mfma_f32_16x16x32_bf16 v[68:71], a[52:55], a[24:27], v[68:71]
buffer_load_dwordx4 v5, s[56:59], s13 offen nt lds
v_mfma_f32_16x16x32_bf16 v[36:39], a[52:55], a[20:23], v[36:39]
ds_read_b64_tr_b16 a[44:45], v13 offset:0
v_mfma_f32_16x16x32_bf16 v[40:43], a[56:59], a[20:23], v[40:43]
ds_read_b64_tr_b16 a[46:47], v13 offset:1024
v_mfma_f32_16x16x32_bf16 v[72:75], a[56:59], a[24:27], v[72:75]
ds_read_b64_tr_b16 a[48:49], v12 offset:256
v_mfma_f32_16x16x32_bf16 v[104:107], a[56:59], a[28:31], v[104:107]
ds_read_b64_tr_b16 a[50:51], v12 offset:1280
v_mfma_f32_16x16x32_bf16 v[136:139], a[56:59], a[32:35], v[136:139]
ds_read_b64_tr_b16 a[52:53], v13 offset:256
v_mfma_f32_16x16x32_bf16 v[140:143], a[60:63], a[32:35], v[140:143]
ds_read_b64_tr_b16 a[54:55], v13 offset:1280
s_add_u32 m0, s17, 0x14400
v_mfma_f32_16x16x32_bf16 v[108:111], a[60:63], a[28:31], v[108:111]
buffer_load_dwordx4 v5, s[60:63], s13 offen nt lds
v_mfma_f32_16x16x32_bf16 v[76:79], a[60:63], a[24:27], v[76:79]
ds_read_b64_tr_b16 a[56:57], v12 offset:512
v_mfma_f32_16x16x32_bf16 v[44:47], a[60:63], a[20:23], v[44:47]
ds_read_b64_tr_b16 a[58:59], v12 offset:1536
v_mfma_f32_16x16x32_bf16 v[48:51], a[64:67], a[20:23], v[48:51]
ds_read_b64_tr_b16 a[60:61], v13 offset:512
v_mfma_f32_16x16x32_bf16 v[80:83], a[64:67], a[24:27], v[80:83]
ds_read_b64_tr_b16 a[62:63], v13 offset:1536
v_mfma_f32_16x16x32_bf16 v[112:115], a[64:67], a[28:31], v[112:115]
v_mfma_f32_16x16x32_bf16 v[144:147], a[64:67], a[32:35], v[144:147]
ds_read_b64_tr_b16 a[64:65], v12 offset:768
s_add_u32 m0, s17, 0x10800
v_mfma_f32_16x16x32_bf16 v[148:151], a[68:71], a[32:35], v[148:151]
buffer_load_dwordx4 v6, s[56:59], 0 offen nt lds
v_mfma_f32_16x16x32_bf16 v[116:119], a[68:71], a[28:31], v[116:119]
ds_read_b64_tr_b16 a[66:67], v12 offset:1792
v_mfma_f32_16x16x32_bf16 v[84:87], a[68:71], a[24:27], v[84:87]
v_mfma_f32_16x16x32_bf16 v[52:55], a[68:71], a[20:23], v[52:55]
ds_read_b64_tr_b16 a[68:69], v13 offset:768
v_mfma_f32_16x16x32_bf16 v[152:155], a[20:23], a[72:75], v[152:155]
ds_read_b64_tr_b16 a[70:71], v13 offset:1792
v_mfma_f32_16x16x32_bf16 v[156:159], a[24:27], a[72:75], v[156:159]
s_add_u32 m0, s17, 0x14800
v_mfma_f32_16x16x32_bf16 v[216:219], a[28:31], a[72:75], v[216:219]
buffer_load_dwordx4 v6, s[60:63], 0 offen nt lds
v_mfma_f32_16x16x32_bf16 v[220:223], a[32:35], a[72:75], v[220:223]
ds_read_b64_tr_b16 a[72:73], v12 offset:16384
v_mfma_f32_16x16x32_bf16 v[228:231], a[32:35], a[76:79], v[228:231]
ds_read_b64_tr_b16 a[74:75], v12 offset:17408
v_mfma_f32_16x16x32_bf16 v[224:227], a[28:31], a[76:79], v[224:227]
v_mfma_f32_16x16x32_bf16 v[164:167], a[24:27], a[76:79], v[164:167]
v_mfma_f32_16x16x32_bf16 v[160:163], a[20:23], a[76:79], v[160:163]
ds_read_b64_tr_b16 a[76:77], v13 offset:16384
v_mfma_f32_16x16x32_bf16 v[168:171], a[20:23], a[80:83], v[168:171]
ds_read_b64_tr_b16 a[78:79], v13 offset:17408
s_add_u32 m0, s17, 0x10c00
v_mfma_f32_16x16x32_bf16 v[172:175], a[24:27], a[80:83], v[172:175]
buffer_load_dwordx4 v6, s[56:59], s13 offen nt lds
v_mfma_f32_16x16x32_bf16 v[232:235], a[28:31], a[80:83], v[232:235]
v_mfma_f32_16x16x32_bf16 v[236:239], a[32:35], a[80:83], v[236:239]
ds_read_b64_tr_b16 a[80:81], v12 offset:16640
v_mfma_f32_16x16x32_bf16 v[244:247], a[32:35], a[84:87], v[244:247]
ds_read_b64_tr_b16 a[82:83], v12 offset:17664
v_mfma_f32_16x16x32_bf16 v[240:243], a[28:31], a[84:87], v[240:243]
v_mfma_f32_16x16x32_bf16 v[180:183], a[24:27], a[84:87], v[180:183]
v_mfma_f32_16x16x32_bf16 v[176:179], a[20:23], a[84:87], v[176:179]
ds_read_b64_tr_b16 a[84:85], v13 offset:16640
s_add_u32 m0, s17, 0x14c00
v_mfma_f32_16x16x32_bf16 v[184:187], a[20:23], a[88:91], v[184:187]
buffer_load_dwordx4 v6, s[60:63], s13 offen nt lds
v_mfma_f32_16x16x32_bf16 v[188:191], a[24:27], a[88:91], v[188:191]
ds_read_b64_tr_b16 a[86:87], v13 offset:17664
v_mfma_f32_16x16x32_bf16 v[248:251], a[28:31], a[88:91], v[248:251]
v_mfma_f32_16x16x32_bf16 v[252:255], a[32:35], a[88:91], v[252:255]
ds_read_b64_tr_b16 a[88:89], v12 offset:16896
v_mfma_f32_16x16x32_bf16 a[236:239], a[32:35], a[104:107], a[236:239]
ds_read_b64_tr_b16 a[90:91], v12 offset:17920
v_mfma_f32_16x16x32_bf16 a[232:235], a[28:31], a[104:107], a[232:235]
v_mfma_f32_16x16x32_bf16 v[196:199], a[24:27], a[104:107], v[196:199]
s_mov_b32 s9, 0x0
v_mfma_f32_16x16x32_bf16 v[192:195], a[20:23], a[104:107], v[192:195]
buffer_load_dword v18, v19, s[68:71], s9 offen
v_mfma_f32_16x16x32_bf16 v[200:203], a[20:23], a[108:111], v[200:203]
v_mfma_f32_16x16x32_bf16 v[204:207], a[24:27], a[108:111], v[204:207]
v_mfma_f32_16x16x32_bf16 a[240:243], a[28:31], a[108:111], a[240:243]
v_mfma_f32_16x16x32_bf16 a[244:247], a[32:35], a[108:111], a[244:247]
v_mfma_f32_16x16x32_bf16 a[252:255], a[32:35], a[112:115], a[252:255]
v_mfma_f32_16x16x32_bf16 a[248:251], a[28:31], a[112:115], a[248:251]
v_mfma_f32_16x16x32_bf16 v[212:215], a[24:27], a[112:115], v[212:215]
v_mfma_f32_16x16x32_bf16 v[208:211], a[20:23], a[112:115], v[208:211]
s_waitcnt lgkmcnt(0)
v_mfma_f32_16x16x32_bf16 v[24:27], a[40:43], a[0:3], v[24:27]
ds_read_b128 a[20:23], v9 offset:32768
v_add_u32 v5, 0x80000, v5
v_mfma_f32_16x16x32_bf16 v[56:59], a[40:43], a[4:7], v[56:59]
ds_read_b128 a[24:27], v9 offset:34816
v_add_u32 v6, 0x80000, v6
v_mfma_f32_16x16x32_bf16 v[88:91], a[40:43], a[8:11], v[88:91]
ds_read_b128 a[28:31], v9 offset:36864
v_mfma_f32_16x16x32_bf16 v[120:123], a[40:43], a[12:15], v[120:123]
ds_read_b128 a[32:35], v9 offset:38912
v_mfma_f32_16x16x32_bf16 v[124:127], a[44:47], a[12:15], v[124:127]
ds_read_b64_tr_b16 a[104:105], v13 offset:25088
v_mfma_f32_16x16x32_bf16 v[92:95], a[44:47], a[8:11], v[92:95]
ds_read_b64_tr_b16 a[106:107], v13 offset:26112
v_mfma_f32_16x16x32_bf16 v[60:63], a[44:47], a[4:7], v[60:63]
ds_read_b64_tr_b16 a[108:109], v12 offset:25344
v_mfma_f32_16x16x32_bf16 v[28:31], a[44:47], a[0:3], v[28:31]
ds_read_b64_tr_b16 a[110:111], v12 offset:26368
v_mfma_f32_16x16x32_bf16 v[32:35], a[48:51], a[0:3], v[32:35]
ds_read_b64_tr_b16 a[112:113], v13 offset:25344
s_waitcnt lgkmcnt(5)
v_mfma_f32_16x16x32_bf16 v[64:67], a[48:51], a[4:7], v[64:67]
ds_read_b64_tr_b16 a[114:115], v13 offset:26368
s_add_u32 m0, s16, 0x8000
v_mfma_f32_16x16x32_bf16 v[96:99], a[48:51], a[8:11], v[96:99]
buffer_load_dwordx4 v2, s[48:51], 0 offen lds
v_mfma_f32_16x16x32_bf16 v[128:131], a[48:51], a[12:15], v[128:131]
ds_read_b64_tr_b16 a[40:41], v12 offset:8192
v_mfma_f32_16x16x32_bf16 v[132:135], a[52:55], a[12:15], v[132:135]
ds_read_b64_tr_b16 a[42:43], v12 offset:9216
v_mfma_f32_16x16x32_bf16 v[100:103], a[52:55], a[8:11], v[100:103]
ds_read_b64_tr_b16 a[44:45], v13 offset:8192
v_mfma_f32_16x16x32_bf16 v[68:71], a[52:55], a[4:7], v[68:71]
ds_read_b64_tr_b16 a[46:47], v13 offset:9216
s_add_u32 m0, s16, 0x8400
v_mfma_f32_16x16x32_bf16 v[36:39], a[52:55], a[0:3], v[36:39]
buffer_load_dwordx4 v3, s[48:51], 0 offen lds
v_mfma_f32_16x16x32_bf16 v[40:43], a[56:59], a[0:3], v[40:43]
ds_read_b64_tr_b16 a[48:49], v12 offset:8448
v_mfma_f32_16x16x32_bf16 v[72:75], a[56:59], a[4:7], v[72:75]
ds_read_b64_tr_b16 a[50:51], v12 offset:9472
v_mfma_f32_16x16x32_bf16 v[104:107], a[56:59], a[8:11], v[104:107]
ds_read_b64_tr_b16 a[52:53], v13 offset:8448
v_mfma_f32_16x16x32_bf16 v[136:139], a[56:59], a[12:15], v[136:139]
ds_read_b64_tr_b16 a[54:55], v13 offset:9472
v_mfma_f32_16x16x32_bf16 v[140:143], a[60:63], a[12:15], v[140:143]
ds_read_b64_tr_b16 a[56:57], v12 offset:8704
s_add_u32 m0, s16, 0x8800
v_mfma_f32_16x16x32_bf16 v[108:111], a[60:63], a[8:11], v[108:111]
buffer_load_dwordx4 v2, s[48:51], s12 offen lds
v_mfma_f32_16x16x32_bf16 v[76:79], a[60:63], a[4:7], v[76:79]
ds_read_b64_tr_b16 a[58:59], v12 offset:9728
v_mfma_f32_16x16x32_bf16 v[44:47], a[60:63], a[0:3], v[44:47]
ds_read_b64_tr_b16 a[60:61], v13 offset:8704
v_mfma_f32_16x16x32_bf16 v[48:51], a[64:67], a[0:3], v[48:51]
ds_read_b64_tr_b16 a[62:63], v13 offset:9728
v_mfma_f32_16x16x32_bf16 v[80:83], a[64:67], a[4:7], v[80:83]
v_mfma_f32_16x16x32_bf16 v[112:115], a[64:67], a[8:11], v[112:115]
s_add_u32 m0, s16, 0x8c00
v_mfma_f32_16x16x32_bf16 v[144:147], a[64:67], a[12:15], v[144:147]
buffer_load_dwordx4 v3, s[48:51], s12 offen lds
v_mfma_f32_16x16x32_bf16 v[148:151], a[68:71], a[12:15], v[148:151]
ds_read_b64_tr_b16 a[64:65], v12 offset:8960
v_mfma_f32_16x16x32_bf16 v[116:119], a[68:71], a[8:11], v[116:119]
ds_read_b64_tr_b16 a[66:67], v12 offset:9984
v_mfma_f32_16x16x32_bf16 v[84:87], a[68:71], a[4:7], v[84:87]
v_mfma_f32_16x16x32_bf16 v[52:55], a[68:71], a[0:3], v[52:55]
ds_read_b64_tr_b16 a[68:69], v13 offset:8960
v_mfma_f32_16x16x32_bf16 v[152:155], a[0:3], a[72:75], v[152:155]
ds_read_b64_tr_b16 a[70:71], v13 offset:9984
s_add_u32 m0, s16, 0x9000
v_mfma_f32_16x16x32_bf16 v[156:159], a[4:7], a[72:75], v[156:159]
buffer_load_dwordx4 v2, s[48:51], s13 offen lds
v_mfma_f32_16x16x32_bf16 v[216:219], a[8:11], a[72:75], v[216:219]
v_mfma_f32_16x16x32_bf16 v[220:223], a[12:15], a[72:75], v[220:223]
ds_read_b64_tr_b16 a[72:73], v12 offset:24576
v_mfma_f32_16x16x32_bf16 v[228:231], a[12:15], a[76:79], v[228:231]
ds_read_b64_tr_b16 a[74:75], v12 offset:25600
v_mfma_f32_16x16x32_bf16 v[224:227], a[8:11], a[76:79], v[224:227]
s_add_u32 m0, s16, 0x9400
v_mfma_f32_16x16x32_bf16 v[164:167], a[4:7], a[76:79], v[164:167]
buffer_load_dwordx4 v3, s[48:51], s13 offen lds
v_mfma_f32_16x16x32_bf16 v[160:163], a[0:3], a[76:79], v[160:163]
ds_read_b64_tr_b16 a[76:77], v13 offset:24576
v_mfma_f32_16x16x32_bf16 v[168:171], a[0:3], a[80:83], v[168:171]
ds_read_b64_tr_b16 a[78:79], v13 offset:25600
v_mfma_f32_16x16x32_bf16 v[172:175], a[4:7], a[80:83], v[172:175]
v_mfma_f32_16x16x32_bf16 v[232:235], a[8:11], a[80:83], v[232:235]
v_mfma_f32_16x16x32_bf16 v[236:239], a[12:15], a[80:83], v[236:239]
ds_read_b64_tr_b16 a[80:81], v12 offset:24832
s_add_u32 m0, s16, 0x9800
v_mfma_f32_16x16x32_bf16 v[244:247], a[12:15], a[84:87], v[244:247]
buffer_load_dwordx4 v2, s[48:51], s14 offen lds
v_mfma_f32_16x16x32_bf16 v[240:243], a[8:11], a[84:87], v[240:243]
ds_read_b64_tr_b16 a[82:83], v12 offset:25856
v_mfma_f32_16x16x32_bf16 v[180:183], a[4:7], a[84:87], v[180:183]
v_mfma_f32_16x16x32_bf16 v[176:179], a[0:3], a[84:87], v[176:179]
ds_read_b64_tr_b16 a[84:85], v13 offset:24832
v_mfma_f32_16x16x32_bf16 v[184:187], a[0:3], a[88:91], v[184:187]
ds_read_b64_tr_b16 a[86:87], v13 offset:25856
v_mfma_f32_16x16x32_bf16 v[188:191], a[4:7], a[88:91], v[188:191]
s_add_u32 m0, s16, 0x9c00
v_mfma_f32_16x16x32_bf16 v[248:251], a[8:11], a[88:91], v[248:251]
buffer_load_dwordx4 v3, s[48:51], s14 offen lds
v_mfma_f32_16x16x32_bf16 v[252:255], a[12:15], a[88:91], v[252:255]
ds_read_b64_tr_b16 a[88:89], v12 offset:25088
v_mfma_f32_16x16x32_bf16 a[236:239], a[12:15], a[92:95], a[236:239]
ds_read_b64_tr_b16 a[90:91], v12 offset:26112
v_add_u32 v12, 0x8000, v12
v_mfma_f32_16x16x32_bf16 a[232:235], a[8:11], a[92:95], a[232:235]
v_add_u32 v13, 0x8000, v13
v_mfma_f32_16x16x32_bf16 v[196:199], a[4:7], a[92:95], v[196:199]
v_mfma_f32_16x16x32_bf16 v[192:195], a[0:3], a[92:95], v[192:195]
s_mov_b32 s9, 0x200000
v_mfma_f32_16x16x32_bf16 v[200:203], a[0:3], a[96:99], v[200:203]
buffer_load_dword v18, v19, s[52:55], s9 offen
v_mfma_f32_16x16x32_bf16 v[204:207], a[4:7], a[96:99], v[204:207]
v_mfma_f32_16x16x32_bf16 a[240:243], a[8:11], a[96:99], a[240:243]
v_mfma_f32_16x16x32_bf16 a[244:247], a[12:15], a[96:99], a[244:247]
v_mfma_f32_16x16x32_bf16 a[252:255], a[12:15], a[100:103], a[252:255]
v_mfma_f32_16x16x32_bf16 a[248:251], a[8:11], a[100:103], a[248:251]
v_mfma_f32_16x16x32_bf16 v[212:215], a[4:7], a[100:103], v[212:215]
v_mfma_f32_16x16x32_bf16 v[208:211], a[0:3], a[100:103], v[208:211]
s_waitcnt vmcnt(18) lgkmcnt(0)
s_barrier
v_mfma_f32_16x16x32_bf16 v[24:27], a[40:43], a[20:23], v[24:27]
ds_read_b128 a[0:3], v8 offset:0
s_add_u32 m0, s17, 0x0
v_mfma_f32_16x16x32_bf16 v[56:59], a[40:43], a[24:27], v[56:59]
buffer_load_dwordx4 v5, s[56:59], 0 offen nt lds
v_mfma_f32_16x16x32_bf16 v[88:91], a[40:43], a[28:31], v[88:91]
ds_read_b128 a[4:7], v8 offset:2048
v_add_u32 v2, 0x80, v2
v_mfma_f32_16x16x32_bf16 v[120:123], a[40:43], a[32:35], v[120:123]
ds_read_b128 a[8:11], v8 offset:4096
v_add_u32 v3, 0x80, v3
v_mfma_f32_16x16x32_bf16 v[124:127], a[44:47], a[32:35], v[124:127]
ds_read_b128 a[12:15], v8 offset:6144
v_mfma_f32_16x16x32_bf16 v[92:95], a[44:47], a[28:31], v[92:95]
ds_read_b64_tr_b16 a[92:93], v13 offset:16896
v_mfma_f32_16x16x32_bf16 v[60:63], a[44:47], a[24:27], v[60:63]
ds_read_b64_tr_b16 a[94:95], v13 offset:17920
s_add_u32 m0, s17, 0x4000
v_mfma_f32_16x16x32_bf16 v[28:31], a[44:47], a[20:23], v[28:31]
buffer_load_dwordx4 v5, s[60:63], 0 offen nt lds
v_mfma_f32_16x16x32_bf16 v[32:35], a[48:51], a[20:23], v[32:35]
ds_read_b64_tr_b16 a[96:97], v12 offset:17152
v_mfma_f32_16x16x32_bf16 v[64:67], a[48:51], a[24:27], v[64:67]
ds_read_b64_tr_b16 a[98:99], v12 offset:18176
v_mfma_f32_16x16x32_bf16 v[96:99], a[48:51], a[28:31], v[96:99]
ds_read_b64_tr_b16 a[100:101], v13 offset:17152
v_mfma_f32_16x16x32_bf16 v[128:131], a[48:51], a[32:35], v[128:131]
ds_read_b64_tr_b16 a[102:103], v13 offset:18176
v_mfma_f32_16x16x32_bf16 v[132:135], a[52:55], a[32:35], v[132:135]
ds_read_b64_tr_b16 a[40:41], v12 offset:0
v_mfma_f32_16x16x32_bf16 v[100:103], a[52:55], a[28:31], v[100:103]
ds_read_b64_tr_b16 a[42:43], v12 offset:1024
s_add_u32 m0, s17, 0x400
v_mfma_f32_16x16x32_bf16 v[68:71], a[52:55], a[24:27], v[68:71]
buffer_load_dwordx4 v5, s[56:59], s13 offen nt lds
v_mfma_f32_16x16x32_bf16 v[36:39], a[52:55], a[20:23], v[36:39]
ds_read_b64_tr_b16 a[44:45], v13 offset:0
v_mfma_f32_16x16x32_bf16 v[40:43], a[56:59], a[20:23], v[40:43]
ds_read_b64_tr_b16 a[46:47], v13 offset:1024
v_mfma_f32_16x16x32_bf16 v[72:75], a[56:59], a[24:27], v[72:75]
ds_read_b64_tr_b16 a[48:49], v12 offset:256
v_mfma_f32_16x16x32_bf16 v[104:107], a[56:59], a[28:31], v[104:107]
ds_read_b64_tr_b16 a[50:51], v12 offset:1280
v_mfma_f32_16x16x32_bf16 v[136:139], a[56:59], a[32:35], v[136:139]
ds_read_b64_tr_b16 a[52:53], v13 offset:256
v_mfma_f32_16x16x32_bf16 v[140:143], a[60:63], a[32:35], v[140:143]
ds_read_b64_tr_b16 a[54:55], v13 offset:1280
s_add_u32 m0, s17, 0x4400
v_mfma_f32_16x16x32_bf16 v[108:111], a[60:63], a[28:31], v[108:111]
buffer_load_dwordx4 v5, s[60:63], s13 offen nt lds
v_mfma_f32_16x16x32_bf16 v[76:79], a[60:63], a[24:27], v[76:79]
ds_read_b64_tr_b16 a[56:57], v12 offset:512
v_mfma_f32_16x16x32_bf16 v[44:47], a[60:63], a[20:23], v[44:47]
ds_read_b64_tr_b16 a[58:59], v12 offset:1536
v_mfma_f32_16x16x32_bf16 v[48:51], a[64:67], a[20:23], v[48:51]
ds_read_b64_tr_b16 a[60:61], v13 offset:512
v_mfma_f32_16x16x32_bf16 v[80:83], a[64:67], a[24:27], v[80:83]
ds_read_b64_tr_b16 a[62:63], v13 offset:1536
v_mfma_f32_16x16x32_bf16 v[112:115], a[64:67], a[28:31], v[112:115]
v_mfma_f32_16x16x32_bf16 v[144:147], a[64:67], a[32:35], v[144:147]
ds_read_b64_tr_b16 a[64:65], v12 offset:768
s_add_u32 m0, s17, 0x800
v_mfma_f32_16x16x32_bf16 v[148:151], a[68:71], a[32:35], v[148:151]
buffer_load_dwordx4 v6, s[56:59], 0 offen nt lds
v_mfma_f32_16x16x32_bf16 v[116:119], a[68:71], a[28:31], v[116:119]
ds_read_b64_tr_b16 a[66:67], v12 offset:1792
v_mfma_f32_16x16x32_bf16 v[84:87], a[68:71], a[24:27], v[84:87]
v_mfma_f32_16x16x32_bf16 v[52:55], a[68:71], a[20:23], v[52:55]
ds_read_b64_tr_b16 a[68:69], v13 offset:768
v_mfma_f32_16x16x32_bf16 v[152:155], a[20:23], a[72:75], v[152:155]
ds_read_b64_tr_b16 a[70:71], v13 offset:1792
v_mfma_f32_16x16x32_bf16 v[156:159], a[24:27], a[72:75], v[156:159]
s_add_u32 m0, s17, 0x4800
v_mfma_f32_16x16x32_bf16 v[216:219], a[28:31], a[72:75], v[216:219]
buffer_load_dwordx4 v6, s[60:63], 0 offen nt lds
v_mfma_f32_16x16x32_bf16 v[220:223], a[32:35], a[72:75], v[220:223]
ds_read_b64_tr_b16 a[72:73], v12 offset:16384
v_mfma_f32_16x16x32_bf16 v[228:231], a[32:35], a[76:79], v[228:231]
ds_read_b64_tr_b16 a[74:75], v12 offset:17408
v_mfma_f32_16x16x32_bf16 v[224:227], a[28:31], a[76:79], v[224:227]
v_mfma_f32_16x16x32_bf16 v[164:167], a[24:27], a[76:79], v[164:167]
v_mfma_f32_16x16x32_bf16 v[160:163], a[20:23], a[76:79], v[160:163]
ds_read_b64_tr_b16 a[76:77], v13 offset:16384
v_mfma_f32_16x16x32_bf16 v[168:171], a[20:23], a[80:83], v[168:171]
ds_read_b64_tr_b16 a[78:79], v13 offset:17408
s_add_u32 m0, s17, 0xc00
v_mfma_f32_16x16x32_bf16 v[172:175], a[24:27], a[80:83], v[172:175]
buffer_load_dwordx4 v6, s[56:59], s13 offen nt lds
v_mfma_f32_16x16x32_bf16 v[232:235], a[28:31], a[80:83], v[232:235]
v_mfma_f32_16x16x32_bf16 v[236:239], a[32:35], a[80:83], v[236:239]
ds_read_b64_tr_b16 a[80:81], v12 offset:16640
v_mfma_f32_16x16x32_bf16 v[244:247], a[32:35], a[84:87], v[244:247]
ds_read_b64_tr_b16 a[82:83], v12 offset:17664
v_mfma_f32_16x16x32_bf16 v[240:243], a[28:31], a[84:87], v[240:243]
v_mfma_f32_16x16x32_bf16 v[180:183], a[24:27], a[84:87], v[180:183]
v_mfma_f32_16x16x32_bf16 v[176:179], a[20:23], a[84:87], v[176:179]
ds_read_b64_tr_b16 a[84:85], v13 offset:16640
s_add_u32 m0, s17, 0x4c00
v_mfma_f32_16x16x32_bf16 v[184:187], a[20:23], a[88:91], v[184:187]
buffer_load_dwordx4 v6, s[60:63], s13 offen nt lds
v_mfma_f32_16x16x32_bf16 v[188:191], a[24:27], a[88:91], v[188:191]
ds_read_b64_tr_b16 a[86:87], v13 offset:17664
v_mfma_f32_16x16x32_bf16 v[248:251], a[28:31], a[88:91], v[248:251]
v_mfma_f32_16x16x32_bf16 v[252:255], a[32:35], a[88:91], v[252:255]
ds_read_b64_tr_b16 a[88:89], v12 offset:16896
v_mfma_f32_16x16x32_bf16 a[236:239], a[32:35], a[104:107], a[236:239]
ds_read_b64_tr_b16 a[90:91], v12 offset:17920
v_mfma_f32_16x16x32_bf16 a[232:235], a[28:31], a[104:107], a[232:235]
v_mfma_f32_16x16x32_bf16 v[196:199], a[24:27], a[104:107], v[196:199]
s_mov_b32 s9, 0x200000
v_mfma_f32_16x16x32_bf16 v[192:195], a[20:23], a[104:107], v[192:195]
buffer_load_dword v18, v19, s[68:71], s9 offen
v_mfma_f32_16x16x32_bf16 v[200:203], a[20:23], a[108:111], v[200:203]
v_mfma_f32_16x16x32_bf16 v[204:207], a[24:27], a[108:111], v[204:207]
v_mfma_f32_16x16x32_bf16 a[240:243], a[28:31], a[108:111], a[240:243]
v_mfma_f32_16x16x32_bf16 a[244:247], a[32:35], a[108:111], a[244:247]
v_mfma_f32_16x16x32_bf16 a[252:255], a[32:35], a[112:115], a[252:255]
v_mfma_f32_16x16x32_bf16 a[248:251], a[28:31], a[112:115], a[248:251]
v_mfma_f32_16x16x32_bf16 v[212:215], a[24:27], a[112:115], v[212:215]
v_mfma_f32_16x16x32_bf16 v[208:211], a[20:23], a[112:115], v[208:211]
s_waitcnt lgkmcnt(0)
v_mfma_f32_16x16x32_bf16 v[24:27], a[40:43], a[0:3], v[24:27]
ds_read_b128 a[20:23], v9 offset:0
v_add_u32 v5, 0x80000, v5
v_mfma_f32_16x16x32_bf16 v[56:59], a[40:43], a[4:7], v[56:59]
ds_read_b128 a[24:27], v9 offset:2048
v_add_u32 v6, 0x80000, v6
v_mfma_f32_16x16x32_bf16 v[88:91], a[40:43], a[8:11], v[88:91]
ds_read_b128 a[28:31], v9 offset:4096
v_mfma_f32_16x16x32_bf16 v[120:123], a[40:43], a[12:15], v[120:123]
ds_read_b128 a[32:35], v9 offset:6144
v_mfma_f32_16x16x32_bf16 v[124:127], a[44:47], a[12:15], v[124:127]
ds_read_b64_tr_b16 a[104:105], v13 offset:25088
v_mfma_f32_16x16x32_bf16 v[92:95], a[44:47], a[8:11], v[92:95]
ds_read_b64_tr_b16 a[106:107], v13 offset:26112
v_mfma_f32_16x16x32_bf16 v[60:63], a[44:47], a[4:7], v[60:63]
ds_read_b64_tr_b16 a[108:109], v12 offset:25344
v_mfma_f32_16x16x32_bf16 v[28:31], a[44:47], a[0:3], v[28:31]
ds_read_b64_tr_b16 a[110:111], v12 offset:26368
v_mfma_f32_16x16x32_bf16 v[32:35], a[48:51], a[0:3], v[32:35]
ds_read_b64_tr_b16 a[112:113], v13 offset:25344
s_waitcnt lgkmcnt(5)
v_mfma_f32_16x16x32_bf16 v[64:67], a[48:51], a[4:7], v[64:67]
ds_read_b64_tr_b16 a[114:115], v13 offset:26368
s_add_u32 m0, s16, 0x0
v_mfma_f32_16x16x32_bf16 v[96:99], a[48:51], a[8:11], v[96:99]
buffer_load_dwordx4 v2, s[48:51], 0 offen lds
v_mfma_f32_16x16x32_bf16 v[128:131], a[48:51], a[12:15], v[128:131]
ds_read_b64_tr_b16 a[40:41], v12 offset:8192
v_mfma_f32_16x16x32_bf16 v[132:135], a[52:55], a[12:15], v[132:135]
ds_read_b64_tr_b16 a[42:43], v12 offset:9216
v_mfma_f32_16x16x32_bf16 v[100:103], a[52:55], a[8:11], v[100:103]
ds_read_b64_tr_b16 a[44:45], v13 offset:8192
v_mfma_f32_16x16x32_bf16 v[68:71], a[52:55], a[4:7], v[68:71]
ds_read_b64_tr_b16 a[46:47], v13 offset:9216
v_mfma_f32_16x16x32_bf16 v[36:39], a[52:55], a[0:3], v[36:39]
ds_read_b64_tr_b16 a[48:49], v12 offset:8448
s_add_u32 m0, s16, 0x400
v_mfma_f32_16x16x32_bf16 v[40:43], a[56:59], a[0:3], v[40:43]
buffer_load_dwordx4 v3, s[48:51], 0 offen lds
v_mfma_f32_16x16x32_bf16 v[72:75], a[56:59], a[4:7], v[72:75]
ds_read_b64_tr_b16 a[50:51], v12 offset:9472
v_mfma_f32_16x16x32_bf16 v[104:107], a[56:59], a[8:11], v[104:107]
ds_read_b64_tr_b16 a[52:53], v13 offset:8448
v_mfma_f32_16x16x32_bf16 v[136:139], a[56:59], a[12:15], v[136:139]
ds_read_b64_tr_b16 a[54:55], v13 offset:9472
v_mfma_f32_16x16x32_bf16 v[140:143], a[60:63], a[12:15], v[140:143]
ds_read_b64_tr_b16 a[56:57], v12 offset:8704
v_mfma_f32_16x16x32_bf16 v[108:111], a[60:63], a[8:11], v[108:111]
ds_read_b64_tr_b16 a[58:59], v12 offset:9728
v_mfma_f32_16x16x32_bf16 v[76:79], a[60:63], a[4:7], v[76:79]
s_add_u32 m0, s16, 0x800
v_mfma_f32_16x16x32_bf16 v[44:47], a[60:63], a[0:3], v[44:47]
buffer_load_dwordx4 v2, s[48:51], s12 offen lds
v_mfma_f32_16x16x32_bf16 v[48:51], a[64:67], a[0:3], v[48:51]
ds_read_b64_tr_b16 a[60:61], v13 offset:8704
v_mfma_f32_16x16x32_bf16 v[80:83], a[64:67], a[4:7], v[80:83]
ds_read_b64_tr_b16 a[62:63], v13 offset:9728
v_mfma_f32_16x16x32_bf16 v[112:115], a[64:67], a[8:11], v[112:115]
v_mfma_f32_16x16x32_bf16 v[144:147], a[64:67], a[12:15], v[144:147]
ds_read_b64_tr_b16 a[64:65], v12 offset:8960
v_mfma_f32_16x16x32_bf16 v[148:151], a[68:71], a[12:15], v[148:151]
ds_read_b64_tr_b16 a[66:67], v12 offset:9984
s_add_u32 m0, s16, 0xc00
v_mfma_f32_16x16x32_bf16 v[116:119], a[68:71], a[8:11], v[116:119]
buffer_load_dwordx4 v3, s[48:51], s12 offen lds
v_mfma_f32_16x16x32_bf16 v[84:87], a[68:71], a[4:7], v[84:87]
v_mfma_f32_16x16x32_bf16 v[52:55], a[68:71], a[0:3], v[52:55]
ds_read_b64_tr_b16 a[68:69], v13 offset:8960
v_mfma_f32_16x16x32_bf16 v[152:155], a[0:3], a[72:75], v[152:155]
ds_read_b64_tr_b16 a[70:71], v13 offset:9984
v_mfma_f32_16x16x32_bf16 v[156:159], a[4:7], a[72:75], v[156:159]
v_mfma_f32_16x16x32_bf16 v[216:219], a[8:11], a[72:75], v[216:219]
v_mfma_f32_16x16x32_bf16 v[220:223], a[12:15], a[72:75], v[220:223]
ds_read_b64_tr_b16 a[72:73], v12 offset:24576
s_add_u32 m0, s16, 0x1000
v_mfma_f32_16x16x32_bf16 v[228:231], a[12:15], a[76:79], v[228:231]
buffer_load_dwordx4 v2, s[48:51], s13 offen lds
v_mfma_f32_16x16x32_bf16 v[224:227], a[8:11], a[76:79], v[224:227]
ds_read_b64_tr_b16 a[74:75], v12 offset:25600
v_mfma_f32_16x16x32_bf16 v[164:167], a[4:7], a[76:79], v[164:167]
v_mfma_f32_16x16x32_bf16 v[160:163], a[0:3], a[76:79], v[160:163]
ds_read_b64_tr_b16 a[76:77], v13 offset:24576
v_mfma_f32_16x16x32_bf16 v[168:171], a[0:3], a[80:83], v[168:171]
ds_read_b64_tr_b16 a[78:79], v13 offset:25600
v_mfma_f32_16x16x32_bf16 v[172:175], a[4:7], a[80:83], v[172:175]
s_add_u32 m0, s16, 0x1400
v_mfma_f32_16x16x32_bf16 v[232:235], a[8:11], a[80:83], v[232:235]
buffer_load_dwordx4 v3, s[48:51], s13 offen lds
v_mfma_f32_16x16x32_bf16 v[236:239], a[12:15], a[80:83], v[236:239]
ds_read_b64_tr_b16 a[80:81], v12 offset:24832
v_mfma_f32_16x16x32_bf16 v[244:247], a[12:15], a[84:87], v[244:247]
ds_read_b64_tr_b16 a[82:83], v12 offset:25856
v_mfma_f32_16x16x32_bf16 v[240:243], a[8:11], a[84:87], v[240:243]
v_mfma_f32_16x16x32_bf16 v[180:183], a[4:7], a[84:87], v[180:183]
v_mfma_f32_16x16x32_bf16 v[176:179], a[0:3], a[84:87], v[176:179]
ds_read_b64_tr_b16 a[84:85], v13 offset:24832
v_mfma_f32_16x16x32_bf16 v[184:187], a[0:3], a[88:91], v[184:187]
ds_read_b64_tr_b16 a[86:87], v13 offset:25856
s_add_u32 m0, s16, 0x1800
v_mfma_f32_16x16x32_bf16 v[188:191], a[4:7], a[88:91], v[188:191]
buffer_load_dwordx4 v2, s[48:51], s14 offen lds
v_mfma_f32_16x16x32_bf16 v[248:251], a[8:11], a[88:91], v[248:251]
v_mfma_f32_16x16x32_bf16 v[252:255], a[12:15], a[88:91], v[252:255]
ds_read_b64_tr_b16 a[88:89], v12 offset:25088
v_mfma_f32_16x16x32_bf16 a[236:239], a[12:15], a[92:95], a[236:239]
ds_read_b64_tr_b16 a[90:91], v12 offset:26112
v_add_u32 v12, 0x8000, v12
v_mfma_f32_16x16x32_bf16 a[232:235], a[8:11], a[92:95], a[232:235]
v_add_u32 v13, 0x8000, v13
v_mfma_f32_16x16x32_bf16 v[196:199], a[4:7], a[92:95], v[196:199]
s_add_u32 m0, s16, 0x1c00
v_mfma_f32_16x16x32_bf16 v[192:195], a[0:3], a[92:95], v[192:195]
buffer_load_dwordx4 v3, s[48:51], s14 offen lds
v_mfma_f32_16x16x32_bf16 v[200:203], a[0:3], a[96:99], v[200:203]
v_mfma_f32_16x16x32_bf16 v[204:207], a[4:7], a[96:99], v[204:207]
v_mfma_f32_16x16x32_bf16 a[240:243], a[8:11], a[96:99], a[240:243]
v_mfma_f32_16x16x32_bf16 a[244:247], a[12:15], a[96:99], a[244:247]
v_mfma_f32_16x16x32_bf16 a[252:255], a[12:15], a[100:103], a[252:255]
v_mfma_f32_16x16x32_bf16 a[248:251], a[8:11], a[100:103], a[248:251]
v_mfma_f32_16x16x32_bf16 v[212:215], a[4:7], a[100:103], v[212:215]
v_mfma_f32_16x16x32_bf16 v[208:211], a[0:3], a[100:103], v[208:211]
s_waitcnt vmcnt(18) lgkmcnt(0)
s_barrier
v_mfma_f32_16x16x32_bf16 v[24:27], a[40:43], a[20:23], v[24:27]
ds_read_b128 a[0:3], v8 offset:32768
s_add_u32 m0, s17, 0x8000
v_mfma_f32_16x16x32_bf16 v[56:59], a[40:43], a[24:27], v[56:59]
buffer_load_dwordx4 v5, s[56:59], 0 offen nt lds
v_mfma_f32_16x16x32_bf16 v[88:91], a[40:43], a[28:31], v[88:91]
ds_read_b128 a[4:7], v8 offset:34816
v_add_u32 v2, 0x80, v2
v_mfma_f32_16x16x32_bf16 v[120:123], a[40:43], a[32:35], v[120:123]
ds_read_b128 a[8:11], v8 offset:36864
v_add_u32 v3, 0x80, v3
v_mfma_f32_16x16x32_bf16 v[124:127], a[44:47], a[32:35], v[124:127]
ds_read_b128 a[12:15], v8 offset:38912
v_mfma_f32_16x16x32_bf16 v[92:95], a[44:47], a[28:31], v[92:95]
ds_read_b64_tr_b16 a[92:93], v13 offset:16896
v_mfma_f32_16x16x32_bf16 v[60:63], a[44:47], a[24:27], v[60:63]
ds_read_b64_tr_b16 a[94:95], v13 offset:17920
s_add_u32 m0, s17, 0xc000
v_mfma_f32_16x16x32_bf16 v[28:31], a[44:47], a[20:23], v[28:31]
buffer_load_dwordx4 v5, s[60:63], 0 offen nt lds
v_mfma_f32_16x16x32_bf16 v[32:35], a[48:51], a[20:23], v[32:35]
ds_read_b64_tr_b16 a[96:97], v12 offset:17152
v_mfma_f32_16x16x32_bf16 v[64:67], a[48:51], a[24:27], v[64:67]
ds_read_b64_tr_b16 a[98:99], v12 offset:18176
v_mfma_f32_16x16x32_bf16 v[96:99], a[48:51], a[28:31], v[96:99]
ds_read_b64_tr_b16 a[100:101], v13 offset:17152
v_mfma_f32_16x16x32_bf16 v[128:131], a[48:51], a[32:35], v[128:131]
ds_read_b64_tr_b16 a[102:103], v13 offset:18176
v_mfma_f32_16x16x32_bf16 v[132:135], a[52:55], a[32:35], v[132:135]
ds_read_b64_tr_b16 a[40:41], v12 offset:0
s_add_u32 m0, s17, 0x8400
v_mfma_f32_16x16x32_bf16 v[100:103], a[52:55], a[28:31], v[100:103]
buffer_load_dwordx4 v5, s[56:59], s13 offen nt lds
v_mfma_f32_16x16x32_bf16 v[68:71], a[52:55], a[24:27], v[68:71]
ds_read_b64_tr_b16 a[42:43], v12 offset:1024
v_mfma_f32_16x16x32_bf16 v[36:39], a[52:55], a[20:23], v[36:39]
ds_read_b64_tr_b16 a[44:45], v13 offset:0
v_mfma_f32_16x16x32_bf16 v[40:43], a[56:59], a[20:23], v[40:43]
ds_read_b64_tr_b16 a[46:47], v13 offset:1024
v_mfma_f32_16x16x32_bf16 v[72:75], a[56:59], a[24:27], v[72:75]
ds_read_b64_tr_b16 a[48:49], v12 offset:256
v_mfma_f32_16x16x32_bf16 v[104:107], a[56:59], a[28:31], v[104:107]
ds_read_b64_tr_b16 a[50:51], v12 offset:1280
s_add_u32 m0, s17, 0xc400
v_mfma_f32_16x16x32_bf16 v[136:139], a[56:59], a[32:35], v[136:139]
buffer_load_dwordx4 v5, s[60:63], s13 offen nt lds
v_mfma_f32_16x16x32_bf16 v[140:143], a[60:63], a[32:35], v[140:143]
ds_read_b64_tr_b16 a[52:53], v13 offset:256
v_mfma_f32_16x16x32_bf16 v[108:111], a[60:63], a[28:31], v[108:111]
ds_read_b64_tr_b16 a[54:55], v13 offset:1280
v_mfma_f32_16x16x32_bf16 v[76:79], a[60:63], a[24:27], v[76:79]
ds_read_b64_tr_b16 a[56:57], v12 offset:512
v_mfma_f32_16x16x32_bf16 v[44:47], a[60:63], a[20:23], v[44:47]
ds_read_b64_tr_b16 a[58:59], v12 offset:1536
v_mfma_f32_16x16x32_bf16 v[48:51], a[64:67], a[20:23], v[48:51]
ds_read_b64_tr_b16 a[60:61], v13 offset:512
s_mov_b32 s9, 0x400000
v_mfma_f32_16x16x32_bf16 v[80:83], a[64:67], a[24:27], v[80:83]
buffer_load_dword v18, v19, s[52:55], s9 offen
v_mfma_f32_16x16x32_bf16 v[112:115], a[64:67], a[28:31], v[112:115]
ds_read_b64_tr_b16 a[62:63], v13 offset:1536
v_mfma_f32_16x16x32_bf16 v[144:147], a[64:67], a[32:35], v[144:147]
ds_read_b64_tr_b16 a[64:65], v12 offset:768
v_mfma_f32_16x16x32_bf16 v[148:151], a[68:71], a[32:35], v[148:151]
ds_read_b64_tr_b16 a[66:67], v12 offset:1792
v_mfma_f32_16x16x32_bf16 v[116:119], a[68:71], a[28:31], v[116:119]
v_mfma_f32_16x16x32_bf16 v[84:87], a[68:71], a[24:27], v[84:87]
s_add_u32 m0, s17, 0x8800
v_mfma_f32_16x16x32_bf16 v[52:55], a[68:71], a[20:23], v[52:55]
buffer_load_dwordx4 v6, s[56:59], 0 offen nt lds
v_mfma_f32_16x16x32_bf16 v[152:155], a[20:23], a[72:75], v[152:155]
ds_read_b64_tr_b16 a[68:69], v13 offset:768
v_mfma_f32_16x16x32_bf16 v[156:159], a[24:27], a[72:75], v[156:159]
ds_read_b64_tr_b16 a[70:71], v13 offset:1792
v_mfma_f32_16x16x32_bf16 v[216:219], a[28:31], a[72:75], v[216:219]
v_mfma_f32_16x16x32_bf16 v[220:223], a[32:35], a[72:75], v[220:223]
ds_read_b64_tr_b16 a[72:73], v12 offset:16384
v_mfma_f32_16x16x32_bf16 v[228:231], a[32:35], a[76:79], v[228:231]
ds_read_b64_tr_b16 a[74:75], v12 offset:17408
s_add_u32 m0, s17, 0xc800
v_mfma_f32_16x16x32_bf16 v[224:227], a[28:31], a[76:79], v[224:227]
buffer_load_dwordx4 v6, s[60:63], 0 offen nt lds
v_mfma_f32_16x16x32_bf16 v[164:167], a[24:27], a[76:79], v[164:167]
v_mfma_f32_16x16x32_bf16 v[160:163], a[20:23], a[76:79], v[160:163]
ds_read_b64_tr_b16 a[76:77], v13 offset:16384
v_mfma_f32_16x16x32_bf16 v[168:171], a[20:23], a[80:83], v[168:171]
ds_read_b64_tr_b16 a[78:79], v13 offset:17408
v_mfma_f32_16x16x32_bf16 v[172:175], a[24:27], a[80:83], v[172:175]
v_mfma_f32_16x16x32_bf16 v[232:235], a[28:31], a[80:83], v[232:235]
s_add_u32 m0, s17, 0x8c00
v_mfma_f32_16x16x32_bf16 v[236:239], a[32:35], a[80:83], v[236:239]
buffer_load_dwordx4 v6, s[56:59], s13 offen nt lds
v_mfma_f32_16x16x32_bf16 v[244:247], a[32:35], a[84:87], v[244:247]
ds_read_b64_tr_b16 a[80:81], v12 offset:16640
v_mfma_f32_16x16x32_bf16 v[240:243], a[28:31], a[84:87], v[240:243]
ds_read_b64_tr_b16 a[82:83], v12 offset:17664
v_mfma_f32_16x16x32_bf16 v[180:183], a[24:27], a[84:87], v[180:183]
v_mfma_f32_16x16x32_bf16 v[176:179], a[20:23], a[84:87], v[176:179]
ds_read_b64_tr_b16 a[84:85], v13 offset:16640
v_mfma_f32_16x16x32_bf16 v[184:187], a[20:23], a[88:91], v[184:187]
ds_read_b64_tr_b16 a[86:87], v13 offset:17664
s_add_u32 m0, s17, 0xcc00
v_mfma_f32_16x16x32_bf16 v[188:191], a[24:27], a[88:91], v[188:191]
buffer_load_dwordx4 v6, s[60:63], s13 offen nt lds
v_mfma_f32_16x16x32_bf16 v[248:251], a[28:31], a[88:91], v[248:251]
v_mfma_f32_16x16x32_bf16 v[252:255], a[32:35], a[88:91], v[252:255]
ds_read_b64_tr_b16 a[88:89], v12 offset:16896
v_mfma_f32_16x16x32_bf16 a[236:239], a[32:35], a[104:107], a[236:239]
ds_read_b64_tr_b16 a[90:91], v12 offset:17920
v_mfma_f32_16x16x32_bf16 a[232:235], a[28:31], a[104:107], a[232:235]
v_mfma_f32_16x16x32_bf16 v[196:199], a[24:27], a[104:107], v[196:199]
v_add_u32 v20, s76, v16
v_mov_b32 v21, s77
v_mfma_f32_16x16x32_bf16 v[192:195], a[20:23], a[104:107], v[192:195]
global_load_dword v18, v[20:21], off sc1
v_mfma_f32_16x16x32_bf16 v[200:203], a[20:23], a[108:111], v[200:203]
v_mfma_f32_16x16x32_bf16 v[204:207], a[24:27], a[108:111], v[204:207]
v_mfma_f32_16x16x32_bf16 a[240:243], a[28:31], a[108:111], a[240:243]
v_mfma_f32_16x16x32_bf16 a[244:247], a[32:35], a[108:111], a[244:247]
v_mfma_f32_16x16x32_bf16 a[252:255], a[32:35], a[112:115], a[252:255]
v_mfma_f32_16x16x32_bf16 a[248:251], a[28:31], a[112:115], a[248:251]
v_mfma_f32_16x16x32_bf16 v[212:215], a[24:27], a[112:115], v[212:215]
v_mfma_f32_16x16x32_bf16 v[208:211], a[20:23], a[112:115], v[208:211]
s_waitcnt lgkmcnt(0)
v_mfma_f32_16x16x32_bf16 v[24:27], a[40:43], a[0:3], v[24:27]
ds_read_b128 a[20:23], v9 offset:32768
v_add_u32 v5, 0xffc80000, v5
v_mfma_f32_16x16x32_bf16 v[56:59], a[40:43], a[4:7], v[56:59]
ds_read_b128 a[24:27], v9 offset:34816
v_add_u32 v6, 0xffc80000, v6
v_mfma_f32_16x16x32_bf16 v[88:91], a[40:43], a[8:11], v[88:91]
ds_read_b128 a[28:31], v9 offset:36864
v_mfma_f32_16x16x32_bf16 v[120:123], a[40:43], a[12:15], v[120:123]
ds_read_b128 a[32:35], v9 offset:38912
v_mfma_f32_16x16x32_bf16 v[124:127], a[44:47], a[12:15], v[124:127]
ds_read_b64_tr_b16 a[104:105], v13 offset:25088
v_mfma_f32_16x16x32_bf16 v[92:95], a[44:47], a[8:11], v[92:95]
ds_read_b64_tr_b16 a[106:107], v13 offset:26112
v_mfma_f32_16x16x32_bf16 v[60:63], a[44:47], a[4:7], v[60:63]
ds_read_b64_tr_b16 a[108:109], v12 offset:25344
v_mfma_f32_16x16x32_bf16 v[28:31], a[44:47], a[0:3], v[28:31]
ds_read_b64_tr_b16 a[110:111], v12 offset:26368
v_mfma_f32_16x16x32_bf16 v[32:35], a[48:51], a[0:3], v[32:35]
ds_read_b64_tr_b16 a[112:113], v13 offset:25344
s_waitcnt lgkmcnt(5)
v_mfma_f32_16x16x32_bf16 v[64:67], a[48:51], a[4:7], v[64:67]
ds_read_b64_tr_b16 a[114:115], v13 offset:26368
s_add_u32 m0, s16, 0x8000
v_mfma_f32_16x16x32_bf16 v[96:99], a[48:51], a[8:11], v[96:99]
buffer_load_dwordx4 v2, s[48:51], 0 offen lds
v_mfma_f32_16x16x32_bf16 v[128:131], a[48:51], a[12:15], v[128:131]
ds_read_b64_tr_b16 a[40:41], v12 offset:8192
v_mfma_f32_16x16x32_bf16 v[132:135], a[52:55], a[12:15], v[132:135]
ds_read_b64_tr_b16 a[42:43], v12 offset:9216
v_mfma_f32_16x16x32_bf16 v[100:103], a[52:55], a[8:11], v[100:103]
ds_read_b64_tr_b16 a[44:45], v13 offset:8192
v_mfma_f32_16x16x32_bf16 v[68:71], a[52:55], a[4:7], v[68:71]
ds_read_b64_tr_b16 a[46:47], v13 offset:9216
s_add_u32 m0, s16, 0x8400
v_mfma_f32_16x16x32_bf16 v[36:39], a[52:55], a[0:3], v[36:39]
buffer_load_dwordx4 v3, s[48:51], 0 offen lds
v_mfma_f32_16x16x32_bf16 v[40:43], a[56:59], a[0:3], v[40:43]
ds_read_b64_tr_b16 a[48:49], v12 offset:8448
v_mfma_f32_16x16x32_bf16 v[72:75], a[56:59], a[4:7], v[72:75]
ds_read_b64_tr_b16 a[50:51], v12 offset:9472
v_mfma_f32_16x16x32_bf16 v[104:107], a[56:59], a[8:11], v[104:107]
ds_read_b64_tr_b16 a[52:53], v13 offset:8448
v_mfma_f32_16x16x32_bf16 v[136:139], a[56:59], a[12:15], v[136:139]
ds_read_b64_tr_b16 a[54:55], v13 offset:9472
v_mfma_f32_16x16x32_bf16 v[140:143], a[60:63], a[12:15], v[140:143]
ds_read_b64_tr_b16 a[56:57], v12 offset:8704
s_add_u32 m0, s16, 0x8800
v_mfma_f32_16x16x32_bf16 v[108:111], a[60:63], a[8:11], v[108:111]
buffer_load_dwordx4 v2, s[48:51], s12 offen lds
v_mfma_f32_16x16x32_bf16 v[76:79], a[60:63], a[4:7], v[76:79]
ds_read_b64_tr_b16 a[58:59], v12 offset:9728
v_mfma_f32_16x16x32_bf16 v[44:47], a[60:63], a[0:3], v[44:47]
ds_read_b64_tr_b16 a[60:61], v13 offset:8704
v_mfma_f32_16x16x32_bf16 v[48:51], a[64:67], a[0:3], v[48:51]
ds_read_b64_tr_b16 a[62:63], v13 offset:9728
v_mfma_f32_16x16x32_bf16 v[80:83], a[64:67], a[4:7], v[80:83]
v_mfma_f32_16x16x32_bf16 v[112:115], a[64:67], a[8:11], v[112:115]
s_add_u32 m0, s16, 0x8c00
v_mfma_f32_16x16x32_bf16 v[144:147], a[64:67], a[12:15], v[144:147]
buffer_load_dwordx4 v3, s[48:51], s12 offen lds
v_mfma_f32_16x16x32_bf16 v[148:151], a[68:71], a[12:15], v[148:151]
ds_read_b64_tr_b16 a[64:65], v12 offset:8960
v_mfma_f32_16x16x32_bf16 v[116:119], a[68:71], a[8:11], v[116:119]
ds_read_b64_tr_b16 a[66:67], v12 offset:9984
v_mfma_f32_16x16x32_bf16 v[84:87], a[68:71], a[4:7], v[84:87]
v_mfma_f32_16x16x32_bf16 v[52:55], a[68:71], a[0:3], v[52:55]
ds_read_b64_tr_b16 a[68:69], v13 offset:8960
v_mfma_f32_16x16x32_bf16 v[152:155], a[0:3], a[72:75], v[152:155]
ds_read_b64_tr_b16 a[70:71], v13 offset:9984
s_add_u32 m0, s16, 0x9000
v_mfma_f32_16x16x32_bf16 v[156:159], a[4:7], a[72:75], v[156:159]
buffer_load_dwordx4 v2, s[48:51], s13 offen lds
v_mfma_f32_16x16x32_bf16 v[216:219], a[8:11], a[72:75], v[216:219]
v_mfma_f32_16x16x32_bf16 v[220:223], a[12:15], a[72:75], v[220:223]
ds_read_b64_tr_b16 a[72:73], v12 offset:24576
v_mfma_f32_16x16x32_bf16 v[228:231], a[12:15], a[76:79], v[228:231]
ds_read_b64_tr_b16 a[74:75], v12 offset:25600
v_mfma_f32_16x16x32_bf16 v[224:227], a[8:11], a[76:79], v[224:227]
s_add_u32 m0, s16, 0x9400
v_mfma_f32_16x16x32_bf16 v[164:167], a[4:7], a[76:79], v[164:167]
buffer_load_dwordx4 v3, s[48:51], s13 offen lds
v_mfma_f32_16x16x32_bf16 v[160:163], a[0:3], a[76:79], v[160:163]
ds_read_b64_tr_b16 a[76:77], v13 offset:24576
v_mfma_f32_16x16x32_bf16 v[168:171], a[0:3], a[80:83], v[168:171]
ds_read_b64_tr_b16 a[78:79], v13 offset:25600
v_mfma_f32_16x16x32_bf16 v[172:175], a[4:7], a[80:83], v[172:175]
v_mfma_f32_16x16x32_bf16 v[232:235], a[8:11], a[80:83], v[232:235]
v_mfma_f32_16x16x32_bf16 v[236:239], a[12:15], a[80:83], v[236:239]
ds_read_b64_tr_b16 a[80:81], v12 offset:24832
s_add_u32 m0, s16, 0x9800
v_mfma_f32_16x16x32_bf16 v[244:247], a[12:15], a[84:87], v[244:247]
buffer_load_dwordx4 v2, s[48:51], s14 offen lds
v_mfma_f32_16x16x32_bf16 v[240:243], a[8:11], a[84:87], v[240:243]
ds_read_b64_tr_b16 a[82:83], v12 offset:25856
v_mfma_f32_16x16x32_bf16 v[180:183], a[4:7], a[84:87], v[180:183]
v_mfma_f32_16x16x32_bf16 v[176:179], a[0:3], a[84:87], v[176:179]
ds_read_b64_tr_b16 a[84:85], v13 offset:24832
v_mfma_f32_16x16x32_bf16 v[184:187], a[0:3], a[88:91], v[184:187]
ds_read_b64_tr_b16 a[86:87], v13 offset:25856
v_mfma_f32_16x16x32_bf16 v[188:191], a[4:7], a[88:91], v[188:191]
s_add_u32 m0, s16, 0x9c00
v_mfma_f32_16x16x32_bf16 v[248:251], a[8:11], a[88:91], v[248:251]
buffer_load_dwordx4 v3, s[48:51], s14 offen lds
v_mfma_f32_16x16x32_bf16 v[252:255], a[12:15], a[88:91], v[252:255]
ds_read_b64_tr_b16 a[88:89], v12 offset:25088
v_mfma_f32_16x16x32_bf16 a[236:239], a[12:15], a[92:95], a[236:239]
ds_read_b64_tr_b16 a[90:91], v12 offset:26112
v_add_u32 v12, 0xffff0000, v12
v_mfma_f32_16x16x32_bf16 a[232:235], a[8:11], a[92:95], a[232:235]
v_add_u32 v13, 0xffff0000, v13
v_mfma_f32_16x16x32_bf16 v[196:199], a[4:7], a[92:95], v[196:199]
v_mfma_f32_16x16x32_bf16 v[192:195], a[0:3], a[92:95], v[192:195]
s_mov_b32 s9, 0x400000
v_mfma_f32_16x16x32_bf16 v[200:203], a[0:3], a[96:99], v[200:203]
buffer_load_dword v18, v19, s[68:71], s9 offen
v_mfma_f32_16x16x32_bf16 v[204:207], a[4:7], a[96:99], v[204:207]
v_mfma_f32_16x16x32_bf16 a[240:243], a[8:11], a[96:99], a[240:243]
v_mfma_f32_16x16x32_bf16 a[244:247], a[12:15], a[96:99], a[244:247]
v_mfma_f32_16x16x32_bf16 a[252:255], a[12:15], a[100:103], a[252:255]
v_mfma_f32_16x16x32_bf16 a[248:251], a[8:11], a[100:103], a[248:251]
v_mfma_f32_16x16x32_bf16 v[212:215], a[4:7], a[100:103], v[212:215]
v_mfma_f32_16x16x32_bf16 v[208:211], a[0:3], a[100:103], v[208:211]
s_waitcnt vmcnt(19) lgkmcnt(0)
s_barrier
v_mfma_f32_16x16x32_bf16 v[24:27], a[40:43], a[20:23], v[24:27]
ds_read_b128 a[0:3], v8 offset:0
s_add_u32 m0, s17, 0x10000
v_mfma_f32_16x16x32_bf16 v[56:59], a[40:43], a[24:27], v[56:59]
buffer_load_dwordx4 v5, s[52:55], 0 offen lds
v_mfma_f32_16x16x32_bf16 v[88:91], a[40:43], a[28:31], v[88:91]
ds_read_b128 a[4:7], v8 offset:2048
v_add_u32 v2, 0x80, v2
v_mfma_f32_16x16x32_bf16 v[120:123], a[40:43], a[32:35], v[120:123]
ds_read_b128 a[8:11], v8 offset:4096
v_add_u32 v3, 0x80, v3
v_mfma_f32_16x16x32_bf16 v[124:127], a[44:47], a[32:35], v[124:127]
ds_read_b128 a[12:15], v8 offset:6144
v_mfma_f32_16x16x32_bf16 v[92:95], a[44:47], a[28:31], v[92:95]
ds_read_b64_tr_b16 a[92:93], v13 offset:16896
v_mfma_f32_16x16x32_bf16 v[60:63], a[44:47], a[24:27], v[60:63]
ds_read_b64_tr_b16 a[94:95], v13 offset:17920
s_add_u32 m0, s17, 0x10400
v_mfma_f32_16x16x32_bf16 v[28:31], a[44:47], a[20:23], v[28:31]
buffer_load_dwordx4 v5, s[52:55], s13 offen lds
v_mfma_f32_16x16x32_bf16 v[32:35], a[48:51], a[20:23], v[32:35]
ds_read_b64_tr_b16 a[96:97], v12 offset:17152
v_mfma_f32_16x16x32_bf16 v[64:67], a[48:51], a[24:27], v[64:67]
ds_read_b64_tr_b16 a[98:99], v12 offset:18176
v_mfma_f32_16x16x32_bf16 v[96:99], a[48:51], a[28:31], v[96:99]
ds_read_b64_tr_b16 a[100:101], v13 offset:17152
v_mfma_f32_16x16x32_bf16 v[128:131], a[48:51], a[32:35], v[128:131]
ds_read_b64_tr_b16 a[102:103], v13 offset:18176
v_mfma_f32_16x16x32_bf16 v[132:135], a[52:55], a[32:35], v[132:135]
ds_read_b64_tr_b16 a[40:41], v12 offset:0
v_mfma_f32_16x16x32_bf16 v[100:103], a[52:55], a[28:31], v[100:103]
ds_read_b64_tr_b16 a[42:43], v12 offset:1024
s_add_u32 m0, s17, 0x10800
v_mfma_f32_16x16x32_bf16 v[68:71], a[52:55], a[24:27], v[68:71]
buffer_load_dwordx4 v6, s[52:55], 0 offen lds
v_mfma_f32_16x16x32_bf16 v[36:39], a[52:55], a[20:23], v[36:39]
ds_read_b64_tr_b16 a[44:45], v13 offset:0
v_mfma_f32_16x16x32_bf16 v[40:43], a[56:59], a[20:23], v[40:43]
ds_read_b64_tr_b16 a[46:47], v13 offset:1024
v_mfma_f32_16x16x32_bf16 v[72:75], a[56:59], a[24:27], v[72:75]
ds_read_b64_tr_b16 a[48:49], v12 offset:256
v_mfma_f32_16x16x32_bf16 v[104:107], a[56:59], a[28:31], v[104:107]
ds_read_b64_tr_b16 a[50:51], v12 offset:1280
v_mfma_f32_16x16x32_bf16 v[136:139], a[56:59], a[32:35], v[136:139]
ds_read_b64_tr_b16 a[52:53], v13 offset:256
v_mfma_f32_16x16x32_bf16 v[140:143], a[60:63], a[32:35], v[140:143]
ds_read_b64_tr_b16 a[54:55], v13 offset:1280
s_add_u32 m0, s17, 0x10c00
v_mfma_f32_16x16x32_bf16 v[108:111], a[60:63], a[28:31], v[108:111]
buffer_load_dwordx4 v6, s[52:55], s13 offen lds
v_mfma_f32_16x16x32_bf16 v[76:79], a[60:63], a[24:27], v[76:79]
ds_read_b64_tr_b16 a[56:57], v12 offset:512
v_mfma_f32_16x16x32_bf16 v[44:47], a[60:63], a[20:23], v[44:47]
ds_read_b64_tr_b16 a[58:59], v12 offset:1536
v_mfma_f32_16x16x32_bf16 v[48:51], a[64:67], a[20:23], v[48:51]
ds_read_b64_tr_b16 a[60:61], v13 offset:512
v_mfma_f32_16x16x32_bf16 v[80:83], a[64:67], a[24:27], v[80:83]
ds_read_b64_tr_b16 a[62:63], v13 offset:1536
v_mfma_f32_16x16x32_bf16 v[112:115], a[64:67], a[28:31], v[112:115]
v_mfma_f32_16x16x32_bf16 v[144:147], a[64:67], a[32:35], v[144:147]
ds_read_b64_tr_b16 a[64:65], v12 offset:768
s_add_u32 m0, s18, 0x14000
v_mfma_f32_16x16x32_bf16 v[148:151], a[68:71], a[32:35], v[148:151]
buffer_load_dwordx4 v7, s[68:71], 0 offen lds
v_mfma_f32_16x16x32_bf16 v[116:119], a[68:71], a[28:31], v[116:119]
ds_read_b64_tr_b16 a[66:67], v12 offset:1792
v_mfma_f32_16x16x32_bf16 v[84:87], a[68:71], a[24:27], v[84:87]
v_mfma_f32_16x16x32_bf16 v[52:55], a[68:71], a[20:23], v[52:55]
ds_read_b64_tr_b16 a[68:69], v13 offset:768
v_mfma_f32_16x16x32_bf16 v[152:155], a[20:23], a[72:75], v[152:155]
ds_read_b64_tr_b16 a[70:71], v13 offset:1792
v_mfma_f32_16x16x32_bf16 v[156:159], a[24:27], a[72:75], v[156:159]
s_add_u32 m0, s18, 0x15000
v_mfma_f32_16x16x32_bf16 v[216:219], a[28:31], a[72:75], v[216:219]
buffer_load_dwordx4 v7, s[68:71], s25 offen lds
v_mfma_f32_16x16x32_bf16 v[220:223], a[32:35], a[72:75], v[220:223]
ds_read_b64_tr_b16 a[72:73], v12 offset:16384
v_mfma_f32_16x16x32_bf16 v[228:231], a[32:35], a[76:79], v[228:231]
ds_read_b64_tr_b16 a[74:75], v12 offset:17408
v_mfma_f32_16x16x32_bf16 v[224:227], a[28:31], a[76:79], v[224:227]
v_mfma_f32_16x16x32_bf16 v[164:167], a[24:27], a[76:79], v[164:167]
v_mfma_f32_16x16x32_bf16 v[160:163], a[20:23], a[76:79], v[160:163]
ds_read_b64_tr_b16 a[76:77], v13 offset:16384
v_mfma_f32_16x16x32_bf16 v[168:171], a[20:23], a[80:83], v[168:171]
ds_read_b64_tr_b16 a[78:79], v13 offset:17408
s_add_u32 m0, s18, 0x16000
v_mfma_f32_16x16x32_bf16 v[172:175], a[24:27], a[80:83], v[172:175]
buffer_load_dwordx4 v7, s[68:71], s26 offen lds
v_mfma_f32_16x16x32_bf16 v[232:235], a[28:31], a[80:83], v[232:235]
v_mfma_f32_16x16x32_bf16 v[236:239], a[32:35], a[80:83], v[236:239]
ds_read_b64_tr_b16 a[80:81], v12 offset:16640
v_mfma_f32_16x16x32_bf16 v[244:247], a[32:35], a[84:87], v[244:247]
ds_read_b64_tr_b16 a[82:83], v12 offset:17664
v_mfma_f32_16x16x32_bf16 v[240:243], a[28:31], a[84:87], v[240:243]
v_mfma_f32_16x16x32_bf16 v[180:183], a[24:27], a[84:87], v[180:183]
v_mfma_f32_16x16x32_bf16 v[176:179], a[20:23], a[84:87], v[176:179]
ds_read_b64_tr_b16 a[84:85], v13 offset:16640
s_add_u32 m0, s18, 0x17000
v_mfma_f32_16x16x32_bf16 v[184:187], a[20:23], a[88:91], v[184:187]
buffer_load_dwordx4 v4, s[44:47], s24 offen lds
v_mfma_f32_16x16x32_bf16 v[188:191], a[24:27], a[88:91], v[188:191]
ds_read_b64_tr_b16 a[86:87], v13 offset:17664
v_mfma_f32_16x16x32_bf16 v[248:251], a[28:31], a[88:91], v[248:251]
v_mfma_f32_16x16x32_bf16 v[252:255], a[32:35], a[88:91], v[252:255]
ds_read_b64_tr_b16 a[88:89], v12 offset:16896
v_mfma_f32_16x16x32_bf16 a[236:239], a[32:35], a[104:107], a[236:239]
ds_read_b64_tr_b16 a[90:91], v12 offset:17920
v_mfma_f32_16x16x32_bf16 a[232:235], a[28:31], a[104:107], a[232:235]
v_mfma_f32_16x16x32_bf16 v[196:199], a[24:27], a[104:107], v[196:199]
s_mov_b32 s9, 0x600000
v_mfma_f32_16x16x32_bf16 v[192:195], a[20:23], a[104:107], v[192:195]
buffer_load_dword v18, v19, s[52:55], s9 offen
v_mfma_f32_16x16x32_bf16 v[200:203], a[20:23], a[108:111], v[200:203]
v_mfma_f32_16x16x32_bf16 v[204:207], a[24:27], a[108:111], v[204:207]
v_mfma_f32_16x16x32_bf16 a[240:243], a[28:31], a[108:111], a[240:243]
v_mfma_f32_16x16x32_bf16 a[244:247], a[32:35], a[108:111], a[244:247]
v_mfma_f32_16x16x32_bf16 a[252:255], a[32:35], a[112:115], a[252:255]
v_mfma_f32_16x16x32_bf16 a[248:251], a[28:31], a[112:115], a[248:251]
v_mfma_f32_16x16x32_bf16 v[212:215], a[24:27], a[112:115], v[212:215]
v_mfma_f32_16x16x32_bf16 v[208:211], a[20:23], a[112:115], v[208:211]
s_waitcnt lgkmcnt(0)
v_mfma_f32_16x16x32_bf16 v[24:27], a[40:43], a[0:3], v[24:27]
ds_read_b128 a[20:23], v9 offset:0
v_add_u32 v5, 0x80000, v5
v_mfma_f32_16x16x32_bf16 v[56:59], a[40:43], a[4:7], v[56:59]
ds_read_b128 a[24:27], v9 offset:2048
v_add_u32 v6, 0x80000, v6
v_mfma_f32_16x16x32_bf16 v[88:91], a[40:43], a[8:11], v[88:91]
ds_read_b128 a[28:31], v9 offset:4096
v_add_u32 v7, 0x60000, v7
v_mfma_f32_16x16x32_bf16 v[120:123], a[40:43], a[12:15], v[120:123]
ds_read_b128 a[32:35], v9 offset:6144
v_add_u32 v4, 0x80, v4
v_mfma_f32_16x16x32_bf16 v[124:127], a[44:47], a[12:15], v[124:127]
ds_read_b64_tr_b16 a[104:105], v13 offset:25088
v_mfma_f32_16x16x32_bf16 v[92:95], a[44:47], a[8:11], v[92:95]
ds_read_b64_tr_b16 a[106:107], v13 offset:26112
v_mfma_f32_16x16x32_bf16 v[60:63], a[44:47], a[4:7], v[60:63]
ds_read_b64_tr_b16 a[108:109], v12 offset:25344
v_mfma_f32_16x16x32_bf16 v[28:31], a[44:47], a[0:3], v[28:31]
ds_read_b64_tr_b16 a[110:111], v12 offset:26368
v_mfma_f32_16x16x32_bf16 v[32:35], a[48:51], a[0:3], v[32:35]
ds_read_b64_tr_b16 a[112:113], v13 offset:25344
s_waitcnt lgkmcnt(5)
v_mfma_f32_16x16x32_bf16 v[64:67], a[48:51], a[4:7], v[64:67]
ds_read_b64_tr_b16 a[114:115], v13 offset:26368
s_add_u32 m0, s16, 0x0
v_mfma_f32_16x16x32_bf16 v[96:99], a[48:51], a[8:11], v[96:99]
buffer_load_dwordx4 v22, s[44:47], s20 offen lds
v_mfma_f32_16x16x32_bf16 v[128:131], a[48:51], a[12:15], v[128:131]
ds_read_b64_tr_b16 a[40:41], v12 offset:8192
v_mfma_f32_16x16x32_bf16 v[132:135], a[52:55], a[12:15], v[132:135]
ds_read_b64_tr_b16 a[42:43], v12 offset:9216
v_mfma_f32_16x16x32_bf16 v[100:103], a[52:55], a[8:11], v[100:103]
ds_read_b64_tr_b16 a[44:45], v13 offset:8192
v_mfma_f32_16x16x32_bf16 v[68:71], a[52:55], a[4:7], v[68:71]
ds_read_b64_tr_b16 a[46:47], v13 offset:9216
v_mfma_f32_16x16x32_bf16 v[36:39], a[52:55], a[0:3], v[36:39]
ds_read_b64_tr_b16 a[48:49], v12 offset:8448
s_add_u32 m0, s16, 0x400
v_mfma_f32_16x16x32_bf16 v[40:43], a[56:59], a[0:3], v[40:43]
buffer_load_dwordx4 v23, s[44:47], s20 offen lds
v_mfma_f32_16x16x32_bf16 v[72:75], a[56:59], a[4:7], v[72:75]
ds_read_b64_tr_b16 a[50:51], v12 offset:9472
v_mfma_f32_16x16x32_bf16 v[104:107], a[56:59], a[8:11], v[104:107]
ds_read_b64_tr_b16 a[52:53], v13 offset:8448
v_mfma_f32_16x16x32_bf16 v[136:139], a[56:59], a[12:15], v[136:139]
ds_read_b64_tr_b16 a[54:55], v13 offset:9472
v_mfma_f32_16x16x32_bf16 v[140:143], a[60:63], a[12:15], v[140:143]
ds_read_b64_tr_b16 a[56:57], v12 offset:8704
v_mfma_f32_16x16x32_bf16 v[108:111], a[60:63], a[8:11], v[108:111]
ds_read_b64_tr_b16 a[58:59], v12 offset:9728
v_mfma_f32_16x16x32_bf16 v[76:79], a[60:63], a[4:7], v[76:79]
s_add_u32 m0, s16, 0x800
v_mfma_f32_16x16x32_bf16 v[44:47], a[60:63], a[0:3], v[44:47]
buffer_load_dwordx4 v22, s[44:47], s21 offen lds
v_mfma_f32_16x16x32_bf16 v[48:51], a[64:67], a[0:3], v[48:51]
ds_read_b64_tr_b16 a[60:61], v13 offset:8704
v_mfma_f32_16x16x32_bf16 v[80:83], a[64:67], a[4:7], v[80:83]
ds_read_b64_tr_b16 a[62:63], v13 offset:9728
v_mfma_f32_16x16x32_bf16 v[112:115], a[64:67], a[8:11], v[112:115]
v_mfma_f32_16x16x32_bf16 v[144:147], a[64:67], a[12:15], v[144:147]
ds_read_b64_tr_b16 a[64:65], v12 offset:8960
v_mfma_f32_16x16x32_bf16 v[148:151], a[68:71], a[12:15], v[148:151]
ds_read_b64_tr_b16 a[66:67], v12 offset:9984
s_add_u32 m0, s16, 0xc00
v_mfma_f32_16x16x32_bf16 v[116:119], a[68:71], a[8:11], v[116:119]
buffer_load_dwordx4 v23, s[44:47], s21 offen lds
v_mfma_f32_16x16x32_bf16 v[84:87], a[68:71], a[4:7], v[84:87]
v_mfma_f32_16x16x32_bf16 v[52:55], a[68:71], a[0:3], v[52:55]
ds_read_b64_tr_b16 a[68:69], v13 offset:8960
v_mfma_f32_16x16x32_bf16 v[152:155], a[0:3], a[72:75], v[152:155]
ds_read_b64_tr_b16 a[70:71], v13 offset:9984
v_mfma_f32_16x16x32_bf16 v[156:159], a[4:7], a[72:75], v[156:159]
v_mfma_f32_16x16x32_bf16 v[216:219], a[8:11], a[72:75], v[216:219]
v_mfma_f32_16x16x32_bf16 v[220:223], a[12:15], a[72:75], v[220:223]
ds_read_b64_tr_b16 a[72:73], v12 offset:24576
s_add_u32 m0, s16, 0x1000
v_mfma_f32_16x16x32_bf16 v[228:231], a[12:15], a[76:79], v[228:231]
buffer_load_dwordx4 v22, s[44:47], s22 offen lds
v_mfma_f32_16x16x32_bf16 v[224:227], a[8:11], a[76:79], v[224:227]
ds_read_b64_tr_b16 a[74:75], v12 offset:25600
v_mfma_f32_16x16x32_bf16 v[164:167], a[4:7], a[76:79], v[164:167]
v_mfma_f32_16x16x32_bf16 v[160:163], a[0:3], a[76:79], v[160:163]
ds_read_b64_tr_b16 a[76:77], v13 offset:24576
v_mfma_f32_16x16x32_bf16 v[168:171], a[0:3], a[80:83], v[168:171]
ds_read_b64_tr_b16 a[78:79], v13 offset:25600
v_mfma_f32_16x16x32_bf16 v[172:175], a[4:7], a[80:83], v[172:175]
s_add_u32 m0, s16, 0x1400
v_mfma_f32_16x16x32_bf16 v[232:235], a[8:11], a[80:83], v[232:235]
buffer_load_dwordx4 v23, s[44:47], s22 offen lds
v_mfma_f32_16x16x32_bf16 v[236:239], a[12:15], a[80:83], v[236:239]
ds_read_b64_tr_b16 a[80:81], v12 offset:24832
v_mfma_f32_16x16x32_bf16 v[244:247], a[12:15], a[84:87], v[244:247]
ds_read_b64_tr_b16 a[82:83], v12 offset:25856
v_mfma_f32_16x16x32_bf16 v[240:243], a[8:11], a[84:87], v[240:243]
v_mfma_f32_16x16x32_bf16 v[180:183], a[4:7], a[84:87], v[180:183]
v_mfma_f32_16x16x32_bf16 v[176:179], a[0:3], a[84:87], v[176:179]
ds_read_b64_tr_b16 a[84:85], v13 offset:24832
v_mfma_f32_16x16x32_bf16 v[184:187], a[0:3], a[88:91], v[184:187]
ds_read_b64_tr_b16 a[86:87], v13 offset:25856
s_add_u32 m0, s16, 0x1800
v_mfma_f32_16x16x32_bf16 v[188:191], a[4:7], a[88:91], v[188:191]
buffer_load_dwordx4 v22, s[44:47], s23 offen lds
v_mfma_f32_16x16x32_bf16 v[248:251], a[8:11], a[88:91], v[248:251]
v_mfma_f32_16x16x32_bf16 v[252:255], a[12:15], a[88:91], v[252:255]
ds_read_b64_tr_b16 a[88:89], v12 offset:25088
v_mfma_f32_16x16x32_bf16 a[236:239], a[12:15], a[92:95], a[236:239]
ds_read_b64_tr_b16 a[90:91], v12 offset:26112
v_add_u32 v12, 0x8000, v12
v_mfma_f32_16x16x32_bf16 a[232:235], a[8:11], a[92:95], a[232:235]
v_add_u32 v13, 0x8000, v13
v_mfma_f32_16x16x32_bf16 v[196:199], a[4:7], a[92:95], v[196:199]
s_add_u32 m0, s16, 0x1c00
v_mfma_f32_16x16x32_bf16 v[192:195], a[0:3], a[92:95], v[192:195]
buffer_load_dwordx4 v23, s[44:47], s23 offen lds
v_mfma_f32_16x16x32_bf16 v[200:203], a[0:3], a[96:99], v[200:203]
v_mfma_f32_16x16x32_bf16 v[204:207], a[4:7], a[96:99], v[204:207]
v_mfma_f32_16x16x32_bf16 a[240:243], a[8:11], a[96:99], a[240:243]
v_mfma_f32_16x16x32_bf16 a[244:247], a[12:15], a[96:99], a[244:247]
v_mfma_f32_16x16x32_bf16 a[252:255], a[12:15], a[100:103], a[252:255]
v_mfma_f32_16x16x32_bf16 a[248:251], a[8:11], a[100:103], a[248:251]
v_mfma_f32_16x16x32_bf16 v[212:215], a[4:7], a[100:103], v[212:215]
v_mfma_f32_16x16x32_bf16 v[208:211], a[0:3], a[100:103], v[208:211]
s_waitcnt vmcnt(18) lgkmcnt(0)
s_barrier
v_mfma_f32_16x16x32_bf16 v[24:27], a[40:43], a[20:23], v[24:27]
ds_read_b128 a[0:3], v8 offset:32768
s_add_u32 m0, s17, 0x0
v_mfma_f32_16x16x32_bf16 v[56:59], a[40:43], a[24:27], v[56:59]
buffer_load_dwordx4 v5, s[52:55], 0 offen lds
v_mfma_f32_16x16x32_bf16 v[88:91], a[40:43], a[28:31], v[88:91]
ds_read_b128 a[4:7], v8 offset:34816
v_add_u32 v22, 0x80, v22
v_mfma_f32_16x16x32_bf16 v[120:123], a[40:43], a[32:35], v[120:123]
ds_read_b128 a[8:11], v8 offset:36864
v_add_u32 v23, 0x80, v23
v_mfma_f32_16x16x32_bf16 v[124:127], a[44:47], a[32:35], v[124:127]
ds_read_b128 a[12:15], v8 offset:38912
v_mfma_f32_16x16x32_bf16 v[92:95], a[44:47], a[28:31], v[92:95]
ds_read_b64_tr_b16 a[92:93], v13 offset:16896
v_mfma_f32_16x16x32_bf16 v[60:63], a[44:47], a[24:27], v[60:63]
ds_read_b64_tr_b16 a[94:95], v13 offset:17920
v_mfma_f32_16x16x32_bf16 v[28:31], a[44:47], a[20:23], v[28:31]
ds_read_b64_tr_b16 a[96:97], v12 offset:17152
s_add_u32 m0, s17, 0x400
v_mfma_f32_16x16x32_bf16 v[32:35], a[48:51], a[20:23], v[32:35]
buffer_load_dwordx4 v5, s[52:55], s13 offen lds
v_mfma_f32_16x16x32_bf16 v[64:67], a[48:51], a[24:27], v[64:67]
ds_read_b64_tr_b16 a[98:99], v12 offset:18176
v_mfma_f32_16x16x32_bf16 v[96:99], a[48:51], a[28:31], v[96:99]
ds_read_b64_tr_b16 a[100:101], v13 offset:17152
v_mfma_f32_16x16x32_bf16 v[128:131], a[48:51], a[32:35], v[128:131]
ds_read_b64_tr_b16 a[102:103], v13 offset:18176
v_mfma_f32_16x16x32_bf16 v[132:135], a[52:55], a[32:35], v[132:135]
ds_read_b64_tr_b16 a[40:41], v12 offset:0
v_mfma_f32_16x16x32_bf16 v[100:103], a[52:55], a[28:31], v[100:103]
ds_read_b64_tr_b16 a[42:43], v12 offset:1024
v_mfma_f32_16x16x32_bf16 v[68:71], a[52:55], a[24:27], v[68:71]
ds_read_b64_tr_b16 a[44:45], v13 offset:0
v_mfma_f32_16x16x32_bf16 v[36:39], a[52:55], a[20:23], v[36:39]
ds_read_b64_tr_b16 a[46:47], v13 offset:1024
s_add_u32 m0, s17, 0x800
v_mfma_f32_16x16x32_bf16 v[40:43], a[56:59], a[20:23], v[40:43]
buffer_load_dwordx4 v6, s[52:55], 0 offen lds
v_mfma_f32_16x16x32_bf16 v[72:75], a[56:59], a[24:27], v[72:75]
ds_read_b64_tr_b16 a[48:49], v12 offset:256
v_mfma_f32_16x16x32_bf16 v[104:107], a[56:59], a[28:31], v[104:107]
ds_read_b64_tr_b16 a[50:51], v12 offset:1280
v_mfma_f32_16x16x32_bf16 v[136:139], a[56:59], a[32:35], v[136:139]
ds_read_b64_tr_b16 a[52:53], v13 offset:256
v_mfma_f32_16x16x32_bf16 v[140:143], a[60:63], a[32:35], v[140:143]
ds_read_b64_tr_b16 a[54:55], v13 offset:1280
v_mfma_f32_16x16x32_bf16 v[108:111], a[60:63], a[28:31], v[108:111]
ds_read_b64_tr_b16 a[56:57], v12 offset:512
v_mfma_f32_16x16x32_bf16 v[76:79], a[60:63], a[24:27], v[76:79]
ds_read_b64_tr_b16 a[58:59], v12 offset:1536
s_add_u32 m0, s17, 0xc00
v_mfma_f32_16x16x32_bf16 v[44:47], a[60:63], a[20:23], v[44:47]
buffer_load_dwordx4 v6, s[52:55], s13 offen lds
v_mfma_f32_16x16x32_bf16 v[48:51], a[64:67], a[20:23], v[48:51]
ds_read_b64_tr_b16 a[60:61], v13 offset:512
v_mfma_f32_16x16x32_bf16 v[80:83], a[64:67], a[24:27], v[80:83]
ds_read_b64_tr_b16 a[62:63], v13 offset:1536
v_mfma_f32_16x16x32_bf16 v[112:115], a[64:67], a[28:31], v[112:115]
v_mfma_f32_16x16x32_bf16 v[144:147], a[64:67], a[32:35], v[144:147]
ds_read_b64_tr_b16 a[64:65], v12 offset:768
v_mfma_f32_16x16x32_bf16 v[148:151], a[68:71], a[32:35], v[148:151]
ds_read_b64_tr_b16 a[66:67], v12 offset:1792
v_mfma_f32_16x16x32_bf16 v[116:119], a[68:71], a[28:31], v[116:119]
v_mfma_f32_16x16x32_bf16 v[84:87], a[68:71], a[24:27], v[84:87]
s_add_u32 m0, s18, 0x4000
v_mfma_f32_16x16x32_bf16 v[52:55], a[68:71], a[20:23], v[52:55]
buffer_load_dwordx4 v7, s[68:71], 0 offen lds
v_mfma_f32_16x16x32_bf16 v[152:155], a[20:23], a[72:75], v[152:155]
ds_read_b64_tr_b16 a[68:69], v13 offset:768
v_mfma_f32_16x16x32_bf16 v[156:159], a[24:27], a[72:75], v[156:159]
ds_read_b64_tr_b16 a[70:71], v13 offset:1792
v_mfma_f32_16x16x32_bf16 v[216:219], a[28:31], a[72:75], v[216:219]
v_mfma_f32_16x16x32_bf16 v[220:223], a[32:35], a[72:75], v[220:223]
ds_read_b64_tr_b16 a[72:73], v12 offset:16384
v_mfma_f32_16x16x32_bf16 v[228:231], a[32:35], a[76:79], v[228:231]
ds_read_b64_tr_b16 a[74:75], v12 offset:17408
v_mfma_f32_16x16x32_bf16 v[224:227], a[28:31], a[76:79], v[224:227]
v_mfma_f32_16x16x32_bf16 v[164:167], a[24:27], a[76:79], v[164:167]
s_add_u32 m0, s18, 0x5000
v_mfma_f32_16x16x32_bf16 v[160:163], a[20:23], a[76:79], v[160:163]
buffer_load_dwordx4 v7, s[68:71], s25 offen lds
v_mfma_f32_16x16x32_bf16 v[168:171], a[20:23], a[80:83], v[168:171]
ds_read_b64_tr_b16 a[76:77], v13 offset:16384
v_mfma_f32_16x16x32_bf16 v[172:175], a[24:27], a[80:83], v[172:175]
ds_read_b64_tr_b16 a[78:79], v13 offset:17408
v_mfma_f32_16x16x32_bf16 v[232:235], a[28:31], a[80:83], v[232:235]
v_mfma_f32_16x16x32_bf16 v[236:239], a[32:35], a[80:83], v[236:239]
ds_read_b64_tr_b16 a[80:81], v12 offset:16640
v_mfma_f32_16x16x32_bf16 v[244:247], a[32:35], a[84:87], v[244:247]
ds_read_b64_tr_b16 a[82:83], v12 offset:17664
v_mfma_f32_16x16x32_bf16 v[240:243], a[28:31], a[84:87], v[240:243]
s_add_u32 m0, s18, 0x6000
v_mfma_f32_16x16x32_bf16 v[180:183], a[24:27], a[84:87], v[180:183]
buffer_load_dwordx4 v7, s[68:71], s26 offen lds
v_mfma_f32_16x16x32_bf16 v[176:179], a[20:23], a[84:87], v[176:179]
ds_read_b64_tr_b16 a[84:85], v13 offset:16640
v_mfma_f32_16x16x32_bf16 v[184:187], a[20:23], a[88:91], v[184:187]
ds_read_b64_tr_b16 a[86:87], v13 offset:17664
v_mfma_f32_16x16x32_bf16 v[188:191], a[24:27], a[88:91], v[188:191]
v_mfma_f32_16x16x32_bf16 v[248:251], a[28:31], a[88:91], v[248:251]
v_mfma_f32_16x16x32_bf16 v[252:255], a[32:35], a[88:91], v[252:255]
ds_read_b64_tr_b16 a[88:89], v12 offset:16896
v_mfma_f32_16x16x32_bf16 a[236:239], a[32:35], a[104:107], a[236:239]
ds_read_b64_tr_b16 a[90:91], v12 offset:17920
v_mfma_f32_16x16x32_bf16 a[232:235], a[28:31], a[104:107], a[232:235]
s_add_u32 m0, s18, 0x7000
v_mfma_f32_16x16x32_bf16 v[196:199], a[24:27], a[104:107], v[196:199]
buffer_load_dwordx4 v4, s[44:47], s24 offen lds
v_mfma_f32_16x16x32_bf16 v[192:195], a[20:23], a[104:107], v[192:195]
v_mfma_f32_16x16x32_bf16 v[200:203], a[20:23], a[108:111], v[200:203]
v_mfma_f32_16x16x32_bf16 v[204:207], a[24:27], a[108:111], v[204:207]
v_mfma_f32_16x16x32_bf16 a[240:243], a[28:31], a[108:111], a[240:243]
v_mfma_f32_16x16x32_bf16 a[244:247], a[32:35], a[108:111], a[244:247]
v_mfma_f32_16x16x32_bf16 a[252:255], a[32:35], a[112:115], a[252:255]
v_mfma_f32_16x16x32_bf16 a[248:251], a[28:31], a[112:115], a[248:251]
v_mfma_f32_16x16x32_bf16 v[212:215], a[24:27], a[112:115], v[212:215]
v_mfma_f32_16x16x32_bf16 v[208:211], a[20:23], a[112:115], v[208:211]
s_waitcnt lgkmcnt(0)
v_mfma_f32_16x16x32_bf16 v[24:27], a[40:43], a[0:3], v[24:27]
ds_read_b128 a[20:23], v9 offset:32768
v_add_u32 v5, 0x80000, v5
v_mfma_f32_16x16x32_bf16 v[56:59], a[40:43], a[4:7], v[56:59]
ds_read_b128 a[24:27], v9 offset:34816
v_add_u32 v6, 0x80000, v6
v_mfma_f32_16x16x32_bf16 v[88:91], a[40:43], a[8:11], v[88:91]
ds_read_b128 a[28:31], v9 offset:36864
v_add_u32 v7, 0x60000, v7
v_mfma_f32_16x16x32_bf16 v[120:123], a[40:43], a[12:15], v[120:123]
ds_read_b128 a[32:35], v9 offset:38912
v_add_u32 v4, 0x80, v4
v_mfma_f32_16x16x32_bf16 v[124:127], a[44:47], a[12:15], v[124:127]
ds_read_b64_tr_b16 a[104:105], v13 offset:25088
v_mfma_f32_16x16x32_bf16 v[92:95], a[44:47], a[8:11], v[92:95]
ds_read_b64_tr_b16 a[106:107], v13 offset:26112
v_mfma_f32_16x16x32_bf16 v[60:63], a[44:47], a[4:7], v[60:63]
ds_read_b64_tr_b16 a[108:109], v12 offset:25344
v_mfma_f32_16x16x32_bf16 v[28:31], a[44:47], a[0:3], v[28:31]
ds_read_b64_tr_b16 a[110:111], v12 offset:26368
v_mfma_f32_16x16x32_bf16 v[32:35], a[48:51], a[0:3], v[32:35]
ds_read_b64_tr_b16 a[112:113], v13 offset:25344
s_waitcnt lgkmcnt(5)
v_mfma_f32_16x16x32_bf16 v[64:67], a[48:51], a[4:7], v[64:67]
ds_read_b64_tr_b16 a[114:115], v13 offset:26368
s_add_u32 m0, s16, 0x8000
v_mfma_f32_16x16x32_bf16 v[96:99], a[48:51], a[8:11], v[96:99]
buffer_load_dwordx4 v22, s[44:47], s20 offen lds
v_mfma_f32_16x16x32_bf16 v[128:131], a[48:51], a[12:15], v[128:131]
ds_read_b64_tr_b16 a[40:41], v12 offset:8192
v_mfma_f32_16x16x32_bf16 v[132:135], a[52:55], a[12:15], v[132:135]
ds_read_b64_tr_b16 a[42:43], v12 offset:9216
v_mfma_f32_16x16x32_bf16 v[100:103], a[52:55], a[8:11], v[100:103]
ds_read_b64_tr_b16 a[44:45], v13 offset:8192
v_mfma_f32_16x16x32_bf16 v[68:71], a[52:55], a[4:7], v[68:71]
ds_read_b64_tr_b16 a[46:47], v13 offset:9216
v_mfma_f32_16x16x32_bf16 v[36:39], a[52:55], a[0:3], v[36:39]
ds_read_b64_tr_b16 a[48:49], v12 offset:8448
s_add_u32 m0, s16, 0x8400
v_mfma_f32_16x16x32_bf16 v[40:43], a[56:59], a[0:3], v[40:43]
buffer_load_dwordx4 v23, s[44:47], s20 offen lds
v_mfma_f32_16x16x32_bf16 v[72:75], a[56:59], a[4:7], v[72:75]
ds_read_b64_tr_b16 a[50:51], v12 offset:9472
v_mfma_f32_16x16x32_bf16 v[104:107], a[56:59], a[8:11], v[104:107]
ds_read_b64_tr_b16 a[52:53], v13 offset:8448
v_mfma_f32_16x16x32_bf16 v[136:139], a[56:59], a[12:15], v[136:139]
ds_read_b64_tr_b16 a[54:55], v13 offset:9472
v_mfma_f32_16x16x32_bf16 v[140:143], a[60:63], a[12:15], v[140:143]
ds_read_b64_tr_b16 a[56:57], v12 offset:8704
v_mfma_f32_16x16x32_bf16 v[108:111], a[60:63], a[8:11], v[108:111]
ds_read_b64_tr_b16 a[58:59], v12 offset:9728
v_mfma_f32_16x16x32_bf16 v[76:79], a[60:63], a[4:7], v[76:79]
s_add_u32 m0, s16, 0x8800
v_mfma_f32_16x16x32_bf16 v[44:47], a[60:63], a[0:3], v[44:47]
buffer_load_dwordx4 v22, s[44:47], s21 offen lds
v_mfma_f32_16x16x32_bf16 v[48:51], a[64:67], a[0:3], v[48:51]
ds_read_b64_tr_b16 a[60:61], v13 offset:8704
v_mfma_f32_16x16x32_bf16 v[80:83], a[64:67], a[4:7], v[80:83]
ds_read_b64_tr_b16 a[62:63], v13 offset:9728
v_mfma_f32_16x16x32_bf16 v[112:115], a[64:67], a[8:11], v[112:115]
v_mfma_f32_16x16x32_bf16 v[144:147], a[64:67], a[12:15], v[144:147]
ds_read_b64_tr_b16 a[64:65], v12 offset:8960
v_mfma_f32_16x16x32_bf16 v[148:151], a[68:71], a[12:15], v[148:151]
ds_read_b64_tr_b16 a[66:67], v12 offset:9984
s_add_u32 m0, s16, 0x8c00
v_mfma_f32_16x16x32_bf16 v[116:119], a[68:71], a[8:11], v[116:119]
buffer_load_dwordx4 v23, s[44:47], s21 offen lds
v_mfma_f32_16x16x32_bf16 v[84:87], a[68:71], a[4:7], v[84:87]
v_mfma_f32_16x16x32_bf16 v[52:55], a[68:71], a[0:3], v[52:55]
ds_read_b64_tr_b16 a[68:69], v13 offset:8960
v_mfma_f32_16x16x32_bf16 v[152:155], a[0:3], a[72:75], v[152:155]
ds_read_b64_tr_b16 a[70:71], v13 offset:9984
v_mfma_f32_16x16x32_bf16 v[156:159], a[4:7], a[72:75], v[156:159]
v_mfma_f32_16x16x32_bf16 v[216:219], a[8:11], a[72:75], v[216:219]
v_mfma_f32_16x16x32_bf16 v[220:223], a[12:15], a[72:75], v[220:223]
ds_read_b64_tr_b16 a[72:73], v12 offset:24576
s_add_u32 m0, s16, 0x9000
v_mfma_f32_16x16x32_bf16 v[228:231], a[12:15], a[76:79], v[228:231]
buffer_load_dwordx4 v22, s[44:47], s22 offen lds
v_mfma_f32_16x16x32_bf16 v[224:227], a[8:11], a[76:79], v[224:227]
ds_read_b64_tr_b16 a[74:75], v12 offset:25600
v_mfma_f32_16x16x32_bf16 v[164:167], a[4:7], a[76:79], v[164:167]
v_mfma_f32_16x16x32_bf16 v[160:163], a[0:3], a[76:79], v[160:163]
ds_read_b64_tr_b16 a[76:77], v13 offset:24576
v_mfma_f32_16x16x32_bf16 v[168:171], a[0:3], a[80:83], v[168:171]
ds_read_b64_tr_b16 a[78:79], v13 offset:25600
v_mfma_f32_16x16x32_bf16 v[172:175], a[4:7], a[80:83], v[172:175]
s_add_u32 m0, s16, 0x9400
v_mfma_f32_16x16x32_bf16 v[232:235], a[8:11], a[80:83], v[232:235]
buffer_load_dwordx4 v23, s[44:47], s22 offen lds
v_mfma_f32_16x16x32_bf16 v[236:239], a[12:15], a[80:83], v[236:239]
ds_read_b64_tr_b16 a[80:81], v12 offset:24832
v_mfma_f32_16x16x32_bf16 v[244:247], a[12:15], a[84:87], v[244:247]
ds_read_b64_tr_b16 a[82:83], v12 offset:25856
v_mfma_f32_16x16x32_bf16 v[240:243], a[8:11], a[84:87], v[240:243]
v_mfma_f32_16x16x32_bf16 v[180:183], a[4:7], a[84:87], v[180:183]
v_mfma_f32_16x16x32_bf16 v[176:179], a[0:3], a[84:87], v[176:179]
ds_read_b64_tr_b16 a[84:85], v13 offset:24832
v_mfma_f32_16x16x32_bf16 v[184:187], a[0:3], a[88:91], v[184:187]
ds_read_b64_tr_b16 a[86:87], v13 offset:25856
s_add_u32 m0, s16, 0x9800
v_mfma_f32_16x16x32_bf16 v[188:191], a[4:7], a[88:91], v[188:191]
buffer_load_dwordx4 v22, s[44:47], s23 offen lds
v_mfma_f32_16x16x32_bf16 v[248:251], a[8:11], a[88:91], v[248:251]
v_mfma_f32_16x16x32_bf16 v[252:255], a[12:15], a[88:91], v[252:255]
ds_read_b64_tr_b16 a[88:89], v12 offset:25088
v_mfma_f32_16x16x32_bf16 a[236:239], a[12:15], a[92:95], a[236:239]
ds_read_b64_tr_b16 a[90:91], v12 offset:26112
v_add_u32 v12, 0x8000, v12
v_mfma_f32_16x16x32_bf16 a[232:235], a[8:11], a[92:95], a[232:235]
v_add_u32 v13, 0x8000, v13
v_mfma_f32_16x16x32_bf16 v[196:199], a[4:7], a[92:95], v[196:199]
s_add_u32 m0, s16, 0x9c00
v_mfma_f32_16x16x32_bf16 v[192:195], a[0:3], a[92:95], v[192:195]
buffer_load_dwordx4 v23, s[44:47], s23 offen lds
v_mfma_f32_16x16x32_bf16 v[200:203], a[0:3], a[96:99], v[200:203]
v_mfma_f32_16x16x32_bf16 v[204:207], a[4:7], a[96:99], v[204:207]
v_mfma_f32_16x16x32_bf16 a[240:243], a[8:11], a[96:99], a[240:243]
v_mfma_f32_16x16x32_bf16 a[244:247], a[12:15], a[96:99], a[244:247]
v_mfma_f32_16x16x32_bf16 a[252:255], a[12:15], a[100:103], a[252:255]
v_mfma_f32_16x16x32_bf16 a[248:251], a[8:11], a[100:103], a[248:251]
v_mfma_f32_16x16x32_bf16 v[212:215], a[4:7], a[100:103], v[212:215]
v_mfma_f32_16x16x32_bf16 v[208:211], a[0:3], a[100:103], v[208:211]
s_waitcnt vmcnt(16) lgkmcnt(0)
s_barrier
v_mfma_f32_16x16x32_bf16 v[24:27], a[40:43], a[20:23], v[24:27]
ds_read_b128 a[0:3], v8 offset:0
s_add_u32 m0, s17, 0x8000
v_mfma_f32_16x16x32_bf16 v[56:59], a[40:43], a[24:27], v[56:59]
buffer_load_dwordx4 v5, s[52:55], 0 offen lds
v_mfma_f32_16x16x32_bf16 v[88:91], a[40:43], a[28:31], v[88:91]
ds_read_b128 a[4:7], v8 offset:2048
v_add_u32 v22, 0x80, v22
v_mfma_f32_16x16x32_bf16 v[120:123], a[40:43], a[32:35], v[120:123]
ds_read_b128 a[8:11], v8 offset:4096
v_add_u32 v23, 0x80, v23
v_mfma_f32_16x16x32_bf16 v[124:127], a[44:47], a[32:35], v[124:127]
ds_read_b128 a[12:15], v8 offset:6144
v_mfma_f32_16x16x32_bf16 v[92:95], a[44:47], a[28:31], v[92:95]
ds_read_b128 a[16:19], v10
v_mfma_f32_16x16x32_bf16 v[60:63], a[44:47], a[24:27], v[60:63]
ds_read_b64_tr_b16 a[92:93], v15 offset:8192
v_mfma_f32_16x16x32_bf16 v[28:31], a[44:47], a[20:23], v[28:31]
ds_read_b64_tr_b16 a[94:95], v15 offset:8448
s_add_u32 m0, s17, 0x8400
v_mfma_f32_16x16x32_bf16 v[32:35], a[48:51], a[20:23], v[32:35]
buffer_load_dwordx4 v5, s[52:55], s13 offen lds
v_mfma_f32_16x16x32_bf16 v[64:67], a[48:51], a[24:27], v[64:67]
ds_read_b64_tr_b16 a[40:41], v12 offset:0
v_mfma_f32_16x16x32_bf16 v[96:99], a[48:51], a[28:31], v[96:99]
ds_read_b64_tr_b16 a[42:43], v12 offset:1024
v_mfma_f32_16x16x32_bf16 v[128:131], a[48:51], a[32:35], v[128:131]
ds_read_b64_tr_b16 a[44:45], v13 offset:0
v_mfma_f32_16x16x32_bf16 v[132:135], a[52:55], a[32:35], v[132:135]
ds_read_b64_tr_b16 a[46:47], v13 offset:1024
v_mfma_f32_16x16x32_bf16 v[100:103], a[52:55], a[28:31], v[100:103]
ds_read_b64_tr_b16 a[48:49], v12 offset:256
v_mfma_f32_16x16x32_bf16 v[68:71], a[52:55], a[24:27], v[68:71]
ds_read_b64_tr_b16 a[50:51], v12 offset:1280
v_mfma_f32_16x16x32_bf16 v[36:39], a[52:55], a[20:23], v[36:39]
ds_read_b64_tr_b16 a[52:53], v13 offset:256
s_add_u32 m0, s17, 0x8800
v_mfma_f32_16x16x32_bf16 v[40:43], a[56:59], a[20:23], v[40:43]
buffer_load_dwordx4 v6, s[52:55], 0 offen lds
v_mfma_f32_16x16x32_bf16 v[72:75], a[56:59], a[24:27], v[72:75]
ds_read_b64_tr_b16 a[54:55], v13 offset:1280
v_mfma_f32_16x16x32_bf16 v[104:107], a[56:59], a[28:31], v[104:107]
v_mfma_f32_16x16x32_bf16 v[136:139], a[56:59], a[32:35], v[136:139]
ds_read_b64_tr_b16 a[56:57], v12 offset:512
v_mfma_f32_16x16x32_bf16 v[140:143], a[60:63], a[32:35], v[140:143]
ds_read_b64_tr_b16 a[58:59], v12 offset:1536
v_mfma_f32_16x16x32_bf16 v[108:111], a[60:63], a[28:31], v[108:111]
v_mfma_f32_16x16x32_bf16 v[76:79], a[60:63], a[24:27], v[76:79]
s_add_u32 m0, s17, 0x8c00
v_mfma_f32_16x16x32_bf16 v[44:47], a[60:63], a[20:23], v[44:47]
buffer_load_dwordx4 v6, s[52:55], s13 offen lds
v_mfma_f32_16x16x32_bf16 v[48:51], a[64:67], a[20:23], v[48:51]
ds_read_b64_tr_b16 a[60:61], v13 offset:512
v_mfma_f32_16x16x32_bf16 v[80:83], a[64:67], a[24:27], v[80:83]
ds_read_b64_tr_b16 a[62:63], v13 offset:1536
v_mfma_f32_16x16x32_bf16 v[112:115], a[64:67], a[28:31], v[112:115]
v_mfma_f32_16x16x32_bf16 v[144:147], a[64:67], a[32:35], v[144:147]
ds_read_b64_tr_b16 a[64:65], v12 offset:768
v_mfma_f32_16x16x32_bf16 v[148:151], a[68:71], a[32:35], v[148:151]
ds_read_b64_tr_b16 a[66:67], v12 offset:1792
v_mfma_f32_16x16x32_bf16 v[116:119], a[68:71], a[28:31], v[116:119]
v_mfma_f32_16x16x32_bf16 v[84:87], a[68:71], a[24:27], v[84:87]
s_add_u32 m0, s18, 0xc000
v_mfma_f32_16x16x32_bf16 v[52:55], a[68:71], a[20:23], v[52:55]
buffer_load_dwordx4 v7, s[68:71], 0 offen lds
v_mfma_f32_16x16x32_bf16 v[152:155], a[20:23], a[72:75], v[152:155]
ds_read_b64_tr_b16 a[68:69], v13 offset:768
v_mfma_f32_16x16x32_bf16 v[156:159], a[24:27], a[72:75], v[156:159]
ds_read_b64_tr_b16 a[70:71], v13 offset:1792
v_mfma_f32_16x16x32_bf16 v[216:219], a[28:31], a[72:75], v[216:219]
v_mfma_f32_16x16x32_bf16 v[220:223], a[32:35], a[72:75], v[220:223]
ds_read_b64_tr_b16 a[72:73], v14 offset:0
v_mfma_f32_16x16x32_bf16 v[228:231], a[32:35], a[76:79], v[228:231]
ds_read_b64_tr_b16 a[74:75], v14 offset:256
v_mfma_f32_16x16x32_bf16 v[224:227], a[28:31], a[76:79], v[224:227]
v_mfma_f32_16x16x32_bf16 v[164:167], a[24:27], a[76:79], v[164:167]
s_add_u32 m0, s18, 0xd000
v_mfma_f32_16x16x32_bf16 v[160:163], a[20:23], a[76:79], v[160:163]
buffer_load_dwordx4 v7, s[68:71], s25 offen lds
v_mfma_f32_16x16x32_bf16 v[168:171], a[20:23], a[80:83], v[168:171]
ds_read_b64_tr_b16 a[76:77], v15 offset:0
v_mfma_f32_16x16x32_bf16 v[172:175], a[24:27], a[80:83], v[172:175]
ds_read_b64_tr_b16 a[78:79], v15 offset:256
v_mfma_f32_16x16x32_bf16 v[232:235], a[28:31], a[80:83], v[232:235]
v_mfma_f32_16x16x32_bf16 v[236:239], a[32:35], a[80:83], v[236:239]
ds_read_b64_tr_b16 a[80:81], v14 offset:4096
v_mfma_f32_16x16x32_bf16 v[244:247], a[32:35], a[84:87], v[244:247]
ds_read_b64_tr_b16 a[82:83], v14 offset:4352
v_mfma_f32_16x16x32_bf16 v[240:243], a[28:31], a[84:87], v[240:243]
s_add_u32 m0, s18, 0xe000
v_mfma_f32_16x16x32_bf16 v[180:183], a[24:27], a[84:87], v[180:183]
buffer_load_dwordx4 v7, s[68:71], s26 offen lds
v_mfma_f32_16x16x32_bf16 v[176:179], a[20:23], a[84:87], v[176:179]
ds_read_b64_tr_b16 a[84:85], v15 offset:4096
v_mfma_f32_16x16x32_bf16 v[184:187], a[20:23], a[88:91], v[184:187]
ds_read_b64_tr_b16 a[86:87], v15 offset:4352
v_mfma_f32_16x16x32_bf16 v[188:191], a[24:27], a[88:91], v[188:191]
v_mfma_f32_16x16x32_bf16 v[248:251], a[28:31], a[88:91], v[248:251]
v_mfma_f32_16x16x32_bf16 v[252:255], a[32:35], a[88:91], v[252:255]
ds_read_b64_tr_b16 a[88:89], v14 offset:8192
v_mfma_f32_16x16x32_bf16 a[236:239], a[32:35], a[104:107], a[236:239]
ds_read_b64_tr_b16 a[90:91], v14 offset:8448
v_mfma_f32_16x16x32_bf16 a[232:235], a[28:31], a[104:107], a[232:235]
s_add_u32 m0, s18, 0xf000
v_mfma_f32_16x16x32_bf16 v[196:199], a[24:27], a[104:107], v[196:199]
buffer_load_dwordx4 v4, s[44:47], s24 offen lds
v_mfma_f32_16x16x32_bf16 v[192:195], a[20:23], a[104:107], v[192:195]
v_mfma_f32_16x16x32_bf16 v[200:203], a[20:23], a[108:111], v[200:203]
v_mfma_f32_16x16x32_bf16 v[204:207], a[24:27], a[108:111], v[204:207]
v_mfma_f32_16x16x32_bf16 a[240:243], a[28:31], a[108:111], a[240:243]
v_mfma_f32_16x16x32_bf16 a[244:247], a[32:35], a[108:111], a[244:247]
v_mfma_f32_16x16x32_bf16 a[252:255], a[32:35], a[112:115], a[252:255]
v_mfma_f32_16x16x32_bf16 a[248:251], a[28:31], a[112:115], a[248:251]
v_mfma_f32_16x16x32_bf16 v[212:215], a[24:27], a[112:115], v[212:215]
v_mfma_f32_16x16x32_bf16 v[208:211], a[20:23], a[112:115], v[208:211]
s_mul_i32 s28, s5, 0x108000
s_mov_b32 s48, s88
s_mov_b32 s49, s89
s_sub_u32 s9, 16, s6
s_lshl_b32 s9, s9, 16
s_add_u32 s9, s9, s28
s_add_u32 s50, s9, 0x2000
s_lshl_b32 s9, s6, 17
s_add_u32 s28, s28, s9
s_lshl_b32 s9, s4, 15
s_add_u32 s28, s28, s9
v_cvt_pk_bf16_f32 v24, v24, v25
v_cvt_pk_bf16_f32 v25, v26, v27
v_cvt_pk_bf16_f32 v26, v28, v29
v_cvt_pk_bf16_f32 v27, v30, v31
v_accvgpr_write_b32 a128, v24
v_accvgpr_write_b32 a129, v25
v_accvgpr_write_b32 a130, v26
v_accvgpr_write_b32 a131, v27
v_cvt_pk_bf16_f32 v32, v32, v33
v_cvt_pk_bf16_f32 v33, v34, v35
v_cvt_pk_bf16_f32 v34, v36, v37
v_cvt_pk_bf16_f32 v35, v38, v39
v_accvgpr_write_b32 a132, v32
v_accvgpr_write_b32 a133, v33
v_accvgpr_write_b32 a134, v34
v_accvgpr_write_b32 a135, v35
v_cvt_pk_bf16_f32 v40, v40, v41
v_cvt_pk_bf16_f32 v41, v42, v43
v_cvt_pk_bf16_f32 v42, v44, v45
v_cvt_pk_bf16_f32 v43, v46, v47
v_accvgpr_write_b32 a136, v40
v_accvgpr_write_b32 a137, v41
v_accvgpr_write_b32 a138, v42
v_accvgpr_write_b32 a139, v43
v_cvt_pk_bf16_f32 v48, v48, v49
v_cvt_pk_bf16_f32 v49, v50, v51
v_cvt_pk_bf16_f32 v50, v52, v53
v_cvt_pk_bf16_f32 v51, v54, v55
v_accvgpr_write_b32 a140, v48
v_accvgpr_write_b32 a141, v49
v_accvgpr_write_b32 a142, v50
v_accvgpr_write_b32 a143, v51
v_cvt_pk_bf16_f32 v56, v56, v57
v_cvt_pk_bf16_f32 v57, v58, v59
v_cvt_pk_bf16_f32 v58, v60, v61
v_cvt_pk_bf16_f32 v59, v62, v63
v_accvgpr_write_b32 a144, v56
v_accvgpr_write_b32 a145, v57
v_accvgpr_write_b32 a146, v58
v_accvgpr_write_b32 a147, v59
v_cvt_pk_bf16_f32 v64, v64, v65
v_cvt_pk_bf16_f32 v65, v66, v67
v_cvt_pk_bf16_f32 v66, v68, v69
v_cvt_pk_bf16_f32 v67, v70, v71
v_accvgpr_write_b32 a148, v64
v_accvgpr_write_b32 a149, v65
v_accvgpr_write_b32 a150, v66
v_accvgpr_write_b32 a151, v67
v_cvt_pk_bf16_f32 v72, v72, v73
v_cvt_pk_bf16_f32 v73, v74, v75
v_cvt_pk_bf16_f32 v74, v76, v77
v_cvt_pk_bf16_f32 v75, v78, v79
v_accvgpr_write_b32 a152, v72
v_accvgpr_write_b32 a153, v73
v_accvgpr_write_b32 a154, v74
v_accvgpr_write_b32 a155, v75
v_cvt_pk_bf16_f32 v80, v80, v81
v_cvt_pk_bf16_f32 v81, v82, v83
v_cvt_pk_bf16_f32 v82, v84, v85
v_cvt_pk_bf16_f32 v83, v86, v87
v_accvgpr_write_b32 a156, v80
v_accvgpr_write_b32 a157, v81
v_accvgpr_write_b32 a158, v82
v_accvgpr_write_b32 a159, v83
v_cvt_pk_bf16_f32 v88, v88, v89
v_cvt_pk_bf16_f32 v89, v90, v91
v_cvt_pk_bf16_f32 v90, v92, v93
v_cvt_pk_bf16_f32 v91, v94, v95
v_accvgpr_write_b32 a160, v88
v_accvgpr_write_b32 a161, v89
v_accvgpr_write_b32 a162, v90
v_accvgpr_write_b32 a163, v91
v_cvt_pk_bf16_f32 v96, v96, v97
v_cvt_pk_bf16_f32 v97, v98, v99
v_cvt_pk_bf16_f32 v98, v100, v101
v_cvt_pk_bf16_f32 v99, v102, v103
v_accvgpr_write_b32 a164, v96
v_accvgpr_write_b32 a165, v97
v_accvgpr_write_b32 a166, v98
v_accvgpr_write_b32 a167, v99
v_cvt_pk_bf16_f32 v104, v104, v105
v_cvt_pk_bf16_f32 v105, v106, v107
v_cvt_pk_bf16_f32 v106, v108, v109
v_cvt_pk_bf16_f32 v107, v110, v111
v_accvgpr_write_b32 a168, v104
v_accvgpr_write_b32 a169, v105
v_accvgpr_write_b32 a170, v106
v_accvgpr_write_b32 a171, v107
v_cvt_pk_bf16_f32 v112, v112, v113
v_cvt_pk_bf16_f32 v113, v114, v115
v_cvt_pk_bf16_f32 v114, v116, v117
v_cvt_pk_bf16_f32 v115, v118, v119
v_accvgpr_write_b32 a172, v112
v_accvgpr_write_b32 a173, v113
v_accvgpr_write_b32 a174, v114
v_accvgpr_write_b32 a175, v115
v_cvt_pk_bf16_f32 v120, v120, v121
v_cvt_pk_bf16_f32 v121, v122, v123
v_cvt_pk_bf16_f32 v122, v124, v125
v_cvt_pk_bf16_f32 v123, v126, v127
v_accvgpr_write_b32 a176, v120
v_accvgpr_write_b32 a177, v121
v_accvgpr_write_b32 a178, v122
v_accvgpr_write_b32 a179, v123
v_cvt_pk_bf16_f32 v128, v128, v129
v_cvt_pk_bf16_f32 v129, v130, v131
v_cvt_pk_bf16_f32 v130, v132, v133
v_cvt_pk_bf16_f32 v131, v134, v135
v_accvgpr_write_b32 a180, v128
v_accvgpr_write_b32 a181, v129
v_accvgpr_write_b32 a182, v130
v_accvgpr_write_b32 a183, v131
v_cvt_pk_bf16_f32 v136, v136, v137
v_cvt_pk_bf16_f32 v137, v138, v139
v_cvt_pk_bf16_f32 v138, v140, v141
v_cvt_pk_bf16_f32 v139, v142, v143
v_accvgpr_write_b32 a184, v136
v_accvgpr_write_b32 a185, v137
v_accvgpr_write_b32 a186, v138
v_accvgpr_write_b32 a187, v139
v_cvt_pk_bf16_f32 v144, v144, v145
v_cvt_pk_bf16_f32 v145, v146, v147
v_cvt_pk_bf16_f32 v146, v148, v149
v_cvt_pk_bf16_f32 v147, v150, v151
v_accvgpr_write_b32 a188, v144
v_accvgpr_write_b32 a189, v145
v_accvgpr_write_b32 a190, v146
v_accvgpr_write_b32 a191, v147
v_accvgpr_read_b32 v24, a232
v_accvgpr_read_b32 v25, a233
v_accvgpr_read_b32 v26, a234
v_accvgpr_read_b32 v27, a235
v_accvgpr_read_b32 v28, a236
v_accvgpr_read_b32 v29, a237
v_accvgpr_read_b32 v30, a238
v_accvgpr_read_b32 v31, a239
v_accvgpr_read_b32 v32, a240
v_accvgpr_read_b32 v33, a241
v_accvgpr_read_b32 v34, a242
v_accvgpr_read_b32 v35, a243
v_accvgpr_read_b32 v36, a244
v_accvgpr_read_b32 v37, a245
v_accvgpr_read_b32 v38, a246
v_accvgpr_read_b32 v39, a247
v_accvgpr_read_b32 v40, a248
v_accvgpr_read_b32 v41, a249
v_accvgpr_read_b32 v42, a250
v_accvgpr_read_b32 v43, a251
v_accvgpr_read_b32 v44, a252
v_accvgpr_read_b32 v45, a253
v_accvgpr_read_b32 v46, a254
v_accvgpr_read_b32 v47, a255
v_cvt_pk_bf16_f32 v152, v152, v153
v_cvt_pk_bf16_f32 v153, v154, v155
v_cvt_pk_bf16_f32 v154, v156, v157
v_cvt_pk_bf16_f32 v155, v158, v159
v_accvgpr_write_b32 a192, v152
v_accvgpr_write_b32 a193, v153
v_accvgpr_write_b32 a194, v154
v_accvgpr_write_b32 a195, v155
v_cvt_pk_bf16_f32 v160, v160, v161
v_cvt_pk_bf16_f32 v161, v162, v163
v_cvt_pk_bf16_f32 v162, v164, v165
v_cvt_pk_bf16_f32 v163, v166, v167
v_accvgpr_write_b32 a196, v160
v_accvgpr_write_b32 a197, v161
v_accvgpr_write_b32 a198, v162
v_accvgpr_write_b32 a199, v163
v_cvt_pk_bf16_f32 v168, v168, v169
v_cvt_pk_bf16_f32 v169, v170, v171
v_cvt_pk_bf16_f32 v170, v172, v173
v_cvt_pk_bf16_f32 v171, v174, v175
v_accvgpr_write_b32 a200, v168
v_accvgpr_write_b32 a201, v169
v_accvgpr_write_b32 a202, v170
v_accvgpr_write_b32 a203, v171
v_cvt_pk_bf16_f32 v176, v176, v177
v_cvt_pk_bf16_f32 v177, v178, v179
v_cvt_pk_bf16_f32 v178, v180, v181
v_cvt_pk_bf16_f32 v179, v182, v183
v_accvgpr_write_b32 a204, v176
v_accvgpr_write_b32 a205, v177
v_accvgpr_write_b32 a206, v178
v_accvgpr_write_b32 a207, v179
v_cvt_pk_bf16_f32 v184, v184, v185
v_cvt_pk_bf16_f32 v185, v186, v187
v_cvt_pk_bf16_f32 v186, v188, v189
v_cvt_pk_bf16_f32 v187, v190, v191
v_accvgpr_write_b32 a208, v184
v_accvgpr_write_b32 a209, v185
v_accvgpr_write_b32 a210, v186
v_accvgpr_write_b32 a211, v187
v_cvt_pk_bf16_f32 v192, v192, v193
v_cvt_pk_bf16_f32 v193, v194, v195
v_cvt_pk_bf16_f32 v194, v196, v197
v_cvt_pk_bf16_f32 v195, v198, v199
v_accvgpr_write_b32 a212, v192
v_accvgpr_write_b32 a213, v193
v_accvgpr_write_b32 a214, v194
v_accvgpr_write_b32 a215, v195
v_cvt_pk_bf16_f32 v200, v200, v201
v_cvt_pk_bf16_f32 v201, v202, v203
v_cvt_pk_bf16_f32 v202, v204, v205
v_cvt_pk_bf16_f32 v203, v206, v207
v_accvgpr_write_b32 a216, v200
v_accvgpr_write_b32 a217, v201
v_accvgpr_write_b32 a218, v202
v_accvgpr_write_b32 a219, v203
v_cvt_pk_bf16_f32 v208, v208, v209
v_cvt_pk_bf16_f32 v209, v210, v211
v_cvt_pk_bf16_f32 v210, v212, v213
v_cvt_pk_bf16_f32 v211, v214, v215
v_accvgpr_write_b32 a220, v208
v_accvgpr_write_b32 a221, v209
v_accvgpr_write_b32 a222, v210
v_accvgpr_write_b32 a223, v211
v_cvt_pk_bf16_f32 v216, v216, v217
v_cvt_pk_bf16_f32 v217, v218, v219
v_cvt_pk_bf16_f32 v218, v220, v221
v_cvt_pk_bf16_f32 v219, v222, v223
v_accvgpr_write_b32 a224, v216
v_accvgpr_write_b32 a225, v217
v_accvgpr_write_b32 a226, v218
v_accvgpr_write_b32 a227, v219
v_cvt_pk_bf16_f32 v224, v224, v225
v_cvt_pk_bf16_f32 v225, v226, v227
v_cvt_pk_bf16_f32 v226, v228, v229
v_cvt_pk_bf16_f32 v227, v230, v231
v_accvgpr_write_b32 a228, v224
v_accvgpr_write_b32 a229, v225
v_accvgpr_write_b32 a230, v226
v_accvgpr_write_b32 a231, v227
v_cvt_pk_bf16_f32 v232, v232, v233
v_cvt_pk_bf16_f32 v233, v234, v235
v_cvt_pk_bf16_f32 v234, v236, v237
v_cvt_pk_bf16_f32 v235, v238, v239
v_accvgpr_write_b32 a232, v232
v_accvgpr_write_b32 a233, v233
v_accvgpr_write_b32 a234, v234
v_accvgpr_write_b32 a235, v235
v_cvt_pk_bf16_f32 v240, v240, v241
v_cvt_pk_bf16_f32 v241, v242, v243
v_cvt_pk_bf16_f32 v242, v244, v245
v_cvt_pk_bf16_f32 v243, v246, v247
v_accvgpr_write_b32 a236, v240
v_accvgpr_write_b32 a237, v241
v_accvgpr_write_b32 a238, v242
v_accvgpr_write_b32 a239, v243
v_cvt_pk_bf16_f32 v248, v248, v249
v_cvt_pk_bf16_f32 v249, v250, v251
v_cvt_pk_bf16_f32 v250, v252, v253
v_cvt_pk_bf16_f32 v251, v254, v255
v_accvgpr_write_b32 a240, v248
v_accvgpr_write_b32 a241, v249
v_accvgpr_write_b32 a242, v250
v_accvgpr_write_b32 a243, v251
v_cvt_pk_bf16_f32 v24, v24, v25
v_cvt_pk_bf16_f32 v25, v26, v27
v_cvt_pk_bf16_f32 v26, v28, v29
v_cvt_pk_bf16_f32 v27, v30, v31
v_accvgpr_write_b32 a244, v24
v_accvgpr_write_b32 a245, v25
v_accvgpr_write_b32 a246, v26
v_accvgpr_write_b32 a247, v27
v_cvt_pk_bf16_f32 v32, v32, v33
v_cvt_pk_bf16_f32 v33, v34, v35
v_cvt_pk_bf16_f32 v34, v36, v37
v_cvt_pk_bf16_f32 v35, v38, v39
v_accvgpr_write_b32 a248, v32
v_accvgpr_write_b32 a249, v33
v_accvgpr_write_b32 a250, v34
v_accvgpr_write_b32 a251, v35
v_cvt_pk_bf16_f32 v40, v40, v41
v_cvt_pk_bf16_f32 v41, v42, v43
v_cvt_pk_bf16_f32 v42, v44, v45
v_cvt_pk_bf16_f32 v43, v46, v47
v_accvgpr_write_b32 a252, v40
v_accvgpr_write_b32 a253, v41
v_accvgpr_write_b32 a254, v42
v_accvgpr_write_b32 a255, v43
s_waitcnt lgkmcnt(0)
v_mfma_f32_16x16x32_bf16 v[24:27], a[40:43], a[0:3], 0
ds_read_b128 a[20:23], v9 offset:0
v_add_u32 v5, 0x80000, v5
v_mfma_f32_16x16x32_bf16 v[56:59], a[40:43], a[4:7], 0
ds_read_b128 a[24:27], v9 offset:2048
v_add_u32 v6, 0x80000, v6
v_mfma_f32_16x16x32_bf16 v[88:91], a[40:43], a[8:11], 0
ds_read_b128 a[28:31], v9 offset:4096
v_add_u32 v7, 0x60000, v7
v_mfma_f32_16x16x32_bf16 v[120:123], a[40:43], a[12:15], 0
ds_read_b128 a[32:35], v9 offset:6144
v_add_u32 v4, 0x80, v4
v_mfma_f32_16x16x32_bf16 v[124:127], a[44:47], a[12:15], 0
ds_read_b128 a[36:39], v11
v_mfma_f32_16x16x32_bf16 v[92:95], a[44:47], a[8:11], 0
ds_read_b64_tr_b16 a[104:105], v15 offset:6144
v_mfma_f32_16x16x32_bf16 v[60:63], a[44:47], a[4:7], 0
ds_read_b64_tr_b16 a[106:107], v15 offset:6400
v_mfma_f32_16x16x32_bf16 v[28:31], a[44:47], a[0:3], 0
ds_read_b64_tr_b16 a[108:109], v14 offset:10240
v_mfma_f32_16x16x32_bf16 v[32:35], a[48:51], a[0:3], 0
ds_read_b64_tr_b16 a[110:111], v14 offset:10496
s_waitcnt lgkmcnt(5)
v_mfma_f32_16x16x32_bf16 v[64:67], a[48:51], a[4:7], 0
ds_read_b64_tr_b16 a[112:113], v15 offset:10240
s_add_u32 m0, s16, 0x0
v_mfma_f32_16x16x32_bf16 v[96:99], a[48:51], a[8:11], 0
buffer_load_dwordx4 v22, s[44:47], s20 offen lds
v_mfma_f32_16x16x32_bf16 v[128:131], a[48:51], a[12:15], 0
ds_read_b64_tr_b16 a[114:115], v15 offset:10496
v_mfma_f32_16x16x32_bf16 v[132:135], a[52:55], a[12:15], 0
ds_read_b64_tr_b16 a[40:41], v12 offset:8192
v_mfma_f32_16x16x32_bf16 v[100:103], a[52:55], a[8:11], 0
ds_read_b64_tr_b16 a[42:43], v12 offset:9216
s_add_u32 m0, s16, 0x400
v_mfma_f32_16x16x32_bf16 v[68:71], a[52:55], a[4:7], 0
buffer_load_dwordx4 v23, s[44:47], s20 offen lds
v_mfma_f32_16x16x32_bf16 v[36:39], a[52:55], a[0:3], 0
ds_read_b64_tr_b16 a[44:45], v13 offset:8192
v_mfma_f32_16x16x32_bf16 v[40:43], a[56:59], a[0:3], 0
ds_read_b64_tr_b16 a[46:47], v13 offset:9216
v_mfma_f32_16x16x32_bf16 v[72:75], a[56:59], a[4:7], 0
ds_read_b64_tr_b16 a[48:49], v12 offset:8448
v_mfma_f32_16x16x32_bf16 v[104:107], a[56:59], a[8:11], 0
ds_read_b64_tr_b16 a[50:51], v12 offset:9472
s_add_u32 m0, s16, 0x800
v_mfma_f32_16x16x32_bf16 v[136:139], a[56:59], a[12:15], 0
buffer_load_dwordx4 v22, s[44:47], s21 offen lds
v_mfma_f32_16x16x32_bf16 v[140:143], a[60:63], a[12:15], 0
ds_read_b64_tr_b16 a[52:53], v13 offset:8448
v_mfma_f32_16x16x32_bf16 v[108:111], a[60:63], a[8:11], 0
ds_read_b64_tr_b16 a[54:55], v13 offset:9472
v_mfma_f32_16x16x32_bf16 v[76:79], a[60:63], a[4:7], 0
ds_read_b64_tr_b16 a[56:57], v12 offset:8704
s_add_u32 m0, s16, 0xc00
v_mfma_f32_16x16x32_bf16 v[44:47], a[60:63], a[0:3], 0
buffer_load_dwordx4 v23, s[44:47], s21 offen lds
v_mfma_f32_16x16x32_bf16 v[48:51], a[64:67], a[0:3], 0
ds_read_b64_tr_b16 a[58:59], v12 offset:9728
v_mfma_f32_16x16x32_bf16 v[80:83], a[64:67], a[4:7], 0
ds_read_b64_tr_b16 a[60:61], v13 offset:8704
v_mfma_f32_16x16x32_bf16 v[112:115], a[64:67], a[8:11], 0
ds_read_b64_tr_b16 a[62:63], v13 offset:9728
v_mfma_f32_16x16x32_bf16 v[144:147], a[64:67], a[12:15], 0
ds_read_b64_tr_b16 a[64:65], v12 offset:8960
s_add_u32 s8, s28, 0x2000
v_mfma_f32_16x16x32_bf16 v[148:151], a[68:71], a[12:15], 0
buffer_store_dwordx4 a[128:131], v16, s[88:91], s8 offen sc1
v_mfma_f32_16x16x32_bf16 v[116:119], a[68:71], a[8:11], 0
ds_read_b64_tr_b16 a[66:67], v12 offset:9984
v_mfma_f32_16x16x32_bf16 v[84:87], a[68:71], a[4:7], 0
v_mfma_f32_16x16x32_bf16 v[52:55], a[68:71], a[0:3], 0
ds_read_b64_tr_b16 a[68:69], v13 offset:8960
v_mfma_f32_16x16x32_bf16 v[152:155], a[72:75], a[0:3], 0
ds_read_b64_tr_b16 a[70:71], v13 offset:9984
s_add_u32 m0, s16, 0x1000
v_mfma_f32_16x16x32_bf16 v[160:163], a[72:75], a[4:7], 0
buffer_load_dwordx4 v22, s[44:47], s22 offen lds
v_mfma_f32_16x16x32_bf16 v[168:171], a[72:75], a[8:11], 0
v_mfma_f32_16x16x32_bf16 v[176:179], a[72:75], a[12:15], 0
ds_read_b64_tr_b16 a[72:73], v14 offset:2048
v_mfma_f32_16x16x32_bf16 v[180:183], a[76:79], a[12:15], 0
ds_read_b64_tr_b16 a[74:75], v14 offset:2304
s_add_u32 m0, s16, 0x1400
v_mfma_f32_16x16x32_bf16 v[172:175], a[76:79], a[8:11], 0
buffer_load_dwordx4 v23, s[44:47], s22 offen lds
v_mfma_f32_16x16x32_bf16 v[164:167], a[76:79], a[4:7], 0
v_mfma_f32_16x16x32_bf16 v[156:159], a[76:79], a[0:3], 0
ds_read_b64_tr_b16 a[76:77], v15 offset:2048
v_mfma_f32_16x16x32_bf16 v[184:187], a[80:83], a[0:3], 0
ds_read_b64_tr_b16 a[78:79], v15 offset:2304
v_mfma_f32_16x16x32_bf16 v[192:195], a[80:83], a[4:7], 0
s_add_u32 m0, s16, 0x1800
v_mfma_f32_16x16x32_bf16 v[200:203], a[80:83], a[8:11], 0
buffer_load_dwordx4 v22, s[44:47], s23 offen lds
v_mfma_f32_16x16x32_bf16 v[208:211], a[80:83], a[12:15], 0
v_mfma_f32_16x16x32_bf16 v[248:251], a[80:83], a[16:19], 0
ds_read_b64_tr_b16 a[80:81], v14 offset:6144
v_mfma_f32_16x16x32_bf16 v[212:215], a[84:87], a[12:15], 0
ds_read_b64_tr_b16 a[82:83], v14 offset:6400
s_add_u32 m0, s16, 0x1c00
v_mfma_f32_16x16x32_bf16 v[204:207], a[84:87], a[8:11], 0
buffer_load_dwordx4 v23, s[44:47], s23 offen lds
v_mfma_f32_16x16x32_bf16 v[196:199], a[84:87], a[4:7], 0
v_add_u32 v12, 0xffff0000, v12
v_add_u32 v13, 0xffff0000, v13
v_mfma_f32_16x16x32_bf16 v[188:191], a[84:87], a[0:3], 0
v_add_u32 v14, 0xffff0000, v14
v_add_u32 v15, 0xffff0000, v15
v_mfma_f32_16x16x32_bf16 v[216:219], a[0:3], a[88:91], 0
v_add_u32 v10, 0xffff0000, v10
v_add_u32 v11, 0xffff0000, v11
v_mfma_f32_16x16x32_bf16 v[224:227], a[4:7], a[88:91], 0
s_add_u32 s8, s28, 0x2400
v_mfma_f32_16x16x32_bf16 v[232:235], a[8:11], a[88:91], 0
buffer_store_dwordx4 a[132:135], v16, s[88:91], s8 offen sc1
v_mfma_f32_16x16x32_bf16 v[240:243], a[12:15], a[88:91], 0
v_mfma_f32_16x16x32_bf16 v[252:255], a[16:19], a[88:91], 0
v_mfma_f32_16x16x32_bf16 v[244:247], a[12:15], a[92:95], 0
v_mfma_f32_16x16x32_bf16 v[236:239], a[8:11], a[92:95], 0
v_mfma_f32_16x16x32_bf16 v[228:231], a[4:7], a[92:95], 0
v_mfma_f32_16x16x32_bf16 v[220:223], a[0:3], a[92:95], 0
s_waitcnt vmcnt(18) lgkmcnt(0)
s_barrier
v_mfma_f32_16x16x32_bf16 v[24:27], a[40:43], a[20:23], v[24:27]
ds_read_b128 a[0:3], v8 offset:32768
s_add_u32 m0, s17, 0x10000
v_mfma_f32_16x16x32_bf16 v[56:59], a[40:43], a[24:27], v[56:59]
buffer_load_dwordx4 v5, s[52:55], 0 offen lds
v_mfma_f32_16x16x32_bf16 v[88:91], a[40:43], a[28:31], v[88:91]
ds_read_b128 a[4:7], v8 offset:34816
v_add_u32 v22, 0x80, v22
v_mfma_f32_16x16x32_bf16 v[120:123], a[40:43], a[32:35], v[120:123]
ds_read_b128 a[8:11], v8 offset:36864
v_add_u32 v23, 0x80, v23
v_mfma_f32_16x16x32_bf16 v[124:127], a[44:47], a[32:35], v[124:127]
ds_read_b128 a[12:15], v8 offset:38912
v_mfma_f32_16x16x32_bf16 v[92:95], a[44:47], a[28:31], v[92:95]
ds_read_b128 a[16:19], v10
s_add_u32 m0, s17, 0x10400
v_mfma_f32_16x16x32_bf16 v[60:63], a[44:47], a[24:27], v[60:63]
buffer_load_dwordx4 v5, s[52:55], s13 offen lds
v_mfma_f32_16x16x32_bf16 v[28:31], a[44:47], a[20:23], v[28:31]
ds_read_b64_tr_b16 a[84:85], v15 offset:4096
v_mfma_f32_16x16x32_bf16 v[32:35], a[48:51], a[20:23], v[32:35]
ds_read_b64_tr_b16 a[86:87], v15 offset:4352
v_mfma_f32_16x16x32_bf16 v[64:67], a[48:51], a[24:27], v[64:67]
ds_read_b64_tr_b16 a[88:89], v14 offset:8192
v_mfma_f32_16x16x32_bf16 v[96:99], a[48:51], a[28:31], v[96:99]
ds_read_b64_tr_b16 a[90:91], v14 offset:8448
v_mfma_f32_16x16x32_bf16 v[128:131], a[48:51], a[32:35], v[128:131]
ds_read_b64_tr_b16 a[92:93], v15 offset:8192
s_add_u32 m0, s17, 0x10800
v_mfma_f32_16x16x32_bf16 v[132:135], a[52:55], a[32:35], v[132:135]
buffer_load_dwordx4 v6, s[52:55], 0 offen lds
v_mfma_f32_16x16x32_bf16 v[100:103], a[52:55], a[28:31], v[100:103]
ds_read_b64_tr_b16 a[94:95], v15 offset:8448
v_mfma_f32_16x16x32_bf16 v[68:71], a[52:55], a[24:27], v[68:71]
ds_read_b64_tr_b16 a[40:41], v12 offset:0
v_mfma_f32_16x16x32_bf16 v[36:39], a[52:55], a[20:23], v[36:39]
ds_read_b64_tr_b16 a[42:43], v12 offset:1024
v_mfma_f32_16x16x32_bf16 v[40:43], a[56:59], a[20:23], v[40:43]
ds_read_b64_tr_b16 a[44:45], v13 offset:0
s_add_u32 m0, s17, 0x10c00
v_mfma_f32_16x16x32_bf16 v[72:75], a[56:59], a[24:27], v[72:75]
buffer_load_dwordx4 v6, s[52:55], s13 offen lds
v_mfma_f32_16x16x32_bf16 v[104:107], a[56:59], a[28:31], v[104:107]
ds_read_b64_tr_b16 a[46:47], v13 offset:1024
v_mfma_f32_16x16x32_bf16 v[136:139], a[56:59], a[32:35], v[136:139]
ds_read_b64_tr_b16 a[48:49], v12 offset:256
v_mfma_f32_16x16x32_bf16 v[140:143], a[60:63], a[32:35], v[140:143]
ds_read_b64_tr_b16 a[50:51], v12 offset:1280
v_mfma_f32_16x16x32_bf16 v[108:111], a[60:63], a[28:31], v[108:111]
ds_read_b64_tr_b16 a[52:53], v13 offset:256
v_mfma_f32_16x16x32_bf16 v[76:79], a[60:63], a[24:27], v[76:79]
ds_read_b64_tr_b16 a[54:55], v13 offset:1280
s_add_u32 s8, s28, 0x2800
v_mfma_f32_16x16x32_bf16 v[44:47], a[60:63], a[20:23], v[44:47]
buffer_store_dwordx4 a[136:139], v16, s[88:91], s8 offen sc1
v_mfma_f32_16x16x32_bf16 v[48:51], a[64:67], a[20:23], v[48:51]
ds_read_b64_tr_b16 a[56:57], v12 offset:512
v_mfma_f32_16x16x32_bf16 v[80:83], a[64:67], a[24:27], v[80:83]
ds_read_b64_tr_b16 a[58:59], v12 offset:1536
v_mfma_f32_16x16x32_bf16 v[112:115], a[64:67], a[28:31], v[112:115]
ds_read_b64_tr_b16 a[60:61], v13 offset:512
v_mfma_f32_16x16x32_bf16 v[144:147], a[64:67], a[32:35], v[144:147]
ds_read_b64_tr_b16 a[62:63], v13 offset:1536
s_add_u32 m0, s18, 0x14000
v_mfma_f32_16x16x32_bf16 v[148:151], a[68:71], a[32:35], v[148:151]
buffer_load_dwordx4 v7, s[68:71], 0 offen lds
v_mfma_f32_16x16x32_bf16 v[116:119], a[68:71], a[28:31], v[116:119]
ds_read_b64_tr_b16 a[64:65], v12 offset:768
v_mfma_f32_16x16x32_bf16 v[84:87], a[68:71], a[24:27], v[84:87]
ds_read_b64_tr_b16 a[66:67], v12 offset:1792
v_mfma_f32_16x16x32_bf16 v[52:55], a[68:71], a[20:23], v[52:55]
ds_read_b64_tr_b16 a[68:69], v13 offset:768
v_mfma_f32_16x16x32_bf16 v[152:155], a[72:75], a[20:23], v[152:155]
ds_read_b64_tr_b16 a[70:71], v13 offset:1792
v_mfma_f32_16x16x32_bf16 v[160:163], a[72:75], a[24:27], v[160:163]
s_add_u32 m0, s18, 0x15000
v_mfma_f32_16x16x32_bf16 v[168:171], a[72:75], a[28:31], v[168:171]
buffer_load_dwordx4 v7, s[68:71], s25 offen lds
v_mfma_f32_16x16x32_bf16 v[176:179], a[72:75], a[32:35], v[176:179]
ds_read_b64_tr_b16 a[72:73], v14 offset:0
v_mfma_f32_16x16x32_bf16 v[180:183], a[76:79], a[32:35], v[180:183]
ds_read_b64_tr_b16 a[74:75], v14 offset:256
v_mfma_f32_16x16x32_bf16 v[172:175], a[76:79], a[28:31], v[172:175]
v_mfma_f32_16x16x32_bf16 v[164:167], a[76:79], a[24:27], v[164:167]
s_add_u32 m0, s18, 0x16000
v_mfma_f32_16x16x32_bf16 v[156:159], a[76:79], a[20:23], v[156:159]
buffer_load_dwordx4 v7, s[68:71], s26 offen lds
v_mfma_f32_16x16x32_bf16 v[184:187], a[80:83], a[20:23], v[184:187]
ds_read_b64_tr_b16 a[76:77], v15 offset:0
v_mfma_f32_16x16x32_bf16 v[192:195], a[80:83], a[24:27], v[192:195]
ds_read_b64_tr_b16 a[78:79], v15 offset:256
v_mfma_f32_16x16x32_bf16 v[200:203], a[80:83], a[28:31], v[200:203]
v_mfma_f32_16x16x32_bf16 v[208:211], a[80:83], a[32:35], v[208:211]
v_mfma_f32_16x16x32_bf16 v[248:251], a[80:83], a[36:39], v[248:251]
ds_read_b64_tr_b16 a[80:81], v14 offset:4096
s_add_u32 m0, s18, 0x17000
v_mfma_f32_16x16x32_bf16 v[212:215], a[104:107], a[32:35], v[212:215]
buffer_load_dwordx4 v4, s[44:47], s24 offen lds
v_mfma_f32_16x16x32_bf16 v[204:207], a[104:107], a[28:31], v[204:207]
ds_read_b64_tr_b16 a[82:83], v14 offset:4352
v_mfma_f32_16x16x32_bf16 v[196:199], a[104:107], a[24:27], v[196:199]
v_mfma_f32_16x16x32_bf16 v[188:191], a[104:107], a[20:23], v[188:191]
v_mfma_f32_16x16x32_bf16 v[216:219], a[20:23], a[108:111], v[216:219]
s_add_u32 s8, s28, 0x2c00
v_mfma_f32_16x16x32_bf16 v[224:227], a[24:27], a[108:111], v[224:227]
buffer_store_dwordx4 a[140:143], v16, s[88:91], s8 offen sc1
v_mfma_f32_16x16x32_bf16 v[232:235], a[28:31], a[108:111], v[232:235]
v_mfma_f32_16x16x32_bf16 v[240:243], a[32:35], a[108:111], v[240:243]
v_mfma_f32_16x16x32_bf16 v[252:255], a[36:39], a[108:111], v[252:255]
v_mfma_f32_16x16x32_bf16 v[244:247], a[32:35], a[112:115], v[244:247]
v_mfma_f32_16x16x32_bf16 v[236:239], a[28:31], a[112:115], v[236:239]
v_mfma_f32_16x16x32_bf16 v[228:231], a[24:27], a[112:115], v[228:231]
v_mfma_f32_16x16x32_bf16 v[220:223], a[20:23], a[112:115], v[220:223]
s_waitcnt lgkmcnt(0)
v_mfma_f32_16x16x32_bf16 v[24:27], a[40:43], a[0:3], v[24:27]
ds_read_b128 a[20:23], v9 offset:32768
v_add_u32 v5, 0x80000, v5
v_mfma_f32_16x16x32_bf16 v[56:59], a[40:43], a[4:7], v[56:59]
ds_read_b128 a[24:27], v9 offset:34816
v_add_u32 v6, 0x80000, v6
v_mfma_f32_16x16x32_bf16 v[88:91], a[40:43], a[8:11], v[88:91]
ds_read_b128 a[28:31], v9 offset:36864
v_add_u32 v7, 0x60000, v7
v_mfma_f32_16x16x32_bf16 v[120:123], a[40:43], a[12:15], v[120:123]
ds_read_b128 a[32:35], v9 offset:38912
v_add_u32 v4, 0x80, v4
v_mfma_f32_16x16x32_bf16 v[124:127], a[44:47], a[12:15], v[124:127]
ds_read_b128 a[36:39], v11
v_mfma_f32_16x16x32_bf16 v[92:95], a[44:47], a[8:11], v[92:95]
ds_read_b64_tr_b16 a[104:105], v15 offset:6144
v_mfma_f32_16x16x32_bf16 v[60:63], a[44:47], a[4:7], v[60:63]
ds_read_b64_tr_b16 a[106:107], v15 offset:6400
v_mfma_f32_16x16x32_bf16 v[28:31], a[44:47], a[0:3], v[28:31]
ds_read_b64_tr_b16 a[108:109], v14 offset:10240
v_mfma_f32_16x16x32_bf16 v[32:35], a[48:51], a[0:3], v[32:35]
ds_read_b64_tr_b16 a[110:111], v14 offset:10496
s_waitcnt lgkmcnt(5)
v_mfma_f32_16x16x32_bf16 v[64:67], a[48:51], a[4:7], v[64:67]
ds_read_b64_tr_b16 a[112:113], v15 offset:10240
s_add_u32 m0, s16, 0x8000
v_mfma_f32_16x16x32_bf16 v[96:99], a[48:51], a[8:11], v[96:99]
buffer_load_dwordx4 v22, s[44:47], s20 offen lds
v_mfma_f32_16x16x32_bf16 v[128:131], a[48:51], a[12:15], v[128:131]
ds_read_b64_tr_b16 a[114:115], v15 offset:10496
v_mfma_f32_16x16x32_bf16 v[132:135], a[52:55], a[12:15], v[132:135]
ds_read_b64_tr_b16 a[40:41], v12 offset:8192
v_mfma_f32_16x16x32_bf16 v[100:103], a[52:55], a[8:11], v[100:103]
ds_read_b64_tr_b16 a[42:43], v12 offset:9216
s_add_u32 m0, s16, 0x8400
v_mfma_f32_16x16x32_bf16 v[68:71], a[52:55], a[4:7], v[68:71]
buffer_load_dwordx4 v23, s[44:47], s20 offen lds
v_mfma_f32_16x16x32_bf16 v[36:39], a[52:55], a[0:3], v[36:39]
ds_read_b64_tr_b16 a[44:45], v13 offset:8192
v_mfma_f32_16x16x32_bf16 v[40:43], a[56:59], a[0:3], v[40:43]
ds_read_b64_tr_b16 a[46:47], v13 offset:9216
v_mfma_f32_16x16x32_bf16 v[72:75], a[56:59], a[4:7], v[72:75]
ds_read_b64_tr_b16 a[48:49], v12 offset:8448
s_add_u32 s8, s28, 0x3000
v_mfma_f32_16x16x32_bf16 v[104:107], a[56:59], a[8:11], v[104:107]
buffer_store_dwordx4 a[144:147], v16, s[88:91], s8 offen sc1
v_mfma_f32_16x16x32_bf16 v[136:139], a[56:59], a[12:15], v[136:139]
ds_read_b64_tr_b16 a[50:51], v12 offset:9472
v_mfma_f32_16x16x32_bf16 v[140:143], a[60:63], a[12:15], v[140:143]
ds_read_b64_tr_b16 a[52:53], v13 offset:8448
v_mfma_f32_16x16x32_bf16 v[108:111], a[60:63], a[8:11], v[108:111]
ds_read_b64_tr_b16 a[54:55], v13 offset:9472
s_add_u32 m0, s16, 0x8800
v_mfma_f32_16x16x32_bf16 v[76:79], a[60:63], a[4:7], v[76:79]
buffer_load_dwordx4 v22, s[44:47], s21 offen lds
v_mfma_f32_16x16x32_bf16 v[44:47], a[60:63], a[0:3], v[44:47]
ds_read_b64_tr_b16 a[56:57], v12 offset:8704
v_mfma_f32_16x16x32_bf16 v[48:51], a[64:67], a[0:3], v[48:51]
ds_read_b64_tr_b16 a[58:59], v12 offset:9728
v_mfma_f32_16x16x32_bf16 v[80:83], a[64:67], a[4:7], v[80:83]
ds_read_b64_tr_b16 a[60:61], v13 offset:8704
s_add_u32 m0, s16, 0x8c00
v_mfma_f32_16x16x32_bf16 v[112:115], a[64:67], a[8:11], v[112:115]
buffer_load_dwordx4 v23, s[44:47], s21 offen lds
v_mfma_f32_16x16x32_bf16 v[144:147], a[64:67], a[12:15], v[144:147]
ds_read_b64_tr_b16 a[62:63], v13 offset:9728
v_mfma_f32_16x16x32_bf16 v[148:151], a[68:71], a[12:15], v[148:151]
ds_read_b64_tr_b16 a[64:65], v12 offset:8960
v_mfma_f32_16x16x32_bf16 v[116:119], a[68:71], a[8:11], v[116:119]
ds_read_b64_tr_b16 a[66:67], v12 offset:9984
s_add_u32 m0, s16, 0x9000
v_mfma_f32_16x16x32_bf16 v[84:87], a[68:71], a[4:7], v[84:87]
buffer_load_dwordx4 v22, s[44:47], s22 offen lds
v_mfma_f32_16x16x32_bf16 v[52:55], a[68:71], a[0:3], v[52:55]
ds_read_b64_tr_b16 a[68:69], v13 offset:8960
v_mfma_f32_16x16x32_bf16 v[152:155], a[72:75], a[0:3], v[152:155]
ds_read_b64_tr_b16 a[70:71], v13 offset:9984
v_mfma_f32_16x16x32_bf16 v[160:163], a[72:75], a[4:7], v[160:163]
v_mfma_f32_16x16x32_bf16 v[168:171], a[72:75], a[8:11], v[168:171]
s_add_u32 s8, s28, 0x3400
v_mfma_f32_16x16x32_bf16 v[176:179], a[72:75], a[12:15], v[176:179]
buffer_store_dwordx4 a[148:151], v16, s[88:91], s8 offen sc1
v_mfma_f32_16x16x32_bf16 v[180:183], a[76:79], a[12:15], v[180:183]
ds_read_b64_tr_b16 a[72:73], v14 offset:2048
v_mfma_f32_16x16x32_bf16 v[172:175], a[76:79], a[8:11], v[172:175]
ds_read_b64_tr_b16 a[74:75], v14 offset:2304
v_mfma_f32_16x16x32_bf16 v[164:167], a[76:79], a[4:7], v[164:167]
s_add_u32 m0, s16, 0x9400
v_mfma_f32_16x16x32_bf16 v[156:159], a[76:79], a[0:3], v[156:159]
buffer_load_dwordx4 v23, s[44:47], s22 offen lds
v_mfma_f32_16x16x32_bf16 v[184:187], a[80:83], a[0:3], v[184:187]
ds_read_b64_tr_b16 a[76:77], v15 offset:2048
v_mfma_f32_16x16x32_bf16 v[192:195], a[80:83], a[4:7], v[192:195]
ds_read_b64_tr_b16 a[78:79], v15 offset:2304
v_mfma_f32_16x16x32_bf16 v[200:203], a[80:83], a[8:11], v[200:203]
s_add_u32 m0, s16, 0x9800
v_mfma_f32_16x16x32_bf16 v[208:211], a[80:83], a[12:15], v[208:211]
buffer_load_dwordx4 v22, s[44:47], s23 offen lds
v_mfma_f32_16x16x32_bf16 v[248:251], a[80:83], a[16:19], v[248:251]
ds_read_b64_tr_b16 a[80:81], v14 offset:6144
v_mfma_f32_16x16x32_bf16 v[212:215], a[84:87], a[12:15], v[212:215]
ds_read_b64_tr_b16 a[82:83], v14 offset:6400
v_add_u32 v12, 0x8000, v12
v_mfma_f32_16x16x32_bf16 v[204:207], a[84:87], a[8:11], v[204:207]
s_add_u32 m0, s16, 0x9c00
v_add_u32 v13, 0x8000, v13
v_add_u32 v14, 0x8000, v14
v_mfma_f32_16x16x32_bf16 v[196:199], a[84:87], a[4:7], v[196:199]
buffer_load_dwordx4 v23, s[44:47], s23 offen lds
v_mfma_f32_16x16x32_bf16 v[188:191], a[84:87], a[0:3], v[188:191]
v_add_u32 v15, 0x8000, v15
v_add_u32 v10, 0x8000, v10
v_mfma_f32_16x16x32_bf16 v[216:219], a[0:3], a[88:91], v[216:219]
v_add_u32 v11, 0x8000, v11
v_mfma_f32_16x16x32_bf16 v[224:227], a[4:7], a[88:91], v[224:227]
v_add_u32 v20, s76, v16
v_mov_b32 v21, s77
v_mfma_f32_16x16x32_bf16 v[232:235], a[8:11], a[88:91], v[232:235]
global_load_dword v18, v[20:21], off sc1
v_mfma_f32_16x16x32_bf16 v[240:243], a[12:15], a[88:91], v[240:243]
v_mfma_f32_16x16x32_bf16 v[252:255], a[16:19], a[88:91], v[252:255]
v_mfma_f32_16x16x32_bf16 v[244:247], a[12:15], a[92:95], v[244:247]
v_mfma_f32_16x16x32_bf16 v[236:239], a[8:11], a[92:95], v[236:239]
v_mfma_f32_16x16x32_bf16 v[228:231], a[4:7], a[92:95], v[228:231]
v_mfma_f32_16x16x32_bf16 v[220:223], a[0:3], a[92:95], v[220:223]
s_waitcnt vmcnt(22) lgkmcnt(0)
s_barrier
v_mfma_f32_16x16x32_bf16 v[24:27], a[40:43], a[20:23], v[24:27]
ds_read_b128 a[0:3], v8 offset:0
s_add_u32 m0, s17, 0x0
v_mfma_f32_16x16x32_bf16 v[56:59], a[40:43], a[24:27], v[56:59]
buffer_load_dwordx4 v5, s[52:55], 0 offen lds
v_mfma_f32_16x16x32_bf16 v[88:91], a[40:43], a[28:31], v[88:91]
ds_read_b128 a[4:7], v8 offset:2048
v_add_u32 v22, 0x80, v22
v_mfma_f32_16x16x32_bf16 v[120:123], a[40:43], a[32:35], v[120:123]
ds_read_b128 a[8:11], v8 offset:4096
v_add_u32 v23, 0x80, v23
v_mfma_f32_16x16x32_bf16 v[124:127], a[44:47], a[32:35], v[124:127]
ds_read_b128 a[12:15], v8 offset:6144
v_mfma_f32_16x16x32_bf16 v[92:95], a[44:47], a[28:31], v[92:95]
ds_read_b128 a[16:19], v10
s_add_u32 m0, s17, 0x400
v_mfma_f32_16x16x32_bf16 v[60:63], a[44:47], a[24:27], v[60:63]
buffer_load_dwordx4 v5, s[52:55], s13 offen lds
v_mfma_f32_16x16x32_bf16 v[28:31], a[44:47], a[20:23], v[28:31]
ds_read_b64_tr_b16 a[84:85], v15 offset:4096
v_mfma_f32_16x16x32_bf16 v[32:35], a[48:51], a[20:23], v[32:35]
ds_read_b64_tr_b16 a[86:87], v15 offset:4352
v_mfma_f32_16x16x32_bf16 v[64:67], a[48:51], a[24:27], v[64:67]
ds_read_b64_tr_b16 a[88:89], v14 offset:8192
v_mfma_f32_16x16x32_bf16 v[96:99], a[48:51], a[28:31], v[96:99]
ds_read_b64_tr_b16 a[90:91], v14 offset:8448
v_mfma_f32_16x16x32_bf16 v[128:131], a[48:51], a[32:35], v[128:131]
ds_read_b64_tr_b16 a[92:93], v15 offset:8192
s_add_u32 m0, s17, 0x800
v_mfma_f32_16x16x32_bf16 v[132:135], a[52:55], a[32:35], v[132:135]
buffer_load_dwordx4 v6, s[52:55], 0 offen lds
v_mfma_f32_16x16x32_bf16 v[100:103], a[52:55], a[28:31], v[100:103]
ds_read_b64_tr_b16 a[94:95], v15 offset:8448
v_mfma_f32_16x16x32_bf16 v[68:71], a[52:55], a[24:27], v[68:71]
ds_read_b64_tr_b16 a[40:41], v12 offset:0
v_mfma_f32_16x16x32_bf16 v[36:39], a[52:55], a[20:23], v[36:39]
ds_read_b64_tr_b16 a[42:43], v12 offset:1024
v_mfma_f32_16x16x32_bf16 v[40:43], a[56:59], a[20:23], v[40:43]
ds_read_b64_tr_b16 a[44:45], v13 offset:0
s_add_u32 m0, s17, 0xc00
v_mfma_f32_16x16x32_bf16 v[72:75], a[56:59], a[24:27], v[72:75]
buffer_load_dwordx4 v6, s[52:55], s13 offen lds
v_mfma_f32_16x16x32_bf16 v[104:107], a[56:59], a[28:31], v[104:107]
ds_read_b64_tr_b16 a[46:47], v13 offset:1024
v_mfma_f32_16x16x32_bf16 v[136:139], a[56:59], a[32:35], v[136:139]
ds_read_b64_tr_b16 a[48:49], v12 offset:256
v_mfma_f32_16x16x32_bf16 v[140:143], a[60:63], a[32:35], v[140:143]
ds_read_b64_tr_b16 a[50:51], v12 offset:1280
v_mfma_f32_16x16x32_bf16 v[108:111], a[60:63], a[28:31], v[108:111]
ds_read_b64_tr_b16 a[52:53], v13 offset:256
v_mfma_f32_16x16x32_bf16 v[76:79], a[60:63], a[24:27], v[76:79]
ds_read_b64_tr_b16 a[54:55], v13 offset:1280
s_add_u32 s8, s28, 0x3800
v_mfma_f32_16x16x32_bf16 v[44:47], a[60:63], a[20:23], v[44:47]
buffer_store_dwordx4 a[152:155], v16, s[88:91], s8 offen sc1
v_mfma_f32_16x16x32_bf16 v[48:51], a[64:67], a[20:23], v[48:51]
ds_read_b64_tr_b16 a[56:57], v12 offset:512
v_mfma_f32_16x16x32_bf16 v[80:83], a[64:67], a[24:27], v[80:83]
ds_read_b64_tr_b16 a[58:59], v12 offset:1536
v_mfma_f32_16x16x32_bf16 v[112:115], a[64:67], a[28:31], v[112:115]
ds_read_b64_tr_b16 a[60:61], v13 offset:512
v_mfma_f32_16x16x32_bf16 v[144:147], a[64:67], a[32:35], v[144:147]
ds_read_b64_tr_b16 a[62:63], v13 offset:1536
s_add_u32 m0, s18, 0x4000
v_mfma_f32_16x16x32_bf16 v[148:151], a[68:71], a[32:35], v[148:151]
buffer_load_dwordx4 v7, s[68:71], 0 offen lds
v_mfma_f32_16x16x32_bf16 v[116:119], a[68:71], a[28:31], v[116:119]
ds_read_b64_tr_b16 a[64:65], v12 offset:768
v_mfma_f32_16x16x32_bf16 v[84:87], a[68:71], a[24:27], v[84:87]
ds_read_b64_tr_b16 a[66:67], v12 offset:1792
v_mfma_f32_16x16x32_bf16 v[52:55], a[68:71], a[20:23], v[52:55]
ds_read_b64_tr_b16 a[68:69], v13 offset:768
v_mfma_f32_16x16x32_bf16 v[152:155], a[72:75], a[20:23], v[152:155]
ds_read_b64_tr_b16 a[70:71], v13 offset:1792
v_mfma_f32_16x16x32_bf16 v[160:163], a[72:75], a[24:27], v[160:163]
s_add_u32 m0, s18, 0x5000
v_mfma_f32_16x16x32_bf16 v[168:171], a[72:75], a[28:31], v[168:171]
buffer_load_dwordx4 v7, s[68:71], s25 offen lds
v_mfma_f32_16x16x32_bf16 v[176:179], a[72:75], a[32:35], v[176:179]
ds_read_b64_tr_b16 a[72:73], v14 offset:0
v_mfma_f32_16x16x32_bf16 v[180:183], a[76:79], a[32:35], v[180:183]
ds_read_b64_tr_b16 a[74:75], v14 offset:256
v_mfma_f32_16x16x32_bf16 v[172:175], a[76:79], a[28:31], v[172:175]
v_mfma_f32_16x16x32_bf16 v[164:167], a[76:79], a[24:27], v[164:167]
s_add_u32 m0, s18, 0x6000
v_mfma_f32_16x16x32_bf16 v[156:159], a[76:79], a[20:23], v[156:159]
buffer_load_dwordx4 v7, s[68:71], s26 offen lds
v_mfma_f32_16x16x32_bf16 v[184:187], a[80:83], a[20:23], v[184:187]
ds_read_b64_tr_b16 a[76:77], v15 offset:0
v_mfma_f32_16x16x32_bf16 v[192:195], a[80:83], a[24:27], v[192:195]
ds_read_b64_tr_b16 a[78:79], v15 offset:256
v_mfma_f32_16x16x32_bf16 v[200:203], a[80:83], a[28:31], v[200:203]
v_mfma_f32_16x16x32_bf16 v[208:211], a[80:83], a[32:35], v[208:211]
v_mfma_f32_16x16x32_bf16 v[248:251], a[80:83], a[36:39], v[248:251]
ds_read_b64_tr_b16 a[80:81], v14 offset:4096
s_add_u32 m0, s18, 0x7000
v_mfma_f32_16x16x32_bf16 v[212:215], a[104:107], a[32:35], v[212:215]
buffer_load_dwordx4 v4, s[44:47], s24 offen lds
v_mfma_f32_16x16x32_bf16 v[204:207], a[104:107], a[28:31], v[204:207]
ds_read_b64_tr_b16 a[82:83], v14 offset:4352
v_mfma_f32_16x16x32_bf16 v[196:199], a[104:107], a[24:27], v[196:199]
v_mfma_f32_16x16x32_bf16 v[188:191], a[104:107], a[20:23], v[188:191]
v_mfma_f32_16x16x32_bf16 v[216:219], a[20:23], a[108:111], v[216:219]
s_add_u32 s8, s28, 0x3c00
v_mfma_f32_16x16x32_bf16 v[224:227], a[24:27], a[108:111], v[224:227]
buffer_store_dwordx4 a[156:159], v16, s[88:91], s8 offen sc1
v_mfma_f32_16x16x32_bf16 v[232:235], a[28:31], a[108:111], v[232:235]
v_mfma_f32_16x16x32_bf16 v[240:243], a[32:35], a[108:111], v[240:243]
v_mfma_f32_16x16x32_bf16 v[252:255], a[36:39], a[108:111], v[252:255]
v_mfma_f32_16x16x32_bf16 v[244:247], a[32:35], a[112:115], v[244:247]
v_mfma_f32_16x16x32_bf16 v[236:239], a[28:31], a[112:115], v[236:239]
v_mfma_f32_16x16x32_bf16 v[228:231], a[24:27], a[112:115], v[228:231]
v_mfma_f32_16x16x32_bf16 v[220:223], a[20:23], a[112:115], v[220:223]
s_waitcnt lgkmcnt(0)
v_mfma_f32_16x16x32_bf16 v[24:27], a[40:43], a[0:3], v[24:27]
ds_read_b128 a[20:23], v9 offset:0
v_add_u32 v5, 0x80000, v5
v_mfma_f32_16x16x32_bf16 v[56:59], a[40:43], a[4:7], v[56:59]
ds_read_b128 a[24:27], v9 offset:2048
v_add_u32 v6, 0x80000, v6
v_mfma_f32_16x16x32_bf16 v[88:91], a[40:43], a[8:11], v[88:91]
ds_read_b128 a[28:31], v9 offset:4096
v_add_u32 v7, 0x60000, v7
v_mfma_f32_16x16x32_bf16 v[120:123], a[40:43], a[12:15], v[120:123]
ds_read_b128 a[32:35], v9 offset:6144
v_add_u32 v4, 0x80, v4
v_mfma_f32_16x16x32_bf16 v[124:127], a[44:47], a[12:15], v[124:127]
ds_read_b128 a[36:39], v11
v_mfma_f32_16x16x32_bf16 v[92:95], a[44:47], a[8:11], v[92:95]
ds_read_b64_tr_b16 a[104:105], v15 offset:6144
v_mfma_f32_16x16x32_bf16 v[60:63], a[44:47], a[4:7], v[60:63]
ds_read_b64_tr_b16 a[106:107], v15 offset:6400
v_mfma_f32_16x16x32_bf16 v[28:31], a[44:47], a[0:3], v[28:31]
ds_read_b64_tr_b16 a[108:109], v14 offset:10240
v_mfma_f32_16x16x32_bf16 v[32:35], a[48:51], a[0:3], v[32:35]
ds_read_b64_tr_b16 a[110:111], v14 offset:10496
s_waitcnt lgkmcnt(5)
v_mfma_f32_16x16x32_bf16 v[64:67], a[48:51], a[4:7], v[64:67]
ds_read_b64_tr_b16 a[112:113], v15 offset:10240
s_add_u32 m0, s16, 0x0
v_mfma_f32_16x16x32_bf16 v[96:99], a[48:51], a[8:11], v[96:99]
buffer_load_dwordx4 v22, s[44:47], s20 offen lds
v_mfma_f32_16x16x32_bf16 v[128:131], a[48:51], a[12:15], v[128:131]
ds_read_b64_tr_b16 a[114:115], v15 offset:10496
v_mfma_f32_16x16x32_bf16 v[132:135], a[52:55], a[12:15], v[132:135]
ds_read_b64_tr_b16 a[40:41], v12 offset:8192
v_mfma_f32_16x16x32_bf16 v[100:103], a[52:55], a[8:11], v[100:103]
ds_read_b64_tr_b16 a[42:43], v12 offset:9216
s_add_u32 m0, s16, 0x400
v_mfma_f32_16x16x32_bf16 v[68:71], a[52:55], a[4:7], v[68:71]
buffer_load_dwordx4 v23, s[44:47], s20 offen lds
v_mfma_f32_16x16x32_bf16 v[36:39], a[52:55], a[0:3], v[36:39]
ds_read_b64_tr_b16 a[44:45], v13 offset:8192
v_mfma_f32_16x16x32_bf16 v[40:43], a[56:59], a[0:3], v[40:43]
ds_read_b64_tr_b16 a[46:47], v13 offset:9216
v_mfma_f32_16x16x32_bf16 v[72:75], a[56:59], a[4:7], v[72:75]
ds_read_b64_tr_b16 a[48:49], v12 offset:8448
v_mfma_f32_16x16x32_bf16 v[104:107], a[56:59], a[8:11], v[104:107]
ds_read_b64_tr_b16 a[50:51], v12 offset:9472
s_add_u32 m0, s16, 0x800
v_mfma_f32_16x16x32_bf16 v[136:139], a[56:59], a[12:15], v[136:139]
buffer_load_dwordx4 v22, s[44:47], s21 offen lds
v_mfma_f32_16x16x32_bf16 v[140:143], a[60:63], a[12:15], v[140:143]
ds_read_b64_tr_b16 a[52:53], v13 offset:8448
v_mfma_f32_16x16x32_bf16 v[108:111], a[60:63], a[8:11], v[108:111]
ds_read_b64_tr_b16 a[54:55], v13 offset:9472
v_mfma_f32_16x16x32_bf16 v[76:79], a[60:63], a[4:7], v[76:79]
ds_read_b64_tr_b16 a[56:57], v12 offset:8704
s_add_u32 m0, s16, 0xc00
v_mfma_f32_16x16x32_bf16 v[44:47], a[60:63], a[0:3], v[44:47]
buffer_load_dwordx4 v23, s[44:47], s21 offen lds
v_mfma_f32_16x16x32_bf16 v[48:51], a[64:67], a[0:3], v[48:51]
ds_read_b64_tr_b16 a[58:59], v12 offset:9728
v_mfma_f32_16x16x32_bf16 v[80:83], a[64:67], a[4:7], v[80:83]
ds_read_b64_tr_b16 a[60:61], v13 offset:8704
v_mfma_f32_16x16x32_bf16 v[112:115], a[64:67], a[8:11], v[112:115]
ds_read_b64_tr_b16 a[62:63], v13 offset:9728
v_mfma_f32_16x16x32_bf16 v[144:147], a[64:67], a[12:15], v[144:147]
ds_read_b64_tr_b16 a[64:65], v12 offset:8960
s_add_u32 s8, s28, 0x6000
v_mfma_f32_16x16x32_bf16 v[148:151], a[68:71], a[12:15], v[148:151]
buffer_store_dwordx4 a[160:163], v16, s[88:91], s8 offen sc1
v_mfma_f32_16x16x32_bf16 v[116:119], a[68:71], a[8:11], v[116:119]
ds_read_b64_tr_b16 a[66:67], v12 offset:9984
v_mfma_f32_16x16x32_bf16 v[84:87], a[68:71], a[4:7], v[84:87]
v_mfma_f32_16x16x32_bf16 v[52:55], a[68:71], a[0:3], v[52:55]
ds_read_b64_tr_b16 a[68:69], v13 offset:8960
v_mfma_f32_16x16x32_bf16 v[152:155], a[72:75], a[0:3], v[152:155]
ds_read_b64_tr_b16 a[70:71], v13 offset:9984
s_add_u32 m0, s16, 0x1000
v_mfma_f32_16x16x32_bf16 v[160:163], a[72:75], a[4:7], v[160:163]
buffer_load_dwordx4 v22, s[44:47], s22 offen lds
v_mfma_f32_16x16x32_bf16 v[168:171], a[72:75], a[8:11], v[168:171]
v_mfma_f32_16x16x32_bf16 v[176:179], a[72:75], a[12:15], v[176:179]
ds_read_b64_tr_b16 a[72:73], v14 offset:2048
v_mfma_f32_16x16x32_bf16 v[180:183], a[76:79], a[12:15], v[180:183]
ds_read_b64_tr_b16 a[74:75], v14 offset:2304
s_add_u32 m0, s16, 0x1400
v_mfma_f32_16x16x32_bf16 v[172:175], a[76:79], a[8:11], v[172:175]
buffer_load_dwordx4 v23, s[44:47], s22 offen lds
v_mfma_f32_16x16x32_bf16 v[164:167], a[76:79], a[4:7], v[164:167]
v_mfma_f32_16x16x32_bf16 v[156:159], a[76:79], a[0:3], v[156:159]
ds_read_b64_tr_b16 a[76:77], v15 offset:2048
v_mfma_f32_16x16x32_bf16 v[184:187], a[80:83], a[0:3], v[184:187]
ds_read_b64_tr_b16 a[78:79], v15 offset:2304
v_mfma_f32_16x16x32_bf16 v[192:195], a[80:83], a[4:7], v[192:195]
s_add_u32 m0, s16, 0x1800
v_mfma_f32_16x16x32_bf16 v[200:203], a[80:83], a[8:11], v[200:203]
buffer_load_dwordx4 v22, s[44:47], s23 offen lds
v_mfma_f32_16x16x32_bf16 v[208:211], a[80:83], a[12:15], v[208:211]
v_mfma_f32_16x16x32_bf16 v[248:251], a[80:83], a[16:19], v[248:251]
ds_read_b64_tr_b16 a[80:81], v14 offset:6144
v_mfma_f32_16x16x32_bf16 v[212:215], a[84:87], a[12:15], v[212:215]
ds_read_b64_tr_b16 a[82:83], v14 offset:6400
s_add_u32 m0, s16, 0x1c00
v_mfma_f32_16x16x32_bf16 v[204:207], a[84:87], a[8:11], v[204:207]
buffer_load_dwordx4 v23, s[44:47], s23 offen lds
v_mfma_f32_16x16x32_bf16 v[196:199], a[84:87], a[4:7], v[196:199]
v_add_u32 v12, 0x8000, v12
v_add_u32 v13, 0x8000, v13
v_mfma_f32_16x16x32_bf16 v[188:191], a[84:87], a[0:3], v[188:191]
v_add_u32 v14, 0x8000, v14
v_add_u32 v15, 0x8000, v15
v_mfma_f32_16x16x32_bf16 v[216:219], a[0:3], a[88:91], v[216:219]
v_add_u32 v10, 0x8000, v10
v_add_u32 v11, 0x8000, v11
v_mfma_f32_16x16x32_bf16 v[224:227], a[4:7], a[88:91], v[224:227]
s_add_u32 s8, s28, 0x6400
v_mfma_f32_16x16x32_bf16 v[232:235], a[8:11], a[88:91], v[232:235]
buffer_store_dwordx4 a[164:167], v16, s[88:91], s8 offen sc1
v_mfma_f32_16x16x32_bf16 v[240:243], a[12:15], a[88:91], v[240:243]
v_mfma_f32_16x16x32_bf16 v[252:255], a[16:19], a[88:91], v[252:255]
v_mfma_f32_16x16x32_bf16 v[244:247], a[12:15], a[92:95], v[244:247]
v_mfma_f32_16x16x32_bf16 v[236:239], a[8:11], a[92:95], v[236:239]
v_mfma_f32_16x16x32_bf16 v[228:231], a[4:7], a[92:95], v[228:231]
v_mfma_f32_16x16x32_bf16 v[220:223], a[0:3], a[92:95], v[220:223]
s_waitcnt vmcnt(21) lgkmcnt(0)
s_barrier
v_mfma_f32_16x16x32_bf16 v[24:27], a[40:43], a[20:23], v[24:27]
ds_read_b128 a[0:3], v8 offset:32768
s_add_u32 m0, s17, 0x8000
v_mfma_f32_16x16x32_bf16 v[56:59], a[40:43], a[24:27], v[56:59]
buffer_load_dwordx4 v5, s[52:55], 0 offen lds
v_mfma_f32_16x16x32_bf16 v[88:91], a[40:43], a[28:31], v[88:91]
ds_read_b128 a[4:7], v8 offset:34816
v_add_u32 v22, 0x80, v22
v_mfma_f32_16x16x32_bf16 v[120:123], a[40:43], a[32:35], v[120:123]
ds_read_b128 a[8:11], v8 offset:36864
v_add_u32 v23, 0x80, v23
v_mfma_f32_16x16x32_bf16 v[124:127], a[44:47], a[32:35], v[124:127]
ds_read_b128 a[12:15], v8 offset:38912
v_mfma_f32_16x16x32_bf16 v[92:95], a[44:47], a[28:31], v[92:95]
ds_read_b128 a[16:19], v10
s_add_u32 m0, s17, 0x8400
v_mfma_f32_16x16x32_bf16 v[60:63], a[44:47], a[24:27], v[60:63]
buffer_load_dwordx4 v5, s[52:55], s13 offen lds
v_mfma_f32_16x16x32_bf16 v[28:31], a[44:47], a[20:23], v[28:31]
ds_read_b64_tr_b16 a[84:85], v15 offset:4096
v_mfma_f32_16x16x32_bf16 v[32:35], a[48:51], a[20:23], v[32:35]
ds_read_b64_tr_b16 a[86:87], v15 offset:4352
v_mfma_f32_16x16x32_bf16 v[64:67], a[48:51], a[24:27], v[64:67]
ds_read_b64_tr_b16 a[88:89], v14 offset:8192
v_mfma_f32_16x16x32_bf16 v[96:99], a[48:51], a[28:31], v[96:99]
ds_read_b64_tr_b16 a[90:91], v14 offset:8448
v_mfma_f32_16x16x32_bf16 v[128:131], a[48:51], a[32:35], v[128:131]
ds_read_b64_tr_b16 a[92:93], v15 offset:8192
s_add_u32 m0, s17, 0x8800
v_mfma_f32_16x16x32_bf16 v[132:135], a[52:55], a[32:35], v[132:135]
buffer_load_dwordx4 v6, s[52:55], 0 offen lds
v_mfma_f32_16x16x32_bf16 v[100:103], a[52:55], a[28:31], v[100:103]
ds_read_b64_tr_b16 a[94:95], v15 offset:8448
v_mfma_f32_16x16x32_bf16 v[68:71], a[52:55], a[24:27], v[68:71]
ds_read_b64_tr_b16 a[40:41], v12 offset:0
v_mfma_f32_16x16x32_bf16 v[36:39], a[52:55], a[20:23], v[36:39]
ds_read_b64_tr_b16 a[42:43], v12 offset:1024
v_mfma_f32_16x16x32_bf16 v[40:43], a[56:59], a[20:23], v[40:43]
ds_read_b64_tr_b16 a[44:45], v13 offset:0
s_add_u32 m0, s17, 0x8c00
v_mfma_f32_16x16x32_bf16 v[72:75], a[56:59], a[24:27], v[72:75]
buffer_load_dwordx4 v6, s[52:55], s13 offen lds
v_mfma_f32_16x16x32_bf16 v[104:107], a[56:59], a[28:31], v[104:107]
ds_read_b64_tr_b16 a[46:47], v13 offset:1024
v_mfma_f32_16x16x32_bf16 v[136:139], a[56:59], a[32:35], v[136:139]
ds_read_b64_tr_b16 a[48:49], v12 offset:256
v_mfma_f32_16x16x32_bf16 v[140:143], a[60:63], a[32:35], v[140:143]
ds_read_b64_tr_b16 a[50:51], v12 offset:1280
v_mfma_f32_16x16x32_bf16 v[108:111], a[60:63], a[28:31], v[108:111]
ds_read_b64_tr_b16 a[52:53], v13 offset:256
v_mfma_f32_16x16x32_bf16 v[76:79], a[60:63], a[24:27], v[76:79]
ds_read_b64_tr_b16 a[54:55], v13 offset:1280
s_add_u32 s8, s28, 0x6800
v_mfma_f32_16x16x32_bf16 v[44:47], a[60:63], a[20:23], v[44:47]
buffer_store_dwordx4 a[168:171], v16, s[88:91], s8 offen sc1
v_mfma_f32_16x16x32_bf16 v[48:51], a[64:67], a[20:23], v[48:51]
ds_read_b64_tr_b16 a[56:57], v12 offset:512
v_mfma_f32_16x16x32_bf16 v[80:83], a[64:67], a[24:27], v[80:83]
ds_read_b64_tr_b16 a[58:59], v12 offset:1536
v_mfma_f32_16x16x32_bf16 v[112:115], a[64:67], a[28:31], v[112:115]
ds_read_b64_tr_b16 a[60:61], v13 offset:512
v_mfma_f32_16x16x32_bf16 v[144:147], a[64:67], a[32:35], v[144:147]
ds_read_b64_tr_b16 a[62:63], v13 offset:1536
s_add_u32 m0, s18, 0xc000
v_mfma_f32_16x16x32_bf16 v[148:151], a[68:71], a[32:35], v[148:151]
buffer_load_dwordx4 v7, s[68:71], 0 offen lds
v_mfma_f32_16x16x32_bf16 v[116:119], a[68:71], a[28:31], v[116:119]
ds_read_b64_tr_b16 a[64:65], v12 offset:768
v_mfma_f32_16x16x32_bf16 v[84:87], a[68:71], a[24:27], v[84:87]
ds_read_b64_tr_b16 a[66:67], v12 offset:1792
v_mfma_f32_16x16x32_bf16 v[52:55], a[68:71], a[20:23], v[52:55]
ds_read_b64_tr_b16 a[68:69], v13 offset:768
v_mfma_f32_16x16x32_bf16 v[152:155], a[72:75], a[20:23], v[152:155]
ds_read_b64_tr_b16 a[70:71], v13 offset:1792
v_mfma_f32_16x16x32_bf16 v[160:163], a[72:75], a[24:27], v[160:163]
s_add_u32 m0, s18, 0xd000
v_mfma_f32_16x16x32_bf16 v[168:171], a[72:75], a[28:31], v[168:171]
buffer_load_dwordx4 v7, s[68:71], s25 offen lds
v_mfma_f32_16x16x32_bf16 v[176:179], a[72:75], a[32:35], v[176:179]
ds_read_b64_tr_b16 a[72:73], v14 offset:0
v_mfma_f32_16x16x32_bf16 v[180:183], a[76:79], a[32:35], v[180:183]
ds_read_b64_tr_b16 a[74:75], v14 offset:256
v_mfma_f32_16x16x32_bf16 v[172:175], a[76:79], a[28:31], v[172:175]
v_mfma_f32_16x16x32_bf16 v[164:167], a[76:79], a[24:27], v[164:167]
s_add_u32 m0, s18, 0xe000
v_mfma_f32_16x16x32_bf16 v[156:159], a[76:79], a[20:23], v[156:159]
buffer_load_dwordx4 v7, s[68:71], s26 offen lds
v_mfma_f32_16x16x32_bf16 v[184:187], a[80:83], a[20:23], v[184:187]
ds_read_b64_tr_b16 a[76:77], v15 offset:0
v_mfma_f32_16x16x32_bf16 v[192:195], a[80:83], a[24:27], v[192:195]
ds_read_b64_tr_b16 a[78:79], v15 offset:256
v_mfma_f32_16x16x32_bf16 v[200:203], a[80:83], a[28:31], v[200:203]
v_mfma_f32_16x16x32_bf16 v[208:211], a[80:83], a[32:35], v[208:211]
v_mfma_f32_16x16x32_bf16 v[248:251], a[80:83], a[36:39], v[248:251]
ds_read_b64_tr_b16 a[80:81], v14 offset:4096
s_add_u32 m0, s18, 0xf000
v_mfma_f32_16x16x32_bf16 v[212:215], a[104:107], a[32:35], v[212:215]
buffer_load_dwordx4 v4, s[44:47], s24 offen lds
v_mfma_f32_16x16x32_bf16 v[204:207], a[104:107], a[28:31], v[204:207]
ds_read_b64_tr_b16 a[82:83], v14 offset:4352
v_mfma_f32_16x16x32_bf16 v[196:199], a[104:107], a[24:27], v[196:199]
v_mfma_f32_16x16x32_bf16 v[188:191], a[104:107], a[20:23], v[188:191]
v_mfma_f32_16x16x32_bf16 v[216:219], a[20:23], a[108:111], v[216:219]
s_add_u32 s8, s28, 0x6c00
v_mfma_f32_16x16x32_bf16 v[224:227], a[24:27], a[108:111], v[224:227]
buffer_store_dwordx4 a[172:175], v16, s[88:91], s8 offen sc1
v_mfma_f32_16x16x32_bf16 v[232:235], a[28:31], a[108:111], v[232:235]
v_mfma_f32_16x16x32_bf16 v[240:243], a[32:35], a[108:111], v[240:243]
v_mfma_f32_16x16x32_bf16 v[252:255], a[36:39], a[108:111], v[252:255]
v_mfma_f32_16x16x32_bf16 v[244:247], a[32:35], a[112:115], v[244:247]
v_mfma_f32_16x16x32_bf16 v[236:239], a[28:31], a[112:115], v[236:239]
v_mfma_f32_16x16x32_bf16 v[228:231], a[24:27], a[112:115], v[228:231]
v_mfma_f32_16x16x32_bf16 v[220:223], a[20:23], a[112:115], v[220:223]
s_waitcnt lgkmcnt(0)
v_mfma_f32_16x16x32_bf16 v[24:27], a[40:43], a[0:3], v[24:27]
ds_read_b128 a[20:23], v9 offset:32768
v_add_u32 v5, 0x80000, v5
v_mfma_f32_16x16x32_bf16 v[56:59], a[40:43], a[4:7], v[56:59]
ds_read_b128 a[24:27], v9 offset:34816
v_add_u32 v6, 0x80000, v6
v_mfma_f32_16x16x32_bf16 v[88:91], a[40:43], a[8:11], v[88:91]
ds_read_b128 a[28:31], v9 offset:36864
v_add_u32 v7, 0x60000, v7
v_mfma_f32_16x16x32_bf16 v[120:123], a[40:43], a[12:15], v[120:123]
ds_read_b128 a[32:35], v9 offset:38912
v_add_u32 v4, 0x80, v4
v_mfma_f32_16x16x32_bf16 v[124:127], a[44:47], a[12:15], v[124:127]
ds_read_b128 a[36:39], v11
v_mfma_f32_16x16x32_bf16 v[92:95], a[44:47], a[8:11], v[92:95]
ds_read_b64_tr_b16 a[104:105], v15 offset:6144
v_mfma_f32_16x16x32_bf16 v[60:63], a[44:47], a[4:7], v[60:63]
ds_read_b64_tr_b16 a[106:107], v15 offset:6400
v_mfma_f32_16x16x32_bf16 v[28:31], a[44:47], a[0:3], v[28:31]
ds_read_b64_tr_b16 a[108:109], v14 offset:10240
v_mfma_f32_16x16x32_bf16 v[32:35], a[48:51], a[0:3], v[32:35]
ds_read_b64_tr_b16 a[110:111], v14 offset:10496
s_waitcnt lgkmcnt(5)
v_mfma_f32_16x16x32_bf16 v[64:67], a[48:51], a[4:7], v[64:67]
ds_read_b64_tr_b16 a[112:113], v15 offset:10240
s_add_u32 m0, s16, 0x8000
v_mfma_f32_16x16x32_bf16 v[96:99], a[48:51], a[8:11], v[96:99]
buffer_load_dwordx4 v22, s[44:47], s20 offen lds
v_mfma_f32_16x16x32_bf16 v[128:131], a[48:51], a[12:15], v[128:131]
ds_read_b64_tr_b16 a[114:115], v15 offset:10496
v_mfma_f32_16x16x32_bf16 v[132:135], a[52:55], a[12:15], v[132:135]
ds_read_b64_tr_b16 a[40:41], v12 offset:8192
v_mfma_f32_16x16x32_bf16 v[100:103], a[52:55], a[8:11], v[100:103]
ds_read_b64_tr_b16 a[42:43], v12 offset:9216
s_add_u32 m0, s16, 0x8400
v_mfma_f32_16x16x32_bf16 v[68:71], a[52:55], a[4:7], v[68:71]
buffer_load_dwordx4 v23, s[44:47], s20 offen lds
v_mfma_f32_16x16x32_bf16 v[36:39], a[52:55], a[0:3], v[36:39]
ds_read_b64_tr_b16 a[44:45], v13 offset:8192
v_mfma_f32_16x16x32_bf16 v[40:43], a[56:59], a[0:3], v[40:43]
ds_read_b64_tr_b16 a[46:47], v13 offset:9216
v_mfma_f32_16x16x32_bf16 v[72:75], a[56:59], a[4:7], v[72:75]
ds_read_b64_tr_b16 a[48:49], v12 offset:8448
v_mfma_f32_16x16x32_bf16 v[104:107], a[56:59], a[8:11], v[104:107]
ds_read_b64_tr_b16 a[50:51], v12 offset:9472
s_add_u32 m0, s16, 0x8800
v_mfma_f32_16x16x32_bf16 v[136:139], a[56:59], a[12:15], v[136:139]
buffer_load_dwordx4 v22, s[44:47], s21 offen lds
v_mfma_f32_16x16x32_bf16 v[140:143], a[60:63], a[12:15], v[140:143]
ds_read_b64_tr_b16 a[52:53], v13 offset:8448
v_mfma_f32_16x16x32_bf16 v[108:111], a[60:63], a[8:11], v[108:111]
ds_read_b64_tr_b16 a[54:55], v13 offset:9472
v_mfma_f32_16x16x32_bf16 v[76:79], a[60:63], a[4:7], v[76:79]
ds_read_b64_tr_b16 a[56:57], v12 offset:8704
s_add_u32 m0, s16, 0x8c00
v_mfma_f32_16x16x32_bf16 v[44:47], a[60:63], a[0:3], v[44:47]
buffer_load_dwordx4 v23, s[44:47], s21 offen lds
v_mfma_f32_16x16x32_bf16 v[48:51], a[64:67], a[0:3], v[48:51]
ds_read_b64_tr_b16 a[58:59], v12 offset:9728
v_mfma_f32_16x16x32_bf16 v[80:83], a[64:67], a[4:7], v[80:83]
ds_read_b64_tr_b16 a[60:61], v13 offset:8704
v_mfma_f32_16x16x32_bf16 v[112:115], a[64:67], a[8:11], v[112:115]
ds_read_b64_tr_b16 a[62:63], v13 offset:9728
v_mfma_f32_16x16x32_bf16 v[144:147], a[64:67], a[12:15], v[144:147]
ds_read_b64_tr_b16 a[64:65], v12 offset:8960
s_add_u32 s8, s28, 0x7000
v_mfma_f32_16x16x32_bf16 v[148:151], a[68:71], a[12:15], v[148:151]
buffer_store_dwordx4 a[176:179], v16, s[88:91], s8 offen sc1
v_mfma_f32_16x16x32_bf16 v[116:119], a[68:71], a[8:11], v[116:119]
ds_read_b64_tr_b16 a[66:67], v12 offset:9984
v_mfma_f32_16x16x32_bf16 v[84:87], a[68:71], a[4:7], v[84:87]
v_mfma_f32_16x16x32_bf16 v[52:55], a[68:71], a[0:3], v[52:55]
ds_read_b64_tr_b16 a[68:69], v13 offset:8960
v_mfma_f32_16x16x32_bf16 v[152:155], a[72:75], a[0:3], v[152:155]
ds_read_b64_tr_b16 a[70:71], v13 offset:9984
s_add_u32 m0, s16, 0x9000
v_mfma_f32_16x16x32_bf16 v[160:163], a[72:75], a[4:7], v[160:163]
buffer_load_dwordx4 v22, s[44:47], s22 offen lds
v_mfma_f32_16x16x32_bf16 v[168:171], a[72:75], a[8:11], v[168:171]
v_mfma_f32_16x16x32_bf16 v[176:179], a[72:75], a[12:15], v[176:179]
ds_read_b64_tr_b16 a[72:73], v14 offset:2048
v_mfma_f32_16x16x32_bf16 v[180:183], a[76:79], a[12:15], v[180:183]
ds_read_b64_tr_b16 a[74:75], v14 offset:2304
s_add_u32 m0, s16, 0x9400
v_mfma_f32_16x16x32_bf16 v[172:175], a[76:79], a[8:11], v[172:175]
buffer_load_dwordx4 v23, s[44:47], s22 offen lds
v_mfma_f32_16x16x32_bf16 v[164:167], a[76:79], a[4:7], v[164:167]
v_mfma_f32_16x16x32_bf16 v[156:159], a[76:79], a[0:3], v[156:159]
ds_read_b64_tr_b16 a[76:77], v15 offset:2048
v_mfma_f32_16x16x32_bf16 v[184:187], a[80:83], a[0:3], v[184:187]
ds_read_b64_tr_b16 a[78:79], v15 offset:2304
v_mfma_f32_16x16x32_bf16 v[192:195], a[80:83], a[4:7], v[192:195]
s_add_u32 m0, s16, 0x9800
v_mfma_f32_16x16x32_bf16 v[200:203], a[80:83], a[8:11], v[200:203]
buffer_load_dwordx4 v22, s[44:47], s23 offen lds
v_mfma_f32_16x16x32_bf16 v[208:211], a[80:83], a[12:15], v[208:211]
v_mfma_f32_16x16x32_bf16 v[248:251], a[80:83], a[16:19], v[248:251]
ds_read_b64_tr_b16 a[80:81], v14 offset:6144
v_mfma_f32_16x16x32_bf16 v[212:215], a[84:87], a[12:15], v[212:215]
ds_read_b64_tr_b16 a[82:83], v14 offset:6400
s_add_u32 m0, s16, 0x9c00
v_mfma_f32_16x16x32_bf16 v[204:207], a[84:87], a[8:11], v[204:207]
buffer_load_dwordx4 v23, s[44:47], s23 offen lds
v_mfma_f32_16x16x32_bf16 v[196:199], a[84:87], a[4:7], v[196:199]
v_add_u32 v12, 0xffff0000, v12
v_add_u32 v13, 0xffff0000, v13
v_mfma_f32_16x16x32_bf16 v[188:191], a[84:87], a[0:3], v[188:191]
v_add_u32 v14, 0xffff0000, v14
v_add_u32 v15, 0xffff0000, v15
v_mfma_f32_16x16x32_bf16 v[216:219], a[0:3], a[88:91], v[216:219]
v_add_u32 v10, 0xffff0000, v10
v_add_u32 v11, 0xffff0000, v11
v_mfma_f32_16x16x32_bf16 v[224:227], a[4:7], a[88:91], v[224:227]
s_add_u32 s8, s28, 0x7400
v_mfma_f32_16x16x32_bf16 v[232:235], a[8:11], a[88:91], v[232:235]
buffer_store_dwordx4 a[180:183], v16, s[88:91], s8 offen sc1
v_mfma_f32_16x16x32_bf16 v[240:243], a[12:15], a[88:91], v[240:243]
v_mfma_f32_16x16x32_bf16 v[252:255], a[16:19], a[88:91], v[252:255]
v_mfma_f32_16x16x32_bf16 v[244:247], a[12:15], a[92:95], v[244:247]
v_mfma_f32_16x16x32_bf16 v[236:239], a[8:11], a[92:95], v[236:239]
v_mfma_f32_16x16x32_bf16 v[228:231], a[4:7], a[92:95], v[228:231]
v_mfma_f32_16x16x32_bf16 v[220:223], a[0:3], a[92:95], v[220:223]
s_waitcnt vmcnt(21) lgkmcnt(0)
s_barrier
v_mfma_f32_16x16x32_bf16 v[24:27], a[40:43], a[20:23], v[24:27]
ds_read_b128 a[0:3], v8 offset:0
s_add_u32 m0, s17, 0x10000
v_mfma_f32_16x16x32_bf16 v[56:59], a[40:43], a[24:27], v[56:59]
buffer_load_dwordx4 v5, s[52:55], 0 offen lds
v_mfma_f32_16x16x32_bf16 v[88:91], a[40:43], a[28:31], v[88:91]
ds_read_b128 a[4:7], v8 offset:2048
v_add_u32 v22, 0x80, v22
v_mfma_f32_16x16x32_bf16 v[120:123], a[40:43], a[32:35], v[120:123]
ds_read_b128 a[8:11], v8 offset:4096
v_add_u32 v23, 0x80, v23
v_mfma_f32_16x16x32_bf16 v[124:127], a[44:47], a[32:35], v[124:127]
ds_read_b128 a[12:15], v8 offset:6144
v_mfma_f32_16x16x32_bf16 v[92:95], a[44:47], a[28:31], v[92:95]
ds_read_b128 a[16:19], v10
s_add_u32 m0, s17, 0x10400
v_mfma_f32_16x16x32_bf16 v[60:63], a[44:47], a[24:27], v[60:63]
buffer_load_dwordx4 v5, s[52:55], s13 offen lds
v_mfma_f32_16x16x32_bf16 v[28:31], a[44:47], a[20:23], v[28:31]
ds_read_b64_tr_b16 a[84:85], v15 offset:4096
v_mfma_f32_16x16x32_bf16 v[32:35], a[48:51], a[20:23], v[32:35]
ds_read_b64_tr_b16 a[86:87], v15 offset:4352
v_mfma_f32_16x16x32_bf16 v[64:67], a[48:51], a[24:27], v[64:67]
ds_read_b64_tr_b16 a[88:89], v14 offset:8192
v_mfma_f32_16x16x32_bf16 v[96:99], a[48:51], a[28:31], v[96:99]
ds_read_b64_tr_b16 a[90:91], v14 offset:8448
v_mfma_f32_16x16x32_bf16 v[128:131], a[48:51], a[32:35], v[128:131]
ds_read_b64_tr_b16 a[92:93], v15 offset:8192
s_add_u32 m0, s17, 0x10800
v_mfma_f32_16x16x32_bf16 v[132:135], a[52:55], a[32:35], v[132:135]
buffer_load_dwordx4 v6, s[52:55], 0 offen lds
v_mfma_f32_16x16x32_bf16 v[100:103], a[52:55], a[28:31], v[100:103]
ds_read_b64_tr_b16 a[94:95], v15 offset:8448
v_mfma_f32_16x16x32_bf16 v[68:71], a[52:55], a[24:27], v[68:71]
ds_read_b64_tr_b16 a[40:41], v12 offset:0
v_mfma_f32_16x16x32_bf16 v[36:39], a[52:55], a[20:23], v[36:39]
ds_read_b64_tr_b16 a[42:43], v12 offset:1024
v_mfma_f32_16x16x32_bf16 v[40:43], a[56:59], a[20:23], v[40:43]
ds_read_b64_tr_b16 a[44:45], v13 offset:0
s_add_u32 m0, s17, 0x10c00
v_mfma_f32_16x16x32_bf16 v[72:75], a[56:59], a[24:27], v[72:75]
buffer_load_dwordx4 v6, s[52:55], s13 offen lds
v_mfma_f32_16x16x32_bf16 v[104:107], a[56:59], a[28:31], v[104:107]
ds_read_b64_tr_b16 a[46:47], v13 offset:1024
v_mfma_f32_16x16x32_bf16 v[136:139], a[56:59], a[32:35], v[136:139]
ds_read_b64_tr_b16 a[48:49], v12 offset:256
v_mfma_f32_16x16x32_bf16 v[140:143], a[60:63], a[32:35], v[140:143]
ds_read_b64_tr_b16 a[50:51], v12 offset:1280
v_mfma_f32_16x16x32_bf16 v[108:111], a[60:63], a[28:31], v[108:111]
ds_read_b64_tr_b16 a[52:53], v13 offset:256
v_mfma_f32_16x16x32_bf16 v[76:79], a[60:63], a[24:27], v[76:79]
ds_read_b64_tr_b16 a[54:55], v13 offset:1280
s_add_u32 s8, s28, 0x7800
v_mfma_f32_16x16x32_bf16 v[44:47], a[60:63], a[20:23], v[44:47]
buffer_store_dwordx4 a[184:187], v16, s[88:91], s8 offen sc1
v_mfma_f32_16x16x32_bf16 v[48:51], a[64:67], a[20:23], v[48:51]
ds_read_b64_tr_b16 a[56:57], v12 offset:512
v_mfma_f32_16x16x32_bf16 v[80:83], a[64:67], a[24:27], v[80:83]
ds_read_b64_tr_b16 a[58:59], v12 offset:1536
v_mfma_f32_16x16x32_bf16 v[112:115], a[64:67], a[28:31], v[112:115]
ds_read_b64_tr_b16 a[60:61], v13 offset:512
v_mfma_f32_16x16x32_bf16 v[144:147], a[64:67], a[32:35], v[144:147]
ds_read_b64_tr_b16 a[62:63], v13 offset:1536
s_add_u32 m0, s18, 0x14000
v_mfma_f32_16x16x32_bf16 v[148:151], a[68:71], a[32:35], v[148:151]
buffer_load_dwordx4 v7, s[68:71], 0 offen lds
v_mfma_f32_16x16x32_bf16 v[116:119], a[68:71], a[28:31], v[116:119]
ds_read_b64_tr_b16 a[64:65], v12 offset:768
v_mfma_f32_16x16x32_bf16 v[84:87], a[68:71], a[24:27], v[84:87]
ds_read_b64_tr_b16 a[66:67], v12 offset:1792
v_mfma_f32_16x16x32_bf16 v[52:55], a[68:71], a[20:23], v[52:55]
ds_read_b64_tr_b16 a[68:69], v13 offset:768
v_mfma_f32_16x16x32_bf16 v[152:155], a[72:75], a[20:23], v[152:155]
ds_read_b64_tr_b16 a[70:71], v13 offset:1792
v_mfma_f32_16x16x32_bf16 v[160:163], a[72:75], a[24:27], v[160:163]
s_add_u32 m0, s18, 0x15000
v_mfma_f32_16x16x32_bf16 v[168:171], a[72:75], a[28:31], v[168:171]
buffer_load_dwordx4 v7, s[68:71], s25 offen lds
v_mfma_f32_16x16x32_bf16 v[176:179], a[72:75], a[32:35], v[176:179]
ds_read_b64_tr_b16 a[72:73], v14 offset:0
v_mfma_f32_16x16x32_bf16 v[180:183], a[76:79], a[32:35], v[180:183]
ds_read_b64_tr_b16 a[74:75], v14 offset:256
v_mfma_f32_16x16x32_bf16 v[172:175], a[76:79], a[28:31], v[172:175]
v_mfma_f32_16x16x32_bf16 v[164:167], a[76:79], a[24:27], v[164:167]
s_add_u32 m0, s18, 0x16000
v_mfma_f32_16x16x32_bf16 v[156:159], a[76:79], a[20:23], v[156:159]
buffer_load_dwordx4 v7, s[68:71], s26 offen lds
v_mfma_f32_16x16x32_bf16 v[184:187], a[80:83], a[20:23], v[184:187]
ds_read_b64_tr_b16 a[76:77], v15 offset:0
v_mfma_f32_16x16x32_bf16 v[192:195], a[80:83], a[24:27], v[192:195]
ds_read_b64_tr_b16 a[78:79], v15 offset:256
v_mfma_f32_16x16x32_bf16 v[200:203], a[80:83], a[28:31], v[200:203]
v_mfma_f32_16x16x32_bf16 v[208:211], a[80:83], a[32:35], v[208:211]
v_mfma_f32_16x16x32_bf16 v[248:251], a[80:83], a[36:39], v[248:251]
ds_read_b64_tr_b16 a[80:81], v14 offset:4096
s_add_u32 m0, s18, 0x17000
v_mfma_f32_16x16x32_bf16 v[212:215], a[104:107], a[32:35], v[212:215]
buffer_load_dwordx4 v4, s[44:47], s24 offen lds
v_mfma_f32_16x16x32_bf16 v[204:207], a[104:107], a[28:31], v[204:207]
ds_read_b64_tr_b16 a[82:83], v14 offset:4352
v_mfma_f32_16x16x32_bf16 v[196:199], a[104:107], a[24:27], v[196:199]
v_mfma_f32_16x16x32_bf16 v[188:191], a[104:107], a[20:23], v[188:191]
v_mfma_f32_16x16x32_bf16 v[216:219], a[20:23], a[108:111], v[216:219]
s_add_u32 s8, s28, 0x7c00
v_mfma_f32_16x16x32_bf16 v[224:227], a[24:27], a[108:111], v[224:227]
buffer_store_dwordx4 a[188:191], v16, s[88:91], s8 offen sc1
v_mfma_f32_16x16x32_bf16 v[232:235], a[28:31], a[108:111], v[232:235]
v_mfma_f32_16x16x32_bf16 v[240:243], a[32:35], a[108:111], v[240:243]
v_mfma_f32_16x16x32_bf16 v[252:255], a[36:39], a[108:111], v[252:255]
v_mfma_f32_16x16x32_bf16 v[244:247], a[32:35], a[112:115], v[244:247]
v_mfma_f32_16x16x32_bf16 v[236:239], a[28:31], a[112:115], v[236:239]
v_mfma_f32_16x16x32_bf16 v[228:231], a[24:27], a[112:115], v[228:231]
v_mfma_f32_16x16x32_bf16 v[220:223], a[20:23], a[112:115], v[220:223]
s_waitcnt lgkmcnt(0)
v_mfma_f32_16x16x32_bf16 v[24:27], a[40:43], a[0:3], v[24:27]
ds_read_b128 a[20:23], v9 offset:0
v_add_u32 v5, 0x80000, v5
v_mfma_f32_16x16x32_bf16 v[56:59], a[40:43], a[4:7], v[56:59]
ds_read_b128 a[24:27], v9 offset:2048
v_add_u32 v6, 0x80000, v6
v_mfma_f32_16x16x32_bf16 v[88:91], a[40:43], a[8:11], v[88:91]
ds_read_b128 a[28:31], v9 offset:4096
v_add_u32 v7, 0x60000, v7
v_mfma_f32_16x16x32_bf16 v[120:123], a[40:43], a[12:15], v[120:123]
ds_read_b128 a[32:35], v9 offset:6144
v_add_u32 v4, 0x80, v4
v_mfma_f32_16x16x32_bf16 v[124:127], a[44:47], a[12:15], v[124:127]
ds_read_b128 a[36:39], v11
v_mfma_f32_16x16x32_bf16 v[92:95], a[44:47], a[8:11], v[92:95]
ds_read_b64_tr_b16 a[104:105], v15 offset:6144
v_mfma_f32_16x16x32_bf16 v[60:63], a[44:47], a[4:7], v[60:63]
ds_read_b64_tr_b16 a[106:107], v15 offset:6400
v_mfma_f32_16x16x32_bf16 v[28:31], a[44:47], a[0:3], v[28:31]
ds_read_b64_tr_b16 a[108:109], v14 offset:10240
v_mfma_f32_16x16x32_bf16 v[32:35], a[48:51], a[0:3], v[32:35]
ds_read_b64_tr_b16 a[110:111], v14 offset:10496
s_waitcnt lgkmcnt(5)
v_mfma_f32_16x16x32_bf16 v[64:67], a[48:51], a[4:7], v[64:67]
ds_read_b64_tr_b16 a[112:113], v15 offset:10240
s_add_u32 m0, s16, 0x0
v_mfma_f32_16x16x32_bf16 v[96:99], a[48:51], a[8:11], v[96:99]
buffer_load_dwordx4 v22, s[44:47], s20 offen lds
v_mfma_f32_16x16x32_bf16 v[128:131], a[48:51], a[12:15], v[128:131]
ds_read_b64_tr_b16 a[114:115], v15 offset:10496
v_mfma_f32_16x16x32_bf16 v[132:135], a[52:55], a[12:15], v[132:135]
ds_read_b64_tr_b16 a[40:41], v12 offset:8192
v_mfma_f32_16x16x32_bf16 v[100:103], a[52:55], a[8:11], v[100:103]
ds_read_b64_tr_b16 a[42:43], v12 offset:9216
s_add_u32 m0, s16, 0x400
v_mfma_f32_16x16x32_bf16 v[68:71], a[52:55], a[4:7], v[68:71]
buffer_load_dwordx4 v23, s[44:47], s20 offen lds
v_mfma_f32_16x16x32_bf16 v[36:39], a[52:55], a[0:3], v[36:39]
ds_read_b64_tr_b16 a[44:45], v13 offset:8192
v_mfma_f32_16x16x32_bf16 v[40:43], a[56:59], a[0:3], v[40:43]
ds_read_b64_tr_b16 a[46:47], v13 offset:9216
v_mfma_f32_16x16x32_bf16 v[72:75], a[56:59], a[4:7], v[72:75]
ds_read_b64_tr_b16 a[48:49], v12 offset:8448
v_mfma_f32_16x16x32_bf16 v[104:107], a[56:59], a[8:11], v[104:107]
ds_read_b64_tr_b16 a[50:51], v12 offset:9472
s_add_u32 m0, s16, 0x800
v_mfma_f32_16x16x32_bf16 v[136:139], a[56:59], a[12:15], v[136:139]
buffer_load_dwordx4 v22, s[44:47], s21 offen lds
v_mfma_f32_16x16x32_bf16 v[140:143], a[60:63], a[12:15], v[140:143]
ds_read_b64_tr_b16 a[52:53], v13 offset:8448
v_mfma_f32_16x16x32_bf16 v[108:111], a[60:63], a[8:11], v[108:111]
ds_read_b64_tr_b16 a[54:55], v13 offset:9472
v_mfma_f32_16x16x32_bf16 v[76:79], a[60:63], a[4:7], v[76:79]
ds_read_b64_tr_b16 a[56:57], v12 offset:8704
s_add_u32 m0, s16, 0xc00
v_mfma_f32_16x16x32_bf16 v[44:47], a[60:63], a[0:3], v[44:47]
buffer_load_dwordx4 v23, s[44:47], s21 offen lds
v_mfma_f32_16x16x32_bf16 v[48:51], a[64:67], a[0:3], v[48:51]
ds_read_b64_tr_b16 a[58:59], v12 offset:9728
v_mfma_f32_16x16x32_bf16 v[80:83], a[64:67], a[4:7], v[80:83]
ds_read_b64_tr_b16 a[60:61], v13 offset:8704
v_mfma_f32_16x16x32_bf16 v[112:115], a[64:67], a[8:11], v[112:115]
ds_read_b64_tr_b16 a[62:63], v13 offset:9728
v_mfma_f32_16x16x32_bf16 v[144:147], a[64:67], a[12:15], v[144:147]
ds_read_b64_tr_b16 a[64:65], v12 offset:8960
s_add_u32 s8, s28, 0x4000
v_mfma_f32_16x16x32_bf16 v[148:151], a[68:71], a[12:15], v[148:151]
buffer_store_dwordx4 a[192:195], v16, s[88:91], s8 offen sc1
v_mfma_f32_16x16x32_bf16 v[116:119], a[68:71], a[8:11], v[116:119]
ds_read_b64_tr_b16 a[66:67], v12 offset:9984
v_mfma_f32_16x16x32_bf16 v[84:87], a[68:71], a[4:7], v[84:87]
v_mfma_f32_16x16x32_bf16 v[52:55], a[68:71], a[0:3], v[52:55]
ds_read_b64_tr_b16 a[68:69], v13 offset:8960
v_mfma_f32_16x16x32_bf16 v[152:155], a[72:75], a[0:3], v[152:155]
ds_read_b64_tr_b16 a[70:71], v13 offset:9984
s_add_u32 m0, s16, 0x1000
v_mfma_f32_16x16x32_bf16 v[160:163], a[72:75], a[4:7], v[160:163]
buffer_load_dwordx4 v22, s[44:47], s22 offen lds
v_mfma_f32_16x16x32_bf16 v[168:171], a[72:75], a[8:11], v[168:171]
v_mfma_f32_16x16x32_bf16 v[176:179], a[72:75], a[12:15], v[176:179]
ds_read_b64_tr_b16 a[72:73], v14 offset:2048
v_mfma_f32_16x16x32_bf16 v[180:183], a[76:79], a[12:15], v[180:183]
ds_read_b64_tr_b16 a[74:75], v14 offset:2304
s_add_u32 m0, s16, 0x1400
v_mfma_f32_16x16x32_bf16 v[172:175], a[76:79], a[8:11], v[172:175]
buffer_load_dwordx4 v23, s[44:47], s22 offen lds
v_mfma_f32_16x16x32_bf16 v[164:167], a[76:79], a[4:7], v[164:167]
v_mfma_f32_16x16x32_bf16 v[156:159], a[76:79], a[0:3], v[156:159]
ds_read_b64_tr_b16 a[76:77], v15 offset:2048
v_mfma_f32_16x16x32_bf16 v[184:187], a[80:83], a[0:3], v[184:187]
ds_read_b64_tr_b16 a[78:79], v15 offset:2304
v_mfma_f32_16x16x32_bf16 v[192:195], a[80:83], a[4:7], v[192:195]
s_add_u32 m0, s16, 0x1800
v_mfma_f32_16x16x32_bf16 v[200:203], a[80:83], a[8:11], v[200:203]
buffer_load_dwordx4 v22, s[44:47], s23 offen lds
v_mfma_f32_16x16x32_bf16 v[208:211], a[80:83], a[12:15], v[208:211]
v_mfma_f32_16x16x32_bf16 v[248:251], a[80:83], a[16:19], v[248:251]
ds_read_b64_tr_b16 a[80:81], v14 offset:6144
v_mfma_f32_16x16x32_bf16 v[212:215], a[84:87], a[12:15], v[212:215]
ds_read_b64_tr_b16 a[82:83], v14 offset:6400
s_add_u32 m0, s16, 0x1c00
v_mfma_f32_16x16x32_bf16 v[204:207], a[84:87], a[8:11], v[204:207]
buffer_load_dwordx4 v23, s[44:47], s23 offen lds
v_mfma_f32_16x16x32_bf16 v[196:199], a[84:87], a[4:7], v[196:199]
v_add_u32 v12, 0x8000, v12
v_add_u32 v13, 0x8000, v13
v_mfma_f32_16x16x32_bf16 v[188:191], a[84:87], a[0:3], v[188:191]
v_add_u32 v14, 0x8000, v14
v_add_u32 v15, 0x8000, v15
v_mfma_f32_16x16x32_bf16 v[216:219], a[0:3], a[88:91], v[216:219]
v_add_u32 v10, 0x8000, v10
v_add_u32 v11, 0x8000, v11
v_mfma_f32_16x16x32_bf16 v[224:227], a[4:7], a[88:91], v[224:227]
s_add_u32 s8, s28, 0x4400
v_mfma_f32_16x16x32_bf16 v[232:235], a[8:11], a[88:91], v[232:235]
buffer_store_dwordx4 a[196:199], v16, s[88:91], s8 offen sc1
v_mfma_f32_16x16x32_bf16 v[240:243], a[12:15], a[88:91], v[240:243]
v_mfma_f32_16x16x32_bf16 v[252:255], a[16:19], a[88:91], v[252:255]
v_mfma_f32_16x16x32_bf16 v[244:247], a[12:15], a[92:95], v[244:247]
v_mfma_f32_16x16x32_bf16 v[236:239], a[8:11], a[92:95], v[236:239]
v_mfma_f32_16x16x32_bf16 v[228:231], a[4:7], a[92:95], v[228:231]
v_mfma_f32_16x16x32_bf16 v[220:223], a[0:3], a[92:95], v[220:223]
s_waitcnt vmcnt(21) lgkmcnt(0)
s_barrier
v_mfma_f32_16x16x32_bf16 v[24:27], a[40:43], a[20:23], v[24:27]
ds_read_b128 a[0:3], v8 offset:32768
s_add_u32 m0, s17, 0x0
v_mfma_f32_16x16x32_bf16 v[56:59], a[40:43], a[24:27], v[56:59]
buffer_load_dwordx4 v5, s[52:55], 0 offen lds
v_mfma_f32_16x16x32_bf16 v[88:91], a[40:43], a[28:31], v[88:91]
ds_read_b128 a[4:7], v8 offset:34816
v_add_u32 v22, 0x80, v22
v_mfma_f32_16x16x32_bf16 v[120:123], a[40:43], a[32:35], v[120:123]
ds_read_b128 a[8:11], v8 offset:36864
v_add_u32 v23, 0x80, v23
v_mfma_f32_16x16x32_bf16 v[124:127], a[44:47], a[32:35], v[124:127]
ds_read_b128 a[12:15], v8 offset:38912
v_mfma_f32_16x16x32_bf16 v[92:95], a[44:47], a[28:31], v[92:95]
ds_read_b128 a[16:19], v10
s_add_u32 m0, s17, 0x400
v_mfma_f32_16x16x32_bf16 v[60:63], a[44:47], a[24:27], v[60:63]
buffer_load_dwordx4 v5, s[52:55], s13 offen lds
v_mfma_f32_16x16x32_bf16 v[28:31], a[44:47], a[20:23], v[28:31]
ds_read_b64_tr_b16 a[84:85], v15 offset:4096
v_mfma_f32_16x16x32_bf16 v[32:35], a[48:51], a[20:23], v[32:35]
ds_read_b64_tr_b16 a[86:87], v15 offset:4352
v_mfma_f32_16x16x32_bf16 v[64:67], a[48:51], a[24:27], v[64:67]
ds_read_b64_tr_b16 a[88:89], v14 offset:8192
v_mfma_f32_16x16x32_bf16 v[96:99], a[48:51], a[28:31], v[96:99]
ds_read_b64_tr_b16 a[90:91], v14 offset:8448
v_mfma_f32_16x16x32_bf16 v[128:131], a[48:51], a[32:35], v[128:131]
ds_read_b64_tr_b16 a[92:93], v15 offset:8192
s_add_u32 m0, s17, 0x800
v_mfma_f32_16x16x32_bf16 v[132:135], a[52:55], a[32:35], v[132:135]
buffer_load_dwordx4 v6, s[52:55], 0 offen lds
v_mfma_f32_16x16x32_bf16 v[100:103], a[52:55], a[28:31], v[100:103]
ds_read_b64_tr_b16 a[94:95], v15 offset:8448
v_mfma_f32_16x16x32_bf16 v[68:71], a[52:55], a[24:27], v[68:71]
ds_read_b64_tr_b16 a[40:41], v12 offset:0
v_mfma_f32_16x16x32_bf16 v[36:39], a[52:55], a[20:23], v[36:39]
ds_read_b64_tr_b16 a[42:43], v12 offset:1024
v_mfma_f32_16x16x32_bf16 v[40:43], a[56:59], a[20:23], v[40:43]
ds_read_b64_tr_b16 a[44:45], v13 offset:0
s_add_u32 m0, s17, 0xc00
v_mfma_f32_16x16x32_bf16 v[72:75], a[56:59], a[24:27], v[72:75]
buffer_load_dwordx4 v6, s[52:55], s13 offen lds
v_mfma_f32_16x16x32_bf16 v[104:107], a[56:59], a[28:31], v[104:107]
ds_read_b64_tr_b16 a[46:47], v13 offset:1024
v_mfma_f32_16x16x32_bf16 v[136:139], a[56:59], a[32:35], v[136:139]
ds_read_b64_tr_b16 a[48:49], v12 offset:256
v_mfma_f32_16x16x32_bf16 v[140:143], a[60:63], a[32:35], v[140:143]
ds_read_b64_tr_b16 a[50:51], v12 offset:1280
v_mfma_f32_16x16x32_bf16 v[108:111], a[60:63], a[28:31], v[108:111]
ds_read_b64_tr_b16 a[52:53], v13 offset:256
v_mfma_f32_16x16x32_bf16 v[76:79], a[60:63], a[24:27], v[76:79]
ds_read_b64_tr_b16 a[54:55], v13 offset:1280
s_add_u32 s8, s28, 0x4800
v_mfma_f32_16x16x32_bf16 v[44:47], a[60:63], a[20:23], v[44:47]
buffer_store_dwordx4 a[200:203], v16, s[88:91], s8 offen sc1
v_mfma_f32_16x16x32_bf16 v[48:51], a[64:67], a[20:23], v[48:51]
ds_read_b64_tr_b16 a[56:57], v12 offset:512
v_mfma_f32_16x16x32_bf16 v[80:83], a[64:67], a[24:27], v[80:83]
ds_read_b64_tr_b16 a[58:59], v12 offset:1536
v_mfma_f32_16x16x32_bf16 v[112:115], a[64:67], a[28:31], v[112:115]
ds_read_b64_tr_b16 a[60:61], v13 offset:512
v_mfma_f32_16x16x32_bf16 v[144:147], a[64:67], a[32:35], v[144:147]
ds_read_b64_tr_b16 a[62:63], v13 offset:1536
s_add_u32 m0, s18, 0x4000
v_mfma_f32_16x16x32_bf16 v[148:151], a[68:71], a[32:35], v[148:151]
buffer_load_dwordx4 v7, s[68:71], 0 offen lds
v_mfma_f32_16x16x32_bf16 v[116:119], a[68:71], a[28:31], v[116:119]
ds_read_b64_tr_b16 a[64:65], v12 offset:768
v_mfma_f32_16x16x32_bf16 v[84:87], a[68:71], a[24:27], v[84:87]
ds_read_b64_tr_b16 a[66:67], v12 offset:1792
v_mfma_f32_16x16x32_bf16 v[52:55], a[68:71], a[20:23], v[52:55]
ds_read_b64_tr_b16 a[68:69], v13 offset:768
v_mfma_f32_16x16x32_bf16 v[152:155], a[72:75], a[20:23], v[152:155]
ds_read_b64_tr_b16 a[70:71], v13 offset:1792
v_mfma_f32_16x16x32_bf16 v[160:163], a[72:75], a[24:27], v[160:163]
s_add_u32 m0, s18, 0x5000
v_mfma_f32_16x16x32_bf16 v[168:171], a[72:75], a[28:31], v[168:171]
buffer_load_dwordx4 v7, s[68:71], s25 offen lds
v_mfma_f32_16x16x32_bf16 v[176:179], a[72:75], a[32:35], v[176:179]
ds_read_b64_tr_b16 a[72:73], v14 offset:0
v_mfma_f32_16x16x32_bf16 v[180:183], a[76:79], a[32:35], v[180:183]
ds_read_b64_tr_b16 a[74:75], v14 offset:256
v_mfma_f32_16x16x32_bf16 v[172:175], a[76:79], a[28:31], v[172:175]
v_mfma_f32_16x16x32_bf16 v[164:167], a[76:79], a[24:27], v[164:167]
s_add_u32 m0, s18, 0x6000
v_mfma_f32_16x16x32_bf16 v[156:159], a[76:79], a[20:23], v[156:159]
buffer_load_dwordx4 v7, s[68:71], s26 offen lds
v_mfma_f32_16x16x32_bf16 v[184:187], a[80:83], a[20:23], v[184:187]
ds_read_b64_tr_b16 a[76:77], v15 offset:0
v_mfma_f32_16x16x32_bf16 v[192:195], a[80:83], a[24:27], v[192:195]
ds_read_b64_tr_b16 a[78:79], v15 offset:256
v_mfma_f32_16x16x32_bf16 v[200:203], a[80:83], a[28:31], v[200:203]
v_mfma_f32_16x16x32_bf16 v[208:211], a[80:83], a[32:35], v[208:211]
v_mfma_f32_16x16x32_bf16 v[248:251], a[80:83], a[36:39], v[248:251]
ds_read_b64_tr_b16 a[80:81], v14 offset:4096
s_add_u32 m0, s18, 0x7000
v_mfma_f32_16x16x32_bf16 v[212:215], a[104:107], a[32:35], v[212:215]
buffer_load_dwordx4 v4, s[44:47], s24 offen lds
v_mfma_f32_16x16x32_bf16 v[204:207], a[104:107], a[28:31], v[204:207]
ds_read_b64_tr_b16 a[82:83], v14 offset:4352
v_mfma_f32_16x16x32_bf16 v[196:199], a[104:107], a[24:27], v[196:199]
v_mfma_f32_16x16x32_bf16 v[188:191], a[104:107], a[20:23], v[188:191]
v_mfma_f32_16x16x32_bf16 v[216:219], a[20:23], a[108:111], v[216:219]
s_add_u32 s8, s28, 0x4c00
v_mfma_f32_16x16x32_bf16 v[224:227], a[24:27], a[108:111], v[224:227]
buffer_store_dwordx4 a[204:207], v16, s[88:91], s8 offen sc1
v_mfma_f32_16x16x32_bf16 v[232:235], a[28:31], a[108:111], v[232:235]
v_mfma_f32_16x16x32_bf16 v[240:243], a[32:35], a[108:111], v[240:243]
v_mfma_f32_16x16x32_bf16 v[252:255], a[36:39], a[108:111], v[252:255]
v_mfma_f32_16x16x32_bf16 v[244:247], a[32:35], a[112:115], v[244:247]
v_mfma_f32_16x16x32_bf16 v[236:239], a[28:31], a[112:115], v[236:239]
v_mfma_f32_16x16x32_bf16 v[228:231], a[24:27], a[112:115], v[228:231]
v_mfma_f32_16x16x32_bf16 v[220:223], a[20:23], a[112:115], v[220:223]
s_waitcnt lgkmcnt(0)
v_mfma_f32_16x16x32_bf16 v[24:27], a[40:43], a[0:3], v[24:27]
ds_read_b128 a[20:23], v9 offset:32768
v_add_u32 v5, 0x80000, v5
v_mfma_f32_16x16x32_bf16 v[56:59], a[40:43], a[4:7], v[56:59]
ds_read_b128 a[24:27], v9 offset:34816
v_add_u32 v6, 0x80000, v6
v_mfma_f32_16x16x32_bf16 v[88:91], a[40:43], a[8:11], v[88:91]
ds_read_b128 a[28:31], v9 offset:36864
v_add_u32 v7, 0x60000, v7
v_mfma_f32_16x16x32_bf16 v[120:123], a[40:43], a[12:15], v[120:123]
ds_read_b128 a[32:35], v9 offset:38912
v_add_u32 v4, 0x80, v4
v_mfma_f32_16x16x32_bf16 v[124:127], a[44:47], a[12:15], v[124:127]
ds_read_b128 a[36:39], v11
v_mfma_f32_16x16x32_bf16 v[92:95], a[44:47], a[8:11], v[92:95]
ds_read_b64_tr_b16 a[104:105], v15 offset:6144
v_mfma_f32_16x16x32_bf16 v[60:63], a[44:47], a[4:7], v[60:63]
ds_read_b64_tr_b16 a[106:107], v15 offset:6400
v_mfma_f32_16x16x32_bf16 v[28:31], a[44:47], a[0:3], v[28:31]
ds_read_b64_tr_b16 a[108:109], v14 offset:10240
v_mfma_f32_16x16x32_bf16 v[32:35], a[48:51], a[0:3], v[32:35]
ds_read_b64_tr_b16 a[110:111], v14 offset:10496
s_waitcnt lgkmcnt(5)
v_mfma_f32_16x16x32_bf16 v[64:67], a[48:51], a[4:7], v[64:67]
ds_read_b64_tr_b16 a[112:113], v15 offset:10240
s_add_u32 m0, s16, 0x8000
v_mfma_f32_16x16x32_bf16 v[96:99], a[48:51], a[8:11], v[96:99]
buffer_load_dwordx4 v22, s[44:47], s20 offen lds
v_mfma_f32_16x16x32_bf16 v[128:131], a[48:51], a[12:15], v[128:131]
ds_read_b64_tr_b16 a[114:115], v15 offset:10496
v_mfma_f32_16x16x32_bf16 v[132:135], a[52:55], a[12:15], v[132:135]
ds_read_b64_tr_b16 a[40:41], v12 offset:8192
v_mfma_f32_16x16x32_bf16 v[100:103], a[52:55], a[8:11], v[100:103]
ds_read_b64_tr_b16 a[42:43], v12 offset:9216
s_add_u32 m0, s16, 0x8400
v_mfma_f32_16x16x32_bf16 v[68:71], a[52:55], a[4:7], v[68:71]
buffer_load_dwordx4 v23, s[44:47], s20 offen lds
v_mfma_f32_16x16x32_bf16 v[36:39], a[52:55], a[0:3], v[36:39]
ds_read_b64_tr_b16 a[44:45], v13 offset:8192
v_mfma_f32_16x16x32_bf16 v[40:43], a[56:59], a[0:3], v[40:43]
ds_read_b64_tr_b16 a[46:47], v13 offset:9216
v_mfma_f32_16x16x32_bf16 v[72:75], a[56:59], a[4:7], v[72:75]
ds_read_b64_tr_b16 a[48:49], v12 offset:8448
v_mfma_f32_16x16x32_bf16 v[104:107], a[56:59], a[8:11], v[104:107]
ds_read_b64_tr_b16 a[50:51], v12 offset:9472
s_add_u32 m0, s16, 0x8800
v_mfma_f32_16x16x32_bf16 v[136:139], a[56:59], a[12:15], v[136:139]
buffer_load_dwordx4 v22, s[44:47], s21 offen lds
v_mfma_f32_16x16x32_bf16 v[140:143], a[60:63], a[12:15], v[140:143]
ds_read_b64_tr_b16 a[52:53], v13 offset:8448
v_mfma_f32_16x16x32_bf16 v[108:111], a[60:63], a[8:11], v[108:111]
ds_read_b64_tr_b16 a[54:55], v13 offset:9472
v_mfma_f32_16x16x32_bf16 v[76:79], a[60:63], a[4:7], v[76:79]
ds_read_b64_tr_b16 a[56:57], v12 offset:8704
s_add_u32 m0, s16, 0x8c00
v_mfma_f32_16x16x32_bf16 v[44:47], a[60:63], a[0:3], v[44:47]
buffer_load_dwordx4 v23, s[44:47], s21 offen lds
v_mfma_f32_16x16x32_bf16 v[48:51], a[64:67], a[0:3], v[48:51]
ds_read_b64_tr_b16 a[58:59], v12 offset:9728
v_mfma_f32_16x16x32_bf16 v[80:83], a[64:67], a[4:7], v[80:83]
ds_read_b64_tr_b16 a[60:61], v13 offset:8704
v_mfma_f32_16x16x32_bf16 v[112:115], a[64:67], a[8:11], v[112:115]
ds_read_b64_tr_b16 a[62:63], v13 offset:9728
v_mfma_f32_16x16x32_bf16 v[144:147], a[64:67], a[12:15], v[144:147]
ds_read_b64_tr_b16 a[64:65], v12 offset:8960
s_add_u32 s8, s28, 0x5000
v_mfma_f32_16x16x32_bf16 v[148:151], a[68:71], a[12:15], v[148:151]
buffer_store_dwordx4 a[208:211], v16, s[88:91], s8 offen sc1
v_mfma_f32_16x16x32_bf16 v[116:119], a[68:71], a[8:11], v[116:119]
ds_read_b64_tr_b16 a[66:67], v12 offset:9984
v_mfma_f32_16x16x32_bf16 v[84:87], a[68:71], a[4:7], v[84:87]
v_mfma_f32_16x16x32_bf16 v[52:55], a[68:71], a[0:3], v[52:55]
ds_read_b64_tr_b16 a[68:69], v13 offset:8960
v_mfma_f32_16x16x32_bf16 v[152:155], a[72:75], a[0:3], v[152:155]
ds_read_b64_tr_b16 a[70:71], v13 offset:9984
s_add_u32 m0, s16, 0x9000
v_mfma_f32_16x16x32_bf16 v[160:163], a[72:75], a[4:7], v[160:163]
buffer_load_dwordx4 v22, s[44:47], s22 offen lds
v_mfma_f32_16x16x32_bf16 v[168:171], a[72:75], a[8:11], v[168:171]
v_mfma_f32_16x16x32_bf16 v[176:179], a[72:75], a[12:15], v[176:179]
ds_read_b64_tr_b16 a[72:73], v14 offset:2048
v_mfma_f32_16x16x32_bf16 v[180:183], a[76:79], a[12:15], v[180:183]
ds_read_b64_tr_b16 a[74:75], v14 offset:2304
s_add_u32 m0, s16, 0x9400
v_mfma_f32_16x16x32_bf16 v[172:175], a[76:79], a[8:11], v[172:175]
buffer_load_dwordx4 v23, s[44:47], s22 offen lds
v_mfma_f32_16x16x32_bf16 v[164:167], a[76:79], a[4:7], v[164:167]
v_mfma_f32_16x16x32_bf16 v[156:159], a[76:79], a[0:3], v[156:159]
ds_read_b64_tr_b16 a[76:77], v15 offset:2048
v_mfma_f32_16x16x32_bf16 v[184:187], a[80:83], a[0:3], v[184:187]
ds_read_b64_tr_b16 a[78:79], v15 offset:2304
v_mfma_f32_16x16x32_bf16 v[192:195], a[80:83], a[4:7], v[192:195]
s_add_u32 m0, s16, 0x9800
v_mfma_f32_16x16x32_bf16 v[200:203], a[80:83], a[8:11], v[200:203]
buffer_load_dwordx4 v22, s[44:47], s23 offen lds
v_mfma_f32_16x16x32_bf16 v[208:211], a[80:83], a[12:15], v[208:211]
v_mfma_f32_16x16x32_bf16 v[248:251], a[80:83], a[16:19], v[248:251]
ds_read_b64_tr_b16 a[80:81], v14 offset:6144
v_mfma_f32_16x16x32_bf16 v[212:215], a[84:87], a[12:15], v[212:215]
ds_read_b64_tr_b16 a[82:83], v14 offset:6400
s_add_u32 m0, s16, 0x9c00
v_mfma_f32_16x16x32_bf16 v[204:207], a[84:87], a[8:11], v[204:207]
buffer_load_dwordx4 v23, s[44:47], s23 offen lds
v_mfma_f32_16x16x32_bf16 v[196:199], a[84:87], a[4:7], v[196:199]
v_add_u32 v12, 0x8000, v12
v_add_u32 v13, 0x8000, v13
v_mfma_f32_16x16x32_bf16 v[188:191], a[84:87], a[0:3], v[188:191]
v_add_u32 v14, 0x8000, v14
v_add_u32 v15, 0x8000, v15
v_mfma_f32_16x16x32_bf16 v[216:219], a[0:3], a[88:91], v[216:219]
v_add_u32 v10, 0x8000, v10
v_add_u32 v11, 0x8000, v11
v_mfma_f32_16x16x32_bf16 v[224:227], a[4:7], a[88:91], v[224:227]
s_add_u32 s8, s28, 0x5400
v_mfma_f32_16x16x32_bf16 v[232:235], a[8:11], a[88:91], v[232:235]
buffer_store_dwordx4 a[212:215], v16, s[88:91], s8 offen sc1
v_mfma_f32_16x16x32_bf16 v[240:243], a[12:15], a[88:91], v[240:243]
v_mfma_f32_16x16x32_bf16 v[252:255], a[16:19], a[88:91], v[252:255]
v_mfma_f32_16x16x32_bf16 v[244:247], a[12:15], a[92:95], v[244:247]
v_mfma_f32_16x16x32_bf16 v[236:239], a[8:11], a[92:95], v[236:239]
v_mfma_f32_16x16x32_bf16 v[228:231], a[4:7], a[92:95], v[228:231]
v_mfma_f32_16x16x32_bf16 v[220:223], a[0:3], a[92:95], v[220:223]
s_waitcnt vmcnt(21) lgkmcnt(0)
s_barrier
v_mfma_f32_16x16x32_bf16 v[24:27], a[40:43], a[20:23], v[24:27]
ds_read_b128 a[0:3], v8 offset:0
s_add_u32 m0, s17, 0x8000
v_mfma_f32_16x16x32_bf16 v[56:59], a[40:43], a[24:27], v[56:59]
buffer_load_dwordx4 v5, s[52:55], 0 offen lds
v_mfma_f32_16x16x32_bf16 v[88:91], a[40:43], a[28:31], v[88:91]
ds_read_b128 a[4:7], v8 offset:2048
v_add_u32 v22, 0x80, v22
v_mfma_f32_16x16x32_bf16 v[120:123], a[40:43], a[32:35], v[120:123]
ds_read_b128 a[8:11], v8 offset:4096
v_add_u32 v23, 0x80, v23
v_mfma_f32_16x16x32_bf16 v[124:127], a[44:47], a[32:35], v[124:127]
ds_read_b128 a[12:15], v8 offset:6144
v_mfma_f32_16x16x32_bf16 v[92:95], a[44:47], a[28:31], v[92:95]
ds_read_b128 a[16:19], v10
s_add_u32 m0, s17, 0x8400
v_mfma_f32_16x16x32_bf16 v[60:63], a[44:47], a[24:27], v[60:63]
buffer_load_dwordx4 v5, s[52:55], s13 offen lds
v_mfma_f32_16x16x32_bf16 v[28:31], a[44:47], a[20:23], v[28:31]
ds_read_b64_tr_b16 a[84:85], v15 offset:4096
v_mfma_f32_16x16x32_bf16 v[32:35], a[48:51], a[20:23], v[32:35]
ds_read_b64_tr_b16 a[86:87], v15 offset:4352
v_mfma_f32_16x16x32_bf16 v[64:67], a[48:51], a[24:27], v[64:67]
ds_read_b64_tr_b16 a[88:89], v14 offset:8192
v_mfma_f32_16x16x32_bf16 v[96:99], a[48:51], a[28:31], v[96:99]
ds_read_b64_tr_b16 a[90:91], v14 offset:8448
s_add_u32 s8, s28, 0x5800
v_mfma_f32_16x16x32_bf16 v[128:131], a[48:51], a[32:35], v[128:131]
buffer_store_dwordx4 a[216:219], v16, s[88:91], s8 offen sc1
v_mfma_f32_16x16x32_bf16 v[132:135], a[52:55], a[32:35], v[132:135]
ds_read_b64_tr_b16 a[92:93], v15 offset:8192
v_mfma_f32_16x16x32_bf16 v[100:103], a[52:55], a[28:31], v[100:103]
ds_read_b64_tr_b16 a[94:95], v15 offset:8448
v_mfma_f32_16x16x32_bf16 v[68:71], a[52:55], a[24:27], v[68:71]
ds_read_b64_tr_b16 a[40:41], v12 offset:0
v_mfma_f32_16x16x32_bf16 v[36:39], a[52:55], a[20:23], v[36:39]
ds_read_b64_tr_b16 a[42:43], v12 offset:1024
s_add_u32 m0, s17, 0x8800
v_mfma_f32_16x16x32_bf16 v[40:43], a[56:59], a[20:23], v[40:43]
buffer_load_dwordx4 v6, s[52:55], 0 offen lds
v_mfma_f32_16x16x32_bf16 v[72:75], a[56:59], a[24:27], v[72:75]
ds_read_b64_tr_b16 a[44:45], v13 offset:0
v_mfma_f32_16x16x32_bf16 v[104:107], a[56:59], a[28:31], v[104:107]
ds_read_b64_tr_b16 a[46:47], v13 offset:1024
v_mfma_f32_16x16x32_bf16 v[136:139], a[56:59], a[32:35], v[136:139]
ds_read_b64_tr_b16 a[48:49], v12 offset:256
v_mfma_f32_16x16x32_bf16 v[140:143], a[60:63], a[32:35], v[140:143]
ds_read_b64_tr_b16 a[50:51], v12 offset:1280
s_add_u32 m0, s17, 0x8c00
v_mfma_f32_16x16x32_bf16 v[108:111], a[60:63], a[28:31], v[108:111]
buffer_load_dwordx4 v6, s[52:55], s13 offen lds
v_mfma_f32_16x16x32_bf16 v[76:79], a[60:63], a[24:27], v[76:79]
ds_read_b64_tr_b16 a[52:53], v13 offset:256
v_mfma_f32_16x16x32_bf16 v[44:47], a[60:63], a[20:23], v[44:47]
ds_read_b64_tr_b16 a[54:55], v13 offset:1280
v_mfma_f32_16x16x32_bf16 v[48:51], a[64:67], a[20:23], v[48:51]
ds_read_b64_tr_b16 a[56:57], v12 offset:512
v_mfma_f32_16x16x32_bf16 v[80:83], a[64:67], a[24:27], v[80:83]
ds_read_b64_tr_b16 a[58:59], v12 offset:1536
s_add_u32 m0, s18, 0xc000
v_mfma_f32_16x16x32_bf16 v[112:115], a[64:67], a[28:31], v[112:115]
buffer_load_dwordx4 v7, s[68:71], 0 offen lds
v_mfma_f32_16x16x32_bf16 v[144:147], a[64:67], a[32:35], v[144:147]
ds_read_b64_tr_b16 a[60:61], v13 offset:512
v_mfma_f32_16x16x32_bf16 v[148:151], a[68:71], a[32:35], v[148:151]
ds_read_b64_tr_b16 a[62:63], v13 offset:1536
v_mfma_f32_16x16x32_bf16 v[116:119], a[68:71], a[28:31], v[116:119]
ds_read_b64_tr_b16 a[64:65], v12 offset:768
v_mfma_f32_16x16x32_bf16 v[84:87], a[68:71], a[24:27], v[84:87]
ds_read_b64_tr_b16 a[66:67], v12 offset:1792
s_add_u32 s8, s28, 0x5c00
v_mfma_f32_16x16x32_bf16 v[52:55], a[68:71], a[20:23], v[52:55]
buffer_store_dwordx4 a[220:223], v16, s[88:91], s8 offen sc1
v_mfma_f32_16x16x32_bf16 v[152:155], a[72:75], a[20:23], v[152:155]
ds_read_b64_tr_b16 a[68:69], v13 offset:768
v_mfma_f32_16x16x32_bf16 v[160:163], a[72:75], a[24:27], v[160:163]
ds_read_b64_tr_b16 a[70:71], v13 offset:1792
v_mfma_f32_16x16x32_bf16 v[168:171], a[72:75], a[28:31], v[168:171]
v_mfma_f32_16x16x32_bf16 v[176:179], a[72:75], a[32:35], v[176:179]
ds_read_b64_tr_b16 a[72:73], v14 offset:0
s_add_u32 m0, s18, 0xd000
v_mfma_f32_16x16x32_bf16 v[180:183], a[76:79], a[32:35], v[180:183]
buffer_load_dwordx4 v7, s[68:71], s25 offen lds
v_mfma_f32_16x16x32_bf16 v[172:175], a[76:79], a[28:31], v[172:175]
ds_read_b64_tr_b16 a[74:75], v14 offset:256
v_mfma_f32_16x16x32_bf16 v[164:167], a[76:79], a[24:27], v[164:167]
v_mfma_f32_16x16x32_bf16 v[156:159], a[76:79], a[20:23], v[156:159]
ds_read_b64_tr_b16 a[76:77], v15 offset:0
v_mfma_f32_16x16x32_bf16 v[184:187], a[80:83], a[20:23], v[184:187]
ds_read_b64_tr_b16 a[78:79], v15 offset:256
s_add_u32 m0, s18, 0xe000
v_mfma_f32_16x16x32_bf16 v[192:195], a[80:83], a[24:27], v[192:195]
buffer_load_dwordx4 v7, s[68:71], s26 offen lds
v_mfma_f32_16x16x32_bf16 v[200:203], a[80:83], a[28:31], v[200:203]
v_mfma_f32_16x16x32_bf16 v[208:211], a[80:83], a[32:35], v[208:211]
v_mfma_f32_16x16x32_bf16 v[248:251], a[80:83], a[36:39], v[248:251]
ds_read_b64_tr_b16 a[80:81], v14 offset:4096
v_mfma_f32_16x16x32_bf16 v[212:215], a[104:107], a[32:35], v[212:215]
ds_read_b64_tr_b16 a[82:83], v14 offset:4352
s_add_u32 m0, s18, 0xf000
v_mfma_f32_16x16x32_bf16 v[204:207], a[104:107], a[28:31], v[204:207]
buffer_load_dwordx4 v4, s[44:47], s24 offen lds
v_mfma_f32_16x16x32_bf16 v[196:199], a[104:107], a[24:27], v[196:199]
v_mfma_f32_16x16x32_bf16 v[188:191], a[104:107], a[20:23], v[188:191]
v_mfma_f32_16x16x32_bf16 v[216:219], a[20:23], a[108:111], v[216:219]
v_mfma_f32_16x16x32_bf16 v[224:227], a[24:27], a[108:111], v[224:227]
v_add_u32 v20, s76, v16
v_mov_b32 v21, s77
v_mfma_f32_16x16x32_bf16 v[232:235], a[28:31], a[108:111], v[232:235]
global_load_dword v18, v[20:21], off sc1
v_mfma_f32_16x16x32_bf16 v[240:243], a[32:35], a[108:111], v[240:243]
v_mfma_f32_16x16x32_bf16 v[252:255], a[36:39], a[108:111], v[252:255]
v_mfma_f32_16x16x32_bf16 v[244:247], a[32:35], a[112:115], v[244:247]
v_mfma_f32_16x16x32_bf16 v[236:239], a[28:31], a[112:115], v[236:239]
v_mfma_f32_16x16x32_bf16 v[228:231], a[24:27], a[112:115], v[228:231]
v_mfma_f32_16x16x32_bf16 v[220:223], a[20:23], a[112:115], v[220:223]
s_waitcnt lgkmcnt(0)
v_mfma_f32_16x16x32_bf16 v[24:27], a[40:43], a[0:3], v[24:27]
ds_read_b128 a[20:23], v9 offset:0
v_add_u32 v5, 0x80000, v5
v_mfma_f32_16x16x32_bf16 v[56:59], a[40:43], a[4:7], v[56:59]
ds_read_b128 a[24:27], v9 offset:2048
v_add_u32 v6, 0x80000, v6
v_mfma_f32_16x16x32_bf16 v[88:91], a[40:43], a[8:11], v[88:91]
ds_read_b128 a[28:31], v9 offset:4096
v_add_u32 v7, 0x60000, v7
v_mfma_f32_16x16x32_bf16 v[120:123], a[40:43], a[12:15], v[120:123]
ds_read_b128 a[32:35], v9 offset:6144
v_add_u32 v4, 0x80, v4
v_mfma_f32_16x16x32_bf16 v[124:127], a[44:47], a[12:15], v[124:127]
ds_read_b128 a[36:39], v11
v_mfma_f32_16x16x32_bf16 v[92:95], a[44:47], a[8:11], v[92:95]
ds_read_b64_tr_b16 a[104:105], v15 offset:6144
v_mfma_f32_16x16x32_bf16 v[60:63], a[44:47], a[4:7], v[60:63]
ds_read_b64_tr_b16 a[106:107], v15 offset:6400
v_mfma_f32_16x16x32_bf16 v[28:31], a[44:47], a[0:3], v[28:31]
ds_read_b64_tr_b16 a[108:109], v14 offset:10240
v_mfma_f32_16x16x32_bf16 v[32:35], a[48:51], a[0:3], v[32:35]
ds_read_b64_tr_b16 a[110:111], v14 offset:10496
s_waitcnt lgkmcnt(5)
v_mfma_f32_16x16x32_bf16 v[64:67], a[48:51], a[4:7], v[64:67]
ds_read_b64_tr_b16 a[112:113], v15 offset:10240
s_add_u32 m0, s16, 0x0
v_mfma_f32_16x16x32_bf16 v[96:99], a[48:51], a[8:11], v[96:99]
buffer_load_dwordx4 v22, s[44:47], s20 offen lds
v_mfma_f32_16x16x32_bf16 v[128:131], a[48:51], a[12:15], v[128:131]
ds_read_b64_tr_b16 a[114:115], v15 offset:10496
v_mfma_f32_16x16x32_bf16 v[132:135], a[52:55], a[12:15], v[132:135]
ds_read_b64_tr_b16 a[40:41], v12 offset:8192
v_mfma_f32_16x16x32_bf16 v[100:103], a[52:55], a[8:11], v[100:103]
ds_read_b64_tr_b16 a[42:43], v12 offset:9216
s_add_u32 m0, s16, 0x400
v_mfma_f32_16x16x32_bf16 v[68:71], a[52:55], a[4:7], v[68:71]
buffer_load_dwordx4 v23, s[44:47], s20 offen lds
v_mfma_f32_16x16x32_bf16 v[36:39], a[52:55], a[0:3], v[36:39]
ds_read_b64_tr_b16 a[44:45], v13 offset:8192
v_mfma_f32_16x16x32_bf16 v[40:43], a[56:59], a[0:3], v[40:43]
ds_read_b64_tr_b16 a[46:47], v13 offset:9216
v_mfma_f32_16x16x32_bf16 v[72:75], a[56:59], a[4:7], v[72:75]
ds_read_b64_tr_b16 a[48:49], v12 offset:8448
v_mfma_f32_16x16x32_bf16 v[104:107], a[56:59], a[8:11], v[104:107]
ds_read_b64_tr_b16 a[50:51], v12 offset:9472
s_add_u32 m0, s16, 0x800
v_mfma_f32_16x16x32_bf16 v[136:139], a[56:59], a[12:15], v[136:139]
buffer_load_dwordx4 v22, s[44:47], s21 offen lds
v_mfma_f32_16x16x32_bf16 v[140:143], a[60:63], a[12:15], v[140:143]
ds_read_b64_tr_b16 a[52:53], v13 offset:8448
v_mfma_f32_16x16x32_bf16 v[108:111], a[60:63], a[8:11], v[108:111]
ds_read_b64_tr_b16 a[54:55], v13 offset:9472
v_mfma_f32_16x16x32_bf16 v[76:79], a[60:63], a[4:7], v[76:79]
ds_read_b64_tr_b16 a[56:57], v12 offset:8704
s_add_u32 m0, s16, 0xc00
v_mfma_f32_16x16x32_bf16 v[44:47], a[60:63], a[0:3], v[44:47]
buffer_load_dwordx4 v23, s[44:47], s21 offen lds
v_mfma_f32_16x16x32_bf16 v[48:51], a[64:67], a[0:3], v[48:51]
ds_read_b64_tr_b16 a[58:59], v12 offset:9728
v_mfma_f32_16x16x32_bf16 v[80:83], a[64:67], a[4:7], v[80:83]
ds_read_b64_tr_b16 a[60:61], v13 offset:8704
v_mfma_f32_16x16x32_bf16 v[112:115], a[64:67], a[8:11], v[112:115]
ds_read_b64_tr_b16 a[62:63], v13 offset:9728
v_mfma_f32_16x16x32_bf16 v[144:147], a[64:67], a[12:15], v[144:147]
ds_read_b64_tr_b16 a[64:65], v12 offset:8960
s_add_u32 s8, s28, 0x8000
v_mfma_f32_16x16x32_bf16 v[148:151], a[68:71], a[12:15], v[148:151]
buffer_store_dwordx4 a[224:227], v16, s[88:91], s8 offen sc1
v_mfma_f32_16x16x32_bf16 v[116:119], a[68:71], a[8:11], v[116:119]
ds_read_b64_tr_b16 a[66:67], v12 offset:9984
v_mfma_f32_16x16x32_bf16 v[84:87], a[68:71], a[4:7], v[84:87]
v_mfma_f32_16x16x32_bf16 v[52:55], a[68:71], a[0:3], v[52:55]
ds_read_b64_tr_b16 a[68:69], v13 offset:8960
v_mfma_f32_16x16x32_bf16 v[152:155], a[72:75], a[0:3], v[152:155]
ds_read_b64_tr_b16 a[70:71], v13 offset:9984
s_add_u32 m0, s16, 0x1000
v_mfma_f32_16x16x32_bf16 v[160:163], a[72:75], a[4:7], v[160:163]
buffer_load_dwordx4 v22, s[44:47], s22 offen lds
v_mfma_f32_16x16x32_bf16 v[168:171], a[72:75], a[8:11], v[168:171]
v_mfma_f32_16x16x32_bf16 v[176:179], a[72:75], a[12:15], v[176:179]
ds_read_b64_tr_b16 a[72:73], v14 offset:2048
v_mfma_f32_16x16x32_bf16 v[180:183], a[76:79], a[12:15], v[180:183]
ds_read_b64_tr_b16 a[74:75], v14 offset:2304
s_add_u32 m0, s16, 0x1400
v_mfma_f32_16x16x32_bf16 v[172:175], a[76:79], a[8:11], v[172:175]
buffer_load_dwordx4 v23, s[44:47], s22 offen lds
v_mfma_f32_16x16x32_bf16 v[164:167], a[76:79], a[4:7], v[164:167]
v_mfma_f32_16x16x32_bf16 v[156:159], a[76:79], a[0:3], v[156:159]
ds_read_b64_tr_b16 a[76:77], v15 offset:2048
v_mfma_f32_16x16x32_bf16 v[184:187], a[80:83], a[0:3], v[184:187]
ds_read_b64_tr_b16 a[78:79], v15 offset:2304
v_mfma_f32_16x16x32_bf16 v[192:195], a[80:83], a[4:7], v[192:195]
s_add_u32 m0, s16, 0x1800
v_mfma_f32_16x16x32_bf16 v[200:203], a[80:83], a[8:11], v[200:203]
buffer_load_dwordx4 v22, s[44:47], s23 offen lds
v_mfma_f32_16x16x32_bf16 v[208:211], a[80:83], a[12:15], v[208:211]
v_mfma_f32_16x16x32_bf16 v[248:251], a[80:83], a[16:19], v[248:251]
ds_read_b64_tr_b16 a[80:81], v14 offset:6144
v_mfma_f32_16x16x32_bf16 v[212:215], a[84:87], a[12:15], v[212:215]
ds_read_b64_tr_b16 a[82:83], v14 offset:6400
s_add_u32 m0, s16, 0x1c00
v_mfma_f32_16x16x32_bf16 v[204:207], a[84:87], a[8:11], v[204:207]
buffer_load_dwordx4 v23, s[44:47], s23 offen lds
v_mfma_f32_16x16x32_bf16 v[196:199], a[84:87], a[4:7], v[196:199]
v_add_u32 v12, 0xffff0000, v12
v_add_u32 v13, 0xffff0000, v13
v_mfma_f32_16x16x32_bf16 v[188:191], a[84:87], a[0:3], v[188:191]
v_add_u32 v14, 0xffff0000, v14
v_add_u32 v15, 0xffff0000, v15
v_mfma_f32_16x16x32_bf16 v[216:219], a[0:3], a[88:91], v[216:219]
v_add_u32 v10, 0xffff0000, v10
v_add_u32 v11, 0xffff0000, v11
v_mfma_f32_16x16x32_bf16 v[224:227], a[4:7], a[88:91], v[224:227]
s_add_u32 s8, s28, 0x8400
v_mfma_f32_16x16x32_bf16 v[232:235], a[8:11], a[88:91], v[232:235]
buffer_store_dwordx4 a[228:231], v16, s[88:91], s8 offen sc1
v_mfma_f32_16x16x32_bf16 v[240:243], a[12:15], a[88:91], v[240:243]
v_mfma_f32_16x16x32_bf16 v[252:255], a[16:19], a[88:91], v[252:255]
v_mfma_f32_16x16x32_bf16 v[244:247], a[12:15], a[92:95], v[244:247]
v_mfma_f32_16x16x32_bf16 v[236:239], a[8:11], a[92:95], v[236:239]
v_mfma_f32_16x16x32_bf16 v[228:231], a[4:7], a[92:95], v[228:231]
v_mfma_f32_16x16x32_bf16 v[220:223], a[0:3], a[92:95], v[220:223]
s_waitcnt vmcnt(22) lgkmcnt(0)
s_barrier
v_mfma_f32_16x16x32_bf16 v[24:27], a[40:43], a[20:23], v[24:27]
ds_read_b128 a[0:3], v8 offset:32768
s_add_u32 m0, s17, 0x10000
v_mfma_f32_16x16x32_bf16 v[56:59], a[40:43], a[24:27], v[56:59]
buffer_load_dwordx4 v5, s[52:55], 0 offen lds
v_mfma_f32_16x16x32_bf16 v[88:91], a[40:43], a[28:31], v[88:91]
ds_read_b128 a[4:7], v8 offset:34816
v_add_u32 v22, 0x80, v22
v_mfma_f32_16x16x32_bf16 v[120:123], a[40:43], a[32:35], v[120:123]
ds_read_b128 a[8:11], v8 offset:36864
v_add_u32 v23, 0x80, v23
v_mfma_f32_16x16x32_bf16 v[124:127], a[44:47], a[32:35], v[124:127]
ds_read_b128 a[12:15], v8 offset:38912
v_mfma_f32_16x16x32_bf16 v[92:95], a[44:47], a[28:31], v[92:95]
ds_read_b128 a[16:19], v10
s_add_u32 m0, s17, 0x10400
v_mfma_f32_16x16x32_bf16 v[60:63], a[44:47], a[24:27], v[60:63]
buffer_load_dwordx4 v5, s[52:55], s13 offen lds
v_mfma_f32_16x16x32_bf16 v[28:31], a[44:47], a[20:23], v[28:31]
ds_read_b64_tr_b16 a[84:85], v15 offset:4096
v_mfma_f32_16x16x32_bf16 v[32:35], a[48:51], a[20:23], v[32:35]
ds_read_b64_tr_b16 a[86:87], v15 offset:4352
v_mfma_f32_16x16x32_bf16 v[64:67], a[48:51], a[24:27], v[64:67]
ds_read_b64_tr_b16 a[88:89], v14 offset:8192
v_mfma_f32_16x16x32_bf16 v[96:99], a[48:51], a[28:31], v[96:99]
ds_read_b64_tr_b16 a[90:91], v14 offset:8448
v_mfma_f32_16x16x32_bf16 v[128:131], a[48:51], a[32:35], v[128:131]
ds_read_b64_tr_b16 a[92:93], v15 offset:8192
s_add_u32 m0, s17, 0x10800
v_mfma_f32_16x16x32_bf16 v[132:135], a[52:55], a[32:35], v[132:135]
buffer_load_dwordx4 v6, s[52:55], 0 offen lds
v_mfma_f32_16x16x32_bf16 v[100:103], a[52:55], a[28:31], v[100:103]
ds_read_b64_tr_b16 a[94:95], v15 offset:8448
v_mfma_f32_16x16x32_bf16 v[68:71], a[52:55], a[24:27], v[68:71]
ds_read_b64_tr_b16 a[40:41], v12 offset:0
v_mfma_f32_16x16x32_bf16 v[36:39], a[52:55], a[20:23], v[36:39]
ds_read_b64_tr_b16 a[42:43], v12 offset:1024
v_mfma_f32_16x16x32_bf16 v[40:43], a[56:59], a[20:23], v[40:43]
ds_read_b64_tr_b16 a[44:45], v13 offset:0
s_add_u32 m0, s17, 0x10c00
v_mfma_f32_16x16x32_bf16 v[72:75], a[56:59], a[24:27], v[72:75]
buffer_load_dwordx4 v6, s[52:55], s13 offen lds
v_mfma_f32_16x16x32_bf16 v[104:107], a[56:59], a[28:31], v[104:107]
ds_read_b64_tr_b16 a[46:47], v13 offset:1024
v_mfma_f32_16x16x32_bf16 v[136:139], a[56:59], a[32:35], v[136:139]
ds_read_b64_tr_b16 a[48:49], v12 offset:256
v_mfma_f32_16x16x32_bf16 v[140:143], a[60:63], a[32:35], v[140:143]
ds_read_b64_tr_b16 a[50:51], v12 offset:1280
v_mfma_f32_16x16x32_bf16 v[108:111], a[60:63], a[28:31], v[108:111]
ds_read_b64_tr_b16 a[52:53], v13 offset:256
v_mfma_f32_16x16x32_bf16 v[76:79], a[60:63], a[24:27], v[76:79]
ds_read_b64_tr_b16 a[54:55], v13 offset:1280
s_add_u32 s8, s28, 0x8800
v_mfma_f32_16x16x32_bf16 v[44:47], a[60:63], a[20:23], v[44:47]
buffer_store_dwordx4 a[232:235], v16, s[88:91], s8 offen sc1
v_mfma_f32_16x16x32_bf16 v[48:51], a[64:67], a[20:23], v[48:51]
ds_read_b64_tr_b16 a[56:57], v12 offset:512
v_mfma_f32_16x16x32_bf16 v[80:83], a[64:67], a[24:27], v[80:83]
ds_read_b64_tr_b16 a[58:59], v12 offset:1536
v_mfma_f32_16x16x32_bf16 v[112:115], a[64:67], a[28:31], v[112:115]
ds_read_b64_tr_b16 a[60:61], v13 offset:512
v_mfma_f32_16x16x32_bf16 v[144:147], a[64:67], a[32:35], v[144:147]
ds_read_b64_tr_b16 a[62:63], v13 offset:1536
s_add_u32 m0, s18, 0x14000
v_mfma_f32_16x16x32_bf16 v[148:151], a[68:71], a[32:35], v[148:151]
buffer_load_dwordx4 v7, s[68:71], 0 offen lds
v_mfma_f32_16x16x32_bf16 v[116:119], a[68:71], a[28:31], v[116:119]
ds_read_b64_tr_b16 a[64:65], v12 offset:768
v_mfma_f32_16x16x32_bf16 v[84:87], a[68:71], a[24:27], v[84:87]
ds_read_b64_tr_b16 a[66:67], v12 offset:1792
v_mfma_f32_16x16x32_bf16 v[52:55], a[68:71], a[20:23], v[52:55]
ds_read_b64_tr_b16 a[68:69], v13 offset:768
v_mfma_f32_16x16x32_bf16 v[152:155], a[72:75], a[20:23], v[152:155]
ds_read_b64_tr_b16 a[70:71], v13 offset:1792
v_mfma_f32_16x16x32_bf16 v[160:163], a[72:75], a[24:27], v[160:163]
s_add_u32 m0, s18, 0x15000
v_mfma_f32_16x16x32_bf16 v[168:171], a[72:75], a[28:31], v[168:171]
buffer_load_dwordx4 v7, s[68:71], s25 offen lds
v_mfma_f32_16x16x32_bf16 v[176:179], a[72:75], a[32:35], v[176:179]
ds_read_b64_tr_b16 a[72:73], v14 offset:0
v_mfma_f32_16x16x32_bf16 v[180:183], a[76:79], a[32:35], v[180:183]
ds_read_b64_tr_b16 a[74:75], v14 offset:256
v_mfma_f32_16x16x32_bf16 v[172:175], a[76:79], a[28:31], v[172:175]
v_mfma_f32_16x16x32_bf16 v[164:167], a[76:79], a[24:27], v[164:167]
s_add_u32 m0, s18, 0x16000
v_mfma_f32_16x16x32_bf16 v[156:159], a[76:79], a[20:23], v[156:159]
buffer_load_dwordx4 v7, s[68:71], s26 offen lds
v_mfma_f32_16x16x32_bf16 v[184:187], a[80:83], a[20:23], v[184:187]
ds_read_b64_tr_b16 a[76:77], v15 offset:0
v_mfma_f32_16x16x32_bf16 v[192:195], a[80:83], a[24:27], v[192:195]
ds_read_b64_tr_b16 a[78:79], v15 offset:256
v_mfma_f32_16x16x32_bf16 v[200:203], a[80:83], a[28:31], v[200:203]
v_mfma_f32_16x16x32_bf16 v[208:211], a[80:83], a[32:35], v[208:211]
v_mfma_f32_16x16x32_bf16 v[248:251], a[80:83], a[36:39], v[248:251]
ds_read_b64_tr_b16 a[80:81], v14 offset:4096
s_add_u32 m0, s18, 0x17000
v_mfma_f32_16x16x32_bf16 v[212:215], a[104:107], a[32:35], v[212:215]
buffer_load_dwordx4 v4, s[44:47], s24 offen lds
v_mfma_f32_16x16x32_bf16 v[204:207], a[104:107], a[28:31], v[204:207]
ds_read_b64_tr_b16 a[82:83], v14 offset:4352
v_mfma_f32_16x16x32_bf16 v[196:199], a[104:107], a[24:27], v[196:199]
v_mfma_f32_16x16x32_bf16 v[188:191], a[104:107], a[20:23], v[188:191]
v_mfma_f32_16x16x32_bf16 v[216:219], a[20:23], a[108:111], v[216:219]
s_add_u32 s8, s28, 0x8c00
v_mfma_f32_16x16x32_bf16 v[224:227], a[24:27], a[108:111], v[224:227]
buffer_store_dwordx4 a[236:239], v16, s[88:91], s8 offen sc1
v_mfma_f32_16x16x32_bf16 v[232:235], a[28:31], a[108:111], v[232:235]
v_mfma_f32_16x16x32_bf16 v[240:243], a[32:35], a[108:111], v[240:243]
v_mfma_f32_16x16x32_bf16 v[252:255], a[36:39], a[108:111], v[252:255]
v_mfma_f32_16x16x32_bf16 v[244:247], a[32:35], a[112:115], v[244:247]
v_mfma_f32_16x16x32_bf16 v[236:239], a[28:31], a[112:115], v[236:239]
v_mfma_f32_16x16x32_bf16 v[228:231], a[24:27], a[112:115], v[228:231]
v_mfma_f32_16x16x32_bf16 v[220:223], a[20:23], a[112:115], v[220:223]
s_waitcnt lgkmcnt(0)
v_mfma_f32_16x16x32_bf16 v[24:27], a[40:43], a[0:3], v[24:27]
ds_read_b128 a[20:23], v9 offset:32768
v_add_u32 v5, 0x80000, v5
v_mfma_f32_16x16x32_bf16 v[56:59], a[40:43], a[4:7], v[56:59]
ds_read_b128 a[24:27], v9 offset:34816
v_add_u32 v6, 0x80000, v6
v_mfma_f32_16x16x32_bf16 v[88:91], a[40:43], a[8:11], v[88:91]
ds_read_b128 a[28:31], v9 offset:36864
v_add_u32 v7, 0x60000, v7
v_mfma_f32_16x16x32_bf16 v[120:123], a[40:43], a[12:15], v[120:123]
ds_read_b128 a[32:35], v9 offset:38912
v_add_u32 v4, 0x80, v4
v_mfma_f32_16x16x32_bf16 v[124:127], a[44:47], a[12:15], v[124:127]
ds_read_b128 a[36:39], v11
v_mfma_f32_16x16x32_bf16 v[92:95], a[44:47], a[8:11], v[92:95]
ds_read_b64_tr_b16 a[104:105], v15 offset:6144
v_mfma_f32_16x16x32_bf16 v[60:63], a[44:47], a[4:7], v[60:63]
ds_read_b64_tr_b16 a[106:107], v15 offset:6400
v_mfma_f32_16x16x32_bf16 v[28:31], a[44:47], a[0:3], v[28:31]
ds_read_b64_tr_b16 a[108:109], v14 offset:10240
v_mfma_f32_16x16x32_bf16 v[32:35], a[48:51], a[0:3], v[32:35]
ds_read_b64_tr_b16 a[110:111], v14 offset:10496
s_waitcnt lgkmcnt(5)
v_mfma_f32_16x16x32_bf16 v[64:67], a[48:51], a[4:7], v[64:67]
ds_read_b64_tr_b16 a[112:113], v15 offset:10240
s_add_u32 m0, s16, 0x8000
v_mfma_f32_16x16x32_bf16 v[96:99], a[48:51], a[8:11], v[96:99]
buffer_load_dwordx4 v22, s[44:47], s20 offen lds
v_mfma_f32_16x16x32_bf16 v[128:131], a[48:51], a[12:15], v[128:131]
ds_read_b64_tr_b16 a[114:115], v15 offset:10496
v_mfma_f32_16x16x32_bf16 v[132:135], a[52:55], a[12:15], v[132:135]
ds_read_b64_tr_b16 a[40:41], v12 offset:8192
v_mfma_f32_16x16x32_bf16 v[100:103], a[52:55], a[8:11], v[100:103]
ds_read_b64_tr_b16 a[42:43], v12 offset:9216
s_add_u32 m0, s16, 0x8400
v_mfma_f32_16x16x32_bf16 v[68:71], a[52:55], a[4:7], v[68:71]
buffer_load_dwordx4 v23, s[44:47], s20 offen lds
v_mfma_f32_16x16x32_bf16 v[36:39], a[52:55], a[0:3], v[36:39]
ds_read_b64_tr_b16 a[44:45], v13 offset:8192
v_mfma_f32_16x16x32_bf16 v[40:43], a[56:59], a[0:3], v[40:43]
ds_read_b64_tr_b16 a[46:47], v13 offset:9216
v_mfma_f32_16x16x32_bf16 v[72:75], a[56:59], a[4:7], v[72:75]
ds_read_b64_tr_b16 a[48:49], v12 offset:8448
v_mfma_f32_16x16x32_bf16 v[104:107], a[56:59], a[8:11], v[104:107]
ds_read_b64_tr_b16 a[50:51], v12 offset:9472
s_add_u32 m0, s16, 0x8800
v_mfma_f32_16x16x32_bf16 v[136:139], a[56:59], a[12:15], v[136:139]
buffer_load_dwordx4 v22, s[44:47], s21 offen lds
v_mfma_f32_16x16x32_bf16 v[140:143], a[60:63], a[12:15], v[140:143]
ds_read_b64_tr_b16 a[52:53], v13 offset:8448
v_mfma_f32_16x16x32_bf16 v[108:111], a[60:63], a[8:11], v[108:111]
ds_read_b64_tr_b16 a[54:55], v13 offset:9472
v_mfma_f32_16x16x32_bf16 v[76:79], a[60:63], a[4:7], v[76:79]
ds_read_b64_tr_b16 a[56:57], v12 offset:8704
s_add_u32 m0, s16, 0x8c00
v_mfma_f32_16x16x32_bf16 v[44:47], a[60:63], a[0:3], v[44:47]
buffer_load_dwordx4 v23, s[44:47], s21 offen lds
v_mfma_f32_16x16x32_bf16 v[48:51], a[64:67], a[0:3], v[48:51]
ds_read_b64_tr_b16 a[58:59], v12 offset:9728
v_mfma_f32_16x16x32_bf16 v[80:83], a[64:67], a[4:7], v[80:83]
ds_read_b64_tr_b16 a[60:61], v13 offset:8704
v_mfma_f32_16x16x32_bf16 v[112:115], a[64:67], a[8:11], v[112:115]
ds_read_b64_tr_b16 a[62:63], v13 offset:9728
v_mfma_f32_16x16x32_bf16 v[144:147], a[64:67], a[12:15], v[144:147]
ds_read_b64_tr_b16 a[64:65], v12 offset:8960
s_add_u32 s8, s28, 0x9000
v_mfma_f32_16x16x32_bf16 v[148:151], a[68:71], a[12:15], v[148:151]
buffer_store_dwordx4 a[240:243], v16, s[88:91], s8 offen sc1
v_mfma_f32_16x16x32_bf16 v[116:119], a[68:71], a[8:11], v[116:119]
ds_read_b64_tr_b16 a[66:67], v12 offset:9984
v_mfma_f32_16x16x32_bf16 v[84:87], a[68:71], a[4:7], v[84:87]
v_mfma_f32_16x16x32_bf16 v[52:55], a[68:71], a[0:3], v[52:55]
ds_read_b64_tr_b16 a[68:69], v13 offset:8960
v_mfma_f32_16x16x32_bf16 v[152:155], a[72:75], a[0:3], v[152:155]
ds_read_b64_tr_b16 a[70:71], v13 offset:9984
s_add_u32 m0, s16, 0x9000
v_mfma_f32_16x16x32_bf16 v[160:163], a[72:75], a[4:7], v[160:163]
buffer_load_dwordx4 v22, s[44:47], s22 offen lds
v_mfma_f32_16x16x32_bf16 v[168:171], a[72:75], a[8:11], v[168:171]
v_mfma_f32_16x16x32_bf16 v[176:179], a[72:75], a[12:15], v[176:179]
ds_read_b64_tr_b16 a[72:73], v14 offset:2048
v_mfma_f32_16x16x32_bf16 v[180:183], a[76:79], a[12:15], v[180:183]
ds_read_b64_tr_b16 a[74:75], v14 offset:2304
s_add_u32 m0, s16, 0x9400
v_mfma_f32_16x16x32_bf16 v[172:175], a[76:79], a[8:11], v[172:175]
buffer_load_dwordx4 v23, s[44:47], s22 offen lds
v_mfma_f32_16x16x32_bf16 v[164:167], a[76:79], a[4:7], v[164:167]
v_mfma_f32_16x16x32_bf16 v[156:159], a[76:79], a[0:3], v[156:159]
ds_read_b64_tr_b16 a[76:77], v15 offset:2048
v_mfma_f32_16x16x32_bf16 v[184:187], a[80:83], a[0:3], v[184:187]
ds_read_b64_tr_b16 a[78:79], v15 offset:2304
v_mfma_f32_16x16x32_bf16 v[192:195], a[80:83], a[4:7], v[192:195]
s_add_u32 m0, s16, 0x9800
v_mfma_f32_16x16x32_bf16 v[200:203], a[80:83], a[8:11], v[200:203]
buffer_load_dwordx4 v22, s[44:47], s23 offen lds
v_mfma_f32_16x16x32_bf16 v[208:211], a[80:83], a[12:15], v[208:211]
v_mfma_f32_16x16x32_bf16 v[248:251], a[80:83], a[16:19], v[248:251]
ds_read_b64_tr_b16 a[80:81], v14 offset:6144
v_mfma_f32_16x16x32_bf16 v[212:215], a[84:87], a[12:15], v[212:215]
ds_read_b64_tr_b16 a[82:83], v14 offset:6400
s_add_u32 m0, s16, 0x9c00
v_mfma_f32_16x16x32_bf16 v[204:207], a[84:87], a[8:11], v[204:207]
buffer_load_dwordx4 v23, s[44:47], s23 offen lds
v_mfma_f32_16x16x32_bf16 v[196:199], a[84:87], a[4:7], v[196:199]
v_add_u32 v12, 0x8000, v12
v_add_u32 v13, 0x8000, v13
v_mfma_f32_16x16x32_bf16 v[188:191], a[84:87], a[0:3], v[188:191]
v_add_u32 v14, 0x8000, v14
v_add_u32 v15, 0x8000, v15
v_mfma_f32_16x16x32_bf16 v[216:219], a[0:3], a[88:91], v[216:219]
v_add_u32 v10, 0x8000, v10
v_add_u32 v11, 0x8000, v11
v_mfma_f32_16x16x32_bf16 v[224:227], a[4:7], a[88:91], v[224:227]
s_add_u32 s8, s28, 0x9400
v_mfma_f32_16x16x32_bf16 v[232:235], a[8:11], a[88:91], v[232:235]
buffer_store_dwordx4 a[244:247], v16, s[88:91], s8 offen sc1
v_mfma_f32_16x16x32_bf16 v[240:243], a[12:15], a[88:91], v[240:243]
v_mfma_f32_16x16x32_bf16 v[252:255], a[16:19], a[88:91], v[252:255]
v_mfma_f32_16x16x32_bf16 v[244:247], a[12:15], a[92:95], v[244:247]
v_mfma_f32_16x16x32_bf16 v[236:239], a[8:11], a[92:95], v[236:239]
v_mfma_f32_16x16x32_bf16 v[228:231], a[4:7], a[92:95], v[228:231]
v_mfma_f32_16x16x32_bf16 v[220:223], a[0:3], a[92:95], v[220:223]
s_waitcnt vmcnt(21) lgkmcnt(0)
s_barrier
v_mfma_f32_16x16x32_bf16 v[24:27], a[40:43], a[20:23], v[24:27]
ds_read_b128 a[0:3], v8 offset:0
s_add_u32 m0, s17, 0x0
v_mfma_f32_16x16x32_bf16 v[56:59], a[40:43], a[24:27], v[56:59]
buffer_load_dwordx4 v5, s[52:55], 0 offen lds
v_mfma_f32_16x16x32_bf16 v[88:91], a[40:43], a[28:31], v[88:91]
ds_read_b128 a[4:7], v8 offset:2048
v_add_u32 v22, 0x80, v22
v_mfma_f32_16x16x32_bf16 v[120:123], a[40:43], a[32:35], v[120:123]
ds_read_b128 a[8:11], v8 offset:4096
v_add_u32 v23, 0x80, v23
v_mfma_f32_16x16x32_bf16 v[124:127], a[44:47], a[32:35], v[124:127]
ds_read_b128 a[12:15], v8 offset:6144
v_mfma_f32_16x16x32_bf16 v[92:95], a[44:47], a[28:31], v[92:95]
ds_read_b128 a[16:19], v10
s_add_u32 m0, s17, 0x400
v_mfma_f32_16x16x32_bf16 v[60:63], a[44:47], a[24:27], v[60:63]
buffer_load_dwordx4 v5, s[52:55], s13 offen lds
v_mfma_f32_16x16x32_bf16 v[28:31], a[44:47], a[20:23], v[28:31]
ds_read_b64_tr_b16 a[84:85], v15 offset:4096
v_mfma_f32_16x16x32_bf16 v[32:35], a[48:51], a[20:23], v[32:35]
ds_read_b64_tr_b16 a[86:87], v15 offset:4352
v_mfma_f32_16x16x32_bf16 v[64:67], a[48:51], a[24:27], v[64:67]
ds_read_b64_tr_b16 a[88:89], v14 offset:8192
v_mfma_f32_16x16x32_bf16 v[96:99], a[48:51], a[28:31], v[96:99]
ds_read_b64_tr_b16 a[90:91], v14 offset:8448
v_mfma_f32_16x16x32_bf16 v[128:131], a[48:51], a[32:35], v[128:131]
ds_read_b64_tr_b16 a[92:93], v15 offset:8192
s_add_u32 m0, s17, 0x800
v_mfma_f32_16x16x32_bf16 v[132:135], a[52:55], a[32:35], v[132:135]
buffer_load_dwordx4 v6, s[52:55], 0 offen lds
v_mfma_f32_16x16x32_bf16 v[100:103], a[52:55], a[28:31], v[100:103]
ds_read_b64_tr_b16 a[94:95], v15 offset:8448
v_mfma_f32_16x16x32_bf16 v[68:71], a[52:55], a[24:27], v[68:71]
ds_read_b64_tr_b16 a[40:41], v12 offset:0
v_mfma_f32_16x16x32_bf16 v[36:39], a[52:55], a[20:23], v[36:39]
ds_read_b64_tr_b16 a[42:43], v12 offset:1024
v_mfma_f32_16x16x32_bf16 v[40:43], a[56:59], a[20:23], v[40:43]
ds_read_b64_tr_b16 a[44:45], v13 offset:0
s_add_u32 m0, s17, 0xc00
v_mfma_f32_16x16x32_bf16 v[72:75], a[56:59], a[24:27], v[72:75]
buffer_load_dwordx4 v6, s[52:55], s13 offen lds
v_mfma_f32_16x16x32_bf16 v[104:107], a[56:59], a[28:31], v[104:107]
ds_read_b64_tr_b16 a[46:47], v13 offset:1024
v_mfma_f32_16x16x32_bf16 v[136:139], a[56:59], a[32:35], v[136:139]
ds_read_b64_tr_b16 a[48:49], v12 offset:256
v_mfma_f32_16x16x32_bf16 v[140:143], a[60:63], a[32:35], v[140:143]
ds_read_b64_tr_b16 a[50:51], v12 offset:1280
v_mfma_f32_16x16x32_bf16 v[108:111], a[60:63], a[28:31], v[108:111]
ds_read_b64_tr_b16 a[52:53], v13 offset:256
v_mfma_f32_16x16x32_bf16 v[76:79], a[60:63], a[24:27], v[76:79]
ds_read_b64_tr_b16 a[54:55], v13 offset:1280
s_add_u32 s8, s28, 0x9800
v_mfma_f32_16x16x32_bf16 v[44:47], a[60:63], a[20:23], v[44:47]
buffer_store_dwordx4 a[248:251], v16, s[88:91], s8 offen sc1
v_mfma_f32_16x16x32_bf16 v[48:51], a[64:67], a[20:23], v[48:51]
ds_read_b64_tr_b16 a[56:57], v12 offset:512
v_mfma_f32_16x16x32_bf16 v[80:83], a[64:67], a[24:27], v[80:83]
ds_read_b64_tr_b16 a[58:59], v12 offset:1536
v_mfma_f32_16x16x32_bf16 v[112:115], a[64:67], a[28:31], v[112:115]
ds_read_b64_tr_b16 a[60:61], v13 offset:512
v_mfma_f32_16x16x32_bf16 v[144:147], a[64:67], a[32:35], v[144:147]
ds_read_b64_tr_b16 a[62:63], v13 offset:1536
s_add_u32 m0, s18, 0x4000
v_mfma_f32_16x16x32_bf16 v[148:151], a[68:71], a[32:35], v[148:151]
buffer_load_dwordx4 v7, s[68:71], 0 offen lds
v_mfma_f32_16x16x32_bf16 v[116:119], a[68:71], a[28:31], v[116:119]
ds_read_b64_tr_b16 a[64:65], v12 offset:768
v_mfma_f32_16x16x32_bf16 v[84:87], a[68:71], a[24:27], v[84:87]
ds_read_b64_tr_b16 a[66:67], v12 offset:1792
v_mfma_f32_16x16x32_bf16 v[52:55], a[68:71], a[20:23], v[52:55]
ds_read_b64_tr_b16 a[68:69], v13 offset:768
v_mfma_f32_16x16x32_bf16 v[152:155], a[72:75], a[20:23], v[152:155]
ds_read_b64_tr_b16 a[70:71], v13 offset:1792
v_mfma_f32_16x16x32_bf16 v[160:163], a[72:75], a[24:27], v[160:163]
s_add_u32 m0, s18, 0x5000
v_mfma_f32_16x16x32_bf16 v[168:171], a[72:75], a[28:31], v[168:171]
buffer_load_dwordx4 v7, s[68:71], s25 offen lds
v_mfma_f32_16x16x32_bf16 v[176:179], a[72:75], a[32:35], v[176:179]
ds_read_b64_tr_b16 a[72:73], v14 offset:0
v_mfma_f32_16x16x32_bf16 v[180:183], a[76:79], a[32:35], v[180:183]
ds_read_b64_tr_b16 a[74:75], v14 offset:256
v_mfma_f32_16x16x32_bf16 v[172:175], a[76:79], a[28:31], v[172:175]
v_mfma_f32_16x16x32_bf16 v[164:167], a[76:79], a[24:27], v[164:167]
s_add_u32 m0, s18, 0x6000
v_mfma_f32_16x16x32_bf16 v[156:159], a[76:79], a[20:23], v[156:159]
buffer_load_dwordx4 v7, s[68:71], s26 offen lds
v_mfma_f32_16x16x32_bf16 v[184:187], a[80:83], a[20:23], v[184:187]
ds_read_b64_tr_b16 a[76:77], v15 offset:0
v_mfma_f32_16x16x32_bf16 v[192:195], a[80:83], a[24:27], v[192:195]
ds_read_b64_tr_b16 a[78:79], v15 offset:256
v_mfma_f32_16x16x32_bf16 v[200:203], a[80:83], a[28:31], v[200:203]
v_mfma_f32_16x16x32_bf16 v[208:211], a[80:83], a[32:35], v[208:211]
v_mfma_f32_16x16x32_bf16 v[248:251], a[80:83], a[36:39], v[248:251]
ds_read_b64_tr_b16 a[80:81], v14 offset:4096
s_add_u32 m0, s18, 0x7000
v_mfma_f32_16x16x32_bf16 v[212:215], a[104:107], a[32:35], v[212:215]
buffer_load_dwordx4 v4, s[44:47], s24 offen lds
v_mfma_f32_16x16x32_bf16 v[204:207], a[104:107], a[28:31], v[204:207]
ds_read_b64_tr_b16 a[82:83], v14 offset:4352
v_mfma_f32_16x16x32_bf16 v[196:199], a[104:107], a[24:27], v[196:199]
v_mfma_f32_16x16x32_bf16 v[188:191], a[104:107], a[20:23], v[188:191]
v_mfma_f32_16x16x32_bf16 v[216:219], a[20:23], a[108:111], v[216:219]
s_add_u32 s8, s28, 0x9c00
v_mfma_f32_16x16x32_bf16 v[224:227], a[24:27], a[108:111], v[224:227]
buffer_store_dwordx4 a[252:255], v16, s[88:91], s8 offen sc1
v_mfma_f32_16x16x32_bf16 v[232:235], a[28:31], a[108:111], v[232:235]
v_mfma_f32_16x16x32_bf16 v[240:243], a[32:35], a[108:111], v[240:243]
v_mfma_f32_16x16x32_bf16 v[252:255], a[36:39], a[108:111], v[252:255]
v_mfma_f32_16x16x32_bf16 v[244:247], a[32:35], a[112:115], v[244:247]
v_mfma_f32_16x16x32_bf16 v[236:239], a[28:31], a[112:115], v[236:239]
v_mfma_f32_16x16x32_bf16 v[228:231], a[24:27], a[112:115], v[228:231]
v_mfma_f32_16x16x32_bf16 v[220:223], a[20:23], a[112:115], v[220:223]
s_waitcnt lgkmcnt(0)
v_mfma_f32_16x16x32_bf16 v[24:27], a[40:43], a[0:3], v[24:27]
ds_read_b128 a[20:23], v9 offset:0
v_add_u32 v5, 0x80000, v5
v_mfma_f32_16x16x32_bf16 v[56:59], a[40:43], a[4:7], v[56:59]
ds_read_b128 a[24:27], v9 offset:2048
v_add_u32 v6, 0x80000, v6
v_mfma_f32_16x16x32_bf16 v[88:91], a[40:43], a[8:11], v[88:91]
ds_read_b128 a[28:31], v9 offset:4096
v_add_u32 v7, 0x60000, v7
v_mfma_f32_16x16x32_bf16 v[120:123], a[40:43], a[12:15], v[120:123]
ds_read_b128 a[32:35], v9 offset:6144
v_add_u32 v4, 0x80, v4
v_mfma_f32_16x16x32_bf16 v[124:127], a[44:47], a[12:15], v[124:127]
ds_read_b128 a[36:39], v11
v_mfma_f32_16x16x32_bf16 v[92:95], a[44:47], a[8:11], v[92:95]
ds_read_b64_tr_b16 a[104:105], v15 offset:6144
v_mfma_f32_16x16x32_bf16 v[60:63], a[44:47], a[4:7], v[60:63]
ds_read_b64_tr_b16 a[106:107], v15 offset:6400
v_mfma_f32_16x16x32_bf16 v[28:31], a[44:47], a[0:3], v[28:31]
ds_read_b64_tr_b16 a[108:109], v14 offset:10240
v_mfma_f32_16x16x32_bf16 v[32:35], a[48:51], a[0:3], v[32:35]
ds_read_b64_tr_b16 a[110:111], v14 offset:10496
s_waitcnt lgkmcnt(5)
v_mfma_f32_16x16x32_bf16 v[64:67], a[48:51], a[4:7], v[64:67]
ds_read_b64_tr_b16 a[112:113], v15 offset:10240
s_add_u32 m0, s16, 0x0
v_mfma_f32_16x16x32_bf16 v[96:99], a[48:51], a[8:11], v[96:99]
buffer_load_dwordx4 v22, s[44:47], s20 offen lds
v_mfma_f32_16x16x32_bf16 v[128:131], a[48:51], a[12:15], v[128:131]
ds_read_b64_tr_b16 a[114:115], v15 offset:10496
v_mfma_f32_16x16x32_bf16 v[132:135], a[52:55], a[12:15], v[132:135]
ds_read_b64_tr_b16 a[40:41], v12 offset:8192
v_mfma_f32_16x16x32_bf16 v[100:103], a[52:55], a[8:11], v[100:103]
ds_read_b64_tr_b16 a[42:43], v12 offset:9216
v_mfma_f32_16x16x32_bf16 v[68:71], a[52:55], a[4:7], v[68:71]
ds_read_b64_tr_b16 a[44:45], v13 offset:8192
s_add_u32 m0, s16, 0x400
v_mfma_f32_16x16x32_bf16 v[36:39], a[52:55], a[0:3], v[36:39]
buffer_load_dwordx4 v23, s[44:47], s20 offen lds
v_mfma_f32_16x16x32_bf16 v[40:43], a[56:59], a[0:3], v[40:43]
ds_read_b64_tr_b16 a[46:47], v13 offset:9216
v_mfma_f32_16x16x32_bf16 v[72:75], a[56:59], a[4:7], v[72:75]
ds_read_b64_tr_b16 a[48:49], v12 offset:8448
v_mfma_f32_16x16x32_bf16 v[104:107], a[56:59], a[8:11], v[104:107]
ds_read_b64_tr_b16 a[50:51], v12 offset:9472
v_mfma_f32_16x16x32_bf16 v[136:139], a[56:59], a[12:15], v[136:139]
ds_read_b64_tr_b16 a[52:53], v13 offset:8448
v_mfma_f32_16x16x32_bf16 v[140:143], a[60:63], a[12:15], v[140:143]
ds_read_b64_tr_b16 a[54:55], v13 offset:9472
s_add_u32 m0, s16, 0x800
v_mfma_f32_16x16x32_bf16 v[108:111], a[60:63], a[8:11], v[108:111]
buffer_load_dwordx4 v22, s[44:47], s21 offen lds
v_mfma_f32_16x16x32_bf16 v[76:79], a[60:63], a[4:7], v[76:79]
ds_read_b64_tr_b16 a[56:57], v12 offset:8704
v_mfma_f32_16x16x32_bf16 v[44:47], a[60:63], a[0:3], v[44:47]
ds_read_b64_tr_b16 a[58:59], v12 offset:9728
v_mfma_f32_16x16x32_bf16 v[48:51], a[64:67], a[0:3], v[48:51]
ds_read_b64_tr_b16 a[60:61], v13 offset:8704
v_mfma_f32_16x16x32_bf16 v[80:83], a[64:67], a[4:7], v[80:83]
ds_read_b64_tr_b16 a[62:63], v13 offset:9728
v_mfma_f32_16x16x32_bf16 v[112:115], a[64:67], a[8:11], v[112:115]
s_add_u32 m0, s16, 0xc00
v_mfma_f32_16x16x32_bf16 v[144:147], a[64:67], a[12:15], v[144:147]
buffer_load_dwordx4 v23, s[44:47], s21 offen lds
v_mfma_f32_16x16x32_bf16 v[148:151], a[68:71], a[12:15], v[148:151]
ds_read_b64_tr_b16 a[64:65], v12 offset:8960
v_mfma_f32_16x16x32_bf16 v[116:119], a[68:71], a[8:11], v[116:119]
ds_read_b64_tr_b16 a[66:67], v12 offset:9984
v_mfma_f32_16x16x32_bf16 v[84:87], a[68:71], a[4:7], v[84:87]
v_mfma_f32_16x16x32_bf16 v[52:55], a[68:71], a[0:3], v[52:55]
ds_read_b64_tr_b16 a[68:69], v13 offset:8960
v_mfma_f32_16x16x32_bf16 v[152:155], a[72:75], a[0:3], v[152:155]
ds_read_b64_tr_b16 a[70:71], v13 offset:9984
s_add_u32 m0, s16, 0x1000
v_mfma_f32_16x16x32_bf16 v[160:163], a[72:75], a[4:7], v[160:163]
buffer_load_dwordx4 v22, s[44:47], s22 offen lds
v_mfma_f32_16x16x32_bf16 v[168:171], a[72:75], a[8:11], v[168:171]
v_mfma_f32_16x16x32_bf16 v[176:179], a[72:75], a[12:15], v[176:179]
ds_read_b64_tr_b16 a[72:73], v14 offset:2048
v_mfma_f32_16x16x32_bf16 v[180:183], a[76:79], a[12:15], v[180:183]
ds_read_b64_tr_b16 a[74:75], v14 offset:2304
v_mfma_f32_16x16x32_bf16 v[172:175], a[76:79], a[8:11], v[172:175]
s_add_u32 m0, s16, 0x1400
v_mfma_f32_16x16x32_bf16 v[164:167], a[76:79], a[4:7], v[164:167]
buffer_load_dwordx4 v23, s[44:47], s22 offen lds
v_mfma_f32_16x16x32_bf16 v[156:159], a[76:79], a[0:3], v[156:159]
ds_read_b64_tr_b16 a[76:77], v15 offset:2048
v_mfma_f32_16x16x32_bf16 v[184:187], a[80:83], a[0:3], v[184:187]
ds_read_b64_tr_b16 a[78:79], v15 offset:2304
v_mfma_f32_16x16x32_bf16 v[192:195], a[80:83], a[4:7], v[192:195]
v_mfma_f32_16x16x32_bf16 v[200:203], a[80:83], a[8:11], v[200:203]
v_mfma_f32_16x16x32_bf16 v[208:211], a[80:83], a[12:15], v[208:211]
s_add_u32 m0, s16, 0x1800
v_mfma_f32_16x16x32_bf16 v[248:251], a[80:83], a[16:19], v[248:251]
buffer_load_dwordx4 v22, s[44:47], s23 offen lds
v_mfma_f32_16x16x32_bf16 v[212:215], a[84:87], a[12:15], v[212:215]
ds_read_b64_tr_b16 a[80:81], v14 offset:6144
v_mfma_f32_16x16x32_bf16 v[204:207], a[84:87], a[8:11], v[204:207]
ds_read_b64_tr_b16 a[82:83], v14 offset:6400
v_add_u32 v12, 0x8000, v12
v_mfma_f32_16x16x32_bf16 v[196:199], a[84:87], a[4:7], v[196:199]
v_add_u32 v13, 0x8000, v13
v_add_u32 v14, 0x8000, v14
v_mfma_f32_16x16x32_bf16 v[188:191], a[84:87], a[0:3], v[188:191]
v_add_u32 v15, 0x8000, v15
v_add_u32 v10, 0x8000, v10
v_mfma_f32_16x16x32_bf16 v[216:219], a[0:3], a[88:91], v[216:219]
s_add_u32 m0, s16, 0x1c00
v_add_u32 v11, 0x8000, v11
v_mfma_f32_16x16x32_bf16 v[224:227], a[4:7], a[88:91], v[224:227]
buffer_load_dwordx4 v23, s[44:47], s23 offen lds
v_mfma_f32_16x16x32_bf16 v[232:235], a[8:11], a[88:91], v[232:235]
v_mfma_f32_16x16x32_bf16 v[240:243], a[12:15], a[88:91], v[240:243]
v_mfma_f32_16x16x32_bf16 v[252:255], a[16:19], a[88:91], v[252:255]
v_mfma_f32_16x16x32_bf16 v[244:247], a[12:15], a[92:95], v[244:247]
v_mfma_f32_16x16x32_bf16 v[236:239], a[8:11], a[92:95], v[236:239]
v_mfma_f32_16x16x32_bf16 v[228:231], a[4:7], a[92:95], v[228:231]
v_mfma_f32_16x16x32_bf16 v[220:223], a[0:3], a[92:95], v[220:223]
s_waitcnt vmcnt(19) lgkmcnt(0)
s_barrier
v_mfma_f32_16x16x32_bf16 v[24:27], a[40:43], a[20:23], v[24:27]
ds_read_b128 a[0:3], v8 offset:32768
s_add_u32 m0, s17, 0x8000
v_mfma_f32_16x16x32_bf16 v[56:59], a[40:43], a[24:27], v[56:59]
buffer_load_dwordx4 v5, s[52:55], 0 offen lds
v_mfma_f32_16x16x32_bf16 v[88:91], a[40:43], a[28:31], v[88:91]
ds_read_b128 a[4:7], v8 offset:34816
v_add_u32 v22, 0x80, v22
v_mfma_f32_16x16x32_bf16 v[120:123], a[40:43], a[32:35], v[120:123]
ds_read_b128 a[8:11], v8 offset:36864
v_add_u32 v23, 0x80, v23
v_mfma_f32_16x16x32_bf16 v[124:127], a[44:47], a[32:35], v[124:127]
ds_read_b128 a[12:15], v8 offset:38912
v_mfma_f32_16x16x32_bf16 v[92:95], a[44:47], a[28:31], v[92:95]
ds_read_b128 a[16:19], v10
v_mfma_f32_16x16x32_bf16 v[60:63], a[44:47], a[24:27], v[60:63]
ds_read_b64_tr_b16 a[84:85], v15 offset:4096
s_add_u32 m0, s17, 0x8400
v_mfma_f32_16x16x32_bf16 v[28:31], a[44:47], a[20:23], v[28:31]
buffer_load_dwordx4 v5, s[52:55], s13 offen lds
v_mfma_f32_16x16x32_bf16 v[32:35], a[48:51], a[20:23], v[32:35]
ds_read_b64_tr_b16 a[86:87], v15 offset:4352
v_mfma_f32_16x16x32_bf16 v[64:67], a[48:51], a[24:27], v[64:67]
ds_read_b64_tr_b16 a[88:89], v14 offset:8192
v_mfma_f32_16x16x32_bf16 v[96:99], a[48:51], a[28:31], v[96:99]
ds_read_b64_tr_b16 a[90:91], v14 offset:8448
v_mfma_f32_16x16x32_bf16 v[128:131], a[48:51], a[32:35], v[128:131]
ds_read_b64_tr_b16 a[92:93], v15 offset:8192
v_mfma_f32_16x16x32_bf16 v[132:135], a[52:55], a[32:35], v[132:135]
ds_read_b64_tr_b16 a[94:95], v15 offset:8448
v_mfma_f32_16x16x32_bf16 v[100:103], a[52:55], a[28:31], v[100:103]
ds_read_b64_tr_b16 a[40:41], v12 offset:0
s_add_u32 m0, s17, 0x8800
v_mfma_f32_16x16x32_bf16 v[68:71], a[52:55], a[24:27], v[68:71]
buffer_load_dwordx4 v6, s[52:55], 0 offen lds
v_mfma_f32_16x16x32_bf16 v[36:39], a[52:55], a[20:23], v[36:39]
ds_read_b64_tr_b16 a[42:43], v12 offset:1024
v_mfma_f32_16x16x32_bf16 v[40:43], a[56:59], a[20:23], v[40:43]
ds_read_b64_tr_b16 a[44:45], v13 offset:0
v_mfma_f32_16x16x32_bf16 v[72:75], a[56:59], a[24:27], v[72:75]
ds_read_b64_tr_b16 a[46:47], v13 offset:1024
v_mfma_f32_16x16x32_bf16 v[104:107], a[56:59], a[28:31], v[104:107]
ds_read_b64_tr_b16 a[48:49], v12 offset:256
v_mfma_f32_16x16x32_bf16 v[136:139], a[56:59], a[32:35], v[136:139]
ds_read_b64_tr_b16 a[50:51], v12 offset:1280
v_mfma_f32_16x16x32_bf16 v[140:143], a[60:63], a[32:35], v[140:143]
ds_read_b64_tr_b16 a[52:53], v13 offset:256
s_add_u32 m0, s17, 0x8c00
v_mfma_f32_16x16x32_bf16 v[108:111], a[60:63], a[28:31], v[108:111]
buffer_load_dwordx4 v6, s[52:55], s13 offen lds
v_mfma_f32_16x16x32_bf16 v[76:79], a[60:63], a[24:27], v[76:79]
ds_read_b64_tr_b16 a[54:55], v13 offset:1280
v_mfma_f32_16x16x32_bf16 v[44:47], a[60:63], a[20:23], v[44:47]
ds_read_b64_tr_b16 a[56:57], v12 offset:512
v_mfma_f32_16x16x32_bf16 v[48:51], a[64:67], a[20:23], v[48:51]
ds_read_b64_tr_b16 a[58:59], v12 offset:1536
v_mfma_f32_16x16x32_bf16 v[80:83], a[64:67], a[24:27], v[80:83]
ds_read_b64_tr_b16 a[60:61], v13 offset:512
v_mfma_f32_16x16x32_bf16 v[112:115], a[64:67], a[28:31], v[112:115]
ds_read_b64_tr_b16 a[62:63], v13 offset:1536
v_mfma_f32_16x16x32_bf16 v[144:147], a[64:67], a[32:35], v[144:147]
ds_read_b64_tr_b16 a[64:65], v12 offset:768
s_add_u32 m0, s18, 0xc000
v_mfma_f32_16x16x32_bf16 v[148:151], a[68:71], a[32:35], v[148:151]
buffer_load_dwordx4 v7, s[68:71], 0 offen lds
v_mfma_f32_16x16x32_bf16 v[116:119], a[68:71], a[28:31], v[116:119]
ds_read_b64_tr_b16 a[66:67], v12 offset:1792
v_mfma_f32_16x16x32_bf16 v[84:87], a[68:71], a[24:27], v[84:87]
v_mfma_f32_16x16x32_bf16 v[52:55], a[68:71], a[20:23], v[52:55]
ds_read_b64_tr_b16 a[68:69], v13 offset:768
v_mfma_f32_16x16x32_bf16 v[152:155], a[72:75], a[20:23], v[152:155]
ds_read_b64_tr_b16 a[70:71], v13 offset:1792
v_mfma_f32_16x16x32_bf16 v[160:163], a[72:75], a[24:27], v[160:163]
v_mfma_f32_16x16x32_bf16 v[168:171], a[72:75], a[28:31], v[168:171]
s_add_u32 m0, s18, 0xd000
v_mfma_f32_16x16x32_bf16 v[176:179], a[72:75], a[32:35], v[176:179]
buffer_load_dwordx4 v7, s[68:71], s25 offen lds
v_mfma_f32_16x16x32_bf16 v[180:183], a[76:79], a[32:35], v[180:183]
ds_read_b64_tr_b16 a[72:73], v14 offset:0
v_mfma_f32_16x16x32_bf16 v[172:175], a[76:79], a[28:31], v[172:175]
ds_read_b64_tr_b16 a[74:75], v14 offset:256
v_mfma_f32_16x16x32_bf16 v[164:167], a[76:79], a[24:27], v[164:167]
v_mfma_f32_16x16x32_bf16 v[156:159], a[76:79], a[20:23], v[156:159]
ds_read_b64_tr_b16 a[76:77], v15 offset:0
v_mfma_f32_16x16x32_bf16 v[184:187], a[80:83], a[20:23], v[184:187]
ds_read_b64_tr_b16 a[78:79], v15 offset:256
v_mfma_f32_16x16x32_bf16 v[192:195], a[80:83], a[24:27], v[192:195]
s_add_u32 m0, s18, 0xe000
v_mfma_f32_16x16x32_bf16 v[200:203], a[80:83], a[28:31], v[200:203]
buffer_load_dwordx4 v7, s[68:71], s26 offen lds
v_mfma_f32_16x16x32_bf16 v[208:211], a[80:83], a[32:35], v[208:211]
v_mfma_f32_16x16x32_bf16 v[248:251], a[80:83], a[36:39], v[248:251]
ds_read_b64_tr_b16 a[80:81], v14 offset:4096
v_mfma_f32_16x16x32_bf16 v[212:215], a[104:107], a[32:35], v[212:215]
ds_read_b64_tr_b16 a[82:83], v14 offset:4352
v_mfma_f32_16x16x32_bf16 v[204:207], a[104:107], a[28:31], v[204:207]
v_mfma_f32_16x16x32_bf16 v[196:199], a[104:107], a[24:27], v[196:199]
v_mfma_f32_16x16x32_bf16 v[188:191], a[104:107], a[20:23], v[188:191]
s_add_u32 m0, s18, 0xf000
v_mfma_f32_16x16x32_bf16 v[216:219], a[20:23], a[108:111], v[216:219]
buffer_load_dwordx4 v4, s[44:47], s24 offen lds
v_mfma_f32_16x16x32_bf16 v[224:227], a[24:27], a[108:111], v[224:227]
v_mfma_f32_16x16x32_bf16 v[232:235], a[28:31], a[108:111], v[232:235]
v_mfma_f32_16x16x32_bf16 v[240:243], a[32:35], a[108:111], v[240:243]
v_mfma_f32_16x16x32_bf16 v[252:255], a[36:39], a[108:111], v[252:255]
v_mfma_f32_16x16x32_bf16 v[244:247], a[32:35], a[112:115], v[244:247]
v_mfma_f32_16x16x32_bf16 v[236:239], a[28:31], a[112:115], v[236:239]
v_mfma_f32_16x16x32_bf16 v[228:231], a[24:27], a[112:115], v[228:231]
v_mfma_f32_16x16x32_bf16 v[220:223], a[20:23], a[112:115], v[220:223]
s_waitcnt lgkmcnt(0)
v_mfma_f32_16x16x32_bf16 v[24:27], a[40:43], a[0:3], v[24:27]
ds_read_b128 a[20:23], v9 offset:32768
v_add_u32 v5, 0x80000, v5
v_mfma_f32_16x16x32_bf16 v[56:59], a[40:43], a[4:7], v[56:59]
ds_read_b128 a[24:27], v9 offset:34816
v_add_u32 v6, 0x80000, v6
v_mfma_f32_16x16x32_bf16 v[88:91], a[40:43], a[8:11], v[88:91]
ds_read_b128 a[28:31], v9 offset:36864
v_add_u32 v7, 0x60000, v7
v_mfma_f32_16x16x32_bf16 v[120:123], a[40:43], a[12:15], v[120:123]
ds_read_b128 a[32:35], v9 offset:38912
v_add_u32 v4, 0x80, v4
v_mfma_f32_16x16x32_bf16 v[124:127], a[44:47], a[12:15], v[124:127]
ds_read_b128 a[36:39], v11
v_mfma_f32_16x16x32_bf16 v[92:95], a[44:47], a[8:11], v[92:95]
ds_read_b64_tr_b16 a[104:105], v15 offset:6144
v_mfma_f32_16x16x32_bf16 v[60:63], a[44:47], a[4:7], v[60:63]
ds_read_b64_tr_b16 a[106:107], v15 offset:6400
v_mfma_f32_16x16x32_bf16 v[28:31], a[44:47], a[0:3], v[28:31]
ds_read_b64_tr_b16 a[108:109], v14 offset:10240
v_mfma_f32_16x16x32_bf16 v[32:35], a[48:51], a[0:3], v[32:35]
ds_read_b64_tr_b16 a[110:111], v14 offset:10496
s_waitcnt lgkmcnt(5)
v_mfma_f32_16x16x32_bf16 v[64:67], a[48:51], a[4:7], v[64:67]
ds_read_b64_tr_b16 a[112:113], v15 offset:10240
s_add_u32 m0, s16, 0x8000
v_mfma_f32_16x16x32_bf16 v[96:99], a[48:51], a[8:11], v[96:99]
buffer_load_dwordx4 v22, s[44:47], s20 offen lds
v_mfma_f32_16x16x32_bf16 v[128:131], a[48:51], a[12:15], v[128:131]
ds_read_b64_tr_b16 a[114:115], v15 offset:10496
v_mfma_f32_16x16x32_bf16 v[132:135], a[52:55], a[12:15], v[132:135]
ds_read_b64_tr_b16 a[40:41], v12 offset:8192
v_mfma_f32_16x16x32_bf16 v[100:103], a[52:55], a[8:11], v[100:103]
ds_read_b64_tr_b16 a[42:43], v12 offset:9216
v_mfma_f32_16x16x32_bf16 v[68:71], a[52:55], a[4:7], v[68:71]
ds_read_b64_tr_b16 a[44:45], v13 offset:8192
s_add_u32 m0, s16, 0x8400
v_mfma_f32_16x16x32_bf16 v[36:39], a[52:55], a[0:3], v[36:39]
buffer_load_dwordx4 v23, s[44:47], s20 offen lds
v_mfma_f32_16x16x32_bf16 v[40:43], a[56:59], a[0:3], v[40:43]
ds_read_b64_tr_b16 a[46:47], v13 offset:9216
v_mfma_f32_16x16x32_bf16 v[72:75], a[56:59], a[4:7], v[72:75]
ds_read_b64_tr_b16 a[48:49], v12 offset:8448
v_mfma_f32_16x16x32_bf16 v[104:107], a[56:59], a[8:11], v[104:107]
ds_read_b64_tr_b16 a[50:51], v12 offset:9472
v_mfma_f32_16x16x32_bf16 v[136:139], a[56:59], a[12:15], v[136:139]
ds_read_b64_tr_b16 a[52:53], v13 offset:8448
v_mfma_f32_16x16x32_bf16 v[140:143], a[60:63], a[12:15], v[140:143]
ds_read_b64_tr_b16 a[54:55], v13 offset:9472
s_add_u32 m0, s16, 0x8800
v_mfma_f32_16x16x32_bf16 v[108:111], a[60:63], a[8:11], v[108:111]
buffer_load_dwordx4 v22, s[44:47], s21 offen lds
v_mfma_f32_16x16x32_bf16 v[76:79], a[60:63], a[4:7], v[76:79]
ds_read_b64_tr_b16 a[56:57], v12 offset:8704
v_mfma_f32_16x16x32_bf16 v[44:47], a[60:63], a[0:3], v[44:47]
ds_read_b64_tr_b16 a[58:59], v12 offset:9728
v_mfma_f32_16x16x32_bf16 v[48:51], a[64:67], a[0:3], v[48:51]
ds_read_b64_tr_b16 a[60:61], v13 offset:8704
v_mfma_f32_16x16x32_bf16 v[80:83], a[64:67], a[4:7], v[80:83]
ds_read_b64_tr_b16 a[62:63], v13 offset:9728
v_mfma_f32_16x16x32_bf16 v[112:115], a[64:67], a[8:11], v[112:115]
s_add_u32 m0, s16, 0x8c00
v_mfma_f32_16x16x32_bf16 v[144:147], a[64:67], a[12:15], v[144:147]
buffer_load_dwordx4 v23, s[44:47], s21 offen lds
v_mfma_f32_16x16x32_bf16 v[148:151], a[68:71], a[12:15], v[148:151]
ds_read_b64_tr_b16 a[64:65], v12 offset:8960
v_mfma_f32_16x16x32_bf16 v[116:119], a[68:71], a[8:11], v[116:119]
ds_read_b64_tr_b16 a[66:67], v12 offset:9984
v_mfma_f32_16x16x32_bf16 v[84:87], a[68:71], a[4:7], v[84:87]
v_mfma_f32_16x16x32_bf16 v[52:55], a[68:71], a[0:3], v[52:55]
ds_read_b64_tr_b16 a[68:69], v13 offset:8960
v_mfma_f32_16x16x32_bf16 v[152:155], a[72:75], a[0:3], v[152:155]
ds_read_b64_tr_b16 a[70:71], v13 offset:9984
s_add_u32 m0, s16, 0x9000
v_mfma_f32_16x16x32_bf16 v[160:163], a[72:75], a[4:7], v[160:163]
buffer_load_dwordx4 v22, s[44:47], s22 offen lds
v_mfma_f32_16x16x32_bf16 v[168:171], a[72:75], a[8:11], v[168:171]
v_mfma_f32_16x16x32_bf16 v[176:179], a[72:75], a[12:15], v[176:179]
ds_read_b64_tr_b16 a[72:73], v14 offset:2048
v_mfma_f32_16x16x32_bf16 v[180:183], a[76:79], a[12:15], v[180:183]
ds_read_b64_tr_b16 a[74:75], v14 offset:2304
v_mfma_f32_16x16x32_bf16 v[172:175], a[76:79], a[8:11], v[172:175]
s_add_u32 m0, s16, 0x9400
v_mfma_f32_16x16x32_bf16 v[164:167], a[76:79], a[4:7], v[164:167]
buffer_load_dwordx4 v23, s[44:47], s22 offen lds
v_mfma_f32_16x16x32_bf16 v[156:159], a[76:79], a[0:3], v[156:159]
ds_read_b64_tr_b16 a[76:77], v15 offset:2048
v_mfma_f32_16x16x32_bf16 v[184:187], a[80:83], a[0:3], v[184:187]
ds_read_b64_tr_b16 a[78:79], v15 offset:2304
v_mfma_f32_16x16x32_bf16 v[192:195], a[80:83], a[4:7], v[192:195]
v_mfma_f32_16x16x32_bf16 v[200:203], a[80:83], a[8:11], v[200:203]
v_mfma_f32_16x16x32_bf16 v[208:211], a[80:83], a[12:15], v[208:211]
s_add_u32 m0, s16, 0x9800
v_mfma_f32_16x16x32_bf16 v[248:251], a[80:83], a[16:19], v[248:251]
buffer_load_dwordx4 v22, s[44:47], s23 offen lds
v_mfma_f32_16x16x32_bf16 v[212:215], a[84:87], a[12:15], v[212:215]
ds_read_b64_tr_b16 a[80:81], v14 offset:6144
v_mfma_f32_16x16x32_bf16 v[204:207], a[84:87], a[8:11], v[204:207]
ds_read_b64_tr_b16 a[82:83], v14 offset:6400
v_add_u32 v12, 0xffff0000, v12
v_mfma_f32_16x16x32_bf16 v[196:199], a[84:87], a[4:7], v[196:199]
v_add_u32 v13, 0xffff0000, v13
v_add_u32 v14, 0xffff0000, v14
v_mfma_f32_16x16x32_bf16 v[188:191], a[84:87], a[0:3], v[188:191]
v_add_u32 v15, 0xffff0000, v15
v_add_u32 v10, 0xffff0000, v10
v_mfma_f32_16x16x32_bf16 v[216:219], a[0:3], a[88:91], v[216:219]
s_add_u32 m0, s16, 0x9c00
v_add_u32 v11, 0xffff0000, v11
v_mfma_f32_16x16x32_bf16 v[224:227], a[4:7], a[88:91], v[224:227]
buffer_load_dwordx4 v23, s[44:47], s23 offen lds
v_mfma_f32_16x16x32_bf16 v[232:235], a[8:11], a[88:91], v[232:235]
v_mfma_f32_16x16x32_bf16 v[240:243], a[12:15], a[88:91], v[240:243]
v_mfma_f32_16x16x32_bf16 v[252:255], a[16:19], a[88:91], v[252:255]
v_mfma_f32_16x16x32_bf16 v[244:247], a[12:15], a[92:95], v[244:247]
v_mfma_f32_16x16x32_bf16 v[236:239], a[8:11], a[92:95], v[236:239]
v_mfma_f32_16x16x32_bf16 v[228:231], a[4:7], a[92:95], v[228:231]
v_mfma_f32_16x16x32_bf16 v[220:223], a[0:3], a[92:95], v[220:223]
s_waitcnt vmcnt(16) lgkmcnt(0)
s_barrier
s_lshl_b32 s10, s5, 2
s_add_u32 s10, s10, 64
s_cmp_lg_u32 s4, 0
s_cbranch_scc1 L_sig_kv
v_mov_b32 v20, 1
s_mov_b64 exec, 1
buffer_atomic_add v20, off, s[84:87], s10 sc1
s_mov_b64 exec, -1
L_sig_kv:
v_mfma_f32_16x16x32_bf16 v[24:27], a[40:43], a[20:23], v[24:27]
ds_read_b128 a[0:3], v8 offset:0
s_add_u32 m0, s17, 0x10000
v_mfma_f32_16x16x32_bf16 v[56:59], a[40:43], a[24:27], v[56:59]
buffer_load_dwordx4 v5, s[52:55], 0 offen lds
v_mfma_f32_16x16x32_bf16 v[88:91], a[40:43], a[28:31], v[88:91]
ds_read_b128 a[4:7], v8 offset:2048
v_add_u32 v22, 0x80, v22
v_mfma_f32_16x16x32_bf16 v[120:123], a[40:43], a[32:35], v[120:123]
ds_read_b128 a[8:11], v8 offset:4096
v_add_u32 v23, 0x80, v23
v_mfma_f32_16x16x32_bf16 v[124:127], a[44:47], a[32:35], v[124:127]
ds_read_b128 a[12:15], v8 offset:6144
v_mfma_f32_16x16x32_bf16 v[92:95], a[44:47], a[28:31], v[92:95]
ds_read_b128 a[16:19], v10
v_mfma_f32_16x16x32_bf16 v[60:63], a[44:47], a[24:27], v[60:63]
ds_read_b64_tr_b16 a[84:85], v15 offset:4096
s_add_u32 m0, s17, 0x10400
v_mfma_f32_16x16x32_bf16 v[28:31], a[44:47], a[20:23], v[28:31]
buffer_load_dwordx4 v5, s[52:55], s13 offen lds
v_mfma_f32_16x16x32_bf16 v[32:35], a[48:51], a[20:23], v[32:35]
ds_read_b64_tr_b16 a[86:87], v15 offset:4352
v_mfma_f32_16x16x32_bf16 v[64:67], a[48:51], a[24:27], v[64:67]
ds_read_b64_tr_b16 a[88:89], v14 offset:8192
v_mfma_f32_16x16x32_bf16 v[96:99], a[48:51], a[28:31], v[96:99]
ds_read_b64_tr_b16 a[90:91], v14 offset:8448
v_mfma_f32_16x16x32_bf16 v[128:131], a[48:51], a[32:35], v[128:131]
ds_read_b64_tr_b16 a[92:93], v15 offset:8192
v_mfma_f32_16x16x32_bf16 v[132:135], a[52:55], a[32:35], v[132:135]
ds_read_b64_tr_b16 a[94:95], v15 offset:8448
v_mfma_f32_16x16x32_bf16 v[100:103], a[52:55], a[28:31], v[100:103]
ds_read_b64_tr_b16 a[40:41], v12 offset:0
s_add_u32 m0, s17, 0x10800
v_mfma_f32_16x16x32_bf16 v[68:71], a[52:55], a[24:27], v[68:71]
buffer_load_dwordx4 v6, s[52:55], 0 offen lds
v_mfma_f32_16x16x32_bf16 v[36:39], a[52:55], a[20:23], v[36:39]
ds_read_b64_tr_b16 a[42:43], v12 offset:1024
v_mfma_f32_16x16x32_bf16 v[40:43], a[56:59], a[20:23], v[40:43]
ds_read_b64_tr_b16 a[44:45], v13 offset:0
v_mfma_f32_16x16x32_bf16 v[72:75], a[56:59], a[24:27], v[72:75]
ds_read_b64_tr_b16 a[46:47], v13 offset:1024
v_mfma_f32_16x16x32_bf16 v[104:107], a[56:59], a[28:31], v[104:107]
ds_read_b64_tr_b16 a[48:49], v12 offset:256
v_mfma_f32_16x16x32_bf16 v[136:139], a[56:59], a[32:35], v[136:139]
ds_read_b64_tr_b16 a[50:51], v12 offset:1280
v_mfma_f32_16x16x32_bf16 v[140:143], a[60:63], a[32:35], v[140:143]
ds_read_b64_tr_b16 a[52:53], v13 offset:256
s_add_u32 m0, s17, 0x10c00
v_mfma_f32_16x16x32_bf16 v[108:111], a[60:63], a[28:31], v[108:111]
buffer_load_dwordx4 v6, s[52:55], s13 offen lds
v_mfma_f32_16x16x32_bf16 v[76:79], a[60:63], a[24:27], v[76:79]
ds_read_b64_tr_b16 a[54:55], v13 offset:1280
v_mfma_f32_16x16x32_bf16 v[44:47], a[60:63], a[20:23], v[44:47]
ds_read_b64_tr_b16 a[56:57], v12 offset:512
v_mfma_f32_16x16x32_bf16 v[48:51], a[64:67], a[20:23], v[48:51]
ds_read_b64_tr_b16 a[58:59], v12 offset:1536
v_mfma_f32_16x16x32_bf16 v[80:83], a[64:67], a[24:27], v[80:83]
ds_read_b64_tr_b16 a[60:61], v13 offset:512
v_mfma_f32_16x16x32_bf16 v[112:115], a[64:67], a[28:31], v[112:115]
ds_read_b64_tr_b16 a[62:63], v13 offset:1536
v_mfma_f32_16x16x32_bf16 v[144:147], a[64:67], a[32:35], v[144:147]
ds_read_b64_tr_b16 a[64:65], v12 offset:768
s_add_u32 m0, s18, 0x14000
v_mfma_f32_16x16x32_bf16 v[148:151], a[68:71], a[32:35], v[148:151]
buffer_load_dwordx4 v7, s[68:71], 0 offen lds
v_mfma_f32_16x16x32_bf16 v[116:119], a[68:71], a[28:31], v[116:119]
ds_read_b64_tr_b16 a[66:67], v12 offset:1792
v_mfma_f32_16x16x32_bf16 v[84:87], a[68:71], a[24:27], v[84:87]
v_mfma_f32_16x16x32_bf16 v[52:55], a[68:71], a[20:23], v[52:55]
ds_read_b64_tr_b16 a[68:69], v13 offset:768
v_mfma_f32_16x16x32_bf16 v[152:155], a[72:75], a[20:23], v[152:155]
ds_read_b64_tr_b16 a[70:71], v13 offset:1792
v_mfma_f32_16x16x32_bf16 v[160:163], a[72:75], a[24:27], v[160:163]
v_mfma_f32_16x16x32_bf16 v[168:171], a[72:75], a[28:31], v[168:171]
s_add_u32 m0, s18, 0x15000
v_mfma_f32_16x16x32_bf16 v[176:179], a[72:75], a[32:35], v[176:179]
buffer_load_dwordx4 v7, s[68:71], s25 offen lds
v_mfma_f32_16x16x32_bf16 v[180:183], a[76:79], a[32:35], v[180:183]
ds_read_b64_tr_b16 a[72:73], v14 offset:0
v_mfma_f32_16x16x32_bf16 v[172:175], a[76:79], a[28:31], v[172:175]
ds_read_b64_tr_b16 a[74:75], v14 offset:256
v_mfma_f32_16x16x32_bf16 v[164:167], a[76:79], a[24:27], v[164:167]
v_mfma_f32_16x16x32_bf16 v[156:159], a[76:79], a[20:23], v[156:159]
ds_read_b64_tr_b16 a[76:77], v15 offset:0
v_mfma_f32_16x16x32_bf16 v[184:187], a[80:83], a[20:23], v[184:187]
ds_read_b64_tr_b16 a[78:79], v15 offset:256
v_mfma_f32_16x16x32_bf16 v[192:195], a[80:83], a[24:27], v[192:195]
s_add_u32 m0, s18, 0x16000
v_mfma_f32_16x16x32_bf16 v[200:203], a[80:83], a[28:31], v[200:203]
buffer_load_dwordx4 v7, s[68:71], s26 offen lds
v_mfma_f32_16x16x32_bf16 v[208:211], a[80:83], a[32:35], v[208:211]
v_mfma_f32_16x16x32_bf16 v[248:251], a[80:83], a[36:39], v[248:251]
ds_read_b64_tr_b16 a[80:81], v14 offset:4096
v_mfma_f32_16x16x32_bf16 v[212:215], a[104:107], a[32:35], v[212:215]
ds_read_b64_tr_b16 a[82:83], v14 offset:4352
v_mfma_f32_16x16x32_bf16 v[204:207], a[104:107], a[28:31], v[204:207]
v_mfma_f32_16x16x32_bf16 v[196:199], a[104:107], a[24:27], v[196:199]
v_mfma_f32_16x16x32_bf16 v[188:191], a[104:107], a[20:23], v[188:191]
s_add_u32 m0, s18, 0x17000
v_mfma_f32_16x16x32_bf16 v[216:219], a[20:23], a[108:111], v[216:219]
buffer_load_dwordx4 v4, s[44:47], s24 offen lds
v_mfma_f32_16x16x32_bf16 v[224:227], a[24:27], a[108:111], v[224:227]
v_mfma_f32_16x16x32_bf16 v[232:235], a[28:31], a[108:111], v[232:235]
v_mfma_f32_16x16x32_bf16 v[240:243], a[32:35], a[108:111], v[240:243]
v_mfma_f32_16x16x32_bf16 v[252:255], a[36:39], a[108:111], v[252:255]
v_mfma_f32_16x16x32_bf16 v[244:247], a[32:35], a[112:115], v[244:247]
v_mfma_f32_16x16x32_bf16 v[236:239], a[28:31], a[112:115], v[236:239]
v_mfma_f32_16x16x32_bf16 v[228:231], a[24:27], a[112:115], v[228:231]
v_mfma_f32_16x16x32_bf16 v[220:223], a[20:23], a[112:115], v[220:223]
s_waitcnt lgkmcnt(0)
v_mfma_f32_16x16x32_bf16 v[24:27], a[40:43], a[0:3], v[24:27]
ds_read_b128 a[20:23], v9 offset:0
v_add_u32 v5, 0x80000, v5
v_mfma_f32_16x16x32_bf16 v[56:59], a[40:43], a[4:7], v[56:59]
ds_read_b128 a[24:27], v9 offset:2048
v_add_u32 v6, 0x80000, v6
v_mfma_f32_16x16x32_bf16 v[88:91], a[40:43], a[8:11], v[88:91]
ds_read_b128 a[28:31], v9 offset:4096
v_add_u32 v7, 0x60000, v7
v_mfma_f32_16x16x32_bf16 v[120:123], a[40:43], a[12:15], v[120:123]
ds_read_b128 a[32:35], v9 offset:6144
v_add_u32 v4, 0x80, v4
v_mfma_f32_16x16x32_bf16 v[124:127], a[44:47], a[12:15], v[124:127]
ds_read_b128 a[36:39], v11
v_mfma_f32_16x16x32_bf16 v[92:95], a[44:47], a[8:11], v[92:95]
ds_read_b64_tr_b16 a[104:105], v15 offset:6144
v_mfma_f32_16x16x32_bf16 v[60:63], a[44:47], a[4:7], v[60:63]
ds_read_b64_tr_b16 a[106:107], v15 offset:6400
v_mfma_f32_16x16x32_bf16 v[28:31], a[44:47], a[0:3], v[28:31]
ds_read_b64_tr_b16 a[108:109], v14 offset:10240
v_mfma_f32_16x16x32_bf16 v[32:35], a[48:51], a[0:3], v[32:35]
ds_read_b64_tr_b16 a[110:111], v14 offset:10496
s_waitcnt lgkmcnt(5)
v_mfma_f32_16x16x32_bf16 v[64:67], a[48:51], a[4:7], v[64:67]
ds_read_b64_tr_b16 a[112:113], v15 offset:10240
s_add_u32 m0, s16, 0x0
v_mfma_f32_16x16x32_bf16 v[96:99], a[48:51], a[8:11], v[96:99]
buffer_load_dwordx4 v22, s[44:47], s20 offen lds
v_mfma_f32_16x16x32_bf16 v[128:131], a[48:51], a[12:15], v[128:131]
ds_read_b64_tr_b16 a[114:115], v15 offset:10496
v_mfma_f32_16x16x32_bf16 v[132:135], a[52:55], a[12:15], v[132:135]
ds_read_b64_tr_b16 a[40:41], v12 offset:8192
v_mfma_f32_16x16x32_bf16 v[100:103], a[52:55], a[8:11], v[100:103]
ds_read_b64_tr_b16 a[42:43], v12 offset:9216
v_mfma_f32_16x16x32_bf16 v[68:71], a[52:55], a[4:7], v[68:71]
ds_read_b64_tr_b16 a[44:45], v13 offset:8192
s_add_u32 m0, s16, 0x400
v_mfma_f32_16x16x32_bf16 v[36:39], a[52:55], a[0:3], v[36:39]
buffer_load_dwordx4 v23, s[44:47], s20 offen lds
v_mfma_f32_16x16x32_bf16 v[40:43], a[56:59], a[0:3], v[40:43]
ds_read_b64_tr_b16 a[46:47], v13 offset:9216
v_mfma_f32_16x16x32_bf16 v[72:75], a[56:59], a[4:7], v[72:75]
ds_read_b64_tr_b16 a[48:49], v12 offset:8448
v_mfma_f32_16x16x32_bf16 v[104:107], a[56:59], a[8:11], v[104:107]
ds_read_b64_tr_b16 a[50:51], v12 offset:9472
v_mfma_f32_16x16x32_bf16 v[136:139], a[56:59], a[12:15], v[136:139]
ds_read_b64_tr_b16 a[52:53], v13 offset:8448
s_add_u32 m0, s16, 0x800
v_mfma_f32_16x16x32_bf16 v[140:143], a[60:63], a[12:15], v[140:143]
buffer_load_dwordx4 v22, s[44:47], s21 offen lds
v_mfma_f32_16x16x32_bf16 v[108:111], a[60:63], a[8:11], v[108:111]
ds_read_b64_tr_b16 a[54:55], v13 offset:9472
v_mfma_f32_16x16x32_bf16 v[76:79], a[60:63], a[4:7], v[76:79]
ds_read_b64_tr_b16 a[56:57], v12 offset:8704
v_mfma_f32_16x16x32_bf16 v[44:47], a[60:63], a[0:3], v[44:47]
ds_read_b64_tr_b16 a[58:59], v12 offset:9728
v_mfma_f32_16x16x32_bf16 v[48:51], a[64:67], a[0:3], v[48:51]
ds_read_b64_tr_b16 a[60:61], v13 offset:8704
s_add_u32 m0, s16, 0xc00
v_mfma_f32_16x16x32_bf16 v[80:83], a[64:67], a[4:7], v[80:83]
buffer_load_dwordx4 v23, s[44:47], s21 offen lds
v_mfma_f32_16x16x32_bf16 v[112:115], a[64:67], a[8:11], v[112:115]
ds_read_b64_tr_b16 a[62:63], v13 offset:9728
v_mfma_f32_16x16x32_bf16 v[144:147], a[64:67], a[12:15], v[144:147]
ds_read_b64_tr_b16 a[64:65], v12 offset:8960
v_mfma_f32_16x16x32_bf16 v[148:151], a[68:71], a[12:15], v[148:151]
ds_read_b64_tr_b16 a[66:67], v12 offset:9984
v_mfma_f32_16x16x32_bf16 v[116:119], a[68:71], a[8:11], v[116:119]
s_add_u32 m0, s16, 0x1000
v_mfma_f32_16x16x32_bf16 v[84:87], a[68:71], a[4:7], v[84:87]
buffer_load_dwordx4 v22, s[44:47], s22 offen lds
v_mfma_f32_16x16x32_bf16 v[52:55], a[68:71], a[0:3], v[52:55]
ds_read_b64_tr_b16 a[68:69], v13 offset:8960
v_mfma_f32_16x16x32_bf16 v[152:155], a[72:75], a[0:3], v[152:155]
ds_read_b64_tr_b16 a[70:71], v13 offset:9984
v_mfma_f32_16x16x32_bf16 v[160:163], a[72:75], a[4:7], v[160:163]
v_mfma_f32_16x16x32_bf16 v[168:171], a[72:75], a[8:11], v[168:171]
s_add_u32 m0, s16, 0x1400
v_mfma_f32_16x16x32_bf16 v[176:179], a[72:75], a[12:15], v[176:179]
buffer_load_dwordx4 v23, s[44:47], s22 offen lds
v_mfma_f32_16x16x32_bf16 v[180:183], a[76:79], a[12:15], v[180:183]
ds_read_b64_tr_b16 a[72:73], v14 offset:2048
v_mfma_f32_16x16x32_bf16 v[172:175], a[76:79], a[8:11], v[172:175]
ds_read_b64_tr_b16 a[74:75], v14 offset:2304
v_mfma_f32_16x16x32_bf16 v[164:167], a[76:79], a[4:7], v[164:167]
v_mfma_f32_16x16x32_bf16 v[156:159], a[76:79], a[0:3], v[156:159]
ds_read_b64_tr_b16 a[76:77], v15 offset:2048
s_add_u32 m0, s16, 0x1800
v_mfma_f32_16x16x32_bf16 v[184:187], a[80:83], a[0:3], v[184:187]
buffer_load_dwordx4 v22, s[44:47], s23 offen lds
v_mfma_f32_16x16x32_bf16 v[192:195], a[80:83], a[4:7], v[192:195]
ds_read_b64_tr_b16 a[78:79], v15 offset:2304
v_mfma_f32_16x16x32_bf16 v[200:203], a[80:83], a[8:11], v[200:203]
v_mfma_f32_16x16x32_bf16 v[208:211], a[80:83], a[12:15], v[208:211]
v_mfma_f32_16x16x32_bf16 v[248:251], a[80:83], a[16:19], v[248:251]
ds_read_b64_tr_b16 a[80:81], v14 offset:6144
s_add_u32 m0, s16, 0x1c00
v_mfma_f32_16x16x32_bf16 v[212:215], a[84:87], a[12:15], v[212:215]
buffer_load_dwordx4 v23, s[44:47], s23 offen lds
v_mfma_f32_16x16x32_bf16 v[204:207], a[84:87], a[8:11], v[204:207]
ds_read_b64_tr_b16 a[82:83], v14 offset:6400
v_add_u32 v12, 0x8000, v12
v_mfma_f32_16x16x32_bf16 v[196:199], a[84:87], a[4:7], v[196:199]
v_add_u32 v13, 0x8000, v13
v_add_u32 v14, 0x8000, v14
v_mfma_f32_16x16x32_bf16 v[188:191], a[84:87], a[0:3], v[188:191]
v_add_u32 v15, 0x8000, v15
v_add_u32 v10, 0x8000, v10
v_mfma_f32_16x16x32_bf16 v[216:219], a[0:3], a[88:91], v[216:219]
v_add_u32 v20, s76, v16
v_mov_b32 v21, s77
v_mfma_f32_16x16x32_bf16 v[224:227], a[4:7], a[88:91], v[224:227]
global_load_dword v18, v[20:21], off sc1
v_mfma_f32_16x16x32_bf16 v[232:235], a[8:11], a[88:91], v[232:235]
v_add_u32 v11, 0x8000, v11
v_mfma_f32_16x16x32_bf16 v[240:243], a[12:15], a[88:91], v[240:243]
v_mfma_f32_16x16x32_bf16 v[252:255], a[16:19], a[88:91], v[252:255]
v_mfma_f32_16x16x32_bf16 v[244:247], a[12:15], a[92:95], v[244:247]
v_mfma_f32_16x16x32_bf16 v[236:239], a[8:11], a[92:95], v[236:239]
v_mfma_f32_16x16x32_bf16 v[228:231], a[4:7], a[92:95], v[228:231]
v_mfma_f32_16x16x32_bf16 v[220:223], a[0:3], a[92:95], v[220:223]
s_waitcnt vmcnt(17) lgkmcnt(0)
s_barrier
v_mfma_f32_16x16x32_bf16 v[24:27], a[40:43], a[20:23], v[24:27]
ds_read_b128 a[0:3], v8 offset:32768
s_add_u32 m0, s17, 0x0
v_mfma_f32_16x16x32_bf16 v[56:59], a[40:43], a[24:27], v[56:59]
buffer_load_dwordx4 v5, s[52:55], 0 offen lds
v_mfma_f32_16x16x32_bf16 v[88:91], a[40:43], a[28:31], v[88:91]
ds_read_b128 a[4:7], v8 offset:34816
v_add_u32 v22, 0x80, v22
v_mfma_f32_16x16x32_bf16 v[120:123], a[40:43], a[32:35], v[120:123]
ds_read_b128 a[8:11], v8 offset:36864
v_add_u32 v23, 0x80, v23
v_mfma_f32_16x16x32_bf16 v[124:127], a[44:47], a[32:35], v[124:127]
ds_read_b128 a[12:15], v8 offset:38912
v_mfma_f32_16x16x32_bf16 v[92:95], a[44:47], a[28:31], v[92:95]
ds_read_b128 a[16:19], v10
v_mfma_f32_16x16x32_bf16 v[60:63], a[44:47], a[24:27], v[60:63]
ds_read_b64_tr_b16 a[84:85], v15 offset:4096
s_add_u32 m0, s17, 0x400
v_mfma_f32_16x16x32_bf16 v[28:31], a[44:47], a[20:23], v[28:31]
buffer_load_dwordx4 v5, s[52:55], s13 offen lds
v_mfma_f32_16x16x32_bf16 v[32:35], a[48:51], a[20:23], v[32:35]
ds_read_b64_tr_b16 a[86:87], v15 offset:4352
v_mfma_f32_16x16x32_bf16 v[64:67], a[48:51], a[24:27], v[64:67]
ds_read_b64_tr_b16 a[88:89], v14 offset:8192
v_mfma_f32_16x16x32_bf16 v[96:99], a[48:51], a[28:31], v[96:99]
ds_read_b64_tr_b16 a[90:91], v14 offset:8448
v_mfma_f32_16x16x32_bf16 v[128:131], a[48:51], a[32:35], v[128:131]
ds_read_b64_tr_b16 a[92:93], v15 offset:8192
v_mfma_f32_16x16x32_bf16 v[132:135], a[52:55], a[32:35], v[132:135]
ds_read_b64_tr_b16 a[94:95], v15 offset:8448
v_mfma_f32_16x16x32_bf16 v[100:103], a[52:55], a[28:31], v[100:103]
ds_read_b64_tr_b16 a[40:41], v12 offset:0
s_add_u32 m0, s17, 0x800
v_mfma_f32_16x16x32_bf16 v[68:71], a[52:55], a[24:27], v[68:71]
buffer_load_dwordx4 v6, s[52:55], 0 offen lds
v_mfma_f32_16x16x32_bf16 v[36:39], a[52:55], a[20:23], v[36:39]
ds_read_b64_tr_b16 a[42:43], v12 offset:1024
v_mfma_f32_16x16x32_bf16 v[40:43], a[56:59], a[20:23], v[40:43]
ds_read_b64_tr_b16 a[44:45], v13 offset:0
v_mfma_f32_16x16x32_bf16 v[72:75], a[56:59], a[24:27], v[72:75]
ds_read_b64_tr_b16 a[46:47], v13 offset:1024
v_mfma_f32_16x16x32_bf16 v[104:107], a[56:59], a[28:31], v[104:107]
ds_read_b64_tr_b16 a[48:49], v12 offset:256
v_mfma_f32_16x16x32_bf16 v[136:139], a[56:59], a[32:35], v[136:139]
ds_read_b64_tr_b16 a[50:51], v12 offset:1280
v_mfma_f32_16x16x32_bf16 v[140:143], a[60:63], a[32:35], v[140:143]
ds_read_b64_tr_b16 a[52:53], v13 offset:256
s_add_u32 m0, s17, 0xc00
v_mfma_f32_16x16x32_bf16 v[108:111], a[60:63], a[28:31], v[108:111]
buffer_load_dwordx4 v6, s[52:55], s13 offen lds
v_mfma_f32_16x16x32_bf16 v[76:79], a[60:63], a[24:27], v[76:79]
ds_read_b64_tr_b16 a[54:55], v13 offset:1280
v_mfma_f32_16x16x32_bf16 v[44:47], a[60:63], a[20:23], v[44:47]
ds_read_b64_tr_b16 a[56:57], v12 offset:512
v_mfma_f32_16x16x32_bf16 v[48:51], a[64:67], a[20:23], v[48:51]
ds_read_b64_tr_b16 a[58:59], v12 offset:1536
v_mfma_f32_16x16x32_bf16 v[80:83], a[64:67], a[24:27], v[80:83]
ds_read_b64_tr_b16 a[60:61], v13 offset:512
v_mfma_f32_16x16x32_bf16 v[112:115], a[64:67], a[28:31], v[112:115]
ds_read_b64_tr_b16 a[62:63], v13 offset:1536
v_mfma_f32_16x16x32_bf16 v[144:147], a[64:67], a[32:35], v[144:147]
ds_read_b64_tr_b16 a[64:65], v12 offset:768
s_add_u32 m0, s18, 0x4000
v_mfma_f32_16x16x32_bf16 v[148:151], a[68:71], a[32:35], v[148:151]
buffer_load_dwordx4 v7, s[68:71], 0 offen lds
v_mfma_f32_16x16x32_bf16 v[116:119], a[68:71], a[28:31], v[116:119]
ds_read_b64_tr_b16 a[66:67], v12 offset:1792
v_mfma_f32_16x16x32_bf16 v[84:87], a[68:71], a[24:27], v[84:87]
v_mfma_f32_16x16x32_bf16 v[52:55], a[68:71], a[20:23], v[52:55]
ds_read_b64_tr_b16 a[68:69], v13 offset:768
v_mfma_f32_16x16x32_bf16 v[152:155], a[72:75], a[20:23], v[152:155]
ds_read_b64_tr_b16 a[70:71], v13 offset:1792
v_mfma_f32_16x16x32_bf16 v[160:163], a[72:75], a[24:27], v[160:163]
v_mfma_f32_16x16x32_bf16 v[168:171], a[72:75], a[28:31], v[168:171]
s_add_u32 m0, s18, 0x5000
v_mfma_f32_16x16x32_bf16 v[176:179], a[72:75], a[32:35], v[176:179]
buffer_load_dwordx4 v7, s[68:71], s25 offen lds
v_mfma_f32_16x16x32_bf16 v[180:183], a[76:79], a[32:35], v[180:183]
ds_read_b64_tr_b16 a[72:73], v14 offset:0
v_mfma_f32_16x16x32_bf16 v[172:175], a[76:79], a[28:31], v[172:175]
ds_read_b64_tr_b16 a[74:75], v14 offset:256
v_mfma_f32_16x16x32_bf16 v[164:167], a[76:79], a[24:27], v[164:167]
v_mfma_f32_16x16x32_bf16 v[156:159], a[76:79], a[20:23], v[156:159]
ds_read_b64_tr_b16 a[76:77], v15 offset:0
v_mfma_f32_16x16x32_bf16 v[184:187], a[80:83], a[20:23], v[184:187]
ds_read_b64_tr_b16 a[78:79], v15 offset:256
v_mfma_f32_16x16x32_bf16 v[192:195], a[80:83], a[24:27], v[192:195]
s_add_u32 m0, s18, 0x6000
v_mfma_f32_16x16x32_bf16 v[200:203], a[80:83], a[28:31], v[200:203]
buffer_load_dwordx4 v7, s[68:71], s26 offen lds
v_mfma_f32_16x16x32_bf16 v[208:211], a[80:83], a[32:35], v[208:211]
v_mfma_f32_16x16x32_bf16 v[248:251], a[80:83], a[36:39], v[248:251]
ds_read_b64_tr_b16 a[80:81], v14 offset:4096
v_mfma_f32_16x16x32_bf16 v[212:215], a[104:107], a[32:35], v[212:215]
ds_read_b64_tr_b16 a[82:83], v14 offset:4352
v_mfma_f32_16x16x32_bf16 v[204:207], a[104:107], a[28:31], v[204:207]
v_mfma_f32_16x16x32_bf16 v[196:199], a[104:107], a[24:27], v[196:199]
v_mfma_f32_16x16x32_bf16 v[188:191], a[104:107], a[20:23], v[188:191]
s_add_u32 m0, s18, 0x7000
v_mfma_f32_16x16x32_bf16 v[216:219], a[20:23], a[108:111], v[216:219]
buffer_load_dwordx4 v4, s[44:47], s24 offen lds
v_mfma_f32_16x16x32_bf16 v[224:227], a[24:27], a[108:111], v[224:227]
v_mfma_f32_16x16x32_bf16 v[232:235], a[28:31], a[108:111], v[232:235]
v_mfma_f32_16x16x32_bf16 v[240:243], a[32:35], a[108:111], v[240:243]
v_mfma_f32_16x16x32_bf16 v[252:255], a[36:39], a[108:111], v[252:255]
v_mfma_f32_16x16x32_bf16 v[244:247], a[32:35], a[112:115], v[244:247]
v_mfma_f32_16x16x32_bf16 v[236:239], a[28:31], a[112:115], v[236:239]
v_mfma_f32_16x16x32_bf16 v[228:231], a[24:27], a[112:115], v[228:231]
v_mfma_f32_16x16x32_bf16 v[220:223], a[20:23], a[112:115], v[220:223]
s_waitcnt lgkmcnt(0)
v_mfma_f32_16x16x32_bf16 v[24:27], a[40:43], a[0:3], v[24:27]
ds_read_b128 a[20:23], v9 offset:32768
v_add_u32 v5, 0x80000, v5
v_mfma_f32_16x16x32_bf16 v[56:59], a[40:43], a[4:7], v[56:59]
ds_read_b128 a[24:27], v9 offset:34816
v_add_u32 v6, 0x80000, v6
v_mfma_f32_16x16x32_bf16 v[88:91], a[40:43], a[8:11], v[88:91]
ds_read_b128 a[28:31], v9 offset:36864
v_add_u32 v7, 0x60000, v7
v_mfma_f32_16x16x32_bf16 v[120:123], a[40:43], a[12:15], v[120:123]
ds_read_b128 a[32:35], v9 offset:38912
v_add_u32 v4, 0x80, v4
v_mfma_f32_16x16x32_bf16 v[124:127], a[44:47], a[12:15], v[124:127]
ds_read_b128 a[36:39], v11
v_mfma_f32_16x16x32_bf16 v[92:95], a[44:47], a[8:11], v[92:95]
ds_read_b64_tr_b16 a[104:105], v15 offset:6144
v_mfma_f32_16x16x32_bf16 v[60:63], a[44:47], a[4:7], v[60:63]
ds_read_b64_tr_b16 a[106:107], v15 offset:6400
v_mfma_f32_16x16x32_bf16 v[28:31], a[44:47], a[0:3], v[28:31]
ds_read_b64_tr_b16 a[108:109], v14 offset:10240
v_mfma_f32_16x16x32_bf16 v[32:35], a[48:51], a[0:3], v[32:35]
ds_read_b64_tr_b16 a[110:111], v14 offset:10496
s_waitcnt lgkmcnt(5)
v_mfma_f32_16x16x32_bf16 v[64:67], a[48:51], a[4:7], v[64:67]
ds_read_b64_tr_b16 a[112:113], v15 offset:10240
s_add_u32 m0, s16, 0x8000
v_mfma_f32_16x16x32_bf16 v[96:99], a[48:51], a[8:11], v[96:99]
buffer_load_dwordx4 v22, s[44:47], s20 offen lds
v_mfma_f32_16x16x32_bf16 v[128:131], a[48:51], a[12:15], v[128:131]
ds_read_b64_tr_b16 a[114:115], v15 offset:10496
v_mfma_f32_16x16x32_bf16 v[132:135], a[52:55], a[12:15], v[132:135]
ds_read_b64_tr_b16 a[40:41], v12 offset:8192
v_mfma_f32_16x16x32_bf16 v[100:103], a[52:55], a[8:11], v[100:103]
ds_read_b64_tr_b16 a[42:43], v12 offset:9216
v_mfma_f32_16x16x32_bf16 v[68:71], a[52:55], a[4:7], v[68:71]
ds_read_b64_tr_b16 a[44:45], v13 offset:8192
s_add_u32 m0, s16, 0x8400
v_mfma_f32_16x16x32_bf16 v[36:39], a[52:55], a[0:3], v[36:39]
buffer_load_dwordx4 v23, s[44:47], s20 offen lds
v_mfma_f32_16x16x32_bf16 v[40:43], a[56:59], a[0:3], v[40:43]
ds_read_b64_tr_b16 a[46:47], v13 offset:9216
v_mfma_f32_16x16x32_bf16 v[72:75], a[56:59], a[4:7], v[72:75]
ds_read_b64_tr_b16 a[48:49], v12 offset:8448
v_mfma_f32_16x16x32_bf16 v[104:107], a[56:59], a[8:11], v[104:107]
ds_read_b64_tr_b16 a[50:51], v12 offset:9472
v_mfma_f32_16x16x32_bf16 v[136:139], a[56:59], a[12:15], v[136:139]
ds_read_b64_tr_b16 a[52:53], v13 offset:8448
v_mfma_f32_16x16x32_bf16 v[140:143], a[60:63], a[12:15], v[140:143]
ds_read_b64_tr_b16 a[54:55], v13 offset:9472
s_add_u32 m0, s16, 0x8800
v_mfma_f32_16x16x32_bf16 v[108:111], a[60:63], a[8:11], v[108:111]
buffer_load_dwordx4 v22, s[44:47], s21 offen lds
v_mfma_f32_16x16x32_bf16 v[76:79], a[60:63], a[4:7], v[76:79]
ds_read_b64_tr_b16 a[56:57], v12 offset:8704
v_mfma_f32_16x16x32_bf16 v[44:47], a[60:63], a[0:3], v[44:47]
ds_read_b64_tr_b16 a[58:59], v12 offset:9728
v_mfma_f32_16x16x32_bf16 v[48:51], a[64:67], a[0:3], v[48:51]
ds_read_b64_tr_b16 a[60:61], v13 offset:8704
v_mfma_f32_16x16x32_bf16 v[80:83], a[64:67], a[4:7], v[80:83]
ds_read_b64_tr_b16 a[62:63], v13 offset:9728
v_mfma_f32_16x16x32_bf16 v[112:115], a[64:67], a[8:11], v[112:115]
s_add_u32 m0, s16, 0x8c00
v_mfma_f32_16x16x32_bf16 v[144:147], a[64:67], a[12:15], v[144:147]
buffer_load_dwordx4 v23, s[44:47], s21 offen lds
v_mfma_f32_16x16x32_bf16 v[148:151], a[68:71], a[12:15], v[148:151]
ds_read_b64_tr_b16 a[64:65], v12 offset:8960
v_mfma_f32_16x16x32_bf16 v[116:119], a[68:71], a[8:11], v[116:119]
ds_read_b64_tr_b16 a[66:67], v12 offset:9984
v_mfma_f32_16x16x32_bf16 v[84:87], a[68:71], a[4:7], v[84:87]
v_mfma_f32_16x16x32_bf16 v[52:55], a[68:71], a[0:3], v[52:55]
ds_read_b64_tr_b16 a[68:69], v13 offset:8960
v_mfma_f32_16x16x32_bf16 v[152:155], a[72:75], a[0:3], v[152:155]
ds_read_b64_tr_b16 a[70:71], v13 offset:9984
s_add_u32 m0, s16, 0x9000
v_mfma_f32_16x16x32_bf16 v[160:163], a[72:75], a[4:7], v[160:163]
buffer_load_dwordx4 v22, s[44:47], s22 offen lds
v_mfma_f32_16x16x32_bf16 v[168:171], a[72:75], a[8:11], v[168:171]
v_mfma_f32_16x16x32_bf16 v[176:179], a[72:75], a[12:15], v[176:179]
ds_read_b64_tr_b16 a[72:73], v14 offset:2048
v_mfma_f32_16x16x32_bf16 v[180:183], a[76:79], a[12:15], v[180:183]
ds_read_b64_tr_b16 a[74:75], v14 offset:2304
v_mfma_f32_16x16x32_bf16 v[172:175], a[76:79], a[8:11], v[172:175]
s_add_u32 m0, s16, 0x9400
v_mfma_f32_16x16x32_bf16 v[164:167], a[76:79], a[4:7], v[164:167]
buffer_load_dwordx4 v23, s[44:47], s22 offen lds
v_mfma_f32_16x16x32_bf16 v[156:159], a[76:79], a[0:3], v[156:159]
ds_read_b64_tr_b16 a[76:77], v15 offset:2048
v_mfma_f32_16x16x32_bf16 v[184:187], a[80:83], a[0:3], v[184:187]
ds_read_b64_tr_b16 a[78:79], v15 offset:2304
v_mfma_f32_16x16x32_bf16 v[192:195], a[80:83], a[4:7], v[192:195]
v_mfma_f32_16x16x32_bf16 v[200:203], a[80:83], a[8:11], v[200:203]
v_mfma_f32_16x16x32_bf16 v[208:211], a[80:83], a[12:15], v[208:211]
s_add_u32 m0, s16, 0x9800
v_mfma_f32_16x16x32_bf16 v[248:251], a[80:83], a[16:19], v[248:251]
buffer_load_dwordx4 v22, s[44:47], s23 offen lds
v_mfma_f32_16x16x32_bf16 v[212:215], a[84:87], a[12:15], v[212:215]
ds_read_b64_tr_b16 a[80:81], v14 offset:6144
v_mfma_f32_16x16x32_bf16 v[204:207], a[84:87], a[8:11], v[204:207]
ds_read_b64_tr_b16 a[82:83], v14 offset:6400
v_add_u32 v12, 0x8000, v12
v_mfma_f32_16x16x32_bf16 v[196:199], a[84:87], a[4:7], v[196:199]
v_add_u32 v13, 0x8000, v13
v_add_u32 v14, 0x8000, v14
v_mfma_f32_16x16x32_bf16 v[188:191], a[84:87], a[0:3], v[188:191]
v_add_u32 v15, 0x8000, v15
v_add_u32 v10, 0x8000, v10
v_mfma_f32_16x16x32_bf16 v[216:219], a[0:3], a[88:91], v[216:219]
s_add_u32 m0, s16, 0x9c00
v_add_u32 v11, 0x8000, v11
v_mfma_f32_16x16x32_bf16 v[224:227], a[4:7], a[88:91], v[224:227]
buffer_load_dwordx4 v23, s[44:47], s23 offen lds
v_mfma_f32_16x16x32_bf16 v[232:235], a[8:11], a[88:91], v[232:235]
v_mfma_f32_16x16x32_bf16 v[240:243], a[12:15], a[88:91], v[240:243]
v_mfma_f32_16x16x32_bf16 v[252:255], a[16:19], a[88:91], v[252:255]
v_mfma_f32_16x16x32_bf16 v[244:247], a[12:15], a[92:95], v[244:247]
v_mfma_f32_16x16x32_bf16 v[236:239], a[8:11], a[92:95], v[236:239]
v_mfma_f32_16x16x32_bf16 v[228:231], a[4:7], a[92:95], v[228:231]
v_mfma_f32_16x16x32_bf16 v[220:223], a[0:3], a[92:95], v[220:223]
s_waitcnt vmcnt(17) lgkmcnt(0)
s_barrier
v_mfma_f32_16x16x32_bf16 v[24:27], a[40:43], a[20:23], v[24:27]
ds_read_b128 a[0:3], v8 offset:0
s_add_u32 m0, s17, 0x8000
v_mfma_f32_16x16x32_bf16 v[56:59], a[40:43], a[24:27], v[56:59]
buffer_load_dwordx4 v5, s[52:55], 0 offen lds
v_mfma_f32_16x16x32_bf16 v[88:91], a[40:43], a[28:31], v[88:91]
ds_read_b128 a[4:7], v8 offset:2048
v_add_u32 v22, 0x80, v22
v_mfma_f32_16x16x32_bf16 v[120:123], a[40:43], a[32:35], v[120:123]
ds_read_b128 a[8:11], v8 offset:4096
v_add_u32 v23, 0x80, v23
v_mfma_f32_16x16x32_bf16 v[124:127], a[44:47], a[32:35], v[124:127]
ds_read_b128 a[12:15], v8 offset:6144
v_mfma_f32_16x16x32_bf16 v[92:95], a[44:47], a[28:31], v[92:95]
ds_read_b128 a[16:19], v10
v_mfma_f32_16x16x32_bf16 v[60:63], a[44:47], a[24:27], v[60:63]
ds_read_b64_tr_b16 a[84:85], v15 offset:4096
s_add_u32 m0, s17, 0x8400
v_mfma_f32_16x16x32_bf16 v[28:31], a[44:47], a[20:23], v[28:31]
buffer_load_dwordx4 v5, s[52:55], s13 offen lds
v_mfma_f32_16x16x32_bf16 v[32:35], a[48:51], a[20:23], v[32:35]
ds_read_b64_tr_b16 a[86:87], v15 offset:4352
v_mfma_f32_16x16x32_bf16 v[64:67], a[48:51], a[24:27], v[64:67]
ds_read_b64_tr_b16 a[88:89], v14 offset:8192
v_mfma_f32_16x16x32_bf16 v[96:99], a[48:51], a[28:31], v[96:99]
ds_read_b64_tr_b16 a[90:91], v14 offset:8448
v_mfma_f32_16x16x32_bf16 v[128:131], a[48:51], a[32:35], v[128:131]
ds_read_b64_tr_b16 a[92:93], v15 offset:8192
v_mfma_f32_16x16x32_bf16 v[132:135], a[52:55], a[32:35], v[132:135]
ds_read_b64_tr_b16 a[94:95], v15 offset:8448
v_mfma_f32_16x16x32_bf16 v[100:103], a[52:55], a[28:31], v[100:103]
ds_read_b64_tr_b16 a[40:41], v12 offset:0
s_add_u32 m0, s17, 0x8800
v_mfma_f32_16x16x32_bf16 v[68:71], a[52:55], a[24:27], v[68:71]
buffer_load_dwordx4 v6, s[52:55], 0 offen lds
v_mfma_f32_16x16x32_bf16 v[36:39], a[52:55], a[20:23], v[36:39]
ds_read_b64_tr_b16 a[42:43], v12 offset:1024
v_mfma_f32_16x16x32_bf16 v[40:43], a[56:59], a[20:23], v[40:43]
ds_read_b64_tr_b16 a[44:45], v13 offset:0
v_mfma_f32_16x16x32_bf16 v[72:75], a[56:59], a[24:27], v[72:75]
ds_read_b64_tr_b16 a[46:47], v13 offset:1024
v_mfma_f32_16x16x32_bf16 v[104:107], a[56:59], a[28:31], v[104:107]
ds_read_b64_tr_b16 a[48:49], v12 offset:256
v_mfma_f32_16x16x32_bf16 v[136:139], a[56:59], a[32:35], v[136:139]
ds_read_b64_tr_b16 a[50:51], v12 offset:1280
v_mfma_f32_16x16x32_bf16 v[140:143], a[60:63], a[32:35], v[140:143]
ds_read_b64_tr_b16 a[52:53], v13 offset:256
s_add_u32 m0, s17, 0x8c00
v_mfma_f32_16x16x32_bf16 v[108:111], a[60:63], a[28:31], v[108:111]
buffer_load_dwordx4 v6, s[52:55], s13 offen lds
v_mfma_f32_16x16x32_bf16 v[76:79], a[60:63], a[24:27], v[76:79]
ds_read_b64_tr_b16 a[54:55], v13 offset:1280
v_mfma_f32_16x16x32_bf16 v[44:47], a[60:63], a[20:23], v[44:47]
ds_read_b64_tr_b16 a[56:57], v12 offset:512
v_mfma_f32_16x16x32_bf16 v[48:51], a[64:67], a[20:23], v[48:51]
ds_read_b64_tr_b16 a[58:59], v12 offset:1536
v_mfma_f32_16x16x32_bf16 v[80:83], a[64:67], a[24:27], v[80:83]
ds_read_b64_tr_b16 a[60:61], v13 offset:512
v_mfma_f32_16x16x32_bf16 v[112:115], a[64:67], a[28:31], v[112:115]
ds_read_b64_tr_b16 a[62:63], v13 offset:1536
v_mfma_f32_16x16x32_bf16 v[144:147], a[64:67], a[32:35], v[144:147]
ds_read_b64_tr_b16 a[64:65], v12 offset:768
s_add_u32 m0, s18, 0xc000
v_mfma_f32_16x16x32_bf16 v[148:151], a[68:71], a[32:35], v[148:151]
buffer_load_dwordx4 v7, s[68:71], 0 offen lds
v_mfma_f32_16x16x32_bf16 v[116:119], a[68:71], a[28:31], v[116:119]
ds_read_b64_tr_b16 a[66:67], v12 offset:1792
v_mfma_f32_16x16x32_bf16 v[84:87], a[68:71], a[24:27], v[84:87]
v_mfma_f32_16x16x32_bf16 v[52:55], a[68:71], a[20:23], v[52:55]
ds_read_b64_tr_b16 a[68:69], v13 offset:768
v_mfma_f32_16x16x32_bf16 v[152:155], a[72:75], a[20:23], v[152:155]
ds_read_b64_tr_b16 a[70:71], v13 offset:1792
v_mfma_f32_16x16x32_bf16 v[160:163], a[72:75], a[24:27], v[160:163]
v_mfma_f32_16x16x32_bf16 v[168:171], a[72:75], a[28:31], v[168:171]
s_add_u32 m0, s18, 0xd000
v_mfma_f32_16x16x32_bf16 v[176:179], a[72:75], a[32:35], v[176:179]
buffer_load_dwordx4 v7, s[68:71], s25 offen lds
v_mfma_f32_16x16x32_bf16 v[180:183], a[76:79], a[32:35], v[180:183]
ds_read_b64_tr_b16 a[72:73], v14 offset:0
v_mfma_f32_16x16x32_bf16 v[172:175], a[76:79], a[28:31], v[172:175]
ds_read_b64_tr_b16 a[74:75], v14 offset:256
v_mfma_f32_16x16x32_bf16 v[164:167], a[76:79], a[24:27], v[164:167]
v_mfma_f32_16x16x32_bf16 v[156:159], a[76:79], a[20:23], v[156:159]
ds_read_b64_tr_b16 a[76:77], v15 offset:0
v_mfma_f32_16x16x32_bf16 v[184:187], a[80:83], a[20:23], v[184:187]
ds_read_b64_tr_b16 a[78:79], v15 offset:256
v_mfma_f32_16x16x32_bf16 v[192:195], a[80:83], a[24:27], v[192:195]
s_add_u32 m0, s18, 0xe000
v_mfma_f32_16x16x32_bf16 v[200:203], a[80:83], a[28:31], v[200:203]
buffer_load_dwordx4 v7, s[68:71], s26 offen lds
v_mfma_f32_16x16x32_bf16 v[208:211], a[80:83], a[32:35], v[208:211]
v_mfma_f32_16x16x32_bf16 v[248:251], a[80:83], a[36:39], v[248:251]
ds_read_b64_tr_b16 a[80:81], v14 offset:4096
v_mfma_f32_16x16x32_bf16 v[212:215], a[104:107], a[32:35], v[212:215]
ds_read_b64_tr_b16 a[82:83], v14 offset:4352
v_mfma_f32_16x16x32_bf16 v[204:207], a[104:107], a[28:31], v[204:207]
v_mfma_f32_16x16x32_bf16 v[196:199], a[104:107], a[24:27], v[196:199]
v_mfma_f32_16x16x32_bf16 v[188:191], a[104:107], a[20:23], v[188:191]
s_add_u32 m0, s18, 0xf000
v_mfma_f32_16x16x32_bf16 v[216:219], a[20:23], a[108:111], v[216:219]
buffer_load_dwordx4 v4, s[44:47], s24 offen lds
v_mfma_f32_16x16x32_bf16 v[224:227], a[24:27], a[108:111], v[224:227]
v_mfma_f32_16x16x32_bf16 v[232:235], a[28:31], a[108:111], v[232:235]
v_mfma_f32_16x16x32_bf16 v[240:243], a[32:35], a[108:111], v[240:243]
v_mfma_f32_16x16x32_bf16 v[252:255], a[36:39], a[108:111], v[252:255]
v_mfma_f32_16x16x32_bf16 v[244:247], a[32:35], a[112:115], v[244:247]
v_mfma_f32_16x16x32_bf16 v[236:239], a[28:31], a[112:115], v[236:239]
v_mfma_f32_16x16x32_bf16 v[228:231], a[24:27], a[112:115], v[228:231]
v_mfma_f32_16x16x32_bf16 v[220:223], a[20:23], a[112:115], v[220:223]
s_waitcnt lgkmcnt(0)
v_mfma_f32_16x16x32_bf16 v[24:27], a[40:43], a[0:3], v[24:27]
ds_read_b128 a[20:23], v9 offset:0
v_add_u32 v5, 0x80000, v5
v_mfma_f32_16x16x32_bf16 v[56:59], a[40:43], a[4:7], v[56:59]
ds_read_b128 a[24:27], v9 offset:2048
v_add_u32 v6, 0x80000, v6
v_mfma_f32_16x16x32_bf16 v[88:91], a[40:43], a[8:11], v[88:91]
ds_read_b128 a[28:31], v9 offset:4096
v_add_u32 v7, 0x60000, v7
v_mfma_f32_16x16x32_bf16 v[120:123], a[40:43], a[12:15], v[120:123]
ds_read_b128 a[32:35], v9 offset:6144
v_add_u32 v4, 0x80, v4
v_mfma_f32_16x16x32_bf16 v[124:127], a[44:47], a[12:15], v[124:127]
ds_read_b128 a[36:39], v11
v_mfma_f32_16x16x32_bf16 v[92:95], a[44:47], a[8:11], v[92:95]
ds_read_b64_tr_b16 a[104:105], v15 offset:6144
v_mfma_f32_16x16x32_bf16 v[60:63], a[44:47], a[4:7], v[60:63]
ds_read_b64_tr_b16 a[106:107], v15 offset:6400
v_mfma_f32_16x16x32_bf16 v[28:31], a[44:47], a[0:3], v[28:31]
ds_read_b64_tr_b16 a[108:109], v14 offset:10240
v_mfma_f32_16x16x32_bf16 v[32:35], a[48:51], a[0:3], v[32:35]
ds_read_b64_tr_b16 a[110:111], v14 offset:10496
s_waitcnt lgkmcnt(5)
v_mfma_f32_16x16x32_bf16 v[64:67], a[48:51], a[4:7], v[64:67]
ds_read_b64_tr_b16 a[112:113], v15 offset:10240
s_add_u32 m0, s16, 0x0
v_mfma_f32_16x16x32_bf16 v[96:99], a[48:51], a[8:11], v[96:99]
buffer_load_dwordx4 v22, s[44:47], s20 offen lds
v_mfma_f32_16x16x32_bf16 v[128:131], a[48:51], a[12:15], v[128:131]
ds_read_b64_tr_b16 a[114:115], v15 offset:10496
v_mfma_f32_16x16x32_bf16 v[132:135], a[52:55], a[12:15], v[132:135]
ds_read_b64_tr_b16 a[40:41], v12 offset:8192
v_mfma_f32_16x16x32_bf16 v[100:103], a[52:55], a[8:11], v[100:103]
ds_read_b64_tr_b16 a[42:43], v12 offset:9216
v_mfma_f32_16x16x32_bf16 v[68:71], a[52:55], a[4:7], v[68:71]
ds_read_b64_tr_b16 a[44:45], v13 offset:8192
s_add_u32 m0, s16, 0x400
v_mfma_f32_16x16x32_bf16 v[36:39], a[52:55], a[0:3], v[36:39]
buffer_load_dwordx4 v23, s[44:47], s20 offen lds
v_mfma_f32_16x16x32_bf16 v[40:43], a[56:59], a[0:3], v[40:43]
ds_read_b64_tr_b16 a[46:47], v13 offset:9216
v_mfma_f32_16x16x32_bf16 v[72:75], a[56:59], a[4:7], v[72:75]
ds_read_b64_tr_b16 a[48:49], v12 offset:8448
v_mfma_f32_16x16x32_bf16 v[104:107], a[56:59], a[8:11], v[104:107]
ds_read_b64_tr_b16 a[50:51], v12 offset:9472
v_mfma_f32_16x16x32_bf16 v[136:139], a[56:59], a[12:15], v[136:139]
ds_read_b64_tr_b16 a[52:53], v13 offset:8448
s_add_u32 m0, s16, 0x800
v_mfma_f32_16x16x32_bf16 v[140:143], a[60:63], a[12:15], v[140:143]
buffer_load_dwordx4 v22, s[44:47], s21 offen lds
v_mfma_f32_16x16x32_bf16 v[108:111], a[60:63], a[8:11], v[108:111]
ds_read_b64_tr_b16 a[54:55], v13 offset:9472
v_mfma_f32_16x16x32_bf16 v[76:79], a[60:63], a[4:7], v[76:79]
ds_read_b64_tr_b16 a[56:57], v12 offset:8704
v_mfma_f32_16x16x32_bf16 v[44:47], a[60:63], a[0:3], v[44:47]
ds_read_b64_tr_b16 a[58:59], v12 offset:9728
v_mfma_f32_16x16x32_bf16 v[48:51], a[64:67], a[0:3], v[48:51]
ds_read_b64_tr_b16 a[60:61], v13 offset:8704
s_add_u32 m0, s16, 0xc00
v_mfma_f32_16x16x32_bf16 v[80:83], a[64:67], a[4:7], v[80:83]
buffer_load_dwordx4 v23, s[44:47], s21 offen lds
v_mfma_f32_16x16x32_bf16 v[112:115], a[64:67], a[8:11], v[112:115]
ds_read_b64_tr_b16 a[62:63], v13 offset:9728
v_mfma_f32_16x16x32_bf16 v[144:147], a[64:67], a[12:15], v[144:147]
ds_read_b64_tr_b16 a[64:65], v12 offset:8960
v_mfma_f32_16x16x32_bf16 v[148:151], a[68:71], a[12:15], v[148:151]
ds_read_b64_tr_b16 a[66:67], v12 offset:9984
v_mfma_f32_16x16x32_bf16 v[116:119], a[68:71], a[8:11], v[116:119]
s_add_u32 m0, s16, 0x1000
v_mfma_f32_16x16x32_bf16 v[84:87], a[68:71], a[4:7], v[84:87]
buffer_load_dwordx4 v22, s[44:47], s22 offen lds
v_mfma_f32_16x16x32_bf16 v[52:55], a[68:71], a[0:3], v[52:55]
ds_read_b64_tr_b16 a[68:69], v13 offset:8960
v_mfma_f32_16x16x32_bf16 v[152:155], a[72:75], a[0:3], v[152:155]
ds_read_b64_tr_b16 a[70:71], v13 offset:9984
v_mfma_f32_16x16x32_bf16 v[160:163], a[72:75], a[4:7], v[160:163]
v_mfma_f32_16x16x32_bf16 v[168:171], a[72:75], a[8:11], v[168:171]
s_add_u32 m0, s16, 0x1400
v_mfma_f32_16x16x32_bf16 v[176:179], a[72:75], a[12:15], v[176:179]
buffer_load_dwordx4 v23, s[44:47], s22 offen lds
v_mfma_f32_16x16x32_bf16 v[180:183], a[76:79], a[12:15], v[180:183]
ds_read_b64_tr_b16 a[72:73], v14 offset:2048
v_mfma_f32_16x16x32_bf16 v[172:175], a[76:79], a[8:11], v[172:175]
ds_read_b64_tr_b16 a[74:75], v14 offset:2304
v_mfma_f32_16x16x32_bf16 v[164:167], a[76:79], a[4:7], v[164:167]
v_mfma_f32_16x16x32_bf16 v[156:159], a[76:79], a[0:3], v[156:159]
ds_read_b64_tr_b16 a[76:77], v15 offset:2048
s_add_u32 m0, s16, 0x1800
v_mfma_f32_16x16x32_bf16 v[184:187], a[80:83], a[0:3], v[184:187]
buffer_load_dwordx4 v22, s[44:47], s23 offen lds
v_mfma_f32_16x16x32_bf16 v[192:195], a[80:83], a[4:7], v[192:195]
ds_read_b64_tr_b16 a[78:79], v15 offset:2304
v_mfma_f32_16x16x32_bf16 v[200:203], a[80:83], a[8:11], v[200:203]
v_mfma_f32_16x16x32_bf16 v[208:211], a[80:83], a[12:15], v[208:211]
v_mfma_f32_16x16x32_bf16 v[248:251], a[80:83], a[16:19], v[248:251]
ds_read_b64_tr_b16 a[80:81], v14 offset:6144
s_add_u32 m0, s16, 0x1c00
v_mfma_f32_16x16x32_bf16 v[212:215], a[84:87], a[12:15], v[212:215]
buffer_load_dwordx4 v23, s[44:47], s23 offen lds
v_mfma_f32_16x16x32_bf16 v[204:207], a[84:87], a[8:11], v[204:207]
ds_read_b64_tr_b16 a[82:83], v14 offset:6400
v_add_u32 v12, 0xffff0000, v12
v_mfma_f32_16x16x32_bf16 v[196:199], a[84:87], a[4:7], v[196:199]
v_add_u32 v13, 0xffff0000, v13
v_add_u32 v14, 0xffff0000, v14
v_mfma_f32_16x16x32_bf16 v[188:191], a[84:87], a[0:3], v[188:191]
v_add_u32 v15, 0xffff0000, v15
v_add_u32 v10, 0xffff0000, v10
v_mfma_f32_16x16x32_bf16 v[216:219], a[0:3], a[88:91], v[216:219]
v_add_u32 v11, 0xffff0000, v11
v_mfma_f32_16x16x32_bf16 v[224:227], a[4:7], a[88:91], v[224:227]
buffer_load_dword v1, off, s[84:87], s10 sc1
v_mfma_f32_16x16x32_bf16 v[232:235], a[8:11], a[88:91], v[232:235]
v_mfma_f32_16x16x32_bf16 v[240:243], a[12:15], a[88:91], v[240:243]
v_mfma_f32_16x16x32_bf16 v[252:255], a[16:19], a[88:91], v[252:255]
v_mfma_f32_16x16x32_bf16 v[244:247], a[12:15], a[92:95], v[244:247]
v_mfma_f32_16x16x32_bf16 v[236:239], a[8:11], a[92:95], v[236:239]
v_mfma_f32_16x16x32_bf16 v[228:231], a[4:7], a[92:95], v[228:231]
v_mfma_f32_16x16x32_bf16 v[220:223], a[0:3], a[92:95], v[220:223]
s_waitcnt vmcnt(17) lgkmcnt(0)
s_barrier
v_mfma_f32_16x16x32_bf16 v[24:27], a[40:43], a[20:23], v[24:27]
ds_read_b128 a[0:3], v8 offset:32768
s_add_u32 m0, s17, 0x10000
v_mfma_f32_16x16x32_bf16 v[56:59], a[40:43], a[24:27], v[56:59]
buffer_load_dwordx4 v5, s[52:55], 0 offen lds
v_mfma_f32_16x16x32_bf16 v[88:91], a[40:43], a[28:31], v[88:91]
ds_read_b128 a[4:7], v8 offset:34816
v_add_u32 v22, 0x80, v22
v_mfma_f32_16x16x32_bf16 v[120:123], a[40:43], a[32:35], v[120:123]
ds_read_b128 a[8:11], v8 offset:36864
v_add_u32 v23, 0x80, v23
v_mfma_f32_16x16x32_bf16 v[124:127], a[44:47], a[32:35], v[124:127]
ds_read_b128 a[12:15], v8 offset:38912
v_mfma_f32_16x16x32_bf16 v[92:95], a[44:47], a[28:31], v[92:95]
ds_read_b128 a[16:19], v10
v_mfma_f32_16x16x32_bf16 v[60:63], a[44:47], a[24:27], v[60:63]
ds_read_b64_tr_b16 a[84:85], v15 offset:4096
s_add_u32 m0, s17, 0x10400
v_mfma_f32_16x16x32_bf16 v[28:31], a[44:47], a[20:23], v[28:31]
buffer_load_dwordx4 v5, s[52:55], s13 offen lds
v_mfma_f32_16x16x32_bf16 v[32:35], a[48:51], a[20:23], v[32:35]
ds_read_b64_tr_b16 a[86:87], v15 offset:4352
v_mfma_f32_16x16x32_bf16 v[64:67], a[48:51], a[24:27], v[64:67]
ds_read_b64_tr_b16 a[88:89], v14 offset:8192
v_mfma_f32_16x16x32_bf16 v[96:99], a[48:51], a[28:31], v[96:99]
ds_read_b64_tr_b16 a[90:91], v14 offset:8448
v_mfma_f32_16x16x32_bf16 v[128:131], a[48:51], a[32:35], v[128:131]
ds_read_b64_tr_b16 a[92:93], v15 offset:8192
v_mfma_f32_16x16x32_bf16 v[132:135], a[52:55], a[32:35], v[132:135]
ds_read_b64_tr_b16 a[94:95], v15 offset:8448
v_mfma_f32_16x16x32_bf16 v[100:103], a[52:55], a[28:31], v[100:103]
ds_read_b64_tr_b16 a[40:41], v12 offset:0
s_add_u32 m0, s17, 0x10800
v_mfma_f32_16x16x32_bf16 v[68:71], a[52:55], a[24:27], v[68:71]
buffer_load_dwordx4 v6, s[52:55], 0 offen lds
v_mfma_f32_16x16x32_bf16 v[36:39], a[52:55], a[20:23], v[36:39]
ds_read_b64_tr_b16 a[42:43], v12 offset:1024
v_mfma_f32_16x16x32_bf16 v[40:43], a[56:59], a[20:23], v[40:43]
ds_read_b64_tr_b16 a[44:45], v13 offset:0
v_mfma_f32_16x16x32_bf16 v[72:75], a[56:59], a[24:27], v[72:75]
ds_read_b64_tr_b16 a[46:47], v13 offset:1024
v_mfma_f32_16x16x32_bf16 v[104:107], a[56:59], a[28:31], v[104:107]
ds_read_b64_tr_b16 a[48:49], v12 offset:256
v_mfma_f32_16x16x32_bf16 v[136:139], a[56:59], a[32:35], v[136:139]
ds_read_b64_tr_b16 a[50:51], v12 offset:1280
v_mfma_f32_16x16x32_bf16 v[140:143], a[60:63], a[32:35], v[140:143]
ds_read_b64_tr_b16 a[52:53], v13 offset:256
s_add_u32 m0, s17, 0x10c00
v_mfma_f32_16x16x32_bf16 v[108:111], a[60:63], a[28:31], v[108:111]
buffer_load_dwordx4 v6, s[52:55], s13 offen lds
v_mfma_f32_16x16x32_bf16 v[76:79], a[60:63], a[24:27], v[76:79]
ds_read_b64_tr_b16 a[54:55], v13 offset:1280
v_mfma_f32_16x16x32_bf16 v[44:47], a[60:63], a[20:23], v[44:47]
ds_read_b64_tr_b16 a[56:57], v12 offset:512
v_mfma_f32_16x16x32_bf16 v[48:51], a[64:67], a[20:23], v[48:51]
ds_read_b64_tr_b16 a[58:59], v12 offset:1536
v_mfma_f32_16x16x32_bf16 v[80:83], a[64:67], a[24:27], v[80:83]
ds_read_b64_tr_b16 a[60:61], v13 offset:512
v_mfma_f32_16x16x32_bf16 v[112:115], a[64:67], a[28:31], v[112:115]
ds_read_b64_tr_b16 a[62:63], v13 offset:1536
v_mfma_f32_16x16x32_bf16 v[144:147], a[64:67], a[32:35], v[144:147]
ds_read_b64_tr_b16 a[64:65], v12 offset:768
s_add_u32 m0, s18, 0x14000
v_mfma_f32_16x16x32_bf16 v[148:151], a[68:71], a[32:35], v[148:151]
buffer_load_dwordx4 v7, s[68:71], 0 offen lds
v_mfma_f32_16x16x32_bf16 v[116:119], a[68:71], a[28:31], v[116:119]
ds_read_b64_tr_b16 a[66:67], v12 offset:1792
v_mfma_f32_16x16x32_bf16 v[84:87], a[68:71], a[24:27], v[84:87]
v_mfma_f32_16x16x32_bf16 v[52:55], a[68:71], a[20:23], v[52:55]
ds_read_b64_tr_b16 a[68:69], v13 offset:768
v_mfma_f32_16x16x32_bf16 v[152:155], a[72:75], a[20:23], v[152:155]
ds_read_b64_tr_b16 a[70:71], v13 offset:1792
v_mfma_f32_16x16x32_bf16 v[160:163], a[72:75], a[24:27], v[160:163]
v_mfma_f32_16x16x32_bf16 v[168:171], a[72:75], a[28:31], v[168:171]
s_add_u32 m0, s18, 0x15000
v_mfma_f32_16x16x32_bf16 v[176:179], a[72:75], a[32:35], v[176:179]
buffer_load_dwordx4 v7, s[68:71], s25 offen lds
v_mfma_f32_16x16x32_bf16 v[180:183], a[76:79], a[32:35], v[180:183]
ds_read_b64_tr_b16 a[72:73], v14 offset:0
v_mfma_f32_16x16x32_bf16 v[172:175], a[76:79], a[28:31], v[172:175]
ds_read_b64_tr_b16 a[74:75], v14 offset:256
v_mfma_f32_16x16x32_bf16 v[164:167], a[76:79], a[24:27], v[164:167]
v_mfma_f32_16x16x32_bf16 v[156:159], a[76:79], a[20:23], v[156:159]
ds_read_b64_tr_b16 a[76:77], v15 offset:0
v_mfma_f32_16x16x32_bf16 v[184:187], a[80:83], a[20:23], v[184:187]
ds_read_b64_tr_b16 a[78:79], v15 offset:256
v_mfma_f32_16x16x32_bf16 v[192:195], a[80:83], a[24:27], v[192:195]
s_add_u32 m0, s18, 0x16000
v_mfma_f32_16x16x32_bf16 v[200:203], a[80:83], a[28:31], v[200:203]
buffer_load_dwordx4 v7, s[68:71], s26 offen lds
v_mfma_f32_16x16x32_bf16 v[208:211], a[80:83], a[32:35], v[208:211]
v_mfma_f32_16x16x32_bf16 v[248:251], a[80:83], a[36:39], v[248:251]
ds_read_b64_tr_b16 a[80:81], v14 offset:4096
v_mfma_f32_16x16x32_bf16 v[212:215], a[104:107], a[32:35], v[212:215]
ds_read_b64_tr_b16 a[82:83], v14 offset:4352
v_mfma_f32_16x16x32_bf16 v[204:207], a[104:107], a[28:31], v[204:207]
v_mfma_f32_16x16x32_bf16 v[196:199], a[104:107], a[24:27], v[196:199]
v_mfma_f32_16x16x32_bf16 v[188:191], a[104:107], a[20:23], v[188:191]
s_add_u32 m0, s18, 0x17000
v_mfma_f32_16x16x32_bf16 v[216:219], a[20:23], a[108:111], v[216:219]
buffer_load_dwordx4 v4, s[44:47], s24 offen lds
v_mfma_f32_16x16x32_bf16 v[224:227], a[24:27], a[108:111], v[224:227]
v_mfma_f32_16x16x32_bf16 v[232:235], a[28:31], a[108:111], v[232:235]
v_mfma_f32_16x16x32_bf16 v[240:243], a[32:35], a[108:111], v[240:243]
v_mfma_f32_16x16x32_bf16 v[252:255], a[36:39], a[108:111], v[252:255]
v_mfma_f32_16x16x32_bf16 v[244:247], a[32:35], a[112:115], v[244:247]
v_mfma_f32_16x16x32_bf16 v[236:239], a[28:31], a[112:115], v[236:239]
v_mfma_f32_16x16x32_bf16 v[228:231], a[24:27], a[112:115], v[228:231]
v_mfma_f32_16x16x32_bf16 v[220:223], a[20:23], a[112:115], v[220:223]
s_waitcnt lgkmcnt(0)
v_mfma_f32_16x16x32_bf16 v[24:27], a[40:43], a[0:3], v[24:27]
ds_read_b128 a[20:23], v9 offset:32768
v_add_u32 v5, 0x80000, v5
v_mfma_f32_16x16x32_bf16 v[56:59], a[40:43], a[4:7], v[56:59]
ds_read_b128 a[24:27], v9 offset:34816
v_add_u32 v6, 0x80000, v6
v_mfma_f32_16x16x32_bf16 v[88:91], a[40:43], a[8:11], v[88:91]
ds_read_b128 a[28:31], v9 offset:36864
v_add_u32 v7, 0x60000, v7
v_mfma_f32_16x16x32_bf16 v[120:123], a[40:43], a[12:15], v[120:123]
ds_read_b128 a[32:35], v9 offset:38912
v_add_u32 v4, 0x80, v4
v_mfma_f32_16x16x32_bf16 v[124:127], a[44:47], a[12:15], v[124:127]
ds_read_b128 a[36:39], v11
v_mfma_f32_16x16x32_bf16 v[92:95], a[44:47], a[8:11], v[92:95]
ds_read_b64_tr_b16 a[104:105], v15 offset:6144
v_mfma_f32_16x16x32_bf16 v[60:63], a[44:47], a[4:7], v[60:63]
ds_read_b64_tr_b16 a[106:107], v15 offset:6400
v_mfma_f32_16x16x32_bf16 v[28:31], a[44:47], a[0:3], v[28:31]
ds_read_b64_tr_b16 a[108:109], v14 offset:10240
v_mfma_f32_16x16x32_bf16 v[32:35], a[48:51], a[0:3], v[32:35]
ds_read_b64_tr_b16 a[110:111], v14 offset:10496
s_waitcnt lgkmcnt(5)
v_mfma_f32_16x16x32_bf16 v[64:67], a[48:51], a[4:7], v[64:67]
ds_read_b64_tr_b16 a[112:113], v15 offset:10240
s_add_u32 m0, s16, 0x8000
v_mfma_f32_16x16x32_bf16 v[96:99], a[48:51], a[8:11], v[96:99]
buffer_load_dwordx4 v22, s[44:47], s20 offen lds
v_mfma_f32_16x16x32_bf16 v[128:131], a[48:51], a[12:15], v[128:131]
ds_read_b64_tr_b16 a[114:115], v15 offset:10496
v_mfma_f32_16x16x32_bf16 v[132:135], a[52:55], a[12:15], v[132:135]
ds_read_b64_tr_b16 a[40:41], v12 offset:8192
v_mfma_f32_16x16x32_bf16 v[100:103], a[52:55], a[8:11], v[100:103]
ds_read_b64_tr_b16 a[42:43], v12 offset:9216
v_mfma_f32_16x16x32_bf16 v[68:71], a[52:55], a[4:7], v[68:71]
ds_read_b64_tr_b16 a[44:45], v13 offset:8192
s_add_u32 m0, s16, 0x8400
v_mfma_f32_16x16x32_bf16 v[36:39], a[52:55], a[0:3], v[36:39]
buffer_load_dwordx4 v23, s[44:47], s20 offen lds
v_mfma_f32_16x16x32_bf16 v[40:43], a[56:59], a[0:3], v[40:43]
ds_read_b64_tr_b16 a[46:47], v13 offset:9216
v_mfma_f32_16x16x32_bf16 v[72:75], a[56:59], a[4:7], v[72:75]
ds_read_b64_tr_b16 a[48:49], v12 offset:8448
v_mfma_f32_16x16x32_bf16 v[104:107], a[56:59], a[8:11], v[104:107]
ds_read_b64_tr_b16 a[50:51], v12 offset:9472
v_mfma_f32_16x16x32_bf16 v[136:139], a[56:59], a[12:15], v[136:139]
ds_read_b64_tr_b16 a[52:53], v13 offset:8448
v_mfma_f32_16x16x32_bf16 v[140:143], a[60:63], a[12:15], v[140:143]
ds_read_b64_tr_b16 a[54:55], v13 offset:9472
s_add_u32 m0, s16, 0x8800
v_mfma_f32_16x16x32_bf16 v[108:111], a[60:63], a[8:11], v[108:111]
buffer_load_dwordx4 v22, s[44:47], s21 offen lds
v_mfma_f32_16x16x32_bf16 v[76:79], a[60:63], a[4:7], v[76:79]
ds_read_b64_tr_b16 a[56:57], v12 offset:8704
v_mfma_f32_16x16x32_bf16 v[44:47], a[60:63], a[0:3], v[44:47]
ds_read_b64_tr_b16 a[58:59], v12 offset:9728
v_mfma_f32_16x16x32_bf16 v[48:51], a[64:67], a[0:3], v[48:51]
ds_read_b64_tr_b16 a[60:61], v13 offset:8704
v_mfma_f32_16x16x32_bf16 v[80:83], a[64:67], a[4:7], v[80:83]
ds_read_b64_tr_b16 a[62:63], v13 offset:9728
v_mfma_f32_16x16x32_bf16 v[112:115], a[64:67], a[8:11], v[112:115]
s_add_u32 m0, s16, 0x8c00
v_mfma_f32_16x16x32_bf16 v[144:147], a[64:67], a[12:15], v[144:147]
buffer_load_dwordx4 v23, s[44:47], s21 offen lds
v_mfma_f32_16x16x32_bf16 v[148:151], a[68:71], a[12:15], v[148:151]
ds_read_b64_tr_b16 a[64:65], v12 offset:8960
v_mfma_f32_16x16x32_bf16 v[116:119], a[68:71], a[8:11], v[116:119]
ds_read_b64_tr_b16 a[66:67], v12 offset:9984
v_mfma_f32_16x16x32_bf16 v[84:87], a[68:71], a[4:7], v[84:87]
v_mfma_f32_16x16x32_bf16 v[52:55], a[68:71], a[0:3], v[52:55]
ds_read_b64_tr_b16 a[68:69], v13 offset:8960
v_mfma_f32_16x16x32_bf16 v[152:155], a[72:75], a[0:3], v[152:155]
ds_read_b64_tr_b16 a[70:71], v13 offset:9984
s_add_u32 m0, s16, 0x9000
v_mfma_f32_16x16x32_bf16 v[160:163], a[72:75], a[4:7], v[160:163]
buffer_load_dwordx4 v22, s[44:47], s22 offen lds
v_mfma_f32_16x16x32_bf16 v[168:171], a[72:75], a[8:11], v[168:171]
v_mfma_f32_16x16x32_bf16 v[176:179], a[72:75], a[12:15], v[176:179]
ds_read_b64_tr_b16 a[72:73], v14 offset:2048
v_mfma_f32_16x16x32_bf16 v[180:183], a[76:79], a[12:15], v[180:183]
ds_read_b64_tr_b16 a[74:75], v14 offset:2304
v_mfma_f32_16x16x32_bf16 v[172:175], a[76:79], a[8:11], v[172:175]
s_add_u32 m0, s16, 0x9400
v_mfma_f32_16x16x32_bf16 v[164:167], a[76:79], a[4:7], v[164:167]
buffer_load_dwordx4 v23, s[44:47], s22 offen lds
v_mfma_f32_16x16x32_bf16 v[156:159], a[76:79], a[0:3], v[156:159]
ds_read_b64_tr_b16 a[76:77], v15 offset:2048
v_mfma_f32_16x16x32_bf16 v[184:187], a[80:83], a[0:3], v[184:187]
ds_read_b64_tr_b16 a[78:79], v15 offset:2304
v_mfma_f32_16x16x32_bf16 v[192:195], a[80:83], a[4:7], v[192:195]
v_mfma_f32_16x16x32_bf16 v[200:203], a[80:83], a[8:11], v[200:203]
v_mfma_f32_16x16x32_bf16 v[208:211], a[80:83], a[12:15], v[208:211]
s_add_u32 m0, s16, 0x9800
v_mfma_f32_16x16x32_bf16 v[248:251], a[80:83], a[16:19], v[248:251]
buffer_load_dwordx4 v22, s[44:47], s23 offen lds
v_mfma_f32_16x16x32_bf16 v[212:215], a[84:87], a[12:15], v[212:215]
ds_read_b64_tr_b16 a[80:81], v14 offset:6144
v_mfma_f32_16x16x32_bf16 v[204:207], a[84:87], a[8:11], v[204:207]
ds_read_b64_tr_b16 a[82:83], v14 offset:6400
v_add_u32 v12, 0x8000, v12
v_mfma_f32_16x16x32_bf16 v[196:199], a[84:87], a[4:7], v[196:199]
v_add_u32 v13, 0x8000, v13
v_add_u32 v14, 0x8000, v14
v_mfma_f32_16x16x32_bf16 v[188:191], a[84:87], a[0:3], v[188:191]
v_add_u32 v15, 0x8000, v15
v_add_u32 v10, 0x8000, v10
v_mfma_f32_16x16x32_bf16 v[216:219], a[0:3], a[88:91], v[216:219]
s_add_u32 m0, s16, 0x9c00
v_add_u32 v11, 0x8000, v11
v_mfma_f32_16x16x32_bf16 v[224:227], a[4:7], a[88:91], v[224:227]
buffer_load_dwordx4 v23, s[44:47], s23 offen lds
v_mfma_f32_16x16x32_bf16 v[232:235], a[8:11], a[88:91], v[232:235]
v_mfma_f32_16x16x32_bf16 v[240:243], a[12:15], a[88:91], v[240:243]
v_mfma_f32_16x16x32_bf16 v[252:255], a[16:19], a[88:91], v[252:255]
v_mfma_f32_16x16x32_bf16 v[244:247], a[12:15], a[92:95], v[244:247]
v_mfma_f32_16x16x32_bf16 v[236:239], a[8:11], a[92:95], v[236:239]
v_mfma_f32_16x16x32_bf16 v[228:231], a[4:7], a[92:95], v[228:231]
v_mfma_f32_16x16x32_bf16 v[220:223], a[0:3], a[92:95], v[220:223]
s_waitcnt vmcnt(16) lgkmcnt(0)
s_mov_b32 s92, 200000
L_spin_kv:
v_readfirstlane_b32 s93, v1
s_nop 1
s_cmp_ge_u32 s93, 8
s_cbranch_scc1 L_spun_kv
s_sub_u32 s92, s92, 1
s_cbranch_scc1 L_spun_kv
s_sleep 4
buffer_load_dword v1, off, s[84:87], s10 sc1
s_waitcnt vmcnt(0)
s_branch L_spin_kv
L_spun_kv:
s_barrier
v_mfma_f32_16x16x32_bf16 v[24:27], a[40:43], a[20:23], v[24:27]
ds_read_b128 a[0:3], v8 offset:0
s_add_u32 m0, s19, 0x0
v_mfma_f32_16x16x32_bf16 v[56:59], a[40:43], a[24:27], v[56:59]
buffer_load_dwordx4 v16, s[48:51], s32 offen offset:0 sc1 lds
v_mfma_f32_16x16x32_bf16 v[88:91], a[40:43], a[28:31], v[88:91]
ds_read_b128 a[4:7], v8 offset:2048
v_add_u32 v22, 0x80, v22
v_mfma_f32_16x16x32_bf16 v[120:123], a[40:43], a[32:35], v[120:123]
ds_read_b128 a[8:11], v8 offset:4096
v_add_u32 v23, 0x80, v23
v_mfma_f32_16x16x32_bf16 v[124:127], a[44:47], a[32:35], v[124:127]
ds_read_b128 a[12:15], v8 offset:6144
v_mfma_f32_16x16x32_bf16 v[92:95], a[44:47], a[28:31], v[92:95]
ds_read_b128 a[16:19], v10
v_mfma_f32_16x16x32_bf16 v[60:63], a[44:47], a[24:27], v[60:63]
ds_read_b64_tr_b16 a[84:85], v15 offset:4096
v_mfma_f32_16x16x32_bf16 v[28:31], a[44:47], a[20:23], v[28:31]
buffer_load_dwordx4 v16, s[48:51], s32 offen offset:1024 sc1 lds
v_mfma_f32_16x16x32_bf16 v[32:35], a[48:51], a[20:23], v[32:35]
ds_read_b64_tr_b16 a[86:87], v15 offset:4352
v_mfma_f32_16x16x32_bf16 v[64:67], a[48:51], a[24:27], v[64:67]
ds_read_b64_tr_b16 a[88:89], v14 offset:8192
v_mfma_f32_16x16x32_bf16 v[96:99], a[48:51], a[28:31], v[96:99]
ds_read_b64_tr_b16 a[90:91], v14 offset:8448
v_mfma_f32_16x16x32_bf16 v[128:131], a[48:51], a[32:35], v[128:131]
ds_read_b64_tr_b16 a[92:93], v15 offset:8192
v_mfma_f32_16x16x32_bf16 v[132:135], a[52:55], a[32:35], v[132:135]
ds_read_b64_tr_b16 a[94:95], v15 offset:8448
v_mfma_f32_16x16x32_bf16 v[100:103], a[52:55], a[28:31], v[100:103]
ds_read_b64_tr_b16 a[40:41], v12 offset:0
v_mfma_f32_16x16x32_bf16 v[68:71], a[52:55], a[24:27], v[68:71]
buffer_load_dwordx4 v16, s[48:51], s32 offen offset:2048 sc1 lds
v_mfma_f32_16x16x32_bf16 v[36:39], a[52:55], a[20:23], v[36:39]
ds_read_b64_tr_b16 a[42:43], v12 offset:1024
v_mfma_f32_16x16x32_bf16 v[40:43], a[56:59], a[20:23], v[40:43]
ds_read_b64_tr_b16 a[44:45], v13 offset:0
v_mfma_f32_16x16x32_bf16 v[72:75], a[56:59], a[24:27], v[72:75]
ds_read_b64_tr_b16 a[46:47], v13 offset:1024
v_mfma_f32_16x16x32_bf16 v[104:107], a[56:59], a[28:31], v[104:107]
ds_read_b64_tr_b16 a[48:49], v12 offset:256
v_mfma_f32_16x16x32_bf16 v[136:139], a[56:59], a[32:35], v[136:139]
ds_read_b64_tr_b16 a[50:51], v12 offset:1280
v_mfma_f32_16x16x32_bf16 v[140:143], a[60:63], a[32:35], v[140:143]
ds_read_b64_tr_b16 a[52:53], v13 offset:256
v_mfma_f32_16x16x32_bf16 v[108:111], a[60:63], a[28:31], v[108:111]
buffer_load_dwordx4 v16, s[48:51], s32 offen offset:3072 sc1 lds
v_mfma_f32_16x16x32_bf16 v[76:79], a[60:63], a[24:27], v[76:79]
ds_read_b64_tr_b16 a[54:55], v13 offset:1280
v_mfma_f32_16x16x32_bf16 v[44:47], a[60:63], a[20:23], v[44:47]
ds_read_b64_tr_b16 a[56:57], v12 offset:512
v_mfma_f32_16x16x32_bf16 v[48:51], a[64:67], a[20:23], v[48:51]
ds_read_b64_tr_b16 a[58:59], v12 offset:1536
v_mfma_f32_16x16x32_bf16 v[80:83], a[64:67], a[24:27], v[80:83]
ds_read_b64_tr_b16 a[60:61], v13 offset:512
v_mfma_f32_16x16x32_bf16 v[112:115], a[64:67], a[28:31], v[112:115]
ds_read_b64_tr_b16 a[62:63], v13 offset:1536
v_mfma_f32_16x16x32_bf16 v[144:147], a[64:67], a[32:35], v[144:147]
ds_read_b64_tr_b16 a[64:65], v12 offset:768
s_add_u32 m0, s19, 0x1000
v_mfma_f32_16x16x32_bf16 v[148:151], a[68:71], a[32:35], v[148:151]
buffer_load_dwordx4 v16, s[48:51], s7 offen offset:0 sc1 lds
v_mfma_f32_16x16x32_bf16 v[116:119], a[68:71], a[28:31], v[116:119]
ds_read_b64_tr_b16 a[66:67], v12 offset:1792
v_mfma_f32_16x16x32_bf16 v[84:87], a[68:71], a[24:27], v[84:87]
v_mfma_f32_16x16x32_bf16 v[52:55], a[68:71], a[20:23], v[52:55]
ds_read_b64_tr_b16 a[68:69], v13 offset:768
v_mfma_f32_16x16x32_bf16 v[152:155], a[72:75], a[20:23], v[152:155]
ds_read_b64_tr_b16 a[70:71], v13 offset:1792
v_mfma_f32_16x16x32_bf16 v[160:163], a[72:75], a[24:27], v[160:163]
v_mfma_f32_16x16x32_bf16 v[168:171], a[72:75], a[28:31], v[168:171]
v_mfma_f32_16x16x32_bf16 v[176:179], a[72:75], a[32:35], v[176:179]
buffer_load_dwordx4 v16, s[48:51], s7 offen offset:1024 sc1 lds
v_mfma_f32_16x16x32_bf16 v[180:183], a[76:79], a[32:35], v[180:183]
ds_read_b64_tr_b16 a[72:73], v14 offset:0
v_mfma_f32_16x16x32_bf16 v[172:175], a[76:79], a[28:31], v[172:175]
ds_read_b64_tr_b16 a[74:75], v14 offset:256
v_mfma_f32_16x16x32_bf16 v[164:167], a[76:79], a[24:27], v[164:167]
v_mfma_f32_16x16x32_bf16 v[156:159], a[76:79], a[20:23], v[156:159]
ds_read_b64_tr_b16 a[76:77], v15 offset:0
v_mfma_f32_16x16x32_bf16 v[184:187], a[80:83], a[20:23], v[184:187]
ds_read_b64_tr_b16 a[78:79], v15 offset:256
v_mfma_f32_16x16x32_bf16 v[192:195], a[80:83], a[24:27], v[192:195]
v_mfma_f32_16x16x32_bf16 v[200:203], a[80:83], a[28:31], v[200:203]
buffer_load_dwordx4 v16, s[48:51], s7 offen offset:2048 sc1 lds
v_mfma_f32_16x16x32_bf16 v[208:211], a[80:83], a[32:35], v[208:211]
v_mfma_f32_16x16x32_bf16 v[248:251], a[80:83], a[36:39], v[248:251]
ds_read_b64_tr_b16 a[80:81], v14 offset:4096
v_mfma_f32_16x16x32_bf16 v[212:215], a[104:107], a[32:35], v[212:215]
ds_read_b64_tr_b16 a[82:83], v14 offset:4352
v_mfma_f32_16x16x32_bf16 v[204:207], a[104:107], a[28:31], v[204:207]
v_mfma_f32_16x16x32_bf16 v[196:199], a[104:107], a[24:27], v[196:199]
v_mfma_f32_16x16x32_bf16 v[188:191], a[104:107], a[20:23], v[188:191]
v_mfma_f32_16x16x32_bf16 v[216:219], a[20:23], a[108:111], v[216:219]
buffer_load_dwordx4 v16, s[48:51], s7 offen offset:3072 sc1 lds
v_mfma_f32_16x16x32_bf16 v[224:227], a[24:27], a[108:111], v[224:227]
v_mfma_f32_16x16x32_bf16 v[232:235], a[28:31], a[108:111], v[232:235]
v_mfma_f32_16x16x32_bf16 v[240:243], a[32:35], a[108:111], v[240:243]
v_mfma_f32_16x16x32_bf16 v[252:255], a[36:39], a[108:111], v[252:255]
v_mfma_f32_16x16x32_bf16 v[244:247], a[32:35], a[112:115], v[244:247]
v_mfma_f32_16x16x32_bf16 v[236:239], a[28:31], a[112:115], v[236:239]
v_mfma_f32_16x16x32_bf16 v[228:231], a[24:27], a[112:115], v[228:231]
v_mfma_f32_16x16x32_bf16 v[220:223], a[20:23], a[112:115], v[220:223]
s_waitcnt lgkmcnt(0)
v_mfma_f32_16x16x32_bf16 v[24:27], a[40:43], a[0:3], v[24:27]
ds_read_b128 a[20:23], v9 offset:0
s_add_u32 s32, s32, s99
s_add_u32 s7, s7, s99
v_mfma_f32_16x16x32_bf16 v[56:59], a[40:43], a[4:7], v[56:59]
ds_read_b128 a[24:27], v9 offset:2048
v_mfma_f32_16x16x32_bf16 v[88:91], a[40:43], a[8:11], v[88:91]
ds_read_b128 a[28:31], v9 offset:4096
v_mfma_f32_16x16x32_bf16 v[120:123], a[40:43], a[12:15], v[120:123]
ds_read_b128 a[32:35], v9 offset:6144
v_mfma_f32_16x16x32_bf16 v[124:127], a[44:47], a[12:15], v[124:127]
ds_read_b128 a[36:39], v11
v_mfma_f32_16x16x32_bf16 v[92:95], a[44:47], a[8:11], v[92:95]
ds_read_b64_tr_b16 a[104:105], v15 offset:6144
v_mfma_f32_16x16x32_bf16 v[60:63], a[44:47], a[4:7], v[60:63]
ds_read_b64_tr_b16 a[106:107], v15 offset:6400
v_mfma_f32_16x16x32_bf16 v[28:31], a[44:47], a[0:3], v[28:31]
ds_read_b64_tr_b16 a[108:109], v14 offset:10240
v_mfma_f32_16x16x32_bf16 v[32:35], a[48:51], a[0:3], v[32:35]
ds_read_b64_tr_b16 a[110:111], v14 offset:10496
s_waitcnt lgkmcnt(5)
v_mfma_f32_16x16x32_bf16 v[64:67], a[48:51], a[4:7], v[64:67]
ds_read_b64_tr_b16 a[112:113], v15 offset:10240
s_add_u32 m0, s19, 0x18000
v_mfma_f32_16x16x32_bf16 v[96:99], a[48:51], a[8:11], v[96:99]
buffer_load_dwordx4 v16, s[48:51], s32 offen offset:0 sc1 lds
v_mfma_f32_16x16x32_bf16 v[128:131], a[48:51], a[12:15], v[128:131]
ds_read_b64_tr_b16 a[114:115], v15 offset:10496
v_mfma_f32_16x16x32_bf16 v[132:135], a[52:55], a[12:15], v[132:135]
ds_read_b64_tr_b16 a[40:41], v12 offset:8192
v_mfma_f32_16x16x32_bf16 v[100:103], a[52:55], a[8:11], v[100:103]
ds_read_b64_tr_b16 a[42:43], v12 offset:9216
v_mfma_f32_16x16x32_bf16 v[68:71], a[52:55], a[4:7], v[68:71]
ds_read_b64_tr_b16 a[44:45], v13 offset:8192
v_mfma_f32_16x16x32_bf16 v[36:39], a[52:55], a[0:3], v[36:39]
buffer_load_dwordx4 v16, s[48:51], s32 offen offset:1024 sc1 lds
v_mfma_f32_16x16x32_bf16 v[40:43], a[56:59], a[0:3], v[40:43]
ds_read_b64_tr_b16 a[46:47], v13 offset:9216
v_mfma_f32_16x16x32_bf16 v[72:75], a[56:59], a[4:7], v[72:75]
ds_read_b64_tr_b16 a[48:49], v12 offset:8448
v_mfma_f32_16x16x32_bf16 v[104:107], a[56:59], a[8:11], v[104:107]
ds_read_b64_tr_b16 a[50:51], v12 offset:9472
v_mfma_f32_16x16x32_bf16 v[136:139], a[56:59], a[12:15], v[136:139]
ds_read_b64_tr_b16 a[52:53], v13 offset:8448
v_mfma_f32_16x16x32_bf16 v[140:143], a[60:63], a[12:15], v[140:143]
ds_read_b64_tr_b16 a[54:55], v13 offset:9472
v_mfma_f32_16x16x32_bf16 v[108:111], a[60:63], a[8:11], v[108:111]
buffer_load_dwordx4 v16, s[48:51], s32 offen offset:2048 sc1 lds
v_mfma_f32_16x16x32_bf16 v[76:79], a[60:63], a[4:7], v[76:79]
ds_read_b64_tr_b16 a[56:57], v12 offset:8704
v_mfma_f32_16x16x32_bf16 v[44:47], a[60:63], a[0:3], v[44:47]
ds_read_b64_tr_b16 a[58:59], v12 offset:9728
v_mfma_f32_16x16x32_bf16 v[48:51], a[64:67], a[0:3], v[48:51]
ds_read_b64_tr_b16 a[60:61], v13 offset:8704
v_mfma_f32_16x16x32_bf16 v[80:83], a[64:67], a[4:7], v[80:83]
ds_read_b64_tr_b16 a[62:63], v13 offset:9728
v_mfma_f32_16x16x32_bf16 v[112:115], a[64:67], a[8:11], v[112:115]
v_mfma_f32_16x16x32_bf16 v[144:147], a[64:67], a[12:15], v[144:147]
buffer_load_dwordx4 v16, s[48:51], s32 offen offset:3072 sc1 lds
v_mfma_f32_16x16x32_bf16 v[148:151], a[68:71], a[12:15], v[148:151]
ds_read_b64_tr_b16 a[64:65], v12 offset:8960
v_mfma_f32_16x16x32_bf16 v[116:119], a[68:71], a[8:11], v[116:119]
ds_read_b64_tr_b16 a[66:67], v12 offset:9984
v_mfma_f32_16x16x32_bf16 v[84:87], a[68:71], a[4:7], v[84:87]
v_mfma_f32_16x16x32_bf16 v[52:55], a[68:71], a[0:3], v[52:55]
ds_read_b64_tr_b16 a[68:69], v13 offset:8960
v_mfma_f32_16x16x32_bf16 v[152:155], a[72:75], a[0:3], v[152:155]
ds_read_b64_tr_b16 a[70:71], v13 offset:9984
s_add_u32 m0, s19, 0x19000
v_mfma_f32_16x16x32_bf16 v[160:163], a[72:75], a[4:7], v[160:163]
buffer_load_dwordx4 v16, s[48:51], s7 offen offset:0 sc1 lds
v_mfma_f32_16x16x32_bf16 v[168:171], a[72:75], a[8:11], v[168:171]
v_mfma_f32_16x16x32_bf16 v[176:179], a[72:75], a[12:15], v[176:179]
ds_read_b64_tr_b16 a[72:73], v14 offset:2048
v_mfma_f32_16x16x32_bf16 v[180:183], a[76:79], a[12:15], v[180:183]
ds_read_b64_tr_b16 a[74:75], v14 offset:2304
v_mfma_f32_16x16x32_bf16 v[172:175], a[76:79], a[8:11], v[172:175]
v_mfma_f32_16x16x32_bf16 v[164:167], a[76:79], a[4:7], v[164:167]
buffer_load_dwordx4 v16, s[48:51], s7 offen offset:1024 sc1 lds
v_mfma_f32_16x16x32_bf16 v[156:159], a[76:79], a[0:3], v[156:159]
ds_read_b64_tr_b16 a[76:77], v15 offset:2048
v_mfma_f32_16x16x32_bf16 v[184:187], a[80:83], a[0:3], v[184:187]
ds_read_b64_tr_b16 a[78:79], v15 offset:2304
v_mfma_f32_16x16x32_bf16 v[192:195], a[80:83], a[4:7], v[192:195]
v_mfma_f32_16x16x32_bf16 v[200:203], a[80:83], a[8:11], v[200:203]
v_mfma_f32_16x16x32_bf16 v[208:211], a[80:83], a[12:15], v[208:211]
v_mfma_f32_16x16x32_bf16 v[248:251], a[80:83], a[16:19], v[248:251]
buffer_load_dwordx4 v16, s[48:51], s7 offen offset:2048 sc1 lds
v_mfma_f32_16x16x32_bf16 v[212:215], a[84:87], a[12:15], v[212:215]
ds_read_b64_tr_b16 a[80:81], v14 offset:6144
v_mfma_f32_16x16x32_bf16 v[204:207], a[84:87], a[8:11], v[204:207]
ds_read_b64_tr_b16 a[82:83], v14 offset:6400
v_add_u32 v12, 0x8000, v12
v_mfma_f32_16x16x32_bf16 v[196:199], a[84:87], a[4:7], v[196:199]
v_add_u32 v13, 0x8000, v13
v_add_u32 v14, 0x8000, v14
v_mfma_f32_16x16x32_bf16 v[188:191], a[84:87], a[0:3], v[188:191]
v_add_u32 v15, 0x8000, v15
v_add_u32 v10, 0x8000, v10
v_mfma_f32_16x16x32_bf16 v[216:219], a[0:3], a[88:91], v[216:219]
v_add_u32 v11, 0x8000, v11
v_mfma_f32_16x16x32_bf16 v[224:227], a[4:7], a[88:91], v[224:227]
buffer_load_dwordx4 v16, s[48:51], s7 offen offset:3072 sc1 lds
v_mfma_f32_16x16x32_bf16 v[232:235], a[8:11], a[88:91], v[232:235]
v_mfma_f32_16x16x32_bf16 v[240:243], a[12:15], a[88:91], v[240:243]
v_mfma_f32_16x16x32_bf16 v[252:255], a[16:19], a[88:91], v[252:255]
v_mfma_f32_16x16x32_bf16 v[244:247], a[12:15], a[92:95], v[244:247]
v_mfma_f32_16x16x32_bf16 v[236:239], a[8:11], a[92:95], v[236:239]
v_mfma_f32_16x16x32_bf16 v[228:231], a[4:7], a[92:95], v[228:231]
v_mfma_f32_16x16x32_bf16 v[220:223], a[0:3], a[92:95], v[220:223]
s_waitcnt vmcnt(16) lgkmcnt(0)
s_barrier
v_mfma_f32_16x16x32_bf16 v[24:27], a[40:43], a[20:23], v[24:27]
ds_read_b128 a[0:3], v8 offset:32768
s_add_u32 m0, s19, 0x8000
s_add_u32 s32, s32, 0x8000
s_add_u32 s7, s7, 0x8000
v_mfma_f32_16x16x32_bf16 v[56:59], a[40:43], a[24:27], v[56:59]
buffer_load_dwordx4 v16, s[48:51], s32 offen offset:0 sc1 lds
v_mfma_f32_16x16x32_bf16 v[88:91], a[40:43], a[28:31], v[88:91]
ds_read_b128 a[4:7], v8 offset:34816
v_mfma_f32_16x16x32_bf16 v[120:123], a[40:43], a[32:35], v[120:123]
ds_read_b128 a[8:11], v8 offset:36864
v_mfma_f32_16x16x32_bf16 v[124:127], a[44:47], a[32:35], v[124:127]
ds_read_b128 a[12:15], v8 offset:38912
v_mfma_f32_16x16x32_bf16 v[92:95], a[44:47], a[28:31], v[92:95]
ds_read_b128 a[16:19], v10
v_mfma_f32_16x16x32_bf16 v[60:63], a[44:47], a[24:27], v[60:63]
ds_read_b64_tr_b16 a[84:85], v15 offset:4096
v_mfma_f32_16x16x32_bf16 v[28:31], a[44:47], a[20:23], v[28:31]
buffer_load_dwordx4 v16, s[48:51], s32 offen offset:1024 sc1 lds
v_mfma_f32_16x16x32_bf16 v[32:35], a[48:51], a[20:23], v[32:35]
ds_read_b64_tr_b16 a[86:87], v15 offset:4352
v_mfma_f32_16x16x32_bf16 v[64:67], a[48:51], a[24:27], v[64:67]
ds_read_b64_tr_b16 a[88:89], v14 offset:8192
v_mfma_f32_16x16x32_bf16 v[96:99], a[48:51], a[28:31], v[96:99]
ds_read_b64_tr_b16 a[90:91], v14 offset:8448
v_mfma_f32_16x16x32_bf16 v[128:131], a[48:51], a[32:35], v[128:131]
ds_read_b64_tr_b16 a[92:93], v15 offset:8192
v_mfma_f32_16x16x32_bf16 v[132:135], a[52:55], a[32:35], v[132:135]
ds_read_b64_tr_b16 a[94:95], v15 offset:8448
v_mfma_f32_16x16x32_bf16 v[100:103], a[52:55], a[28:31], v[100:103]
buffer_load_dwordx4 v16, s[48:51], s32 offen offset:2048 sc1 lds
v_mfma_f32_16x16x32_bf16 v[68:71], a[52:55], a[24:27], v[68:71]
ds_read_b64_tr_b16 a[40:41], v12 offset:0
v_mfma_f32_16x16x32_bf16 v[36:39], a[52:55], a[20:23], v[36:39]
ds_read_b64_tr_b16 a[42:43], v12 offset:1024
v_mfma_f32_16x16x32_bf16 v[40:43], a[56:59], a[20:23], v[40:43]
ds_read_b64_tr_b16 a[44:45], v13 offset:0
v_mfma_f32_16x16x32_bf16 v[72:75], a[56:59], a[24:27], v[72:75]
ds_read_b64_tr_b16 a[46:47], v13 offset:1024
v_mfma_f32_16x16x32_bf16 v[104:107], a[56:59], a[28:31], v[104:107]
ds_read_b64_tr_b16 a[48:49], v12 offset:256
v_mfma_f32_16x16x32_bf16 v[136:139], a[56:59], a[32:35], v[136:139]
buffer_load_dwordx4 v16, s[48:51], s32 offen offset:3072 sc1 lds
v_mfma_f32_16x16x32_bf16 v[140:143], a[60:63], a[32:35], v[140:143]
ds_read_b64_tr_b16 a[50:51], v12 offset:1280
v_mfma_f32_16x16x32_bf16 v[108:111], a[60:63], a[28:31], v[108:111]
ds_read_b64_tr_b16 a[52:53], v13 offset:256
v_mfma_f32_16x16x32_bf16 v[76:79], a[60:63], a[24:27], v[76:79]
ds_read_b64_tr_b16 a[54:55], v13 offset:1280
v_mfma_f32_16x16x32_bf16 v[44:47], a[60:63], a[20:23], v[44:47]
ds_read_b64_tr_b16 a[56:57], v12 offset:512
v_mfma_f32_16x16x32_bf16 v[48:51], a[64:67], a[20:23], v[48:51]
ds_read_b64_tr_b16 a[58:59], v12 offset:1536
s_add_u32 m0, s19, 0x9000
v_mfma_f32_16x16x32_bf16 v[80:83], a[64:67], a[24:27], v[80:83]
buffer_load_dwordx4 v16, s[48:51], s7 offen offset:0 sc1 lds
v_mfma_f32_16x16x32_bf16 v[112:115], a[64:67], a[28:31], v[112:115]
ds_read_b64_tr_b16 a[60:61], v13 offset:512
v_mfma_f32_16x16x32_bf16 v[144:147], a[64:67], a[32:35], v[144:147]
ds_read_b64_tr_b16 a[62:63], v13 offset:1536
v_mfma_f32_16x16x32_bf16 v[148:151], a[68:71], a[32:35], v[148:151]
ds_read_b64_tr_b16 a[64:65], v12 offset:768
v_mfma_f32_16x16x32_bf16 v[116:119], a[68:71], a[28:31], v[116:119]
ds_read_b64_tr_b16 a[66:67], v12 offset:1792
v_mfma_f32_16x16x32_bf16 v[84:87], a[68:71], a[24:27], v[84:87]
v_mfma_f32_16x16x32_bf16 v[52:55], a[68:71], a[20:23], v[52:55]
buffer_load_dwordx4 v16, s[48:51], s7 offen offset:1024 sc1 lds
v_mfma_f32_16x16x32_bf16 v[152:155], a[72:75], a[20:23], v[152:155]
ds_read_b64_tr_b16 a[68:69], v13 offset:768
v_mfma_f32_16x16x32_bf16 v[160:163], a[72:75], a[24:27], v[160:163]
ds_read_b64_tr_b16 a[70:71], v13 offset:1792
v_mfma_f32_16x16x32_bf16 v[168:171], a[72:75], a[28:31], v[168:171]
v_mfma_f32_16x16x32_bf16 v[176:179], a[72:75], a[32:35], v[176:179]
ds_read_b64_tr_b16 a[72:73], v14 offset:0
v_mfma_f32_16x16x32_bf16 v[180:183], a[76:79], a[32:35], v[180:183]
ds_read_b64_tr_b16 a[74:75], v14 offset:256
v_mfma_f32_16x16x32_bf16 v[172:175], a[76:79], a[28:31], v[172:175]
buffer_load_dwordx4 v16, s[48:51], s7 offen offset:2048 sc1 lds
v_mfma_f32_16x16x32_bf16 v[164:167], a[76:79], a[24:27], v[164:167]
v_mfma_f32_16x16x32_bf16 v[156:159], a[76:79], a[20:23], v[156:159]
ds_read_b64_tr_b16 a[76:77], v15 offset:0
v_mfma_f32_16x16x32_bf16 v[184:187], a[80:83], a[20:23], v[184:187]
ds_read_b64_tr_b16 a[78:79], v15 offset:256
v_mfma_f32_16x16x32_bf16 v[192:195], a[80:83], a[24:27], v[192:195]
v_mfma_f32_16x16x32_bf16 v[200:203], a[80:83], a[28:31], v[200:203]
v_mfma_f32_16x16x32_bf16 v[208:211], a[80:83], a[32:35], v[208:211]
buffer_load_dwordx4 v16, s[48:51], s7 offen offset:3072 sc1 lds
v_mfma_f32_16x16x32_bf16 v[248:251], a[80:83], a[36:39], v[248:251]
ds_read_b64_tr_b16 a[80:81], v14 offset:4096
v_mfma_f32_16x16x32_bf16 v[212:215], a[104:107], a[32:35], v[212:215]
ds_read_b64_tr_b16 a[82:83], v14 offset:4352
v_mfma_f32_16x16x32_bf16 v[204:207], a[104:107], a[28:31], v[204:207]
v_mfma_f32_16x16x32_bf16 v[196:199], a[104:107], a[24:27], v[196:199]
v_mfma_f32_16x16x32_bf16 v[188:191], a[104:107], a[20:23], v[188:191]
v_add_u32 v20, s76, v16
v_mov_b32 v21, s77
v_mfma_f32_16x16x32_bf16 v[216:219], a[20:23], a[108:111], v[216:219]
global_load_dword v18, v[20:21], off sc1
v_mfma_f32_16x16x32_bf16 v[224:227], a[24:27], a[108:111], v[224:227]
v_mfma_f32_16x16x32_bf16 v[232:235], a[28:31], a[108:111], v[232:235]
v_mfma_f32_16x16x32_bf16 v[240:243], a[32:35], a[108:111], v[240:243]
v_mfma_f32_16x16x32_bf16 v[252:255], a[36:39], a[108:111], v[252:255]
v_mfma_f32_16x16x32_bf16 v[244:247], a[32:35], a[112:115], v[244:247]
v_mfma_f32_16x16x32_bf16 v[236:239], a[28:31], a[112:115], v[236:239]
v_mfma_f32_16x16x32_bf16 v[228:231], a[24:27], a[112:115], v[228:231]
v_mfma_f32_16x16x32_bf16 v[220:223], a[20:23], a[112:115], v[220:223]
s_waitcnt lgkmcnt(0)
v_mfma_f32_16x16x32_bf16 v[24:27], a[40:43], a[0:3], v[24:27]
ds_read_b128 a[20:23], v9 offset:32768
s_add_u32 s32, s32, 0x8000
s_add_u32 s7, s7, 0x8000
v_mfma_f32_16x16x32_bf16 v[56:59], a[40:43], a[4:7], v[56:59]
ds_read_b128 a[24:27], v9 offset:34816
v_mfma_f32_16x16x32_bf16 v[88:91], a[40:43], a[8:11], v[88:91]
ds_read_b128 a[28:31], v9 offset:36864
v_mfma_f32_16x16x32_bf16 v[120:123], a[40:43], a[12:15], v[120:123]
ds_read_b128 a[32:35], v9 offset:38912
v_mfma_f32_16x16x32_bf16 v[124:127], a[44:47], a[12:15], v[124:127]
ds_read_b128 a[36:39], v11
v_mfma_f32_16x16x32_bf16 v[92:95], a[44:47], a[8:11], v[92:95]
ds_read_b64_tr_b16 a[104:105], v15 offset:6144
v_mfma_f32_16x16x32_bf16 v[60:63], a[44:47], a[4:7], v[60:63]
ds_read_b64_tr_b16 a[106:107], v15 offset:6400
v_mfma_f32_16x16x32_bf16 v[28:31], a[44:47], a[0:3], v[28:31]
ds_read_b64_tr_b16 a[108:109], v14 offset:10240
v_mfma_f32_16x16x32_bf16 v[32:35], a[48:51], a[0:3], v[32:35]
ds_read_b64_tr_b16 a[110:111], v14 offset:10496
v_mfma_f32_16x16x32_bf16 v[64:67], a[48:51], a[4:7], v[64:67]
ds_read_b64_tr_b16 a[112:113], v15 offset:10240
v_mfma_f32_16x16x32_bf16 v[96:99], a[48:51], a[8:11], v[96:99]
ds_read_b64_tr_b16 a[114:115], v15 offset:10496
v_mfma_f32_16x16x32_bf16 v[128:131], a[48:51], a[12:15], v[128:131]
ds_read_b64_tr_b16 a[40:41], v12 offset:8192
v_mfma_f32_16x16x32_bf16 v[132:135], a[52:55], a[12:15], v[132:135]
ds_read_b64_tr_b16 a[42:43], v12 offset:9216
v_mfma_f32_16x16x32_bf16 v[100:103], a[52:55], a[8:11], v[100:103]
ds_read_b64_tr_b16 a[44:45], v13 offset:8192
v_mfma_f32_16x16x32_bf16 v[68:71], a[52:55], a[4:7], v[68:71]
ds_read_b64_tr_b16 a[46:47], v13 offset:9216
v_mfma_f32_16x16x32_bf16 v[36:39], a[52:55], a[0:3], v[36:39]
ds_read_b64_tr_b16 a[48:49], v12 offset:8448
v_mfma_f32_16x16x32_bf16 v[40:43], a[56:59], a[0:3], v[40:43]
ds_read_b64_tr_b16 a[50:51], v12 offset:9472
v_mfma_f32_16x16x32_bf16 v[72:75], a[56:59], a[4:7], v[72:75]
ds_read_b64_tr_b16 a[52:53], v13 offset:8448
v_mfma_f32_16x16x32_bf16 v[104:107], a[56:59], a[8:11], v[104:107]
ds_read_b64_tr_b16 a[54:55], v13 offset:9472
v_mfma_f32_16x16x32_bf16 v[136:139], a[56:59], a[12:15], v[136:139]
ds_read_b64_tr_b16 a[56:57], v12 offset:8704
v_mfma_f32_16x16x32_bf16 v[140:143], a[60:63], a[12:15], v[140:143]
ds_read_b64_tr_b16 a[58:59], v12 offset:9728
v_mfma_f32_16x16x32_bf16 v[108:111], a[60:63], a[8:11], v[108:111]
v_mfma_f32_16x16x32_bf16 v[76:79], a[60:63], a[4:7], v[76:79]
v_mfma_f32_16x16x32_bf16 v[44:47], a[60:63], a[0:3], v[44:47]
ds_read_b64_tr_b16 a[60:61], v13 offset:8704
v_mfma_f32_16x16x32_bf16 v[48:51], a[64:67], a[0:3], v[48:51]
ds_read_b64_tr_b16 a[62:63], v13 offset:9728
v_mfma_f32_16x16x32_bf16 v[80:83], a[64:67], a[4:7], v[80:83]
v_mfma_f32_16x16x32_bf16 v[112:115], a[64:67], a[8:11], v[112:115]
v_mfma_f32_16x16x32_bf16 v[144:147], a[64:67], a[12:15], v[144:147]
ds_read_b64_tr_b16 a[64:65], v12 offset:8960
v_mfma_f32_16x16x32_bf16 v[148:151], a[68:71], a[12:15], v[148:151]
ds_read_b64_tr_b16 a[66:67], v12 offset:9984
v_mfma_f32_16x16x32_bf16 v[116:119], a[68:71], a[8:11], v[116:119]
v_mfma_f32_16x16x32_bf16 v[84:87], a[68:71], a[4:7], v[84:87]
v_mfma_f32_16x16x32_bf16 v[52:55], a[68:71], a[0:3], v[52:55]
ds_read_b64_tr_b16 a[68:69], v13 offset:8960
v_mfma_f32_16x16x32_bf16 v[152:155], a[72:75], a[0:3], v[152:155]
ds_read_b64_tr_b16 a[70:71], v13 offset:9984
v_mfma_f32_16x16x32_bf16 v[160:163], a[72:75], a[4:7], v[160:163]
v_mfma_f32_16x16x32_bf16 v[168:171], a[72:75], a[8:11], v[168:171]
v_mfma_f32_16x16x32_bf16 v[176:179], a[72:75], a[12:15], v[176:179]
ds_read_b64_tr_b16 a[72:73], v14 offset:2048
v_mfma_f32_16x16x32_bf16 v[180:183], a[76:79], a[12:15], v[180:183]
ds_read_b64_tr_b16 a[74:75], v14 offset:2304
v_mfma_f32_16x16x32_bf16 v[172:175], a[76:79], a[8:11], v[172:175]
v_mfma_f32_16x16x32_bf16 v[164:167], a[76:79], a[4:7], v[164:167]
v_mfma_f32_16x16x32_bf16 v[156:159], a[76:79], a[0:3], v[156:159]
ds_read_b64_tr_b16 a[76:77], v15 offset:2048
v_mfma_f32_16x16x32_bf16 v[184:187], a[80:83], a[0:3], v[184:187]
ds_read_b64_tr_b16 a[78:79], v15 offset:2304
v_mfma_f32_16x16x32_bf16 v[192:195], a[80:83], a[4:7], v[192:195]
v_mfma_f32_16x16x32_bf16 v[200:203], a[80:83], a[8:11], v[200:203]
v_mfma_f32_16x16x32_bf16 v[208:211], a[80:83], a[12:15], v[208:211]
v_mfma_f32_16x16x32_bf16 v[248:251], a[80:83], a[16:19], v[248:251]
ds_read_b64_tr_b16 a[80:81], v14 offset:6144
v_mfma_f32_16x16x32_bf16 v[212:215], a[84:87], a[12:15], v[212:215]
ds_read_b64_tr_b16 a[82:83], v14 offset:6400
v_add_u32 v12, 0xffff0000, v12
v_mfma_f32_16x16x32_bf16 v[204:207], a[84:87], a[8:11], v[204:207]
v_add_u32 v13, 0xffff0000, v13
v_add_u32 v14, 0xffff0000, v14
v_mfma_f32_16x16x32_bf16 v[196:199], a[84:87], a[4:7], v[196:199]
v_add_u32 v15, 0xffff0000, v15
v_add_u32 v10, 0xffff0000, v10
v_mfma_f32_16x16x32_bf16 v[188:191], a[84:87], a[0:3], v[188:191]
v_add_u32 v11, 0xffff0000, v11
v_mfma_f32_16x16x32_bf16 v[216:219], a[0:3], a[88:91], v[216:219]
v_mfma_f32_16x16x32_bf16 v[224:227], a[4:7], a[88:91], v[224:227]
v_mfma_f32_16x16x32_bf16 v[232:235], a[8:11], a[88:91], v[232:235]
v_mfma_f32_16x16x32_bf16 v[240:243], a[12:15], a[88:91], v[240:243]
v_mfma_f32_16x16x32_bf16 v[252:255], a[16:19], a[88:91], v[252:255]
v_mfma_f32_16x16x32_bf16 v[244:247], a[12:15], a[92:95], v[244:247]
v_mfma_f32_16x16x32_bf16 v[236:239], a[8:11], a[92:95], v[236:239]
v_mfma_f32_16x16x32_bf16 v[228:231], a[4:7], a[92:95], v[228:231]
v_mfma_f32_16x16x32_bf16 v[220:223], a[0:3], a[92:95], v[220:223]
s_waitcnt lgkmcnt(0)
s_barrier
v_mfma_f32_16x16x32_bf16 v[24:27], a[40:43], a[20:23], v[24:27]
v_mfma_f32_16x16x32_bf16 v[56:59], a[40:43], a[24:27], v[56:59]
v_mfma_f32_16x16x32_bf16 v[88:91], a[40:43], a[28:31], v[88:91]
v_mfma_f32_16x16x32_bf16 v[120:123], a[40:43], a[32:35], v[120:123]
v_mfma_f32_16x16x32_bf16 v[124:127], a[44:47], a[32:35], v[124:127]
v_mfma_f32_16x16x32_bf16 v[92:95], a[44:47], a[28:31], v[92:95]
v_mfma_f32_16x16x32_bf16 v[60:63], a[44:47], a[24:27], v[60:63]
v_mfma_f32_16x16x32_bf16 v[28:31], a[44:47], a[20:23], v[28:31]
v_mfma_f32_16x16x32_bf16 v[32:35], a[48:51], a[20:23], v[32:35]
v_mfma_f32_16x16x32_bf16 v[64:67], a[48:51], a[24:27], v[64:67]
v_mfma_f32_16x16x32_bf16 v[96:99], a[48:51], a[28:31], v[96:99]
v_mfma_f32_16x16x32_bf16 v[128:131], a[48:51], a[32:35], v[128:131]
v_mfma_f32_16x16x32_bf16 v[132:135], a[52:55], a[32:35], v[132:135]
v_mfma_f32_16x16x32_bf16 v[100:103], a[52:55], a[28:31], v[100:103]
v_mfma_f32_16x16x32_bf16 v[68:71], a[52:55], a[24:27], v[68:71]
v_mfma_f32_16x16x32_bf16 v[36:39], a[52:55], a[20:23], v[36:39]
v_mfma_f32_16x16x32_bf16 v[40:43], a[56:59], a[20:23], v[40:43]
v_mfma_f32_16x16x32_bf16 v[72:75], a[56:59], a[24:27], v[72:75]
v_mfma_f32_16x16x32_bf16 v[104:107], a[56:59], a[28:31], v[104:107]
v_mfma_f32_16x16x32_bf16 v[136:139], a[56:59], a[32:35], v[136:139]
v_mfma_f32_16x16x32_bf16 v[140:143], a[60:63], a[32:35], v[140:143]
v_mfma_f32_16x16x32_bf16 v[108:111], a[60:63], a[28:31], v[108:111]
v_mfma_f32_16x16x32_bf16 v[76:79], a[60:63], a[24:27], v[76:79]
v_mfma_f32_16x16x32_bf16 v[44:47], a[60:63], a[20:23], v[44:47]
v_mfma_f32_16x16x32_bf16 v[48:51], a[64:67], a[20:23], v[48:51]
v_mfma_f32_16x16x32_bf16 v[80:83], a[64:67], a[24:27], v[80:83]
v_mfma_f32_16x16x32_bf16 v[112:115], a[64:67], a[28:31], v[112:115]
v_mfma_f32_16x16x32_bf16 v[144:147], a[64:67], a[32:35], v[144:147]
v_mfma_f32_16x16x32_bf16 v[148:151], a[68:71], a[32:35], v[148:151]
v_mfma_f32_16x16x32_bf16 v[116:119], a[68:71], a[28:31], v[116:119]
v_mfma_f32_16x16x32_bf16 v[84:87], a[68:71], a[24:27], v[84:87]
v_mfma_f32_16x16x32_bf16 v[52:55], a[68:71], a[20:23], v[52:55]
v_mfma_f32_16x16x32_bf16 v[152:155], a[72:75], a[20:23], v[152:155]
v_mfma_f32_16x16x32_bf16 v[160:163], a[72:75], a[24:27], v[160:163]
v_mfma_f32_16x16x32_bf16 v[168:171], a[72:75], a[28:31], v[168:171]
v_mfma_f32_16x16x32_bf16 v[176:179], a[72:75], a[32:35], v[176:179]
v_mfma_f32_16x16x32_bf16 v[180:183], a[76:79], a[32:35], v[180:183]
v_mfma_f32_16x16x32_bf16 v[172:175], a[76:79], a[28:31], v[172:175]
v_mfma_f32_16x16x32_bf16 v[164:167], a[76:79], a[24:27], v[164:167]
v_mfma_f32_16x16x32_bf16 v[156:159], a[76:79], a[20:23], v[156:159]
v_mfma_f32_16x16x32_bf16 v[184:187], a[80:83], a[20:23], v[184:187]
v_mfma_f32_16x16x32_bf16 v[192:195], a[80:83], a[24:27], v[192:195]
v_mfma_f32_16x16x32_bf16 v[200:203], a[80:83], a[28:31], v[200:203]
v_mfma_f32_16x16x32_bf16 v[208:211], a[80:83], a[32:35], v[208:211]
v_mfma_f32_16x16x32_bf16 v[248:251], a[80:83], a[36:39], v[248:251]
v_mfma_f32_16x16x32_bf16 v[212:215], a[104:107], a[32:35], v[212:215]
v_mfma_f32_16x16x32_bf16 v[204:207], a[104:107], a[28:31], v[204:207]
v_mfma_f32_16x16x32_bf16 v[196:199], a[104:107], a[24:27], v[196:199]
v_mfma_f32_16x16x32_bf16 v[188:191], a[104:107], a[20:23], v[188:191]
v_mfma_f32_16x16x32_bf16 v[216:219], a[20:23], a[108:111], v[216:219]
v_mfma_f32_16x16x32_bf16 v[224:227], a[24:27], a[108:111], v[224:227]
v_mfma_f32_16x16x32_bf16 v[232:235], a[28:31], a[108:111], v[232:235]
v_mfma_f32_16x16x32_bf16 v[240:243], a[32:35], a[108:111], v[240:243]
v_mfma_f32_16x16x32_bf16 v[252:255], a[36:39], a[108:111], v[252:255]
v_mfma_f32_16x16x32_bf16 v[244:247], a[32:35], a[112:115], v[244:247]
v_mfma_f32_16x16x32_bf16 v[236:239], a[28:31], a[112:115], v[236:239]
v_mfma_f32_16x16x32_bf16 v[228:231], a[24:27], a[112:115], v[228:231]
v_mfma_f32_16x16x32_bf16 v[220:223], a[20:23], a[112:115], v[220:223]
s_lshl_b32 s8, s4, 11
s_add_u32 s9, s8, 65536
v_add_u32 v17, s9, v16
s_sub_u32 s9, 79872, s8
s_waitcnt vmcnt(0)
v_add_u32 v18, s9, v16
s_lshr_b32 s8, s4, 1
s_lshl_b32 s8, s8, 14
s_and_b32 s9, s4, 1
s_lshl_b32 s9, s9, 3
s_add_u32 s8, s8, s9
s_add_u32 s8, s8, 65536
v_add_u32 v19, s8, v16
v_cvt_pk_bf16_f32 v248, v248, v249
v_cvt_pk_bf16_f32 v249, v250, v251
v_cvt_pk_bf16_f32 v250, v252, v253
v_cvt_pk_bf16_f32 v251, v254, v255
ds_write_b64 v19, v[248:249]
ds_write_b64 v19, v[250:251] offset:1024
s_bitcmp1_b32 s4, 0
s_cbranch_scc1 L_bx_odd
v_cvt_pk_bf16_f32 v184, v184, v185
v_cvt_pk_bf16_f32 v185, v186, v187
v_cvt_pk_bf16_f32 v186, v188, v189
v_cvt_pk_bf16_f32 v187, v190, v191
v_cvt_pk_bf16_f32 v192, v192, v193
v_cvt_pk_bf16_f32 v193, v194, v195
v_cvt_pk_bf16_f32 v194, v196, v197
v_cvt_pk_bf16_f32 v195, v198, v199
v_cvt_pk_bf16_f32 v200, v200, v201
v_cvt_pk_bf16_f32 v201, v202, v203
v_cvt_pk_bf16_f32 v202, v204, v205
v_cvt_pk_bf16_f32 v203, v206, v207
v_cvt_pk_bf16_f32 v208, v208, v209
v_cvt_pk_bf16_f32 v209, v210, v211
v_cvt_pk_bf16_f32 v210, v212, v213
v_cvt_pk_bf16_f32 v211, v214, v215
v_cvt_pk_bf16_f32 v216, v216, v217
v_cvt_pk_bf16_f32 v217, v218, v219
v_cvt_pk_bf16_f32 v218, v220, v221
v_cvt_pk_bf16_f32 v219, v222, v223
v_cvt_pk_bf16_f32 v224, v224, v225
v_cvt_pk_bf16_f32 v225, v226, v227
v_cvt_pk_bf16_f32 v226, v228, v229
v_cvt_pk_bf16_f32 v227, v230, v231
v_cvt_pk_bf16_f32 v232, v232, v233
v_cvt_pk_bf16_f32 v233, v234, v235
v_cvt_pk_bf16_f32 v234, v236, v237
v_cvt_pk_bf16_f32 v235, v238, v239
v_cvt_pk_bf16_f32 v240, v240, v241
v_cvt_pk_bf16_f32 v241, v242, v243
v_cvt_pk_bf16_f32 v242, v244, v245
v_cvt_pk_bf16_f32 v243, v246, v247
v_cvt_pk_bf16_f32 v152, v152, v153
v_cvt_pk_bf16_f32 v153, v154, v155
v_cvt_pk_bf16_f32 v154, v156, v157
v_cvt_pk_bf16_f32 v155, v158, v159
v_cvt_pk_bf16_f32 v160, v160, v161
v_cvt_pk_bf16_f32 v161, v162, v163
v_cvt_pk_bf16_f32 v162, v164, v165
v_cvt_pk_bf16_f32 v163, v166, v167
v_cvt_pk_bf16_f32 v168, v168, v169
v_cvt_pk_bf16_f32 v169, v170, v171
v_cvt_pk_bf16_f32 v170, v172, v173
v_cvt_pk_bf16_f32 v171, v174, v175
v_cvt_pk_bf16_f32 v176, v176, v177
v_cvt_pk_bf16_f32 v177, v178, v179
v_cvt_pk_bf16_f32 v178, v180, v181
v_cvt_pk_bf16_f32 v179, v182, v183
s_branch L_bx_packed
L_bx_odd:
v_cvt_pk_bf16_f32 v187, v186, v187
v_cvt_pk_bf16_f32 v186, v184, v185
v_cvt_pk_bf16_f32 v184, v188, v189
v_cvt_pk_bf16_f32 v185, v190, v191
v_cvt_pk_bf16_f32 v195, v194, v195
v_cvt_pk_bf16_f32 v194, v192, v193
v_cvt_pk_bf16_f32 v192, v196, v197
v_cvt_pk_bf16_f32 v193, v198, v199
v_cvt_pk_bf16_f32 v203, v202, v203
v_cvt_pk_bf16_f32 v202, v200, v201
v_cvt_pk_bf16_f32 v200, v204, v205
v_cvt_pk_bf16_f32 v201, v206, v207
v_cvt_pk_bf16_f32 v211, v210, v211
v_cvt_pk_bf16_f32 v210, v208, v209
v_cvt_pk_bf16_f32 v208, v212, v213
v_cvt_pk_bf16_f32 v209, v214, v215
v_cvt_pk_bf16_f32 v219, v218, v219
v_cvt_pk_bf16_f32 v218, v216, v217
v_cvt_pk_bf16_f32 v216, v220, v221
v_cvt_pk_bf16_f32 v217, v222, v223
v_cvt_pk_bf16_f32 v227, v226, v227
v_cvt_pk_bf16_f32 v226, v224, v225
v_cvt_pk_bf16_f32 v224, v228, v229
v_cvt_pk_bf16_f32 v225, v230, v231
v_cvt_pk_bf16_f32 v235, v234, v235
v_cvt_pk_bf16_f32 v234, v232, v233
v_cvt_pk_bf16_f32 v232, v236, v237
v_cvt_pk_bf16_f32 v233, v238, v239
v_cvt_pk_bf16_f32 v243, v242, v243
v_cvt_pk_bf16_f32 v242, v240, v241
v_cvt_pk_bf16_f32 v240, v244, v245
v_cvt_pk_bf16_f32 v241, v246, v247
v_cvt_pk_bf16_f32 v155, v154, v155
v_cvt_pk_bf16_f32 v154, v152, v153
v_cvt_pk_bf16_f32 v152, v156, v157
v_cvt_pk_bf16_f32 v153, v158, v159
v_cvt_pk_bf16_f32 v163, v162, v163
v_cvt_pk_bf16_f32 v162, v160, v161
v_cvt_pk_bf16_f32 v160, v164, v165
v_cvt_pk_bf16_f32 v161, v166, v167
v_cvt_pk_bf16_f32 v171, v170, v171
v_cvt_pk_bf16_f32 v170, v168, v169
v_cvt_pk_bf16_f32 v168, v172, v173
v_cvt_pk_bf16_f32 v169, v174, v175
v_cvt_pk_bf16_f32 v179, v178, v179
v_cvt_pk_bf16_f32 v178, v176, v177
v_cvt_pk_bf16_f32 v176, v180, v181
v_cvt_pk_bf16_f32 v177, v182, v183
L_bx_packed:
ds_write_b128 v17, v[184:187] offset:2048
ds_write_b128 v17, v[216:219] offset:3072
ds_write_b128 v17, v[200:203] offset:18432
ds_write_b128 v17, v[232:235] offset:19456
s_cmp_eq_u32 s4, 0
s_cbranch_scc1 L_bx_skip
ds_write_b128 v18, v[192:195] offset:2048
ds_write_b128 v18, v[224:227] offset:3072
ds_write_b128 v18, v[208:211] offset:18432
ds_write_b128 v18, v[240:243] offset:19456
L_bx_skip:
s_mov_b32 s8, 0x3e0293ee
s_mov_b32 s9, 0x3e0293ee
s_lshl_b32 s10, s2, 2
s_add_u32 s10, s10, s4
s_lshl_b32 s10, s10, 12
s_add_u32 s10, s10, 0x3800000
buffer_store_dwordx4 a[116:119], v16, s[88:91], s10 offen offset:0 sc1
v_pk_mul_f32 v[24:25], v[24:25], s[8:9]
v_pk_mul_f32 v[26:27], v[26:27], s[8:9]
v_pk_mul_f32 v[28:29], v[28:29], s[8:9]
v_pk_mul_f32 v[30:31], v[30:31], s[8:9]
v_cvt_pk_bf16_f32 v24, v24, v25
v_cvt_pk_bf16_f32 v25, v26, v27
v_cvt_pk_bf16_f32 v26, v28, v29
v_cvt_pk_bf16_f32 v27, v30, v31
v_accvgpr_write_b32 a160, v24
v_accvgpr_write_b32 a161, v25
v_accvgpr_write_b32 a162, v26
v_accvgpr_write_b32 a163, v27
v_pk_mul_f32 v[32:33], v[32:33], s[8:9]
v_pk_mul_f32 v[34:35], v[34:35], s[8:9]
v_pk_mul_f32 v[36:37], v[36:37], s[8:9]
v_pk_mul_f32 v[38:39], v[38:39], s[8:9]
v_cvt_pk_bf16_f32 v32, v32, v33
v_cvt_pk_bf16_f32 v33, v34, v35
v_cvt_pk_bf16_f32 v34, v36, v37
v_cvt_pk_bf16_f32 v35, v38, v39
v_accvgpr_write_b32 a164, v32
v_accvgpr_write_b32 a165, v33
v_accvgpr_write_b32 a166, v34
v_accvgpr_write_b32 a167, v35
v_pk_mul_f32 v[40:41], v[40:41], s[8:9]
v_pk_mul_f32 v[42:43], v[42:43], s[8:9]
v_pk_mul_f32 v[44:45], v[44:45], s[8:9]
v_pk_mul_f32 v[46:47], v[46:47], s[8:9]
v_cvt_pk_bf16_f32 v40, v40, v41
v_cvt_pk_bf16_f32 v41, v42, v43
v_cvt_pk_bf16_f32 v42, v44, v45
v_cvt_pk_bf16_f32 v43, v46, v47
v_accvgpr_write_b32 a168, v40
v_accvgpr_write_b32 a169, v41
v_accvgpr_write_b32 a170, v42
v_accvgpr_write_b32 a171, v43
v_pk_mul_f32 v[48:49], v[48:49], s[8:9]
v_pk_mul_f32 v[50:51], v[50:51], s[8:9]
v_pk_mul_f32 v[52:53], v[52:53], s[8:9]
v_pk_mul_f32 v[54:55], v[54:55], s[8:9]
v_cvt_pk_bf16_f32 v48, v48, v49
v_cvt_pk_bf16_f32 v49, v50, v51
v_cvt_pk_bf16_f32 v50, v52, v53
v_cvt_pk_bf16_f32 v51, v54, v55
v_accvgpr_write_b32 a172, v48
v_accvgpr_write_b32 a173, v49
v_accvgpr_write_b32 a174, v50
v_accvgpr_write_b32 a175, v51
buffer_store_dwordx4 a[116:119], v16, s[88:91], s10 offen offset:1024 sc1
v_pk_mul_f32 v[56:57], v[56:57], s[8:9]
v_pk_mul_f32 v[58:59], v[58:59], s[8:9]
v_pk_mul_f32 v[60:61], v[60:61], s[8:9]
v_pk_mul_f32 v[62:63], v[62:63], s[8:9]
v_cvt_pk_bf16_f32 v56, v56, v57
v_cvt_pk_bf16_f32 v57, v58, v59
v_cvt_pk_bf16_f32 v58, v60, v61
v_cvt_pk_bf16_f32 v59, v62, v63
v_accvgpr_write_b32 a176, v56
v_accvgpr_write_b32 a177, v57
v_accvgpr_write_b32 a178, v58
v_accvgpr_write_b32 a179, v59
v_pk_mul_f32 v[64:65], v[64:65], s[8:9]
v_pk_mul_f32 v[66:67], v[66:67], s[8:9]
v_pk_mul_f32 v[68:69], v[68:69], s[8:9]
v_pk_mul_f32 v[70:71], v[70:71], s[8:9]
v_cvt_pk_bf16_f32 v64, v64, v65
v_cvt_pk_bf16_f32 v65, v66, v67
v_cvt_pk_bf16_f32 v66, v68, v69
v_cvt_pk_bf16_f32 v67, v70, v71
v_accvgpr_write_b32 a180, v64
v_accvgpr_write_b32 a181, v65
v_accvgpr_write_b32 a182, v66
v_accvgpr_write_b32 a183, v67
v_pk_mul_f32 v[72:73], v[72:73], s[8:9]
v_pk_mul_f32 v[74:75], v[74:75], s[8:9]
v_pk_mul_f32 v[76:77], v[76:77], s[8:9]
v_pk_mul_f32 v[78:79], v[78:79], s[8:9]
v_cvt_pk_bf16_f32 v72, v72, v73
v_cvt_pk_bf16_f32 v73, v74, v75
v_cvt_pk_bf16_f32 v74, v76, v77
v_cvt_pk_bf16_f32 v75, v78, v79
v_accvgpr_write_b32 a184, v72
v_accvgpr_write_b32 a185, v73
v_accvgpr_write_b32 a186, v74
v_accvgpr_write_b32 a187, v75
v_pk_mul_f32 v[80:81], v[80:81], s[8:9]
v_pk_mul_f32 v[82:83], v[82:83], s[8:9]
v_pk_mul_f32 v[84:85], v[84:85], s[8:9]
v_pk_mul_f32 v[86:87], v[86:87], s[8:9]
v_cvt_pk_bf16_f32 v80, v80, v81
v_cvt_pk_bf16_f32 v81, v82, v83
v_cvt_pk_bf16_f32 v82, v84, v85
v_cvt_pk_bf16_f32 v83, v86, v87
v_accvgpr_write_b32 a188, v80
v_accvgpr_write_b32 a189, v81
v_accvgpr_write_b32 a190, v82
v_accvgpr_write_b32 a191, v83
buffer_store_dwordx4 a[116:119], v16, s[88:91], s10 offen offset:2048 sc1
v_pk_mul_f32 v[88:89], v[88:89], s[8:9]
v_pk_mul_f32 v[90:91], v[90:91], s[8:9]
v_pk_mul_f32 v[92:93], v[92:93], s[8:9]
v_pk_mul_f32 v[94:95], v[94:95], s[8:9]
v_cvt_pk_bf16_f32 v88, v88, v89
v_cvt_pk_bf16_f32 v89, v90, v91
v_cvt_pk_bf16_f32 v90, v92, v93
v_cvt_pk_bf16_f32 v91, v94, v95
v_accvgpr_write_b32 a192, v88
v_accvgpr_write_b32 a193, v89
v_accvgpr_write_b32 a194, v90
v_accvgpr_write_b32 a195, v91
v_pk_mul_f32 v[96:97], v[96:97], s[8:9]
v_pk_mul_f32 v[98:99], v[98:99], s[8:9]
v_pk_mul_f32 v[100:101], v[100:101], s[8:9]
v_pk_mul_f32 v[102:103], v[102:103], s[8:9]
v_cvt_pk_bf16_f32 v96, v96, v97
v_cvt_pk_bf16_f32 v97, v98, v99
v_cvt_pk_bf16_f32 v98, v100, v101
v_cvt_pk_bf16_f32 v99, v102, v103
v_accvgpr_write_b32 a196, v96
v_accvgpr_write_b32 a197, v97
v_accvgpr_write_b32 a198, v98
v_accvgpr_write_b32 a199, v99
v_pk_mul_f32 v[104:105], v[104:105], s[8:9]
v_pk_mul_f32 v[106:107], v[106:107], s[8:9]
v_pk_mul_f32 v[108:109], v[108:109], s[8:9]
v_pk_mul_f32 v[110:111], v[110:111], s[8:9]
v_cvt_pk_bf16_f32 v104, v104, v105
v_cvt_pk_bf16_f32 v105, v106, v107
v_cvt_pk_bf16_f32 v106, v108, v109
v_cvt_pk_bf16_f32 v107, v110, v111
v_accvgpr_write_b32 a200, v104
v_accvgpr_write_b32 a201, v105
v_accvgpr_write_b32 a202, v106
v_accvgpr_write_b32 a203, v107
v_pk_mul_f32 v[112:113], v[112:113], s[8:9]
v_pk_mul_f32 v[114:115], v[114:115], s[8:9]
v_pk_mul_f32 v[116:117], v[116:117], s[8:9]
v_pk_mul_f32 v[118:119], v[118:119], s[8:9]
v_cvt_pk_bf16_f32 v112, v112, v113
v_cvt_pk_bf16_f32 v113, v114, v115
v_cvt_pk_bf16_f32 v114, v116, v117
v_cvt_pk_bf16_f32 v115, v118, v119
v_accvgpr_write_b32 a204, v112
v_accvgpr_write_b32 a205, v113
v_accvgpr_write_b32 a206, v114
v_accvgpr_write_b32 a207, v115
buffer_store_dwordx4 a[116:119], v16, s[88:91], s10 offen offset:3072 sc1
v_pk_mul_f32 v[120:121], v[120:121], s[8:9]
v_pk_mul_f32 v[122:123], v[122:123], s[8:9]
v_pk_mul_f32 v[124:125], v[124:125], s[8:9]
v_pk_mul_f32 v[126:127], v[126:127], s[8:9]
v_cvt_pk_bf16_f32 v120, v120, v121
v_cvt_pk_bf16_f32 v121, v122, v123
v_cvt_pk_bf16_f32 v122, v124, v125
v_cvt_pk_bf16_f32 v123, v126, v127
v_accvgpr_write_b32 a208, v120
v_accvgpr_write_b32 a209, v121
v_accvgpr_write_b32 a210, v122
v_accvgpr_write_b32 a211, v123
v_pk_mul_f32 v[128:129], v[128:129], s[8:9]
v_pk_mul_f32 v[130:131], v[130:131], s[8:9]
v_pk_mul_f32 v[132:133], v[132:133], s[8:9]
v_pk_mul_f32 v[134:135], v[134:135], s[8:9]
v_cvt_pk_bf16_f32 v128, v128, v129
v_cvt_pk_bf16_f32 v129, v130, v131
v_cvt_pk_bf16_f32 v130, v132, v133
v_cvt_pk_bf16_f32 v131, v134, v135
v_accvgpr_write_b32 a212, v128
v_accvgpr_write_b32 a213, v129
v_accvgpr_write_b32 a214, v130
v_accvgpr_write_b32 a215, v131
v_pk_mul_f32 v[136:137], v[136:137], s[8:9]
v_pk_mul_f32 v[138:139], v[138:139], s[8:9]
v_pk_mul_f32 v[140:141], v[140:141], s[8:9]
v_pk_mul_f32 v[142:143], v[142:143], s[8:9]
v_cvt_pk_bf16_f32 v136, v136, v137
v_cvt_pk_bf16_f32 v137, v138, v139
v_cvt_pk_bf16_f32 v138, v140, v141
v_cvt_pk_bf16_f32 v139, v142, v143
v_accvgpr_write_b32 a216, v136
v_accvgpr_write_b32 a217, v137
v_accvgpr_write_b32 a218, v138
v_accvgpr_write_b32 a219, v139
v_pk_mul_f32 v[144:145], v[144:145], s[8:9]
v_pk_mul_f32 v[146:147], v[146:147], s[8:9]
v_pk_mul_f32 v[148:149], v[148:149], s[8:9]
v_pk_mul_f32 v[150:151], v[150:151], s[8:9]
v_cvt_pk_bf16_f32 v144, v144, v145
v_cvt_pk_bf16_f32 v145, v146, v147
v_cvt_pk_bf16_f32 v146, v148, v149
v_cvt_pk_bf16_f32 v147, v150, v151
v_accvgpr_write_b32 a220, v144
v_accvgpr_write_b32 a221, v145
v_accvgpr_write_b32 a222, v146
v_accvgpr_write_b32 a223, v147
s_waitcnt lgkmcnt(0)
s_barrier
ds_read_b128 v[188:191], v17 offset:0
ds_read_b64 v[24:25], v17 offset:1024
ds_read_b64 v[28:29], v17 offset:1032
ds_read_b128 v[196:199], v18 offset:0
ds_read_b64 v[32:33], v18 offset:1024
ds_read_b64 v[36:37], v18 offset:1032
ds_read_b128 v[204:207], v17 offset:16384
ds_read_b64 v[40:41], v17 offset:17408
ds_read_b64 v[44:45], v17 offset:17416
ds_read_b128 v[212:215], v18 offset:16384
ds_read_b64 v[48:49], v18 offset:17408
ds_read_b64 v[52:53], v18 offset:17416
v_and_b32 v104, 15, v0
v_lshrrev_b32 v105, 4, v0
v_lshlrev_b32 v105, 2, v105
v_sub_u32 v104, v104, v105
v_mov_b32 v107, 0xf149f2ca
s_or_b32 s8, s6, s4
s_cmp_eq_u32 s8, 0
s_cselect_b32 s8, 0xf149f2ca, 0
v_add_u32 v105, 16, v104
v_and_b32 v105, 0xfffffff1, v105
v_cmp_eq_u32 s[36:37], 0, v105
v_add_u32 v105, 15, v104
v_and_b32 v105, 0xfffffff1, v105
v_cmp_eq_u32 s[38:39], 0, v105
v_add_u32 v105, 14, v104
v_and_b32 v105, 0xfffffff1, v105
v_cmp_eq_u32 s[40:41], 0, v105
v_add_u32 v105, 13, v104
v_and_b32 v105, 0xfffffff1, v105
v_cmp_eq_u32 s[42:43], 0, v105
s_nop 1
v_cndmask_b32 v92, v107, 0, s[36:37]
v_cndmask_b32 v93, v107, 0, s[38:39]
v_cndmask_b32 v94, v107, 0, s[40:41]
v_cndmask_b32 v95, v107, 0, s[42:43]
v_add_u32 v105, 0, v104
v_and_b32 v105, 0xfffffff1, v105
v_cmp_eq_u32 s[36:37], 0, v105
v_add_u32 v105, -1, v104
v_and_b32 v105, 0xfffffff1, v105
v_cmp_eq_u32 s[38:39], 0, v105
v_add_u32 v105, -2, v104
v_and_b32 v105, 0xfffffff1, v105
v_cmp_eq_u32 s[40:41], 0, v105
v_add_u32 v105, -3, v104
v_and_b32 v105, 0xfffffff1, v105
v_cmp_eq_u32 s[42:43], 0, v105
s_nop 1
v_cndmask_b32 v96, v107, 0, s[36:37]
v_cndmask_b32 v97, v107, 0, s[38:39]
v_cndmask_b32 v98, v107, 0, s[40:41]
v_cndmask_b32 v99, v107, 0, s[42:43]
v_min_f32 v88, s8, v92
v_mov_b32 v140, 0x3f803f80
v_min_f32 v89, s8, v93
v_mov_b32 v141, 0x3f803f80
v_min_f32 v90, s8, v94
v_mov_b32 v142, 0x3f803f80
v_min_f32 v91, s8, v95
v_mov_b32 v143, 0x3f803f80
v_mov_b32 v26, v216
v_mov_b32 v27, v217
v_mov_b32 v30, v218
v_mov_b32 v31, v219
v_mov_b32 v34, v224
v_mov_b32 v35, v225
v_mov_b32 v38, v226
v_mov_b32 v39, v227
v_mov_b32 v42, v232
v_mov_b32 v43, v233
v_mov_b32 v46, v234
v_mov_b32 v47, v235
v_mov_b32 v50, v240
v_mov_b32 v51, v241
v_mov_b32 v54, v242
v_mov_b32 v55, v243
v_mfma_f32_16x16x32_bf16 v[60:63], v[184:187], v[152:155], v[96:99]
v_mfma_f32_16x16x32_bf16 v[68:71], v[192:195], v[160:163], v[96:99]
v_mfma_f32_16x16x32_bf16 v[76:79], v[200:203], v[168:171], v[96:99]
v_mfma_f32_16x16x32_bf16 v[84:87], v[208:211], v[176:179], v[96:99]
s_waitcnt lgkmcnt(11)
v_mfma_f32_16x16x32_bf16 v[56:59], v[188:191], v[152:155], v[88:91]
s_waitcnt lgkmcnt(8)
v_mfma_f32_16x16x32_bf16 v[64:67], v[196:199], v[160:163], v[92:95]
s_waitcnt lgkmcnt(5)
v_mfma_f32_16x16x32_bf16 v[72:75], v[204:207], v[168:171], v[92:95]
s_waitcnt lgkmcnt(2)
v_mfma_f32_16x16x32_bf16 v[80:83], v[212:215], v[176:179], v[92:95]
s_mov_b32 s8, 0x3e8293ee
s_mul_i32 s9, s6, 0x140000
s_sub_u32 s10, 0x12c0000, s9
s_lshl_b32 s11, s5, 13
s_add_u32 s11, s11, 0x2200000
s_add_u32 s9, s9, s11
s_add_u32 s10, s10, s11
s_lshl_b32 s11, s4, 10
s_add_u32 s28, s9, s11
s_add_u32 s30, s10, s11
s_sub_u32 s11, 0x1c00, s11
s_add_u32 s29, s9, s11
s_add_u32 s31, s10, s11
v_max3_f32 v100, v56, v57, v58
v_max3_f32 v100, v100, v59, v60
v_max3_f32 v100, v100, v61, v62
v_max_f32 v100, v100, v63
v_max3_f32 v101, v64, v65, v66
v_max3_f32 v101, v101, v67, v68
v_max3_f32 v101, v101, v69, v70
v_max_f32 v101, v101, v71
v_max3_f32 v102, v72, v73, v74
v_max3_f32 v102, v102, v75, v76
v_max3_f32 v102, v102, v77, v78
v_max_f32 v102, v102, v79
v_max3_f32 v103, v80, v81, v82
v_max3_f32 v103, v103, v83, v84
v_max3_f32 v103, v103, v85, v86
v_max_f32 v103, v103, v87
v_mov_b32 v104, v100
v_mov_b32 v105, v101
v_mov_b32 v106, v102
v_mov_b32 v107, v103
s_nop 1
v_permlane16_swap_b32 v104, v100
v_permlane16_swap_b32 v105, v101
v_permlane16_swap_b32 v106, v102
v_permlane16_swap_b32 v107, v103
v_max_f32 v100, v100, v104
v_max_f32 v101, v101, v105
v_max_f32 v102, v102, v106
v_max_f32 v103, v103, v107
v_mov_b32 v104, v100
v_mov_b32 v105, v101
v_mov_b32 v106, v102
v_mov_b32 v107, v103
s_nop 1
v_permlane32_swap_b32 v104, v100
v_permlane32_swap_b32 v105, v101
v_permlane32_swap_b32 v106, v102
v_permlane32_swap_b32 v107, v103
v_max_f32 v100, v100, v104
v_max_f32 v101, v101, v105
v_max_f32 v102, v102, v106
v_max_f32 v103, v103, v107
v_mul_f32 v100, s8, v100
v_mul_f32 v101, s8, v101
v_mul_f32 v102, s8, v102
v_mul_f32 v103, s8, v103
v_fma_f32 v56, v56, s8, -v100
v_fma_f32 v57, v57, s8, -v100
v_fma_f32 v58, v58, s8, -v100
v_fma_f32 v59, v59, s8, -v100
v_fma_f32 v60, v60, s8, -v100
v_fma_f32 v61, v61, s8, -v100
v_fma_f32 v62, v62, s8, -v100
v_fma_f32 v63, v63, s8, -v100
v_exp_f32 v56, v56
v_exp_f32 v57, v57
v_exp_f32 v58, v58
v_exp_f32 v59, v59
v_exp_f32 v60, v60
v_exp_f32 v61, v61
v_exp_f32 v62, v62
v_exp_f32 v63, v63
v_fma_f32 v64, v64, s8, -v101
v_fma_f32 v65, v65, s8, -v101
v_fma_f32 v66, v66, s8, -v101
v_fma_f32 v67, v67, s8, -v101
v_fma_f32 v68, v68, s8, -v101
v_fma_f32 v69, v69, s8, -v101
v_fma_f32 v70, v70, s8, -v101
v_fma_f32 v71, v71, s8, -v101
v_exp_f32 v64, v64
v_exp_f32 v65, v65
v_exp_f32 v66, v66
v_exp_f32 v67, v67
v_exp_f32 v68, v68
v_exp_f32 v69, v69
v_exp_f32 v70, v70
v_exp_f32 v71, v71
v_fma_f32 v72, v72, s8, -v102
v_fma_f32 v73, v73, s8, -v102
v_fma_f32 v74, v74, s8, -v102
v_fma_f32 v75, v75, s8, -v102
v_fma_f32 v76, v76, s8, -v102
v_fma_f32 v77, v77, s8, -v102
v_fma_f32 v78, v78, s8, -v102
v_fma_f32 v79, v79, s8, -v102
v_exp_f32 v72, v72
v_exp_f32 v73, v73
v_exp_f32 v74, v74
v_exp_f32 v75, v75
v_exp_f32 v76, v76
v_exp_f32 v77, v77
v_exp_f32 v78, v78
v_exp_f32 v79, v79
v_fma_f32 v80, v80, s8, -v103
v_fma_f32 v81, v81, s8, -v103
v_fma_f32 v82, v82, s8, -v103
v_fma_f32 v83, v83, s8, -v103
v_fma_f32 v84, v84, s8, -v103
v_fma_f32 v85, v85, s8, -v103
v_fma_f32 v86, v86, s8, -v103
v_fma_f32 v87, v87, s8, -v103
v_exp_f32 v80, v80
v_exp_f32 v81, v81
v_exp_f32 v82, v82
v_exp_f32 v83, v83
v_exp_f32 v84, v84
v_exp_f32 v85, v85
v_exp_f32 v86, v86
v_exp_f32 v87, v87
v_cvt_pk_bf16_f32 v56, v56, v57
v_cvt_pk_bf16_f32 v57, v58, v59
v_cvt_pk_bf16_f32 v58, v60, v61
v_cvt_pk_bf16_f32 v59, v62, v63
v_cvt_pk_bf16_f32 v64, v64, v65
v_cvt_pk_bf16_f32 v65, v66, v67
v_cvt_pk_bf16_f32 v66, v68, v69
v_cvt_pk_bf16_f32 v67, v70, v71
v_cvt_pk_bf16_f32 v72, v72, v73
v_cvt_pk_bf16_f32 v73, v74, v75
v_cvt_pk_bf16_f32 v74, v76, v77
v_cvt_pk_bf16_f32 v75, v78, v79
v_cvt_pk_bf16_f32 v80, v80, v81
v_cvt_pk_bf16_f32 v81, v82, v83
v_cvt_pk_bf16_f32 v82, v84, v85
v_cvt_pk_bf16_f32 v83, v86, v87
s_nop 0
v_mfma_f32_16x16x32_bf16 v[156:159], v[140:143], v[56:59], 0
v_mfma_f32_16x16x32_bf16 v[164:167], v[140:143], v[64:67], 0
v_mfma_f32_16x16x32_bf16 v[172:175], v[140:143], v[72:75], 0
v_mfma_f32_16x16x32_bf16 v[180:183], v[140:143], v[80:83], 0
v_mfma_f32_16x16x32_bf16 v[108:111], v[24:27], v[56:59], 0
v_mfma_f32_16x16x32_bf16 v[112:115], v[28:31], v[56:59], 0
v_mfma_f32_16x16x32_bf16 v[116:119], v[32:35], v[64:67], 0
v_mfma_f32_16x16x32_bf16 v[120:123], v[36:39], v[64:67], 0
v_mfma_f32_16x16x32_bf16 v[124:127], v[40:43], v[72:75], 0
v_mfma_f32_16x16x32_bf16 v[128:131], v[44:47], v[72:75], 0
s_waitcnt lgkmcnt(1)
v_mfma_f32_16x16x32_bf16 v[132:135], v[48:51], v[80:83], 0
s_waitcnt lgkmcnt(0)
v_mfma_f32_16x16x32_bf16 v[136:139], v[52:55], v[80:83], 0
v_rcp_f32 v100, v156
v_rcp_f32 v101, v164
v_rcp_f32 v102, v172
v_rcp_f32 v103, v180
s_nop 3
v_mul_f32 v108, v100, v108
v_mul_f32 v109, v100, v109
v_mul_f32 v110, v100, v110
v_mul_f32 v111, v100, v111
v_mul_f32 v112, v100, v112
v_mul_f32 v113, v100, v113
v_mul_f32 v114, v100, v114
v_mul_f32 v115, v100, v115
v_cvt_pk_bf16_f32 v108, v108, v109
v_cvt_pk_bf16_f32 v109, v110, v111
v_cvt_pk_bf16_f32 v110, v112, v113
v_cvt_pk_bf16_f32 v111, v114, v115
buffer_store_dwordx4 v[108:111], v16, s[88:91], s28 offen sc1
v_mul_f32 v116, v101, v116
v_mul_f32 v117, v101, v117
v_mul_f32 v118, v101, v118
v_mul_f32 v119, v101, v119
v_mul_f32 v120, v101, v120
v_mul_f32 v121, v101, v121
v_mul_f32 v122, v101, v122
v_mul_f32 v123, v101, v123
v_cvt_pk_bf16_f32 v116, v116, v117
v_cvt_pk_bf16_f32 v117, v118, v119
v_cvt_pk_bf16_f32 v118, v120, v121
v_cvt_pk_bf16_f32 v119, v122, v123
buffer_store_dwordx4 v[116:119], v16, s[88:91], s29 offen sc1
v_mul_f32 v124, v102, v124
v_mul_f32 v125, v102, v125
v_mul_f32 v126, v102, v126
v_mul_f32 v127, v102, v127
v_mul_f32 v128, v102, v128
v_mul_f32 v129, v102, v129
v_mul_f32 v130, v102, v130
v_mul_f32 v131, v102, v131
v_cvt_pk_bf16_f32 v124, v124, v125
v_cvt_pk_bf16_f32 v125, v126, v127
v_cvt_pk_bf16_f32 v126, v128, v129
v_cvt_pk_bf16_f32 v127, v130, v131
buffer_store_dwordx4 v[124:127], v16, s[88:91], s30 offen sc1
v_mul_f32 v132, v103, v132
v_mul_f32 v133, v103, v133
v_mul_f32 v134, v103, v134
v_mul_f32 v135, v103, v135
v_mul_f32 v136, v103, v136
v_mul_f32 v137, v103, v137
v_mul_f32 v138, v103, v138
v_mul_f32 v139, v103, v139
v_cvt_pk_bf16_f32 v132, v132, v133
v_cvt_pk_bf16_f32 v133, v134, v135
v_cvt_pk_bf16_f32 v134, v136, v137
v_cvt_pk_bf16_f32 v135, v138, v139
buffer_store_dwordx4 v[132:135], v16, s[88:91], s31 offen sc1
s_mul_i32 s8, s5, 0x6000
s_add_u32 s8, s8, 0x40000
s_add_u32 s28, s28, s8
s_add_u32 s29, s29, s8
s_add_u32 s30, s30, s8
s_add_u32 s31, s31, s8
v_mov_b32 v3, v16
s_mov_b32 s33, 0
L_att_start:
s_mov_b64 s[34:35], 0
v_mov_b32 v1, v3
v_add_u32 v2, 98304, v3
v_mov_b32 v4, 0x3f803f80
v_accvgpr_write_b32 a240, v4
v_accvgpr_write_b32 a241, v4
v_accvgpr_write_b32 a242, v4
v_accvgpr_write_b32 a243, v4
v_accvgpr_write_b32 a224, 0
v_accvgpr_write_b32 a225, 0
v_accvgpr_write_b32 a226, 0
v_accvgpr_write_b32 a227, 0
v_accvgpr_write_b32 a228, 0
v_accvgpr_write_b32 a229, 0
v_accvgpr_write_b32 a230, 0
v_accvgpr_write_b32 a231, 0
v_accvgpr_write_b32 a232, 0
v_accvgpr_write_b32 a233, 0
v_accvgpr_write_b32 a234, 0
v_accvgpr_write_b32 a235, 0
v_accvgpr_write_b32 a236, 0
v_accvgpr_write_b32 a237, 0
v_accvgpr_write_b32 a238, 0
v_accvgpr_write_b32 a239, 0
v_mov_b32 v128, 0
v_mov_b32 v129, 0
v_mov_b32 v130, 0
v_mov_b32 v131, 0
v_mov_b32 v132, 0
v_mov_b32 v133, 0
v_mov_b32 v134, 0
v_mov_b32 v135, 0
v_mov_b32 v136, 0
v_mov_b32 v137, 0
v_mov_b32 v138, 0
v_mov_b32 v139, 0
v_mov_b32 v140, 0
v_mov_b32 v141, 0
v_mov_b32 v142, 0
v_mov_b32 v143, 0
v_mov_b32 v144, 0
v_mov_b32 v145, 0
v_mov_b32 v146, 0
v_mov_b32 v147, 0
v_mov_b32 v148, 0
v_mov_b32 v149, 0
v_mov_b32 v150, 0
v_mov_b32 v151, 0
v_mov_b32 v152, 0
v_mov_b32 v153, 0
v_mov_b32 v154, 0
v_mov_b32 v155, 0
v_mov_b32 v156, 0
v_mov_b32 v157, 0
v_mov_b32 v158, 0
v_mov_b32 v159, 0
v_mov_b32 v160, 0
v_mov_b32 v161, 0
v_mov_b32 v162, 0
v_mov_b32 v163, 0
v_mov_b32 v164, 0
v_mov_b32 v165, 0
v_mov_b32 v166, 0
v_mov_b32 v167, 0
v_mov_b32 v168, 0
v_mov_b32 v169, 0
v_mov_b32 v170, 0
v_mov_b32 v171, 0
v_mov_b32 v172, 0
v_mov_b32 v173, 0
v_mov_b32 v174, 0
v_mov_b32 v175, 0
v_mov_b32 v176, 0
v_mov_b32 v177, 0
v_mov_b32 v178, 0
v_mov_b32 v179, 0
v_mov_b32 v180, 0
v_mov_b32 v181, 0
v_mov_b32 v182, 0
v_mov_b32 v183, 0
v_mov_b32 v184, 0
v_mov_b32 v185, 0
v_mov_b32 v186, 0
v_mov_b32 v187, 0
v_mov_b32 v188, 0
v_mov_b32 v189, 0
v_mov_b32 v190, 0
v_mov_b32 v191, 0
v_mov_b32 v192, 0
v_mov_b32 v193, 0
v_mov_b32 v194, 0
v_mov_b32 v195, 0
v_mov_b32 v196, 0
v_mov_b32 v197, 0
v_mov_b32 v198, 0
v_mov_b32 v199, 0
v_mov_b32 v200, 0
v_mov_b32 v201, 0
v_mov_b32 v202, 0
v_mov_b32 v203, 0
v_mov_b32 v204, 0
v_mov_b32 v205, 0
v_mov_b32 v206, 0
v_mov_b32 v207, 0
v_mov_b32 v208, 0
v_mov_b32 v209, 0
v_mov_b32 v210, 0
v_mov_b32 v211, 0
v_mov_b32 v212, 0
v_mov_b32 v213, 0
v_mov_b32 v214, 0
v_mov_b32 v215, 0
v_mov_b32 v216, 0
v_mov_b32 v217, 0
v_mov_b32 v218, 0
v_mov_b32 v219, 0
v_mov_b32 v220, 0
v_mov_b32 v221, 0
v_mov_b32 v222, 0
v_mov_b32 v223, 0
v_mov_b32 v224, 0
v_mov_b32 v225, 0
v_mov_b32 v226, 0
v_mov_b32 v227, 0
v_mov_b32 v228, 0
v_mov_b32 v229, 0
v_mov_b32 v230, 0
v_mov_b32 v231, 0
v_mov_b32 v232, 0
v_mov_b32 v233, 0
v_mov_b32 v234, 0
v_mov_b32 v235, 0
v_mov_b32 v236, 0
v_mov_b32 v237, 0
v_mov_b32 v238, 0
v_mov_b32 v239, 0
v_mov_b32 v240, 0
v_mov_b32 v241, 0
v_mov_b32 v242, 0
v_mov_b32 v243, 0
v_mov_b32 v244, 0
v_mov_b32 v245, 0
v_mov_b32 v246, 0
v_mov_b32 v247, 0
v_mov_b32 v248, 0
v_mov_b32 v249, 0
v_mov_b32 v250, 0
v_mov_b32 v251, 0
v_mov_b32 v252, 0
v_mov_b32 v253, 0
v_mov_b32 v254, 0
v_mov_b32 v255, 0
v_and_b32 v5, 15, v0
v_lshrrev_b32 v6, 4, v0
v_lshlrev_b32 v6, 2, v6
v_sub_u32 v5, v5, v6
v_mov_b32 v6, 0xf149f2ca
s_or_b32 s8, s6, s4
s_lshl_b32 s8, s8, 4
v_add_u32 v7, s8, v5
v_cmp_le_i32 s[36:37], 0, v7
v_cmp_le_i32 s[38:39], 1, v7
v_cmp_le_i32 s[40:41], 2, v7
v_cmp_le_i32 s[42:43], 3, v7
s_nop 1
v_cndmask_b32 v48, v6, 0, s[36:37]
v_cndmask_b32 v49, v6, 0, s[38:39]
v_cndmask_b32 v50, v6, 0, s[40:41]
v_cndmask_b32 v51, v6, 0, s[42:43]
s_waitcnt vmcnt(25)
s_barrier
ds_read_b128 a[0:3], v1 offset:8192
ds_read_b128 a[4:7], v1 offset:9216
ds_read_b128 a[8:11], v1 offset:10240
ds_read_b128 a[12:15], v1 offset:11264
ds_read_b128 a[16:19], v1 offset:12288
ds_read_b128 a[20:23], v1 offset:13312
ds_read_b128 a[24:27], v1 offset:14336
ds_read_b128 a[28:31], v1 offset:15360
s_cmp_lg_u32 s33, 0
s_cbranch_scc1 L_att_havemax
s_waitcnt lgkmcnt(7)
v_mfma_f32_16x16x32_bf16 v[16:19], a[0:3], a[160:163], v[48:51]
s_waitcnt lgkmcnt(6)
v_mfma_f32_16x16x32_bf16 v[16:19], a[4:7], a[164:167], v[16:19]
s_waitcnt lgkmcnt(5)
v_mfma_f32_16x16x32_bf16 v[16:19], a[8:11], a[168:171], v[16:19]
s_waitcnt lgkmcnt(4)
v_mfma_f32_16x16x32_bf16 v[16:19], a[12:15], a[172:175], v[16:19]
v_mfma_f32_16x16x32_bf16 v[20:23], a[0:3], a[176:179], 0
v_mfma_f32_16x16x32_bf16 v[20:23], a[4:7], a[180:183], v[20:23]
v_mfma_f32_16x16x32_bf16 v[20:23], a[8:11], a[184:187], v[20:23]
v_mfma_f32_16x16x32_bf16 v[20:23], a[12:15], a[188:191], v[20:23]
v_mfma_f32_16x16x32_bf16 v[24:27], a[0:3], a[192:195], 0
v_mfma_f32_16x16x32_bf16 v[24:27], a[4:7], a[196:199], v[24:27]
v_mfma_f32_16x16x32_bf16 v[24:27], a[8:11], a[200:203], v[24:27]
v_mfma_f32_16x16x32_bf16 v[24:27], a[12:15], a[204:207], v[24:27]
v_mfma_f32_16x16x32_bf16 v[28:31], a[0:3], a[208:211], 0
v_mfma_f32_16x16x32_bf16 v[28:31], a[4:7], a[212:215], v[28:31]
v_mfma_f32_16x16x32_bf16 v[28:31], a[8:11], a[216:219], v[28:31]
v_mfma_f32_16x16x32_bf16 v[28:31], a[12:15], a[220:223], v[28:31]
s_nop 7
v_max3_f32 v8, v16, v17, v18
v_max_f32 v8, v8, v19
v_max3_f32 v9, v20, v21, v22
v_max_f32 v9, v9, v23
v_max3_f32 v10, v24, v25, v26
v_max_f32 v10, v10, v27
v_max3_f32 v11, v28, v29, v30
v_max_f32 v11, v11, v31
v_mov_b32 v12, v8
v_mov_b32 v13, v9
v_mov_b32 v14, v10
v_mov_b32 v15, v11
s_nop 1
v_permlane16_swap_b32 v12, v8
v_permlane16_swap_b32 v13, v9
v_permlane16_swap_b32 v14, v10
v_permlane16_swap_b32 v15, v11
v_max_f32 v8, v8, v12
v_max_f32 v9, v9, v13
v_max_f32 v10, v10, v14
v_max_f32 v11, v11, v15
v_mov_b32 v12, v8
v_mov_b32 v13, v9
v_mov_b32 v14, v10
v_mov_b32 v15, v11
s_nop 1
v_permlane32_swap_b32 v12, v8
v_permlane32_swap_b32 v13, v9
v_permlane32_swap_b32 v14, v10
v_permlane32_swap_b32 v15, v11
v_max_f32 v8, v8, v12
v_max_f32 v9, v9, v13
v_max_f32 v10, v10, v14
v_max_f32 v11, v11, v15
L_att_havemax:
v_sub_f32 v80, 0, v8
v_sub_f32 v81, 0, v8
v_sub_f32 v82, 0, v8
v_sub_f32 v83, 0, v8
v_sub_f32 v84, 0, v9
v_sub_f32 v85, 0, v9
v_sub_f32 v86, 0, v9
v_sub_f32 v87, 0, v9
v_sub_f32 v88, 0, v10
v_sub_f32 v89, 0, v10
v_sub_f32 v90, 0, v10
v_sub_f32 v91, 0, v10
v_sub_f32 v92, 0, v11
v_sub_f32 v93, 0, v11
v_sub_f32 v94, 0, v11
v_sub_f32 v95, 0, v11
s_and_b32 s8, s4, 1
s_lshl_b32 s8, s8, 4
v_add_u32 v7, s8, v5
v_cmp_le_i32 s[36:37], 0, v7
v_cmp_le_i32 s[38:39], 1, v7
v_cmp_le_i32 s[40:41], 2, v7
v_cmp_le_i32 s[42:43], 3, v7
s_nop 1
v_cndmask_b32 v96, v6, v80, s[36:37]
v_cndmask_b32 v97, v6, v80, s[38:39]
v_cndmask_b32 v98, v6, v80, s[40:41]
v_cndmask_b32 v99, v6, v80, s[42:43]
v_cndmask_b32 v112, v6, v88, s[36:37]
v_cndmask_b32 v113, v6, v88, s[38:39]
v_cndmask_b32 v114, v6, v88, s[40:41]
v_cndmask_b32 v115, v6, v88, s[42:43]
v_cmp_le_i32 s[36:37], 16, v7
v_cmp_le_i32 s[38:39], 17, v7
v_cmp_le_i32 s[40:41], 18, v7
v_cmp_le_i32 s[42:43], 19, v7
s_nop 1
v_cndmask_b32 v100, v6, v80, s[36:37]
v_cndmask_b32 v101, v6, v80, s[38:39]
v_cndmask_b32 v102, v6, v80, s[40:41]
v_cndmask_b32 v103, v6, v80, s[42:43]
v_cndmask_b32 v116, v6, v88, s[36:37]
v_cndmask_b32 v117, v6, v88, s[38:39]
v_cndmask_b32 v118, v6, v88, s[40:41]
v_cndmask_b32 v119, v6, v88, s[42:43]
s_and_b32 s8, s4, 1
s_xor_b32 s8, s8, 1
s_lshl_b32 s8, s8, 4
v_add_u32 v7, s8, v5
v_cmp_le_i32 s[36:37], 0, v7
v_cmp_le_i32 s[38:39], 1, v7
v_cmp_le_i32 s[40:41], 2, v7
v_cmp_le_i32 s[42:43], 3, v7
s_nop 1
v_cndmask_b32 v104, v6, v84, s[36:37]
v_cndmask_b32 v105, v6, v84, s[38:39]
v_cndmask_b32 v106, v6, v84, s[40:41]
v_cndmask_b32 v107, v6, v84, s[42:43]
v_cndmask_b32 v120, v6, v92, s[36:37]
v_cndmask_b32 v121, v6, v92, s[38:39]
v_cndmask_b32 v122, v6, v92, s[40:41]
v_cndmask_b32 v123, v6, v92, s[42:43]
v_cmp_le_i32 s[36:37], 16, v7
v_cmp_le_i32 s[38:39], 17, v7
v_cmp_le_i32 s[40:41], 18, v7
v_cmp_le_i32 s[42:43], 19, v7
s_nop 1
v_cndmask_b32 v108, v6, v84, s[36:37]
v_cndmask_b32 v109, v6, v84, s[38:39]
v_cndmask_b32 v110, v6, v84, s[40:41]
v_cndmask_b32 v111, v6, v84, s[42:43]
v_cndmask_b32 v124, v6, v92, s[36:37]
v_cndmask_b32 v125, v6, v92, s[38:39]
v_cndmask_b32 v126, v6, v92, s[40:41]
v_cndmask_b32 v127, v6, v92, s[42:43]
s_lshl_b32 s8, s2, 2
s_add_u32 s8, s8, s4
s_lshl_b32 s8, s8, 11
v_lshrrev_b32 v8, 2, v0
v_lshl_add_u32 v8, v8, 7, s8
s_waitcnt lgkmcnt(0)
s_mov_b32 s15, s6
s_cmp_eq_u32 s6, 0
s_cbranch_scc1 L_att_j0
v_mfma_f32_16x16x32_bf16 v[16:19], a[0:3], a[160:163], v[80:83]
v_mfma_f32_16x16x32_bf16 v[16:19], a[4:7], a[164:167], v[16:19]
v_mfma_f32_16x16x32_bf16 v[16:19], a[8:11], a[168:171], v[16:19]
s_add_u32 m0, s27, 0x0
v_mfma_f32_16x16x32_bf16 v[16:19], a[12:15], a[172:175], v[16:19]
buffer_load_dwordx4 v3, s[48:51], s32 offen offset:0 sc1 lds
v_mfma_f32_16x16x32_bf16 v[20:23], a[0:3], a[176:179], v[84:87]
v_mfma_f32_16x16x32_bf16 v[20:23], a[4:7], a[180:183], v[20:23]
v_mfma_f32_16x16x32_bf16 v[20:23], a[8:11], a[184:187], v[20:23]
v_mfma_f32_16x16x32_bf16 v[20:23], a[12:15], a[188:191], v[20:23]
s_nop 2
v_exp_f32 v16, v16
v_mfma_f32_16x16x32_bf16 v[24:27], a[0:3], a[192:195], v[88:91]
s_nop 0
v_exp_f32 v17, v17
v_mfma_f32_16x16x32_bf16 v[24:27], a[4:7], a[196:199], v[24:27]
v_exp_f32 v18, v18
v_mfma_f32_16x16x32_bf16 v[24:27], a[8:11], a[200:203], v[24:27]
v_exp_f32 v19, v19
v_mfma_f32_16x16x32_bf16 v[24:27], a[12:15], a[204:207], v[24:27]
buffer_load_dwordx4 v3, s[48:51], s32 offen offset:1024 sc1 lds
v_mfma_f32_16x16x32_bf16 v[28:31], a[0:3], a[208:211], v[92:95]
v_exp_f32 v20, v20
v_mfma_f32_16x16x32_bf16 v[28:31], a[4:7], a[212:215], v[28:31]
v_cvt_pk_bf16_f32 v48, v16, v17
v_cvt_pk_bf16_f32 v49, v18, v19
v_mfma_f32_16x16x32_bf16 v[28:31], a[8:11], a[216:219], v[28:31]
v_exp_f32 v21, v21
v_mfma_f32_16x16x32_bf16 v[28:31], a[12:15], a[220:223], v[28:31]
v_cvt_pk_bf16_f32 v52, v20, v21
v_mfma_f32_16x16x32_bf16 v[32:35], a[16:19], a[160:163], v[80:83]
v_exp_f32 v22, v22
v_mfma_f32_16x16x32_bf16 v[32:35], a[20:23], a[164:167], v[32:35]
v_mfma_f32_16x16x32_bf16 v[32:35], a[24:27], a[168:171], v[32:35]
buffer_load_dwordx4 v3, s[48:51], s32 offen offset:2048 sc1 lds
v_mfma_f32_16x16x32_bf16 v[32:35], a[28:31], a[172:175], v[32:35]
v_mfma_f32_16x16x32_bf16 v[36:39], a[16:19], a[176:179], v[84:87]
v_exp_f32 v23, v23
v_mfma_f32_16x16x32_bf16 v[36:39], a[20:23], a[180:183], v[36:39]
v_cvt_pk_bf16_f32 v53, v22, v23
v_mfma_f32_16x16x32_bf16 v[36:39], a[24:27], a[184:187], v[36:39]
v_exp_f32 v24, v24
v_mfma_f32_16x16x32_bf16 v[36:39], a[28:31], a[188:191], v[36:39]
v_mfma_f32_16x16x32_bf16 v[40:43], a[16:19], a[192:195], v[88:91]
v_exp_f32 v25, v25
v_mfma_f32_16x16x32_bf16 v[40:43], a[20:23], a[196:199], v[40:43]
v_cvt_pk_bf16_f32 v56, v24, v25
v_mfma_f32_16x16x32_bf16 v[40:43], a[24:27], a[200:203], v[40:43]
buffer_load_dwordx4 v3, s[48:51], s32 offen offset:3072 sc1 lds
v_mfma_f32_16x16x32_bf16 v[40:43], a[28:31], a[204:207], v[40:43]
v_mfma_f32_16x16x32_bf16 v[44:47], a[16:19], a[208:211], v[92:95]
v_exp_f32 v26, v26
v_mfma_f32_16x16x32_bf16 v[44:47], a[20:23], a[212:215], v[44:47]
v_mfma_f32_16x16x32_bf16 v[44:47], a[24:27], a[216:219], v[44:47]
v_exp_f32 v27, v27
v_mfma_f32_16x16x32_bf16 v[44:47], a[28:31], a[220:223], v[44:47]
v_cvt_pk_bf16_f32 v57, v26, v27
s_waitcnt lgkmcnt(0)
ds_read_b128 a[0:3], v1 offset:24576
ds_read_b128 a[4:7], v1 offset:25600
ds_read_b128 a[8:11], v1 offset:26624
ds_read_b128 a[12:15], v1 offset:27648
ds_read_b128 a[16:19], v1 offset:28672
ds_read_b128 a[20:23], v1 offset:29696
ds_read_b128 a[24:27], v1 offset:30720
ds_read_b128 a[28:31], v1 offset:31744
s_waitcnt lgkmcnt(7)
v_mfma_f32_16x16x32_bf16 v[16:19], a[0:3], a[160:163], v[80:83]
ds_read_b128 a[32:35], v1 offset:16384
v_exp_f32 v28, v28
s_waitcnt lgkmcnt(7)
v_mfma_f32_16x16x32_bf16 v[16:19], a[4:7], a[164:167], v[16:19]
v_exp_f32 v29, v29
s_waitcnt lgkmcnt(6)
v_mfma_f32_16x16x32_bf16 v[16:19], a[8:11], a[168:171], v[16:19]
s_add_u32 m0, s27, 0x1000
v_exp_f32 v30, v30
s_waitcnt lgkmcnt(5)
v_mfma_f32_16x16x32_bf16 v[16:19], a[12:15], a[172:175], v[16:19]
buffer_load_dwordx4 v3, s[48:51], s7 offen offset:0 sc1 lds
v_mfma_f32_16x16x32_bf16 v[20:23], a[0:3], a[176:179], v[84:87]
ds_read_b128 a[36:39], v1 offset:17408
v_exp_f32 v31, v31
v_mfma_f32_16x16x32_bf16 v[20:23], a[4:7], a[180:183], v[20:23]
v_exp_f32 v32, v32
v_mfma_f32_16x16x32_bf16 v[20:23], a[8:11], a[184:187], v[20:23]
ds_read_b128 a[40:43], v1 offset:18432
v_exp_f32 v33, v33
v_mfma_f32_16x16x32_bf16 v[20:23], a[12:15], a[188:191], v[20:23]
v_exp_f32 v34, v34
v_mfma_f32_16x16x32_bf16 v[24:27], a[0:3], a[192:195], v[88:91]
v_exp_f32 v35, v35
v_mfma_f32_16x16x32_bf16 v[24:27], a[4:7], a[196:199], v[24:27]
v_exp_f32 v36, v36
v_mfma_f32_16x16x32_bf16 v[24:27], a[8:11], a[200:203], v[24:27]
ds_read_b128 a[44:47], v1 offset:19456
v_exp_f32 v37, v37
v_mfma_f32_16x16x32_bf16 v[24:27], a[12:15], a[204:207], v[24:27]
buffer_load_dwordx4 v3, s[48:51], s7 offen offset:1024 sc1 lds
v_cvt_pk_bf16_f32 v60, v28, v29
v_cvt_pk_bf16_f32 v61, v30, v31
v_mfma_f32_16x16x32_bf16 v[28:31], a[0:3], a[208:211], v[92:95]
v_exp_f32 v38, v38
v_mfma_f32_16x16x32_bf16 v[28:31], a[4:7], a[212:215], v[28:31]
ds_read_b128 a[48:51], v1 offset:20480
v_exp_f32 v39, v39
v_mfma_f32_16x16x32_bf16 v[28:31], a[8:11], a[216:219], v[28:31]
v_exp_f32 v40, v40
v_mfma_f32_16x16x32_bf16 v[28:31], a[12:15], a[220:223], v[28:31]
v_exp_f32 v41, v41
v_cvt_pk_bf16_f32 v50, v32, v33
v_cvt_pk_bf16_f32 v51, v34, v35
s_waitcnt lgkmcnt(8)
v_mfma_f32_16x16x32_bf16 v[32:35], a[16:19], a[160:163], v[80:83]
ds_read_b128 a[52:55], v1 offset:21504
v_exp_f32 v42, v42
s_waitcnt lgkmcnt(8)
v_mfma_f32_16x16x32_bf16 v[32:35], a[20:23], a[164:167], v[32:35]
v_exp_f32 v43, v43
s_waitcnt lgkmcnt(7)
v_mfma_f32_16x16x32_bf16 v[32:35], a[24:27], a[168:171], v[32:35]
buffer_load_dwordx4 v3, s[48:51], s7 offen offset:2048 sc1 lds
s_waitcnt lgkmcnt(6)
v_mfma_f32_16x16x32_bf16 v[32:35], a[28:31], a[172:175], v[32:35]
v_exp_f32 v44, v44
v_cvt_pk_bf16_f32 v54, v36, v37
v_cvt_pk_bf16_f32 v55, v38, v39
v_mfma_f32_16x16x32_bf16 v[36:39], a[16:19], a[176:179], v[84:87]
ds_read_b128 a[56:59], v1 offset:22528
v_exp_f32 v45, v45
v_mfma_f32_16x16x32_bf16 v[36:39], a[20:23], a[180:183], v[36:39]
v_exp_f32 v46, v46
v_mfma_f32_16x16x32_bf16 v[36:39], a[24:27], a[184:187], v[36:39]
v_exp_f32 v47, v47
v_mfma_f32_16x16x32_bf16 v[36:39], a[28:31], a[188:191], v[36:39]
ds_read_b128 a[60:63], v1 offset:23552
v_exp_f32 v16, v16
v_cvt_pk_bf16_f32 v58, v40, v41
v_cvt_pk_bf16_f32 v59, v42, v43
v_mfma_f32_16x16x32_bf16 v[40:43], a[16:19], a[192:195], v[88:91]
v_exp_f32 v17, v17
v_mfma_f32_16x16x32_bf16 v[40:43], a[20:23], a[196:199], v[40:43]
v_exp_f32 v18, v18
v_mfma_f32_16x16x32_bf16 v[40:43], a[24:27], a[200:203], v[40:43]
buffer_load_dwordx4 v3, s[48:51], s7 offen offset:3072 sc1 lds
v_mfma_f32_16x16x32_bf16 v[40:43], a[28:31], a[204:207], v[40:43]
s_add_u32 s32, s32, 0x8000
s_add_u32 s7, s7, 0x8000
s_xor_b32 s27, s27, 0x38000
v_cvt_pk_bf16_f32 v62, v44, v45
v_cvt_pk_bf16_f32 v63, v46, v47
v_mfma_f32_16x16x32_bf16 v[44:47], a[16:19], a[208:211], v[92:95]
v_xor_b32 v1, 0x8000, v1
v_exp_f32 v19, v19
v_mfma_f32_16x16x32_bf16 v[44:47], a[20:23], a[212:215], v[44:47]
v_exp_f32 v20, v20
v_mfma_f32_16x16x32_bf16 v[44:47], a[24:27], a[216:219], v[44:47]
v_exp_f32 v21, v21
v_mfma_f32_16x16x32_bf16 v[44:47], a[28:31], a[220:223], v[44:47]
v_exp_f32 v22, v22
v_exp_f32 v23, v23
v_exp_f32 v24, v24
v_exp_f32 v25, v25
v_exp_f32 v26, v26
v_exp_f32 v27, v27
v_cvt_pk_bf16_f32 v64, v16, v17
v_cvt_pk_bf16_f32 v65, v18, v19
v_cvt_pk_bf16_f32 v68, v20, v21
v_cvt_pk_bf16_f32 v69, v22, v23
v_cvt_pk_bf16_f32 v72, v24, v25
v_cvt_pk_bf16_f32 v73, v26, v27
s_branch L_att_dodd
L_att_deven:
s_waitcnt vmcnt(16) lgkmcnt(0)
s_barrier
v_mfma_f32_16x16x32_bf16 v[128:131], a[32:35], v[48:51], v[128:131]
ds_read_b128 a[0:3], v1 offset:8192
v_mfma_f32_16x16x32_bf16 v[160:163], a[32:35], v[52:55], v[160:163]
v_exp_f32 v28, v28
v_mfma_f32_16x16x32_bf16 v[192:195], a[32:35], v[56:59], v[192:195]
v_mfma_f32_16x16x32_bf16 v[224:227], a[32:35], v[60:63], v[224:227]
ds_read_b128 a[4:7], v1 offset:9216
v_mfma_f32_16x16x32_bf16 v[228:231], a[36:39], v[60:63], v[228:231]
v_exp_f32 v29, v29
v_mfma_f32_16x16x32_bf16 v[196:199], a[36:39], v[56:59], v[196:199]
v_exp_f32 v30, v30
v_mfma_f32_16x16x32_bf16 v[164:167], a[36:39], v[52:55], v[164:167]
v_cvt_pk_bf16_f32 v76, v28, v29
v_mfma_f32_16x16x32_bf16 v[132:135], a[36:39], v[48:51], v[132:135]
ds_read_b128 a[8:11], v1 offset:10240
s_add_u32 m0, s27, 0x0
v_mfma_f32_16x16x32_bf16 v[136:139], a[40:43], v[48:51], v[136:139]
buffer_load_dwordx4 v3, s[48:51], s32 offen offset:0 sc1 lds
v_mfma_f32_16x16x32_bf16 v[168:171], a[40:43], v[52:55], v[168:171]
v_exp_f32 v31, v31
v_mfma_f32_16x16x32_bf16 v[200:203], a[40:43], v[56:59], v[200:203]
v_exp_f32 v32, v32
v_mfma_f32_16x16x32_bf16 v[232:235], a[40:43], v[60:63], v[232:235]
ds_read_b128 a[12:15], v1 offset:11264
v_cvt_pk_bf16_f32 v77, v30, v31
v_mfma_f32_16x16x32_bf16 v[236:239], a[44:47], v[60:63], v[236:239]
v_mfma_f32_16x16x32_bf16 v[204:207], a[44:47], v[56:59], v[204:207]
v_exp_f32 v33, v33
v_mfma_f32_16x16x32_bf16 v[172:175], a[44:47], v[52:55], v[172:175]
v_exp_f32 v34, v34
v_mfma_f32_16x16x32_bf16 v[140:143], a[44:47], v[48:51], v[140:143]
ds_read_b128 a[16:19], v1 offset:12288
v_cvt_pk_bf16_f32 v66, v32, v33
v_mfma_f32_16x16x32_bf16 v[144:147], a[48:51], v[48:51], v[144:147]
v_mfma_f32_16x16x32_bf16 v[176:179], a[48:51], v[52:55], v[176:179]
v_exp_f32 v35, v35
v_mfma_f32_16x16x32_bf16 v[208:211], a[48:51], v[56:59], v[208:211]
v_exp_f32 v36, v36
v_mfma_f32_16x16x32_bf16 v[240:243], a[48:51], v[60:63], v[240:243]
ds_read_b128 a[20:23], v1 offset:13312
v_cvt_pk_bf16_f32 v67, v34, v35
v_mfma_f32_16x16x32_bf16 v[244:247], a[52:55], v[60:63], v[244:247]
v_mfma_f32_16x16x32_bf16 v[212:215], a[52:55], v[56:59], v[212:215]
v_exp_f32 v37, v37
v_mfma_f32_16x16x32_bf16 v[180:183], a[52:55], v[52:55], v[180:183]
v_exp_f32 v38, v38
v_mfma_f32_16x16x32_bf16 v[148:151], a[52:55], v[48:51], v[148:151]
ds_read_b128 a[24:27], v1 offset:14336
v_cvt_pk_bf16_f32 v70, v36, v37
v_mfma_f32_16x16x32_bf16 v[152:155], a[56:59], v[48:51], v[152:155]
buffer_load_dwordx4 v3, s[48:51], s32 offen offset:1024 sc1 lds
v_mfma_f32_16x16x32_bf16 v[184:187], a[56:59], v[52:55], v[184:187]
v_mfma_f32_16x16x32_bf16 v[216:219], a[56:59], v[56:59], v[216:219]
v_exp_f32 v39, v39
v_mfma_f32_16x16x32_bf16 v[248:251], a[56:59], v[60:63], v[248:251]
ds_read_b128 a[28:31], v1 offset:15360
v_cvt_pk_bf16_f32 v71, v38, v39
v_mfma_f32_16x16x32_bf16 v[252:255], a[60:63], v[60:63], v[252:255]
v_exp_f32 v40, v40
v_mfma_f32_16x16x32_bf16 v[220:223], a[60:63], v[56:59], v[220:223]
v_mfma_f32_16x16x32_bf16 v[188:191], a[60:63], v[52:55], v[188:191]
v_exp_f32 v41, v41
v_mfma_f32_16x16x32_bf16 v[156:159], a[60:63], v[48:51], v[156:159]
ds_read_b128 a[32:35], v1 offset:0
v_cvt_pk_bf16_f32 v74, v40, v41
v_mfma_f32_16x16x32_bf16 a[224:227], a[240:243], v[48:51], a[224:227]
v_exp_f32 v42, v42
v_mfma_f32_16x16x32_bf16 a[228:231], a[240:243], v[52:55], a[228:231]
v_mfma_f32_16x16x32_bf16 a[232:235], a[240:243], v[56:59], a[232:235]
v_exp_f32 v43, v43
v_mfma_f32_16x16x32_bf16 a[236:239], a[240:243], v[60:63], a[236:239]
ds_read_b128 a[36:39], v1 offset:1024
s_waitcnt lgkmcnt(6)
v_mfma_f32_16x16x32_bf16 v[16:19], a[0:3], a[160:163], v[80:83]
v_exp_f32 v44, v44
v_mfma_f32_16x16x32_bf16 v[16:19], a[4:7], a[164:167], v[16:19]
v_cvt_pk_bf16_f32 v75, v42, v43
v_mfma_f32_16x16x32_bf16 v[16:19], a[8:11], a[168:171], v[16:19]
v_exp_f32 v45, v45
v_mfma_f32_16x16x32_bf16 v[16:19], a[12:15], a[172:175], v[16:19]
ds_read_b128 a[40:43], v1 offset:2048
v_cvt_pk_bf16_f32 v78, v44, v45
v_mfma_f32_16x16x32_bf16 v[20:23], a[0:3], a[176:179], v[84:87]
v_exp_f32 v46, v46
v_mfma_f32_16x16x32_bf16 v[20:23], a[4:7], a[180:183], v[20:23]
buffer_load_dwordx4 v3, s[48:51], s32 offen offset:2048 sc1 lds
v_mfma_f32_16x16x32_bf16 v[20:23], a[8:11], a[184:187], v[20:23]
v_mfma_f32_16x16x32_bf16 v[20:23], a[12:15], a[188:191], v[20:23]
ds_read_b128 a[44:47], v1 offset:3072
v_mfma_f32_16x16x32_bf16 v[24:27], a[0:3], a[192:195], v[88:91]
v_exp_f32 v47, v47
v_mfma_f32_16x16x32_bf16 v[24:27], a[4:7], a[196:199], v[24:27]
v_exp_f32 v16, v16
v_mfma_f32_16x16x32_bf16 v[24:27], a[8:11], a[200:203], v[24:27]
v_cvt_pk_bf16_f32 v79, v46, v47
v_mfma_f32_16x16x32_bf16 v[24:27], a[12:15], a[204:207], v[24:27]
ds_read_b128 a[48:51], v1 offset:4096
v_mfma_f32_16x16x32_bf16 v[28:31], a[0:3], a[208:211], v[92:95]
v_exp_f32 v17, v17
v_mfma_f32_16x16x32_bf16 v[28:31], a[4:7], a[212:215], v[28:31]
v_exp_f32 v18, v18
v_mfma_f32_16x16x32_bf16 v[28:31], a[8:11], a[216:219], v[28:31]
v_cvt_pk_bf16_f32 v48, v16, v17
v_mfma_f32_16x16x32_bf16 v[28:31], a[12:15], a[220:223], v[28:31]
ds_read_b128 a[52:55], v1 offset:5120
s_waitcnt lgkmcnt(6)
v_mfma_f32_16x16x32_bf16 v[32:35], a[16:19], a[160:163], v[80:83]
v_exp_f32 v19, v19
v_mfma_f32_16x16x32_bf16 v[32:35], a[20:23], a[164:167], v[32:35]
v_exp_f32 v20, v20
v_mfma_f32_16x16x32_bf16 v[32:35], a[24:27], a[168:171], v[32:35]
v_cvt_pk_bf16_f32 v49, v18, v19
v_mfma_f32_16x16x32_bf16 v[32:35], a[28:31], a[172:175], v[32:35]
ds_read_b128 a[56:59], v1 offset:6144
v_mfma_f32_16x16x32_bf16 v[36:39], a[16:19], a[176:179], v[84:87]
v_exp_f32 v21, v21
v_mfma_f32_16x16x32_bf16 v[36:39], a[20:23], a[180:183], v[36:39]
buffer_load_dwordx4 v3, s[48:51], s32 offen offset:3072 sc1 lds
v_mfma_f32_16x16x32_bf16 v[36:39], a[24:27], a[184:187], v[36:39]
v_exp_f32 v22, v22
v_mfma_f32_16x16x32_bf16 v[36:39], a[28:31], a[188:191], v[36:39]
ds_read_b128 a[60:63], v1 offset:7168
v_cvt_pk_bf16_f32 v52, v20, v21
v_mfma_f32_16x16x32_bf16 v[40:43], a[16:19], a[192:195], v[88:91]
v_mfma_f32_16x16x32_bf16 v[40:43], a[20:23], a[196:199], v[40:43]
v_exp_f32 v23, v23
v_mfma_f32_16x16x32_bf16 v[40:43], a[24:27], a[200:203], v[40:43]
v_exp_f32 v24, v24
v_mfma_f32_16x16x32_bf16 v[40:43], a[28:31], a[204:207], v[40:43]
v_cvt_pk_bf16_f32 v53, v22, v23
v_mfma_f32_16x16x32_bf16 v[44:47], a[16:19], a[208:211], v[92:95]
v_exp_f32 v25, v25
v_mfma_f32_16x16x32_bf16 v[44:47], a[20:23], a[212:215], v[44:47]
v_exp_f32 v26, v26
v_mfma_f32_16x16x32_bf16 v[44:47], a[24:27], a[216:219], v[44:47]
v_exp_f32 v27, v27
v_mfma_f32_16x16x32_bf16 v[44:47], a[28:31], a[220:223], v[44:47]
v_cvt_pk_bf16_f32 v56, v24, v25
v_cvt_pk_bf16_f32 v57, v26, v27
s_waitcnt lgkmcnt(0)
v_mfma_f32_16x16x32_bf16 v[128:131], a[32:35], v[64:67], v[128:131]
ds_read_b128 a[0:3], v1 offset:24576
v_mfma_f32_16x16x32_bf16 v[160:163], a[32:35], v[68:71], v[160:163]
v_exp_f32 v28, v28
v_mfma_f32_16x16x32_bf16 v[192:195], a[32:35], v[72:75], v[192:195]
v_mfma_f32_16x16x32_bf16 v[224:227], a[32:35], v[76:79], v[224:227]
ds_read_b128 a[4:7], v1 offset:25600
v_mfma_f32_16x16x32_bf16 v[228:231], a[36:39], v[76:79], v[228:231]
v_exp_f32 v29, v29
v_mfma_f32_16x16x32_bf16 v[196:199], a[36:39], v[72:75], v[196:199]
v_exp_f32 v30, v30
v_mfma_f32_16x16x32_bf16 v[164:167], a[36:39], v[68:71], v[164:167]
v_cvt_pk_bf16_f32 v60, v28, v29
v_mfma_f32_16x16x32_bf16 v[132:135], a[36:39], v[64:67], v[132:135]
ds_read_b128 a[8:11], v1 offset:26624
s_add_u32 m0, s27, 0x1000
v_mfma_f32_16x16x32_bf16 v[136:139], a[40:43], v[64:67], v[136:139]
buffer_load_dwordx4 v3, s[48:51], s7 offen offset:0 sc1 lds
v_mfma_f32_16x16x32_bf16 v[168:171], a[40:43], v[68:71], v[168:171]
v_exp_f32 v31, v31
v_mfma_f32_16x16x32_bf16 v[200:203], a[40:43], v[72:75], v[200:203]
v_exp_f32 v32, v32
v_mfma_f32_16x16x32_bf16 v[232:235], a[40:43], v[76:79], v[232:235]
ds_read_b128 a[12:15], v1 offset:27648
v_cvt_pk_bf16_f32 v61, v30, v31
v_mfma_f32_16x16x32_bf16 v[236:239], a[44:47], v[76:79], v[236:239]
v_mfma_f32_16x16x32_bf16 v[204:207], a[44:47], v[72:75], v[204:207]
v_exp_f32 v33, v33
v_mfma_f32_16x16x32_bf16 v[172:175], a[44:47], v[68:71], v[172:175]
v_exp_f32 v34, v34
v_mfma_f32_16x16x32_bf16 v[140:143], a[44:47], v[64:67], v[140:143]
ds_read_b128 a[16:19], v1 offset:28672
v_cvt_pk_bf16_f32 v50, v32, v33
v_mfma_f32_16x16x32_bf16 v[144:147], a[48:51], v[64:67], v[144:147]
v_mfma_f32_16x16x32_bf16 v[176:179], a[48:51], v[68:71], v[176:179]
v_exp_f32 v35, v35
v_mfma_f32_16x16x32_bf16 v[208:211], a[48:51], v[72:75], v[208:211]
v_exp_f32 v36, v36
v_mfma_f32_16x16x32_bf16 v[240:243], a[48:51], v[76:79], v[240:243]
ds_read_b128 a[20:23], v1 offset:29696
v_cvt_pk_bf16_f32 v51, v34, v35
v_mfma_f32_16x16x32_bf16 v[244:247], a[52:55], v[76:79], v[244:247]
v_exp_f32 v37, v37
v_mfma_f32_16x16x32_bf16 v[212:215], a[52:55], v[72:75], v[212:215]
v_cvt_pk_bf16_f32 v54, v36, v37
v_mfma_f32_16x16x32_bf16 v[180:183], a[52:55], v[68:71], v[180:183]
v_exp_f32 v38, v38
v_mfma_f32_16x16x32_bf16 v[148:151], a[52:55], v[64:67], v[148:151]
ds_read_b128 a[24:27], v1 offset:30720
v_mfma_f32_16x16x32_bf16 v[152:155], a[56:59], v[64:67], v[152:155]
buffer_load_dwordx4 v3, s[48:51], s7 offen offset:1024 sc1 lds
v_mfma_f32_16x16x32_bf16 v[184:187], a[56:59], v[68:71], v[184:187]
v_exp_f32 v39, v39
v_mfma_f32_16x16x32_bf16 v[216:219], a[56:59], v[72:75], v[216:219]
v_cvt_pk_bf16_f32 v55, v38, v39
v_mfma_f32_16x16x32_bf16 v[248:251], a[56:59], v[76:79], v[248:251]
ds_read_b128 a[28:31], v1 offset:31744
v_mfma_f32_16x16x32_bf16 v[252:255], a[60:63], v[76:79], v[252:255]
v_exp_f32 v40, v40
v_mfma_f32_16x16x32_bf16 v[220:223], a[60:63], v[72:75], v[220:223]
v_exp_f32 v41, v41
v_mfma_f32_16x16x32_bf16 v[188:191], a[60:63], v[68:71], v[188:191]
v_cvt_pk_bf16_f32 v58, v40, v41
v_mfma_f32_16x16x32_bf16 v[156:159], a[60:63], v[64:67], v[156:159]
ds_read_b128 a[32:35], v1 offset:16384
v_mfma_f32_16x16x32_bf16 a[224:227], a[240:243], v[64:67], a[224:227]
v_exp_f32 v42, v42
v_mfma_f32_16x16x32_bf16 a[228:231], a[240:243], v[68:71], a[228:231]
v_exp_f32 v43, v43
v_mfma_f32_16x16x32_bf16 a[232:235], a[240:243], v[72:75], a[232:235]
v_exp_f32 v44, v44
v_mfma_f32_16x16x32_bf16 a[236:239], a[240:243], v[76:79], a[236:239]
ds_read_b128 a[36:39], v1 offset:17408
s_waitcnt lgkmcnt(6)
v_mfma_f32_16x16x32_bf16 v[16:19], a[0:3], a[160:163], v[80:83]
v_cvt_pk_bf16_f32 v59, v42, v43
v_mfma_f32_16x16x32_bf16 v[16:19], a[4:7], a[164:167], v[16:19]
v_exp_f32 v45, v45
v_mfma_f32_16x16x32_bf16 v[16:19], a[8:11], a[168:171], v[16:19]
v_exp_f32 v46, v46
v_mfma_f32_16x16x32_bf16 v[16:19], a[12:15], a[172:175], v[16:19]
ds_read_b128 a[40:43], v1 offset:18432
v_cvt_pk_bf16_f32 v62, v44, v45
v_mfma_f32_16x16x32_bf16 v[20:23], a[0:3], a[176:179], v[84:87]
v_mfma_f32_16x16x32_bf16 v[20:23], a[4:7], a[180:183], v[20:23]
buffer_load_dwordx4 v3, s[48:51], s7 offen offset:2048 sc1 lds
v_mfma_f32_16x16x32_bf16 v[20:23], a[8:11], a[184:187], v[20:23]
v_exp_f32 v47, v47
v_mfma_f32_16x16x32_bf16 v[20:23], a[12:15], a[188:191], v[20:23]
ds_read_b128 a[44:47], v1 offset:19456
v_cvt_pk_bf16_f32 v63, v46, v47
v_mfma_f32_16x16x32_bf16 v[24:27], a[0:3], a[192:195], v[88:91]
v_exp_f32 v16, v16
v_mfma_f32_16x16x32_bf16 v[24:27], a[4:7], a[196:199], v[24:27]
v_mfma_f32_16x16x32_bf16 v[24:27], a[8:11], a[200:203], v[24:27]
v_exp_f32 v17, v17
v_mfma_f32_16x16x32_bf16 v[24:27], a[12:15], a[204:207], v[24:27]
ds_read_b128 a[48:51], v1 offset:20480
v_cvt_pk_bf16_f32 v64, v16, v17
v_mfma_f32_16x16x32_bf16 v[28:31], a[0:3], a[208:211], v[92:95]
v_exp_f32 v18, v18
v_mfma_f32_16x16x32_bf16 v[28:31], a[4:7], a[212:215], v[28:31]
v_mfma_f32_16x16x32_bf16 v[28:31], a[8:11], a[216:219], v[28:31]
v_exp_f32 v19, v19
v_mfma_f32_16x16x32_bf16 v[28:31], a[12:15], a[220:223], v[28:31]
ds_read_b128 a[52:55], v1 offset:21504
s_waitcnt lgkmcnt(6)
v_mfma_f32_16x16x32_bf16 v[32:35], a[16:19], a[160:163], v[80:83]
v_exp_f32 v20, v20
v_mfma_f32_16x16x32_bf16 v[32:35], a[20:23], a[164:167], v[32:35]
v_exp_f32 v21, v21
v_mfma_f32_16x16x32_bf16 v[32:35], a[24:27], a[168:171], v[32:35]
v_cvt_pk_bf16_f32 v65, v18, v19
v_cvt_pk_bf16_f32 v68, v20, v21
v_mfma_f32_16x16x32_bf16 v[32:35], a[28:31], a[172:175], v[32:35]
ds_read_b128 a[56:59], v1 offset:22528
v_mfma_f32_16x16x32_bf16 v[36:39], a[16:19], a[176:179], v[84:87]
v_exp_f32 v22, v22
v_mfma_f32_16x16x32_bf16 v[36:39], a[20:23], a[180:183], v[36:39]
buffer_load_dwordx4 v3, s[48:51], s7 offen offset:3072 sc1 lds
v_mfma_f32_16x16x32_bf16 v[36:39], a[24:27], a[184:187], v[36:39]
v_exp_f32 v23, v23
v_mfma_f32_16x16x32_bf16 v[36:39], a[28:31], a[188:191], v[36:39]
ds_read_b128 a[60:63], v1 offset:23552
s_add_u32 s32, s32, 0x8000
v_mfma_f32_16x16x32_bf16 v[40:43], a[16:19], a[192:195], v[88:91]
s_add_u32 s7, s7, 0x8000
s_xor_b32 s27, s27, 0x38000
v_xor_b32 v1, 0x8000, v1
v_mfma_f32_16x16x32_bf16 v[40:43], a[20:23], a[196:199], v[40:43]
v_cvt_pk_bf16_f32 v69, v22, v23
v_mfma_f32_16x16x32_bf16 v[40:43], a[24:27], a[200:203], v[40:43]
v_exp_f32 v24, v24
v_mfma_f32_16x16x32_bf16 v[40:43], a[28:31], a[204:207], v[40:43]
v_exp_f32 v25, v25
v_mfma_f32_16x16x32_bf16 v[44:47], a[16:19], a[208:211], v[92:95]
v_cvt_pk_bf16_f32 v72, v24, v25
v_mfma_f32_16x16x32_bf16 v[44:47], a[20:23], a[212:215], v[44:47]
v_exp_f32 v26, v26
v_mfma_f32_16x16x32_bf16 v[44:47], a[24:27], a[216:219], v[44:47]
v_exp_f32 v27, v27
v_mfma_f32_16x16x32_bf16 v[44:47], a[28:31], a[220:223], v[44:47]
v_cvt_pk_bf16_f32 v73, v26, v27
L_att_dodd:
s_waitcnt vmcnt(16) lgkmcnt(0)
s_barrier
v_mfma_f32_16x16x32_bf16 v[128:131], a[32:35], v[48:51], v[128:131]
ds_read_b128 a[0:3], v2 offset:8192
v_mfma_f32_16x16x32_bf16 v[160:163], a[32:35], v[52:55], v[160:163]
v_exp_f32 v28, v28
v_mfma_f32_16x16x32_bf16 v[192:195], a[32:35], v[56:59], v[192:195]
v_mfma_f32_16x16x32_bf16 v[224:227], a[32:35], v[60:63], v[224:227]
ds_read_b128 a[4:7], v2 offset:9216
v_mfma_f32_16x16x32_bf16 v[228:231], a[36:39], v[60:63], v[228:231]
v_exp_f32 v29, v29
v_mfma_f32_16x16x32_bf16 v[196:199], a[36:39], v[56:59], v[196:199]
v_exp_f32 v30, v30
v_mfma_f32_16x16x32_bf16 v[164:167], a[36:39], v[52:55], v[164:167]
v_cvt_pk_bf16_f32 v76, v28, v29
v_mfma_f32_16x16x32_bf16 v[132:135], a[36:39], v[48:51], v[132:135]
ds_read_b128 a[8:11], v2 offset:10240
s_add_u32 m0, s19, 0x0
v_mfma_f32_16x16x32_bf16 v[136:139], a[40:43], v[48:51], v[136:139]
buffer_load_dwordx4 v3, s[48:51], s32 offen offset:0 sc1 lds
v_mfma_f32_16x16x32_bf16 v[168:171], a[40:43], v[52:55], v[168:171]
v_exp_f32 v31, v31
v_mfma_f32_16x16x32_bf16 v[200:203], a[40:43], v[56:59], v[200:203]
v_exp_f32 v32, v32
v_mfma_f32_16x16x32_bf16 v[232:235], a[40:43], v[60:63], v[232:235]
ds_read_b128 a[12:15], v2 offset:11264
v_cvt_pk_bf16_f32 v77, v30, v31
v_mfma_f32_16x16x32_bf16 v[236:239], a[44:47], v[60:63], v[236:239]
v_mfma_f32_16x16x32_bf16 v[204:207], a[44:47], v[56:59], v[204:207]
v_exp_f32 v33, v33
v_mfma_f32_16x16x32_bf16 v[172:175], a[44:47], v[52:55], v[172:175]
v_exp_f32 v34, v34
v_mfma_f32_16x16x32_bf16 v[140:143], a[44:47], v[48:51], v[140:143]
ds_read_b128 a[16:19], v2 offset:12288
v_cvt_pk_bf16_f32 v66, v32, v33
v_mfma_f32_16x16x32_bf16 v[144:147], a[48:51], v[48:51], v[144:147]
v_mfma_f32_16x16x32_bf16 v[176:179], a[48:51], v[52:55], v[176:179]
v_exp_f32 v35, v35
v_mfma_f32_16x16x32_bf16 v[208:211], a[48:51], v[56:59], v[208:211]
v_exp_f32 v36, v36
v_mfma_f32_16x16x32_bf16 v[240:243], a[48:51], v[60:63], v[240:243]
ds_read_b128 a[20:23], v2 offset:13312
v_cvt_pk_bf16_f32 v67, v34, v35
v_mfma_f32_16x16x32_bf16 v[244:247], a[52:55], v[60:63], v[244:247]
v_mfma_f32_16x16x32_bf16 v[212:215], a[52:55], v[56:59], v[212:215]
v_exp_f32 v37, v37
v_mfma_f32_16x16x32_bf16 v[180:183], a[52:55], v[52:55], v[180:183]
v_exp_f32 v38, v38
v_mfma_f32_16x16x32_bf16 v[148:151], a[52:55], v[48:51], v[148:151]
ds_read_b128 a[24:27], v2 offset:14336
v_cvt_pk_bf16_f32 v70, v36, v37
v_mfma_f32_16x16x32_bf16 v[152:155], a[56:59], v[48:51], v[152:155]
buffer_load_dwordx4 v3, s[48:51], s32 offen offset:1024 sc1 lds
v_mfma_f32_16x16x32_bf16 v[184:187], a[56:59], v[52:55], v[184:187]
v_mfma_f32_16x16x32_bf16 v[216:219], a[56:59], v[56:59], v[216:219]
v_exp_f32 v39, v39
v_mfma_f32_16x16x32_bf16 v[248:251], a[56:59], v[60:63], v[248:251]
ds_read_b128 a[28:31], v2 offset:15360
v_cvt_pk_bf16_f32 v71, v38, v39
v_mfma_f32_16x16x32_bf16 v[252:255], a[60:63], v[60:63], v[252:255]
v_exp_f32 v40, v40
v_mfma_f32_16x16x32_bf16 v[220:223], a[60:63], v[56:59], v[220:223]
v_mfma_f32_16x16x32_bf16 v[188:191], a[60:63], v[52:55], v[188:191]
v_exp_f32 v41, v41
v_mfma_f32_16x16x32_bf16 v[156:159], a[60:63], v[48:51], v[156:159]
ds_read_b128 a[32:35], v2 offset:0
v_cvt_pk_bf16_f32 v74, v40, v41
v_mfma_f32_16x16x32_bf16 a[224:227], a[240:243], v[48:51], a[224:227]
v_exp_f32 v42, v42
v_mfma_f32_16x16x32_bf16 a[228:231], a[240:243], v[52:55], a[228:231]
v_mfma_f32_16x16x32_bf16 a[232:235], a[240:243], v[56:59], a[232:235]
v_exp_f32 v43, v43
v_mfma_f32_16x16x32_bf16 a[236:239], a[240:243], v[60:63], a[236:239]
ds_read_b128 a[36:39], v2 offset:1024
s_waitcnt lgkmcnt(6)
v_mfma_f32_16x16x32_bf16 v[16:19], a[0:3], a[160:163], v[80:83]
v_exp_f32 v44, v44
v_mfma_f32_16x16x32_bf16 v[16:19], a[4:7], a[164:167], v[16:19]
v_cvt_pk_bf16_f32 v75, v42, v43
v_mfma_f32_16x16x32_bf16 v[16:19], a[8:11], a[168:171], v[16:19]
v_exp_f32 v45, v45
v_mfma_f32_16x16x32_bf16 v[16:19], a[12:15], a[172:175], v[16:19]
ds_read_b128 a[40:43], v2 offset:2048
v_cvt_pk_bf16_f32 v78, v44, v45
v_mfma_f32_16x16x32_bf16 v[20:23], a[0:3], a[176:179], v[84:87]
v_exp_f32 v46, v46
v_mfma_f32_16x16x32_bf16 v[20:23], a[4:7], a[180:183], v[20:23]
buffer_load_dwordx4 v3, s[48:51], s32 offen offset:2048 sc1 lds
v_mfma_f32_16x16x32_bf16 v[20:23], a[8:11], a[184:187], v[20:23]
v_mfma_f32_16x16x32_bf16 v[20:23], a[12:15], a[188:191], v[20:23]
ds_read_b128 a[44:47], v2 offset:3072
v_mfma_f32_16x16x32_bf16 v[24:27], a[0:3], a[192:195], v[88:91]
v_exp_f32 v47, v47
v_mfma_f32_16x16x32_bf16 v[24:27], a[4:7], a[196:199], v[24:27]
v_exp_f32 v16, v16
v_mfma_f32_16x16x32_bf16 v[24:27], a[8:11], a[200:203], v[24:27]
v_cvt_pk_bf16_f32 v79, v46, v47
v_mfma_f32_16x16x32_bf16 v[24:27], a[12:15], a[204:207], v[24:27]
ds_read_b128 a[48:51], v2 offset:4096
v_mfma_f32_16x16x32_bf16 v[28:31], a[0:3], a[208:211], v[92:95]
v_exp_f32 v17, v17
v_mfma_f32_16x16x32_bf16 v[28:31], a[4:7], a[212:215], v[28:31]
v_exp_f32 v18, v18
v_mfma_f32_16x16x32_bf16 v[28:31], a[8:11], a[216:219], v[28:31]
v_cvt_pk_bf16_f32 v48, v16, v17
v_mfma_f32_16x16x32_bf16 v[28:31], a[12:15], a[220:223], v[28:31]
ds_read_b128 a[52:55], v2 offset:5120
s_waitcnt lgkmcnt(6)
v_mfma_f32_16x16x32_bf16 v[32:35], a[16:19], a[160:163], v[80:83]
v_exp_f32 v19, v19
v_mfma_f32_16x16x32_bf16 v[32:35], a[20:23], a[164:167], v[32:35]
v_exp_f32 v20, v20
v_mfma_f32_16x16x32_bf16 v[32:35], a[24:27], a[168:171], v[32:35]
v_cvt_pk_bf16_f32 v49, v18, v19
v_mfma_f32_16x16x32_bf16 v[32:35], a[28:31], a[172:175], v[32:35]
ds_read_b128 a[56:59], v2 offset:6144
v_mfma_f32_16x16x32_bf16 v[36:39], a[16:19], a[176:179], v[84:87]
v_exp_f32 v21, v21
v_mfma_f32_16x16x32_bf16 v[36:39], a[20:23], a[180:183], v[36:39]
buffer_load_dwordx4 v3, s[48:51], s32 offen offset:3072 sc1 lds
v_mfma_f32_16x16x32_bf16 v[36:39], a[24:27], a[184:187], v[36:39]
v_exp_f32 v22, v22
v_mfma_f32_16x16x32_bf16 v[36:39], a[28:31], a[188:191], v[36:39]
ds_read_b128 a[60:63], v2 offset:7168
v_cvt_pk_bf16_f32 v52, v20, v21
v_mfma_f32_16x16x32_bf16 v[40:43], a[16:19], a[192:195], v[88:91]
v_mfma_f32_16x16x32_bf16 v[40:43], a[20:23], a[196:199], v[40:43]
v_exp_f32 v23, v23
v_mfma_f32_16x16x32_bf16 v[40:43], a[24:27], a[200:203], v[40:43]
v_exp_f32 v24, v24
v_mfma_f32_16x16x32_bf16 v[40:43], a[28:31], a[204:207], v[40:43]
v_cvt_pk_bf16_f32 v53, v22, v23
v_mfma_f32_16x16x32_bf16 v[44:47], a[16:19], a[208:211], v[92:95]
v_exp_f32 v25, v25
v_mfma_f32_16x16x32_bf16 v[44:47], a[20:23], a[212:215], v[44:47]
v_exp_f32 v26, v26
v_mfma_f32_16x16x32_bf16 v[44:47], a[24:27], a[216:219], v[44:47]
v_exp_f32 v27, v27
v_mfma_f32_16x16x32_bf16 v[44:47], a[28:31], a[220:223], v[44:47]
v_cvt_pk_bf16_f32 v56, v24, v25
v_cvt_pk_bf16_f32 v57, v26, v27
s_waitcnt lgkmcnt(0)
v_mfma_f32_16x16x32_bf16 v[128:131], a[32:35], v[64:67], v[128:131]
ds_read_b128 a[0:3], v2 offset:24576
v_mfma_f32_16x16x32_bf16 v[160:163], a[32:35], v[68:71], v[160:163]
v_exp_f32 v28, v28
v_mfma_f32_16x16x32_bf16 v[192:195], a[32:35], v[72:75], v[192:195]
v_mfma_f32_16x16x32_bf16 v[224:227], a[32:35], v[76:79], v[224:227]
ds_read_b128 a[4:7], v2 offset:25600
v_mfma_f32_16x16x32_bf16 v[228:231], a[36:39], v[76:79], v[228:231]
v_exp_f32 v29, v29
v_mfma_f32_16x16x32_bf16 v[196:199], a[36:39], v[72:75], v[196:199]
v_exp_f32 v30, v30
v_mfma_f32_16x16x32_bf16 v[164:167], a[36:39], v[68:71], v[164:167]
v_cvt_pk_bf16_f32 v60, v28, v29
v_mfma_f32_16x16x32_bf16 v[132:135], a[36:39], v[64:67], v[132:135]
ds_read_b128 a[8:11], v2 offset:26624
s_add_u32 m0, s19, 0x1000
v_mfma_f32_16x16x32_bf16 v[136:139], a[40:43], v[64:67], v[136:139]
buffer_load_dwordx4 v3, s[48:51], s7 offen offset:0 sc1 lds
v_mfma_f32_16x16x32_bf16 v[168:171], a[40:43], v[68:71], v[168:171]
v_exp_f32 v31, v31
v_mfma_f32_16x16x32_bf16 v[200:203], a[40:43], v[72:75], v[200:203]
v_exp_f32 v32, v32
v_mfma_f32_16x16x32_bf16 v[232:235], a[40:43], v[76:79], v[232:235]
ds_read_b128 a[12:15], v2 offset:27648
v_cvt_pk_bf16_f32 v61, v30, v31
v_mfma_f32_16x16x32_bf16 v[236:239], a[44:47], v[76:79], v[236:239]
v_mfma_f32_16x16x32_bf16 v[204:207], a[44:47], v[72:75], v[204:207]
v_exp_f32 v33, v33
v_mfma_f32_16x16x32_bf16 v[172:175], a[44:47], v[68:71], v[172:175]
v_exp_f32 v34, v34
v_mfma_f32_16x16x32_bf16 v[140:143], a[44:47], v[64:67], v[140:143]
ds_read_b128 a[16:19], v2 offset:28672
v_cvt_pk_bf16_f32 v50, v32, v33
v_mfma_f32_16x16x32_bf16 v[144:147], a[48:51], v[64:67], v[144:147]
v_exp_f32 v35, v35
v_mfma_f32_16x16x32_bf16 v[176:179], a[48:51], v[68:71], v[176:179]
v_cvt_pk_bf16_f32 v51, v34, v35
v_mfma_f32_16x16x32_bf16 v[208:211], a[48:51], v[72:75], v[208:211]
v_exp_f32 v36, v36
v_mfma_f32_16x16x32_bf16 v[240:243], a[48:51], v[76:79], v[240:243]
ds_read_b128 a[20:23], v2 offset:29696
v_mfma_f32_16x16x32_bf16 v[244:247], a[52:55], v[76:79], v[244:247]
v_exp_f32 v37, v37
v_mfma_f32_16x16x32_bf16 v[212:215], a[52:55], v[72:75], v[212:215]
v_cvt_pk_bf16_f32 v54, v36, v37
v_mfma_f32_16x16x32_bf16 v[180:183], a[52:55], v[68:71], v[180:183]
v_exp_f32 v38, v38
v_mfma_f32_16x16x32_bf16 v[148:151], a[52:55], v[64:67], v[148:151]
ds_read_b128 a[24:27], v2 offset:30720
v_mfma_f32_16x16x32_bf16 v[152:155], a[56:59], v[64:67], v[152:155]
buffer_load_dwordx4 v3, s[48:51], s7 offen offset:1024 sc1 lds
v_mfma_f32_16x16x32_bf16 v[184:187], a[56:59], v[68:71], v[184:187]
v_exp_f32 v39, v39
v_mfma_f32_16x16x32_bf16 v[216:219], a[56:59], v[72:75], v[216:219]
v_exp_f32 v40, v40
v_mfma_f32_16x16x32_bf16 v[248:251], a[56:59], v[76:79], v[248:251]
ds_read_b128 a[28:31], v2 offset:31744
v_cvt_pk_bf16_f32 v55, v38, v39
v_mfma_f32_16x16x32_bf16 v[252:255], a[60:63], v[76:79], v[252:255]
v_mfma_f32_16x16x32_bf16 v[220:223], a[60:63], v[72:75], v[220:223]
v_exp_f32 v41, v41
v_mfma_f32_16x16x32_bf16 v[188:191], a[60:63], v[68:71], v[188:191]
v_exp_f32 v42, v42
v_mfma_f32_16x16x32_bf16 v[156:159], a[60:63], v[64:67], v[156:159]
ds_read_b128 a[32:35], v2 offset:16384
v_cvt_pk_bf16_f32 v58, v40, v41
v_mfma_f32_16x16x32_bf16 a[224:227], a[240:243], v[64:67], a[224:227]
v_mfma_f32_16x16x32_bf16 a[228:231], a[240:243], v[68:71], a[228:231]
v_exp_f32 v43, v43
v_mfma_f32_16x16x32_bf16 a[232:235], a[240:243], v[72:75], a[232:235]
v_exp_f32 v44, v44
v_mfma_f32_16x16x32_bf16 a[236:239], a[240:243], v[76:79], a[236:239]
ds_read_b128 a[36:39], v2 offset:17408
s_waitcnt lgkmcnt(6)
v_mfma_f32_16x16x32_bf16 v[16:19], a[0:3], a[160:163], v[80:83]
v_exp_f32 v45, v45
v_mfma_f32_16x16x32_bf16 v[16:19], a[4:7], a[164:167], v[16:19]
v_cvt_pk_bf16_f32 v59, v42, v43
v_cvt_pk_bf16_f32 v62, v44, v45
v_mfma_f32_16x16x32_bf16 v[16:19], a[8:11], a[168:171], v[16:19]
v_exp_f32 v46, v46
v_mfma_f32_16x16x32_bf16 v[16:19], a[12:15], a[172:175], v[16:19]
ds_read_b128 a[40:43], v2 offset:18432
v_mfma_f32_16x16x32_bf16 v[20:23], a[0:3], a[176:179], v[84:87]
v_exp_f32 v47, v47
v_mfma_f32_16x16x32_bf16 v[20:23], a[4:7], a[180:183], v[20:23]
buffer_load_dwordx4 v3, s[48:51], s7 offen offset:2048 sc1 lds
v_mfma_f32_16x16x32_bf16 v[20:23], a[8:11], a[184:187], v[20:23]
v_cvt_pk_bf16_f32 v63, v46, v47
v_mfma_f32_16x16x32_bf16 v[20:23], a[12:15], a[188:191], v[20:23]
ds_read_b128 a[44:47], v2 offset:19456
v_mfma_f32_16x16x32_bf16 v[24:27], a[0:3], a[192:195], v[88:91]
v_exp_f32 v16, v16
v_mfma_f32_16x16x32_bf16 v[24:27], a[4:7], a[196:199], v[24:27]
v_exp_f32 v17, v17
v_mfma_f32_16x16x32_bf16 v[24:27], a[8:11], a[200:203], v[24:27]
v_exp_f32 v18, v18
v_mfma_f32_16x16x32_bf16 v[24:27], a[12:15], a[204:207], v[24:27]
ds_read_b128 a[48:51], v2 offset:20480
v_cvt_pk_bf16_f32 v64, v16, v17
v_mfma_f32_16x16x32_bf16 v[28:31], a[0:3], a[208:211], v[92:95]
v_mfma_f32_16x16x32_bf16 v[28:31], a[4:7], a[212:215], v[28:31]
v_exp_f32 v19, v19
v_mfma_f32_16x16x32_bf16 v[28:31], a[8:11], a[216:219], v[28:31]
v_exp_f32 v20, v20
v_mfma_f32_16x16x32_bf16 v[28:31], a[12:15], a[220:223], v[28:31]
ds_read_b128 a[52:55], v2 offset:21504
s_waitcnt lgkmcnt(6)
v_mfma_f32_16x16x32_bf16 v[32:35], a[16:19], a[160:163], v[80:83]
v_cvt_pk_bf16_f32 v65, v18, v19
v_mfma_f32_16x16x32_bf16 v[32:35], a[20:23], a[164:167], v[32:35]
v_exp_f32 v21, v21
v_mfma_f32_16x16x32_bf16 v[32:35], a[24:27], a[168:171], v[32:35]
v_exp_f32 v22, v22
v_mfma_f32_16x16x32_bf16 v[32:35], a[28:31], a[172:175], v[32:35]
ds_read_b128 a[56:59], v2 offset:22528
v_cvt_pk_bf16_f32 v68, v20, v21
v_mfma_f32_16x16x32_bf16 v[36:39], a[16:19], a[176:179], v[84:87]
v_exp_f32 v23, v23
v_mfma_f32_16x16x32_bf16 v[36:39], a[20:23], a[180:183], v[36:39]
buffer_load_dwordx4 v3, s[48:51], s7 offen offset:3072 sc1 lds
v_mfma_f32_16x16x32_bf16 v[36:39], a[24:27], a[184:187], v[36:39]
v_cvt_pk_bf16_f32 v69, v22, v23
v_mfma_f32_16x16x32_bf16 v[36:39], a[28:31], a[188:191], v[36:39]
ds_read_b128 a[60:63], v2 offset:23552
s_add_u32 s32, s32, 0x8000
v_mfma_f32_16x16x32_bf16 v[40:43], a[16:19], a[192:195], v[88:91]
s_add_u32 s7, s7, 0x8000
s_xor_b32 s19, s19, 0x8000
v_xor_b32 v2, 0x38000, v2
v_mfma_f32_16x16x32_bf16 v[40:43], a[20:23], a[196:199], v[40:43]
s_sub_u32 s15, s15, 1
s_cmp_lg_u32 s15, 0
v_mfma_f32_16x16x32_bf16 v[40:43], a[24:27], a[200:203], v[40:43]
v_exp_f32 v24, v24
v_mfma_f32_16x16x32_bf16 v[40:43], a[28:31], a[204:207], v[40:43]
v_exp_f32 v25, v25
v_mfma_f32_16x16x32_bf16 v[44:47], a[16:19], a[208:211], v[92:95]
v_cvt_pk_bf16_f32 v72, v24, v25
v_mfma_f32_16x16x32_bf16 v[44:47], a[20:23], a[212:215], v[44:47]
v_exp_f32 v26, v26
v_mfma_f32_16x16x32_bf16 v[44:47], a[24:27], a[216:219], v[44:47]
v_exp_f32 v27, v27
v_mfma_f32_16x16x32_bf16 v[44:47], a[28:31], a[220:223], v[44:47]
v_cvt_pk_bf16_f32 v73, v26, v27
s_cbranch_scc1 L_att_deven
s_cmp_ge_u32 s4, 2
s_cbranch_scc1 L_att_dl0_1
L_att_dl0_0:
s_waitcnt vmcnt(16) lgkmcnt(0)
s_barrier
v_mfma_f32_16x16x32_bf16 v[128:131], a[32:35], v[48:51], v[128:131]
ds_read_b128 a[0:3], v1 offset:8192
v_mfma_f32_16x16x32_bf16 v[160:163], a[32:35], v[52:55], v[160:163]
v_exp_f32 v28, v28
v_mfma_f32_16x16x32_bf16 v[192:195], a[32:35], v[56:59], v[192:195]
v_mfma_f32_16x16x32_bf16 v[224:227], a[32:35], v[60:63], v[224:227]
ds_read_b128 a[4:7], v1 offset:9216
v_mfma_f32_16x16x32_bf16 v[228:231], a[36:39], v[60:63], v[228:231]
s_add_u32 m0, s27, 0x0
v_exp_f32 v29, v29
v_mfma_f32_16x16x32_bf16 v[196:199], a[36:39], v[56:59], v[196:199]
buffer_load_dwordx4 v3, s[48:51], s32 offen offset:0 sc1 lds
v_mfma_f32_16x16x32_bf16 v[164:167], a[36:39], v[52:55], v[164:167]
v_exp_f32 v30, v30
v_mfma_f32_16x16x32_bf16 v[132:135], a[36:39], v[48:51], v[132:135]
ds_read_b128 a[8:11], v1 offset:10240
v_cvt_pk_bf16_f32 v76, v28, v29
v_mfma_f32_16x16x32_bf16 v[136:139], a[40:43], v[48:51], v[136:139]
v_mfma_f32_16x16x32_bf16 v[168:171], a[40:43], v[52:55], v[168:171]
v_exp_f32 v31, v31
v_mfma_f32_16x16x32_bf16 v[200:203], a[40:43], v[56:59], v[200:203]
v_exp_f32 v32, v32
v_mfma_f32_16x16x32_bf16 v[232:235], a[40:43], v[60:63], v[232:235]
ds_read_b128 a[12:15], v1 offset:11264
v_cvt_pk_bf16_f32 v77, v30, v31
v_mfma_f32_16x16x32_bf16 v[236:239], a[44:47], v[60:63], v[236:239]
v_mfma_f32_16x16x32_bf16 v[204:207], a[44:47], v[56:59], v[204:207]
v_exp_f32 v33, v33
v_mfma_f32_16x16x32_bf16 v[172:175], a[44:47], v[52:55], v[172:175]
v_exp_f32 v34, v34
v_mfma_f32_16x16x32_bf16 v[140:143], a[44:47], v[48:51], v[140:143]
ds_read_b128 a[16:19], v1 offset:12288
s_mov_b32 s9, 0x0
v_mfma_f32_16x16x32_bf16 v[144:147], a[48:51], v[48:51], v[144:147]
buffer_load_dword v9, v8, s[72:75], s9 offen
v_mfma_f32_16x16x32_bf16 v[176:179], a[48:51], v[52:55], v[176:179]
v_cvt_pk_bf16_f32 v66, v32, v33
v_mfma_f32_16x16x32_bf16 v[208:211], a[48:51], v[56:59], v[208:211]
v_exp_f32 v35, v35
v_mfma_f32_16x16x32_bf16 v[240:243], a[48:51], v[60:63], v[240:243]
ds_read_b128 a[20:23], v1 offset:13312
v_cvt_pk_bf16_f32 v67, v34, v35
v_mfma_f32_16x16x32_bf16 v[244:247], a[52:55], v[60:63], v[244:247]
v_exp_f32 v36, v36
v_mfma_f32_16x16x32_bf16 v[212:215], a[52:55], v[56:59], v[212:215]
v_exp_f32 v37, v37
v_mfma_f32_16x16x32_bf16 v[180:183], a[52:55], v[52:55], v[180:183]
v_cvt_pk_bf16_f32 v70, v36, v37
v_mfma_f32_16x16x32_bf16 v[148:151], a[52:55], v[48:51], v[148:151]
ds_read_b128 a[24:27], v1 offset:14336
v_mfma_f32_16x16x32_bf16 v[152:155], a[56:59], v[48:51], v[152:155]
v_exp_f32 v38, v38
v_mfma_f32_16x16x32_bf16 v[184:187], a[56:59], v[52:55], v[184:187]
v_exp_f32 v39, v39
v_mfma_f32_16x16x32_bf16 v[216:219], a[56:59], v[56:59], v[216:219]
v_cvt_pk_bf16_f32 v71, v38, v39
v_mfma_f32_16x16x32_bf16 v[248:251], a[56:59], v[60:63], v[248:251]
buffer_load_dwordx4 v3, s[48:51], s32 offen offset:1024 sc1 lds
v_mfma_f32_16x16x32_bf16 v[252:255], a[60:63], v[60:63], v[252:255]
ds_read_b128 a[28:31], v1 offset:15360
v_mfma_f32_16x16x32_bf16 v[220:223], a[60:63], v[56:59], v[220:223]
v_exp_f32 v40, v40
v_mfma_f32_16x16x32_bf16 v[188:191], a[60:63], v[52:55], v[188:191]
v_exp_f32 v41, v41
v_mfma_f32_16x16x32_bf16 v[156:159], a[60:63], v[48:51], v[156:159]
ds_read_b128 a[32:35], v1 offset:0
v_cvt_pk_bf16_f32 v74, v40, v41
v_mfma_f32_16x16x32_bf16 a[224:227], a[240:243], v[48:51], a[224:227]
v_mfma_f32_16x16x32_bf16 a[228:231], a[240:243], v[52:55], a[228:231]
v_exp_f32 v42, v42
v_mfma_f32_16x16x32_bf16 a[232:235], a[240:243], v[56:59], a[232:235]
v_exp_f32 v43, v43
v_mfma_f32_16x16x32_bf16 a[236:239], a[240:243], v[60:63], a[236:239]
ds_read_b128 a[36:39], v1 offset:1024
s_waitcnt lgkmcnt(6)
v_mfma_f32_16x16x32_bf16 v[16:19], a[0:3], a[160:163], v[96:99]
v_exp_f32 v44, v44
v_mfma_f32_16x16x32_bf16 v[16:19], a[4:7], a[164:167], v[16:19]
v_cvt_pk_bf16_f32 v75, v42, v43
v_mfma_f32_16x16x32_bf16 v[16:19], a[8:11], a[168:171], v[16:19]
buffer_load_dwordx4 v3, s[48:51], s32 offen offset:2048 sc1 lds
v_mfma_f32_16x16x32_bf16 v[16:19], a[12:15], a[172:175], v[16:19]
ds_read_b128 a[40:43], v1 offset:2048
v_mfma_f32_16x16x32_bf16 v[20:23], a[0:3], a[176:179], v[84:87]
v_exp_f32 v45, v45
v_mfma_f32_16x16x32_bf16 v[20:23], a[4:7], a[180:183], v[20:23]
v_exp_f32 v46, v46
v_mfma_f32_16x16x32_bf16 v[20:23], a[8:11], a[184:187], v[20:23]
v_cvt_pk_bf16_f32 v78, v44, v45
v_mfma_f32_16x16x32_bf16 v[20:23], a[12:15], a[188:191], v[20:23]
ds_read_b128 a[44:47], v1 offset:3072
v_mfma_f32_16x16x32_bf16 v[24:27], a[0:3], a[192:195], v[88:91]
v_exp_f32 v47, v47
v_mfma_f32_16x16x32_bf16 v[24:27], a[4:7], a[196:199], v[24:27]
v_exp_f32 v16, v16
v_mfma_f32_16x16x32_bf16 v[24:27], a[8:11], a[200:203], v[24:27]
v_cvt_pk_bf16_f32 v79, v46, v47
v_mfma_f32_16x16x32_bf16 v[24:27], a[12:15], a[204:207], v[24:27]
ds_read_b128 a[48:51], v1 offset:4096
v_mfma_f32_16x16x32_bf16 v[28:31], a[0:3], a[208:211], v[92:95]
v_exp_f32 v17, v17
v_mfma_f32_16x16x32_bf16 v[28:31], a[4:7], a[212:215], v[28:31]
buffer_load_dwordx4 v3, s[48:51], s32 offen offset:3072 sc1 lds
v_mfma_f32_16x16x32_bf16 v[28:31], a[8:11], a[216:219], v[28:31]
v_exp_f32 v18, v18
v_mfma_f32_16x16x32_bf16 v[28:31], a[12:15], a[220:223], v[28:31]
ds_read_b128 a[52:55], v1 offset:5120
s_waitcnt lgkmcnt(6)
v_mfma_f32_16x16x32_bf16 v[32:35], a[16:19], a[160:163], v[100:103]
v_cvt_pk_bf16_f32 v48, v16, v17
v_mfma_f32_16x16x32_bf16 v[32:35], a[20:23], a[164:167], v[32:35]
v_exp_f32 v19, v19
v_mfma_f32_16x16x32_bf16 v[32:35], a[24:27], a[168:171], v[32:35]
v_exp_f32 v20, v20
v_mfma_f32_16x16x32_bf16 v[32:35], a[28:31], a[172:175], v[32:35]
ds_read_b128 a[56:59], v1 offset:6144
v_cvt_pk_bf16_f32 v49, v18, v19
v_mfma_f32_16x16x32_bf16 v[36:39], a[16:19], a[176:179], v[84:87]
v_exp_f32 v21, v21
v_mfma_f32_16x16x32_bf16 v[36:39], a[20:23], a[180:183], v[36:39]
v_cvt_pk_bf16_f32 v52, v20, v21
v_mfma_f32_16x16x32_bf16 v[36:39], a[24:27], a[184:187], v[36:39]
v_exp_f32 v22, v22
v_mfma_f32_16x16x32_bf16 v[36:39], a[28:31], a[188:191], v[36:39]
ds_read_b128 a[60:63], v1 offset:7168
s_mov_b32 s9, 0x0
v_mfma_f32_16x16x32_bf16 v[40:43], a[16:19], a[192:195], v[88:91]
buffer_load_dword v9, v8, s[64:67], s9 offen
v_mfma_f32_16x16x32_bf16 v[40:43], a[20:23], a[196:199], v[40:43]
v_exp_f32 v23, v23
v_mfma_f32_16x16x32_bf16 v[40:43], a[24:27], a[200:203], v[40:43]
v_cvt_pk_bf16_f32 v53, v22, v23
v_mfma_f32_16x16x32_bf16 v[40:43], a[28:31], a[204:207], v[40:43]
v_exp_f32 v24, v24
v_mfma_f32_16x16x32_bf16 v[44:47], a[16:19], a[208:211], v[92:95]
v_exp_f32 v25, v25
v_mfma_f32_16x16x32_bf16 v[44:47], a[20:23], a[212:215], v[44:47]
v_exp_f32 v26, v26
v_mfma_f32_16x16x32_bf16 v[44:47], a[24:27], a[216:219], v[44:47]
v_exp_f32 v27, v27
v_mfma_f32_16x16x32_bf16 v[44:47], a[28:31], a[220:223], v[44:47]
v_cvt_pk_bf16_f32 v56, v24, v25
v_cvt_pk_bf16_f32 v57, v26, v27
s_waitcnt lgkmcnt(0)
v_mfma_f32_16x16x32_bf16 v[128:131], a[32:35], v[64:67], v[128:131]
ds_read_b128 a[0:3], v1 offset:24576
v_mfma_f32_16x16x32_bf16 v[160:163], a[32:35], v[68:71], v[160:163]
v_exp_f32 v28, v28
v_mfma_f32_16x16x32_bf16 v[192:195], a[32:35], v[72:75], v[192:195]
v_mfma_f32_16x16x32_bf16 v[224:227], a[32:35], v[76:79], v[224:227]
ds_read_b128 a[4:7], v1 offset:25600
v_mfma_f32_16x16x32_bf16 v[228:231], a[36:39], v[76:79], v[228:231]
s_add_u32 m0, s27, 0x1000
v_exp_f32 v29, v29
v_mfma_f32_16x16x32_bf16 v[196:199], a[36:39], v[72:75], v[196:199]
buffer_load_dwordx4 v3, s[48:51], s7 offen offset:0 sc1 lds
v_mfma_f32_16x16x32_bf16 v[164:167], a[36:39], v[68:71], v[164:167]
ds_read_b128 a[8:11], v1 offset:26624
v_cvt_pk_bf16_f32 v60, v28, v29
v_mfma_f32_16x16x32_bf16 v[132:135], a[36:39], v[64:67], v[132:135]
v_exp_f32 v30, v30
v_mfma_f32_16x16x32_bf16 v[136:139], a[40:43], v[64:67], v[136:139]
v_exp_f32 v31, v31
v_mfma_f32_16x16x32_bf16 v[168:171], a[40:43], v[68:71], v[168:171]
v_cvt_pk_bf16_f32 v61, v30, v31
v_mfma_f32_16x16x32_bf16 v[200:203], a[40:43], v[72:75], v[200:203]
ds_read_b128 a[12:15], v1 offset:27648
v_mfma_f32_16x16x32_bf16 v[232:235], a[40:43], v[76:79], v[232:235]
v_exp_f32 v32, v32
v_mfma_f32_16x16x32_bf16 v[236:239], a[44:47], v[76:79], v[236:239]
v_exp_f32 v33, v33
v_mfma_f32_16x16x32_bf16 v[204:207], a[44:47], v[72:75], v[204:207]
ds_read_b128 a[16:19], v1 offset:28672
v_cvt_pk_bf16_f32 v50, v32, v33
v_mfma_f32_16x16x32_bf16 v[172:175], a[44:47], v[68:71], v[172:175]
v_exp_f32 v34, v34
v_mfma_f32_16x16x32_bf16 v[140:143], a[44:47], v[64:67], v[140:143]
v_exp_f32 v35, v35
v_mfma_f32_16x16x32_bf16 v[144:147], a[48:51], v[64:67], v[144:147]
v_cvt_pk_bf16_f32 v51, v34, v35
v_mfma_f32_16x16x32_bf16 v[176:179], a[48:51], v[68:71], v[176:179]
buffer_load_dwordx4 v3, s[48:51], s7 offen offset:1024 sc1 lds
v_mfma_f32_16x16x32_bf16 v[208:211], a[48:51], v[72:75], v[208:211]
ds_read_b128 a[20:23], v1 offset:29696
v_mfma_f32_16x16x32_bf16 v[240:243], a[48:51], v[76:79], v[240:243]
v_exp_f32 v36, v36
v_mfma_f32_16x16x32_bf16 v[244:247], a[52:55], v[76:79], v[244:247]
ds_read_b128 a[24:27], v1 offset:30720
v_mfma_f32_16x16x32_bf16 v[212:215], a[52:55], v[72:75], v[212:215]
v_exp_f32 v37, v37
v_mfma_f32_16x16x32_bf16 v[180:183], a[52:55], v[68:71], v[180:183]
v_exp_f32 v38, v38
v_mfma_f32_16x16x32_bf16 v[148:151], a[52:55], v[64:67], v[148:151]
v_cvt_pk_bf16_f32 v54, v36, v37
v_mfma_f32_16x16x32_bf16 v[152:155], a[56:59], v[64:67], v[152:155]
ds_read_b128 a[28:31], v1 offset:31744
v_mfma_f32_16x16x32_bf16 v[184:187], a[56:59], v[68:71], v[184:187]
v_exp_f32 v39, v39
v_mfma_f32_16x16x32_bf16 v[216:219], a[56:59], v[72:75], v[216:219]
v_exp_f32 v40, v40
v_mfma_f32_16x16x32_bf16 v[248:251], a[56:59], v[76:79], v[248:251]
ds_read_b128 a[32:35], v1 offset:16384
v_cvt_pk_bf16_f32 v55, v38, v39
v_mfma_f32_16x16x32_bf16 v[252:255], a[60:63], v[76:79], v[252:255]
v_exp_f32 v41, v41
v_mfma_f32_16x16x32_bf16 v[220:223], a[60:63], v[72:75], v[220:223]
buffer_load_dwordx4 v3, s[48:51], s7 offen offset:2048 sc1 lds
v_mfma_f32_16x16x32_bf16 v[188:191], a[60:63], v[68:71], v[188:191]
ds_read_b128 a[36:39], v1 offset:17408
v_cvt_pk_bf16_f32 v58, v40, v41
v_mfma_f32_16x16x32_bf16 v[156:159], a[60:63], v[64:67], v[156:159]
v_exp_f32 v42, v42
v_mfma_f32_16x16x32_bf16 a[224:227], a[240:243], v[64:67], a[224:227]
v_mfma_f32_16x16x32_bf16 a[228:231], a[240:243], v[68:71], a[228:231]
v_exp_f32 v43, v43
v_mfma_f32_16x16x32_bf16 a[232:235], a[240:243], v[72:75], a[232:235]
ds_read_b128 a[40:43], v1 offset:18432
v_cvt_pk_bf16_f32 v59, v42, v43
v_mfma_f32_16x16x32_bf16 a[236:239], a[240:243], v[76:79], a[236:239]
s_waitcnt lgkmcnt(7)
v_exp_f32 v44, v44
v_mfma_f32_16x16x32_bf16 v[20:23], a[0:3], a[176:179], v[84:87]
v_exp_f32 v45, v45
v_mfma_f32_16x16x32_bf16 v[20:23], a[4:7], a[180:183], v[20:23]
ds_read_b128 a[44:47], v1 offset:19456
v_cvt_pk_bf16_f32 v62, v44, v45
v_mfma_f32_16x16x32_bf16 v[20:23], a[8:11], a[184:187], v[20:23]
v_mfma_f32_16x16x32_bf16 v[20:23], a[12:15], a[188:191], v[20:23]
s_mov_b32 s9, 0x400000
v_exp_f32 v46, v46
v_mfma_f32_16x16x32_bf16 v[24:27], a[0:3], a[192:195], v[88:91]
buffer_load_dword v9, v8, s[64:67], s9 offen
v_mfma_f32_16x16x32_bf16 v[24:27], a[4:7], a[196:199], v[24:27]
ds_read_b128 a[48:51], v1 offset:20480
v_mfma_f32_16x16x32_bf16 v[24:27], a[8:11], a[200:203], v[24:27]
v_exp_f32 v47, v47
v_mfma_f32_16x16x32_bf16 v[24:27], a[12:15], a[204:207], v[24:27]
v_exp_f32 v20, v20
v_mfma_f32_16x16x32_bf16 v[28:31], a[0:3], a[208:211], v[92:95]
ds_read_b128 a[52:55], v1 offset:21504
v_cvt_pk_bf16_f32 v63, v46, v47
v_mfma_f32_16x16x32_bf16 v[28:31], a[4:7], a[212:215], v[28:31]
v_exp_f32 v21, v21
v_mfma_f32_16x16x32_bf16 v[28:31], a[8:11], a[216:219], v[28:31]
v_cvt_pk_bf16_f32 v68, v20, v21
v_mfma_f32_16x16x32_bf16 v[28:31], a[12:15], a[220:223], v[28:31]
s_waitcnt lgkmcnt(6)
v_exp_f32 v22, v22
v_mfma_f32_16x16x32_bf16 v[36:39], a[16:19], a[176:179], v[84:87]
ds_read_b128 a[56:59], v1 offset:22528
v_mfma_f32_16x16x32_bf16 v[36:39], a[20:23], a[180:183], v[36:39]
v_exp_f32 v23, v23
v_mfma_f32_16x16x32_bf16 v[36:39], a[24:27], a[184:187], v[36:39]
v_exp_f32 v24, v24
v_mfma_f32_16x16x32_bf16 v[36:39], a[28:31], a[188:191], v[36:39]
ds_read_b128 a[60:63], v1 offset:23552
v_cvt_pk_bf16_f32 v69, v22, v23
v_mfma_f32_16x16x32_bf16 v[40:43], a[16:19], a[192:195], v[88:91]
buffer_load_dwordx4 v3, s[48:51], s7 offen offset:3072 sc1 lds
v_mfma_f32_16x16x32_bf16 v[40:43], a[20:23], a[196:199], v[40:43]
s_add_u32 s32, s32, 0x8000
s_add_u32 s7, s7, 0x8000
s_xor_b32 s27, s27, 0x38000
v_mfma_f32_16x16x32_bf16 v[40:43], a[24:27], a[200:203], v[40:43]
v_xor_b32 v1, 0x8000, v1
v_mfma_f32_16x16x32_bf16 v[40:43], a[28:31], a[204:207], v[40:43]
v_mfma_f32_16x16x32_bf16 v[44:47], a[16:19], a[208:211], v[92:95]
v_exp_f32 v25, v25
v_mfma_f32_16x16x32_bf16 v[44:47], a[20:23], a[212:215], v[44:47]
v_exp_f32 v26, v26
v_mfma_f32_16x16x32_bf16 v[44:47], a[24:27], a[216:219], v[44:47]
v_exp_f32 v27, v27
v_mfma_f32_16x16x32_bf16 v[44:47], a[28:31], a[220:223], v[44:47]
v_cvt_pk_bf16_f32 v72, v24, v25
v_cvt_pk_bf16_f32 v73, v26, v27
L_att_l1_0:
s_waitcnt vmcnt(16) lgkmcnt(0)
s_barrier
v_mfma_f32_16x16x32_bf16 v[128:131], a[32:35], v[48:51], v[128:131]
ds_read_b128 a[0:3], v2 offset:8192
v_mfma_f32_16x16x32_bf16 v[160:163], a[32:35], v[52:55], v[160:163]
v_exp_f32 v28, v28
v_mfma_f32_16x16x32_bf16 v[192:195], a[32:35], v[56:59], v[192:195]
v_mfma_f32_16x16x32_bf16 v[224:227], a[32:35], v[60:63], v[224:227]
ds_read_b128 a[4:7], v2 offset:9216
s_add_u32 m0, s19, 0x0
v_mfma_f32_16x16x32_bf16 v[228:231], a[36:39], v[60:63], v[228:231]
buffer_load_dwordx4 v3, s[48:51], s32 offen offset:0 sc1 lds
v_mfma_f32_16x16x32_bf16 v[196:199], a[36:39], v[56:59], v[196:199]
v_exp_f32 v29, v29
v_mfma_f32_16x16x32_bf16 v[164:167], a[36:39], v[52:55], v[164:167]
ds_read_b128 a[8:11], v2 offset:10240
v_cvt_pk_bf16_f32 v76, v28, v29
v_mfma_f32_16x16x32_bf16 v[132:135], a[36:39], v[48:51], v[132:135]
v_mfma_f32_16x16x32_bf16 v[136:139], a[40:43], v[48:51], v[136:139]
v_exp_f32 v30, v30
v_mfma_f32_16x16x32_bf16 v[168:171], a[40:43], v[52:55], v[168:171]
v_exp_f32 v31, v31
v_mfma_f32_16x16x32_bf16 v[200:203], a[40:43], v[56:59], v[200:203]
ds_read_b128 a[12:15], v2 offset:11264
v_cvt_pk_bf16_f32 v77, v30, v31
v_mfma_f32_16x16x32_bf16 v[232:235], a[40:43], v[60:63], v[232:235]
v_mfma_f32_16x16x32_bf16 v[236:239], a[44:47], v[60:63], v[236:239]
v_exp_f32 v36, v36
v_mfma_f32_16x16x32_bf16 v[204:207], a[44:47], v[56:59], v[204:207]
ds_read_b128 a[16:19], v2 offset:12288
s_mov_b32 s9, 0x200000
v_mfma_f32_16x16x32_bf16 v[172:175], a[44:47], v[52:55], v[172:175]
buffer_load_dword v9, v8, s[64:67], s9 offen
v_mfma_f32_16x16x32_bf16 v[140:143], a[44:47], v[48:51], v[140:143]
v_exp_f32 v37, v37
v_mfma_f32_16x16x32_bf16 v[144:147], a[48:51], v[48:51], v[144:147]
v_cvt_pk_bf16_f32 v70, v36, v37
v_mfma_f32_16x16x32_bf16 v[176:179], a[48:51], v[52:55], v[176:179]
ds_read_b128 a[20:23], v2 offset:13312
v_mfma_f32_16x16x32_bf16 v[208:211], a[48:51], v[56:59], v[208:211]
v_exp_f32 v38, v38
v_mfma_f32_16x16x32_bf16 v[240:243], a[48:51], v[60:63], v[240:243]
v_mfma_f32_16x16x32_bf16 v[244:247], a[52:55], v[60:63], v[244:247]
ds_read_b128 a[24:27], v2 offset:14336
v_mfma_f32_16x16x32_bf16 v[212:215], a[52:55], v[56:59], v[212:215]
v_exp_f32 v39, v39
v_mfma_f32_16x16x32_bf16 v[180:183], a[52:55], v[52:55], v[180:183]
v_exp_f32 v40, v40
v_mfma_f32_16x16x32_bf16 v[148:151], a[52:55], v[48:51], v[148:151]
v_cvt_pk_bf16_f32 v71, v38, v39
v_mfma_f32_16x16x32_bf16 v[152:155], a[56:59], v[48:51], v[152:155]
buffer_load_dwordx4 v3, s[48:51], s32 offen offset:1024 sc1 lds
v_mfma_f32_16x16x32_bf16 v[184:187], a[56:59], v[52:55], v[184:187]
ds_read_b128 a[28:31], v2 offset:15360
v_mfma_f32_16x16x32_bf16 v[216:219], a[56:59], v[56:59], v[216:219]
v_exp_f32 v41, v41
v_mfma_f32_16x16x32_bf16 v[248:251], a[56:59], v[60:63], v[248:251]
ds_read_b128 a[32:35], v2 offset:0
v_cvt_pk_bf16_f32 v74, v40, v41
v_mfma_f32_16x16x32_bf16 v[252:255], a[60:63], v[60:63], v[252:255]
v_exp_f32 v42, v42
v_mfma_f32_16x16x32_bf16 v[220:223], a[60:63], v[56:59], v[220:223]
v_mfma_f32_16x16x32_bf16 v[188:191], a[60:63], v[52:55], v[188:191]
ds_read_b128 a[36:39], v2 offset:1024
v_mfma_f32_16x16x32_bf16 v[156:159], a[60:63], v[48:51], v[156:159]
v_exp_f32 v43, v43
v_mfma_f32_16x16x32_bf16 a[224:227], a[240:243], v[48:51], a[224:227]
v_exp_f32 v44, v44
v_mfma_f32_16x16x32_bf16 a[228:231], a[240:243], v[52:55], a[228:231]
buffer_load_dwordx4 v3, s[48:51], s32 offen offset:2048 sc1 lds
v_mfma_f32_16x16x32_bf16 a[232:235], a[240:243], v[56:59], a[232:235]
ds_read_b128 a[40:43], v2 offset:2048
v_cvt_pk_bf16_f32 v75, v42, v43
v_mfma_f32_16x16x32_bf16 a[236:239], a[240:243], v[60:63], a[236:239]
s_waitcnt lgkmcnt(7)
v_mfma_f32_16x16x32_bf16 v[20:23], a[0:3], a[176:179], v[84:87]
v_exp_f32 v45, v45
v_mfma_f32_16x16x32_bf16 v[20:23], a[4:7], a[180:183], v[20:23]
ds_read_b128 a[44:47], v2 offset:3072
v_cvt_pk_bf16_f32 v78, v44, v45
v_mfma_f32_16x16x32_bf16 v[20:23], a[8:11], a[184:187], v[20:23]
v_mfma_f32_16x16x32_bf16 v[20:23], a[12:15], a[188:191], v[20:23]
v_exp_f32 v46, v46
v_mfma_f32_16x16x32_bf16 v[24:27], a[0:3], a[192:195], v[88:91]
v_exp_f32 v47, v47
v_mfma_f32_16x16x32_bf16 v[24:27], a[4:7], a[196:199], v[24:27]
ds_read_b128 a[48:51], v2 offset:4096
v_cvt_pk_bf16_f32 v79, v46, v47
v_mfma_f32_16x16x32_bf16 v[24:27], a[8:11], a[200:203], v[24:27]
v_mfma_f32_16x16x32_bf16 v[24:27], a[12:15], a[204:207], v[24:27]
buffer_load_dwordx4 v3, s[48:51], s32 offen offset:3072 sc1 lds
v_mfma_f32_16x16x32_bf16 v[28:31], a[0:3], a[208:211], v[92:95]
ds_read_b128 a[52:55], v2 offset:5120
v_mfma_f32_16x16x32_bf16 v[28:31], a[4:7], a[212:215], v[28:31]
v_exp_f32 v20, v20
v_mfma_f32_16x16x32_bf16 v[28:31], a[8:11], a[216:219], v[28:31]
v_exp_f32 v21, v21
v_mfma_f32_16x16x32_bf16 v[28:31], a[12:15], a[220:223], v[28:31]
s_waitcnt lgkmcnt(6)
v_cvt_pk_bf16_f32 v52, v20, v21
v_mfma_f32_16x16x32_bf16 v[36:39], a[16:19], a[176:179], v[84:87]
ds_read_b128 a[56:59], v2 offset:6144
v_mfma_f32_16x16x32_bf16 v[36:39], a[20:23], a[180:183], v[36:39]
v_exp_f32 v22, v22
v_mfma_f32_16x16x32_bf16 v[36:39], a[24:27], a[184:187], v[36:39]
v_mfma_f32_16x16x32_bf16 v[36:39], a[28:31], a[188:191], v[36:39]
ds_read_b128 a[60:63], v2 offset:7168
v_mfma_f32_16x16x32_bf16 v[40:43], a[16:19], a[192:195], v[88:91]
s_mov_b32 s9, 0x600000
v_exp_f32 v23, v23
v_mfma_f32_16x16x32_bf16 v[40:43], a[20:23], a[196:199], v[40:43]
buffer_load_dword v9, v8, s[64:67], s9 offen
v_mfma_f32_16x16x32_bf16 v[40:43], a[24:27], a[200:203], v[40:43]
v_exp_f32 v24, v24
v_mfma_f32_16x16x32_bf16 v[40:43], a[28:31], a[204:207], v[40:43]
v_cvt_pk_bf16_f32 v53, v22, v23
v_mfma_f32_16x16x32_bf16 v[44:47], a[16:19], a[208:211], v[92:95]
v_exp_f32 v25, v25
v_mfma_f32_16x16x32_bf16 v[44:47], a[20:23], a[212:215], v[44:47]
v_exp_f32 v26, v26
v_mfma_f32_16x16x32_bf16 v[44:47], a[24:27], a[216:219], v[44:47]
v_exp_f32 v27, v27
v_mfma_f32_16x16x32_bf16 v[44:47], a[28:31], a[220:223], v[44:47]
v_cvt_pk_bf16_f32 v56, v24, v25
v_cvt_pk_bf16_f32 v57, v26, v27
s_waitcnt lgkmcnt(0)
v_mfma_f32_16x16x32_bf16 v[160:163], a[32:35], v[68:71], v[160:163]
ds_read_b128 a[0:3], v2 offset:24576
v_mfma_f32_16x16x32_bf16 v[192:195], a[32:35], v[72:75], v[192:195]
v_exp_f32 v28, v28
v_mfma_f32_16x16x32_bf16 v[224:227], a[32:35], v[76:79], v[224:227]
ds_read_b128 a[4:7], v2 offset:25600
v_mfma_f32_16x16x32_bf16 v[228:231], a[36:39], v[76:79], v[228:231]
s_add_u32 m0, s19, 0x1000
v_mfma_f32_16x16x32_bf16 v[196:199], a[36:39], v[72:75], v[196:199]
buffer_load_dwordx4 v3, s[48:51], s7 offen offset:0 sc1 lds
v_mfma_f32_16x16x32_bf16 v[164:167], a[36:39], v[68:71], v[164:167]
ds_read_b128 a[8:11], v2 offset:26624
v_mfma_f32_16x16x32_bf16 v[168:171], a[40:43], v[68:71], v[168:171]
v_exp_f32 v29, v29
v_mfma_f32_16x16x32_bf16 v[200:203], a[40:43], v[72:75], v[200:203]
v_exp_f32 v30, v30
v_mfma_f32_16x16x32_bf16 v[232:235], a[40:43], v[76:79], v[232:235]
ds_read_b128 a[12:15], v2 offset:27648
v_cvt_pk_bf16_f32 v60, v28, v29
v_mfma_f32_16x16x32_bf16 v[236:239], a[44:47], v[76:79], v[236:239]
v_exp_f32 v31, v31
v_mfma_f32_16x16x32_bf16 v[204:207], a[44:47], v[72:75], v[204:207]
v_exp_f32 v36, v36
v_mfma_f32_16x16x32_bf16 v[172:175], a[44:47], v[68:71], v[172:175]
ds_read_b128 a[16:19], v2 offset:28672
v_cvt_pk_bf16_f32 v61, v30, v31
v_mfma_f32_16x16x32_bf16 v[176:179], a[48:51], v[68:71], v[176:179]
v_exp_f32 v37, v37
v_mfma_f32_16x16x32_bf16 v[208:211], a[48:51], v[72:75], v[208:211]
v_exp_f32 v38, v38
v_mfma_f32_16x16x32_bf16 v[240:243], a[48:51], v[76:79], v[240:243]
buffer_load_dwordx4 v3, s[48:51], s7 offen offset:1024 sc1 lds
v_mfma_f32_16x16x32_bf16 v[244:247], a[52:55], v[76:79], v[244:247]
ds_read_b128 a[20:23], v2 offset:29696
v_cvt_pk_bf16_f32 v54, v36, v37
v_mfma_f32_16x16x32_bf16 v[212:215], a[52:55], v[72:75], v[212:215]
v_exp_f32 v39, v39
v_mfma_f32_16x16x32_bf16 v[180:183], a[52:55], v[68:71], v[180:183]
ds_read_b128 a[24:27], v2 offset:30720
v_cvt_pk_bf16_f32 v55, v38, v39
v_mfma_f32_16x16x32_bf16 v[184:187], a[56:59], v[68:71], v[184:187]
v_exp_f32 v40, v40
v_mfma_f32_16x16x32_bf16 v[216:219], a[56:59], v[72:75], v[216:219]
v_exp_f32 v41, v41
v_mfma_f32_16x16x32_bf16 v[248:251], a[56:59], v[76:79], v[248:251]
ds_read_b128 a[28:31], v2 offset:31744
v_cvt_pk_bf16_f32 v58, v40, v41
v_mfma_f32_16x16x32_bf16 v[252:255], a[60:63], v[76:79], v[252:255]
v_exp_f32 v42, v42
v_mfma_f32_16x16x32_bf16 v[220:223], a[60:63], v[72:75], v[220:223]
v_exp_f32 v43, v43
v_mfma_f32_16x16x32_bf16 v[188:191], a[60:63], v[68:71], v[188:191]
ds_read_b128 a[32:35], v2 offset:16384
v_cvt_pk_bf16_f32 v59, v42, v43
v_mfma_f32_16x16x32_bf16 a[228:231], a[240:243], v[68:71], a[228:231]
buffer_load_dwordx4 v3, s[48:51], s7 offen offset:2048 sc1 lds
v_mfma_f32_16x16x32_bf16 a[232:235], a[240:243], v[72:75], a[232:235]
ds_read_b128 a[36:39], v2 offset:17408
v_mfma_f32_16x16x32_bf16 a[236:239], a[240:243], v[76:79], a[236:239]
s_waitcnt lgkmcnt(6)
v_exp_f32 v44, v44
v_mfma_f32_16x16x32_bf16 v[20:23], a[0:3], a[176:179], v[104:107]
v_mfma_f32_16x16x32_bf16 v[20:23], a[4:7], a[180:183], v[20:23]
ds_read_b128 a[40:43], v2 offset:18432
v_mfma_f32_16x16x32_bf16 v[20:23], a[8:11], a[184:187], v[20:23]
v_exp_f32 v45, v45
v_mfma_f32_16x16x32_bf16 v[20:23], a[12:15], a[188:191], v[20:23]
v_exp_f32 v46, v46
v_mfma_f32_16x16x32_bf16 v[24:27], a[0:3], a[192:195], v[88:91]
ds_read_b128 a[44:47], v2 offset:19456
v_cvt_pk_bf16_f32 v62, v44, v45
v_mfma_f32_16x16x32_bf16 v[24:27], a[4:7], a[196:199], v[24:27]
v_exp_f32 v47, v47
v_mfma_f32_16x16x32_bf16 v[24:27], a[8:11], a[200:203], v[24:27]
v_cvt_pk_bf16_f32 v63, v46, v47
v_mfma_f32_16x16x32_bf16 v[24:27], a[12:15], a[204:207], v[24:27]
buffer_load_dwordx4 v3, s[48:51], s7 offen offset:3072 sc1 lds
v_mfma_f32_16x16x32_bf16 v[28:31], a[0:3], a[208:211], v[92:95]
ds_read_b128 a[48:51], v2 offset:20480
v_exp_f32 v20, v20
v_mfma_f32_16x16x32_bf16 v[28:31], a[4:7], a[212:215], v[28:31]
v_exp_f32 v21, v21
v_mfma_f32_16x16x32_bf16 v[28:31], a[8:11], a[216:219], v[28:31]
ds_read_b128 a[52:55], v2 offset:21504
v_cvt_pk_bf16_f32 v68, v20, v21
v_mfma_f32_16x16x32_bf16 v[28:31], a[12:15], a[220:223], v[28:31]
s_waitcnt lgkmcnt(6)
v_exp_f32 v22, v22
v_mfma_f32_16x16x32_bf16 v[36:39], a[16:19], a[176:179], v[108:111]
v_exp_f32 v23, v23
v_mfma_f32_16x16x32_bf16 v[36:39], a[20:23], a[180:183], v[36:39]
ds_read_b128 a[56:59], v2 offset:22528
v_cvt_pk_bf16_f32 v69, v22, v23
v_mfma_f32_16x16x32_bf16 v[36:39], a[24:27], a[184:187], v[36:39]
v_exp_f32 v24, v24
v_mfma_f32_16x16x32_bf16 v[36:39], a[28:31], a[188:191], v[36:39]
v_mov_b32 v5, s77
v_mfma_f32_16x16x32_bf16 v[40:43], a[16:19], a[192:195], v[88:91]
ds_read_b128 a[60:63], v2 offset:23552
v_add_u32 v4, s76, v3
v_mfma_f32_16x16x32_bf16 v[40:43], a[20:23], a[196:199], v[40:43]
global_load_dword v9, v[4:5], off sc1
v_mfma_f32_16x16x32_bf16 v[40:43], a[24:27], a[200:203], v[40:43]
s_add_u32 s32, s32, 0x8000
s_add_u32 s7, s7, 0x8000
s_xor_b32 s19, s19, 0x8000
v_mfma_f32_16x16x32_bf16 v[40:43], a[28:31], a[204:207], v[40:43]
s_sub_u32 s15, 7, s6
s_lshl_b32 s15, s15, 1
v_xor_b32 v2, 0x38000, v2
v_mfma_f32_16x16x32_bf16 v[44:47], a[16:19], a[208:211], v[92:95]
v_exp_f32 v25, v25
v_mfma_f32_16x16x32_bf16 v[44:47], a[20:23], a[212:215], v[44:47]
v_exp_f32 v26, v26
v_mfma_f32_16x16x32_bf16 v[44:47], a[24:27], a[216:219], v[44:47]
v_exp_f32 v27, v27
v_mfma_f32_16x16x32_bf16 v[44:47], a[28:31], a[220:223], v[44:47]
v_cvt_pk_bf16_f32 v72, v24, v25
v_cvt_pk_bf16_f32 v73, v26, v27
s_cbranch_scc0 L_att_lh0_0
s_waitcnt vmcnt(16) lgkmcnt(0)
s_barrier
s_cmp_lg_u32 s33, 0
s_cbranch_scc1 L_sig_bs0
s_lshl_b32 s8, s6, 2
s_add_u32 s8, s8, 192
s_cmp_lg_u32 s4, 0
s_cbranch_scc1 L_sig_bs0
v_mov_b32 v4, 1
s_mov_b64 exec, 1
buffer_atomic_add v4, off, s[84:87], s8 sc1
s_mov_b64 exec, -1
L_sig_bs0:
v_mfma_f32_16x16x32_bf16 v[160:163], a[32:35], v[52:55], v[160:163]
ds_read_b128 a[0:3], v1 offset:8192
v_mfma_f32_16x16x32_bf16 v[192:195], a[32:35], v[56:59], v[192:195]
v_exp_f32 v28, v28
v_mfma_f32_16x16x32_bf16 v[224:227], a[32:35], v[60:63], v[224:227]
ds_read_b128 a[4:7], v1 offset:9216
v_mfma_f32_16x16x32_bf16 v[228:231], a[36:39], v[60:63], v[228:231]
v_mfma_f32_16x16x32_bf16 v[196:199], a[36:39], v[56:59], v[196:199]
ds_read_b128 a[8:11], v1 offset:10240
s_add_u32 m0, s27, 0x0
v_mfma_f32_16x16x32_bf16 v[164:167], a[36:39], v[52:55], v[164:167]
buffer_load_dwordx4 v3, s[48:51], s32 offen offset:0 sc1 lds
v_mfma_f32_16x16x32_bf16 v[168:171], a[40:43], v[52:55], v[168:171]
v_exp_f32 v29, v29
v_mfma_f32_16x16x32_bf16 v[200:203], a[40:43], v[56:59], v[200:203]
ds_read_b128 a[12:15], v1 offset:11264
v_cvt_pk_bf16_f32 v76, v28, v29
v_mfma_f32_16x16x32_bf16 v[232:235], a[40:43], v[60:63], v[232:235]
v_exp_f32 v30, v30
v_mfma_f32_16x16x32_bf16 v[236:239], a[44:47], v[60:63], v[236:239]
ds_read_b128 a[16:19], v1 offset:12288
v_mfma_f32_16x16x32_bf16 v[204:207], a[44:47], v[56:59], v[204:207]
v_exp_f32 v31, v31
v_mfma_f32_16x16x32_bf16 v[172:175], a[44:47], v[52:55], v[172:175]
ds_read_b128 a[20:23], v1 offset:13312
v_cvt_pk_bf16_f32 v77, v30, v31
v_mfma_f32_16x16x32_bf16 v[176:179], a[48:51], v[52:55], v[176:179]
v_exp_f32 v36, v36
v_mfma_f32_16x16x32_bf16 v[208:211], a[48:51], v[56:59], v[208:211]
v_exp_f32 v37, v37
v_mfma_f32_16x16x32_bf16 v[240:243], a[48:51], v[60:63], v[240:243]
ds_read_b128 a[24:27], v1 offset:14336
v_cvt_pk_bf16_f32 v70, v36, v37
v_mfma_f32_16x16x32_bf16 v[244:247], a[52:55], v[60:63], v[244:247]
buffer_load_dwordx4 v3, s[48:51], s32 offen offset:1024 sc1 lds
v_mfma_f32_16x16x32_bf16 v[212:215], a[52:55], v[56:59], v[212:215]
ds_read_b128 a[28:31], v1 offset:15360
v_mfma_f32_16x16x32_bf16 v[180:183], a[52:55], v[52:55], v[180:183]
v_exp_f32 v38, v38
v_mfma_f32_16x16x32_bf16 v[184:187], a[56:59], v[52:55], v[184:187]
v_mfma_f32_16x16x32_bf16 v[216:219], a[56:59], v[56:59], v[216:219]
ds_read_b128 a[32:35], v1 offset:0
v_mfma_f32_16x16x32_bf16 v[248:251], a[56:59], v[60:63], v[248:251]
v_exp_f32 v39, v39
v_mfma_f32_16x16x32_bf16 v[252:255], a[60:63], v[60:63], v[252:255]
ds_read_b128 a[36:39], v1 offset:1024
v_cvt_pk_bf16_f32 v71, v38, v39
v_mfma_f32_16x16x32_bf16 v[220:223], a[60:63], v[56:59], v[220:223]
v_exp_f32 v40, v40
v_mfma_f32_16x16x32_bf16 v[188:191], a[60:63], v[52:55], v[188:191]
ds_read_b128 a[40:43], v1 offset:2048
v_mfma_f32_16x16x32_bf16 a[228:231], a[240:243], v[52:55], a[228:231]
v_exp_f32 v41, v41
v_mfma_f32_16x16x32_bf16 a[232:235], a[240:243], v[56:59], a[232:235]
buffer_load_dwordx4 v3, s[48:51], s32 offen offset:2048 sc1 lds
v_mfma_f32_16x16x32_bf16 a[236:239], a[240:243], v[60:63], a[236:239]
ds_read_b128 a[44:47], v1 offset:3072
s_waitcnt lgkmcnt(8)
v_mfma_f32_16x16x32_bf16 v[24:27], a[0:3], a[192:195], v[88:91]
v_exp_f32 v42, v42
v_mfma_f32_16x16x32_bf16 v[24:27], a[4:7], a[196:199], v[24:27]
ds_read_b128 a[48:51], v1 offset:4096
v_cvt_pk_bf16_f32 v74, v40, v41
v_mfma_f32_16x16x32_bf16 v[24:27], a[8:11], a[200:203], v[24:27]
v_exp_f32 v43, v43
v_mfma_f32_16x16x32_bf16 v[24:27], a[12:15], a[204:207], v[24:27]
ds_read_b128 a[52:55], v1 offset:5120
v_cvt_pk_bf16_f32 v75, v42, v43
v_mfma_f32_16x16x32_bf16 v[28:31], a[0:3], a[208:211], v[92:95]
v_exp_f32 v44, v44
v_mfma_f32_16x16x32_bf16 v[28:31], a[4:7], a[212:215], v[28:31]
v_exp_f32 v45, v45
v_mfma_f32_16x16x32_bf16 v[28:31], a[8:11], a[216:219], v[28:31]
ds_read_b128 a[56:59], v1 offset:6144
v_cvt_pk_bf16_f32 v78, v44, v45
v_mfma_f32_16x16x32_bf16 v[28:31], a[12:15], a[220:223], v[28:31]
s_waitcnt lgkmcnt(7)
v_exp_f32 v46, v46
v_mfma_f32_16x16x32_bf16 v[40:43], a[16:19], a[192:195], v[88:91]
buffer_load_dwordx4 v3, s[48:51], s32 offen offset:3072 sc1 lds
v_mfma_f32_16x16x32_bf16 v[40:43], a[20:23], a[196:199], v[40:43]
ds_read_b128 a[60:63], v1 offset:7168
v_mfma_f32_16x16x32_bf16 v[40:43], a[24:27], a[200:203], v[40:43]
v_exp_f32 v47, v47
v_mfma_f32_16x16x32_bf16 v[40:43], a[28:31], a[204:207], v[40:43]
v_exp_f32 v24, v24
v_cvt_pk_bf16_f32 v79, v46, v47
v_mfma_f32_16x16x32_bf16 v[44:47], a[16:19], a[208:211], v[92:95]
v_exp_f32 v25, v25
v_mfma_f32_16x16x32_bf16 v[44:47], a[20:23], a[212:215], v[44:47]
v_exp_f32 v26, v26
v_mfma_f32_16x16x32_bf16 v[44:47], a[24:27], a[216:219], v[44:47]
v_exp_f32 v27, v27
v_mfma_f32_16x16x32_bf16 v[44:47], a[28:31], a[220:223], v[44:47]
v_cvt_pk_bf16_f32 v56, v24, v25
v_cvt_pk_bf16_f32 v57, v26, v27
s_waitcnt lgkmcnt(0)
v_mfma_f32_16x16x32_bf16 v[160:163], a[32:35], v[68:71], v[160:163]
ds_read_b128 a[0:3], v1 offset:24576
v_mfma_f32_16x16x32_bf16 v[192:195], a[32:35], v[72:75], v[192:195]
v_exp_f32 v28, v28
v_mfma_f32_16x16x32_bf16 v[224:227], a[32:35], v[76:79], v[224:227]
ds_read_b128 a[4:7], v1 offset:25600
v_mfma_f32_16x16x32_bf16 v[228:231], a[36:39], v[76:79], v[228:231]
v_mfma_f32_16x16x32_bf16 v[196:199], a[36:39], v[72:75], v[196:199]
ds_read_b128 a[8:11], v1 offset:26624
s_add_u32 m0, s27, 0x1000
v_mfma_f32_16x16x32_bf16 v[164:167], a[36:39], v[68:71], v[164:167]
buffer_load_dwordx4 v3, s[48:51], s7 offen offset:0 sc1 lds
v_mfma_f32_16x16x32_bf16 v[168:171], a[40:43], v[68:71], v[168:171]
v_exp_f32 v29, v29
v_mfma_f32_16x16x32_bf16 v[200:203], a[40:43], v[72:75], v[200:203]
ds_read_b128 a[12:15], v1 offset:27648
v_cvt_pk_bf16_f32 v60, v28, v29
v_mfma_f32_16x16x32_bf16 v[232:235], a[40:43], v[76:79], v[232:235]
v_exp_f32 v30, v30
v_mfma_f32_16x16x32_bf16 v[236:239], a[44:47], v[76:79], v[236:239]
ds_read_b128 a[16:19], v1 offset:28672
v_mfma_f32_16x16x32_bf16 v[204:207], a[44:47], v[72:75], v[204:207]
v_exp_f32 v31, v31
v_mfma_f32_16x16x32_bf16 v[172:175], a[44:47], v[68:71], v[172:175]
ds_read_b128 a[20:23], v1 offset:29696
v_cvt_pk_bf16_f32 v61, v30, v31
v_mfma_f32_16x16x32_bf16 v[176:179], a[48:51], v[68:71], v[176:179]
v_mfma_f32_16x16x32_bf16 v[208:211], a[48:51], v[72:75], v[208:211]
v_exp_f32 v40, v40
v_mfma_f32_16x16x32_bf16 v[240:243], a[48:51], v[76:79], v[240:243]
ds_read_b128 a[24:27], v1 offset:30720
v_mfma_f32_16x16x32_bf16 v[244:247], a[52:55], v[76:79], v[244:247]
buffer_load_dwordx4 v3, s[48:51], s7 offen offset:1024 sc1 lds
v_mfma_f32_16x16x32_bf16 v[212:215], a[52:55], v[72:75], v[212:215]
ds_read_b128 a[28:31], v1 offset:31744
v_mfma_f32_16x16x32_bf16 v[180:183], a[52:55], v[68:71], v[180:183]
v_exp_f32 v41, v41
v_mfma_f32_16x16x32_bf16 v[184:187], a[56:59], v[68:71], v[184:187]
v_exp_f32 v42, v42
v_mfma_f32_16x16x32_bf16 v[216:219], a[56:59], v[72:75], v[216:219]
ds_read_b128 a[32:35], v1 offset:16384
v_cvt_pk_bf16_f32 v58, v40, v41
v_mfma_f32_16x16x32_bf16 v[248:251], a[56:59], v[76:79], v[248:251]
v_mfma_f32_16x16x32_bf16 v[252:255], a[60:63], v[76:79], v[252:255]
ds_read_b128 a[36:39], v1 offset:17408
v_mfma_f32_16x16x32_bf16 v[220:223], a[60:63], v[72:75], v[220:223]
v_exp_f32 v43, v43
v_mfma_f32_16x16x32_bf16 v[188:191], a[60:63], v[68:71], v[188:191]
ds_read_b128 a[40:43], v1 offset:18432
v_cvt_pk_bf16_f32 v59, v42, v43
v_mfma_f32_16x16x32_bf16 a[228:231], a[240:243], v[68:71], a[228:231]
v_exp_f32 v44, v44
v_mfma_f32_16x16x32_bf16 a[232:235], a[240:243], v[72:75], a[232:235]
buffer_load_dwordx4 v3, s[48:51], s7 offen offset:2048 sc1 lds
v_mfma_f32_16x16x32_bf16 a[236:239], a[240:243], v[76:79], a[236:239]
ds_read_b128 a[44:47], v1 offset:19456
s_waitcnt lgkmcnt(8)
v_mfma_f32_16x16x32_bf16 v[24:27], a[0:3], a[192:195], v[88:91]
v_exp_f32 v45, v45
v_mfma_f32_16x16x32_bf16 v[24:27], a[4:7], a[196:199], v[24:27]
ds_read_b128 a[48:51], v1 offset:20480
v_cvt_pk_bf16_f32 v62, v44, v45
v_mfma_f32_16x16x32_bf16 v[24:27], a[8:11], a[200:203], v[24:27]
v_mfma_f32_16x16x32_bf16 v[24:27], a[12:15], a[204:207], v[24:27]
ds_read_b128 a[52:55], v1 offset:21504
v_mfma_f32_16x16x32_bf16 v[28:31], a[0:3], a[208:211], v[92:95]
v_exp_f32 v46, v46
v_mfma_f32_16x16x32_bf16 v[28:31], a[4:7], a[212:215], v[28:31]
v_exp_f32 v47, v47
v_mfma_f32_16x16x32_bf16 v[28:31], a[8:11], a[216:219], v[28:31]
ds_read_b128 a[56:59], v1 offset:22528
v_cvt_pk_bf16_f32 v63, v46, v47
v_mfma_f32_16x16x32_bf16 v[28:31], a[12:15], a[220:223], v[28:31]
s_waitcnt lgkmcnt(7)
v_exp_f32 v24, v24
v_mfma_f32_16x16x32_bf16 v[40:43], a[16:19], a[192:195], v[88:91]
buffer_load_dwordx4 v3, s[48:51], s7 offen offset:3072 sc1 lds
v_mfma_f32_16x16x32_bf16 v[40:43], a[20:23], a[196:199], v[40:43]
ds_read_b128 a[60:63], v1 offset:23552
s_add_u32 s32, s32, 0x8000
v_mfma_f32_16x16x32_bf16 v[40:43], a[24:27], a[200:203], v[40:43]
s_add_u32 s7, s7, 0x8000
s_xor_b32 s27, s27, 0x38000
v_xor_b32 v1, 0x8000, v1
v_mfma_f32_16x16x32_bf16 v[40:43], a[28:31], a[204:207], v[40:43]
v_mfma_f32_16x16x32_bf16 v[44:47], a[16:19], a[208:211], v[92:95]
v_exp_f32 v25, v25
v_mfma_f32_16x16x32_bf16 v[44:47], a[20:23], a[212:215], v[44:47]
v_exp_f32 v26, v26
v_mfma_f32_16x16x32_bf16 v[44:47], a[24:27], a[216:219], v[44:47]
v_exp_f32 v27, v27
v_mfma_f32_16x16x32_bf16 v[44:47], a[28:31], a[220:223], v[44:47]
v_cvt_pk_bf16_f32 v72, v24, v25
v_cvt_pk_bf16_f32 v73, v26, v27
s_nop 7
v_accvgpr_read_b32 v4, a224
v_accvgpr_read_b32 v6, a228
s_mov_b32 s8, 0x5f800000
v_cmp_nge_f32 s[36:37], s8, v4
v_cmp_nge_f32 s[38:39], s8, v6
v_rcp_f32 v4, v4
v_rcp_f32 v6, v6
s_or_b64 s[34:35], s[34:35], s[36:37]
s_or_b64 s[34:35], s[34:35], s[38:39]
v_pk_mul_f32 v[128:129], v[128:129], v[4:5] op_sel_hi:[1,0]
v_pk_mul_f32 v[130:131], v[130:131], v[4:5] op_sel_hi:[1,0]
v_pk_mul_f32 v[132:133], v[132:133], v[4:5] op_sel_hi:[1,0]
v_pk_mul_f32 v[134:135], v[134:135], v[4:5] op_sel_hi:[1,0]
v_cvt_pk_bf16_f32 v128, v128, v129
v_cvt_pk_bf16_f32 v129, v130, v131
v_cvt_pk_bf16_f32 v130, v132, v133
v_cvt_pk_bf16_f32 v131, v134, v135
s_add_u32 s8, s28, 0x0
buffer_store_dwordx4 v[128:131], v3, s[88:91], s8 offen sc1
v_pk_mul_f32 v[136:137], v[136:137], v[4:5] op_sel_hi:[1,0]
v_pk_mul_f32 v[138:139], v[138:139], v[4:5] op_sel_hi:[1,0]
v_pk_mul_f32 v[140:141], v[140:141], v[4:5] op_sel_hi:[1,0]
v_pk_mul_f32 v[142:143], v[142:143], v[4:5] op_sel_hi:[1,0]
v_cvt_pk_bf16_f32 v136, v136, v137
v_cvt_pk_bf16_f32 v137, v138, v139
v_cvt_pk_bf16_f32 v138, v140, v141
v_cvt_pk_bf16_f32 v139, v142, v143
s_add_u32 s8, s28, 0x2000
buffer_store_dwordx4 v[136:139], v3, s[88:91], s8 offen sc1
v_pk_mul_f32 v[144:145], v[144:145], v[4:5] op_sel_hi:[1,0]
v_pk_mul_f32 v[146:147], v[146:147], v[4:5] op_sel_hi:[1,0]
v_pk_mul_f32 v[148:149], v[148:149], v[4:5] op_sel_hi:[1,0]
v_pk_mul_f32 v[150:151], v[150:151], v[4:5] op_sel_hi:[1,0]
v_cvt_pk_bf16_f32 v144, v144, v145
v_cvt_pk_bf16_f32 v145, v146, v147
v_cvt_pk_bf16_f32 v146, v148, v149
v_cvt_pk_bf16_f32 v147, v150, v151
s_add_u32 s8, s28, 0x4000
buffer_store_dwordx4 v[144:147], v3, s[88:91], s8 offen sc1
v_pk_mul_f32 v[152:153], v[152:153], v[4:5] op_sel_hi:[1,0]
v_pk_mul_f32 v[154:155], v[154:155], v[4:5] op_sel_hi:[1,0]
v_pk_mul_f32 v[156:157], v[156:157], v[4:5] op_sel_hi:[1,0]
v_pk_mul_f32 v[158:159], v[158:159], v[4:5] op_sel_hi:[1,0]
v_cvt_pk_bf16_f32 v152, v152, v153
v_cvt_pk_bf16_f32 v153, v154, v155
v_cvt_pk_bf16_f32 v154, v156, v157
v_cvt_pk_bf16_f32 v155, v158, v159
s_add_u32 s8, s28, 0x6000
buffer_store_dwordx4 v[152:155], v3, s[88:91], s8 offen sc1
v_pk_mul_f32 v[160:161], v[160:161], v[6:7] op_sel_hi:[1,0]
v_pk_mul_f32 v[162:163], v[162:163], v[6:7] op_sel_hi:[1,0]
v_pk_mul_f32 v[164:165], v[164:165], v[6:7] op_sel_hi:[1,0]
v_pk_mul_f32 v[166:167], v[166:167], v[6:7] op_sel_hi:[1,0]
v_cvt_pk_bf16_f32 v160, v160, v161
v_cvt_pk_bf16_f32 v161, v162, v163
v_cvt_pk_bf16_f32 v162, v164, v165
v_cvt_pk_bf16_f32 v163, v166, v167
s_add_u32 s8, s29, 0x0
buffer_store_dwordx4 v[160:163], v3, s[88:91], s8 offen sc1
v_pk_mul_f32 v[168:169], v[168:169], v[6:7] op_sel_hi:[1,0]
v_pk_mul_f32 v[170:171], v[170:171], v[6:7] op_sel_hi:[1,0]
v_pk_mul_f32 v[172:173], v[172:173], v[6:7] op_sel_hi:[1,0]
v_pk_mul_f32 v[174:175], v[174:175], v[6:7] op_sel_hi:[1,0]
v_cvt_pk_bf16_f32 v168, v168, v169
v_cvt_pk_bf16_f32 v169, v170, v171
v_cvt_pk_bf16_f32 v170, v172, v173
v_cvt_pk_bf16_f32 v171, v174, v175
s_add_u32 s8, s29, 0x2000
buffer_store_dwordx4 v[168:171], v3, s[88:91], s8 offen sc1
v_pk_mul_f32 v[176:177], v[176:177], v[6:7] op_sel_hi:[1,0]
v_pk_mul_f32 v[178:179], v[178:179], v[6:7] op_sel_hi:[1,0]
v_pk_mul_f32 v[180:181], v[180:181], v[6:7] op_sel_hi:[1,0]
v_pk_mul_f32 v[182:183], v[182:183], v[6:7] op_sel_hi:[1,0]
v_cvt_pk_bf16_f32 v176, v176, v177
v_cvt_pk_bf16_f32 v177, v178, v179
v_cvt_pk_bf16_f32 v178, v180, v181
v_cvt_pk_bf16_f32 v179, v182, v183
s_add_u32 s8, s29, 0x4000
buffer_store_dwordx4 v[176:179], v3, s[88:91], s8 offen sc1
v_pk_mul_f32 v[184:185], v[184:185], v[6:7] op_sel_hi:[1,0]
v_pk_mul_f32 v[186:187], v[186:187], v[6:7] op_sel_hi:[1,0]
v_pk_mul_f32 v[188:189], v[188:189], v[6:7] op_sel_hi:[1,0]
v_pk_mul_f32 v[190:191], v[190:191], v[6:7] op_sel_hi:[1,0]
v_cvt_pk_bf16_f32 v184, v184, v185
v_cvt_pk_bf16_f32 v185, v186, v187
v_cvt_pk_bf16_f32 v186, v188, v189
v_cvt_pk_bf16_f32 v187, v190, v191
s_add_u32 s8, s29, 0x6000
buffer_store_dwordx4 v[184:187], v3, s[88:91], s8 offen sc1
s_branch L_att_sodd
L_att_lh0_0:
s_waitcnt vmcnt(16) lgkmcnt(0)
s_barrier
s_cmp_lg_u32 s33, 0
s_cbranch_scc1 L_sig_bh0
s_lshl_b32 s8, s6, 2
s_add_u32 s8, s8, 192
s_cmp_lg_u32 s4, 0
s_cbranch_scc1 L_sig_bh0
v_mov_b32 v4, 1
s_mov_b64 exec, 1
buffer_atomic_add v4, off, s[84:87], s8 sc1
s_mov_b64 exec, -1
L_sig_bh0:
v_and_b32 v15, 7, v0
v_lshlrev_b32 v15, 2, v15
s_bfe_u32 s99, s2, 0x20001
s_lshl_b32 s99, s99, 2
s_lshr_b32 s8, s2, 6
s_add_u32 s99, s99, s8
buffer_load_dword v14, v15, s[84:87], 0 offen offset:192 sc1
s_bfe_u32 s100, s2, 0x30003
s_and_b32 s10, s2, 1
s_sub_u32 s11, 15, s99
s_min_u32 s11, s11, s99
s_lshl_b32 s11, s11, 1
s_add_u32 s11, s11, s10
s_lshl_b32 s11, s11, 6
s_add_u32 s11, s11, 0x3604000
s_mov_b32 s12, 14336
v_bfe_u32 v12, v0, 2, 2
v_lshlrev_b32 v12, 11, v12
v_lshrrev_b32 v13, 4, v0
v_lshl_add_u32 v12, v13, 6, v12
v_and_b32 v13, 3, v0
v_lshl_add_u32 v12, v13, 4, v12
s_lshl_b32 s8, s10, 7
v_xor_b32 v12, s8, v12
s_lshl_b32 s8, s4, 15
s_lshl_b32 s9, s100, 8
s_add_u32 s8, s8, s9
s_lshl_b32 s9, s10, 20
s_add_u32 s8, s8, s9
v_add_u32 v12, s8, v12
v_xor_b32 v13, 32, v12
v_add_u32 v13, 7168, v13
s_mul_i32 s25, s10, 0x300000
s_sub_u32 s25, s25, 917504
s_mul_i32 s101, s99, 0x140000
s_lshl_b32 s8, s4, 11
s_add_u32 s101, s101, s8
s_lshl_b32 s8, s10, 17
s_add_u32 s101, s101, s8
s_add_u32 s101, s101, 0x21fe000
s_mul_i32 s26, s10, 393216
s_add_u32 s26, s26, 139264
v_mfma_f32_16x16x32_bf16 v[160:163], a[32:35], v[52:55], v[160:163]
ds_read_b128 a[0:3], v1 offset:8192
v_mfma_f32_16x16x32_bf16 v[192:195], a[32:35], v[56:59], v[192:195]
v_exp_f32 v28, v28
v_mfma_f32_16x16x32_bf16 v[224:227], a[32:35], v[60:63], v[224:227]
ds_read_b128 a[4:7], v1 offset:9216
v_mfma_f32_16x16x32_bf16 v[228:231], a[36:39], v[60:63], v[228:231]
v_mfma_f32_16x16x32_bf16 v[196:199], a[36:39], v[56:59], v[196:199]
ds_read_b128 a[8:11], v1 offset:10240
s_add_u32 m0, s17, 0x10000
v_mfma_f32_16x16x32_bf16 v[164:167], a[36:39], v[52:55], v[164:167]
buffer_load_dwordx4 v12, s[72:75], 0 offen lds
v_mfma_f32_16x16x32_bf16 v[168:171], a[40:43], v[52:55], v[168:171]
v_exp_f32 v29, v29
v_mfma_f32_16x16x32_bf16 v[200:203], a[40:43], v[56:59], v[200:203]
ds_read_b128 a[12:15], v1 offset:11264
v_cvt_pk_bf16_f32 v76, v28, v29
v_mfma_f32_16x16x32_bf16 v[232:235], a[40:43], v[60:63], v[232:235]
v_exp_f32 v30, v30
v_mfma_f32_16x16x32_bf16 v[236:239], a[44:47], v[60:63], v[236:239]
ds_read_b128 a[16:19], v1 offset:12288
v_mfma_f32_16x16x32_bf16 v[204:207], a[44:47], v[56:59], v[204:207]
v_exp_f32 v31, v31
v_mfma_f32_16x16x32_bf16 v[172:175], a[44:47], v[52:55], v[172:175]
ds_read_b128 a[20:23], v1 offset:13312
v_cvt_pk_bf16_f32 v77, v30, v31
v_mfma_f32_16x16x32_bf16 v[176:179], a[48:51], v[52:55], v[176:179]
v_exp_f32 v36, v36
v_mfma_f32_16x16x32_bf16 v[208:211], a[48:51], v[56:59], v[208:211]
v_exp_f32 v37, v37
v_mfma_f32_16x16x32_bf16 v[240:243], a[48:51], v[60:63], v[240:243]
ds_read_b128 a[24:27], v1 offset:14336
v_cvt_pk_bf16_f32 v70, v36, v37
v_mfma_f32_16x16x32_bf16 v[244:247], a[52:55], v[60:63], v[244:247]
buffer_load_dwordx4 v13, s[72:75], 0 offen offset:1024 lds
v_mfma_f32_16x16x32_bf16 v[212:215], a[52:55], v[56:59], v[212:215]
ds_read_b128 a[28:31], v1 offset:15360
v_mfma_f32_16x16x32_bf16 v[180:183], a[52:55], v[52:55], v[180:183]
v_exp_f32 v38, v38
v_mfma_f32_16x16x32_bf16 v[184:187], a[56:59], v[52:55], v[184:187]
v_mfma_f32_16x16x32_bf16 v[216:219], a[56:59], v[56:59], v[216:219]
ds_read_b128 a[32:35], v1 offset:0
v_mfma_f32_16x16x32_bf16 v[248:251], a[56:59], v[60:63], v[248:251]
v_exp_f32 v39, v39
v_mfma_f32_16x16x32_bf16 v[252:255], a[60:63], v[60:63], v[252:255]
ds_read_b128 a[36:39], v1 offset:1024
v_cvt_pk_bf16_f32 v71, v38, v39
v_mfma_f32_16x16x32_bf16 v[220:223], a[60:63], v[56:59], v[220:223]
v_exp_f32 v40, v40
v_mfma_f32_16x16x32_bf16 v[188:191], a[60:63], v[52:55], v[188:191]
ds_read_b128 a[40:43], v1 offset:2048
v_mfma_f32_16x16x32_bf16 a[228:231], a[240:243], v[52:55], a[228:231]
v_exp_f32 v41, v41
v_mfma_f32_16x16x32_bf16 a[232:235], a[240:243], v[56:59], a[232:235]
buffer_load_dwordx4 v12, s[72:75], s12 offen offset:2048 lds
v_mfma_f32_16x16x32_bf16 a[236:239], a[240:243], v[60:63], a[236:239]
ds_read_b128 a[44:47], v1 offset:3072
s_waitcnt lgkmcnt(8)
v_mfma_f32_16x16x32_bf16 v[24:27], a[0:3], a[192:195], v[112:115]
v_exp_f32 v42, v42
v_mfma_f32_16x16x32_bf16 v[24:27], a[4:7], a[196:199], v[24:27]
ds_read_b128 a[48:51], v1 offset:4096
v_cvt_pk_bf16_f32 v74, v40, v41
v_mfma_f32_16x16x32_bf16 v[24:27], a[8:11], a[200:203], v[24:27]
v_exp_f32 v43, v43
v_mfma_f32_16x16x32_bf16 v[24:27], a[12:15], a[204:207], v[24:27]
ds_read_b128 a[52:55], v1 offset:5120
v_cvt_pk_bf16_f32 v75, v42, v43
v_mfma_f32_16x16x32_bf16 v[28:31], a[0:3], a[208:211], v[92:95]
v_exp_f32 v44, v44
v_mfma_f32_16x16x32_bf16 v[28:31], a[4:7], a[212:215], v[28:31]
v_exp_f32 v45, v45
v_mfma_f32_16x16x32_bf16 v[28:31], a[8:11], a[216:219], v[28:31]
ds_read_b128 a[56:59], v1 offset:6144
v_cvt_pk_bf16_f32 v78, v44, v45
v_mfma_f32_16x16x32_bf16 v[28:31], a[12:15], a[220:223], v[28:31]
s_waitcnt lgkmcnt(7)
v_exp_f32 v46, v46
v_mfma_f32_16x16x32_bf16 v[40:43], a[16:19], a[192:195], v[116:119]
buffer_load_dwordx4 v13, s[72:75], s12 offen offset:3072 lds
v_mfma_f32_16x16x32_bf16 v[40:43], a[20:23], a[196:199], v[40:43]
ds_read_b128 a[60:63], v1 offset:7168
v_mfma_f32_16x16x32_bf16 v[40:43], a[24:27], a[200:203], v[40:43]
v_exp_f32 v47, v47
v_mfma_f32_16x16x32_bf16 v[40:43], a[28:31], a[204:207], v[40:43]
v_exp_f32 v24, v24
v_cvt_pk_bf16_f32 v79, v46, v47
v_mfma_f32_16x16x32_bf16 v[44:47], a[16:19], a[208:211], v[92:95]
v_exp_f32 v25, v25
v_mfma_f32_16x16x32_bf16 v[44:47], a[20:23], a[212:215], v[44:47]
v_exp_f32 v26, v26
v_mfma_f32_16x16x32_bf16 v[44:47], a[24:27], a[216:219], v[44:47]
v_exp_f32 v27, v27
v_mfma_f32_16x16x32_bf16 v[44:47], a[28:31], a[220:223], v[44:47]
v_cvt_pk_bf16_f32 v56, v24, v25
v_cvt_pk_bf16_f32 v57, v26, v27
s_waitcnt lgkmcnt(0)
v_mfma_f32_16x16x32_bf16 v[160:163], a[32:35], v[68:71], v[160:163]
ds_read_b128 a[0:3], v1 offset:24576
v_exp_f32 v28, v28
v_mfma_f32_16x16x32_bf16 v[192:195], a[32:35], v[72:75], v[192:195]
ds_read_b128 a[4:7], v1 offset:25600
v_exp_f32 v29, v29
v_mfma_f32_16x16x32_bf16 v[224:227], a[32:35], v[76:79], v[224:227]
v_add_u32 v12, 0x20000, v12
v_exp_f32 v30, v30
v_mfma_f32_16x16x32_bf16 v[228:231], a[36:39], v[76:79], v[228:231]
ds_read_b128 a[8:11], v1 offset:26624
s_add_u32 m0, s17, 0x14000
v_mfma_f32_16x16x32_bf16 v[196:199], a[36:39], v[72:75], v[196:199]
buffer_load_dwordx4 v12, s[72:75], 0 offen lds
v_mfma_f32_16x16x32_bf16 v[164:167], a[36:39], v[68:71], v[164:167]
ds_read_b128 a[12:15], v1 offset:27648
v_cvt_pk_bf16_f32 v60, v28, v29
v_mfma_f32_16x16x32_bf16 v[168:171], a[40:43], v[68:71], v[168:171]
v_exp_f32 v31, v31
v_mfma_f32_16x16x32_bf16 v[200:203], a[40:43], v[72:75], v[200:203]
ds_read_b128 a[16:19], v1 offset:28672
v_cvt_pk_bf16_f32 v61, v30, v31
v_mfma_f32_16x16x32_bf16 v[232:235], a[40:43], v[76:79], v[232:235]
v_exp_f32 v40, v40
v_mfma_f32_16x16x32_bf16 v[236:239], a[44:47], v[76:79], v[236:239]
ds_read_b128 a[20:23], v1 offset:29696
v_mfma_f32_16x16x32_bf16 v[204:207], a[44:47], v[72:75], v[204:207]
v_exp_f32 v41, v41
v_mfma_f32_16x16x32_bf16 v[172:175], a[44:47], v[68:71], v[172:175]
ds_read_b128 a[24:27], v1 offset:30720
v_add_u32 v13, 0x20000, v13
v_mfma_f32_16x16x32_bf16 v[176:179], a[48:51], v[68:71], v[176:179]
buffer_load_dwordx4 v13, s[72:75], 0 offen offset:1024 lds
v_mfma_f32_16x16x32_bf16 v[208:211], a[48:51], v[72:75], v[208:211]
ds_read_b128 a[28:31], v1 offset:31744
v_cvt_pk_bf16_f32 v58, v40, v41
v_mfma_f32_16x16x32_bf16 v[240:243], a[48:51], v[76:79], v[240:243]
v_exp_f32 v42, v42
v_mfma_f32_16x16x32_bf16 v[244:247], a[52:55], v[76:79], v[244:247]
ds_read_b128 a[32:35], v1 offset:16384
v_mfma_f32_16x16x32_bf16 v[212:215], a[52:55], v[72:75], v[212:215]
ds_read_b128 a[36:39], v1 offset:17408
v_mfma_f32_16x16x32_bf16 v[180:183], a[52:55], v[68:71], v[180:183]
v_exp_f32 v43, v43
v_mfma_f32_16x16x32_bf16 v[184:187], a[56:59], v[68:71], v[184:187]
ds_read_b128 a[40:43], v1 offset:18432
v_cvt_pk_bf16_f32 v59, v42, v43
v_mfma_f32_16x16x32_bf16 v[216:219], a[56:59], v[72:75], v[216:219]
v_exp_f32 v44, v44
v_mfma_f32_16x16x32_bf16 v[248:251], a[56:59], v[76:79], v[248:251]
buffer_load_dwordx4 v12, s[72:75], s12 offen offset:2048 lds
v_mfma_f32_16x16x32_bf16 v[252:255], a[60:63], v[76:79], v[252:255]
ds_read_b128 a[44:47], v1 offset:19456
v_mfma_f32_16x16x32_bf16 v[220:223], a[60:63], v[72:75], v[220:223]
ds_read_b128 a[48:51], v1 offset:20480
v_mfma_f32_16x16x32_bf16 v[188:191], a[60:63], v[68:71], v[188:191]
v_exp_f32 v45, v45
v_mfma_f32_16x16x32_bf16 a[228:231], a[240:243], v[68:71], a[228:231]
ds_read_b128 a[52:55], v1 offset:21504
v_cvt_pk_bf16_f32 v62, v44, v45
v_mfma_f32_16x16x32_bf16 a[232:235], a[240:243], v[72:75], a[232:235]
v_exp_f32 v46, v46
v_mfma_f32_16x16x32_bf16 a[236:239], a[240:243], v[76:79], a[236:239]
ds_read_b128 a[56:59], v1 offset:22528
s_waitcnt lgkmcnt(11)
v_mfma_f32_16x16x32_bf16 v[28:31], a[0:3], a[208:211], v[92:95]
v_exp_f32 v47, v47
v_mfma_f32_16x16x32_bf16 v[28:31], a[4:7], a[212:215], v[28:31]
buffer_load_dwordx4 v13, s[72:75], s12 offen offset:3072 lds
v_mfma_f32_16x16x32_bf16 v[28:31], a[8:11], a[216:219], v[28:31]
ds_read_b128 a[60:63], v1 offset:23552
v_xor_b32 v1, 0x8000, v1
v_mfma_f32_16x16x32_bf16 v[28:31], a[12:15], a[220:223], v[28:31]
s_waitcnt lgkmcnt(8)
v_cvt_pk_bf16_f32 v63, v46, v47
v_mfma_f32_16x16x32_bf16 v[44:47], a[16:19], a[208:211], v[92:95]
v_mfma_f32_16x16x32_bf16 v[44:47], a[20:23], a[212:215], v[44:47]
v_mfma_f32_16x16x32_bf16 v[44:47], a[24:27], a[216:219], v[44:47]
v_mfma_f32_16x16x32_bf16 v[44:47], a[28:31], a[220:223], v[44:47]
s_nop 7
v_accvgpr_read_b32 v4, a224
v_accvgpr_read_b32 v6, a228
s_mov_b32 s8, 0x5f800000
v_cmp_nge_f32 s[36:37], s8, v4
v_cmp_nge_f32 s[38:39], s8, v6
v_rcp_f32 v4, v4
v_rcp_f32 v6, v6
s_or_b64 s[34:35], s[34:35], s[36:37]
s_or_b64 s[34:35], s[34:35], s[38:39]
v_pk_mul_f32 v[128:129], v[128:129], v[4:5] op_sel_hi:[1,0]
v_pk_mul_f32 v[130:131], v[130:131], v[4:5] op_sel_hi:[1,0]
v_pk_mul_f32 v[132:133], v[132:133], v[4:5] op_sel_hi:[1,0]
v_pk_mul_f32 v[134:135], v[134:135], v[4:5] op_sel_hi:[1,0]
v_cvt_pk_bf16_f32 v128, v128, v129
v_cvt_pk_bf16_f32 v129, v130, v131
v_cvt_pk_bf16_f32 v130, v132, v133
v_cvt_pk_bf16_f32 v131, v134, v135
s_add_u32 s8, s28, 0x0
buffer_store_dwordx4 v[128:131], v3, s[88:91], s8 offen sc1
v_pk_mul_f32 v[136:137], v[136:137], v[4:5] op_sel_hi:[1,0]
v_pk_mul_f32 v[138:139], v[138:139], v[4:5] op_sel_hi:[1,0]
v_pk_mul_f32 v[140:141], v[140:141], v[4:5] op_sel_hi:[1,0]
v_pk_mul_f32 v[142:143], v[142:143], v[4:5] op_sel_hi:[1,0]
v_cvt_pk_bf16_f32 v136, v136, v137
v_cvt_pk_bf16_f32 v137, v138, v139
v_cvt_pk_bf16_f32 v138, v140, v141
v_cvt_pk_bf16_f32 v139, v142, v143
s_add_u32 s8, s28, 0x2000
buffer_store_dwordx4 v[136:139], v3, s[88:91], s8 offen sc1
v_pk_mul_f32 v[144:145], v[144:145], v[4:5] op_sel_hi:[1,0]
v_pk_mul_f32 v[146:147], v[146:147], v[4:5] op_sel_hi:[1,0]
v_pk_mul_f32 v[148:149], v[148:149], v[4:5] op_sel_hi:[1,0]
v_pk_mul_f32 v[150:151], v[150:151], v[4:5] op_sel_hi:[1,0]
v_cvt_pk_bf16_f32 v144, v144, v145
v_cvt_pk_bf16_f32 v145, v146, v147
v_cvt_pk_bf16_f32 v146, v148, v149
v_cvt_pk_bf16_f32 v147, v150, v151
s_add_u32 s8, s28, 0x4000
buffer_store_dwordx4 v[144:147], v3, s[88:91], s8 offen sc1
v_pk_mul_f32 v[152:153], v[152:153], v[4:5] op_sel_hi:[1,0]
v_pk_mul_f32 v[154:155], v[154:155], v[4:5] op_sel_hi:[1,0]
v_pk_mul_f32 v[156:157], v[156:157], v[4:5] op_sel_hi:[1,0]
v_pk_mul_f32 v[158:159], v[158:159], v[4:5] op_sel_hi:[1,0]
v_cvt_pk_bf16_f32 v152, v152, v153
v_cvt_pk_bf16_f32 v153, v154, v155
v_cvt_pk_bf16_f32 v154, v156, v157
v_cvt_pk_bf16_f32 v155, v158, v159
s_add_u32 s8, s28, 0x6000
buffer_store_dwordx4 v[152:155], v3, s[88:91], s8 offen sc1
v_pk_mul_f32 v[160:161], v[160:161], v[6:7] op_sel_hi:[1,0]
v_pk_mul_f32 v[162:163], v[162:163], v[6:7] op_sel_hi:[1,0]
v_pk_mul_f32 v[164:165], v[164:165], v[6:7] op_sel_hi:[1,0]
v_pk_mul_f32 v[166:167], v[166:167], v[6:7] op_sel_hi:[1,0]
v_cvt_pk_bf16_f32 v160, v160, v161
v_cvt_pk_bf16_f32 v161, v162, v163
v_cvt_pk_bf16_f32 v162, v164, v165
v_cvt_pk_bf16_f32 v163, v166, v167
s_add_u32 s8, s29, 0x0
buffer_store_dwordx4 v[160:163], v3, s[88:91], s8 offen sc1
v_pk_mul_f32 v[168:169], v[168:169], v[6:7] op_sel_hi:[1,0]
v_pk_mul_f32 v[170:171], v[170:171], v[6:7] op_sel_hi:[1,0]
v_pk_mul_f32 v[172:173], v[172:173], v[6:7] op_sel_hi:[1,0]
v_pk_mul_f32 v[174:175], v[174:175], v[6:7] op_sel_hi:[1,0]
v_cvt_pk_bf16_f32 v168, v168, v169
v_cvt_pk_bf16_f32 v169, v170, v171
v_cvt_pk_bf16_f32 v170, v172, v173
v_cvt_pk_bf16_f32 v171, v174, v175
s_add_u32 s8, s29, 0x2000
buffer_store_dwordx4 v[168:171], v3, s[88:91], s8 offen sc1
v_pk_mul_f32 v[176:177], v[176:177], v[6:7] op_sel_hi:[1,0]
v_pk_mul_f32 v[178:179], v[178:179], v[6:7] op_sel_hi:[1,0]
v_pk_mul_f32 v[180:181], v[180:181], v[6:7] op_sel_hi:[1,0]
v_pk_mul_f32 v[182:183], v[182:183], v[6:7] op_sel_hi:[1,0]
v_cvt_pk_bf16_f32 v176, v176, v177
v_cvt_pk_bf16_f32 v177, v178, v179
v_cvt_pk_bf16_f32 v178, v180, v181
v_cvt_pk_bf16_f32 v179, v182, v183
s_add_u32 s8, s29, 0x4000
buffer_store_dwordx4 v[176:179], v3, s[88:91], s8 offen sc1
v_pk_mul_f32 v[184:185], v[184:185], v[6:7] op_sel_hi:[1,0]
v_pk_mul_f32 v[186:187], v[186:187], v[6:7] op_sel_hi:[1,0]
v_pk_mul_f32 v[188:189], v[188:189], v[6:7] op_sel_hi:[1,0]
v_pk_mul_f32 v[190:191], v[190:191], v[6:7] op_sel_hi:[1,0]
v_cvt_pk_bf16_f32 v184, v184, v185
v_cvt_pk_bf16_f32 v185, v186, v187
v_cvt_pk_bf16_f32 v186, v188, v189
v_cvt_pk_bf16_f32 v187, v190, v191
s_add_u32 s8, s29, 0x6000
buffer_store_dwordx4 v[184:187], v3, s[88:91], s8 offen sc1
s_branch L_att_h1_0
L_att_dl0_1:
s_waitcnt vmcnt(16) lgkmcnt(0)
s_barrier
v_mfma_f32_16x16x32_bf16 v[128:131], a[32:35], v[48:51], v[128:131]
ds_read_b128 a[0:3], v1 offset:8192
v_mfma_f32_16x16x32_bf16 v[160:163], a[32:35], v[52:55], v[160:163]
v_exp_f32 v28, v28
v_mfma_f32_16x16x32_bf16 v[192:195], a[32:35], v[56:59], v[192:195]
v_mfma_f32_16x16x32_bf16 v[224:227], a[32:35], v[60:63], v[224:227]
ds_read_b128 a[4:7], v1 offset:9216
v_mfma_f32_16x16x32_bf16 v[228:231], a[36:39], v[60:63], v[228:231]
s_add_u32 m0, s27, 0x0
v_exp_f32 v29, v29
v_mfma_f32_16x16x32_bf16 v[196:199], a[36:39], v[56:59], v[196:199]
buffer_load_dwordx4 v3, s[48:51], s32 offen offset:0 sc1 lds
v_mfma_f32_16x16x32_bf16 v[164:167], a[36:39], v[52:55], v[164:167]
v_exp_f32 v30, v30
v_mfma_f32_16x16x32_bf16 v[132:135], a[36:39], v[48:51], v[132:135]
ds_read_b128 a[8:11], v1 offset:10240
v_cvt_pk_bf16_f32 v76, v28, v29
v_mfma_f32_16x16x32_bf16 v[136:139], a[40:43], v[48:51], v[136:139]
v_mfma_f32_16x16x32_bf16 v[168:171], a[40:43], v[52:55], v[168:171]
v_exp_f32 v31, v31
v_mfma_f32_16x16x32_bf16 v[200:203], a[40:43], v[56:59], v[200:203]
v_exp_f32 v32, v32
v_mfma_f32_16x16x32_bf16 v[232:235], a[40:43], v[60:63], v[232:235]
ds_read_b128 a[12:15], v1 offset:11264
v_cvt_pk_bf16_f32 v77, v30, v31
v_mfma_f32_16x16x32_bf16 v[236:239], a[44:47], v[60:63], v[236:239]
v_mfma_f32_16x16x32_bf16 v[204:207], a[44:47], v[56:59], v[204:207]
v_exp_f32 v33, v33
v_mfma_f32_16x16x32_bf16 v[172:175], a[44:47], v[52:55], v[172:175]
v_exp_f32 v34, v34
v_mfma_f32_16x16x32_bf16 v[140:143], a[44:47], v[48:51], v[140:143]
ds_read_b128 a[16:19], v1 offset:12288
s_mov_b32 s9, 0x0
v_mfma_f32_16x16x32_bf16 v[144:147], a[48:51], v[48:51], v[144:147]
buffer_load_dword v9, v8, s[72:75], s9 offen
v_mfma_f32_16x16x32_bf16 v[176:179], a[48:51], v[52:55], v[176:179]
v_cvt_pk_bf16_f32 v66, v32, v33
v_mfma_f32_16x16x32_bf16 v[208:211], a[48:51], v[56:59], v[208:211]
v_exp_f32 v35, v35
v_mfma_f32_16x16x32_bf16 v[240:243], a[48:51], v[60:63], v[240:243]
ds_read_b128 a[20:23], v1 offset:13312
v_cvt_pk_bf16_f32 v67, v34, v35
v_mfma_f32_16x16x32_bf16 v[244:247], a[52:55], v[60:63], v[244:247]
v_exp_f32 v36, v36
v_mfma_f32_16x16x32_bf16 v[212:215], a[52:55], v[56:59], v[212:215]
v_exp_f32 v37, v37
v_mfma_f32_16x16x32_bf16 v[180:183], a[52:55], v[52:55], v[180:183]
v_cvt_pk_bf16_f32 v70, v36, v37
v_mfma_f32_16x16x32_bf16 v[148:151], a[52:55], v[48:51], v[148:151]
ds_read_b128 a[24:27], v1 offset:14336
v_mfma_f32_16x16x32_bf16 v[152:155], a[56:59], v[48:51], v[152:155]
v_exp_f32 v38, v38
v_mfma_f32_16x16x32_bf16 v[184:187], a[56:59], v[52:55], v[184:187]
v_exp_f32 v39, v39
v_mfma_f32_16x16x32_bf16 v[216:219], a[56:59], v[56:59], v[216:219]
v_cvt_pk_bf16_f32 v71, v38, v39
v_mfma_f32_16x16x32_bf16 v[248:251], a[56:59], v[60:63], v[248:251]
buffer_load_dwordx4 v3, s[48:51], s32 offen offset:1024 sc1 lds
v_mfma_f32_16x16x32_bf16 v[252:255], a[60:63], v[60:63], v[252:255]
ds_read_b128 a[28:31], v1 offset:15360
v_mfma_f32_16x16x32_bf16 v[220:223], a[60:63], v[56:59], v[220:223]
v_exp_f32 v40, v40
v_mfma_f32_16x16x32_bf16 v[188:191], a[60:63], v[52:55], v[188:191]
v_exp_f32 v41, v41
v_mfma_f32_16x16x32_bf16 v[156:159], a[60:63], v[48:51], v[156:159]
ds_read_b128 a[32:35], v1 offset:0
v_cvt_pk_bf16_f32 v74, v40, v41
v_mfma_f32_16x16x32_bf16 a[224:227], a[240:243], v[48:51], a[224:227]
v_mfma_f32_16x16x32_bf16 a[228:231], a[240:243], v[52:55], a[228:231]
v_exp_f32 v42, v42
v_mfma_f32_16x16x32_bf16 a[232:235], a[240:243], v[56:59], a[232:235]
v_exp_f32 v43, v43
v_mfma_f32_16x16x32_bf16 a[236:239], a[240:243], v[60:63], a[236:239]
ds_read_b128 a[36:39], v1 offset:1024
s_waitcnt lgkmcnt(6)
v_mfma_f32_16x16x32_bf16 v[16:19], a[0:3], a[160:163], v[80:83]
v_exp_f32 v44, v44
v_mfma_f32_16x16x32_bf16 v[16:19], a[4:7], a[164:167], v[16:19]
v_cvt_pk_bf16_f32 v75, v42, v43
v_mfma_f32_16x16x32_bf16 v[16:19], a[8:11], a[168:171], v[16:19]
buffer_load_dwordx4 v3, s[48:51], s32 offen offset:2048 sc1 lds
v_mfma_f32_16x16x32_bf16 v[16:19], a[12:15], a[172:175], v[16:19]
ds_read_b128 a[40:43], v1 offset:2048
v_mfma_f32_16x16x32_bf16 v[20:23], a[0:3], a[176:179], v[84:87]
v_exp_f32 v45, v45
v_mfma_f32_16x16x32_bf16 v[20:23], a[4:7], a[180:183], v[20:23]
v_exp_f32 v46, v46
v_mfma_f32_16x16x32_bf16 v[20:23], a[8:11], a[184:187], v[20:23]
v_cvt_pk_bf16_f32 v78, v44, v45
v_mfma_f32_16x16x32_bf16 v[20:23], a[12:15], a[188:191], v[20:23]
ds_read_b128 a[44:47], v1 offset:3072
v_mfma_f32_16x16x32_bf16 v[24:27], a[0:3], a[192:195], v[88:91]
v_exp_f32 v47, v47
v_mfma_f32_16x16x32_bf16 v[24:27], a[4:7], a[196:199], v[24:27]
v_exp_f32 v16, v16
v_mfma_f32_16x16x32_bf16 v[24:27], a[8:11], a[200:203], v[24:27]
v_cvt_pk_bf16_f32 v79, v46, v47
v_mfma_f32_16x16x32_bf16 v[24:27], a[12:15], a[204:207], v[24:27]
ds_read_b128 a[48:51], v1 offset:4096
v_mfma_f32_16x16x32_bf16 v[28:31], a[0:3], a[208:211], v[92:95]
v_exp_f32 v17, v17
v_mfma_f32_16x16x32_bf16 v[28:31], a[4:7], a[212:215], v[28:31]
buffer_load_dwordx4 v3, s[48:51], s32 offen offset:3072 sc1 lds
v_mfma_f32_16x16x32_bf16 v[28:31], a[8:11], a[216:219], v[28:31]
v_exp_f32 v18, v18
v_mfma_f32_16x16x32_bf16 v[28:31], a[12:15], a[220:223], v[28:31]
ds_read_b128 a[52:55], v1 offset:5120
s_waitcnt lgkmcnt(6)
v_mfma_f32_16x16x32_bf16 v[32:35], a[16:19], a[160:163], v[80:83]
v_cvt_pk_bf16_f32 v48, v16, v17
v_mfma_f32_16x16x32_bf16 v[32:35], a[20:23], a[164:167], v[32:35]
v_exp_f32 v19, v19
v_mfma_f32_16x16x32_bf16 v[32:35], a[24:27], a[168:171], v[32:35]
v_exp_f32 v20, v20
v_mfma_f32_16x16x32_bf16 v[32:35], a[28:31], a[172:175], v[32:35]
ds_read_b128 a[56:59], v1 offset:6144
v_cvt_pk_bf16_f32 v49, v18, v19
v_mfma_f32_16x16x32_bf16 v[36:39], a[16:19], a[176:179], v[84:87]
v_exp_f32 v21, v21
v_mfma_f32_16x16x32_bf16 v[36:39], a[20:23], a[180:183], v[36:39]
v_cvt_pk_bf16_f32 v52, v20, v21
v_mfma_f32_16x16x32_bf16 v[36:39], a[24:27], a[184:187], v[36:39]
v_exp_f32 v22, v22
v_mfma_f32_16x16x32_bf16 v[36:39], a[28:31], a[188:191], v[36:39]
ds_read_b128 a[60:63], v1 offset:7168
s_mov_b32 s9, 0x0
v_mfma_f32_16x16x32_bf16 v[40:43], a[16:19], a[192:195], v[88:91]
buffer_load_dword v9, v8, s[64:67], s9 offen
v_mfma_f32_16x16x32_bf16 v[40:43], a[20:23], a[196:199], v[40:43]
v_exp_f32 v23, v23
v_mfma_f32_16x16x32_bf16 v[40:43], a[24:27], a[200:203], v[40:43]
v_cvt_pk_bf16_f32 v53, v22, v23
v_mfma_f32_16x16x32_bf16 v[40:43], a[28:31], a[204:207], v[40:43]
v_exp_f32 v24, v24
v_mfma_f32_16x16x32_bf16 v[44:47], a[16:19], a[208:211], v[92:95]
v_exp_f32 v25, v25
v_mfma_f32_16x16x32_bf16 v[44:47], a[20:23], a[212:215], v[44:47]
v_exp_f32 v26, v26
v_mfma_f32_16x16x32_bf16 v[44:47], a[24:27], a[216:219], v[44:47]
v_exp_f32 v27, v27
v_mfma_f32_16x16x32_bf16 v[44:47], a[28:31], a[220:223], v[44:47]
v_cvt_pk_bf16_f32 v56, v24, v25
v_cvt_pk_bf16_f32 v57, v26, v27
s_waitcnt lgkmcnt(0)
v_mfma_f32_16x16x32_bf16 v[128:131], a[32:35], v[64:67], v[128:131]
ds_read_b128 a[0:3], v1 offset:24576
v_mfma_f32_16x16x32_bf16 v[160:163], a[32:35], v[68:71], v[160:163]
v_exp_f32 v28, v28
v_mfma_f32_16x16x32_bf16 v[192:195], a[32:35], v[72:75], v[192:195]
v_mfma_f32_16x16x32_bf16 v[224:227], a[32:35], v[76:79], v[224:227]
ds_read_b128 a[4:7], v1 offset:25600
v_mfma_f32_16x16x32_bf16 v[228:231], a[36:39], v[76:79], v[228:231]
v_exp_f32 v29, v29
v_mfma_f32_16x16x32_bf16 v[196:199], a[36:39], v[72:75], v[196:199]
s_add_u32 m0, s27, 0x1000
v_exp_f32 v30, v30
v_mfma_f32_16x16x32_bf16 v[164:167], a[36:39], v[68:71], v[164:167]
buffer_load_dwordx4 v3, s[48:51], s7 offen offset:0 sc1 lds
v_mfma_f32_16x16x32_bf16 v[132:135], a[36:39], v[64:67], v[132:135]
ds_read_b128 a[8:11], v1 offset:26624
v_cvt_pk_bf16_f32 v60, v28, v29
v_mfma_f32_16x16x32_bf16 v[136:139], a[40:43], v[64:67], v[136:139]
v_mfma_f32_16x16x32_bf16 v[168:171], a[40:43], v[68:71], v[168:171]
v_exp_f32 v31, v31
v_mfma_f32_16x16x32_bf16 v[200:203], a[40:43], v[72:75], v[200:203]
v_exp_f32 v32, v32
v_mfma_f32_16x16x32_bf16 v[232:235], a[40:43], v[76:79], v[232:235]
ds_read_b128 a[12:15], v1 offset:27648
v_cvt_pk_bf16_f32 v61, v30, v31
v_mfma_f32_16x16x32_bf16 v[236:239], a[44:47], v[76:79], v[236:239]
v_mfma_f32_16x16x32_bf16 v[204:207], a[44:47], v[72:75], v[204:207]
v_exp_f32 v33, v33
v_mfma_f32_16x16x32_bf16 v[172:175], a[44:47], v[68:71], v[172:175]
v_exp_f32 v34, v34
v_mfma_f32_16x16x32_bf16 v[140:143], a[44:47], v[64:67], v[140:143]
ds_read_b128 a[16:19], v1 offset:28672
v_cvt_pk_bf16_f32 v50, v32, v33
v_mfma_f32_16x16x32_bf16 v[144:147], a[48:51], v[64:67], v[144:147]
v_exp_f32 v35, v35
v_mfma_f32_16x16x32_bf16 v[176:179], a[48:51], v[68:71], v[176:179]
v_cvt_pk_bf16_f32 v51, v34, v35
v_mfma_f32_16x16x32_bf16 v[208:211], a[48:51], v[72:75], v[208:211]
v_exp_f32 v36, v36
v_mfma_f32_16x16x32_bf16 v[240:243], a[48:51], v[76:79], v[240:243]
buffer_load_dwordx4 v3, s[48:51], s7 offen offset:1024 sc1 lds
v_mfma_f32_16x16x32_bf16 v[244:247], a[52:55], v[76:79], v[244:247]
ds_read_b128 a[20:23], v1 offset:29696
v_mfma_f32_16x16x32_bf16 v[212:215], a[52:55], v[72:75], v[212:215]
v_exp_f32 v37, v37
v_mfma_f32_16x16x32_bf16 v[180:183], a[52:55], v[68:71], v[180:183]
v_cvt_pk_bf16_f32 v54, v36, v37
v_mfma_f32_16x16x32_bf16 v[148:151], a[52:55], v[64:67], v[148:151]
ds_read_b128 a[24:27], v1 offset:30720
v_mfma_f32_16x16x32_bf16 v[152:155], a[56:59], v[64:67], v[152:155]
v_exp_f32 v38, v38
v_mfma_f32_16x16x32_bf16 v[184:187], a[56:59], v[68:71], v[184:187]
v_exp_f32 v39, v39
v_mfma_f32_16x16x32_bf16 v[216:219], a[56:59], v[72:75], v[216:219]
v_exp_f32 v40, v40
v_mfma_f32_16x16x32_bf16 v[248:251], a[56:59], v[76:79], v[248:251]
ds_read_b128 a[28:31], v1 offset:31744
v_cvt_pk_bf16_f32 v55, v38, v39
v_mfma_f32_16x16x32_bf16 v[252:255], a[60:63], v[76:79], v[252:255]
v_mfma_f32_16x16x32_bf16 v[220:223], a[60:63], v[72:75], v[220:223]
v_exp_f32 v41, v41
v_mfma_f32_16x16x32_bf16 v[188:191], a[60:63], v[68:71], v[188:191]
v_exp_f32 v42, v42
v_mfma_f32_16x16x32_bf16 v[156:159], a[60:63], v[64:67], v[156:159]
ds_read_b128 a[32:35], v1 offset:16384
v_cvt_pk_bf16_f32 v58, v40, v41
v_mfma_f32_16x16x32_bf16 a[224:227], a[240:243], v[64:67], a[224:227]
v_mfma_f32_16x16x32_bf16 a[228:231], a[240:243], v[68:71], a[228:231]
buffer_load_dwordx4 v3, s[48:51], s7 offen offset:2048 sc1 lds
v_mfma_f32_16x16x32_bf16 a[232:235], a[240:243], v[72:75], a[232:235]
v_exp_f32 v43, v43
v_mfma_f32_16x16x32_bf16 a[236:239], a[240:243], v[76:79], a[236:239]
ds_read_b128 a[36:39], v1 offset:17408
s_waitcnt lgkmcnt(6)
v_mfma_f32_16x16x32_bf16 v[16:19], a[0:3], a[160:163], v[96:99]
v_exp_f32 v44, v44
v_mfma_f32_16x16x32_bf16 v[16:19], a[4:7], a[164:167], v[16:19]
v_exp_f32 v45, v45
v_mfma_f32_16x16x32_bf16 v[16:19], a[8:11], a[168:171], v[16:19]
v_cvt_pk_bf16_f32 v59, v42, v43
v_cvt_pk_bf16_f32 v62, v44, v45
v_mfma_f32_16x16x32_bf16 v[16:19], a[12:15], a[172:175], v[16:19]
ds_read_b128 a[40:43], v1 offset:18432
v_mfma_f32_16x16x32_bf16 v[20:23], a[0:3], a[176:179], v[84:87]
v_exp_f32 v46, v46
v_mfma_f32_16x16x32_bf16 v[20:23], a[4:7], a[180:183], v[20:23]
v_exp_f32 v47, v47
v_mfma_f32_16x16x32_bf16 v[20:23], a[8:11], a[184:187], v[20:23]
v_cvt_pk_bf16_f32 v63, v46, v47
v_mfma_f32_16x16x32_bf16 v[20:23], a[12:15], a[188:191], v[20:23]
ds_read_b128 a[44:47], v1 offset:19456
v_mfma_f32_16x16x32_bf16 v[24:27], a[0:3], a[192:195], v[88:91]
v_exp_f32 v16, v16
v_mfma_f32_16x16x32_bf16 v[24:27], a[4:7], a[196:199], v[24:27]
s_mov_b32 s9, 0x400000
v_exp_f32 v17, v17
v_mfma_f32_16x16x32_bf16 v[24:27], a[8:11], a[200:203], v[24:27]
buffer_load_dword v9, v8, s[64:67], s9 offen
v_mfma_f32_16x16x32_bf16 v[24:27], a[12:15], a[204:207], v[24:27]
ds_read_b128 a[48:51], v1 offset:20480
v_cvt_pk_bf16_f32 v64, v16, v17
v_mfma_f32_16x16x32_bf16 v[28:31], a[0:3], a[208:211], v[92:95]
v_exp_f32 v18, v18
v_mfma_f32_16x16x32_bf16 v[28:31], a[4:7], a[212:215], v[28:31]
v_mfma_f32_16x16x32_bf16 v[28:31], a[8:11], a[216:219], v[28:31]
v_exp_f32 v19, v19
v_mfma_f32_16x16x32_bf16 v[28:31], a[12:15], a[220:223], v[28:31]
ds_read_b128 a[52:55], v1 offset:21504
s_waitcnt lgkmcnt(6)
v_mfma_f32_16x16x32_bf16 v[32:35], a[16:19], a[160:163], v[100:103]
v_exp_f32 v20, v20
v_mfma_f32_16x16x32_bf16 v[32:35], a[20:23], a[164:167], v[32:35]
v_cvt_pk_bf16_f32 v65, v18, v19
v_mfma_f32_16x16x32_bf16 v[32:35], a[24:27], a[168:171], v[32:35]
v_exp_f32 v21, v21
v_mfma_f32_16x16x32_bf16 v[32:35], a[28:31], a[172:175], v[32:35]
ds_read_b128 a[56:59], v1 offset:22528
v_cvt_pk_bf16_f32 v68, v20, v21
v_mfma_f32_16x16x32_bf16 v[36:39], a[16:19], a[176:179], v[84:87]
v_exp_f32 v22, v22
v_mfma_f32_16x16x32_bf16 v[36:39], a[20:23], a[180:183], v[36:39]
v_exp_f32 v23, v23
v_mfma_f32_16x16x32_bf16 v[36:39], a[24:27], a[184:187], v[36:39]
v_cvt_pk_bf16_f32 v69, v22, v23
v_mfma_f32_16x16x32_bf16 v[36:39], a[28:31], a[188:191], v[36:39]
buffer_load_dwordx4 v3, s[48:51], s7 offen offset:3072 sc1 lds
v_mfma_f32_16x16x32_bf16 v[40:43], a[16:19], a[192:195], v[88:91]
ds_read_b128 a[60:63], v1 offset:23552
s_add_u32 s32, s32, 0x8000
v_mfma_f32_16x16x32_bf16 v[40:43], a[20:23], a[196:199], v[40:43]
s_add_u32 s7, s7, 0x8000
s_xor_b32 s27, s27, 0x38000
v_xor_b32 v1, 0x8000, v1
v_mfma_f32_16x16x32_bf16 v[40:43], a[24:27], a[200:203], v[40:43]
v_exp_f32 v24, v24
v_mfma_f32_16x16x32_bf16 v[40:43], a[28:31], a[204:207], v[40:43]
v_exp_f32 v25, v25
v_mfma_f32_16x16x32_bf16 v[44:47], a[16:19], a[208:211], v[92:95]
v_cvt_pk_bf16_f32 v72, v24, v25
v_mfma_f32_16x16x32_bf16 v[44:47], a[20:23], a[212:215], v[44:47]
v_exp_f32 v26, v26
v_mfma_f32_16x16x32_bf16 v[44:47], a[24:27], a[216:219], v[44:47]
v_exp_f32 v27, v27
v_mfma_f32_16x16x32_bf16 v[44:47], a[28:31], a[220:223], v[44:47]
v_cvt_pk_bf16_f32 v73, v26, v27
L_att_l1_1:
s_waitcnt vmcnt(16) lgkmcnt(0)
s_barrier
v_mfma_f32_16x16x32_bf16 v[128:131], a[32:35], v[48:51], v[128:131]
ds_read_b128 a[0:3], v2 offset:8192
v_mfma_f32_16x16x32_bf16 v[160:163], a[32:35], v[52:55], v[160:163]
v_exp_f32 v28, v28
v_mfma_f32_16x16x32_bf16 v[192:195], a[32:35], v[56:59], v[192:195]
v_mfma_f32_16x16x32_bf16 v[224:227], a[32:35], v[60:63], v[224:227]
ds_read_b128 a[4:7], v2 offset:9216
s_add_u32 m0, s19, 0x0
v_mfma_f32_16x16x32_bf16 v[228:231], a[36:39], v[60:63], v[228:231]
buffer_load_dwordx4 v3, s[48:51], s32 offen offset:0 sc1 lds
v_mfma_f32_16x16x32_bf16 v[196:199], a[36:39], v[56:59], v[196:199]
v_exp_f32 v29, v29
v_mfma_f32_16x16x32_bf16 v[164:167], a[36:39], v[52:55], v[164:167]
ds_read_b128 a[8:11], v2 offset:10240
v_cvt_pk_bf16_f32 v76, v28, v29
v_mfma_f32_16x16x32_bf16 v[132:135], a[36:39], v[48:51], v[132:135]
v_exp_f32 v30, v30
v_mfma_f32_16x16x32_bf16 v[136:139], a[40:43], v[48:51], v[136:139]
v_mfma_f32_16x16x32_bf16 v[168:171], a[40:43], v[52:55], v[168:171]
v_exp_f32 v31, v31
v_mfma_f32_16x16x32_bf16 v[200:203], a[40:43], v[56:59], v[200:203]
ds_read_b128 a[12:15], v2 offset:11264
v_cvt_pk_bf16_f32 v77, v30, v31
v_mfma_f32_16x16x32_bf16 v[232:235], a[40:43], v[60:63], v[232:235]
v_exp_f32 v32, v32
v_mfma_f32_16x16x32_bf16 v[236:239], a[44:47], v[60:63], v[236:239]
v_exp_f32 v33, v33
v_mfma_f32_16x16x32_bf16 v[204:207], a[44:47], v[56:59], v[204:207]
ds_read_b128 a[16:19], v2 offset:12288
s_mov_b32 s9, 0x200000
v_mfma_f32_16x16x32_bf16 v[172:175], a[44:47], v[52:55], v[172:175]
buffer_load_dword v9, v8, s[64:67], s9 offen
v_mfma_f32_16x16x32_bf16 v[140:143], a[44:47], v[48:51], v[140:143]
v_cvt_pk_bf16_f32 v66, v32, v33
v_mfma_f32_16x16x32_bf16 v[144:147], a[48:51], v[48:51], v[144:147]
v_exp_f32 v34, v34
v_mfma_f32_16x16x32_bf16 v[176:179], a[48:51], v[52:55], v[176:179]
ds_read_b128 a[20:23], v2 offset:13312
v_mfma_f32_16x16x32_bf16 v[208:211], a[48:51], v[56:59], v[208:211]
v_exp_f32 v35, v35
v_mfma_f32_16x16x32_bf16 v[240:243], a[48:51], v[60:63], v[240:243]
v_exp_f32 v36, v36
v_mfma_f32_16x16x32_bf16 v[244:247], a[52:55], v[60:63], v[244:247]
ds_read_b128 a[24:27], v2 offset:14336
v_cvt_pk_bf16_f32 v67, v34, v35
v_mfma_f32_16x16x32_bf16 v[212:215], a[52:55], v[56:59], v[212:215]
v_mfma_f32_16x16x32_bf16 v[180:183], a[52:55], v[52:55], v[180:183]
v_exp_f32 v37, v37
v_mfma_f32_16x16x32_bf16 v[148:151], a[52:55], v[48:51], v[148:151]
v_exp_f32 v38, v38
v_mfma_f32_16x16x32_bf16 v[152:155], a[56:59], v[48:51], v[152:155]
buffer_load_dwordx4 v3, s[48:51], s32 offen offset:1024 sc1 lds
v_mfma_f32_16x16x32_bf16 v[184:187], a[56:59], v[52:55], v[184:187]
ds_read_b128 a[28:31], v2 offset:15360
v_cvt_pk_bf16_f32 v70, v36, v37
v_mfma_f32_16x16x32_bf16 v[216:219], a[56:59], v[56:59], v[216:219]
v_exp_f32 v39, v39
v_mfma_f32_16x16x32_bf16 v[248:251], a[56:59], v[60:63], v[248:251]
ds_read_b128 a[32:35], v2 offset:0
v_cvt_pk_bf16_f32 v71, v38, v39
v_mfma_f32_16x16x32_bf16 v[252:255], a[60:63], v[60:63], v[252:255]
v_mfma_f32_16x16x32_bf16 v[220:223], a[60:63], v[56:59], v[220:223]
v_exp_f32 v40, v40
v_mfma_f32_16x16x32_bf16 v[188:191], a[60:63], v[52:55], v[188:191]
ds_read_b128 a[36:39], v2 offset:1024
v_mfma_f32_16x16x32_bf16 v[156:159], a[60:63], v[48:51], v[156:159]
v_exp_f32 v41, v41
v_mfma_f32_16x16x32_bf16 a[224:227], a[240:243], v[48:51], a[224:227]
v_exp_f32 v42, v42
v_mfma_f32_16x16x32_bf16 a[228:231], a[240:243], v[52:55], a[228:231]
buffer_load_dwordx4 v3, s[48:51], s32 offen offset:2048 sc1 lds
v_mfma_f32_16x16x32_bf16 a[232:235], a[240:243], v[56:59], a[232:235]
ds_read_b128 a[40:43], v2 offset:2048
v_cvt_pk_bf16_f32 v74, v40, v41
v_mfma_f32_16x16x32_bf16 a[236:239], a[240:243], v[60:63], a[236:239]
s_waitcnt lgkmcnt(7)
v_mfma_f32_16x16x32_bf16 v[20:23], a[0:3], a[176:179], v[104:107]
v_exp_f32 v43, v43
v_mfma_f32_16x16x32_bf16 v[20:23], a[4:7], a[180:183], v[20:23]
ds_read_b128 a[44:47], v2 offset:3072
v_cvt_pk_bf16_f32 v75, v42, v43
v_mfma_f32_16x16x32_bf16 v[20:23], a[8:11], a[184:187], v[20:23]
v_exp_f32 v44, v44
v_mfma_f32_16x16x32_bf16 v[20:23], a[12:15], a[188:191], v[20:23]
v_mfma_f32_16x16x32_bf16 v[24:27], a[0:3], a[192:195], v[88:91]
v_exp_f32 v45, v45
v_mfma_f32_16x16x32_bf16 v[24:27], a[4:7], a[196:199], v[24:27]
ds_read_b128 a[48:51], v2 offset:4096
v_cvt_pk_bf16_f32 v78, v44, v45
v_mfma_f32_16x16x32_bf16 v[24:27], a[8:11], a[200:203], v[24:27]
v_exp_f32 v46, v46
v_mfma_f32_16x16x32_bf16 v[24:27], a[12:15], a[204:207], v[24:27]
buffer_load_dwordx4 v3, s[48:51], s32 offen offset:3072 sc1 lds
v_mfma_f32_16x16x32_bf16 v[28:31], a[0:3], a[208:211], v[92:95]
ds_read_b128 a[52:55], v2 offset:5120
v_mfma_f32_16x16x32_bf16 v[28:31], a[4:7], a[212:215], v[28:31]
v_exp_f32 v47, v47
v_mfma_f32_16x16x32_bf16 v[28:31], a[8:11], a[216:219], v[28:31]
v_cvt_pk_bf16_f32 v79, v46, v47
v_mfma_f32_16x16x32_bf16 v[28:31], a[12:15], a[220:223], v[28:31]
s_waitcnt lgkmcnt(6)
v_exp_f32 v20, v20
v_mfma_f32_16x16x32_bf16 v[36:39], a[16:19], a[176:179], v[108:111]
ds_read_b128 a[56:59], v2 offset:6144
v_mfma_f32_16x16x32_bf16 v[36:39], a[20:23], a[180:183], v[36:39]
v_exp_f32 v21, v21
v_mfma_f32_16x16x32_bf16 v[36:39], a[24:27], a[184:187], v[36:39]
v_exp_f32 v22, v22
v_mfma_f32_16x16x32_bf16 v[36:39], a[28:31], a[188:191], v[36:39]
ds_read_b128 a[60:63], v2 offset:7168
v_cvt_pk_bf16_f32 v52, v20, v21
v_mfma_f32_16x16x32_bf16 v[40:43], a[16:19], a[192:195], v[88:91]
s_mov_b32 s9, 0x600000
v_mfma_f32_16x16x32_bf16 v[40:43], a[20:23], a[196:199], v[40:43]
buffer_load_dword v9, v8, s[64:67], s9 offen
v_mfma_f32_16x16x32_bf16 v[40:43], a[24:27], a[200:203], v[40:43]
v_exp_f32 v23, v23
v_mfma_f32_16x16x32_bf16 v[40:43], a[28:31], a[204:207], v[40:43]
v_exp_f32 v24, v24
v_mfma_f32_16x16x32_bf16 v[44:47], a[16:19], a[208:211], v[92:95]
v_exp_f32 v25, v25
v_mfma_f32_16x16x32_bf16 v[44:47], a[20:23], a[212:215], v[44:47]
v_exp_f32 v26, v26
v_mfma_f32_16x16x32_bf16 v[44:47], a[24:27], a[216:219], v[44:47]
v_exp_f32 v27, v27
v_mfma_f32_16x16x32_bf16 v[44:47], a[28:31], a[220:223], v[44:47]
v_cvt_pk_bf16_f32 v53, v22, v23
v_cvt_pk_bf16_f32 v56, v24, v25
v_cvt_pk_bf16_f32 v57, v26, v27
s_waitcnt lgkmcnt(0)
v_mfma_f32_16x16x32_bf16 v[128:131], a[32:35], v[64:67], v[128:131]
ds_read_b128 a[0:3], v2 offset:24576
v_mfma_f32_16x16x32_bf16 v[160:163], a[32:35], v[68:71], v[160:163]
v_exp_f32 v28, v28
v_mfma_f32_16x16x32_bf16 v[192:195], a[32:35], v[72:75], v[192:195]
ds_read_b128 a[4:7], v2 offset:25600
v_mfma_f32_16x16x32_bf16 v[224:227], a[32:35], v[76:79], v[224:227]
v_mfma_f32_16x16x32_bf16 v[228:231], a[36:39], v[76:79], v[228:231]
s_add_u32 m0, s19, 0x1000
v_exp_f32 v29, v29
v_mfma_f32_16x16x32_bf16 v[196:199], a[36:39], v[72:75], v[196:199]
buffer_load_dwordx4 v3, s[48:51], s7 offen offset:0 sc1 lds
v_mfma_f32_16x16x32_bf16 v[164:167], a[36:39], v[68:71], v[164:167]
ds_read_b128 a[8:11], v2 offset:26624
v_cvt_pk_bf16_f32 v60, v28, v29
v_mfma_f32_16x16x32_bf16 v[132:135], a[36:39], v[64:67], v[132:135]
v_exp_f32 v30, v30
v_mfma_f32_16x16x32_bf16 v[136:139], a[40:43], v[64:67], v[136:139]
ds_read_b128 a[12:15], v2 offset:27648
v_mfma_f32_16x16x32_bf16 v[168:171], a[40:43], v[68:71], v[168:171]
v_mfma_f32_16x16x32_bf16 v[200:203], a[40:43], v[72:75], v[200:203]
v_exp_f32 v31, v31
v_mfma_f32_16x16x32_bf16 v[232:235], a[40:43], v[76:79], v[232:235]
ds_read_b128 a[16:19], v2 offset:28672
v_cvt_pk_bf16_f32 v61, v30, v31
v_mfma_f32_16x16x32_bf16 v[236:239], a[44:47], v[76:79], v[236:239]
v_exp_f32 v36, v36
v_mfma_f32_16x16x32_bf16 v[204:207], a[44:47], v[72:75], v[204:207]
v_exp_f32 v37, v37
v_mfma_f32_16x16x32_bf16 v[172:175], a[44:47], v[68:71], v[172:175]
ds_read_b128 a[20:23], v2 offset:29696
v_cvt_pk_bf16_f32 v54, v36, v37
v_mfma_f32_16x16x32_bf16 v[140:143], a[44:47], v[64:67], v[140:143]
buffer_load_dwordx4 v3, s[48:51], s7 offen offset:1024 sc1 lds
v_mfma_f32_16x16x32_bf16 v[144:147], a[48:51], v[64:67], v[144:147]
v_mfma_f32_16x16x32_bf16 v[176:179], a[48:51], v[68:71], v[176:179]
ds_read_b128 a[24:27], v2 offset:30720
v_mfma_f32_16x16x32_bf16 v[208:211], a[48:51], v[72:75], v[208:211]
v_exp_f32 v38, v38
v_mfma_f32_16x16x32_bf16 v[240:243], a[48:51], v[76:79], v[240:243]
v_exp_f32 v39, v39
v_mfma_f32_16x16x32_bf16 v[244:247], a[52:55], v[76:79], v[244:247]
ds_read_b128 a[28:31], v2 offset:31744
v_cvt_pk_bf16_f32 v55, v38, v39
v_mfma_f32_16x16x32_bf16 v[212:215], a[52:55], v[72:75], v[212:215]
v_exp_f32 v40, v40
v_mfma_f32_16x16x32_bf16 v[180:183], a[52:55], v[68:71], v[180:183]
v_mfma_f32_16x16x32_bf16 v[148:151], a[52:55], v[64:67], v[148:151]
ds_read_b128 a[32:35], v2 offset:16384
v_mfma_f32_16x16x32_bf16 v[152:155], a[56:59], v[64:67], v[152:155]
v_exp_f32 v41, v41
v_mfma_f32_16x16x32_bf16 v[184:187], a[56:59], v[68:71], v[184:187]
buffer_load_dwordx4 v3, s[48:51], s7 offen offset:2048 sc1 lds
v_mfma_f32_16x16x32_bf16 v[216:219], a[56:59], v[72:75], v[216:219]
ds_read_b128 a[36:39], v2 offset:17408
v_cvt_pk_bf16_f32 v58, v40, v41
v_mfma_f32_16x16x32_bf16 v[248:251], a[56:59], v[76:79], v[248:251]
v_exp_f32 v42, v42
v_mfma_f32_16x16x32_bf16 v[252:255], a[60:63], v[76:79], v[252:255]
v_exp_f32 v43, v43
v_mfma_f32_16x16x32_bf16 v[220:223], a[60:63], v[72:75], v[220:223]
ds_read_b128 a[40:43], v2 offset:18432
v_cvt_pk_bf16_f32 v59, v42, v43
v_mfma_f32_16x16x32_bf16 v[188:191], a[60:63], v[68:71], v[188:191]
v_mfma_f32_16x16x32_bf16 v[156:159], a[60:63], v[64:67], v[156:159]
v_exp_f32 v44, v44
v_mfma_f32_16x16x32_bf16 a[224:227], a[240:243], v[64:67], a[224:227]
ds_read_b128 a[44:47], v2 offset:19456
v_mfma_f32_16x16x32_bf16 a[228:231], a[240:243], v[68:71], a[228:231]
v_exp_f32 v45, v45
v_mfma_f32_16x16x32_bf16 a[232:235], a[240:243], v[72:75], a[232:235]
s_waitcnt lgkmcnt(8)
v_exp_f32 v46, v46
v_mfma_f32_16x16x32_bf16 a[236:239], a[240:243], v[76:79], a[236:239]
buffer_load_dwordx4 v3, s[48:51], s7 offen offset:3072 sc1 lds
v_mfma_f32_16x16x32_bf16 v[24:27], a[0:3], a[192:195], v[88:91]
ds_read_b128 a[48:51], v2 offset:20480
v_cvt_pk_bf16_f32 v62, v44, v45
v_mfma_f32_16x16x32_bf16 v[24:27], a[4:7], a[196:199], v[24:27]
v_mfma_f32_16x16x32_bf16 v[24:27], a[8:11], a[200:203], v[24:27]
ds_read_b128 a[52:55], v2 offset:21504
v_mfma_f32_16x16x32_bf16 v[24:27], a[12:15], a[204:207], v[24:27]
v_exp_f32 v47, v47
v_mfma_f32_16x16x32_bf16 v[28:31], a[0:3], a[208:211], v[92:95]
v_cvt_pk_bf16_f32 v63, v46, v47
v_mfma_f32_16x16x32_bf16 v[28:31], a[4:7], a[212:215], v[28:31]
ds_read_b128 a[56:59], v2 offset:22528
v_mfma_f32_16x16x32_bf16 v[28:31], a[8:11], a[216:219], v[28:31]
v_mfma_f32_16x16x32_bf16 v[28:31], a[12:15], a[220:223], v[28:31]
s_waitcnt lgkmcnt(7)
v_mov_b32 v5, s77
v_exp_f32 v24, v24
v_mfma_f32_16x16x32_bf16 v[40:43], a[16:19], a[192:195], v[88:91]
ds_read_b128 a[60:63], v2 offset:23552
v_add_u32 v4, s76, v3
v_mfma_f32_16x16x32_bf16 v[40:43], a[20:23], a[196:199], v[40:43]
global_load_dword v9, v[4:5], off sc1
v_mfma_f32_16x16x32_bf16 v[40:43], a[24:27], a[200:203], v[40:43]
s_add_u32 s32, s32, 0x8000
s_add_u32 s7, s7, 0x8000
s_xor_b32 s19, s19, 0x8000
v_mfma_f32_16x16x32_bf16 v[40:43], a[28:31], a[204:207], v[40:43]
s_sub_u32 s15, 7, s6
s_lshl_b32 s15, s15, 1
v_xor_b32 v2, 0x38000, v2
v_mfma_f32_16x16x32_bf16 v[44:47], a[16:19], a[208:211], v[92:95]
v_exp_f32 v25, v25
v_mfma_f32_16x16x32_bf16 v[44:47], a[20:23], a[212:215], v[44:47]
v_exp_f32 v26, v26
v_mfma_f32_16x16x32_bf16 v[44:47], a[24:27], a[216:219], v[44:47]
v_exp_f32 v27, v27
v_mfma_f32_16x16x32_bf16 v[44:47], a[28:31], a[220:223], v[44:47]
v_cvt_pk_bf16_f32 v72, v24, v25
v_cvt_pk_bf16_f32 v73, v26, v27
s_cbranch_scc0 L_att_lh0_1
s_waitcnt vmcnt(16) lgkmcnt(0)
s_barrier
s_cmp_lg_u32 s33, 0
s_cbranch_scc1 L_sig_bs1
s_lshl_b32 s8, s6, 2
s_add_u32 s8, s8, 192
s_cmp_lg_u32 s4, 0
s_cbranch_scc1 L_sig_bs1
v_mov_b32 v4, 1
s_mov_b64 exec, 1
buffer_atomic_add v4, off, s[84:87], s8 sc1
s_mov_b64 exec, -1
L_sig_bs1:
v_mfma_f32_16x16x32_bf16 v[160:163], a[32:35], v[52:55], v[160:163]
ds_read_b128 a[0:3], v1 offset:8192
v_mfma_f32_16x16x32_bf16 v[192:195], a[32:35], v[56:59], v[192:195]
v_exp_f32 v28, v28
v_mfma_f32_16x16x32_bf16 v[224:227], a[32:35], v[60:63], v[224:227]
ds_read_b128 a[4:7], v1 offset:9216
v_mfma_f32_16x16x32_bf16 v[228:231], a[36:39], v[60:63], v[228:231]
v_mfma_f32_16x16x32_bf16 v[196:199], a[36:39], v[56:59], v[196:199]
ds_read_b128 a[8:11], v1 offset:10240
s_add_u32 m0, s27, 0x0
v_mfma_f32_16x16x32_bf16 v[164:167], a[36:39], v[52:55], v[164:167]
buffer_load_dwordx4 v3, s[48:51], s32 offen offset:0 sc1 lds
v_mfma_f32_16x16x32_bf16 v[168:171], a[40:43], v[52:55], v[168:171]
v_exp_f32 v29, v29
v_mfma_f32_16x16x32_bf16 v[200:203], a[40:43], v[56:59], v[200:203]
ds_read_b128 a[12:15], v1 offset:11264
v_cvt_pk_bf16_f32 v76, v28, v29
v_mfma_f32_16x16x32_bf16 v[232:235], a[40:43], v[60:63], v[232:235]
v_exp_f32 v30, v30
v_mfma_f32_16x16x32_bf16 v[236:239], a[44:47], v[60:63], v[236:239]
ds_read_b128 a[16:19], v1 offset:12288
v_mfma_f32_16x16x32_bf16 v[204:207], a[44:47], v[56:59], v[204:207]
v_mfma_f32_16x16x32_bf16 v[172:175], a[44:47], v[52:55], v[172:175]
ds_read_b128 a[20:23], v1 offset:13312
v_mfma_f32_16x16x32_bf16 v[176:179], a[48:51], v[52:55], v[176:179]
v_exp_f32 v31, v31
v_mfma_f32_16x16x32_bf16 v[208:211], a[48:51], v[56:59], v[208:211]
v_exp_f32 v40, v40
v_mfma_f32_16x16x32_bf16 v[240:243], a[48:51], v[60:63], v[240:243]
ds_read_b128 a[24:27], v1 offset:14336
v_cvt_pk_bf16_f32 v77, v30, v31
v_mfma_f32_16x16x32_bf16 v[244:247], a[52:55], v[60:63], v[244:247]
buffer_load_dwordx4 v3, s[48:51], s32 offen offset:1024 sc1 lds
v_mfma_f32_16x16x32_bf16 v[212:215], a[52:55], v[56:59], v[212:215]
ds_read_b128 a[28:31], v1 offset:15360
v_mfma_f32_16x16x32_bf16 v[180:183], a[52:55], v[52:55], v[180:183]
v_mfma_f32_16x16x32_bf16 v[184:187], a[56:59], v[52:55], v[184:187]
v_exp_f32 v41, v41
v_mfma_f32_16x16x32_bf16 v[216:219], a[56:59], v[56:59], v[216:219]
ds_read_b128 a[32:35], v1 offset:0
v_cvt_pk_bf16_f32 v74, v40, v41
v_mfma_f32_16x16x32_bf16 v[248:251], a[56:59], v[60:63], v[248:251]
v_exp_f32 v42, v42
v_mfma_f32_16x16x32_bf16 v[252:255], a[60:63], v[60:63], v[252:255]
ds_read_b128 a[36:39], v1 offset:1024
v_mfma_f32_16x16x32_bf16 v[220:223], a[60:63], v[56:59], v[220:223]
v_mfma_f32_16x16x32_bf16 v[188:191], a[60:63], v[52:55], v[188:191]
ds_read_b128 a[40:43], v1 offset:2048
v_mfma_f32_16x16x32_bf16 a[228:231], a[240:243], v[52:55], a[228:231]
v_exp_f32 v43, v43
v_mfma_f32_16x16x32_bf16 a[232:235], a[240:243], v[56:59], a[232:235]
buffer_load_dwordx4 v3, s[48:51], s32 offen offset:2048 sc1 lds
v_mfma_f32_16x16x32_bf16 a[236:239], a[240:243], v[60:63], a[236:239]
ds_read_b128 a[44:47], v1 offset:3072
s_waitcnt lgkmcnt(8)
v_mfma_f32_16x16x32_bf16 v[24:27], a[0:3], a[192:195], v[88:91]
v_exp_f32 v44, v44
v_mfma_f32_16x16x32_bf16 v[24:27], a[4:7], a[196:199], v[24:27]
ds_read_b128 a[48:51], v1 offset:4096
v_cvt_pk_bf16_f32 v75, v42, v43
v_mfma_f32_16x16x32_bf16 v[24:27], a[8:11], a[200:203], v[24:27]
v_exp_f32 v45, v45
v_mfma_f32_16x16x32_bf16 v[24:27], a[12:15], a[204:207], v[24:27]
ds_read_b128 a[52:55], v1 offset:5120
v_cvt_pk_bf16_f32 v78, v44, v45
v_mfma_f32_16x16x32_bf16 v[28:31], a[0:3], a[208:211], v[92:95]
v_mfma_f32_16x16x32_bf16 v[28:31], a[4:7], a[212:215], v[28:31]
v_exp_f32 v46, v46
v_mfma_f32_16x16x32_bf16 v[28:31], a[8:11], a[216:219], v[28:31]
ds_read_b128 a[56:59], v1 offset:6144
v_mfma_f32_16x16x32_bf16 v[28:31], a[12:15], a[220:223], v[28:31]
s_waitcnt lgkmcnt(7)
v_exp_f32 v47, v47
v_mfma_f32_16x16x32_bf16 v[40:43], a[16:19], a[192:195], v[88:91]
buffer_load_dwordx4 v3, s[48:51], s32 offen offset:3072 sc1 lds
v_mfma_f32_16x16x32_bf16 v[40:43], a[20:23], a[196:199], v[40:43]
ds_read_b128 a[60:63], v1 offset:7168
v_cvt_pk_bf16_f32 v79, v46, v47
v_mfma_f32_16x16x32_bf16 v[40:43], a[24:27], a[200:203], v[40:43]
v_mfma_f32_16x16x32_bf16 v[40:43], a[28:31], a[204:207], v[40:43]
v_exp_f32 v24, v24
v_mfma_f32_16x16x32_bf16 v[44:47], a[16:19], a[208:211], v[92:95]
v_exp_f32 v25, v25
v_mfma_f32_16x16x32_bf16 v[44:47], a[20:23], a[212:215], v[44:47]
v_exp_f32 v26, v26
v_mfma_f32_16x16x32_bf16 v[44:47], a[24:27], a[216:219], v[44:47]
v_exp_f32 v27, v27
v_mfma_f32_16x16x32_bf16 v[44:47], a[28:31], a[220:223], v[44:47]
v_cvt_pk_bf16_f32 v56, v24, v25
v_cvt_pk_bf16_f32 v57, v26, v27
s_waitcnt lgkmcnt(0)
v_mfma_f32_16x16x32_bf16 v[192:195], a[32:35], v[72:75], v[192:195]
ds_read_b128 a[0:3], v1 offset:24576
v_exp_f32 v28, v28
v_mfma_f32_16x16x32_bf16 v[224:227], a[32:35], v[76:79], v[224:227]
ds_read_b128 a[4:7], v1 offset:25600
v_exp_f32 v29, v29
v_mfma_f32_16x16x32_bf16 v[228:231], a[36:39], v[76:79], v[228:231]
v_exp_f32 v30, v30
v_mfma_f32_16x16x32_bf16 v[196:199], a[36:39], v[72:75], v[196:199]
ds_read_b128 a[8:11], v1 offset:26624
s_add_u32 m0, s27, 0x1000
v_mfma_f32_16x16x32_bf16 v[200:203], a[40:43], v[72:75], v[200:203]
buffer_load_dwordx4 v3, s[48:51], s7 offen offset:0 sc1 lds
v_mfma_f32_16x16x32_bf16 v[232:235], a[40:43], v[76:79], v[232:235]
ds_read_b128 a[12:15], v1 offset:27648
v_exp_f32 v31, v31
v_mfma_f32_16x16x32_bf16 v[236:239], a[44:47], v[76:79], v[236:239]
v_exp_f32 v40, v40
v_mfma_f32_16x16x32_bf16 v[204:207], a[44:47], v[72:75], v[204:207]
ds_read_b128 a[16:19], v1 offset:28672
v_exp_f32 v41, v41
v_mfma_f32_16x16x32_bf16 v[208:211], a[48:51], v[72:75], v[208:211]
v_exp_f32 v42, v42
v_mfma_f32_16x16x32_bf16 v[240:243], a[48:51], v[76:79], v[240:243]
ds_read_b128 a[20:23], v1 offset:29696
v_exp_f32 v43, v43
v_mfma_f32_16x16x32_bf16 v[244:247], a[52:55], v[76:79], v[244:247]
ds_read_b128 a[24:27], v1 offset:30720
v_cvt_pk_bf16_f32 v60, v28, v29
v_mfma_f32_16x16x32_bf16 v[212:215], a[52:55], v[72:75], v[212:215]
v_exp_f32 v44, v44
v_mfma_f32_16x16x32_bf16 v[216:219], a[56:59], v[72:75], v[216:219]
buffer_load_dwordx4 v3, s[48:51], s7 offen offset:1024 sc1 lds
v_mfma_f32_16x16x32_bf16 v[248:251], a[56:59], v[76:79], v[248:251]
ds_read_b128 a[28:31], v1 offset:31744
v_cvt_pk_bf16_f32 v61, v30, v31
v_mfma_f32_16x16x32_bf16 v[252:255], a[60:63], v[76:79], v[252:255]
ds_read_b128 a[32:35], v1 offset:16384
v_cvt_pk_bf16_f32 v58, v40, v41
v_mfma_f32_16x16x32_bf16 v[220:223], a[60:63], v[72:75], v[220:223]
v_exp_f32 v45, v45
v_mfma_f32_16x16x32_bf16 a[232:235], a[240:243], v[72:75], a[232:235]
ds_read_b128 a[36:39], v1 offset:17408
v_cvt_pk_bf16_f32 v59, v42, v43
v_mfma_f32_16x16x32_bf16 a[236:239], a[240:243], v[76:79], a[236:239]
s_waitcnt lgkmcnt(6)
v_exp_f32 v46, v46
v_mfma_f32_16x16x32_bf16 v[24:27], a[0:3], a[192:195], v[88:91]
ds_read_b128 a[40:43], v1 offset:18432
v_cvt_pk_bf16_f32 v62, v44, v45
v_mfma_f32_16x16x32_bf16 v[24:27], a[4:7], a[196:199], v[24:27]
ds_read_b128 a[44:47], v1 offset:19456
v_mfma_f32_16x16x32_bf16 v[24:27], a[8:11], a[200:203], v[24:27]
buffer_load_dwordx4 v3, s[48:51], s7 offen offset:2048 sc1 lds
v_mfma_f32_16x16x32_bf16 v[24:27], a[12:15], a[204:207], v[24:27]
ds_read_b128 a[48:51], v1 offset:20480
v_mfma_f32_16x16x32_bf16 v[28:31], a[0:3], a[208:211], v[92:95]
v_exp_f32 v47, v47
v_mfma_f32_16x16x32_bf16 v[28:31], a[4:7], a[212:215], v[28:31]
ds_read_b128 a[52:55], v1 offset:21504
v_cvt_pk_bf16_f32 v63, v46, v47
v_mfma_f32_16x16x32_bf16 v[28:31], a[8:11], a[216:219], v[28:31]
v_mfma_f32_16x16x32_bf16 v[28:31], a[12:15], a[220:223], v[28:31]
ds_read_b128 a[56:59], v1 offset:22528
s_waitcnt lgkmcnt(7)
v_mfma_f32_16x16x32_bf16 v[40:43], a[16:19], a[192:195], v[88:91]
v_exp_f32 v24, v24
v_mfma_f32_16x16x32_bf16 v[40:43], a[20:23], a[196:199], v[40:43]
ds_read_b128 a[60:63], v1 offset:23552
v_exp_f32 v25, v25
v_mfma_f32_16x16x32_bf16 v[40:43], a[24:27], a[200:203], v[40:43]
buffer_load_dwordx4 v3, s[48:51], s7 offen offset:3072 sc1 lds
v_mfma_f32_16x16x32_bf16 v[40:43], a[28:31], a[204:207], v[40:43]
s_add_u32 s32, s32, 0x8000
s_add_u32 s7, s7, 0x8000
s_xor_b32 s27, s27, 0x38000
v_mfma_f32_16x16x32_bf16 v[44:47], a[16:19], a[208:211], v[92:95]
v_xor_b32 v1, 0x8000, v1
v_cvt_pk_bf16_f32 v72, v24, v25
v_mfma_f32_16x16x32_bf16 v[44:47], a[20:23], a[212:215], v[44:47]
v_exp_f32 v26, v26
v_mfma_f32_16x16x32_bf16 v[44:47], a[24:27], a[216:219], v[44:47]
v_exp_f32 v27, v27
v_mfma_f32_16x16x32_bf16 v[44:47], a[28:31], a[220:223], v[44:47]
v_cvt_pk_bf16_f32 v73, v26, v27
s_nop 7
v_accvgpr_read_b32 v4, a224
v_accvgpr_read_b32 v6, a228
s_mov_b32 s8, 0x5f800000
v_cmp_nge_f32 s[36:37], s8, v4
v_cmp_nge_f32 s[38:39], s8, v6
v_rcp_f32 v4, v4
v_rcp_f32 v6, v6
s_or_b64 s[34:35], s[34:35], s[36:37]
s_or_b64 s[34:35], s[34:35], s[38:39]
v_pk_mul_f32 v[128:129], v[128:129], v[4:5] op_sel_hi:[1,0]
v_pk_mul_f32 v[130:131], v[130:131], v[4:5] op_sel_hi:[1,0]
v_pk_mul_f32 v[132:133], v[132:133], v[4:5] op_sel_hi:[1,0]
v_pk_mul_f32 v[134:135], v[134:135], v[4:5] op_sel_hi:[1,0]
v_cvt_pk_bf16_f32 v128, v128, v129
v_cvt_pk_bf16_f32 v129, v130, v131
v_cvt_pk_bf16_f32 v130, v132, v133
v_cvt_pk_bf16_f32 v131, v134, v135
s_add_u32 s8, s28, 0x0
buffer_store_dwordx4 v[128:131], v3, s[88:91], s8 offen sc1
v_pk_mul_f32 v[136:137], v[136:137], v[4:5] op_sel_hi:[1,0]
v_pk_mul_f32 v[138:139], v[138:139], v[4:5] op_sel_hi:[1,0]
v_pk_mul_f32 v[140:141], v[140:141], v[4:5] op_sel_hi:[1,0]
v_pk_mul_f32 v[142:143], v[142:143], v[4:5] op_sel_hi:[1,0]
v_cvt_pk_bf16_f32 v136, v136, v137
v_cvt_pk_bf16_f32 v137, v138, v139
v_cvt_pk_bf16_f32 v138, v140, v141
v_cvt_pk_bf16_f32 v139, v142, v143
s_add_u32 s8, s28, 0x2000
buffer_store_dwordx4 v[136:139], v3, s[88:91], s8 offen sc1
v_pk_mul_f32 v[144:145], v[144:145], v[4:5] op_sel_hi:[1,0]
v_pk_mul_f32 v[146:147], v[146:147], v[4:5] op_sel_hi:[1,0]
v_pk_mul_f32 v[148:149], v[148:149], v[4:5] op_sel_hi:[1,0]
v_pk_mul_f32 v[150:151], v[150:151], v[4:5] op_sel_hi:[1,0]
v_cvt_pk_bf16_f32 v144, v144, v145
v_cvt_pk_bf16_f32 v145, v146, v147
v_cvt_pk_bf16_f32 v146, v148, v149
v_cvt_pk_bf16_f32 v147, v150, v151
s_add_u32 s8, s28, 0x4000
buffer_store_dwordx4 v[144:147], v3, s[88:91], s8 offen sc1
v_pk_mul_f32 v[152:153], v[152:153], v[4:5] op_sel_hi:[1,0]
v_pk_mul_f32 v[154:155], v[154:155], v[4:5] op_sel_hi:[1,0]
v_pk_mul_f32 v[156:157], v[156:157], v[4:5] op_sel_hi:[1,0]
v_pk_mul_f32 v[158:159], v[158:159], v[4:5] op_sel_hi:[1,0]
v_cvt_pk_bf16_f32 v152, v152, v153
v_cvt_pk_bf16_f32 v153, v154, v155
v_cvt_pk_bf16_f32 v154, v156, v157
v_cvt_pk_bf16_f32 v155, v158, v159
s_add_u32 s8, s28, 0x6000
buffer_store_dwordx4 v[152:155], v3, s[88:91], s8 offen sc1
v_pk_mul_f32 v[160:161], v[160:161], v[6:7] op_sel_hi:[1,0]
v_pk_mul_f32 v[162:163], v[162:163], v[6:7] op_sel_hi:[1,0]
v_pk_mul_f32 v[164:165], v[164:165], v[6:7] op_sel_hi:[1,0]
v_pk_mul_f32 v[166:167], v[166:167], v[6:7] op_sel_hi:[1,0]
v_cvt_pk_bf16_f32 v160, v160, v161
v_cvt_pk_bf16_f32 v161, v162, v163
v_cvt_pk_bf16_f32 v162, v164, v165
v_cvt_pk_bf16_f32 v163, v166, v167
s_add_u32 s8, s29, 0x0
buffer_store_dwordx4 v[160:163], v3, s[88:91], s8 offen sc1
v_pk_mul_f32 v[168:169], v[168:169], v[6:7] op_sel_hi:[1,0]
v_pk_mul_f32 v[170:171], v[170:171], v[6:7] op_sel_hi:[1,0]
v_pk_mul_f32 v[172:173], v[172:173], v[6:7] op_sel_hi:[1,0]
v_pk_mul_f32 v[174:175], v[174:175], v[6:7] op_sel_hi:[1,0]
v_cvt_pk_bf16_f32 v168, v168, v169
v_cvt_pk_bf16_f32 v169, v170, v171
v_cvt_pk_bf16_f32 v170, v172, v173
v_cvt_pk_bf16_f32 v171, v174, v175
s_add_u32 s8, s29, 0x2000
buffer_store_dwordx4 v[168:171], v3, s[88:91], s8 offen sc1
v_pk_mul_f32 v[176:177], v[176:177], v[6:7] op_sel_hi:[1,0]
v_pk_mul_f32 v[178:179], v[178:179], v[6:7] op_sel_hi:[1,0]
v_pk_mul_f32 v[180:181], v[180:181], v[6:7] op_sel_hi:[1,0]
v_pk_mul_f32 v[182:183], v[182:183], v[6:7] op_sel_hi:[1,0]
v_cvt_pk_bf16_f32 v176, v176, v177
v_cvt_pk_bf16_f32 v177, v178, v179
v_cvt_pk_bf16_f32 v178, v180, v181
v_cvt_pk_bf16_f32 v179, v182, v183
s_add_u32 s8, s29, 0x4000
buffer_store_dwordx4 v[176:179], v3, s[88:91], s8 offen sc1
v_pk_mul_f32 v[184:185], v[184:185], v[6:7] op_sel_hi:[1,0]
v_pk_mul_f32 v[186:187], v[186:187], v[6:7] op_sel_hi:[1,0]
v_pk_mul_f32 v[188:189], v[188:189], v[6:7] op_sel_hi:[1,0]
v_pk_mul_f32 v[190:191], v[190:191], v[6:7] op_sel_hi:[1,0]
v_cvt_pk_bf16_f32 v184, v184, v185
v_cvt_pk_bf16_f32 v185, v186, v187
v_cvt_pk_bf16_f32 v186, v188, v189
v_cvt_pk_bf16_f32 v187, v190, v191
s_add_u32 s8, s29, 0x6000
buffer_store_dwordx4 v[184:187], v3, s[88:91], s8 offen sc1
s_branch L_att_sodd
L_att_lh0_1:
s_waitcnt vmcnt(16) lgkmcnt(0)
s_barrier
s_cmp_lg_u32 s33, 0
s_cbranch_scc1 L_sig_bh1
s_lshl_b32 s8, s6, 2
s_add_u32 s8, s8, 192
s_cmp_lg_u32 s4, 0
s_cbranch_scc1 L_sig_bh1
v_mov_b32 v4, 1
s_mov_b64 exec, 1
buffer_atomic_add v4, off, s[84:87], s8 sc1
s_mov_b64 exec, -1
L_sig_bh1:
v_and_b32 v15, 7, v0
v_lshlrev_b32 v15, 2, v15
s_bfe_u32 s99, s2, 0x20001
s_lshl_b32 s99, s99, 2
s_lshr_b32 s8, s2, 6
s_add_u32 s99, s99, s8
buffer_load_dword v14, v15, s[84:87], 0 offen offset:192 sc1
s_bfe_u32 s100, s2, 0x30003
s_and_b32 s10, s2, 1
s_sub_u32 s11, 15, s99
s_min_u32 s11, s11, s99
s_lshl_b32 s11, s11, 1
s_add_u32 s11, s11, s10
s_lshl_b32 s11, s11, 6
s_add_u32 s11, s11, 0x3604000
s_mov_b32 s12, 14336
v_bfe_u32 v12, v0, 2, 2
v_lshlrev_b32 v12, 11, v12
v_lshrrev_b32 v13, 4, v0
v_lshl_add_u32 v12, v13, 6, v12
v_and_b32 v13, 3, v0
v_lshl_add_u32 v12, v13, 4, v12
s_lshl_b32 s8, s10, 7
v_xor_b32 v12, s8, v12
s_lshl_b32 s8, s4, 15
s_lshl_b32 s9, s100, 8
s_add_u32 s8, s8, s9
s_lshl_b32 s9, s10, 20
s_add_u32 s8, s8, s9
v_add_u32 v12, s8, v12
v_xor_b32 v13, 32, v12
v_add_u32 v13, 7168, v13
s_mul_i32 s25, s10, 0x300000
s_sub_u32 s25, s25, 917504
s_mul_i32 s101, s99, 0x140000
s_lshl_b32 s8, s4, 11
s_add_u32 s101, s101, s8
s_lshl_b32 s8, s10, 17
s_add_u32 s101, s101, s8
s_add_u32 s101, s101, 0x21fe000
s_mul_i32 s26, s10, 393216
s_add_u32 s26, s26, 139264
v_mfma_f32_16x16x32_bf16 v[160:163], a[32:35], v[52:55], v[160:163]
ds_read_b128 a[0:3], v1 offset:8192
v_mfma_f32_16x16x32_bf16 v[192:195], a[32:35], v[56:59], v[192:195]
v_exp_f32 v28, v28
v_mfma_f32_16x16x32_bf16 v[224:227], a[32:35], v[60:63], v[224:227]
ds_read_b128 a[4:7], v1 offset:9216
v_mfma_f32_16x16x32_bf16 v[228:231], a[36:39], v[60:63], v[228:231]
v_mfma_f32_16x16x32_bf16 v[196:199], a[36:39], v[56:59], v[196:199]
ds_read_b128 a[8:11], v1 offset:10240
s_add_u32 m0, s17, 0x10000
v_mfma_f32_16x16x32_bf16 v[164:167], a[36:39], v[52:55], v[164:167]
buffer_load_dwordx4 v12, s[72:75], 0 offen lds
v_mfma_f32_16x16x32_bf16 v[168:171], a[40:43], v[52:55], v[168:171]
v_exp_f32 v29, v29
v_mfma_f32_16x16x32_bf16 v[200:203], a[40:43], v[56:59], v[200:203]
ds_read_b128 a[12:15], v1 offset:11264
v_cvt_pk_bf16_f32 v76, v28, v29
v_mfma_f32_16x16x32_bf16 v[232:235], a[40:43], v[60:63], v[232:235]
v_exp_f32 v30, v30
v_mfma_f32_16x16x32_bf16 v[236:239], a[44:47], v[60:63], v[236:239]
ds_read_b128 a[16:19], v1 offset:12288
v_mfma_f32_16x16x32_bf16 v[204:207], a[44:47], v[56:59], v[204:207]
v_mfma_f32_16x16x32_bf16 v[172:175], a[44:47], v[52:55], v[172:175]
ds_read_b128 a[20:23], v1 offset:13312
v_mfma_f32_16x16x32_bf16 v[176:179], a[48:51], v[52:55], v[176:179]
v_exp_f32 v31, v31
v_mfma_f32_16x16x32_bf16 v[208:211], a[48:51], v[56:59], v[208:211]
v_exp_f32 v40, v40
v_mfma_f32_16x16x32_bf16 v[240:243], a[48:51], v[60:63], v[240:243]
ds_read_b128 a[24:27], v1 offset:14336
v_cvt_pk_bf16_f32 v77, v30, v31
v_mfma_f32_16x16x32_bf16 v[244:247], a[52:55], v[60:63], v[244:247]
buffer_load_dwordx4 v13, s[72:75], 0 offen offset:1024 lds
v_mfma_f32_16x16x32_bf16 v[212:215], a[52:55], v[56:59], v[212:215]
ds_read_b128 a[28:31], v1 offset:15360
v_mfma_f32_16x16x32_bf16 v[180:183], a[52:55], v[52:55], v[180:183]
v_mfma_f32_16x16x32_bf16 v[184:187], a[56:59], v[52:55], v[184:187]
v_exp_f32 v41, v41
v_mfma_f32_16x16x32_bf16 v[216:219], a[56:59], v[56:59], v[216:219]
ds_read_b128 a[32:35], v1 offset:0
v_cvt_pk_bf16_f32 v74, v40, v41
v_mfma_f32_16x16x32_bf16 v[248:251], a[56:59], v[60:63], v[248:251]
v_exp_f32 v42, v42
v_mfma_f32_16x16x32_bf16 v[252:255], a[60:63], v[60:63], v[252:255]
ds_read_b128 a[36:39], v1 offset:1024
v_mfma_f32_16x16x32_bf16 v[220:223], a[60:63], v[56:59], v[220:223]
v_mfma_f32_16x16x32_bf16 v[188:191], a[60:63], v[52:55], v[188:191]
ds_read_b128 a[40:43], v1 offset:2048
v_mfma_f32_16x16x32_bf16 a[228:231], a[240:243], v[52:55], a[228:231]
v_exp_f32 v43, v43
v_mfma_f32_16x16x32_bf16 a[232:235], a[240:243], v[56:59], a[232:235]
buffer_load_dwordx4 v12, s[72:75], s12 offen offset:2048 lds
v_mfma_f32_16x16x32_bf16 a[236:239], a[240:243], v[60:63], a[236:239]
ds_read_b128 a[44:47], v1 offset:3072
s_waitcnt lgkmcnt(8)
v_mfma_f32_16x16x32_bf16 v[24:27], a[0:3], a[192:195], v[88:91]
v_exp_f32 v44, v44
v_mfma_f32_16x16x32_bf16 v[24:27], a[4:7], a[196:199], v[24:27]
ds_read_b128 a[48:51], v1 offset:4096
v_cvt_pk_bf16_f32 v75, v42, v43
v_mfma_f32_16x16x32_bf16 v[24:27], a[8:11], a[200:203], v[24:27]
v_exp_f32 v45, v45
v_mfma_f32_16x16x32_bf16 v[24:27], a[12:15], a[204:207], v[24:27]
ds_read_b128 a[52:55], v1 offset:5120
v_cvt_pk_bf16_f32 v78, v44, v45
v_mfma_f32_16x16x32_bf16 v[28:31], a[0:3], a[208:211], v[92:95]
v_mfma_f32_16x16x32_bf16 v[28:31], a[4:7], a[212:215], v[28:31]
v_exp_f32 v46, v46
v_mfma_f32_16x16x32_bf16 v[28:31], a[8:11], a[216:219], v[28:31]
ds_read_b128 a[56:59], v1 offset:6144
v_mfma_f32_16x16x32_bf16 v[28:31], a[12:15], a[220:223], v[28:31]
s_waitcnt lgkmcnt(7)
v_exp_f32 v47, v47
v_mfma_f32_16x16x32_bf16 v[40:43], a[16:19], a[192:195], v[88:91]
buffer_load_dwordx4 v13, s[72:75], s12 offen offset:3072 lds
v_mfma_f32_16x16x32_bf16 v[40:43], a[20:23], a[196:199], v[40:43]
ds_read_b128 a[60:63], v1 offset:7168
v_cvt_pk_bf16_f32 v79, v46, v47
v_mfma_f32_16x16x32_bf16 v[40:43], a[24:27], a[200:203], v[40:43]
v_mfma_f32_16x16x32_bf16 v[40:43], a[28:31], a[204:207], v[40:43]
v_exp_f32 v24, v24
v_mfma_f32_16x16x32_bf16 v[44:47], a[16:19], a[208:211], v[92:95]
v_exp_f32 v25, v25
v_mfma_f32_16x16x32_bf16 v[44:47], a[20:23], a[212:215], v[44:47]
v_exp_f32 v26, v26
v_mfma_f32_16x16x32_bf16 v[44:47], a[24:27], a[216:219], v[44:47]
v_exp_f32 v27, v27
v_mfma_f32_16x16x32_bf16 v[44:47], a[28:31], a[220:223], v[44:47]
v_cvt_pk_bf16_f32 v56, v24, v25
v_cvt_pk_bf16_f32 v57, v26, v27
s_waitcnt lgkmcnt(0)
v_mfma_f32_16x16x32_bf16 v[192:195], a[32:35], v[72:75], v[192:195]
ds_read_b128 a[0:3], v1 offset:24576
v_exp_f32 v28, v28
v_mfma_f32_16x16x32_bf16 v[224:227], a[32:35], v[76:79], v[224:227]
ds_read_b128 a[4:7], v1 offset:25600
v_exp_f32 v29, v29
v_mfma_f32_16x16x32_bf16 v[228:231], a[36:39], v[76:79], v[228:231]
v_add_u32 v12, 0x20000, v12
v_exp_f32 v30, v30
v_mfma_f32_16x16x32_bf16 v[196:199], a[36:39], v[72:75], v[196:199]
ds_read_b128 a[8:11], v1 offset:26624
s_add_u32 m0, s17, 0x14000
v_mfma_f32_16x16x32_bf16 v[200:203], a[40:43], v[72:75], v[200:203]
buffer_load_dwordx4 v12, s[72:75], 0 offen lds
v_mfma_f32_16x16x32_bf16 v[232:235], a[40:43], v[76:79], v[232:235]
ds_read_b128 a[12:15], v1 offset:27648
v_exp_f32 v31, v31
v_mfma_f32_16x16x32_bf16 v[236:239], a[44:47], v[76:79], v[236:239]
v_exp_f32 v40, v40
v_mfma_f32_16x16x32_bf16 v[204:207], a[44:47], v[72:75], v[204:207]
ds_read_b128 a[16:19], v1 offset:28672
v_exp_f32 v41, v41
v_mfma_f32_16x16x32_bf16 v[208:211], a[48:51], v[72:75], v[208:211]
v_exp_f32 v42, v42
v_mfma_f32_16x16x32_bf16 v[240:243], a[48:51], v[76:79], v[240:243]
ds_read_b128 a[20:23], v1 offset:29696
v_exp_f32 v43, v43
v_mfma_f32_16x16x32_bf16 v[244:247], a[52:55], v[76:79], v[244:247]
ds_read_b128 a[24:27], v1 offset:30720
v_cvt_pk_bf16_f32 v60, v28, v29
v_mfma_f32_16x16x32_bf16 v[212:215], a[52:55], v[72:75], v[212:215]
v_add_u32 v13, 0x20000, v13
v_cvt_pk_bf16_f32 v61, v30, v31
v_mfma_f32_16x16x32_bf16 v[216:219], a[56:59], v[72:75], v[216:219]
buffer_load_dwordx4 v13, s[72:75], 0 offen offset:1024 lds
v_mfma_f32_16x16x32_bf16 v[248:251], a[56:59], v[76:79], v[248:251]
ds_read_b128 a[28:31], v1 offset:31744
v_cvt_pk_bf16_f32 v58, v40, v41
v_mfma_f32_16x16x32_bf16 v[252:255], a[60:63], v[76:79], v[252:255]
ds_read_b128 a[32:35], v1 offset:16384
v_cvt_pk_bf16_f32 v59, v42, v43
v_mfma_f32_16x16x32_bf16 v[220:223], a[60:63], v[72:75], v[220:223]
v_exp_f32 v44, v44
v_mfma_f32_16x16x32_bf16 a[232:235], a[240:243], v[72:75], a[232:235]
ds_read_b128 a[36:39], v1 offset:17408
v_mfma_f32_16x16x32_bf16 a[236:239], a[240:243], v[76:79], a[236:239]
s_waitcnt lgkmcnt(6)
v_exp_f32 v45, v45
v_mfma_f32_16x16x32_bf16 v[24:27], a[0:3], a[192:195], v[112:115]
ds_read_b128 a[40:43], v1 offset:18432
v_cvt_pk_bf16_f32 v62, v44, v45
v_mfma_f32_16x16x32_bf16 v[24:27], a[4:7], a[196:199], v[24:27]
ds_read_b128 a[44:47], v1 offset:19456
v_mfma_f32_16x16x32_bf16 v[24:27], a[8:11], a[200:203], v[24:27]
buffer_load_dwordx4 v12, s[72:75], s12 offen offset:2048 lds
v_mfma_f32_16x16x32_bf16 v[24:27], a[12:15], a[204:207], v[24:27]
ds_read_b128 a[48:51], v1 offset:20480
v_mfma_f32_16x16x32_bf16 v[28:31], a[0:3], a[208:211], v[92:95]
v_exp_f32 v46, v46
v_mfma_f32_16x16x32_bf16 v[28:31], a[4:7], a[212:215], v[28:31]
ds_read_b128 a[52:55], v1 offset:21504
v_mfma_f32_16x16x32_bf16 v[28:31], a[8:11], a[216:219], v[28:31]
v_exp_f32 v47, v47
v_mfma_f32_16x16x32_bf16 v[28:31], a[12:15], a[220:223], v[28:31]
ds_read_b128 a[56:59], v1 offset:22528
s_waitcnt lgkmcnt(7)
v_mfma_f32_16x16x32_bf16 v[40:43], a[16:19], a[192:195], v[116:119]
v_exp_f32 v24, v24
v_mfma_f32_16x16x32_bf16 v[40:43], a[20:23], a[196:199], v[40:43]
ds_read_b128 a[60:63], v1 offset:23552
v_cvt_pk_bf16_f32 v63, v46, v47
v_mfma_f32_16x16x32_bf16 v[40:43], a[24:27], a[200:203], v[40:43]
buffer_load_dwordx4 v13, s[72:75], s12 offen offset:3072 lds
v_mfma_f32_16x16x32_bf16 v[40:43], a[28:31], a[204:207], v[40:43]
v_xor_b32 v1, 0x8000, v1
v_mfma_f32_16x16x32_bf16 v[44:47], a[16:19], a[208:211], v[92:95]
v_exp_f32 v25, v25
v_mfma_f32_16x16x32_bf16 v[44:47], a[20:23], a[212:215], v[44:47]
v_exp_f32 v26, v26
v_mfma_f32_16x16x32_bf16 v[44:47], a[24:27], a[216:219], v[44:47]
v_exp_f32 v27, v27
v_mfma_f32_16x16x32_bf16 v[44:47], a[28:31], a[220:223], v[44:47]
v_cvt_pk_bf16_f32 v72, v24, v25
v_cvt_pk_bf16_f32 v73, v26, v27
s_nop 7
v_accvgpr_read_b32 v4, a224
v_accvgpr_read_b32 v6, a228
s_mov_b32 s8, 0x5f800000
v_cmp_nge_f32 s[36:37], s8, v4
v_cmp_nge_f32 s[38:39], s8, v6
v_rcp_f32 v4, v4
v_rcp_f32 v6, v6
s_or_b64 s[34:35], s[34:35], s[36:37]
s_or_b64 s[34:35], s[34:35], s[38:39]
v_pk_mul_f32 v[128:129], v[128:129], v[4:5] op_sel_hi:[1,0]
v_pk_mul_f32 v[130:131], v[130:131], v[4:5] op_sel_hi:[1,0]
v_pk_mul_f32 v[132:133], v[132:133], v[4:5] op_sel_hi:[1,0]
v_pk_mul_f32 v[134:135], v[134:135], v[4:5] op_sel_hi:[1,0]
v_cvt_pk_bf16_f32 v128, v128, v129
v_cvt_pk_bf16_f32 v129, v130, v131
v_cvt_pk_bf16_f32 v130, v132, v133
v_cvt_pk_bf16_f32 v131, v134, v135
s_add_u32 s8, s28, 0x0
buffer_store_dwordx4 v[128:131], v3, s[88:91], s8 offen sc1
v_pk_mul_f32 v[136:137], v[136:137], v[4:5] op_sel_hi:[1,0]
v_pk_mul_f32 v[138:139], v[138:139], v[4:5] op_sel_hi:[1,0]
v_pk_mul_f32 v[140:141], v[140:141], v[4:5] op_sel_hi:[1,0]
v_pk_mul_f32 v[142:143], v[142:143], v[4:5] op_sel_hi:[1,0]
v_cvt_pk_bf16_f32 v136, v136, v137
v_cvt_pk_bf16_f32 v137, v138, v139
v_cvt_pk_bf16_f32 v138, v140, v141
v_cvt_pk_bf16_f32 v139, v142, v143
s_add_u32 s8, s28, 0x2000
buffer_store_dwordx4 v[136:139], v3, s[88:91], s8 offen sc1
v_pk_mul_f32 v[144:145], v[144:145], v[4:5] op_sel_hi:[1,0]
v_pk_mul_f32 v[146:147], v[146:147], v[4:5] op_sel_hi:[1,0]
v_pk_mul_f32 v[148:149], v[148:149], v[4:5] op_sel_hi:[1,0]
v_pk_mul_f32 v[150:151], v[150:151], v[4:5] op_sel_hi:[1,0]
v_cvt_pk_bf16_f32 v144, v144, v145
v_cvt_pk_bf16_f32 v145, v146, v147
v_cvt_pk_bf16_f32 v146, v148, v149
v_cvt_pk_bf16_f32 v147, v150, v151
s_add_u32 s8, s28, 0x4000
buffer_store_dwordx4 v[144:147], v3, s[88:91], s8 offen sc1
v_pk_mul_f32 v[152:153], v[152:153], v[4:5] op_sel_hi:[1,0]
v_pk_mul_f32 v[154:155], v[154:155], v[4:5] op_sel_hi:[1,0]
v_pk_mul_f32 v[156:157], v[156:157], v[4:5] op_sel_hi:[1,0]
v_pk_mul_f32 v[158:159], v[158:159], v[4:5] op_sel_hi:[1,0]
v_cvt_pk_bf16_f32 v152, v152, v153
v_cvt_pk_bf16_f32 v153, v154, v155
v_cvt_pk_bf16_f32 v154, v156, v157
v_cvt_pk_bf16_f32 v155, v158, v159
s_add_u32 s8, s28, 0x6000
buffer_store_dwordx4 v[152:155], v3, s[88:91], s8 offen sc1
v_pk_mul_f32 v[160:161], v[160:161], v[6:7] op_sel_hi:[1,0]
v_pk_mul_f32 v[162:163], v[162:163], v[6:7] op_sel_hi:[1,0]
v_pk_mul_f32 v[164:165], v[164:165], v[6:7] op_sel_hi:[1,0]
v_pk_mul_f32 v[166:167], v[166:167], v[6:7] op_sel_hi:[1,0]
v_cvt_pk_bf16_f32 v160, v160, v161
v_cvt_pk_bf16_f32 v161, v162, v163
v_cvt_pk_bf16_f32 v162, v164, v165
v_cvt_pk_bf16_f32 v163, v166, v167
s_add_u32 s8, s29, 0x0
buffer_store_dwordx4 v[160:163], v3, s[88:91], s8 offen sc1
v_pk_mul_f32 v[168:169], v[168:169], v[6:7] op_sel_hi:[1,0]
v_pk_mul_f32 v[170:171], v[170:171], v[6:7] op_sel_hi:[1,0]
v_pk_mul_f32 v[172:173], v[172:173], v[6:7] op_sel_hi:[1,0]
v_pk_mul_f32 v[174:175], v[174:175], v[6:7] op_sel_hi:[1,0]
v_cvt_pk_bf16_f32 v168, v168, v169
v_cvt_pk_bf16_f32 v169, v170, v171
v_cvt_pk_bf16_f32 v170, v172, v173
v_cvt_pk_bf16_f32 v171, v174, v175
s_add_u32 s8, s29, 0x2000
buffer_store_dwordx4 v[168:171], v3, s[88:91], s8 offen sc1
v_pk_mul_f32 v[176:177], v[176:177], v[6:7] op_sel_hi:[1,0]
v_pk_mul_f32 v[178:179], v[178:179], v[6:7] op_sel_hi:[1,0]
v_pk_mul_f32 v[180:181], v[180:181], v[6:7] op_sel_hi:[1,0]
v_pk_mul_f32 v[182:183], v[182:183], v[6:7] op_sel_hi:[1,0]
v_cvt_pk_bf16_f32 v176, v176, v177
v_cvt_pk_bf16_f32 v177, v178, v179
v_cvt_pk_bf16_f32 v178, v180, v181
v_cvt_pk_bf16_f32 v179, v182, v183
s_add_u32 s8, s29, 0x4000
buffer_store_dwordx4 v[176:179], v3, s[88:91], s8 offen sc1
v_pk_mul_f32 v[184:185], v[184:185], v[6:7] op_sel_hi:[1,0]
v_pk_mul_f32 v[186:187], v[186:187], v[6:7] op_sel_hi:[1,0]
v_pk_mul_f32 v[188:189], v[188:189], v[6:7] op_sel_hi:[1,0]
v_pk_mul_f32 v[190:191], v[190:191], v[6:7] op_sel_hi:[1,0]
v_cvt_pk_bf16_f32 v184, v184, v185
v_cvt_pk_bf16_f32 v185, v186, v187
v_cvt_pk_bf16_f32 v186, v188, v189
v_cvt_pk_bf16_f32 v187, v190, v191
s_add_u32 s8, s29, 0x6000
buffer_store_dwordx4 v[184:187], v3, s[88:91], s8 offen sc1
s_branch L_att_h1_1
L_att_j0:
s_cmp_ge_u32 s4, 2
s_cbranch_scc1 L_att_nl0_1
L_att_nl0_0:
v_mfma_f32_16x16x32_bf16 v[16:19], a[0:3], a[160:163], v[96:99]
v_mfma_f32_16x16x32_bf16 v[16:19], a[4:7], a[164:167], v[16:19]
s_add_u32 m0, s27, 0x0
v_mfma_f32_16x16x32_bf16 v[16:19], a[8:11], a[168:171], v[16:19]
buffer_load_dwordx4 v3, s[48:51], s32 offen offset:0 sc1 lds
v_mfma_f32_16x16x32_bf16 v[16:19], a[12:15], a[172:175], v[16:19]
v_mfma_f32_16x16x32_bf16 v[20:23], a[0:3], a[176:179], v[84:87]
v_mfma_f32_16x16x32_bf16 v[20:23], a[4:7], a[180:183], v[20:23]
v_mfma_f32_16x16x32_bf16 v[20:23], a[8:11], a[184:187], v[20:23]
s_mov_b32 s9, 0x0
v_mfma_f32_16x16x32_bf16 v[20:23], a[12:15], a[188:191], v[20:23]
buffer_load_dword v9, v8, s[72:75], s9 offen
v_mfma_f32_16x16x32_bf16 v[24:27], a[0:3], a[192:195], v[88:91]
s_nop 0
v_exp_f32 v16, v16
v_mfma_f32_16x16x32_bf16 v[24:27], a[4:7], a[196:199], v[24:27]
v_exp_f32 v17, v17
v_mfma_f32_16x16x32_bf16 v[24:27], a[8:11], a[200:203], v[24:27]
v_exp_f32 v18, v18
v_mfma_f32_16x16x32_bf16 v[24:27], a[12:15], a[204:207], v[24:27]
v_exp_f32 v19, v19
v_mfma_f32_16x16x32_bf16 v[28:31], a[0:3], a[208:211], v[92:95]
buffer_load_dwordx4 v3, s[48:51], s32 offen offset:1024 sc1 lds
v_mfma_f32_16x16x32_bf16 v[28:31], a[4:7], a[212:215], v[28:31]
v_exp_f32 v20, v20
v_mfma_f32_16x16x32_bf16 v[28:31], a[8:11], a[216:219], v[28:31]
v_exp_f32 v21, v21
v_mfma_f32_16x16x32_bf16 v[28:31], a[12:15], a[220:223], v[28:31]
v_cvt_pk_bf16_f32 v48, v16, v17
v_cvt_pk_bf16_f32 v49, v18, v19
v_mfma_f32_16x16x32_bf16 v[32:35], a[16:19], a[160:163], v[100:103]
v_exp_f32 v22, v22
v_mfma_f32_16x16x32_bf16 v[32:35], a[20:23], a[164:167], v[32:35]
buffer_load_dwordx4 v3, s[48:51], s32 offen offset:2048 sc1 lds
v_mfma_f32_16x16x32_bf16 v[32:35], a[24:27], a[168:171], v[32:35]
v_cvt_pk_bf16_f32 v52, v20, v21
v_mfma_f32_16x16x32_bf16 v[32:35], a[28:31], a[172:175], v[32:35]
v_mfma_f32_16x16x32_bf16 v[36:39], a[16:19], a[176:179], v[84:87]
v_exp_f32 v23, v23
v_mfma_f32_16x16x32_bf16 v[36:39], a[20:23], a[180:183], v[36:39]
v_cvt_pk_bf16_f32 v53, v22, v23
v_mfma_f32_16x16x32_bf16 v[36:39], a[24:27], a[184:187], v[36:39]
buffer_load_dwordx4 v3, s[48:51], s32 offen offset:3072 sc1 lds
v_mfma_f32_16x16x32_bf16 v[36:39], a[28:31], a[188:191], v[36:39]
v_exp_f32 v24, v24
v_mfma_f32_16x16x32_bf16 v[40:43], a[16:19], a[192:195], v[88:91]
v_mfma_f32_16x16x32_bf16 v[40:43], a[20:23], a[196:199], v[40:43]
v_exp_f32 v25, v25
v_mfma_f32_16x16x32_bf16 v[40:43], a[24:27], a[200:203], v[40:43]
s_mov_b32 s9, 0x0
v_cvt_pk_bf16_f32 v56, v24, v25
v_mfma_f32_16x16x32_bf16 v[40:43], a[28:31], a[204:207], v[40:43]
buffer_load_dword v9, v8, s[64:67], s9 offen
v_mfma_f32_16x16x32_bf16 v[44:47], a[16:19], a[208:211], v[92:95]
v_exp_f32 v26, v26
v_mfma_f32_16x16x32_bf16 v[44:47], a[20:23], a[212:215], v[44:47]
v_mfma_f32_16x16x32_bf16 v[44:47], a[24:27], a[216:219], v[44:47]
v_exp_f32 v27, v27
v_mfma_f32_16x16x32_bf16 v[44:47], a[28:31], a[220:223], v[44:47]
v_cvt_pk_bf16_f32 v57, v26, v27
s_waitcnt lgkmcnt(0)
ds_read_b128 a[0:3], v1 offset:24576
ds_read_b128 a[4:7], v1 offset:25600
ds_read_b128 a[8:11], v1 offset:26624
ds_read_b128 a[12:15], v1 offset:27648
ds_read_b128 a[16:19], v1 offset:28672
ds_read_b128 a[20:23], v1 offset:29696
ds_read_b128 a[24:27], v1 offset:30720
ds_read_b128 a[28:31], v1 offset:31744
s_waitcnt lgkmcnt(7)
v_mfma_f32_16x16x32_bf16 v[20:23], a[0:3], a[176:179], v[84:87]
ds_read_b128 a[32:35], v1 offset:16384
v_exp_f32 v28, v28
s_waitcnt lgkmcnt(7)
v_mfma_f32_16x16x32_bf16 v[20:23], a[4:7], a[180:183], v[20:23]
s_add_u32 m0, s27, 0x1000
v_exp_f32 v29, v29
s_waitcnt lgkmcnt(6)
v_mfma_f32_16x16x32_bf16 v[20:23], a[8:11], a[184:187], v[20:23]
buffer_load_dwordx4 v3, s[48:51], s7 offen offset:0 sc1 lds
s_waitcnt lgkmcnt(5)
v_mfma_f32_16x16x32_bf16 v[20:23], a[12:15], a[188:191], v[20:23]
ds_read_b128 a[36:39], v1 offset:17408
v_exp_f32 v30, v30
v_mfma_f32_16x16x32_bf16 v[24:27], a[0:3], a[192:195], v[88:91]
ds_read_b128 a[40:43], v1 offset:18432
v_exp_f32 v31, v31
v_mfma_f32_16x16x32_bf16 v[24:27], a[4:7], a[196:199], v[24:27]
v_exp_f32 v32, v32
v_mfma_f32_16x16x32_bf16 v[24:27], a[8:11], a[200:203], v[24:27]
buffer_load_dwordx4 v3, s[48:51], s7 offen offset:1024 sc1 lds
v_mfma_f32_16x16x32_bf16 v[24:27], a[12:15], a[204:207], v[24:27]
ds_read_b128 a[44:47], v1 offset:19456
v_exp_f32 v33, v33
v_cvt_pk_bf16_f32 v60, v28, v29
v_cvt_pk_bf16_f32 v61, v30, v31
v_mfma_f32_16x16x32_bf16 v[28:31], a[0:3], a[208:211], v[92:95]
v_exp_f32 v34, v34
v_mfma_f32_16x16x32_bf16 v[28:31], a[4:7], a[212:215], v[28:31]
ds_read_b128 a[48:51], v1 offset:20480
v_exp_f32 v35, v35
v_mfma_f32_16x16x32_bf16 v[28:31], a[8:11], a[216:219], v[28:31]
v_exp_f32 v36, v36
v_mfma_f32_16x16x32_bf16 v[28:31], a[12:15], a[220:223], v[28:31]
buffer_load_dwordx4 v3, s[48:51], s7 offen offset:2048 sc1 lds
v_exp_f32 v37, v37
v_exp_f32 v38, v38
v_exp_f32 v39, v39
v_cvt_pk_bf16_f32 v54, v36, v37
v_cvt_pk_bf16_f32 v55, v38, v39
s_waitcnt lgkmcnt(8)
v_mfma_f32_16x16x32_bf16 v[36:39], a[16:19], a[176:179], v[84:87]
ds_read_b128 a[52:55], v1 offset:21504
v_exp_f32 v40, v40
s_waitcnt lgkmcnt(8)
v_mfma_f32_16x16x32_bf16 v[36:39], a[20:23], a[180:183], v[36:39]
v_exp_f32 v41, v41
s_waitcnt lgkmcnt(7)
v_mfma_f32_16x16x32_bf16 v[36:39], a[24:27], a[184:187], v[36:39]
ds_read_b128 a[56:59], v1 offset:22528
s_mov_b32 s9, 0x400000
s_waitcnt lgkmcnt(7)
v_mfma_f32_16x16x32_bf16 v[36:39], a[28:31], a[188:191], v[36:39]
buffer_load_dword v9, v8, s[64:67], s9 offen
v_exp_f32 v42, v42
v_exp_f32 v43, v43
v_cvt_pk_bf16_f32 v58, v40, v41
v_cvt_pk_bf16_f32 v59, v42, v43
v_mfma_f32_16x16x32_bf16 v[40:43], a[16:19], a[192:195], v[88:91]
ds_read_b128 a[60:63], v1 offset:23552
v_exp_f32 v44, v44
v_mfma_f32_16x16x32_bf16 v[40:43], a[20:23], a[196:199], v[40:43]
v_exp_f32 v45, v45
v_mfma_f32_16x16x32_bf16 v[40:43], a[24:27], a[200:203], v[40:43]
v_exp_f32 v46, v46
v_mfma_f32_16x16x32_bf16 v[40:43], a[28:31], a[204:207], v[40:43]
buffer_load_dwordx4 v3, s[48:51], s7 offen offset:3072 sc1 lds
v_exp_f32 v47, v47
v_cvt_pk_bf16_f32 v62, v44, v45
v_cvt_pk_bf16_f32 v63, v46, v47
v_mfma_f32_16x16x32_bf16 v[44:47], a[16:19], a[208:211], v[92:95]
s_add_u32 s32, s32, 0x8000
s_add_u32 s7, s7, 0x8000
s_xor_b32 s27, s27, 0x38000
v_mfma_f32_16x16x32_bf16 v[44:47], a[20:23], a[212:215], v[44:47]
v_xor_b32 v1, 0x8000, v1
v_exp_f32 v20, v20
v_mfma_f32_16x16x32_bf16 v[44:47], a[24:27], a[216:219], v[44:47]
v_exp_f32 v21, v21
v_mfma_f32_16x16x32_bf16 v[44:47], a[28:31], a[220:223], v[44:47]
v_exp_f32 v22, v22
v_exp_f32 v23, v23
v_exp_f32 v24, v24
v_exp_f32 v25, v25
v_exp_f32 v26, v26
v_exp_f32 v27, v27
v_cvt_pk_bf16_f32 v50, v32, v33
v_cvt_pk_bf16_f32 v51, v34, v35
v_cvt_pk_bf16_f32 v68, v20, v21
v_cvt_pk_bf16_f32 v69, v22, v23
v_cvt_pk_bf16_f32 v72, v24, v25
v_cvt_pk_bf16_f32 v73, v26, v27
s_branch L_att_l1_0
L_att_nl0_1:
v_mfma_f32_16x16x32_bf16 v[16:19], a[0:3], a[160:163], v[80:83]
v_mfma_f32_16x16x32_bf16 v[16:19], a[4:7], a[164:167], v[16:19]
s_add_u32 m0, s27, 0x0
v_mfma_f32_16x16x32_bf16 v[16:19], a[8:11], a[168:171], v[16:19]
buffer_load_dwordx4 v3, s[48:51], s32 offen offset:0 sc1 lds
v_mfma_f32_16x16x32_bf16 v[16:19], a[12:15], a[172:175], v[16:19]
v_mfma_f32_16x16x32_bf16 v[20:23], a[0:3], a[176:179], v[84:87]
v_mfma_f32_16x16x32_bf16 v[20:23], a[4:7], a[180:183], v[20:23]
v_mfma_f32_16x16x32_bf16 v[20:23], a[8:11], a[184:187], v[20:23]
s_mov_b32 s9, 0x0
v_mfma_f32_16x16x32_bf16 v[20:23], a[12:15], a[188:191], v[20:23]
buffer_load_dword v9, v8, s[72:75], s9 offen
v_mfma_f32_16x16x32_bf16 v[24:27], a[0:3], a[192:195], v[88:91]
s_nop 0
v_exp_f32 v16, v16
v_mfma_f32_16x16x32_bf16 v[24:27], a[4:7], a[196:199], v[24:27]
v_exp_f32 v17, v17
v_mfma_f32_16x16x32_bf16 v[24:27], a[8:11], a[200:203], v[24:27]
v_exp_f32 v18, v18
v_mfma_f32_16x16x32_bf16 v[24:27], a[12:15], a[204:207], v[24:27]
v_exp_f32 v19, v19
v_mfma_f32_16x16x32_bf16 v[28:31], a[0:3], a[208:211], v[92:95]
buffer_load_dwordx4 v3, s[48:51], s32 offen offset:1024 sc1 lds
v_mfma_f32_16x16x32_bf16 v[28:31], a[4:7], a[212:215], v[28:31]
v_exp_f32 v20, v20
v_mfma_f32_16x16x32_bf16 v[28:31], a[8:11], a[216:219], v[28:31]
v_exp_f32 v21, v21
v_mfma_f32_16x16x32_bf16 v[28:31], a[12:15], a[220:223], v[28:31]
v_cvt_pk_bf16_f32 v48, v16, v17
v_cvt_pk_bf16_f32 v49, v18, v19
v_mfma_f32_16x16x32_bf16 v[32:35], a[16:19], a[160:163], v[80:83]
v_exp_f32 v22, v22
v_mfma_f32_16x16x32_bf16 v[32:35], a[20:23], a[164:167], v[32:35]
buffer_load_dwordx4 v3, s[48:51], s32 offen offset:2048 sc1 lds
v_mfma_f32_16x16x32_bf16 v[32:35], a[24:27], a[168:171], v[32:35]
v_cvt_pk_bf16_f32 v52, v20, v21
v_mfma_f32_16x16x32_bf16 v[32:35], a[28:31], a[172:175], v[32:35]
v_mfma_f32_16x16x32_bf16 v[36:39], a[16:19], a[176:179], v[84:87]
v_exp_f32 v23, v23
v_mfma_f32_16x16x32_bf16 v[36:39], a[20:23], a[180:183], v[36:39]
v_cvt_pk_bf16_f32 v53, v22, v23
v_mfma_f32_16x16x32_bf16 v[36:39], a[24:27], a[184:187], v[36:39]
buffer_load_dwordx4 v3, s[48:51], s32 offen offset:3072 sc1 lds
v_mfma_f32_16x16x32_bf16 v[36:39], a[28:31], a[188:191], v[36:39]
v_exp_f32 v24, v24
v_mfma_f32_16x16x32_bf16 v[40:43], a[16:19], a[192:195], v[88:91]
v_mfma_f32_16x16x32_bf16 v[40:43], a[20:23], a[196:199], v[40:43]
v_exp_f32 v25, v25
v_mfma_f32_16x16x32_bf16 v[40:43], a[24:27], a[200:203], v[40:43]
s_mov_b32 s9, 0x0
v_cvt_pk_bf16_f32 v56, v24, v25
v_mfma_f32_16x16x32_bf16 v[40:43], a[28:31], a[204:207], v[40:43]
buffer_load_dword v9, v8, s[64:67], s9 offen
v_mfma_f32_16x16x32_bf16 v[44:47], a[16:19], a[208:211], v[92:95]
v_exp_f32 v26, v26
v_mfma_f32_16x16x32_bf16 v[44:47], a[20:23], a[212:215], v[44:47]
v_mfma_f32_16x16x32_bf16 v[44:47], a[24:27], a[216:219], v[44:47]
v_exp_f32 v27, v27
v_mfma_f32_16x16x32_bf16 v[44:47], a[28:31], a[220:223], v[44:47]
v_cvt_pk_bf16_f32 v57, v26, v27
s_waitcnt lgkmcnt(0)
ds_read_b128 a[0:3], v1 offset:24576
ds_read_b128 a[4:7], v1 offset:25600
ds_read_b128 a[8:11], v1 offset:26624
ds_read_b128 a[12:15], v1 offset:27648
ds_read_b128 a[16:19], v1 offset:28672
ds_read_b128 a[20:23], v1 offset:29696
ds_read_b128 a[24:27], v1 offset:30720
ds_read_b128 a[28:31], v1 offset:31744
s_waitcnt lgkmcnt(7)
v_mfma_f32_16x16x32_bf16 v[16:19], a[0:3], a[160:163], v[96:99]
ds_read_b128 a[32:35], v1 offset:16384
v_exp_f32 v28, v28
s_waitcnt lgkmcnt(7)
v_mfma_f32_16x16x32_bf16 v[16:19], a[4:7], a[164:167], v[16:19]
v_exp_f32 v29, v29
s_waitcnt lgkmcnt(6)
v_mfma_f32_16x16x32_bf16 v[16:19], a[8:11], a[168:171], v[16:19]
s_add_u32 m0, s27, 0x1000
v_exp_f32 v30, v30
s_waitcnt lgkmcnt(5)
v_mfma_f32_16x16x32_bf16 v[16:19], a[12:15], a[172:175], v[16:19]
buffer_load_dwordx4 v3, s[48:51], s7 offen offset:0 sc1 lds
v_mfma_f32_16x16x32_bf16 v[20:23], a[0:3], a[176:179], v[84:87]
ds_read_b128 a[36:39], v1 offset:17408
v_exp_f32 v31, v31
v_mfma_f32_16x16x32_bf16 v[20:23], a[4:7], a[180:183], v[20:23]
v_exp_f32 v32, v32
v_mfma_f32_16x16x32_bf16 v[20:23], a[8:11], a[184:187], v[20:23]
ds_read_b128 a[40:43], v1 offset:18432
v_exp_f32 v33, v33
v_mfma_f32_16x16x32_bf16 v[20:23], a[12:15], a[188:191], v[20:23]
v_exp_f32 v34, v34
v_mfma_f32_16x16x32_bf16 v[24:27], a[0:3], a[192:195], v[88:91]
v_exp_f32 v35, v35
v_mfma_f32_16x16x32_bf16 v[24:27], a[4:7], a[196:199], v[24:27]
buffer_load_dwordx4 v3, s[48:51], s7 offen offset:1024 sc1 lds
v_mfma_f32_16x16x32_bf16 v[24:27], a[8:11], a[200:203], v[24:27]
ds_read_b128 a[44:47], v1 offset:19456
v_exp_f32 v36, v36
v_mfma_f32_16x16x32_bf16 v[24:27], a[12:15], a[204:207], v[24:27]
v_exp_f32 v37, v37
v_cvt_pk_bf16_f32 v60, v28, v29
v_cvt_pk_bf16_f32 v61, v30, v31
v_mfma_f32_16x16x32_bf16 v[28:31], a[0:3], a[208:211], v[92:95]
v_exp_f32 v38, v38
v_mfma_f32_16x16x32_bf16 v[28:31], a[4:7], a[212:215], v[28:31]
ds_read_b128 a[48:51], v1 offset:20480
v_exp_f32 v39, v39
v_mfma_f32_16x16x32_bf16 v[28:31], a[8:11], a[216:219], v[28:31]
v_exp_f32 v40, v40
v_mfma_f32_16x16x32_bf16 v[28:31], a[12:15], a[220:223], v[28:31]
buffer_load_dwordx4 v3, s[48:51], s7 offen offset:2048 sc1 lds
v_cvt_pk_bf16_f32 v50, v32, v33
v_cvt_pk_bf16_f32 v51, v34, v35
s_waitcnt lgkmcnt(8)
v_mfma_f32_16x16x32_bf16 v[32:35], a[16:19], a[160:163], v[100:103]
ds_read_b128 a[52:55], v1 offset:21504
v_exp_f32 v41, v41
s_waitcnt lgkmcnt(8)
v_mfma_f32_16x16x32_bf16 v[32:35], a[20:23], a[164:167], v[32:35]
v_exp_f32 v42, v42
s_waitcnt lgkmcnt(7)
v_mfma_f32_16x16x32_bf16 v[32:35], a[24:27], a[168:171], v[32:35]
v_exp_f32 v43, v43
s_waitcnt lgkmcnt(6)
v_mfma_f32_16x16x32_bf16 v[32:35], a[28:31], a[172:175], v[32:35]
v_exp_f32 v44, v44
v_cvt_pk_bf16_f32 v54, v36, v37
v_cvt_pk_bf16_f32 v55, v38, v39
v_mfma_f32_16x16x32_bf16 v[36:39], a[16:19], a[176:179], v[84:87]
ds_read_b128 a[56:59], v1 offset:22528
s_mov_b32 s9, 0x400000
v_mfma_f32_16x16x32_bf16 v[36:39], a[20:23], a[180:183], v[36:39]
buffer_load_dword v9, v8, s[64:67], s9 offen
v_mfma_f32_16x16x32_bf16 v[36:39], a[24:27], a[184:187], v[36:39]
v_exp_f32 v45, v45
v_mfma_f32_16x16x32_bf16 v[36:39], a[28:31], a[188:191], v[36:39]
ds_read_b128 a[60:63], v1 offset:23552
v_exp_f32 v46, v46
v_cvt_pk_bf16_f32 v58, v40, v41
v_cvt_pk_bf16_f32 v59, v42, v43
v_mfma_f32_16x16x32_bf16 v[40:43], a[16:19], a[192:195], v[88:91]
v_exp_f32 v47, v47
v_mfma_f32_16x16x32_bf16 v[40:43], a[20:23], a[196:199], v[40:43]
v_exp_f32 v16, v16
v_mfma_f32_16x16x32_bf16 v[40:43], a[24:27], a[200:203], v[40:43]
v_exp_f32 v17, v17
v_mfma_f32_16x16x32_bf16 v[40:43], a[28:31], a[204:207], v[40:43]
buffer_load_dwordx4 v3, s[48:51], s7 offen offset:3072 sc1 lds
v_cvt_pk_bf16_f32 v62, v44, v45
v_cvt_pk_bf16_f32 v63, v46, v47
v_mfma_f32_16x16x32_bf16 v[44:47], a[16:19], a[208:211], v[92:95]
s_add_u32 s32, s32, 0x8000
s_add_u32 s7, s7, 0x8000
s_xor_b32 s27, s27, 0x38000
v_mfma_f32_16x16x32_bf16 v[44:47], a[20:23], a[212:215], v[44:47]
v_xor_b32 v1, 0x8000, v1
v_exp_f32 v18, v18
v_mfma_f32_16x16x32_bf16 v[44:47], a[24:27], a[216:219], v[44:47]
v_exp_f32 v19, v19
v_mfma_f32_16x16x32_bf16 v[44:47], a[28:31], a[220:223], v[44:47]
v_exp_f32 v20, v20
v_exp_f32 v21, v21
v_exp_f32 v22, v22
v_exp_f32 v23, v23
v_exp_f32 v24, v24
v_exp_f32 v25, v25
v_exp_f32 v26, v26
v_exp_f32 v27, v27
v_cvt_pk_bf16_f32 v64, v16, v17
v_cvt_pk_bf16_f32 v65, v18, v19
v_cvt_pk_bf16_f32 v68, v20, v21
v_cvt_pk_bf16_f32 v69, v22, v23
v_cvt_pk_bf16_f32 v72, v24, v25
v_cvt_pk_bf16_f32 v73, v26, v27
s_branch L_att_l1_1
L_att_seven:
s_waitcnt vmcnt(16) lgkmcnt(0)
s_barrier
v_mfma_f32_16x16x32_bf16 v[192:195], a[32:35], v[56:59], v[192:195]
ds_read_b128 a[0:3], v1 offset:8192
v_exp_f32 v28, v28
v_mfma_f32_16x16x32_bf16 v[224:227], a[32:35], v[60:63], v[224:227]
ds_read_b128 a[4:7], v1 offset:9216
v_exp_f32 v29, v29
v_mfma_f32_16x16x32_bf16 v[228:231], a[36:39], v[60:63], v[228:231]
v_exp_f32 v30, v30
v_mfma_f32_16x16x32_bf16 v[196:199], a[36:39], v[56:59], v[196:199]
ds_read_b128 a[8:11], v1 offset:10240
s_add_u32 m0, s27, 0x0
v_mfma_f32_16x16x32_bf16 v[200:203], a[40:43], v[56:59], v[200:203]
buffer_load_dwordx4 v3, s[48:51], s32 offen offset:0 sc1 lds
v_mfma_f32_16x16x32_bf16 v[232:235], a[40:43], v[60:63], v[232:235]
ds_read_b128 a[12:15], v1 offset:11264
v_exp_f32 v31, v31
v_mfma_f32_16x16x32_bf16 v[236:239], a[44:47], v[60:63], v[236:239]
v_exp_f32 v40, v40
v_mfma_f32_16x16x32_bf16 v[204:207], a[44:47], v[56:59], v[204:207]
ds_read_b128 a[16:19], v1 offset:12288
v_cvt_pk_bf16_f32 v76, v28, v29
v_mfma_f32_16x16x32_bf16 v[208:211], a[48:51], v[56:59], v[208:211]
v_exp_f32 v41, v41
v_mfma_f32_16x16x32_bf16 v[240:243], a[48:51], v[60:63], v[240:243]
ds_read_b128 a[20:23], v1 offset:13312
v_cvt_pk_bf16_f32 v77, v30, v31
v_mfma_f32_16x16x32_bf16 v[244:247], a[52:55], v[60:63], v[244:247]
ds_read_b128 a[24:27], v1 offset:14336
v_cvt_pk_bf16_f32 v74, v40, v41
v_mfma_f32_16x16x32_bf16 v[212:215], a[52:55], v[56:59], v[212:215]
v_exp_f32 v42, v42
v_mfma_f32_16x16x32_bf16 v[216:219], a[56:59], v[56:59], v[216:219]
buffer_load_dwordx4 v3, s[48:51], s32 offen offset:1024 sc1 lds
v_mfma_f32_16x16x32_bf16 v[248:251], a[56:59], v[60:63], v[248:251]
ds_read_b128 a[28:31], v1 offset:15360
v_mfma_f32_16x16x32_bf16 v[252:255], a[60:63], v[60:63], v[252:255]
ds_read_b128 a[32:35], v1 offset:0
v_mfma_f32_16x16x32_bf16 v[220:223], a[60:63], v[56:59], v[220:223]
v_exp_f32 v43, v43
v_mfma_f32_16x16x32_bf16 a[232:235], a[240:243], v[56:59], a[232:235]
ds_read_b128 a[36:39], v1 offset:1024
v_cvt_pk_bf16_f32 v75, v42, v43
v_mfma_f32_16x16x32_bf16 a[236:239], a[240:243], v[60:63], a[236:239]
s_waitcnt lgkmcnt(6)
v_exp_f32 v44, v44
v_mfma_f32_16x16x32_bf16 v[24:27], a[0:3], a[192:195], v[88:91]
ds_read_b128 a[40:43], v1 offset:2048
v_mfma_f32_16x16x32_bf16 v[24:27], a[4:7], a[196:199], v[24:27]
ds_read_b128 a[44:47], v1 offset:3072
v_mfma_f32_16x16x32_bf16 v[24:27], a[8:11], a[200:203], v[24:27]
buffer_load_dwordx4 v3, s[48:51], s32 offen offset:2048 sc1 lds
v_mfma_f32_16x16x32_bf16 v[24:27], a[12:15], a[204:207], v[24:27]
ds_read_b128 a[48:51], v1 offset:4096
v_mfma_f32_16x16x32_bf16 v[28:31], a[0:3], a[208:211], v[92:95]
v_exp_f32 v45, v45
v_mfma_f32_16x16x32_bf16 v[28:31], a[4:7], a[212:215], v[28:31]
ds_read_b128 a[52:55], v1 offset:5120
v_cvt_pk_bf16_f32 v78, v44, v45
v_mfma_f32_16x16x32_bf16 v[28:31], a[8:11], a[216:219], v[28:31]
v_exp_f32 v46, v46
v_mfma_f32_16x16x32_bf16 v[28:31], a[12:15], a[220:223], v[28:31]
ds_read_b128 a[56:59], v1 offset:6144
s_waitcnt lgkmcnt(7)
v_mfma_f32_16x16x32_bf16 v[40:43], a[16:19], a[192:195], v[88:91]
v_exp_f32 v47, v47
v_mfma_f32_16x16x32_bf16 v[40:43], a[20:23], a[196:199], v[40:43]
ds_read_b128 a[60:63], v1 offset:7168
v_cvt_pk_bf16_f32 v79, v46, v47
v_mfma_f32_16x16x32_bf16 v[40:43], a[24:27], a[200:203], v[40:43]
buffer_load_dwordx4 v3, s[48:51], s32 offen offset:3072 sc1 lds
v_mfma_f32_16x16x32_bf16 v[40:43], a[28:31], a[204:207], v[40:43]
v_exp_f32 v24, v24
v_mfma_f32_16x16x32_bf16 v[44:47], a[16:19], a[208:211], v[92:95]
v_exp_f32 v25, v25
v_mfma_f32_16x16x32_bf16 v[44:47], a[20:23], a[212:215], v[44:47]
v_exp_f32 v26, v26
v_mfma_f32_16x16x32_bf16 v[44:47], a[24:27], a[216:219], v[44:47]
v_exp_f32 v27, v27
v_mfma_f32_16x16x32_bf16 v[44:47], a[28:31], a[220:223], v[44:47]
v_cvt_pk_bf16_f32 v56, v24, v25
v_cvt_pk_bf16_f32 v57, v26, v27
s_waitcnt lgkmcnt(0)
v_mfma_f32_16x16x32_bf16 v[192:195], a[32:35], v[72:75], v[192:195]
ds_read_b128 a[0:3], v1 offset:24576
v_exp_f32 v28, v28
v_mfma_f32_16x16x32_bf16 v[224:227], a[32:35], v[76:79], v[224:227]
ds_read_b128 a[4:7], v1 offset:25600
v_exp_f32 v29, v29
v_mfma_f32_16x16x32_bf16 v[228:231], a[36:39], v[76:79], v[228:231]
v_exp_f32 v30, v30
v_mfma_f32_16x16x32_bf16 v[196:199], a[36:39], v[72:75], v[196:199]
ds_read_b128 a[8:11], v1 offset:26624
s_add_u32 m0, s27, 0x1000
v_mfma_f32_16x16x32_bf16 v[200:203], a[40:43], v[72:75], v[200:203]
buffer_load_dwordx4 v3, s[48:51], s7 offen offset:0 sc1 lds
v_mfma_f32_16x16x32_bf16 v[232:235], a[40:43], v[76:79], v[232:235]
ds_read_b128 a[12:15], v1 offset:27648
v_exp_f32 v31, v31
v_mfma_f32_16x16x32_bf16 v[236:239], a[44:47], v[76:79], v[236:239]
v_exp_f32 v40, v40
v_mfma_f32_16x16x32_bf16 v[204:207], a[44:47], v[72:75], v[204:207]
ds_read_b128 a[16:19], v1 offset:28672
v_exp_f32 v41, v41
v_mfma_f32_16x16x32_bf16 v[208:211], a[48:51], v[72:75], v[208:211]
v_exp_f32 v42, v42
v_mfma_f32_16x16x32_bf16 v[240:243], a[48:51], v[76:79], v[240:243]
ds_read_b128 a[20:23], v1 offset:29696
v_exp_f32 v43, v43
v_mfma_f32_16x16x32_bf16 v[244:247], a[52:55], v[76:79], v[244:247]
ds_read_b128 a[24:27], v1 offset:30720
v_cvt_pk_bf16_f32 v60, v28, v29
v_mfma_f32_16x16x32_bf16 v[212:215], a[52:55], v[72:75], v[212:215]
v_exp_f32 v44, v44
v_mfma_f32_16x16x32_bf16 v[216:219], a[56:59], v[72:75], v[216:219]
buffer_load_dwordx4 v3, s[48:51], s7 offen offset:1024 sc1 lds
v_mfma_f32_16x16x32_bf16 v[248:251], a[56:59], v[76:79], v[248:251]
ds_read_b128 a[28:31], v1 offset:31744
v_cvt_pk_bf16_f32 v61, v30, v31
v_mfma_f32_16x16x32_bf16 v[252:255], a[60:63], v[76:79], v[252:255]
ds_read_b128 a[32:35], v1 offset:16384
v_cvt_pk_bf16_f32 v58, v40, v41
v_mfma_f32_16x16x32_bf16 v[220:223], a[60:63], v[72:75], v[220:223]
v_exp_f32 v45, v45
v_mfma_f32_16x16x32_bf16 a[232:235], a[240:243], v[72:75], a[232:235]
ds_read_b128 a[36:39], v1 offset:17408
v_cvt_pk_bf16_f32 v59, v42, v43
v_mfma_f32_16x16x32_bf16 a[236:239], a[240:243], v[76:79], a[236:239]
s_waitcnt lgkmcnt(6)
v_exp_f32 v46, v46
v_mfma_f32_16x16x32_bf16 v[24:27], a[0:3], a[192:195], v[88:91]
ds_read_b128 a[40:43], v1 offset:18432
v_cvt_pk_bf16_f32 v62, v44, v45
v_mfma_f32_16x16x32_bf16 v[24:27], a[4:7], a[196:199], v[24:27]
ds_read_b128 a[44:47], v1 offset:19456
v_mfma_f32_16x16x32_bf16 v[24:27], a[8:11], a[200:203], v[24:27]
buffer_load_dwordx4 v3, s[48:51], s7 offen offset:2048 sc1 lds
v_mfma_f32_16x16x32_bf16 v[24:27], a[12:15], a[204:207], v[24:27]
ds_read_b128 a[48:51], v1 offset:20480
v_mfma_f32_16x16x32_bf16 v[28:31], a[0:3], a[208:211], v[92:95]
v_exp_f32 v47, v47
v_mfma_f32_16x16x32_bf16 v[28:31], a[4:7], a[212:215], v[28:31]
ds_read_b128 a[52:55], v1 offset:21504
v_cvt_pk_bf16_f32 v63, v46, v47
v_mfma_f32_16x16x32_bf16 v[28:31], a[8:11], a[216:219], v[28:31]
v_mfma_f32_16x16x32_bf16 v[28:31], a[12:15], a[220:223], v[28:31]
ds_read_b128 a[56:59], v1 offset:22528
s_waitcnt lgkmcnt(7)
v_mfma_f32_16x16x32_bf16 v[40:43], a[16:19], a[192:195], v[88:91]
v_exp_f32 v24, v24
v_mfma_f32_16x16x32_bf16 v[40:43], a[20:23], a[196:199], v[40:43]
ds_read_b128 a[60:63], v1 offset:23552
v_exp_f32 v25, v25
v_mfma_f32_16x16x32_bf16 v[40:43], a[24:27], a[200:203], v[40:43]
buffer_load_dwordx4 v3, s[48:51], s7 offen offset:3072 sc1 lds
v_mfma_f32_16x16x32_bf16 v[40:43], a[28:31], a[204:207], v[40:43]
s_add_u32 s32, s32, 0x8000
s_add_u32 s7, s7, 0x8000
s_xor_b32 s27, s27, 0x38000
v_mfma_f32_16x16x32_bf16 v[44:47], a[16:19], a[208:211], v[92:95]
v_xor_b32 v1, 0x8000, v1
v_cvt_pk_bf16_f32 v72, v24, v25
v_mfma_f32_16x16x32_bf16 v[44:47], a[20:23], a[212:215], v[44:47]
v_exp_f32 v26, v26
v_mfma_f32_16x16x32_bf16 v[44:47], a[24:27], a[216:219], v[44:47]
v_exp_f32 v27, v27
v_mfma_f32_16x16x32_bf16 v[44:47], a[28:31], a[220:223], v[44:47]
v_cvt_pk_bf16_f32 v73, v26, v27
L_att_sodd:
s_waitcnt vmcnt(16) lgkmcnt(0)
s_barrier
v_mfma_f32_16x16x32_bf16 v[192:195], a[32:35], v[56:59], v[192:195]
ds_read_b128 a[0:3], v2 offset:8192
v_exp_f32 v28, v28
v_mfma_f32_16x16x32_bf16 v[224:227], a[32:35], v[60:63], v[224:227]
ds_read_b128 a[4:7], v2 offset:9216
v_exp_f32 v29, v29
v_mfma_f32_16x16x32_bf16 v[228:231], a[36:39], v[60:63], v[228:231]
v_exp_f32 v30, v30
v_mfma_f32_16x16x32_bf16 v[196:199], a[36:39], v[56:59], v[196:199]
ds_read_b128 a[8:11], v2 offset:10240
s_add_u32 m0, s19, 0x0
v_mfma_f32_16x16x32_bf16 v[200:203], a[40:43], v[56:59], v[200:203]
buffer_load_dwordx4 v3, s[48:51], s32 offen offset:0 sc1 lds
v_mfma_f32_16x16x32_bf16 v[232:235], a[40:43], v[60:63], v[232:235]
ds_read_b128 a[12:15], v2 offset:11264
v_exp_f32 v31, v31
v_mfma_f32_16x16x32_bf16 v[236:239], a[44:47], v[60:63], v[236:239]
v_exp_f32 v40, v40
v_mfma_f32_16x16x32_bf16 v[204:207], a[44:47], v[56:59], v[204:207]
ds_read_b128 a[16:19], v2 offset:12288
v_cvt_pk_bf16_f32 v76, v28, v29
v_mfma_f32_16x16x32_bf16 v[208:211], a[48:51], v[56:59], v[208:211]
v_exp_f32 v41, v41
v_mfma_f32_16x16x32_bf16 v[240:243], a[48:51], v[60:63], v[240:243]
ds_read_b128 a[20:23], v2 offset:13312
v_cvt_pk_bf16_f32 v77, v30, v31
v_mfma_f32_16x16x32_bf16 v[244:247], a[52:55], v[60:63], v[244:247]
ds_read_b128 a[24:27], v2 offset:14336
v_cvt_pk_bf16_f32 v74, v40, v41
v_mfma_f32_16x16x32_bf16 v[212:215], a[52:55], v[56:59], v[212:215]
v_exp_f32 v42, v42
v_mfma_f32_16x16x32_bf16 v[216:219], a[56:59], v[56:59], v[216:219]
buffer_load_dwordx4 v3, s[48:51], s32 offen offset:1024 sc1 lds
v_mfma_f32_16x16x32_bf16 v[248:251], a[56:59], v[60:63], v[248:251]
ds_read_b128 a[28:31], v2 offset:15360
v_mfma_f32_16x16x32_bf16 v[252:255], a[60:63], v[60:63], v[252:255]
ds_read_b128 a[32:35], v2 offset:0
v_mfma_f32_16x16x32_bf16 v[220:223], a[60:63], v[56:59], v[220:223]
v_exp_f32 v43, v43
v_mfma_f32_16x16x32_bf16 a[232:235], a[240:243], v[56:59], a[232:235]
ds_read_b128 a[36:39], v2 offset:1024
v_cvt_pk_bf16_f32 v75, v42, v43
v_mfma_f32_16x16x32_bf16 a[236:239], a[240:243], v[60:63], a[236:239]
s_waitcnt lgkmcnt(6)
v_exp_f32 v44, v44
v_mfma_f32_16x16x32_bf16 v[24:27], a[0:3], a[192:195], v[88:91]
ds_read_b128 a[40:43], v2 offset:2048
v_mfma_f32_16x16x32_bf16 v[24:27], a[4:7], a[196:199], v[24:27]
ds_read_b128 a[44:47], v2 offset:3072
v_mfma_f32_16x16x32_bf16 v[24:27], a[8:11], a[200:203], v[24:27]
buffer_load_dwordx4 v3, s[48:51], s32 offen offset:2048 sc1 lds
v_mfma_f32_16x16x32_bf16 v[24:27], a[12:15], a[204:207], v[24:27]
ds_read_b128 a[48:51], v2 offset:4096
v_mfma_f32_16x16x32_bf16 v[28:31], a[0:3], a[208:211], v[92:95]
v_exp_f32 v45, v45
v_mfma_f32_16x16x32_bf16 v[28:31], a[4:7], a[212:215], v[28:31]
ds_read_b128 a[52:55], v2 offset:5120
v_cvt_pk_bf16_f32 v78, v44, v45
v_mfma_f32_16x16x32_bf16 v[28:31], a[8:11], a[216:219], v[28:31]
v_exp_f32 v46, v46
v_mfma_f32_16x16x32_bf16 v[28:31], a[12:15], a[220:223], v[28:31]
ds_read_b128 a[56:59], v2 offset:6144
s_waitcnt lgkmcnt(7)
v_mfma_f32_16x16x32_bf16 v[40:43], a[16:19], a[192:195], v[88:91]
v_exp_f32 v47, v47
v_mfma_f32_16x16x32_bf16 v[40:43], a[20:23], a[196:199], v[40:43]
ds_read_b128 a[60:63], v2 offset:7168
v_cvt_pk_bf16_f32 v79, v46, v47
v_mfma_f32_16x16x32_bf16 v[40:43], a[24:27], a[200:203], v[40:43]
buffer_load_dwordx4 v3, s[48:51], s32 offen offset:3072 sc1 lds
v_mfma_f32_16x16x32_bf16 v[40:43], a[28:31], a[204:207], v[40:43]
v_exp_f32 v24, v24
v_mfma_f32_16x16x32_bf16 v[44:47], a[16:19], a[208:211], v[92:95]
v_exp_f32 v25, v25
v_mfma_f32_16x16x32_bf16 v[44:47], a[20:23], a[212:215], v[44:47]
v_exp_f32 v26, v26
v_mfma_f32_16x16x32_bf16 v[44:47], a[24:27], a[216:219], v[44:47]
v_exp_f32 v27, v27
v_mfma_f32_16x16x32_bf16 v[44:47], a[28:31], a[220:223], v[44:47]
v_cvt_pk_bf16_f32 v56, v24, v25
v_cvt_pk_bf16_f32 v57, v26, v27
s_waitcnt lgkmcnt(0)
v_mfma_f32_16x16x32_bf16 v[192:195], a[32:35], v[72:75], v[192:195]
ds_read_b128 a[0:3], v2 offset:24576
v_exp_f32 v28, v28
v_mfma_f32_16x16x32_bf16 v[224:227], a[32:35], v[76:79], v[224:227]
ds_read_b128 a[4:7], v2 offset:25600
v_exp_f32 v29, v29
v_mfma_f32_16x16x32_bf16 v[228:231], a[36:39], v[76:79], v[228:231]
v_exp_f32 v30, v30
v_mfma_f32_16x16x32_bf16 v[196:199], a[36:39], v[72:75], v[196:199]
ds_read_b128 a[8:11], v2 offset:26624
s_add_u32 m0, s19, 0x1000
v_mfma_f32_16x16x32_bf16 v[200:203], a[40:43], v[72:75], v[200:203]
buffer_load_dwordx4 v3, s[48:51], s7 offen offset:0 sc1 lds
v_mfma_f32_16x16x32_bf16 v[232:235], a[40:43], v[76:79], v[232:235]
ds_read_b128 a[12:15], v2 offset:27648
v_exp_f32 v31, v31
v_mfma_f32_16x16x32_bf16 v[236:239], a[44:47], v[76:79], v[236:239]
v_exp_f32 v40, v40
v_mfma_f32_16x16x32_bf16 v[204:207], a[44:47], v[72:75], v[204:207]
ds_read_b128 a[16:19], v2 offset:28672
v_exp_f32 v41, v41
v_mfma_f32_16x16x32_bf16 v[208:211], a[48:51], v[72:75], v[208:211]
v_exp_f32 v42, v42
v_mfma_f32_16x16x32_bf16 v[240:243], a[48:51], v[76:79], v[240:243]
ds_read_b128 a[20:23], v2 offset:29696
v_exp_f32 v43, v43
v_mfma_f32_16x16x32_bf16 v[244:247], a[52:55], v[76:79], v[244:247]
ds_read_b128 a[24:27], v2 offset:30720
v_cvt_pk_bf16_f32 v60, v28, v29
v_mfma_f32_16x16x32_bf16 v[212:215], a[52:55], v[72:75], v[212:215]
v_exp_f32 v44, v44
v_mfma_f32_16x16x32_bf16 v[216:219], a[56:59], v[72:75], v[216:219]
buffer_load_dwordx4 v3, s[48:51], s7 offen offset:1024 sc1 lds
v_mfma_f32_16x16x32_bf16 v[248:251], a[56:59], v[76:79], v[248:251]
ds_read_b128 a[28:31], v2 offset:31744
v_cvt_pk_bf16_f32 v61, v30, v31
v_mfma_f32_16x16x32_bf16 v[252:255], a[60:63], v[76:79], v[252:255]
ds_read_b128 a[32:35], v2 offset:16384
v_cvt_pk_bf16_f32 v58, v40, v41
v_mfma_f32_16x16x32_bf16 v[220:223], a[60:63], v[72:75], v[220:223]
v_exp_f32 v45, v45
v_mfma_f32_16x16x32_bf16 a[232:235], a[240:243], v[72:75], a[232:235]
ds_read_b128 a[36:39], v2 offset:17408
v_cvt_pk_bf16_f32 v59, v42, v43
v_mfma_f32_16x16x32_bf16 a[236:239], a[240:243], v[76:79], a[236:239]
s_waitcnt lgkmcnt(6)
v_exp_f32 v46, v46
v_mfma_f32_16x16x32_bf16 v[24:27], a[0:3], a[192:195], v[88:91]
ds_read_b128 a[40:43], v2 offset:18432
v_cvt_pk_bf16_f32 v62, v44, v45
v_mfma_f32_16x16x32_bf16 v[24:27], a[4:7], a[196:199], v[24:27]
ds_read_b128 a[44:47], v2 offset:19456
v_mfma_f32_16x16x32_bf16 v[24:27], a[8:11], a[200:203], v[24:27]
buffer_load_dwordx4 v3, s[48:51], s7 offen offset:2048 sc1 lds
v_mfma_f32_16x16x32_bf16 v[24:27], a[12:15], a[204:207], v[24:27]
ds_read_b128 a[48:51], v2 offset:20480
v_mfma_f32_16x16x32_bf16 v[28:31], a[0:3], a[208:211], v[92:95]
v_exp_f32 v47, v47
v_mfma_f32_16x16x32_bf16 v[28:31], a[4:7], a[212:215], v[28:31]
ds_read_b128 a[52:55], v2 offset:21504
v_cvt_pk_bf16_f32 v63, v46, v47
v_mfma_f32_16x16x32_bf16 v[28:31], a[8:11], a[216:219], v[28:31]
v_mfma_f32_16x16x32_bf16 v[28:31], a[12:15], a[220:223], v[28:31]
ds_read_b128 a[56:59], v2 offset:22528
s_waitcnt lgkmcnt(7)
v_mfma_f32_16x16x32_bf16 v[40:43], a[16:19], a[192:195], v[88:91]
v_exp_f32 v24, v24
v_mfma_f32_16x16x32_bf16 v[40:43], a[20:23], a[196:199], v[40:43]
ds_read_b128 a[60:63], v2 offset:23552
v_exp_f32 v25, v25
v_mfma_f32_16x16x32_bf16 v[40:43], a[24:27], a[200:203], v[40:43]
buffer_load_dwordx4 v3, s[48:51], s7 offen offset:3072 sc1 lds
v_mfma_f32_16x16x32_bf16 v[40:43], a[28:31], a[204:207], v[40:43]
s_add_u32 s32, s32, 0x8000
s_add_u32 s7, s7, 0x8000
s_xor_b32 s19, s19, 0x8000
v_mfma_f32_16x16x32_bf16 v[44:47], a[16:19], a[208:211], v[92:95]
s_sub_u32 s15, s15, 1
s_cmp_lg_u32 s15, 0
v_xor_b32 v2, 0x38000, v2
v_mfma_f32_16x16x32_bf16 v[44:47], a[20:23], a[212:215], v[44:47]
v_exp_f32 v26, v26
v_mfma_f32_16x16x32_bf16 v[44:47], a[24:27], a[216:219], v[44:47]
v_exp_f32 v27, v27
v_mfma_f32_16x16x32_bf16 v[44:47], a[28:31], a[220:223], v[44:47]
v_cvt_pk_bf16_f32 v72, v24, v25
v_cvt_pk_bf16_f32 v73, v26, v27
s_cbranch_scc1 L_att_seven
s_cmp_ge_u32 s4, 2
s_cbranch_scc1 L_att_sh0_1
L_att_sh0_0:
s_waitcnt vmcnt(16) lgkmcnt(0)
s_barrier
v_and_b32 v15, 7, v0
v_lshlrev_b32 v15, 2, v15
s_bfe_u32 s99, s2, 0x20001
s_lshl_b32 s99, s99, 2
s_lshr_b32 s8, s2, 6
s_add_u32 s99, s99, s8
buffer_load_dword v14, v15, s[84:87], 0 offen offset:192 sc1
s_bfe_u32 s100, s2, 0x30003
s_and_b32 s10, s2, 1
s_sub_u32 s11, 15, s99
s_min_u32 s11, s11, s99
s_lshl_b32 s11, s11, 1
s_add_u32 s11, s11, s10
s_lshl_b32 s11, s11, 6
s_add_u32 s11, s11, 0x3604000
s_mov_b32 s12, 14336
v_bfe_u32 v12, v0, 2, 2
v_lshlrev_b32 v12, 11, v12
v_lshrrev_b32 v13, 4, v0
v_lshl_add_u32 v12, v13, 6, v12
v_and_b32 v13, 3, v0
v_lshl_add_u32 v12, v13, 4, v12
s_lshl_b32 s8, s10, 7
v_xor_b32 v12, s8, v12
s_lshl_b32 s8, s4, 15
s_lshl_b32 s9, s100, 8
s_add_u32 s8, s8, s9
s_lshl_b32 s9, s10, 20
s_add_u32 s8, s8, s9
v_add_u32 v12, s8, v12
v_xor_b32 v13, 32, v12
v_add_u32 v13, 7168, v13
s_mul_i32 s25, s10, 0x300000
s_sub_u32 s25, s25, 917504
s_mul_i32 s101, s99, 0x140000
s_lshl_b32 s8, s4, 11
s_add_u32 s101, s101, s8
s_lshl_b32 s8, s10, 17
s_add_u32 s101, s101, s8
s_add_u32 s101, s101, 0x21fe000
s_mul_i32 s26, s10, 393216
s_add_u32 s26, s26, 139264
v_mfma_f32_16x16x32_bf16 v[192:195], a[32:35], v[56:59], v[192:195]
ds_read_b128 a[0:3], v1 offset:8192
v_exp_f32 v28, v28
v_mfma_f32_16x16x32_bf16 v[224:227], a[32:35], v[60:63], v[224:227]
ds_read_b128 a[4:7], v1 offset:9216
v_exp_f32 v29, v29
v_mfma_f32_16x16x32_bf16 v[228:231], a[36:39], v[60:63], v[228:231]
v_exp_f32 v30, v30
v_mfma_f32_16x16x32_bf16 v[196:199], a[36:39], v[56:59], v[196:199]
ds_read_b128 a[8:11], v1 offset:10240
s_add_u32 m0, s17, 0x10000
v_mfma_f32_16x16x32_bf16 v[200:203], a[40:43], v[56:59], v[200:203]
buffer_load_dwordx4 v12, s[72:75], 0 offen lds
v_mfma_f32_16x16x32_bf16 v[232:235], a[40:43], v[60:63], v[232:235]
ds_read_b128 a[12:15], v1 offset:11264
v_exp_f32 v31, v31
v_mfma_f32_16x16x32_bf16 v[236:239], a[44:47], v[60:63], v[236:239]
v_exp_f32 v40, v40
v_mfma_f32_16x16x32_bf16 v[204:207], a[44:47], v[56:59], v[204:207]
ds_read_b128 a[16:19], v1 offset:12288
v_cvt_pk_bf16_f32 v76, v28, v29
v_mfma_f32_16x16x32_bf16 v[208:211], a[48:51], v[56:59], v[208:211]
v_exp_f32 v41, v41
v_mfma_f32_16x16x32_bf16 v[240:243], a[48:51], v[60:63], v[240:243]
ds_read_b128 a[20:23], v1 offset:13312
v_cvt_pk_bf16_f32 v77, v30, v31
v_mfma_f32_16x16x32_bf16 v[244:247], a[52:55], v[60:63], v[244:247]
ds_read_b128 a[24:27], v1 offset:14336
v_cvt_pk_bf16_f32 v74, v40, v41
v_mfma_f32_16x16x32_bf16 v[212:215], a[52:55], v[56:59], v[212:215]
v_exp_f32 v42, v42
v_mfma_f32_16x16x32_bf16 v[216:219], a[56:59], v[56:59], v[216:219]
buffer_load_dwordx4 v13, s[72:75], 0 offen offset:1024 lds
v_mfma_f32_16x16x32_bf16 v[248:251], a[56:59], v[60:63], v[248:251]
ds_read_b128 a[28:31], v1 offset:15360
v_mfma_f32_16x16x32_bf16 v[252:255], a[60:63], v[60:63], v[252:255]
ds_read_b128 a[32:35], v1 offset:0
v_mfma_f32_16x16x32_bf16 v[220:223], a[60:63], v[56:59], v[220:223]
v_exp_f32 v43, v43
v_mfma_f32_16x16x32_bf16 a[232:235], a[240:243], v[56:59], a[232:235]
ds_read_b128 a[36:39], v1 offset:1024
v_cvt_pk_bf16_f32 v75, v42, v43
v_mfma_f32_16x16x32_bf16 a[236:239], a[240:243], v[60:63], a[236:239]
s_waitcnt lgkmcnt(6)
v_exp_f32 v44, v44
v_mfma_f32_16x16x32_bf16 v[24:27], a[0:3], a[192:195], v[112:115]
ds_read_b128 a[40:43], v1 offset:2048
v_mfma_f32_16x16x32_bf16 v[24:27], a[4:7], a[196:199], v[24:27]
ds_read_b128 a[44:47], v1 offset:3072
v_mfma_f32_16x16x32_bf16 v[24:27], a[8:11], a[200:203], v[24:27]
buffer_load_dwordx4 v12, s[72:75], s12 offen offset:2048 lds
v_mfma_f32_16x16x32_bf16 v[24:27], a[12:15], a[204:207], v[24:27]
ds_read_b128 a[48:51], v1 offset:4096
v_mfma_f32_16x16x32_bf16 v[28:31], a[0:3], a[208:211], v[92:95]
v_exp_f32 v45, v45
v_mfma_f32_16x16x32_bf16 v[28:31], a[4:7], a[212:215], v[28:31]
ds_read_b128 a[52:55], v1 offset:5120
v_cvt_pk_bf16_f32 v78, v44, v45
v_mfma_f32_16x16x32_bf16 v[28:31], a[8:11], a[216:219], v[28:31]
v_exp_f32 v46, v46
v_mfma_f32_16x16x32_bf16 v[28:31], a[12:15], a[220:223], v[28:31]
ds_read_b128 a[56:59], v1 offset:6144
s_waitcnt lgkmcnt(7)
v_mfma_f32_16x16x32_bf16 v[40:43], a[16:19], a[192:195], v[116:119]
v_exp_f32 v47, v47
v_mfma_f32_16x16x32_bf16 v[40:43], a[20:23], a[196:199], v[40:43]
ds_read_b128 a[60:63], v1 offset:7168
v_cvt_pk_bf16_f32 v79, v46, v47
v_mfma_f32_16x16x32_bf16 v[40:43], a[24:27], a[200:203], v[40:43]
buffer_load_dwordx4 v13, s[72:75], s12 offen offset:3072 lds
v_mfma_f32_16x16x32_bf16 v[40:43], a[28:31], a[204:207], v[40:43]
v_exp_f32 v24, v24
v_mfma_f32_16x16x32_bf16 v[44:47], a[16:19], a[208:211], v[92:95]
v_exp_f32 v25, v25
v_mfma_f32_16x16x32_bf16 v[44:47], a[20:23], a[212:215], v[44:47]
v_exp_f32 v26, v26
v_mfma_f32_16x16x32_bf16 v[44:47], a[24:27], a[216:219], v[44:47]
v_exp_f32 v27, v27
v_mfma_f32_16x16x32_bf16 v[44:47], a[28:31], a[220:223], v[44:47]
v_cvt_pk_bf16_f32 v56, v24, v25
v_cvt_pk_bf16_f32 v57, v26, v27
s_waitcnt lgkmcnt(0)
v_mfma_f32_16x16x32_bf16 v[192:195], a[32:35], v[72:75], v[192:195]
ds_read_b128 a[0:3], v1 offset:24576
v_exp_f32 v28, v28
v_mfma_f32_16x16x32_bf16 v[224:227], a[32:35], v[76:79], v[224:227]
ds_read_b128 a[4:7], v1 offset:25600
v_add_u32 v12, 0x20000, v12
v_mfma_f32_16x16x32_bf16 v[228:231], a[36:39], v[76:79], v[228:231]
ds_read_b128 a[8:11], v1 offset:26624
s_add_u32 m0, s17, 0x14000
v_mfma_f32_16x16x32_bf16 v[196:199], a[36:39], v[72:75], v[196:199]
buffer_load_dwordx4 v12, s[72:75], 0 offen lds
v_mfma_f32_16x16x32_bf16 v[200:203], a[40:43], v[72:75], v[200:203]
ds_read_b128 a[12:15], v1 offset:27648
v_exp_f32 v29, v29
v_mfma_f32_16x16x32_bf16 v[232:235], a[40:43], v[76:79], v[232:235]
ds_read_b128 a[16:19], v1 offset:28672
v_exp_f32 v30, v30
v_mfma_f32_16x16x32_bf16 v[236:239], a[44:47], v[76:79], v[236:239]
ds_read_b128 a[20:23], v1 offset:29696
v_exp_f32 v31, v31
v_mfma_f32_16x16x32_bf16 v[204:207], a[44:47], v[72:75], v[204:207]
ds_read_b128 a[24:27], v1 offset:30720
v_exp_f32 v40, v40
v_mfma_f32_16x16x32_bf16 v[208:211], a[48:51], v[72:75], v[208:211]
v_add_u32 v13, 0x20000, v13
v_exp_f32 v41, v41
v_mfma_f32_16x16x32_bf16 v[240:243], a[48:51], v[76:79], v[240:243]
buffer_load_dwordx4 v13, s[72:75], 0 offen offset:1024 lds
v_mfma_f32_16x16x32_bf16 v[244:247], a[52:55], v[76:79], v[244:247]
ds_read_b128 a[28:31], v1 offset:31744
v_exp_f32 v42, v42
v_mfma_f32_16x16x32_bf16 v[212:215], a[52:55], v[72:75], v[212:215]
ds_read_b128 a[32:35], v1 offset:16384
v_exp_f32 v43, v43
v_mfma_f32_16x16x32_bf16 v[216:219], a[56:59], v[72:75], v[216:219]
ds_read_b128 a[36:39], v1 offset:17408
v_exp_f32 v44, v44
v_mfma_f32_16x16x32_bf16 v[248:251], a[56:59], v[76:79], v[248:251]
ds_read_b128 a[40:43], v1 offset:18432
v_exp_f32 v45, v45
v_mfma_f32_16x16x32_bf16 v[252:255], a[60:63], v[76:79], v[252:255]
ds_read_b128 a[44:47], v1 offset:19456
v_exp_f32 v46, v46
v_mfma_f32_16x16x32_bf16 v[220:223], a[60:63], v[72:75], v[220:223]
buffer_load_dwordx4 v12, s[72:75], s12 offen offset:2048 lds
v_mfma_f32_16x16x32_bf16 a[232:235], a[240:243], v[72:75], a[232:235]
ds_read_b128 a[48:51], v1 offset:20480
v_cvt_pk_bf16_f32 v60, v28, v29
v_mfma_f32_16x16x32_bf16 a[236:239], a[240:243], v[76:79], a[236:239]
ds_read_b128 a[52:55], v1 offset:21504
s_waitcnt lgkmcnt(10)
v_cvt_pk_bf16_f32 v61, v30, v31
v_mfma_f32_16x16x32_bf16 v[28:31], a[0:3], a[208:211], v[92:95]
ds_read_b128 a[56:59], v1 offset:22528
v_cvt_pk_bf16_f32 v58, v40, v41
v_mfma_f32_16x16x32_bf16 v[28:31], a[4:7], a[212:215], v[28:31]
ds_read_b128 a[60:63], v1 offset:23552
v_cvt_pk_bf16_f32 v59, v42, v43
v_mfma_f32_16x16x32_bf16 v[28:31], a[8:11], a[216:219], v[28:31]
s_waitcnt lgkmcnt(8)
v_exp_f32 v47, v47
v_mfma_f32_16x16x32_bf16 v[28:31], a[12:15], a[220:223], v[28:31]
buffer_load_dwordx4 v13, s[72:75], s12 offen offset:3072 lds
v_cvt_pk_bf16_f32 v62, v44, v45
v_cvt_pk_bf16_f32 v63, v46, v47
v_mfma_f32_16x16x32_bf16 v[44:47], a[16:19], a[208:211], v[92:95]
v_xor_b32 v1, 0x8000, v1
v_mfma_f32_16x16x32_bf16 v[44:47], a[20:23], a[212:215], v[44:47]
v_mfma_f32_16x16x32_bf16 v[44:47], a[24:27], a[216:219], v[44:47]
v_mfma_f32_16x16x32_bf16 v[44:47], a[28:31], a[220:223], v[44:47]
L_att_h1_0:
s_waitcnt vmcnt(8) lgkmcnt(0)
s_mov_b32 s92, 200000
L_spin_b0:
v_cmp_gt_u32 vcc, 32, v14
s_nop 4
s_cbranch_vccz L_spun_b0
s_sub_u32 s92, s92, 1
s_cbranch_scc1 L_spun_b0
s_sleep 2
buffer_load_dword v14, v15, s[84:87], 0 offen offset:192 sc1
s_waitcnt vmcnt(0)
s_branch L_spin_b0
L_spun_b0:
s_barrier
v_mfma_f32_16x16x32_bf16 v[192:195], a[32:35], v[56:59], v[192:195]
ds_read_b128 a[0:3], v2 offset:8192
v_exp_f32 v28, v28
v_mfma_f32_16x16x32_bf16 v[224:227], a[32:35], v[60:63], v[224:227]
ds_read_b128 a[4:7], v2 offset:9216
v_exp_f32 v29, v29
v_mfma_f32_16x16x32_bf16 v[228:231], a[36:39], v[60:63], v[228:231]
ds_read_b128 a[8:11], v2 offset:10240
s_add_u32 s101, s101, 0x2000
v_mfma_f32_16x16x32_bf16 v[196:199], a[36:39], v[56:59], v[196:199]
buffer_load_dwordx4 a[64:67], v3, s[88:91], s101 offen sc1
v_mfma_f32_16x16x32_bf16 v[200:203], a[40:43], v[56:59], v[200:203]
ds_read_b128 a[12:15], v2 offset:11264
v_exp_f32 v30, v30
v_mfma_f32_16x16x32_bf16 v[232:235], a[40:43], v[60:63], v[232:235]
ds_read_b128 a[16:19], v2 offset:12288
v_exp_f32 v31, v31
v_mfma_f32_16x16x32_bf16 v[236:239], a[44:47], v[60:63], v[236:239]
ds_read_b128 a[20:23], v2 offset:13312
v_exp_f32 v44, v44
v_mfma_f32_16x16x32_bf16 v[204:207], a[44:47], v[56:59], v[204:207]
ds_read_b128 a[24:27], v2 offset:14336
v_exp_f32 v45, v45
v_mfma_f32_16x16x32_bf16 v[208:211], a[48:51], v[56:59], v[208:211]
v_exp_f32 v46, v46
v_mfma_f32_16x16x32_bf16 v[240:243], a[48:51], v[60:63], v[240:243]
buffer_load_dwordx4 a[68:71], v3, s[88:91], s101 offen offset:1024 sc1
v_mfma_f32_16x16x32_bf16 v[244:247], a[52:55], v[60:63], v[244:247]
ds_read_b128 a[28:31], v2 offset:15360
v_cvt_pk_bf16_f32 v76, v28, v29
v_mfma_f32_16x16x32_bf16 v[212:215], a[52:55], v[56:59], v[212:215]
ds_read_b128 a[32:35], v2 offset:0
v_cvt_pk_bf16_f32 v77, v30, v31
v_mfma_f32_16x16x32_bf16 v[216:219], a[56:59], v[56:59], v[216:219]
ds_read_b128 a[36:39], v2 offset:1024
v_cvt_pk_bf16_f32 v78, v44, v45
v_mfma_f32_16x16x32_bf16 v[248:251], a[56:59], v[60:63], v[248:251]
ds_read_b128 a[40:43], v2 offset:2048
v_mfma_f32_16x16x32_bf16 v[252:255], a[60:63], v[60:63], v[252:255]
ds_read_b128 a[44:47], v2 offset:3072
s_add_u32 s101, s101, 0x2000
v_mfma_f32_16x16x32_bf16 v[220:223], a[60:63], v[56:59], v[220:223]
buffer_load_dwordx4 a[72:75], v3, s[88:91], s101 offen sc1
v_mfma_f32_16x16x32_bf16 a[232:235], a[240:243], v[56:59], a[232:235]
ds_read_b128 a[48:51], v2 offset:4096
v_mfma_f32_16x16x32_bf16 a[236:239], a[240:243], v[60:63], a[236:239]
ds_read_b128 a[52:55], v2 offset:5120
s_waitcnt lgkmcnt(10)
v_mfma_f32_16x16x32_bf16 v[28:31], a[0:3], a[208:211], v[92:95]
ds_read_b128 a[56:59], v2 offset:6144
v_mfma_f32_16x16x32_bf16 v[28:31], a[4:7], a[212:215], v[28:31]
ds_read_b128 a[60:63], v2 offset:7168
v_mfma_f32_16x16x32_bf16 v[28:31], a[8:11], a[216:219], v[28:31]
s_waitcnt lgkmcnt(8)
v_exp_f32 v47, v47
v_mfma_f32_16x16x32_bf16 v[28:31], a[12:15], a[220:223], v[28:31]
buffer_load_dwordx4 a[76:79], v3, s[88:91], s101 offen offset:1024 sc1
v_cvt_pk_bf16_f32 v79, v46, v47
v_mfma_f32_16x16x32_bf16 v[44:47], a[16:19], a[208:211], v[92:95]
v_mfma_f32_16x16x32_bf16 v[44:47], a[20:23], a[212:215], v[44:47]
v_mfma_f32_16x16x32_bf16 v[44:47], a[24:27], a[216:219], v[44:47]
v_mfma_f32_16x16x32_bf16 v[44:47], a[28:31], a[220:223], v[44:47]
s_waitcnt lgkmcnt(0)
v_mfma_f32_16x16x32_bf16 v[224:227], a[32:35], v[76:79], v[224:227]
ds_read_b128 a[0:3], v2 offset:24576
s_add_u32 s101, s101, 0x2000
v_mfma_f32_16x16x32_bf16 v[228:231], a[36:39], v[76:79], v[228:231]
buffer_load_dwordx4 a[80:83], v3, s[88:91], s101 offen sc1
v_mfma_f32_16x16x32_bf16 v[232:235], a[40:43], v[76:79], v[232:235]
ds_read_b128 a[4:7], v2 offset:25600
v_exp_f32 v28, v28
v_mfma_f32_16x16x32_bf16 v[236:239], a[44:47], v[76:79], v[236:239]
ds_read_b128 a[8:11], v2 offset:26624
v_exp_f32 v29, v29
v_mfma_f32_16x16x32_bf16 v[240:243], a[48:51], v[76:79], v[240:243]
ds_read_b128 a[12:15], v2 offset:27648
v_exp_f32 v30, v30
v_mfma_f32_16x16x32_bf16 v[244:247], a[52:55], v[76:79], v[244:247]
buffer_load_dwordx4 a[84:87], v3, s[88:91], s101 offen offset:1024 sc1
v_mfma_f32_16x16x32_bf16 v[248:251], a[56:59], v[76:79], v[248:251]
ds_read_b128 a[16:19], v2 offset:28672
v_exp_f32 v31, v31
v_mfma_f32_16x16x32_bf16 v[252:255], a[60:63], v[76:79], v[252:255]
ds_read_b128 a[20:23], v2 offset:29696
s_waitcnt lgkmcnt(2)
v_mfma_f32_16x16x32_bf16 a[236:239], a[240:243], v[76:79], a[236:239]
ds_read_b128 a[24:27], v2 offset:30720
s_add_u32 s101, s101, 0x2000
v_cvt_pk_bf16_f32 v60, v28, v29
v_cvt_pk_bf16_f32 v61, v30, v31
v_mfma_f32_16x16x32_bf16 v[28:31], a[0:3], a[208:211], v[120:123]
buffer_load_dwordx4 a[88:91], v3, s[88:91], s101 offen sc1
v_mfma_f32_16x16x32_bf16 v[28:31], a[4:7], a[212:215], v[28:31]
ds_read_b128 a[28:31], v2 offset:31744
v_exp_f32 v44, v44
v_mfma_f32_16x16x32_bf16 v[28:31], a[8:11], a[216:219], v[28:31]
ds_read_b128 a[32:35], v2 offset:16384
v_exp_f32 v45, v45
v_mfma_f32_16x16x32_bf16 v[28:31], a[12:15], a[220:223], v[28:31]
ds_read_b128 a[36:39], v2 offset:17408
s_waitcnt lgkmcnt(2)
v_exp_f32 v46, v46
v_exp_f32 v47, v47
v_cvt_pk_bf16_f32 v62, v44, v45
v_cvt_pk_bf16_f32 v63, v46, v47
v_mfma_f32_16x16x32_bf16 v[44:47], a[16:19], a[208:211], v[124:127]
buffer_load_dwordx4 a[92:95], v3, s[88:91], s101 offen offset:1024 sc1
v_mfma_f32_16x16x32_bf16 v[44:47], a[20:23], a[212:215], v[44:47]
ds_read_b128 a[40:43], v2 offset:18432
v_mfma_f32_16x16x32_bf16 v[44:47], a[24:27], a[216:219], v[44:47]
ds_read_b128 a[44:47], v2 offset:19456
v_mfma_f32_16x16x32_bf16 v[44:47], a[28:31], a[220:223], v[44:47]
ds_read_b128 a[48:51], v2 offset:20480
ds_read_b128 a[52:55], v2 offset:21504
ds_read_b128 a[56:59], v2 offset:22528
ds_read_b128 a[60:63], v2 offset:23552
v_xor_b32 v2, 0x38000, v2
s_waitcnt  lgkmcnt(0)
s_barrier
v_exp_f32 v28, v28
v_exp_f32 v29, v29
v_exp_f32 v30, v30
v_exp_f32 v31, v31
v_exp_f32 v44, v44
v_exp_f32 v45, v45
v_exp_f32 v46, v46
v_exp_f32 v47, v47
v_cvt_pk_bf16_f32 v76, v28, v29
v_cvt_pk_bf16_f32 v77, v30, v31
v_cvt_pk_bf16_f32 v78, v44, v45
v_cvt_pk_bf16_f32 v79, v46, v47
v_mfma_f32_16x16x32_bf16 v[224:227], a[32:35], v[60:63], v[224:227]
v_mfma_f32_16x16x32_bf16 v[228:231], a[36:39], v[60:63], v[228:231]
v_mfma_f32_16x16x32_bf16 v[232:235], a[40:43], v[60:63], v[232:235]
v_mfma_f32_16x16x32_bf16 v[236:239], a[44:47], v[60:63], v[236:239]
v_mfma_f32_16x16x32_bf16 v[240:243], a[48:51], v[60:63], v[240:243]
v_mfma_f32_16x16x32_bf16 v[244:247], a[52:55], v[60:63], v[244:247]
v_mfma_f32_16x16x32_bf16 v[248:251], a[56:59], v[60:63], v[248:251]
v_mfma_f32_16x16x32_bf16 v[252:255], a[60:63], v[60:63], v[252:255]
v_mfma_f32_16x16x32_bf16 a[236:239], a[240:243], v[60:63], a[236:239]
ds_read_b128 a[32:35], v1 offset:0
ds_read_b128 a[36:39], v1 offset:1024
ds_read_b128 a[40:43], v1 offset:2048
ds_read_b128 a[44:47], v1 offset:3072
ds_read_b128 a[48:51], v1 offset:4096
ds_read_b128 a[52:55], v1 offset:5120
ds_read_b128 a[56:59], v1 offset:6144
ds_read_b128 a[60:63], v1 offset:7168
s_waitcnt lgkmcnt(0)
v_mfma_f32_16x16x32_bf16 v[224:227], a[32:35], v[76:79], v[224:227]
v_mfma_f32_16x16x32_bf16 v[228:231], a[36:39], v[76:79], v[228:231]
v_mfma_f32_16x16x32_bf16 v[232:235], a[40:43], v[76:79], v[232:235]
v_mfma_f32_16x16x32_bf16 v[236:239], a[44:47], v[76:79], v[236:239]
v_mfma_f32_16x16x32_bf16 v[240:243], a[48:51], v[76:79], v[240:243]
v_mfma_f32_16x16x32_bf16 v[244:247], a[52:55], v[76:79], v[244:247]
v_mfma_f32_16x16x32_bf16 v[248:251], a[56:59], v[76:79], v[248:251]
v_mfma_f32_16x16x32_bf16 v[252:255], a[60:63], v[76:79], v[252:255]
v_mfma_f32_16x16x32_bf16 a[236:239], a[240:243], v[76:79], a[236:239]
v_xor_b32 v1, 0x8000, v1
s_branch L_att_fin
L_att_sh0_1:
s_waitcnt vmcnt(16) lgkmcnt(0)
s_barrier
v_and_b32 v15, 7, v0
v_lshlrev_b32 v15, 2, v15
s_bfe_u32 s99, s2, 0x20001
s_lshl_b32 s99, s99, 2
s_lshr_b32 s8, s2, 6
s_add_u32 s99, s99, s8
buffer_load_dword v14, v15, s[84:87], 0 offen offset:192 sc1
s_bfe_u32 s100, s2, 0x30003
s_and_b32 s10, s2, 1
s_sub_u32 s11, 15, s99
s_min_u32 s11, s11, s99
s_lshl_b32 s11, s11, 1
s_add_u32 s11, s11, s10
s_lshl_b32 s11, s11, 6
s_add_u32 s11, s11, 0x3604000
s_mov_b32 s12, 14336
v_bfe_u32 v12, v0, 2, 2
v_lshlrev_b32 v12, 11, v12
v_lshrrev_b32 v13, 4, v0
v_lshl_add_u32 v12, v13, 6, v12
v_and_b32 v13, 3, v0
v_lshl_add_u32 v12, v13, 4, v12
s_lshl_b32 s8, s10, 7
v_xor_b32 v12, s8, v12
s_lshl_b32 s8, s4, 15
s_lshl_b32 s9, s100, 8
s_add_u32 s8, s8, s9
s_lshl_b32 s9, s10, 20
s_add_u32 s8, s8, s9
v_add_u32 v12, s8, v12
v_xor_b32 v13, 32, v12
v_add_u32 v13, 7168, v13
s_mul_i32 s25, s10, 0x300000
s_sub_u32 s25, s25, 917504
s_mul_i32 s101, s99, 0x140000
s_lshl_b32 s8, s4, 11
s_add_u32 s101, s101, s8
s_lshl_b32 s8, s10, 17
s_add_u32 s101, s101, s8
s_add_u32 s101, s101, 0x21fe000
s_mul_i32 s26, s10, 393216
s_add_u32 s26, s26, 139264
v_mfma_f32_16x16x32_bf16 v[192:195], a[32:35], v[56:59], v[192:195]
ds_read_b128 a[0:3], v1 offset:8192
v_exp_f32 v28, v28
v_mfma_f32_16x16x32_bf16 v[224:227], a[32:35], v[60:63], v[224:227]
ds_read_b128 a[4:7], v1 offset:9216
v_exp_f32 v29, v29
v_mfma_f32_16x16x32_bf16 v[228:231], a[36:39], v[60:63], v[228:231]
v_exp_f32 v30, v30
v_mfma_f32_16x16x32_bf16 v[196:199], a[36:39], v[56:59], v[196:199]
ds_read_b128 a[8:11], v1 offset:10240
s_add_u32 m0, s17, 0x10000
v_mfma_f32_16x16x32_bf16 v[200:203], a[40:43], v[56:59], v[200:203]
buffer_load_dwordx4 v12, s[72:75], 0 offen lds
v_mfma_f32_16x16x32_bf16 v[232:235], a[40:43], v[60:63], v[232:235]
ds_read_b128 a[12:15], v1 offset:11264
v_exp_f32 v31, v31
v_mfma_f32_16x16x32_bf16 v[236:239], a[44:47], v[60:63], v[236:239]
v_exp_f32 v40, v40
v_mfma_f32_16x16x32_bf16 v[204:207], a[44:47], v[56:59], v[204:207]
ds_read_b128 a[16:19], v1 offset:12288
v_cvt_pk_bf16_f32 v76, v28, v29
v_mfma_f32_16x16x32_bf16 v[208:211], a[48:51], v[56:59], v[208:211]
v_exp_f32 v41, v41
v_mfma_f32_16x16x32_bf16 v[240:243], a[48:51], v[60:63], v[240:243]
ds_read_b128 a[20:23], v1 offset:13312
v_cvt_pk_bf16_f32 v77, v30, v31
v_mfma_f32_16x16x32_bf16 v[244:247], a[52:55], v[60:63], v[244:247]
ds_read_b128 a[24:27], v1 offset:14336
v_cvt_pk_bf16_f32 v74, v40, v41
v_mfma_f32_16x16x32_bf16 v[212:215], a[52:55], v[56:59], v[212:215]
v_exp_f32 v42, v42
v_mfma_f32_16x16x32_bf16 v[216:219], a[56:59], v[56:59], v[216:219]
buffer_load_dwordx4 v13, s[72:75], 0 offen offset:1024 lds
v_mfma_f32_16x16x32_bf16 v[248:251], a[56:59], v[60:63], v[248:251]
ds_read_b128 a[28:31], v1 offset:15360
v_mfma_f32_16x16x32_bf16 v[252:255], a[60:63], v[60:63], v[252:255]
ds_read_b128 a[32:35], v1 offset:0
v_mfma_f32_16x16x32_bf16 v[220:223], a[60:63], v[56:59], v[220:223]
v_exp_f32 v43, v43
v_mfma_f32_16x16x32_bf16 a[232:235], a[240:243], v[56:59], a[232:235]
ds_read_b128 a[36:39], v1 offset:1024
v_cvt_pk_bf16_f32 v75, v42, v43
v_mfma_f32_16x16x32_bf16 a[236:239], a[240:243], v[60:63], a[236:239]
s_waitcnt lgkmcnt(6)
v_exp_f32 v44, v44
v_mfma_f32_16x16x32_bf16 v[24:27], a[0:3], a[192:195], v[88:91]
ds_read_b128 a[40:43], v1 offset:2048
v_mfma_f32_16x16x32_bf16 v[24:27], a[4:7], a[196:199], v[24:27]
ds_read_b128 a[44:47], v1 offset:3072
v_mfma_f32_16x16x32_bf16 v[24:27], a[8:11], a[200:203], v[24:27]
buffer_load_dwordx4 v12, s[72:75], s12 offen offset:2048 lds
v_mfma_f32_16x16x32_bf16 v[24:27], a[12:15], a[204:207], v[24:27]
ds_read_b128 a[48:51], v1 offset:4096
v_mfma_f32_16x16x32_bf16 v[28:31], a[0:3], a[208:211], v[92:95]
v_exp_f32 v45, v45
v_mfma_f32_16x16x32_bf16 v[28:31], a[4:7], a[212:215], v[28:31]
ds_read_b128 a[52:55], v1 offset:5120
v_cvt_pk_bf16_f32 v78, v44, v45
v_mfma_f32_16x16x32_bf16 v[28:31], a[8:11], a[216:219], v[28:31]
v_exp_f32 v46, v46
v_mfma_f32_16x16x32_bf16 v[28:31], a[12:15], a[220:223], v[28:31]
ds_read_b128 a[56:59], v1 offset:6144
s_waitcnt lgkmcnt(7)
v_mfma_f32_16x16x32_bf16 v[40:43], a[16:19], a[192:195], v[88:91]
v_exp_f32 v47, v47
v_mfma_f32_16x16x32_bf16 v[40:43], a[20:23], a[196:199], v[40:43]
ds_read_b128 a[60:63], v1 offset:7168
v_cvt_pk_bf16_f32 v79, v46, v47
v_mfma_f32_16x16x32_bf16 v[40:43], a[24:27], a[200:203], v[40:43]
buffer_load_dwordx4 v13, s[72:75], s12 offen offset:3072 lds
v_mfma_f32_16x16x32_bf16 v[40:43], a[28:31], a[204:207], v[40:43]
v_exp_f32 v24, v24
v_mfma_f32_16x16x32_bf16 v[44:47], a[16:19], a[208:211], v[92:95]
v_exp_f32 v25, v25
v_mfma_f32_16x16x32_bf16 v[44:47], a[20:23], a[212:215], v[44:47]
v_exp_f32 v26, v26
v_mfma_f32_16x16x32_bf16 v[44:47], a[24:27], a[216:219], v[44:47]
v_exp_f32 v27, v27
v_mfma_f32_16x16x32_bf16 v[44:47], a[28:31], a[220:223], v[44:47]
v_cvt_pk_bf16_f32 v56, v24, v25
v_cvt_pk_bf16_f32 v57, v26, v27
s_waitcnt lgkmcnt(0)
v_mfma_f32_16x16x32_bf16 v[192:195], a[32:35], v[72:75], v[192:195]
ds_read_b128 a[0:3], v1 offset:24576
v_exp_f32 v28, v28
v_mfma_f32_16x16x32_bf16 v[224:227], a[32:35], v[76:79], v[224:227]
ds_read_b128 a[4:7], v1 offset:25600
v_exp_f32 v29, v29
v_mfma_f32_16x16x32_bf16 v[228:231], a[36:39], v[76:79], v[228:231]
v_add_u32 v12, 0x20000, v12
v_exp_f32 v30, v30
v_mfma_f32_16x16x32_bf16 v[196:199], a[36:39], v[72:75], v[196:199]
ds_read_b128 a[8:11], v1 offset:26624
s_add_u32 m0, s17, 0x14000
v_mfma_f32_16x16x32_bf16 v[200:203], a[40:43], v[72:75], v[200:203]
buffer_load_dwordx4 v12, s[72:75], 0 offen lds
v_mfma_f32_16x16x32_bf16 v[232:235], a[40:43], v[76:79], v[232:235]
ds_read_b128 a[12:15], v1 offset:27648
v_exp_f32 v31, v31
v_mfma_f32_16x16x32_bf16 v[236:239], a[44:47], v[76:79], v[236:239]
v_exp_f32 v40, v40
v_mfma_f32_16x16x32_bf16 v[204:207], a[44:47], v[72:75], v[204:207]
ds_read_b128 a[16:19], v1 offset:28672
v_exp_f32 v41, v41
v_mfma_f32_16x16x32_bf16 v[208:211], a[48:51], v[72:75], v[208:211]
v_exp_f32 v42, v42
v_mfma_f32_16x16x32_bf16 v[240:243], a[48:51], v[76:79], v[240:243]
ds_read_b128 a[20:23], v1 offset:29696
v_exp_f32 v43, v43
v_mfma_f32_16x16x32_bf16 v[244:247], a[52:55], v[76:79], v[244:247]
ds_read_b128 a[24:27], v1 offset:30720
v_cvt_pk_bf16_f32 v60, v28, v29
v_mfma_f32_16x16x32_bf16 v[212:215], a[52:55], v[72:75], v[212:215]
v_add_u32 v13, 0x20000, v13
v_cvt_pk_bf16_f32 v61, v30, v31
v_mfma_f32_16x16x32_bf16 v[216:219], a[56:59], v[72:75], v[216:219]
buffer_load_dwordx4 v13, s[72:75], 0 offen offset:1024 lds
v_mfma_f32_16x16x32_bf16 v[248:251], a[56:59], v[76:79], v[248:251]
ds_read_b128 a[28:31], v1 offset:31744
v_cvt_pk_bf16_f32 v58, v40, v41
v_mfma_f32_16x16x32_bf16 v[252:255], a[60:63], v[76:79], v[252:255]
ds_read_b128 a[32:35], v1 offset:16384
v_cvt_pk_bf16_f32 v59, v42, v43
v_mfma_f32_16x16x32_bf16 v[220:223], a[60:63], v[72:75], v[220:223]
v_exp_f32 v44, v44
v_mfma_f32_16x16x32_bf16 a[232:235], a[240:243], v[72:75], a[232:235]
ds_read_b128 a[36:39], v1 offset:17408
v_mfma_f32_16x16x32_bf16 a[236:239], a[240:243], v[76:79], a[236:239]
s_waitcnt lgkmcnt(6)
v_exp_f32 v45, v45
v_mfma_f32_16x16x32_bf16 v[24:27], a[0:3], a[192:195], v[112:115]
ds_read_b128 a[40:43], v1 offset:18432
v_cvt_pk_bf16_f32 v62, v44, v45
v_mfma_f32_16x16x32_bf16 v[24:27], a[4:7], a[196:199], v[24:27]
ds_read_b128 a[44:47], v1 offset:19456
v_mfma_f32_16x16x32_bf16 v[24:27], a[8:11], a[200:203], v[24:27]
buffer_load_dwordx4 v12, s[72:75], s12 offen offset:2048 lds
v_mfma_f32_16x16x32_bf16 v[24:27], a[12:15], a[204:207], v[24:27]
ds_read_b128 a[48:51], v1 offset:20480
v_mfma_f32_16x16x32_bf16 v[28:31], a[0:3], a[208:211], v[92:95]
v_exp_f32 v46, v46
v_mfma_f32_16x16x32_bf16 v[28:31], a[4:7], a[212:215], v[28:31]
ds_read_b128 a[52:55], v1 offset:21504
v_mfma_f32_16x16x32_bf16 v[28:31], a[8:11], a[216:219], v[28:31]
v_exp_f32 v47, v47
v_mfma_f32_16x16x32_bf16 v[28:31], a[12:15], a[220:223], v[28:31]
ds_read_b128 a[56:59], v1 offset:22528
s_waitcnt lgkmcnt(7)
v_mfma_f32_16x16x32_bf16 v[40:43], a[16:19], a[192:195], v[116:119]
v_exp_f32 v24, v24
v_mfma_f32_16x16x32_bf16 v[40:43], a[20:23], a[196:199], v[40:43]
ds_read_b128 a[60:63], v1 offset:23552
v_cvt_pk_bf16_f32 v63, v46, v47
v_mfma_f32_16x16x32_bf16 v[40:43], a[24:27], a[200:203], v[40:43]
buffer_load_dwordx4 v13, s[72:75], s12 offen offset:3072 lds
v_mfma_f32_16x16x32_bf16 v[40:43], a[28:31], a[204:207], v[40:43]
v_xor_b32 v1, 0x8000, v1
v_mfma_f32_16x16x32_bf16 v[44:47], a[16:19], a[208:211], v[92:95]
v_exp_f32 v25, v25
v_mfma_f32_16x16x32_bf16 v[44:47], a[20:23], a[212:215], v[44:47]
v_exp_f32 v26, v26
v_mfma_f32_16x16x32_bf16 v[44:47], a[24:27], a[216:219], v[44:47]
v_exp_f32 v27, v27
v_mfma_f32_16x16x32_bf16 v[44:47], a[28:31], a[220:223], v[44:47]
v_cvt_pk_bf16_f32 v72, v24, v25
v_cvt_pk_bf16_f32 v73, v26, v27
L_att_h1_1:
s_waitcnt vmcnt(8) lgkmcnt(0)
s_mov_b32 s92, 200000
L_spin_b1:
v_cmp_gt_u32 vcc, 32, v14
s_nop 4
s_cbranch_vccz L_spun_b1
s_sub_u32 s92, s92, 1
s_cbranch_scc1 L_spun_b1
s_sleep 2
buffer_load_dword v14, v15, s[84:87], 0 offen offset:192 sc1
s_waitcnt vmcnt(0)
s_branch L_spin_b1
L_spun_b1:
s_barrier
v_mfma_f32_16x16x32_bf16 v[192:195], a[32:35], v[56:59], v[192:195]
ds_read_b128 a[0:3], v2 offset:8192
v_exp_f32 v28, v28
v_mfma_f32_16x16x32_bf16 v[224:227], a[32:35], v[60:63], v[224:227]
ds_read_b128 a[4:7], v2 offset:9216
v_exp_f32 v29, v29
v_mfma_f32_16x16x32_bf16 v[228:231], a[36:39], v[60:63], v[228:231]
ds_read_b128 a[8:11], v2 offset:10240
s_add_u32 s101, s101, 0x2000
v_mfma_f32_16x16x32_bf16 v[196:199], a[36:39], v[56:59], v[196:199]
buffer_load_dwordx4 a[64:67], v3, s[88:91], s101 offen sc1
v_mfma_f32_16x16x32_bf16 v[200:203], a[40:43], v[56:59], v[200:203]
ds_read_b128 a[12:15], v2 offset:11264
v_exp_f32 v30, v30
v_mfma_f32_16x16x32_bf16 v[232:235], a[40:43], v[60:63], v[232:235]
ds_read_b128 a[16:19], v2 offset:12288
v_exp_f32 v31, v31
v_mfma_f32_16x16x32_bf16 v[236:239], a[44:47], v[60:63], v[236:239]
ds_read_b128 a[20:23], v2 offset:13312
v_exp_f32 v40, v40
v_mfma_f32_16x16x32_bf16 v[204:207], a[44:47], v[56:59], v[204:207]
ds_read_b128 a[24:27], v2 offset:14336
v_exp_f32 v41, v41
v_mfma_f32_16x16x32_bf16 v[208:211], a[48:51], v[56:59], v[208:211]
v_exp_f32 v42, v42
v_mfma_f32_16x16x32_bf16 v[240:243], a[48:51], v[60:63], v[240:243]
buffer_load_dwordx4 a[68:71], v3, s[88:91], s101 offen offset:1024 sc1
v_mfma_f32_16x16x32_bf16 v[244:247], a[52:55], v[60:63], v[244:247]
ds_read_b128 a[28:31], v2 offset:15360
v_exp_f32 v43, v43
v_mfma_f32_16x16x32_bf16 v[212:215], a[52:55], v[56:59], v[212:215]
ds_read_b128 a[32:35], v2 offset:0
v_exp_f32 v44, v44
v_mfma_f32_16x16x32_bf16 v[216:219], a[56:59], v[56:59], v[216:219]
ds_read_b128 a[36:39], v2 offset:1024
v_exp_f32 v45, v45
v_mfma_f32_16x16x32_bf16 v[248:251], a[56:59], v[60:63], v[248:251]
ds_read_b128 a[40:43], v2 offset:2048
v_exp_f32 v46, v46
v_mfma_f32_16x16x32_bf16 v[252:255], a[60:63], v[60:63], v[252:255]
ds_read_b128 a[44:47], v2 offset:3072
s_add_u32 s101, s101, 0x2000
v_mfma_f32_16x16x32_bf16 v[220:223], a[60:63], v[56:59], v[220:223]
buffer_load_dwordx4 a[72:75], v3, s[88:91], s101 offen sc1
v_mfma_f32_16x16x32_bf16 a[232:235], a[240:243], v[56:59], a[232:235]
ds_read_b128 a[48:51], v2 offset:4096
v_cvt_pk_bf16_f32 v76, v28, v29
v_mfma_f32_16x16x32_bf16 a[236:239], a[240:243], v[60:63], a[236:239]
ds_read_b128 a[52:55], v2 offset:5120
s_waitcnt lgkmcnt(10)
v_cvt_pk_bf16_f32 v77, v30, v31
v_mfma_f32_16x16x32_bf16 v[28:31], a[0:3], a[208:211], v[120:123]
ds_read_b128 a[56:59], v2 offset:6144
v_cvt_pk_bf16_f32 v74, v40, v41
v_mfma_f32_16x16x32_bf16 v[28:31], a[4:7], a[212:215], v[28:31]
ds_read_b128 a[60:63], v2 offset:7168
v_cvt_pk_bf16_f32 v75, v42, v43
v_mfma_f32_16x16x32_bf16 v[28:31], a[8:11], a[216:219], v[28:31]
s_waitcnt lgkmcnt(8)
v_exp_f32 v47, v47
v_mfma_f32_16x16x32_bf16 v[28:31], a[12:15], a[220:223], v[28:31]
buffer_load_dwordx4 a[76:79], v3, s[88:91], s101 offen offset:1024 sc1
v_cvt_pk_bf16_f32 v78, v44, v45
v_cvt_pk_bf16_f32 v79, v46, v47
v_mfma_f32_16x16x32_bf16 v[44:47], a[16:19], a[208:211], v[124:127]
v_mfma_f32_16x16x32_bf16 v[44:47], a[20:23], a[212:215], v[44:47]
v_mfma_f32_16x16x32_bf16 v[44:47], a[24:27], a[216:219], v[44:47]
v_mfma_f32_16x16x32_bf16 v[44:47], a[28:31], a[220:223], v[44:47]
s_waitcnt lgkmcnt(0)
v_mfma_f32_16x16x32_bf16 v[192:195], a[32:35], v[72:75], v[192:195]
v_exp_f32 v28, v28
v_mfma_f32_16x16x32_bf16 v[224:227], a[32:35], v[76:79], v[224:227]
ds_read_b128 a[32:35], v2 offset:16384
s_add_u32 s101, s101, 0x2000
v_mfma_f32_16x16x32_bf16 v[228:231], a[36:39], v[76:79], v[228:231]
buffer_load_dwordx4 a[80:83], v3, s[88:91], s101 offen sc1
v_mfma_f32_16x16x32_bf16 v[196:199], a[36:39], v[72:75], v[196:199]
ds_read_b128 a[36:39], v2 offset:17408
v_exp_f32 v29, v29
v_mfma_f32_16x16x32_bf16 v[200:203], a[40:43], v[72:75], v[200:203]
v_exp_f32 v30, v30
v_mfma_f32_16x16x32_bf16 v[232:235], a[40:43], v[76:79], v[232:235]
ds_read_b128 a[40:43], v2 offset:18432
v_exp_f32 v31, v31
v_mfma_f32_16x16x32_bf16 v[236:239], a[44:47], v[76:79], v[236:239]
buffer_load_dwordx4 a[84:87], v3, s[88:91], s101 offen offset:1024 sc1
v_mfma_f32_16x16x32_bf16 v[204:207], a[44:47], v[72:75], v[204:207]
ds_read_b128 a[44:47], v2 offset:19456
v_exp_f32 v44, v44
v_mfma_f32_16x16x32_bf16 v[208:211], a[48:51], v[72:75], v[208:211]
v_exp_f32 v45, v45
v_mfma_f32_16x16x32_bf16 v[240:243], a[48:51], v[76:79], v[240:243]
ds_read_b128 a[48:51], v2 offset:20480
s_add_u32 s101, s101, 0x2000
v_mfma_f32_16x16x32_bf16 v[244:247], a[52:55], v[76:79], v[244:247]
buffer_load_dwordx4 a[88:91], v3, s[88:91], s101 offen sc1
v_mfma_f32_16x16x32_bf16 v[212:215], a[52:55], v[72:75], v[212:215]
ds_read_b128 a[52:55], v2 offset:21504
v_cvt_pk_bf16_f32 v60, v28, v29
v_mfma_f32_16x16x32_bf16 v[216:219], a[56:59], v[72:75], v[216:219]
v_exp_f32 v46, v46
v_mfma_f32_16x16x32_bf16 v[248:251], a[56:59], v[76:79], v[248:251]
ds_read_b128 a[56:59], v2 offset:22528
v_cvt_pk_bf16_f32 v61, v30, v31
v_mfma_f32_16x16x32_bf16 v[252:255], a[60:63], v[76:79], v[252:255]
buffer_load_dwordx4 a[92:95], v3, s[88:91], s101 offen offset:1024 sc1
v_mfma_f32_16x16x32_bf16 v[220:223], a[60:63], v[72:75], v[220:223]
ds_read_b128 a[60:63], v2 offset:23552
v_xor_b32 v2, 0x38000, v2
v_mfma_f32_16x16x32_bf16 a[232:235], a[240:243], v[72:75], a[232:235]
v_exp_f32 v47, v47
v_mfma_f32_16x16x32_bf16 a[236:239], a[240:243], v[76:79], a[236:239]
v_cvt_pk_bf16_f32 v62, v44, v45
v_cvt_pk_bf16_f32 v63, v46, v47
s_waitcnt  lgkmcnt(0)
s_barrier
v_mfma_f32_16x16x32_bf16 v[224:227], a[32:35], v[60:63], v[224:227]
v_mfma_f32_16x16x32_bf16 v[228:231], a[36:39], v[60:63], v[228:231]
v_mfma_f32_16x16x32_bf16 v[232:235], a[40:43], v[60:63], v[232:235]
v_mfma_f32_16x16x32_bf16 v[236:239], a[44:47], v[60:63], v[236:239]
v_mfma_f32_16x16x32_bf16 v[240:243], a[48:51], v[60:63], v[240:243]
v_mfma_f32_16x16x32_bf16 v[244:247], a[52:55], v[60:63], v[244:247]
v_mfma_f32_16x16x32_bf16 v[248:251], a[56:59], v[60:63], v[248:251]
v_mfma_f32_16x16x32_bf16 v[252:255], a[60:63], v[60:63], v[252:255]
v_mfma_f32_16x16x32_bf16 a[236:239], a[240:243], v[60:63], a[236:239]
s_waitcnt lgkmcnt(0)
v_xor_b32 v1, 0x8000, v1
L_att_fin:
s_nop 7
v_accvgpr_read_b32 v4, a232
v_accvgpr_read_b32 v6, a236
s_mov_b32 s8, 0x5f800000
v_cmp_nge_f32 s[36:37], s8, v4
v_cmp_nge_f32 s[38:39], s8, v6
v_rcp_f32 v4, v4
v_rcp_f32 v6, v6
s_or_b64 s[34:35], s[34:35], s[36:37]
s_or_b64 s[34:35], s[34:35], s[38:39]
v_pk_mul_f32 v[192:193], v[192:193], v[4:5] op_sel_hi:[1,0]
v_pk_mul_f32 v[194:195], v[194:195], v[4:5] op_sel_hi:[1,0]
v_pk_mul_f32 v[196:197], v[196:197], v[4:5] op_sel_hi:[1,0]
v_pk_mul_f32 v[198:199], v[198:199], v[4:5] op_sel_hi:[1,0]
v_cvt_pk_bf16_f32 v192, v192, v193
v_cvt_pk_bf16_f32 v193, v194, v195
v_cvt_pk_bf16_f32 v194, v196, v197
v_cvt_pk_bf16_f32 v195, v198, v199
s_add_u32 s8, s30, 0x0
buffer_store_dwordx4 v[192:195], v3, s[88:91], s8 offen sc1
v_pk_mul_f32 v[200:201], v[200:201], v[4:5] op_sel_hi:[1,0]
v_pk_mul_f32 v[202:203], v[202:203], v[4:5] op_sel_hi:[1,0]
v_pk_mul_f32 v[204:205], v[204:205], v[4:5] op_sel_hi:[1,0]
v_pk_mul_f32 v[206:207], v[206:207], v[4:5] op_sel_hi:[1,0]
v_cvt_pk_bf16_f32 v200, v200, v201
v_cvt_pk_bf16_f32 v201, v202, v203
v_cvt_pk_bf16_f32 v202, v204, v205
v_cvt_pk_bf16_f32 v203, v206, v207
s_add_u32 s8, s30, 0x2000
buffer_store_dwordx4 v[200:203], v3, s[88:91], s8 offen sc1
v_pk_mul_f32 v[208:209], v[208:209], v[4:5] op_sel_hi:[1,0]
v_pk_mul_f32 v[210:211], v[210:211], v[4:5] op_sel_hi:[1,0]
v_pk_mul_f32 v[212:213], v[212:213], v[4:5] op_sel_hi:[1,0]
v_pk_mul_f32 v[214:215], v[214:215], v[4:5] op_sel_hi:[1,0]
v_cvt_pk_bf16_f32 v208, v208, v209
v_cvt_pk_bf16_f32 v209, v210, v211
v_cvt_pk_bf16_f32 v210, v212, v213
v_cvt_pk_bf16_f32 v211, v214, v215
s_add_u32 s8, s30, 0x4000
buffer_store_dwordx4 v[208:211], v3, s[88:91], s8 offen sc1
v_pk_mul_f32 v[216:217], v[216:217], v[4:5] op_sel_hi:[1,0]
v_pk_mul_f32 v[218:219], v[218:219], v[4:5] op_sel_hi:[1,0]
v_pk_mul_f32 v[220:221], v[220:221], v[4:5] op_sel_hi:[1,0]
v_pk_mul_f32 v[222:223], v[222:223], v[4:5] op_sel_hi:[1,0]
v_cvt_pk_bf16_f32 v216, v216, v217
v_cvt_pk_bf16_f32 v217, v218, v219
v_cvt_pk_bf16_f32 v218, v220, v221
v_cvt_pk_bf16_f32 v219, v222, v223
s_add_u32 s8, s30, 0x6000
buffer_store_dwordx4 v[216:219], v3, s[88:91], s8 offen sc1
v_pk_mul_f32 v[224:225], v[224:225], v[6:7] op_sel_hi:[1,0]
v_pk_mul_f32 v[226:227], v[226:227], v[6:7] op_sel_hi:[1,0]
v_pk_mul_f32 v[228:229], v[228:229], v[6:7] op_sel_hi:[1,0]
v_pk_mul_f32 v[230:231], v[230:231], v[6:7] op_sel_hi:[1,0]
v_cvt_pk_bf16_f32 v224, v224, v225
v_cvt_pk_bf16_f32 v225, v226, v227
v_cvt_pk_bf16_f32 v226, v228, v229
v_cvt_pk_bf16_f32 v227, v230, v231
s_add_u32 s8, s31, 0x0
buffer_store_dwordx4 v[224:227], v3, s[88:91], s8 offen sc1
v_pk_mul_f32 v[232:233], v[232:233], v[6:7] op_sel_hi:[1,0]
v_pk_mul_f32 v[234:235], v[234:235], v[6:7] op_sel_hi:[1,0]
v_pk_mul_f32 v[236:237], v[236:237], v[6:7] op_sel_hi:[1,0]
v_pk_mul_f32 v[238:239], v[238:239], v[6:7] op_sel_hi:[1,0]
v_cvt_pk_bf16_f32 v232, v232, v233
v_cvt_pk_bf16_f32 v233, v234, v235
v_cvt_pk_bf16_f32 v234, v236, v237
v_cvt_pk_bf16_f32 v235, v238, v239
s_add_u32 s8, s31, 0x2000
buffer_store_dwordx4 v[232:235], v3, s[88:91], s8 offen sc1
v_pk_mul_f32 v[240:241], v[240:241], v[6:7] op_sel_hi:[1,0]
v_pk_mul_f32 v[242:243], v[242:243], v[6:7] op_sel_hi:[1,0]
v_pk_mul_f32 v[244:245], v[244:245], v[6:7] op_sel_hi:[1,0]
v_pk_mul_f32 v[246:247], v[246:247], v[6:7] op_sel_hi:[1,0]
v_cvt_pk_bf16_f32 v240, v240, v241
v_cvt_pk_bf16_f32 v241, v242, v243
v_cvt_pk_bf16_f32 v242, v244, v245
v_cvt_pk_bf16_f32 v243, v246, v247
s_add_u32 s8, s31, 0x4000
buffer_store_dwordx4 v[240:243], v3, s[88:91], s8 offen sc1
v_pk_mul_f32 v[248:249], v[248:249], v[6:7] op_sel_hi:[1,0]
v_pk_mul_f32 v[250:251], v[250:251], v[6:7] op_sel_hi:[1,0]
v_pk_mul_f32 v[252:253], v[252:253], v[6:7] op_sel_hi:[1,0]
v_pk_mul_f32 v[254:255], v[254:255], v[6:7] op_sel_hi:[1,0]
v_cvt_pk_bf16_f32 v248, v248, v249
v_cvt_pk_bf16_f32 v249, v250, v251
v_cvt_pk_bf16_f32 v250, v252, v253
v_cvt_pk_bf16_f32 v251, v254, v255
s_add_u32 s8, s31, 0x6000
buffer_store_dwordx4 v[248:251], v3, s[88:91], s8 offen sc1
s_cmp_lg_u64 s[34:35], 0
s_cselect_b32 s8, 1, 0
s_lshl_b32 s9, s4, 2
s_add_u32 s9, s9, 131072
v_mov_b32 v4, s9
v_mov_b32 v5, s8
ds_write_b32 v4, v5
v_lshrrev_b32 v17, 4, v0
v_lshlrev_b32 v18, 10, v17
v_and_b32 v17, 1, v17
v_lshl_add_u32 v18, v17, 5, v18
v_bfe_u32 v17, v0, 2, 2
v_lshl_add_u32 v18, v17, 6, v18
v_and_b32 v17, 3, v0
v_lshl_add_u32 v4, v17, 3, v18
v_add_u32 v4, 65536, v4
v_xor_b32 v5, 32, v4
v_and_b32 v20, 15, v0
v_lshlrev_b32 v20, 2, v20
s_waitcnt vmcnt(12) lgkmcnt(0)
s_barrier
v_and_b32 v17, 3, v0
v_lshlrev_b32 v17, 2, v17
v_add_u32 v17, 131072, v17
ds_read_b32 v18, v17
s_waitcnt lgkmcnt(0)
v_cmp_ne_u32 vcc, 0, v18
s_cmp_lg_u32 s33, 0
s_cbranch_scc1 L_att_done
s_nop 4
s_cbranch_vccnz L_att_fallback
L_att_done:
ds_read_b64_tr_b16 v[152:153], v4 offset:0
ds_read_b64_tr_b16 v[154:155], v4 offset:4096
ds_read_b64_tr_b16 v[156:157], v5 offset:0
ds_read_b64_tr_b16 v[158:159], v5 offset:4096
ds_read_b64_tr_b16 v[160:161], v4 offset:256
ds_read_b64_tr_b16 v[162:163], v4 offset:4352
ds_read_b64_tr_b16 v[164:165], v5 offset:256
ds_read_b64_tr_b16 v[166:167], v5 offset:4352
ds_read_b64_tr_b16 v[168:169], v4 offset:512
ds_read_b64_tr_b16 v[170:171], v4 offset:4608
ds_read_b64_tr_b16 v[172:173], v5 offset:512
ds_read_b64_tr_b16 v[174:175], v5 offset:4608
ds_read_b64_tr_b16 v[176:177], v4 offset:768
ds_read_b64_tr_b16 v[178:179], v4 offset:4864
ds_read_b64_tr_b16 v[180:181], v5 offset:768
ds_read_b64_tr_b16 v[182:183], v5 offset:4864
s_add_u32 m0, s17, 0x18000
v_add_u32 v12, 0x20000, v12
s_nop 0
buffer_load_dwordx4 v12, s[72:75], 0 offen lds
v_add_u32 v13, 0x20000, v13
s_nop 0
buffer_load_dwordx4 v13, s[72:75], 0 offen offset:1024 lds
buffer_load_dwordx4 v12, s[72:75], s12 offen offset:2048 lds
buffer_load_dwordx4 v13, s[72:75], s12 offen offset:3072 lds
s_waitcnt lgkmcnt(8)
v_mfma_f32_16x16x32_bf16 v[24:27], v[152:155], a[64:67], 0
ds_read_b64_tr_b16 v[184:185], v4 offset:8192
ds_read_b64_tr_b16 v[186:187], v4 offset:12288
v_mfma_f32_16x16x32_bf16 v[40:43], v[152:155], a[68:71], 0
ds_read_b64_tr_b16 v[188:189], v5 offset:8192
v_mfma_f32_16x16x32_bf16 v[44:47], v[156:159], a[68:71], 0
ds_read_b64_tr_b16 v[190:191], v5 offset:12288
s_add_u32 s101, s101, 0x2000
v_mfma_f32_16x16x32_bf16 v[28:31], v[156:159], a[64:67], 0
buffer_load_dwordx4 a[96:99], v3, s[88:91], s101 offen sc1
v_mfma_f32_16x16x32_bf16 v[32:35], v[160:163], a[64:67], 0
ds_read_b64_tr_b16 v[192:193], v4 offset:8448
ds_read_b64_tr_b16 v[194:195], v4 offset:12544
v_mfma_f32_16x16x32_bf16 v[48:51], v[160:163], a[68:71], 0
ds_read_b64_tr_b16 v[196:197], v5 offset:8448
v_mfma_f32_16x16x32_bf16 v[52:55], v[164:167], a[68:71], 0
ds_read_b64_tr_b16 v[198:199], v5 offset:12544
s_waitcnt lgkmcnt(8)
v_mfma_f32_16x16x32_bf16 v[36:39], v[164:167], a[64:67], 0
buffer_load_dwordx4 a[100:103], v3, s[88:91], s101 offen offset:1024 sc1
v_mfma_f32_16x16x32_bf16 v[56:59], v[168:171], a[64:67], 0
ds_read_b64_tr_b16 v[200:201], v4 offset:8704
ds_read_b64_tr_b16 v[202:203], v4 offset:12800
v_mfma_f32_16x16x32_bf16 v[72:75], v[168:171], a[68:71], 0
ds_read_b64_tr_b16 v[204:205], v5 offset:8704
v_mfma_f32_16x16x32_bf16 v[76:79], v[172:175], a[68:71], 0
ds_read_b64_tr_b16 v[206:207], v5 offset:12800
s_add_u32 s101, s101, 0x2000
v_mfma_f32_16x16x32_bf16 v[60:63], v[172:175], a[64:67], 0
buffer_load_dwordx4 a[104:107], v3, s[88:91], s101 offen sc1
v_mfma_f32_16x16x32_bf16 v[64:67], v[176:179], a[64:67], 0
ds_read_b64_tr_b16 v[208:209], v4 offset:8960
ds_read_b64_tr_b16 v[210:211], v4 offset:13056
v_mfma_f32_16x16x32_bf16 v[80:83], v[176:179], a[68:71], 0
ds_read_b64_tr_b16 v[212:213], v5 offset:8960
s_waitcnt vmcnt(15) lgkmcnt(7)
v_mfma_f32_16x16x32_bf16 v[84:87], v[180:183], a[68:71], 0
ds_read_b64_tr_b16 v[214:215], v5 offset:13056
s_barrier
v_mfma_f32_16x16x32_bf16 v[68:71], v[180:183], a[64:67], 0
buffer_load_dwordx4 a[108:111], v3, s[88:91], s101 offen offset:1024 sc1
v_mfma_f32_16x16x32_bf16 v[24:27], v[184:187], a[72:75], v[24:27]
ds_read_b64_tr_b16 v[152:153], v4 offset:16384
ds_read_b64_tr_b16 v[154:155], v4 offset:20480
v_mfma_f32_16x16x32_bf16 v[40:43], v[184:187], a[76:79], v[40:43]
ds_read_b64_tr_b16 v[156:157], v5 offset:16384
v_add_u32 v12, 0x20000, v12
v_mfma_f32_16x16x32_bf16 v[44:47], v[188:191], a[76:79], v[44:47]
ds_read_b64_tr_b16 v[158:159], v5 offset:20480
s_add_u32 m0, s17, 0x1c000
v_mfma_f32_16x16x32_bf16 v[28:31], v[188:191], a[72:75], v[28:31]
buffer_load_dwordx4 v12, s[72:75], 0 offen lds
v_mfma_f32_16x16x32_bf16 v[32:35], v[192:195], a[72:75], v[32:35]
ds_read_b64_tr_b16 v[160:161], v4 offset:16640
ds_read_b64_tr_b16 v[162:163], v4 offset:20736
v_mfma_f32_16x16x32_bf16 v[48:51], v[192:195], a[76:79], v[48:51]
ds_read_b64_tr_b16 v[164:165], v5 offset:16640
v_add_u32 v13, 0x20000, v13
v_mfma_f32_16x16x32_bf16 v[52:55], v[196:199], a[76:79], v[52:55]
ds_read_b64_tr_b16 v[166:167], v5 offset:20736
s_waitcnt lgkmcnt(8)
v_mfma_f32_16x16x32_bf16 v[36:39], v[196:199], a[72:75], v[36:39]
buffer_load_dwordx4 v13, s[72:75], 0 offen offset:1024 lds
v_mfma_f32_16x16x32_bf16 v[56:59], v[200:203], a[72:75], v[56:59]
ds_read_b64_tr_b16 v[168:169], v4 offset:16896
ds_read_b64_tr_b16 v[170:171], v4 offset:20992
v_mfma_f32_16x16x32_bf16 v[72:75], v[200:203], a[76:79], v[72:75]
ds_read_b64_tr_b16 v[172:173], v5 offset:16896
v_mfma_f32_16x16x32_bf16 v[76:79], v[204:207], a[76:79], v[76:79]
ds_read_b64_tr_b16 v[174:175], v5 offset:20992
v_mfma_f32_16x16x32_bf16 v[60:63], v[204:207], a[72:75], v[60:63]
buffer_load_dwordx4 v12, s[72:75], s12 offen offset:2048 lds
v_mfma_f32_16x16x32_bf16 v[64:67], v[208:211], a[72:75], v[64:67]
ds_read_b64_tr_b16 v[176:177], v4 offset:17152
ds_read_b64_tr_b16 v[178:179], v4 offset:21248
v_mfma_f32_16x16x32_bf16 v[80:83], v[208:211], a[76:79], v[80:83]
ds_read_b64_tr_b16 v[180:181], v5 offset:17152
s_waitcnt lgkmcnt(7)
v_mfma_f32_16x16x32_bf16 v[84:87], v[212:215], a[76:79], v[84:87]
ds_read_b64_tr_b16 v[182:183], v5 offset:21248
v_mfma_f32_16x16x32_bf16 v[68:71], v[212:215], a[72:75], v[68:71]
buffer_load_dwordx4 v13, s[72:75], s12 offen offset:3072 lds
v_mfma_f32_16x16x32_bf16 v[24:27], v[152:155], a[80:83], v[24:27]
ds_read_b64_tr_b16 v[184:185], v4 offset:24576
ds_read_b64_tr_b16 v[186:187], v4 offset:28672
v_mfma_f32_16x16x32_bf16 v[40:43], v[152:155], a[84:87], v[40:43]
ds_read_b64_tr_b16 v[188:189], v5 offset:24576
v_mfma_f32_16x16x32_bf16 v[44:47], v[156:159], a[84:87], v[44:47]
ds_read_b64_tr_b16 v[190:191], v5 offset:28672
s_add_u32 s101, s101, 0x2000
v_mfma_f32_16x16x32_bf16 v[28:31], v[156:159], a[80:83], v[28:31]
buffer_load_dwordx4 a[112:115], v3, s[88:91], s101 offen sc1
v_mfma_f32_16x16x32_bf16 v[32:35], v[160:163], a[80:83], v[32:35]
ds_read_b64_tr_b16 v[192:193], v4 offset:24832
ds_read_b64_tr_b16 v[194:195], v4 offset:28928
v_mfma_f32_16x16x32_bf16 v[48:51], v[160:163], a[84:87], v[48:51]
ds_read_b64_tr_b16 v[196:197], v5 offset:24832
v_mfma_f32_16x16x32_bf16 v[52:55], v[164:167], a[84:87], v[52:55]
ds_read_b64_tr_b16 v[198:199], v5 offset:28928
s_waitcnt lgkmcnt(8)
v_mfma_f32_16x16x32_bf16 v[36:39], v[164:167], a[80:83], v[36:39]
buffer_load_dwordx4 a[116:119], v3, s[88:91], s101 offen offset:1024 sc1
v_mfma_f32_16x16x32_bf16 v[56:59], v[168:171], a[80:83], v[56:59]
ds_read_b64_tr_b16 v[200:201], v4 offset:25088
ds_read_b64_tr_b16 v[202:203], v4 offset:29184
v_mfma_f32_16x16x32_bf16 v[72:75], v[168:171], a[84:87], v[72:75]
ds_read_b64_tr_b16 v[204:205], v5 offset:25088
v_mfma_f32_16x16x32_bf16 v[76:79], v[172:175], a[84:87], v[76:79]
ds_read_b64_tr_b16 v[206:207], v5 offset:29184
s_add_u32 s101, s101, 0x2000
v_mfma_f32_16x16x32_bf16 v[60:63], v[172:175], a[80:83], v[60:63]
buffer_load_dwordx4 a[120:123], v3, s[88:91], s101 offen sc1
v_mfma_f32_16x16x32_bf16 v[64:67], v[176:179], a[80:83], v[64:67]
ds_read_b64_tr_b16 v[208:209], v4 offset:25344
ds_read_b64_tr_b16 v[210:211], v4 offset:29440
v_mfma_f32_16x16x32_bf16 v[80:83], v[176:179], a[84:87], v[80:83]
ds_read_b64_tr_b16 v[212:213], v5 offset:25344
s_waitcnt vmcnt(7) lgkmcnt(7)
v_mfma_f32_16x16x32_bf16 v[84:87], v[180:183], a[84:87], v[84:87]
ds_read_b64_tr_b16 v[214:215], v5 offset:29440
s_barrier
v_mfma_f32_16x16x32_bf16 v[68:71], v[180:183], a[80:83], v[68:71]
buffer_load_dwordx4 a[124:127], v3, s[88:91], s101 offen offset:1024 sc1
s_cmp_lg_u32 s4, 0
s_cbranch_scc1 L_flag_set
s_lshl_b32 s8, s6, 5
s_add_u32 s8, s8, s5
s_lshl_b32 s8, s8, 2
s_add_u32 s8, s8, 0x3604000
v_mov_b32 v17, 1
s_mov_b64 exec, 1
buffer_store_dword v17, off, s[88:91], s8 sc1
s_mov_b64 exec, -1
L_flag_set:
v_mfma_f32_16x16x32_bf16 v[24:27], v[184:187], a[88:91], v[24:27]
ds_read_b64_tr_b16 v[152:153], v4 offset:32768
ds_read_b64_tr_b16 v[154:155], v4 offset:36864
v_mfma_f32_16x16x32_bf16 v[40:43], v[184:187], a[92:95], v[40:43]
ds_read_b64_tr_b16 v[156:157], v5 offset:32768
v_add_u32 v12, 0x20000, v12
v_mfma_f32_16x16x32_bf16 v[44:47], v[188:191], a[92:95], v[44:47]
ds_read_b64_tr_b16 v[158:159], v5 offset:36864
s_add_u32 m0, s17, 0x10000
v_mfma_f32_16x16x32_bf16 v[28:31], v[188:191], a[88:91], v[28:31]
buffer_load_dwordx4 v12, s[72:75], 0 offen lds
v_mfma_f32_16x16x32_bf16 v[32:35], v[192:195], a[88:91], v[32:35]
ds_read_b64_tr_b16 v[160:161], v4 offset:33024
ds_read_b64_tr_b16 v[162:163], v4 offset:37120
v_mfma_f32_16x16x32_bf16 v[48:51], v[192:195], a[92:95], v[48:51]
ds_read_b64_tr_b16 v[164:165], v5 offset:33024
v_add_u32 v13, 0x20000, v13
v_mfma_f32_16x16x32_bf16 v[52:55], v[196:199], a[92:95], v[52:55]
ds_read_b64_tr_b16 v[166:167], v5 offset:37120
s_waitcnt lgkmcnt(8)
v_mfma_f32_16x16x32_bf16 v[36:39], v[196:199], a[88:91], v[36:39]
buffer_load_dwordx4 v13, s[72:75], 0 offen offset:1024 lds
v_mfma_f32_16x16x32_bf16 v[56:59], v[200:203], a[88:91], v[56:59]
ds_read_b64_tr_b16 v[168:169], v4 offset:33280
ds_read_b64_tr_b16 v[170:171], v4 offset:37376
v_mfma_f32_16x16x32_bf16 v[72:75], v[200:203], a[92:95], v[72:75]
ds_read_b64_tr_b16 v[172:173], v5 offset:33280
v_mfma_f32_16x16x32_bf16 v[76:79], v[204:207], a[92:95], v[76:79]
ds_read_b64_tr_b16 v[174:175], v5 offset:37376
v_mfma_f32_16x16x32_bf16 v[60:63], v[204:207], a[88:91], v[60:63]
buffer_load_dwordx4 v12, s[72:75], s12 offen offset:2048 lds
v_mfma_f32_16x16x32_bf16 v[64:67], v[208:211], a[88:91], v[64:67]
ds_read_b64_tr_b16 v[176:177], v4 offset:33536
ds_read_b64_tr_b16 v[178:179], v4 offset:37632
v_mfma_f32_16x16x32_bf16 v[80:83], v[208:211], a[92:95], v[80:83]
ds_read_b64_tr_b16 v[180:181], v5 offset:33536
s_waitcnt lgkmcnt(7)
v_mfma_f32_16x16x32_bf16 v[84:87], v[212:215], a[92:95], v[84:87]
ds_read_b64_tr_b16 v[182:183], v5 offset:37632
v_mfma_f32_16x16x32_bf16 v[68:71], v[212:215], a[88:91], v[68:71]
buffer_load_dwordx4 v13, s[72:75], s12 offen offset:3072 lds
v_mfma_f32_16x16x32_bf16 v[24:27], v[152:155], a[96:99], v[24:27]
ds_read_b64_tr_b16 v[184:185], v4 offset:40960
ds_read_b64_tr_b16 v[186:187], v4 offset:45056
v_mfma_f32_16x16x32_bf16 v[40:43], v[152:155], a[100:103], v[40:43]
ds_read_b64_tr_b16 v[188:189], v5 offset:40960
v_mfma_f32_16x16x32_bf16 v[44:47], v[156:159], a[100:103], v[44:47]
ds_read_b64_tr_b16 v[190:191], v5 offset:45056
s_add_u32 s101, s101, 0x2000
v_mfma_f32_16x16x32_bf16 v[28:31], v[156:159], a[96:99], v[28:31]
buffer_load_dwordx4 a[64:67], v3, s[88:91], s101 offen sc1
v_mfma_f32_16x16x32_bf16 v[32:35], v[160:163], a[96:99], v[32:35]
ds_read_b64_tr_b16 v[192:193], v4 offset:41216
ds_read_b64_tr_b16 v[194:195], v4 offset:45312
v_mfma_f32_16x16x32_bf16 v[48:51], v[160:163], a[100:103], v[48:51]
ds_read_b64_tr_b16 v[196:197], v5 offset:41216
v_mfma_f32_16x16x32_bf16 v[52:55], v[164:167], a[100:103], v[52:55]
ds_read_b64_tr_b16 v[198:199], v5 offset:45312
s_waitcnt lgkmcnt(8)
v_mfma_f32_16x16x32_bf16 v[36:39], v[164:167], a[96:99], v[36:39]
buffer_load_dwordx4 a[68:71], v3, s[88:91], s101 offen offset:1024 sc1
v_mfma_f32_16x16x32_bf16 v[56:59], v[168:171], a[96:99], v[56:59]
ds_read_b64_tr_b16 v[200:201], v4 offset:41472
ds_read_b64_tr_b16 v[202:203], v4 offset:45568
v_mfma_f32_16x16x32_bf16 v[72:75], v[168:171], a[100:103], v[72:75]
ds_read_b64_tr_b16 v[204:205], v5 offset:41472
v_mfma_f32_16x16x32_bf16 v[76:79], v[172:175], a[100:103], v[76:79]
ds_read_b64_tr_b16 v[206:207], v5 offset:45568
s_add_u32 s101, s101, 0x2000
v_mfma_f32_16x16x32_bf16 v[60:63], v[172:175], a[96:99], v[60:63]
buffer_load_dwordx4 a[72:75], v3, s[88:91], s101 offen sc1
v_mfma_f32_16x16x32_bf16 v[64:67], v[176:179], a[96:99], v[64:67]
ds_read_b64_tr_b16 v[208:209], v4 offset:41728
ds_read_b64_tr_b16 v[210:211], v4 offset:45824
v_mfma_f32_16x16x32_bf16 v[80:83], v[176:179], a[100:103], v[80:83]
ds_read_b64_tr_b16 v[212:213], v5 offset:41728
s_waitcnt vmcnt(7) lgkmcnt(7)
v_mfma_f32_16x16x32_bf16 v[84:87], v[180:183], a[100:103], v[84:87]
ds_read_b64_tr_b16 v[214:215], v5 offset:45824
s_barrier
v_mfma_f32_16x16x32_bf16 v[68:71], v[180:183], a[96:99], v[68:71]
buffer_load_dwordx4 a[76:79], v3, s[88:91], s101 offen offset:1024 sc1
v_mfma_f32_16x16x32_bf16 v[24:27], v[184:187], a[104:107], v[24:27]
ds_read_b64_tr_b16 v[152:153], v4 offset:49152
ds_read_b64_tr_b16 v[154:155], v4 offset:53248
v_mfma_f32_16x16x32_bf16 v[40:43], v[184:187], a[108:111], v[40:43]
ds_read_b64_tr_b16 v[156:157], v5 offset:49152
v_add_u32 v12, 0x20000, v12
v_mfma_f32_16x16x32_bf16 v[44:47], v[188:191], a[108:111], v[44:47]
ds_read_b64_tr_b16 v[158:159], v5 offset:53248
s_add_u32 m0, s17, 0x14000
v_mfma_f32_16x16x32_bf16 v[28:31], v[188:191], a[104:107], v[28:31]
buffer_load_dwordx4 v12, s[72:75], 0 offen lds
v_mfma_f32_16x16x32_bf16 v[32:35], v[192:195], a[104:107], v[32:35]
ds_read_b64_tr_b16 v[160:161], v4 offset:49408
ds_read_b64_tr_b16 v[162:163], v4 offset:53504
v_mfma_f32_16x16x32_bf16 v[48:51], v[192:195], a[108:111], v[48:51]
ds_read_b64_tr_b16 v[164:165], v5 offset:49408
v_add_u32 v13, 0x20000, v13
v_mfma_f32_16x16x32_bf16 v[52:55], v[196:199], a[108:111], v[52:55]
ds_read_b64_tr_b16 v[166:167], v5 offset:53504
s_waitcnt lgkmcnt(8)
v_mfma_f32_16x16x32_bf16 v[36:39], v[196:199], a[104:107], v[36:39]
buffer_load_dwordx4 v13, s[72:75], 0 offen offset:1024 lds
v_mfma_f32_16x16x32_bf16 v[56:59], v[200:203], a[104:107], v[56:59]
ds_read_b64_tr_b16 v[168:169], v4 offset:49664
ds_read_b64_tr_b16 v[170:171], v4 offset:53760
v_mfma_f32_16x16x32_bf16 v[72:75], v[200:203], a[108:111], v[72:75]
ds_read_b64_tr_b16 v[172:173], v5 offset:49664
v_mfma_f32_16x16x32_bf16 v[76:79], v[204:207], a[108:111], v[76:79]
ds_read_b64_tr_b16 v[174:175], v5 offset:53760
v_mfma_f32_16x16x32_bf16 v[60:63], v[204:207], a[104:107], v[60:63]
buffer_load_dwordx4 v12, s[72:75], s12 offen offset:2048 lds
v_mfma_f32_16x16x32_bf16 v[64:67], v[208:211], a[104:107], v[64:67]
ds_read_b64_tr_b16 v[176:177], v4 offset:49920
ds_read_b64_tr_b16 v[178:179], v4 offset:54016
v_mfma_f32_16x16x32_bf16 v[80:83], v[208:211], a[108:111], v[80:83]
ds_read_b64_tr_b16 v[180:181], v5 offset:49920
s_waitcnt lgkmcnt(7)
v_mfma_f32_16x16x32_bf16 v[84:87], v[212:215], a[108:111], v[84:87]
ds_read_b64_tr_b16 v[182:183], v5 offset:54016
v_mfma_f32_16x16x32_bf16 v[68:71], v[212:215], a[104:107], v[68:71]
buffer_load_dwordx4 v13, s[72:75], s12 offen offset:3072 lds
v_mfma_f32_16x16x32_bf16 v[24:27], v[152:155], a[112:115], v[24:27]
ds_read_b64_tr_b16 v[184:185], v4 offset:57344
ds_read_b64_tr_b16 v[186:187], v4 offset:61440
v_mfma_f32_16x16x32_bf16 v[40:43], v[152:155], a[116:119], v[40:43]
ds_read_b64_tr_b16 v[188:189], v5 offset:57344
v_mfma_f32_16x16x32_bf16 v[44:47], v[156:159], a[116:119], v[44:47]
ds_read_b64_tr_b16 v[190:191], v5 offset:61440
s_add_u32 s101, s101, 0x2000
v_mfma_f32_16x16x32_bf16 v[28:31], v[156:159], a[112:115], v[28:31]
buffer_load_dwordx4 a[80:83], v3, s[88:91], s101 offen sc1
v_mfma_f32_16x16x32_bf16 v[32:35], v[160:163], a[112:115], v[32:35]
ds_read_b64_tr_b16 v[192:193], v4 offset:57600
ds_read_b64_tr_b16 v[194:195], v4 offset:61696
v_mfma_f32_16x16x32_bf16 v[48:51], v[160:163], a[116:119], v[48:51]
ds_read_b64_tr_b16 v[196:197], v5 offset:57600
v_mfma_f32_16x16x32_bf16 v[52:55], v[164:167], a[116:119], v[52:55]
ds_read_b64_tr_b16 v[198:199], v5 offset:61696
s_waitcnt lgkmcnt(8)
v_mfma_f32_16x16x32_bf16 v[36:39], v[164:167], a[112:115], v[36:39]
buffer_load_dwordx4 a[84:87], v3, s[88:91], s101 offen offset:1024 sc1
v_mfma_f32_16x16x32_bf16 v[56:59], v[168:171], a[112:115], v[56:59]
ds_read_b64_tr_b16 v[200:201], v4 offset:57856
ds_read_b64_tr_b16 v[202:203], v4 offset:61952
v_mfma_f32_16x16x32_bf16 v[72:75], v[168:171], a[116:119], v[72:75]
ds_read_b64_tr_b16 v[204:205], v5 offset:57856
v_mfma_f32_16x16x32_bf16 v[76:79], v[172:175], a[116:119], v[76:79]
ds_read_b64_tr_b16 v[206:207], v5 offset:61952
s_add_u32 s101, s101, 0x2000
v_mfma_f32_16x16x32_bf16 v[60:63], v[172:175], a[112:115], v[60:63]
buffer_load_dwordx4 a[88:91], v3, s[88:91], s101 offen sc1
v_mfma_f32_16x16x32_bf16 v[64:67], v[176:179], a[112:115], v[64:67]
ds_read_b64_tr_b16 v[208:209], v4 offset:58112
ds_read_b64_tr_b16 v[210:211], v4 offset:62208
v_mfma_f32_16x16x32_bf16 v[80:83], v[176:179], a[116:119], v[80:83]
ds_read_b64_tr_b16 v[212:213], v5 offset:58112
s_waitcnt vmcnt(7) lgkmcnt(7)
v_mfma_f32_16x16x32_bf16 v[84:87], v[180:183], a[116:119], v[84:87]
ds_read_b64_tr_b16 v[214:215], v5 offset:62208
s_barrier
v_mfma_f32_16x16x32_bf16 v[68:71], v[180:183], a[112:115], v[68:71]
buffer_load_dwordx4 a[92:95], v3, s[88:91], s101 offen offset:1024 sc1
v_mfma_f32_16x16x32_bf16 v[24:27], v[184:187], a[120:123], v[24:27]
ds_read_b64_tr_b16 v[152:153], v4 offset:0
ds_read_b64_tr_b16 v[154:155], v4 offset:4096
v_mfma_f32_16x16x32_bf16 v[40:43], v[184:187], a[124:127], v[40:43]
ds_read_b64_tr_b16 v[156:157], v5 offset:0
v_add_u32 v12, 0x20000, v12
v_mfma_f32_16x16x32_bf16 v[44:47], v[188:191], a[124:127], v[44:47]
ds_read_b64_tr_b16 v[158:159], v5 offset:4096
s_add_u32 m0, s17, 0x18000
v_mfma_f32_16x16x32_bf16 v[28:31], v[188:191], a[120:123], v[28:31]
buffer_load_dwordx4 v12, s[72:75], 0 offen lds
v_mfma_f32_16x16x32_bf16 v[32:35], v[192:195], a[120:123], v[32:35]
ds_read_b64_tr_b16 v[160:161], v4 offset:256
ds_read_b64_tr_b16 v[162:163], v4 offset:4352
v_mfma_f32_16x16x32_bf16 v[48:51], v[192:195], a[124:127], v[48:51]
ds_read_b64_tr_b16 v[164:165], v5 offset:256
v_add_u32 v13, 0x20000, v13
v_mfma_f32_16x16x32_bf16 v[52:55], v[196:199], a[124:127], v[52:55]
ds_read_b64_tr_b16 v[166:167], v5 offset:4352
s_waitcnt lgkmcnt(8)
v_mfma_f32_16x16x32_bf16 v[36:39], v[196:199], a[120:123], v[36:39]
buffer_load_dwordx4 v13, s[72:75], 0 offen offset:1024 lds
v_mfma_f32_16x16x32_bf16 v[56:59], v[200:203], a[120:123], v[56:59]
ds_read_b64_tr_b16 v[168:169], v4 offset:512
ds_read_b64_tr_b16 v[170:171], v4 offset:4608
v_mfma_f32_16x16x32_bf16 v[72:75], v[200:203], a[124:127], v[72:75]
ds_read_b64_tr_b16 v[172:173], v5 offset:512
v_mfma_f32_16x16x32_bf16 v[76:79], v[204:207], a[124:127], v[76:79]
ds_read_b64_tr_b16 v[174:175], v5 offset:4608
v_mfma_f32_16x16x32_bf16 v[60:63], v[204:207], a[120:123], v[60:63]
buffer_load_dwordx4 v12, s[72:75], s12 offen offset:2048 lds
v_mfma_f32_16x16x32_bf16 v[64:67], v[208:211], a[120:123], v[64:67]
ds_read_b64_tr_b16 v[176:177], v4 offset:768
ds_read_b64_tr_b16 v[178:179], v4 offset:4864
v_mfma_f32_16x16x32_bf16 v[80:83], v[208:211], a[124:127], v[80:83]
ds_read_b64_tr_b16 v[180:181], v5 offset:768
s_waitcnt lgkmcnt(7)
v_mfma_f32_16x16x32_bf16 v[84:87], v[212:215], a[124:127], v[84:87]
ds_read_b64_tr_b16 v[182:183], v5 offset:4864
v_mfma_f32_16x16x32_bf16 v[68:71], v[212:215], a[120:123], v[68:71]
buffer_load_dwordx4 v13, s[72:75], s12 offen offset:3072 lds
v_mfma_f32_16x16x32_bf16 v[24:27], v[152:155], a[64:67], v[24:27]
ds_read_b64_tr_b16 v[184:185], v4 offset:8192
ds_read_b64_tr_b16 v[186:187], v4 offset:12288
v_mfma_f32_16x16x32_bf16 v[40:43], v[152:155], a[68:71], v[40:43]
ds_read_b64_tr_b16 v[188:189], v5 offset:8192
v_mfma_f32_16x16x32_bf16 v[44:47], v[156:159], a[68:71], v[44:47]
ds_read_b64_tr_b16 v[190:191], v5 offset:12288
s_add_u32 s101, s101, 0x2000
v_mfma_f32_16x16x32_bf16 v[28:31], v[156:159], a[64:67], v[28:31]
buffer_load_dwordx4 a[96:99], v3, s[88:91], s101 offen sc1
v_mfma_f32_16x16x32_bf16 v[32:35], v[160:163], a[64:67], v[32:35]
ds_read_b64_tr_b16 v[192:193], v4 offset:8448
ds_read_b64_tr_b16 v[194:195], v4 offset:12544
v_mfma_f32_16x16x32_bf16 v[48:51], v[160:163], a[68:71], v[48:51]
ds_read_b64_tr_b16 v[196:197], v5 offset:8448
v_mfma_f32_16x16x32_bf16 v[52:55], v[164:167], a[68:71], v[52:55]
ds_read_b64_tr_b16 v[198:199], v5 offset:12544
s_waitcnt lgkmcnt(8)
v_mfma_f32_16x16x32_bf16 v[36:39], v[164:167], a[64:67], v[36:39]
buffer_load_dwordx4 a[100:103], v3, s[88:91], s101 offen offset:1024 sc1
v_mfma_f32_16x16x32_bf16 v[56:59], v[168:171], a[64:67], v[56:59]
ds_read_b64_tr_b16 v[200:201], v4 offset:8704
ds_read_b64_tr_b16 v[202:203], v4 offset:12800
v_mfma_f32_16x16x32_bf16 v[72:75], v[168:171], a[68:71], v[72:75]
ds_read_b64_tr_b16 v[204:205], v5 offset:8704
v_mfma_f32_16x16x32_bf16 v[76:79], v[172:175], a[68:71], v[76:79]
ds_read_b64_tr_b16 v[206:207], v5 offset:12800
s_add_u32 s101, s101, 0x2000
v_mfma_f32_16x16x32_bf16 v[60:63], v[172:175], a[64:67], v[60:63]
buffer_load_dwordx4 a[104:107], v3, s[88:91], s101 offen sc1
v_mfma_f32_16x16x32_bf16 v[64:67], v[176:179], a[64:67], v[64:67]
ds_read_b64_tr_b16 v[208:209], v4 offset:8960
ds_read_b64_tr_b16 v[210:211], v4 offset:13056
v_mfma_f32_16x16x32_bf16 v[80:83], v[176:179], a[68:71], v[80:83]
ds_read_b64_tr_b16 v[212:213], v5 offset:8960
s_waitcnt vmcnt(7) lgkmcnt(7)
v_mfma_f32_16x16x32_bf16 v[84:87], v[180:183], a[68:71], v[84:87]
ds_read_b64_tr_b16 v[214:215], v5 offset:13056
s_barrier
v_mfma_f32_16x16x32_bf16 v[68:71], v[180:183], a[64:67], v[68:71]
buffer_load_dwordx4 a[108:111], v3, s[88:91], s101 offen offset:1024 sc1
buffer_load_dword v14, v20, s[88:91], s11 offen sc1
v_mfma_f32_16x16x32_bf16 v[24:27], v[184:187], a[72:75], v[24:27]
ds_read_b64_tr_b16 v[152:153], v4 offset:16384
ds_read_b64_tr_b16 v[154:155], v4 offset:20480
v_mfma_f32_16x16x32_bf16 v[40:43], v[184:187], a[76:79], v[40:43]
ds_read_b64_tr_b16 v[156:157], v5 offset:16384
v_add_u32 v12, 0x20000, v12
v_mfma_f32_16x16x32_bf16 v[44:47], v[188:191], a[76:79], v[44:47]
ds_read_b64_tr_b16 v[158:159], v5 offset:20480
s_add_u32 m0, s17, 0x1c000
v_mfma_f32_16x16x32_bf16 v[28:31], v[188:191], a[72:75], v[28:31]
buffer_load_dwordx4 v12, s[72:75], 0 offen lds
v_mfma_f32_16x16x32_bf16 v[32:35], v[192:195], a[72:75], v[32:35]
ds_read_b64_tr_b16 v[160:161], v4 offset:16640
ds_read_b64_tr_b16 v[162:163], v4 offset:20736
v_mfma_f32_16x16x32_bf16 v[48:51], v[192:195], a[76:79], v[48:51]
ds_read_b64_tr_b16 v[164:165], v5 offset:16640
v_add_u32 v13, 0x20000, v13
v_mfma_f32_16x16x32_bf16 v[52:55], v[196:199], a[76:79], v[52:55]
ds_read_b64_tr_b16 v[166:167], v5 offset:20736
s_waitcnt lgkmcnt(8)
v_mfma_f32_16x16x32_bf16 v[36:39], v[196:199], a[72:75], v[36:39]
buffer_load_dwordx4 v13, s[72:75], 0 offen offset:1024 lds
v_mfma_f32_16x16x32_bf16 v[56:59], v[200:203], a[72:75], v[56:59]
ds_read_b64_tr_b16 v[168:169], v4 offset:16896
ds_read_b64_tr_b16 v[170:171], v4 offset:20992
v_mfma_f32_16x16x32_bf16 v[72:75], v[200:203], a[76:79], v[72:75]
ds_read_b64_tr_b16 v[172:173], v5 offset:16896
v_mfma_f32_16x16x32_bf16 v[76:79], v[204:207], a[76:79], v[76:79]
ds_read_b64_tr_b16 v[174:175], v5 offset:20992
v_mfma_f32_16x16x32_bf16 v[60:63], v[204:207], a[72:75], v[60:63]
buffer_load_dwordx4 v12, s[72:75], s12 offen offset:2048 lds
v_mfma_f32_16x16x32_bf16 v[64:67], v[208:211], a[72:75], v[64:67]
ds_read_b64_tr_b16 v[176:177], v4 offset:17152
ds_read_b64_tr_b16 v[178:179], v4 offset:21248
v_mfma_f32_16x16x32_bf16 v[80:83], v[208:211], a[76:79], v[80:83]
ds_read_b64_tr_b16 v[180:181], v5 offset:17152
s_waitcnt lgkmcnt(7)
v_mfma_f32_16x16x32_bf16 v[84:87], v[212:215], a[76:79], v[84:87]
ds_read_b64_tr_b16 v[182:183], v5 offset:21248
v_mfma_f32_16x16x32_bf16 v[68:71], v[212:215], a[72:75], v[68:71]
buffer_load_dwordx4 v13, s[72:75], s12 offen offset:3072 lds
v_mfma_f32_16x16x32_bf16 v[24:27], v[152:155], a[80:83], v[24:27]
ds_read_b64_tr_b16 v[184:185], v4 offset:24576
ds_read_b64_tr_b16 v[186:187], v4 offset:28672
v_mfma_f32_16x16x32_bf16 v[40:43], v[152:155], a[84:87], v[40:43]
ds_read_b64_tr_b16 v[188:189], v5 offset:24576
v_mfma_f32_16x16x32_bf16 v[44:47], v[156:159], a[84:87], v[44:47]
ds_read_b64_tr_b16 v[190:191], v5 offset:28672
s_add_u32 s101, s101, 0x2000
v_mfma_f32_16x16x32_bf16 v[28:31], v[156:159], a[80:83], v[28:31]
buffer_load_dwordx4 a[112:115], v3, s[88:91], s101 offen sc1
v_mfma_f32_16x16x32_bf16 v[32:35], v[160:163], a[80:83], v[32:35]
ds_read_b64_tr_b16 v[192:193], v4 offset:24832
ds_read_b64_tr_b16 v[194:195], v4 offset:28928
v_mfma_f32_16x16x32_bf16 v[48:51], v[160:163], a[84:87], v[48:51]
ds_read_b64_tr_b16 v[196:197], v5 offset:24832
v_mfma_f32_16x16x32_bf16 v[52:55], v[164:167], a[84:87], v[52:55]
ds_read_b64_tr_b16 v[198:199], v5 offset:28928
s_waitcnt lgkmcnt(8)
v_mfma_f32_16x16x32_bf16 v[36:39], v[164:167], a[80:83], v[36:39]
buffer_load_dwordx4 a[116:119], v3, s[88:91], s101 offen offset:1024 sc1
v_mfma_f32_16x16x32_bf16 v[56:59], v[168:171], a[80:83], v[56:59]
ds_read_b64_tr_b16 v[200:201], v4 offset:25088
ds_read_b64_tr_b16 v[202:203], v4 offset:29184
v_mfma_f32_16x16x32_bf16 v[72:75], v[168:171], a[84:87], v[72:75]
ds_read_b64_tr_b16 v[204:205], v5 offset:25088
v_mfma_f32_16x16x32_bf16 v[76:79], v[172:175], a[84:87], v[76:79]
ds_read_b64_tr_b16 v[206:207], v5 offset:29184
s_add_u32 s101, s101, 0x2000
v_mfma_f32_16x16x32_bf16 v[60:63], v[172:175], a[80:83], v[60:63]
buffer_load_dwordx4 a[120:123], v3, s[88:91], s101 offen sc1
v_mfma_f32_16x16x32_bf16 v[64:67], v[176:179], a[80:83], v[64:67]
ds_read_b64_tr_b16 v[208:209], v4 offset:25344
ds_read_b64_tr_b16 v[210:211], v4 offset:29440
v_mfma_f32_16x16x32_bf16 v[80:83], v[176:179], a[84:87], v[80:83]
ds_read_b64_tr_b16 v[212:213], v5 offset:25344
s_waitcnt vmcnt(7) lgkmcnt(7)
v_mfma_f32_16x16x32_bf16 v[84:87], v[180:183], a[84:87], v[84:87]
ds_read_b64_tr_b16 v[214:215], v5 offset:29440
s_barrier
v_mfma_f32_16x16x32_bf16 v[68:71], v[180:183], a[80:83], v[68:71]
buffer_load_dwordx4 a[124:127], v3, s[88:91], s101 offen offset:1024 sc1
s_mov_b32 s92, 200000
L_spin_c:
v_cmp_ne_u32 vcc, 1, v14
s_nop 4
s_cbranch_vccz L_spun_c
s_sub_u32 s92, s92, 1
s_cbranch_scc1 L_spun_c
s_sleep 2
buffer_load_dword v14, v20, s[88:91], s11 offen sc1
s_waitcnt vmcnt(0)
s_branch L_spin_c
L_spun_c:
v_mfma_f32_16x16x32_bf16 v[24:27], v[184:187], a[88:91], v[24:27]
ds_read_b64_tr_b16 v[152:153], v4 offset:32768
ds_read_b64_tr_b16 v[154:155], v4 offset:36864
v_mfma_f32_16x16x32_bf16 v[40:43], v[184:187], a[92:95], v[40:43]
ds_read_b64_tr_b16 v[156:157], v5 offset:32768
v_add_u32 v12, s25, v12
v_mfma_f32_16x16x32_bf16 v[44:47], v[188:191], a[92:95], v[44:47]
ds_read_b64_tr_b16 v[158:159], v5 offset:36864
s_add_u32 m0, s17, 0x10000
v_mfma_f32_16x16x32_bf16 v[28:31], v[188:191], a[88:91], v[28:31]
buffer_load_dwordx4 v12, s[64:67], 0 offen lds
v_mfma_f32_16x16x32_bf16 v[32:35], v[192:195], a[88:91], v[32:35]
ds_read_b64_tr_b16 v[160:161], v4 offset:33024
ds_read_b64_tr_b16 v[162:163], v4 offset:37120
v_mfma_f32_16x16x32_bf16 v[48:51], v[192:195], a[92:95], v[48:51]
ds_read_b64_tr_b16 v[164:165], v5 offset:33024
v_add_u32 v13, s25, v13
v_mfma_f32_16x16x32_bf16 v[52:55], v[196:199], a[92:95], v[52:55]
ds_read_b64_tr_b16 v[166:167], v5 offset:37120
s_waitcnt lgkmcnt(8)
v_mfma_f32_16x16x32_bf16 v[36:39], v[196:199], a[88:91], v[36:39]
buffer_load_dwordx4 v13, s[64:67], 0 offen offset:1024 lds
v_mfma_f32_16x16x32_bf16 v[56:59], v[200:203], a[88:91], v[56:59]
ds_read_b64_tr_b16 v[168:169], v4 offset:33280
ds_read_b64_tr_b16 v[170:171], v4 offset:37376
v_mfma_f32_16x16x32_bf16 v[72:75], v[200:203], a[92:95], v[72:75]
ds_read_b64_tr_b16 v[172:173], v5 offset:33280
v_mfma_f32_16x16x32_bf16 v[76:79], v[204:207], a[92:95], v[76:79]
ds_read_b64_tr_b16 v[174:175], v5 offset:37376
v_mfma_f32_16x16x32_bf16 v[60:63], v[204:207], a[88:91], v[60:63]
buffer_load_dwordx4 v12, s[64:67], s12 offen offset:2048 lds
v_mfma_f32_16x16x32_bf16 v[64:67], v[208:211], a[88:91], v[64:67]
ds_read_b64_tr_b16 v[176:177], v4 offset:33536
ds_read_b64_tr_b16 v[178:179], v4 offset:37632
v_mfma_f32_16x16x32_bf16 v[80:83], v[208:211], a[92:95], v[80:83]
ds_read_b64_tr_b16 v[180:181], v5 offset:33536
s_waitcnt lgkmcnt(7)
v_mfma_f32_16x16x32_bf16 v[84:87], v[212:215], a[92:95], v[84:87]
ds_read_b64_tr_b16 v[182:183], v5 offset:37632
v_mfma_f32_16x16x32_bf16 v[68:71], v[212:215], a[88:91], v[68:71]
buffer_load_dwordx4 v13, s[64:67], s12 offen offset:3072 lds
v_mfma_f32_16x16x32_bf16 v[24:27], v[152:155], a[96:99], v[24:27]
ds_read_b64_tr_b16 v[184:185], v4 offset:40960
ds_read_b64_tr_b16 v[186:187], v4 offset:45056
v_mfma_f32_16x16x32_bf16 v[40:43], v[152:155], a[100:103], v[40:43]
ds_read_b64_tr_b16 v[188:189], v5 offset:40960
v_mfma_f32_16x16x32_bf16 v[44:47], v[156:159], a[100:103], v[44:47]
ds_read_b64_tr_b16 v[190:191], v5 offset:45056
s_add_u32 s101, s101, s26
v_mfma_f32_16x16x32_bf16 v[28:31], v[156:159], a[96:99], v[28:31]
buffer_load_dwordx4 a[64:67], v3, s[88:91], s101 offen sc1
v_mfma_f32_16x16x32_bf16 v[32:35], v[160:163], a[96:99], v[32:35]
ds_read_b64_tr_b16 v[192:193], v4 offset:41216
ds_read_b64_tr_b16 v[194:195], v4 offset:45312
v_mfma_f32_16x16x32_bf16 v[48:51], v[160:163], a[100:103], v[48:51]
ds_read_b64_tr_b16 v[196:197], v5 offset:41216
v_mfma_f32_16x16x32_bf16 v[52:55], v[164:167], a[100:103], v[52:55]
ds_read_b64_tr_b16 v[198:199], v5 offset:45312
s_waitcnt lgkmcnt(8)
v_mfma_f32_16x16x32_bf16 v[36:39], v[164:167], a[96:99], v[36:39]
buffer_load_dwordx4 a[68:71], v3, s[88:91], s101 offen offset:1024 sc1
v_mfma_f32_16x16x32_bf16 v[56:59], v[168:171], a[96:99], v[56:59]
ds_read_b64_tr_b16 v[200:201], v4 offset:41472
ds_read_b64_tr_b16 v[202:203], v4 offset:45568
v_mfma_f32_16x16x32_bf16 v[72:75], v[168:171], a[100:103], v[72:75]
ds_read_b64_tr_b16 v[204:205], v5 offset:41472
v_mfma_f32_16x16x32_bf16 v[76:79], v[172:175], a[100:103], v[76:79]
ds_read_b64_tr_b16 v[206:207], v5 offset:45568
s_add_u32 s101, s101, 0x2000
v_mfma_f32_16x16x32_bf16 v[60:63], v[172:175], a[96:99], v[60:63]
buffer_load_dwordx4 a[72:75], v3, s[88:91], s101 offen sc1
v_mfma_f32_16x16x32_bf16 v[64:67], v[176:179], a[96:99], v[64:67]
ds_read_b64_tr_b16 v[208:209], v4 offset:41728
ds_read_b64_tr_b16 v[210:211], v4 offset:45824
v_mfma_f32_16x16x32_bf16 v[80:83], v[176:179], a[100:103], v[80:83]
ds_read_b64_tr_b16 v[212:213], v5 offset:41728
s_waitcnt vmcnt(7) lgkmcnt(7)
v_mfma_f32_16x16x32_bf16 v[84:87], v[180:183], a[100:103], v[84:87]
ds_read_b64_tr_b16 v[214:215], v5 offset:45824
s_barrier
v_mfma_f32_16x16x32_bf16 v[68:71], v[180:183], a[96:99], v[68:71]
buffer_load_dwordx4 a[76:79], v3, s[88:91], s101 offen offset:1024 sc1
v_mfma_f32_16x16x32_bf16 v[24:27], v[184:187], a[104:107], v[24:27]
ds_read_b64_tr_b16 v[152:153], v4 offset:49152
ds_read_b64_tr_b16 v[154:155], v4 offset:53248
v_mfma_f32_16x16x32_bf16 v[40:43], v[184:187], a[108:111], v[40:43]
ds_read_b64_tr_b16 v[156:157], v5 offset:49152
v_add_u32 v12, 0x20000, v12
v_mfma_f32_16x16x32_bf16 v[44:47], v[188:191], a[108:111], v[44:47]
ds_read_b64_tr_b16 v[158:159], v5 offset:53248
s_add_u32 m0, s17, 0x14000
v_mfma_f32_16x16x32_bf16 v[28:31], v[188:191], a[104:107], v[28:31]
buffer_load_dwordx4 v12, s[64:67], 0 offen lds
v_mfma_f32_16x16x32_bf16 v[32:35], v[192:195], a[104:107], v[32:35]
ds_read_b64_tr_b16 v[160:161], v4 offset:49408
ds_read_b64_tr_b16 v[162:163], v4 offset:53504
v_mfma_f32_16x16x32_bf16 v[48:51], v[192:195], a[108:111], v[48:51]
ds_read_b64_tr_b16 v[164:165], v5 offset:49408
v_add_u32 v13, 0x20000, v13
v_mfma_f32_16x16x32_bf16 v[52:55], v[196:199], a[108:111], v[52:55]
ds_read_b64_tr_b16 v[166:167], v5 offset:53504
s_waitcnt lgkmcnt(8)
v_mfma_f32_16x16x32_bf16 v[36:39], v[196:199], a[104:107], v[36:39]
buffer_load_dwordx4 v13, s[64:67], 0 offen offset:1024 lds
v_mfma_f32_16x16x32_bf16 v[56:59], v[200:203], a[104:107], v[56:59]
ds_read_b64_tr_b16 v[168:169], v4 offset:49664
ds_read_b64_tr_b16 v[170:171], v4 offset:53760
v_mfma_f32_16x16x32_bf16 v[72:75], v[200:203], a[108:111], v[72:75]
ds_read_b64_tr_b16 v[172:173], v5 offset:49664
v_mfma_f32_16x16x32_bf16 v[76:79], v[204:207], a[108:111], v[76:79]
ds_read_b64_tr_b16 v[174:175], v5 offset:53760
v_mfma_f32_16x16x32_bf16 v[60:63], v[204:207], a[104:107], v[60:63]
buffer_load_dwordx4 v12, s[64:67], s12 offen offset:2048 lds
v_mfma_f32_16x16x32_bf16 v[64:67], v[208:211], a[104:107], v[64:67]
ds_read_b64_tr_b16 v[176:177], v4 offset:49920
ds_read_b64_tr_b16 v[178:179], v4 offset:54016
v_mfma_f32_16x16x32_bf16 v[80:83], v[208:211], a[108:111], v[80:83]
ds_read_b64_tr_b16 v[180:181], v5 offset:49920
s_waitcnt lgkmcnt(7)
v_mfma_f32_16x16x32_bf16 v[84:87], v[212:215], a[108:111], v[84:87]
ds_read_b64_tr_b16 v[182:183], v5 offset:54016
v_mfma_f32_16x16x32_bf16 v[68:71], v[212:215], a[104:107], v[68:71]
buffer_load_dwordx4 v13, s[64:67], s12 offen offset:3072 lds
v_mfma_f32_16x16x32_bf16 v[24:27], v[152:155], a[112:115], v[24:27]
ds_read_b64_tr_b16 v[184:185], v4 offset:57344
ds_read_b64_tr_b16 v[186:187], v4 offset:61440
v_mfma_f32_16x16x32_bf16 v[40:43], v[152:155], a[116:119], v[40:43]
ds_read_b64_tr_b16 v[188:189], v5 offset:57344
v_mfma_f32_16x16x32_bf16 v[44:47], v[156:159], a[116:119], v[44:47]
ds_read_b64_tr_b16 v[190:191], v5 offset:61440
s_add_u32 s101, s101, 0x2000
v_mfma_f32_16x16x32_bf16 v[28:31], v[156:159], a[112:115], v[28:31]
buffer_load_dwordx4 a[80:83], v3, s[88:91], s101 offen sc1
v_mfma_f32_16x16x32_bf16 v[32:35], v[160:163], a[112:115], v[32:35]
ds_read_b64_tr_b16 v[192:193], v4 offset:57600
ds_read_b64_tr_b16 v[194:195], v4 offset:61696
v_mfma_f32_16x16x32_bf16 v[48:51], v[160:163], a[116:119], v[48:51]
ds_read_b64_tr_b16 v[196:197], v5 offset:57600
v_mfma_f32_16x16x32_bf16 v[52:55], v[164:167], a[116:119], v[52:55]
ds_read_b64_tr_b16 v[198:199], v5 offset:61696
s_waitcnt lgkmcnt(8)
v_mfma_f32_16x16x32_bf16 v[36:39], v[164:167], a[112:115], v[36:39]
buffer_load_dwordx4 a[84:87], v3, s[88:91], s101 offen offset:1024 sc1
v_mfma_f32_16x16x32_bf16 v[56:59], v[168:171], a[112:115], v[56:59]
ds_read_b64_tr_b16 v[200:201], v4 offset:57856
ds_read_b64_tr_b16 v[202:203], v4 offset:61952
v_mfma_f32_16x16x32_bf16 v[72:75], v[168:171], a[116:119], v[72:75]
ds_read_b64_tr_b16 v[204:205], v5 offset:57856
v_mfma_f32_16x16x32_bf16 v[76:79], v[172:175], a[116:119], v[76:79]
ds_read_b64_tr_b16 v[206:207], v5 offset:61952
s_add_u32 s101, s101, 0x2000
v_mfma_f32_16x16x32_bf16 v[60:63], v[172:175], a[112:115], v[60:63]
buffer_load_dwordx4 a[88:91], v3, s[88:91], s101 offen sc1
v_mfma_f32_16x16x32_bf16 v[64:67], v[176:179], a[112:115], v[64:67]
ds_read_b64_tr_b16 v[208:209], v4 offset:58112
ds_read_b64_tr_b16 v[210:211], v4 offset:62208
v_mfma_f32_16x16x32_bf16 v[80:83], v[176:179], a[116:119], v[80:83]
ds_read_b64_tr_b16 v[212:213], v5 offset:58112
s_waitcnt vmcnt(7) lgkmcnt(7)
v_mfma_f32_16x16x32_bf16 v[84:87], v[180:183], a[116:119], v[84:87]
ds_read_b64_tr_b16 v[214:215], v5 offset:62208
s_barrier
v_mfma_f32_16x16x32_bf16 v[68:71], v[180:183], a[112:115], v[68:71]
buffer_load_dwordx4 a[92:95], v3, s[88:91], s101 offen offset:1024 sc1
v_mfma_f32_16x16x32_bf16 v[24:27], v[184:187], a[120:123], v[24:27]
ds_read_b64_tr_b16 v[152:153], v4 offset:0
ds_read_b64_tr_b16 v[154:155], v4 offset:4096
v_mfma_f32_16x16x32_bf16 v[40:43], v[184:187], a[124:127], v[40:43]
ds_read_b64_tr_b16 v[156:157], v5 offset:0
v_add_u32 v12, 0x20000, v12
v_mfma_f32_16x16x32_bf16 v[44:47], v[188:191], a[124:127], v[44:47]
ds_read_b64_tr_b16 v[158:159], v5 offset:4096
s_add_u32 m0, s17, 0x18000
v_mfma_f32_16x16x32_bf16 v[28:31], v[188:191], a[120:123], v[28:31]
buffer_load_dwordx4 v12, s[64:67], 0 offen lds
v_mfma_f32_16x16x32_bf16 v[32:35], v[192:195], a[120:123], v[32:35]
ds_read_b64_tr_b16 v[160:161], v4 offset:256
ds_read_b64_tr_b16 v[162:163], v4 offset:4352
v_mfma_f32_16x16x32_bf16 v[48:51], v[192:195], a[124:127], v[48:51]
ds_read_b64_tr_b16 v[164:165], v5 offset:256
v_add_u32 v13, 0x20000, v13
v_mfma_f32_16x16x32_bf16 v[52:55], v[196:199], a[124:127], v[52:55]
ds_read_b64_tr_b16 v[166:167], v5 offset:4352
s_waitcnt lgkmcnt(8)
v_mfma_f32_16x16x32_bf16 v[36:39], v[196:199], a[120:123], v[36:39]
buffer_load_dwordx4 v13, s[64:67], 0 offen offset:1024 lds
v_mfma_f32_16x16x32_bf16 v[56:59], v[200:203], a[120:123], v[56:59]
ds_read_b64_tr_b16 v[168:169], v4 offset:512
ds_read_b64_tr_b16 v[170:171], v4 offset:4608
v_mfma_f32_16x16x32_bf16 v[72:75], v[200:203], a[124:127], v[72:75]
ds_read_b64_tr_b16 v[172:173], v5 offset:512
v_mfma_f32_16x16x32_bf16 v[76:79], v[204:207], a[124:127], v[76:79]
ds_read_b64_tr_b16 v[174:175], v5 offset:4608
v_mfma_f32_16x16x32_bf16 v[60:63], v[204:207], a[120:123], v[60:63]
buffer_load_dwordx4 v12, s[64:67], s12 offen offset:2048 lds
v_mfma_f32_16x16x32_bf16 v[64:67], v[208:211], a[120:123], v[64:67]
ds_read_b64_tr_b16 v[176:177], v4 offset:768
ds_read_b64_tr_b16 v[178:179], v4 offset:4864
v_mfma_f32_16x16x32_bf16 v[80:83], v[208:211], a[124:127], v[80:83]
ds_read_b64_tr_b16 v[180:181], v5 offset:768
s_waitcnt lgkmcnt(7)
v_mfma_f32_16x16x32_bf16 v[84:87], v[212:215], a[124:127], v[84:87]
ds_read_b64_tr_b16 v[182:183], v5 offset:4864
v_mfma_f32_16x16x32_bf16 v[68:71], v[212:215], a[120:123], v[68:71]
buffer_load_dwordx4 v13, s[64:67], s12 offen offset:3072 lds
v_mfma_f32_16x16x32_bf16 v[88:91], v[152:155], a[64:67], 0
ds_read_b64_tr_b16 v[184:185], v4 offset:8192
ds_read_b64_tr_b16 v[186:187], v4 offset:12288
v_mfma_f32_16x16x32_bf16 v[104:107], v[152:155], a[68:71], 0
ds_read_b64_tr_b16 v[188:189], v5 offset:8192
v_mfma_f32_16x16x32_bf16 v[108:111], v[156:159], a[68:71], 0
ds_read_b64_tr_b16 v[190:191], v5 offset:12288
s_add_u32 s101, s101, 0x2000
v_mfma_f32_16x16x32_bf16 v[92:95], v[156:159], a[64:67], 0
buffer_load_dwordx4 a[96:99], v3, s[88:91], s101 offen sc1
v_mfma_f32_16x16x32_bf16 v[96:99], v[160:163], a[64:67], 0
ds_read_b64_tr_b16 v[192:193], v4 offset:8448
ds_read_b64_tr_b16 v[194:195], v4 offset:12544
v_mfma_f32_16x16x32_bf16 v[112:115], v[160:163], a[68:71], 0
ds_read_b64_tr_b16 v[196:197], v5 offset:8448
v_mfma_f32_16x16x32_bf16 v[116:119], v[164:167], a[68:71], 0
ds_read_b64_tr_b16 v[198:199], v5 offset:12544
s_waitcnt lgkmcnt(8)
v_mfma_f32_16x16x32_bf16 v[100:103], v[164:167], a[64:67], 0
buffer_load_dwordx4 a[100:103], v3, s[88:91], s101 offen offset:1024 sc1
v_mfma_f32_16x16x32_bf16 v[120:123], v[168:171], a[64:67], 0
ds_read_b64_tr_b16 v[200:201], v4 offset:8704
ds_read_b64_tr_b16 v[202:203], v4 offset:12800
v_mfma_f32_16x16x32_bf16 v[136:139], v[168:171], a[68:71], 0
ds_read_b64_tr_b16 v[204:205], v5 offset:8704
v_mfma_f32_16x16x32_bf16 v[140:143], v[172:175], a[68:71], 0
ds_read_b64_tr_b16 v[206:207], v5 offset:12800
s_add_u32 s101, s101, 0x2000
v_mfma_f32_16x16x32_bf16 v[124:127], v[172:175], a[64:67], 0
buffer_load_dwordx4 a[104:107], v3, s[88:91], s101 offen sc1
v_mfma_f32_16x16x32_bf16 v[128:131], v[176:179], a[64:67], 0
ds_read_b64_tr_b16 v[208:209], v4 offset:8960
ds_read_b64_tr_b16 v[210:211], v4 offset:13056
v_mfma_f32_16x16x32_bf16 v[144:147], v[176:179], a[68:71], 0
ds_read_b64_tr_b16 v[212:213], v5 offset:8960
s_waitcnt vmcnt(7) lgkmcnt(7)
v_mfma_f32_16x16x32_bf16 v[148:151], v[180:183], a[68:71], 0
ds_read_b64_tr_b16 v[214:215], v5 offset:13056
s_barrier
v_mfma_f32_16x16x32_bf16 v[132:135], v[180:183], a[64:67], 0
buffer_load_dwordx4 a[108:111], v3, s[88:91], s101 offen offset:1024 sc1
s_mov_b32 s15, 7
L_p4_loop:
v_mfma_f32_16x16x32_bf16 v[88:91], v[184:187], a[72:75], v[88:91]
ds_read_b64_tr_b16 v[152:153], v4 offset:16384
ds_read_b64_tr_b16 v[154:155], v4 offset:20480
v_mfma_f32_16x16x32_bf16 v[104:107], v[184:187], a[76:79], v[104:107]
ds_read_b64_tr_b16 v[156:157], v5 offset:16384
v_add_u32 v12, 0x20000, v12
v_mfma_f32_16x16x32_bf16 v[108:111], v[188:191], a[76:79], v[108:111]
ds_read_b64_tr_b16 v[158:159], v5 offset:20480
s_add_u32 m0, s17, 0x1c000
v_mfma_f32_16x16x32_bf16 v[92:95], v[188:191], a[72:75], v[92:95]
buffer_load_dwordx4 v12, s[64:67], 0 offen lds
v_mfma_f32_16x16x32_bf16 v[96:99], v[192:195], a[72:75], v[96:99]
ds_read_b64_tr_b16 v[160:161], v4 offset:16640
ds_read_b64_tr_b16 v[162:163], v4 offset:20736
v_mfma_f32_16x16x32_bf16 v[112:115], v[192:195], a[76:79], v[112:115]
ds_read_b64_tr_b16 v[164:165], v5 offset:16640
v_add_u32 v13, 0x20000, v13
v_mfma_f32_16x16x32_bf16 v[116:119], v[196:199], a[76:79], v[116:119]
ds_read_b64_tr_b16 v[166:167], v5 offset:20736
s_waitcnt lgkmcnt(8)
v_mfma_f32_16x16x32_bf16 v[100:103], v[196:199], a[72:75], v[100:103]
buffer_load_dwordx4 v13, s[64:67], 0 offen offset:1024 lds
v_mfma_f32_16x16x32_bf16 v[120:123], v[200:203], a[72:75], v[120:123]
ds_read_b64_tr_b16 v[168:169], v4 offset:16896
ds_read_b64_tr_b16 v[170:171], v4 offset:20992
v_mfma_f32_16x16x32_bf16 v[136:139], v[200:203], a[76:79], v[136:139]
ds_read_b64_tr_b16 v[172:173], v5 offset:16896
v_mfma_f32_16x16x32_bf16 v[140:143], v[204:207], a[76:79], v[140:143]
ds_read_b64_tr_b16 v[174:175], v5 offset:20992
v_mfma_f32_16x16x32_bf16 v[124:127], v[204:207], a[72:75], v[124:127]
buffer_load_dwordx4 v12, s[64:67], s12 offen offset:2048 lds
v_mfma_f32_16x16x32_bf16 v[128:131], v[208:211], a[72:75], v[128:131]
ds_read_b64_tr_b16 v[176:177], v4 offset:17152
ds_read_b64_tr_b16 v[178:179], v4 offset:21248
v_mfma_f32_16x16x32_bf16 v[144:147], v[208:211], a[76:79], v[144:147]
ds_read_b64_tr_b16 v[180:181], v5 offset:17152
s_waitcnt lgkmcnt(7)
v_mfma_f32_16x16x32_bf16 v[148:151], v[212:215], a[76:79], v[148:151]
ds_read_b64_tr_b16 v[182:183], v5 offset:21248
v_mfma_f32_16x16x32_bf16 v[132:135], v[212:215], a[72:75], v[132:135]
buffer_load_dwordx4 v13, s[64:67], s12 offen offset:3072 lds
v_mfma_f32_16x16x32_bf16 v[88:91], v[152:155], a[80:83], v[88:91]
ds_read_b64_tr_b16 v[184:185], v4 offset:24576
ds_read_b64_tr_b16 v[186:187], v4 offset:28672
v_mfma_f32_16x16x32_bf16 v[104:107], v[152:155], a[84:87], v[104:107]
ds_read_b64_tr_b16 v[188:189], v5 offset:24576
v_mfma_f32_16x16x32_bf16 v[108:111], v[156:159], a[84:87], v[108:111]
ds_read_b64_tr_b16 v[190:191], v5 offset:28672
s_add_u32 s101, s101, 0x2000
v_mfma_f32_16x16x32_bf16 v[92:95], v[156:159], a[80:83], v[92:95]
buffer_load_dwordx4 a[112:115], v3, s[88:91], s101 offen sc1
v_mfma_f32_16x16x32_bf16 v[96:99], v[160:163], a[80:83], v[96:99]
ds_read_b64_tr_b16 v[192:193], v4 offset:24832
ds_read_b64_tr_b16 v[194:195], v4 offset:28928
v_mfma_f32_16x16x32_bf16 v[112:115], v[160:163], a[84:87], v[112:115]
ds_read_b64_tr_b16 v[196:197], v5 offset:24832
v_mfma_f32_16x16x32_bf16 v[116:119], v[164:167], a[84:87], v[116:119]
ds_read_b64_tr_b16 v[198:199], v5 offset:28928
s_waitcnt lgkmcnt(8)
v_mfma_f32_16x16x32_bf16 v[100:103], v[164:167], a[80:83], v[100:103]
buffer_load_dwordx4 a[116:119], v3, s[88:91], s101 offen offset:1024 sc1
v_mfma_f32_16x16x32_bf16 v[120:123], v[168:171], a[80:83], v[120:123]
ds_read_b64_tr_b16 v[200:201], v4 offset:25088
ds_read_b64_tr_b16 v[202:203], v4 offset:29184
v_mfma_f32_16x16x32_bf16 v[136:139], v[168:171], a[84:87], v[136:139]
ds_read_b64_tr_b16 v[204:205], v5 offset:25088
v_mfma_f32_16x16x32_bf16 v[140:143], v[172:175], a[84:87], v[140:143]
ds_read_b64_tr_b16 v[206:207], v5 offset:29184
s_add_u32 s101, s101, 0x2000
v_mfma_f32_16x16x32_bf16 v[124:127], v[172:175], a[80:83], v[124:127]
buffer_load_dwordx4 a[120:123], v3, s[88:91], s101 offen sc1
v_mfma_f32_16x16x32_bf16 v[128:131], v[176:179], a[80:83], v[128:131]
ds_read_b64_tr_b16 v[208:209], v4 offset:25344
ds_read_b64_tr_b16 v[210:211], v4 offset:29440
v_mfma_f32_16x16x32_bf16 v[144:147], v[176:179], a[84:87], v[144:147]
ds_read_b64_tr_b16 v[212:213], v5 offset:25344
s_waitcnt vmcnt(7) lgkmcnt(7)
v_mfma_f32_16x16x32_bf16 v[148:151], v[180:183], a[84:87], v[148:151]
ds_read_b64_tr_b16 v[214:215], v5 offset:29440
s_barrier
v_mfma_f32_16x16x32_bf16 v[132:135], v[180:183], a[80:83], v[132:135]
buffer_load_dwordx4 a[124:127], v3, s[88:91], s101 offen offset:1024 sc1
v_mfma_f32_16x16x32_bf16 v[88:91], v[184:187], a[88:91], v[88:91]
ds_read_b64_tr_b16 v[152:153], v4 offset:32768
ds_read_b64_tr_b16 v[154:155], v4 offset:36864
v_mfma_f32_16x16x32_bf16 v[104:107], v[184:187], a[92:95], v[104:107]
ds_read_b64_tr_b16 v[156:157], v5 offset:32768
v_add_u32 v12, 0x20000, v12
v_mfma_f32_16x16x32_bf16 v[108:111], v[188:191], a[92:95], v[108:111]
ds_read_b64_tr_b16 v[158:159], v5 offset:36864
s_add_u32 m0, s17, 0x10000
v_mfma_f32_16x16x32_bf16 v[92:95], v[188:191], a[88:91], v[92:95]
buffer_load_dwordx4 v12, s[64:67], 0 offen lds
v_mfma_f32_16x16x32_bf16 v[96:99], v[192:195], a[88:91], v[96:99]
ds_read_b64_tr_b16 v[160:161], v4 offset:33024
ds_read_b64_tr_b16 v[162:163], v4 offset:37120
v_mfma_f32_16x16x32_bf16 v[112:115], v[192:195], a[92:95], v[112:115]
ds_read_b64_tr_b16 v[164:165], v5 offset:33024
v_add_u32 v13, 0x20000, v13
v_mfma_f32_16x16x32_bf16 v[116:119], v[196:199], a[92:95], v[116:119]
ds_read_b64_tr_b16 v[166:167], v5 offset:37120
s_waitcnt lgkmcnt(8)
v_mfma_f32_16x16x32_bf16 v[100:103], v[196:199], a[88:91], v[100:103]
buffer_load_dwordx4 v13, s[64:67], 0 offen offset:1024 lds
v_mfma_f32_16x16x32_bf16 v[120:123], v[200:203], a[88:91], v[120:123]
ds_read_b64_tr_b16 v[168:169], v4 offset:33280
ds_read_b64_tr_b16 v[170:171], v4 offset:37376
v_mfma_f32_16x16x32_bf16 v[136:139], v[200:203], a[92:95], v[136:139]
ds_read_b64_tr_b16 v[172:173], v5 offset:33280
v_mfma_f32_16x16x32_bf16 v[140:143], v[204:207], a[92:95], v[140:143]
ds_read_b64_tr_b16 v[174:175], v5 offset:37376
v_mfma_f32_16x16x32_bf16 v[124:127], v[204:207], a[88:91], v[124:127]
buffer_load_dwordx4 v12, s[64:67], s12 offen offset:2048 lds
v_mfma_f32_16x16x32_bf16 v[128:131], v[208:211], a[88:91], v[128:131]
ds_read_b64_tr_b16 v[176:177], v4 offset:33536
ds_read_b64_tr_b16 v[178:179], v4 offset:37632
v_mfma_f32_16x16x32_bf16 v[144:147], v[208:211], a[92:95], v[144:147]
ds_read_b64_tr_b16 v[180:181], v5 offset:33536
s_waitcnt lgkmcnt(7)
v_mfma_f32_16x16x32_bf16 v[148:151], v[212:215], a[92:95], v[148:151]
ds_read_b64_tr_b16 v[182:183], v5 offset:37632
v_mfma_f32_16x16x32_bf16 v[132:135], v[212:215], a[88:91], v[132:135]
buffer_load_dwordx4 v13, s[64:67], s12 offen offset:3072 lds
v_mfma_f32_16x16x32_bf16 v[88:91], v[152:155], a[96:99], v[88:91]
ds_read_b64_tr_b16 v[184:185], v4 offset:40960
ds_read_b64_tr_b16 v[186:187], v4 offset:45056
v_mfma_f32_16x16x32_bf16 v[104:107], v[152:155], a[100:103], v[104:107]
ds_read_b64_tr_b16 v[188:189], v5 offset:40960
v_mfma_f32_16x16x32_bf16 v[108:111], v[156:159], a[100:103], v[108:111]
ds_read_b64_tr_b16 v[190:191], v5 offset:45056
s_add_u32 s101, s101, 0x2000
v_mfma_f32_16x16x32_bf16 v[92:95], v[156:159], a[96:99], v[92:95]
buffer_load_dwordx4 a[64:67], v3, s[88:91], s101 offen sc1
v_mfma_f32_16x16x32_bf16 v[96:99], v[160:163], a[96:99], v[96:99]
ds_read_b64_tr_b16 v[192:193], v4 offset:41216
ds_read_b64_tr_b16 v[194:195], v4 offset:45312
v_mfma_f32_16x16x32_bf16 v[112:115], v[160:163], a[100:103], v[112:115]
ds_read_b64_tr_b16 v[196:197], v5 offset:41216
v_mfma_f32_16x16x32_bf16 v[116:119], v[164:167], a[100:103], v[116:119]
ds_read_b64_tr_b16 v[198:199], v5 offset:45312
s_waitcnt lgkmcnt(8)
v_mfma_f32_16x16x32_bf16 v[100:103], v[164:167], a[96:99], v[100:103]
buffer_load_dwordx4 a[68:71], v3, s[88:91], s101 offen offset:1024 sc1
v_mfma_f32_16x16x32_bf16 v[120:123], v[168:171], a[96:99], v[120:123]
ds_read_b64_tr_b16 v[200:201], v4 offset:41472
ds_read_b64_tr_b16 v[202:203], v4 offset:45568
v_mfma_f32_16x16x32_bf16 v[136:139], v[168:171], a[100:103], v[136:139]
ds_read_b64_tr_b16 v[204:205], v5 offset:41472
v_mfma_f32_16x16x32_bf16 v[140:143], v[172:175], a[100:103], v[140:143]
ds_read_b64_tr_b16 v[206:207], v5 offset:45568
s_add_u32 s101, s101, 0x2000
v_mfma_f32_16x16x32_bf16 v[124:127], v[172:175], a[96:99], v[124:127]
buffer_load_dwordx4 a[72:75], v3, s[88:91], s101 offen sc1
v_mfma_f32_16x16x32_bf16 v[128:131], v[176:179], a[96:99], v[128:131]
ds_read_b64_tr_b16 v[208:209], v4 offset:41728
ds_read_b64_tr_b16 v[210:211], v4 offset:45824
v_mfma_f32_16x16x32_bf16 v[144:147], v[176:179], a[100:103], v[144:147]
ds_read_b64_tr_b16 v[212:213], v5 offset:41728
s_waitcnt vmcnt(7) lgkmcnt(7)
v_mfma_f32_16x16x32_bf16 v[148:151], v[180:183], a[100:103], v[148:151]
ds_read_b64_tr_b16 v[214:215], v5 offset:45824
s_barrier
v_mfma_f32_16x16x32_bf16 v[132:135], v[180:183], a[96:99], v[132:135]
buffer_load_dwordx4 a[76:79], v3, s[88:91], s101 offen offset:1024 sc1
v_mfma_f32_16x16x32_bf16 v[88:91], v[184:187], a[104:107], v[88:91]
ds_read_b64_tr_b16 v[152:153], v4 offset:49152
ds_read_b64_tr_b16 v[154:155], v4 offset:53248
v_mfma_f32_16x16x32_bf16 v[104:107], v[184:187], a[108:111], v[104:107]
ds_read_b64_tr_b16 v[156:157], v5 offset:49152
v_add_u32 v12, 0x20000, v12
v_mfma_f32_16x16x32_bf16 v[108:111], v[188:191], a[108:111], v[108:111]
ds_read_b64_tr_b16 v[158:159], v5 offset:53248
s_add_u32 m0, s17, 0x14000
v_mfma_f32_16x16x32_bf16 v[92:95], v[188:191], a[104:107], v[92:95]
buffer_load_dwordx4 v12, s[64:67], 0 offen lds
v_mfma_f32_16x16x32_bf16 v[96:99], v[192:195], a[104:107], v[96:99]
ds_read_b64_tr_b16 v[160:161], v4 offset:49408
ds_read_b64_tr_b16 v[162:163], v4 offset:53504
v_mfma_f32_16x16x32_bf16 v[112:115], v[192:195], a[108:111], v[112:115]
ds_read_b64_tr_b16 v[164:165], v5 offset:49408
v_add_u32 v13, 0x20000, v13
v_mfma_f32_16x16x32_bf16 v[116:119], v[196:199], a[108:111], v[116:119]
ds_read_b64_tr_b16 v[166:167], v5 offset:53504
s_waitcnt lgkmcnt(8)
v_mfma_f32_16x16x32_bf16 v[100:103], v[196:199], a[104:107], v[100:103]
buffer_load_dwordx4 v13, s[64:67], 0 offen offset:1024 lds
v_mfma_f32_16x16x32_bf16 v[120:123], v[200:203], a[104:107], v[120:123]
ds_read_b64_tr_b16 v[168:169], v4 offset:49664
ds_read_b64_tr_b16 v[170:171], v4 offset:53760
v_mfma_f32_16x16x32_bf16 v[136:139], v[200:203], a[108:111], v[136:139]
ds_read_b64_tr_b16 v[172:173], v5 offset:49664
v_mfma_f32_16x16x32_bf16 v[140:143], v[204:207], a[108:111], v[140:143]
ds_read_b64_tr_b16 v[174:175], v5 offset:53760
v_mfma_f32_16x16x32_bf16 v[124:127], v[204:207], a[104:107], v[124:127]
buffer_load_dwordx4 v12, s[64:67], s12 offen offset:2048 lds
v_mfma_f32_16x16x32_bf16 v[128:131], v[208:211], a[104:107], v[128:131]
ds_read_b64_tr_b16 v[176:177], v4 offset:49920
ds_read_b64_tr_b16 v[178:179], v4 offset:54016
v_mfma_f32_16x16x32_bf16 v[144:147], v[208:211], a[108:111], v[144:147]
ds_read_b64_tr_b16 v[180:181], v5 offset:49920
s_waitcnt lgkmcnt(7)
v_mfma_f32_16x16x32_bf16 v[148:151], v[212:215], a[108:111], v[148:151]
ds_read_b64_tr_b16 v[182:183], v5 offset:54016
v_mfma_f32_16x16x32_bf16 v[132:135], v[212:215], a[104:107], v[132:135]
buffer_load_dwordx4 v13, s[64:67], s12 offen offset:3072 lds
v_mfma_f32_16x16x32_bf16 v[88:91], v[152:155], a[112:115], v[88:91]
ds_read_b64_tr_b16 v[184:185], v4 offset:57344
ds_read_b64_tr_b16 v[186:187], v4 offset:61440
v_mfma_f32_16x16x32_bf16 v[104:107], v[152:155], a[116:119], v[104:107]
ds_read_b64_tr_b16 v[188:189], v5 offset:57344
v_mfma_f32_16x16x32_bf16 v[108:111], v[156:159], a[116:119], v[108:111]
ds_read_b64_tr_b16 v[190:191], v5 offset:61440
s_add_u32 s101, s101, 0x2000
v_mfma_f32_16x16x32_bf16 v[92:95], v[156:159], a[112:115], v[92:95]
buffer_load_dwordx4 a[80:83], v3, s[88:91], s101 offen sc1
v_mfma_f32_16x16x32_bf16 v[96:99], v[160:163], a[112:115], v[96:99]
ds_read_b64_tr_b16 v[192:193], v4 offset:57600
ds_read_b64_tr_b16 v[194:195], v4 offset:61696
v_mfma_f32_16x16x32_bf16 v[112:115], v[160:163], a[116:119], v[112:115]
ds_read_b64_tr_b16 v[196:197], v5 offset:57600
v_mfma_f32_16x16x32_bf16 v[116:119], v[164:167], a[116:119], v[116:119]
ds_read_b64_tr_b16 v[198:199], v5 offset:61696
s_waitcnt lgkmcnt(8)
v_mfma_f32_16x16x32_bf16 v[100:103], v[164:167], a[112:115], v[100:103]
buffer_load_dwordx4 a[84:87], v3, s[88:91], s101 offen offset:1024 sc1
v_mfma_f32_16x16x32_bf16 v[120:123], v[168:171], a[112:115], v[120:123]
ds_read_b64_tr_b16 v[200:201], v4 offset:57856
ds_read_b64_tr_b16 v[202:203], v4 offset:61952
v_mfma_f32_16x16x32_bf16 v[136:139], v[168:171], a[116:119], v[136:139]
ds_read_b64_tr_b16 v[204:205], v5 offset:57856
v_mfma_f32_16x16x32_bf16 v[140:143], v[172:175], a[116:119], v[140:143]
ds_read_b64_tr_b16 v[206:207], v5 offset:61952
s_add_u32 s101, s101, 0x2000
v_mfma_f32_16x16x32_bf16 v[124:127], v[172:175], a[112:115], v[124:127]
buffer_load_dwordx4 a[88:91], v3, s[88:91], s101 offen sc1
v_mfma_f32_16x16x32_bf16 v[128:131], v[176:179], a[112:115], v[128:131]
ds_read_b64_tr_b16 v[208:209], v4 offset:58112
ds_read_b64_tr_b16 v[210:211], v4 offset:62208
v_mfma_f32_16x16x32_bf16 v[144:147], v[176:179], a[116:119], v[144:147]
ds_read_b64_tr_b16 v[212:213], v5 offset:58112
s_waitcnt vmcnt(7) lgkmcnt(7)
v_mfma_f32_16x16x32_bf16 v[148:151], v[180:183], a[116:119], v[148:151]
ds_read_b64_tr_b16 v[214:215], v5 offset:62208
s_barrier
v_mfma_f32_16x16x32_bf16 v[132:135], v[180:183], a[112:115], v[132:135]
buffer_load_dwordx4 a[92:95], v3, s[88:91], s101 offen offset:1024 sc1
v_mfma_f32_16x16x32_bf16 v[88:91], v[184:187], a[120:123], v[88:91]
ds_read_b64_tr_b16 v[152:153], v4 offset:0
ds_read_b64_tr_b16 v[154:155], v4 offset:4096
v_mfma_f32_16x16x32_bf16 v[104:107], v[184:187], a[124:127], v[104:107]
ds_read_b64_tr_b16 v[156:157], v5 offset:0
v_add_u32 v12, 0x20000, v12
v_mfma_f32_16x16x32_bf16 v[108:111], v[188:191], a[124:127], v[108:111]
ds_read_b64_tr_b16 v[158:159], v5 offset:4096
s_add_u32 m0, s17, 0x18000
v_mfma_f32_16x16x32_bf16 v[92:95], v[188:191], a[120:123], v[92:95]
buffer_load_dwordx4 v12, s[64:67], 0 offen lds
v_mfma_f32_16x16x32_bf16 v[96:99], v[192:195], a[120:123], v[96:99]
ds_read_b64_tr_b16 v[160:161], v4 offset:256
ds_read_b64_tr_b16 v[162:163], v4 offset:4352
v_mfma_f32_16x16x32_bf16 v[112:115], v[192:195], a[124:127], v[112:115]
ds_read_b64_tr_b16 v[164:165], v5 offset:256
v_add_u32 v13, 0x20000, v13
v_mfma_f32_16x16x32_bf16 v[116:119], v[196:199], a[124:127], v[116:119]
ds_read_b64_tr_b16 v[166:167], v5 offset:4352
s_waitcnt lgkmcnt(8)
v_mfma_f32_16x16x32_bf16 v[100:103], v[196:199], a[120:123], v[100:103]
buffer_load_dwordx4 v13, s[64:67], 0 offen offset:1024 lds
v_mfma_f32_16x16x32_bf16 v[120:123], v[200:203], a[120:123], v[120:123]
ds_read_b64_tr_b16 v[168:169], v4 offset:512
ds_read_b64_tr_b16 v[170:171], v4 offset:4608
v_mfma_f32_16x16x32_bf16 v[136:139], v[200:203], a[124:127], v[136:139]
ds_read_b64_tr_b16 v[172:173], v5 offset:512
v_mfma_f32_16x16x32_bf16 v[140:143], v[204:207], a[124:127], v[140:143]
ds_read_b64_tr_b16 v[174:175], v5 offset:4608
v_mfma_f32_16x16x32_bf16 v[124:127], v[204:207], a[120:123], v[124:127]
buffer_load_dwordx4 v12, s[64:67], s12 offen offset:2048 lds
v_mfma_f32_16x16x32_bf16 v[128:131], v[208:211], a[120:123], v[128:131]
ds_read_b64_tr_b16 v[176:177], v4 offset:768
ds_read_b64_tr_b16 v[178:179], v4 offset:4864
v_mfma_f32_16x16x32_bf16 v[144:147], v[208:211], a[124:127], v[144:147]
ds_read_b64_tr_b16 v[180:181], v5 offset:768
s_waitcnt lgkmcnt(7)
v_mfma_f32_16x16x32_bf16 v[148:151], v[212:215], a[124:127], v[148:151]
ds_read_b64_tr_b16 v[182:183], v5 offset:4864
v_mfma_f32_16x16x32_bf16 v[132:135], v[212:215], a[120:123], v[132:135]
buffer_load_dwordx4 v13, s[64:67], s12 offen offset:3072 lds
v_mfma_f32_16x16x32_bf16 v[88:91], v[152:155], a[64:67], v[88:91]
ds_read_b64_tr_b16 v[184:185], v4 offset:8192
ds_read_b64_tr_b16 v[186:187], v4 offset:12288
v_mfma_f32_16x16x32_bf16 v[104:107], v[152:155], a[68:71], v[104:107]
ds_read_b64_tr_b16 v[188:189], v5 offset:8192
v_mfma_f32_16x16x32_bf16 v[108:111], v[156:159], a[68:71], v[108:111]
ds_read_b64_tr_b16 v[190:191], v5 offset:12288
s_add_u32 s101, s101, 0x2000
v_mfma_f32_16x16x32_bf16 v[92:95], v[156:159], a[64:67], v[92:95]
buffer_load_dwordx4 a[96:99], v3, s[88:91], s101 offen sc1
v_mfma_f32_16x16x32_bf16 v[96:99], v[160:163], a[64:67], v[96:99]
ds_read_b64_tr_b16 v[192:193], v4 offset:8448
ds_read_b64_tr_b16 v[194:195], v4 offset:12544
v_mfma_f32_16x16x32_bf16 v[112:115], v[160:163], a[68:71], v[112:115]
ds_read_b64_tr_b16 v[196:197], v5 offset:8448
v_mfma_f32_16x16x32_bf16 v[116:119], v[164:167], a[68:71], v[116:119]
ds_read_b64_tr_b16 v[198:199], v5 offset:12544
s_waitcnt lgkmcnt(8)
v_mfma_f32_16x16x32_bf16 v[100:103], v[164:167], a[64:67], v[100:103]
buffer_load_dwordx4 a[100:103], v3, s[88:91], s101 offen offset:1024 sc1
v_mfma_f32_16x16x32_bf16 v[120:123], v[168:171], a[64:67], v[120:123]
ds_read_b64_tr_b16 v[200:201], v4 offset:8704
ds_read_b64_tr_b16 v[202:203], v4 offset:12800
v_mfma_f32_16x16x32_bf16 v[136:139], v[168:171], a[68:71], v[136:139]
ds_read_b64_tr_b16 v[204:205], v5 offset:8704
s_sub_u32 s15, s15, 1
v_mfma_f32_16x16x32_bf16 v[140:143], v[172:175], a[68:71], v[140:143]
ds_read_b64_tr_b16 v[206:207], v5 offset:12800
s_add_u32 s101, s101, 0x2000
v_mfma_f32_16x16x32_bf16 v[124:127], v[172:175], a[64:67], v[124:127]
buffer_load_dwordx4 a[104:107], v3, s[88:91], s101 offen sc1
v_mfma_f32_16x16x32_bf16 v[128:131], v[176:179], a[64:67], v[128:131]
ds_read_b64_tr_b16 v[208:209], v4 offset:8960
ds_read_b64_tr_b16 v[210:211], v4 offset:13056
v_mfma_f32_16x16x32_bf16 v[144:147], v[176:179], a[68:71], v[144:147]
ds_read_b64_tr_b16 v[212:213], v5 offset:8960
s_waitcnt vmcnt(7) lgkmcnt(7)
v_mfma_f32_16x16x32_bf16 v[148:151], v[180:183], a[68:71], v[148:151]
ds_read_b64_tr_b16 v[214:215], v5 offset:13056
s_barrier
v_mfma_f32_16x16x32_bf16 v[132:135], v[180:183], a[64:67], v[132:135]
buffer_load_dwordx4 a[108:111], v3, s[88:91], s101 offen offset:1024 sc1
s_cmp_lg_u32 s15, 0
s_cbranch_scc1 L_p4_loop
s_lshl_b32 s8, s99, 7
s_lshl_b32 s9, s4, 5
s_add_u32 s8, s8, s9
s_lshl_b32 s9, s8, 2
s_add_u32 s9, s9, 0x3600000
buffer_load_dword v8, v20, s[88:91], s9 offen sc1
buffer_load_dword v9, v20, s[88:91], s9 offen offset:64 sc1
v_mfma_f32_16x16x32_bf16 v[88:91], v[184:187], a[72:75], v[88:91]
ds_read_b64_tr_b16 v[152:153], v4 offset:16896
ds_read_b64_tr_b16 v[154:155], v4 offset:20992
v_mfma_f32_16x16x32_bf16 v[104:107], v[184:187], a[76:79], v[104:107]
ds_read_b64_tr_b16 v[156:157], v5 offset:16896
v_add_u32 v12, 0x20000, v12
v_mfma_f32_16x16x32_bf16 v[108:111], v[188:191], a[76:79], v[108:111]
ds_read_b64_tr_b16 v[158:159], v5 offset:20992
s_add_u32 m0, s17, 0x1c000
v_mfma_f32_16x16x32_bf16 v[92:95], v[188:191], a[72:75], v[92:95]
buffer_load_dwordx4 v12, s[64:67], 0 offen lds
v_mfma_f32_16x16x32_bf16 v[96:99], v[192:195], a[72:75], v[96:99]
ds_read_b64_tr_b16 v[160:161], v4 offset:17152
ds_read_b64_tr_b16 v[162:163], v4 offset:21248
v_mfma_f32_16x16x32_bf16 v[112:115], v[192:195], a[76:79], v[112:115]
ds_read_b64_tr_b16 v[164:165], v5 offset:17152
v_add_u32 v13, 0x20000, v13
v_mfma_f32_16x16x32_bf16 v[116:119], v[196:199], a[76:79], v[116:119]
ds_read_b64_tr_b16 v[166:167], v5 offset:21248
s_waitcnt lgkmcnt(8)
v_mfma_f32_16x16x32_bf16 v[100:103], v[196:199], a[72:75], v[100:103]
buffer_load_dwordx4 v13, s[64:67], 0 offen offset:1024 lds
v_mfma_f32_16x16x32_bf16 v[120:123], v[200:203], a[72:75], v[120:123]
ds_read_b64_tr_b16 v[168:169], v4 offset:25088
ds_read_b64_tr_b16 v[170:171], v4 offset:29184
v_mfma_f32_16x16x32_bf16 v[136:139], v[200:203], a[76:79], v[136:139]
ds_read_b64_tr_b16 v[172:173], v5 offset:25088
v_mfma_f32_16x16x32_bf16 v[140:143], v[204:207], a[76:79], v[140:143]
ds_read_b64_tr_b16 v[174:175], v5 offset:29184
v_mfma_f32_16x16x32_bf16 v[124:127], v[204:207], a[72:75], v[124:127]
buffer_load_dwordx4 v12, s[64:67], s12 offen offset:2048 lds
v_mfma_f32_16x16x32_bf16 v[128:131], v[208:211], a[72:75], v[128:131]
ds_read_b64_tr_b16 v[176:177], v4 offset:25344
ds_read_b64_tr_b16 v[178:179], v4 offset:29440
v_mfma_f32_16x16x32_bf16 v[144:147], v[208:211], a[76:79], v[144:147]
ds_read_b64_tr_b16 v[180:181], v5 offset:25344
s_waitcnt vmcnt(3) lgkmcnt(7)
v_mfma_f32_16x16x32_bf16 v[148:151], v[212:215], a[76:79], v[148:151]
ds_read_b64_tr_b16 v[182:183], v5 offset:29440
s_barrier
v_mfma_f32_16x16x32_bf16 v[132:135], v[212:215], a[72:75], v[132:135]
buffer_load_dwordx4 v13, s[64:67], s12 offen offset:3072 lds
v_and_b32 v18, 16, v0
v_lshrrev_b32 v19, 5, v0
v_lshlrev_b32 v19, 4, v19
v_lshl_add_u32 v18, v18, 1, v19
v_lshl_add_u32 v17, v20, 9, v18
s_lshl_b32 s8, s8, 11
s_lshl_b32 s9, s100, 8
s_add_u32 s8, s8, s9
s_lshl_b32 s9, s10, 7
s_add_u32 s8, s8, s9
s_add_u32 s9, s8, 0x8000
s_lshl_b32 s28, s2, 2
s_add_u32 s28, s28, s4
s_lshl_b32 s28, s28, 12
s_add_u32 s28, s28, 0x3800000
s_xor_b32 s30, s28, 0x4000
s_add_u32 s101, s101, 0x2000
s_nop 0
buffer_load_dwordx4 a[112:115], v3, s[88:91], s101 offen sc1
buffer_load_dwordx4 a[116:119], v3, s[88:91], s101 offen offset:1024 sc1
s_add_u32 s101, s101, 0x2000
s_nop 0
buffer_load_dwordx4 a[120:123], v3, s[88:91], s101 offen sc1
buffer_load_dwordx4 a[124:127], v3, s[88:91], s101 offen offset:1024 sc1
v_mfma_f32_16x16x32_bf16 v[120:123], v[152:155], a[80:83], v[120:123]
ds_read_b64_tr_b16 v[184:185], v4 offset:33280
v_sub_f32 v10, 1.0, v8
v_mfma_f32_16x16x32_bf16 v[136:139], v[152:155], a[84:87], v[136:139]
ds_read_b64_tr_b16 v[186:187], v4 offset:37376
v_sub_f32 v11, 1.0, v9
v_mfma_f32_16x16x32_bf16 v[140:143], v[156:159], a[84:87], v[140:143]
ds_read_b64_tr_b16 v[188:189], v5 offset:33280
v_mul_f32 v56, v10, v56
v_mfma_f32_16x16x32_bf16 v[124:127], v[156:159], a[80:83], v[124:127]
ds_read_b64_tr_b16 v[190:191], v5 offset:37376
v_mul_f32 v57, v10, v57
v_mfma_f32_16x16x32_bf16 v[128:131], v[160:163], a[80:83], v[128:131]
ds_read_b64_tr_b16 v[192:193], v4 offset:33536
v_mul_f32 v58, v10, v58
v_mfma_f32_16x16x32_bf16 v[144:147], v[160:163], a[84:87], v[144:147]
ds_read_b64_tr_b16 v[194:195], v4 offset:37632
v_mul_f32 v59, v10, v59
v_mfma_f32_16x16x32_bf16 v[148:151], v[164:167], a[84:87], v[148:151]
ds_read_b64_tr_b16 v[196:197], v5 offset:33536
s_waitcnt lgkmcnt(7)
v_mfma_f32_16x16x32_bf16 v[132:135], v[164:167], a[80:83], v[132:135]
ds_read_b64_tr_b16 v[198:199], v5 offset:37632
v_mul_f32 v60, v10, v60
v_mfma_f32_16x16x32_bf16 v[120:123], v[168:171], a[88:91], v[120:123]
ds_read_b64_tr_b16 v[200:201], v4 offset:41472
v_mul_f32 v61, v10, v61
v_mfma_f32_16x16x32_bf16 v[136:139], v[168:171], a[92:95], v[136:139]
ds_read_b64_tr_b16 v[202:203], v4 offset:45568
v_mul_f32 v62, v10, v62
v_mfma_f32_16x16x32_bf16 v[140:143], v[172:175], a[92:95], v[140:143]
ds_read_b64_tr_b16 v[204:205], v5 offset:41472
v_mul_f32 v63, v10, v63
v_mfma_f32_16x16x32_bf16 v[124:127], v[172:175], a[88:91], v[124:127]
ds_read_b64_tr_b16 v[206:207], v5 offset:45568
v_mul_f32 v64, v10, v64
v_mfma_f32_16x16x32_bf16 v[128:131], v[176:179], a[88:91], v[128:131]
ds_read_b64_tr_b16 v[208:209], v4 offset:41728
v_mul_f32 v65, v10, v65
v_mfma_f32_16x16x32_bf16 v[144:147], v[176:179], a[92:95], v[144:147]
ds_read_b64_tr_b16 v[210:211], v4 offset:45824
s_waitcnt vmcnt(0) lgkmcnt(6)
v_mfma_f32_16x16x32_bf16 v[148:151], v[180:183], a[92:95], v[148:151]
ds_read_b64_tr_b16 v[212:213], v5 offset:41728
s_barrier
v_mfma_f32_16x16x32_bf16 v[132:135], v[180:183], a[88:91], v[132:135]
ds_read_b64_tr_b16 v[214:215], v5 offset:45824
v_mul_f32 v66, v10, v66
v_mul_f32 v67, v10, v67
v_mfma_f32_16x16x32_bf16 v[120:123], v[184:187], a[96:99], v[120:123]
ds_read_b64_tr_b16 v[152:153], v4 offset:49664
v_mul_f32 v68, v10, v68
v_mfma_f32_16x16x32_bf16 v[136:139], v[184:187], a[100:103], v[136:139]
ds_read_b64_tr_b16 v[154:155], v4 offset:53760
v_mul_f32 v69, v10, v69
v_mfma_f32_16x16x32_bf16 v[140:143], v[188:191], a[100:103], v[140:143]
ds_read_b64_tr_b16 v[156:157], v5 offset:49664
v_mul_f32 v70, v10, v70
v_mfma_f32_16x16x32_bf16 v[124:127], v[188:191], a[96:99], v[124:127]
ds_read_b64_tr_b16 v[158:159], v5 offset:53760
v_mul_f32 v71, v10, v71
v_mfma_f32_16x16x32_bf16 v[128:131], v[192:195], a[96:99], v[128:131]
ds_read_b64_tr_b16 v[160:161], v4 offset:49920
v_mul_f32 v72, v11, v72
v_mfma_f32_16x16x32_bf16 v[144:147], v[192:195], a[100:103], v[144:147]
ds_read_b64_tr_b16 v[162:163], v4 offset:54016
v_mul_f32 v73, v11, v73
v_mfma_f32_16x16x32_bf16 v[148:151], v[196:199], a[100:103], v[148:151]
ds_read_b64_tr_b16 v[164:165], v5 offset:49920
s_waitcnt lgkmcnt(7)
v_mfma_f32_16x16x32_bf16 v[132:135], v[196:199], a[96:99], v[132:135]
ds_read_b64_tr_b16 v[166:167], v5 offset:54016
v_mul_f32 v74, v11, v74
v_mfma_f32_16x16x32_bf16 v[120:123], v[200:203], a[104:107], v[120:123]
ds_read_b64_tr_b16 v[168:169], v4 offset:57856
v_mul_f32 v75, v11, v75
v_mfma_f32_16x16x32_bf16 v[136:139], v[200:203], a[108:111], v[136:139]
ds_read_b64_tr_b16 v[170:171], v4 offset:61952
v_mul_f32 v76, v11, v76
v_mfma_f32_16x16x32_bf16 v[140:143], v[204:207], a[108:111], v[140:143]
ds_read_b64_tr_b16 v[172:173], v5 offset:57856
v_mul_f32 v77, v11, v77
v_mfma_f32_16x16x32_bf16 v[124:127], v[204:207], a[104:107], v[124:127]
ds_read_b64_tr_b16 v[174:175], v5 offset:61952
v_mul_f32 v78, v11, v78
v_mfma_f32_16x16x32_bf16 v[128:131], v[208:211], a[104:107], v[128:131]
ds_read_b64_tr_b16 v[176:177], v4 offset:58112
v_mul_f32 v79, v11, v79
v_mfma_f32_16x16x32_bf16 v[144:147], v[208:211], a[108:111], v[144:147]
ds_read_b64_tr_b16 v[178:179], v4 offset:62208
s_waitcnt lgkmcnt(6)
v_mfma_f32_16x16x32_bf16 v[148:151], v[212:215], a[108:111], v[148:151]
ds_read_b64_tr_b16 v[180:181], v5 offset:58112
v_mul_f32 v80, v11, v80
v_mfma_f32_16x16x32_bf16 v[132:135], v[212:215], a[104:107], v[132:135]
ds_read_b64_tr_b16 v[182:183], v5 offset:62208
v_mul_f32 v81, v11, v81
v_mfma_f32_16x16x32_bf16 v[120:123], v[152:155], a[112:115], v[120:123]
ds_read_b64_tr_b16 v[184:185], v4 offset:16384
v_mul_f32 v82, v11, v82
v_mfma_f32_16x16x32_bf16 v[136:139], v[152:155], a[116:119], v[136:139]
ds_read_b64_tr_b16 v[186:187], v4 offset:20480
v_mul_f32 v83, v11, v83
v_mfma_f32_16x16x32_bf16 v[140:143], v[156:159], a[116:119], v[140:143]
ds_read_b64_tr_b16 v[188:189], v5 offset:16384
v_mul_f32 v84, v11, v84
v_mfma_f32_16x16x32_bf16 v[124:127], v[156:159], a[112:115], v[124:127]
ds_read_b64_tr_b16 v[190:191], v5 offset:20480
v_mul_f32 v85, v11, v85
v_mfma_f32_16x16x32_bf16 v[128:131], v[160:163], a[112:115], v[128:131]
ds_read_b64_tr_b16 v[192:193], v4 offset:16640
v_mul_f32 v86, v11, v86
v_mfma_f32_16x16x32_bf16 v[144:147], v[160:163], a[116:119], v[144:147]
ds_read_b64_tr_b16 v[194:195], v4 offset:20736
v_mul_f32 v87, v11, v87
v_mfma_f32_16x16x32_bf16 v[148:151], v[164:167], a[116:119], v[148:151]
ds_read_b64_tr_b16 v[196:197], v5 offset:16640
s_waitcnt lgkmcnt(7)
v_mfma_f32_16x16x32_bf16 v[132:135], v[164:167], a[112:115], v[132:135]
ds_read_b64_tr_b16 v[198:199], v5 offset:20736
v_mul_f32 v24, v10, v24
v_mfma_f32_16x16x32_bf16 v[120:123], v[168:171], a[120:123], v[120:123]
ds_read_b64_tr_b16 v[200:201], v4 offset:24576
v_mul_f32 v25, v10, v25
v_mfma_f32_16x16x32_bf16 v[136:139], v[168:171], a[124:127], v[136:139]
ds_read_b64_tr_b16 v[202:203], v4 offset:28672
v_mul_f32 v26, v10, v26
v_mfma_f32_16x16x32_bf16 v[140:143], v[172:175], a[124:127], v[140:143]
ds_read_b64_tr_b16 v[204:205], v5 offset:24576
v_mul_f32 v27, v10, v27
v_mfma_f32_16x16x32_bf16 v[124:127], v[172:175], a[120:123], v[124:127]
ds_read_b64_tr_b16 v[206:207], v5 offset:28672
v_mul_f32 v28, v10, v28
v_mfma_f32_16x16x32_bf16 v[128:131], v[176:179], a[120:123], v[128:131]
ds_read_b64_tr_b16 v[208:209], v4 offset:24832
v_mul_f32 v29, v10, v29
v_mfma_f32_16x16x32_bf16 v[144:147], v[176:179], a[124:127], v[144:147]
ds_read_b64_tr_b16 v[210:211], v4 offset:28928
s_waitcnt lgkmcnt(6)
v_mfma_f32_16x16x32_bf16 v[148:151], v[180:183], a[124:127], v[148:151]
ds_read_b64_tr_b16 v[212:213], v5 offset:24832
v_mul_f32 v30, v10, v30
v_mfma_f32_16x16x32_bf16 v[132:135], v[180:183], a[120:123], v[132:135]
ds_read_b64_tr_b16 v[214:215], v5 offset:28928
v_mul_f32 v31, v10, v31
v_mfma_f32_16x16x32_bf16 v[88:91], v[184:187], a[80:83], v[88:91]
ds_read_b64_tr_b16 v[152:153], v4 offset:32768
v_mfma_f32_16x16x32_bf16 v[104:107], v[184:187], a[84:87], v[104:107]
ds_read_b64_tr_b16 v[154:155], v4 offset:36864
v_mfma_f32_16x16x32_bf16 v[108:111], v[188:191], a[84:87], v[108:111]
ds_read_b64_tr_b16 v[156:157], v5 offset:32768
v_mfma_f32_16x16x32_bf16 v[92:95], v[188:191], a[80:83], v[92:95]
ds_read_b64_tr_b16 v[158:159], v5 offset:36864
v_fmac_f32 v56, v8, v120
v_fmac_f32 v57, v8, v121
v_fmac_f32 v58, v8, v122
v_fmac_f32 v59, v8, v123
v_mfma_f32_16x16x32_bf16 v[96:99], v[192:195], a[80:83], v[96:99]
ds_read_b64_tr_b16 v[160:161], v4 offset:33024
v_fmac_f32 v60, v8, v124
v_fmac_f32 v61, v8, v125
v_fmac_f32 v62, v8, v126
v_fmac_f32 v63, v8, v127
v_mfma_f32_16x16x32_bf16 v[112:115], v[192:195], a[84:87], v[112:115]
ds_read_b64_tr_b16 v[162:163], v4 offset:37120
v_cvt_pk_bf16_f32 v56, v56, v57
v_cvt_pk_bf16_f32 v57, v58, v59
v_cvt_pk_bf16_f32 v58, v60, v61
v_cvt_pk_bf16_f32 v59, v62, v63
v_mfma_f32_16x16x32_bf16 v[116:119], v[196:199], a[84:87], v[116:119]
ds_read_b64_tr_b16 v[164:165], v5 offset:33024
s_waitcnt lgkmcnt(7)
buffer_store_dwordx4 v[56:59], v3, s[88:91], s30 offen offset:0 sc1
v_fmac_f32 v64, v8, v128
v_fmac_f32 v65, v8, v129
v_fmac_f32 v66, v8, v130
v_mfma_f32_16x16x32_bf16 v[100:103], v[196:199], a[80:83], v[100:103]
ds_read_b64_tr_b16 v[166:167], v5 offset:37120
v_fmac_f32 v67, v8, v131
v_fmac_f32 v68, v8, v132
v_fmac_f32 v69, v8, v133
v_fmac_f32 v70, v8, v134
v_mfma_f32_16x16x32_bf16 v[88:91], v[200:203], a[88:91], v[88:91]
ds_read_b64_tr_b16 v[168:169], v4 offset:40960
v_fmac_f32 v71, v8, v135
v_cvt_pk_bf16_f32 v64, v64, v65
v_cvt_pk_bf16_f32 v65, v66, v67
v_cvt_pk_bf16_f32 v66, v68, v69
v_mfma_f32_16x16x32_bf16 v[104:107], v[200:203], a[92:95], v[104:107]
ds_read_b64_tr_b16 v[170:171], v4 offset:45056
v_cvt_pk_bf16_f32 v67, v70, v71
buffer_store_dwordx4 v[64:67], v3, s[88:91], s30 offen offset:1024 sc1
v_fmac_f32 v72, v9, v136
v_fmac_f32 v73, v9, v137
v_mfma_f32_16x16x32_bf16 v[108:111], v[204:207], a[92:95], v[108:111]
ds_read_b64_tr_b16 v[172:173], v5 offset:40960
v_fmac_f32 v74, v9, v138
v_fmac_f32 v75, v9, v139
v_fmac_f32 v76, v9, v140
v_fmac_f32 v77, v9, v141
v_mfma_f32_16x16x32_bf16 v[92:95], v[204:207], a[88:91], v[92:95]
ds_read_b64_tr_b16 v[174:175], v5 offset:45056
v_fmac_f32 v78, v9, v142
v_fmac_f32 v79, v9, v143
v_cvt_pk_bf16_f32 v72, v72, v73
v_cvt_pk_bf16_f32 v73, v74, v75
v_mfma_f32_16x16x32_bf16 v[96:99], v[208:211], a[88:91], v[96:99]
ds_read_b64_tr_b16 v[176:177], v4 offset:41216
v_cvt_pk_bf16_f32 v74, v76, v77
v_cvt_pk_bf16_f32 v75, v78, v79
buffer_store_dwordx4 v[72:75], v3, s[88:91], s30 offen offset:2048 sc1
v_fmac_f32 v80, v9, v144
v_mfma_f32_16x16x32_bf16 v[112:115], v[208:211], a[92:95], v[112:115]
ds_read_b64_tr_b16 v[178:179], v4 offset:45312
s_waitcnt lgkmcnt(6)
v_fmac_f32 v81, v9, v145
v_fmac_f32 v82, v9, v146
v_fmac_f32 v83, v9, v147
v_fmac_f32 v84, v9, v148
v_mfma_f32_16x16x32_bf16 v[116:119], v[212:215], a[92:95], v[116:119]
ds_read_b64_tr_b16 v[180:181], v5 offset:41216
v_fmac_f32 v85, v9, v149
v_fmac_f32 v86, v9, v150
v_fmac_f32 v87, v9, v151
v_cvt_pk_bf16_f32 v80, v80, v81
v_mfma_f32_16x16x32_bf16 v[100:103], v[212:215], a[88:91], v[100:103]
ds_read_b64_tr_b16 v[182:183], v5 offset:45312
v_cvt_pk_bf16_f32 v81, v82, v83
v_cvt_pk_bf16_f32 v82, v84, v85
v_cvt_pk_bf16_f32 v83, v86, v87
buffer_store_dwordx4 v[80:83], v3, s[88:91], s30 offen offset:3072 sc1
v_mfma_f32_16x16x32_bf16 v[88:91], v[152:155], a[96:99], v[88:91]
ds_read_b64_tr_b16 v[184:185], v4 offset:49152
v_mul_f32 v32, v10, v32
v_mfma_f32_16x16x32_bf16 v[104:107], v[152:155], a[100:103], v[104:107]
ds_read_b64_tr_b16 v[186:187], v4 offset:53248
v_mul_f32 v33, v10, v33
v_mfma_f32_16x16x32_bf16 v[108:111], v[156:159], a[100:103], v[108:111]
ds_read_b64_tr_b16 v[188:189], v5 offset:49152
v_mul_f32 v34, v10, v34
v_mfma_f32_16x16x32_bf16 v[92:95], v[156:159], a[96:99], v[92:95]
ds_read_b64_tr_b16 v[190:191], v5 offset:53248
v_mul_f32 v35, v10, v35
v_mfma_f32_16x16x32_bf16 v[96:99], v[160:163], a[96:99], v[96:99]
ds_read_b64_tr_b16 v[192:193], v4 offset:49408
v_mul_f32 v36, v10, v36
v_mfma_f32_16x16x32_bf16 v[112:115], v[160:163], a[100:103], v[112:115]
ds_read_b64_tr_b16 v[194:195], v4 offset:53504
v_mul_f32 v37, v10, v37
v_mfma_f32_16x16x32_bf16 v[116:119], v[164:167], a[100:103], v[116:119]
ds_read_b64_tr_b16 v[196:197], v5 offset:49408
s_waitcnt lgkmcnt(7)
v_mfma_f32_16x16x32_bf16 v[100:103], v[164:167], a[96:99], v[100:103]
ds_read_b64_tr_b16 v[198:199], v5 offset:53504
v_mul_f32 v38, v10, v38
v_mfma_f32_16x16x32_bf16 v[88:91], v[168:171], a[104:107], v[88:91]
ds_read_b64_tr_b16 v[200:201], v4 offset:57344
v_mul_f32 v39, v10, v39
v_mfma_f32_16x16x32_bf16 v[104:107], v[168:171], a[108:111], v[104:107]
ds_read_b64_tr_b16 v[202:203], v4 offset:61440
v_mul_f32 v40, v11, v40
v_mfma_f32_16x16x32_bf16 v[108:111], v[172:175], a[108:111], v[108:111]
ds_read_b64_tr_b16 v[204:205], v5 offset:57344
v_mul_f32 v41, v11, v41
v_mfma_f32_16x16x32_bf16 v[92:95], v[172:175], a[104:107], v[92:95]
ds_read_b64_tr_b16 v[206:207], v5 offset:61440
v_mul_f32 v42, v11, v42
v_mfma_f32_16x16x32_bf16 v[96:99], v[176:179], a[104:107], v[96:99]
ds_read_b64_tr_b16 v[208:209], v4 offset:57600
v_mul_f32 v43, v11, v43
v_mfma_f32_16x16x32_bf16 v[112:115], v[176:179], a[108:111], v[112:115]
ds_read_b64_tr_b16 v[210:211], v4 offset:61696
s_waitcnt lgkmcnt(6)
v_mfma_f32_16x16x32_bf16 v[116:119], v[180:183], a[108:111], v[116:119]
ds_read_b64_tr_b16 v[212:213], v5 offset:57600
v_mul_f32 v44, v11, v44
v_mfma_f32_16x16x32_bf16 v[100:103], v[180:183], a[104:107], v[100:103]
ds_read_b64_tr_b16 v[214:215], v5 offset:61696
v_mul_f32 v45, v11, v45
v_mfma_f32_16x16x32_bf16 v[88:91], v[184:187], a[112:115], v[88:91]
v_mul_f32 v46, v11, v46
v_mul_f32 v47, v11, v47
v_mfma_f32_16x16x32_bf16 v[104:107], v[184:187], a[116:119], v[104:107]
v_mul_f32 v48, v11, v48
v_mul_f32 v49, v11, v49
v_mfma_f32_16x16x32_bf16 v[108:111], v[188:191], a[116:119], v[108:111]
v_mul_f32 v50, v11, v50
v_mul_f32 v51, v11, v51
v_mfma_f32_16x16x32_bf16 v[92:95], v[188:191], a[112:115], v[92:95]
v_mul_f32 v52, v11, v52
v_mul_f32 v53, v11, v53
v_mfma_f32_16x16x32_bf16 v[96:99], v[192:195], a[112:115], v[96:99]
v_mul_f32 v54, v11, v54
v_mul_f32 v55, v11, v55
v_mfma_f32_16x16x32_bf16 v[112:115], v[192:195], a[116:119], v[112:115]
v_mfma_f32_16x16x32_bf16 v[116:119], v[196:199], a[116:119], v[116:119]
s_waitcnt lgkmcnt(0)
v_mfma_f32_16x16x32_bf16 v[100:103], v[196:199], a[112:115], v[100:103]
v_mfma_f32_16x16x32_bf16 v[88:91], v[200:203], a[120:123], v[88:91]
v_mfma_f32_16x16x32_bf16 v[104:107], v[200:203], a[124:127], v[104:107]
v_mfma_f32_16x16x32_bf16 v[108:111], v[204:207], a[124:127], v[108:111]
v_mfma_f32_16x16x32_bf16 v[92:95], v[204:207], a[120:123], v[92:95]
v_mfma_f32_16x16x32_bf16 v[96:99], v[208:211], a[120:123], v[96:99]
v_mfma_f32_16x16x32_bf16 v[112:115], v[208:211], a[124:127], v[112:115]
v_mfma_f32_16x16x32_bf16 v[116:119], v[212:215], a[124:127], v[116:119]
v_mfma_f32_16x16x32_bf16 v[100:103], v[212:215], a[120:123], v[100:103]
buffer_load_dwordx4 v[152:155], v3, s[88:91], s28 offen offset:0 sc1
buffer_load_dwordx4 v[156:159], v3, s[88:91], s28 offen offset:1024 sc1
buffer_load_dwordx4 v[160:163], v3, s[88:91], s28 offen offset:2048 sc1
buffer_load_dwordx4 v[164:167], v3, s[88:91], s28 offen offset:3072 sc1
v_fmac_f32 v24, v8, v88
v_fmac_f32 v25, v8, v89
v_fmac_f32 v26, v8, v90
v_fmac_f32 v27, v8, v91
v_fmac_f32 v28, v8, v92
v_fmac_f32 v29, v8, v93
v_fmac_f32 v30, v8, v94
v_fmac_f32 v31, v8, v95
v_fmac_f32 v32, v8, v96
v_fmac_f32 v33, v8, v97
v_fmac_f32 v34, v8, v98
v_fmac_f32 v35, v8, v99
v_fmac_f32 v36, v8, v100
v_fmac_f32 v37, v8, v101
v_fmac_f32 v38, v8, v102
v_fmac_f32 v39, v8, v103
v_fmac_f32 v40, v9, v104
v_fmac_f32 v41, v9, v105
v_fmac_f32 v42, v9, v106
v_fmac_f32 v43, v9, v107
v_fmac_f32 v44, v9, v108
v_fmac_f32 v45, v9, v109
v_fmac_f32 v46, v9, v110
v_fmac_f32 v47, v9, v111
v_fmac_f32 v48, v9, v112
v_fmac_f32 v49, v9, v113
v_fmac_f32 v50, v9, v114
v_fmac_f32 v51, v9, v115
v_fmac_f32 v52, v9, v116
v_fmac_f32 v53, v9, v117
v_fmac_f32 v54, v9, v118
v_fmac_f32 v55, v9, v119
s_mov_b32 s92, 200000
L_spin_x:
s_waitcnt vmcnt(0)
v_max3_u32 v168, v152, v153, 0
v_max3_u32 v168, v154, v155, v168
v_max3_u32 v168, v156, v157, v168
v_max3_u32 v168, v158, v159, v168
v_max3_u32 v168, v160, v161, v168
v_max3_u32 v168, v162, v163, v168
v_max3_u32 v168, v164, v165, v168
v_max3_u32 v168, v166, v167, v168
v_cmp_eq_u32 vcc, -1, v168
s_sub_u32 s92, s92, 1
s_cbranch_scc1 L_spun_x
s_nop 3
s_cbranch_vccz L_spun_x
s_sleep 2
buffer_load_dwordx4 v[152:155], v3, s[88:91], s28 offen offset:0 sc1
buffer_load_dwordx4 v[156:159], v3, s[88:91], s28 offen offset:1024 sc1
buffer_load_dwordx4 v[160:163], v3, s[88:91], s28 offen offset:2048 sc1
buffer_load_dwordx4 v[164:167], v3, s[88:91], s28 offen offset:3072 sc1
s_branch L_spin_x
L_spun_x:
v_lshlrev_b32 v168, 16, v152
v_and_b32 v169, 0xffff0000, v152
v_pk_add_f32 v[24:25], v[24:25], v[168:169]
v_lshlrev_b32 v168, 16, v153
v_and_b32 v169, 0xffff0000, v153
v_pk_add_f32 v[26:27], v[26:27], v[168:169]
v_lshlrev_b32 v168, 16, v154
v_and_b32 v169, 0xffff0000, v154
v_pk_add_f32 v[28:29], v[28:29], v[168:169]
v_lshlrev_b32 v168, 16, v155
v_and_b32 v169, 0xffff0000, v155
v_pk_add_f32 v[30:31], v[30:31], v[168:169]
v_cvt_pk_bf16_f32 v24, v24, v25
v_cvt_pk_bf16_f32 v25, v26, v27
v_cvt_pk_bf16_f32 v26, v28, v29
v_cvt_pk_bf16_f32 v27, v30, v31
s_nop 1
v_permlane16_swap_b32 v24, v26
v_permlane16_swap_b32 v25, v27
buffer_store_dwordx4 v[24:27], v17, s[80:83], s8 offen offset:0
v_lshlrev_b32 v168, 16, v156
v_and_b32 v169, 0xffff0000, v156
v_pk_add_f32 v[32:33], v[32:33], v[168:169]
v_lshlrev_b32 v168, 16, v157
v_and_b32 v169, 0xffff0000, v157
v_pk_add_f32 v[34:35], v[34:35], v[168:169]
v_lshlrev_b32 v168, 16, v158
v_and_b32 v169, 0xffff0000, v158
v_pk_add_f32 v[36:37], v[36:37], v[168:169]
v_lshlrev_b32 v168, 16, v159
v_and_b32 v169, 0xffff0000, v159
v_pk_add_f32 v[38:39], v[38:39], v[168:169]
v_cvt_pk_bf16_f32 v32, v32, v33
v_cvt_pk_bf16_f32 v33, v34, v35
v_cvt_pk_bf16_f32 v34, v36, v37
v_cvt_pk_bf16_f32 v35, v38, v39
s_nop 1
v_permlane16_swap_b32 v32, v34
v_permlane16_swap_b32 v33, v35
buffer_store_dwordx4 v[32:35], v17, s[80:83], s8 offen offset:64
v_lshlrev_b32 v168, 16, v160
v_and_b32 v169, 0xffff0000, v160
v_pk_add_f32 v[40:41], v[40:41], v[168:169]
v_lshlrev_b32 v168, 16, v161
v_and_b32 v169, 0xffff0000, v161
v_pk_add_f32 v[42:43], v[42:43], v[168:169]
v_lshlrev_b32 v168, 16, v162
v_and_b32 v169, 0xffff0000, v162
v_pk_add_f32 v[44:45], v[44:45], v[168:169]
v_lshlrev_b32 v168, 16, v163
v_and_b32 v169, 0xffff0000, v163
v_pk_add_f32 v[46:47], v[46:47], v[168:169]
v_cvt_pk_bf16_f32 v40, v40, v41
v_cvt_pk_bf16_f32 v41, v42, v43
v_cvt_pk_bf16_f32 v42, v44, v45
v_cvt_pk_bf16_f32 v43, v46, v47
s_nop 1
v_permlane16_swap_b32 v40, v42
v_permlane16_swap_b32 v41, v43
buffer_store_dwordx4 v[40:43], v17, s[80:83], s9 offen offset:0
v_lshlrev_b32 v168, 16, v164
v_and_b32 v169, 0xffff0000, v164
v_pk_add_f32 v[48:49], v[48:49], v[168:169]
v_lshlrev_b32 v168, 16, v165
v_and_b32 v169, 0xffff0000, v165
v_pk_add_f32 v[50:51], v[50:51], v[168:169]
v_lshlrev_b32 v168, 16, v166
v_and_b32 v169, 0xffff0000, v166
v_pk_add_f32 v[52:53], v[52:53], v[168:169]
v_lshlrev_b32 v168, 16, v167
v_and_b32 v169, 0xffff0000, v167
v_pk_add_f32 v[54:55], v[54:55], v[168:169]
v_cvt_pk_bf16_f32 v48, v48, v49
v_cvt_pk_bf16_f32 v49, v50, v51
v_cvt_pk_bf16_f32 v50, v52, v53
v_cvt_pk_bf16_f32 v51, v54, v55
s_nop 1
v_permlane16_swap_b32 v48, v50
v_permlane16_swap_b32 v49, v51
buffer_store_dwordx4 v[48:51], v17, s[80:83], s9 offen offset:64
L_end:
s_endpgm
L_att_fallback:
s_waitcnt vmcnt(0)
s_mov_b32 s33, 1
s_mul_i32 s32, s5, 0x108000
s_lshl_b32 s19, s4, 13
s_add_u32 s32, s32, s19
s_cmp_eq_u32 s4, 0
s_cselect_b32 s99, 0x200000, 0
s_add_u32 s32, s32, s99
s_sub_u32 s99, 0x8000, s99
s_add_u32 s7, s32, 0x1000
s_add_u32 s27, s19, 131072
v_and_b32 v5, 15, v0
v_lshrrev_b32 v6, 4, v0
v_lshlrev_b32 v6, 2, v6
v_sub_u32 v5, v5, v6
v_mov_b32 v6, 0xf149f2ca
s_lshr_b32 s8, s20, 11
v_add_u32 v80, s8, v5
v_mov_b32 v8, v6
s_lshr_b32 s8, s21, 11
v_add_u32 v84, s8, v5
v_mov_b32 v9, v6
s_lshr_b32 s8, s22, 11
v_add_u32 v88, s8, v5
v_mov_b32 v10, v6
s_lshr_b32 s8, s23, 11
v_add_u32 v92, s8, v5
v_mov_b32 v11, v6
s_sub_u32 s15, 16, s6
s_lshl_b32 s15, s15, 1
L_fb_loop:
s_waitcnt lgkmcnt(0)
s_barrier
s_add_u32 m0, s19, 0x0
s_nop 0
buffer_load_dwordx4 v3, s[48:51], s32 offen offset:0 sc1 lds
buffer_load_dwordx4 v3, s[48:51], s32 offen offset:1024 sc1 lds
buffer_load_dwordx4 v3, s[48:51], s32 offen offset:2048 sc1 lds
buffer_load_dwordx4 v3, s[48:51], s32 offen offset:3072 sc1 lds
s_add_u32 m0, s19, 0x1000
s_nop 0
buffer_load_dwordx4 v3, s[48:51], s7 offen offset:0 sc1 lds
buffer_load_dwordx4 v3, s[48:51], s7 offen offset:1024 sc1 lds
buffer_load_dwordx4 v3, s[48:51], s7 offen offset:2048 sc1 lds
buffer_load_dwordx4 v3, s[48:51], s7 offen offset:3072 sc1 lds
s_add_u32 s32, s32, s99
s_add_u32 s7, s7, s99
s_mov_b32 s99, 0x8000
s_waitcnt vmcnt(0)
s_barrier
ds_read_b128 a[0:3], v3 offset:8192
ds_read_b128 a[4:7], v3 offset:9216
ds_read_b128 a[8:11], v3 offset:10240
ds_read_b128 a[12:15], v3 offset:11264
ds_read_b128 a[16:19], v3 offset:12288
ds_read_b128 a[20:23], v3 offset:13312
ds_read_b128 a[24:27], v3 offset:14336
ds_read_b128 a[28:31], v3 offset:15360
s_waitcnt lgkmcnt(0)
v_mfma_f32_16x16x32_bf16 v[16:19], a[0:3], a[160:163], 0
v_mfma_f32_16x16x32_bf16 v[16:19], a[4:7], a[164:167], v[16:19]
v_mfma_f32_16x16x32_bf16 v[16:19], a[8:11], a[168:171], v[16:19]
v_mfma_f32_16x16x32_bf16 v[16:19], a[12:15], a[172:175], v[16:19]
v_mfma_f32_16x16x32_bf16 v[20:23], a[0:3], a[176:179], 0
v_mfma_f32_16x16x32_bf16 v[20:23], a[4:7], a[180:183], v[20:23]
v_mfma_f32_16x16x32_bf16 v[20:23], a[8:11], a[184:187], v[20:23]
v_mfma_f32_16x16x32_bf16 v[20:23], a[12:15], a[188:191], v[20:23]
v_mfma_f32_16x16x32_bf16 v[24:27], a[0:3], a[192:195], 0
v_mfma_f32_16x16x32_bf16 v[24:27], a[4:7], a[196:199], v[24:27]
v_mfma_f32_16x16x32_bf16 v[24:27], a[8:11], a[200:203], v[24:27]
v_mfma_f32_16x16x32_bf16 v[24:27], a[12:15], a[204:207], v[24:27]
v_mfma_f32_16x16x32_bf16 v[28:31], a[0:3], a[208:211], 0
v_mfma_f32_16x16x32_bf16 v[28:31], a[4:7], a[212:215], v[28:31]
v_mfma_f32_16x16x32_bf16 v[28:31], a[8:11], a[216:219], v[28:31]
v_mfma_f32_16x16x32_bf16 v[28:31], a[12:15], a[220:223], v[28:31]
v_mfma_f32_16x16x32_bf16 v[32:35], a[16:19], a[160:163], 0
v_mfma_f32_16x16x32_bf16 v[32:35], a[20:23], a[164:167], v[32:35]
v_mfma_f32_16x16x32_bf16 v[32:35], a[24:27], a[168:171], v[32:35]
v_mfma_f32_16x16x32_bf16 v[32:35], a[28:31], a[172:175], v[32:35]
v_mfma_f32_16x16x32_bf16 v[36:39], a[16:19], a[176:179], 0
v_mfma_f32_16x16x32_bf16 v[36:39], a[20:23], a[180:183], v[36:39]
v_mfma_f32_16x16x32_bf16 v[36:39], a[24:27], a[184:187], v[36:39]
v_mfma_f32_16x16x32_bf16 v[36:39], a[28:31], a[188:191], v[36:39]
v_mfma_f32_16x16x32_bf16 v[40:43], a[16:19], a[192:195], 0
v_mfma_f32_16x16x32_bf16 v[40:43], a[20:23], a[196:199], v[40:43]
v_mfma_f32_16x16x32_bf16 v[40:43], a[24:27], a[200:203], v[40:43]
v_mfma_f32_16x16x32_bf16 v[40:43], a[28:31], a[204:207], v[40:43]
v_mfma_f32_16x16x32_bf16 v[44:47], a[16:19], a[208:211], 0
v_mfma_f32_16x16x32_bf16 v[44:47], a[20:23], a[212:215], v[44:47]
v_mfma_f32_16x16x32_bf16 v[44:47], a[24:27], a[216:219], v[44:47]
v_mfma_f32_16x16x32_bf16 v[44:47], a[28:31], a[220:223], v[44:47]
s_nop 7
v_cmp_le_i32 s[36:37], 0, v80
v_cmp_le_i32 s[38:39], 1, v80
v_cmp_le_i32 s[40:41], 2, v80
v_cmp_le_i32 s[42:43], 3, v80
s_nop 1
v_cndmask_b32 v16, v6, v16, s[36:37]
v_cndmask_b32 v17, v6, v17, s[38:39]
v_cndmask_b32 v18, v6, v18, s[40:41]
v_cndmask_b32 v19, v6, v19, s[42:43]
v_max3_f32 v8, v8, v16, v17
v_max3_f32 v8, v8, v18, v19
v_cmp_le_i32 s[36:37], 0, v84
v_cmp_le_i32 s[38:39], 1, v84
v_cmp_le_i32 s[40:41], 2, v84
v_cmp_le_i32 s[42:43], 3, v84
s_nop 1
v_cndmask_b32 v20, v6, v20, s[36:37]
v_cndmask_b32 v21, v6, v21, s[38:39]
v_cndmask_b32 v22, v6, v22, s[40:41]
v_cndmask_b32 v23, v6, v23, s[42:43]
v_max3_f32 v9, v9, v20, v21
v_max3_f32 v9, v9, v22, v23
v_cmp_le_i32 s[36:37], 0, v88
v_cmp_le_i32 s[38:39], 1, v88
v_cmp_le_i32 s[40:41], 2, v88
v_cmp_le_i32 s[42:43], 3, v88
s_nop 1
v_cndmask_b32 v24, v6, v24, s[36:37]
v_cndmask_b32 v25, v6, v25, s[38:39]
v_cndmask_b32 v26, v6, v26, s[40:41]
v_cndmask_b32 v27, v6, v27, s[42:43]
v_max3_f32 v10, v10, v24, v25
v_max3_f32 v10, v10, v26, v27
v_cmp_le_i32 s[36:37], 0, v92
v_cmp_le_i32 s[38:39], 1, v92
v_cmp_le_i32 s[40:41], 2, v92
v_cmp_le_i32 s[42:43], 3, v92
s_nop 1
v_cndmask_b32 v28, v6, v28, s[36:37]
v_cndmask_b32 v29, v6, v29, s[38:39]
v_cndmask_b32 v30, v6, v30, s[40:41]
v_cndmask_b32 v31, v6, v31, s[42:43]
v_max3_f32 v11, v11, v28, v29
v_max3_f32 v11, v11, v30, v31
v_cmp_le_i32 s[36:37], 16, v80
v_cmp_le_i32 s[38:39], 17, v80
v_cmp_le_i32 s[40:41], 18, v80
v_cmp_le_i32 s[42:43], 19, v80
s_nop 1
v_cndmask_b32 v32, v6, v32, s[36:37]
v_cndmask_b32 v33, v6, v33, s[38:39]
v_cndmask_b32 v34, v6, v34, s[40:41]
v_cndmask_b32 v35, v6, v35, s[42:43]
v_max3_f32 v8, v8, v32, v33
v_max3_f32 v8, v8, v34, v35
v_cmp_le_i32 s[36:37], 16, v84
v_cmp_le_i32 s[38:39], 17, v84
v_cmp_le_i32 s[40:41], 18, v84
v_cmp_le_i32 s[42:43], 19, v84
s_nop 1
v_cndmask_b32 v36, v6, v36, s[36:37]
v_cndmask_b32 v37, v6, v37, s[38:39]
v_cndmask_b32 v38, v6, v38, s[40:41]
v_cndmask_b32 v39, v6, v39, s[42:43]
v_max3_f32 v9, v9, v36, v37
v_max3_f32 v9, v9, v38, v39
v_cmp_le_i32 s[36:37], 16, v88
v_cmp_le_i32 s[38:39], 17, v88
v_cmp_le_i32 s[40:41], 18, v88
v_cmp_le_i32 s[42:43], 19, v88
s_nop 1
v_cndmask_b32 v40, v6, v40, s[36:37]
v_cndmask_b32 v41, v6, v41, s[38:39]
v_cndmask_b32 v42, v6, v42, s[40:41]
v_cndmask_b32 v43, v6, v43, s[42:43]
v_max3_f32 v10, v10, v40, v41
v_max3_f32 v10, v10, v42, v43
v_cmp_le_i32 s[36:37], 16, v92
v_cmp_le_i32 s[38:39], 17, v92
v_cmp_le_i32 s[40:41], 18, v92
v_cmp_le_i32 s[42:43], 19, v92
s_nop 1
v_cndmask_b32 v44, v6, v44, s[36:37]
v_cndmask_b32 v45, v6, v45, s[38:39]
v_cndmask_b32 v46, v6, v46, s[40:41]
v_cndmask_b32 v47, v6, v47, s[42:43]
v_max3_f32 v11, v11, v44, v45
v_max3_f32 v11, v11, v46, v47
ds_read_b128 a[0:3], v3 offset:24576
ds_read_b128 a[4:7], v3 offset:25600
ds_read_b128 a[8:11], v3 offset:26624
ds_read_b128 a[12:15], v3 offset:27648
ds_read_b128 a[16:19], v3 offset:28672
ds_read_b128 a[20:23], v3 offset:29696
ds_read_b128 a[24:27], v3 offset:30720
ds_read_b128 a[28:31], v3 offset:31744
s_waitcnt lgkmcnt(0)
v_mfma_f32_16x16x32_bf16 v[16:19], a[0:3], a[160:163], 0
v_mfma_f32_16x16x32_bf16 v[16:19], a[4:7], a[164:167], v[16:19]
v_mfma_f32_16x16x32_bf16 v[16:19], a[8:11], a[168:171], v[16:19]
v_mfma_f32_16x16x32_bf16 v[16:19], a[12:15], a[172:175], v[16:19]
v_mfma_f32_16x16x32_bf16 v[20:23], a[0:3], a[176:179], 0
v_mfma_f32_16x16x32_bf16 v[20:23], a[4:7], a[180:183], v[20:23]
v_mfma_f32_16x16x32_bf16 v[20:23], a[8:11], a[184:187], v[20:23]
v_mfma_f32_16x16x32_bf16 v[20:23], a[12:15], a[188:191], v[20:23]
v_mfma_f32_16x16x32_bf16 v[24:27], a[0:3], a[192:195], 0
v_mfma_f32_16x16x32_bf16 v[24:27], a[4:7], a[196:199], v[24:27]
v_mfma_f32_16x16x32_bf16 v[24:27], a[8:11], a[200:203], v[24:27]
v_mfma_f32_16x16x32_bf16 v[24:27], a[12:15], a[204:207], v[24:27]
v_mfma_f32_16x16x32_bf16 v[28:31], a[0:3], a[208:211], 0
v_mfma_f32_16x16x32_bf16 v[28:31], a[4:7], a[212:215], v[28:31]
v_mfma_f32_16x16x32_bf16 v[28:31], a[8:11], a[216:219], v[28:31]
v_mfma_f32_16x16x32_bf16 v[28:31], a[12:15], a[220:223], v[28:31]
v_mfma_f32_16x16x32_bf16 v[32:35], a[16:19], a[160:163], 0
v_mfma_f32_16x16x32_bf16 v[32:35], a[20:23], a[164:167], v[32:35]
v_mfma_f32_16x16x32_bf16 v[32:35], a[24:27], a[168:171], v[32:35]
v_mfma_f32_16x16x32_bf16 v[32:35], a[28:31], a[172:175], v[32:35]
v_mfma_f32_16x16x32_bf16 v[36:39], a[16:19], a[176:179], 0
v_mfma_f32_16x16x32_bf16 v[36:39], a[20:23], a[180:183], v[36:39]
v_mfma_f32_16x16x32_bf16 v[36:39], a[24:27], a[184:187], v[36:39]
v_mfma_f32_16x16x32_bf16 v[36:39], a[28:31], a[188:191], v[36:39]
v_mfma_f32_16x16x32_bf16 v[40:43], a[16:19], a[192:195], 0
v_mfma_f32_16x16x32_bf16 v[40:43], a[20:23], a[196:199], v[40:43]
v_mfma_f32_16x16x32_bf16 v[40:43], a[24:27], a[200:203], v[40:43]
v_mfma_f32_16x16x32_bf16 v[40:43], a[28:31], a[204:207], v[40:43]
v_mfma_f32_16x16x32_bf16 v[44:47], a[16:19], a[208:211], 0
v_mfma_f32_16x16x32_bf16 v[44:47], a[20:23], a[212:215], v[44:47]
v_mfma_f32_16x16x32_bf16 v[44:47], a[24:27], a[216:219], v[44:47]
v_mfma_f32_16x16x32_bf16 v[44:47], a[28:31], a[220:223], v[44:47]
s_nop 7
v_cmp_le_i32 s[36:37], 32, v80
v_cmp_le_i32 s[38:39], 33, v80
v_cmp_le_i32 s[40:41], 34, v80
v_cmp_le_i32 s[42:43], 35, v80
s_nop 1
v_cndmask_b32 v16, v6, v16, s[36:37]
v_cndmask_b32 v17, v6, v17, s[38:39]
v_cndmask_b32 v18, v6, v18, s[40:41]
v_cndmask_b32 v19, v6, v19, s[42:43]
v_max3_f32 v8, v8, v16, v17
v_max3_f32 v8, v8, v18, v19
v_cmp_le_i32 s[36:37], 32, v84
v_cmp_le_i32 s[38:39], 33, v84
v_cmp_le_i32 s[40:41], 34, v84
v_cmp_le_i32 s[42:43], 35, v84
s_nop 1
v_cndmask_b32 v20, v6, v20, s[36:37]
v_cndmask_b32 v21, v6, v21, s[38:39]
v_cndmask_b32 v22, v6, v22, s[40:41]
v_cndmask_b32 v23, v6, v23, s[42:43]
v_max3_f32 v9, v9, v20, v21
v_max3_f32 v9, v9, v22, v23
v_cmp_le_i32 s[36:37], 32, v88
v_cmp_le_i32 s[38:39], 33, v88
v_cmp_le_i32 s[40:41], 34, v88
v_cmp_le_i32 s[42:43], 35, v88
s_nop 1
v_cndmask_b32 v24, v6, v24, s[36:37]
v_cndmask_b32 v25, v6, v25, s[38:39]
v_cndmask_b32 v26, v6, v26, s[40:41]
v_cndmask_b32 v27, v6, v27, s[42:43]
v_max3_f32 v10, v10, v24, v25
v_max3_f32 v10, v10, v26, v27
v_cmp_le_i32 s[36:37], 32, v92
v_cmp_le_i32 s[38:39], 33, v92
v_cmp_le_i32 s[40:41], 34, v92
v_cmp_le_i32 s[42:43], 35, v92
s_nop 1
v_cndmask_b32 v28, v6, v28, s[36:37]
v_cndmask_b32 v29, v6, v29, s[38:39]
v_cndmask_b32 v30, v6, v30, s[40:41]
v_cndmask_b32 v31, v6, v31, s[42:43]
v_max3_f32 v11, v11, v28, v29
v_max3_f32 v11, v11, v30, v31
v_cmp_le_i32 s[36:37], 48, v80
v_cmp_le_i32 s[38:39], 49, v80
v_cmp_le_i32 s[40:41], 50, v80
v_cmp_le_i32 s[42:43], 51, v80
s_nop 1
v_cndmask_b32 v32, v6, v32, s[36:37]
v_cndmask_b32 v33, v6, v33, s[38:39]
v_cndmask_b32 v34, v6, v34, s[40:41]
v_cndmask_b32 v35, v6, v35, s[42:43]
v_max3_f32 v8, v8, v32, v33
v_max3_f32 v8, v8, v34, v35
v_cmp_le_i32 s[36:37], 48, v84
v_cmp_le_i32 s[38:39], 49, v84
v_cmp_le_i32 s[40:41], 50, v84
v_cmp_le_i32 s[42:43], 51, v84
s_nop 1
v_cndmask_b32 v36, v6, v36, s[36:37]
v_cndmask_b32 v37, v6, v37, s[38:39]
v_cndmask_b32 v38, v6, v38, s[40:41]
v_cndmask_b32 v39, v6, v39, s[42:43]
v_max3_f32 v9, v9, v36, v37
v_max3_f32 v9, v9, v38, v39
v_cmp_le_i32 s[36:37], 48, v88
v_cmp_le_i32 s[38:39], 49, v88
v_cmp_le_i32 s[40:41], 50, v88
v_cmp_le_i32 s[42:43], 51, v88
s_nop 1
v_cndmask_b32 v40, v6, v40, s[36:37]
v_cndmask_b32 v41, v6, v41, s[38:39]
v_cndmask_b32 v42, v6, v42, s[40:41]
v_cndmask_b32 v43, v6, v43, s[42:43]
v_max3_f32 v10, v10, v40, v41
v_max3_f32 v10, v10, v42, v43
v_cmp_le_i32 s[36:37], 48, v92
v_cmp_le_i32 s[38:39], 49, v92
v_cmp_le_i32 s[40:41], 50, v92
v_cmp_le_i32 s[42:43], 51, v92
s_nop 1
v_cndmask_b32 v44, v6, v44, s[36:37]
v_cndmask_b32 v45, v6, v45, s[38:39]
v_cndmask_b32 v46, v6, v46, s[40:41]
v_cndmask_b32 v47, v6, v47, s[42:43]
v_max3_f32 v11, v11, v44, v45
v_max3_f32 v11, v11, v46, v47
v_subrev_u32 v80, 64, v80
v_subrev_u32 v84, 64, v84
v_subrev_u32 v88, 64, v88
v_subrev_u32 v92, 64, v92
s_sub_u32 s15, s15, 1
s_cmp_lg_u32 s15, 0
s_cbranch_scc1 L_fb_loop
v_mov_b32 v12, v8
v_mov_b32 v13, v9
v_mov_b32 v14, v10
v_mov_b32 v15, v11
s_nop 1
v_permlane16_swap_b32 v12, v8
v_permlane16_swap_b32 v13, v9
v_permlane16_swap_b32 v14, v10
v_permlane16_swap_b32 v15, v11
v_max_f32 v8, v8, v12
v_max_f32 v9, v9, v13
v_max_f32 v10, v10, v14
v_max_f32 v11, v11, v15
v_mov_b32 v12, v8
v_mov_b32 v13, v9
v_mov_b32 v14, v10
v_mov_b32 v15, v11
s_nop 1
v_permlane32_swap_b32 v12, v8
v_permlane32_swap_b32 v13, v9
v_permlane32_swap_b32 v14, v10
v_permlane32_swap_b32 v15, v11
v_max_f32 v8, v8, v12
v_max_f32 v9, v9, v13
v_max_f32 v10, v10, v14
v_max_f32 v11, v11, v15
s_barrier
s_mul_i32 s32, s5, 0x108000
s_lshl_b32 s19, s4, 13
s_add_u32 s32, s32, s19
s_cmp_eq_u32 s4, 0
s_cselect_b32 s99, 0x200000, 0
s_add_u32 s32, s32, s99
s_sub_u32 s99, 0x8000, s99
s_add_u32 s7, s32, 0x1000
s_add_u32 s27, s19, 131072
s_add_u32 m0, s19, 0x0
s_nop 0
buffer_load_dwordx4 v3, s[48:51], s32 offen offset:0 sc1 lds
buffer_load_dwordx4 v3, s[48:51], s32 offen offset:1024 sc1 lds
buffer_load_dwordx4 v3, s[48:51], s32 offen offset:2048 sc1 lds
buffer_load_dwordx4 v3, s[48:51], s32 offen offset:3072 sc1 lds
s_add_u32 m0, s19, 0x1000
s_nop 0
buffer_load_dwordx4 v3, s[48:51], s7 offen offset:0 sc1 lds
buffer_load_dwordx4 v3, s[48:51], s7 offen offset:1024 sc1 lds
buffer_load_dwordx4 v3, s[48:51], s7 offen offset:2048 sc1 lds
buffer_load_dwordx4 v3, s[48:51], s7 offen offset:3072 sc1 lds
s_add_u32 s32, s32, s99
s_add_u32 s7, s7, s99
s_add_u32 m0, s19, 0x18000
s_nop 0
buffer_load_dwordx4 v3, s[48:51], s32 offen offset:0 sc1 lds
buffer_load_dwordx4 v3, s[48:51], s32 offen offset:1024 sc1 lds
buffer_load_dwordx4 v3, s[48:51], s32 offen offset:2048 sc1 lds
buffer_load_dwordx4 v3, s[48:51], s32 offen offset:3072 sc1 lds
s_add_u32 m0, s19, 0x19000
s_nop 0
buffer_load_dwordx4 v3, s[48:51], s7 offen offset:0 sc1 lds
buffer_load_dwordx4 v3, s[48:51], s7 offen offset:1024 sc1 lds
buffer_load_dwordx4 v3, s[48:51], s7 offen offset:2048 sc1 lds
buffer_load_dwordx4 v3, s[48:51], s7 offen offset:3072 sc1 lds
s_add_u32 s32, s32, 0x8000
s_add_u32 s7, s7, 0x8000
s_add_u32 m0, s19, 0x8000
s_nop 0
buffer_load_dwordx4 v3, s[48:51], s32 offen offset:0 sc1 lds
buffer_load_dwordx4 v3, s[48:51], s32 offen offset:1024 sc1 lds
buffer_load_dwordx4 v3, s[48:51], s32 offen offset:2048 sc1 lds
buffer_load_dwordx4 v3, s[48:51], s32 offen offset:3072 sc1 lds
s_add_u32 m0, s19, 0x9000
s_nop 0
buffer_load_dwordx4 v3, s[48:51], s7 offen offset:0 sc1 lds
buffer_load_dwordx4 v3, s[48:51], s7 offen offset:1024 sc1 lds
buffer_load_dwordx4 v3, s[48:51], s7 offen offset:2048 sc1 lds
buffer_load_dwordx4 v3, s[48:51], s7 offen offset:3072 sc1 lds
s_add_u32 s32, s32, 0x8000
s_add_u32 s7, s7, 0x8000
s_waitcnt vmcnt(16)
s_branch L_att_start
.section .rodata,"a"
.p2align 6
.amdhsa_kernel gated_mix__compressed_kv_cla__sliding_local_dilated__prompt_kernel
  .amdhsa_next_free_vgpr 512
  .amdhsa_next_free_sgpr 102
  .amdhsa_accum_offset 256
  .amdhsa_group_segment_fixed_size 0
  .amdhsa_kernarg_size 104
  .amdhsa_user_sgpr_count 2
  .amdhsa_user_sgpr_kernarg_segment_ptr 1
  .amdhsa_system_sgpr_workgroup_id_x 1
.end_amdhsa_kernel
```

```asm
; @launch grid=(256,1,1) block=(256,1,1) lds=163840
.amdgcn_target "amdgcn-amd-amdhsa--gfx950"
.text
.globl gated_mix__compressed_kv_cla__sliding_local_dilated__prompt_kernel
.p2align 8
.type gated_mix__compressed_kv_cla__sliding_local_dilated__prompt_kernel,@function
gated_mix__compressed_kv_cla__sliding_local_dilated__prompt_kernel:
s_load_dwordx16 s[16:31], s[0:1], 0
s_load_dwordx8 s[32:39], s[0:1], 64
s_load_dwordx2 s[88:89], s[0:1], 96
s_cmp_ge_u32 s2, 256
s_cbranch_scc1 L_end
v_lshrrev_b32 v1, 6, v0
v_and_b32 v0, 63, v0
v_readfirstlane_b32 s4, v1
s_and_b32 s5, s2, 7
s_lshl_b32 s5, s5, 2
s_bfe_u32 s3, s2, 0x20003
s_add_u32 s5, s5, s3
s_lshr_b32 s6, s2, 5
s_mov_b32 s12, 0x4000
s_mov_b32 s13, 0x8000
s_mov_b32 s14, 0xc000
s_mov_b32 s46, 0x400000
s_mov_b32 s47, 0x20000
s_mov_b32 s50, 0x200000
s_mov_b32 s51, 0x20000
s_mov_b32 s54, 0x800000
s_mov_b32 s55, 0x20000
s_mov_b32 s58, 0x400000
s_mov_b32 s59, 0x20000
s_mov_b32 s62, 0x400000
s_mov_b32 s63, 0x20000
s_mov_b32 s66, 0x800000
s_mov_b32 s67, 0x20000
s_mov_b32 s70, 0x600000
s_mov_b32 s71, 0x20000
s_mov_b32 s74, 0x200000
s_mov_b32 s75, 0x20000
s_mov_b32 s78, 0x800
s_mov_b32 s79, 0x20000
s_mov_b32 s82, 0x400000
s_mov_b32 s83, 0x20000
s_mov_b32 s86, 0x100
s_mov_b32 s87, 0x20000
s_mov_b32 s90, 0x10000000
s_mov_b32 s91, 0x20000
v_lshlrev_b32 v16, 4, v0
v_bfe_u32 v17, v0, 2, 2
s_lshl_b32 s8, s4, 4
v_add_u32 v17, s8, v17
v_lshlrev_b32 v17, 13, v17
v_lshrrev_b32 v18, 4, v0
v_lshl_add_u32 v17, v18, 6, v17
v_and_b32 v18, 3, v0
v_lshl_add_u32 v17, v18, 4, v17
s_lshl_b32 s8, s5, 8
v_add_u32 v5, s8, v17
v_xor_b32 v6, 32, v5
v_add_u32 v6, 0x10000, v6
v_lshrrev_b32 v17, 4, v0
v_xor_b32 v17, v17, v0
v_and_b32 v17, 7, v17
v_lshlrev_b32 v17, 4, v17
v_lshrrev_b32 v18, 3, v0
v_lshl_add_u32 v2, v18, 10, v17
s_lshl_b32 s8, s6, 18
s_lshl_b32 s9, s4, 16
s_add_u32 s8, s8, s9
v_add_u32 v2, s8, v2
v_xor_b32 v3, 64, v2
v_add_u32 v3, 0x2000, v3
s_sub_u32 s10, 15, s6
s_cmp_lt_u32 s5, 16
s_cselect_b32 s10, s6, s10
s_lshl_b32 s10, s10, 4
s_and_b32 s11, s5, 15
s_add_u32 s10, s10, s11
s_lshl_b32 s10, s10, 3
s_lshl_b32 s11, s4, 1
s_add_u32 s10, s10, s11
s_lshl_b32 s100, s10, 11
s_lshl_b32 s101, s10, 2
s_add_u32 s101, s101, 0x3600000
s_waitcnt lgkmcnt(0)
s_mov_b64 s[48:49], s[18:19]
s_mov_b64 s[56:57], s[22:23]
s_mov_b64 s[60:61], s[24:25]
L_args:
s_mov_b64 s[44:45], s[16:17]
s_mov_b64 s[76:77], s[34:35]
s_mov_b64 s[52:53], s[20:21]
s_mov_b64 s[64:65], s[26:27]
s_mov_b64 s[68:69], s[30:31]
s_mov_b64 s[72:73], s[32:33]
s_mov_b64 s[80:81], s[36:37]
s_mov_b64 s[84:85], s[38:39]
s_lshl_b32 s16, s4, 13
s_add_u32 s16, s16, 0x18000
s_lshl_b32 s17, s4, 12
s_lshl_b32 s18, s4, 10
s_mov_b32 s25, 0x800
s_mov_b32 s26, 0x1000
s_mov_b32 s3, 0
s_add_u32 m0, s17, 0x0
s_nop 0
buffer_load_dwordx4 v5, s[56:59], 0 offen lds
s_add_u32 m0, s17, 0x4000
s_nop 0
buffer_load_dwordx4 v5, s[60:63], 0 offen lds
s_add_u32 m0, s17, 0x400
s_nop 0
buffer_load_dwordx4 v5, s[56:59], s13 offen lds
s_add_u32 m0, s17, 0x4400
s_nop 0
buffer_load_dwordx4 v5, s[60:63], s13 offen lds
s_add_u32 m0, s17, 0x800
s_nop 0
buffer_load_dwordx4 v6, s[56:59], 0 offen lds
s_add_u32 m0, s17, 0x4800
s_nop 0
buffer_load_dwordx4 v6, s[60:63], 0 offen lds
s_add_u32 m0, s17, 0xc00
s_nop 0
buffer_load_dwordx4 v6, s[56:59], s13 offen lds
s_add_u32 m0, s17, 0x4c00
s_nop 0
buffer_load_dwordx4 v6, s[60:63], s13 offen lds
v_add_u32 v5, 0x80000, v5
v_add_u32 v6, 0x80000, v6
s_add_u32 m0, s16, 0x0
s_nop 0
buffer_load_dwordx4 v2, s[48:51], 0 offen lds
s_add_u32 m0, s16, 0x400
s_nop 0
buffer_load_dwordx4 v3, s[48:51], 0 offen lds
s_add_u32 m0, s16, 0x800
s_nop 0
buffer_load_dwordx4 v2, s[48:51], s12 offen lds
s_add_u32 m0, s16, 0xc00
s_nop 0
buffer_load_dwordx4 v3, s[48:51], s12 offen lds
s_add_u32 m0, s16, 0x1000
s_nop 0
buffer_load_dwordx4 v2, s[48:51], s13 offen lds
s_add_u32 m0, s16, 0x1400
s_nop 0
buffer_load_dwordx4 v3, s[48:51], s13 offen lds
s_add_u32 m0, s16, 0x1800
s_nop 0
buffer_load_dwordx4 v2, s[48:51], s14 offen lds
s_add_u32 m0, s16, 0x1c00
s_nop 0
buffer_load_dwordx4 v3, s[48:51], s14 offen lds
v_add_u32 v2, 0x80, v2
v_add_u32 v3, 0x80, v3
s_add_u32 m0, s17, 0x8000
s_nop 0
buffer_load_dwordx4 v5, s[56:59], 0 offen lds
s_add_u32 m0, s17, 0xc000
s_nop 0
buffer_load_dwordx4 v5, s[60:63], 0 offen lds
s_add_u32 m0, s17, 0x8400
s_nop 0
buffer_load_dwordx4 v5, s[56:59], s13 offen lds
s_add_u32 m0, s17, 0xc400
s_nop 0
buffer_load_dwordx4 v5, s[60:63], s13 offen lds
s_add_u32 m0, s17, 0x8800
s_nop 0
buffer_load_dwordx4 v6, s[56:59], 0 offen lds
s_add_u32 m0, s17, 0xc800
s_nop 0
buffer_load_dwordx4 v6, s[60:63], 0 offen lds
s_add_u32 m0, s17, 0x8c00
s_nop 0
buffer_load_dwordx4 v6, s[56:59], s13 offen lds
s_add_u32 m0, s17, 0xcc00
s_nop 0
buffer_load_dwordx4 v6, s[60:63], s13 offen lds
v_add_u32 v5, 0x80000, v5
v_add_u32 v6, 0x80000, v6
s_add_u32 m0, s16, 0x8000
s_nop 0
buffer_load_dwordx4 v2, s[48:51], 0 offen lds
s_add_u32 m0, s16, 0x8400
s_nop 0
buffer_load_dwordx4 v3, s[48:51], 0 offen lds
s_add_u32 m0, s16, 0x8800
s_nop 0
buffer_load_dwordx4 v2, s[48:51], s12 offen lds
s_add_u32 m0, s16, 0x8c00
s_nop 0
buffer_load_dwordx4 v3, s[48:51], s12 offen lds
s_add_u32 m0, s16, 0x9000
s_nop 0
buffer_load_dwordx4 v2, s[48:51], s13 offen lds
s_add_u32 m0, s16, 0x9400
s_nop 0
buffer_load_dwordx4 v3, s[48:51], s13 offen lds
s_add_u32 m0, s16, 0x9800
s_nop 0
buffer_load_dwordx4 v2, s[48:51], s14 offen lds
s_add_u32 m0, s16, 0x9c00
s_nop 0
buffer_load_dwordx4 v3, s[48:51], s14 offen lds
v_add_u32 v2, 0x80, v2
v_add_u32 v3, 0x80, v3
s_add_u32 m0, s17, 0x10000
s_nop 0
buffer_load_dwordx4 v5, s[56:59], 0 offen lds
s_add_u32 m0, s17, 0x14000
s_nop 0
buffer_load_dwordx4 v5, s[60:63], 0 offen lds
s_add_u32 m0, s17, 0x10400
s_nop 0
buffer_load_dwordx4 v5, s[56:59], s13 offen lds
s_add_u32 m0, s17, 0x14400
s_nop 0
buffer_load_dwordx4 v5, s[60:63], s13 offen lds
s_add_u32 m0, s17, 0x10800
s_nop 0
buffer_load_dwordx4 v6, s[56:59], 0 offen lds
s_add_u32 m0, s17, 0x14800
s_nop 0
buffer_load_dwordx4 v6, s[60:63], 0 offen lds
s_add_u32 m0, s17, 0x10c00
s_nop 0
buffer_load_dwordx4 v6, s[56:59], s13 offen lds
s_add_u32 m0, s17, 0x14c00
s_nop 0
buffer_load_dwordx4 v6, s[60:63], s13 offen lds
v_add_u32 v5, 0x80000, v5
v_add_u32 v6, 0x80000, v6
v_lshrrev_b32 v17, 4, v0
v_xor_b32 v17, v17, v0
v_and_b32 v17, 7, v17
v_lshlrev_b32 v17, 4, v17
v_lshrrev_b32 v18, 3, v0
v_lshl_add_u32 v22, v18, 11, v17
v_xor_b32 v23, 64, v22
v_add_u32 v23, 0x4000, v23
s_and_b32 s8, s4, 1
s_lshl_b32 s9, s8, 6
s_lshl_b32 s8, s8, 14
v_xor_b32 v4, s9, v22
v_add_u32 v4, s8, v4
s_lshl_b32 s8, s6, 18
s_sub_u32 s9, 15, s6
s_lshl_b32 s9, s9, 18
s_lshl_b32 s10, s4, 15
s_sub_u32 s11, 0x38000, s10
s_add_u32 s20, s8, s10
s_add_u32 s21, s8, s11
s_add_u32 s22, s9, s10
s_add_u32 s23, s9, s11
s_cmp_lt_u32 s4, 2
s_cselect_b32 s24, s8, s9
s_max_u32 s24, s24, 0x8000
s_sub_u32 s24, s24, 0x8000
v_lshrrev_b32 v17, 2, v0
s_lshl_b32 s8, s4, 4
v_add_u32 v17, s8, v17
v_mul_u32_u24 v17, 0x1800, v17
v_and_b32 v18, 3, v0
v_lshlrev_b32 v18, 4, v18
v_and_b32 v19, 32, v0
v_xor_b32 v18, v18, v19
s_lshl_b32 s8, s5, 6
v_add3_u32 v7, v17, v18, s8
v_and_b32 v17, 15, v0
v_lshrrev_b32 v18, 1, v17
v_lshrrev_b32 v19, 4, v0
v_xor_b32 v18, v18, v19
v_lshlrev_b32 v18, 4, v18
v_lshl_add_u32 v10, v17, 7, v18
v_add_u32 v8, s16, v10
v_xor_b32 v9, 64, v8
s_lshr_b32 s8, s4, 1
s_lshl_b32 s8, s8, 11
s_add_u32 s8, s8, 94208
v_add_u32 v10, s8, v10
v_xor_b32 v11, 64, v10
v_lshrrev_b32 v17, 4, v0
v_lshlrev_b32 v18, 11, v17
v_and_b32 v17, 1, v17
v_lshl_add_u32 v18, v17, 5, v18
v_bfe_u32 v17, v0, 2, 2
v_lshl_add_u32 v18, v17, 6, v18
v_and_b32 v17, 3, v0
v_lshl_add_u32 v12, v17, 3, v18
v_xor_b32 v13, 32, v12
v_lshrrev_b32 v17, 4, v0
v_lshlrev_b32 v18, 9, v17
v_and_b32 v17, 1, v17
v_lshl_add_u32 v18, v17, 5, v18
v_bfe_u32 v17, v0, 2, 2
v_lshl_add_u32 v18, v17, 6, v18
v_and_b32 v17, 3, v0
v_lshl_add_u32 v14, v17, 3, v18
s_and_b32 s8, s4, 1
s_lshl_b32 s8, s8, 5
v_xor_b32 v14, s8, v14
v_add_u32 v14, 81920, v14
v_xor_b32 v15, 32, v14
s_mul_i32 s32, s5, 0x108000
s_lshl_b32 s19, s4, 13
s_add_u32 s32, s32, s19
s_cmp_eq_u32 s4, 0
s_cselect_b32 s99, 0x200000, 0
s_add_u32 s32, s32, s99
s_sub_u32 s99, 0x8000, s99
s_add_u32 s7, s32, 0x1000
s_add_u32 s27, s19, 131072
v_accvgpr_write_b32 a152, v10
v_accvgpr_write_b32 a153, v11
v_accvgpr_write_b32 a154, v4
v_accvgpr_write_b32 a155, v7
v_accvgpr_write_b32 a156, v14
v_accvgpr_write_b32 a157, v15
s_lshl_b32 s8, s2, 2
s_add_u32 s8, s8, s4
s_lshl_b32 s8, s8, 11
v_lshrrev_b32 v19, 2, v0
v_lshl_add_u32 v19, v19, 7, s8
s_mov_b32 s9, 0x0
s_nop 0
buffer_load_dword a120, v19, s[48:51], s9 offen
s_getpc_b64 s[0:1]
s_and_b32 s0, s0, 0xfffffc00
s_lshr_b32 s8, s2, 3
s_lshl_b32 s8, s8, 2
s_add_u32 s8, s8, s4
s_min_u32 s8, s8, 92
s_lshl_b32 s8, s8, 10
s_add_u32 s0, s0, s8
s_addc_u32 s1, s1, 0
v_add_u32 v60, s0, v16
v_mov_b32 v61, s1
s_nop 0
global_load_dword a120, v[60:61], off sc1
s_cmp_lg_u32 s4, 0
s_cbranch_scc1 L_flag_clr
s_lshl_b32 s8, s6, 5
s_add_u32 s8, s8, s5
s_lshl_b32 s8, s8, 2
s_add_u32 s8, s8, 0x3604000
v_mov_b32 v17, 0
s_mov_b64 exec, 1
buffer_store_dword v17, off, s[88:91], s8 sc1
s_mov_b64 exec, -1
L_flag_clr:
s_waitcnt vmcnt(26)
s_barrier
ds_read_b64_tr_b16 a[80:81], v12 offset:0
ds_read_b64_tr_b16 a[82:83], v12 offset:1024
ds_read_b64_tr_b16 a[84:85], v12 offset:8192
ds_read_b64_tr_b16 a[86:87], v12 offset:9216
ds_read_b128 a[0:3], v8 offset:0
ds_read_b128 a[20:23], v9 offset:0
ds_read_b128 a[4:7], v8 offset:2048
ds_read_b128 a[24:27], v9 offset:2048
ds_read_b128 a[8:11], v8 offset:4096
ds_read_b128 a[28:31], v9 offset:4096
ds_read_b128 a[12:15], v8 offset:6144
ds_read_b128 a[32:35], v9 offset:6144
ds_read_b64_tr_b16 a[88:89], v13 offset:0
ds_read_b64_tr_b16 a[90:91], v13 offset:1024
ds_read_b64_tr_b16 a[92:93], v13 offset:8192
ds_read_b64_tr_b16 a[94:95], v13 offset:9216
ds_read_b64_tr_b16 a[96:97], v12 offset:256
ds_read_b64_tr_b16 a[98:99], v12 offset:1280
ds_read_b64_tr_b16 a[100:101], v12 offset:8448
ds_read_b64_tr_b16 a[102:103], v12 offset:9472
s_waitcnt lgkmcnt(0)
L_S0:
v_mfma_f32_16x16x32_bf16 v[24:27], a[80:83], a[0:3], 0
ds_read_b64_tr_b16 a[104:105], v13 offset:256
s_waitcnt vmcnt(10)
s_add_u32 m0, s16, 0x0
v_mfma_f32_16x16x32_bf16 v[24:27], a[84:87], a[20:23], v[24:27]
buffer_load_dwordx4 v2, s[48:51], 0 offen lds
v_mfma_f32_16x16x32_bf16 v[32:35], a[84:87], a[24:27], 0
ds_read_b64_tr_b16 a[106:107], v13 offset:1280
v_mfma_f32_16x16x32_bf16 v[32:35], a[80:83], a[4:7], v[32:35]
ds_read_b64_tr_b16 a[108:109], v13 offset:8448
v_mfma_f32_16x16x32_bf16 v[40:43], a[80:83], a[8:11], 0
ds_read_b64_tr_b16 a[110:111], v13 offset:9472
v_mfma_f32_16x16x32_bf16 v[40:43], a[84:87], a[28:31], v[40:43]
ds_read_b128 a[40:43], v8 offset:32768
v_mfma_f32_16x16x32_bf16 v[48:51], a[84:87], a[32:35], 0
ds_read_b128 a[60:63], v9 offset:32768
s_add_u32 m0, s16, 0x400
v_mfma_f32_16x16x32_bf16 v[48:51], a[80:83], a[12:15], v[48:51]
buffer_load_dwordx4 v3, s[48:51], 0 offen lds
v_mfma_f32_16x16x32_bf16 v[52:55], a[88:91], a[12:15], 0
ds_read_b64_tr_b16 a[80:81], v12 offset:512
v_mfma_f32_16x16x32_bf16 v[52:55], a[92:95], a[32:35], v[52:55]
ds_read_b64_tr_b16 a[82:83], v12 offset:1536
v_mfma_f32_16x16x32_bf16 v[44:47], a[92:95], a[28:31], 0
ds_read_b64_tr_b16 a[84:85], v12 offset:8704
v_mfma_f32_16x16x32_bf16 v[44:47], a[88:91], a[8:11], v[44:47]
ds_read_b64_tr_b16 a[86:87], v12 offset:9728
v_mfma_f32_16x16x32_bf16 v[36:39], a[88:91], a[4:7], 0
ds_read_b128 a[44:47], v8 offset:34816
s_add_u32 m0, s16, 0x800
v_mfma_f32_16x16x32_bf16 v[36:39], a[92:95], a[24:27], v[36:39]
buffer_load_dwordx4 v2, s[48:51], s12 offen lds
v_mfma_f32_16x16x32_bf16 v[28:31], a[92:95], a[20:23], 0
ds_read_b128 a[64:67], v9 offset:34816
v_mfma_f32_16x16x32_bf16 v[28:31], a[88:91], a[0:3], v[28:31]
ds_read_b128 a[48:51], v8 offset:36864
v_mfma_f32_16x16x32_bf16 v[56:59], a[96:99], a[0:3], 0
ds_read_b64_tr_b16 a[88:89], v13 offset:512
v_mfma_f32_16x16x32_bf16 v[56:59], a[100:103], a[20:23], v[56:59]
ds_read_b64_tr_b16 a[90:91], v13 offset:1536
v_mfma_f32_16x16x32_bf16 v[64:67], a[100:103], a[24:27], 0
ds_read_b64_tr_b16 a[92:93], v13 offset:8704
v_mfma_f32_16x16x32_bf16 v[64:67], a[96:99], a[4:7], v[64:67]
ds_read_b64_tr_b16 a[94:95], v13 offset:9728
s_add_u32 m0, s16, 0xc00
v_mfma_f32_16x16x32_bf16 v[72:75], a[96:99], a[8:11], 0
buffer_load_dwordx4 v3, s[48:51], s12 offen lds
v_mfma_f32_16x16x32_bf16 v[72:75], a[100:103], a[28:31], v[72:75]
ds_read_b128 a[68:71], v9 offset:36864
v_mfma_f32_16x16x32_bf16 v[80:83], a[100:103], a[32:35], 0
ds_read_b128 a[52:55], v8 offset:38912
v_mfma_f32_16x16x32_bf16 v[80:83], a[96:99], a[12:15], v[80:83]
ds_read_b128 a[72:75], v9 offset:38912
s_waitcnt lgkmcnt(15)
v_mfma_f32_16x16x32_bf16 v[84:87], a[104:107], a[12:15], 0
ds_read_b64_tr_b16 a[96:97], v12 offset:768
v_mfma_f32_16x16x32_bf16 v[84:87], a[108:111], a[32:35], v[84:87]
ds_read_b64_tr_b16 a[98:99], v12 offset:1792
s_add_u32 m0, s16, 0x1000
v_mfma_f32_16x16x32_bf16 v[76:79], a[108:111], a[28:31], 0
buffer_load_dwordx4 v2, s[48:51], s13 offen lds
v_mfma_f32_16x16x32_bf16 v[76:79], a[104:107], a[8:11], v[76:79]
ds_read_b64_tr_b16 a[100:101], v12 offset:8960
v_mfma_f32_16x16x32_bf16 v[68:71], a[104:107], a[4:7], 0
ds_read_b64_tr_b16 a[102:103], v12 offset:9984
v_mfma_f32_16x16x32_bf16 v[68:71], a[108:111], a[24:27], v[68:71]
v_mfma_f32_16x16x32_bf16 v[60:63], a[108:111], a[20:23], 0
v_mfma_f32_16x16x32_bf16 v[60:63], a[104:107], a[0:3], v[60:63]
s_waitcnt lgkmcnt(7)
v_mfma_f32_16x16x32_bf16 v[88:91], a[80:83], a[0:3], 0
ds_read_b64_tr_b16 a[104:105], v13 offset:768
s_add_u32 m0, s16, 0x1400
v_mfma_f32_16x16x32_bf16 v[88:91], a[84:87], a[20:23], v[88:91]
buffer_load_dwordx4 v3, s[48:51], s13 offen lds
v_mfma_f32_16x16x32_bf16 v[96:99], a[84:87], a[24:27], 0
ds_read_b64_tr_b16 a[106:107], v13 offset:1792
v_mfma_f32_16x16x32_bf16 v[96:99], a[80:83], a[4:7], v[96:99]
ds_read_b64_tr_b16 a[108:109], v13 offset:8960
v_mfma_f32_16x16x32_bf16 v[104:107], a[80:83], a[8:11], 0
ds_read_b64_tr_b16 a[110:111], v13 offset:9984
v_mfma_f32_16x16x32_bf16 v[104:107], a[84:87], a[28:31], v[104:107]
v_mfma_f32_16x16x32_bf16 v[112:115], a[84:87], a[32:35], 0
s_add_u32 m0, s16, 0x1800
v_mfma_f32_16x16x32_bf16 v[112:115], a[80:83], a[12:15], v[112:115]
buffer_load_dwordx4 v2, s[48:51], s14 offen lds
v_mfma_f32_16x16x32_bf16 v[116:119], a[88:91], a[12:15], 0
ds_read_b64_tr_b16 a[80:81], v12 offset:16384
v_mfma_f32_16x16x32_bf16 v[116:119], a[92:95], a[32:35], v[116:119]
ds_read_b64_tr_b16 a[82:83], v12 offset:17408
v_mfma_f32_16x16x32_bf16 v[108:111], a[92:95], a[28:31], 0
ds_read_b64_tr_b16 a[84:85], v12 offset:24576
v_mfma_f32_16x16x32_bf16 v[108:111], a[88:91], a[8:11], v[108:111]
ds_read_b64_tr_b16 a[86:87], v12 offset:25600
v_mfma_f32_16x16x32_bf16 v[100:103], a[88:91], a[4:7], 0
v_mfma_f32_16x16x32_bf16 v[100:103], a[92:95], a[24:27], v[100:103]
s_add_u32 m0, s16, 0x1c00
v_mfma_f32_16x16x32_bf16 v[92:95], a[92:95], a[20:23], 0
buffer_load_dwordx4 v3, s[48:51], s14 offen lds
v_mfma_f32_16x16x32_bf16 v[92:95], a[88:91], a[0:3], v[92:95]
s_waitcnt lgkmcnt(4)
v_add_u32 v2, 0x80, v2
v_add_u32 v3, 0x80, v3
v_mfma_f32_16x16x32_bf16 v[120:123], a[96:99], a[0:3], 0
ds_read_b64_tr_b16 a[88:89], v13 offset:16384
v_mfma_f32_16x16x32_bf16 v[120:123], a[100:103], a[20:23], v[120:123]
ds_read_b64_tr_b16 a[90:91], v13 offset:17408
v_mfma_f32_16x16x32_bf16 v[128:131], a[100:103], a[24:27], 0
ds_read_b64_tr_b16 a[92:93], v13 offset:24576
s_waitcnt lgkmcnt(15)
v_mfma_f32_16x16x32_bf16 v[128:131], a[96:99], a[4:7], v[128:131]
ds_read_b64_tr_b16 a[94:95], v13 offset:25600
s_add_u32 m0, s16, 0x8000
v_mfma_f32_16x16x32_bf16 v[136:139], a[96:99], a[8:11], 0
buffer_load_dwordx4 v2, s[48:51], 0 offen lds
v_mfma_f32_16x16x32_bf16 v[136:139], a[100:103], a[28:31], v[136:139]
v_mfma_f32_16x16x32_bf16 v[144:147], a[100:103], a[32:35], 0
v_mfma_f32_16x16x32_bf16 v[144:147], a[96:99], a[12:15], v[144:147]
v_mfma_f32_16x16x32_bf16 v[148:151], a[104:107], a[12:15], 0
ds_read_b64_tr_b16 a[96:97], v12 offset:16640
v_mfma_f32_16x16x32_bf16 v[148:151], a[108:111], a[32:35], v[148:151]
ds_read_b64_tr_b16 a[98:99], v12 offset:17664
s_add_u32 m0, s16, 0x8400
v_mfma_f32_16x16x32_bf16 v[140:143], a[108:111], a[28:31], 0
buffer_load_dwordx4 v3, s[48:51], 0 offen lds
v_mfma_f32_16x16x32_bf16 v[140:143], a[104:107], a[8:11], v[140:143]
ds_read_b64_tr_b16 a[100:101], v12 offset:24832
v_mfma_f32_16x16x32_bf16 v[132:135], a[104:107], a[4:7], 0
ds_read_b64_tr_b16 a[102:103], v12 offset:25856
v_mfma_f32_16x16x32_bf16 v[132:135], a[108:111], a[24:27], v[132:135]
v_mfma_f32_16x16x32_bf16 v[124:127], a[108:111], a[20:23], 0
v_mfma_f32_16x16x32_bf16 v[124:127], a[104:107], a[0:3], v[124:127]
s_waitcnt lgkmcnt(4)
v_mfma_f32_16x16x32_bf16 v[152:155], a[0:3], a[80:83], 0
ds_read_b64_tr_b16 a[104:105], v13 offset:16640
s_add_u32 m0, s16, 0x8800
v_mfma_f32_16x16x32_bf16 v[152:155], a[20:23], a[84:87], v[152:155]
buffer_load_dwordx4 v2, s[48:51], s12 offen lds
v_mfma_f32_16x16x32_bf16 v[156:159], a[24:27], a[84:87], 0
ds_read_b64_tr_b16 a[106:107], v13 offset:17664
v_mfma_f32_16x16x32_bf16 v[156:159], a[4:7], a[80:83], v[156:159]
ds_read_b64_tr_b16 a[108:109], v13 offset:24832
v_mfma_f32_16x16x32_bf16 v[160:163], a[8:11], a[80:83], 0
ds_read_b64_tr_b16 a[110:111], v13 offset:25856
v_mfma_f32_16x16x32_bf16 v[160:163], a[28:31], a[84:87], v[160:163]
v_mfma_f32_16x16x32_bf16 v[164:167], a[32:35], a[84:87], 0
s_add_u32 m0, s16, 0x8c00
v_mfma_f32_16x16x32_bf16 v[164:167], a[12:15], a[80:83], v[164:167]
buffer_load_dwordx4 v3, s[48:51], s12 offen lds
v_mfma_f32_16x16x32_bf16 v[180:183], a[12:15], a[88:91], 0
ds_read_b64_tr_b16 a[80:81], v12 offset:16896
v_mfma_f32_16x16x32_bf16 v[180:183], a[32:35], a[92:95], v[180:183]
ds_read_b64_tr_b16 a[82:83], v12 offset:17920
v_mfma_f32_16x16x32_bf16 v[176:179], a[28:31], a[92:95], 0
ds_read_b64_tr_b16 a[84:85], v12 offset:25088
v_mfma_f32_16x16x32_bf16 v[176:179], a[8:11], a[88:91], v[176:179]
ds_read_b64_tr_b16 a[86:87], v12 offset:26112
v_mfma_f32_16x16x32_bf16 v[172:175], a[4:7], a[88:91], 0
v_mfma_f32_16x16x32_bf16 v[172:175], a[24:27], a[92:95], v[172:175]
s_add_u32 m0, s16, 0x9000
v_mfma_f32_16x16x32_bf16 v[168:171], a[20:23], a[92:95], 0
buffer_load_dwordx4 v2, s[48:51], s13 offen lds
v_mfma_f32_16x16x32_bf16 v[168:171], a[0:3], a[88:91], v[168:171]
s_waitcnt lgkmcnt(4)
v_mfma_f32_16x16x32_bf16 v[184:187], a[0:3], a[96:99], 0
ds_read_b64_tr_b16 a[88:89], v13 offset:16896
v_mfma_f32_16x16x32_bf16 v[184:187], a[20:23], a[100:103], v[184:187]
ds_read_b64_tr_b16 a[90:91], v13 offset:17920
v_mfma_f32_16x16x32_bf16 v[188:191], a[24:27], a[100:103], 0
ds_read_b64_tr_b16 a[92:93], v13 offset:25088
v_mfma_f32_16x16x32_bf16 v[188:191], a[4:7], a[96:99], v[188:191]
ds_read_b64_tr_b16 a[94:95], v13 offset:26112
s_add_u32 m0, s16, 0x9400
v_mfma_f32_16x16x32_bf16 v[192:195], a[8:11], a[96:99], 0
buffer_load_dwordx4 v3, s[48:51], s13 offen lds
v_mfma_f32_16x16x32_bf16 v[192:195], a[28:31], a[100:103], v[192:195]
v_mfma_f32_16x16x32_bf16 v[196:199], a[32:35], a[100:103], 0
v_mfma_f32_16x16x32_bf16 v[196:199], a[12:15], a[96:99], v[196:199]
v_mfma_f32_16x16x32_bf16 v[212:215], a[12:15], a[104:107], 0
ds_read_b64_tr_b16 a[96:97], v12 offset:17152
v_mfma_f32_16x16x32_bf16 v[212:215], a[32:35], a[108:111], v[212:215]
ds_read_b64_tr_b16 a[98:99], v12 offset:18176
v_mfma_f32_16x16x32_bf16 v[208:211], a[28:31], a[108:111], 0
ds_read_b64_tr_b16 a[100:101], v12 offset:25344
s_add_u32 m0, s16, 0x9800
v_mfma_f32_16x16x32_bf16 v[208:211], a[8:11], a[104:107], v[208:211]
buffer_load_dwordx4 v2, s[48:51], s14 offen lds
v_mfma_f32_16x16x32_bf16 v[204:207], a[4:7], a[104:107], 0
ds_read_b64_tr_b16 a[102:103], v12 offset:26368
v_mfma_f32_16x16x32_bf16 v[204:207], a[24:27], a[108:111], v[204:207]
v_mfma_f32_16x16x32_bf16 v[200:203], a[20:23], a[108:111], 0
v_mfma_f32_16x16x32_bf16 v[200:203], a[0:3], a[104:107], v[200:203]
s_waitcnt lgkmcnt(4)
v_mfma_f32_16x16x32_bf16 v[248:251], a[0:3], a[80:83], 0
ds_read_b64_tr_b16 a[104:105], v13 offset:17152
s_add_u32 m0, s16, 0x9c00
v_mfma_f32_16x16x32_bf16 v[248:251], a[20:23], a[84:87], v[248:251]
buffer_load_dwordx4 v3, s[48:51], s14 offen lds
v_mfma_f32_16x16x32_bf16 v[252:255], a[24:27], a[84:87], 0
ds_read_b64_tr_b16 a[106:107], v13 offset:18176
v_add_u32 v2, 0x80, v2
v_mfma_f32_16x16x32_bf16 v[252:255], a[4:7], a[80:83], v[252:255]
ds_read_b64_tr_b16 a[108:109], v13 offset:25344
v_add_u32 v3, 0x80, v3
v_mfma_f32_16x16x32_bf16 v[216:219], a[8:11], a[80:83], 0
ds_read_b64_tr_b16 a[110:111], v13 offset:26368
v_add_u32 v12, 0x8000, v12
v_mfma_f32_16x16x32_bf16 v[216:219], a[28:31], a[84:87], v[216:219]
v_add_u32 v13, 0x8000, v13
v_mfma_f32_16x16x32_bf16 v[220:223], a[32:35], a[84:87], 0
v_mfma_f32_16x16x32_bf16 v[220:223], a[12:15], a[80:83], v[220:223]
v_mfma_f32_16x16x32_bf16 v[236:239], a[12:15], a[88:91], 0
s_waitcnt vmcnt(34) lgkmcnt(0)
v_mfma_f32_16x16x32_bf16 v[236:239], a[32:35], a[92:95], v[236:239]
s_barrier
s_add_u32 m0, s17, 0x0
v_mfma_f32_16x16x32_bf16 v[232:235], a[28:31], a[92:95], 0
buffer_load_dwordx4 v5, s[56:59], 0 offen lds
v_mfma_f32_16x16x32_bf16 v[232:235], a[8:11], a[88:91], v[232:235]
ds_read_b64_tr_b16 a[80:81], v12 offset:0
v_mfma_f32_16x16x32_bf16 v[228:231], a[4:7], a[88:91], 0
ds_read_b64_tr_b16 a[82:83], v12 offset:1024
v_mfma_f32_16x16x32_bf16 v[228:231], a[24:27], a[92:95], v[228:231]
ds_read_b64_tr_b16 a[84:85], v12 offset:8192
v_mfma_f32_16x16x32_bf16 v[224:227], a[20:23], a[92:95], 0
ds_read_b64_tr_b16 a[86:87], v12 offset:9216
s_waitcnt lgkmcnt(4)
v_mfma_f32_16x16x32_bf16 v[224:227], a[0:3], a[88:91], v[224:227]
buffer_load_dwordx4 a[128:131], v16, s[44:47], s100 offen offset:0
v_mfma_f32_16x16x32_bf16 v[240:243], a[0:3], a[96:99], 0
ds_read_b64_tr_b16 a[88:89], v13 offset:0
v_mfma_f32_16x16x32_bf16 v[240:243], a[20:23], a[100:103], v[240:243]
ds_read_b64_tr_b16 a[90:91], v13 offset:1024
v_mfma_f32_16x16x32_bf16 v[244:247], a[24:27], a[100:103], 0
ds_read_b64_tr_b16 a[92:93], v13 offset:8192
v_mfma_f32_16x16x32_bf16 v[244:247], a[4:7], a[96:99], v[244:247]
ds_read_b64_tr_b16 a[94:95], v13 offset:9216
v_mfma_f32_16x16x32_bf16 a[232:235], a[8:11], a[96:99], 0
s_add_u32 m0, s17, 0x4000
v_mfma_f32_16x16x32_bf16 a[232:235], a[28:31], a[100:103], a[232:235]
buffer_load_dwordx4 v5, s[60:63], 0 offen lds
v_mfma_f32_16x16x32_bf16 a[236:239], a[32:35], a[100:103], 0
v_mfma_f32_16x16x32_bf16 a[236:239], a[12:15], a[96:99], a[236:239]
v_mfma_f32_16x16x32_bf16 a[252:255], a[12:15], a[104:107], 0
ds_read_b64_tr_b16 a[96:97], v12 offset:256
v_mfma_f32_16x16x32_bf16 a[252:255], a[32:35], a[108:111], a[252:255]
ds_read_b64_tr_b16 a[98:99], v12 offset:1280
v_mfma_f32_16x16x32_bf16 a[248:251], a[28:31], a[108:111], 0
ds_read_b64_tr_b16 a[100:101], v12 offset:8448
v_mfma_f32_16x16x32_bf16 a[248:251], a[8:11], a[104:107], a[248:251]
buffer_load_dwordx4 a[132:135], v16, s[44:47], s100 offen offset:1024
v_mfma_f32_16x16x32_bf16 a[244:247], a[4:7], a[104:107], 0
ds_read_b64_tr_b16 a[102:103], v12 offset:9472
v_mfma_f32_16x16x32_bf16 a[244:247], a[24:27], a[108:111], a[244:247]
v_mfma_f32_16x16x32_bf16 a[240:243], a[20:23], a[108:111], 0
v_mfma_f32_16x16x32_bf16 a[240:243], a[0:3], a[104:107], a[240:243]
s_add_u32 m0, s17, 0x400
s_waitcnt lgkmcnt(4)
L_S1:
v_mfma_f32_16x16x32_bf16 v[24:27], a[80:83], a[40:43], v[24:27]
buffer_load_dwordx4 v5, s[56:59], s13 offen lds
v_mfma_f32_16x16x32_bf16 v[24:27], a[84:87], a[60:63], v[24:27]
ds_read_b64_tr_b16 a[104:105], v13 offset:256
s_waitcnt vmcnt(13)
v_mfma_f32_16x16x32_bf16 v[32:35], a[84:87], a[64:67], v[32:35]
ds_read_b64_tr_b16 a[106:107], v13 offset:1280
v_mfma_f32_16x16x32_bf16 v[32:35], a[80:83], a[44:47], v[32:35]
ds_read_b64_tr_b16 a[108:109], v13 offset:8448
v_mfma_f32_16x16x32_bf16 v[40:43], a[80:83], a[48:51], v[40:43]
ds_read_b64_tr_b16 a[110:111], v13 offset:9472
v_mfma_f32_16x16x32_bf16 v[40:43], a[84:87], a[68:71], v[40:43]
ds_read_b128 a[0:3], v8 offset:0
s_add_u32 m0, s17, 0x4400
v_mfma_f32_16x16x32_bf16 v[48:51], a[84:87], a[72:75], v[48:51]
buffer_load_dwordx4 v5, s[60:63], s13 offen lds
v_mfma_f32_16x16x32_bf16 v[48:51], a[80:83], a[52:55], v[48:51]
ds_read_b128 a[20:23], v9 offset:0
v_mfma_f32_16x16x32_bf16 v[52:55], a[88:91], a[52:55], v[52:55]
ds_read_b64_tr_b16 a[80:81], v12 offset:512
v_mfma_f32_16x16x32_bf16 v[52:55], a[92:95], a[72:75], v[52:55]
ds_read_b64_tr_b16 a[82:83], v12 offset:1536
v_mfma_f32_16x16x32_bf16 v[44:47], a[92:95], a[68:71], v[44:47]
ds_read_b64_tr_b16 a[84:85], v12 offset:8704
v_mfma_f32_16x16x32_bf16 v[44:47], a[88:91], a[48:51], v[44:47]
ds_read_b64_tr_b16 a[86:87], v12 offset:9728
v_mfma_f32_16x16x32_bf16 v[36:39], a[88:91], a[44:47], v[36:39]
buffer_load_dwordx4 a[136:139], v16, s[44:47], s100 offen offset:2048
v_mfma_f32_16x16x32_bf16 v[36:39], a[92:95], a[64:67], v[36:39]
ds_read_b128 a[4:7], v8 offset:2048
v_mfma_f32_16x16x32_bf16 v[28:31], a[92:95], a[60:63], v[28:31]
ds_read_b128 a[24:27], v9 offset:2048
v_mfma_f32_16x16x32_bf16 v[28:31], a[88:91], a[40:43], v[28:31]
ds_read_b128 a[8:11], v8 offset:4096
s_waitcnt lgkmcnt(9)
v_mfma_f32_16x16x32_bf16 v[56:59], a[96:99], a[40:43], v[56:59]
ds_read_b64_tr_b16 a[88:89], v13 offset:512
v_mfma_f32_16x16x32_bf16 v[56:59], a[100:103], a[60:63], v[56:59]
ds_read_b64_tr_b16 a[90:91], v13 offset:1536
s_add_u32 m0, s17, 0x800
v_mfma_f32_16x16x32_bf16 v[64:67], a[100:103], a[64:67], v[64:67]
buffer_load_dwordx4 v6, s[56:59], 0 offen lds
v_mfma_f32_16x16x32_bf16 v[64:67], a[96:99], a[44:47], v[64:67]
ds_read_b64_tr_b16 a[92:93], v13 offset:8704
v_mfma_f32_16x16x32_bf16 v[72:75], a[96:99], a[48:51], v[72:75]
ds_read_b64_tr_b16 a[94:95], v13 offset:9728
v_mfma_f32_16x16x32_bf16 v[72:75], a[100:103], a[68:71], v[72:75]
ds_read_b128 a[28:31], v9 offset:4096
v_mfma_f32_16x16x32_bf16 v[80:83], a[100:103], a[72:75], v[80:83]
ds_read_b128 a[12:15], v8 offset:6144
v_mfma_f32_16x16x32_bf16 v[80:83], a[96:99], a[52:55], v[80:83]
buffer_load_dwordx4 a[140:143], v16, s[44:47], s100 offen offset:3072
v_mfma_f32_16x16x32_bf16 v[84:87], a[104:107], a[52:55], v[84:87]
ds_read_b64_tr_b16 a[96:97], v12 offset:768
v_mfma_f32_16x16x32_bf16 v[84:87], a[108:111], a[72:75], v[84:87]
ds_read_b64_tr_b16 a[98:99], v12 offset:1792
v_mfma_f32_16x16x32_bf16 v[76:79], a[108:111], a[68:71], v[76:79]
ds_read_b64_tr_b16 a[100:101], v12 offset:8960
v_mfma_f32_16x16x32_bf16 v[76:79], a[104:107], a[48:51], v[76:79]
ds_read_b64_tr_b16 a[102:103], v12 offset:9984
v_mfma_f32_16x16x32_bf16 v[68:71], a[104:107], a[44:47], v[68:71]
ds_read_b128 a[32:35], v9 offset:6144
s_add_u32 m0, s17, 0x4800
v_mfma_f32_16x16x32_bf16 v[68:71], a[108:111], a[64:67], v[68:71]
buffer_load_dwordx4 v6, s[60:63], 0 offen lds
v_mfma_f32_16x16x32_bf16 v[60:63], a[108:111], a[60:63], v[60:63]
v_mfma_f32_16x16x32_bf16 v[60:63], a[104:107], a[40:43], v[60:63]
s_waitcnt lgkmcnt(7)
v_mfma_f32_16x16x32_bf16 v[88:91], a[80:83], a[40:43], v[88:91]
ds_read_b64_tr_b16 a[104:105], v13 offset:768
v_mfma_f32_16x16x32_bf16 v[88:91], a[84:87], a[60:63], v[88:91]
ds_read_b64_tr_b16 a[106:107], v13 offset:1792
v_mfma_f32_16x16x32_bf16 v[96:99], a[84:87], a[64:67], v[96:99]
ds_read_b64_tr_b16 a[108:109], v13 offset:8960
v_mfma_f32_16x16x32_bf16 v[96:99], a[80:83], a[44:47], v[96:99]
buffer_load_dwordx4 a[144:147], v16, s[76:79], 0 offen offset:0
v_mfma_f32_16x16x32_bf16 v[104:107], a[80:83], a[48:51], v[104:107]
ds_read_b64_tr_b16 a[110:111], v13 offset:9984
v_mfma_f32_16x16x32_bf16 v[104:107], a[84:87], a[68:71], v[104:107]
v_mfma_f32_16x16x32_bf16 v[112:115], a[84:87], a[72:75], v[112:115]
v_mfma_f32_16x16x32_bf16 v[112:115], a[80:83], a[52:55], v[112:115]
v_mfma_f32_16x16x32_bf16 v[116:119], a[88:91], a[52:55], v[116:119]
ds_read_b64_tr_b16 a[80:81], v12 offset:16384
s_add_u32 m0, s17, 0xc00
v_mfma_f32_16x16x32_bf16 v[116:119], a[92:95], a[72:75], v[116:119]
buffer_load_dwordx4 v6, s[56:59], s13 offen lds
v_mfma_f32_16x16x32_bf16 v[108:111], a[92:95], a[68:71], v[108:111]
ds_read_b64_tr_b16 a[82:83], v12 offset:17408
v_mfma_f32_16x16x32_bf16 v[108:111], a[88:91], a[48:51], v[108:111]
ds_read_b64_tr_b16 a[84:85], v12 offset:24576
v_mfma_f32_16x16x32_bf16 v[100:103], a[88:91], a[44:47], v[100:103]
ds_read_b64_tr_b16 a[86:87], v12 offset:25600
v_mfma_f32_16x16x32_bf16 v[100:103], a[92:95], a[64:67], v[100:103]
s_add_u32 m0, s17, 0x4c00
v_mfma_f32_16x16x32_bf16 v[92:95], a[92:95], a[60:63], v[92:95]
buffer_load_dwordx4 v6, s[60:63], s13 offen lds
v_mfma_f32_16x16x32_bf16 v[92:95], a[88:91], a[40:43], v[92:95]
s_waitcnt lgkmcnt(4)
v_add_u32 v5, 0x80000, v5
v_add_u32 v6, 0x80000, v6
v_mfma_f32_16x16x32_bf16 v[120:123], a[96:99], a[40:43], v[120:123]
ds_read_b64_tr_b16 a[88:89], v13 offset:16384
v_mfma_f32_16x16x32_bf16 v[120:123], a[100:103], a[60:63], v[120:123]
ds_read_b64_tr_b16 a[90:91], v13 offset:17408
v_mfma_f32_16x16x32_bf16 v[128:131], a[100:103], a[64:67], v[128:131]
ds_read_b64_tr_b16 a[92:93], v13 offset:24576
v_mfma_f32_16x16x32_bf16 v[128:131], a[96:99], a[44:47], v[128:131]
ds_read_b64_tr_b16 a[94:95], v13 offset:25600
v_mfma_f32_16x16x32_bf16 v[136:139], a[96:99], a[48:51], v[136:139]
buffer_load_dwordx4 a[148:151], v16, s[76:79], 0 offen offset:1024
v_mfma_f32_16x16x32_bf16 v[136:139], a[100:103], a[68:71], v[136:139]
v_mfma_f32_16x16x32_bf16 v[144:147], a[100:103], a[72:75], v[144:147]
v_mfma_f32_16x16x32_bf16 v[144:147], a[96:99], a[52:55], v[144:147]
v_mfma_f32_16x16x32_bf16 v[148:151], a[104:107], a[52:55], v[148:151]
ds_read_b64_tr_b16 a[96:97], v12 offset:16640
s_waitcnt lgkmcnt(13)
v_mfma_f32_16x16x32_bf16 v[148:151], a[108:111], a[72:75], v[148:151]
ds_read_b64_tr_b16 a[98:99], v12 offset:17664
s_add_u32 m0, s16, 0x0
v_mfma_f32_16x16x32_bf16 v[140:143], a[108:111], a[68:71], v[140:143]
buffer_load_dwordx4 v2, s[48:51], 0 offen lds
v_mfma_f32_16x16x32_bf16 v[140:143], a[104:107], a[48:51], v[140:143]
ds_read_b64_tr_b16 a[100:101], v12 offset:24832
v_mfma_f32_16x16x32_bf16 v[132:135], a[104:107], a[44:47], v[132:135]
ds_read_b64_tr_b16 a[102:103], v12 offset:25856
v_mfma_f32_16x16x32_bf16 v[132:135], a[108:111], a[64:67], v[132:135]
v_mfma_f32_16x16x32_bf16 v[124:127], a[108:111], a[60:63], v[124:127]
s_add_u32 m0, s16, 0x400
s_waitcnt lgkmcnt(4)
v_mfma_f32_16x16x32_bf16 v[124:127], a[104:107], a[40:43], v[124:127]
buffer_load_dwordx4 v3, s[48:51], 0 offen lds
v_mfma_f32_16x16x32_bf16 v[152:155], a[40:43], a[80:83], v[152:155]
ds_read_b64_tr_b16 a[104:105], v13 offset:16640
v_mfma_f32_16x16x32_bf16 v[152:155], a[60:63], a[84:87], v[152:155]
ds_read_b64_tr_b16 a[106:107], v13 offset:17664
v_mfma_f32_16x16x32_bf16 v[156:159], a[64:67], a[84:87], v[156:159]
ds_read_b64_tr_b16 a[108:109], v13 offset:24832
v_mfma_f32_16x16x32_bf16 v[156:159], a[44:47], a[80:83], v[156:159]
ds_read_b64_tr_b16 a[110:111], v13 offset:25856
v_mfma_f32_16x16x32_bf16 v[160:163], a[48:51], a[80:83], v[160:163]
s_add_u32 m0, s16, 0x800
v_mfma_f32_16x16x32_bf16 v[160:163], a[68:71], a[84:87], v[160:163]
buffer_load_dwordx4 v2, s[48:51], s12 offen lds
v_mfma_f32_16x16x32_bf16 v[164:167], a[72:75], a[84:87], v[164:167]
v_mfma_f32_16x16x32_bf16 v[164:167], a[52:55], a[80:83], v[164:167]
v_mfma_f32_16x16x32_bf16 v[180:183], a[52:55], a[88:91], v[180:183]
ds_read_b64_tr_b16 a[80:81], v12 offset:16896
v_mfma_f32_16x16x32_bf16 v[180:183], a[72:75], a[92:95], v[180:183]
ds_read_b64_tr_b16 a[82:83], v12 offset:17920
v_mfma_f32_16x16x32_bf16 v[176:179], a[68:71], a[92:95], v[176:179]
ds_read_b64_tr_b16 a[84:85], v12 offset:25088
s_add_u32 m0, s16, 0xc00
v_mfma_f32_16x16x32_bf16 v[176:179], a[48:51], a[88:91], v[176:179]
buffer_load_dwordx4 v3, s[48:51], s12 offen lds
v_mfma_f32_16x16x32_bf16 v[172:175], a[44:47], a[88:91], v[172:175]
ds_read_b64_tr_b16 a[86:87], v12 offset:26112
v_mfma_f32_16x16x32_bf16 v[172:175], a[64:67], a[92:95], v[172:175]
v_mfma_f32_16x16x32_bf16 v[168:171], a[60:63], a[92:95], v[168:171]
v_mfma_f32_16x16x32_bf16 v[168:171], a[40:43], a[88:91], v[168:171]
s_waitcnt lgkmcnt(4)
v_mfma_f32_16x16x32_bf16 v[184:187], a[40:43], a[96:99], v[184:187]
ds_read_b64_tr_b16 a[88:89], v13 offset:16896
s_add_u32 m0, s16, 0x1000
v_mfma_f32_16x16x32_bf16 v[184:187], a[60:63], a[100:103], v[184:187]
buffer_load_dwordx4 v2, s[48:51], s13 offen lds
v_mfma_f32_16x16x32_bf16 v[188:191], a[64:67], a[100:103], v[188:191]
ds_read_b64_tr_b16 a[90:91], v13 offset:17920
v_mfma_f32_16x16x32_bf16 v[188:191], a[44:47], a[96:99], v[188:191]
ds_read_b64_tr_b16 a[92:93], v13 offset:25088
v_mfma_f32_16x16x32_bf16 v[192:195], a[48:51], a[96:99], v[192:195]
ds_read_b64_tr_b16 a[94:95], v13 offset:26112
v_mfma_f32_16x16x32_bf16 v[192:195], a[68:71], a[100:103], v[192:195]
s_add_u32 m0, s16, 0x1400
v_mfma_f32_16x16x32_bf16 v[196:199], a[72:75], a[100:103], v[196:199]
buffer_load_dwordx4 v3, s[48:51], s13 offen lds
v_mfma_f32_16x16x32_bf16 v[196:199], a[52:55], a[96:99], v[196:199]
v_mfma_f32_16x16x32_bf16 v[212:215], a[52:55], a[104:107], v[212:215]
ds_read_b64_tr_b16 a[96:97], v12 offset:17152
v_mfma_f32_16x16x32_bf16 v[212:215], a[72:75], a[108:111], v[212:215]
ds_read_b64_tr_b16 a[98:99], v12 offset:18176
v_mfma_f32_16x16x32_bf16 v[208:211], a[68:71], a[108:111], v[208:211]
ds_read_b64_tr_b16 a[100:101], v12 offset:25344
v_mfma_f32_16x16x32_bf16 v[208:211], a[48:51], a[104:107], v[208:211]
ds_read_b64_tr_b16 a[102:103], v12 offset:26368
s_add_u32 m0, s16, 0x1800
v_mfma_f32_16x16x32_bf16 v[204:207], a[44:47], a[104:107], v[204:207]
buffer_load_dwordx4 v2, s[48:51], s14 offen lds
v_mfma_f32_16x16x32_bf16 v[204:207], a[64:67], a[108:111], v[204:207]
v_mfma_f32_16x16x32_bf16 v[200:203], a[60:63], a[108:111], v[200:203]
v_mfma_f32_16x16x32_bf16 v[200:203], a[40:43], a[104:107], v[200:203]
s_waitcnt lgkmcnt(4)
v_mfma_f32_16x16x32_bf16 v[248:251], a[40:43], a[80:83], v[248:251]
ds_read_b64_tr_b16 a[104:105], v13 offset:17152
v_mfma_f32_16x16x32_bf16 v[248:251], a[60:63], a[84:87], v[248:251]
ds_read_b64_tr_b16 a[106:107], v13 offset:18176
s_add_u32 m0, s16, 0x1c00
v_mfma_f32_16x16x32_bf16 v[252:255], a[64:67], a[84:87], v[252:255]
buffer_load_dwordx4 v3, s[48:51], s14 offen lds
v_mfma_f32_16x16x32_bf16 v[252:255], a[44:47], a[80:83], v[252:255]
ds_read_b64_tr_b16 a[108:109], v13 offset:25344
v_add_u32 v2, 0x80, v2
v_mfma_f32_16x16x32_bf16 v[216:219], a[48:51], a[80:83], v[216:219]
ds_read_b64_tr_b16 a[110:111], v13 offset:26368
v_add_u32 v3, 0x80, v3
v_mfma_f32_16x16x32_bf16 v[216:219], a[68:71], a[84:87], v[216:219]
v_add_u32 v12, 0x8000, v12
v_add_u32 v13, 0x8000, v13
v_mfma_f32_16x16x32_bf16 v[220:223], a[72:75], a[84:87], v[220:223]
v_mfma_f32_16x16x32_bf16 v[220:223], a[52:55], a[80:83], v[220:223]
v_mfma_f32_16x16x32_bf16 v[236:239], a[52:55], a[88:91], v[236:239]
s_waitcnt vmcnt(40) lgkmcnt(0)
v_mfma_f32_16x16x32_bf16 v[236:239], a[72:75], a[92:95], v[236:239]
s_barrier
s_add_u32 m0, s17, 0x8000
v_mfma_f32_16x16x32_bf16 v[232:235], a[68:71], a[92:95], v[232:235]
buffer_load_dwordx4 v5, s[56:59], 0 offen lds
v_mfma_f32_16x16x32_bf16 v[232:235], a[48:51], a[88:91], v[232:235]
ds_read_b64_tr_b16 a[80:81], v12 offset:0
v_mfma_f32_16x16x32_bf16 v[228:231], a[44:47], a[88:91], v[228:231]
ds_read_b64_tr_b16 a[82:83], v12 offset:1024
v_mfma_f32_16x16x32_bf16 v[228:231], a[64:67], a[92:95], v[228:231]
ds_read_b64_tr_b16 a[84:85], v12 offset:8192
v_mfma_f32_16x16x32_bf16 v[224:227], a[60:63], a[92:95], v[224:227]
ds_read_b64_tr_b16 a[86:87], v12 offset:9216
v_mfma_f32_16x16x32_bf16 v[224:227], a[40:43], a[88:91], v[224:227]
s_waitcnt lgkmcnt(4)
v_mfma_f32_16x16x32_bf16 v[240:243], a[40:43], a[96:99], v[240:243]
ds_read_b64_tr_b16 a[88:89], v13 offset:0
s_add_u32 m0, s17, 0xc000
v_mfma_f32_16x16x32_bf16 v[240:243], a[60:63], a[100:103], v[240:243]
buffer_load_dwordx4 v5, s[60:63], 0 offen lds
v_mfma_f32_16x16x32_bf16 v[244:247], a[64:67], a[100:103], v[244:247]
ds_read_b64_tr_b16 a[90:91], v13 offset:1024
v_mfma_f32_16x16x32_bf16 v[244:247], a[44:47], a[96:99], v[244:247]
ds_read_b64_tr_b16 a[92:93], v13 offset:8192
v_mfma_f32_16x16x32_bf16 a[232:235], a[48:51], a[96:99], a[232:235]
ds_read_b64_tr_b16 a[94:95], v13 offset:9216
v_mfma_f32_16x16x32_bf16 a[232:235], a[68:71], a[100:103], a[232:235]
v_mfma_f32_16x16x32_bf16 a[236:239], a[72:75], a[100:103], a[236:239]
v_mfma_f32_16x16x32_bf16 a[236:239], a[52:55], a[96:99], a[236:239]
s_add_u32 m0, s17, 0x8400
v_mfma_f32_16x16x32_bf16 a[252:255], a[52:55], a[104:107], a[252:255]
buffer_load_dwordx4 v5, s[56:59], s13 offen lds
v_mfma_f32_16x16x32_bf16 a[252:255], a[72:75], a[108:111], a[252:255]
ds_read_b64_tr_b16 a[96:97], v12 offset:256
v_mfma_f32_16x16x32_bf16 a[248:251], a[68:71], a[108:111], a[248:251]
ds_read_b64_tr_b16 a[98:99], v12 offset:1280
v_mfma_f32_16x16x32_bf16 a[248:251], a[48:51], a[104:107], a[248:251]
ds_read_b64_tr_b16 a[100:101], v12 offset:8448
v_mfma_f32_16x16x32_bf16 a[244:247], a[44:47], a[104:107], a[244:247]
ds_read_b64_tr_b16 a[102:103], v12 offset:9472
v_mfma_f32_16x16x32_bf16 a[244:247], a[64:67], a[108:111], a[244:247]
v_mfma_f32_16x16x32_bf16 a[240:243], a[60:63], a[108:111], a[240:243]
s_add_u32 m0, s17, 0xc400
s_waitcnt lgkmcnt(4)
v_mfma_f32_16x16x32_bf16 a[240:243], a[40:43], a[104:107], a[240:243]
buffer_load_dwordx4 v5, s[60:63], s13 offen lds
L_S2:
v_mfma_f32_16x16x32_bf16 v[24:27], a[80:83], a[0:3], v[24:27]
ds_read_b64_tr_b16 a[104:105], v13 offset:256
s_waitcnt vmcnt(26)
v_mfma_f32_16x16x32_bf16 v[24:27], a[84:87], a[20:23], v[24:27]
ds_read_b64_tr_b16 a[106:107], v13 offset:1280
v_mfma_f32_16x16x32_bf16 v[32:35], a[84:87], a[24:27], v[32:35]
ds_read_b64_tr_b16 a[108:109], v13 offset:8448
v_mfma_f32_16x16x32_bf16 v[32:35], a[80:83], a[4:7], v[32:35]
ds_read_b64_tr_b16 a[110:111], v13 offset:9472
v_mfma_f32_16x16x32_bf16 v[40:43], a[80:83], a[8:11], v[40:43]
ds_read_b128 a[40:43], v8 offset:32768
v_mfma_f32_16x16x32_bf16 v[40:43], a[84:87], a[28:31], v[40:43]
ds_read_b128 a[60:63], v9 offset:32768
s_mov_b32 s9, 0x0
v_mfma_f32_16x16x32_bf16 v[48:51], a[84:87], a[32:35], v[48:51]
buffer_load_dword a120, v19, s[44:47], s9 offen
v_mfma_f32_16x16x32_bf16 v[48:51], a[80:83], a[12:15], v[48:51]
ds_read_b128 a[44:47], v8 offset:34816
v_mfma_f32_16x16x32_bf16 v[52:55], a[88:91], a[12:15], v[52:55]
ds_read_b64_tr_b16 a[80:81], v12 offset:512
v_mfma_f32_16x16x32_bf16 v[52:55], a[92:95], a[32:35], v[52:55]
ds_read_b64_tr_b16 a[82:83], v12 offset:1536
v_mfma_f32_16x16x32_bf16 v[44:47], a[92:95], a[28:31], v[44:47]
ds_read_b64_tr_b16 a[84:85], v12 offset:8704
v_mfma_f32_16x16x32_bf16 v[44:47], a[88:91], a[8:11], v[44:47]
ds_read_b64_tr_b16 a[86:87], v12 offset:9728
v_mfma_f32_16x16x32_bf16 v[36:39], a[88:91], a[4:7], v[36:39]
ds_read_b128 a[64:67], v9 offset:34816
s_add_u32 m0, s17, 0x8800
v_mfma_f32_16x16x32_bf16 v[36:39], a[92:95], a[24:27], v[36:39]
buffer_load_dwordx4 v6, s[56:59], 0 offen lds
v_mfma_f32_16x16x32_bf16 v[28:31], a[92:95], a[20:23], v[28:31]
ds_read_b128 a[48:51], v8 offset:36864
v_mfma_f32_16x16x32_bf16 v[28:31], a[88:91], a[0:3], v[28:31]
ds_read_b128 a[68:71], v9 offset:36864
s_waitcnt lgkmcnt(10)
v_mfma_f32_16x16x32_bf16 v[56:59], a[96:99], a[0:3], v[56:59]
ds_read_b64_tr_b16 a[88:89], v13 offset:512
v_mfma_f32_16x16x32_bf16 v[56:59], a[100:103], a[20:23], v[56:59]
ds_read_b64_tr_b16 a[90:91], v13 offset:1536
v_mfma_f32_16x16x32_bf16 v[64:67], a[100:103], a[24:27], v[64:67]
ds_read_b64_tr_b16 a[92:93], v13 offset:8704
v_mfma_f32_16x16x32_bf16 v[64:67], a[96:99], a[4:7], v[64:67]
ds_read_b64_tr_b16 a[94:95], v13 offset:9728
s_add_u32 m0, s17, 0xc800
v_mfma_f32_16x16x32_bf16 v[72:75], a[96:99], a[8:11], v[72:75]
buffer_load_dwordx4 v6, s[60:63], 0 offen lds
v_mfma_f32_16x16x32_bf16 v[72:75], a[100:103], a[28:31], v[72:75]
ds_read_b128 a[52:55], v8 offset:38912
v_mfma_f32_16x16x32_bf16 v[80:83], a[100:103], a[32:35], v[80:83]
ds_read_b128 a[72:75], v9 offset:38912
v_mfma_f32_16x16x32_bf16 v[80:83], a[96:99], a[12:15], v[80:83]
v_mfma_f32_16x16x32_bf16 v[84:87], a[104:107], a[12:15], v[84:87]
ds_read_b64_tr_b16 a[96:97], v12 offset:768
v_mfma_f32_16x16x32_bf16 v[84:87], a[108:111], a[32:35], v[84:87]
ds_read_b64_tr_b16 a[98:99], v12 offset:1792
v_mfma_f32_16x16x32_bf16 v[76:79], a[108:111], a[28:31], v[76:79]
ds_read_b64_tr_b16 a[100:101], v12 offset:8960
s_add_u32 m0, s17, 0x8c00
v_mfma_f32_16x16x32_bf16 v[76:79], a[104:107], a[8:11], v[76:79]
buffer_load_dwordx4 v6, s[56:59], s13 offen lds
v_mfma_f32_16x16x32_bf16 v[68:71], a[104:107], a[4:7], v[68:71]
ds_read_b64_tr_b16 a[102:103], v12 offset:9984
v_mfma_f32_16x16x32_bf16 v[68:71], a[108:111], a[24:27], v[68:71]
v_mfma_f32_16x16x32_bf16 v[60:63], a[108:111], a[20:23], v[60:63]
v_mfma_f32_16x16x32_bf16 v[60:63], a[104:107], a[0:3], v[60:63]
s_waitcnt lgkmcnt(6)
v_mfma_f32_16x16x32_bf16 v[88:91], a[80:83], a[0:3], v[88:91]
ds_read_b64_tr_b16 a[104:105], v13 offset:768
v_mfma_f32_16x16x32_bf16 v[88:91], a[84:87], a[20:23], v[88:91]
ds_read_b64_tr_b16 a[106:107], v13 offset:1792
s_add_u32 m0, s17, 0xcc00
v_mfma_f32_16x16x32_bf16 v[96:99], a[84:87], a[24:27], v[96:99]
buffer_load_dwordx4 v6, s[60:63], s13 offen lds
v_mfma_f32_16x16x32_bf16 v[96:99], a[80:83], a[4:7], v[96:99]
ds_read_b64_tr_b16 a[108:109], v13 offset:8960
v_add_u32 v5, 0x80000, v5
v_mfma_f32_16x16x32_bf16 v[104:107], a[80:83], a[8:11], v[104:107]
ds_read_b64_tr_b16 a[110:111], v13 offset:9984
v_add_u32 v6, 0x80000, v6
v_mfma_f32_16x16x32_bf16 v[104:107], a[84:87], a[28:31], v[104:107]
v_mfma_f32_16x16x32_bf16 v[112:115], a[84:87], a[32:35], v[112:115]
v_mfma_f32_16x16x32_bf16 v[112:115], a[80:83], a[12:15], v[112:115]
v_mfma_f32_16x16x32_bf16 v[116:119], a[88:91], a[12:15], v[116:119]
ds_read_b64_tr_b16 a[80:81], v12 offset:16384
s_mov_b32 s9, 0x200000
v_mfma_f32_16x16x32_bf16 v[116:119], a[92:95], a[32:35], v[116:119]
buffer_load_dword a120, v19, s[44:47], s9 offen
v_mfma_f32_16x16x32_bf16 v[108:111], a[92:95], a[28:31], v[108:111]
ds_read_b64_tr_b16 a[82:83], v12 offset:17408
v_mfma_f32_16x16x32_bf16 v[108:111], a[88:91], a[8:11], v[108:111]
ds_read_b64_tr_b16 a[84:85], v12 offset:24576
v_mfma_f32_16x16x32_bf16 v[100:103], a[88:91], a[4:7], v[100:103]
ds_read_b64_tr_b16 a[86:87], v12 offset:25600
v_mfma_f32_16x16x32_bf16 v[100:103], a[92:95], a[24:27], v[100:103]
v_mfma_f32_16x16x32_bf16 v[92:95], a[92:95], a[20:23], v[92:95]
v_mfma_f32_16x16x32_bf16 v[92:95], a[88:91], a[0:3], v[92:95]
s_add_u32 m0, s16, 0x8000
s_waitcnt lgkmcnt(12)
s_waitcnt lgkmcnt(4)
v_mfma_f32_16x16x32_bf16 v[120:123], a[96:99], a[0:3], v[120:123]
buffer_load_dwordx4 v2, s[48:51], 0 offen lds
v_mfma_f32_16x16x32_bf16 v[120:123], a[100:103], a[20:23], v[120:123]
ds_read_b64_tr_b16 a[88:89], v13 offset:16384
v_mfma_f32_16x16x32_bf16 v[128:131], a[100:103], a[24:27], v[128:131]
ds_read_b64_tr_b16 a[90:91], v13 offset:17408
v_mfma_f32_16x16x32_bf16 v[128:131], a[96:99], a[4:7], v[128:131]
ds_read_b64_tr_b16 a[92:93], v13 offset:24576
v_mfma_f32_16x16x32_bf16 v[136:139], a[96:99], a[8:11], v[136:139]
ds_read_b64_tr_b16 a[94:95], v13 offset:25600
v_mfma_f32_16x16x32_bf16 v[136:139], a[100:103], a[28:31], v[136:139]
v_mfma_f32_16x16x32_bf16 v[144:147], a[100:103], a[32:35], v[144:147]
s_add_u32 m0, s16, 0x8400
v_mfma_f32_16x16x32_bf16 v[144:147], a[96:99], a[12:15], v[144:147]
buffer_load_dwordx4 v3, s[48:51], 0 offen lds
v_mfma_f32_16x16x32_bf16 v[148:151], a[104:107], a[12:15], v[148:151]
ds_read_b64_tr_b16 a[96:97], v12 offset:16640
v_mfma_f32_16x16x32_bf16 v[148:151], a[108:111], a[32:35], v[148:151]
ds_read_b64_tr_b16 a[98:99], v12 offset:17664
v_mfma_f32_16x16x32_bf16 v[140:143], a[108:111], a[28:31], v[140:143]
ds_read_b64_tr_b16 a[100:101], v12 offset:24832
v_mfma_f32_16x16x32_bf16 v[140:143], a[104:107], a[8:11], v[140:143]
ds_read_b64_tr_b16 a[102:103], v12 offset:25856
v_mfma_f32_16x16x32_bf16 v[132:135], a[104:107], a[4:7], v[132:135]
v_mfma_f32_16x16x32_bf16 v[132:135], a[108:111], a[24:27], v[132:135]
s_add_u32 m0, s16, 0x8800
v_mfma_f32_16x16x32_bf16 v[124:127], a[108:111], a[20:23], v[124:127]
buffer_load_dwordx4 v2, s[48:51], s12 offen lds
v_mfma_f32_16x16x32_bf16 v[124:127], a[104:107], a[0:3], v[124:127]
s_waitcnt lgkmcnt(4)
v_mfma_f32_16x16x32_bf16 v[152:155], a[0:3], a[80:83], v[152:155]
ds_read_b64_tr_b16 a[104:105], v13 offset:16640
v_mfma_f32_16x16x32_bf16 v[152:155], a[20:23], a[84:87], v[152:155]
ds_read_b64_tr_b16 a[106:107], v13 offset:17664
v_mfma_f32_16x16x32_bf16 v[156:159], a[24:27], a[84:87], v[156:159]
ds_read_b64_tr_b16 a[108:109], v13 offset:24832
v_mfma_f32_16x16x32_bf16 v[156:159], a[4:7], a[80:83], v[156:159]
ds_read_b64_tr_b16 a[110:111], v13 offset:25856
v_mfma_f32_16x16x32_bf16 v[160:163], a[8:11], a[80:83], v[160:163]
s_add_u32 m0, s16, 0x8c00
v_mfma_f32_16x16x32_bf16 v[160:163], a[28:31], a[84:87], v[160:163]
buffer_load_dwordx4 v3, s[48:51], s12 offen lds
v_mfma_f32_16x16x32_bf16 v[164:167], a[32:35], a[84:87], v[164:167]
v_mfma_f32_16x16x32_bf16 v[164:167], a[12:15], a[80:83], v[164:167]
v_mfma_f32_16x16x32_bf16 v[180:183], a[12:15], a[88:91], v[180:183]
ds_read_b64_tr_b16 a[80:81], v12 offset:16896
v_mfma_f32_16x16x32_bf16 v[180:183], a[32:35], a[92:95], v[180:183]
ds_read_b64_tr_b16 a[82:83], v12 offset:17920
v_mfma_f32_16x16x32_bf16 v[176:179], a[28:31], a[92:95], v[176:179]
ds_read_b64_tr_b16 a[84:85], v12 offset:25088
v_mfma_f32_16x16x32_bf16 v[176:179], a[8:11], a[88:91], v[176:179]
ds_read_b64_tr_b16 a[86:87], v12 offset:26112
s_add_u32 m0, s16, 0x9000
v_mfma_f32_16x16x32_bf16 v[172:175], a[4:7], a[88:91], v[172:175]
buffer_load_dwordx4 v2, s[48:51], s13 offen lds
v_mfma_f32_16x16x32_bf16 v[172:175], a[24:27], a[92:95], v[172:175]
v_mfma_f32_16x16x32_bf16 v[168:171], a[20:23], a[92:95], v[168:171]
v_mfma_f32_16x16x32_bf16 v[168:171], a[0:3], a[88:91], v[168:171]
s_waitcnt lgkmcnt(4)
v_mfma_f32_16x16x32_bf16 v[184:187], a[0:3], a[96:99], v[184:187]
ds_read_b64_tr_b16 a[88:89], v13 offset:16896
v_mfma_f32_16x16x32_bf16 v[184:187], a[20:23], a[100:103], v[184:187]
ds_read_b64_tr_b16 a[90:91], v13 offset:17920
v_mfma_f32_16x16x32_bf16 v[188:191], a[24:27], a[100:103], v[188:191]
ds_read_b64_tr_b16 a[92:93], v13 offset:25088
s_add_u32 m0, s16, 0x9400
v_mfma_f32_16x16x32_bf16 v[188:191], a[4:7], a[96:99], v[188:191]
buffer_load_dwordx4 v3, s[48:51], s13 offen lds
v_mfma_f32_16x16x32_bf16 v[192:195], a[8:11], a[96:99], v[192:195]
ds_read_b64_tr_b16 a[94:95], v13 offset:26112
v_mfma_f32_16x16x32_bf16 v[192:195], a[28:31], a[100:103], v[192:195]
v_mfma_f32_16x16x32_bf16 v[196:199], a[32:35], a[100:103], v[196:199]
v_mfma_f32_16x16x32_bf16 v[196:199], a[12:15], a[96:99], v[196:199]
v_mfma_f32_16x16x32_bf16 v[212:215], a[12:15], a[104:107], v[212:215]
ds_read_b64_tr_b16 a[96:97], v12 offset:17152
v_mfma_f32_16x16x32_bf16 v[212:215], a[32:35], a[108:111], v[212:215]
ds_read_b64_tr_b16 a[98:99], v12 offset:18176
s_add_u32 m0, s16, 0x9800
v_mfma_f32_16x16x32_bf16 v[208:211], a[28:31], a[108:111], v[208:211]
buffer_load_dwordx4 v2, s[48:51], s14 offen lds
v_mfma_f32_16x16x32_bf16 v[208:211], a[8:11], a[104:107], v[208:211]
ds_read_b64_tr_b16 a[100:101], v12 offset:25344
v_mfma_f32_16x16x32_bf16 v[204:207], a[4:7], a[104:107], v[204:207]
ds_read_b64_tr_b16 a[102:103], v12 offset:26368
v_mfma_f32_16x16x32_bf16 v[204:207], a[24:27], a[108:111], v[204:207]
v_mfma_f32_16x16x32_bf16 v[200:203], a[20:23], a[108:111], v[200:203]
v_mfma_f32_16x16x32_bf16 v[200:203], a[0:3], a[104:107], v[200:203]
s_waitcnt lgkmcnt(4)
v_mfma_f32_16x16x32_bf16 v[248:251], a[0:3], a[80:83], v[248:251]
ds_read_b64_tr_b16 a[104:105], v13 offset:17152
s_add_u32 m0, s16, 0x9c00
v_mfma_f32_16x16x32_bf16 v[248:251], a[20:23], a[84:87], v[248:251]
buffer_load_dwordx4 v3, s[48:51], s14 offen lds
v_mfma_f32_16x16x32_bf16 v[252:255], a[24:27], a[84:87], v[252:255]
ds_read_b64_tr_b16 a[106:107], v13 offset:18176
v_add_u32 v2, 0x80, v2
v_mfma_f32_16x16x32_bf16 v[252:255], a[4:7], a[80:83], v[252:255]
ds_read_b64_tr_b16 a[108:109], v13 offset:25344
v_add_u32 v3, 0x80, v3
v_mfma_f32_16x16x32_bf16 v[216:219], a[8:11], a[80:83], v[216:219]
ds_read_b64_tr_b16 a[110:111], v13 offset:26368
v_add_u32 v12, 0xffff0000, v12
v_mfma_f32_16x16x32_bf16 v[216:219], a[28:31], a[84:87], v[216:219]
v_add_u32 v13, 0xffff0000, v13
v_mfma_f32_16x16x32_bf16 v[220:223], a[32:35], a[84:87], v[220:223]
v_mfma_f32_16x16x32_bf16 v[220:223], a[12:15], a[80:83], v[220:223]
v_mfma_f32_16x16x32_bf16 v[236:239], a[12:15], a[88:91], v[236:239]
s_waitcnt vmcnt(27) lgkmcnt(0)
v_mfma_f32_16x16x32_bf16 v[236:239], a[32:35], a[92:95], v[236:239]
s_barrier
s_add_u32 m0, s17, 0x10000
v_mfma_f32_16x16x32_bf16 v[232:235], a[28:31], a[92:95], v[232:235]
buffer_load_dwordx4 v5, s[56:59], 0 offen lds
v_mfma_f32_16x16x32_bf16 v[232:235], a[8:11], a[88:91], v[232:235]
ds_read_b64_tr_b16 a[80:81], v12 offset:0
v_mfma_f32_16x16x32_bf16 v[228:231], a[4:7], a[88:91], v[228:231]
ds_read_b64_tr_b16 a[82:83], v12 offset:1024
v_mfma_f32_16x16x32_bf16 v[228:231], a[24:27], a[92:95], v[228:231]
ds_read_b64_tr_b16 a[84:85], v12 offset:8192
v_mfma_f32_16x16x32_bf16 v[224:227], a[20:23], a[92:95], v[224:227]
ds_read_b64_tr_b16 a[86:87], v12 offset:9216
v_mfma_f32_16x16x32_bf16 v[224:227], a[0:3], a[88:91], v[224:227]
s_waitcnt lgkmcnt(4)
v_mfma_f32_16x16x32_bf16 v[240:243], a[0:3], a[96:99], v[240:243]
ds_read_b64_tr_b16 a[88:89], v13 offset:0
s_add_u32 m0, s17, 0x14000
v_mfma_f32_16x16x32_bf16 v[240:243], a[20:23], a[100:103], v[240:243]
buffer_load_dwordx4 v5, s[60:63], 0 offen lds
v_mfma_f32_16x16x32_bf16 v[244:247], a[24:27], a[100:103], v[244:247]
ds_read_b64_tr_b16 a[90:91], v13 offset:1024
v_mfma_f32_16x16x32_bf16 v[244:247], a[4:7], a[96:99], v[244:247]
ds_read_b64_tr_b16 a[92:93], v13 offset:8192
v_mfma_f32_16x16x32_bf16 a[232:235], a[8:11], a[96:99], a[232:235]
ds_read_b64_tr_b16 a[94:95], v13 offset:9216
v_mfma_f32_16x16x32_bf16 a[232:235], a[28:31], a[100:103], a[232:235]
v_mfma_f32_16x16x32_bf16 a[236:239], a[32:35], a[100:103], a[236:239]
v_mfma_f32_16x16x32_bf16 a[236:239], a[12:15], a[96:99], a[236:239]
s_add_u32 m0, s17, 0x10400
v_mfma_f32_16x16x32_bf16 a[252:255], a[12:15], a[104:107], a[252:255]
buffer_load_dwordx4 v5, s[56:59], s13 offen lds
v_mfma_f32_16x16x32_bf16 a[252:255], a[32:35], a[108:111], a[252:255]
ds_read_b64_tr_b16 a[96:97], v12 offset:256
v_mfma_f32_16x16x32_bf16 a[248:251], a[28:31], a[108:111], a[248:251]
ds_read_b64_tr_b16 a[98:99], v12 offset:1280
v_mfma_f32_16x16x32_bf16 a[248:251], a[8:11], a[104:107], a[248:251]
ds_read_b64_tr_b16 a[100:101], v12 offset:8448
v_mfma_f32_16x16x32_bf16 a[244:247], a[4:7], a[104:107], a[244:247]
ds_read_b64_tr_b16 a[102:103], v12 offset:9472
v_mfma_f32_16x16x32_bf16 a[244:247], a[24:27], a[108:111], a[244:247]
v_mfma_f32_16x16x32_bf16 a[240:243], a[20:23], a[108:111], a[240:243]
s_add_u32 m0, s17, 0x14400
s_waitcnt lgkmcnt(4)
v_mfma_f32_16x16x32_bf16 a[240:243], a[0:3], a[104:107], a[240:243]
buffer_load_dwordx4 v5, s[60:63], s13 offen lds
L_S3:
v_mfma_f32_16x16x32_bf16 v[24:27], a[80:83], a[40:43], v[24:27]
ds_read_b64_tr_b16 a[104:105], v13 offset:256
s_waitcnt vmcnt(22)
v_mfma_f32_16x16x32_bf16 v[24:27], a[84:87], a[60:63], v[24:27]
ds_read_b64_tr_b16 a[106:107], v13 offset:1280
v_mfma_f32_16x16x32_bf16 v[32:35], a[84:87], a[64:67], v[32:35]
ds_read_b64_tr_b16 a[108:109], v13 offset:8448
v_mfma_f32_16x16x32_bf16 v[32:35], a[80:83], a[44:47], v[32:35]
ds_read_b64_tr_b16 a[110:111], v13 offset:9472
v_mfma_f32_16x16x32_bf16 v[40:43], a[80:83], a[48:51], v[40:43]
ds_read_b128 a[0:3], v8 offset:0
v_mfma_f32_16x16x32_bf16 v[40:43], a[84:87], a[68:71], v[40:43]
ds_read_b128 a[20:23], v9 offset:0
s_mov_b32 s9, 0x0
v_mfma_f32_16x16x32_bf16 v[48:51], a[84:87], a[72:75], v[48:51]
buffer_load_dword a120, v19, s[52:55], s9 offen
v_mfma_f32_16x16x32_bf16 v[48:51], a[80:83], a[52:55], v[48:51]
ds_read_b128 a[4:7], v8 offset:2048
v_mfma_f32_16x16x32_bf16 v[52:55], a[88:91], a[52:55], v[52:55]
ds_read_b64_tr_b16 a[80:81], v12 offset:512
v_mfma_f32_16x16x32_bf16 v[52:55], a[92:95], a[72:75], v[52:55]
ds_read_b64_tr_b16 a[82:83], v12 offset:1536
v_mfma_f32_16x16x32_bf16 v[44:47], a[92:95], a[68:71], v[44:47]
ds_read_b64_tr_b16 a[84:85], v12 offset:8704
v_mfma_f32_16x16x32_bf16 v[44:47], a[88:91], a[48:51], v[44:47]
ds_read_b64_tr_b16 a[86:87], v12 offset:9728
v_mfma_f32_16x16x32_bf16 v[36:39], a[88:91], a[44:47], v[36:39]
ds_read_b128 a[24:27], v9 offset:2048
s_add_u32 m0, s17, 0x10800
v_mfma_f32_16x16x32_bf16 v[36:39], a[92:95], a[64:67], v[36:39]
buffer_load_dwordx4 v6, s[56:59], 0 offen lds
v_mfma_f32_16x16x32_bf16 v[28:31], a[92:95], a[60:63], v[28:31]
ds_read_b128 a[8:11], v8 offset:4096
v_mfma_f32_16x16x32_bf16 v[28:31], a[88:91], a[40:43], v[28:31]
ds_read_b128 a[28:31], v9 offset:4096
s_waitcnt lgkmcnt(10)
v_mfma_f32_16x16x32_bf16 v[56:59], a[96:99], a[40:43], v[56:59]
ds_read_b64_tr_b16 a[88:89], v13 offset:512
v_mfma_f32_16x16x32_bf16 v[56:59], a[100:103], a[60:63], v[56:59]
ds_read_b64_tr_b16 a[90:91], v13 offset:1536
v_mfma_f32_16x16x32_bf16 v[64:67], a[100:103], a[64:67], v[64:67]
ds_read_b64_tr_b16 a[92:93], v13 offset:8704
v_mfma_f32_16x16x32_bf16 v[64:67], a[96:99], a[44:47], v[64:67]
ds_read_b64_tr_b16 a[94:95], v13 offset:9728
s_add_u32 m0, s17, 0x14800
v_mfma_f32_16x16x32_bf16 v[72:75], a[96:99], a[48:51], v[72:75]
buffer_load_dwordx4 v6, s[60:63], 0 offen lds
v_mfma_f32_16x16x32_bf16 v[72:75], a[100:103], a[68:71], v[72:75]
ds_read_b128 a[12:15], v8 offset:6144
v_mfma_f32_16x16x32_bf16 v[80:83], a[100:103], a[72:75], v[80:83]
ds_read_b128 a[32:35], v9 offset:6144
v_mfma_f32_16x16x32_bf16 v[80:83], a[96:99], a[52:55], v[80:83]
v_mfma_f32_16x16x32_bf16 v[84:87], a[104:107], a[52:55], v[84:87]
ds_read_b64_tr_b16 a[96:97], v12 offset:768
v_mfma_f32_16x16x32_bf16 v[84:87], a[108:111], a[72:75], v[84:87]
ds_read_b64_tr_b16 a[98:99], v12 offset:1792
v_mfma_f32_16x16x32_bf16 v[76:79], a[108:111], a[68:71], v[76:79]
ds_read_b64_tr_b16 a[100:101], v12 offset:8960
s_add_u32 m0, s17, 0x10c00
v_mfma_f32_16x16x32_bf16 v[76:79], a[104:107], a[48:51], v[76:79]
buffer_load_dwordx4 v6, s[56:59], s13 offen lds
v_mfma_f32_16x16x32_bf16 v[68:71], a[104:107], a[44:47], v[68:71]
ds_read_b64_tr_b16 a[102:103], v12 offset:9984
v_mfma_f32_16x16x32_bf16 v[68:71], a[108:111], a[64:67], v[68:71]
v_mfma_f32_16x16x32_bf16 v[60:63], a[108:111], a[60:63], v[60:63]
v_mfma_f32_16x16x32_bf16 v[60:63], a[104:107], a[40:43], v[60:63]
s_waitcnt lgkmcnt(6)
v_mfma_f32_16x16x32_bf16 v[88:91], a[80:83], a[40:43], v[88:91]
ds_read_b64_tr_b16 a[104:105], v13 offset:768
v_mfma_f32_16x16x32_bf16 v[88:91], a[84:87], a[60:63], v[88:91]
ds_read_b64_tr_b16 a[106:107], v13 offset:1792
s_add_u32 m0, s17, 0x14c00
v_mfma_f32_16x16x32_bf16 v[96:99], a[84:87], a[64:67], v[96:99]
buffer_load_dwordx4 v6, s[60:63], s13 offen lds
v_mfma_f32_16x16x32_bf16 v[96:99], a[80:83], a[44:47], v[96:99]
ds_read_b64_tr_b16 a[108:109], v13 offset:8960
v_add_u32 v5, 0x80000, v5
v_mfma_f32_16x16x32_bf16 v[104:107], a[80:83], a[48:51], v[104:107]
ds_read_b64_tr_b16 a[110:111], v13 offset:9984
v_add_u32 v6, 0x80000, v6
v_mfma_f32_16x16x32_bf16 v[104:107], a[84:87], a[68:71], v[104:107]
v_mfma_f32_16x16x32_bf16 v[112:115], a[84:87], a[72:75], v[112:115]
v_mfma_f32_16x16x32_bf16 v[112:115], a[80:83], a[52:55], v[112:115]
v_mfma_f32_16x16x32_bf16 v[116:119], a[88:91], a[52:55], v[116:119]
ds_read_b64_tr_b16 a[80:81], v12 offset:16384
s_mov_b32 s9, 0x0
v_mfma_f32_16x16x32_bf16 v[116:119], a[92:95], a[72:75], v[116:119]
buffer_load_dword a120, v19, s[68:71], s9 offen
v_mfma_f32_16x16x32_bf16 v[108:111], a[92:95], a[68:71], v[108:111]
ds_read_b64_tr_b16 a[82:83], v12 offset:17408
v_mfma_f32_16x16x32_bf16 v[108:111], a[88:91], a[48:51], v[108:111]
ds_read_b64_tr_b16 a[84:85], v12 offset:24576
v_mfma_f32_16x16x32_bf16 v[100:103], a[88:91], a[44:47], v[100:103]
ds_read_b64_tr_b16 a[86:87], v12 offset:25600
v_mfma_f32_16x16x32_bf16 v[100:103], a[92:95], a[64:67], v[100:103]
v_mfma_f32_16x16x32_bf16 v[92:95], a[92:95], a[60:63], v[92:95]
v_mfma_f32_16x16x32_bf16 v[92:95], a[88:91], a[40:43], v[92:95]
s_add_u32 m0, s16, 0x0
s_waitcnt lgkmcnt(12)
s_waitcnt lgkmcnt(4)
v_mfma_f32_16x16x32_bf16 v[120:123], a[96:99], a[40:43], v[120:123]
buffer_load_dwordx4 v2, s[48:51], 0 offen lds
v_mfma_f32_16x16x32_bf16 v[120:123], a[100:103], a[60:63], v[120:123]
ds_read_b64_tr_b16 a[88:89], v13 offset:16384
v_mfma_f32_16x16x32_bf16 v[128:131], a[100:103], a[64:67], v[128:131]
ds_read_b64_tr_b16 a[90:91], v13 offset:17408
v_mfma_f32_16x16x32_bf16 v[128:131], a[96:99], a[44:47], v[128:131]
ds_read_b64_tr_b16 a[92:93], v13 offset:24576
v_mfma_f32_16x16x32_bf16 v[136:139], a[96:99], a[48:51], v[136:139]
ds_read_b64_tr_b16 a[94:95], v13 offset:25600
v_mfma_f32_16x16x32_bf16 v[136:139], a[100:103], a[68:71], v[136:139]
v_mfma_f32_16x16x32_bf16 v[144:147], a[100:103], a[72:75], v[144:147]
s_add_u32 m0, s16, 0x400
v_mfma_f32_16x16x32_bf16 v[144:147], a[96:99], a[52:55], v[144:147]
buffer_load_dwordx4 v3, s[48:51], 0 offen lds
v_mfma_f32_16x16x32_bf16 v[148:151], a[104:107], a[52:55], v[148:151]
ds_read_b64_tr_b16 a[96:97], v12 offset:16640
v_mfma_f32_16x16x32_bf16 v[148:151], a[108:111], a[72:75], v[148:151]
ds_read_b64_tr_b16 a[98:99], v12 offset:17664
v_mfma_f32_16x16x32_bf16 v[140:143], a[108:111], a[68:71], v[140:143]
ds_read_b64_tr_b16 a[100:101], v12 offset:24832
v_mfma_f32_16x16x32_bf16 v[140:143], a[104:107], a[48:51], v[140:143]
ds_read_b64_tr_b16 a[102:103], v12 offset:25856
v_mfma_f32_16x16x32_bf16 v[132:135], a[104:107], a[44:47], v[132:135]
v_mfma_f32_16x16x32_bf16 v[132:135], a[108:111], a[64:67], v[132:135]
s_add_u32 m0, s16, 0x800
v_mfma_f32_16x16x32_bf16 v[124:127], a[108:111], a[60:63], v[124:127]
buffer_load_dwordx4 v2, s[48:51], s12 offen lds
v_mfma_f32_16x16x32_bf16 v[124:127], a[104:107], a[40:43], v[124:127]
s_waitcnt lgkmcnt(4)
v_mfma_f32_16x16x32_bf16 v[152:155], a[40:43], a[80:83], v[152:155]
ds_read_b64_tr_b16 a[104:105], v13 offset:16640
v_mfma_f32_16x16x32_bf16 v[152:155], a[60:63], a[84:87], v[152:155]
ds_read_b64_tr_b16 a[106:107], v13 offset:17664
v_mfma_f32_16x16x32_bf16 v[156:159], a[64:67], a[84:87], v[156:159]
ds_read_b64_tr_b16 a[108:109], v13 offset:24832
v_mfma_f32_16x16x32_bf16 v[156:159], a[44:47], a[80:83], v[156:159]
ds_read_b64_tr_b16 a[110:111], v13 offset:25856
v_mfma_f32_16x16x32_bf16 v[160:163], a[48:51], a[80:83], v[160:163]
s_add_u32 m0, s16, 0xc00
v_mfma_f32_16x16x32_bf16 v[160:163], a[68:71], a[84:87], v[160:163]
buffer_load_dwordx4 v3, s[48:51], s12 offen lds
v_mfma_f32_16x16x32_bf16 v[164:167], a[72:75], a[84:87], v[164:167]
v_mfma_f32_16x16x32_bf16 v[164:167], a[52:55], a[80:83], v[164:167]
v_mfma_f32_16x16x32_bf16 v[180:183], a[52:55], a[88:91], v[180:183]
ds_read_b64_tr_b16 a[80:81], v12 offset:16896
v_mfma_f32_16x16x32_bf16 v[180:183], a[72:75], a[92:95], v[180:183]
ds_read_b64_tr_b16 a[82:83], v12 offset:17920
v_mfma_f32_16x16x32_bf16 v[176:179], a[68:71], a[92:95], v[176:179]
ds_read_b64_tr_b16 a[84:85], v12 offset:25088
v_mfma_f32_16x16x32_bf16 v[176:179], a[48:51], a[88:91], v[176:179]
ds_read_b64_tr_b16 a[86:87], v12 offset:26112
s_add_u32 m0, s16, 0x1000
v_mfma_f32_16x16x32_bf16 v[172:175], a[44:47], a[88:91], v[172:175]
buffer_load_dwordx4 v2, s[48:51], s13 offen lds
v_mfma_f32_16x16x32_bf16 v[172:175], a[64:67], a[92:95], v[172:175]
v_mfma_f32_16x16x32_bf16 v[168:171], a[60:63], a[92:95], v[168:171]
v_mfma_f32_16x16x32_bf16 v[168:171], a[40:43], a[88:91], v[168:171]
s_waitcnt lgkmcnt(4)
v_mfma_f32_16x16x32_bf16 v[184:187], a[40:43], a[96:99], v[184:187]
ds_read_b64_tr_b16 a[88:89], v13 offset:16896
v_mfma_f32_16x16x32_bf16 v[184:187], a[60:63], a[100:103], v[184:187]
ds_read_b64_tr_b16 a[90:91], v13 offset:17920
v_mfma_f32_16x16x32_bf16 v[188:191], a[64:67], a[100:103], v[188:191]
ds_read_b64_tr_b16 a[92:93], v13 offset:25088
s_add_u32 m0, s16, 0x1400
v_mfma_f32_16x16x32_bf16 v[188:191], a[44:47], a[96:99], v[188:191]
buffer_load_dwordx4 v3, s[48:51], s13 offen lds
v_mfma_f32_16x16x32_bf16 v[192:195], a[48:51], a[96:99], v[192:195]
ds_read_b64_tr_b16 a[94:95], v13 offset:26112
v_mfma_f32_16x16x32_bf16 v[192:195], a[68:71], a[100:103], v[192:195]
v_mfma_f32_16x16x32_bf16 v[196:199], a[72:75], a[100:103], v[196:199]
v_mfma_f32_16x16x32_bf16 v[196:199], a[52:55], a[96:99], v[196:199]
v_mfma_f32_16x16x32_bf16 v[212:215], a[52:55], a[104:107], v[212:215]
ds_read_b64_tr_b16 a[96:97], v12 offset:17152
v_mfma_f32_16x16x32_bf16 v[212:215], a[72:75], a[108:111], v[212:215]
ds_read_b64_tr_b16 a[98:99], v12 offset:18176
s_add_u32 m0, s16, 0x1800
v_mfma_f32_16x16x32_bf16 v[208:211], a[68:71], a[108:111], v[208:211]
buffer_load_dwordx4 v2, s[48:51], s14 offen lds
v_mfma_f32_16x16x32_bf16 v[208:211], a[48:51], a[104:107], v[208:211]
ds_read_b64_tr_b16 a[100:101], v12 offset:25344
v_mfma_f32_16x16x32_bf16 v[204:207], a[44:47], a[104:107], v[204:207]
ds_read_b64_tr_b16 a[102:103], v12 offset:26368
v_mfma_f32_16x16x32_bf16 v[204:207], a[64:67], a[108:111], v[204:207]
v_mfma_f32_16x16x32_bf16 v[200:203], a[60:63], a[108:111], v[200:203]
v_mfma_f32_16x16x32_bf16 v[200:203], a[40:43], a[104:107], v[200:203]
s_waitcnt lgkmcnt(4)
v_mfma_f32_16x16x32_bf16 v[248:251], a[40:43], a[80:83], v[248:251]
ds_read_b64_tr_b16 a[104:105], v13 offset:17152
s_add_u32 m0, s16, 0x1c00
v_mfma_f32_16x16x32_bf16 v[248:251], a[60:63], a[84:87], v[248:251]
buffer_load_dwordx4 v3, s[48:51], s14 offen lds
v_mfma_f32_16x16x32_bf16 v[252:255], a[64:67], a[84:87], v[252:255]
ds_read_b64_tr_b16 a[106:107], v13 offset:18176
v_add_u32 v2, 0x80, v2
v_mfma_f32_16x16x32_bf16 v[252:255], a[44:47], a[80:83], v[252:255]
ds_read_b64_tr_b16 a[108:109], v13 offset:25344
v_add_u32 v3, 0x80, v3
v_mfma_f32_16x16x32_bf16 v[216:219], a[48:51], a[80:83], v[216:219]
ds_read_b64_tr_b16 a[110:111], v13 offset:26368
v_add_u32 v12, 0x8000, v12
v_mfma_f32_16x16x32_bf16 v[216:219], a[68:71], a[84:87], v[216:219]
v_add_u32 v13, 0x8000, v13
v_mfma_f32_16x16x32_bf16 v[220:223], a[72:75], a[84:87], v[220:223]
v_mfma_f32_16x16x32_bf16 v[220:223], a[52:55], a[80:83], v[220:223]
v_mfma_f32_16x16x32_bf16 v[236:239], a[52:55], a[88:91], v[236:239]
s_waitcnt vmcnt(27) lgkmcnt(0)
v_mfma_f32_16x16x32_bf16 v[236:239], a[72:75], a[92:95], v[236:239]
s_barrier
s_add_u32 m0, s17, 0x0
v_mfma_f32_16x16x32_bf16 v[232:235], a[68:71], a[92:95], v[232:235]
buffer_load_dwordx4 v5, s[56:59], 0 offen lds
v_mfma_f32_16x16x32_bf16 v[232:235], a[48:51], a[88:91], v[232:235]
ds_read_b64_tr_b16 a[80:81], v12 offset:0
v_accvgpr_read_b32 v7, a144
v_mfma_f32_16x16x32_bf16 v[228:231], a[44:47], a[88:91], v[228:231]
ds_read_b64_tr_b16 a[82:83], v12 offset:1024
v_lshlrev_b32 v4, 16, v7
v_mfma_f32_16x16x32_bf16 v[228:231], a[64:67], a[92:95], v[228:231]
ds_read_b64_tr_b16 a[84:85], v12 offset:8192
v_and_b32 v7, 0xffff0000, v7
v_mfma_f32_16x16x32_bf16 v[224:227], a[60:63], a[92:95], v[224:227]
ds_read_b64_tr_b16 a[86:87], v12 offset:9216
v_accvgpr_read_b32 v15, a128
v_mfma_f32_16x16x32_bf16 v[224:227], a[40:43], a[88:91], v[224:227]
s_waitcnt lgkmcnt(4)
v_lshlrev_b32 v14, 16, v15
v_and_b32 v15, 0xffff0000, v15
v_mfma_f32_16x16x32_bf16 v[240:243], a[40:43], a[96:99], v[240:243]
ds_read_b64_tr_b16 a[88:89], v13 offset:0
s_add_u32 m0, s17, 0x4000
v_mfma_f32_16x16x32_bf16 v[240:243], a[60:63], a[100:103], v[240:243]
buffer_load_dwordx4 v5, s[60:63], 0 offen lds
v_mfma_f32_16x16x32_bf16 v[244:247], a[64:67], a[100:103], v[244:247]
ds_read_b64_tr_b16 a[90:91], v13 offset:1024
v_mul_f32 v10, v4, v14
v_mfma_f32_16x16x32_bf16 v[244:247], a[44:47], a[96:99], v[244:247]
ds_read_b64_tr_b16 a[92:93], v13 offset:8192
v_fmac_f32 v10, v7, v15
v_mfma_f32_16x16x32_bf16 a[232:235], a[48:51], a[96:99], a[232:235]
ds_read_b64_tr_b16 a[94:95], v13 offset:9216
v_accvgpr_read_b32 v15, a136
v_mfma_f32_16x16x32_bf16 a[232:235], a[68:71], a[100:103], a[232:235]
v_lshlrev_b32 v14, 16, v15
v_and_b32 v15, 0xffff0000, v15
v_mfma_f32_16x16x32_bf16 a[236:239], a[72:75], a[100:103], a[236:239]
v_mul_f32 v11, v4, v14
v_fmac_f32 v11, v7, v15
v_mfma_f32_16x16x32_bf16 a[236:239], a[52:55], a[96:99], a[236:239]
s_add_u32 m0, s17, 0x400
v_accvgpr_read_b32 v7, a145
v_lshlrev_b32 v4, 16, v7
v_mfma_f32_16x16x32_bf16 a[252:255], a[52:55], a[104:107], a[252:255]
buffer_load_dwordx4 v5, s[56:59], s13 offen lds
v_mfma_f32_16x16x32_bf16 a[252:255], a[72:75], a[108:111], a[252:255]
ds_read_b64_tr_b16 a[96:97], v12 offset:256
v_and_b32 v7, 0xffff0000, v7
v_mfma_f32_16x16x32_bf16 a[248:251], a[68:71], a[108:111], a[248:251]
ds_read_b64_tr_b16 a[98:99], v12 offset:1280
v_accvgpr_read_b32 v15, a129
v_mfma_f32_16x16x32_bf16 a[248:251], a[48:51], a[104:107], a[248:251]
ds_read_b64_tr_b16 a[100:101], v12 offset:8448
v_lshlrev_b32 v14, 16, v15
v_mfma_f32_16x16x32_bf16 a[244:247], a[44:47], a[104:107], a[244:247]
ds_read_b64_tr_b16 a[102:103], v12 offset:9472
v_and_b32 v15, 0xffff0000, v15
v_mfma_f32_16x16x32_bf16 a[244:247], a[64:67], a[108:111], a[244:247]
v_fmac_f32 v10, v4, v14
v_fmac_f32 v10, v7, v15
v_mfma_f32_16x16x32_bf16 a[240:243], a[60:63], a[108:111], a[240:243]
v_accvgpr_read_b32 v15, a137
v_lshlrev_b32 v14, 16, v15
v_mfma_f32_16x16x32_bf16 a[240:243], a[40:43], a[104:107], a[240:243]
s_add_u32 m0, s17, 0x4400
s_waitcnt lgkmcnt(4)
v_and_b32 v15, 0xffff0000, v15
L_S4:
v_mfma_f32_16x16x32_bf16 v[24:27], a[80:83], a[0:3], v[24:27]
buffer_load_dwordx4 v5, s[60:63], s13 offen lds
v_mfma_f32_16x16x32_bf16 v[24:27], a[84:87], a[20:23], v[24:27]
ds_read_b64_tr_b16 a[104:105], v13 offset:256
s_waitcnt vmcnt(22)
v_mfma_f32_16x16x32_bf16 v[32:35], a[84:87], a[24:27], v[32:35]
ds_read_b64_tr_b16 a[106:107], v13 offset:1280
v_fmac_f32 v11, v4, v14
v_mfma_f32_16x16x32_bf16 v[32:35], a[80:83], a[4:7], v[32:35]
ds_read_b64_tr_b16 a[108:109], v13 offset:8448
v_fmac_f32 v11, v7, v15
v_mfma_f32_16x16x32_bf16 v[40:43], a[80:83], a[8:11], v[40:43]
ds_read_b64_tr_b16 a[110:111], v13 offset:9472
v_accvgpr_read_b32 v7, a146
v_mfma_f32_16x16x32_bf16 v[40:43], a[84:87], a[28:31], v[40:43]
ds_read_b128 a[40:43], v8 offset:32768
v_lshlrev_b32 v4, 16, v7
v_mfma_f32_16x16x32_bf16 v[48:51], a[84:87], a[32:35], v[48:51]
ds_read_b128 a[60:63], v9 offset:32768
s_add_u32 m0, s17, 0x800
v_mfma_f32_16x16x32_bf16 v[48:51], a[80:83], a[12:15], v[48:51]
buffer_load_dwordx4 v6, s[56:59], 0 offen lds
v_mfma_f32_16x16x32_bf16 v[52:55], a[88:91], a[12:15], v[52:55]
ds_read_b64_tr_b16 a[80:81], v12 offset:512
v_and_b32 v7, 0xffff0000, v7
v_mfma_f32_16x16x32_bf16 v[52:55], a[92:95], a[32:35], v[52:55]
ds_read_b64_tr_b16 a[82:83], v12 offset:1536
v_accvgpr_read_b32 v15, a130
v_mfma_f32_16x16x32_bf16 v[44:47], a[92:95], a[28:31], v[44:47]
ds_read_b64_tr_b16 a[84:85], v12 offset:8704
v_lshlrev_b32 v14, 16, v15
v_mfma_f32_16x16x32_bf16 v[44:47], a[88:91], a[8:11], v[44:47]
ds_read_b64_tr_b16 a[86:87], v12 offset:9728
v_and_b32 v15, 0xffff0000, v15
v_mfma_f32_16x16x32_bf16 v[36:39], a[88:91], a[4:7], v[36:39]
ds_read_b128 a[44:47], v8 offset:34816
v_fmac_f32 v10, v4, v14
v_mfma_f32_16x16x32_bf16 v[36:39], a[92:95], a[24:27], v[36:39]
ds_read_b128 a[64:67], v9 offset:34816
s_waitcnt lgkmcnt(8)
v_mfma_f32_16x16x32_bf16 v[28:31], a[92:95], a[20:23], v[28:31]
ds_read_b128 a[48:51], v8 offset:36864
s_add_u32 m0, s17, 0x4800
v_mfma_f32_16x16x32_bf16 v[28:31], a[88:91], a[0:3], v[28:31]
buffer_load_dwordx4 v6, s[60:63], 0 offen lds
v_mfma_f32_16x16x32_bf16 v[56:59], a[96:99], a[0:3], v[56:59]
ds_read_b64_tr_b16 a[88:89], v13 offset:512
v_fmac_f32 v10, v7, v15
v_mfma_f32_16x16x32_bf16 v[56:59], a[100:103], a[20:23], v[56:59]
ds_read_b64_tr_b16 a[90:91], v13 offset:1536
v_accvgpr_read_b32 v15, a138
v_mfma_f32_16x16x32_bf16 v[64:67], a[100:103], a[24:27], v[64:67]
ds_read_b64_tr_b16 a[92:93], v13 offset:8704
v_lshlrev_b32 v14, 16, v15
v_mfma_f32_16x16x32_bf16 v[64:67], a[96:99], a[4:7], v[64:67]
ds_read_b64_tr_b16 a[94:95], v13 offset:9728
v_and_b32 v15, 0xffff0000, v15
v_mfma_f32_16x16x32_bf16 v[72:75], a[96:99], a[8:11], v[72:75]
ds_read_b128 a[68:71], v9 offset:36864
v_fmac_f32 v11, v4, v14
v_mfma_f32_16x16x32_bf16 v[72:75], a[100:103], a[28:31], v[72:75]
ds_read_b128 a[52:55], v8 offset:38912
s_add_u32 m0, s17, 0xc00
v_mfma_f32_16x16x32_bf16 v[80:83], a[100:103], a[32:35], v[80:83]
buffer_load_dwordx4 v6, s[56:59], s13 offen lds
v_mfma_f32_16x16x32_bf16 v[80:83], a[96:99], a[12:15], v[80:83]
ds_read_b128 a[72:75], v9 offset:38912
v_fmac_f32 v11, v7, v15
v_mfma_f32_16x16x32_bf16 v[84:87], a[104:107], a[12:15], v[84:87]
ds_read_b64_tr_b16 a[96:97], v12 offset:768
v_accvgpr_read_b32 v7, a147
v_mfma_f32_16x16x32_bf16 v[84:87], a[108:111], a[32:35], v[84:87]
ds_read_b64_tr_b16 a[98:99], v12 offset:1792
v_lshlrev_b32 v4, 16, v7
v_mfma_f32_16x16x32_bf16 v[76:79], a[108:111], a[28:31], v[76:79]
ds_read_b64_tr_b16 a[100:101], v12 offset:8960
v_and_b32 v7, 0xffff0000, v7
v_mfma_f32_16x16x32_bf16 v[76:79], a[104:107], a[8:11], v[76:79]
ds_read_b64_tr_b16 a[102:103], v12 offset:9984
v_accvgpr_read_b32 v15, a131
v_mfma_f32_16x16x32_bf16 v[68:71], a[104:107], a[4:7], v[68:71]
s_add_u32 m0, s17, 0x4c00
v_lshlrev_b32 v14, 16, v15
v_and_b32 v15, 0xffff0000, v15
v_mfma_f32_16x16x32_bf16 v[68:71], a[108:111], a[24:27], v[68:71]
buffer_load_dwordx4 v6, s[60:63], s13 offen lds
v_mfma_f32_16x16x32_bf16 v[60:63], a[108:111], a[20:23], v[60:63]
v_add_u32 v5, 0x80000, v5
v_add_u32 v6, 0x80000, v6
v_mfma_f32_16x16x32_bf16 v[60:63], a[104:107], a[0:3], v[60:63]
s_waitcnt lgkmcnt(7)
v_fmac_f32 v10, v4, v14
v_fmac_f32 v10, v7, v15
v_mfma_f32_16x16x32_bf16 v[88:91], a[80:83], a[0:3], v[88:91]
ds_read_b64_tr_b16 a[104:105], v13 offset:768
v_accvgpr_read_b32 v15, a139
v_mfma_f32_16x16x32_bf16 v[88:91], a[84:87], a[20:23], v[88:91]
ds_read_b64_tr_b16 a[106:107], v13 offset:1792
v_lshlrev_b32 v14, 16, v15
v_mfma_f32_16x16x32_bf16 v[96:99], a[84:87], a[24:27], v[96:99]
ds_read_b64_tr_b16 a[108:109], v13 offset:8960
v_and_b32 v15, 0xffff0000, v15
v_mfma_f32_16x16x32_bf16 v[96:99], a[80:83], a[4:7], v[96:99]
ds_read_b64_tr_b16 a[110:111], v13 offset:9984
v_fmac_f32 v11, v4, v14
v_mfma_f32_16x16x32_bf16 v[104:107], a[80:83], a[8:11], v[104:107]
s_mov_b32 s9, 0x200000
v_fmac_f32 v11, v7, v15
v_accvgpr_read_b32 v7, a148
v_mfma_f32_16x16x32_bf16 v[104:107], a[84:87], a[28:31], v[104:107]
buffer_load_dword a120, v19, s[52:55], s9 offen
v_mfma_f32_16x16x32_bf16 v[112:115], a[84:87], a[32:35], v[112:115]
v_lshlrev_b32 v4, 16, v7
v_and_b32 v7, 0xffff0000, v7
v_mfma_f32_16x16x32_bf16 v[112:115], a[80:83], a[12:15], v[112:115]
v_accvgpr_read_b32 v15, a132
v_lshlrev_b32 v14, 16, v15
v_mfma_f32_16x16x32_bf16 v[116:119], a[88:91], a[12:15], v[116:119]
ds_read_b64_tr_b16 a[80:81], v12 offset:16384
v_and_b32 v15, 0xffff0000, v15
v_mfma_f32_16x16x32_bf16 v[116:119], a[92:95], a[32:35], v[116:119]
ds_read_b64_tr_b16 a[82:83], v12 offset:17408
v_fmac_f32 v10, v4, v14
v_mfma_f32_16x16x32_bf16 v[108:111], a[92:95], a[28:31], v[108:111]
ds_read_b64_tr_b16 a[84:85], v12 offset:24576
s_waitcnt lgkmcnt(11)
v_mfma_f32_16x16x32_bf16 v[108:111], a[88:91], a[8:11], v[108:111]
ds_read_b64_tr_b16 a[86:87], v12 offset:25600
s_add_u32 m0, s16, 0x8000
v_mfma_f32_16x16x32_bf16 v[100:103], a[88:91], a[4:7], v[100:103]
buffer_load_dwordx4 v2, s[48:51], 0 offen lds
v_mfma_f32_16x16x32_bf16 v[100:103], a[92:95], a[24:27], v[100:103]
v_fmac_f32 v10, v7, v15
v_accvgpr_read_b32 v15, a140
v_mfma_f32_16x16x32_bf16 v[92:95], a[92:95], a[20:23], v[92:95]
v_lshlrev_b32 v14, 16, v15
v_and_b32 v15, 0xffff0000, v15
v_mfma_f32_16x16x32_bf16 v[92:95], a[88:91], a[0:3], v[92:95]
s_waitcnt lgkmcnt(4)
v_fmac_f32 v11, v4, v14
v_fmac_f32 v11, v7, v15
v_mfma_f32_16x16x32_bf16 v[120:123], a[96:99], a[0:3], v[120:123]
ds_read_b64_tr_b16 a[88:89], v13 offset:16384
v_accvgpr_read_b32 v7, a149
v_mfma_f32_16x16x32_bf16 v[120:123], a[100:103], a[20:23], v[120:123]
ds_read_b64_tr_b16 a[90:91], v13 offset:17408
v_lshlrev_b32 v4, 16, v7
v_mfma_f32_16x16x32_bf16 v[128:131], a[100:103], a[24:27], v[128:131]
ds_read_b64_tr_b16 a[92:93], v13 offset:24576
v_and_b32 v7, 0xffff0000, v7
v_mfma_f32_16x16x32_bf16 v[128:131], a[96:99], a[4:7], v[128:131]
ds_read_b64_tr_b16 a[94:95], v13 offset:25600
s_add_u32 m0, s16, 0x8400
v_mfma_f32_16x16x32_bf16 v[136:139], a[96:99], a[8:11], v[136:139]
buffer_load_dwordx4 v3, s[48:51], 0 offen lds
v_mfma_f32_16x16x32_bf16 v[136:139], a[100:103], a[28:31], v[136:139]
v_accvgpr_read_b32 v15, a133
v_lshlrev_b32 v14, 16, v15
v_mfma_f32_16x16x32_bf16 v[144:147], a[100:103], a[32:35], v[144:147]
v_and_b32 v15, 0xffff0000, v15
v_fmac_f32 v10, v4, v14
v_mfma_f32_16x16x32_bf16 v[144:147], a[96:99], a[12:15], v[144:147]
v_fmac_f32 v10, v7, v15
v_accvgpr_read_b32 v15, a141
v_mfma_f32_16x16x32_bf16 v[148:151], a[104:107], a[12:15], v[148:151]
ds_read_b64_tr_b16 a[96:97], v12 offset:16640
v_lshlrev_b32 v14, 16, v15
v_mfma_f32_16x16x32_bf16 v[148:151], a[108:111], a[32:35], v[148:151]
ds_read_b64_tr_b16 a[98:99], v12 offset:17664
v_and_b32 v15, 0xffff0000, v15
v_mfma_f32_16x16x32_bf16 v[140:143], a[108:111], a[28:31], v[140:143]
ds_read_b64_tr_b16 a[100:101], v12 offset:24832
s_add_u32 m0, s16, 0x8800
v_mfma_f32_16x16x32_bf16 v[140:143], a[104:107], a[8:11], v[140:143]
buffer_load_dwordx4 v2, s[48:51], s12 offen lds
v_mfma_f32_16x16x32_bf16 v[132:135], a[104:107], a[4:7], v[132:135]
ds_read_b64_tr_b16 a[102:103], v12 offset:25856
v_fmac_f32 v11, v4, v14
v_mfma_f32_16x16x32_bf16 v[132:135], a[108:111], a[24:27], v[132:135]
v_fmac_f32 v11, v7, v15
v_accvgpr_read_b32 v7, a150
v_mfma_f32_16x16x32_bf16 v[124:127], a[108:111], a[20:23], v[124:127]
v_lshlrev_b32 v4, 16, v7
v_and_b32 v7, 0xffff0000, v7
v_mfma_f32_16x16x32_bf16 v[124:127], a[104:107], a[0:3], v[124:127]
s_waitcnt lgkmcnt(4)
v_accvgpr_read_b32 v15, a134
v_lshlrev_b32 v14, 16, v15
v_mfma_f32_16x16x32_bf16 v[152:155], a[0:3], a[80:83], v[152:155]
ds_read_b64_tr_b16 a[104:105], v13 offset:16640
v_and_b32 v15, 0xffff0000, v15
v_mfma_f32_16x16x32_bf16 v[152:155], a[20:23], a[84:87], v[152:155]
ds_read_b64_tr_b16 a[106:107], v13 offset:17664
s_add_u32 m0, s16, 0x8c00
v_mfma_f32_16x16x32_bf16 v[156:159], a[24:27], a[84:87], v[156:159]
buffer_load_dwordx4 v3, s[48:51], s12 offen lds
v_mfma_f32_16x16x32_bf16 v[156:159], a[4:7], a[80:83], v[156:159]
ds_read_b64_tr_b16 a[108:109], v13 offset:24832
v_fmac_f32 v10, v4, v14
v_mfma_f32_16x16x32_bf16 v[160:163], a[8:11], a[80:83], v[160:163]
ds_read_b64_tr_b16 a[110:111], v13 offset:25856
v_fmac_f32 v10, v7, v15
v_mfma_f32_16x16x32_bf16 v[160:163], a[28:31], a[84:87], v[160:163]
v_accvgpr_read_b32 v15, a142
v_lshlrev_b32 v14, 16, v15
v_mfma_f32_16x16x32_bf16 v[164:167], a[32:35], a[84:87], v[164:167]
v_and_b32 v15, 0xffff0000, v15
v_fmac_f32 v11, v4, v14
v_mfma_f32_16x16x32_bf16 v[164:167], a[12:15], a[80:83], v[164:167]
v_fmac_f32 v11, v7, v15
v_accvgpr_read_b32 v7, a151
v_mfma_f32_16x16x32_bf16 v[180:183], a[12:15], a[88:91], v[180:183]
ds_read_b64_tr_b16 a[80:81], v12 offset:16896
v_lshlrev_b32 v4, 16, v7
v_mfma_f32_16x16x32_bf16 v[180:183], a[32:35], a[92:95], v[180:183]
ds_read_b64_tr_b16 a[82:83], v12 offset:17920
s_add_u32 m0, s16, 0x9000
v_mfma_f32_16x16x32_bf16 v[176:179], a[28:31], a[92:95], v[176:179]
buffer_load_dwordx4 v2, s[48:51], s13 offen lds
v_mfma_f32_16x16x32_bf16 v[176:179], a[8:11], a[88:91], v[176:179]
ds_read_b64_tr_b16 a[84:85], v12 offset:25088
v_and_b32 v7, 0xffff0000, v7
v_mfma_f32_16x16x32_bf16 v[172:175], a[4:7], a[88:91], v[172:175]
ds_read_b64_tr_b16 a[86:87], v12 offset:26112
v_accvgpr_read_b32 v15, a135
v_mfma_f32_16x16x32_bf16 v[172:175], a[24:27], a[92:95], v[172:175]
v_lshlrev_b32 v14, 16, v15
v_and_b32 v15, 0xffff0000, v15
v_mfma_f32_16x16x32_bf16 v[168:171], a[20:23], a[92:95], v[168:171]
v_fmac_f32 v10, v4, v14
v_fmac_f32 v10, v7, v15
v_mfma_f32_16x16x32_bf16 v[168:171], a[0:3], a[88:91], v[168:171]
s_waitcnt lgkmcnt(4)
v_accvgpr_read_b32 v15, a143
v_lshlrev_b32 v14, 16, v15
v_mfma_f32_16x16x32_bf16 v[184:187], a[0:3], a[96:99], v[184:187]
ds_read_b64_tr_b16 a[88:89], v13 offset:16896
s_add_u32 m0, s16, 0x9400
v_mfma_f32_16x16x32_bf16 v[184:187], a[20:23], a[100:103], v[184:187]
buffer_load_dwordx4 v3, s[48:51], s13 offen lds
v_mfma_f32_16x16x32_bf16 v[188:191], a[24:27], a[100:103], v[188:191]
ds_read_b64_tr_b16 a[90:91], v13 offset:17920
v_and_b32 v15, 0xffff0000, v15
v_mfma_f32_16x16x32_bf16 v[188:191], a[4:7], a[96:99], v[188:191]
ds_read_b64_tr_b16 a[92:93], v13 offset:25088
v_fmac_f32 v11, v4, v14
v_mfma_f32_16x16x32_bf16 v[192:195], a[8:11], a[96:99], v[192:195]
ds_read_b64_tr_b16 a[94:95], v13 offset:26112
v_fmac_f32 v11, v7, v15
v_mfma_f32_16x16x32_bf16 v[192:195], a[28:31], a[100:103], v[192:195]
v_add_f32_dpp v10, v10, v10 row_ror:8 row_mask:0xf bank_mask:0xf
v_add_f32_dpp v11, v11, v11 row_ror:8 row_mask:0xf bank_mask:0xf
v_mfma_f32_16x16x32_bf16 v[196:199], a[32:35], a[100:103], v[196:199]
v_add_f32_dpp v10, v10, v10 row_ror:4 row_mask:0xf bank_mask:0xf
v_add_f32_dpp v11, v11, v11 row_ror:4 row_mask:0xf bank_mask:0xf
v_mfma_f32_16x16x32_bf16 v[196:199], a[12:15], a[96:99], v[196:199]
v_add_f32_dpp v10, v10, v10 row_ror:2 row_mask:0xf bank_mask:0xf
v_add_f32_dpp v11, v11, v11 row_ror:2 row_mask:0xf bank_mask:0xf
v_mfma_f32_16x16x32_bf16 v[212:215], a[12:15], a[104:107], v[212:215]
ds_read_b64_tr_b16 a[96:97], v12 offset:17152
s_add_u32 m0, s16, 0x9800
v_mfma_f32_16x16x32_bf16 v[212:215], a[32:35], a[108:111], v[212:215]
buffer_load_dwordx4 v2, s[48:51], s14 offen lds
v_mfma_f32_16x16x32_bf16 v[208:211], a[28:31], a[108:111], v[208:211]
ds_read_b64_tr_b16 a[98:99], v12 offset:18176
v_add_f32_dpp v10, v10, v10 row_ror:1 row_mask:0xf bank_mask:0xf
v_mfma_f32_16x16x32_bf16 v[208:211], a[8:11], a[104:107], v[208:211]
ds_read_b64_tr_b16 a[100:101], v12 offset:25344
v_add_f32_dpp v11, v11, v11 row_ror:1 row_mask:0xf bank_mask:0xf
v_mfma_f32_16x16x32_bf16 v[204:207], a[4:7], a[104:107], v[204:207]
ds_read_b64_tr_b16 a[102:103], v12 offset:26368
v_mov_b32 v4, v10
v_mfma_f32_16x16x32_bf16 v[204:207], a[24:27], a[108:111], v[204:207]
v_mov_b32 v7, v11
v_mfma_f32_16x16x32_bf16 v[200:203], a[20:23], a[108:111], v[200:203]
v_permlane16_swap_b32 v4, v10
v_permlane16_swap_b32 v7, v11
v_mfma_f32_16x16x32_bf16 v[200:203], a[0:3], a[104:107], v[200:203]
s_add_u32 m0, s16, 0x9c00
s_waitcnt lgkmcnt(4)
v_add_f32 v10, v10, v4
v_mfma_f32_16x16x32_bf16 v[248:251], a[0:3], a[80:83], v[248:251]
buffer_load_dwordx4 v3, s[48:51], s14 offen lds
v_mfma_f32_16x16x32_bf16 v[248:251], a[20:23], a[84:87], v[248:251]
ds_read_b64_tr_b16 a[104:105], v13 offset:17152
v_add_u32 v2, 0x80, v2
v_mfma_f32_16x16x32_bf16 v[252:255], a[24:27], a[84:87], v[252:255]
ds_read_b64_tr_b16 a[106:107], v13 offset:18176
v_add_u32 v3, 0x80, v3
v_mfma_f32_16x16x32_bf16 v[252:255], a[4:7], a[80:83], v[252:255]
ds_read_b64_tr_b16 a[108:109], v13 offset:25344
v_add_f32 v11, v11, v7
v_mfma_f32_16x16x32_bf16 v[216:219], a[8:11], a[80:83], v[216:219]
ds_read_b64_tr_b16 a[110:111], v13 offset:26368
v_add_u32 v12, 0x8000, v12
v_mfma_f32_16x16x32_bf16 v[216:219], a[28:31], a[84:87], v[216:219]
v_add_u32 v13, 0x8000, v13
v_mov_b32 v4, v10
v_mfma_f32_16x16x32_bf16 v[220:223], a[32:35], a[84:87], v[220:223]
v_mov_b32 v7, v11
v_mfma_f32_16x16x32_bf16 v[220:223], a[12:15], a[80:83], v[220:223]
v_permlane32_swap_b32 v4, v10
v_permlane32_swap_b32 v7, v11
v_mfma_f32_16x16x32_bf16 v[236:239], a[12:15], a[88:91], v[236:239]
s_waitcnt vmcnt(26) lgkmcnt(0)
v_add_f32 v10, v10, v4
v_add_f32 v11, v11, v7
v_mfma_f32_16x16x32_bf16 v[236:239], a[32:35], a[92:95], v[236:239]
s_barrier
s_add_u32 m0, s17, 0x8000
v_mul_f32 v10, 0xbfb8aa3b, v10
v_mfma_f32_16x16x32_bf16 v[232:235], a[28:31], a[92:95], v[232:235]
buffer_load_dwordx4 v5, s[56:59], 0 offen lds
v_mfma_f32_16x16x32_bf16 v[232:235], a[8:11], a[88:91], v[232:235]
ds_read_b64_tr_b16 a[80:81], v12 offset:0
v_mul_f32 v11, 0xbfb8aa3b, v11
v_mfma_f32_16x16x32_bf16 v[228:231], a[4:7], a[88:91], v[228:231]
ds_read_b64_tr_b16 a[82:83], v12 offset:1024
v_mfma_f32_16x16x32_bf16 v[228:231], a[24:27], a[92:95], v[228:231]
ds_read_b64_tr_b16 a[84:85], v12 offset:8192
v_mfma_f32_16x16x32_bf16 v[224:227], a[20:23], a[92:95], v[224:227]
ds_read_b64_tr_b16 a[86:87], v12 offset:9216
v_mfma_f32_16x16x32_bf16 v[224:227], a[0:3], a[88:91], v[224:227]
s_waitcnt lgkmcnt(4)
v_exp_f32 v10, v10
v_mfma_f32_16x16x32_bf16 v[240:243], a[0:3], a[96:99], v[240:243]
ds_read_b64_tr_b16 a[88:89], v13 offset:0
s_add_u32 m0, s17, 0xc000
v_mfma_f32_16x16x32_bf16 v[240:243], a[20:23], a[100:103], v[240:243]
buffer_load_dwordx4 v5, s[60:63], 0 offen lds
v_mfma_f32_16x16x32_bf16 v[244:247], a[24:27], a[100:103], v[244:247]
ds_read_b64_tr_b16 a[90:91], v13 offset:1024
v_mfma_f32_16x16x32_bf16 v[244:247], a[4:7], a[96:99], v[244:247]
ds_read_b64_tr_b16 a[92:93], v13 offset:8192
v_mfma_f32_16x16x32_bf16 a[232:235], a[8:11], a[96:99], a[232:235]
ds_read_b64_tr_b16 a[94:95], v13 offset:9216
v_mfma_f32_16x16x32_bf16 a[232:235], a[28:31], a[100:103], a[232:235]
v_exp_f32 v11, v11
v_mfma_f32_16x16x32_bf16 a[236:239], a[32:35], a[100:103], a[236:239]
v_add_f32 v10, 1.0, v10
v_add_f32 v11, 1.0, v11
v_mfma_f32_16x16x32_bf16 a[236:239], a[12:15], a[96:99], a[236:239]
s_add_u32 m0, s17, 0x8400
v_rcp_f32 v10, v10
v_mfma_f32_16x16x32_bf16 a[252:255], a[12:15], a[104:107], a[252:255]
buffer_load_dwordx4 v5, s[56:59], s13 offen lds
v_mfma_f32_16x16x32_bf16 a[252:255], a[32:35], a[108:111], a[252:255]
ds_read_b64_tr_b16 a[96:97], v12 offset:256
v_mfma_f32_16x16x32_bf16 a[248:251], a[28:31], a[108:111], a[248:251]
ds_read_b64_tr_b16 a[98:99], v12 offset:1280
v_mfma_f32_16x16x32_bf16 a[248:251], a[8:11], a[104:107], a[248:251]
ds_read_b64_tr_b16 a[100:101], v12 offset:8448
v_mfma_f32_16x16x32_bf16 a[244:247], a[4:7], a[104:107], a[244:247]
ds_read_b64_tr_b16 a[102:103], v12 offset:9472
v_mfma_f32_16x16x32_bf16 a[244:247], a[24:27], a[108:111], a[244:247]
v_rcp_f32 v11, v11
v_mfma_f32_16x16x32_bf16 a[240:243], a[20:23], a[108:111], a[240:243]
s_add_u32 m0, s17, 0xc400
s_waitcnt lgkmcnt(4)
v_mfma_f32_16x16x32_bf16 a[240:243], a[0:3], a[104:107], a[240:243]
buffer_load_dwordx4 v5, s[60:63], s13 offen lds
L_S5:
v_mfma_f32_16x16x32_bf16 v[24:27], a[80:83], a[40:43], v[24:27]
ds_read_b64_tr_b16 a[104:105], v13 offset:256
s_waitcnt vmcnt(21)
v_mfma_f32_16x16x32_bf16 v[24:27], a[84:87], a[60:63], v[24:27]
ds_read_b64_tr_b16 a[106:107], v13 offset:1280
v_mfma_f32_16x16x32_bf16 v[32:35], a[84:87], a[64:67], v[32:35]
ds_read_b64_tr_b16 a[108:109], v13 offset:8448
v_mfma_f32_16x16x32_bf16 v[32:35], a[80:83], a[44:47], v[32:35]
ds_read_b64_tr_b16 a[110:111], v13 offset:9472
v_mfma_f32_16x16x32_bf16 v[40:43], a[80:83], a[48:51], v[40:43]
ds_read_b128 a[0:3], v8 offset:0
v_mfma_f32_16x16x32_bf16 v[40:43], a[84:87], a[68:71], v[40:43]
ds_read_b128 a[20:23], v9 offset:0
s_mov_b32 s9, 0x200000
v_mfma_f32_16x16x32_bf16 v[48:51], a[84:87], a[72:75], v[48:51]
buffer_load_dword a120, v19, s[68:71], s9 offen
v_mfma_f32_16x16x32_bf16 v[48:51], a[80:83], a[52:55], v[48:51]
ds_read_b128 a[4:7], v8 offset:2048
v_mfma_f32_16x16x32_bf16 v[52:55], a[88:91], a[52:55], v[52:55]
ds_read_b64_tr_b16 a[80:81], v12 offset:512
v_mfma_f32_16x16x32_bf16 v[52:55], a[92:95], a[72:75], v[52:55]
ds_read_b64_tr_b16 a[82:83], v12 offset:1536
v_mfma_f32_16x16x32_bf16 v[44:47], a[92:95], a[68:71], v[44:47]
ds_read_b64_tr_b16 a[84:85], v12 offset:8704
v_mfma_f32_16x16x32_bf16 v[44:47], a[88:91], a[48:51], v[44:47]
ds_read_b64_tr_b16 a[86:87], v12 offset:9728
v_mfma_f32_16x16x32_bf16 v[36:39], a[88:91], a[44:47], v[36:39]
ds_read_b128 a[24:27], v9 offset:2048
s_add_u32 m0, s17, 0x8800
v_mfma_f32_16x16x32_bf16 v[36:39], a[92:95], a[64:67], v[36:39]
buffer_load_dwordx4 v6, s[56:59], 0 offen lds
v_mfma_f32_16x16x32_bf16 v[28:31], a[92:95], a[60:63], v[28:31]
ds_read_b128 a[8:11], v8 offset:4096
v_mfma_f32_16x16x32_bf16 v[28:31], a[88:91], a[40:43], v[28:31]
ds_read_b128 a[28:31], v9 offset:4096
s_waitcnt lgkmcnt(10)
v_mfma_f32_16x16x32_bf16 v[56:59], a[96:99], a[40:43], v[56:59]
ds_read_b64_tr_b16 a[88:89], v13 offset:512
v_mfma_f32_16x16x32_bf16 v[56:59], a[100:103], a[60:63], v[56:59]
ds_read_b64_tr_b16 a[90:91], v13 offset:1536
v_mfma_f32_16x16x32_bf16 v[64:67], a[100:103], a[64:67], v[64:67]
ds_read_b64_tr_b16 a[92:93], v13 offset:8704
v_mfma_f32_16x16x32_bf16 v[64:67], a[96:99], a[44:47], v[64:67]
ds_read_b64_tr_b16 a[94:95], v13 offset:9728
s_add_u32 m0, s17, 0xc800
v_mfma_f32_16x16x32_bf16 v[72:75], a[96:99], a[48:51], v[72:75]
buffer_load_dwordx4 v6, s[60:63], 0 offen lds
v_mfma_f32_16x16x32_bf16 v[72:75], a[100:103], a[68:71], v[72:75]
ds_read_b128 a[12:15], v8 offset:6144
v_mfma_f32_16x16x32_bf16 v[80:83], a[100:103], a[72:75], v[80:83]
ds_read_b128 a[32:35], v9 offset:6144
v_mfma_f32_16x16x32_bf16 v[80:83], a[96:99], a[52:55], v[80:83]
buffer_store_dwordx2 v[10:11], off, s[88:91], s101 sc1
v_mfma_f32_16x16x32_bf16 v[84:87], a[104:107], a[52:55], v[84:87]
ds_read_b64_tr_b16 a[96:97], v12 offset:768
v_accvgpr_read_b32 v15, a157
v_mfma_f32_16x16x32_bf16 v[84:87], a[108:111], a[72:75], v[84:87]
ds_read_b64_tr_b16 a[98:99], v12 offset:1792
v_accvgpr_read_b32 v14, a156
v_mfma_f32_16x16x32_bf16 v[76:79], a[108:111], a[68:71], v[76:79]
ds_read_b64_tr_b16 a[100:101], v12 offset:8960
s_add_u32 m0, s17, 0x8c00
v_mfma_f32_16x16x32_bf16 v[76:79], a[104:107], a[48:51], v[76:79]
buffer_load_dwordx4 v6, s[56:59], s13 offen lds
v_mfma_f32_16x16x32_bf16 v[68:71], a[104:107], a[44:47], v[68:71]
ds_read_b64_tr_b16 a[102:103], v12 offset:9984
v_accvgpr_read_b32 v7, a155
v_mfma_f32_16x16x32_bf16 v[68:71], a[108:111], a[64:67], v[68:71]
v_accvgpr_read_b32 v4, a154
v_accvgpr_read_b32 v11, a153
v_mfma_f32_16x16x32_bf16 v[60:63], a[108:111], a[60:63], v[60:63]
v_accvgpr_read_b32 v10, a152
v_mfma_f32_16x16x32_bf16 v[60:63], a[104:107], a[40:43], v[60:63]
s_waitcnt lgkmcnt(6)
v_mfma_f32_16x16x32_bf16 v[88:91], a[80:83], a[40:43], v[88:91]
ds_read_b64_tr_b16 a[104:105], v13 offset:768
v_mfma_f32_16x16x32_bf16 v[88:91], a[84:87], a[60:63], v[88:91]
ds_read_b64_tr_b16 a[106:107], v13 offset:1792
s_add_u32 m0, s17, 0xcc00
v_mfma_f32_16x16x32_bf16 v[96:99], a[84:87], a[64:67], v[96:99]
buffer_load_dwordx4 v6, s[60:63], s13 offen lds
v_mfma_f32_16x16x32_bf16 v[96:99], a[80:83], a[44:47], v[96:99]
ds_read_b64_tr_b16 a[108:109], v13 offset:8960
v_add_u32 v5, 0xffc80000, v5
v_mfma_f32_16x16x32_bf16 v[104:107], a[80:83], a[48:51], v[104:107]
ds_read_b64_tr_b16 a[110:111], v13 offset:9984
v_add_u32 v6, 0xffc80000, v6
v_mfma_f32_16x16x32_bf16 v[104:107], a[84:87], a[68:71], v[104:107]
v_mfma_f32_16x16x32_bf16 v[112:115], a[84:87], a[72:75], v[112:115]
v_mfma_f32_16x16x32_bf16 v[112:115], a[80:83], a[52:55], v[112:115]
v_mov_b32 v21, s1
v_mfma_f32_16x16x32_bf16 v[116:119], a[88:91], a[52:55], v[116:119]
ds_read_b64_tr_b16 a[80:81], v12 offset:16384
v_add_u32 v20, s0, v16
v_mfma_f32_16x16x32_bf16 v[116:119], a[92:95], a[72:75], v[116:119]
global_load_dword a120, v[20:21], off sc1
v_mfma_f32_16x16x32_bf16 v[108:111], a[92:95], a[68:71], v[108:111]
ds_read_b64_tr_b16 a[82:83], v12 offset:17408
v_mfma_f32_16x16x32_bf16 v[108:111], a[88:91], a[48:51], v[108:111]
ds_read_b64_tr_b16 a[84:85], v12 offset:24576
v_mfma_f32_16x16x32_bf16 v[100:103], a[88:91], a[44:47], v[100:103]
ds_read_b64_tr_b16 a[86:87], v12 offset:25600
v_mfma_f32_16x16x32_bf16 v[100:103], a[92:95], a[64:67], v[100:103]
v_mfma_f32_16x16x32_bf16 v[92:95], a[92:95], a[60:63], v[92:95]
v_mfma_f32_16x16x32_bf16 v[92:95], a[88:91], a[40:43], v[92:95]
s_add_u32 m0, s16, 0x0
s_waitcnt lgkmcnt(12)
s_waitcnt lgkmcnt(4)
v_mfma_f32_16x16x32_bf16 v[120:123], a[96:99], a[40:43], v[120:123]
buffer_load_dwordx4 v22, s[44:47], s20 offen lds
v_mfma_f32_16x16x32_bf16 v[120:123], a[100:103], a[60:63], v[120:123]
ds_read_b64_tr_b16 a[88:89], v13 offset:16384
v_mfma_f32_16x16x32_bf16 v[128:131], a[100:103], a[64:67], v[128:131]
ds_read_b64_tr_b16 a[90:91], v13 offset:17408
v_mfma_f32_16x16x32_bf16 v[128:131], a[96:99], a[44:47], v[128:131]
ds_read_b64_tr_b16 a[92:93], v13 offset:24576
v_mfma_f32_16x16x32_bf16 v[136:139], a[96:99], a[48:51], v[136:139]
ds_read_b64_tr_b16 a[94:95], v13 offset:25600
v_mfma_f32_16x16x32_bf16 v[136:139], a[100:103], a[68:71], v[136:139]
v_mfma_f32_16x16x32_bf16 v[144:147], a[100:103], a[72:75], v[144:147]
s_add_u32 m0, s16, 0x400
v_mfma_f32_16x16x32_bf16 v[144:147], a[96:99], a[52:55], v[144:147]
buffer_load_dwordx4 v23, s[44:47], s20 offen lds
v_mfma_f32_16x16x32_bf16 v[148:151], a[104:107], a[52:55], v[148:151]
ds_read_b64_tr_b16 a[96:97], v12 offset:16640
v_mfma_f32_16x16x32_bf16 v[148:151], a[108:111], a[72:75], v[148:151]
ds_read_b64_tr_b16 a[98:99], v12 offset:17664
v_mfma_f32_16x16x32_bf16 v[140:143], a[108:111], a[68:71], v[140:143]
ds_read_b64_tr_b16 a[100:101], v12 offset:24832
v_mfma_f32_16x16x32_bf16 v[140:143], a[104:107], a[48:51], v[140:143]
ds_read_b64_tr_b16 a[102:103], v12 offset:25856
v_mfma_f32_16x16x32_bf16 v[132:135], a[104:107], a[44:47], v[132:135]
v_mfma_f32_16x16x32_bf16 v[132:135], a[108:111], a[64:67], v[132:135]
s_add_u32 m0, s16, 0x800
v_mfma_f32_16x16x32_bf16 v[124:127], a[108:111], a[60:63], v[124:127]
buffer_load_dwordx4 v22, s[44:47], s21 offen lds
v_mfma_f32_16x16x32_bf16 v[124:127], a[104:107], a[40:43], v[124:127]
s_waitcnt lgkmcnt(4)
v_mfma_f32_16x16x32_bf16 v[152:155], a[40:43], a[80:83], v[152:155]
ds_read_b64_tr_b16 a[104:105], v13 offset:16640
v_mfma_f32_16x16x32_bf16 v[152:155], a[60:63], a[84:87], v[152:155]
ds_read_b64_tr_b16 a[106:107], v13 offset:17664
v_mfma_f32_16x16x32_bf16 v[156:159], a[64:67], a[84:87], v[156:159]
ds_read_b64_tr_b16 a[108:109], v13 offset:24832
v_mfma_f32_16x16x32_bf16 v[156:159], a[44:47], a[80:83], v[156:159]
ds_read_b64_tr_b16 a[110:111], v13 offset:25856
v_mfma_f32_16x16x32_bf16 v[160:163], a[48:51], a[80:83], v[160:163]
s_add_u32 m0, s16, 0xc00
v_mfma_f32_16x16x32_bf16 v[160:163], a[68:71], a[84:87], v[160:163]
buffer_load_dwordx4 v23, s[44:47], s21 offen lds
v_mfma_f32_16x16x32_bf16 v[164:167], a[72:75], a[84:87], v[164:167]
v_mfma_f32_16x16x32_bf16 v[164:167], a[52:55], a[80:83], v[164:167]
v_mfma_f32_16x16x32_bf16 v[180:183], a[52:55], a[88:91], v[180:183]
ds_read_b64_tr_b16 a[80:81], v12 offset:16896
v_mfma_f32_16x16x32_bf16 v[180:183], a[72:75], a[92:95], v[180:183]
ds_read_b64_tr_b16 a[82:83], v12 offset:17920
v_mfma_f32_16x16x32_bf16 v[176:179], a[68:71], a[92:95], v[176:179]
ds_read_b64_tr_b16 a[84:85], v12 offset:25088
v_mfma_f32_16x16x32_bf16 v[176:179], a[48:51], a[88:91], v[176:179]
ds_read_b64_tr_b16 a[86:87], v12 offset:26112
s_add_u32 m0, s16, 0x1000
v_mfma_f32_16x16x32_bf16 v[172:175], a[44:47], a[88:91], v[172:175]
buffer_load_dwordx4 v22, s[44:47], s22 offen lds
v_mfma_f32_16x16x32_bf16 v[172:175], a[64:67], a[92:95], v[172:175]
v_mfma_f32_16x16x32_bf16 v[168:171], a[60:63], a[92:95], v[168:171]
v_mfma_f32_16x16x32_bf16 v[168:171], a[40:43], a[88:91], v[168:171]
s_waitcnt lgkmcnt(4)
v_mfma_f32_16x16x32_bf16 v[184:187], a[40:43], a[96:99], v[184:187]
ds_read_b64_tr_b16 a[88:89], v13 offset:16896
v_mfma_f32_16x16x32_bf16 v[184:187], a[60:63], a[100:103], v[184:187]
ds_read_b64_tr_b16 a[90:91], v13 offset:17920
v_mfma_f32_16x16x32_bf16 v[188:191], a[64:67], a[100:103], v[188:191]
ds_read_b64_tr_b16 a[92:93], v13 offset:25088
s_add_u32 m0, s16, 0x1400
v_mfma_f32_16x16x32_bf16 v[188:191], a[44:47], a[96:99], v[188:191]
buffer_load_dwordx4 v23, s[44:47], s22 offen lds
v_mfma_f32_16x16x32_bf16 v[192:195], a[48:51], a[96:99], v[192:195]
ds_read_b64_tr_b16 a[94:95], v13 offset:26112
v_mfma_f32_16x16x32_bf16 v[192:195], a[68:71], a[100:103], v[192:195]
v_mfma_f32_16x16x32_bf16 v[196:199], a[72:75], a[100:103], v[196:199]
v_mfma_f32_16x16x32_bf16 v[196:199], a[52:55], a[96:99], v[196:199]
v_mfma_f32_16x16x32_bf16 v[212:215], a[52:55], a[104:107], v[212:215]
ds_read_b64_tr_b16 a[96:97], v12 offset:17152
v_mfma_f32_16x16x32_bf16 v[212:215], a[72:75], a[108:111], v[212:215]
ds_read_b64_tr_b16 a[98:99], v12 offset:18176
s_add_u32 m0, s16, 0x1800
v_mfma_f32_16x16x32_bf16 v[208:211], a[68:71], a[108:111], v[208:211]
buffer_load_dwordx4 v22, s[44:47], s23 offen lds
v_mfma_f32_16x16x32_bf16 v[208:211], a[48:51], a[104:107], v[208:211]
ds_read_b64_tr_b16 a[100:101], v12 offset:25344
v_mfma_f32_16x16x32_bf16 v[204:207], a[44:47], a[104:107], v[204:207]
ds_read_b64_tr_b16 a[102:103], v12 offset:26368
v_mfma_f32_16x16x32_bf16 v[204:207], a[64:67], a[108:111], v[204:207]
v_mfma_f32_16x16x32_bf16 v[200:203], a[60:63], a[108:111], v[200:203]
v_mfma_f32_16x16x32_bf16 v[200:203], a[40:43], a[104:107], v[200:203]
s_waitcnt lgkmcnt(4)
v_mfma_f32_16x16x32_bf16 v[248:251], a[40:43], a[80:83], v[248:251]
ds_read_b64_tr_b16 a[104:105], v13 offset:17152
s_add_u32 m0, s16, 0x1c00
v_mfma_f32_16x16x32_bf16 v[248:251], a[60:63], a[84:87], v[248:251]
buffer_load_dwordx4 v23, s[44:47], s23 offen lds
v_mfma_f32_16x16x32_bf16 v[252:255], a[64:67], a[84:87], v[252:255]
ds_read_b64_tr_b16 a[106:107], v13 offset:18176
v_add_u32 v22, 0x80, v22
v_mfma_f32_16x16x32_bf16 v[252:255], a[44:47], a[80:83], v[252:255]
ds_read_b64_tr_b16 a[108:109], v13 offset:25344
v_add_u32 v23, 0x80, v23
v_mfma_f32_16x16x32_bf16 v[216:219], a[48:51], a[80:83], v[216:219]
ds_read_b64_tr_b16 a[110:111], v13 offset:26368
v_add_u32 v12, 0xffff0000, v12
v_mfma_f32_16x16x32_bf16 v[216:219], a[68:71], a[84:87], v[216:219]
v_add_u32 v13, 0xffff0000, v13
v_mfma_f32_16x16x32_bf16 v[220:223], a[72:75], a[84:87], v[220:223]
v_mfma_f32_16x16x32_bf16 v[220:223], a[52:55], a[80:83], v[220:223]
v_mfma_f32_16x16x32_bf16 v[236:239], a[52:55], a[88:91], v[236:239]
s_waitcnt vmcnt(28) lgkmcnt(0)
v_mfma_f32_16x16x32_bf16 v[236:239], a[72:75], a[92:95], v[236:239]
s_barrier
s_add_u32 m0, s17, 0x10000
v_mfma_f32_16x16x32_bf16 v[232:235], a[68:71], a[92:95], v[232:235]
buffer_load_dwordx4 v5, s[52:55], 0 offen lds
v_mfma_f32_16x16x32_bf16 v[232:235], a[48:51], a[88:91], v[232:235]
ds_read_b64_tr_b16 a[80:81], v12 offset:0
s_mul_i32 s28, s5, 0x108000
v_mfma_f32_16x16x32_bf16 v[228:231], a[44:47], a[88:91], v[228:231]
ds_read_b64_tr_b16 a[82:83], v12 offset:1024
s_mov_b32 s48, s88
v_mfma_f32_16x16x32_bf16 v[228:231], a[64:67], a[92:95], v[228:231]
ds_read_b64_tr_b16 a[84:85], v12 offset:8192
s_mov_b32 s49, s89
v_mfma_f32_16x16x32_bf16 v[224:227], a[60:63], a[92:95], v[224:227]
ds_read_b64_tr_b16 a[86:87], v12 offset:9216
s_sub_u32 s11, 16, s6
v_mfma_f32_16x16x32_bf16 v[224:227], a[40:43], a[88:91], v[224:227]
s_waitcnt lgkmcnt(4)
s_lshl_b32 s11, s11, 16
s_add_u32 s11, s11, s28
v_mfma_f32_16x16x32_bf16 v[240:243], a[40:43], a[96:99], v[240:243]
ds_read_b64_tr_b16 a[88:89], v13 offset:0
s_add_u32 m0, s17, 0x10400
v_mfma_f32_16x16x32_bf16 v[240:243], a[60:63], a[100:103], v[240:243]
buffer_load_dwordx4 v5, s[52:55], s13 offen lds
v_mfma_f32_16x16x32_bf16 v[244:247], a[64:67], a[100:103], v[244:247]
ds_read_b64_tr_b16 a[90:91], v13 offset:1024
s_add_u32 s50, s11, 0x2000
v_mfma_f32_16x16x32_bf16 v[244:247], a[44:47], a[96:99], v[244:247]
ds_read_b64_tr_b16 a[92:93], v13 offset:8192
s_lshl_b32 s11, s6, 17
v_mfma_f32_16x16x32_bf16 a[232:235], a[48:51], a[96:99], a[232:235]
ds_read_b64_tr_b16 a[94:95], v13 offset:9216
s_add_u32 s28, s28, s11
v_mfma_f32_16x16x32_bf16 a[232:235], a[68:71], a[100:103], a[232:235]
s_lshl_b32 s11, s4, 15
s_add_u32 s28, s28, s11
s_lshl_b32 s10, s5, 2
v_mfma_f32_16x16x32_bf16 a[236:239], a[72:75], a[100:103], a[236:239]
s_add_u32 s10, s10, 64
v_mfma_f32_16x16x32_bf16 a[236:239], a[52:55], a[96:99], a[236:239]
s_add_u32 m0, s17, 0x10800
v_mfma_f32_16x16x32_bf16 a[252:255], a[52:55], a[104:107], a[252:255]
buffer_load_dwordx4 v6, s[52:55], 0 offen lds
v_mfma_f32_16x16x32_bf16 a[252:255], a[72:75], a[108:111], a[252:255]
ds_read_b64_tr_b16 a[96:97], v12 offset:256
v_mfma_f32_16x16x32_bf16 a[248:251], a[68:71], a[108:111], a[248:251]
ds_read_b64_tr_b16 a[98:99], v12 offset:1280
v_mfma_f32_16x16x32_bf16 a[248:251], a[48:51], a[104:107], a[248:251]
ds_read_b64_tr_b16 a[100:101], v12 offset:8448
v_mfma_f32_16x16x32_bf16 a[244:247], a[44:47], a[104:107], a[244:247]
ds_read_b64_tr_b16 a[102:103], v12 offset:9472
v_mfma_f32_16x16x32_bf16 a[244:247], a[64:67], a[108:111], a[244:247]
v_mfma_f32_16x16x32_bf16 a[240:243], a[60:63], a[108:111], a[240:243]
v_mfma_f32_16x16x32_bf16 a[240:243], a[40:43], a[104:107], a[240:243]
s_add_u32 m0, s17, 0x10c00
s_waitcnt lgkmcnt(4)
L_S6:
v_mfma_f32_16x16x32_bf16 v[24:27], a[80:83], a[0:3], v[24:27]
buffer_load_dwordx4 v6, s[52:55], s13 offen lds
v_mfma_f32_16x16x32_bf16 v[24:27], a[84:87], a[20:23], v[24:27]
ds_read_b64_tr_b16 a[104:105], v13 offset:256
s_waitcnt vmcnt(23)
v_mfma_f32_16x16x32_bf16 v[32:35], a[84:87], a[24:27], v[32:35]
ds_read_b64_tr_b16 a[106:107], v13 offset:1280
v_mfma_f32_16x16x32_bf16 v[32:35], a[80:83], a[4:7], v[32:35]
ds_read_b64_tr_b16 a[108:109], v13 offset:8448
v_mfma_f32_16x16x32_bf16 v[40:43], a[80:83], a[8:11], v[40:43]
ds_read_b64_tr_b16 a[110:111], v13 offset:9472
v_mfma_f32_16x16x32_bf16 v[40:43], a[84:87], a[28:31], v[40:43]
ds_read_b128 a[40:43], v8 offset:32768
v_mfma_f32_16x16x32_bf16 v[48:51], a[84:87], a[32:35], v[48:51]
ds_read_b128 a[60:63], v9 offset:32768
s_add_u32 m0, s18, 0x14000
v_mfma_f32_16x16x32_bf16 v[48:51], a[80:83], a[12:15], v[48:51]
buffer_load_dwordx4 v7, s[68:71], 0 offen lds
v_mfma_f32_16x16x32_bf16 v[52:55], a[88:91], a[12:15], v[52:55]
ds_read_b64_tr_b16 a[80:81], v12 offset:512
v_mfma_f32_16x16x32_bf16 v[52:55], a[92:95], a[32:35], v[52:55]
ds_read_b64_tr_b16 a[82:83], v12 offset:1536
v_mfma_f32_16x16x32_bf16 v[44:47], a[92:95], a[28:31], v[44:47]
ds_read_b64_tr_b16 a[84:85], v12 offset:8704
v_mfma_f32_16x16x32_bf16 v[44:47], a[88:91], a[8:11], v[44:47]
ds_read_b64_tr_b16 a[86:87], v12 offset:9728
v_mfma_f32_16x16x32_bf16 v[36:39], a[88:91], a[4:7], v[36:39]
ds_read_b128 a[44:47], v8 offset:34816
v_mfma_f32_16x16x32_bf16 v[36:39], a[92:95], a[24:27], v[36:39]
ds_read_b128 a[64:67], v9 offset:34816
s_waitcnt lgkmcnt(8)
v_mfma_f32_16x16x32_bf16 v[28:31], a[92:95], a[20:23], v[28:31]
ds_read_b128 a[48:51], v8 offset:36864
s_add_u32 m0, s18, 0x15000
v_mfma_f32_16x16x32_bf16 v[28:31], a[88:91], a[0:3], v[28:31]
buffer_load_dwordx4 v7, s[68:71], s25 offen lds
v_mfma_f32_16x16x32_bf16 v[56:59], a[96:99], a[0:3], v[56:59]
ds_read_b64_tr_b16 a[88:89], v13 offset:512
v_mfma_f32_16x16x32_bf16 v[56:59], a[100:103], a[20:23], v[56:59]
ds_read_b64_tr_b16 a[90:91], v13 offset:1536
v_mfma_f32_16x16x32_bf16 v[64:67], a[100:103], a[24:27], v[64:67]
ds_read_b64_tr_b16 a[92:93], v13 offset:8704
v_mfma_f32_16x16x32_bf16 v[64:67], a[96:99], a[4:7], v[64:67]
ds_read_b64_tr_b16 a[94:95], v13 offset:9728
v_mfma_f32_16x16x32_bf16 v[72:75], a[96:99], a[8:11], v[72:75]
ds_read_b128 a[68:71], v9 offset:36864
v_mfma_f32_16x16x32_bf16 v[72:75], a[100:103], a[28:31], v[72:75]
ds_read_b128 a[52:55], v8 offset:38912
s_add_u32 m0, s18, 0x16000
v_mfma_f32_16x16x32_bf16 v[80:83], a[100:103], a[32:35], v[80:83]
buffer_load_dwordx4 v7, s[68:71], s26 offen lds
v_mfma_f32_16x16x32_bf16 v[80:83], a[96:99], a[12:15], v[80:83]
ds_read_b128 a[72:75], v9 offset:38912
v_mfma_f32_16x16x32_bf16 v[84:87], a[104:107], a[12:15], v[84:87]
ds_read_b64_tr_b16 a[96:97], v12 offset:768
v_mfma_f32_16x16x32_bf16 v[84:87], a[108:111], a[32:35], v[84:87]
ds_read_b64_tr_b16 a[98:99], v12 offset:1792
v_mfma_f32_16x16x32_bf16 v[76:79], a[108:111], a[28:31], v[76:79]
ds_read_b64_tr_b16 a[100:101], v12 offset:8960
v_mfma_f32_16x16x32_bf16 v[76:79], a[104:107], a[8:11], v[76:79]
ds_read_b64_tr_b16 a[102:103], v12 offset:9984
v_mfma_f32_16x16x32_bf16 v[68:71], a[104:107], a[4:7], v[68:71]
s_add_u32 m0, s18, 0x17000
v_mfma_f32_16x16x32_bf16 v[68:71], a[108:111], a[24:27], v[68:71]
buffer_load_dwordx4 v4, s[44:47], s24 offen lds
v_mfma_f32_16x16x32_bf16 v[60:63], a[108:111], a[20:23], v[60:63]
v_add_u32 v5, 0x80000, v5
v_add_u32 v6, 0x80000, v6
v_mfma_f32_16x16x32_bf16 v[60:63], a[104:107], a[0:3], v[60:63]
s_waitcnt lgkmcnt(7)
v_add_u32 v7, 0x60000, v7
v_add_u32 v4, 0x80, v4
v_mfma_f32_16x16x32_bf16 v[88:91], a[80:83], a[0:3], v[88:91]
ds_read_b64_tr_b16 a[104:105], v13 offset:768
v_mfma_f32_16x16x32_bf16 v[88:91], a[84:87], a[20:23], v[88:91]
ds_read_b64_tr_b16 a[106:107], v13 offset:1792
v_mfma_f32_16x16x32_bf16 v[96:99], a[84:87], a[24:27], v[96:99]
ds_read_b64_tr_b16 a[108:109], v13 offset:8960
v_mfma_f32_16x16x32_bf16 v[96:99], a[80:83], a[4:7], v[96:99]
ds_read_b64_tr_b16 a[110:111], v13 offset:9984
v_mfma_f32_16x16x32_bf16 v[104:107], a[80:83], a[8:11], v[104:107]
s_mov_b32 s9, 0x400000
v_mfma_f32_16x16x32_bf16 v[104:107], a[84:87], a[28:31], v[104:107]
buffer_load_dword a120, v19, s[52:55], s9 offen
v_mfma_f32_16x16x32_bf16 v[112:115], a[84:87], a[32:35], v[112:115]
v_mfma_f32_16x16x32_bf16 v[112:115], a[80:83], a[12:15], v[112:115]
v_mfma_f32_16x16x32_bf16 v[116:119], a[88:91], a[12:15], v[116:119]
ds_read_b64_tr_b16 a[80:81], v12 offset:16384
v_mfma_f32_16x16x32_bf16 v[116:119], a[92:95], a[32:35], v[116:119]
ds_read_b64_tr_b16 a[82:83], v12 offset:17408
v_mfma_f32_16x16x32_bf16 v[108:111], a[92:95], a[28:31], v[108:111]
ds_read_b64_tr_b16 a[84:85], v12 offset:24576
s_waitcnt lgkmcnt(11)
v_mfma_f32_16x16x32_bf16 v[108:111], a[88:91], a[8:11], v[108:111]
ds_read_b64_tr_b16 a[86:87], v12 offset:25600
s_add_u32 m0, s16, 0x8000
v_mfma_f32_16x16x32_bf16 v[100:103], a[88:91], a[4:7], v[100:103]
buffer_load_dwordx4 v22, s[44:47], s20 offen lds
v_mfma_f32_16x16x32_bf16 v[100:103], a[92:95], a[24:27], v[100:103]
v_mfma_f32_16x16x32_bf16 v[92:95], a[92:95], a[20:23], v[92:95]
v_mfma_f32_16x16x32_bf16 v[92:95], a[88:91], a[0:3], v[92:95]
s_waitcnt lgkmcnt(4)
v_mfma_f32_16x16x32_bf16 v[120:123], a[96:99], a[0:3], v[120:123]
ds_read_b64_tr_b16 a[88:89], v13 offset:16384
v_mfma_f32_16x16x32_bf16 v[120:123], a[100:103], a[20:23], v[120:123]
ds_read_b64_tr_b16 a[90:91], v13 offset:17408
v_mfma_f32_16x16x32_bf16 v[128:131], a[100:103], a[24:27], v[128:131]
ds_read_b64_tr_b16 a[92:93], v13 offset:24576
v_mfma_f32_16x16x32_bf16 v[128:131], a[96:99], a[4:7], v[128:131]
ds_read_b64_tr_b16 a[94:95], v13 offset:25600
s_add_u32 m0, s16, 0x8400
v_mfma_f32_16x16x32_bf16 v[136:139], a[96:99], a[8:11], v[136:139]
buffer_load_dwordx4 v23, s[44:47], s20 offen lds
v_mfma_f32_16x16x32_bf16 v[136:139], a[100:103], a[28:31], v[136:139]
v_mfma_f32_16x16x32_bf16 v[144:147], a[100:103], a[32:35], v[144:147]
v_mfma_f32_16x16x32_bf16 v[144:147], a[96:99], a[12:15], v[144:147]
v_mfma_f32_16x16x32_bf16 v[148:151], a[104:107], a[12:15], v[148:151]
ds_read_b64_tr_b16 a[96:97], v12 offset:16640
v_mfma_f32_16x16x32_bf16 v[148:151], a[108:111], a[32:35], v[148:151]
ds_read_b64_tr_b16 a[98:99], v12 offset:17664
v_mfma_f32_16x16x32_bf16 v[140:143], a[108:111], a[28:31], v[140:143]
ds_read_b64_tr_b16 a[100:101], v12 offset:24832
s_add_u32 m0, s16, 0x8800
v_mfma_f32_16x16x32_bf16 v[140:143], a[104:107], a[8:11], v[140:143]
buffer_load_dwordx4 v22, s[44:47], s21 offen lds
v_mfma_f32_16x16x32_bf16 v[132:135], a[104:107], a[4:7], v[132:135]
ds_read_b64_tr_b16 a[102:103], v12 offset:25856
v_mfma_f32_16x16x32_bf16 v[132:135], a[108:111], a[24:27], v[132:135]
v_mfma_f32_16x16x32_bf16 v[124:127], a[108:111], a[20:23], v[124:127]
v_mfma_f32_16x16x32_bf16 v[124:127], a[104:107], a[0:3], v[124:127]
s_waitcnt lgkmcnt(4)
v_mfma_f32_16x16x32_bf16 v[152:155], a[0:3], a[80:83], v[152:155]
ds_read_b64_tr_b16 a[104:105], v13 offset:16640
v_mfma_f32_16x16x32_bf16 v[152:155], a[20:23], a[84:87], v[152:155]
ds_read_b64_tr_b16 a[106:107], v13 offset:17664
s_add_u32 m0, s16, 0x8c00
v_mfma_f32_16x16x32_bf16 v[156:159], a[24:27], a[84:87], v[156:159]
buffer_load_dwordx4 v23, s[44:47], s21 offen lds
v_mfma_f32_16x16x32_bf16 v[156:159], a[4:7], a[80:83], v[156:159]
ds_read_b64_tr_b16 a[108:109], v13 offset:24832
v_mfma_f32_16x16x32_bf16 v[160:163], a[8:11], a[80:83], v[160:163]
ds_read_b64_tr_b16 a[110:111], v13 offset:25856
v_mfma_f32_16x16x32_bf16 v[160:163], a[28:31], a[84:87], v[160:163]
v_mfma_f32_16x16x32_bf16 v[164:167], a[32:35], a[84:87], v[164:167]
v_mfma_f32_16x16x32_bf16 v[164:167], a[12:15], a[80:83], v[164:167]
v_mfma_f32_16x16x32_bf16 v[180:183], a[12:15], a[88:91], v[180:183]
ds_read_b64_tr_b16 a[80:81], v12 offset:16896
v_mfma_f32_16x16x32_bf16 v[180:183], a[32:35], a[92:95], v[180:183]
ds_read_b64_tr_b16 a[82:83], v12 offset:17920
s_add_u32 m0, s16, 0x9000
v_mfma_f32_16x16x32_bf16 v[176:179], a[28:31], a[92:95], v[176:179]
buffer_load_dwordx4 v22, s[44:47], s22 offen lds
v_mfma_f32_16x16x32_bf16 v[176:179], a[8:11], a[88:91], v[176:179]
ds_read_b64_tr_b16 a[84:85], v12 offset:25088
v_mfma_f32_16x16x32_bf16 v[172:175], a[4:7], a[88:91], v[172:175]
ds_read_b64_tr_b16 a[86:87], v12 offset:26112
v_mfma_f32_16x16x32_bf16 v[172:175], a[24:27], a[92:95], v[172:175]
v_mfma_f32_16x16x32_bf16 v[168:171], a[20:23], a[92:95], v[168:171]
v_mfma_f32_16x16x32_bf16 v[168:171], a[0:3], a[88:91], v[168:171]
s_waitcnt lgkmcnt(4)
v_mfma_f32_16x16x32_bf16 v[184:187], a[0:3], a[96:99], v[184:187]
ds_read_b64_tr_b16 a[88:89], v13 offset:16896
s_add_u32 m0, s16, 0x9400
v_mfma_f32_16x16x32_bf16 v[184:187], a[20:23], a[100:103], v[184:187]
buffer_load_dwordx4 v23, s[44:47], s22 offen lds
v_mfma_f32_16x16x32_bf16 v[188:191], a[24:27], a[100:103], v[188:191]
ds_read_b64_tr_b16 a[90:91], v13 offset:17920
v_mfma_f32_16x16x32_bf16 v[188:191], a[4:7], a[96:99], v[188:191]
ds_read_b64_tr_b16 a[92:93], v13 offset:25088
v_mfma_f32_16x16x32_bf16 v[192:195], a[8:11], a[96:99], v[192:195]
ds_read_b64_tr_b16 a[94:95], v13 offset:26112
v_mfma_f32_16x16x32_bf16 v[192:195], a[28:31], a[100:103], v[192:195]
v_mfma_f32_16x16x32_bf16 v[196:199], a[32:35], a[100:103], v[196:199]
v_mfma_f32_16x16x32_bf16 v[196:199], a[12:15], a[96:99], v[196:199]
v_mfma_f32_16x16x32_bf16 v[212:215], a[12:15], a[104:107], v[212:215]
ds_read_b64_tr_b16 a[96:97], v12 offset:17152
s_add_u32 m0, s16, 0x9800
v_mfma_f32_16x16x32_bf16 v[212:215], a[32:35], a[108:111], v[212:215]
buffer_load_dwordx4 v22, s[44:47], s23 offen lds
v_mfma_f32_16x16x32_bf16 v[208:211], a[28:31], a[108:111], v[208:211]
ds_read_b64_tr_b16 a[98:99], v12 offset:18176
v_mfma_f32_16x16x32_bf16 v[208:211], a[8:11], a[104:107], v[208:211]
ds_read_b64_tr_b16 a[100:101], v12 offset:25344
v_mfma_f32_16x16x32_bf16 v[204:207], a[4:7], a[104:107], v[204:207]
ds_read_b64_tr_b16 a[102:103], v12 offset:26368
v_mfma_f32_16x16x32_bf16 v[204:207], a[24:27], a[108:111], v[204:207]
v_mfma_f32_16x16x32_bf16 v[200:203], a[20:23], a[108:111], v[200:203]
v_mfma_f32_16x16x32_bf16 v[200:203], a[0:3], a[104:107], v[200:203]
s_add_u32 m0, s16, 0x9c00
s_waitcnt lgkmcnt(4)
v_mfma_f32_16x16x32_bf16 v[248:251], a[0:3], a[80:83], v[248:251]
buffer_load_dwordx4 v23, s[44:47], s23 offen lds
v_mfma_f32_16x16x32_bf16 v[248:251], a[20:23], a[84:87], v[248:251]
ds_read_b64_tr_b16 a[104:105], v13 offset:17152
v_add_u32 v22, 0x80, v22
v_mfma_f32_16x16x32_bf16 v[252:255], a[24:27], a[84:87], v[252:255]
ds_read_b64_tr_b16 a[106:107], v13 offset:18176
v_add_u32 v23, 0x80, v23
v_mfma_f32_16x16x32_bf16 v[252:255], a[4:7], a[80:83], v[252:255]
ds_read_b64_tr_b16 a[108:109], v13 offset:25344
v_mfma_f32_16x16x32_bf16 v[216:219], a[8:11], a[80:83], v[216:219]
ds_read_b64_tr_b16 a[110:111], v13 offset:26368
v_add_u32 v12, 0x8000, v12
v_mfma_f32_16x16x32_bf16 v[216:219], a[28:31], a[84:87], v[216:219]
v_add_u32 v13, 0x8000, v13
v_mfma_f32_16x16x32_bf16 v[220:223], a[32:35], a[84:87], v[220:223]
v_mfma_f32_16x16x32_bf16 v[220:223], a[12:15], a[80:83], v[220:223]
v_mfma_f32_16x16x32_bf16 v[236:239], a[12:15], a[88:91], v[236:239]
s_waitcnt vmcnt(26) lgkmcnt(0)
v_mfma_f32_16x16x32_bf16 v[236:239], a[32:35], a[92:95], v[236:239]
s_barrier
s_add_u32 m0, s17, 0x0
v_mfma_f32_16x16x32_bf16 v[232:235], a[28:31], a[92:95], v[232:235]
buffer_load_dwordx4 v5, s[52:55], 0 offen lds
v_mfma_f32_16x16x32_bf16 v[232:235], a[8:11], a[88:91], v[232:235]
ds_read_b64_tr_b16 a[80:81], v12 offset:0
v_mfma_f32_16x16x32_bf16 v[228:231], a[4:7], a[88:91], v[228:231]
ds_read_b64_tr_b16 a[82:83], v12 offset:1024
v_mfma_f32_16x16x32_bf16 v[228:231], a[24:27], a[92:95], v[228:231]
ds_read_b64_tr_b16 a[84:85], v12 offset:8192
v_mfma_f32_16x16x32_bf16 v[224:227], a[20:23], a[92:95], v[224:227]
ds_read_b64_tr_b16 a[86:87], v12 offset:9216
v_mfma_f32_16x16x32_bf16 v[224:227], a[0:3], a[88:91], v[224:227]
s_waitcnt lgkmcnt(4)
v_mfma_f32_16x16x32_bf16 v[240:243], a[0:3], a[96:99], v[240:243]
ds_read_b64_tr_b16 a[88:89], v13 offset:0
s_add_u32 m0, s17, 0x400
v_mfma_f32_16x16x32_bf16 v[240:243], a[20:23], a[100:103], v[240:243]
buffer_load_dwordx4 v5, s[52:55], s13 offen lds
v_mfma_f32_16x16x32_bf16 v[244:247], a[24:27], a[100:103], v[244:247]
ds_read_b64_tr_b16 a[90:91], v13 offset:1024
v_mfma_f32_16x16x32_bf16 v[244:247], a[4:7], a[96:99], v[244:247]
ds_read_b64_tr_b16 a[92:93], v13 offset:8192
v_mfma_f32_16x16x32_bf16 a[232:235], a[8:11], a[96:99], a[232:235]
ds_read_b64_tr_b16 a[94:95], v13 offset:9216
v_mfma_f32_16x16x32_bf16 a[232:235], a[28:31], a[100:103], a[232:235]
v_mfma_f32_16x16x32_bf16 a[236:239], a[32:35], a[100:103], a[236:239]
v_mfma_f32_16x16x32_bf16 a[236:239], a[12:15], a[96:99], a[236:239]
s_add_u32 m0, s17, 0x800
v_mfma_f32_16x16x32_bf16 a[252:255], a[12:15], a[104:107], a[252:255]
buffer_load_dwordx4 v6, s[52:55], 0 offen lds
v_mfma_f32_16x16x32_bf16 a[252:255], a[32:35], a[108:111], a[252:255]
ds_read_b64_tr_b16 a[96:97], v12 offset:256
v_mfma_f32_16x16x32_bf16 a[248:251], a[28:31], a[108:111], a[248:251]
ds_read_b64_tr_b16 a[98:99], v12 offset:1280
v_mfma_f32_16x16x32_bf16 a[248:251], a[8:11], a[104:107], a[248:251]
ds_read_b64_tr_b16 a[100:101], v12 offset:8448
v_mfma_f32_16x16x32_bf16 a[244:247], a[4:7], a[104:107], a[244:247]
ds_read_b64_tr_b16 a[102:103], v12 offset:9472
v_mfma_f32_16x16x32_bf16 a[244:247], a[24:27], a[108:111], a[244:247]
v_mfma_f32_16x16x32_bf16 a[240:243], a[20:23], a[108:111], a[240:243]
s_add_u32 m0, s17, 0xc00
s_waitcnt lgkmcnt(4)
v_mfma_f32_16x16x32_bf16 a[240:243], a[0:3], a[104:107], a[240:243]
buffer_load_dwordx4 v6, s[52:55], s13 offen lds
L_S7:
v_mfma_f32_16x16x32_bf16 v[24:27], a[80:83], a[40:43], v[24:27]
ds_read_b64_tr_b16 a[104:105], v13 offset:256
s_waitcnt vmcnt(21)
v_mfma_f32_16x16x32_bf16 v[24:27], a[84:87], a[60:63], v[24:27]
ds_read_b64_tr_b16 a[106:107], v13 offset:1280
v_mfma_f32_16x16x32_bf16 v[32:35], a[84:87], a[64:67], v[32:35]
ds_read_b64_tr_b16 a[108:109], v13 offset:8448
v_mfma_f32_16x16x32_bf16 v[32:35], a[80:83], a[44:47], v[32:35]
ds_read_b64_tr_b16 a[110:111], v13 offset:9472
v_mfma_f32_16x16x32_bf16 v[40:43], a[80:83], a[48:51], v[40:43]
ds_read_b128 a[0:3], v8 offset:0
v_mfma_f32_16x16x32_bf16 v[40:43], a[84:87], a[68:71], v[40:43]
ds_read_b128 a[20:23], v9 offset:0
s_mov_b32 s9, 0x400000
v_mfma_f32_16x16x32_bf16 v[48:51], a[84:87], a[72:75], v[48:51]
buffer_load_dword a120, v19, s[68:71], s9 offen
v_mfma_f32_16x16x32_bf16 v[48:51], a[80:83], a[52:55], v[48:51]
ds_read_b128 a[4:7], v8 offset:2048
v_mfma_f32_16x16x32_bf16 v[52:55], a[88:91], a[52:55], v[52:55]
ds_read_b64_tr_b16 a[80:81], v12 offset:512
v_mfma_f32_16x16x32_bf16 v[52:55], a[92:95], a[72:75], v[52:55]
ds_read_b64_tr_b16 a[82:83], v12 offset:1536
v_mfma_f32_16x16x32_bf16 v[44:47], a[92:95], a[68:71], v[44:47]
ds_read_b64_tr_b16 a[84:85], v12 offset:8704
v_mfma_f32_16x16x32_bf16 v[44:47], a[88:91], a[48:51], v[44:47]
ds_read_b64_tr_b16 a[86:87], v12 offset:9728
v_mfma_f32_16x16x32_bf16 v[36:39], a[88:91], a[44:47], v[36:39]
ds_read_b128 a[24:27], v9 offset:2048
s_add_u32 m0, s18, 0x4000
v_mfma_f32_16x16x32_bf16 v[36:39], a[92:95], a[64:67], v[36:39]
buffer_load_dwordx4 v7, s[68:71], 0 offen lds
v_mfma_f32_16x16x32_bf16 v[28:31], a[92:95], a[60:63], v[28:31]
ds_read_b128 a[8:11], v8 offset:4096
v_mfma_f32_16x16x32_bf16 v[28:31], a[88:91], a[40:43], v[28:31]
ds_read_b128 a[28:31], v9 offset:4096
s_waitcnt lgkmcnt(10)
v_mfma_f32_16x16x32_bf16 v[56:59], a[96:99], a[40:43], v[56:59]
ds_read_b64_tr_b16 a[88:89], v13 offset:512
v_mfma_f32_16x16x32_bf16 v[56:59], a[100:103], a[60:63], v[56:59]
ds_read_b64_tr_b16 a[90:91], v13 offset:1536
v_mfma_f32_16x16x32_bf16 v[64:67], a[100:103], a[64:67], v[64:67]
ds_read_b64_tr_b16 a[92:93], v13 offset:8704
v_mfma_f32_16x16x32_bf16 v[64:67], a[96:99], a[44:47], v[64:67]
ds_read_b64_tr_b16 a[94:95], v13 offset:9728
s_add_u32 m0, s18, 0x5000
v_cvt_pk_bf16_f32 v24, v24, v25
v_mfma_f32_16x16x32_bf16 v[72:75], a[96:99], a[48:51], v[72:75]
buffer_load_dwordx4 v7, s[68:71], s25 offen lds
v_mfma_f32_16x16x32_bf16 v[72:75], a[100:103], a[68:71], v[72:75]
ds_read_b128 a[12:15], v8 offset:6144
v_cvt_pk_bf16_f32 v25, v26, v27
v_mfma_f32_16x16x32_bf16 v[80:83], a[100:103], a[72:75], v[80:83]
ds_read_b128 a[32:35], v9 offset:6144
v_cvt_pk_bf16_f32 v26, v28, v29
v_cvt_pk_bf16_f32 v27, v30, v31
v_mfma_f32_16x16x32_bf16 v[80:83], a[96:99], a[52:55], v[80:83]
v_accvgpr_write_b32 a128, v24
v_accvgpr_write_b32 a129, v25
v_mfma_f32_16x16x32_bf16 v[84:87], a[104:107], a[52:55], v[84:87]
ds_read_b64_tr_b16 a[96:97], v12 offset:768
v_accvgpr_write_b32 a130, v26
v_mfma_f32_16x16x32_bf16 v[84:87], a[108:111], a[72:75], v[84:87]
ds_read_b64_tr_b16 a[98:99], v12 offset:1792
v_accvgpr_write_b32 a131, v27
v_cvt_pk_bf16_f32 v32, v32, v33
v_mfma_f32_16x16x32_bf16 v[76:79], a[108:111], a[68:71], v[76:79]
ds_read_b64_tr_b16 a[100:101], v12 offset:8960
s_add_u32 m0, s18, 0x6000
v_mfma_f32_16x16x32_bf16 v[76:79], a[104:107], a[48:51], v[76:79]
buffer_load_dwordx4 v7, s[68:71], s26 offen lds
v_mfma_f32_16x16x32_bf16 v[68:71], a[104:107], a[44:47], v[68:71]
ds_read_b64_tr_b16 a[102:103], v12 offset:9984
v_cvt_pk_bf16_f32 v33, v34, v35
v_cvt_pk_bf16_f32 v34, v36, v37
v_mfma_f32_16x16x32_bf16 v[68:71], a[108:111], a[64:67], v[68:71]
v_cvt_pk_bf16_f32 v35, v38, v39
v_accvgpr_write_b32 a132, v32
v_mfma_f32_16x16x32_bf16 v[60:63], a[108:111], a[60:63], v[60:63]
v_accvgpr_write_b32 a133, v33
v_accvgpr_write_b32 a134, v34
v_mfma_f32_16x16x32_bf16 v[60:63], a[104:107], a[40:43], v[60:63]
s_waitcnt lgkmcnt(6)
v_accvgpr_write_b32 a135, v35
v_cvt_pk_bf16_f32 v40, v40, v41
v_cvt_pk_bf16_f32 v41, v42, v43
v_mfma_f32_16x16x32_bf16 v[88:91], a[80:83], a[40:43], v[88:91]
ds_read_b64_tr_b16 a[104:105], v13 offset:768
v_cvt_pk_bf16_f32 v42, v44, v45
v_mfma_f32_16x16x32_bf16 v[88:91], a[84:87], a[60:63], v[88:91]
ds_read_b64_tr_b16 a[106:107], v13 offset:1792
s_add_u32 m0, s18, 0x7000
v_mfma_f32_16x16x32_bf16 v[96:99], a[84:87], a[64:67], v[96:99]
buffer_load_dwordx4 v4, s[44:47], s24 offen lds
v_cvt_pk_bf16_f32 v43, v46, v47
v_mfma_f32_16x16x32_bf16 v[96:99], a[80:83], a[44:47], v[96:99]
ds_read_b64_tr_b16 a[108:109], v13 offset:8960
v_add_u32 v5, 0x80000, v5
v_mfma_f32_16x16x32_bf16 v[104:107], a[80:83], a[48:51], v[104:107]
ds_read_b64_tr_b16 a[110:111], v13 offset:9984
v_add_u32 v6, 0x80000, v6
v_mfma_f32_16x16x32_bf16 v[104:107], a[84:87], a[68:71], v[104:107]
v_add_u32 v7, 0x60000, v7
v_add_u32 v4, 0x80, v4
v_accvgpr_write_b32 a136, v40
v_mfma_f32_16x16x32_bf16 v[112:115], a[84:87], a[72:75], v[112:115]
v_accvgpr_write_b32 a137, v41
v_accvgpr_write_b32 a138, v42
v_mfma_f32_16x16x32_bf16 v[112:115], a[80:83], a[52:55], v[112:115]
v_accvgpr_write_b32 a139, v43
v_cvt_pk_bf16_f32 v48, v48, v49
v_mfma_f32_16x16x32_bf16 v[116:119], a[88:91], a[52:55], v[116:119]
ds_read_b64_tr_b16 a[80:81], v12 offset:16384
s_mov_b32 s9, 0x600000
v_cvt_pk_bf16_f32 v49, v50, v51
v_mfma_f32_16x16x32_bf16 v[116:119], a[92:95], a[72:75], v[116:119]
buffer_load_dword a120, v19, s[52:55], s9 offen
v_mfma_f32_16x16x32_bf16 v[108:111], a[92:95], a[68:71], v[108:111]
ds_read_b64_tr_b16 a[82:83], v12 offset:17408
v_cvt_pk_bf16_f32 v50, v52, v53
v_mfma_f32_16x16x32_bf16 v[108:111], a[88:91], a[48:51], v[108:111]
ds_read_b64_tr_b16 a[84:85], v12 offset:24576
v_cvt_pk_bf16_f32 v51, v54, v55
v_accvgpr_write_b32 a140, v48
v_mfma_f32_16x16x32_bf16 v[100:103], a[88:91], a[44:47], v[100:103]
ds_read_b64_tr_b16 a[86:87], v12 offset:25600
v_accvgpr_write_b32 a141, v49
v_mfma_f32_16x16x32_bf16 v[100:103], a[92:95], a[64:67], v[100:103]
v_accvgpr_write_b32 a142, v50
v_accvgpr_write_b32 a143, v51
v_mfma_f32_16x16x32_bf16 v[92:95], a[92:95], a[60:63], v[92:95]
v_cvt_pk_bf16_f32 v56, v56, v57
v_cvt_pk_bf16_f32 v57, v58, v59
v_cvt_pk_bf16_f32 v58, v60, v61
v_mfma_f32_16x16x32_bf16 v[92:95], a[88:91], a[40:43], v[92:95]
s_add_u32 m0, s16, 0x0
s_waitcnt lgkmcnt(12)
s_waitcnt lgkmcnt(4)
v_mfma_f32_16x16x32_bf16 v[120:123], a[96:99], a[40:43], v[120:123]
buffer_load_dwordx4 v22, s[44:47], s20 offen lds
v_mfma_f32_16x16x32_bf16 v[120:123], a[100:103], a[60:63], v[120:123]
ds_read_b64_tr_b16 a[88:89], v13 offset:16384
v_cvt_pk_bf16_f32 v59, v62, v63
v_accvgpr_write_b32 a144, v56
v_mfma_f32_16x16x32_bf16 v[128:131], a[100:103], a[64:67], v[128:131]
ds_read_b64_tr_b16 a[90:91], v13 offset:17408
v_accvgpr_write_b32 a145, v57
v_mfma_f32_16x16x32_bf16 v[128:131], a[96:99], a[44:47], v[128:131]
ds_read_b64_tr_b16 a[92:93], v13 offset:24576
v_accvgpr_write_b32 a146, v58
v_mfma_f32_16x16x32_bf16 v[136:139], a[96:99], a[48:51], v[136:139]
ds_read_b64_tr_b16 a[94:95], v13 offset:25600
v_accvgpr_write_b32 a147, v59
v_cvt_pk_bf16_f32 v64, v64, v65
v_mfma_f32_16x16x32_bf16 v[136:139], a[100:103], a[68:71], v[136:139]
v_cvt_pk_bf16_f32 v65, v66, v67
v_cvt_pk_bf16_f32 v66, v68, v69
v_mfma_f32_16x16x32_bf16 v[144:147], a[100:103], a[72:75], v[144:147]
s_add_u32 m0, s16, 0x400
v_cvt_pk_bf16_f32 v67, v70, v71
v_accvgpr_write_b32 a148, v64
v_mfma_f32_16x16x32_bf16 v[144:147], a[96:99], a[52:55], v[144:147]
buffer_load_dwordx4 v23, s[44:47], s20 offen lds
v_accvgpr_write_b32 a149, v65
v_mfma_f32_16x16x32_bf16 v[148:151], a[104:107], a[52:55], v[148:151]
ds_read_b64_tr_b16 a[96:97], v12 offset:16640
v_accvgpr_write_b32 a150, v66
v_mfma_f32_16x16x32_bf16 v[148:151], a[108:111], a[72:75], v[148:151]
ds_read_b64_tr_b16 a[98:99], v12 offset:17664
v_accvgpr_write_b32 a151, v67
v_mfma_f32_16x16x32_bf16 v[140:143], a[108:111], a[68:71], v[140:143]
ds_read_b64_tr_b16 a[100:101], v12 offset:24832
v_cvt_pk_bf16_f32 v72, v72, v73
v_cvt_pk_bf16_f32 v73, v74, v75
v_mfma_f32_16x16x32_bf16 v[140:143], a[104:107], a[48:51], v[140:143]
ds_read_b64_tr_b16 a[102:103], v12 offset:25856
v_cvt_pk_bf16_f32 v74, v76, v77
v_mfma_f32_16x16x32_bf16 v[132:135], a[104:107], a[44:47], v[132:135]
v_cvt_pk_bf16_f32 v75, v78, v79
v_accvgpr_write_b32 a152, v72
v_mfma_f32_16x16x32_bf16 v[132:135], a[108:111], a[64:67], v[132:135]
s_add_u32 m0, s16, 0x800
v_accvgpr_write_b32 a153, v73
v_accvgpr_write_b32 a154, v74
v_accvgpr_write_b32 a155, v75
v_mfma_f32_16x16x32_bf16 v[124:127], a[108:111], a[60:63], v[124:127]
buffer_load_dwordx4 v22, s[44:47], s21 offen lds
v_mfma_f32_16x16x32_bf16 v[124:127], a[104:107], a[40:43], v[124:127]
s_waitcnt lgkmcnt(4)
v_cvt_pk_bf16_f32 v80, v80, v81
v_cvt_pk_bf16_f32 v81, v82, v83
v_mfma_f32_16x16x32_bf16 v[152:155], a[40:43], a[80:83], v[152:155]
ds_read_b64_tr_b16 a[104:105], v13 offset:16640
v_cvt_pk_bf16_f32 v82, v84, v85
v_cvt_pk_bf16_f32 v83, v86, v87
v_mfma_f32_16x16x32_bf16 v[152:155], a[60:63], a[84:87], v[152:155]
ds_read_b64_tr_b16 a[106:107], v13 offset:17664
v_accvgpr_write_b32 a156, v80
v_mfma_f32_16x16x32_bf16 v[156:159], a[64:67], a[84:87], v[156:159]
ds_read_b64_tr_b16 a[108:109], v13 offset:24832
v_accvgpr_write_b32 a157, v81
v_mfma_f32_16x16x32_bf16 v[156:159], a[44:47], a[80:83], v[156:159]
ds_read_b64_tr_b16 a[110:111], v13 offset:25856
v_accvgpr_write_b32 a158, v82
v_accvgpr_write_b32 a159, v83
v_mfma_f32_16x16x32_bf16 v[160:163], a[48:51], a[80:83], v[160:163]
s_add_u32 m0, s16, 0xc00
v_cvt_pk_bf16_f32 v88, v88, v89
v_cvt_pk_bf16_f32 v89, v90, v91
v_mfma_f32_16x16x32_bf16 v[160:163], a[68:71], a[84:87], v[160:163]
buffer_load_dwordx4 v23, s[44:47], s21 offen lds
v_mfma_f32_16x16x32_bf16 v[164:167], a[72:75], a[84:87], v[164:167]
v_cvt_pk_bf16_f32 v90, v92, v93
v_cvt_pk_bf16_f32 v91, v94, v95
v_accvgpr_write_b32 a160, v88
v_mfma_f32_16x16x32_bf16 v[164:167], a[52:55], a[80:83], v[164:167]
v_accvgpr_write_b32 a161, v89
v_accvgpr_write_b32 a162, v90
v_mfma_f32_16x16x32_bf16 v[180:183], a[52:55], a[88:91], v[180:183]
ds_read_b64_tr_b16 a[80:81], v12 offset:16896
v_accvgpr_write_b32 a163, v91
v_mfma_f32_16x16x32_bf16 v[180:183], a[72:75], a[92:95], v[180:183]
ds_read_b64_tr_b16 a[82:83], v12 offset:17920
v_cvt_pk_bf16_f32 v96, v96, v97
v_cvt_pk_bf16_f32 v97, v98, v99
v_mfma_f32_16x16x32_bf16 v[176:179], a[68:71], a[92:95], v[176:179]
ds_read_b64_tr_b16 a[84:85], v12 offset:25088
v_cvt_pk_bf16_f32 v98, v100, v101
v_mfma_f32_16x16x32_bf16 v[176:179], a[48:51], a[88:91], v[176:179]
ds_read_b64_tr_b16 a[86:87], v12 offset:26112
s_add_u32 m0, s16, 0x1000
v_mfma_f32_16x16x32_bf16 v[172:175], a[44:47], a[88:91], v[172:175]
buffer_load_dwordx4 v22, s[44:47], s22 offen lds
v_cvt_pk_bf16_f32 v99, v102, v103
v_mfma_f32_16x16x32_bf16 v[172:175], a[64:67], a[92:95], v[172:175]
v_accvgpr_write_b32 a164, v96
v_accvgpr_write_b32 a165, v97
v_mfma_f32_16x16x32_bf16 v[168:171], a[60:63], a[92:95], v[168:171]
v_accvgpr_write_b32 a166, v98
v_accvgpr_write_b32 a167, v99
v_mfma_f32_16x16x32_bf16 v[168:171], a[40:43], a[88:91], v[168:171]
s_waitcnt lgkmcnt(4)
v_cvt_pk_bf16_f32 v104, v104, v105
v_cvt_pk_bf16_f32 v105, v106, v107
v_cvt_pk_bf16_f32 v106, v108, v109
v_mfma_f32_16x16x32_bf16 v[184:187], a[40:43], a[96:99], v[184:187]
ds_read_b64_tr_b16 a[88:89], v13 offset:16896
v_cvt_pk_bf16_f32 v107, v110, v111
v_mfma_f32_16x16x32_bf16 v[184:187], a[60:63], a[100:103], v[184:187]
ds_read_b64_tr_b16 a[90:91], v13 offset:17920
v_accvgpr_write_b32 a168, v104
v_mfma_f32_16x16x32_bf16 v[188:191], a[64:67], a[100:103], v[188:191]
ds_read_b64_tr_b16 a[92:93], v13 offset:25088
s_add_u32 m0, s16, 0x1400
v_accvgpr_write_b32 a169, v105
v_mfma_f32_16x16x32_bf16 v[188:191], a[44:47], a[96:99], v[188:191]
buffer_load_dwordx4 v23, s[44:47], s22 offen lds
v_mfma_f32_16x16x32_bf16 v[192:195], a[48:51], a[96:99], v[192:195]
ds_read_b64_tr_b16 a[94:95], v13 offset:26112
v_accvgpr_write_b32 a170, v106
v_mfma_f32_16x16x32_bf16 v[192:195], a[68:71], a[100:103], v[192:195]
v_accvgpr_write_b32 a171, v107
v_cvt_pk_bf16_f32 v112, v112, v113
v_cvt_pk_bf16_f32 v113, v114, v115
v_mfma_f32_16x16x32_bf16 v[196:199], a[72:75], a[100:103], v[196:199]
v_cvt_pk_bf16_f32 v114, v116, v117
v_cvt_pk_bf16_f32 v115, v118, v119
v_mfma_f32_16x16x32_bf16 v[196:199], a[52:55], a[96:99], v[196:199]
v_accvgpr_write_b32 a172, v112
v_accvgpr_write_b32 a173, v113
v_mfma_f32_16x16x32_bf16 v[212:215], a[52:55], a[104:107], v[212:215]
ds_read_b64_tr_b16 a[96:97], v12 offset:17152
v_accvgpr_write_b32 a174, v114
v_accvgpr_write_b32 a175, v115
v_mfma_f32_16x16x32_bf16 v[212:215], a[72:75], a[108:111], v[212:215]
ds_read_b64_tr_b16 a[98:99], v12 offset:18176
s_add_u32 m0, s16, 0x1800
v_mfma_f32_16x16x32_bf16 v[208:211], a[68:71], a[108:111], v[208:211]
buffer_load_dwordx4 v22, s[44:47], s23 offen lds
v_mfma_f32_16x16x32_bf16 v[208:211], a[48:51], a[104:107], v[208:211]
ds_read_b64_tr_b16 a[100:101], v12 offset:25344
v_cvt_pk_bf16_f32 v120, v120, v121
v_cvt_pk_bf16_f32 v121, v122, v123
v_mfma_f32_16x16x32_bf16 v[204:207], a[44:47], a[104:107], v[204:207]
ds_read_b64_tr_b16 a[102:103], v12 offset:26368
v_cvt_pk_bf16_f32 v122, v124, v125
v_mfma_f32_16x16x32_bf16 v[204:207], a[64:67], a[108:111], v[204:207]
v_cvt_pk_bf16_f32 v123, v126, v127
v_accvgpr_write_b32 a176, v120
v_mfma_f32_16x16x32_bf16 v[200:203], a[60:63], a[108:111], v[200:203]
v_accvgpr_write_b32 a177, v121
v_accvgpr_write_b32 a178, v122
v_accvgpr_write_b32 a179, v123
v_mfma_f32_16x16x32_bf16 v[200:203], a[40:43], a[104:107], v[200:203]
s_waitcnt lgkmcnt(4)
v_cvt_pk_bf16_f32 v128, v128, v129
v_cvt_pk_bf16_f32 v129, v130, v131
v_mfma_f32_16x16x32_bf16 v[248:251], a[40:43], a[80:83], v[248:251]
ds_read_b64_tr_b16 a[104:105], v13 offset:17152
s_add_u32 m0, s16, 0x1c00
v_mfma_f32_16x16x32_bf16 v[248:251], a[60:63], a[84:87], v[248:251]
buffer_load_dwordx4 v23, s[44:47], s23 offen lds
v_cvt_pk_bf16_f32 v130, v132, v133
v_mfma_f32_16x16x32_bf16 v[252:255], a[64:67], a[84:87], v[252:255]
ds_read_b64_tr_b16 a[106:107], v13 offset:18176
v_add_u32 v22, 0x80, v22
v_mfma_f32_16x16x32_bf16 v[252:255], a[44:47], a[80:83], v[252:255]
ds_read_b64_tr_b16 a[108:109], v13 offset:25344
v_add_u32 v23, 0x80, v23
v_mfma_f32_16x16x32_bf16 v[216:219], a[48:51], a[80:83], v[216:219]
ds_read_b64_tr_b16 a[110:111], v13 offset:26368
v_add_u32 v12, 0x8000, v12
v_cvt_pk_bf16_f32 v131, v134, v135
v_mfma_f32_16x16x32_bf16 v[216:219], a[68:71], a[84:87], v[216:219]
v_add_u32 v13, 0x8000, v13
v_accvgpr_write_b32 a180, v128
v_mfma_f32_16x16x32_bf16 v[220:223], a[72:75], a[84:87], v[220:223]
v_accvgpr_write_b32 a181, v129
v_accvgpr_write_b32 a182, v130
v_mfma_f32_16x16x32_bf16 v[220:223], a[52:55], a[80:83], v[220:223]
v_accvgpr_write_b32 a183, v131
v_cvt_pk_bf16_f32 v136, v136, v137
v_cvt_pk_bf16_f32 v137, v138, v139
v_mfma_f32_16x16x32_bf16 v[236:239], a[52:55], a[88:91], v[236:239]
s_waitcnt vmcnt(27) lgkmcnt(0)
v_cvt_pk_bf16_f32 v138, v140, v141
v_cvt_pk_bf16_f32 v139, v142, v143
v_mfma_f32_16x16x32_bf16 v[236:239], a[72:75], a[92:95], v[236:239]
s_barrier
s_add_u32 m0, s17, 0x8000
v_accvgpr_write_b32 a184, v136
v_mfma_f32_16x16x32_bf16 v[232:235], a[68:71], a[92:95], v[232:235]
buffer_load_dwordx4 v5, s[52:55], 0 offen lds
v_accvgpr_write_b32 a185, v137
v_mfma_f32_16x16x32_bf16 v[232:235], a[48:51], a[88:91], v[232:235]
ds_read_b64_tr_b16 a[80:81], v12 offset:0
v_accvgpr_write_b32 a186, v138
v_mfma_f32_16x16x32_bf16 v[228:231], a[44:47], a[88:91], v[228:231]
ds_read_b64_tr_b16 a[82:83], v12 offset:1024
v_accvgpr_write_b32 a187, v139
v_mfma_f32_16x16x32_bf16 v[228:231], a[64:67], a[92:95], v[228:231]
ds_read_b64_tr_b16 a[84:85], v12 offset:8192
v_cvt_pk_bf16_f32 v144, v144, v145
v_cvt_pk_bf16_f32 v145, v146, v147
v_mfma_f32_16x16x32_bf16 v[224:227], a[60:63], a[92:95], v[224:227]
ds_read_b64_tr_b16 a[86:87], v12 offset:9216
v_cvt_pk_bf16_f32 v146, v148, v149
v_mfma_f32_16x16x32_bf16 v[224:227], a[40:43], a[88:91], v[224:227]
s_waitcnt lgkmcnt(4)
v_cvt_pk_bf16_f32 v147, v150, v151
v_accvgpr_write_b32 a188, v144
v_mfma_f32_16x16x32_bf16 v[240:243], a[40:43], a[96:99], v[240:243]
ds_read_b64_tr_b16 a[88:89], v13 offset:0
s_add_u32 m0, s17, 0x8400
v_accvgpr_write_b32 a189, v145
v_mfma_f32_16x16x32_bf16 v[240:243], a[60:63], a[100:103], v[240:243]
buffer_load_dwordx4 v5, s[52:55], s13 offen lds
v_mfma_f32_16x16x32_bf16 v[244:247], a[64:67], a[100:103], v[244:247]
ds_read_b64_tr_b16 a[90:91], v13 offset:1024
v_accvgpr_write_b32 a190, v146
v_mfma_f32_16x16x32_bf16 v[244:247], a[44:47], a[96:99], v[244:247]
ds_read_b64_tr_b16 a[92:93], v13 offset:8192
v_accvgpr_write_b32 a191, v147
v_cvt_pk_bf16_f32 v152, v152, v153
v_mfma_f32_16x16x32_bf16 a[232:235], a[48:51], a[96:99], a[232:235]
ds_read_b64_tr_b16 a[94:95], v13 offset:9216
v_cvt_pk_bf16_f32 v153, v154, v155
v_mfma_f32_16x16x32_bf16 a[232:235], a[68:71], a[100:103], a[232:235]
v_cvt_pk_bf16_f32 v154, v156, v157
v_cvt_pk_bf16_f32 v155, v158, v159
v_mfma_f32_16x16x32_bf16 a[236:239], a[72:75], a[100:103], a[236:239]
v_accvgpr_write_b32 a192, v152
v_accvgpr_write_b32 a193, v153
v_accvgpr_write_b32 a194, v154
v_mfma_f32_16x16x32_bf16 a[236:239], a[52:55], a[96:99], a[236:239]
s_add_u32 m0, s17, 0x8800
v_accvgpr_write_b32 a195, v155
v_cvt_pk_bf16_f32 v160, v160, v161
v_mfma_f32_16x16x32_bf16 a[252:255], a[52:55], a[104:107], a[252:255]
buffer_load_dwordx4 v6, s[52:55], 0 offen lds
v_mfma_f32_16x16x32_bf16 a[252:255], a[72:75], a[108:111], a[252:255]
ds_read_b64_tr_b16 a[96:97], v12 offset:256
v_cvt_pk_bf16_f32 v161, v162, v163
v_cvt_pk_bf16_f32 v162, v164, v165
v_mfma_f32_16x16x32_bf16 a[248:251], a[68:71], a[108:111], a[248:251]
ds_read_b64_tr_b16 a[98:99], v12 offset:1280
v_cvt_pk_bf16_f32 v163, v166, v167
v_mfma_f32_16x16x32_bf16 a[248:251], a[48:51], a[104:107], a[248:251]
ds_read_b64_tr_b16 a[100:101], v12 offset:8448
v_accvgpr_write_b32 a196, v160
v_mfma_f32_16x16x32_bf16 a[244:247], a[44:47], a[104:107], a[244:247]
ds_read_b64_tr_b16 a[102:103], v12 offset:9472
v_accvgpr_write_b32 a197, v161
v_accvgpr_write_b32 a198, v162
v_mfma_f32_16x16x32_bf16 a[244:247], a[64:67], a[108:111], a[244:247]
v_accvgpr_write_b32 a199, v163
v_cvt_pk_bf16_f32 v168, v168, v169
v_mfma_f32_16x16x32_bf16 a[240:243], a[60:63], a[108:111], a[240:243]
s_add_u32 m0, s17, 0x8c00
s_waitcnt lgkmcnt(4)
v_cvt_pk_bf16_f32 v169, v170, v171
v_mfma_f32_16x16x32_bf16 a[240:243], a[40:43], a[104:107], a[240:243]
buffer_load_dwordx4 v6, s[52:55], s13 offen lds
v_cvt_pk_bf16_f32 v170, v172, v173
L_S8:
v_mfma_f32_16x16x32_bf16 v[24:27], a[80:83], a[0:3], 0
ds_read_b64_tr_b16 a[104:105], v13 offset:256
s_waitcnt vmcnt(22)
v_mfma_f32_16x16x32_bf16 v[24:27], a[84:87], a[20:23], v[24:27]
ds_read_b64_tr_b16 a[106:107], v13 offset:1280
v_cvt_pk_bf16_f32 v171, v174, v175
v_mfma_f32_16x16x32_bf16 v[32:35], a[84:87], a[24:27], 0
ds_read_b64_tr_b16 a[108:109], v13 offset:8448
v_accvgpr_write_b32 a200, v168
v_accvgpr_write_b32 a201, v169
v_mfma_f32_16x16x32_bf16 v[32:35], a[80:83], a[4:7], v[32:35]
ds_read_b64_tr_b16 a[110:111], v13 offset:9472
v_accvgpr_write_b32 a202, v170
v_mfma_f32_16x16x32_bf16 v[40:43], a[80:83], a[8:11], 0
ds_read_b128 a[40:43], v8 offset:32768
v_accvgpr_write_b32 a203, v171
v_mfma_f32_16x16x32_bf16 v[40:43], a[84:87], a[28:31], v[40:43]
ds_read_b128 a[60:63], v9 offset:32768
s_add_u32 m0, s18, 0xc000
v_cvt_pk_bf16_f32 v176, v176, v177
v_mfma_f32_16x16x32_bf16 v[48:51], a[84:87], a[32:35], 0
buffer_load_dwordx4 v7, s[68:71], 0 offen lds
v_mfma_f32_16x16x32_bf16 v[48:51], a[80:83], a[12:15], v[48:51]
ds_read_b128 a[44:47], v8 offset:34816
v_cvt_pk_bf16_f32 v177, v178, v179
v_mfma_f32_16x16x32_bf16 v[52:55], a[88:91], a[12:15], 0
ds_read_b64_tr_b16 a[80:81], v12 offset:512
v_cvt_pk_bf16_f32 v178, v180, v181
v_cvt_pk_bf16_f32 v179, v182, v183
v_mfma_f32_16x16x32_bf16 v[52:55], a[92:95], a[32:35], v[52:55]
ds_read_b64_tr_b16 a[82:83], v12 offset:1536
v_accvgpr_write_b32 a204, v176
v_mfma_f32_16x16x32_bf16 v[44:47], a[92:95], a[28:31], 0
ds_read_b64_tr_b16 a[84:85], v12 offset:8704
v_accvgpr_write_b32 a205, v177
v_mfma_f32_16x16x32_bf16 v[44:47], a[88:91], a[8:11], v[44:47]
ds_read_b64_tr_b16 a[86:87], v12 offset:9728
v_accvgpr_write_b32 a206, v178
v_accvgpr_write_b32 a207, v179
v_mfma_f32_16x16x32_bf16 v[36:39], a[88:91], a[4:7], 0
ds_read_b128 a[64:67], v9 offset:34816
s_add_u32 m0, s18, 0xd000
v_mfma_f32_16x16x32_bf16 v[36:39], a[92:95], a[24:27], v[36:39]
buffer_load_dwordx4 v7, s[68:71], s25 offen lds
v_mfma_f32_16x16x32_bf16 v[28:31], a[92:95], a[20:23], 0
ds_read_b128 a[48:51], v8 offset:36864
v_cvt_pk_bf16_f32 v184, v184, v185
v_cvt_pk_bf16_f32 v185, v186, v187
v_mfma_f32_16x16x32_bf16 v[28:31], a[88:91], a[0:3], v[28:31]
ds_read_b128 a[68:71], v9 offset:36864
s_waitcnt lgkmcnt(10)
v_mfma_f32_16x16x32_bf16 v[56:59], a[96:99], a[0:3], 0
ds_read_b64_tr_b16 a[88:89], v13 offset:512
v_cvt_pk_bf16_f32 v186, v188, v189
v_mfma_f32_16x16x32_bf16 v[56:59], a[100:103], a[20:23], v[56:59]
ds_read_b64_tr_b16 a[90:91], v13 offset:1536
v_cvt_pk_bf16_f32 v187, v190, v191
v_accvgpr_write_b32 a208, v184
v_mfma_f32_16x16x32_bf16 v[64:67], a[100:103], a[24:27], 0
ds_read_b64_tr_b16 a[92:93], v13 offset:8704
v_accvgpr_write_b32 a209, v185
v_mfma_f32_16x16x32_bf16 v[64:67], a[96:99], a[4:7], v[64:67]
ds_read_b64_tr_b16 a[94:95], v13 offset:9728
s_add_u32 m0, s18, 0xe000
v_mfma_f32_16x16x32_bf16 v[72:75], a[96:99], a[8:11], 0
buffer_load_dwordx4 v7, s[68:71], s26 offen lds
v_accvgpr_write_b32 a210, v186
v_mfma_f32_16x16x32_bf16 v[72:75], a[100:103], a[28:31], v[72:75]
ds_read_b128 a[52:55], v8 offset:38912
v_accvgpr_write_b32 a211, v187
v_mfma_f32_16x16x32_bf16 v[80:83], a[100:103], a[32:35], 0
ds_read_b128 a[72:75], v9 offset:38912
v_cvt_pk_bf16_f32 v192, v192, v193
v_mfma_f32_16x16x32_bf16 v[80:83], a[96:99], a[12:15], v[80:83]
ds_read_b128 a[16:19], v10
v_cvt_pk_bf16_f32 v193, v194, v195
v_cvt_pk_bf16_f32 v194, v196, v197
v_mfma_f32_16x16x32_bf16 v[84:87], a[104:107], a[12:15], 0
ds_read_b64_tr_b16 a[96:97], v12 offset:768
v_cvt_pk_bf16_f32 v195, v198, v199
v_mfma_f32_16x16x32_bf16 v[84:87], a[108:111], a[32:35], v[84:87]
ds_read_b64_tr_b16 a[98:99], v12 offset:1792
v_accvgpr_write_b32 a212, v192
v_mfma_f32_16x16x32_bf16 v[76:79], a[108:111], a[28:31], 0
ds_read_b64_tr_b16 a[100:101], v12 offset:8960
s_add_u32 m0, s18, 0xf000
v_accvgpr_write_b32 a213, v193
v_mfma_f32_16x16x32_bf16 v[76:79], a[104:107], a[8:11], v[76:79]
buffer_load_dwordx4 v4, s[44:47], s24 offen lds
v_mfma_f32_16x16x32_bf16 v[68:71], a[104:107], a[4:7], 0
ds_read_b64_tr_b16 a[102:103], v12 offset:9984
v_add_u32 v5, 0x80000, v5
v_mfma_f32_16x16x32_bf16 v[68:71], a[108:111], a[24:27], v[68:71]
ds_read_b128 a[36:39], v11
v_add_u32 v6, 0x80000, v6
v_accvgpr_write_b32 a214, v194
v_mfma_f32_16x16x32_bf16 v[60:63], a[108:111], a[20:23], 0
v_add_u32 v7, 0x60000, v7
v_add_u32 v4, 0x80, v4
v_mfma_f32_16x16x32_bf16 v[60:63], a[104:107], a[0:3], v[60:63]
s_waitcnt lgkmcnt(8)
v_accvgpr_write_b32 a215, v195
v_cvt_pk_bf16_f32 v200, v200, v201
v_mfma_f32_16x16x32_bf16 v[88:91], a[80:83], a[0:3], 0
ds_read_b64_tr_b16 a[104:105], v13 offset:768
s_waitcnt lgkmcnt(7)
v_cvt_pk_bf16_f32 v201, v202, v203
v_mfma_f32_16x16x32_bf16 v[88:91], a[84:87], a[20:23], v[88:91]
ds_read_b64_tr_b16 a[106:107], v13 offset:1792
s_add_u32 m0, s16, 0x8000
v_mfma_f32_16x16x32_bf16 v[96:99], a[84:87], a[24:27], 0
buffer_load_dwordx4 v22, s[44:47], s20 offen lds
v_mfma_f32_16x16x32_bf16 v[96:99], a[80:83], a[4:7], v[96:99]
ds_read_b64_tr_b16 a[108:109], v13 offset:8960
v_cvt_pk_bf16_f32 v202, v204, v205
v_cvt_pk_bf16_f32 v203, v206, v207
v_mfma_f32_16x16x32_bf16 v[104:107], a[80:83], a[8:11], 0
ds_read_b64_tr_b16 a[110:111], v13 offset:9984
v_accvgpr_write_b32 a216, v200
v_mfma_f32_16x16x32_bf16 v[104:107], a[84:87], a[28:31], v[104:107]
v_accvgpr_write_b32 a217, v201
v_accvgpr_write_b32 a218, v202
v_mfma_f32_16x16x32_bf16 v[112:115], a[84:87], a[32:35], 0
v_accvgpr_write_b32 a219, v203
v_cvt_pk_bf16_f32 v208, v208, v209
v_cvt_pk_bf16_f32 v209, v210, v211
v_mfma_f32_16x16x32_bf16 v[112:115], a[80:83], a[12:15], v[112:115]
v_cvt_pk_bf16_f32 v210, v212, v213
v_cvt_pk_bf16_f32 v211, v214, v215
v_mfma_f32_16x16x32_bf16 v[116:119], a[88:91], a[12:15], 0
ds_read_b64_tr_b16 a[80:81], v14 offset:0
s_add_u32 m0, s16, 0x8400
v_mfma_f32_16x16x32_bf16 v[116:119], a[92:95], a[32:35], v[116:119]
buffer_load_dwordx4 v23, s[44:47], s20 offen lds
v_accvgpr_write_b32 a220, v208
v_mfma_f32_16x16x32_bf16 v[108:111], a[92:95], a[28:31], 0
ds_read_b64_tr_b16 a[82:83], v14 offset:256
v_accvgpr_write_b32 a221, v209
v_mfma_f32_16x16x32_bf16 v[108:111], a[88:91], a[8:11], v[108:111]
ds_read_b64_tr_b16 a[84:85], v14 offset:2048
v_accvgpr_write_b32 a222, v210
v_mfma_f32_16x16x32_bf16 v[100:103], a[88:91], a[4:7], 0
ds_read_b64_tr_b16 a[86:87], v14 offset:2304
v_accvgpr_write_b32 a223, v211
v_cvt_pk_bf16_f32 v248, v248, v249
v_mfma_f32_16x16x32_bf16 v[100:103], a[92:95], a[24:27], v[100:103]
v_cvt_pk_bf16_f32 v249, v250, v251
v_cvt_pk_bf16_f32 v250, v252, v253
v_mfma_f32_16x16x32_bf16 v[92:95], a[92:95], a[20:23], 0
v_cvt_pk_bf16_f32 v251, v254, v255
v_accvgpr_write_b32 a224, v248
v_mfma_f32_16x16x32_bf16 v[92:95], a[88:91], a[0:3], v[92:95]
s_add_u32 m0, s16, 0x8800
s_waitcnt lgkmcnt(4)
v_accvgpr_write_b32 a225, v249
v_accvgpr_write_b32 a226, v250
v_mfma_f32_16x16x32_bf16 v[120:123], a[96:99], a[0:3], 0
buffer_load_dwordx4 v22, s[44:47], s21 offen lds
v_mfma_f32_16x16x32_bf16 v[120:123], a[100:103], a[20:23], v[120:123]
ds_read_b64_tr_b16 a[88:89], v15 offset:0
v_accvgpr_write_b32 a227, v251
v_mfma_f32_16x16x32_bf16 v[128:131], a[100:103], a[24:27], 0
ds_read_b64_tr_b16 a[90:91], v15 offset:256
v_cvt_pk_bf16_f32 v216, v216, v217
v_cvt_pk_bf16_f32 v217, v218, v219
v_mfma_f32_16x16x32_bf16 v[128:131], a[96:99], a[4:7], v[128:131]
ds_read_b64_tr_b16 a[92:93], v15 offset:2048
v_cvt_pk_bf16_f32 v218, v220, v221
v_mfma_f32_16x16x32_bf16 v[136:139], a[96:99], a[8:11], 0
ds_read_b64_tr_b16 a[94:95], v15 offset:2304
v_cvt_pk_bf16_f32 v219, v222, v223
v_mfma_f32_16x16x32_bf16 v[136:139], a[100:103], a[28:31], v[136:139]
v_accvgpr_write_b32 a228, v216
v_accvgpr_write_b32 a229, v217
v_accvgpr_write_b32 a230, v218
v_mfma_f32_16x16x32_bf16 v[144:147], a[100:103], a[32:35], 0
s_add_u32 m0, s16, 0x8c00
v_accvgpr_write_b32 a231, v219
v_cvt_pk_bf16_f32 v224, v224, v225
v_mfma_f32_16x16x32_bf16 v[144:147], a[96:99], a[12:15], v[144:147]
buffer_load_dwordx4 v23, s[44:47], s21 offen lds
v_mfma_f32_16x16x32_bf16 v[148:151], a[104:107], a[12:15], 0
ds_read_b64_tr_b16 a[96:97], v14 offset:4096
v_cvt_pk_bf16_f32 v225, v226, v227
v_cvt_pk_bf16_f32 v226, v228, v229
v_mfma_f32_16x16x32_bf16 v[148:151], a[108:111], a[32:35], v[148:151]
ds_read_b64_tr_b16 a[98:99], v14 offset:4352
v_cvt_pk_bf16_f32 v227, v230, v231
v_mfma_f32_16x16x32_bf16 v[140:143], a[108:111], a[28:31], 0
ds_read_b64_tr_b16 a[100:101], v14 offset:6144
v_accvgpr_write_b32 a112, v224
v_mfma_f32_16x16x32_bf16 v[140:143], a[104:107], a[8:11], v[140:143]
ds_read_b64_tr_b16 a[102:103], v14 offset:6400
v_accvgpr_write_b32 a113, v225
v_accvgpr_write_b32 a114, v226
v_mfma_f32_16x16x32_bf16 v[132:135], a[104:107], a[4:7], 0
v_accvgpr_write_b32 a115, v227
v_cvt_pk_bf16_f32 v232, v232, v233
v_mfma_f32_16x16x32_bf16 v[132:135], a[108:111], a[24:27], v[132:135]
s_add_u32 m0, s16, 0x9000
v_cvt_pk_bf16_f32 v233, v234, v235
v_cvt_pk_bf16_f32 v234, v236, v237
v_mfma_f32_16x16x32_bf16 v[124:127], a[108:111], a[20:23], 0
buffer_load_dwordx4 v22, s[44:47], s22 offen lds
v_cvt_pk_bf16_f32 v235, v238, v239
v_mfma_f32_16x16x32_bf16 v[124:127], a[104:107], a[0:3], v[124:127]
s_waitcnt lgkmcnt(4)
v_accvgpr_write_b32 a116, v232
v_accvgpr_write_b32 a117, v233
v_mfma_f32_16x16x32_bf16 v[152:155], a[80:83], a[0:3], 0
ds_read_b64_tr_b16 a[104:105], v15 offset:4096
v_accvgpr_write_b32 a118, v234
v_mfma_f32_16x16x32_bf16 v[152:155], a[84:87], a[20:23], v[152:155]
ds_read_b64_tr_b16 a[106:107], v15 offset:4352
v_accvgpr_write_b32 a119, v235
v_cvt_pk_bf16_f32 v240, v240, v241
v_mfma_f32_16x16x32_bf16 v[160:163], a[84:87], a[24:27], 0
ds_read_b64_tr_b16 a[108:109], v15 offset:6144
v_cvt_pk_bf16_f32 v241, v242, v243
v_mfma_f32_16x16x32_bf16 v[160:163], a[80:83], a[4:7], v[160:163]
ds_read_b64_tr_b16 a[110:111], v15 offset:6400
v_cvt_pk_bf16_f32 v242, v244, v245
v_mfma_f32_16x16x32_bf16 v[168:171], a[80:83], a[8:11], 0
s_add_u32 m0, s16, 0x9400
v_cvt_pk_bf16_f32 v243, v246, v247
v_accvgpr_write_b32 a124, v240
v_accvgpr_write_b32 a125, v241
v_mfma_f32_16x16x32_bf16 v[168:171], a[84:87], a[28:31], v[168:171]
buffer_load_dwordx4 v23, s[44:47], s22 offen lds
v_mfma_f32_16x16x32_bf16 v[176:179], a[84:87], a[32:35], 0
v_accvgpr_write_b32 a126, v242
v_accvgpr_write_b32 a127, v243
v_mfma_f32_16x16x32_bf16 v[176:179], a[80:83], a[12:15], v[176:179]
v_accvgpr_read_b32 v2, a232
v_accvgpr_read_b32 v3, a233
v_cvt_pk_bf16_f32 v2, v2, v3
v_mfma_f32_16x16x32_bf16 v[180:183], a[88:91], a[12:15], 0
ds_read_b64_tr_b16 a[80:81], v14 offset:8192
v_accvgpr_write_b32 a232, v2
v_mfma_f32_16x16x32_bf16 v[180:183], a[92:95], a[32:35], v[180:183]
ds_read_b64_tr_b16 a[82:83], v14 offset:8448
v_accvgpr_read_b32 v2, a234
v_mfma_f32_16x16x32_bf16 v[172:175], a[92:95], a[28:31], 0
ds_read_b64_tr_b16 a[84:85], v14 offset:10240
v_accvgpr_read_b32 v3, a235
v_cvt_pk_bf16_f32 v2, v2, v3
v_mfma_f32_16x16x32_bf16 v[172:175], a[88:91], a[8:11], v[172:175]
ds_read_b64_tr_b16 a[86:87], v14 offset:10496
s_add_u32 m0, s16, 0x9800
v_mfma_f32_16x16x32_bf16 v[164:167], a[88:91], a[4:7], 0
buffer_load_dwordx4 v22, s[44:47], s23 offen lds
v_mfma_f32_16x16x32_bf16 v[164:167], a[92:95], a[24:27], v[164:167]
v_accvgpr_write_b32 a233, v2
v_accvgpr_read_b32 v2, a236
v_accvgpr_read_b32 v3, a237
v_mfma_f32_16x16x32_bf16 v[156:159], a[92:95], a[20:23], 0
v_cvt_pk_bf16_f32 v2, v2, v3
v_accvgpr_write_b32 a234, v2
v_mfma_f32_16x16x32_bf16 v[156:159], a[88:91], a[0:3], v[156:159]
s_waitcnt lgkmcnt(4)
v_accvgpr_read_b32 v2, a238
v_accvgpr_read_b32 v3, a239
v_mfma_f32_16x16x32_bf16 v[184:187], a[96:99], a[0:3], 0
ds_read_b64_tr_b16 a[88:89], v15 offset:8192
v_cvt_pk_bf16_f32 v2, v2, v3
v_accvgpr_write_b32 a235, v2
v_mfma_f32_16x16x32_bf16 v[184:187], a[100:103], a[20:23], v[184:187]
ds_read_b64_tr_b16 a[90:91], v15 offset:8448
v_accvgpr_read_b32 v2, a240
v_mfma_f32_16x16x32_bf16 v[192:195], a[100:103], a[24:27], 0
ds_read_b64_tr_b16 a[92:93], v15 offset:10240
s_add_u32 m0, s16, 0x9c00
v_mfma_f32_16x16x32_bf16 v[192:195], a[96:99], a[4:7], v[192:195]
buffer_load_dwordx4 v23, s[44:47], s23 offen lds
v_accvgpr_read_b32 v3, a241
v_mfma_f32_16x16x32_bf16 v[200:203], a[96:99], a[8:11], 0
ds_read_b64_tr_b16 a[94:95], v15 offset:10496
v_add_u32 v22, 0x80, v22
v_mfma_f32_16x16x32_bf16 v[200:203], a[100:103], a[28:31], v[200:203]
v_add_u32 v23, 0x80, v23
v_add_u32 v12, 0xffff0000, v12
v_mfma_f32_16x16x32_bf16 v[208:211], a[100:103], a[32:35], 0
v_add_u32 v13, 0xffff0000, v13
v_add_u32 v14, 0xffff0000, v14
v_cvt_pk_bf16_f32 v2, v2, v3
v_mfma_f32_16x16x32_bf16 v[208:211], a[96:99], a[12:15], v[208:211]
v_add_u32 v15, 0xffff0000, v15
v_add_u32 v10, 0xffff0000, v10
v_mfma_f32_16x16x32_bf16 v[248:251], a[96:99], a[16:19], 0
v_add_u32 v11, 0xffff0000, v11
v_accvgpr_write_b32 a240, v2
v_mfma_f32_16x16x32_bf16 v[248:251], a[100:103], a[36:39], v[248:251]
v_accvgpr_read_b32 v2, a242
v_accvgpr_read_b32 v3, a243
v_cvt_pk_bf16_f32 v2, v2, v3
v_mfma_f32_16x16x32_bf16 v[212:215], a[104:107], a[12:15], 0
s_waitcnt vmcnt(25) lgkmcnt(0)
v_accvgpr_write_b32 a241, v2
v_accvgpr_read_b32 v2, a244
v_mfma_f32_16x16x32_bf16 v[212:215], a[108:111], a[32:35], v[212:215]
s_barrier
s_add_u32 m0, s17, 0x10000
v_accvgpr_read_b32 v3, a245
v_mfma_f32_16x16x32_bf16 v[204:207], a[108:111], a[28:31], 0
buffer_load_dwordx4 v5, s[52:55], 0 offen lds
v_cvt_pk_bf16_f32 v2, v2, v3
v_mfma_f32_16x16x32_bf16 v[204:207], a[104:107], a[8:11], v[204:207]
ds_read_b64_tr_b16 a[96:97], v12 offset:0
v_accvgpr_write_b32 a242, v2
v_mfma_f32_16x16x32_bf16 v[196:199], a[104:107], a[4:7], 0
ds_read_b64_tr_b16 a[98:99], v12 offset:1024
v_accvgpr_read_b32 v2, a246
v_mfma_f32_16x16x32_bf16 v[196:199], a[108:111], a[24:27], v[196:199]
ds_read_b64_tr_b16 a[100:101], v12 offset:8192
v_accvgpr_read_b32 v3, a247
v_cvt_pk_bf16_f32 v2, v2, v3
v_mfma_f32_16x16x32_bf16 v[188:191], a[108:111], a[20:23], 0
ds_read_b64_tr_b16 a[102:103], v12 offset:9216
v_accvgpr_write_b32 a243, v2
v_mfma_f32_16x16x32_bf16 v[188:191], a[104:107], a[0:3], v[188:191]
s_add_u32 m0, s17, 0x10400
s_waitcnt lgkmcnt(4)
v_accvgpr_read_b32 v2, a248
v_mfma_f32_16x16x32_bf16 v[216:219], a[0:3], a[80:83], 0
buffer_load_dwordx4 v5, s[52:55], s13 offen lds
v_accvgpr_read_b32 v3, a249
v_mfma_f32_16x16x32_bf16 v[216:219], a[20:23], a[84:87], v[216:219]
ds_read_b64_tr_b16 a[104:105], v13 offset:0
v_cvt_pk_bf16_f32 v2, v2, v3
v_mfma_f32_16x16x32_bf16 v[224:227], a[24:27], a[84:87], 0
ds_read_b64_tr_b16 a[106:107], v13 offset:1024
v_accvgpr_write_b32 a248, v2
v_mfma_f32_16x16x32_bf16 v[224:227], a[4:7], a[80:83], v[224:227]
ds_read_b64_tr_b16 a[108:109], v13 offset:8192
v_accvgpr_read_b32 v2, a250
v_accvgpr_read_b32 v3, a251
v_mfma_f32_16x16x32_bf16 v[232:235], a[8:11], a[80:83], 0
ds_read_b64_tr_b16 a[110:111], v13 offset:9216
v_cvt_pk_bf16_f32 v2, v2, v3
v_mfma_f32_16x16x32_bf16 v[232:235], a[28:31], a[84:87], v[232:235]
s_add_u32 s8, s28, 0x2000
v_accvgpr_write_b32 a249, v2
v_accvgpr_read_b32 v2, a252
v_mfma_f32_16x16x32_bf16 v[240:243], a[32:35], a[84:87], 0
buffer_store_dwordx4 a[128:131], v16, s[88:91], s8 offen sc1
v_accvgpr_read_b32 v3, a253
v_mfma_f32_16x16x32_bf16 v[240:243], a[12:15], a[80:83], v[240:243]
v_cvt_pk_bf16_f32 v2, v2, v3
v_accvgpr_write_b32 a250, v2
v_mfma_f32_16x16x32_bf16 v[252:255], a[16:19], a[80:83], 0
v_accvgpr_read_b32 v2, a254
v_accvgpr_read_b32 v3, a255
v_mfma_f32_16x16x32_bf16 v[252:255], a[36:39], a[84:87], v[252:255]
v_cvt_pk_bf16_f32 v2, v2, v3
v_accvgpr_write_b32 a251, v2
v_mfma_f32_16x16x32_bf16 v[244:247], a[12:15], a[88:91], 0
ds_read_b64_tr_b16 a[80:81], v12 offset:256
v_mfma_f32_16x16x32_bf16 v[244:247], a[32:35], a[92:95], v[244:247]
ds_read_b64_tr_b16 a[82:83], v12 offset:1280
s_add_u32 m0, s17, 0x10800
v_mfma_f32_16x16x32_bf16 v[236:239], a[28:31], a[92:95], 0
buffer_load_dwordx4 v6, s[52:55], 0 offen lds
v_mfma_f32_16x16x32_bf16 v[236:239], a[8:11], a[88:91], v[236:239]
ds_read_b64_tr_b16 a[84:85], v12 offset:8448
v_mfma_f32_16x16x32_bf16 v[228:231], a[4:7], a[88:91], 0
ds_read_b64_tr_b16 a[86:87], v12 offset:9472
v_mfma_f32_16x16x32_bf16 v[228:231], a[24:27], a[92:95], v[228:231]
v_mfma_f32_16x16x32_bf16 v[220:223], a[20:23], a[92:95], 0
v_mfma_f32_16x16x32_bf16 v[220:223], a[0:3], a[88:91], v[220:223]
s_add_u32 m0, s17, 0x10c00
s_waitcnt lgkmcnt(4)
L_S9:
v_mfma_f32_16x16x32_bf16 v[24:27], a[96:99], a[40:43], v[24:27]
buffer_load_dwordx4 v6, s[52:55], s13 offen lds
v_mfma_f32_16x16x32_bf16 v[24:27], a[100:103], a[60:63], v[24:27]
ds_read_b64_tr_b16 a[88:89], v13 offset:256
s_waitcnt vmcnt(21)
v_mfma_f32_16x16x32_bf16 v[32:35], a[100:103], a[64:67], v[32:35]
ds_read_b64_tr_b16 a[90:91], v13 offset:1280
v_mfma_f32_16x16x32_bf16 v[32:35], a[96:99], a[44:47], v[32:35]
ds_read_b64_tr_b16 a[92:93], v13 offset:8448
v_mfma_f32_16x16x32_bf16 v[40:43], a[96:99], a[48:51], v[40:43]
ds_read_b64_tr_b16 a[94:95], v13 offset:9472
v_mfma_f32_16x16x32_bf16 v[40:43], a[100:103], a[68:71], v[40:43]
ds_read_b128 a[0:3], v8 offset:0
s_add_u32 m0, s18, 0x14000
v_mfma_f32_16x16x32_bf16 v[48:51], a[100:103], a[72:75], v[48:51]
buffer_load_dwordx4 v7, s[68:71], 0 offen lds
v_mfma_f32_16x16x32_bf16 v[48:51], a[96:99], a[52:55], v[48:51]
ds_read_b128 a[20:23], v9 offset:0
v_mfma_f32_16x16x32_bf16 v[52:55], a[104:107], a[52:55], v[52:55]
ds_read_b64_tr_b16 a[96:97], v12 offset:512
v_mfma_f32_16x16x32_bf16 v[52:55], a[108:111], a[72:75], v[52:55]
ds_read_b64_tr_b16 a[98:99], v12 offset:1536
v_mfma_f32_16x16x32_bf16 v[44:47], a[108:111], a[68:71], v[44:47]
ds_read_b64_tr_b16 a[100:101], v12 offset:8704
v_mfma_f32_16x16x32_bf16 v[44:47], a[104:107], a[48:51], v[44:47]
ds_read_b64_tr_b16 a[102:103], v12 offset:9728
s_add_u32 s8, s28, 0x3000
v_mfma_f32_16x16x32_bf16 v[36:39], a[104:107], a[44:47], v[36:39]
buffer_store_dwordx4 a[132:135], v16, s[88:91], s8 offen sc1
v_mfma_f32_16x16x32_bf16 v[36:39], a[108:111], a[64:67], v[36:39]
ds_read_b128 a[4:7], v8 offset:2048
v_mfma_f32_16x16x32_bf16 v[28:31], a[108:111], a[60:63], v[28:31]
ds_read_b128 a[24:27], v9 offset:2048
v_mfma_f32_16x16x32_bf16 v[28:31], a[104:107], a[40:43], v[28:31]
ds_read_b128 a[8:11], v8 offset:4096
s_waitcnt lgkmcnt(9)
v_mfma_f32_16x16x32_bf16 v[56:59], a[80:83], a[40:43], v[56:59]
ds_read_b64_tr_b16 a[104:105], v13 offset:512
v_mfma_f32_16x16x32_bf16 v[56:59], a[84:87], a[60:63], v[56:59]
ds_read_b64_tr_b16 a[106:107], v13 offset:1536
s_add_u32 m0, s18, 0x15000
v_mfma_f32_16x16x32_bf16 v[64:67], a[84:87], a[64:67], v[64:67]
buffer_load_dwordx4 v7, s[68:71], s25 offen lds
v_mfma_f32_16x16x32_bf16 v[64:67], a[80:83], a[44:47], v[64:67]
ds_read_b64_tr_b16 a[108:109], v13 offset:8704
v_mfma_f32_16x16x32_bf16 v[72:75], a[80:83], a[48:51], v[72:75]
ds_read_b64_tr_b16 a[110:111], v13 offset:9728
v_mfma_f32_16x16x32_bf16 v[72:75], a[84:87], a[68:71], v[72:75]
ds_read_b128 a[28:31], v9 offset:4096
v_mfma_f32_16x16x32_bf16 v[80:83], a[84:87], a[72:75], v[80:83]
ds_read_b128 a[12:15], v8 offset:6144
v_mfma_f32_16x16x32_bf16 v[80:83], a[80:83], a[52:55], v[80:83]
ds_read_b128 a[32:35], v9 offset:6144
s_add_u32 m0, s18, 0x16000
v_mfma_f32_16x16x32_bf16 v[84:87], a[88:91], a[52:55], v[84:87]
buffer_load_dwordx4 v7, s[68:71], s26 offen lds
v_mfma_f32_16x16x32_bf16 v[84:87], a[92:95], a[72:75], v[84:87]
ds_read_b64_tr_b16 a[80:81], v12 offset:768
v_mfma_f32_16x16x32_bf16 v[76:79], a[92:95], a[68:71], v[76:79]
ds_read_b64_tr_b16 a[82:83], v12 offset:1792
v_mfma_f32_16x16x32_bf16 v[76:79], a[88:91], a[48:51], v[76:79]
ds_read_b64_tr_b16 a[84:85], v12 offset:8960
v_mfma_f32_16x16x32_bf16 v[68:71], a[88:91], a[44:47], v[68:71]
ds_read_b64_tr_b16 a[86:87], v12 offset:9984
s_waitcnt lgkmcnt(7)
v_mfma_f32_16x16x32_bf16 v[68:71], a[92:95], a[64:67], v[68:71]
ds_read_b128 a[56:59], v10
s_add_u32 m0, s18, 0x17000
v_mfma_f32_16x16x32_bf16 v[60:63], a[92:95], a[60:63], v[60:63]
buffer_load_dwordx4 v4, s[44:47], s24 offen lds
v_mfma_f32_16x16x32_bf16 v[60:63], a[88:91], a[40:43], v[60:63]
ds_read_b128 a[76:79], v11
v_add_u32 v5, 0x80000, v5
v_mfma_f32_16x16x32_bf16 v[88:91], a[96:99], a[40:43], v[88:91]
ds_read_b64_tr_b16 a[88:89], v13 offset:768
v_add_u32 v6, 0x80000, v6
v_mfma_f32_16x16x32_bf16 v[88:91], a[100:103], a[60:63], v[88:91]
ds_read_b64_tr_b16 a[90:91], v13 offset:1792
v_add_u32 v7, 0x60000, v7
v_mfma_f32_16x16x32_bf16 v[96:99], a[100:103], a[64:67], v[96:99]
ds_read_b64_tr_b16 a[92:93], v13 offset:8960
v_add_u32 v4, 0x80, v4
v_mfma_f32_16x16x32_bf16 v[96:99], a[96:99], a[44:47], v[96:99]
ds_read_b64_tr_b16 a[94:95], v13 offset:9984
s_add_u32 s8, s28, 0x6000
v_mfma_f32_16x16x32_bf16 v[104:107], a[96:99], a[48:51], v[104:107]
buffer_store_dwordx4 a[136:139], v16, s[88:91], s8 offen sc1
v_mfma_f32_16x16x32_bf16 v[104:107], a[100:103], a[68:71], v[104:107]
v_mfma_f32_16x16x32_bf16 v[112:115], a[100:103], a[72:75], v[112:115]
v_mfma_f32_16x16x32_bf16 v[112:115], a[96:99], a[52:55], v[112:115]
v_mfma_f32_16x16x32_bf16 v[116:119], a[104:107], a[52:55], v[116:119]
ds_read_b64_tr_b16 a[96:97], v14 offset:0
s_waitcnt lgkmcnt(11)
v_mfma_f32_16x16x32_bf16 v[116:119], a[108:111], a[72:75], v[116:119]
ds_read_b64_tr_b16 a[98:99], v14 offset:256
s_add_u32 m0, s16, 0x0
v_mfma_f32_16x16x32_bf16 v[108:111], a[108:111], a[68:71], v[108:111]
buffer_load_dwordx4 v22, s[44:47], s20 offen lds
v_mfma_f32_16x16x32_bf16 v[108:111], a[104:107], a[48:51], v[108:111]
ds_read_b64_tr_b16 a[100:101], v14 offset:2048
v_mfma_f32_16x16x32_bf16 v[100:103], a[104:107], a[44:47], v[100:103]
ds_read_b64_tr_b16 a[102:103], v14 offset:2304
v_mfma_f32_16x16x32_bf16 v[100:103], a[108:111], a[64:67], v[100:103]
v_mfma_f32_16x16x32_bf16 v[92:95], a[108:111], a[60:63], v[92:95]
v_mfma_f32_16x16x32_bf16 v[92:95], a[104:107], a[40:43], v[92:95]
s_add_u32 m0, s16, 0x400
s_waitcnt lgkmcnt(4)
v_mfma_f32_16x16x32_bf16 v[120:123], a[80:83], a[40:43], v[120:123]
buffer_load_dwordx4 v23, s[44:47], s20 offen lds
v_mfma_f32_16x16x32_bf16 v[120:123], a[84:87], a[60:63], v[120:123]
ds_read_b64_tr_b16 a[104:105], v15 offset:0
v_mfma_f32_16x16x32_bf16 v[128:131], a[84:87], a[64:67], v[128:131]
ds_read_b64_tr_b16 a[106:107], v15 offset:256
v_mfma_f32_16x16x32_bf16 v[128:131], a[80:83], a[44:47], v[128:131]
ds_read_b64_tr_b16 a[108:109], v15 offset:2048
v_mfma_f32_16x16x32_bf16 v[136:139], a[80:83], a[48:51], v[136:139]
ds_read_b64_tr_b16 a[110:111], v15 offset:2304
v_mfma_f32_16x16x32_bf16 v[136:139], a[84:87], a[68:71], v[136:139]
s_add_u32 m0, s16, 0x800
v_mfma_f32_16x16x32_bf16 v[144:147], a[84:87], a[72:75], v[144:147]
buffer_load_dwordx4 v22, s[44:47], s21 offen lds
v_mfma_f32_16x16x32_bf16 v[144:147], a[80:83], a[52:55], v[144:147]
v_mfma_f32_16x16x32_bf16 v[148:151], a[88:91], a[52:55], v[148:151]
ds_read_b64_tr_b16 a[80:81], v14 offset:4096
v_mfma_f32_16x16x32_bf16 v[148:151], a[92:95], a[72:75], v[148:151]
ds_read_b64_tr_b16 a[82:83], v14 offset:4352
v_mfma_f32_16x16x32_bf16 v[140:143], a[92:95], a[68:71], v[140:143]
ds_read_b64_tr_b16 a[84:85], v14 offset:6144
v_mfma_f32_16x16x32_bf16 v[140:143], a[88:91], a[48:51], v[140:143]
ds_read_b64_tr_b16 a[86:87], v14 offset:6400
s_add_u32 m0, s16, 0xc00
v_mfma_f32_16x16x32_bf16 v[132:135], a[88:91], a[44:47], v[132:135]
buffer_load_dwordx4 v23, s[44:47], s21 offen lds
v_mfma_f32_16x16x32_bf16 v[132:135], a[92:95], a[64:67], v[132:135]
v_mfma_f32_16x16x32_bf16 v[124:127], a[92:95], a[60:63], v[124:127]
v_mfma_f32_16x16x32_bf16 v[124:127], a[88:91], a[40:43], v[124:127]
s_waitcnt lgkmcnt(4)
v_mfma_f32_16x16x32_bf16 v[152:155], a[96:99], a[40:43], v[152:155]
ds_read_b64_tr_b16 a[88:89], v15 offset:4096
v_mfma_f32_16x16x32_bf16 v[152:155], a[100:103], a[60:63], v[152:155]
ds_read_b64_tr_b16 a[90:91], v15 offset:4352
s_add_u32 m0, s16, 0x1000
v_mfma_f32_16x16x32_bf16 v[160:163], a[100:103], a[64:67], v[160:163]
buffer_load_dwordx4 v22, s[44:47], s22 offen lds
v_mfma_f32_16x16x32_bf16 v[160:163], a[96:99], a[44:47], v[160:163]
ds_read_b64_tr_b16 a[92:93], v15 offset:6144
v_mfma_f32_16x16x32_bf16 v[168:171], a[96:99], a[48:51], v[168:171]
ds_read_b64_tr_b16 a[94:95], v15 offset:6400
v_mfma_f32_16x16x32_bf16 v[168:171], a[100:103], a[68:71], v[168:171]
v_mfma_f32_16x16x32_bf16 v[176:179], a[100:103], a[72:75], v[176:179]
v_mfma_f32_16x16x32_bf16 v[176:179], a[96:99], a[52:55], v[176:179]
s_add_u32 m0, s16, 0x1400
v_mfma_f32_16x16x32_bf16 v[180:183], a[104:107], a[52:55], v[180:183]
buffer_load_dwordx4 v23, s[44:47], s22 offen lds
v_mfma_f32_16x16x32_bf16 v[180:183], a[108:111], a[72:75], v[180:183]
ds_read_b64_tr_b16 a[96:97], v14 offset:8192
v_mfma_f32_16x16x32_bf16 v[172:175], a[108:111], a[68:71], v[172:175]
ds_read_b64_tr_b16 a[98:99], v14 offset:8448
v_mfma_f32_16x16x32_bf16 v[172:175], a[104:107], a[48:51], v[172:175]
ds_read_b64_tr_b16 a[100:101], v14 offset:10240
v_mfma_f32_16x16x32_bf16 v[164:167], a[104:107], a[44:47], v[164:167]
ds_read_b64_tr_b16 a[102:103], v14 offset:10496
v_mfma_f32_16x16x32_bf16 v[164:167], a[108:111], a[64:67], v[164:167]
s_add_u32 m0, s16, 0x1800
v_mfma_f32_16x16x32_bf16 v[156:159], a[108:111], a[60:63], v[156:159]
buffer_load_dwordx4 v22, s[44:47], s23 offen lds
v_mfma_f32_16x16x32_bf16 v[156:159], a[104:107], a[40:43], v[156:159]
s_waitcnt lgkmcnt(4)
v_mfma_f32_16x16x32_bf16 v[184:187], a[80:83], a[40:43], v[184:187]
ds_read_b64_tr_b16 a[104:105], v15 offset:8192
v_mfma_f32_16x16x32_bf16 v[184:187], a[84:87], a[60:63], v[184:187]
ds_read_b64_tr_b16 a[106:107], v15 offset:8448
v_mfma_f32_16x16x32_bf16 v[192:195], a[84:87], a[64:67], v[192:195]
ds_read_b64_tr_b16 a[108:109], v15 offset:10240
v_mfma_f32_16x16x32_bf16 v[192:195], a[80:83], a[44:47], v[192:195]
ds_read_b64_tr_b16 a[110:111], v15 offset:10496
s_add_u32 m0, s16, 0x1c00
v_mfma_f32_16x16x32_bf16 v[200:203], a[80:83], a[48:51], v[200:203]
buffer_load_dwordx4 v23, s[44:47], s23 offen lds
v_mfma_f32_16x16x32_bf16 v[200:203], a[84:87], a[68:71], v[200:203]
v_add_u32 v22, 0x80, v22
v_add_u32 v23, 0x80, v23
v_mfma_f32_16x16x32_bf16 v[208:211], a[84:87], a[72:75], v[208:211]
v_add_u32 v12, 0x8000, v12
v_add_u32 v13, 0x8000, v13
v_mfma_f32_16x16x32_bf16 v[208:211], a[80:83], a[52:55], v[208:211]
v_add_u32 v14, 0x8000, v14
v_add_u32 v15, 0x8000, v15
v_mfma_f32_16x16x32_bf16 v[248:251], a[80:83], a[56:59], v[248:251]
v_add_u32 v10, 0x8000, v10
v_add_u32 v11, 0x8000, v11
v_mfma_f32_16x16x32_bf16 v[248:251], a[84:87], a[76:79], v[248:251]
v_mfma_f32_16x16x32_bf16 v[212:215], a[88:91], a[52:55], v[212:215]
s_waitcnt vmcnt(27) lgkmcnt(0)
v_mfma_f32_16x16x32_bf16 v[212:215], a[92:95], a[72:75], v[212:215]
s_barrier
s_add_u32 m0, s17, 0x0
v_mfma_f32_16x16x32_bf16 v[204:207], a[92:95], a[68:71], v[204:207]
buffer_load_dwordx4 v5, s[52:55], 0 offen lds
v_mfma_f32_16x16x32_bf16 v[204:207], a[88:91], a[48:51], v[204:207]
ds_read_b64_tr_b16 a[80:81], v12 offset:0
v_mfma_f32_16x16x32_bf16 v[196:199], a[88:91], a[44:47], v[196:199]
ds_read_b64_tr_b16 a[82:83], v12 offset:1024
v_mfma_f32_16x16x32_bf16 v[196:199], a[92:95], a[64:67], v[196:199]
ds_read_b64_tr_b16 a[84:85], v12 offset:8192
s_waitcnt lgkmcnt(3)
v_mfma_f32_16x16x32_bf16 v[188:191], a[92:95], a[60:63], v[188:191]
ds_read_b64_tr_b16 a[86:87], v12 offset:9216
s_add_u32 m0, s17, 0x400
v_mfma_f32_16x16x32_bf16 v[188:191], a[88:91], a[40:43], v[188:191]
buffer_load_dwordx4 v5, s[52:55], s13 offen lds
v_mfma_f32_16x16x32_bf16 v[216:219], a[40:43], a[96:99], v[216:219]
ds_read_b64_tr_b16 a[88:89], v13 offset:0
v_mfma_f32_16x16x32_bf16 v[216:219], a[60:63], a[100:103], v[216:219]
ds_read_b64_tr_b16 a[90:91], v13 offset:1024
v_mfma_f32_16x16x32_bf16 v[224:227], a[64:67], a[100:103], v[224:227]
ds_read_b64_tr_b16 a[92:93], v13 offset:8192
v_mfma_f32_16x16x32_bf16 v[224:227], a[44:47], a[96:99], v[224:227]
ds_read_b64_tr_b16 a[94:95], v13 offset:9216
v_mfma_f32_16x16x32_bf16 v[232:235], a[48:51], a[96:99], v[232:235]
v_add_u32 v20, s0, v16
v_mov_b32 v21, s1
v_mfma_f32_16x16x32_bf16 v[232:235], a[68:71], a[100:103], v[232:235]
global_load_dword a120, v[20:21], off sc1
v_mfma_f32_16x16x32_bf16 v[240:243], a[72:75], a[100:103], v[240:243]
v_mfma_f32_16x16x32_bf16 v[240:243], a[52:55], a[96:99], v[240:243]
v_mfma_f32_16x16x32_bf16 v[252:255], a[56:59], a[96:99], v[252:255]
v_mfma_f32_16x16x32_bf16 v[252:255], a[76:79], a[100:103], v[252:255]
v_mfma_f32_16x16x32_bf16 v[244:247], a[52:55], a[104:107], v[244:247]
ds_read_b64_tr_b16 a[96:97], v12 offset:256
s_add_u32 m0, s17, 0x800
v_mfma_f32_16x16x32_bf16 v[244:247], a[72:75], a[108:111], v[244:247]
buffer_load_dwordx4 v6, s[52:55], 0 offen lds
v_mfma_f32_16x16x32_bf16 v[236:239], a[68:71], a[108:111], v[236:239]
ds_read_b64_tr_b16 a[98:99], v12 offset:1280
v_mfma_f32_16x16x32_bf16 v[236:239], a[48:51], a[104:107], v[236:239]
ds_read_b64_tr_b16 a[100:101], v12 offset:8448
v_mfma_f32_16x16x32_bf16 v[228:231], a[44:47], a[104:107], v[228:231]
ds_read_b64_tr_b16 a[102:103], v12 offset:9472
v_mfma_f32_16x16x32_bf16 v[228:231], a[64:67], a[108:111], v[228:231]
s_add_u32 m0, s17, 0xc00
v_mfma_f32_16x16x32_bf16 v[220:223], a[60:63], a[108:111], v[220:223]
buffer_load_dwordx4 v6, s[52:55], s13 offen lds
v_mfma_f32_16x16x32_bf16 v[220:223], a[40:43], a[104:107], v[220:223]
s_waitcnt lgkmcnt(4)
L_S10:
v_mfma_f32_16x16x32_bf16 v[24:27], a[80:83], a[0:3], v[24:27]
ds_read_b64_tr_b16 a[104:105], v13 offset:256
s_waitcnt vmcnt(24)
v_mfma_f32_16x16x32_bf16 v[24:27], a[84:87], a[20:23], v[24:27]
ds_read_b64_tr_b16 a[106:107], v13 offset:1280
v_mfma_f32_16x16x32_bf16 v[32:35], a[84:87], a[24:27], v[32:35]
ds_read_b64_tr_b16 a[108:109], v13 offset:8448
v_mfma_f32_16x16x32_bf16 v[32:35], a[80:83], a[4:7], v[32:35]
ds_read_b64_tr_b16 a[110:111], v13 offset:9472
s_add_u32 s8, s28, 0x7000
v_mfma_f32_16x16x32_bf16 v[40:43], a[80:83], a[8:11], v[40:43]
buffer_store_dwordx4 a[140:143], v16, s[88:91], s8 offen sc1
v_mfma_f32_16x16x32_bf16 v[40:43], a[84:87], a[28:31], v[40:43]
ds_read_b128 a[40:43], v8 offset:32768
v_mfma_f32_16x16x32_bf16 v[48:51], a[84:87], a[32:35], v[48:51]
ds_read_b128 a[60:63], v9 offset:32768
v_mfma_f32_16x16x32_bf16 v[48:51], a[80:83], a[12:15], v[48:51]
ds_read_b128 a[44:47], v8 offset:34816
v_mfma_f32_16x16x32_bf16 v[52:55], a[88:91], a[12:15], v[52:55]
ds_read_b64_tr_b16 a[80:81], v12 offset:512
v_mfma_f32_16x16x32_bf16 v[52:55], a[92:95], a[32:35], v[52:55]
ds_read_b64_tr_b16 a[82:83], v12 offset:1536
s_add_u32 m0, s18, 0x4000
v_mfma_f32_16x16x32_bf16 v[44:47], a[92:95], a[28:31], v[44:47]
buffer_load_dwordx4 v7, s[68:71], 0 offen lds
v_mfma_f32_16x16x32_bf16 v[44:47], a[88:91], a[8:11], v[44:47]
ds_read_b64_tr_b16 a[84:85], v12 offset:8704
v_mfma_f32_16x16x32_bf16 v[36:39], a[88:91], a[4:7], v[36:39]
ds_read_b64_tr_b16 a[86:87], v12 offset:9728
v_mfma_f32_16x16x32_bf16 v[36:39], a[92:95], a[24:27], v[36:39]
ds_read_b128 a[64:67], v9 offset:34816
s_waitcnt lgkmcnt(8)
v_mfma_f32_16x16x32_bf16 v[28:31], a[92:95], a[20:23], v[28:31]
ds_read_b128 a[48:51], v8 offset:36864
s_add_u32 m0, s18, 0x5000
v_mfma_f32_16x16x32_bf16 v[28:31], a[88:91], a[0:3], v[28:31]
buffer_load_dwordx4 v7, s[68:71], s25 offen lds
v_mfma_f32_16x16x32_bf16 v[56:59], a[96:99], a[0:3], v[56:59]
ds_read_b64_tr_b16 a[88:89], v13 offset:512
v_mfma_f32_16x16x32_bf16 v[56:59], a[100:103], a[20:23], v[56:59]
ds_read_b64_tr_b16 a[90:91], v13 offset:1536
v_mfma_f32_16x16x32_bf16 v[64:67], a[100:103], a[24:27], v[64:67]
ds_read_b64_tr_b16 a[92:93], v13 offset:8704
v_mfma_f32_16x16x32_bf16 v[64:67], a[96:99], a[4:7], v[64:67]
ds_read_b64_tr_b16 a[94:95], v13 offset:9728
v_mfma_f32_16x16x32_bf16 v[72:75], a[96:99], a[8:11], v[72:75]
ds_read_b128 a[68:71], v9 offset:36864
s_add_u32 s8, s28, 0x2400
v_mfma_f32_16x16x32_bf16 v[72:75], a[100:103], a[28:31], v[72:75]
buffer_store_dwordx4 a[144:147], v16, s[88:91], s8 offen sc1
v_mfma_f32_16x16x32_bf16 v[80:83], a[100:103], a[32:35], v[80:83]
ds_read_b128 a[52:55], v8 offset:38912
v_mfma_f32_16x16x32_bf16 v[80:83], a[96:99], a[12:15], v[80:83]
ds_read_b128 a[72:75], v9 offset:38912
v_mfma_f32_16x16x32_bf16 v[84:87], a[104:107], a[12:15], v[84:87]
ds_read_b64_tr_b16 a[96:97], v12 offset:768
v_mfma_f32_16x16x32_bf16 v[84:87], a[108:111], a[32:35], v[84:87]
ds_read_b64_tr_b16 a[98:99], v12 offset:1792
v_mfma_f32_16x16x32_bf16 v[76:79], a[108:111], a[28:31], v[76:79]
ds_read_b64_tr_b16 a[100:101], v12 offset:8960
s_add_u32 m0, s18, 0x6000
v_mfma_f32_16x16x32_bf16 v[76:79], a[104:107], a[8:11], v[76:79]
buffer_load_dwordx4 v7, s[68:71], s26 offen lds
v_mfma_f32_16x16x32_bf16 v[68:71], a[104:107], a[4:7], v[68:71]
ds_read_b64_tr_b16 a[102:103], v12 offset:9984
v_mfma_f32_16x16x32_bf16 v[68:71], a[108:111], a[24:27], v[68:71]
ds_read_b128 a[16:19], v10
v_mfma_f32_16x16x32_bf16 v[60:63], a[108:111], a[20:23], v[60:63]
ds_read_b128 a[36:39], v11
v_mfma_f32_16x16x32_bf16 v[60:63], a[104:107], a[0:3], v[60:63]
s_waitcnt lgkmcnt(9)
v_mfma_f32_16x16x32_bf16 v[88:91], a[80:83], a[0:3], v[88:91]
ds_read_b64_tr_b16 a[104:105], v13 offset:768
s_add_u32 m0, s18, 0x7000
v_mfma_f32_16x16x32_bf16 v[88:91], a[84:87], a[20:23], v[88:91]
buffer_load_dwordx4 v4, s[44:47], s24 offen lds
v_mfma_f32_16x16x32_bf16 v[96:99], a[84:87], a[24:27], v[96:99]
ds_read_b64_tr_b16 a[106:107], v13 offset:1792
v_add_u32 v5, 0x80000, v5
v_mfma_f32_16x16x32_bf16 v[96:99], a[80:83], a[4:7], v[96:99]
ds_read_b64_tr_b16 a[108:109], v13 offset:8960
v_add_u32 v6, 0x80000, v6
v_mfma_f32_16x16x32_bf16 v[104:107], a[80:83], a[8:11], v[104:107]
ds_read_b64_tr_b16 a[110:111], v13 offset:9984
v_add_u32 v7, 0x60000, v7
v_mfma_f32_16x16x32_bf16 v[104:107], a[84:87], a[28:31], v[104:107]
s_add_u32 s8, s28, 0x3400
v_add_u32 v4, 0x80, v4
v_mfma_f32_16x16x32_bf16 v[112:115], a[84:87], a[32:35], v[112:115]
buffer_store_dwordx4 a[148:151], v16, s[88:91], s8 offen sc1
v_mfma_f32_16x16x32_bf16 v[112:115], a[80:83], a[12:15], v[112:115]
v_mfma_f32_16x16x32_bf16 v[116:119], a[88:91], a[12:15], v[116:119]
ds_read_b64_tr_b16 a[80:81], v14 offset:0
v_mfma_f32_16x16x32_bf16 v[116:119], a[92:95], a[32:35], v[116:119]
ds_read_b64_tr_b16 a[82:83], v14 offset:256
v_mfma_f32_16x16x32_bf16 v[108:111], a[92:95], a[28:31], v[108:111]
ds_read_b64_tr_b16 a[84:85], v14 offset:2048
s_waitcnt lgkmcnt(13)
v_mfma_f32_16x16x32_bf16 v[108:111], a[88:91], a[8:11], v[108:111]
ds_read_b64_tr_b16 a[86:87], v14 offset:2304
s_add_u32 m0, s16, 0x8000
v_mfma_f32_16x16x32_bf16 v[100:103], a[88:91], a[4:7], v[100:103]
buffer_load_dwordx4 v22, s[44:47], s20 offen lds
v_mfma_f32_16x16x32_bf16 v[100:103], a[92:95], a[24:27], v[100:103]
v_mfma_f32_16x16x32_bf16 v[92:95], a[92:95], a[20:23], v[92:95]
v_mfma_f32_16x16x32_bf16 v[92:95], a[88:91], a[0:3], v[92:95]
s_waitcnt lgkmcnt(4)
v_mfma_f32_16x16x32_bf16 v[120:123], a[96:99], a[0:3], v[120:123]
ds_read_b64_tr_b16 a[88:89], v15 offset:0
v_mfma_f32_16x16x32_bf16 v[120:123], a[100:103], a[20:23], v[120:123]
ds_read_b64_tr_b16 a[90:91], v15 offset:256
s_add_u32 m0, s16, 0x8400
v_mfma_f32_16x16x32_bf16 v[128:131], a[100:103], a[24:27], v[128:131]
buffer_load_dwordx4 v23, s[44:47], s20 offen lds
v_mfma_f32_16x16x32_bf16 v[128:131], a[96:99], a[4:7], v[128:131]
ds_read_b64_tr_b16 a[92:93], v15 offset:2048
v_mfma_f32_16x16x32_bf16 v[136:139], a[96:99], a[8:11], v[136:139]
ds_read_b64_tr_b16 a[94:95], v15 offset:2304
v_mfma_f32_16x16x32_bf16 v[136:139], a[100:103], a[28:31], v[136:139]
v_mfma_f32_16x16x32_bf16 v[144:147], a[100:103], a[32:35], v[144:147]
s_add_u32 m0, s16, 0x8800
v_mfma_f32_16x16x32_bf16 v[144:147], a[96:99], a[12:15], v[144:147]
buffer_load_dwordx4 v22, s[44:47], s21 offen lds
v_mfma_f32_16x16x32_bf16 v[148:151], a[104:107], a[12:15], v[148:151]
ds_read_b64_tr_b16 a[96:97], v14 offset:4096
v_mfma_f32_16x16x32_bf16 v[148:151], a[108:111], a[32:35], v[148:151]
ds_read_b64_tr_b16 a[98:99], v14 offset:4352
v_mfma_f32_16x16x32_bf16 v[140:143], a[108:111], a[28:31], v[140:143]
ds_read_b64_tr_b16 a[100:101], v14 offset:6144
v_mfma_f32_16x16x32_bf16 v[140:143], a[104:107], a[8:11], v[140:143]
ds_read_b64_tr_b16 a[102:103], v14 offset:6400
v_mfma_f32_16x16x32_bf16 v[132:135], a[104:107], a[4:7], v[132:135]
s_add_u32 m0, s16, 0x8c00
v_mfma_f32_16x16x32_bf16 v[132:135], a[108:111], a[24:27], v[132:135]
buffer_load_dwordx4 v23, s[44:47], s21 offen lds
v_mfma_f32_16x16x32_bf16 v[124:127], a[108:111], a[20:23], v[124:127]
v_mfma_f32_16x16x32_bf16 v[124:127], a[104:107], a[0:3], v[124:127]
s_waitcnt lgkmcnt(4)
v_mfma_f32_16x16x32_bf16 v[152:155], a[80:83], a[0:3], v[152:155]
ds_read_b64_tr_b16 a[104:105], v15 offset:4096
v_mfma_f32_16x16x32_bf16 v[152:155], a[84:87], a[20:23], v[152:155]
ds_read_b64_tr_b16 a[106:107], v15 offset:4352
v_mfma_f32_16x16x32_bf16 v[160:163], a[84:87], a[24:27], v[160:163]
ds_read_b64_tr_b16 a[108:109], v15 offset:6144
s_add_u32 m0, s16, 0x9000
v_mfma_f32_16x16x32_bf16 v[160:163], a[80:83], a[4:7], v[160:163]
buffer_load_dwordx4 v22, s[44:47], s22 offen lds
v_mfma_f32_16x16x32_bf16 v[168:171], a[80:83], a[8:11], v[168:171]
ds_read_b64_tr_b16 a[110:111], v15 offset:6400
v_mfma_f32_16x16x32_bf16 v[168:171], a[84:87], a[28:31], v[168:171]
v_mfma_f32_16x16x32_bf16 v[176:179], a[84:87], a[32:35], v[176:179]
v_mfma_f32_16x16x32_bf16 v[176:179], a[80:83], a[12:15], v[176:179]
s_add_u32 m0, s16, 0x9400
v_mfma_f32_16x16x32_bf16 v[180:183], a[88:91], a[12:15], v[180:183]
buffer_load_dwordx4 v23, s[44:47], s22 offen lds
v_mfma_f32_16x16x32_bf16 v[180:183], a[92:95], a[32:35], v[180:183]
ds_read_b64_tr_b16 a[80:81], v14 offset:8192
v_mfma_f32_16x16x32_bf16 v[172:175], a[92:95], a[28:31], v[172:175]
ds_read_b64_tr_b16 a[82:83], v14 offset:8448
v_mfma_f32_16x16x32_bf16 v[172:175], a[88:91], a[8:11], v[172:175]
ds_read_b64_tr_b16 a[84:85], v14 offset:10240
v_mfma_f32_16x16x32_bf16 v[164:167], a[88:91], a[4:7], v[164:167]
ds_read_b64_tr_b16 a[86:87], v14 offset:10496
v_mfma_f32_16x16x32_bf16 v[164:167], a[92:95], a[24:27], v[164:167]
s_add_u32 m0, s16, 0x9800
v_mfma_f32_16x16x32_bf16 v[156:159], a[92:95], a[20:23], v[156:159]
buffer_load_dwordx4 v22, s[44:47], s23 offen lds
v_mfma_f32_16x16x32_bf16 v[156:159], a[88:91], a[0:3], v[156:159]
s_waitcnt lgkmcnt(4)
v_mfma_f32_16x16x32_bf16 v[184:187], a[96:99], a[0:3], v[184:187]
ds_read_b64_tr_b16 a[88:89], v15 offset:8192
v_mfma_f32_16x16x32_bf16 v[184:187], a[100:103], a[20:23], v[184:187]
ds_read_b64_tr_b16 a[90:91], v15 offset:8448
v_mfma_f32_16x16x32_bf16 v[192:195], a[100:103], a[24:27], v[192:195]
ds_read_b64_tr_b16 a[92:93], v15 offset:10240
v_mfma_f32_16x16x32_bf16 v[192:195], a[96:99], a[4:7], v[192:195]
ds_read_b64_tr_b16 a[94:95], v15 offset:10496
s_add_u32 m0, s16, 0x9c00
v_mfma_f32_16x16x32_bf16 v[200:203], a[96:99], a[8:11], v[200:203]
buffer_load_dwordx4 v23, s[44:47], s23 offen lds
v_mfma_f32_16x16x32_bf16 v[200:203], a[100:103], a[28:31], v[200:203]
v_add_u32 v22, 0x80, v22
v_add_u32 v23, 0x80, v23
v_mfma_f32_16x16x32_bf16 v[208:211], a[100:103], a[32:35], v[208:211]
v_add_u32 v12, 0x8000, v12
v_add_u32 v13, 0x8000, v13
v_mfma_f32_16x16x32_bf16 v[208:211], a[96:99], a[12:15], v[208:211]
v_add_u32 v14, 0x8000, v14
v_add_u32 v15, 0x8000, v15
v_mfma_f32_16x16x32_bf16 v[248:251], a[96:99], a[16:19], v[248:251]
v_add_u32 v10, 0x8000, v10
v_add_u32 v11, 0x8000, v11
v_mfma_f32_16x16x32_bf16 v[248:251], a[100:103], a[36:39], v[248:251]
v_mfma_f32_16x16x32_bf16 v[212:215], a[104:107], a[12:15], v[212:215]
s_waitcnt vmcnt(29) lgkmcnt(0)
v_mfma_f32_16x16x32_bf16 v[212:215], a[108:111], a[32:35], v[212:215]
s_barrier
s_add_u32 m0, s17, 0x8000
v_mfma_f32_16x16x32_bf16 v[204:207], a[108:111], a[28:31], v[204:207]
buffer_load_dwordx4 v5, s[52:55], 0 offen lds
v_mfma_f32_16x16x32_bf16 v[204:207], a[104:107], a[8:11], v[204:207]
ds_read_b64_tr_b16 a[96:97], v12 offset:0
v_mfma_f32_16x16x32_bf16 v[196:199], a[104:107], a[4:7], v[196:199]
ds_read_b64_tr_b16 a[98:99], v12 offset:1024
v_mfma_f32_16x16x32_bf16 v[196:199], a[108:111], a[24:27], v[196:199]
ds_read_b64_tr_b16 a[100:101], v12 offset:8192
v_mfma_f32_16x16x32_bf16 v[188:191], a[108:111], a[20:23], v[188:191]
ds_read_b64_tr_b16 a[102:103], v12 offset:9216
v_mfma_f32_16x16x32_bf16 v[188:191], a[104:107], a[0:3], v[188:191]
s_add_u32 m0, s17, 0x8400
s_waitcnt lgkmcnt(4)
v_mfma_f32_16x16x32_bf16 v[216:219], a[0:3], a[80:83], v[216:219]
buffer_load_dwordx4 v5, s[52:55], s13 offen lds
v_mfma_f32_16x16x32_bf16 v[216:219], a[20:23], a[84:87], v[216:219]
ds_read_b64_tr_b16 a[104:105], v13 offset:0
v_mfma_f32_16x16x32_bf16 v[224:227], a[24:27], a[84:87], v[224:227]
ds_read_b64_tr_b16 a[106:107], v13 offset:1024
v_mfma_f32_16x16x32_bf16 v[224:227], a[4:7], a[80:83], v[224:227]
ds_read_b64_tr_b16 a[108:109], v13 offset:8192
v_mfma_f32_16x16x32_bf16 v[232:235], a[8:11], a[80:83], v[232:235]
ds_read_b64_tr_b16 a[110:111], v13 offset:9216
v_mfma_f32_16x16x32_bf16 v[232:235], a[28:31], a[84:87], v[232:235]
s_add_u32 s8, s28, 0x6400
v_mfma_f32_16x16x32_bf16 v[240:243], a[32:35], a[84:87], v[240:243]
buffer_store_dwordx4 a[152:155], v16, s[88:91], s8 offen sc1
v_mfma_f32_16x16x32_bf16 v[240:243], a[12:15], a[80:83], v[240:243]
v_mfma_f32_16x16x32_bf16 v[252:255], a[16:19], a[80:83], v[252:255]
v_mfma_f32_16x16x32_bf16 v[252:255], a[36:39], a[84:87], v[252:255]
v_mfma_f32_16x16x32_bf16 v[244:247], a[12:15], a[88:91], v[244:247]
ds_read_b64_tr_b16 a[80:81], v12 offset:256
v_mfma_f32_16x16x32_bf16 v[244:247], a[32:35], a[92:95], v[244:247]
ds_read_b64_tr_b16 a[82:83], v12 offset:1280
s_add_u32 m0, s17, 0x8800
v_mfma_f32_16x16x32_bf16 v[236:239], a[28:31], a[92:95], v[236:239]
buffer_load_dwordx4 v6, s[52:55], 0 offen lds
v_mfma_f32_16x16x32_bf16 v[236:239], a[8:11], a[88:91], v[236:239]
ds_read_b64_tr_b16 a[84:85], v12 offset:8448
v_mfma_f32_16x16x32_bf16 v[228:231], a[4:7], a[88:91], v[228:231]
ds_read_b64_tr_b16 a[86:87], v12 offset:9472
v_mfma_f32_16x16x32_bf16 v[228:231], a[24:27], a[92:95], v[228:231]
v_mfma_f32_16x16x32_bf16 v[220:223], a[20:23], a[92:95], v[220:223]
v_mfma_f32_16x16x32_bf16 v[220:223], a[0:3], a[88:91], v[220:223]
s_add_u32 m0, s17, 0x8c00
s_waitcnt lgkmcnt(4)
L_S11:
v_mfma_f32_16x16x32_bf16 v[24:27], a[96:99], a[40:43], v[24:27]
buffer_load_dwordx4 v6, s[52:55], s13 offen lds
v_mfma_f32_16x16x32_bf16 v[24:27], a[100:103], a[60:63], v[24:27]
ds_read_b64_tr_b16 a[88:89], v13 offset:256
s_waitcnt vmcnt(25)
v_mfma_f32_16x16x32_bf16 v[32:35], a[100:103], a[64:67], v[32:35]
ds_read_b64_tr_b16 a[90:91], v13 offset:1280
v_mfma_f32_16x16x32_bf16 v[32:35], a[96:99], a[44:47], v[32:35]
ds_read_b64_tr_b16 a[92:93], v13 offset:8448
v_mfma_f32_16x16x32_bf16 v[40:43], a[96:99], a[48:51], v[40:43]
ds_read_b64_tr_b16 a[94:95], v13 offset:9472
v_mfma_f32_16x16x32_bf16 v[40:43], a[100:103], a[68:71], v[40:43]
ds_read_b128 a[0:3], v8 offset:0
s_add_u32 m0, s18, 0xc000
v_mfma_f32_16x16x32_bf16 v[48:51], a[100:103], a[72:75], v[48:51]
buffer_load_dwordx4 v7, s[68:71], 0 offen lds
v_mfma_f32_16x16x32_bf16 v[48:51], a[96:99], a[52:55], v[48:51]
ds_read_b128 a[20:23], v9 offset:0
v_mfma_f32_16x16x32_bf16 v[52:55], a[104:107], a[52:55], v[52:55]
ds_read_b64_tr_b16 a[96:97], v12 offset:512
v_mfma_f32_16x16x32_bf16 v[52:55], a[108:111], a[72:75], v[52:55]
ds_read_b64_tr_b16 a[98:99], v12 offset:1536
v_mfma_f32_16x16x32_bf16 v[44:47], a[108:111], a[68:71], v[44:47]
ds_read_b64_tr_b16 a[100:101], v12 offset:8704
v_mfma_f32_16x16x32_bf16 v[44:47], a[104:107], a[48:51], v[44:47]
ds_read_b64_tr_b16 a[102:103], v12 offset:9728
s_add_u32 s8, s28, 0x7400
v_mfma_f32_16x16x32_bf16 v[36:39], a[104:107], a[44:47], v[36:39]
buffer_store_dwordx4 a[156:159], v16, s[88:91], s8 offen sc1
v_mfma_f32_16x16x32_bf16 v[36:39], a[108:111], a[64:67], v[36:39]
ds_read_b128 a[4:7], v8 offset:2048
v_mfma_f32_16x16x32_bf16 v[28:31], a[108:111], a[60:63], v[28:31]
ds_read_b128 a[24:27], v9 offset:2048
v_mfma_f32_16x16x32_bf16 v[28:31], a[104:107], a[40:43], v[28:31]
ds_read_b128 a[8:11], v8 offset:4096
s_waitcnt lgkmcnt(9)
v_mfma_f32_16x16x32_bf16 v[56:59], a[80:83], a[40:43], v[56:59]
ds_read_b64_tr_b16 a[104:105], v13 offset:512
v_mfma_f32_16x16x32_bf16 v[56:59], a[84:87], a[60:63], v[56:59]
ds_read_b64_tr_b16 a[106:107], v13 offset:1536
s_add_u32 m0, s18, 0xd000
v_mfma_f32_16x16x32_bf16 v[64:67], a[84:87], a[64:67], v[64:67]
buffer_load_dwordx4 v7, s[68:71], s25 offen lds
v_mfma_f32_16x16x32_bf16 v[64:67], a[80:83], a[44:47], v[64:67]
ds_read_b64_tr_b16 a[108:109], v13 offset:8704
v_mfma_f32_16x16x32_bf16 v[72:75], a[80:83], a[48:51], v[72:75]
ds_read_b64_tr_b16 a[110:111], v13 offset:9728
v_mfma_f32_16x16x32_bf16 v[72:75], a[84:87], a[68:71], v[72:75]
ds_read_b128 a[28:31], v9 offset:4096
v_mfma_f32_16x16x32_bf16 v[80:83], a[84:87], a[72:75], v[80:83]
ds_read_b128 a[12:15], v8 offset:6144
v_mfma_f32_16x16x32_bf16 v[80:83], a[80:83], a[52:55], v[80:83]
ds_read_b128 a[32:35], v9 offset:6144
s_add_u32 m0, s18, 0xe000
v_mfma_f32_16x16x32_bf16 v[84:87], a[88:91], a[52:55], v[84:87]
buffer_load_dwordx4 v7, s[68:71], s26 offen lds
v_mfma_f32_16x16x32_bf16 v[84:87], a[92:95], a[72:75], v[84:87]
ds_read_b64_tr_b16 a[80:81], v12 offset:768
v_mfma_f32_16x16x32_bf16 v[76:79], a[92:95], a[68:71], v[76:79]
ds_read_b64_tr_b16 a[82:83], v12 offset:1792
v_mfma_f32_16x16x32_bf16 v[76:79], a[88:91], a[48:51], v[76:79]
ds_read_b64_tr_b16 a[84:85], v12 offset:8960
v_mfma_f32_16x16x32_bf16 v[68:71], a[88:91], a[44:47], v[68:71]
ds_read_b64_tr_b16 a[86:87], v12 offset:9984
s_waitcnt lgkmcnt(7)
v_mfma_f32_16x16x32_bf16 v[68:71], a[92:95], a[64:67], v[68:71]
ds_read_b128 a[56:59], v10
s_add_u32 m0, s18, 0xf000
v_mfma_f32_16x16x32_bf16 v[60:63], a[92:95], a[60:63], v[60:63]
buffer_load_dwordx4 v4, s[44:47], s24 offen lds
v_mfma_f32_16x16x32_bf16 v[60:63], a[88:91], a[40:43], v[60:63]
ds_read_b128 a[76:79], v11
v_add_u32 v5, 0x80000, v5
v_mfma_f32_16x16x32_bf16 v[88:91], a[96:99], a[40:43], v[88:91]
ds_read_b64_tr_b16 a[88:89], v13 offset:768
v_add_u32 v6, 0x80000, v6
v_mfma_f32_16x16x32_bf16 v[88:91], a[100:103], a[60:63], v[88:91]
ds_read_b64_tr_b16 a[90:91], v13 offset:1792
v_add_u32 v7, 0x60000, v7
v_mfma_f32_16x16x32_bf16 v[96:99], a[100:103], a[64:67], v[96:99]
ds_read_b64_tr_b16 a[92:93], v13 offset:8960
v_add_u32 v4, 0x80, v4
v_mfma_f32_16x16x32_bf16 v[96:99], a[96:99], a[44:47], v[96:99]
ds_read_b64_tr_b16 a[94:95], v13 offset:9984
s_add_u32 s8, s28, 0x2800
v_mfma_f32_16x16x32_bf16 v[104:107], a[96:99], a[48:51], v[104:107]
buffer_store_dwordx4 a[160:163], v16, s[88:91], s8 offen sc1
v_mfma_f32_16x16x32_bf16 v[104:107], a[100:103], a[68:71], v[104:107]
v_mfma_f32_16x16x32_bf16 v[112:115], a[100:103], a[72:75], v[112:115]
v_mfma_f32_16x16x32_bf16 v[112:115], a[96:99], a[52:55], v[112:115]
v_mfma_f32_16x16x32_bf16 v[116:119], a[104:107], a[52:55], v[116:119]
ds_read_b64_tr_b16 a[96:97], v14 offset:0
s_waitcnt lgkmcnt(11)
v_mfma_f32_16x16x32_bf16 v[116:119], a[108:111], a[72:75], v[116:119]
ds_read_b64_tr_b16 a[98:99], v14 offset:256
s_add_u32 m0, s16, 0x0
v_mfma_f32_16x16x32_bf16 v[108:111], a[108:111], a[68:71], v[108:111]
buffer_load_dwordx4 v22, s[44:47], s20 offen lds
v_mfma_f32_16x16x32_bf16 v[108:111], a[104:107], a[48:51], v[108:111]
ds_read_b64_tr_b16 a[100:101], v14 offset:2048
v_mfma_f32_16x16x32_bf16 v[100:103], a[104:107], a[44:47], v[100:103]
ds_read_b64_tr_b16 a[102:103], v14 offset:2304
v_mfma_f32_16x16x32_bf16 v[100:103], a[108:111], a[64:67], v[100:103]
v_mfma_f32_16x16x32_bf16 v[92:95], a[108:111], a[60:63], v[92:95]
v_mfma_f32_16x16x32_bf16 v[92:95], a[104:107], a[40:43], v[92:95]
s_add_u32 m0, s16, 0x400
s_waitcnt lgkmcnt(4)
v_mfma_f32_16x16x32_bf16 v[120:123], a[80:83], a[40:43], v[120:123]
buffer_load_dwordx4 v23, s[44:47], s20 offen lds
v_mfma_f32_16x16x32_bf16 v[120:123], a[84:87], a[60:63], v[120:123]
ds_read_b64_tr_b16 a[104:105], v15 offset:0
v_mfma_f32_16x16x32_bf16 v[128:131], a[84:87], a[64:67], v[128:131]
ds_read_b64_tr_b16 a[106:107], v15 offset:256
v_mfma_f32_16x16x32_bf16 v[128:131], a[80:83], a[44:47], v[128:131]
ds_read_b64_tr_b16 a[108:109], v15 offset:2048
v_mfma_f32_16x16x32_bf16 v[136:139], a[80:83], a[48:51], v[136:139]
ds_read_b64_tr_b16 a[110:111], v15 offset:2304
v_mfma_f32_16x16x32_bf16 v[136:139], a[84:87], a[68:71], v[136:139]
s_add_u32 m0, s16, 0x800
v_mfma_f32_16x16x32_bf16 v[144:147], a[84:87], a[72:75], v[144:147]
buffer_load_dwordx4 v22, s[44:47], s21 offen lds
v_mfma_f32_16x16x32_bf16 v[144:147], a[80:83], a[52:55], v[144:147]
v_mfma_f32_16x16x32_bf16 v[148:151], a[88:91], a[52:55], v[148:151]
ds_read_b64_tr_b16 a[80:81], v14 offset:4096
v_mfma_f32_16x16x32_bf16 v[148:151], a[92:95], a[72:75], v[148:151]
ds_read_b64_tr_b16 a[82:83], v14 offset:4352
v_mfma_f32_16x16x32_bf16 v[140:143], a[92:95], a[68:71], v[140:143]
ds_read_b64_tr_b16 a[84:85], v14 offset:6144
v_mfma_f32_16x16x32_bf16 v[140:143], a[88:91], a[48:51], v[140:143]
ds_read_b64_tr_b16 a[86:87], v14 offset:6400
s_add_u32 m0, s16, 0xc00
v_mfma_f32_16x16x32_bf16 v[132:135], a[88:91], a[44:47], v[132:135]
buffer_load_dwordx4 v23, s[44:47], s21 offen lds
v_mfma_f32_16x16x32_bf16 v[132:135], a[92:95], a[64:67], v[132:135]
v_mfma_f32_16x16x32_bf16 v[124:127], a[92:95], a[60:63], v[124:127]
v_mfma_f32_16x16x32_bf16 v[124:127], a[88:91], a[40:43], v[124:127]
s_waitcnt lgkmcnt(4)
v_mfma_f32_16x16x32_bf16 v[152:155], a[96:99], a[40:43], v[152:155]
ds_read_b64_tr_b16 a[88:89], v15 offset:4096
v_mfma_f32_16x16x32_bf16 v[152:155], a[100:103], a[60:63], v[152:155]
ds_read_b64_tr_b16 a[90:91], v15 offset:4352
s_add_u32 m0, s16, 0x1000
v_mfma_f32_16x16x32_bf16 v[160:163], a[100:103], a[64:67], v[160:163]
buffer_load_dwordx4 v22, s[44:47], s22 offen lds
v_mfma_f32_16x16x32_bf16 v[160:163], a[96:99], a[44:47], v[160:163]
ds_read_b64_tr_b16 a[92:93], v15 offset:6144
v_mfma_f32_16x16x32_bf16 v[168:171], a[96:99], a[48:51], v[168:171]
ds_read_b64_tr_b16 a[94:95], v15 offset:6400
v_mfma_f32_16x16x32_bf16 v[168:171], a[100:103], a[68:71], v[168:171]
v_mfma_f32_16x16x32_bf16 v[176:179], a[100:103], a[72:75], v[176:179]
v_mfma_f32_16x16x32_bf16 v[176:179], a[96:99], a[52:55], v[176:179]
s_add_u32 m0, s16, 0x1400
v_mfma_f32_16x16x32_bf16 v[180:183], a[104:107], a[52:55], v[180:183]
buffer_load_dwordx4 v23, s[44:47], s22 offen lds
v_mfma_f32_16x16x32_bf16 v[180:183], a[108:111], a[72:75], v[180:183]
ds_read_b64_tr_b16 a[96:97], v14 offset:8192
v_mfma_f32_16x16x32_bf16 v[172:175], a[108:111], a[68:71], v[172:175]
ds_read_b64_tr_b16 a[98:99], v14 offset:8448
v_mfma_f32_16x16x32_bf16 v[172:175], a[104:107], a[48:51], v[172:175]
ds_read_b64_tr_b16 a[100:101], v14 offset:10240
v_mfma_f32_16x16x32_bf16 v[164:167], a[104:107], a[44:47], v[164:167]
ds_read_b64_tr_b16 a[102:103], v14 offset:10496
v_mfma_f32_16x16x32_bf16 v[164:167], a[108:111], a[64:67], v[164:167]
s_add_u32 m0, s16, 0x1800
v_mfma_f32_16x16x32_bf16 v[156:159], a[108:111], a[60:63], v[156:159]
buffer_load_dwordx4 v22, s[44:47], s23 offen lds
v_mfma_f32_16x16x32_bf16 v[156:159], a[104:107], a[40:43], v[156:159]
s_waitcnt lgkmcnt(4)
v_mfma_f32_16x16x32_bf16 v[184:187], a[80:83], a[40:43], v[184:187]
ds_read_b64_tr_b16 a[104:105], v15 offset:8192
v_mfma_f32_16x16x32_bf16 v[184:187], a[84:87], a[60:63], v[184:187]
ds_read_b64_tr_b16 a[106:107], v15 offset:8448
v_mfma_f32_16x16x32_bf16 v[192:195], a[84:87], a[64:67], v[192:195]
ds_read_b64_tr_b16 a[108:109], v15 offset:10240
v_mfma_f32_16x16x32_bf16 v[192:195], a[80:83], a[44:47], v[192:195]
ds_read_b64_tr_b16 a[110:111], v15 offset:10496
s_add_u32 m0, s16, 0x1c00
v_mfma_f32_16x16x32_bf16 v[200:203], a[80:83], a[48:51], v[200:203]
buffer_load_dwordx4 v23, s[44:47], s23 offen lds
v_mfma_f32_16x16x32_bf16 v[200:203], a[84:87], a[68:71], v[200:203]
v_add_u32 v22, 0x80, v22
v_add_u32 v23, 0x80, v23
v_mfma_f32_16x16x32_bf16 v[208:211], a[84:87], a[72:75], v[208:211]
v_add_u32 v12, 0xffff0000, v12
v_add_u32 v13, 0xffff0000, v13
v_mfma_f32_16x16x32_bf16 v[208:211], a[80:83], a[52:55], v[208:211]
v_add_u32 v14, 0xffff0000, v14
v_add_u32 v15, 0xffff0000, v15
v_mfma_f32_16x16x32_bf16 v[248:251], a[80:83], a[56:59], v[248:251]
v_add_u32 v10, 0xffff0000, v10
v_add_u32 v11, 0xffff0000, v11
v_mfma_f32_16x16x32_bf16 v[248:251], a[84:87], a[76:79], v[248:251]
v_mfma_f32_16x16x32_bf16 v[212:215], a[88:91], a[52:55], v[212:215]
s_waitcnt vmcnt(28) lgkmcnt(0)
v_mfma_f32_16x16x32_bf16 v[212:215], a[92:95], a[72:75], v[212:215]
s_barrier
s_add_u32 m0, s17, 0x10000
v_mfma_f32_16x16x32_bf16 v[204:207], a[92:95], a[68:71], v[204:207]
buffer_load_dwordx4 v5, s[52:55], 0 offen lds
v_mfma_f32_16x16x32_bf16 v[204:207], a[88:91], a[48:51], v[204:207]
ds_read_b64_tr_b16 a[80:81], v12 offset:0
v_mfma_f32_16x16x32_bf16 v[196:199], a[88:91], a[44:47], v[196:199]
ds_read_b64_tr_b16 a[82:83], v12 offset:1024
v_mfma_f32_16x16x32_bf16 v[196:199], a[92:95], a[64:67], v[196:199]
ds_read_b64_tr_b16 a[84:85], v12 offset:8192
v_mfma_f32_16x16x32_bf16 v[188:191], a[92:95], a[60:63], v[188:191]
ds_read_b64_tr_b16 a[86:87], v12 offset:9216
v_mfma_f32_16x16x32_bf16 v[188:191], a[88:91], a[40:43], v[188:191]
s_add_u32 m0, s17, 0x10400
s_waitcnt lgkmcnt(4)
v_mfma_f32_16x16x32_bf16 v[216:219], a[40:43], a[96:99], v[216:219]
buffer_load_dwordx4 v5, s[52:55], s13 offen lds
v_mfma_f32_16x16x32_bf16 v[216:219], a[60:63], a[100:103], v[216:219]
ds_read_b64_tr_b16 a[88:89], v13 offset:0
v_mfma_f32_16x16x32_bf16 v[224:227], a[64:67], a[100:103], v[224:227]
ds_read_b64_tr_b16 a[90:91], v13 offset:1024
v_mfma_f32_16x16x32_bf16 v[224:227], a[44:47], a[96:99], v[224:227]
ds_read_b64_tr_b16 a[92:93], v13 offset:8192
v_mfma_f32_16x16x32_bf16 v[232:235], a[48:51], a[96:99], v[232:235]
ds_read_b64_tr_b16 a[94:95], v13 offset:9216
v_mfma_f32_16x16x32_bf16 v[232:235], a[68:71], a[100:103], v[232:235]
s_add_u32 s8, s28, 0x3800
v_mfma_f32_16x16x32_bf16 v[240:243], a[72:75], a[100:103], v[240:243]
buffer_store_dwordx4 a[164:167], v16, s[88:91], s8 offen sc1
v_mfma_f32_16x16x32_bf16 v[240:243], a[52:55], a[96:99], v[240:243]
v_mfma_f32_16x16x32_bf16 v[252:255], a[56:59], a[96:99], v[252:255]
v_mfma_f32_16x16x32_bf16 v[252:255], a[76:79], a[100:103], v[252:255]
v_mfma_f32_16x16x32_bf16 v[244:247], a[52:55], a[104:107], v[244:247]
ds_read_b64_tr_b16 a[96:97], v12 offset:256
v_mfma_f32_16x16x32_bf16 v[244:247], a[72:75], a[108:111], v[244:247]
ds_read_b64_tr_b16 a[98:99], v12 offset:1280
s_add_u32 m0, s17, 0x10800
v_mfma_f32_16x16x32_bf16 v[236:239], a[68:71], a[108:111], v[236:239]
buffer_load_dwordx4 v6, s[52:55], 0 offen lds
v_mfma_f32_16x16x32_bf16 v[236:239], a[48:51], a[104:107], v[236:239]
ds_read_b64_tr_b16 a[100:101], v12 offset:8448
v_mfma_f32_16x16x32_bf16 v[228:231], a[44:47], a[104:107], v[228:231]
ds_read_b64_tr_b16 a[102:103], v12 offset:9472
v_mfma_f32_16x16x32_bf16 v[228:231], a[64:67], a[108:111], v[228:231]
v_mfma_f32_16x16x32_bf16 v[220:223], a[60:63], a[108:111], v[220:223]
v_mfma_f32_16x16x32_bf16 v[220:223], a[40:43], a[104:107], v[220:223]
s_add_u32 m0, s17, 0x10c00
s_waitcnt lgkmcnt(4)
L_S12:
v_mfma_f32_16x16x32_bf16 v[24:27], a[80:83], a[0:3], v[24:27]
buffer_load_dwordx4 v6, s[52:55], s13 offen lds
v_mfma_f32_16x16x32_bf16 v[24:27], a[84:87], a[20:23], v[24:27]
ds_read_b64_tr_b16 a[104:105], v13 offset:256
s_waitcnt vmcnt(24)
v_mfma_f32_16x16x32_bf16 v[32:35], a[84:87], a[24:27], v[32:35]
ds_read_b64_tr_b16 a[106:107], v13 offset:1280
v_mfma_f32_16x16x32_bf16 v[32:35], a[80:83], a[4:7], v[32:35]
ds_read_b64_tr_b16 a[108:109], v13 offset:8448
v_mfma_f32_16x16x32_bf16 v[40:43], a[80:83], a[8:11], v[40:43]
ds_read_b64_tr_b16 a[110:111], v13 offset:9472
v_mfma_f32_16x16x32_bf16 v[40:43], a[84:87], a[28:31], v[40:43]
ds_read_b128 a[40:43], v8 offset:32768
s_add_u32 m0, s18, 0x14000
v_mfma_f32_16x16x32_bf16 v[48:51], a[84:87], a[32:35], v[48:51]
buffer_load_dwordx4 v7, s[68:71], 0 offen lds
v_mfma_f32_16x16x32_bf16 v[48:51], a[80:83], a[12:15], v[48:51]
ds_read_b128 a[60:63], v9 offset:32768
v_mfma_f32_16x16x32_bf16 v[52:55], a[88:91], a[12:15], v[52:55]
ds_read_b64_tr_b16 a[80:81], v12 offset:512
v_mfma_f32_16x16x32_bf16 v[52:55], a[92:95], a[32:35], v[52:55]
ds_read_b64_tr_b16 a[82:83], v12 offset:1536
v_mfma_f32_16x16x32_bf16 v[44:47], a[92:95], a[28:31], v[44:47]
ds_read_b64_tr_b16 a[84:85], v12 offset:8704
v_mfma_f32_16x16x32_bf16 v[44:47], a[88:91], a[8:11], v[44:47]
ds_read_b64_tr_b16 a[86:87], v12 offset:9728
s_add_u32 s8, s28, 0x6800
v_mfma_f32_16x16x32_bf16 v[36:39], a[88:91], a[4:7], v[36:39]
buffer_store_dwordx4 a[168:171], v16, s[88:91], s8 offen sc1
v_mfma_f32_16x16x32_bf16 v[36:39], a[92:95], a[24:27], v[36:39]
ds_read_b128 a[44:47], v8 offset:34816
v_mfma_f32_16x16x32_bf16 v[28:31], a[92:95], a[20:23], v[28:31]
ds_read_b128 a[64:67], v9 offset:34816
v_mfma_f32_16x16x32_bf16 v[28:31], a[88:91], a[0:3], v[28:31]
ds_read_b128 a[48:51], v8 offset:36864
s_waitcnt lgkmcnt(9)
v_mfma_f32_16x16x32_bf16 v[56:59], a[96:99], a[0:3], v[56:59]
ds_read_b64_tr_b16 a[88:89], v13 offset:512
v_mfma_f32_16x16x32_bf16 v[56:59], a[100:103], a[20:23], v[56:59]
ds_read_b64_tr_b16 a[90:91], v13 offset:1536
s_add_u32 m0, s18, 0x15000
v_mfma_f32_16x16x32_bf16 v[64:67], a[100:103], a[24:27], v[64:67]
buffer_load_dwordx4 v7, s[68:71], s25 offen lds
v_mfma_f32_16x16x32_bf16 v[64:67], a[96:99], a[4:7], v[64:67]
ds_read_b64_tr_b16 a[92:93], v13 offset:8704
v_mfma_f32_16x16x32_bf16 v[72:75], a[96:99], a[8:11], v[72:75]
ds_read_b64_tr_b16 a[94:95], v13 offset:9728
v_mfma_f32_16x16x32_bf16 v[72:75], a[100:103], a[28:31], v[72:75]
ds_read_b128 a[68:71], v9 offset:36864
v_mfma_f32_16x16x32_bf16 v[80:83], a[100:103], a[32:35], v[80:83]
ds_read_b128 a[52:55], v8 offset:38912
v_mfma_f32_16x16x32_bf16 v[80:83], a[96:99], a[12:15], v[80:83]
ds_read_b128 a[72:75], v9 offset:38912
s_add_u32 m0, s18, 0x16000
v_mfma_f32_16x16x32_bf16 v[84:87], a[104:107], a[12:15], v[84:87]
buffer_load_dwordx4 v7, s[68:71], s26 offen lds
v_mfma_f32_16x16x32_bf16 v[84:87], a[108:111], a[32:35], v[84:87]
ds_read_b64_tr_b16 a[96:97], v12 offset:768
v_mfma_f32_16x16x32_bf16 v[76:79], a[108:111], a[28:31], v[76:79]
ds_read_b64_tr_b16 a[98:99], v12 offset:1792
v_mfma_f32_16x16x32_bf16 v[76:79], a[104:107], a[8:11], v[76:79]
ds_read_b64_tr_b16 a[100:101], v12 offset:8960
v_mfma_f32_16x16x32_bf16 v[68:71], a[104:107], a[4:7], v[68:71]
ds_read_b64_tr_b16 a[102:103], v12 offset:9984
s_waitcnt lgkmcnt(7)
v_mfma_f32_16x16x32_bf16 v[68:71], a[108:111], a[24:27], v[68:71]
ds_read_b128 a[16:19], v10
s_add_u32 m0, s18, 0x17000
v_mfma_f32_16x16x32_bf16 v[60:63], a[108:111], a[20:23], v[60:63]
buffer_load_dwordx4 v4, s[44:47], s24 offen lds
v_mfma_f32_16x16x32_bf16 v[60:63], a[104:107], a[0:3], v[60:63]
ds_read_b128 a[36:39], v11
v_add_u32 v5, 0x80000, v5
v_mfma_f32_16x16x32_bf16 v[88:91], a[80:83], a[0:3], v[88:91]
ds_read_b64_tr_b16 a[104:105], v13 offset:768
v_add_u32 v6, 0x80000, v6
v_mfma_f32_16x16x32_bf16 v[88:91], a[84:87], a[20:23], v[88:91]
ds_read_b64_tr_b16 a[106:107], v13 offset:1792
v_add_u32 v7, 0x60000, v7
v_mfma_f32_16x16x32_bf16 v[96:99], a[84:87], a[24:27], v[96:99]
ds_read_b64_tr_b16 a[108:109], v13 offset:8960
v_add_u32 v4, 0x80, v4
v_mfma_f32_16x16x32_bf16 v[96:99], a[80:83], a[4:7], v[96:99]
ds_read_b64_tr_b16 a[110:111], v13 offset:9984
s_add_u32 s8, s28, 0x7800
v_mfma_f32_16x16x32_bf16 v[104:107], a[80:83], a[8:11], v[104:107]
buffer_store_dwordx4 a[172:175], v16, s[88:91], s8 offen sc1
v_mfma_f32_16x16x32_bf16 v[104:107], a[84:87], a[28:31], v[104:107]
v_mfma_f32_16x16x32_bf16 v[112:115], a[84:87], a[32:35], v[112:115]
v_mfma_f32_16x16x32_bf16 v[112:115], a[80:83], a[12:15], v[112:115]
v_mfma_f32_16x16x32_bf16 v[116:119], a[88:91], a[12:15], v[116:119]
ds_read_b64_tr_b16 a[80:81], v14 offset:0
s_waitcnt lgkmcnt(11)
v_mfma_f32_16x16x32_bf16 v[116:119], a[92:95], a[32:35], v[116:119]
ds_read_b64_tr_b16 a[82:83], v14 offset:256
s_add_u32 m0, s16, 0x8000
v_mfma_f32_16x16x32_bf16 v[108:111], a[92:95], a[28:31], v[108:111]
buffer_load_dwordx4 v22, s[44:47], s20 offen lds
v_mfma_f32_16x16x32_bf16 v[108:111], a[88:91], a[8:11], v[108:111]
ds_read_b64_tr_b16 a[84:85], v14 offset:2048
v_mfma_f32_16x16x32_bf16 v[100:103], a[88:91], a[4:7], v[100:103]
ds_read_b64_tr_b16 a[86:87], v14 offset:2304
v_mfma_f32_16x16x32_bf16 v[100:103], a[92:95], a[24:27], v[100:103]
v_mfma_f32_16x16x32_bf16 v[92:95], a[92:95], a[20:23], v[92:95]
v_mfma_f32_16x16x32_bf16 v[92:95], a[88:91], a[0:3], v[92:95]
s_add_u32 m0, s16, 0x8400
s_waitcnt lgkmcnt(4)
v_mfma_f32_16x16x32_bf16 v[120:123], a[96:99], a[0:3], v[120:123]
buffer_load_dwordx4 v23, s[44:47], s20 offen lds
v_mfma_f32_16x16x32_bf16 v[120:123], a[100:103], a[20:23], v[120:123]
ds_read_b64_tr_b16 a[88:89], v15 offset:0
v_mfma_f32_16x16x32_bf16 v[128:131], a[100:103], a[24:27], v[128:131]
ds_read_b64_tr_b16 a[90:91], v15 offset:256
v_mfma_f32_16x16x32_bf16 v[128:131], a[96:99], a[4:7], v[128:131]
ds_read_b64_tr_b16 a[92:93], v15 offset:2048
v_mfma_f32_16x16x32_bf16 v[136:139], a[96:99], a[8:11], v[136:139]
ds_read_b64_tr_b16 a[94:95], v15 offset:2304
v_mfma_f32_16x16x32_bf16 v[136:139], a[100:103], a[28:31], v[136:139]
s_add_u32 m0, s16, 0x8800
v_mfma_f32_16x16x32_bf16 v[144:147], a[100:103], a[32:35], v[144:147]
buffer_load_dwordx4 v22, s[44:47], s21 offen lds
v_mfma_f32_16x16x32_bf16 v[144:147], a[96:99], a[12:15], v[144:147]
v_mfma_f32_16x16x32_bf16 v[148:151], a[104:107], a[12:15], v[148:151]
ds_read_b64_tr_b16 a[96:97], v14 offset:4096
v_mfma_f32_16x16x32_bf16 v[148:151], a[108:111], a[32:35], v[148:151]
ds_read_b64_tr_b16 a[98:99], v14 offset:4352
v_mfma_f32_16x16x32_bf16 v[140:143], a[108:111], a[28:31], v[140:143]
ds_read_b64_tr_b16 a[100:101], v14 offset:6144
v_mfma_f32_16x16x32_bf16 v[140:143], a[104:107], a[8:11], v[140:143]
ds_read_b64_tr_b16 a[102:103], v14 offset:6400
s_add_u32 m0, s16, 0x8c00
v_mfma_f32_16x16x32_bf16 v[132:135], a[104:107], a[4:7], v[132:135]
buffer_load_dwordx4 v23, s[44:47], s21 offen lds
v_mfma_f32_16x16x32_bf16 v[132:135], a[108:111], a[24:27], v[132:135]
v_mfma_f32_16x16x32_bf16 v[124:127], a[108:111], a[20:23], v[124:127]
v_mfma_f32_16x16x32_bf16 v[124:127], a[104:107], a[0:3], v[124:127]
s_waitcnt lgkmcnt(4)
v_mfma_f32_16x16x32_bf16 v[152:155], a[80:83], a[0:3], v[152:155]
ds_read_b64_tr_b16 a[104:105], v15 offset:4096
v_mfma_f32_16x16x32_bf16 v[152:155], a[84:87], a[20:23], v[152:155]
ds_read_b64_tr_b16 a[106:107], v15 offset:4352
s_add_u32 m0, s16, 0x9000
v_mfma_f32_16x16x32_bf16 v[160:163], a[84:87], a[24:27], v[160:163]
buffer_load_dwordx4 v22, s[44:47], s22 offen lds
v_mfma_f32_16x16x32_bf16 v[160:163], a[80:83], a[4:7], v[160:163]
ds_read_b64_tr_b16 a[108:109], v15 offset:6144
v_mfma_f32_16x16x32_bf16 v[168:171], a[80:83], a[8:11], v[168:171]
ds_read_b64_tr_b16 a[110:111], v15 offset:6400
v_mfma_f32_16x16x32_bf16 v[168:171], a[84:87], a[28:31], v[168:171]
v_mfma_f32_16x16x32_bf16 v[176:179], a[84:87], a[32:35], v[176:179]
v_mfma_f32_16x16x32_bf16 v[176:179], a[80:83], a[12:15], v[176:179]
s_add_u32 m0, s16, 0x9400
v_mfma_f32_16x16x32_bf16 v[180:183], a[88:91], a[12:15], v[180:183]
buffer_load_dwordx4 v23, s[44:47], s22 offen lds
v_mfma_f32_16x16x32_bf16 v[180:183], a[92:95], a[32:35], v[180:183]
ds_read_b64_tr_b16 a[80:81], v14 offset:8192
v_mfma_f32_16x16x32_bf16 v[172:175], a[92:95], a[28:31], v[172:175]
ds_read_b64_tr_b16 a[82:83], v14 offset:8448
v_mfma_f32_16x16x32_bf16 v[172:175], a[88:91], a[8:11], v[172:175]
ds_read_b64_tr_b16 a[84:85], v14 offset:10240
v_mfma_f32_16x16x32_bf16 v[164:167], a[88:91], a[4:7], v[164:167]
ds_read_b64_tr_b16 a[86:87], v14 offset:10496
v_mfma_f32_16x16x32_bf16 v[164:167], a[92:95], a[24:27], v[164:167]
s_add_u32 m0, s16, 0x9800
v_mfma_f32_16x16x32_bf16 v[156:159], a[92:95], a[20:23], v[156:159]
buffer_load_dwordx4 v22, s[44:47], s23 offen lds
v_mfma_f32_16x16x32_bf16 v[156:159], a[88:91], a[0:3], v[156:159]
s_waitcnt lgkmcnt(4)
v_mfma_f32_16x16x32_bf16 v[184:187], a[96:99], a[0:3], v[184:187]
ds_read_b64_tr_b16 a[88:89], v15 offset:8192
v_mfma_f32_16x16x32_bf16 v[184:187], a[100:103], a[20:23], v[184:187]
ds_read_b64_tr_b16 a[90:91], v15 offset:8448
v_mfma_f32_16x16x32_bf16 v[192:195], a[100:103], a[24:27], v[192:195]
ds_read_b64_tr_b16 a[92:93], v15 offset:10240
v_mfma_f32_16x16x32_bf16 v[192:195], a[96:99], a[4:7], v[192:195]
ds_read_b64_tr_b16 a[94:95], v15 offset:10496
s_add_u32 m0, s16, 0x9c00
v_mfma_f32_16x16x32_bf16 v[200:203], a[96:99], a[8:11], v[200:203]
buffer_load_dwordx4 v23, s[44:47], s23 offen lds
v_mfma_f32_16x16x32_bf16 v[200:203], a[100:103], a[28:31], v[200:203]
v_add_u32 v22, 0x80, v22
v_add_u32 v23, 0x80, v23
v_mfma_f32_16x16x32_bf16 v[208:211], a[100:103], a[32:35], v[208:211]
v_add_u32 v12, 0x8000, v12
v_add_u32 v13, 0x8000, v13
v_mfma_f32_16x16x32_bf16 v[208:211], a[96:99], a[12:15], v[208:211]
v_add_u32 v14, 0x8000, v14
v_add_u32 v15, 0x8000, v15
v_mfma_f32_16x16x32_bf16 v[248:251], a[96:99], a[16:19], v[248:251]
v_add_u32 v10, 0x8000, v10
v_add_u32 v11, 0x8000, v11
v_mfma_f32_16x16x32_bf16 v[248:251], a[100:103], a[36:39], v[248:251]
v_mfma_f32_16x16x32_bf16 v[212:215], a[104:107], a[12:15], v[212:215]
s_waitcnt vmcnt(28) lgkmcnt(0)
v_mfma_f32_16x16x32_bf16 v[212:215], a[108:111], a[32:35], v[212:215]
s_barrier
s_add_u32 m0, s17, 0x0
v_mfma_f32_16x16x32_bf16 v[204:207], a[108:111], a[28:31], v[204:207]
buffer_load_dwordx4 v5, s[52:55], 0 offen lds
v_mfma_f32_16x16x32_bf16 v[204:207], a[104:107], a[8:11], v[204:207]
ds_read_b64_tr_b16 a[96:97], v12 offset:0
v_mfma_f32_16x16x32_bf16 v[196:199], a[104:107], a[4:7], v[196:199]
ds_read_b64_tr_b16 a[98:99], v12 offset:1024
v_mfma_f32_16x16x32_bf16 v[196:199], a[108:111], a[24:27], v[196:199]
ds_read_b64_tr_b16 a[100:101], v12 offset:8192
s_waitcnt lgkmcnt(3)
v_mfma_f32_16x16x32_bf16 v[188:191], a[108:111], a[20:23], v[188:191]
ds_read_b64_tr_b16 a[102:103], v12 offset:9216
s_add_u32 m0, s17, 0x400
v_mfma_f32_16x16x32_bf16 v[188:191], a[104:107], a[0:3], v[188:191]
buffer_load_dwordx4 v5, s[52:55], s13 offen lds
v_mfma_f32_16x16x32_bf16 v[216:219], a[0:3], a[80:83], v[216:219]
ds_read_b64_tr_b16 a[104:105], v13 offset:0
v_mfma_f32_16x16x32_bf16 v[216:219], a[20:23], a[84:87], v[216:219]
ds_read_b64_tr_b16 a[106:107], v13 offset:1024
v_mfma_f32_16x16x32_bf16 v[224:227], a[24:27], a[84:87], v[224:227]
ds_read_b64_tr_b16 a[108:109], v13 offset:8192
v_mfma_f32_16x16x32_bf16 v[224:227], a[4:7], a[80:83], v[224:227]
ds_read_b64_tr_b16 a[110:111], v13 offset:9216
v_mfma_f32_16x16x32_bf16 v[232:235], a[8:11], a[80:83], v[232:235]
s_add_u32 s8, s28, 0x2c00
v_mfma_f32_16x16x32_bf16 v[232:235], a[28:31], a[84:87], v[232:235]
buffer_store_dwordx4 a[176:179], v16, s[88:91], s8 offen sc1
v_mfma_f32_16x16x32_bf16 v[240:243], a[32:35], a[84:87], v[240:243]
v_mfma_f32_16x16x32_bf16 v[240:243], a[12:15], a[80:83], v[240:243]
v_mfma_f32_16x16x32_bf16 v[252:255], a[16:19], a[80:83], v[252:255]
v_mfma_f32_16x16x32_bf16 v[252:255], a[36:39], a[84:87], v[252:255]
v_mfma_f32_16x16x32_bf16 v[244:247], a[12:15], a[88:91], v[244:247]
ds_read_b64_tr_b16 a[80:81], v12 offset:256
s_add_u32 m0, s17, 0x800
v_mfma_f32_16x16x32_bf16 v[244:247], a[32:35], a[92:95], v[244:247]
buffer_load_dwordx4 v6, s[52:55], 0 offen lds
v_mfma_f32_16x16x32_bf16 v[236:239], a[28:31], a[92:95], v[236:239]
ds_read_b64_tr_b16 a[82:83], v12 offset:1280
v_mfma_f32_16x16x32_bf16 v[236:239], a[8:11], a[88:91], v[236:239]
ds_read_b64_tr_b16 a[84:85], v12 offset:8448
v_mfma_f32_16x16x32_bf16 v[228:231], a[4:7], a[88:91], v[228:231]
ds_read_b64_tr_b16 a[86:87], v12 offset:9472
v_mfma_f32_16x16x32_bf16 v[228:231], a[24:27], a[92:95], v[228:231]
s_add_u32 m0, s17, 0xc00
v_mfma_f32_16x16x32_bf16 v[220:223], a[20:23], a[92:95], v[220:223]
buffer_load_dwordx4 v6, s[52:55], s13 offen lds
v_mfma_f32_16x16x32_bf16 v[220:223], a[0:3], a[88:91], v[220:223]
s_waitcnt lgkmcnt(4)
L_S13:
v_mfma_f32_16x16x32_bf16 v[24:27], a[96:99], a[40:43], v[24:27]
ds_read_b64_tr_b16 a[88:89], v13 offset:256
s_waitcnt vmcnt(24)
v_mfma_f32_16x16x32_bf16 v[24:27], a[100:103], a[60:63], v[24:27]
ds_read_b64_tr_b16 a[90:91], v13 offset:1280
v_mfma_f32_16x16x32_bf16 v[32:35], a[100:103], a[64:67], v[32:35]
ds_read_b64_tr_b16 a[92:93], v13 offset:8448
v_mfma_f32_16x16x32_bf16 v[32:35], a[96:99], a[44:47], v[32:35]
ds_read_b64_tr_b16 a[94:95], v13 offset:9472
s_add_u32 s8, s28, 0x3c00
v_mfma_f32_16x16x32_bf16 v[40:43], a[96:99], a[48:51], v[40:43]
buffer_store_dwordx4 a[180:183], v16, s[88:91], s8 offen sc1
v_mfma_f32_16x16x32_bf16 v[40:43], a[100:103], a[68:71], v[40:43]
ds_read_b128 a[0:3], v8 offset:0
v_mfma_f32_16x16x32_bf16 v[48:51], a[100:103], a[72:75], v[48:51]
ds_read_b128 a[20:23], v9 offset:0
v_mfma_f32_16x16x32_bf16 v[48:51], a[96:99], a[52:55], v[48:51]
ds_read_b128 a[4:7], v8 offset:2048
v_mfma_f32_16x16x32_bf16 v[52:55], a[104:107], a[52:55], v[52:55]
ds_read_b64_tr_b16 a[96:97], v12 offset:512
v_mfma_f32_16x16x32_bf16 v[52:55], a[108:111], a[72:75], v[52:55]
ds_read_b64_tr_b16 a[98:99], v12 offset:1536
s_add_u32 m0, s18, 0x4000
v_mfma_f32_16x16x32_bf16 v[44:47], a[108:111], a[68:71], v[44:47]
buffer_load_dwordx4 v7, s[68:71], 0 offen lds
v_mfma_f32_16x16x32_bf16 v[44:47], a[104:107], a[48:51], v[44:47]
ds_read_b64_tr_b16 a[100:101], v12 offset:8704
v_mfma_f32_16x16x32_bf16 v[36:39], a[104:107], a[44:47], v[36:39]
ds_read_b64_tr_b16 a[102:103], v12 offset:9728
v_mfma_f32_16x16x32_bf16 v[36:39], a[108:111], a[64:67], v[36:39]
ds_read_b128 a[24:27], v9 offset:2048
s_waitcnt lgkmcnt(8)
v_mfma_f32_16x16x32_bf16 v[28:31], a[108:111], a[60:63], v[28:31]
ds_read_b128 a[8:11], v8 offset:4096
s_add_u32 m0, s18, 0x5000
v_mfma_f32_16x16x32_bf16 v[28:31], a[104:107], a[40:43], v[28:31]
buffer_load_dwordx4 v7, s[68:71], s25 offen lds
v_mfma_f32_16x16x32_bf16 v[56:59], a[80:83], a[40:43], v[56:59]
ds_read_b64_tr_b16 a[104:105], v13 offset:512
v_mfma_f32_16x16x32_bf16 v[56:59], a[84:87], a[60:63], v[56:59]
ds_read_b64_tr_b16 a[106:107], v13 offset:1536
v_mfma_f32_16x16x32_bf16 v[64:67], a[84:87], a[64:67], v[64:67]
ds_read_b64_tr_b16 a[108:109], v13 offset:8704
v_mfma_f32_16x16x32_bf16 v[64:67], a[80:83], a[44:47], v[64:67]
ds_read_b64_tr_b16 a[110:111], v13 offset:9728
v_mfma_f32_16x16x32_bf16 v[72:75], a[80:83], a[48:51], v[72:75]
ds_read_b128 a[28:31], v9 offset:4096
s_add_u32 s8, s28, 0x6c00
v_mfma_f32_16x16x32_bf16 v[72:75], a[84:87], a[68:71], v[72:75]
buffer_store_dwordx4 a[184:187], v16, s[88:91], s8 offen sc1
v_mfma_f32_16x16x32_bf16 v[80:83], a[84:87], a[72:75], v[80:83]
ds_read_b128 a[12:15], v8 offset:6144
v_mfma_f32_16x16x32_bf16 v[80:83], a[80:83], a[52:55], v[80:83]
ds_read_b128 a[32:35], v9 offset:6144
v_mfma_f32_16x16x32_bf16 v[84:87], a[88:91], a[52:55], v[84:87]
ds_read_b64_tr_b16 a[80:81], v12 offset:768
v_mfma_f32_16x16x32_bf16 v[84:87], a[92:95], a[72:75], v[84:87]
ds_read_b64_tr_b16 a[82:83], v12 offset:1792
v_mfma_f32_16x16x32_bf16 v[76:79], a[92:95], a[68:71], v[76:79]
ds_read_b64_tr_b16 a[84:85], v12 offset:8960
s_add_u32 m0, s18, 0x6000
v_mfma_f32_16x16x32_bf16 v[76:79], a[88:91], a[48:51], v[76:79]
buffer_load_dwordx4 v7, s[68:71], s26 offen lds
v_mfma_f32_16x16x32_bf16 v[68:71], a[88:91], a[44:47], v[68:71]
ds_read_b64_tr_b16 a[86:87], v12 offset:9984
v_mfma_f32_16x16x32_bf16 v[68:71], a[92:95], a[64:67], v[68:71]
ds_read_b128 a[56:59], v10
v_mfma_f32_16x16x32_bf16 v[60:63], a[92:95], a[60:63], v[60:63]
ds_read_b128 a[76:79], v11
v_mfma_f32_16x16x32_bf16 v[60:63], a[88:91], a[40:43], v[60:63]
s_waitcnt lgkmcnt(9)
v_mfma_f32_16x16x32_bf16 v[88:91], a[96:99], a[40:43], v[88:91]
ds_read_b64_tr_b16 a[88:89], v13 offset:768
s_add_u32 m0, s18, 0x7000
v_mfma_f32_16x16x32_bf16 v[88:91], a[100:103], a[60:63], v[88:91]
buffer_load_dwordx4 v4, s[44:47], s24 offen lds
v_mfma_f32_16x16x32_bf16 v[96:99], a[100:103], a[64:67], v[96:99]
ds_read_b64_tr_b16 a[90:91], v13 offset:1792
v_add_u32 v5, 0x80000, v5
v_mfma_f32_16x16x32_bf16 v[96:99], a[96:99], a[44:47], v[96:99]
ds_read_b64_tr_b16 a[92:93], v13 offset:8960
v_add_u32 v6, 0x80000, v6
v_mfma_f32_16x16x32_bf16 v[104:107], a[96:99], a[48:51], v[104:107]
ds_read_b64_tr_b16 a[94:95], v13 offset:9984
v_add_u32 v7, 0x60000, v7
v_mfma_f32_16x16x32_bf16 v[104:107], a[100:103], a[68:71], v[104:107]
s_add_u32 s8, s28, 0x7c00
v_add_u32 v4, 0x80, v4
v_mfma_f32_16x16x32_bf16 v[112:115], a[100:103], a[72:75], v[112:115]
buffer_store_dwordx4 a[188:191], v16, s[88:91], s8 offen sc1
v_mfma_f32_16x16x32_bf16 v[112:115], a[96:99], a[52:55], v[112:115]
v_mfma_f32_16x16x32_bf16 v[116:119], a[104:107], a[52:55], v[116:119]
ds_read_b64_tr_b16 a[96:97], v14 offset:0
v_mfma_f32_16x16x32_bf16 v[116:119], a[108:111], a[72:75], v[116:119]
ds_read_b64_tr_b16 a[98:99], v14 offset:256
v_mfma_f32_16x16x32_bf16 v[108:111], a[108:111], a[68:71], v[108:111]
ds_read_b64_tr_b16 a[100:101], v14 offset:2048
s_waitcnt lgkmcnt(13)
v_mfma_f32_16x16x32_bf16 v[108:111], a[104:107], a[48:51], v[108:111]
ds_read_b64_tr_b16 a[102:103], v14 offset:2304
s_add_u32 m0, s16, 0x0
v_mfma_f32_16x16x32_bf16 v[100:103], a[104:107], a[44:47], v[100:103]
buffer_load_dwordx4 v22, s[44:47], s20 offen lds
v_mfma_f32_16x16x32_bf16 v[100:103], a[108:111], a[64:67], v[100:103]
v_mfma_f32_16x16x32_bf16 v[92:95], a[108:111], a[60:63], v[92:95]
v_mfma_f32_16x16x32_bf16 v[92:95], a[104:107], a[40:43], v[92:95]
s_waitcnt lgkmcnt(4)
v_mfma_f32_16x16x32_bf16 v[120:123], a[80:83], a[40:43], v[120:123]
ds_read_b64_tr_b16 a[104:105], v15 offset:0
v_mfma_f32_16x16x32_bf16 v[120:123], a[84:87], a[60:63], v[120:123]
ds_read_b64_tr_b16 a[106:107], v15 offset:256
s_add_u32 m0, s16, 0x400
v_mfma_f32_16x16x32_bf16 v[128:131], a[84:87], a[64:67], v[128:131]
buffer_load_dwordx4 v23, s[44:47], s20 offen lds
v_mfma_f32_16x16x32_bf16 v[128:131], a[80:83], a[44:47], v[128:131]
ds_read_b64_tr_b16 a[108:109], v15 offset:2048
v_mfma_f32_16x16x32_bf16 v[136:139], a[80:83], a[48:51], v[136:139]
ds_read_b64_tr_b16 a[110:111], v15 offset:2304
v_mfma_f32_16x16x32_bf16 v[136:139], a[84:87], a[68:71], v[136:139]
v_mfma_f32_16x16x32_bf16 v[144:147], a[84:87], a[72:75], v[144:147]
s_add_u32 m0, s16, 0x800
v_mfma_f32_16x16x32_bf16 v[144:147], a[80:83], a[52:55], v[144:147]
buffer_load_dwordx4 v22, s[44:47], s21 offen lds
v_mfma_f32_16x16x32_bf16 v[148:151], a[88:91], a[52:55], v[148:151]
ds_read_b64_tr_b16 a[80:81], v14 offset:4096
v_mfma_f32_16x16x32_bf16 v[148:151], a[92:95], a[72:75], v[148:151]
ds_read_b64_tr_b16 a[82:83], v14 offset:4352
v_mfma_f32_16x16x32_bf16 v[140:143], a[92:95], a[68:71], v[140:143]
ds_read_b64_tr_b16 a[84:85], v14 offset:6144
v_mfma_f32_16x16x32_bf16 v[140:143], a[88:91], a[48:51], v[140:143]
ds_read_b64_tr_b16 a[86:87], v14 offset:6400
v_mfma_f32_16x16x32_bf16 v[132:135], a[88:91], a[44:47], v[132:135]
s_add_u32 m0, s16, 0xc00
v_mfma_f32_16x16x32_bf16 v[132:135], a[92:95], a[64:67], v[132:135]
buffer_load_dwordx4 v23, s[44:47], s21 offen lds
v_mfma_f32_16x16x32_bf16 v[124:127], a[92:95], a[60:63], v[124:127]
v_mfma_f32_16x16x32_bf16 v[124:127], a[88:91], a[40:43], v[124:127]
s_waitcnt lgkmcnt(4)
v_mfma_f32_16x16x32_bf16 v[152:155], a[96:99], a[40:43], v[152:155]
ds_read_b64_tr_b16 a[88:89], v15 offset:4096
v_mfma_f32_16x16x32_bf16 v[152:155], a[100:103], a[60:63], v[152:155]
ds_read_b64_tr_b16 a[90:91], v15 offset:4352
v_mfma_f32_16x16x32_bf16 v[160:163], a[100:103], a[64:67], v[160:163]
ds_read_b64_tr_b16 a[92:93], v15 offset:6144
s_add_u32 m0, s16, 0x1000
v_mfma_f32_16x16x32_bf16 v[160:163], a[96:99], a[44:47], v[160:163]
buffer_load_dwordx4 v22, s[44:47], s22 offen lds
v_mfma_f32_16x16x32_bf16 v[168:171], a[96:99], a[48:51], v[168:171]
ds_read_b64_tr_b16 a[94:95], v15 offset:6400
v_mfma_f32_16x16x32_bf16 v[168:171], a[100:103], a[68:71], v[168:171]
v_mfma_f32_16x16x32_bf16 v[176:179], a[100:103], a[72:75], v[176:179]
v_mfma_f32_16x16x32_bf16 v[176:179], a[96:99], a[52:55], v[176:179]
s_add_u32 m0, s16, 0x1400
v_mfma_f32_16x16x32_bf16 v[180:183], a[104:107], a[52:55], v[180:183]
buffer_load_dwordx4 v23, s[44:47], s22 offen lds
v_mfma_f32_16x16x32_bf16 v[180:183], a[108:111], a[72:75], v[180:183]
ds_read_b64_tr_b16 a[96:97], v14 offset:8192
v_mfma_f32_16x16x32_bf16 v[172:175], a[108:111], a[68:71], v[172:175]
ds_read_b64_tr_b16 a[98:99], v14 offset:8448
v_mfma_f32_16x16x32_bf16 v[172:175], a[104:107], a[48:51], v[172:175]
ds_read_b64_tr_b16 a[100:101], v14 offset:10240
v_mfma_f32_16x16x32_bf16 v[164:167], a[104:107], a[44:47], v[164:167]
ds_read_b64_tr_b16 a[102:103], v14 offset:10496
v_mfma_f32_16x16x32_bf16 v[164:167], a[108:111], a[64:67], v[164:167]
s_add_u32 m0, s16, 0x1800
v_mfma_f32_16x16x32_bf16 v[156:159], a[108:111], a[60:63], v[156:159]
buffer_load_dwordx4 v22, s[44:47], s23 offen lds
v_mfma_f32_16x16x32_bf16 v[156:159], a[104:107], a[40:43], v[156:159]
s_waitcnt lgkmcnt(4)
v_mfma_f32_16x16x32_bf16 v[184:187], a[80:83], a[40:43], v[184:187]
ds_read_b64_tr_b16 a[104:105], v15 offset:8192
v_mfma_f32_16x16x32_bf16 v[184:187], a[84:87], a[60:63], v[184:187]
ds_read_b64_tr_b16 a[106:107], v15 offset:8448
v_mfma_f32_16x16x32_bf16 v[192:195], a[84:87], a[64:67], v[192:195]
ds_read_b64_tr_b16 a[108:109], v15 offset:10240
v_mfma_f32_16x16x32_bf16 v[192:195], a[80:83], a[44:47], v[192:195]
ds_read_b64_tr_b16 a[110:111], v15 offset:10496
s_add_u32 m0, s16, 0x1c00
v_mfma_f32_16x16x32_bf16 v[200:203], a[80:83], a[48:51], v[200:203]
buffer_load_dwordx4 v23, s[44:47], s23 offen lds
v_mfma_f32_16x16x32_bf16 v[200:203], a[84:87], a[68:71], v[200:203]
v_add_u32 v22, 0x80, v22
v_add_u32 v23, 0x80, v23
v_mfma_f32_16x16x32_bf16 v[208:211], a[84:87], a[72:75], v[208:211]
v_add_u32 v12, 0x8000, v12
v_add_u32 v13, 0x8000, v13
v_mfma_f32_16x16x32_bf16 v[208:211], a[80:83], a[52:55], v[208:211]
v_add_u32 v14, 0x8000, v14
v_add_u32 v15, 0x8000, v15
v_mfma_f32_16x16x32_bf16 v[248:251], a[80:83], a[56:59], v[248:251]
v_add_u32 v10, 0x8000, v10
v_add_u32 v11, 0x8000, v11
v_mfma_f32_16x16x32_bf16 v[248:251], a[84:87], a[76:79], v[248:251]
v_mfma_f32_16x16x32_bf16 v[212:215], a[88:91], a[52:55], v[212:215]
s_waitcnt vmcnt(29) lgkmcnt(0)
v_mfma_f32_16x16x32_bf16 v[212:215], a[92:95], a[72:75], v[212:215]
s_barrier
s_add_u32 m0, s17, 0x8000
v_mfma_f32_16x16x32_bf16 v[204:207], a[92:95], a[68:71], v[204:207]
buffer_load_dwordx4 v5, s[52:55], 0 offen lds
v_mfma_f32_16x16x32_bf16 v[204:207], a[88:91], a[48:51], v[204:207]
ds_read_b64_tr_b16 a[80:81], v12 offset:0
v_mfma_f32_16x16x32_bf16 v[196:199], a[88:91], a[44:47], v[196:199]
ds_read_b64_tr_b16 a[82:83], v12 offset:1024
v_mfma_f32_16x16x32_bf16 v[196:199], a[92:95], a[64:67], v[196:199]
ds_read_b64_tr_b16 a[84:85], v12 offset:8192
s_waitcnt lgkmcnt(3)
v_mfma_f32_16x16x32_bf16 v[188:191], a[92:95], a[60:63], v[188:191]
ds_read_b64_tr_b16 a[86:87], v12 offset:9216
s_add_u32 m0, s17, 0x8400
v_mfma_f32_16x16x32_bf16 v[188:191], a[88:91], a[40:43], v[188:191]
buffer_load_dwordx4 v5, s[52:55], s13 offen lds
v_mfma_f32_16x16x32_bf16 v[216:219], a[40:43], a[96:99], v[216:219]
ds_read_b64_tr_b16 a[88:89], v13 offset:0
v_mfma_f32_16x16x32_bf16 v[216:219], a[60:63], a[100:103], v[216:219]
ds_read_b64_tr_b16 a[90:91], v13 offset:1024
v_mfma_f32_16x16x32_bf16 v[224:227], a[64:67], a[100:103], v[224:227]
ds_read_b64_tr_b16 a[92:93], v13 offset:8192
v_mfma_f32_16x16x32_bf16 v[224:227], a[44:47], a[96:99], v[224:227]
ds_read_b64_tr_b16 a[94:95], v13 offset:9216
v_mfma_f32_16x16x32_bf16 v[232:235], a[48:51], a[96:99], v[232:235]
v_add_u32 v20, s0, v16
v_mov_b32 v21, s1
v_mfma_f32_16x16x32_bf16 v[232:235], a[68:71], a[100:103], v[232:235]
global_load_dword a120, v[20:21], off sc1
v_mfma_f32_16x16x32_bf16 v[240:243], a[72:75], a[100:103], v[240:243]
v_mfma_f32_16x16x32_bf16 v[240:243], a[52:55], a[96:99], v[240:243]
v_mfma_f32_16x16x32_bf16 v[252:255], a[56:59], a[96:99], v[252:255]
v_mfma_f32_16x16x32_bf16 v[252:255], a[76:79], a[100:103], v[252:255]
v_mfma_f32_16x16x32_bf16 v[244:247], a[52:55], a[104:107], v[244:247]
ds_read_b64_tr_b16 a[96:97], v12 offset:256
s_add_u32 m0, s17, 0x8800
v_mfma_f32_16x16x32_bf16 v[244:247], a[72:75], a[108:111], v[244:247]
buffer_load_dwordx4 v6, s[52:55], 0 offen lds
v_mfma_f32_16x16x32_bf16 v[236:239], a[68:71], a[108:111], v[236:239]
ds_read_b64_tr_b16 a[98:99], v12 offset:1280
v_mfma_f32_16x16x32_bf16 v[236:239], a[48:51], a[104:107], v[236:239]
ds_read_b64_tr_b16 a[100:101], v12 offset:8448
v_mfma_f32_16x16x32_bf16 v[228:231], a[44:47], a[104:107], v[228:231]
ds_read_b64_tr_b16 a[102:103], v12 offset:9472
v_mfma_f32_16x16x32_bf16 v[228:231], a[64:67], a[108:111], v[228:231]
s_add_u32 m0, s17, 0x8c00
v_mfma_f32_16x16x32_bf16 v[220:223], a[60:63], a[108:111], v[220:223]
buffer_load_dwordx4 v6, s[52:55], s13 offen lds
v_mfma_f32_16x16x32_bf16 v[220:223], a[40:43], a[104:107], v[220:223]
s_waitcnt lgkmcnt(4)
L_S14:
v_mfma_f32_16x16x32_bf16 v[24:27], a[80:83], a[0:3], v[24:27]
ds_read_b64_tr_b16 a[104:105], v13 offset:256
s_waitcnt vmcnt(25)
v_mfma_f32_16x16x32_bf16 v[24:27], a[84:87], a[20:23], v[24:27]
ds_read_b64_tr_b16 a[106:107], v13 offset:1280
v_mfma_f32_16x16x32_bf16 v[32:35], a[84:87], a[24:27], v[32:35]
ds_read_b64_tr_b16 a[108:109], v13 offset:8448
v_mfma_f32_16x16x32_bf16 v[32:35], a[80:83], a[4:7], v[32:35]
ds_read_b64_tr_b16 a[110:111], v13 offset:9472
s_add_u32 s8, s28, 0x4000
v_mfma_f32_16x16x32_bf16 v[40:43], a[80:83], a[8:11], v[40:43]
buffer_store_dwordx4 a[192:195], v16, s[88:91], s8 offen sc1
v_mfma_f32_16x16x32_bf16 v[40:43], a[84:87], a[28:31], v[40:43]
ds_read_b128 a[40:43], v8 offset:32768
v_mfma_f32_16x16x32_bf16 v[48:51], a[84:87], a[32:35], v[48:51]
ds_read_b128 a[60:63], v9 offset:32768
v_mfma_f32_16x16x32_bf16 v[48:51], a[80:83], a[12:15], v[48:51]
ds_read_b128 a[44:47], v8 offset:34816
v_mfma_f32_16x16x32_bf16 v[52:55], a[88:91], a[12:15], v[52:55]
ds_read_b64_tr_b16 a[80:81], v12 offset:512
v_mfma_f32_16x16x32_bf16 v[52:55], a[92:95], a[32:35], v[52:55]
ds_read_b64_tr_b16 a[82:83], v12 offset:1536
s_add_u32 m0, s18, 0xc000
v_mfma_f32_16x16x32_bf16 v[44:47], a[92:95], a[28:31], v[44:47]
buffer_load_dwordx4 v7, s[68:71], 0 offen lds
v_mfma_f32_16x16x32_bf16 v[44:47], a[88:91], a[8:11], v[44:47]
ds_read_b64_tr_b16 a[84:85], v12 offset:8704
v_mfma_f32_16x16x32_bf16 v[36:39], a[88:91], a[4:7], v[36:39]
ds_read_b64_tr_b16 a[86:87], v12 offset:9728
v_mfma_f32_16x16x32_bf16 v[36:39], a[92:95], a[24:27], v[36:39]
ds_read_b128 a[64:67], v9 offset:34816
s_waitcnt lgkmcnt(8)
v_mfma_f32_16x16x32_bf16 v[28:31], a[92:95], a[20:23], v[28:31]
ds_read_b128 a[48:51], v8 offset:36864
s_add_u32 m0, s18, 0xd000
v_mfma_f32_16x16x32_bf16 v[28:31], a[88:91], a[0:3], v[28:31]
buffer_load_dwordx4 v7, s[68:71], s25 offen lds
v_mfma_f32_16x16x32_bf16 v[56:59], a[96:99], a[0:3], v[56:59]
ds_read_b64_tr_b16 a[88:89], v13 offset:512
v_mfma_f32_16x16x32_bf16 v[56:59], a[100:103], a[20:23], v[56:59]
ds_read_b64_tr_b16 a[90:91], v13 offset:1536
v_mfma_f32_16x16x32_bf16 v[64:67], a[100:103], a[24:27], v[64:67]
ds_read_b64_tr_b16 a[92:93], v13 offset:8704
v_mfma_f32_16x16x32_bf16 v[64:67], a[96:99], a[4:7], v[64:67]
ds_read_b64_tr_b16 a[94:95], v13 offset:9728
v_mfma_f32_16x16x32_bf16 v[72:75], a[96:99], a[8:11], v[72:75]
ds_read_b128 a[68:71], v9 offset:36864
s_add_u32 s8, s28, 0x8000
v_mfma_f32_16x16x32_bf16 v[72:75], a[100:103], a[28:31], v[72:75]
buffer_store_dwordx4 a[196:199], v16, s[88:91], s8 offen sc1
v_mfma_f32_16x16x32_bf16 v[80:83], a[100:103], a[32:35], v[80:83]
ds_read_b128 a[52:55], v8 offset:38912
v_mfma_f32_16x16x32_bf16 v[80:83], a[96:99], a[12:15], v[80:83]
ds_read_b128 a[72:75], v9 offset:38912
v_mfma_f32_16x16x32_bf16 v[84:87], a[104:107], a[12:15], v[84:87]
ds_read_b64_tr_b16 a[96:97], v12 offset:768
v_mfma_f32_16x16x32_bf16 v[84:87], a[108:111], a[32:35], v[84:87]
ds_read_b64_tr_b16 a[98:99], v12 offset:1792
v_mfma_f32_16x16x32_bf16 v[76:79], a[108:111], a[28:31], v[76:79]
ds_read_b64_tr_b16 a[100:101], v12 offset:8960
s_add_u32 m0, s18, 0xe000
v_mfma_f32_16x16x32_bf16 v[76:79], a[104:107], a[8:11], v[76:79]
buffer_load_dwordx4 v7, s[68:71], s26 offen lds
v_mfma_f32_16x16x32_bf16 v[68:71], a[104:107], a[4:7], v[68:71]
ds_read_b64_tr_b16 a[102:103], v12 offset:9984
v_mfma_f32_16x16x32_bf16 v[68:71], a[108:111], a[24:27], v[68:71]
ds_read_b128 a[16:19], v10
v_mfma_f32_16x16x32_bf16 v[60:63], a[108:111], a[20:23], v[60:63]
ds_read_b128 a[36:39], v11
v_mfma_f32_16x16x32_bf16 v[60:63], a[104:107], a[0:3], v[60:63]
s_waitcnt lgkmcnt(9)
v_mfma_f32_16x16x32_bf16 v[88:91], a[80:83], a[0:3], v[88:91]
ds_read_b64_tr_b16 a[104:105], v13 offset:768
s_add_u32 m0, s18, 0xf000
v_mfma_f32_16x16x32_bf16 v[88:91], a[84:87], a[20:23], v[88:91]
buffer_load_dwordx4 v4, s[44:47], s24 offen lds
v_mfma_f32_16x16x32_bf16 v[96:99], a[84:87], a[24:27], v[96:99]
ds_read_b64_tr_b16 a[106:107], v13 offset:1792
v_add_u32 v5, 0x80000, v5
v_mfma_f32_16x16x32_bf16 v[96:99], a[80:83], a[4:7], v[96:99]
ds_read_b64_tr_b16 a[108:109], v13 offset:8960
v_add_u32 v6, 0x80000, v6
v_mfma_f32_16x16x32_bf16 v[104:107], a[80:83], a[8:11], v[104:107]
ds_read_b64_tr_b16 a[110:111], v13 offset:9984
v_add_u32 v7, 0x60000, v7
v_mfma_f32_16x16x32_bf16 v[104:107], a[84:87], a[28:31], v[104:107]
s_add_u32 s8, s28, 0x4400
v_add_u32 v4, 0x80, v4
v_mfma_f32_16x16x32_bf16 v[112:115], a[84:87], a[32:35], v[112:115]
buffer_store_dwordx4 a[200:203], v16, s[88:91], s8 offen sc1
v_mfma_f32_16x16x32_bf16 v[112:115], a[80:83], a[12:15], v[112:115]
v_mfma_f32_16x16x32_bf16 v[116:119], a[88:91], a[12:15], v[116:119]
ds_read_b64_tr_b16 a[80:81], v14 offset:0
v_mfma_f32_16x16x32_bf16 v[116:119], a[92:95], a[32:35], v[116:119]
ds_read_b64_tr_b16 a[82:83], v14 offset:256
v_mfma_f32_16x16x32_bf16 v[108:111], a[92:95], a[28:31], v[108:111]
ds_read_b64_tr_b16 a[84:85], v14 offset:2048
s_waitcnt lgkmcnt(13)
v_mfma_f32_16x16x32_bf16 v[108:111], a[88:91], a[8:11], v[108:111]
ds_read_b64_tr_b16 a[86:87], v14 offset:2304
s_add_u32 m0, s16, 0x8000
v_mfma_f32_16x16x32_bf16 v[100:103], a[88:91], a[4:7], v[100:103]
buffer_load_dwordx4 v22, s[44:47], s20 offen lds
v_mfma_f32_16x16x32_bf16 v[100:103], a[92:95], a[24:27], v[100:103]
v_mfma_f32_16x16x32_bf16 v[92:95], a[92:95], a[20:23], v[92:95]
v_mfma_f32_16x16x32_bf16 v[92:95], a[88:91], a[0:3], v[92:95]
s_waitcnt lgkmcnt(4)
v_mfma_f32_16x16x32_bf16 v[120:123], a[96:99], a[0:3], v[120:123]
ds_read_b64_tr_b16 a[88:89], v15 offset:0
v_mfma_f32_16x16x32_bf16 v[120:123], a[100:103], a[20:23], v[120:123]
ds_read_b64_tr_b16 a[90:91], v15 offset:256
s_add_u32 m0, s16, 0x8400
v_mfma_f32_16x16x32_bf16 v[128:131], a[100:103], a[24:27], v[128:131]
buffer_load_dwordx4 v23, s[44:47], s20 offen lds
v_mfma_f32_16x16x32_bf16 v[128:131], a[96:99], a[4:7], v[128:131]
ds_read_b64_tr_b16 a[92:93], v15 offset:2048
v_mfma_f32_16x16x32_bf16 v[136:139], a[96:99], a[8:11], v[136:139]
ds_read_b64_tr_b16 a[94:95], v15 offset:2304
v_mfma_f32_16x16x32_bf16 v[136:139], a[100:103], a[28:31], v[136:139]
v_mfma_f32_16x16x32_bf16 v[144:147], a[100:103], a[32:35], v[144:147]
s_add_u32 m0, s16, 0x8800
v_mfma_f32_16x16x32_bf16 v[144:147], a[96:99], a[12:15], v[144:147]
buffer_load_dwordx4 v22, s[44:47], s21 offen lds
v_mfma_f32_16x16x32_bf16 v[148:151], a[104:107], a[12:15], v[148:151]
ds_read_b64_tr_b16 a[96:97], v14 offset:4096
v_mfma_f32_16x16x32_bf16 v[148:151], a[108:111], a[32:35], v[148:151]
ds_read_b64_tr_b16 a[98:99], v14 offset:4352
v_mfma_f32_16x16x32_bf16 v[140:143], a[108:111], a[28:31], v[140:143]
ds_read_b64_tr_b16 a[100:101], v14 offset:6144
v_mfma_f32_16x16x32_bf16 v[140:143], a[104:107], a[8:11], v[140:143]
ds_read_b64_tr_b16 a[102:103], v14 offset:6400
v_mfma_f32_16x16x32_bf16 v[132:135], a[104:107], a[4:7], v[132:135]
s_add_u32 m0, s16, 0x8c00
v_mfma_f32_16x16x32_bf16 v[132:135], a[108:111], a[24:27], v[132:135]
buffer_load_dwordx4 v23, s[44:47], s21 offen lds
v_mfma_f32_16x16x32_bf16 v[124:127], a[108:111], a[20:23], v[124:127]
v_mfma_f32_16x16x32_bf16 v[124:127], a[104:107], a[0:3], v[124:127]
s_waitcnt lgkmcnt(4)
v_mfma_f32_16x16x32_bf16 v[152:155], a[80:83], a[0:3], v[152:155]
ds_read_b64_tr_b16 a[104:105], v15 offset:4096
v_mfma_f32_16x16x32_bf16 v[152:155], a[84:87], a[20:23], v[152:155]
ds_read_b64_tr_b16 a[106:107], v15 offset:4352
v_mfma_f32_16x16x32_bf16 v[160:163], a[84:87], a[24:27], v[160:163]
ds_read_b64_tr_b16 a[108:109], v15 offset:6144
s_add_u32 m0, s16, 0x9000
v_mfma_f32_16x16x32_bf16 v[160:163], a[80:83], a[4:7], v[160:163]
buffer_load_dwordx4 v22, s[44:47], s22 offen lds
v_mfma_f32_16x16x32_bf16 v[168:171], a[80:83], a[8:11], v[168:171]
ds_read_b64_tr_b16 a[110:111], v15 offset:6400
v_mfma_f32_16x16x32_bf16 v[168:171], a[84:87], a[28:31], v[168:171]
v_mfma_f32_16x16x32_bf16 v[176:179], a[84:87], a[32:35], v[176:179]
v_mfma_f32_16x16x32_bf16 v[176:179], a[80:83], a[12:15], v[176:179]
s_add_u32 m0, s16, 0x9400
v_mfma_f32_16x16x32_bf16 v[180:183], a[88:91], a[12:15], v[180:183]
buffer_load_dwordx4 v23, s[44:47], s22 offen lds
v_mfma_f32_16x16x32_bf16 v[180:183], a[92:95], a[32:35], v[180:183]
ds_read_b64_tr_b16 a[80:81], v14 offset:8192
v_mfma_f32_16x16x32_bf16 v[172:175], a[92:95], a[28:31], v[172:175]
ds_read_b64_tr_b16 a[82:83], v14 offset:8448
v_mfma_f32_16x16x32_bf16 v[172:175], a[88:91], a[8:11], v[172:175]
ds_read_b64_tr_b16 a[84:85], v14 offset:10240
v_mfma_f32_16x16x32_bf16 v[164:167], a[88:91], a[4:7], v[164:167]
ds_read_b64_tr_b16 a[86:87], v14 offset:10496
v_mfma_f32_16x16x32_bf16 v[164:167], a[92:95], a[24:27], v[164:167]
s_add_u32 m0, s16, 0x9800
v_mfma_f32_16x16x32_bf16 v[156:159], a[92:95], a[20:23], v[156:159]
buffer_load_dwordx4 v22, s[44:47], s23 offen lds
v_mfma_f32_16x16x32_bf16 v[156:159], a[88:91], a[0:3], v[156:159]
s_waitcnt lgkmcnt(4)
v_mfma_f32_16x16x32_bf16 v[184:187], a[96:99], a[0:3], v[184:187]
ds_read_b64_tr_b16 a[88:89], v15 offset:8192
v_mfma_f32_16x16x32_bf16 v[184:187], a[100:103], a[20:23], v[184:187]
ds_read_b64_tr_b16 a[90:91], v15 offset:8448
v_mfma_f32_16x16x32_bf16 v[192:195], a[100:103], a[24:27], v[192:195]
ds_read_b64_tr_b16 a[92:93], v15 offset:10240
v_mfma_f32_16x16x32_bf16 v[192:195], a[96:99], a[4:7], v[192:195]
ds_read_b64_tr_b16 a[94:95], v15 offset:10496
s_add_u32 m0, s16, 0x9c00
v_mfma_f32_16x16x32_bf16 v[200:203], a[96:99], a[8:11], v[200:203]
buffer_load_dwordx4 v23, s[44:47], s23 offen lds
v_mfma_f32_16x16x32_bf16 v[200:203], a[100:103], a[28:31], v[200:203]
v_add_u32 v22, 0x80, v22
v_add_u32 v23, 0x80, v23
v_mfma_f32_16x16x32_bf16 v[208:211], a[100:103], a[32:35], v[208:211]
v_add_u32 v12, 0xffff0000, v12
v_add_u32 v13, 0xffff0000, v13
v_mfma_f32_16x16x32_bf16 v[208:211], a[96:99], a[12:15], v[208:211]
v_add_u32 v14, 0xffff0000, v14
v_add_u32 v15, 0xffff0000, v15
v_mfma_f32_16x16x32_bf16 v[248:251], a[96:99], a[16:19], v[248:251]
v_add_u32 v10, 0xffff0000, v10
v_add_u32 v11, 0xffff0000, v11
v_mfma_f32_16x16x32_bf16 v[248:251], a[100:103], a[36:39], v[248:251]
v_mfma_f32_16x16x32_bf16 v[212:215], a[104:107], a[12:15], v[212:215]
s_waitcnt vmcnt(29) lgkmcnt(0)
v_mfma_f32_16x16x32_bf16 v[212:215], a[108:111], a[32:35], v[212:215]
s_barrier
s_add_u32 m0, s17, 0x10000
v_mfma_f32_16x16x32_bf16 v[204:207], a[108:111], a[28:31], v[204:207]
buffer_load_dwordx4 v5, s[52:55], 0 offen lds
v_mfma_f32_16x16x32_bf16 v[204:207], a[104:107], a[8:11], v[204:207]
ds_read_b64_tr_b16 a[96:97], v12 offset:0
v_mfma_f32_16x16x32_bf16 v[196:199], a[104:107], a[4:7], v[196:199]
ds_read_b64_tr_b16 a[98:99], v12 offset:1024
v_mfma_f32_16x16x32_bf16 v[196:199], a[108:111], a[24:27], v[196:199]
ds_read_b64_tr_b16 a[100:101], v12 offset:8192
v_mfma_f32_16x16x32_bf16 v[188:191], a[108:111], a[20:23], v[188:191]
ds_read_b64_tr_b16 a[102:103], v12 offset:9216
v_mfma_f32_16x16x32_bf16 v[188:191], a[104:107], a[0:3], v[188:191]
s_add_u32 m0, s17, 0x10400
s_waitcnt lgkmcnt(4)
v_mfma_f32_16x16x32_bf16 v[216:219], a[0:3], a[80:83], v[216:219]
buffer_load_dwordx4 v5, s[52:55], s13 offen lds
v_mfma_f32_16x16x32_bf16 v[216:219], a[20:23], a[84:87], v[216:219]
ds_read_b64_tr_b16 a[104:105], v13 offset:0
v_mfma_f32_16x16x32_bf16 v[224:227], a[24:27], a[84:87], v[224:227]
ds_read_b64_tr_b16 a[106:107], v13 offset:1024
v_mfma_f32_16x16x32_bf16 v[224:227], a[4:7], a[80:83], v[224:227]
ds_read_b64_tr_b16 a[108:109], v13 offset:8192
v_mfma_f32_16x16x32_bf16 v[232:235], a[8:11], a[80:83], v[232:235]
ds_read_b64_tr_b16 a[110:111], v13 offset:9216
v_mfma_f32_16x16x32_bf16 v[232:235], a[28:31], a[84:87], v[232:235]
s_add_u32 s8, s28, 0x8400
v_mfma_f32_16x16x32_bf16 v[240:243], a[32:35], a[84:87], v[240:243]
buffer_store_dwordx4 a[204:207], v16, s[88:91], s8 offen sc1
v_mfma_f32_16x16x32_bf16 v[240:243], a[12:15], a[80:83], v[240:243]
v_mfma_f32_16x16x32_bf16 v[252:255], a[16:19], a[80:83], v[252:255]
v_mfma_f32_16x16x32_bf16 v[252:255], a[36:39], a[84:87], v[252:255]
v_mfma_f32_16x16x32_bf16 v[244:247], a[12:15], a[88:91], v[244:247]
ds_read_b64_tr_b16 a[80:81], v12 offset:256
v_mfma_f32_16x16x32_bf16 v[244:247], a[32:35], a[92:95], v[244:247]
ds_read_b64_tr_b16 a[82:83], v12 offset:1280
s_add_u32 m0, s17, 0x10800
v_mfma_f32_16x16x32_bf16 v[236:239], a[28:31], a[92:95], v[236:239]
buffer_load_dwordx4 v6, s[52:55], 0 offen lds
v_mfma_f32_16x16x32_bf16 v[236:239], a[8:11], a[88:91], v[236:239]
ds_read_b64_tr_b16 a[84:85], v12 offset:8448
v_mfma_f32_16x16x32_bf16 v[228:231], a[4:7], a[88:91], v[228:231]
ds_read_b64_tr_b16 a[86:87], v12 offset:9472
v_mfma_f32_16x16x32_bf16 v[228:231], a[24:27], a[92:95], v[228:231]
v_mfma_f32_16x16x32_bf16 v[220:223], a[20:23], a[92:95], v[220:223]
v_mfma_f32_16x16x32_bf16 v[220:223], a[0:3], a[88:91], v[220:223]
s_add_u32 m0, s17, 0x10c00
s_waitcnt lgkmcnt(4)
L_S15:
v_mfma_f32_16x16x32_bf16 v[24:27], a[96:99], a[40:43], v[24:27]
buffer_load_dwordx4 v6, s[52:55], s13 offen lds
v_mfma_f32_16x16x32_bf16 v[24:27], a[100:103], a[60:63], v[24:27]
ds_read_b64_tr_b16 a[88:89], v13 offset:256
s_waitcnt vmcnt(25)
v_mfma_f32_16x16x32_bf16 v[32:35], a[100:103], a[64:67], v[32:35]
ds_read_b64_tr_b16 a[90:91], v13 offset:1280
v_mfma_f32_16x16x32_bf16 v[32:35], a[96:99], a[44:47], v[32:35]
ds_read_b64_tr_b16 a[92:93], v13 offset:8448
v_mfma_f32_16x16x32_bf16 v[40:43], a[96:99], a[48:51], v[40:43]
ds_read_b64_tr_b16 a[94:95], v13 offset:9472
v_mfma_f32_16x16x32_bf16 v[40:43], a[100:103], a[68:71], v[40:43]
ds_read_b128 a[0:3], v8 offset:0
s_add_u32 m0, s18, 0x14000
v_mfma_f32_16x16x32_bf16 v[48:51], a[100:103], a[72:75], v[48:51]
buffer_load_dwordx4 v7, s[68:71], 0 offen lds
v_mfma_f32_16x16x32_bf16 v[48:51], a[96:99], a[52:55], v[48:51]
ds_read_b128 a[20:23], v9 offset:0
v_mfma_f32_16x16x32_bf16 v[52:55], a[104:107], a[52:55], v[52:55]
ds_read_b64_tr_b16 a[96:97], v12 offset:512
v_mfma_f32_16x16x32_bf16 v[52:55], a[108:111], a[72:75], v[52:55]
ds_read_b64_tr_b16 a[98:99], v12 offset:1536
v_mfma_f32_16x16x32_bf16 v[44:47], a[108:111], a[68:71], v[44:47]
ds_read_b64_tr_b16 a[100:101], v12 offset:8704
v_mfma_f32_16x16x32_bf16 v[44:47], a[104:107], a[48:51], v[44:47]
ds_read_b64_tr_b16 a[102:103], v12 offset:9728
s_add_u32 s8, s28, 0x4800
v_mfma_f32_16x16x32_bf16 v[36:39], a[104:107], a[44:47], v[36:39]
buffer_store_dwordx4 a[208:211], v16, s[88:91], s8 offen sc1
v_mfma_f32_16x16x32_bf16 v[36:39], a[108:111], a[64:67], v[36:39]
ds_read_b128 a[4:7], v8 offset:2048
v_mfma_f32_16x16x32_bf16 v[28:31], a[108:111], a[60:63], v[28:31]
ds_read_b128 a[24:27], v9 offset:2048
v_mfma_f32_16x16x32_bf16 v[28:31], a[104:107], a[40:43], v[28:31]
ds_read_b128 a[8:11], v8 offset:4096
s_waitcnt lgkmcnt(9)
v_mfma_f32_16x16x32_bf16 v[56:59], a[80:83], a[40:43], v[56:59]
ds_read_b64_tr_b16 a[104:105], v13 offset:512
v_mfma_f32_16x16x32_bf16 v[56:59], a[84:87], a[60:63], v[56:59]
ds_read_b64_tr_b16 a[106:107], v13 offset:1536
s_add_u32 m0, s18, 0x15000
v_mfma_f32_16x16x32_bf16 v[64:67], a[84:87], a[64:67], v[64:67]
buffer_load_dwordx4 v7, s[68:71], s25 offen lds
v_mfma_f32_16x16x32_bf16 v[64:67], a[80:83], a[44:47], v[64:67]
ds_read_b64_tr_b16 a[108:109], v13 offset:8704
v_mfma_f32_16x16x32_bf16 v[72:75], a[80:83], a[48:51], v[72:75]
ds_read_b64_tr_b16 a[110:111], v13 offset:9728
v_mfma_f32_16x16x32_bf16 v[72:75], a[84:87], a[68:71], v[72:75]
ds_read_b128 a[28:31], v9 offset:4096
v_mfma_f32_16x16x32_bf16 v[80:83], a[84:87], a[72:75], v[80:83]
ds_read_b128 a[12:15], v8 offset:6144
v_mfma_f32_16x16x32_bf16 v[80:83], a[80:83], a[52:55], v[80:83]
ds_read_b128 a[32:35], v9 offset:6144
s_add_u32 m0, s18, 0x16000
v_mfma_f32_16x16x32_bf16 v[84:87], a[88:91], a[52:55], v[84:87]
buffer_load_dwordx4 v7, s[68:71], s26 offen lds
v_mfma_f32_16x16x32_bf16 v[84:87], a[92:95], a[72:75], v[84:87]
ds_read_b64_tr_b16 a[80:81], v12 offset:768
v_mfma_f32_16x16x32_bf16 v[76:79], a[92:95], a[68:71], v[76:79]
ds_read_b64_tr_b16 a[82:83], v12 offset:1792
v_mfma_f32_16x16x32_bf16 v[76:79], a[88:91], a[48:51], v[76:79]
ds_read_b64_tr_b16 a[84:85], v12 offset:8960
v_mfma_f32_16x16x32_bf16 v[68:71], a[88:91], a[44:47], v[68:71]
ds_read_b64_tr_b16 a[86:87], v12 offset:9984
s_waitcnt lgkmcnt(7)
v_mfma_f32_16x16x32_bf16 v[68:71], a[92:95], a[64:67], v[68:71]
ds_read_b128 a[56:59], v10
s_add_u32 m0, s18, 0x17000
v_mfma_f32_16x16x32_bf16 v[60:63], a[92:95], a[60:63], v[60:63]
buffer_load_dwordx4 v4, s[44:47], s24 offen lds
v_mfma_f32_16x16x32_bf16 v[60:63], a[88:91], a[40:43], v[60:63]
ds_read_b128 a[76:79], v11
v_add_u32 v5, 0x80000, v5
v_mfma_f32_16x16x32_bf16 v[88:91], a[96:99], a[40:43], v[88:91]
ds_read_b64_tr_b16 a[88:89], v13 offset:768
v_add_u32 v6, 0x80000, v6
v_mfma_f32_16x16x32_bf16 v[88:91], a[100:103], a[60:63], v[88:91]
ds_read_b64_tr_b16 a[90:91], v13 offset:1792
v_add_u32 v7, 0x60000, v7
v_mfma_f32_16x16x32_bf16 v[96:99], a[100:103], a[64:67], v[96:99]
ds_read_b64_tr_b16 a[92:93], v13 offset:8960
v_add_u32 v4, 0x80, v4
v_mfma_f32_16x16x32_bf16 v[96:99], a[96:99], a[44:47], v[96:99]
ds_read_b64_tr_b16 a[94:95], v13 offset:9984
s_add_u32 s8, s28, 0x8800
v_mfma_f32_16x16x32_bf16 v[104:107], a[96:99], a[48:51], v[104:107]
buffer_store_dwordx4 a[212:215], v16, s[88:91], s8 offen sc1
v_mfma_f32_16x16x32_bf16 v[104:107], a[100:103], a[68:71], v[104:107]
v_mfma_f32_16x16x32_bf16 v[112:115], a[100:103], a[72:75], v[112:115]
v_mfma_f32_16x16x32_bf16 v[112:115], a[96:99], a[52:55], v[112:115]
v_mfma_f32_16x16x32_bf16 v[116:119], a[104:107], a[52:55], v[116:119]
ds_read_b64_tr_b16 a[96:97], v14 offset:0
s_waitcnt lgkmcnt(11)
v_mfma_f32_16x16x32_bf16 v[116:119], a[108:111], a[72:75], v[116:119]
ds_read_b64_tr_b16 a[98:99], v14 offset:256
s_add_u32 m0, s16, 0x0
v_mfma_f32_16x16x32_bf16 v[108:111], a[108:111], a[68:71], v[108:111]
buffer_load_dwordx4 v22, s[44:47], s20 offen lds
v_mfma_f32_16x16x32_bf16 v[108:111], a[104:107], a[48:51], v[108:111]
ds_read_b64_tr_b16 a[100:101], v14 offset:2048
v_mfma_f32_16x16x32_bf16 v[100:103], a[104:107], a[44:47], v[100:103]
ds_read_b64_tr_b16 a[102:103], v14 offset:2304
v_mfma_f32_16x16x32_bf16 v[100:103], a[108:111], a[64:67], v[100:103]
v_mfma_f32_16x16x32_bf16 v[92:95], a[108:111], a[60:63], v[92:95]
v_mfma_f32_16x16x32_bf16 v[92:95], a[104:107], a[40:43], v[92:95]
s_add_u32 m0, s16, 0x400
s_waitcnt lgkmcnt(4)
v_mfma_f32_16x16x32_bf16 v[120:123], a[80:83], a[40:43], v[120:123]
buffer_load_dwordx4 v23, s[44:47], s20 offen lds
v_mfma_f32_16x16x32_bf16 v[120:123], a[84:87], a[60:63], v[120:123]
ds_read_b64_tr_b16 a[104:105], v15 offset:0
v_mfma_f32_16x16x32_bf16 v[128:131], a[84:87], a[64:67], v[128:131]
ds_read_b64_tr_b16 a[106:107], v15 offset:256
v_mfma_f32_16x16x32_bf16 v[128:131], a[80:83], a[44:47], v[128:131]
ds_read_b64_tr_b16 a[108:109], v15 offset:2048
v_mfma_f32_16x16x32_bf16 v[136:139], a[80:83], a[48:51], v[136:139]
ds_read_b64_tr_b16 a[110:111], v15 offset:2304
v_mfma_f32_16x16x32_bf16 v[136:139], a[84:87], a[68:71], v[136:139]
s_add_u32 m0, s16, 0x800
v_mfma_f32_16x16x32_bf16 v[144:147], a[84:87], a[72:75], v[144:147]
buffer_load_dwordx4 v22, s[44:47], s21 offen lds
v_mfma_f32_16x16x32_bf16 v[144:147], a[80:83], a[52:55], v[144:147]
v_mfma_f32_16x16x32_bf16 v[148:151], a[88:91], a[52:55], v[148:151]
ds_read_b64_tr_b16 a[80:81], v14 offset:4096
v_mfma_f32_16x16x32_bf16 v[148:151], a[92:95], a[72:75], v[148:151]
ds_read_b64_tr_b16 a[82:83], v14 offset:4352
v_mfma_f32_16x16x32_bf16 v[140:143], a[92:95], a[68:71], v[140:143]
ds_read_b64_tr_b16 a[84:85], v14 offset:6144
v_mfma_f32_16x16x32_bf16 v[140:143], a[88:91], a[48:51], v[140:143]
ds_read_b64_tr_b16 a[86:87], v14 offset:6400
s_add_u32 m0, s16, 0xc00
v_mfma_f32_16x16x32_bf16 v[132:135], a[88:91], a[44:47], v[132:135]
buffer_load_dwordx4 v23, s[44:47], s21 offen lds
v_mfma_f32_16x16x32_bf16 v[132:135], a[92:95], a[64:67], v[132:135]
v_mfma_f32_16x16x32_bf16 v[124:127], a[92:95], a[60:63], v[124:127]
v_mfma_f32_16x16x32_bf16 v[124:127], a[88:91], a[40:43], v[124:127]
s_waitcnt lgkmcnt(4)
v_mfma_f32_16x16x32_bf16 v[152:155], a[96:99], a[40:43], v[152:155]
ds_read_b64_tr_b16 a[88:89], v15 offset:4096
v_mfma_f32_16x16x32_bf16 v[152:155], a[100:103], a[60:63], v[152:155]
ds_read_b64_tr_b16 a[90:91], v15 offset:4352
s_add_u32 m0, s16, 0x1000
v_mfma_f32_16x16x32_bf16 v[160:163], a[100:103], a[64:67], v[160:163]
buffer_load_dwordx4 v22, s[44:47], s22 offen lds
v_mfma_f32_16x16x32_bf16 v[160:163], a[96:99], a[44:47], v[160:163]
ds_read_b64_tr_b16 a[92:93], v15 offset:6144
v_mfma_f32_16x16x32_bf16 v[168:171], a[96:99], a[48:51], v[168:171]
ds_read_b64_tr_b16 a[94:95], v15 offset:6400
v_mfma_f32_16x16x32_bf16 v[168:171], a[100:103], a[68:71], v[168:171]
v_mfma_f32_16x16x32_bf16 v[176:179], a[100:103], a[72:75], v[176:179]
v_mfma_f32_16x16x32_bf16 v[176:179], a[96:99], a[52:55], v[176:179]
s_add_u32 m0, s16, 0x1400
v_mfma_f32_16x16x32_bf16 v[180:183], a[104:107], a[52:55], v[180:183]
buffer_load_dwordx4 v23, s[44:47], s22 offen lds
v_mfma_f32_16x16x32_bf16 v[180:183], a[108:111], a[72:75], v[180:183]
ds_read_b64_tr_b16 a[96:97], v14 offset:8192
v_mfma_f32_16x16x32_bf16 v[172:175], a[108:111], a[68:71], v[172:175]
ds_read_b64_tr_b16 a[98:99], v14 offset:8448
v_mfma_f32_16x16x32_bf16 v[172:175], a[104:107], a[48:51], v[172:175]
ds_read_b64_tr_b16 a[100:101], v14 offset:10240
v_mfma_f32_16x16x32_bf16 v[164:167], a[104:107], a[44:47], v[164:167]
ds_read_b64_tr_b16 a[102:103], v14 offset:10496
v_mfma_f32_16x16x32_bf16 v[164:167], a[108:111], a[64:67], v[164:167]
s_add_u32 m0, s16, 0x1800
v_mfma_f32_16x16x32_bf16 v[156:159], a[108:111], a[60:63], v[156:159]
buffer_load_dwordx4 v22, s[44:47], s23 offen lds
v_mfma_f32_16x16x32_bf16 v[156:159], a[104:107], a[40:43], v[156:159]
s_waitcnt lgkmcnt(4)
v_mfma_f32_16x16x32_bf16 v[184:187], a[80:83], a[40:43], v[184:187]
ds_read_b64_tr_b16 a[104:105], v15 offset:8192
v_mfma_f32_16x16x32_bf16 v[184:187], a[84:87], a[60:63], v[184:187]
ds_read_b64_tr_b16 a[106:107], v15 offset:8448
v_mfma_f32_16x16x32_bf16 v[192:195], a[84:87], a[64:67], v[192:195]
ds_read_b64_tr_b16 a[108:109], v15 offset:10240
v_mfma_f32_16x16x32_bf16 v[192:195], a[80:83], a[44:47], v[192:195]
ds_read_b64_tr_b16 a[110:111], v15 offset:10496
s_add_u32 m0, s16, 0x1c00
v_mfma_f32_16x16x32_bf16 v[200:203], a[80:83], a[48:51], v[200:203]
buffer_load_dwordx4 v23, s[44:47], s23 offen lds
v_mfma_f32_16x16x32_bf16 v[200:203], a[84:87], a[68:71], v[200:203]
v_add_u32 v22, 0x80, v22
v_add_u32 v23, 0x80, v23
v_mfma_f32_16x16x32_bf16 v[208:211], a[84:87], a[72:75], v[208:211]
v_add_u32 v12, 0x8000, v12
v_add_u32 v13, 0x8000, v13
v_mfma_f32_16x16x32_bf16 v[208:211], a[80:83], a[52:55], v[208:211]
v_add_u32 v14, 0x8000, v14
v_add_u32 v15, 0x8000, v15
v_mfma_f32_16x16x32_bf16 v[248:251], a[80:83], a[56:59], v[248:251]
v_add_u32 v10, 0x8000, v10
v_add_u32 v11, 0x8000, v11
v_mfma_f32_16x16x32_bf16 v[248:251], a[84:87], a[76:79], v[248:251]
v_mfma_f32_16x16x32_bf16 v[212:215], a[88:91], a[52:55], v[212:215]
s_waitcnt vmcnt(28) lgkmcnt(0)
v_mfma_f32_16x16x32_bf16 v[212:215], a[92:95], a[72:75], v[212:215]
s_barrier
s_add_u32 m0, s17, 0x0
v_mfma_f32_16x16x32_bf16 v[204:207], a[92:95], a[68:71], v[204:207]
buffer_load_dwordx4 v5, s[52:55], 0 offen lds
v_mfma_f32_16x16x32_bf16 v[204:207], a[88:91], a[48:51], v[204:207]
ds_read_b64_tr_b16 a[80:81], v12 offset:0
v_mfma_f32_16x16x32_bf16 v[196:199], a[88:91], a[44:47], v[196:199]
ds_read_b64_tr_b16 a[82:83], v12 offset:1024
v_mfma_f32_16x16x32_bf16 v[196:199], a[92:95], a[64:67], v[196:199]
ds_read_b64_tr_b16 a[84:85], v12 offset:8192
v_mfma_f32_16x16x32_bf16 v[188:191], a[92:95], a[60:63], v[188:191]
ds_read_b64_tr_b16 a[86:87], v12 offset:9216
v_mfma_f32_16x16x32_bf16 v[188:191], a[88:91], a[40:43], v[188:191]
s_add_u32 m0, s17, 0x400
s_waitcnt lgkmcnt(4)
v_mfma_f32_16x16x32_bf16 v[216:219], a[40:43], a[96:99], v[216:219]
buffer_load_dwordx4 v5, s[52:55], s13 offen lds
v_mfma_f32_16x16x32_bf16 v[216:219], a[60:63], a[100:103], v[216:219]
ds_read_b64_tr_b16 a[88:89], v13 offset:0
v_mfma_f32_16x16x32_bf16 v[224:227], a[64:67], a[100:103], v[224:227]
ds_read_b64_tr_b16 a[90:91], v13 offset:1024
v_mfma_f32_16x16x32_bf16 v[224:227], a[44:47], a[96:99], v[224:227]
ds_read_b64_tr_b16 a[92:93], v13 offset:8192
v_mfma_f32_16x16x32_bf16 v[232:235], a[48:51], a[96:99], v[232:235]
ds_read_b64_tr_b16 a[94:95], v13 offset:9216
v_mfma_f32_16x16x32_bf16 v[232:235], a[68:71], a[100:103], v[232:235]
s_add_u32 s8, s28, 0x4c00
v_mfma_f32_16x16x32_bf16 v[240:243], a[72:75], a[100:103], v[240:243]
buffer_store_dwordx4 a[216:219], v16, s[88:91], s8 offen sc1
v_mfma_f32_16x16x32_bf16 v[240:243], a[52:55], a[96:99], v[240:243]
v_mfma_f32_16x16x32_bf16 v[252:255], a[56:59], a[96:99], v[252:255]
v_mfma_f32_16x16x32_bf16 v[252:255], a[76:79], a[100:103], v[252:255]
v_mfma_f32_16x16x32_bf16 v[244:247], a[52:55], a[104:107], v[244:247]
ds_read_b64_tr_b16 a[96:97], v12 offset:256
v_mfma_f32_16x16x32_bf16 v[244:247], a[72:75], a[108:111], v[244:247]
ds_read_b64_tr_b16 a[98:99], v12 offset:1280
s_add_u32 m0, s17, 0x800
v_mfma_f32_16x16x32_bf16 v[236:239], a[68:71], a[108:111], v[236:239]
buffer_load_dwordx4 v6, s[52:55], 0 offen lds
v_mfma_f32_16x16x32_bf16 v[236:239], a[48:51], a[104:107], v[236:239]
ds_read_b64_tr_b16 a[100:101], v12 offset:8448
v_mfma_f32_16x16x32_bf16 v[228:231], a[44:47], a[104:107], v[228:231]
ds_read_b64_tr_b16 a[102:103], v12 offset:9472
v_mfma_f32_16x16x32_bf16 v[228:231], a[64:67], a[108:111], v[228:231]
v_mfma_f32_16x16x32_bf16 v[220:223], a[60:63], a[108:111], v[220:223]
v_mfma_f32_16x16x32_bf16 v[220:223], a[40:43], a[104:107], v[220:223]
s_add_u32 m0, s17, 0xc00
s_waitcnt lgkmcnt(4)
L_S16:
v_mfma_f32_16x16x32_bf16 v[24:27], a[80:83], a[0:3], v[24:27]
buffer_load_dwordx4 v6, s[52:55], s13 offen lds
v_mfma_f32_16x16x32_bf16 v[24:27], a[84:87], a[20:23], v[24:27]
ds_read_b64_tr_b16 a[104:105], v13 offset:256
s_waitcnt vmcnt(24)
v_mfma_f32_16x16x32_bf16 v[32:35], a[84:87], a[24:27], v[32:35]
ds_read_b64_tr_b16 a[106:107], v13 offset:1280
v_mfma_f32_16x16x32_bf16 v[32:35], a[80:83], a[4:7], v[32:35]
ds_read_b64_tr_b16 a[108:109], v13 offset:8448
v_mfma_f32_16x16x32_bf16 v[40:43], a[80:83], a[8:11], v[40:43]
ds_read_b64_tr_b16 a[110:111], v13 offset:9472
v_mfma_f32_16x16x32_bf16 v[40:43], a[84:87], a[28:31], v[40:43]
ds_read_b128 a[40:43], v8 offset:32768
s_add_u32 m0, s18, 0x4000
v_mfma_f32_16x16x32_bf16 v[48:51], a[84:87], a[32:35], v[48:51]
buffer_load_dwordx4 v7, s[68:71], 0 offen lds
v_mfma_f32_16x16x32_bf16 v[48:51], a[80:83], a[12:15], v[48:51]
ds_read_b128 a[60:63], v9 offset:32768
v_mfma_f32_16x16x32_bf16 v[52:55], a[88:91], a[12:15], v[52:55]
ds_read_b64_tr_b16 a[80:81], v12 offset:512
v_mfma_f32_16x16x32_bf16 v[52:55], a[92:95], a[32:35], v[52:55]
ds_read_b64_tr_b16 a[82:83], v12 offset:1536
v_mfma_f32_16x16x32_bf16 v[44:47], a[92:95], a[28:31], v[44:47]
ds_read_b64_tr_b16 a[84:85], v12 offset:8704
v_mfma_f32_16x16x32_bf16 v[44:47], a[88:91], a[8:11], v[44:47]
ds_read_b64_tr_b16 a[86:87], v12 offset:9728
s_add_u32 s8, s28, 0x8c00
v_mfma_f32_16x16x32_bf16 v[36:39], a[88:91], a[4:7], v[36:39]
buffer_store_dwordx4 a[220:223], v16, s[88:91], s8 offen sc1
v_mfma_f32_16x16x32_bf16 v[36:39], a[92:95], a[24:27], v[36:39]
ds_read_b128 a[44:47], v8 offset:34816
v_mfma_f32_16x16x32_bf16 v[28:31], a[92:95], a[20:23], v[28:31]
ds_read_b128 a[64:67], v9 offset:34816
v_mfma_f32_16x16x32_bf16 v[28:31], a[88:91], a[0:3], v[28:31]
ds_read_b128 a[48:51], v8 offset:36864
s_waitcnt lgkmcnt(9)
v_mfma_f32_16x16x32_bf16 v[56:59], a[96:99], a[0:3], v[56:59]
ds_read_b64_tr_b16 a[88:89], v13 offset:512
v_mfma_f32_16x16x32_bf16 v[56:59], a[100:103], a[20:23], v[56:59]
ds_read_b64_tr_b16 a[90:91], v13 offset:1536
s_add_u32 m0, s18, 0x5000
v_mfma_f32_16x16x32_bf16 v[64:67], a[100:103], a[24:27], v[64:67]
buffer_load_dwordx4 v7, s[68:71], s25 offen lds
v_mfma_f32_16x16x32_bf16 v[64:67], a[96:99], a[4:7], v[64:67]
ds_read_b64_tr_b16 a[92:93], v13 offset:8704
v_mfma_f32_16x16x32_bf16 v[72:75], a[96:99], a[8:11], v[72:75]
ds_read_b64_tr_b16 a[94:95], v13 offset:9728
v_mfma_f32_16x16x32_bf16 v[72:75], a[100:103], a[28:31], v[72:75]
ds_read_b128 a[68:71], v9 offset:36864
v_mfma_f32_16x16x32_bf16 v[80:83], a[100:103], a[32:35], v[80:83]
ds_read_b128 a[52:55], v8 offset:38912
v_mfma_f32_16x16x32_bf16 v[80:83], a[96:99], a[12:15], v[80:83]
ds_read_b128 a[72:75], v9 offset:38912
s_add_u32 m0, s18, 0x6000
v_mfma_f32_16x16x32_bf16 v[84:87], a[104:107], a[12:15], v[84:87]
buffer_load_dwordx4 v7, s[68:71], s26 offen lds
v_mfma_f32_16x16x32_bf16 v[84:87], a[108:111], a[32:35], v[84:87]
ds_read_b64_tr_b16 a[96:97], v12 offset:768
v_mfma_f32_16x16x32_bf16 v[76:79], a[108:111], a[28:31], v[76:79]
ds_read_b64_tr_b16 a[98:99], v12 offset:1792
v_mfma_f32_16x16x32_bf16 v[76:79], a[104:107], a[8:11], v[76:79]
ds_read_b64_tr_b16 a[100:101], v12 offset:8960
v_mfma_f32_16x16x32_bf16 v[68:71], a[104:107], a[4:7], v[68:71]
ds_read_b64_tr_b16 a[102:103], v12 offset:9984
s_waitcnt lgkmcnt(7)
v_mfma_f32_16x16x32_bf16 v[68:71], a[108:111], a[24:27], v[68:71]
ds_read_b128 a[16:19], v10
s_add_u32 m0, s18, 0x7000
v_mfma_f32_16x16x32_bf16 v[60:63], a[108:111], a[20:23], v[60:63]
buffer_load_dwordx4 v4, s[44:47], s24 offen lds
v_mfma_f32_16x16x32_bf16 v[60:63], a[104:107], a[0:3], v[60:63]
ds_read_b128 a[36:39], v11
v_add_u32 v5, 0x80000, v5
v_mfma_f32_16x16x32_bf16 v[88:91], a[80:83], a[0:3], v[88:91]
ds_read_b64_tr_b16 a[104:105], v13 offset:768
v_add_u32 v6, 0x80000, v6
v_mfma_f32_16x16x32_bf16 v[88:91], a[84:87], a[20:23], v[88:91]
ds_read_b64_tr_b16 a[106:107], v13 offset:1792
v_add_u32 v7, 0x60000, v7
v_mfma_f32_16x16x32_bf16 v[96:99], a[84:87], a[24:27], v[96:99]
ds_read_b64_tr_b16 a[108:109], v13 offset:8960
v_add_u32 v4, 0x80, v4
v_mfma_f32_16x16x32_bf16 v[96:99], a[80:83], a[4:7], v[96:99]
ds_read_b64_tr_b16 a[110:111], v13 offset:9984
s_add_u32 s8, s28, 0x5000
v_mfma_f32_16x16x32_bf16 v[104:107], a[80:83], a[8:11], v[104:107]
buffer_store_dwordx4 a[224:227], v16, s[88:91], s8 offen sc1
v_mfma_f32_16x16x32_bf16 v[104:107], a[84:87], a[28:31], v[104:107]
v_mfma_f32_16x16x32_bf16 v[112:115], a[84:87], a[32:35], v[112:115]
v_mfma_f32_16x16x32_bf16 v[112:115], a[80:83], a[12:15], v[112:115]
v_mfma_f32_16x16x32_bf16 v[116:119], a[88:91], a[12:15], v[116:119]
ds_read_b64_tr_b16 a[80:81], v14 offset:0
s_waitcnt lgkmcnt(11)
v_mfma_f32_16x16x32_bf16 v[116:119], a[92:95], a[32:35], v[116:119]
ds_read_b64_tr_b16 a[82:83], v14 offset:256
s_add_u32 m0, s16, 0x8000
v_mfma_f32_16x16x32_bf16 v[108:111], a[92:95], a[28:31], v[108:111]
buffer_load_dwordx4 v22, s[44:47], s20 offen lds
v_mfma_f32_16x16x32_bf16 v[108:111], a[88:91], a[8:11], v[108:111]
ds_read_b64_tr_b16 a[84:85], v14 offset:2048
v_mfma_f32_16x16x32_bf16 v[100:103], a[88:91], a[4:7], v[100:103]
ds_read_b64_tr_b16 a[86:87], v14 offset:2304
v_mfma_f32_16x16x32_bf16 v[100:103], a[92:95], a[24:27], v[100:103]
v_mfma_f32_16x16x32_bf16 v[92:95], a[92:95], a[20:23], v[92:95]
v_mfma_f32_16x16x32_bf16 v[92:95], a[88:91], a[0:3], v[92:95]
s_add_u32 m0, s16, 0x8400
s_waitcnt lgkmcnt(4)
v_mfma_f32_16x16x32_bf16 v[120:123], a[96:99], a[0:3], v[120:123]
buffer_load_dwordx4 v23, s[44:47], s20 offen lds
v_mfma_f32_16x16x32_bf16 v[120:123], a[100:103], a[20:23], v[120:123]
ds_read_b64_tr_b16 a[88:89], v15 offset:0
v_mfma_f32_16x16x32_bf16 v[128:131], a[100:103], a[24:27], v[128:131]
ds_read_b64_tr_b16 a[90:91], v15 offset:256
v_mfma_f32_16x16x32_bf16 v[128:131], a[96:99], a[4:7], v[128:131]
ds_read_b64_tr_b16 a[92:93], v15 offset:2048
v_mfma_f32_16x16x32_bf16 v[136:139], a[96:99], a[8:11], v[136:139]
ds_read_b64_tr_b16 a[94:95], v15 offset:2304
v_mfma_f32_16x16x32_bf16 v[136:139], a[100:103], a[28:31], v[136:139]
s_add_u32 m0, s16, 0x8800
v_mfma_f32_16x16x32_bf16 v[144:147], a[100:103], a[32:35], v[144:147]
buffer_load_dwordx4 v22, s[44:47], s21 offen lds
v_mfma_f32_16x16x32_bf16 v[144:147], a[96:99], a[12:15], v[144:147]
v_mfma_f32_16x16x32_bf16 v[148:151], a[104:107], a[12:15], v[148:151]
ds_read_b64_tr_b16 a[96:97], v14 offset:4096
v_mfma_f32_16x16x32_bf16 v[148:151], a[108:111], a[32:35], v[148:151]
ds_read_b64_tr_b16 a[98:99], v14 offset:4352
v_mfma_f32_16x16x32_bf16 v[140:143], a[108:111], a[28:31], v[140:143]
ds_read_b64_tr_b16 a[100:101], v14 offset:6144
v_mfma_f32_16x16x32_bf16 v[140:143], a[104:107], a[8:11], v[140:143]
ds_read_b64_tr_b16 a[102:103], v14 offset:6400
s_add_u32 m0, s16, 0x8c00
v_mfma_f32_16x16x32_bf16 v[132:135], a[104:107], a[4:7], v[132:135]
buffer_load_dwordx4 v23, s[44:47], s21 offen lds
v_mfma_f32_16x16x32_bf16 v[132:135], a[108:111], a[24:27], v[132:135]
v_mfma_f32_16x16x32_bf16 v[124:127], a[108:111], a[20:23], v[124:127]
v_mfma_f32_16x16x32_bf16 v[124:127], a[104:107], a[0:3], v[124:127]
s_waitcnt lgkmcnt(4)
v_mfma_f32_16x16x32_bf16 v[152:155], a[80:83], a[0:3], v[152:155]
ds_read_b64_tr_b16 a[104:105], v15 offset:4096
v_mfma_f32_16x16x32_bf16 v[152:155], a[84:87], a[20:23], v[152:155]
ds_read_b64_tr_b16 a[106:107], v15 offset:4352
s_add_u32 m0, s16, 0x9000
v_mfma_f32_16x16x32_bf16 v[160:163], a[84:87], a[24:27], v[160:163]
buffer_load_dwordx4 v22, s[44:47], s22 offen lds
v_mfma_f32_16x16x32_bf16 v[160:163], a[80:83], a[4:7], v[160:163]
ds_read_b64_tr_b16 a[108:109], v15 offset:6144
v_mfma_f32_16x16x32_bf16 v[168:171], a[80:83], a[8:11], v[168:171]
ds_read_b64_tr_b16 a[110:111], v15 offset:6400
v_mfma_f32_16x16x32_bf16 v[168:171], a[84:87], a[28:31], v[168:171]
v_mfma_f32_16x16x32_bf16 v[176:179], a[84:87], a[32:35], v[176:179]
v_mfma_f32_16x16x32_bf16 v[176:179], a[80:83], a[12:15], v[176:179]
s_add_u32 m0, s16, 0x9400
v_mfma_f32_16x16x32_bf16 v[180:183], a[88:91], a[12:15], v[180:183]
buffer_load_dwordx4 v23, s[44:47], s22 offen lds
v_mfma_f32_16x16x32_bf16 v[180:183], a[92:95], a[32:35], v[180:183]
ds_read_b64_tr_b16 a[80:81], v14 offset:8192
v_mfma_f32_16x16x32_bf16 v[172:175], a[92:95], a[28:31], v[172:175]
ds_read_b64_tr_b16 a[82:83], v14 offset:8448
v_mfma_f32_16x16x32_bf16 v[172:175], a[88:91], a[8:11], v[172:175]
ds_read_b64_tr_b16 a[84:85], v14 offset:10240
v_mfma_f32_16x16x32_bf16 v[164:167], a[88:91], a[4:7], v[164:167]
ds_read_b64_tr_b16 a[86:87], v14 offset:10496
v_mfma_f32_16x16x32_bf16 v[164:167], a[92:95], a[24:27], v[164:167]
s_add_u32 m0, s16, 0x9800
v_mfma_f32_16x16x32_bf16 v[156:159], a[92:95], a[20:23], v[156:159]
buffer_load_dwordx4 v22, s[44:47], s23 offen lds
v_mfma_f32_16x16x32_bf16 v[156:159], a[88:91], a[0:3], v[156:159]
s_waitcnt lgkmcnt(4)
v_mfma_f32_16x16x32_bf16 v[184:187], a[96:99], a[0:3], v[184:187]
ds_read_b64_tr_b16 a[88:89], v15 offset:8192
v_mfma_f32_16x16x32_bf16 v[184:187], a[100:103], a[20:23], v[184:187]
ds_read_b64_tr_b16 a[90:91], v15 offset:8448
v_mfma_f32_16x16x32_bf16 v[192:195], a[100:103], a[24:27], v[192:195]
ds_read_b64_tr_b16 a[92:93], v15 offset:10240
v_mfma_f32_16x16x32_bf16 v[192:195], a[96:99], a[4:7], v[192:195]
ds_read_b64_tr_b16 a[94:95], v15 offset:10496
s_add_u32 m0, s16, 0x9c00
v_mfma_f32_16x16x32_bf16 v[200:203], a[96:99], a[8:11], v[200:203]
buffer_load_dwordx4 v23, s[44:47], s23 offen lds
v_mfma_f32_16x16x32_bf16 v[200:203], a[100:103], a[28:31], v[200:203]
v_add_u32 v22, 0x80, v22
v_add_u32 v23, 0x80, v23
v_mfma_f32_16x16x32_bf16 v[208:211], a[100:103], a[32:35], v[208:211]
v_add_u32 v12, 0x8000, v12
v_add_u32 v13, 0x8000, v13
v_mfma_f32_16x16x32_bf16 v[208:211], a[96:99], a[12:15], v[208:211]
v_add_u32 v14, 0x8000, v14
v_add_u32 v15, 0x8000, v15
v_mfma_f32_16x16x32_bf16 v[248:251], a[96:99], a[16:19], v[248:251]
v_add_u32 v10, 0x8000, v10
v_add_u32 v11, 0x8000, v11
v_mfma_f32_16x16x32_bf16 v[248:251], a[100:103], a[36:39], v[248:251]
v_mfma_f32_16x16x32_bf16 v[212:215], a[104:107], a[12:15], v[212:215]
s_waitcnt vmcnt(28) lgkmcnt(0)
v_mfma_f32_16x16x32_bf16 v[212:215], a[108:111], a[32:35], v[212:215]
s_barrier
s_add_u32 m0, s17, 0x8000
v_mfma_f32_16x16x32_bf16 v[204:207], a[108:111], a[28:31], v[204:207]
buffer_load_dwordx4 v5, s[52:55], 0 offen lds
v_mfma_f32_16x16x32_bf16 v[204:207], a[104:107], a[8:11], v[204:207]
ds_read_b64_tr_b16 a[96:97], v12 offset:0
v_mfma_f32_16x16x32_bf16 v[196:199], a[104:107], a[4:7], v[196:199]
ds_read_b64_tr_b16 a[98:99], v12 offset:1024
v_mfma_f32_16x16x32_bf16 v[196:199], a[108:111], a[24:27], v[196:199]
ds_read_b64_tr_b16 a[100:101], v12 offset:8192
v_mfma_f32_16x16x32_bf16 v[188:191], a[108:111], a[20:23], v[188:191]
ds_read_b64_tr_b16 a[102:103], v12 offset:9216
v_mfma_f32_16x16x32_bf16 v[188:191], a[104:107], a[0:3], v[188:191]
s_add_u32 m0, s17, 0x8400
s_waitcnt lgkmcnt(4)
v_mfma_f32_16x16x32_bf16 v[216:219], a[0:3], a[80:83], v[216:219]
buffer_load_dwordx4 v5, s[52:55], s13 offen lds
v_mfma_f32_16x16x32_bf16 v[216:219], a[20:23], a[84:87], v[216:219]
ds_read_b64_tr_b16 a[104:105], v13 offset:0
v_mfma_f32_16x16x32_bf16 v[224:227], a[24:27], a[84:87], v[224:227]
ds_read_b64_tr_b16 a[106:107], v13 offset:1024
v_mfma_f32_16x16x32_bf16 v[224:227], a[4:7], a[80:83], v[224:227]
ds_read_b64_tr_b16 a[108:109], v13 offset:8192
v_mfma_f32_16x16x32_bf16 v[232:235], a[8:11], a[80:83], v[232:235]
ds_read_b64_tr_b16 a[110:111], v13 offset:9216
v_mfma_f32_16x16x32_bf16 v[232:235], a[28:31], a[84:87], v[232:235]
s_add_u32 s8, s28, 0x9000
v_mfma_f32_16x16x32_bf16 v[240:243], a[32:35], a[84:87], v[240:243]
buffer_store_dwordx4 a[228:231], v16, s[88:91], s8 offen sc1
v_mfma_f32_16x16x32_bf16 v[240:243], a[12:15], a[80:83], v[240:243]
v_mfma_f32_16x16x32_bf16 v[252:255], a[16:19], a[80:83], v[252:255]
v_mfma_f32_16x16x32_bf16 v[252:255], a[36:39], a[84:87], v[252:255]
v_mfma_f32_16x16x32_bf16 v[244:247], a[12:15], a[88:91], v[244:247]
ds_read_b64_tr_b16 a[80:81], v12 offset:256
v_mfma_f32_16x16x32_bf16 v[244:247], a[32:35], a[92:95], v[244:247]
ds_read_b64_tr_b16 a[82:83], v12 offset:1280
s_add_u32 m0, s17, 0x8800
v_mfma_f32_16x16x32_bf16 v[236:239], a[28:31], a[92:95], v[236:239]
buffer_load_dwordx4 v6, s[52:55], 0 offen lds
v_mfma_f32_16x16x32_bf16 v[236:239], a[8:11], a[88:91], v[236:239]
ds_read_b64_tr_b16 a[84:85], v12 offset:8448
v_mfma_f32_16x16x32_bf16 v[228:231], a[4:7], a[88:91], v[228:231]
ds_read_b64_tr_b16 a[86:87], v12 offset:9472
v_mfma_f32_16x16x32_bf16 v[228:231], a[24:27], a[92:95], v[228:231]
v_mfma_f32_16x16x32_bf16 v[220:223], a[20:23], a[92:95], v[220:223]
v_mfma_f32_16x16x32_bf16 v[220:223], a[0:3], a[88:91], v[220:223]
s_add_u32 m0, s17, 0x8c00
s_waitcnt lgkmcnt(4)
L_S17:
v_mfma_f32_16x16x32_bf16 v[24:27], a[96:99], a[40:43], v[24:27]
buffer_load_dwordx4 v6, s[52:55], s13 offen lds
v_mfma_f32_16x16x32_bf16 v[24:27], a[100:103], a[60:63], v[24:27]
ds_read_b64_tr_b16 a[88:89], v13 offset:256
s_waitcnt vmcnt(24)
v_mfma_f32_16x16x32_bf16 v[32:35], a[100:103], a[64:67], v[32:35]
ds_read_b64_tr_b16 a[90:91], v13 offset:1280
v_mfma_f32_16x16x32_bf16 v[32:35], a[96:99], a[44:47], v[32:35]
ds_read_b64_tr_b16 a[92:93], v13 offset:8448
v_mfma_f32_16x16x32_bf16 v[40:43], a[96:99], a[48:51], v[40:43]
ds_read_b64_tr_b16 a[94:95], v13 offset:9472
v_mfma_f32_16x16x32_bf16 v[40:43], a[100:103], a[68:71], v[40:43]
ds_read_b128 a[0:3], v8 offset:0
s_add_u32 m0, s18, 0xc000
v_mfma_f32_16x16x32_bf16 v[48:51], a[100:103], a[72:75], v[48:51]
buffer_load_dwordx4 v7, s[68:71], 0 offen lds
v_mfma_f32_16x16x32_bf16 v[48:51], a[96:99], a[52:55], v[48:51]
ds_read_b128 a[20:23], v9 offset:0
v_mfma_f32_16x16x32_bf16 v[52:55], a[104:107], a[52:55], v[52:55]
ds_read_b64_tr_b16 a[96:97], v12 offset:512
v_mfma_f32_16x16x32_bf16 v[52:55], a[108:111], a[72:75], v[52:55]
ds_read_b64_tr_b16 a[98:99], v12 offset:1536
v_mfma_f32_16x16x32_bf16 v[44:47], a[108:111], a[68:71], v[44:47]
ds_read_b64_tr_b16 a[100:101], v12 offset:8704
v_mfma_f32_16x16x32_bf16 v[44:47], a[104:107], a[48:51], v[44:47]
ds_read_b64_tr_b16 a[102:103], v12 offset:9728
s_add_u32 s8, s28, 0x5400
v_mfma_f32_16x16x32_bf16 v[36:39], a[104:107], a[44:47], v[36:39]
buffer_store_dwordx4 a[112:115], v16, s[88:91], s8 offen sc1
v_mfma_f32_16x16x32_bf16 v[36:39], a[108:111], a[64:67], v[36:39]
ds_read_b128 a[4:7], v8 offset:2048
v_mfma_f32_16x16x32_bf16 v[28:31], a[108:111], a[60:63], v[28:31]
ds_read_b128 a[24:27], v9 offset:2048
v_mfma_f32_16x16x32_bf16 v[28:31], a[104:107], a[40:43], v[28:31]
ds_read_b128 a[8:11], v8 offset:4096
s_waitcnt lgkmcnt(9)
v_mfma_f32_16x16x32_bf16 v[56:59], a[80:83], a[40:43], v[56:59]
ds_read_b64_tr_b16 a[104:105], v13 offset:512
v_mfma_f32_16x16x32_bf16 v[56:59], a[84:87], a[60:63], v[56:59]
ds_read_b64_tr_b16 a[106:107], v13 offset:1536
s_add_u32 m0, s18, 0xd000
v_mfma_f32_16x16x32_bf16 v[64:67], a[84:87], a[64:67], v[64:67]
buffer_load_dwordx4 v7, s[68:71], s25 offen lds
v_mfma_f32_16x16x32_bf16 v[64:67], a[80:83], a[44:47], v[64:67]
ds_read_b64_tr_b16 a[108:109], v13 offset:8704
v_mfma_f32_16x16x32_bf16 v[72:75], a[80:83], a[48:51], v[72:75]
ds_read_b64_tr_b16 a[110:111], v13 offset:9728
v_mfma_f32_16x16x32_bf16 v[72:75], a[84:87], a[68:71], v[72:75]
ds_read_b128 a[28:31], v9 offset:4096
v_mfma_f32_16x16x32_bf16 v[80:83], a[84:87], a[72:75], v[80:83]
ds_read_b128 a[12:15], v8 offset:6144
v_mfma_f32_16x16x32_bf16 v[80:83], a[80:83], a[52:55], v[80:83]
ds_read_b128 a[32:35], v9 offset:6144
s_add_u32 m0, s18, 0xe000
v_mfma_f32_16x16x32_bf16 v[84:87], a[88:91], a[52:55], v[84:87]
buffer_load_dwordx4 v7, s[68:71], s26 offen lds
v_mfma_f32_16x16x32_bf16 v[84:87], a[92:95], a[72:75], v[84:87]
ds_read_b64_tr_b16 a[80:81], v12 offset:768
v_mfma_f32_16x16x32_bf16 v[76:79], a[92:95], a[68:71], v[76:79]
ds_read_b64_tr_b16 a[82:83], v12 offset:1792
v_mfma_f32_16x16x32_bf16 v[76:79], a[88:91], a[48:51], v[76:79]
ds_read_b64_tr_b16 a[84:85], v12 offset:8960
v_mfma_f32_16x16x32_bf16 v[68:71], a[88:91], a[44:47], v[68:71]
ds_read_b64_tr_b16 a[86:87], v12 offset:9984
s_waitcnt lgkmcnt(7)
v_mfma_f32_16x16x32_bf16 v[68:71], a[92:95], a[64:67], v[68:71]
ds_read_b128 a[56:59], v10
s_add_u32 m0, s18, 0xf000
v_mfma_f32_16x16x32_bf16 v[60:63], a[92:95], a[60:63], v[60:63]
buffer_load_dwordx4 v4, s[44:47], s24 offen lds
v_mfma_f32_16x16x32_bf16 v[60:63], a[88:91], a[40:43], v[60:63]
ds_read_b128 a[76:79], v11
v_add_u32 v5, 0x80000, v5
v_mfma_f32_16x16x32_bf16 v[88:91], a[96:99], a[40:43], v[88:91]
ds_read_b64_tr_b16 a[88:89], v13 offset:768
v_add_u32 v6, 0x80000, v6
v_mfma_f32_16x16x32_bf16 v[88:91], a[100:103], a[60:63], v[88:91]
ds_read_b64_tr_b16 a[90:91], v13 offset:1792
v_add_u32 v7, 0x60000, v7
v_mfma_f32_16x16x32_bf16 v[96:99], a[100:103], a[64:67], v[96:99]
ds_read_b64_tr_b16 a[92:93], v13 offset:8960
v_add_u32 v4, 0x80, v4
v_mfma_f32_16x16x32_bf16 v[96:99], a[96:99], a[44:47], v[96:99]
ds_read_b64_tr_b16 a[94:95], v13 offset:9984
s_add_u32 s8, s28, 0x9400
v_mfma_f32_16x16x32_bf16 v[104:107], a[96:99], a[48:51], v[104:107]
buffer_store_dwordx4 a[116:119], v16, s[88:91], s8 offen sc1
v_mfma_f32_16x16x32_bf16 v[104:107], a[100:103], a[68:71], v[104:107]
v_mfma_f32_16x16x32_bf16 v[112:115], a[100:103], a[72:75], v[112:115]
v_mfma_f32_16x16x32_bf16 v[112:115], a[96:99], a[52:55], v[112:115]
v_mfma_f32_16x16x32_bf16 v[116:119], a[104:107], a[52:55], v[116:119]
ds_read_b64_tr_b16 a[96:97], v14 offset:0
s_waitcnt lgkmcnt(11)
v_mfma_f32_16x16x32_bf16 v[116:119], a[108:111], a[72:75], v[116:119]
ds_read_b64_tr_b16 a[98:99], v14 offset:256
s_add_u32 m0, s16, 0x0
v_mfma_f32_16x16x32_bf16 v[108:111], a[108:111], a[68:71], v[108:111]
buffer_load_dwordx4 v22, s[44:47], s20 offen lds
v_mfma_f32_16x16x32_bf16 v[108:111], a[104:107], a[48:51], v[108:111]
ds_read_b64_tr_b16 a[100:101], v14 offset:2048
v_mfma_f32_16x16x32_bf16 v[100:103], a[104:107], a[44:47], v[100:103]
ds_read_b64_tr_b16 a[102:103], v14 offset:2304
v_mfma_f32_16x16x32_bf16 v[100:103], a[108:111], a[64:67], v[100:103]
v_mfma_f32_16x16x32_bf16 v[92:95], a[108:111], a[60:63], v[92:95]
v_mfma_f32_16x16x32_bf16 v[92:95], a[104:107], a[40:43], v[92:95]
s_add_u32 m0, s16, 0x400
s_waitcnt lgkmcnt(4)
v_mfma_f32_16x16x32_bf16 v[120:123], a[80:83], a[40:43], v[120:123]
buffer_load_dwordx4 v23, s[44:47], s20 offen lds
v_mfma_f32_16x16x32_bf16 v[120:123], a[84:87], a[60:63], v[120:123]
ds_read_b64_tr_b16 a[104:105], v15 offset:0
v_mfma_f32_16x16x32_bf16 v[128:131], a[84:87], a[64:67], v[128:131]
ds_read_b64_tr_b16 a[106:107], v15 offset:256
v_mfma_f32_16x16x32_bf16 v[128:131], a[80:83], a[44:47], v[128:131]
ds_read_b64_tr_b16 a[108:109], v15 offset:2048
v_mfma_f32_16x16x32_bf16 v[136:139], a[80:83], a[48:51], v[136:139]
ds_read_b64_tr_b16 a[110:111], v15 offset:2304
v_mfma_f32_16x16x32_bf16 v[136:139], a[84:87], a[68:71], v[136:139]
s_add_u32 m0, s16, 0x800
v_mfma_f32_16x16x32_bf16 v[144:147], a[84:87], a[72:75], v[144:147]
buffer_load_dwordx4 v22, s[44:47], s21 offen lds
v_mfma_f32_16x16x32_bf16 v[144:147], a[80:83], a[52:55], v[144:147]
v_mfma_f32_16x16x32_bf16 v[148:151], a[88:91], a[52:55], v[148:151]
ds_read_b64_tr_b16 a[80:81], v14 offset:4096
v_mfma_f32_16x16x32_bf16 v[148:151], a[92:95], a[72:75], v[148:151]
ds_read_b64_tr_b16 a[82:83], v14 offset:4352
v_mfma_f32_16x16x32_bf16 v[140:143], a[92:95], a[68:71], v[140:143]
ds_read_b64_tr_b16 a[84:85], v14 offset:6144
v_mfma_f32_16x16x32_bf16 v[140:143], a[88:91], a[48:51], v[140:143]
ds_read_b64_tr_b16 a[86:87], v14 offset:6400
s_add_u32 m0, s16, 0xc00
v_mfma_f32_16x16x32_bf16 v[132:135], a[88:91], a[44:47], v[132:135]
buffer_load_dwordx4 v23, s[44:47], s21 offen lds
v_mfma_f32_16x16x32_bf16 v[132:135], a[92:95], a[64:67], v[132:135]
v_mfma_f32_16x16x32_bf16 v[124:127], a[92:95], a[60:63], v[124:127]
v_mfma_f32_16x16x32_bf16 v[124:127], a[88:91], a[40:43], v[124:127]
s_waitcnt lgkmcnt(4)
v_mfma_f32_16x16x32_bf16 v[152:155], a[96:99], a[40:43], v[152:155]
ds_read_b64_tr_b16 a[88:89], v15 offset:4096
v_mfma_f32_16x16x32_bf16 v[152:155], a[100:103], a[60:63], v[152:155]
ds_read_b64_tr_b16 a[90:91], v15 offset:4352
s_add_u32 m0, s16, 0x1000
v_mfma_f32_16x16x32_bf16 v[160:163], a[100:103], a[64:67], v[160:163]
buffer_load_dwordx4 v22, s[44:47], s22 offen lds
v_mfma_f32_16x16x32_bf16 v[160:163], a[96:99], a[44:47], v[160:163]
ds_read_b64_tr_b16 a[92:93], v15 offset:6144
v_mfma_f32_16x16x32_bf16 v[168:171], a[96:99], a[48:51], v[168:171]
ds_read_b64_tr_b16 a[94:95], v15 offset:6400
v_mfma_f32_16x16x32_bf16 v[168:171], a[100:103], a[68:71], v[168:171]
v_mfma_f32_16x16x32_bf16 v[176:179], a[100:103], a[72:75], v[176:179]
v_mfma_f32_16x16x32_bf16 v[176:179], a[96:99], a[52:55], v[176:179]
s_add_u32 m0, s16, 0x1400
v_mfma_f32_16x16x32_bf16 v[180:183], a[104:107], a[52:55], v[180:183]
buffer_load_dwordx4 v23, s[44:47], s22 offen lds
v_mfma_f32_16x16x32_bf16 v[180:183], a[108:111], a[72:75], v[180:183]
ds_read_b64_tr_b16 a[96:97], v14 offset:8192
v_mfma_f32_16x16x32_bf16 v[172:175], a[108:111], a[68:71], v[172:175]
ds_read_b64_tr_b16 a[98:99], v14 offset:8448
v_mfma_f32_16x16x32_bf16 v[172:175], a[104:107], a[48:51], v[172:175]
ds_read_b64_tr_b16 a[100:101], v14 offset:10240
v_mfma_f32_16x16x32_bf16 v[164:167], a[104:107], a[44:47], v[164:167]
ds_read_b64_tr_b16 a[102:103], v14 offset:10496
v_mfma_f32_16x16x32_bf16 v[164:167], a[108:111], a[64:67], v[164:167]
s_add_u32 m0, s16, 0x1800
v_mfma_f32_16x16x32_bf16 v[156:159], a[108:111], a[60:63], v[156:159]
buffer_load_dwordx4 v22, s[44:47], s23 offen lds
v_mfma_f32_16x16x32_bf16 v[156:159], a[104:107], a[40:43], v[156:159]
s_waitcnt lgkmcnt(4)
v_mfma_f32_16x16x32_bf16 v[184:187], a[80:83], a[40:43], v[184:187]
ds_read_b64_tr_b16 a[104:105], v15 offset:8192
v_mfma_f32_16x16x32_bf16 v[184:187], a[84:87], a[60:63], v[184:187]
ds_read_b64_tr_b16 a[106:107], v15 offset:8448
v_mfma_f32_16x16x32_bf16 v[192:195], a[84:87], a[64:67], v[192:195]
ds_read_b64_tr_b16 a[108:109], v15 offset:10240
v_mfma_f32_16x16x32_bf16 v[192:195], a[80:83], a[44:47], v[192:195]
ds_read_b64_tr_b16 a[110:111], v15 offset:10496
s_add_u32 m0, s16, 0x1c00
v_mfma_f32_16x16x32_bf16 v[200:203], a[80:83], a[48:51], v[200:203]
buffer_load_dwordx4 v23, s[44:47], s23 offen lds
v_mfma_f32_16x16x32_bf16 v[200:203], a[84:87], a[68:71], v[200:203]
v_add_u32 v22, 0x80, v22
v_add_u32 v23, 0x80, v23
v_mfma_f32_16x16x32_bf16 v[208:211], a[84:87], a[72:75], v[208:211]
v_add_u32 v12, 0xffff0000, v12
v_add_u32 v13, 0xffff0000, v13
v_mfma_f32_16x16x32_bf16 v[208:211], a[80:83], a[52:55], v[208:211]
v_add_u32 v14, 0xffff0000, v14
v_add_u32 v15, 0xffff0000, v15
v_mfma_f32_16x16x32_bf16 v[248:251], a[80:83], a[56:59], v[248:251]
v_add_u32 v10, 0xffff0000, v10
v_add_u32 v11, 0xffff0000, v11
v_mfma_f32_16x16x32_bf16 v[248:251], a[84:87], a[76:79], v[248:251]
v_mfma_f32_16x16x32_bf16 v[212:215], a[88:91], a[52:55], v[212:215]
s_waitcnt vmcnt(28) lgkmcnt(0)
v_mfma_f32_16x16x32_bf16 v[212:215], a[92:95], a[72:75], v[212:215]
s_barrier
s_add_u32 m0, s17, 0x10000
v_mfma_f32_16x16x32_bf16 v[204:207], a[92:95], a[68:71], v[204:207]
buffer_load_dwordx4 v5, s[52:55], 0 offen lds
v_mfma_f32_16x16x32_bf16 v[204:207], a[88:91], a[48:51], v[204:207]
ds_read_b64_tr_b16 a[80:81], v12 offset:0
v_mfma_f32_16x16x32_bf16 v[196:199], a[88:91], a[44:47], v[196:199]
ds_read_b64_tr_b16 a[82:83], v12 offset:1024
s_waitcnt lgkmcnt(2)
v_mfma_f32_16x16x32_bf16 v[196:199], a[92:95], a[64:67], v[196:199]
ds_read_b64_tr_b16 a[84:85], v12 offset:8192
v_mov_b32 v21, s1
v_mfma_f32_16x16x32_bf16 v[188:191], a[92:95], a[60:63], v[188:191]
ds_read_b64_tr_b16 a[86:87], v12 offset:9216
v_add_u32 v20, s0, v16
v_mfma_f32_16x16x32_bf16 v[188:191], a[88:91], a[40:43], v[188:191]
global_load_dword a120, v[20:21], off sc1
v_mfma_f32_16x16x32_bf16 v[216:219], a[40:43], a[96:99], v[216:219]
ds_read_b64_tr_b16 a[88:89], v13 offset:0
v_mfma_f32_16x16x32_bf16 v[216:219], a[60:63], a[100:103], v[216:219]
ds_read_b64_tr_b16 a[90:91], v13 offset:1024
v_mfma_f32_16x16x32_bf16 v[224:227], a[64:67], a[100:103], v[224:227]
ds_read_b64_tr_b16 a[92:93], v13 offset:8192
v_mfma_f32_16x16x32_bf16 v[224:227], a[44:47], a[96:99], v[224:227]
ds_read_b64_tr_b16 a[94:95], v13 offset:9216
s_add_u32 m0, s17, 0x10400
v_mfma_f32_16x16x32_bf16 v[232:235], a[48:51], a[96:99], v[232:235]
buffer_load_dwordx4 v5, s[52:55], s13 offen lds
v_mfma_f32_16x16x32_bf16 v[232:235], a[68:71], a[100:103], v[232:235]
v_mfma_f32_16x16x32_bf16 v[240:243], a[72:75], a[100:103], v[240:243]
v_mfma_f32_16x16x32_bf16 v[240:243], a[52:55], a[96:99], v[240:243]
v_mfma_f32_16x16x32_bf16 v[252:255], a[56:59], a[96:99], v[252:255]
v_mfma_f32_16x16x32_bf16 v[252:255], a[76:79], a[100:103], v[252:255]
s_add_u32 m0, s17, 0x10800
v_mfma_f32_16x16x32_bf16 v[244:247], a[52:55], a[104:107], v[244:247]
buffer_load_dwordx4 v6, s[52:55], 0 offen lds
v_mfma_f32_16x16x32_bf16 v[244:247], a[72:75], a[108:111], v[244:247]
ds_read_b64_tr_b16 a[96:97], v12 offset:256
v_mfma_f32_16x16x32_bf16 v[236:239], a[68:71], a[108:111], v[236:239]
ds_read_b64_tr_b16 a[98:99], v12 offset:1280
v_mfma_f32_16x16x32_bf16 v[236:239], a[48:51], a[104:107], v[236:239]
ds_read_b64_tr_b16 a[100:101], v12 offset:8448
v_mfma_f32_16x16x32_bf16 v[228:231], a[44:47], a[104:107], v[228:231]
ds_read_b64_tr_b16 a[102:103], v12 offset:9472
s_add_u32 s8, s28, 0x5800
v_mfma_f32_16x16x32_bf16 v[228:231], a[64:67], a[108:111], v[228:231]
buffer_store_dwordx4 a[124:127], v16, s[88:91], s8 offen sc1
v_mfma_f32_16x16x32_bf16 v[220:223], a[60:63], a[108:111], v[220:223]
v_mfma_f32_16x16x32_bf16 v[220:223], a[40:43], a[104:107], v[220:223]
s_waitcnt lgkmcnt(4)
L_S18:
v_mfma_f32_16x16x32_bf16 v[24:27], a[80:83], a[0:3], v[24:27]
ds_read_b64_tr_b16 a[104:105], v13 offset:256
s_waitcnt vmcnt(24)
v_mfma_f32_16x16x32_bf16 v[24:27], a[84:87], a[20:23], v[24:27]
ds_read_b64_tr_b16 a[106:107], v13 offset:1280
v_mfma_f32_16x16x32_bf16 v[32:35], a[84:87], a[24:27], v[32:35]
ds_read_b64_tr_b16 a[108:109], v13 offset:8448
s_add_u32 m0, s17, 0x10c00
v_mfma_f32_16x16x32_bf16 v[32:35], a[80:83], a[4:7], v[32:35]
buffer_load_dwordx4 v6, s[52:55], s13 offen lds
v_mfma_f32_16x16x32_bf16 v[40:43], a[80:83], a[8:11], v[40:43]
ds_read_b64_tr_b16 a[110:111], v13 offset:9472
v_mfma_f32_16x16x32_bf16 v[40:43], a[84:87], a[28:31], v[40:43]
ds_read_b128 a[40:43], v8 offset:32768
v_mfma_f32_16x16x32_bf16 v[48:51], a[84:87], a[32:35], v[48:51]
ds_read_b128 a[60:63], v9 offset:32768
v_mfma_f32_16x16x32_bf16 v[48:51], a[80:83], a[12:15], v[48:51]
ds_read_b128 a[44:47], v8 offset:34816
s_add_u32 s8, s28, 0x9800
v_mfma_f32_16x16x32_bf16 v[52:55], a[88:91], a[12:15], v[52:55]
buffer_store_dwordx4 a[232:235], v16, s[88:91], s8 offen sc1
v_mfma_f32_16x16x32_bf16 v[52:55], a[92:95], a[32:35], v[52:55]
ds_read_b64_tr_b16 a[80:81], v12 offset:512
v_mfma_f32_16x16x32_bf16 v[44:47], a[92:95], a[28:31], v[44:47]
ds_read_b64_tr_b16 a[82:83], v12 offset:1536
v_mfma_f32_16x16x32_bf16 v[44:47], a[88:91], a[8:11], v[44:47]
ds_read_b64_tr_b16 a[84:85], v12 offset:8704
v_mfma_f32_16x16x32_bf16 v[36:39], a[88:91], a[4:7], v[36:39]
ds_read_b64_tr_b16 a[86:87], v12 offset:9728
v_mfma_f32_16x16x32_bf16 v[36:39], a[92:95], a[24:27], v[36:39]
ds_read_b128 a[64:67], v9 offset:34816
s_add_u32 m0, s18, 0x14000
v_mfma_f32_16x16x32_bf16 v[28:31], a[92:95], a[20:23], v[28:31]
buffer_load_dwordx4 v7, s[68:71], 0 offen lds
v_mfma_f32_16x16x32_bf16 v[28:31], a[88:91], a[0:3], v[28:31]
ds_read_b128 a[48:51], v8 offset:36864
s_waitcnt lgkmcnt(9)
v_mfma_f32_16x16x32_bf16 v[56:59], a[96:99], a[0:3], v[56:59]
ds_read_b64_tr_b16 a[88:89], v13 offset:512
v_mfma_f32_16x16x32_bf16 v[56:59], a[100:103], a[20:23], v[56:59]
ds_read_b64_tr_b16 a[90:91], v13 offset:1536
v_mfma_f32_16x16x32_bf16 v[64:67], a[100:103], a[24:27], v[64:67]
ds_read_b64_tr_b16 a[92:93], v13 offset:8704
s_add_u32 m0, s18, 0x15000
v_mfma_f32_16x16x32_bf16 v[64:67], a[96:99], a[4:7], v[64:67]
buffer_load_dwordx4 v7, s[68:71], s25 offen lds
v_mfma_f32_16x16x32_bf16 v[72:75], a[96:99], a[8:11], v[72:75]
ds_read_b64_tr_b16 a[94:95], v13 offset:9728
v_mfma_f32_16x16x32_bf16 v[72:75], a[100:103], a[28:31], v[72:75]
ds_read_b128 a[68:71], v9 offset:36864
v_mfma_f32_16x16x32_bf16 v[80:83], a[100:103], a[32:35], v[80:83]
ds_read_b128 a[52:55], v8 offset:38912
v_mfma_f32_16x16x32_bf16 v[80:83], a[96:99], a[12:15], v[80:83]
ds_read_b128 a[72:75], v9 offset:38912
s_add_u32 s8, s28, 0x5c00
v_mfma_f32_16x16x32_bf16 v[84:87], a[104:107], a[12:15], v[84:87]
buffer_store_dwordx4 a[240:243], v16, s[88:91], s8 offen sc1
v_mfma_f32_16x16x32_bf16 v[84:87], a[108:111], a[32:35], v[84:87]
ds_read_b64_tr_b16 a[96:97], v12 offset:768
v_mfma_f32_16x16x32_bf16 v[76:79], a[108:111], a[28:31], v[76:79]
ds_read_b64_tr_b16 a[98:99], v12 offset:1792
v_mfma_f32_16x16x32_bf16 v[76:79], a[104:107], a[8:11], v[76:79]
ds_read_b64_tr_b16 a[100:101], v12 offset:8960
v_mfma_f32_16x16x32_bf16 v[68:71], a[104:107], a[4:7], v[68:71]
ds_read_b64_tr_b16 a[102:103], v12 offset:9984
v_mfma_f32_16x16x32_bf16 v[68:71], a[108:111], a[24:27], v[68:71]
ds_read_b128 a[16:19], v10
s_add_u32 m0, s18, 0x16000
v_mfma_f32_16x16x32_bf16 v[60:63], a[108:111], a[20:23], v[60:63]
buffer_load_dwordx4 v7, s[68:71], s26 offen lds
v_mfma_f32_16x16x32_bf16 v[60:63], a[104:107], a[0:3], v[60:63]
ds_read_b128 a[36:39], v11
s_waitcnt lgkmcnt(9)
v_mfma_f32_16x16x32_bf16 v[88:91], a[80:83], a[0:3], v[88:91]
ds_read_b64_tr_b16 a[104:105], v13 offset:768
v_mfma_f32_16x16x32_bf16 v[88:91], a[84:87], a[20:23], v[88:91]
ds_read_b64_tr_b16 a[106:107], v13 offset:1792
v_mfma_f32_16x16x32_bf16 v[96:99], a[84:87], a[24:27], v[96:99]
ds_read_b64_tr_b16 a[108:109], v13 offset:8960
s_add_u32 m0, s18, 0x17000
v_mfma_f32_16x16x32_bf16 v[96:99], a[80:83], a[4:7], v[96:99]
buffer_load_dwordx4 v4, s[44:47], s24 offen lds
v_mfma_f32_16x16x32_bf16 v[104:107], a[80:83], a[8:11], v[104:107]
ds_read_b64_tr_b16 a[110:111], v13 offset:9984
v_add_u32 v5, 0x80000, v5
v_mfma_f32_16x16x32_bf16 v[104:107], a[84:87], a[28:31], v[104:107]
v_add_u32 v6, 0x80000, v6
v_add_u32 v7, 0x60000, v7
v_mfma_f32_16x16x32_bf16 v[112:115], a[84:87], a[32:35], v[112:115]
v_add_u32 v4, 0x80, v4
v_mfma_f32_16x16x32_bf16 v[112:115], a[80:83], a[12:15], v[112:115]
v_mfma_f32_16x16x32_bf16 v[116:119], a[88:91], a[12:15], v[116:119]
ds_read_b64_tr_b16 a[80:81], v14 offset:0
s_add_u32 s8, s28, 0x9c00
v_mfma_f32_16x16x32_bf16 v[116:119], a[92:95], a[32:35], v[116:119]
buffer_store_dwordx4 a[248:251], v16, s[88:91], s8 offen sc1
v_mfma_f32_16x16x32_bf16 v[108:111], a[92:95], a[28:31], v[108:111]
ds_read_b64_tr_b16 a[82:83], v14 offset:256
v_mfma_f32_16x16x32_bf16 v[108:111], a[88:91], a[8:11], v[108:111]
ds_read_b64_tr_b16 a[84:85], v14 offset:2048
v_mfma_f32_16x16x32_bf16 v[100:103], a[88:91], a[4:7], v[100:103]
ds_read_b64_tr_b16 a[86:87], v14 offset:2304
v_mfma_f32_16x16x32_bf16 v[100:103], a[92:95], a[24:27], v[100:103]
s_add_u32 m0, s16, 0x8000
s_waitcnt lgkmcnt(14)
v_mfma_f32_16x16x32_bf16 v[92:95], a[92:95], a[20:23], v[92:95]
buffer_load_dwordx4 v22, s[44:47], s20 offen lds
v_mfma_f32_16x16x32_bf16 v[92:95], a[88:91], a[0:3], v[92:95]
s_waitcnt lgkmcnt(4)
v_mfma_f32_16x16x32_bf16 v[120:123], a[96:99], a[0:3], v[120:123]
ds_read_b64_tr_b16 a[88:89], v15 offset:0
v_mfma_f32_16x16x32_bf16 v[120:123], a[100:103], a[20:23], v[120:123]
ds_read_b64_tr_b16 a[90:91], v15 offset:256
v_mfma_f32_16x16x32_bf16 v[128:131], a[100:103], a[24:27], v[128:131]
ds_read_b64_tr_b16 a[92:93], v15 offset:2048
v_mfma_f32_16x16x32_bf16 v[128:131], a[96:99], a[4:7], v[128:131]
ds_read_b64_tr_b16 a[94:95], v15 offset:2304
s_add_u32 m0, s16, 0x8400
v_mfma_f32_16x16x32_bf16 v[136:139], a[96:99], a[8:11], v[136:139]
buffer_load_dwordx4 v23, s[44:47], s20 offen lds
v_mfma_f32_16x16x32_bf16 v[136:139], a[100:103], a[28:31], v[136:139]
v_mfma_f32_16x16x32_bf16 v[144:147], a[100:103], a[32:35], v[144:147]
v_mfma_f32_16x16x32_bf16 v[144:147], a[96:99], a[12:15], v[144:147]
v_mfma_f32_16x16x32_bf16 v[148:151], a[104:107], a[12:15], v[148:151]
ds_read_b64_tr_b16 a[96:97], v14 offset:4096
s_add_u32 m0, s16, 0x8800
v_mfma_f32_16x16x32_bf16 v[148:151], a[108:111], a[32:35], v[148:151]
buffer_load_dwordx4 v22, s[44:47], s21 offen lds
v_mfma_f32_16x16x32_bf16 v[140:143], a[108:111], a[28:31], v[140:143]
ds_read_b64_tr_b16 a[98:99], v14 offset:4352
v_mfma_f32_16x16x32_bf16 v[140:143], a[104:107], a[8:11], v[140:143]
ds_read_b64_tr_b16 a[100:101], v14 offset:6144
v_mfma_f32_16x16x32_bf16 v[132:135], a[104:107], a[4:7], v[132:135]
ds_read_b64_tr_b16 a[102:103], v14 offset:6400
v_mfma_f32_16x16x32_bf16 v[132:135], a[108:111], a[24:27], v[132:135]
s_add_u32 m0, s16, 0x8c00
v_mfma_f32_16x16x32_bf16 v[124:127], a[108:111], a[20:23], v[124:127]
buffer_load_dwordx4 v23, s[44:47], s21 offen lds
v_mfma_f32_16x16x32_bf16 v[124:127], a[104:107], a[0:3], v[124:127]
s_waitcnt lgkmcnt(4)
v_mfma_f32_16x16x32_bf16 v[152:155], a[80:83], a[0:3], v[152:155]
ds_read_b64_tr_b16 a[104:105], v15 offset:4096
v_mfma_f32_16x16x32_bf16 v[152:155], a[84:87], a[20:23], v[152:155]
ds_read_b64_tr_b16 a[106:107], v15 offset:4352
v_mfma_f32_16x16x32_bf16 v[160:163], a[84:87], a[24:27], v[160:163]
ds_read_b64_tr_b16 a[108:109], v15 offset:6144
v_mfma_f32_16x16x32_bf16 v[160:163], a[80:83], a[4:7], v[160:163]
ds_read_b64_tr_b16 a[110:111], v15 offset:6400
s_add_u32 m0, s16, 0x9000
v_mfma_f32_16x16x32_bf16 v[168:171], a[80:83], a[8:11], v[168:171]
buffer_load_dwordx4 v22, s[44:47], s22 offen lds
v_mfma_f32_16x16x32_bf16 v[168:171], a[84:87], a[28:31], v[168:171]
v_mfma_f32_16x16x32_bf16 v[176:179], a[84:87], a[32:35], v[176:179]
v_mfma_f32_16x16x32_bf16 v[176:179], a[80:83], a[12:15], v[176:179]
v_mfma_f32_16x16x32_bf16 v[180:183], a[88:91], a[12:15], v[180:183]
ds_read_b64_tr_b16 a[80:81], v14 offset:8192
s_add_u32 m0, s16, 0x9400
v_mfma_f32_16x16x32_bf16 v[180:183], a[92:95], a[32:35], v[180:183]
buffer_load_dwordx4 v23, s[44:47], s22 offen lds
v_mfma_f32_16x16x32_bf16 v[172:175], a[92:95], a[28:31], v[172:175]
ds_read_b64_tr_b16 a[82:83], v14 offset:8448
v_mfma_f32_16x16x32_bf16 v[172:175], a[88:91], a[8:11], v[172:175]
ds_read_b64_tr_b16 a[84:85], v14 offset:10240
v_mfma_f32_16x16x32_bf16 v[164:167], a[88:91], a[4:7], v[164:167]
ds_read_b64_tr_b16 a[86:87], v14 offset:10496
v_mfma_f32_16x16x32_bf16 v[164:167], a[92:95], a[24:27], v[164:167]
v_mfma_f32_16x16x32_bf16 v[156:159], a[92:95], a[20:23], v[156:159]
s_add_u32 m0, s16, 0x9800
s_waitcnt lgkmcnt(4)
v_mfma_f32_16x16x32_bf16 v[156:159], a[88:91], a[0:3], v[156:159]
buffer_load_dwordx4 v22, s[44:47], s23 offen lds
v_mfma_f32_16x16x32_bf16 v[184:187], a[96:99], a[0:3], v[184:187]
ds_read_b64_tr_b16 a[88:89], v15 offset:8192
v_mfma_f32_16x16x32_bf16 v[184:187], a[100:103], a[20:23], v[184:187]
ds_read_b64_tr_b16 a[90:91], v15 offset:8448
v_mfma_f32_16x16x32_bf16 v[192:195], a[100:103], a[24:27], v[192:195]
ds_read_b64_tr_b16 a[92:93], v15 offset:10240
v_mfma_f32_16x16x32_bf16 v[192:195], a[96:99], a[4:7], v[192:195]
ds_read_b64_tr_b16 a[94:95], v15 offset:10496
s_add_u32 m0, s16, 0x9c00
v_mfma_f32_16x16x32_bf16 v[200:203], a[96:99], a[8:11], v[200:203]
buffer_load_dwordx4 v23, s[44:47], s23 offen lds
v_mfma_f32_16x16x32_bf16 v[200:203], a[100:103], a[28:31], v[200:203]
v_add_u32 v22, 0x80, v22
v_add_u32 v23, 0x80, v23
v_mfma_f32_16x16x32_bf16 v[208:211], a[100:103], a[32:35], v[208:211]
v_add_u32 v12, 0x8000, v12
v_add_u32 v13, 0x8000, v13
v_mfma_f32_16x16x32_bf16 v[208:211], a[96:99], a[12:15], v[208:211]
v_add_u32 v14, 0x8000, v14
v_add_u32 v15, 0x8000, v15
v_mfma_f32_16x16x32_bf16 v[248:251], a[96:99], a[16:19], v[248:251]
v_add_u32 v10, 0x8000, v10
v_add_u32 v11, 0x8000, v11
v_mfma_f32_16x16x32_bf16 v[248:251], a[100:103], a[36:39], v[248:251]
v_mfma_f32_16x16x32_bf16 v[212:215], a[104:107], a[12:15], v[212:215]
s_waitcnt vmcnt(30) lgkmcnt(0)
v_mfma_f32_16x16x32_bf16 v[212:215], a[108:111], a[32:35], v[212:215]
s_barrier
s_add_u32 m0, s17, 0x0
v_mfma_f32_16x16x32_bf16 v[204:207], a[108:111], a[28:31], v[204:207]
buffer_load_dwordx4 v5, s[52:55], 0 offen lds
v_mfma_f32_16x16x32_bf16 v[204:207], a[104:107], a[8:11], v[204:207]
ds_read_b64_tr_b16 a[96:97], v12 offset:0
v_mfma_f32_16x16x32_bf16 v[196:199], a[104:107], a[4:7], v[196:199]
ds_read_b64_tr_b16 a[98:99], v12 offset:1024
v_mfma_f32_16x16x32_bf16 v[196:199], a[108:111], a[24:27], v[196:199]
ds_read_b64_tr_b16 a[100:101], v12 offset:8192
v_mfma_f32_16x16x32_bf16 v[188:191], a[108:111], a[20:23], v[188:191]
ds_read_b64_tr_b16 a[102:103], v12 offset:9216
v_mfma_f32_16x16x32_bf16 v[188:191], a[104:107], a[0:3], v[188:191]
s_waitcnt lgkmcnt(4)
v_mfma_f32_16x16x32_bf16 v[216:219], a[0:3], a[80:83], v[216:219]
ds_read_b64_tr_b16 a[104:105], v13 offset:0
s_add_u32 m0, s17, 0x400
v_mfma_f32_16x16x32_bf16 v[216:219], a[20:23], a[84:87], v[216:219]
buffer_load_dwordx4 v5, s[52:55], s13 offen lds
v_mfma_f32_16x16x32_bf16 v[224:227], a[24:27], a[84:87], v[224:227]
ds_read_b64_tr_b16 a[106:107], v13 offset:1024
v_mfma_f32_16x16x32_bf16 v[224:227], a[4:7], a[80:83], v[224:227]
ds_read_b64_tr_b16 a[108:109], v13 offset:8192
v_mfma_f32_16x16x32_bf16 v[232:235], a[8:11], a[80:83], v[232:235]
ds_read_b64_tr_b16 a[110:111], v13 offset:9216
v_mfma_f32_16x16x32_bf16 v[232:235], a[28:31], a[84:87], v[232:235]
v_mfma_f32_16x16x32_bf16 v[240:243], a[32:35], a[84:87], v[240:243]
v_mfma_f32_16x16x32_bf16 v[240:243], a[12:15], a[80:83], v[240:243]
s_add_u32 m0, s17, 0x800
v_mfma_f32_16x16x32_bf16 v[252:255], a[16:19], a[80:83], v[252:255]
buffer_load_dwordx4 v6, s[52:55], 0 offen lds
v_mfma_f32_16x16x32_bf16 v[252:255], a[36:39], a[84:87], v[252:255]
v_mfma_f32_16x16x32_bf16 v[244:247], a[12:15], a[88:91], v[244:247]
ds_read_b64_tr_b16 a[80:81], v12 offset:256
v_mfma_f32_16x16x32_bf16 v[244:247], a[32:35], a[92:95], v[244:247]
ds_read_b64_tr_b16 a[82:83], v12 offset:1280
v_mfma_f32_16x16x32_bf16 v[236:239], a[28:31], a[92:95], v[236:239]
ds_read_b64_tr_b16 a[84:85], v12 offset:8448
v_mfma_f32_16x16x32_bf16 v[236:239], a[8:11], a[88:91], v[236:239]
ds_read_b64_tr_b16 a[86:87], v12 offset:9472
v_mfma_f32_16x16x32_bf16 v[228:231], a[4:7], a[88:91], v[228:231]
s_add_u32 m0, s17, 0xc00
v_mfma_f32_16x16x32_bf16 v[228:231], a[24:27], a[92:95], v[228:231]
buffer_load_dwordx4 v6, s[52:55], s13 offen lds
v_mfma_f32_16x16x32_bf16 v[220:223], a[20:23], a[92:95], v[220:223]
v_mfma_f32_16x16x32_bf16 v[220:223], a[0:3], a[88:91], v[220:223]
s_waitcnt lgkmcnt(4)
L_S19:
v_mfma_f32_16x16x32_bf16 v[24:27], a[96:99], a[40:43], v[24:27]
ds_read_b64_tr_b16 a[88:89], v13 offset:256
s_waitcnt vmcnt(25)
v_mfma_f32_16x16x32_bf16 v[24:27], a[100:103], a[60:63], v[24:27]
ds_read_b64_tr_b16 a[90:91], v13 offset:1280
v_mfma_f32_16x16x32_bf16 v[32:35], a[100:103], a[64:67], v[32:35]
ds_read_b64_tr_b16 a[92:93], v13 offset:8448
v_mfma_f32_16x16x32_bf16 v[32:35], a[96:99], a[44:47], v[32:35]
ds_read_b64_tr_b16 a[94:95], v13 offset:9472
s_add_u32 m0, s18, 0x4000
v_mfma_f32_16x16x32_bf16 v[40:43], a[96:99], a[48:51], v[40:43]
buffer_load_dwordx4 v7, s[68:71], 0 offen lds
v_mfma_f32_16x16x32_bf16 v[40:43], a[100:103], a[68:71], v[40:43]
ds_read_b128 a[0:3], v8 offset:0
v_mfma_f32_16x16x32_bf16 v[48:51], a[100:103], a[72:75], v[48:51]
ds_read_b128 a[20:23], v9 offset:0
v_mfma_f32_16x16x32_bf16 v[48:51], a[96:99], a[52:55], v[48:51]
ds_read_b128 a[4:7], v8 offset:2048
v_mfma_f32_16x16x32_bf16 v[52:55], a[104:107], a[52:55], v[52:55]
ds_read_b64_tr_b16 a[96:97], v12 offset:512
v_mfma_f32_16x16x32_bf16 v[52:55], a[108:111], a[72:75], v[52:55]
ds_read_b64_tr_b16 a[98:99], v12 offset:1536
v_mfma_f32_16x16x32_bf16 v[44:47], a[108:111], a[68:71], v[44:47]
ds_read_b64_tr_b16 a[100:101], v12 offset:8704
s_add_u32 m0, s18, 0x5000
v_mfma_f32_16x16x32_bf16 v[44:47], a[104:107], a[48:51], v[44:47]
buffer_load_dwordx4 v7, s[68:71], s25 offen lds
v_mfma_f32_16x16x32_bf16 v[36:39], a[104:107], a[44:47], v[36:39]
ds_read_b64_tr_b16 a[102:103], v12 offset:9728
v_mfma_f32_16x16x32_bf16 v[36:39], a[108:111], a[64:67], v[36:39]
ds_read_b128 a[24:27], v9 offset:2048
v_mfma_f32_16x16x32_bf16 v[28:31], a[108:111], a[60:63], v[28:31]
ds_read_b128 a[8:11], v8 offset:4096
v_mfma_f32_16x16x32_bf16 v[28:31], a[104:107], a[40:43], v[28:31]
ds_read_b128 a[28:31], v9 offset:4096
s_waitcnt lgkmcnt(10)
v_mfma_f32_16x16x32_bf16 v[56:59], a[80:83], a[40:43], v[56:59]
ds_read_b64_tr_b16 a[104:105], v13 offset:512
v_mfma_f32_16x16x32_bf16 v[56:59], a[84:87], a[60:63], v[56:59]
ds_read_b64_tr_b16 a[106:107], v13 offset:1536
s_add_u32 m0, s18, 0x6000
v_mfma_f32_16x16x32_bf16 v[64:67], a[84:87], a[64:67], v[64:67]
buffer_load_dwordx4 v7, s[68:71], s26 offen lds
v_mfma_f32_16x16x32_bf16 v[64:67], a[80:83], a[44:47], v[64:67]
ds_read_b64_tr_b16 a[108:109], v13 offset:8704
v_mfma_f32_16x16x32_bf16 v[72:75], a[80:83], a[48:51], v[72:75]
ds_read_b64_tr_b16 a[110:111], v13 offset:9728
v_mfma_f32_16x16x32_bf16 v[72:75], a[84:87], a[68:71], v[72:75]
ds_read_b128 a[12:15], v8 offset:6144
v_mfma_f32_16x16x32_bf16 v[80:83], a[84:87], a[72:75], v[80:83]
ds_read_b128 a[32:35], v9 offset:6144
v_mfma_f32_16x16x32_bf16 v[80:83], a[80:83], a[52:55], v[80:83]
ds_read_b128 a[56:59], v10
v_mfma_f32_16x16x32_bf16 v[84:87], a[88:91], a[52:55], v[84:87]
ds_read_b64_tr_b16 a[80:81], v12 offset:768
s_add_u32 m0, s18, 0x7000
v_mfma_f32_16x16x32_bf16 v[84:87], a[92:95], a[72:75], v[84:87]
buffer_load_dwordx4 v4, s[44:47], s24 offen lds
v_mfma_f32_16x16x32_bf16 v[76:79], a[92:95], a[68:71], v[76:79]
ds_read_b64_tr_b16 a[82:83], v12 offset:1792
v_add_u32 v5, 0x80000, v5
v_mfma_f32_16x16x32_bf16 v[76:79], a[88:91], a[48:51], v[76:79]
ds_read_b64_tr_b16 a[84:85], v12 offset:8960
v_add_u32 v6, 0x80000, v6
v_mfma_f32_16x16x32_bf16 v[68:71], a[88:91], a[44:47], v[68:71]
ds_read_b64_tr_b16 a[86:87], v12 offset:9984
v_add_u32 v7, 0x60000, v7
v_mfma_f32_16x16x32_bf16 v[68:71], a[92:95], a[64:67], v[68:71]
ds_read_b128 a[76:79], v11
v_add_u32 v4, 0x80, v4
v_mfma_f32_16x16x32_bf16 v[60:63], a[92:95], a[60:63], v[60:63]
v_mfma_f32_16x16x32_bf16 v[60:63], a[88:91], a[40:43], v[60:63]
s_waitcnt lgkmcnt(6)
s_waitcnt lgkmcnt(8)
v_mfma_f32_16x16x32_bf16 v[88:91], a[96:99], a[40:43], v[88:91]
ds_read_b64_tr_b16 a[88:89], v13 offset:768
s_add_u32 m0, s16, 0x0
v_mfma_f32_16x16x32_bf16 v[88:91], a[100:103], a[60:63], v[88:91]
buffer_load_dwordx4 v22, s[44:47], s20 offen lds
v_mfma_f32_16x16x32_bf16 v[96:99], a[100:103], a[64:67], v[96:99]
ds_read_b64_tr_b16 a[90:91], v13 offset:1792
v_mfma_f32_16x16x32_bf16 v[96:99], a[96:99], a[44:47], v[96:99]
ds_read_b64_tr_b16 a[92:93], v13 offset:8960
v_mfma_f32_16x16x32_bf16 v[104:107], a[96:99], a[48:51], v[104:107]
ds_read_b64_tr_b16 a[94:95], v13 offset:9984
v_mfma_f32_16x16x32_bf16 v[104:107], a[100:103], a[68:71], v[104:107]
v_mfma_f32_16x16x32_bf16 v[112:115], a[100:103], a[72:75], v[112:115]
v_mfma_f32_16x16x32_bf16 v[112:115], a[96:99], a[52:55], v[112:115]
s_add_u32 m0, s16, 0x400
v_mfma_f32_16x16x32_bf16 v[116:119], a[104:107], a[52:55], v[116:119]
buffer_load_dwordx4 v23, s[44:47], s20 offen lds
v_mfma_f32_16x16x32_bf16 v[116:119], a[108:111], a[72:75], v[116:119]
ds_read_b64_tr_b16 a[96:97], v14 offset:0
v_mfma_f32_16x16x32_bf16 v[108:111], a[108:111], a[68:71], v[108:111]
ds_read_b64_tr_b16 a[98:99], v14 offset:256
v_mfma_f32_16x16x32_bf16 v[108:111], a[104:107], a[48:51], v[108:111]
ds_read_b64_tr_b16 a[100:101], v14 offset:2048
v_mfma_f32_16x16x32_bf16 v[100:103], a[104:107], a[44:47], v[100:103]
ds_read_b64_tr_b16 a[102:103], v14 offset:2304
v_mfma_f32_16x16x32_bf16 v[100:103], a[108:111], a[64:67], v[100:103]
v_mfma_f32_16x16x32_bf16 v[92:95], a[108:111], a[60:63], v[92:95]
s_add_u32 m0, s16, 0x800
s_waitcnt lgkmcnt(4)
v_mfma_f32_16x16x32_bf16 v[92:95], a[104:107], a[40:43], v[92:95]
buffer_load_dwordx4 v22, s[44:47], s21 offen lds
v_mfma_f32_16x16x32_bf16 v[120:123], a[80:83], a[40:43], v[120:123]
ds_read_b64_tr_b16 a[104:105], v15 offset:0
v_mfma_f32_16x16x32_bf16 v[120:123], a[84:87], a[60:63], v[120:123]
ds_read_b64_tr_b16 a[106:107], v15 offset:256
v_mfma_f32_16x16x32_bf16 v[128:131], a[84:87], a[64:67], v[128:131]
ds_read_b64_tr_b16 a[108:109], v15 offset:2048
v_mfma_f32_16x16x32_bf16 v[128:131], a[80:83], a[44:47], v[128:131]
ds_read_b64_tr_b16 a[110:111], v15 offset:2304
v_mfma_f32_16x16x32_bf16 v[136:139], a[80:83], a[48:51], v[136:139]
v_mfma_f32_16x16x32_bf16 v[136:139], a[84:87], a[68:71], v[136:139]
s_add_u32 m0, s16, 0xc00
v_mfma_f32_16x16x32_bf16 v[144:147], a[84:87], a[72:75], v[144:147]
buffer_load_dwordx4 v23, s[44:47], s21 offen lds
v_mfma_f32_16x16x32_bf16 v[144:147], a[80:83], a[52:55], v[144:147]
v_mfma_f32_16x16x32_bf16 v[148:151], a[88:91], a[52:55], v[148:151]
ds_read_b64_tr_b16 a[80:81], v14 offset:4096
v_mfma_f32_16x16x32_bf16 v[148:151], a[92:95], a[72:75], v[148:151]
ds_read_b64_tr_b16 a[82:83], v14 offset:4352
v_mfma_f32_16x16x32_bf16 v[140:143], a[92:95], a[68:71], v[140:143]
ds_read_b64_tr_b16 a[84:85], v14 offset:6144
v_mfma_f32_16x16x32_bf16 v[140:143], a[88:91], a[48:51], v[140:143]
ds_read_b64_tr_b16 a[86:87], v14 offset:6400
v_mfma_f32_16x16x32_bf16 v[132:135], a[88:91], a[44:47], v[132:135]
s_add_u32 m0, s16, 0x1000
v_mfma_f32_16x16x32_bf16 v[132:135], a[92:95], a[64:67], v[132:135]
buffer_load_dwordx4 v22, s[44:47], s22 offen lds
v_mfma_f32_16x16x32_bf16 v[124:127], a[92:95], a[60:63], v[124:127]
v_mfma_f32_16x16x32_bf16 v[124:127], a[88:91], a[40:43], v[124:127]
s_waitcnt lgkmcnt(4)
v_mfma_f32_16x16x32_bf16 v[152:155], a[96:99], a[40:43], v[152:155]
ds_read_b64_tr_b16 a[88:89], v15 offset:4096
v_mfma_f32_16x16x32_bf16 v[152:155], a[100:103], a[60:63], v[152:155]
ds_read_b64_tr_b16 a[90:91], v15 offset:4352
v_mfma_f32_16x16x32_bf16 v[160:163], a[100:103], a[64:67], v[160:163]
ds_read_b64_tr_b16 a[92:93], v15 offset:6144
v_mfma_f32_16x16x32_bf16 v[160:163], a[96:99], a[44:47], v[160:163]
ds_read_b64_tr_b16 a[94:95], v15 offset:6400
s_add_u32 m0, s16, 0x1400
v_mfma_f32_16x16x32_bf16 v[168:171], a[96:99], a[48:51], v[168:171]
buffer_load_dwordx4 v23, s[44:47], s22 offen lds
v_mfma_f32_16x16x32_bf16 v[168:171], a[100:103], a[68:71], v[168:171]
v_mfma_f32_16x16x32_bf16 v[176:179], a[100:103], a[72:75], v[176:179]
v_mfma_f32_16x16x32_bf16 v[176:179], a[96:99], a[52:55], v[176:179]
v_mfma_f32_16x16x32_bf16 v[180:183], a[104:107], a[52:55], v[180:183]
ds_read_b64_tr_b16 a[96:97], v14 offset:8192
v_mfma_f32_16x16x32_bf16 v[180:183], a[108:111], a[72:75], v[180:183]
ds_read_b64_tr_b16 a[98:99], v14 offset:8448
v_mfma_f32_16x16x32_bf16 v[172:175], a[108:111], a[68:71], v[172:175]
ds_read_b64_tr_b16 a[100:101], v14 offset:10240
s_add_u32 m0, s16, 0x1800
v_mfma_f32_16x16x32_bf16 v[172:175], a[104:107], a[48:51], v[172:175]
buffer_load_dwordx4 v22, s[44:47], s23 offen lds
v_mfma_f32_16x16x32_bf16 v[164:167], a[104:107], a[44:47], v[164:167]
ds_read_b64_tr_b16 a[102:103], v14 offset:10496
v_mfma_f32_16x16x32_bf16 v[164:167], a[108:111], a[64:67], v[164:167]
v_mfma_f32_16x16x32_bf16 v[156:159], a[108:111], a[60:63], v[156:159]
v_mfma_f32_16x16x32_bf16 v[156:159], a[104:107], a[40:43], v[156:159]
s_waitcnt lgkmcnt(4)
v_mfma_f32_16x16x32_bf16 v[184:187], a[80:83], a[40:43], v[184:187]
ds_read_b64_tr_b16 a[104:105], v15 offset:8192
v_mfma_f32_16x16x32_bf16 v[184:187], a[84:87], a[60:63], v[184:187]
ds_read_b64_tr_b16 a[106:107], v15 offset:8448
s_add_u32 m0, s16, 0x1c00
v_mfma_f32_16x16x32_bf16 v[192:195], a[84:87], a[64:67], v[192:195]
buffer_load_dwordx4 v23, s[44:47], s23 offen lds
v_mfma_f32_16x16x32_bf16 v[192:195], a[80:83], a[44:47], v[192:195]
ds_read_b64_tr_b16 a[108:109], v15 offset:10240
v_add_u32 v22, 0x80, v22
v_mfma_f32_16x16x32_bf16 v[200:203], a[80:83], a[48:51], v[200:203]
ds_read_b64_tr_b16 a[110:111], v15 offset:10496
v_add_u32 v23, 0x80, v23
v_mfma_f32_16x16x32_bf16 v[200:203], a[84:87], a[68:71], v[200:203]
v_add_u32 v12, 0x8000, v12
v_add_u32 v13, 0x8000, v13
v_mfma_f32_16x16x32_bf16 v[208:211], a[84:87], a[72:75], v[208:211]
v_add_u32 v14, 0x8000, v14
v_add_u32 v15, 0x8000, v15
v_mfma_f32_16x16x32_bf16 v[208:211], a[80:83], a[52:55], v[208:211]
v_add_u32 v10, 0x8000, v10
v_add_u32 v11, 0x8000, v11
v_mfma_f32_16x16x32_bf16 v[248:251], a[80:83], a[56:59], v[248:251]
v_mfma_f32_16x16x32_bf16 v[248:251], a[84:87], a[76:79], v[248:251]
v_mfma_f32_16x16x32_bf16 v[212:215], a[88:91], a[52:55], v[212:215]
s_waitcnt vmcnt(24) lgkmcnt(0)
v_mfma_f32_16x16x32_bf16 v[212:215], a[92:95], a[72:75], v[212:215]
s_barrier
s_add_u32 m0, s17, 0x8000
s_cmp_lg_u32 s4, 0
s_cbranch_scc1 L_sig_kv
v_mov_b32 v20, 1
s_mov_b64 exec, 1
buffer_atomic_add v20, off, s[84:87], s10 sc1
s_mov_b64 exec, -1
L_sig_kv:
v_mfma_f32_16x16x32_bf16 v[204:207], a[92:95], a[68:71], v[204:207]
buffer_load_dwordx4 v5, s[52:55], 0 offen lds
v_mfma_f32_16x16x32_bf16 v[204:207], a[88:91], a[48:51], v[204:207]
ds_read_b64_tr_b16 a[80:81], v12 offset:0
v_mfma_f32_16x16x32_bf16 v[196:199], a[88:91], a[44:47], v[196:199]
ds_read_b64_tr_b16 a[82:83], v12 offset:1024
v_mfma_f32_16x16x32_bf16 v[196:199], a[92:95], a[64:67], v[196:199]
ds_read_b64_tr_b16 a[84:85], v12 offset:8192
v_mfma_f32_16x16x32_bf16 v[188:191], a[92:95], a[60:63], v[188:191]
ds_read_b64_tr_b16 a[86:87], v12 offset:9216
v_mfma_f32_16x16x32_bf16 v[188:191], a[88:91], a[40:43], v[188:191]
s_waitcnt lgkmcnt(4)
v_mfma_f32_16x16x32_bf16 v[216:219], a[40:43], a[96:99], v[216:219]
ds_read_b64_tr_b16 a[88:89], v13 offset:0
s_add_u32 m0, s17, 0x8400
v_mfma_f32_16x16x32_bf16 v[216:219], a[60:63], a[100:103], v[216:219]
buffer_load_dwordx4 v5, s[52:55], s13 offen lds
v_mfma_f32_16x16x32_bf16 v[224:227], a[64:67], a[100:103], v[224:227]
ds_read_b64_tr_b16 a[90:91], v13 offset:1024
v_mfma_f32_16x16x32_bf16 v[224:227], a[44:47], a[96:99], v[224:227]
ds_read_b64_tr_b16 a[92:93], v13 offset:8192
v_mfma_f32_16x16x32_bf16 v[232:235], a[48:51], a[96:99], v[232:235]
ds_read_b64_tr_b16 a[94:95], v13 offset:9216
v_mfma_f32_16x16x32_bf16 v[232:235], a[68:71], a[100:103], v[232:235]
v_mfma_f32_16x16x32_bf16 v[240:243], a[72:75], a[100:103], v[240:243]
v_mfma_f32_16x16x32_bf16 v[240:243], a[52:55], a[96:99], v[240:243]
s_add_u32 m0, s17, 0x8800
v_mfma_f32_16x16x32_bf16 v[252:255], a[56:59], a[96:99], v[252:255]
buffer_load_dwordx4 v6, s[52:55], 0 offen lds
v_mfma_f32_16x16x32_bf16 v[252:255], a[76:79], a[100:103], v[252:255]
v_mfma_f32_16x16x32_bf16 v[244:247], a[52:55], a[104:107], v[244:247]
ds_read_b64_tr_b16 a[96:97], v12 offset:256
v_mfma_f32_16x16x32_bf16 v[244:247], a[72:75], a[108:111], v[244:247]
ds_read_b64_tr_b16 a[98:99], v12 offset:1280
v_mfma_f32_16x16x32_bf16 v[236:239], a[68:71], a[108:111], v[236:239]
ds_read_b64_tr_b16 a[100:101], v12 offset:8448
v_mfma_f32_16x16x32_bf16 v[236:239], a[48:51], a[104:107], v[236:239]
ds_read_b64_tr_b16 a[102:103], v12 offset:9472
v_mfma_f32_16x16x32_bf16 v[228:231], a[44:47], a[104:107], v[228:231]
s_add_u32 m0, s17, 0x8c00
v_mfma_f32_16x16x32_bf16 v[228:231], a[64:67], a[108:111], v[228:231]
buffer_load_dwordx4 v6, s[52:55], s13 offen lds
v_mfma_f32_16x16x32_bf16 v[220:223], a[60:63], a[108:111], v[220:223]
v_mfma_f32_16x16x32_bf16 v[220:223], a[40:43], a[104:107], v[220:223]
s_waitcnt lgkmcnt(4)
L_S20:
v_mfma_f32_16x16x32_bf16 v[24:27], a[80:83], a[0:3], v[24:27]
ds_read_b64_tr_b16 a[104:105], v13 offset:256
s_waitcnt vmcnt(20)
v_mfma_f32_16x16x32_bf16 v[24:27], a[84:87], a[20:23], v[24:27]
ds_read_b64_tr_b16 a[106:107], v13 offset:1280
v_mfma_f32_16x16x32_bf16 v[32:35], a[84:87], a[24:27], v[32:35]
ds_read_b64_tr_b16 a[108:109], v13 offset:8448
v_mfma_f32_16x16x32_bf16 v[32:35], a[80:83], a[4:7], v[32:35]
ds_read_b64_tr_b16 a[110:111], v13 offset:9472
s_add_u32 m0, s18, 0xc000
v_mfma_f32_16x16x32_bf16 v[40:43], a[80:83], a[8:11], v[40:43]
buffer_load_dwordx4 v7, s[68:71], 0 offen lds
v_mfma_f32_16x16x32_bf16 v[40:43], a[84:87], a[28:31], v[40:43]
ds_read_b128 a[40:43], v8 offset:32768
v_mfma_f32_16x16x32_bf16 v[48:51], a[84:87], a[32:35], v[48:51]
ds_read_b128 a[60:63], v9 offset:32768
v_mfma_f32_16x16x32_bf16 v[48:51], a[80:83], a[12:15], v[48:51]
ds_read_b128 a[44:47], v8 offset:34816
v_mfma_f32_16x16x32_bf16 v[52:55], a[88:91], a[12:15], v[52:55]
ds_read_b64_tr_b16 a[80:81], v12 offset:512
v_mfma_f32_16x16x32_bf16 v[52:55], a[92:95], a[32:35], v[52:55]
ds_read_b64_tr_b16 a[82:83], v12 offset:1536
v_mfma_f32_16x16x32_bf16 v[44:47], a[92:95], a[28:31], v[44:47]
ds_read_b64_tr_b16 a[84:85], v12 offset:8704
s_add_u32 m0, s18, 0xd000
v_mfma_f32_16x16x32_bf16 v[44:47], a[88:91], a[8:11], v[44:47]
buffer_load_dwordx4 v7, s[68:71], s25 offen lds
v_mfma_f32_16x16x32_bf16 v[36:39], a[88:91], a[4:7], v[36:39]
ds_read_b64_tr_b16 a[86:87], v12 offset:9728
v_mfma_f32_16x16x32_bf16 v[36:39], a[92:95], a[24:27], v[36:39]
ds_read_b128 a[64:67], v9 offset:34816
v_mfma_f32_16x16x32_bf16 v[28:31], a[92:95], a[20:23], v[28:31]
ds_read_b128 a[48:51], v8 offset:36864
v_mfma_f32_16x16x32_bf16 v[28:31], a[88:91], a[0:3], v[28:31]
ds_read_b128 a[68:71], v9 offset:36864
s_waitcnt lgkmcnt(10)
v_mfma_f32_16x16x32_bf16 v[56:59], a[96:99], a[0:3], v[56:59]
ds_read_b64_tr_b16 a[88:89], v13 offset:512
v_mfma_f32_16x16x32_bf16 v[56:59], a[100:103], a[20:23], v[56:59]
ds_read_b64_tr_b16 a[90:91], v13 offset:1536
s_add_u32 m0, s18, 0xe000
v_mfma_f32_16x16x32_bf16 v[64:67], a[100:103], a[24:27], v[64:67]
buffer_load_dwordx4 v7, s[68:71], s26 offen lds
v_mfma_f32_16x16x32_bf16 v[64:67], a[96:99], a[4:7], v[64:67]
ds_read_b64_tr_b16 a[92:93], v13 offset:8704
v_mfma_f32_16x16x32_bf16 v[72:75], a[96:99], a[8:11], v[72:75]
ds_read_b64_tr_b16 a[94:95], v13 offset:9728
v_mfma_f32_16x16x32_bf16 v[72:75], a[100:103], a[28:31], v[72:75]
ds_read_b128 a[52:55], v8 offset:38912
v_mfma_f32_16x16x32_bf16 v[80:83], a[100:103], a[32:35], v[80:83]
ds_read_b128 a[72:75], v9 offset:38912
v_mfma_f32_16x16x32_bf16 v[80:83], a[96:99], a[12:15], v[80:83]
ds_read_b128 a[16:19], v10
v_mfma_f32_16x16x32_bf16 v[84:87], a[104:107], a[12:15], v[84:87]
ds_read_b64_tr_b16 a[96:97], v12 offset:768
s_add_u32 m0, s18, 0xf000
v_mfma_f32_16x16x32_bf16 v[84:87], a[108:111], a[32:35], v[84:87]
buffer_load_dwordx4 v4, s[44:47], s24 offen lds
v_mfma_f32_16x16x32_bf16 v[76:79], a[108:111], a[28:31], v[76:79]
ds_read_b64_tr_b16 a[98:99], v12 offset:1792
v_add_u32 v5, 0x80000, v5
v_mfma_f32_16x16x32_bf16 v[76:79], a[104:107], a[8:11], v[76:79]
ds_read_b64_tr_b16 a[100:101], v12 offset:8960
v_add_u32 v6, 0x80000, v6
v_mfma_f32_16x16x32_bf16 v[68:71], a[104:107], a[4:7], v[68:71]
ds_read_b64_tr_b16 a[102:103], v12 offset:9984
v_add_u32 v7, 0x60000, v7
v_mfma_f32_16x16x32_bf16 v[68:71], a[108:111], a[24:27], v[68:71]
ds_read_b128 a[36:39], v11
v_add_u32 v4, 0x80, v4
v_mfma_f32_16x16x32_bf16 v[60:63], a[108:111], a[20:23], v[60:63]
v_mfma_f32_16x16x32_bf16 v[60:63], a[104:107], a[0:3], v[60:63]
s_waitcnt lgkmcnt(6)
s_waitcnt lgkmcnt(8)
v_mfma_f32_16x16x32_bf16 v[88:91], a[80:83], a[0:3], v[88:91]
ds_read_b64_tr_b16 a[104:105], v13 offset:768
s_add_u32 m0, s16, 0x8000
v_mfma_f32_16x16x32_bf16 v[88:91], a[84:87], a[20:23], v[88:91]
buffer_load_dwordx4 v22, s[44:47], s20 offen lds
v_mfma_f32_16x16x32_bf16 v[96:99], a[84:87], a[24:27], v[96:99]
ds_read_b64_tr_b16 a[106:107], v13 offset:1792
v_mfma_f32_16x16x32_bf16 v[96:99], a[80:83], a[4:7], v[96:99]
ds_read_b64_tr_b16 a[108:109], v13 offset:8960
v_mfma_f32_16x16x32_bf16 v[104:107], a[80:83], a[8:11], v[104:107]
ds_read_b64_tr_b16 a[110:111], v13 offset:9984
v_mfma_f32_16x16x32_bf16 v[104:107], a[84:87], a[28:31], v[104:107]
v_mfma_f32_16x16x32_bf16 v[112:115], a[84:87], a[32:35], v[112:115]
v_mfma_f32_16x16x32_bf16 v[112:115], a[80:83], a[12:15], v[112:115]
s_add_u32 m0, s16, 0x8400
v_mfma_f32_16x16x32_bf16 v[116:119], a[88:91], a[12:15], v[116:119]
buffer_load_dwordx4 v23, s[44:47], s20 offen lds
v_mfma_f32_16x16x32_bf16 v[116:119], a[92:95], a[32:35], v[116:119]
ds_read_b64_tr_b16 a[80:81], v14 offset:0
v_mfma_f32_16x16x32_bf16 v[108:111], a[92:95], a[28:31], v[108:111]
ds_read_b64_tr_b16 a[82:83], v14 offset:256
v_mfma_f32_16x16x32_bf16 v[108:111], a[88:91], a[8:11], v[108:111]
ds_read_b64_tr_b16 a[84:85], v14 offset:2048
v_mfma_f32_16x16x32_bf16 v[100:103], a[88:91], a[4:7], v[100:103]
ds_read_b64_tr_b16 a[86:87], v14 offset:2304
v_mfma_f32_16x16x32_bf16 v[100:103], a[92:95], a[24:27], v[100:103]
v_mfma_f32_16x16x32_bf16 v[92:95], a[92:95], a[20:23], v[92:95]
s_add_u32 m0, s16, 0x8800
s_waitcnt lgkmcnt(4)
v_mfma_f32_16x16x32_bf16 v[92:95], a[88:91], a[0:3], v[92:95]
buffer_load_dwordx4 v22, s[44:47], s21 offen lds
v_mfma_f32_16x16x32_bf16 v[120:123], a[96:99], a[0:3], v[120:123]
ds_read_b64_tr_b16 a[88:89], v15 offset:0
v_mfma_f32_16x16x32_bf16 v[120:123], a[100:103], a[20:23], v[120:123]
ds_read_b64_tr_b16 a[90:91], v15 offset:256
v_mfma_f32_16x16x32_bf16 v[128:131], a[100:103], a[24:27], v[128:131]
ds_read_b64_tr_b16 a[92:93], v15 offset:2048
v_mfma_f32_16x16x32_bf16 v[128:131], a[96:99], a[4:7], v[128:131]
ds_read_b64_tr_b16 a[94:95], v15 offset:2304
v_mfma_f32_16x16x32_bf16 v[136:139], a[96:99], a[8:11], v[136:139]
v_mfma_f32_16x16x32_bf16 v[136:139], a[100:103], a[28:31], v[136:139]
s_add_u32 m0, s16, 0x8c00
v_mfma_f32_16x16x32_bf16 v[144:147], a[100:103], a[32:35], v[144:147]
buffer_load_dwordx4 v23, s[44:47], s21 offen lds
v_mfma_f32_16x16x32_bf16 v[144:147], a[96:99], a[12:15], v[144:147]
v_mfma_f32_16x16x32_bf16 v[148:151], a[104:107], a[12:15], v[148:151]
ds_read_b64_tr_b16 a[96:97], v14 offset:4096
v_mfma_f32_16x16x32_bf16 v[148:151], a[108:111], a[32:35], v[148:151]
ds_read_b64_tr_b16 a[98:99], v14 offset:4352
v_mfma_f32_16x16x32_bf16 v[140:143], a[108:111], a[28:31], v[140:143]
ds_read_b64_tr_b16 a[100:101], v14 offset:6144
v_mfma_f32_16x16x32_bf16 v[140:143], a[104:107], a[8:11], v[140:143]
ds_read_b64_tr_b16 a[102:103], v14 offset:6400
v_mfma_f32_16x16x32_bf16 v[132:135], a[104:107], a[4:7], v[132:135]
s_add_u32 m0, s16, 0x9000
v_mfma_f32_16x16x32_bf16 v[132:135], a[108:111], a[24:27], v[132:135]
buffer_load_dwordx4 v22, s[44:47], s22 offen lds
v_mfma_f32_16x16x32_bf16 v[124:127], a[108:111], a[20:23], v[124:127]
v_mfma_f32_16x16x32_bf16 v[124:127], a[104:107], a[0:3], v[124:127]
s_waitcnt lgkmcnt(4)
v_mfma_f32_16x16x32_bf16 v[152:155], a[80:83], a[0:3], v[152:155]
ds_read_b64_tr_b16 a[104:105], v15 offset:4096
v_mfma_f32_16x16x32_bf16 v[152:155], a[84:87], a[20:23], v[152:155]
ds_read_b64_tr_b16 a[106:107], v15 offset:4352
v_mfma_f32_16x16x32_bf16 v[160:163], a[84:87], a[24:27], v[160:163]
ds_read_b64_tr_b16 a[108:109], v15 offset:6144
v_mfma_f32_16x16x32_bf16 v[160:163], a[80:83], a[4:7], v[160:163]
ds_read_b64_tr_b16 a[110:111], v15 offset:6400
s_add_u32 m0, s16, 0x9400
v_mfma_f32_16x16x32_bf16 v[168:171], a[80:83], a[8:11], v[168:171]
buffer_load_dwordx4 v23, s[44:47], s22 offen lds
v_mfma_f32_16x16x32_bf16 v[168:171], a[84:87], a[28:31], v[168:171]
v_mfma_f32_16x16x32_bf16 v[176:179], a[84:87], a[32:35], v[176:179]
v_mfma_f32_16x16x32_bf16 v[176:179], a[80:83], a[12:15], v[176:179]
v_mfma_f32_16x16x32_bf16 v[180:183], a[88:91], a[12:15], v[180:183]
ds_read_b64_tr_b16 a[80:81], v14 offset:8192
v_mfma_f32_16x16x32_bf16 v[180:183], a[92:95], a[32:35], v[180:183]
ds_read_b64_tr_b16 a[82:83], v14 offset:8448
v_mfma_f32_16x16x32_bf16 v[172:175], a[92:95], a[28:31], v[172:175]
ds_read_b64_tr_b16 a[84:85], v14 offset:10240
s_add_u32 m0, s16, 0x9800
v_mfma_f32_16x16x32_bf16 v[172:175], a[88:91], a[8:11], v[172:175]
buffer_load_dwordx4 v22, s[44:47], s23 offen lds
v_mfma_f32_16x16x32_bf16 v[164:167], a[88:91], a[4:7], v[164:167]
ds_read_b64_tr_b16 a[86:87], v14 offset:10496
v_mfma_f32_16x16x32_bf16 v[164:167], a[92:95], a[24:27], v[164:167]
v_mfma_f32_16x16x32_bf16 v[156:159], a[92:95], a[20:23], v[156:159]
v_mfma_f32_16x16x32_bf16 v[156:159], a[88:91], a[0:3], v[156:159]
s_waitcnt lgkmcnt(4)
v_mfma_f32_16x16x32_bf16 v[184:187], a[96:99], a[0:3], v[184:187]
ds_read_b64_tr_b16 a[88:89], v15 offset:8192
v_mfma_f32_16x16x32_bf16 v[184:187], a[100:103], a[20:23], v[184:187]
ds_read_b64_tr_b16 a[90:91], v15 offset:8448
s_add_u32 m0, s16, 0x9c00
v_mfma_f32_16x16x32_bf16 v[192:195], a[100:103], a[24:27], v[192:195]
buffer_load_dwordx4 v23, s[44:47], s23 offen lds
v_mfma_f32_16x16x32_bf16 v[192:195], a[96:99], a[4:7], v[192:195]
ds_read_b64_tr_b16 a[92:93], v15 offset:10240
v_add_u32 v22, 0x80, v22
v_mfma_f32_16x16x32_bf16 v[200:203], a[96:99], a[8:11], v[200:203]
ds_read_b64_tr_b16 a[94:95], v15 offset:10496
v_add_u32 v23, 0x80, v23
v_mfma_f32_16x16x32_bf16 v[200:203], a[100:103], a[28:31], v[200:203]
v_add_u32 v12, 0xffff0000, v12
v_add_u32 v13, 0xffff0000, v13
v_mfma_f32_16x16x32_bf16 v[208:211], a[100:103], a[32:35], v[208:211]
v_add_u32 v14, 0xffff0000, v14
v_add_u32 v15, 0xffff0000, v15
v_mfma_f32_16x16x32_bf16 v[208:211], a[96:99], a[12:15], v[208:211]
v_add_u32 v10, 0xffff0000, v10
v_add_u32 v11, 0xffff0000, v11
v_mfma_f32_16x16x32_bf16 v[248:251], a[96:99], a[16:19], v[248:251]
v_mfma_f32_16x16x32_bf16 v[248:251], a[100:103], a[36:39], v[248:251]
v_mfma_f32_16x16x32_bf16 v[212:215], a[104:107], a[12:15], v[212:215]
s_waitcnt vmcnt(24) lgkmcnt(0)
v_mfma_f32_16x16x32_bf16 v[212:215], a[108:111], a[32:35], v[212:215]
s_barrier
s_add_u32 m0, s17, 0x10000
v_mfma_f32_16x16x32_bf16 v[204:207], a[108:111], a[28:31], v[204:207]
buffer_load_dwordx4 v5, s[52:55], 0 offen lds
v_mfma_f32_16x16x32_bf16 v[204:207], a[104:107], a[8:11], v[204:207]
ds_read_b64_tr_b16 a[96:97], v12 offset:0
v_mfma_f32_16x16x32_bf16 v[196:199], a[104:107], a[4:7], v[196:199]
ds_read_b64_tr_b16 a[98:99], v12 offset:1024
v_mfma_f32_16x16x32_bf16 v[196:199], a[108:111], a[24:27], v[196:199]
ds_read_b64_tr_b16 a[100:101], v12 offset:8192
v_mfma_f32_16x16x32_bf16 v[188:191], a[108:111], a[20:23], v[188:191]
ds_read_b64_tr_b16 a[102:103], v12 offset:9216
v_mfma_f32_16x16x32_bf16 v[188:191], a[104:107], a[0:3], v[188:191]
s_add_u32 m0, s17, 0x10400
s_waitcnt lgkmcnt(4)
v_mfma_f32_16x16x32_bf16 v[216:219], a[0:3], a[80:83], v[216:219]
buffer_load_dwordx4 v5, s[52:55], s13 offen lds
v_mfma_f32_16x16x32_bf16 v[216:219], a[20:23], a[84:87], v[216:219]
ds_read_b64_tr_b16 a[104:105], v13 offset:0
v_mfma_f32_16x16x32_bf16 v[224:227], a[24:27], a[84:87], v[224:227]
ds_read_b64_tr_b16 a[106:107], v13 offset:1024
v_mfma_f32_16x16x32_bf16 v[224:227], a[4:7], a[80:83], v[224:227]
ds_read_b64_tr_b16 a[108:109], v13 offset:8192
v_mfma_f32_16x16x32_bf16 v[232:235], a[8:11], a[80:83], v[232:235]
ds_read_b64_tr_b16 a[110:111], v13 offset:9216
v_mfma_f32_16x16x32_bf16 v[232:235], a[28:31], a[84:87], v[232:235]
s_add_u32 m0, s17, 0x10800
v_mfma_f32_16x16x32_bf16 v[240:243], a[32:35], a[84:87], v[240:243]
buffer_load_dwordx4 v6, s[52:55], 0 offen lds
v_mfma_f32_16x16x32_bf16 v[240:243], a[12:15], a[80:83], v[240:243]
v_mfma_f32_16x16x32_bf16 v[252:255], a[16:19], a[80:83], v[252:255]
v_mfma_f32_16x16x32_bf16 v[252:255], a[36:39], a[84:87], v[252:255]
v_mfma_f32_16x16x32_bf16 v[244:247], a[12:15], a[88:91], v[244:247]
ds_read_b64_tr_b16 a[80:81], v12 offset:256
v_mfma_f32_16x16x32_bf16 v[244:247], a[32:35], a[92:95], v[244:247]
ds_read_b64_tr_b16 a[82:83], v12 offset:1280
v_mfma_f32_16x16x32_bf16 v[236:239], a[28:31], a[92:95], v[236:239]
ds_read_b64_tr_b16 a[84:85], v12 offset:8448
s_add_u32 m0, s17, 0x10c00
v_mfma_f32_16x16x32_bf16 v[236:239], a[8:11], a[88:91], v[236:239]
buffer_load_dwordx4 v6, s[52:55], s13 offen lds
v_mfma_f32_16x16x32_bf16 v[228:231], a[4:7], a[88:91], v[228:231]
ds_read_b64_tr_b16 a[86:87], v12 offset:9472
v_mfma_f32_16x16x32_bf16 v[228:231], a[24:27], a[92:95], v[228:231]
v_mfma_f32_16x16x32_bf16 v[220:223], a[20:23], a[92:95], v[220:223]
v_mfma_f32_16x16x32_bf16 v[220:223], a[0:3], a[88:91], v[220:223]
s_add_u32 m0, s18, 0x14000
s_waitcnt lgkmcnt(4)
L_S21:
v_mfma_f32_16x16x32_bf16 v[24:27], a[96:99], a[40:43], v[24:27]
ds_read_b64_tr_b16 a[88:89], v13 offset:256
s_waitcnt vmcnt(20)
v_mfma_f32_16x16x32_bf16 v[24:27], a[100:103], a[60:63], v[24:27]
buffer_load_dwordx4 v7, s[68:71], 0 offen lds
v_mfma_f32_16x16x32_bf16 v[32:35], a[100:103], a[64:67], v[32:35]
ds_read_b64_tr_b16 a[90:91], v13 offset:1280
v_mfma_f32_16x16x32_bf16 v[32:35], a[96:99], a[44:47], v[32:35]
ds_read_b64_tr_b16 a[92:93], v13 offset:8448
v_mfma_f32_16x16x32_bf16 v[40:43], a[96:99], a[48:51], v[40:43]
ds_read_b64_tr_b16 a[94:95], v13 offset:9472
v_mfma_f32_16x16x32_bf16 v[40:43], a[100:103], a[68:71], v[40:43]
ds_read_b128 a[0:3], v8 offset:0
v_mfma_f32_16x16x32_bf16 v[48:51], a[100:103], a[72:75], v[48:51]
ds_read_b128 a[20:23], v9 offset:0
s_add_u32 m0, s18, 0x15000
v_mfma_f32_16x16x32_bf16 v[48:51], a[96:99], a[52:55], v[48:51]
buffer_load_dwordx4 v7, s[68:71], s25 offen lds
v_mfma_f32_16x16x32_bf16 v[52:55], a[104:107], a[52:55], v[52:55]
ds_read_b64_tr_b16 a[96:97], v12 offset:512
v_mfma_f32_16x16x32_bf16 v[52:55], a[108:111], a[72:75], v[52:55]
ds_read_b64_tr_b16 a[98:99], v12 offset:1536
v_mfma_f32_16x16x32_bf16 v[44:47], a[108:111], a[68:71], v[44:47]
ds_read_b64_tr_b16 a[100:101], v12 offset:8704
v_mfma_f32_16x16x32_bf16 v[44:47], a[104:107], a[48:51], v[44:47]
ds_read_b64_tr_b16 a[102:103], v12 offset:9728
v_mfma_f32_16x16x32_bf16 v[36:39], a[104:107], a[44:47], v[36:39]
ds_read_b128 a[4:7], v8 offset:2048
v_mfma_f32_16x16x32_bf16 v[36:39], a[108:111], a[64:67], v[36:39]
ds_read_b128 a[24:27], v9 offset:2048
s_add_u32 m0, s18, 0x16000
v_mfma_f32_16x16x32_bf16 v[28:31], a[108:111], a[60:63], v[28:31]
buffer_load_dwordx4 v7, s[68:71], s26 offen lds
v_mfma_f32_16x16x32_bf16 v[28:31], a[104:107], a[40:43], v[28:31]
ds_read_b128 a[8:11], v8 offset:4096
s_waitcnt lgkmcnt(9)
v_mfma_f32_16x16x32_bf16 v[56:59], a[80:83], a[40:43], v[56:59]
ds_read_b64_tr_b16 a[104:105], v13 offset:512
v_mfma_f32_16x16x32_bf16 v[56:59], a[84:87], a[60:63], v[56:59]
ds_read_b64_tr_b16 a[106:107], v13 offset:1536
v_mfma_f32_16x16x32_bf16 v[64:67], a[84:87], a[64:67], v[64:67]
ds_read_b64_tr_b16 a[108:109], v13 offset:8704
v_mfma_f32_16x16x32_bf16 v[64:67], a[80:83], a[44:47], v[64:67]
ds_read_b64_tr_b16 a[110:111], v13 offset:9728
s_add_u32 m0, s18, 0x17000
v_mfma_f32_16x16x32_bf16 v[72:75], a[80:83], a[48:51], v[72:75]
buffer_load_dwordx4 v4, s[44:47], s24 offen lds
v_mfma_f32_16x16x32_bf16 v[72:75], a[84:87], a[68:71], v[72:75]
ds_read_b128 a[28:31], v9 offset:4096
v_add_u32 v5, 0x80000, v5
v_mfma_f32_16x16x32_bf16 v[80:83], a[84:87], a[72:75], v[80:83]
ds_read_b128 a[12:15], v8 offset:6144
v_add_u32 v6, 0x80000, v6
v_mfma_f32_16x16x32_bf16 v[80:83], a[80:83], a[52:55], v[80:83]
ds_read_b128 a[32:35], v9 offset:6144
v_add_u32 v7, 0x60000, v7
v_mfma_f32_16x16x32_bf16 v[84:87], a[88:91], a[52:55], v[84:87]
ds_read_b64_tr_b16 a[80:81], v12 offset:768
v_add_u32 v4, 0x80, v4
v_mfma_f32_16x16x32_bf16 v[84:87], a[92:95], a[72:75], v[84:87]
ds_read_b64_tr_b16 a[82:83], v12 offset:1792
v_mfma_f32_16x16x32_bf16 v[76:79], a[92:95], a[68:71], v[76:79]
buffer_load_dword v1, off, s[84:87], s10 sc1
v_mfma_f32_16x16x32_bf16 v[76:79], a[88:91], a[48:51], v[76:79]
ds_read_b64_tr_b16 a[84:85], v12 offset:8960
v_mfma_f32_16x16x32_bf16 v[68:71], a[88:91], a[44:47], v[68:71]
ds_read_b64_tr_b16 a[86:87], v12 offset:9984
v_mfma_f32_16x16x32_bf16 v[68:71], a[92:95], a[64:67], v[68:71]
ds_read_b128 a[56:59], v10
v_mfma_f32_16x16x32_bf16 v[60:63], a[92:95], a[60:63], v[60:63]
ds_read_b128 a[76:79], v11
v_mfma_f32_16x16x32_bf16 v[60:63], a[88:91], a[40:43], v[60:63]
s_waitcnt lgkmcnt(9)
v_mfma_f32_16x16x32_bf16 v[88:91], a[96:99], a[40:43], v[88:91]
ds_read_b64_tr_b16 a[88:89], v13 offset:768
v_mfma_f32_16x16x32_bf16 v[88:91], a[100:103], a[60:63], v[88:91]
ds_read_b64_tr_b16 a[90:91], v13 offset:1792
v_mfma_f32_16x16x32_bf16 v[96:99], a[100:103], a[64:67], v[96:99]
ds_read_b64_tr_b16 a[92:93], v13 offset:8960
v_mfma_f32_16x16x32_bf16 v[96:99], a[96:99], a[44:47], v[96:99]
ds_read_b64_tr_b16 a[94:95], v13 offset:9984
v_mfma_f32_16x16x32_bf16 v[104:107], a[96:99], a[48:51], v[104:107]
v_mfma_f32_16x16x32_bf16 v[104:107], a[100:103], a[68:71], v[104:107]
v_mfma_f32_16x16x32_bf16 v[112:115], a[100:103], a[72:75], v[112:115]
v_mfma_f32_16x16x32_bf16 v[112:115], a[96:99], a[52:55], v[112:115]
v_mfma_f32_16x16x32_bf16 v[116:119], a[104:107], a[52:55], v[116:119]
ds_read_b64_tr_b16 a[96:97], v14 offset:0
v_mfma_f32_16x16x32_bf16 v[116:119], a[108:111], a[72:75], v[116:119]
ds_read_b64_tr_b16 a[98:99], v14 offset:256
v_mfma_f32_16x16x32_bf16 v[108:111], a[108:111], a[68:71], v[108:111]
ds_read_b64_tr_b16 a[100:101], v14 offset:2048
v_mfma_f32_16x16x32_bf16 v[108:111], a[104:107], a[48:51], v[108:111]
ds_read_b64_tr_b16 a[102:103], v14 offset:2304
v_mfma_f32_16x16x32_bf16 v[100:103], a[104:107], a[44:47], v[100:103]
v_mfma_f32_16x16x32_bf16 v[100:103], a[108:111], a[64:67], v[100:103]
v_mfma_f32_16x16x32_bf16 v[92:95], a[108:111], a[60:63], v[92:95]
v_mfma_f32_16x16x32_bf16 v[92:95], a[104:107], a[40:43], v[92:95]
s_waitcnt lgkmcnt(4)
v_mfma_f32_16x16x32_bf16 v[120:123], a[80:83], a[40:43], v[120:123]
ds_read_b64_tr_b16 a[104:105], v15 offset:0
v_mfma_f32_16x16x32_bf16 v[120:123], a[84:87], a[60:63], v[120:123]
ds_read_b64_tr_b16 a[106:107], v15 offset:256
v_mfma_f32_16x16x32_bf16 v[128:131], a[84:87], a[64:67], v[128:131]
ds_read_b64_tr_b16 a[108:109], v15 offset:2048
v_mfma_f32_16x16x32_bf16 v[128:131], a[80:83], a[44:47], v[128:131]
ds_read_b64_tr_b16 a[110:111], v15 offset:2304
v_mfma_f32_16x16x32_bf16 v[136:139], a[80:83], a[48:51], v[136:139]
v_mfma_f32_16x16x32_bf16 v[136:139], a[84:87], a[68:71], v[136:139]
v_mfma_f32_16x16x32_bf16 v[144:147], a[84:87], a[72:75], v[144:147]
v_mfma_f32_16x16x32_bf16 v[144:147], a[80:83], a[52:55], v[144:147]
v_mfma_f32_16x16x32_bf16 v[148:151], a[88:91], a[52:55], v[148:151]
ds_read_b64_tr_b16 a[80:81], v14 offset:4096
v_mfma_f32_16x16x32_bf16 v[148:151], a[92:95], a[72:75], v[148:151]
ds_read_b64_tr_b16 a[82:83], v14 offset:4352
v_mfma_f32_16x16x32_bf16 v[140:143], a[92:95], a[68:71], v[140:143]
ds_read_b64_tr_b16 a[84:85], v14 offset:6144
v_mfma_f32_16x16x32_bf16 v[140:143], a[88:91], a[48:51], v[140:143]
ds_read_b64_tr_b16 a[86:87], v14 offset:6400
v_mfma_f32_16x16x32_bf16 v[132:135], a[88:91], a[44:47], v[132:135]
v_mfma_f32_16x16x32_bf16 v[132:135], a[92:95], a[64:67], v[132:135]
v_mfma_f32_16x16x32_bf16 v[124:127], a[92:95], a[60:63], v[124:127]
v_mfma_f32_16x16x32_bf16 v[124:127], a[88:91], a[40:43], v[124:127]
s_waitcnt lgkmcnt(4)
v_mfma_f32_16x16x32_bf16 v[152:155], a[96:99], a[40:43], v[152:155]
ds_read_b64_tr_b16 a[88:89], v15 offset:4096
v_mfma_f32_16x16x32_bf16 v[152:155], a[100:103], a[60:63], v[152:155]
ds_read_b64_tr_b16 a[90:91], v15 offset:4352
v_mfma_f32_16x16x32_bf16 v[160:163], a[100:103], a[64:67], v[160:163]
ds_read_b64_tr_b16 a[92:93], v15 offset:6144
v_mfma_f32_16x16x32_bf16 v[160:163], a[96:99], a[44:47], v[160:163]
ds_read_b64_tr_b16 a[94:95], v15 offset:6400
v_mfma_f32_16x16x32_bf16 v[168:171], a[96:99], a[48:51], v[168:171]
v_mfma_f32_16x16x32_bf16 v[168:171], a[100:103], a[68:71], v[168:171]
v_mfma_f32_16x16x32_bf16 v[176:179], a[100:103], a[72:75], v[176:179]
v_mfma_f32_16x16x32_bf16 v[176:179], a[96:99], a[52:55], v[176:179]
v_mfma_f32_16x16x32_bf16 v[180:183], a[104:107], a[52:55], v[180:183]
ds_read_b64_tr_b16 a[96:97], v14 offset:8192
v_mfma_f32_16x16x32_bf16 v[180:183], a[108:111], a[72:75], v[180:183]
ds_read_b64_tr_b16 a[98:99], v14 offset:8448
v_mfma_f32_16x16x32_bf16 v[172:175], a[108:111], a[68:71], v[172:175]
ds_read_b64_tr_b16 a[100:101], v14 offset:10240
v_mfma_f32_16x16x32_bf16 v[172:175], a[104:107], a[48:51], v[172:175]
ds_read_b64_tr_b16 a[102:103], v14 offset:10496
v_mfma_f32_16x16x32_bf16 v[164:167], a[104:107], a[44:47], v[164:167]
v_mfma_f32_16x16x32_bf16 v[164:167], a[108:111], a[64:67], v[164:167]
v_mfma_f32_16x16x32_bf16 v[156:159], a[108:111], a[60:63], v[156:159]
v_mfma_f32_16x16x32_bf16 v[156:159], a[104:107], a[40:43], v[156:159]
s_waitcnt lgkmcnt(4)
v_mfma_f32_16x16x32_bf16 v[184:187], a[80:83], a[40:43], v[184:187]
ds_read_b64_tr_b16 a[104:105], v15 offset:8192
v_mfma_f32_16x16x32_bf16 v[184:187], a[84:87], a[60:63], v[184:187]
ds_read_b64_tr_b16 a[106:107], v15 offset:8448
v_mfma_f32_16x16x32_bf16 v[192:195], a[84:87], a[64:67], v[192:195]
ds_read_b64_tr_b16 a[108:109], v15 offset:10240
v_mfma_f32_16x16x32_bf16 v[192:195], a[80:83], a[44:47], v[192:195]
ds_read_b64_tr_b16 a[110:111], v15 offset:10496
v_add_u32 v12, 0x8000, v12
v_mfma_f32_16x16x32_bf16 v[200:203], a[80:83], a[48:51], v[200:203]
v_add_u32 v13, 0x8000, v13
v_add_u32 v14, 0x8000, v14
v_mfma_f32_16x16x32_bf16 v[200:203], a[84:87], a[68:71], v[200:203]
v_add_u32 v15, 0x8000, v15
v_add_u32 v10, 0x8000, v10
v_mfma_f32_16x16x32_bf16 v[208:211], a[84:87], a[72:75], v[208:211]
v_add_u32 v11, 0x8000, v11
v_mfma_f32_16x16x32_bf16 v[208:211], a[80:83], a[52:55], v[208:211]
v_mfma_f32_16x16x32_bf16 v[248:251], a[80:83], a[56:59], v[248:251]
v_mfma_f32_16x16x32_bf16 v[248:251], a[84:87], a[76:79], v[248:251]
v_mfma_f32_16x16x32_bf16 v[212:215], a[88:91], a[52:55], v[212:215]
s_waitcnt vmcnt(0) lgkmcnt(0)
s_mov_b32 s92, 200000
L_spin_kv:
v_readfirstlane_b32 s93, v1
s_nop 1
s_cmp_ge_u32 s93, 8
s_cbranch_scc1 L_spun_kv
s_sub_u32 s92, s92, 1
s_cbranch_scc1 L_spun_kv
s_sleep 4
buffer_load_dword v1, off, s[84:87], s10 sc1
s_waitcnt vmcnt(0)
s_branch L_spin_kv
L_spun_kv:
v_mfma_f32_16x16x32_bf16 v[212:215], a[92:95], a[72:75], v[212:215]
s_barrier
s_add_u32 m0, s19, 0x0
v_mfma_f32_16x16x32_bf16 v[204:207], a[92:95], a[68:71], v[204:207]
buffer_load_dwordx4 v16, s[48:51], s32 offen offset:0 sc1 lds
v_mov_b32 v3, v16
v_mfma_f32_16x16x32_bf16 v[204:207], a[88:91], a[48:51], v[204:207]
ds_read_b64_tr_b16 a[80:81], v12 offset:0
v_mov_b32 v22, 0x3f803f80
v_mfma_f32_16x16x32_bf16 v[196:199], a[88:91], a[44:47], v[196:199]
ds_read_b64_tr_b16 a[82:83], v12 offset:1024
s_mov_b32 s33, 0
v_mfma_f32_16x16x32_bf16 v[196:199], a[92:95], a[64:67], v[196:199]
ds_read_b64_tr_b16 a[84:85], v12 offset:8192
s_lshl_b32 s10, s2, 2
v_mfma_f32_16x16x32_bf16 v[188:191], a[92:95], a[60:63], v[188:191]
ds_read_b64_tr_b16 a[86:87], v12 offset:9216
s_add_u32 s10, s10, s4
v_mfma_f32_16x16x32_bf16 v[188:191], a[88:91], a[40:43], v[188:191]
s_waitcnt lgkmcnt(4)
s_lshl_b32 s10, s10, 12
s_add_u32 s10, s10, 0x3800000
v_mfma_f32_16x16x32_bf16 v[216:219], a[40:43], a[96:99], v[216:219]
buffer_load_dwordx4 v16, s[48:51], s32 offen offset:1024 sc1 lds
v_mfma_f32_16x16x32_bf16 v[216:219], a[60:63], a[100:103], v[216:219]
ds_read_b64_tr_b16 a[88:89], v13 offset:0
v_accvgpr_write_b32 a240, v22
v_mfma_f32_16x16x32_bf16 v[224:227], a[64:67], a[100:103], v[224:227]
ds_read_b64_tr_b16 a[90:91], v13 offset:1024
v_accvgpr_write_b32 a241, v22
v_accvgpr_write_b32 a242, v22
v_mfma_f32_16x16x32_bf16 v[224:227], a[44:47], a[96:99], v[224:227]
ds_read_b64_tr_b16 a[92:93], v13 offset:8192
v_accvgpr_write_b32 a243, v22
v_mfma_f32_16x16x32_bf16 v[232:235], a[48:51], a[96:99], v[232:235]
ds_read_b64_tr_b16 a[94:95], v13 offset:9216
v_accvgpr_write_b32 a116, -1
v_mfma_f32_16x16x32_bf16 v[232:235], a[68:71], a[100:103], v[232:235]
v_accvgpr_write_b32 a117, -1
v_accvgpr_write_b32 a118, -1
v_mfma_f32_16x16x32_bf16 v[240:243], a[72:75], a[100:103], v[240:243]
v_accvgpr_write_b32 a119, -1
v_mov_b32 v1, v3
v_mfma_f32_16x16x32_bf16 v[240:243], a[52:55], a[96:99], v[240:243]
buffer_load_dwordx4 v16, s[48:51], s32 offen offset:2048 sc1 lds
v_mfma_f32_16x16x32_bf16 v[252:255], a[56:59], a[96:99], v[252:255]
v_add_u32 v2, 98304, v3
v_mfma_f32_16x16x32_bf16 v[252:255], a[76:79], a[100:103], v[252:255]
s_mov_b64 s[34:35], 0
v_accvgpr_write_b32 a224, 0
v_accvgpr_write_b32 a225, 0
v_mfma_f32_16x16x32_bf16 v[244:247], a[52:55], a[104:107], v[244:247]
ds_read_b64_tr_b16 a[96:97], v12 offset:256
v_accvgpr_write_b32 a226, 0
v_accvgpr_write_b32 a227, 0
v_mfma_f32_16x16x32_bf16 v[244:247], a[72:75], a[108:111], v[244:247]
ds_read_b64_tr_b16 a[98:99], v12 offset:1280
v_accvgpr_write_b32 a228, 0
v_mfma_f32_16x16x32_bf16 v[236:239], a[68:71], a[108:111], v[236:239]
ds_read_b64_tr_b16 a[100:101], v12 offset:8448
v_accvgpr_write_b32 a229, 0
v_mfma_f32_16x16x32_bf16 v[236:239], a[48:51], a[104:107], v[236:239]
ds_read_b64_tr_b16 a[102:103], v12 offset:9472
v_accvgpr_write_b32 a230, 0
v_mfma_f32_16x16x32_bf16 v[228:231], a[44:47], a[104:107], v[228:231]
buffer_load_dwordx4 v16, s[48:51], s32 offen offset:3072 sc1 lds
v_mfma_f32_16x16x32_bf16 v[228:231], a[64:67], a[108:111], v[228:231]
v_accvgpr_write_b32 a231, 0
v_accvgpr_write_b32 a232, 0
v_mfma_f32_16x16x32_bf16 v[220:223], a[60:63], a[108:111], v[220:223]
v_accvgpr_write_b32 a233, 0
v_accvgpr_write_b32 a234, 0
v_mfma_f32_16x16x32_bf16 v[220:223], a[40:43], a[104:107], v[220:223]
s_waitcnt lgkmcnt(4)
v_accvgpr_write_b32 a235, 0
v_accvgpr_write_b32 a236, 0
L_S22:
v_mfma_f32_16x16x32_bf16 v[24:27], a[80:83], a[0:3], v[24:27]
ds_read_b64_tr_b16 a[104:105], v13 offset:256
s_waitcnt vmcnt(13)
v_accvgpr_write_b32 a237, 0
v_mfma_f32_16x16x32_bf16 v[24:27], a[84:87], a[20:23], v[24:27]
ds_read_b64_tr_b16 a[106:107], v13 offset:1280
s_add_u32 m0, s19, 0x1000
v_mfma_f32_16x16x32_bf16 v[32:35], a[84:87], a[24:27], v[32:35]
buffer_load_dwordx4 v16, s[48:51], s7 offen offset:0 sc1 lds
v_mfma_f32_16x16x32_bf16 v[32:35], a[80:83], a[4:7], v[32:35]
ds_read_b64_tr_b16 a[108:109], v13 offset:8448
v_accvgpr_write_b32 a238, 0
v_mfma_f32_16x16x32_bf16 v[40:43], a[80:83], a[8:11], v[40:43]
ds_read_b64_tr_b16 a[110:111], v13 offset:9472
v_accvgpr_write_b32 a239, 0
v_mfma_f32_16x16x32_bf16 v[40:43], a[84:87], a[28:31], v[40:43]
ds_read_b128 a[40:43], v8 offset:32768
s_mul_i32 s8, s6, 0x140000
v_mfma_f32_16x16x32_bf16 v[48:51], a[84:87], a[32:35], v[48:51]
ds_read_b128 a[60:63], v9 offset:32768
s_sub_u32 s9, 0x12c0000, s8
v_mfma_f32_16x16x32_bf16 v[48:51], a[80:83], a[12:15], v[48:51]
ds_read_b128 a[44:47], v8 offset:34816
s_lshl_b32 s11, s5, 13
v_mfma_f32_16x16x32_bf16 v[52:55], a[88:91], a[12:15], v[52:55]
ds_read_b64_tr_b16 a[80:81], v12 offset:512
s_add_u32 s11, s11, 0x2200000
s_add_u32 s8, s8, s11
v_mfma_f32_16x16x32_bf16 v[52:55], a[92:95], a[32:35], v[52:55]
buffer_load_dwordx4 v16, s[48:51], s7 offen offset:1024 sc1 lds
v_mfma_f32_16x16x32_bf16 v[44:47], a[92:95], a[28:31], v[44:47]
ds_read_b64_tr_b16 a[82:83], v12 offset:1536
s_add_u32 s9, s9, s11
v_mfma_f32_16x16x32_bf16 v[44:47], a[88:91], a[8:11], v[44:47]
ds_read_b64_tr_b16 a[84:85], v12 offset:8704
s_lshl_b32 s11, s4, 10
v_mfma_f32_16x16x32_bf16 v[36:39], a[88:91], a[4:7], v[36:39]
ds_read_b64_tr_b16 a[86:87], v12 offset:9728
s_add_u32 s44, s8, s11
v_mfma_f32_16x16x32_bf16 v[36:39], a[92:95], a[24:27], v[36:39]
ds_read_b128 a[64:67], v9 offset:34816
s_add_u32 s46, s9, s11
v_mfma_f32_16x16x32_bf16 v[28:31], a[92:95], a[20:23], v[28:31]
ds_read_b128 a[48:51], v8 offset:36864
s_sub_u32 s11, 0x1c00, s11
v_mfma_f32_16x16x32_bf16 v[28:31], a[88:91], a[0:3], v[28:31]
ds_read_b128 a[68:71], v9 offset:36864
s_waitcnt lgkmcnt(10)
v_mfma_f32_16x16x32_bf16 v[56:59], a[96:99], a[0:3], v[56:59]
buffer_load_dwordx4 v16, s[48:51], s7 offen offset:2048 sc1 lds
s_add_u32 s45, s8, s11
v_mfma_f32_16x16x32_bf16 v[56:59], a[100:103], a[20:23], v[56:59]
ds_read_b64_tr_b16 a[88:89], v13 offset:512
s_add_u32 s47, s9, s11
v_mfma_f32_16x16x32_bf16 v[64:67], a[100:103], a[24:27], v[64:67]
ds_read_b64_tr_b16 a[90:91], v13 offset:1536
s_mul_i32 s8, s5, 0x6000
v_mfma_f32_16x16x32_bf16 v[64:67], a[96:99], a[4:7], v[64:67]
ds_read_b64_tr_b16 a[92:93], v13 offset:8704
s_add_u32 s8, s8, 0x40000
v_mfma_f32_16x16x32_bf16 v[72:75], a[96:99], a[8:11], v[72:75]
ds_read_b64_tr_b16 a[94:95], v13 offset:9728
s_add_u32 s28, s44, s8
v_mfma_f32_16x16x32_bf16 v[72:75], a[100:103], a[28:31], v[72:75]
ds_read_b128 a[52:55], v8 offset:38912
s_add_u32 s29, s45, s8
v_mfma_f32_16x16x32_bf16 v[80:83], a[100:103], a[32:35], v[80:83]
buffer_load_dwordx4 v16, s[48:51], s7 offen offset:3072 sc1 lds
v_mfma_f32_16x16x32_bf16 v[80:83], a[96:99], a[12:15], v[80:83]
ds_read_b128 a[72:75], v9 offset:38912
s_add_u32 s32, s32, s99
v_mfma_f32_16x16x32_bf16 v[84:87], a[104:107], a[12:15], v[84:87]
ds_read_b64_tr_b16 a[96:97], v12 offset:768
s_add_u32 s7, s7, s99
s_add_u32 s30, s46, s8
v_mfma_f32_16x16x32_bf16 v[84:87], a[108:111], a[32:35], v[84:87]
ds_read_b64_tr_b16 a[98:99], v12 offset:1792
s_add_u32 s31, s47, s8
v_mfma_f32_16x16x32_bf16 v[76:79], a[108:111], a[28:31], v[76:79]
ds_read_b64_tr_b16 a[100:101], v12 offset:8960
s_lshl_b32 s8, s4, 11
v_mfma_f32_16x16x32_bf16 v[76:79], a[104:107], a[8:11], v[76:79]
ds_read_b64_tr_b16 a[102:103], v12 offset:9984
v_mov_b32 v21, s1
v_mfma_f32_16x16x32_bf16 v[68:71], a[104:107], a[4:7], v[68:71]
ds_read_b128 a[16:19], v10
v_add_u32 v20, s0, v16
v_mfma_f32_16x16x32_bf16 v[68:71], a[108:111], a[24:27], v[68:71]
global_load_dword a120, v[20:21], off sc1
v_mfma_f32_16x16x32_bf16 v[60:63], a[108:111], a[20:23], v[60:63]
ds_read_b128 a[36:39], v11
s_add_u32 s9, s8, 131072
v_mfma_f32_16x16x32_bf16 v[60:63], a[104:107], a[0:3], v[60:63]
s_waitcnt lgkmcnt(8)
v_add_u32 v4, s9, v16
v_mfma_f32_16x16x32_bf16 v[88:91], a[80:83], a[0:3], v[88:91]
ds_read_b64_tr_b16 a[104:105], v13 offset:768
s_sub_u32 s9, 145408, s8
v_mfma_f32_16x16x32_bf16 v[88:91], a[84:87], a[20:23], v[88:91]
ds_read_b64_tr_b16 a[106:107], v13 offset:1792
v_mfma_f32_16x16x32_bf16 v[96:99], a[84:87], a[24:27], v[96:99]
ds_read_b64_tr_b16 a[108:109], v13 offset:8960
v_mfma_f32_16x16x32_bf16 v[96:99], a[80:83], a[4:7], v[96:99]
ds_read_b64_tr_b16 a[110:111], v13 offset:9984
s_add_u32 m0, s19, 0x18000
v_mfma_f32_16x16x32_bf16 v[104:107], a[80:83], a[8:11], v[104:107]
buffer_load_dwordx4 v16, s[48:51], s32 offen offset:0 sc1 lds
v_mfma_f32_16x16x32_bf16 v[104:107], a[84:87], a[28:31], v[104:107]
s_cmp_eq_u32 s4, 0
s_cselect_b32 s8, 131072, s9
v_add_u32 v5, s8, v16
v_mfma_f32_16x16x32_bf16 v[112:115], a[84:87], a[32:35], v[112:115]
s_cmp_eq_u32 s4, 3
s_cselect_b32 s8, 0, 8
s_add_u32 s9, s9, s8
v_mfma_f32_16x16x32_bf16 v[112:115], a[80:83], a[12:15], v[112:115]
v_add_u32 v6, s9, v16
v_xor_b32 v7, 8, v6
v_mfma_f32_16x16x32_bf16 v[116:119], a[88:91], a[12:15], v[116:119]
ds_read_b64_tr_b16 a[80:81], v14 offset:0
s_lshr_b32 s8, s4, 1
s_lshl_b32 s8, s8, 14
v_mfma_f32_16x16x32_bf16 v[116:119], a[92:95], a[32:35], v[116:119]
ds_read_b64_tr_b16 a[82:83], v14 offset:256
s_and_b32 s9, s4, 1
v_mfma_f32_16x16x32_bf16 v[108:111], a[92:95], a[28:31], v[108:111]
ds_read_b64_tr_b16 a[84:85], v14 offset:2048
s_lshl_b32 s9, s9, 3
v_mfma_f32_16x16x32_bf16 v[108:111], a[88:91], a[8:11], v[108:111]
buffer_load_dwordx4 v16, s[48:51], s32 offen offset:1024 sc1 lds
v_mfma_f32_16x16x32_bf16 v[100:103], a[88:91], a[4:7], v[100:103]
ds_read_b64_tr_b16 a[86:87], v14 offset:2304
s_xor_b32 s9, s9, 131080
v_mfma_f32_16x16x32_bf16 v[100:103], a[92:95], a[24:27], v[100:103]
s_add_u32 s8, s8, s9
v_add_u32 v22, s8, v16
v_mfma_f32_16x16x32_bf16 v[92:95], a[92:95], a[20:23], v[92:95]
s_bfe_u32 s99, s2, 0x20001
s_lshl_b32 s99, s99, 2
s_lshr_b32 s8, s2, 6
v_mfma_f32_16x16x32_bf16 v[92:95], a[88:91], a[0:3], v[92:95]
s_waitcnt lgkmcnt(4)
s_add_u32 s99, s99, s8
s_bfe_u32 s100, s2, 0x30003
v_mfma_f32_16x16x32_bf16 v[120:123], a[96:99], a[0:3], v[120:123]
ds_read_b64_tr_b16 a[88:89], v15 offset:0
s_and_b32 s14, s2, 1
s_sub_u32 s24, 15, s99
v_mfma_f32_16x16x32_bf16 v[120:123], a[100:103], a[20:23], v[120:123]
buffer_load_dwordx4 v16, s[48:51], s32 offen offset:2048 sc1 lds
v_mfma_f32_16x16x32_bf16 v[128:131], a[100:103], a[24:27], v[128:131]
ds_read_b64_tr_b16 a[90:91], v15 offset:256
s_min_u32 s18, s24, s99
v_mfma_f32_16x16x32_bf16 v[128:131], a[96:99], a[4:7], v[128:131]
ds_read_b64_tr_b16 a[92:93], v15 offset:2048
s_lshl_b32 s24, s18, 1
v_mfma_f32_16x16x32_bf16 v[136:139], a[96:99], a[8:11], v[136:139]
ds_read_b64_tr_b16 a[94:95], v15 offset:2304
s_add_u32 s24, s24, s14
v_mfma_f32_16x16x32_bf16 v[136:139], a[100:103], a[28:31], v[136:139]
s_lshl_b32 s24, s24, 6
s_add_u32 s24, s24, 0x3604000
s_mov_b32 s12, 14336
v_mfma_f32_16x16x32_bf16 v[144:147], a[100:103], a[32:35], v[144:147]
s_and_b32 s16, s6, 1
s_lshl_b32 s16, s16, 15
s_add_u32 s16, s16, 98304
v_mfma_f32_16x16x32_bf16 v[144:147], a[96:99], a[12:15], v[144:147]
s_add_u32 s16, s16, s17
s_lshl_b32 s13, s4, 15
s_lshl_b32 s9, s100, 8
v_mfma_f32_16x16x32_bf16 v[148:151], a[104:107], a[12:15], v[148:151]
buffer_load_dwordx4 v16, s[48:51], s32 offen offset:3072 sc1 lds
s_add_u32 s13, s13, s9
v_mfma_f32_16x16x32_bf16 v[148:151], a[108:111], a[32:35], v[148:151]
ds_read_b64_tr_b16 a[96:97], v14 offset:4096
s_mul_i32 s9, s14, 0x100080
v_mfma_f32_16x16x32_bf16 v[140:143], a[108:111], a[28:31], v[140:143]
ds_read_b64_tr_b16 a[98:99], v14 offset:4352
s_add_u32 s13, s13, s9
v_mfma_f32_16x16x32_bf16 v[140:143], a[104:107], a[8:11], v[140:143]
ds_read_b64_tr_b16 a[100:101], v14 offset:6144
s_mul_i32 s25, s14, 0x300000
v_mfma_f32_16x16x32_bf16 v[132:135], a[104:107], a[4:7], v[132:135]
ds_read_b64_tr_b16 a[102:103], v14 offset:6400
s_sub_u32 s25, s25, 917504
v_mfma_f32_16x16x32_bf16 v[132:135], a[108:111], a[24:27], v[132:135]
s_mul_i32 s101, s99, 0x140000
s_lshl_b32 s8, s4, 11
s_add_u32 s101, s101, s8
v_mfma_f32_16x16x32_bf16 v[124:127], a[108:111], a[20:23], v[124:127]
s_add_u32 m0, s19, 0x19000
s_waitcnt lgkmcnt(4)
s_lshl_b32 s8, s14, 17
v_mfma_f32_16x16x32_bf16 v[124:127], a[104:107], a[0:3], v[124:127]
buffer_load_dwordx4 v16, s[48:51], s7 offen offset:0 sc1 lds
v_mfma_f32_16x16x32_bf16 v[152:155], a[80:83], a[0:3], v[152:155]
ds_read_b64_tr_b16 a[104:105], v15 offset:4096
s_add_u32 s101, s101, s8
s_add_u32 s101, s101, 0x21fe000
v_mfma_f32_16x16x32_bf16 v[152:155], a[84:87], a[20:23], v[152:155]
ds_read_b64_tr_b16 a[106:107], v15 offset:4352
s_mul_i32 s26, s14, 393216
v_mfma_f32_16x16x32_bf16 v[160:163], a[84:87], a[24:27], v[160:163]
ds_read_b64_tr_b16 a[108:109], v15 offset:6144
s_add_u32 s26, s26, 139264
v_mfma_f32_16x16x32_bf16 v[160:163], a[80:83], a[4:7], v[160:163]
ds_read_b64_tr_b16 a[110:111], v15 offset:6400
s_mov_b32 s52, 0x3e0293ee
v_mfma_f32_16x16x32_bf16 v[168:171], a[80:83], a[8:11], v[168:171]
s_mov_b32 s53, 0x3e0293ee
s_mov_b32 s54, 0x3e8293ee
v_mfma_f32_16x16x32_bf16 v[168:171], a[84:87], a[28:31], v[168:171]
buffer_load_dwordx4 v16, s[48:51], s7 offen offset:1024 sc1 lds
v_mfma_f32_16x16x32_bf16 v[176:179], a[84:87], a[32:35], v[176:179]
s_or_b32 s55, s6, s4
s_cselect_b32 s55, 0, 0xf149f2ca
s_mov_b32 s56, 0x50000
v_mfma_f32_16x16x32_bf16 v[176:179], a[80:83], a[12:15], v[176:179]
s_mov_b32 s57, 0x5550055
s_mov_b32 s58, 0xa0000
s_mov_b32 s59, 0xaaa00aa
v_mfma_f32_16x16x32_bf16 v[180:183], a[88:91], a[12:15], v[180:183]
ds_read_b64_tr_b16 a[80:81], v14 offset:8192
s_mov_b32 s60, 0x150001
s_mov_b32 s61, 0x15550155
v_mfma_f32_16x16x32_bf16 v[180:183], a[92:95], a[32:35], v[180:183]
ds_read_b64_tr_b16 a[82:83], v14 offset:8448
s_mov_b32 s62, 0x2a0002
v_mfma_f32_16x16x32_bf16 v[172:175], a[92:95], a[28:31], v[172:175]
ds_read_b64_tr_b16 a[84:85], v14 offset:10240
s_mov_b32 s63, 0x2aaa02aa
v_mfma_f32_16x16x32_bf16 v[172:175], a[88:91], a[8:11], v[172:175]
ds_read_b64_tr_b16 a[86:87], v14 offset:10496
s_mov_b32 s68, 0x55505555
v_mfma_f32_16x16x32_bf16 v[164:167], a[88:91], a[4:7], v[164:167]
buffer_load_dwordx4 v16, s[48:51], s7 offen offset:2048 sc1 lds
v_mfma_f32_16x16x32_bf16 v[164:167], a[92:95], a[24:27], v[164:167]
s_mov_b32 s69, 0x50005500
s_mov_b32 s70, 0xaaa0aaaa
s_mov_b32 s71, 0xa000aa00
v_mfma_f32_16x16x32_bf16 v[156:159], a[92:95], a[20:23], v[156:159]
s_mov_b32 s76, 0x55405554
s_mov_b32 s77, 0x40005400
s_mov_b32 s78, 0xaa80aaa8
v_mfma_f32_16x16x32_bf16 v[156:159], a[88:91], a[0:3], v[156:159]
s_waitcnt lgkmcnt(4)
s_mov_b32 s79, 0x8000a800
s_mov_b32 s11, 0xf149f2ca
v_mfma_f32_16x16x32_bf16 v[184:187], a[96:99], a[0:3], v[184:187]
ds_read_b64_tr_b16 a[88:89], v15 offset:8192
s_mov_b32 s36, 0xfff0ffff
s_mov_b32 s37, 0xf000ff00
v_mfma_f32_16x16x32_bf16 v[184:187], a[100:103], a[20:23], v[184:187]
ds_read_b64_tr_b16 a[90:91], v15 offset:8448
s_mov_b32 s38, 0xffe0fffe
v_mfma_f32_16x16x32_bf16 v[192:195], a[100:103], a[24:27], v[192:195]
ds_read_b64_tr_b16 a[92:93], v15 offset:10240
s_mov_b32 s39, 0xe000fe00
v_mfma_f32_16x16x32_bf16 v[192:195], a[96:99], a[4:7], v[192:195]
buffer_load_dwordx4 v16, s[48:51], s7 offen offset:3072 sc1 lds
v_mfma_f32_16x16x32_bf16 v[200:203], a[96:99], a[8:11], v[200:203]
ds_read_b64_tr_b16 a[94:95], v15 offset:10496
s_add_u32 s32, s32, 0x8000
v_mfma_f32_16x16x32_bf16 v[200:203], a[100:103], a[28:31], v[200:203]
s_add_u32 s7, s7, 0x8000
v_add_u32 v12, 0x8000, v12
v_add_u32 v13, 0x8000, v13
v_mfma_f32_16x16x32_bf16 v[208:211], a[100:103], a[32:35], v[208:211]
s_mov_b32 s40, 0xffc0fffc
v_add_u32 v14, 0x8000, v14
v_add_u32 v15, 0x8000, v15
v_mfma_f32_16x16x32_bf16 v[208:211], a[96:99], a[12:15], v[208:211]
s_mov_b32 s41, 0xc000fc00
v_add_u32 v10, 0x8000, v10
v_add_u32 v11, 0x8000, v11
v_mfma_f32_16x16x32_bf16 v[248:251], a[96:99], a[16:19], v[248:251]
s_mov_b32 s42, 0xff80fff8
s_mov_b32 s43, 0x8000f800
v_mfma_f32_16x16x32_bf16 v[248:251], a[100:103], a[36:39], v[248:251]
s_bitcmp1_b32 s4, 0
s_cselect_b32 s8, 0x7f800000, s11
s_cselect_b32 s9, s11, 0x7f800000
v_mfma_f32_16x16x32_bf16 v[212:215], a[104:107], a[12:15], v[212:215]
s_waitcnt vmcnt(18) lgkmcnt(0)
v_mfma_f32_16x16x32_bf16 v[212:215], a[108:111], a[32:35], v[212:215]
s_barrier
s_add_u32 m0, s19, 0x8000
v_mfma_f32_16x16x32_bf16 v[204:207], a[108:111], a[28:31], v[204:207]
buffer_load_dwordx4 v16, s[48:51], s32 offen offset:0 sc1 lds
v_mfma_f32_16x16x32_bf16 v[204:207], a[104:107], a[8:11], v[204:207]
ds_read_b64_tr_b16 a[96:97], v14 offset:4096
v_mfma_f32_16x16x32_bf16 v[196:199], a[104:107], a[4:7], v[196:199]
ds_read_b64_tr_b16 a[98:99], v14 offset:4352
v_mfma_f32_16x16x32_bf16 v[196:199], a[108:111], a[24:27], v[196:199]
ds_read_b64_tr_b16 a[100:101], v14 offset:6144
v_mfma_f32_16x16x32_bf16 v[188:191], a[108:111], a[20:23], v[188:191]
ds_read_b64_tr_b16 a[102:103], v14 offset:6400
s_waitcnt lgkmcnt(4)
v_mfma_f32_16x16x32_bf16 v[188:191], a[104:107], a[0:3], v[188:191]
buffer_load_dwordx4 v16, s[48:51], s32 offen offset:1024 sc1 lds
v_mfma_f32_16x16x32_bf16 v[216:219], a[0:3], a[80:83], v[216:219]
ds_read_b64_tr_b16 a[104:105], v15 offset:4096
v_mfma_f32_16x16x32_bf16 v[216:219], a[20:23], a[84:87], v[216:219]
ds_read_b64_tr_b16 a[106:107], v15 offset:4352
v_mfma_f32_16x16x32_bf16 v[224:227], a[24:27], a[84:87], v[224:227]
ds_read_b64_tr_b16 a[108:109], v15 offset:6144
v_mfma_f32_16x16x32_bf16 v[224:227], a[4:7], a[80:83], v[224:227]
ds_read_b64_tr_b16 a[110:111], v15 offset:6400
v_mfma_f32_16x16x32_bf16 v[232:235], a[8:11], a[80:83], v[232:235]
buffer_store_dwordx4 a[116:119], v16, s[88:91], s10 offen offset:0 sc1
v_mfma_f32_16x16x32_bf16 v[232:235], a[28:31], a[84:87], v[232:235]
ds_read_b128 a[56:59], v10
v_mfma_f32_16x16x32_bf16 v[240:243], a[32:35], a[84:87], v[240:243]
ds_read_b128 a[76:79], v11
v_mfma_f32_16x16x32_bf16 v[240:243], a[12:15], a[80:83], v[240:243]
v_mfma_f32_16x16x32_bf16 v[252:255], a[16:19], a[80:83], v[252:255]
v_mfma_f32_16x16x32_bf16 v[252:255], a[36:39], a[84:87], v[252:255]
buffer_load_dwordx4 v16, s[48:51], s32 offen offset:2048 sc1 lds
v_mfma_f32_16x16x32_bf16 v[244:247], a[12:15], a[88:91], v[244:247]
ds_read_b64_tr_b16 a[80:81], v14 offset:8192
v_mfma_f32_16x16x32_bf16 v[244:247], a[32:35], a[92:95], v[244:247]
ds_read_b64_tr_b16 a[82:83], v14 offset:8448
v_mfma_f32_16x16x32_bf16 v[236:239], a[28:31], a[92:95], v[236:239]
ds_read_b64_tr_b16 a[84:85], v14 offset:10240
v_mfma_f32_16x16x32_bf16 v[236:239], a[8:11], a[88:91], v[236:239]
ds_read_b64_tr_b16 a[86:87], v14 offset:10496
v_mfma_f32_16x16x32_bf16 v[228:231], a[4:7], a[88:91], v[228:231]
buffer_load_dwordx4 v16, s[48:51], s32 offen offset:3072 sc1 lds
v_mfma_f32_16x16x32_bf16 v[228:231], a[24:27], a[92:95], v[228:231]
v_mfma_f32_16x16x32_bf16 v[220:223], a[20:23], a[92:95], v[220:223]
v_mfma_f32_16x16x32_bf16 v[220:223], a[0:3], a[88:91], v[220:223]
s_waitcnt lgkmcnt(6)
L_S23:
v_mfma_f32_16x16x32_bf16 v[184:187], a[96:99], a[40:43], v[184:187]
ds_read_b64_tr_b16 a[88:89], v15 offset:8192
v_mov_b32 v8, v19
v_mov_b32 v9, 0xf149f2ca
v_mfma_f32_16x16x32_bf16 v[184:187], a[100:103], a[60:63], v[184:187]
buffer_store_dwordx4 a[116:119], v16, s[88:91], s10 offen offset:1024 sc1
v_mfma_f32_16x16x32_bf16 v[192:195], a[100:103], a[64:67], v[192:195]
ds_read_b64_tr_b16 a[90:91], v15 offset:8448
v_mfma_f32_16x16x32_bf16 v[192:195], a[96:99], a[44:47], v[192:195]
ds_read_b64_tr_b16 a[92:93], v15 offset:10240
v_mfma_f32_16x16x32_bf16 v[200:203], a[96:99], a[48:51], v[200:203]
ds_read_b64_tr_b16 a[94:95], v15 offset:10496
v_mfma_f32_16x16x32_bf16 v[200:203], a[100:103], a[68:71], v[200:203]
s_add_u32 m0, s19, 0x9000
v_mfma_f32_16x16x32_bf16 v[208:211], a[100:103], a[72:75], v[208:211]
buffer_load_dwordx4 v16, s[48:51], s7 offen offset:0 sc1 lds
v_mfma_f32_16x16x32_bf16 v[208:211], a[96:99], a[52:55], v[208:211]
s_waitcnt lgkmcnt(9)
v_mfma_f32_16x16x32_bf16 v[248:251], a[96:99], a[56:59], v[248:251]
s_waitcnt lgkmcnt(8)
v_mfma_f32_16x16x32_bf16 v[248:251], a[100:103], a[76:79], v[248:251]
v_mfma_f32_16x16x32_bf16 v[212:215], a[104:107], a[52:55], v[212:215]
ds_read_b64_tr_b16 a[96:97], v14 offset:0
v_mfma_f32_16x16x32_bf16 v[212:215], a[108:111], a[72:75], v[212:215]
buffer_load_dwordx4 v16, s[48:51], s7 offen offset:1024 sc1 lds
v_mfma_f32_16x16x32_bf16 v[204:207], a[108:111], a[68:71], v[204:207]
ds_read_b64_tr_b16 a[98:99], v14 offset:256
v_mfma_f32_16x16x32_bf16 v[204:207], a[104:107], a[48:51], v[204:207]
ds_read_b64_tr_b16 a[100:101], v14 offset:2048
v_mfma_f32_16x16x32_bf16 v[196:199], a[104:107], a[44:47], v[196:199]
ds_read_b64_tr_b16 a[102:103], v14 offset:2304
v_mfma_f32_16x16x32_bf16 v[196:199], a[108:111], a[64:67], v[196:199]
v_mfma_f32_16x16x32_bf16 v[188:191], a[108:111], a[60:63], v[188:191]
buffer_store_dwordx4 a[116:119], v16, s[88:91], s10 offen offset:2048 sc1
v_mfma_f32_16x16x32_bf16 v[188:191], a[104:107], a[40:43], v[188:191]
s_waitcnt lgkmcnt(4)
v_mfma_f32_16x16x32_bf16 v[216:219], a[40:43], a[80:83], v[216:219]
ds_read_b64_tr_b16 a[104:105], v15 offset:0
v_mfma_f32_16x16x32_bf16 v[216:219], a[60:63], a[84:87], v[216:219]
ds_read_b64_tr_b16 a[106:107], v15 offset:256
v_mfma_f32_16x16x32_bf16 v[224:227], a[64:67], a[84:87], v[224:227]
ds_read_b64_tr_b16 a[108:109], v15 offset:2048
v_mfma_f32_16x16x32_bf16 v[224:227], a[44:47], a[80:83], v[224:227]
buffer_load_dwordx4 v16, s[48:51], s7 offen offset:2048 sc1 lds
v_mfma_f32_16x16x32_bf16 v[232:235], a[48:51], a[80:83], v[232:235]
ds_read_b64_tr_b16 a[110:111], v15 offset:2304
v_cvt_pk_bf16_f32 v248, v248, v249
v_mfma_f32_16x16x32_bf16 v[232:235], a[68:71], a[84:87], v[232:235]
v_cvt_pk_bf16_f32 v249, v250, v251
v_cvt_pk_bf16_f32 v184, v184, v185
v_mfma_f32_16x16x32_bf16 v[240:243], a[72:75], a[84:87], v[240:243]
v_cvt_pk_bf16_f32 v185, v186, v187
v_cvt_pk_bf16_f32 v186, v188, v189
v_cvt_pk_bf16_f32 v187, v190, v191
v_mfma_f32_16x16x32_bf16 v[240:243], a[52:55], a[80:83], v[240:243]
v_cvt_pk_bf16_f32 v192, v192, v193
v_cvt_pk_bf16_f32 v193, v194, v195
v_mfma_f32_16x16x32_bf16 v[252:255], a[56:59], a[80:83], v[252:255]
buffer_load_dwordx4 v16, s[48:51], s7 offen offset:3072 sc1 lds
v_mfma_f32_16x16x32_bf16 v[252:255], a[76:79], a[84:87], v[252:255]
s_add_u32 s32, s32, 0x8000
s_add_u32 s7, s7, 0x8000
v_cvt_pk_bf16_f32 v194, v196, v197
v_mfma_f32_16x16x32_bf16 v[244:247], a[52:55], a[88:91], v[244:247]
ds_read_b64_tr_b16 a[80:81], v12 offset:0
v_cvt_pk_bf16_f32 v195, v198, v199
v_cvt_pk_bf16_f32 v200, v200, v201
v_mfma_f32_16x16x32_bf16 v[244:247], a[72:75], a[92:95], v[244:247]
ds_read_b64_tr_b16 a[82:83], v12 offset:1024
v_cvt_pk_bf16_f32 v201, v202, v203
v_mfma_f32_16x16x32_bf16 v[236:239], a[68:71], a[92:95], v[236:239]
ds_read_b64_tr_b16 a[84:85], v12 offset:8192
v_cvt_pk_bf16_f32 v202, v204, v205
v_mfma_f32_16x16x32_bf16 v[236:239], a[48:51], a[88:91], v[236:239]
buffer_store_dwordx4 a[116:119], v16, s[88:91], s10 offen offset:3072 sc1
v_mfma_f32_16x16x32_bf16 v[228:231], a[44:47], a[88:91], v[228:231]
ds_read_b64_tr_b16 a[86:87], v12 offset:9216
v_cvt_pk_bf16_f32 v203, v206, v207
v_cvt_pk_bf16_f32 v208, v208, v209
v_mfma_f32_16x16x32_bf16 v[228:231], a[64:67], a[92:95], v[228:231]
v_cvt_pk_bf16_f32 v209, v210, v211
v_cvt_pk_bf16_f32 v210, v212, v213
v_mfma_f32_16x16x32_bf16 v[220:223], a[60:63], a[92:95], v[220:223]
v_cvt_pk_bf16_f32 v211, v214, v215
v_mfma_f32_16x16x32_bf16 v[220:223], a[40:43], a[88:91], v[220:223]
s_waitcnt lgkmcnt(4)
v_mfma_f32_16x16x32_bf16 v[152:155], a[96:99], a[40:43], v[152:155]
ds_read_b64_tr_b16 a[88:89], v13 offset:0
v_mfma_f32_16x16x32_bf16 v[152:155], a[100:103], a[60:63], v[152:155]
ds_read_b64_tr_b16 a[90:91], v13 offset:1024
v_mfma_f32_16x16x32_bf16 v[160:163], a[100:103], a[64:67], v[160:163]
ds_read_b64_tr_b16 a[92:93], v13 offset:8192
v_mfma_f32_16x16x32_bf16 v[160:163], a[96:99], a[44:47], v[160:163]
ds_read_b64_tr_b16 a[94:95], v13 offset:9216
v_mfma_f32_16x16x32_bf16 v[168:171], a[96:99], a[48:51], v[168:171]
ds_write_b64 v22, v[248:249]
v_mfma_f32_16x16x32_bf16 v[168:171], a[100:103], a[68:71], v[168:171]
ds_write_b128 v5, v[192:195] offset:2048
v_mfma_f32_16x16x32_bf16 v[176:179], a[100:103], a[72:75], v[176:179]
ds_write_b128 v5, v[208:211] offset:18432
v_mfma_f32_16x16x32_bf16 v[176:179], a[96:99], a[52:55], v[176:179]
ds_write_b128 v4, v[184:187] offset:2048
v_mfma_f32_16x16x32_bf16 v[180:183], a[104:107], a[52:55], v[180:183]
ds_read_b64_tr_b16 a[96:97], v12 offset:256
v_mfma_f32_16x16x32_bf16 v[180:183], a[108:111], a[72:75], v[180:183]
ds_read_b64_tr_b16 a[98:99], v12 offset:1280
v_mfma_f32_16x16x32_bf16 v[172:175], a[108:111], a[68:71], v[172:175]
ds_read_b64_tr_b16 a[100:101], v12 offset:8448
v_mfma_f32_16x16x32_bf16 v[172:175], a[104:107], a[48:51], v[172:175]
ds_read_b64_tr_b16 a[102:103], v12 offset:9472
v_mfma_f32_16x16x32_bf16 v[164:167], a[104:107], a[44:47], v[164:167]
ds_write_b128 v4, v[200:203] offset:18432
v_cvt_pk_bf16_f32 v252, v252, v253
v_mfma_f32_16x16x32_bf16 v[164:167], a[108:111], a[64:67], v[164:167]
v_cvt_pk_bf16_f32 v253, v254, v255
v_cvt_pk_bf16_f32 v219, v218, v219
v_mfma_f32_16x16x32_bf16 v[156:159], a[108:111], a[60:63], v[156:159]
v_cvt_pk_bf16_f32 v218, v216, v217
v_cvt_pk_bf16_f32 v223, v222, v223
v_mfma_f32_16x16x32_bf16 v[156:159], a[104:107], a[40:43], v[156:159]
s_waitcnt lgkmcnt(4)
v_cvt_pk_bf16_f32 v222, v220, v221
v_cvt_pk_bf16_f32 v227, v226, v227
v_mfma_f32_16x16x32_bf16 v[24:27], a[80:83], a[40:43], v[24:27]
ds_read_b64_tr_b16 a[104:105], v13 offset:256
v_cvt_pk_bf16_f32 v226, v224, v225
v_cvt_pk_bf16_f32 v231, v230, v231
v_mfma_f32_16x16x32_bf16 v[24:27], a[84:87], a[60:63], v[24:27]
ds_read_b64_tr_b16 a[106:107], v13 offset:1280
v_cvt_pk_bf16_f32 v230, v228, v229
v_mfma_f32_16x16x32_bf16 v[32:35], a[84:87], a[64:67], v[32:35]
ds_read_b64_tr_b16 a[108:109], v13 offset:8448
v_cvt_pk_bf16_f32 v235, v234, v235
v_mfma_f32_16x16x32_bf16 v[32:35], a[80:83], a[44:47], v[32:35]
ds_read_b64_tr_b16 a[110:111], v13 offset:9472
v_cvt_pk_bf16_f32 v234, v232, v233
v_mfma_f32_16x16x32_bf16 v[40:43], a[80:83], a[48:51], v[40:43]
v_cvt_pk_bf16_f32 v239, v238, v239
v_cvt_pk_bf16_f32 v238, v236, v237
v_cvt_pk_bf16_f32 v243, v242, v243
v_mfma_f32_16x16x32_bf16 v[40:43], a[84:87], a[68:71], v[40:43]
v_cvt_pk_bf16_f32 v242, v240, v241
v_cvt_pk_bf16_f32 v247, v246, v247
v_mfma_f32_16x16x32_bf16 v[48:51], a[84:87], a[72:75], v[48:51]
v_cvt_pk_bf16_f32 v246, v244, v245
v_mfma_f32_16x16x32_bf16 v[48:51], a[80:83], a[52:55], v[48:51]
ds_write_b64 v22, v[252:253] offset:1024
v_mfma_f32_16x16x32_bf16 v[52:55], a[88:91], a[52:55], v[52:55]
ds_read_b64_tr_b16 a[80:81], v12 offset:512
v_mfma_f32_16x16x32_bf16 v[52:55], a[92:95], a[72:75], v[52:55]
ds_read_b64_tr_b16 a[82:83], v12 offset:1536
v_mfma_f32_16x16x32_bf16 v[44:47], a[92:95], a[68:71], v[44:47]
ds_read_b64_tr_b16 a[84:85], v12 offset:8704
v_mfma_f32_16x16x32_bf16 v[44:47], a[88:91], a[48:51], v[44:47]
ds_read_b64_tr_b16 a[86:87], v12 offset:9728
v_mfma_f32_16x16x32_bf16 v[36:39], a[88:91], a[44:47], v[36:39]
ds_write_b64 v5, v[226:227] offset:3072
v_mfma_f32_16x16x32_bf16 v[36:39], a[92:95], a[64:67], v[36:39]
ds_write_b64 v5, v[230:231] offset:3080
v_mfma_f32_16x16x32_bf16 v[28:31], a[92:95], a[60:63], v[28:31]
ds_write_b64 v5, v[242:243] offset:19456
v_mfma_f32_16x16x32_bf16 v[28:31], a[88:91], a[40:43], v[28:31]
s_waitcnt lgkmcnt(4)
v_mfma_f32_16x16x32_bf16 v[56:59], a[96:99], a[40:43], v[56:59]
ds_read_b64_tr_b16 a[88:89], v13 offset:512
v_mfma_f32_16x16x32_bf16 v[56:59], a[100:103], a[60:63], v[56:59]
ds_read_b64_tr_b16 a[90:91], v13 offset:1536
v_mfma_f32_16x16x32_bf16 v[64:67], a[100:103], a[64:67], v[64:67]
ds_read_b64_tr_b16 a[92:93], v13 offset:8704
v_mfma_f32_16x16x32_bf16 v[64:67], a[96:99], a[44:47], v[64:67]
ds_read_b64_tr_b16 a[94:95], v13 offset:9728
v_mfma_f32_16x16x32_bf16 v[72:75], a[96:99], a[48:51], v[72:75]
ds_write_b64 v5, v[246:247] offset:19464
v_mfma_f32_16x16x32_bf16 v[72:75], a[100:103], a[68:71], v[72:75]
ds_write_b64 v4, v[218:219] offset:3072
v_mfma_f32_16x16x32_bf16 v[80:83], a[100:103], a[72:75], v[80:83]
ds_write_b64 v4, v[222:223] offset:3080
v_mfma_f32_16x16x32_bf16 v[80:83], a[96:99], a[52:55], v[80:83]
ds_write_b64 v4, v[234:235] offset:19456
v_mfma_f32_16x16x32_bf16 v[84:87], a[104:107], a[52:55], v[84:87]
ds_read_b64_tr_b16 a[96:97], v12 offset:768
v_mfma_f32_16x16x32_bf16 v[84:87], a[108:111], a[72:75], v[84:87]
ds_read_b64_tr_b16 a[98:99], v12 offset:1792
v_mfma_f32_16x16x32_bf16 v[76:79], a[108:111], a[68:71], v[76:79]
ds_read_b64_tr_b16 a[100:101], v12 offset:8960
v_mfma_f32_16x16x32_bf16 v[76:79], a[104:107], a[48:51], v[76:79]
ds_read_b64_tr_b16 a[102:103], v12 offset:9984
v_mfma_f32_16x16x32_bf16 v[68:71], a[104:107], a[44:47], v[68:71]
ds_write_b64 v4, v[238:239] offset:19464
v_cvt_pk_bf16_f32 v152, v152, v153
v_mfma_f32_16x16x32_bf16 v[68:71], a[108:111], a[64:67], v[68:71]
v_cvt_pk_bf16_f32 v153, v154, v155
v_cvt_pk_bf16_f32 v154, v156, v157
v_mfma_f32_16x16x32_bf16 v[60:63], a[108:111], a[60:63], v[60:63]
v_cvt_pk_bf16_f32 v155, v158, v159
v_cvt_pk_bf16_f32 v160, v160, v161
v_mfma_f32_16x16x32_bf16 v[60:63], a[104:107], a[40:43], v[60:63]
s_waitcnt lgkmcnt(4)
v_cvt_pk_bf16_f32 v161, v162, v163
v_cvt_pk_bf16_f32 v162, v164, v165
v_mfma_f32_16x16x32_bf16 v[88:91], a[80:83], a[40:43], v[88:91]
ds_read_b64_tr_b16 a[104:105], v13 offset:768
v_cvt_pk_bf16_f32 v163, v166, v167
v_cvt_pk_bf16_f32 v168, v168, v169
v_mfma_f32_16x16x32_bf16 v[88:91], a[84:87], a[60:63], v[88:91]
ds_read_b64_tr_b16 a[106:107], v13 offset:1792
v_cvt_pk_bf16_f32 v169, v170, v171
v_mfma_f32_16x16x32_bf16 v[96:99], a[84:87], a[64:67], v[96:99]
ds_read_b64_tr_b16 a[108:109], v13 offset:8960
v_cvt_pk_bf16_f32 v170, v172, v173
v_mfma_f32_16x16x32_bf16 v[96:99], a[80:83], a[44:47], v[96:99]
ds_read_b64_tr_b16 a[110:111], v13 offset:9984
v_cvt_pk_bf16_f32 v171, v174, v175
v_mfma_f32_16x16x32_bf16 v[104:107], a[80:83], a[48:51], v[104:107]
v_cvt_pk_bf16_f32 v176, v176, v177
v_cvt_pk_bf16_f32 v177, v178, v179
v_cvt_pk_bf16_f32 v178, v180, v181
v_mfma_f32_16x16x32_bf16 v[104:107], a[84:87], a[68:71], v[104:107]
v_cvt_pk_bf16_f32 v179, v182, v183
v_mfma_f32_16x16x32_bf16 v[112:115], a[84:87], a[72:75], v[112:115]
v_mfma_f32_16x16x32_bf16 v[112:115], a[80:83], a[52:55], v[112:115]
v_mfma_f32_16x16x32_bf16 v[116:119], a[88:91], a[52:55], v[116:119]
v_mfma_f32_16x16x32_bf16 v[116:119], a[92:95], a[72:75], v[116:119]
v_mfma_f32_16x16x32_bf16 v[108:111], a[92:95], a[68:71], v[108:111]
v_mfma_f32_16x16x32_bf16 v[108:111], a[88:91], a[48:51], v[108:111]
v_mov_b32 v15, s6
v_writelane_b32 v15, s18, 0
v_mfma_f32_16x16x32_bf16 v[100:103], a[88:91], a[44:47], v[100:103]
v_lshlrev_b32 v15, 2, v15
v_bfe_u32 v12, v0, 2, 2
v_lshlrev_b32 v12, 11, v12
v_mfma_f32_16x16x32_bf16 v[100:103], a[92:95], a[64:67], v[100:103]
v_lshrrev_b32 v13, 4, v0
v_lshl_add_u32 v12, v13, 6, v12
v_mfma_f32_16x16x32_bf16 v[92:95], a[92:95], a[60:63], v[92:95]
v_and_b32 v13, 3, v0
v_lshl_add_u32 v12, v13, 4, v12
v_mfma_f32_16x16x32_bf16 v[92:95], a[88:91], a[40:43], v[92:95]
s_waitcnt lgkmcnt(0)
v_xor_b32 v12, s13, v12
v_xor_b32 v13, 32, v12
v_mfma_f32_16x16x32_bf16 v[120:123], a[96:99], a[40:43], v[120:123]
v_add_u32 v13, 7168, v13
v_mul_f32 v24, s52, v24
v_mul_f32 v25, s52, v25
v_mfma_f32_16x16x32_bf16 v[120:123], a[100:103], a[60:63], v[120:123]
v_mul_f32 v26, s52, v26
v_mul_f32 v27, s52, v27
v_mfma_f32_16x16x32_bf16 v[128:131], a[100:103], a[64:67], v[128:131]
v_mul_f32 v28, s52, v28
v_mul_f32 v29, s52, v29
v_mfma_f32_16x16x32_bf16 v[128:131], a[96:99], a[44:47], v[128:131]
v_mul_f32 v30, s52, v30
v_mul_f32 v31, s52, v31
v_mfma_f32_16x16x32_bf16 v[136:139], a[96:99], a[48:51], v[136:139]
v_cvt_pk_bf16_f32 v24, v24, v25
v_cvt_pk_bf16_f32 v25, v26, v27
v_cvt_pk_bf16_f32 v26, v28, v29
v_mfma_f32_16x16x32_bf16 v[136:139], a[100:103], a[68:71], v[136:139]
v_cvt_pk_bf16_f32 v27, v30, v31
v_accvgpr_write_b32 a160, v24
v_mfma_f32_16x16x32_bf16 v[144:147], a[100:103], a[72:75], v[144:147]
v_accvgpr_write_b32 a161, v25
v_accvgpr_write_b32 a162, v26
v_mfma_f32_16x16x32_bf16 v[144:147], a[96:99], a[52:55], v[144:147]
v_accvgpr_write_b32 a163, v27
v_mul_f32 v32, s52, v32
v_mfma_f32_16x16x32_bf16 v[148:151], a[104:107], a[52:55], v[148:151]
v_mul_f32 v33, s52, v33
v_mul_f32 v34, s52, v34
v_mul_f32 v35, s52, v35
v_mfma_f32_16x16x32_bf16 v[148:151], a[108:111], a[72:75], v[148:151]
v_mul_f32 v36, s52, v36
v_mul_f32 v37, s52, v37
v_mfma_f32_16x16x32_bf16 v[140:143], a[108:111], a[68:71], v[140:143]
v_mul_f32 v38, s52, v38
v_mul_f32 v39, s52, v39
v_mfma_f32_16x16x32_bf16 v[140:143], a[104:107], a[48:51], v[140:143]
v_cvt_pk_bf16_f32 v32, v32, v33
v_cvt_pk_bf16_f32 v33, v34, v35
v_mfma_f32_16x16x32_bf16 v[132:135], a[104:107], a[44:47], v[132:135]
v_cvt_pk_bf16_f32 v34, v36, v37
v_cvt_pk_bf16_f32 v35, v38, v39
v_accvgpr_write_b32 a176, v32
v_mfma_f32_16x16x32_bf16 v[132:135], a[108:111], a[64:67], v[132:135]
v_accvgpr_write_b32 a177, v33
v_accvgpr_write_b32 a178, v34
v_mfma_f32_16x16x32_bf16 v[124:127], a[108:111], a[60:63], v[124:127]
v_accvgpr_write_b32 a179, v35
v_mfma_f32_16x16x32_bf16 v[124:127], a[104:107], a[40:43], v[124:127]
s_waitcnt vmcnt(21) lgkmcnt(0)
s_barrier
ds_read_b64 v[188:189], v4 offset:8
ds_read_b64 v[190:191], v4 offset:0
ds_read_b64 v[216:217], v4 offset:1032
ds_read_b64 v[220:221], v4 offset:1024
ds_read_b64 v[196:197], v6 offset:0
ds_read_b64 v[198:199], v7 offset:0
ds_read_b64 v[224:225], v6 offset:1024
ds_read_b64 v[228:229], v7 offset:1024
ds_read_b64 v[204:205], v4 offset:16392
ds_read_b64 v[206:207], v4 offset:16384
ds_read_b64 v[232:233], v4 offset:17416
ds_read_b64 v[236:237], v4 offset:17408
ds_read_b64 v[212:213], v6 offset:16384
ds_read_b64 v[214:215], v7 offset:16384
ds_read_b64 v[240:241], v6 offset:17408
ds_read_b64 v[244:245], v7 offset:17408
ds_read_b128 a[0:3], v1 offset:8192
ds_read_b128 a[4:7], v1 offset:9216
ds_read_b128 a[8:11], v1 offset:10240
ds_read_b128 a[12:15], v1 offset:11264
ds_read_b128 a[16:19], v1 offset:12288
ds_read_b128 a[20:23], v1 offset:13312
ds_read_b128 a[24:27], v1 offset:14336
ds_read_b128 a[28:31], v1 offset:15360
v_pk_mul_f32 v[40:41], v[40:41], s[52:53]
v_pk_mul_f32 v[42:43], v[42:43], s[52:53]
v_pk_mul_f32 v[44:45], v[44:45], s[52:53]
v_pk_mul_f32 v[46:47], v[46:47], s[52:53]
v_cvt_pk_bf16_f32 v40, v40, v41
v_cvt_pk_bf16_f32 v41, v42, v43
v_cvt_pk_bf16_f32 v42, v44, v45
v_cvt_pk_bf16_f32 v43, v46, v47
v_accvgpr_write_b32 a192, v40
v_accvgpr_write_b32 a193, v41
v_accvgpr_write_b32 a194, v42
v_accvgpr_write_b32 a195, v43
v_pk_mul_f32 v[48:49], v[48:49], s[52:53]
v_pk_mul_f32 v[50:51], v[50:51], s[52:53]
v_pk_mul_f32 v[52:53], v[52:53], s[52:53]
v_pk_mul_f32 v[54:55], v[54:55], s[52:53]
v_cvt_pk_bf16_f32 v48, v48, v49
v_cvt_pk_bf16_f32 v49, v50, v51
v_cvt_pk_bf16_f32 v50, v52, v53
v_cvt_pk_bf16_f32 v51, v54, v55
v_accvgpr_write_b32 a208, v48
v_accvgpr_write_b32 a209, v49
v_accvgpr_write_b32 a210, v50
v_accvgpr_write_b32 a211, v51
v_mov_b32 v47, s55
v_cndmask_b32 v36, v9, 0, s[56:57]
v_cndmask_b32 v40, v9, 0, s[68:69]
v_min_f32 v32, s55, v36
v_cndmask_b32 v44, v47, 0, s[36:37]
v_cndmask_b32 v37, v9, 0, s[58:59]
v_cndmask_b32 v41, v9, 0, s[70:71]
v_min_f32 v33, s55, v37
v_cndmask_b32 v45, v47, 0, s[38:39]
v_cndmask_b32 v38, v9, 0, s[60:61]
v_cndmask_b32 v42, v9, 0, s[76:77]
v_min_f32 v34, s55, v38
v_cndmask_b32 v46, v47, 0, s[40:41]
v_cndmask_b32 v39, v9, 0, s[62:63]
v_cndmask_b32 v43, v9, 0, s[78:79]
v_min_f32 v35, s55, v39
v_cndmask_b32 v47, v47, 0, s[42:43]
v_pk_mul_f32 v[56:57], v[56:57], s[52:53]
v_pk_mul_f32 v[58:59], v[58:59], s[52:53]
v_pk_mul_f32 v[60:61], v[60:61], s[52:53]
v_pk_mul_f32 v[62:63], v[62:63], s[52:53]
v_cvt_pk_bf16_f32 v56, v56, v57
v_cvt_pk_bf16_f32 v57, v58, v59
v_cvt_pk_bf16_f32 v58, v60, v61
v_cvt_pk_bf16_f32 v59, v62, v63
v_accvgpr_write_b32 a164, v56
v_accvgpr_write_b32 a165, v57
v_accvgpr_write_b32 a166, v58
v_accvgpr_write_b32 a167, v59
v_pk_mul_f32 v[64:65], v[64:65], s[52:53]
v_pk_mul_f32 v[66:67], v[66:67], s[52:53]
v_pk_mul_f32 v[68:69], v[68:69], s[52:53]
v_pk_mul_f32 v[70:71], v[70:71], s[52:53]
v_cvt_pk_bf16_f32 v64, v64, v65
v_cvt_pk_bf16_f32 v65, v66, v67
v_cvt_pk_bf16_f32 v66, v68, v69
v_cvt_pk_bf16_f32 v67, v70, v71
v_accvgpr_write_b32 a180, v64
v_accvgpr_write_b32 a181, v65
v_accvgpr_write_b32 a182, v66
v_accvgpr_write_b32 a183, v67
v_pk_mul_f32 v[72:73], v[72:73], s[52:53]
v_pk_mul_f32 v[74:75], v[74:75], s[52:53]
v_pk_mul_f32 v[76:77], v[76:77], s[52:53]
v_pk_mul_f32 v[78:79], v[78:79], s[52:53]
v_cvt_pk_bf16_f32 v72, v72, v73
v_cvt_pk_bf16_f32 v73, v74, v75
v_cvt_pk_bf16_f32 v74, v76, v77
v_cvt_pk_bf16_f32 v75, v78, v79
v_accvgpr_write_b32 a196, v72
v_accvgpr_write_b32 a197, v73
v_accvgpr_write_b32 a198, v74
v_accvgpr_write_b32 a199, v75
v_pk_mul_f32 v[80:81], v[80:81], s[52:53]
v_pk_mul_f32 v[82:83], v[82:83], s[52:53]
v_pk_mul_f32 v[84:85], v[84:85], s[52:53]
v_pk_mul_f32 v[86:87], v[86:87], s[52:53]
v_cvt_pk_bf16_f32 v80, v80, v81
v_cvt_pk_bf16_f32 v81, v82, v83
v_cvt_pk_bf16_f32 v82, v84, v85
v_cvt_pk_bf16_f32 v83, v86, v87
v_accvgpr_write_b32 a212, v80
v_accvgpr_write_b32 a213, v81
v_accvgpr_write_b32 a214, v82
v_accvgpr_write_b32 a215, v83
v_pk_mul_f32 v[88:89], v[88:89], s[52:53]
v_pk_mul_f32 v[90:91], v[90:91], s[52:53]
v_pk_mul_f32 v[92:93], v[92:93], s[52:53]
v_pk_mul_f32 v[94:95], v[94:95], s[52:53]
v_cvt_pk_bf16_f32 v88, v88, v89
v_cvt_pk_bf16_f32 v89, v90, v91
v_cvt_pk_bf16_f32 v90, v92, v93
v_cvt_pk_bf16_f32 v91, v94, v95
v_accvgpr_write_b32 a168, v88
v_accvgpr_write_b32 a169, v89
v_accvgpr_write_b32 a170, v90
v_accvgpr_write_b32 a171, v91
v_pk_mul_f32 v[96:97], v[96:97], s[52:53]
v_pk_mul_f32 v[98:99], v[98:99], s[52:53]
v_pk_mul_f32 v[100:101], v[100:101], s[52:53]
v_pk_mul_f32 v[102:103], v[102:103], s[52:53]
v_cvt_pk_bf16_f32 v96, v96, v97
v_cvt_pk_bf16_f32 v97, v98, v99
v_cvt_pk_bf16_f32 v98, v100, v101
v_cvt_pk_bf16_f32 v99, v102, v103
v_accvgpr_write_b32 a184, v96
v_accvgpr_write_b32 a185, v97
v_accvgpr_write_b32 a186, v98
v_accvgpr_write_b32 a187, v99
v_pk_mul_f32 v[104:105], v[104:105], s[52:53]
v_pk_mul_f32 v[106:107], v[106:107], s[52:53]
v_pk_mul_f32 v[108:109], v[108:109], s[52:53]
v_pk_mul_f32 v[110:111], v[110:111], s[52:53]
v_cvt_pk_bf16_f32 v104, v104, v105
v_cvt_pk_bf16_f32 v105, v106, v107
v_cvt_pk_bf16_f32 v106, v108, v109
v_cvt_pk_bf16_f32 v107, v110, v111
v_accvgpr_write_b32 a200, v104
v_accvgpr_write_b32 a201, v105
v_accvgpr_write_b32 a202, v106
v_accvgpr_write_b32 a203, v107
v_pk_mul_f32 v[112:113], v[112:113], s[52:53]
v_pk_mul_f32 v[114:115], v[114:115], s[52:53]
v_pk_mul_f32 v[116:117], v[116:117], s[52:53]
v_pk_mul_f32 v[118:119], v[118:119], s[52:53]
v_cvt_pk_bf16_f32 v112, v112, v113
v_cvt_pk_bf16_f32 v113, v114, v115
v_cvt_pk_bf16_f32 v114, v116, v117
v_cvt_pk_bf16_f32 v115, v118, v119
v_accvgpr_write_b32 a216, v112
v_accvgpr_write_b32 a217, v113
v_accvgpr_write_b32 a218, v114
v_accvgpr_write_b32 a219, v115
v_pk_mul_f32 v[120:121], v[120:121], s[52:53]
v_pk_mul_f32 v[122:123], v[122:123], s[52:53]
v_pk_mul_f32 v[124:125], v[124:125], s[52:53]
v_pk_mul_f32 v[126:127], v[126:127], s[52:53]
v_cvt_pk_bf16_f32 v120, v120, v121
v_cvt_pk_bf16_f32 v121, v122, v123
v_cvt_pk_bf16_f32 v122, v124, v125
v_cvt_pk_bf16_f32 v123, v126, v127
v_accvgpr_write_b32 a172, v120
v_accvgpr_write_b32 a173, v121
v_accvgpr_write_b32 a174, v122
v_accvgpr_write_b32 a175, v123
v_pk_mul_f32 v[128:129], v[128:129], s[52:53]
v_pk_mul_f32 v[130:131], v[130:131], s[52:53]
v_pk_mul_f32 v[132:133], v[132:133], s[52:53]
v_pk_mul_f32 v[134:135], v[134:135], s[52:53]
v_cvt_pk_bf16_f32 v128, v128, v129
v_cvt_pk_bf16_f32 v129, v130, v131
v_cvt_pk_bf16_f32 v130, v132, v133
v_cvt_pk_bf16_f32 v131, v134, v135
v_accvgpr_write_b32 a188, v128
v_accvgpr_write_b32 a189, v129
v_accvgpr_write_b32 a190, v130
v_accvgpr_write_b32 a191, v131
v_pk_mul_f32 v[136:137], v[136:137], s[52:53]
v_pk_mul_f32 v[138:139], v[138:139], s[52:53]
v_pk_mul_f32 v[140:141], v[140:141], s[52:53]
v_pk_mul_f32 v[142:143], v[142:143], s[52:53]
v_cvt_pk_bf16_f32 v136, v136, v137
v_cvt_pk_bf16_f32 v137, v138, v139
v_cvt_pk_bf16_f32 v138, v140, v141
v_cvt_pk_bf16_f32 v139, v142, v143
v_accvgpr_write_b32 a204, v136
v_accvgpr_write_b32 a205, v137
v_accvgpr_write_b32 a206, v138
v_accvgpr_write_b32 a207, v139
v_pk_mul_f32 v[144:145], v[144:145], s[52:53]
v_pk_mul_f32 v[146:147], v[146:147], s[52:53]
v_pk_mul_f32 v[148:149], v[148:149], s[52:53]
v_pk_mul_f32 v[150:151], v[150:151], s[52:53]
v_cvt_pk_bf16_f32 v144, v144, v145
v_cvt_pk_bf16_f32 v145, v146, v147
v_cvt_pk_bf16_f32 v146, v148, v149
v_cvt_pk_bf16_f32 v147, v150, v151
v_accvgpr_write_b32 a220, v144
v_accvgpr_write_b32 a221, v145
v_accvgpr_write_b32 a222, v146
v_accvgpr_write_b32 a223, v147
s_waitcnt lgkmcnt(0)
s_barrier
v_mfma_f32_16x16x32_bf16 v[52:55], v[184:187], v[152:155], v[40:43]
v_mov_b32 v140, 0
v_mov_b32 v141, 0
v_mfma_f32_16x16x32_bf16 v[48:51], v[188:191], v[152:155], v[32:35]
v_mov_b32 v142, 0
v_mov_b32 v143, 0
v_mfma_f32_16x16x32_bf16 v[60:63], v[192:195], v[160:163], v[40:43]
v_mov_b32 v144, 0
v_mov_b32 v145, 0
v_mfma_f32_16x16x32_bf16 v[56:59], v[196:199], v[160:163], v[36:39]
v_mov_b32 v146, 0
v_mov_b32 v147, 0
v_mfma_f32_16x16x32_bf16 v[68:71], v[200:203], v[168:171], v[40:43]
v_mov_b32 v148, 0
v_mov_b32 v149, 0
v_mfma_f32_16x16x32_bf16 v[64:67], v[204:207], v[168:171], v[36:39]
v_max3_f32 v136, v48, v49, v50
v_max3_f32 v136, v136, v51, v52
v_mfma_f32_16x16x32_bf16 v[76:79], v[208:211], v[176:179], v[40:43]
v_max3_f32 v136, v136, v53, v54
v_max_f32 v136, v136, v55
v_mfma_f32_16x16x32_bf16 v[72:75], v[212:215], v[176:179], v[36:39]
v_max3_f32 v137, v56, v57, v58
v_max3_f32 v137, v137, v59, v60
v_mfma_f32_16x16x32_bf16 v[16:19], a[0:3], a[160:163], v[44:47]
v_max3_f32 v137, v137, v61, v62
v_max_f32 v137, v137, v63
v_mfma_f32_16x16x32_bf16 v[16:19], a[4:7], a[164:167], v[16:19]
v_max3_f32 v138, v64, v65, v66
v_max3_f32 v138, v138, v67, v68
v_mfma_f32_16x16x32_bf16 v[16:19], a[8:11], a[168:171], v[16:19]
v_max3_f32 v138, v138, v69, v70
v_max_f32 v138, v138, v71
v_mfma_f32_16x16x32_bf16 v[16:19], a[12:15], a[172:175], v[16:19]
v_max3_f32 v139, v72, v73, v74
v_max3_f32 v139, v139, v75, v76
v_mfma_f32_16x16x32_bf16 v[20:23], a[0:3], a[176:179], 0
v_max3_f32 v139, v139, v77, v78
v_max_f32 v139, v139, v79
v_mfma_f32_16x16x32_bf16 v[20:23], a[4:7], a[180:183], v[20:23]
v_mov_b32 v150, 0
v_mov_b32 v151, 0
v_mfma_f32_16x16x32_bf16 v[20:23], a[8:11], a[184:187], v[20:23]
v_mov_b32 v248, 0
v_mov_b32 v249, 0
v_mfma_f32_16x16x32_bf16 v[20:23], a[12:15], a[188:191], v[20:23]
v_mov_b32 v250, 0
v_mov_b32 v251, 0
v_mfma_f32_16x16x32_bf16 v[24:27], a[0:3], a[192:195], 0
v_mov_b32 v252, 0
v_mov_b32 v253, 0
v_mfma_f32_16x16x32_bf16 v[24:27], a[4:7], a[196:199], v[24:27]
v_mov_b32 v254, 0
v_mov_b32 v255, 0
v_mfma_f32_16x16x32_bf16 v[24:27], a[8:11], a[200:203], v[24:27]
v_max3_f32 v80, v16, v17, v18
v_max_f32 v80, v80, v19
v_mfma_f32_16x16x32_bf16 v[24:27], a[12:15], a[204:207], v[24:27]
v_max3_f32 v84, v20, v21, v22
v_max_f32 v84, v84, v23
v_mfma_f32_16x16x32_bf16 v[28:31], a[0:3], a[208:211], 0
v_mov_b32 v128, v136
v_mov_b32 v129, v137
v_mfma_f32_16x16x32_bf16 v[28:31], a[4:7], a[212:215], v[28:31]
v_mov_b32 v130, v138
v_mov_b32 v131, v139
v_mfma_f32_16x16x32_bf16 v[28:31], a[8:11], a[216:219], v[28:31]
v_permlane16_swap_b32 v128, v136
v_permlane16_swap_b32 v129, v137
v_mfma_f32_16x16x32_bf16 v[28:31], a[12:15], a[220:223], v[28:31]
v_permlane16_swap_b32 v130, v138
v_permlane16_swap_b32 v131, v139
v_max_f32 v136, v136, v128
v_max_f32 v137, v137, v129
v_max_f32 v138, v138, v130
v_max_f32 v139, v139, v131
v_max3_f32 v88, v24, v25, v26
v_max_f32 v88, v88, v27
v_mov_b32 v128, v136
v_mov_b32 v129, v137
v_mov_b32 v130, v138
v_mov_b32 v131, v139
v_max3_f32 v92, v28, v29, v30
v_max_f32 v92, v92, v31
v_permlane32_swap_b32 v128, v136
v_permlane32_swap_b32 v129, v137
v_permlane32_swap_b32 v130, v138
v_permlane32_swap_b32 v131, v139
v_max_f32 v136, v136, v128
v_max_f32 v137, v137, v129
v_max_f32 v138, v138, v130
v_max_f32 v139, v139, v131
v_mul_f32 v136, s54, v136
v_mul_f32 v137, s54, v137
v_mul_f32 v138, s54, v138
v_mul_f32 v139, s54, v139
v_fma_f32 v48, v48, s54, -v136
v_fma_f32 v49, v49, s54, -v136
v_fma_f32 v50, v50, s54, -v136
v_fma_f32 v51, v51, s54, -v136
v_fma_f32 v52, v52, s54, -v136
v_fma_f32 v53, v53, s54, -v136
v_fma_f32 v54, v54, s54, -v136
v_fma_f32 v55, v55, s54, -v136
v_exp_f32 v48, v48
v_exp_f32 v49, v49
v_exp_f32 v50, v50
v_exp_f32 v51, v51
v_exp_f32 v52, v52
v_exp_f32 v53, v53
v_exp_f32 v54, v54
v_exp_f32 v55, v55
v_fma_f32 v56, v56, s54, -v137
v_fma_f32 v57, v57, s54, -v137
v_fma_f32 v58, v58, s54, -v137
v_fma_f32 v59, v59, s54, -v137
v_fma_f32 v60, v60, s54, -v137
v_fma_f32 v61, v61, s54, -v137
v_fma_f32 v62, v62, s54, -v137
v_fma_f32 v63, v63, s54, -v137
v_exp_f32 v56, v56
v_exp_f32 v57, v57
v_exp_f32 v58, v58
v_exp_f32 v59, v59
v_exp_f32 v60, v60
v_exp_f32 v61, v61
v_exp_f32 v62, v62
v_exp_f32 v63, v63
v_fma_f32 v64, v64, s54, -v138
v_fma_f32 v65, v65, s54, -v138
v_fma_f32 v66, v66, s54, -v138
v_fma_f32 v67, v67, s54, -v138
v_fma_f32 v68, v68, s54, -v138
v_fma_f32 v69, v69, s54, -v138
v_fma_f32 v70, v70, s54, -v138
v_fma_f32 v71, v71, s54, -v138
v_exp_f32 v64, v64
v_exp_f32 v65, v65
v_exp_f32 v66, v66
v_exp_f32 v67, v67
v_exp_f32 v68, v68
v_exp_f32 v69, v69
v_exp_f32 v70, v70
v_exp_f32 v71, v71
v_fma_f32 v72, v72, s54, -v139
v_fma_f32 v73, v73, s54, -v139
v_fma_f32 v74, v74, s54, -v139
v_fma_f32 v75, v75, s54, -v139
v_fma_f32 v76, v76, s54, -v139
v_fma_f32 v77, v77, s54, -v139
v_fma_f32 v78, v78, s54, -v139
v_fma_f32 v79, v79, s54, -v139
v_exp_f32 v72, v72
v_exp_f32 v73, v73
v_exp_f32 v74, v74
v_exp_f32 v75, v75
v_exp_f32 v76, v76
v_exp_f32 v77, v77
v_exp_f32 v78, v78
v_exp_f32 v79, v79
v_cvt_pk_bf16_f32 v48, v48, v49
v_cvt_pk_bf16_f32 v49, v50, v51
v_cvt_pk_bf16_f32 v50, v52, v53
v_cvt_pk_bf16_f32 v51, v54, v55
v_cvt_pk_bf16_f32 v56, v56, v57
v_cvt_pk_bf16_f32 v57, v58, v59
v_cvt_pk_bf16_f32 v58, v60, v61
v_cvt_pk_bf16_f32 v59, v62, v63
v_cvt_pk_bf16_f32 v64, v64, v65
v_cvt_pk_bf16_f32 v65, v66, v67
v_cvt_pk_bf16_f32 v66, v68, v69
v_cvt_pk_bf16_f32 v67, v70, v71
v_cvt_pk_bf16_f32 v72, v72, v73
v_cvt_pk_bf16_f32 v73, v74, v75
v_cvt_pk_bf16_f32 v74, v76, v77
v_cvt_pk_bf16_f32 v75, v78, v79
v_mfma_f32_16x16x32_bf16 v[156:159], a[240:243], v[48:51], 0
v_mov_b32 v128, v80
v_mov_b32 v129, v84
v_mfma_f32_16x16x32_bf16 v[164:167], a[240:243], v[56:59], 0
v_mov_b32 v130, v88
v_mov_b32 v131, v92
v_mfma_f32_16x16x32_bf16 v[172:175], a[240:243], v[64:67], 0
v_permlane16_swap_b32 v128, v80
v_permlane16_swap_b32 v129, v84
v_mfma_f32_16x16x32_bf16 v[180:183], a[240:243], v[72:75], 0
v_permlane16_swap_b32 v130, v88
v_permlane16_swap_b32 v131, v92
v_mfma_f32_16x16x32_bf16 v[184:187], v[216:219], v[48:51], 0
v_max_f32 v80, v80, v128
v_max_f32 v84, v84, v129
v_mfma_f32_16x16x32_bf16 v[188:191], v[220:223], v[48:51], 0
v_max_f32 v88, v88, v130
v_max_f32 v92, v92, v131
v_mfma_f32_16x16x32_bf16 v[192:195], v[224:227], v[56:59], 0
v_mov_b32 v128, v80
v_mov_b32 v129, v84
v_mfma_f32_16x16x32_bf16 v[196:199], v[228:231], v[56:59], 0
v_mov_b32 v130, v88
v_mov_b32 v131, v92
v_mfma_f32_16x16x32_bf16 v[200:203], v[232:235], v[64:67], 0
v_permlane32_swap_b32 v128, v80
v_permlane32_swap_b32 v129, v84
v_mfma_f32_16x16x32_bf16 v[204:207], v[236:239], v[64:67], 0
v_permlane32_swap_b32 v130, v88
v_permlane32_swap_b32 v131, v92
v_mfma_f32_16x16x32_bf16 v[208:211], v[240:243], v[72:75], 0
v_max_f32 v80, v80, v128
v_max_f32 v84, v84, v129
v_mfma_f32_16x16x32_bf16 v[212:215], v[244:247], v[72:75], 0
v_max_f32 v88, v88, v130
v_max_f32 v92, v92, v131
v_rcp_f32 v128, v156
v_rcp_f32 v130, v164
v_rcp_f32 v132, v172
v_rcp_f32 v134, v180
v_sub_f32 v83, 0, v80
v_sub_f32 v82, 0, v80
v_sub_f32 v81, 0, v80
v_sub_f32 v80, 0, v80
v_min_f32 v103, s8, v80
v_cndmask_b32 v96, v103, v80, s[36:37]
v_cndmask_b32 v97, v103, v80, s[38:39]
v_cndmask_b32 v98, v103, v80, s[40:41]
v_cndmask_b32 v99, v103, v80, s[42:43]
v_cndmask_b32 v100, v9, v103, s[36:37]
v_cndmask_b32 v101, v9, v103, s[38:39]
v_cndmask_b32 v102, v9, v103, s[40:41]
v_cndmask_b32 v103, v9, v103, s[42:43]
v_pk_mul_f32 v[184:185], v[184:185], v[128:129] op_sel_hi:[1,0]
v_pk_mul_f32 v[186:187], v[186:187], v[128:129] op_sel_hi:[1,0]
v_pk_mul_f32 v[188:189], v[188:189], v[128:129] op_sel_hi:[1,0]
v_pk_mul_f32 v[190:191], v[190:191], v[128:129] op_sel_hi:[1,0]
v_pk_mul_f32 v[192:193], v[192:193], v[130:131] op_sel_hi:[1,0]
v_pk_mul_f32 v[194:195], v[194:195], v[130:131] op_sel_hi:[1,0]
v_pk_mul_f32 v[196:197], v[196:197], v[130:131] op_sel_hi:[1,0]
v_pk_mul_f32 v[198:199], v[198:199], v[130:131] op_sel_hi:[1,0]
v_pk_mul_f32 v[200:201], v[200:201], v[132:133] op_sel_hi:[1,0]
v_pk_mul_f32 v[202:203], v[202:203], v[132:133] op_sel_hi:[1,0]
v_pk_mul_f32 v[204:205], v[204:205], v[132:133] op_sel_hi:[1,0]
v_pk_mul_f32 v[206:207], v[206:207], v[132:133] op_sel_hi:[1,0]
v_pk_mul_f32 v[208:209], v[208:209], v[134:135] op_sel_hi:[1,0]
v_pk_mul_f32 v[210:211], v[210:211], v[134:135] op_sel_hi:[1,0]
v_pk_mul_f32 v[212:213], v[212:213], v[134:135] op_sel_hi:[1,0]
v_pk_mul_f32 v[214:215], v[214:215], v[134:135] op_sel_hi:[1,0]
s_bitcmp1_b32 s4, 0
s_cbranch_scc1 L_ob_odd
v_cvt_pk_bf16_f32 v32, v184, v185
v_cvt_pk_bf16_f32 v33, v186, v187
v_cvt_pk_bf16_f32 v34, v188, v189
v_cvt_pk_bf16_f32 v35, v190, v191
v_cvt_pk_bf16_f32 v36, v192, v193
v_cvt_pk_bf16_f32 v37, v194, v195
v_cvt_pk_bf16_f32 v38, v196, v197
v_cvt_pk_bf16_f32 v39, v198, v199
v_cvt_pk_bf16_f32 v40, v200, v201
v_cvt_pk_bf16_f32 v41, v202, v203
v_cvt_pk_bf16_f32 v42, v204, v205
v_cvt_pk_bf16_f32 v43, v206, v207
v_cvt_pk_bf16_f32 v44, v208, v209
v_cvt_pk_bf16_f32 v45, v210, v211
v_cvt_pk_bf16_f32 v46, v212, v213
v_cvt_pk_bf16_f32 v47, v214, v215
s_branch L_ob_packed
L_ob_odd:
v_cvt_pk_bf16_f32 v35, v186, v187
v_cvt_pk_bf16_f32 v34, v184, v185
v_cvt_pk_bf16_f32 v32, v188, v189
v_cvt_pk_bf16_f32 v33, v190, v191
v_cvt_pk_bf16_f32 v39, v194, v195
v_cvt_pk_bf16_f32 v38, v192, v193
v_cvt_pk_bf16_f32 v36, v196, v197
v_cvt_pk_bf16_f32 v37, v198, v199
v_cvt_pk_bf16_f32 v43, v202, v203
v_cvt_pk_bf16_f32 v42, v200, v201
v_cvt_pk_bf16_f32 v40, v204, v205
v_cvt_pk_bf16_f32 v41, v206, v207
v_cvt_pk_bf16_f32 v47, v210, v211
v_cvt_pk_bf16_f32 v46, v208, v209
v_cvt_pk_bf16_f32 v44, v212, v213
v_cvt_pk_bf16_f32 v45, v214, v215
L_ob_packed:
buffer_store_dwordx4 v[32:35], v3, s[88:91], s44 offen sc1
v_sub_f32 v87, 0, v84
v_sub_f32 v86, 0, v84
v_sub_f32 v85, 0, v84
v_sub_f32 v84, 0, v84
v_min_f32 v111, s9, v84
v_cndmask_b32 v104, v111, v84, s[36:37]
v_cndmask_b32 v105, v111, v84, s[38:39]
v_cndmask_b32 v106, v111, v84, s[40:41]
v_cndmask_b32 v107, v111, v84, s[42:43]
v_cndmask_b32 v108, v9, v111, s[36:37]
v_cndmask_b32 v109, v9, v111, s[38:39]
v_cndmask_b32 v110, v9, v111, s[40:41]
v_cndmask_b32 v111, v9, v111, s[42:43]
v_sub_f32 v91, 0, v88
v_sub_f32 v90, 0, v88
v_sub_f32 v89, 0, v88
v_sub_f32 v88, 0, v88
v_min_f32 v119, s8, v88
v_cndmask_b32 v112, v119, v88, s[36:37]
v_cndmask_b32 v113, v119, v88, s[38:39]
v_cndmask_b32 v114, v119, v88, s[40:41]
v_cndmask_b32 v115, v119, v88, s[42:43]
v_cndmask_b32 v116, v9, v119, s[36:37]
buffer_store_dwordx4 v[36:39], v3, s[88:91], s45 offen sc1
v_cndmask_b32 v117, v9, v119, s[38:39]
v_cndmask_b32 v118, v9, v119, s[40:41]
v_cndmask_b32 v119, v9, v119, s[42:43]
v_sub_f32 v95, 0, v92
v_sub_f32 v94, 0, v92
v_sub_f32 v93, 0, v92
v_sub_f32 v92, 0, v92
v_min_f32 v127, s9, v92
v_cndmask_b32 v120, v127, v92, s[36:37]
v_cndmask_b32 v121, v127, v92, s[38:39]
v_cndmask_b32 v122, v127, v92, s[40:41]
v_cndmask_b32 v123, v127, v92, s[42:43]
v_cndmask_b32 v124, v9, v127, s[36:37]
v_cndmask_b32 v125, v9, v127, s[38:39]
v_cndmask_b32 v126, v9, v127, s[40:41]
v_cndmask_b32 v127, v9, v127, s[42:43]
v_mov_b64 v[128:129], 0
v_mov_b64 v[130:131], 0
v_mov_b64 v[132:133], 0
v_mov_b64 v[134:135], 0
v_mov_b64 v[136:137], 0
v_mov_b64 v[138:139], 0
v_mov_b64 v[152:153], 0
buffer_store_dwordx4 v[40:43], v3, s[88:91], s46 offen sc1
v_mov_b64 v[154:155], 0
v_mov_b64 v[156:157], 0
v_mov_b64 v[158:159], 0
v_mov_b64 v[160:161], 0
v_mov_b64 v[162:163], 0
v_mov_b64 v[164:165], 0
v_mov_b64 v[166:167], 0
v_mov_b64 v[168:169], 0
v_mov_b64 v[170:171], 0
v_mov_b64 v[172:173], 0
v_mov_b64 v[174:175], 0
v_mov_b64 v[176:177], 0
v_mov_b64 v[178:179], 0
v_mov_b64 v[180:181], 0
v_mov_b64 v[182:183], 0
v_mov_b64 v[184:185], 0
v_mov_b64 v[186:187], 0
v_mov_b64 v[188:189], 0
v_mov_b64 v[190:191], 0
v_mov_b64 v[192:193], 0
v_mov_b64 v[194:195], 0
v_mov_b64 v[196:197], 0
v_mov_b64 v[198:199], 0
buffer_store_dwordx4 v[44:47], v3, s[88:91], s47 offen sc1
v_mov_b64 v[200:201], 0
v_mov_b64 v[202:203], 0
v_mov_b64 v[204:205], 0
v_mov_b64 v[206:207], 0
v_mov_b64 v[208:209], 0
v_mov_b64 v[210:211], 0
v_mov_b64 v[212:213], 0
v_mov_b64 v[214:215], 0
v_mov_b64 v[216:217], 0
v_mov_b64 v[218:219], 0
v_mov_b64 v[220:221], 0
v_mov_b64 v[222:223], 0
v_mov_b64 v[224:225], 0
v_mov_b64 v[226:227], 0
v_mov_b64 v[228:229], 0
v_mov_b64 v[230:231], 0
v_mov_b64 v[232:233], 0
v_mov_b64 v[234:235], 0
v_mov_b64 v[236:237], 0
v_mov_b64 v[238:239], 0
v_mov_b64 v[240:241], 0
v_mov_b64 v[242:243], 0
v_mov_b64 v[244:245], 0
v_mov_b64 v[246:247], 0
L_att_start:
s_mov_b32 s15, s6
s_cmp_eq_u32 s6, 0
s_cbranch_scc1 L_att_j0
v_mfma_f32_16x16x32_bf16 v[16:19], a[0:3], a[160:163], v[80:83]
v_mfma_f32_16x16x32_bf16 v[16:19], a[4:7], a[164:167], v[16:19]
v_mfma_f32_16x16x32_bf16 v[16:19], a[8:11], a[168:171], v[16:19]
s_add_u32 m0, s27, 0x0
v_mfma_f32_16x16x32_bf16 v[16:19], a[12:15], a[172:175], v[16:19]
buffer_load_dwordx4 v3, s[48:51], s32 offen offset:0 sc1 lds
v_mfma_f32_16x16x32_bf16 v[20:23], a[0:3], a[176:179], v[84:87]
v_mfma_f32_16x16x32_bf16 v[20:23], a[4:7], a[180:183], v[20:23]
v_mfma_f32_16x16x32_bf16 v[20:23], a[8:11], a[184:187], v[20:23]
v_mfma_f32_16x16x32_bf16 v[20:23], a[12:15], a[188:191], v[20:23]
s_nop 2
v_exp_f32 v16, v16
v_mfma_f32_16x16x32_bf16 v[24:27], a[0:3], a[192:195], v[88:91]
s_nop 0
v_exp_f32 v17, v17
v_mfma_f32_16x16x32_bf16 v[24:27], a[4:7], a[196:199], v[24:27]
v_exp_f32 v18, v18
v_mfma_f32_16x16x32_bf16 v[24:27], a[8:11], a[200:203], v[24:27]
buffer_load_dwordx4 v3, s[48:51], s32 offen offset:1024 sc1 lds
v_mfma_f32_16x16x32_bf16 v[24:27], a[12:15], a[204:207], v[24:27]
v_exp_f32 v19, v19
v_mfma_f32_16x16x32_bf16 v[28:31], a[0:3], a[208:211], v[92:95]
v_exp_f32 v20, v20
v_mfma_f32_16x16x32_bf16 v[28:31], a[4:7], a[212:215], v[28:31]
v_cvt_pk_bf16_f32 v48, v16, v17
v_cvt_pk_bf16_f32 v49, v18, v19
v_mfma_f32_16x16x32_bf16 v[28:31], a[8:11], a[216:219], v[28:31]
v_exp_f32 v21, v21
v_mfma_f32_16x16x32_bf16 v[28:31], a[12:15], a[220:223], v[28:31]
v_cvt_pk_bf16_f32 v52, v20, v21
v_mfma_f32_16x16x32_bf16 v[32:35], a[16:19], a[160:163], v[80:83]
v_exp_f32 v22, v22
v_mfma_f32_16x16x32_bf16 v[32:35], a[20:23], a[164:167], v[32:35]
v_mfma_f32_16x16x32_bf16 v[32:35], a[24:27], a[168:171], v[32:35]
buffer_load_dwordx4 v3, s[48:51], s32 offen offset:2048 sc1 lds
v_mfma_f32_16x16x32_bf16 v[32:35], a[28:31], a[172:175], v[32:35]
v_mfma_f32_16x16x32_bf16 v[36:39], a[16:19], a[176:179], v[84:87]
v_exp_f32 v23, v23
v_mfma_f32_16x16x32_bf16 v[36:39], a[20:23], a[180:183], v[36:39]
v_cvt_pk_bf16_f32 v53, v22, v23
v_mfma_f32_16x16x32_bf16 v[36:39], a[24:27], a[184:187], v[36:39]
v_exp_f32 v24, v24
v_mfma_f32_16x16x32_bf16 v[36:39], a[28:31], a[188:191], v[36:39]
v_mfma_f32_16x16x32_bf16 v[40:43], a[16:19], a[192:195], v[88:91]
v_exp_f32 v25, v25
v_mfma_f32_16x16x32_bf16 v[40:43], a[20:23], a[196:199], v[40:43]
buffer_load_dwordx4 v3, s[48:51], s32 offen offset:3072 sc1 lds
v_mfma_f32_16x16x32_bf16 v[40:43], a[24:27], a[200:203], v[40:43]
s_add_u32 s32, s32, 0x8000
v_mfma_f32_16x16x32_bf16 v[40:43], a[28:31], a[204:207], v[40:43]
v_mfma_f32_16x16x32_bf16 v[44:47], a[16:19], a[208:211], v[92:95]
v_exp_f32 v26, v26
v_mfma_f32_16x16x32_bf16 v[44:47], a[20:23], a[212:215], v[44:47]
v_mfma_f32_16x16x32_bf16 v[44:47], a[24:27], a[216:219], v[44:47]
v_exp_f32 v27, v27
v_mfma_f32_16x16x32_bf16 v[44:47], a[28:31], a[220:223], v[44:47]
s_waitcnt lgkmcnt(0)
ds_read_b128 a[0:3], v1 offset:24576
ds_read_b128 a[4:7], v1 offset:25600
ds_read_b128 a[8:11], v1 offset:26624
ds_read_b128 a[12:15], v1 offset:27648
ds_read_b128 a[16:19], v1 offset:28672
ds_read_b128 a[20:23], v1 offset:29696
ds_read_b128 a[24:27], v1 offset:30720
ds_read_b128 a[28:31], v1 offset:31744
s_waitcnt lgkmcnt(7)
v_mfma_f32_16x16x32_bf16 v[16:19], a[0:3], a[160:163], v[80:83]
ds_read_b128 a[32:35], v1 offset:16384
v_cvt_pk_bf16_f32 v56, v24, v25
s_waitcnt lgkmcnt(7)
v_mfma_f32_16x16x32_bf16 v[16:19], a[4:7], a[164:167], v[16:19]
v_exp_f32 v28, v28
s_waitcnt lgkmcnt(6)
v_mfma_f32_16x16x32_bf16 v[16:19], a[8:11], a[168:171], v[16:19]
s_add_u32 m0, s27, 0x1000
v_exp_f32 v29, v29
s_waitcnt lgkmcnt(5)
v_mfma_f32_16x16x32_bf16 v[16:19], a[12:15], a[172:175], v[16:19]
buffer_load_dwordx4 v3, s[48:51], s7 offen offset:0 sc1 lds
v_mfma_f32_16x16x32_bf16 v[20:23], a[0:3], a[176:179], v[84:87]
ds_read_b128 a[36:39], v1 offset:17408
v_cvt_pk_bf16_f32 v57, v26, v27
v_mfma_f32_16x16x32_bf16 v[20:23], a[4:7], a[180:183], v[20:23]
v_exp_f32 v30, v30
v_mfma_f32_16x16x32_bf16 v[20:23], a[8:11], a[184:187], v[20:23]
ds_read_b128 a[40:43], v1 offset:18432
v_cvt_pk_bf16_f32 v60, v28, v29
v_mfma_f32_16x16x32_bf16 v[20:23], a[12:15], a[188:191], v[20:23]
v_exp_f32 v31, v31
v_mfma_f32_16x16x32_bf16 v[24:27], a[0:3], a[192:195], v[88:91]
v_exp_f32 v32, v32
v_mfma_f32_16x16x32_bf16 v[24:27], a[4:7], a[196:199], v[24:27]
ds_read_b128 a[44:47], v1 offset:19456
v_cvt_pk_bf16_f32 v61, v30, v31
v_mfma_f32_16x16x32_bf16 v[24:27], a[8:11], a[200:203], v[24:27]
buffer_load_dwordx4 v3, s[48:51], s7 offen offset:1024 sc1 lds
v_mfma_f32_16x16x32_bf16 v[24:27], a[12:15], a[204:207], v[24:27]
v_exp_f32 v33, v33
v_mfma_f32_16x16x32_bf16 v[28:31], a[0:3], a[208:211], v[92:95]
v_exp_f32 v34, v34
v_mfma_f32_16x16x32_bf16 v[28:31], a[4:7], a[212:215], v[28:31]
ds_read_b128 a[48:51], v1 offset:20480
v_cvt_pk_bf16_f32 v50, v32, v33
v_mfma_f32_16x16x32_bf16 v[28:31], a[8:11], a[216:219], v[28:31]
v_exp_f32 v35, v35
v_mfma_f32_16x16x32_bf16 v[28:31], a[12:15], a[220:223], v[28:31]
v_exp_f32 v36, v36
v_cvt_pk_bf16_f32 v51, v34, v35
s_waitcnt lgkmcnt(8)
v_mfma_f32_16x16x32_bf16 v[32:35], a[16:19], a[160:163], v[80:83]
buffer_load_dwordx4 v3, s[48:51], s7 offen offset:2048 sc1 lds
s_waitcnt lgkmcnt(7)
v_mfma_f32_16x16x32_bf16 v[32:35], a[20:23], a[164:167], v[32:35]
ds_read_b128 a[52:55], v1 offset:21504
v_exp_f32 v37, v37
s_waitcnt lgkmcnt(7)
v_mfma_f32_16x16x32_bf16 v[32:35], a[24:27], a[168:171], v[32:35]
v_exp_f32 v38, v38
s_waitcnt lgkmcnt(6)
v_mfma_f32_16x16x32_bf16 v[32:35], a[28:31], a[172:175], v[32:35]
ds_read_b128 a[56:59], v1 offset:22528
v_cvt_pk_bf16_f32 v54, v36, v37
v_exp_f32 v39, v39
s_nop 0
v_cvt_pk_bf16_f32 v55, v38, v39
v_mfma_f32_16x16x32_bf16 v[36:39], a[16:19], a[176:179], v[84:87]
v_exp_f32 v40, v40
v_mfma_f32_16x16x32_bf16 v[36:39], a[20:23], a[180:183], v[36:39]
v_exp_f32 v41, v41
v_mfma_f32_16x16x32_bf16 v[36:39], a[24:27], a[184:187], v[36:39]
ds_read_b128 a[60:63], v1 offset:23552
v_xor_b32 v1, 0x8000, v1
v_mfma_f32_16x16x32_bf16 v[36:39], a[28:31], a[188:191], v[36:39]
buffer_load_dwordx4 v3, s[48:51], s7 offen offset:3072 sc1 lds
v_exp_f32 v42, v42
v_exp_f32 v43, v43
v_cvt_pk_bf16_f32 v58, v40, v41
v_cvt_pk_bf16_f32 v59, v42, v43
v_mfma_f32_16x16x32_bf16 v[40:43], a[16:19], a[192:195], v[88:91]
s_add_u32 s7, s7, 0x8000
v_exp_f32 v44, v44
v_mfma_f32_16x16x32_bf16 v[40:43], a[20:23], a[196:199], v[40:43]
s_xor_b32 s27, s27, 0x38000
v_exp_f32 v45, v45
v_mfma_f32_16x16x32_bf16 v[40:43], a[24:27], a[200:203], v[40:43]
v_exp_f32 v46, v46
v_mfma_f32_16x16x32_bf16 v[40:43], a[28:31], a[204:207], v[40:43]
v_exp_f32 v47, v47
v_cvt_pk_bf16_f32 v62, v44, v45
v_cvt_pk_bf16_f32 v63, v46, v47
v_mfma_f32_16x16x32_bf16 v[44:47], a[16:19], a[208:211], v[92:95]
v_exp_f32 v16, v16
v_mfma_f32_16x16x32_bf16 v[44:47], a[20:23], a[212:215], v[44:47]
v_exp_f32 v17, v17
v_mfma_f32_16x16x32_bf16 v[44:47], a[24:27], a[216:219], v[44:47]
s_waitcnt vmcnt(16) lgkmcnt(0)
v_exp_f32 v18, v18
v_mfma_f32_16x16x32_bf16 v[44:47], a[28:31], a[220:223], v[44:47]
s_barrier
v_cvt_pk_bf16_f32 v64, v16, v17
v_exp_f32 v19, v19
v_exp_f32 v20, v20
v_exp_f32 v21, v21
v_exp_f32 v22, v22
v_exp_f32 v23, v23
v_exp_f32 v24, v24
v_exp_f32 v25, v25
v_exp_f32 v26, v26
v_exp_f32 v27, v27
v_cvt_pk_bf16_f32 v65, v18, v19
v_cvt_pk_bf16_f32 v68, v20, v21
v_cvt_pk_bf16_f32 v69, v22, v23
s_branch L_att_dodd
L_att_deven:
v_mfma_f32_16x16x32_bf16 v[128:131], a[32:35], v[48:51], v[128:131]
ds_read_b128 a[0:3], v1 offset:8192
v_cvt_pk_bf16_f32 v72, v24, v25
v_mfma_f32_16x16x32_bf16 v[160:163], a[32:35], v[52:55], v[160:163]
v_exp_f32 v28, v28
v_mfma_f32_16x16x32_bf16 v[192:195], a[32:35], v[56:59], v[192:195]
v_cvt_pk_bf16_f32 v73, v26, v27
v_mfma_f32_16x16x32_bf16 v[224:227], a[32:35], v[60:63], v[224:227]
ds_read_b128 a[4:7], v1 offset:9216
v_mfma_f32_16x16x32_bf16 v[228:231], a[36:39], v[60:63], v[228:231]
v_exp_f32 v29, v29
v_mfma_f32_16x16x32_bf16 v[196:199], a[36:39], v[56:59], v[196:199]
v_exp_f32 v30, v30
v_mfma_f32_16x16x32_bf16 v[164:167], a[36:39], v[52:55], v[164:167]
s_add_u32 m0, s27, 0x0
v_cvt_pk_bf16_f32 v76, v28, v29
v_mfma_f32_16x16x32_bf16 v[132:135], a[36:39], v[48:51], v[132:135]
ds_read_b128 a[8:11], v1 offset:10240
v_mfma_f32_16x16x32_bf16 v[136:139], a[40:43], v[48:51], v[136:139]
buffer_load_dwordx4 v3, s[48:51], s32 offen offset:0 sc1 lds
v_mfma_f32_16x16x32_bf16 v[168:171], a[40:43], v[52:55], v[168:171]
v_exp_f32 v31, v31
v_mfma_f32_16x16x32_bf16 v[200:203], a[40:43], v[56:59], v[200:203]
v_exp_f32 v32, v32
v_mfma_f32_16x16x32_bf16 v[232:235], a[40:43], v[60:63], v[232:235]
ds_read_b128 a[12:15], v1 offset:11264
v_cvt_pk_bf16_f32 v77, v30, v31
v_mfma_f32_16x16x32_bf16 v[236:239], a[44:47], v[60:63], v[236:239]
v_mfma_f32_16x16x32_bf16 v[204:207], a[44:47], v[56:59], v[204:207]
v_exp_f32 v33, v33
v_mfma_f32_16x16x32_bf16 v[172:175], a[44:47], v[52:55], v[172:175]
v_exp_f32 v34, v34
v_mfma_f32_16x16x32_bf16 v[140:143], a[44:47], v[48:51], v[140:143]
ds_read_b128 a[16:19], v1 offset:12288
v_cvt_pk_bf16_f32 v66, v32, v33
v_mfma_f32_16x16x32_bf16 v[144:147], a[48:51], v[48:51], v[144:147]
v_mfma_f32_16x16x32_bf16 v[176:179], a[48:51], v[52:55], v[176:179]
v_exp_f32 v35, v35
v_mfma_f32_16x16x32_bf16 v[208:211], a[48:51], v[56:59], v[208:211]
v_exp_f32 v36, v36
v_mfma_f32_16x16x32_bf16 v[240:243], a[48:51], v[60:63], v[240:243]
ds_read_b128 a[20:23], v1 offset:13312
v_cvt_pk_bf16_f32 v67, v34, v35
v_mfma_f32_16x16x32_bf16 v[244:247], a[52:55], v[60:63], v[244:247]
v_mfma_f32_16x16x32_bf16 v[212:215], a[52:55], v[56:59], v[212:215]
v_exp_f32 v37, v37
v_mfma_f32_16x16x32_bf16 v[180:183], a[52:55], v[52:55], v[180:183]
v_exp_f32 v38, v38
v_mfma_f32_16x16x32_bf16 v[148:151], a[52:55], v[48:51], v[148:151]
ds_read_b128 a[24:27], v1 offset:14336
v_cvt_pk_bf16_f32 v70, v36, v37
v_mfma_f32_16x16x32_bf16 v[152:155], a[56:59], v[48:51], v[152:155]
buffer_load_dwordx4 v3, s[48:51], s32 offen offset:1024 sc1 lds
v_mfma_f32_16x16x32_bf16 v[184:187], a[56:59], v[52:55], v[184:187]
v_mfma_f32_16x16x32_bf16 v[216:219], a[56:59], v[56:59], v[216:219]
v_exp_f32 v39, v39
v_mfma_f32_16x16x32_bf16 v[248:251], a[56:59], v[60:63], v[248:251]
ds_read_b128 a[28:31], v1 offset:15360
v_cvt_pk_bf16_f32 v71, v38, v39
v_mfma_f32_16x16x32_bf16 v[252:255], a[60:63], v[60:63], v[252:255]
v_exp_f32 v40, v40
v_mfma_f32_16x16x32_bf16 v[220:223], a[60:63], v[56:59], v[220:223]
v_mfma_f32_16x16x32_bf16 v[188:191], a[60:63], v[52:55], v[188:191]
v_exp_f32 v41, v41
v_mfma_f32_16x16x32_bf16 v[156:159], a[60:63], v[48:51], v[156:159]
ds_read_b128 a[32:35], v1 offset:0
v_cvt_pk_bf16_f32 v74, v40, v41
v_mfma_f32_16x16x32_bf16 a[224:227], a[240:243], v[48:51], a[224:227]
v_exp_f32 v42, v42
v_mfma_f32_16x16x32_bf16 a[228:231], a[240:243], v[52:55], a[228:231]
v_mfma_f32_16x16x32_bf16 a[232:235], a[240:243], v[56:59], a[232:235]
s_waitcnt lgkmcnt(5)
v_exp_f32 v43, v43
v_mfma_f32_16x16x32_bf16 a[236:239], a[240:243], v[60:63], a[236:239]
ds_read_b128 a[36:39], v1 offset:1024
v_cvt_pk_bf16_f32 v75, v42, v43
v_mfma_f32_16x16x32_bf16 v[16:19], a[0:3], a[160:163], v[80:83]
v_exp_f32 v44, v44
v_mfma_f32_16x16x32_bf16 v[16:19], a[4:7], a[164:167], v[16:19]
v_mfma_f32_16x16x32_bf16 v[16:19], a[8:11], a[168:171], v[16:19]
v_exp_f32 v45, v45
v_mfma_f32_16x16x32_bf16 v[16:19], a[12:15], a[172:175], v[16:19]
ds_read_b128 a[40:43], v1 offset:2048
v_cvt_pk_bf16_f32 v78, v44, v45
v_mfma_f32_16x16x32_bf16 v[20:23], a[0:3], a[176:179], v[84:87]
buffer_load_dwordx4 v3, s[48:51], s32 offen offset:2048 sc1 lds
v_mfma_f32_16x16x32_bf16 v[20:23], a[4:7], a[180:183], v[20:23]
v_exp_f32 v46, v46
v_mfma_f32_16x16x32_bf16 v[20:23], a[8:11], a[184:187], v[20:23]
v_mfma_f32_16x16x32_bf16 v[20:23], a[12:15], a[188:191], v[20:23]
ds_read_b128 a[44:47], v1 offset:3072
v_mfma_f32_16x16x32_bf16 v[24:27], a[0:3], a[192:195], v[88:91]
v_exp_f32 v47, v47
v_mfma_f32_16x16x32_bf16 v[24:27], a[4:7], a[196:199], v[24:27]
v_exp_f32 v16, v16
v_mfma_f32_16x16x32_bf16 v[24:27], a[8:11], a[200:203], v[24:27]
v_cvt_pk_bf16_f32 v79, v46, v47
v_mfma_f32_16x16x32_bf16 v[24:27], a[12:15], a[204:207], v[24:27]
ds_read_b128 a[48:51], v1 offset:4096
v_mfma_f32_16x16x32_bf16 v[28:31], a[0:3], a[208:211], v[92:95]
v_exp_f32 v17, v17
v_mfma_f32_16x16x32_bf16 v[28:31], a[4:7], a[212:215], v[28:31]
v_exp_f32 v18, v18
v_mfma_f32_16x16x32_bf16 v[28:31], a[8:11], a[216:219], v[28:31]
s_waitcnt lgkmcnt(5)
v_cvt_pk_bf16_f32 v48, v16, v17
v_mfma_f32_16x16x32_bf16 v[28:31], a[12:15], a[220:223], v[28:31]
ds_read_b128 a[52:55], v1 offset:5120
v_mfma_f32_16x16x32_bf16 v[32:35], a[16:19], a[160:163], v[80:83]
v_exp_f32 v19, v19
v_mfma_f32_16x16x32_bf16 v[32:35], a[20:23], a[164:167], v[32:35]
v_exp_f32 v20, v20
v_mfma_f32_16x16x32_bf16 v[32:35], a[24:27], a[168:171], v[32:35]
v_cvt_pk_bf16_f32 v49, v18, v19
v_mfma_f32_16x16x32_bf16 v[32:35], a[28:31], a[172:175], v[32:35]
ds_read_b128 a[56:59], v1 offset:6144
v_mfma_f32_16x16x32_bf16 v[36:39], a[16:19], a[176:179], v[84:87]
buffer_load_dwordx4 v3, s[48:51], s32 offen offset:3072 sc1 lds
v_mfma_f32_16x16x32_bf16 v[36:39], a[20:23], a[180:183], v[36:39]
s_add_u32 s32, s32, 0x8000
v_exp_f32 v21, v21
v_mfma_f32_16x16x32_bf16 v[36:39], a[24:27], a[184:187], v[36:39]
v_exp_f32 v22, v22
v_mfma_f32_16x16x32_bf16 v[36:39], a[28:31], a[188:191], v[36:39]
ds_read_b128 a[60:63], v1 offset:7168
v_cvt_pk_bf16_f32 v52, v20, v21
v_mfma_f32_16x16x32_bf16 v[40:43], a[16:19], a[192:195], v[88:91]
v_mfma_f32_16x16x32_bf16 v[40:43], a[20:23], a[196:199], v[40:43]
v_exp_f32 v23, v23
v_mfma_f32_16x16x32_bf16 v[40:43], a[24:27], a[200:203], v[40:43]
v_exp_f32 v24, v24
v_mfma_f32_16x16x32_bf16 v[40:43], a[28:31], a[204:207], v[40:43]
v_cvt_pk_bf16_f32 v53, v22, v23
v_mfma_f32_16x16x32_bf16 v[44:47], a[16:19], a[208:211], v[92:95]
v_exp_f32 v25, v25
v_mfma_f32_16x16x32_bf16 v[44:47], a[20:23], a[212:215], v[44:47]
v_exp_f32 v26, v26
v_mfma_f32_16x16x32_bf16 v[44:47], a[24:27], a[216:219], v[44:47]
v_exp_f32 v27, v27
v_mfma_f32_16x16x32_bf16 v[44:47], a[28:31], a[220:223], v[44:47]
s_waitcnt lgkmcnt(0)
v_mfma_f32_16x16x32_bf16 v[128:131], a[32:35], v[64:67], v[128:131]
ds_read_b128 a[0:3], v1 offset:24576
v_cvt_pk_bf16_f32 v56, v24, v25
v_mfma_f32_16x16x32_bf16 v[160:163], a[32:35], v[68:71], v[160:163]
v_exp_f32 v28, v28
v_mfma_f32_16x16x32_bf16 v[192:195], a[32:35], v[72:75], v[192:195]
v_cvt_pk_bf16_f32 v57, v26, v27
v_mfma_f32_16x16x32_bf16 v[224:227], a[32:35], v[76:79], v[224:227]
ds_read_b128 a[4:7], v1 offset:25600
v_mfma_f32_16x16x32_bf16 v[228:231], a[36:39], v[76:79], v[228:231]
v_exp_f32 v29, v29
v_mfma_f32_16x16x32_bf16 v[196:199], a[36:39], v[72:75], v[196:199]
v_exp_f32 v30, v30
v_mfma_f32_16x16x32_bf16 v[164:167], a[36:39], v[68:71], v[164:167]
s_add_u32 m0, s27, 0x1000
v_cvt_pk_bf16_f32 v60, v28, v29
v_mfma_f32_16x16x32_bf16 v[132:135], a[36:39], v[64:67], v[132:135]
buffer_load_dwordx4 v3, s[48:51], s7 offen offset:0 sc1 lds
v_mfma_f32_16x16x32_bf16 v[136:139], a[40:43], v[64:67], v[136:139]
ds_read_b128 a[8:11], v1 offset:26624
v_mfma_f32_16x16x32_bf16 v[168:171], a[40:43], v[68:71], v[168:171]
v_exp_f32 v31, v31
v_mfma_f32_16x16x32_bf16 v[200:203], a[40:43], v[72:75], v[200:203]
v_exp_f32 v32, v32
v_mfma_f32_16x16x32_bf16 v[232:235], a[40:43], v[76:79], v[232:235]
ds_read_b128 a[12:15], v1 offset:27648
v_cvt_pk_bf16_f32 v61, v30, v31
v_mfma_f32_16x16x32_bf16 v[236:239], a[44:47], v[76:79], v[236:239]
v_mfma_f32_16x16x32_bf16 v[204:207], a[44:47], v[72:75], v[204:207]
v_exp_f32 v33, v33
v_mfma_f32_16x16x32_bf16 v[172:175], a[44:47], v[68:71], v[172:175]
v_exp_f32 v34, v34
v_mfma_f32_16x16x32_bf16 v[140:143], a[44:47], v[64:67], v[140:143]
ds_read_b128 a[16:19], v1 offset:28672
v_cvt_pk_bf16_f32 v50, v32, v33
v_mfma_f32_16x16x32_bf16 v[144:147], a[48:51], v[64:67], v[144:147]
v_mfma_f32_16x16x32_bf16 v[176:179], a[48:51], v[68:71], v[176:179]
v_exp_f32 v35, v35
v_mfma_f32_16x16x32_bf16 v[208:211], a[48:51], v[72:75], v[208:211]
v_exp_f32 v36, v36
v_mfma_f32_16x16x32_bf16 v[240:243], a[48:51], v[76:79], v[240:243]
ds_read_b128 a[20:23], v1 offset:29696
v_cvt_pk_bf16_f32 v51, v34, v35
v_mfma_f32_16x16x32_bf16 v[244:247], a[52:55], v[76:79], v[244:247]
v_mfma_f32_16x16x32_bf16 v[212:215], a[52:55], v[72:75], v[212:215]
v_exp_f32 v37, v37
v_mfma_f32_16x16x32_bf16 v[180:183], a[52:55], v[68:71], v[180:183]
v_exp_f32 v38, v38
v_mfma_f32_16x16x32_bf16 v[148:151], a[52:55], v[64:67], v[148:151]
buffer_load_dwordx4 v3, s[48:51], s7 offen offset:1024 sc1 lds
v_mfma_f32_16x16x32_bf16 v[152:155], a[56:59], v[64:67], v[152:155]
ds_read_b128 a[24:27], v1 offset:30720
v_cvt_pk_bf16_f32 v54, v36, v37
v_mfma_f32_16x16x32_bf16 v[184:187], a[56:59], v[68:71], v[184:187]
v_mfma_f32_16x16x32_bf16 v[216:219], a[56:59], v[72:75], v[216:219]
v_exp_f32 v39, v39
v_mfma_f32_16x16x32_bf16 v[248:251], a[56:59], v[76:79], v[248:251]
ds_read_b128 a[28:31], v1 offset:31744
v_cvt_pk_bf16_f32 v55, v38, v39
v_mfma_f32_16x16x32_bf16 v[252:255], a[60:63], v[76:79], v[252:255]
v_exp_f32 v40, v40
v_mfma_f32_16x16x32_bf16 v[220:223], a[60:63], v[72:75], v[220:223]
v_mfma_f32_16x16x32_bf16 v[188:191], a[60:63], v[68:71], v[188:191]
v_exp_f32 v41, v41
v_mfma_f32_16x16x32_bf16 v[156:159], a[60:63], v[64:67], v[156:159]
ds_read_b128 a[32:35], v1 offset:16384
v_cvt_pk_bf16_f32 v58, v40, v41
v_mfma_f32_16x16x32_bf16 a[224:227], a[240:243], v[64:67], a[224:227]
v_exp_f32 v42, v42
v_mfma_f32_16x16x32_bf16 a[228:231], a[240:243], v[68:71], a[228:231]
v_mfma_f32_16x16x32_bf16 a[232:235], a[240:243], v[72:75], a[232:235]
ds_read_b128 a[36:39], v1 offset:17408
v_mfma_f32_16x16x32_bf16 a[236:239], a[240:243], v[76:79], a[236:239]
s_waitcnt lgkmcnt(6)
v_exp_f32 v43, v43
v_mfma_f32_16x16x32_bf16 v[16:19], a[0:3], a[160:163], v[80:83]
v_exp_f32 v44, v44
v_mfma_f32_16x16x32_bf16 v[16:19], a[4:7], a[164:167], v[16:19]
v_cvt_pk_bf16_f32 v59, v42, v43
v_mfma_f32_16x16x32_bf16 v[16:19], a[8:11], a[168:171], v[16:19]
ds_read_b128 a[40:43], v1 offset:18432
v_mfma_f32_16x16x32_bf16 v[16:19], a[12:15], a[172:175], v[16:19]
buffer_load_dwordx4 v3, s[48:51], s7 offen offset:2048 sc1 lds
v_mfma_f32_16x16x32_bf16 v[20:23], a[0:3], a[176:179], v[84:87]
v_exp_f32 v45, v45
v_mfma_f32_16x16x32_bf16 v[20:23], a[4:7], a[180:183], v[20:23]
v_exp_f32 v46, v46
v_mfma_f32_16x16x32_bf16 v[20:23], a[8:11], a[184:187], v[20:23]
ds_read_b128 a[44:47], v1 offset:19456
v_cvt_pk_bf16_f32 v62, v44, v45
v_mfma_f32_16x16x32_bf16 v[20:23], a[12:15], a[188:191], v[20:23]
v_mfma_f32_16x16x32_bf16 v[24:27], a[0:3], a[192:195], v[88:91]
v_exp_f32 v47, v47
v_mfma_f32_16x16x32_bf16 v[24:27], a[4:7], a[196:199], v[24:27]
v_exp_f32 v16, v16
v_mfma_f32_16x16x32_bf16 v[24:27], a[8:11], a[200:203], v[24:27]
ds_read_b128 a[48:51], v1 offset:20480
v_cvt_pk_bf16_f32 v63, v46, v47
v_mfma_f32_16x16x32_bf16 v[24:27], a[12:15], a[204:207], v[24:27]
v_mfma_f32_16x16x32_bf16 v[28:31], a[0:3], a[208:211], v[92:95]
v_exp_f32 v17, v17
v_mfma_f32_16x16x32_bf16 v[28:31], a[4:7], a[212:215], v[28:31]
v_exp_f32 v18, v18
v_mfma_f32_16x16x32_bf16 v[28:31], a[8:11], a[216:219], v[28:31]
ds_read_b128 a[52:55], v1 offset:21504
v_cvt_pk_bf16_f32 v64, v16, v17
v_mfma_f32_16x16x32_bf16 v[28:31], a[12:15], a[220:223], v[28:31]
s_waitcnt lgkmcnt(6)
v_mfma_f32_16x16x32_bf16 v[32:35], a[16:19], a[160:163], v[80:83]
v_exp_f32 v19, v19
v_mfma_f32_16x16x32_bf16 v[32:35], a[20:23], a[164:167], v[32:35]
v_exp_f32 v20, v20
v_mfma_f32_16x16x32_bf16 v[32:35], a[24:27], a[168:171], v[32:35]
ds_read_b128 a[56:59], v1 offset:22528
v_cvt_pk_bf16_f32 v65, v18, v19
v_mfma_f32_16x16x32_bf16 v[32:35], a[28:31], a[172:175], v[32:35]
buffer_load_dwordx4 v3, s[48:51], s7 offen offset:3072 sc1 lds
v_mfma_f32_16x16x32_bf16 v[36:39], a[16:19], a[176:179], v[84:87]
s_add_u32 s7, s7, 0x8000
v_mfma_f32_16x16x32_bf16 v[36:39], a[20:23], a[180:183], v[36:39]
s_xor_b32 s27, s27, 0x38000
v_exp_f32 v21, v21
v_mfma_f32_16x16x32_bf16 v[36:39], a[24:27], a[184:187], v[36:39]
ds_read_b128 a[60:63], v1 offset:23552
v_xor_b32 v1, 0x8000, v1
v_mfma_f32_16x16x32_bf16 v[36:39], a[28:31], a[188:191], v[36:39]
v_exp_f32 v22, v22
v_mfma_f32_16x16x32_bf16 v[40:43], a[16:19], a[192:195], v[88:91]
v_cvt_pk_bf16_f32 v68, v20, v21
v_mfma_f32_16x16x32_bf16 v[40:43], a[20:23], a[196:199], v[40:43]
v_exp_f32 v23, v23
v_mfma_f32_16x16x32_bf16 v[40:43], a[24:27], a[200:203], v[40:43]
v_exp_f32 v24, v24
v_mfma_f32_16x16x32_bf16 v[40:43], a[28:31], a[204:207], v[40:43]
v_cvt_pk_bf16_f32 v69, v22, v23
v_mfma_f32_16x16x32_bf16 v[44:47], a[16:19], a[208:211], v[92:95]
v_exp_f32 v25, v25
v_mfma_f32_16x16x32_bf16 v[44:47], a[20:23], a[212:215], v[44:47]
v_exp_f32 v26, v26
v_mfma_f32_16x16x32_bf16 v[44:47], a[24:27], a[216:219], v[44:47]
s_waitcnt vmcnt(16) lgkmcnt(0)
v_exp_f32 v27, v27
v_mfma_f32_16x16x32_bf16 v[44:47], a[28:31], a[220:223], v[44:47]
s_barrier
L_att_dodd:
v_mfma_f32_16x16x32_bf16 v[128:131], a[32:35], v[48:51], v[128:131]
ds_read_b128 a[0:3], v2 offset:8192
v_cvt_pk_bf16_f32 v72, v24, v25
v_mfma_f32_16x16x32_bf16 v[160:163], a[32:35], v[52:55], v[160:163]
v_exp_f32 v28, v28
v_mfma_f32_16x16x32_bf16 v[192:195], a[32:35], v[56:59], v[192:195]
v_cvt_pk_bf16_f32 v73, v26, v27
v_mfma_f32_16x16x32_bf16 v[224:227], a[32:35], v[60:63], v[224:227]
ds_read_b128 a[4:7], v2 offset:9216
v_mfma_f32_16x16x32_bf16 v[228:231], a[36:39], v[60:63], v[228:231]
v_exp_f32 v29, v29
v_mfma_f32_16x16x32_bf16 v[196:199], a[36:39], v[56:59], v[196:199]
v_exp_f32 v30, v30
v_mfma_f32_16x16x32_bf16 v[164:167], a[36:39], v[52:55], v[164:167]
s_add_u32 m0, s19, 0x0
v_cvt_pk_bf16_f32 v76, v28, v29
v_mfma_f32_16x16x32_bf16 v[132:135], a[36:39], v[48:51], v[132:135]
ds_read_b128 a[8:11], v2 offset:10240
v_mfma_f32_16x16x32_bf16 v[136:139], a[40:43], v[48:51], v[136:139]
buffer_load_dwordx4 v3, s[48:51], s32 offen offset:0 sc1 lds
v_mfma_f32_16x16x32_bf16 v[168:171], a[40:43], v[52:55], v[168:171]
v_exp_f32 v31, v31
v_mfma_f32_16x16x32_bf16 v[200:203], a[40:43], v[56:59], v[200:203]
v_exp_f32 v32, v32
v_mfma_f32_16x16x32_bf16 v[232:235], a[40:43], v[60:63], v[232:235]
ds_read_b128 a[12:15], v2 offset:11264
v_cvt_pk_bf16_f32 v77, v30, v31
v_mfma_f32_16x16x32_bf16 v[236:239], a[44:47], v[60:63], v[236:239]
v_mfma_f32_16x16x32_bf16 v[204:207], a[44:47], v[56:59], v[204:207]
v_exp_f32 v33, v33
v_mfma_f32_16x16x32_bf16 v[172:175], a[44:47], v[52:55], v[172:175]
v_exp_f32 v34, v34
v_mfma_f32_16x16x32_bf16 v[140:143], a[44:47], v[48:51], v[140:143]
ds_read_b128 a[16:19], v2 offset:12288
v_cvt_pk_bf16_f32 v66, v32, v33
v_mfma_f32_16x16x32_bf16 v[144:147], a[48:51], v[48:51], v[144:147]
v_mfma_f32_16x16x32_bf16 v[176:179], a[48:51], v[52:55], v[176:179]
v_exp_f32 v35, v35
v_mfma_f32_16x16x32_bf16 v[208:211], a[48:51], v[56:59], v[208:211]
v_exp_f32 v36, v36
v_mfma_f32_16x16x32_bf16 v[240:243], a[48:51], v[60:63], v[240:243]
ds_read_b128 a[20:23], v2 offset:13312
v_cvt_pk_bf16_f32 v67, v34, v35
v_mfma_f32_16x16x32_bf16 v[244:247], a[52:55], v[60:63], v[244:247]
v_mfma_f32_16x16x32_bf16 v[212:215], a[52:55], v[56:59], v[212:215]
v_exp_f32 v37, v37
v_mfma_f32_16x16x32_bf16 v[180:183], a[52:55], v[52:55], v[180:183]
v_exp_f32 v38, v38
v_mfma_f32_16x16x32_bf16 v[148:151], a[52:55], v[48:51], v[148:151]
ds_read_b128 a[24:27], v2 offset:14336
v_cvt_pk_bf16_f32 v70, v36, v37
v_mfma_f32_16x16x32_bf16 v[152:155], a[56:59], v[48:51], v[152:155]
buffer_load_dwordx4 v3, s[48:51], s32 offen offset:1024 sc1 lds
v_mfma_f32_16x16x32_bf16 v[184:187], a[56:59], v[52:55], v[184:187]
v_mfma_f32_16x16x32_bf16 v[216:219], a[56:59], v[56:59], v[216:219]
v_exp_f32 v39, v39
v_mfma_f32_16x16x32_bf16 v[248:251], a[56:59], v[60:63], v[248:251]
ds_read_b128 a[28:31], v2 offset:15360
v_cvt_pk_bf16_f32 v71, v38, v39
v_mfma_f32_16x16x32_bf16 v[252:255], a[60:63], v[60:63], v[252:255]
v_exp_f32 v40, v40
v_mfma_f32_16x16x32_bf16 v[220:223], a[60:63], v[56:59], v[220:223]
v_mfma_f32_16x16x32_bf16 v[188:191], a[60:63], v[52:55], v[188:191]
v_exp_f32 v41, v41
v_mfma_f32_16x16x32_bf16 v[156:159], a[60:63], v[48:51], v[156:159]
ds_read_b128 a[32:35], v2 offset:0
v_cvt_pk_bf16_f32 v74, v40, v41
v_mfma_f32_16x16x32_bf16 a[224:227], a[240:243], v[48:51], a[224:227]
v_exp_f32 v42, v42
v_mfma_f32_16x16x32_bf16 a[228:231], a[240:243], v[52:55], a[228:231]
v_mfma_f32_16x16x32_bf16 a[232:235], a[240:243], v[56:59], a[232:235]
s_waitcnt lgkmcnt(5)
v_exp_f32 v43, v43
v_mfma_f32_16x16x32_bf16 a[236:239], a[240:243], v[60:63], a[236:239]
ds_read_b128 a[36:39], v2 offset:1024
v_cvt_pk_bf16_f32 v75, v42, v43
v_mfma_f32_16x16x32_bf16 v[16:19], a[0:3], a[160:163], v[80:83]
v_exp_f32 v44, v44
v_mfma_f32_16x16x32_bf16 v[16:19], a[4:7], a[164:167], v[16:19]
v_mfma_f32_16x16x32_bf16 v[16:19], a[8:11], a[168:171], v[16:19]
v_exp_f32 v45, v45
v_mfma_f32_16x16x32_bf16 v[16:19], a[12:15], a[172:175], v[16:19]
ds_read_b128 a[40:43], v2 offset:2048
v_cvt_pk_bf16_f32 v78, v44, v45
v_mfma_f32_16x16x32_bf16 v[20:23], a[0:3], a[176:179], v[84:87]
buffer_load_dwordx4 v3, s[48:51], s32 offen offset:2048 sc1 lds
v_mfma_f32_16x16x32_bf16 v[20:23], a[4:7], a[180:183], v[20:23]
v_exp_f32 v46, v46
v_mfma_f32_16x16x32_bf16 v[20:23], a[8:11], a[184:187], v[20:23]
v_mfma_f32_16x16x32_bf16 v[20:23], a[12:15], a[188:191], v[20:23]
ds_read_b128 a[44:47], v2 offset:3072
v_mfma_f32_16x16x32_bf16 v[24:27], a[0:3], a[192:195], v[88:91]
v_exp_f32 v47, v47
v_mfma_f32_16x16x32_bf16 v[24:27], a[4:7], a[196:199], v[24:27]
v_exp_f32 v16, v16
v_mfma_f32_16x16x32_bf16 v[24:27], a[8:11], a[200:203], v[24:27]
v_cvt_pk_bf16_f32 v79, v46, v47
v_mfma_f32_16x16x32_bf16 v[24:27], a[12:15], a[204:207], v[24:27]
ds_read_b128 a[48:51], v2 offset:4096
v_mfma_f32_16x16x32_bf16 v[28:31], a[0:3], a[208:211], v[92:95]
v_exp_f32 v17, v17
v_mfma_f32_16x16x32_bf16 v[28:31], a[4:7], a[212:215], v[28:31]
v_exp_f32 v18, v18
v_mfma_f32_16x16x32_bf16 v[28:31], a[8:11], a[216:219], v[28:31]
s_waitcnt lgkmcnt(5)
v_cvt_pk_bf16_f32 v48, v16, v17
v_mfma_f32_16x16x32_bf16 v[28:31], a[12:15], a[220:223], v[28:31]
ds_read_b128 a[52:55], v2 offset:5120
v_mfma_f32_16x16x32_bf16 v[32:35], a[16:19], a[160:163], v[80:83]
v_exp_f32 v19, v19
v_mfma_f32_16x16x32_bf16 v[32:35], a[20:23], a[164:167], v[32:35]
v_exp_f32 v20, v20
v_mfma_f32_16x16x32_bf16 v[32:35], a[24:27], a[168:171], v[32:35]
v_cvt_pk_bf16_f32 v49, v18, v19
v_mfma_f32_16x16x32_bf16 v[32:35], a[28:31], a[172:175], v[32:35]
ds_read_b128 a[56:59], v2 offset:6144
v_mfma_f32_16x16x32_bf16 v[36:39], a[16:19], a[176:179], v[84:87]
buffer_load_dwordx4 v3, s[48:51], s32 offen offset:3072 sc1 lds
v_mfma_f32_16x16x32_bf16 v[36:39], a[20:23], a[180:183], v[36:39]
s_add_u32 s32, s32, 0x8000
v_exp_f32 v21, v21
v_mfma_f32_16x16x32_bf16 v[36:39], a[24:27], a[184:187], v[36:39]
v_exp_f32 v22, v22
v_mfma_f32_16x16x32_bf16 v[36:39], a[28:31], a[188:191], v[36:39]
ds_read_b128 a[60:63], v2 offset:7168
v_cvt_pk_bf16_f32 v52, v20, v21
v_mfma_f32_16x16x32_bf16 v[40:43], a[16:19], a[192:195], v[88:91]
v_mfma_f32_16x16x32_bf16 v[40:43], a[20:23], a[196:199], v[40:43]
v_exp_f32 v23, v23
v_mfma_f32_16x16x32_bf16 v[40:43], a[24:27], a[200:203], v[40:43]
v_exp_f32 v24, v24
v_mfma_f32_16x16x32_bf16 v[40:43], a[28:31], a[204:207], v[40:43]
v_cvt_pk_bf16_f32 v53, v22, v23
v_mfma_f32_16x16x32_bf16 v[44:47], a[16:19], a[208:211], v[92:95]
v_exp_f32 v25, v25
v_mfma_f32_16x16x32_bf16 v[44:47], a[20:23], a[212:215], v[44:47]
v_exp_f32 v26, v26
v_mfma_f32_16x16x32_bf16 v[44:47], a[24:27], a[216:219], v[44:47]
v_exp_f32 v27, v27
v_mfma_f32_16x16x32_bf16 v[44:47], a[28:31], a[220:223], v[44:47]
s_waitcnt lgkmcnt(0)
v_mfma_f32_16x16x32_bf16 v[128:131], a[32:35], v[64:67], v[128:131]
ds_read_b128 a[0:3], v2 offset:24576
v_cvt_pk_bf16_f32 v56, v24, v25
v_mfma_f32_16x16x32_bf16 v[160:163], a[32:35], v[68:71], v[160:163]
v_exp_f32 v28, v28
v_mfma_f32_16x16x32_bf16 v[192:195], a[32:35], v[72:75], v[192:195]
v_cvt_pk_bf16_f32 v57, v26, v27
v_mfma_f32_16x16x32_bf16 v[224:227], a[32:35], v[76:79], v[224:227]
ds_read_b128 a[4:7], v2 offset:25600
v_mfma_f32_16x16x32_bf16 v[228:231], a[36:39], v[76:79], v[228:231]
v_exp_f32 v29, v29
v_mfma_f32_16x16x32_bf16 v[196:199], a[36:39], v[72:75], v[196:199]
v_exp_f32 v30, v30
v_mfma_f32_16x16x32_bf16 v[164:167], a[36:39], v[68:71], v[164:167]
s_add_u32 m0, s19, 0x1000
v_cvt_pk_bf16_f32 v60, v28, v29
v_mfma_f32_16x16x32_bf16 v[132:135], a[36:39], v[64:67], v[132:135]
buffer_load_dwordx4 v3, s[48:51], s7 offen offset:0 sc1 lds
v_mfma_f32_16x16x32_bf16 v[136:139], a[40:43], v[64:67], v[136:139]
ds_read_b128 a[8:11], v2 offset:26624
v_mfma_f32_16x16x32_bf16 v[168:171], a[40:43], v[68:71], v[168:171]
v_exp_f32 v31, v31
v_mfma_f32_16x16x32_bf16 v[200:203], a[40:43], v[72:75], v[200:203]
v_exp_f32 v32, v32
v_mfma_f32_16x16x32_bf16 v[232:235], a[40:43], v[76:79], v[232:235]
ds_read_b128 a[12:15], v2 offset:27648
v_cvt_pk_bf16_f32 v61, v30, v31
v_mfma_f32_16x16x32_bf16 v[236:239], a[44:47], v[76:79], v[236:239]
v_mfma_f32_16x16x32_bf16 v[204:207], a[44:47], v[72:75], v[204:207]
v_exp_f32 v33, v33
v_mfma_f32_16x16x32_bf16 v[172:175], a[44:47], v[68:71], v[172:175]
v_exp_f32 v34, v34
v_mfma_f32_16x16x32_bf16 v[140:143], a[44:47], v[64:67], v[140:143]
ds_read_b128 a[16:19], v2 offset:28672
v_cvt_pk_bf16_f32 v50, v32, v33
v_mfma_f32_16x16x32_bf16 v[144:147], a[48:51], v[64:67], v[144:147]
v_mfma_f32_16x16x32_bf16 v[176:179], a[48:51], v[68:71], v[176:179]
v_exp_f32 v35, v35
v_mfma_f32_16x16x32_bf16 v[208:211], a[48:51], v[72:75], v[208:211]
v_exp_f32 v36, v36
v_mfma_f32_16x16x32_bf16 v[240:243], a[48:51], v[76:79], v[240:243]
ds_read_b128 a[20:23], v2 offset:29696
v_cvt_pk_bf16_f32 v51, v34, v35
v_mfma_f32_16x16x32_bf16 v[244:247], a[52:55], v[76:79], v[244:247]
v_mfma_f32_16x16x32_bf16 v[212:215], a[52:55], v[72:75], v[212:215]
v_exp_f32 v37, v37
v_mfma_f32_16x16x32_bf16 v[180:183], a[52:55], v[68:71], v[180:183]
buffer_load_dwordx4 v3, s[48:51], s7 offen offset:1024 sc1 lds
v_mfma_f32_16x16x32_bf16 v[148:151], a[52:55], v[64:67], v[148:151]
ds_read_b128 a[24:27], v2 offset:30720
v_cvt_pk_bf16_f32 v54, v36, v37
v_mfma_f32_16x16x32_bf16 v[152:155], a[56:59], v[64:67], v[152:155]
v_exp_f32 v38, v38
v_mfma_f32_16x16x32_bf16 v[184:187], a[56:59], v[68:71], v[184:187]
v_mfma_f32_16x16x32_bf16 v[216:219], a[56:59], v[72:75], v[216:219]
v_exp_f32 v39, v39
v_mfma_f32_16x16x32_bf16 v[248:251], a[56:59], v[76:79], v[248:251]
ds_read_b128 a[28:31], v2 offset:31744
v_cvt_pk_bf16_f32 v55, v38, v39
v_mfma_f32_16x16x32_bf16 v[252:255], a[60:63], v[76:79], v[252:255]
v_exp_f32 v40, v40
v_mfma_f32_16x16x32_bf16 v[220:223], a[60:63], v[72:75], v[220:223]
v_mfma_f32_16x16x32_bf16 v[188:191], a[60:63], v[68:71], v[188:191]
v_exp_f32 v41, v41
v_mfma_f32_16x16x32_bf16 v[156:159], a[60:63], v[64:67], v[156:159]
ds_read_b128 a[32:35], v2 offset:16384
v_cvt_pk_bf16_f32 v58, v40, v41
v_mfma_f32_16x16x32_bf16 a[224:227], a[240:243], v[64:67], a[224:227]
v_exp_f32 v42, v42
v_mfma_f32_16x16x32_bf16 a[228:231], a[240:243], v[68:71], a[228:231]
v_mfma_f32_16x16x32_bf16 a[232:235], a[240:243], v[72:75], a[232:235]
ds_read_b128 a[36:39], v2 offset:17408
v_mfma_f32_16x16x32_bf16 a[236:239], a[240:243], v[76:79], a[236:239]
s_waitcnt lgkmcnt(6)
v_exp_f32 v43, v43
v_mfma_f32_16x16x32_bf16 v[16:19], a[0:3], a[160:163], v[80:83]
v_exp_f32 v44, v44
v_mfma_f32_16x16x32_bf16 v[16:19], a[4:7], a[164:167], v[16:19]
v_exp_f32 v45, v45
v_mfma_f32_16x16x32_bf16 v[16:19], a[8:11], a[168:171], v[16:19]
buffer_load_dwordx4 v3, s[48:51], s7 offen offset:2048 sc1 lds
v_mfma_f32_16x16x32_bf16 v[16:19], a[12:15], a[172:175], v[16:19]
ds_read_b128 a[40:43], v2 offset:18432
v_cvt_pk_bf16_f32 v59, v42, v43
v_mfma_f32_16x16x32_bf16 v[20:23], a[0:3], a[176:179], v[84:87]
v_cvt_pk_bf16_f32 v62, v44, v45
v_mfma_f32_16x16x32_bf16 v[20:23], a[4:7], a[180:183], v[20:23]
v_exp_f32 v46, v46
v_mfma_f32_16x16x32_bf16 v[20:23], a[8:11], a[184:187], v[20:23]
ds_read_b128 a[44:47], v2 offset:19456
v_mfma_f32_16x16x32_bf16 v[20:23], a[12:15], a[188:191], v[20:23]
v_exp_f32 v47, v47
v_mfma_f32_16x16x32_bf16 v[24:27], a[0:3], a[192:195], v[88:91]
v_cvt_pk_bf16_f32 v63, v46, v47
v_mfma_f32_16x16x32_bf16 v[24:27], a[4:7], a[196:199], v[24:27]
v_exp_f32 v16, v16
v_mfma_f32_16x16x32_bf16 v[24:27], a[8:11], a[200:203], v[24:27]
ds_read_b128 a[48:51], v2 offset:20480
v_mfma_f32_16x16x32_bf16 v[24:27], a[12:15], a[204:207], v[24:27]
v_exp_f32 v17, v17
v_mfma_f32_16x16x32_bf16 v[28:31], a[0:3], a[208:211], v[92:95]
v_cvt_pk_bf16_f32 v64, v16, v17
v_mfma_f32_16x16x32_bf16 v[28:31], a[4:7], a[212:215], v[28:31]
v_exp_f32 v18, v18
v_mfma_f32_16x16x32_bf16 v[28:31], a[8:11], a[216:219], v[28:31]
ds_read_b128 a[52:55], v2 offset:21504
v_mfma_f32_16x16x32_bf16 v[28:31], a[12:15], a[220:223], v[28:31]
s_waitcnt lgkmcnt(6)
v_exp_f32 v19, v19
v_mfma_f32_16x16x32_bf16 v[32:35], a[16:19], a[160:163], v[80:83]
v_cvt_pk_bf16_f32 v65, v18, v19
v_mfma_f32_16x16x32_bf16 v[32:35], a[20:23], a[164:167], v[32:35]
buffer_load_dwordx4 v3, s[48:51], s7 offen offset:3072 sc1 lds
v_mfma_f32_16x16x32_bf16 v[32:35], a[24:27], a[168:171], v[32:35]
ds_read_b128 a[56:59], v2 offset:22528
v_mfma_f32_16x16x32_bf16 v[32:35], a[28:31], a[172:175], v[32:35]
s_add_u32 s7, s7, 0x8000
v_exp_f32 v20, v20
v_mfma_f32_16x16x32_bf16 v[36:39], a[16:19], a[176:179], v[84:87]
s_xor_b32 s19, s19, 0x8000
v_exp_f32 v21, v21
v_mfma_f32_16x16x32_bf16 v[36:39], a[20:23], a[180:183], v[36:39]
s_sub_u32 s15, s15, 1
v_cvt_pk_bf16_f32 v68, v20, v21
v_mfma_f32_16x16x32_bf16 v[36:39], a[24:27], a[184:187], v[36:39]
ds_read_b128 a[60:63], v2 offset:23552
v_xor_b32 v2, 0x38000, v2
v_mfma_f32_16x16x32_bf16 v[36:39], a[28:31], a[188:191], v[36:39]
s_cmp_lg_u32 s15, 0
v_exp_f32 v22, v22
v_mfma_f32_16x16x32_bf16 v[40:43], a[16:19], a[192:195], v[88:91]
v_exp_f32 v23, v23
v_mfma_f32_16x16x32_bf16 v[40:43], a[20:23], a[196:199], v[40:43]
v_cvt_pk_bf16_f32 v69, v22, v23
v_mfma_f32_16x16x32_bf16 v[40:43], a[24:27], a[200:203], v[40:43]
v_exp_f32 v24, v24
v_mfma_f32_16x16x32_bf16 v[40:43], a[28:31], a[204:207], v[40:43]
v_exp_f32 v25, v25
v_mfma_f32_16x16x32_bf16 v[44:47], a[16:19], a[208:211], v[92:95]
v_exp_f32 v26, v26
v_mfma_f32_16x16x32_bf16 v[44:47], a[20:23], a[212:215], v[44:47]
v_exp_f32 v27, v27
v_mfma_f32_16x16x32_bf16 v[44:47], a[24:27], a[216:219], v[44:47]
s_waitcnt vmcnt(16) lgkmcnt(0)
v_mfma_f32_16x16x32_bf16 v[44:47], a[28:31], a[220:223], v[44:47]
s_barrier
s_cbranch_scc1 L_att_deven
s_cmp_ge_u32 s4, 2
s_cbranch_scc1 L_att_dl0_1
L_att_dl0_0:
v_mfma_f32_16x16x32_bf16 v[128:131], a[32:35], v[48:51], v[128:131]
ds_read_b128 a[0:3], v1 offset:8192
v_cvt_pk_bf16_f32 v72, v24, v25
v_mfma_f32_16x16x32_bf16 v[160:163], a[32:35], v[52:55], v[160:163]
v_exp_f32 v28, v28
v_mfma_f32_16x16x32_bf16 v[192:195], a[32:35], v[56:59], v[192:195]
v_cvt_pk_bf16_f32 v73, v26, v27
v_mfma_f32_16x16x32_bf16 v[224:227], a[32:35], v[60:63], v[224:227]
ds_read_b128 a[4:7], v1 offset:9216
v_mfma_f32_16x16x32_bf16 v[228:231], a[36:39], v[60:63], v[228:231]
s_add_u32 m0, s27, 0x0
v_exp_f32 v29, v29
v_mfma_f32_16x16x32_bf16 v[196:199], a[36:39], v[56:59], v[196:199]
buffer_load_dwordx4 v3, s[48:51], s32 offen offset:0 sc1 lds
v_mfma_f32_16x16x32_bf16 v[164:167], a[36:39], v[52:55], v[164:167]
v_exp_f32 v30, v30
v_mfma_f32_16x16x32_bf16 v[132:135], a[36:39], v[48:51], v[132:135]
ds_read_b128 a[8:11], v1 offset:10240
v_cvt_pk_bf16_f32 v76, v28, v29
v_mfma_f32_16x16x32_bf16 v[136:139], a[40:43], v[48:51], v[136:139]
v_mfma_f32_16x16x32_bf16 v[168:171], a[40:43], v[52:55], v[168:171]
v_exp_f32 v31, v31
v_mfma_f32_16x16x32_bf16 v[200:203], a[40:43], v[56:59], v[200:203]
v_exp_f32 v32, v32
v_mfma_f32_16x16x32_bf16 v[232:235], a[40:43], v[60:63], v[232:235]
ds_read_b128 a[12:15], v1 offset:11264
v_cvt_pk_bf16_f32 v77, v30, v31
v_mfma_f32_16x16x32_bf16 v[236:239], a[44:47], v[60:63], v[236:239]
v_mfma_f32_16x16x32_bf16 v[204:207], a[44:47], v[56:59], v[204:207]
v_exp_f32 v33, v33
v_mfma_f32_16x16x32_bf16 v[172:175], a[44:47], v[52:55], v[172:175]
s_mov_b32 s9, 0x0
v_exp_f32 v34, v34
v_mfma_f32_16x16x32_bf16 v[140:143], a[44:47], v[48:51], v[140:143]
ds_read_b128 a[16:19], v1 offset:12288
v_cvt_pk_bf16_f32 v66, v32, v33
v_mfma_f32_16x16x32_bf16 v[144:147], a[48:51], v[48:51], v[144:147]
buffer_load_dword a244, v8, s[72:75], s9 offen
v_mfma_f32_16x16x32_bf16 v[176:179], a[48:51], v[52:55], v[176:179]
v_mfma_f32_16x16x32_bf16 v[208:211], a[48:51], v[56:59], v[208:211]
v_exp_f32 v35, v35
v_mfma_f32_16x16x32_bf16 v[240:243], a[48:51], v[60:63], v[240:243]
ds_read_b128 a[20:23], v1 offset:13312
v_cvt_pk_bf16_f32 v67, v34, v35
v_mfma_f32_16x16x32_bf16 v[244:247], a[52:55], v[60:63], v[244:247]
v_exp_f32 v36, v36
v_mfma_f32_16x16x32_bf16 v[212:215], a[52:55], v[56:59], v[212:215]
v_exp_f32 v37, v37
v_mfma_f32_16x16x32_bf16 v[180:183], a[52:55], v[52:55], v[180:183]
v_cvt_pk_bf16_f32 v70, v36, v37
v_mfma_f32_16x16x32_bf16 v[148:151], a[52:55], v[48:51], v[148:151]
ds_read_b128 a[24:27], v1 offset:14336
v_mfma_f32_16x16x32_bf16 v[152:155], a[56:59], v[48:51], v[152:155]
v_exp_f32 v38, v38
v_mfma_f32_16x16x32_bf16 v[184:187], a[56:59], v[52:55], v[184:187]
v_exp_f32 v39, v39
v_mfma_f32_16x16x32_bf16 v[216:219], a[56:59], v[56:59], v[216:219]
v_cvt_pk_bf16_f32 v71, v38, v39
v_mfma_f32_16x16x32_bf16 v[248:251], a[56:59], v[60:63], v[248:251]
buffer_load_dwordx4 v3, s[48:51], s32 offen offset:1024 sc1 lds
v_mfma_f32_16x16x32_bf16 v[252:255], a[60:63], v[60:63], v[252:255]
ds_read_b128 a[28:31], v1 offset:15360
v_mfma_f32_16x16x32_bf16 v[220:223], a[60:63], v[56:59], v[220:223]
v_exp_f32 v40, v40
v_mfma_f32_16x16x32_bf16 v[188:191], a[60:63], v[52:55], v[188:191]
v_exp_f32 v41, v41
v_mfma_f32_16x16x32_bf16 v[156:159], a[60:63], v[48:51], v[156:159]
ds_read_b128 a[32:35], v1 offset:0
v_cvt_pk_bf16_f32 v74, v40, v41
v_mfma_f32_16x16x32_bf16 a[224:227], a[240:243], v[48:51], a[224:227]
v_mfma_f32_16x16x32_bf16 a[228:231], a[240:243], v[52:55], a[228:231]
v_exp_f32 v42, v42
v_mfma_f32_16x16x32_bf16 a[232:235], a[240:243], v[56:59], a[232:235]
s_waitcnt lgkmcnt(5)
v_exp_f32 v43, v43
v_mfma_f32_16x16x32_bf16 a[236:239], a[240:243], v[60:63], a[236:239]
ds_read_b128 a[36:39], v1 offset:1024
v_cvt_pk_bf16_f32 v75, v42, v43
v_mfma_f32_16x16x32_bf16 v[16:19], a[0:3], a[160:163], v[96:99]
v_exp_f32 v44, v44
v_mfma_f32_16x16x32_bf16 v[16:19], a[4:7], a[164:167], v[16:19]
v_mfma_f32_16x16x32_bf16 v[16:19], a[8:11], a[168:171], v[16:19]
buffer_load_dwordx4 v3, s[48:51], s32 offen offset:2048 sc1 lds
v_mfma_f32_16x16x32_bf16 v[16:19], a[12:15], a[172:175], v[16:19]
ds_read_b128 a[40:43], v1 offset:2048
v_mfma_f32_16x16x32_bf16 v[20:23], a[0:3], a[176:179], v[84:87]
v_exp_f32 v45, v45
v_mfma_f32_16x16x32_bf16 v[20:23], a[4:7], a[180:183], v[20:23]
v_exp_f32 v46, v46
v_mfma_f32_16x16x32_bf16 v[20:23], a[8:11], a[184:187], v[20:23]
v_cvt_pk_bf16_f32 v78, v44, v45
v_mfma_f32_16x16x32_bf16 v[20:23], a[12:15], a[188:191], v[20:23]
ds_read_b128 a[44:47], v1 offset:3072
v_mfma_f32_16x16x32_bf16 v[24:27], a[0:3], a[192:195], v[88:91]
v_exp_f32 v47, v47
v_mfma_f32_16x16x32_bf16 v[24:27], a[4:7], a[196:199], v[24:27]
v_exp_f32 v16, v16
v_mfma_f32_16x16x32_bf16 v[24:27], a[8:11], a[200:203], v[24:27]
v_cvt_pk_bf16_f32 v79, v46, v47
v_mfma_f32_16x16x32_bf16 v[24:27], a[12:15], a[204:207], v[24:27]
ds_read_b128 a[48:51], v1 offset:4096
v_mfma_f32_16x16x32_bf16 v[28:31], a[0:3], a[208:211], v[92:95]
v_exp_f32 v17, v17
v_mfma_f32_16x16x32_bf16 v[28:31], a[4:7], a[212:215], v[28:31]
buffer_load_dwordx4 v3, s[48:51], s32 offen offset:3072 sc1 lds
v_mfma_f32_16x16x32_bf16 v[28:31], a[8:11], a[216:219], v[28:31]
s_waitcnt lgkmcnt(5)
v_exp_f32 v18, v18
v_mfma_f32_16x16x32_bf16 v[28:31], a[12:15], a[220:223], v[28:31]
ds_read_b128 a[52:55], v1 offset:5120
v_cvt_pk_bf16_f32 v48, v16, v17
v_mfma_f32_16x16x32_bf16 v[32:35], a[16:19], a[160:163], v[100:103]
v_mfma_f32_16x16x32_bf16 v[32:35], a[20:23], a[164:167], v[32:35]
v_exp_f32 v19, v19
v_mfma_f32_16x16x32_bf16 v[32:35], a[24:27], a[168:171], v[32:35]
v_exp_f32 v20, v20
v_mfma_f32_16x16x32_bf16 v[32:35], a[28:31], a[172:175], v[32:35]
ds_read_b128 a[56:59], v1 offset:6144
v_cvt_pk_bf16_f32 v49, v18, v19
v_mfma_f32_16x16x32_bf16 v[36:39], a[16:19], a[176:179], v[84:87]
v_exp_f32 v21, v21
v_mfma_f32_16x16x32_bf16 v[36:39], a[20:23], a[180:183], v[36:39]
v_cvt_pk_bf16_f32 v52, v20, v21
v_mfma_f32_16x16x32_bf16 v[36:39], a[24:27], a[184:187], v[36:39]
s_mov_b32 s9, 0x0
v_exp_f32 v22, v22
v_mfma_f32_16x16x32_bf16 v[36:39], a[28:31], a[188:191], v[36:39]
ds_read_b128 a[60:63], v1 offset:7168
v_mfma_f32_16x16x32_bf16 v[40:43], a[16:19], a[192:195], v[88:91]
buffer_load_dword a244, v8, s[64:67], s9 offen
v_mfma_f32_16x16x32_bf16 v[40:43], a[20:23], a[196:199], v[40:43]
v_exp_f32 v23, v23
v_mfma_f32_16x16x32_bf16 v[40:43], a[24:27], a[200:203], v[40:43]
v_cvt_pk_bf16_f32 v53, v22, v23
v_mfma_f32_16x16x32_bf16 v[40:43], a[28:31], a[204:207], v[40:43]
v_exp_f32 v24, v24
v_mfma_f32_16x16x32_bf16 v[44:47], a[16:19], a[208:211], v[92:95]
v_exp_f32 v25, v25
v_mfma_f32_16x16x32_bf16 v[44:47], a[20:23], a[212:215], v[44:47]
v_exp_f32 v26, v26
v_mfma_f32_16x16x32_bf16 v[44:47], a[24:27], a[216:219], v[44:47]
v_exp_f32 v27, v27
v_mfma_f32_16x16x32_bf16 v[44:47], a[28:31], a[220:223], v[44:47]
s_waitcnt lgkmcnt(0)
v_mfma_f32_16x16x32_bf16 v[128:131], a[32:35], v[64:67], v[128:131]
ds_read_b128 a[0:3], v1 offset:24576
v_cvt_pk_bf16_f32 v56, v24, v25
v_mfma_f32_16x16x32_bf16 v[160:163], a[32:35], v[68:71], v[160:163]
v_exp_f32 v28, v28
v_mfma_f32_16x16x32_bf16 v[192:195], a[32:35], v[72:75], v[192:195]
v_cvt_pk_bf16_f32 v57, v26, v27
v_mfma_f32_16x16x32_bf16 v[224:227], a[32:35], v[76:79], v[224:227]
ds_read_b128 a[4:7], v1 offset:25600
v_mfma_f32_16x16x32_bf16 v[228:231], a[36:39], v[76:79], v[228:231]
s_add_u32 m0, s27, 0x1000
v_exp_f32 v29, v29
v_mfma_f32_16x16x32_bf16 v[196:199], a[36:39], v[72:75], v[196:199]
buffer_load_dwordx4 v3, s[48:51], s7 offen offset:0 sc1 lds
v_mfma_f32_16x16x32_bf16 v[164:167], a[36:39], v[68:71], v[164:167]
ds_read_b128 a[8:11], v1 offset:26624
v_cvt_pk_bf16_f32 v60, v28, v29
v_mfma_f32_16x16x32_bf16 v[132:135], a[36:39], v[64:67], v[132:135]
v_exp_f32 v30, v30
v_mfma_f32_16x16x32_bf16 v[136:139], a[40:43], v[64:67], v[136:139]
v_mfma_f32_16x16x32_bf16 v[168:171], a[40:43], v[68:71], v[168:171]
v_exp_f32 v31, v31
v_mfma_f32_16x16x32_bf16 v[200:203], a[40:43], v[72:75], v[200:203]
ds_read_b128 a[12:15], v1 offset:27648
v_cvt_pk_bf16_f32 v61, v30, v31
v_mfma_f32_16x16x32_bf16 v[232:235], a[40:43], v[76:79], v[232:235]
v_exp_f32 v32, v32
v_mfma_f32_16x16x32_bf16 v[236:239], a[44:47], v[76:79], v[236:239]
v_exp_f32 v33, v33
v_mfma_f32_16x16x32_bf16 v[204:207], a[44:47], v[72:75], v[204:207]
ds_read_b128 a[16:19], v1 offset:28672
v_cvt_pk_bf16_f32 v50, v32, v33
v_mfma_f32_16x16x32_bf16 v[172:175], a[44:47], v[68:71], v[172:175]
v_mfma_f32_16x16x32_bf16 v[140:143], a[44:47], v[64:67], v[140:143]
v_exp_f32 v34, v34
v_mfma_f32_16x16x32_bf16 v[144:147], a[48:51], v[64:67], v[144:147]
buffer_load_dwordx4 v3, s[48:51], s7 offen offset:1024 sc1 lds
v_mfma_f32_16x16x32_bf16 v[176:179], a[48:51], v[68:71], v[176:179]
ds_read_b128 a[20:23], v1 offset:29696
v_mfma_f32_16x16x32_bf16 v[208:211], a[48:51], v[72:75], v[208:211]
v_exp_f32 v35, v35
v_mfma_f32_16x16x32_bf16 v[240:243], a[48:51], v[76:79], v[240:243]
v_cvt_pk_bf16_f32 v51, v34, v35
v_mfma_f32_16x16x32_bf16 v[244:247], a[52:55], v[76:79], v[244:247]
ds_read_b128 a[24:27], v1 offset:30720
v_mfma_f32_16x16x32_bf16 v[212:215], a[52:55], v[72:75], v[212:215]
v_exp_f32 v36, v36
v_mfma_f32_16x16x32_bf16 v[180:183], a[52:55], v[68:71], v[180:183]
v_exp_f32 v37, v37
v_mfma_f32_16x16x32_bf16 v[148:151], a[52:55], v[64:67], v[148:151]
ds_read_b128 a[28:31], v1 offset:31744
v_cvt_pk_bf16_f32 v54, v36, v37
v_mfma_f32_16x16x32_bf16 v[152:155], a[56:59], v[64:67], v[152:155]
v_exp_f32 v38, v38
v_mfma_f32_16x16x32_bf16 v[184:187], a[56:59], v[68:71], v[184:187]
v_mfma_f32_16x16x32_bf16 v[216:219], a[56:59], v[72:75], v[216:219]
v_exp_f32 v39, v39
v_mfma_f32_16x16x32_bf16 v[248:251], a[56:59], v[76:79], v[248:251]
buffer_load_dwordx4 v3, s[48:51], s7 offen offset:2048 sc1 lds
v_mfma_f32_16x16x32_bf16 v[252:255], a[60:63], v[76:79], v[252:255]
ds_read_b128 a[32:35], v1 offset:16384
v_cvt_pk_bf16_f32 v55, v38, v39
v_mfma_f32_16x16x32_bf16 v[220:223], a[60:63], v[72:75], v[220:223]
v_exp_f32 v40, v40
v_mfma_f32_16x16x32_bf16 v[188:191], a[60:63], v[68:71], v[188:191]
ds_read_b128 a[36:39], v1 offset:17408
v_mfma_f32_16x16x32_bf16 v[156:159], a[60:63], v[64:67], v[156:159]
v_mfma_f32_16x16x32_bf16 a[224:227], a[240:243], v[64:67], a[224:227]
v_exp_f32 v41, v41
v_mfma_f32_16x16x32_bf16 a[228:231], a[240:243], v[68:71], a[228:231]
ds_read_b128 a[40:43], v1 offset:18432
v_cvt_pk_bf16_f32 v58, v40, v41
v_mfma_f32_16x16x32_bf16 a[232:235], a[240:243], v[72:75], a[232:235]
v_exp_f32 v42, v42
v_mfma_f32_16x16x32_bf16 a[236:239], a[240:243], v[76:79], a[236:239]
s_waitcnt lgkmcnt(7)
v_exp_f32 v43, v43
v_mfma_f32_16x16x32_bf16 v[20:23], a[0:3], a[176:179], v[84:87]
s_mov_b32 s9, 0x400000
v_cvt_pk_bf16_f32 v59, v42, v43
v_mfma_f32_16x16x32_bf16 v[20:23], a[4:7], a[180:183], v[20:23]
buffer_load_dword a244, v8, s[64:67], s9 offen
v_mfma_f32_16x16x32_bf16 v[20:23], a[8:11], a[184:187], v[20:23]
ds_read_b128 a[44:47], v1 offset:19456
v_mfma_f32_16x16x32_bf16 v[20:23], a[12:15], a[188:191], v[20:23]
v_exp_f32 v44, v44
v_mfma_f32_16x16x32_bf16 v[24:27], a[0:3], a[192:195], v[88:91]
ds_read_b128 a[48:51], v1 offset:20480
v_mfma_f32_16x16x32_bf16 v[24:27], a[4:7], a[196:199], v[24:27]
v_exp_f32 v45, v45
v_mfma_f32_16x16x32_bf16 v[24:27], a[8:11], a[200:203], v[24:27]
v_cvt_pk_bf16_f32 v62, v44, v45
v_mfma_f32_16x16x32_bf16 v[24:27], a[12:15], a[204:207], v[24:27]
ds_read_b128 a[52:55], v1 offset:21504
v_mfma_f32_16x16x32_bf16 v[28:31], a[0:3], a[208:211], v[92:95]
v_exp_f32 v46, v46
v_mfma_f32_16x16x32_bf16 v[28:31], a[4:7], a[212:215], v[28:31]
v_exp_f32 v47, v47
v_mfma_f32_16x16x32_bf16 v[28:31], a[8:11], a[216:219], v[28:31]
s_waitcnt lgkmcnt(6)
v_exp_f32 v20, v20
v_mfma_f32_16x16x32_bf16 v[28:31], a[12:15], a[220:223], v[28:31]
ds_read_b128 a[56:59], v1 offset:22528
v_cvt_pk_bf16_f32 v63, v46, v47
v_mfma_f32_16x16x32_bf16 v[36:39], a[16:19], a[176:179], v[84:87]
buffer_load_dwordx4 v3, s[48:51], s7 offen offset:3072 sc1 lds
v_mfma_f32_16x16x32_bf16 v[36:39], a[20:23], a[180:183], v[36:39]
s_add_u32 s32, s32, 0x8000
v_mfma_f32_16x16x32_bf16 v[36:39], a[24:27], a[184:187], v[36:39]
ds_read_b128 a[60:63], v1 offset:23552
v_xor_b32 v1, 0x8000, v1
v_mfma_f32_16x16x32_bf16 v[36:39], a[28:31], a[188:191], v[36:39]
s_add_u32 s7, s7, 0x8000
v_exp_f32 v21, v21
v_mfma_f32_16x16x32_bf16 v[40:43], a[16:19], a[192:195], v[88:91]
s_xor_b32 s27, s27, 0x38000
v_exp_f32 v22, v22
v_mfma_f32_16x16x32_bf16 v[40:43], a[20:23], a[196:199], v[40:43]
v_cvt_pk_bf16_f32 v68, v20, v21
v_mfma_f32_16x16x32_bf16 v[40:43], a[24:27], a[200:203], v[40:43]
v_exp_f32 v23, v23
v_mfma_f32_16x16x32_bf16 v[40:43], a[28:31], a[204:207], v[40:43]
v_exp_f32 v24, v24
v_mfma_f32_16x16x32_bf16 v[44:47], a[16:19], a[208:211], v[92:95]
v_exp_f32 v25, v25
v_mfma_f32_16x16x32_bf16 v[44:47], a[20:23], a[212:215], v[44:47]
v_exp_f32 v26, v26
v_mfma_f32_16x16x32_bf16 v[44:47], a[24:27], a[216:219], v[44:47]
s_waitcnt vmcnt(19) lgkmcnt(0)
v_exp_f32 v27, v27
v_mfma_f32_16x16x32_bf16 v[44:47], a[28:31], a[220:223], v[44:47]
s_barrier
v_cvt_pk_bf16_f32 v69, v22, v23
L_att_l1_0:
v_mfma_f32_16x16x32_bf16 v[128:131], a[32:35], v[48:51], v[128:131]
ds_read_b128 a[0:3], v2 offset:8192
v_cvt_pk_bf16_f32 v72, v24, v25
v_mfma_f32_16x16x32_bf16 v[160:163], a[32:35], v[52:55], v[160:163]
v_exp_f32 v28, v28
v_mfma_f32_16x16x32_bf16 v[192:195], a[32:35], v[56:59], v[192:195]
s_add_u32 m0, s19, 0x0
v_cvt_pk_bf16_f32 v73, v26, v27
v_mfma_f32_16x16x32_bf16 v[224:227], a[32:35], v[60:63], v[224:227]
ds_read_b128 a[4:7], v2 offset:9216
v_mfma_f32_16x16x32_bf16 v[228:231], a[36:39], v[60:63], v[228:231]
buffer_load_dwordx4 v3, s[48:51], s32 offen offset:0 sc1 lds
v_mfma_f32_16x16x32_bf16 v[196:199], a[36:39], v[56:59], v[196:199]
v_exp_f32 v29, v29
v_mfma_f32_16x16x32_bf16 v[164:167], a[36:39], v[52:55], v[164:167]
ds_read_b128 a[8:11], v2 offset:10240
v_cvt_pk_bf16_f32 v76, v28, v29
v_mfma_f32_16x16x32_bf16 v[132:135], a[36:39], v[48:51], v[132:135]
v_mfma_f32_16x16x32_bf16 v[136:139], a[40:43], v[48:51], v[136:139]
v_exp_f32 v30, v30
v_mfma_f32_16x16x32_bf16 v[168:171], a[40:43], v[52:55], v[168:171]
v_exp_f32 v31, v31
v_mfma_f32_16x16x32_bf16 v[200:203], a[40:43], v[56:59], v[200:203]
ds_read_b128 a[12:15], v2 offset:11264
v_cvt_pk_bf16_f32 v77, v30, v31
v_mfma_f32_16x16x32_bf16 v[232:235], a[40:43], v[60:63], v[232:235]
v_mfma_f32_16x16x32_bf16 v[236:239], a[44:47], v[60:63], v[236:239]
s_mov_b32 s9, 0x200000
v_exp_f32 v36, v36
v_mfma_f32_16x16x32_bf16 v[204:207], a[44:47], v[56:59], v[204:207]
ds_read_b128 a[16:19], v2 offset:12288
v_mfma_f32_16x16x32_bf16 v[172:175], a[44:47], v[52:55], v[172:175]
buffer_load_dword a244, v8, s[64:67], s9 offen
v_mfma_f32_16x16x32_bf16 v[140:143], a[44:47], v[48:51], v[140:143]
v_exp_f32 v37, v37
v_mfma_f32_16x16x32_bf16 v[144:147], a[48:51], v[48:51], v[144:147]
v_cvt_pk_bf16_f32 v70, v36, v37
v_mfma_f32_16x16x32_bf16 v[176:179], a[48:51], v[52:55], v[176:179]
ds_read_b128 a[20:23], v2 offset:13312
v_mfma_f32_16x16x32_bf16 v[208:211], a[48:51], v[56:59], v[208:211]
v_exp_f32 v38, v38
v_mfma_f32_16x16x32_bf16 v[240:243], a[48:51], v[60:63], v[240:243]
v_mfma_f32_16x16x32_bf16 v[244:247], a[52:55], v[60:63], v[244:247]
ds_read_b128 a[24:27], v2 offset:14336
v_mfma_f32_16x16x32_bf16 v[212:215], a[52:55], v[56:59], v[212:215]
v_exp_f32 v39, v39
v_mfma_f32_16x16x32_bf16 v[180:183], a[52:55], v[52:55], v[180:183]
v_exp_f32 v40, v40
v_mfma_f32_16x16x32_bf16 v[148:151], a[52:55], v[48:51], v[148:151]
v_cvt_pk_bf16_f32 v71, v38, v39
v_mfma_f32_16x16x32_bf16 v[152:155], a[56:59], v[48:51], v[152:155]
buffer_load_dwordx4 v3, s[48:51], s32 offen offset:1024 sc1 lds
v_mfma_f32_16x16x32_bf16 v[184:187], a[56:59], v[52:55], v[184:187]
ds_read_b128 a[28:31], v2 offset:15360
v_mfma_f32_16x16x32_bf16 v[216:219], a[56:59], v[56:59], v[216:219]
v_exp_f32 v41, v41
v_mfma_f32_16x16x32_bf16 v[248:251], a[56:59], v[60:63], v[248:251]
ds_read_b128 a[32:35], v2 offset:0
v_cvt_pk_bf16_f32 v74, v40, v41
v_mfma_f32_16x16x32_bf16 v[252:255], a[60:63], v[60:63], v[252:255]
v_exp_f32 v42, v42
v_mfma_f32_16x16x32_bf16 v[220:223], a[60:63], v[56:59], v[220:223]
v_mfma_f32_16x16x32_bf16 v[188:191], a[60:63], v[52:55], v[188:191]
ds_read_b128 a[36:39], v2 offset:1024
v_mfma_f32_16x16x32_bf16 v[156:159], a[60:63], v[48:51], v[156:159]
v_exp_f32 v43, v43
v_mfma_f32_16x16x32_bf16 a[224:227], a[240:243], v[48:51], a[224:227]
v_exp_f32 v44, v44
v_mfma_f32_16x16x32_bf16 a[228:231], a[240:243], v[52:55], a[228:231]
buffer_load_dwordx4 v3, s[48:51], s32 offen offset:2048 sc1 lds
v_mfma_f32_16x16x32_bf16 a[232:235], a[240:243], v[56:59], a[232:235]
ds_read_b128 a[40:43], v2 offset:2048
v_cvt_pk_bf16_f32 v75, v42, v43
v_mfma_f32_16x16x32_bf16 a[236:239], a[240:243], v[60:63], a[236:239]
s_waitcnt lgkmcnt(7)
v_mfma_f32_16x16x32_bf16 v[20:23], a[0:3], a[176:179], v[84:87]
v_exp_f32 v45, v45
v_mfma_f32_16x16x32_bf16 v[20:23], a[4:7], a[180:183], v[20:23]
ds_read_b128 a[44:47], v2 offset:3072
v_cvt_pk_bf16_f32 v78, v44, v45
v_mfma_f32_16x16x32_bf16 v[20:23], a[8:11], a[184:187], v[20:23]
v_mfma_f32_16x16x32_bf16 v[20:23], a[12:15], a[188:191], v[20:23]
v_exp_f32 v46, v46
v_mfma_f32_16x16x32_bf16 v[24:27], a[0:3], a[192:195], v[88:91]
v_exp_f32 v47, v47
v_mfma_f32_16x16x32_bf16 v[24:27], a[4:7], a[196:199], v[24:27]
ds_read_b128 a[48:51], v2 offset:4096
v_cvt_pk_bf16_f32 v79, v46, v47
v_mfma_f32_16x16x32_bf16 v[24:27], a[8:11], a[200:203], v[24:27]
v_mfma_f32_16x16x32_bf16 v[24:27], a[12:15], a[204:207], v[24:27]
buffer_load_dwordx4 v3, s[48:51], s32 offen offset:3072 sc1 lds
v_mfma_f32_16x16x32_bf16 v[28:31], a[0:3], a[208:211], v[92:95]
ds_read_b128 a[52:55], v2 offset:5120
v_mfma_f32_16x16x32_bf16 v[28:31], a[4:7], a[212:215], v[28:31]
v_exp_f32 v20, v20
v_mfma_f32_16x16x32_bf16 v[28:31], a[8:11], a[216:219], v[28:31]
v_exp_f32 v21, v21
v_mfma_f32_16x16x32_bf16 v[28:31], a[12:15], a[220:223], v[28:31]
s_waitcnt lgkmcnt(6)
v_cvt_pk_bf16_f32 v52, v20, v21
v_mfma_f32_16x16x32_bf16 v[36:39], a[16:19], a[176:179], v[84:87]
ds_read_b128 a[56:59], v2 offset:6144
v_mfma_f32_16x16x32_bf16 v[36:39], a[20:23], a[180:183], v[36:39]
v_exp_f32 v22, v22
v_mfma_f32_16x16x32_bf16 v[36:39], a[24:27], a[184:187], v[36:39]
v_mfma_f32_16x16x32_bf16 v[36:39], a[28:31], a[188:191], v[36:39]
ds_read_b128 a[60:63], v2 offset:7168
v_mfma_f32_16x16x32_bf16 v[40:43], a[16:19], a[192:195], v[88:91]
s_mov_b32 s9, 0x600000
v_exp_f32 v23, v23
v_mfma_f32_16x16x32_bf16 v[40:43], a[20:23], a[196:199], v[40:43]
buffer_load_dword a244, v8, s[64:67], s9 offen
v_mfma_f32_16x16x32_bf16 v[40:43], a[24:27], a[200:203], v[40:43]
v_exp_f32 v24, v24
v_mfma_f32_16x16x32_bf16 v[40:43], a[28:31], a[204:207], v[40:43]
v_cvt_pk_bf16_f32 v53, v22, v23
v_mfma_f32_16x16x32_bf16 v[44:47], a[16:19], a[208:211], v[92:95]
v_exp_f32 v25, v25
v_mfma_f32_16x16x32_bf16 v[44:47], a[20:23], a[212:215], v[44:47]
v_exp_f32 v26, v26
v_mfma_f32_16x16x32_bf16 v[44:47], a[24:27], a[216:219], v[44:47]
v_exp_f32 v27, v27
v_mfma_f32_16x16x32_bf16 v[44:47], a[28:31], a[220:223], v[44:47]
s_waitcnt lgkmcnt(0)
v_mfma_f32_16x16x32_bf16 v[160:163], a[32:35], v[68:71], v[160:163]
ds_read_b128 a[0:3], v2 offset:24576
v_cvt_pk_bf16_f32 v56, v24, v25
v_mfma_f32_16x16x32_bf16 v[192:195], a[32:35], v[72:75], v[192:195]
v_exp_f32 v28, v28
v_mfma_f32_16x16x32_bf16 v[224:227], a[32:35], v[76:79], v[224:227]
ds_read_b128 a[4:7], v2 offset:25600
v_cvt_pk_bf16_f32 v57, v26, v27
v_mfma_f32_16x16x32_bf16 v[228:231], a[36:39], v[76:79], v[228:231]
s_add_u32 m0, s19, 0x1000
v_mfma_f32_16x16x32_bf16 v[196:199], a[36:39], v[72:75], v[196:199]
buffer_load_dwordx4 v3, s[48:51], s7 offen offset:0 sc1 lds
v_mfma_f32_16x16x32_bf16 v[164:167], a[36:39], v[68:71], v[164:167]
ds_read_b128 a[8:11], v2 offset:26624
v_mfma_f32_16x16x32_bf16 v[168:171], a[40:43], v[68:71], v[168:171]
v_exp_f32 v29, v29
v_mfma_f32_16x16x32_bf16 v[200:203], a[40:43], v[72:75], v[200:203]
v_exp_f32 v30, v30
v_mfma_f32_16x16x32_bf16 v[232:235], a[40:43], v[76:79], v[232:235]
ds_read_b128 a[12:15], v2 offset:27648
v_cvt_pk_bf16_f32 v60, v28, v29
v_mfma_f32_16x16x32_bf16 v[236:239], a[44:47], v[76:79], v[236:239]
v_exp_f32 v31, v31
v_mfma_f32_16x16x32_bf16 v[204:207], a[44:47], v[72:75], v[204:207]
v_exp_f32 v36, v36
v_mfma_f32_16x16x32_bf16 v[172:175], a[44:47], v[68:71], v[172:175]
ds_read_b128 a[16:19], v2 offset:28672
v_cvt_pk_bf16_f32 v61, v30, v31
v_mfma_f32_16x16x32_bf16 v[176:179], a[48:51], v[68:71], v[176:179]
buffer_load_dwordx4 v3, s[48:51], s7 offen offset:1024 sc1 lds
v_mfma_f32_16x16x32_bf16 v[208:211], a[48:51], v[72:75], v[208:211]
v_mfma_f32_16x16x32_bf16 v[240:243], a[48:51], v[76:79], v[240:243]
ds_read_b128 a[20:23], v2 offset:29696
v_mfma_f32_16x16x32_bf16 v[244:247], a[52:55], v[76:79], v[244:247]
v_exp_f32 v37, v37
v_mfma_f32_16x16x32_bf16 v[212:215], a[52:55], v[72:75], v[212:215]
ds_read_b128 a[24:27], v2 offset:30720
v_cvt_pk_bf16_f32 v54, v36, v37
v_mfma_f32_16x16x32_bf16 v[180:183], a[52:55], v[68:71], v[180:183]
v_exp_f32 v38, v38
v_mfma_f32_16x16x32_bf16 v[184:187], a[56:59], v[68:71], v[184:187]
v_exp_f32 v39, v39
v_mfma_f32_16x16x32_bf16 v[216:219], a[56:59], v[72:75], v[216:219]
ds_read_b128 a[28:31], v2 offset:31744
v_cvt_pk_bf16_f32 v55, v38, v39
v_mfma_f32_16x16x32_bf16 v[248:251], a[56:59], v[76:79], v[248:251]
v_exp_f32 v40, v40
v_mfma_f32_16x16x32_bf16 v[252:255], a[60:63], v[76:79], v[252:255]
buffer_load_dwordx4 v3, s[48:51], s7 offen offset:2048 sc1 lds
v_mfma_f32_16x16x32_bf16 v[220:223], a[60:63], v[72:75], v[220:223]
ds_read_b128 a[32:35], v2 offset:16384
v_mfma_f32_16x16x32_bf16 v[188:191], a[60:63], v[68:71], v[188:191]
v_exp_f32 v41, v41
v_mfma_f32_16x16x32_bf16 a[228:231], a[240:243], v[68:71], a[228:231]
v_cvt_pk_bf16_f32 v58, v40, v41
v_mfma_f32_16x16x32_bf16 a[232:235], a[240:243], v[72:75], a[232:235]
ds_read_b128 a[36:39], v2 offset:17408
v_mfma_f32_16x16x32_bf16 a[236:239], a[240:243], v[76:79], a[236:239]
s_waitcnt lgkmcnt(6)
v_exp_f32 v42, v42
v_mfma_f32_16x16x32_bf16 v[20:23], a[0:3], a[176:179], v[104:107]
v_exp_f32 v43, v43
v_mfma_f32_16x16x32_bf16 v[20:23], a[4:7], a[180:183], v[20:23]
ds_read_b128 a[40:43], v2 offset:18432
v_cvt_pk_bf16_f32 v59, v42, v43
v_mfma_f32_16x16x32_bf16 v[20:23], a[8:11], a[184:187], v[20:23]
v_exp_f32 v44, v44
v_mfma_f32_16x16x32_bf16 v[20:23], a[12:15], a[188:191], v[20:23]
buffer_load_dwordx4 v3, s[48:51], s7 offen offset:3072 sc1 lds
v_mfma_f32_16x16x32_bf16 v[24:27], a[0:3], a[192:195], v[88:91]
ds_read_b128 a[44:47], v2 offset:19456
v_mfma_f32_16x16x32_bf16 v[24:27], a[4:7], a[196:199], v[24:27]
v_exp_f32 v45, v45
v_mfma_f32_16x16x32_bf16 v[24:27], a[8:11], a[200:203], v[24:27]
ds_read_b128 a[48:51], v2 offset:20480
v_add_u32 v4, s0, v3
v_mfma_f32_16x16x32_bf16 v[24:27], a[12:15], a[204:207], v[24:27]
v_exp_f32 v46, v46
v_mfma_f32_16x16x32_bf16 v[28:31], a[0:3], a[208:211], v[92:95]
v_cvt_pk_bf16_f32 v62, v44, v45
v_mfma_f32_16x16x32_bf16 v[28:31], a[4:7], a[212:215], v[28:31]
ds_read_b128 a[52:55], v2 offset:21504
v_mov_b32 v5, s1
v_mfma_f32_16x16x32_bf16 v[28:31], a[8:11], a[216:219], v[28:31]
s_waitcnt lgkmcnt(6)
v_exp_f32 v47, v47
v_mfma_f32_16x16x32_bf16 v[28:31], a[12:15], a[220:223], v[28:31]
global_load_dword a244, v[4:5], off sc1
v_mfma_f32_16x16x32_bf16 v[36:39], a[16:19], a[176:179], v[108:111]
ds_read_b128 a[56:59], v2 offset:22528
v_cvt_pk_bf16_f32 v63, v46, v47
v_mfma_f32_16x16x32_bf16 v[36:39], a[20:23], a[180:183], v[36:39]
s_add_u32 s32, s32, 0x8000
v_exp_f32 v20, v20
v_mfma_f32_16x16x32_bf16 v[36:39], a[24:27], a[184:187], v[36:39]
s_add_u32 s7, s7, 0x8000
v_exp_f32 v21, v21
v_mfma_f32_16x16x32_bf16 v[36:39], a[28:31], a[188:191], v[36:39]
ds_read_b128 a[60:63], v2 offset:23552
v_xor_b32 v2, 0x38000, v2
v_mfma_f32_16x16x32_bf16 v[40:43], a[16:19], a[192:195], v[88:91]
s_xor_b32 s19, s19, 0x8000
v_exp_f32 v22, v22
v_mfma_f32_16x16x32_bf16 v[40:43], a[20:23], a[196:199], v[40:43]
s_sub_u32 s15, 7, s6
v_exp_f32 v23, v23
v_mfma_f32_16x16x32_bf16 v[40:43], a[24:27], a[200:203], v[40:43]
s_lshl_b32 s15, s15, 1
v_exp_f32 v24, v24
v_mfma_f32_16x16x32_bf16 v[40:43], a[28:31], a[204:207], v[40:43]
v_exp_f32 v25, v25
v_mfma_f32_16x16x32_bf16 v[44:47], a[16:19], a[208:211], v[92:95]
v_exp_f32 v26, v26
v_mfma_f32_16x16x32_bf16 v[44:47], a[20:23], a[212:215], v[44:47]
v_exp_f32 v27, v27
v_mfma_f32_16x16x32_bf16 v[44:47], a[24:27], a[216:219], v[44:47]
s_waitcnt vmcnt(22) lgkmcnt(0)
v_cvt_pk_bf16_f32 v68, v20, v21
v_cvt_pk_bf16_f32 v69, v22, v23
v_mfma_f32_16x16x32_bf16 v[44:47], a[28:31], a[220:223], v[44:47]
s_barrier
s_cbranch_scc0 L_att_lh0_0
s_cmp_lg_u32 s33, 0
s_cbranch_scc1 L_sig_bs0
s_lshl_b32 s8, s6, 2
s_add_u32 s8, s8, 192
s_cmp_lg_u32 s4, 0
s_cbranch_scc1 L_sig_bs0
v_mov_b32 v4, 1
s_mov_b64 exec, 1
buffer_atomic_add v4, off, s[84:87], s8 sc1
s_mov_b64 exec, -1
L_sig_bs0:
v_mfma_f32_16x16x32_bf16 v[160:163], a[32:35], v[52:55], v[160:163]
ds_read_b128 a[0:3], v1 offset:8192
v_cvt_pk_bf16_f32 v72, v24, v25
v_mfma_f32_16x16x32_bf16 v[192:195], a[32:35], v[56:59], v[192:195]
v_exp_f32 v28, v28
v_mfma_f32_16x16x32_bf16 v[224:227], a[32:35], v[60:63], v[224:227]
ds_read_b128 a[4:7], v1 offset:9216
v_cvt_pk_bf16_f32 v73, v26, v27
v_mfma_f32_16x16x32_bf16 v[228:231], a[36:39], v[60:63], v[228:231]
s_add_u32 m0, s27, 0x0
v_exp_f32 v29, v29
v_mfma_f32_16x16x32_bf16 v[196:199], a[36:39], v[56:59], v[196:199]
ds_read_b128 a[8:11], v1 offset:10240
v_cvt_pk_bf16_f32 v76, v28, v29
v_mfma_f32_16x16x32_bf16 v[164:167], a[36:39], v[52:55], v[164:167]
buffer_load_dwordx4 v3, s[48:51], s32 offen offset:0 sc1 lds
v_mfma_f32_16x16x32_bf16 v[168:171], a[40:43], v[52:55], v[168:171]
v_exp_f32 v30, v30
v_mfma_f32_16x16x32_bf16 v[200:203], a[40:43], v[56:59], v[200:203]
ds_read_b128 a[12:15], v1 offset:11264
v_mfma_f32_16x16x32_bf16 v[232:235], a[40:43], v[60:63], v[232:235]
v_exp_f32 v31, v31
v_mfma_f32_16x16x32_bf16 v[236:239], a[44:47], v[60:63], v[236:239]
ds_read_b128 a[16:19], v1 offset:12288
v_cvt_pk_bf16_f32 v77, v30, v31
v_mfma_f32_16x16x32_bf16 v[204:207], a[44:47], v[56:59], v[204:207]
v_exp_f32 v36, v36
v_mfma_f32_16x16x32_bf16 v[172:175], a[44:47], v[52:55], v[172:175]
ds_read_b128 a[20:23], v1 offset:13312
v_mfma_f32_16x16x32_bf16 v[176:179], a[48:51], v[52:55], v[176:179]
v_exp_f32 v37, v37
v_mfma_f32_16x16x32_bf16 v[208:211], a[48:51], v[56:59], v[208:211]
v_exp_f32 v38, v38
v_mfma_f32_16x16x32_bf16 v[240:243], a[48:51], v[60:63], v[240:243]
ds_read_b128 a[24:27], v1 offset:14336
v_cvt_pk_bf16_f32 v70, v36, v37
v_mfma_f32_16x16x32_bf16 v[244:247], a[52:55], v[60:63], v[244:247]
buffer_load_dwordx4 v3, s[48:51], s32 offen offset:1024 sc1 lds
v_mfma_f32_16x16x32_bf16 v[212:215], a[52:55], v[56:59], v[212:215]
ds_read_b128 a[28:31], v1 offset:15360
v_mfma_f32_16x16x32_bf16 v[180:183], a[52:55], v[52:55], v[180:183]
v_exp_f32 v39, v39
v_mfma_f32_16x16x32_bf16 v[184:187], a[56:59], v[52:55], v[184:187]
v_exp_f32 v40, v40
v_mfma_f32_16x16x32_bf16 v[216:219], a[56:59], v[56:59], v[216:219]
ds_read_b128 a[32:35], v1 offset:0
v_cvt_pk_bf16_f32 v71, v38, v39
v_mfma_f32_16x16x32_bf16 v[248:251], a[56:59], v[60:63], v[248:251]
v_exp_f32 v41, v41
v_mfma_f32_16x16x32_bf16 v[252:255], a[60:63], v[60:63], v[252:255]
ds_read_b128 a[36:39], v1 offset:1024
v_cvt_pk_bf16_f32 v74, v40, v41
v_mfma_f32_16x16x32_bf16 v[220:223], a[60:63], v[56:59], v[220:223]
v_exp_f32 v42, v42
v_mfma_f32_16x16x32_bf16 v[188:191], a[60:63], v[52:55], v[188:191]
ds_read_b128 a[40:43], v1 offset:2048
v_mfma_f32_16x16x32_bf16 a[228:231], a[240:243], v[52:55], a[228:231]
s_waitcnt lgkmcnt(7)
v_exp_f32 v43, v43
v_mfma_f32_16x16x32_bf16 a[232:235], a[240:243], v[56:59], a[232:235]
buffer_load_dwordx4 v3, s[48:51], s32 offen offset:2048 sc1 lds
v_mfma_f32_16x16x32_bf16 a[236:239], a[240:243], v[60:63], a[236:239]
ds_read_b128 a[44:47], v1 offset:3072
v_cvt_pk_bf16_f32 v75, v42, v43
v_mfma_f32_16x16x32_bf16 v[24:27], a[0:3], a[192:195], v[88:91]
v_exp_f32 v44, v44
v_mfma_f32_16x16x32_bf16 v[24:27], a[4:7], a[196:199], v[24:27]
ds_read_b128 a[48:51], v1 offset:4096
v_mfma_f32_16x16x32_bf16 v[24:27], a[8:11], a[200:203], v[24:27]
v_exp_f32 v45, v45
v_mfma_f32_16x16x32_bf16 v[24:27], a[12:15], a[204:207], v[24:27]
ds_read_b128 a[52:55], v1 offset:5120
v_cvt_pk_bf16_f32 v78, v44, v45
v_mfma_f32_16x16x32_bf16 v[28:31], a[0:3], a[208:211], v[92:95]
v_exp_f32 v46, v46
v_mfma_f32_16x16x32_bf16 v[28:31], a[4:7], a[212:215], v[28:31]
v_exp_f32 v47, v47
v_mfma_f32_16x16x32_bf16 v[28:31], a[8:11], a[216:219], v[28:31]
ds_read_b128 a[56:59], v1 offset:6144
v_cvt_pk_bf16_f32 v79, v46, v47
v_mfma_f32_16x16x32_bf16 v[28:31], a[12:15], a[220:223], v[28:31]
s_waitcnt lgkmcnt(7)
v_exp_f32 v24, v24
v_mfma_f32_16x16x32_bf16 v[40:43], a[16:19], a[192:195], v[88:91]
buffer_load_dwordx4 v3, s[48:51], s32 offen offset:3072 sc1 lds
v_mfma_f32_16x16x32_bf16 v[40:43], a[20:23], a[196:199], v[40:43]
ds_read_b128 a[60:63], v1 offset:7168
v_mfma_f32_16x16x32_bf16 v[40:43], a[24:27], a[200:203], v[40:43]
s_add_u32 s32, s32, 0x8000
v_exp_f32 v25, v25
v_mfma_f32_16x16x32_bf16 v[40:43], a[28:31], a[204:207], v[40:43]
v_exp_f32 v26, v26
v_mfma_f32_16x16x32_bf16 v[44:47], a[16:19], a[208:211], v[92:95]
v_exp_f32 v27, v27
v_mfma_f32_16x16x32_bf16 v[44:47], a[20:23], a[212:215], v[44:47]
v_exp_f32 v28, v28
v_mfma_f32_16x16x32_bf16 v[44:47], a[24:27], a[216:219], v[44:47]
v_exp_f32 v29, v29
v_mfma_f32_16x16x32_bf16 v[44:47], a[28:31], a[220:223], v[44:47]
s_waitcnt lgkmcnt(0)
v_mfma_f32_16x16x32_bf16 v[160:163], a[32:35], v[68:71], v[160:163]
ds_read_b128 a[0:3], v1 offset:24576
v_cvt_pk_bf16_f32 v56, v24, v25
v_mfma_f32_16x16x32_bf16 v[192:195], a[32:35], v[72:75], v[192:195]
v_exp_f32 v30, v30
v_mfma_f32_16x16x32_bf16 v[224:227], a[32:35], v[76:79], v[224:227]
ds_read_b128 a[4:7], v1 offset:25600
v_cvt_pk_bf16_f32 v57, v26, v27
v_mfma_f32_16x16x32_bf16 v[228:231], a[36:39], v[76:79], v[228:231]
s_add_u32 m0, s27, 0x1000
v_cvt_pk_bf16_f32 v60, v28, v29
v_mfma_f32_16x16x32_bf16 v[196:199], a[36:39], v[72:75], v[196:199]
buffer_load_dwordx4 v3, s[48:51], s7 offen offset:0 sc1 lds
v_mfma_f32_16x16x32_bf16 v[164:167], a[36:39], v[68:71], v[164:167]
ds_read_b128 a[8:11], v1 offset:26624
v_mfma_f32_16x16x32_bf16 v[168:171], a[40:43], v[68:71], v[168:171]
ds_read_b128 a[12:15], v1 offset:27648
v_mfma_f32_16x16x32_bf16 v[200:203], a[40:43], v[72:75], v[200:203]
v_exp_f32 v31, v31
v_mfma_f32_16x16x32_bf16 v[232:235], a[40:43], v[76:79], v[232:235]
v_exp_f32 v40, v40
v_mfma_f32_16x16x32_bf16 v[236:239], a[44:47], v[76:79], v[236:239]
ds_read_b128 a[16:19], v1 offset:28672
v_cvt_pk_bf16_f32 v61, v30, v31
v_mfma_f32_16x16x32_bf16 v[204:207], a[44:47], v[72:75], v[204:207]
v_mfma_f32_16x16x32_bf16 v[172:175], a[44:47], v[68:71], v[172:175]
ds_read_b128 a[20:23], v1 offset:29696
v_mfma_f32_16x16x32_bf16 v[176:179], a[48:51], v[68:71], v[176:179]
v_exp_f32 v41, v41
v_mfma_f32_16x16x32_bf16 v[208:211], a[48:51], v[72:75], v[208:211]
ds_read_b128 a[24:27], v1 offset:30720
v_cvt_pk_bf16_f32 v58, v40, v41
v_mfma_f32_16x16x32_bf16 v[240:243], a[48:51], v[76:79], v[240:243]
buffer_load_dwordx4 v3, s[48:51], s7 offen offset:1024 sc1 lds
v_mfma_f32_16x16x32_bf16 v[244:247], a[52:55], v[76:79], v[244:247]
v_exp_f32 v42, v42
v_mfma_f32_16x16x32_bf16 v[212:215], a[52:55], v[72:75], v[212:215]
ds_read_b128 a[28:31], v1 offset:31744
v_mfma_f32_16x16x32_bf16 v[180:183], a[52:55], v[68:71], v[180:183]
v_exp_f32 v43, v43
v_mfma_f32_16x16x32_bf16 v[184:187], a[56:59], v[68:71], v[184:187]
ds_read_b128 a[32:35], v1 offset:16384
v_cvt_pk_bf16_f32 v59, v42, v43
v_mfma_f32_16x16x32_bf16 v[216:219], a[56:59], v[72:75], v[216:219]
v_mfma_f32_16x16x32_bf16 v[248:251], a[56:59], v[76:79], v[248:251]
ds_read_b128 a[36:39], v1 offset:17408
v_mfma_f32_16x16x32_bf16 v[252:255], a[60:63], v[76:79], v[252:255]
v_exp_f32 v44, v44
v_mfma_f32_16x16x32_bf16 v[220:223], a[60:63], v[72:75], v[220:223]
v_exp_f32 v45, v45
v_mfma_f32_16x16x32_bf16 v[188:191], a[60:63], v[68:71], v[188:191]
buffer_load_dwordx4 v3, s[48:51], s7 offen offset:2048 sc1 lds
v_mfma_f32_16x16x32_bf16 a[228:231], a[240:243], v[68:71], a[228:231]
ds_read_b128 a[40:43], v1 offset:18432
v_cvt_pk_bf16_f32 v62, v44, v45
v_mfma_f32_16x16x32_bf16 a[232:235], a[240:243], v[72:75], a[232:235]
ds_read_b128 a[44:47], v1 offset:19456
v_mfma_f32_16x16x32_bf16 a[236:239], a[240:243], v[76:79], a[236:239]
s_waitcnt lgkmcnt(8)
v_exp_f32 v46, v46
v_mfma_f32_16x16x32_bf16 v[24:27], a[0:3], a[192:195], v[88:91]
ds_read_b128 a[48:51], v1 offset:20480
v_mfma_f32_16x16x32_bf16 v[24:27], a[4:7], a[196:199], v[24:27]
v_mfma_f32_16x16x32_bf16 v[24:27], a[8:11], a[200:203], v[24:27]
v_exp_f32 v47, v47
v_mfma_f32_16x16x32_bf16 v[24:27], a[12:15], a[204:207], v[24:27]
ds_read_b128 a[52:55], v1 offset:21504
v_cvt_pk_bf16_f32 v63, v46, v47
v_mfma_f32_16x16x32_bf16 v[28:31], a[0:3], a[208:211], v[92:95]
v_mfma_f32_16x16x32_bf16 v[28:31], a[4:7], a[212:215], v[28:31]
ds_read_b128 a[56:59], v1 offset:22528
v_mfma_f32_16x16x32_bf16 v[28:31], a[8:11], a[216:219], v[28:31]
buffer_load_dwordx4 v3, s[48:51], s7 offen offset:3072 sc1 lds
v_mfma_f32_16x16x32_bf16 v[28:31], a[12:15], a[220:223], v[28:31]
ds_read_b128 a[60:63], v1 offset:23552
s_waitcnt lgkmcnt(8)
v_mfma_f32_16x16x32_bf16 v[40:43], a[16:19], a[192:195], v[88:91]
s_add_u32 s7, s7, 0x8000
v_xor_b32 v1, 0x8000, v1
v_mfma_f32_16x16x32_bf16 v[40:43], a[20:23], a[196:199], v[40:43]
s_xor_b32 s27, s27, 0x38000
v_exp_f32 v24, v24
v_mfma_f32_16x16x32_bf16 v[40:43], a[24:27], a[200:203], v[40:43]
v_exp_f32 v25, v25
v_mfma_f32_16x16x32_bf16 v[40:43], a[28:31], a[204:207], v[40:43]
v_exp_f32 v26, v26
v_mfma_f32_16x16x32_bf16 v[44:47], a[16:19], a[208:211], v[92:95]
v_exp_f32 v27, v27
v_mfma_f32_16x16x32_bf16 v[44:47], a[20:23], a[212:215], v[44:47]
v_exp_f32 v28, v28
v_mfma_f32_16x16x32_bf16 v[44:47], a[24:27], a[216:219], v[44:47]
s_waitcnt vmcnt(19) lgkmcnt(0)
v_exp_f32 v29, v29
v_mfma_f32_16x16x32_bf16 v[44:47], a[28:31], a[220:223], v[44:47]
s_barrier
s_nop 7
v_accvgpr_read_b32 v4, a224
v_accvgpr_read_b32 v6, a228
s_mov_b32 s8, 0x5f800000
v_cmp_nge_f32 s[36:37], s8, v4
v_cmp_nge_f32 s[38:39], s8, v6
v_rcp_f32 v4, v4
v_rcp_f32 v6, v6
s_or_b64 s[34:35], s[34:35], s[36:37]
s_or_b64 s[34:35], s[34:35], s[38:39]
v_pk_mul_f32 v[128:129], v[128:129], v[4:5] op_sel_hi:[1,0]
v_pk_mul_f32 v[130:131], v[130:131], v[4:5] op_sel_hi:[1,0]
v_pk_mul_f32 v[132:133], v[132:133], v[4:5] op_sel_hi:[1,0]
v_pk_mul_f32 v[134:135], v[134:135], v[4:5] op_sel_hi:[1,0]
v_cvt_pk_bf16_f32 v128, v128, v129
v_cvt_pk_bf16_f32 v129, v130, v131
v_cvt_pk_bf16_f32 v130, v132, v133
v_cvt_pk_bf16_f32 v131, v134, v135
s_add_u32 s8, s28, 0x0
buffer_store_dwordx4 v[128:131], v3, s[88:91], s8 offen sc1
v_pk_mul_f32 v[136:137], v[136:137], v[4:5] op_sel_hi:[1,0]
v_pk_mul_f32 v[138:139], v[138:139], v[4:5] op_sel_hi:[1,0]
v_pk_mul_f32 v[140:141], v[140:141], v[4:5] op_sel_hi:[1,0]
v_pk_mul_f32 v[142:143], v[142:143], v[4:5] op_sel_hi:[1,0]
v_cvt_pk_bf16_f32 v136, v136, v137
v_cvt_pk_bf16_f32 v137, v138, v139
v_cvt_pk_bf16_f32 v138, v140, v141
v_cvt_pk_bf16_f32 v139, v142, v143
s_add_u32 s8, s28, 0x2000
buffer_store_dwordx4 v[136:139], v3, s[88:91], s8 offen sc1
v_pk_mul_f32 v[144:145], v[144:145], v[4:5] op_sel_hi:[1,0]
v_pk_mul_f32 v[146:147], v[146:147], v[4:5] op_sel_hi:[1,0]
v_pk_mul_f32 v[148:149], v[148:149], v[4:5] op_sel_hi:[1,0]
v_pk_mul_f32 v[150:151], v[150:151], v[4:5] op_sel_hi:[1,0]
v_cvt_pk_bf16_f32 v144, v144, v145
v_cvt_pk_bf16_f32 v145, v146, v147
v_cvt_pk_bf16_f32 v146, v148, v149
v_cvt_pk_bf16_f32 v147, v150, v151
s_add_u32 s8, s28, 0x4000
buffer_store_dwordx4 v[144:147], v3, s[88:91], s8 offen sc1
v_pk_mul_f32 v[152:153], v[152:153], v[4:5] op_sel_hi:[1,0]
v_pk_mul_f32 v[154:155], v[154:155], v[4:5] op_sel_hi:[1,0]
v_pk_mul_f32 v[156:157], v[156:157], v[4:5] op_sel_hi:[1,0]
v_pk_mul_f32 v[158:159], v[158:159], v[4:5] op_sel_hi:[1,0]
v_cvt_pk_bf16_f32 v152, v152, v153
v_cvt_pk_bf16_f32 v153, v154, v155
v_cvt_pk_bf16_f32 v154, v156, v157
v_cvt_pk_bf16_f32 v155, v158, v159
s_add_u32 s8, s28, 0x6000
buffer_store_dwordx4 v[152:155], v3, s[88:91], s8 offen sc1
v_pk_mul_f32 v[160:161], v[160:161], v[6:7] op_sel_hi:[1,0]
v_pk_mul_f32 v[162:163], v[162:163], v[6:7] op_sel_hi:[1,0]
v_pk_mul_f32 v[164:165], v[164:165], v[6:7] op_sel_hi:[1,0]
v_pk_mul_f32 v[166:167], v[166:167], v[6:7] op_sel_hi:[1,0]
v_cvt_pk_bf16_f32 v160, v160, v161
v_cvt_pk_bf16_f32 v161, v162, v163
v_cvt_pk_bf16_f32 v162, v164, v165
v_cvt_pk_bf16_f32 v163, v166, v167
s_add_u32 s8, s29, 0x0
buffer_store_dwordx4 v[160:163], v3, s[88:91], s8 offen sc1
v_pk_mul_f32 v[168:169], v[168:169], v[6:7] op_sel_hi:[1,0]
v_pk_mul_f32 v[170:171], v[170:171], v[6:7] op_sel_hi:[1,0]
v_pk_mul_f32 v[172:173], v[172:173], v[6:7] op_sel_hi:[1,0]
v_pk_mul_f32 v[174:175], v[174:175], v[6:7] op_sel_hi:[1,0]
v_cvt_pk_bf16_f32 v168, v168, v169
v_cvt_pk_bf16_f32 v169, v170, v171
v_cvt_pk_bf16_f32 v170, v172, v173
v_cvt_pk_bf16_f32 v171, v174, v175
s_add_u32 s8, s29, 0x2000
buffer_store_dwordx4 v[168:171], v3, s[88:91], s8 offen sc1
v_pk_mul_f32 v[176:177], v[176:177], v[6:7] op_sel_hi:[1,0]
v_pk_mul_f32 v[178:179], v[178:179], v[6:7] op_sel_hi:[1,0]
v_pk_mul_f32 v[180:181], v[180:181], v[6:7] op_sel_hi:[1,0]
v_pk_mul_f32 v[182:183], v[182:183], v[6:7] op_sel_hi:[1,0]
v_cvt_pk_bf16_f32 v176, v176, v177
v_cvt_pk_bf16_f32 v177, v178, v179
v_cvt_pk_bf16_f32 v178, v180, v181
v_cvt_pk_bf16_f32 v179, v182, v183
s_add_u32 s8, s29, 0x4000
buffer_store_dwordx4 v[176:179], v3, s[88:91], s8 offen sc1
v_pk_mul_f32 v[184:185], v[184:185], v[6:7] op_sel_hi:[1,0]
v_pk_mul_f32 v[186:187], v[186:187], v[6:7] op_sel_hi:[1,0]
v_pk_mul_f32 v[188:189], v[188:189], v[6:7] op_sel_hi:[1,0]
v_pk_mul_f32 v[190:191], v[190:191], v[6:7] op_sel_hi:[1,0]
v_cvt_pk_bf16_f32 v184, v184, v185
v_cvt_pk_bf16_f32 v185, v186, v187
v_cvt_pk_bf16_f32 v186, v188, v189
v_cvt_pk_bf16_f32 v187, v190, v191
s_add_u32 s8, s29, 0x6000
buffer_store_dwordx4 v[184:187], v3, s[88:91], s8 offen sc1
s_branch L_att_sodd
L_att_lh0_0:
s_cmp_lg_u32 s33, 0
s_cbranch_scc1 L_sig_bh0
s_lshl_b32 s8, s6, 2
s_add_u32 s8, s8, 192
s_cmp_lg_u32 s4, 0
s_cbranch_scc1 L_sig_bh0
v_mov_b32 v4, 1
s_mov_b64 exec, 1
buffer_atomic_add v4, off, s[84:87], s8 sc1
s_mov_b64 exec, -1
L_sig_bh0:
v_mfma_f32_16x16x32_bf16 v[160:163], a[32:35], v[52:55], v[160:163]
v_exp_f32 v28, v28
v_mfma_f32_16x16x32_bf16 v[192:195], a[32:35], v[56:59], v[192:195]
buffer_load_dword v14, v15, s[84:87], 0 offen offset:192 sc1
v_mfma_f32_16x16x32_bf16 v[224:227], a[32:35], v[60:63], v[224:227]
v_exp_f32 v29, v29
v_mfma_f32_16x16x32_bf16 v[228:231], a[36:39], v[60:63], v[228:231]
v_exp_f32 v30, v30
v_mfma_f32_16x16x32_bf16 v[196:199], a[36:39], v[56:59], v[196:199]
s_add_u32 m0, s17, 0x10000
v_exp_f32 v31, v31
v_mfma_f32_16x16x32_bf16 v[164:167], a[36:39], v[52:55], v[164:167]
ds_read_b128 a[0:3], v1 offset:8192
v_cvt_pk_bf16_f32 v72, v24, v25
v_mfma_f32_16x16x32_bf16 v[168:171], a[40:43], v[52:55], v[168:171]
ds_read_b128 a[4:7], v1 offset:9216
v_cvt_pk_bf16_f32 v73, v26, v27
v_mfma_f32_16x16x32_bf16 v[200:203], a[40:43], v[56:59], v[200:203]
buffer_load_dwordx4 v12, s[72:75], 0 offen lds
v_mfma_f32_16x16x32_bf16 v[232:235], a[40:43], v[60:63], v[232:235]
ds_read_b128 a[8:11], v1 offset:10240
v_cvt_pk_bf16_f32 v76, v28, v29
v_mfma_f32_16x16x32_bf16 v[236:239], a[44:47], v[60:63], v[236:239]
v_exp_f32 v36, v36
v_mfma_f32_16x16x32_bf16 v[204:207], a[44:47], v[56:59], v[204:207]
v_exp_f32 v37, v37
v_mfma_f32_16x16x32_bf16 v[172:175], a[44:47], v[52:55], v[172:175]
ds_read_b128 a[12:15], v1 offset:11264
v_cvt_pk_bf16_f32 v77, v30, v31
v_mfma_f32_16x16x32_bf16 v[176:179], a[48:51], v[52:55], v[176:179]
buffer_load_dwordx4 v13, s[72:75], 0 offen offset:1024 lds
v_mfma_f32_16x16x32_bf16 v[208:211], a[48:51], v[56:59], v[208:211]
ds_read_b128 a[16:19], v1 offset:12288
v_cvt_pk_bf16_f32 v70, v36, v37
v_mfma_f32_16x16x32_bf16 v[240:243], a[48:51], v[60:63], v[240:243]
ds_read_b128 a[20:23], v1 offset:13312
v_exp_f32 v38, v38
v_mfma_f32_16x16x32_bf16 v[244:247], a[52:55], v[60:63], v[244:247]
ds_read_b128 a[24:27], v1 offset:14336
v_exp_f32 v39, v39
v_mfma_f32_16x16x32_bf16 v[212:215], a[52:55], v[56:59], v[212:215]
v_exp_f32 v40, v40
v_mfma_f32_16x16x32_bf16 v[180:183], a[52:55], v[52:55], v[180:183]
buffer_load_dwordx4 v12, s[72:75], s12 offen offset:2048 lds
v_mfma_f32_16x16x32_bf16 v[184:187], a[56:59], v[52:55], v[184:187]
ds_read_b128 a[28:31], v1 offset:15360
v_cvt_pk_bf16_f32 v71, v38, v39
v_mfma_f32_16x16x32_bf16 v[216:219], a[56:59], v[56:59], v[216:219]
buffer_load_dwordx4 v13, s[72:75], s12 offen offset:3072 lds
v_mfma_f32_16x16x32_bf16 v[248:251], a[56:59], v[60:63], v[248:251]
v_exp_f32 v41, v41
v_mfma_f32_16x16x32_bf16 v[252:255], a[60:63], v[60:63], v[252:255]
s_add_u32 m0, s17, 0x14000
v_exp_f32 v42, v42
v_mfma_f32_16x16x32_bf16 v[220:223], a[60:63], v[56:59], v[220:223]
ds_read_b128 a[32:35], v1 offset:0
v_cvt_pk_bf16_f32 v74, v40, v41
v_mfma_f32_16x16x32_bf16 v[188:191], a[60:63], v[52:55], v[188:191]
ds_read_b128 a[36:39], v1 offset:1024
v_add_u32 v12, 0x20000, v12
v_mfma_f32_16x16x32_bf16 a[228:231], a[240:243], v[52:55], a[228:231]
buffer_load_dwordx4 v12, s[72:75], 0 offen lds
v_mfma_f32_16x16x32_bf16 a[232:235], a[240:243], v[56:59], a[232:235]
ds_read_b128 a[40:43], v1 offset:2048
v_exp_f32 v43, v43
v_mfma_f32_16x16x32_bf16 a[236:239], a[240:243], v[60:63], a[236:239]
s_waitcnt lgkmcnt(7)
v_exp_f32 v44, v44
v_mfma_f32_16x16x32_bf16 v[24:27], a[0:3], a[192:195], v[112:115]
ds_read_b128 a[44:47], v1 offset:3072
v_cvt_pk_bf16_f32 v75, v42, v43
v_mfma_f32_16x16x32_bf16 v[24:27], a[4:7], a[196:199], v[24:27]
ds_read_b128 a[48:51], v1 offset:4096
v_add_u32 v13, 0x20000, v13
v_mfma_f32_16x16x32_bf16 v[24:27], a[8:11], a[200:203], v[24:27]
v_exp_f32 v45, v45
v_mfma_f32_16x16x32_bf16 v[24:27], a[12:15], a[204:207], v[24:27]
buffer_load_dwordx4 v13, s[72:75], 0 offen offset:1024 lds
v_mfma_f32_16x16x32_bf16 v[28:31], a[0:3], a[208:211], v[92:95]
v_exp_f32 v46, v46
v_mfma_f32_16x16x32_bf16 v[28:31], a[4:7], a[212:215], v[28:31]
ds_read_b128 a[52:55], v1 offset:5120
v_cvt_pk_bf16_f32 v78, v44, v45
v_mfma_f32_16x16x32_bf16 v[28:31], a[8:11], a[216:219], v[28:31]
ds_read_b128 a[56:59], v1 offset:6144
v_exp_f32 v47, v47
v_mfma_f32_16x16x32_bf16 v[28:31], a[12:15], a[220:223], v[28:31]
s_waitcnt lgkmcnt(7)
v_exp_f32 v24, v24
v_mfma_f32_16x16x32_bf16 v[40:43], a[16:19], a[192:195], v[116:119]
buffer_load_dwordx4 v12, s[72:75], s12 offen offset:2048 lds
v_mfma_f32_16x16x32_bf16 v[40:43], a[20:23], a[196:199], v[40:43]
ds_read_b128 a[60:63], v1 offset:7168
v_cvt_pk_bf16_f32 v79, v46, v47
v_mfma_f32_16x16x32_bf16 v[40:43], a[24:27], a[200:203], v[40:43]
v_exp_f32 v25, v25
v_mfma_f32_16x16x32_bf16 v[40:43], a[28:31], a[204:207], v[40:43]
buffer_load_dwordx4 v13, s[72:75], s12 offen offset:3072 lds
v_mfma_f32_16x16x32_bf16 v[44:47], a[16:19], a[208:211], v[92:95]
v_exp_f32 v26, v26
v_mfma_f32_16x16x32_bf16 v[44:47], a[20:23], a[212:215], v[44:47]
v_exp_f32 v27, v27
v_mfma_f32_16x16x32_bf16 v[44:47], a[24:27], a[216:219], v[44:47]
v_exp_f32 v28, v28
v_mfma_f32_16x16x32_bf16 v[44:47], a[28:31], a[220:223], v[44:47]
s_waitcnt lgkmcnt(0)
v_exp_f32 v29, v29
v_mfma_f32_16x16x32_bf16 v[160:163], a[32:35], v[68:71], v[160:163]
ds_read_b128 a[0:3], v1 offset:24576
v_cvt_pk_bf16_f32 v56, v24, v25
v_mfma_f32_16x16x32_bf16 v[192:195], a[32:35], v[72:75], v[192:195]
ds_read_b128 a[4:7], v1 offset:25600
v_add_u32 v12, 0x20000, v12
v_mfma_f32_16x16x32_bf16 v[224:227], a[32:35], v[76:79], v[224:227]
v_exp_f32 v30, v30
v_mfma_f32_16x16x32_bf16 v[228:231], a[36:39], v[76:79], v[228:231]
s_add_u32 m0, s16, 0x0
v_exp_f32 v31, v31
v_mfma_f32_16x16x32_bf16 v[196:199], a[36:39], v[72:75], v[196:199]
buffer_load_dwordx4 v12, s[72:75], 0 offen lds
v_mfma_f32_16x16x32_bf16 v[164:167], a[36:39], v[68:71], v[164:167]
ds_read_b128 a[8:11], v1 offset:26624
v_add_u32 v13, 0x20000, v13
v_mfma_f32_16x16x32_bf16 v[168:171], a[40:43], v[68:71], v[168:171]
buffer_load_dwordx4 v13, s[72:75], 0 offen offset:1024 lds
v_mfma_f32_16x16x32_bf16 v[200:203], a[40:43], v[72:75], v[200:203]
ds_read_b128 a[12:15], v1 offset:27648
v_cvt_pk_bf16_f32 v57, v26, v27
v_mfma_f32_16x16x32_bf16 v[232:235], a[40:43], v[76:79], v[232:235]
ds_read_b128 a[16:19], v1 offset:28672
v_cvt_pk_bf16_f32 v60, v28, v29
v_mfma_f32_16x16x32_bf16 v[236:239], a[44:47], v[76:79], v[236:239]
v_exp_f32 v40, v40
v_mfma_f32_16x16x32_bf16 v[204:207], a[44:47], v[72:75], v[204:207]
buffer_load_dwordx4 v12, s[72:75], s12 offen offset:2048 lds
v_mfma_f32_16x16x32_bf16 v[172:175], a[44:47], v[68:71], v[172:175]
ds_read_b128 a[20:23], v1 offset:29696
v_cvt_pk_bf16_f32 v61, v30, v31
v_mfma_f32_16x16x32_bf16 v[176:179], a[48:51], v[68:71], v[176:179]
buffer_load_dwordx4 v13, s[72:75], s12 offen offset:3072 lds
v_mfma_f32_16x16x32_bf16 v[208:211], a[48:51], v[72:75], v[208:211]
ds_read_b128 a[24:27], v1 offset:30720
v_mfma_f32_16x16x32_bf16 v[240:243], a[48:51], v[76:79], v[240:243]
ds_read_b128 a[28:31], v1 offset:31744
v_mfma_f32_16x16x32_bf16 v[244:247], a[52:55], v[76:79], v[244:247]
v_exp_f32 v41, v41
v_mfma_f32_16x16x32_bf16 v[212:215], a[52:55], v[72:75], v[212:215]
s_add_u32 m0, s16, 0x4000
v_exp_f32 v42, v42
v_mfma_f32_16x16x32_bf16 v[180:183], a[52:55], v[68:71], v[180:183]
ds_read_b128 a[32:35], v1 offset:16384
v_cvt_pk_bf16_f32 v58, v40, v41
v_mfma_f32_16x16x32_bf16 v[184:187], a[56:59], v[68:71], v[184:187]
ds_read_b128 a[36:39], v1 offset:17408
v_add_u32 v12, 0x20000, v12
v_mfma_f32_16x16x32_bf16 v[216:219], a[56:59], v[72:75], v[216:219]
buffer_load_dwordx4 v12, s[72:75], 0 offen lds
v_mfma_f32_16x16x32_bf16 v[248:251], a[56:59], v[76:79], v[248:251]
ds_read_b128 a[40:43], v1 offset:18432
v_exp_f32 v43, v43
v_mfma_f32_16x16x32_bf16 v[252:255], a[60:63], v[76:79], v[252:255]
v_exp_f32 v44, v44
v_mfma_f32_16x16x32_bf16 v[220:223], a[60:63], v[72:75], v[220:223]
ds_read_b128 a[44:47], v1 offset:19456
v_add_u32 v13, 0x20000, v13
v_mfma_f32_16x16x32_bf16 v[188:191], a[60:63], v[68:71], v[188:191]
buffer_load_dwordx4 v13, s[72:75], 0 offen offset:1024 lds
v_mfma_f32_16x16x32_bf16 a[228:231], a[240:243], v[68:71], a[228:231]
ds_read_b128 a[48:51], v1 offset:20480
v_cvt_pk_bf16_f32 v59, v42, v43
v_mfma_f32_16x16x32_bf16 a[232:235], a[240:243], v[72:75], a[232:235]
s_waitcnt lgkmcnt(9)
v_exp_f32 v45, v45
v_mfma_f32_16x16x32_bf16 a[236:239], a[240:243], v[76:79], a[236:239]
ds_read_b128 a[52:55], v1 offset:21504
v_exp_f32 v46, v46
v_mfma_f32_16x16x32_bf16 v[28:31], a[0:3], a[208:211], v[92:95]
buffer_load_dwordx4 v12, s[72:75], s12 offen offset:2048 lds
v_mfma_f32_16x16x32_bf16 v[28:31], a[4:7], a[212:215], v[28:31]
ds_read_b128 a[56:59], v1 offset:22528
v_cvt_pk_bf16_f32 v62, v44, v45
v_mfma_f32_16x16x32_bf16 v[28:31], a[8:11], a[216:219], v[28:31]
ds_read_b128 a[60:63], v1 offset:23552
v_xor_b32 v1, 0x8000, v1
v_mfma_f32_16x16x32_bf16 v[28:31], a[12:15], a[220:223], v[28:31]
s_waitcnt lgkmcnt(8)
v_exp_f32 v47, v47
s_nop 0
v_cvt_pk_bf16_f32 v63, v46, v47
v_mfma_f32_16x16x32_bf16 v[44:47], a[16:19], a[208:211], v[92:95]
buffer_load_dwordx4 v13, s[72:75], s12 offen offset:3072 lds
v_mfma_f32_16x16x32_bf16 v[44:47], a[20:23], a[212:215], v[44:47]
v_mfma_f32_16x16x32_bf16 v[44:47], a[24:27], a[216:219], v[44:47]
v_mfma_f32_16x16x32_bf16 v[44:47], a[28:31], a[220:223], v[44:47]
s_nop 7
v_accvgpr_read_b32 v4, a224
v_accvgpr_read_b32 v6, a228
s_mov_b32 s8, 0x5f800000
v_cmp_nge_f32 s[36:37], s8, v4
v_cmp_nge_f32 s[38:39], s8, v6
v_rcp_f32 v4, v4
v_rcp_f32 v6, v6
s_or_b64 s[34:35], s[34:35], s[36:37]
s_or_b64 s[34:35], s[34:35], s[38:39]
v_pk_mul_f32 v[128:129], v[128:129], v[4:5] op_sel_hi:[1,0]
v_pk_mul_f32 v[130:131], v[130:131], v[4:5] op_sel_hi:[1,0]
v_pk_mul_f32 v[132:133], v[132:133], v[4:5] op_sel_hi:[1,0]
v_pk_mul_f32 v[134:135], v[134:135], v[4:5] op_sel_hi:[1,0]
v_cvt_pk_bf16_f32 v128, v128, v129
v_cvt_pk_bf16_f32 v129, v130, v131
v_cvt_pk_bf16_f32 v130, v132, v133
v_cvt_pk_bf16_f32 v131, v134, v135
s_add_u32 s8, s28, 0x0
buffer_store_dwordx4 v[128:131], v3, s[88:91], s8 offen sc1
v_pk_mul_f32 v[136:137], v[136:137], v[4:5] op_sel_hi:[1,0]
v_pk_mul_f32 v[138:139], v[138:139], v[4:5] op_sel_hi:[1,0]
v_pk_mul_f32 v[140:141], v[140:141], v[4:5] op_sel_hi:[1,0]
v_pk_mul_f32 v[142:143], v[142:143], v[4:5] op_sel_hi:[1,0]
v_cvt_pk_bf16_f32 v136, v136, v137
v_cvt_pk_bf16_f32 v137, v138, v139
v_cvt_pk_bf16_f32 v138, v140, v141
v_cvt_pk_bf16_f32 v139, v142, v143
s_add_u32 s8, s28, 0x2000
buffer_store_dwordx4 v[136:139], v3, s[88:91], s8 offen sc1
v_pk_mul_f32 v[144:145], v[144:145], v[4:5] op_sel_hi:[1,0]
v_pk_mul_f32 v[146:147], v[146:147], v[4:5] op_sel_hi:[1,0]
v_pk_mul_f32 v[148:149], v[148:149], v[4:5] op_sel_hi:[1,0]
v_pk_mul_f32 v[150:151], v[150:151], v[4:5] op_sel_hi:[1,0]
v_cvt_pk_bf16_f32 v144, v144, v145
v_cvt_pk_bf16_f32 v145, v146, v147
v_cvt_pk_bf16_f32 v146, v148, v149
v_cvt_pk_bf16_f32 v147, v150, v151
s_add_u32 s8, s28, 0x4000
buffer_store_dwordx4 v[144:147], v3, s[88:91], s8 offen sc1
v_pk_mul_f32 v[152:153], v[152:153], v[4:5] op_sel_hi:[1,0]
v_pk_mul_f32 v[154:155], v[154:155], v[4:5] op_sel_hi:[1,0]
v_pk_mul_f32 v[156:157], v[156:157], v[4:5] op_sel_hi:[1,0]
v_pk_mul_f32 v[158:159], v[158:159], v[4:5] op_sel_hi:[1,0]
v_cvt_pk_bf16_f32 v152, v152, v153
v_cvt_pk_bf16_f32 v153, v154, v155
v_cvt_pk_bf16_f32 v154, v156, v157
v_cvt_pk_bf16_f32 v155, v158, v159
s_add_u32 s8, s28, 0x6000
buffer_store_dwordx4 v[152:155], v3, s[88:91], s8 offen sc1
v_pk_mul_f32 v[160:161], v[160:161], v[6:7] op_sel_hi:[1,0]
v_pk_mul_f32 v[162:163], v[162:163], v[6:7] op_sel_hi:[1,0]
v_pk_mul_f32 v[164:165], v[164:165], v[6:7] op_sel_hi:[1,0]
v_pk_mul_f32 v[166:167], v[166:167], v[6:7] op_sel_hi:[1,0]
v_cvt_pk_bf16_f32 v160, v160, v161
v_cvt_pk_bf16_f32 v161, v162, v163
v_cvt_pk_bf16_f32 v162, v164, v165
v_cvt_pk_bf16_f32 v163, v166, v167
s_add_u32 s8, s29, 0x0
buffer_store_dwordx4 v[160:163], v3, s[88:91], s8 offen sc1
v_pk_mul_f32 v[168:169], v[168:169], v[6:7] op_sel_hi:[1,0]
v_pk_mul_f32 v[170:171], v[170:171], v[6:7] op_sel_hi:[1,0]
v_pk_mul_f32 v[172:173], v[172:173], v[6:7] op_sel_hi:[1,0]
v_pk_mul_f32 v[174:175], v[174:175], v[6:7] op_sel_hi:[1,0]
v_cvt_pk_bf16_f32 v168, v168, v169
v_cvt_pk_bf16_f32 v169, v170, v171
v_cvt_pk_bf16_f32 v170, v172, v173
v_cvt_pk_bf16_f32 v171, v174, v175
s_add_u32 s8, s29, 0x2000
buffer_store_dwordx4 v[168:171], v3, s[88:91], s8 offen sc1
v_pk_mul_f32 v[176:177], v[176:177], v[6:7] op_sel_hi:[1,0]
v_pk_mul_f32 v[178:179], v[178:179], v[6:7] op_sel_hi:[1,0]
v_pk_mul_f32 v[180:181], v[180:181], v[6:7] op_sel_hi:[1,0]
v_pk_mul_f32 v[182:183], v[182:183], v[6:7] op_sel_hi:[1,0]
v_cvt_pk_bf16_f32 v176, v176, v177
v_cvt_pk_bf16_f32 v177, v178, v179
v_cvt_pk_bf16_f32 v178, v180, v181
v_cvt_pk_bf16_f32 v179, v182, v183
s_add_u32 s8, s29, 0x4000
buffer_store_dwordx4 v[176:179], v3, s[88:91], s8 offen sc1
v_pk_mul_f32 v[184:185], v[184:185], v[6:7] op_sel_hi:[1,0]
v_pk_mul_f32 v[186:187], v[186:187], v[6:7] op_sel_hi:[1,0]
v_pk_mul_f32 v[188:189], v[188:189], v[6:7] op_sel_hi:[1,0]
v_pk_mul_f32 v[190:191], v[190:191], v[6:7] op_sel_hi:[1,0]
v_cvt_pk_bf16_f32 v184, v184, v185
v_cvt_pk_bf16_f32 v185, v186, v187
v_cvt_pk_bf16_f32 v186, v188, v189
v_cvt_pk_bf16_f32 v187, v190, v191
s_add_u32 s8, s29, 0x6000
buffer_store_dwordx4 v[184:187], v3, s[88:91], s8 offen sc1
s_branch L_att_h1_0
L_att_dl0_1:
v_mfma_f32_16x16x32_bf16 v[128:131], a[32:35], v[48:51], v[128:131]
ds_read_b128 a[0:3], v1 offset:8192
v_cvt_pk_bf16_f32 v72, v24, v25
v_mfma_f32_16x16x32_bf16 v[160:163], a[32:35], v[52:55], v[160:163]
v_exp_f32 v28, v28
v_mfma_f32_16x16x32_bf16 v[192:195], a[32:35], v[56:59], v[192:195]
v_cvt_pk_bf16_f32 v73, v26, v27
v_mfma_f32_16x16x32_bf16 v[224:227], a[32:35], v[60:63], v[224:227]
ds_read_b128 a[4:7], v1 offset:9216
v_mfma_f32_16x16x32_bf16 v[228:231], a[36:39], v[60:63], v[228:231]
s_add_u32 m0, s27, 0x0
v_exp_f32 v29, v29
v_mfma_f32_16x16x32_bf16 v[196:199], a[36:39], v[56:59], v[196:199]
buffer_load_dwordx4 v3, s[48:51], s32 offen offset:0 sc1 lds
v_mfma_f32_16x16x32_bf16 v[164:167], a[36:39], v[52:55], v[164:167]
v_exp_f32 v30, v30
v_mfma_f32_16x16x32_bf16 v[132:135], a[36:39], v[48:51], v[132:135]
ds_read_b128 a[8:11], v1 offset:10240
v_cvt_pk_bf16_f32 v76, v28, v29
v_mfma_f32_16x16x32_bf16 v[136:139], a[40:43], v[48:51], v[136:139]
v_mfma_f32_16x16x32_bf16 v[168:171], a[40:43], v[52:55], v[168:171]
v_exp_f32 v31, v31
v_mfma_f32_16x16x32_bf16 v[200:203], a[40:43], v[56:59], v[200:203]
v_exp_f32 v32, v32
v_mfma_f32_16x16x32_bf16 v[232:235], a[40:43], v[60:63], v[232:235]
ds_read_b128 a[12:15], v1 offset:11264
v_cvt_pk_bf16_f32 v77, v30, v31
v_mfma_f32_16x16x32_bf16 v[236:239], a[44:47], v[60:63], v[236:239]
v_mfma_f32_16x16x32_bf16 v[204:207], a[44:47], v[56:59], v[204:207]
v_exp_f32 v33, v33
v_mfma_f32_16x16x32_bf16 v[172:175], a[44:47], v[52:55], v[172:175]
s_mov_b32 s9, 0x0
v_exp_f32 v34, v34
v_mfma_f32_16x16x32_bf16 v[140:143], a[44:47], v[48:51], v[140:143]
ds_read_b128 a[16:19], v1 offset:12288
v_cvt_pk_bf16_f32 v66, v32, v33
v_mfma_f32_16x16x32_bf16 v[144:147], a[48:51], v[48:51], v[144:147]
buffer_load_dword a244, v8, s[72:75], s9 offen
v_mfma_f32_16x16x32_bf16 v[176:179], a[48:51], v[52:55], v[176:179]
v_mfma_f32_16x16x32_bf16 v[208:211], a[48:51], v[56:59], v[208:211]
v_exp_f32 v35, v35
v_mfma_f32_16x16x32_bf16 v[240:243], a[48:51], v[60:63], v[240:243]
ds_read_b128 a[20:23], v1 offset:13312
v_cvt_pk_bf16_f32 v67, v34, v35
v_mfma_f32_16x16x32_bf16 v[244:247], a[52:55], v[60:63], v[244:247]
v_exp_f32 v36, v36
v_mfma_f32_16x16x32_bf16 v[212:215], a[52:55], v[56:59], v[212:215]
v_exp_f32 v37, v37
v_mfma_f32_16x16x32_bf16 v[180:183], a[52:55], v[52:55], v[180:183]
v_cvt_pk_bf16_f32 v70, v36, v37
v_mfma_f32_16x16x32_bf16 v[148:151], a[52:55], v[48:51], v[148:151]
ds_read_b128 a[24:27], v1 offset:14336
v_mfma_f32_16x16x32_bf16 v[152:155], a[56:59], v[48:51], v[152:155]
v_exp_f32 v38, v38
v_mfma_f32_16x16x32_bf16 v[184:187], a[56:59], v[52:55], v[184:187]
v_exp_f32 v39, v39
v_mfma_f32_16x16x32_bf16 v[216:219], a[56:59], v[56:59], v[216:219]
v_cvt_pk_bf16_f32 v71, v38, v39
v_mfma_f32_16x16x32_bf16 v[248:251], a[56:59], v[60:63], v[248:251]
buffer_load_dwordx4 v3, s[48:51], s32 offen offset:1024 sc1 lds
v_mfma_f32_16x16x32_bf16 v[252:255], a[60:63], v[60:63], v[252:255]
ds_read_b128 a[28:31], v1 offset:15360
v_mfma_f32_16x16x32_bf16 v[220:223], a[60:63], v[56:59], v[220:223]
v_exp_f32 v40, v40
v_mfma_f32_16x16x32_bf16 v[188:191], a[60:63], v[52:55], v[188:191]
v_exp_f32 v41, v41
v_mfma_f32_16x16x32_bf16 v[156:159], a[60:63], v[48:51], v[156:159]
ds_read_b128 a[32:35], v1 offset:0
v_cvt_pk_bf16_f32 v74, v40, v41
v_mfma_f32_16x16x32_bf16 a[224:227], a[240:243], v[48:51], a[224:227]
v_mfma_f32_16x16x32_bf16 a[228:231], a[240:243], v[52:55], a[228:231]
v_exp_f32 v42, v42
v_mfma_f32_16x16x32_bf16 a[232:235], a[240:243], v[56:59], a[232:235]
s_waitcnt lgkmcnt(5)
v_exp_f32 v43, v43
v_mfma_f32_16x16x32_bf16 a[236:239], a[240:243], v[60:63], a[236:239]
ds_read_b128 a[36:39], v1 offset:1024
v_cvt_pk_bf16_f32 v75, v42, v43
v_mfma_f32_16x16x32_bf16 v[16:19], a[0:3], a[160:163], v[80:83]
v_exp_f32 v44, v44
v_mfma_f32_16x16x32_bf16 v[16:19], a[4:7], a[164:167], v[16:19]
v_mfma_f32_16x16x32_bf16 v[16:19], a[8:11], a[168:171], v[16:19]
buffer_load_dwordx4 v3, s[48:51], s32 offen offset:2048 sc1 lds
v_mfma_f32_16x16x32_bf16 v[16:19], a[12:15], a[172:175], v[16:19]
ds_read_b128 a[40:43], v1 offset:2048
v_mfma_f32_16x16x32_bf16 v[20:23], a[0:3], a[176:179], v[84:87]
v_exp_f32 v45, v45
v_mfma_f32_16x16x32_bf16 v[20:23], a[4:7], a[180:183], v[20:23]
v_exp_f32 v46, v46
v_mfma_f32_16x16x32_bf16 v[20:23], a[8:11], a[184:187], v[20:23]
v_cvt_pk_bf16_f32 v78, v44, v45
v_mfma_f32_16x16x32_bf16 v[20:23], a[12:15], a[188:191], v[20:23]
ds_read_b128 a[44:47], v1 offset:3072
v_mfma_f32_16x16x32_bf16 v[24:27], a[0:3], a[192:195], v[88:91]
v_exp_f32 v47, v47
v_mfma_f32_16x16x32_bf16 v[24:27], a[4:7], a[196:199], v[24:27]
v_exp_f32 v16, v16
v_mfma_f32_16x16x32_bf16 v[24:27], a[8:11], a[200:203], v[24:27]
v_cvt_pk_bf16_f32 v79, v46, v47
v_mfma_f32_16x16x32_bf16 v[24:27], a[12:15], a[204:207], v[24:27]
ds_read_b128 a[48:51], v1 offset:4096
v_mfma_f32_16x16x32_bf16 v[28:31], a[0:3], a[208:211], v[92:95]
v_exp_f32 v17, v17
v_mfma_f32_16x16x32_bf16 v[28:31], a[4:7], a[212:215], v[28:31]
buffer_load_dwordx4 v3, s[48:51], s32 offen offset:3072 sc1 lds
v_mfma_f32_16x16x32_bf16 v[28:31], a[8:11], a[216:219], v[28:31]
s_waitcnt lgkmcnt(5)
v_exp_f32 v18, v18
v_mfma_f32_16x16x32_bf16 v[28:31], a[12:15], a[220:223], v[28:31]
ds_read_b128 a[52:55], v1 offset:5120
v_cvt_pk_bf16_f32 v48, v16, v17
v_mfma_f32_16x16x32_bf16 v[32:35], a[16:19], a[160:163], v[80:83]
v_mfma_f32_16x16x32_bf16 v[32:35], a[20:23], a[164:167], v[32:35]
v_exp_f32 v19, v19
v_mfma_f32_16x16x32_bf16 v[32:35], a[24:27], a[168:171], v[32:35]
v_exp_f32 v20, v20
v_mfma_f32_16x16x32_bf16 v[32:35], a[28:31], a[172:175], v[32:35]
ds_read_b128 a[56:59], v1 offset:6144
v_cvt_pk_bf16_f32 v49, v18, v19
v_mfma_f32_16x16x32_bf16 v[36:39], a[16:19], a[176:179], v[84:87]
v_exp_f32 v21, v21
v_mfma_f32_16x16x32_bf16 v[36:39], a[20:23], a[180:183], v[36:39]
v_cvt_pk_bf16_f32 v52, v20, v21
v_mfma_f32_16x16x32_bf16 v[36:39], a[24:27], a[184:187], v[36:39]
s_mov_b32 s9, 0x0
v_exp_f32 v22, v22
v_mfma_f32_16x16x32_bf16 v[36:39], a[28:31], a[188:191], v[36:39]
ds_read_b128 a[60:63], v1 offset:7168
v_mfma_f32_16x16x32_bf16 v[40:43], a[16:19], a[192:195], v[88:91]
buffer_load_dword a244, v8, s[64:67], s9 offen
v_mfma_f32_16x16x32_bf16 v[40:43], a[20:23], a[196:199], v[40:43]
v_exp_f32 v23, v23
v_mfma_f32_16x16x32_bf16 v[40:43], a[24:27], a[200:203], v[40:43]
v_cvt_pk_bf16_f32 v53, v22, v23
v_mfma_f32_16x16x32_bf16 v[40:43], a[28:31], a[204:207], v[40:43]
v_exp_f32 v24, v24
v_mfma_f32_16x16x32_bf16 v[44:47], a[16:19], a[208:211], v[92:95]
v_exp_f32 v25, v25
v_mfma_f32_16x16x32_bf16 v[44:47], a[20:23], a[212:215], v[44:47]
v_exp_f32 v26, v26
v_mfma_f32_16x16x32_bf16 v[44:47], a[24:27], a[216:219], v[44:47]
v_exp_f32 v27, v27
v_mfma_f32_16x16x32_bf16 v[44:47], a[28:31], a[220:223], v[44:47]
s_waitcnt lgkmcnt(0)
v_mfma_f32_16x16x32_bf16 v[128:131], a[32:35], v[64:67], v[128:131]
ds_read_b128 a[0:3], v1 offset:24576
v_cvt_pk_bf16_f32 v56, v24, v25
v_mfma_f32_16x16x32_bf16 v[160:163], a[32:35], v[68:71], v[160:163]
v_exp_f32 v28, v28
v_mfma_f32_16x16x32_bf16 v[192:195], a[32:35], v[72:75], v[192:195]
v_cvt_pk_bf16_f32 v57, v26, v27
v_mfma_f32_16x16x32_bf16 v[224:227], a[32:35], v[76:79], v[224:227]
ds_read_b128 a[4:7], v1 offset:25600
v_mfma_f32_16x16x32_bf16 v[228:231], a[36:39], v[76:79], v[228:231]
v_exp_f32 v29, v29
v_mfma_f32_16x16x32_bf16 v[196:199], a[36:39], v[72:75], v[196:199]
s_add_u32 m0, s27, 0x1000
v_exp_f32 v30, v30
v_mfma_f32_16x16x32_bf16 v[164:167], a[36:39], v[68:71], v[164:167]
buffer_load_dwordx4 v3, s[48:51], s7 offen offset:0 sc1 lds
v_mfma_f32_16x16x32_bf16 v[132:135], a[36:39], v[64:67], v[132:135]
ds_read_b128 a[8:11], v1 offset:26624
v_cvt_pk_bf16_f32 v60, v28, v29
v_mfma_f32_16x16x32_bf16 v[136:139], a[40:43], v[64:67], v[136:139]
v_mfma_f32_16x16x32_bf16 v[168:171], a[40:43], v[68:71], v[168:171]
v_exp_f32 v31, v31
v_mfma_f32_16x16x32_bf16 v[200:203], a[40:43], v[72:75], v[200:203]
v_exp_f32 v32, v32
v_mfma_f32_16x16x32_bf16 v[232:235], a[40:43], v[76:79], v[232:235]
ds_read_b128 a[12:15], v1 offset:27648
v_cvt_pk_bf16_f32 v61, v30, v31
v_mfma_f32_16x16x32_bf16 v[236:239], a[44:47], v[76:79], v[236:239]
v_mfma_f32_16x16x32_bf16 v[204:207], a[44:47], v[72:75], v[204:207]
v_exp_f32 v33, v33
v_mfma_f32_16x16x32_bf16 v[172:175], a[44:47], v[68:71], v[172:175]
v_exp_f32 v34, v34
v_mfma_f32_16x16x32_bf16 v[140:143], a[44:47], v[64:67], v[140:143]
ds_read_b128 a[16:19], v1 offset:28672
v_cvt_pk_bf16_f32 v50, v32, v33
v_mfma_f32_16x16x32_bf16 v[144:147], a[48:51], v[64:67], v[144:147]
v_mfma_f32_16x16x32_bf16 v[176:179], a[48:51], v[68:71], v[176:179]
v_exp_f32 v35, v35
v_mfma_f32_16x16x32_bf16 v[208:211], a[48:51], v[72:75], v[208:211]
buffer_load_dwordx4 v3, s[48:51], s7 offen offset:1024 sc1 lds
v_mfma_f32_16x16x32_bf16 v[240:243], a[48:51], v[76:79], v[240:243]
ds_read_b128 a[20:23], v1 offset:29696
v_cvt_pk_bf16_f32 v51, v34, v35
v_mfma_f32_16x16x32_bf16 v[244:247], a[52:55], v[76:79], v[244:247]
v_exp_f32 v36, v36
v_mfma_f32_16x16x32_bf16 v[212:215], a[52:55], v[72:75], v[212:215]
v_mfma_f32_16x16x32_bf16 v[180:183], a[52:55], v[68:71], v[180:183]
v_exp_f32 v37, v37
v_mfma_f32_16x16x32_bf16 v[148:151], a[52:55], v[64:67], v[148:151]
ds_read_b128 a[24:27], v1 offset:30720
v_cvt_pk_bf16_f32 v54, v36, v37
v_mfma_f32_16x16x32_bf16 v[152:155], a[56:59], v[64:67], v[152:155]
v_exp_f32 v38, v38
v_mfma_f32_16x16x32_bf16 v[184:187], a[56:59], v[68:71], v[184:187]
v_mfma_f32_16x16x32_bf16 v[216:219], a[56:59], v[72:75], v[216:219]
v_exp_f32 v39, v39
v_mfma_f32_16x16x32_bf16 v[248:251], a[56:59], v[76:79], v[248:251]
ds_read_b128 a[28:31], v1 offset:31744
v_cvt_pk_bf16_f32 v55, v38, v39
v_mfma_f32_16x16x32_bf16 v[252:255], a[60:63], v[76:79], v[252:255]
v_exp_f32 v40, v40
v_mfma_f32_16x16x32_bf16 v[220:223], a[60:63], v[72:75], v[220:223]
v_mfma_f32_16x16x32_bf16 v[188:191], a[60:63], v[68:71], v[188:191]
v_exp_f32 v41, v41
v_mfma_f32_16x16x32_bf16 v[156:159], a[60:63], v[64:67], v[156:159]
buffer_load_dwordx4 v3, s[48:51], s7 offen offset:2048 sc1 lds
v_mfma_f32_16x16x32_bf16 a[224:227], a[240:243], v[64:67], a[224:227]
ds_read_b128 a[32:35], v1 offset:16384
v_cvt_pk_bf16_f32 v58, v40, v41
v_mfma_f32_16x16x32_bf16 a[228:231], a[240:243], v[68:71], a[228:231]
v_exp_f32 v42, v42
v_mfma_f32_16x16x32_bf16 a[232:235], a[240:243], v[72:75], a[232:235]
ds_read_b128 a[36:39], v1 offset:17408
v_mfma_f32_16x16x32_bf16 a[236:239], a[240:243], v[76:79], a[236:239]
s_waitcnt lgkmcnt(6)
v_mfma_f32_16x16x32_bf16 v[16:19], a[0:3], a[160:163], v[96:99]
v_exp_f32 v43, v43
v_mfma_f32_16x16x32_bf16 v[16:19], a[4:7], a[164:167], v[16:19]
v_exp_f32 v44, v44
v_mfma_f32_16x16x32_bf16 v[16:19], a[8:11], a[168:171], v[16:19]
ds_read_b128 a[40:43], v1 offset:18432
v_cvt_pk_bf16_f32 v59, v42, v43
v_mfma_f32_16x16x32_bf16 v[16:19], a[12:15], a[172:175], v[16:19]
v_exp_f32 v45, v45
v_mfma_f32_16x16x32_bf16 v[20:23], a[0:3], a[176:179], v[84:87]
v_cvt_pk_bf16_f32 v62, v44, v45
v_mfma_f32_16x16x32_bf16 v[20:23], a[4:7], a[180:183], v[20:23]
s_mov_b32 s9, 0x400000
v_exp_f32 v46, v46
v_mfma_f32_16x16x32_bf16 v[20:23], a[8:11], a[184:187], v[20:23]
ds_read_b128 a[44:47], v1 offset:19456
v_mfma_f32_16x16x32_bf16 v[20:23], a[12:15], a[188:191], v[20:23]
buffer_load_dword a244, v8, s[64:67], s9 offen
v_mfma_f32_16x16x32_bf16 v[24:27], a[0:3], a[192:195], v[88:91]
v_exp_f32 v47, v47
v_mfma_f32_16x16x32_bf16 v[24:27], a[4:7], a[196:199], v[24:27]
v_cvt_pk_bf16_f32 v63, v46, v47
v_mfma_f32_16x16x32_bf16 v[24:27], a[8:11], a[200:203], v[24:27]
ds_read_b128 a[48:51], v1 offset:20480
v_mfma_f32_16x16x32_bf16 v[24:27], a[12:15], a[204:207], v[24:27]
v_exp_f32 v16, v16
v_mfma_f32_16x16x32_bf16 v[28:31], a[0:3], a[208:211], v[92:95]
v_exp_f32 v17, v17
v_mfma_f32_16x16x32_bf16 v[28:31], a[4:7], a[212:215], v[28:31]
v_cvt_pk_bf16_f32 v64, v16, v17
v_mfma_f32_16x16x32_bf16 v[28:31], a[8:11], a[216:219], v[28:31]
ds_read_b128 a[52:55], v1 offset:21504
v_mfma_f32_16x16x32_bf16 v[28:31], a[12:15], a[220:223], v[28:31]
s_waitcnt lgkmcnt(6)
v_exp_f32 v18, v18
v_mfma_f32_16x16x32_bf16 v[32:35], a[16:19], a[160:163], v[100:103]
v_exp_f32 v19, v19
v_mfma_f32_16x16x32_bf16 v[32:35], a[20:23], a[164:167], v[32:35]
v_cvt_pk_bf16_f32 v65, v18, v19
v_mfma_f32_16x16x32_bf16 v[32:35], a[24:27], a[168:171], v[32:35]
ds_read_b128 a[56:59], v1 offset:22528
v_mfma_f32_16x16x32_bf16 v[32:35], a[28:31], a[172:175], v[32:35]
buffer_load_dwordx4 v3, s[48:51], s7 offen offset:3072 sc1 lds
v_mfma_f32_16x16x32_bf16 v[36:39], a[16:19], a[176:179], v[84:87]
s_add_u32 s32, s32, 0x8000
v_exp_f32 v20, v20
v_mfma_f32_16x16x32_bf16 v[36:39], a[20:23], a[180:183], v[36:39]
s_add_u32 s7, s7, 0x8000
v_exp_f32 v21, v21
v_mfma_f32_16x16x32_bf16 v[36:39], a[24:27], a[184:187], v[36:39]
ds_read_b128 a[60:63], v1 offset:23552
v_xor_b32 v1, 0x8000, v1
v_mfma_f32_16x16x32_bf16 v[36:39], a[28:31], a[188:191], v[36:39]
s_xor_b32 s27, s27, 0x38000
v_cvt_pk_bf16_f32 v68, v20, v21
v_mfma_f32_16x16x32_bf16 v[40:43], a[16:19], a[192:195], v[88:91]
v_exp_f32 v22, v22
v_mfma_f32_16x16x32_bf16 v[40:43], a[20:23], a[196:199], v[40:43]
v_exp_f32 v23, v23
v_mfma_f32_16x16x32_bf16 v[40:43], a[24:27], a[200:203], v[40:43]
v_cvt_pk_bf16_f32 v69, v22, v23
v_mfma_f32_16x16x32_bf16 v[40:43], a[28:31], a[204:207], v[40:43]
v_exp_f32 v24, v24
v_mfma_f32_16x16x32_bf16 v[44:47], a[16:19], a[208:211], v[92:95]
v_exp_f32 v25, v25
v_mfma_f32_16x16x32_bf16 v[44:47], a[20:23], a[212:215], v[44:47]
v_exp_f32 v26, v26
v_mfma_f32_16x16x32_bf16 v[44:47], a[24:27], a[216:219], v[44:47]
s_waitcnt vmcnt(19) lgkmcnt(0)
v_exp_f32 v27, v27
v_mfma_f32_16x16x32_bf16 v[44:47], a[28:31], a[220:223], v[44:47]
s_barrier
L_att_l1_1:
v_mfma_f32_16x16x32_bf16 v[128:131], a[32:35], v[48:51], v[128:131]
ds_read_b128 a[0:3], v2 offset:8192
v_cvt_pk_bf16_f32 v72, v24, v25
v_mfma_f32_16x16x32_bf16 v[160:163], a[32:35], v[52:55], v[160:163]
v_exp_f32 v28, v28
v_mfma_f32_16x16x32_bf16 v[192:195], a[32:35], v[56:59], v[192:195]
s_add_u32 m0, s19, 0x0
v_cvt_pk_bf16_f32 v73, v26, v27
v_mfma_f32_16x16x32_bf16 v[224:227], a[32:35], v[60:63], v[224:227]
ds_read_b128 a[4:7], v2 offset:9216
v_mfma_f32_16x16x32_bf16 v[228:231], a[36:39], v[60:63], v[228:231]
buffer_load_dwordx4 v3, s[48:51], s32 offen offset:0 sc1 lds
v_mfma_f32_16x16x32_bf16 v[196:199], a[36:39], v[56:59], v[196:199]
v_exp_f32 v29, v29
v_mfma_f32_16x16x32_bf16 v[164:167], a[36:39], v[52:55], v[164:167]
ds_read_b128 a[8:11], v2 offset:10240
v_cvt_pk_bf16_f32 v76, v28, v29
v_mfma_f32_16x16x32_bf16 v[132:135], a[36:39], v[48:51], v[132:135]
v_exp_f32 v30, v30
v_mfma_f32_16x16x32_bf16 v[136:139], a[40:43], v[48:51], v[136:139]
v_mfma_f32_16x16x32_bf16 v[168:171], a[40:43], v[52:55], v[168:171]
v_exp_f32 v31, v31
v_mfma_f32_16x16x32_bf16 v[200:203], a[40:43], v[56:59], v[200:203]
ds_read_b128 a[12:15], v2 offset:11264
v_cvt_pk_bf16_f32 v77, v30, v31
v_mfma_f32_16x16x32_bf16 v[232:235], a[40:43], v[60:63], v[232:235]
v_exp_f32 v32, v32
v_mfma_f32_16x16x32_bf16 v[236:239], a[44:47], v[60:63], v[236:239]
s_mov_b32 s9, 0x200000
v_exp_f32 v33, v33
v_mfma_f32_16x16x32_bf16 v[204:207], a[44:47], v[56:59], v[204:207]
ds_read_b128 a[16:19], v2 offset:12288
v_cvt_pk_bf16_f32 v66, v32, v33
v_mfma_f32_16x16x32_bf16 v[172:175], a[44:47], v[52:55], v[172:175]
buffer_load_dword a244, v8, s[64:67], s9 offen
v_mfma_f32_16x16x32_bf16 v[140:143], a[44:47], v[48:51], v[140:143]
v_mfma_f32_16x16x32_bf16 v[144:147], a[48:51], v[48:51], v[144:147]
v_exp_f32 v34, v34
v_mfma_f32_16x16x32_bf16 v[176:179], a[48:51], v[52:55], v[176:179]
ds_read_b128 a[20:23], v2 offset:13312
v_mfma_f32_16x16x32_bf16 v[208:211], a[48:51], v[56:59], v[208:211]
v_exp_f32 v35, v35
v_mfma_f32_16x16x32_bf16 v[240:243], a[48:51], v[60:63], v[240:243]
v_exp_f32 v36, v36
v_mfma_f32_16x16x32_bf16 v[244:247], a[52:55], v[60:63], v[244:247]
ds_read_b128 a[24:27], v2 offset:14336
v_cvt_pk_bf16_f32 v67, v34, v35
v_mfma_f32_16x16x32_bf16 v[212:215], a[52:55], v[56:59], v[212:215]
v_mfma_f32_16x16x32_bf16 v[180:183], a[52:55], v[52:55], v[180:183]
v_exp_f32 v37, v37
v_mfma_f32_16x16x32_bf16 v[148:151], a[52:55], v[48:51], v[148:151]
v_exp_f32 v38, v38
v_mfma_f32_16x16x32_bf16 v[152:155], a[56:59], v[48:51], v[152:155]
buffer_load_dwordx4 v3, s[48:51], s32 offen offset:1024 sc1 lds
v_mfma_f32_16x16x32_bf16 v[184:187], a[56:59], v[52:55], v[184:187]
ds_read_b128 a[28:31], v2 offset:15360
v_cvt_pk_bf16_f32 v70, v36, v37
v_mfma_f32_16x16x32_bf16 v[216:219], a[56:59], v[56:59], v[216:219]
v_exp_f32 v39, v39
v_mfma_f32_16x16x32_bf16 v[248:251], a[56:59], v[60:63], v[248:251]
ds_read_b128 a[32:35], v2 offset:0
v_cvt_pk_bf16_f32 v71, v38, v39
v_mfma_f32_16x16x32_bf16 v[252:255], a[60:63], v[60:63], v[252:255]
v_mfma_f32_16x16x32_bf16 v[220:223], a[60:63], v[56:59], v[220:223]
v_exp_f32 v40, v40
v_mfma_f32_16x16x32_bf16 v[188:191], a[60:63], v[52:55], v[188:191]
ds_read_b128 a[36:39], v2 offset:1024
v_mfma_f32_16x16x32_bf16 v[156:159], a[60:63], v[48:51], v[156:159]
v_exp_f32 v41, v41
v_mfma_f32_16x16x32_bf16 a[224:227], a[240:243], v[48:51], a[224:227]
v_exp_f32 v42, v42
v_mfma_f32_16x16x32_bf16 a[228:231], a[240:243], v[52:55], a[228:231]
buffer_load_dwordx4 v3, s[48:51], s32 offen offset:2048 sc1 lds
v_mfma_f32_16x16x32_bf16 a[232:235], a[240:243], v[56:59], a[232:235]
ds_read_b128 a[40:43], v2 offset:2048
v_cvt_pk_bf16_f32 v74, v40, v41
v_mfma_f32_16x16x32_bf16 a[236:239], a[240:243], v[60:63], a[236:239]
s_waitcnt lgkmcnt(7)
v_mfma_f32_16x16x32_bf16 v[20:23], a[0:3], a[176:179], v[104:107]
v_exp_f32 v43, v43
v_mfma_f32_16x16x32_bf16 v[20:23], a[4:7], a[180:183], v[20:23]
ds_read_b128 a[44:47], v2 offset:3072
v_cvt_pk_bf16_f32 v75, v42, v43
v_mfma_f32_16x16x32_bf16 v[20:23], a[8:11], a[184:187], v[20:23]
v_exp_f32 v44, v44
v_mfma_f32_16x16x32_bf16 v[20:23], a[12:15], a[188:191], v[20:23]
v_mfma_f32_16x16x32_bf16 v[24:27], a[0:3], a[192:195], v[88:91]
v_exp_f32 v45, v45
v_mfma_f32_16x16x32_bf16 v[24:27], a[4:7], a[196:199], v[24:27]
ds_read_b128 a[48:51], v2 offset:4096
v_cvt_pk_bf16_f32 v78, v44, v45
v_mfma_f32_16x16x32_bf16 v[24:27], a[8:11], a[200:203], v[24:27]
v_exp_f32 v46, v46
v_mfma_f32_16x16x32_bf16 v[24:27], a[12:15], a[204:207], v[24:27]
buffer_load_dwordx4 v3, s[48:51], s32 offen offset:3072 sc1 lds
v_mfma_f32_16x16x32_bf16 v[28:31], a[0:3], a[208:211], v[92:95]
ds_read_b128 a[52:55], v2 offset:5120
v_mfma_f32_16x16x32_bf16 v[28:31], a[4:7], a[212:215], v[28:31]
v_exp_f32 v47, v47
v_mfma_f32_16x16x32_bf16 v[28:31], a[8:11], a[216:219], v[28:31]
v_cvt_pk_bf16_f32 v79, v46, v47
v_mfma_f32_16x16x32_bf16 v[28:31], a[12:15], a[220:223], v[28:31]
s_waitcnt lgkmcnt(6)
v_exp_f32 v20, v20
v_mfma_f32_16x16x32_bf16 v[36:39], a[16:19], a[176:179], v[108:111]
ds_read_b128 a[56:59], v2 offset:6144
v_mfma_f32_16x16x32_bf16 v[36:39], a[20:23], a[180:183], v[36:39]
v_exp_f32 v21, v21
v_mfma_f32_16x16x32_bf16 v[36:39], a[24:27], a[184:187], v[36:39]
v_exp_f32 v22, v22
v_mfma_f32_16x16x32_bf16 v[36:39], a[28:31], a[188:191], v[36:39]
ds_read_b128 a[60:63], v2 offset:7168
v_cvt_pk_bf16_f32 v52, v20, v21
v_mfma_f32_16x16x32_bf16 v[40:43], a[16:19], a[192:195], v[88:91]
s_mov_b32 s9, 0x600000
v_mfma_f32_16x16x32_bf16 v[40:43], a[20:23], a[196:199], v[40:43]
buffer_load_dword a244, v8, s[64:67], s9 offen
v_mfma_f32_16x16x32_bf16 v[40:43], a[24:27], a[200:203], v[40:43]
v_exp_f32 v23, v23
v_mfma_f32_16x16x32_bf16 v[40:43], a[28:31], a[204:207], v[40:43]
v_exp_f32 v24, v24
v_mfma_f32_16x16x32_bf16 v[44:47], a[16:19], a[208:211], v[92:95]
v_exp_f32 v25, v25
v_mfma_f32_16x16x32_bf16 v[44:47], a[20:23], a[212:215], v[44:47]
v_exp_f32 v26, v26
v_mfma_f32_16x16x32_bf16 v[44:47], a[24:27], a[216:219], v[44:47]
v_exp_f32 v27, v27
v_mfma_f32_16x16x32_bf16 v[44:47], a[28:31], a[220:223], v[44:47]
s_waitcnt lgkmcnt(0)
v_cvt_pk_bf16_f32 v53, v22, v23
v_mfma_f32_16x16x32_bf16 v[128:131], a[32:35], v[64:67], v[128:131]
ds_read_b128 a[0:3], v2 offset:24576
v_cvt_pk_bf16_f32 v56, v24, v25
v_mfma_f32_16x16x32_bf16 v[160:163], a[32:35], v[68:71], v[160:163]
v_exp_f32 v28, v28
v_mfma_f32_16x16x32_bf16 v[192:195], a[32:35], v[72:75], v[192:195]
ds_read_b128 a[4:7], v2 offset:25600
v_cvt_pk_bf16_f32 v57, v26, v27
v_mfma_f32_16x16x32_bf16 v[224:227], a[32:35], v[76:79], v[224:227]
s_add_u32 m0, s19, 0x1000
v_mfma_f32_16x16x32_bf16 v[228:231], a[36:39], v[76:79], v[228:231]
buffer_load_dwordx4 v3, s[48:51], s7 offen offset:0 sc1 lds
v_mfma_f32_16x16x32_bf16 v[196:199], a[36:39], v[72:75], v[196:199]
ds_read_b128 a[8:11], v2 offset:26624
v_mfma_f32_16x16x32_bf16 v[164:167], a[36:39], v[68:71], v[164:167]
v_exp_f32 v29, v29
v_mfma_f32_16x16x32_bf16 v[132:135], a[36:39], v[64:67], v[132:135]
v_exp_f32 v30, v30
v_mfma_f32_16x16x32_bf16 v[136:139], a[40:43], v[64:67], v[136:139]
ds_read_b128 a[12:15], v2 offset:27648
v_cvt_pk_bf16_f32 v60, v28, v29
v_mfma_f32_16x16x32_bf16 v[168:171], a[40:43], v[68:71], v[168:171]
v_exp_f32 v31, v31
v_mfma_f32_16x16x32_bf16 v[200:203], a[40:43], v[72:75], v[200:203]
v_cvt_pk_bf16_f32 v61, v30, v31
v_mfma_f32_16x16x32_bf16 v[232:235], a[40:43], v[76:79], v[232:235]
ds_read_b128 a[16:19], v2 offset:28672
v_mfma_f32_16x16x32_bf16 v[236:239], a[44:47], v[76:79], v[236:239]
v_exp_f32 v36, v36
v_mfma_f32_16x16x32_bf16 v[204:207], a[44:47], v[72:75], v[204:207]
buffer_load_dwordx4 v3, s[48:51], s7 offen offset:1024 sc1 lds
v_mfma_f32_16x16x32_bf16 v[172:175], a[44:47], v[68:71], v[172:175]
ds_read_b128 a[20:23], v2 offset:29696
v_mfma_f32_16x16x32_bf16 v[140:143], a[44:47], v[64:67], v[140:143]
v_exp_f32 v37, v37
v_mfma_f32_16x16x32_bf16 v[144:147], a[48:51], v[64:67], v[144:147]
v_exp_f32 v38, v38
v_mfma_f32_16x16x32_bf16 v[176:179], a[48:51], v[68:71], v[176:179]
ds_read_b128 a[24:27], v2 offset:30720
v_cvt_pk_bf16_f32 v54, v36, v37
v_mfma_f32_16x16x32_bf16 v[208:211], a[48:51], v[72:75], v[208:211]
v_mfma_f32_16x16x32_bf16 v[240:243], a[48:51], v[76:79], v[240:243]
v_exp_f32 v39, v39
v_mfma_f32_16x16x32_bf16 v[244:247], a[52:55], v[76:79], v[244:247]
ds_read_b128 a[28:31], v2 offset:31744
v_cvt_pk_bf16_f32 v55, v38, v39
v_mfma_f32_16x16x32_bf16 v[212:215], a[52:55], v[72:75], v[212:215]
v_exp_f32 v40, v40
v_mfma_f32_16x16x32_bf16 v[180:183], a[52:55], v[68:71], v[180:183]
buffer_load_dwordx4 v3, s[48:51], s7 offen offset:2048 sc1 lds
v_mfma_f32_16x16x32_bf16 v[148:151], a[52:55], v[64:67], v[148:151]
ds_read_b128 a[32:35], v2 offset:16384
v_mfma_f32_16x16x32_bf16 v[152:155], a[56:59], v[64:67], v[152:155]
v_exp_f32 v41, v41
v_mfma_f32_16x16x32_bf16 v[184:187], a[56:59], v[68:71], v[184:187]
ds_read_b128 a[36:39], v2 offset:17408
v_cvt_pk_bf16_f32 v58, v40, v41
v_mfma_f32_16x16x32_bf16 v[216:219], a[56:59], v[72:75], v[216:219]
v_mfma_f32_16x16x32_bf16 v[248:251], a[56:59], v[76:79], v[248:251]
v_exp_f32 v42, v42
v_mfma_f32_16x16x32_bf16 v[252:255], a[60:63], v[76:79], v[252:255]
ds_read_b128 a[40:43], v2 offset:18432
v_mfma_f32_16x16x32_bf16 v[220:223], a[60:63], v[72:75], v[220:223]
v_exp_f32 v43, v43
v_mfma_f32_16x16x32_bf16 v[188:191], a[60:63], v[68:71], v[188:191]
buffer_load_dwordx4 v3, s[48:51], s7 offen offset:3072 sc1 lds
v_mfma_f32_16x16x32_bf16 v[156:159], a[60:63], v[64:67], v[156:159]
ds_read_b128 a[44:47], v2 offset:19456
v_cvt_pk_bf16_f32 v59, v42, v43
v_mfma_f32_16x16x32_bf16 a[224:227], a[240:243], v[64:67], a[224:227]
v_exp_f32 v44, v44
v_mfma_f32_16x16x32_bf16 a[228:231], a[240:243], v[68:71], a[228:231]
v_mfma_f32_16x16x32_bf16 a[232:235], a[240:243], v[72:75], a[232:235]
ds_read_b128 a[48:51], v2 offset:20480
v_add_u32 v4, s0, v3
v_mfma_f32_16x16x32_bf16 a[236:239], a[240:243], v[76:79], a[236:239]
s_waitcnt lgkmcnt(9)
v_exp_f32 v45, v45
v_mfma_f32_16x16x32_bf16 v[24:27], a[0:3], a[192:195], v[88:91]
v_exp_f32 v46, v46
v_mfma_f32_16x16x32_bf16 v[24:27], a[4:7], a[196:199], v[24:27]
ds_read_b128 a[52:55], v2 offset:21504
v_mov_b32 v5, s1
v_mfma_f32_16x16x32_bf16 v[24:27], a[8:11], a[200:203], v[24:27]
v_exp_f32 v47, v47
v_mfma_f32_16x16x32_bf16 v[24:27], a[12:15], a[204:207], v[24:27]
global_load_dword a244, v[4:5], off sc1
v_mfma_f32_16x16x32_bf16 v[28:31], a[0:3], a[208:211], v[92:95]
ds_read_b128 a[56:59], v2 offset:22528
v_cvt_pk_bf16_f32 v62, v44, v45
v_mfma_f32_16x16x32_bf16 v[28:31], a[4:7], a[212:215], v[28:31]
s_add_u32 s32, s32, 0x8000
v_cvt_pk_bf16_f32 v63, v46, v47
v_mfma_f32_16x16x32_bf16 v[28:31], a[8:11], a[216:219], v[28:31]
s_waitcnt lgkmcnt(7)
v_mfma_f32_16x16x32_bf16 v[28:31], a[12:15], a[220:223], v[28:31]
ds_read_b128 a[60:63], v2 offset:23552
s_add_u32 s7, s7, 0x8000
v_mfma_f32_16x16x32_bf16 v[40:43], a[16:19], a[192:195], v[88:91]
s_xor_b32 s19, s19, 0x8000
v_xor_b32 v2, 0x38000, v2
v_mfma_f32_16x16x32_bf16 v[40:43], a[20:23], a[196:199], v[40:43]
s_sub_u32 s15, 7, s6
v_exp_f32 v24, v24
v_mfma_f32_16x16x32_bf16 v[40:43], a[24:27], a[200:203], v[40:43]
s_lshl_b32 s15, s15, 1
v_exp_f32 v25, v25
v_mfma_f32_16x16x32_bf16 v[40:43], a[28:31], a[204:207], v[40:43]
v_exp_f32 v26, v26
v_mfma_f32_16x16x32_bf16 v[44:47], a[16:19], a[208:211], v[92:95]
v_exp_f32 v27, v27
v_mfma_f32_16x16x32_bf16 v[44:47], a[20:23], a[212:215], v[44:47]
v_exp_f32 v28, v28
v_mfma_f32_16x16x32_bf16 v[44:47], a[24:27], a[216:219], v[44:47]
s_waitcnt vmcnt(22) lgkmcnt(0)
v_exp_f32 v29, v29
v_mfma_f32_16x16x32_bf16 v[44:47], a[28:31], a[220:223], v[44:47]
s_barrier
s_cbranch_scc0 L_att_lh0_1
s_cmp_lg_u32 s33, 0
s_cbranch_scc1 L_sig_bs1
s_lshl_b32 s8, s6, 2
s_add_u32 s8, s8, 192
s_cmp_lg_u32 s4, 0
s_cbranch_scc1 L_sig_bs1
v_mov_b32 v4, 1
s_mov_b64 exec, 1
buffer_atomic_add v4, off, s[84:87], s8 sc1
s_mov_b64 exec, -1
L_sig_bs1:
v_mfma_f32_16x16x32_bf16 v[160:163], a[32:35], v[52:55], v[160:163]
ds_read_b128 a[0:3], v1 offset:8192
v_cvt_pk_bf16_f32 v72, v24, v25
v_mfma_f32_16x16x32_bf16 v[192:195], a[32:35], v[56:59], v[192:195]
v_exp_f32 v30, v30
v_mfma_f32_16x16x32_bf16 v[224:227], a[32:35], v[60:63], v[224:227]
ds_read_b128 a[4:7], v1 offset:9216
v_cvt_pk_bf16_f32 v73, v26, v27
v_mfma_f32_16x16x32_bf16 v[228:231], a[36:39], v[60:63], v[228:231]
s_add_u32 m0, s27, 0x0
v_cvt_pk_bf16_f32 v76, v28, v29
v_mfma_f32_16x16x32_bf16 v[196:199], a[36:39], v[56:59], v[196:199]
ds_read_b128 a[8:11], v1 offset:10240
v_mfma_f32_16x16x32_bf16 v[164:167], a[36:39], v[52:55], v[164:167]
buffer_load_dwordx4 v3, s[48:51], s32 offen offset:0 sc1 lds
v_mfma_f32_16x16x32_bf16 v[168:171], a[40:43], v[52:55], v[168:171]
v_exp_f32 v31, v31
v_mfma_f32_16x16x32_bf16 v[200:203], a[40:43], v[56:59], v[200:203]
ds_read_b128 a[12:15], v1 offset:11264
v_cvt_pk_bf16_f32 v77, v30, v31
v_mfma_f32_16x16x32_bf16 v[232:235], a[40:43], v[60:63], v[232:235]
v_exp_f32 v40, v40
v_mfma_f32_16x16x32_bf16 v[236:239], a[44:47], v[60:63], v[236:239]
ds_read_b128 a[16:19], v1 offset:12288
v_mfma_f32_16x16x32_bf16 v[204:207], a[44:47], v[56:59], v[204:207]
v_mfma_f32_16x16x32_bf16 v[172:175], a[44:47], v[52:55], v[172:175]
ds_read_b128 a[20:23], v1 offset:13312
v_mfma_f32_16x16x32_bf16 v[176:179], a[48:51], v[52:55], v[176:179]
v_exp_f32 v41, v41
v_mfma_f32_16x16x32_bf16 v[208:211], a[48:51], v[56:59], v[208:211]
v_exp_f32 v42, v42
v_mfma_f32_16x16x32_bf16 v[240:243], a[48:51], v[60:63], v[240:243]
ds_read_b128 a[24:27], v1 offset:14336
v_cvt_pk_bf16_f32 v74, v40, v41
v_mfma_f32_16x16x32_bf16 v[244:247], a[52:55], v[60:63], v[244:247]
buffer_load_dwordx4 v3, s[48:51], s32 offen offset:1024 sc1 lds
v_mfma_f32_16x16x32_bf16 v[212:215], a[52:55], v[56:59], v[212:215]
ds_read_b128 a[28:31], v1 offset:15360
v_mfma_f32_16x16x32_bf16 v[180:183], a[52:55], v[52:55], v[180:183]
v_mfma_f32_16x16x32_bf16 v[184:187], a[56:59], v[52:55], v[184:187]
v_exp_f32 v43, v43
v_mfma_f32_16x16x32_bf16 v[216:219], a[56:59], v[56:59], v[216:219]
ds_read_b128 a[32:35], v1 offset:0
v_cvt_pk_bf16_f32 v75, v42, v43
v_mfma_f32_16x16x32_bf16 v[248:251], a[56:59], v[60:63], v[248:251]
v_exp_f32 v44, v44
v_mfma_f32_16x16x32_bf16 v[252:255], a[60:63], v[60:63], v[252:255]
ds_read_b128 a[36:39], v1 offset:1024
v_mfma_f32_16x16x32_bf16 v[220:223], a[60:63], v[56:59], v[220:223]
v_mfma_f32_16x16x32_bf16 v[188:191], a[60:63], v[52:55], v[188:191]
ds_read_b128 a[40:43], v1 offset:2048
v_mfma_f32_16x16x32_bf16 a[228:231], a[240:243], v[52:55], a[228:231]
s_waitcnt lgkmcnt(7)
v_exp_f32 v45, v45
v_mfma_f32_16x16x32_bf16 a[232:235], a[240:243], v[56:59], a[232:235]
buffer_load_dwordx4 v3, s[48:51], s32 offen offset:2048 sc1 lds
v_mfma_f32_16x16x32_bf16 a[236:239], a[240:243], v[60:63], a[236:239]
ds_read_b128 a[44:47], v1 offset:3072
v_cvt_pk_bf16_f32 v78, v44, v45
v_mfma_f32_16x16x32_bf16 v[24:27], a[0:3], a[192:195], v[88:91]
v_exp_f32 v46, v46
v_mfma_f32_16x16x32_bf16 v[24:27], a[4:7], a[196:199], v[24:27]
ds_read_b128 a[48:51], v1 offset:4096
v_mfma_f32_16x16x32_bf16 v[24:27], a[8:11], a[200:203], v[24:27]
v_exp_f32 v47, v47
v_mfma_f32_16x16x32_bf16 v[24:27], a[12:15], a[204:207], v[24:27]
ds_read_b128 a[52:55], v1 offset:5120
v_cvt_pk_bf16_f32 v79, v46, v47
v_mfma_f32_16x16x32_bf16 v[28:31], a[0:3], a[208:211], v[92:95]
v_mfma_f32_16x16x32_bf16 v[28:31], a[4:7], a[212:215], v[28:31]
v_mfma_f32_16x16x32_bf16 v[28:31], a[8:11], a[216:219], v[28:31]
ds_read_b128 a[56:59], v1 offset:6144
v_mfma_f32_16x16x32_bf16 v[28:31], a[12:15], a[220:223], v[28:31]
s_waitcnt lgkmcnt(7)
v_exp_f32 v24, v24
v_mfma_f32_16x16x32_bf16 v[40:43], a[16:19], a[192:195], v[88:91]
buffer_load_dwordx4 v3, s[48:51], s32 offen offset:3072 sc1 lds
v_mfma_f32_16x16x32_bf16 v[40:43], a[20:23], a[196:199], v[40:43]
ds_read_b128 a[60:63], v1 offset:7168
v_mfma_f32_16x16x32_bf16 v[40:43], a[24:27], a[200:203], v[40:43]
s_add_u32 s32, s32, 0x8000
v_exp_f32 v25, v25
v_mfma_f32_16x16x32_bf16 v[40:43], a[28:31], a[204:207], v[40:43]
v_exp_f32 v26, v26
v_mfma_f32_16x16x32_bf16 v[44:47], a[16:19], a[208:211], v[92:95]
v_exp_f32 v27, v27
v_mfma_f32_16x16x32_bf16 v[44:47], a[20:23], a[212:215], v[44:47]
v_exp_f32 v28, v28
v_mfma_f32_16x16x32_bf16 v[44:47], a[24:27], a[216:219], v[44:47]
v_exp_f32 v29, v29
v_mfma_f32_16x16x32_bf16 v[44:47], a[28:31], a[220:223], v[44:47]
s_waitcnt lgkmcnt(0)
v_mfma_f32_16x16x32_bf16 v[192:195], a[32:35], v[72:75], v[192:195]
v_exp_f32 v30, v30
v_mfma_f32_16x16x32_bf16 v[224:227], a[32:35], v[76:79], v[224:227]
v_exp_f32 v31, v31
v_mfma_f32_16x16x32_bf16 v[228:231], a[36:39], v[76:79], v[228:231]
s_add_u32 m0, s27, 0x1000
v_exp_f32 v40, v40
v_mfma_f32_16x16x32_bf16 v[196:199], a[36:39], v[72:75], v[196:199]
buffer_load_dwordx4 v3, s[48:51], s7 offen offset:0 sc1 lds
v_mfma_f32_16x16x32_bf16 v[200:203], a[40:43], v[72:75], v[200:203]
ds_read_b128 a[0:3], v1 offset:24576
v_cvt_pk_bf16_f32 v56, v24, v25
v_mfma_f32_16x16x32_bf16 v[232:235], a[40:43], v[76:79], v[232:235]
ds_read_b128 a[4:7], v1 offset:25600
v_cvt_pk_bf16_f32 v57, v26, v27
v_mfma_f32_16x16x32_bf16 v[236:239], a[44:47], v[76:79], v[236:239]
v_exp_f32 v41, v41
v_mfma_f32_16x16x32_bf16 v[204:207], a[44:47], v[72:75], v[204:207]
v_exp_f32 v42, v42
v_mfma_f32_16x16x32_bf16 v[208:211], a[48:51], v[72:75], v[208:211]
ds_read_b128 a[8:11], v1 offset:26624
v_cvt_pk_bf16_f32 v60, v28, v29
v_mfma_f32_16x16x32_bf16 v[240:243], a[48:51], v[76:79], v[240:243]
ds_read_b128 a[12:15], v1 offset:27648
v_cvt_pk_bf16_f32 v61, v30, v31
v_mfma_f32_16x16x32_bf16 v[244:247], a[52:55], v[76:79], v[244:247]
buffer_load_dwordx4 v3, s[48:51], s7 offen offset:1024 sc1 lds
v_mfma_f32_16x16x32_bf16 v[212:215], a[52:55], v[72:75], v[212:215]
ds_read_b128 a[16:19], v1 offset:28672
v_cvt_pk_bf16_f32 v58, v40, v41
v_mfma_f32_16x16x32_bf16 v[216:219], a[56:59], v[72:75], v[216:219]
ds_read_b128 a[20:23], v1 offset:29696
v_mfma_f32_16x16x32_bf16 v[248:251], a[56:59], v[76:79], v[248:251]
ds_read_b128 a[24:27], v1 offset:30720
v_mfma_f32_16x16x32_bf16 v[252:255], a[60:63], v[76:79], v[252:255]
ds_read_b128 a[28:31], v1 offset:31744
v_exp_f32 v43, v43
v_mfma_f32_16x16x32_bf16 v[220:223], a[60:63], v[72:75], v[220:223]
ds_read_b128 a[32:35], v1 offset:16384
v_exp_f32 v44, v44
v_mfma_f32_16x16x32_bf16 a[232:235], a[240:243], v[72:75], a[232:235]
s_waitcnt lgkmcnt(5)
v_exp_f32 v45, v45
v_mfma_f32_16x16x32_bf16 a[236:239], a[240:243], v[76:79], a[236:239]
ds_read_b128 a[36:39], v1 offset:17408
v_cvt_pk_bf16_f32 v59, v42, v43
v_mfma_f32_16x16x32_bf16 v[24:27], a[0:3], a[192:195], v[88:91]
v_exp_f32 v46, v46
v_mfma_f32_16x16x32_bf16 v[24:27], a[4:7], a[196:199], v[24:27]
v_exp_f32 v47, v47
v_mfma_f32_16x16x32_bf16 v[24:27], a[8:11], a[200:203], v[24:27]
buffer_load_dwordx4 v3, s[48:51], s7 offen offset:2048 sc1 lds
v_mfma_f32_16x16x32_bf16 v[24:27], a[12:15], a[204:207], v[24:27]
ds_read_b128 a[40:43], v1 offset:18432
v_cvt_pk_bf16_f32 v62, v44, v45
v_mfma_f32_16x16x32_bf16 v[28:31], a[0:3], a[208:211], v[92:95]
ds_read_b128 a[44:47], v1 offset:19456
v_cvt_pk_bf16_f32 v63, v46, v47
v_mfma_f32_16x16x32_bf16 v[28:31], a[4:7], a[212:215], v[28:31]
buffer_load_dwordx4 v3, s[48:51], s7 offen offset:3072 sc1 lds
v_mfma_f32_16x16x32_bf16 v[28:31], a[8:11], a[216:219], v[28:31]
ds_read_b128 a[48:51], v1 offset:20480
s_add_u32 s7, s7, 0x8000
v_mfma_f32_16x16x32_bf16 v[28:31], a[12:15], a[220:223], v[28:31]
ds_read_b128 a[52:55], v1 offset:21504
s_waitcnt lgkmcnt(6)
v_mfma_f32_16x16x32_bf16 v[40:43], a[16:19], a[192:195], v[88:91]
ds_read_b128 a[56:59], v1 offset:22528
s_xor_b32 s27, s27, 0x38000
v_mfma_f32_16x16x32_bf16 v[40:43], a[20:23], a[196:199], v[40:43]
ds_read_b128 a[60:63], v1 offset:23552
v_xor_b32 v1, 0x8000, v1
v_mfma_f32_16x16x32_bf16 v[40:43], a[24:27], a[200:203], v[40:43]
v_exp_f32 v24, v24
v_mfma_f32_16x16x32_bf16 v[40:43], a[28:31], a[204:207], v[40:43]
v_exp_f32 v25, v25
v_mfma_f32_16x16x32_bf16 v[44:47], a[16:19], a[208:211], v[92:95]
v_exp_f32 v26, v26
v_mfma_f32_16x16x32_bf16 v[44:47], a[20:23], a[212:215], v[44:47]
v_exp_f32 v27, v27
v_mfma_f32_16x16x32_bf16 v[44:47], a[24:27], a[216:219], v[44:47]
s_waitcnt vmcnt(19) lgkmcnt(0)
v_exp_f32 v28, v28
v_mfma_f32_16x16x32_bf16 v[44:47], a[28:31], a[220:223], v[44:47]
s_barrier
v_exp_f32 v29, v29
s_nop 7
v_accvgpr_read_b32 v4, a224
v_accvgpr_read_b32 v6, a228
s_mov_b32 s8, 0x5f800000
v_cmp_nge_f32 s[36:37], s8, v4
v_cmp_nge_f32 s[38:39], s8, v6
v_rcp_f32 v4, v4
v_rcp_f32 v6, v6
s_or_b64 s[34:35], s[34:35], s[36:37]
s_or_b64 s[34:35], s[34:35], s[38:39]
v_pk_mul_f32 v[128:129], v[128:129], v[4:5] op_sel_hi:[1,0]
v_pk_mul_f32 v[130:131], v[130:131], v[4:5] op_sel_hi:[1,0]
v_pk_mul_f32 v[132:133], v[132:133], v[4:5] op_sel_hi:[1,0]
v_pk_mul_f32 v[134:135], v[134:135], v[4:5] op_sel_hi:[1,0]
v_cvt_pk_bf16_f32 v128, v128, v129
v_cvt_pk_bf16_f32 v129, v130, v131
v_cvt_pk_bf16_f32 v130, v132, v133
v_cvt_pk_bf16_f32 v131, v134, v135
s_add_u32 s8, s28, 0x0
buffer_store_dwordx4 v[128:131], v3, s[88:91], s8 offen sc1
v_pk_mul_f32 v[136:137], v[136:137], v[4:5] op_sel_hi:[1,0]
v_pk_mul_f32 v[138:139], v[138:139], v[4:5] op_sel_hi:[1,0]
v_pk_mul_f32 v[140:141], v[140:141], v[4:5] op_sel_hi:[1,0]
v_pk_mul_f32 v[142:143], v[142:143], v[4:5] op_sel_hi:[1,0]
v_cvt_pk_bf16_f32 v136, v136, v137
v_cvt_pk_bf16_f32 v137, v138, v139
v_cvt_pk_bf16_f32 v138, v140, v141
v_cvt_pk_bf16_f32 v139, v142, v143
s_add_u32 s8, s28, 0x2000
buffer_store_dwordx4 v[136:139], v3, s[88:91], s8 offen sc1
v_pk_mul_f32 v[144:145], v[144:145], v[4:5] op_sel_hi:[1,0]
v_pk_mul_f32 v[146:147], v[146:147], v[4:5] op_sel_hi:[1,0]
v_pk_mul_f32 v[148:149], v[148:149], v[4:5] op_sel_hi:[1,0]
v_pk_mul_f32 v[150:151], v[150:151], v[4:5] op_sel_hi:[1,0]
v_cvt_pk_bf16_f32 v144, v144, v145
v_cvt_pk_bf16_f32 v145, v146, v147
v_cvt_pk_bf16_f32 v146, v148, v149
v_cvt_pk_bf16_f32 v147, v150, v151
s_add_u32 s8, s28, 0x4000
buffer_store_dwordx4 v[144:147], v3, s[88:91], s8 offen sc1
v_pk_mul_f32 v[152:153], v[152:153], v[4:5] op_sel_hi:[1,0]
v_pk_mul_f32 v[154:155], v[154:155], v[4:5] op_sel_hi:[1,0]
v_pk_mul_f32 v[156:157], v[156:157], v[4:5] op_sel_hi:[1,0]
v_pk_mul_f32 v[158:159], v[158:159], v[4:5] op_sel_hi:[1,0]
v_cvt_pk_bf16_f32 v152, v152, v153
v_cvt_pk_bf16_f32 v153, v154, v155
v_cvt_pk_bf16_f32 v154, v156, v157
v_cvt_pk_bf16_f32 v155, v158, v159
s_add_u32 s8, s28, 0x6000
buffer_store_dwordx4 v[152:155], v3, s[88:91], s8 offen sc1
v_pk_mul_f32 v[160:161], v[160:161], v[6:7] op_sel_hi:[1,0]
v_pk_mul_f32 v[162:163], v[162:163], v[6:7] op_sel_hi:[1,0]
v_pk_mul_f32 v[164:165], v[164:165], v[6:7] op_sel_hi:[1,0]
v_pk_mul_f32 v[166:167], v[166:167], v[6:7] op_sel_hi:[1,0]
v_cvt_pk_bf16_f32 v160, v160, v161
v_cvt_pk_bf16_f32 v161, v162, v163
v_cvt_pk_bf16_f32 v162, v164, v165
v_cvt_pk_bf16_f32 v163, v166, v167
s_add_u32 s8, s29, 0x0
buffer_store_dwordx4 v[160:163], v3, s[88:91], s8 offen sc1
v_pk_mul_f32 v[168:169], v[168:169], v[6:7] op_sel_hi:[1,0]
v_pk_mul_f32 v[170:171], v[170:171], v[6:7] op_sel_hi:[1,0]
v_pk_mul_f32 v[172:173], v[172:173], v[6:7] op_sel_hi:[1,0]
v_pk_mul_f32 v[174:175], v[174:175], v[6:7] op_sel_hi:[1,0]
v_cvt_pk_bf16_f32 v168, v168, v169
v_cvt_pk_bf16_f32 v169, v170, v171
v_cvt_pk_bf16_f32 v170, v172, v173
v_cvt_pk_bf16_f32 v171, v174, v175
s_add_u32 s8, s29, 0x2000
buffer_store_dwordx4 v[168:171], v3, s[88:91], s8 offen sc1
v_pk_mul_f32 v[176:177], v[176:177], v[6:7] op_sel_hi:[1,0]
v_pk_mul_f32 v[178:179], v[178:179], v[6:7] op_sel_hi:[1,0]
v_pk_mul_f32 v[180:181], v[180:181], v[6:7] op_sel_hi:[1,0]
v_pk_mul_f32 v[182:183], v[182:183], v[6:7] op_sel_hi:[1,0]
v_cvt_pk_bf16_f32 v176, v176, v177
v_cvt_pk_bf16_f32 v177, v178, v179
v_cvt_pk_bf16_f32 v178, v180, v181
v_cvt_pk_bf16_f32 v179, v182, v183
s_add_u32 s8, s29, 0x4000
buffer_store_dwordx4 v[176:179], v3, s[88:91], s8 offen sc1
v_pk_mul_f32 v[184:185], v[184:185], v[6:7] op_sel_hi:[1,0]
v_pk_mul_f32 v[186:187], v[186:187], v[6:7] op_sel_hi:[1,0]
v_pk_mul_f32 v[188:189], v[188:189], v[6:7] op_sel_hi:[1,0]
v_pk_mul_f32 v[190:191], v[190:191], v[6:7] op_sel_hi:[1,0]
v_cvt_pk_bf16_f32 v184, v184, v185
v_cvt_pk_bf16_f32 v185, v186, v187
v_cvt_pk_bf16_f32 v186, v188, v189
v_cvt_pk_bf16_f32 v187, v190, v191
s_add_u32 s8, s29, 0x6000
buffer_store_dwordx4 v[184:187], v3, s[88:91], s8 offen sc1
s_branch L_att_sodd
L_att_lh0_1:
s_cmp_lg_u32 s33, 0
s_cbranch_scc1 L_sig_bh1
s_lshl_b32 s8, s6, 2
s_add_u32 s8, s8, 192
s_cmp_lg_u32 s4, 0
s_cbranch_scc1 L_sig_bh1
v_mov_b32 v4, 1
s_mov_b64 exec, 1
buffer_atomic_add v4, off, s[84:87], s8 sc1
s_mov_b64 exec, -1
L_sig_bh1:
v_mfma_f32_16x16x32_bf16 v[160:163], a[32:35], v[52:55], v[160:163]
ds_read_b128 a[0:3], v1 offset:8192
v_cvt_pk_bf16_f32 v72, v24, v25
v_mfma_f32_16x16x32_bf16 v[192:195], a[32:35], v[56:59], v[192:195]
v_exp_f32 v30, v30
v_mfma_f32_16x16x32_bf16 v[224:227], a[32:35], v[60:63], v[224:227]
buffer_load_dword v14, v15, s[84:87], 0 offen offset:192 sc1
v_mfma_f32_16x16x32_bf16 v[228:231], a[36:39], v[60:63], v[228:231]
ds_read_b128 a[4:7], v1 offset:9216
v_cvt_pk_bf16_f32 v73, v26, v27
v_mfma_f32_16x16x32_bf16 v[196:199], a[36:39], v[56:59], v[196:199]
ds_read_b128 a[8:11], v1 offset:10240
v_cvt_pk_bf16_f32 v76, v28, v29
v_mfma_f32_16x16x32_bf16 v[164:167], a[36:39], v[52:55], v[164:167]
s_add_u32 m0, s17, 0x10000
v_mfma_f32_16x16x32_bf16 v[168:171], a[40:43], v[52:55], v[168:171]
buffer_load_dwordx4 v12, s[72:75], 0 offen lds
v_mfma_f32_16x16x32_bf16 v[200:203], a[40:43], v[56:59], v[200:203]
ds_read_b128 a[12:15], v1 offset:11264
v_mfma_f32_16x16x32_bf16 v[232:235], a[40:43], v[60:63], v[232:235]
v_exp_f32 v31, v31
v_mfma_f32_16x16x32_bf16 v[236:239], a[44:47], v[60:63], v[236:239]
ds_read_b128 a[16:19], v1 offset:12288
v_cvt_pk_bf16_f32 v77, v30, v31
v_mfma_f32_16x16x32_bf16 v[204:207], a[44:47], v[56:59], v[204:207]
v_exp_f32 v40, v40
v_mfma_f32_16x16x32_bf16 v[172:175], a[44:47], v[52:55], v[172:175]
buffer_load_dwordx4 v13, s[72:75], 0 offen offset:1024 lds
v_mfma_f32_16x16x32_bf16 v[176:179], a[48:51], v[52:55], v[176:179]
ds_read_b128 a[20:23], v1 offset:13312
v_mfma_f32_16x16x32_bf16 v[208:211], a[48:51], v[56:59], v[208:211]
v_exp_f32 v41, v41
v_mfma_f32_16x16x32_bf16 v[240:243], a[48:51], v[60:63], v[240:243]
ds_read_b128 a[24:27], v1 offset:14336
v_cvt_pk_bf16_f32 v74, v40, v41
v_mfma_f32_16x16x32_bf16 v[244:247], a[52:55], v[60:63], v[244:247]
buffer_load_dwordx4 v12, s[72:75], s12 offen offset:2048 lds
v_mfma_f32_16x16x32_bf16 v[212:215], a[52:55], v[56:59], v[212:215]
ds_read_b128 a[28:31], v1 offset:15360
v_mfma_f32_16x16x32_bf16 v[180:183], a[52:55], v[52:55], v[180:183]
v_exp_f32 v42, v42
v_mfma_f32_16x16x32_bf16 v[184:187], a[56:59], v[52:55], v[184:187]
v_exp_f32 v43, v43
v_mfma_f32_16x16x32_bf16 v[216:219], a[56:59], v[56:59], v[216:219]
ds_read_b128 a[32:35], v1 offset:0
v_cvt_pk_bf16_f32 v75, v42, v43
v_mfma_f32_16x16x32_bf16 v[248:251], a[56:59], v[60:63], v[248:251]
buffer_load_dwordx4 v13, s[72:75], s12 offen offset:3072 lds
v_mfma_f32_16x16x32_bf16 v[252:255], a[60:63], v[60:63], v[252:255]
ds_read_b128 a[36:39], v1 offset:1024
v_mfma_f32_16x16x32_bf16 v[220:223], a[60:63], v[56:59], v[220:223]
v_exp_f32 v44, v44
v_mfma_f32_16x16x32_bf16 v[188:191], a[60:63], v[52:55], v[188:191]
ds_read_b128 a[40:43], v1 offset:2048
v_add_u32 v12, 0x20000, v12
v_mfma_f32_16x16x32_bf16 a[228:231], a[240:243], v[52:55], a[228:231]
s_add_u32 m0, s17, 0x14000
v_exp_f32 v45, v45
v_mfma_f32_16x16x32_bf16 a[232:235], a[240:243], v[56:59], a[232:235]
buffer_load_dwordx4 v12, s[72:75], 0 offen lds
v_mfma_f32_16x16x32_bf16 a[236:239], a[240:243], v[60:63], a[236:239]
ds_read_b128 a[44:47], v1 offset:3072
s_waitcnt lgkmcnt(8)
v_mfma_f32_16x16x32_bf16 v[24:27], a[0:3], a[192:195], v[88:91]
v_exp_f32 v46, v46
v_mfma_f32_16x16x32_bf16 v[24:27], a[4:7], a[196:199], v[24:27]
ds_read_b128 a[48:51], v1 offset:4096
v_add_u32 v13, 0x20000, v13
v_mfma_f32_16x16x32_bf16 v[24:27], a[8:11], a[200:203], v[24:27]
buffer_load_dwordx4 v13, s[72:75], 0 offen offset:1024 lds
v_mfma_f32_16x16x32_bf16 v[24:27], a[12:15], a[204:207], v[24:27]
ds_read_b128 a[52:55], v1 offset:5120
v_cvt_pk_bf16_f32 v78, v44, v45
v_mfma_f32_16x16x32_bf16 v[28:31], a[0:3], a[208:211], v[92:95]
v_exp_f32 v47, v47
v_mfma_f32_16x16x32_bf16 v[28:31], a[4:7], a[212:215], v[28:31]
s_waitcnt lgkmcnt(6)
v_cvt_pk_bf16_f32 v79, v46, v47
v_mfma_f32_16x16x32_bf16 v[28:31], a[8:11], a[216:219], v[28:31]
ds_read_b128 a[56:59], v1 offset:6144
v_mfma_f32_16x16x32_bf16 v[28:31], a[12:15], a[220:223], v[28:31]
buffer_load_dwordx4 v12, s[72:75], s12 offen offset:2048 lds
v_mfma_f32_16x16x32_bf16 v[40:43], a[16:19], a[192:195], v[88:91]
ds_read_b128 a[60:63], v1 offset:7168
v_mfma_f32_16x16x32_bf16 v[40:43], a[20:23], a[196:199], v[40:43]
v_exp_f32 v24, v24
v_mfma_f32_16x16x32_bf16 v[40:43], a[24:27], a[200:203], v[40:43]
v_exp_f32 v25, v25
v_mfma_f32_16x16x32_bf16 v[40:43], a[28:31], a[204:207], v[40:43]
buffer_load_dwordx4 v13, s[72:75], s12 offen offset:3072 lds
v_mfma_f32_16x16x32_bf16 v[44:47], a[16:19], a[208:211], v[92:95]
v_exp_f32 v26, v26
v_mfma_f32_16x16x32_bf16 v[44:47], a[20:23], a[212:215], v[44:47]
v_exp_f32 v27, v27
v_mfma_f32_16x16x32_bf16 v[44:47], a[24:27], a[216:219], v[44:47]
v_exp_f32 v28, v28
v_mfma_f32_16x16x32_bf16 v[44:47], a[28:31], a[220:223], v[44:47]
s_waitcnt lgkmcnt(0)
v_exp_f32 v29, v29
v_mfma_f32_16x16x32_bf16 v[192:195], a[32:35], v[72:75], v[192:195]
v_exp_f32 v30, v30
v_mfma_f32_16x16x32_bf16 v[224:227], a[32:35], v[76:79], v[224:227]
s_add_u32 m0, s16, 0x0
v_exp_f32 v31, v31
v_mfma_f32_16x16x32_bf16 v[228:231], a[36:39], v[76:79], v[228:231]
ds_read_b128 a[0:3], v1 offset:24576
v_add_u32 v12, 0x20000, v12
v_mfma_f32_16x16x32_bf16 v[196:199], a[36:39], v[72:75], v[196:199]
buffer_load_dwordx4 v12, s[72:75], 0 offen lds
v_mfma_f32_16x16x32_bf16 v[200:203], a[40:43], v[72:75], v[200:203]
ds_read_b128 a[4:7], v1 offset:25600
v_cvt_pk_bf16_f32 v56, v24, v25
v_mfma_f32_16x16x32_bf16 v[232:235], a[40:43], v[76:79], v[232:235]
ds_read_b128 a[8:11], v1 offset:26624
v_cvt_pk_bf16_f32 v57, v26, v27
v_mfma_f32_16x16x32_bf16 v[236:239], a[44:47], v[76:79], v[236:239]
ds_read_b128 a[12:15], v1 offset:27648
v_add_u32 v13, 0x20000, v13
v_mfma_f32_16x16x32_bf16 v[204:207], a[44:47], v[72:75], v[204:207]
buffer_load_dwordx4 v13, s[72:75], 0 offen offset:1024 lds
v_mfma_f32_16x16x32_bf16 v[208:211], a[48:51], v[72:75], v[208:211]
v_exp_f32 v40, v40
v_mfma_f32_16x16x32_bf16 v[240:243], a[48:51], v[76:79], v[240:243]
buffer_load_dwordx4 v12, s[72:75], s12 offen offset:2048 lds
v_mfma_f32_16x16x32_bf16 v[244:247], a[52:55], v[76:79], v[244:247]
ds_read_b128 a[16:19], v1 offset:28672
v_cvt_pk_bf16_f32 v60, v28, v29
v_mfma_f32_16x16x32_bf16 v[212:215], a[52:55], v[72:75], v[212:215]
ds_read_b128 a[20:23], v1 offset:29696
v_cvt_pk_bf16_f32 v61, v30, v31
v_mfma_f32_16x16x32_bf16 v[216:219], a[56:59], v[72:75], v[216:219]
ds_read_b128 a[24:27], v1 offset:30720
v_exp_f32 v41, v41
v_mfma_f32_16x16x32_bf16 v[248:251], a[56:59], v[76:79], v[248:251]
buffer_load_dwordx4 v13, s[72:75], s12 offen offset:3072 lds
v_mfma_f32_16x16x32_bf16 v[252:255], a[60:63], v[76:79], v[252:255]
ds_read_b128 a[28:31], v1 offset:31744
v_exp_f32 v42, v42
v_mfma_f32_16x16x32_bf16 v[220:223], a[60:63], v[72:75], v[220:223]
ds_read_b128 a[32:35], v1 offset:16384
v_cvt_pk_bf16_f32 v58, v40, v41
v_mfma_f32_16x16x32_bf16 a[232:235], a[240:243], v[72:75], a[232:235]
s_waitcnt lgkmcnt(5)
v_exp_f32 v43, v43
v_mfma_f32_16x16x32_bf16 a[236:239], a[240:243], v[76:79], a[236:239]
s_add_u32 m0, s16, 0x4000
v_exp_f32 v44, v44
v_mfma_f32_16x16x32_bf16 v[24:27], a[0:3], a[192:195], v[112:115]
ds_read_b128 a[36:39], v1 offset:17408
v_add_u32 v12, 0x20000, v12
v_mfma_f32_16x16x32_bf16 v[24:27], a[4:7], a[196:199], v[24:27]
buffer_load_dwordx4 v12, s[72:75], 0 offen lds
v_mfma_f32_16x16x32_bf16 v[24:27], a[8:11], a[200:203], v[24:27]
ds_read_b128 a[40:43], v1 offset:18432
v_cvt_pk_bf16_f32 v59, v42, v43
v_mfma_f32_16x16x32_bf16 v[24:27], a[12:15], a[204:207], v[24:27]
ds_read_b128 a[44:47], v1 offset:19456
v_add_u32 v13, 0x20000, v13
v_mfma_f32_16x16x32_bf16 v[28:31], a[0:3], a[208:211], v[92:95]
buffer_load_dwordx4 v13, s[72:75], 0 offen offset:1024 lds
v_mfma_f32_16x16x32_bf16 v[28:31], a[4:7], a[212:215], v[28:31]
ds_read_b128 a[48:51], v1 offset:20480
v_exp_f32 v45, v45
v_mfma_f32_16x16x32_bf16 v[28:31], a[8:11], a[216:219], v[28:31]
s_waitcnt lgkmcnt(5)
v_exp_f32 v46, v46
v_mfma_f32_16x16x32_bf16 v[28:31], a[12:15], a[220:223], v[28:31]
ds_read_b128 a[52:55], v1 offset:21504
v_cvt_pk_bf16_f32 v62, v44, v45
v_mfma_f32_16x16x32_bf16 v[40:43], a[16:19], a[192:195], v[116:119]
ds_read_b128 a[56:59], v1 offset:22528
v_exp_f32 v47, v47
v_mfma_f32_16x16x32_bf16 v[40:43], a[20:23], a[196:199], v[40:43]
buffer_load_dwordx4 v12, s[72:75], s12 offen offset:2048 lds
v_mfma_f32_16x16x32_bf16 v[40:43], a[24:27], a[200:203], v[40:43]
ds_read_b128 a[60:63], v1 offset:23552
v_xor_b32 v1, 0x8000, v1
v_mfma_f32_16x16x32_bf16 v[40:43], a[28:31], a[204:207], v[40:43]
buffer_load_dwordx4 v13, s[72:75], s12 offen offset:3072 lds
v_cvt_pk_bf16_f32 v63, v46, v47
v_mfma_f32_16x16x32_bf16 v[44:47], a[16:19], a[208:211], v[92:95]
v_exp_f32 v24, v24
v_mfma_f32_16x16x32_bf16 v[44:47], a[20:23], a[212:215], v[44:47]
v_exp_f32 v25, v25
v_mfma_f32_16x16x32_bf16 v[44:47], a[24:27], a[216:219], v[44:47]
v_exp_f32 v26, v26
v_mfma_f32_16x16x32_bf16 v[44:47], a[28:31], a[220:223], v[44:47]
v_exp_f32 v27, v27
v_exp_f32 v28, v28
v_exp_f32 v29, v29
s_nop 7
v_accvgpr_read_b32 v4, a224
v_accvgpr_read_b32 v6, a228
s_mov_b32 s8, 0x5f800000
v_cmp_nge_f32 s[36:37], s8, v4
v_cmp_nge_f32 s[38:39], s8, v6
v_rcp_f32 v4, v4
v_rcp_f32 v6, v6
s_or_b64 s[34:35], s[34:35], s[36:37]
s_or_b64 s[34:35], s[34:35], s[38:39]
v_pk_mul_f32 v[128:129], v[128:129], v[4:5] op_sel_hi:[1,0]
v_pk_mul_f32 v[130:131], v[130:131], v[4:5] op_sel_hi:[1,0]
v_pk_mul_f32 v[132:133], v[132:133], v[4:5] op_sel_hi:[1,0]
v_pk_mul_f32 v[134:135], v[134:135], v[4:5] op_sel_hi:[1,0]
v_cvt_pk_bf16_f32 v128, v128, v129
v_cvt_pk_bf16_f32 v129, v130, v131
v_cvt_pk_bf16_f32 v130, v132, v133
v_cvt_pk_bf16_f32 v131, v134, v135
s_add_u32 s8, s28, 0x0
buffer_store_dwordx4 v[128:131], v3, s[88:91], s8 offen sc1
v_pk_mul_f32 v[136:137], v[136:137], v[4:5] op_sel_hi:[1,0]
v_pk_mul_f32 v[138:139], v[138:139], v[4:5] op_sel_hi:[1,0]
v_pk_mul_f32 v[140:141], v[140:141], v[4:5] op_sel_hi:[1,0]
v_pk_mul_f32 v[142:143], v[142:143], v[4:5] op_sel_hi:[1,0]
v_cvt_pk_bf16_f32 v136, v136, v137
v_cvt_pk_bf16_f32 v137, v138, v139
v_cvt_pk_bf16_f32 v138, v140, v141
v_cvt_pk_bf16_f32 v139, v142, v143
s_add_u32 s8, s28, 0x2000
buffer_store_dwordx4 v[136:139], v3, s[88:91], s8 offen sc1
v_pk_mul_f32 v[144:145], v[144:145], v[4:5] op_sel_hi:[1,0]
v_pk_mul_f32 v[146:147], v[146:147], v[4:5] op_sel_hi:[1,0]
v_pk_mul_f32 v[148:149], v[148:149], v[4:5] op_sel_hi:[1,0]
v_pk_mul_f32 v[150:151], v[150:151], v[4:5] op_sel_hi:[1,0]
v_cvt_pk_bf16_f32 v144, v144, v145
v_cvt_pk_bf16_f32 v145, v146, v147
v_cvt_pk_bf16_f32 v146, v148, v149
v_cvt_pk_bf16_f32 v147, v150, v151
s_add_u32 s8, s28, 0x4000
buffer_store_dwordx4 v[144:147], v3, s[88:91], s8 offen sc1
v_pk_mul_f32 v[152:153], v[152:153], v[4:5] op_sel_hi:[1,0]
v_pk_mul_f32 v[154:155], v[154:155], v[4:5] op_sel_hi:[1,0]
v_pk_mul_f32 v[156:157], v[156:157], v[4:5] op_sel_hi:[1,0]
v_pk_mul_f32 v[158:159], v[158:159], v[4:5] op_sel_hi:[1,0]
v_cvt_pk_bf16_f32 v152, v152, v153
v_cvt_pk_bf16_f32 v153, v154, v155
v_cvt_pk_bf16_f32 v154, v156, v157
v_cvt_pk_bf16_f32 v155, v158, v159
s_add_u32 s8, s28, 0x6000
buffer_store_dwordx4 v[152:155], v3, s[88:91], s8 offen sc1
v_pk_mul_f32 v[160:161], v[160:161], v[6:7] op_sel_hi:[1,0]
v_pk_mul_f32 v[162:163], v[162:163], v[6:7] op_sel_hi:[1,0]
v_pk_mul_f32 v[164:165], v[164:165], v[6:7] op_sel_hi:[1,0]
v_pk_mul_f32 v[166:167], v[166:167], v[6:7] op_sel_hi:[1,0]
v_cvt_pk_bf16_f32 v160, v160, v161
v_cvt_pk_bf16_f32 v161, v162, v163
v_cvt_pk_bf16_f32 v162, v164, v165
v_cvt_pk_bf16_f32 v163, v166, v167
s_add_u32 s8, s29, 0x0
buffer_store_dwordx4 v[160:163], v3, s[88:91], s8 offen sc1
v_pk_mul_f32 v[168:169], v[168:169], v[6:7] op_sel_hi:[1,0]
v_pk_mul_f32 v[170:171], v[170:171], v[6:7] op_sel_hi:[1,0]
v_pk_mul_f32 v[172:173], v[172:173], v[6:7] op_sel_hi:[1,0]
v_pk_mul_f32 v[174:175], v[174:175], v[6:7] op_sel_hi:[1,0]
v_cvt_pk_bf16_f32 v168, v168, v169
v_cvt_pk_bf16_f32 v169, v170, v171
v_cvt_pk_bf16_f32 v170, v172, v173
v_cvt_pk_bf16_f32 v171, v174, v175
s_add_u32 s8, s29, 0x2000
buffer_store_dwordx4 v[168:171], v3, s[88:91], s8 offen sc1
v_pk_mul_f32 v[176:177], v[176:177], v[6:7] op_sel_hi:[1,0]
v_pk_mul_f32 v[178:179], v[178:179], v[6:7] op_sel_hi:[1,0]
v_pk_mul_f32 v[180:181], v[180:181], v[6:7] op_sel_hi:[1,0]
v_pk_mul_f32 v[182:183], v[182:183], v[6:7] op_sel_hi:[1,0]
v_cvt_pk_bf16_f32 v176, v176, v177
v_cvt_pk_bf16_f32 v177, v178, v179
v_cvt_pk_bf16_f32 v178, v180, v181
v_cvt_pk_bf16_f32 v179, v182, v183
s_add_u32 s8, s29, 0x4000
buffer_store_dwordx4 v[176:179], v3, s[88:91], s8 offen sc1
v_pk_mul_f32 v[184:185], v[184:185], v[6:7] op_sel_hi:[1,0]
v_pk_mul_f32 v[186:187], v[186:187], v[6:7] op_sel_hi:[1,0]
v_pk_mul_f32 v[188:189], v[188:189], v[6:7] op_sel_hi:[1,0]
v_pk_mul_f32 v[190:191], v[190:191], v[6:7] op_sel_hi:[1,0]
v_cvt_pk_bf16_f32 v184, v184, v185
v_cvt_pk_bf16_f32 v185, v186, v187
v_cvt_pk_bf16_f32 v186, v188, v189
v_cvt_pk_bf16_f32 v187, v190, v191
s_add_u32 s8, s29, 0x6000
buffer_store_dwordx4 v[184:187], v3, s[88:91], s8 offen sc1
s_branch L_att_h1_1
L_att_j0:
s_cmp_ge_u32 s4, 2
s_cbranch_scc1 L_att_nl0_1
L_att_nl0_0:
v_mfma_f32_16x16x32_bf16 v[16:19], a[0:3], a[160:163], v[96:99]
v_mfma_f32_16x16x32_bf16 v[16:19], a[4:7], a[164:167], v[16:19]
s_add_u32 m0, s27, 0x0
v_mfma_f32_16x16x32_bf16 v[16:19], a[8:11], a[168:171], v[16:19]
buffer_load_dwordx4 v3, s[48:51], s32 offen offset:0 sc1 lds
v_mfma_f32_16x16x32_bf16 v[16:19], a[12:15], a[172:175], v[16:19]
v_mfma_f32_16x16x32_bf16 v[20:23], a[0:3], a[176:179], v[84:87]
v_mfma_f32_16x16x32_bf16 v[20:23], a[4:7], a[180:183], v[20:23]
v_mfma_f32_16x16x32_bf16 v[20:23], a[8:11], a[184:187], v[20:23]
s_mov_b32 s9, 0x0
v_mfma_f32_16x16x32_bf16 v[20:23], a[12:15], a[188:191], v[20:23]
buffer_load_dword a244, v8, s[72:75], s9 offen
v_mfma_f32_16x16x32_bf16 v[24:27], a[0:3], a[192:195], v[88:91]
s_nop 0
v_exp_f32 v16, v16
v_mfma_f32_16x16x32_bf16 v[24:27], a[4:7], a[196:199], v[24:27]
v_exp_f32 v17, v17
v_mfma_f32_16x16x32_bf16 v[24:27], a[8:11], a[200:203], v[24:27]
v_exp_f32 v18, v18
v_mfma_f32_16x16x32_bf16 v[24:27], a[12:15], a[204:207], v[24:27]
v_exp_f32 v19, v19
v_mfma_f32_16x16x32_bf16 v[28:31], a[0:3], a[208:211], v[92:95]
buffer_load_dwordx4 v3, s[48:51], s32 offen offset:1024 sc1 lds
v_mfma_f32_16x16x32_bf16 v[28:31], a[4:7], a[212:215], v[28:31]
v_exp_f32 v20, v20
v_mfma_f32_16x16x32_bf16 v[28:31], a[8:11], a[216:219], v[28:31]
v_exp_f32 v21, v21
v_mfma_f32_16x16x32_bf16 v[28:31], a[12:15], a[220:223], v[28:31]
v_cvt_pk_bf16_f32 v48, v16, v17
v_cvt_pk_bf16_f32 v49, v18, v19
v_mfma_f32_16x16x32_bf16 v[32:35], a[16:19], a[160:163], v[100:103]
v_exp_f32 v22, v22
v_mfma_f32_16x16x32_bf16 v[32:35], a[20:23], a[164:167], v[32:35]
buffer_load_dwordx4 v3, s[48:51], s32 offen offset:2048 sc1 lds
v_mfma_f32_16x16x32_bf16 v[32:35], a[24:27], a[168:171], v[32:35]
v_cvt_pk_bf16_f32 v52, v20, v21
v_mfma_f32_16x16x32_bf16 v[32:35], a[28:31], a[172:175], v[32:35]
v_mfma_f32_16x16x32_bf16 v[36:39], a[16:19], a[176:179], v[84:87]
v_exp_f32 v23, v23
v_mfma_f32_16x16x32_bf16 v[36:39], a[20:23], a[180:183], v[36:39]
v_cvt_pk_bf16_f32 v53, v22, v23
v_mfma_f32_16x16x32_bf16 v[36:39], a[24:27], a[184:187], v[36:39]
buffer_load_dwordx4 v3, s[48:51], s32 offen offset:3072 sc1 lds
v_mfma_f32_16x16x32_bf16 v[36:39], a[28:31], a[188:191], v[36:39]
v_exp_f32 v24, v24
v_mfma_f32_16x16x32_bf16 v[40:43], a[16:19], a[192:195], v[88:91]
v_mfma_f32_16x16x32_bf16 v[40:43], a[20:23], a[196:199], v[40:43]
v_exp_f32 v25, v25
v_mfma_f32_16x16x32_bf16 v[40:43], a[24:27], a[200:203], v[40:43]
s_mov_b32 s9, 0x0
v_mfma_f32_16x16x32_bf16 v[40:43], a[28:31], a[204:207], v[40:43]
buffer_load_dword a244, v8, s[64:67], s9 offen
v_mfma_f32_16x16x32_bf16 v[44:47], a[16:19], a[208:211], v[92:95]
v_exp_f32 v26, v26
v_mfma_f32_16x16x32_bf16 v[44:47], a[20:23], a[212:215], v[44:47]
v_mfma_f32_16x16x32_bf16 v[44:47], a[24:27], a[216:219], v[44:47]
v_exp_f32 v27, v27
v_mfma_f32_16x16x32_bf16 v[44:47], a[28:31], a[220:223], v[44:47]
s_waitcnt lgkmcnt(0)
ds_read_b128 a[0:3], v1 offset:24576
ds_read_b128 a[4:7], v1 offset:25600
ds_read_b128 a[8:11], v1 offset:26624
ds_read_b128 a[12:15], v1 offset:27648
ds_read_b128 a[16:19], v1 offset:28672
ds_read_b128 a[20:23], v1 offset:29696
ds_read_b128 a[24:27], v1 offset:30720
ds_read_b128 a[28:31], v1 offset:31744
s_waitcnt lgkmcnt(7)
v_mfma_f32_16x16x32_bf16 v[20:23], a[0:3], a[176:179], v[84:87]
s_add_u32 m0, s27, 0x1000
v_exp_f32 v28, v28
s_waitcnt lgkmcnt(6)
v_mfma_f32_16x16x32_bf16 v[20:23], a[4:7], a[180:183], v[20:23]
buffer_load_dwordx4 v3, s[48:51], s7 offen offset:0 sc1 lds
s_waitcnt lgkmcnt(5)
v_mfma_f32_16x16x32_bf16 v[20:23], a[8:11], a[184:187], v[20:23]
v_exp_f32 v29, v29
s_waitcnt lgkmcnt(4)
v_mfma_f32_16x16x32_bf16 v[20:23], a[12:15], a[188:191], v[20:23]
ds_read_b128 a[32:35], v1 offset:16384
v_cvt_pk_bf16_f32 v56, v24, v25
v_cvt_pk_bf16_f32 v57, v26, v27
v_mfma_f32_16x16x32_bf16 v[24:27], a[0:3], a[192:195], v[88:91]
v_exp_f32 v30, v30
v_mfma_f32_16x16x32_bf16 v[24:27], a[4:7], a[196:199], v[24:27]
ds_read_b128 a[36:39], v1 offset:17408
v_cvt_pk_bf16_f32 v60, v28, v29
v_mfma_f32_16x16x32_bf16 v[24:27], a[8:11], a[200:203], v[24:27]
buffer_load_dwordx4 v3, s[48:51], s7 offen offset:1024 sc1 lds
v_mfma_f32_16x16x32_bf16 v[24:27], a[12:15], a[204:207], v[24:27]
ds_read_b128 a[40:43], v1 offset:18432
v_exp_f32 v31, v31
s_nop 0
v_cvt_pk_bf16_f32 v61, v30, v31
v_mfma_f32_16x16x32_bf16 v[28:31], a[0:3], a[208:211], v[92:95]
v_exp_f32 v32, v32
v_mfma_f32_16x16x32_bf16 v[28:31], a[4:7], a[212:215], v[28:31]
ds_read_b128 a[44:47], v1 offset:19456
v_exp_f32 v33, v33
v_mfma_f32_16x16x32_bf16 v[28:31], a[8:11], a[216:219], v[28:31]
buffer_load_dwordx4 v3, s[48:51], s7 offen offset:2048 sc1 lds
v_mfma_f32_16x16x32_bf16 v[28:31], a[12:15], a[220:223], v[28:31]
s_mov_b32 s9, 0x400000
v_exp_f32 v34, v34
v_exp_f32 v35, v35
v_exp_f32 v36, v36
v_exp_f32 v37, v37
v_exp_f32 v38, v38
v_exp_f32 v39, v39
v_cvt_pk_bf16_f32 v54, v36, v37
v_cvt_pk_bf16_f32 v55, v38, v39
s_waitcnt lgkmcnt(7)
v_mfma_f32_16x16x32_bf16 v[36:39], a[16:19], a[176:179], v[84:87]
ds_read_b128 a[48:51], v1 offset:20480
v_cvt_pk_bf16_f32 v50, v32, v33
s_waitcnt lgkmcnt(7)
v_mfma_f32_16x16x32_bf16 v[36:39], a[20:23], a[180:183], v[36:39]
ds_read_b128 a[52:55], v1 offset:21504
v_cvt_pk_bf16_f32 v51, v34, v35
s_waitcnt lgkmcnt(7)
v_mfma_f32_16x16x32_bf16 v[36:39], a[24:27], a[184:187], v[36:39]
buffer_load_dword a244, v8, s[64:67], s9 offen
s_waitcnt lgkmcnt(6)
v_mfma_f32_16x16x32_bf16 v[36:39], a[28:31], a[188:191], v[36:39]
ds_read_b128 a[56:59], v1 offset:22528
v_exp_f32 v40, v40
v_exp_f32 v41, v41
v_exp_f32 v42, v42
v_exp_f32 v43, v43
v_cvt_pk_bf16_f32 v58, v40, v41
v_cvt_pk_bf16_f32 v59, v42, v43
v_mfma_f32_16x16x32_bf16 v[40:43], a[16:19], a[192:195], v[88:91]
buffer_load_dwordx4 v3, s[48:51], s7 offen offset:3072 sc1 lds
v_mfma_f32_16x16x32_bf16 v[40:43], a[20:23], a[196:199], v[40:43]
ds_read_b128 a[60:63], v1 offset:23552
v_xor_b32 v1, 0x8000, v1
v_mfma_f32_16x16x32_bf16 v[40:43], a[24:27], a[200:203], v[40:43]
s_add_u32 s32, s32, 0x8000
v_exp_f32 v44, v44
v_mfma_f32_16x16x32_bf16 v[40:43], a[28:31], a[204:207], v[40:43]
s_add_u32 s7, s7, 0x8000
v_exp_f32 v45, v45
v_exp_f32 v46, v46
v_exp_f32 v47, v47
v_cvt_pk_bf16_f32 v62, v44, v45
v_cvt_pk_bf16_f32 v63, v46, v47
v_mfma_f32_16x16x32_bf16 v[44:47], a[16:19], a[208:211], v[92:95]
s_xor_b32 s27, s27, 0x38000
v_exp_f32 v20, v20
v_mfma_f32_16x16x32_bf16 v[44:47], a[20:23], a[212:215], v[44:47]
v_exp_f32 v21, v21
v_mfma_f32_16x16x32_bf16 v[44:47], a[24:27], a[216:219], v[44:47]
s_waitcnt vmcnt(19) lgkmcnt(0)
v_exp_f32 v22, v22
v_mfma_f32_16x16x32_bf16 v[44:47], a[28:31], a[220:223], v[44:47]
s_barrier
v_cvt_pk_bf16_f32 v68, v20, v21
v_exp_f32 v23, v23
v_exp_f32 v24, v24
v_exp_f32 v25, v25
v_exp_f32 v26, v26
v_exp_f32 v27, v27
v_cvt_pk_bf16_f32 v69, v22, v23
s_branch L_att_l1_0
L_att_nl0_1:
v_mfma_f32_16x16x32_bf16 v[16:19], a[0:3], a[160:163], v[80:83]
v_mfma_f32_16x16x32_bf16 v[16:19], a[4:7], a[164:167], v[16:19]
s_add_u32 m0, s27, 0x0
v_mfma_f32_16x16x32_bf16 v[16:19], a[8:11], a[168:171], v[16:19]
buffer_load_dwordx4 v3, s[48:51], s32 offen offset:0 sc1 lds
v_mfma_f32_16x16x32_bf16 v[16:19], a[12:15], a[172:175], v[16:19]
v_mfma_f32_16x16x32_bf16 v[20:23], a[0:3], a[176:179], v[84:87]
v_mfma_f32_16x16x32_bf16 v[20:23], a[4:7], a[180:183], v[20:23]
v_mfma_f32_16x16x32_bf16 v[20:23], a[8:11], a[184:187], v[20:23]
s_mov_b32 s9, 0x0
v_mfma_f32_16x16x32_bf16 v[20:23], a[12:15], a[188:191], v[20:23]
buffer_load_dword a244, v8, s[72:75], s9 offen
v_mfma_f32_16x16x32_bf16 v[24:27], a[0:3], a[192:195], v[88:91]
s_nop 0
v_exp_f32 v16, v16
v_mfma_f32_16x16x32_bf16 v[24:27], a[4:7], a[196:199], v[24:27]
v_exp_f32 v17, v17
v_mfma_f32_16x16x32_bf16 v[24:27], a[8:11], a[200:203], v[24:27]
v_exp_f32 v18, v18
v_mfma_f32_16x16x32_bf16 v[24:27], a[12:15], a[204:207], v[24:27]
v_exp_f32 v19, v19
v_mfma_f32_16x16x32_bf16 v[28:31], a[0:3], a[208:211], v[92:95]
buffer_load_dwordx4 v3, s[48:51], s32 offen offset:1024 sc1 lds
v_mfma_f32_16x16x32_bf16 v[28:31], a[4:7], a[212:215], v[28:31]
v_exp_f32 v20, v20
v_mfma_f32_16x16x32_bf16 v[28:31], a[8:11], a[216:219], v[28:31]
v_exp_f32 v21, v21
v_mfma_f32_16x16x32_bf16 v[28:31], a[12:15], a[220:223], v[28:31]
v_cvt_pk_bf16_f32 v48, v16, v17
v_cvt_pk_bf16_f32 v49, v18, v19
v_mfma_f32_16x16x32_bf16 v[32:35], a[16:19], a[160:163], v[80:83]
v_exp_f32 v22, v22
v_mfma_f32_16x16x32_bf16 v[32:35], a[20:23], a[164:167], v[32:35]
buffer_load_dwordx4 v3, s[48:51], s32 offen offset:2048 sc1 lds
v_mfma_f32_16x16x32_bf16 v[32:35], a[24:27], a[168:171], v[32:35]
v_cvt_pk_bf16_f32 v52, v20, v21
v_mfma_f32_16x16x32_bf16 v[32:35], a[28:31], a[172:175], v[32:35]
v_mfma_f32_16x16x32_bf16 v[36:39], a[16:19], a[176:179], v[84:87]
v_exp_f32 v23, v23
v_mfma_f32_16x16x32_bf16 v[36:39], a[20:23], a[180:183], v[36:39]
v_cvt_pk_bf16_f32 v53, v22, v23
v_mfma_f32_16x16x32_bf16 v[36:39], a[24:27], a[184:187], v[36:39]
buffer_load_dwordx4 v3, s[48:51], s32 offen offset:3072 sc1 lds
v_mfma_f32_16x16x32_bf16 v[36:39], a[28:31], a[188:191], v[36:39]
v_exp_f32 v24, v24
v_mfma_f32_16x16x32_bf16 v[40:43], a[16:19], a[192:195], v[88:91]
v_mfma_f32_16x16x32_bf16 v[40:43], a[20:23], a[196:199], v[40:43]
v_exp_f32 v25, v25
v_mfma_f32_16x16x32_bf16 v[40:43], a[24:27], a[200:203], v[40:43]
s_mov_b32 s9, 0x0
v_mfma_f32_16x16x32_bf16 v[40:43], a[28:31], a[204:207], v[40:43]
buffer_load_dword a244, v8, s[64:67], s9 offen
v_mfma_f32_16x16x32_bf16 v[44:47], a[16:19], a[208:211], v[92:95]
v_exp_f32 v26, v26
v_mfma_f32_16x16x32_bf16 v[44:47], a[20:23], a[212:215], v[44:47]
v_mfma_f32_16x16x32_bf16 v[44:47], a[24:27], a[216:219], v[44:47]
v_exp_f32 v27, v27
v_mfma_f32_16x16x32_bf16 v[44:47], a[28:31], a[220:223], v[44:47]
s_waitcnt lgkmcnt(0)
ds_read_b128 a[0:3], v1 offset:24576
ds_read_b128 a[4:7], v1 offset:25600
ds_read_b128 a[8:11], v1 offset:26624
ds_read_b128 a[12:15], v1 offset:27648
ds_read_b128 a[16:19], v1 offset:28672
ds_read_b128 a[20:23], v1 offset:29696
ds_read_b128 a[24:27], v1 offset:30720
ds_read_b128 a[28:31], v1 offset:31744
s_waitcnt lgkmcnt(7)
v_mfma_f32_16x16x32_bf16 v[16:19], a[0:3], a[160:163], v[96:99]
ds_read_b128 a[32:35], v1 offset:16384
v_cvt_pk_bf16_f32 v56, v24, v25
s_waitcnt lgkmcnt(7)
v_mfma_f32_16x16x32_bf16 v[16:19], a[4:7], a[164:167], v[16:19]
s_add_u32 m0, s27, 0x1000
v_exp_f32 v28, v28
s_waitcnt lgkmcnt(6)
v_mfma_f32_16x16x32_bf16 v[16:19], a[8:11], a[168:171], v[16:19]
buffer_load_dwordx4 v3, s[48:51], s7 offen offset:0 sc1 lds
s_waitcnt lgkmcnt(5)
v_mfma_f32_16x16x32_bf16 v[16:19], a[12:15], a[172:175], v[16:19]
ds_read_b128 a[36:39], v1 offset:17408
v_cvt_pk_bf16_f32 v57, v26, v27
v_mfma_f32_16x16x32_bf16 v[20:23], a[0:3], a[176:179], v[84:87]
v_exp_f32 v29, v29
v_mfma_f32_16x16x32_bf16 v[20:23], a[4:7], a[180:183], v[20:23]
v_exp_f32 v30, v30
v_mfma_f32_16x16x32_bf16 v[20:23], a[8:11], a[184:187], v[20:23]
ds_read_b128 a[40:43], v1 offset:18432
v_cvt_pk_bf16_f32 v60, v28, v29
v_mfma_f32_16x16x32_bf16 v[20:23], a[12:15], a[188:191], v[20:23]
buffer_load_dwordx4 v3, s[48:51], s7 offen offset:1024 sc1 lds
v_mfma_f32_16x16x32_bf16 v[24:27], a[0:3], a[192:195], v[88:91]
v_exp_f32 v31, v31
v_mfma_f32_16x16x32_bf16 v[24:27], a[4:7], a[196:199], v[24:27]
ds_read_b128 a[44:47], v1 offset:19456
v_cvt_pk_bf16_f32 v61, v30, v31
v_mfma_f32_16x16x32_bf16 v[24:27], a[8:11], a[200:203], v[24:27]
v_exp_f32 v32, v32
v_mfma_f32_16x16x32_bf16 v[24:27], a[12:15], a[204:207], v[24:27]
v_exp_f32 v33, v33
v_mfma_f32_16x16x32_bf16 v[28:31], a[0:3], a[208:211], v[92:95]
v_exp_f32 v34, v34
v_mfma_f32_16x16x32_bf16 v[28:31], a[4:7], a[212:215], v[28:31]
buffer_load_dwordx4 v3, s[48:51], s7 offen offset:2048 sc1 lds
v_mfma_f32_16x16x32_bf16 v[28:31], a[8:11], a[216:219], v[28:31]
ds_read_b128 a[48:51], v1 offset:20480
v_cvt_pk_bf16_f32 v50, v32, v33
v_mfma_f32_16x16x32_bf16 v[28:31], a[12:15], a[220:223], v[28:31]
v_exp_f32 v35, v35
s_nop 0
v_cvt_pk_bf16_f32 v51, v34, v35
s_waitcnt lgkmcnt(8)
v_mfma_f32_16x16x32_bf16 v[32:35], a[16:19], a[160:163], v[100:103]
ds_read_b128 a[52:55], v1 offset:21504
v_exp_f32 v36, v36
s_waitcnt lgkmcnt(8)
v_mfma_f32_16x16x32_bf16 v[32:35], a[20:23], a[164:167], v[32:35]
s_mov_b32 s9, 0x400000
v_exp_f32 v37, v37
s_waitcnt lgkmcnt(7)
v_mfma_f32_16x16x32_bf16 v[32:35], a[24:27], a[168:171], v[32:35]
buffer_load_dword a244, v8, s[64:67], s9 offen
s_waitcnt lgkmcnt(6)
v_mfma_f32_16x16x32_bf16 v[32:35], a[28:31], a[172:175], v[32:35]
ds_read_b128 a[56:59], v1 offset:22528
v_cvt_pk_bf16_f32 v54, v36, v37
v_exp_f32 v38, v38
v_exp_f32 v39, v39
s_nop 0
v_cvt_pk_bf16_f32 v55, v38, v39
v_mfma_f32_16x16x32_bf16 v[36:39], a[16:19], a[176:179], v[84:87]
v_exp_f32 v40, v40
v_mfma_f32_16x16x32_bf16 v[36:39], a[20:23], a[180:183], v[36:39]
v_exp_f32 v41, v41
v_mfma_f32_16x16x32_bf16 v[36:39], a[24:27], a[184:187], v[36:39]
ds_read_b128 a[60:63], v1 offset:23552
v_xor_b32 v1, 0x8000, v1
v_mfma_f32_16x16x32_bf16 v[36:39], a[28:31], a[188:191], v[36:39]
buffer_load_dwordx4 v3, s[48:51], s7 offen offset:3072 sc1 lds
v_exp_f32 v42, v42
v_exp_f32 v43, v43
v_cvt_pk_bf16_f32 v58, v40, v41
v_cvt_pk_bf16_f32 v59, v42, v43
v_mfma_f32_16x16x32_bf16 v[40:43], a[16:19], a[192:195], v[88:91]
s_add_u32 s32, s32, 0x8000
v_exp_f32 v44, v44
v_mfma_f32_16x16x32_bf16 v[40:43], a[20:23], a[196:199], v[40:43]
s_add_u32 s7, s7, 0x8000
v_exp_f32 v45, v45
v_mfma_f32_16x16x32_bf16 v[40:43], a[24:27], a[200:203], v[40:43]
s_xor_b32 s27, s27, 0x38000
v_exp_f32 v46, v46
v_mfma_f32_16x16x32_bf16 v[40:43], a[28:31], a[204:207], v[40:43]
v_exp_f32 v47, v47
v_cvt_pk_bf16_f32 v62, v44, v45
v_cvt_pk_bf16_f32 v63, v46, v47
v_mfma_f32_16x16x32_bf16 v[44:47], a[16:19], a[208:211], v[92:95]
v_exp_f32 v16, v16
v_mfma_f32_16x16x32_bf16 v[44:47], a[20:23], a[212:215], v[44:47]
v_exp_f32 v17, v17
v_mfma_f32_16x16x32_bf16 v[44:47], a[24:27], a[216:219], v[44:47]
s_waitcnt vmcnt(19) lgkmcnt(0)
v_exp_f32 v18, v18
v_mfma_f32_16x16x32_bf16 v[44:47], a[28:31], a[220:223], v[44:47]
s_barrier
v_cvt_pk_bf16_f32 v64, v16, v17
v_exp_f32 v19, v19
v_exp_f32 v20, v20
v_exp_f32 v21, v21
v_exp_f32 v22, v22
v_exp_f32 v23, v23
v_exp_f32 v24, v24
v_exp_f32 v25, v25
v_exp_f32 v26, v26
v_exp_f32 v27, v27
v_cvt_pk_bf16_f32 v65, v18, v19
v_cvt_pk_bf16_f32 v68, v20, v21
v_cvt_pk_bf16_f32 v69, v22, v23
s_branch L_att_l1_1
L_att_seven:
v_mfma_f32_16x16x32_bf16 v[192:195], a[32:35], v[56:59], v[192:195]
ds_read_b128 a[0:3], v1 offset:8192
v_cvt_pk_bf16_f32 v72, v24, v25
v_mfma_f32_16x16x32_bf16 v[224:227], a[32:35], v[60:63], v[224:227]
ds_read_b128 a[4:7], v1 offset:9216
v_cvt_pk_bf16_f32 v73, v26, v27
v_mfma_f32_16x16x32_bf16 v[228:231], a[36:39], v[60:63], v[228:231]
s_add_u32 m0, s27, 0x0
v_exp_f32 v30, v30
v_mfma_f32_16x16x32_bf16 v[196:199], a[36:39], v[56:59], v[196:199]
buffer_load_dwordx4 v3, s[48:51], s32 offen offset:0 sc1 lds
v_mfma_f32_16x16x32_bf16 v[200:203], a[40:43], v[56:59], v[200:203]
ds_read_b128 a[8:11], v1 offset:10240
v_cvt_pk_bf16_f32 v76, v28, v29
v_mfma_f32_16x16x32_bf16 v[232:235], a[40:43], v[60:63], v[232:235]
ds_read_b128 a[12:15], v1 offset:11264
v_mfma_f32_16x16x32_bf16 v[236:239], a[44:47], v[60:63], v[236:239]
v_exp_f32 v31, v31
v_mfma_f32_16x16x32_bf16 v[204:207], a[44:47], v[56:59], v[204:207]
ds_read_b128 a[16:19], v1 offset:12288
v_cvt_pk_bf16_f32 v77, v30, v31
v_mfma_f32_16x16x32_bf16 v[208:211], a[48:51], v[56:59], v[208:211]
v_exp_f32 v40, v40
v_mfma_f32_16x16x32_bf16 v[240:243], a[48:51], v[60:63], v[240:243]
ds_read_b128 a[20:23], v1 offset:13312
v_mfma_f32_16x16x32_bf16 v[244:247], a[52:55], v[60:63], v[244:247]
ds_read_b128 a[24:27], v1 offset:14336
v_mfma_f32_16x16x32_bf16 v[212:215], a[52:55], v[56:59], v[212:215]
buffer_load_dwordx4 v3, s[48:51], s32 offen offset:1024 sc1 lds
v_mfma_f32_16x16x32_bf16 v[216:219], a[56:59], v[56:59], v[216:219]
ds_read_b128 a[28:31], v1 offset:15360
v_mfma_f32_16x16x32_bf16 v[248:251], a[56:59], v[60:63], v[248:251]
v_exp_f32 v41, v41
v_mfma_f32_16x16x32_bf16 v[252:255], a[60:63], v[60:63], v[252:255]
ds_read_b128 a[32:35], v1 offset:0
v_cvt_pk_bf16_f32 v74, v40, v41
v_mfma_f32_16x16x32_bf16 v[220:223], a[60:63], v[56:59], v[220:223]
v_exp_f32 v42, v42
v_mfma_f32_16x16x32_bf16 a[232:235], a[240:243], v[56:59], a[232:235]
ds_read_b128 a[36:39], v1 offset:1024
v_mfma_f32_16x16x32_bf16 a[236:239], a[240:243], v[60:63], a[236:239]
s_waitcnt lgkmcnt(6)
v_exp_f32 v43, v43
v_mfma_f32_16x16x32_bf16 v[24:27], a[0:3], a[192:195], v[88:91]
ds_read_b128 a[40:43], v1 offset:2048
v_cvt_pk_bf16_f32 v75, v42, v43
v_mfma_f32_16x16x32_bf16 v[24:27], a[4:7], a[196:199], v[24:27]
buffer_load_dwordx4 v3, s[48:51], s32 offen offset:2048 sc1 lds
v_mfma_f32_16x16x32_bf16 v[24:27], a[8:11], a[200:203], v[24:27]
ds_read_b128 a[44:47], v1 offset:3072
v_mfma_f32_16x16x32_bf16 v[24:27], a[12:15], a[204:207], v[24:27]
ds_read_b128 a[48:51], v1 offset:4096
v_exp_f32 v44, v44
v_mfma_f32_16x16x32_bf16 v[28:31], a[0:3], a[208:211], v[92:95]
v_exp_f32 v45, v45
v_mfma_f32_16x16x32_bf16 v[28:31], a[4:7], a[212:215], v[28:31]
ds_read_b128 a[52:55], v1 offset:5120
v_exp_f32 v46, v46
v_mfma_f32_16x16x32_bf16 v[28:31], a[8:11], a[216:219], v[28:31]
s_waitcnt lgkmcnt(6)
v_exp_f32 v47, v47
v_mfma_f32_16x16x32_bf16 v[28:31], a[12:15], a[220:223], v[28:31]
ds_read_b128 a[56:59], v1 offset:6144
v_cvt_pk_bf16_f32 v78, v44, v45
v_mfma_f32_16x16x32_bf16 v[40:43], a[16:19], a[192:195], v[88:91]
v_exp_f32 v24, v24
v_mfma_f32_16x16x32_bf16 v[40:43], a[20:23], a[196:199], v[40:43]
buffer_load_dwordx4 v3, s[48:51], s32 offen offset:3072 sc1 lds
v_mfma_f32_16x16x32_bf16 v[40:43], a[24:27], a[200:203], v[40:43]
ds_read_b128 a[60:63], v1 offset:7168
v_cvt_pk_bf16_f32 v79, v46, v47
v_mfma_f32_16x16x32_bf16 v[40:43], a[28:31], a[204:207], v[40:43]
s_add_u32 s32, s32, 0x8000
v_exp_f32 v25, v25
v_mfma_f32_16x16x32_bf16 v[44:47], a[16:19], a[208:211], v[92:95]
v_exp_f32 v26, v26
v_mfma_f32_16x16x32_bf16 v[44:47], a[20:23], a[212:215], v[44:47]
v_exp_f32 v27, v27
v_mfma_f32_16x16x32_bf16 v[44:47], a[24:27], a[216:219], v[44:47]
v_exp_f32 v28, v28
v_mfma_f32_16x16x32_bf16 v[44:47], a[28:31], a[220:223], v[44:47]
s_waitcnt lgkmcnt(0)
v_exp_f32 v29, v29
v_mfma_f32_16x16x32_bf16 v[192:195], a[32:35], v[72:75], v[192:195]
v_exp_f32 v30, v30
v_mfma_f32_16x16x32_bf16 v[224:227], a[32:35], v[76:79], v[224:227]
v_exp_f32 v31, v31
v_mfma_f32_16x16x32_bf16 v[228:231], a[36:39], v[76:79], v[228:231]
s_add_u32 m0, s27, 0x1000
v_exp_f32 v40, v40
v_mfma_f32_16x16x32_bf16 v[196:199], a[36:39], v[72:75], v[196:199]
buffer_load_dwordx4 v3, s[48:51], s7 offen offset:0 sc1 lds
v_mfma_f32_16x16x32_bf16 v[200:203], a[40:43], v[72:75], v[200:203]
ds_read_b128 a[0:3], v1 offset:24576
v_cvt_pk_bf16_f32 v56, v24, v25
v_mfma_f32_16x16x32_bf16 v[232:235], a[40:43], v[76:79], v[232:235]
ds_read_b128 a[4:7], v1 offset:25600
v_cvt_pk_bf16_f32 v57, v26, v27
v_mfma_f32_16x16x32_bf16 v[236:239], a[44:47], v[76:79], v[236:239]
v_exp_f32 v41, v41
v_mfma_f32_16x16x32_bf16 v[204:207], a[44:47], v[72:75], v[204:207]
v_exp_f32 v42, v42
v_mfma_f32_16x16x32_bf16 v[208:211], a[48:51], v[72:75], v[208:211]
ds_read_b128 a[8:11], v1 offset:26624
v_cvt_pk_bf16_f32 v60, v28, v29
v_mfma_f32_16x16x32_bf16 v[240:243], a[48:51], v[76:79], v[240:243]
ds_read_b128 a[12:15], v1 offset:27648
v_cvt_pk_bf16_f32 v61, v30, v31
v_mfma_f32_16x16x32_bf16 v[244:247], a[52:55], v[76:79], v[244:247]
buffer_load_dwordx4 v3, s[48:51], s7 offen offset:1024 sc1 lds
v_mfma_f32_16x16x32_bf16 v[212:215], a[52:55], v[72:75], v[212:215]
ds_read_b128 a[16:19], v1 offset:28672
v_cvt_pk_bf16_f32 v58, v40, v41
v_mfma_f32_16x16x32_bf16 v[216:219], a[56:59], v[72:75], v[216:219]
ds_read_b128 a[20:23], v1 offset:29696
v_mfma_f32_16x16x32_bf16 v[248:251], a[56:59], v[76:79], v[248:251]
ds_read_b128 a[24:27], v1 offset:30720
v_mfma_f32_16x16x32_bf16 v[252:255], a[60:63], v[76:79], v[252:255]
ds_read_b128 a[28:31], v1 offset:31744
v_exp_f32 v43, v43
v_mfma_f32_16x16x32_bf16 v[220:223], a[60:63], v[72:75], v[220:223]
ds_read_b128 a[32:35], v1 offset:16384
v_exp_f32 v44, v44
v_mfma_f32_16x16x32_bf16 a[232:235], a[240:243], v[72:75], a[232:235]
s_waitcnt lgkmcnt(5)
v_exp_f32 v45, v45
v_mfma_f32_16x16x32_bf16 a[236:239], a[240:243], v[76:79], a[236:239]
ds_read_b128 a[36:39], v1 offset:17408
v_cvt_pk_bf16_f32 v59, v42, v43
v_mfma_f32_16x16x32_bf16 v[24:27], a[0:3], a[192:195], v[88:91]
v_exp_f32 v46, v46
v_mfma_f32_16x16x32_bf16 v[24:27], a[4:7], a[196:199], v[24:27]
v_exp_f32 v47, v47
v_mfma_f32_16x16x32_bf16 v[24:27], a[8:11], a[200:203], v[24:27]
buffer_load_dwordx4 v3, s[48:51], s7 offen offset:2048 sc1 lds
v_mfma_f32_16x16x32_bf16 v[24:27], a[12:15], a[204:207], v[24:27]
ds_read_b128 a[40:43], v1 offset:18432
v_cvt_pk_bf16_f32 v62, v44, v45
v_mfma_f32_16x16x32_bf16 v[28:31], a[0:3], a[208:211], v[92:95]
ds_read_b128 a[44:47], v1 offset:19456
v_cvt_pk_bf16_f32 v63, v46, v47
v_mfma_f32_16x16x32_bf16 v[28:31], a[4:7], a[212:215], v[28:31]
buffer_load_dwordx4 v3, s[48:51], s7 offen offset:3072 sc1 lds
v_mfma_f32_16x16x32_bf16 v[28:31], a[8:11], a[216:219], v[28:31]
ds_read_b128 a[48:51], v1 offset:20480
s_add_u32 s7, s7, 0x8000
v_mfma_f32_16x16x32_bf16 v[28:31], a[12:15], a[220:223], v[28:31]
ds_read_b128 a[52:55], v1 offset:21504
s_waitcnt lgkmcnt(6)
v_mfma_f32_16x16x32_bf16 v[40:43], a[16:19], a[192:195], v[88:91]
ds_read_b128 a[56:59], v1 offset:22528
s_xor_b32 s27, s27, 0x38000
v_mfma_f32_16x16x32_bf16 v[40:43], a[20:23], a[196:199], v[40:43]
ds_read_b128 a[60:63], v1 offset:23552
v_xor_b32 v1, 0x8000, v1
v_mfma_f32_16x16x32_bf16 v[40:43], a[24:27], a[200:203], v[40:43]
v_exp_f32 v24, v24
v_mfma_f32_16x16x32_bf16 v[40:43], a[28:31], a[204:207], v[40:43]
v_exp_f32 v25, v25
v_mfma_f32_16x16x32_bf16 v[44:47], a[16:19], a[208:211], v[92:95]
v_exp_f32 v26, v26
v_mfma_f32_16x16x32_bf16 v[44:47], a[20:23], a[212:215], v[44:47]
v_exp_f32 v27, v27
v_mfma_f32_16x16x32_bf16 v[44:47], a[24:27], a[216:219], v[44:47]
s_waitcnt vmcnt(16) lgkmcnt(0)
v_exp_f32 v28, v28
v_mfma_f32_16x16x32_bf16 v[44:47], a[28:31], a[220:223], v[44:47]
s_barrier
v_exp_f32 v29, v29
L_att_sodd:
v_mfma_f32_16x16x32_bf16 v[192:195], a[32:35], v[56:59], v[192:195]
ds_read_b128 a[0:3], v2 offset:8192
v_cvt_pk_bf16_f32 v72, v24, v25
v_mfma_f32_16x16x32_bf16 v[224:227], a[32:35], v[60:63], v[224:227]
ds_read_b128 a[4:7], v2 offset:9216
v_cvt_pk_bf16_f32 v73, v26, v27
v_mfma_f32_16x16x32_bf16 v[228:231], a[36:39], v[60:63], v[228:231]
s_add_u32 m0, s19, 0x0
v_exp_f32 v30, v30
v_mfma_f32_16x16x32_bf16 v[196:199], a[36:39], v[56:59], v[196:199]
buffer_load_dwordx4 v3, s[48:51], s32 offen offset:0 sc1 lds
v_mfma_f32_16x16x32_bf16 v[200:203], a[40:43], v[56:59], v[200:203]
ds_read_b128 a[8:11], v2 offset:10240
v_cvt_pk_bf16_f32 v76, v28, v29
v_mfma_f32_16x16x32_bf16 v[232:235], a[40:43], v[60:63], v[232:235]
ds_read_b128 a[12:15], v2 offset:11264
v_mfma_f32_16x16x32_bf16 v[236:239], a[44:47], v[60:63], v[236:239]
v_exp_f32 v31, v31
v_mfma_f32_16x16x32_bf16 v[204:207], a[44:47], v[56:59], v[204:207]
ds_read_b128 a[16:19], v2 offset:12288
v_cvt_pk_bf16_f32 v77, v30, v31
v_mfma_f32_16x16x32_bf16 v[208:211], a[48:51], v[56:59], v[208:211]
v_exp_f32 v40, v40
v_mfma_f32_16x16x32_bf16 v[240:243], a[48:51], v[60:63], v[240:243]
ds_read_b128 a[20:23], v2 offset:13312
v_mfma_f32_16x16x32_bf16 v[244:247], a[52:55], v[60:63], v[244:247]
ds_read_b128 a[24:27], v2 offset:14336
v_mfma_f32_16x16x32_bf16 v[212:215], a[52:55], v[56:59], v[212:215]
buffer_load_dwordx4 v3, s[48:51], s32 offen offset:1024 sc1 lds
v_mfma_f32_16x16x32_bf16 v[216:219], a[56:59], v[56:59], v[216:219]
ds_read_b128 a[28:31], v2 offset:15360
v_mfma_f32_16x16x32_bf16 v[248:251], a[56:59], v[60:63], v[248:251]
v_exp_f32 v41, v41
v_mfma_f32_16x16x32_bf16 v[252:255], a[60:63], v[60:63], v[252:255]
ds_read_b128 a[32:35], v2 offset:0
v_cvt_pk_bf16_f32 v74, v40, v41
v_mfma_f32_16x16x32_bf16 v[220:223], a[60:63], v[56:59], v[220:223]
v_exp_f32 v42, v42
v_mfma_f32_16x16x32_bf16 a[232:235], a[240:243], v[56:59], a[232:235]
ds_read_b128 a[36:39], v2 offset:1024
v_mfma_f32_16x16x32_bf16 a[236:239], a[240:243], v[60:63], a[236:239]
s_waitcnt lgkmcnt(6)
v_exp_f32 v43, v43
v_mfma_f32_16x16x32_bf16 v[24:27], a[0:3], a[192:195], v[88:91]
ds_read_b128 a[40:43], v2 offset:2048
v_cvt_pk_bf16_f32 v75, v42, v43
v_mfma_f32_16x16x32_bf16 v[24:27], a[4:7], a[196:199], v[24:27]
buffer_load_dwordx4 v3, s[48:51], s32 offen offset:2048 sc1 lds
v_mfma_f32_16x16x32_bf16 v[24:27], a[8:11], a[200:203], v[24:27]
ds_read_b128 a[44:47], v2 offset:3072
v_mfma_f32_16x16x32_bf16 v[24:27], a[12:15], a[204:207], v[24:27]
ds_read_b128 a[48:51], v2 offset:4096
v_exp_f32 v44, v44
v_mfma_f32_16x16x32_bf16 v[28:31], a[0:3], a[208:211], v[92:95]
v_exp_f32 v45, v45
v_mfma_f32_16x16x32_bf16 v[28:31], a[4:7], a[212:215], v[28:31]
ds_read_b128 a[52:55], v2 offset:5120
v_exp_f32 v46, v46
v_mfma_f32_16x16x32_bf16 v[28:31], a[8:11], a[216:219], v[28:31]
s_waitcnt lgkmcnt(6)
v_exp_f32 v47, v47
v_mfma_f32_16x16x32_bf16 v[28:31], a[12:15], a[220:223], v[28:31]
ds_read_b128 a[56:59], v2 offset:6144
v_cvt_pk_bf16_f32 v78, v44, v45
v_mfma_f32_16x16x32_bf16 v[40:43], a[16:19], a[192:195], v[88:91]
v_exp_f32 v24, v24
v_mfma_f32_16x16x32_bf16 v[40:43], a[20:23], a[196:199], v[40:43]
buffer_load_dwordx4 v3, s[48:51], s32 offen offset:3072 sc1 lds
v_mfma_f32_16x16x32_bf16 v[40:43], a[24:27], a[200:203], v[40:43]
ds_read_b128 a[60:63], v2 offset:7168
v_cvt_pk_bf16_f32 v79, v46, v47
v_mfma_f32_16x16x32_bf16 v[40:43], a[28:31], a[204:207], v[40:43]
s_add_u32 s32, s32, 0x8000
v_exp_f32 v25, v25
v_mfma_f32_16x16x32_bf16 v[44:47], a[16:19], a[208:211], v[92:95]
v_exp_f32 v26, v26
v_mfma_f32_16x16x32_bf16 v[44:47], a[20:23], a[212:215], v[44:47]
v_exp_f32 v27, v27
v_mfma_f32_16x16x32_bf16 v[44:47], a[24:27], a[216:219], v[44:47]
v_exp_f32 v28, v28
v_mfma_f32_16x16x32_bf16 v[44:47], a[28:31], a[220:223], v[44:47]
s_waitcnt lgkmcnt(0)
v_exp_f32 v29, v29
v_mfma_f32_16x16x32_bf16 v[192:195], a[32:35], v[72:75], v[192:195]
v_exp_f32 v30, v30
v_mfma_f32_16x16x32_bf16 v[224:227], a[32:35], v[76:79], v[224:227]
v_exp_f32 v31, v31
v_mfma_f32_16x16x32_bf16 v[228:231], a[36:39], v[76:79], v[228:231]
s_add_u32 m0, s19, 0x1000
v_exp_f32 v40, v40
v_mfma_f32_16x16x32_bf16 v[196:199], a[36:39], v[72:75], v[196:199]
buffer_load_dwordx4 v3, s[48:51], s7 offen offset:0 sc1 lds
v_mfma_f32_16x16x32_bf16 v[200:203], a[40:43], v[72:75], v[200:203]
ds_read_b128 a[0:3], v2 offset:24576
v_cvt_pk_bf16_f32 v56, v24, v25
v_mfma_f32_16x16x32_bf16 v[232:235], a[40:43], v[76:79], v[232:235]
ds_read_b128 a[4:7], v2 offset:25600
v_cvt_pk_bf16_f32 v57, v26, v27
v_mfma_f32_16x16x32_bf16 v[236:239], a[44:47], v[76:79], v[236:239]
v_exp_f32 v41, v41
v_mfma_f32_16x16x32_bf16 v[204:207], a[44:47], v[72:75], v[204:207]
v_exp_f32 v42, v42
v_mfma_f32_16x16x32_bf16 v[208:211], a[48:51], v[72:75], v[208:211]
ds_read_b128 a[8:11], v2 offset:26624
v_cvt_pk_bf16_f32 v60, v28, v29
v_mfma_f32_16x16x32_bf16 v[240:243], a[48:51], v[76:79], v[240:243]
ds_read_b128 a[12:15], v2 offset:27648
v_cvt_pk_bf16_f32 v61, v30, v31
v_mfma_f32_16x16x32_bf16 v[244:247], a[52:55], v[76:79], v[244:247]
buffer_load_dwordx4 v3, s[48:51], s7 offen offset:1024 sc1 lds
v_mfma_f32_16x16x32_bf16 v[212:215], a[52:55], v[72:75], v[212:215]
ds_read_b128 a[16:19], v2 offset:28672
v_cvt_pk_bf16_f32 v58, v40, v41
v_mfma_f32_16x16x32_bf16 v[216:219], a[56:59], v[72:75], v[216:219]
ds_read_b128 a[20:23], v2 offset:29696
v_exp_f32 v43, v43
v_mfma_f32_16x16x32_bf16 v[248:251], a[56:59], v[76:79], v[248:251]
ds_read_b128 a[24:27], v2 offset:30720
v_cvt_pk_bf16_f32 v59, v42, v43
v_mfma_f32_16x16x32_bf16 v[252:255], a[60:63], v[76:79], v[252:255]
ds_read_b128 a[28:31], v2 offset:31744
v_exp_f32 v44, v44
v_mfma_f32_16x16x32_bf16 v[220:223], a[60:63], v[72:75], v[220:223]
ds_read_b128 a[32:35], v2 offset:16384
v_exp_f32 v45, v45
v_mfma_f32_16x16x32_bf16 a[232:235], a[240:243], v[72:75], a[232:235]
s_waitcnt lgkmcnt(5)
v_exp_f32 v46, v46
v_mfma_f32_16x16x32_bf16 a[236:239], a[240:243], v[76:79], a[236:239]
ds_read_b128 a[36:39], v2 offset:17408
v_cvt_pk_bf16_f32 v62, v44, v45
v_mfma_f32_16x16x32_bf16 v[24:27], a[0:3], a[192:195], v[88:91]
buffer_load_dwordx4 v3, s[48:51], s7 offen offset:2048 sc1 lds
v_mfma_f32_16x16x32_bf16 v[24:27], a[4:7], a[196:199], v[24:27]
v_exp_f32 v47, v47
v_mfma_f32_16x16x32_bf16 v[24:27], a[8:11], a[200:203], v[24:27]
ds_read_b128 a[40:43], v2 offset:18432
v_cvt_pk_bf16_f32 v63, v46, v47
v_mfma_f32_16x16x32_bf16 v[24:27], a[12:15], a[204:207], v[24:27]
buffer_load_dwordx4 v3, s[48:51], s7 offen offset:3072 sc1 lds
v_mfma_f32_16x16x32_bf16 v[28:31], a[0:3], a[208:211], v[92:95]
ds_read_b128 a[44:47], v2 offset:19456
s_add_u32 s7, s7, 0x8000
v_mfma_f32_16x16x32_bf16 v[28:31], a[4:7], a[212:215], v[28:31]
ds_read_b128 a[48:51], v2 offset:20480
s_xor_b32 s19, s19, 0x8000
v_mfma_f32_16x16x32_bf16 v[28:31], a[8:11], a[216:219], v[28:31]
ds_read_b128 a[52:55], v2 offset:21504
s_sub_u32 s15, s15, 1
v_mfma_f32_16x16x32_bf16 v[28:31], a[12:15], a[220:223], v[28:31]
ds_read_b128 a[56:59], v2 offset:22528
s_waitcnt lgkmcnt(7)
v_mfma_f32_16x16x32_bf16 v[40:43], a[16:19], a[192:195], v[88:91]
s_cmp_lg_u32 s15, 0
v_exp_f32 v24, v24
v_mfma_f32_16x16x32_bf16 v[40:43], a[20:23], a[196:199], v[40:43]
ds_read_b128 a[60:63], v2 offset:23552
v_xor_b32 v2, 0x38000, v2
v_mfma_f32_16x16x32_bf16 v[40:43], a[24:27], a[200:203], v[40:43]
v_exp_f32 v25, v25
v_mfma_f32_16x16x32_bf16 v[40:43], a[28:31], a[204:207], v[40:43]
v_exp_f32 v26, v26
v_mfma_f32_16x16x32_bf16 v[44:47], a[16:19], a[208:211], v[92:95]
v_exp_f32 v27, v27
v_mfma_f32_16x16x32_bf16 v[44:47], a[20:23], a[212:215], v[44:47]
v_exp_f32 v28, v28
v_mfma_f32_16x16x32_bf16 v[44:47], a[24:27], a[216:219], v[44:47]
s_waitcnt vmcnt(16) lgkmcnt(0)
v_exp_f32 v29, v29
v_mfma_f32_16x16x32_bf16 v[44:47], a[28:31], a[220:223], v[44:47]
s_barrier
s_cbranch_scc1 L_att_seven
s_cmp_ge_u32 s4, 2
s_cbranch_scc1 L_att_sh0_1
L_att_sh0_0:
v_mfma_f32_16x16x32_bf16 v[192:195], a[32:35], v[56:59], v[192:195]
v_exp_f32 v30, v30
v_mfma_f32_16x16x32_bf16 v[224:227], a[32:35], v[60:63], v[224:227]
buffer_load_dword v14, v15, s[84:87], 0 offen offset:192 sc1
v_mfma_f32_16x16x32_bf16 v[228:231], a[36:39], v[60:63], v[228:231]
v_exp_f32 v31, v31
v_mfma_f32_16x16x32_bf16 v[196:199], a[36:39], v[56:59], v[196:199]
s_add_u32 m0, s17, 0x10000
v_exp_f32 v40, v40
v_mfma_f32_16x16x32_bf16 v[200:203], a[40:43], v[56:59], v[200:203]
ds_read_b128 a[0:3], v1 offset:8192
v_cvt_pk_bf16_f32 v72, v24, v25
v_mfma_f32_16x16x32_bf16 v[232:235], a[40:43], v[60:63], v[232:235]
ds_read_b128 a[4:7], v1 offset:9216
v_cvt_pk_bf16_f32 v73, v26, v27
v_mfma_f32_16x16x32_bf16 v[236:239], a[44:47], v[60:63], v[236:239]
buffer_load_dwordx4 v12, s[72:75], 0 offen lds
v_mfma_f32_16x16x32_bf16 v[204:207], a[44:47], v[56:59], v[204:207]
ds_read_b128 a[8:11], v1 offset:10240
v_cvt_pk_bf16_f32 v76, v28, v29
v_mfma_f32_16x16x32_bf16 v[208:211], a[48:51], v[56:59], v[208:211]
buffer_load_dwordx4 v13, s[72:75], 0 offen offset:1024 lds
v_mfma_f32_16x16x32_bf16 v[240:243], a[48:51], v[60:63], v[240:243]
ds_read_b128 a[12:15], v1 offset:11264
v_cvt_pk_bf16_f32 v77, v30, v31
v_mfma_f32_16x16x32_bf16 v[244:247], a[52:55], v[60:63], v[244:247]
buffer_load_dwordx4 v12, s[72:75], s12 offen offset:2048 lds
v_mfma_f32_16x16x32_bf16 v[212:215], a[52:55], v[56:59], v[212:215]
ds_read_b128 a[16:19], v1 offset:12288
v_exp_f32 v41, v41
v_mfma_f32_16x16x32_bf16 v[216:219], a[56:59], v[56:59], v[216:219]
ds_read_b128 a[20:23], v1 offset:13312
v_cvt_pk_bf16_f32 v74, v40, v41
v_mfma_f32_16x16x32_bf16 v[248:251], a[56:59], v[60:63], v[248:251]
ds_read_b128 a[24:27], v1 offset:14336
v_exp_f32 v42, v42
v_mfma_f32_16x16x32_bf16 v[252:255], a[60:63], v[60:63], v[252:255]
buffer_load_dwordx4 v13, s[72:75], s12 offen offset:3072 lds
v_mfma_f32_16x16x32_bf16 v[220:223], a[60:63], v[56:59], v[220:223]
ds_read_b128 a[28:31], v1 offset:15360
s_waitcnt lgkmcnt(4)
v_mfma_f32_16x16x32_bf16 a[232:235], a[240:243], v[56:59], a[232:235]
s_add_u32 m0, s17, 0x14000
v_exp_f32 v43, v43
v_mfma_f32_16x16x32_bf16 a[236:239], a[240:243], v[60:63], a[236:239]
ds_read_b128 a[32:35], v1 offset:0
v_add_u32 v12, 0x20000, v12
v_mfma_f32_16x16x32_bf16 v[24:27], a[0:3], a[192:195], v[112:115]
buffer_load_dwordx4 v12, s[72:75], 0 offen lds
v_mfma_f32_16x16x32_bf16 v[24:27], a[4:7], a[196:199], v[24:27]
ds_read_b128 a[36:39], v1 offset:1024
v_cvt_pk_bf16_f32 v75, v42, v43
v_mfma_f32_16x16x32_bf16 v[24:27], a[8:11], a[200:203], v[24:27]
ds_read_b128 a[40:43], v1 offset:2048
v_exp_f32 v44, v44
v_mfma_f32_16x16x32_bf16 v[24:27], a[12:15], a[204:207], v[24:27]
ds_read_b128 a[44:47], v1 offset:3072
v_exp_f32 v45, v45
v_mfma_f32_16x16x32_bf16 v[28:31], a[0:3], a[208:211], v[92:95]
v_exp_f32 v46, v46
v_mfma_f32_16x16x32_bf16 v[28:31], a[4:7], a[212:215], v[28:31]
ds_read_b128 a[48:51], v1 offset:4096
v_add_u32 v13, 0x20000, v13
v_mfma_f32_16x16x32_bf16 v[28:31], a[8:11], a[216:219], v[28:31]
s_waitcnt lgkmcnt(5)
v_exp_f32 v47, v47
v_mfma_f32_16x16x32_bf16 v[28:31], a[12:15], a[220:223], v[28:31]
buffer_load_dwordx4 v13, s[72:75], 0 offen offset:1024 lds
v_mfma_f32_16x16x32_bf16 v[40:43], a[16:19], a[192:195], v[116:119]
ds_read_b128 a[52:55], v1 offset:5120
v_exp_f32 v24, v24
v_mfma_f32_16x16x32_bf16 v[40:43], a[20:23], a[196:199], v[40:43]
buffer_load_dwordx4 v12, s[72:75], s12 offen offset:2048 lds
v_mfma_f32_16x16x32_bf16 v[40:43], a[24:27], a[200:203], v[40:43]
ds_read_b128 a[56:59], v1 offset:6144
v_exp_f32 v25, v25
v_mfma_f32_16x16x32_bf16 v[40:43], a[28:31], a[204:207], v[40:43]
ds_read_b128 a[60:63], v1 offset:7168
v_cvt_pk_bf16_f32 v78, v44, v45
v_cvt_pk_bf16_f32 v79, v46, v47
v_mfma_f32_16x16x32_bf16 v[44:47], a[16:19], a[208:211], v[92:95]
buffer_load_dwordx4 v13, s[72:75], s12 offen offset:3072 lds
v_mfma_f32_16x16x32_bf16 v[44:47], a[20:23], a[212:215], v[44:47]
v_exp_f32 v26, v26
v_mfma_f32_16x16x32_bf16 v[44:47], a[24:27], a[216:219], v[44:47]
v_exp_f32 v27, v27
v_mfma_f32_16x16x32_bf16 v[44:47], a[28:31], a[220:223], v[44:47]
s_waitcnt lgkmcnt(0)
v_exp_f32 v28, v28
v_exp_f32 v29, v29
v_mfma_f32_16x16x32_bf16 v[192:195], a[32:35], v[72:75], v[192:195]
ds_read_b128 a[0:3], v1 offset:24576
v_cvt_pk_bf16_f32 v56, v24, v25
v_mfma_f32_16x16x32_bf16 v[224:227], a[32:35], v[76:79], v[224:227]
ds_read_b128 a[4:7], v1 offset:25600
v_add_u32 v12, 0x20000, v12
v_mfma_f32_16x16x32_bf16 v[228:231], a[36:39], v[76:79], v[228:231]
s_add_u32 m0, s16, 0x0
v_exp_f32 v30, v30
v_mfma_f32_16x16x32_bf16 v[196:199], a[36:39], v[72:75], v[196:199]
buffer_load_dwordx4 v12, s[72:75], 0 offen lds
v_mfma_f32_16x16x32_bf16 v[200:203], a[40:43], v[72:75], v[200:203]
ds_read_b128 a[8:11], v1 offset:26624
v_add_u32 v13, 0x20000, v13
v_mfma_f32_16x16x32_bf16 v[232:235], a[40:43], v[76:79], v[232:235]
buffer_load_dwordx4 v13, s[72:75], 0 offen offset:1024 lds
v_mfma_f32_16x16x32_bf16 v[236:239], a[44:47], v[76:79], v[236:239]
ds_read_b128 a[12:15], v1 offset:27648
v_cvt_pk_bf16_f32 v57, v26, v27
v_mfma_f32_16x16x32_bf16 v[204:207], a[44:47], v[72:75], v[204:207]
buffer_load_dwordx4 v12, s[72:75], s12 offen offset:2048 lds
v_mfma_f32_16x16x32_bf16 v[208:211], a[48:51], v[72:75], v[208:211]
ds_read_b128 a[16:19], v1 offset:28672
v_cvt_pk_bf16_f32 v60, v28, v29
v_mfma_f32_16x16x32_bf16 v[240:243], a[48:51], v[76:79], v[240:243]
buffer_load_dwordx4 v13, s[72:75], s12 offen offset:3072 lds
v_mfma_f32_16x16x32_bf16 v[244:247], a[52:55], v[76:79], v[244:247]
ds_read_b128 a[20:23], v1 offset:29696
v_exp_f32 v31, v31
v_mfma_f32_16x16x32_bf16 v[212:215], a[52:55], v[72:75], v[212:215]
ds_read_b128 a[24:27], v1 offset:30720
s_add_u32 m0, s16, 0x4000
v_mfma_f32_16x16x32_bf16 v[216:219], a[56:59], v[72:75], v[216:219]
ds_read_b128 a[28:31], v1 offset:31744
v_add_u32 v12, 0x20000, v12
v_mfma_f32_16x16x32_bf16 v[248:251], a[56:59], v[76:79], v[248:251]
buffer_load_dwordx4 v12, s[72:75], 0 offen lds
v_mfma_f32_16x16x32_bf16 v[252:255], a[60:63], v[76:79], v[252:255]
ds_read_b128 a[32:35], v1 offset:16384
v_cvt_pk_bf16_f32 v61, v30, v31
v_mfma_f32_16x16x32_bf16 v[220:223], a[60:63], v[72:75], v[220:223]
ds_read_b128 a[36:39], v1 offset:17408
v_add_u32 v13, 0x20000, v13
v_mfma_f32_16x16x32_bf16 a[232:235], a[240:243], v[72:75], a[232:235]
buffer_load_dwordx4 v13, s[72:75], 0 offen offset:1024 lds
v_mfma_f32_16x16x32_bf16 a[236:239], a[240:243], v[76:79], a[236:239]
ds_read_b128 a[40:43], v1 offset:18432
s_waitcnt lgkmcnt(7)
v_mfma_f32_16x16x32_bf16 v[28:31], a[0:3], a[208:211], v[92:95]
ds_read_b128 a[44:47], v1 offset:19456
v_exp_f32 v40, v40
v_mfma_f32_16x16x32_bf16 v[28:31], a[4:7], a[212:215], v[28:31]
buffer_load_dwordx4 v12, s[72:75], s12 offen offset:2048 lds
v_mfma_f32_16x16x32_bf16 v[28:31], a[8:11], a[216:219], v[28:31]
ds_read_b128 a[48:51], v1 offset:20480
v_exp_f32 v41, v41
v_mfma_f32_16x16x32_bf16 v[28:31], a[12:15], a[220:223], v[28:31]
ds_read_b128 a[52:55], v1 offset:21504
s_waitcnt lgkmcnt(6)
v_exp_f32 v42, v42
v_exp_f32 v43, v43
v_exp_f32 v44, v44
v_exp_f32 v45, v45
v_exp_f32 v46, v46
v_exp_f32 v47, v47
v_cvt_pk_bf16_f32 v62, v44, v45
v_cvt_pk_bf16_f32 v63, v46, v47
v_mfma_f32_16x16x32_bf16 v[44:47], a[16:19], a[208:211], v[92:95]
buffer_load_dwordx4 v13, s[72:75], s12 offen offset:3072 lds
v_mfma_f32_16x16x32_bf16 v[44:47], a[20:23], a[212:215], v[44:47]
ds_read_b128 a[56:59], v1 offset:22528
v_cvt_pk_bf16_f32 v58, v40, v41
v_mfma_f32_16x16x32_bf16 v[44:47], a[24:27], a[216:219], v[44:47]
ds_read_b128 a[60:63], v1 offset:23552
v_xor_b32 v1, 0x8000, v1
v_mfma_f32_16x16x32_bf16 v[44:47], a[28:31], a[220:223], v[44:47]
v_cvt_pk_bf16_f32 v59, v42, v43
L_att_h1_0:
s_waitcnt vmcnt(16) lgkmcnt(0)
s_mov_b32 s92, 200000
L_spin_b0:
v_cmp_gt_u32 vcc, 32, v14
s_nop 4
s_cbranch_vccz L_spun_b0
s_sub_u32 s92, s92, 1
s_cbranch_scc1 L_spun_b0
s_sleep 2
buffer_load_dword v14, v15, s[84:87], 0 offen offset:192 sc1
s_waitcnt vmcnt(0)
s_branch L_spin_b0
L_spun_b0:
s_barrier
v_mfma_f32_16x16x32_bf16 v[192:195], a[32:35], v[56:59], v[192:195]
v_exp_f32 v28, v28
v_mfma_f32_16x16x32_bf16 v[224:227], a[32:35], v[60:63], v[224:227]
s_add_u32 s101, s101, 0x2000
v_exp_f32 v29, v29
v_mfma_f32_16x16x32_bf16 v[228:231], a[36:39], v[60:63], v[228:231]
ds_read_b128 a[0:3], v2 offset:8192
v_cvt_pk_bf16_f32 v76, v28, v29
v_mfma_f32_16x16x32_bf16 v[196:199], a[36:39], v[56:59], v[196:199]
buffer_load_dwordx4 a[64:67], v3, s[88:91], s101 offen sc1
v_mfma_f32_16x16x32_bf16 v[200:203], a[40:43], v[56:59], v[200:203]
ds_read_b128 a[4:7], v2 offset:9216
v_exp_f32 v30, v30
v_mfma_f32_16x16x32_bf16 v[232:235], a[40:43], v[60:63], v[232:235]
ds_read_b128 a[8:11], v2 offset:10240
v_exp_f32 v31, v31
v_mfma_f32_16x16x32_bf16 v[236:239], a[44:47], v[60:63], v[236:239]
buffer_load_dwordx4 a[68:71], v3, s[88:91], s101 offen offset:1024 sc1
v_mfma_f32_16x16x32_bf16 v[204:207], a[44:47], v[56:59], v[204:207]
ds_read_b128 a[12:15], v2 offset:11264
s_add_u32 s101, s101, 0x2000
v_mfma_f32_16x16x32_bf16 v[208:211], a[48:51], v[56:59], v[208:211]
buffer_load_dwordx4 a[72:75], v3, s[88:91], s101 offen sc1
v_mfma_f32_16x16x32_bf16 v[240:243], a[48:51], v[60:63], v[240:243]
ds_read_b128 a[16:19], v2 offset:12288
v_exp_f32 v44, v44
v_mfma_f32_16x16x32_bf16 v[244:247], a[52:55], v[60:63], v[244:247]
buffer_load_dwordx4 a[76:79], v3, s[88:91], s101 offen offset:1024 sc1
v_mfma_f32_16x16x32_bf16 v[212:215], a[52:55], v[56:59], v[212:215]
ds_read_b128 a[20:23], v2 offset:13312
v_exp_f32 v45, v45
v_mfma_f32_16x16x32_bf16 v[216:219], a[56:59], v[56:59], v[216:219]
ds_read_b128 a[24:27], v2 offset:14336
v_exp_f32 v46, v46
v_mfma_f32_16x16x32_bf16 v[248:251], a[56:59], v[60:63], v[248:251]
ds_read_b128 a[28:31], v2 offset:15360
v_exp_f32 v47, v47
v_mfma_f32_16x16x32_bf16 v[252:255], a[60:63], v[60:63], v[252:255]
ds_read_b128 a[32:35], v2 offset:0
s_add_u32 s101, s101, 0x2000
v_mfma_f32_16x16x32_bf16 v[220:223], a[60:63], v[56:59], v[220:223]
buffer_load_dwordx4 a[80:83], v3, s[88:91], s101 offen sc1
v_mfma_f32_16x16x32_bf16 a[232:235], a[240:243], v[56:59], a[232:235]
ds_read_b128 a[36:39], v2 offset:1024
s_waitcnt lgkmcnt(6)
v_mfma_f32_16x16x32_bf16 a[236:239], a[240:243], v[60:63], a[236:239]
buffer_load_dwordx4 a[84:87], v3, s[88:91], s101 offen offset:1024 sc1
v_cvt_pk_bf16_f32 v77, v30, v31
v_mfma_f32_16x16x32_bf16 v[28:31], a[0:3], a[208:211], v[92:95]
ds_read_b128 a[40:43], v2 offset:2048
v_cvt_pk_bf16_f32 v78, v44, v45
v_mfma_f32_16x16x32_bf16 v[28:31], a[4:7], a[212:215], v[28:31]
ds_read_b128 a[44:47], v2 offset:3072
s_waitcnt lgkmcnt(4)
v_mfma_f32_16x16x32_bf16 v[28:31], a[8:11], a[216:219], v[28:31]
ds_read_b128 a[48:51], v2 offset:4096
s_add_u32 s101, s101, 0x2000
v_mfma_f32_16x16x32_bf16 v[28:31], a[12:15], a[220:223], v[28:31]
buffer_load_dwordx4 a[88:91], v3, s[88:91], s101 offen sc1
v_cvt_pk_bf16_f32 v79, v46, v47
v_mfma_f32_16x16x32_bf16 v[44:47], a[16:19], a[208:211], v[92:95]
ds_read_b128 a[52:55], v2 offset:5120
v_mfma_f32_16x16x32_bf16 v[44:47], a[20:23], a[212:215], v[44:47]
buffer_load_dwordx4 a[92:95], v3, s[88:91], s101 offen offset:1024 sc1
v_mfma_f32_16x16x32_bf16 v[44:47], a[24:27], a[216:219], v[44:47]
ds_read_b128 a[56:59], v2 offset:6144
v_mfma_f32_16x16x32_bf16 v[44:47], a[28:31], a[220:223], v[44:47]
ds_read_b128 a[60:63], v2 offset:7168
s_waitcnt lgkmcnt(0)
v_mfma_f32_16x16x32_bf16 v[224:227], a[32:35], v[76:79], v[224:227]
ds_read_b128 a[0:3], v2 offset:24576
s_add_u32 s101, s101, 0x2000
v_mfma_f32_16x16x32_bf16 v[228:231], a[36:39], v[76:79], v[228:231]
buffer_load_dwordx4 a[96:99], v3, s[88:91], s101 offen sc1
v_mfma_f32_16x16x32_bf16 v[232:235], a[40:43], v[76:79], v[232:235]
ds_read_b128 a[4:7], v2 offset:25600
v_exp_f32 v28, v28
v_mfma_f32_16x16x32_bf16 v[236:239], a[44:47], v[76:79], v[236:239]
buffer_load_dwordx4 a[100:103], v3, s[88:91], s101 offen offset:1024 sc1
v_mfma_f32_16x16x32_bf16 v[240:243], a[48:51], v[76:79], v[240:243]
ds_read_b128 a[8:11], v2 offset:26624
s_add_u32 s101, s101, 0x2000
v_mfma_f32_16x16x32_bf16 v[244:247], a[52:55], v[76:79], v[244:247]
buffer_load_dwordx4 a[104:107], v3, s[88:91], s101 offen sc1
v_mfma_f32_16x16x32_bf16 v[248:251], a[56:59], v[76:79], v[248:251]
ds_read_b128 a[12:15], v2 offset:27648
s_waitcnt lgkmcnt(0)
v_mfma_f32_16x16x32_bf16 v[252:255], a[60:63], v[76:79], v[252:255]
buffer_load_dwordx4 a[108:111], v3, s[88:91], s101 offen offset:1024 sc1
ds_read_b128 a[16:19], v2 offset:28672
v_mfma_f32_16x16x32_bf16 a[236:239], a[240:243], v[76:79], a[236:239]
ds_read_b128 a[20:23], v2 offset:29696
s_add_u32 s101, s101, 0x2000
v_exp_f32 v29, v29
v_exp_f32 v30, v30
v_exp_f32 v31, v31
v_cvt_pk_bf16_f32 v60, v28, v29
v_cvt_pk_bf16_f32 v61, v30, v31
v_mfma_f32_16x16x32_bf16 v[28:31], a[0:3], a[208:211], v[120:123]
buffer_load_dwordx4 a[112:115], v3, s[88:91], s101 offen sc1
ds_read_b128 a[24:27], v2 offset:30720
v_mfma_f32_16x16x32_bf16 v[28:31], a[4:7], a[212:215], v[28:31]
ds_read_b128 a[28:31], v2 offset:31744
s_waitcnt lgkmcnt(0)
v_mfma_f32_16x16x32_bf16 v[28:31], a[8:11], a[216:219], v[28:31]
buffer_load_dwordx4 a[116:119], v3, s[88:91], s101 offen offset:1024 sc1
v_mfma_f32_16x16x32_bf16 v[28:31], a[12:15], a[220:223], v[28:31]
ds_read_b128 a[32:35], v2 offset:16384
s_add_u32 s101, s101, 0x2000
v_exp_f32 v44, v44
v_exp_f32 v45, v45
v_exp_f32 v46, v46
v_exp_f32 v47, v47
v_cvt_pk_bf16_f32 v62, v44, v45
v_cvt_pk_bf16_f32 v63, v46, v47
v_mfma_f32_16x16x32_bf16 v[44:47], a[16:19], a[208:211], v[124:127]
buffer_load_dwordx4 a[120:123], v3, s[88:91], s101 offen sc1
v_mfma_f32_16x16x32_bf16 v[44:47], a[20:23], a[212:215], v[44:47]
buffer_load_dwordx4 a[124:127], v3, s[88:91], s101 offen offset:1024 sc1
v_mfma_f32_16x16x32_bf16 v[44:47], a[24:27], a[216:219], v[44:47]
ds_read_b128 a[36:39], v2 offset:17408
v_mfma_f32_16x16x32_bf16 v[44:47], a[28:31], a[220:223], v[44:47]
ds_read_b128 a[40:43], v2 offset:18432
ds_read_b128 a[44:47], v2 offset:19456
ds_read_b128 a[48:51], v2 offset:20480
ds_read_b128 a[52:55], v2 offset:21504
ds_read_b128 a[56:59], v2 offset:22528
ds_read_b128 a[60:63], v2 offset:23552
v_xor_b32 v2, 0x38000, v2
s_waitcnt lgkmcnt(0)
s_barrier
v_exp_f32 v28, v28
v_exp_f32 v29, v29
v_exp_f32 v30, v30
v_exp_f32 v31, v31
v_exp_f32 v44, v44
v_exp_f32 v45, v45
v_exp_f32 v46, v46
v_exp_f32 v47, v47
v_cvt_pk_bf16_f32 v76, v28, v29
v_cvt_pk_bf16_f32 v77, v30, v31
v_cvt_pk_bf16_f32 v78, v44, v45
v_cvt_pk_bf16_f32 v79, v46, v47
v_mfma_f32_16x16x32_bf16 v[224:227], a[32:35], v[60:63], v[224:227]
v_mfma_f32_16x16x32_bf16 v[228:231], a[36:39], v[60:63], v[228:231]
v_mfma_f32_16x16x32_bf16 v[232:235], a[40:43], v[60:63], v[232:235]
v_mfma_f32_16x16x32_bf16 v[236:239], a[44:47], v[60:63], v[236:239]
v_mfma_f32_16x16x32_bf16 v[240:243], a[48:51], v[60:63], v[240:243]
v_mfma_f32_16x16x32_bf16 v[244:247], a[52:55], v[60:63], v[244:247]
v_mfma_f32_16x16x32_bf16 v[248:251], a[56:59], v[60:63], v[248:251]
v_mfma_f32_16x16x32_bf16 v[252:255], a[60:63], v[60:63], v[252:255]
v_mfma_f32_16x16x32_bf16 a[236:239], a[240:243], v[60:63], a[236:239]
ds_read_b128 a[32:35], v1 offset:0
ds_read_b128 a[36:39], v1 offset:1024
ds_read_b128 a[40:43], v1 offset:2048
ds_read_b128 a[44:47], v1 offset:3072
ds_read_b128 a[48:51], v1 offset:4096
ds_read_b128 a[52:55], v1 offset:5120
ds_read_b128 a[56:59], v1 offset:6144
ds_read_b128 a[60:63], v1 offset:7168
s_waitcnt lgkmcnt(0)
v_mfma_f32_16x16x32_bf16 v[224:227], a[32:35], v[76:79], v[224:227]
v_mfma_f32_16x16x32_bf16 v[228:231], a[36:39], v[76:79], v[228:231]
v_mfma_f32_16x16x32_bf16 v[232:235], a[40:43], v[76:79], v[232:235]
v_mfma_f32_16x16x32_bf16 v[236:239], a[44:47], v[76:79], v[236:239]
v_mfma_f32_16x16x32_bf16 v[240:243], a[48:51], v[76:79], v[240:243]
v_mfma_f32_16x16x32_bf16 v[244:247], a[52:55], v[76:79], v[244:247]
v_mfma_f32_16x16x32_bf16 v[248:251], a[56:59], v[76:79], v[248:251]
v_mfma_f32_16x16x32_bf16 v[252:255], a[60:63], v[76:79], v[252:255]
v_mfma_f32_16x16x32_bf16 a[236:239], a[240:243], v[76:79], a[236:239]
v_xor_b32 v1, 0x8000, v1
s_branch L_att_fin
L_att_sh0_1:
v_mfma_f32_16x16x32_bf16 v[192:195], a[32:35], v[56:59], v[192:195]
v_exp_f32 v30, v30
v_mfma_f32_16x16x32_bf16 v[224:227], a[32:35], v[60:63], v[224:227]
buffer_load_dword v14, v15, s[84:87], 0 offen offset:192 sc1
v_mfma_f32_16x16x32_bf16 v[228:231], a[36:39], v[60:63], v[228:231]
v_exp_f32 v31, v31
v_mfma_f32_16x16x32_bf16 v[196:199], a[36:39], v[56:59], v[196:199]
s_add_u32 m0, s17, 0x10000
v_exp_f32 v40, v40
v_mfma_f32_16x16x32_bf16 v[200:203], a[40:43], v[56:59], v[200:203]
ds_read_b128 a[0:3], v1 offset:8192
v_cvt_pk_bf16_f32 v72, v24, v25
v_mfma_f32_16x16x32_bf16 v[232:235], a[40:43], v[60:63], v[232:235]
ds_read_b128 a[4:7], v1 offset:9216
v_cvt_pk_bf16_f32 v73, v26, v27
v_mfma_f32_16x16x32_bf16 v[236:239], a[44:47], v[60:63], v[236:239]
buffer_load_dwordx4 v12, s[72:75], 0 offen lds
v_mfma_f32_16x16x32_bf16 v[204:207], a[44:47], v[56:59], v[204:207]
ds_read_b128 a[8:11], v1 offset:10240
v_cvt_pk_bf16_f32 v76, v28, v29
v_mfma_f32_16x16x32_bf16 v[208:211], a[48:51], v[56:59], v[208:211]
buffer_load_dwordx4 v13, s[72:75], 0 offen offset:1024 lds
v_mfma_f32_16x16x32_bf16 v[240:243], a[48:51], v[60:63], v[240:243]
ds_read_b128 a[12:15], v1 offset:11264
v_cvt_pk_bf16_f32 v77, v30, v31
v_mfma_f32_16x16x32_bf16 v[244:247], a[52:55], v[60:63], v[244:247]
buffer_load_dwordx4 v12, s[72:75], s12 offen offset:2048 lds
v_mfma_f32_16x16x32_bf16 v[212:215], a[52:55], v[56:59], v[212:215]
ds_read_b128 a[16:19], v1 offset:12288
v_exp_f32 v41, v41
v_mfma_f32_16x16x32_bf16 v[216:219], a[56:59], v[56:59], v[216:219]
ds_read_b128 a[20:23], v1 offset:13312
v_cvt_pk_bf16_f32 v74, v40, v41
v_mfma_f32_16x16x32_bf16 v[248:251], a[56:59], v[60:63], v[248:251]
ds_read_b128 a[24:27], v1 offset:14336
v_exp_f32 v42, v42
v_mfma_f32_16x16x32_bf16 v[252:255], a[60:63], v[60:63], v[252:255]
buffer_load_dwordx4 v13, s[72:75], s12 offen offset:3072 lds
v_mfma_f32_16x16x32_bf16 v[220:223], a[60:63], v[56:59], v[220:223]
ds_read_b128 a[28:31], v1 offset:15360
s_waitcnt lgkmcnt(4)
v_mfma_f32_16x16x32_bf16 a[232:235], a[240:243], v[56:59], a[232:235]
s_add_u32 m0, s17, 0x14000
v_exp_f32 v43, v43
v_mfma_f32_16x16x32_bf16 a[236:239], a[240:243], v[60:63], a[236:239]
ds_read_b128 a[32:35], v1 offset:0
v_add_u32 v12, 0x20000, v12
v_mfma_f32_16x16x32_bf16 v[24:27], a[0:3], a[192:195], v[88:91]
buffer_load_dwordx4 v12, s[72:75], 0 offen lds
v_mfma_f32_16x16x32_bf16 v[24:27], a[4:7], a[196:199], v[24:27]
ds_read_b128 a[36:39], v1 offset:1024
v_cvt_pk_bf16_f32 v75, v42, v43
v_mfma_f32_16x16x32_bf16 v[24:27], a[8:11], a[200:203], v[24:27]
ds_read_b128 a[40:43], v1 offset:2048
v_exp_f32 v44, v44
v_mfma_f32_16x16x32_bf16 v[24:27], a[12:15], a[204:207], v[24:27]
ds_read_b128 a[44:47], v1 offset:3072
v_exp_f32 v45, v45
v_mfma_f32_16x16x32_bf16 v[28:31], a[0:3], a[208:211], v[92:95]
v_exp_f32 v46, v46
v_mfma_f32_16x16x32_bf16 v[28:31], a[4:7], a[212:215], v[28:31]
ds_read_b128 a[48:51], v1 offset:4096
v_add_u32 v13, 0x20000, v13
v_mfma_f32_16x16x32_bf16 v[28:31], a[8:11], a[216:219], v[28:31]
s_waitcnt lgkmcnt(5)
v_exp_f32 v47, v47
v_mfma_f32_16x16x32_bf16 v[28:31], a[12:15], a[220:223], v[28:31]
buffer_load_dwordx4 v13, s[72:75], 0 offen offset:1024 lds
v_mfma_f32_16x16x32_bf16 v[40:43], a[16:19], a[192:195], v[88:91]
ds_read_b128 a[52:55], v1 offset:5120
v_exp_f32 v24, v24
v_mfma_f32_16x16x32_bf16 v[40:43], a[20:23], a[196:199], v[40:43]
buffer_load_dwordx4 v12, s[72:75], s12 offen offset:2048 lds
v_mfma_f32_16x16x32_bf16 v[40:43], a[24:27], a[200:203], v[40:43]
ds_read_b128 a[56:59], v1 offset:6144
v_exp_f32 v25, v25
v_mfma_f32_16x16x32_bf16 v[40:43], a[28:31], a[204:207], v[40:43]
ds_read_b128 a[60:63], v1 offset:7168
v_cvt_pk_bf16_f32 v78, v44, v45
v_cvt_pk_bf16_f32 v79, v46, v47
v_mfma_f32_16x16x32_bf16 v[44:47], a[16:19], a[208:211], v[92:95]
buffer_load_dwordx4 v13, s[72:75], s12 offen offset:3072 lds
v_mfma_f32_16x16x32_bf16 v[44:47], a[20:23], a[212:215], v[44:47]
v_exp_f32 v26, v26
v_mfma_f32_16x16x32_bf16 v[44:47], a[24:27], a[216:219], v[44:47]
v_exp_f32 v27, v27
v_mfma_f32_16x16x32_bf16 v[44:47], a[28:31], a[220:223], v[44:47]
s_waitcnt lgkmcnt(0)
v_exp_f32 v28, v28
v_exp_f32 v29, v29
v_mfma_f32_16x16x32_bf16 v[192:195], a[32:35], v[72:75], v[192:195]
v_exp_f32 v30, v30
v_mfma_f32_16x16x32_bf16 v[224:227], a[32:35], v[76:79], v[224:227]
s_add_u32 m0, s16, 0x0
v_exp_f32 v31, v31
v_mfma_f32_16x16x32_bf16 v[228:231], a[36:39], v[76:79], v[228:231]
ds_read_b128 a[0:3], v1 offset:24576
v_add_u32 v12, 0x20000, v12
v_mfma_f32_16x16x32_bf16 v[196:199], a[36:39], v[72:75], v[196:199]
buffer_load_dwordx4 v12, s[72:75], 0 offen lds
v_mfma_f32_16x16x32_bf16 v[200:203], a[40:43], v[72:75], v[200:203]
ds_read_b128 a[4:7], v1 offset:25600
v_cvt_pk_bf16_f32 v56, v24, v25
v_mfma_f32_16x16x32_bf16 v[232:235], a[40:43], v[76:79], v[232:235]
ds_read_b128 a[8:11], v1 offset:26624
v_cvt_pk_bf16_f32 v57, v26, v27
v_mfma_f32_16x16x32_bf16 v[236:239], a[44:47], v[76:79], v[236:239]
ds_read_b128 a[12:15], v1 offset:27648
v_add_u32 v13, 0x20000, v13
v_mfma_f32_16x16x32_bf16 v[204:207], a[44:47], v[72:75], v[204:207]
buffer_load_dwordx4 v13, s[72:75], 0 offen offset:1024 lds
v_mfma_f32_16x16x32_bf16 v[208:211], a[48:51], v[72:75], v[208:211]
v_exp_f32 v40, v40
v_mfma_f32_16x16x32_bf16 v[240:243], a[48:51], v[76:79], v[240:243]
buffer_load_dwordx4 v12, s[72:75], s12 offen offset:2048 lds
v_mfma_f32_16x16x32_bf16 v[244:247], a[52:55], v[76:79], v[244:247]
ds_read_b128 a[16:19], v1 offset:28672
v_cvt_pk_bf16_f32 v60, v28, v29
v_mfma_f32_16x16x32_bf16 v[212:215], a[52:55], v[72:75], v[212:215]
ds_read_b128 a[20:23], v1 offset:29696
v_cvt_pk_bf16_f32 v61, v30, v31
v_mfma_f32_16x16x32_bf16 v[216:219], a[56:59], v[72:75], v[216:219]
ds_read_b128 a[24:27], v1 offset:30720
v_exp_f32 v41, v41
v_mfma_f32_16x16x32_bf16 v[248:251], a[56:59], v[76:79], v[248:251]
buffer_load_dwordx4 v13, s[72:75], s12 offen offset:3072 lds
v_mfma_f32_16x16x32_bf16 v[252:255], a[60:63], v[76:79], v[252:255]
ds_read_b128 a[28:31], v1 offset:31744
v_exp_f32 v42, v42
v_mfma_f32_16x16x32_bf16 v[220:223], a[60:63], v[72:75], v[220:223]
ds_read_b128 a[32:35], v1 offset:16384
v_cvt_pk_bf16_f32 v58, v40, v41
v_mfma_f32_16x16x32_bf16 a[232:235], a[240:243], v[72:75], a[232:235]
s_waitcnt lgkmcnt(5)
v_exp_f32 v43, v43
v_mfma_f32_16x16x32_bf16 a[236:239], a[240:243], v[76:79], a[236:239]
s_add_u32 m0, s16, 0x4000
v_exp_f32 v44, v44
v_mfma_f32_16x16x32_bf16 v[24:27], a[0:3], a[192:195], v[112:115]
ds_read_b128 a[36:39], v1 offset:17408
v_add_u32 v12, 0x20000, v12
v_mfma_f32_16x16x32_bf16 v[24:27], a[4:7], a[196:199], v[24:27]
buffer_load_dwordx4 v12, s[72:75], 0 offen lds
v_mfma_f32_16x16x32_bf16 v[24:27], a[8:11], a[200:203], v[24:27]
ds_read_b128 a[40:43], v1 offset:18432
v_cvt_pk_bf16_f32 v59, v42, v43
v_mfma_f32_16x16x32_bf16 v[24:27], a[12:15], a[204:207], v[24:27]
ds_read_b128 a[44:47], v1 offset:19456
v_add_u32 v13, 0x20000, v13
v_mfma_f32_16x16x32_bf16 v[28:31], a[0:3], a[208:211], v[92:95]
buffer_load_dwordx4 v13, s[72:75], 0 offen offset:1024 lds
v_mfma_f32_16x16x32_bf16 v[28:31], a[4:7], a[212:215], v[28:31]
ds_read_b128 a[48:51], v1 offset:20480
v_exp_f32 v45, v45
v_mfma_f32_16x16x32_bf16 v[28:31], a[8:11], a[216:219], v[28:31]
s_waitcnt lgkmcnt(5)
v_exp_f32 v46, v46
v_mfma_f32_16x16x32_bf16 v[28:31], a[12:15], a[220:223], v[28:31]
ds_read_b128 a[52:55], v1 offset:21504
v_cvt_pk_bf16_f32 v62, v44, v45
v_mfma_f32_16x16x32_bf16 v[40:43], a[16:19], a[192:195], v[116:119]
ds_read_b128 a[56:59], v1 offset:22528
v_exp_f32 v47, v47
v_mfma_f32_16x16x32_bf16 v[40:43], a[20:23], a[196:199], v[40:43]
buffer_load_dwordx4 v12, s[72:75], s12 offen offset:2048 lds
v_mfma_f32_16x16x32_bf16 v[40:43], a[24:27], a[200:203], v[40:43]
ds_read_b128 a[60:63], v1 offset:23552
v_xor_b32 v1, 0x8000, v1
v_mfma_f32_16x16x32_bf16 v[40:43], a[28:31], a[204:207], v[40:43]
buffer_load_dwordx4 v13, s[72:75], s12 offen offset:3072 lds
v_cvt_pk_bf16_f32 v63, v46, v47
v_mfma_f32_16x16x32_bf16 v[44:47], a[16:19], a[208:211], v[92:95]
v_exp_f32 v24, v24
v_mfma_f32_16x16x32_bf16 v[44:47], a[20:23], a[212:215], v[44:47]
v_exp_f32 v25, v25
v_mfma_f32_16x16x32_bf16 v[44:47], a[24:27], a[216:219], v[44:47]
v_exp_f32 v26, v26
v_mfma_f32_16x16x32_bf16 v[44:47], a[28:31], a[220:223], v[44:47]
v_exp_f32 v27, v27
v_exp_f32 v28, v28
v_exp_f32 v29, v29
L_att_h1_1:
s_waitcnt vmcnt(16) lgkmcnt(0)
s_mov_b32 s92, 200000
L_spin_b1:
v_cmp_gt_u32 vcc, 32, v14
s_nop 4
s_cbranch_vccz L_spun_b1
s_sub_u32 s92, s92, 1
s_cbranch_scc1 L_spun_b1
s_sleep 2
buffer_load_dword v14, v15, s[84:87], 0 offen offset:192 sc1
s_waitcnt vmcnt(0)
s_branch L_spin_b1
L_spun_b1:
s_barrier
v_mfma_f32_16x16x32_bf16 v[192:195], a[32:35], v[56:59], v[192:195]
v_exp_f32 v30, v30
v_mfma_f32_16x16x32_bf16 v[224:227], a[32:35], v[60:63], v[224:227]
s_add_u32 s101, s101, 0x2000
v_exp_f32 v31, v31
v_mfma_f32_16x16x32_bf16 v[228:231], a[36:39], v[60:63], v[228:231]
ds_read_b128 a[0:3], v2 offset:8192
v_cvt_pk_bf16_f32 v72, v24, v25
v_mfma_f32_16x16x32_bf16 v[196:199], a[36:39], v[56:59], v[196:199]
buffer_load_dwordx4 a[64:67], v3, s[88:91], s101 offen sc1
v_mfma_f32_16x16x32_bf16 v[200:203], a[40:43], v[56:59], v[200:203]
ds_read_b128 a[4:7], v2 offset:9216
v_cvt_pk_bf16_f32 v73, v26, v27
v_mfma_f32_16x16x32_bf16 v[232:235], a[40:43], v[60:63], v[232:235]
ds_read_b128 a[8:11], v2 offset:10240
v_cvt_pk_bf16_f32 v76, v28, v29
v_mfma_f32_16x16x32_bf16 v[236:239], a[44:47], v[60:63], v[236:239]
buffer_load_dwordx4 a[68:71], v3, s[88:91], s101 offen offset:1024 sc1
v_mfma_f32_16x16x32_bf16 v[204:207], a[44:47], v[56:59], v[204:207]
ds_read_b128 a[12:15], v2 offset:11264
s_add_u32 s101, s101, 0x2000
v_mfma_f32_16x16x32_bf16 v[208:211], a[48:51], v[56:59], v[208:211]
buffer_load_dwordx4 a[72:75], v3, s[88:91], s101 offen sc1
v_mfma_f32_16x16x32_bf16 v[240:243], a[48:51], v[60:63], v[240:243]
ds_read_b128 a[16:19], v2 offset:12288
v_cvt_pk_bf16_f32 v77, v30, v31
v_mfma_f32_16x16x32_bf16 v[244:247], a[52:55], v[60:63], v[244:247]
buffer_load_dwordx4 a[76:79], v3, s[88:91], s101 offen offset:1024 sc1
v_mfma_f32_16x16x32_bf16 v[212:215], a[52:55], v[56:59], v[212:215]
ds_read_b128 a[20:23], v2 offset:13312
v_exp_f32 v40, v40
v_mfma_f32_16x16x32_bf16 v[216:219], a[56:59], v[56:59], v[216:219]
ds_read_b128 a[24:27], v2 offset:14336
v_exp_f32 v41, v41
v_mfma_f32_16x16x32_bf16 v[248:251], a[56:59], v[60:63], v[248:251]
ds_read_b128 a[28:31], v2 offset:15360
v_exp_f32 v42, v42
v_mfma_f32_16x16x32_bf16 v[252:255], a[60:63], v[60:63], v[252:255]
ds_read_b128 a[32:35], v2 offset:0
s_add_u32 s101, s101, 0x2000
v_mfma_f32_16x16x32_bf16 v[220:223], a[60:63], v[56:59], v[220:223]
buffer_load_dwordx4 a[80:83], v3, s[88:91], s101 offen sc1
v_mfma_f32_16x16x32_bf16 a[232:235], a[240:243], v[56:59], a[232:235]
ds_read_b128 a[36:39], v2 offset:1024
s_waitcnt lgkmcnt(6)
v_mfma_f32_16x16x32_bf16 a[236:239], a[240:243], v[60:63], a[236:239]
buffer_load_dwordx4 a[84:87], v3, s[88:91], s101 offen offset:1024 sc1
v_mfma_f32_16x16x32_bf16 v[28:31], a[0:3], a[208:211], v[120:123]
ds_read_b128 a[40:43], v2 offset:2048
v_exp_f32 v43, v43
v_mfma_f32_16x16x32_bf16 v[28:31], a[4:7], a[212:215], v[28:31]
ds_read_b128 a[44:47], v2 offset:3072
s_waitcnt lgkmcnt(4)
v_mfma_f32_16x16x32_bf16 v[28:31], a[8:11], a[216:219], v[28:31]
ds_read_b128 a[48:51], v2 offset:4096
s_add_u32 s101, s101, 0x2000
v_mfma_f32_16x16x32_bf16 v[28:31], a[12:15], a[220:223], v[28:31]
buffer_load_dwordx4 a[88:91], v3, s[88:91], s101 offen sc1
v_exp_f32 v44, v44
v_exp_f32 v45, v45
v_exp_f32 v46, v46
v_exp_f32 v47, v47
v_cvt_pk_bf16_f32 v78, v44, v45
v_cvt_pk_bf16_f32 v79, v46, v47
v_mfma_f32_16x16x32_bf16 v[44:47], a[16:19], a[208:211], v[124:127]
ds_read_b128 a[52:55], v2 offset:5120
v_cvt_pk_bf16_f32 v74, v40, v41
v_mfma_f32_16x16x32_bf16 v[44:47], a[20:23], a[212:215], v[44:47]
buffer_load_dwordx4 a[92:95], v3, s[88:91], s101 offen offset:1024 sc1
v_mfma_f32_16x16x32_bf16 v[44:47], a[24:27], a[216:219], v[44:47]
ds_read_b128 a[56:59], v2 offset:6144
v_cvt_pk_bf16_f32 v75, v42, v43
v_mfma_f32_16x16x32_bf16 v[44:47], a[28:31], a[220:223], v[44:47]
ds_read_b128 a[60:63], v2 offset:7168
s_waitcnt lgkmcnt(0)
v_mfma_f32_16x16x32_bf16 v[192:195], a[32:35], v[72:75], v[192:195]
v_exp_f32 v28, v28
v_mfma_f32_16x16x32_bf16 v[224:227], a[32:35], v[76:79], v[224:227]
s_add_u32 s101, s101, 0x2000
v_exp_f32 v29, v29
v_mfma_f32_16x16x32_bf16 v[228:231], a[36:39], v[76:79], v[228:231]
buffer_load_dwordx4 a[96:99], v3, s[88:91], s101 offen sc1
v_mfma_f32_16x16x32_bf16 v[196:199], a[36:39], v[72:75], v[196:199]
ds_read_b128 a[32:35], v2 offset:16384
v_cvt_pk_bf16_f32 v60, v28, v29
v_mfma_f32_16x16x32_bf16 v[200:203], a[40:43], v[72:75], v[200:203]
buffer_load_dwordx4 a[100:103], v3, s[88:91], s101 offen offset:1024 sc1
v_mfma_f32_16x16x32_bf16 v[232:235], a[40:43], v[76:79], v[232:235]
ds_read_b128 a[36:39], v2 offset:17408
s_add_u32 s101, s101, 0x2000
v_mfma_f32_16x16x32_bf16 v[236:239], a[44:47], v[76:79], v[236:239]
buffer_load_dwordx4 a[104:107], v3, s[88:91], s101 offen sc1
v_mfma_f32_16x16x32_bf16 v[204:207], a[44:47], v[72:75], v[204:207]
ds_read_b128 a[40:43], v2 offset:18432
v_exp_f32 v30, v30
v_mfma_f32_16x16x32_bf16 v[208:211], a[48:51], v[72:75], v[208:211]
buffer_load_dwordx4 a[108:111], v3, s[88:91], s101 offen offset:1024 sc1
v_mfma_f32_16x16x32_bf16 v[240:243], a[48:51], v[76:79], v[240:243]
ds_read_b128 a[44:47], v2 offset:19456
s_add_u32 s101, s101, 0x2000
v_mfma_f32_16x16x32_bf16 v[244:247], a[52:55], v[76:79], v[244:247]
buffer_load_dwordx4 a[112:115], v3, s[88:91], s101 offen sc1
v_mfma_f32_16x16x32_bf16 v[212:215], a[52:55], v[72:75], v[212:215]
ds_read_b128 a[48:51], v2 offset:20480
v_exp_f32 v31, v31
v_mfma_f32_16x16x32_bf16 v[216:219], a[56:59], v[72:75], v[216:219]
buffer_load_dwordx4 a[116:119], v3, s[88:91], s101 offen offset:1024 sc1
v_mfma_f32_16x16x32_bf16 v[248:251], a[56:59], v[76:79], v[248:251]
ds_read_b128 a[52:55], v2 offset:21504
s_add_u32 s101, s101, 0x2000
v_mfma_f32_16x16x32_bf16 v[252:255], a[60:63], v[76:79], v[252:255]
buffer_load_dwordx4 a[120:123], v3, s[88:91], s101 offen sc1
v_mfma_f32_16x16x32_bf16 v[220:223], a[60:63], v[72:75], v[220:223]
buffer_load_dwordx4 a[124:127], v3, s[88:91], s101 offen offset:1024 sc1
v_mfma_f32_16x16x32_bf16 a[232:235], a[240:243], v[72:75], a[232:235]
ds_read_b128 a[56:59], v2 offset:22528
v_exp_f32 v44, v44
v_mfma_f32_16x16x32_bf16 a[236:239], a[240:243], v[76:79], a[236:239]
ds_read_b128 a[60:63], v2 offset:23552
v_xor_b32 v2, 0x38000, v2
v_exp_f32 v45, v45
v_exp_f32 v46, v46
v_exp_f32 v47, v47
v_cvt_pk_bf16_f32 v61, v30, v31
v_cvt_pk_bf16_f32 v62, v44, v45
v_cvt_pk_bf16_f32 v63, v46, v47
s_waitcnt lgkmcnt(0)
s_barrier
v_mfma_f32_16x16x32_bf16 v[224:227], a[32:35], v[60:63], v[224:227]
v_mfma_f32_16x16x32_bf16 v[228:231], a[36:39], v[60:63], v[228:231]
v_mfma_f32_16x16x32_bf16 v[232:235], a[40:43], v[60:63], v[232:235]
v_mfma_f32_16x16x32_bf16 v[236:239], a[44:47], v[60:63], v[236:239]
v_mfma_f32_16x16x32_bf16 v[240:243], a[48:51], v[60:63], v[240:243]
v_mfma_f32_16x16x32_bf16 v[244:247], a[52:55], v[60:63], v[244:247]
v_mfma_f32_16x16x32_bf16 v[248:251], a[56:59], v[60:63], v[248:251]
v_mfma_f32_16x16x32_bf16 v[252:255], a[60:63], v[60:63], v[252:255]
v_mfma_f32_16x16x32_bf16 a[236:239], a[240:243], v[60:63], a[236:239]
s_waitcnt lgkmcnt(0)
v_xor_b32 v1, 0x8000, v1
L_att_fin:
s_nop 7
v_accvgpr_read_b32 v4, a232
v_accvgpr_read_b32 v6, a236
s_mov_b32 s8, 0x5f800000
v_cmp_nge_f32 s[36:37], s8, v4
v_cmp_nge_f32 s[38:39], s8, v6
v_rcp_f32 v4, v4
v_rcp_f32 v6, v6
s_or_b64 s[34:35], s[34:35], s[36:37]
s_or_b64 s[34:35], s[34:35], s[38:39]
v_pk_mul_f32 v[192:193], v[192:193], v[4:5] op_sel_hi:[1,0]
v_pk_mul_f32 v[194:195], v[194:195], v[4:5] op_sel_hi:[1,0]
v_pk_mul_f32 v[196:197], v[196:197], v[4:5] op_sel_hi:[1,0]
v_pk_mul_f32 v[198:199], v[198:199], v[4:5] op_sel_hi:[1,0]
v_cvt_pk_bf16_f32 v192, v192, v193
v_cvt_pk_bf16_f32 v193, v194, v195
v_cvt_pk_bf16_f32 v194, v196, v197
v_cvt_pk_bf16_f32 v195, v198, v199
s_add_u32 s8, s30, 0x0
buffer_store_dwordx4 v[192:195], v3, s[88:91], s8 offen sc1
v_pk_mul_f32 v[200:201], v[200:201], v[4:5] op_sel_hi:[1,0]
v_pk_mul_f32 v[202:203], v[202:203], v[4:5] op_sel_hi:[1,0]
v_pk_mul_f32 v[204:205], v[204:205], v[4:5] op_sel_hi:[1,0]
v_pk_mul_f32 v[206:207], v[206:207], v[4:5] op_sel_hi:[1,0]
v_cvt_pk_bf16_f32 v200, v200, v201
v_cvt_pk_bf16_f32 v201, v202, v203
v_cvt_pk_bf16_f32 v202, v204, v205
v_cvt_pk_bf16_f32 v203, v206, v207
s_add_u32 s8, s30, 0x2000
buffer_store_dwordx4 v[200:203], v3, s[88:91], s8 offen sc1
v_pk_mul_f32 v[208:209], v[208:209], v[4:5] op_sel_hi:[1,0]
v_pk_mul_f32 v[210:211], v[210:211], v[4:5] op_sel_hi:[1,0]
v_pk_mul_f32 v[212:213], v[212:213], v[4:5] op_sel_hi:[1,0]
v_pk_mul_f32 v[214:215], v[214:215], v[4:5] op_sel_hi:[1,0]
v_cvt_pk_bf16_f32 v208, v208, v209
v_cvt_pk_bf16_f32 v209, v210, v211
v_cvt_pk_bf16_f32 v210, v212, v213
v_cvt_pk_bf16_f32 v211, v214, v215
s_add_u32 s8, s30, 0x4000
buffer_store_dwordx4 v[208:211], v3, s[88:91], s8 offen sc1
v_pk_mul_f32 v[216:217], v[216:217], v[4:5] op_sel_hi:[1,0]
v_pk_mul_f32 v[218:219], v[218:219], v[4:5] op_sel_hi:[1,0]
v_pk_mul_f32 v[220:221], v[220:221], v[4:5] op_sel_hi:[1,0]
v_pk_mul_f32 v[222:223], v[222:223], v[4:5] op_sel_hi:[1,0]
v_cvt_pk_bf16_f32 v216, v216, v217
v_cvt_pk_bf16_f32 v217, v218, v219
v_cvt_pk_bf16_f32 v218, v220, v221
v_cvt_pk_bf16_f32 v219, v222, v223
s_add_u32 s8, s30, 0x6000
buffer_store_dwordx4 v[216:219], v3, s[88:91], s8 offen sc1
v_pk_mul_f32 v[224:225], v[224:225], v[6:7] op_sel_hi:[1,0]
v_pk_mul_f32 v[226:227], v[226:227], v[6:7] op_sel_hi:[1,0]
v_pk_mul_f32 v[228:229], v[228:229], v[6:7] op_sel_hi:[1,0]
v_pk_mul_f32 v[230:231], v[230:231], v[6:7] op_sel_hi:[1,0]
v_cvt_pk_bf16_f32 v224, v224, v225
v_cvt_pk_bf16_f32 v225, v226, v227
v_cvt_pk_bf16_f32 v226, v228, v229
v_cvt_pk_bf16_f32 v227, v230, v231
s_add_u32 s8, s31, 0x0
buffer_store_dwordx4 v[224:227], v3, s[88:91], s8 offen sc1
v_pk_mul_f32 v[232:233], v[232:233], v[6:7] op_sel_hi:[1,0]
v_pk_mul_f32 v[234:235], v[234:235], v[6:7] op_sel_hi:[1,0]
v_pk_mul_f32 v[236:237], v[236:237], v[6:7] op_sel_hi:[1,0]
v_pk_mul_f32 v[238:239], v[238:239], v[6:7] op_sel_hi:[1,0]
v_cvt_pk_bf16_f32 v232, v232, v233
v_cvt_pk_bf16_f32 v233, v234, v235
v_cvt_pk_bf16_f32 v234, v236, v237
v_cvt_pk_bf16_f32 v235, v238, v239
s_add_u32 s8, s31, 0x2000
buffer_store_dwordx4 v[232:235], v3, s[88:91], s8 offen sc1
v_pk_mul_f32 v[240:241], v[240:241], v[6:7] op_sel_hi:[1,0]
v_pk_mul_f32 v[242:243], v[242:243], v[6:7] op_sel_hi:[1,0]
v_pk_mul_f32 v[244:245], v[244:245], v[6:7] op_sel_hi:[1,0]
v_pk_mul_f32 v[246:247], v[246:247], v[6:7] op_sel_hi:[1,0]
v_cvt_pk_bf16_f32 v240, v240, v241
v_cvt_pk_bf16_f32 v241, v242, v243
v_cvt_pk_bf16_f32 v242, v244, v245
v_cvt_pk_bf16_f32 v243, v246, v247
s_add_u32 s8, s31, 0x4000
buffer_store_dwordx4 v[240:243], v3, s[88:91], s8 offen sc1
v_pk_mul_f32 v[248:249], v[248:249], v[6:7] op_sel_hi:[1,0]
v_pk_mul_f32 v[250:251], v[250:251], v[6:7] op_sel_hi:[1,0]
v_pk_mul_f32 v[252:253], v[252:253], v[6:7] op_sel_hi:[1,0]
v_pk_mul_f32 v[254:255], v[254:255], v[6:7] op_sel_hi:[1,0]
v_cvt_pk_bf16_f32 v248, v248, v249
v_cvt_pk_bf16_f32 v249, v250, v251
v_cvt_pk_bf16_f32 v250, v252, v253
v_cvt_pk_bf16_f32 v251, v254, v255
s_add_u32 s8, s31, 0x6000
buffer_store_dwordx4 v[248:251], v3, s[88:91], s8 offen sc1
s_cmp_lg_u64 s[34:35], 0
s_cselect_b32 s8, 1, 0
s_lshl_b32 s9, s4, 2
s_add_u32 s9, s9, 24576
v_mov_b32 v4, s9
v_mov_b32 v5, s8
ds_write_b32 v4, v5
v_lshrrev_b32 v17, 4, v0
v_lshlrev_b32 v18, 10, v17
v_and_b32 v17, 1, v17
v_lshl_add_u32 v18, v17, 5, v18
v_bfe_u32 v17, v0, 2, 2
v_lshl_add_u32 v18, v17, 6, v18
v_and_b32 v17, 3, v0
v_lshl_add_u32 v4, v17, 3, v18
s_sub_u32 s8, s16, s17
v_add_u32 v6, s8, v4
v_xor_b32 v7, 32, v6
v_add_u32 v4, 65536, v4
v_xor_b32 v5, 32, v4
v_and_b32 v20, 15, v0
v_lshlrev_b32 v20, 2, v20
s_waitcnt vmcnt(20) lgkmcnt(0)
s_barrier
v_and_b32 v17, 3, v0
v_lshlrev_b32 v17, 2, v17
v_add_u32 v17, 24576, v17
ds_read_b32 v18, v17
s_waitcnt lgkmcnt(0)
v_cmp_ne_u32 vcc, 0, v18
s_cmp_lg_u32 s33, 0
s_cbranch_scc1 L_att_done
s_nop 4
s_cbranch_vccnz L_att_fallback
L_att_done:
ds_read_b64_tr_b16 v[152:153], v4 offset:512
ds_read_b64_tr_b16 v[154:155], v4 offset:4608
ds_read_b64_tr_b16 v[156:157], v4 offset:8704
ds_read_b64_tr_b16 v[158:159], v4 offset:12800
ds_read_b64_tr_b16 v[160:161], v5 offset:512
ds_read_b64_tr_b16 v[162:163], v5 offset:4608
ds_read_b64_tr_b16 v[164:165], v5 offset:8704
ds_read_b64_tr_b16 v[166:167], v5 offset:12800
ds_read_b64_tr_b16 v[168:169], v4 offset:768
ds_read_b64_tr_b16 v[170:171], v4 offset:4864
ds_read_b64_tr_b16 v[172:173], v4 offset:8960
ds_read_b64_tr_b16 v[174:175], v4 offset:13056
ds_read_b64_tr_b16 v[176:177], v5 offset:768
ds_read_b64_tr_b16 v[178:179], v5 offset:4864
ds_read_b64_tr_b16 v[180:181], v5 offset:8960
ds_read_b64_tr_b16 v[182:183], v5 offset:13056
s_waitcnt lgkmcnt(8)
v_mfma_f32_16x16x32_bf16 v[56:59], v[152:155], a[64:67], 0
ds_read_b64_tr_b16 v[184:185], v4 offset:0
v_mov_b32 v88, 0
v_mfma_f32_16x16x32_bf16 v[56:59], v[156:159], a[72:75], v[56:59]
ds_read_b64_tr_b16 v[186:187], v4 offset:4096
v_mov_b32 v89, 0
v_mfma_f32_16x16x32_bf16 v[72:75], v[156:159], a[76:79], 0
ds_read_b64_tr_b16 v[188:189], v4 offset:8192
v_mov_b32 v90, 0
v_mfma_f32_16x16x32_bf16 v[72:75], v[152:155], a[68:71], v[72:75]
ds_read_b64_tr_b16 v[190:191], v4 offset:12288
v_mov_b32 v91, 0
v_mfma_f32_16x16x32_bf16 v[76:79], v[160:163], a[68:71], 0
ds_read_b64_tr_b16 v[192:193], v5 offset:0
v_mfma_f32_16x16x32_bf16 v[76:79], v[164:167], a[76:79], v[76:79]
ds_read_b64_tr_b16 v[194:195], v5 offset:4096
v_mfma_f32_16x16x32_bf16 v[60:63], v[164:167], a[72:75], 0
ds_read_b64_tr_b16 v[196:197], v5 offset:8192
s_waitcnt lgkmcnt(7)
v_mfma_f32_16x16x32_bf16 v[60:63], v[160:163], a[64:67], v[60:63]
ds_read_b64_tr_b16 v[198:199], v5 offset:12288
v_mfma_f32_16x16x32_bf16 v[64:67], v[168:171], a[64:67], 0
ds_read_b64_tr_b16 v[200:201], v4 offset:256
v_mfma_f32_16x16x32_bf16 v[64:67], v[172:175], a[72:75], v[64:67]
ds_read_b64_tr_b16 v[202:203], v4 offset:4352
v_mfma_f32_16x16x32_bf16 v[80:83], v[172:175], a[76:79], 0
ds_read_b64_tr_b16 v[204:205], v4 offset:8448
v_mfma_f32_16x16x32_bf16 v[80:83], v[168:171], a[68:71], v[80:83]
ds_read_b64_tr_b16 v[206:207], v4 offset:12544
v_mfma_f32_16x16x32_bf16 v[84:87], v[176:179], a[68:71], 0
ds_read_b64_tr_b16 v[208:209], v5 offset:256
v_mfma_f32_16x16x32_bf16 v[84:87], v[180:183], a[76:79], v[84:87]
ds_read_b64_tr_b16 v[210:211], v5 offset:4352
s_waitcnt vmcnt(16) lgkmcnt(6)
v_mfma_f32_16x16x32_bf16 v[68:71], v[180:183], a[72:75], 0
ds_read_b64_tr_b16 v[212:213], v5 offset:8448
s_barrier
v_mfma_f32_16x16x32_bf16 v[68:71], v[176:179], a[64:67], v[68:71]
ds_read_b64_tr_b16 v[214:215], v5 offset:12544
v_mfma_f32_16x16x32_bf16 v[24:27], v[184:187], a[64:67], 0
ds_read_b64_tr_b16 v[152:153], v4 offset:16896
v_mfma_f32_16x16x32_bf16 v[24:27], v[188:191], a[72:75], v[24:27]
ds_read_b64_tr_b16 v[154:155], v4 offset:20992
v_mfma_f32_16x16x32_bf16 v[40:43], v[188:191], a[76:79], 0
ds_read_b64_tr_b16 v[156:157], v4 offset:25088
v_mfma_f32_16x16x32_bf16 v[40:43], v[184:187], a[68:71], v[40:43]
ds_read_b64_tr_b16 v[158:159], v4 offset:29184
v_mfma_f32_16x16x32_bf16 v[44:47], v[192:195], a[68:71], 0
ds_read_b64_tr_b16 v[160:161], v5 offset:16896
v_mfma_f32_16x16x32_bf16 v[44:47], v[196:199], a[76:79], v[44:47]
ds_read_b64_tr_b16 v[162:163], v5 offset:20992
v_mfma_f32_16x16x32_bf16 v[28:31], v[196:199], a[72:75], 0
ds_read_b64_tr_b16 v[164:165], v5 offset:25088
s_waitcnt lgkmcnt(7)
v_mfma_f32_16x16x32_bf16 v[28:31], v[192:195], a[64:67], v[28:31]
ds_read_b64_tr_b16 v[166:167], v5 offset:29184
v_mfma_f32_16x16x32_bf16 v[32:35], v[200:203], a[64:67], 0
ds_read_b64_tr_b16 v[168:169], v4 offset:17152
v_mfma_f32_16x16x32_bf16 v[32:35], v[204:207], a[72:75], v[32:35]
ds_read_b64_tr_b16 v[170:171], v4 offset:21248
v_mfma_f32_16x16x32_bf16 v[48:51], v[204:207], a[76:79], 0
ds_read_b64_tr_b16 v[172:173], v4 offset:25344
v_mfma_f32_16x16x32_bf16 v[48:51], v[200:203], a[68:71], v[48:51]
ds_read_b64_tr_b16 v[174:175], v4 offset:29440
v_mfma_f32_16x16x32_bf16 v[52:55], v[208:211], a[68:71], 0
ds_read_b64_tr_b16 v[176:177], v5 offset:17152
v_mfma_f32_16x16x32_bf16 v[52:55], v[212:215], a[76:79], v[52:55]
ds_read_b64_tr_b16 v[178:179], v5 offset:21248
s_waitcnt lgkmcnt(6)
v_mfma_f32_16x16x32_bf16 v[36:39], v[212:215], a[72:75], 0
ds_read_b64_tr_b16 v[180:181], v5 offset:25344
v_mfma_f32_16x16x32_bf16 v[36:39], v[208:211], a[64:67], v[36:39]
ds_read_b64_tr_b16 v[182:183], v5 offset:29440
v_mfma_f32_16x16x32_bf16 v[56:59], v[152:155], a[80:83], v[56:59]
ds_read_b64_tr_b16 v[184:185], v4 offset:16384
v_mov_b32 v92, 0
v_mfma_f32_16x16x32_bf16 v[56:59], v[156:159], a[88:91], v[56:59]
ds_read_b64_tr_b16 v[186:187], v4 offset:20480
v_mov_b32 v93, 0
v_mfma_f32_16x16x32_bf16 v[72:75], v[156:159], a[92:95], v[72:75]
ds_read_b64_tr_b16 v[188:189], v4 offset:24576
v_mov_b32 v94, 0
v_mfma_f32_16x16x32_bf16 v[72:75], v[152:155], a[84:87], v[72:75]
ds_read_b64_tr_b16 v[190:191], v4 offset:28672
v_mov_b32 v95, 0
v_mfma_f32_16x16x32_bf16 v[76:79], v[160:163], a[84:87], v[76:79]
ds_read_b64_tr_b16 v[192:193], v5 offset:16384
v_mfma_f32_16x16x32_bf16 v[76:79], v[164:167], a[92:95], v[76:79]
ds_read_b64_tr_b16 v[194:195], v5 offset:20480
v_mfma_f32_16x16x32_bf16 v[60:63], v[164:167], a[88:91], v[60:63]
ds_read_b64_tr_b16 v[196:197], v5 offset:24576
s_waitcnt lgkmcnt(7)
v_mfma_f32_16x16x32_bf16 v[60:63], v[160:163], a[80:83], v[60:63]
ds_read_b64_tr_b16 v[198:199], v5 offset:28672
v_mfma_f32_16x16x32_bf16 v[64:67], v[168:171], a[80:83], v[64:67]
ds_read_b64_tr_b16 v[200:201], v4 offset:16640
v_mfma_f32_16x16x32_bf16 v[64:67], v[172:175], a[88:91], v[64:67]
ds_read_b64_tr_b16 v[202:203], v4 offset:20736
v_mfma_f32_16x16x32_bf16 v[80:83], v[172:175], a[92:95], v[80:83]
ds_read_b64_tr_b16 v[204:205], v4 offset:24832
v_mfma_f32_16x16x32_bf16 v[80:83], v[168:171], a[84:87], v[80:83]
ds_read_b64_tr_b16 v[206:207], v4 offset:28928
v_mfma_f32_16x16x32_bf16 v[84:87], v[176:179], a[84:87], v[84:87]
ds_read_b64_tr_b16 v[208:209], v5 offset:16640
v_mfma_f32_16x16x32_bf16 v[84:87], v[180:183], a[92:95], v[84:87]
ds_read_b64_tr_b16 v[210:211], v5 offset:20736
s_waitcnt vmcnt(0) lgkmcnt(6)
v_mfma_f32_16x16x32_bf16 v[68:71], v[180:183], a[88:91], v[68:71]
ds_read_b64_tr_b16 v[212:213], v5 offset:24832
s_barrier
v_mfma_f32_16x16x32_bf16 v[68:71], v[176:179], a[80:83], v[68:71]
ds_read_b64_tr_b16 v[214:215], v5 offset:28928
s_cmp_lg_u32 s4, 0
s_cbranch_scc1 L_flag_set
s_lshl_b32 s8, s6, 5
s_add_u32 s8, s8, s5
s_lshl_b32 s8, s8, 2
s_add_u32 s8, s8, 0x3604000
v_mov_b32 v17, 1
s_mov_b64 exec, 1
buffer_store_dword v17, off, s[88:91], s8 sc1
s_mov_b64 exec, -1
L_flag_set:
v_mfma_f32_16x16x32_bf16 v[24:27], v[184:187], a[80:83], v[24:27]
ds_read_b64_tr_b16 v[152:153], v6 offset:512
ds_read_b64_tr_b16 v[154:155], v6 offset:4608
v_mfma_f32_16x16x32_bf16 v[24:27], v[188:191], a[88:91], v[24:27]
ds_read_b64_tr_b16 v[156:157], v6 offset:8704
v_add_u32 v12, 0x20000, v12
v_mfma_f32_16x16x32_bf16 v[40:43], v[188:191], a[92:95], v[40:43]
ds_read_b64_tr_b16 v[158:159], v6 offset:12800
s_add_u32 m0, s17, 0x10000
v_mfma_f32_16x16x32_bf16 v[40:43], v[184:187], a[84:87], v[40:43]
buffer_load_dwordx4 v12, s[72:75], 0 offen lds
v_mfma_f32_16x16x32_bf16 v[44:47], v[192:195], a[84:87], v[44:47]
ds_read_b64_tr_b16 v[160:161], v7 offset:512
ds_read_b64_tr_b16 v[162:163], v7 offset:4608
v_mfma_f32_16x16x32_bf16 v[44:47], v[196:199], a[92:95], v[44:47]
ds_read_b64_tr_b16 v[164:165], v7 offset:8704
v_add_u32 v13, 0x20000, v13
v_mfma_f32_16x16x32_bf16 v[28:31], v[196:199], a[88:91], v[28:31]
ds_read_b64_tr_b16 v[166:167], v7 offset:12800
s_waitcnt lgkmcnt(8)
v_mfma_f32_16x16x32_bf16 v[28:31], v[192:195], a[80:83], v[28:31]
buffer_load_dwordx4 v13, s[72:75], 0 offen offset:1024 lds
v_mfma_f32_16x16x32_bf16 v[32:35], v[200:203], a[80:83], v[32:35]
ds_read_b64_tr_b16 v[168:169], v6 offset:768
ds_read_b64_tr_b16 v[170:171], v6 offset:4864
v_mfma_f32_16x16x32_bf16 v[32:35], v[204:207], a[88:91], v[32:35]
ds_read_b64_tr_b16 v[172:173], v6 offset:8960
v_mfma_f32_16x16x32_bf16 v[48:51], v[204:207], a[92:95], v[48:51]
ds_read_b64_tr_b16 v[174:175], v6 offset:13056
v_mfma_f32_16x16x32_bf16 v[48:51], v[200:203], a[84:87], v[48:51]
buffer_load_dwordx4 v12, s[72:75], s12 offen offset:2048 lds
v_mfma_f32_16x16x32_bf16 v[52:55], v[208:211], a[84:87], v[52:55]
ds_read_b64_tr_b16 v[176:177], v7 offset:768
ds_read_b64_tr_b16 v[178:179], v7 offset:4864
v_mfma_f32_16x16x32_bf16 v[52:55], v[212:215], a[92:95], v[52:55]
ds_read_b64_tr_b16 v[180:181], v7 offset:8960
s_waitcnt lgkmcnt(7)
v_mfma_f32_16x16x32_bf16 v[36:39], v[212:215], a[88:91], v[36:39]
ds_read_b64_tr_b16 v[182:183], v7 offset:13056
v_mfma_f32_16x16x32_bf16 v[36:39], v[208:211], a[80:83], v[36:39]
buffer_load_dwordx4 v13, s[72:75], s12 offen offset:3072 lds
v_mfma_f32_16x16x32_bf16 v[56:59], v[152:155], a[96:99], v[56:59]
ds_read_b64_tr_b16 v[184:185], v6 offset:0
ds_read_b64_tr_b16 v[186:187], v6 offset:4096
v_mfma_f32_16x16x32_bf16 v[56:59], v[156:159], a[104:107], v[56:59]
ds_read_b64_tr_b16 v[188:189], v6 offset:8192
v_mov_b32 v96, 0
v_mfma_f32_16x16x32_bf16 v[72:75], v[156:159], a[108:111], v[72:75]
ds_read_b64_tr_b16 v[190:191], v6 offset:12288
s_add_u32 s101, s101, 0x2000
v_mfma_f32_16x16x32_bf16 v[72:75], v[152:155], a[100:103], v[72:75]
buffer_load_dwordx4 a[64:67], v3, s[88:91], s101 offen sc1
v_mfma_f32_16x16x32_bf16 v[76:79], v[160:163], a[100:103], v[76:79]
ds_read_b64_tr_b16 v[192:193], v7 offset:0
ds_read_b64_tr_b16 v[194:195], v7 offset:4096
v_mfma_f32_16x16x32_bf16 v[76:79], v[164:167], a[108:111], v[76:79]
ds_read_b64_tr_b16 v[196:197], v7 offset:8192
v_mov_b32 v97, 0
v_mfma_f32_16x16x32_bf16 v[60:63], v[164:167], a[104:107], v[60:63]
ds_read_b64_tr_b16 v[198:199], v7 offset:12288
s_waitcnt lgkmcnt(8)
v_mfma_f32_16x16x32_bf16 v[60:63], v[160:163], a[96:99], v[60:63]
buffer_load_dwordx4 a[68:71], v3, s[88:91], s101 offen offset:1024 sc1
v_mfma_f32_16x16x32_bf16 v[64:67], v[168:171], a[96:99], v[64:67]
ds_read_b64_tr_b16 v[200:201], v6 offset:256
ds_read_b64_tr_b16 v[202:203], v6 offset:4352
v_mfma_f32_16x16x32_bf16 v[64:67], v[172:175], a[104:107], v[64:67]
ds_read_b64_tr_b16 v[204:205], v6 offset:8448
v_mov_b32 v98, 0
v_mfma_f32_16x16x32_bf16 v[80:83], v[172:175], a[108:111], v[80:83]
ds_read_b64_tr_b16 v[206:207], v6 offset:12544
s_add_u32 s101, s101, 0x2000
v_mfma_f32_16x16x32_bf16 v[80:83], v[168:171], a[100:103], v[80:83]
buffer_load_dwordx4 a[72:75], v3, s[88:91], s101 offen sc1
v_mfma_f32_16x16x32_bf16 v[84:87], v[176:179], a[100:103], v[84:87]
ds_read_b64_tr_b16 v[208:209], v7 offset:256
ds_read_b64_tr_b16 v[210:211], v7 offset:4352
v_mfma_f32_16x16x32_bf16 v[84:87], v[180:183], a[108:111], v[84:87]
ds_read_b64_tr_b16 v[212:213], v7 offset:8448
s_waitcnt vmcnt(15) lgkmcnt(7)
v_mfma_f32_16x16x32_bf16 v[68:71], v[180:183], a[104:107], v[68:71]
ds_read_b64_tr_b16 v[214:215], v7 offset:12544
s_barrier
v_mfma_f32_16x16x32_bf16 v[68:71], v[176:179], a[96:99], v[68:71]
buffer_load_dwordx4 a[76:79], v3, s[88:91], s101 offen offset:1024 sc1
v_mov_b32 v99, 0
v_mfma_f32_16x16x32_bf16 v[24:27], v[184:187], a[96:99], v[24:27]
ds_read_b64_tr_b16 v[152:153], v6 offset:16896
ds_read_b64_tr_b16 v[154:155], v6 offset:20992
v_mfma_f32_16x16x32_bf16 v[24:27], v[188:191], a[104:107], v[24:27]
ds_read_b64_tr_b16 v[156:157], v6 offset:25088
v_add_u32 v12, 0x20000, v12
v_mfma_f32_16x16x32_bf16 v[40:43], v[188:191], a[108:111], v[40:43]
ds_read_b64_tr_b16 v[158:159], v6 offset:29184
s_add_u32 m0, s17, 0x14000
v_mfma_f32_16x16x32_bf16 v[40:43], v[184:187], a[100:103], v[40:43]
buffer_load_dwordx4 v12, s[72:75], 0 offen lds
v_mfma_f32_16x16x32_bf16 v[44:47], v[192:195], a[100:103], v[44:47]
ds_read_b64_tr_b16 v[160:161], v7 offset:16896
ds_read_b64_tr_b16 v[162:163], v7 offset:20992
v_mfma_f32_16x16x32_bf16 v[44:47], v[196:199], a[108:111], v[44:47]
ds_read_b64_tr_b16 v[164:165], v7 offset:25088
v_add_u32 v13, 0x20000, v13
v_mfma_f32_16x16x32_bf16 v[28:31], v[196:199], a[104:107], v[28:31]
ds_read_b64_tr_b16 v[166:167], v7 offset:29184
s_waitcnt lgkmcnt(8)
v_mfma_f32_16x16x32_bf16 v[28:31], v[192:195], a[96:99], v[28:31]
buffer_load_dwordx4 v13, s[72:75], 0 offen offset:1024 lds
v_mfma_f32_16x16x32_bf16 v[32:35], v[200:203], a[96:99], v[32:35]
ds_read_b64_tr_b16 v[168:169], v6 offset:17152
ds_read_b64_tr_b16 v[170:171], v6 offset:21248
v_mfma_f32_16x16x32_bf16 v[32:35], v[204:207], a[104:107], v[32:35]
ds_read_b64_tr_b16 v[172:173], v6 offset:25344
v_mfma_f32_16x16x32_bf16 v[48:51], v[204:207], a[108:111], v[48:51]
ds_read_b64_tr_b16 v[174:175], v6 offset:29440
v_mfma_f32_16x16x32_bf16 v[48:51], v[200:203], a[100:103], v[48:51]
buffer_load_dwordx4 v12, s[72:75], s12 offen offset:2048 lds
v_mfma_f32_16x16x32_bf16 v[52:55], v[208:211], a[100:103], v[52:55]
ds_read_b64_tr_b16 v[176:177], v7 offset:17152
ds_read_b64_tr_b16 v[178:179], v7 offset:21248
v_mfma_f32_16x16x32_bf16 v[52:55], v[212:215], a[108:111], v[52:55]
ds_read_b64_tr_b16 v[180:181], v7 offset:25344
s_waitcnt lgkmcnt(7)
v_mfma_f32_16x16x32_bf16 v[36:39], v[212:215], a[104:107], v[36:39]
ds_read_b64_tr_b16 v[182:183], v7 offset:29440
v_mfma_f32_16x16x32_bf16 v[36:39], v[208:211], a[96:99], v[36:39]
buffer_load_dwordx4 v13, s[72:75], s12 offen offset:3072 lds
v_mfma_f32_16x16x32_bf16 v[56:59], v[152:155], a[112:115], v[56:59]
ds_read_b64_tr_b16 v[184:185], v6 offset:16384
ds_read_b64_tr_b16 v[186:187], v6 offset:20480
v_mfma_f32_16x16x32_bf16 v[56:59], v[156:159], a[120:123], v[56:59]
ds_read_b64_tr_b16 v[188:189], v6 offset:24576
v_mov_b32 v100, 0
v_mfma_f32_16x16x32_bf16 v[72:75], v[156:159], a[124:127], v[72:75]
ds_read_b64_tr_b16 v[190:191], v6 offset:28672
s_add_u32 s101, s101, 0x2000
v_mfma_f32_16x16x32_bf16 v[72:75], v[152:155], a[116:119], v[72:75]
buffer_load_dwordx4 a[80:83], v3, s[88:91], s101 offen sc1
v_mfma_f32_16x16x32_bf16 v[76:79], v[160:163], a[116:119], v[76:79]
ds_read_b64_tr_b16 v[192:193], v7 offset:16384
ds_read_b64_tr_b16 v[194:195], v7 offset:20480
v_mfma_f32_16x16x32_bf16 v[76:79], v[164:167], a[124:127], v[76:79]
ds_read_b64_tr_b16 v[196:197], v7 offset:24576
v_mov_b32 v101, 0
v_mfma_f32_16x16x32_bf16 v[60:63], v[164:167], a[120:123], v[60:63]
ds_read_b64_tr_b16 v[198:199], v7 offset:28672
s_waitcnt lgkmcnt(8)
v_mfma_f32_16x16x32_bf16 v[60:63], v[160:163], a[112:115], v[60:63]
buffer_load_dwordx4 a[84:87], v3, s[88:91], s101 offen offset:1024 sc1
v_mfma_f32_16x16x32_bf16 v[64:67], v[168:171], a[112:115], v[64:67]
ds_read_b64_tr_b16 v[200:201], v6 offset:16640
ds_read_b64_tr_b16 v[202:203], v6 offset:20736
v_mfma_f32_16x16x32_bf16 v[64:67], v[172:175], a[120:123], v[64:67]
ds_read_b64_tr_b16 v[204:205], v6 offset:24832
v_mov_b32 v102, 0
v_mfma_f32_16x16x32_bf16 v[80:83], v[172:175], a[124:127], v[80:83]
ds_read_b64_tr_b16 v[206:207], v6 offset:28928
s_add_u32 s101, s101, 0x2000
v_mfma_f32_16x16x32_bf16 v[80:83], v[168:171], a[116:119], v[80:83]
buffer_load_dwordx4 a[88:91], v3, s[88:91], s101 offen sc1
v_mfma_f32_16x16x32_bf16 v[84:87], v[176:179], a[116:119], v[84:87]
ds_read_b64_tr_b16 v[208:209], v7 offset:16640
ds_read_b64_tr_b16 v[210:211], v7 offset:20736
v_mfma_f32_16x16x32_bf16 v[84:87], v[180:183], a[124:127], v[84:87]
ds_read_b64_tr_b16 v[212:213], v7 offset:24832
s_waitcnt vmcnt(7) lgkmcnt(7)
v_mfma_f32_16x16x32_bf16 v[68:71], v[180:183], a[120:123], v[68:71]
ds_read_b64_tr_b16 v[214:215], v7 offset:28928
s_barrier
v_mfma_f32_16x16x32_bf16 v[68:71], v[176:179], a[112:115], v[68:71]
buffer_load_dwordx4 a[92:95], v3, s[88:91], s101 offen offset:1024 sc1
v_mov_b32 v103, 0
v_mfma_f32_16x16x32_bf16 v[24:27], v[184:187], a[112:115], v[24:27]
ds_read_b64_tr_b16 v[152:153], v4 offset:512
ds_read_b64_tr_b16 v[154:155], v4 offset:4608
v_mfma_f32_16x16x32_bf16 v[24:27], v[188:191], a[120:123], v[24:27]
ds_read_b64_tr_b16 v[156:157], v4 offset:8704
v_add_u32 v12, 0x20000, v12
v_mfma_f32_16x16x32_bf16 v[40:43], v[188:191], a[124:127], v[40:43]
ds_read_b64_tr_b16 v[158:159], v4 offset:12800
s_add_u32 m0, s16, 0x0
v_mfma_f32_16x16x32_bf16 v[40:43], v[184:187], a[116:119], v[40:43]
buffer_load_dwordx4 v12, s[72:75], 0 offen lds
v_mfma_f32_16x16x32_bf16 v[44:47], v[192:195], a[116:119], v[44:47]
ds_read_b64_tr_b16 v[160:161], v5 offset:512
ds_read_b64_tr_b16 v[162:163], v5 offset:4608
v_mfma_f32_16x16x32_bf16 v[44:47], v[196:199], a[124:127], v[44:47]
ds_read_b64_tr_b16 v[164:165], v5 offset:8704
v_add_u32 v13, 0x20000, v13
v_mfma_f32_16x16x32_bf16 v[28:31], v[196:199], a[120:123], v[28:31]
ds_read_b64_tr_b16 v[166:167], v5 offset:12800
s_waitcnt lgkmcnt(8)
v_mfma_f32_16x16x32_bf16 v[28:31], v[192:195], a[112:115], v[28:31]
buffer_load_dwordx4 v13, s[72:75], 0 offen offset:1024 lds
v_mfma_f32_16x16x32_bf16 v[32:35], v[200:203], a[112:115], v[32:35]
ds_read_b64_tr_b16 v[168:169], v4 offset:768
ds_read_b64_tr_b16 v[170:171], v4 offset:4864
v_mfma_f32_16x16x32_bf16 v[32:35], v[204:207], a[120:123], v[32:35]
ds_read_b64_tr_b16 v[172:173], v4 offset:8960
v_mfma_f32_16x16x32_bf16 v[48:51], v[204:207], a[124:127], v[48:51]
ds_read_b64_tr_b16 v[174:175], v4 offset:13056
v_mfma_f32_16x16x32_bf16 v[48:51], v[200:203], a[116:119], v[48:51]
buffer_load_dwordx4 v12, s[72:75], s12 offen offset:2048 lds
v_mfma_f32_16x16x32_bf16 v[52:55], v[208:211], a[116:119], v[52:55]
ds_read_b64_tr_b16 v[176:177], v5 offset:768
ds_read_b64_tr_b16 v[178:179], v5 offset:4864
v_mfma_f32_16x16x32_bf16 v[52:55], v[212:215], a[124:127], v[52:55]
ds_read_b64_tr_b16 v[180:181], v5 offset:8960
s_waitcnt lgkmcnt(7)
v_mfma_f32_16x16x32_bf16 v[36:39], v[212:215], a[120:123], v[36:39]
ds_read_b64_tr_b16 v[182:183], v5 offset:13056
v_mfma_f32_16x16x32_bf16 v[36:39], v[208:211], a[112:115], v[36:39]
buffer_load_dwordx4 v13, s[72:75], s12 offen offset:3072 lds
v_mfma_f32_16x16x32_bf16 v[56:59], v[152:155], a[64:67], v[56:59]
ds_read_b64_tr_b16 v[184:185], v4 offset:0
ds_read_b64_tr_b16 v[186:187], v4 offset:4096
v_mfma_f32_16x16x32_bf16 v[56:59], v[156:159], a[72:75], v[56:59]
ds_read_b64_tr_b16 v[188:189], v4 offset:8192
v_mov_b32 v104, 0
v_mfma_f32_16x16x32_bf16 v[72:75], v[156:159], a[76:79], v[72:75]
ds_read_b64_tr_b16 v[190:191], v4 offset:12288
s_add_u32 s101, s101, 0x2000
v_mfma_f32_16x16x32_bf16 v[72:75], v[152:155], a[68:71], v[72:75]
buffer_load_dwordx4 a[96:99], v3, s[88:91], s101 offen sc1
v_mfma_f32_16x16x32_bf16 v[76:79], v[160:163], a[68:71], v[76:79]
ds_read_b64_tr_b16 v[192:193], v5 offset:0
ds_read_b64_tr_b16 v[194:195], v5 offset:4096
v_mfma_f32_16x16x32_bf16 v[76:79], v[164:167], a[76:79], v[76:79]
ds_read_b64_tr_b16 v[196:197], v5 offset:8192
v_mov_b32 v105, 0
v_mfma_f32_16x16x32_bf16 v[60:63], v[164:167], a[72:75], v[60:63]
ds_read_b64_tr_b16 v[198:199], v5 offset:12288
s_waitcnt lgkmcnt(8)
v_mfma_f32_16x16x32_bf16 v[60:63], v[160:163], a[64:67], v[60:63]
buffer_load_dwordx4 a[100:103], v3, s[88:91], s101 offen offset:1024 sc1
v_mfma_f32_16x16x32_bf16 v[64:67], v[168:171], a[64:67], v[64:67]
ds_read_b64_tr_b16 v[200:201], v4 offset:256
ds_read_b64_tr_b16 v[202:203], v4 offset:4352
v_mfma_f32_16x16x32_bf16 v[64:67], v[172:175], a[72:75], v[64:67]
ds_read_b64_tr_b16 v[204:205], v4 offset:8448
v_mov_b32 v106, 0
v_mfma_f32_16x16x32_bf16 v[80:83], v[172:175], a[76:79], v[80:83]
ds_read_b64_tr_b16 v[206:207], v4 offset:12544
s_add_u32 s101, s101, 0x2000
v_mfma_f32_16x16x32_bf16 v[80:83], v[168:171], a[68:71], v[80:83]
buffer_load_dwordx4 a[104:107], v3, s[88:91], s101 offen sc1
v_mfma_f32_16x16x32_bf16 v[84:87], v[176:179], a[68:71], v[84:87]
ds_read_b64_tr_b16 v[208:209], v5 offset:256
ds_read_b64_tr_b16 v[210:211], v5 offset:4352
v_mfma_f32_16x16x32_bf16 v[84:87], v[180:183], a[76:79], v[84:87]
ds_read_b64_tr_b16 v[212:213], v5 offset:8448
s_waitcnt vmcnt(7) lgkmcnt(7)
v_mfma_f32_16x16x32_bf16 v[68:71], v[180:183], a[72:75], v[68:71]
ds_read_b64_tr_b16 v[214:215], v5 offset:12544
s_barrier
v_mfma_f32_16x16x32_bf16 v[68:71], v[176:179], a[64:67], v[68:71]
buffer_load_dwordx4 a[108:111], v3, s[88:91], s101 offen offset:1024 sc1
v_mov_b32 v107, 0
buffer_load_dword v14, v20, s[88:91], s24 offen sc1
v_mfma_f32_16x16x32_bf16 v[24:27], v[184:187], a[64:67], v[24:27]
ds_read_b64_tr_b16 v[152:153], v4 offset:16896
ds_read_b64_tr_b16 v[154:155], v4 offset:20992
v_mfma_f32_16x16x32_bf16 v[24:27], v[188:191], a[72:75], v[24:27]
ds_read_b64_tr_b16 v[156:157], v4 offset:25088
v_add_u32 v12, 0x20000, v12
v_mfma_f32_16x16x32_bf16 v[40:43], v[188:191], a[76:79], v[40:43]
ds_read_b64_tr_b16 v[158:159], v4 offset:29184
s_add_u32 m0, s16, 0x4000
v_mfma_f32_16x16x32_bf16 v[40:43], v[184:187], a[68:71], v[40:43]
buffer_load_dwordx4 v12, s[72:75], 0 offen lds
v_mfma_f32_16x16x32_bf16 v[44:47], v[192:195], a[68:71], v[44:47]
ds_read_b64_tr_b16 v[160:161], v5 offset:16896
ds_read_b64_tr_b16 v[162:163], v5 offset:20992
v_mfma_f32_16x16x32_bf16 v[44:47], v[196:199], a[76:79], v[44:47]
ds_read_b64_tr_b16 v[164:165], v5 offset:25088
v_add_u32 v13, 0x20000, v13
v_mfma_f32_16x16x32_bf16 v[28:31], v[196:199], a[72:75], v[28:31]
ds_read_b64_tr_b16 v[166:167], v5 offset:29184
s_waitcnt lgkmcnt(8)
v_mfma_f32_16x16x32_bf16 v[28:31], v[192:195], a[64:67], v[28:31]
buffer_load_dwordx4 v13, s[72:75], 0 offen offset:1024 lds
v_mfma_f32_16x16x32_bf16 v[32:35], v[200:203], a[64:67], v[32:35]
ds_read_b64_tr_b16 v[168:169], v4 offset:17152
ds_read_b64_tr_b16 v[170:171], v4 offset:21248
v_mfma_f32_16x16x32_bf16 v[32:35], v[204:207], a[72:75], v[32:35]
ds_read_b64_tr_b16 v[172:173], v4 offset:25344
v_mfma_f32_16x16x32_bf16 v[48:51], v[204:207], a[76:79], v[48:51]
ds_read_b64_tr_b16 v[174:175], v4 offset:29440
v_mfma_f32_16x16x32_bf16 v[48:51], v[200:203], a[68:71], v[48:51]
buffer_load_dwordx4 v12, s[72:75], s12 offen offset:2048 lds
v_mfma_f32_16x16x32_bf16 v[52:55], v[208:211], a[68:71], v[52:55]
ds_read_b64_tr_b16 v[176:177], v5 offset:17152
ds_read_b64_tr_b16 v[178:179], v5 offset:21248
v_mfma_f32_16x16x32_bf16 v[52:55], v[212:215], a[76:79], v[52:55]
ds_read_b64_tr_b16 v[180:181], v5 offset:25344
s_waitcnt lgkmcnt(7)
v_mfma_f32_16x16x32_bf16 v[36:39], v[212:215], a[72:75], v[36:39]
ds_read_b64_tr_b16 v[182:183], v5 offset:29440
v_mfma_f32_16x16x32_bf16 v[36:39], v[208:211], a[64:67], v[36:39]
buffer_load_dwordx4 v13, s[72:75], s12 offen offset:3072 lds
v_mfma_f32_16x16x32_bf16 v[56:59], v[152:155], a[80:83], v[56:59]
ds_read_b64_tr_b16 v[184:185], v4 offset:16384
ds_read_b64_tr_b16 v[186:187], v4 offset:20480
v_mfma_f32_16x16x32_bf16 v[56:59], v[156:159], a[88:91], v[56:59]
ds_read_b64_tr_b16 v[188:189], v4 offset:24576
v_mov_b32 v108, 0
v_mfma_f32_16x16x32_bf16 v[72:75], v[156:159], a[92:95], v[72:75]
ds_read_b64_tr_b16 v[190:191], v4 offset:28672
s_add_u32 s101, s101, 0x2000
v_mfma_f32_16x16x32_bf16 v[72:75], v[152:155], a[84:87], v[72:75]
buffer_load_dwordx4 a[112:115], v3, s[88:91], s101 offen sc1
v_mfma_f32_16x16x32_bf16 v[76:79], v[160:163], a[84:87], v[76:79]
ds_read_b64_tr_b16 v[192:193], v5 offset:16384
ds_read_b64_tr_b16 v[194:195], v5 offset:20480
v_mfma_f32_16x16x32_bf16 v[76:79], v[164:167], a[92:95], v[76:79]
ds_read_b64_tr_b16 v[196:197], v5 offset:24576
v_mov_b32 v109, 0
v_mfma_f32_16x16x32_bf16 v[60:63], v[164:167], a[88:91], v[60:63]
ds_read_b64_tr_b16 v[198:199], v5 offset:28672
s_waitcnt lgkmcnt(8)
v_mfma_f32_16x16x32_bf16 v[60:63], v[160:163], a[80:83], v[60:63]
buffer_load_dwordx4 a[116:119], v3, s[88:91], s101 offen offset:1024 sc1
v_mfma_f32_16x16x32_bf16 v[64:67], v[168:171], a[80:83], v[64:67]
ds_read_b64_tr_b16 v[200:201], v4 offset:16640
ds_read_b64_tr_b16 v[202:203], v4 offset:20736
v_mfma_f32_16x16x32_bf16 v[64:67], v[172:175], a[88:91], v[64:67]
ds_read_b64_tr_b16 v[204:205], v4 offset:24832
v_mov_b32 v110, 0
v_mfma_f32_16x16x32_bf16 v[80:83], v[172:175], a[92:95], v[80:83]
ds_read_b64_tr_b16 v[206:207], v4 offset:28928
s_add_u32 s101, s101, 0x2000
v_mfma_f32_16x16x32_bf16 v[80:83], v[168:171], a[84:87], v[80:83]
buffer_load_dwordx4 a[120:123], v3, s[88:91], s101 offen sc1
v_mfma_f32_16x16x32_bf16 v[84:87], v[176:179], a[84:87], v[84:87]
ds_read_b64_tr_b16 v[208:209], v5 offset:16640
ds_read_b64_tr_b16 v[210:211], v5 offset:20736
v_mfma_f32_16x16x32_bf16 v[84:87], v[180:183], a[92:95], v[84:87]
ds_read_b64_tr_b16 v[212:213], v5 offset:24832
s_waitcnt vmcnt(7) lgkmcnt(7)
v_mfma_f32_16x16x32_bf16 v[68:71], v[180:183], a[88:91], v[68:71]
ds_read_b64_tr_b16 v[214:215], v5 offset:28928
s_barrier
v_mfma_f32_16x16x32_bf16 v[68:71], v[176:179], a[80:83], v[68:71]
buffer_load_dwordx4 a[124:127], v3, s[88:91], s101 offen offset:1024 sc1
v_mov_b32 v111, 0
s_mov_b32 s92, 200000
L_spin_c:
v_cmp_ne_u32 vcc, 1, v14
s_nop 4
s_cbranch_vccz L_spun_c
s_sub_u32 s92, s92, 1
s_cbranch_scc1 L_spun_c
s_sleep 2
buffer_load_dword v14, v20, s[88:91], s24 offen sc1
s_waitcnt vmcnt(0)
s_branch L_spin_c
L_spun_c:
v_mfma_f32_16x16x32_bf16 v[24:27], v[184:187], a[80:83], v[24:27]
ds_read_b64_tr_b16 v[152:153], v6 offset:512
ds_read_b64_tr_b16 v[154:155], v6 offset:4608
v_mfma_f32_16x16x32_bf16 v[24:27], v[188:191], a[88:91], v[24:27]
ds_read_b64_tr_b16 v[156:157], v6 offset:8704
v_add_u32 v12, s25, v12
v_mfma_f32_16x16x32_bf16 v[40:43], v[188:191], a[92:95], v[40:43]
ds_read_b64_tr_b16 v[158:159], v6 offset:12800
s_add_u32 m0, s17, 0x10000
v_mfma_f32_16x16x32_bf16 v[40:43], v[184:187], a[84:87], v[40:43]
buffer_load_dwordx4 v12, s[64:67], 0 offen lds
v_mfma_f32_16x16x32_bf16 v[44:47], v[192:195], a[84:87], v[44:47]
ds_read_b64_tr_b16 v[160:161], v7 offset:512
ds_read_b64_tr_b16 v[162:163], v7 offset:4608
v_mfma_f32_16x16x32_bf16 v[44:47], v[196:199], a[92:95], v[44:47]
ds_read_b64_tr_b16 v[164:165], v7 offset:8704
v_add_u32 v13, s25, v13
v_mfma_f32_16x16x32_bf16 v[28:31], v[196:199], a[88:91], v[28:31]
ds_read_b64_tr_b16 v[166:167], v7 offset:12800
s_waitcnt lgkmcnt(8)
v_mfma_f32_16x16x32_bf16 v[28:31], v[192:195], a[80:83], v[28:31]
buffer_load_dwordx4 v13, s[64:67], 0 offen offset:1024 lds
v_mfma_f32_16x16x32_bf16 v[32:35], v[200:203], a[80:83], v[32:35]
ds_read_b64_tr_b16 v[168:169], v6 offset:768
ds_read_b64_tr_b16 v[170:171], v6 offset:4864
v_mfma_f32_16x16x32_bf16 v[32:35], v[204:207], a[88:91], v[32:35]
ds_read_b64_tr_b16 v[172:173], v6 offset:8960
v_mfma_f32_16x16x32_bf16 v[48:51], v[204:207], a[92:95], v[48:51]
ds_read_b64_tr_b16 v[174:175], v6 offset:13056
v_mfma_f32_16x16x32_bf16 v[48:51], v[200:203], a[84:87], v[48:51]
buffer_load_dwordx4 v12, s[64:67], s12 offen offset:2048 lds
v_mfma_f32_16x16x32_bf16 v[52:55], v[208:211], a[84:87], v[52:55]
ds_read_b64_tr_b16 v[176:177], v7 offset:768
ds_read_b64_tr_b16 v[178:179], v7 offset:4864
v_mfma_f32_16x16x32_bf16 v[52:55], v[212:215], a[92:95], v[52:55]
ds_read_b64_tr_b16 v[180:181], v7 offset:8960
s_waitcnt lgkmcnt(7)
v_mfma_f32_16x16x32_bf16 v[36:39], v[212:215], a[88:91], v[36:39]
ds_read_b64_tr_b16 v[182:183], v7 offset:13056
v_mfma_f32_16x16x32_bf16 v[36:39], v[208:211], a[80:83], v[36:39]
buffer_load_dwordx4 v13, s[64:67], s12 offen offset:3072 lds
v_mfma_f32_16x16x32_bf16 v[56:59], v[152:155], a[96:99], v[56:59]
ds_read_b64_tr_b16 v[184:185], v6 offset:0
ds_read_b64_tr_b16 v[186:187], v6 offset:4096
v_mfma_f32_16x16x32_bf16 v[56:59], v[156:159], a[104:107], v[56:59]
ds_read_b64_tr_b16 v[188:189], v6 offset:8192
v_mov_b32 v112, 0
v_mfma_f32_16x16x32_bf16 v[72:75], v[156:159], a[108:111], v[72:75]
ds_read_b64_tr_b16 v[190:191], v6 offset:12288
s_add_u32 s101, s101, s26
v_mfma_f32_16x16x32_bf16 v[72:75], v[152:155], a[100:103], v[72:75]
buffer_load_dwordx4 a[64:67], v3, s[88:91], s101 offen sc1
v_mfma_f32_16x16x32_bf16 v[76:79], v[160:163], a[100:103], v[76:79]
ds_read_b64_tr_b16 v[192:193], v7 offset:0
ds_read_b64_tr_b16 v[194:195], v7 offset:4096
v_mfma_f32_16x16x32_bf16 v[76:79], v[164:167], a[108:111], v[76:79]
ds_read_b64_tr_b16 v[196:197], v7 offset:8192
v_mov_b32 v113, 0
v_mfma_f32_16x16x32_bf16 v[60:63], v[164:167], a[104:107], v[60:63]
ds_read_b64_tr_b16 v[198:199], v7 offset:12288
s_waitcnt lgkmcnt(8)
v_mfma_f32_16x16x32_bf16 v[60:63], v[160:163], a[96:99], v[60:63]
buffer_load_dwordx4 a[68:71], v3, s[88:91], s101 offen offset:1024 sc1
v_mfma_f32_16x16x32_bf16 v[64:67], v[168:171], a[96:99], v[64:67]
ds_read_b64_tr_b16 v[200:201], v6 offset:256
ds_read_b64_tr_b16 v[202:203], v6 offset:4352
v_mfma_f32_16x16x32_bf16 v[64:67], v[172:175], a[104:107], v[64:67]
ds_read_b64_tr_b16 v[204:205], v6 offset:8448
v_mov_b32 v114, 0
v_mfma_f32_16x16x32_bf16 v[80:83], v[172:175], a[108:111], v[80:83]
ds_read_b64_tr_b16 v[206:207], v6 offset:12544
s_add_u32 s101, s101, 0x2000
v_mfma_f32_16x16x32_bf16 v[80:83], v[168:171], a[100:103], v[80:83]
buffer_load_dwordx4 a[72:75], v3, s[88:91], s101 offen sc1
v_mfma_f32_16x16x32_bf16 v[84:87], v[176:179], a[100:103], v[84:87]
ds_read_b64_tr_b16 v[208:209], v7 offset:256
ds_read_b64_tr_b16 v[210:211], v7 offset:4352
v_mfma_f32_16x16x32_bf16 v[84:87], v[180:183], a[108:111], v[84:87]
ds_read_b64_tr_b16 v[212:213], v7 offset:8448
s_waitcnt vmcnt(7) lgkmcnt(7)
v_mfma_f32_16x16x32_bf16 v[68:71], v[180:183], a[104:107], v[68:71]
ds_read_b64_tr_b16 v[214:215], v7 offset:12544
s_barrier
v_mfma_f32_16x16x32_bf16 v[68:71], v[176:179], a[96:99], v[68:71]
buffer_load_dwordx4 a[76:79], v3, s[88:91], s101 offen offset:1024 sc1
v_mov_b32 v115, 0
v_mfma_f32_16x16x32_bf16 v[24:27], v[184:187], a[96:99], v[24:27]
ds_read_b64_tr_b16 v[152:153], v6 offset:16896
ds_read_b64_tr_b16 v[154:155], v6 offset:20992
v_mfma_f32_16x16x32_bf16 v[24:27], v[188:191], a[104:107], v[24:27]
ds_read_b64_tr_b16 v[156:157], v6 offset:25088
v_add_u32 v12, 0x20000, v12
v_mfma_f32_16x16x32_bf16 v[40:43], v[188:191], a[108:111], v[40:43]
ds_read_b64_tr_b16 v[158:159], v6 offset:29184
s_add_u32 m0, s17, 0x14000
v_mfma_f32_16x16x32_bf16 v[40:43], v[184:187], a[100:103], v[40:43]
buffer_load_dwordx4 v12, s[64:67], 0 offen lds
v_mfma_f32_16x16x32_bf16 v[44:47], v[192:195], a[100:103], v[44:47]
ds_read_b64_tr_b16 v[160:161], v7 offset:16896
ds_read_b64_tr_b16 v[162:163], v7 offset:20992
v_mfma_f32_16x16x32_bf16 v[44:47], v[196:199], a[108:111], v[44:47]
ds_read_b64_tr_b16 v[164:165], v7 offset:25088
v_add_u32 v13, 0x20000, v13
v_mfma_f32_16x16x32_bf16 v[28:31], v[196:199], a[104:107], v[28:31]
ds_read_b64_tr_b16 v[166:167], v7 offset:29184
s_waitcnt lgkmcnt(8)
v_mfma_f32_16x16x32_bf16 v[28:31], v[192:195], a[96:99], v[28:31]
buffer_load_dwordx4 v13, s[64:67], 0 offen offset:1024 lds
v_mfma_f32_16x16x32_bf16 v[32:35], v[200:203], a[96:99], v[32:35]
ds_read_b64_tr_b16 v[168:169], v6 offset:17152
ds_read_b64_tr_b16 v[170:171], v6 offset:21248
v_mfma_f32_16x16x32_bf16 v[32:35], v[204:207], a[104:107], v[32:35]
ds_read_b64_tr_b16 v[172:173], v6 offset:25344
v_mfma_f32_16x16x32_bf16 v[48:51], v[204:207], a[108:111], v[48:51]
ds_read_b64_tr_b16 v[174:175], v6 offset:29440
v_mfma_f32_16x16x32_bf16 v[48:51], v[200:203], a[100:103], v[48:51]
buffer_load_dwordx4 v12, s[64:67], s12 offen offset:2048 lds
v_mfma_f32_16x16x32_bf16 v[52:55], v[208:211], a[100:103], v[52:55]
ds_read_b64_tr_b16 v[176:177], v7 offset:17152
ds_read_b64_tr_b16 v[178:179], v7 offset:21248
v_mfma_f32_16x16x32_bf16 v[52:55], v[212:215], a[108:111], v[52:55]
ds_read_b64_tr_b16 v[180:181], v7 offset:25344
s_waitcnt lgkmcnt(7)
v_mfma_f32_16x16x32_bf16 v[36:39], v[212:215], a[104:107], v[36:39]
ds_read_b64_tr_b16 v[182:183], v7 offset:29440
v_mfma_f32_16x16x32_bf16 v[36:39], v[208:211], a[96:99], v[36:39]
buffer_load_dwordx4 v13, s[64:67], s12 offen offset:3072 lds
v_mfma_f32_16x16x32_bf16 v[56:59], v[152:155], a[112:115], v[56:59]
ds_read_b64_tr_b16 v[184:185], v6 offset:16384
ds_read_b64_tr_b16 v[186:187], v6 offset:20480
v_mfma_f32_16x16x32_bf16 v[56:59], v[156:159], a[120:123], v[56:59]
ds_read_b64_tr_b16 v[188:189], v6 offset:24576
v_mov_b32 v116, 0
v_mfma_f32_16x16x32_bf16 v[72:75], v[156:159], a[124:127], v[72:75]
ds_read_b64_tr_b16 v[190:191], v6 offset:28672
s_add_u32 s101, s101, 0x2000
v_mfma_f32_16x16x32_bf16 v[72:75], v[152:155], a[116:119], v[72:75]
buffer_load_dwordx4 a[80:83], v3, s[88:91], s101 offen sc1
v_mfma_f32_16x16x32_bf16 v[76:79], v[160:163], a[116:119], v[76:79]
ds_read_b64_tr_b16 v[192:193], v7 offset:16384
ds_read_b64_tr_b16 v[194:195], v7 offset:20480
v_mfma_f32_16x16x32_bf16 v[76:79], v[164:167], a[124:127], v[76:79]
ds_read_b64_tr_b16 v[196:197], v7 offset:24576
v_mov_b32 v117, 0
v_mfma_f32_16x16x32_bf16 v[60:63], v[164:167], a[120:123], v[60:63]
ds_read_b64_tr_b16 v[198:199], v7 offset:28672
s_waitcnt lgkmcnt(8)
v_mfma_f32_16x16x32_bf16 v[60:63], v[160:163], a[112:115], v[60:63]
buffer_load_dwordx4 a[84:87], v3, s[88:91], s101 offen offset:1024 sc1
v_mfma_f32_16x16x32_bf16 v[64:67], v[168:171], a[112:115], v[64:67]
ds_read_b64_tr_b16 v[200:201], v6 offset:16640
ds_read_b64_tr_b16 v[202:203], v6 offset:20736
v_mfma_f32_16x16x32_bf16 v[64:67], v[172:175], a[120:123], v[64:67]
ds_read_b64_tr_b16 v[204:205], v6 offset:24832
v_mov_b32 v118, 0
v_mfma_f32_16x16x32_bf16 v[80:83], v[172:175], a[124:127], v[80:83]
ds_read_b64_tr_b16 v[206:207], v6 offset:28928
s_add_u32 s101, s101, 0x2000
v_mfma_f32_16x16x32_bf16 v[80:83], v[168:171], a[116:119], v[80:83]
buffer_load_dwordx4 a[88:91], v3, s[88:91], s101 offen sc1
v_mfma_f32_16x16x32_bf16 v[84:87], v[176:179], a[116:119], v[84:87]
ds_read_b64_tr_b16 v[208:209], v7 offset:16640
ds_read_b64_tr_b16 v[210:211], v7 offset:20736
v_mfma_f32_16x16x32_bf16 v[84:87], v[180:183], a[124:127], v[84:87]
ds_read_b64_tr_b16 v[212:213], v7 offset:24832
s_waitcnt vmcnt(7) lgkmcnt(7)
v_mfma_f32_16x16x32_bf16 v[68:71], v[180:183], a[120:123], v[68:71]
ds_read_b64_tr_b16 v[214:215], v7 offset:28928
s_barrier
v_mfma_f32_16x16x32_bf16 v[68:71], v[176:179], a[112:115], v[68:71]
buffer_load_dwordx4 a[92:95], v3, s[88:91], s101 offen offset:1024 sc1
v_mov_b32 v119, 0
v_mfma_f32_16x16x32_bf16 v[24:27], v[184:187], a[112:115], v[24:27]
ds_read_b64_tr_b16 v[152:153], v4 offset:512
ds_read_b64_tr_b16 v[154:155], v4 offset:4608
v_mfma_f32_16x16x32_bf16 v[24:27], v[188:191], a[120:123], v[24:27]
ds_read_b64_tr_b16 v[156:157], v4 offset:8704
v_add_u32 v12, 0x20000, v12
v_mfma_f32_16x16x32_bf16 v[40:43], v[188:191], a[124:127], v[40:43]
ds_read_b64_tr_b16 v[158:159], v4 offset:12800
s_add_u32 m0, s16, 0x0
v_mfma_f32_16x16x32_bf16 v[40:43], v[184:187], a[116:119], v[40:43]
buffer_load_dwordx4 v12, s[64:67], 0 offen lds
v_mfma_f32_16x16x32_bf16 v[44:47], v[192:195], a[116:119], v[44:47]
ds_read_b64_tr_b16 v[160:161], v5 offset:512
ds_read_b64_tr_b16 v[162:163], v5 offset:4608
v_mfma_f32_16x16x32_bf16 v[44:47], v[196:199], a[124:127], v[44:47]
ds_read_b64_tr_b16 v[164:165], v5 offset:8704
v_add_u32 v13, 0x20000, v13
v_mfma_f32_16x16x32_bf16 v[28:31], v[196:199], a[120:123], v[28:31]
ds_read_b64_tr_b16 v[166:167], v5 offset:12800
s_waitcnt lgkmcnt(8)
v_mfma_f32_16x16x32_bf16 v[28:31], v[192:195], a[112:115], v[28:31]
buffer_load_dwordx4 v13, s[64:67], 0 offen offset:1024 lds
v_mfma_f32_16x16x32_bf16 v[32:35], v[200:203], a[112:115], v[32:35]
ds_read_b64_tr_b16 v[168:169], v4 offset:768
ds_read_b64_tr_b16 v[170:171], v4 offset:4864
v_mfma_f32_16x16x32_bf16 v[32:35], v[204:207], a[120:123], v[32:35]
ds_read_b64_tr_b16 v[172:173], v4 offset:8960
v_mfma_f32_16x16x32_bf16 v[48:51], v[204:207], a[124:127], v[48:51]
ds_read_b64_tr_b16 v[174:175], v4 offset:13056
v_mfma_f32_16x16x32_bf16 v[48:51], v[200:203], a[116:119], v[48:51]
buffer_load_dwordx4 v12, s[64:67], s12 offen offset:2048 lds
v_mfma_f32_16x16x32_bf16 v[52:55], v[208:211], a[116:119], v[52:55]
ds_read_b64_tr_b16 v[176:177], v5 offset:768
ds_read_b64_tr_b16 v[178:179], v5 offset:4864
v_mfma_f32_16x16x32_bf16 v[52:55], v[212:215], a[124:127], v[52:55]
ds_read_b64_tr_b16 v[180:181], v5 offset:8960
s_waitcnt lgkmcnt(7)
v_mfma_f32_16x16x32_bf16 v[36:39], v[212:215], a[120:123], v[36:39]
ds_read_b64_tr_b16 v[182:183], v5 offset:13056
v_mfma_f32_16x16x32_bf16 v[36:39], v[208:211], a[112:115], v[36:39]
buffer_load_dwordx4 v13, s[64:67], s12 offen offset:3072 lds
v_mfma_f32_16x16x32_bf16 v[120:123], v[152:155], a[64:67], 0
ds_read_b64_tr_b16 v[184:185], v4 offset:0
ds_read_b64_tr_b16 v[186:187], v4 offset:4096
v_mfma_f32_16x16x32_bf16 v[120:123], v[156:159], a[72:75], v[120:123]
ds_read_b64_tr_b16 v[188:189], v4 offset:8192
v_mfma_f32_16x16x32_bf16 v[136:139], v[156:159], a[76:79], 0
ds_read_b64_tr_b16 v[190:191], v4 offset:12288
s_add_u32 s101, s101, 0x2000
v_mfma_f32_16x16x32_bf16 v[136:139], v[152:155], a[68:71], v[136:139]
buffer_load_dwordx4 a[96:99], v3, s[88:91], s101 offen sc1
v_mfma_f32_16x16x32_bf16 v[140:143], v[160:163], a[68:71], 0
ds_read_b64_tr_b16 v[192:193], v5 offset:0
ds_read_b64_tr_b16 v[194:195], v5 offset:4096
v_mfma_f32_16x16x32_bf16 v[140:143], v[164:167], a[76:79], v[140:143]
ds_read_b64_tr_b16 v[196:197], v5 offset:8192
v_mfma_f32_16x16x32_bf16 v[124:127], v[164:167], a[72:75], 0
ds_read_b64_tr_b16 v[198:199], v5 offset:12288
s_waitcnt lgkmcnt(8)
v_mfma_f32_16x16x32_bf16 v[124:127], v[160:163], a[64:67], v[124:127]
buffer_load_dwordx4 a[100:103], v3, s[88:91], s101 offen offset:1024 sc1
v_mfma_f32_16x16x32_bf16 v[128:131], v[168:171], a[64:67], 0
ds_read_b64_tr_b16 v[200:201], v4 offset:256
ds_read_b64_tr_b16 v[202:203], v4 offset:4352
v_mfma_f32_16x16x32_bf16 v[128:131], v[172:175], a[72:75], v[128:131]
ds_read_b64_tr_b16 v[204:205], v4 offset:8448
v_mfma_f32_16x16x32_bf16 v[144:147], v[172:175], a[76:79], 0
ds_read_b64_tr_b16 v[206:207], v4 offset:12544
s_add_u32 s101, s101, 0x2000
v_mfma_f32_16x16x32_bf16 v[144:147], v[168:171], a[68:71], v[144:147]
buffer_load_dwordx4 a[104:107], v3, s[88:91], s101 offen sc1
v_mfma_f32_16x16x32_bf16 v[148:151], v[176:179], a[68:71], 0
ds_read_b64_tr_b16 v[208:209], v5 offset:256
ds_read_b64_tr_b16 v[210:211], v5 offset:4352
v_mfma_f32_16x16x32_bf16 v[148:151], v[180:183], a[76:79], v[148:151]
ds_read_b64_tr_b16 v[212:213], v5 offset:8448
s_waitcnt vmcnt(7) lgkmcnt(7)
v_mfma_f32_16x16x32_bf16 v[132:135], v[180:183], a[72:75], 0
ds_read_b64_tr_b16 v[214:215], v5 offset:12544
s_barrier
v_mfma_f32_16x16x32_bf16 v[132:135], v[176:179], a[64:67], v[132:135]
buffer_load_dwordx4 a[108:111], v3, s[88:91], s101 offen offset:1024 sc1
s_mov_b32 s15, 7
L_p4_loop:
v_mfma_f32_16x16x32_bf16 v[88:91], v[184:187], a[64:67], v[88:91]
ds_read_b64_tr_b16 v[152:153], v4 offset:16896
ds_read_b64_tr_b16 v[154:155], v4 offset:20992
v_mfma_f32_16x16x32_bf16 v[88:91], v[188:191], a[72:75], v[88:91]
ds_read_b64_tr_b16 v[156:157], v4 offset:25088
v_add_u32 v12, 0x20000, v12
v_mfma_f32_16x16x32_bf16 v[104:107], v[188:191], a[76:79], v[104:107]
ds_read_b64_tr_b16 v[158:159], v4 offset:29184
s_add_u32 m0, s16, 0x4000
v_mfma_f32_16x16x32_bf16 v[104:107], v[184:187], a[68:71], v[104:107]
buffer_load_dwordx4 v12, s[64:67], 0 offen lds
v_mfma_f32_16x16x32_bf16 v[108:111], v[192:195], a[68:71], v[108:111]
ds_read_b64_tr_b16 v[160:161], v5 offset:16896
ds_read_b64_tr_b16 v[162:163], v5 offset:20992
v_mfma_f32_16x16x32_bf16 v[108:111], v[196:199], a[76:79], v[108:111]
ds_read_b64_tr_b16 v[164:165], v5 offset:25088
v_add_u32 v13, 0x20000, v13
v_mfma_f32_16x16x32_bf16 v[92:95], v[196:199], a[72:75], v[92:95]
ds_read_b64_tr_b16 v[166:167], v5 offset:29184
s_waitcnt lgkmcnt(8)
v_mfma_f32_16x16x32_bf16 v[92:95], v[192:195], a[64:67], v[92:95]
buffer_load_dwordx4 v13, s[64:67], 0 offen offset:1024 lds
v_mfma_f32_16x16x32_bf16 v[96:99], v[200:203], a[64:67], v[96:99]
ds_read_b64_tr_b16 v[168:169], v4 offset:17152
ds_read_b64_tr_b16 v[170:171], v4 offset:21248
v_mfma_f32_16x16x32_bf16 v[96:99], v[204:207], a[72:75], v[96:99]
ds_read_b64_tr_b16 v[172:173], v4 offset:25344
v_mfma_f32_16x16x32_bf16 v[112:115], v[204:207], a[76:79], v[112:115]
ds_read_b64_tr_b16 v[174:175], v4 offset:29440
v_mfma_f32_16x16x32_bf16 v[112:115], v[200:203], a[68:71], v[112:115]
buffer_load_dwordx4 v12, s[64:67], s12 offen offset:2048 lds
v_mfma_f32_16x16x32_bf16 v[116:119], v[208:211], a[68:71], v[116:119]
ds_read_b64_tr_b16 v[176:177], v5 offset:17152
ds_read_b64_tr_b16 v[178:179], v5 offset:21248
v_mfma_f32_16x16x32_bf16 v[116:119], v[212:215], a[76:79], v[116:119]
ds_read_b64_tr_b16 v[180:181], v5 offset:25344
s_waitcnt lgkmcnt(7)
v_mfma_f32_16x16x32_bf16 v[100:103], v[212:215], a[72:75], v[100:103]
ds_read_b64_tr_b16 v[182:183], v5 offset:29440
v_mfma_f32_16x16x32_bf16 v[100:103], v[208:211], a[64:67], v[100:103]
buffer_load_dwordx4 v13, s[64:67], s12 offen offset:3072 lds
v_mfma_f32_16x16x32_bf16 v[120:123], v[152:155], a[80:83], v[120:123]
ds_read_b64_tr_b16 v[184:185], v4 offset:16384
ds_read_b64_tr_b16 v[186:187], v4 offset:20480
v_mfma_f32_16x16x32_bf16 v[120:123], v[156:159], a[88:91], v[120:123]
ds_read_b64_tr_b16 v[188:189], v4 offset:24576
v_mfma_f32_16x16x32_bf16 v[136:139], v[156:159], a[92:95], v[136:139]
ds_read_b64_tr_b16 v[190:191], v4 offset:28672
s_add_u32 s101, s101, 0x2000
v_mfma_f32_16x16x32_bf16 v[136:139], v[152:155], a[84:87], v[136:139]
buffer_load_dwordx4 a[112:115], v3, s[88:91], s101 offen sc1
v_mfma_f32_16x16x32_bf16 v[140:143], v[160:163], a[84:87], v[140:143]
ds_read_b64_tr_b16 v[192:193], v5 offset:16384
ds_read_b64_tr_b16 v[194:195], v5 offset:20480
v_mfma_f32_16x16x32_bf16 v[140:143], v[164:167], a[92:95], v[140:143]
ds_read_b64_tr_b16 v[196:197], v5 offset:24576
v_mfma_f32_16x16x32_bf16 v[124:127], v[164:167], a[88:91], v[124:127]
ds_read_b64_tr_b16 v[198:199], v5 offset:28672
s_waitcnt lgkmcnt(8)
v_mfma_f32_16x16x32_bf16 v[124:127], v[160:163], a[80:83], v[124:127]
buffer_load_dwordx4 a[116:119], v3, s[88:91], s101 offen offset:1024 sc1
v_mfma_f32_16x16x32_bf16 v[128:131], v[168:171], a[80:83], v[128:131]
ds_read_b64_tr_b16 v[200:201], v4 offset:16640
ds_read_b64_tr_b16 v[202:203], v4 offset:20736
v_mfma_f32_16x16x32_bf16 v[128:131], v[172:175], a[88:91], v[128:131]
ds_read_b64_tr_b16 v[204:205], v4 offset:24832
v_mfma_f32_16x16x32_bf16 v[144:147], v[172:175], a[92:95], v[144:147]
ds_read_b64_tr_b16 v[206:207], v4 offset:28928
s_add_u32 s101, s101, 0x2000
v_mfma_f32_16x16x32_bf16 v[144:147], v[168:171], a[84:87], v[144:147]
buffer_load_dwordx4 a[120:123], v3, s[88:91], s101 offen sc1
v_mfma_f32_16x16x32_bf16 v[148:151], v[176:179], a[84:87], v[148:151]
ds_read_b64_tr_b16 v[208:209], v5 offset:16640
ds_read_b64_tr_b16 v[210:211], v5 offset:20736
v_mfma_f32_16x16x32_bf16 v[148:151], v[180:183], a[92:95], v[148:151]
ds_read_b64_tr_b16 v[212:213], v5 offset:24832
s_waitcnt vmcnt(7) lgkmcnt(7)
v_mfma_f32_16x16x32_bf16 v[132:135], v[180:183], a[88:91], v[132:135]
ds_read_b64_tr_b16 v[214:215], v5 offset:28928
s_barrier
v_mfma_f32_16x16x32_bf16 v[132:135], v[176:179], a[80:83], v[132:135]
buffer_load_dwordx4 a[124:127], v3, s[88:91], s101 offen offset:1024 sc1
v_mfma_f32_16x16x32_bf16 v[88:91], v[184:187], a[80:83], v[88:91]
ds_read_b64_tr_b16 v[152:153], v6 offset:512
ds_read_b64_tr_b16 v[154:155], v6 offset:4608
v_mfma_f32_16x16x32_bf16 v[88:91], v[188:191], a[88:91], v[88:91]
ds_read_b64_tr_b16 v[156:157], v6 offset:8704
v_add_u32 v12, 0x20000, v12
v_mfma_f32_16x16x32_bf16 v[104:107], v[188:191], a[92:95], v[104:107]
ds_read_b64_tr_b16 v[158:159], v6 offset:12800
s_add_u32 m0, s17, 0x10000
v_mfma_f32_16x16x32_bf16 v[104:107], v[184:187], a[84:87], v[104:107]
buffer_load_dwordx4 v12, s[64:67], 0 offen lds
v_mfma_f32_16x16x32_bf16 v[108:111], v[192:195], a[84:87], v[108:111]
ds_read_b64_tr_b16 v[160:161], v7 offset:512
ds_read_b64_tr_b16 v[162:163], v7 offset:4608
v_mfma_f32_16x16x32_bf16 v[108:111], v[196:199], a[92:95], v[108:111]
ds_read_b64_tr_b16 v[164:165], v7 offset:8704
v_add_u32 v13, 0x20000, v13
v_mfma_f32_16x16x32_bf16 v[92:95], v[196:199], a[88:91], v[92:95]
ds_read_b64_tr_b16 v[166:167], v7 offset:12800
s_waitcnt lgkmcnt(8)
v_mfma_f32_16x16x32_bf16 v[92:95], v[192:195], a[80:83], v[92:95]
buffer_load_dwordx4 v13, s[64:67], 0 offen offset:1024 lds
v_mfma_f32_16x16x32_bf16 v[96:99], v[200:203], a[80:83], v[96:99]
ds_read_b64_tr_b16 v[168:169], v6 offset:768
ds_read_b64_tr_b16 v[170:171], v6 offset:4864
v_mfma_f32_16x16x32_bf16 v[96:99], v[204:207], a[88:91], v[96:99]
ds_read_b64_tr_b16 v[172:173], v6 offset:8960
v_mfma_f32_16x16x32_bf16 v[112:115], v[204:207], a[92:95], v[112:115]
ds_read_b64_tr_b16 v[174:175], v6 offset:13056
v_mfma_f32_16x16x32_bf16 v[112:115], v[200:203], a[84:87], v[112:115]
buffer_load_dwordx4 v12, s[64:67], s12 offen offset:2048 lds
v_mfma_f32_16x16x32_bf16 v[116:119], v[208:211], a[84:87], v[116:119]
ds_read_b64_tr_b16 v[176:177], v7 offset:768
ds_read_b64_tr_b16 v[178:179], v7 offset:4864
v_mfma_f32_16x16x32_bf16 v[116:119], v[212:215], a[92:95], v[116:119]
ds_read_b64_tr_b16 v[180:181], v7 offset:8960
s_waitcnt lgkmcnt(7)
v_mfma_f32_16x16x32_bf16 v[100:103], v[212:215], a[88:91], v[100:103]
ds_read_b64_tr_b16 v[182:183], v7 offset:13056
v_mfma_f32_16x16x32_bf16 v[100:103], v[208:211], a[80:83], v[100:103]
buffer_load_dwordx4 v13, s[64:67], s12 offen offset:3072 lds
v_mfma_f32_16x16x32_bf16 v[120:123], v[152:155], a[96:99], v[120:123]
ds_read_b64_tr_b16 v[184:185], v6 offset:0
ds_read_b64_tr_b16 v[186:187], v6 offset:4096
v_mfma_f32_16x16x32_bf16 v[120:123], v[156:159], a[104:107], v[120:123]
ds_read_b64_tr_b16 v[188:189], v6 offset:8192
v_mfma_f32_16x16x32_bf16 v[136:139], v[156:159], a[108:111], v[136:139]
ds_read_b64_tr_b16 v[190:191], v6 offset:12288
s_add_u32 s101, s101, 0x2000
v_mfma_f32_16x16x32_bf16 v[136:139], v[152:155], a[100:103], v[136:139]
buffer_load_dwordx4 a[64:67], v3, s[88:91], s101 offen sc1
v_mfma_f32_16x16x32_bf16 v[140:143], v[160:163], a[100:103], v[140:143]
ds_read_b64_tr_b16 v[192:193], v7 offset:0
ds_read_b64_tr_b16 v[194:195], v7 offset:4096
v_mfma_f32_16x16x32_bf16 v[140:143], v[164:167], a[108:111], v[140:143]
ds_read_b64_tr_b16 v[196:197], v7 offset:8192
v_mfma_f32_16x16x32_bf16 v[124:127], v[164:167], a[104:107], v[124:127]
ds_read_b64_tr_b16 v[198:199], v7 offset:12288
s_waitcnt lgkmcnt(8)
v_mfma_f32_16x16x32_bf16 v[124:127], v[160:163], a[96:99], v[124:127]
buffer_load_dwordx4 a[68:71], v3, s[88:91], s101 offen offset:1024 sc1
v_mfma_f32_16x16x32_bf16 v[128:131], v[168:171], a[96:99], v[128:131]
ds_read_b64_tr_b16 v[200:201], v6 offset:256
ds_read_b64_tr_b16 v[202:203], v6 offset:4352
v_mfma_f32_16x16x32_bf16 v[128:131], v[172:175], a[104:107], v[128:131]
ds_read_b64_tr_b16 v[204:205], v6 offset:8448
v_mfma_f32_16x16x32_bf16 v[144:147], v[172:175], a[108:111], v[144:147]
ds_read_b64_tr_b16 v[206:207], v6 offset:12544
s_add_u32 s101, s101, 0x2000
v_mfma_f32_16x16x32_bf16 v[144:147], v[168:171], a[100:103], v[144:147]
buffer_load_dwordx4 a[72:75], v3, s[88:91], s101 offen sc1
v_mfma_f32_16x16x32_bf16 v[148:151], v[176:179], a[100:103], v[148:151]
ds_read_b64_tr_b16 v[208:209], v7 offset:256
ds_read_b64_tr_b16 v[210:211], v7 offset:4352
v_mfma_f32_16x16x32_bf16 v[148:151], v[180:183], a[108:111], v[148:151]
ds_read_b64_tr_b16 v[212:213], v7 offset:8448
s_waitcnt vmcnt(7) lgkmcnt(7)
v_mfma_f32_16x16x32_bf16 v[132:135], v[180:183], a[104:107], v[132:135]
ds_read_b64_tr_b16 v[214:215], v7 offset:12544
s_barrier
v_mfma_f32_16x16x32_bf16 v[132:135], v[176:179], a[96:99], v[132:135]
buffer_load_dwordx4 a[76:79], v3, s[88:91], s101 offen offset:1024 sc1
v_mfma_f32_16x16x32_bf16 v[88:91], v[184:187], a[96:99], v[88:91]
ds_read_b64_tr_b16 v[152:153], v6 offset:16896
ds_read_b64_tr_b16 v[154:155], v6 offset:20992
v_mfma_f32_16x16x32_bf16 v[88:91], v[188:191], a[104:107], v[88:91]
ds_read_b64_tr_b16 v[156:157], v6 offset:25088
v_add_u32 v12, 0x20000, v12
v_mfma_f32_16x16x32_bf16 v[104:107], v[188:191], a[108:111], v[104:107]
ds_read_b64_tr_b16 v[158:159], v6 offset:29184
s_add_u32 m0, s17, 0x14000
v_mfma_f32_16x16x32_bf16 v[104:107], v[184:187], a[100:103], v[104:107]
buffer_load_dwordx4 v12, s[64:67], 0 offen lds
v_mfma_f32_16x16x32_bf16 v[108:111], v[192:195], a[100:103], v[108:111]
ds_read_b64_tr_b16 v[160:161], v7 offset:16896
ds_read_b64_tr_b16 v[162:163], v7 offset:20992
v_mfma_f32_16x16x32_bf16 v[108:111], v[196:199], a[108:111], v[108:111]
ds_read_b64_tr_b16 v[164:165], v7 offset:25088
v_add_u32 v13, 0x20000, v13
v_mfma_f32_16x16x32_bf16 v[92:95], v[196:199], a[104:107], v[92:95]
ds_read_b64_tr_b16 v[166:167], v7 offset:29184
s_waitcnt lgkmcnt(8)
v_mfma_f32_16x16x32_bf16 v[92:95], v[192:195], a[96:99], v[92:95]
buffer_load_dwordx4 v13, s[64:67], 0 offen offset:1024 lds
v_mfma_f32_16x16x32_bf16 v[96:99], v[200:203], a[96:99], v[96:99]
ds_read_b64_tr_b16 v[168:169], v6 offset:17152
ds_read_b64_tr_b16 v[170:171], v6 offset:21248
v_mfma_f32_16x16x32_bf16 v[96:99], v[204:207], a[104:107], v[96:99]
ds_read_b64_tr_b16 v[172:173], v6 offset:25344
v_mfma_f32_16x16x32_bf16 v[112:115], v[204:207], a[108:111], v[112:115]
ds_read_b64_tr_b16 v[174:175], v6 offset:29440
v_mfma_f32_16x16x32_bf16 v[112:115], v[200:203], a[100:103], v[112:115]
buffer_load_dwordx4 v12, s[64:67], s12 offen offset:2048 lds
v_mfma_f32_16x16x32_bf16 v[116:119], v[208:211], a[100:103], v[116:119]
ds_read_b64_tr_b16 v[176:177], v7 offset:17152
ds_read_b64_tr_b16 v[178:179], v7 offset:21248
v_mfma_f32_16x16x32_bf16 v[116:119], v[212:215], a[108:111], v[116:119]
ds_read_b64_tr_b16 v[180:181], v7 offset:25344
s_waitcnt lgkmcnt(7)
v_mfma_f32_16x16x32_bf16 v[100:103], v[212:215], a[104:107], v[100:103]
ds_read_b64_tr_b16 v[182:183], v7 offset:29440
v_mfma_f32_16x16x32_bf16 v[100:103], v[208:211], a[96:99], v[100:103]
buffer_load_dwordx4 v13, s[64:67], s12 offen offset:3072 lds
v_mfma_f32_16x16x32_bf16 v[120:123], v[152:155], a[112:115], v[120:123]
ds_read_b64_tr_b16 v[184:185], v6 offset:16384
ds_read_b64_tr_b16 v[186:187], v6 offset:20480
v_mfma_f32_16x16x32_bf16 v[120:123], v[156:159], a[120:123], v[120:123]
ds_read_b64_tr_b16 v[188:189], v6 offset:24576
v_mfma_f32_16x16x32_bf16 v[136:139], v[156:159], a[124:127], v[136:139]
ds_read_b64_tr_b16 v[190:191], v6 offset:28672
s_add_u32 s101, s101, 0x2000
v_mfma_f32_16x16x32_bf16 v[136:139], v[152:155], a[116:119], v[136:139]
buffer_load_dwordx4 a[80:83], v3, s[88:91], s101 offen sc1
v_mfma_f32_16x16x32_bf16 v[140:143], v[160:163], a[116:119], v[140:143]
ds_read_b64_tr_b16 v[192:193], v7 offset:16384
ds_read_b64_tr_b16 v[194:195], v7 offset:20480
v_mfma_f32_16x16x32_bf16 v[140:143], v[164:167], a[124:127], v[140:143]
ds_read_b64_tr_b16 v[196:197], v7 offset:24576
v_mfma_f32_16x16x32_bf16 v[124:127], v[164:167], a[120:123], v[124:127]
ds_read_b64_tr_b16 v[198:199], v7 offset:28672
s_waitcnt lgkmcnt(8)
v_mfma_f32_16x16x32_bf16 v[124:127], v[160:163], a[112:115], v[124:127]
buffer_load_dwordx4 a[84:87], v3, s[88:91], s101 offen offset:1024 sc1
v_mfma_f32_16x16x32_bf16 v[128:131], v[168:171], a[112:115], v[128:131]
ds_read_b64_tr_b16 v[200:201], v6 offset:16640
ds_read_b64_tr_b16 v[202:203], v6 offset:20736
v_mfma_f32_16x16x32_bf16 v[128:131], v[172:175], a[120:123], v[128:131]
ds_read_b64_tr_b16 v[204:205], v6 offset:24832
v_mfma_f32_16x16x32_bf16 v[144:147], v[172:175], a[124:127], v[144:147]
ds_read_b64_tr_b16 v[206:207], v6 offset:28928
s_add_u32 s101, s101, 0x2000
v_mfma_f32_16x16x32_bf16 v[144:147], v[168:171], a[116:119], v[144:147]
buffer_load_dwordx4 a[88:91], v3, s[88:91], s101 offen sc1
v_mfma_f32_16x16x32_bf16 v[148:151], v[176:179], a[116:119], v[148:151]
ds_read_b64_tr_b16 v[208:209], v7 offset:16640
ds_read_b64_tr_b16 v[210:211], v7 offset:20736
v_mfma_f32_16x16x32_bf16 v[148:151], v[180:183], a[124:127], v[148:151]
ds_read_b64_tr_b16 v[212:213], v7 offset:24832
s_waitcnt vmcnt(7) lgkmcnt(7)
v_mfma_f32_16x16x32_bf16 v[132:135], v[180:183], a[120:123], v[132:135]
ds_read_b64_tr_b16 v[214:215], v7 offset:28928
s_barrier
v_mfma_f32_16x16x32_bf16 v[132:135], v[176:179], a[112:115], v[132:135]
buffer_load_dwordx4 a[92:95], v3, s[88:91], s101 offen offset:1024 sc1
v_mfma_f32_16x16x32_bf16 v[88:91], v[184:187], a[112:115], v[88:91]
ds_read_b64_tr_b16 v[152:153], v4 offset:512
ds_read_b64_tr_b16 v[154:155], v4 offset:4608
v_mfma_f32_16x16x32_bf16 v[88:91], v[188:191], a[120:123], v[88:91]
ds_read_b64_tr_b16 v[156:157], v4 offset:8704
v_add_u32 v12, 0x20000, v12
v_mfma_f32_16x16x32_bf16 v[104:107], v[188:191], a[124:127], v[104:107]
ds_read_b64_tr_b16 v[158:159], v4 offset:12800
s_add_u32 m0, s16, 0x0
v_mfma_f32_16x16x32_bf16 v[104:107], v[184:187], a[116:119], v[104:107]
buffer_load_dwordx4 v12, s[64:67], 0 offen lds
v_mfma_f32_16x16x32_bf16 v[108:111], v[192:195], a[116:119], v[108:111]
ds_read_b64_tr_b16 v[160:161], v5 offset:512
ds_read_b64_tr_b16 v[162:163], v5 offset:4608
v_mfma_f32_16x16x32_bf16 v[108:111], v[196:199], a[124:127], v[108:111]
ds_read_b64_tr_b16 v[164:165], v5 offset:8704
v_add_u32 v13, 0x20000, v13
v_mfma_f32_16x16x32_bf16 v[92:95], v[196:199], a[120:123], v[92:95]
ds_read_b64_tr_b16 v[166:167], v5 offset:12800
s_waitcnt lgkmcnt(8)
v_mfma_f32_16x16x32_bf16 v[92:95], v[192:195], a[112:115], v[92:95]
buffer_load_dwordx4 v13, s[64:67], 0 offen offset:1024 lds
v_mfma_f32_16x16x32_bf16 v[96:99], v[200:203], a[112:115], v[96:99]
ds_read_b64_tr_b16 v[168:169], v4 offset:768
ds_read_b64_tr_b16 v[170:171], v4 offset:4864
v_mfma_f32_16x16x32_bf16 v[96:99], v[204:207], a[120:123], v[96:99]
ds_read_b64_tr_b16 v[172:173], v4 offset:8960
v_mfma_f32_16x16x32_bf16 v[112:115], v[204:207], a[124:127], v[112:115]
ds_read_b64_tr_b16 v[174:175], v4 offset:13056
v_mfma_f32_16x16x32_bf16 v[112:115], v[200:203], a[116:119], v[112:115]
buffer_load_dwordx4 v12, s[64:67], s12 offen offset:2048 lds
v_mfma_f32_16x16x32_bf16 v[116:119], v[208:211], a[116:119], v[116:119]
ds_read_b64_tr_b16 v[176:177], v5 offset:768
ds_read_b64_tr_b16 v[178:179], v5 offset:4864
v_mfma_f32_16x16x32_bf16 v[116:119], v[212:215], a[124:127], v[116:119]
ds_read_b64_tr_b16 v[180:181], v5 offset:8960
s_waitcnt lgkmcnt(7)
v_mfma_f32_16x16x32_bf16 v[100:103], v[212:215], a[120:123], v[100:103]
ds_read_b64_tr_b16 v[182:183], v5 offset:13056
v_mfma_f32_16x16x32_bf16 v[100:103], v[208:211], a[112:115], v[100:103]
buffer_load_dwordx4 v13, s[64:67], s12 offen offset:3072 lds
v_mfma_f32_16x16x32_bf16 v[120:123], v[152:155], a[64:67], v[120:123]
ds_read_b64_tr_b16 v[184:185], v4 offset:0
ds_read_b64_tr_b16 v[186:187], v4 offset:4096
v_mfma_f32_16x16x32_bf16 v[120:123], v[156:159], a[72:75], v[120:123]
ds_read_b64_tr_b16 v[188:189], v4 offset:8192
v_mfma_f32_16x16x32_bf16 v[136:139], v[156:159], a[76:79], v[136:139]
ds_read_b64_tr_b16 v[190:191], v4 offset:12288
s_add_u32 s101, s101, 0x2000
v_mfma_f32_16x16x32_bf16 v[136:139], v[152:155], a[68:71], v[136:139]
buffer_load_dwordx4 a[96:99], v3, s[88:91], s101 offen sc1
v_mfma_f32_16x16x32_bf16 v[140:143], v[160:163], a[68:71], v[140:143]
ds_read_b64_tr_b16 v[192:193], v5 offset:0
ds_read_b64_tr_b16 v[194:195], v5 offset:4096
v_mfma_f32_16x16x32_bf16 v[140:143], v[164:167], a[76:79], v[140:143]
ds_read_b64_tr_b16 v[196:197], v5 offset:8192
v_mfma_f32_16x16x32_bf16 v[124:127], v[164:167], a[72:75], v[124:127]
ds_read_b64_tr_b16 v[198:199], v5 offset:12288
s_waitcnt lgkmcnt(8)
v_mfma_f32_16x16x32_bf16 v[124:127], v[160:163], a[64:67], v[124:127]
buffer_load_dwordx4 a[100:103], v3, s[88:91], s101 offen offset:1024 sc1
v_mfma_f32_16x16x32_bf16 v[128:131], v[168:171], a[64:67], v[128:131]
ds_read_b64_tr_b16 v[200:201], v4 offset:256
ds_read_b64_tr_b16 v[202:203], v4 offset:4352
v_mfma_f32_16x16x32_bf16 v[128:131], v[172:175], a[72:75], v[128:131]
ds_read_b64_tr_b16 v[204:205], v4 offset:8448
s_sub_u32 s15, s15, 1
v_mfma_f32_16x16x32_bf16 v[144:147], v[172:175], a[76:79], v[144:147]
ds_read_b64_tr_b16 v[206:207], v4 offset:12544
s_add_u32 s101, s101, 0x2000
v_mfma_f32_16x16x32_bf16 v[144:147], v[168:171], a[68:71], v[144:147]
buffer_load_dwordx4 a[104:107], v3, s[88:91], s101 offen sc1
v_mfma_f32_16x16x32_bf16 v[148:151], v[176:179], a[68:71], v[148:151]
ds_read_b64_tr_b16 v[208:209], v5 offset:256
ds_read_b64_tr_b16 v[210:211], v5 offset:4352
v_mfma_f32_16x16x32_bf16 v[148:151], v[180:183], a[76:79], v[148:151]
ds_read_b64_tr_b16 v[212:213], v5 offset:8448
s_waitcnt vmcnt(7) lgkmcnt(7)
v_mfma_f32_16x16x32_bf16 v[132:135], v[180:183], a[72:75], v[132:135]
ds_read_b64_tr_b16 v[214:215], v5 offset:12544
s_barrier
v_mfma_f32_16x16x32_bf16 v[132:135], v[176:179], a[64:67], v[132:135]
buffer_load_dwordx4 a[108:111], v3, s[88:91], s101 offen offset:1024 sc1
s_cmp_lg_u32 s15, 0
s_cbranch_scc1 L_p4_loop
s_lshl_b32 s8, s99, 7
s_lshl_b32 s9, s4, 5
s_add_u32 s8, s8, s9
s_lshl_b32 s9, s8, 2
s_add_u32 s9, s9, 0x3600000
buffer_load_dword v8, v20, s[88:91], s9 offen sc1
buffer_load_dword v9, v20, s[88:91], s9 offen offset:64 sc1
v_mfma_f32_16x16x32_bf16 v[88:91], v[184:187], a[64:67], v[88:91]
ds_read_b64_tr_b16 v[152:153], v4 offset:16896
ds_read_b64_tr_b16 v[154:155], v4 offset:20992
v_mfma_f32_16x16x32_bf16 v[88:91], v[188:191], a[72:75], v[88:91]
ds_read_b64_tr_b16 v[156:157], v4 offset:25088
v_add_u32 v12, 0x20000, v12
v_mfma_f32_16x16x32_bf16 v[104:107], v[188:191], a[76:79], v[104:107]
ds_read_b64_tr_b16 v[158:159], v4 offset:29184
s_add_u32 m0, s16, 0x4000
v_mfma_f32_16x16x32_bf16 v[104:107], v[184:187], a[68:71], v[104:107]
buffer_load_dwordx4 v12, s[64:67], 0 offen lds
v_mfma_f32_16x16x32_bf16 v[108:111], v[192:195], a[68:71], v[108:111]
ds_read_b64_tr_b16 v[160:161], v5 offset:16896
ds_read_b64_tr_b16 v[162:163], v5 offset:20992
v_mfma_f32_16x16x32_bf16 v[108:111], v[196:199], a[76:79], v[108:111]
ds_read_b64_tr_b16 v[164:165], v5 offset:25088
v_add_u32 v13, 0x20000, v13
v_mfma_f32_16x16x32_bf16 v[92:95], v[196:199], a[72:75], v[92:95]
ds_read_b64_tr_b16 v[166:167], v5 offset:29184
s_waitcnt lgkmcnt(8)
v_mfma_f32_16x16x32_bf16 v[92:95], v[192:195], a[64:67], v[92:95]
buffer_load_dwordx4 v13, s[64:67], 0 offen offset:1024 lds
v_mfma_f32_16x16x32_bf16 v[96:99], v[200:203], a[64:67], v[96:99]
ds_read_b64_tr_b16 v[168:169], v4 offset:17152
ds_read_b64_tr_b16 v[170:171], v4 offset:21248
v_mfma_f32_16x16x32_bf16 v[96:99], v[204:207], a[72:75], v[96:99]
ds_read_b64_tr_b16 v[172:173], v4 offset:25344
v_mfma_f32_16x16x32_bf16 v[112:115], v[204:207], a[76:79], v[112:115]
ds_read_b64_tr_b16 v[174:175], v4 offset:29440
v_mfma_f32_16x16x32_bf16 v[112:115], v[200:203], a[68:71], v[112:115]
buffer_load_dwordx4 v12, s[64:67], s12 offen offset:2048 lds
v_mfma_f32_16x16x32_bf16 v[116:119], v[208:211], a[68:71], v[116:119]
ds_read_b64_tr_b16 v[176:177], v5 offset:17152
ds_read_b64_tr_b16 v[178:179], v5 offset:21248
v_mfma_f32_16x16x32_bf16 v[116:119], v[212:215], a[76:79], v[116:119]
ds_read_b64_tr_b16 v[180:181], v5 offset:25344
s_waitcnt vmcnt(3) lgkmcnt(7)
v_mfma_f32_16x16x32_bf16 v[100:103], v[212:215], a[72:75], v[100:103]
ds_read_b64_tr_b16 v[182:183], v5 offset:29440
s_barrier
v_mfma_f32_16x16x32_bf16 v[100:103], v[208:211], a[64:67], v[100:103]
buffer_load_dwordx4 v13, s[64:67], s12 offen offset:3072 lds
v_and_b32 v18, 16, v0
v_lshrrev_b32 v19, 5, v0
v_lshlrev_b32 v19, 4, v19
v_lshl_add_u32 v18, v18, 1, v19
v_lshl_add_u32 v17, v20, 9, v18
s_lshl_b32 s8, s8, 11
s_lshl_b32 s9, s100, 8
s_add_u32 s8, s8, s9
s_lshl_b32 s9, s14, 7
s_add_u32 s8, s8, s9
s_add_u32 s9, s8, 0x8000
s_lshl_b32 s28, s2, 2
s_add_u32 s28, s28, s4
s_lshl_b32 s28, s28, 12
s_add_u32 s28, s28, 0x3800000
s_xor_b32 s30, s28, 0x4000
s_add_u32 s101, s101, 0x2000
s_nop 0
buffer_load_dwordx4 a[112:115], v3, s[88:91], s101 offen sc1
buffer_load_dwordx4 a[116:119], v3, s[88:91], s101 offen offset:1024 sc1
s_add_u32 s101, s101, 0x2000
s_nop 0
buffer_load_dwordx4 a[120:123], v3, s[88:91], s101 offen sc1
buffer_load_dwordx4 a[124:127], v3, s[88:91], s101 offen offset:1024 sc1
v_mfma_f32_16x16x32_bf16 v[120:123], v[152:155], a[80:83], v[120:123]
ds_read_b64_tr_b16 v[184:185], v6 offset:512
v_sub_f32 v10, 1.0, v8
v_mfma_f32_16x16x32_bf16 v[120:123], v[156:159], a[88:91], v[120:123]
ds_read_b64_tr_b16 v[186:187], v6 offset:4608
v_sub_f32 v11, 1.0, v9
v_mfma_f32_16x16x32_bf16 v[136:139], v[156:159], a[92:95], v[136:139]
ds_read_b64_tr_b16 v[188:189], v6 offset:8704
v_mul_f32 v56, v10, v56
v_mfma_f32_16x16x32_bf16 v[136:139], v[152:155], a[84:87], v[136:139]
ds_read_b64_tr_b16 v[190:191], v6 offset:12800
v_mul_f32 v57, v10, v57
v_mfma_f32_16x16x32_bf16 v[140:143], v[160:163], a[84:87], v[140:143]
ds_read_b64_tr_b16 v[192:193], v7 offset:512
v_mul_f32 v58, v10, v58
v_mfma_f32_16x16x32_bf16 v[140:143], v[164:167], a[92:95], v[140:143]
ds_read_b64_tr_b16 v[194:195], v7 offset:4608
v_mul_f32 v59, v10, v59
v_mfma_f32_16x16x32_bf16 v[124:127], v[164:167], a[88:91], v[124:127]
ds_read_b64_tr_b16 v[196:197], v7 offset:8704
s_waitcnt lgkmcnt(7)
v_mfma_f32_16x16x32_bf16 v[124:127], v[160:163], a[80:83], v[124:127]
ds_read_b64_tr_b16 v[198:199], v7 offset:12800
v_mul_f32 v60, v10, v60
v_mfma_f32_16x16x32_bf16 v[128:131], v[168:171], a[80:83], v[128:131]
ds_read_b64_tr_b16 v[200:201], v6 offset:768
v_mul_f32 v61, v10, v61
v_mfma_f32_16x16x32_bf16 v[128:131], v[172:175], a[88:91], v[128:131]
ds_read_b64_tr_b16 v[202:203], v6 offset:4864
v_mul_f32 v62, v10, v62
v_mfma_f32_16x16x32_bf16 v[144:147], v[172:175], a[92:95], v[144:147]
ds_read_b64_tr_b16 v[204:205], v6 offset:8960
v_mul_f32 v63, v10, v63
v_mfma_f32_16x16x32_bf16 v[144:147], v[168:171], a[84:87], v[144:147]
ds_read_b64_tr_b16 v[206:207], v6 offset:13056
v_mul_f32 v64, v10, v64
v_mfma_f32_16x16x32_bf16 v[148:151], v[176:179], a[84:87], v[148:151]
ds_read_b64_tr_b16 v[208:209], v7 offset:768
v_mul_f32 v65, v10, v65
v_mfma_f32_16x16x32_bf16 v[148:151], v[180:183], a[92:95], v[148:151]
ds_read_b64_tr_b16 v[210:211], v7 offset:4864
s_waitcnt vmcnt(0) lgkmcnt(6)
v_mfma_f32_16x16x32_bf16 v[132:135], v[180:183], a[88:91], v[132:135]
ds_read_b64_tr_b16 v[212:213], v7 offset:8960
s_barrier
v_mfma_f32_16x16x32_bf16 v[132:135], v[176:179], a[80:83], v[132:135]
ds_read_b64_tr_b16 v[214:215], v7 offset:13056
v_mul_f32 v66, v10, v66
v_mul_f32 v67, v10, v67
v_mfma_f32_16x16x32_bf16 v[120:123], v[184:187], a[96:99], v[120:123]
ds_read_b64_tr_b16 v[152:153], v6 offset:16896
v_mul_f32 v68, v10, v68
v_mfma_f32_16x16x32_bf16 v[120:123], v[188:191], a[104:107], v[120:123]
ds_read_b64_tr_b16 v[154:155], v6 offset:20992
v_mul_f32 v69, v10, v69
v_mfma_f32_16x16x32_bf16 v[136:139], v[188:191], a[108:111], v[136:139]
ds_read_b64_tr_b16 v[156:157], v6 offset:25088
v_mul_f32 v70, v10, v70
v_mfma_f32_16x16x32_bf16 v[136:139], v[184:187], a[100:103], v[136:139]
ds_read_b64_tr_b16 v[158:159], v6 offset:29184
v_mul_f32 v71, v10, v71
v_mfma_f32_16x16x32_bf16 v[140:143], v[192:195], a[100:103], v[140:143]
ds_read_b64_tr_b16 v[160:161], v7 offset:16896
v_mul_f32 v72, v11, v72
v_mfma_f32_16x16x32_bf16 v[140:143], v[196:199], a[108:111], v[140:143]
ds_read_b64_tr_b16 v[162:163], v7 offset:20992
v_mul_f32 v73, v11, v73
v_mfma_f32_16x16x32_bf16 v[124:127], v[196:199], a[104:107], v[124:127]
ds_read_b64_tr_b16 v[164:165], v7 offset:25088
s_waitcnt lgkmcnt(7)
v_mfma_f32_16x16x32_bf16 v[124:127], v[192:195], a[96:99], v[124:127]
ds_read_b64_tr_b16 v[166:167], v7 offset:29184
v_mul_f32 v74, v11, v74
v_mfma_f32_16x16x32_bf16 v[128:131], v[200:203], a[96:99], v[128:131]
ds_read_b64_tr_b16 v[168:169], v6 offset:17152
v_mul_f32 v75, v11, v75
v_mfma_f32_16x16x32_bf16 v[128:131], v[204:207], a[104:107], v[128:131]
ds_read_b64_tr_b16 v[170:171], v6 offset:21248
v_mul_f32 v76, v11, v76
v_mfma_f32_16x16x32_bf16 v[144:147], v[204:207], a[108:111], v[144:147]
ds_read_b64_tr_b16 v[172:173], v6 offset:25344
v_mul_f32 v77, v11, v77
v_mfma_f32_16x16x32_bf16 v[144:147], v[200:203], a[100:103], v[144:147]
ds_read_b64_tr_b16 v[174:175], v6 offset:29440
v_mul_f32 v78, v11, v78
v_mfma_f32_16x16x32_bf16 v[148:151], v[208:211], a[100:103], v[148:151]
ds_read_b64_tr_b16 v[176:177], v7 offset:17152
v_mul_f32 v79, v11, v79
v_mfma_f32_16x16x32_bf16 v[148:151], v[212:215], a[108:111], v[148:151]
ds_read_b64_tr_b16 v[178:179], v7 offset:21248
s_waitcnt lgkmcnt(6)
v_mfma_f32_16x16x32_bf16 v[132:135], v[212:215], a[104:107], v[132:135]
ds_read_b64_tr_b16 v[180:181], v7 offset:25344
v_mul_f32 v80, v11, v80
v_mfma_f32_16x16x32_bf16 v[132:135], v[208:211], a[96:99], v[132:135]
ds_read_b64_tr_b16 v[182:183], v7 offset:29440
v_mul_f32 v81, v11, v81
v_mfma_f32_16x16x32_bf16 v[120:123], v[152:155], a[112:115], v[120:123]
ds_read_b64_tr_b16 v[184:185], v4 offset:16384
v_mul_f32 v82, v11, v82
v_mfma_f32_16x16x32_bf16 v[120:123], v[156:159], a[120:123], v[120:123]
ds_read_b64_tr_b16 v[186:187], v4 offset:20480
v_mul_f32 v83, v11, v83
v_mfma_f32_16x16x32_bf16 v[136:139], v[156:159], a[124:127], v[136:139]
ds_read_b64_tr_b16 v[188:189], v4 offset:24576
v_mul_f32 v84, v11, v84
v_mfma_f32_16x16x32_bf16 v[136:139], v[152:155], a[116:119], v[136:139]
ds_read_b64_tr_b16 v[190:191], v4 offset:28672
v_mul_f32 v85, v11, v85
v_mfma_f32_16x16x32_bf16 v[140:143], v[160:163], a[116:119], v[140:143]
ds_read_b64_tr_b16 v[192:193], v5 offset:16384
v_mul_f32 v86, v11, v86
v_mfma_f32_16x16x32_bf16 v[140:143], v[164:167], a[124:127], v[140:143]
ds_read_b64_tr_b16 v[194:195], v5 offset:20480
v_mul_f32 v87, v11, v87
v_mfma_f32_16x16x32_bf16 v[124:127], v[164:167], a[120:123], v[124:127]
ds_read_b64_tr_b16 v[196:197], v5 offset:24576
s_waitcnt lgkmcnt(7)
v_mfma_f32_16x16x32_bf16 v[124:127], v[160:163], a[112:115], v[124:127]
ds_read_b64_tr_b16 v[198:199], v5 offset:28672
v_mul_f32 v24, v10, v24
v_mfma_f32_16x16x32_bf16 v[128:131], v[168:171], a[112:115], v[128:131]
ds_read_b64_tr_b16 v[200:201], v4 offset:16640
v_mul_f32 v25, v10, v25
v_mfma_f32_16x16x32_bf16 v[128:131], v[172:175], a[120:123], v[128:131]
ds_read_b64_tr_b16 v[202:203], v4 offset:20736
v_mul_f32 v26, v10, v26
v_mfma_f32_16x16x32_bf16 v[144:147], v[172:175], a[124:127], v[144:147]
ds_read_b64_tr_b16 v[204:205], v4 offset:24832
v_mul_f32 v27, v10, v27
v_mfma_f32_16x16x32_bf16 v[144:147], v[168:171], a[116:119], v[144:147]
ds_read_b64_tr_b16 v[206:207], v4 offset:28928
v_mul_f32 v28, v10, v28
v_mfma_f32_16x16x32_bf16 v[148:151], v[176:179], a[116:119], v[148:151]
ds_read_b64_tr_b16 v[208:209], v5 offset:16640
v_mul_f32 v29, v10, v29
v_mfma_f32_16x16x32_bf16 v[148:151], v[180:183], a[124:127], v[148:151]
ds_read_b64_tr_b16 v[210:211], v5 offset:20736
s_waitcnt lgkmcnt(6)
v_mfma_f32_16x16x32_bf16 v[132:135], v[180:183], a[120:123], v[132:135]
ds_read_b64_tr_b16 v[212:213], v5 offset:24832
v_mul_f32 v30, v10, v30
v_mfma_f32_16x16x32_bf16 v[132:135], v[176:179], a[112:115], v[132:135]
ds_read_b64_tr_b16 v[214:215], v5 offset:28928
v_mul_f32 v31, v10, v31
v_mfma_f32_16x16x32_bf16 v[88:91], v[184:187], a[80:83], v[88:91]
ds_read_b64_tr_b16 v[152:153], v6 offset:0
v_mfma_f32_16x16x32_bf16 v[88:91], v[188:191], a[88:91], v[88:91]
ds_read_b64_tr_b16 v[154:155], v6 offset:4096
v_mfma_f32_16x16x32_bf16 v[104:107], v[188:191], a[92:95], v[104:107]
ds_read_b64_tr_b16 v[156:157], v6 offset:8192
v_mfma_f32_16x16x32_bf16 v[104:107], v[184:187], a[84:87], v[104:107]
ds_read_b64_tr_b16 v[158:159], v6 offset:12288
v_fmac_f32 v56, v8, v120
v_fmac_f32 v57, v8, v121
v_fmac_f32 v58, v8, v122
v_fmac_f32 v59, v8, v123
v_mfma_f32_16x16x32_bf16 v[108:111], v[192:195], a[84:87], v[108:111]
ds_read_b64_tr_b16 v[160:161], v7 offset:0
v_fmac_f32 v60, v8, v124
v_fmac_f32 v61, v8, v125
v_fmac_f32 v62, v8, v126
v_fmac_f32 v63, v8, v127
v_mfma_f32_16x16x32_bf16 v[108:111], v[196:199], a[92:95], v[108:111]
ds_read_b64_tr_b16 v[162:163], v7 offset:4096
v_cvt_pk_bf16_f32 v56, v56, v57
v_cvt_pk_bf16_f32 v57, v58, v59
v_cvt_pk_bf16_f32 v58, v60, v61
v_cvt_pk_bf16_f32 v59, v62, v63
v_mfma_f32_16x16x32_bf16 v[92:95], v[196:199], a[88:91], v[92:95]
ds_read_b64_tr_b16 v[164:165], v7 offset:8192
s_waitcnt lgkmcnt(7)
buffer_store_dwordx4 v[56:59], v3, s[88:91], s30 offen offset:0 sc1
v_fmac_f32 v64, v8, v128
v_fmac_f32 v65, v8, v129
v_fmac_f32 v66, v8, v130
v_mfma_f32_16x16x32_bf16 v[92:95], v[192:195], a[80:83], v[92:95]
ds_read_b64_tr_b16 v[166:167], v7 offset:12288
v_fmac_f32 v67, v8, v131
v_fmac_f32 v68, v8, v132
v_fmac_f32 v69, v8, v133
v_fmac_f32 v70, v8, v134
v_mfma_f32_16x16x32_bf16 v[96:99], v[200:203], a[80:83], v[96:99]
ds_read_b64_tr_b16 v[168:169], v6 offset:256
v_fmac_f32 v71, v8, v135
v_cvt_pk_bf16_f32 v64, v64, v65
v_cvt_pk_bf16_f32 v65, v66, v67
v_cvt_pk_bf16_f32 v66, v68, v69
v_mfma_f32_16x16x32_bf16 v[96:99], v[204:207], a[88:91], v[96:99]
ds_read_b64_tr_b16 v[170:171], v6 offset:4352
v_cvt_pk_bf16_f32 v67, v70, v71
buffer_store_dwordx4 v[64:67], v3, s[88:91], s30 offen offset:1024 sc1
v_fmac_f32 v72, v9, v136
v_fmac_f32 v73, v9, v137
v_mfma_f32_16x16x32_bf16 v[112:115], v[204:207], a[92:95], v[112:115]
ds_read_b64_tr_b16 v[172:173], v6 offset:8448
v_fmac_f32 v74, v9, v138
v_fmac_f32 v75, v9, v139
v_fmac_f32 v76, v9, v140
v_fmac_f32 v77, v9, v141
v_mfma_f32_16x16x32_bf16 v[112:115], v[200:203], a[84:87], v[112:115]
ds_read_b64_tr_b16 v[174:175], v6 offset:12544
v_fmac_f32 v78, v9, v142
v_fmac_f32 v79, v9, v143
v_cvt_pk_bf16_f32 v72, v72, v73
v_cvt_pk_bf16_f32 v73, v74, v75
v_mfma_f32_16x16x32_bf16 v[116:119], v[208:211], a[84:87], v[116:119]
ds_read_b64_tr_b16 v[176:177], v7 offset:256
v_cvt_pk_bf16_f32 v74, v76, v77
v_cvt_pk_bf16_f32 v75, v78, v79
buffer_store_dwordx4 v[72:75], v3, s[88:91], s30 offen offset:2048 sc1
v_fmac_f32 v80, v9, v144
v_mfma_f32_16x16x32_bf16 v[116:119], v[212:215], a[92:95], v[116:119]
ds_read_b64_tr_b16 v[178:179], v7 offset:4352
s_waitcnt lgkmcnt(6)
v_fmac_f32 v81, v9, v145
v_fmac_f32 v82, v9, v146
v_fmac_f32 v83, v9, v147
v_fmac_f32 v84, v9, v148
v_mfma_f32_16x16x32_bf16 v[100:103], v[212:215], a[88:91], v[100:103]
ds_read_b64_tr_b16 v[180:181], v7 offset:8448
v_fmac_f32 v85, v9, v149
v_fmac_f32 v86, v9, v150
v_fmac_f32 v87, v9, v151
v_cvt_pk_bf16_f32 v80, v80, v81
v_mfma_f32_16x16x32_bf16 v[100:103], v[208:211], a[80:83], v[100:103]
ds_read_b64_tr_b16 v[182:183], v7 offset:12544
v_cvt_pk_bf16_f32 v81, v82, v83
v_cvt_pk_bf16_f32 v82, v84, v85
v_cvt_pk_bf16_f32 v83, v86, v87
buffer_store_dwordx4 v[80:83], v3, s[88:91], s30 offen offset:3072 sc1
v_mfma_f32_16x16x32_bf16 v[88:91], v[152:155], a[96:99], v[88:91]
ds_read_b64_tr_b16 v[184:185], v6 offset:16384
v_mul_f32 v32, v10, v32
v_mfma_f32_16x16x32_bf16 v[88:91], v[156:159], a[104:107], v[88:91]
ds_read_b64_tr_b16 v[186:187], v6 offset:20480
v_mul_f32 v33, v10, v33
v_mfma_f32_16x16x32_bf16 v[104:107], v[156:159], a[108:111], v[104:107]
ds_read_b64_tr_b16 v[188:189], v6 offset:24576
v_mul_f32 v34, v10, v34
v_mfma_f32_16x16x32_bf16 v[104:107], v[152:155], a[100:103], v[104:107]
ds_read_b64_tr_b16 v[190:191], v6 offset:28672
v_mul_f32 v35, v10, v35
v_mfma_f32_16x16x32_bf16 v[108:111], v[160:163], a[100:103], v[108:111]
ds_read_b64_tr_b16 v[192:193], v7 offset:16384
v_mul_f32 v36, v10, v36
v_mfma_f32_16x16x32_bf16 v[108:111], v[164:167], a[108:111], v[108:111]
ds_read_b64_tr_b16 v[194:195], v7 offset:20480
v_mul_f32 v37, v10, v37
v_mfma_f32_16x16x32_bf16 v[92:95], v[164:167], a[104:107], v[92:95]
ds_read_b64_tr_b16 v[196:197], v7 offset:24576
s_waitcnt lgkmcnt(7)
v_mfma_f32_16x16x32_bf16 v[92:95], v[160:163], a[96:99], v[92:95]
ds_read_b64_tr_b16 v[198:199], v7 offset:28672
v_mul_f32 v38, v10, v38
v_mfma_f32_16x16x32_bf16 v[96:99], v[168:171], a[96:99], v[96:99]
ds_read_b64_tr_b16 v[200:201], v6 offset:16640
v_mul_f32 v39, v10, v39
v_mfma_f32_16x16x32_bf16 v[96:99], v[172:175], a[104:107], v[96:99]
ds_read_b64_tr_b16 v[202:203], v6 offset:20736
v_mul_f32 v40, v11, v40
v_mfma_f32_16x16x32_bf16 v[112:115], v[172:175], a[108:111], v[112:115]
ds_read_b64_tr_b16 v[204:205], v6 offset:24832
v_mul_f32 v41, v11, v41
v_mfma_f32_16x16x32_bf16 v[112:115], v[168:171], a[100:103], v[112:115]
ds_read_b64_tr_b16 v[206:207], v6 offset:28928
v_mul_f32 v42, v11, v42
v_mfma_f32_16x16x32_bf16 v[116:119], v[176:179], a[100:103], v[116:119]
ds_read_b64_tr_b16 v[208:209], v7 offset:16640
v_mul_f32 v43, v11, v43
v_mfma_f32_16x16x32_bf16 v[116:119], v[180:183], a[108:111], v[116:119]
ds_read_b64_tr_b16 v[210:211], v7 offset:20736
s_waitcnt lgkmcnt(6)
v_mfma_f32_16x16x32_bf16 v[100:103], v[180:183], a[104:107], v[100:103]
ds_read_b64_tr_b16 v[212:213], v7 offset:24832
v_mul_f32 v44, v11, v44
v_mfma_f32_16x16x32_bf16 v[100:103], v[176:179], a[96:99], v[100:103]
ds_read_b64_tr_b16 v[214:215], v7 offset:28928
v_mul_f32 v45, v11, v45
v_mfma_f32_16x16x32_bf16 v[88:91], v[184:187], a[112:115], v[88:91]
v_mul_f32 v46, v11, v46
v_mul_f32 v47, v11, v47
v_mfma_f32_16x16x32_bf16 v[88:91], v[188:191], a[120:123], v[88:91]
v_mul_f32 v48, v11, v48
v_mul_f32 v49, v11, v49
v_mfma_f32_16x16x32_bf16 v[104:107], v[188:191], a[124:127], v[104:107]
v_mul_f32 v50, v11, v50
v_mul_f32 v51, v11, v51
v_mfma_f32_16x16x32_bf16 v[104:107], v[184:187], a[116:119], v[104:107]
v_mul_f32 v52, v11, v52
v_mul_f32 v53, v11, v53
v_mfma_f32_16x16x32_bf16 v[108:111], v[192:195], a[116:119], v[108:111]
v_mul_f32 v54, v11, v54
v_mul_f32 v55, v11, v55
v_mfma_f32_16x16x32_bf16 v[108:111], v[196:199], a[124:127], v[108:111]
v_mfma_f32_16x16x32_bf16 v[92:95], v[196:199], a[120:123], v[92:95]
s_waitcnt lgkmcnt(0)
v_mfma_f32_16x16x32_bf16 v[92:95], v[192:195], a[112:115], v[92:95]
v_mfma_f32_16x16x32_bf16 v[96:99], v[200:203], a[112:115], v[96:99]
v_mfma_f32_16x16x32_bf16 v[96:99], v[204:207], a[120:123], v[96:99]
v_mfma_f32_16x16x32_bf16 v[112:115], v[204:207], a[124:127], v[112:115]
v_mfma_f32_16x16x32_bf16 v[112:115], v[200:203], a[116:119], v[112:115]
v_mfma_f32_16x16x32_bf16 v[116:119], v[208:211], a[116:119], v[116:119]
v_mfma_f32_16x16x32_bf16 v[116:119], v[212:215], a[124:127], v[116:119]
v_mfma_f32_16x16x32_bf16 v[100:103], v[212:215], a[120:123], v[100:103]
v_mfma_f32_16x16x32_bf16 v[100:103], v[208:211], a[112:115], v[100:103]
buffer_load_dwordx4 v[152:155], v3, s[88:91], s28 offen offset:0 sc1
buffer_load_dwordx4 v[156:159], v3, s[88:91], s28 offen offset:1024 sc1
buffer_load_dwordx4 v[160:163], v3, s[88:91], s28 offen offset:2048 sc1
buffer_load_dwordx4 v[164:167], v3, s[88:91], s28 offen offset:3072 sc1
v_fmac_f32 v24, v8, v88
v_fmac_f32 v25, v8, v89
v_fmac_f32 v26, v8, v90
v_fmac_f32 v27, v8, v91
v_fmac_f32 v28, v8, v92
v_fmac_f32 v29, v8, v93
v_fmac_f32 v30, v8, v94
v_fmac_f32 v31, v8, v95
v_fmac_f32 v32, v8, v96
v_fmac_f32 v33, v8, v97
v_fmac_f32 v34, v8, v98
v_fmac_f32 v35, v8, v99
v_fmac_f32 v36, v8, v100
v_fmac_f32 v37, v8, v101
v_fmac_f32 v38, v8, v102
v_fmac_f32 v39, v8, v103
v_fmac_f32 v40, v9, v104
v_fmac_f32 v41, v9, v105
v_fmac_f32 v42, v9, v106
v_fmac_f32 v43, v9, v107
v_fmac_f32 v44, v9, v108
v_fmac_f32 v45, v9, v109
v_fmac_f32 v46, v9, v110
v_fmac_f32 v47, v9, v111
v_fmac_f32 v48, v9, v112
v_fmac_f32 v49, v9, v113
v_fmac_f32 v50, v9, v114
v_fmac_f32 v51, v9, v115
v_fmac_f32 v52, v9, v116
v_fmac_f32 v53, v9, v117
v_fmac_f32 v54, v9, v118
v_fmac_f32 v55, v9, v119
s_mov_b32 s92, 200000
L_spin_x:
s_waitcnt vmcnt(0)
v_max3_u32 v168, v152, v153, 0
v_max3_u32 v168, v154, v155, v168
v_max3_u32 v168, v156, v157, v168
v_max3_u32 v168, v158, v159, v168
v_max3_u32 v168, v160, v161, v168
v_max3_u32 v168, v162, v163, v168
v_max3_u32 v168, v164, v165, v168
v_max3_u32 v168, v166, v167, v168
v_cmp_eq_u32 vcc, -1, v168
s_sub_u32 s92, s92, 1
s_cbranch_scc1 L_spun_x
s_nop 3
s_cbranch_vccz L_spun_x
s_sleep 2
buffer_load_dwordx4 v[152:155], v3, s[88:91], s28 offen offset:0 sc1
buffer_load_dwordx4 v[156:159], v3, s[88:91], s28 offen offset:1024 sc1
buffer_load_dwordx4 v[160:163], v3, s[88:91], s28 offen offset:2048 sc1
buffer_load_dwordx4 v[164:167], v3, s[88:91], s28 offen offset:3072 sc1
s_branch L_spin_x
L_spun_x:
v_lshlrev_b32 v168, 16, v152
v_and_b32 v169, 0xffff0000, v152
v_pk_add_f32 v[24:25], v[24:25], v[168:169]
v_lshlrev_b32 v168, 16, v153
v_and_b32 v169, 0xffff0000, v153
v_pk_add_f32 v[26:27], v[26:27], v[168:169]
v_lshlrev_b32 v168, 16, v154
v_and_b32 v169, 0xffff0000, v154
v_pk_add_f32 v[28:29], v[28:29], v[168:169]
v_lshlrev_b32 v168, 16, v155
v_and_b32 v169, 0xffff0000, v155
v_pk_add_f32 v[30:31], v[30:31], v[168:169]
v_cvt_pk_bf16_f32 v24, v24, v25
v_cvt_pk_bf16_f32 v25, v26, v27
v_cvt_pk_bf16_f32 v26, v28, v29
v_cvt_pk_bf16_f32 v27, v30, v31
s_nop 1
v_permlane16_swap_b32 v24, v26
v_permlane16_swap_b32 v25, v27
buffer_store_dwordx4 v[24:27], v17, s[80:83], s8 offen offset:0
v_lshlrev_b32 v168, 16, v156
v_and_b32 v169, 0xffff0000, v156
v_pk_add_f32 v[32:33], v[32:33], v[168:169]
v_lshlrev_b32 v168, 16, v157
v_and_b32 v169, 0xffff0000, v157
v_pk_add_f32 v[34:35], v[34:35], v[168:169]
v_lshlrev_b32 v168, 16, v158
v_and_b32 v169, 0xffff0000, v158
v_pk_add_f32 v[36:37], v[36:37], v[168:169]
v_lshlrev_b32 v168, 16, v159
v_and_b32 v169, 0xffff0000, v159
v_pk_add_f32 v[38:39], v[38:39], v[168:169]
v_cvt_pk_bf16_f32 v32, v32, v33
v_cvt_pk_bf16_f32 v33, v34, v35
v_cvt_pk_bf16_f32 v34, v36, v37
v_cvt_pk_bf16_f32 v35, v38, v39
s_nop 1
v_permlane16_swap_b32 v32, v34
v_permlane16_swap_b32 v33, v35
buffer_store_dwordx4 v[32:35], v17, s[80:83], s8 offen offset:64
v_lshlrev_b32 v168, 16, v160
v_and_b32 v169, 0xffff0000, v160
v_pk_add_f32 v[40:41], v[40:41], v[168:169]
v_lshlrev_b32 v168, 16, v161
v_and_b32 v169, 0xffff0000, v161
v_pk_add_f32 v[42:43], v[42:43], v[168:169]
v_lshlrev_b32 v168, 16, v162
v_and_b32 v169, 0xffff0000, v162
v_pk_add_f32 v[44:45], v[44:45], v[168:169]
v_lshlrev_b32 v168, 16, v163
v_and_b32 v169, 0xffff0000, v163
v_pk_add_f32 v[46:47], v[46:47], v[168:169]
v_cvt_pk_bf16_f32 v40, v40, v41
v_cvt_pk_bf16_f32 v41, v42, v43
v_cvt_pk_bf16_f32 v42, v44, v45
v_cvt_pk_bf16_f32 v43, v46, v47
s_nop 1
v_permlane16_swap_b32 v40, v42
v_permlane16_swap_b32 v41, v43
buffer_store_dwordx4 v[40:43], v17, s[80:83], s9 offen offset:0
v_lshlrev_b32 v168, 16, v164
v_and_b32 v169, 0xffff0000, v164
v_pk_add_f32 v[48:49], v[48:49], v[168:169]
v_lshlrev_b32 v168, 16, v165
v_and_b32 v169, 0xffff0000, v165
v_pk_add_f32 v[50:51], v[50:51], v[168:169]
v_lshlrev_b32 v168, 16, v166
v_and_b32 v169, 0xffff0000, v166
v_pk_add_f32 v[52:53], v[52:53], v[168:169]
v_lshlrev_b32 v168, 16, v167
v_and_b32 v169, 0xffff0000, v167
v_pk_add_f32 v[54:55], v[54:55], v[168:169]
v_cvt_pk_bf16_f32 v48, v48, v49
v_cvt_pk_bf16_f32 v49, v50, v51
v_cvt_pk_bf16_f32 v50, v52, v53
v_cvt_pk_bf16_f32 v51, v54, v55
s_nop 1
v_permlane16_swap_b32 v48, v50
v_permlane16_swap_b32 v49, v51
buffer_store_dwordx4 v[48:51], v17, s[80:83], s9 offen offset:64
L_end:
s_endpgm
L_att_fallback:
s_waitcnt vmcnt(0)
s_mov_b32 s33, 1
s_mul_i32 s32, s5, 0x108000
s_lshl_b32 s19, s4, 13
s_add_u32 s32, s32, s19
s_cmp_eq_u32 s4, 0
s_cselect_b32 s99, 0x200000, 0
s_add_u32 s32, s32, s99
s_sub_u32 s99, 0x8000, s99
s_add_u32 s7, s32, 0x1000
s_add_u32 s27, s19, 131072
v_and_b32 v5, 15, v0
v_lshrrev_b32 v6, 4, v0
v_lshlrev_b32 v6, 2, v6
v_sub_u32 v5, v5, v6
s_lshr_b32 s8, s20, 11
v_add_u32 v96, s8, v5
v_mov_b32 v80, v9
s_lshr_b32 s8, s21, 11
v_add_u32 v97, s8, v5
v_mov_b32 v84, v9
s_lshr_b32 s8, s22, 11
v_add_u32 v98, s8, v5
v_mov_b32 v88, v9
s_lshr_b32 s8, s23, 11
v_add_u32 v99, s8, v5
v_mov_b32 v92, v9
s_sub_u32 s15, 16, s6
s_lshl_b32 s15, s15, 1
L_fb_loop:
s_waitcnt lgkmcnt(0)
s_barrier
s_add_u32 m0, s19, 0x0
s_nop 0
buffer_load_dwordx4 v3, s[48:51], s32 offen offset:0 sc1 lds
buffer_load_dwordx4 v3, s[48:51], s32 offen offset:1024 sc1 lds
buffer_load_dwordx4 v3, s[48:51], s32 offen offset:2048 sc1 lds
buffer_load_dwordx4 v3, s[48:51], s32 offen offset:3072 sc1 lds
s_add_u32 m0, s19, 0x1000
s_nop 0
buffer_load_dwordx4 v3, s[48:51], s7 offen offset:0 sc1 lds
buffer_load_dwordx4 v3, s[48:51], s7 offen offset:1024 sc1 lds
buffer_load_dwordx4 v3, s[48:51], s7 offen offset:2048 sc1 lds
buffer_load_dwordx4 v3, s[48:51], s7 offen offset:3072 sc1 lds
s_add_u32 s32, s32, s99
s_add_u32 s7, s7, s99
s_mov_b32 s99, 0x8000
s_waitcnt vmcnt(0)
s_barrier
ds_read_b128 a[0:3], v3 offset:8192
ds_read_b128 a[4:7], v3 offset:9216
ds_read_b128 a[8:11], v3 offset:10240
ds_read_b128 a[12:15], v3 offset:11264
ds_read_b128 a[16:19], v3 offset:12288
ds_read_b128 a[20:23], v3 offset:13312
ds_read_b128 a[24:27], v3 offset:14336
ds_read_b128 a[28:31], v3 offset:15360
s_waitcnt lgkmcnt(0)
v_mfma_f32_16x16x32_bf16 v[16:19], a[0:3], a[160:163], 0
v_mfma_f32_16x16x32_bf16 v[16:19], a[4:7], a[164:167], v[16:19]
v_mfma_f32_16x16x32_bf16 v[16:19], a[8:11], a[168:171], v[16:19]
v_mfma_f32_16x16x32_bf16 v[16:19], a[12:15], a[172:175], v[16:19]
v_mfma_f32_16x16x32_bf16 v[20:23], a[0:3], a[176:179], 0
v_mfma_f32_16x16x32_bf16 v[20:23], a[4:7], a[180:183], v[20:23]
v_mfma_f32_16x16x32_bf16 v[20:23], a[8:11], a[184:187], v[20:23]
v_mfma_f32_16x16x32_bf16 v[20:23], a[12:15], a[188:191], v[20:23]
v_mfma_f32_16x16x32_bf16 v[24:27], a[0:3], a[192:195], 0
v_mfma_f32_16x16x32_bf16 v[24:27], a[4:7], a[196:199], v[24:27]
v_mfma_f32_16x16x32_bf16 v[24:27], a[8:11], a[200:203], v[24:27]
v_mfma_f32_16x16x32_bf16 v[24:27], a[12:15], a[204:207], v[24:27]
v_mfma_f32_16x16x32_bf16 v[28:31], a[0:3], a[208:211], 0
v_mfma_f32_16x16x32_bf16 v[28:31], a[4:7], a[212:215], v[28:31]
v_mfma_f32_16x16x32_bf16 v[28:31], a[8:11], a[216:219], v[28:31]
v_mfma_f32_16x16x32_bf16 v[28:31], a[12:15], a[220:223], v[28:31]
v_mfma_f32_16x16x32_bf16 v[32:35], a[16:19], a[160:163], 0
v_mfma_f32_16x16x32_bf16 v[32:35], a[20:23], a[164:167], v[32:35]
v_mfma_f32_16x16x32_bf16 v[32:35], a[24:27], a[168:171], v[32:35]
v_mfma_f32_16x16x32_bf16 v[32:35], a[28:31], a[172:175], v[32:35]
v_mfma_f32_16x16x32_bf16 v[36:39], a[16:19], a[176:179], 0
v_mfma_f32_16x16x32_bf16 v[36:39], a[20:23], a[180:183], v[36:39]
v_mfma_f32_16x16x32_bf16 v[36:39], a[24:27], a[184:187], v[36:39]
v_mfma_f32_16x16x32_bf16 v[36:39], a[28:31], a[188:191], v[36:39]
v_mfma_f32_16x16x32_bf16 v[40:43], a[16:19], a[192:195], 0
v_mfma_f32_16x16x32_bf16 v[40:43], a[20:23], a[196:199], v[40:43]
v_mfma_f32_16x16x32_bf16 v[40:43], a[24:27], a[200:203], v[40:43]
v_mfma_f32_16x16x32_bf16 v[40:43], a[28:31], a[204:207], v[40:43]
v_mfma_f32_16x16x32_bf16 v[44:47], a[16:19], a[208:211], 0
v_mfma_f32_16x16x32_bf16 v[44:47], a[20:23], a[212:215], v[44:47]
v_mfma_f32_16x16x32_bf16 v[44:47], a[24:27], a[216:219], v[44:47]
v_mfma_f32_16x16x32_bf16 v[44:47], a[28:31], a[220:223], v[44:47]
s_nop 7
v_cmp_le_i32 s[36:37], 0, v96
v_cmp_le_i32 s[38:39], 1, v96
v_cmp_le_i32 s[40:41], 2, v96
v_cmp_le_i32 s[42:43], 3, v96
s_nop 1
v_cndmask_b32 v16, v9, v16, s[36:37]
v_cndmask_b32 v17, v9, v17, s[38:39]
v_cndmask_b32 v18, v9, v18, s[40:41]
v_cndmask_b32 v19, v9, v19, s[42:43]
v_max3_f32 v80, v80, v16, v17
v_max3_f32 v80, v80, v18, v19
v_cmp_le_i32 s[36:37], 0, v97
v_cmp_le_i32 s[38:39], 1, v97
v_cmp_le_i32 s[40:41], 2, v97
v_cmp_le_i32 s[42:43], 3, v97
s_nop 1
v_cndmask_b32 v20, v9, v20, s[36:37]
v_cndmask_b32 v21, v9, v21, s[38:39]
v_cndmask_b32 v22, v9, v22, s[40:41]
v_cndmask_b32 v23, v9, v23, s[42:43]
v_max3_f32 v84, v84, v20, v21
v_max3_f32 v84, v84, v22, v23
v_cmp_le_i32 s[36:37], 0, v98
v_cmp_le_i32 s[38:39], 1, v98
v_cmp_le_i32 s[40:41], 2, v98
v_cmp_le_i32 s[42:43], 3, v98
s_nop 1
v_cndmask_b32 v24, v9, v24, s[36:37]
v_cndmask_b32 v25, v9, v25, s[38:39]
v_cndmask_b32 v26, v9, v26, s[40:41]
v_cndmask_b32 v27, v9, v27, s[42:43]
v_max3_f32 v88, v88, v24, v25
v_max3_f32 v88, v88, v26, v27
v_cmp_le_i32 s[36:37], 0, v99
v_cmp_le_i32 s[38:39], 1, v99
v_cmp_le_i32 s[40:41], 2, v99
v_cmp_le_i32 s[42:43], 3, v99
s_nop 1
v_cndmask_b32 v28, v9, v28, s[36:37]
v_cndmask_b32 v29, v9, v29, s[38:39]
v_cndmask_b32 v30, v9, v30, s[40:41]
v_cndmask_b32 v31, v9, v31, s[42:43]
v_max3_f32 v92, v92, v28, v29
v_max3_f32 v92, v92, v30, v31
v_cmp_le_i32 s[36:37], 16, v96
v_cmp_le_i32 s[38:39], 17, v96
v_cmp_le_i32 s[40:41], 18, v96
v_cmp_le_i32 s[42:43], 19, v96
s_nop 1
v_cndmask_b32 v32, v9, v32, s[36:37]
v_cndmask_b32 v33, v9, v33, s[38:39]
v_cndmask_b32 v34, v9, v34, s[40:41]
v_cndmask_b32 v35, v9, v35, s[42:43]
v_max3_f32 v80, v80, v32, v33
v_max3_f32 v80, v80, v34, v35
v_cmp_le_i32 s[36:37], 16, v97
v_cmp_le_i32 s[38:39], 17, v97
v_cmp_le_i32 s[40:41], 18, v97
v_cmp_le_i32 s[42:43], 19, v97
s_nop 1
v_cndmask_b32 v36, v9, v36, s[36:37]
v_cndmask_b32 v37, v9, v37, s[38:39]
v_cndmask_b32 v38, v9, v38, s[40:41]
v_cndmask_b32 v39, v9, v39, s[42:43]
v_max3_f32 v84, v84, v36, v37
v_max3_f32 v84, v84, v38, v39
v_cmp_le_i32 s[36:37], 16, v98
v_cmp_le_i32 s[38:39], 17, v98
v_cmp_le_i32 s[40:41], 18, v98
v_cmp_le_i32 s[42:43], 19, v98
s_nop 1
v_cndmask_b32 v40, v9, v40, s[36:37]
v_cndmask_b32 v41, v9, v41, s[38:39]
v_cndmask_b32 v42, v9, v42, s[40:41]
v_cndmask_b32 v43, v9, v43, s[42:43]
v_max3_f32 v88, v88, v40, v41
v_max3_f32 v88, v88, v42, v43
v_cmp_le_i32 s[36:37], 16, v99
v_cmp_le_i32 s[38:39], 17, v99
v_cmp_le_i32 s[40:41], 18, v99
v_cmp_le_i32 s[42:43], 19, v99
s_nop 1
v_cndmask_b32 v44, v9, v44, s[36:37]
v_cndmask_b32 v45, v9, v45, s[38:39]
v_cndmask_b32 v46, v9, v46, s[40:41]
v_cndmask_b32 v47, v9, v47, s[42:43]
v_max3_f32 v92, v92, v44, v45
v_max3_f32 v92, v92, v46, v47
ds_read_b128 a[0:3], v3 offset:24576
ds_read_b128 a[4:7], v3 offset:25600
ds_read_b128 a[8:11], v3 offset:26624
ds_read_b128 a[12:15], v3 offset:27648
ds_read_b128 a[16:19], v3 offset:28672
ds_read_b128 a[20:23], v3 offset:29696
ds_read_b128 a[24:27], v3 offset:30720
ds_read_b128 a[28:31], v3 offset:31744
s_waitcnt lgkmcnt(0)
v_mfma_f32_16x16x32_bf16 v[16:19], a[0:3], a[160:163], 0
v_mfma_f32_16x16x32_bf16 v[16:19], a[4:7], a[164:167], v[16:19]
v_mfma_f32_16x16x32_bf16 v[16:19], a[8:11], a[168:171], v[16:19]
v_mfma_f32_16x16x32_bf16 v[16:19], a[12:15], a[172:175], v[16:19]
v_mfma_f32_16x16x32_bf16 v[20:23], a[0:3], a[176:179], 0
v_mfma_f32_16x16x32_bf16 v[20:23], a[4:7], a[180:183], v[20:23]
v_mfma_f32_16x16x32_bf16 v[20:23], a[8:11], a[184:187], v[20:23]
v_mfma_f32_16x16x32_bf16 v[20:23], a[12:15], a[188:191], v[20:23]
v_mfma_f32_16x16x32_bf16 v[24:27], a[0:3], a[192:195], 0
v_mfma_f32_16x16x32_bf16 v[24:27], a[4:7], a[196:199], v[24:27]
v_mfma_f32_16x16x32_bf16 v[24:27], a[8:11], a[200:203], v[24:27]
v_mfma_f32_16x16x32_bf16 v[24:27], a[12:15], a[204:207], v[24:27]
v_mfma_f32_16x16x32_bf16 v[28:31], a[0:3], a[208:211], 0
v_mfma_f32_16x16x32_bf16 v[28:31], a[4:7], a[212:215], v[28:31]
v_mfma_f32_16x16x32_bf16 v[28:31], a[8:11], a[216:219], v[28:31]
v_mfma_f32_16x16x32_bf16 v[28:31], a[12:15], a[220:223], v[28:31]
v_mfma_f32_16x16x32_bf16 v[32:35], a[16:19], a[160:163], 0
v_mfma_f32_16x16x32_bf16 v[32:35], a[20:23], a[164:167], v[32:35]
v_mfma_f32_16x16x32_bf16 v[32:35], a[24:27], a[168:171], v[32:35]
v_mfma_f32_16x16x32_bf16 v[32:35], a[28:31], a[172:175], v[32:35]
v_mfma_f32_16x16x32_bf16 v[36:39], a[16:19], a[176:179], 0
v_mfma_f32_16x16x32_bf16 v[36:39], a[20:23], a[180:183], v[36:39]
v_mfma_f32_16x16x32_bf16 v[36:39], a[24:27], a[184:187], v[36:39]
v_mfma_f32_16x16x32_bf16 v[36:39], a[28:31], a[188:191], v[36:39]
v_mfma_f32_16x16x32_bf16 v[40:43], a[16:19], a[192:195], 0
v_mfma_f32_16x16x32_bf16 v[40:43], a[20:23], a[196:199], v[40:43]
v_mfma_f32_16x16x32_bf16 v[40:43], a[24:27], a[200:203], v[40:43]
v_mfma_f32_16x16x32_bf16 v[40:43], a[28:31], a[204:207], v[40:43]
v_mfma_f32_16x16x32_bf16 v[44:47], a[16:19], a[208:211], 0
v_mfma_f32_16x16x32_bf16 v[44:47], a[20:23], a[212:215], v[44:47]
v_mfma_f32_16x16x32_bf16 v[44:47], a[24:27], a[216:219], v[44:47]
v_mfma_f32_16x16x32_bf16 v[44:47], a[28:31], a[220:223], v[44:47]
s_nop 7
v_cmp_le_i32 s[36:37], 32, v96
v_cmp_le_i32 s[38:39], 33, v96
v_cmp_le_i32 s[40:41], 34, v96
v_cmp_le_i32 s[42:43], 35, v96
s_nop 1
v_cndmask_b32 v16, v9, v16, s[36:37]
v_cndmask_b32 v17, v9, v17, s[38:39]
v_cndmask_b32 v18, v9, v18, s[40:41]
v_cndmask_b32 v19, v9, v19, s[42:43]
v_max3_f32 v80, v80, v16, v17
v_max3_f32 v80, v80, v18, v19
v_cmp_le_i32 s[36:37], 32, v97
v_cmp_le_i32 s[38:39], 33, v97
v_cmp_le_i32 s[40:41], 34, v97
v_cmp_le_i32 s[42:43], 35, v97
s_nop 1
v_cndmask_b32 v20, v9, v20, s[36:37]
v_cndmask_b32 v21, v9, v21, s[38:39]
v_cndmask_b32 v22, v9, v22, s[40:41]
v_cndmask_b32 v23, v9, v23, s[42:43]
v_max3_f32 v84, v84, v20, v21
v_max3_f32 v84, v84, v22, v23
v_cmp_le_i32 s[36:37], 32, v98
v_cmp_le_i32 s[38:39], 33, v98
v_cmp_le_i32 s[40:41], 34, v98
v_cmp_le_i32 s[42:43], 35, v98
s_nop 1
v_cndmask_b32 v24, v9, v24, s[36:37]
v_cndmask_b32 v25, v9, v25, s[38:39]
v_cndmask_b32 v26, v9, v26, s[40:41]
v_cndmask_b32 v27, v9, v27, s[42:43]
v_max3_f32 v88, v88, v24, v25
v_max3_f32 v88, v88, v26, v27
v_cmp_le_i32 s[36:37], 32, v99
v_cmp_le_i32 s[38:39], 33, v99
v_cmp_le_i32 s[40:41], 34, v99
v_cmp_le_i32 s[42:43], 35, v99
s_nop 1
v_cndmask_b32 v28, v9, v28, s[36:37]
v_cndmask_b32 v29, v9, v29, s[38:39]
v_cndmask_b32 v30, v9, v30, s[40:41]
v_cndmask_b32 v31, v9, v31, s[42:43]
v_max3_f32 v92, v92, v28, v29
v_max3_f32 v92, v92, v30, v31
v_cmp_le_i32 s[36:37], 48, v96
v_cmp_le_i32 s[38:39], 49, v96
v_cmp_le_i32 s[40:41], 50, v96
v_cmp_le_i32 s[42:43], 51, v96
s_nop 1
v_cndmask_b32 v32, v9, v32, s[36:37]
v_cndmask_b32 v33, v9, v33, s[38:39]
v_cndmask_b32 v34, v9, v34, s[40:41]
v_cndmask_b32 v35, v9, v35, s[42:43]
v_max3_f32 v80, v80, v32, v33
v_max3_f32 v80, v80, v34, v35
v_cmp_le_i32 s[36:37], 48, v97
v_cmp_le_i32 s[38:39], 49, v97
v_cmp_le_i32 s[40:41], 50, v97
v_cmp_le_i32 s[42:43], 51, v97
s_nop 1
v_cndmask_b32 v36, v9, v36, s[36:37]
v_cndmask_b32 v37, v9, v37, s[38:39]
v_cndmask_b32 v38, v9, v38, s[40:41]
v_cndmask_b32 v39, v9, v39, s[42:43]
v_max3_f32 v84, v84, v36, v37
v_max3_f32 v84, v84, v38, v39
v_cmp_le_i32 s[36:37], 48, v98
v_cmp_le_i32 s[38:39], 49, v98
v_cmp_le_i32 s[40:41], 50, v98
v_cmp_le_i32 s[42:43], 51, v98
s_nop 1
v_cndmask_b32 v40, v9, v40, s[36:37]
v_cndmask_b32 v41, v9, v41, s[38:39]
v_cndmask_b32 v42, v9, v42, s[40:41]
v_cndmask_b32 v43, v9, v43, s[42:43]
v_max3_f32 v88, v88, v40, v41
v_max3_f32 v88, v88, v42, v43
v_cmp_le_i32 s[36:37], 48, v99
v_cmp_le_i32 s[38:39], 49, v99
v_cmp_le_i32 s[40:41], 50, v99
v_cmp_le_i32 s[42:43], 51, v99
s_nop 1
v_cndmask_b32 v44, v9, v44, s[36:37]
v_cndmask_b32 v45, v9, v45, s[38:39]
v_cndmask_b32 v46, v9, v46, s[40:41]
v_cndmask_b32 v47, v9, v47, s[42:43]
v_max3_f32 v92, v92, v44, v45
v_max3_f32 v92, v92, v46, v47
v_subrev_u32 v96, 64, v96
v_subrev_u32 v97, 64, v97
v_subrev_u32 v98, 64, v98
v_subrev_u32 v99, 64, v99
s_sub_u32 s15, s15, 1
s_cmp_lg_u32 s15, 0
s_cbranch_scc1 L_fb_loop
v_mov_b32 v16, v80
v_mov_b32 v20, v84
v_mov_b32 v24, v88
v_mov_b32 v28, v92
v_permlane16_swap_b32 v16, v80
v_permlane16_swap_b32 v20, v84
v_permlane16_swap_b32 v24, v88
v_permlane16_swap_b32 v28, v92
v_max_f32 v80, v80, v16
v_max_f32 v84, v84, v20
v_max_f32 v88, v88, v24
v_max_f32 v92, v92, v28
v_mov_b32 v16, v80
v_mov_b32 v20, v84
v_mov_b32 v24, v88
v_mov_b32 v28, v92
v_permlane32_swap_b32 v16, v80
v_permlane32_swap_b32 v20, v84
v_permlane32_swap_b32 v24, v88
v_permlane32_swap_b32 v28, v92
v_max_f32 v80, v80, v16
v_max_f32 v84, v84, v20
v_max_f32 v88, v88, v24
v_max_f32 v92, v92, v28
s_barrier
s_mul_i32 s32, s5, 0x108000
s_lshl_b32 s19, s4, 13
s_add_u32 s32, s32, s19
s_cmp_eq_u32 s4, 0
s_cselect_b32 s99, 0x200000, 0
s_add_u32 s32, s32, s99
s_sub_u32 s99, 0x8000, s99
s_add_u32 s7, s32, 0x1000
s_add_u32 s27, s19, 131072
s_add_u32 m0, s19, 0x0
s_nop 0
buffer_load_dwordx4 v3, s[48:51], s32 offen offset:0 sc1 lds
buffer_load_dwordx4 v3, s[48:51], s32 offen offset:1024 sc1 lds
buffer_load_dwordx4 v3, s[48:51], s32 offen offset:2048 sc1 lds
buffer_load_dwordx4 v3, s[48:51], s32 offen offset:3072 sc1 lds
s_add_u32 m0, s19, 0x1000
s_nop 0
buffer_load_dwordx4 v3, s[48:51], s7 offen offset:0 sc1 lds
buffer_load_dwordx4 v3, s[48:51], s7 offen offset:1024 sc1 lds
buffer_load_dwordx4 v3, s[48:51], s7 offen offset:2048 sc1 lds
buffer_load_dwordx4 v3, s[48:51], s7 offen offset:3072 sc1 lds
s_add_u32 s32, s32, s99
s_add_u32 s7, s7, s99
s_add_u32 m0, s19, 0x18000
s_nop 0
buffer_load_dwordx4 v3, s[48:51], s32 offen offset:0 sc1 lds
buffer_load_dwordx4 v3, s[48:51], s32 offen offset:1024 sc1 lds
buffer_load_dwordx4 v3, s[48:51], s32 offen offset:2048 sc1 lds
buffer_load_dwordx4 v3, s[48:51], s32 offen offset:3072 sc1 lds
s_add_u32 m0, s19, 0x19000
s_nop 0
buffer_load_dwordx4 v3, s[48:51], s7 offen offset:0 sc1 lds
buffer_load_dwordx4 v3, s[48:51], s7 offen offset:1024 sc1 lds
buffer_load_dwordx4 v3, s[48:51], s7 offen offset:2048 sc1 lds
buffer_load_dwordx4 v3, s[48:51], s7 offen offset:3072 sc1 lds
s_add_u32 s32, s32, 0x8000
s_add_u32 s7, s7, 0x8000
s_add_u32 m0, s19, 0x8000
s_nop 0
buffer_load_dwordx4 v3, s[48:51], s32 offen offset:0 sc1 lds
buffer_load_dwordx4 v3, s[48:51], s32 offen offset:1024 sc1 lds
buffer_load_dwordx4 v3, s[48:51], s32 offen offset:2048 sc1 lds
buffer_load_dwordx4 v3, s[48:51], s32 offen offset:3072 sc1 lds
s_add_u32 m0, s19, 0x9000
s_nop 0
buffer_load_dwordx4 v3, s[48:51], s7 offen offset:0 sc1 lds
buffer_load_dwordx4 v3, s[48:51], s7 offen offset:1024 sc1 lds
buffer_load_dwordx4 v3, s[48:51], s7 offen offset:2048 sc1 lds
buffer_load_dwordx4 v3, s[48:51], s7 offen offset:3072 sc1 lds
s_add_u32 s32, s32, 0x8000
s_add_u32 s7, s7, 0x8000
s_bfe_u32 s99, s2, 0x20001
s_lshl_b32 s99, s99, 2
s_lshr_b32 s8, s2, 6
s_add_u32 s99, s99, s8
s_bfe_u32 s100, s2, 0x30003
s_and_b32 s14, s2, 1
s_sub_u32 s24, 15, s99
s_min_u32 s18, s24, s99
s_lshl_b32 s24, s18, 1
s_add_u32 s24, s24, s14
s_lshl_b32 s24, s24, 6
s_add_u32 s24, s24, 0x3604000
s_mov_b32 s12, 14336
s_and_b32 s16, s6, 1
s_lshl_b32 s16, s16, 15
s_add_u32 s16, s16, 98304
s_add_u32 s16, s16, s17
s_lshl_b32 s13, s4, 15
s_lshl_b32 s9, s100, 8
s_add_u32 s13, s13, s9
s_mul_i32 s9, s14, 0x100080
s_add_u32 s13, s13, s9
s_mul_i32 s25, s14, 0x300000
s_sub_u32 s25, s25, 917504
s_mul_i32 s101, s99, 0x140000
s_lshl_b32 s8, s4, 11
s_add_u32 s101, s101, s8
s_lshl_b32 s8, s14, 17
s_add_u32 s101, s101, s8
s_add_u32 s101, s101, 0x21fe000
s_mul_i32 s26, s14, 393216
s_add_u32 s26, s26, 139264
v_mov_b32 v15, s6
v_writelane_b32 v15, s18, 0
v_lshlrev_b32 v15, 2, v15
v_bfe_u32 v12, v0, 2, 2
v_lshlrev_b32 v12, 11, v12
v_lshrrev_b32 v13, 4, v0
v_lshl_add_u32 v12, v13, 6, v12
v_and_b32 v13, 3, v0
v_lshl_add_u32 v12, v13, 4, v12
v_xor_b32 v12, s13, v12
v_xor_b32 v13, 32, v12
v_add_u32 v13, 7168, v13
s_mov_b32 s11, 0xf149f2ca
s_mov_b32 s36, 0xfff0ffff
s_mov_b32 s37, 0xf000ff00
s_mov_b32 s38, 0xffe0fffe
s_mov_b32 s39, 0xe000fe00
s_mov_b32 s40, 0xffc0fffc
s_mov_b32 s41, 0xc000fc00
s_mov_b32 s42, 0xff80fff8
s_mov_b32 s43, 0x8000f800
s_bitcmp1_b32 s4, 0
s_cselect_b32 s8, 0x7f800000, s11
s_cselect_b32 s9, s11, 0x7f800000
v_mov_b32 v1, v3
v_add_u32 v2, 98304, v3
s_mov_b64 s[34:35], 0
v_accvgpr_write_b32 a224, 0
v_accvgpr_write_b32 a225, 0
v_accvgpr_write_b32 a226, 0
v_accvgpr_write_b32 a227, 0
v_accvgpr_write_b32 a228, 0
v_accvgpr_write_b32 a229, 0
v_accvgpr_write_b32 a230, 0
v_accvgpr_write_b32 a231, 0
v_accvgpr_write_b32 a232, 0
v_accvgpr_write_b32 a233, 0
v_accvgpr_write_b32 a234, 0
v_accvgpr_write_b32 a235, 0
v_accvgpr_write_b32 a236, 0
v_accvgpr_write_b32 a237, 0
v_accvgpr_write_b32 a238, 0
v_accvgpr_write_b32 a239, 0
v_sub_f32 v83, 0, v80
v_sub_f32 v82, 0, v80
v_sub_f32 v81, 0, v80
v_sub_f32 v80, 0, v80
v_min_f32 v103, s8, v80
v_cndmask_b32 v96, v103, v80, s[36:37]
v_cndmask_b32 v97, v103, v80, s[38:39]
v_cndmask_b32 v98, v103, v80, s[40:41]
v_cndmask_b32 v99, v103, v80, s[42:43]
v_cndmask_b32 v100, v9, v103, s[36:37]
v_cndmask_b32 v101, v9, v103, s[38:39]
v_cndmask_b32 v102, v9, v103, s[40:41]
v_cndmask_b32 v103, v9, v103, s[42:43]
v_sub_f32 v87, 0, v84
v_sub_f32 v86, 0, v84
v_sub_f32 v85, 0, v84
v_sub_f32 v84, 0, v84
v_min_f32 v111, s9, v84
v_cndmask_b32 v104, v111, v84, s[36:37]
v_cndmask_b32 v105, v111, v84, s[38:39]
v_cndmask_b32 v106, v111, v84, s[40:41]
v_cndmask_b32 v107, v111, v84, s[42:43]
v_cndmask_b32 v108, v9, v111, s[36:37]
v_cndmask_b32 v109, v9, v111, s[38:39]
v_cndmask_b32 v110, v9, v111, s[40:41]
v_cndmask_b32 v111, v9, v111, s[42:43]
v_sub_f32 v91, 0, v88
v_sub_f32 v90, 0, v88
v_sub_f32 v89, 0, v88
v_sub_f32 v88, 0, v88
v_min_f32 v119, s8, v88
v_cndmask_b32 v112, v119, v88, s[36:37]
v_cndmask_b32 v113, v119, v88, s[38:39]
v_cndmask_b32 v114, v119, v88, s[40:41]
v_cndmask_b32 v115, v119, v88, s[42:43]
v_cndmask_b32 v116, v9, v119, s[36:37]
v_cndmask_b32 v117, v9, v119, s[38:39]
v_cndmask_b32 v118, v9, v119, s[40:41]
v_cndmask_b32 v119, v9, v119, s[42:43]
v_sub_f32 v95, 0, v92
v_sub_f32 v94, 0, v92
v_sub_f32 v93, 0, v92
v_sub_f32 v92, 0, v92
v_min_f32 v127, s9, v92
v_cndmask_b32 v120, v127, v92, s[36:37]
v_cndmask_b32 v121, v127, v92, s[38:39]
v_cndmask_b32 v122, v127, v92, s[40:41]
v_cndmask_b32 v123, v127, v92, s[42:43]
v_cndmask_b32 v124, v9, v127, s[36:37]
v_cndmask_b32 v125, v9, v127, s[38:39]
v_cndmask_b32 v126, v9, v127, s[40:41]
v_cndmask_b32 v127, v9, v127, s[42:43]
v_mov_b32 v128, 0
v_mov_b32 v129, 0
v_mov_b32 v130, 0
v_mov_b32 v131, 0
v_mov_b32 v132, 0
v_mov_b32 v133, 0
v_mov_b32 v134, 0
v_mov_b32 v135, 0
v_mov_b32 v136, 0
v_mov_b32 v137, 0
v_mov_b32 v138, 0
v_mov_b32 v139, 0
v_mov_b32 v140, 0
v_mov_b32 v141, 0
v_mov_b32 v142, 0
v_mov_b32 v143, 0
v_mov_b32 v144, 0
v_mov_b32 v145, 0
v_mov_b32 v146, 0
v_mov_b32 v147, 0
v_mov_b32 v148, 0
v_mov_b32 v149, 0
v_mov_b32 v150, 0
v_mov_b32 v151, 0
v_mov_b32 v152, 0
v_mov_b32 v153, 0
v_mov_b32 v154, 0
v_mov_b32 v155, 0
v_mov_b32 v156, 0
v_mov_b32 v157, 0
v_mov_b32 v158, 0
v_mov_b32 v159, 0
v_mov_b32 v160, 0
v_mov_b32 v161, 0
v_mov_b32 v162, 0
v_mov_b32 v163, 0
v_mov_b32 v164, 0
v_mov_b32 v165, 0
v_mov_b32 v166, 0
v_mov_b32 v167, 0
v_mov_b32 v168, 0
v_mov_b32 v169, 0
v_mov_b32 v170, 0
v_mov_b32 v171, 0
v_mov_b32 v172, 0
v_mov_b32 v173, 0
v_mov_b32 v174, 0
v_mov_b32 v175, 0
v_mov_b32 v176, 0
v_mov_b32 v177, 0
v_mov_b32 v178, 0
v_mov_b32 v179, 0
v_mov_b32 v180, 0
v_mov_b32 v181, 0
v_mov_b32 v182, 0
v_mov_b32 v183, 0
v_mov_b32 v184, 0
v_mov_b32 v185, 0
v_mov_b32 v186, 0
v_mov_b32 v187, 0
v_mov_b32 v188, 0
v_mov_b32 v189, 0
v_mov_b32 v190, 0
v_mov_b32 v191, 0
v_mov_b32 v192, 0
v_mov_b32 v193, 0
v_mov_b32 v194, 0
v_mov_b32 v195, 0
v_mov_b32 v196, 0
v_mov_b32 v197, 0
v_mov_b32 v198, 0
v_mov_b32 v199, 0
v_mov_b32 v200, 0
v_mov_b32 v201, 0
v_mov_b32 v202, 0
v_mov_b32 v203, 0
v_mov_b32 v204, 0
v_mov_b32 v205, 0
v_mov_b32 v206, 0
v_mov_b32 v207, 0
v_mov_b32 v208, 0
v_mov_b32 v209, 0
v_mov_b32 v210, 0
v_mov_b32 v211, 0
v_mov_b32 v212, 0
v_mov_b32 v213, 0
v_mov_b32 v214, 0
v_mov_b32 v215, 0
v_mov_b32 v216, 0
v_mov_b32 v217, 0
v_mov_b32 v218, 0
v_mov_b32 v219, 0
v_mov_b32 v220, 0
v_mov_b32 v221, 0
v_mov_b32 v222, 0
v_mov_b32 v223, 0
v_mov_b32 v224, 0
v_mov_b32 v225, 0
v_mov_b32 v226, 0
v_mov_b32 v227, 0
v_mov_b32 v228, 0
v_mov_b32 v229, 0
v_mov_b32 v230, 0
v_mov_b32 v231, 0
v_mov_b32 v232, 0
v_mov_b32 v233, 0
v_mov_b32 v234, 0
v_mov_b32 v235, 0
v_mov_b32 v236, 0
v_mov_b32 v237, 0
v_mov_b32 v238, 0
v_mov_b32 v239, 0
v_mov_b32 v240, 0
v_mov_b32 v241, 0
v_mov_b32 v242, 0
v_mov_b32 v243, 0
v_mov_b32 v244, 0
v_mov_b32 v245, 0
v_mov_b32 v246, 0
v_mov_b32 v247, 0
v_mov_b32 v248, 0
v_mov_b32 v249, 0
v_mov_b32 v250, 0
v_mov_b32 v251, 0
v_mov_b32 v252, 0
v_mov_b32 v253, 0
v_mov_b32 v254, 0
v_mov_b32 v255, 0
s_waitcnt vmcnt(16)
s_barrier
ds_read_b128 a[0:3], v1 offset:8192
ds_read_b128 a[4:7], v1 offset:9216
ds_read_b128 a[8:11], v1 offset:10240
ds_read_b128 a[12:15], v1 offset:11264
ds_read_b128 a[16:19], v1 offset:12288
ds_read_b128 a[20:23], v1 offset:13312
ds_read_b128 a[24:27], v1 offset:14336
ds_read_b128 a[28:31], v1 offset:15360
s_waitcnt lgkmcnt(0)
s_branch L_att_start
.section .rodata,"a"
.p2align 6
.amdhsa_kernel gated_mix__compressed_kv_cla__sliding_local_dilated__prompt_kernel
  .amdhsa_next_free_vgpr 512
  .amdhsa_next_free_sgpr 102
  .amdhsa_accum_offset 256
  .amdhsa_group_segment_fixed_size 0
  .amdhsa_kernarg_size 104
  .amdhsa_user_sgpr_count 2
  .amdhsa_user_sgpr_kernarg_segment_ptr 1
  .amdhsa_system_sgpr_workgroup_id_x 1
.end_amdhsa_kernel
```

```asm
; @launch grid=(256,1,1) block=(256,1,1) lds=163840
.amdgcn_target "amdgcn-amd-amdhsa--gfx950"
.text
.globl gated_mix__compressed_kv_cla__sliding_local_dilated__prompt_kernel
.p2align 8
.type gated_mix__compressed_kv_cla__sliding_local_dilated__prompt_kernel,@function
gated_mix__compressed_kv_cla__sliding_local_dilated__prompt_kernel:
s_load_dwordx16 s[16:31], s[0:1], 0
s_load_dwordx8 s[32:39], s[0:1], 64
s_load_dwordx2 s[88:89], s[0:1], 96
s_cmp_ge_u32 s2, 256
s_cbranch_scc1 L_end
v_lshrrev_b32 v1, 6, v0
v_and_b32 v0, 63, v0
v_readfirstlane_b32 s4, v1
v_lshlrev_b32 v16, 4, v0
s_lshr_b32 s8, s2, 3
s_lshl_b32 s8, s8, 2
s_add_u32 s8, s8, s4
s_min_u32 s8, s8, 97
s_lshl_b32 s8, s8, 10
s_getpc_b64 s[92:93]
L_here:
s_add_u32 s8, s8, L_page0-L_here
s_add_u32 s92, s92, s8
s_addc_u32 s93, s93, 0
v_add_u32 v60, s92, v16
v_mov_b32 v61, s93
global_load_dword a120, v[60:61], off sc1
s_and_b32 s5, s2, 7
s_lshl_b32 s5, s5, 2
s_bfe_u32 s3, s2, 0x20003
s_add_u32 s5, s5, s3
s_lshr_b32 s6, s2, 5
s_mov_b32 s12, 0x4000
s_mov_b32 s13, 0x8000
s_mov_b32 s14, 0xc000
s_mov_b32 s46, 0x400000
s_mov_b32 s47, 0x20000
s_mov_b32 s50, 0x200000
s_mov_b32 s51, 0x20000
s_mov_b32 s54, 0x800000
s_mov_b32 s55, 0x20000
s_mov_b32 s58, 0x400000
s_mov_b32 s59, 0x20000
s_mov_b32 s62, 0x400000
s_mov_b32 s63, 0x20000
s_mov_b32 s66, 0x800000
s_mov_b32 s67, 0x20000
s_mov_b32 s70, 0x600000
s_mov_b32 s71, 0x20000
s_mov_b32 s74, 0x200000
s_mov_b32 s75, 0x20000
s_mov_b32 s78, 0x800
s_mov_b32 s79, 0x20000
s_mov_b32 s82, 0x400000
s_mov_b32 s83, 0x20000
s_mov_b32 s86, 0x100
s_mov_b32 s87, 0x20000
s_mov_b32 s90, 0x10000000
s_mov_b32 s91, 0x20000
v_bfe_u32 v17, v0, 2, 2
s_lshl_b32 s8, s4, 4
v_add_u32 v17, s8, v17
v_lshlrev_b32 v17, 13, v17
v_lshrrev_b32 v18, 4, v0
v_lshl_add_u32 v17, v18, 6, v17
v_and_b32 v18, 3, v0
v_lshl_add_u32 v17, v18, 4, v17
s_lshl_b32 s8, s5, 8
v_add_u32 v5, s8, v17
v_xor_b32 v6, 32, v5
v_add_u32 v6, 0x10000, v6
v_lshrrev_b32 v17, 4, v0
v_xor_b32 v17, v17, v0
v_and_b32 v17, 7, v17
v_lshlrev_b32 v17, 4, v17
v_lshrrev_b32 v18, 3, v0
v_lshl_add_u32 v2, v18, 10, v17
s_lshl_b32 s8, s6, 18
s_lshl_b32 s9, s4, 16
s_add_u32 s8, s8, s9
v_add_u32 v2, s8, v2
v_xor_b32 v3, 64, v2
v_add_u32 v3, 0x2000, v3
s_sub_u32 s10, 15, s6
s_cmp_lt_u32 s5, 16
s_cselect_b32 s10, s6, s10
s_lshl_b32 s10, s10, 4
s_and_b32 s11, s5, 15
s_add_u32 s10, s10, s11
s_lshl_b32 s10, s10, 3
s_lshl_b32 s11, s4, 1
s_add_u32 s10, s10, s11
s_lshl_b32 s100, s10, 11
s_lshl_b32 s101, s10, 2
s_add_u32 s101, s101, 0x3700000
s_lshl_b32 s8, s2, 2
s_add_u32 s8, s8, s4
s_lshl_b32 s8, s8, 11
v_lshrrev_b32 v19, 2, v0
v_lshl_add_u32 v19, v19, 7, s8
s_lshr_b32 s8, s2, 3
s_lshl_b32 s8, s8, 2
s_add_u32 s8, s8, s4
s_lshl_b32 s8, s8, 4
s_and_b32 s9, s2, 7
s_add_u32 s8, s8, s9
s_lshl_b32 s8, s8, 10
v_bfe_u32 v63, v0, 2, 3
v_lshl_add_u32 v63, v63, 7, s8
v_lshrrev_b32 v59, 5, v0
v_lshl_add_u32 v63, v59, 13, v63
v_mov_b32 v62, v19
s_waitcnt lgkmcnt(0)
s_mov_b64 s[48:49], s[18:19]
s_mov_b64 s[56:57], s[22:23]
s_mov_b64 s[60:61], s[24:25]
L_args:
s_mov_b64 s[0:1], s[92:93]
s_mov_b64 s[44:45], s[16:17]
s_mov_b64 s[76:77], s[34:35]
s_mov_b64 s[52:53], s[20:21]
s_mov_b64 s[64:65], s[26:27]
s_mov_b64 s[68:69], s[30:31]
s_mov_b64 s[72:73], s[32:33]
s_mov_b64 s[80:81], s[36:37]
s_mov_b64 s[84:85], s[38:39]
s_lshl_b32 s16, s4, 13
s_add_u32 s16, s16, 0x18000
s_lshl_b32 s17, s4, 12
s_lshl_b32 s18, s4, 10
s_mov_b32 s25, 0x800
s_mov_b32 s26, 0x1000
s_mov_b32 s3, 0
s_mov_b32 s9, 0x0
s_nop 0
buffer_load_dword a120, v63, s[56:59], s9 offen
s_mov_b32 s9, 0x0
s_nop 0
buffer_load_dword a120, v63, s[60:63], s9 offen
s_add_u32 m0, s17, 0x0
s_nop 0
buffer_load_dwordx4 v5, s[56:59], 0 offen lds
s_add_u32 m0, s17, 0x4000
s_nop 0
buffer_load_dwordx4 v5, s[60:63], 0 offen lds
s_add_u32 m0, s17, 0x400
s_nop 0
buffer_load_dwordx4 v5, s[56:59], s13 offen lds
s_add_u32 m0, s17, 0x4400
s_nop 0
buffer_load_dwordx4 v5, s[60:63], s13 offen lds
s_add_u32 m0, s17, 0x800
s_nop 0
buffer_load_dwordx4 v6, s[56:59], 0 offen lds
s_add_u32 m0, s17, 0x4800
s_nop 0
buffer_load_dwordx4 v6, s[60:63], 0 offen lds
s_add_u32 m0, s17, 0xc00
s_nop 0
buffer_load_dwordx4 v6, s[56:59], s13 offen lds
s_add_u32 m0, s17, 0x4c00
s_nop 0
buffer_load_dwordx4 v6, s[60:63], s13 offen lds
v_add_u32 v5, 0x80000, v5
v_add_u32 v6, 0x80000, v6
s_add_u32 m0, s16, 0x0
s_nop 0
buffer_load_dwordx4 v2, s[48:51], 0 offen lds
s_add_u32 m0, s16, 0x400
s_nop 0
buffer_load_dwordx4 v3, s[48:51], 0 offen lds
s_add_u32 m0, s16, 0x800
s_nop 0
buffer_load_dwordx4 v2, s[48:51], s12 offen lds
s_add_u32 m0, s16, 0xc00
s_nop 0
buffer_load_dwordx4 v3, s[48:51], s12 offen lds
s_add_u32 m0, s16, 0x1000
s_nop 0
buffer_load_dwordx4 v2, s[48:51], s13 offen lds
s_add_u32 m0, s16, 0x1400
s_nop 0
buffer_load_dwordx4 v3, s[48:51], s13 offen lds
s_add_u32 m0, s16, 0x1800
s_nop 0
buffer_load_dwordx4 v2, s[48:51], s14 offen lds
s_add_u32 m0, s16, 0x1c00
s_nop 0
buffer_load_dwordx4 v3, s[48:51], s14 offen lds
v_add_u32 v2, 0x80, v2
v_add_u32 v3, 0x80, v3
L_hopA:
s_mov_b32 s95, 1
s_cmp_eq_u32 s4, 0
s_cbranch_scc1 L_padA0
s_cmp_eq_u32 s4, 1
s_cbranch_scc1 L_padA1
s_cmp_eq_u32 s4, 2
s_cbranch_scc1 L_padA2
s_branch L_padA3
L_hopA_ret:
s_mov_b32 s95, 0
v_lshrrev_b32 v17, 4, v0
v_xor_b32 v17, v17, v0
v_and_b32 v17, 7, v17
v_lshlrev_b32 v17, 4, v17
v_lshrrev_b32 v18, 3, v0
v_lshl_add_u32 v22, v18, 11, v17
v_xor_b32 v23, 64, v22
v_add_u32 v23, 0x4000, v23
s_and_b32 s8, s4, 1
s_lshl_b32 s9, s8, 6
s_lshl_b32 s8, s8, 14
v_xor_b32 v4, s9, v22
v_add_u32 v4, s8, v4
s_lshl_b32 s8, s6, 18
s_sub_u32 s9, 15, s6
s_lshl_b32 s9, s9, 18
s_lshl_b32 s10, s4, 15
s_sub_u32 s11, 0x38000, s10
s_add_u32 s20, s8, s10
s_add_u32 s21, s8, s11
s_add_u32 s22, s9, s10
s_add_u32 s23, s9, s11
s_cmp_lt_u32 s4, 2
s_cselect_b32 s24, s8, s9
s_max_u32 s24, s24, 0x8000
s_sub_u32 s24, s24, 0x8000
v_lshrrev_b32 v17, 2, v0
s_lshl_b32 s8, s4, 4
v_add_u32 v17, s8, v17
v_mul_u32_u24 v17, 0x1800, v17
v_and_b32 v18, 3, v0
v_lshlrev_b32 v18, 4, v18
v_and_b32 v19, 32, v0
v_xor_b32 v18, v18, v19
s_lshl_b32 s8, s5, 6
v_add3_u32 v7, v17, v18, s8
v_and_b32 v17, 15, v0
v_lshrrev_b32 v18, 1, v17
v_lshrrev_b32 v19, 4, v0
v_xor_b32 v18, v18, v19
v_lshlrev_b32 v18, 4, v18
v_lshl_add_u32 v10, v17, 7, v18
v_add_u32 v8, s16, v10
v_xor_b32 v9, 64, v8
s_lshr_b32 s8, s4, 1
s_lshl_b32 s8, s8, 11
s_add_u32 s8, s8, 94208
v_add_u32 v10, s8, v10
v_xor_b32 v11, 64, v10
v_lshrrev_b32 v17, 4, v0
v_lshlrev_b32 v18, 11, v17
v_and_b32 v17, 1, v17
v_lshl_add_u32 v18, v17, 5, v18
v_bfe_u32 v17, v0, 2, 2
v_lshl_add_u32 v18, v17, 6, v18
v_and_b32 v17, 3, v0
v_lshl_add_u32 v12, v17, 3, v18
v_xor_b32 v13, 32, v12
v_lshrrev_b32 v17, 4, v0
v_lshlrev_b32 v18, 9, v17
v_and_b32 v17, 1, v17
v_lshl_add_u32 v18, v17, 5, v18
v_bfe_u32 v17, v0, 2, 2
v_lshl_add_u32 v18, v17, 6, v18
v_and_b32 v17, 3, v0
v_lshl_add_u32 v14, v17, 3, v18
s_and_b32 s8, s4, 1
s_lshl_b32 s8, s8, 5
v_xor_b32 v14, s8, v14
v_add_u32 v14, 81920, v14
v_xor_b32 v15, 32, v14
s_mul_i32 s32, s5, 0x10c400
s_lshl_b32 s19, s4, 13
s_add_u32 s32, s32, s19
s_cmp_eq_u32 s4, 0
s_cselect_b32 s94, 0x200000, 0
s_add_u32 s32, s32, s94
s_sub_u32 s94, 0x8000, s94
s_add_u32 s7, s32, 0x1000
s_add_u32 s27, s19, 131072
s_add_u32 m0, s16, 0x8000
s_nop 0
buffer_load_dwordx4 v2, s[48:51], 0 offen lds
s_add_u32 m0, s16, 0x8400
s_nop 0
buffer_load_dwordx4 v3, s[48:51], 0 offen lds
s_add_u32 m0, s16, 0x8800
s_nop 0
buffer_load_dwordx4 v2, s[48:51], s12 offen lds
s_add_u32 m0, s16, 0x8c00
s_nop 0
buffer_load_dwordx4 v3, s[48:51], s12 offen lds
s_add_u32 m0, s16, 0x9000
s_nop 0
buffer_load_dwordx4 v2, s[48:51], s13 offen lds
s_add_u32 m0, s16, 0x9400
s_nop 0
buffer_load_dwordx4 v3, s[48:51], s13 offen lds
s_add_u32 m0, s16, 0x9800
s_nop 0
buffer_load_dwordx4 v2, s[48:51], s14 offen lds
s_add_u32 m0, s16, 0x9c00
s_nop 0
buffer_load_dwordx4 v3, s[48:51], s14 offen lds
v_add_u32 v2, 0x80, v2
v_add_u32 v3, 0x80, v3
s_mov_b32 s9, 0x0
s_nop 0
buffer_load_dword a120, v62, s[48:51], s9 offen
v_mov_b32 v19, v62
v_mov_b32 v18, v63
s_cmp_lg_u32 s4, 0
s_cbranch_scc1 L_flag_clr
s_lshl_b32 s8, s6, 5
s_add_u32 s8, s8, s5
s_lshl_b32 s8, s8, 2
s_add_u32 s8, s8, 0x3704000
v_mov_b32 v17, 0
s_mov_b64 exec, 1
buffer_store_dword v17, off, s[88:91], s8 sc1
s_mov_b64 exec, -1
L_flag_clr:
s_waitcnt vmcnt(9)
s_barrier
s_branch L_main
.p2align 12
L_page0:
L_padA0:
s_branch L_padA4
L_main:
ds_read_b64_tr_b16 a[80:81], v12 offset:0
ds_read_b64_tr_b16 a[82:83], v12 offset:1024
ds_read_b64_tr_b16 a[84:85], v12 offset:8192
ds_read_b64_tr_b16 a[86:87], v12 offset:9216
ds_read_b128 a[0:3], v8 offset:0
ds_read_b128 a[20:23], v9 offset:0
ds_read_b128 a[4:7], v8 offset:2048
ds_read_b128 a[24:27], v9 offset:2048
ds_read_b128 a[8:11], v8 offset:4096
ds_read_b128 a[28:31], v9 offset:4096
ds_read_b128 a[12:15], v8 offset:6144
ds_read_b128 a[32:35], v9 offset:6144
ds_read_b64_tr_b16 a[88:89], v13 offset:0
ds_read_b64_tr_b16 a[90:91], v13 offset:1024
ds_read_b64_tr_b16 a[92:93], v13 offset:8192
ds_read_b64_tr_b16 a[94:95], v13 offset:9216
ds_read_b64_tr_b16 a[96:97], v12 offset:256
ds_read_b64_tr_b16 a[98:99], v12 offset:1280
ds_read_b64_tr_b16 a[100:101], v12 offset:8448
ds_read_b64_tr_b16 a[102:103], v12 offset:9472
s_waitcnt lgkmcnt(0)
L_S0:
v_mfma_f32_16x16x32_bf16 v[24:27], a[80:83], a[0:3], 0
ds_read_b64_tr_b16 a[104:105], v13 offset:256
s_add_u32 m0, s17, 0x8000
v_mfma_f32_16x16x32_bf16 v[24:27], a[84:87], a[20:23], v[24:27]
buffer_load_dwordx4 v5, s[56:59], 0 offen lds
v_mfma_f32_16x16x32_bf16 v[32:35], a[84:87], a[24:27], 0
ds_read_b64_tr_b16 a[106:107], v13 offset:1280
v_mfma_f32_16x16x32_bf16 v[32:35], a[80:83], a[4:7], v[32:35]
ds_read_b64_tr_b16 a[108:109], v13 offset:8448
v_mfma_f32_16x16x32_bf16 v[40:43], a[80:83], a[8:11], 0
ds_read_b64_tr_b16 a[110:111], v13 offset:9472
v_mfma_f32_16x16x32_bf16 v[40:43], a[84:87], a[28:31], v[40:43]
s_add_u32 m0, s17, 0xc000
v_mfma_f32_16x16x32_bf16 v[48:51], a[84:87], a[32:35], 0
buffer_load_dwordx4 v5, s[60:63], 0 offen lds
v_mfma_f32_16x16x32_bf16 v[48:51], a[80:83], a[12:15], v[48:51]
v_mfma_f32_16x16x32_bf16 v[52:55], a[88:91], a[12:15], 0
ds_read_b64_tr_b16 a[80:81], v12 offset:512
v_mfma_f32_16x16x32_bf16 v[52:55], a[92:95], a[32:35], v[52:55]
ds_read_b64_tr_b16 a[82:83], v12 offset:1536
v_mfma_f32_16x16x32_bf16 v[44:47], a[92:95], a[28:31], 0
ds_read_b64_tr_b16 a[84:85], v12 offset:8704
s_add_u32 m0, s17, 0x8400
v_mfma_f32_16x16x32_bf16 v[44:47], a[88:91], a[8:11], v[44:47]
buffer_load_dwordx4 v5, s[56:59], s13 offen lds
v_mfma_f32_16x16x32_bf16 v[36:39], a[88:91], a[4:7], 0
ds_read_b64_tr_b16 a[86:87], v12 offset:9728
v_mfma_f32_16x16x32_bf16 v[36:39], a[92:95], a[24:27], v[36:39]
v_mfma_f32_16x16x32_bf16 v[28:31], a[92:95], a[20:23], 0
v_mfma_f32_16x16x32_bf16 v[28:31], a[88:91], a[0:3], v[28:31]
s_add_u32 m0, s17, 0xc400
v_mfma_f32_16x16x32_bf16 v[56:59], a[96:99], a[0:3], 0
buffer_load_dwordx4 v5, s[60:63], s13 offen lds
v_mfma_f32_16x16x32_bf16 v[56:59], a[100:103], a[20:23], v[56:59]
ds_read_b64_tr_b16 a[88:89], v13 offset:512
v_mfma_f32_16x16x32_bf16 v[64:67], a[100:103], a[24:27], 0
ds_read_b64_tr_b16 a[90:91], v13 offset:1536
v_mfma_f32_16x16x32_bf16 v[64:67], a[96:99], a[4:7], v[64:67]
ds_read_b64_tr_b16 a[92:93], v13 offset:8704
v_mfma_f32_16x16x32_bf16 v[72:75], a[96:99], a[8:11], 0
ds_read_b64_tr_b16 a[94:95], v13 offset:9728
s_add_u32 m0, s17, 0x8800
v_mfma_f32_16x16x32_bf16 v[72:75], a[100:103], a[28:31], v[72:75]
buffer_load_dwordx4 v6, s[56:59], 0 offen lds
v_mfma_f32_16x16x32_bf16 v[80:83], a[100:103], a[32:35], 0
v_mfma_f32_16x16x32_bf16 v[80:83], a[96:99], a[12:15], v[80:83]
s_waitcnt lgkmcnt(10)
v_mfma_f32_16x16x32_bf16 v[84:87], a[104:107], a[12:15], 0
ds_read_b64_tr_b16 a[96:97], v12 offset:768
s_waitcnt lgkmcnt(9)
v_mfma_f32_16x16x32_bf16 v[84:87], a[108:111], a[32:35], v[84:87]
ds_read_b64_tr_b16 a[98:99], v12 offset:1792
s_add_u32 m0, s17, 0xc800
v_mfma_f32_16x16x32_bf16 v[76:79], a[108:111], a[28:31], 0
buffer_load_dwordx4 v6, s[60:63], 0 offen lds
v_mfma_f32_16x16x32_bf16 v[76:79], a[104:107], a[8:11], v[76:79]
ds_read_b64_tr_b16 a[100:101], v12 offset:8960
v_mfma_f32_16x16x32_bf16 v[68:71], a[104:107], a[4:7], 0
ds_read_b64_tr_b16 a[102:103], v12 offset:9984
v_mfma_f32_16x16x32_bf16 v[68:71], a[108:111], a[24:27], v[68:71]
v_mfma_f32_16x16x32_bf16 v[60:63], a[108:111], a[20:23], 0
s_add_u32 m0, s17, 0x8c00
s_waitcnt lgkmcnt(4)
v_mfma_f32_16x16x32_bf16 v[60:63], a[104:107], a[0:3], v[60:63]
buffer_load_dwordx4 v6, s[56:59], s13 offen lds
v_mfma_f32_16x16x32_bf16 v[88:91], a[80:83], a[0:3], 0
ds_read_b64_tr_b16 a[104:105], v13 offset:768
v_mfma_f32_16x16x32_bf16 v[88:91], a[84:87], a[20:23], v[88:91]
ds_read_b64_tr_b16 a[106:107], v13 offset:1792
v_mfma_f32_16x16x32_bf16 v[96:99], a[84:87], a[24:27], 0
ds_read_b64_tr_b16 a[108:109], v13 offset:8960
v_mfma_f32_16x16x32_bf16 v[96:99], a[80:83], a[4:7], v[96:99]
ds_read_b64_tr_b16 a[110:111], v13 offset:9984
s_add_u32 m0, s17, 0xcc00
v_mfma_f32_16x16x32_bf16 v[104:107], a[80:83], a[8:11], 0
buffer_load_dwordx4 v6, s[60:63], s13 offen lds
v_mfma_f32_16x16x32_bf16 v[104:107], a[84:87], a[28:31], v[104:107]
v_add_u32 v5, 0x80000, v5
v_add_u32 v6, 0x80000, v6
v_mfma_f32_16x16x32_bf16 v[112:115], a[84:87], a[32:35], 0
v_mfma_f32_16x16x32_bf16 v[112:115], a[80:83], a[12:15], v[112:115]
v_mfma_f32_16x16x32_bf16 v[116:119], a[88:91], a[12:15], 0
ds_read_b64_tr_b16 a[80:81], v12 offset:16384
s_add_u32 m0, s16, 0x0
v_mfma_f32_16x16x32_bf16 v[116:119], a[92:95], a[32:35], v[116:119]
buffer_load_dwordx4 v2, s[48:51], 0 offen lds
v_mfma_f32_16x16x32_bf16 v[108:111], a[92:95], a[28:31], 0
ds_read_b64_tr_b16 a[82:83], v12 offset:17408
v_mfma_f32_16x16x32_bf16 v[108:111], a[88:91], a[8:11], v[108:111]
ds_read_b64_tr_b16 a[84:85], v12 offset:24576
v_mfma_f32_16x16x32_bf16 v[100:103], a[88:91], a[4:7], 0
ds_read_b64_tr_b16 a[86:87], v12 offset:25600
v_mfma_f32_16x16x32_bf16 v[100:103], a[92:95], a[24:27], v[100:103]
s_add_u32 m0, s16, 0x400
v_mfma_f32_16x16x32_bf16 v[92:95], a[92:95], a[20:23], 0
buffer_load_dwordx4 v3, s[48:51], 0 offen lds
v_mfma_f32_16x16x32_bf16 v[92:95], a[88:91], a[0:3], v[92:95]
s_waitcnt lgkmcnt(4)
v_mfma_f32_16x16x32_bf16 v[120:123], a[96:99], a[0:3], 0
ds_read_b64_tr_b16 a[88:89], v13 offset:16384
s_waitcnt vmcnt(11)
v_mfma_f32_16x16x32_bf16 v[120:123], a[100:103], a[20:23], v[120:123]
ds_read_b64_tr_b16 a[90:91], v13 offset:17408
v_mfma_f32_16x16x32_bf16 v[128:131], a[100:103], a[24:27], 0
ds_read_b64_tr_b16 a[92:93], v13 offset:24576
s_add_u32 m0, s16, 0x800
v_mfma_f32_16x16x32_bf16 v[128:131], a[96:99], a[4:7], v[128:131]
buffer_load_dwordx4 v2, s[48:51], s12 offen lds
v_mfma_f32_16x16x32_bf16 v[136:139], a[96:99], a[8:11], 0
ds_read_b64_tr_b16 a[94:95], v13 offset:25600
v_mfma_f32_16x16x32_bf16 v[136:139], a[100:103], a[28:31], v[136:139]
ds_read_b128 a[40:43], v8 offset:32768
v_mfma_f32_16x16x32_bf16 v[144:147], a[100:103], a[32:35], 0
ds_read_b128 a[60:63], v9 offset:32768
v_mfma_f32_16x16x32_bf16 v[144:147], a[96:99], a[12:15], v[144:147]
ds_read_b128 a[44:47], v8 offset:34816
s_add_u32 m0, s16, 0xc00
v_mfma_f32_16x16x32_bf16 v[148:151], a[104:107], a[12:15], 0
buffer_load_dwordx4 v3, s[48:51], s12 offen lds
v_mfma_f32_16x16x32_bf16 v[148:151], a[108:111], a[32:35], v[148:151]
ds_read_b64_tr_b16 a[96:97], v12 offset:16640
v_mfma_f32_16x16x32_bf16 v[140:143], a[108:111], a[28:31], 0
ds_read_b64_tr_b16 a[98:99], v12 offset:17664
v_mfma_f32_16x16x32_bf16 v[140:143], a[104:107], a[8:11], v[140:143]
ds_read_b64_tr_b16 a[100:101], v12 offset:24832
v_mfma_f32_16x16x32_bf16 v[132:135], a[104:107], a[4:7], 0
ds_read_b64_tr_b16 a[102:103], v12 offset:25856
s_add_u32 m0, s16, 0x1000
v_mfma_f32_16x16x32_bf16 v[132:135], a[108:111], a[24:27], v[132:135]
buffer_load_dwordx4 v2, s[48:51], s13 offen lds
v_mfma_f32_16x16x32_bf16 v[124:127], a[108:111], a[20:23], 0
ds_read_b128 a[64:67], v9 offset:34816
v_mfma_f32_16x16x32_bf16 v[124:127], a[104:107], a[0:3], v[124:127]
ds_read_b128 a[48:51], v8 offset:36864
s_waitcnt lgkmcnt(9)
v_mfma_f32_16x16x32_bf16 v[152:155], a[0:3], a[80:83], 0
ds_read_b64_tr_b16 a[104:105], v13 offset:16640
v_mfma_f32_16x16x32_bf16 v[152:155], a[20:23], a[84:87], v[152:155]
ds_read_b64_tr_b16 a[106:107], v13 offset:17664
s_add_u32 m0, s16, 0x1400
v_mfma_f32_16x16x32_bf16 v[156:159], a[24:27], a[84:87], 0
buffer_load_dwordx4 v3, s[48:51], s13 offen lds
v_mfma_f32_16x16x32_bf16 v[156:159], a[4:7], a[80:83], v[156:159]
ds_read_b64_tr_b16 a[108:109], v13 offset:24832
v_mfma_f32_16x16x32_bf16 v[160:163], a[8:11], a[80:83], 0
ds_read_b64_tr_b16 a[110:111], v13 offset:25856
v_mfma_f32_16x16x32_bf16 v[160:163], a[28:31], a[84:87], v[160:163]
ds_read_b128 a[68:71], v9 offset:36864
v_mfma_f32_16x16x32_bf16 v[164:167], a[32:35], a[84:87], 0
ds_read_b128 a[52:55], v8 offset:38912
s_add_u32 m0, s16, 0x1800
v_mfma_f32_16x16x32_bf16 v[164:167], a[12:15], a[80:83], v[164:167]
buffer_load_dwordx4 v2, s[48:51], s14 offen lds
v_mfma_f32_16x16x32_bf16 v[180:183], a[12:15], a[88:91], 0
ds_read_b64_tr_b16 a[80:81], v12 offset:16896
v_mfma_f32_16x16x32_bf16 v[180:183], a[32:35], a[92:95], v[180:183]
ds_read_b64_tr_b16 a[82:83], v12 offset:17920
v_mfma_f32_16x16x32_bf16 v[176:179], a[28:31], a[92:95], 0
ds_read_b64_tr_b16 a[84:85], v12 offset:25088
v_mfma_f32_16x16x32_bf16 v[176:179], a[8:11], a[88:91], v[176:179]
ds_read_b64_tr_b16 a[86:87], v12 offset:26112
s_add_u32 m0, s16, 0x1c00
v_mfma_f32_16x16x32_bf16 v[172:175], a[4:7], a[88:91], 0
buffer_load_dwordx4 v3, s[48:51], s14 offen lds
v_mfma_f32_16x16x32_bf16 v[172:175], a[24:27], a[92:95], v[172:175]
ds_read_b128 a[72:75], v9 offset:38912
v_add_u32 v2, 0x80, v2
v_mfma_f32_16x16x32_bf16 v[168:171], a[20:23], a[92:95], 0
v_add_u32 v3, 0x80, v3
v_mfma_f32_16x16x32_bf16 v[168:171], a[0:3], a[88:91], v[168:171]
s_waitcnt lgkmcnt(7)
v_mfma_f32_16x16x32_bf16 v[184:187], a[0:3], a[96:99], 0
ds_read_b64_tr_b16 a[88:89], v13 offset:16896
s_add_u32 m0, s17, 0x10000
v_mfma_f32_16x16x32_bf16 v[184:187], a[20:23], a[100:103], v[184:187]
buffer_load_dwordx4 v5, s[56:59], 0 offen lds
v_mfma_f32_16x16x32_bf16 v[188:191], a[24:27], a[100:103], 0
ds_read_b64_tr_b16 a[90:91], v13 offset:17920
v_mfma_f32_16x16x32_bf16 v[188:191], a[4:7], a[96:99], v[188:191]
ds_read_b64_tr_b16 a[92:93], v13 offset:25088
v_mfma_f32_16x16x32_bf16 v[192:195], a[8:11], a[96:99], 0
ds_read_b64_tr_b16 a[94:95], v13 offset:26112
v_mfma_f32_16x16x32_bf16 v[192:195], a[28:31], a[100:103], v[192:195]
s_add_u32 m0, s17, 0x14000
v_mfma_f32_16x16x32_bf16 v[196:199], a[32:35], a[100:103], 0
buffer_load_dwordx4 v5, s[60:63], 0 offen lds
v_mfma_f32_16x16x32_bf16 v[196:199], a[12:15], a[96:99], v[196:199]
v_mfma_f32_16x16x32_bf16 v[212:215], a[12:15], a[104:107], 0
ds_read_b64_tr_b16 a[96:97], v12 offset:17152
v_mfma_f32_16x16x32_bf16 v[212:215], a[32:35], a[108:111], v[212:215]
ds_read_b64_tr_b16 a[98:99], v12 offset:18176
v_mfma_f32_16x16x32_bf16 v[208:211], a[28:31], a[108:111], 0
ds_read_b64_tr_b16 a[100:101], v12 offset:25344
s_add_u32 m0, s17, 0x10400
v_mfma_f32_16x16x32_bf16 v[208:211], a[8:11], a[104:107], v[208:211]
buffer_load_dwordx4 v5, s[56:59], s13 offen lds
v_mfma_f32_16x16x32_bf16 v[204:207], a[4:7], a[104:107], 0
ds_read_b64_tr_b16 a[102:103], v12 offset:26368
v_mfma_f32_16x16x32_bf16 v[204:207], a[24:27], a[108:111], v[204:207]
v_mfma_f32_16x16x32_bf16 v[200:203], a[20:23], a[108:111], 0
v_mfma_f32_16x16x32_bf16 v[200:203], a[0:3], a[104:107], v[200:203]
s_add_u32 m0, s17, 0x14400
s_waitcnt lgkmcnt(4)
v_mfma_f32_16x16x32_bf16 v[248:251], a[0:3], a[80:83], 0
buffer_load_dwordx4 v5, s[60:63], s13 offen lds
v_mfma_f32_16x16x32_bf16 v[248:251], a[20:23], a[84:87], v[248:251]
ds_read_b64_tr_b16 a[104:105], v13 offset:17152
v_mfma_f32_16x16x32_bf16 v[252:255], a[24:27], a[84:87], 0
ds_read_b64_tr_b16 a[106:107], v13 offset:18176
v_mfma_f32_16x16x32_bf16 v[252:255], a[4:7], a[80:83], v[252:255]
ds_read_b64_tr_b16 a[108:109], v13 offset:25344
v_mfma_f32_16x16x32_bf16 v[216:219], a[8:11], a[80:83], 0
ds_read_b64_tr_b16 a[110:111], v13 offset:26368
s_add_u32 m0, s17, 0x10800
v_mfma_f32_16x16x32_bf16 v[216:219], a[28:31], a[84:87], v[216:219]
buffer_load_dwordx4 v6, s[56:59], 0 offen lds
v_mfma_f32_16x16x32_bf16 v[220:223], a[32:35], a[84:87], 0
v_add_u32 v12, 0x8000, v12
v_add_u32 v13, 0x8000, v13
v_mfma_f32_16x16x32_bf16 v[220:223], a[12:15], a[80:83], v[220:223]
v_mfma_f32_16x16x32_bf16 v[236:239], a[12:15], a[88:91], 0
s_waitcnt vmcnt(13) lgkmcnt(0)
v_mfma_f32_16x16x32_bf16 v[236:239], a[32:35], a[92:95], v[236:239]
s_barrier
s_add_u32 m0, s17, 0x14800
v_mfma_f32_16x16x32_bf16 v[232:235], a[28:31], a[92:95], 0
buffer_load_dwordx4 v6, s[60:63], 0 offen lds
v_mfma_f32_16x16x32_bf16 v[232:235], a[8:11], a[88:91], v[232:235]
ds_read_b64_tr_b16 a[80:81], v12 offset:0
v_mfma_f32_16x16x32_bf16 v[228:231], a[4:7], a[88:91], 0
ds_read_b64_tr_b16 a[82:83], v12 offset:1024
v_mfma_f32_16x16x32_bf16 v[228:231], a[24:27], a[92:95], v[228:231]
ds_read_b64_tr_b16 a[84:85], v12 offset:8192
s_waitcnt lgkmcnt(3)
v_mfma_f32_16x16x32_bf16 v[224:227], a[20:23], a[92:95], 0
ds_read_b64_tr_b16 a[86:87], v12 offset:9216
s_add_u32 m0, s17, 0x10c00
v_mfma_f32_16x16x32_bf16 v[224:227], a[0:3], a[88:91], v[224:227]
buffer_load_dwordx4 v6, s[56:59], s13 offen lds
v_mfma_f32_16x16x32_bf16 v[240:243], a[0:3], a[96:99], 0
ds_read_b64_tr_b16 a[88:89], v13 offset:0
v_mfma_f32_16x16x32_bf16 v[240:243], a[20:23], a[100:103], v[240:243]
ds_read_b64_tr_b16 a[90:91], v13 offset:1024
v_mfma_f32_16x16x32_bf16 v[244:247], a[24:27], a[100:103], 0
ds_read_b64_tr_b16 a[92:93], v13 offset:8192
v_mfma_f32_16x16x32_bf16 v[244:247], a[4:7], a[96:99], v[244:247]
ds_read_b64_tr_b16 a[94:95], v13 offset:9216
s_add_u32 m0, s17, 0x14c00
v_mfma_f32_16x16x32_bf16 a[232:235], a[8:11], a[96:99], 0
buffer_load_dwordx4 v6, s[60:63], s13 offen lds
v_mfma_f32_16x16x32_bf16 a[232:235], a[28:31], a[100:103], a[232:235]
v_add_u32 v5, 0x80000, v5
v_add_u32 v6, 0x80000, v6
v_mfma_f32_16x16x32_bf16 a[236:239], a[32:35], a[100:103], 0
v_mfma_f32_16x16x32_bf16 a[236:239], a[12:15], a[96:99], a[236:239]
s_waitcnt lgkmcnt(15)
v_mfma_f32_16x16x32_bf16 a[252:255], a[12:15], a[104:107], 0
ds_read_b64_tr_b16 a[96:97], v12 offset:256
s_add_u32 m0, s16, 0x8000
v_mfma_f32_16x16x32_bf16 a[252:255], a[32:35], a[108:111], a[252:255]
buffer_load_dwordx4 v2, s[48:51], 0 offen lds
v_mfma_f32_16x16x32_bf16 a[248:251], a[28:31], a[108:111], 0
ds_read_b64_tr_b16 a[98:99], v12 offset:1280
v_mfma_f32_16x16x32_bf16 a[248:251], a[8:11], a[104:107], a[248:251]
ds_read_b64_tr_b16 a[100:101], v12 offset:8448
v_mfma_f32_16x16x32_bf16 a[244:247], a[4:7], a[104:107], 0
ds_read_b64_tr_b16 a[102:103], v12 offset:9472
v_mfma_f32_16x16x32_bf16 a[244:247], a[24:27], a[108:111], a[244:247]
s_add_u32 m0, s16, 0x8400
v_mfma_f32_16x16x32_bf16 a[240:243], a[20:23], a[108:111], 0
buffer_load_dwordx4 v3, s[48:51], 0 offen lds
v_mfma_f32_16x16x32_bf16 a[240:243], a[0:3], a[104:107], a[240:243]
s_waitcnt lgkmcnt(4)
L_S1:
v_mfma_f32_16x16x32_bf16 v[24:27], a[80:83], a[40:43], v[24:27]
ds_read_b64_tr_b16 a[104:105], v13 offset:256
v_mfma_f32_16x16x32_bf16 v[24:27], a[84:87], a[60:63], v[24:27]
ds_read_b64_tr_b16 a[106:107], v13 offset:1280
v_mfma_f32_16x16x32_bf16 v[32:35], a[84:87], a[64:67], v[32:35]
ds_read_b64_tr_b16 a[108:109], v13 offset:8448
s_add_u32 m0, s16, 0x8800
v_mfma_f32_16x16x32_bf16 v[32:35], a[80:83], a[44:47], v[32:35]
buffer_load_dwordx4 v2, s[48:51], s12 offen lds
v_mfma_f32_16x16x32_bf16 v[40:43], a[80:83], a[48:51], v[40:43]
ds_read_b64_tr_b16 a[110:111], v13 offset:9472
v_mfma_f32_16x16x32_bf16 v[40:43], a[84:87], a[68:71], v[40:43]
v_mfma_f32_16x16x32_bf16 v[48:51], a[84:87], a[72:75], v[48:51]
v_mfma_f32_16x16x32_bf16 v[48:51], a[80:83], a[52:55], v[48:51]
s_add_u32 m0, s16, 0x8c00
v_mfma_f32_16x16x32_bf16 v[52:55], a[88:91], a[52:55], v[52:55]
buffer_load_dwordx4 v3, s[48:51], s12 offen lds
v_mfma_f32_16x16x32_bf16 v[52:55], a[92:95], a[72:75], v[52:55]
ds_read_b64_tr_b16 a[80:81], v12 offset:512
v_mfma_f32_16x16x32_bf16 v[44:47], a[92:95], a[68:71], v[44:47]
ds_read_b64_tr_b16 a[82:83], v12 offset:1536
v_mfma_f32_16x16x32_bf16 v[44:47], a[88:91], a[48:51], v[44:47]
ds_read_b64_tr_b16 a[84:85], v12 offset:8704
v_mfma_f32_16x16x32_bf16 v[36:39], a[88:91], a[44:47], v[36:39]
ds_read_b64_tr_b16 a[86:87], v12 offset:9728
s_add_u32 m0, s16, 0x9000
v_mfma_f32_16x16x32_bf16 v[36:39], a[92:95], a[64:67], v[36:39]
buffer_load_dwordx4 v2, s[48:51], s13 offen lds
v_mfma_f32_16x16x32_bf16 v[28:31], a[92:95], a[60:63], v[28:31]
v_mfma_f32_16x16x32_bf16 v[28:31], a[88:91], a[40:43], v[28:31]
s_waitcnt lgkmcnt(4)
v_mfma_f32_16x16x32_bf16 v[56:59], a[96:99], a[40:43], v[56:59]
ds_read_b64_tr_b16 a[88:89], v13 offset:512
v_mfma_f32_16x16x32_bf16 v[56:59], a[100:103], a[60:63], v[56:59]
ds_read_b64_tr_b16 a[90:91], v13 offset:1536
s_add_u32 m0, s16, 0x9400
v_mfma_f32_16x16x32_bf16 v[64:67], a[100:103], a[64:67], v[64:67]
buffer_load_dwordx4 v3, s[48:51], s13 offen lds
v_mfma_f32_16x16x32_bf16 v[64:67], a[96:99], a[44:47], v[64:67]
ds_read_b64_tr_b16 a[92:93], v13 offset:8704
v_mfma_f32_16x16x32_bf16 v[72:75], a[96:99], a[48:51], v[72:75]
ds_read_b64_tr_b16 a[94:95], v13 offset:9728
v_mfma_f32_16x16x32_bf16 v[72:75], a[100:103], a[68:71], v[72:75]
v_mfma_f32_16x16x32_bf16 v[80:83], a[100:103], a[72:75], v[80:83]
s_add_u32 m0, s16, 0x9800
v_mfma_f32_16x16x32_bf16 v[80:83], a[96:99], a[52:55], v[80:83]
buffer_load_dwordx4 v2, s[48:51], s14 offen lds
v_mfma_f32_16x16x32_bf16 v[84:87], a[104:107], a[52:55], v[84:87]
ds_read_b64_tr_b16 a[96:97], v12 offset:768
v_mfma_f32_16x16x32_bf16 v[84:87], a[108:111], a[72:75], v[84:87]
ds_read_b64_tr_b16 a[98:99], v12 offset:1792
v_mfma_f32_16x16x32_bf16 v[76:79], a[108:111], a[68:71], v[76:79]
ds_read_b64_tr_b16 a[100:101], v12 offset:8960
v_mfma_f32_16x16x32_bf16 v[76:79], a[104:107], a[48:51], v[76:79]
ds_read_b64_tr_b16 a[102:103], v12 offset:9984
s_add_u32 m0, s16, 0x9c00
v_mfma_f32_16x16x32_bf16 v[68:71], a[104:107], a[44:47], v[68:71]
buffer_load_dwordx4 v3, s[48:51], s14 offen lds
v_mfma_f32_16x16x32_bf16 v[68:71], a[108:111], a[64:67], v[68:71]
v_add_u32 v2, 0x80, v2
v_add_u32 v3, 0x80, v3
v_mfma_f32_16x16x32_bf16 v[60:63], a[108:111], a[60:63], v[60:63]
v_mfma_f32_16x16x32_bf16 v[60:63], a[104:107], a[40:43], v[60:63]
s_add_u32 m0, s17, 0x0
s_waitcnt lgkmcnt(4)
v_mfma_f32_16x16x32_bf16 v[88:91], a[80:83], a[40:43], v[88:91]
ds_read_b64_tr_b16 a[104:105], v13 offset:768
s_waitcnt vmcnt(16)
v_mfma_f32_16x16x32_bf16 v[88:91], a[84:87], a[60:63], v[88:91]
buffer_load_dwordx4 v5, s[56:59], 0 offen lds
v_mfma_f32_16x16x32_bf16 v[96:99], a[84:87], a[64:67], v[96:99]
ds_read_b64_tr_b16 a[106:107], v13 offset:1792
v_mfma_f32_16x16x32_bf16 v[96:99], a[80:83], a[44:47], v[96:99]
ds_read_b64_tr_b16 a[108:109], v13 offset:8960
v_mfma_f32_16x16x32_bf16 v[104:107], a[80:83], a[48:51], v[104:107]
ds_read_b64_tr_b16 a[110:111], v13 offset:9984
v_mfma_f32_16x16x32_bf16 v[104:107], a[84:87], a[68:71], v[104:107]
ds_read_b128 a[0:3], v8 offset:0
s_add_u32 m0, s17, 0x4000
v_mfma_f32_16x16x32_bf16 v[112:115], a[84:87], a[72:75], v[112:115]
buffer_load_dwordx4 v5, s[60:63], 0 offen lds
v_mfma_f32_16x16x32_bf16 v[112:115], a[80:83], a[52:55], v[112:115]
ds_read_b128 a[20:23], v9 offset:0
v_mfma_f32_16x16x32_bf16 v[116:119], a[88:91], a[52:55], v[116:119]
ds_read_b64_tr_b16 a[80:81], v12 offset:16384
v_mfma_f32_16x16x32_bf16 v[116:119], a[92:95], a[72:75], v[116:119]
ds_read_b64_tr_b16 a[82:83], v12 offset:17408
v_mfma_f32_16x16x32_bf16 v[108:111], a[92:95], a[68:71], v[108:111]
ds_read_b64_tr_b16 a[84:85], v12 offset:24576
s_add_u32 m0, s17, 0x400
v_mfma_f32_16x16x32_bf16 v[108:111], a[88:91], a[48:51], v[108:111]
buffer_load_dwordx4 v5, s[56:59], s13 offen lds
v_mfma_f32_16x16x32_bf16 v[100:103], a[88:91], a[44:47], v[100:103]
ds_read_b64_tr_b16 a[86:87], v12 offset:25600
v_mfma_f32_16x16x32_bf16 v[100:103], a[92:95], a[64:67], v[100:103]
ds_read_b128 a[4:7], v8 offset:2048
v_mfma_f32_16x16x32_bf16 v[92:95], a[92:95], a[60:63], v[92:95]
ds_read_b128 a[24:27], v9 offset:2048
s_waitcnt lgkmcnt(8)
v_mfma_f32_16x16x32_bf16 v[92:95], a[88:91], a[40:43], v[92:95]
ds_read_b128 a[8:11], v8 offset:4096
s_add_u32 m0, s17, 0x4400
v_mfma_f32_16x16x32_bf16 v[120:123], a[96:99], a[40:43], v[120:123]
buffer_load_dwordx4 v5, s[60:63], s13 offen lds
v_mfma_f32_16x16x32_bf16 v[120:123], a[100:103], a[60:63], v[120:123]
ds_read_b64_tr_b16 a[88:89], v13 offset:16384
v_mfma_f32_16x16x32_bf16 v[128:131], a[100:103], a[64:67], v[128:131]
ds_read_b64_tr_b16 a[90:91], v13 offset:17408
v_mfma_f32_16x16x32_bf16 v[128:131], a[96:99], a[44:47], v[128:131]
ds_read_b64_tr_b16 a[92:93], v13 offset:24576
v_mfma_f32_16x16x32_bf16 v[136:139], a[96:99], a[48:51], v[136:139]
ds_read_b64_tr_b16 a[94:95], v13 offset:25600
s_add_u32 m0, s17, 0x800
v_mfma_f32_16x16x32_bf16 v[136:139], a[100:103], a[68:71], v[136:139]
buffer_load_dwordx4 v6, s[56:59], 0 offen lds
v_mfma_f32_16x16x32_bf16 v[144:147], a[100:103], a[72:75], v[144:147]
ds_read_b128 a[28:31], v9 offset:4096
v_mfma_f32_16x16x32_bf16 v[144:147], a[96:99], a[52:55], v[144:147]
ds_read_b128 a[12:15], v8 offset:6144
v_mfma_f32_16x16x32_bf16 v[148:151], a[104:107], a[52:55], v[148:151]
ds_read_b64_tr_b16 a[96:97], v12 offset:16640
v_mfma_f32_16x16x32_bf16 v[148:151], a[108:111], a[72:75], v[148:151]
ds_read_b64_tr_b16 a[98:99], v12 offset:17664
s_add_u32 m0, s17, 0x4800
v_mfma_f32_16x16x32_bf16 v[140:143], a[108:111], a[68:71], v[140:143]
buffer_load_dwordx4 v6, s[60:63], 0 offen lds
v_mfma_f32_16x16x32_bf16 v[140:143], a[104:107], a[48:51], v[140:143]
ds_read_b64_tr_b16 a[100:101], v12 offset:24832
v_mfma_f32_16x16x32_bf16 v[132:135], a[104:107], a[44:47], v[132:135]
ds_read_b64_tr_b16 a[102:103], v12 offset:25856
v_mfma_f32_16x16x32_bf16 v[132:135], a[108:111], a[64:67], v[132:135]
ds_read_b128 a[32:35], v9 offset:6144
v_mfma_f32_16x16x32_bf16 v[124:127], a[108:111], a[60:63], v[124:127]
s_add_u32 m0, s17, 0xc00
s_waitcnt lgkmcnt(7)
v_mfma_f32_16x16x32_bf16 v[124:127], a[104:107], a[40:43], v[124:127]
buffer_load_dwordx4 v6, s[56:59], s13 offen lds
v_mfma_f32_16x16x32_bf16 v[152:155], a[40:43], a[80:83], v[152:155]
ds_read_b64_tr_b16 a[104:105], v13 offset:16640
v_mfma_f32_16x16x32_bf16 v[152:155], a[60:63], a[84:87], v[152:155]
ds_read_b64_tr_b16 a[106:107], v13 offset:17664
v_mfma_f32_16x16x32_bf16 v[156:159], a[64:67], a[84:87], v[156:159]
ds_read_b64_tr_b16 a[108:109], v13 offset:24832
v_mfma_f32_16x16x32_bf16 v[156:159], a[44:47], a[80:83], v[156:159]
ds_read_b64_tr_b16 a[110:111], v13 offset:25856
s_add_u32 m0, s17, 0x4c00
v_mfma_f32_16x16x32_bf16 v[160:163], a[48:51], a[80:83], v[160:163]
buffer_load_dwordx4 v6, s[60:63], s13 offen lds
v_mfma_f32_16x16x32_bf16 v[160:163], a[68:71], a[84:87], v[160:163]
v_add_u32 v5, 0x80000, v5
v_add_u32 v6, 0x80000, v6
v_mfma_f32_16x16x32_bf16 v[164:167], a[72:75], a[84:87], v[164:167]
v_mfma_f32_16x16x32_bf16 v[164:167], a[52:55], a[80:83], v[164:167]
v_mfma_f32_16x16x32_bf16 v[180:183], a[52:55], a[88:91], v[180:183]
ds_read_b64_tr_b16 a[80:81], v12 offset:16896
s_mov_b32 s9, 0x200000
v_mfma_f32_16x16x32_bf16 v[180:183], a[72:75], a[92:95], v[180:183]
buffer_load_dword a120, v18, s[56:59], s9 offen
v_mfma_f32_16x16x32_bf16 v[176:179], a[68:71], a[92:95], v[176:179]
ds_read_b64_tr_b16 a[82:83], v12 offset:17920
v_mfma_f32_16x16x32_bf16 v[176:179], a[48:51], a[88:91], v[176:179]
ds_read_b64_tr_b16 a[84:85], v12 offset:25088
v_mfma_f32_16x16x32_bf16 v[172:175], a[44:47], a[88:91], v[172:175]
ds_read_b64_tr_b16 a[86:87], v12 offset:26112
v_mfma_f32_16x16x32_bf16 v[172:175], a[64:67], a[92:95], v[172:175]
s_add_u32 m0, s16, 0x0
s_waitcnt lgkmcnt(8)
v_mfma_f32_16x16x32_bf16 v[168:171], a[60:63], a[92:95], v[168:171]
buffer_load_dwordx4 v2, s[48:51], 0 offen lds
v_mfma_f32_16x16x32_bf16 v[168:171], a[40:43], a[88:91], v[168:171]
s_waitcnt lgkmcnt(4)
v_mfma_f32_16x16x32_bf16 v[184:187], a[40:43], a[96:99], v[184:187]
ds_read_b64_tr_b16 a[88:89], v13 offset:16896
v_mfma_f32_16x16x32_bf16 v[184:187], a[60:63], a[100:103], v[184:187]
ds_read_b64_tr_b16 a[90:91], v13 offset:17920
v_mfma_f32_16x16x32_bf16 v[188:191], a[64:67], a[100:103], v[188:191]
ds_read_b64_tr_b16 a[92:93], v13 offset:25088
s_add_u32 m0, s16, 0x400
v_mfma_f32_16x16x32_bf16 v[188:191], a[44:47], a[96:99], v[188:191]
buffer_load_dwordx4 v3, s[48:51], 0 offen lds
v_mfma_f32_16x16x32_bf16 v[192:195], a[48:51], a[96:99], v[192:195]
ds_read_b64_tr_b16 a[94:95], v13 offset:26112
v_mfma_f32_16x16x32_bf16 v[192:195], a[68:71], a[100:103], v[192:195]
v_mfma_f32_16x16x32_bf16 v[196:199], a[72:75], a[100:103], v[196:199]
v_mfma_f32_16x16x32_bf16 v[196:199], a[52:55], a[96:99], v[196:199]
s_add_u32 m0, s16, 0x800
v_mfma_f32_16x16x32_bf16 v[212:215], a[52:55], a[104:107], v[212:215]
buffer_load_dwordx4 v2, s[48:51], s12 offen lds
v_mfma_f32_16x16x32_bf16 v[212:215], a[72:75], a[108:111], v[212:215]
ds_read_b64_tr_b16 a[96:97], v12 offset:17152
v_mfma_f32_16x16x32_bf16 v[208:211], a[68:71], a[108:111], v[208:211]
ds_read_b64_tr_b16 a[98:99], v12 offset:18176
v_mfma_f32_16x16x32_bf16 v[208:211], a[48:51], a[104:107], v[208:211]
ds_read_b64_tr_b16 a[100:101], v12 offset:25344
v_mfma_f32_16x16x32_bf16 v[204:207], a[44:47], a[104:107], v[204:207]
ds_read_b64_tr_b16 a[102:103], v12 offset:26368
s_add_u32 m0, s16, 0xc00
v_mfma_f32_16x16x32_bf16 v[204:207], a[64:67], a[108:111], v[204:207]
buffer_load_dwordx4 v3, s[48:51], s12 offen lds
v_mfma_f32_16x16x32_bf16 v[200:203], a[60:63], a[108:111], v[200:203]
v_mfma_f32_16x16x32_bf16 v[200:203], a[40:43], a[104:107], v[200:203]
s_waitcnt lgkmcnt(4)
v_mfma_f32_16x16x32_bf16 v[248:251], a[40:43], a[80:83], v[248:251]
ds_read_b64_tr_b16 a[104:105], v13 offset:17152
v_mfma_f32_16x16x32_bf16 v[248:251], a[60:63], a[84:87], v[248:251]
ds_read_b64_tr_b16 a[106:107], v13 offset:18176
s_add_u32 m0, s16, 0x1000
v_mfma_f32_16x16x32_bf16 v[252:255], a[64:67], a[84:87], v[252:255]
buffer_load_dwordx4 v2, s[48:51], s13 offen lds
v_mfma_f32_16x16x32_bf16 v[252:255], a[44:47], a[80:83], v[252:255]
ds_read_b64_tr_b16 a[108:109], v13 offset:25344
v_mfma_f32_16x16x32_bf16 v[216:219], a[48:51], a[80:83], v[216:219]
ds_read_b64_tr_b16 a[110:111], v13 offset:26368
v_add_u32 v12, 0x8000, v12
v_mfma_f32_16x16x32_bf16 v[216:219], a[68:71], a[84:87], v[216:219]
v_add_u32 v13, 0x8000, v13
v_mfma_f32_16x16x32_bf16 v[220:223], a[72:75], a[84:87], v[220:223]
s_add_u32 m0, s16, 0x1400
v_mfma_f32_16x16x32_bf16 v[220:223], a[52:55], a[80:83], v[220:223]
buffer_load_dwordx4 v3, s[48:51], s13 offen lds
v_mfma_f32_16x16x32_bf16 v[236:239], a[52:55], a[88:91], v[236:239]
s_waitcnt vmcnt(23) lgkmcnt(0)
v_mfma_f32_16x16x32_bf16 v[236:239], a[72:75], a[92:95], v[236:239]
s_barrier
v_mfma_f32_16x16x32_bf16 v[232:235], a[68:71], a[92:95], v[232:235]
ds_read_b64_tr_b16 a[80:81], v12 offset:0
v_mfma_f32_16x16x32_bf16 v[232:235], a[48:51], a[88:91], v[232:235]
ds_read_b64_tr_b16 a[82:83], v12 offset:1024
s_add_u32 m0, s16, 0x1800
v_mfma_f32_16x16x32_bf16 v[228:231], a[44:47], a[88:91], v[228:231]
buffer_load_dwordx4 v2, s[48:51], s14 offen lds
v_mfma_f32_16x16x32_bf16 v[228:231], a[64:67], a[92:95], v[228:231]
ds_read_b64_tr_b16 a[84:85], v12 offset:8192
v_mfma_f32_16x16x32_bf16 v[224:227], a[60:63], a[92:95], v[224:227]
ds_read_b64_tr_b16 a[86:87], v12 offset:9216
v_mfma_f32_16x16x32_bf16 v[224:227], a[40:43], a[88:91], v[224:227]
L_padA1:
s_cmp_eq_u32 s95, 1
s_cbranch_scc1 L_padA5
s_waitcnt lgkmcnt(4)
v_mfma_f32_16x16x32_bf16 v[240:243], a[40:43], a[96:99], v[240:243]
ds_read_b64_tr_b16 a[88:89], v13 offset:0
s_add_u32 m0, s16, 0x1c00
v_mfma_f32_16x16x32_bf16 v[240:243], a[60:63], a[100:103], v[240:243]
buffer_load_dwordx4 v3, s[48:51], s14 offen lds
v_mfma_f32_16x16x32_bf16 v[244:247], a[64:67], a[100:103], v[244:247]
ds_read_b64_tr_b16 a[90:91], v13 offset:1024
v_add_u32 v2, 0x80, v2
v_mfma_f32_16x16x32_bf16 v[244:247], a[44:47], a[96:99], v[244:247]
ds_read_b64_tr_b16 a[92:93], v13 offset:8192
v_add_u32 v3, 0x80, v3
v_mfma_f32_16x16x32_bf16 a[232:235], a[48:51], a[96:99], a[232:235]
ds_read_b64_tr_b16 a[94:95], v13 offset:9216
v_mfma_f32_16x16x32_bf16 a[232:235], a[68:71], a[100:103], a[232:235]
s_mov_b32 s9, 0x200000
v_mfma_f32_16x16x32_bf16 a[236:239], a[72:75], a[100:103], a[236:239]
buffer_load_dword a120, v18, s[60:63], s9 offen
v_mfma_f32_16x16x32_bf16 a[236:239], a[52:55], a[96:99], a[236:239]
v_mfma_f32_16x16x32_bf16 a[252:255], a[52:55], a[104:107], a[252:255]
ds_read_b64_tr_b16 a[96:97], v12 offset:256
v_mfma_f32_16x16x32_bf16 a[252:255], a[72:75], a[108:111], a[252:255]
ds_read_b64_tr_b16 a[98:99], v12 offset:1280
v_mfma_f32_16x16x32_bf16 a[248:251], a[68:71], a[108:111], a[248:251]
ds_read_b64_tr_b16 a[100:101], v12 offset:8448
s_add_u32 m0, s17, 0x8000
v_mfma_f32_16x16x32_bf16 a[248:251], a[48:51], a[104:107], a[248:251]
buffer_load_dwordx4 v5, s[56:59], 0 offen lds
v_mfma_f32_16x16x32_bf16 a[244:247], a[44:47], a[104:107], a[244:247]
ds_read_b64_tr_b16 a[102:103], v12 offset:9472
v_mfma_f32_16x16x32_bf16 a[244:247], a[64:67], a[108:111], a[244:247]
v_mfma_f32_16x16x32_bf16 a[240:243], a[60:63], a[108:111], a[240:243]
v_mfma_f32_16x16x32_bf16 a[240:243], a[40:43], a[104:107], a[240:243]
s_add_u32 m0, s17, 0xc000
s_waitcnt lgkmcnt(4)
L_S2:
v_mfma_f32_16x16x32_bf16 v[24:27], a[80:83], a[0:3], v[24:27]
buffer_load_dwordx4 v5, s[60:63], 0 offen lds
v_mfma_f32_16x16x32_bf16 v[24:27], a[84:87], a[20:23], v[24:27]
ds_read_b64_tr_b16 a[104:105], v13 offset:256
s_waitcnt vmcnt(20)
v_mfma_f32_16x16x32_bf16 v[32:35], a[84:87], a[24:27], v[32:35]
ds_read_b64_tr_b16 a[106:107], v13 offset:1280
v_mfma_f32_16x16x32_bf16 v[32:35], a[80:83], a[4:7], v[32:35]
ds_read_b64_tr_b16 a[108:109], v13 offset:8448
v_mfma_f32_16x16x32_bf16 v[40:43], a[80:83], a[8:11], v[40:43]
ds_read_b64_tr_b16 a[110:111], v13 offset:9472
s_add_u32 m0, s17, 0x8400
v_mfma_f32_16x16x32_bf16 v[40:43], a[84:87], a[28:31], v[40:43]
buffer_load_dwordx4 v5, s[56:59], s13 offen lds
v_mfma_f32_16x16x32_bf16 v[48:51], a[84:87], a[32:35], v[48:51]
ds_read_b128 a[40:43], v8 offset:32768
v_mfma_f32_16x16x32_bf16 v[48:51], a[80:83], a[12:15], v[48:51]
ds_read_b128 a[60:63], v9 offset:32768
v_mfma_f32_16x16x32_bf16 v[52:55], a[88:91], a[12:15], v[52:55]
ds_read_b64_tr_b16 a[80:81], v12 offset:512
v_mfma_f32_16x16x32_bf16 v[52:55], a[92:95], a[32:35], v[52:55]
ds_read_b64_tr_b16 a[82:83], v12 offset:1536
s_add_u32 m0, s17, 0xc400
v_mfma_f32_16x16x32_bf16 v[44:47], a[92:95], a[28:31], v[44:47]
buffer_load_dwordx4 v5, s[60:63], s13 offen lds
v_mfma_f32_16x16x32_bf16 v[44:47], a[88:91], a[8:11], v[44:47]
ds_read_b64_tr_b16 a[84:85], v12 offset:8704
v_mfma_f32_16x16x32_bf16 v[36:39], a[88:91], a[4:7], v[36:39]
ds_read_b64_tr_b16 a[86:87], v12 offset:9728
v_mfma_f32_16x16x32_bf16 v[36:39], a[92:95], a[24:27], v[36:39]
ds_read_b128 a[44:47], v8 offset:34816
s_waitcnt lgkmcnt(7)
v_mfma_f32_16x16x32_bf16 v[28:31], a[92:95], a[20:23], v[28:31]
ds_read_b128 a[64:67], v9 offset:34816
s_add_u32 m0, s17, 0x8800
v_mfma_f32_16x16x32_bf16 v[28:31], a[88:91], a[0:3], v[28:31]
buffer_load_dwordx4 v6, s[56:59], 0 offen lds
v_mfma_f32_16x16x32_bf16 v[56:59], a[96:99], a[0:3], v[56:59]
ds_read_b64_tr_b16 a[88:89], v13 offset:512
v_mfma_f32_16x16x32_bf16 v[56:59], a[100:103], a[20:23], v[56:59]
ds_read_b64_tr_b16 a[90:91], v13 offset:1536
v_mfma_f32_16x16x32_bf16 v[64:67], a[100:103], a[24:27], v[64:67]
ds_read_b64_tr_b16 a[92:93], v13 offset:8704
v_mfma_f32_16x16x32_bf16 v[64:67], a[96:99], a[4:7], v[64:67]
ds_read_b64_tr_b16 a[94:95], v13 offset:9728
s_add_u32 m0, s17, 0xc800
v_mfma_f32_16x16x32_bf16 v[72:75], a[96:99], a[8:11], v[72:75]
buffer_load_dwordx4 v6, s[60:63], 0 offen lds
v_mfma_f32_16x16x32_bf16 v[72:75], a[100:103], a[28:31], v[72:75]
ds_read_b128 a[48:51], v8 offset:36864
v_mfma_f32_16x16x32_bf16 v[80:83], a[100:103], a[32:35], v[80:83]
ds_read_b128 a[68:71], v9 offset:36864
v_mfma_f32_16x16x32_bf16 v[80:83], a[96:99], a[12:15], v[80:83]
ds_read_b128 a[52:55], v8 offset:38912
v_mfma_f32_16x16x32_bf16 v[84:87], a[104:107], a[12:15], v[84:87]
ds_read_b64_tr_b16 a[96:97], v12 offset:768
s_add_u32 m0, s17, 0x8c00
v_mfma_f32_16x16x32_bf16 v[84:87], a[108:111], a[32:35], v[84:87]
buffer_load_dwordx4 v6, s[56:59], s13 offen lds
v_mfma_f32_16x16x32_bf16 v[76:79], a[108:111], a[28:31], v[76:79]
ds_read_b64_tr_b16 a[98:99], v12 offset:1792
v_mfma_f32_16x16x32_bf16 v[76:79], a[104:107], a[8:11], v[76:79]
ds_read_b64_tr_b16 a[100:101], v12 offset:8960
v_mfma_f32_16x16x32_bf16 v[68:71], a[104:107], a[4:7], v[68:71]
ds_read_b64_tr_b16 a[102:103], v12 offset:9984
v_mfma_f32_16x16x32_bf16 v[68:71], a[108:111], a[24:27], v[68:71]
ds_read_b128 a[72:75], v9 offset:38912
s_add_u32 m0, s17, 0xcc00
v_mfma_f32_16x16x32_bf16 v[60:63], a[108:111], a[20:23], v[60:63]
buffer_load_dwordx4 v6, s[60:63], s13 offen lds
v_mfma_f32_16x16x32_bf16 v[60:63], a[104:107], a[0:3], v[60:63]
s_waitcnt lgkmcnt(8)
v_add_u32 v5, 0x80000, v5
v_add_u32 v6, 0x80000, v6
v_mfma_f32_16x16x32_bf16 v[88:91], a[80:83], a[0:3], v[88:91]
ds_read_b64_tr_b16 a[104:105], v13 offset:768
v_mfma_f32_16x16x32_bf16 v[88:91], a[84:87], a[20:23], v[88:91]
ds_read_b64_tr_b16 a[106:107], v13 offset:1792
v_mfma_f32_16x16x32_bf16 v[96:99], a[84:87], a[24:27], v[96:99]
ds_read_b64_tr_b16 a[108:109], v13 offset:8960
v_mfma_f32_16x16x32_bf16 v[96:99], a[80:83], a[4:7], v[96:99]
ds_read_b64_tr_b16 a[110:111], v13 offset:9984
v_mfma_f32_16x16x32_bf16 v[104:107], a[80:83], a[8:11], v[104:107]
s_add_u32 m0, s16, 0x8000
s_waitcnt lgkmcnt(4)
v_mfma_f32_16x16x32_bf16 v[104:107], a[84:87], a[28:31], v[104:107]
buffer_load_dwordx4 v2, s[48:51], 0 offen lds
v_mfma_f32_16x16x32_bf16 v[112:115], a[84:87], a[32:35], v[112:115]
v_mfma_f32_16x16x32_bf16 v[112:115], a[80:83], a[12:15], v[112:115]
v_mfma_f32_16x16x32_bf16 v[116:119], a[88:91], a[12:15], v[116:119]
ds_read_b64_tr_b16 a[80:81], v12 offset:16384
v_mfma_f32_16x16x32_bf16 v[116:119], a[92:95], a[32:35], v[116:119]
ds_read_b64_tr_b16 a[82:83], v12 offset:17408
v_mfma_f32_16x16x32_bf16 v[108:111], a[92:95], a[28:31], v[108:111]
ds_read_b64_tr_b16 a[84:85], v12 offset:24576
v_mfma_f32_16x16x32_bf16 v[108:111], a[88:91], a[8:11], v[108:111]
ds_read_b64_tr_b16 a[86:87], v12 offset:25600
s_add_u32 m0, s16, 0x8400
v_mfma_f32_16x16x32_bf16 v[100:103], a[88:91], a[4:7], v[100:103]
buffer_load_dwordx4 v3, s[48:51], 0 offen lds
v_mfma_f32_16x16x32_bf16 v[100:103], a[92:95], a[24:27], v[100:103]
v_mfma_f32_16x16x32_bf16 v[92:95], a[92:95], a[20:23], v[92:95]
v_mfma_f32_16x16x32_bf16 v[92:95], a[88:91], a[0:3], v[92:95]
s_waitcnt lgkmcnt(4)
v_mfma_f32_16x16x32_bf16 v[120:123], a[96:99], a[0:3], v[120:123]
ds_read_b64_tr_b16 a[88:89], v13 offset:16384
v_mfma_f32_16x16x32_bf16 v[120:123], a[100:103], a[20:23], v[120:123]
ds_read_b64_tr_b16 a[90:91], v13 offset:17408
v_mfma_f32_16x16x32_bf16 v[128:131], a[100:103], a[24:27], v[128:131]
ds_read_b64_tr_b16 a[92:93], v13 offset:24576
v_mfma_f32_16x16x32_bf16 v[128:131], a[96:99], a[4:7], v[128:131]
ds_read_b64_tr_b16 a[94:95], v13 offset:25600
s_add_u32 m0, s16, 0x8800
v_mfma_f32_16x16x32_bf16 v[136:139], a[96:99], a[8:11], v[136:139]
buffer_load_dwordx4 v2, s[48:51], s12 offen lds
v_mfma_f32_16x16x32_bf16 v[136:139], a[100:103], a[28:31], v[136:139]
v_mfma_f32_16x16x32_bf16 v[144:147], a[100:103], a[32:35], v[144:147]
v_mfma_f32_16x16x32_bf16 v[144:147], a[96:99], a[12:15], v[144:147]
v_mfma_f32_16x16x32_bf16 v[148:151], a[104:107], a[12:15], v[148:151]
ds_read_b64_tr_b16 a[96:97], v12 offset:16640
v_mfma_f32_16x16x32_bf16 v[148:151], a[108:111], a[32:35], v[148:151]
ds_read_b64_tr_b16 a[98:99], v12 offset:17664
v_mfma_f32_16x16x32_bf16 v[140:143], a[108:111], a[28:31], v[140:143]
ds_read_b64_tr_b16 a[100:101], v12 offset:24832
s_add_u32 m0, s16, 0x8c00
v_mfma_f32_16x16x32_bf16 v[140:143], a[104:107], a[8:11], v[140:143]
buffer_load_dwordx4 v3, s[48:51], s12 offen lds
v_mfma_f32_16x16x32_bf16 v[132:135], a[104:107], a[4:7], v[132:135]
ds_read_b64_tr_b16 a[102:103], v12 offset:25856
v_mfma_f32_16x16x32_bf16 v[132:135], a[108:111], a[24:27], v[132:135]
v_mfma_f32_16x16x32_bf16 v[124:127], a[108:111], a[20:23], v[124:127]
v_mfma_f32_16x16x32_bf16 v[124:127], a[104:107], a[0:3], v[124:127]
s_waitcnt lgkmcnt(4)
v_mfma_f32_16x16x32_bf16 v[152:155], a[0:3], a[80:83], v[152:155]
ds_read_b64_tr_b16 a[104:105], v13 offset:16640
v_mfma_f32_16x16x32_bf16 v[152:155], a[20:23], a[84:87], v[152:155]
ds_read_b64_tr_b16 a[106:107], v13 offset:17664
s_add_u32 m0, s16, 0x9000
v_mfma_f32_16x16x32_bf16 v[156:159], a[24:27], a[84:87], v[156:159]
buffer_load_dwordx4 v2, s[48:51], s13 offen lds
v_mfma_f32_16x16x32_bf16 v[156:159], a[4:7], a[80:83], v[156:159]
ds_read_b64_tr_b16 a[108:109], v13 offset:24832
v_mfma_f32_16x16x32_bf16 v[160:163], a[8:11], a[80:83], v[160:163]
ds_read_b64_tr_b16 a[110:111], v13 offset:25856
v_mfma_f32_16x16x32_bf16 v[160:163], a[28:31], a[84:87], v[160:163]
v_mfma_f32_16x16x32_bf16 v[164:167], a[32:35], a[84:87], v[164:167]
v_mfma_f32_16x16x32_bf16 v[164:167], a[12:15], a[80:83], v[164:167]
v_mfma_f32_16x16x32_bf16 v[180:183], a[12:15], a[88:91], v[180:183]
ds_read_b64_tr_b16 a[80:81], v12 offset:16896
v_mfma_f32_16x16x32_bf16 v[180:183], a[32:35], a[92:95], v[180:183]
ds_read_b64_tr_b16 a[82:83], v12 offset:17920
s_add_u32 m0, s16, 0x9400
v_mfma_f32_16x16x32_bf16 v[176:179], a[28:31], a[92:95], v[176:179]
buffer_load_dwordx4 v3, s[48:51], s13 offen lds
v_mfma_f32_16x16x32_bf16 v[176:179], a[8:11], a[88:91], v[176:179]
ds_read_b64_tr_b16 a[84:85], v12 offset:25088
v_mfma_f32_16x16x32_bf16 v[172:175], a[4:7], a[88:91], v[172:175]
ds_read_b64_tr_b16 a[86:87], v12 offset:26112
v_mfma_f32_16x16x32_bf16 v[172:175], a[24:27], a[92:95], v[172:175]
v_mfma_f32_16x16x32_bf16 v[168:171], a[20:23], a[92:95], v[168:171]
v_mfma_f32_16x16x32_bf16 v[168:171], a[0:3], a[88:91], v[168:171]
s_waitcnt lgkmcnt(4)
v_mfma_f32_16x16x32_bf16 v[184:187], a[0:3], a[96:99], v[184:187]
ds_read_b64_tr_b16 a[88:89], v13 offset:16896
s_add_u32 m0, s16, 0x9800
v_mfma_f32_16x16x32_bf16 v[184:187], a[20:23], a[100:103], v[184:187]
buffer_load_dwordx4 v2, s[48:51], s14 offen lds
v_mfma_f32_16x16x32_bf16 v[188:191], a[24:27], a[100:103], v[188:191]
ds_read_b64_tr_b16 a[90:91], v13 offset:17920
v_mfma_f32_16x16x32_bf16 v[188:191], a[4:7], a[96:99], v[188:191]
ds_read_b64_tr_b16 a[92:93], v13 offset:25088
v_mfma_f32_16x16x32_bf16 v[192:195], a[8:11], a[96:99], v[192:195]
ds_read_b64_tr_b16 a[94:95], v13 offset:26112
v_mfma_f32_16x16x32_bf16 v[192:195], a[28:31], a[100:103], v[192:195]
v_mfma_f32_16x16x32_bf16 v[196:199], a[32:35], a[100:103], v[196:199]
v_mfma_f32_16x16x32_bf16 v[196:199], a[12:15], a[96:99], v[196:199]
v_mfma_f32_16x16x32_bf16 v[212:215], a[12:15], a[104:107], v[212:215]
ds_read_b64_tr_b16 a[96:97], v12 offset:17152
s_add_u32 m0, s16, 0x9c00
v_mfma_f32_16x16x32_bf16 v[212:215], a[32:35], a[108:111], v[212:215]
buffer_load_dwordx4 v3, s[48:51], s14 offen lds
v_mfma_f32_16x16x32_bf16 v[208:211], a[28:31], a[108:111], v[208:211]
ds_read_b64_tr_b16 a[98:99], v12 offset:18176
v_add_u32 v2, 0x80, v2
v_mfma_f32_16x16x32_bf16 v[208:211], a[8:11], a[104:107], v[208:211]
ds_read_b64_tr_b16 a[100:101], v12 offset:25344
v_add_u32 v3, 0x80, v3
v_mfma_f32_16x16x32_bf16 v[204:207], a[4:7], a[104:107], v[204:207]
ds_read_b64_tr_b16 a[102:103], v12 offset:26368
v_mfma_f32_16x16x32_bf16 v[204:207], a[24:27], a[108:111], v[204:207]
v_mfma_f32_16x16x32_bf16 v[200:203], a[20:23], a[108:111], v[200:203]
v_mfma_f32_16x16x32_bf16 v[200:203], a[0:3], a[104:107], v[200:203]
s_mov_b32 s9, 0x0
s_waitcnt lgkmcnt(4)
v_mfma_f32_16x16x32_bf16 v[248:251], a[0:3], a[80:83], v[248:251]
buffer_load_dword a120, v19, s[44:47], s9 offen
v_mfma_f32_16x16x32_bf16 v[248:251], a[20:23], a[84:87], v[248:251]
ds_read_b64_tr_b16 a[104:105], v13 offset:17152
v_mfma_f32_16x16x32_bf16 v[252:255], a[24:27], a[84:87], v[252:255]
ds_read_b64_tr_b16 a[106:107], v13 offset:18176
v_mfma_f32_16x16x32_bf16 v[252:255], a[4:7], a[80:83], v[252:255]
ds_read_b64_tr_b16 a[108:109], v13 offset:25344
v_mfma_f32_16x16x32_bf16 v[216:219], a[8:11], a[80:83], v[216:219]
ds_read_b64_tr_b16 a[110:111], v13 offset:26368
v_add_u32 v12, 0xffff0000, v12
v_mfma_f32_16x16x32_bf16 v[216:219], a[28:31], a[84:87], v[216:219]
v_add_u32 v13, 0xffff0000, v13
v_mfma_f32_16x16x32_bf16 v[220:223], a[32:35], a[84:87], v[220:223]
v_mfma_f32_16x16x32_bf16 v[220:223], a[12:15], a[80:83], v[220:223]
v_mfma_f32_16x16x32_bf16 v[236:239], a[12:15], a[88:91], v[236:239]
s_waitcnt vmcnt(27) lgkmcnt(0)
v_mfma_f32_16x16x32_bf16 v[236:239], a[32:35], a[92:95], v[236:239]
s_barrier
s_add_u32 m0, s17, 0x10000
v_mfma_f32_16x16x32_bf16 v[232:235], a[28:31], a[92:95], v[232:235]
buffer_load_dwordx4 v5, s[56:59], 0 offen lds
v_mfma_f32_16x16x32_bf16 v[232:235], a[8:11], a[88:91], v[232:235]
ds_read_b64_tr_b16 a[80:81], v12 offset:0
v_mfma_f32_16x16x32_bf16 v[228:231], a[4:7], a[88:91], v[228:231]
ds_read_b64_tr_b16 a[82:83], v12 offset:1024
v_mfma_f32_16x16x32_bf16 v[228:231], a[24:27], a[92:95], v[228:231]
ds_read_b64_tr_b16 a[84:85], v12 offset:8192
v_mfma_f32_16x16x32_bf16 v[224:227], a[20:23], a[92:95], v[224:227]
ds_read_b64_tr_b16 a[86:87], v12 offset:9216
v_mfma_f32_16x16x32_bf16 v[224:227], a[0:3], a[88:91], v[224:227]
s_waitcnt lgkmcnt(4)
v_mfma_f32_16x16x32_bf16 v[240:243], a[0:3], a[96:99], v[240:243]
ds_read_b64_tr_b16 a[88:89], v13 offset:0
s_add_u32 m0, s17, 0x14000
v_mfma_f32_16x16x32_bf16 v[240:243], a[20:23], a[100:103], v[240:243]
buffer_load_dwordx4 v5, s[60:63], 0 offen lds
v_mfma_f32_16x16x32_bf16 v[244:247], a[24:27], a[100:103], v[244:247]
ds_read_b64_tr_b16 a[90:91], v13 offset:1024
v_mfma_f32_16x16x32_bf16 v[244:247], a[4:7], a[96:99], v[244:247]
ds_read_b64_tr_b16 a[92:93], v13 offset:8192
v_mfma_f32_16x16x32_bf16 a[232:235], a[8:11], a[96:99], a[232:235]
ds_read_b64_tr_b16 a[94:95], v13 offset:9216
v_mfma_f32_16x16x32_bf16 a[232:235], a[28:31], a[100:103], a[232:235]
v_mfma_f32_16x16x32_bf16 a[236:239], a[32:35], a[100:103], a[236:239]
v_mfma_f32_16x16x32_bf16 a[236:239], a[12:15], a[96:99], a[236:239]
s_add_u32 m0, s17, 0x10400
v_mfma_f32_16x16x32_bf16 a[252:255], a[12:15], a[104:107], a[252:255]
buffer_load_dwordx4 v5, s[56:59], s13 offen lds
v_mfma_f32_16x16x32_bf16 a[252:255], a[32:35], a[108:111], a[252:255]
ds_read_b64_tr_b16 a[96:97], v12 offset:256
v_mfma_f32_16x16x32_bf16 a[248:251], a[28:31], a[108:111], a[248:251]
ds_read_b64_tr_b16 a[98:99], v12 offset:1280
v_mfma_f32_16x16x32_bf16 a[248:251], a[8:11], a[104:107], a[248:251]
ds_read_b64_tr_b16 a[100:101], v12 offset:8448
v_mfma_f32_16x16x32_bf16 a[244:247], a[4:7], a[104:107], a[244:247]
ds_read_b64_tr_b16 a[102:103], v12 offset:9472
v_mfma_f32_16x16x32_bf16 a[244:247], a[24:27], a[108:111], a[244:247]
v_mfma_f32_16x16x32_bf16 a[240:243], a[20:23], a[108:111], a[240:243]
s_add_u32 m0, s17, 0x14400
s_waitcnt lgkmcnt(4)
v_mfma_f32_16x16x32_bf16 a[240:243], a[0:3], a[104:107], a[240:243]
buffer_load_dwordx4 v5, s[60:63], s13 offen lds
L_S3:
v_mfma_f32_16x16x32_bf16 v[24:27], a[80:83], a[40:43], v[24:27]
ds_read_b64_tr_b16 a[104:105], v13 offset:256
s_waitcnt vmcnt(22)
v_mfma_f32_16x16x32_bf16 v[24:27], a[84:87], a[60:63], v[24:27]
ds_read_b64_tr_b16 a[106:107], v13 offset:1280
v_mfma_f32_16x16x32_bf16 v[32:35], a[84:87], a[64:67], v[32:35]
ds_read_b64_tr_b16 a[108:109], v13 offset:8448
v_mfma_f32_16x16x32_bf16 v[32:35], a[80:83], a[44:47], v[32:35]
ds_read_b64_tr_b16 a[110:111], v13 offset:9472
v_mfma_f32_16x16x32_bf16 v[40:43], a[80:83], a[48:51], v[40:43]
ds_read_b128 a[0:3], v8 offset:0
v_mfma_f32_16x16x32_bf16 v[40:43], a[84:87], a[68:71], v[40:43]
ds_read_b128 a[20:23], v9 offset:0
s_add_u32 m0, s17, 0x10800
v_mfma_f32_16x16x32_bf16 v[48:51], a[84:87], a[72:75], v[48:51]
buffer_load_dwordx4 v6, s[56:59], 0 offen lds
v_mfma_f32_16x16x32_bf16 v[48:51], a[80:83], a[52:55], v[48:51]
ds_read_b128 a[4:7], v8 offset:2048
v_mfma_f32_16x16x32_bf16 v[52:55], a[88:91], a[52:55], v[52:55]
ds_read_b64_tr_b16 a[80:81], v12 offset:512
v_mfma_f32_16x16x32_bf16 v[52:55], a[92:95], a[72:75], v[52:55]
ds_read_b64_tr_b16 a[82:83], v12 offset:1536
v_mfma_f32_16x16x32_bf16 v[44:47], a[92:95], a[68:71], v[44:47]
ds_read_b64_tr_b16 a[84:85], v12 offset:8704
v_mfma_f32_16x16x32_bf16 v[44:47], a[88:91], a[48:51], v[44:47]
ds_read_b64_tr_b16 a[86:87], v12 offset:9728
v_mfma_f32_16x16x32_bf16 v[36:39], a[88:91], a[44:47], v[36:39]
ds_read_b128 a[24:27], v9 offset:2048
s_add_u32 m0, s17, 0x14800
v_mfma_f32_16x16x32_bf16 v[36:39], a[92:95], a[64:67], v[36:39]
buffer_load_dwordx4 v6, s[60:63], 0 offen lds
v_mfma_f32_16x16x32_bf16 v[28:31], a[92:95], a[60:63], v[28:31]
ds_read_b128 a[8:11], v8 offset:4096
v_mfma_f32_16x16x32_bf16 v[28:31], a[88:91], a[40:43], v[28:31]
ds_read_b128 a[28:31], v9 offset:4096
s_waitcnt lgkmcnt(10)
v_mfma_f32_16x16x32_bf16 v[56:59], a[96:99], a[40:43], v[56:59]
ds_read_b64_tr_b16 a[88:89], v13 offset:512
v_mfma_f32_16x16x32_bf16 v[56:59], a[100:103], a[60:63], v[56:59]
ds_read_b64_tr_b16 a[90:91], v13 offset:1536
v_mfma_f32_16x16x32_bf16 v[64:67], a[100:103], a[64:67], v[64:67]
ds_read_b64_tr_b16 a[92:93], v13 offset:8704
v_mfma_f32_16x16x32_bf16 v[64:67], a[96:99], a[44:47], v[64:67]
ds_read_b64_tr_b16 a[94:95], v13 offset:9728
s_add_u32 m0, s17, 0x10c00
v_mfma_f32_16x16x32_bf16 v[72:75], a[96:99], a[48:51], v[72:75]
buffer_load_dwordx4 v6, s[56:59], s13 offen lds
v_mfma_f32_16x16x32_bf16 v[72:75], a[100:103], a[68:71], v[72:75]
ds_read_b128 a[12:15], v8 offset:6144
v_mfma_f32_16x16x32_bf16 v[80:83], a[100:103], a[72:75], v[80:83]
ds_read_b128 a[32:35], v9 offset:6144
v_mfma_f32_16x16x32_bf16 v[80:83], a[96:99], a[52:55], v[80:83]
v_mfma_f32_16x16x32_bf16 v[84:87], a[104:107], a[52:55], v[84:87]
ds_read_b64_tr_b16 a[96:97], v12 offset:768
v_mfma_f32_16x16x32_bf16 v[84:87], a[108:111], a[72:75], v[84:87]
ds_read_b64_tr_b16 a[98:99], v12 offset:1792
v_mfma_f32_16x16x32_bf16 v[76:79], a[108:111], a[68:71], v[76:79]
ds_read_b64_tr_b16 a[100:101], v12 offset:8960
s_add_u32 m0, s17, 0x14c00
v_mfma_f32_16x16x32_bf16 v[76:79], a[104:107], a[48:51], v[76:79]
buffer_load_dwordx4 v6, s[60:63], s13 offen lds
v_mfma_f32_16x16x32_bf16 v[68:71], a[104:107], a[44:47], v[68:71]
ds_read_b64_tr_b16 a[102:103], v12 offset:9984
v_add_u32 v5, 0x80000, v5
v_mfma_f32_16x16x32_bf16 v[68:71], a[108:111], a[64:67], v[68:71]
v_add_u32 v6, 0x80000, v6
v_mfma_f32_16x16x32_bf16 v[60:63], a[108:111], a[60:63], v[60:63]
v_mfma_f32_16x16x32_bf16 v[60:63], a[104:107], a[40:43], v[60:63]
s_waitcnt lgkmcnt(6)
v_mfma_f32_16x16x32_bf16 v[88:91], a[80:83], a[40:43], v[88:91]
ds_read_b64_tr_b16 a[104:105], v13 offset:768
v_mfma_f32_16x16x32_bf16 v[88:91], a[84:87], a[60:63], v[88:91]
ds_read_b64_tr_b16 a[106:107], v13 offset:1792
s_mov_b32 s9, 0x200000
v_mfma_f32_16x16x32_bf16 v[96:99], a[84:87], a[64:67], v[96:99]
buffer_load_dword a120, v19, s[44:47], s9 offen
v_mfma_f32_16x16x32_bf16 v[96:99], a[80:83], a[44:47], v[96:99]
ds_read_b64_tr_b16 a[108:109], v13 offset:8960
v_mfma_f32_16x16x32_bf16 v[104:107], a[80:83], a[48:51], v[104:107]
ds_read_b64_tr_b16 a[110:111], v13 offset:9984
v_mfma_f32_16x16x32_bf16 v[104:107], a[84:87], a[68:71], v[104:107]
v_mfma_f32_16x16x32_bf16 v[112:115], a[84:87], a[72:75], v[112:115]
v_mfma_f32_16x16x32_bf16 v[112:115], a[80:83], a[52:55], v[112:115]
s_waitcnt lgkmcnt(8)
v_mfma_f32_16x16x32_bf16 v[116:119], a[88:91], a[52:55], v[116:119]
ds_read_b64_tr_b16 a[80:81], v12 offset:16384
s_add_u32 m0, s16, 0x0
v_mfma_f32_16x16x32_bf16 v[116:119], a[92:95], a[72:75], v[116:119]
buffer_load_dwordx4 v2, s[48:51], 0 offen lds
v_mfma_f32_16x16x32_bf16 v[108:111], a[92:95], a[68:71], v[108:111]
ds_read_b64_tr_b16 a[82:83], v12 offset:17408
v_mfma_f32_16x16x32_bf16 v[108:111], a[88:91], a[48:51], v[108:111]
ds_read_b64_tr_b16 a[84:85], v12 offset:24576
v_mfma_f32_16x16x32_bf16 v[100:103], a[88:91], a[44:47], v[100:103]
ds_read_b64_tr_b16 a[86:87], v12 offset:25600
v_mfma_f32_16x16x32_bf16 v[100:103], a[92:95], a[64:67], v[100:103]
v_mfma_f32_16x16x32_bf16 v[92:95], a[92:95], a[60:63], v[92:95]
v_mfma_f32_16x16x32_bf16 v[92:95], a[88:91], a[40:43], v[92:95]
s_add_u32 m0, s16, 0x400
s_waitcnt lgkmcnt(4)
v_mfma_f32_16x16x32_bf16 v[120:123], a[96:99], a[40:43], v[120:123]
buffer_load_dwordx4 v3, s[48:51], 0 offen lds
v_mfma_f32_16x16x32_bf16 v[120:123], a[100:103], a[60:63], v[120:123]
ds_read_b64_tr_b16 a[88:89], v13 offset:16384
v_mfma_f32_16x16x32_bf16 v[128:131], a[100:103], a[64:67], v[128:131]
ds_read_b64_tr_b16 a[90:91], v13 offset:17408
v_mfma_f32_16x16x32_bf16 v[128:131], a[96:99], a[44:47], v[128:131]
ds_read_b64_tr_b16 a[92:93], v13 offset:24576
v_mfma_f32_16x16x32_bf16 v[136:139], a[96:99], a[48:51], v[136:139]
ds_read_b64_tr_b16 a[94:95], v13 offset:25600
v_mfma_f32_16x16x32_bf16 v[136:139], a[100:103], a[68:71], v[136:139]
v_mfma_f32_16x16x32_bf16 v[144:147], a[100:103], a[72:75], v[144:147]
s_add_u32 m0, s16, 0x800
v_mfma_f32_16x16x32_bf16 v[144:147], a[96:99], a[52:55], v[144:147]
buffer_load_dwordx4 v2, s[48:51], s12 offen lds
v_mfma_f32_16x16x32_bf16 v[148:151], a[104:107], a[52:55], v[148:151]
ds_read_b64_tr_b16 a[96:97], v12 offset:16640
v_mfma_f32_16x16x32_bf16 v[148:151], a[108:111], a[72:75], v[148:151]
ds_read_b64_tr_b16 a[98:99], v12 offset:17664
v_mfma_f32_16x16x32_bf16 v[140:143], a[108:111], a[68:71], v[140:143]
ds_read_b64_tr_b16 a[100:101], v12 offset:24832
v_mfma_f32_16x16x32_bf16 v[140:143], a[104:107], a[48:51], v[140:143]
ds_read_b64_tr_b16 a[102:103], v12 offset:25856
v_mfma_f32_16x16x32_bf16 v[132:135], a[104:107], a[44:47], v[132:135]
v_mfma_f32_16x16x32_bf16 v[132:135], a[108:111], a[64:67], v[132:135]
s_add_u32 m0, s16, 0xc00
v_mfma_f32_16x16x32_bf16 v[124:127], a[108:111], a[60:63], v[124:127]
buffer_load_dwordx4 v3, s[48:51], s12 offen lds
v_mfma_f32_16x16x32_bf16 v[124:127], a[104:107], a[40:43], v[124:127]
s_waitcnt lgkmcnt(4)
v_mfma_f32_16x16x32_bf16 v[152:155], a[40:43], a[80:83], v[152:155]
ds_read_b64_tr_b16 a[104:105], v13 offset:16640
v_mfma_f32_16x16x32_bf16 v[152:155], a[60:63], a[84:87], v[152:155]
ds_read_b64_tr_b16 a[106:107], v13 offset:17664
v_mfma_f32_16x16x32_bf16 v[156:159], a[64:67], a[84:87], v[156:159]
ds_read_b64_tr_b16 a[108:109], v13 offset:24832
v_mfma_f32_16x16x32_bf16 v[156:159], a[44:47], a[80:83], v[156:159]
ds_read_b64_tr_b16 a[110:111], v13 offset:25856
v_mfma_f32_16x16x32_bf16 v[160:163], a[48:51], a[80:83], v[160:163]
s_add_u32 m0, s16, 0x1000
v_mfma_f32_16x16x32_bf16 v[160:163], a[68:71], a[84:87], v[160:163]
buffer_load_dwordx4 v2, s[48:51], s13 offen lds
v_mfma_f32_16x16x32_bf16 v[164:167], a[72:75], a[84:87], v[164:167]
v_mfma_f32_16x16x32_bf16 v[164:167], a[52:55], a[80:83], v[164:167]
v_mfma_f32_16x16x32_bf16 v[180:183], a[52:55], a[88:91], v[180:183]
ds_read_b64_tr_b16 a[80:81], v12 offset:16896
v_mfma_f32_16x16x32_bf16 v[180:183], a[72:75], a[92:95], v[180:183]
ds_read_b64_tr_b16 a[82:83], v12 offset:17920
v_mfma_f32_16x16x32_bf16 v[176:179], a[68:71], a[92:95], v[176:179]
ds_read_b64_tr_b16 a[84:85], v12 offset:25088
v_mfma_f32_16x16x32_bf16 v[176:179], a[48:51], a[88:91], v[176:179]
ds_read_b64_tr_b16 a[86:87], v12 offset:26112
s_add_u32 m0, s16, 0x1400
v_mfma_f32_16x16x32_bf16 v[172:175], a[44:47], a[88:91], v[172:175]
buffer_load_dwordx4 v3, s[48:51], s13 offen lds
v_mfma_f32_16x16x32_bf16 v[172:175], a[64:67], a[92:95], v[172:175]
v_mfma_f32_16x16x32_bf16 v[168:171], a[60:63], a[92:95], v[168:171]
v_mfma_f32_16x16x32_bf16 v[168:171], a[40:43], a[88:91], v[168:171]
s_waitcnt lgkmcnt(4)
v_mfma_f32_16x16x32_bf16 v[184:187], a[40:43], a[96:99], v[184:187]
ds_read_b64_tr_b16 a[88:89], v13 offset:16896
v_mfma_f32_16x16x32_bf16 v[184:187], a[60:63], a[100:103], v[184:187]
ds_read_b64_tr_b16 a[90:91], v13 offset:17920
v_mfma_f32_16x16x32_bf16 v[188:191], a[64:67], a[100:103], v[188:191]
ds_read_b64_tr_b16 a[92:93], v13 offset:25088
s_add_u32 m0, s16, 0x1800
v_mfma_f32_16x16x32_bf16 v[188:191], a[44:47], a[96:99], v[188:191]
buffer_load_dwordx4 v2, s[48:51], s14 offen lds
v_mfma_f32_16x16x32_bf16 v[192:195], a[48:51], a[96:99], v[192:195]
ds_read_b64_tr_b16 a[94:95], v13 offset:26112
v_mfma_f32_16x16x32_bf16 v[192:195], a[68:71], a[100:103], v[192:195]
v_mfma_f32_16x16x32_bf16 v[196:199], a[72:75], a[100:103], v[196:199]
v_mfma_f32_16x16x32_bf16 v[196:199], a[52:55], a[96:99], v[196:199]
v_mfma_f32_16x16x32_bf16 v[212:215], a[52:55], a[104:107], v[212:215]
ds_read_b64_tr_b16 a[96:97], v12 offset:17152
v_mfma_f32_16x16x32_bf16 v[212:215], a[72:75], a[108:111], v[212:215]
ds_read_b64_tr_b16 a[98:99], v12 offset:18176
s_add_u32 m0, s16, 0x1c00
v_mfma_f32_16x16x32_bf16 v[208:211], a[68:71], a[108:111], v[208:211]
buffer_load_dwordx4 v3, s[48:51], s14 offen lds
v_mfma_f32_16x16x32_bf16 v[208:211], a[48:51], a[104:107], v[208:211]
ds_read_b64_tr_b16 a[100:101], v12 offset:25344
v_add_u32 v2, 0x80, v2
v_mfma_f32_16x16x32_bf16 v[204:207], a[44:47], a[104:107], v[204:207]
ds_read_b64_tr_b16 a[102:103], v12 offset:26368
v_add_u32 v3, 0x80, v3
v_mfma_f32_16x16x32_bf16 v[204:207], a[64:67], a[108:111], v[204:207]
v_mfma_f32_16x16x32_bf16 v[200:203], a[60:63], a[108:111], v[200:203]
v_mfma_f32_16x16x32_bf16 v[200:203], a[40:43], a[104:107], v[200:203]
s_waitcnt lgkmcnt(4)
v_mfma_f32_16x16x32_bf16 v[248:251], a[40:43], a[80:83], v[248:251]
ds_read_b64_tr_b16 a[104:105], v13 offset:17152
s_mov_b32 s9, 0x0
v_mfma_f32_16x16x32_bf16 v[248:251], a[60:63], a[84:87], v[248:251]
buffer_load_dword a120, v18, s[52:55], s9 offen
v_mfma_f32_16x16x32_bf16 v[252:255], a[64:67], a[84:87], v[252:255]
ds_read_b64_tr_b16 a[106:107], v13 offset:18176
v_mfma_f32_16x16x32_bf16 v[252:255], a[44:47], a[80:83], v[252:255]
ds_read_b64_tr_b16 a[108:109], v13 offset:25344
v_mfma_f32_16x16x32_bf16 v[216:219], a[48:51], a[80:83], v[216:219]
ds_read_b64_tr_b16 a[110:111], v13 offset:26368
v_add_u32 v12, 0x8000, v12
v_mfma_f32_16x16x32_bf16 v[216:219], a[68:71], a[84:87], v[216:219]
v_add_u32 v13, 0x8000, v13
v_mfma_f32_16x16x32_bf16 v[220:223], a[72:75], a[84:87], v[220:223]
v_mfma_f32_16x16x32_bf16 v[220:223], a[52:55], a[80:83], v[220:223]
v_mfma_f32_16x16x32_bf16 v[236:239], a[52:55], a[88:91], v[236:239]
s_waitcnt vmcnt(27) lgkmcnt(0)
v_mfma_f32_16x16x32_bf16 v[236:239], a[72:75], a[92:95], v[236:239]
s_barrier
s_add_u32 m0, s17, 0x0
v_mfma_f32_16x16x32_bf16 v[232:235], a[68:71], a[92:95], v[232:235]
buffer_load_dwordx4 v5, s[56:59], 0 offen lds
v_mfma_f32_16x16x32_bf16 v[232:235], a[48:51], a[88:91], v[232:235]
ds_read_b64_tr_b16 a[80:81], v12 offset:0
v_mfma_f32_16x16x32_bf16 v[228:231], a[44:47], a[88:91], v[228:231]
ds_read_b64_tr_b16 a[82:83], v12 offset:1024
v_mfma_f32_16x16x32_bf16 v[228:231], a[64:67], a[92:95], v[228:231]
ds_read_b64_tr_b16 a[84:85], v12 offset:8192
v_mfma_f32_16x16x32_bf16 v[224:227], a[60:63], a[92:95], v[224:227]
ds_read_b64_tr_b16 a[86:87], v12 offset:9216
v_mfma_f32_16x16x32_bf16 v[224:227], a[40:43], a[88:91], v[224:227]
s_waitcnt lgkmcnt(4)
v_mfma_f32_16x16x32_bf16 v[240:243], a[40:43], a[96:99], v[240:243]
ds_read_b64_tr_b16 a[88:89], v13 offset:0
s_add_u32 m0, s17, 0x4000
v_mfma_f32_16x16x32_bf16 v[240:243], a[60:63], a[100:103], v[240:243]
buffer_load_dwordx4 v5, s[60:63], 0 offen lds
v_mfma_f32_16x16x32_bf16 v[244:247], a[64:67], a[100:103], v[244:247]
ds_read_b64_tr_b16 a[90:91], v13 offset:1024
v_mfma_f32_16x16x32_bf16 v[244:247], a[44:47], a[96:99], v[244:247]
ds_read_b64_tr_b16 a[92:93], v13 offset:8192
v_mfma_f32_16x16x32_bf16 a[232:235], a[48:51], a[96:99], a[232:235]
ds_read_b64_tr_b16 a[94:95], v13 offset:9216
v_mfma_f32_16x16x32_bf16 a[232:235], a[68:71], a[100:103], a[232:235]
L_padA2:
s_cmp_eq_u32 s95, 1
s_cbranch_scc1 L_padA6
v_mfma_f32_16x16x32_bf16 a[236:239], a[72:75], a[100:103], a[236:239]
v_mfma_f32_16x16x32_bf16 a[236:239], a[52:55], a[96:99], a[236:239]
s_add_u32 m0, s17, 0x400
v_mfma_f32_16x16x32_bf16 a[252:255], a[52:55], a[104:107], a[252:255]
buffer_load_dwordx4 v5, s[56:59], s13 offen lds
v_mfma_f32_16x16x32_bf16 a[252:255], a[72:75], a[108:111], a[252:255]
ds_read_b64_tr_b16 a[96:97], v12 offset:256
v_mfma_f32_16x16x32_bf16 a[248:251], a[68:71], a[108:111], a[248:251]
ds_read_b64_tr_b16 a[98:99], v12 offset:1280
v_mfma_f32_16x16x32_bf16 a[248:251], a[48:51], a[104:107], a[248:251]
ds_read_b64_tr_b16 a[100:101], v12 offset:8448
v_mfma_f32_16x16x32_bf16 a[244:247], a[44:47], a[104:107], a[244:247]
ds_read_b64_tr_b16 a[102:103], v12 offset:9472
v_mfma_f32_16x16x32_bf16 a[244:247], a[64:67], a[108:111], a[244:247]
v_mfma_f32_16x16x32_bf16 a[240:243], a[60:63], a[108:111], a[240:243]
v_mfma_f32_16x16x32_bf16 a[240:243], a[40:43], a[104:107], a[240:243]
s_add_u32 m0, s17, 0x4400
s_waitcnt lgkmcnt(4)
L_S4:
v_mfma_f32_16x16x32_bf16 v[24:27], a[80:83], a[0:3], v[24:27]
buffer_load_dwordx4 v5, s[60:63], s13 offen lds
v_mfma_f32_16x16x32_bf16 v[24:27], a[84:87], a[20:23], v[24:27]
ds_read_b64_tr_b16 a[104:105], v13 offset:256
s_waitcnt vmcnt(23)
v_mfma_f32_16x16x32_bf16 v[32:35], a[84:87], a[24:27], v[32:35]
ds_read_b64_tr_b16 a[106:107], v13 offset:1280
v_mfma_f32_16x16x32_bf16 v[32:35], a[80:83], a[4:7], v[32:35]
ds_read_b64_tr_b16 a[108:109], v13 offset:8448
v_mfma_f32_16x16x32_bf16 v[40:43], a[80:83], a[8:11], v[40:43]
ds_read_b64_tr_b16 a[110:111], v13 offset:9472
v_mfma_f32_16x16x32_bf16 v[40:43], a[84:87], a[28:31], v[40:43]
ds_read_b128 a[40:43], v8 offset:32768
v_mfma_f32_16x16x32_bf16 v[48:51], a[84:87], a[32:35], v[48:51]
ds_read_b128 a[60:63], v9 offset:32768
s_add_u32 m0, s17, 0x800
v_mfma_f32_16x16x32_bf16 v[48:51], a[80:83], a[12:15], v[48:51]
buffer_load_dwordx4 v6, s[56:59], 0 offen lds
v_mfma_f32_16x16x32_bf16 v[52:55], a[88:91], a[12:15], v[52:55]
ds_read_b64_tr_b16 a[80:81], v12 offset:512
v_mfma_f32_16x16x32_bf16 v[52:55], a[92:95], a[32:35], v[52:55]
ds_read_b64_tr_b16 a[82:83], v12 offset:1536
v_mfma_f32_16x16x32_bf16 v[44:47], a[92:95], a[28:31], v[44:47]
ds_read_b64_tr_b16 a[84:85], v12 offset:8704
v_mfma_f32_16x16x32_bf16 v[44:47], a[88:91], a[8:11], v[44:47]
ds_read_b64_tr_b16 a[86:87], v12 offset:9728
v_mfma_f32_16x16x32_bf16 v[36:39], a[88:91], a[4:7], v[36:39]
ds_read_b128 a[44:47], v8 offset:34816
v_mfma_f32_16x16x32_bf16 v[36:39], a[92:95], a[24:27], v[36:39]
ds_read_b128 a[64:67], v9 offset:34816
s_waitcnt lgkmcnt(8)
v_mfma_f32_16x16x32_bf16 v[28:31], a[92:95], a[20:23], v[28:31]
ds_read_b128 a[48:51], v8 offset:36864
s_add_u32 m0, s17, 0x4800
v_mfma_f32_16x16x32_bf16 v[28:31], a[88:91], a[0:3], v[28:31]
buffer_load_dwordx4 v6, s[60:63], 0 offen lds
v_mfma_f32_16x16x32_bf16 v[56:59], a[96:99], a[0:3], v[56:59]
ds_read_b64_tr_b16 a[88:89], v13 offset:512
v_mfma_f32_16x16x32_bf16 v[56:59], a[100:103], a[20:23], v[56:59]
ds_read_b64_tr_b16 a[90:91], v13 offset:1536
v_mfma_f32_16x16x32_bf16 v[64:67], a[100:103], a[24:27], v[64:67]
ds_read_b64_tr_b16 a[92:93], v13 offset:8704
v_mfma_f32_16x16x32_bf16 v[64:67], a[96:99], a[4:7], v[64:67]
ds_read_b64_tr_b16 a[94:95], v13 offset:9728
v_mfma_f32_16x16x32_bf16 v[72:75], a[96:99], a[8:11], v[72:75]
ds_read_b128 a[68:71], v9 offset:36864
v_mfma_f32_16x16x32_bf16 v[72:75], a[100:103], a[28:31], v[72:75]
ds_read_b128 a[52:55], v8 offset:38912
s_add_u32 m0, s17, 0xc00
v_mfma_f32_16x16x32_bf16 v[80:83], a[100:103], a[32:35], v[80:83]
buffer_load_dwordx4 v6, s[56:59], s13 offen lds
v_mfma_f32_16x16x32_bf16 v[80:83], a[96:99], a[12:15], v[80:83]
ds_read_b128 a[72:75], v9 offset:38912
v_mfma_f32_16x16x32_bf16 v[84:87], a[104:107], a[12:15], v[84:87]
ds_read_b64_tr_b16 a[96:97], v12 offset:768
v_mfma_f32_16x16x32_bf16 v[84:87], a[108:111], a[32:35], v[84:87]
ds_read_b64_tr_b16 a[98:99], v12 offset:1792
v_mfma_f32_16x16x32_bf16 v[76:79], a[108:111], a[28:31], v[76:79]
ds_read_b64_tr_b16 a[100:101], v12 offset:8960
v_mfma_f32_16x16x32_bf16 v[76:79], a[104:107], a[8:11], v[76:79]
ds_read_b64_tr_b16 a[102:103], v12 offset:9984
v_mfma_f32_16x16x32_bf16 v[68:71], a[104:107], a[4:7], v[68:71]
s_add_u32 m0, s17, 0x4c00
v_mfma_f32_16x16x32_bf16 v[68:71], a[108:111], a[24:27], v[68:71]
buffer_load_dwordx4 v6, s[60:63], s13 offen lds
v_mfma_f32_16x16x32_bf16 v[60:63], a[108:111], a[20:23], v[60:63]
v_add_u32 v5, 0x80000, v5
v_add_u32 v6, 0x80000, v6
v_mfma_f32_16x16x32_bf16 v[60:63], a[104:107], a[0:3], v[60:63]
s_waitcnt lgkmcnt(7)
v_mfma_f32_16x16x32_bf16 v[88:91], a[80:83], a[0:3], v[88:91]
ds_read_b64_tr_b16 a[104:105], v13 offset:768
v_mfma_f32_16x16x32_bf16 v[88:91], a[84:87], a[20:23], v[88:91]
ds_read_b64_tr_b16 a[106:107], v13 offset:1792
v_mfma_f32_16x16x32_bf16 v[96:99], a[84:87], a[24:27], v[96:99]
ds_read_b64_tr_b16 a[108:109], v13 offset:8960
v_mfma_f32_16x16x32_bf16 v[96:99], a[80:83], a[4:7], v[96:99]
ds_read_b64_tr_b16 a[110:111], v13 offset:9984
v_mfma_f32_16x16x32_bf16 v[104:107], a[80:83], a[8:11], v[104:107]
s_add_u32 m0, s16, 0x8000
s_waitcnt lgkmcnt(8)
v_mfma_f32_16x16x32_bf16 v[104:107], a[84:87], a[28:31], v[104:107]
buffer_load_dwordx4 v2, s[48:51], 0 offen lds
v_mfma_f32_16x16x32_bf16 v[112:115], a[84:87], a[32:35], v[112:115]
v_mfma_f32_16x16x32_bf16 v[112:115], a[80:83], a[12:15], v[112:115]
v_mfma_f32_16x16x32_bf16 v[116:119], a[88:91], a[12:15], v[116:119]
ds_read_b64_tr_b16 a[80:81], v12 offset:16384
v_mfma_f32_16x16x32_bf16 v[116:119], a[92:95], a[32:35], v[116:119]
ds_read_b64_tr_b16 a[82:83], v12 offset:17408
v_mfma_f32_16x16x32_bf16 v[108:111], a[92:95], a[28:31], v[108:111]
ds_read_b64_tr_b16 a[84:85], v12 offset:24576
v_mfma_f32_16x16x32_bf16 v[108:111], a[88:91], a[8:11], v[108:111]
ds_read_b64_tr_b16 a[86:87], v12 offset:25600
s_add_u32 m0, s16, 0x8400
v_mfma_f32_16x16x32_bf16 v[100:103], a[88:91], a[4:7], v[100:103]
buffer_load_dwordx4 v3, s[48:51], 0 offen lds
v_mfma_f32_16x16x32_bf16 v[100:103], a[92:95], a[24:27], v[100:103]
v_mfma_f32_16x16x32_bf16 v[92:95], a[92:95], a[20:23], v[92:95]
v_mfma_f32_16x16x32_bf16 v[92:95], a[88:91], a[0:3], v[92:95]
s_waitcnt lgkmcnt(4)
v_mfma_f32_16x16x32_bf16 v[120:123], a[96:99], a[0:3], v[120:123]
ds_read_b64_tr_b16 a[88:89], v13 offset:16384
v_mfma_f32_16x16x32_bf16 v[120:123], a[100:103], a[20:23], v[120:123]
ds_read_b64_tr_b16 a[90:91], v13 offset:17408
v_mfma_f32_16x16x32_bf16 v[128:131], a[100:103], a[24:27], v[128:131]
ds_read_b64_tr_b16 a[92:93], v13 offset:24576
v_mfma_f32_16x16x32_bf16 v[128:131], a[96:99], a[4:7], v[128:131]
ds_read_b64_tr_b16 a[94:95], v13 offset:25600
s_add_u32 m0, s16, 0x8800
v_mfma_f32_16x16x32_bf16 v[136:139], a[96:99], a[8:11], v[136:139]
buffer_load_dwordx4 v2, s[48:51], s12 offen lds
v_mfma_f32_16x16x32_bf16 v[136:139], a[100:103], a[28:31], v[136:139]
v_mfma_f32_16x16x32_bf16 v[144:147], a[100:103], a[32:35], v[144:147]
v_mfma_f32_16x16x32_bf16 v[144:147], a[96:99], a[12:15], v[144:147]
v_mfma_f32_16x16x32_bf16 v[148:151], a[104:107], a[12:15], v[148:151]
ds_read_b64_tr_b16 a[96:97], v12 offset:16640
v_mfma_f32_16x16x32_bf16 v[148:151], a[108:111], a[32:35], v[148:151]
ds_read_b64_tr_b16 a[98:99], v12 offset:17664
v_mfma_f32_16x16x32_bf16 v[140:143], a[108:111], a[28:31], v[140:143]
ds_read_b64_tr_b16 a[100:101], v12 offset:24832
s_add_u32 m0, s16, 0x8c00
v_mfma_f32_16x16x32_bf16 v[140:143], a[104:107], a[8:11], v[140:143]
buffer_load_dwordx4 v3, s[48:51], s12 offen lds
v_mfma_f32_16x16x32_bf16 v[132:135], a[104:107], a[4:7], v[132:135]
ds_read_b64_tr_b16 a[102:103], v12 offset:25856
v_mfma_f32_16x16x32_bf16 v[132:135], a[108:111], a[24:27], v[132:135]
v_mfma_f32_16x16x32_bf16 v[124:127], a[108:111], a[20:23], v[124:127]
v_mfma_f32_16x16x32_bf16 v[124:127], a[104:107], a[0:3], v[124:127]
s_waitcnt lgkmcnt(4)
v_mfma_f32_16x16x32_bf16 v[152:155], a[0:3], a[80:83], v[152:155]
ds_read_b64_tr_b16 a[104:105], v13 offset:16640
v_mfma_f32_16x16x32_bf16 v[152:155], a[20:23], a[84:87], v[152:155]
ds_read_b64_tr_b16 a[106:107], v13 offset:17664
s_add_u32 m0, s16, 0x9000
v_mfma_f32_16x16x32_bf16 v[156:159], a[24:27], a[84:87], v[156:159]
buffer_load_dwordx4 v2, s[48:51], s13 offen lds
v_mfma_f32_16x16x32_bf16 v[156:159], a[4:7], a[80:83], v[156:159]
ds_read_b64_tr_b16 a[108:109], v13 offset:24832
v_mfma_f32_16x16x32_bf16 v[160:163], a[8:11], a[80:83], v[160:163]
ds_read_b64_tr_b16 a[110:111], v13 offset:25856
v_mfma_f32_16x16x32_bf16 v[160:163], a[28:31], a[84:87], v[160:163]
v_mfma_f32_16x16x32_bf16 v[164:167], a[32:35], a[84:87], v[164:167]
v_mfma_f32_16x16x32_bf16 v[164:167], a[12:15], a[80:83], v[164:167]
v_mfma_f32_16x16x32_bf16 v[180:183], a[12:15], a[88:91], v[180:183]
ds_read_b64_tr_b16 a[80:81], v12 offset:16896
v_mfma_f32_16x16x32_bf16 v[180:183], a[32:35], a[92:95], v[180:183]
ds_read_b64_tr_b16 a[82:83], v12 offset:17920
s_add_u32 m0, s16, 0x9400
v_mfma_f32_16x16x32_bf16 v[176:179], a[28:31], a[92:95], v[176:179]
buffer_load_dwordx4 v3, s[48:51], s13 offen lds
v_mfma_f32_16x16x32_bf16 v[176:179], a[8:11], a[88:91], v[176:179]
ds_read_b64_tr_b16 a[84:85], v12 offset:25088
v_mfma_f32_16x16x32_bf16 v[172:175], a[4:7], a[88:91], v[172:175]
ds_read_b64_tr_b16 a[86:87], v12 offset:26112
v_mfma_f32_16x16x32_bf16 v[172:175], a[24:27], a[92:95], v[172:175]
v_mfma_f32_16x16x32_bf16 v[168:171], a[20:23], a[92:95], v[168:171]
v_mfma_f32_16x16x32_bf16 v[168:171], a[0:3], a[88:91], v[168:171]
s_waitcnt lgkmcnt(4)
v_mfma_f32_16x16x32_bf16 v[184:187], a[0:3], a[96:99], v[184:187]
ds_read_b64_tr_b16 a[88:89], v13 offset:16896
s_add_u32 m0, s16, 0x9800
v_mfma_f32_16x16x32_bf16 v[184:187], a[20:23], a[100:103], v[184:187]
buffer_load_dwordx4 v2, s[48:51], s14 offen lds
v_mfma_f32_16x16x32_bf16 v[188:191], a[24:27], a[100:103], v[188:191]
ds_read_b64_tr_b16 a[90:91], v13 offset:17920
v_mfma_f32_16x16x32_bf16 v[188:191], a[4:7], a[96:99], v[188:191]
ds_read_b64_tr_b16 a[92:93], v13 offset:25088
v_mfma_f32_16x16x32_bf16 v[192:195], a[8:11], a[96:99], v[192:195]
ds_read_b64_tr_b16 a[94:95], v13 offset:26112
v_mfma_f32_16x16x32_bf16 v[192:195], a[28:31], a[100:103], v[192:195]
v_mfma_f32_16x16x32_bf16 v[196:199], a[32:35], a[100:103], v[196:199]
v_mfma_f32_16x16x32_bf16 v[196:199], a[12:15], a[96:99], v[196:199]
v_mfma_f32_16x16x32_bf16 v[212:215], a[12:15], a[104:107], v[212:215]
ds_read_b64_tr_b16 a[96:97], v12 offset:17152
s_add_u32 m0, s16, 0x9c00
v_mfma_f32_16x16x32_bf16 v[212:215], a[32:35], a[108:111], v[212:215]
buffer_load_dwordx4 v3, s[48:51], s14 offen lds
v_mfma_f32_16x16x32_bf16 v[208:211], a[28:31], a[108:111], v[208:211]
ds_read_b64_tr_b16 a[98:99], v12 offset:18176
v_add_u32 v2, 0x80, v2
v_mfma_f32_16x16x32_bf16 v[208:211], a[8:11], a[104:107], v[208:211]
ds_read_b64_tr_b16 a[100:101], v12 offset:25344
v_add_u32 v3, 0x80, v3
v_mfma_f32_16x16x32_bf16 v[204:207], a[4:7], a[104:107], v[204:207]
ds_read_b64_tr_b16 a[102:103], v12 offset:26368
v_mfma_f32_16x16x32_bf16 v[204:207], a[24:27], a[108:111], v[204:207]
v_mfma_f32_16x16x32_bf16 v[200:203], a[20:23], a[108:111], v[200:203]
v_mfma_f32_16x16x32_bf16 v[200:203], a[0:3], a[104:107], v[200:203]
s_mov_b32 s9, 0x0
s_waitcnt lgkmcnt(4)
v_mfma_f32_16x16x32_bf16 v[248:251], a[0:3], a[80:83], v[248:251]
buffer_load_dword a120, v19, s[68:71], s9 offen
v_mfma_f32_16x16x32_bf16 v[248:251], a[20:23], a[84:87], v[248:251]
ds_read_b64_tr_b16 a[104:105], v13 offset:17152
v_mfma_f32_16x16x32_bf16 v[252:255], a[24:27], a[84:87], v[252:255]
ds_read_b64_tr_b16 a[106:107], v13 offset:18176
v_mfma_f32_16x16x32_bf16 v[252:255], a[4:7], a[80:83], v[252:255]
ds_read_b64_tr_b16 a[108:109], v13 offset:25344
v_mfma_f32_16x16x32_bf16 v[216:219], a[8:11], a[80:83], v[216:219]
ds_read_b64_tr_b16 a[110:111], v13 offset:26368
v_add_u32 v12, 0x8000, v12
v_mfma_f32_16x16x32_bf16 v[216:219], a[28:31], a[84:87], v[216:219]
v_add_u32 v13, 0x8000, v13
v_mfma_f32_16x16x32_bf16 v[220:223], a[32:35], a[84:87], v[220:223]
v_mfma_f32_16x16x32_bf16 v[220:223], a[12:15], a[80:83], v[220:223]
v_mfma_f32_16x16x32_bf16 v[236:239], a[12:15], a[88:91], v[236:239]
s_waitcnt vmcnt(27) lgkmcnt(0)
v_mfma_f32_16x16x32_bf16 v[236:239], a[32:35], a[92:95], v[236:239]
s_barrier
s_add_u32 m0, s17, 0x8000
v_mfma_f32_16x16x32_bf16 v[232:235], a[28:31], a[92:95], v[232:235]
buffer_load_dwordx4 v5, s[56:59], 0 offen lds
v_mfma_f32_16x16x32_bf16 v[232:235], a[8:11], a[88:91], v[232:235]
ds_read_b64_tr_b16 a[80:81], v12 offset:0
v_mfma_f32_16x16x32_bf16 v[228:231], a[4:7], a[88:91], v[228:231]
ds_read_b64_tr_b16 a[82:83], v12 offset:1024
v_mfma_f32_16x16x32_bf16 v[228:231], a[24:27], a[92:95], v[228:231]
ds_read_b64_tr_b16 a[84:85], v12 offset:8192
v_mfma_f32_16x16x32_bf16 v[224:227], a[20:23], a[92:95], v[224:227]
ds_read_b64_tr_b16 a[86:87], v12 offset:9216
v_mfma_f32_16x16x32_bf16 v[224:227], a[0:3], a[88:91], v[224:227]
s_add_u32 m0, s17, 0xc000
s_waitcnt lgkmcnt(4)
v_mfma_f32_16x16x32_bf16 v[240:243], a[0:3], a[96:99], v[240:243]
buffer_load_dwordx4 v5, s[60:63], 0 offen lds
v_mfma_f32_16x16x32_bf16 v[240:243], a[20:23], a[100:103], v[240:243]
ds_read_b64_tr_b16 a[88:89], v13 offset:0
v_mfma_f32_16x16x32_bf16 v[244:247], a[24:27], a[100:103], v[244:247]
ds_read_b64_tr_b16 a[90:91], v13 offset:1024
v_mfma_f32_16x16x32_bf16 v[244:247], a[4:7], a[96:99], v[244:247]
ds_read_b64_tr_b16 a[92:93], v13 offset:8192
v_mfma_f32_16x16x32_bf16 a[232:235], a[8:11], a[96:99], a[232:235]
ds_read_b64_tr_b16 a[94:95], v13 offset:9216
v_mfma_f32_16x16x32_bf16 a[232:235], a[28:31], a[100:103], a[232:235]
v_mfma_f32_16x16x32_bf16 a[236:239], a[32:35], a[100:103], a[236:239]
s_add_u32 m0, s17, 0x8400
v_mfma_f32_16x16x32_bf16 a[236:239], a[12:15], a[96:99], a[236:239]
buffer_load_dwordx4 v5, s[56:59], s13 offen lds
v_mfma_f32_16x16x32_bf16 a[252:255], a[12:15], a[104:107], a[252:255]
ds_read_b64_tr_b16 a[96:97], v12 offset:256
v_mfma_f32_16x16x32_bf16 a[252:255], a[32:35], a[108:111], a[252:255]
ds_read_b64_tr_b16 a[98:99], v12 offset:1280
v_mfma_f32_16x16x32_bf16 a[248:251], a[28:31], a[108:111], a[248:251]
ds_read_b64_tr_b16 a[100:101], v12 offset:8448
v_mfma_f32_16x16x32_bf16 a[248:251], a[8:11], a[104:107], a[248:251]
ds_read_b64_tr_b16 a[102:103], v12 offset:9472
v_mfma_f32_16x16x32_bf16 a[244:247], a[4:7], a[104:107], a[244:247]
s_add_u32 m0, s17, 0xc400
v_mfma_f32_16x16x32_bf16 a[244:247], a[24:27], a[108:111], a[244:247]
buffer_load_dwordx4 v5, s[60:63], s13 offen lds
v_mfma_f32_16x16x32_bf16 a[240:243], a[20:23], a[108:111], a[240:243]
v_mfma_f32_16x16x32_bf16 a[240:243], a[0:3], a[104:107], a[240:243]
s_waitcnt lgkmcnt(4)
L_S5:
v_mfma_f32_16x16x32_bf16 v[24:27], a[80:83], a[40:43], v[24:27]
ds_read_b64_tr_b16 a[104:105], v13 offset:256
s_waitcnt vmcnt(22)
v_mfma_f32_16x16x32_bf16 v[24:27], a[84:87], a[60:63], v[24:27]
ds_read_b64_tr_b16 a[106:107], v13 offset:1280
v_mfma_f32_16x16x32_bf16 v[32:35], a[84:87], a[64:67], v[32:35]
ds_read_b64_tr_b16 a[108:109], v13 offset:8448
v_mfma_f32_16x16x32_bf16 v[32:35], a[80:83], a[44:47], v[32:35]
ds_read_b64_tr_b16 a[110:111], v13 offset:9472
s_add_u32 m0, s17, 0x8800
v_mfma_f32_16x16x32_bf16 v[40:43], a[80:83], a[48:51], v[40:43]
buffer_load_dwordx4 v6, s[56:59], 0 offen lds
v_mfma_f32_16x16x32_bf16 v[40:43], a[84:87], a[68:71], v[40:43]
ds_read_b128 a[0:3], v8 offset:0
v_mfma_f32_16x16x32_bf16 v[48:51], a[84:87], a[72:75], v[48:51]
ds_read_b128 a[20:23], v9 offset:0
v_mfma_f32_16x16x32_bf16 v[48:51], a[80:83], a[52:55], v[48:51]
ds_read_b128 a[4:7], v8 offset:2048
v_mfma_f32_16x16x32_bf16 v[52:55], a[88:91], a[52:55], v[52:55]
ds_read_b64_tr_b16 a[80:81], v12 offset:512
v_mfma_f32_16x16x32_bf16 v[52:55], a[92:95], a[72:75], v[52:55]
ds_read_b64_tr_b16 a[82:83], v12 offset:1536
v_mfma_f32_16x16x32_bf16 v[44:47], a[92:95], a[68:71], v[44:47]
ds_read_b64_tr_b16 a[84:85], v12 offset:8704
s_mov_b32 s9, 0x200000
v_mfma_f32_16x16x32_bf16 v[44:47], a[88:91], a[48:51], v[44:47]
buffer_load_dword a120, v18, s[52:55], s9 offen
v_mfma_f32_16x16x32_bf16 v[36:39], a[88:91], a[44:47], v[36:39]
ds_read_b64_tr_b16 a[86:87], v12 offset:9728
v_mfma_f32_16x16x32_bf16 v[36:39], a[92:95], a[64:67], v[36:39]
ds_read_b128 a[24:27], v9 offset:2048
v_mfma_f32_16x16x32_bf16 v[28:31], a[92:95], a[60:63], v[28:31]
ds_read_b128 a[8:11], v8 offset:4096
v_mfma_f32_16x16x32_bf16 v[28:31], a[88:91], a[40:43], v[28:31]
ds_read_b128 a[28:31], v9 offset:4096
s_waitcnt lgkmcnt(10)
v_mfma_f32_16x16x32_bf16 v[56:59], a[96:99], a[40:43], v[56:59]
ds_read_b64_tr_b16 a[88:89], v13 offset:512
s_add_u32 m0, s17, 0xc800
v_mfma_f32_16x16x32_bf16 v[56:59], a[100:103], a[60:63], v[56:59]
buffer_load_dwordx4 v6, s[60:63], 0 offen lds
v_mfma_f32_16x16x32_bf16 v[64:67], a[100:103], a[64:67], v[64:67]
ds_read_b64_tr_b16 a[90:91], v13 offset:1536
v_mfma_f32_16x16x32_bf16 v[64:67], a[96:99], a[44:47], v[64:67]
ds_read_b64_tr_b16 a[92:93], v13 offset:8704
v_mfma_f32_16x16x32_bf16 v[72:75], a[96:99], a[48:51], v[72:75]
ds_read_b64_tr_b16 a[94:95], v13 offset:9728
v_mfma_f32_16x16x32_bf16 v[72:75], a[100:103], a[68:71], v[72:75]
ds_read_b128 a[12:15], v8 offset:6144
v_mfma_f32_16x16x32_bf16 v[80:83], a[100:103], a[72:75], v[80:83]
ds_read_b128 a[32:35], v9 offset:6144
v_mfma_f32_16x16x32_bf16 v[80:83], a[96:99], a[52:55], v[80:83]
s_add_u32 m0, s17, 0x8c00
v_mfma_f32_16x16x32_bf16 v[84:87], a[104:107], a[52:55], v[84:87]
buffer_load_dwordx4 v6, s[56:59], s13 offen lds
v_mfma_f32_16x16x32_bf16 v[84:87], a[108:111], a[72:75], v[84:87]
ds_read_b64_tr_b16 a[96:97], v12 offset:768
v_mfma_f32_16x16x32_bf16 v[76:79], a[108:111], a[68:71], v[76:79]
ds_read_b64_tr_b16 a[98:99], v12 offset:1792
v_mfma_f32_16x16x32_bf16 v[76:79], a[104:107], a[48:51], v[76:79]
ds_read_b64_tr_b16 a[100:101], v12 offset:8960
v_mfma_f32_16x16x32_bf16 v[68:71], a[104:107], a[44:47], v[68:71]
ds_read_b64_tr_b16 a[102:103], v12 offset:9984
v_mfma_f32_16x16x32_bf16 v[68:71], a[108:111], a[64:67], v[68:71]
v_mfma_f32_16x16x32_bf16 v[60:63], a[108:111], a[60:63], v[60:63]
s_add_u32 m0, s17, 0xcc00
s_waitcnt lgkmcnt(6)
v_mfma_f32_16x16x32_bf16 v[60:63], a[104:107], a[40:43], v[60:63]
buffer_load_dwordx4 v6, s[60:63], s13 offen lds
v_mfma_f32_16x16x32_bf16 v[88:91], a[80:83], a[40:43], v[88:91]
ds_read_b64_tr_b16 a[104:105], v13 offset:768
v_add_u32 v5, 0xffc80000, v5
v_mfma_f32_16x16x32_bf16 v[88:91], a[84:87], a[60:63], v[88:91]
ds_read_b64_tr_b16 a[106:107], v13 offset:1792
v_add_u32 v6, 0xffc80000, v6
v_mfma_f32_16x16x32_bf16 v[96:99], a[84:87], a[64:67], v[96:99]
ds_read_b64_tr_b16 a[108:109], v13 offset:8960
v_mfma_f32_16x16x32_bf16 v[96:99], a[80:83], a[44:47], v[96:99]
ds_read_b64_tr_b16 a[110:111], v13 offset:9984
v_mfma_f32_16x16x32_bf16 v[104:107], a[80:83], a[48:51], v[104:107]
s_add_u32 m0, s16, 0x0
s_waitcnt lgkmcnt(8)
v_mfma_f32_16x16x32_bf16 v[104:107], a[84:87], a[68:71], v[104:107]
buffer_load_dwordx4 v22, s[44:47], s20 offen lds
v_mfma_f32_16x16x32_bf16 v[112:115], a[84:87], a[72:75], v[112:115]
v_mfma_f32_16x16x32_bf16 v[112:115], a[80:83], a[52:55], v[112:115]
v_mfma_f32_16x16x32_bf16 v[116:119], a[88:91], a[52:55], v[116:119]
ds_read_b64_tr_b16 a[80:81], v12 offset:16384
v_mfma_f32_16x16x32_bf16 v[116:119], a[92:95], a[72:75], v[116:119]
ds_read_b64_tr_b16 a[82:83], v12 offset:17408
v_mfma_f32_16x16x32_bf16 v[108:111], a[92:95], a[68:71], v[108:111]
ds_read_b64_tr_b16 a[84:85], v12 offset:24576
v_mfma_f32_16x16x32_bf16 v[108:111], a[88:91], a[48:51], v[108:111]
ds_read_b64_tr_b16 a[86:87], v12 offset:25600
s_add_u32 m0, s16, 0x400
v_mfma_f32_16x16x32_bf16 v[100:103], a[88:91], a[44:47], v[100:103]
buffer_load_dwordx4 v23, s[44:47], s20 offen lds
v_mfma_f32_16x16x32_bf16 v[100:103], a[92:95], a[64:67], v[100:103]
v_mfma_f32_16x16x32_bf16 v[92:95], a[92:95], a[60:63], v[92:95]
v_mfma_f32_16x16x32_bf16 v[92:95], a[88:91], a[40:43], v[92:95]
s_waitcnt lgkmcnt(4)
v_mfma_f32_16x16x32_bf16 v[120:123], a[96:99], a[40:43], v[120:123]
ds_read_b64_tr_b16 a[88:89], v13 offset:16384
v_mfma_f32_16x16x32_bf16 v[120:123], a[100:103], a[60:63], v[120:123]
ds_read_b64_tr_b16 a[90:91], v13 offset:17408
s_mov_b32 s9, 0x200000
v_mfma_f32_16x16x32_bf16 v[128:131], a[100:103], a[64:67], v[128:131]
buffer_load_dword a120, v19, s[68:71], s9 offen
v_mfma_f32_16x16x32_bf16 v[128:131], a[96:99], a[44:47], v[128:131]
ds_read_b64_tr_b16 a[92:93], v13 offset:24576
v_mfma_f32_16x16x32_bf16 v[136:139], a[96:99], a[48:51], v[136:139]
ds_read_b64_tr_b16 a[94:95], v13 offset:25600
v_mfma_f32_16x16x32_bf16 v[136:139], a[100:103], a[68:71], v[136:139]
v_mfma_f32_16x16x32_bf16 v[144:147], a[100:103], a[72:75], v[144:147]
v_mfma_f32_16x16x32_bf16 v[144:147], a[96:99], a[52:55], v[144:147]
v_mfma_f32_16x16x32_bf16 v[148:151], a[104:107], a[52:55], v[148:151]
ds_read_b64_tr_b16 a[96:97], v12 offset:16640
s_add_u32 m0, s16, 0x800
v_mfma_f32_16x16x32_bf16 v[148:151], a[108:111], a[72:75], v[148:151]
buffer_load_dwordx4 v22, s[44:47], s21 offen lds
v_mfma_f32_16x16x32_bf16 v[140:143], a[108:111], a[68:71], v[140:143]
ds_read_b64_tr_b16 a[98:99], v12 offset:17664
v_mfma_f32_16x16x32_bf16 v[140:143], a[104:107], a[48:51], v[140:143]
ds_read_b64_tr_b16 a[100:101], v12 offset:24832
v_mfma_f32_16x16x32_bf16 v[132:135], a[104:107], a[44:47], v[132:135]
ds_read_b64_tr_b16 a[102:103], v12 offset:25856
v_mfma_f32_16x16x32_bf16 v[132:135], a[108:111], a[64:67], v[132:135]
v_mfma_f32_16x16x32_bf16 v[124:127], a[108:111], a[60:63], v[124:127]
v_mfma_f32_16x16x32_bf16 v[124:127], a[104:107], a[40:43], v[124:127]
s_add_u32 m0, s16, 0xc00
s_waitcnt lgkmcnt(4)
v_mfma_f32_16x16x32_bf16 v[152:155], a[40:43], a[80:83], v[152:155]
buffer_load_dwordx4 v23, s[44:47], s21 offen lds
v_mfma_f32_16x16x32_bf16 v[152:155], a[60:63], a[84:87], v[152:155]
ds_read_b64_tr_b16 a[104:105], v13 offset:16640
v_mfma_f32_16x16x32_bf16 v[156:159], a[64:67], a[84:87], v[156:159]
ds_read_b64_tr_b16 a[106:107], v13 offset:17664
v_mfma_f32_16x16x32_bf16 v[156:159], a[44:47], a[80:83], v[156:159]
ds_read_b64_tr_b16 a[108:109], v13 offset:24832
v_mfma_f32_16x16x32_bf16 v[160:163], a[48:51], a[80:83], v[160:163]
ds_read_b64_tr_b16 a[110:111], v13 offset:25856
v_mfma_f32_16x16x32_bf16 v[160:163], a[68:71], a[84:87], v[160:163]
s_add_u32 m0, s16, 0x1000
v_mfma_f32_16x16x32_bf16 v[164:167], a[72:75], a[84:87], v[164:167]
buffer_load_dwordx4 v22, s[44:47], s22 offen lds
v_mfma_f32_16x16x32_bf16 v[164:167], a[52:55], a[80:83], v[164:167]
v_mfma_f32_16x16x32_bf16 v[180:183], a[52:55], a[88:91], v[180:183]
ds_read_b64_tr_b16 a[80:81], v12 offset:16896
v_mfma_f32_16x16x32_bf16 v[180:183], a[72:75], a[92:95], v[180:183]
ds_read_b64_tr_b16 a[82:83], v12 offset:17920
v_mfma_f32_16x16x32_bf16 v[176:179], a[68:71], a[92:95], v[176:179]
ds_read_b64_tr_b16 a[84:85], v12 offset:25088
v_mfma_f32_16x16x32_bf16 v[176:179], a[48:51], a[88:91], v[176:179]
ds_read_b64_tr_b16 a[86:87], v12 offset:26112
v_mfma_f32_16x16x32_bf16 v[172:175], a[44:47], a[88:91], v[172:175]
s_add_u32 m0, s16, 0x1400
v_mfma_f32_16x16x32_bf16 v[172:175], a[64:67], a[92:95], v[172:175]
buffer_load_dwordx4 v23, s[44:47], s22 offen lds
v_mfma_f32_16x16x32_bf16 v[168:171], a[60:63], a[92:95], v[168:171]
v_mfma_f32_16x16x32_bf16 v[168:171], a[40:43], a[88:91], v[168:171]
s_waitcnt lgkmcnt(4)
v_mfma_f32_16x16x32_bf16 v[184:187], a[40:43], a[96:99], v[184:187]
ds_read_b64_tr_b16 a[88:89], v13 offset:16896
v_mfma_f32_16x16x32_bf16 v[184:187], a[60:63], a[100:103], v[184:187]
ds_read_b64_tr_b16 a[90:91], v13 offset:17920
v_mfma_f32_16x16x32_bf16 v[188:191], a[64:67], a[100:103], v[188:191]
ds_read_b64_tr_b16 a[92:93], v13 offset:25088
v_mfma_f32_16x16x32_bf16 v[188:191], a[44:47], a[96:99], v[188:191]
ds_read_b64_tr_b16 a[94:95], v13 offset:26112
s_add_u32 m0, s16, 0x1800
v_mfma_f32_16x16x32_bf16 v[192:195], a[48:51], a[96:99], v[192:195]
buffer_load_dwordx4 v22, s[44:47], s23 offen lds
v_mfma_f32_16x16x32_bf16 v[192:195], a[68:71], a[100:103], v[192:195]
v_mfma_f32_16x16x32_bf16 v[196:199], a[72:75], a[100:103], v[196:199]
v_mfma_f32_16x16x32_bf16 v[196:199], a[52:55], a[96:99], v[196:199]
v_mfma_f32_16x16x32_bf16 v[212:215], a[52:55], a[104:107], v[212:215]
ds_read_b64_tr_b16 a[96:97], v12 offset:17152
v_mfma_f32_16x16x32_bf16 v[212:215], a[72:75], a[108:111], v[212:215]
ds_read_b64_tr_b16 a[98:99], v12 offset:18176
s_add_u32 m0, s16, 0x1c00
v_mfma_f32_16x16x32_bf16 v[208:211], a[68:71], a[108:111], v[208:211]
buffer_load_dwordx4 v23, s[44:47], s23 offen lds
v_mfma_f32_16x16x32_bf16 v[208:211], a[48:51], a[104:107], v[208:211]
ds_read_b64_tr_b16 a[100:101], v12 offset:25344
v_add_u32 v22, 0x80, v22
v_mfma_f32_16x16x32_bf16 v[204:207], a[44:47], a[104:107], v[204:207]
ds_read_b64_tr_b16 a[102:103], v12 offset:26368
v_add_u32 v23, 0x80, v23
v_mfma_f32_16x16x32_bf16 v[204:207], a[64:67], a[108:111], v[204:207]
v_mfma_f32_16x16x32_bf16 v[200:203], a[60:63], a[108:111], v[200:203]
v_mfma_f32_16x16x32_bf16 v[200:203], a[40:43], a[104:107], v[200:203]
s_waitcnt lgkmcnt(4)
v_mov_b32 v21, s1
v_mfma_f32_16x16x32_bf16 v[248:251], a[40:43], a[80:83], v[248:251]
ds_read_b64_tr_b16 a[104:105], v13 offset:17152
v_add_u32 v20, s0, v16
v_mfma_f32_16x16x32_bf16 v[248:251], a[60:63], a[84:87], v[248:251]
global_load_dword a120, v[20:21], off sc1
v_mfma_f32_16x16x32_bf16 v[252:255], a[64:67], a[84:87], v[252:255]
ds_read_b64_tr_b16 a[106:107], v13 offset:18176
v_mfma_f32_16x16x32_bf16 v[252:255], a[44:47], a[80:83], v[252:255]
ds_read_b64_tr_b16 a[108:109], v13 offset:25344
v_mfma_f32_16x16x32_bf16 v[216:219], a[48:51], a[80:83], v[216:219]
ds_read_b64_tr_b16 a[110:111], v13 offset:26368
v_add_u32 v12, 0xffff0000, v12
v_mfma_f32_16x16x32_bf16 v[216:219], a[68:71], a[84:87], v[216:219]
v_add_u32 v13, 0xffff0000, v13
v_mfma_f32_16x16x32_bf16 v[220:223], a[72:75], a[84:87], v[220:223]
v_mfma_f32_16x16x32_bf16 v[220:223], a[52:55], a[80:83], v[220:223]
v_mfma_f32_16x16x32_bf16 v[236:239], a[52:55], a[88:91], v[236:239]
s_waitcnt vmcnt(28) lgkmcnt(0)
v_mfma_f32_16x16x32_bf16 v[236:239], a[72:75], a[92:95], v[236:239]
s_barrier
s_add_u32 m0, s17, 0x10000
v_mfma_f32_16x16x32_bf16 v[232:235], a[68:71], a[92:95], v[232:235]
buffer_load_dwordx4 v5, s[52:55], 0 offen lds
v_mfma_f32_16x16x32_bf16 v[232:235], a[48:51], a[88:91], v[232:235]
ds_read_b64_tr_b16 a[80:81], v12 offset:0
s_mul_i32 s28, s5, 0x10c400
v_mfma_f32_16x16x32_bf16 v[228:231], a[44:47], a[88:91], v[228:231]
ds_read_b64_tr_b16 a[82:83], v12 offset:1024
s_mov_b32 s48, s88
v_mfma_f32_16x16x32_bf16 v[228:231], a[64:67], a[92:95], v[228:231]
ds_read_b64_tr_b16 a[84:85], v12 offset:8192
s_mov_b32 s49, s89
v_mfma_f32_16x16x32_bf16 v[224:227], a[60:63], a[92:95], v[224:227]
ds_read_b64_tr_b16 a[86:87], v12 offset:9216
s_sub_u32 s11, 16, s6
v_mfma_f32_16x16x32_bf16 v[224:227], a[40:43], a[88:91], v[224:227]
s_waitcnt lgkmcnt(4)
s_lshl_b32 s11, s11, 16
s_add_u32 s11, s11, s28
v_mfma_f32_16x16x32_bf16 v[240:243], a[40:43], a[96:99], v[240:243]
ds_read_b64_tr_b16 a[88:89], v13 offset:0
s_add_u32 m0, s17, 0x10400
v_mfma_f32_16x16x32_bf16 v[240:243], a[60:63], a[100:103], v[240:243]
buffer_load_dwordx4 v5, s[52:55], s13 offen lds
v_mfma_f32_16x16x32_bf16 v[244:247], a[64:67], a[100:103], v[244:247]
ds_read_b64_tr_b16 a[90:91], v13 offset:1024
s_add_u32 s50, s11, 0x2000
v_mfma_f32_16x16x32_bf16 v[244:247], a[44:47], a[96:99], v[244:247]
ds_read_b64_tr_b16 a[92:93], v13 offset:8192
s_lshl_b32 s11, s6, 17
v_mfma_f32_16x16x32_bf16 a[232:235], a[48:51], a[96:99], a[232:235]
ds_read_b64_tr_b16 a[94:95], v13 offset:9216
s_add_u32 s28, s28, s11
v_mfma_f32_16x16x32_bf16 a[232:235], a[68:71], a[100:103], a[232:235]
s_lshl_b32 s11, s4, 15
s_add_u32 s28, s28, s11
s_lshl_b32 s10, s5, 2
v_mfma_f32_16x16x32_bf16 a[236:239], a[72:75], a[100:103], a[236:239]
s_add_u32 s10, s10, 64
v_mfma_f32_16x16x32_bf16 a[236:239], a[52:55], a[96:99], a[236:239]
L_padA3:
s_cmp_eq_u32 s95, 1
s_cbranch_scc1 L_padA7
s_add_u32 m0, s17, 0x10800
v_mfma_f32_16x16x32_bf16 a[252:255], a[52:55], a[104:107], a[252:255]
buffer_load_dwordx4 v6, s[52:55], 0 offen lds
v_mfma_f32_16x16x32_bf16 a[252:255], a[72:75], a[108:111], a[252:255]
ds_read_b64_tr_b16 a[96:97], v12 offset:256
v_mfma_f32_16x16x32_bf16 a[248:251], a[68:71], a[108:111], a[248:251]
ds_read_b64_tr_b16 a[98:99], v12 offset:1280
v_mfma_f32_16x16x32_bf16 a[248:251], a[48:51], a[104:107], a[248:251]
ds_read_b64_tr_b16 a[100:101], v12 offset:8448
v_mfma_f32_16x16x32_bf16 a[244:247], a[44:47], a[104:107], a[244:247]
ds_read_b64_tr_b16 a[102:103], v12 offset:9472
v_mfma_f32_16x16x32_bf16 a[244:247], a[64:67], a[108:111], a[244:247]
v_mfma_f32_16x16x32_bf16 a[240:243], a[60:63], a[108:111], a[240:243]
v_mfma_f32_16x16x32_bf16 a[240:243], a[40:43], a[104:107], a[240:243]
s_add_u32 m0, s17, 0x10c00
s_waitcnt lgkmcnt(4)
L_S6:
v_mfma_f32_16x16x32_bf16 v[24:27], a[80:83], a[0:3], v[24:27]
buffer_load_dwordx4 v6, s[52:55], s13 offen lds
v_mfma_f32_16x16x32_bf16 v[24:27], a[84:87], a[20:23], v[24:27]
ds_read_b64_tr_b16 a[104:105], v13 offset:256
s_waitcnt vmcnt(24)
v_mfma_f32_16x16x32_bf16 v[32:35], a[84:87], a[24:27], v[32:35]
ds_read_b64_tr_b16 a[106:107], v13 offset:1280
v_mfma_f32_16x16x32_bf16 v[32:35], a[80:83], a[4:7], v[32:35]
ds_read_b64_tr_b16 a[108:109], v13 offset:8448
v_mfma_f32_16x16x32_bf16 v[40:43], a[80:83], a[8:11], v[40:43]
ds_read_b64_tr_b16 a[110:111], v13 offset:9472
v_mfma_f32_16x16x32_bf16 v[40:43], a[84:87], a[28:31], v[40:43]
ds_read_b128 a[40:43], v8 offset:32768
v_mfma_f32_16x16x32_bf16 v[48:51], a[84:87], a[32:35], v[48:51]
ds_read_b128 a[60:63], v9 offset:32768
s_add_u32 m0, s18, 0x14000
v_mfma_f32_16x16x32_bf16 v[48:51], a[80:83], a[12:15], v[48:51]
buffer_load_dwordx4 v7, s[68:71], 0 offen lds
v_mfma_f32_16x16x32_bf16 v[52:55], a[88:91], a[12:15], v[52:55]
ds_read_b64_tr_b16 a[80:81], v12 offset:512
v_mfma_f32_16x16x32_bf16 v[52:55], a[92:95], a[32:35], v[52:55]
ds_read_b64_tr_b16 a[82:83], v12 offset:1536
v_mfma_f32_16x16x32_bf16 v[44:47], a[92:95], a[28:31], v[44:47]
ds_read_b64_tr_b16 a[84:85], v12 offset:8704
v_mfma_f32_16x16x32_bf16 v[44:47], a[88:91], a[8:11], v[44:47]
ds_read_b64_tr_b16 a[86:87], v12 offset:9728
v_mfma_f32_16x16x32_bf16 v[36:39], a[88:91], a[4:7], v[36:39]
ds_read_b128 a[44:47], v8 offset:34816
v_mfma_f32_16x16x32_bf16 v[36:39], a[92:95], a[24:27], v[36:39]
ds_read_b128 a[64:67], v9 offset:34816
s_waitcnt lgkmcnt(8)
v_mfma_f32_16x16x32_bf16 v[28:31], a[92:95], a[20:23], v[28:31]
ds_read_b128 a[48:51], v8 offset:36864
s_add_u32 m0, s18, 0x15000
v_mfma_f32_16x16x32_bf16 v[28:31], a[88:91], a[0:3], v[28:31]
buffer_load_dwordx4 v7, s[68:71], s25 offen lds
v_mfma_f32_16x16x32_bf16 v[56:59], a[96:99], a[0:3], v[56:59]
ds_read_b64_tr_b16 a[88:89], v13 offset:512
v_mfma_f32_16x16x32_bf16 v[56:59], a[100:103], a[20:23], v[56:59]
ds_read_b64_tr_b16 a[90:91], v13 offset:1536
v_mfma_f32_16x16x32_bf16 v[64:67], a[100:103], a[24:27], v[64:67]
ds_read_b64_tr_b16 a[92:93], v13 offset:8704
v_mfma_f32_16x16x32_bf16 v[64:67], a[96:99], a[4:7], v[64:67]
ds_read_b64_tr_b16 a[94:95], v13 offset:9728
v_mfma_f32_16x16x32_bf16 v[72:75], a[96:99], a[8:11], v[72:75]
ds_read_b128 a[68:71], v9 offset:36864
v_mfma_f32_16x16x32_bf16 v[72:75], a[100:103], a[28:31], v[72:75]
ds_read_b128 a[52:55], v8 offset:38912
s_add_u32 m0, s18, 0x16000
v_mfma_f32_16x16x32_bf16 v[80:83], a[100:103], a[32:35], v[80:83]
buffer_load_dwordx4 v7, s[68:71], s26 offen lds
v_mfma_f32_16x16x32_bf16 v[80:83], a[96:99], a[12:15], v[80:83]
ds_read_b128 a[72:75], v9 offset:38912
v_mfma_f32_16x16x32_bf16 v[84:87], a[104:107], a[12:15], v[84:87]
ds_read_b64_tr_b16 a[96:97], v12 offset:768
v_mfma_f32_16x16x32_bf16 v[84:87], a[108:111], a[32:35], v[84:87]
ds_read_b64_tr_b16 a[98:99], v12 offset:1792
v_mfma_f32_16x16x32_bf16 v[76:79], a[108:111], a[28:31], v[76:79]
ds_read_b64_tr_b16 a[100:101], v12 offset:8960
v_mfma_f32_16x16x32_bf16 v[76:79], a[104:107], a[8:11], v[76:79]
ds_read_b64_tr_b16 a[102:103], v12 offset:9984
v_mfma_f32_16x16x32_bf16 v[68:71], a[104:107], a[4:7], v[68:71]
s_add_u32 m0, s18, 0x17000
v_mfma_f32_16x16x32_bf16 v[68:71], a[108:111], a[24:27], v[68:71]
buffer_load_dwordx4 v4, s[44:47], s24 offen lds
v_mfma_f32_16x16x32_bf16 v[60:63], a[108:111], a[20:23], v[60:63]
v_add_u32 v5, 0x80000, v5
v_add_u32 v6, 0x80000, v6
v_mfma_f32_16x16x32_bf16 v[60:63], a[104:107], a[0:3], v[60:63]
s_waitcnt lgkmcnt(7)
v_add_u32 v7, 0x60000, v7
v_add_u32 v4, 0x80, v4
v_mfma_f32_16x16x32_bf16 v[88:91], a[80:83], a[0:3], v[88:91]
ds_read_b64_tr_b16 a[104:105], v13 offset:768
v_mfma_f32_16x16x32_bf16 v[88:91], a[84:87], a[20:23], v[88:91]
ds_read_b64_tr_b16 a[106:107], v13 offset:1792
v_mfma_f32_16x16x32_bf16 v[96:99], a[84:87], a[24:27], v[96:99]
ds_read_b64_tr_b16 a[108:109], v13 offset:8960
v_mfma_f32_16x16x32_bf16 v[96:99], a[80:83], a[4:7], v[96:99]
ds_read_b64_tr_b16 a[110:111], v13 offset:9984
v_mfma_f32_16x16x32_bf16 v[104:107], a[80:83], a[8:11], v[104:107]
s_add_u32 m0, s16, 0x8000
s_waitcnt lgkmcnt(8)
v_mfma_f32_16x16x32_bf16 v[104:107], a[84:87], a[28:31], v[104:107]
buffer_load_dwordx4 v22, s[44:47], s20 offen lds
v_mfma_f32_16x16x32_bf16 v[112:115], a[84:87], a[32:35], v[112:115]
v_mfma_f32_16x16x32_bf16 v[112:115], a[80:83], a[12:15], v[112:115]
v_mfma_f32_16x16x32_bf16 v[116:119], a[88:91], a[12:15], v[116:119]
ds_read_b64_tr_b16 a[80:81], v12 offset:16384
v_mfma_f32_16x16x32_bf16 v[116:119], a[92:95], a[32:35], v[116:119]
ds_read_b64_tr_b16 a[82:83], v12 offset:17408
v_mfma_f32_16x16x32_bf16 v[108:111], a[92:95], a[28:31], v[108:111]
ds_read_b64_tr_b16 a[84:85], v12 offset:24576
v_mfma_f32_16x16x32_bf16 v[108:111], a[88:91], a[8:11], v[108:111]
ds_read_b64_tr_b16 a[86:87], v12 offset:25600
s_add_u32 m0, s16, 0x8400
v_mfma_f32_16x16x32_bf16 v[100:103], a[88:91], a[4:7], v[100:103]
buffer_load_dwordx4 v23, s[44:47], s20 offen lds
v_mfma_f32_16x16x32_bf16 v[100:103], a[92:95], a[24:27], v[100:103]
v_mfma_f32_16x16x32_bf16 v[92:95], a[92:95], a[20:23], v[92:95]
v_mfma_f32_16x16x32_bf16 v[92:95], a[88:91], a[0:3], v[92:95]
s_waitcnt lgkmcnt(4)
v_mfma_f32_16x16x32_bf16 v[120:123], a[96:99], a[0:3], v[120:123]
ds_read_b64_tr_b16 a[88:89], v13 offset:16384
v_mfma_f32_16x16x32_bf16 v[120:123], a[100:103], a[20:23], v[120:123]
ds_read_b64_tr_b16 a[90:91], v13 offset:17408
v_mfma_f32_16x16x32_bf16 v[128:131], a[100:103], a[24:27], v[128:131]
ds_read_b64_tr_b16 a[92:93], v13 offset:24576
v_mfma_f32_16x16x32_bf16 v[128:131], a[96:99], a[4:7], v[128:131]
ds_read_b64_tr_b16 a[94:95], v13 offset:25600
s_add_u32 m0, s16, 0x8800
v_mfma_f32_16x16x32_bf16 v[136:139], a[96:99], a[8:11], v[136:139]
buffer_load_dwordx4 v22, s[44:47], s21 offen lds
v_mfma_f32_16x16x32_bf16 v[136:139], a[100:103], a[28:31], v[136:139]
v_mfma_f32_16x16x32_bf16 v[144:147], a[100:103], a[32:35], v[144:147]
v_mfma_f32_16x16x32_bf16 v[144:147], a[96:99], a[12:15], v[144:147]
v_mfma_f32_16x16x32_bf16 v[148:151], a[104:107], a[12:15], v[148:151]
ds_read_b64_tr_b16 a[96:97], v12 offset:16640
v_mfma_f32_16x16x32_bf16 v[148:151], a[108:111], a[32:35], v[148:151]
ds_read_b64_tr_b16 a[98:99], v12 offset:17664
v_mfma_f32_16x16x32_bf16 v[140:143], a[108:111], a[28:31], v[140:143]
ds_read_b64_tr_b16 a[100:101], v12 offset:24832
s_add_u32 m0, s16, 0x8c00
v_mfma_f32_16x16x32_bf16 v[140:143], a[104:107], a[8:11], v[140:143]
buffer_load_dwordx4 v23, s[44:47], s21 offen lds
v_mfma_f32_16x16x32_bf16 v[132:135], a[104:107], a[4:7], v[132:135]
ds_read_b64_tr_b16 a[102:103], v12 offset:25856
v_mfma_f32_16x16x32_bf16 v[132:135], a[108:111], a[24:27], v[132:135]
v_mfma_f32_16x16x32_bf16 v[124:127], a[108:111], a[20:23], v[124:127]
v_mfma_f32_16x16x32_bf16 v[124:127], a[104:107], a[0:3], v[124:127]
s_waitcnt lgkmcnt(4)
v_mfma_f32_16x16x32_bf16 v[152:155], a[0:3], a[80:83], v[152:155]
ds_read_b64_tr_b16 a[104:105], v13 offset:16640
v_mfma_f32_16x16x32_bf16 v[152:155], a[20:23], a[84:87], v[152:155]
ds_read_b64_tr_b16 a[106:107], v13 offset:17664
s_add_u32 m0, s16, 0x9000
v_mfma_f32_16x16x32_bf16 v[156:159], a[24:27], a[84:87], v[156:159]
buffer_load_dwordx4 v22, s[44:47], s22 offen lds
v_mfma_f32_16x16x32_bf16 v[156:159], a[4:7], a[80:83], v[156:159]
ds_read_b64_tr_b16 a[108:109], v13 offset:24832
v_mfma_f32_16x16x32_bf16 v[160:163], a[8:11], a[80:83], v[160:163]
ds_read_b64_tr_b16 a[110:111], v13 offset:25856
v_mfma_f32_16x16x32_bf16 v[160:163], a[28:31], a[84:87], v[160:163]
v_mfma_f32_16x16x32_bf16 v[164:167], a[32:35], a[84:87], v[164:167]
v_mfma_f32_16x16x32_bf16 v[164:167], a[12:15], a[80:83], v[164:167]
v_mfma_f32_16x16x32_bf16 v[180:183], a[12:15], a[88:91], v[180:183]
ds_read_b64_tr_b16 a[80:81], v12 offset:16896
v_mfma_f32_16x16x32_bf16 v[180:183], a[32:35], a[92:95], v[180:183]
ds_read_b64_tr_b16 a[82:83], v12 offset:17920
s_add_u32 m0, s16, 0x9400
v_mfma_f32_16x16x32_bf16 v[176:179], a[28:31], a[92:95], v[176:179]
buffer_load_dwordx4 v23, s[44:47], s22 offen lds
v_mfma_f32_16x16x32_bf16 v[176:179], a[8:11], a[88:91], v[176:179]
ds_read_b64_tr_b16 a[84:85], v12 offset:25088
v_mfma_f32_16x16x32_bf16 v[172:175], a[4:7], a[88:91], v[172:175]
ds_read_b64_tr_b16 a[86:87], v12 offset:26112
v_mfma_f32_16x16x32_bf16 v[172:175], a[24:27], a[92:95], v[172:175]
v_mfma_f32_16x16x32_bf16 v[168:171], a[20:23], a[92:95], v[168:171]
v_mfma_f32_16x16x32_bf16 v[168:171], a[0:3], a[88:91], v[168:171]
s_waitcnt lgkmcnt(4)
v_mfma_f32_16x16x32_bf16 v[184:187], a[0:3], a[96:99], v[184:187]
ds_read_b64_tr_b16 a[88:89], v13 offset:16896
s_add_u32 m0, s16, 0x9800
v_mfma_f32_16x16x32_bf16 v[184:187], a[20:23], a[100:103], v[184:187]
buffer_load_dwordx4 v22, s[44:47], s23 offen lds
v_mfma_f32_16x16x32_bf16 v[188:191], a[24:27], a[100:103], v[188:191]
ds_read_b64_tr_b16 a[90:91], v13 offset:17920
v_mfma_f32_16x16x32_bf16 v[188:191], a[4:7], a[96:99], v[188:191]
ds_read_b64_tr_b16 a[92:93], v13 offset:25088
v_mfma_f32_16x16x32_bf16 v[192:195], a[8:11], a[96:99], v[192:195]
ds_read_b64_tr_b16 a[94:95], v13 offset:26112
v_mfma_f32_16x16x32_bf16 v[192:195], a[28:31], a[100:103], v[192:195]
v_mfma_f32_16x16x32_bf16 v[196:199], a[32:35], a[100:103], v[196:199]
v_mfma_f32_16x16x32_bf16 v[196:199], a[12:15], a[96:99], v[196:199]
v_mfma_f32_16x16x32_bf16 v[212:215], a[12:15], a[104:107], v[212:215]
ds_read_b64_tr_b16 a[96:97], v12 offset:17152
s_add_u32 m0, s16, 0x9c00
v_mfma_f32_16x16x32_bf16 v[212:215], a[32:35], a[108:111], v[212:215]
buffer_load_dwordx4 v23, s[44:47], s23 offen lds
v_mfma_f32_16x16x32_bf16 v[208:211], a[28:31], a[108:111], v[208:211]
ds_read_b64_tr_b16 a[98:99], v12 offset:18176
v_add_u32 v22, 0x80, v22
v_mfma_f32_16x16x32_bf16 v[208:211], a[8:11], a[104:107], v[208:211]
ds_read_b64_tr_b16 a[100:101], v12 offset:25344
v_add_u32 v23, 0x80, v23
v_mfma_f32_16x16x32_bf16 v[204:207], a[4:7], a[104:107], v[204:207]
ds_read_b64_tr_b16 a[102:103], v12 offset:26368
v_mfma_f32_16x16x32_bf16 v[204:207], a[24:27], a[108:111], v[204:207]
v_mfma_f32_16x16x32_bf16 v[200:203], a[20:23], a[108:111], v[200:203]
v_mfma_f32_16x16x32_bf16 v[200:203], a[0:3], a[104:107], v[200:203]
s_mov_b32 s9, 0x400000
s_waitcnt lgkmcnt(4)
v_mfma_f32_16x16x32_bf16 v[248:251], a[0:3], a[80:83], v[248:251]
buffer_load_dword a120, v18, s[52:55], s9 offen
v_mfma_f32_16x16x32_bf16 v[248:251], a[20:23], a[84:87], v[248:251]
ds_read_b64_tr_b16 a[104:105], v13 offset:17152
v_mfma_f32_16x16x32_bf16 v[252:255], a[24:27], a[84:87], v[252:255]
ds_read_b64_tr_b16 a[106:107], v13 offset:18176
v_mfma_f32_16x16x32_bf16 v[252:255], a[4:7], a[80:83], v[252:255]
ds_read_b64_tr_b16 a[108:109], v13 offset:25344
v_mfma_f32_16x16x32_bf16 v[216:219], a[8:11], a[80:83], v[216:219]
ds_read_b64_tr_b16 a[110:111], v13 offset:26368
v_add_u32 v12, 0x8000, v12
v_mfma_f32_16x16x32_bf16 v[216:219], a[28:31], a[84:87], v[216:219]
v_add_u32 v13, 0x8000, v13
v_mfma_f32_16x16x32_bf16 v[220:223], a[32:35], a[84:87], v[220:223]
v_mfma_f32_16x16x32_bf16 v[220:223], a[12:15], a[80:83], v[220:223]
v_mfma_f32_16x16x32_bf16 v[236:239], a[12:15], a[88:91], v[236:239]
s_waitcnt vmcnt(27) lgkmcnt(0)
v_mfma_f32_16x16x32_bf16 v[236:239], a[32:35], a[92:95], v[236:239]
s_barrier
s_add_u32 m0, s17, 0x0
v_mfma_f32_16x16x32_bf16 v[232:235], a[28:31], a[92:95], v[232:235]
buffer_load_dwordx4 v5, s[52:55], 0 offen lds
v_mfma_f32_16x16x32_bf16 v[232:235], a[8:11], a[88:91], v[232:235]
ds_read_b64_tr_b16 a[80:81], v12 offset:0
v_mfma_f32_16x16x32_bf16 v[228:231], a[4:7], a[88:91], v[228:231]
ds_read_b64_tr_b16 a[82:83], v12 offset:1024
v_mfma_f32_16x16x32_bf16 v[228:231], a[24:27], a[92:95], v[228:231]
ds_read_b64_tr_b16 a[84:85], v12 offset:8192
v_mfma_f32_16x16x32_bf16 v[224:227], a[20:23], a[92:95], v[224:227]
ds_read_b64_tr_b16 a[86:87], v12 offset:9216
v_mfma_f32_16x16x32_bf16 v[224:227], a[0:3], a[88:91], v[224:227]
s_waitcnt lgkmcnt(4)
v_mfma_f32_16x16x32_bf16 v[240:243], a[0:3], a[96:99], v[240:243]
ds_read_b64_tr_b16 a[88:89], v13 offset:0
s_add_u32 m0, s17, 0x400
v_mfma_f32_16x16x32_bf16 v[240:243], a[20:23], a[100:103], v[240:243]
buffer_load_dwordx4 v5, s[52:55], s13 offen lds
v_mfma_f32_16x16x32_bf16 v[244:247], a[24:27], a[100:103], v[244:247]
ds_read_b64_tr_b16 a[90:91], v13 offset:1024
v_mfma_f32_16x16x32_bf16 v[244:247], a[4:7], a[96:99], v[244:247]
ds_read_b64_tr_b16 a[92:93], v13 offset:8192
v_mfma_f32_16x16x32_bf16 a[232:235], a[8:11], a[96:99], a[232:235]
ds_read_b64_tr_b16 a[94:95], v13 offset:9216
v_mfma_f32_16x16x32_bf16 a[232:235], a[28:31], a[100:103], a[232:235]
v_mfma_f32_16x16x32_bf16 a[236:239], a[32:35], a[100:103], a[236:239]
v_mfma_f32_16x16x32_bf16 a[236:239], a[12:15], a[96:99], a[236:239]
s_add_u32 m0, s17, 0x800
v_mfma_f32_16x16x32_bf16 a[252:255], a[12:15], a[104:107], a[252:255]
buffer_load_dwordx4 v6, s[52:55], 0 offen lds
v_mfma_f32_16x16x32_bf16 a[252:255], a[32:35], a[108:111], a[252:255]
ds_read_b64_tr_b16 a[96:97], v12 offset:256
v_mfma_f32_16x16x32_bf16 a[248:251], a[28:31], a[108:111], a[248:251]
ds_read_b64_tr_b16 a[98:99], v12 offset:1280
v_mfma_f32_16x16x32_bf16 a[248:251], a[8:11], a[104:107], a[248:251]
ds_read_b64_tr_b16 a[100:101], v12 offset:8448
v_mfma_f32_16x16x32_bf16 a[244:247], a[4:7], a[104:107], a[244:247]
ds_read_b64_tr_b16 a[102:103], v12 offset:9472
v_mfma_f32_16x16x32_bf16 a[244:247], a[24:27], a[108:111], a[244:247]
v_mfma_f32_16x16x32_bf16 a[240:243], a[20:23], a[108:111], a[240:243]
s_add_u32 m0, s17, 0xc00
s_waitcnt lgkmcnt(4)
v_mfma_f32_16x16x32_bf16 a[240:243], a[0:3], a[104:107], a[240:243]
buffer_load_dwordx4 v6, s[52:55], s13 offen lds
L_S7:
v_mfma_f32_16x16x32_bf16 v[24:27], a[80:83], a[40:43], v[24:27]
ds_read_b64_tr_b16 a[104:105], v13 offset:256
s_waitcnt vmcnt(22)
v_mfma_f32_16x16x32_bf16 v[24:27], a[84:87], a[60:63], v[24:27]
ds_read_b64_tr_b16 a[106:107], v13 offset:1280
v_mfma_f32_16x16x32_bf16 v[32:35], a[84:87], a[64:67], v[32:35]
ds_read_b64_tr_b16 a[108:109], v13 offset:8448
v_mfma_f32_16x16x32_bf16 v[32:35], a[80:83], a[44:47], v[32:35]
ds_read_b64_tr_b16 a[110:111], v13 offset:9472
v_mfma_f32_16x16x32_bf16 v[40:43], a[80:83], a[48:51], v[40:43]
ds_read_b128 a[0:3], v8 offset:0
v_mfma_f32_16x16x32_bf16 v[40:43], a[84:87], a[68:71], v[40:43]
ds_read_b128 a[20:23], v9 offset:0
s_add_u32 m0, s18, 0x4000
v_mfma_f32_16x16x32_bf16 v[48:51], a[84:87], a[72:75], v[48:51]
buffer_load_dwordx4 v7, s[68:71], 0 offen lds
v_mfma_f32_16x16x32_bf16 v[48:51], a[80:83], a[52:55], v[48:51]
ds_read_b128 a[4:7], v8 offset:2048
v_mfma_f32_16x16x32_bf16 v[52:55], a[88:91], a[52:55], v[52:55]
ds_read_b64_tr_b16 a[80:81], v12 offset:512
v_mfma_f32_16x16x32_bf16 v[52:55], a[92:95], a[72:75], v[52:55]
ds_read_b64_tr_b16 a[82:83], v12 offset:1536
v_mfma_f32_16x16x32_bf16 v[44:47], a[92:95], a[68:71], v[44:47]
ds_read_b64_tr_b16 a[84:85], v12 offset:8704
v_mfma_f32_16x16x32_bf16 v[44:47], a[88:91], a[48:51], v[44:47]
ds_read_b64_tr_b16 a[86:87], v12 offset:9728
v_mfma_f32_16x16x32_bf16 v[36:39], a[88:91], a[44:47], v[36:39]
ds_read_b128 a[24:27], v9 offset:2048
s_add_u32 m0, s18, 0x5000
v_mfma_f32_16x16x32_bf16 v[36:39], a[92:95], a[64:67], v[36:39]
buffer_load_dwordx4 v7, s[68:71], s25 offen lds
v_mfma_f32_16x16x32_bf16 v[28:31], a[92:95], a[60:63], v[28:31]
ds_read_b128 a[8:11], v8 offset:4096
v_mfma_f32_16x16x32_bf16 v[28:31], a[88:91], a[40:43], v[28:31]
ds_read_b128 a[28:31], v9 offset:4096
s_waitcnt lgkmcnt(10)
v_mfma_f32_16x16x32_bf16 v[56:59], a[96:99], a[40:43], v[56:59]
ds_read_b64_tr_b16 a[88:89], v13 offset:512
v_mfma_f32_16x16x32_bf16 v[56:59], a[100:103], a[60:63], v[56:59]
ds_read_b64_tr_b16 a[90:91], v13 offset:1536
v_mfma_f32_16x16x32_bf16 v[64:67], a[100:103], a[64:67], v[64:67]
ds_read_b64_tr_b16 a[92:93], v13 offset:8704
v_mfma_f32_16x16x32_bf16 v[64:67], a[96:99], a[44:47], v[64:67]
ds_read_b64_tr_b16 a[94:95], v13 offset:9728
s_add_u32 m0, s18, 0x6000
v_cvt_pk_bf16_f32 v24, v24, v25
v_mfma_f32_16x16x32_bf16 v[72:75], a[96:99], a[48:51], v[72:75]
buffer_load_dwordx4 v7, s[68:71], s26 offen lds
v_mfma_f32_16x16x32_bf16 v[72:75], a[100:103], a[68:71], v[72:75]
ds_read_b128 a[12:15], v8 offset:6144
v_cvt_pk_bf16_f32 v25, v26, v27
v_mfma_f32_16x16x32_bf16 v[80:83], a[100:103], a[72:75], v[80:83]
ds_read_b128 a[32:35], v9 offset:6144
v_cvt_pk_bf16_f32 v26, v28, v29
v_cvt_pk_bf16_f32 v27, v30, v31
v_mfma_f32_16x16x32_bf16 v[80:83], a[96:99], a[52:55], v[80:83]
v_accvgpr_write_b32 a128, v24
v_accvgpr_write_b32 a129, v25
v_mfma_f32_16x16x32_bf16 v[84:87], a[104:107], a[52:55], v[84:87]
ds_read_b64_tr_b16 a[96:97], v12 offset:768
v_accvgpr_write_b32 a130, v26
v_mfma_f32_16x16x32_bf16 v[84:87], a[108:111], a[72:75], v[84:87]
ds_read_b64_tr_b16 a[98:99], v12 offset:1792
v_accvgpr_write_b32 a131, v27
v_cvt_pk_bf16_f32 v32, v32, v33
v_mfma_f32_16x16x32_bf16 v[76:79], a[108:111], a[68:71], v[76:79]
ds_read_b64_tr_b16 a[100:101], v12 offset:8960
s_add_u32 m0, s18, 0x7000
v_mfma_f32_16x16x32_bf16 v[76:79], a[104:107], a[48:51], v[76:79]
buffer_load_dwordx4 v4, s[44:47], s24 offen lds
v_mfma_f32_16x16x32_bf16 v[68:71], a[104:107], a[44:47], v[68:71]
ds_read_b64_tr_b16 a[102:103], v12 offset:9984
v_add_u32 v5, 0x80000, v5
v_cvt_pk_bf16_f32 v33, v34, v35
v_mfma_f32_16x16x32_bf16 v[68:71], a[108:111], a[64:67], v[68:71]
v_add_u32 v6, 0x80000, v6
v_add_u32 v7, 0x60000, v7
v_mfma_f32_16x16x32_bf16 v[60:63], a[108:111], a[60:63], v[60:63]
v_add_u32 v4, 0x80, v4
v_cvt_pk_bf16_f32 v34, v36, v37
v_mfma_f32_16x16x32_bf16 v[60:63], a[104:107], a[40:43], v[60:63]
s_waitcnt lgkmcnt(6)
v_cvt_pk_bf16_f32 v35, v38, v39
v_accvgpr_write_b32 a132, v32
v_accvgpr_write_b32 a133, v33
v_mfma_f32_16x16x32_bf16 v[88:91], a[80:83], a[40:43], v[88:91]
ds_read_b64_tr_b16 a[104:105], v13 offset:768
v_accvgpr_write_b32 a134, v34
v_mfma_f32_16x16x32_bf16 v[88:91], a[84:87], a[60:63], v[88:91]
ds_read_b64_tr_b16 a[106:107], v13 offset:1792
s_mov_b32 s9, 0x400000
v_mfma_f32_16x16x32_bf16 v[96:99], a[84:87], a[64:67], v[96:99]
buffer_load_dword a120, v19, s[68:71], s9 offen
v_accvgpr_write_b32 a135, v35
v_mfma_f32_16x16x32_bf16 v[96:99], a[80:83], a[44:47], v[96:99]
ds_read_b64_tr_b16 a[108:109], v13 offset:8960
v_cvt_pk_bf16_f32 v40, v40, v41
v_mfma_f32_16x16x32_bf16 v[104:107], a[80:83], a[48:51], v[104:107]
ds_read_b64_tr_b16 a[110:111], v13 offset:9984
v_cvt_pk_bf16_f32 v41, v42, v43
v_mfma_f32_16x16x32_bf16 v[104:107], a[84:87], a[68:71], v[104:107]
v_cvt_pk_bf16_f32 v42, v44, v45
v_cvt_pk_bf16_f32 v43, v46, v47
v_accvgpr_write_b32 a136, v40
v_mfma_f32_16x16x32_bf16 v[112:115], a[84:87], a[72:75], v[112:115]
v_accvgpr_write_b32 a137, v41
v_accvgpr_write_b32 a138, v42
v_mfma_f32_16x16x32_bf16 v[112:115], a[80:83], a[52:55], v[112:115]
s_waitcnt lgkmcnt(8)
v_accvgpr_write_b32 a139, v43
v_cvt_pk_bf16_f32 v48, v48, v49
v_mfma_f32_16x16x32_bf16 v[116:119], a[88:91], a[52:55], v[116:119]
ds_read_b64_tr_b16 a[80:81], v12 offset:16384
s_add_u32 m0, s16, 0x0
v_cvt_pk_bf16_f32 v49, v50, v51
v_mfma_f32_16x16x32_bf16 v[116:119], a[92:95], a[72:75], v[116:119]
buffer_load_dwordx4 v22, s[44:47], s20 offen lds
v_mfma_f32_16x16x32_bf16 v[108:111], a[92:95], a[68:71], v[108:111]
ds_read_b64_tr_b16 a[82:83], v12 offset:17408
v_cvt_pk_bf16_f32 v50, v52, v53
v_mfma_f32_16x16x32_bf16 v[108:111], a[88:91], a[48:51], v[108:111]
ds_read_b64_tr_b16 a[84:85], v12 offset:24576
v_cvt_pk_bf16_f32 v51, v54, v55
v_accvgpr_write_b32 a140, v48
v_mfma_f32_16x16x32_bf16 v[100:103], a[88:91], a[44:47], v[100:103]
ds_read_b64_tr_b16 a[86:87], v12 offset:25600
v_accvgpr_write_b32 a141, v49
v_mfma_f32_16x16x32_bf16 v[100:103], a[92:95], a[64:67], v[100:103]
v_accvgpr_write_b32 a142, v50
v_accvgpr_write_b32 a143, v51
v_mfma_f32_16x16x32_bf16 v[92:95], a[92:95], a[60:63], v[92:95]
v_cvt_pk_bf16_f32 v56, v56, v57
v_cvt_pk_bf16_f32 v57, v58, v59
v_cvt_pk_bf16_f32 v58, v60, v61
v_mfma_f32_16x16x32_bf16 v[92:95], a[88:91], a[40:43], v[92:95]
s_add_u32 m0, s16, 0x400
s_waitcnt lgkmcnt(4)
v_cvt_pk_bf16_f32 v59, v62, v63
v_mfma_f32_16x16x32_bf16 v[120:123], a[96:99], a[40:43], v[120:123]
buffer_load_dwordx4 v23, s[44:47], s20 offen lds
v_mfma_f32_16x16x32_bf16 v[120:123], a[100:103], a[60:63], v[120:123]
ds_read_b64_tr_b16 a[88:89], v13 offset:16384
v_accvgpr_write_b32 a144, v56
v_accvgpr_write_b32 a145, v57
v_mfma_f32_16x16x32_bf16 v[128:131], a[100:103], a[64:67], v[128:131]
ds_read_b64_tr_b16 a[90:91], v13 offset:17408
v_accvgpr_write_b32 a146, v58
v_mfma_f32_16x16x32_bf16 v[128:131], a[96:99], a[44:47], v[128:131]
ds_read_b64_tr_b16 a[92:93], v13 offset:24576
v_accvgpr_write_b32 a147, v59
v_mfma_f32_16x16x32_bf16 v[136:139], a[96:99], a[48:51], v[136:139]
ds_read_b64_tr_b16 a[94:95], v13 offset:25600
v_cvt_pk_bf16_f32 v64, v64, v65
v_cvt_pk_bf16_f32 v65, v66, v67
v_mfma_f32_16x16x32_bf16 v[136:139], a[100:103], a[68:71], v[136:139]
v_cvt_pk_bf16_f32 v66, v68, v69
v_cvt_pk_bf16_f32 v67, v70, v71
v_mfma_f32_16x16x32_bf16 v[144:147], a[100:103], a[72:75], v[144:147]
s_add_u32 m0, s16, 0x800
v_accvgpr_write_b32 a148, v64
v_accvgpr_write_b32 a149, v65
v_mfma_f32_16x16x32_bf16 v[144:147], a[96:99], a[52:55], v[144:147]
buffer_load_dwordx4 v22, s[44:47], s21 offen lds
v_accvgpr_write_b32 a150, v66
v_mfma_f32_16x16x32_bf16 v[148:151], a[104:107], a[52:55], v[148:151]
ds_read_b64_tr_b16 a[96:97], v12 offset:16640
v_accvgpr_write_b32 a151, v67
v_mfma_f32_16x16x32_bf16 v[148:151], a[108:111], a[72:75], v[148:151]
ds_read_b64_tr_b16 a[98:99], v12 offset:17664
v_cvt_pk_bf16_f32 v72, v72, v73
v_mfma_f32_16x16x32_bf16 v[140:143], a[108:111], a[68:71], v[140:143]
ds_read_b64_tr_b16 a[100:101], v12 offset:24832
v_cvt_pk_bf16_f32 v73, v74, v75
v_cvt_pk_bf16_f32 v74, v76, v77
v_mfma_f32_16x16x32_bf16 v[140:143], a[104:107], a[48:51], v[140:143]
ds_read_b64_tr_b16 a[102:103], v12 offset:25856
v_cvt_pk_bf16_f32 v75, v78, v79
v_mfma_f32_16x16x32_bf16 v[132:135], a[104:107], a[44:47], v[132:135]
v_accvgpr_write_b32 a152, v72
v_accvgpr_write_b32 a153, v73
v_mfma_f32_16x16x32_bf16 v[132:135], a[108:111], a[64:67], v[132:135]
s_add_u32 m0, s16, 0xc00
v_accvgpr_write_b32 a154, v74
v_accvgpr_write_b32 a155, v75
v_cvt_pk_bf16_f32 v80, v80, v81
v_mfma_f32_16x16x32_bf16 v[124:127], a[108:111], a[60:63], v[124:127]
buffer_load_dwordx4 v23, s[44:47], s21 offen lds
v_mfma_f32_16x16x32_bf16 v[124:127], a[104:107], a[40:43], v[124:127]
s_waitcnt lgkmcnt(4)
v_cvt_pk_bf16_f32 v81, v82, v83
v_cvt_pk_bf16_f32 v82, v84, v85
v_mfma_f32_16x16x32_bf16 v[152:155], a[40:43], a[80:83], v[152:155]
ds_read_b64_tr_b16 a[104:105], v13 offset:16640
v_cvt_pk_bf16_f32 v83, v86, v87
v_accvgpr_write_b32 a156, v80
v_mfma_f32_16x16x32_bf16 v[152:155], a[60:63], a[84:87], v[152:155]
ds_read_b64_tr_b16 a[106:107], v13 offset:17664
v_accvgpr_write_b32 a157, v81
v_mfma_f32_16x16x32_bf16 v[156:159], a[64:67], a[84:87], v[156:159]
ds_read_b64_tr_b16 a[108:109], v13 offset:24832
v_accvgpr_write_b32 a158, v82
v_mfma_f32_16x16x32_bf16 v[156:159], a[44:47], a[80:83], v[156:159]
ds_read_b64_tr_b16 a[110:111], v13 offset:25856
v_accvgpr_write_b32 a159, v83
v_cvt_pk_bf16_f32 v88, v88, v89
v_mfma_f32_16x16x32_bf16 v[160:163], a[48:51], a[80:83], v[160:163]
s_add_u32 m0, s16, 0x1000
v_cvt_pk_bf16_f32 v89, v90, v91
v_cvt_pk_bf16_f32 v90, v92, v93
v_mfma_f32_16x16x32_bf16 v[160:163], a[68:71], a[84:87], v[160:163]
buffer_load_dwordx4 v22, s[44:47], s22 offen lds
v_mfma_f32_16x16x32_bf16 v[164:167], a[72:75], a[84:87], v[164:167]
v_cvt_pk_bf16_f32 v91, v94, v95
v_accvgpr_write_b32 a160, v88
v_accvgpr_write_b32 a161, v89
v_mfma_f32_16x16x32_bf16 v[164:167], a[52:55], a[80:83], v[164:167]
v_accvgpr_write_b32 a162, v90
v_accvgpr_write_b32 a163, v91
v_mfma_f32_16x16x32_bf16 v[180:183], a[52:55], a[88:91], v[180:183]
ds_read_b64_tr_b16 a[80:81], v12 offset:16896
v_cvt_pk_bf16_f32 v96, v96, v97
v_mfma_f32_16x16x32_bf16 v[180:183], a[72:75], a[92:95], v[180:183]
ds_read_b64_tr_b16 a[82:83], v12 offset:17920
v_cvt_pk_bf16_f32 v97, v98, v99
v_cvt_pk_bf16_f32 v98, v100, v101
v_mfma_f32_16x16x32_bf16 v[176:179], a[68:71], a[92:95], v[176:179]
ds_read_b64_tr_b16 a[84:85], v12 offset:25088
v_cvt_pk_bf16_f32 v99, v102, v103
v_mfma_f32_16x16x32_bf16 v[176:179], a[48:51], a[88:91], v[176:179]
ds_read_b64_tr_b16 a[86:87], v12 offset:26112
s_add_u32 m0, s16, 0x1400
v_mfma_f32_16x16x32_bf16 v[172:175], a[44:47], a[88:91], v[172:175]
buffer_load_dwordx4 v23, s[44:47], s22 offen lds
v_accvgpr_write_b32 a164, v96
v_mfma_f32_16x16x32_bf16 v[172:175], a[64:67], a[92:95], v[172:175]
v_accvgpr_write_b32 a165, v97
v_accvgpr_write_b32 a166, v98
v_mfma_f32_16x16x32_bf16 v[168:171], a[60:63], a[92:95], v[168:171]
v_accvgpr_write_b32 a167, v99
v_cvt_pk_bf16_f32 v104, v104, v105
v_mfma_f32_16x16x32_bf16 v[168:171], a[40:43], a[88:91], v[168:171]
s_waitcnt lgkmcnt(4)
v_cvt_pk_bf16_f32 v105, v106, v107
v_cvt_pk_bf16_f32 v106, v108, v109
v_cvt_pk_bf16_f32 v107, v110, v111
v_mfma_f32_16x16x32_bf16 v[184:187], a[40:43], a[96:99], v[184:187]
ds_read_b64_tr_b16 a[88:89], v13 offset:16896
v_accvgpr_write_b32 a168, v104
v_mfma_f32_16x16x32_bf16 v[184:187], a[60:63], a[100:103], v[184:187]
ds_read_b64_tr_b16 a[90:91], v13 offset:17920
v_accvgpr_write_b32 a169, v105
v_mfma_f32_16x16x32_bf16 v[188:191], a[64:67], a[100:103], v[188:191]
ds_read_b64_tr_b16 a[92:93], v13 offset:25088
L_padA4:
s_cmp_eq_u32 s95, 1
s_cbranch_scc1 L_padA8
s_add_u32 m0, s16, 0x1800
v_accvgpr_write_b32 a170, v106
v_mfma_f32_16x16x32_bf16 v[188:191], a[44:47], a[96:99], v[188:191]
buffer_load_dwordx4 v22, s[44:47], s23 offen lds
v_mfma_f32_16x16x32_bf16 v[192:195], a[48:51], a[96:99], v[192:195]
ds_read_b64_tr_b16 a[94:95], v13 offset:26112
v_accvgpr_write_b32 a171, v107
v_mfma_f32_16x16x32_bf16 v[192:195], a[68:71], a[100:103], v[192:195]
v_cvt_pk_bf16_f32 v112, v112, v113
v_cvt_pk_bf16_f32 v113, v114, v115
v_cvt_pk_bf16_f32 v114, v116, v117
v_mfma_f32_16x16x32_bf16 v[196:199], a[72:75], a[100:103], v[196:199]
v_cvt_pk_bf16_f32 v115, v118, v119
v_accvgpr_write_b32 a172, v112
v_mfma_f32_16x16x32_bf16 v[196:199], a[52:55], a[96:99], v[196:199]
v_accvgpr_write_b32 a173, v113
v_accvgpr_write_b32 a174, v114
v_mfma_f32_16x16x32_bf16 v[212:215], a[52:55], a[104:107], v[212:215]
ds_read_b64_tr_b16 a[96:97], v12 offset:17152
v_accvgpr_write_b32 a175, v115
v_cvt_pk_bf16_f32 v120, v120, v121
v_mfma_f32_16x16x32_bf16 v[212:215], a[72:75], a[108:111], v[212:215]
ds_read_b64_tr_b16 a[98:99], v12 offset:18176
s_add_u32 m0, s16, 0x1c00
v_mfma_f32_16x16x32_bf16 v[208:211], a[68:71], a[108:111], v[208:211]
buffer_load_dwordx4 v23, s[44:47], s23 offen lds
v_mfma_f32_16x16x32_bf16 v[208:211], a[48:51], a[104:107], v[208:211]
ds_read_b64_tr_b16 a[100:101], v12 offset:25344
v_add_u32 v22, 0x80, v22
v_cvt_pk_bf16_f32 v121, v122, v123
v_mfma_f32_16x16x32_bf16 v[204:207], a[44:47], a[104:107], v[204:207]
ds_read_b64_tr_b16 a[102:103], v12 offset:26368
v_add_u32 v23, 0x80, v23
v_mfma_f32_16x16x32_bf16 v[204:207], a[64:67], a[108:111], v[204:207]
v_cvt_pk_bf16_f32 v122, v124, v125
v_cvt_pk_bf16_f32 v123, v126, v127
v_mfma_f32_16x16x32_bf16 v[200:203], a[60:63], a[108:111], v[200:203]
v_accvgpr_write_b32 a176, v120
v_accvgpr_write_b32 a177, v121
v_accvgpr_write_b32 a178, v122
v_mfma_f32_16x16x32_bf16 v[200:203], a[40:43], a[104:107], v[200:203]
s_waitcnt lgkmcnt(4)
v_accvgpr_write_b32 a179, v123
v_cvt_pk_bf16_f32 v128, v128, v129
v_mfma_f32_16x16x32_bf16 v[248:251], a[40:43], a[80:83], v[248:251]
ds_read_b64_tr_b16 a[104:105], v13 offset:17152
s_mov_b32 s9, 0x600000
v_mfma_f32_16x16x32_bf16 v[248:251], a[60:63], a[84:87], v[248:251]
buffer_load_dword a120, v18, s[52:55], s9 offen
v_cvt_pk_bf16_f32 v129, v130, v131
v_mfma_f32_16x16x32_bf16 v[252:255], a[64:67], a[84:87], v[252:255]
ds_read_b64_tr_b16 a[106:107], v13 offset:18176
v_cvt_pk_bf16_f32 v130, v132, v133
v_mfma_f32_16x16x32_bf16 v[252:255], a[44:47], a[80:83], v[252:255]
ds_read_b64_tr_b16 a[108:109], v13 offset:25344
v_cvt_pk_bf16_f32 v131, v134, v135
v_mfma_f32_16x16x32_bf16 v[216:219], a[48:51], a[80:83], v[216:219]
ds_read_b64_tr_b16 a[110:111], v13 offset:26368
v_add_u32 v12, 0x8000, v12
v_accvgpr_write_b32 a180, v128
v_mfma_f32_16x16x32_bf16 v[216:219], a[68:71], a[84:87], v[216:219]
v_add_u32 v13, 0x8000, v13
v_accvgpr_write_b32 a181, v129
v_mfma_f32_16x16x32_bf16 v[220:223], a[72:75], a[84:87], v[220:223]
v_accvgpr_write_b32 a182, v130
v_accvgpr_write_b32 a183, v131
v_mfma_f32_16x16x32_bf16 v[220:223], a[52:55], a[80:83], v[220:223]
v_cvt_pk_bf16_f32 v136, v136, v137
v_cvt_pk_bf16_f32 v137, v138, v139
v_cvt_pk_bf16_f32 v138, v140, v141
v_mfma_f32_16x16x32_bf16 v[236:239], a[52:55], a[88:91], v[236:239]
s_waitcnt vmcnt(27) lgkmcnt(0)
v_cvt_pk_bf16_f32 v139, v142, v143
v_accvgpr_write_b32 a184, v136
v_mfma_f32_16x16x32_bf16 v[236:239], a[72:75], a[92:95], v[236:239]
s_barrier
s_add_u32 m0, s17, 0x8000
v_accvgpr_write_b32 a185, v137
v_mfma_f32_16x16x32_bf16 v[232:235], a[68:71], a[92:95], v[232:235]
buffer_load_dwordx4 v5, s[52:55], 0 offen lds
v_accvgpr_write_b32 a186, v138
v_mfma_f32_16x16x32_bf16 v[232:235], a[48:51], a[88:91], v[232:235]
ds_read_b64_tr_b16 a[80:81], v12 offset:0
v_accvgpr_write_b32 a187, v139
v_mfma_f32_16x16x32_bf16 v[228:231], a[44:47], a[88:91], v[228:231]
ds_read_b64_tr_b16 a[82:83], v12 offset:1024
v_cvt_pk_bf16_f32 v144, v144, v145
v_mfma_f32_16x16x32_bf16 v[228:231], a[64:67], a[92:95], v[228:231]
ds_read_b64_tr_b16 a[84:85], v12 offset:8192
s_waitcnt lgkmcnt(3)
v_cvt_pk_bf16_f32 v145, v146, v147
v_mfma_f32_16x16x32_bf16 v[224:227], a[60:63], a[92:95], v[224:227]
ds_read_b64_tr_b16 a[86:87], v12 offset:9216
s_add_u32 m0, s17, 0x8400
v_mfma_f32_16x16x32_bf16 v[224:227], a[40:43], a[88:91], v[224:227]
buffer_load_dwordx4 v5, s[52:55], s13 offen lds
v_mfma_f32_16x16x32_bf16 v[240:243], a[40:43], a[96:99], v[240:243]
ds_read_b64_tr_b16 a[88:89], v13 offset:0
v_cvt_pk_bf16_f32 v146, v148, v149
v_cvt_pk_bf16_f32 v147, v150, v151
v_mfma_f32_16x16x32_bf16 v[240:243], a[60:63], a[100:103], v[240:243]
ds_read_b64_tr_b16 a[90:91], v13 offset:1024
v_accvgpr_write_b32 a188, v144
v_mfma_f32_16x16x32_bf16 v[244:247], a[64:67], a[100:103], v[244:247]
ds_read_b64_tr_b16 a[92:93], v13 offset:8192
v_accvgpr_write_b32 a189, v145
v_mfma_f32_16x16x32_bf16 v[244:247], a[44:47], a[96:99], v[244:247]
ds_read_b64_tr_b16 a[94:95], v13 offset:9216
v_accvgpr_write_b32 a190, v146
v_accvgpr_write_b32 a191, v147
v_mfma_f32_16x16x32_bf16 a[232:235], a[48:51], a[96:99], a[232:235]
s_add_u32 m0, s17, 0x8800
v_cvt_pk_bf16_f32 v152, v152, v153
v_cvt_pk_bf16_f32 v153, v154, v155
v_mfma_f32_16x16x32_bf16 a[232:235], a[68:71], a[100:103], a[232:235]
buffer_load_dwordx4 v6, s[52:55], 0 offen lds
v_mfma_f32_16x16x32_bf16 a[236:239], a[72:75], a[100:103], a[236:239]
v_cvt_pk_bf16_f32 v154, v156, v157
v_cvt_pk_bf16_f32 v155, v158, v159
v_accvgpr_write_b32 a192, v152
v_mfma_f32_16x16x32_bf16 a[236:239], a[52:55], a[96:99], a[236:239]
v_accvgpr_write_b32 a193, v153
v_accvgpr_write_b32 a194, v154
v_mfma_f32_16x16x32_bf16 a[252:255], a[52:55], a[104:107], a[252:255]
ds_read_b64_tr_b16 a[96:97], v12 offset:256
v_accvgpr_write_b32 a195, v155
v_mfma_f32_16x16x32_bf16 a[252:255], a[72:75], a[108:111], a[252:255]
ds_read_b64_tr_b16 a[98:99], v12 offset:1280
v_cvt_pk_bf16_f32 v160, v160, v161
v_cvt_pk_bf16_f32 v161, v162, v163
v_mfma_f32_16x16x32_bf16 a[248:251], a[68:71], a[108:111], a[248:251]
ds_read_b64_tr_b16 a[100:101], v12 offset:8448
s_add_u32 m0, s17, 0x8c00
v_mfma_f32_16x16x32_bf16 a[248:251], a[48:51], a[104:107], a[248:251]
buffer_load_dwordx4 v6, s[52:55], s13 offen lds
v_mfma_f32_16x16x32_bf16 a[244:247], a[44:47], a[104:107], a[244:247]
ds_read_b64_tr_b16 a[102:103], v12 offset:9472
v_cvt_pk_bf16_f32 v162, v164, v165
v_cvt_pk_bf16_f32 v163, v166, v167
v_mfma_f32_16x16x32_bf16 a[244:247], a[64:67], a[108:111], a[244:247]
v_accvgpr_write_b32 a196, v160
v_accvgpr_write_b32 a197, v161
v_mfma_f32_16x16x32_bf16 a[240:243], a[60:63], a[108:111], a[240:243]
v_accvgpr_write_b32 a198, v162
v_accvgpr_write_b32 a199, v163
v_mfma_f32_16x16x32_bf16 a[240:243], a[40:43], a[104:107], a[240:243]
s_add_u32 m0, s18, 0xc000
s_waitcnt lgkmcnt(4)
v_cvt_pk_bf16_f32 v168, v168, v169
v_cvt_pk_bf16_f32 v169, v170, v171
L_S8:
v_mfma_f32_16x16x32_bf16 v[24:27], a[80:83], a[0:3], 0
ds_read_b64_tr_b16 a[104:105], v13 offset:256
s_waitcnt vmcnt(23)
v_mfma_f32_16x16x32_bf16 v[24:27], a[84:87], a[20:23], v[24:27]
buffer_load_dwordx4 v7, s[68:71], 0 offen lds
v_mfma_f32_16x16x32_bf16 v[32:35], a[84:87], a[24:27], 0
ds_read_b64_tr_b16 a[106:107], v13 offset:1280
v_cvt_pk_bf16_f32 v170, v172, v173
v_cvt_pk_bf16_f32 v171, v174, v175
v_mfma_f32_16x16x32_bf16 v[32:35], a[80:83], a[4:7], v[32:35]
ds_read_b64_tr_b16 a[108:109], v13 offset:8448
v_accvgpr_write_b32 a200, v168
v_mfma_f32_16x16x32_bf16 v[40:43], a[80:83], a[8:11], 0
ds_read_b64_tr_b16 a[110:111], v13 offset:9472
v_accvgpr_write_b32 a201, v169
v_mfma_f32_16x16x32_bf16 v[40:43], a[84:87], a[28:31], v[40:43]
ds_read_b128 a[40:43], v8 offset:32768
v_accvgpr_write_b32 a202, v170
v_accvgpr_write_b32 a203, v171
v_mfma_f32_16x16x32_bf16 v[48:51], a[84:87], a[32:35], 0
ds_read_b128 a[60:63], v9 offset:32768
s_add_u32 s8, s28, 0x2000
v_mfma_f32_16x16x32_bf16 v[48:51], a[80:83], a[12:15], v[48:51]
buffer_store_dwordx4 a[128:131], v16, s[88:91], s8 offen sc1
v_mfma_f32_16x16x32_bf16 v[52:55], a[88:91], a[12:15], 0
ds_read_b64_tr_b16 a[80:81], v12 offset:512
v_cvt_pk_bf16_f32 v176, v176, v177
v_cvt_pk_bf16_f32 v177, v178, v179
v_mfma_f32_16x16x32_bf16 v[52:55], a[92:95], a[32:35], v[52:55]
ds_read_b64_tr_b16 a[82:83], v12 offset:1536
v_cvt_pk_bf16_f32 v178, v180, v181
v_mfma_f32_16x16x32_bf16 v[44:47], a[92:95], a[28:31], 0
ds_read_b64_tr_b16 a[84:85], v12 offset:8704
v_cvt_pk_bf16_f32 v179, v182, v183
v_mfma_f32_16x16x32_bf16 v[44:47], a[88:91], a[8:11], v[44:47]
ds_read_b64_tr_b16 a[86:87], v12 offset:9728
v_accvgpr_write_b32 a204, v176
v_accvgpr_write_b32 a205, v177
v_mfma_f32_16x16x32_bf16 v[36:39], a[88:91], a[4:7], 0
ds_read_b128 a[44:47], v8 offset:34816
s_add_u32 m0, s18, 0xd000
v_mfma_f32_16x16x32_bf16 v[36:39], a[92:95], a[24:27], v[36:39]
buffer_load_dwordx4 v7, s[68:71], s25 offen lds
v_mfma_f32_16x16x32_bf16 v[28:31], a[92:95], a[20:23], 0
ds_read_b128 a[64:67], v9 offset:34816
v_accvgpr_write_b32 a206, v178
v_accvgpr_write_b32 a207, v179
v_mfma_f32_16x16x32_bf16 v[28:31], a[88:91], a[0:3], v[28:31]
ds_read_b128 a[48:51], v8 offset:36864
s_waitcnt lgkmcnt(9)
v_mfma_f32_16x16x32_bf16 v[56:59], a[96:99], a[0:3], 0
ds_read_b64_tr_b16 a[88:89], v13 offset:512
v_cvt_pk_bf16_f32 v184, v184, v185
v_mfma_f32_16x16x32_bf16 v[56:59], a[100:103], a[20:23], v[56:59]
ds_read_b64_tr_b16 a[90:91], v13 offset:1536
v_cvt_pk_bf16_f32 v185, v186, v187
v_cvt_pk_bf16_f32 v186, v188, v189
v_mfma_f32_16x16x32_bf16 v[64:67], a[100:103], a[24:27], 0
ds_read_b64_tr_b16 a[92:93], v13 offset:8704
s_add_u32 m0, s18, 0xe000
v_mfma_f32_16x16x32_bf16 v[64:67], a[96:99], a[4:7], v[64:67]
buffer_load_dwordx4 v7, s[68:71], s26 offen lds
v_mfma_f32_16x16x32_bf16 v[72:75], a[96:99], a[8:11], 0
ds_read_b64_tr_b16 a[94:95], v13 offset:9728
v_cvt_pk_bf16_f32 v187, v190, v191
v_accvgpr_write_b32 a208, v184
v_mfma_f32_16x16x32_bf16 v[72:75], a[100:103], a[28:31], v[72:75]
ds_read_b128 a[68:71], v9 offset:36864
v_accvgpr_write_b32 a209, v185
v_mfma_f32_16x16x32_bf16 v[80:83], a[100:103], a[32:35], 0
ds_read_b128 a[52:55], v8 offset:38912
v_accvgpr_write_b32 a210, v186
v_mfma_f32_16x16x32_bf16 v[80:83], a[96:99], a[12:15], v[80:83]
ds_read_b128 a[72:75], v9 offset:38912
v_accvgpr_write_b32 a211, v187
v_cvt_pk_bf16_f32 v192, v192, v193
v_mfma_f32_16x16x32_bf16 v[84:87], a[104:107], a[12:15], 0
ds_read_b64_tr_b16 a[96:97], v12 offset:768
s_add_u32 m0, s18, 0xf000
v_mfma_f32_16x16x32_bf16 v[84:87], a[108:111], a[32:35], v[84:87]
buffer_load_dwordx4 v4, s[44:47], s24 offen lds
v_mfma_f32_16x16x32_bf16 v[76:79], a[108:111], a[28:31], 0
ds_read_b64_tr_b16 a[98:99], v12 offset:1792
v_add_u32 v5, 0x80000, v5
v_cvt_pk_bf16_f32 v193, v194, v195
v_mfma_f32_16x16x32_bf16 v[76:79], a[104:107], a[8:11], v[76:79]
ds_read_b64_tr_b16 a[100:101], v12 offset:8960
v_add_u32 v6, 0x80000, v6
v_mfma_f32_16x16x32_bf16 v[68:71], a[104:107], a[4:7], 0
ds_read_b64_tr_b16 a[102:103], v12 offset:9984
v_add_u32 v7, 0x60000, v7
v_mfma_f32_16x16x32_bf16 v[68:71], a[108:111], a[24:27], v[68:71]
ds_read_b128 a[16:19], v10
v_add_u32 v4, 0x80, v4
v_cvt_pk_bf16_f32 v194, v196, v197
v_mfma_f32_16x16x32_bf16 v[60:63], a[108:111], a[20:23], 0
ds_read_b128 a[36:39], v11
s_add_u32 m0, s16, 0x8000
s_waitcnt lgkmcnt(6)
v_mfma_f32_16x16x32_bf16 v[60:63], a[104:107], a[0:3], v[60:63]
buffer_load_dwordx4 v22, s[44:47], s20 offen lds
s_waitcnt lgkmcnt(9)
v_mfma_f32_16x16x32_bf16 v[88:91], a[80:83], a[0:3], 0
ds_read_b64_tr_b16 a[104:105], v13 offset:768
v_cvt_pk_bf16_f32 v195, v198, v199
v_accvgpr_write_b32 a212, v192
v_mfma_f32_16x16x32_bf16 v[88:91], a[84:87], a[20:23], v[88:91]
ds_read_b64_tr_b16 a[106:107], v13 offset:1792
v_accvgpr_write_b32 a213, v193
v_mfma_f32_16x16x32_bf16 v[96:99], a[84:87], a[24:27], 0
ds_read_b64_tr_b16 a[108:109], v13 offset:8960
v_accvgpr_write_b32 a214, v194
v_mfma_f32_16x16x32_bf16 v[96:99], a[80:83], a[4:7], v[96:99]
ds_read_b64_tr_b16 a[110:111], v13 offset:9984
s_add_u32 m0, s16, 0x8400
v_accvgpr_write_b32 a215, v195
v_mfma_f32_16x16x32_bf16 v[104:107], a[80:83], a[8:11], 0
buffer_load_dwordx4 v23, s[44:47], s20 offen lds
v_mfma_f32_16x16x32_bf16 v[104:107], a[84:87], a[28:31], v[104:107]
v_cvt_pk_bf16_f32 v200, v200, v201
v_cvt_pk_bf16_f32 v201, v202, v203
v_mfma_f32_16x16x32_bf16 v[112:115], a[84:87], a[32:35], 0
v_cvt_pk_bf16_f32 v202, v204, v205
v_cvt_pk_bf16_f32 v203, v206, v207
v_accvgpr_write_b32 a216, v200
v_mfma_f32_16x16x32_bf16 v[112:115], a[80:83], a[12:15], v[112:115]
v_accvgpr_write_b32 a217, v201
v_accvgpr_write_b32 a218, v202
v_mfma_f32_16x16x32_bf16 v[116:119], a[88:91], a[12:15], 0
ds_read_b64_tr_b16 a[80:81], v14 offset:0
v_accvgpr_write_b32 a219, v203
v_mfma_f32_16x16x32_bf16 v[116:119], a[92:95], a[32:35], v[116:119]
ds_read_b64_tr_b16 a[82:83], v14 offset:256
s_add_u32 s8, s28, 0x3000
v_cvt_pk_bf16_f32 v208, v208, v209
v_mfma_f32_16x16x32_bf16 v[108:111], a[92:95], a[28:31], 0
buffer_store_dwordx4 a[132:135], v16, s[88:91], s8 offen sc1
v_mfma_f32_16x16x32_bf16 v[108:111], a[88:91], a[8:11], v[108:111]
ds_read_b64_tr_b16 a[84:85], v14 offset:2048
v_cvt_pk_bf16_f32 v209, v210, v211
v_mfma_f32_16x16x32_bf16 v[100:103], a[88:91], a[4:7], 0
ds_read_b64_tr_b16 a[86:87], v14 offset:2304
v_cvt_pk_bf16_f32 v210, v212, v213
v_cvt_pk_bf16_f32 v211, v214, v215
v_mfma_f32_16x16x32_bf16 v[100:103], a[92:95], a[24:27], v[100:103]
v_accvgpr_write_b32 a220, v208
v_accvgpr_write_b32 a221, v209
v_mfma_f32_16x16x32_bf16 v[92:95], a[92:95], a[20:23], 0
v_accvgpr_write_b32 a222, v210
v_accvgpr_write_b32 a223, v211
v_mfma_f32_16x16x32_bf16 v[92:95], a[88:91], a[0:3], v[92:95]
s_add_u32 m0, s16, 0x8800
s_waitcnt lgkmcnt(4)
v_cvt_pk_bf16_f32 v248, v248, v249
v_cvt_pk_bf16_f32 v249, v250, v251
v_mfma_f32_16x16x32_bf16 v[120:123], a[96:99], a[0:3], 0
buffer_load_dwordx4 v22, s[44:47], s21 offen lds
v_mfma_f32_16x16x32_bf16 v[120:123], a[100:103], a[20:23], v[120:123]
ds_read_b64_tr_b16 a[88:89], v15 offset:0
v_cvt_pk_bf16_f32 v250, v252, v253
v_mfma_f32_16x16x32_bf16 v[128:131], a[100:103], a[24:27], 0
ds_read_b64_tr_b16 a[90:91], v15 offset:256
v_cvt_pk_bf16_f32 v251, v254, v255
v_accvgpr_write_b32 a224, v248
v_mfma_f32_16x16x32_bf16 v[128:131], a[96:99], a[4:7], v[128:131]
ds_read_b64_tr_b16 a[92:93], v15 offset:2048
v_accvgpr_write_b32 a225, v249
v_mfma_f32_16x16x32_bf16 v[136:139], a[96:99], a[8:11], 0
ds_read_b64_tr_b16 a[94:95], v15 offset:2304
v_accvgpr_write_b32 a226, v250
v_mfma_f32_16x16x32_bf16 v[136:139], a[100:103], a[28:31], v[136:139]
s_add_u32 m0, s16, 0x8c00
v_accvgpr_write_b32 a227, v251
v_cvt_pk_bf16_f32 v216, v216, v217
v_cvt_pk_bf16_f32 v217, v218, v219
v_mfma_f32_16x16x32_bf16 v[144:147], a[100:103], a[32:35], 0
buffer_load_dwordx4 v23, s[44:47], s21 offen lds
v_mfma_f32_16x16x32_bf16 v[144:147], a[96:99], a[12:15], v[144:147]
v_cvt_pk_bf16_f32 v218, v220, v221
v_cvt_pk_bf16_f32 v219, v222, v223
v_mfma_f32_16x16x32_bf16 v[148:151], a[104:107], a[12:15], 0
ds_read_b64_tr_b16 a[96:97], v14 offset:4096
v_accvgpr_write_b32 a228, v216
v_accvgpr_write_b32 a229, v217
v_mfma_f32_16x16x32_bf16 v[148:151], a[108:111], a[32:35], v[148:151]
ds_read_b64_tr_b16 a[98:99], v14 offset:4352
v_accvgpr_write_b32 a230, v218
v_mfma_f32_16x16x32_bf16 v[140:143], a[108:111], a[28:31], 0
ds_read_b64_tr_b16 a[100:101], v14 offset:6144
v_accvgpr_write_b32 a231, v219
v_mfma_f32_16x16x32_bf16 v[140:143], a[104:107], a[8:11], v[140:143]
ds_read_b64_tr_b16 a[102:103], v14 offset:6400
s_add_u32 m0, s16, 0x9000
v_cvt_pk_bf16_f32 v224, v224, v225
v_mfma_f32_16x16x32_bf16 v[132:135], a[104:107], a[4:7], 0
buffer_load_dwordx4 v22, s[44:47], s22 offen lds
v_mfma_f32_16x16x32_bf16 v[132:135], a[108:111], a[24:27], v[132:135]
v_cvt_pk_bf16_f32 v225, v226, v227
v_cvt_pk_bf16_f32 v226, v228, v229
v_mfma_f32_16x16x32_bf16 v[124:127], a[108:111], a[20:23], 0
v_cvt_pk_bf16_f32 v227, v230, v231
v_accvgpr_write_b32 a112, v224
v_accvgpr_write_b32 a113, v225
v_mfma_f32_16x16x32_bf16 v[124:127], a[104:107], a[0:3], v[124:127]
s_waitcnt lgkmcnt(4)
v_accvgpr_write_b32 a114, v226
v_accvgpr_write_b32 a115, v227
v_mfma_f32_16x16x32_bf16 v[152:155], a[80:83], a[0:3], 0
ds_read_b64_tr_b16 a[104:105], v15 offset:4096
v_cvt_pk_bf16_f32 v232, v232, v233
v_mfma_f32_16x16x32_bf16 v[152:155], a[84:87], a[20:23], v[152:155]
ds_read_b64_tr_b16 a[106:107], v15 offset:4352
s_add_u32 m0, s16, 0x9400
v_cvt_pk_bf16_f32 v233, v234, v235
v_mfma_f32_16x16x32_bf16 v[160:163], a[84:87], a[24:27], 0
buffer_load_dwordx4 v23, s[44:47], s22 offen lds
v_mfma_f32_16x16x32_bf16 v[160:163], a[80:83], a[4:7], v[160:163]
ds_read_b64_tr_b16 a[108:109], v15 offset:6144
v_cvt_pk_bf16_f32 v234, v236, v237
v_mfma_f32_16x16x32_bf16 v[168:171], a[80:83], a[8:11], 0
ds_read_b64_tr_b16 a[110:111], v15 offset:6400
v_cvt_pk_bf16_f32 v235, v238, v239
v_accvgpr_write_b32 a116, v232
v_mfma_f32_16x16x32_bf16 v[168:171], a[84:87], a[28:31], v[168:171]
v_accvgpr_write_b32 a117, v233
v_accvgpr_write_b32 a118, v234
v_mfma_f32_16x16x32_bf16 v[176:179], a[84:87], a[32:35], 0
v_accvgpr_write_b32 a119, v235
v_cvt_pk_bf16_f32 v240, v240, v241
v_mfma_f32_16x16x32_bf16 v[176:179], a[80:83], a[12:15], v[176:179]
s_add_u32 m0, s16, 0x9800
v_cvt_pk_bf16_f32 v241, v242, v243
v_cvt_pk_bf16_f32 v242, v244, v245
v_cvt_pk_bf16_f32 v243, v246, v247
v_mfma_f32_16x16x32_bf16 v[180:183], a[88:91], a[12:15], 0
buffer_load_dwordx4 v22, s[44:47], s23 offen lds
v_mfma_f32_16x16x32_bf16 v[180:183], a[92:95], a[32:35], v[180:183]
ds_read_b64_tr_b16 a[80:81], v14 offset:8192
v_accvgpr_write_b32 a124, v240
v_mfma_f32_16x16x32_bf16 v[172:175], a[92:95], a[28:31], 0
ds_read_b64_tr_b16 a[82:83], v14 offset:8448
v_accvgpr_write_b32 a125, v241
v_accvgpr_write_b32 a126, v242
v_mfma_f32_16x16x32_bf16 v[172:175], a[88:91], a[8:11], v[172:175]
ds_read_b64_tr_b16 a[84:85], v14 offset:10240
v_accvgpr_write_b32 a127, v243
v_mfma_f32_16x16x32_bf16 v[164:167], a[88:91], a[4:7], 0
ds_read_b64_tr_b16 a[86:87], v14 offset:10496
v_accvgpr_read_b32 v2, a232
v_mfma_f32_16x16x32_bf16 v[164:167], a[92:95], a[24:27], v[164:167]
s_add_u32 m0, s16, 0x9c00
v_accvgpr_read_b32 v3, a233
v_cvt_pk_bf16_f32 v2, v2, v3
v_accvgpr_write_b32 a232, v2
v_mfma_f32_16x16x32_bf16 v[156:159], a[92:95], a[20:23], 0
buffer_load_dwordx4 v23, s[44:47], s23 offen lds
v_mfma_f32_16x16x32_bf16 v[156:159], a[88:91], a[0:3], v[156:159]
s_waitcnt lgkmcnt(4)
v_add_u32 v22, 0x80, v22
v_add_u32 v23, 0x80, v23
v_mfma_f32_16x16x32_bf16 v[184:187], a[96:99], a[0:3], 0
ds_read_b64_tr_b16 a[88:89], v15 offset:8192
v_accvgpr_read_b32 v2, a234
v_accvgpr_read_b32 v3, a235
v_mfma_f32_16x16x32_bf16 v[184:187], a[100:103], a[20:23], v[184:187]
ds_read_b64_tr_b16 a[90:91], v15 offset:8448
v_cvt_pk_bf16_f32 v2, v2, v3
v_mfma_f32_16x16x32_bf16 v[192:195], a[100:103], a[24:27], 0
ds_read_b64_tr_b16 a[92:93], v15 offset:10240
v_accvgpr_write_b32 a233, v2
v_mfma_f32_16x16x32_bf16 v[192:195], a[96:99], a[4:7], v[192:195]
ds_read_b64_tr_b16 a[94:95], v15 offset:10496
s_add_u32 s8, s28, 0x6000
v_accvgpr_read_b32 v2, a236
v_mfma_f32_16x16x32_bf16 v[200:203], a[96:99], a[8:11], 0
buffer_store_dwordx4 a[136:139], v16, s[88:91], s8 offen sc1
v_mfma_f32_16x16x32_bf16 v[200:203], a[100:103], a[28:31], v[200:203]
v_add_u32 v12, 0xffff0000, v12
v_add_u32 v13, 0xffff0000, v13
v_mfma_f32_16x16x32_bf16 v[208:211], a[100:103], a[32:35], 0
v_add_u32 v14, 0xffff0000, v14
v_add_u32 v15, 0xffff0000, v15
v_accvgpr_read_b32 v3, a237
v_mfma_f32_16x16x32_bf16 v[208:211], a[96:99], a[12:15], v[208:211]
v_add_u32 v10, 0xffff0000, v10
v_add_u32 v11, 0xffff0000, v11
v_mfma_f32_16x16x32_bf16 v[248:251], a[96:99], a[16:19], 0
v_cvt_pk_bf16_f32 v2, v2, v3
v_accvgpr_write_b32 a234, v2
v_mfma_f32_16x16x32_bf16 v[248:251], a[100:103], a[36:39], v[248:251]
v_accvgpr_read_b32 v2, a238
v_accvgpr_read_b32 v3, a239
v_cvt_pk_bf16_f32 v2, v2, v3
v_mfma_f32_16x16x32_bf16 v[212:215], a[104:107], a[12:15], 0
s_waitcnt vmcnt(29) lgkmcnt(0)
v_accvgpr_write_b32 a235, v2
v_accvgpr_read_b32 v2, a240
v_mfma_f32_16x16x32_bf16 v[212:215], a[108:111], a[32:35], v[212:215]
s_barrier
s_add_u32 m0, s17, 0x10000
v_accvgpr_read_b32 v3, a241
v_mfma_f32_16x16x32_bf16 v[204:207], a[108:111], a[28:31], 0
buffer_load_dwordx4 v5, s[52:55], 0 offen lds
v_cvt_pk_bf16_f32 v2, v2, v3
v_mfma_f32_16x16x32_bf16 v[204:207], a[104:107], a[8:11], v[204:207]
ds_read_b64_tr_b16 a[96:97], v12 offset:0
v_accvgpr_write_b32 a240, v2
v_mfma_f32_16x16x32_bf16 v[196:199], a[104:107], a[4:7], 0
ds_read_b64_tr_b16 a[98:99], v12 offset:1024
v_accvgpr_read_b32 v2, a242
v_mfma_f32_16x16x32_bf16 v[196:199], a[108:111], a[24:27], v[196:199]
ds_read_b64_tr_b16 a[100:101], v12 offset:8192
v_accvgpr_read_b32 v3, a243
v_cvt_pk_bf16_f32 v2, v2, v3
v_mfma_f32_16x16x32_bf16 v[188:191], a[108:111], a[20:23], 0
ds_read_b64_tr_b16 a[102:103], v12 offset:9216
v_accvgpr_write_b32 a241, v2
v_mfma_f32_16x16x32_bf16 v[188:191], a[104:107], a[0:3], v[188:191]
s_add_u32 m0, s17, 0x10400
s_waitcnt lgkmcnt(4)
v_accvgpr_read_b32 v2, a244
v_mfma_f32_16x16x32_bf16 v[216:219], a[0:3], a[80:83], 0
buffer_load_dwordx4 v5, s[52:55], s13 offen lds
v_accvgpr_read_b32 v3, a245
v_mfma_f32_16x16x32_bf16 v[216:219], a[20:23], a[84:87], v[216:219]
ds_read_b64_tr_b16 a[104:105], v13 offset:0
v_cvt_pk_bf16_f32 v2, v2, v3
v_mfma_f32_16x16x32_bf16 v[224:227], a[24:27], a[84:87], 0
ds_read_b64_tr_b16 a[106:107], v13 offset:1024
v_accvgpr_write_b32 a242, v2
v_mfma_f32_16x16x32_bf16 v[224:227], a[4:7], a[80:83], v[224:227]
ds_read_b64_tr_b16 a[108:109], v13 offset:8192
v_accvgpr_read_b32 v2, a246
v_accvgpr_read_b32 v3, a247
v_mfma_f32_16x16x32_bf16 v[232:235], a[8:11], a[80:83], 0
ds_read_b64_tr_b16 a[110:111], v13 offset:9216
v_cvt_pk_bf16_f32 v2, v2, v3
v_mfma_f32_16x16x32_bf16 v[232:235], a[28:31], a[84:87], v[232:235]
s_add_u32 m0, s17, 0x10800
v_accvgpr_write_b32 a243, v2
v_accvgpr_read_b32 v2, a248
v_mfma_f32_16x16x32_bf16 v[240:243], a[32:35], a[84:87], 0
buffer_load_dwordx4 v6, s[52:55], 0 offen lds
v_accvgpr_read_b32 v3, a249
v_mfma_f32_16x16x32_bf16 v[240:243], a[12:15], a[80:83], v[240:243]
v_cvt_pk_bf16_f32 v2, v2, v3
v_accvgpr_write_b32 a248, v2
v_mfma_f32_16x16x32_bf16 v[252:255], a[16:19], a[80:83], 0
v_accvgpr_read_b32 v2, a250
v_accvgpr_read_b32 v3, a251
v_mfma_f32_16x16x32_bf16 v[252:255], a[36:39], a[84:87], v[252:255]
v_cvt_pk_bf16_f32 v2, v2, v3
v_accvgpr_write_b32 a249, v2
v_accvgpr_read_b32 v2, a252
v_mfma_f32_16x16x32_bf16 v[244:247], a[12:15], a[88:91], 0
ds_read_b64_tr_b16 a[80:81], v12 offset:256
v_accvgpr_read_b32 v3, a253
v_mfma_f32_16x16x32_bf16 v[244:247], a[32:35], a[92:95], v[244:247]
ds_read_b64_tr_b16 a[82:83], v12 offset:1280
s_add_u32 m0, s17, 0x10c00
v_mfma_f32_16x16x32_bf16 v[236:239], a[28:31], a[92:95], 0
buffer_load_dwordx4 v6, s[52:55], s13 offen lds
v_cvt_pk_bf16_f32 v2, v2, v3
v_mfma_f32_16x16x32_bf16 v[236:239], a[8:11], a[88:91], v[236:239]
ds_read_b64_tr_b16 a[84:85], v12 offset:8448
v_accvgpr_write_b32 a250, v2
v_mfma_f32_16x16x32_bf16 v[228:231], a[4:7], a[88:91], 0
ds_read_b64_tr_b16 a[86:87], v12 offset:9472
v_accvgpr_read_b32 v2, a254
v_mfma_f32_16x16x32_bf16 v[228:231], a[24:27], a[92:95], v[228:231]
L_padA5:
s_cmp_eq_u32 s95, 1
s_cbranch_scc1 L_padA9
v_accvgpr_read_b32 v3, a255
v_cvt_pk_bf16_f32 v2, v2, v3
v_accvgpr_write_b32 a251, v2
v_mfma_f32_16x16x32_bf16 v[220:223], a[20:23], a[92:95], 0
v_mfma_f32_16x16x32_bf16 v[220:223], a[0:3], a[88:91], v[220:223]
s_add_u32 m0, s18, 0x14000
s_waitcnt lgkmcnt(4)
L_S9:
v_mfma_f32_16x16x32_bf16 v[24:27], a[96:99], a[40:43], v[24:27]
buffer_load_dwordx4 v7, s[68:71], 0 offen lds
v_mfma_f32_16x16x32_bf16 v[24:27], a[100:103], a[60:63], v[24:27]
ds_read_b64_tr_b16 a[88:89], v13 offset:256
s_waitcnt vmcnt(25)
v_mfma_f32_16x16x32_bf16 v[32:35], a[100:103], a[64:67], v[32:35]
ds_read_b64_tr_b16 a[90:91], v13 offset:1280
v_mfma_f32_16x16x32_bf16 v[32:35], a[96:99], a[44:47], v[32:35]
ds_read_b64_tr_b16 a[92:93], v13 offset:8448
v_mfma_f32_16x16x32_bf16 v[40:43], a[96:99], a[48:51], v[40:43]
ds_read_b64_tr_b16 a[94:95], v13 offset:9472
v_mfma_f32_16x16x32_bf16 v[40:43], a[100:103], a[68:71], v[40:43]
ds_read_b128 a[0:3], v8 offset:0
s_add_u32 s8, s28, 0x7000
v_mfma_f32_16x16x32_bf16 v[48:51], a[100:103], a[72:75], v[48:51]
buffer_store_dwordx4 a[140:143], v16, s[88:91], s8 offen sc1
v_mfma_f32_16x16x32_bf16 v[48:51], a[96:99], a[52:55], v[48:51]
ds_read_b128 a[20:23], v9 offset:0
v_mfma_f32_16x16x32_bf16 v[52:55], a[104:107], a[52:55], v[52:55]
ds_read_b64_tr_b16 a[96:97], v12 offset:512
v_mfma_f32_16x16x32_bf16 v[52:55], a[108:111], a[72:75], v[52:55]
ds_read_b64_tr_b16 a[98:99], v12 offset:1536
v_mfma_f32_16x16x32_bf16 v[44:47], a[108:111], a[68:71], v[44:47]
ds_read_b64_tr_b16 a[100:101], v12 offset:8704
v_mfma_f32_16x16x32_bf16 v[44:47], a[104:107], a[48:51], v[44:47]
ds_read_b64_tr_b16 a[102:103], v12 offset:9728
s_add_u32 m0, s18, 0x15000
v_mfma_f32_16x16x32_bf16 v[36:39], a[104:107], a[44:47], v[36:39]
buffer_load_dwordx4 v7, s[68:71], s25 offen lds
v_mfma_f32_16x16x32_bf16 v[36:39], a[108:111], a[64:67], v[36:39]
ds_read_b128 a[4:7], v8 offset:2048
v_mfma_f32_16x16x32_bf16 v[28:31], a[108:111], a[60:63], v[28:31]
ds_read_b128 a[24:27], v9 offset:2048
v_mfma_f32_16x16x32_bf16 v[28:31], a[104:107], a[40:43], v[28:31]
ds_read_b128 a[8:11], v8 offset:4096
s_waitcnt lgkmcnt(9)
v_mfma_f32_16x16x32_bf16 v[56:59], a[80:83], a[40:43], v[56:59]
ds_read_b64_tr_b16 a[104:105], v13 offset:512
v_mfma_f32_16x16x32_bf16 v[56:59], a[84:87], a[60:63], v[56:59]
ds_read_b64_tr_b16 a[106:107], v13 offset:1536
s_add_u32 m0, s18, 0x16000
v_mfma_f32_16x16x32_bf16 v[64:67], a[84:87], a[64:67], v[64:67]
buffer_load_dwordx4 v7, s[68:71], s26 offen lds
v_mfma_f32_16x16x32_bf16 v[64:67], a[80:83], a[44:47], v[64:67]
ds_read_b64_tr_b16 a[108:109], v13 offset:8704
v_mfma_f32_16x16x32_bf16 v[72:75], a[80:83], a[48:51], v[72:75]
ds_read_b64_tr_b16 a[110:111], v13 offset:9728
v_mfma_f32_16x16x32_bf16 v[72:75], a[84:87], a[68:71], v[72:75]
ds_read_b128 a[28:31], v9 offset:4096
v_mfma_f32_16x16x32_bf16 v[80:83], a[84:87], a[72:75], v[80:83]
ds_read_b128 a[12:15], v8 offset:6144
v_mfma_f32_16x16x32_bf16 v[80:83], a[80:83], a[52:55], v[80:83]
ds_read_b128 a[32:35], v9 offset:6144
s_add_u32 m0, s18, 0x17000
v_mfma_f32_16x16x32_bf16 v[84:87], a[88:91], a[52:55], v[84:87]
buffer_load_dwordx4 v4, s[44:47], s24 offen lds
v_mfma_f32_16x16x32_bf16 v[84:87], a[92:95], a[72:75], v[84:87]
ds_read_b64_tr_b16 a[80:81], v12 offset:768
v_add_u32 v5, 0x80000, v5
v_mfma_f32_16x16x32_bf16 v[76:79], a[92:95], a[68:71], v[76:79]
ds_read_b64_tr_b16 a[82:83], v12 offset:1792
v_add_u32 v6, 0x80000, v6
v_mfma_f32_16x16x32_bf16 v[76:79], a[88:91], a[48:51], v[76:79]
ds_read_b64_tr_b16 a[84:85], v12 offset:8960
v_add_u32 v7, 0x60000, v7
v_mfma_f32_16x16x32_bf16 v[68:71], a[88:91], a[44:47], v[68:71]
ds_read_b64_tr_b16 a[86:87], v12 offset:9984
v_add_u32 v4, 0x80, v4
v_mfma_f32_16x16x32_bf16 v[68:71], a[92:95], a[64:67], v[68:71]
ds_read_b128 a[56:59], v10
s_add_u32 m0, s16, 0x0
s_waitcnt lgkmcnt(5)
v_mfma_f32_16x16x32_bf16 v[60:63], a[92:95], a[60:63], v[60:63]
buffer_load_dwordx4 v22, s[44:47], s20 offen lds
v_mfma_f32_16x16x32_bf16 v[60:63], a[88:91], a[40:43], v[60:63]
ds_read_b128 a[76:79], v11
s_waitcnt lgkmcnt(9)
v_mfma_f32_16x16x32_bf16 v[88:91], a[96:99], a[40:43], v[88:91]
ds_read_b64_tr_b16 a[88:89], v13 offset:768
v_mfma_f32_16x16x32_bf16 v[88:91], a[100:103], a[60:63], v[88:91]
ds_read_b64_tr_b16 a[90:91], v13 offset:1792
v_mfma_f32_16x16x32_bf16 v[96:99], a[100:103], a[64:67], v[96:99]
ds_read_b64_tr_b16 a[92:93], v13 offset:8960
v_mfma_f32_16x16x32_bf16 v[96:99], a[96:99], a[44:47], v[96:99]
ds_read_b64_tr_b16 a[94:95], v13 offset:9984
s_add_u32 m0, s16, 0x400
v_mfma_f32_16x16x32_bf16 v[104:107], a[96:99], a[48:51], v[104:107]
buffer_load_dwordx4 v23, s[44:47], s20 offen lds
v_mfma_f32_16x16x32_bf16 v[104:107], a[100:103], a[68:71], v[104:107]
v_mfma_f32_16x16x32_bf16 v[112:115], a[100:103], a[72:75], v[112:115]
v_mfma_f32_16x16x32_bf16 v[112:115], a[96:99], a[52:55], v[112:115]
v_mfma_f32_16x16x32_bf16 v[116:119], a[104:107], a[52:55], v[116:119]
ds_read_b64_tr_b16 a[96:97], v14 offset:0
v_mfma_f32_16x16x32_bf16 v[116:119], a[108:111], a[72:75], v[116:119]
ds_read_b64_tr_b16 a[98:99], v14 offset:256
s_add_u32 s8, s28, 0x2400
v_mfma_f32_16x16x32_bf16 v[108:111], a[108:111], a[68:71], v[108:111]
buffer_store_dwordx4 a[144:147], v16, s[88:91], s8 offen sc1
v_mfma_f32_16x16x32_bf16 v[108:111], a[104:107], a[48:51], v[108:111]
ds_read_b64_tr_b16 a[100:101], v14 offset:2048
v_mfma_f32_16x16x32_bf16 v[100:103], a[104:107], a[44:47], v[100:103]
ds_read_b64_tr_b16 a[102:103], v14 offset:2304
v_mfma_f32_16x16x32_bf16 v[100:103], a[108:111], a[64:67], v[100:103]
v_mfma_f32_16x16x32_bf16 v[92:95], a[108:111], a[60:63], v[92:95]
v_mfma_f32_16x16x32_bf16 v[92:95], a[104:107], a[40:43], v[92:95]
s_add_u32 m0, s16, 0x800
s_waitcnt lgkmcnt(4)
v_mfma_f32_16x16x32_bf16 v[120:123], a[80:83], a[40:43], v[120:123]
buffer_load_dwordx4 v22, s[44:47], s21 offen lds
v_mfma_f32_16x16x32_bf16 v[120:123], a[84:87], a[60:63], v[120:123]
ds_read_b64_tr_b16 a[104:105], v15 offset:0
v_mfma_f32_16x16x32_bf16 v[128:131], a[84:87], a[64:67], v[128:131]
ds_read_b64_tr_b16 a[106:107], v15 offset:256
v_mfma_f32_16x16x32_bf16 v[128:131], a[80:83], a[44:47], v[128:131]
ds_read_b64_tr_b16 a[108:109], v15 offset:2048
v_mfma_f32_16x16x32_bf16 v[136:139], a[80:83], a[48:51], v[136:139]
ds_read_b64_tr_b16 a[110:111], v15 offset:2304
v_mfma_f32_16x16x32_bf16 v[136:139], a[84:87], a[68:71], v[136:139]
s_add_u32 m0, s16, 0xc00
v_mfma_f32_16x16x32_bf16 v[144:147], a[84:87], a[72:75], v[144:147]
buffer_load_dwordx4 v23, s[44:47], s21 offen lds
v_mfma_f32_16x16x32_bf16 v[144:147], a[80:83], a[52:55], v[144:147]
v_mfma_f32_16x16x32_bf16 v[148:151], a[88:91], a[52:55], v[148:151]
ds_read_b64_tr_b16 a[80:81], v14 offset:4096
v_mfma_f32_16x16x32_bf16 v[148:151], a[92:95], a[72:75], v[148:151]
ds_read_b64_tr_b16 a[82:83], v14 offset:4352
v_mfma_f32_16x16x32_bf16 v[140:143], a[92:95], a[68:71], v[140:143]
ds_read_b64_tr_b16 a[84:85], v14 offset:6144
v_mfma_f32_16x16x32_bf16 v[140:143], a[88:91], a[48:51], v[140:143]
ds_read_b64_tr_b16 a[86:87], v14 offset:6400
s_add_u32 m0, s16, 0x1000
v_mfma_f32_16x16x32_bf16 v[132:135], a[88:91], a[44:47], v[132:135]
buffer_load_dwordx4 v22, s[44:47], s22 offen lds
v_mfma_f32_16x16x32_bf16 v[132:135], a[92:95], a[64:67], v[132:135]
v_mfma_f32_16x16x32_bf16 v[124:127], a[92:95], a[60:63], v[124:127]
v_mfma_f32_16x16x32_bf16 v[124:127], a[88:91], a[40:43], v[124:127]
s_waitcnt lgkmcnt(4)
v_mfma_f32_16x16x32_bf16 v[152:155], a[96:99], a[40:43], v[152:155]
ds_read_b64_tr_b16 a[88:89], v15 offset:4096
v_mfma_f32_16x16x32_bf16 v[152:155], a[100:103], a[60:63], v[152:155]
ds_read_b64_tr_b16 a[90:91], v15 offset:4352
s_add_u32 m0, s16, 0x1400
v_mfma_f32_16x16x32_bf16 v[160:163], a[100:103], a[64:67], v[160:163]
buffer_load_dwordx4 v23, s[44:47], s22 offen lds
v_mfma_f32_16x16x32_bf16 v[160:163], a[96:99], a[44:47], v[160:163]
ds_read_b64_tr_b16 a[92:93], v15 offset:6144
v_mfma_f32_16x16x32_bf16 v[168:171], a[96:99], a[48:51], v[168:171]
ds_read_b64_tr_b16 a[94:95], v15 offset:6400
v_mfma_f32_16x16x32_bf16 v[168:171], a[100:103], a[68:71], v[168:171]
v_mfma_f32_16x16x32_bf16 v[176:179], a[100:103], a[72:75], v[176:179]
v_mfma_f32_16x16x32_bf16 v[176:179], a[96:99], a[52:55], v[176:179]
s_add_u32 m0, s16, 0x1800
v_mfma_f32_16x16x32_bf16 v[180:183], a[104:107], a[52:55], v[180:183]
buffer_load_dwordx4 v22, s[44:47], s23 offen lds
v_mfma_f32_16x16x32_bf16 v[180:183], a[108:111], a[72:75], v[180:183]
ds_read_b64_tr_b16 a[96:97], v14 offset:8192
v_mfma_f32_16x16x32_bf16 v[172:175], a[108:111], a[68:71], v[172:175]
ds_read_b64_tr_b16 a[98:99], v14 offset:8448
v_mfma_f32_16x16x32_bf16 v[172:175], a[104:107], a[48:51], v[172:175]
ds_read_b64_tr_b16 a[100:101], v14 offset:10240
v_mfma_f32_16x16x32_bf16 v[164:167], a[104:107], a[44:47], v[164:167]
ds_read_b64_tr_b16 a[102:103], v14 offset:10496
v_mfma_f32_16x16x32_bf16 v[164:167], a[108:111], a[64:67], v[164:167]
s_add_u32 m0, s16, 0x1c00
v_mfma_f32_16x16x32_bf16 v[156:159], a[108:111], a[60:63], v[156:159]
buffer_load_dwordx4 v23, s[44:47], s23 offen lds
v_mfma_f32_16x16x32_bf16 v[156:159], a[104:107], a[40:43], v[156:159]
s_waitcnt lgkmcnt(4)
v_add_u32 v22, 0x80, v22
v_add_u32 v23, 0x80, v23
v_mfma_f32_16x16x32_bf16 v[184:187], a[80:83], a[40:43], v[184:187]
ds_read_b64_tr_b16 a[104:105], v15 offset:8192
v_mfma_f32_16x16x32_bf16 v[184:187], a[84:87], a[60:63], v[184:187]
ds_read_b64_tr_b16 a[106:107], v15 offset:8448
v_mfma_f32_16x16x32_bf16 v[192:195], a[84:87], a[64:67], v[192:195]
ds_read_b64_tr_b16 a[108:109], v15 offset:10240
v_mfma_f32_16x16x32_bf16 v[192:195], a[80:83], a[44:47], v[192:195]
ds_read_b64_tr_b16 a[110:111], v15 offset:10496
s_add_u32 s8, s28, 0x3400
v_mfma_f32_16x16x32_bf16 v[200:203], a[80:83], a[48:51], v[200:203]
buffer_store_dwordx4 a[148:151], v16, s[88:91], s8 offen sc1
v_mfma_f32_16x16x32_bf16 v[200:203], a[84:87], a[68:71], v[200:203]
v_add_u32 v12, 0x8000, v12
v_add_u32 v13, 0x8000, v13
v_mfma_f32_16x16x32_bf16 v[208:211], a[84:87], a[72:75], v[208:211]
v_add_u32 v14, 0x8000, v14
v_add_u32 v15, 0x8000, v15
v_mfma_f32_16x16x32_bf16 v[208:211], a[80:83], a[52:55], v[208:211]
v_add_u32 v10, 0x8000, v10
v_add_u32 v11, 0x8000, v11
v_mfma_f32_16x16x32_bf16 v[248:251], a[80:83], a[56:59], v[248:251]
v_mfma_f32_16x16x32_bf16 v[248:251], a[84:87], a[76:79], v[248:251]
v_mfma_f32_16x16x32_bf16 v[212:215], a[88:91], a[52:55], v[212:215]
s_waitcnt vmcnt(29) lgkmcnt(0)
v_mfma_f32_16x16x32_bf16 v[212:215], a[92:95], a[72:75], v[212:215]
s_barrier
s_add_u32 m0, s17, 0x0
v_mfma_f32_16x16x32_bf16 v[204:207], a[92:95], a[68:71], v[204:207]
buffer_load_dwordx4 v5, s[52:55], 0 offen lds
v_mfma_f32_16x16x32_bf16 v[204:207], a[88:91], a[48:51], v[204:207]
ds_read_b64_tr_b16 a[80:81], v12 offset:0
v_mfma_f32_16x16x32_bf16 v[196:199], a[88:91], a[44:47], v[196:199]
ds_read_b64_tr_b16 a[82:83], v12 offset:1024
v_mfma_f32_16x16x32_bf16 v[196:199], a[92:95], a[64:67], v[196:199]
ds_read_b64_tr_b16 a[84:85], v12 offset:8192
s_waitcnt lgkmcnt(3)
v_mfma_f32_16x16x32_bf16 v[188:191], a[92:95], a[60:63], v[188:191]
ds_read_b64_tr_b16 a[86:87], v12 offset:9216
s_add_u32 m0, s17, 0x400
v_mfma_f32_16x16x32_bf16 v[188:191], a[88:91], a[40:43], v[188:191]
buffer_load_dwordx4 v5, s[52:55], s13 offen lds
v_mfma_f32_16x16x32_bf16 v[216:219], a[40:43], a[96:99], v[216:219]
ds_read_b64_tr_b16 a[88:89], v13 offset:0
v_mfma_f32_16x16x32_bf16 v[216:219], a[60:63], a[100:103], v[216:219]
ds_read_b64_tr_b16 a[90:91], v13 offset:1024
v_mfma_f32_16x16x32_bf16 v[224:227], a[64:67], a[100:103], v[224:227]
ds_read_b64_tr_b16 a[92:93], v13 offset:8192
v_mfma_f32_16x16x32_bf16 v[224:227], a[44:47], a[96:99], v[224:227]
ds_read_b64_tr_b16 a[94:95], v13 offset:9216
v_mfma_f32_16x16x32_bf16 v[232:235], a[48:51], a[96:99], v[232:235]
s_add_u32 m0, s17, 0x800
v_mfma_f32_16x16x32_bf16 v[232:235], a[68:71], a[100:103], v[232:235]
buffer_load_dwordx4 v6, s[52:55], 0 offen lds
v_mfma_f32_16x16x32_bf16 v[240:243], a[72:75], a[100:103], v[240:243]
v_mfma_f32_16x16x32_bf16 v[240:243], a[52:55], a[96:99], v[240:243]
v_mfma_f32_16x16x32_bf16 v[252:255], a[56:59], a[96:99], v[252:255]
v_mfma_f32_16x16x32_bf16 v[252:255], a[76:79], a[100:103], v[252:255]
v_mfma_f32_16x16x32_bf16 v[244:247], a[52:55], a[104:107], v[244:247]
ds_read_b64_tr_b16 a[96:97], v12 offset:256
s_add_u32 m0, s17, 0xc00
v_mfma_f32_16x16x32_bf16 v[244:247], a[72:75], a[108:111], v[244:247]
buffer_load_dwordx4 v6, s[52:55], s13 offen lds
v_mfma_f32_16x16x32_bf16 v[236:239], a[68:71], a[108:111], v[236:239]
ds_read_b64_tr_b16 a[98:99], v12 offset:1280
v_mfma_f32_16x16x32_bf16 v[236:239], a[48:51], a[104:107], v[236:239]
ds_read_b64_tr_b16 a[100:101], v12 offset:8448
v_mfma_f32_16x16x32_bf16 v[228:231], a[44:47], a[104:107], v[228:231]
ds_read_b64_tr_b16 a[102:103], v12 offset:9472
v_mfma_f32_16x16x32_bf16 v[228:231], a[64:67], a[108:111], v[228:231]
v_add_u32 v20, s0, v16
v_mov_b32 v21, s1
v_mfma_f32_16x16x32_bf16 v[220:223], a[60:63], a[108:111], v[220:223]
global_load_dword a120, v[20:21], off sc1
v_mfma_f32_16x16x32_bf16 v[220:223], a[40:43], a[104:107], v[220:223]
s_waitcnt lgkmcnt(4)
L_S10:
v_mfma_f32_16x16x32_bf16 v[24:27], a[80:83], a[0:3], v[24:27]
ds_read_b64_tr_b16 a[104:105], v13 offset:256
s_waitcnt vmcnt(25)
v_mfma_f32_16x16x32_bf16 v[24:27], a[84:87], a[20:23], v[24:27]
ds_read_b64_tr_b16 a[106:107], v13 offset:1280
v_mfma_f32_16x16x32_bf16 v[32:35], a[84:87], a[24:27], v[32:35]
ds_read_b64_tr_b16 a[108:109], v13 offset:8448
v_mfma_f32_16x16x32_bf16 v[32:35], a[80:83], a[4:7], v[32:35]
ds_read_b64_tr_b16 a[110:111], v13 offset:9472
s_add_u32 m0, s18, 0x4000
v_mfma_f32_16x16x32_bf16 v[40:43], a[80:83], a[8:11], v[40:43]
buffer_load_dwordx4 v7, s[68:71], 0 offen lds
v_mfma_f32_16x16x32_bf16 v[40:43], a[84:87], a[28:31], v[40:43]
ds_read_b128 a[40:43], v8 offset:32768
v_mfma_f32_16x16x32_bf16 v[48:51], a[84:87], a[32:35], v[48:51]
ds_read_b128 a[60:63], v9 offset:32768
v_mfma_f32_16x16x32_bf16 v[48:51], a[80:83], a[12:15], v[48:51]
ds_read_b128 a[44:47], v8 offset:34816
v_mfma_f32_16x16x32_bf16 v[52:55], a[88:91], a[12:15], v[52:55]
ds_read_b64_tr_b16 a[80:81], v12 offset:512
v_mfma_f32_16x16x32_bf16 v[52:55], a[92:95], a[32:35], v[52:55]
ds_read_b64_tr_b16 a[82:83], v12 offset:1536
s_add_u32 m0, s18, 0x5000
v_mfma_f32_16x16x32_bf16 v[44:47], a[92:95], a[28:31], v[44:47]
buffer_load_dwordx4 v7, s[68:71], s25 offen lds
v_mfma_f32_16x16x32_bf16 v[44:47], a[88:91], a[8:11], v[44:47]
ds_read_b64_tr_b16 a[84:85], v12 offset:8704
v_mfma_f32_16x16x32_bf16 v[36:39], a[88:91], a[4:7], v[36:39]
ds_read_b64_tr_b16 a[86:87], v12 offset:9728
v_mfma_f32_16x16x32_bf16 v[36:39], a[92:95], a[24:27], v[36:39]
ds_read_b128 a[64:67], v9 offset:34816
s_waitcnt lgkmcnt(8)
v_mfma_f32_16x16x32_bf16 v[28:31], a[92:95], a[20:23], v[28:31]
ds_read_b128 a[48:51], v8 offset:36864
s_add_u32 m0, s18, 0x6000
v_mfma_f32_16x16x32_bf16 v[28:31], a[88:91], a[0:3], v[28:31]
buffer_load_dwordx4 v7, s[68:71], s26 offen lds
v_mfma_f32_16x16x32_bf16 v[56:59], a[96:99], a[0:3], v[56:59]
ds_read_b64_tr_b16 a[88:89], v13 offset:512
v_mfma_f32_16x16x32_bf16 v[56:59], a[100:103], a[20:23], v[56:59]
ds_read_b64_tr_b16 a[90:91], v13 offset:1536
v_mfma_f32_16x16x32_bf16 v[64:67], a[100:103], a[24:27], v[64:67]
ds_read_b64_tr_b16 a[92:93], v13 offset:8704
v_mfma_f32_16x16x32_bf16 v[64:67], a[96:99], a[4:7], v[64:67]
ds_read_b64_tr_b16 a[94:95], v13 offset:9728
v_mfma_f32_16x16x32_bf16 v[72:75], a[96:99], a[8:11], v[72:75]
ds_read_b128 a[68:71], v9 offset:36864
s_add_u32 m0, s18, 0x7000
v_mfma_f32_16x16x32_bf16 v[72:75], a[100:103], a[28:31], v[72:75]
buffer_load_dwordx4 v4, s[44:47], s24 offen lds
v_mfma_f32_16x16x32_bf16 v[80:83], a[100:103], a[32:35], v[80:83]
ds_read_b128 a[52:55], v8 offset:38912
v_add_u32 v5, 0x80000, v5
v_mfma_f32_16x16x32_bf16 v[80:83], a[96:99], a[12:15], v[80:83]
ds_read_b128 a[72:75], v9 offset:38912
v_add_u32 v6, 0x80000, v6
v_mfma_f32_16x16x32_bf16 v[84:87], a[104:107], a[12:15], v[84:87]
ds_read_b64_tr_b16 a[96:97], v12 offset:768
v_add_u32 v7, 0x60000, v7
v_mfma_f32_16x16x32_bf16 v[84:87], a[108:111], a[32:35], v[84:87]
ds_read_b64_tr_b16 a[98:99], v12 offset:1792
v_add_u32 v4, 0x80, v4
v_mfma_f32_16x16x32_bf16 v[76:79], a[108:111], a[28:31], v[76:79]
ds_read_b64_tr_b16 a[100:101], v12 offset:8960
s_add_u32 s8, s28, 0x6400
v_mfma_f32_16x16x32_bf16 v[76:79], a[104:107], a[8:11], v[76:79]
buffer_store_dwordx4 a[152:155], v16, s[88:91], s8 offen sc1
v_mfma_f32_16x16x32_bf16 v[68:71], a[104:107], a[4:7], v[68:71]
ds_read_b64_tr_b16 a[102:103], v12 offset:9984
v_mfma_f32_16x16x32_bf16 v[68:71], a[108:111], a[24:27], v[68:71]
ds_read_b128 a[16:19], v10
v_mfma_f32_16x16x32_bf16 v[60:63], a[108:111], a[20:23], v[60:63]
ds_read_b128 a[36:39], v11
v_mfma_f32_16x16x32_bf16 v[60:63], a[104:107], a[0:3], v[60:63]
s_waitcnt lgkmcnt(6)
s_waitcnt lgkmcnt(9)
v_mfma_f32_16x16x32_bf16 v[88:91], a[80:83], a[0:3], v[88:91]
ds_read_b64_tr_b16 a[104:105], v13 offset:768
s_add_u32 m0, s16, 0x8000
v_mfma_f32_16x16x32_bf16 v[88:91], a[84:87], a[20:23], v[88:91]
buffer_load_dwordx4 v22, s[44:47], s20 offen lds
v_mfma_f32_16x16x32_bf16 v[96:99], a[84:87], a[24:27], v[96:99]
ds_read_b64_tr_b16 a[106:107], v13 offset:1792
v_mfma_f32_16x16x32_bf16 v[96:99], a[80:83], a[4:7], v[96:99]
ds_read_b64_tr_b16 a[108:109], v13 offset:8960
v_mfma_f32_16x16x32_bf16 v[104:107], a[80:83], a[8:11], v[104:107]
ds_read_b64_tr_b16 a[110:111], v13 offset:9984
v_mfma_f32_16x16x32_bf16 v[104:107], a[84:87], a[28:31], v[104:107]
s_add_u32 m0, s16, 0x8400
v_mfma_f32_16x16x32_bf16 v[112:115], a[84:87], a[32:35], v[112:115]
buffer_load_dwordx4 v23, s[44:47], s20 offen lds
v_mfma_f32_16x16x32_bf16 v[112:115], a[80:83], a[12:15], v[112:115]
v_mfma_f32_16x16x32_bf16 v[116:119], a[88:91], a[12:15], v[116:119]
ds_read_b64_tr_b16 a[80:81], v14 offset:0
v_mfma_f32_16x16x32_bf16 v[116:119], a[92:95], a[32:35], v[116:119]
ds_read_b64_tr_b16 a[82:83], v14 offset:256
v_mfma_f32_16x16x32_bf16 v[108:111], a[92:95], a[28:31], v[108:111]
ds_read_b64_tr_b16 a[84:85], v14 offset:2048
v_mfma_f32_16x16x32_bf16 v[108:111], a[88:91], a[8:11], v[108:111]
ds_read_b64_tr_b16 a[86:87], v14 offset:2304
s_add_u32 m0, s16, 0x8800
v_mfma_f32_16x16x32_bf16 v[100:103], a[88:91], a[4:7], v[100:103]
buffer_load_dwordx4 v22, s[44:47], s21 offen lds
v_mfma_f32_16x16x32_bf16 v[100:103], a[92:95], a[24:27], v[100:103]
v_mfma_f32_16x16x32_bf16 v[92:95], a[92:95], a[20:23], v[92:95]
v_mfma_f32_16x16x32_bf16 v[92:95], a[88:91], a[0:3], v[92:95]
s_waitcnt lgkmcnt(4)
v_mfma_f32_16x16x32_bf16 v[120:123], a[96:99], a[0:3], v[120:123]
ds_read_b64_tr_b16 a[88:89], v15 offset:0
v_mfma_f32_16x16x32_bf16 v[120:123], a[100:103], a[20:23], v[120:123]
ds_read_b64_tr_b16 a[90:91], v15 offset:256
s_add_u32 m0, s16, 0x8c00
v_mfma_f32_16x16x32_bf16 v[128:131], a[100:103], a[24:27], v[128:131]
buffer_load_dwordx4 v23, s[44:47], s21 offen lds
v_mfma_f32_16x16x32_bf16 v[128:131], a[96:99], a[4:7], v[128:131]
ds_read_b64_tr_b16 a[92:93], v15 offset:2048
v_mfma_f32_16x16x32_bf16 v[136:139], a[96:99], a[8:11], v[136:139]
ds_read_b64_tr_b16 a[94:95], v15 offset:2304
v_mfma_f32_16x16x32_bf16 v[136:139], a[100:103], a[28:31], v[136:139]
v_mfma_f32_16x16x32_bf16 v[144:147], a[100:103], a[32:35], v[144:147]
s_add_u32 s8, s28, 0x7400
v_mfma_f32_16x16x32_bf16 v[144:147], a[96:99], a[12:15], v[144:147]
buffer_store_dwordx4 a[156:159], v16, s[88:91], s8 offen sc1
v_mfma_f32_16x16x32_bf16 v[148:151], a[104:107], a[12:15], v[148:151]
ds_read_b64_tr_b16 a[96:97], v14 offset:4096
v_mfma_f32_16x16x32_bf16 v[148:151], a[108:111], a[32:35], v[148:151]
ds_read_b64_tr_b16 a[98:99], v14 offset:4352
v_mfma_f32_16x16x32_bf16 v[140:143], a[108:111], a[28:31], v[140:143]
ds_read_b64_tr_b16 a[100:101], v14 offset:6144
v_mfma_f32_16x16x32_bf16 v[140:143], a[104:107], a[8:11], v[140:143]
ds_read_b64_tr_b16 a[102:103], v14 offset:6400
v_mfma_f32_16x16x32_bf16 v[132:135], a[104:107], a[4:7], v[132:135]
s_add_u32 m0, s16, 0x9000
v_mfma_f32_16x16x32_bf16 v[132:135], a[108:111], a[24:27], v[132:135]
buffer_load_dwordx4 v22, s[44:47], s22 offen lds
v_mfma_f32_16x16x32_bf16 v[124:127], a[108:111], a[20:23], v[124:127]
v_mfma_f32_16x16x32_bf16 v[124:127], a[104:107], a[0:3], v[124:127]
s_waitcnt lgkmcnt(4)
v_mfma_f32_16x16x32_bf16 v[152:155], a[80:83], a[0:3], v[152:155]
ds_read_b64_tr_b16 a[104:105], v15 offset:4096
v_mfma_f32_16x16x32_bf16 v[152:155], a[84:87], a[20:23], v[152:155]
ds_read_b64_tr_b16 a[106:107], v15 offset:4352
v_mfma_f32_16x16x32_bf16 v[160:163], a[84:87], a[24:27], v[160:163]
ds_read_b64_tr_b16 a[108:109], v15 offset:6144
s_add_u32 m0, s16, 0x9400
v_mfma_f32_16x16x32_bf16 v[160:163], a[80:83], a[4:7], v[160:163]
buffer_load_dwordx4 v23, s[44:47], s22 offen lds
v_mfma_f32_16x16x32_bf16 v[168:171], a[80:83], a[8:11], v[168:171]
ds_read_b64_tr_b16 a[110:111], v15 offset:6400
v_mfma_f32_16x16x32_bf16 v[168:171], a[84:87], a[28:31], v[168:171]
v_mfma_f32_16x16x32_bf16 v[176:179], a[84:87], a[32:35], v[176:179]
v_mfma_f32_16x16x32_bf16 v[176:179], a[80:83], a[12:15], v[176:179]
s_add_u32 m0, s16, 0x9800
v_mfma_f32_16x16x32_bf16 v[180:183], a[88:91], a[12:15], v[180:183]
buffer_load_dwordx4 v22, s[44:47], s23 offen lds
v_mfma_f32_16x16x32_bf16 v[180:183], a[92:95], a[32:35], v[180:183]
ds_read_b64_tr_b16 a[80:81], v14 offset:8192
v_mfma_f32_16x16x32_bf16 v[172:175], a[92:95], a[28:31], v[172:175]
ds_read_b64_tr_b16 a[82:83], v14 offset:8448
v_mfma_f32_16x16x32_bf16 v[172:175], a[88:91], a[8:11], v[172:175]
ds_read_b64_tr_b16 a[84:85], v14 offset:10240
v_mfma_f32_16x16x32_bf16 v[164:167], a[88:91], a[4:7], v[164:167]
ds_read_b64_tr_b16 a[86:87], v14 offset:10496
v_mfma_f32_16x16x32_bf16 v[164:167], a[92:95], a[24:27], v[164:167]
s_add_u32 m0, s16, 0x9c00
v_mfma_f32_16x16x32_bf16 v[156:159], a[92:95], a[20:23], v[156:159]
buffer_load_dwordx4 v23, s[44:47], s23 offen lds
v_mfma_f32_16x16x32_bf16 v[156:159], a[88:91], a[0:3], v[156:159]
s_waitcnt lgkmcnt(4)
v_add_u32 v22, 0x80, v22
v_add_u32 v23, 0x80, v23
v_mfma_f32_16x16x32_bf16 v[184:187], a[96:99], a[0:3], v[184:187]
ds_read_b64_tr_b16 a[88:89], v15 offset:8192
v_mfma_f32_16x16x32_bf16 v[184:187], a[100:103], a[20:23], v[184:187]
ds_read_b64_tr_b16 a[90:91], v15 offset:8448
v_mfma_f32_16x16x32_bf16 v[192:195], a[100:103], a[24:27], v[192:195]
ds_read_b64_tr_b16 a[92:93], v15 offset:10240
v_mfma_f32_16x16x32_bf16 v[192:195], a[96:99], a[4:7], v[192:195]
ds_read_b64_tr_b16 a[94:95], v15 offset:10496
s_add_u32 s8, s28, 0x2800
v_mfma_f32_16x16x32_bf16 v[200:203], a[96:99], a[8:11], v[200:203]
buffer_store_dwordx4 a[160:163], v16, s[88:91], s8 offen sc1
v_mfma_f32_16x16x32_bf16 v[200:203], a[100:103], a[28:31], v[200:203]
v_add_u32 v12, 0x8000, v12
v_add_u32 v13, 0x8000, v13
v_mfma_f32_16x16x32_bf16 v[208:211], a[100:103], a[32:35], v[208:211]
v_add_u32 v14, 0x8000, v14
v_add_u32 v15, 0x8000, v15
v_mfma_f32_16x16x32_bf16 v[208:211], a[96:99], a[12:15], v[208:211]
v_add_u32 v10, 0x8000, v10
v_add_u32 v11, 0x8000, v11
v_mfma_f32_16x16x32_bf16 v[248:251], a[96:99], a[16:19], v[248:251]
v_mfma_f32_16x16x32_bf16 v[248:251], a[100:103], a[36:39], v[248:251]
v_mfma_f32_16x16x32_bf16 v[212:215], a[104:107], a[12:15], v[212:215]
s_waitcnt vmcnt(30) lgkmcnt(0)
v_mfma_f32_16x16x32_bf16 v[212:215], a[108:111], a[32:35], v[212:215]
s_barrier
s_add_u32 m0, s17, 0x8000
v_mfma_f32_16x16x32_bf16 v[204:207], a[108:111], a[28:31], v[204:207]
buffer_load_dwordx4 v5, s[52:55], 0 offen lds
v_mfma_f32_16x16x32_bf16 v[204:207], a[104:107], a[8:11], v[204:207]
ds_read_b64_tr_b16 a[96:97], v12 offset:0
v_mfma_f32_16x16x32_bf16 v[196:199], a[104:107], a[4:7], v[196:199]
ds_read_b64_tr_b16 a[98:99], v12 offset:1024
v_mfma_f32_16x16x32_bf16 v[196:199], a[108:111], a[24:27], v[196:199]
ds_read_b64_tr_b16 a[100:101], v12 offset:8192
v_mfma_f32_16x16x32_bf16 v[188:191], a[108:111], a[20:23], v[188:191]
ds_read_b64_tr_b16 a[102:103], v12 offset:9216
v_mfma_f32_16x16x32_bf16 v[188:191], a[104:107], a[0:3], v[188:191]
s_add_u32 m0, s17, 0x8400
s_waitcnt lgkmcnt(4)
v_mfma_f32_16x16x32_bf16 v[216:219], a[0:3], a[80:83], v[216:219]
buffer_load_dwordx4 v5, s[52:55], s13 offen lds
v_mfma_f32_16x16x32_bf16 v[216:219], a[20:23], a[84:87], v[216:219]
ds_read_b64_tr_b16 a[104:105], v13 offset:0
v_mfma_f32_16x16x32_bf16 v[224:227], a[24:27], a[84:87], v[224:227]
ds_read_b64_tr_b16 a[106:107], v13 offset:1024
v_mfma_f32_16x16x32_bf16 v[224:227], a[4:7], a[80:83], v[224:227]
ds_read_b64_tr_b16 a[108:109], v13 offset:8192
v_mfma_f32_16x16x32_bf16 v[232:235], a[8:11], a[80:83], v[232:235]
ds_read_b64_tr_b16 a[110:111], v13 offset:9216
v_mfma_f32_16x16x32_bf16 v[232:235], a[28:31], a[84:87], v[232:235]
s_add_u32 m0, s17, 0x8800
v_mfma_f32_16x16x32_bf16 v[240:243], a[32:35], a[84:87], v[240:243]
buffer_load_dwordx4 v6, s[52:55], 0 offen lds
v_mfma_f32_16x16x32_bf16 v[240:243], a[12:15], a[80:83], v[240:243]
v_mfma_f32_16x16x32_bf16 v[252:255], a[16:19], a[80:83], v[252:255]
v_mfma_f32_16x16x32_bf16 v[252:255], a[36:39], a[84:87], v[252:255]
v_mfma_f32_16x16x32_bf16 v[244:247], a[12:15], a[88:91], v[244:247]
ds_read_b64_tr_b16 a[80:81], v12 offset:256
v_mfma_f32_16x16x32_bf16 v[244:247], a[32:35], a[92:95], v[244:247]
ds_read_b64_tr_b16 a[82:83], v12 offset:1280
s_add_u32 m0, s17, 0x8c00
v_mfma_f32_16x16x32_bf16 v[236:239], a[28:31], a[92:95], v[236:239]
buffer_load_dwordx4 v6, s[52:55], s13 offen lds
v_mfma_f32_16x16x32_bf16 v[236:239], a[8:11], a[88:91], v[236:239]
ds_read_b64_tr_b16 a[84:85], v12 offset:8448
v_mfma_f32_16x16x32_bf16 v[228:231], a[4:7], a[88:91], v[228:231]
ds_read_b64_tr_b16 a[86:87], v12 offset:9472
v_mfma_f32_16x16x32_bf16 v[228:231], a[24:27], a[92:95], v[228:231]
v_mfma_f32_16x16x32_bf16 v[220:223], a[20:23], a[92:95], v[220:223]
v_mfma_f32_16x16x32_bf16 v[220:223], a[0:3], a[88:91], v[220:223]
s_add_u32 m0, s18, 0xc000
s_waitcnt lgkmcnt(4)
L_S11:
v_mfma_f32_16x16x32_bf16 v[24:27], a[96:99], a[40:43], v[24:27]
buffer_load_dwordx4 v7, s[68:71], 0 offen lds
v_mfma_f32_16x16x32_bf16 v[24:27], a[100:103], a[60:63], v[24:27]
ds_read_b64_tr_b16 a[88:89], v13 offset:256
s_waitcnt vmcnt(26)
v_mfma_f32_16x16x32_bf16 v[32:35], a[100:103], a[64:67], v[32:35]
ds_read_b64_tr_b16 a[90:91], v13 offset:1280
v_mfma_f32_16x16x32_bf16 v[32:35], a[96:99], a[44:47], v[32:35]
ds_read_b64_tr_b16 a[92:93], v13 offset:8448
v_mfma_f32_16x16x32_bf16 v[40:43], a[96:99], a[48:51], v[40:43]
ds_read_b64_tr_b16 a[94:95], v13 offset:9472
v_mfma_f32_16x16x32_bf16 v[40:43], a[100:103], a[68:71], v[40:43]
ds_read_b128 a[0:3], v8 offset:0
s_add_u32 s8, s28, 0x3800
v_mfma_f32_16x16x32_bf16 v[48:51], a[100:103], a[72:75], v[48:51]
buffer_store_dwordx4 a[164:167], v16, s[88:91], s8 offen sc1
v_mfma_f32_16x16x32_bf16 v[48:51], a[96:99], a[52:55], v[48:51]
ds_read_b128 a[20:23], v9 offset:0
v_mfma_f32_16x16x32_bf16 v[52:55], a[104:107], a[52:55], v[52:55]
ds_read_b64_tr_b16 a[96:97], v12 offset:512
v_mfma_f32_16x16x32_bf16 v[52:55], a[108:111], a[72:75], v[52:55]
ds_read_b64_tr_b16 a[98:99], v12 offset:1536
v_mfma_f32_16x16x32_bf16 v[44:47], a[108:111], a[68:71], v[44:47]
ds_read_b64_tr_b16 a[100:101], v12 offset:8704
v_mfma_f32_16x16x32_bf16 v[44:47], a[104:107], a[48:51], v[44:47]
ds_read_b64_tr_b16 a[102:103], v12 offset:9728
s_add_u32 m0, s18, 0xd000
v_mfma_f32_16x16x32_bf16 v[36:39], a[104:107], a[44:47], v[36:39]
buffer_load_dwordx4 v7, s[68:71], s25 offen lds
v_mfma_f32_16x16x32_bf16 v[36:39], a[108:111], a[64:67], v[36:39]
ds_read_b128 a[4:7], v8 offset:2048
L_padA6:
s_cmp_eq_u32 s95, 1
s_cbranch_scc1 L_padA10
v_mfma_f32_16x16x32_bf16 v[28:31], a[108:111], a[60:63], v[28:31]
ds_read_b128 a[24:27], v9 offset:2048
v_mfma_f32_16x16x32_bf16 v[28:31], a[104:107], a[40:43], v[28:31]
ds_read_b128 a[8:11], v8 offset:4096
s_waitcnt lgkmcnt(9)
v_mfma_f32_16x16x32_bf16 v[56:59], a[80:83], a[40:43], v[56:59]
ds_read_b64_tr_b16 a[104:105], v13 offset:512
v_mfma_f32_16x16x32_bf16 v[56:59], a[84:87], a[60:63], v[56:59]
ds_read_b64_tr_b16 a[106:107], v13 offset:1536
s_add_u32 m0, s18, 0xe000
v_mfma_f32_16x16x32_bf16 v[64:67], a[84:87], a[64:67], v[64:67]
buffer_load_dwordx4 v7, s[68:71], s26 offen lds
v_mfma_f32_16x16x32_bf16 v[64:67], a[80:83], a[44:47], v[64:67]
ds_read_b64_tr_b16 a[108:109], v13 offset:8704
v_mfma_f32_16x16x32_bf16 v[72:75], a[80:83], a[48:51], v[72:75]
ds_read_b64_tr_b16 a[110:111], v13 offset:9728
v_mfma_f32_16x16x32_bf16 v[72:75], a[84:87], a[68:71], v[72:75]
ds_read_b128 a[28:31], v9 offset:4096
v_mfma_f32_16x16x32_bf16 v[80:83], a[84:87], a[72:75], v[80:83]
ds_read_b128 a[12:15], v8 offset:6144
v_mfma_f32_16x16x32_bf16 v[80:83], a[80:83], a[52:55], v[80:83]
ds_read_b128 a[32:35], v9 offset:6144
s_add_u32 m0, s18, 0xf000
v_mfma_f32_16x16x32_bf16 v[84:87], a[88:91], a[52:55], v[84:87]
buffer_load_dwordx4 v4, s[44:47], s24 offen lds
v_mfma_f32_16x16x32_bf16 v[84:87], a[92:95], a[72:75], v[84:87]
ds_read_b64_tr_b16 a[80:81], v12 offset:768
v_add_u32 v5, 0x80000, v5
v_mfma_f32_16x16x32_bf16 v[76:79], a[92:95], a[68:71], v[76:79]
ds_read_b64_tr_b16 a[82:83], v12 offset:1792
v_add_u32 v6, 0x80000, v6
v_mfma_f32_16x16x32_bf16 v[76:79], a[88:91], a[48:51], v[76:79]
ds_read_b64_tr_b16 a[84:85], v12 offset:8960
v_add_u32 v7, 0x60000, v7
v_mfma_f32_16x16x32_bf16 v[68:71], a[88:91], a[44:47], v[68:71]
ds_read_b64_tr_b16 a[86:87], v12 offset:9984
v_add_u32 v4, 0x80, v4
v_mfma_f32_16x16x32_bf16 v[68:71], a[92:95], a[64:67], v[68:71]
ds_read_b128 a[56:59], v10
s_add_u32 m0, s16, 0x0
s_waitcnt lgkmcnt(5)
v_mfma_f32_16x16x32_bf16 v[60:63], a[92:95], a[60:63], v[60:63]
buffer_load_dwordx4 v22, s[44:47], s20 offen lds
v_mfma_f32_16x16x32_bf16 v[60:63], a[88:91], a[40:43], v[60:63]
ds_read_b128 a[76:79], v11
s_waitcnt lgkmcnt(9)
v_mfma_f32_16x16x32_bf16 v[88:91], a[96:99], a[40:43], v[88:91]
ds_read_b64_tr_b16 a[88:89], v13 offset:768
v_mfma_f32_16x16x32_bf16 v[88:91], a[100:103], a[60:63], v[88:91]
ds_read_b64_tr_b16 a[90:91], v13 offset:1792
v_mfma_f32_16x16x32_bf16 v[96:99], a[100:103], a[64:67], v[96:99]
ds_read_b64_tr_b16 a[92:93], v13 offset:8960
v_mfma_f32_16x16x32_bf16 v[96:99], a[96:99], a[44:47], v[96:99]
ds_read_b64_tr_b16 a[94:95], v13 offset:9984
s_add_u32 m0, s16, 0x400
v_mfma_f32_16x16x32_bf16 v[104:107], a[96:99], a[48:51], v[104:107]
buffer_load_dwordx4 v23, s[44:47], s20 offen lds
v_mfma_f32_16x16x32_bf16 v[104:107], a[100:103], a[68:71], v[104:107]
v_mfma_f32_16x16x32_bf16 v[112:115], a[100:103], a[72:75], v[112:115]
v_mfma_f32_16x16x32_bf16 v[112:115], a[96:99], a[52:55], v[112:115]
v_mfma_f32_16x16x32_bf16 v[116:119], a[104:107], a[52:55], v[116:119]
ds_read_b64_tr_b16 a[96:97], v14 offset:0
v_mfma_f32_16x16x32_bf16 v[116:119], a[108:111], a[72:75], v[116:119]
ds_read_b64_tr_b16 a[98:99], v14 offset:256
s_add_u32 s8, s28, 0x6800
v_mfma_f32_16x16x32_bf16 v[108:111], a[108:111], a[68:71], v[108:111]
buffer_store_dwordx4 a[168:171], v16, s[88:91], s8 offen sc1
v_mfma_f32_16x16x32_bf16 v[108:111], a[104:107], a[48:51], v[108:111]
ds_read_b64_tr_b16 a[100:101], v14 offset:2048
v_mfma_f32_16x16x32_bf16 v[100:103], a[104:107], a[44:47], v[100:103]
ds_read_b64_tr_b16 a[102:103], v14 offset:2304
v_mfma_f32_16x16x32_bf16 v[100:103], a[108:111], a[64:67], v[100:103]
v_mfma_f32_16x16x32_bf16 v[92:95], a[108:111], a[60:63], v[92:95]
v_mfma_f32_16x16x32_bf16 v[92:95], a[104:107], a[40:43], v[92:95]
s_add_u32 m0, s16, 0x800
s_waitcnt lgkmcnt(4)
v_mfma_f32_16x16x32_bf16 v[120:123], a[80:83], a[40:43], v[120:123]
buffer_load_dwordx4 v22, s[44:47], s21 offen lds
v_mfma_f32_16x16x32_bf16 v[120:123], a[84:87], a[60:63], v[120:123]
ds_read_b64_tr_b16 a[104:105], v15 offset:0
v_mfma_f32_16x16x32_bf16 v[128:131], a[84:87], a[64:67], v[128:131]
ds_read_b64_tr_b16 a[106:107], v15 offset:256
v_mfma_f32_16x16x32_bf16 v[128:131], a[80:83], a[44:47], v[128:131]
ds_read_b64_tr_b16 a[108:109], v15 offset:2048
v_mfma_f32_16x16x32_bf16 v[136:139], a[80:83], a[48:51], v[136:139]
ds_read_b64_tr_b16 a[110:111], v15 offset:2304
v_mfma_f32_16x16x32_bf16 v[136:139], a[84:87], a[68:71], v[136:139]
s_add_u32 m0, s16, 0xc00
v_mfma_f32_16x16x32_bf16 v[144:147], a[84:87], a[72:75], v[144:147]
buffer_load_dwordx4 v23, s[44:47], s21 offen lds
v_mfma_f32_16x16x32_bf16 v[144:147], a[80:83], a[52:55], v[144:147]
v_mfma_f32_16x16x32_bf16 v[148:151], a[88:91], a[52:55], v[148:151]
ds_read_b64_tr_b16 a[80:81], v14 offset:4096
v_mfma_f32_16x16x32_bf16 v[148:151], a[92:95], a[72:75], v[148:151]
ds_read_b64_tr_b16 a[82:83], v14 offset:4352
v_mfma_f32_16x16x32_bf16 v[140:143], a[92:95], a[68:71], v[140:143]
ds_read_b64_tr_b16 a[84:85], v14 offset:6144
v_mfma_f32_16x16x32_bf16 v[140:143], a[88:91], a[48:51], v[140:143]
ds_read_b64_tr_b16 a[86:87], v14 offset:6400
s_add_u32 m0, s16, 0x1000
v_mfma_f32_16x16x32_bf16 v[132:135], a[88:91], a[44:47], v[132:135]
buffer_load_dwordx4 v22, s[44:47], s22 offen lds
v_mfma_f32_16x16x32_bf16 v[132:135], a[92:95], a[64:67], v[132:135]
v_mfma_f32_16x16x32_bf16 v[124:127], a[92:95], a[60:63], v[124:127]
v_mfma_f32_16x16x32_bf16 v[124:127], a[88:91], a[40:43], v[124:127]
s_waitcnt lgkmcnt(4)
v_mfma_f32_16x16x32_bf16 v[152:155], a[96:99], a[40:43], v[152:155]
ds_read_b64_tr_b16 a[88:89], v15 offset:4096
v_mfma_f32_16x16x32_bf16 v[152:155], a[100:103], a[60:63], v[152:155]
ds_read_b64_tr_b16 a[90:91], v15 offset:4352
s_add_u32 m0, s16, 0x1400
v_mfma_f32_16x16x32_bf16 v[160:163], a[100:103], a[64:67], v[160:163]
buffer_load_dwordx4 v23, s[44:47], s22 offen lds
v_mfma_f32_16x16x32_bf16 v[160:163], a[96:99], a[44:47], v[160:163]
ds_read_b64_tr_b16 a[92:93], v15 offset:6144
v_mfma_f32_16x16x32_bf16 v[168:171], a[96:99], a[48:51], v[168:171]
ds_read_b64_tr_b16 a[94:95], v15 offset:6400
v_mfma_f32_16x16x32_bf16 v[168:171], a[100:103], a[68:71], v[168:171]
v_mfma_f32_16x16x32_bf16 v[176:179], a[100:103], a[72:75], v[176:179]
v_mfma_f32_16x16x32_bf16 v[176:179], a[96:99], a[52:55], v[176:179]
s_add_u32 m0, s16, 0x1800
v_mfma_f32_16x16x32_bf16 v[180:183], a[104:107], a[52:55], v[180:183]
buffer_load_dwordx4 v22, s[44:47], s23 offen lds
v_mfma_f32_16x16x32_bf16 v[180:183], a[108:111], a[72:75], v[180:183]
ds_read_b64_tr_b16 a[96:97], v14 offset:8192
v_mfma_f32_16x16x32_bf16 v[172:175], a[108:111], a[68:71], v[172:175]
ds_read_b64_tr_b16 a[98:99], v14 offset:8448
v_mfma_f32_16x16x32_bf16 v[172:175], a[104:107], a[48:51], v[172:175]
ds_read_b64_tr_b16 a[100:101], v14 offset:10240
v_mfma_f32_16x16x32_bf16 v[164:167], a[104:107], a[44:47], v[164:167]
ds_read_b64_tr_b16 a[102:103], v14 offset:10496
v_mfma_f32_16x16x32_bf16 v[164:167], a[108:111], a[64:67], v[164:167]
s_add_u32 m0, s16, 0x1c00
v_mfma_f32_16x16x32_bf16 v[156:159], a[108:111], a[60:63], v[156:159]
buffer_load_dwordx4 v23, s[44:47], s23 offen lds
v_mfma_f32_16x16x32_bf16 v[156:159], a[104:107], a[40:43], v[156:159]
s_waitcnt lgkmcnt(4)
v_add_u32 v22, 0x80, v22
v_add_u32 v23, 0x80, v23
v_mfma_f32_16x16x32_bf16 v[184:187], a[80:83], a[40:43], v[184:187]
ds_read_b64_tr_b16 a[104:105], v15 offset:8192
v_mfma_f32_16x16x32_bf16 v[184:187], a[84:87], a[60:63], v[184:187]
ds_read_b64_tr_b16 a[106:107], v15 offset:8448
v_mfma_f32_16x16x32_bf16 v[192:195], a[84:87], a[64:67], v[192:195]
ds_read_b64_tr_b16 a[108:109], v15 offset:10240
v_mfma_f32_16x16x32_bf16 v[192:195], a[80:83], a[44:47], v[192:195]
ds_read_b64_tr_b16 a[110:111], v15 offset:10496
s_add_u32 s8, s28, 0x7800
v_mfma_f32_16x16x32_bf16 v[200:203], a[80:83], a[48:51], v[200:203]
buffer_store_dwordx4 a[172:175], v16, s[88:91], s8 offen sc1
v_mfma_f32_16x16x32_bf16 v[200:203], a[84:87], a[68:71], v[200:203]
v_add_u32 v12, 0xffff0000, v12
v_add_u32 v13, 0xffff0000, v13
v_mfma_f32_16x16x32_bf16 v[208:211], a[84:87], a[72:75], v[208:211]
v_add_u32 v14, 0xffff0000, v14
v_add_u32 v15, 0xffff0000, v15
v_mfma_f32_16x16x32_bf16 v[208:211], a[80:83], a[52:55], v[208:211]
v_add_u32 v10, 0xffff0000, v10
v_add_u32 v11, 0xffff0000, v11
v_mfma_f32_16x16x32_bf16 v[248:251], a[80:83], a[56:59], v[248:251]
v_mfma_f32_16x16x32_bf16 v[248:251], a[84:87], a[76:79], v[248:251]
v_mfma_f32_16x16x32_bf16 v[212:215], a[88:91], a[52:55], v[212:215]
s_waitcnt vmcnt(30) lgkmcnt(0)
v_mfma_f32_16x16x32_bf16 v[212:215], a[92:95], a[72:75], v[212:215]
s_barrier
s_add_u32 m0, s17, 0x10000
v_mfma_f32_16x16x32_bf16 v[204:207], a[92:95], a[68:71], v[204:207]
buffer_load_dwordx4 v5, s[52:55], 0 offen lds
v_mfma_f32_16x16x32_bf16 v[204:207], a[88:91], a[48:51], v[204:207]
ds_read_b64_tr_b16 a[80:81], v12 offset:0
v_mfma_f32_16x16x32_bf16 v[196:199], a[88:91], a[44:47], v[196:199]
ds_read_b64_tr_b16 a[82:83], v12 offset:1024
v_mfma_f32_16x16x32_bf16 v[196:199], a[92:95], a[64:67], v[196:199]
ds_read_b64_tr_b16 a[84:85], v12 offset:8192
s_waitcnt lgkmcnt(3)
v_mfma_f32_16x16x32_bf16 v[188:191], a[92:95], a[60:63], v[188:191]
ds_read_b64_tr_b16 a[86:87], v12 offset:9216
s_add_u32 m0, s17, 0x10400
v_mfma_f32_16x16x32_bf16 v[188:191], a[88:91], a[40:43], v[188:191]
buffer_load_dwordx4 v5, s[52:55], s13 offen lds
v_mfma_f32_16x16x32_bf16 v[216:219], a[40:43], a[96:99], v[216:219]
ds_read_b64_tr_b16 a[88:89], v13 offset:0
v_mfma_f32_16x16x32_bf16 v[216:219], a[60:63], a[100:103], v[216:219]
ds_read_b64_tr_b16 a[90:91], v13 offset:1024
v_mfma_f32_16x16x32_bf16 v[224:227], a[64:67], a[100:103], v[224:227]
ds_read_b64_tr_b16 a[92:93], v13 offset:8192
v_mfma_f32_16x16x32_bf16 v[224:227], a[44:47], a[96:99], v[224:227]
ds_read_b64_tr_b16 a[94:95], v13 offset:9216
v_mfma_f32_16x16x32_bf16 v[232:235], a[48:51], a[96:99], v[232:235]
s_add_u32 m0, s17, 0x10800
v_mfma_f32_16x16x32_bf16 v[232:235], a[68:71], a[100:103], v[232:235]
buffer_load_dwordx4 v6, s[52:55], 0 offen lds
v_mfma_f32_16x16x32_bf16 v[240:243], a[72:75], a[100:103], v[240:243]
v_mfma_f32_16x16x32_bf16 v[240:243], a[52:55], a[96:99], v[240:243]
v_mfma_f32_16x16x32_bf16 v[252:255], a[56:59], a[96:99], v[252:255]
v_mfma_f32_16x16x32_bf16 v[252:255], a[76:79], a[100:103], v[252:255]
v_mfma_f32_16x16x32_bf16 v[244:247], a[52:55], a[104:107], v[244:247]
ds_read_b64_tr_b16 a[96:97], v12 offset:256
s_add_u32 m0, s17, 0x10c00
v_mfma_f32_16x16x32_bf16 v[244:247], a[72:75], a[108:111], v[244:247]
buffer_load_dwordx4 v6, s[52:55], s13 offen lds
v_mfma_f32_16x16x32_bf16 v[236:239], a[68:71], a[108:111], v[236:239]
ds_read_b64_tr_b16 a[98:99], v12 offset:1280
v_mfma_f32_16x16x32_bf16 v[236:239], a[48:51], a[104:107], v[236:239]
ds_read_b64_tr_b16 a[100:101], v12 offset:8448
v_mfma_f32_16x16x32_bf16 v[228:231], a[44:47], a[104:107], v[228:231]
ds_read_b64_tr_b16 a[102:103], v12 offset:9472
v_mfma_f32_16x16x32_bf16 v[228:231], a[64:67], a[108:111], v[228:231]
s_add_u32 s8, s28, 0x2c00
v_mfma_f32_16x16x32_bf16 v[220:223], a[60:63], a[108:111], v[220:223]
buffer_store_dwordx4 a[176:179], v16, s[88:91], s8 offen sc1
v_mfma_f32_16x16x32_bf16 v[220:223], a[40:43], a[104:107], v[220:223]
s_waitcnt lgkmcnt(4)
L_S12:
v_mfma_f32_16x16x32_bf16 v[24:27], a[80:83], a[0:3], v[24:27]
ds_read_b64_tr_b16 a[104:105], v13 offset:256
s_waitcnt vmcnt(25)
v_mfma_f32_16x16x32_bf16 v[24:27], a[84:87], a[20:23], v[24:27]
ds_read_b64_tr_b16 a[106:107], v13 offset:1280
v_mfma_f32_16x16x32_bf16 v[32:35], a[84:87], a[24:27], v[32:35]
ds_read_b64_tr_b16 a[108:109], v13 offset:8448
v_mfma_f32_16x16x32_bf16 v[32:35], a[80:83], a[4:7], v[32:35]
ds_read_b64_tr_b16 a[110:111], v13 offset:9472
s_add_u32 m0, s18, 0x14000
v_mfma_f32_16x16x32_bf16 v[40:43], a[80:83], a[8:11], v[40:43]
buffer_load_dwordx4 v7, s[68:71], 0 offen lds
v_mfma_f32_16x16x32_bf16 v[40:43], a[84:87], a[28:31], v[40:43]
ds_read_b128 a[40:43], v8 offset:32768
v_mfma_f32_16x16x32_bf16 v[48:51], a[84:87], a[32:35], v[48:51]
ds_read_b128 a[60:63], v9 offset:32768
v_mfma_f32_16x16x32_bf16 v[48:51], a[80:83], a[12:15], v[48:51]
ds_read_b128 a[44:47], v8 offset:34816
v_mfma_f32_16x16x32_bf16 v[52:55], a[88:91], a[12:15], v[52:55]
ds_read_b64_tr_b16 a[80:81], v12 offset:512
v_mfma_f32_16x16x32_bf16 v[52:55], a[92:95], a[32:35], v[52:55]
ds_read_b64_tr_b16 a[82:83], v12 offset:1536
s_add_u32 m0, s18, 0x15000
v_mfma_f32_16x16x32_bf16 v[44:47], a[92:95], a[28:31], v[44:47]
buffer_load_dwordx4 v7, s[68:71], s25 offen lds
v_mfma_f32_16x16x32_bf16 v[44:47], a[88:91], a[8:11], v[44:47]
ds_read_b64_tr_b16 a[84:85], v12 offset:8704
v_mfma_f32_16x16x32_bf16 v[36:39], a[88:91], a[4:7], v[36:39]
ds_read_b64_tr_b16 a[86:87], v12 offset:9728
v_mfma_f32_16x16x32_bf16 v[36:39], a[92:95], a[24:27], v[36:39]
ds_read_b128 a[64:67], v9 offset:34816
s_waitcnt lgkmcnt(8)
v_mfma_f32_16x16x32_bf16 v[28:31], a[92:95], a[20:23], v[28:31]
ds_read_b128 a[48:51], v8 offset:36864
s_add_u32 m0, s18, 0x16000
v_mfma_f32_16x16x32_bf16 v[28:31], a[88:91], a[0:3], v[28:31]
buffer_load_dwordx4 v7, s[68:71], s26 offen lds
v_mfma_f32_16x16x32_bf16 v[56:59], a[96:99], a[0:3], v[56:59]
ds_read_b64_tr_b16 a[88:89], v13 offset:512
v_mfma_f32_16x16x32_bf16 v[56:59], a[100:103], a[20:23], v[56:59]
ds_read_b64_tr_b16 a[90:91], v13 offset:1536
v_mfma_f32_16x16x32_bf16 v[64:67], a[100:103], a[24:27], v[64:67]
ds_read_b64_tr_b16 a[92:93], v13 offset:8704
v_mfma_f32_16x16x32_bf16 v[64:67], a[96:99], a[4:7], v[64:67]
ds_read_b64_tr_b16 a[94:95], v13 offset:9728
v_mfma_f32_16x16x32_bf16 v[72:75], a[96:99], a[8:11], v[72:75]
ds_read_b128 a[68:71], v9 offset:36864
s_add_u32 m0, s18, 0x17000
v_mfma_f32_16x16x32_bf16 v[72:75], a[100:103], a[28:31], v[72:75]
buffer_load_dwordx4 v4, s[44:47], s24 offen lds
v_mfma_f32_16x16x32_bf16 v[80:83], a[100:103], a[32:35], v[80:83]
ds_read_b128 a[52:55], v8 offset:38912
v_add_u32 v5, 0x80000, v5
v_mfma_f32_16x16x32_bf16 v[80:83], a[96:99], a[12:15], v[80:83]
ds_read_b128 a[72:75], v9 offset:38912
v_add_u32 v6, 0x80000, v6
v_mfma_f32_16x16x32_bf16 v[84:87], a[104:107], a[12:15], v[84:87]
ds_read_b64_tr_b16 a[96:97], v12 offset:768
v_add_u32 v7, 0x60000, v7
v_mfma_f32_16x16x32_bf16 v[84:87], a[108:111], a[32:35], v[84:87]
ds_read_b64_tr_b16 a[98:99], v12 offset:1792
v_add_u32 v4, 0x80, v4
v_mfma_f32_16x16x32_bf16 v[76:79], a[108:111], a[28:31], v[76:79]
ds_read_b64_tr_b16 a[100:101], v12 offset:8960
s_add_u32 s8, s28, 0x3c00
v_mfma_f32_16x16x32_bf16 v[76:79], a[104:107], a[8:11], v[76:79]
buffer_store_dwordx4 a[180:183], v16, s[88:91], s8 offen sc1
v_mfma_f32_16x16x32_bf16 v[68:71], a[104:107], a[4:7], v[68:71]
ds_read_b64_tr_b16 a[102:103], v12 offset:9984
v_mfma_f32_16x16x32_bf16 v[68:71], a[108:111], a[24:27], v[68:71]
ds_read_b128 a[16:19], v10
v_mfma_f32_16x16x32_bf16 v[60:63], a[108:111], a[20:23], v[60:63]
ds_read_b128 a[36:39], v11
v_mfma_f32_16x16x32_bf16 v[60:63], a[104:107], a[0:3], v[60:63]
s_waitcnt lgkmcnt(6)
s_waitcnt lgkmcnt(9)
v_mfma_f32_16x16x32_bf16 v[88:91], a[80:83], a[0:3], v[88:91]
ds_read_b64_tr_b16 a[104:105], v13 offset:768
s_add_u32 m0, s16, 0x8000
v_mfma_f32_16x16x32_bf16 v[88:91], a[84:87], a[20:23], v[88:91]
buffer_load_dwordx4 v22, s[44:47], s20 offen lds
v_mfma_f32_16x16x32_bf16 v[96:99], a[84:87], a[24:27], v[96:99]
ds_read_b64_tr_b16 a[106:107], v13 offset:1792
v_mfma_f32_16x16x32_bf16 v[96:99], a[80:83], a[4:7], v[96:99]
ds_read_b64_tr_b16 a[108:109], v13 offset:8960
v_mfma_f32_16x16x32_bf16 v[104:107], a[80:83], a[8:11], v[104:107]
ds_read_b64_tr_b16 a[110:111], v13 offset:9984
v_mfma_f32_16x16x32_bf16 v[104:107], a[84:87], a[28:31], v[104:107]
s_add_u32 m0, s16, 0x8400
v_mfma_f32_16x16x32_bf16 v[112:115], a[84:87], a[32:35], v[112:115]
buffer_load_dwordx4 v23, s[44:47], s20 offen lds
v_mfma_f32_16x16x32_bf16 v[112:115], a[80:83], a[12:15], v[112:115]
v_mfma_f32_16x16x32_bf16 v[116:119], a[88:91], a[12:15], v[116:119]
ds_read_b64_tr_b16 a[80:81], v14 offset:0
v_mfma_f32_16x16x32_bf16 v[116:119], a[92:95], a[32:35], v[116:119]
ds_read_b64_tr_b16 a[82:83], v14 offset:256
v_mfma_f32_16x16x32_bf16 v[108:111], a[92:95], a[28:31], v[108:111]
ds_read_b64_tr_b16 a[84:85], v14 offset:2048
v_mfma_f32_16x16x32_bf16 v[108:111], a[88:91], a[8:11], v[108:111]
ds_read_b64_tr_b16 a[86:87], v14 offset:2304
s_add_u32 m0, s16, 0x8800
v_mfma_f32_16x16x32_bf16 v[100:103], a[88:91], a[4:7], v[100:103]
buffer_load_dwordx4 v22, s[44:47], s21 offen lds
v_mfma_f32_16x16x32_bf16 v[100:103], a[92:95], a[24:27], v[100:103]
v_mfma_f32_16x16x32_bf16 v[92:95], a[92:95], a[20:23], v[92:95]
v_mfma_f32_16x16x32_bf16 v[92:95], a[88:91], a[0:3], v[92:95]
s_waitcnt lgkmcnt(4)
v_mfma_f32_16x16x32_bf16 v[120:123], a[96:99], a[0:3], v[120:123]
ds_read_b64_tr_b16 a[88:89], v15 offset:0
v_mfma_f32_16x16x32_bf16 v[120:123], a[100:103], a[20:23], v[120:123]
ds_read_b64_tr_b16 a[90:91], v15 offset:256
s_add_u32 m0, s16, 0x8c00
v_mfma_f32_16x16x32_bf16 v[128:131], a[100:103], a[24:27], v[128:131]
buffer_load_dwordx4 v23, s[44:47], s21 offen lds
v_mfma_f32_16x16x32_bf16 v[128:131], a[96:99], a[4:7], v[128:131]
ds_read_b64_tr_b16 a[92:93], v15 offset:2048
v_mfma_f32_16x16x32_bf16 v[136:139], a[96:99], a[8:11], v[136:139]
ds_read_b64_tr_b16 a[94:95], v15 offset:2304
v_mfma_f32_16x16x32_bf16 v[136:139], a[100:103], a[28:31], v[136:139]
v_mfma_f32_16x16x32_bf16 v[144:147], a[100:103], a[32:35], v[144:147]
s_add_u32 s8, s28, 0x6c00
v_mfma_f32_16x16x32_bf16 v[144:147], a[96:99], a[12:15], v[144:147]
buffer_store_dwordx4 a[184:187], v16, s[88:91], s8 offen sc1
v_mfma_f32_16x16x32_bf16 v[148:151], a[104:107], a[12:15], v[148:151]
ds_read_b64_tr_b16 a[96:97], v14 offset:4096
v_mfma_f32_16x16x32_bf16 v[148:151], a[108:111], a[32:35], v[148:151]
ds_read_b64_tr_b16 a[98:99], v14 offset:4352
v_mfma_f32_16x16x32_bf16 v[140:143], a[108:111], a[28:31], v[140:143]
ds_read_b64_tr_b16 a[100:101], v14 offset:6144
v_mfma_f32_16x16x32_bf16 v[140:143], a[104:107], a[8:11], v[140:143]
ds_read_b64_tr_b16 a[102:103], v14 offset:6400
v_mfma_f32_16x16x32_bf16 v[132:135], a[104:107], a[4:7], v[132:135]
s_add_u32 m0, s16, 0x9000
v_mfma_f32_16x16x32_bf16 v[132:135], a[108:111], a[24:27], v[132:135]
buffer_load_dwordx4 v22, s[44:47], s22 offen lds
v_mfma_f32_16x16x32_bf16 v[124:127], a[108:111], a[20:23], v[124:127]
v_mfma_f32_16x16x32_bf16 v[124:127], a[104:107], a[0:3], v[124:127]
s_waitcnt lgkmcnt(4)
v_mfma_f32_16x16x32_bf16 v[152:155], a[80:83], a[0:3], v[152:155]
ds_read_b64_tr_b16 a[104:105], v15 offset:4096
v_mfma_f32_16x16x32_bf16 v[152:155], a[84:87], a[20:23], v[152:155]
ds_read_b64_tr_b16 a[106:107], v15 offset:4352
v_mfma_f32_16x16x32_bf16 v[160:163], a[84:87], a[24:27], v[160:163]
ds_read_b64_tr_b16 a[108:109], v15 offset:6144
s_add_u32 m0, s16, 0x9400
v_mfma_f32_16x16x32_bf16 v[160:163], a[80:83], a[4:7], v[160:163]
buffer_load_dwordx4 v23, s[44:47], s22 offen lds
v_mfma_f32_16x16x32_bf16 v[168:171], a[80:83], a[8:11], v[168:171]
ds_read_b64_tr_b16 a[110:111], v15 offset:6400
v_mfma_f32_16x16x32_bf16 v[168:171], a[84:87], a[28:31], v[168:171]
v_mfma_f32_16x16x32_bf16 v[176:179], a[84:87], a[32:35], v[176:179]
v_mfma_f32_16x16x32_bf16 v[176:179], a[80:83], a[12:15], v[176:179]
s_add_u32 m0, s16, 0x9800
v_mfma_f32_16x16x32_bf16 v[180:183], a[88:91], a[12:15], v[180:183]
buffer_load_dwordx4 v22, s[44:47], s23 offen lds
v_mfma_f32_16x16x32_bf16 v[180:183], a[92:95], a[32:35], v[180:183]
ds_read_b64_tr_b16 a[80:81], v14 offset:8192
v_mfma_f32_16x16x32_bf16 v[172:175], a[92:95], a[28:31], v[172:175]
ds_read_b64_tr_b16 a[82:83], v14 offset:8448
v_mfma_f32_16x16x32_bf16 v[172:175], a[88:91], a[8:11], v[172:175]
ds_read_b64_tr_b16 a[84:85], v14 offset:10240
v_mfma_f32_16x16x32_bf16 v[164:167], a[88:91], a[4:7], v[164:167]
ds_read_b64_tr_b16 a[86:87], v14 offset:10496
v_mfma_f32_16x16x32_bf16 v[164:167], a[92:95], a[24:27], v[164:167]
s_add_u32 m0, s16, 0x9c00
v_mfma_f32_16x16x32_bf16 v[156:159], a[92:95], a[20:23], v[156:159]
buffer_load_dwordx4 v23, s[44:47], s23 offen lds
v_mfma_f32_16x16x32_bf16 v[156:159], a[88:91], a[0:3], v[156:159]
s_waitcnt lgkmcnt(4)
v_add_u32 v22, 0x80, v22
v_add_u32 v23, 0x80, v23
v_mfma_f32_16x16x32_bf16 v[184:187], a[96:99], a[0:3], v[184:187]
ds_read_b64_tr_b16 a[88:89], v15 offset:8192
v_mfma_f32_16x16x32_bf16 v[184:187], a[100:103], a[20:23], v[184:187]
ds_read_b64_tr_b16 a[90:91], v15 offset:8448
v_mfma_f32_16x16x32_bf16 v[192:195], a[100:103], a[24:27], v[192:195]
ds_read_b64_tr_b16 a[92:93], v15 offset:10240
v_mfma_f32_16x16x32_bf16 v[192:195], a[96:99], a[4:7], v[192:195]
ds_read_b64_tr_b16 a[94:95], v15 offset:10496
s_add_u32 s8, s28, 0x7c00
v_mfma_f32_16x16x32_bf16 v[200:203], a[96:99], a[8:11], v[200:203]
buffer_store_dwordx4 a[188:191], v16, s[88:91], s8 offen sc1
v_mfma_f32_16x16x32_bf16 v[200:203], a[100:103], a[28:31], v[200:203]
v_add_u32 v12, 0x8000, v12
v_add_u32 v13, 0x8000, v13
v_mfma_f32_16x16x32_bf16 v[208:211], a[100:103], a[32:35], v[208:211]
v_add_u32 v14, 0x8000, v14
v_add_u32 v15, 0x8000, v15
v_mfma_f32_16x16x32_bf16 v[208:211], a[96:99], a[12:15], v[208:211]
v_add_u32 v10, 0x8000, v10
v_add_u32 v11, 0x8000, v11
v_mfma_f32_16x16x32_bf16 v[248:251], a[96:99], a[16:19], v[248:251]
v_mfma_f32_16x16x32_bf16 v[248:251], a[100:103], a[36:39], v[248:251]
v_mfma_f32_16x16x32_bf16 v[212:215], a[104:107], a[12:15], v[212:215]
s_waitcnt vmcnt(30) lgkmcnt(0)
v_mfma_f32_16x16x32_bf16 v[212:215], a[108:111], a[32:35], v[212:215]
s_barrier
s_add_u32 m0, s17, 0x0
v_mfma_f32_16x16x32_bf16 v[204:207], a[108:111], a[28:31], v[204:207]
buffer_load_dwordx4 v5, s[52:55], 0 offen lds
v_mfma_f32_16x16x32_bf16 v[204:207], a[104:107], a[8:11], v[204:207]
ds_read_b64_tr_b16 a[96:97], v12 offset:0
v_mfma_f32_16x16x32_bf16 v[196:199], a[104:107], a[4:7], v[196:199]
ds_read_b64_tr_b16 a[98:99], v12 offset:1024
v_mfma_f32_16x16x32_bf16 v[196:199], a[108:111], a[24:27], v[196:199]
ds_read_b64_tr_b16 a[100:101], v12 offset:8192
v_mfma_f32_16x16x32_bf16 v[188:191], a[108:111], a[20:23], v[188:191]
ds_read_b64_tr_b16 a[102:103], v12 offset:9216
v_mfma_f32_16x16x32_bf16 v[188:191], a[104:107], a[0:3], v[188:191]
s_add_u32 m0, s17, 0x400
s_waitcnt lgkmcnt(4)
v_mfma_f32_16x16x32_bf16 v[216:219], a[0:3], a[80:83], v[216:219]
buffer_load_dwordx4 v5, s[52:55], s13 offen lds
v_mfma_f32_16x16x32_bf16 v[216:219], a[20:23], a[84:87], v[216:219]
ds_read_b64_tr_b16 a[104:105], v13 offset:0
v_mfma_f32_16x16x32_bf16 v[224:227], a[24:27], a[84:87], v[224:227]
ds_read_b64_tr_b16 a[106:107], v13 offset:1024
v_mfma_f32_16x16x32_bf16 v[224:227], a[4:7], a[80:83], v[224:227]
ds_read_b64_tr_b16 a[108:109], v13 offset:8192
v_mfma_f32_16x16x32_bf16 v[232:235], a[8:11], a[80:83], v[232:235]
ds_read_b64_tr_b16 a[110:111], v13 offset:9216
v_mfma_f32_16x16x32_bf16 v[232:235], a[28:31], a[84:87], v[232:235]
s_add_u32 m0, s17, 0x800
v_mfma_f32_16x16x32_bf16 v[240:243], a[32:35], a[84:87], v[240:243]
buffer_load_dwordx4 v6, s[52:55], 0 offen lds
v_mfma_f32_16x16x32_bf16 v[240:243], a[12:15], a[80:83], v[240:243]
v_mfma_f32_16x16x32_bf16 v[252:255], a[16:19], a[80:83], v[252:255]
v_mfma_f32_16x16x32_bf16 v[252:255], a[36:39], a[84:87], v[252:255]
v_mfma_f32_16x16x32_bf16 v[244:247], a[12:15], a[88:91], v[244:247]
ds_read_b64_tr_b16 a[80:81], v12 offset:256
v_mfma_f32_16x16x32_bf16 v[244:247], a[32:35], a[92:95], v[244:247]
ds_read_b64_tr_b16 a[82:83], v12 offset:1280
s_add_u32 m0, s17, 0xc00
v_mfma_f32_16x16x32_bf16 v[236:239], a[28:31], a[92:95], v[236:239]
buffer_load_dwordx4 v6, s[52:55], s13 offen lds
v_mfma_f32_16x16x32_bf16 v[236:239], a[8:11], a[88:91], v[236:239]
ds_read_b64_tr_b16 a[84:85], v12 offset:8448
v_mfma_f32_16x16x32_bf16 v[228:231], a[4:7], a[88:91], v[228:231]
ds_read_b64_tr_b16 a[86:87], v12 offset:9472
v_mfma_f32_16x16x32_bf16 v[228:231], a[24:27], a[92:95], v[228:231]
v_mfma_f32_16x16x32_bf16 v[220:223], a[20:23], a[92:95], v[220:223]
v_mfma_f32_16x16x32_bf16 v[220:223], a[0:3], a[88:91], v[220:223]
s_add_u32 m0, s18, 0x4000
s_waitcnt lgkmcnt(4)
L_S13:
v_mfma_f32_16x16x32_bf16 v[24:27], a[96:99], a[40:43], v[24:27]
buffer_load_dwordx4 v7, s[68:71], 0 offen lds
v_mfma_f32_16x16x32_bf16 v[24:27], a[100:103], a[60:63], v[24:27]
ds_read_b64_tr_b16 a[88:89], v13 offset:256
s_waitcnt vmcnt(26)
v_mfma_f32_16x16x32_bf16 v[32:35], a[100:103], a[64:67], v[32:35]
ds_read_b64_tr_b16 a[90:91], v13 offset:1280
v_mfma_f32_16x16x32_bf16 v[32:35], a[96:99], a[44:47], v[32:35]
ds_read_b64_tr_b16 a[92:93], v13 offset:8448
v_mfma_f32_16x16x32_bf16 v[40:43], a[96:99], a[48:51], v[40:43]
ds_read_b64_tr_b16 a[94:95], v13 offset:9472
v_mfma_f32_16x16x32_bf16 v[40:43], a[100:103], a[68:71], v[40:43]
ds_read_b128 a[0:3], v8 offset:0
s_add_u32 s8, s28, 0x4000
v_mfma_f32_16x16x32_bf16 v[48:51], a[100:103], a[72:75], v[48:51]
buffer_store_dwordx4 a[192:195], v16, s[88:91], s8 offen sc1
v_mfma_f32_16x16x32_bf16 v[48:51], a[96:99], a[52:55], v[48:51]
ds_read_b128 a[20:23], v9 offset:0
v_mfma_f32_16x16x32_bf16 v[52:55], a[104:107], a[52:55], v[52:55]
ds_read_b64_tr_b16 a[96:97], v12 offset:512
v_mfma_f32_16x16x32_bf16 v[52:55], a[108:111], a[72:75], v[52:55]
ds_read_b64_tr_b16 a[98:99], v12 offset:1536
v_mfma_f32_16x16x32_bf16 v[44:47], a[108:111], a[68:71], v[44:47]
ds_read_b64_tr_b16 a[100:101], v12 offset:8704
v_mfma_f32_16x16x32_bf16 v[44:47], a[104:107], a[48:51], v[44:47]
ds_read_b64_tr_b16 a[102:103], v12 offset:9728
s_add_u32 m0, s18, 0x5000
v_mfma_f32_16x16x32_bf16 v[36:39], a[104:107], a[44:47], v[36:39]
buffer_load_dwordx4 v7, s[68:71], s25 offen lds
v_mfma_f32_16x16x32_bf16 v[36:39], a[108:111], a[64:67], v[36:39]
ds_read_b128 a[4:7], v8 offset:2048
v_mfma_f32_16x16x32_bf16 v[28:31], a[108:111], a[60:63], v[28:31]
ds_read_b128 a[24:27], v9 offset:2048
v_mfma_f32_16x16x32_bf16 v[28:31], a[104:107], a[40:43], v[28:31]
ds_read_b128 a[8:11], v8 offset:4096
s_waitcnt lgkmcnt(9)
v_mfma_f32_16x16x32_bf16 v[56:59], a[80:83], a[40:43], v[56:59]
ds_read_b64_tr_b16 a[104:105], v13 offset:512
v_mfma_f32_16x16x32_bf16 v[56:59], a[84:87], a[60:63], v[56:59]
ds_read_b64_tr_b16 a[106:107], v13 offset:1536
s_add_u32 m0, s18, 0x6000
v_mfma_f32_16x16x32_bf16 v[64:67], a[84:87], a[64:67], v[64:67]
buffer_load_dwordx4 v7, s[68:71], s26 offen lds
v_mfma_f32_16x16x32_bf16 v[64:67], a[80:83], a[44:47], v[64:67]
ds_read_b64_tr_b16 a[108:109], v13 offset:8704
v_mfma_f32_16x16x32_bf16 v[72:75], a[80:83], a[48:51], v[72:75]
ds_read_b64_tr_b16 a[110:111], v13 offset:9728
v_mfma_f32_16x16x32_bf16 v[72:75], a[84:87], a[68:71], v[72:75]
ds_read_b128 a[28:31], v9 offset:4096
v_mfma_f32_16x16x32_bf16 v[80:83], a[84:87], a[72:75], v[80:83]
ds_read_b128 a[12:15], v8 offset:6144
v_mfma_f32_16x16x32_bf16 v[80:83], a[80:83], a[52:55], v[80:83]
ds_read_b128 a[32:35], v9 offset:6144
s_add_u32 m0, s18, 0x7000
v_mfma_f32_16x16x32_bf16 v[84:87], a[88:91], a[52:55], v[84:87]
buffer_load_dwordx4 v4, s[44:47], s24 offen lds
v_mfma_f32_16x16x32_bf16 v[84:87], a[92:95], a[72:75], v[84:87]
ds_read_b64_tr_b16 a[80:81], v12 offset:768
v_add_u32 v5, 0x80000, v5
v_mfma_f32_16x16x32_bf16 v[76:79], a[92:95], a[68:71], v[76:79]
ds_read_b64_tr_b16 a[82:83], v12 offset:1792
L_padA7:
s_cmp_eq_u32 s95, 1
s_cbranch_scc1 L_padA11
v_add_u32 v6, 0x80000, v6
v_mfma_f32_16x16x32_bf16 v[76:79], a[88:91], a[48:51], v[76:79]
ds_read_b64_tr_b16 a[84:85], v12 offset:8960
v_add_u32 v7, 0x60000, v7
v_mfma_f32_16x16x32_bf16 v[68:71], a[88:91], a[44:47], v[68:71]
ds_read_b64_tr_b16 a[86:87], v12 offset:9984
v_add_u32 v4, 0x80, v4
v_mfma_f32_16x16x32_bf16 v[68:71], a[92:95], a[64:67], v[68:71]
ds_read_b128 a[56:59], v10
s_add_u32 m0, s16, 0x0
s_waitcnt lgkmcnt(5)
v_mfma_f32_16x16x32_bf16 v[60:63], a[92:95], a[60:63], v[60:63]
buffer_load_dwordx4 v22, s[44:47], s20 offen lds
v_mfma_f32_16x16x32_bf16 v[60:63], a[88:91], a[40:43], v[60:63]
ds_read_b128 a[76:79], v11
s_waitcnt lgkmcnt(9)
v_mfma_f32_16x16x32_bf16 v[88:91], a[96:99], a[40:43], v[88:91]
ds_read_b64_tr_b16 a[88:89], v13 offset:768
v_mfma_f32_16x16x32_bf16 v[88:91], a[100:103], a[60:63], v[88:91]
ds_read_b64_tr_b16 a[90:91], v13 offset:1792
v_mfma_f32_16x16x32_bf16 v[96:99], a[100:103], a[64:67], v[96:99]
ds_read_b64_tr_b16 a[92:93], v13 offset:8960
v_mfma_f32_16x16x32_bf16 v[96:99], a[96:99], a[44:47], v[96:99]
ds_read_b64_tr_b16 a[94:95], v13 offset:9984
s_add_u32 m0, s16, 0x400
v_mfma_f32_16x16x32_bf16 v[104:107], a[96:99], a[48:51], v[104:107]
buffer_load_dwordx4 v23, s[44:47], s20 offen lds
v_mfma_f32_16x16x32_bf16 v[104:107], a[100:103], a[68:71], v[104:107]
v_mfma_f32_16x16x32_bf16 v[112:115], a[100:103], a[72:75], v[112:115]
v_mfma_f32_16x16x32_bf16 v[112:115], a[96:99], a[52:55], v[112:115]
v_mfma_f32_16x16x32_bf16 v[116:119], a[104:107], a[52:55], v[116:119]
ds_read_b64_tr_b16 a[96:97], v14 offset:0
v_mfma_f32_16x16x32_bf16 v[116:119], a[108:111], a[72:75], v[116:119]
ds_read_b64_tr_b16 a[98:99], v14 offset:256
s_add_u32 s8, s28, 0x8000
v_mfma_f32_16x16x32_bf16 v[108:111], a[108:111], a[68:71], v[108:111]
buffer_store_dwordx4 a[196:199], v16, s[88:91], s8 offen sc1
v_mfma_f32_16x16x32_bf16 v[108:111], a[104:107], a[48:51], v[108:111]
ds_read_b64_tr_b16 a[100:101], v14 offset:2048
v_mfma_f32_16x16x32_bf16 v[100:103], a[104:107], a[44:47], v[100:103]
ds_read_b64_tr_b16 a[102:103], v14 offset:2304
v_mfma_f32_16x16x32_bf16 v[100:103], a[108:111], a[64:67], v[100:103]
v_mfma_f32_16x16x32_bf16 v[92:95], a[108:111], a[60:63], v[92:95]
v_mfma_f32_16x16x32_bf16 v[92:95], a[104:107], a[40:43], v[92:95]
s_add_u32 m0, s16, 0x800
s_waitcnt lgkmcnt(4)
v_mfma_f32_16x16x32_bf16 v[120:123], a[80:83], a[40:43], v[120:123]
buffer_load_dwordx4 v22, s[44:47], s21 offen lds
v_mfma_f32_16x16x32_bf16 v[120:123], a[84:87], a[60:63], v[120:123]
ds_read_b64_tr_b16 a[104:105], v15 offset:0
v_mfma_f32_16x16x32_bf16 v[128:131], a[84:87], a[64:67], v[128:131]
ds_read_b64_tr_b16 a[106:107], v15 offset:256
v_mfma_f32_16x16x32_bf16 v[128:131], a[80:83], a[44:47], v[128:131]
ds_read_b64_tr_b16 a[108:109], v15 offset:2048
v_mfma_f32_16x16x32_bf16 v[136:139], a[80:83], a[48:51], v[136:139]
ds_read_b64_tr_b16 a[110:111], v15 offset:2304
v_mfma_f32_16x16x32_bf16 v[136:139], a[84:87], a[68:71], v[136:139]
s_add_u32 m0, s16, 0xc00
v_mfma_f32_16x16x32_bf16 v[144:147], a[84:87], a[72:75], v[144:147]
buffer_load_dwordx4 v23, s[44:47], s21 offen lds
v_mfma_f32_16x16x32_bf16 v[144:147], a[80:83], a[52:55], v[144:147]
v_mfma_f32_16x16x32_bf16 v[148:151], a[88:91], a[52:55], v[148:151]
ds_read_b64_tr_b16 a[80:81], v14 offset:4096
v_mfma_f32_16x16x32_bf16 v[148:151], a[92:95], a[72:75], v[148:151]
ds_read_b64_tr_b16 a[82:83], v14 offset:4352
v_mfma_f32_16x16x32_bf16 v[140:143], a[92:95], a[68:71], v[140:143]
ds_read_b64_tr_b16 a[84:85], v14 offset:6144
v_mfma_f32_16x16x32_bf16 v[140:143], a[88:91], a[48:51], v[140:143]
ds_read_b64_tr_b16 a[86:87], v14 offset:6400
s_add_u32 m0, s16, 0x1000
v_mfma_f32_16x16x32_bf16 v[132:135], a[88:91], a[44:47], v[132:135]
buffer_load_dwordx4 v22, s[44:47], s22 offen lds
v_mfma_f32_16x16x32_bf16 v[132:135], a[92:95], a[64:67], v[132:135]
v_mfma_f32_16x16x32_bf16 v[124:127], a[92:95], a[60:63], v[124:127]
v_mfma_f32_16x16x32_bf16 v[124:127], a[88:91], a[40:43], v[124:127]
s_waitcnt lgkmcnt(4)
v_mfma_f32_16x16x32_bf16 v[152:155], a[96:99], a[40:43], v[152:155]
ds_read_b64_tr_b16 a[88:89], v15 offset:4096
v_mfma_f32_16x16x32_bf16 v[152:155], a[100:103], a[60:63], v[152:155]
ds_read_b64_tr_b16 a[90:91], v15 offset:4352
s_add_u32 m0, s16, 0x1400
v_mfma_f32_16x16x32_bf16 v[160:163], a[100:103], a[64:67], v[160:163]
buffer_load_dwordx4 v23, s[44:47], s22 offen lds
v_mfma_f32_16x16x32_bf16 v[160:163], a[96:99], a[44:47], v[160:163]
ds_read_b64_tr_b16 a[92:93], v15 offset:6144
v_mfma_f32_16x16x32_bf16 v[168:171], a[96:99], a[48:51], v[168:171]
ds_read_b64_tr_b16 a[94:95], v15 offset:6400
v_mfma_f32_16x16x32_bf16 v[168:171], a[100:103], a[68:71], v[168:171]
v_mfma_f32_16x16x32_bf16 v[176:179], a[100:103], a[72:75], v[176:179]
v_mfma_f32_16x16x32_bf16 v[176:179], a[96:99], a[52:55], v[176:179]
s_add_u32 m0, s16, 0x1800
v_mfma_f32_16x16x32_bf16 v[180:183], a[104:107], a[52:55], v[180:183]
buffer_load_dwordx4 v22, s[44:47], s23 offen lds
v_mfma_f32_16x16x32_bf16 v[180:183], a[108:111], a[72:75], v[180:183]
ds_read_b64_tr_b16 a[96:97], v14 offset:8192
v_mfma_f32_16x16x32_bf16 v[172:175], a[108:111], a[68:71], v[172:175]
ds_read_b64_tr_b16 a[98:99], v14 offset:8448
v_mfma_f32_16x16x32_bf16 v[172:175], a[104:107], a[48:51], v[172:175]
ds_read_b64_tr_b16 a[100:101], v14 offset:10240
v_mfma_f32_16x16x32_bf16 v[164:167], a[104:107], a[44:47], v[164:167]
ds_read_b64_tr_b16 a[102:103], v14 offset:10496
v_mfma_f32_16x16x32_bf16 v[164:167], a[108:111], a[64:67], v[164:167]
s_add_u32 m0, s16, 0x1c00
v_mfma_f32_16x16x32_bf16 v[156:159], a[108:111], a[60:63], v[156:159]
buffer_load_dwordx4 v23, s[44:47], s23 offen lds
v_mfma_f32_16x16x32_bf16 v[156:159], a[104:107], a[40:43], v[156:159]
s_waitcnt lgkmcnt(4)
v_add_u32 v22, 0x80, v22
v_add_u32 v23, 0x80, v23
v_mfma_f32_16x16x32_bf16 v[184:187], a[80:83], a[40:43], v[184:187]
ds_read_b64_tr_b16 a[104:105], v15 offset:8192
v_mfma_f32_16x16x32_bf16 v[184:187], a[84:87], a[60:63], v[184:187]
ds_read_b64_tr_b16 a[106:107], v15 offset:8448
v_mfma_f32_16x16x32_bf16 v[192:195], a[84:87], a[64:67], v[192:195]
ds_read_b64_tr_b16 a[108:109], v15 offset:10240
v_mfma_f32_16x16x32_bf16 v[192:195], a[80:83], a[44:47], v[192:195]
ds_read_b64_tr_b16 a[110:111], v15 offset:10496
s_add_u32 s8, s28, 0x4400
v_mfma_f32_16x16x32_bf16 v[200:203], a[80:83], a[48:51], v[200:203]
buffer_store_dwordx4 a[200:203], v16, s[88:91], s8 offen sc1
v_mfma_f32_16x16x32_bf16 v[200:203], a[84:87], a[68:71], v[200:203]
v_add_u32 v12, 0x8000, v12
v_add_u32 v13, 0x8000, v13
v_mfma_f32_16x16x32_bf16 v[208:211], a[84:87], a[72:75], v[208:211]
v_add_u32 v14, 0x8000, v14
v_add_u32 v15, 0x8000, v15
v_mfma_f32_16x16x32_bf16 v[208:211], a[80:83], a[52:55], v[208:211]
v_add_u32 v10, 0x8000, v10
v_add_u32 v11, 0x8000, v11
v_mfma_f32_16x16x32_bf16 v[248:251], a[80:83], a[56:59], v[248:251]
v_mfma_f32_16x16x32_bf16 v[248:251], a[84:87], a[76:79], v[248:251]
v_mfma_f32_16x16x32_bf16 v[212:215], a[88:91], a[52:55], v[212:215]
s_waitcnt vmcnt(30) lgkmcnt(0)
v_mfma_f32_16x16x32_bf16 v[212:215], a[92:95], a[72:75], v[212:215]
s_barrier
s_add_u32 m0, s17, 0x8000
v_mfma_f32_16x16x32_bf16 v[204:207], a[92:95], a[68:71], v[204:207]
buffer_load_dwordx4 v5, s[52:55], 0 offen lds
v_mfma_f32_16x16x32_bf16 v[204:207], a[88:91], a[48:51], v[204:207]
ds_read_b64_tr_b16 a[80:81], v12 offset:0
v_mfma_f32_16x16x32_bf16 v[196:199], a[88:91], a[44:47], v[196:199]
ds_read_b64_tr_b16 a[82:83], v12 offset:1024
v_mfma_f32_16x16x32_bf16 v[196:199], a[92:95], a[64:67], v[196:199]
ds_read_b64_tr_b16 a[84:85], v12 offset:8192
s_waitcnt lgkmcnt(3)
v_mfma_f32_16x16x32_bf16 v[188:191], a[92:95], a[60:63], v[188:191]
ds_read_b64_tr_b16 a[86:87], v12 offset:9216
s_add_u32 m0, s17, 0x8400
v_mfma_f32_16x16x32_bf16 v[188:191], a[88:91], a[40:43], v[188:191]
buffer_load_dwordx4 v5, s[52:55], s13 offen lds
v_mfma_f32_16x16x32_bf16 v[216:219], a[40:43], a[96:99], v[216:219]
ds_read_b64_tr_b16 a[88:89], v13 offset:0
v_mfma_f32_16x16x32_bf16 v[216:219], a[60:63], a[100:103], v[216:219]
ds_read_b64_tr_b16 a[90:91], v13 offset:1024
v_mfma_f32_16x16x32_bf16 v[224:227], a[64:67], a[100:103], v[224:227]
ds_read_b64_tr_b16 a[92:93], v13 offset:8192
v_mfma_f32_16x16x32_bf16 v[224:227], a[44:47], a[96:99], v[224:227]
ds_read_b64_tr_b16 a[94:95], v13 offset:9216
v_mfma_f32_16x16x32_bf16 v[232:235], a[48:51], a[96:99], v[232:235]
s_add_u32 m0, s17, 0x8800
v_mfma_f32_16x16x32_bf16 v[232:235], a[68:71], a[100:103], v[232:235]
buffer_load_dwordx4 v6, s[52:55], 0 offen lds
v_mfma_f32_16x16x32_bf16 v[240:243], a[72:75], a[100:103], v[240:243]
v_mfma_f32_16x16x32_bf16 v[240:243], a[52:55], a[96:99], v[240:243]
v_mfma_f32_16x16x32_bf16 v[252:255], a[56:59], a[96:99], v[252:255]
v_mfma_f32_16x16x32_bf16 v[252:255], a[76:79], a[100:103], v[252:255]
v_mfma_f32_16x16x32_bf16 v[244:247], a[52:55], a[104:107], v[244:247]
ds_read_b64_tr_b16 a[96:97], v12 offset:256
s_add_u32 m0, s17, 0x8c00
v_mfma_f32_16x16x32_bf16 v[244:247], a[72:75], a[108:111], v[244:247]
buffer_load_dwordx4 v6, s[52:55], s13 offen lds
v_mfma_f32_16x16x32_bf16 v[236:239], a[68:71], a[108:111], v[236:239]
ds_read_b64_tr_b16 a[98:99], v12 offset:1280
v_mfma_f32_16x16x32_bf16 v[236:239], a[48:51], a[104:107], v[236:239]
ds_read_b64_tr_b16 a[100:101], v12 offset:8448
v_mfma_f32_16x16x32_bf16 v[228:231], a[44:47], a[104:107], v[228:231]
ds_read_b64_tr_b16 a[102:103], v12 offset:9472
v_mfma_f32_16x16x32_bf16 v[228:231], a[64:67], a[108:111], v[228:231]
v_add_u32 v20, s0, v16
v_mov_b32 v21, s1
v_mfma_f32_16x16x32_bf16 v[220:223], a[60:63], a[108:111], v[220:223]
global_load_dword a120, v[20:21], off sc1
v_mfma_f32_16x16x32_bf16 v[220:223], a[40:43], a[104:107], v[220:223]
s_waitcnt lgkmcnt(4)
L_S14:
v_mfma_f32_16x16x32_bf16 v[24:27], a[80:83], a[0:3], v[24:27]
ds_read_b64_tr_b16 a[104:105], v13 offset:256
s_waitcnt vmcnt(25)
v_mfma_f32_16x16x32_bf16 v[24:27], a[84:87], a[20:23], v[24:27]
ds_read_b64_tr_b16 a[106:107], v13 offset:1280
v_mfma_f32_16x16x32_bf16 v[32:35], a[84:87], a[24:27], v[32:35]
ds_read_b64_tr_b16 a[108:109], v13 offset:8448
v_mfma_f32_16x16x32_bf16 v[32:35], a[80:83], a[4:7], v[32:35]
ds_read_b64_tr_b16 a[110:111], v13 offset:9472
s_add_u32 m0, s18, 0xc000
v_mfma_f32_16x16x32_bf16 v[40:43], a[80:83], a[8:11], v[40:43]
buffer_load_dwordx4 v7, s[68:71], 0 offen lds
v_mfma_f32_16x16x32_bf16 v[40:43], a[84:87], a[28:31], v[40:43]
ds_read_b128 a[40:43], v8 offset:32768
v_mfma_f32_16x16x32_bf16 v[48:51], a[84:87], a[32:35], v[48:51]
ds_read_b128 a[60:63], v9 offset:32768
v_mfma_f32_16x16x32_bf16 v[48:51], a[80:83], a[12:15], v[48:51]
ds_read_b128 a[44:47], v8 offset:34816
v_mfma_f32_16x16x32_bf16 v[52:55], a[88:91], a[12:15], v[52:55]
ds_read_b64_tr_b16 a[80:81], v12 offset:512
v_mfma_f32_16x16x32_bf16 v[52:55], a[92:95], a[32:35], v[52:55]
ds_read_b64_tr_b16 a[82:83], v12 offset:1536
s_add_u32 m0, s18, 0xd000
v_mfma_f32_16x16x32_bf16 v[44:47], a[92:95], a[28:31], v[44:47]
buffer_load_dwordx4 v7, s[68:71], s25 offen lds
v_mfma_f32_16x16x32_bf16 v[44:47], a[88:91], a[8:11], v[44:47]
ds_read_b64_tr_b16 a[84:85], v12 offset:8704
v_mfma_f32_16x16x32_bf16 v[36:39], a[88:91], a[4:7], v[36:39]
ds_read_b64_tr_b16 a[86:87], v12 offset:9728
v_mfma_f32_16x16x32_bf16 v[36:39], a[92:95], a[24:27], v[36:39]
ds_read_b128 a[64:67], v9 offset:34816
s_waitcnt lgkmcnt(8)
v_mfma_f32_16x16x32_bf16 v[28:31], a[92:95], a[20:23], v[28:31]
ds_read_b128 a[48:51], v8 offset:36864
s_add_u32 m0, s18, 0xe000
v_mfma_f32_16x16x32_bf16 v[28:31], a[88:91], a[0:3], v[28:31]
buffer_load_dwordx4 v7, s[68:71], s26 offen lds
v_mfma_f32_16x16x32_bf16 v[56:59], a[96:99], a[0:3], v[56:59]
ds_read_b64_tr_b16 a[88:89], v13 offset:512
v_mfma_f32_16x16x32_bf16 v[56:59], a[100:103], a[20:23], v[56:59]
ds_read_b64_tr_b16 a[90:91], v13 offset:1536
v_mfma_f32_16x16x32_bf16 v[64:67], a[100:103], a[24:27], v[64:67]
ds_read_b64_tr_b16 a[92:93], v13 offset:8704
v_mfma_f32_16x16x32_bf16 v[64:67], a[96:99], a[4:7], v[64:67]
ds_read_b64_tr_b16 a[94:95], v13 offset:9728
v_mfma_f32_16x16x32_bf16 v[72:75], a[96:99], a[8:11], v[72:75]
ds_read_b128 a[68:71], v9 offset:36864
s_add_u32 m0, s18, 0xf000
v_mfma_f32_16x16x32_bf16 v[72:75], a[100:103], a[28:31], v[72:75]
buffer_load_dwordx4 v4, s[44:47], s24 offen lds
v_mfma_f32_16x16x32_bf16 v[80:83], a[100:103], a[32:35], v[80:83]
ds_read_b128 a[52:55], v8 offset:38912
v_add_u32 v5, 0x80000, v5
v_mfma_f32_16x16x32_bf16 v[80:83], a[96:99], a[12:15], v[80:83]
ds_read_b128 a[72:75], v9 offset:38912
v_add_u32 v6, 0x80000, v6
v_mfma_f32_16x16x32_bf16 v[84:87], a[104:107], a[12:15], v[84:87]
ds_read_b64_tr_b16 a[96:97], v12 offset:768
v_add_u32 v7, 0x60000, v7
v_mfma_f32_16x16x32_bf16 v[84:87], a[108:111], a[32:35], v[84:87]
ds_read_b64_tr_b16 a[98:99], v12 offset:1792
v_add_u32 v4, 0x80, v4
v_mfma_f32_16x16x32_bf16 v[76:79], a[108:111], a[28:31], v[76:79]
ds_read_b64_tr_b16 a[100:101], v12 offset:8960
s_add_u32 s8, s28, 0x8400
v_mfma_f32_16x16x32_bf16 v[76:79], a[104:107], a[8:11], v[76:79]
buffer_store_dwordx4 a[204:207], v16, s[88:91], s8 offen sc1
v_mfma_f32_16x16x32_bf16 v[68:71], a[104:107], a[4:7], v[68:71]
ds_read_b64_tr_b16 a[102:103], v12 offset:9984
v_mfma_f32_16x16x32_bf16 v[68:71], a[108:111], a[24:27], v[68:71]
ds_read_b128 a[16:19], v10
v_mfma_f32_16x16x32_bf16 v[60:63], a[108:111], a[20:23], v[60:63]
ds_read_b128 a[36:39], v11
v_mfma_f32_16x16x32_bf16 v[60:63], a[104:107], a[0:3], v[60:63]
s_waitcnt lgkmcnt(6)
s_waitcnt lgkmcnt(9)
v_mfma_f32_16x16x32_bf16 v[88:91], a[80:83], a[0:3], v[88:91]
ds_read_b64_tr_b16 a[104:105], v13 offset:768
s_add_u32 m0, s16, 0x8000
v_mfma_f32_16x16x32_bf16 v[88:91], a[84:87], a[20:23], v[88:91]
buffer_load_dwordx4 v22, s[44:47], s20 offen lds
v_mfma_f32_16x16x32_bf16 v[96:99], a[84:87], a[24:27], v[96:99]
ds_read_b64_tr_b16 a[106:107], v13 offset:1792
v_mfma_f32_16x16x32_bf16 v[96:99], a[80:83], a[4:7], v[96:99]
ds_read_b64_tr_b16 a[108:109], v13 offset:8960
v_mfma_f32_16x16x32_bf16 v[104:107], a[80:83], a[8:11], v[104:107]
ds_read_b64_tr_b16 a[110:111], v13 offset:9984
v_mfma_f32_16x16x32_bf16 v[104:107], a[84:87], a[28:31], v[104:107]
s_add_u32 m0, s16, 0x8400
v_mfma_f32_16x16x32_bf16 v[112:115], a[84:87], a[32:35], v[112:115]
buffer_load_dwordx4 v23, s[44:47], s20 offen lds
v_mfma_f32_16x16x32_bf16 v[112:115], a[80:83], a[12:15], v[112:115]
v_mfma_f32_16x16x32_bf16 v[116:119], a[88:91], a[12:15], v[116:119]
ds_read_b64_tr_b16 a[80:81], v14 offset:0
v_mfma_f32_16x16x32_bf16 v[116:119], a[92:95], a[32:35], v[116:119]
ds_read_b64_tr_b16 a[82:83], v14 offset:256
v_mfma_f32_16x16x32_bf16 v[108:111], a[92:95], a[28:31], v[108:111]
ds_read_b64_tr_b16 a[84:85], v14 offset:2048
v_mfma_f32_16x16x32_bf16 v[108:111], a[88:91], a[8:11], v[108:111]
ds_read_b64_tr_b16 a[86:87], v14 offset:2304
s_add_u32 m0, s16, 0x8800
v_mfma_f32_16x16x32_bf16 v[100:103], a[88:91], a[4:7], v[100:103]
buffer_load_dwordx4 v22, s[44:47], s21 offen lds
v_mfma_f32_16x16x32_bf16 v[100:103], a[92:95], a[24:27], v[100:103]
v_mfma_f32_16x16x32_bf16 v[92:95], a[92:95], a[20:23], v[92:95]
v_mfma_f32_16x16x32_bf16 v[92:95], a[88:91], a[0:3], v[92:95]
s_waitcnt lgkmcnt(4)
v_mfma_f32_16x16x32_bf16 v[120:123], a[96:99], a[0:3], v[120:123]
ds_read_b64_tr_b16 a[88:89], v15 offset:0
v_mfma_f32_16x16x32_bf16 v[120:123], a[100:103], a[20:23], v[120:123]
ds_read_b64_tr_b16 a[90:91], v15 offset:256
s_add_u32 m0, s16, 0x8c00
v_mfma_f32_16x16x32_bf16 v[128:131], a[100:103], a[24:27], v[128:131]
buffer_load_dwordx4 v23, s[44:47], s21 offen lds
v_mfma_f32_16x16x32_bf16 v[128:131], a[96:99], a[4:7], v[128:131]
ds_read_b64_tr_b16 a[92:93], v15 offset:2048
v_mfma_f32_16x16x32_bf16 v[136:139], a[96:99], a[8:11], v[136:139]
ds_read_b64_tr_b16 a[94:95], v15 offset:2304
v_mfma_f32_16x16x32_bf16 v[136:139], a[100:103], a[28:31], v[136:139]
v_mfma_f32_16x16x32_bf16 v[144:147], a[100:103], a[32:35], v[144:147]
s_add_u32 s8, s28, 0x4800
v_mfma_f32_16x16x32_bf16 v[144:147], a[96:99], a[12:15], v[144:147]
buffer_store_dwordx4 a[208:211], v16, s[88:91], s8 offen sc1
v_mfma_f32_16x16x32_bf16 v[148:151], a[104:107], a[12:15], v[148:151]
ds_read_b64_tr_b16 a[96:97], v14 offset:4096
v_mfma_f32_16x16x32_bf16 v[148:151], a[108:111], a[32:35], v[148:151]
ds_read_b64_tr_b16 a[98:99], v14 offset:4352
v_mfma_f32_16x16x32_bf16 v[140:143], a[108:111], a[28:31], v[140:143]
ds_read_b64_tr_b16 a[100:101], v14 offset:6144
v_mfma_f32_16x16x32_bf16 v[140:143], a[104:107], a[8:11], v[140:143]
ds_read_b64_tr_b16 a[102:103], v14 offset:6400
v_mfma_f32_16x16x32_bf16 v[132:135], a[104:107], a[4:7], v[132:135]
s_add_u32 m0, s16, 0x9000
v_mfma_f32_16x16x32_bf16 v[132:135], a[108:111], a[24:27], v[132:135]
buffer_load_dwordx4 v22, s[44:47], s22 offen lds
v_mfma_f32_16x16x32_bf16 v[124:127], a[108:111], a[20:23], v[124:127]
v_mfma_f32_16x16x32_bf16 v[124:127], a[104:107], a[0:3], v[124:127]
s_waitcnt lgkmcnt(4)
v_mfma_f32_16x16x32_bf16 v[152:155], a[80:83], a[0:3], v[152:155]
ds_read_b64_tr_b16 a[104:105], v15 offset:4096
v_mfma_f32_16x16x32_bf16 v[152:155], a[84:87], a[20:23], v[152:155]
ds_read_b64_tr_b16 a[106:107], v15 offset:4352
v_mfma_f32_16x16x32_bf16 v[160:163], a[84:87], a[24:27], v[160:163]
ds_read_b64_tr_b16 a[108:109], v15 offset:6144
s_add_u32 m0, s16, 0x9400
v_mfma_f32_16x16x32_bf16 v[160:163], a[80:83], a[4:7], v[160:163]
buffer_load_dwordx4 v23, s[44:47], s22 offen lds
v_mfma_f32_16x16x32_bf16 v[168:171], a[80:83], a[8:11], v[168:171]
ds_read_b64_tr_b16 a[110:111], v15 offset:6400
v_mfma_f32_16x16x32_bf16 v[168:171], a[84:87], a[28:31], v[168:171]
v_mfma_f32_16x16x32_bf16 v[176:179], a[84:87], a[32:35], v[176:179]
v_mfma_f32_16x16x32_bf16 v[176:179], a[80:83], a[12:15], v[176:179]
s_add_u32 m0, s16, 0x9800
v_mfma_f32_16x16x32_bf16 v[180:183], a[88:91], a[12:15], v[180:183]
buffer_load_dwordx4 v22, s[44:47], s23 offen lds
v_mfma_f32_16x16x32_bf16 v[180:183], a[92:95], a[32:35], v[180:183]
ds_read_b64_tr_b16 a[80:81], v14 offset:8192
v_mfma_f32_16x16x32_bf16 v[172:175], a[92:95], a[28:31], v[172:175]
ds_read_b64_tr_b16 a[82:83], v14 offset:8448
v_mfma_f32_16x16x32_bf16 v[172:175], a[88:91], a[8:11], v[172:175]
ds_read_b64_tr_b16 a[84:85], v14 offset:10240
v_mfma_f32_16x16x32_bf16 v[164:167], a[88:91], a[4:7], v[164:167]
ds_read_b64_tr_b16 a[86:87], v14 offset:10496
v_mfma_f32_16x16x32_bf16 v[164:167], a[92:95], a[24:27], v[164:167]
s_add_u32 m0, s16, 0x9c00
v_mfma_f32_16x16x32_bf16 v[156:159], a[92:95], a[20:23], v[156:159]
buffer_load_dwordx4 v23, s[44:47], s23 offen lds
v_mfma_f32_16x16x32_bf16 v[156:159], a[88:91], a[0:3], v[156:159]
s_waitcnt lgkmcnt(4)
v_add_u32 v22, 0x80, v22
v_add_u32 v23, 0x80, v23
v_mfma_f32_16x16x32_bf16 v[184:187], a[96:99], a[0:3], v[184:187]
ds_read_b64_tr_b16 a[88:89], v15 offset:8192
v_mfma_f32_16x16x32_bf16 v[184:187], a[100:103], a[20:23], v[184:187]
ds_read_b64_tr_b16 a[90:91], v15 offset:8448
v_mfma_f32_16x16x32_bf16 v[192:195], a[100:103], a[24:27], v[192:195]
ds_read_b64_tr_b16 a[92:93], v15 offset:10240
v_mfma_f32_16x16x32_bf16 v[192:195], a[96:99], a[4:7], v[192:195]
ds_read_b64_tr_b16 a[94:95], v15 offset:10496
s_add_u32 s8, s28, 0x8800
v_mfma_f32_16x16x32_bf16 v[200:203], a[96:99], a[8:11], v[200:203]
buffer_store_dwordx4 a[212:215], v16, s[88:91], s8 offen sc1
v_mfma_f32_16x16x32_bf16 v[200:203], a[100:103], a[28:31], v[200:203]
v_add_u32 v12, 0xffff0000, v12
v_add_u32 v13, 0xffff0000, v13
v_mfma_f32_16x16x32_bf16 v[208:211], a[100:103], a[32:35], v[208:211]
v_add_u32 v14, 0xffff0000, v14
v_add_u32 v15, 0xffff0000, v15
v_mfma_f32_16x16x32_bf16 v[208:211], a[96:99], a[12:15], v[208:211]
v_add_u32 v10, 0xffff0000, v10
v_add_u32 v11, 0xffff0000, v11
v_mfma_f32_16x16x32_bf16 v[248:251], a[96:99], a[16:19], v[248:251]
v_mfma_f32_16x16x32_bf16 v[248:251], a[100:103], a[36:39], v[248:251]
v_mfma_f32_16x16x32_bf16 v[212:215], a[104:107], a[12:15], v[212:215]
s_waitcnt vmcnt(30) lgkmcnt(0)
v_mfma_f32_16x16x32_bf16 v[212:215], a[108:111], a[32:35], v[212:215]
s_barrier
s_add_u32 m0, s17, 0x10000
v_mfma_f32_16x16x32_bf16 v[204:207], a[108:111], a[28:31], v[204:207]
buffer_load_dwordx4 v5, s[52:55], 0 offen lds
v_mfma_f32_16x16x32_bf16 v[204:207], a[104:107], a[8:11], v[204:207]
ds_read_b64_tr_b16 a[96:97], v12 offset:0
v_mfma_f32_16x16x32_bf16 v[196:199], a[104:107], a[4:7], v[196:199]
ds_read_b64_tr_b16 a[98:99], v12 offset:1024
v_mfma_f32_16x16x32_bf16 v[196:199], a[108:111], a[24:27], v[196:199]
ds_read_b64_tr_b16 a[100:101], v12 offset:8192
v_mfma_f32_16x16x32_bf16 v[188:191], a[108:111], a[20:23], v[188:191]
ds_read_b64_tr_b16 a[102:103], v12 offset:9216
v_mfma_f32_16x16x32_bf16 v[188:191], a[104:107], a[0:3], v[188:191]
s_add_u32 m0, s17, 0x10400
s_waitcnt lgkmcnt(4)
v_mfma_f32_16x16x32_bf16 v[216:219], a[0:3], a[80:83], v[216:219]
buffer_load_dwordx4 v5, s[52:55], s13 offen lds
v_mfma_f32_16x16x32_bf16 v[216:219], a[20:23], a[84:87], v[216:219]
ds_read_b64_tr_b16 a[104:105], v13 offset:0
v_mfma_f32_16x16x32_bf16 v[224:227], a[24:27], a[84:87], v[224:227]
ds_read_b64_tr_b16 a[106:107], v13 offset:1024
v_mfma_f32_16x16x32_bf16 v[224:227], a[4:7], a[80:83], v[224:227]
ds_read_b64_tr_b16 a[108:109], v13 offset:8192
v_mfma_f32_16x16x32_bf16 v[232:235], a[8:11], a[80:83], v[232:235]
ds_read_b64_tr_b16 a[110:111], v13 offset:9216
v_mfma_f32_16x16x32_bf16 v[232:235], a[28:31], a[84:87], v[232:235]
s_add_u32 m0, s17, 0x10800
v_mfma_f32_16x16x32_bf16 v[240:243], a[32:35], a[84:87], v[240:243]
buffer_load_dwordx4 v6, s[52:55], 0 offen lds
v_mfma_f32_16x16x32_bf16 v[240:243], a[12:15], a[80:83], v[240:243]
v_mfma_f32_16x16x32_bf16 v[252:255], a[16:19], a[80:83], v[252:255]
v_mfma_f32_16x16x32_bf16 v[252:255], a[36:39], a[84:87], v[252:255]
v_mfma_f32_16x16x32_bf16 v[244:247], a[12:15], a[88:91], v[244:247]
ds_read_b64_tr_b16 a[80:81], v12 offset:256
v_mfma_f32_16x16x32_bf16 v[244:247], a[32:35], a[92:95], v[244:247]
ds_read_b64_tr_b16 a[82:83], v12 offset:1280
s_add_u32 m0, s17, 0x10c00
v_mfma_f32_16x16x32_bf16 v[236:239], a[28:31], a[92:95], v[236:239]
buffer_load_dwordx4 v6, s[52:55], s13 offen lds
v_mfma_f32_16x16x32_bf16 v[236:239], a[8:11], a[88:91], v[236:239]
ds_read_b64_tr_b16 a[84:85], v12 offset:8448
v_mfma_f32_16x16x32_bf16 v[228:231], a[4:7], a[88:91], v[228:231]
ds_read_b64_tr_b16 a[86:87], v12 offset:9472
v_mfma_f32_16x16x32_bf16 v[228:231], a[24:27], a[92:95], v[228:231]
v_mfma_f32_16x16x32_bf16 v[220:223], a[20:23], a[92:95], v[220:223]
v_mfma_f32_16x16x32_bf16 v[220:223], a[0:3], a[88:91], v[220:223]
s_add_u32 m0, s18, 0x14000
s_waitcnt lgkmcnt(4)
L_S15:
v_mfma_f32_16x16x32_bf16 v[24:27], a[96:99], a[40:43], v[24:27]
buffer_load_dwordx4 v7, s[68:71], 0 offen lds
v_mfma_f32_16x16x32_bf16 v[24:27], a[100:103], a[60:63], v[24:27]
ds_read_b64_tr_b16 a[88:89], v13 offset:256
s_waitcnt vmcnt(26)
v_mfma_f32_16x16x32_bf16 v[32:35], a[100:103], a[64:67], v[32:35]
ds_read_b64_tr_b16 a[90:91], v13 offset:1280
v_mfma_f32_16x16x32_bf16 v[32:35], a[96:99], a[44:47], v[32:35]
ds_read_b64_tr_b16 a[92:93], v13 offset:8448
v_mfma_f32_16x16x32_bf16 v[40:43], a[96:99], a[48:51], v[40:43]
ds_read_b64_tr_b16 a[94:95], v13 offset:9472
v_mfma_f32_16x16x32_bf16 v[40:43], a[100:103], a[68:71], v[40:43]
ds_read_b128 a[0:3], v8 offset:0
s_add_u32 s8, s28, 0x4c00
v_mfma_f32_16x16x32_bf16 v[48:51], a[100:103], a[72:75], v[48:51]
buffer_store_dwordx4 a[216:219], v16, s[88:91], s8 offen sc1
v_mfma_f32_16x16x32_bf16 v[48:51], a[96:99], a[52:55], v[48:51]
ds_read_b128 a[20:23], v9 offset:0
v_mfma_f32_16x16x32_bf16 v[52:55], a[104:107], a[52:55], v[52:55]
ds_read_b64_tr_b16 a[96:97], v12 offset:512
v_mfma_f32_16x16x32_bf16 v[52:55], a[108:111], a[72:75], v[52:55]
ds_read_b64_tr_b16 a[98:99], v12 offset:1536
v_mfma_f32_16x16x32_bf16 v[44:47], a[108:111], a[68:71], v[44:47]
ds_read_b64_tr_b16 a[100:101], v12 offset:8704
v_mfma_f32_16x16x32_bf16 v[44:47], a[104:107], a[48:51], v[44:47]
ds_read_b64_tr_b16 a[102:103], v12 offset:9728
s_add_u32 m0, s18, 0x15000
v_mfma_f32_16x16x32_bf16 v[36:39], a[104:107], a[44:47], v[36:39]
buffer_load_dwordx4 v7, s[68:71], s25 offen lds
v_mfma_f32_16x16x32_bf16 v[36:39], a[108:111], a[64:67], v[36:39]
ds_read_b128 a[4:7], v8 offset:2048
v_mfma_f32_16x16x32_bf16 v[28:31], a[108:111], a[60:63], v[28:31]
ds_read_b128 a[24:27], v9 offset:2048
v_mfma_f32_16x16x32_bf16 v[28:31], a[104:107], a[40:43], v[28:31]
ds_read_b128 a[8:11], v8 offset:4096
s_waitcnt lgkmcnt(9)
v_mfma_f32_16x16x32_bf16 v[56:59], a[80:83], a[40:43], v[56:59]
ds_read_b64_tr_b16 a[104:105], v13 offset:512
v_mfma_f32_16x16x32_bf16 v[56:59], a[84:87], a[60:63], v[56:59]
ds_read_b64_tr_b16 a[106:107], v13 offset:1536
s_add_u32 m0, s18, 0x16000
v_mfma_f32_16x16x32_bf16 v[64:67], a[84:87], a[64:67], v[64:67]
buffer_load_dwordx4 v7, s[68:71], s26 offen lds
v_mfma_f32_16x16x32_bf16 v[64:67], a[80:83], a[44:47], v[64:67]
ds_read_b64_tr_b16 a[108:109], v13 offset:8704
v_mfma_f32_16x16x32_bf16 v[72:75], a[80:83], a[48:51], v[72:75]
ds_read_b64_tr_b16 a[110:111], v13 offset:9728
v_mfma_f32_16x16x32_bf16 v[72:75], a[84:87], a[68:71], v[72:75]
ds_read_b128 a[28:31], v9 offset:4096
v_mfma_f32_16x16x32_bf16 v[80:83], a[84:87], a[72:75], v[80:83]
ds_read_b128 a[12:15], v8 offset:6144
v_mfma_f32_16x16x32_bf16 v[80:83], a[80:83], a[52:55], v[80:83]
ds_read_b128 a[32:35], v9 offset:6144
s_add_u32 m0, s18, 0x17000
v_mfma_f32_16x16x32_bf16 v[84:87], a[88:91], a[52:55], v[84:87]
buffer_load_dwordx4 v4, s[44:47], s24 offen lds
v_mfma_f32_16x16x32_bf16 v[84:87], a[92:95], a[72:75], v[84:87]
ds_read_b64_tr_b16 a[80:81], v12 offset:768
v_add_u32 v5, 0x80000, v5
v_mfma_f32_16x16x32_bf16 v[76:79], a[92:95], a[68:71], v[76:79]
ds_read_b64_tr_b16 a[82:83], v12 offset:1792
v_add_u32 v6, 0x80000, v6
v_mfma_f32_16x16x32_bf16 v[76:79], a[88:91], a[48:51], v[76:79]
ds_read_b64_tr_b16 a[84:85], v12 offset:8960
v_add_u32 v7, 0x60000, v7
v_mfma_f32_16x16x32_bf16 v[68:71], a[88:91], a[44:47], v[68:71]
ds_read_b64_tr_b16 a[86:87], v12 offset:9984
v_add_u32 v4, 0x80, v4
v_mfma_f32_16x16x32_bf16 v[68:71], a[92:95], a[64:67], v[68:71]
ds_read_b128 a[56:59], v10
s_add_u32 m0, s16, 0x0
s_waitcnt lgkmcnt(5)
v_mfma_f32_16x16x32_bf16 v[60:63], a[92:95], a[60:63], v[60:63]
buffer_load_dwordx4 v22, s[44:47], s20 offen lds
v_mfma_f32_16x16x32_bf16 v[60:63], a[88:91], a[40:43], v[60:63]
ds_read_b128 a[76:79], v11
s_waitcnt lgkmcnt(9)
v_mfma_f32_16x16x32_bf16 v[88:91], a[96:99], a[40:43], v[88:91]
ds_read_b64_tr_b16 a[88:89], v13 offset:768
v_mfma_f32_16x16x32_bf16 v[88:91], a[100:103], a[60:63], v[88:91]
ds_read_b64_tr_b16 a[90:91], v13 offset:1792
v_mfma_f32_16x16x32_bf16 v[96:99], a[100:103], a[64:67], v[96:99]
ds_read_b64_tr_b16 a[92:93], v13 offset:8960
v_mfma_f32_16x16x32_bf16 v[96:99], a[96:99], a[44:47], v[96:99]
ds_read_b64_tr_b16 a[94:95], v13 offset:9984
s_add_u32 m0, s16, 0x400
v_mfma_f32_16x16x32_bf16 v[104:107], a[96:99], a[48:51], v[104:107]
buffer_load_dwordx4 v23, s[44:47], s20 offen lds
v_mfma_f32_16x16x32_bf16 v[104:107], a[100:103], a[68:71], v[104:107]
v_mfma_f32_16x16x32_bf16 v[112:115], a[100:103], a[72:75], v[112:115]
v_mfma_f32_16x16x32_bf16 v[112:115], a[96:99], a[52:55], v[112:115]
v_mfma_f32_16x16x32_bf16 v[116:119], a[104:107], a[52:55], v[116:119]
ds_read_b64_tr_b16 a[96:97], v14 offset:0
v_mfma_f32_16x16x32_bf16 v[116:119], a[108:111], a[72:75], v[116:119]
ds_read_b64_tr_b16 a[98:99], v14 offset:256
s_add_u32 s8, s28, 0x8c00
v_mfma_f32_16x16x32_bf16 v[108:111], a[108:111], a[68:71], v[108:111]
buffer_store_dwordx4 a[220:223], v16, s[88:91], s8 offen sc1
v_mfma_f32_16x16x32_bf16 v[108:111], a[104:107], a[48:51], v[108:111]
ds_read_b64_tr_b16 a[100:101], v14 offset:2048
v_mfma_f32_16x16x32_bf16 v[100:103], a[104:107], a[44:47], v[100:103]
ds_read_b64_tr_b16 a[102:103], v14 offset:2304
v_mfma_f32_16x16x32_bf16 v[100:103], a[108:111], a[64:67], v[100:103]
L_padA8:
s_cmp_eq_u32 s95, 1
s_cbranch_scc1 L_padA12
v_mfma_f32_16x16x32_bf16 v[92:95], a[108:111], a[60:63], v[92:95]
v_mfma_f32_16x16x32_bf16 v[92:95], a[104:107], a[40:43], v[92:95]
s_add_u32 m0, s16, 0x800
s_waitcnt lgkmcnt(4)
v_mfma_f32_16x16x32_bf16 v[120:123], a[80:83], a[40:43], v[120:123]
buffer_load_dwordx4 v22, s[44:47], s21 offen lds
v_mfma_f32_16x16x32_bf16 v[120:123], a[84:87], a[60:63], v[120:123]
ds_read_b64_tr_b16 a[104:105], v15 offset:0
v_mfma_f32_16x16x32_bf16 v[128:131], a[84:87], a[64:67], v[128:131]
ds_read_b64_tr_b16 a[106:107], v15 offset:256
v_mfma_f32_16x16x32_bf16 v[128:131], a[80:83], a[44:47], v[128:131]
ds_read_b64_tr_b16 a[108:109], v15 offset:2048
v_mfma_f32_16x16x32_bf16 v[136:139], a[80:83], a[48:51], v[136:139]
ds_read_b64_tr_b16 a[110:111], v15 offset:2304
v_mfma_f32_16x16x32_bf16 v[136:139], a[84:87], a[68:71], v[136:139]
s_add_u32 m0, s16, 0xc00
v_mfma_f32_16x16x32_bf16 v[144:147], a[84:87], a[72:75], v[144:147]
buffer_load_dwordx4 v23, s[44:47], s21 offen lds
v_mfma_f32_16x16x32_bf16 v[144:147], a[80:83], a[52:55], v[144:147]
v_mfma_f32_16x16x32_bf16 v[148:151], a[88:91], a[52:55], v[148:151]
ds_read_b64_tr_b16 a[80:81], v14 offset:4096
v_mfma_f32_16x16x32_bf16 v[148:151], a[92:95], a[72:75], v[148:151]
ds_read_b64_tr_b16 a[82:83], v14 offset:4352
v_mfma_f32_16x16x32_bf16 v[140:143], a[92:95], a[68:71], v[140:143]
ds_read_b64_tr_b16 a[84:85], v14 offset:6144
v_mfma_f32_16x16x32_bf16 v[140:143], a[88:91], a[48:51], v[140:143]
ds_read_b64_tr_b16 a[86:87], v14 offset:6400
s_add_u32 m0, s16, 0x1000
v_mfma_f32_16x16x32_bf16 v[132:135], a[88:91], a[44:47], v[132:135]
buffer_load_dwordx4 v22, s[44:47], s22 offen lds
v_mfma_f32_16x16x32_bf16 v[132:135], a[92:95], a[64:67], v[132:135]
v_mfma_f32_16x16x32_bf16 v[124:127], a[92:95], a[60:63], v[124:127]
v_mfma_f32_16x16x32_bf16 v[124:127], a[88:91], a[40:43], v[124:127]
s_waitcnt lgkmcnt(4)
v_mfma_f32_16x16x32_bf16 v[152:155], a[96:99], a[40:43], v[152:155]
ds_read_b64_tr_b16 a[88:89], v15 offset:4096
v_mfma_f32_16x16x32_bf16 v[152:155], a[100:103], a[60:63], v[152:155]
ds_read_b64_tr_b16 a[90:91], v15 offset:4352
s_add_u32 m0, s16, 0x1400
v_mfma_f32_16x16x32_bf16 v[160:163], a[100:103], a[64:67], v[160:163]
buffer_load_dwordx4 v23, s[44:47], s22 offen lds
v_mfma_f32_16x16x32_bf16 v[160:163], a[96:99], a[44:47], v[160:163]
ds_read_b64_tr_b16 a[92:93], v15 offset:6144
v_mfma_f32_16x16x32_bf16 v[168:171], a[96:99], a[48:51], v[168:171]
ds_read_b64_tr_b16 a[94:95], v15 offset:6400
v_mfma_f32_16x16x32_bf16 v[168:171], a[100:103], a[68:71], v[168:171]
v_mfma_f32_16x16x32_bf16 v[176:179], a[100:103], a[72:75], v[176:179]
v_mfma_f32_16x16x32_bf16 v[176:179], a[96:99], a[52:55], v[176:179]
s_add_u32 m0, s16, 0x1800
v_mfma_f32_16x16x32_bf16 v[180:183], a[104:107], a[52:55], v[180:183]
buffer_load_dwordx4 v22, s[44:47], s23 offen lds
v_mfma_f32_16x16x32_bf16 v[180:183], a[108:111], a[72:75], v[180:183]
ds_read_b64_tr_b16 a[96:97], v14 offset:8192
v_mfma_f32_16x16x32_bf16 v[172:175], a[108:111], a[68:71], v[172:175]
ds_read_b64_tr_b16 a[98:99], v14 offset:8448
v_mfma_f32_16x16x32_bf16 v[172:175], a[104:107], a[48:51], v[172:175]
ds_read_b64_tr_b16 a[100:101], v14 offset:10240
v_mfma_f32_16x16x32_bf16 v[164:167], a[104:107], a[44:47], v[164:167]
ds_read_b64_tr_b16 a[102:103], v14 offset:10496
v_mfma_f32_16x16x32_bf16 v[164:167], a[108:111], a[64:67], v[164:167]
s_add_u32 m0, s16, 0x1c00
v_mfma_f32_16x16x32_bf16 v[156:159], a[108:111], a[60:63], v[156:159]
buffer_load_dwordx4 v23, s[44:47], s23 offen lds
v_mfma_f32_16x16x32_bf16 v[156:159], a[104:107], a[40:43], v[156:159]
s_waitcnt lgkmcnt(4)
v_add_u32 v22, 0x80, v22
v_add_u32 v23, 0x80, v23
v_mfma_f32_16x16x32_bf16 v[184:187], a[80:83], a[40:43], v[184:187]
ds_read_b64_tr_b16 a[104:105], v15 offset:8192
v_mfma_f32_16x16x32_bf16 v[184:187], a[84:87], a[60:63], v[184:187]
ds_read_b64_tr_b16 a[106:107], v15 offset:8448
v_mfma_f32_16x16x32_bf16 v[192:195], a[84:87], a[64:67], v[192:195]
ds_read_b64_tr_b16 a[108:109], v15 offset:10240
v_mfma_f32_16x16x32_bf16 v[192:195], a[80:83], a[44:47], v[192:195]
ds_read_b64_tr_b16 a[110:111], v15 offset:10496
s_add_u32 s8, s28, 0x5000
v_mfma_f32_16x16x32_bf16 v[200:203], a[80:83], a[48:51], v[200:203]
buffer_store_dwordx4 a[224:227], v16, s[88:91], s8 offen sc1
v_mfma_f32_16x16x32_bf16 v[200:203], a[84:87], a[68:71], v[200:203]
v_add_u32 v12, 0x8000, v12
v_add_u32 v13, 0x8000, v13
v_mfma_f32_16x16x32_bf16 v[208:211], a[84:87], a[72:75], v[208:211]
v_add_u32 v14, 0x8000, v14
v_add_u32 v15, 0x8000, v15
v_mfma_f32_16x16x32_bf16 v[208:211], a[80:83], a[52:55], v[208:211]
v_add_u32 v10, 0x8000, v10
v_add_u32 v11, 0x8000, v11
v_mfma_f32_16x16x32_bf16 v[248:251], a[80:83], a[56:59], v[248:251]
v_mfma_f32_16x16x32_bf16 v[248:251], a[84:87], a[76:79], v[248:251]
v_mfma_f32_16x16x32_bf16 v[212:215], a[88:91], a[52:55], v[212:215]
s_waitcnt vmcnt(30) lgkmcnt(0)
v_mfma_f32_16x16x32_bf16 v[212:215], a[92:95], a[72:75], v[212:215]
s_barrier
s_add_u32 m0, s17, 0x0
v_mfma_f32_16x16x32_bf16 v[204:207], a[92:95], a[68:71], v[204:207]
buffer_load_dwordx4 v5, s[52:55], 0 offen lds
v_mfma_f32_16x16x32_bf16 v[204:207], a[88:91], a[48:51], v[204:207]
ds_read_b64_tr_b16 a[80:81], v12 offset:0
v_mfma_f32_16x16x32_bf16 v[196:199], a[88:91], a[44:47], v[196:199]
ds_read_b64_tr_b16 a[82:83], v12 offset:1024
v_mfma_f32_16x16x32_bf16 v[196:199], a[92:95], a[64:67], v[196:199]
ds_read_b64_tr_b16 a[84:85], v12 offset:8192
v_mfma_f32_16x16x32_bf16 v[188:191], a[92:95], a[60:63], v[188:191]
ds_read_b64_tr_b16 a[86:87], v12 offset:9216
v_mfma_f32_16x16x32_bf16 v[188:191], a[88:91], a[40:43], v[188:191]
s_add_u32 m0, s17, 0x400
s_waitcnt lgkmcnt(4)
v_mfma_f32_16x16x32_bf16 v[216:219], a[40:43], a[96:99], v[216:219]
buffer_load_dwordx4 v5, s[52:55], s13 offen lds
v_mfma_f32_16x16x32_bf16 v[216:219], a[60:63], a[100:103], v[216:219]
ds_read_b64_tr_b16 a[88:89], v13 offset:0
v_mfma_f32_16x16x32_bf16 v[224:227], a[64:67], a[100:103], v[224:227]
ds_read_b64_tr_b16 a[90:91], v13 offset:1024
v_mfma_f32_16x16x32_bf16 v[224:227], a[44:47], a[96:99], v[224:227]
ds_read_b64_tr_b16 a[92:93], v13 offset:8192
v_mfma_f32_16x16x32_bf16 v[232:235], a[48:51], a[96:99], v[232:235]
ds_read_b64_tr_b16 a[94:95], v13 offset:9216
v_mfma_f32_16x16x32_bf16 v[232:235], a[68:71], a[100:103], v[232:235]
s_add_u32 m0, s17, 0x800
v_mfma_f32_16x16x32_bf16 v[240:243], a[72:75], a[100:103], v[240:243]
buffer_load_dwordx4 v6, s[52:55], 0 offen lds
v_mfma_f32_16x16x32_bf16 v[240:243], a[52:55], a[96:99], v[240:243]
v_mfma_f32_16x16x32_bf16 v[252:255], a[56:59], a[96:99], v[252:255]
v_mfma_f32_16x16x32_bf16 v[252:255], a[76:79], a[100:103], v[252:255]
v_mfma_f32_16x16x32_bf16 v[244:247], a[52:55], a[104:107], v[244:247]
ds_read_b64_tr_b16 a[96:97], v12 offset:256
v_mfma_f32_16x16x32_bf16 v[244:247], a[72:75], a[108:111], v[244:247]
ds_read_b64_tr_b16 a[98:99], v12 offset:1280
s_add_u32 m0, s17, 0xc00
v_mfma_f32_16x16x32_bf16 v[236:239], a[68:71], a[108:111], v[236:239]
buffer_load_dwordx4 v6, s[52:55], s13 offen lds
v_mfma_f32_16x16x32_bf16 v[236:239], a[48:51], a[104:107], v[236:239]
ds_read_b64_tr_b16 a[100:101], v12 offset:8448
v_mfma_f32_16x16x32_bf16 v[228:231], a[44:47], a[104:107], v[228:231]
ds_read_b64_tr_b16 a[102:103], v12 offset:9472
v_mfma_f32_16x16x32_bf16 v[228:231], a[64:67], a[108:111], v[228:231]
v_mfma_f32_16x16x32_bf16 v[220:223], a[60:63], a[108:111], v[220:223]
v_mfma_f32_16x16x32_bf16 v[220:223], a[40:43], a[104:107], v[220:223]
s_add_u32 m0, s18, 0x4000
s_waitcnt lgkmcnt(4)
L_S16:
v_mfma_f32_16x16x32_bf16 v[24:27], a[80:83], a[0:3], v[24:27]
buffer_load_dwordx4 v7, s[68:71], 0 offen lds
v_mfma_f32_16x16x32_bf16 v[24:27], a[84:87], a[20:23], v[24:27]
ds_read_b64_tr_b16 a[104:105], v13 offset:256
s_waitcnt vmcnt(25)
v_mfma_f32_16x16x32_bf16 v[32:35], a[84:87], a[24:27], v[32:35]
ds_read_b64_tr_b16 a[106:107], v13 offset:1280
v_mfma_f32_16x16x32_bf16 v[32:35], a[80:83], a[4:7], v[32:35]
ds_read_b64_tr_b16 a[108:109], v13 offset:8448
v_mfma_f32_16x16x32_bf16 v[40:43], a[80:83], a[8:11], v[40:43]
ds_read_b64_tr_b16 a[110:111], v13 offset:9472
v_mfma_f32_16x16x32_bf16 v[40:43], a[84:87], a[28:31], v[40:43]
ds_read_b128 a[40:43], v8 offset:32768
s_add_u32 s8, s28, 0x9000
v_mfma_f32_16x16x32_bf16 v[48:51], a[84:87], a[32:35], v[48:51]
buffer_store_dwordx4 a[228:231], v16, s[88:91], s8 offen sc1
v_mfma_f32_16x16x32_bf16 v[48:51], a[80:83], a[12:15], v[48:51]
ds_read_b128 a[60:63], v9 offset:32768
v_mfma_f32_16x16x32_bf16 v[52:55], a[88:91], a[12:15], v[52:55]
ds_read_b64_tr_b16 a[80:81], v12 offset:512
v_mfma_f32_16x16x32_bf16 v[52:55], a[92:95], a[32:35], v[52:55]
ds_read_b64_tr_b16 a[82:83], v12 offset:1536
v_mfma_f32_16x16x32_bf16 v[44:47], a[92:95], a[28:31], v[44:47]
ds_read_b64_tr_b16 a[84:85], v12 offset:8704
v_mfma_f32_16x16x32_bf16 v[44:47], a[88:91], a[8:11], v[44:47]
ds_read_b64_tr_b16 a[86:87], v12 offset:9728
s_add_u32 m0, s18, 0x5000
v_mfma_f32_16x16x32_bf16 v[36:39], a[88:91], a[4:7], v[36:39]
buffer_load_dwordx4 v7, s[68:71], s25 offen lds
v_mfma_f32_16x16x32_bf16 v[36:39], a[92:95], a[24:27], v[36:39]
ds_read_b128 a[44:47], v8 offset:34816
v_mfma_f32_16x16x32_bf16 v[28:31], a[92:95], a[20:23], v[28:31]
ds_read_b128 a[64:67], v9 offset:34816
v_mfma_f32_16x16x32_bf16 v[28:31], a[88:91], a[0:3], v[28:31]
ds_read_b128 a[48:51], v8 offset:36864
s_waitcnt lgkmcnt(9)
v_mfma_f32_16x16x32_bf16 v[56:59], a[96:99], a[0:3], v[56:59]
ds_read_b64_tr_b16 a[88:89], v13 offset:512
v_mfma_f32_16x16x32_bf16 v[56:59], a[100:103], a[20:23], v[56:59]
ds_read_b64_tr_b16 a[90:91], v13 offset:1536
s_add_u32 m0, s18, 0x6000
v_mfma_f32_16x16x32_bf16 v[64:67], a[100:103], a[24:27], v[64:67]
buffer_load_dwordx4 v7, s[68:71], s26 offen lds
v_mfma_f32_16x16x32_bf16 v[64:67], a[96:99], a[4:7], v[64:67]
ds_read_b64_tr_b16 a[92:93], v13 offset:8704
v_mfma_f32_16x16x32_bf16 v[72:75], a[96:99], a[8:11], v[72:75]
ds_read_b64_tr_b16 a[94:95], v13 offset:9728
v_mfma_f32_16x16x32_bf16 v[72:75], a[100:103], a[28:31], v[72:75]
ds_read_b128 a[68:71], v9 offset:36864
v_mfma_f32_16x16x32_bf16 v[80:83], a[100:103], a[32:35], v[80:83]
ds_read_b128 a[52:55], v8 offset:38912
v_mfma_f32_16x16x32_bf16 v[80:83], a[96:99], a[12:15], v[80:83]
ds_read_b128 a[72:75], v9 offset:38912
s_add_u32 m0, s18, 0x7000
v_mfma_f32_16x16x32_bf16 v[84:87], a[104:107], a[12:15], v[84:87]
buffer_load_dwordx4 v4, s[44:47], s24 offen lds
v_mfma_f32_16x16x32_bf16 v[84:87], a[108:111], a[32:35], v[84:87]
ds_read_b64_tr_b16 a[96:97], v12 offset:768
v_add_u32 v5, 0x80000, v5
v_mfma_f32_16x16x32_bf16 v[76:79], a[108:111], a[28:31], v[76:79]
ds_read_b64_tr_b16 a[98:99], v12 offset:1792
v_add_u32 v6, 0x80000, v6
v_mfma_f32_16x16x32_bf16 v[76:79], a[104:107], a[8:11], v[76:79]
ds_read_b64_tr_b16 a[100:101], v12 offset:8960
v_add_u32 v7, 0x60000, v7
v_mfma_f32_16x16x32_bf16 v[68:71], a[104:107], a[4:7], v[68:71]
ds_read_b64_tr_b16 a[102:103], v12 offset:9984
v_add_u32 v4, 0x80, v4
v_mfma_f32_16x16x32_bf16 v[68:71], a[108:111], a[24:27], v[68:71]
ds_read_b128 a[16:19], v10
s_add_u32 m0, s16, 0x8000
s_waitcnt lgkmcnt(5)
v_mfma_f32_16x16x32_bf16 v[60:63], a[108:111], a[20:23], v[60:63]
buffer_load_dwordx4 v22, s[44:47], s20 offen lds
v_mfma_f32_16x16x32_bf16 v[60:63], a[104:107], a[0:3], v[60:63]
ds_read_b128 a[36:39], v11
s_waitcnt lgkmcnt(9)
v_mfma_f32_16x16x32_bf16 v[88:91], a[80:83], a[0:3], v[88:91]
ds_read_b64_tr_b16 a[104:105], v13 offset:768
v_mfma_f32_16x16x32_bf16 v[88:91], a[84:87], a[20:23], v[88:91]
ds_read_b64_tr_b16 a[106:107], v13 offset:1792
v_mfma_f32_16x16x32_bf16 v[96:99], a[84:87], a[24:27], v[96:99]
ds_read_b64_tr_b16 a[108:109], v13 offset:8960
v_mfma_f32_16x16x32_bf16 v[96:99], a[80:83], a[4:7], v[96:99]
ds_read_b64_tr_b16 a[110:111], v13 offset:9984
s_add_u32 m0, s16, 0x8400
v_mfma_f32_16x16x32_bf16 v[104:107], a[80:83], a[8:11], v[104:107]
buffer_load_dwordx4 v23, s[44:47], s20 offen lds
v_mfma_f32_16x16x32_bf16 v[104:107], a[84:87], a[28:31], v[104:107]
v_mfma_f32_16x16x32_bf16 v[112:115], a[84:87], a[32:35], v[112:115]
v_mfma_f32_16x16x32_bf16 v[112:115], a[80:83], a[12:15], v[112:115]
v_mfma_f32_16x16x32_bf16 v[116:119], a[88:91], a[12:15], v[116:119]
ds_read_b64_tr_b16 a[80:81], v14 offset:0
v_mfma_f32_16x16x32_bf16 v[116:119], a[92:95], a[32:35], v[116:119]
ds_read_b64_tr_b16 a[82:83], v14 offset:256
s_add_u32 s8, s28, 0x5400
v_mfma_f32_16x16x32_bf16 v[108:111], a[92:95], a[28:31], v[108:111]
buffer_store_dwordx4 a[112:115], v16, s[88:91], s8 offen sc1
v_mfma_f32_16x16x32_bf16 v[108:111], a[88:91], a[8:11], v[108:111]
ds_read_b64_tr_b16 a[84:85], v14 offset:2048
v_mfma_f32_16x16x32_bf16 v[100:103], a[88:91], a[4:7], v[100:103]
ds_read_b64_tr_b16 a[86:87], v14 offset:2304
v_mfma_f32_16x16x32_bf16 v[100:103], a[92:95], a[24:27], v[100:103]
v_mfma_f32_16x16x32_bf16 v[92:95], a[92:95], a[20:23], v[92:95]
v_mfma_f32_16x16x32_bf16 v[92:95], a[88:91], a[0:3], v[92:95]
s_add_u32 m0, s16, 0x8800
s_waitcnt lgkmcnt(4)
v_mfma_f32_16x16x32_bf16 v[120:123], a[96:99], a[0:3], v[120:123]
buffer_load_dwordx4 v22, s[44:47], s21 offen lds
v_mfma_f32_16x16x32_bf16 v[120:123], a[100:103], a[20:23], v[120:123]
ds_read_b64_tr_b16 a[88:89], v15 offset:0
v_mfma_f32_16x16x32_bf16 v[128:131], a[100:103], a[24:27], v[128:131]
ds_read_b64_tr_b16 a[90:91], v15 offset:256
v_mfma_f32_16x16x32_bf16 v[128:131], a[96:99], a[4:7], v[128:131]
ds_read_b64_tr_b16 a[92:93], v15 offset:2048
v_mfma_f32_16x16x32_bf16 v[136:139], a[96:99], a[8:11], v[136:139]
ds_read_b64_tr_b16 a[94:95], v15 offset:2304
v_mfma_f32_16x16x32_bf16 v[136:139], a[100:103], a[28:31], v[136:139]
s_add_u32 m0, s16, 0x8c00
v_mfma_f32_16x16x32_bf16 v[144:147], a[100:103], a[32:35], v[144:147]
buffer_load_dwordx4 v23, s[44:47], s21 offen lds
v_mfma_f32_16x16x32_bf16 v[144:147], a[96:99], a[12:15], v[144:147]
v_mfma_f32_16x16x32_bf16 v[148:151], a[104:107], a[12:15], v[148:151]
ds_read_b64_tr_b16 a[96:97], v14 offset:4096
v_mfma_f32_16x16x32_bf16 v[148:151], a[108:111], a[32:35], v[148:151]
ds_read_b64_tr_b16 a[98:99], v14 offset:4352
v_mfma_f32_16x16x32_bf16 v[140:143], a[108:111], a[28:31], v[140:143]
ds_read_b64_tr_b16 a[100:101], v14 offset:6144
v_mfma_f32_16x16x32_bf16 v[140:143], a[104:107], a[8:11], v[140:143]
ds_read_b64_tr_b16 a[102:103], v14 offset:6400
s_add_u32 m0, s16, 0x9000
v_mfma_f32_16x16x32_bf16 v[132:135], a[104:107], a[4:7], v[132:135]
buffer_load_dwordx4 v22, s[44:47], s22 offen lds
v_mfma_f32_16x16x32_bf16 v[132:135], a[108:111], a[24:27], v[132:135]
v_mfma_f32_16x16x32_bf16 v[124:127], a[108:111], a[20:23], v[124:127]
v_mfma_f32_16x16x32_bf16 v[124:127], a[104:107], a[0:3], v[124:127]
s_waitcnt lgkmcnt(4)
v_mfma_f32_16x16x32_bf16 v[152:155], a[80:83], a[0:3], v[152:155]
ds_read_b64_tr_b16 a[104:105], v15 offset:4096
v_mfma_f32_16x16x32_bf16 v[152:155], a[84:87], a[20:23], v[152:155]
ds_read_b64_tr_b16 a[106:107], v15 offset:4352
s_add_u32 m0, s16, 0x9400
v_mfma_f32_16x16x32_bf16 v[160:163], a[84:87], a[24:27], v[160:163]
buffer_load_dwordx4 v23, s[44:47], s22 offen lds
v_mfma_f32_16x16x32_bf16 v[160:163], a[80:83], a[4:7], v[160:163]
ds_read_b64_tr_b16 a[108:109], v15 offset:6144
v_mfma_f32_16x16x32_bf16 v[168:171], a[80:83], a[8:11], v[168:171]
ds_read_b64_tr_b16 a[110:111], v15 offset:6400
v_mfma_f32_16x16x32_bf16 v[168:171], a[84:87], a[28:31], v[168:171]
v_mfma_f32_16x16x32_bf16 v[176:179], a[84:87], a[32:35], v[176:179]
v_mfma_f32_16x16x32_bf16 v[176:179], a[80:83], a[12:15], v[176:179]
s_add_u32 m0, s16, 0x9800
v_mfma_f32_16x16x32_bf16 v[180:183], a[88:91], a[12:15], v[180:183]
buffer_load_dwordx4 v22, s[44:47], s23 offen lds
v_mfma_f32_16x16x32_bf16 v[180:183], a[92:95], a[32:35], v[180:183]
ds_read_b64_tr_b16 a[80:81], v14 offset:8192
v_mfma_f32_16x16x32_bf16 v[172:175], a[92:95], a[28:31], v[172:175]
ds_read_b64_tr_b16 a[82:83], v14 offset:8448
v_mfma_f32_16x16x32_bf16 v[172:175], a[88:91], a[8:11], v[172:175]
ds_read_b64_tr_b16 a[84:85], v14 offset:10240
v_mfma_f32_16x16x32_bf16 v[164:167], a[88:91], a[4:7], v[164:167]
ds_read_b64_tr_b16 a[86:87], v14 offset:10496
v_mfma_f32_16x16x32_bf16 v[164:167], a[92:95], a[24:27], v[164:167]
s_add_u32 m0, s16, 0x9c00
v_mfma_f32_16x16x32_bf16 v[156:159], a[92:95], a[20:23], v[156:159]
buffer_load_dwordx4 v23, s[44:47], s23 offen lds
v_mfma_f32_16x16x32_bf16 v[156:159], a[88:91], a[0:3], v[156:159]
s_waitcnt lgkmcnt(4)
v_add_u32 v22, 0x80, v22
v_add_u32 v23, 0x80, v23
v_mfma_f32_16x16x32_bf16 v[184:187], a[96:99], a[0:3], v[184:187]
ds_read_b64_tr_b16 a[88:89], v15 offset:8192
v_mfma_f32_16x16x32_bf16 v[184:187], a[100:103], a[20:23], v[184:187]
ds_read_b64_tr_b16 a[90:91], v15 offset:8448
v_mfma_f32_16x16x32_bf16 v[192:195], a[100:103], a[24:27], v[192:195]
ds_read_b64_tr_b16 a[92:93], v15 offset:10240
v_mfma_f32_16x16x32_bf16 v[192:195], a[96:99], a[4:7], v[192:195]
ds_read_b64_tr_b16 a[94:95], v15 offset:10496
s_add_u32 s8, s28, 0x9400
v_mfma_f32_16x16x32_bf16 v[200:203], a[96:99], a[8:11], v[200:203]
buffer_store_dwordx4 a[116:119], v16, s[88:91], s8 offen sc1
v_mfma_f32_16x16x32_bf16 v[200:203], a[100:103], a[28:31], v[200:203]
v_add_u32 v12, 0x8000, v12
v_add_u32 v13, 0x8000, v13
v_mfma_f32_16x16x32_bf16 v[208:211], a[100:103], a[32:35], v[208:211]
v_add_u32 v14, 0x8000, v14
v_add_u32 v15, 0x8000, v15
v_mfma_f32_16x16x32_bf16 v[208:211], a[96:99], a[12:15], v[208:211]
v_add_u32 v10, 0x8000, v10
v_add_u32 v11, 0x8000, v11
v_mfma_f32_16x16x32_bf16 v[248:251], a[96:99], a[16:19], v[248:251]
v_mfma_f32_16x16x32_bf16 v[248:251], a[100:103], a[36:39], v[248:251]
v_mfma_f32_16x16x32_bf16 v[212:215], a[104:107], a[12:15], v[212:215]
s_waitcnt vmcnt(29) lgkmcnt(0)
v_mfma_f32_16x16x32_bf16 v[212:215], a[108:111], a[32:35], v[212:215]
s_barrier
s_add_u32 m0, s17, 0x8000
v_mfma_f32_16x16x32_bf16 v[204:207], a[108:111], a[28:31], v[204:207]
buffer_load_dwordx4 v5, s[52:55], 0 offen lds
v_mfma_f32_16x16x32_bf16 v[204:207], a[104:107], a[8:11], v[204:207]
ds_read_b64_tr_b16 a[96:97], v12 offset:0
v_mfma_f32_16x16x32_bf16 v[196:199], a[104:107], a[4:7], v[196:199]
ds_read_b64_tr_b16 a[98:99], v12 offset:1024
v_mfma_f32_16x16x32_bf16 v[196:199], a[108:111], a[24:27], v[196:199]
ds_read_b64_tr_b16 a[100:101], v12 offset:8192
s_waitcnt lgkmcnt(3)
v_mfma_f32_16x16x32_bf16 v[188:191], a[108:111], a[20:23], v[188:191]
ds_read_b64_tr_b16 a[102:103], v12 offset:9216
s_add_u32 m0, s17, 0x8400
v_mfma_f32_16x16x32_bf16 v[188:191], a[104:107], a[0:3], v[188:191]
buffer_load_dwordx4 v5, s[52:55], s13 offen lds
v_mfma_f32_16x16x32_bf16 v[216:219], a[0:3], a[80:83], v[216:219]
ds_read_b64_tr_b16 a[104:105], v13 offset:0
v_mfma_f32_16x16x32_bf16 v[216:219], a[20:23], a[84:87], v[216:219]
ds_read_b64_tr_b16 a[106:107], v13 offset:1024
v_mfma_f32_16x16x32_bf16 v[224:227], a[24:27], a[84:87], v[224:227]
ds_read_b64_tr_b16 a[108:109], v13 offset:8192
v_mfma_f32_16x16x32_bf16 v[224:227], a[4:7], a[80:83], v[224:227]
ds_read_b64_tr_b16 a[110:111], v13 offset:9216
v_mfma_f32_16x16x32_bf16 v[232:235], a[8:11], a[80:83], v[232:235]
s_add_u32 m0, s17, 0x8800
v_mfma_f32_16x16x32_bf16 v[232:235], a[28:31], a[84:87], v[232:235]
buffer_load_dwordx4 v6, s[52:55], 0 offen lds
v_mfma_f32_16x16x32_bf16 v[240:243], a[32:35], a[84:87], v[240:243]
v_mfma_f32_16x16x32_bf16 v[240:243], a[12:15], a[80:83], v[240:243]
v_mfma_f32_16x16x32_bf16 v[252:255], a[16:19], a[80:83], v[252:255]
v_mfma_f32_16x16x32_bf16 v[252:255], a[36:39], a[84:87], v[252:255]
v_mfma_f32_16x16x32_bf16 v[244:247], a[12:15], a[88:91], v[244:247]
ds_read_b64_tr_b16 a[80:81], v12 offset:256
s_add_u32 m0, s17, 0x8c00
v_mfma_f32_16x16x32_bf16 v[244:247], a[32:35], a[92:95], v[244:247]
buffer_load_dwordx4 v6, s[52:55], s13 offen lds
v_mfma_f32_16x16x32_bf16 v[236:239], a[28:31], a[92:95], v[236:239]
ds_read_b64_tr_b16 a[82:83], v12 offset:1280
v_mfma_f32_16x16x32_bf16 v[236:239], a[8:11], a[88:91], v[236:239]
ds_read_b64_tr_b16 a[84:85], v12 offset:8448
v_mfma_f32_16x16x32_bf16 v[228:231], a[4:7], a[88:91], v[228:231]
ds_read_b64_tr_b16 a[86:87], v12 offset:9472
v_mfma_f32_16x16x32_bf16 v[228:231], a[24:27], a[92:95], v[228:231]
s_add_u32 s8, s28, 0x5800
v_mfma_f32_16x16x32_bf16 v[220:223], a[20:23], a[92:95], v[220:223]
buffer_store_dwordx4 a[124:127], v16, s[88:91], s8 offen sc1
v_mfma_f32_16x16x32_bf16 v[220:223], a[0:3], a[88:91], v[220:223]
s_waitcnt lgkmcnt(4)
L_S17:
v_mfma_f32_16x16x32_bf16 v[24:27], a[96:99], a[40:43], v[24:27]
ds_read_b64_tr_b16 a[88:89], v13 offset:256
s_waitcnt vmcnt(25)
v_mfma_f32_16x16x32_bf16 v[24:27], a[100:103], a[60:63], v[24:27]
ds_read_b64_tr_b16 a[90:91], v13 offset:1280
v_mfma_f32_16x16x32_bf16 v[32:35], a[100:103], a[64:67], v[32:35]
ds_read_b64_tr_b16 a[92:93], v13 offset:8448
v_mfma_f32_16x16x32_bf16 v[32:35], a[96:99], a[44:47], v[32:35]
ds_read_b64_tr_b16 a[94:95], v13 offset:9472
s_add_u32 m0, s18, 0xc000
v_mfma_f32_16x16x32_bf16 v[40:43], a[96:99], a[48:51], v[40:43]
buffer_load_dwordx4 v7, s[68:71], 0 offen lds
v_mfma_f32_16x16x32_bf16 v[40:43], a[100:103], a[68:71], v[40:43]
ds_read_b128 a[0:3], v8 offset:0
v_mfma_f32_16x16x32_bf16 v[48:51], a[100:103], a[72:75], v[48:51]
ds_read_b128 a[20:23], v9 offset:0
v_mfma_f32_16x16x32_bf16 v[48:51], a[96:99], a[52:55], v[48:51]
ds_read_b128 a[4:7], v8 offset:2048
v_mfma_f32_16x16x32_bf16 v[52:55], a[104:107], a[52:55], v[52:55]
ds_read_b64_tr_b16 a[96:97], v12 offset:512
v_mfma_f32_16x16x32_bf16 v[52:55], a[108:111], a[72:75], v[52:55]
ds_read_b64_tr_b16 a[98:99], v12 offset:1536
s_add_u32 m0, s18, 0xd000
v_mfma_f32_16x16x32_bf16 v[44:47], a[108:111], a[68:71], v[44:47]
buffer_load_dwordx4 v7, s[68:71], s25 offen lds
v_mfma_f32_16x16x32_bf16 v[44:47], a[104:107], a[48:51], v[44:47]
ds_read_b64_tr_b16 a[100:101], v12 offset:8704
v_mfma_f32_16x16x32_bf16 v[36:39], a[104:107], a[44:47], v[36:39]
ds_read_b64_tr_b16 a[102:103], v12 offset:9728
v_mfma_f32_16x16x32_bf16 v[36:39], a[108:111], a[64:67], v[36:39]
ds_read_b128 a[24:27], v9 offset:2048
s_waitcnt lgkmcnt(8)
v_mfma_f32_16x16x32_bf16 v[28:31], a[108:111], a[60:63], v[28:31]
ds_read_b128 a[8:11], v8 offset:4096
s_add_u32 m0, s18, 0xe000
v_mfma_f32_16x16x32_bf16 v[28:31], a[104:107], a[40:43], v[28:31]
buffer_load_dwordx4 v7, s[68:71], s26 offen lds
v_mfma_f32_16x16x32_bf16 v[56:59], a[80:83], a[40:43], v[56:59]
ds_read_b64_tr_b16 a[104:105], v13 offset:512
v_mfma_f32_16x16x32_bf16 v[56:59], a[84:87], a[60:63], v[56:59]
ds_read_b64_tr_b16 a[106:107], v13 offset:1536
v_mfma_f32_16x16x32_bf16 v[64:67], a[84:87], a[64:67], v[64:67]
ds_read_b64_tr_b16 a[108:109], v13 offset:8704
v_mfma_f32_16x16x32_bf16 v[64:67], a[80:83], a[44:47], v[64:67]
ds_read_b64_tr_b16 a[110:111], v13 offset:9728
v_mfma_f32_16x16x32_bf16 v[72:75], a[80:83], a[48:51], v[72:75]
ds_read_b128 a[28:31], v9 offset:4096
s_add_u32 m0, s18, 0xf000
v_mfma_f32_16x16x32_bf16 v[72:75], a[84:87], a[68:71], v[72:75]
buffer_load_dwordx4 v4, s[44:47], s24 offen lds
v_mfma_f32_16x16x32_bf16 v[80:83], a[84:87], a[72:75], v[80:83]
ds_read_b128 a[12:15], v8 offset:6144
v_add_u32 v5, 0x80000, v5
v_mfma_f32_16x16x32_bf16 v[80:83], a[80:83], a[52:55], v[80:83]
ds_read_b128 a[32:35], v9 offset:6144
v_add_u32 v6, 0x80000, v6
v_mfma_f32_16x16x32_bf16 v[84:87], a[88:91], a[52:55], v[84:87]
ds_read_b64_tr_b16 a[80:81], v12 offset:768
v_add_u32 v7, 0x60000, v7
v_mfma_f32_16x16x32_bf16 v[84:87], a[92:95], a[72:75], v[84:87]
ds_read_b64_tr_b16 a[82:83], v12 offset:1792
v_add_u32 v4, 0x80, v4
v_mfma_f32_16x16x32_bf16 v[76:79], a[92:95], a[68:71], v[76:79]
ds_read_b64_tr_b16 a[84:85], v12 offset:8960
s_add_u32 s8, s28, 0x9800
v_mfma_f32_16x16x32_bf16 v[76:79], a[88:91], a[48:51], v[76:79]
buffer_store_dwordx4 a[232:235], v16, s[88:91], s8 offen sc1
v_mfma_f32_16x16x32_bf16 v[68:71], a[88:91], a[44:47], v[68:71]
ds_read_b64_tr_b16 a[86:87], v12 offset:9984
v_mfma_f32_16x16x32_bf16 v[68:71], a[92:95], a[64:67], v[68:71]
ds_read_b128 a[56:59], v10
v_mfma_f32_16x16x32_bf16 v[60:63], a[92:95], a[60:63], v[60:63]
ds_read_b128 a[76:79], v11
v_mfma_f32_16x16x32_bf16 v[60:63], a[88:91], a[40:43], v[60:63]
s_waitcnt lgkmcnt(6)
s_waitcnt lgkmcnt(9)
v_mfma_f32_16x16x32_bf16 v[88:91], a[96:99], a[40:43], v[88:91]
ds_read_b64_tr_b16 a[88:89], v13 offset:768
s_add_u32 m0, s16, 0x0
v_mfma_f32_16x16x32_bf16 v[88:91], a[100:103], a[60:63], v[88:91]
buffer_load_dwordx4 v22, s[44:47], s20 offen lds
v_mfma_f32_16x16x32_bf16 v[96:99], a[100:103], a[64:67], v[96:99]
ds_read_b64_tr_b16 a[90:91], v13 offset:1792
v_mfma_f32_16x16x32_bf16 v[96:99], a[96:99], a[44:47], v[96:99]
ds_read_b64_tr_b16 a[92:93], v13 offset:8960
v_mfma_f32_16x16x32_bf16 v[104:107], a[96:99], a[48:51], v[104:107]
ds_read_b64_tr_b16 a[94:95], v13 offset:9984
v_mfma_f32_16x16x32_bf16 v[104:107], a[100:103], a[68:71], v[104:107]
s_add_u32 m0, s16, 0x400
v_mfma_f32_16x16x32_bf16 v[112:115], a[100:103], a[72:75], v[112:115]
buffer_load_dwordx4 v23, s[44:47], s20 offen lds
v_mfma_f32_16x16x32_bf16 v[112:115], a[96:99], a[52:55], v[112:115]
v_mfma_f32_16x16x32_bf16 v[116:119], a[104:107], a[52:55], v[116:119]
ds_read_b64_tr_b16 a[96:97], v14 offset:0
v_mfma_f32_16x16x32_bf16 v[116:119], a[108:111], a[72:75], v[116:119]
ds_read_b64_tr_b16 a[98:99], v14 offset:256
v_mfma_f32_16x16x32_bf16 v[108:111], a[108:111], a[68:71], v[108:111]
ds_read_b64_tr_b16 a[100:101], v14 offset:2048
v_mfma_f32_16x16x32_bf16 v[108:111], a[104:107], a[48:51], v[108:111]
ds_read_b64_tr_b16 a[102:103], v14 offset:2304
s_add_u32 m0, s16, 0x800
v_mfma_f32_16x16x32_bf16 v[100:103], a[104:107], a[44:47], v[100:103]
buffer_load_dwordx4 v22, s[44:47], s21 offen lds
v_mfma_f32_16x16x32_bf16 v[100:103], a[108:111], a[64:67], v[100:103]
v_mfma_f32_16x16x32_bf16 v[92:95], a[108:111], a[60:63], v[92:95]
v_mfma_f32_16x16x32_bf16 v[92:95], a[104:107], a[40:43], v[92:95]
s_waitcnt lgkmcnt(4)
v_mfma_f32_16x16x32_bf16 v[120:123], a[80:83], a[40:43], v[120:123]
ds_read_b64_tr_b16 a[104:105], v15 offset:0
v_mfma_f32_16x16x32_bf16 v[120:123], a[84:87], a[60:63], v[120:123]
ds_read_b64_tr_b16 a[106:107], v15 offset:256
s_add_u32 m0, s16, 0xc00
v_mfma_f32_16x16x32_bf16 v[128:131], a[84:87], a[64:67], v[128:131]
buffer_load_dwordx4 v23, s[44:47], s21 offen lds
v_mfma_f32_16x16x32_bf16 v[128:131], a[80:83], a[44:47], v[128:131]
ds_read_b64_tr_b16 a[108:109], v15 offset:2048
v_mfma_f32_16x16x32_bf16 v[136:139], a[80:83], a[48:51], v[136:139]
ds_read_b64_tr_b16 a[110:111], v15 offset:2304
v_mfma_f32_16x16x32_bf16 v[136:139], a[84:87], a[68:71], v[136:139]
v_mfma_f32_16x16x32_bf16 v[144:147], a[84:87], a[72:75], v[144:147]
s_add_u32 s8, s28, 0x5c00
v_mfma_f32_16x16x32_bf16 v[144:147], a[80:83], a[52:55], v[144:147]
buffer_store_dwordx4 a[240:243], v16, s[88:91], s8 offen sc1
v_mfma_f32_16x16x32_bf16 v[148:151], a[88:91], a[52:55], v[148:151]
ds_read_b64_tr_b16 a[80:81], v14 offset:4096
v_mfma_f32_16x16x32_bf16 v[148:151], a[92:95], a[72:75], v[148:151]
ds_read_b64_tr_b16 a[82:83], v14 offset:4352
v_mfma_f32_16x16x32_bf16 v[140:143], a[92:95], a[68:71], v[140:143]
ds_read_b64_tr_b16 a[84:85], v14 offset:6144
v_mfma_f32_16x16x32_bf16 v[140:143], a[88:91], a[48:51], v[140:143]
ds_read_b64_tr_b16 a[86:87], v14 offset:6400
v_mfma_f32_16x16x32_bf16 v[132:135], a[88:91], a[44:47], v[132:135]
s_add_u32 m0, s16, 0x1000
v_mfma_f32_16x16x32_bf16 v[132:135], a[92:95], a[64:67], v[132:135]
buffer_load_dwordx4 v22, s[44:47], s22 offen lds
v_mfma_f32_16x16x32_bf16 v[124:127], a[92:95], a[60:63], v[124:127]
L_padA9:
s_cmp_eq_u32 s95, 1
s_cbranch_scc1 L_padA13
v_mfma_f32_16x16x32_bf16 v[124:127], a[88:91], a[40:43], v[124:127]
s_waitcnt lgkmcnt(4)
v_mfma_f32_16x16x32_bf16 v[152:155], a[96:99], a[40:43], v[152:155]
ds_read_b64_tr_b16 a[88:89], v15 offset:4096
v_mfma_f32_16x16x32_bf16 v[152:155], a[100:103], a[60:63], v[152:155]
ds_read_b64_tr_b16 a[90:91], v15 offset:4352
v_mfma_f32_16x16x32_bf16 v[160:163], a[100:103], a[64:67], v[160:163]
ds_read_b64_tr_b16 a[92:93], v15 offset:6144
s_add_u32 m0, s16, 0x1400
v_mfma_f32_16x16x32_bf16 v[160:163], a[96:99], a[44:47], v[160:163]
buffer_load_dwordx4 v23, s[44:47], s22 offen lds
v_mfma_f32_16x16x32_bf16 v[168:171], a[96:99], a[48:51], v[168:171]
ds_read_b64_tr_b16 a[94:95], v15 offset:6400
v_mfma_f32_16x16x32_bf16 v[168:171], a[100:103], a[68:71], v[168:171]
v_mfma_f32_16x16x32_bf16 v[176:179], a[100:103], a[72:75], v[176:179]
v_mfma_f32_16x16x32_bf16 v[176:179], a[96:99], a[52:55], v[176:179]
s_add_u32 m0, s16, 0x1800
v_mfma_f32_16x16x32_bf16 v[180:183], a[104:107], a[52:55], v[180:183]
buffer_load_dwordx4 v22, s[44:47], s23 offen lds
v_mfma_f32_16x16x32_bf16 v[180:183], a[108:111], a[72:75], v[180:183]
ds_read_b64_tr_b16 a[96:97], v14 offset:8192
v_mfma_f32_16x16x32_bf16 v[172:175], a[108:111], a[68:71], v[172:175]
ds_read_b64_tr_b16 a[98:99], v14 offset:8448
v_mfma_f32_16x16x32_bf16 v[172:175], a[104:107], a[48:51], v[172:175]
ds_read_b64_tr_b16 a[100:101], v14 offset:10240
v_mfma_f32_16x16x32_bf16 v[164:167], a[104:107], a[44:47], v[164:167]
ds_read_b64_tr_b16 a[102:103], v14 offset:10496
v_mfma_f32_16x16x32_bf16 v[164:167], a[108:111], a[64:67], v[164:167]
s_add_u32 m0, s16, 0x1c00
v_mfma_f32_16x16x32_bf16 v[156:159], a[108:111], a[60:63], v[156:159]
buffer_load_dwordx4 v23, s[44:47], s23 offen lds
v_mfma_f32_16x16x32_bf16 v[156:159], a[104:107], a[40:43], v[156:159]
s_waitcnt lgkmcnt(4)
v_add_u32 v22, 0x80, v22
v_add_u32 v23, 0x80, v23
v_mfma_f32_16x16x32_bf16 v[184:187], a[80:83], a[40:43], v[184:187]
ds_read_b64_tr_b16 a[104:105], v15 offset:8192
v_mfma_f32_16x16x32_bf16 v[184:187], a[84:87], a[60:63], v[184:187]
ds_read_b64_tr_b16 a[106:107], v15 offset:8448
v_mfma_f32_16x16x32_bf16 v[192:195], a[84:87], a[64:67], v[192:195]
ds_read_b64_tr_b16 a[108:109], v15 offset:10240
v_mfma_f32_16x16x32_bf16 v[192:195], a[80:83], a[44:47], v[192:195]
ds_read_b64_tr_b16 a[110:111], v15 offset:10496
s_add_u32 s8, s28, 0x9c00
v_mfma_f32_16x16x32_bf16 v[200:203], a[80:83], a[48:51], v[200:203]
buffer_store_dwordx4 a[248:251], v16, s[88:91], s8 offen sc1
v_mfma_f32_16x16x32_bf16 v[200:203], a[84:87], a[68:71], v[200:203]
v_add_u32 v12, 0xffff0000, v12
v_add_u32 v13, 0xffff0000, v13
v_mfma_f32_16x16x32_bf16 v[208:211], a[84:87], a[72:75], v[208:211]
v_add_u32 v14, 0xffff0000, v14
v_add_u32 v15, 0xffff0000, v15
v_mfma_f32_16x16x32_bf16 v[208:211], a[80:83], a[52:55], v[208:211]
v_add_u32 v10, 0xffff0000, v10
v_add_u32 v11, 0xffff0000, v11
v_mfma_f32_16x16x32_bf16 v[248:251], a[80:83], a[56:59], v[248:251]
v_mfma_f32_16x16x32_bf16 v[248:251], a[84:87], a[76:79], v[248:251]
v_mfma_f32_16x16x32_bf16 v[212:215], a[88:91], a[52:55], v[212:215]
s_waitcnt vmcnt(30) lgkmcnt(0)
v_mfma_f32_16x16x32_bf16 v[212:215], a[92:95], a[72:75], v[212:215]
s_barrier
s_add_u32 m0, s17, 0x10000
v_mfma_f32_16x16x32_bf16 v[204:207], a[92:95], a[68:71], v[204:207]
buffer_load_dwordx4 v5, s[52:55], 0 offen lds
v_mfma_f32_16x16x32_bf16 v[204:207], a[88:91], a[48:51], v[204:207]
ds_read_b64_tr_b16 a[80:81], v12 offset:0
v_mfma_f32_16x16x32_bf16 v[196:199], a[88:91], a[44:47], v[196:199]
ds_read_b64_tr_b16 a[82:83], v12 offset:1024
v_mfma_f32_16x16x32_bf16 v[196:199], a[92:95], a[64:67], v[196:199]
ds_read_b64_tr_b16 a[84:85], v12 offset:8192
s_waitcnt lgkmcnt(3)
v_mfma_f32_16x16x32_bf16 v[188:191], a[92:95], a[60:63], v[188:191]
ds_read_b64_tr_b16 a[86:87], v12 offset:9216
s_add_u32 m0, s17, 0x10400
v_mfma_f32_16x16x32_bf16 v[188:191], a[88:91], a[40:43], v[188:191]
buffer_load_dwordx4 v5, s[52:55], s13 offen lds
v_mfma_f32_16x16x32_bf16 v[216:219], a[40:43], a[96:99], v[216:219]
ds_read_b64_tr_b16 a[88:89], v13 offset:0
v_mfma_f32_16x16x32_bf16 v[216:219], a[60:63], a[100:103], v[216:219]
ds_read_b64_tr_b16 a[90:91], v13 offset:1024
v_mfma_f32_16x16x32_bf16 v[224:227], a[64:67], a[100:103], v[224:227]
ds_read_b64_tr_b16 a[92:93], v13 offset:8192
v_mfma_f32_16x16x32_bf16 v[224:227], a[44:47], a[96:99], v[224:227]
ds_read_b64_tr_b16 a[94:95], v13 offset:9216
v_mfma_f32_16x16x32_bf16 v[232:235], a[48:51], a[96:99], v[232:235]
s_add_u32 m0, s17, 0x10800
v_mfma_f32_16x16x32_bf16 v[232:235], a[68:71], a[100:103], v[232:235]
buffer_load_dwordx4 v6, s[52:55], 0 offen lds
v_mfma_f32_16x16x32_bf16 v[240:243], a[72:75], a[100:103], v[240:243]
v_mfma_f32_16x16x32_bf16 v[240:243], a[52:55], a[96:99], v[240:243]
v_mfma_f32_16x16x32_bf16 v[252:255], a[56:59], a[96:99], v[252:255]
v_mfma_f32_16x16x32_bf16 v[252:255], a[76:79], a[100:103], v[252:255]
v_mfma_f32_16x16x32_bf16 v[244:247], a[52:55], a[104:107], v[244:247]
ds_read_b64_tr_b16 a[96:97], v12 offset:256
s_add_u32 m0, s17, 0x10c00
v_mfma_f32_16x16x32_bf16 v[244:247], a[72:75], a[108:111], v[244:247]
buffer_load_dwordx4 v6, s[52:55], s13 offen lds
v_mfma_f32_16x16x32_bf16 v[236:239], a[68:71], a[108:111], v[236:239]
ds_read_b64_tr_b16 a[98:99], v12 offset:1280
v_mfma_f32_16x16x32_bf16 v[236:239], a[48:51], a[104:107], v[236:239]
ds_read_b64_tr_b16 a[100:101], v12 offset:8448
v_mfma_f32_16x16x32_bf16 v[228:231], a[44:47], a[104:107], v[228:231]
ds_read_b64_tr_b16 a[102:103], v12 offset:9472
v_mfma_f32_16x16x32_bf16 v[228:231], a[64:67], a[108:111], v[228:231]
v_mfma_f32_16x16x32_bf16 v[220:223], a[60:63], a[108:111], v[220:223]
buffer_load_dwordx4 a[128:131], v16, s[44:47], s100 offen offset:0
v_mfma_f32_16x16x32_bf16 v[220:223], a[40:43], a[104:107], v[220:223]
s_waitcnt lgkmcnt(4)
L_S18:
v_mfma_f32_16x16x32_bf16 v[24:27], a[80:83], a[0:3], v[24:27]
ds_read_b64_tr_b16 a[104:105], v13 offset:256
s_waitcnt vmcnt(26)
v_mfma_f32_16x16x32_bf16 v[24:27], a[84:87], a[20:23], v[24:27]
ds_read_b64_tr_b16 a[106:107], v13 offset:1280
v_mfma_f32_16x16x32_bf16 v[32:35], a[84:87], a[24:27], v[32:35]
ds_read_b64_tr_b16 a[108:109], v13 offset:8448
v_mfma_f32_16x16x32_bf16 v[32:35], a[80:83], a[4:7], v[32:35]
ds_read_b64_tr_b16 a[110:111], v13 offset:9472
s_add_u32 m0, s18, 0x14000
v_mfma_f32_16x16x32_bf16 v[40:43], a[80:83], a[8:11], v[40:43]
buffer_load_dwordx4 v7, s[68:71], 0 offen lds
v_mfma_f32_16x16x32_bf16 v[40:43], a[84:87], a[28:31], v[40:43]
ds_read_b128 a[40:43], v8 offset:32768
v_mfma_f32_16x16x32_bf16 v[48:51], a[84:87], a[32:35], v[48:51]
ds_read_b128 a[60:63], v9 offset:32768
v_mfma_f32_16x16x32_bf16 v[48:51], a[80:83], a[12:15], v[48:51]
ds_read_b128 a[44:47], v8 offset:34816
v_mfma_f32_16x16x32_bf16 v[52:55], a[88:91], a[12:15], v[52:55]
ds_read_b64_tr_b16 a[80:81], v12 offset:512
v_mfma_f32_16x16x32_bf16 v[52:55], a[92:95], a[32:35], v[52:55]
ds_read_b64_tr_b16 a[82:83], v12 offset:1536
s_add_u32 m0, s18, 0x15000
v_mfma_f32_16x16x32_bf16 v[44:47], a[92:95], a[28:31], v[44:47]
buffer_load_dwordx4 v7, s[68:71], s25 offen lds
v_mfma_f32_16x16x32_bf16 v[44:47], a[88:91], a[8:11], v[44:47]
ds_read_b64_tr_b16 a[84:85], v12 offset:8704
v_mfma_f32_16x16x32_bf16 v[36:39], a[88:91], a[4:7], v[36:39]
ds_read_b64_tr_b16 a[86:87], v12 offset:9728
v_mfma_f32_16x16x32_bf16 v[36:39], a[92:95], a[24:27], v[36:39]
ds_read_b128 a[64:67], v9 offset:34816
s_waitcnt lgkmcnt(8)
v_mfma_f32_16x16x32_bf16 v[28:31], a[92:95], a[20:23], v[28:31]
ds_read_b128 a[48:51], v8 offset:36864
s_add_u32 m0, s18, 0x16000
v_mfma_f32_16x16x32_bf16 v[28:31], a[88:91], a[0:3], v[28:31]
buffer_load_dwordx4 v7, s[68:71], s26 offen lds
v_mfma_f32_16x16x32_bf16 v[56:59], a[96:99], a[0:3], v[56:59]
ds_read_b64_tr_b16 a[88:89], v13 offset:512
v_mfma_f32_16x16x32_bf16 v[56:59], a[100:103], a[20:23], v[56:59]
ds_read_b64_tr_b16 a[90:91], v13 offset:1536
v_mfma_f32_16x16x32_bf16 v[64:67], a[100:103], a[24:27], v[64:67]
ds_read_b64_tr_b16 a[92:93], v13 offset:8704
v_mfma_f32_16x16x32_bf16 v[64:67], a[96:99], a[4:7], v[64:67]
ds_read_b64_tr_b16 a[94:95], v13 offset:9728
v_mfma_f32_16x16x32_bf16 v[72:75], a[96:99], a[8:11], v[72:75]
ds_read_b128 a[68:71], v9 offset:36864
s_add_u32 m0, s18, 0x17000
v_mfma_f32_16x16x32_bf16 v[72:75], a[100:103], a[28:31], v[72:75]
buffer_load_dwordx4 v4, s[44:47], s24 offen lds
v_mfma_f32_16x16x32_bf16 v[80:83], a[100:103], a[32:35], v[80:83]
ds_read_b128 a[52:55], v8 offset:38912
v_add_u32 v5, 0x80000, v5
v_mfma_f32_16x16x32_bf16 v[80:83], a[96:99], a[12:15], v[80:83]
ds_read_b128 a[72:75], v9 offset:38912
v_add_u32 v6, 0x80000, v6
v_mfma_f32_16x16x32_bf16 v[84:87], a[104:107], a[12:15], v[84:87]
ds_read_b64_tr_b16 a[96:97], v12 offset:768
v_add_u32 v7, 0x60000, v7
v_mfma_f32_16x16x32_bf16 v[84:87], a[108:111], a[32:35], v[84:87]
ds_read_b64_tr_b16 a[98:99], v12 offset:1792
v_add_u32 v4, 0x80, v4
v_mfma_f32_16x16x32_bf16 v[76:79], a[108:111], a[28:31], v[76:79]
ds_read_b64_tr_b16 a[100:101], v12 offset:8960
v_mfma_f32_16x16x32_bf16 v[76:79], a[104:107], a[8:11], v[76:79]
buffer_load_dwordx4 a[132:135], v16, s[44:47], s100 offen offset:1024
v_mfma_f32_16x16x32_bf16 v[68:71], a[104:107], a[4:7], v[68:71]
ds_read_b64_tr_b16 a[102:103], v12 offset:9984
v_mfma_f32_16x16x32_bf16 v[68:71], a[108:111], a[24:27], v[68:71]
ds_read_b128 a[16:19], v10
v_mfma_f32_16x16x32_bf16 v[60:63], a[108:111], a[20:23], v[60:63]
ds_read_b128 a[36:39], v11
v_mfma_f32_16x16x32_bf16 v[60:63], a[104:107], a[0:3], v[60:63]
s_waitcnt lgkmcnt(6)
s_waitcnt lgkmcnt(9)
v_mfma_f32_16x16x32_bf16 v[88:91], a[80:83], a[0:3], v[88:91]
ds_read_b64_tr_b16 a[104:105], v13 offset:768
s_add_u32 m0, s16, 0x8000
v_mfma_f32_16x16x32_bf16 v[88:91], a[84:87], a[20:23], v[88:91]
buffer_load_dwordx4 v22, s[44:47], s20 offen lds
v_mfma_f32_16x16x32_bf16 v[96:99], a[84:87], a[24:27], v[96:99]
ds_read_b64_tr_b16 a[106:107], v13 offset:1792
v_mfma_f32_16x16x32_bf16 v[96:99], a[80:83], a[4:7], v[96:99]
ds_read_b64_tr_b16 a[108:109], v13 offset:8960
v_mfma_f32_16x16x32_bf16 v[104:107], a[80:83], a[8:11], v[104:107]
ds_read_b64_tr_b16 a[110:111], v13 offset:9984
v_mfma_f32_16x16x32_bf16 v[104:107], a[84:87], a[28:31], v[104:107]
s_add_u32 m0, s16, 0x8400
v_mfma_f32_16x16x32_bf16 v[112:115], a[84:87], a[32:35], v[112:115]
buffer_load_dwordx4 v23, s[44:47], s20 offen lds
v_mfma_f32_16x16x32_bf16 v[112:115], a[80:83], a[12:15], v[112:115]
v_mfma_f32_16x16x32_bf16 v[116:119], a[88:91], a[12:15], v[116:119]
ds_read_b64_tr_b16 a[80:81], v14 offset:0
v_mfma_f32_16x16x32_bf16 v[116:119], a[92:95], a[32:35], v[116:119]
ds_read_b64_tr_b16 a[82:83], v14 offset:256
v_mfma_f32_16x16x32_bf16 v[108:111], a[92:95], a[28:31], v[108:111]
ds_read_b64_tr_b16 a[84:85], v14 offset:2048
v_mfma_f32_16x16x32_bf16 v[108:111], a[88:91], a[8:11], v[108:111]
ds_read_b64_tr_b16 a[86:87], v14 offset:2304
s_add_u32 m0, s16, 0x8800
v_mfma_f32_16x16x32_bf16 v[100:103], a[88:91], a[4:7], v[100:103]
buffer_load_dwordx4 v22, s[44:47], s21 offen lds
v_mfma_f32_16x16x32_bf16 v[100:103], a[92:95], a[24:27], v[100:103]
v_mfma_f32_16x16x32_bf16 v[92:95], a[92:95], a[20:23], v[92:95]
v_mfma_f32_16x16x32_bf16 v[92:95], a[88:91], a[0:3], v[92:95]
s_waitcnt lgkmcnt(4)
v_mfma_f32_16x16x32_bf16 v[120:123], a[96:99], a[0:3], v[120:123]
ds_read_b64_tr_b16 a[88:89], v15 offset:0
v_mfma_f32_16x16x32_bf16 v[120:123], a[100:103], a[20:23], v[120:123]
ds_read_b64_tr_b16 a[90:91], v15 offset:256
s_add_u32 m0, s16, 0x8c00
v_mfma_f32_16x16x32_bf16 v[128:131], a[100:103], a[24:27], v[128:131]
buffer_load_dwordx4 v23, s[44:47], s21 offen lds
v_mfma_f32_16x16x32_bf16 v[128:131], a[96:99], a[4:7], v[128:131]
ds_read_b64_tr_b16 a[92:93], v15 offset:2048
v_mfma_f32_16x16x32_bf16 v[136:139], a[96:99], a[8:11], v[136:139]
ds_read_b64_tr_b16 a[94:95], v15 offset:2304
v_mfma_f32_16x16x32_bf16 v[136:139], a[100:103], a[28:31], v[136:139]
v_mfma_f32_16x16x32_bf16 v[144:147], a[100:103], a[32:35], v[144:147]
v_mfma_f32_16x16x32_bf16 v[144:147], a[96:99], a[12:15], v[144:147]
buffer_load_dwordx4 a[136:139], v16, s[44:47], s100 offen offset:2048
v_mfma_f32_16x16x32_bf16 v[148:151], a[104:107], a[12:15], v[148:151]
ds_read_b64_tr_b16 a[96:97], v14 offset:4096
v_mfma_f32_16x16x32_bf16 v[148:151], a[108:111], a[32:35], v[148:151]
ds_read_b64_tr_b16 a[98:99], v14 offset:4352
v_mfma_f32_16x16x32_bf16 v[140:143], a[108:111], a[28:31], v[140:143]
ds_read_b64_tr_b16 a[100:101], v14 offset:6144
v_mfma_f32_16x16x32_bf16 v[140:143], a[104:107], a[8:11], v[140:143]
ds_read_b64_tr_b16 a[102:103], v14 offset:6400
v_mfma_f32_16x16x32_bf16 v[132:135], a[104:107], a[4:7], v[132:135]
s_add_u32 m0, s16, 0x9000
v_mfma_f32_16x16x32_bf16 v[132:135], a[108:111], a[24:27], v[132:135]
buffer_load_dwordx4 v22, s[44:47], s22 offen lds
v_mfma_f32_16x16x32_bf16 v[124:127], a[108:111], a[20:23], v[124:127]
v_mfma_f32_16x16x32_bf16 v[124:127], a[104:107], a[0:3], v[124:127]
s_waitcnt lgkmcnt(4)
v_mfma_f32_16x16x32_bf16 v[152:155], a[80:83], a[0:3], v[152:155]
ds_read_b64_tr_b16 a[104:105], v15 offset:4096
v_mfma_f32_16x16x32_bf16 v[152:155], a[84:87], a[20:23], v[152:155]
ds_read_b64_tr_b16 a[106:107], v15 offset:4352
v_mfma_f32_16x16x32_bf16 v[160:163], a[84:87], a[24:27], v[160:163]
ds_read_b64_tr_b16 a[108:109], v15 offset:6144
s_add_u32 m0, s16, 0x9400
v_mfma_f32_16x16x32_bf16 v[160:163], a[80:83], a[4:7], v[160:163]
buffer_load_dwordx4 v23, s[44:47], s22 offen lds
v_mfma_f32_16x16x32_bf16 v[168:171], a[80:83], a[8:11], v[168:171]
ds_read_b64_tr_b16 a[110:111], v15 offset:6400
v_mfma_f32_16x16x32_bf16 v[168:171], a[84:87], a[28:31], v[168:171]
v_mfma_f32_16x16x32_bf16 v[176:179], a[84:87], a[32:35], v[176:179]
v_mfma_f32_16x16x32_bf16 v[176:179], a[80:83], a[12:15], v[176:179]
s_add_u32 m0, s16, 0x9800
v_mfma_f32_16x16x32_bf16 v[180:183], a[88:91], a[12:15], v[180:183]
buffer_load_dwordx4 v22, s[44:47], s23 offen lds
v_mfma_f32_16x16x32_bf16 v[180:183], a[92:95], a[32:35], v[180:183]
ds_read_b64_tr_b16 a[80:81], v14 offset:8192
v_mfma_f32_16x16x32_bf16 v[172:175], a[92:95], a[28:31], v[172:175]
ds_read_b64_tr_b16 a[82:83], v14 offset:8448
v_mfma_f32_16x16x32_bf16 v[172:175], a[88:91], a[8:11], v[172:175]
ds_read_b64_tr_b16 a[84:85], v14 offset:10240
v_mfma_f32_16x16x32_bf16 v[164:167], a[88:91], a[4:7], v[164:167]
ds_read_b64_tr_b16 a[86:87], v14 offset:10496
v_mfma_f32_16x16x32_bf16 v[164:167], a[92:95], a[24:27], v[164:167]
s_add_u32 m0, s16, 0x9c00
v_mfma_f32_16x16x32_bf16 v[156:159], a[92:95], a[20:23], v[156:159]
buffer_load_dwordx4 v23, s[44:47], s23 offen lds
v_mfma_f32_16x16x32_bf16 v[156:159], a[88:91], a[0:3], v[156:159]
s_waitcnt lgkmcnt(4)
v_add_u32 v22, 0x80, v22
v_add_u32 v23, 0x80, v23
v_mfma_f32_16x16x32_bf16 v[184:187], a[96:99], a[0:3], v[184:187]
ds_read_b64_tr_b16 a[88:89], v15 offset:8192
v_mfma_f32_16x16x32_bf16 v[184:187], a[100:103], a[20:23], v[184:187]
ds_read_b64_tr_b16 a[90:91], v15 offset:8448
v_mfma_f32_16x16x32_bf16 v[192:195], a[100:103], a[24:27], v[192:195]
ds_read_b64_tr_b16 a[92:93], v15 offset:10240
v_mov_b32 v21, s1
v_mfma_f32_16x16x32_bf16 v[192:195], a[96:99], a[4:7], v[192:195]
ds_read_b64_tr_b16 a[94:95], v15 offset:10496
v_add_u32 v20, s0, v16
v_mfma_f32_16x16x32_bf16 v[200:203], a[96:99], a[8:11], v[200:203]
global_load_dword a120, v[20:21], off sc1
v_mfma_f32_16x16x32_bf16 v[200:203], a[100:103], a[28:31], v[200:203]
v_add_u32 v12, 0x8000, v12
v_add_u32 v13, 0x8000, v13
v_mfma_f32_16x16x32_bf16 v[208:211], a[100:103], a[32:35], v[208:211]
v_add_u32 v14, 0x8000, v14
v_add_u32 v15, 0x8000, v15
v_mfma_f32_16x16x32_bf16 v[208:211], a[96:99], a[12:15], v[208:211]
v_add_u32 v10, 0x8000, v10
v_add_u32 v11, 0x8000, v11
v_mfma_f32_16x16x32_bf16 v[248:251], a[96:99], a[16:19], v[248:251]
v_mfma_f32_16x16x32_bf16 v[248:251], a[100:103], a[36:39], v[248:251]
v_mfma_f32_16x16x32_bf16 v[212:215], a[104:107], a[12:15], v[212:215]
s_waitcnt vmcnt(20) lgkmcnt(0)
v_mfma_f32_16x16x32_bf16 v[212:215], a[108:111], a[32:35], v[212:215]
s_barrier
s_add_u32 m0, s17, 0x0
s_cmp_lg_u32 s4, 0
s_cbranch_scc1 L_sig_kv
v_mov_b32 v20, 1
s_mov_b64 exec, 1
buffer_atomic_add v20, off, s[84:87], s10 sc1
s_mov_b64 exec, -1
L_sig_kv:
v_mfma_f32_16x16x32_bf16 v[204:207], a[108:111], a[28:31], v[204:207]
buffer_load_dwordx4 v5, s[52:55], 0 offen lds
v_mfma_f32_16x16x32_bf16 v[204:207], a[104:107], a[8:11], v[204:207]
ds_read_b64_tr_b16 a[96:97], v12 offset:0
v_mfma_f32_16x16x32_bf16 v[196:199], a[104:107], a[4:7], v[196:199]
ds_read_b64_tr_b16 a[98:99], v12 offset:1024
v_mfma_f32_16x16x32_bf16 v[196:199], a[108:111], a[24:27], v[196:199]
ds_read_b64_tr_b16 a[100:101], v12 offset:8192
v_mfma_f32_16x16x32_bf16 v[188:191], a[108:111], a[20:23], v[188:191]
ds_read_b64_tr_b16 a[102:103], v12 offset:9216
v_mfma_f32_16x16x32_bf16 v[188:191], a[104:107], a[0:3], v[188:191]
s_add_u32 m0, s17, 0x400
s_waitcnt lgkmcnt(4)
v_mfma_f32_16x16x32_bf16 v[216:219], a[0:3], a[80:83], v[216:219]
buffer_load_dwordx4 v5, s[52:55], s13 offen lds
v_mfma_f32_16x16x32_bf16 v[216:219], a[20:23], a[84:87], v[216:219]
ds_read_b64_tr_b16 a[104:105], v13 offset:0
v_mfma_f32_16x16x32_bf16 v[224:227], a[24:27], a[84:87], v[224:227]
ds_read_b64_tr_b16 a[106:107], v13 offset:1024
v_mfma_f32_16x16x32_bf16 v[224:227], a[4:7], a[80:83], v[224:227]
ds_read_b64_tr_b16 a[108:109], v13 offset:8192
v_mfma_f32_16x16x32_bf16 v[232:235], a[8:11], a[80:83], v[232:235]
ds_read_b64_tr_b16 a[110:111], v13 offset:9216
v_mfma_f32_16x16x32_bf16 v[232:235], a[28:31], a[84:87], v[232:235]
s_add_u32 m0, s17, 0x800
v_mfma_f32_16x16x32_bf16 v[240:243], a[32:35], a[84:87], v[240:243]
buffer_load_dwordx4 v6, s[52:55], 0 offen lds
v_mfma_f32_16x16x32_bf16 v[240:243], a[12:15], a[80:83], v[240:243]
v_mfma_f32_16x16x32_bf16 v[252:255], a[16:19], a[80:83], v[252:255]
v_mfma_f32_16x16x32_bf16 v[252:255], a[36:39], a[84:87], v[252:255]
v_mfma_f32_16x16x32_bf16 v[244:247], a[12:15], a[88:91], v[244:247]
ds_read_b64_tr_b16 a[80:81], v12 offset:256
v_mfma_f32_16x16x32_bf16 v[244:247], a[32:35], a[92:95], v[244:247]
ds_read_b64_tr_b16 a[82:83], v12 offset:1280
s_add_u32 m0, s17, 0xc00
v_mfma_f32_16x16x32_bf16 v[236:239], a[28:31], a[92:95], v[236:239]
buffer_load_dwordx4 v6, s[52:55], s13 offen lds
v_mfma_f32_16x16x32_bf16 v[236:239], a[8:11], a[88:91], v[236:239]
ds_read_b64_tr_b16 a[84:85], v12 offset:8448
v_mfma_f32_16x16x32_bf16 v[228:231], a[4:7], a[88:91], v[228:231]
ds_read_b64_tr_b16 a[86:87], v12 offset:9472
v_mfma_f32_16x16x32_bf16 v[228:231], a[24:27], a[92:95], v[228:231]
v_mfma_f32_16x16x32_bf16 v[220:223], a[20:23], a[92:95], v[220:223]
v_mfma_f32_16x16x32_bf16 v[220:223], a[0:3], a[88:91], v[220:223]
s_add_u32 m0, s18, 0x4000
s_waitcnt lgkmcnt(4)
L_S19:
v_mfma_f32_16x16x32_bf16 v[24:27], a[96:99], a[40:43], v[24:27]
buffer_load_dwordx4 v7, s[68:71], 0 offen lds
v_mfma_f32_16x16x32_bf16 v[24:27], a[100:103], a[60:63], v[24:27]
ds_read_b64_tr_b16 a[88:89], v13 offset:256
s_waitcnt vmcnt(26)
v_mfma_f32_16x16x32_bf16 v[32:35], a[100:103], a[64:67], v[32:35]
ds_read_b64_tr_b16 a[90:91], v13 offset:1280
v_mfma_f32_16x16x32_bf16 v[32:35], a[96:99], a[44:47], v[32:35]
ds_read_b64_tr_b16 a[92:93], v13 offset:8448
v_mfma_f32_16x16x32_bf16 v[40:43], a[96:99], a[48:51], v[40:43]
ds_read_b64_tr_b16 a[94:95], v13 offset:9472
v_mfma_f32_16x16x32_bf16 v[40:43], a[100:103], a[68:71], v[40:43]
ds_read_b128 a[0:3], v8 offset:0
v_mfma_f32_16x16x32_bf16 v[48:51], a[100:103], a[72:75], v[48:51]
buffer_load_dwordx4 a[140:143], v16, s[44:47], s100 offen offset:3072
v_mfma_f32_16x16x32_bf16 v[48:51], a[96:99], a[52:55], v[48:51]
ds_read_b128 a[20:23], v9 offset:0
v_mfma_f32_16x16x32_bf16 v[52:55], a[104:107], a[52:55], v[52:55]
ds_read_b64_tr_b16 a[96:97], v12 offset:512
v_mfma_f32_16x16x32_bf16 v[52:55], a[108:111], a[72:75], v[52:55]
ds_read_b64_tr_b16 a[98:99], v12 offset:1536
v_mfma_f32_16x16x32_bf16 v[44:47], a[108:111], a[68:71], v[44:47]
ds_read_b64_tr_b16 a[100:101], v12 offset:8704
v_mfma_f32_16x16x32_bf16 v[44:47], a[104:107], a[48:51], v[44:47]
ds_read_b64_tr_b16 a[102:103], v12 offset:9728
s_add_u32 m0, s18, 0x5000
v_mfma_f32_16x16x32_bf16 v[36:39], a[104:107], a[44:47], v[36:39]
buffer_load_dwordx4 v7, s[68:71], s25 offen lds
v_mfma_f32_16x16x32_bf16 v[36:39], a[108:111], a[64:67], v[36:39]
ds_read_b128 a[4:7], v8 offset:2048
v_mfma_f32_16x16x32_bf16 v[28:31], a[108:111], a[60:63], v[28:31]
ds_read_b128 a[24:27], v9 offset:2048
v_mfma_f32_16x16x32_bf16 v[28:31], a[104:107], a[40:43], v[28:31]
ds_read_b128 a[8:11], v8 offset:4096
s_waitcnt lgkmcnt(9)
v_mfma_f32_16x16x32_bf16 v[56:59], a[80:83], a[40:43], v[56:59]
ds_read_b64_tr_b16 a[104:105], v13 offset:512
v_mfma_f32_16x16x32_bf16 v[56:59], a[84:87], a[60:63], v[56:59]
ds_read_b64_tr_b16 a[106:107], v13 offset:1536
s_add_u32 m0, s18, 0x6000
v_mfma_f32_16x16x32_bf16 v[64:67], a[84:87], a[64:67], v[64:67]
buffer_load_dwordx4 v7, s[68:71], s26 offen lds
v_mfma_f32_16x16x32_bf16 v[64:67], a[80:83], a[44:47], v[64:67]
ds_read_b64_tr_b16 a[108:109], v13 offset:8704
v_mfma_f32_16x16x32_bf16 v[72:75], a[80:83], a[48:51], v[72:75]
ds_read_b64_tr_b16 a[110:111], v13 offset:9728
v_mfma_f32_16x16x32_bf16 v[72:75], a[84:87], a[68:71], v[72:75]
ds_read_b128 a[28:31], v9 offset:4096
v_mfma_f32_16x16x32_bf16 v[80:83], a[84:87], a[72:75], v[80:83]
ds_read_b128 a[12:15], v8 offset:6144
v_mfma_f32_16x16x32_bf16 v[80:83], a[80:83], a[52:55], v[80:83]
ds_read_b128 a[32:35], v9 offset:6144
s_add_u32 m0, s18, 0x7000
v_mfma_f32_16x16x32_bf16 v[84:87], a[88:91], a[52:55], v[84:87]
buffer_load_dwordx4 v4, s[44:47], s24 offen lds
v_mfma_f32_16x16x32_bf16 v[84:87], a[92:95], a[72:75], v[84:87]
ds_read_b64_tr_b16 a[80:81], v12 offset:768
v_add_u32 v5, 0x80000, v5
v_mfma_f32_16x16x32_bf16 v[76:79], a[92:95], a[68:71], v[76:79]
ds_read_b64_tr_b16 a[82:83], v12 offset:1792
v_add_u32 v6, 0x80000, v6
v_mfma_f32_16x16x32_bf16 v[76:79], a[88:91], a[48:51], v[76:79]
ds_read_b64_tr_b16 a[84:85], v12 offset:8960
v_add_u32 v7, 0x60000, v7
v_mfma_f32_16x16x32_bf16 v[68:71], a[88:91], a[44:47], v[68:71]
ds_read_b64_tr_b16 a[86:87], v12 offset:9984
v_add_u32 v4, 0x80, v4
v_mfma_f32_16x16x32_bf16 v[68:71], a[92:95], a[64:67], v[68:71]
ds_read_b128 a[56:59], v10
s_add_u32 m0, s16, 0x0
s_waitcnt lgkmcnt(5)
v_mfma_f32_16x16x32_bf16 v[60:63], a[92:95], a[60:63], v[60:63]
buffer_load_dwordx4 v22, s[44:47], s20 offen lds
v_mfma_f32_16x16x32_bf16 v[60:63], a[88:91], a[40:43], v[60:63]
ds_read_b128 a[76:79], v11
s_waitcnt lgkmcnt(9)
v_mfma_f32_16x16x32_bf16 v[88:91], a[96:99], a[40:43], v[88:91]
ds_read_b64_tr_b16 a[88:89], v13 offset:768
v_mfma_f32_16x16x32_bf16 v[88:91], a[100:103], a[60:63], v[88:91]
ds_read_b64_tr_b16 a[90:91], v13 offset:1792
v_mfma_f32_16x16x32_bf16 v[96:99], a[100:103], a[64:67], v[96:99]
ds_read_b64_tr_b16 a[92:93], v13 offset:8960
v_mfma_f32_16x16x32_bf16 v[96:99], a[96:99], a[44:47], v[96:99]
ds_read_b64_tr_b16 a[94:95], v13 offset:9984
s_add_u32 m0, s16, 0x400
v_mfma_f32_16x16x32_bf16 v[104:107], a[96:99], a[48:51], v[104:107]
buffer_load_dwordx4 v23, s[44:47], s20 offen lds
v_mfma_f32_16x16x32_bf16 v[104:107], a[100:103], a[68:71], v[104:107]
v_mfma_f32_16x16x32_bf16 v[112:115], a[100:103], a[72:75], v[112:115]
v_mfma_f32_16x16x32_bf16 v[112:115], a[96:99], a[52:55], v[112:115]
v_mfma_f32_16x16x32_bf16 v[116:119], a[104:107], a[52:55], v[116:119]
ds_read_b64_tr_b16 a[96:97], v14 offset:0
v_mfma_f32_16x16x32_bf16 v[116:119], a[108:111], a[72:75], v[116:119]
ds_read_b64_tr_b16 a[98:99], v14 offset:256
v_mfma_f32_16x16x32_bf16 v[108:111], a[108:111], a[68:71], v[108:111]
buffer_load_dwordx4 a[144:147], v16, s[76:79], 0 offen offset:0
v_mfma_f32_16x16x32_bf16 v[108:111], a[104:107], a[48:51], v[108:111]
ds_read_b64_tr_b16 a[100:101], v14 offset:2048
v_mfma_f32_16x16x32_bf16 v[100:103], a[104:107], a[44:47], v[100:103]
ds_read_b64_tr_b16 a[102:103], v14 offset:2304
v_mfma_f32_16x16x32_bf16 v[100:103], a[108:111], a[64:67], v[100:103]
v_mfma_f32_16x16x32_bf16 v[92:95], a[108:111], a[60:63], v[92:95]
v_mfma_f32_16x16x32_bf16 v[92:95], a[104:107], a[40:43], v[92:95]
s_add_u32 m0, s16, 0x800
s_waitcnt lgkmcnt(4)
v_mfma_f32_16x16x32_bf16 v[120:123], a[80:83], a[40:43], v[120:123]
buffer_load_dwordx4 v22, s[44:47], s21 offen lds
v_mfma_f32_16x16x32_bf16 v[120:123], a[84:87], a[60:63], v[120:123]
ds_read_b64_tr_b16 a[104:105], v15 offset:0
v_mfma_f32_16x16x32_bf16 v[128:131], a[84:87], a[64:67], v[128:131]
ds_read_b64_tr_b16 a[106:107], v15 offset:256
v_mfma_f32_16x16x32_bf16 v[128:131], a[80:83], a[44:47], v[128:131]
ds_read_b64_tr_b16 a[108:109], v15 offset:2048
v_mfma_f32_16x16x32_bf16 v[136:139], a[80:83], a[48:51], v[136:139]
ds_read_b64_tr_b16 a[110:111], v15 offset:2304
v_mfma_f32_16x16x32_bf16 v[136:139], a[84:87], a[68:71], v[136:139]
s_add_u32 m0, s16, 0xc00
v_mfma_f32_16x16x32_bf16 v[144:147], a[84:87], a[72:75], v[144:147]
buffer_load_dwordx4 v23, s[44:47], s21 offen lds
v_mfma_f32_16x16x32_bf16 v[144:147], a[80:83], a[52:55], v[144:147]
v_mfma_f32_16x16x32_bf16 v[148:151], a[88:91], a[52:55], v[148:151]
ds_read_b64_tr_b16 a[80:81], v14 offset:4096
v_mfma_f32_16x16x32_bf16 v[148:151], a[92:95], a[72:75], v[148:151]
ds_read_b64_tr_b16 a[82:83], v14 offset:4352
v_mfma_f32_16x16x32_bf16 v[140:143], a[92:95], a[68:71], v[140:143]
ds_read_b64_tr_b16 a[84:85], v14 offset:6144
v_mfma_f32_16x16x32_bf16 v[140:143], a[88:91], a[48:51], v[140:143]
ds_read_b64_tr_b16 a[86:87], v14 offset:6400
s_add_u32 m0, s16, 0x1000
v_mfma_f32_16x16x32_bf16 v[132:135], a[88:91], a[44:47], v[132:135]
buffer_load_dwordx4 v22, s[44:47], s22 offen lds
v_mfma_f32_16x16x32_bf16 v[132:135], a[92:95], a[64:67], v[132:135]
v_mfma_f32_16x16x32_bf16 v[124:127], a[92:95], a[60:63], v[124:127]
v_mfma_f32_16x16x32_bf16 v[124:127], a[88:91], a[40:43], v[124:127]
s_waitcnt lgkmcnt(4)
v_mfma_f32_16x16x32_bf16 v[152:155], a[96:99], a[40:43], v[152:155]
ds_read_b64_tr_b16 a[88:89], v15 offset:4096
v_mfma_f32_16x16x32_bf16 v[152:155], a[100:103], a[60:63], v[152:155]
ds_read_b64_tr_b16 a[90:91], v15 offset:4352
s_add_u32 m0, s16, 0x1400
v_mfma_f32_16x16x32_bf16 v[160:163], a[100:103], a[64:67], v[160:163]
buffer_load_dwordx4 v23, s[44:47], s22 offen lds
v_mfma_f32_16x16x32_bf16 v[160:163], a[96:99], a[44:47], v[160:163]
ds_read_b64_tr_b16 a[92:93], v15 offset:6144
v_mfma_f32_16x16x32_bf16 v[168:171], a[96:99], a[48:51], v[168:171]
ds_read_b64_tr_b16 a[94:95], v15 offset:6400
v_mfma_f32_16x16x32_bf16 v[168:171], a[100:103], a[68:71], v[168:171]
v_mfma_f32_16x16x32_bf16 v[176:179], a[100:103], a[72:75], v[176:179]
v_mfma_f32_16x16x32_bf16 v[176:179], a[96:99], a[52:55], v[176:179]
s_add_u32 m0, s16, 0x1800
v_mfma_f32_16x16x32_bf16 v[180:183], a[104:107], a[52:55], v[180:183]
buffer_load_dwordx4 v22, s[44:47], s23 offen lds
v_mfma_f32_16x16x32_bf16 v[180:183], a[108:111], a[72:75], v[180:183]
ds_read_b64_tr_b16 a[96:97], v14 offset:8192
v_mfma_f32_16x16x32_bf16 v[172:175], a[108:111], a[68:71], v[172:175]
ds_read_b64_tr_b16 a[98:99], v14 offset:8448
v_mfma_f32_16x16x32_bf16 v[172:175], a[104:107], a[48:51], v[172:175]
ds_read_b64_tr_b16 a[100:101], v14 offset:10240
v_mfma_f32_16x16x32_bf16 v[164:167], a[104:107], a[44:47], v[164:167]
ds_read_b64_tr_b16 a[102:103], v14 offset:10496
v_mfma_f32_16x16x32_bf16 v[164:167], a[108:111], a[64:67], v[164:167]
s_add_u32 m0, s16, 0x1c00
v_mfma_f32_16x16x32_bf16 v[156:159], a[108:111], a[60:63], v[156:159]
buffer_load_dwordx4 v23, s[44:47], s23 offen lds
v_mfma_f32_16x16x32_bf16 v[156:159], a[104:107], a[40:43], v[156:159]
s_waitcnt lgkmcnt(4)
v_add_u32 v22, 0x80, v22
v_add_u32 v23, 0x80, v23
v_mfma_f32_16x16x32_bf16 v[184:187], a[80:83], a[40:43], v[184:187]
ds_read_b64_tr_b16 a[104:105], v15 offset:8192
L_padA10:
s_cmp_eq_u32 s95, 1
s_cbranch_scc1 L_hopA_ret
v_mfma_f32_16x16x32_bf16 v[184:187], a[84:87], a[60:63], v[184:187]
ds_read_b64_tr_b16 a[106:107], v15 offset:8448
v_mfma_f32_16x16x32_bf16 v[192:195], a[84:87], a[64:67], v[192:195]
ds_read_b64_tr_b16 a[108:109], v15 offset:10240
v_mfma_f32_16x16x32_bf16 v[192:195], a[80:83], a[44:47], v[192:195]
ds_read_b64_tr_b16 a[110:111], v15 offset:10496
v_add_u32 v12, 0x8000, v12
v_mfma_f32_16x16x32_bf16 v[200:203], a[80:83], a[48:51], v[200:203]
buffer_load_dwordx4 a[148:151], v16, s[76:79], 0 offen offset:1024
v_mfma_f32_16x16x32_bf16 v[200:203], a[84:87], a[68:71], v[200:203]
v_add_u32 v13, 0x8000, v13
v_add_u32 v14, 0x8000, v14
v_mfma_f32_16x16x32_bf16 v[208:211], a[84:87], a[72:75], v[208:211]
v_add_u32 v15, 0x8000, v15
v_add_u32 v10, 0x8000, v10
v_mfma_f32_16x16x32_bf16 v[208:211], a[80:83], a[52:55], v[208:211]
v_add_u32 v11, 0x8000, v11
v_mfma_f32_16x16x32_bf16 v[248:251], a[80:83], a[56:59], v[248:251]
v_mfma_f32_16x16x32_bf16 v[248:251], a[84:87], a[76:79], v[248:251]
v_mfma_f32_16x16x32_bf16 v[212:215], a[88:91], a[52:55], v[212:215]
s_waitcnt vmcnt(30) lgkmcnt(0)
v_mfma_f32_16x16x32_bf16 v[212:215], a[92:95], a[72:75], v[212:215]
s_barrier
s_add_u32 m0, s17, 0x8000
v_mfma_f32_16x16x32_bf16 v[204:207], a[92:95], a[68:71], v[204:207]
buffer_load_dwordx4 v5, s[52:55], 0 offen lds
v_mfma_f32_16x16x32_bf16 v[204:207], a[88:91], a[48:51], v[204:207]
ds_read_b64_tr_b16 a[80:81], v12 offset:0
v_mfma_f32_16x16x32_bf16 v[196:199], a[88:91], a[44:47], v[196:199]
ds_read_b64_tr_b16 a[82:83], v12 offset:1024
v_mfma_f32_16x16x32_bf16 v[196:199], a[92:95], a[64:67], v[196:199]
ds_read_b64_tr_b16 a[84:85], v12 offset:8192
v_mfma_f32_16x16x32_bf16 v[188:191], a[92:95], a[60:63], v[188:191]
ds_read_b64_tr_b16 a[86:87], v12 offset:9216
v_mfma_f32_16x16x32_bf16 v[188:191], a[88:91], a[40:43], v[188:191]
s_waitcnt lgkmcnt(4)
v_mfma_f32_16x16x32_bf16 v[216:219], a[40:43], a[96:99], v[216:219]
ds_read_b64_tr_b16 a[88:89], v13 offset:0
s_add_u32 m0, s17, 0x8400
v_mfma_f32_16x16x32_bf16 v[216:219], a[60:63], a[100:103], v[216:219]
buffer_load_dwordx4 v5, s[52:55], s13 offen lds
v_mfma_f32_16x16x32_bf16 v[224:227], a[64:67], a[100:103], v[224:227]
ds_read_b64_tr_b16 a[90:91], v13 offset:1024
v_mfma_f32_16x16x32_bf16 v[224:227], a[44:47], a[96:99], v[224:227]
ds_read_b64_tr_b16 a[92:93], v13 offset:8192
v_mfma_f32_16x16x32_bf16 v[232:235], a[48:51], a[96:99], v[232:235]
ds_read_b64_tr_b16 a[94:95], v13 offset:9216
v_mfma_f32_16x16x32_bf16 v[232:235], a[68:71], a[100:103], v[232:235]
v_mfma_f32_16x16x32_bf16 v[240:243], a[72:75], a[100:103], v[240:243]
v_mfma_f32_16x16x32_bf16 v[240:243], a[52:55], a[96:99], v[240:243]
s_add_u32 m0, s17, 0x8800
v_mfma_f32_16x16x32_bf16 v[252:255], a[56:59], a[96:99], v[252:255]
buffer_load_dwordx4 v6, s[52:55], 0 offen lds
v_mfma_f32_16x16x32_bf16 v[252:255], a[76:79], a[100:103], v[252:255]
v_mfma_f32_16x16x32_bf16 v[244:247], a[52:55], a[104:107], v[244:247]
ds_read_b64_tr_b16 a[96:97], v12 offset:256
v_mfma_f32_16x16x32_bf16 v[244:247], a[72:75], a[108:111], v[244:247]
ds_read_b64_tr_b16 a[98:99], v12 offset:1280
v_mfma_f32_16x16x32_bf16 v[236:239], a[68:71], a[108:111], v[236:239]
ds_read_b64_tr_b16 a[100:101], v12 offset:8448
v_mfma_f32_16x16x32_bf16 v[236:239], a[48:51], a[104:107], v[236:239]
ds_read_b64_tr_b16 a[102:103], v12 offset:9472
v_mfma_f32_16x16x32_bf16 v[228:231], a[44:47], a[104:107], v[228:231]
s_add_u32 m0, s17, 0x8c00
v_mfma_f32_16x16x32_bf16 v[228:231], a[64:67], a[108:111], v[228:231]
buffer_load_dwordx4 v6, s[52:55], s13 offen lds
v_mfma_f32_16x16x32_bf16 v[220:223], a[60:63], a[108:111], v[220:223]
v_mfma_f32_16x16x32_bf16 v[220:223], a[40:43], a[104:107], v[220:223]
s_waitcnt lgkmcnt(4)
L_S20:
v_mfma_f32_16x16x32_bf16 v[24:27], a[80:83], a[0:3], v[24:27]
ds_read_b64_tr_b16 a[104:105], v13 offset:256
s_waitcnt vmcnt(24)
v_mfma_f32_16x16x32_bf16 v[24:27], a[84:87], a[20:23], v[24:27]
ds_read_b64_tr_b16 a[106:107], v13 offset:1280
v_mfma_f32_16x16x32_bf16 v[32:35], a[84:87], a[24:27], v[32:35]
ds_read_b64_tr_b16 a[108:109], v13 offset:8448
v_mfma_f32_16x16x32_bf16 v[32:35], a[80:83], a[4:7], v[32:35]
ds_read_b64_tr_b16 a[110:111], v13 offset:9472
s_add_u32 m0, s18, 0xc000
v_mfma_f32_16x16x32_bf16 v[40:43], a[80:83], a[8:11], v[40:43]
buffer_load_dwordx4 v7, s[68:71], 0 offen lds
v_mfma_f32_16x16x32_bf16 v[40:43], a[84:87], a[28:31], v[40:43]
ds_read_b128 a[40:43], v8 offset:32768
v_mfma_f32_16x16x32_bf16 v[48:51], a[84:87], a[32:35], v[48:51]
ds_read_b128 a[60:63], v9 offset:32768
v_mfma_f32_16x16x32_bf16 v[48:51], a[80:83], a[12:15], v[48:51]
ds_read_b128 a[44:47], v8 offset:34816
v_mfma_f32_16x16x32_bf16 v[52:55], a[88:91], a[12:15], v[52:55]
ds_read_b64_tr_b16 a[80:81], v12 offset:512
v_mfma_f32_16x16x32_bf16 v[52:55], a[92:95], a[32:35], v[52:55]
ds_read_b64_tr_b16 a[82:83], v12 offset:1536
v_mfma_f32_16x16x32_bf16 v[44:47], a[92:95], a[28:31], v[44:47]
ds_read_b64_tr_b16 a[84:85], v12 offset:8704
s_add_u32 m0, s18, 0xd000
v_mfma_f32_16x16x32_bf16 v[44:47], a[88:91], a[8:11], v[44:47]
buffer_load_dwordx4 v7, s[68:71], s25 offen lds
v_mfma_f32_16x16x32_bf16 v[36:39], a[88:91], a[4:7], v[36:39]
ds_read_b64_tr_b16 a[86:87], v12 offset:9728
v_mfma_f32_16x16x32_bf16 v[36:39], a[92:95], a[24:27], v[36:39]
ds_read_b128 a[64:67], v9 offset:34816
v_mfma_f32_16x16x32_bf16 v[28:31], a[92:95], a[20:23], v[28:31]
ds_read_b128 a[48:51], v8 offset:36864
v_mfma_f32_16x16x32_bf16 v[28:31], a[88:91], a[0:3], v[28:31]
ds_read_b128 a[68:71], v9 offset:36864
s_waitcnt lgkmcnt(10)
v_mfma_f32_16x16x32_bf16 v[56:59], a[96:99], a[0:3], v[56:59]
ds_read_b64_tr_b16 a[88:89], v13 offset:512
v_mfma_f32_16x16x32_bf16 v[56:59], a[100:103], a[20:23], v[56:59]
ds_read_b64_tr_b16 a[90:91], v13 offset:1536
s_add_u32 m0, s18, 0xe000
v_mfma_f32_16x16x32_bf16 v[64:67], a[100:103], a[24:27], v[64:67]
buffer_load_dwordx4 v7, s[68:71], s26 offen lds
v_mfma_f32_16x16x32_bf16 v[64:67], a[96:99], a[4:7], v[64:67]
ds_read_b64_tr_b16 a[92:93], v13 offset:8704
v_mfma_f32_16x16x32_bf16 v[72:75], a[96:99], a[8:11], v[72:75]
ds_read_b64_tr_b16 a[94:95], v13 offset:9728
v_mfma_f32_16x16x32_bf16 v[72:75], a[100:103], a[28:31], v[72:75]
ds_read_b128 a[52:55], v8 offset:38912
v_mfma_f32_16x16x32_bf16 v[80:83], a[100:103], a[32:35], v[80:83]
ds_read_b128 a[72:75], v9 offset:38912
v_mfma_f32_16x16x32_bf16 v[80:83], a[96:99], a[12:15], v[80:83]
ds_read_b128 a[16:19], v10
v_mfma_f32_16x16x32_bf16 v[84:87], a[104:107], a[12:15], v[84:87]
ds_read_b64_tr_b16 a[96:97], v12 offset:768
s_add_u32 m0, s18, 0xf000
v_mfma_f32_16x16x32_bf16 v[84:87], a[108:111], a[32:35], v[84:87]
buffer_load_dwordx4 v4, s[44:47], s24 offen lds
v_mfma_f32_16x16x32_bf16 v[76:79], a[108:111], a[28:31], v[76:79]
ds_read_b64_tr_b16 a[98:99], v12 offset:1792
v_add_u32 v5, 0x80000, v5
v_mfma_f32_16x16x32_bf16 v[76:79], a[104:107], a[8:11], v[76:79]
ds_read_b64_tr_b16 a[100:101], v12 offset:8960
v_add_u32 v6, 0x80000, v6
v_mfma_f32_16x16x32_bf16 v[68:71], a[104:107], a[4:7], v[68:71]
ds_read_b64_tr_b16 a[102:103], v12 offset:9984
v_add_u32 v7, 0x60000, v7
v_mfma_f32_16x16x32_bf16 v[68:71], a[108:111], a[24:27], v[68:71]
ds_read_b128 a[36:39], v11
v_add_u32 v4, 0x80, v4
v_mfma_f32_16x16x32_bf16 v[60:63], a[108:111], a[20:23], v[60:63]
s_waitcnt vmcnt(15)
v_accvgpr_read_b32 v18, a144
v_lshlrev_b32 v1, 16, v18
v_mfma_f32_16x16x32_bf16 v[60:63], a[104:107], a[0:3], v[60:63]
s_waitcnt lgkmcnt(6)
s_waitcnt lgkmcnt(8)
v_and_b32 v18, 0xffff0000, v18
v_mfma_f32_16x16x32_bf16 v[88:91], a[80:83], a[0:3], v[88:91]
ds_read_b64_tr_b16 a[104:105], v13 offset:768
s_add_u32 m0, s16, 0x8000
v_mfma_f32_16x16x32_bf16 v[88:91], a[84:87], a[20:23], v[88:91]
buffer_load_dwordx4 v22, s[44:47], s20 offen lds
v_mfma_f32_16x16x32_bf16 v[96:99], a[84:87], a[24:27], v[96:99]
ds_read_b64_tr_b16 a[106:107], v13 offset:1792
v_accvgpr_read_b32 v21, a128
v_mfma_f32_16x16x32_bf16 v[96:99], a[80:83], a[4:7], v[96:99]
ds_read_b64_tr_b16 a[108:109], v13 offset:8960
v_lshlrev_b32 v20, 16, v21
v_mfma_f32_16x16x32_bf16 v[104:107], a[80:83], a[8:11], v[104:107]
ds_read_b64_tr_b16 a[110:111], v13 offset:9984
v_and_b32 v21, 0xffff0000, v21
v_mfma_f32_16x16x32_bf16 v[104:107], a[84:87], a[28:31], v[104:107]
v_mul_f32 v2, v1, v20
v_fmac_f32 v2, v18, v21
v_mfma_f32_16x16x32_bf16 v[112:115], a[84:87], a[32:35], v[112:115]
v_accvgpr_read_b32 v21, a136
v_lshlrev_b32 v20, 16, v21
v_mfma_f32_16x16x32_bf16 v[112:115], a[80:83], a[12:15], v[112:115]
s_add_u32 m0, s16, 0x8400
v_and_b32 v21, 0xffff0000, v21
v_mul_f32 v3, v1, v20
v_mfma_f32_16x16x32_bf16 v[116:119], a[88:91], a[12:15], v[116:119]
buffer_load_dwordx4 v23, s[44:47], s20 offen lds
v_mfma_f32_16x16x32_bf16 v[116:119], a[92:95], a[32:35], v[116:119]
ds_read_b64_tr_b16 a[80:81], v14 offset:0
v_fmac_f32 v3, v18, v21
v_mfma_f32_16x16x32_bf16 v[108:111], a[92:95], a[28:31], v[108:111]
ds_read_b64_tr_b16 a[82:83], v14 offset:256
v_accvgpr_read_b32 v18, a145
v_mfma_f32_16x16x32_bf16 v[108:111], a[88:91], a[8:11], v[108:111]
ds_read_b64_tr_b16 a[84:85], v14 offset:2048
v_lshlrev_b32 v1, 16, v18
v_mfma_f32_16x16x32_bf16 v[100:103], a[88:91], a[4:7], v[100:103]
ds_read_b64_tr_b16 a[86:87], v14 offset:2304
v_and_b32 v18, 0xffff0000, v18
v_mfma_f32_16x16x32_bf16 v[100:103], a[92:95], a[24:27], v[100:103]
v_accvgpr_read_b32 v21, a129
v_lshlrev_b32 v20, 16, v21
v_mfma_f32_16x16x32_bf16 v[92:95], a[92:95], a[20:23], v[92:95]
s_add_u32 m0, s16, 0x8800
s_waitcnt lgkmcnt(4)
v_and_b32 v21, 0xffff0000, v21
v_mfma_f32_16x16x32_bf16 v[92:95], a[88:91], a[0:3], v[92:95]
buffer_load_dwordx4 v22, s[44:47], s21 offen lds
v_mfma_f32_16x16x32_bf16 v[120:123], a[96:99], a[0:3], v[120:123]
ds_read_b64_tr_b16 a[88:89], v15 offset:0
v_fmac_f32 v2, v1, v20
v_mfma_f32_16x16x32_bf16 v[120:123], a[100:103], a[20:23], v[120:123]
ds_read_b64_tr_b16 a[90:91], v15 offset:256
v_fmac_f32 v2, v18, v21
v_mfma_f32_16x16x32_bf16 v[128:131], a[100:103], a[24:27], v[128:131]
ds_read_b64_tr_b16 a[92:93], v15 offset:2048
v_accvgpr_read_b32 v21, a137
v_mfma_f32_16x16x32_bf16 v[128:131], a[96:99], a[4:7], v[128:131]
ds_read_b64_tr_b16 a[94:95], v15 offset:2304
v_lshlrev_b32 v20, 16, v21
v_mfma_f32_16x16x32_bf16 v[136:139], a[96:99], a[8:11], v[136:139]
v_and_b32 v21, 0xffff0000, v21
v_fmac_f32 v3, v1, v20
v_mfma_f32_16x16x32_bf16 v[136:139], a[100:103], a[28:31], v[136:139]
s_add_u32 m0, s16, 0x8c00
v_fmac_f32 v3, v18, v21
v_accvgpr_read_b32 v18, a146
v_mfma_f32_16x16x32_bf16 v[144:147], a[100:103], a[32:35], v[144:147]
buffer_load_dwordx4 v23, s[44:47], s21 offen lds
v_mfma_f32_16x16x32_bf16 v[144:147], a[96:99], a[12:15], v[144:147]
v_lshlrev_b32 v1, 16, v18
v_and_b32 v18, 0xffff0000, v18
v_mfma_f32_16x16x32_bf16 v[148:151], a[104:107], a[12:15], v[148:151]
ds_read_b64_tr_b16 a[96:97], v14 offset:4096
v_accvgpr_read_b32 v21, a130
v_mfma_f32_16x16x32_bf16 v[148:151], a[108:111], a[32:35], v[148:151]
ds_read_b64_tr_b16 a[98:99], v14 offset:4352
v_lshlrev_b32 v20, 16, v21
v_mfma_f32_16x16x32_bf16 v[140:143], a[108:111], a[28:31], v[140:143]
ds_read_b64_tr_b16 a[100:101], v14 offset:6144
v_and_b32 v21, 0xffff0000, v21
v_mfma_f32_16x16x32_bf16 v[140:143], a[104:107], a[8:11], v[140:143]
ds_read_b64_tr_b16 a[102:103], v14 offset:6400
v_fmac_f32 v2, v1, v20
v_mfma_f32_16x16x32_bf16 v[132:135], a[104:107], a[4:7], v[132:135]
s_add_u32 m0, s16, 0x9000
v_fmac_f32 v2, v18, v21
v_accvgpr_read_b32 v21, a138
v_mfma_f32_16x16x32_bf16 v[132:135], a[108:111], a[24:27], v[132:135]
buffer_load_dwordx4 v22, s[44:47], s22 offen lds
v_mfma_f32_16x16x32_bf16 v[124:127], a[108:111], a[20:23], v[124:127]
v_lshlrev_b32 v20, 16, v21
v_and_b32 v21, 0xffff0000, v21
v_mfma_f32_16x16x32_bf16 v[124:127], a[104:107], a[0:3], v[124:127]
s_waitcnt lgkmcnt(4)
v_fmac_f32 v3, v1, v20
v_fmac_f32 v3, v18, v21
v_mfma_f32_16x16x32_bf16 v[152:155], a[80:83], a[0:3], v[152:155]
ds_read_b64_tr_b16 a[104:105], v15 offset:4096
v_accvgpr_read_b32 v18, a147
v_mfma_f32_16x16x32_bf16 v[152:155], a[84:87], a[20:23], v[152:155]
ds_read_b64_tr_b16 a[106:107], v15 offset:4352
v_lshlrev_b32 v1, 16, v18
v_mfma_f32_16x16x32_bf16 v[160:163], a[84:87], a[24:27], v[160:163]
ds_read_b64_tr_b16 a[108:109], v15 offset:6144
v_and_b32 v18, 0xffff0000, v18
v_mfma_f32_16x16x32_bf16 v[160:163], a[80:83], a[4:7], v[160:163]
ds_read_b64_tr_b16 a[110:111], v15 offset:6400
s_add_u32 m0, s16, 0x9400
v_mfma_f32_16x16x32_bf16 v[168:171], a[80:83], a[8:11], v[168:171]
buffer_load_dwordx4 v23, s[44:47], s22 offen lds
v_mfma_f32_16x16x32_bf16 v[168:171], a[84:87], a[28:31], v[168:171]
v_accvgpr_read_b32 v21, a131
v_lshlrev_b32 v20, 16, v21
v_mfma_f32_16x16x32_bf16 v[176:179], a[84:87], a[32:35], v[176:179]
v_and_b32 v21, 0xffff0000, v21
v_fmac_f32 v2, v1, v20
v_mfma_f32_16x16x32_bf16 v[176:179], a[80:83], a[12:15], v[176:179]
v_fmac_f32 v2, v18, v21
v_accvgpr_read_b32 v21, a139
v_mfma_f32_16x16x32_bf16 v[180:183], a[88:91], a[12:15], v[180:183]
ds_read_b64_tr_b16 a[80:81], v14 offset:8192
v_lshlrev_b32 v20, 16, v21
v_mfma_f32_16x16x32_bf16 v[180:183], a[92:95], a[32:35], v[180:183]
ds_read_b64_tr_b16 a[82:83], v14 offset:8448
v_and_b32 v21, 0xffff0000, v21
v_mfma_f32_16x16x32_bf16 v[172:175], a[92:95], a[28:31], v[172:175]
ds_read_b64_tr_b16 a[84:85], v14 offset:10240
s_add_u32 m0, s16, 0x9800
v_mfma_f32_16x16x32_bf16 v[172:175], a[88:91], a[8:11], v[172:175]
buffer_load_dwordx4 v22, s[44:47], s23 offen lds
v_mfma_f32_16x16x32_bf16 v[164:167], a[88:91], a[4:7], v[164:167]
ds_read_b64_tr_b16 a[86:87], v14 offset:10496
v_fmac_f32 v3, v1, v20
v_mfma_f32_16x16x32_bf16 v[164:167], a[92:95], a[24:27], v[164:167]
v_fmac_f32 v3, v18, v21
s_waitcnt vmcnt(15)
v_accvgpr_read_b32 v18, a148
v_mfma_f32_16x16x32_bf16 v[156:159], a[92:95], a[20:23], v[156:159]
v_lshlrev_b32 v1, 16, v18
v_and_b32 v18, 0xffff0000, v18
v_mfma_f32_16x16x32_bf16 v[156:159], a[88:91], a[0:3], v[156:159]
s_waitcnt lgkmcnt(4)
v_accvgpr_read_b32 v21, a132
v_lshlrev_b32 v20, 16, v21
v_mfma_f32_16x16x32_bf16 v[184:187], a[96:99], a[0:3], v[184:187]
ds_read_b64_tr_b16 a[88:89], v15 offset:8192
v_and_b32 v21, 0xffff0000, v21
v_mfma_f32_16x16x32_bf16 v[184:187], a[100:103], a[20:23], v[184:187]
ds_read_b64_tr_b16 a[90:91], v15 offset:8448
s_add_u32 m0, s16, 0x9c00
v_mfma_f32_16x16x32_bf16 v[192:195], a[100:103], a[24:27], v[192:195]
buffer_load_dwordx4 v23, s[44:47], s23 offen lds
v_mfma_f32_16x16x32_bf16 v[192:195], a[96:99], a[4:7], v[192:195]
ds_read_b64_tr_b16 a[92:93], v15 offset:10240
v_add_u32 v22, 0x80, v22
v_mfma_f32_16x16x32_bf16 v[200:203], a[96:99], a[8:11], v[200:203]
ds_read_b64_tr_b16 a[94:95], v15 offset:10496
v_add_u32 v23, 0x80, v23
v_mfma_f32_16x16x32_bf16 v[200:203], a[100:103], a[28:31], v[200:203]
v_add_u32 v12, 0xffff0000, v12
v_add_u32 v13, 0xffff0000, v13
v_mfma_f32_16x16x32_bf16 v[208:211], a[100:103], a[32:35], v[208:211]
v_add_u32 v14, 0xffff0000, v14
v_add_u32 v15, 0xffff0000, v15
v_mfma_f32_16x16x32_bf16 v[208:211], a[96:99], a[12:15], v[208:211]
v_add_u32 v10, 0xffff0000, v10
v_add_u32 v11, 0xffff0000, v11
v_mfma_f32_16x16x32_bf16 v[248:251], a[96:99], a[16:19], v[248:251]
v_fmac_f32 v2, v1, v20
v_fmac_f32 v2, v18, v21
v_mfma_f32_16x16x32_bf16 v[248:251], a[100:103], a[36:39], v[248:251]
v_accvgpr_read_b32 v21, a140
v_lshlrev_b32 v20, 16, v21
v_mfma_f32_16x16x32_bf16 v[212:215], a[104:107], a[12:15], v[212:215]
s_waitcnt vmcnt(26) lgkmcnt(0)
v_and_b32 v21, 0xffff0000, v21
v_fmac_f32 v3, v1, v20
v_mfma_f32_16x16x32_bf16 v[212:215], a[108:111], a[32:35], v[212:215]
s_barrier
s_add_u32 m0, s17, 0x10000
v_fmac_f32 v3, v18, v21
v_mfma_f32_16x16x32_bf16 v[204:207], a[108:111], a[28:31], v[204:207]
buffer_load_dwordx4 v5, s[52:55], 0 offen lds
v_mfma_f32_16x16x32_bf16 v[204:207], a[104:107], a[8:11], v[204:207]
ds_read_b64_tr_b16 a[96:97], v12 offset:0
v_accvgpr_read_b32 v18, a149
v_mfma_f32_16x16x32_bf16 v[196:199], a[104:107], a[4:7], v[196:199]
ds_read_b64_tr_b16 a[98:99], v12 offset:1024
v_lshlrev_b32 v1, 16, v18
v_mfma_f32_16x16x32_bf16 v[196:199], a[108:111], a[24:27], v[196:199]
ds_read_b64_tr_b16 a[100:101], v12 offset:8192
v_and_b32 v18, 0xffff0000, v18
v_mfma_f32_16x16x32_bf16 v[188:191], a[108:111], a[20:23], v[188:191]
ds_read_b64_tr_b16 a[102:103], v12 offset:9216
v_accvgpr_read_b32 v21, a133
v_mfma_f32_16x16x32_bf16 v[188:191], a[104:107], a[0:3], v[188:191]
s_waitcnt lgkmcnt(4)
v_lshlrev_b32 v20, 16, v21
v_and_b32 v21, 0xffff0000, v21
v_mfma_f32_16x16x32_bf16 v[216:219], a[0:3], a[80:83], v[216:219]
ds_read_b64_tr_b16 a[104:105], v13 offset:0
s_add_u32 m0, s17, 0x10400
v_mfma_f32_16x16x32_bf16 v[216:219], a[20:23], a[84:87], v[216:219]
buffer_load_dwordx4 v5, s[52:55], s13 offen lds
v_mfma_f32_16x16x32_bf16 v[224:227], a[24:27], a[84:87], v[224:227]
ds_read_b64_tr_b16 a[106:107], v13 offset:1024
v_fmac_f32 v2, v1, v20
v_mfma_f32_16x16x32_bf16 v[224:227], a[4:7], a[80:83], v[224:227]
ds_read_b64_tr_b16 a[108:109], v13 offset:8192
v_fmac_f32 v2, v18, v21
v_mfma_f32_16x16x32_bf16 v[232:235], a[8:11], a[80:83], v[232:235]
ds_read_b64_tr_b16 a[110:111], v13 offset:9216
v_accvgpr_read_b32 v21, a141
v_mfma_f32_16x16x32_bf16 v[232:235], a[28:31], a[84:87], v[232:235]
s_lshl_b32 s15, s2, 2
v_lshlrev_b32 v20, 16, v21
v_and_b32 v21, 0xffff0000, v21
v_mfma_f32_16x16x32_bf16 v[240:243], a[32:35], a[84:87], v[240:243]
s_add_u32 s15, s15, s4
v_fmac_f32 v3, v1, v20
v_fmac_f32 v3, v18, v21
v_mfma_f32_16x16x32_bf16 v[240:243], a[12:15], a[80:83], v[240:243]
s_lshl_b32 s15, s15, 12
v_accvgpr_read_b32 v18, a150
v_lshlrev_b32 v1, 16, v18
v_mfma_f32_16x16x32_bf16 v[252:255], a[16:19], a[80:83], v[252:255]
s_add_u32 m0, s17, 0x10800
v_and_b32 v18, 0xffff0000, v18
v_accvgpr_read_b32 v21, a134
v_mfma_f32_16x16x32_bf16 v[252:255], a[36:39], a[84:87], v[252:255]
buffer_load_dwordx4 v6, s[52:55], 0 offen lds
v_mfma_f32_16x16x32_bf16 v[244:247], a[12:15], a[88:91], v[244:247]
ds_read_b64_tr_b16 a[80:81], v12 offset:256
v_lshlrev_b32 v20, 16, v21
v_mfma_f32_16x16x32_bf16 v[244:247], a[32:35], a[92:95], v[244:247]
ds_read_b64_tr_b16 a[82:83], v12 offset:1280
v_and_b32 v21, 0xffff0000, v21
v_mfma_f32_16x16x32_bf16 v[236:239], a[28:31], a[92:95], v[236:239]
ds_read_b64_tr_b16 a[84:85], v12 offset:8448
v_fmac_f32 v2, v1, v20
v_mfma_f32_16x16x32_bf16 v[236:239], a[8:11], a[88:91], v[236:239]
ds_read_b64_tr_b16 a[86:87], v12 offset:9472
v_fmac_f32 v2, v18, v21
v_mfma_f32_16x16x32_bf16 v[228:231], a[4:7], a[88:91], v[228:231]
s_add_u32 s15, s15, 0x3800000
v_accvgpr_read_b32 v21, a142
v_lshlrev_b32 v20, 16, v21
v_mfma_f32_16x16x32_bf16 v[228:231], a[24:27], a[92:95], v[228:231]
v_and_b32 v21, 0xffff0000, v21
v_fmac_f32 v3, v1, v20
v_mfma_f32_16x16x32_bf16 v[220:223], a[20:23], a[92:95], v[220:223]
s_add_u32 m0, s17, 0x10c00
s_waitcnt lgkmcnt(4)
v_fmac_f32 v3, v18, v21
v_mfma_f32_16x16x32_bf16 v[220:223], a[0:3], a[88:91], v[220:223]
buffer_load_dwordx4 v6, s[52:55], s13 offen lds
L_S21:
v_mfma_f32_16x16x32_bf16 v[24:27], a[96:99], a[40:43], v[24:27]
ds_read_b64_tr_b16 a[88:89], v13 offset:256
s_waitcnt vmcnt(21)
v_mfma_f32_16x16x32_bf16 v[24:27], a[100:103], a[60:63], v[24:27]
ds_read_b64_tr_b16 a[90:91], v13 offset:1280
v_accvgpr_read_b32 v18, a151
v_mfma_f32_16x16x32_bf16 v[32:35], a[100:103], a[64:67], v[32:35]
ds_read_b64_tr_b16 a[92:93], v13 offset:8448
v_lshlrev_b32 v1, 16, v18
v_mfma_f32_16x16x32_bf16 v[32:35], a[96:99], a[44:47], v[32:35]
ds_read_b64_tr_b16 a[94:95], v13 offset:9472
v_and_b32 v18, 0xffff0000, v18
v_mfma_f32_16x16x32_bf16 v[40:43], a[96:99], a[48:51], v[40:43]
ds_read_b128 a[0:3], v8 offset:0
v_accvgpr_read_b32 v21, a135
v_mfma_f32_16x16x32_bf16 v[40:43], a[100:103], a[68:71], v[40:43]
ds_read_b128 a[20:23], v9 offset:0
v_lshlrev_b32 v20, 16, v21
v_mfma_f32_16x16x32_bf16 v[48:51], a[100:103], a[72:75], v[48:51]
ds_read_b128 a[4:7], v8 offset:2048
s_add_u32 m0, s18, 0x14000
v_mfma_f32_16x16x32_bf16 v[48:51], a[96:99], a[52:55], v[48:51]
buffer_load_dwordx4 v7, s[68:71], 0 offen lds
v_mfma_f32_16x16x32_bf16 v[52:55], a[104:107], a[52:55], v[52:55]
ds_read_b64_tr_b16 a[96:97], v12 offset:512
v_and_b32 v21, 0xffff0000, v21
v_mfma_f32_16x16x32_bf16 v[52:55], a[108:111], a[72:75], v[52:55]
ds_read_b64_tr_b16 a[98:99], v12 offset:1536
v_fmac_f32 v2, v1, v20
v_mfma_f32_16x16x32_bf16 v[44:47], a[108:111], a[68:71], v[44:47]
ds_read_b64_tr_b16 a[100:101], v12 offset:8704
v_fmac_f32 v2, v18, v21
v_mfma_f32_16x16x32_bf16 v[44:47], a[104:107], a[48:51], v[44:47]
ds_read_b64_tr_b16 a[102:103], v12 offset:9728
v_accvgpr_read_b32 v21, a143
v_mfma_f32_16x16x32_bf16 v[36:39], a[104:107], a[44:47], v[36:39]
ds_read_b128 a[24:27], v9 offset:2048
v_lshlrev_b32 v20, 16, v21
v_mfma_f32_16x16x32_bf16 v[36:39], a[108:111], a[64:67], v[36:39]
ds_read_b128 a[8:11], v8 offset:4096
s_waitcnt lgkmcnt(9)
v_mfma_f32_16x16x32_bf16 v[28:31], a[108:111], a[60:63], v[28:31]
ds_read_b128 a[28:31], v9 offset:4096
s_add_u32 m0, s18, 0x15000
v_mfma_f32_16x16x32_bf16 v[28:31], a[104:107], a[40:43], v[28:31]
buffer_load_dwordx4 v7, s[68:71], s25 offen lds
v_mfma_f32_16x16x32_bf16 v[56:59], a[80:83], a[40:43], v[56:59]
ds_read_b64_tr_b16 a[104:105], v13 offset:512
v_and_b32 v21, 0xffff0000, v21
v_mfma_f32_16x16x32_bf16 v[56:59], a[84:87], a[60:63], v[56:59]
ds_read_b64_tr_b16 a[106:107], v13 offset:1536
v_fmac_f32 v3, v1, v20
v_mfma_f32_16x16x32_bf16 v[64:67], a[84:87], a[64:67], v[64:67]
ds_read_b64_tr_b16 a[108:109], v13 offset:8704
v_fmac_f32 v3, v18, v21
v_mfma_f32_16x16x32_bf16 v[64:67], a[80:83], a[44:47], v[64:67]
ds_read_b64_tr_b16 a[110:111], v13 offset:9728
v_add_f32_dpp v2, v2, v2 row_ror:8 row_mask:0xf bank_mask:0xf
v_mfma_f32_16x16x32_bf16 v[72:75], a[80:83], a[48:51], v[72:75]
ds_read_b128 a[12:15], v8 offset:6144
v_add_f32_dpp v3, v3, v3 row_ror:8 row_mask:0xf bank_mask:0xf
v_mfma_f32_16x16x32_bf16 v[72:75], a[84:87], a[68:71], v[72:75]
ds_read_b128 a[32:35], v9 offset:6144
v_add_f32_dpp v2, v2, v2 row_ror:4 row_mask:0xf bank_mask:0xf
v_mfma_f32_16x16x32_bf16 v[80:83], a[84:87], a[72:75], v[80:83]
ds_read_b128 a[56:59], v10
s_add_u32 m0, s18, 0x16000
v_mfma_f32_16x16x32_bf16 v[80:83], a[80:83], a[52:55], v[80:83]
buffer_load_dwordx4 v7, s[68:71], s26 offen lds
v_mfma_f32_16x16x32_bf16 v[84:87], a[88:91], a[52:55], v[84:87]
ds_read_b64_tr_b16 a[80:81], v12 offset:768
v_add_f32_dpp v3, v3, v3 row_ror:4 row_mask:0xf bank_mask:0xf
v_mfma_f32_16x16x32_bf16 v[84:87], a[92:95], a[72:75], v[84:87]
ds_read_b64_tr_b16 a[82:83], v12 offset:1792
v_add_f32_dpp v2, v2, v2 row_ror:2 row_mask:0xf bank_mask:0xf
v_mfma_f32_16x16x32_bf16 v[76:79], a[92:95], a[68:71], v[76:79]
ds_read_b64_tr_b16 a[84:85], v12 offset:8960
v_add_f32_dpp v3, v3, v3 row_ror:2 row_mask:0xf bank_mask:0xf
v_mfma_f32_16x16x32_bf16 v[76:79], a[88:91], a[48:51], v[76:79]
ds_read_b64_tr_b16 a[86:87], v12 offset:9984
v_add_f32_dpp v2, v2, v2 row_ror:1 row_mask:0xf bank_mask:0xf
v_mfma_f32_16x16x32_bf16 v[68:71], a[88:91], a[44:47], v[68:71]
ds_read_b128 a[76:79], v11
v_add_f32_dpp v3, v3, v3 row_ror:1 row_mask:0xf bank_mask:0xf
v_mfma_f32_16x16x32_bf16 v[68:71], a[92:95], a[64:67], v[68:71]
v_mov_b32 v1, v2
v_mov_b32 v18, v3
v_mfma_f32_16x16x32_bf16 v[60:63], a[92:95], a[60:63], v[60:63]
s_add_u32 m0, s18, 0x17000
s_waitcnt lgkmcnt(8)
v_permlane16_swap_b32 v1, v2
v_mfma_f32_16x16x32_bf16 v[60:63], a[88:91], a[40:43], v[60:63]
buffer_load_dwordx4 v4, s[44:47], s24 offen lds
v_mfma_f32_16x16x32_bf16 v[88:91], a[96:99], a[40:43], v[88:91]
ds_read_b64_tr_b16 a[88:89], v13 offset:768
v_add_u32 v5, 0x80000, v5
v_mfma_f32_16x16x32_bf16 v[88:91], a[100:103], a[60:63], v[88:91]
ds_read_b64_tr_b16 a[90:91], v13 offset:1792
v_add_u32 v6, 0x80000, v6
v_mfma_f32_16x16x32_bf16 v[96:99], a[100:103], a[64:67], v[96:99]
ds_read_b64_tr_b16 a[92:93], v13 offset:8960
v_add_u32 v7, 0x60000, v7
v_mfma_f32_16x16x32_bf16 v[96:99], a[96:99], a[44:47], v[96:99]
ds_read_b64_tr_b16 a[94:95], v13 offset:9984
v_add_u32 v4, 0x80, v4
v_mfma_f32_16x16x32_bf16 v[104:107], a[96:99], a[48:51], v[104:107]
v_permlane16_swap_b32 v18, v3
v_add_f32 v2, v2, v1
v_mfma_f32_16x16x32_bf16 v[104:107], a[100:103], a[68:71], v[104:107]
v_add_f32 v3, v3, v18
v_mov_b32 v1, v2
v_mfma_f32_16x16x32_bf16 v[112:115], a[100:103], a[72:75], v[112:115]
v_mov_b32 v18, v3
v_accvgpr_write_b32 a116, -1
v_mfma_f32_16x16x32_bf16 v[112:115], a[96:99], a[52:55], v[112:115]
buffer_load_dword v23, off, s[84:87], s10 sc1
v_mfma_f32_16x16x32_bf16 v[116:119], a[104:107], a[52:55], v[116:119]
ds_read_b64_tr_b16 a[96:97], v14 offset:0
v_permlane32_swap_b32 v1, v2
v_mfma_f32_16x16x32_bf16 v[116:119], a[108:111], a[72:75], v[116:119]
ds_read_b64_tr_b16 a[98:99], v14 offset:256
v_permlane32_swap_b32 v18, v3
v_mfma_f32_16x16x32_bf16 v[108:111], a[108:111], a[68:71], v[108:111]
ds_read_b64_tr_b16 a[100:101], v14 offset:2048
v_add_f32 v2, v2, v1
v_mfma_f32_16x16x32_bf16 v[108:111], a[104:107], a[48:51], v[108:111]
ds_read_b64_tr_b16 a[102:103], v14 offset:2304
v_add_f32 v3, v3, v18
v_mfma_f32_16x16x32_bf16 v[100:103], a[104:107], a[44:47], v[100:103]
v_mul_f32 v2, 0xbfb8aa3b, v2
v_mul_f32 v3, 0xbfb8aa3b, v3
v_mfma_f32_16x16x32_bf16 v[100:103], a[108:111], a[64:67], v[100:103]
v_exp_f32 v2, v2
v_mfma_f32_16x16x32_bf16 v[92:95], a[108:111], a[60:63], v[92:95]
v_exp_f32 v3, v3
v_mfma_f32_16x16x32_bf16 v[92:95], a[104:107], a[40:43], v[92:95]
s_waitcnt lgkmcnt(4)
v_add_f32 v2, 1.0, v2
v_add_f32 v3, 1.0, v3
v_mfma_f32_16x16x32_bf16 v[120:123], a[80:83], a[40:43], v[120:123]
ds_read_b64_tr_b16 a[104:105], v15 offset:0
v_accvgpr_write_b32 a117, -1
v_mfma_f32_16x16x32_bf16 v[120:123], a[84:87], a[60:63], v[120:123]
ds_read_b64_tr_b16 a[106:107], v15 offset:256
v_accvgpr_write_b32 a118, -1
v_mfma_f32_16x16x32_bf16 v[128:131], a[84:87], a[64:67], v[128:131]
ds_read_b64_tr_b16 a[108:109], v15 offset:2048
v_accvgpr_write_b32 a119, -1
v_mfma_f32_16x16x32_bf16 v[128:131], a[80:83], a[44:47], v[128:131]
ds_read_b64_tr_b16 a[110:111], v15 offset:2304
v_mfma_f32_16x16x32_bf16 v[136:139], a[80:83], a[48:51], v[136:139]
v_rcp_f32 v2, v2
v_mfma_f32_16x16x32_bf16 v[136:139], a[84:87], a[68:71], v[136:139]
v_rcp_f32 v3, v3
v_mfma_f32_16x16x32_bf16 v[144:147], a[84:87], a[72:75], v[144:147]
buffer_store_dwordx2 v[2:3], off, s[88:91], s101 sc1
v_mfma_f32_16x16x32_bf16 v[144:147], a[80:83], a[52:55], v[144:147]
L_padA11:
s_cmp_eq_u32 s95, 1
s_cbranch_scc1 L_hopA_ret
v_mfma_f32_16x16x32_bf16 v[148:151], a[88:91], a[52:55], v[148:151]
ds_read_b64_tr_b16 a[80:81], v14 offset:4096
v_mfma_f32_16x16x32_bf16 v[148:151], a[92:95], a[72:75], v[148:151]
ds_read_b64_tr_b16 a[82:83], v14 offset:4352
v_mfma_f32_16x16x32_bf16 v[140:143], a[92:95], a[68:71], v[140:143]
ds_read_b64_tr_b16 a[84:85], v14 offset:6144
v_mfma_f32_16x16x32_bf16 v[140:143], a[88:91], a[48:51], v[140:143]
ds_read_b64_tr_b16 a[86:87], v14 offset:6400
v_mfma_f32_16x16x32_bf16 v[132:135], a[88:91], a[44:47], v[132:135]
v_mfma_f32_16x16x32_bf16 v[132:135], a[92:95], a[64:67], v[132:135]
v_mfma_f32_16x16x32_bf16 v[124:127], a[92:95], a[60:63], v[124:127]
v_mfma_f32_16x16x32_bf16 v[124:127], a[88:91], a[40:43], v[124:127]
s_waitcnt lgkmcnt(4)
v_mfma_f32_16x16x32_bf16 v[152:155], a[96:99], a[40:43], v[152:155]
ds_read_b64_tr_b16 a[88:89], v15 offset:4096
v_mfma_f32_16x16x32_bf16 v[152:155], a[100:103], a[60:63], v[152:155]
ds_read_b64_tr_b16 a[90:91], v15 offset:4352
v_mfma_f32_16x16x32_bf16 v[160:163], a[100:103], a[64:67], v[160:163]
ds_read_b64_tr_b16 a[92:93], v15 offset:6144
v_mfma_f32_16x16x32_bf16 v[160:163], a[96:99], a[44:47], v[160:163]
ds_read_b64_tr_b16 a[94:95], v15 offset:6400
v_mfma_f32_16x16x32_bf16 v[168:171], a[96:99], a[48:51], v[168:171]
v_mfma_f32_16x16x32_bf16 v[168:171], a[100:103], a[68:71], v[168:171]
v_mfma_f32_16x16x32_bf16 v[176:179], a[100:103], a[72:75], v[176:179]
v_mfma_f32_16x16x32_bf16 v[176:179], a[96:99], a[52:55], v[176:179]
v_mfma_f32_16x16x32_bf16 v[180:183], a[104:107], a[52:55], v[180:183]
ds_read_b64_tr_b16 a[96:97], v14 offset:8192
v_mfma_f32_16x16x32_bf16 v[180:183], a[108:111], a[72:75], v[180:183]
ds_read_b64_tr_b16 a[98:99], v14 offset:8448
v_mfma_f32_16x16x32_bf16 v[172:175], a[108:111], a[68:71], v[172:175]
ds_read_b64_tr_b16 a[100:101], v14 offset:10240
v_mfma_f32_16x16x32_bf16 v[172:175], a[104:107], a[48:51], v[172:175]
ds_read_b64_tr_b16 a[102:103], v14 offset:10496
v_mfma_f32_16x16x32_bf16 v[164:167], a[104:107], a[44:47], v[164:167]
v_mfma_f32_16x16x32_bf16 v[164:167], a[108:111], a[64:67], v[164:167]
v_mfma_f32_16x16x32_bf16 v[156:159], a[108:111], a[60:63], v[156:159]
v_mfma_f32_16x16x32_bf16 v[156:159], a[104:107], a[40:43], v[156:159]
s_waitcnt lgkmcnt(4)
v_mfma_f32_16x16x32_bf16 v[184:187], a[80:83], a[40:43], v[184:187]
ds_read_b64_tr_b16 a[104:105], v15 offset:8192
v_mfma_f32_16x16x32_bf16 v[184:187], a[84:87], a[60:63], v[184:187]
ds_read_b64_tr_b16 a[106:107], v15 offset:8448
v_mfma_f32_16x16x32_bf16 v[192:195], a[84:87], a[64:67], v[192:195]
ds_read_b64_tr_b16 a[108:109], v15 offset:10240
v_mfma_f32_16x16x32_bf16 v[192:195], a[80:83], a[44:47], v[192:195]
ds_read_b64_tr_b16 a[110:111], v15 offset:10496
v_add_u32 v12, 0x8000, v12
v_mfma_f32_16x16x32_bf16 v[200:203], a[80:83], a[48:51], v[200:203]
v_add_u32 v13, 0x8000, v13
v_add_u32 v14, 0x8000, v14
v_mfma_f32_16x16x32_bf16 v[200:203], a[84:87], a[68:71], v[200:203]
v_add_u32 v15, 0x8000, v15
v_add_u32 v10, 0x8000, v10
v_mfma_f32_16x16x32_bf16 v[208:211], a[84:87], a[72:75], v[208:211]
v_add_u32 v11, 0x8000, v11
v_mfma_f32_16x16x32_bf16 v[208:211], a[80:83], a[52:55], v[208:211]
v_mfma_f32_16x16x32_bf16 v[248:251], a[80:83], a[56:59], v[248:251]
v_mfma_f32_16x16x32_bf16 v[248:251], a[84:87], a[76:79], v[248:251]
v_mfma_f32_16x16x32_bf16 v[212:215], a[88:91], a[52:55], v[212:215]
s_waitcnt vmcnt(1) lgkmcnt(0)
s_mov_b32 s92, 200000
L_spin_kv:
v_readfirstlane_b32 s93, v23
s_nop 1
s_cmp_ge_u32 s93, 8
s_cbranch_scc1 L_spun_kv
s_sub_u32 s92, s92, 1
s_cbranch_scc1 L_spun_kv
s_sleep 4
buffer_load_dword v23, off, s[84:87], s10 sc1
s_waitcnt vmcnt(0)
s_branch L_spin_kv
L_spun_kv:
v_mfma_f32_16x16x32_bf16 v[212:215], a[92:95], a[72:75], v[212:215]
s_barrier
s_add_u32 m0, s19, 0x0
v_mfma_f32_16x16x32_bf16 v[204:207], a[92:95], a[68:71], v[204:207]
buffer_load_dwordx4 v16, s[48:51], s32 offen offset:0 sc1 lds
v_mov_b32 v3, v16
v_mfma_f32_16x16x32_bf16 v[204:207], a[88:91], a[48:51], v[204:207]
ds_read_b64_tr_b16 a[80:81], v12 offset:0
v_mov_b32 v22, 0x3f803f80
v_mfma_f32_16x16x32_bf16 v[196:199], a[88:91], a[44:47], v[196:199]
ds_read_b64_tr_b16 a[82:83], v12 offset:1024
s_mov_b32 s33, 0
v_mfma_f32_16x16x32_bf16 v[196:199], a[92:95], a[64:67], v[196:199]
ds_read_b64_tr_b16 a[84:85], v12 offset:8192
v_accvgpr_write_b32 a240, v22
v_mfma_f32_16x16x32_bf16 v[188:191], a[92:95], a[60:63], v[188:191]
ds_read_b64_tr_b16 a[86:87], v12 offset:9216
v_accvgpr_write_b32 a241, v22
v_mfma_f32_16x16x32_bf16 v[188:191], a[88:91], a[40:43], v[188:191]
s_waitcnt lgkmcnt(4)
v_accvgpr_write_b32 a242, v22
v_accvgpr_write_b32 a243, v22
v_mfma_f32_16x16x32_bf16 v[216:219], a[40:43], a[96:99], v[216:219]
buffer_load_dwordx4 v16, s[48:51], s32 offen offset:1024 sc1 lds
v_mfma_f32_16x16x32_bf16 v[216:219], a[60:63], a[100:103], v[216:219]
ds_read_b64_tr_b16 a[88:89], v13 offset:0
s_mov_b32 s36, 0x33333333
v_mfma_f32_16x16x32_bf16 v[224:227], a[64:67], a[100:103], v[224:227]
ds_read_b64_tr_b16 a[90:91], v13 offset:1024
s_mov_b32 s37, 0xcccccccc
v_cndmask_b32 v4, 0, v22, s[36:37]
v_mfma_f32_16x16x32_bf16 v[224:227], a[44:47], a[96:99], v[224:227]
ds_read_b64_tr_b16 a[92:93], v13 offset:8192
v_accvgpr_write_b32 a232, v4
v_mfma_f32_16x16x32_bf16 v[232:235], a[48:51], a[96:99], v[232:235]
ds_read_b64_tr_b16 a[94:95], v13 offset:9216
v_accvgpr_write_b32 a233, v4
v_mfma_f32_16x16x32_bf16 v[232:235], a[68:71], a[100:103], v[232:235]
v_accvgpr_write_b32 a234, v4
v_accvgpr_write_b32 a235, v4
v_mfma_f32_16x16x32_bf16 v[240:243], a[72:75], a[100:103], v[240:243]
s_mov_b32 s36, 0x44444444
s_mov_b32 s37, 0x44444444
v_cndmask_b32 v4, 0, v22, s[36:37]
v_mfma_f32_16x16x32_bf16 v[240:243], a[52:55], a[96:99], v[240:243]
buffer_load_dwordx4 v16, s[48:51], s32 offen offset:2048 sc1 lds
v_mfma_f32_16x16x32_bf16 v[252:255], a[56:59], a[96:99], v[252:255]
v_accvgpr_write_b32 a236, v4
v_accvgpr_write_b32 a237, v4
v_mfma_f32_16x16x32_bf16 v[252:255], a[76:79], a[100:103], v[252:255]
v_accvgpr_write_b32 a238, v4
v_accvgpr_write_b32 a239, v4
v_mfma_f32_16x16x32_bf16 v[244:247], a[52:55], a[104:107], v[244:247]
ds_read_b64_tr_b16 a[96:97], v12 offset:256
v_mov_b32 v1, v3
v_add_u32 v2, 98304, v3
v_mfma_f32_16x16x32_bf16 v[244:247], a[72:75], a[108:111], v[244:247]
ds_read_b64_tr_b16 a[98:99], v12 offset:1280
s_mov_b64 s[34:35], 0
v_mfma_f32_16x16x32_bf16 v[236:239], a[68:71], a[108:111], v[236:239]
ds_read_b64_tr_b16 a[100:101], v12 offset:8448
v_accvgpr_write_b32 a224, 0
v_mfma_f32_16x16x32_bf16 v[236:239], a[48:51], a[104:107], v[236:239]
ds_read_b64_tr_b16 a[102:103], v12 offset:9472
v_accvgpr_write_b32 a225, 0
v_mfma_f32_16x16x32_bf16 v[228:231], a[44:47], a[104:107], v[228:231]
buffer_load_dwordx4 v16, s[48:51], s32 offen offset:3072 sc1 lds
v_mfma_f32_16x16x32_bf16 v[228:231], a[64:67], a[108:111], v[228:231]
v_accvgpr_write_b32 a226, 0
v_accvgpr_write_b32 a227, 0
v_mfma_f32_16x16x32_bf16 v[220:223], a[60:63], a[108:111], v[220:223]
v_accvgpr_write_b32 a228, 0
v_accvgpr_write_b32 a229, 0
v_mfma_f32_16x16x32_bf16 v[220:223], a[40:43], a[104:107], v[220:223]
s_waitcnt lgkmcnt(4)
v_accvgpr_write_b32 a230, 0
v_accvgpr_write_b32 a231, 0
L_S22:
v_mfma_f32_16x16x32_bf16 v[24:27], a[80:83], a[0:3], v[24:27]
ds_read_b64_tr_b16 a[104:105], v13 offset:256
s_waitcnt vmcnt(14)
s_mul_i32 s8, s6, 0x142400
v_mfma_f32_16x16x32_bf16 v[24:27], a[84:87], a[20:23], v[24:27]
ds_read_b64_tr_b16 a[106:107], v13 offset:1280
s_add_u32 m0, s19, 0x1000
v_mfma_f32_16x16x32_bf16 v[32:35], a[84:87], a[24:27], v[32:35]
buffer_load_dwordx4 v16, s[48:51], s7 offen offset:0 sc1 lds
v_mfma_f32_16x16x32_bf16 v[32:35], a[80:83], a[4:7], v[32:35]
ds_read_b64_tr_b16 a[108:109], v13 offset:8448
s_sub_u32 s9, 0x12e1c00, s8
v_mfma_f32_16x16x32_bf16 v[40:43], a[80:83], a[8:11], v[40:43]
ds_read_b64_tr_b16 a[110:111], v13 offset:9472
s_lshl_b32 s11, s5, 13
v_mfma_f32_16x16x32_bf16 v[40:43], a[84:87], a[28:31], v[40:43]
ds_read_b128 a[40:43], v8 offset:32768
s_add_u32 s11, s11, 0x2200000
v_mfma_f32_16x16x32_bf16 v[48:51], a[84:87], a[32:35], v[48:51]
ds_read_b128 a[60:63], v9 offset:32768
s_add_u32 s8, s8, s11
v_mfma_f32_16x16x32_bf16 v[48:51], a[80:83], a[12:15], v[48:51]
ds_read_b128 a[44:47], v8 offset:34816
s_add_u32 s9, s9, s11
v_mfma_f32_16x16x32_bf16 v[52:55], a[88:91], a[12:15], v[52:55]
ds_read_b64_tr_b16 a[80:81], v12 offset:512
s_lshl_b32 s11, s4, 10
s_add_u32 s44, s8, s11
v_mfma_f32_16x16x32_bf16 v[52:55], a[92:95], a[32:35], v[52:55]
buffer_load_dwordx4 v16, s[48:51], s7 offen offset:1024 sc1 lds
v_mfma_f32_16x16x32_bf16 v[44:47], a[92:95], a[28:31], v[44:47]
ds_read_b64_tr_b16 a[82:83], v12 offset:1536
s_add_u32 s46, s9, s11
v_mfma_f32_16x16x32_bf16 v[44:47], a[88:91], a[8:11], v[44:47]
ds_read_b64_tr_b16 a[84:85], v12 offset:8704
s_sub_u32 s11, 0x1c00, s11
v_mfma_f32_16x16x32_bf16 v[36:39], a[88:91], a[4:7], v[36:39]
ds_read_b64_tr_b16 a[86:87], v12 offset:9728
s_add_u32 s45, s8, s11
v_mfma_f32_16x16x32_bf16 v[36:39], a[92:95], a[24:27], v[36:39]
ds_read_b128 a[64:67], v9 offset:34816
s_add_u32 s47, s9, s11
v_mfma_f32_16x16x32_bf16 v[28:31], a[92:95], a[20:23], v[28:31]
ds_read_b128 a[48:51], v8 offset:36864
s_mul_i32 s8, s5, 0x6000
v_mfma_f32_16x16x32_bf16 v[28:31], a[88:91], a[0:3], v[28:31]
ds_read_b128 a[68:71], v9 offset:36864
s_waitcnt lgkmcnt(10)
v_mfma_f32_16x16x32_bf16 v[56:59], a[96:99], a[0:3], v[56:59]
buffer_load_dwordx4 v16, s[48:51], s7 offen offset:2048 sc1 lds
s_add_u32 s8, s8, 0x40000
v_mfma_f32_16x16x32_bf16 v[56:59], a[100:103], a[20:23], v[56:59]
ds_read_b64_tr_b16 a[88:89], v13 offset:512
s_add_u32 s28, s44, s8
v_mfma_f32_16x16x32_bf16 v[64:67], a[100:103], a[24:27], v[64:67]
ds_read_b64_tr_b16 a[90:91], v13 offset:1536
s_add_u32 s29, s45, s8
v_mfma_f32_16x16x32_bf16 v[64:67], a[96:99], a[4:7], v[64:67]
ds_read_b64_tr_b16 a[92:93], v13 offset:8704
s_add_u32 s30, s46, s8
v_mfma_f32_16x16x32_bf16 v[72:75], a[96:99], a[8:11], v[72:75]
ds_read_b64_tr_b16 a[94:95], v13 offset:9728
s_add_u32 s31, s47, s8
v_mfma_f32_16x16x32_bf16 v[72:75], a[100:103], a[28:31], v[72:75]
ds_read_b128 a[52:55], v8 offset:38912
s_lshl_b32 s8, s4, 11
v_mfma_f32_16x16x32_bf16 v[80:83], a[100:103], a[32:35], v[80:83]
buffer_load_dwordx4 v16, s[48:51], s7 offen offset:3072 sc1 lds
v_mfma_f32_16x16x32_bf16 v[80:83], a[96:99], a[12:15], v[80:83]
ds_read_b128 a[72:75], v9 offset:38912
s_add_u32 s32, s32, s94
v_mfma_f32_16x16x32_bf16 v[84:87], a[104:107], a[12:15], v[84:87]
ds_read_b64_tr_b16 a[96:97], v12 offset:768
s_add_u32 s7, s7, s94
s_add_u32 s9, s8, 131072
v_mfma_f32_16x16x32_bf16 v[84:87], a[108:111], a[32:35], v[84:87]
ds_read_b64_tr_b16 a[98:99], v12 offset:1792
v_add_u32 v4, s9, v16
v_mfma_f32_16x16x32_bf16 v[76:79], a[108:111], a[28:31], v[76:79]
ds_read_b64_tr_b16 a[100:101], v12 offset:8960
s_sub_u32 s9, 145408, s8
v_mfma_f32_16x16x32_bf16 v[76:79], a[104:107], a[8:11], v[76:79]
ds_read_b64_tr_b16 a[102:103], v12 offset:9984
v_mfma_f32_16x16x32_bf16 v[68:71], a[104:107], a[4:7], v[68:71]
ds_read_b128 a[16:19], v10
s_add_u32 m0, s19, 0x18000
v_mfma_f32_16x16x32_bf16 v[68:71], a[108:111], a[24:27], v[68:71]
buffer_load_dwordx4 v16, s[48:51], s32 offen offset:0 sc1 lds
v_mfma_f32_16x16x32_bf16 v[60:63], a[108:111], a[20:23], v[60:63]
ds_read_b128 a[36:39], v11
v_mfma_f32_16x16x32_bf16 v[60:63], a[104:107], a[0:3], v[60:63]
s_waitcnt lgkmcnt(8)
s_cmp_eq_u32 s4, 0
s_cselect_b32 s8, 131072, s9
v_mfma_f32_16x16x32_bf16 v[88:91], a[80:83], a[0:3], v[88:91]
ds_read_b64_tr_b16 a[104:105], v13 offset:768
v_add_u32 v5, s8, v16
v_mfma_f32_16x16x32_bf16 v[88:91], a[84:87], a[20:23], v[88:91]
ds_read_b64_tr_b16 a[106:107], v13 offset:1792
v_mfma_f32_16x16x32_bf16 v[96:99], a[84:87], a[24:27], v[96:99]
ds_read_b64_tr_b16 a[108:109], v13 offset:8960
v_mfma_f32_16x16x32_bf16 v[96:99], a[80:83], a[4:7], v[96:99]
ds_read_b64_tr_b16 a[110:111], v13 offset:9984
v_mfma_f32_16x16x32_bf16 v[104:107], a[80:83], a[8:11], v[104:107]
buffer_load_dwordx4 v16, s[48:51], s32 offen offset:1024 sc1 lds
v_mfma_f32_16x16x32_bf16 v[104:107], a[84:87], a[28:31], v[104:107]
s_cmp_eq_u32 s4, 3
s_cselect_b32 s8, 0, 8
s_add_u32 s9, s9, s8
v_mfma_f32_16x16x32_bf16 v[112:115], a[84:87], a[32:35], v[112:115]
v_add_u32 v6, s9, v16
v_xor_b32 v7, 8, v6
v_mfma_f32_16x16x32_bf16 v[112:115], a[80:83], a[12:15], v[112:115]
s_lshr_b32 s8, s4, 1
s_lshl_b32 s8, s8, 14
s_and_b32 s9, s4, 1
v_mfma_f32_16x16x32_bf16 v[116:119], a[88:91], a[12:15], v[116:119]
ds_read_b64_tr_b16 a[80:81], v14 offset:0
s_lshl_b32 s9, s9, 3
s_xor_b32 s9, s9, 131080
v_mfma_f32_16x16x32_bf16 v[116:119], a[92:95], a[32:35], v[116:119]
ds_read_b64_tr_b16 a[82:83], v14 offset:256
s_add_u32 s8, s8, s9
v_mfma_f32_16x16x32_bf16 v[108:111], a[92:95], a[28:31], v[108:111]
ds_read_b64_tr_b16 a[84:85], v14 offset:2048
v_add_u32 v22, s8, v16
v_mfma_f32_16x16x32_bf16 v[108:111], a[88:91], a[8:11], v[108:111]
buffer_load_dwordx4 v16, s[48:51], s32 offen offset:2048 sc1 lds
v_mfma_f32_16x16x32_bf16 v[100:103], a[88:91], a[4:7], v[100:103]
ds_read_b64_tr_b16 a[86:87], v14 offset:2304
s_bfe_u32 s99, s2, 0x20001
v_mfma_f32_16x16x32_bf16 v[100:103], a[92:95], a[24:27], v[100:103]
s_lshl_b32 s99, s99, 2
s_lshr_b32 s8, s2, 6
s_add_u32 s99, s99, s8
v_mfma_f32_16x16x32_bf16 v[92:95], a[92:95], a[20:23], v[92:95]
s_bfe_u32 s100, s2, 0x30003
s_and_b32 s14, s2, 1
s_sub_u32 s24, 15, s99
v_mfma_f32_16x16x32_bf16 v[92:95], a[88:91], a[0:3], v[92:95]
s_waitcnt lgkmcnt(4)
s_min_u32 s18, s24, s99
s_lshl_b32 s24, s18, 1
v_mfma_f32_16x16x32_bf16 v[120:123], a[96:99], a[0:3], v[120:123]
ds_read_b64_tr_b16 a[88:89], v15 offset:0
s_add_u32 s24, s24, s14
s_lshl_b32 s24, s24, 6
v_mfma_f32_16x16x32_bf16 v[120:123], a[100:103], a[20:23], v[120:123]
buffer_load_dwordx4 v16, s[48:51], s32 offen offset:3072 sc1 lds
v_mfma_f32_16x16x32_bf16 v[128:131], a[100:103], a[24:27], v[128:131]
ds_read_b64_tr_b16 a[90:91], v15 offset:256
s_add_u32 s24, s24, 0x3704000
v_mfma_f32_16x16x32_bf16 v[128:131], a[96:99], a[4:7], v[128:131]
ds_read_b64_tr_b16 a[92:93], v15 offset:2048
s_mov_b32 s12, 14336
v_mfma_f32_16x16x32_bf16 v[136:139], a[96:99], a[8:11], v[136:139]
ds_read_b64_tr_b16 a[94:95], v15 offset:2304
s_and_b32 s16, s6, 1
v_mfma_f32_16x16x32_bf16 v[136:139], a[100:103], a[28:31], v[136:139]
s_lshl_b32 s16, s16, 15
s_add_u32 s16, s16, 98304
s_add_u32 s16, s16, s17
v_mfma_f32_16x16x32_bf16 v[144:147], a[100:103], a[32:35], v[144:147]
s_lshl_b32 s13, s4, 15
s_lshl_b32 s9, s100, 8
s_add_u32 s13, s13, s9
v_mfma_f32_16x16x32_bf16 v[144:147], a[96:99], a[12:15], v[144:147]
s_add_u32 m0, s19, 0x19000
s_mul_i32 s9, s14, 0x100080
s_add_u32 s13, s13, s9
v_mfma_f32_16x16x32_bf16 v[148:151], a[104:107], a[12:15], v[148:151]
buffer_load_dwordx4 v16, s[48:51], s7 offen offset:0 sc1 lds
s_mul_i32 s25, s14, 0x300000
v_mfma_f32_16x16x32_bf16 v[148:151], a[108:111], a[32:35], v[148:151]
ds_read_b64_tr_b16 a[96:97], v14 offset:4096
s_sub_u32 s25, s25, 917504
v_mfma_f32_16x16x32_bf16 v[140:143], a[108:111], a[28:31], v[140:143]
ds_read_b64_tr_b16 a[98:99], v14 offset:4352
s_mul_i32 s101, s99, 0x142400
v_mfma_f32_16x16x32_bf16 v[140:143], a[104:107], a[8:11], v[140:143]
ds_read_b64_tr_b16 a[100:101], v14 offset:6144
s_lshl_b32 s8, s4, 11
v_mfma_f32_16x16x32_bf16 v[132:135], a[104:107], a[4:7], v[132:135]
ds_read_b64_tr_b16 a[102:103], v14 offset:6400
s_add_u32 s101, s101, s8
v_mfma_f32_16x16x32_bf16 v[132:135], a[108:111], a[24:27], v[132:135]
s_lshl_b32 s8, s14, 17
s_add_u32 s101, s101, s8
s_add_u32 s101, s101, 0x21fe000
v_mfma_f32_16x16x32_bf16 v[124:127], a[108:111], a[20:23], v[124:127]
s_waitcnt lgkmcnt(4)
s_mul_i32 s26, s14, 393216
s_add_u32 s26, s26, 139264
v_mfma_f32_16x16x32_bf16 v[124:127], a[104:107], a[0:3], v[124:127]
buffer_load_dwordx4 v16, s[48:51], s7 offen offset:1024 sc1 lds
v_mfma_f32_16x16x32_bf16 v[152:155], a[80:83], a[0:3], v[152:155]
ds_read_b64_tr_b16 a[104:105], v15 offset:4096
s_mov_b32 s52, 0x3e0293ee
s_mov_b32 s53, 0x3e0293ee
v_mfma_f32_16x16x32_bf16 v[152:155], a[84:87], a[20:23], v[152:155]
ds_read_b64_tr_b16 a[106:107], v15 offset:4352
s_mov_b32 s54, 0x3e8293ee
v_mfma_f32_16x16x32_bf16 v[160:163], a[84:87], a[24:27], v[160:163]
ds_read_b64_tr_b16 a[108:109], v15 offset:6144
v_mfma_f32_16x16x32_bf16 v[160:163], a[80:83], a[4:7], v[160:163]
ds_read_b64_tr_b16 a[110:111], v15 offset:6400
v_mfma_f32_16x16x32_bf16 v[168:171], a[80:83], a[8:11], v[168:171]
s_or_b32 s55, s6, s4
s_cselect_b32 s55, 0, 0xf149f2ca
s_mov_b32 s56, 0x50000
v_mfma_f32_16x16x32_bf16 v[168:171], a[84:87], a[28:31], v[168:171]
buffer_load_dwordx4 v16, s[48:51], s7 offen offset:2048 sc1 lds
v_mfma_f32_16x16x32_bf16 v[176:179], a[84:87], a[32:35], v[176:179]
s_mov_b32 s57, 0x5550055
s_mov_b32 s58, 0xa0000
s_mov_b32 s59, 0xaaa00aa
v_mfma_f32_16x16x32_bf16 v[176:179], a[80:83], a[12:15], v[176:179]
s_mov_b32 s60, 0x150001
s_mov_b32 s61, 0x15550155
s_mov_b32 s62, 0x2a0002
v_mfma_f32_16x16x32_bf16 v[180:183], a[88:91], a[12:15], v[180:183]
ds_read_b64_tr_b16 a[80:81], v14 offset:8192
s_mov_b32 s63, 0x2aaa02aa
s_mov_b32 s68, 0x55505555
v_mfma_f32_16x16x32_bf16 v[180:183], a[92:95], a[32:35], v[180:183]
ds_read_b64_tr_b16 a[82:83], v14 offset:8448
s_mov_b32 s69, 0x50005500
v_mfma_f32_16x16x32_bf16 v[172:175], a[92:95], a[28:31], v[172:175]
ds_read_b64_tr_b16 a[84:85], v14 offset:10240
s_mov_b32 s70, 0xaaa0aaaa
v_mfma_f32_16x16x32_bf16 v[172:175], a[88:91], a[8:11], v[172:175]
ds_read_b64_tr_b16 a[86:87], v14 offset:10496
s_mov_b32 s71, 0xa000aa00
v_mfma_f32_16x16x32_bf16 v[164:167], a[88:91], a[4:7], v[164:167]
buffer_load_dwordx4 v16, s[48:51], s7 offen offset:3072 sc1 lds
v_mfma_f32_16x16x32_bf16 v[164:167], a[92:95], a[24:27], v[164:167]
s_add_u32 s32, s32, 0x8000
s_add_u32 s7, s7, 0x8000
s_mov_b32 s76, 0x55405554
v_mfma_f32_16x16x32_bf16 v[156:159], a[92:95], a[20:23], v[156:159]
s_mov_b32 s77, 0x40005400
s_mov_b32 s78, 0xaa80aaa8
s_mov_b32 s79, 0x8000a800
v_mfma_f32_16x16x32_bf16 v[156:159], a[88:91], a[0:3], v[156:159]
s_waitcnt lgkmcnt(4)
s_mov_b32 s11, 0xf149f2ca
s_mov_b32 s36, 0xfff0ffff
v_mfma_f32_16x16x32_bf16 v[184:187], a[96:99], a[0:3], v[184:187]
ds_read_b64_tr_b16 a[88:89], v15 offset:8192
s_mov_b32 s37, 0xf000ff00
s_mov_b32 s38, 0xffe0fffe
v_mfma_f32_16x16x32_bf16 v[184:187], a[100:103], a[20:23], v[184:187]
ds_read_b64_tr_b16 a[90:91], v15 offset:8448
v_mov_b32 v21, s1
v_mfma_f32_16x16x32_bf16 v[192:195], a[100:103], a[24:27], v[192:195]
ds_read_b64_tr_b16 a[92:93], v15 offset:10240
v_add_u32 v20, s0, v16
v_mfma_f32_16x16x32_bf16 v[192:195], a[96:99], a[4:7], v[192:195]
global_load_dword a120, v[20:21], off sc1
v_mfma_f32_16x16x32_bf16 v[200:203], a[96:99], a[8:11], v[200:203]
ds_read_b64_tr_b16 a[94:95], v15 offset:10496
v_add_u32 v12, 0x8000, v12
v_mfma_f32_16x16x32_bf16 v[200:203], a[100:103], a[28:31], v[200:203]
s_mov_b32 s39, 0xe000fe00
v_add_u32 v13, 0x8000, v13
v_add_u32 v14, 0x8000, v14
v_mfma_f32_16x16x32_bf16 v[208:211], a[100:103], a[32:35], v[208:211]
s_mov_b32 s40, 0xffc0fffc
v_add_u32 v15, 0x8000, v15
v_add_u32 v10, 0x8000, v10
v_mfma_f32_16x16x32_bf16 v[208:211], a[96:99], a[12:15], v[208:211]
s_mov_b32 s41, 0xc000fc00
s_mov_b32 s42, 0xff80fff8
v_add_u32 v11, 0x8000, v11
v_mfma_f32_16x16x32_bf16 v[248:251], a[96:99], a[16:19], v[248:251]
s_mov_b32 s43, 0x8000f800
s_bitcmp1_b32 s4, 0
s_cselect_b32 s8, 0x7f800000, s11
s_cselect_b32 s9, s11, 0x7f800000
v_mfma_f32_16x16x32_bf16 v[248:251], a[100:103], a[36:39], v[248:251]
v_mfma_f32_16x16x32_bf16 v[212:215], a[104:107], a[12:15], v[212:215]
s_waitcnt vmcnt(19) lgkmcnt(0)
v_mfma_f32_16x16x32_bf16 v[212:215], a[108:111], a[32:35], v[212:215]
s_barrier
s_add_u32 m0, s19, 0x8000
v_mfma_f32_16x16x32_bf16 v[204:207], a[108:111], a[28:31], v[204:207]
buffer_load_dwordx4 v16, s[48:51], s32 offen offset:0 sc1 lds
v_mfma_f32_16x16x32_bf16 v[204:207], a[104:107], a[8:11], v[204:207]
ds_read_b64_tr_b16 a[96:97], v14 offset:4096
v_mfma_f32_16x16x32_bf16 v[196:199], a[104:107], a[4:7], v[196:199]
ds_read_b64_tr_b16 a[98:99], v14 offset:4352
v_mfma_f32_16x16x32_bf16 v[196:199], a[108:111], a[24:27], v[196:199]
ds_read_b64_tr_b16 a[100:101], v14 offset:6144
v_mfma_f32_16x16x32_bf16 v[188:191], a[108:111], a[20:23], v[188:191]
ds_read_b64_tr_b16 a[102:103], v14 offset:6400
s_waitcnt lgkmcnt(4)
v_mfma_f32_16x16x32_bf16 v[188:191], a[104:107], a[0:3], v[188:191]
buffer_load_dwordx4 v16, s[48:51], s32 offen offset:1024 sc1 lds
v_mfma_f32_16x16x32_bf16 v[216:219], a[0:3], a[80:83], v[216:219]
ds_read_b64_tr_b16 a[104:105], v15 offset:4096
v_mfma_f32_16x16x32_bf16 v[216:219], a[20:23], a[84:87], v[216:219]
ds_read_b64_tr_b16 a[106:107], v15 offset:4352
v_mfma_f32_16x16x32_bf16 v[224:227], a[24:27], a[84:87], v[224:227]
ds_read_b64_tr_b16 a[108:109], v15 offset:6144
v_mfma_f32_16x16x32_bf16 v[224:227], a[4:7], a[80:83], v[224:227]
ds_read_b64_tr_b16 a[110:111], v15 offset:6400
v_mfma_f32_16x16x32_bf16 v[232:235], a[8:11], a[80:83], v[232:235]
buffer_store_dwordx4 a[116:119], v16, s[88:91], s15 offen offset:0 sc1
v_mfma_f32_16x16x32_bf16 v[232:235], a[28:31], a[84:87], v[232:235]
ds_read_b128 a[56:59], v10
v_mfma_f32_16x16x32_bf16 v[240:243], a[32:35], a[84:87], v[240:243]
ds_read_b128 a[76:79], v11
v_mfma_f32_16x16x32_bf16 v[240:243], a[12:15], a[80:83], v[240:243]
v_mfma_f32_16x16x32_bf16 v[252:255], a[16:19], a[80:83], v[252:255]
v_mfma_f32_16x16x32_bf16 v[252:255], a[36:39], a[84:87], v[252:255]
buffer_load_dwordx4 v16, s[48:51], s32 offen offset:2048 sc1 lds
v_mfma_f32_16x16x32_bf16 v[244:247], a[12:15], a[88:91], v[244:247]
ds_read_b64_tr_b16 a[80:81], v14 offset:8192
v_mfma_f32_16x16x32_bf16 v[244:247], a[32:35], a[92:95], v[244:247]
ds_read_b64_tr_b16 a[82:83], v14 offset:8448
v_mfma_f32_16x16x32_bf16 v[236:239], a[28:31], a[92:95], v[236:239]
ds_read_b64_tr_b16 a[84:85], v14 offset:10240
v_mfma_f32_16x16x32_bf16 v[236:239], a[8:11], a[88:91], v[236:239]
ds_read_b64_tr_b16 a[86:87], v14 offset:10496
v_mfma_f32_16x16x32_bf16 v[228:231], a[4:7], a[88:91], v[228:231]
buffer_load_dwordx4 v16, s[48:51], s32 offen offset:3072 sc1 lds
v_mfma_f32_16x16x32_bf16 v[228:231], a[24:27], a[92:95], v[228:231]
v_mfma_f32_16x16x32_bf16 v[220:223], a[20:23], a[92:95], v[220:223]
v_mfma_f32_16x16x32_bf16 v[220:223], a[0:3], a[88:91], v[220:223]
s_waitcnt lgkmcnt(6)
L_S23:
v_mfma_f32_16x16x32_bf16 v[184:187], a[96:99], a[40:43], v[184:187]
ds_read_b64_tr_b16 a[88:89], v15 offset:8192
v_mov_b32 v8, v19
v_mov_b32 v9, 0xf149f2ca
v_mfma_f32_16x16x32_bf16 v[184:187], a[100:103], a[60:63], v[184:187]
buffer_store_dwordx4 a[116:119], v16, s[88:91], s15 offen offset:1024 sc1
v_mfma_f32_16x16x32_bf16 v[192:195], a[100:103], a[64:67], v[192:195]
ds_read_b64_tr_b16 a[90:91], v15 offset:8448
v_mfma_f32_16x16x32_bf16 v[192:195], a[96:99], a[44:47], v[192:195]
ds_read_b64_tr_b16 a[92:93], v15 offset:10240
v_mfma_f32_16x16x32_bf16 v[200:203], a[96:99], a[48:51], v[200:203]
ds_read_b64_tr_b16 a[94:95], v15 offset:10496
v_mfma_f32_16x16x32_bf16 v[200:203], a[100:103], a[68:71], v[200:203]
s_add_u32 m0, s19, 0x9000
v_mfma_f32_16x16x32_bf16 v[208:211], a[100:103], a[72:75], v[208:211]
buffer_load_dwordx4 v16, s[48:51], s7 offen offset:0 sc1 lds
v_mfma_f32_16x16x32_bf16 v[208:211], a[96:99], a[52:55], v[208:211]
s_waitcnt lgkmcnt(9)
v_mfma_f32_16x16x32_bf16 v[248:251], a[96:99], a[56:59], v[248:251]
s_waitcnt lgkmcnt(8)
v_mfma_f32_16x16x32_bf16 v[248:251], a[100:103], a[76:79], v[248:251]
v_mfma_f32_16x16x32_bf16 v[212:215], a[104:107], a[52:55], v[212:215]
ds_read_b64_tr_b16 a[96:97], v14 offset:0
v_mfma_f32_16x16x32_bf16 v[212:215], a[108:111], a[72:75], v[212:215]
buffer_load_dwordx4 v16, s[48:51], s7 offen offset:1024 sc1 lds
v_mfma_f32_16x16x32_bf16 v[204:207], a[108:111], a[68:71], v[204:207]
ds_read_b64_tr_b16 a[98:99], v14 offset:256
v_mfma_f32_16x16x32_bf16 v[204:207], a[104:107], a[48:51], v[204:207]
ds_read_b64_tr_b16 a[100:101], v14 offset:2048
v_mfma_f32_16x16x32_bf16 v[196:199], a[104:107], a[44:47], v[196:199]
ds_read_b64_tr_b16 a[102:103], v14 offset:2304
v_mfma_f32_16x16x32_bf16 v[196:199], a[108:111], a[64:67], v[196:199]
v_mfma_f32_16x16x32_bf16 v[188:191], a[108:111], a[60:63], v[188:191]
buffer_store_dwordx4 a[116:119], v16, s[88:91], s15 offen offset:2048 sc1
v_mfma_f32_16x16x32_bf16 v[188:191], a[104:107], a[40:43], v[188:191]
s_waitcnt lgkmcnt(4)
v_mfma_f32_16x16x32_bf16 v[216:219], a[40:43], a[80:83], v[216:219]
ds_read_b64_tr_b16 a[104:105], v15 offset:0
v_mfma_f32_16x16x32_bf16 v[216:219], a[60:63], a[84:87], v[216:219]
ds_read_b64_tr_b16 a[106:107], v15 offset:256
v_mfma_f32_16x16x32_bf16 v[224:227], a[64:67], a[84:87], v[224:227]
ds_read_b64_tr_b16 a[108:109], v15 offset:2048
v_mfma_f32_16x16x32_bf16 v[224:227], a[44:47], a[80:83], v[224:227]
buffer_load_dwordx4 v16, s[48:51], s7 offen offset:2048 sc1 lds
v_mfma_f32_16x16x32_bf16 v[232:235], a[48:51], a[80:83], v[232:235]
ds_read_b64_tr_b16 a[110:111], v15 offset:2304
v_cvt_pk_bf16_f32 v248, v248, v249
v_mfma_f32_16x16x32_bf16 v[232:235], a[68:71], a[84:87], v[232:235]
v_cvt_pk_bf16_f32 v249, v250, v251
v_cvt_pk_bf16_f32 v184, v184, v185
v_mfma_f32_16x16x32_bf16 v[240:243], a[72:75], a[84:87], v[240:243]
v_cvt_pk_bf16_f32 v185, v186, v187
v_cvt_pk_bf16_f32 v186, v188, v189
v_cvt_pk_bf16_f32 v187, v190, v191
v_mfma_f32_16x16x32_bf16 v[240:243], a[52:55], a[80:83], v[240:243]
v_cvt_pk_bf16_f32 v192, v192, v193
v_cvt_pk_bf16_f32 v193, v194, v195
v_mfma_f32_16x16x32_bf16 v[252:255], a[56:59], a[80:83], v[252:255]
buffer_load_dwordx4 v16, s[48:51], s7 offen offset:3072 sc1 lds
v_mfma_f32_16x16x32_bf16 v[252:255], a[76:79], a[84:87], v[252:255]
s_add_u32 s32, s32, 0x8000
s_add_u32 s7, s7, 0x8000
v_cvt_pk_bf16_f32 v194, v196, v197
v_mfma_f32_16x16x32_bf16 v[244:247], a[52:55], a[88:91], v[244:247]
ds_read_b64_tr_b16 a[80:81], v12 offset:0
v_cvt_pk_bf16_f32 v195, v198, v199
v_cvt_pk_bf16_f32 v200, v200, v201
v_mfma_f32_16x16x32_bf16 v[244:247], a[72:75], a[92:95], v[244:247]
ds_read_b64_tr_b16 a[82:83], v12 offset:1024
v_cvt_pk_bf16_f32 v201, v202, v203
v_mfma_f32_16x16x32_bf16 v[236:239], a[68:71], a[92:95], v[236:239]
ds_read_b64_tr_b16 a[84:85], v12 offset:8192
v_cvt_pk_bf16_f32 v202, v204, v205
v_mfma_f32_16x16x32_bf16 v[236:239], a[48:51], a[88:91], v[236:239]
buffer_store_dwordx4 a[116:119], v16, s[88:91], s15 offen offset:3072 sc1
v_mfma_f32_16x16x32_bf16 v[228:231], a[44:47], a[88:91], v[228:231]
ds_read_b64_tr_b16 a[86:87], v12 offset:9216
v_cvt_pk_bf16_f32 v203, v206, v207
v_cvt_pk_bf16_f32 v208, v208, v209
v_mfma_f32_16x16x32_bf16 v[228:231], a[64:67], a[92:95], v[228:231]
L_padA12:
s_cmp_eq_u32 s95, 1
s_cbranch_scc1 L_hopA_ret
v_cvt_pk_bf16_f32 v209, v210, v211
v_cvt_pk_bf16_f32 v210, v212, v213
v_mfma_f32_16x16x32_bf16 v[220:223], a[60:63], a[92:95], v[220:223]
v_cvt_pk_bf16_f32 v211, v214, v215
v_mfma_f32_16x16x32_bf16 v[220:223], a[40:43], a[88:91], v[220:223]
s_waitcnt lgkmcnt(4)
v_mfma_f32_16x16x32_bf16 v[152:155], a[96:99], a[40:43], v[152:155]
ds_read_b64_tr_b16 a[88:89], v13 offset:0
v_mfma_f32_16x16x32_bf16 v[152:155], a[100:103], a[60:63], v[152:155]
ds_read_b64_tr_b16 a[90:91], v13 offset:1024
v_mfma_f32_16x16x32_bf16 v[160:163], a[100:103], a[64:67], v[160:163]
ds_read_b64_tr_b16 a[92:93], v13 offset:8192
v_mfma_f32_16x16x32_bf16 v[160:163], a[96:99], a[44:47], v[160:163]
ds_read_b64_tr_b16 a[94:95], v13 offset:9216
v_mfma_f32_16x16x32_bf16 v[168:171], a[96:99], a[48:51], v[168:171]
ds_write_b64 v22, v[248:249]
v_mfma_f32_16x16x32_bf16 v[168:171], a[100:103], a[68:71], v[168:171]
ds_write_b128 v5, v[192:195] offset:2048
v_mfma_f32_16x16x32_bf16 v[176:179], a[100:103], a[72:75], v[176:179]
ds_write_b128 v5, v[208:211] offset:18432
v_mfma_f32_16x16x32_bf16 v[176:179], a[96:99], a[52:55], v[176:179]
ds_write_b128 v4, v[184:187] offset:2048
v_mfma_f32_16x16x32_bf16 v[180:183], a[104:107], a[52:55], v[180:183]
ds_read_b64_tr_b16 a[96:97], v12 offset:256
v_mfma_f32_16x16x32_bf16 v[180:183], a[108:111], a[72:75], v[180:183]
ds_read_b64_tr_b16 a[98:99], v12 offset:1280
v_mfma_f32_16x16x32_bf16 v[172:175], a[108:111], a[68:71], v[172:175]
ds_read_b64_tr_b16 a[100:101], v12 offset:8448
v_mfma_f32_16x16x32_bf16 v[172:175], a[104:107], a[48:51], v[172:175]
ds_read_b64_tr_b16 a[102:103], v12 offset:9472
v_mfma_f32_16x16x32_bf16 v[164:167], a[104:107], a[44:47], v[164:167]
ds_write_b128 v4, v[200:203] offset:18432
v_cvt_pk_bf16_f32 v252, v252, v253
v_mfma_f32_16x16x32_bf16 v[164:167], a[108:111], a[64:67], v[164:167]
v_cvt_pk_bf16_f32 v253, v254, v255
v_cvt_pk_bf16_f32 v219, v218, v219
v_mfma_f32_16x16x32_bf16 v[156:159], a[108:111], a[60:63], v[156:159]
v_cvt_pk_bf16_f32 v218, v216, v217
v_cvt_pk_bf16_f32 v223, v222, v223
v_mfma_f32_16x16x32_bf16 v[156:159], a[104:107], a[40:43], v[156:159]
s_waitcnt lgkmcnt(4)
v_cvt_pk_bf16_f32 v222, v220, v221
v_cvt_pk_bf16_f32 v227, v226, v227
v_mfma_f32_16x16x32_bf16 v[24:27], a[80:83], a[40:43], v[24:27]
ds_read_b64_tr_b16 a[104:105], v13 offset:256
v_cvt_pk_bf16_f32 v226, v224, v225
v_cvt_pk_bf16_f32 v231, v230, v231
v_mfma_f32_16x16x32_bf16 v[24:27], a[84:87], a[60:63], v[24:27]
ds_read_b64_tr_b16 a[106:107], v13 offset:1280
v_cvt_pk_bf16_f32 v230, v228, v229
v_mfma_f32_16x16x32_bf16 v[32:35], a[84:87], a[64:67], v[32:35]
ds_read_b64_tr_b16 a[108:109], v13 offset:8448
v_cvt_pk_bf16_f32 v235, v234, v235
v_mfma_f32_16x16x32_bf16 v[32:35], a[80:83], a[44:47], v[32:35]
ds_read_b64_tr_b16 a[110:111], v13 offset:9472
v_cvt_pk_bf16_f32 v234, v232, v233
v_mfma_f32_16x16x32_bf16 v[40:43], a[80:83], a[48:51], v[40:43]
v_cvt_pk_bf16_f32 v239, v238, v239
v_cvt_pk_bf16_f32 v238, v236, v237
v_cvt_pk_bf16_f32 v243, v242, v243
v_mfma_f32_16x16x32_bf16 v[40:43], a[84:87], a[68:71], v[40:43]
v_cvt_pk_bf16_f32 v242, v240, v241
v_cvt_pk_bf16_f32 v247, v246, v247
v_mfma_f32_16x16x32_bf16 v[48:51], a[84:87], a[72:75], v[48:51]
v_cvt_pk_bf16_f32 v246, v244, v245
v_mfma_f32_16x16x32_bf16 v[48:51], a[80:83], a[52:55], v[48:51]
ds_write_b64 v22, v[252:253] offset:1024
v_mfma_f32_16x16x32_bf16 v[52:55], a[88:91], a[52:55], v[52:55]
ds_read_b64_tr_b16 a[80:81], v12 offset:512
v_mfma_f32_16x16x32_bf16 v[52:55], a[92:95], a[72:75], v[52:55]
ds_read_b64_tr_b16 a[82:83], v12 offset:1536
v_mfma_f32_16x16x32_bf16 v[44:47], a[92:95], a[68:71], v[44:47]
ds_read_b64_tr_b16 a[84:85], v12 offset:8704
v_mfma_f32_16x16x32_bf16 v[44:47], a[88:91], a[48:51], v[44:47]
ds_read_b64_tr_b16 a[86:87], v12 offset:9728
v_mfma_f32_16x16x32_bf16 v[36:39], a[88:91], a[44:47], v[36:39]
ds_write_b64 v5, v[226:227] offset:3072
v_mfma_f32_16x16x32_bf16 v[36:39], a[92:95], a[64:67], v[36:39]
ds_write_b64 v5, v[230:231] offset:3080
v_mfma_f32_16x16x32_bf16 v[28:31], a[92:95], a[60:63], v[28:31]
ds_write_b64 v5, v[242:243] offset:19456
v_mfma_f32_16x16x32_bf16 v[28:31], a[88:91], a[40:43], v[28:31]
s_waitcnt lgkmcnt(4)
v_mfma_f32_16x16x32_bf16 v[56:59], a[96:99], a[40:43], v[56:59]
ds_read_b64_tr_b16 a[88:89], v13 offset:512
v_mfma_f32_16x16x32_bf16 v[56:59], a[100:103], a[60:63], v[56:59]
ds_read_b64_tr_b16 a[90:91], v13 offset:1536
v_mfma_f32_16x16x32_bf16 v[64:67], a[100:103], a[64:67], v[64:67]
ds_read_b64_tr_b16 a[92:93], v13 offset:8704
v_mfma_f32_16x16x32_bf16 v[64:67], a[96:99], a[44:47], v[64:67]
ds_read_b64_tr_b16 a[94:95], v13 offset:9728
v_mfma_f32_16x16x32_bf16 v[72:75], a[96:99], a[48:51], v[72:75]
ds_write_b64 v5, v[246:247] offset:19464
v_mfma_f32_16x16x32_bf16 v[72:75], a[100:103], a[68:71], v[72:75]
ds_write_b64 v4, v[218:219] offset:3072
v_mfma_f32_16x16x32_bf16 v[80:83], a[100:103], a[72:75], v[80:83]
ds_write_b64 v4, v[222:223] offset:3080
v_mfma_f32_16x16x32_bf16 v[80:83], a[96:99], a[52:55], v[80:83]
ds_write_b64 v4, v[234:235] offset:19456
v_mfma_f32_16x16x32_bf16 v[84:87], a[104:107], a[52:55], v[84:87]
ds_read_b64_tr_b16 a[96:97], v12 offset:768
v_mfma_f32_16x16x32_bf16 v[84:87], a[108:111], a[72:75], v[84:87]
ds_read_b64_tr_b16 a[98:99], v12 offset:1792
v_mfma_f32_16x16x32_bf16 v[76:79], a[108:111], a[68:71], v[76:79]
ds_read_b64_tr_b16 a[100:101], v12 offset:8960
v_mfma_f32_16x16x32_bf16 v[76:79], a[104:107], a[48:51], v[76:79]
ds_read_b64_tr_b16 a[102:103], v12 offset:9984
v_mfma_f32_16x16x32_bf16 v[68:71], a[104:107], a[44:47], v[68:71]
ds_write_b64 v4, v[238:239] offset:19464
v_cvt_pk_bf16_f32 v152, v152, v153
v_mfma_f32_16x16x32_bf16 v[68:71], a[108:111], a[64:67], v[68:71]
v_cvt_pk_bf16_f32 v153, v154, v155
v_cvt_pk_bf16_f32 v154, v156, v157
v_mfma_f32_16x16x32_bf16 v[60:63], a[108:111], a[60:63], v[60:63]
v_cvt_pk_bf16_f32 v155, v158, v159
v_cvt_pk_bf16_f32 v160, v160, v161
v_mfma_f32_16x16x32_bf16 v[60:63], a[104:107], a[40:43], v[60:63]
s_waitcnt lgkmcnt(4)
v_cvt_pk_bf16_f32 v161, v162, v163
v_cvt_pk_bf16_f32 v162, v164, v165
v_mfma_f32_16x16x32_bf16 v[88:91], a[80:83], a[40:43], v[88:91]
ds_read_b64_tr_b16 a[104:105], v13 offset:768
v_cvt_pk_bf16_f32 v163, v166, v167
v_cvt_pk_bf16_f32 v168, v168, v169
v_mfma_f32_16x16x32_bf16 v[88:91], a[84:87], a[60:63], v[88:91]
ds_read_b64_tr_b16 a[106:107], v13 offset:1792
v_cvt_pk_bf16_f32 v169, v170, v171
v_mfma_f32_16x16x32_bf16 v[96:99], a[84:87], a[64:67], v[96:99]
ds_read_b64_tr_b16 a[108:109], v13 offset:8960
v_cvt_pk_bf16_f32 v170, v172, v173
v_mfma_f32_16x16x32_bf16 v[96:99], a[80:83], a[44:47], v[96:99]
ds_read_b64_tr_b16 a[110:111], v13 offset:9984
v_cvt_pk_bf16_f32 v171, v174, v175
v_mfma_f32_16x16x32_bf16 v[104:107], a[80:83], a[48:51], v[104:107]
v_cvt_pk_bf16_f32 v176, v176, v177
v_cvt_pk_bf16_f32 v177, v178, v179
v_cvt_pk_bf16_f32 v178, v180, v181
v_mfma_f32_16x16x32_bf16 v[104:107], a[84:87], a[68:71], v[104:107]
v_cvt_pk_bf16_f32 v179, v182, v183
v_mfma_f32_16x16x32_bf16 v[112:115], a[84:87], a[72:75], v[112:115]
v_mfma_f32_16x16x32_bf16 v[112:115], a[80:83], a[52:55], v[112:115]
v_mfma_f32_16x16x32_bf16 v[116:119], a[88:91], a[52:55], v[116:119]
v_mfma_f32_16x16x32_bf16 v[116:119], a[92:95], a[72:75], v[116:119]
v_mfma_f32_16x16x32_bf16 v[108:111], a[92:95], a[68:71], v[108:111]
v_mfma_f32_16x16x32_bf16 v[108:111], a[88:91], a[48:51], v[108:111]
v_mov_b32 v15, s6
v_writelane_b32 v15, s18, 0
v_mfma_f32_16x16x32_bf16 v[100:103], a[88:91], a[44:47], v[100:103]
v_lshlrev_b32 v15, 2, v15
v_bfe_u32 v12, v0, 2, 2
v_lshlrev_b32 v12, 11, v12
v_mfma_f32_16x16x32_bf16 v[100:103], a[92:95], a[64:67], v[100:103]
v_lshrrev_b32 v13, 4, v0
v_lshl_add_u32 v12, v13, 6, v12
v_mfma_f32_16x16x32_bf16 v[92:95], a[92:95], a[60:63], v[92:95]
v_and_b32 v13, 3, v0
v_lshl_add_u32 v12, v13, 4, v12
v_mfma_f32_16x16x32_bf16 v[92:95], a[88:91], a[40:43], v[92:95]
s_waitcnt lgkmcnt(0)
v_xor_b32 v12, s13, v12
v_xor_b32 v13, 32, v12
v_mfma_f32_16x16x32_bf16 v[120:123], a[96:99], a[40:43], v[120:123]
v_add_u32 v13, 7168, v13
v_mul_f32 v24, s52, v24
v_mul_f32 v25, s52, v25
v_mfma_f32_16x16x32_bf16 v[120:123], a[100:103], a[60:63], v[120:123]
v_mul_f32 v26, s52, v26
v_mul_f32 v27, s52, v27
v_mfma_f32_16x16x32_bf16 v[128:131], a[100:103], a[64:67], v[128:131]
v_mul_f32 v28, s52, v28
v_mul_f32 v29, s52, v29
v_mfma_f32_16x16x32_bf16 v[128:131], a[96:99], a[44:47], v[128:131]
v_mul_f32 v30, s52, v30
v_mul_f32 v31, s52, v31
v_mfma_f32_16x16x32_bf16 v[136:139], a[96:99], a[48:51], v[136:139]
v_cvt_pk_bf16_f32 v24, v24, v25
v_cvt_pk_bf16_f32 v25, v26, v27
v_cvt_pk_bf16_f32 v26, v28, v29
v_mfma_f32_16x16x32_bf16 v[136:139], a[100:103], a[68:71], v[136:139]
v_cvt_pk_bf16_f32 v27, v30, v31
v_accvgpr_write_b32 a160, v24
v_mfma_f32_16x16x32_bf16 v[144:147], a[100:103], a[72:75], v[144:147]
v_accvgpr_write_b32 a161, v25
v_accvgpr_write_b32 a162, v26
v_mfma_f32_16x16x32_bf16 v[144:147], a[96:99], a[52:55], v[144:147]
v_accvgpr_write_b32 a163, v27
v_mul_f32 v32, s52, v32
v_mfma_f32_16x16x32_bf16 v[148:151], a[104:107], a[52:55], v[148:151]
v_mul_f32 v33, s52, v33
v_mul_f32 v34, s52, v34
v_mul_f32 v35, s52, v35
v_mfma_f32_16x16x32_bf16 v[148:151], a[108:111], a[72:75], v[148:151]
v_mul_f32 v36, s52, v36
v_mul_f32 v37, s52, v37
v_mfma_f32_16x16x32_bf16 v[140:143], a[108:111], a[68:71], v[140:143]
v_mul_f32 v38, s52, v38
v_mul_f32 v39, s52, v39
v_mfma_f32_16x16x32_bf16 v[140:143], a[104:107], a[48:51], v[140:143]
v_cvt_pk_bf16_f32 v32, v32, v33
v_cvt_pk_bf16_f32 v33, v34, v35
v_mfma_f32_16x16x32_bf16 v[132:135], a[104:107], a[44:47], v[132:135]
v_cvt_pk_bf16_f32 v34, v36, v37
v_cvt_pk_bf16_f32 v35, v38, v39
v_accvgpr_write_b32 a176, v32
v_mfma_f32_16x16x32_bf16 v[132:135], a[108:111], a[64:67], v[132:135]
v_accvgpr_write_b32 a177, v33
v_accvgpr_write_b32 a178, v34
v_mfma_f32_16x16x32_bf16 v[124:127], a[108:111], a[60:63], v[124:127]
v_accvgpr_write_b32 a179, v35
v_mfma_f32_16x16x32_bf16 v[124:127], a[104:107], a[40:43], v[124:127]
L_trans:
s_waitcnt vmcnt(21) lgkmcnt(0)
s_barrier
ds_read_b64 v[188:189], v4 offset:8
ds_read_b64 v[190:191], v4 offset:0
ds_read_b64 v[216:217], v4 offset:1032
ds_read_b64 v[220:221], v4 offset:1024
ds_read_b64 v[196:197], v6 offset:0
ds_read_b64 v[198:199], v7 offset:0
ds_read_b64 v[224:225], v6 offset:1024
ds_read_b64 v[228:229], v7 offset:1024
ds_read_b64 v[204:205], v4 offset:16392
ds_read_b64 v[206:207], v4 offset:16384
ds_read_b64 v[232:233], v4 offset:17416
ds_read_b64 v[236:237], v4 offset:17408
ds_read_b64 v[212:213], v6 offset:16384
ds_read_b64 v[214:215], v7 offset:16384
ds_read_b64 v[240:241], v6 offset:17408
ds_read_b64 v[244:245], v7 offset:17408
ds_read_b128 a[0:3], v1 offset:8192
ds_read_b128 a[4:7], v1 offset:9216
ds_read_b128 a[8:11], v1 offset:10240
ds_read_b128 a[12:15], v1 offset:11264
ds_read_b128 a[16:19], v1 offset:12288
ds_read_b128 a[20:23], v1 offset:13312
ds_read_b128 a[24:27], v1 offset:14336
ds_read_b128 a[28:31], v1 offset:15360
L_hopB:
s_mov_b32 s95, 0
v_pk_mul_f32 v[40:41], v[40:41], s[52:53]
v_pk_mul_f32 v[42:43], v[42:43], s[52:53]
v_pk_mul_f32 v[44:45], v[44:45], s[52:53]
v_pk_mul_f32 v[46:47], v[46:47], s[52:53]
v_cvt_pk_bf16_f32 v40, v40, v41
v_cvt_pk_bf16_f32 v41, v42, v43
v_cvt_pk_bf16_f32 v42, v44, v45
v_cvt_pk_bf16_f32 v43, v46, v47
v_accvgpr_write_b32 a192, v40
v_accvgpr_write_b32 a193, v41
v_accvgpr_write_b32 a194, v42
v_accvgpr_write_b32 a195, v43
v_pk_mul_f32 v[48:49], v[48:49], s[52:53]
v_pk_mul_f32 v[50:51], v[50:51], s[52:53]
v_pk_mul_f32 v[52:53], v[52:53], s[52:53]
v_pk_mul_f32 v[54:55], v[54:55], s[52:53]
v_cvt_pk_bf16_f32 v48, v48, v49
v_cvt_pk_bf16_f32 v49, v50, v51
v_cvt_pk_bf16_f32 v50, v52, v53
v_cvt_pk_bf16_f32 v51, v54, v55
v_accvgpr_write_b32 a208, v48
v_accvgpr_write_b32 a209, v49
v_accvgpr_write_b32 a210, v50
v_accvgpr_write_b32 a211, v51
v_mov_b32 v47, s55
v_cndmask_b32 v36, v9, 0, s[56:57]
v_cndmask_b32 v40, v9, 0, s[68:69]
v_min_f32 v32, s55, v36
v_cndmask_b32 v44, v47, 0, s[36:37]
v_cndmask_b32 v37, v9, 0, s[58:59]
v_cndmask_b32 v41, v9, 0, s[70:71]
v_min_f32 v33, s55, v37
v_cndmask_b32 v45, v47, 0, s[38:39]
v_cndmask_b32 v38, v9, 0, s[60:61]
v_cndmask_b32 v42, v9, 0, s[76:77]
v_min_f32 v34, s55, v38
v_cndmask_b32 v46, v47, 0, s[40:41]
v_cndmask_b32 v39, v9, 0, s[62:63]
v_cndmask_b32 v43, v9, 0, s[78:79]
v_min_f32 v35, s55, v39
v_cndmask_b32 v47, v47, 0, s[42:43]
v_pk_mul_f32 v[56:57], v[56:57], s[52:53]
v_pk_mul_f32 v[58:59], v[58:59], s[52:53]
v_pk_mul_f32 v[60:61], v[60:61], s[52:53]
v_pk_mul_f32 v[62:63], v[62:63], s[52:53]
v_cvt_pk_bf16_f32 v56, v56, v57
v_cvt_pk_bf16_f32 v57, v58, v59
v_cvt_pk_bf16_f32 v58, v60, v61
v_cvt_pk_bf16_f32 v59, v62, v63
v_accvgpr_write_b32 a164, v56
v_accvgpr_write_b32 a165, v57
v_accvgpr_write_b32 a166, v58
v_accvgpr_write_b32 a167, v59
v_pk_mul_f32 v[64:65], v[64:65], s[52:53]
v_pk_mul_f32 v[66:67], v[66:67], s[52:53]
v_pk_mul_f32 v[68:69], v[68:69], s[52:53]
v_pk_mul_f32 v[70:71], v[70:71], s[52:53]
v_cvt_pk_bf16_f32 v64, v64, v65
v_cvt_pk_bf16_f32 v65, v66, v67
v_cvt_pk_bf16_f32 v66, v68, v69
v_cvt_pk_bf16_f32 v67, v70, v71
v_accvgpr_write_b32 a180, v64
v_accvgpr_write_b32 a181, v65
v_accvgpr_write_b32 a182, v66
v_accvgpr_write_b32 a183, v67
v_pk_mul_f32 v[72:73], v[72:73], s[52:53]
v_pk_mul_f32 v[74:75], v[74:75], s[52:53]
v_pk_mul_f32 v[76:77], v[76:77], s[52:53]
v_pk_mul_f32 v[78:79], v[78:79], s[52:53]
v_cvt_pk_bf16_f32 v72, v72, v73
v_cvt_pk_bf16_f32 v73, v74, v75
v_cvt_pk_bf16_f32 v74, v76, v77
v_cvt_pk_bf16_f32 v75, v78, v79
v_accvgpr_write_b32 a196, v72
v_accvgpr_write_b32 a197, v73
v_accvgpr_write_b32 a198, v74
v_accvgpr_write_b32 a199, v75
v_pk_mul_f32 v[80:81], v[80:81], s[52:53]
v_pk_mul_f32 v[82:83], v[82:83], s[52:53]
v_pk_mul_f32 v[84:85], v[84:85], s[52:53]
v_pk_mul_f32 v[86:87], v[86:87], s[52:53]
v_cvt_pk_bf16_f32 v80, v80, v81
v_cvt_pk_bf16_f32 v81, v82, v83
v_cvt_pk_bf16_f32 v82, v84, v85
v_cvt_pk_bf16_f32 v83, v86, v87
v_accvgpr_write_b32 a212, v80
v_accvgpr_write_b32 a213, v81
v_accvgpr_write_b32 a214, v82
v_accvgpr_write_b32 a215, v83
v_pk_mul_f32 v[88:89], v[88:89], s[52:53]
v_pk_mul_f32 v[90:91], v[90:91], s[52:53]
v_pk_mul_f32 v[92:93], v[92:93], s[52:53]
v_pk_mul_f32 v[94:95], v[94:95], s[52:53]
v_cvt_pk_bf16_f32 v88, v88, v89
v_cvt_pk_bf16_f32 v89, v90, v91
v_cvt_pk_bf16_f32 v90, v92, v93
v_cvt_pk_bf16_f32 v91, v94, v95
v_accvgpr_write_b32 a168, v88
v_accvgpr_write_b32 a169, v89
v_accvgpr_write_b32 a170, v90
v_accvgpr_write_b32 a171, v91
v_pk_mul_f32 v[96:97], v[96:97], s[52:53]
v_pk_mul_f32 v[98:99], v[98:99], s[52:53]
v_pk_mul_f32 v[100:101], v[100:101], s[52:53]
v_pk_mul_f32 v[102:103], v[102:103], s[52:53]
v_cvt_pk_bf16_f32 v96, v96, v97
v_cvt_pk_bf16_f32 v97, v98, v99
v_cvt_pk_bf16_f32 v98, v100, v101
v_cvt_pk_bf16_f32 v99, v102, v103
v_accvgpr_write_b32 a184, v96
v_accvgpr_write_b32 a185, v97
v_accvgpr_write_b32 a186, v98
v_accvgpr_write_b32 a187, v99
v_pk_mul_f32 v[104:105], v[104:105], s[52:53]
v_pk_mul_f32 v[106:107], v[106:107], s[52:53]
v_pk_mul_f32 v[108:109], v[108:109], s[52:53]
v_pk_mul_f32 v[110:111], v[110:111], s[52:53]
v_cvt_pk_bf16_f32 v104, v104, v105
v_cvt_pk_bf16_f32 v105, v106, v107
v_cvt_pk_bf16_f32 v106, v108, v109
v_cvt_pk_bf16_f32 v107, v110, v111
v_accvgpr_write_b32 a200, v104
v_accvgpr_write_b32 a201, v105
v_accvgpr_write_b32 a202, v106
v_accvgpr_write_b32 a203, v107
v_pk_mul_f32 v[112:113], v[112:113], s[52:53]
v_pk_mul_f32 v[114:115], v[114:115], s[52:53]
v_pk_mul_f32 v[116:117], v[116:117], s[52:53]
v_pk_mul_f32 v[118:119], v[118:119], s[52:53]
v_cvt_pk_bf16_f32 v112, v112, v113
v_cvt_pk_bf16_f32 v113, v114, v115
v_cvt_pk_bf16_f32 v114, v116, v117
v_cvt_pk_bf16_f32 v115, v118, v119
v_accvgpr_write_b32 a216, v112
v_accvgpr_write_b32 a217, v113
v_accvgpr_write_b32 a218, v114
v_accvgpr_write_b32 a219, v115
v_pk_mul_f32 v[120:121], v[120:121], s[52:53]
v_pk_mul_f32 v[122:123], v[122:123], s[52:53]
v_pk_mul_f32 v[124:125], v[124:125], s[52:53]
v_pk_mul_f32 v[126:127], v[126:127], s[52:53]
v_cvt_pk_bf16_f32 v120, v120, v121
v_cvt_pk_bf16_f32 v121, v122, v123
v_cvt_pk_bf16_f32 v122, v124, v125
v_cvt_pk_bf16_f32 v123, v126, v127
v_accvgpr_write_b32 a172, v120
v_accvgpr_write_b32 a173, v121
v_accvgpr_write_b32 a174, v122
v_accvgpr_write_b32 a175, v123
v_pk_mul_f32 v[128:129], v[128:129], s[52:53]
v_pk_mul_f32 v[130:131], v[130:131], s[52:53]
v_pk_mul_f32 v[132:133], v[132:133], s[52:53]
v_pk_mul_f32 v[134:135], v[134:135], s[52:53]
v_cvt_pk_bf16_f32 v128, v128, v129
v_cvt_pk_bf16_f32 v129, v130, v131
v_cvt_pk_bf16_f32 v130, v132, v133
v_cvt_pk_bf16_f32 v131, v134, v135
v_accvgpr_write_b32 a188, v128
v_accvgpr_write_b32 a189, v129
v_accvgpr_write_b32 a190, v130
v_accvgpr_write_b32 a191, v131
v_pk_mul_f32 v[136:137], v[136:137], s[52:53]
v_pk_mul_f32 v[138:139], v[138:139], s[52:53]
v_pk_mul_f32 v[140:141], v[140:141], s[52:53]
v_pk_mul_f32 v[142:143], v[142:143], s[52:53]
v_cvt_pk_bf16_f32 v136, v136, v137
v_cvt_pk_bf16_f32 v137, v138, v139
v_cvt_pk_bf16_f32 v138, v140, v141
v_cvt_pk_bf16_f32 v139, v142, v143
v_accvgpr_write_b32 a204, v136
v_accvgpr_write_b32 a205, v137
v_accvgpr_write_b32 a206, v138
v_accvgpr_write_b32 a207, v139
v_pk_mul_f32 v[144:145], v[144:145], s[52:53]
v_pk_mul_f32 v[146:147], v[146:147], s[52:53]
v_pk_mul_f32 v[148:149], v[148:149], s[52:53]
v_pk_mul_f32 v[150:151], v[150:151], s[52:53]
v_cvt_pk_bf16_f32 v144, v144, v145
v_cvt_pk_bf16_f32 v145, v146, v147
v_cvt_pk_bf16_f32 v146, v148, v149
v_cvt_pk_bf16_f32 v147, v150, v151
v_accvgpr_write_b32 a220, v144
v_accvgpr_write_b32 a221, v145
v_accvgpr_write_b32 a222, v146
v_accvgpr_write_b32 a223, v147
s_waitcnt lgkmcnt(0)
s_barrier
v_mfma_f32_16x16x32_bf16 v[52:55], v[184:187], v[152:155], v[40:43]
v_mov_b32 v140, 0
v_mov_b32 v141, 0
v_mfma_f32_16x16x32_bf16 v[48:51], v[188:191], v[152:155], v[32:35]
v_mov_b32 v142, 0
v_mov_b32 v143, 0
v_mfma_f32_16x16x32_bf16 v[60:63], v[192:195], v[160:163], v[40:43]
v_mov_b32 v144, 0
v_mov_b32 v145, 0
v_mfma_f32_16x16x32_bf16 v[56:59], v[196:199], v[160:163], v[36:39]
v_mov_b32 v146, 0
v_mov_b32 v147, 0
v_mfma_f32_16x16x32_bf16 v[68:71], v[200:203], v[168:171], v[40:43]
v_mov_b32 v148, 0
v_mov_b32 v149, 0
v_mfma_f32_16x16x32_bf16 v[64:67], v[204:207], v[168:171], v[36:39]
v_max3_f32 v136, v48, v49, v50
v_max3_f32 v136, v136, v51, v52
v_mfma_f32_16x16x32_bf16 v[76:79], v[208:211], v[176:179], v[40:43]
v_max3_f32 v136, v136, v53, v54
v_max_f32 v136, v136, v55
v_mfma_f32_16x16x32_bf16 v[72:75], v[212:215], v[176:179], v[36:39]
v_max3_f32 v137, v56, v57, v58
v_max3_f32 v137, v137, v59, v60
v_mfma_f32_16x16x32_bf16 v[16:19], a[0:3], a[160:163], v[44:47]
v_max3_f32 v137, v137, v61, v62
v_max_f32 v137, v137, v63
v_mfma_f32_16x16x32_bf16 v[16:19], a[4:7], a[164:167], v[16:19]
v_max3_f32 v138, v64, v65, v66
v_max3_f32 v138, v138, v67, v68
v_mfma_f32_16x16x32_bf16 v[16:19], a[8:11], a[168:171], v[16:19]
v_max3_f32 v138, v138, v69, v70
v_max_f32 v138, v138, v71
v_mfma_f32_16x16x32_bf16 v[16:19], a[12:15], a[172:175], v[16:19]
v_max3_f32 v139, v72, v73, v74
v_max3_f32 v139, v139, v75, v76
v_mfma_f32_16x16x32_bf16 v[20:23], a[0:3], a[176:179], 0
v_max3_f32 v139, v139, v77, v78
v_max_f32 v139, v139, v79
v_mfma_f32_16x16x32_bf16 v[20:23], a[4:7], a[180:183], v[20:23]
v_mov_b32 v150, 0
v_mov_b32 v151, 0
v_mfma_f32_16x16x32_bf16 v[20:23], a[8:11], a[184:187], v[20:23]
v_mov_b32 v248, 0
v_mov_b32 v249, 0
v_mfma_f32_16x16x32_bf16 v[20:23], a[12:15], a[188:191], v[20:23]
v_mov_b32 v250, 0
v_mov_b32 v251, 0
v_mfma_f32_16x16x32_bf16 v[24:27], a[0:3], a[192:195], 0
v_mov_b32 v252, 0
v_mov_b32 v253, 0
v_mfma_f32_16x16x32_bf16 v[24:27], a[4:7], a[196:199], v[24:27]
v_mov_b32 v254, 0
v_mov_b32 v255, 0
v_mfma_f32_16x16x32_bf16 v[24:27], a[8:11], a[200:203], v[24:27]
v_max3_f32 v80, v16, v17, v18
v_max_f32 v80, v80, v19
v_mfma_f32_16x16x32_bf16 v[24:27], a[12:15], a[204:207], v[24:27]
v_max3_f32 v84, v20, v21, v22
v_max_f32 v84, v84, v23
v_mfma_f32_16x16x32_bf16 v[28:31], a[0:3], a[208:211], 0
v_mov_b32 v128, v136
v_mov_b32 v129, v137
v_mfma_f32_16x16x32_bf16 v[28:31], a[4:7], a[212:215], v[28:31]
v_mov_b32 v130, v138
v_mov_b32 v131, v139
v_mfma_f32_16x16x32_bf16 v[28:31], a[8:11], a[216:219], v[28:31]
v_permlane16_swap_b32 v128, v136
v_permlane16_swap_b32 v129, v137
v_mfma_f32_16x16x32_bf16 v[28:31], a[12:15], a[220:223], v[28:31]
v_permlane16_swap_b32 v130, v138
v_permlane16_swap_b32 v131, v139
v_max_f32 v136, v136, v128
v_max_f32 v137, v137, v129
v_max_f32 v138, v138, v130
v_max_f32 v139, v139, v131
v_max3_f32 v88, v24, v25, v26
v_max_f32 v88, v88, v27
v_mov_b32 v128, v136
v_mov_b32 v129, v137
v_mov_b32 v130, v138
v_mov_b32 v131, v139
v_max3_f32 v92, v28, v29, v30
v_max_f32 v92, v92, v31
v_permlane32_swap_b32 v128, v136
v_permlane32_swap_b32 v129, v137
v_permlane32_swap_b32 v130, v138
v_permlane32_swap_b32 v131, v139
v_max_f32 v136, v136, v128
v_max_f32 v137, v137, v129
v_max_f32 v138, v138, v130
v_max_f32 v139, v139, v131
v_mul_f32 v136, s54, v136
v_mul_f32 v137, s54, v137
v_mul_f32 v138, s54, v138
v_mul_f32 v139, s54, v139
v_fma_f32 v48, v48, s54, -v136
v_fma_f32 v49, v49, s54, -v136
v_fma_f32 v50, v50, s54, -v136
v_fma_f32 v51, v51, s54, -v136
v_fma_f32 v52, v52, s54, -v136
v_fma_f32 v53, v53, s54, -v136
v_fma_f32 v54, v54, s54, -v136
v_fma_f32 v55, v55, s54, -v136
v_exp_f32 v48, v48
v_exp_f32 v49, v49
v_exp_f32 v50, v50
v_exp_f32 v51, v51
v_exp_f32 v52, v52
v_exp_f32 v53, v53
v_exp_f32 v54, v54
v_exp_f32 v55, v55
v_fma_f32 v56, v56, s54, -v137
v_fma_f32 v57, v57, s54, -v137
v_fma_f32 v58, v58, s54, -v137
v_fma_f32 v59, v59, s54, -v137
v_fma_f32 v60, v60, s54, -v137
v_fma_f32 v61, v61, s54, -v137
v_fma_f32 v62, v62, s54, -v137
v_fma_f32 v63, v63, s54, -v137
v_exp_f32 v56, v56
v_exp_f32 v57, v57
v_exp_f32 v58, v58
v_exp_f32 v59, v59
v_exp_f32 v60, v60
v_exp_f32 v61, v61
v_exp_f32 v62, v62
v_exp_f32 v63, v63
v_fma_f32 v64, v64, s54, -v138
v_fma_f32 v65, v65, s54, -v138
v_fma_f32 v66, v66, s54, -v138
v_fma_f32 v67, v67, s54, -v138
v_fma_f32 v68, v68, s54, -v138
v_fma_f32 v69, v69, s54, -v138
v_fma_f32 v70, v70, s54, -v138
v_fma_f32 v71, v71, s54, -v138
v_exp_f32 v64, v64
L_padA13:
s_cmp_eq_u32 s95, 1
s_cbranch_scc1 L_hopA_ret
v_exp_f32 v65, v65
v_exp_f32 v66, v66
v_exp_f32 v67, v67
v_exp_f32 v68, v68
v_exp_f32 v69, v69
v_exp_f32 v70, v70
v_exp_f32 v71, v71
v_fma_f32 v72, v72, s54, -v139
v_fma_f32 v73, v73, s54, -v139
v_fma_f32 v74, v74, s54, -v139
v_fma_f32 v75, v75, s54, -v139
v_fma_f32 v76, v76, s54, -v139
v_fma_f32 v77, v77, s54, -v139
v_fma_f32 v78, v78, s54, -v139
v_fma_f32 v79, v79, s54, -v139
v_exp_f32 v72, v72
v_exp_f32 v73, v73
v_exp_f32 v74, v74
v_exp_f32 v75, v75
v_exp_f32 v76, v76
v_exp_f32 v77, v77
v_exp_f32 v78, v78
v_exp_f32 v79, v79
v_cvt_pk_bf16_f32 v48, v48, v49
v_cvt_pk_bf16_f32 v49, v50, v51
v_cvt_pk_bf16_f32 v50, v52, v53
v_cvt_pk_bf16_f32 v51, v54, v55
v_cvt_pk_bf16_f32 v56, v56, v57
v_cvt_pk_bf16_f32 v57, v58, v59
v_cvt_pk_bf16_f32 v58, v60, v61
v_cvt_pk_bf16_f32 v59, v62, v63
v_cvt_pk_bf16_f32 v64, v64, v65
v_cvt_pk_bf16_f32 v65, v66, v67
v_cvt_pk_bf16_f32 v66, v68, v69
v_cvt_pk_bf16_f32 v67, v70, v71
v_cvt_pk_bf16_f32 v72, v72, v73
v_cvt_pk_bf16_f32 v73, v74, v75
v_cvt_pk_bf16_f32 v74, v76, v77
v_cvt_pk_bf16_f32 v75, v78, v79
v_mfma_f32_16x16x32_bf16 v[156:159], a[240:243], v[48:51], 0
v_mov_b32 v128, v80
v_mov_b32 v129, v84
v_mfma_f32_16x16x32_bf16 v[164:167], a[240:243], v[56:59], 0
v_mov_b32 v130, v88
v_mov_b32 v131, v92
v_mfma_f32_16x16x32_bf16 v[172:175], a[240:243], v[64:67], 0
v_permlane16_swap_b32 v128, v80
v_permlane16_swap_b32 v129, v84
v_mfma_f32_16x16x32_bf16 v[180:183], a[240:243], v[72:75], 0
v_permlane16_swap_b32 v130, v88
v_permlane16_swap_b32 v131, v92
v_mfma_f32_16x16x32_bf16 v[184:187], v[216:219], v[48:51], 0
v_max_f32 v80, v80, v128
v_max_f32 v84, v84, v129
v_mfma_f32_16x16x32_bf16 v[188:191], v[220:223], v[48:51], 0
v_max_f32 v88, v88, v130
v_max_f32 v92, v92, v131
v_mfma_f32_16x16x32_bf16 v[192:195], v[224:227], v[56:59], 0
v_mov_b32 v128, v80
v_mov_b32 v129, v84
v_mfma_f32_16x16x32_bf16 v[196:199], v[228:231], v[56:59], 0
v_mov_b32 v130, v88
v_mov_b32 v131, v92
v_mfma_f32_16x16x32_bf16 v[200:203], v[232:235], v[64:67], 0
v_permlane32_swap_b32 v128, v80
v_permlane32_swap_b32 v129, v84
v_mfma_f32_16x16x32_bf16 v[204:207], v[236:239], v[64:67], 0
v_permlane32_swap_b32 v130, v88
v_permlane32_swap_b32 v131, v92
v_mfma_f32_16x16x32_bf16 v[208:211], v[240:243], v[72:75], 0
v_max_f32 v80, v80, v128
v_max_f32 v84, v84, v129
v_mfma_f32_16x16x32_bf16 v[212:215], v[244:247], v[72:75], 0
v_max_f32 v88, v88, v130
v_max_f32 v92, v92, v131
v_rcp_f32 v128, v156
v_rcp_f32 v130, v164
v_rcp_f32 v132, v172
v_rcp_f32 v134, v180
v_sub_f32 v83, 0, v80
v_sub_f32 v82, 0, v80
v_sub_f32 v81, 0, v80
v_sub_f32 v80, 0, v80
v_min_f32 v103, s8, v80
v_cndmask_b32 v96, v103, v80, s[36:37]
v_cndmask_b32 v97, v103, v80, s[38:39]
v_cndmask_b32 v98, v103, v80, s[40:41]
v_cndmask_b32 v99, v103, v80, s[42:43]
v_cndmask_b32 v100, v9, v103, s[36:37]
v_cndmask_b32 v101, v9, v103, s[38:39]
v_cndmask_b32 v102, v9, v103, s[40:41]
v_cndmask_b32 v103, v9, v103, s[42:43]
v_pk_mul_f32 v[184:185], v[184:185], v[128:129] op_sel_hi:[1,0]
v_pk_mul_f32 v[186:187], v[186:187], v[128:129] op_sel_hi:[1,0]
v_pk_mul_f32 v[188:189], v[188:189], v[128:129] op_sel_hi:[1,0]
v_pk_mul_f32 v[190:191], v[190:191], v[128:129] op_sel_hi:[1,0]
v_pk_mul_f32 v[192:193], v[192:193], v[130:131] op_sel_hi:[1,0]
v_pk_mul_f32 v[194:195], v[194:195], v[130:131] op_sel_hi:[1,0]
v_pk_mul_f32 v[196:197], v[196:197], v[130:131] op_sel_hi:[1,0]
v_pk_mul_f32 v[198:199], v[198:199], v[130:131] op_sel_hi:[1,0]
v_pk_mul_f32 v[200:201], v[200:201], v[132:133] op_sel_hi:[1,0]
v_pk_mul_f32 v[202:203], v[202:203], v[132:133] op_sel_hi:[1,0]
v_pk_mul_f32 v[204:205], v[204:205], v[132:133] op_sel_hi:[1,0]
v_pk_mul_f32 v[206:207], v[206:207], v[132:133] op_sel_hi:[1,0]
v_pk_mul_f32 v[208:209], v[208:209], v[134:135] op_sel_hi:[1,0]
v_pk_mul_f32 v[210:211], v[210:211], v[134:135] op_sel_hi:[1,0]
v_pk_mul_f32 v[212:213], v[212:213], v[134:135] op_sel_hi:[1,0]
v_pk_mul_f32 v[214:215], v[214:215], v[134:135] op_sel_hi:[1,0]
s_bitcmp1_b32 s4, 0
s_cbranch_scc1 L_ob_odd
v_cvt_pk_bf16_f32 v32, v184, v185
v_cvt_pk_bf16_f32 v33, v186, v187
v_cvt_pk_bf16_f32 v34, v188, v189
v_cvt_pk_bf16_f32 v35, v190, v191
v_cvt_pk_bf16_f32 v36, v192, v193
v_cvt_pk_bf16_f32 v37, v194, v195
v_cvt_pk_bf16_f32 v38, v196, v197
v_cvt_pk_bf16_f32 v39, v198, v199
v_cvt_pk_bf16_f32 v40, v200, v201
v_cvt_pk_bf16_f32 v41, v202, v203
v_cvt_pk_bf16_f32 v42, v204, v205
v_cvt_pk_bf16_f32 v43, v206, v207
v_cvt_pk_bf16_f32 v44, v208, v209
v_cvt_pk_bf16_f32 v45, v210, v211
v_cvt_pk_bf16_f32 v46, v212, v213
v_cvt_pk_bf16_f32 v47, v214, v215
s_branch L_ob_packed
L_ob_odd:
v_cvt_pk_bf16_f32 v35, v186, v187
v_cvt_pk_bf16_f32 v34, v184, v185
v_cvt_pk_bf16_f32 v32, v188, v189
v_cvt_pk_bf16_f32 v33, v190, v191
v_cvt_pk_bf16_f32 v39, v194, v195
v_cvt_pk_bf16_f32 v38, v192, v193
v_cvt_pk_bf16_f32 v36, v196, v197
v_cvt_pk_bf16_f32 v37, v198, v199
v_cvt_pk_bf16_f32 v43, v202, v203
v_cvt_pk_bf16_f32 v42, v200, v201
v_cvt_pk_bf16_f32 v40, v204, v205
v_cvt_pk_bf16_f32 v41, v206, v207
v_cvt_pk_bf16_f32 v47, v210, v211
v_cvt_pk_bf16_f32 v46, v208, v209
v_cvt_pk_bf16_f32 v44, v212, v213
v_cvt_pk_bf16_f32 v45, v214, v215
L_ob_packed:
buffer_store_dwordx4 v[32:35], v3, s[88:91], s44 offen sc1
v_sub_f32 v87, 0, v84
v_sub_f32 v86, 0, v84
v_sub_f32 v85, 0, v84
v_sub_f32 v84, 0, v84
v_min_f32 v111, s9, v84
v_cndmask_b32 v104, v111, v84, s[36:37]
v_cndmask_b32 v105, v111, v84, s[38:39]
v_cndmask_b32 v106, v111, v84, s[40:41]
v_cndmask_b32 v107, v111, v84, s[42:43]
v_cndmask_b32 v108, v9, v111, s[36:37]
v_cndmask_b32 v109, v9, v111, s[38:39]
v_cndmask_b32 v110, v9, v111, s[40:41]
v_cndmask_b32 v111, v9, v111, s[42:43]
v_sub_f32 v91, 0, v88
v_sub_f32 v90, 0, v88
v_sub_f32 v89, 0, v88
v_sub_f32 v88, 0, v88
v_min_f32 v119, s8, v88
v_cndmask_b32 v112, v119, v88, s[36:37]
v_cndmask_b32 v113, v119, v88, s[38:39]
v_cndmask_b32 v114, v119, v88, s[40:41]
v_cndmask_b32 v115, v119, v88, s[42:43]
v_cndmask_b32 v116, v9, v119, s[36:37]
v_cndmask_b32 v117, v9, v119, s[38:39]
buffer_store_dwordx4 v[36:39], v3, s[88:91], s45 offen sc1
v_cndmask_b32 v118, v9, v119, s[40:41]
v_cndmask_b32 v119, v9, v119, s[42:43]
v_sub_f32 v95, 0, v92
v_sub_f32 v94, 0, v92
v_sub_f32 v93, 0, v92
v_sub_f32 v92, 0, v92
v_min_f32 v127, s9, v92
v_cndmask_b32 v120, v127, v92, s[36:37]
v_cndmask_b32 v121, v127, v92, s[38:39]
v_cndmask_b32 v122, v127, v92, s[40:41]
v_cndmask_b32 v123, v127, v92, s[42:43]
v_cndmask_b32 v124, v9, v127, s[36:37]
v_cndmask_b32 v125, v9, v127, s[38:39]
v_cndmask_b32 v126, v9, v127, s[40:41]
v_cndmask_b32 v127, v9, v127, s[42:43]
v_and_b32 v9, 1, v0
v_mul_u32_u24 v9, 0xaaaa, v9
v_add_u32 v9, 0x4444, v9
v_mov_b64 v[128:129], 0
v_mov_b64 v[130:131], 0
v_mov_b64 v[132:133], 0
v_mov_b64 v[134:135], 0
v_mov_b64 v[136:137], 0
v_mov_b64 v[138:139], 0
buffer_store_dwordx4 v[40:43], v3, s[88:91], s46 offen sc1
v_mov_b64 v[152:153], 0
v_mov_b64 v[154:155], 0
v_mov_b64 v[156:157], 0
v_mov_b64 v[158:159], 0
v_mov_b64 v[160:161], 0
v_mov_b64 v[162:163], 0
v_mov_b64 v[164:165], 0
v_mov_b64 v[166:167], 0
v_mov_b64 v[168:169], 0
v_mov_b64 v[170:171], 0
v_mov_b64 v[172:173], 0
v_mov_b64 v[174:175], 0
v_mov_b64 v[176:177], 0
v_mov_b64 v[178:179], 0
v_mov_b64 v[180:181], 0
v_mov_b64 v[182:183], 0
v_mov_b64 v[184:185], 0
v_mov_b64 v[186:187], 0
v_mov_b64 v[188:189], 0
v_mov_b64 v[190:191], 0
v_mov_b64 v[192:193], 0
v_mov_b64 v[194:195], 0
v_mov_b64 v[196:197], 0
v_mov_b64 v[198:199], 0
buffer_store_dwordx4 v[44:47], v3, s[88:91], s47 offen sc1
v_mov_b64 v[200:201], 0
v_mov_b64 v[202:203], 0
v_mov_b64 v[204:205], 0
v_mov_b64 v[206:207], 0
v_mov_b64 v[208:209], 0
v_mov_b64 v[210:211], 0
v_mov_b64 v[212:213], 0
v_mov_b64 v[214:215], 0
v_mov_b64 v[216:217], 0
v_mov_b64 v[218:219], 0
v_mov_b64 v[220:221], 0
v_mov_b64 v[222:223], 0
v_mov_b64 v[224:225], 0
v_mov_b64 v[226:227], 0
v_mov_b64 v[228:229], 0
v_mov_b64 v[230:231], 0
v_mov_b64 v[232:233], 0
v_mov_b64 v[234:235], 0
v_mov_b64 v[236:237], 0
v_mov_b64 v[238:239], 0
v_mov_b64 v[240:241], 0
v_mov_b64 v[242:243], 0
v_mov_b64 v[244:245], 0
v_mov_b64 v[246:247], 0
L_att_start:
s_mov_b32 s15, s6
s_cmp_eq_u32 s6, 0
s_cbranch_scc1 L_att_j0
v_mfma_f32_16x16x32_bf16 v[16:19], a[0:3], a[160:163], v[80:83]
v_mfma_f32_16x16x32_bf16 v[16:19], a[4:7], a[164:167], v[16:19]
v_mfma_f32_16x16x32_bf16 v[16:19], a[8:11], a[168:171], v[16:19]
s_add_u32 m0, s27, 0x0
v_mfma_f32_16x16x32_bf16 v[16:19], a[12:15], a[172:175], v[16:19]
buffer_load_dwordx4 v3, s[48:51], s32 offen offset:0 sc1 lds
v_mfma_f32_16x16x32_bf16 v[20:23], a[0:3], a[176:179], v[84:87]
v_mfma_f32_16x16x32_bf16 v[20:23], a[4:7], a[180:183], v[20:23]
v_mfma_f32_16x16x32_bf16 v[20:23], a[8:11], a[184:187], v[20:23]
v_mfma_f32_16x16x32_bf16 v[20:23], a[12:15], a[188:191], v[20:23]
s_nop 2
v_exp_f32 v16, v16
v_mfma_f32_16x16x32_bf16 v[24:27], a[0:3], a[192:195], v[88:91]
s_nop 0
v_exp_f32 v17, v17
v_mfma_f32_16x16x32_bf16 v[24:27], a[4:7], a[196:199], v[24:27]
v_exp_f32 v18, v18
v_mfma_f32_16x16x32_bf16 v[24:27], a[8:11], a[200:203], v[24:27]
buffer_load_dwordx4 v3, s[48:51], s32 offen offset:1024 sc1 lds
v_mfma_f32_16x16x32_bf16 v[24:27], a[12:15], a[204:207], v[24:27]
v_exp_f32 v19, v19
v_mfma_f32_16x16x32_bf16 v[28:31], a[0:3], a[208:211], v[92:95]
v_exp_f32 v20, v20
v_mfma_f32_16x16x32_bf16 v[28:31], a[4:7], a[212:215], v[28:31]
v_cvt_pk_bf16_f32 v48, v16, v17
v_cvt_pk_bf16_f32 v49, v18, v19
v_mfma_f32_16x16x32_bf16 v[28:31], a[8:11], a[216:219], v[28:31]
v_exp_f32 v21, v21
v_mfma_f32_16x16x32_bf16 v[28:31], a[12:15], a[220:223], v[28:31]
v_cvt_pk_bf16_f32 v52, v20, v21
v_mfma_f32_16x16x32_bf16 v[32:35], a[16:19], a[160:163], v[80:83]
v_exp_f32 v22, v22
v_mfma_f32_16x16x32_bf16 v[32:35], a[20:23], a[164:167], v[32:35]
v_mfma_f32_16x16x32_bf16 v[32:35], a[24:27], a[168:171], v[32:35]
buffer_load_dwordx4 v3, s[48:51], s32 offen offset:2048 sc1 lds
v_mfma_f32_16x16x32_bf16 v[32:35], a[28:31], a[172:175], v[32:35]
v_mfma_f32_16x16x32_bf16 v[36:39], a[16:19], a[176:179], v[84:87]
v_exp_f32 v23, v23
v_mfma_f32_16x16x32_bf16 v[36:39], a[20:23], a[180:183], v[36:39]
v_cvt_pk_bf16_f32 v53, v22, v23
v_mfma_f32_16x16x32_bf16 v[36:39], a[24:27], a[184:187], v[36:39]
v_exp_f32 v24, v24
v_mfma_f32_16x16x32_bf16 v[36:39], a[28:31], a[188:191], v[36:39]
v_mfma_f32_16x16x32_bf16 v[40:43], a[16:19], a[192:195], v[88:91]
v_exp_f32 v25, v25
v_mfma_f32_16x16x32_bf16 v[40:43], a[20:23], a[196:199], v[40:43]
buffer_load_dwordx4 v3, s[48:51], s32 offen offset:3072 sc1 lds
v_mfma_f32_16x16x32_bf16 v[40:43], a[24:27], a[200:203], v[40:43]
s_add_u32 s32, s32, 0x8000
v_mfma_f32_16x16x32_bf16 v[40:43], a[28:31], a[204:207], v[40:43]
v_mfma_f32_16x16x32_bf16 v[44:47], a[16:19], a[208:211], v[92:95]
v_exp_f32 v26, v26
v_mfma_f32_16x16x32_bf16 v[44:47], a[20:23], a[212:215], v[44:47]
v_mfma_f32_16x16x32_bf16 v[44:47], a[24:27], a[216:219], v[44:47]
v_exp_f32 v27, v27
v_mfma_f32_16x16x32_bf16 v[44:47], a[28:31], a[220:223], v[44:47]
s_waitcnt lgkmcnt(0)
ds_read_b128 a[0:3], v1 offset:24576
ds_read_b128 a[4:7], v1 offset:25600
ds_read_b128 a[8:11], v1 offset:26624
ds_read_b128 a[12:15], v1 offset:27648
ds_read_b128 a[16:19], v1 offset:28672
ds_read_b128 a[20:23], v1 offset:29696
ds_read_b128 a[24:27], v1 offset:30720
ds_read_b128 a[28:31], v1 offset:31744
s_waitcnt lgkmcnt(7)
v_mfma_f32_16x16x32_bf16 v[16:19], a[0:3], a[160:163], v[80:83]
ds_read_b128 a[32:35], v1 offset:16384
v_cvt_pk_bf16_f32 v56, v24, v25
s_waitcnt lgkmcnt(7)
v_mfma_f32_16x16x32_bf16 v[16:19], a[4:7], a[164:167], v[16:19]
v_exp_f32 v28, v28
s_waitcnt lgkmcnt(6)
v_mfma_f32_16x16x32_bf16 v[16:19], a[8:11], a[168:171], v[16:19]
s_add_u32 m0, s27, 0x1000
v_exp_f32 v29, v29
s_waitcnt lgkmcnt(5)
v_mfma_f32_16x16x32_bf16 v[16:19], a[12:15], a[172:175], v[16:19]
buffer_load_dwordx4 v3, s[48:51], s7 offen offset:0 sc1 lds
v_mfma_f32_16x16x32_bf16 v[20:23], a[0:3], a[176:179], v[84:87]
ds_read_b128 a[36:39], v1 offset:17408
v_cvt_pk_bf16_f32 v57, v26, v27
v_mfma_f32_16x16x32_bf16 v[20:23], a[4:7], a[180:183], v[20:23]
v_exp_f32 v30, v30
v_mfma_f32_16x16x32_bf16 v[20:23], a[8:11], a[184:187], v[20:23]
ds_read_b128 a[40:43], v1 offset:18432
v_cvt_pk_bf16_f32 v60, v28, v29
v_mfma_f32_16x16x32_bf16 v[20:23], a[12:15], a[188:191], v[20:23]
v_exp_f32 v31, v31
v_mfma_f32_16x16x32_bf16 v[24:27], a[0:3], a[192:195], v[88:91]
v_exp_f32 v32, v32
v_mfma_f32_16x16x32_bf16 v[24:27], a[4:7], a[196:199], v[24:27]
ds_read_b128 a[44:47], v1 offset:19456
v_cvt_pk_bf16_f32 v61, v30, v31
v_mfma_f32_16x16x32_bf16 v[24:27], a[8:11], a[200:203], v[24:27]
buffer_load_dwordx4 v3, s[48:51], s7 offen offset:1024 sc1 lds
v_mfma_f32_16x16x32_bf16 v[24:27], a[12:15], a[204:207], v[24:27]
v_exp_f32 v33, v33
v_mfma_f32_16x16x32_bf16 v[28:31], a[0:3], a[208:211], v[92:95]
v_exp_f32 v34, v34
v_mfma_f32_16x16x32_bf16 v[28:31], a[4:7], a[212:215], v[28:31]
ds_read_b128 a[48:51], v1 offset:20480
v_cvt_pk_bf16_f32 v50, v32, v33
v_mfma_f32_16x16x32_bf16 v[28:31], a[8:11], a[216:219], v[28:31]
v_exp_f32 v35, v35
v_mfma_f32_16x16x32_bf16 v[28:31], a[12:15], a[220:223], v[28:31]
v_exp_f32 v36, v36
v_cvt_pk_bf16_f32 v51, v34, v35
s_waitcnt lgkmcnt(8)
v_mfma_f32_16x16x32_bf16 v[32:35], a[16:19], a[160:163], v[80:83]
buffer_load_dwordx4 v3, s[48:51], s7 offen offset:2048 sc1 lds
s_waitcnt lgkmcnt(7)
v_mfma_f32_16x16x32_bf16 v[32:35], a[20:23], a[164:167], v[32:35]
ds_read_b128 a[52:55], v1 offset:21504
v_exp_f32 v37, v37
s_waitcnt lgkmcnt(7)
v_mfma_f32_16x16x32_bf16 v[32:35], a[24:27], a[168:171], v[32:35]
v_exp_f32 v38, v38
s_waitcnt lgkmcnt(6)
v_mfma_f32_16x16x32_bf16 v[32:35], a[28:31], a[172:175], v[32:35]
ds_read_b128 a[56:59], v1 offset:22528
v_cvt_pk_bf16_f32 v54, v36, v37
v_exp_f32 v39, v39
s_nop 0
v_cvt_pk_bf16_f32 v55, v38, v39
v_mfma_f32_16x16x32_bf16 v[36:39], a[16:19], a[176:179], v[84:87]
v_exp_f32 v40, v40
v_mfma_f32_16x16x32_bf16 v[36:39], a[20:23], a[180:183], v[36:39]
v_exp_f32 v41, v41
v_mfma_f32_16x16x32_bf16 v[36:39], a[24:27], a[184:187], v[36:39]
ds_read_b128 a[60:63], v1 offset:23552
v_xor_b32 v1, 0x8000, v1
v_mfma_f32_16x16x32_bf16 v[36:39], a[28:31], a[188:191], v[36:39]
buffer_load_dwordx4 v3, s[48:51], s7 offen offset:3072 sc1 lds
v_exp_f32 v42, v42
v_exp_f32 v43, v43
v_cvt_pk_bf16_f32 v58, v40, v41
v_cvt_pk_bf16_f32 v59, v42, v43
v_mfma_f32_16x16x32_bf16 v[40:43], a[16:19], a[192:195], v[88:91]
s_add_u32 s7, s7, 0x8000
v_exp_f32 v44, v44
v_mfma_f32_16x16x32_bf16 v[40:43], a[20:23], a[196:199], v[40:43]
s_xor_b32 s27, s27, 0x38000
v_exp_f32 v45, v45
v_mfma_f32_16x16x32_bf16 v[40:43], a[24:27], a[200:203], v[40:43]
v_exp_f32 v46, v46
v_mfma_f32_16x16x32_bf16 v[40:43], a[28:31], a[204:207], v[40:43]
v_exp_f32 v47, v47
v_cvt_pk_bf16_f32 v62, v44, v45
v_cvt_pk_bf16_f32 v63, v46, v47
v_mfma_f32_16x16x32_bf16 v[44:47], a[16:19], a[208:211], v[92:95]
v_exp_f32 v16, v16
v_mfma_f32_16x16x32_bf16 v[44:47], a[20:23], a[212:215], v[44:47]
v_exp_f32 v17, v17
v_mfma_f32_16x16x32_bf16 v[44:47], a[24:27], a[216:219], v[44:47]
s_waitcnt vmcnt(16) lgkmcnt(0)
v_exp_f32 v18, v18
v_mfma_f32_16x16x32_bf16 v[44:47], a[28:31], a[220:223], v[44:47]
s_barrier
v_cvt_pk_bf16_f32 v64, v16, v17
v_exp_f32 v19, v19
v_exp_f32 v20, v20
v_exp_f32 v21, v21
v_exp_f32 v22, v22
v_exp_f32 v23, v23
v_exp_f32 v24, v24
v_exp_f32 v25, v25
v_exp_f32 v26, v26
v_exp_f32 v27, v27
v_cvt_pk_bf16_f32 v65, v18, v19
v_cvt_pk_bf16_f32 v68, v20, v21
v_cvt_pk_bf16_f32 v69, v22, v23
s_branch L_att_dodd
L_att_deven:
v_mfma_f32_16x16x32_bf16 v[128:131], a[32:35], v[48:51], v[128:131]
ds_read_b128 a[0:3], v1 offset:8192
v_cvt_pk_bf16_f32 v72, v24, v25
v_mfma_f32_16x16x32_bf16 v[160:163], a[32:35], v[52:55], v[160:163]
v_exp_f32 v28, v28
v_mfma_f32_16x16x32_bf16 v[192:195], a[32:35], v[56:59], v[192:195]
v_cvt_pk_bf16_f32 v73, v26, v27
v_mfma_f32_16x16x32_bf16 v[224:227], a[32:35], v[60:63], v[224:227]
ds_read_b128 a[4:7], v1 offset:9216
v_mfma_f32_16x16x32_bf16 v[228:231], a[36:39], v[60:63], v[228:231]
v_exp_f32 v29, v29
v_mfma_f32_16x16x32_bf16 v[196:199], a[36:39], v[56:59], v[196:199]
v_exp_f32 v30, v30
v_mfma_f32_16x16x32_bf16 v[164:167], a[36:39], v[52:55], v[164:167]
s_add_u32 m0, s27, 0x0
v_cvt_pk_bf16_f32 v76, v28, v29
v_mfma_f32_16x16x32_bf16 v[132:135], a[36:39], v[48:51], v[132:135]
buffer_load_dwordx4 v3, s[48:51], s32 offen offset:0 sc1 lds
v_mfma_f32_16x16x32_bf16 v[136:139], a[40:43], v[48:51], v[136:139]
ds_read_b128 a[8:11], v1 offset:10240
v_mfma_f32_16x16x32_bf16 v[168:171], a[40:43], v[52:55], v[168:171]
v_exp_f32 v31, v31
v_mfma_f32_16x16x32_bf16 v[200:203], a[40:43], v[56:59], v[200:203]
v_exp_f32 v32, v32
v_mfma_f32_16x16x32_bf16 v[232:235], a[40:43], v[60:63], v[232:235]
ds_read_b128 a[12:15], v1 offset:11264
v_cvt_pk_bf16_f32 v77, v30, v31
v_mfma_f32_16x16x32_bf16 v[236:239], a[44:47], v[60:63], v[236:239]
v_mfma_f32_16x16x32_bf16 v[204:207], a[44:47], v[56:59], v[204:207]
v_exp_f32 v33, v33
v_mfma_f32_16x16x32_bf16 v[172:175], a[44:47], v[52:55], v[172:175]
v_exp_f32 v34, v34
v_mfma_f32_16x16x32_bf16 v[140:143], a[44:47], v[48:51], v[140:143]
ds_read_b128 a[16:19], v1 offset:12288
v_cvt_pk_bf16_f32 v66, v32, v33
v_mfma_f32_16x16x32_bf16 v[144:147], a[48:51], v[48:51], v[144:147]
v_mfma_f32_16x16x32_bf16 v[176:179], a[48:51], v[52:55], v[176:179]
v_exp_f32 v35, v35
v_mfma_f32_16x16x32_bf16 v[208:211], a[48:51], v[56:59], v[208:211]
v_exp_f32 v36, v36
v_mfma_f32_16x16x32_bf16 v[240:243], a[48:51], v[60:63], v[240:243]
ds_read_b128 a[20:23], v1 offset:13312
v_cvt_pk_bf16_f32 v67, v34, v35
v_mfma_f32_16x16x32_bf16 v[244:247], a[52:55], v[60:63], v[244:247]
v_exp_f32 v37, v37
v_mfma_f32_16x16x32_bf16 v[212:215], a[52:55], v[56:59], v[212:215]
v_cvt_pk_bf16_f32 v70, v36, v37
v_mfma_f32_16x16x32_bf16 v[180:183], a[52:55], v[52:55], v[180:183]
ds_read_b128 a[24:27], v1 offset:14336
v_mfma_f32_16x16x32_bf16 v[148:151], a[52:55], v[48:51], v[148:151]
buffer_load_dwordx4 v3, s[48:51], s32 offen offset:1024 sc1 lds
v_mfma_f32_16x16x32_bf16 v[152:155], a[56:59], v[48:51], v[152:155]
v_exp_f32 v38, v38
v_mfma_f32_16x16x32_bf16 v[184:187], a[56:59], v[52:55], v[184:187]
v_exp_f32 v39, v39
v_mfma_f32_16x16x32_bf16 v[216:219], a[56:59], v[56:59], v[216:219]
ds_read_b128 a[28:31], v1 offset:15360
v_cvt_pk_bf16_f32 v71, v38, v39
v_mfma_f32_16x16x32_bf16 v[248:251], a[56:59], v[60:63], v[248:251]
v_mfma_f32_16x16x32_bf16 v[252:255], a[60:63], v[60:63], v[252:255]
v_exp_f32 v40, v40
v_mfma_f32_16x16x32_bf16 v[220:223], a[60:63], v[56:59], v[220:223]
v_exp_f32 v41, v41
v_mfma_f32_16x16x32_bf16 v[188:191], a[60:63], v[52:55], v[188:191]
ds_read_b128 a[32:35], v1 offset:0
v_cvt_pk_bf16_f32 v74, v40, v41
v_mfma_f32_16x16x32_bf16 v[156:159], a[60:63], v[48:51], v[156:159]
v_smfmac_f32_16x16x64_bf16 a[224:227], a[232:235], v[48:55], v9
v_exp_f32 v42, v42
v_smfmac_f32_16x16x64_bf16 a[228:231], a[232:235], v[56:63], v9
s_waitcnt lgkmcnt(5)
v_exp_f32 v43, v43
v_mfma_f32_16x16x32_bf16 v[16:19], a[0:3], a[160:163], v[80:83]
ds_read_b128 a[36:39], v1 offset:1024
v_cvt_pk_bf16_f32 v75, v42, v43
v_mfma_f32_16x16x32_bf16 v[16:19], a[4:7], a[164:167], v[16:19]
v_exp_f32 v44, v44
v_mfma_f32_16x16x32_bf16 v[16:19], a[8:11], a[168:171], v[16:19]
v_mfma_f32_16x16x32_bf16 v[16:19], a[12:15], a[172:175], v[16:19]
v_exp_f32 v45, v45
v_mfma_f32_16x16x32_bf16 v[20:23], a[0:3], a[176:179], v[84:87]
ds_read_b128 a[40:43], v1 offset:2048
v_cvt_pk_bf16_f32 v78, v44, v45
v_mfma_f32_16x16x32_bf16 v[20:23], a[4:7], a[180:183], v[20:23]
buffer_load_dwordx4 v3, s[48:51], s32 offen offset:2048 sc1 lds
v_mfma_f32_16x16x32_bf16 v[20:23], a[8:11], a[184:187], v[20:23]
v_exp_f32 v46, v46
v_mfma_f32_16x16x32_bf16 v[20:23], a[12:15], a[188:191], v[20:23]
ds_read_b128 a[44:47], v1 offset:3072
v_mfma_f32_16x16x32_bf16 v[24:27], a[0:3], a[192:195], v[88:91]
v_mfma_f32_16x16x32_bf16 v[24:27], a[4:7], a[196:199], v[24:27]
v_exp_f32 v47, v47
v_mfma_f32_16x16x32_bf16 v[24:27], a[8:11], a[200:203], v[24:27]
v_exp_f32 v16, v16
v_mfma_f32_16x16x32_bf16 v[24:27], a[12:15], a[204:207], v[24:27]
ds_read_b128 a[48:51], v1 offset:4096
v_cvt_pk_bf16_f32 v79, v46, v47
v_mfma_f32_16x16x32_bf16 v[28:31], a[0:3], a[208:211], v[92:95]
v_mfma_f32_16x16x32_bf16 v[28:31], a[4:7], a[212:215], v[28:31]
v_exp_f32 v17, v17
v_mfma_f32_16x16x32_bf16 v[28:31], a[8:11], a[216:219], v[28:31]
s_waitcnt lgkmcnt(5)
v_exp_f32 v18, v18
v_mfma_f32_16x16x32_bf16 v[28:31], a[12:15], a[220:223], v[28:31]
ds_read_b128 a[52:55], v1 offset:5120
v_cvt_pk_bf16_f32 v48, v16, v17
v_mfma_f32_16x16x32_bf16 v[32:35], a[16:19], a[160:163], v[80:83]
v_mfma_f32_16x16x32_bf16 v[32:35], a[20:23], a[164:167], v[32:35]
v_exp_f32 v19, v19
v_mfma_f32_16x16x32_bf16 v[32:35], a[24:27], a[168:171], v[32:35]
v_exp_f32 v20, v20
v_mfma_f32_16x16x32_bf16 v[32:35], a[28:31], a[172:175], v[32:35]
ds_read_b128 a[56:59], v1 offset:6144
v_cvt_pk_bf16_f32 v49, v18, v19
v_mfma_f32_16x16x32_bf16 v[36:39], a[16:19], a[176:179], v[84:87]
v_exp_f32 v21, v21
v_mfma_f32_16x16x32_bf16 v[36:39], a[20:23], a[180:183], v[36:39]
buffer_load_dwordx4 v3, s[48:51], s32 offen offset:3072 sc1 lds
v_mfma_f32_16x16x32_bf16 v[36:39], a[24:27], a[184:187], v[36:39]
s_add_u32 s32, s32, 0x8000
v_cvt_pk_bf16_f32 v52, v20, v21
v_mfma_f32_16x16x32_bf16 v[36:39], a[28:31], a[188:191], v[36:39]
ds_read_b128 a[60:63], v1 offset:7168
v_mfma_f32_16x16x32_bf16 v[40:43], a[16:19], a[192:195], v[88:91]
v_exp_f32 v22, v22
v_mfma_f32_16x16x32_bf16 v[40:43], a[20:23], a[196:199], v[40:43]
v_exp_f32 v23, v23
v_mfma_f32_16x16x32_bf16 v[40:43], a[24:27], a[200:203], v[40:43]
v_cvt_pk_bf16_f32 v53, v22, v23
v_mfma_f32_16x16x32_bf16 v[40:43], a[28:31], a[204:207], v[40:43]
v_exp_f32 v24, v24
v_mfma_f32_16x16x32_bf16 v[44:47], a[16:19], a[208:211], v[92:95]
v_exp_f32 v25, v25
v_mfma_f32_16x16x32_bf16 v[44:47], a[20:23], a[212:215], v[44:47]
v_exp_f32 v26, v26
v_mfma_f32_16x16x32_bf16 v[44:47], a[24:27], a[216:219], v[44:47]
v_exp_f32 v27, v27
v_mfma_f32_16x16x32_bf16 v[44:47], a[28:31], a[220:223], v[44:47]
s_waitcnt lgkmcnt(0)
v_mfma_f32_16x16x32_bf16 v[128:131], a[32:35], v[64:67], v[128:131]
ds_read_b128 a[0:3], v1 offset:24576
v_cvt_pk_bf16_f32 v56, v24, v25
v_mfma_f32_16x16x32_bf16 v[160:163], a[32:35], v[68:71], v[160:163]
v_exp_f32 v28, v28
v_mfma_f32_16x16x32_bf16 v[192:195], a[32:35], v[72:75], v[192:195]
v_cvt_pk_bf16_f32 v57, v26, v27
v_mfma_f32_16x16x32_bf16 v[224:227], a[32:35], v[76:79], v[224:227]
ds_read_b128 a[4:7], v1 offset:25600
v_mfma_f32_16x16x32_bf16 v[228:231], a[36:39], v[76:79], v[228:231]
v_exp_f32 v29, v29
v_mfma_f32_16x16x32_bf16 v[196:199], a[36:39], v[72:75], v[196:199]
v_exp_f32 v30, v30
v_mfma_f32_16x16x32_bf16 v[164:167], a[36:39], v[68:71], v[164:167]
s_add_u32 m0, s27, 0x1000
v_cvt_pk_bf16_f32 v60, v28, v29
v_mfma_f32_16x16x32_bf16 v[132:135], a[36:39], v[64:67], v[132:135]
buffer_load_dwordx4 v3, s[48:51], s7 offen offset:0 sc1 lds
v_mfma_f32_16x16x32_bf16 v[136:139], a[40:43], v[64:67], v[136:139]
ds_read_b128 a[8:11], v1 offset:26624
v_mfma_f32_16x16x32_bf16 v[168:171], a[40:43], v[68:71], v[168:171]
v_exp_f32 v31, v31
v_mfma_f32_16x16x32_bf16 v[200:203], a[40:43], v[72:75], v[200:203]
v_exp_f32 v32, v32
v_mfma_f32_16x16x32_bf16 v[232:235], a[40:43], v[76:79], v[232:235]
ds_read_b128 a[12:15], v1 offset:27648
v_cvt_pk_bf16_f32 v61, v30, v31
v_mfma_f32_16x16x32_bf16 v[236:239], a[44:47], v[76:79], v[236:239]
v_mfma_f32_16x16x32_bf16 v[204:207], a[44:47], v[72:75], v[204:207]
v_exp_f32 v33, v33
v_mfma_f32_16x16x32_bf16 v[172:175], a[44:47], v[68:71], v[172:175]
v_exp_f32 v34, v34
v_mfma_f32_16x16x32_bf16 v[140:143], a[44:47], v[64:67], v[140:143]
ds_read_b128 a[16:19], v1 offset:28672
v_cvt_pk_bf16_f32 v50, v32, v33
v_mfma_f32_16x16x32_bf16 v[144:147], a[48:51], v[64:67], v[144:147]
v_mfma_f32_16x16x32_bf16 v[176:179], a[48:51], v[68:71], v[176:179]
v_exp_f32 v35, v35
v_mfma_f32_16x16x32_bf16 v[208:211], a[48:51], v[72:75], v[208:211]
ds_read_b128 a[20:23], v1 offset:29696
v_cvt_pk_bf16_f32 v51, v34, v35
v_mfma_f32_16x16x32_bf16 v[240:243], a[48:51], v[76:79], v[240:243]
v_exp_f32 v36, v36
v_mfma_f32_16x16x32_bf16 v[244:247], a[52:55], v[76:79], v[244:247]
v_exp_f32 v37, v37
v_mfma_f32_16x16x32_bf16 v[212:215], a[52:55], v[72:75], v[212:215]
v_cvt_pk_bf16_f32 v54, v36, v37
v_mfma_f32_16x16x32_bf16 v[180:183], a[52:55], v[68:71], v[180:183]
buffer_load_dwordx4 v3, s[48:51], s7 offen offset:1024 sc1 lds
v_mfma_f32_16x16x32_bf16 v[148:151], a[52:55], v[64:67], v[148:151]
ds_read_b128 a[24:27], v1 offset:30720
v_mfma_f32_16x16x32_bf16 v[152:155], a[56:59], v[64:67], v[152:155]
v_exp_f32 v38, v38
v_mfma_f32_16x16x32_bf16 v[184:187], a[56:59], v[68:71], v[184:187]
v_exp_f32 v39, v39
v_mfma_f32_16x16x32_bf16 v[216:219], a[56:59], v[72:75], v[216:219]
ds_read_b128 a[28:31], v1 offset:31744
v_cvt_pk_bf16_f32 v55, v38, v39
v_mfma_f32_16x16x32_bf16 v[248:251], a[56:59], v[76:79], v[248:251]
v_mfma_f32_16x16x32_bf16 v[252:255], a[60:63], v[76:79], v[252:255]
v_exp_f32 v40, v40
v_mfma_f32_16x16x32_bf16 v[220:223], a[60:63], v[72:75], v[220:223]
v_exp_f32 v41, v41
v_mfma_f32_16x16x32_bf16 v[188:191], a[60:63], v[68:71], v[188:191]
ds_read_b128 a[32:35], v1 offset:16384
v_cvt_pk_bf16_f32 v58, v40, v41
v_mfma_f32_16x16x32_bf16 v[156:159], a[60:63], v[64:67], v[156:159]
v_smfmac_f32_16x16x64_bf16 a[224:227], a[232:235], v[64:71], v9
s_waitcnt lgkmcnt(5)
v_exp_f32 v42, v42
v_smfmac_f32_16x16x64_bf16 a[228:231], a[232:235], v[72:79], v9
ds_read_b128 a[36:39], v1 offset:17408
v_mfma_f32_16x16x32_bf16 v[16:19], a[0:3], a[160:163], v[80:83]
v_exp_f32 v43, v43
v_mfma_f32_16x16x32_bf16 v[16:19], a[4:7], a[164:167], v[16:19]
v_exp_f32 v44, v44
v_mfma_f32_16x16x32_bf16 v[16:19], a[8:11], a[168:171], v[16:19]
v_cvt_pk_bf16_f32 v59, v42, v43
v_mfma_f32_16x16x32_bf16 v[16:19], a[12:15], a[172:175], v[16:19]
ds_read_b128 a[40:43], v1 offset:18432
v_mfma_f32_16x16x32_bf16 v[20:23], a[0:3], a[176:179], v[84:87]
buffer_load_dwordx4 v3, s[48:51], s7 offen offset:2048 sc1 lds
v_mfma_f32_16x16x32_bf16 v[20:23], a[4:7], a[180:183], v[20:23]
v_exp_f32 v45, v45
v_mfma_f32_16x16x32_bf16 v[20:23], a[8:11], a[184:187], v[20:23]
v_exp_f32 v46, v46
v_mfma_f32_16x16x32_bf16 v[20:23], a[12:15], a[188:191], v[20:23]
ds_read_b128 a[44:47], v1 offset:19456
v_cvt_pk_bf16_f32 v62, v44, v45
v_mfma_f32_16x16x32_bf16 v[24:27], a[0:3], a[192:195], v[88:91]
v_mfma_f32_16x16x32_bf16 v[24:27], a[4:7], a[196:199], v[24:27]
v_exp_f32 v47, v47
v_mfma_f32_16x16x32_bf16 v[24:27], a[8:11], a[200:203], v[24:27]
v_exp_f32 v16, v16
v_mfma_f32_16x16x32_bf16 v[24:27], a[12:15], a[204:207], v[24:27]
ds_read_b128 a[48:51], v1 offset:20480
v_cvt_pk_bf16_f32 v63, v46, v47
v_mfma_f32_16x16x32_bf16 v[28:31], a[0:3], a[208:211], v[92:95]
v_mfma_f32_16x16x32_bf16 v[28:31], a[4:7], a[212:215], v[28:31]
v_exp_f32 v17, v17
v_mfma_f32_16x16x32_bf16 v[28:31], a[8:11], a[216:219], v[28:31]
ds_read_b128 a[52:55], v1 offset:21504
v_cvt_pk_bf16_f32 v64, v16, v17
v_mfma_f32_16x16x32_bf16 v[28:31], a[12:15], a[220:223], v[28:31]
s_waitcnt lgkmcnt(6)
v_exp_f32 v18, v18
v_mfma_f32_16x16x32_bf16 v[32:35], a[16:19], a[160:163], v[80:83]
v_mfma_f32_16x16x32_bf16 v[32:35], a[20:23], a[164:167], v[32:35]
v_exp_f32 v19, v19
v_mfma_f32_16x16x32_bf16 v[32:35], a[24:27], a[168:171], v[32:35]
ds_read_b128 a[56:59], v1 offset:22528
v_cvt_pk_bf16_f32 v65, v18, v19
v_mfma_f32_16x16x32_bf16 v[32:35], a[28:31], a[172:175], v[32:35]
buffer_load_dwordx4 v3, s[48:51], s7 offen offset:3072 sc1 lds
v_mfma_f32_16x16x32_bf16 v[36:39], a[16:19], a[176:179], v[84:87]
s_add_u32 s7, s7, 0x8000
v_exp_f32 v20, v20
v_mfma_f32_16x16x32_bf16 v[36:39], a[20:23], a[180:183], v[36:39]
s_xor_b32 s27, s27, 0x38000
v_exp_f32 v21, v21
v_mfma_f32_16x16x32_bf16 v[36:39], a[24:27], a[184:187], v[36:39]
ds_read_b128 a[60:63], v1 offset:23552
v_xor_b32 v1, 0x8000, v1
v_mfma_f32_16x16x32_bf16 v[36:39], a[28:31], a[188:191], v[36:39]
v_cvt_pk_bf16_f32 v68, v20, v21
v_mfma_f32_16x16x32_bf16 v[40:43], a[16:19], a[192:195], v[88:91]
v_exp_f32 v22, v22
v_mfma_f32_16x16x32_bf16 v[40:43], a[20:23], a[196:199], v[40:43]
v_exp_f32 v23, v23
v_mfma_f32_16x16x32_bf16 v[40:43], a[24:27], a[200:203], v[40:43]
v_cvt_pk_bf16_f32 v69, v22, v23
v_mfma_f32_16x16x32_bf16 v[40:43], a[28:31], a[204:207], v[40:43]
v_exp_f32 v24, v24
v_mfma_f32_16x16x32_bf16 v[44:47], a[16:19], a[208:211], v[92:95]
v_exp_f32 v25, v25
v_mfma_f32_16x16x32_bf16 v[44:47], a[20:23], a[212:215], v[44:47]
v_exp_f32 v26, v26
v_mfma_f32_16x16x32_bf16 v[44:47], a[24:27], a[216:219], v[44:47]
s_waitcnt vmcnt(16) lgkmcnt(0)
v_exp_f32 v27, v27
v_mfma_f32_16x16x32_bf16 v[44:47], a[28:31], a[220:223], v[44:47]
s_barrier
L_att_dodd:
v_mfma_f32_16x16x32_bf16 v[128:131], a[32:35], v[48:51], v[128:131]
ds_read_b128 a[0:3], v2 offset:8192
v_cvt_pk_bf16_f32 v72, v24, v25
v_mfma_f32_16x16x32_bf16 v[160:163], a[32:35], v[52:55], v[160:163]
v_exp_f32 v28, v28
v_mfma_f32_16x16x32_bf16 v[192:195], a[32:35], v[56:59], v[192:195]
v_cvt_pk_bf16_f32 v73, v26, v27
v_mfma_f32_16x16x32_bf16 v[224:227], a[32:35], v[60:63], v[224:227]
ds_read_b128 a[4:7], v2 offset:9216
v_mfma_f32_16x16x32_bf16 v[228:231], a[36:39], v[60:63], v[228:231]
v_exp_f32 v29, v29
v_mfma_f32_16x16x32_bf16 v[196:199], a[36:39], v[56:59], v[196:199]
v_exp_f32 v30, v30
v_mfma_f32_16x16x32_bf16 v[164:167], a[36:39], v[52:55], v[164:167]
s_add_u32 m0, s19, 0x0
v_cvt_pk_bf16_f32 v76, v28, v29
v_mfma_f32_16x16x32_bf16 v[132:135], a[36:39], v[48:51], v[132:135]
buffer_load_dwordx4 v3, s[48:51], s32 offen offset:0 sc1 lds
v_mfma_f32_16x16x32_bf16 v[136:139], a[40:43], v[48:51], v[136:139]
ds_read_b128 a[8:11], v2 offset:10240
v_mfma_f32_16x16x32_bf16 v[168:171], a[40:43], v[52:55], v[168:171]
v_exp_f32 v31, v31
v_mfma_f32_16x16x32_bf16 v[200:203], a[40:43], v[56:59], v[200:203]
v_exp_f32 v32, v32
v_mfma_f32_16x16x32_bf16 v[232:235], a[40:43], v[60:63], v[232:235]
ds_read_b128 a[12:15], v2 offset:11264
v_cvt_pk_bf16_f32 v77, v30, v31
v_mfma_f32_16x16x32_bf16 v[236:239], a[44:47], v[60:63], v[236:239]
v_mfma_f32_16x16x32_bf16 v[204:207], a[44:47], v[56:59], v[204:207]
v_exp_f32 v33, v33
v_mfma_f32_16x16x32_bf16 v[172:175], a[44:47], v[52:55], v[172:175]
v_exp_f32 v34, v34
v_mfma_f32_16x16x32_bf16 v[140:143], a[44:47], v[48:51], v[140:143]
ds_read_b128 a[16:19], v2 offset:12288
v_cvt_pk_bf16_f32 v66, v32, v33
v_mfma_f32_16x16x32_bf16 v[144:147], a[48:51], v[48:51], v[144:147]
v_mfma_f32_16x16x32_bf16 v[176:179], a[48:51], v[52:55], v[176:179]
v_exp_f32 v35, v35
v_mfma_f32_16x16x32_bf16 v[208:211], a[48:51], v[56:59], v[208:211]
v_exp_f32 v36, v36
v_mfma_f32_16x16x32_bf16 v[240:243], a[48:51], v[60:63], v[240:243]
ds_read_b128 a[20:23], v2 offset:13312
v_cvt_pk_bf16_f32 v67, v34, v35
v_mfma_f32_16x16x32_bf16 v[244:247], a[52:55], v[60:63], v[244:247]
v_exp_f32 v37, v37
v_mfma_f32_16x16x32_bf16 v[212:215], a[52:55], v[56:59], v[212:215]
v_cvt_pk_bf16_f32 v70, v36, v37
v_mfma_f32_16x16x32_bf16 v[180:183], a[52:55], v[52:55], v[180:183]
ds_read_b128 a[24:27], v2 offset:14336
v_mfma_f32_16x16x32_bf16 v[148:151], a[52:55], v[48:51], v[148:151]
buffer_load_dwordx4 v3, s[48:51], s32 offen offset:1024 sc1 lds
v_mfma_f32_16x16x32_bf16 v[152:155], a[56:59], v[48:51], v[152:155]
v_exp_f32 v38, v38
v_mfma_f32_16x16x32_bf16 v[184:187], a[56:59], v[52:55], v[184:187]
v_exp_f32 v39, v39
v_mfma_f32_16x16x32_bf16 v[216:219], a[56:59], v[56:59], v[216:219]
ds_read_b128 a[28:31], v2 offset:15360
v_cvt_pk_bf16_f32 v71, v38, v39
v_mfma_f32_16x16x32_bf16 v[248:251], a[56:59], v[60:63], v[248:251]
v_mfma_f32_16x16x32_bf16 v[252:255], a[60:63], v[60:63], v[252:255]
v_exp_f32 v40, v40
v_mfma_f32_16x16x32_bf16 v[220:223], a[60:63], v[56:59], v[220:223]
v_exp_f32 v41, v41
v_mfma_f32_16x16x32_bf16 v[188:191], a[60:63], v[52:55], v[188:191]
ds_read_b128 a[32:35], v2 offset:0
v_cvt_pk_bf16_f32 v74, v40, v41
v_mfma_f32_16x16x32_bf16 v[156:159], a[60:63], v[48:51], v[156:159]
v_smfmac_f32_16x16x64_bf16 a[224:227], a[232:235], v[48:55], v9
v_exp_f32 v42, v42
v_smfmac_f32_16x16x64_bf16 a[228:231], a[232:235], v[56:63], v9
s_waitcnt lgkmcnt(5)
v_exp_f32 v43, v43
v_mfma_f32_16x16x32_bf16 v[16:19], a[0:3], a[160:163], v[80:83]
ds_read_b128 a[36:39], v2 offset:1024
v_cvt_pk_bf16_f32 v75, v42, v43
v_mfma_f32_16x16x32_bf16 v[16:19], a[4:7], a[164:167], v[16:19]
v_exp_f32 v44, v44
v_mfma_f32_16x16x32_bf16 v[16:19], a[8:11], a[168:171], v[16:19]
v_mfma_f32_16x16x32_bf16 v[16:19], a[12:15], a[172:175], v[16:19]
v_exp_f32 v45, v45
v_mfma_f32_16x16x32_bf16 v[20:23], a[0:3], a[176:179], v[84:87]
ds_read_b128 a[40:43], v2 offset:2048
v_cvt_pk_bf16_f32 v78, v44, v45
v_mfma_f32_16x16x32_bf16 v[20:23], a[4:7], a[180:183], v[20:23]
buffer_load_dwordx4 v3, s[48:51], s32 offen offset:2048 sc1 lds
v_mfma_f32_16x16x32_bf16 v[20:23], a[8:11], a[184:187], v[20:23]
v_exp_f32 v46, v46
v_mfma_f32_16x16x32_bf16 v[20:23], a[12:15], a[188:191], v[20:23]
ds_read_b128 a[44:47], v2 offset:3072
v_mfma_f32_16x16x32_bf16 v[24:27], a[0:3], a[192:195], v[88:91]
v_mfma_f32_16x16x32_bf16 v[24:27], a[4:7], a[196:199], v[24:27]
v_exp_f32 v47, v47
v_mfma_f32_16x16x32_bf16 v[24:27], a[8:11], a[200:203], v[24:27]
v_exp_f32 v16, v16
v_mfma_f32_16x16x32_bf16 v[24:27], a[12:15], a[204:207], v[24:27]
ds_read_b128 a[48:51], v2 offset:4096
v_cvt_pk_bf16_f32 v79, v46, v47
v_mfma_f32_16x16x32_bf16 v[28:31], a[0:3], a[208:211], v[92:95]
v_mfma_f32_16x16x32_bf16 v[28:31], a[4:7], a[212:215], v[28:31]
v_exp_f32 v17, v17
v_mfma_f32_16x16x32_bf16 v[28:31], a[8:11], a[216:219], v[28:31]
s_waitcnt lgkmcnt(5)
v_exp_f32 v18, v18
v_mfma_f32_16x16x32_bf16 v[28:31], a[12:15], a[220:223], v[28:31]
ds_read_b128 a[52:55], v2 offset:5120
v_cvt_pk_bf16_f32 v48, v16, v17
v_mfma_f32_16x16x32_bf16 v[32:35], a[16:19], a[160:163], v[80:83]
v_mfma_f32_16x16x32_bf16 v[32:35], a[20:23], a[164:167], v[32:35]
v_exp_f32 v19, v19
v_mfma_f32_16x16x32_bf16 v[32:35], a[24:27], a[168:171], v[32:35]
v_exp_f32 v20, v20
v_mfma_f32_16x16x32_bf16 v[32:35], a[28:31], a[172:175], v[32:35]
ds_read_b128 a[56:59], v2 offset:6144
v_cvt_pk_bf16_f32 v49, v18, v19
v_mfma_f32_16x16x32_bf16 v[36:39], a[16:19], a[176:179], v[84:87]
v_exp_f32 v21, v21
v_mfma_f32_16x16x32_bf16 v[36:39], a[20:23], a[180:183], v[36:39]
buffer_load_dwordx4 v3, s[48:51], s32 offen offset:3072 sc1 lds
v_mfma_f32_16x16x32_bf16 v[36:39], a[24:27], a[184:187], v[36:39]
s_add_u32 s32, s32, 0x8000
v_cvt_pk_bf16_f32 v52, v20, v21
v_mfma_f32_16x16x32_bf16 v[36:39], a[28:31], a[188:191], v[36:39]
ds_read_b128 a[60:63], v2 offset:7168
v_mfma_f32_16x16x32_bf16 v[40:43], a[16:19], a[192:195], v[88:91]
v_exp_f32 v22, v22
v_mfma_f32_16x16x32_bf16 v[40:43], a[20:23], a[196:199], v[40:43]
v_exp_f32 v23, v23
v_mfma_f32_16x16x32_bf16 v[40:43], a[24:27], a[200:203], v[40:43]
v_cvt_pk_bf16_f32 v53, v22, v23
v_mfma_f32_16x16x32_bf16 v[40:43], a[28:31], a[204:207], v[40:43]
v_exp_f32 v24, v24
v_mfma_f32_16x16x32_bf16 v[44:47], a[16:19], a[208:211], v[92:95]
v_exp_f32 v25, v25
v_mfma_f32_16x16x32_bf16 v[44:47], a[20:23], a[212:215], v[44:47]
v_exp_f32 v26, v26
v_mfma_f32_16x16x32_bf16 v[44:47], a[24:27], a[216:219], v[44:47]
v_exp_f32 v27, v27
v_mfma_f32_16x16x32_bf16 v[44:47], a[28:31], a[220:223], v[44:47]
s_waitcnt lgkmcnt(0)
v_mfma_f32_16x16x32_bf16 v[128:131], a[32:35], v[64:67], v[128:131]
ds_read_b128 a[0:3], v2 offset:24576
v_cvt_pk_bf16_f32 v56, v24, v25
v_mfma_f32_16x16x32_bf16 v[160:163], a[32:35], v[68:71], v[160:163]
v_exp_f32 v28, v28
v_mfma_f32_16x16x32_bf16 v[192:195], a[32:35], v[72:75], v[192:195]
v_cvt_pk_bf16_f32 v57, v26, v27
v_mfma_f32_16x16x32_bf16 v[224:227], a[32:35], v[76:79], v[224:227]
ds_read_b128 a[4:7], v2 offset:25600
v_mfma_f32_16x16x32_bf16 v[228:231], a[36:39], v[76:79], v[228:231]
v_exp_f32 v29, v29
v_mfma_f32_16x16x32_bf16 v[196:199], a[36:39], v[72:75], v[196:199]
v_exp_f32 v30, v30
v_mfma_f32_16x16x32_bf16 v[164:167], a[36:39], v[68:71], v[164:167]
s_add_u32 m0, s19, 0x1000
v_cvt_pk_bf16_f32 v60, v28, v29
v_mfma_f32_16x16x32_bf16 v[132:135], a[36:39], v[64:67], v[132:135]
buffer_load_dwordx4 v3, s[48:51], s7 offen offset:0 sc1 lds
v_mfma_f32_16x16x32_bf16 v[136:139], a[40:43], v[64:67], v[136:139]
ds_read_b128 a[8:11], v2 offset:26624
v_mfma_f32_16x16x32_bf16 v[168:171], a[40:43], v[68:71], v[168:171]
v_exp_f32 v31, v31
v_mfma_f32_16x16x32_bf16 v[200:203], a[40:43], v[72:75], v[200:203]
v_exp_f32 v32, v32
v_mfma_f32_16x16x32_bf16 v[232:235], a[40:43], v[76:79], v[232:235]
ds_read_b128 a[12:15], v2 offset:27648
v_cvt_pk_bf16_f32 v61, v30, v31
v_mfma_f32_16x16x32_bf16 v[236:239], a[44:47], v[76:79], v[236:239]
v_mfma_f32_16x16x32_bf16 v[204:207], a[44:47], v[72:75], v[204:207]
v_exp_f32 v33, v33
v_mfma_f32_16x16x32_bf16 v[172:175], a[44:47], v[68:71], v[172:175]
v_exp_f32 v34, v34
v_mfma_f32_16x16x32_bf16 v[140:143], a[44:47], v[64:67], v[140:143]
ds_read_b128 a[16:19], v2 offset:28672
v_cvt_pk_bf16_f32 v50, v32, v33
v_mfma_f32_16x16x32_bf16 v[144:147], a[48:51], v[64:67], v[144:147]
v_exp_f32 v35, v35
v_mfma_f32_16x16x32_bf16 v[176:179], a[48:51], v[68:71], v[176:179]
v_cvt_pk_bf16_f32 v51, v34, v35
v_mfma_f32_16x16x32_bf16 v[208:211], a[48:51], v[72:75], v[208:211]
ds_read_b128 a[20:23], v2 offset:29696
v_mfma_f32_16x16x32_bf16 v[240:243], a[48:51], v[76:79], v[240:243]
v_exp_f32 v36, v36
v_mfma_f32_16x16x32_bf16 v[244:247], a[52:55], v[76:79], v[244:247]
v_exp_f32 v37, v37
v_mfma_f32_16x16x32_bf16 v[212:215], a[52:55], v[72:75], v[212:215]
v_cvt_pk_bf16_f32 v54, v36, v37
v_mfma_f32_16x16x32_bf16 v[180:183], a[52:55], v[68:71], v[180:183]
buffer_load_dwordx4 v3, s[48:51], s7 offen offset:1024 sc1 lds
v_mfma_f32_16x16x32_bf16 v[148:151], a[52:55], v[64:67], v[148:151]
ds_read_b128 a[24:27], v2 offset:30720
v_mfma_f32_16x16x32_bf16 v[152:155], a[56:59], v[64:67], v[152:155]
v_exp_f32 v38, v38
v_mfma_f32_16x16x32_bf16 v[184:187], a[56:59], v[68:71], v[184:187]
v_exp_f32 v39, v39
v_mfma_f32_16x16x32_bf16 v[216:219], a[56:59], v[72:75], v[216:219]
ds_read_b128 a[28:31], v2 offset:31744
v_cvt_pk_bf16_f32 v55, v38, v39
v_mfma_f32_16x16x32_bf16 v[248:251], a[56:59], v[76:79], v[248:251]
v_exp_f32 v40, v40
v_mfma_f32_16x16x32_bf16 v[252:255], a[60:63], v[76:79], v[252:255]
v_mfma_f32_16x16x32_bf16 v[220:223], a[60:63], v[72:75], v[220:223]
v_exp_f32 v41, v41
v_mfma_f32_16x16x32_bf16 v[188:191], a[60:63], v[68:71], v[188:191]
ds_read_b128 a[32:35], v2 offset:16384
v_cvt_pk_bf16_f32 v58, v40, v41
v_mfma_f32_16x16x32_bf16 v[156:159], a[60:63], v[64:67], v[156:159]
v_exp_f32 v42, v42
v_smfmac_f32_16x16x64_bf16 a[224:227], a[232:235], v[64:71], v9
s_waitcnt lgkmcnt(5)
v_smfmac_f32_16x16x64_bf16 a[228:231], a[232:235], v[72:79], v9
ds_read_b128 a[36:39], v2 offset:17408
v_mfma_f32_16x16x32_bf16 v[16:19], a[0:3], a[160:163], v[80:83]
v_exp_f32 v43, v43
v_mfma_f32_16x16x32_bf16 v[16:19], a[4:7], a[164:167], v[16:19]
v_exp_f32 v44, v44
v_mfma_f32_16x16x32_bf16 v[16:19], a[8:11], a[168:171], v[16:19]
buffer_load_dwordx4 v3, s[48:51], s7 offen offset:2048 sc1 lds
v_mfma_f32_16x16x32_bf16 v[16:19], a[12:15], a[172:175], v[16:19]
ds_read_b128 a[40:43], v2 offset:18432
v_cvt_pk_bf16_f32 v59, v42, v43
v_mfma_f32_16x16x32_bf16 v[20:23], a[0:3], a[176:179], v[84:87]
v_exp_f32 v45, v45
v_mfma_f32_16x16x32_bf16 v[20:23], a[4:7], a[180:183], v[20:23]
v_cvt_pk_bf16_f32 v62, v44, v45
v_mfma_f32_16x16x32_bf16 v[20:23], a[8:11], a[184:187], v[20:23]
v_exp_f32 v46, v46
v_mfma_f32_16x16x32_bf16 v[20:23], a[12:15], a[188:191], v[20:23]
ds_read_b128 a[44:47], v2 offset:19456
v_mfma_f32_16x16x32_bf16 v[24:27], a[0:3], a[192:195], v[88:91]
v_exp_f32 v47, v47
v_mfma_f32_16x16x32_bf16 v[24:27], a[4:7], a[196:199], v[24:27]
v_cvt_pk_bf16_f32 v63, v46, v47
v_mfma_f32_16x16x32_bf16 v[24:27], a[8:11], a[200:203], v[24:27]
v_exp_f32 v16, v16
v_mfma_f32_16x16x32_bf16 v[24:27], a[12:15], a[204:207], v[24:27]
ds_read_b128 a[48:51], v2 offset:20480
v_mfma_f32_16x16x32_bf16 v[28:31], a[0:3], a[208:211], v[92:95]
v_exp_f32 v17, v17
v_mfma_f32_16x16x32_bf16 v[28:31], a[4:7], a[212:215], v[28:31]
v_exp_f32 v18, v18
v_mfma_f32_16x16x32_bf16 v[28:31], a[8:11], a[216:219], v[28:31]
ds_read_b128 a[52:55], v2 offset:21504
v_cvt_pk_bf16_f32 v64, v16, v17
v_mfma_f32_16x16x32_bf16 v[28:31], a[12:15], a[220:223], v[28:31]
s_waitcnt lgkmcnt(6)
v_mfma_f32_16x16x32_bf16 v[32:35], a[16:19], a[160:163], v[80:83]
v_exp_f32 v19, v19
v_mfma_f32_16x16x32_bf16 v[32:35], a[20:23], a[164:167], v[32:35]
buffer_load_dwordx4 v3, s[48:51], s7 offen offset:3072 sc1 lds
v_mfma_f32_16x16x32_bf16 v[32:35], a[24:27], a[168:171], v[32:35]
ds_read_b128 a[56:59], v2 offset:22528
v_cvt_pk_bf16_f32 v65, v18, v19
v_mfma_f32_16x16x32_bf16 v[32:35], a[28:31], a[172:175], v[32:35]
s_add_u32 s7, s7, 0x8000
v_exp_f32 v20, v20
v_mfma_f32_16x16x32_bf16 v[36:39], a[16:19], a[176:179], v[84:87]
s_xor_b32 s19, s19, 0x8000
v_mfma_f32_16x16x32_bf16 v[36:39], a[20:23], a[180:183], v[36:39]
s_sub_u32 s15, s15, 1
v_exp_f32 v21, v21
v_mfma_f32_16x16x32_bf16 v[36:39], a[24:27], a[184:187], v[36:39]
ds_read_b128 a[60:63], v2 offset:23552
v_xor_b32 v2, 0x38000, v2
v_mfma_f32_16x16x32_bf16 v[36:39], a[28:31], a[188:191], v[36:39]
s_cmp_lg_u32 s15, 0
v_exp_f32 v22, v22
v_mfma_f32_16x16x32_bf16 v[40:43], a[16:19], a[192:195], v[88:91]
v_exp_f32 v23, v23
v_mfma_f32_16x16x32_bf16 v[40:43], a[20:23], a[196:199], v[40:43]
v_cvt_pk_bf16_f32 v68, v20, v21
v_cvt_pk_bf16_f32 v69, v22, v23
v_mfma_f32_16x16x32_bf16 v[40:43], a[24:27], a[200:203], v[40:43]
v_exp_f32 v24, v24
v_mfma_f32_16x16x32_bf16 v[40:43], a[28:31], a[204:207], v[40:43]
v_exp_f32 v25, v25
v_mfma_f32_16x16x32_bf16 v[44:47], a[16:19], a[208:211], v[92:95]
v_exp_f32 v26, v26
v_mfma_f32_16x16x32_bf16 v[44:47], a[20:23], a[212:215], v[44:47]
v_exp_f32 v27, v27
v_mfma_f32_16x16x32_bf16 v[44:47], a[24:27], a[216:219], v[44:47]
s_waitcnt vmcnt(16) lgkmcnt(0)
v_mfma_f32_16x16x32_bf16 v[44:47], a[28:31], a[220:223], v[44:47]
s_barrier
s_cbranch_scc1 L_att_deven
s_cmp_ge_u32 s4, 2
s_cbranch_scc1 L_att_dl0_1
L_att_dl0_0:
v_mfma_f32_16x16x32_bf16 v[128:131], a[32:35], v[48:51], v[128:131]
ds_read_b128 a[0:3], v1 offset:8192
v_cvt_pk_bf16_f32 v72, v24, v25
v_mfma_f32_16x16x32_bf16 v[160:163], a[32:35], v[52:55], v[160:163]
v_exp_f32 v28, v28
v_mfma_f32_16x16x32_bf16 v[192:195], a[32:35], v[56:59], v[192:195]
v_cvt_pk_bf16_f32 v73, v26, v27
v_mfma_f32_16x16x32_bf16 v[224:227], a[32:35], v[60:63], v[224:227]
ds_read_b128 a[4:7], v1 offset:9216
v_mfma_f32_16x16x32_bf16 v[228:231], a[36:39], v[60:63], v[228:231]
s_add_u32 m0, s27, 0x0
v_exp_f32 v29, v29
v_mfma_f32_16x16x32_bf16 v[196:199], a[36:39], v[56:59], v[196:199]
buffer_load_dwordx4 v3, s[48:51], s32 offen offset:0 sc1 lds
v_mfma_f32_16x16x32_bf16 v[164:167], a[36:39], v[52:55], v[164:167]
v_exp_f32 v30, v30
v_mfma_f32_16x16x32_bf16 v[132:135], a[36:39], v[48:51], v[132:135]
ds_read_b128 a[8:11], v1 offset:10240
v_cvt_pk_bf16_f32 v76, v28, v29
v_mfma_f32_16x16x32_bf16 v[136:139], a[40:43], v[48:51], v[136:139]
v_mfma_f32_16x16x32_bf16 v[168:171], a[40:43], v[52:55], v[168:171]
v_exp_f32 v31, v31
v_mfma_f32_16x16x32_bf16 v[200:203], a[40:43], v[56:59], v[200:203]
v_exp_f32 v32, v32
v_mfma_f32_16x16x32_bf16 v[232:235], a[40:43], v[60:63], v[232:235]
ds_read_b128 a[12:15], v1 offset:11264
v_cvt_pk_bf16_f32 v77, v30, v31
v_mfma_f32_16x16x32_bf16 v[236:239], a[44:47], v[60:63], v[236:239]
v_exp_f32 v33, v33
v_mfma_f32_16x16x32_bf16 v[204:207], a[44:47], v[56:59], v[204:207]
v_cvt_pk_bf16_f32 v66, v32, v33
v_mfma_f32_16x16x32_bf16 v[172:175], a[44:47], v[52:55], v[172:175]
s_mov_b32 s9, 0x0
v_exp_f32 v34, v34
v_mfma_f32_16x16x32_bf16 v[140:143], a[44:47], v[48:51], v[140:143]
ds_read_b128 a[16:19], v1 offset:12288
v_mfma_f32_16x16x32_bf16 v[144:147], a[48:51], v[48:51], v[144:147]
buffer_load_dword a244, v8, s[72:75], s9 offen
v_mfma_f32_16x16x32_bf16 v[176:179], a[48:51], v[52:55], v[176:179]
v_exp_f32 v35, v35
v_mfma_f32_16x16x32_bf16 v[208:211], a[48:51], v[56:59], v[208:211]
v_exp_f32 v36, v36
v_mfma_f32_16x16x32_bf16 v[240:243], a[48:51], v[60:63], v[240:243]
ds_read_b128 a[20:23], v1 offset:13312
v_cvt_pk_bf16_f32 v67, v34, v35
v_mfma_f32_16x16x32_bf16 v[244:247], a[52:55], v[60:63], v[244:247]
v_mfma_f32_16x16x32_bf16 v[212:215], a[52:55], v[56:59], v[212:215]
v_exp_f32 v37, v37
v_mfma_f32_16x16x32_bf16 v[180:183], a[52:55], v[52:55], v[180:183]
ds_read_b128 a[24:27], v1 offset:14336
v_cvt_pk_bf16_f32 v70, v36, v37
v_mfma_f32_16x16x32_bf16 v[148:151], a[52:55], v[48:51], v[148:151]
v_exp_f32 v38, v38
v_mfma_f32_16x16x32_bf16 v[152:155], a[56:59], v[48:51], v[152:155]
v_mfma_f32_16x16x32_bf16 v[184:187], a[56:59], v[52:55], v[184:187]
v_exp_f32 v39, v39
v_mfma_f32_16x16x32_bf16 v[216:219], a[56:59], v[56:59], v[216:219]
buffer_load_dwordx4 v3, s[48:51], s32 offen offset:1024 sc1 lds
v_mfma_f32_16x16x32_bf16 v[248:251], a[56:59], v[60:63], v[248:251]
ds_read_b128 a[28:31], v1 offset:15360
v_cvt_pk_bf16_f32 v71, v38, v39
v_mfma_f32_16x16x32_bf16 v[252:255], a[60:63], v[60:63], v[252:255]
v_exp_f32 v40, v40
v_mfma_f32_16x16x32_bf16 v[220:223], a[60:63], v[56:59], v[220:223]
v_exp_f32 v41, v41
v_mfma_f32_16x16x32_bf16 v[188:191], a[60:63], v[52:55], v[188:191]
ds_read_b128 a[32:35], v1 offset:0
v_cvt_pk_bf16_f32 v74, v40, v41
v_mfma_f32_16x16x32_bf16 v[156:159], a[60:63], v[48:51], v[156:159]
v_smfmac_f32_16x16x64_bf16 a[224:227], a[232:235], v[48:55], v9
v_exp_f32 v42, v42
v_smfmac_f32_16x16x64_bf16 a[228:231], a[232:235], v[56:63], v9
s_waitcnt lgkmcnt(5)
v_exp_f32 v43, v43
v_mfma_f32_16x16x32_bf16 v[16:19], a[0:3], a[160:163], v[96:99]
ds_read_b128 a[36:39], v1 offset:1024
v_cvt_pk_bf16_f32 v75, v42, v43
v_mfma_f32_16x16x32_bf16 v[16:19], a[4:7], a[164:167], v[16:19]
v_exp_f32 v44, v44
v_mfma_f32_16x16x32_bf16 v[16:19], a[8:11], a[168:171], v[16:19]
v_mfma_f32_16x16x32_bf16 v[16:19], a[12:15], a[172:175], v[16:19]
buffer_load_dwordx4 v3, s[48:51], s32 offen offset:2048 sc1 lds
v_mfma_f32_16x16x32_bf16 v[20:23], a[0:3], a[176:179], v[84:87]
ds_read_b128 a[40:43], v1 offset:2048
v_mfma_f32_16x16x32_bf16 v[20:23], a[4:7], a[180:183], v[20:23]
v_exp_f32 v45, v45
v_mfma_f32_16x16x32_bf16 v[20:23], a[8:11], a[184:187], v[20:23]
v_exp_f32 v46, v46
v_mfma_f32_16x16x32_bf16 v[20:23], a[12:15], a[188:191], v[20:23]
ds_read_b128 a[44:47], v1 offset:3072
v_cvt_pk_bf16_f32 v78, v44, v45
v_mfma_f32_16x16x32_bf16 v[24:27], a[0:3], a[192:195], v[88:91]
v_mfma_f32_16x16x32_bf16 v[24:27], a[4:7], a[196:199], v[24:27]
v_exp_f32 v47, v47
v_mfma_f32_16x16x32_bf16 v[24:27], a[8:11], a[200:203], v[24:27]
v_exp_f32 v16, v16
v_mfma_f32_16x16x32_bf16 v[24:27], a[12:15], a[204:207], v[24:27]
ds_read_b128 a[48:51], v1 offset:4096
v_cvt_pk_bf16_f32 v79, v46, v47
v_mfma_f32_16x16x32_bf16 v[28:31], a[0:3], a[208:211], v[92:95]
v_exp_f32 v17, v17
v_mfma_f32_16x16x32_bf16 v[28:31], a[4:7], a[212:215], v[28:31]
s_waitcnt lgkmcnt(5)
v_cvt_pk_bf16_f32 v48, v16, v17
v_mfma_f32_16x16x32_bf16 v[28:31], a[8:11], a[216:219], v[28:31]
buffer_load_dwordx4 v3, s[48:51], s32 offen offset:3072 sc1 lds
v_mfma_f32_16x16x32_bf16 v[28:31], a[12:15], a[220:223], v[28:31]
ds_read_b128 a[52:55], v1 offset:5120
v_mfma_f32_16x16x32_bf16 v[32:35], a[16:19], a[160:163], v[100:103]
v_exp_f32 v18, v18
v_mfma_f32_16x16x32_bf16 v[32:35], a[20:23], a[164:167], v[32:35]
v_exp_f32 v19, v19
v_mfma_f32_16x16x32_bf16 v[32:35], a[24:27], a[168:171], v[32:35]
v_exp_f32 v20, v20
v_mfma_f32_16x16x32_bf16 v[32:35], a[28:31], a[172:175], v[32:35]
ds_read_b128 a[56:59], v1 offset:6144
v_cvt_pk_bf16_f32 v49, v18, v19
v_mfma_f32_16x16x32_bf16 v[36:39], a[16:19], a[176:179], v[84:87]
v_mfma_f32_16x16x32_bf16 v[36:39], a[20:23], a[180:183], v[36:39]
v_exp_f32 v21, v21
v_mfma_f32_16x16x32_bf16 v[36:39], a[24:27], a[184:187], v[36:39]
s_mov_b32 s9, 0x0
v_exp_f32 v22, v22
v_mfma_f32_16x16x32_bf16 v[36:39], a[28:31], a[188:191], v[36:39]
ds_read_b128 a[60:63], v1 offset:7168
v_cvt_pk_bf16_f32 v52, v20, v21
v_mfma_f32_16x16x32_bf16 v[40:43], a[16:19], a[192:195], v[88:91]
buffer_load_dword a244, v8, s[64:67], s9 offen
v_mfma_f32_16x16x32_bf16 v[40:43], a[20:23], a[196:199], v[40:43]
v_mfma_f32_16x16x32_bf16 v[40:43], a[24:27], a[200:203], v[40:43]
v_exp_f32 v23, v23
v_mfma_f32_16x16x32_bf16 v[40:43], a[28:31], a[204:207], v[40:43]
v_exp_f32 v24, v24
v_mfma_f32_16x16x32_bf16 v[44:47], a[16:19], a[208:211], v[92:95]
v_exp_f32 v25, v25
v_mfma_f32_16x16x32_bf16 v[44:47], a[20:23], a[212:215], v[44:47]
v_exp_f32 v26, v26
v_mfma_f32_16x16x32_bf16 v[44:47], a[24:27], a[216:219], v[44:47]
v_exp_f32 v27, v27
v_mfma_f32_16x16x32_bf16 v[44:47], a[28:31], a[220:223], v[44:47]
s_waitcnt lgkmcnt(0)
v_cvt_pk_bf16_f32 v53, v22, v23
v_mfma_f32_16x16x32_bf16 v[128:131], a[32:35], v[64:67], v[128:131]
ds_read_b128 a[0:3], v1 offset:24576
v_cvt_pk_bf16_f32 v56, v24, v25
v_mfma_f32_16x16x32_bf16 v[160:163], a[32:35], v[68:71], v[160:163]
v_exp_f32 v28, v28
v_mfma_f32_16x16x32_bf16 v[192:195], a[32:35], v[72:75], v[192:195]
v_cvt_pk_bf16_f32 v57, v26, v27
v_mfma_f32_16x16x32_bf16 v[224:227], a[32:35], v[76:79], v[224:227]
ds_read_b128 a[4:7], v1 offset:25600
v_mfma_f32_16x16x32_bf16 v[228:231], a[36:39], v[76:79], v[228:231]
s_add_u32 m0, s27, 0x1000
v_exp_f32 v29, v29
v_mfma_f32_16x16x32_bf16 v[196:199], a[36:39], v[72:75], v[196:199]
buffer_load_dwordx4 v3, s[48:51], s7 offen offset:0 sc1 lds
v_mfma_f32_16x16x32_bf16 v[164:167], a[36:39], v[68:71], v[164:167]
ds_read_b128 a[8:11], v1 offset:26624
v_cvt_pk_bf16_f32 v60, v28, v29
v_mfma_f32_16x16x32_bf16 v[132:135], a[36:39], v[64:67], v[132:135]
v_exp_f32 v30, v30
v_mfma_f32_16x16x32_bf16 v[136:139], a[40:43], v[64:67], v[136:139]
v_exp_f32 v31, v31
v_mfma_f32_16x16x32_bf16 v[168:171], a[40:43], v[68:71], v[168:171]
ds_read_b128 a[12:15], v1 offset:27648
v_cvt_pk_bf16_f32 v61, v30, v31
v_mfma_f32_16x16x32_bf16 v[200:203], a[40:43], v[72:75], v[200:203]
v_mfma_f32_16x16x32_bf16 v[232:235], a[40:43], v[76:79], v[232:235]
v_exp_f32 v32, v32
v_mfma_f32_16x16x32_bf16 v[236:239], a[44:47], v[76:79], v[236:239]
v_exp_f32 v33, v33
v_mfma_f32_16x16x32_bf16 v[204:207], a[44:47], v[72:75], v[204:207]
ds_read_b128 a[16:19], v1 offset:28672
v_cvt_pk_bf16_f32 v50, v32, v33
v_mfma_f32_16x16x32_bf16 v[172:175], a[44:47], v[68:71], v[172:175]
v_exp_f32 v34, v34
v_mfma_f32_16x16x32_bf16 v[140:143], a[44:47], v[64:67], v[140:143]
buffer_load_dwordx4 v3, s[48:51], s7 offen offset:1024 sc1 lds
v_mfma_f32_16x16x32_bf16 v[144:147], a[48:51], v[64:67], v[144:147]
ds_read_b128 a[20:23], v1 offset:29696
v_mfma_f32_16x16x32_bf16 v[176:179], a[48:51], v[68:71], v[176:179]
v_mfma_f32_16x16x32_bf16 v[208:211], a[48:51], v[72:75], v[208:211]
v_exp_f32 v35, v35
v_mfma_f32_16x16x32_bf16 v[240:243], a[48:51], v[76:79], v[240:243]
ds_read_b128 a[24:27], v1 offset:30720
v_cvt_pk_bf16_f32 v51, v34, v35
v_mfma_f32_16x16x32_bf16 v[244:247], a[52:55], v[76:79], v[244:247]
v_exp_f32 v36, v36
v_mfma_f32_16x16x32_bf16 v[212:215], a[52:55], v[72:75], v[212:215]
v_exp_f32 v37, v37
v_mfma_f32_16x16x32_bf16 v[180:183], a[52:55], v[68:71], v[180:183]
ds_read_b128 a[28:31], v1 offset:31744
v_cvt_pk_bf16_f32 v54, v36, v37
v_mfma_f32_16x16x32_bf16 v[148:151], a[52:55], v[64:67], v[148:151]
v_mfma_f32_16x16x32_bf16 v[152:155], a[56:59], v[64:67], v[152:155]
v_exp_f32 v38, v38
v_mfma_f32_16x16x32_bf16 v[184:187], a[56:59], v[68:71], v[184:187]
v_exp_f32 v39, v39
v_mfma_f32_16x16x32_bf16 v[216:219], a[56:59], v[72:75], v[216:219]
buffer_load_dwordx4 v3, s[48:51], s7 offen offset:2048 sc1 lds
v_mfma_f32_16x16x32_bf16 v[248:251], a[56:59], v[76:79], v[248:251]
ds_read_b128 a[32:35], v1 offset:16384
v_cvt_pk_bf16_f32 v55, v38, v39
v_mfma_f32_16x16x32_bf16 v[252:255], a[60:63], v[76:79], v[252:255]
v_exp_f32 v40, v40
v_mfma_f32_16x16x32_bf16 v[220:223], a[60:63], v[72:75], v[220:223]
ds_read_b128 a[36:39], v1 offset:17408
v_mfma_f32_16x16x32_bf16 v[188:191], a[60:63], v[68:71], v[188:191]
v_mfma_f32_16x16x32_bf16 v[156:159], a[60:63], v[64:67], v[156:159]
v_exp_f32 v41, v41
v_smfmac_f32_16x16x64_bf16 a[224:227], a[232:235], v[64:71], v9
ds_read_b128 a[40:43], v1 offset:18432
v_cvt_pk_bf16_f32 v58, v40, v41
v_smfmac_f32_16x16x64_bf16 a[228:231], a[232:235], v[72:79], v9
s_waitcnt lgkmcnt(7)
v_exp_f32 v42, v42
v_mfma_f32_16x16x32_bf16 v[20:23], a[0:3], a[176:179], v[84:87]
s_mov_b32 s9, 0x400000
v_exp_f32 v43, v43
v_mfma_f32_16x16x32_bf16 v[20:23], a[4:7], a[180:183], v[20:23]
ds_read_b128 a[44:47], v1 offset:19456
v_cvt_pk_bf16_f32 v59, v42, v43
v_mfma_f32_16x16x32_bf16 v[20:23], a[8:11], a[184:187], v[20:23]
buffer_load_dword a244, v8, s[64:67], s9 offen
v_mfma_f32_16x16x32_bf16 v[20:23], a[12:15], a[188:191], v[20:23]
v_mfma_f32_16x16x32_bf16 v[24:27], a[0:3], a[192:195], v[88:91]
v_exp_f32 v44, v44
v_mfma_f32_16x16x32_bf16 v[24:27], a[4:7], a[196:199], v[24:27]
ds_read_b128 a[48:51], v1 offset:20480
v_mfma_f32_16x16x32_bf16 v[24:27], a[8:11], a[200:203], v[24:27]
v_exp_f32 v45, v45
v_mfma_f32_16x16x32_bf16 v[24:27], a[12:15], a[204:207], v[24:27]
v_exp_f32 v46, v46
v_mfma_f32_16x16x32_bf16 v[28:31], a[0:3], a[208:211], v[92:95]
ds_read_b128 a[52:55], v1 offset:21504
v_cvt_pk_bf16_f32 v62, v44, v45
v_mfma_f32_16x16x32_bf16 v[28:31], a[4:7], a[212:215], v[28:31]
v_mfma_f32_16x16x32_bf16 v[28:31], a[8:11], a[216:219], v[28:31]
s_waitcnt lgkmcnt(6)
v_exp_f32 v47, v47
v_mfma_f32_16x16x32_bf16 v[28:31], a[12:15], a[220:223], v[28:31]
ds_read_b128 a[56:59], v1 offset:22528
v_cvt_pk_bf16_f32 v63, v46, v47
v_mfma_f32_16x16x32_bf16 v[36:39], a[16:19], a[176:179], v[84:87]
buffer_load_dwordx4 v3, s[48:51], s7 offen offset:3072 sc1 lds
v_mfma_f32_16x16x32_bf16 v[36:39], a[20:23], a[180:183], v[36:39]
s_add_u32 s32, s32, 0x8000
v_exp_f32 v20, v20
v_mfma_f32_16x16x32_bf16 v[36:39], a[24:27], a[184:187], v[36:39]
ds_read_b128 a[60:63], v1 offset:23552
v_xor_b32 v1, 0x8000, v1
v_mfma_f32_16x16x32_bf16 v[36:39], a[28:31], a[188:191], v[36:39]
s_add_u32 s7, s7, 0x8000
v_exp_f32 v21, v21
v_mfma_f32_16x16x32_bf16 v[40:43], a[16:19], a[192:195], v[88:91]
s_xor_b32 s27, s27, 0x38000
v_cvt_pk_bf16_f32 v68, v20, v21
v_mfma_f32_16x16x32_bf16 v[40:43], a[20:23], a[196:199], v[40:43]
v_exp_f32 v22, v22
v_mfma_f32_16x16x32_bf16 v[40:43], a[24:27], a[200:203], v[40:43]
v_exp_f32 v23, v23
v_mfma_f32_16x16x32_bf16 v[40:43], a[28:31], a[204:207], v[40:43]
v_exp_f32 v24, v24
v_mfma_f32_16x16x32_bf16 v[44:47], a[16:19], a[208:211], v[92:95]
v_exp_f32 v25, v25
v_mfma_f32_16x16x32_bf16 v[44:47], a[20:23], a[212:215], v[44:47]
v_exp_f32 v26, v26
v_mfma_f32_16x16x32_bf16 v[44:47], a[24:27], a[216:219], v[44:47]
s_waitcnt vmcnt(19) lgkmcnt(0)
v_exp_f32 v27, v27
v_mfma_f32_16x16x32_bf16 v[44:47], a[28:31], a[220:223], v[44:47]
s_barrier
v_cvt_pk_bf16_f32 v69, v22, v23
L_att_l1_0:
v_mfma_f32_16x16x32_bf16 v[128:131], a[32:35], v[48:51], v[128:131]
ds_read_b128 a[0:3], v2 offset:8192
v_cvt_pk_bf16_f32 v72, v24, v25
v_mfma_f32_16x16x32_bf16 v[160:163], a[32:35], v[52:55], v[160:163]
v_exp_f32 v28, v28
v_mfma_f32_16x16x32_bf16 v[192:195], a[32:35], v[56:59], v[192:195]
s_add_u32 m0, s19, 0x0
v_cvt_pk_bf16_f32 v73, v26, v27
v_mfma_f32_16x16x32_bf16 v[224:227], a[32:35], v[60:63], v[224:227]
ds_read_b128 a[4:7], v2 offset:9216
v_mfma_f32_16x16x32_bf16 v[228:231], a[36:39], v[60:63], v[228:231]
buffer_load_dwordx4 v3, s[48:51], s32 offen offset:0 sc1 lds
v_mfma_f32_16x16x32_bf16 v[196:199], a[36:39], v[56:59], v[196:199]
v_exp_f32 v29, v29
v_mfma_f32_16x16x32_bf16 v[164:167], a[36:39], v[52:55], v[164:167]
ds_read_b128 a[8:11], v2 offset:10240
v_cvt_pk_bf16_f32 v76, v28, v29
v_mfma_f32_16x16x32_bf16 v[132:135], a[36:39], v[48:51], v[132:135]
v_exp_f32 v30, v30
v_mfma_f32_16x16x32_bf16 v[136:139], a[40:43], v[48:51], v[136:139]
v_mfma_f32_16x16x32_bf16 v[168:171], a[40:43], v[52:55], v[168:171]
ds_read_b128 a[12:15], v2 offset:11264
v_mfma_f32_16x16x32_bf16 v[200:203], a[40:43], v[56:59], v[200:203]
v_exp_f32 v31, v31
v_mfma_f32_16x16x32_bf16 v[232:235], a[40:43], v[60:63], v[232:235]
v_exp_f32 v36, v36
v_mfma_f32_16x16x32_bf16 v[236:239], a[44:47], v[60:63], v[236:239]
s_mov_b32 s9, 0x200000
v_cvt_pk_bf16_f32 v77, v30, v31
v_mfma_f32_16x16x32_bf16 v[204:207], a[44:47], v[56:59], v[204:207]
ds_read_b128 a[16:19], v2 offset:12288
v_mfma_f32_16x16x32_bf16 v[172:175], a[44:47], v[52:55], v[172:175]
buffer_load_dword a244, v8, s[64:67], s9 offen
v_mfma_f32_16x16x32_bf16 v[140:143], a[44:47], v[48:51], v[140:143]
v_exp_f32 v37, v37
v_mfma_f32_16x16x32_bf16 v[144:147], a[48:51], v[48:51], v[144:147]
ds_read_b128 a[20:23], v2 offset:13312
v_cvt_pk_bf16_f32 v70, v36, v37
v_mfma_f32_16x16x32_bf16 v[176:179], a[48:51], v[52:55], v[176:179]
v_exp_f32 v38, v38
v_mfma_f32_16x16x32_bf16 v[208:211], a[48:51], v[56:59], v[208:211]
v_mfma_f32_16x16x32_bf16 v[240:243], a[48:51], v[60:63], v[240:243]
ds_read_b128 a[24:27], v2 offset:14336
v_mfma_f32_16x16x32_bf16 v[244:247], a[52:55], v[60:63], v[244:247]
v_exp_f32 v39, v39
v_mfma_f32_16x16x32_bf16 v[212:215], a[52:55], v[56:59], v[212:215]
v_exp_f32 v40, v40
v_mfma_f32_16x16x32_bf16 v[180:183], a[52:55], v[52:55], v[180:183]
v_cvt_pk_bf16_f32 v71, v38, v39
v_mfma_f32_16x16x32_bf16 v[148:151], a[52:55], v[48:51], v[148:151]
buffer_load_dwordx4 v3, s[48:51], s32 offen offset:1024 sc1 lds
v_mfma_f32_16x16x32_bf16 v[152:155], a[56:59], v[48:51], v[152:155]
ds_read_b128 a[28:31], v2 offset:15360
v_mfma_f32_16x16x32_bf16 v[184:187], a[56:59], v[52:55], v[184:187]
v_exp_f32 v41, v41
v_mfma_f32_16x16x32_bf16 v[216:219], a[56:59], v[56:59], v[216:219]
ds_read_b128 a[32:35], v2 offset:0
v_cvt_pk_bf16_f32 v74, v40, v41
v_mfma_f32_16x16x32_bf16 v[248:251], a[56:59], v[60:63], v[248:251]
v_exp_f32 v42, v42
v_mfma_f32_16x16x32_bf16 v[252:255], a[60:63], v[60:63], v[252:255]
v_mfma_f32_16x16x32_bf16 v[220:223], a[60:63], v[56:59], v[220:223]
ds_read_b128 a[36:39], v2 offset:1024
v_mfma_f32_16x16x32_bf16 v[188:191], a[60:63], v[52:55], v[188:191]
v_exp_f32 v43, v43
v_mfma_f32_16x16x32_bf16 v[156:159], a[60:63], v[48:51], v[156:159]
s_waitcnt lgkmcnt(6)
v_exp_f32 v44, v44
v_smfmac_f32_16x16x64_bf16 a[224:227], a[232:235], v[48:55], v9
buffer_load_dwordx4 v3, s[48:51], s32 offen offset:2048 sc1 lds
v_smfmac_f32_16x16x64_bf16 a[228:231], a[232:235], v[56:63], v9
ds_read_b128 a[40:43], v2 offset:2048
v_cvt_pk_bf16_f32 v75, v42, v43
v_mfma_f32_16x16x32_bf16 v[20:23], a[0:3], a[176:179], v[84:87]
v_mfma_f32_16x16x32_bf16 v[20:23], a[4:7], a[180:183], v[20:23]
v_exp_f32 v45, v45
v_mfma_f32_16x16x32_bf16 v[20:23], a[8:11], a[184:187], v[20:23]
ds_read_b128 a[44:47], v2 offset:3072
v_cvt_pk_bf16_f32 v78, v44, v45
v_mfma_f32_16x16x32_bf16 v[20:23], a[12:15], a[188:191], v[20:23]
v_exp_f32 v46, v46
v_mfma_f32_16x16x32_bf16 v[24:27], a[0:3], a[192:195], v[88:91]
v_mfma_f32_16x16x32_bf16 v[24:27], a[4:7], a[196:199], v[24:27]
ds_read_b128 a[48:51], v2 offset:4096
v_mfma_f32_16x16x32_bf16 v[24:27], a[8:11], a[200:203], v[24:27]
v_exp_f32 v47, v47
v_mfma_f32_16x16x32_bf16 v[24:27], a[12:15], a[204:207], v[24:27]
s_nop 0
v_exp_f32 v20, v20
v_mfma_f32_16x16x32_bf16 v[28:31], a[0:3], a[208:211], v[92:95]
buffer_load_dwordx4 v3, s[48:51], s32 offen offset:3072 sc1 lds
v_mfma_f32_16x16x32_bf16 v[28:31], a[4:7], a[212:215], v[28:31]
ds_read_b128 a[52:55], v2 offset:5120
v_cvt_pk_bf16_f32 v79, v46, v47
v_mfma_f32_16x16x32_bf16 v[28:31], a[8:11], a[216:219], v[28:31]
v_mfma_f32_16x16x32_bf16 v[28:31], a[12:15], a[220:223], v[28:31]
s_waitcnt lgkmcnt(6)
v_exp_f32 v21, v21
v_mfma_f32_16x16x32_bf16 v[36:39], a[16:19], a[176:179], v[84:87]
ds_read_b128 a[56:59], v2 offset:6144
v_cvt_pk_bf16_f32 v52, v20, v21
v_mfma_f32_16x16x32_bf16 v[36:39], a[20:23], a[180:183], v[36:39]
v_exp_f32 v22, v22
v_mfma_f32_16x16x32_bf16 v[36:39], a[24:27], a[184:187], v[36:39]
v_mfma_f32_16x16x32_bf16 v[36:39], a[28:31], a[188:191], v[36:39]
ds_read_b128 a[60:63], v2 offset:7168
v_mfma_f32_16x16x32_bf16 v[40:43], a[16:19], a[192:195], v[88:91]
s_mov_b32 s9, 0x600000
v_exp_f32 v23, v23
v_mfma_f32_16x16x32_bf16 v[40:43], a[20:23], a[196:199], v[40:43]
buffer_load_dword a244, v8, s[64:67], s9 offen
v_mfma_f32_16x16x32_bf16 v[40:43], a[24:27], a[200:203], v[40:43]
v_exp_f32 v24, v24
v_mfma_f32_16x16x32_bf16 v[40:43], a[28:31], a[204:207], v[40:43]
v_cvt_pk_bf16_f32 v53, v22, v23
v_mfma_f32_16x16x32_bf16 v[44:47], a[16:19], a[208:211], v[92:95]
v_exp_f32 v25, v25
v_mfma_f32_16x16x32_bf16 v[44:47], a[20:23], a[212:215], v[44:47]
v_exp_f32 v26, v26
v_mfma_f32_16x16x32_bf16 v[44:47], a[24:27], a[216:219], v[44:47]
v_exp_f32 v27, v27
v_mfma_f32_16x16x32_bf16 v[44:47], a[28:31], a[220:223], v[44:47]
s_waitcnt lgkmcnt(0)
v_mfma_f32_16x16x32_bf16 v[160:163], a[32:35], v[68:71], v[160:163]
ds_read_b128 a[0:3], v2 offset:24576
v_cvt_pk_bf16_f32 v56, v24, v25
v_mfma_f32_16x16x32_bf16 v[192:195], a[32:35], v[72:75], v[192:195]
v_exp_f32 v28, v28
v_mfma_f32_16x16x32_bf16 v[224:227], a[32:35], v[76:79], v[224:227]
ds_read_b128 a[4:7], v2 offset:25600
v_cvt_pk_bf16_f32 v57, v26, v27
v_mfma_f32_16x16x32_bf16 v[228:231], a[36:39], v[76:79], v[228:231]
s_add_u32 m0, s19, 0x1000
v_mfma_f32_16x16x32_bf16 v[196:199], a[36:39], v[72:75], v[196:199]
buffer_load_dwordx4 v3, s[48:51], s7 offen offset:0 sc1 lds
v_mfma_f32_16x16x32_bf16 v[164:167], a[36:39], v[68:71], v[164:167]
ds_read_b128 a[8:11], v2 offset:26624
v_mfma_f32_16x16x32_bf16 v[168:171], a[40:43], v[68:71], v[168:171]
v_exp_f32 v29, v29
v_mfma_f32_16x16x32_bf16 v[200:203], a[40:43], v[72:75], v[200:203]
v_exp_f32 v30, v30
v_mfma_f32_16x16x32_bf16 v[232:235], a[40:43], v[76:79], v[232:235]
ds_read_b128 a[12:15], v2 offset:27648
v_cvt_pk_bf16_f32 v60, v28, v29
v_mfma_f32_16x16x32_bf16 v[236:239], a[44:47], v[76:79], v[236:239]
v_exp_f32 v31, v31
v_mfma_f32_16x16x32_bf16 v[204:207], a[44:47], v[72:75], v[204:207]
v_exp_f32 v36, v36
v_mfma_f32_16x16x32_bf16 v[172:175], a[44:47], v[68:71], v[172:175]
ds_read_b128 a[16:19], v2 offset:28672
v_cvt_pk_bf16_f32 v61, v30, v31
v_mfma_f32_16x16x32_bf16 v[176:179], a[48:51], v[68:71], v[176:179]
buffer_load_dwordx4 v3, s[48:51], s7 offen offset:1024 sc1 lds
v_mfma_f32_16x16x32_bf16 v[208:211], a[48:51], v[72:75], v[208:211]
ds_read_b128 a[20:23], v2 offset:29696
v_mfma_f32_16x16x32_bf16 v[240:243], a[48:51], v[76:79], v[240:243]
v_mfma_f32_16x16x32_bf16 v[244:247], a[52:55], v[76:79], v[244:247]
v_exp_f32 v37, v37
v_mfma_f32_16x16x32_bf16 v[212:215], a[52:55], v[72:75], v[212:215]
ds_read_b128 a[24:27], v2 offset:30720
v_cvt_pk_bf16_f32 v54, v36, v37
v_mfma_f32_16x16x32_bf16 v[180:183], a[52:55], v[68:71], v[180:183]
v_exp_f32 v38, v38
v_mfma_f32_16x16x32_bf16 v[184:187], a[56:59], v[68:71], v[184:187]
v_exp_f32 v39, v39
v_mfma_f32_16x16x32_bf16 v[216:219], a[56:59], v[72:75], v[216:219]
ds_read_b128 a[28:31], v2 offset:31744
v_cvt_pk_bf16_f32 v55, v38, v39
v_mfma_f32_16x16x32_bf16 v[248:251], a[56:59], v[76:79], v[248:251]
v_exp_f32 v40, v40
v_mfma_f32_16x16x32_bf16 v[252:255], a[60:63], v[76:79], v[252:255]
buffer_load_dwordx4 v3, s[48:51], s7 offen offset:2048 sc1 lds
v_mfma_f32_16x16x32_bf16 v[220:223], a[60:63], v[72:75], v[220:223]
ds_read_b128 a[32:35], v2 offset:16384
v_mfma_f32_16x16x32_bf16 v[188:191], a[60:63], v[68:71], v[188:191]
v_exp_f32 v41, v41
v_mfma_f32_16x16x32_bf16 a[224:227], a[236:239], v[68:71], a[224:227]
ds_read_b128 a[36:39], v2 offset:17408
v_cvt_pk_bf16_f32 v58, v40, v41
v_smfmac_f32_16x16x64_bf16 a[228:231], a[232:235], v[72:79], v9
s_waitcnt lgkmcnt(6)
v_exp_f32 v42, v42
v_mfma_f32_16x16x32_bf16 v[20:23], a[0:3], a[176:179], v[104:107]
v_exp_f32 v43, v43
v_mfma_f32_16x16x32_bf16 v[20:23], a[4:7], a[180:183], v[20:23]
ds_read_b128 a[40:43], v2 offset:18432
v_cvt_pk_bf16_f32 v59, v42, v43
v_mfma_f32_16x16x32_bf16 v[20:23], a[8:11], a[184:187], v[20:23]
v_exp_f32 v44, v44
v_mfma_f32_16x16x32_bf16 v[20:23], a[12:15], a[188:191], v[20:23]
buffer_load_dwordx4 v3, s[48:51], s7 offen offset:3072 sc1 lds
v_mfma_f32_16x16x32_bf16 v[24:27], a[0:3], a[192:195], v[88:91]
ds_read_b128 a[44:47], v2 offset:19456
v_mfma_f32_16x16x32_bf16 v[24:27], a[4:7], a[196:199], v[24:27]
v_exp_f32 v45, v45
v_mfma_f32_16x16x32_bf16 v[24:27], a[8:11], a[200:203], v[24:27]
v_exp_f32 v46, v46
v_mfma_f32_16x16x32_bf16 v[24:27], a[12:15], a[204:207], v[24:27]
ds_read_b128 a[48:51], v2 offset:20480
v_add_u32 v4, s0, v3
v_mfma_f32_16x16x32_bf16 v[28:31], a[0:3], a[208:211], v[92:95]
v_cvt_pk_bf16_f32 v62, v44, v45
v_mfma_f32_16x16x32_bf16 v[28:31], a[4:7], a[212:215], v[28:31]
ds_read_b128 a[52:55], v2 offset:21504
v_mov_b32 v5, s1
v_mfma_f32_16x16x32_bf16 v[28:31], a[8:11], a[216:219], v[28:31]
s_waitcnt lgkmcnt(6)
v_exp_f32 v47, v47
v_mfma_f32_16x16x32_bf16 v[28:31], a[12:15], a[220:223], v[28:31]
global_load_dword a244, v[4:5], off sc1
v_mfma_f32_16x16x32_bf16 v[36:39], a[16:19], a[176:179], v[108:111]
ds_read_b128 a[56:59], v2 offset:22528
v_cvt_pk_bf16_f32 v63, v46, v47
v_mfma_f32_16x16x32_bf16 v[36:39], a[20:23], a[180:183], v[36:39]
s_add_u32 s32, s32, 0x8000
v_exp_f32 v20, v20
v_mfma_f32_16x16x32_bf16 v[36:39], a[24:27], a[184:187], v[36:39]
s_add_u32 s7, s7, 0x8000
v_exp_f32 v21, v21
v_mfma_f32_16x16x32_bf16 v[36:39], a[28:31], a[188:191], v[36:39]
ds_read_b128 a[60:63], v2 offset:23552
v_xor_b32 v2, 0x38000, v2
v_mfma_f32_16x16x32_bf16 v[40:43], a[16:19], a[192:195], v[88:91]
s_xor_b32 s19, s19, 0x8000
v_exp_f32 v22, v22
v_mfma_f32_16x16x32_bf16 v[40:43], a[20:23], a[196:199], v[40:43]
s_sub_u32 s15, 7, s6
v_exp_f32 v23, v23
v_mfma_f32_16x16x32_bf16 v[40:43], a[24:27], a[200:203], v[40:43]
s_lshl_b32 s15, s15, 1
v_exp_f32 v24, v24
v_mfma_f32_16x16x32_bf16 v[40:43], a[28:31], a[204:207], v[40:43]
v_exp_f32 v25, v25
v_mfma_f32_16x16x32_bf16 v[44:47], a[16:19], a[208:211], v[92:95]
v_exp_f32 v26, v26
v_mfma_f32_16x16x32_bf16 v[44:47], a[20:23], a[212:215], v[44:47]
v_exp_f32 v27, v27
v_mfma_f32_16x16x32_bf16 v[44:47], a[24:27], a[216:219], v[44:47]
s_waitcnt vmcnt(22) lgkmcnt(0)
v_cvt_pk_bf16_f32 v68, v20, v21
v_cvt_pk_bf16_f32 v69, v22, v23
v_mfma_f32_16x16x32_bf16 v[44:47], a[28:31], a[220:223], v[44:47]
s_barrier
s_cbranch_scc0 L_att_lh0_0
s_cmp_lg_u32 s33, 0
s_cbranch_scc1 L_sig_bs0
s_lshl_b32 s8, s6, 2
s_add_u32 s8, s8, 192
s_cmp_lg_u32 s4, 0
s_cbranch_scc1 L_sig_bs0
v_mov_b32 v4, 1
s_mov_b64 exec, 1
buffer_atomic_add v4, off, s[84:87], s8 sc1
s_mov_b64 exec, -1
L_sig_bs0:
v_mfma_f32_16x16x32_bf16 v[160:163], a[32:35], v[52:55], v[160:163]
ds_read_b128 a[0:3], v1 offset:8192
v_cvt_pk_bf16_f32 v72, v24, v25
v_mfma_f32_16x16x32_bf16 v[192:195], a[32:35], v[56:59], v[192:195]
v_exp_f32 v28, v28
v_mfma_f32_16x16x32_bf16 v[224:227], a[32:35], v[60:63], v[224:227]
ds_read_b128 a[4:7], v1 offset:9216
v_cvt_pk_bf16_f32 v73, v26, v27
v_mfma_f32_16x16x32_bf16 v[228:231], a[36:39], v[60:63], v[228:231]
s_add_u32 m0, s27, 0x0
v_exp_f32 v29, v29
v_mfma_f32_16x16x32_bf16 v[196:199], a[36:39], v[56:59], v[196:199]
buffer_load_dwordx4 v3, s[48:51], s32 offen offset:0 sc1 lds
v_mfma_f32_16x16x32_bf16 v[164:167], a[36:39], v[52:55], v[164:167]
ds_read_b128 a[8:11], v1 offset:10240
v_cvt_pk_bf16_f32 v76, v28, v29
v_mfma_f32_16x16x32_bf16 v[168:171], a[40:43], v[52:55], v[168:171]
ds_read_b128 a[12:15], v1 offset:11264
v_accvgpr_read_b32 v6, a224
v_mfma_f32_16x16x32_bf16 v[200:203], a[40:43], v[56:59], v[200:203]
v_exp_f32 v30, v30
v_mfma_f32_16x16x32_bf16 v[232:235], a[40:43], v[60:63], v[232:235]
v_exp_f32 v31, v31
v_mfma_f32_16x16x32_bf16 v[236:239], a[44:47], v[60:63], v[236:239]
ds_read_b128 a[16:19], v1 offset:12288
v_cvt_pk_bf16_f32 v77, v30, v31
v_mfma_f32_16x16x32_bf16 v[204:207], a[44:47], v[56:59], v[204:207]
v_exp_f32 v36, v36
v_mfma_f32_16x16x32_bf16 v[172:175], a[44:47], v[52:55], v[172:175]
ds_read_b128 a[20:23], v1 offset:13312
v_accvgpr_read_b32 v7, a225
v_mfma_f32_16x16x32_bf16 v[176:179], a[48:51], v[52:55], v[176:179]
v_exp_f32 v37, v37
v_mfma_f32_16x16x32_bf16 v[208:211], a[48:51], v[56:59], v[208:211]
ds_read_b128 a[24:27], v1 offset:14336
v_cvt_pk_bf16_f32 v70, v36, v37
v_mfma_f32_16x16x32_bf16 v[240:243], a[48:51], v[60:63], v[240:243]
buffer_load_dwordx4 v3, s[48:51], s32 offen offset:1024 sc1 lds
v_mfma_f32_16x16x32_bf16 v[244:247], a[52:55], v[60:63], v[244:247]
v_exp_f32 v38, v38
v_mfma_f32_16x16x32_bf16 v[212:215], a[52:55], v[56:59], v[212:215]
ds_read_b128 a[28:31], v1 offset:15360
v_add_f32 v6, v6, v7
v_mfma_f32_16x16x32_bf16 v[180:183], a[52:55], v[52:55], v[180:183]
v_exp_f32 v39, v39
v_mfma_f32_16x16x32_bf16 v[184:187], a[56:59], v[52:55], v[184:187]
ds_read_b128 a[32:35], v1 offset:0
v_cvt_pk_bf16_f32 v71, v38, v39
v_mfma_f32_16x16x32_bf16 v[216:219], a[56:59], v[56:59], v[216:219]
v_exp_f32 v40, v40
v_mfma_f32_16x16x32_bf16 v[248:251], a[56:59], v[60:63], v[248:251]
ds_read_b128 a[36:39], v1 offset:1024
v_cmp_nge_f32 vcc, 0x5f800000, v6
v_mfma_f32_16x16x32_bf16 v[252:255], a[60:63], v[60:63], v[252:255]
v_exp_f32 v41, v41
v_mfma_f32_16x16x32_bf16 v[220:223], a[60:63], v[56:59], v[220:223]
v_exp_f32 v42, v42
v_mfma_f32_16x16x32_bf16 v[188:191], a[60:63], v[52:55], v[188:191]
ds_read_b128 a[40:43], v1 offset:2048
v_cvt_pk_bf16_f32 v74, v40, v41
v_mfma_f32_16x16x32_bf16 a[224:227], a[236:239], v[52:55], a[224:227]
buffer_load_dwordx4 v3, s[48:51], s32 offen offset:2048 sc1 lds
v_smfmac_f32_16x16x64_bf16 a[228:231], a[232:235], v[56:63], v9
ds_read_b128 a[44:47], v1 offset:3072
s_waitcnt lgkmcnt(8)
v_mfma_f32_16x16x32_bf16 v[24:27], a[0:3], a[192:195], v[88:91]
v_exp_f32 v43, v43
v_mfma_f32_16x16x32_bf16 v[24:27], a[4:7], a[196:199], v[24:27]
ds_read_b128 a[48:51], v1 offset:4096
v_cvt_pk_bf16_f32 v75, v42, v43
v_mfma_f32_16x16x32_bf16 v[24:27], a[8:11], a[200:203], v[24:27]
v_exp_f32 v44, v44
v_mfma_f32_16x16x32_bf16 v[24:27], a[12:15], a[204:207], v[24:27]
v_exp_f32 v45, v45
v_mfma_f32_16x16x32_bf16 v[28:31], a[0:3], a[208:211], v[92:95]
ds_read_b128 a[52:55], v1 offset:5120
v_cvt_pk_bf16_f32 v78, v44, v45
v_mfma_f32_16x16x32_bf16 v[28:31], a[4:7], a[212:215], v[28:31]
v_exp_f32 v46, v46
v_mfma_f32_16x16x32_bf16 v[28:31], a[8:11], a[216:219], v[28:31]
ds_read_b128 a[56:59], v1 offset:6144
v_mfma_f32_16x16x32_bf16 v[28:31], a[12:15], a[220:223], v[28:31]
s_waitcnt lgkmcnt(7)
v_exp_f32 v47, v47
v_mfma_f32_16x16x32_bf16 v[40:43], a[16:19], a[192:195], v[88:91]
buffer_load_dwordx4 v3, s[48:51], s32 offen offset:3072 sc1 lds
v_mfma_f32_16x16x32_bf16 v[40:43], a[20:23], a[196:199], v[40:43]
ds_read_b128 a[60:63], v1 offset:7168
v_cvt_pk_bf16_f32 v79, v46, v47
v_mfma_f32_16x16x32_bf16 v[40:43], a[24:27], a[200:203], v[40:43]
s_add_u32 s32, s32, 0x8000
v_exp_f32 v24, v24
v_mfma_f32_16x16x32_bf16 v[40:43], a[28:31], a[204:207], v[40:43]
v_exp_f32 v25, v25
v_mfma_f32_16x16x32_bf16 v[44:47], a[16:19], a[208:211], v[92:95]
v_exp_f32 v26, v26
v_mfma_f32_16x16x32_bf16 v[44:47], a[20:23], a[212:215], v[44:47]
v_exp_f32 v27, v27
v_mfma_f32_16x16x32_bf16 v[44:47], a[24:27], a[216:219], v[44:47]
v_exp_f32 v28, v28
v_mfma_f32_16x16x32_bf16 v[44:47], a[28:31], a[220:223], v[44:47]
s_waitcnt lgkmcnt(0)
v_exp_f32 v29, v29
v_mfma_f32_16x16x32_bf16 v[160:163], a[32:35], v[68:71], v[160:163]
ds_read_b128 a[0:3], v1 offset:24576
v_cvt_pk_bf16_f32 v56, v24, v25
v_mfma_f32_16x16x32_bf16 v[192:195], a[32:35], v[72:75], v[192:195]
v_exp_f32 v30, v30
v_mfma_f32_16x16x32_bf16 v[224:227], a[32:35], v[76:79], v[224:227]
ds_read_b128 a[4:7], v1 offset:25600
v_cvt_pk_bf16_f32 v57, v26, v27
v_mfma_f32_16x16x32_bf16 v[228:231], a[36:39], v[76:79], v[228:231]
s_add_u32 m0, s27, 0x1000
v_cvt_pk_bf16_f32 v60, v28, v29
v_mfma_f32_16x16x32_bf16 v[196:199], a[36:39], v[72:75], v[196:199]
buffer_load_dwordx4 v3, s[48:51], s7 offen offset:0 sc1 lds
v_mfma_f32_16x16x32_bf16 v[164:167], a[36:39], v[68:71], v[164:167]
ds_read_b128 a[8:11], v1 offset:26624
v_mfma_f32_16x16x32_bf16 v[168:171], a[40:43], v[68:71], v[168:171]
ds_read_b128 a[12:15], v1 offset:27648
v_mfma_f32_16x16x32_bf16 v[200:203], a[40:43], v[72:75], v[200:203]
v_exp_f32 v31, v31
v_mfma_f32_16x16x32_bf16 v[232:235], a[40:43], v[76:79], v[232:235]
v_exp_f32 v40, v40
v_mfma_f32_16x16x32_bf16 v[236:239], a[44:47], v[76:79], v[236:239]
ds_read_b128 a[16:19], v1 offset:28672
v_cvt_pk_bf16_f32 v61, v30, v31
v_mfma_f32_16x16x32_bf16 v[204:207], a[44:47], v[72:75], v[204:207]
v_exp_f32 v41, v41
v_mfma_f32_16x16x32_bf16 v[172:175], a[44:47], v[68:71], v[172:175]
ds_read_b128 a[20:23], v1 offset:29696
v_cvt_pk_bf16_f32 v58, v40, v41
v_mfma_f32_16x16x32_bf16 v[176:179], a[48:51], v[68:71], v[176:179]
v_rcp_f32 v6, v6
v_mfma_f32_16x16x32_bf16 v[208:211], a[48:51], v[72:75], v[208:211]
buffer_load_dwordx4 v3, s[48:51], s7 offen offset:1024 sc1 lds
v_mfma_f32_16x16x32_bf16 v[240:243], a[48:51], v[76:79], v[240:243]
ds_read_b128 a[24:27], v1 offset:30720
s_or_b64 s[34:35], s[34:35], vcc
v_mfma_f32_16x16x32_bf16 v[244:247], a[52:55], v[76:79], v[244:247]
ds_read_b128 a[28:31], v1 offset:31744
s_add_u32 s8, s28, 0x0
v_mfma_f32_16x16x32_bf16 v[212:215], a[52:55], v[72:75], v[212:215]
v_exp_f32 v42, v42
v_mfma_f32_16x16x32_bf16 v[180:183], a[52:55], v[68:71], v[180:183]
v_exp_f32 v43, v43
v_mfma_f32_16x16x32_bf16 v[184:187], a[56:59], v[68:71], v[184:187]
ds_read_b128 a[32:35], v1 offset:16384
v_cvt_pk_bf16_f32 v59, v42, v43
v_mfma_f32_16x16x32_bf16 v[216:219], a[56:59], v[72:75], v[216:219]
v_exp_f32 v44, v44
v_mfma_f32_16x16x32_bf16 v[248:251], a[56:59], v[76:79], v[248:251]
ds_read_b128 a[36:39], v1 offset:17408
v_mul_f32 v128, v6, v128
v_mfma_f32_16x16x32_bf16 v[252:255], a[60:63], v[76:79], v[252:255]
v_mul_f32 v129, v6, v129
v_mul_f32 v130, v6, v130
v_mfma_f32_16x16x32_bf16 v[220:223], a[60:63], v[72:75], v[220:223]
ds_read_b128 a[40:43], v1 offset:18432
v_mul_f32 v131, v6, v131
v_mfma_f32_16x16x32_bf16 v[188:191], a[60:63], v[68:71], v[188:191]
buffer_load_dwordx4 v3, s[48:51], s7 offen offset:2048 sc1 lds
v_mfma_f32_16x16x32_bf16 a[224:227], a[236:239], v[68:71], a[224:227]
ds_read_b128 a[44:47], v1 offset:19456
v_mul_f32 v132, v6, v132
v_smfmac_f32_16x16x64_bf16 a[228:231], a[232:235], v[72:79], v9
s_waitcnt lgkmcnt(8)
v_exp_f32 v45, v45
v_mfma_f32_16x16x32_bf16 v[24:27], a[0:3], a[192:195], v[88:91]
v_exp_f32 v46, v46
v_mfma_f32_16x16x32_bf16 v[24:27], a[4:7], a[196:199], v[24:27]
ds_read_b128 a[48:51], v1 offset:20480
v_cvt_pk_bf16_f32 v62, v44, v45
v_mfma_f32_16x16x32_bf16 v[24:27], a[8:11], a[200:203], v[24:27]
v_exp_f32 v47, v47
v_mfma_f32_16x16x32_bf16 v[24:27], a[12:15], a[204:207], v[24:27]
ds_read_b128 a[52:55], v1 offset:21504
v_cvt_pk_bf16_f32 v63, v46, v47
v_mfma_f32_16x16x32_bf16 v[28:31], a[0:3], a[208:211], v[92:95]
v_mul_f32 v133, v6, v133
v_mul_f32 v134, v6, v134
v_mfma_f32_16x16x32_bf16 v[28:31], a[4:7], a[212:215], v[28:31]
ds_read_b128 a[56:59], v1 offset:22528
v_mul_f32 v135, v6, v135
v_mfma_f32_16x16x32_bf16 v[28:31], a[8:11], a[216:219], v[28:31]
buffer_load_dwordx4 v3, s[48:51], s7 offen offset:3072 sc1 lds
v_mfma_f32_16x16x32_bf16 v[28:31], a[12:15], a[220:223], v[28:31]
ds_read_b128 a[60:63], v1 offset:23552
s_waitcnt lgkmcnt(8)
v_mfma_f32_16x16x32_bf16 v[40:43], a[16:19], a[192:195], v[88:91]
s_add_u32 s7, s7, 0x8000
v_xor_b32 v1, 0x8000, v1
v_cvt_pk_bf16_f32 v128, v128, v129
v_mfma_f32_16x16x32_bf16 v[40:43], a[20:23], a[196:199], v[40:43]
s_xor_b32 s27, s27, 0x38000
v_exp_f32 v24, v24
v_mfma_f32_16x16x32_bf16 v[40:43], a[24:27], a[200:203], v[40:43]
v_exp_f32 v25, v25
v_mfma_f32_16x16x32_bf16 v[40:43], a[28:31], a[204:207], v[40:43]
v_exp_f32 v26, v26
v_mfma_f32_16x16x32_bf16 v[44:47], a[16:19], a[208:211], v[92:95]
v_exp_f32 v27, v27
v_mfma_f32_16x16x32_bf16 v[44:47], a[20:23], a[212:215], v[44:47]
v_exp_f32 v28, v28
v_mfma_f32_16x16x32_bf16 v[44:47], a[24:27], a[216:219], v[44:47]
s_waitcnt vmcnt(19) lgkmcnt(0)
v_exp_f32 v29, v29
v_mfma_f32_16x16x32_bf16 v[44:47], a[28:31], a[220:223], v[44:47]
s_barrier
v_cvt_pk_bf16_f32 v129, v130, v131
v_cvt_pk_bf16_f32 v130, v132, v133
v_cvt_pk_bf16_f32 v131, v134, v135
buffer_store_dwordx4 v[128:131], v3, s[88:91], s8 offen sc1
s_add_u32 s8, s28, 0x2000
v_mul_f32 v136, v6, v136
v_mul_f32 v137, v6, v137
v_mul_f32 v138, v6, v138
v_mul_f32 v139, v6, v139
v_mul_f32 v140, v6, v140
v_mul_f32 v141, v6, v141
v_mul_f32 v142, v6, v142
v_mul_f32 v143, v6, v143
v_cvt_pk_bf16_f32 v136, v136, v137
v_cvt_pk_bf16_f32 v137, v138, v139
v_cvt_pk_bf16_f32 v138, v140, v141
v_cvt_pk_bf16_f32 v139, v142, v143
buffer_store_dwordx4 v[136:139], v3, s[88:91], s8 offen sc1
s_add_u32 s8, s28, 0x4000
v_mul_f32 v144, v6, v144
v_mul_f32 v145, v6, v145
v_mul_f32 v146, v6, v146
v_mul_f32 v147, v6, v147
v_mul_f32 v148, v6, v148
v_mul_f32 v149, v6, v149
v_mul_f32 v150, v6, v150
v_mul_f32 v151, v6, v151
v_cvt_pk_bf16_f32 v144, v144, v145
v_cvt_pk_bf16_f32 v145, v146, v147
v_cvt_pk_bf16_f32 v146, v148, v149
v_cvt_pk_bf16_f32 v147, v150, v151
buffer_store_dwordx4 v[144:147], v3, s[88:91], s8 offen sc1
s_add_u32 s8, s28, 0x6000
v_mul_f32 v152, v6, v152
v_mul_f32 v153, v6, v153
v_mul_f32 v154, v6, v154
v_mul_f32 v155, v6, v155
v_mul_f32 v156, v6, v156
v_mul_f32 v157, v6, v157
v_mul_f32 v158, v6, v158
v_mul_f32 v159, v6, v159
v_cvt_pk_bf16_f32 v152, v152, v153
v_cvt_pk_bf16_f32 v153, v154, v155
v_cvt_pk_bf16_f32 v154, v156, v157
v_cvt_pk_bf16_f32 v155, v158, v159
buffer_store_dwordx4 v[152:155], v3, s[88:91], s8 offen sc1
v_accvgpr_read_b32 v6, a226
v_accvgpr_read_b32 v7, a227
v_add_f32 v6, v6, v7
v_cmp_nge_f32 vcc, 0x5f800000, v6
v_rcp_f32 v6, v6
s_or_b64 s[34:35], s[34:35], vcc
s_add_u32 s8, s29, 0x0
v_pk_mul_f32 v[160:161], v[160:161], v[6:7] op_sel_hi:[1,0]
v_pk_mul_f32 v[162:163], v[162:163], v[6:7] op_sel_hi:[1,0]
v_pk_mul_f32 v[164:165], v[164:165], v[6:7] op_sel_hi:[1,0]
v_pk_mul_f32 v[166:167], v[166:167], v[6:7] op_sel_hi:[1,0]
v_cvt_pk_bf16_f32 v160, v160, v161
v_cvt_pk_bf16_f32 v161, v162, v163
v_cvt_pk_bf16_f32 v162, v164, v165
v_cvt_pk_bf16_f32 v163, v166, v167
buffer_store_dwordx4 v[160:163], v3, s[88:91], s8 offen sc1
s_add_u32 s8, s29, 0x2000
v_pk_mul_f32 v[168:169], v[168:169], v[6:7] op_sel_hi:[1,0]
v_pk_mul_f32 v[170:171], v[170:171], v[6:7] op_sel_hi:[1,0]
v_pk_mul_f32 v[172:173], v[172:173], v[6:7] op_sel_hi:[1,0]
v_pk_mul_f32 v[174:175], v[174:175], v[6:7] op_sel_hi:[1,0]
v_cvt_pk_bf16_f32 v168, v168, v169
v_cvt_pk_bf16_f32 v169, v170, v171
v_cvt_pk_bf16_f32 v170, v172, v173
v_cvt_pk_bf16_f32 v171, v174, v175
buffer_store_dwordx4 v[168:171], v3, s[88:91], s8 offen sc1
s_add_u32 s8, s29, 0x4000
v_pk_mul_f32 v[176:177], v[176:177], v[6:7] op_sel_hi:[1,0]
v_pk_mul_f32 v[178:179], v[178:179], v[6:7] op_sel_hi:[1,0]
v_pk_mul_f32 v[180:181], v[180:181], v[6:7] op_sel_hi:[1,0]
v_pk_mul_f32 v[182:183], v[182:183], v[6:7] op_sel_hi:[1,0]
v_cvt_pk_bf16_f32 v176, v176, v177
v_cvt_pk_bf16_f32 v177, v178, v179
v_cvt_pk_bf16_f32 v178, v180, v181
v_cvt_pk_bf16_f32 v179, v182, v183
buffer_store_dwordx4 v[176:179], v3, s[88:91], s8 offen sc1
s_add_u32 s8, s29, 0x6000
v_pk_mul_f32 v[184:185], v[184:185], v[6:7] op_sel_hi:[1,0]
v_pk_mul_f32 v[186:187], v[186:187], v[6:7] op_sel_hi:[1,0]
v_pk_mul_f32 v[188:189], v[188:189], v[6:7] op_sel_hi:[1,0]
v_pk_mul_f32 v[190:191], v[190:191], v[6:7] op_sel_hi:[1,0]
v_cvt_pk_bf16_f32 v184, v184, v185
v_cvt_pk_bf16_f32 v185, v186, v187
v_cvt_pk_bf16_f32 v186, v188, v189
v_cvt_pk_bf16_f32 v187, v190, v191
buffer_store_dwordx4 v[184:187], v3, s[88:91], s8 offen sc1
s_branch L_att_sodd
L_att_lh0_0:
s_cmp_lg_u32 s33, 0
s_cbranch_scc1 L_sig_bh0
s_lshl_b32 s8, s6, 2
s_add_u32 s8, s8, 192
s_cmp_lg_u32 s4, 0
s_cbranch_scc1 L_sig_bh0
v_mov_b32 v4, 1
s_mov_b64 exec, 1
buffer_atomic_add v4, off, s[84:87], s8 sc1
s_mov_b64 exec, -1
L_sig_bh0:
v_mfma_f32_16x16x32_bf16 v[160:163], a[32:35], v[52:55], v[160:163]
v_exp_f32 v28, v28
v_mfma_f32_16x16x32_bf16 v[192:195], a[32:35], v[56:59], v[192:195]
buffer_load_dword v14, v15, s[84:87], 0 offen offset:192 sc1
v_mfma_f32_16x16x32_bf16 v[224:227], a[32:35], v[60:63], v[224:227]
v_exp_f32 v29, v29
v_mfma_f32_16x16x32_bf16 v[228:231], a[36:39], v[60:63], v[228:231]
v_exp_f32 v30, v30
v_mfma_f32_16x16x32_bf16 v[196:199], a[36:39], v[56:59], v[196:199]
s_add_u32 m0, s17, 0x10000
v_exp_f32 v31, v31
v_mfma_f32_16x16x32_bf16 v[164:167], a[36:39], v[52:55], v[164:167]
ds_read_b128 a[0:3], v1 offset:8192
v_cvt_pk_bf16_f32 v72, v24, v25
v_mfma_f32_16x16x32_bf16 v[168:171], a[40:43], v[52:55], v[168:171]
ds_read_b128 a[4:7], v1 offset:9216
v_cvt_pk_bf16_f32 v73, v26, v27
v_mfma_f32_16x16x32_bf16 v[200:203], a[40:43], v[56:59], v[200:203]
buffer_load_dwordx4 v12, s[72:75], 0 offen lds
v_mfma_f32_16x16x32_bf16 v[232:235], a[40:43], v[60:63], v[232:235]
ds_read_b128 a[8:11], v1 offset:10240
v_cvt_pk_bf16_f32 v76, v28, v29
v_mfma_f32_16x16x32_bf16 v[236:239], a[44:47], v[60:63], v[236:239]
v_exp_f32 v36, v36
v_mfma_f32_16x16x32_bf16 v[204:207], a[44:47], v[56:59], v[204:207]
v_exp_f32 v37, v37
v_mfma_f32_16x16x32_bf16 v[172:175], a[44:47], v[52:55], v[172:175]
ds_read_b128 a[12:15], v1 offset:11264
v_cvt_pk_bf16_f32 v77, v30, v31
v_mfma_f32_16x16x32_bf16 v[176:179], a[48:51], v[52:55], v[176:179]
buffer_load_dwordx4 v13, s[72:75], 0 offen offset:1024 lds
v_mfma_f32_16x16x32_bf16 v[208:211], a[48:51], v[56:59], v[208:211]
ds_read_b128 a[16:19], v1 offset:12288
v_cvt_pk_bf16_f32 v70, v36, v37
v_mfma_f32_16x16x32_bf16 v[240:243], a[48:51], v[60:63], v[240:243]
ds_read_b128 a[20:23], v1 offset:13312
v_exp_f32 v38, v38
v_mfma_f32_16x16x32_bf16 v[244:247], a[52:55], v[60:63], v[244:247]
ds_read_b128 a[24:27], v1 offset:14336
v_exp_f32 v39, v39
v_mfma_f32_16x16x32_bf16 v[212:215], a[52:55], v[56:59], v[212:215]
v_exp_f32 v40, v40
v_mfma_f32_16x16x32_bf16 v[180:183], a[52:55], v[52:55], v[180:183]
buffer_load_dwordx4 v12, s[72:75], s12 offen offset:2048 lds
v_mfma_f32_16x16x32_bf16 v[184:187], a[56:59], v[52:55], v[184:187]
ds_read_b128 a[28:31], v1 offset:15360
v_exp_f32 v41, v41
v_mfma_f32_16x16x32_bf16 v[216:219], a[56:59], v[56:59], v[216:219]
buffer_load_dwordx4 v13, s[72:75], s12 offen offset:3072 lds
v_mfma_f32_16x16x32_bf16 v[248:251], a[56:59], v[60:63], v[248:251]
s_add_u32 m0, s17, 0x14000
v_exp_f32 v42, v42
v_mfma_f32_16x16x32_bf16 v[252:255], a[60:63], v[60:63], v[252:255]
ds_read_b128 a[32:35], v1 offset:0
v_cvt_pk_bf16_f32 v71, v38, v39
v_mfma_f32_16x16x32_bf16 v[220:223], a[60:63], v[56:59], v[220:223]
ds_read_b128 a[36:39], v1 offset:1024
v_add_u32 v12, 0x20000, v12
v_mfma_f32_16x16x32_bf16 v[188:191], a[60:63], v[52:55], v[188:191]
buffer_load_dwordx4 v12, s[72:75], 0 offen lds
v_mfma_f32_16x16x32_bf16 a[224:227], a[236:239], v[52:55], a[224:227]
ds_read_b128 a[40:43], v1 offset:2048
v_exp_f32 v43, v43
v_smfmac_f32_16x16x64_bf16 a[228:231], a[232:235], v[56:63], v9
s_waitcnt lgkmcnt(7)
v_exp_f32 v44, v44
v_mfma_f32_16x16x32_bf16 v[24:27], a[0:3], a[192:195], v[112:115]
ds_read_b128 a[44:47], v1 offset:3072
v_exp_f32 v45, v45
v_mfma_f32_16x16x32_bf16 v[24:27], a[4:7], a[196:199], v[24:27]
ds_read_b128 a[48:51], v1 offset:4096
v_add_u32 v13, 0x20000, v13
v_mfma_f32_16x16x32_bf16 v[24:27], a[8:11], a[200:203], v[24:27]
v_exp_f32 v46, v46
v_mfma_f32_16x16x32_bf16 v[24:27], a[12:15], a[204:207], v[24:27]
buffer_load_dwordx4 v13, s[72:75], 0 offen offset:1024 lds
v_mfma_f32_16x16x32_bf16 v[28:31], a[0:3], a[208:211], v[92:95]
v_exp_f32 v47, v47
v_mfma_f32_16x16x32_bf16 v[28:31], a[4:7], a[212:215], v[28:31]
ds_read_b128 a[52:55], v1 offset:5120
v_cvt_pk_bf16_f32 v74, v40, v41
v_mfma_f32_16x16x32_bf16 v[28:31], a[8:11], a[216:219], v[28:31]
ds_read_b128 a[56:59], v1 offset:6144
v_cvt_pk_bf16_f32 v75, v42, v43
v_mfma_f32_16x16x32_bf16 v[28:31], a[12:15], a[220:223], v[28:31]
s_waitcnt lgkmcnt(7)
v_exp_f32 v24, v24
v_mfma_f32_16x16x32_bf16 v[40:43], a[16:19], a[192:195], v[116:119]
buffer_load_dwordx4 v12, s[72:75], s12 offen offset:2048 lds
v_mfma_f32_16x16x32_bf16 v[40:43], a[20:23], a[196:199], v[40:43]
ds_read_b128 a[60:63], v1 offset:7168
v_cvt_pk_bf16_f32 v78, v44, v45
v_mfma_f32_16x16x32_bf16 v[40:43], a[24:27], a[200:203], v[40:43]
v_exp_f32 v25, v25
v_mfma_f32_16x16x32_bf16 v[40:43], a[28:31], a[204:207], v[40:43]
buffer_load_dwordx4 v13, s[72:75], s12 offen offset:3072 lds
v_cvt_pk_bf16_f32 v79, v46, v47
v_mfma_f32_16x16x32_bf16 v[44:47], a[16:19], a[208:211], v[92:95]
v_exp_f32 v26, v26
v_mfma_f32_16x16x32_bf16 v[44:47], a[20:23], a[212:215], v[44:47]
v_exp_f32 v27, v27
v_mfma_f32_16x16x32_bf16 v[44:47], a[24:27], a[216:219], v[44:47]
v_exp_f32 v28, v28
v_mfma_f32_16x16x32_bf16 v[44:47], a[28:31], a[220:223], v[44:47]
s_waitcnt lgkmcnt(0)
v_exp_f32 v29, v29
v_mfma_f32_16x16x32_bf16 v[160:163], a[32:35], v[68:71], v[160:163]
ds_read_b128 a[0:3], v1 offset:24576
v_cvt_pk_bf16_f32 v56, v24, v25
v_mfma_f32_16x16x32_bf16 v[192:195], a[32:35], v[72:75], v[192:195]
ds_read_b128 a[4:7], v1 offset:25600
v_add_u32 v12, 0x20000, v12
v_mfma_f32_16x16x32_bf16 v[224:227], a[32:35], v[76:79], v[224:227]
s_add_u32 m0, s16, 0x0
v_exp_f32 v30, v30
v_mfma_f32_16x16x32_bf16 v[228:231], a[36:39], v[76:79], v[228:231]
buffer_load_dwordx4 v12, s[72:75], 0 offen lds
v_mfma_f32_16x16x32_bf16 v[196:199], a[36:39], v[72:75], v[196:199]
ds_read_b128 a[8:11], v1 offset:26624
v_add_u32 v13, 0x20000, v13
v_mfma_f32_16x16x32_bf16 v[164:167], a[36:39], v[68:71], v[164:167]
buffer_load_dwordx4 v13, s[72:75], 0 offen offset:1024 lds
v_mfma_f32_16x16x32_bf16 v[168:171], a[40:43], v[68:71], v[168:171]
ds_read_b128 a[12:15], v1 offset:27648
v_cvt_pk_bf16_f32 v57, v26, v27
v_mfma_f32_16x16x32_bf16 v[200:203], a[40:43], v[72:75], v[200:203]
v_exp_f32 v31, v31
v_mfma_f32_16x16x32_bf16 v[232:235], a[40:43], v[76:79], v[232:235]
ds_read_b128 a[16:19], v1 offset:28672
v_cvt_pk_bf16_f32 v60, v28, v29
v_mfma_f32_16x16x32_bf16 v[236:239], a[44:47], v[76:79], v[236:239]
buffer_load_dwordx4 v12, s[72:75], s12 offen offset:2048 lds
v_mfma_f32_16x16x32_bf16 v[204:207], a[44:47], v[72:75], v[204:207]
ds_read_b128 a[20:23], v1 offset:29696
v_cvt_pk_bf16_f32 v61, v30, v31
v_mfma_f32_16x16x32_bf16 v[172:175], a[44:47], v[68:71], v[172:175]
buffer_load_dwordx4 v13, s[72:75], s12 offen offset:3072 lds
v_mfma_f32_16x16x32_bf16 v[176:179], a[48:51], v[68:71], v[176:179]
ds_read_b128 a[24:27], v1 offset:30720
v_mfma_f32_16x16x32_bf16 v[208:211], a[48:51], v[72:75], v[208:211]
ds_read_b128 a[28:31], v1 offset:31744
v_mfma_f32_16x16x32_bf16 v[240:243], a[48:51], v[76:79], v[240:243]
v_exp_f32 v40, v40
v_mfma_f32_16x16x32_bf16 v[244:247], a[52:55], v[76:79], v[244:247]
s_add_u32 m0, s16, 0x4000
v_exp_f32 v41, v41
v_mfma_f32_16x16x32_bf16 v[212:215], a[52:55], v[72:75], v[212:215]
ds_read_b128 a[32:35], v1 offset:16384
v_cvt_pk_bf16_f32 v58, v40, v41
v_mfma_f32_16x16x32_bf16 v[180:183], a[52:55], v[68:71], v[180:183]
ds_read_b128 a[36:39], v1 offset:17408
v_add_u32 v12, 0x20000, v12
v_mfma_f32_16x16x32_bf16 v[184:187], a[56:59], v[68:71], v[184:187]
buffer_load_dwordx4 v12, s[72:75], 0 offen lds
v_mfma_f32_16x16x32_bf16 v[216:219], a[56:59], v[72:75], v[216:219]
ds_read_b128 a[40:43], v1 offset:18432
v_mfma_f32_16x16x32_bf16 v[248:251], a[56:59], v[76:79], v[248:251]
v_exp_f32 v42, v42
v_mfma_f32_16x16x32_bf16 v[252:255], a[60:63], v[76:79], v[252:255]
ds_read_b128 a[44:47], v1 offset:19456
v_add_u32 v13, 0x20000, v13
v_mfma_f32_16x16x32_bf16 v[220:223], a[60:63], v[72:75], v[220:223]
buffer_load_dwordx4 v13, s[72:75], 0 offen offset:1024 lds
v_mfma_f32_16x16x32_bf16 v[188:191], a[60:63], v[68:71], v[188:191]
ds_read_b128 a[48:51], v1 offset:20480
v_exp_f32 v43, v43
v_mfma_f32_16x16x32_bf16 a[224:227], a[236:239], v[68:71], a[224:227]
s_waitcnt lgkmcnt(9)
v_exp_f32 v44, v44
v_smfmac_f32_16x16x64_bf16 a[228:231], a[232:235], v[72:79], v9
ds_read_b128 a[52:55], v1 offset:21504
v_exp_f32 v45, v45
v_mfma_f32_16x16x32_bf16 v[28:31], a[0:3], a[208:211], v[92:95]
buffer_load_dwordx4 v12, s[72:75], s12 offen offset:2048 lds
v_mfma_f32_16x16x32_bf16 v[28:31], a[4:7], a[212:215], v[28:31]
ds_read_b128 a[56:59], v1 offset:22528
v_exp_f32 v46, v46
v_mfma_f32_16x16x32_bf16 v[28:31], a[8:11], a[216:219], v[28:31]
ds_read_b128 a[60:63], v1 offset:23552
v_xor_b32 v1, 0x8000, v1
v_mfma_f32_16x16x32_bf16 v[28:31], a[12:15], a[220:223], v[28:31]
s_waitcnt lgkmcnt(8)
v_exp_f32 v47, v47
v_cvt_pk_bf16_f32 v62, v44, v45
v_cvt_pk_bf16_f32 v63, v46, v47
v_mfma_f32_16x16x32_bf16 v[44:47], a[16:19], a[208:211], v[92:95]
buffer_load_dwordx4 v13, s[72:75], s12 offen offset:3072 lds
v_mfma_f32_16x16x32_bf16 v[44:47], a[20:23], a[212:215], v[44:47]
v_cvt_pk_bf16_f32 v59, v42, v43
v_mfma_f32_16x16x32_bf16 v[44:47], a[24:27], a[216:219], v[44:47]
v_mfma_f32_16x16x32_bf16 v[44:47], a[28:31], a[220:223], v[44:47]
v_accvgpr_read_b32 v6, a224
v_accvgpr_read_b32 v7, a225
v_add_f32 v6, v6, v7
v_cmp_nge_f32 vcc, 0x5f800000, v6
v_rcp_f32 v6, v6
s_or_b64 s[34:35], s[34:35], vcc
s_add_u32 s8, s28, 0x0
v_pk_mul_f32 v[128:129], v[128:129], v[6:7] op_sel_hi:[1,0]
v_pk_mul_f32 v[130:131], v[130:131], v[6:7] op_sel_hi:[1,0]
v_pk_mul_f32 v[132:133], v[132:133], v[6:7] op_sel_hi:[1,0]
v_pk_mul_f32 v[134:135], v[134:135], v[6:7] op_sel_hi:[1,0]
v_cvt_pk_bf16_f32 v128, v128, v129
v_cvt_pk_bf16_f32 v129, v130, v131
v_cvt_pk_bf16_f32 v130, v132, v133
v_cvt_pk_bf16_f32 v131, v134, v135
buffer_store_dwordx4 v[128:131], v3, s[88:91], s8 offen sc1
s_add_u32 s8, s28, 0x2000
v_pk_mul_f32 v[136:137], v[136:137], v[6:7] op_sel_hi:[1,0]
v_pk_mul_f32 v[138:139], v[138:139], v[6:7] op_sel_hi:[1,0]
v_pk_mul_f32 v[140:141], v[140:141], v[6:7] op_sel_hi:[1,0]
v_pk_mul_f32 v[142:143], v[142:143], v[6:7] op_sel_hi:[1,0]
v_cvt_pk_bf16_f32 v136, v136, v137
v_cvt_pk_bf16_f32 v137, v138, v139
v_cvt_pk_bf16_f32 v138, v140, v141
v_cvt_pk_bf16_f32 v139, v142, v143
buffer_store_dwordx4 v[136:139], v3, s[88:91], s8 offen sc1
s_add_u32 s8, s28, 0x4000
v_pk_mul_f32 v[144:145], v[144:145], v[6:7] op_sel_hi:[1,0]
v_pk_mul_f32 v[146:147], v[146:147], v[6:7] op_sel_hi:[1,0]
v_pk_mul_f32 v[148:149], v[148:149], v[6:7] op_sel_hi:[1,0]
v_pk_mul_f32 v[150:151], v[150:151], v[6:7] op_sel_hi:[1,0]
v_cvt_pk_bf16_f32 v144, v144, v145
v_cvt_pk_bf16_f32 v145, v146, v147
v_cvt_pk_bf16_f32 v146, v148, v149
v_cvt_pk_bf16_f32 v147, v150, v151
buffer_store_dwordx4 v[144:147], v3, s[88:91], s8 offen sc1
s_add_u32 s8, s28, 0x6000
v_pk_mul_f32 v[152:153], v[152:153], v[6:7] op_sel_hi:[1,0]
v_pk_mul_f32 v[154:155], v[154:155], v[6:7] op_sel_hi:[1,0]
v_pk_mul_f32 v[156:157], v[156:157], v[6:7] op_sel_hi:[1,0]
v_pk_mul_f32 v[158:159], v[158:159], v[6:7] op_sel_hi:[1,0]
v_cvt_pk_bf16_f32 v152, v152, v153
v_cvt_pk_bf16_f32 v153, v154, v155
v_cvt_pk_bf16_f32 v154, v156, v157
v_cvt_pk_bf16_f32 v155, v158, v159
buffer_store_dwordx4 v[152:155], v3, s[88:91], s8 offen sc1
v_accvgpr_read_b32 v6, a226
v_accvgpr_read_b32 v7, a227
v_add_f32 v6, v6, v7
v_cmp_nge_f32 vcc, 0x5f800000, v6
v_rcp_f32 v6, v6
s_or_b64 s[34:35], s[34:35], vcc
s_add_u32 s8, s29, 0x0
v_pk_mul_f32 v[160:161], v[160:161], v[6:7] op_sel_hi:[1,0]
v_pk_mul_f32 v[162:163], v[162:163], v[6:7] op_sel_hi:[1,0]
v_pk_mul_f32 v[164:165], v[164:165], v[6:7] op_sel_hi:[1,0]
v_pk_mul_f32 v[166:167], v[166:167], v[6:7] op_sel_hi:[1,0]
v_cvt_pk_bf16_f32 v160, v160, v161
v_cvt_pk_bf16_f32 v161, v162, v163
v_cvt_pk_bf16_f32 v162, v164, v165
v_cvt_pk_bf16_f32 v163, v166, v167
buffer_store_dwordx4 v[160:163], v3, s[88:91], s8 offen sc1
s_add_u32 s8, s29, 0x2000
v_pk_mul_f32 v[168:169], v[168:169], v[6:7] op_sel_hi:[1,0]
v_pk_mul_f32 v[170:171], v[170:171], v[6:7] op_sel_hi:[1,0]
v_pk_mul_f32 v[172:173], v[172:173], v[6:7] op_sel_hi:[1,0]
v_pk_mul_f32 v[174:175], v[174:175], v[6:7] op_sel_hi:[1,0]
v_cvt_pk_bf16_f32 v168, v168, v169
v_cvt_pk_bf16_f32 v169, v170, v171
v_cvt_pk_bf16_f32 v170, v172, v173
v_cvt_pk_bf16_f32 v171, v174, v175
buffer_store_dwordx4 v[168:171], v3, s[88:91], s8 offen sc1
s_add_u32 s8, s29, 0x4000
v_pk_mul_f32 v[176:177], v[176:177], v[6:7] op_sel_hi:[1,0]
v_pk_mul_f32 v[178:179], v[178:179], v[6:7] op_sel_hi:[1,0]
v_pk_mul_f32 v[180:181], v[180:181], v[6:7] op_sel_hi:[1,0]
v_pk_mul_f32 v[182:183], v[182:183], v[6:7] op_sel_hi:[1,0]
v_cvt_pk_bf16_f32 v176, v176, v177
v_cvt_pk_bf16_f32 v177, v178, v179
v_cvt_pk_bf16_f32 v178, v180, v181
v_cvt_pk_bf16_f32 v179, v182, v183
buffer_store_dwordx4 v[176:179], v3, s[88:91], s8 offen sc1
s_add_u32 s8, s29, 0x6000
v_pk_mul_f32 v[184:185], v[184:185], v[6:7] op_sel_hi:[1,0]
v_pk_mul_f32 v[186:187], v[186:187], v[6:7] op_sel_hi:[1,0]
v_pk_mul_f32 v[188:189], v[188:189], v[6:7] op_sel_hi:[1,0]
v_pk_mul_f32 v[190:191], v[190:191], v[6:7] op_sel_hi:[1,0]
v_cvt_pk_bf16_f32 v184, v184, v185
v_cvt_pk_bf16_f32 v185, v186, v187
v_cvt_pk_bf16_f32 v186, v188, v189
v_cvt_pk_bf16_f32 v187, v190, v191
buffer_store_dwordx4 v[184:187], v3, s[88:91], s8 offen sc1
s_branch L_att_h1_0
L_att_dl0_1:
v_mfma_f32_16x16x32_bf16 v[128:131], a[32:35], v[48:51], v[128:131]
ds_read_b128 a[0:3], v1 offset:8192
v_cvt_pk_bf16_f32 v72, v24, v25
v_mfma_f32_16x16x32_bf16 v[160:163], a[32:35], v[52:55], v[160:163]
v_exp_f32 v28, v28
v_mfma_f32_16x16x32_bf16 v[192:195], a[32:35], v[56:59], v[192:195]
v_cvt_pk_bf16_f32 v73, v26, v27
v_mfma_f32_16x16x32_bf16 v[224:227], a[32:35], v[60:63], v[224:227]
ds_read_b128 a[4:7], v1 offset:9216
v_mfma_f32_16x16x32_bf16 v[228:231], a[36:39], v[60:63], v[228:231]
s_add_u32 m0, s27, 0x0
v_exp_f32 v29, v29
v_mfma_f32_16x16x32_bf16 v[196:199], a[36:39], v[56:59], v[196:199]
buffer_load_dwordx4 v3, s[48:51], s32 offen offset:0 sc1 lds
v_mfma_f32_16x16x32_bf16 v[164:167], a[36:39], v[52:55], v[164:167]
v_exp_f32 v30, v30
v_mfma_f32_16x16x32_bf16 v[132:135], a[36:39], v[48:51], v[132:135]
ds_read_b128 a[8:11], v1 offset:10240
v_cvt_pk_bf16_f32 v76, v28, v29
v_mfma_f32_16x16x32_bf16 v[136:139], a[40:43], v[48:51], v[136:139]
v_mfma_f32_16x16x32_bf16 v[168:171], a[40:43], v[52:55], v[168:171]
v_exp_f32 v31, v31
v_mfma_f32_16x16x32_bf16 v[200:203], a[40:43], v[56:59], v[200:203]
v_exp_f32 v32, v32
v_mfma_f32_16x16x32_bf16 v[232:235], a[40:43], v[60:63], v[232:235]
ds_read_b128 a[12:15], v1 offset:11264
v_cvt_pk_bf16_f32 v77, v30, v31
v_mfma_f32_16x16x32_bf16 v[236:239], a[44:47], v[60:63], v[236:239]
v_exp_f32 v33, v33
v_mfma_f32_16x16x32_bf16 v[204:207], a[44:47], v[56:59], v[204:207]
v_cvt_pk_bf16_f32 v66, v32, v33
v_mfma_f32_16x16x32_bf16 v[172:175], a[44:47], v[52:55], v[172:175]
s_mov_b32 s9, 0x0
v_exp_f32 v34, v34
v_mfma_f32_16x16x32_bf16 v[140:143], a[44:47], v[48:51], v[140:143]
ds_read_b128 a[16:19], v1 offset:12288
v_mfma_f32_16x16x32_bf16 v[144:147], a[48:51], v[48:51], v[144:147]
buffer_load_dword a244, v8, s[72:75], s9 offen
v_mfma_f32_16x16x32_bf16 v[176:179], a[48:51], v[52:55], v[176:179]
v_exp_f32 v35, v35
v_mfma_f32_16x16x32_bf16 v[208:211], a[48:51], v[56:59], v[208:211]
v_exp_f32 v36, v36
v_mfma_f32_16x16x32_bf16 v[240:243], a[48:51], v[60:63], v[240:243]
ds_read_b128 a[20:23], v1 offset:13312
v_cvt_pk_bf16_f32 v67, v34, v35
v_mfma_f32_16x16x32_bf16 v[244:247], a[52:55], v[60:63], v[244:247]
v_mfma_f32_16x16x32_bf16 v[212:215], a[52:55], v[56:59], v[212:215]
v_exp_f32 v37, v37
v_mfma_f32_16x16x32_bf16 v[180:183], a[52:55], v[52:55], v[180:183]
ds_read_b128 a[24:27], v1 offset:14336
v_cvt_pk_bf16_f32 v70, v36, v37
v_mfma_f32_16x16x32_bf16 v[148:151], a[52:55], v[48:51], v[148:151]
v_exp_f32 v38, v38
v_mfma_f32_16x16x32_bf16 v[152:155], a[56:59], v[48:51], v[152:155]
v_mfma_f32_16x16x32_bf16 v[184:187], a[56:59], v[52:55], v[184:187]
v_exp_f32 v39, v39
v_mfma_f32_16x16x32_bf16 v[216:219], a[56:59], v[56:59], v[216:219]
buffer_load_dwordx4 v3, s[48:51], s32 offen offset:1024 sc1 lds
v_mfma_f32_16x16x32_bf16 v[248:251], a[56:59], v[60:63], v[248:251]
ds_read_b128 a[28:31], v1 offset:15360
v_cvt_pk_bf16_f32 v71, v38, v39
v_mfma_f32_16x16x32_bf16 v[252:255], a[60:63], v[60:63], v[252:255]
v_exp_f32 v40, v40
v_mfma_f32_16x16x32_bf16 v[220:223], a[60:63], v[56:59], v[220:223]
v_exp_f32 v41, v41
v_mfma_f32_16x16x32_bf16 v[188:191], a[60:63], v[52:55], v[188:191]
ds_read_b128 a[32:35], v1 offset:0
v_cvt_pk_bf16_f32 v74, v40, v41
v_mfma_f32_16x16x32_bf16 v[156:159], a[60:63], v[48:51], v[156:159]
v_smfmac_f32_16x16x64_bf16 a[224:227], a[232:235], v[48:55], v9
v_exp_f32 v42, v42
v_smfmac_f32_16x16x64_bf16 a[228:231], a[232:235], v[56:63], v9
s_waitcnt lgkmcnt(5)
v_exp_f32 v43, v43
v_mfma_f32_16x16x32_bf16 v[16:19], a[0:3], a[160:163], v[80:83]
ds_read_b128 a[36:39], v1 offset:1024
v_cvt_pk_bf16_f32 v75, v42, v43
v_mfma_f32_16x16x32_bf16 v[16:19], a[4:7], a[164:167], v[16:19]
v_exp_f32 v44, v44
v_mfma_f32_16x16x32_bf16 v[16:19], a[8:11], a[168:171], v[16:19]
v_mfma_f32_16x16x32_bf16 v[16:19], a[12:15], a[172:175], v[16:19]
buffer_load_dwordx4 v3, s[48:51], s32 offen offset:2048 sc1 lds
v_mfma_f32_16x16x32_bf16 v[20:23], a[0:3], a[176:179], v[84:87]
ds_read_b128 a[40:43], v1 offset:2048
v_mfma_f32_16x16x32_bf16 v[20:23], a[4:7], a[180:183], v[20:23]
v_exp_f32 v45, v45
v_mfma_f32_16x16x32_bf16 v[20:23], a[8:11], a[184:187], v[20:23]
v_exp_f32 v46, v46
v_mfma_f32_16x16x32_bf16 v[20:23], a[12:15], a[188:191], v[20:23]
ds_read_b128 a[44:47], v1 offset:3072
v_cvt_pk_bf16_f32 v78, v44, v45
v_mfma_f32_16x16x32_bf16 v[24:27], a[0:3], a[192:195], v[88:91]
v_mfma_f32_16x16x32_bf16 v[24:27], a[4:7], a[196:199], v[24:27]
v_exp_f32 v47, v47
v_mfma_f32_16x16x32_bf16 v[24:27], a[8:11], a[200:203], v[24:27]
v_exp_f32 v16, v16
v_mfma_f32_16x16x32_bf16 v[24:27], a[12:15], a[204:207], v[24:27]
ds_read_b128 a[48:51], v1 offset:4096
v_cvt_pk_bf16_f32 v79, v46, v47
v_mfma_f32_16x16x32_bf16 v[28:31], a[0:3], a[208:211], v[92:95]
v_exp_f32 v17, v17
v_mfma_f32_16x16x32_bf16 v[28:31], a[4:7], a[212:215], v[28:31]
s_waitcnt lgkmcnt(5)
v_cvt_pk_bf16_f32 v48, v16, v17
v_mfma_f32_16x16x32_bf16 v[28:31], a[8:11], a[216:219], v[28:31]
buffer_load_dwordx4 v3, s[48:51], s32 offen offset:3072 sc1 lds
v_mfma_f32_16x16x32_bf16 v[28:31], a[12:15], a[220:223], v[28:31]
ds_read_b128 a[52:55], v1 offset:5120
v_mfma_f32_16x16x32_bf16 v[32:35], a[16:19], a[160:163], v[80:83]
v_exp_f32 v18, v18
v_mfma_f32_16x16x32_bf16 v[32:35], a[20:23], a[164:167], v[32:35]
v_exp_f32 v19, v19
v_mfma_f32_16x16x32_bf16 v[32:35], a[24:27], a[168:171], v[32:35]
v_exp_f32 v20, v20
v_mfma_f32_16x16x32_bf16 v[32:35], a[28:31], a[172:175], v[32:35]
ds_read_b128 a[56:59], v1 offset:6144
v_cvt_pk_bf16_f32 v49, v18, v19
v_mfma_f32_16x16x32_bf16 v[36:39], a[16:19], a[176:179], v[84:87]
v_mfma_f32_16x16x32_bf16 v[36:39], a[20:23], a[180:183], v[36:39]
v_exp_f32 v21, v21
v_mfma_f32_16x16x32_bf16 v[36:39], a[24:27], a[184:187], v[36:39]
s_mov_b32 s9, 0x0
v_exp_f32 v22, v22
v_mfma_f32_16x16x32_bf16 v[36:39], a[28:31], a[188:191], v[36:39]
ds_read_b128 a[60:63], v1 offset:7168
v_cvt_pk_bf16_f32 v52, v20, v21
v_mfma_f32_16x16x32_bf16 v[40:43], a[16:19], a[192:195], v[88:91]
buffer_load_dword a244, v8, s[64:67], s9 offen
v_mfma_f32_16x16x32_bf16 v[40:43], a[20:23], a[196:199], v[40:43]
v_mfma_f32_16x16x32_bf16 v[40:43], a[24:27], a[200:203], v[40:43]
v_exp_f32 v23, v23
v_mfma_f32_16x16x32_bf16 v[40:43], a[28:31], a[204:207], v[40:43]
v_exp_f32 v24, v24
v_mfma_f32_16x16x32_bf16 v[44:47], a[16:19], a[208:211], v[92:95]
v_exp_f32 v25, v25
v_mfma_f32_16x16x32_bf16 v[44:47], a[20:23], a[212:215], v[44:47]
v_exp_f32 v26, v26
v_mfma_f32_16x16x32_bf16 v[44:47], a[24:27], a[216:219], v[44:47]
v_exp_f32 v27, v27
v_mfma_f32_16x16x32_bf16 v[44:47], a[28:31], a[220:223], v[44:47]
s_waitcnt lgkmcnt(0)
v_cvt_pk_bf16_f32 v53, v22, v23
v_mfma_f32_16x16x32_bf16 v[128:131], a[32:35], v[64:67], v[128:131]
ds_read_b128 a[0:3], v1 offset:24576
v_cvt_pk_bf16_f32 v56, v24, v25
v_mfma_f32_16x16x32_bf16 v[160:163], a[32:35], v[68:71], v[160:163]
v_exp_f32 v28, v28
v_mfma_f32_16x16x32_bf16 v[192:195], a[32:35], v[72:75], v[192:195]
v_cvt_pk_bf16_f32 v57, v26, v27
v_mfma_f32_16x16x32_bf16 v[224:227], a[32:35], v[76:79], v[224:227]
ds_read_b128 a[4:7], v1 offset:25600
v_mfma_f32_16x16x32_bf16 v[228:231], a[36:39], v[76:79], v[228:231]
v_exp_f32 v29, v29
v_mfma_f32_16x16x32_bf16 v[196:199], a[36:39], v[72:75], v[196:199]
s_add_u32 m0, s27, 0x1000
v_exp_f32 v30, v30
v_mfma_f32_16x16x32_bf16 v[164:167], a[36:39], v[68:71], v[164:167]
buffer_load_dwordx4 v3, s[48:51], s7 offen offset:0 sc1 lds
v_mfma_f32_16x16x32_bf16 v[132:135], a[36:39], v[64:67], v[132:135]
ds_read_b128 a[8:11], v1 offset:26624
v_cvt_pk_bf16_f32 v60, v28, v29
v_mfma_f32_16x16x32_bf16 v[136:139], a[40:43], v[64:67], v[136:139]
v_mfma_f32_16x16x32_bf16 v[168:171], a[40:43], v[68:71], v[168:171]
v_exp_f32 v31, v31
v_mfma_f32_16x16x32_bf16 v[200:203], a[40:43], v[72:75], v[200:203]
v_exp_f32 v32, v32
v_mfma_f32_16x16x32_bf16 v[232:235], a[40:43], v[76:79], v[232:235]
ds_read_b128 a[12:15], v1 offset:27648
v_cvt_pk_bf16_f32 v61, v30, v31
v_mfma_f32_16x16x32_bf16 v[236:239], a[44:47], v[76:79], v[236:239]
v_mfma_f32_16x16x32_bf16 v[204:207], a[44:47], v[72:75], v[204:207]
v_exp_f32 v33, v33
v_mfma_f32_16x16x32_bf16 v[172:175], a[44:47], v[68:71], v[172:175]
v_exp_f32 v34, v34
v_mfma_f32_16x16x32_bf16 v[140:143], a[44:47], v[64:67], v[140:143]
ds_read_b128 a[16:19], v1 offset:28672
v_cvt_pk_bf16_f32 v50, v32, v33
v_mfma_f32_16x16x32_bf16 v[144:147], a[48:51], v[64:67], v[144:147]
v_exp_f32 v35, v35
v_mfma_f32_16x16x32_bf16 v[176:179], a[48:51], v[68:71], v[176:179]
v_cvt_pk_bf16_f32 v51, v34, v35
v_mfma_f32_16x16x32_bf16 v[208:211], a[48:51], v[72:75], v[208:211]
buffer_load_dwordx4 v3, s[48:51], s7 offen offset:1024 sc1 lds
v_mfma_f32_16x16x32_bf16 v[240:243], a[48:51], v[76:79], v[240:243]
ds_read_b128 a[20:23], v1 offset:29696
v_mfma_f32_16x16x32_bf16 v[244:247], a[52:55], v[76:79], v[244:247]
v_exp_f32 v36, v36
v_mfma_f32_16x16x32_bf16 v[212:215], a[52:55], v[72:75], v[212:215]
v_exp_f32 v37, v37
v_mfma_f32_16x16x32_bf16 v[180:183], a[52:55], v[68:71], v[180:183]
ds_read_b128 a[24:27], v1 offset:30720
v_cvt_pk_bf16_f32 v54, v36, v37
v_mfma_f32_16x16x32_bf16 v[148:151], a[52:55], v[64:67], v[148:151]
v_mfma_f32_16x16x32_bf16 v[152:155], a[56:59], v[64:67], v[152:155]
v_exp_f32 v38, v38
v_mfma_f32_16x16x32_bf16 v[184:187], a[56:59], v[68:71], v[184:187]
v_exp_f32 v39, v39
v_mfma_f32_16x16x32_bf16 v[216:219], a[56:59], v[72:75], v[216:219]
ds_read_b128 a[28:31], v1 offset:31744
v_cvt_pk_bf16_f32 v55, v38, v39
v_mfma_f32_16x16x32_bf16 v[248:251], a[56:59], v[76:79], v[248:251]
v_exp_f32 v40, v40
v_mfma_f32_16x16x32_bf16 v[252:255], a[60:63], v[76:79], v[252:255]
v_mfma_f32_16x16x32_bf16 v[220:223], a[60:63], v[72:75], v[220:223]
v_exp_f32 v41, v41
v_mfma_f32_16x16x32_bf16 v[188:191], a[60:63], v[68:71], v[188:191]
buffer_load_dwordx4 v3, s[48:51], s7 offen offset:2048 sc1 lds
v_mfma_f32_16x16x32_bf16 v[156:159], a[60:63], v[64:67], v[156:159]
ds_read_b128 a[32:35], v1 offset:16384
v_cvt_pk_bf16_f32 v58, v40, v41
v_smfmac_f32_16x16x64_bf16 a[224:227], a[232:235], v[64:71], v9
s_waitcnt lgkmcnt(5)
v_exp_f32 v42, v42
v_smfmac_f32_16x16x64_bf16 a[228:231], a[232:235], v[72:79], v9
ds_read_b128 a[36:39], v1 offset:17408
v_mfma_f32_16x16x32_bf16 v[16:19], a[0:3], a[160:163], v[96:99]
v_mfma_f32_16x16x32_bf16 v[16:19], a[4:7], a[164:167], v[16:19]
v_exp_f32 v43, v43
v_mfma_f32_16x16x32_bf16 v[16:19], a[8:11], a[168:171], v[16:19]
v_exp_f32 v44, v44
v_mfma_f32_16x16x32_bf16 v[16:19], a[12:15], a[172:175], v[16:19]
ds_read_b128 a[40:43], v1 offset:18432
v_cvt_pk_bf16_f32 v59, v42, v43
v_mfma_f32_16x16x32_bf16 v[20:23], a[0:3], a[176:179], v[84:87]
v_exp_f32 v45, v45
v_mfma_f32_16x16x32_bf16 v[20:23], a[4:7], a[180:183], v[20:23]
v_cvt_pk_bf16_f32 v62, v44, v45
v_mfma_f32_16x16x32_bf16 v[20:23], a[8:11], a[184:187], v[20:23]
s_mov_b32 s9, 0x400000
v_exp_f32 v46, v46
v_mfma_f32_16x16x32_bf16 v[20:23], a[12:15], a[188:191], v[20:23]
ds_read_b128 a[44:47], v1 offset:19456
v_mfma_f32_16x16x32_bf16 v[24:27], a[0:3], a[192:195], v[88:91]
buffer_load_dword a244, v8, s[64:67], s9 offen
v_mfma_f32_16x16x32_bf16 v[24:27], a[4:7], a[196:199], v[24:27]
v_exp_f32 v47, v47
v_mfma_f32_16x16x32_bf16 v[24:27], a[8:11], a[200:203], v[24:27]
v_cvt_pk_bf16_f32 v63, v46, v47
v_mfma_f32_16x16x32_bf16 v[24:27], a[12:15], a[204:207], v[24:27]
ds_read_b128 a[48:51], v1 offset:20480
v_mfma_f32_16x16x32_bf16 v[28:31], a[0:3], a[208:211], v[92:95]
v_exp_f32 v16, v16
v_mfma_f32_16x16x32_bf16 v[28:31], a[4:7], a[212:215], v[28:31]
v_exp_f32 v17, v17
v_mfma_f32_16x16x32_bf16 v[28:31], a[8:11], a[216:219], v[28:31]
ds_read_b128 a[52:55], v1 offset:21504
v_cvt_pk_bf16_f32 v64, v16, v17
v_mfma_f32_16x16x32_bf16 v[28:31], a[12:15], a[220:223], v[28:31]
s_waitcnt lgkmcnt(6)
v_exp_f32 v18, v18
v_mfma_f32_16x16x32_bf16 v[32:35], a[16:19], a[160:163], v[100:103]
v_mfma_f32_16x16x32_bf16 v[32:35], a[20:23], a[164:167], v[32:35]
v_exp_f32 v19, v19
v_mfma_f32_16x16x32_bf16 v[32:35], a[24:27], a[168:171], v[32:35]
ds_read_b128 a[56:59], v1 offset:22528
v_cvt_pk_bf16_f32 v65, v18, v19
v_mfma_f32_16x16x32_bf16 v[32:35], a[28:31], a[172:175], v[32:35]
v_exp_f32 v20, v20
v_mfma_f32_16x16x32_bf16 v[36:39], a[16:19], a[176:179], v[84:87]
buffer_load_dwordx4 v3, s[48:51], s7 offen offset:3072 sc1 lds
v_mfma_f32_16x16x32_bf16 v[36:39], a[20:23], a[180:183], v[36:39]
s_add_u32 s32, s32, 0x8000
v_mfma_f32_16x16x32_bf16 v[36:39], a[24:27], a[184:187], v[36:39]
ds_read_b128 a[60:63], v1 offset:23552
v_xor_b32 v1, 0x8000, v1
v_mfma_f32_16x16x32_bf16 v[36:39], a[28:31], a[188:191], v[36:39]
s_add_u32 s7, s7, 0x8000
v_exp_f32 v21, v21
v_mfma_f32_16x16x32_bf16 v[40:43], a[16:19], a[192:195], v[88:91]
s_xor_b32 s27, s27, 0x38000
v_exp_f32 v22, v22
v_mfma_f32_16x16x32_bf16 v[40:43], a[20:23], a[196:199], v[40:43]
v_exp_f32 v23, v23
v_mfma_f32_16x16x32_bf16 v[40:43], a[24:27], a[200:203], v[40:43]
v_cvt_pk_bf16_f32 v68, v20, v21
v_cvt_pk_bf16_f32 v69, v22, v23
v_mfma_f32_16x16x32_bf16 v[40:43], a[28:31], a[204:207], v[40:43]
v_exp_f32 v24, v24
v_mfma_f32_16x16x32_bf16 v[44:47], a[16:19], a[208:211], v[92:95]
v_exp_f32 v25, v25
v_mfma_f32_16x16x32_bf16 v[44:47], a[20:23], a[212:215], v[44:47]
v_exp_f32 v26, v26
v_mfma_f32_16x16x32_bf16 v[44:47], a[24:27], a[216:219], v[44:47]
s_waitcnt vmcnt(19) lgkmcnt(0)
v_exp_f32 v27, v27
v_mfma_f32_16x16x32_bf16 v[44:47], a[28:31], a[220:223], v[44:47]
s_barrier
L_att_l1_1:
v_mfma_f32_16x16x32_bf16 v[128:131], a[32:35], v[48:51], v[128:131]
ds_read_b128 a[0:3], v2 offset:8192
v_cvt_pk_bf16_f32 v72, v24, v25
v_mfma_f32_16x16x32_bf16 v[160:163], a[32:35], v[52:55], v[160:163]
v_exp_f32 v28, v28
v_mfma_f32_16x16x32_bf16 v[192:195], a[32:35], v[56:59], v[192:195]
s_add_u32 m0, s19, 0x0
v_cvt_pk_bf16_f32 v73, v26, v27
v_mfma_f32_16x16x32_bf16 v[224:227], a[32:35], v[60:63], v[224:227]
ds_read_b128 a[4:7], v2 offset:9216
v_mfma_f32_16x16x32_bf16 v[228:231], a[36:39], v[60:63], v[228:231]
buffer_load_dwordx4 v3, s[48:51], s32 offen offset:0 sc1 lds
v_mfma_f32_16x16x32_bf16 v[196:199], a[36:39], v[56:59], v[196:199]
v_exp_f32 v29, v29
v_mfma_f32_16x16x32_bf16 v[164:167], a[36:39], v[52:55], v[164:167]
ds_read_b128 a[8:11], v2 offset:10240
v_cvt_pk_bf16_f32 v76, v28, v29
v_mfma_f32_16x16x32_bf16 v[132:135], a[36:39], v[48:51], v[132:135]
v_exp_f32 v30, v30
v_mfma_f32_16x16x32_bf16 v[136:139], a[40:43], v[48:51], v[136:139]
v_exp_f32 v31, v31
v_mfma_f32_16x16x32_bf16 v[168:171], a[40:43], v[52:55], v[168:171]
ds_read_b128 a[12:15], v2 offset:11264
v_cvt_pk_bf16_f32 v77, v30, v31
v_mfma_f32_16x16x32_bf16 v[200:203], a[40:43], v[56:59], v[200:203]
v_mfma_f32_16x16x32_bf16 v[232:235], a[40:43], v[60:63], v[232:235]
v_exp_f32 v32, v32
v_mfma_f32_16x16x32_bf16 v[236:239], a[44:47], v[60:63], v[236:239]
s_mov_b32 s9, 0x200000
v_exp_f32 v33, v33
v_mfma_f32_16x16x32_bf16 v[204:207], a[44:47], v[56:59], v[204:207]
ds_read_b128 a[16:19], v2 offset:12288
v_cvt_pk_bf16_f32 v66, v32, v33
v_mfma_f32_16x16x32_bf16 v[172:175], a[44:47], v[52:55], v[172:175]
buffer_load_dword a244, v8, s[64:67], s9 offen
v_mfma_f32_16x16x32_bf16 v[140:143], a[44:47], v[48:51], v[140:143]
v_exp_f32 v34, v34
v_mfma_f32_16x16x32_bf16 v[144:147], a[48:51], v[48:51], v[144:147]
ds_read_b128 a[20:23], v2 offset:13312
v_mfma_f32_16x16x32_bf16 v[176:179], a[48:51], v[52:55], v[176:179]
v_exp_f32 v35, v35
v_mfma_f32_16x16x32_bf16 v[208:211], a[48:51], v[56:59], v[208:211]
v_cvt_pk_bf16_f32 v67, v34, v35
v_mfma_f32_16x16x32_bf16 v[240:243], a[48:51], v[60:63], v[240:243]
ds_read_b128 a[24:27], v2 offset:14336
v_mfma_f32_16x16x32_bf16 v[244:247], a[52:55], v[60:63], v[244:247]
v_exp_f32 v36, v36
v_mfma_f32_16x16x32_bf16 v[212:215], a[52:55], v[56:59], v[212:215]
v_exp_f32 v37, v37
v_mfma_f32_16x16x32_bf16 v[180:183], a[52:55], v[52:55], v[180:183]
v_exp_f32 v38, v38
v_mfma_f32_16x16x32_bf16 v[148:151], a[52:55], v[48:51], v[148:151]
buffer_load_dwordx4 v3, s[48:51], s32 offen offset:1024 sc1 lds
v_mfma_f32_16x16x32_bf16 v[152:155], a[56:59], v[48:51], v[152:155]
ds_read_b128 a[28:31], v2 offset:15360
v_cvt_pk_bf16_f32 v70, v36, v37
v_mfma_f32_16x16x32_bf16 v[184:187], a[56:59], v[52:55], v[184:187]
v_mfma_f32_16x16x32_bf16 v[216:219], a[56:59], v[56:59], v[216:219]
ds_read_b128 a[32:35], v2 offset:0
v_mfma_f32_16x16x32_bf16 v[248:251], a[56:59], v[60:63], v[248:251]
v_exp_f32 v39, v39
v_mfma_f32_16x16x32_bf16 v[252:255], a[60:63], v[60:63], v[252:255]
v_exp_f32 v40, v40
v_mfma_f32_16x16x32_bf16 v[220:223], a[60:63], v[56:59], v[220:223]
ds_read_b128 a[36:39], v2 offset:1024
v_cvt_pk_bf16_f32 v71, v38, v39
v_mfma_f32_16x16x32_bf16 v[188:191], a[60:63], v[52:55], v[188:191]
v_exp_f32 v41, v41
v_mfma_f32_16x16x32_bf16 v[156:159], a[60:63], v[48:51], v[156:159]
s_waitcnt lgkmcnt(6)
v_exp_f32 v42, v42
v_smfmac_f32_16x16x64_bf16 a[224:227], a[232:235], v[48:55], v9
buffer_load_dwordx4 v3, s[48:51], s32 offen offset:2048 sc1 lds
v_smfmac_f32_16x16x64_bf16 a[228:231], a[232:235], v[56:63], v9
ds_read_b128 a[40:43], v2 offset:2048
v_cvt_pk_bf16_f32 v74, v40, v41
v_mfma_f32_16x16x32_bf16 v[20:23], a[0:3], a[176:179], v[104:107]
v_mfma_f32_16x16x32_bf16 v[20:23], a[4:7], a[180:183], v[20:23]
v_exp_f32 v43, v43
v_mfma_f32_16x16x32_bf16 v[20:23], a[8:11], a[184:187], v[20:23]
ds_read_b128 a[44:47], v2 offset:3072
v_cvt_pk_bf16_f32 v75, v42, v43
v_mfma_f32_16x16x32_bf16 v[20:23], a[12:15], a[188:191], v[20:23]
v_exp_f32 v44, v44
v_mfma_f32_16x16x32_bf16 v[24:27], a[0:3], a[192:195], v[88:91]
v_exp_f32 v45, v45
v_mfma_f32_16x16x32_bf16 v[24:27], a[4:7], a[196:199], v[24:27]
ds_read_b128 a[48:51], v2 offset:4096
v_cvt_pk_bf16_f32 v78, v44, v45
v_mfma_f32_16x16x32_bf16 v[24:27], a[8:11], a[200:203], v[24:27]
v_mfma_f32_16x16x32_bf16 v[24:27], a[12:15], a[204:207], v[24:27]
v_exp_f32 v46, v46
v_mfma_f32_16x16x32_bf16 v[28:31], a[0:3], a[208:211], v[92:95]
buffer_load_dwordx4 v3, s[48:51], s32 offen offset:3072 sc1 lds
v_mfma_f32_16x16x32_bf16 v[28:31], a[4:7], a[212:215], v[28:31]
ds_read_b128 a[52:55], v2 offset:5120
v_mfma_f32_16x16x32_bf16 v[28:31], a[8:11], a[216:219], v[28:31]
v_exp_f32 v47, v47
v_mfma_f32_16x16x32_bf16 v[28:31], a[12:15], a[220:223], v[28:31]
s_waitcnt lgkmcnt(6)
v_exp_f32 v20, v20
v_mfma_f32_16x16x32_bf16 v[36:39], a[16:19], a[176:179], v[108:111]
ds_read_b128 a[56:59], v2 offset:6144
v_cvt_pk_bf16_f32 v79, v46, v47
v_mfma_f32_16x16x32_bf16 v[36:39], a[20:23], a[180:183], v[36:39]
v_exp_f32 v21, v21
v_mfma_f32_16x16x32_bf16 v[36:39], a[24:27], a[184:187], v[36:39]
v_cvt_pk_bf16_f32 v52, v20, v21
v_mfma_f32_16x16x32_bf16 v[36:39], a[28:31], a[188:191], v[36:39]
ds_read_b128 a[60:63], v2 offset:7168
v_mfma_f32_16x16x32_bf16 v[40:43], a[16:19], a[192:195], v[88:91]
s_mov_b32 s9, 0x600000
v_exp_f32 v22, v22
v_mfma_f32_16x16x32_bf16 v[40:43], a[20:23], a[196:199], v[40:43]
buffer_load_dword a244, v8, s[64:67], s9 offen
v_mfma_f32_16x16x32_bf16 v[40:43], a[24:27], a[200:203], v[40:43]
v_exp_f32 v23, v23
v_mfma_f32_16x16x32_bf16 v[40:43], a[28:31], a[204:207], v[40:43]
v_exp_f32 v24, v24
v_mfma_f32_16x16x32_bf16 v[44:47], a[16:19], a[208:211], v[92:95]
v_exp_f32 v25, v25
v_mfma_f32_16x16x32_bf16 v[44:47], a[20:23], a[212:215], v[44:47]
v_exp_f32 v26, v26
v_mfma_f32_16x16x32_bf16 v[44:47], a[24:27], a[216:219], v[44:47]
v_exp_f32 v27, v27
v_mfma_f32_16x16x32_bf16 v[44:47], a[28:31], a[220:223], v[44:47]
s_waitcnt lgkmcnt(0)
v_cvt_pk_bf16_f32 v53, v22, v23
v_mfma_f32_16x16x32_bf16 v[128:131], a[32:35], v[64:67], v[128:131]
ds_read_b128 a[0:3], v2 offset:24576
v_cvt_pk_bf16_f32 v56, v24, v25
v_mfma_f32_16x16x32_bf16 v[160:163], a[32:35], v[68:71], v[160:163]
v_exp_f32 v28, v28
v_mfma_f32_16x16x32_bf16 v[192:195], a[32:35], v[72:75], v[192:195]
ds_read_b128 a[4:7], v2 offset:25600
v_cvt_pk_bf16_f32 v57, v26, v27
v_mfma_f32_16x16x32_bf16 v[224:227], a[32:35], v[76:79], v[224:227]
s_add_u32 m0, s19, 0x1000
v_mfma_f32_16x16x32_bf16 v[228:231], a[36:39], v[76:79], v[228:231]
buffer_load_dwordx4 v3, s[48:51], s7 offen offset:0 sc1 lds
v_mfma_f32_16x16x32_bf16 v[196:199], a[36:39], v[72:75], v[196:199]
ds_read_b128 a[8:11], v2 offset:26624
v_mfma_f32_16x16x32_bf16 v[164:167], a[36:39], v[68:71], v[164:167]
v_exp_f32 v29, v29
v_mfma_f32_16x16x32_bf16 v[132:135], a[36:39], v[64:67], v[132:135]
v_exp_f32 v30, v30
v_mfma_f32_16x16x32_bf16 v[136:139], a[40:43], v[64:67], v[136:139]
ds_read_b128 a[12:15], v2 offset:27648
v_cvt_pk_bf16_f32 v60, v28, v29
v_mfma_f32_16x16x32_bf16 v[168:171], a[40:43], v[68:71], v[168:171]
v_exp_f32 v31, v31
v_mfma_f32_16x16x32_bf16 v[200:203], a[40:43], v[72:75], v[200:203]
v_exp_f32 v36, v36
v_mfma_f32_16x16x32_bf16 v[232:235], a[40:43], v[76:79], v[232:235]
ds_read_b128 a[16:19], v2 offset:28672
v_cvt_pk_bf16_f32 v61, v30, v31
v_mfma_f32_16x16x32_bf16 v[236:239], a[44:47], v[76:79], v[236:239]
buffer_load_dwordx4 v3, s[48:51], s7 offen offset:1024 sc1 lds
v_mfma_f32_16x16x32_bf16 v[204:207], a[44:47], v[72:75], v[204:207]
ds_read_b128 a[20:23], v2 offset:29696
v_mfma_f32_16x16x32_bf16 v[172:175], a[44:47], v[68:71], v[172:175]
v_mfma_f32_16x16x32_bf16 v[140:143], a[44:47], v[64:67], v[140:143]
v_exp_f32 v37, v37
v_mfma_f32_16x16x32_bf16 v[144:147], a[48:51], v[64:67], v[144:147]
ds_read_b128 a[24:27], v2 offset:30720
v_cvt_pk_bf16_f32 v54, v36, v37
v_mfma_f32_16x16x32_bf16 v[176:179], a[48:51], v[68:71], v[176:179]
v_exp_f32 v38, v38
v_mfma_f32_16x16x32_bf16 v[208:211], a[48:51], v[72:75], v[208:211]
v_exp_f32 v39, v39
v_mfma_f32_16x16x32_bf16 v[240:243], a[48:51], v[76:79], v[240:243]
ds_read_b128 a[28:31], v2 offset:31744
v_cvt_pk_bf16_f32 v55, v38, v39
v_mfma_f32_16x16x32_bf16 v[244:247], a[52:55], v[76:79], v[244:247]
v_exp_f32 v40, v40
v_mfma_f32_16x16x32_bf16 v[212:215], a[52:55], v[72:75], v[212:215]
buffer_load_dwordx4 v3, s[48:51], s7 offen offset:2048 sc1 lds
v_mfma_f32_16x16x32_bf16 v[180:183], a[52:55], v[68:71], v[180:183]
ds_read_b128 a[32:35], v2 offset:16384
v_mfma_f32_16x16x32_bf16 v[148:151], a[52:55], v[64:67], v[148:151]
v_mfma_f32_16x16x32_bf16 v[152:155], a[56:59], v[64:67], v[152:155]
ds_read_b128 a[36:39], v2 offset:17408
v_mfma_f32_16x16x32_bf16 v[184:187], a[56:59], v[68:71], v[184:187]
v_exp_f32 v41, v41
v_mfma_f32_16x16x32_bf16 v[216:219], a[56:59], v[72:75], v[216:219]
v_exp_f32 v42, v42
v_mfma_f32_16x16x32_bf16 v[248:251], a[56:59], v[76:79], v[248:251]
ds_read_b128 a[40:43], v2 offset:18432
v_cvt_pk_bf16_f32 v58, v40, v41
v_mfma_f32_16x16x32_bf16 v[252:255], a[60:63], v[76:79], v[252:255]
v_exp_f32 v43, v43
v_mfma_f32_16x16x32_bf16 v[220:223], a[60:63], v[72:75], v[220:223]
buffer_load_dwordx4 v3, s[48:51], s7 offen offset:3072 sc1 lds
v_mfma_f32_16x16x32_bf16 v[188:191], a[60:63], v[68:71], v[188:191]
ds_read_b128 a[44:47], v2 offset:19456
v_cvt_pk_bf16_f32 v59, v42, v43
v_mfma_f32_16x16x32_bf16 v[156:159], a[60:63], v[64:67], v[156:159]
v_exp_f32 v44, v44
v_smfmac_f32_16x16x64_bf16 a[224:227], a[232:235], v[64:71], v9
s_waitcnt lgkmcnt(8)
v_exp_f32 v45, v45
v_smfmac_f32_16x16x64_bf16 a[228:231], a[232:235], v[72:79], v9
ds_read_b128 a[48:51], v2 offset:20480
v_add_u32 v4, s0, v3
v_mfma_f32_16x16x32_bf16 v[24:27], a[0:3], a[192:195], v[88:91]
v_cvt_pk_bf16_f32 v62, v44, v45
v_mfma_f32_16x16x32_bf16 v[24:27], a[4:7], a[196:199], v[24:27]
ds_read_b128 a[52:55], v2 offset:21504
v_mov_b32 v5, s1
v_mfma_f32_16x16x32_bf16 v[24:27], a[8:11], a[200:203], v[24:27]
v_exp_f32 v46, v46
v_mfma_f32_16x16x32_bf16 v[24:27], a[12:15], a[204:207], v[24:27]
global_load_dword a244, v[4:5], off sc1
v_mfma_f32_16x16x32_bf16 v[28:31], a[0:3], a[208:211], v[92:95]
ds_read_b128 a[56:59], v2 offset:22528
v_mfma_f32_16x16x32_bf16 v[28:31], a[4:7], a[212:215], v[28:31]
s_add_u32 s32, s32, 0x8000
v_exp_f32 v47, v47
v_mfma_f32_16x16x32_bf16 v[28:31], a[8:11], a[216:219], v[28:31]
s_waitcnt lgkmcnt(7)
v_cvt_pk_bf16_f32 v63, v46, v47
v_mfma_f32_16x16x32_bf16 v[28:31], a[12:15], a[220:223], v[28:31]
ds_read_b128 a[60:63], v2 offset:23552
s_add_u32 s7, s7, 0x8000
v_mfma_f32_16x16x32_bf16 v[40:43], a[16:19], a[192:195], v[88:91]
s_xor_b32 s19, s19, 0x8000
v_xor_b32 v2, 0x38000, v2
v_mfma_f32_16x16x32_bf16 v[40:43], a[20:23], a[196:199], v[40:43]
s_sub_u32 s15, 7, s6
v_exp_f32 v24, v24
v_mfma_f32_16x16x32_bf16 v[40:43], a[24:27], a[200:203], v[40:43]
s_lshl_b32 s15, s15, 1
v_exp_f32 v25, v25
v_mfma_f32_16x16x32_bf16 v[40:43], a[28:31], a[204:207], v[40:43]
v_exp_f32 v26, v26
v_mfma_f32_16x16x32_bf16 v[44:47], a[16:19], a[208:211], v[92:95]
v_exp_f32 v27, v27
v_mfma_f32_16x16x32_bf16 v[44:47], a[20:23], a[212:215], v[44:47]
v_exp_f32 v28, v28
v_mfma_f32_16x16x32_bf16 v[44:47], a[24:27], a[216:219], v[44:47]
s_waitcnt vmcnt(22) lgkmcnt(0)
v_exp_f32 v29, v29
v_mfma_f32_16x16x32_bf16 v[44:47], a[28:31], a[220:223], v[44:47]
s_barrier
s_cbranch_scc0 L_att_lh0_1
s_cmp_lg_u32 s33, 0
s_cbranch_scc1 L_sig_bs1
s_lshl_b32 s8, s6, 2
s_add_u32 s8, s8, 192
s_cmp_lg_u32 s4, 0
s_cbranch_scc1 L_sig_bs1
v_mov_b32 v4, 1
s_mov_b64 exec, 1
buffer_atomic_add v4, off, s[84:87], s8 sc1
s_mov_b64 exec, -1
L_sig_bs1:
v_mfma_f32_16x16x32_bf16 v[160:163], a[32:35], v[52:55], v[160:163]
ds_read_b128 a[0:3], v1 offset:8192
v_cvt_pk_bf16_f32 v72, v24, v25
v_mfma_f32_16x16x32_bf16 v[192:195], a[32:35], v[56:59], v[192:195]
v_exp_f32 v30, v30
v_mfma_f32_16x16x32_bf16 v[224:227], a[32:35], v[60:63], v[224:227]
ds_read_b128 a[4:7], v1 offset:9216
v_cvt_pk_bf16_f32 v73, v26, v27
v_mfma_f32_16x16x32_bf16 v[228:231], a[36:39], v[60:63], v[228:231]
s_add_u32 m0, s27, 0x0
v_cvt_pk_bf16_f32 v76, v28, v29
v_accvgpr_read_b32 v6, a224
v_mfma_f32_16x16x32_bf16 v[196:199], a[36:39], v[56:59], v[196:199]
buffer_load_dwordx4 v3, s[48:51], s32 offen offset:0 sc1 lds
v_mfma_f32_16x16x32_bf16 v[164:167], a[36:39], v[52:55], v[164:167]
ds_read_b128 a[8:11], v1 offset:10240
v_accvgpr_read_b32 v7, a225
v_mfma_f32_16x16x32_bf16 v[168:171], a[40:43], v[52:55], v[168:171]
ds_read_b128 a[12:15], v1 offset:11264
v_add_f32 v6, v6, v7
v_mfma_f32_16x16x32_bf16 v[200:203], a[40:43], v[56:59], v[200:203]
v_exp_f32 v31, v31
v_mfma_f32_16x16x32_bf16 v[232:235], a[40:43], v[60:63], v[232:235]
v_exp_f32 v40, v40
v_mfma_f32_16x16x32_bf16 v[236:239], a[44:47], v[60:63], v[236:239]
ds_read_b128 a[16:19], v1 offset:12288
v_cvt_pk_bf16_f32 v77, v30, v31
v_mfma_f32_16x16x32_bf16 v[204:207], a[44:47], v[56:59], v[204:207]
v_cmp_nge_f32 vcc, 0x5f800000, v6
v_mfma_f32_16x16x32_bf16 v[172:175], a[44:47], v[52:55], v[172:175]
ds_read_b128 a[20:23], v1 offset:13312
v_mfma_f32_16x16x32_bf16 v[176:179], a[48:51], v[52:55], v[176:179]
v_exp_f32 v41, v41
v_mfma_f32_16x16x32_bf16 v[208:211], a[48:51], v[56:59], v[208:211]
ds_read_b128 a[24:27], v1 offset:14336
v_cvt_pk_bf16_f32 v74, v40, v41
v_mfma_f32_16x16x32_bf16 v[240:243], a[48:51], v[60:63], v[240:243]
buffer_load_dwordx4 v3, s[48:51], s32 offen offset:1024 sc1 lds
v_mfma_f32_16x16x32_bf16 v[244:247], a[52:55], v[60:63], v[244:247]
v_exp_f32 v42, v42
v_mfma_f32_16x16x32_bf16 v[212:215], a[52:55], v[56:59], v[212:215]
ds_read_b128 a[28:31], v1 offset:15360
v_mfma_f32_16x16x32_bf16 v[180:183], a[52:55], v[52:55], v[180:183]
v_exp_f32 v43, v43
v_mfma_f32_16x16x32_bf16 v[184:187], a[56:59], v[52:55], v[184:187]
ds_read_b128 a[32:35], v1 offset:0
v_cvt_pk_bf16_f32 v75, v42, v43
v_mfma_f32_16x16x32_bf16 v[216:219], a[56:59], v[56:59], v[216:219]
v_rcp_f32 v6, v6
v_mfma_f32_16x16x32_bf16 v[248:251], a[56:59], v[60:63], v[248:251]
ds_read_b128 a[36:39], v1 offset:1024
s_or_b64 s[34:35], s[34:35], vcc
v_mfma_f32_16x16x32_bf16 v[252:255], a[60:63], v[60:63], v[252:255]
s_add_u32 s8, s28, 0x0
v_exp_f32 v44, v44
v_mfma_f32_16x16x32_bf16 v[220:223], a[60:63], v[56:59], v[220:223]
v_exp_f32 v45, v45
v_mfma_f32_16x16x32_bf16 v[188:191], a[60:63], v[52:55], v[188:191]
ds_read_b128 a[40:43], v1 offset:2048
v_cvt_pk_bf16_f32 v78, v44, v45
v_mfma_f32_16x16x32_bf16 a[224:227], a[236:239], v[52:55], a[224:227]
buffer_load_dwordx4 v3, s[48:51], s32 offen offset:2048 sc1 lds
v_smfmac_f32_16x16x64_bf16 a[228:231], a[232:235], v[56:63], v9
ds_read_b128 a[44:47], v1 offset:3072
s_waitcnt lgkmcnt(8)
v_mfma_f32_16x16x32_bf16 v[24:27], a[0:3], a[192:195], v[88:91]
v_exp_f32 v46, v46
v_mfma_f32_16x16x32_bf16 v[24:27], a[4:7], a[196:199], v[24:27]
ds_read_b128 a[48:51], v1 offset:4096
v_mul_f32 v128, v6, v128
v_mfma_f32_16x16x32_bf16 v[24:27], a[8:11], a[200:203], v[24:27]
v_mul_f32 v129, v6, v129
v_mul_f32 v130, v6, v130
v_mfma_f32_16x16x32_bf16 v[24:27], a[12:15], a[204:207], v[24:27]
v_exp_f32 v47, v47
v_mfma_f32_16x16x32_bf16 v[28:31], a[0:3], a[208:211], v[92:95]
ds_read_b128 a[52:55], v1 offset:5120
v_cvt_pk_bf16_f32 v79, v46, v47
v_mfma_f32_16x16x32_bf16 v[28:31], a[4:7], a[212:215], v[28:31]
v_mul_f32 v131, v6, v131
v_mul_f32 v132, v6, v132
v_mfma_f32_16x16x32_bf16 v[28:31], a[8:11], a[216:219], v[28:31]
ds_read_b128 a[56:59], v1 offset:6144
v_mul_f32 v133, v6, v133
v_mfma_f32_16x16x32_bf16 v[28:31], a[12:15], a[220:223], v[28:31]
s_waitcnt lgkmcnt(7)
v_exp_f32 v24, v24
v_mfma_f32_16x16x32_bf16 v[40:43], a[16:19], a[192:195], v[88:91]
buffer_load_dwordx4 v3, s[48:51], s32 offen offset:3072 sc1 lds
v_mfma_f32_16x16x32_bf16 v[40:43], a[20:23], a[196:199], v[40:43]
ds_read_b128 a[60:63], v1 offset:7168
v_mul_f32 v134, v6, v134
v_mfma_f32_16x16x32_bf16 v[40:43], a[24:27], a[200:203], v[40:43]
s_add_u32 s32, s32, 0x8000
v_exp_f32 v25, v25
v_mfma_f32_16x16x32_bf16 v[40:43], a[28:31], a[204:207], v[40:43]
v_exp_f32 v26, v26
v_mfma_f32_16x16x32_bf16 v[44:47], a[16:19], a[208:211], v[92:95]
v_exp_f32 v27, v27
v_mfma_f32_16x16x32_bf16 v[44:47], a[20:23], a[212:215], v[44:47]
v_exp_f32 v28, v28
v_mfma_f32_16x16x32_bf16 v[44:47], a[24:27], a[216:219], v[44:47]
v_exp_f32 v29, v29
v_mfma_f32_16x16x32_bf16 v[44:47], a[28:31], a[220:223], v[44:47]
s_waitcnt lgkmcnt(0)
v_mul_f32 v135, v6, v135
v_cvt_pk_bf16_f32 v128, v128, v129
v_mfma_f32_16x16x32_bf16 v[192:195], a[32:35], v[72:75], v[192:195]
s_add_u32 m0, s27, 0x1000
v_exp_f32 v30, v30
v_mfma_f32_16x16x32_bf16 v[224:227], a[32:35], v[76:79], v[224:227]
buffer_load_dwordx4 v3, s[48:51], s7 offen offset:0 sc1 lds
v_mfma_f32_16x16x32_bf16 v[228:231], a[36:39], v[76:79], v[228:231]
v_exp_f32 v31, v31
v_mfma_f32_16x16x32_bf16 v[196:199], a[36:39], v[72:75], v[196:199]
ds_read_b128 a[0:3], v1 offset:24576
v_cvt_pk_bf16_f32 v56, v24, v25
v_mfma_f32_16x16x32_bf16 v[200:203], a[40:43], v[72:75], v[200:203]
ds_read_b128 a[4:7], v1 offset:25600
v_cvt_pk_bf16_f32 v57, v26, v27
v_mfma_f32_16x16x32_bf16 v[232:235], a[40:43], v[76:79], v[232:235]
v_exp_f32 v40, v40
v_mfma_f32_16x16x32_bf16 v[236:239], a[44:47], v[76:79], v[236:239]
ds_read_b128 a[8:11], v1 offset:26624
v_cvt_pk_bf16_f32 v60, v28, v29
v_mfma_f32_16x16x32_bf16 v[204:207], a[44:47], v[72:75], v[204:207]
v_exp_f32 v41, v41
v_mfma_f32_16x16x32_bf16 v[208:211], a[48:51], v[72:75], v[208:211]
ds_read_b128 a[12:15], v1 offset:27648
v_cvt_pk_bf16_f32 v61, v30, v31
v_mfma_f32_16x16x32_bf16 v[240:243], a[48:51], v[76:79], v[240:243]
ds_read_b128 a[16:19], v1 offset:28672
v_cvt_pk_bf16_f32 v58, v40, v41
v_mfma_f32_16x16x32_bf16 v[244:247], a[52:55], v[76:79], v[244:247]
v_exp_f32 v42, v42
v_mfma_f32_16x16x32_bf16 v[212:215], a[52:55], v[72:75], v[212:215]
buffer_load_dwordx4 v3, s[48:51], s7 offen offset:1024 sc1 lds
v_mfma_f32_16x16x32_bf16 v[216:219], a[56:59], v[72:75], v[216:219]
ds_read_b128 a[20:23], v1 offset:29696
v_cvt_pk_bf16_f32 v129, v130, v131
v_mfma_f32_16x16x32_bf16 v[248:251], a[56:59], v[76:79], v[248:251]
ds_read_b128 a[24:27], v1 offset:30720
v_cvt_pk_bf16_f32 v130, v132, v133
v_mfma_f32_16x16x32_bf16 v[252:255], a[60:63], v[76:79], v[252:255]
ds_read_b128 a[28:31], v1 offset:31744
v_cvt_pk_bf16_f32 v131, v134, v135
v_mfma_f32_16x16x32_bf16 v[220:223], a[60:63], v[72:75], v[220:223]
s_waitcnt lgkmcnt(4)
v_exp_f32 v43, v43
v_smfmac_f32_16x16x64_bf16 a[228:231], a[232:235], v[72:79], v9
ds_read_b128 a[32:35], v1 offset:16384
v_cvt_pk_bf16_f32 v59, v42, v43
v_mfma_f32_16x16x32_bf16 v[24:27], a[0:3], a[192:195], v[88:91]
ds_read_b128 a[36:39], v1 offset:17408
buffer_store_dwordx4 v[128:131], v3, s[88:91], s8 offen sc1
v_mfma_f32_16x16x32_bf16 v[24:27], a[4:7], a[196:199], v[24:27]
buffer_load_dwordx4 v3, s[48:51], s7 offen offset:2048 sc1 lds
v_mfma_f32_16x16x32_bf16 v[24:27], a[8:11], a[200:203], v[24:27]
ds_read_b128 a[40:43], v1 offset:18432
v_exp_f32 v44, v44
v_mfma_f32_16x16x32_bf16 v[24:27], a[12:15], a[204:207], v[24:27]
ds_read_b128 a[44:47], v1 offset:19456
v_exp_f32 v45, v45
v_mfma_f32_16x16x32_bf16 v[28:31], a[0:3], a[208:211], v[92:95]
ds_read_b128 a[48:51], v1 offset:20480
v_exp_f32 v46, v46
v_mfma_f32_16x16x32_bf16 v[28:31], a[4:7], a[212:215], v[28:31]
s_waitcnt lgkmcnt(5)
v_exp_f32 v47, v47
v_mfma_f32_16x16x32_bf16 v[28:31], a[8:11], a[216:219], v[28:31]
ds_read_b128 a[52:55], v1 offset:21504
v_cvt_pk_bf16_f32 v62, v44, v45
v_mfma_f32_16x16x32_bf16 v[28:31], a[12:15], a[220:223], v[28:31]
ds_read_b128 a[56:59], v1 offset:22528
v_cvt_pk_bf16_f32 v63, v46, v47
v_mfma_f32_16x16x32_bf16 v[40:43], a[16:19], a[192:195], v[88:91]
ds_read_b128 a[60:63], v1 offset:23552
v_xor_b32 v1, 0x8000, v1
v_mfma_f32_16x16x32_bf16 v[40:43], a[20:23], a[196:199], v[40:43]
buffer_load_dwordx4 v3, s[48:51], s7 offen offset:3072 sc1 lds
v_mfma_f32_16x16x32_bf16 v[40:43], a[24:27], a[200:203], v[40:43]
s_add_u32 s7, s7, 0x8000
v_exp_f32 v24, v24
v_mfma_f32_16x16x32_bf16 v[40:43], a[28:31], a[204:207], v[40:43]
s_xor_b32 s27, s27, 0x38000
v_exp_f32 v25, v25
v_mfma_f32_16x16x32_bf16 v[44:47], a[16:19], a[208:211], v[92:95]
s_add_u32 s8, s28, 0x2000
v_exp_f32 v26, v26
v_mfma_f32_16x16x32_bf16 v[44:47], a[20:23], a[212:215], v[44:47]
v_exp_f32 v27, v27
v_mfma_f32_16x16x32_bf16 v[44:47], a[24:27], a[216:219], v[44:47]
s_waitcnt vmcnt(19) lgkmcnt(0)
v_exp_f32 v28, v28
v_mfma_f32_16x16x32_bf16 v[44:47], a[28:31], a[220:223], v[44:47]
s_barrier
v_exp_f32 v29, v29
v_mul_f32 v136, v6, v136
v_mul_f32 v137, v6, v137
v_mul_f32 v138, v6, v138
v_mul_f32 v139, v6, v139
v_mul_f32 v140, v6, v140
v_mul_f32 v141, v6, v141
v_mul_f32 v142, v6, v142
v_mul_f32 v143, v6, v143
v_cvt_pk_bf16_f32 v136, v136, v137
v_cvt_pk_bf16_f32 v137, v138, v139
v_cvt_pk_bf16_f32 v138, v140, v141
v_cvt_pk_bf16_f32 v139, v142, v143
buffer_store_dwordx4 v[136:139], v3, s[88:91], s8 offen sc1
s_add_u32 s8, s28, 0x4000
v_mul_f32 v144, v6, v144
v_mul_f32 v145, v6, v145
v_mul_f32 v146, v6, v146
v_mul_f32 v147, v6, v147
v_mul_f32 v148, v6, v148
v_mul_f32 v149, v6, v149
v_mul_f32 v150, v6, v150
v_mul_f32 v151, v6, v151
v_cvt_pk_bf16_f32 v144, v144, v145
v_cvt_pk_bf16_f32 v145, v146, v147
v_cvt_pk_bf16_f32 v146, v148, v149
v_cvt_pk_bf16_f32 v147, v150, v151
buffer_store_dwordx4 v[144:147], v3, s[88:91], s8 offen sc1
s_add_u32 s8, s28, 0x6000
v_mul_f32 v152, v6, v152
v_mul_f32 v153, v6, v153
v_mul_f32 v154, v6, v154
v_mul_f32 v155, v6, v155
v_mul_f32 v156, v6, v156
v_mul_f32 v157, v6, v157
v_mul_f32 v158, v6, v158
v_mul_f32 v159, v6, v159
v_cvt_pk_bf16_f32 v152, v152, v153
v_cvt_pk_bf16_f32 v153, v154, v155
v_cvt_pk_bf16_f32 v154, v156, v157
v_cvt_pk_bf16_f32 v155, v158, v159
buffer_store_dwordx4 v[152:155], v3, s[88:91], s8 offen sc1
v_accvgpr_read_b32 v6, a226
v_accvgpr_read_b32 v7, a227
v_add_f32 v6, v6, v7
v_cmp_nge_f32 vcc, 0x5f800000, v6
v_rcp_f32 v6, v6
s_or_b64 s[34:35], s[34:35], vcc
s_add_u32 s8, s29, 0x0
v_pk_mul_f32 v[160:161], v[160:161], v[6:7] op_sel_hi:[1,0]
v_pk_mul_f32 v[162:163], v[162:163], v[6:7] op_sel_hi:[1,0]
v_pk_mul_f32 v[164:165], v[164:165], v[6:7] op_sel_hi:[1,0]
v_pk_mul_f32 v[166:167], v[166:167], v[6:7] op_sel_hi:[1,0]
v_cvt_pk_bf16_f32 v160, v160, v161
v_cvt_pk_bf16_f32 v161, v162, v163
v_cvt_pk_bf16_f32 v162, v164, v165
v_cvt_pk_bf16_f32 v163, v166, v167
buffer_store_dwordx4 v[160:163], v3, s[88:91], s8 offen sc1
s_add_u32 s8, s29, 0x2000
v_pk_mul_f32 v[168:169], v[168:169], v[6:7] op_sel_hi:[1,0]
v_pk_mul_f32 v[170:171], v[170:171], v[6:7] op_sel_hi:[1,0]
v_pk_mul_f32 v[172:173], v[172:173], v[6:7] op_sel_hi:[1,0]
v_pk_mul_f32 v[174:175], v[174:175], v[6:7] op_sel_hi:[1,0]
v_cvt_pk_bf16_f32 v168, v168, v169
v_cvt_pk_bf16_f32 v169, v170, v171
v_cvt_pk_bf16_f32 v170, v172, v173
v_cvt_pk_bf16_f32 v171, v174, v175
buffer_store_dwordx4 v[168:171], v3, s[88:91], s8 offen sc1
s_add_u32 s8, s29, 0x4000
v_pk_mul_f32 v[176:177], v[176:177], v[6:7] op_sel_hi:[1,0]
v_pk_mul_f32 v[178:179], v[178:179], v[6:7] op_sel_hi:[1,0]
v_pk_mul_f32 v[180:181], v[180:181], v[6:7] op_sel_hi:[1,0]
v_pk_mul_f32 v[182:183], v[182:183], v[6:7] op_sel_hi:[1,0]
v_cvt_pk_bf16_f32 v176, v176, v177
v_cvt_pk_bf16_f32 v177, v178, v179
v_cvt_pk_bf16_f32 v178, v180, v181
v_cvt_pk_bf16_f32 v179, v182, v183
buffer_store_dwordx4 v[176:179], v3, s[88:91], s8 offen sc1
s_add_u32 s8, s29, 0x6000
v_pk_mul_f32 v[184:185], v[184:185], v[6:7] op_sel_hi:[1,0]
v_pk_mul_f32 v[186:187], v[186:187], v[6:7] op_sel_hi:[1,0]
v_pk_mul_f32 v[188:189], v[188:189], v[6:7] op_sel_hi:[1,0]
v_pk_mul_f32 v[190:191], v[190:191], v[6:7] op_sel_hi:[1,0]
v_cvt_pk_bf16_f32 v184, v184, v185
v_cvt_pk_bf16_f32 v185, v186, v187
v_cvt_pk_bf16_f32 v186, v188, v189
v_cvt_pk_bf16_f32 v187, v190, v191
buffer_store_dwordx4 v[184:187], v3, s[88:91], s8 offen sc1
s_branch L_att_sodd
L_att_lh0_1:
s_cmp_lg_u32 s33, 0
s_cbranch_scc1 L_sig_bh1
s_lshl_b32 s8, s6, 2
s_add_u32 s8, s8, 192
s_cmp_lg_u32 s4, 0
s_cbranch_scc1 L_sig_bh1
v_mov_b32 v4, 1
s_mov_b64 exec, 1
buffer_atomic_add v4, off, s[84:87], s8 sc1
s_mov_b64 exec, -1
L_sig_bh1:
v_mfma_f32_16x16x32_bf16 v[160:163], a[32:35], v[52:55], v[160:163]
ds_read_b128 a[0:3], v1 offset:8192
v_cvt_pk_bf16_f32 v72, v24, v25
v_mfma_f32_16x16x32_bf16 v[192:195], a[32:35], v[56:59], v[192:195]
v_exp_f32 v30, v30
v_mfma_f32_16x16x32_bf16 v[224:227], a[32:35], v[60:63], v[224:227]
buffer_load_dword v14, v15, s[84:87], 0 offen offset:192 sc1
v_mfma_f32_16x16x32_bf16 v[228:231], a[36:39], v[60:63], v[228:231]
ds_read_b128 a[4:7], v1 offset:9216
v_cvt_pk_bf16_f32 v73, v26, v27
v_mfma_f32_16x16x32_bf16 v[196:199], a[36:39], v[56:59], v[196:199]
ds_read_b128 a[8:11], v1 offset:10240
v_cvt_pk_bf16_f32 v76, v28, v29
v_mfma_f32_16x16x32_bf16 v[164:167], a[36:39], v[52:55], v[164:167]
s_add_u32 m0, s17, 0x10000
v_exp_f32 v31, v31
v_mfma_f32_16x16x32_bf16 v[168:171], a[40:43], v[52:55], v[168:171]
buffer_load_dwordx4 v12, s[72:75], 0 offen lds
v_mfma_f32_16x16x32_bf16 v[200:203], a[40:43], v[56:59], v[200:203]
ds_read_b128 a[12:15], v1 offset:11264
v_cvt_pk_bf16_f32 v77, v30, v31
v_mfma_f32_16x16x32_bf16 v[232:235], a[40:43], v[60:63], v[232:235]
v_exp_f32 v40, v40
v_mfma_f32_16x16x32_bf16 v[236:239], a[44:47], v[60:63], v[236:239]
ds_read_b128 a[16:19], v1 offset:12288
v_mfma_f32_16x16x32_bf16 v[204:207], a[44:47], v[56:59], v[204:207]
v_exp_f32 v41, v41
v_mfma_f32_16x16x32_bf16 v[172:175], a[44:47], v[52:55], v[172:175]
buffer_load_dwordx4 v13, s[72:75], 0 offen offset:1024 lds
v_mfma_f32_16x16x32_bf16 v[176:179], a[48:51], v[52:55], v[176:179]
ds_read_b128 a[20:23], v1 offset:13312
v_cvt_pk_bf16_f32 v74, v40, v41
v_mfma_f32_16x16x32_bf16 v[208:211], a[48:51], v[56:59], v[208:211]
ds_read_b128 a[24:27], v1 offset:14336
v_mfma_f32_16x16x32_bf16 v[240:243], a[48:51], v[60:63], v[240:243]
v_exp_f32 v42, v42
v_mfma_f32_16x16x32_bf16 v[244:247], a[52:55], v[60:63], v[244:247]
buffer_load_dwordx4 v12, s[72:75], s12 offen offset:2048 lds
v_mfma_f32_16x16x32_bf16 v[212:215], a[52:55], v[56:59], v[212:215]
ds_read_b128 a[28:31], v1 offset:15360
v_mfma_f32_16x16x32_bf16 v[180:183], a[52:55], v[52:55], v[180:183]
v_exp_f32 v43, v43
v_mfma_f32_16x16x32_bf16 v[184:187], a[56:59], v[52:55], v[184:187]
ds_read_b128 a[32:35], v1 offset:0
v_cvt_pk_bf16_f32 v75, v42, v43
v_mfma_f32_16x16x32_bf16 v[216:219], a[56:59], v[56:59], v[216:219]
v_exp_f32 v44, v44
v_mfma_f32_16x16x32_bf16 v[248:251], a[56:59], v[60:63], v[248:251]
buffer_load_dwordx4 v13, s[72:75], s12 offen offset:3072 lds
v_mfma_f32_16x16x32_bf16 v[252:255], a[60:63], v[60:63], v[252:255]
ds_read_b128 a[36:39], v1 offset:1024
v_mfma_f32_16x16x32_bf16 v[220:223], a[60:63], v[56:59], v[220:223]
s_add_u32 m0, s17, 0x14000
v_exp_f32 v45, v45
v_mfma_f32_16x16x32_bf16 v[188:191], a[60:63], v[52:55], v[188:191]
ds_read_b128 a[40:43], v1 offset:2048
v_add_u32 v12, 0x20000, v12
v_mfma_f32_16x16x32_bf16 a[224:227], a[236:239], v[52:55], a[224:227]
buffer_load_dwordx4 v12, s[72:75], 0 offen lds
v_smfmac_f32_16x16x64_bf16 a[228:231], a[232:235], v[56:63], v9
ds_read_b128 a[44:47], v1 offset:3072
s_waitcnt lgkmcnt(8)
v_mfma_f32_16x16x32_bf16 v[24:27], a[0:3], a[192:195], v[88:91]
v_exp_f32 v46, v46
v_mfma_f32_16x16x32_bf16 v[24:27], a[4:7], a[196:199], v[24:27]
ds_read_b128 a[48:51], v1 offset:4096
v_add_u32 v13, 0x20000, v13
v_mfma_f32_16x16x32_bf16 v[24:27], a[8:11], a[200:203], v[24:27]
buffer_load_dwordx4 v13, s[72:75], 0 offen offset:1024 lds
v_mfma_f32_16x16x32_bf16 v[24:27], a[12:15], a[204:207], v[24:27]
v_exp_f32 v47, v47
v_mfma_f32_16x16x32_bf16 v[28:31], a[0:3], a[208:211], v[92:95]
ds_read_b128 a[52:55], v1 offset:5120
v_cvt_pk_bf16_f32 v78, v44, v45
v_mfma_f32_16x16x32_bf16 v[28:31], a[4:7], a[212:215], v[28:31]
s_waitcnt lgkmcnt(6)
v_cvt_pk_bf16_f32 v79, v46, v47
v_mfma_f32_16x16x32_bf16 v[28:31], a[8:11], a[216:219], v[28:31]
ds_read_b128 a[56:59], v1 offset:6144
v_mfma_f32_16x16x32_bf16 v[28:31], a[12:15], a[220:223], v[28:31]
buffer_load_dwordx4 v12, s[72:75], s12 offen offset:2048 lds
v_mfma_f32_16x16x32_bf16 v[40:43], a[16:19], a[192:195], v[88:91]
ds_read_b128 a[60:63], v1 offset:7168
v_mfma_f32_16x16x32_bf16 v[40:43], a[20:23], a[196:199], v[40:43]
v_exp_f32 v24, v24
v_mfma_f32_16x16x32_bf16 v[40:43], a[24:27], a[200:203], v[40:43]
v_exp_f32 v25, v25
v_mfma_f32_16x16x32_bf16 v[40:43], a[28:31], a[204:207], v[40:43]
buffer_load_dwordx4 v13, s[72:75], s12 offen offset:3072 lds
v_mfma_f32_16x16x32_bf16 v[44:47], a[16:19], a[208:211], v[92:95]
v_exp_f32 v26, v26
v_mfma_f32_16x16x32_bf16 v[44:47], a[20:23], a[212:215], v[44:47]
v_exp_f32 v27, v27
v_mfma_f32_16x16x32_bf16 v[44:47], a[24:27], a[216:219], v[44:47]
v_exp_f32 v28, v28
v_mfma_f32_16x16x32_bf16 v[44:47], a[28:31], a[220:223], v[44:47]
s_waitcnt lgkmcnt(0)
v_exp_f32 v29, v29
v_mfma_f32_16x16x32_bf16 v[192:195], a[32:35], v[72:75], v[192:195]
s_add_u32 m0, s16, 0x0
v_add_u32 v12, 0x20000, v12
v_cvt_pk_bf16_f32 v56, v24, v25
v_mfma_f32_16x16x32_bf16 v[224:227], a[32:35], v[76:79], v[224:227]
buffer_load_dwordx4 v12, s[72:75], 0 offen lds
v_mfma_f32_16x16x32_bf16 v[228:231], a[36:39], v[76:79], v[228:231]
ds_read_b128 a[0:3], v1 offset:24576
v_cvt_pk_bf16_f32 v57, v26, v27
v_mfma_f32_16x16x32_bf16 v[196:199], a[36:39], v[72:75], v[196:199]
v_exp_f32 v30, v30
v_mfma_f32_16x16x32_bf16 v[200:203], a[40:43], v[72:75], v[200:203]
ds_read_b128 a[4:7], v1 offset:25600
v_cvt_pk_bf16_f32 v60, v28, v29
v_mfma_f32_16x16x32_bf16 v[232:235], a[40:43], v[76:79], v[232:235]
ds_read_b128 a[8:11], v1 offset:26624
v_add_u32 v13, 0x20000, v13
v_mfma_f32_16x16x32_bf16 v[236:239], a[44:47], v[76:79], v[236:239]
buffer_load_dwordx4 v13, s[72:75], 0 offen offset:1024 lds
v_mfma_f32_16x16x32_bf16 v[204:207], a[44:47], v[72:75], v[204:207]
ds_read_b128 a[12:15], v1 offset:27648
v_exp_f32 v31, v31
v_mfma_f32_16x16x32_bf16 v[208:211], a[48:51], v[72:75], v[208:211]
buffer_load_dwordx4 v12, s[72:75], s12 offen offset:2048 lds
v_mfma_f32_16x16x32_bf16 v[240:243], a[48:51], v[76:79], v[240:243]
ds_read_b128 a[16:19], v1 offset:28672
v_exp_f32 v40, v40
v_mfma_f32_16x16x32_bf16 v[244:247], a[52:55], v[76:79], v[244:247]
ds_read_b128 a[20:23], v1 offset:29696
v_cvt_pk_bf16_f32 v61, v30, v31
v_mfma_f32_16x16x32_bf16 v[212:215], a[52:55], v[72:75], v[212:215]
buffer_load_dwordx4 v13, s[72:75], s12 offen offset:3072 lds
v_mfma_f32_16x16x32_bf16 v[216:219], a[56:59], v[72:75], v[216:219]
ds_read_b128 a[24:27], v1 offset:30720
v_exp_f32 v41, v41
v_mfma_f32_16x16x32_bf16 v[248:251], a[56:59], v[76:79], v[248:251]
ds_read_b128 a[28:31], v1 offset:31744
v_exp_f32 v42, v42
v_mfma_f32_16x16x32_bf16 v[252:255], a[60:63], v[76:79], v[252:255]
ds_read_b128 a[32:35], v1 offset:16384
v_cvt_pk_bf16_f32 v58, v40, v41
v_mfma_f32_16x16x32_bf16 v[220:223], a[60:63], v[72:75], v[220:223]
s_waitcnt lgkmcnt(5)
v_exp_f32 v43, v43
v_smfmac_f32_16x16x64_bf16 a[228:231], a[232:235], v[72:79], v9
ds_read_b128 a[36:39], v1 offset:17408
v_add_u32 v12, 0x20000, v12
v_mfma_f32_16x16x32_bf16 v[24:27], a[0:3], a[192:195], v[112:115]
s_add_u32 m0, s16, 0x4000
v_exp_f32 v44, v44
v_mfma_f32_16x16x32_bf16 v[24:27], a[4:7], a[196:199], v[24:27]
buffer_load_dwordx4 v12, s[72:75], 0 offen lds
v_mfma_f32_16x16x32_bf16 v[24:27], a[8:11], a[200:203], v[24:27]
ds_read_b128 a[40:43], v1 offset:18432
v_add_u32 v13, 0x20000, v13
v_mfma_f32_16x16x32_bf16 v[24:27], a[12:15], a[204:207], v[24:27]
buffer_load_dwordx4 v13, s[72:75], 0 offen offset:1024 lds
v_mfma_f32_16x16x32_bf16 v[28:31], a[0:3], a[208:211], v[92:95]
ds_read_b128 a[44:47], v1 offset:19456
v_cvt_pk_bf16_f32 v59, v42, v43
v_mfma_f32_16x16x32_bf16 v[28:31], a[4:7], a[212:215], v[28:31]
ds_read_b128 a[48:51], v1 offset:20480
v_exp_f32 v45, v45
v_mfma_f32_16x16x32_bf16 v[28:31], a[8:11], a[216:219], v[28:31]
s_waitcnt lgkmcnt(5)
v_exp_f32 v46, v46
v_mfma_f32_16x16x32_bf16 v[28:31], a[12:15], a[220:223], v[28:31]
buffer_load_dwordx4 v12, s[72:75], s12 offen offset:2048 lds
v_mfma_f32_16x16x32_bf16 v[40:43], a[16:19], a[192:195], v[116:119]
ds_read_b128 a[52:55], v1 offset:21504
v_exp_f32 v47, v47
v_mfma_f32_16x16x32_bf16 v[40:43], a[20:23], a[196:199], v[40:43]
ds_read_b128 a[56:59], v1 offset:22528
v_exp_f32 v24, v24
v_mfma_f32_16x16x32_bf16 v[40:43], a[24:27], a[200:203], v[40:43]
ds_read_b128 a[60:63], v1 offset:23552
v_xor_b32 v1, 0x8000, v1
v_mfma_f32_16x16x32_bf16 v[40:43], a[28:31], a[204:207], v[40:43]
v_exp_f32 v25, v25
v_cvt_pk_bf16_f32 v62, v44, v45
v_cvt_pk_bf16_f32 v63, v46, v47
v_mfma_f32_16x16x32_bf16 v[44:47], a[16:19], a[208:211], v[92:95]
v_exp_f32 v26, v26
v_mfma_f32_16x16x32_bf16 v[44:47], a[20:23], a[212:215], v[44:47]
buffer_load_dwordx4 v13, s[72:75], s12 offen offset:3072 lds
v_mfma_f32_16x16x32_bf16 v[44:47], a[24:27], a[216:219], v[44:47]
v_exp_f32 v27, v27
v_mfma_f32_16x16x32_bf16 v[44:47], a[28:31], a[220:223], v[44:47]
v_exp_f32 v28, v28
v_exp_f32 v29, v29
v_accvgpr_read_b32 v6, a224
v_accvgpr_read_b32 v7, a225
v_add_f32 v6, v6, v7
v_cmp_nge_f32 vcc, 0x5f800000, v6
v_rcp_f32 v6, v6
s_or_b64 s[34:35], s[34:35], vcc
s_add_u32 s8, s28, 0x0
v_pk_mul_f32 v[128:129], v[128:129], v[6:7] op_sel_hi:[1,0]
v_pk_mul_f32 v[130:131], v[130:131], v[6:7] op_sel_hi:[1,0]
v_pk_mul_f32 v[132:133], v[132:133], v[6:7] op_sel_hi:[1,0]
v_pk_mul_f32 v[134:135], v[134:135], v[6:7] op_sel_hi:[1,0]
v_cvt_pk_bf16_f32 v128, v128, v129
v_cvt_pk_bf16_f32 v129, v130, v131
v_cvt_pk_bf16_f32 v130, v132, v133
v_cvt_pk_bf16_f32 v131, v134, v135
buffer_store_dwordx4 v[128:131], v3, s[88:91], s8 offen sc1
s_add_u32 s8, s28, 0x2000
v_pk_mul_f32 v[136:137], v[136:137], v[6:7] op_sel_hi:[1,0]
v_pk_mul_f32 v[138:139], v[138:139], v[6:7] op_sel_hi:[1,0]
v_pk_mul_f32 v[140:141], v[140:141], v[6:7] op_sel_hi:[1,0]
v_pk_mul_f32 v[142:143], v[142:143], v[6:7] op_sel_hi:[1,0]
v_cvt_pk_bf16_f32 v136, v136, v137
v_cvt_pk_bf16_f32 v137, v138, v139
v_cvt_pk_bf16_f32 v138, v140, v141
v_cvt_pk_bf16_f32 v139, v142, v143
buffer_store_dwordx4 v[136:139], v3, s[88:91], s8 offen sc1
s_add_u32 s8, s28, 0x4000
v_pk_mul_f32 v[144:145], v[144:145], v[6:7] op_sel_hi:[1,0]
v_pk_mul_f32 v[146:147], v[146:147], v[6:7] op_sel_hi:[1,0]
v_pk_mul_f32 v[148:149], v[148:149], v[6:7] op_sel_hi:[1,0]
v_pk_mul_f32 v[150:151], v[150:151], v[6:7] op_sel_hi:[1,0]
v_cvt_pk_bf16_f32 v144, v144, v145
v_cvt_pk_bf16_f32 v145, v146, v147
v_cvt_pk_bf16_f32 v146, v148, v149
v_cvt_pk_bf16_f32 v147, v150, v151
buffer_store_dwordx4 v[144:147], v3, s[88:91], s8 offen sc1
s_add_u32 s8, s28, 0x6000
v_pk_mul_f32 v[152:153], v[152:153], v[6:7] op_sel_hi:[1,0]
v_pk_mul_f32 v[154:155], v[154:155], v[6:7] op_sel_hi:[1,0]
v_pk_mul_f32 v[156:157], v[156:157], v[6:7] op_sel_hi:[1,0]
v_pk_mul_f32 v[158:159], v[158:159], v[6:7] op_sel_hi:[1,0]
v_cvt_pk_bf16_f32 v152, v152, v153
v_cvt_pk_bf16_f32 v153, v154, v155
v_cvt_pk_bf16_f32 v154, v156, v157
v_cvt_pk_bf16_f32 v155, v158, v159
buffer_store_dwordx4 v[152:155], v3, s[88:91], s8 offen sc1
v_accvgpr_read_b32 v6, a226
v_accvgpr_read_b32 v7, a227
v_add_f32 v6, v6, v7
v_cmp_nge_f32 vcc, 0x5f800000, v6
v_rcp_f32 v6, v6
s_or_b64 s[34:35], s[34:35], vcc
s_add_u32 s8, s29, 0x0
v_pk_mul_f32 v[160:161], v[160:161], v[6:7] op_sel_hi:[1,0]
v_pk_mul_f32 v[162:163], v[162:163], v[6:7] op_sel_hi:[1,0]
v_pk_mul_f32 v[164:165], v[164:165], v[6:7] op_sel_hi:[1,0]
v_pk_mul_f32 v[166:167], v[166:167], v[6:7] op_sel_hi:[1,0]
v_cvt_pk_bf16_f32 v160, v160, v161
v_cvt_pk_bf16_f32 v161, v162, v163
v_cvt_pk_bf16_f32 v162, v164, v165
v_cvt_pk_bf16_f32 v163, v166, v167
buffer_store_dwordx4 v[160:163], v3, s[88:91], s8 offen sc1
s_add_u32 s8, s29, 0x2000
v_pk_mul_f32 v[168:169], v[168:169], v[6:7] op_sel_hi:[1,0]
v_pk_mul_f32 v[170:171], v[170:171], v[6:7] op_sel_hi:[1,0]
v_pk_mul_f32 v[172:173], v[172:173], v[6:7] op_sel_hi:[1,0]
v_pk_mul_f32 v[174:175], v[174:175], v[6:7] op_sel_hi:[1,0]
v_cvt_pk_bf16_f32 v168, v168, v169
v_cvt_pk_bf16_f32 v169, v170, v171
v_cvt_pk_bf16_f32 v170, v172, v173
v_cvt_pk_bf16_f32 v171, v174, v175
buffer_store_dwordx4 v[168:171], v3, s[88:91], s8 offen sc1
s_add_u32 s8, s29, 0x4000
v_pk_mul_f32 v[176:177], v[176:177], v[6:7] op_sel_hi:[1,0]
v_pk_mul_f32 v[178:179], v[178:179], v[6:7] op_sel_hi:[1,0]
v_pk_mul_f32 v[180:181], v[180:181], v[6:7] op_sel_hi:[1,0]
v_pk_mul_f32 v[182:183], v[182:183], v[6:7] op_sel_hi:[1,0]
v_cvt_pk_bf16_f32 v176, v176, v177
v_cvt_pk_bf16_f32 v177, v178, v179
v_cvt_pk_bf16_f32 v178, v180, v181
v_cvt_pk_bf16_f32 v179, v182, v183
buffer_store_dwordx4 v[176:179], v3, s[88:91], s8 offen sc1
s_add_u32 s8, s29, 0x6000
v_pk_mul_f32 v[184:185], v[184:185], v[6:7] op_sel_hi:[1,0]
v_pk_mul_f32 v[186:187], v[186:187], v[6:7] op_sel_hi:[1,0]
v_pk_mul_f32 v[188:189], v[188:189], v[6:7] op_sel_hi:[1,0]
v_pk_mul_f32 v[190:191], v[190:191], v[6:7] op_sel_hi:[1,0]
v_cvt_pk_bf16_f32 v184, v184, v185
v_cvt_pk_bf16_f32 v185, v186, v187
v_cvt_pk_bf16_f32 v186, v188, v189
v_cvt_pk_bf16_f32 v187, v190, v191
buffer_store_dwordx4 v[184:187], v3, s[88:91], s8 offen sc1
s_branch L_att_h1_1
L_att_j0:
s_cmp_ge_u32 s4, 2
s_cbranch_scc1 L_att_nl0_1
L_att_nl0_0:
v_mfma_f32_16x16x32_bf16 v[16:19], a[0:3], a[160:163], v[96:99]
v_mfma_f32_16x16x32_bf16 v[16:19], a[4:7], a[164:167], v[16:19]
s_add_u32 m0, s27, 0x0
v_mfma_f32_16x16x32_bf16 v[16:19], a[8:11], a[168:171], v[16:19]
buffer_load_dwordx4 v3, s[48:51], s32 offen offset:0 sc1 lds
v_mfma_f32_16x16x32_bf16 v[16:19], a[12:15], a[172:175], v[16:19]
v_mfma_f32_16x16x32_bf16 v[20:23], a[0:3], a[176:179], v[84:87]
v_mfma_f32_16x16x32_bf16 v[20:23], a[4:7], a[180:183], v[20:23]
v_mfma_f32_16x16x32_bf16 v[20:23], a[8:11], a[184:187], v[20:23]
s_mov_b32 s9, 0x0
v_mfma_f32_16x16x32_bf16 v[20:23], a[12:15], a[188:191], v[20:23]
buffer_load_dword a244, v8, s[72:75], s9 offen
v_mfma_f32_16x16x32_bf16 v[24:27], a[0:3], a[192:195], v[88:91]
s_nop 0
v_exp_f32 v16, v16
v_mfma_f32_16x16x32_bf16 v[24:27], a[4:7], a[196:199], v[24:27]
v_exp_f32 v17, v17
v_mfma_f32_16x16x32_bf16 v[24:27], a[8:11], a[200:203], v[24:27]
v_exp_f32 v18, v18
v_mfma_f32_16x16x32_bf16 v[24:27], a[12:15], a[204:207], v[24:27]
v_exp_f32 v19, v19
v_mfma_f32_16x16x32_bf16 v[28:31], a[0:3], a[208:211], v[92:95]
buffer_load_dwordx4 v3, s[48:51], s32 offen offset:1024 sc1 lds
v_mfma_f32_16x16x32_bf16 v[28:31], a[4:7], a[212:215], v[28:31]
v_exp_f32 v20, v20
v_mfma_f32_16x16x32_bf16 v[28:31], a[8:11], a[216:219], v[28:31]
v_exp_f32 v21, v21
v_mfma_f32_16x16x32_bf16 v[28:31], a[12:15], a[220:223], v[28:31]
v_cvt_pk_bf16_f32 v48, v16, v17
v_cvt_pk_bf16_f32 v49, v18, v19
v_mfma_f32_16x16x32_bf16 v[32:35], a[16:19], a[160:163], v[100:103]
v_exp_f32 v22, v22
v_mfma_f32_16x16x32_bf16 v[32:35], a[20:23], a[164:167], v[32:35]
buffer_load_dwordx4 v3, s[48:51], s32 offen offset:2048 sc1 lds
v_mfma_f32_16x16x32_bf16 v[32:35], a[24:27], a[168:171], v[32:35]
v_cvt_pk_bf16_f32 v52, v20, v21
v_mfma_f32_16x16x32_bf16 v[32:35], a[28:31], a[172:175], v[32:35]
v_mfma_f32_16x16x32_bf16 v[36:39], a[16:19], a[176:179], v[84:87]
v_exp_f32 v23, v23
v_mfma_f32_16x16x32_bf16 v[36:39], a[20:23], a[180:183], v[36:39]
v_cvt_pk_bf16_f32 v53, v22, v23
v_mfma_f32_16x16x32_bf16 v[36:39], a[24:27], a[184:187], v[36:39]
buffer_load_dwordx4 v3, s[48:51], s32 offen offset:3072 sc1 lds
v_mfma_f32_16x16x32_bf16 v[36:39], a[28:31], a[188:191], v[36:39]
v_exp_f32 v24, v24
v_mfma_f32_16x16x32_bf16 v[40:43], a[16:19], a[192:195], v[88:91]
v_mfma_f32_16x16x32_bf16 v[40:43], a[20:23], a[196:199], v[40:43]
v_exp_f32 v25, v25
v_mfma_f32_16x16x32_bf16 v[40:43], a[24:27], a[200:203], v[40:43]
s_mov_b32 s9, 0x0
v_mfma_f32_16x16x32_bf16 v[40:43], a[28:31], a[204:207], v[40:43]
buffer_load_dword a244, v8, s[64:67], s9 offen
v_mfma_f32_16x16x32_bf16 v[44:47], a[16:19], a[208:211], v[92:95]
v_exp_f32 v26, v26
v_mfma_f32_16x16x32_bf16 v[44:47], a[20:23], a[212:215], v[44:47]
v_mfma_f32_16x16x32_bf16 v[44:47], a[24:27], a[216:219], v[44:47]
v_exp_f32 v27, v27
v_mfma_f32_16x16x32_bf16 v[44:47], a[28:31], a[220:223], v[44:47]
s_waitcnt lgkmcnt(0)
ds_read_b128 a[0:3], v1 offset:24576
ds_read_b128 a[4:7], v1 offset:25600
ds_read_b128 a[8:11], v1 offset:26624
ds_read_b128 a[12:15], v1 offset:27648
ds_read_b128 a[16:19], v1 offset:28672
ds_read_b128 a[20:23], v1 offset:29696
ds_read_b128 a[24:27], v1 offset:30720
ds_read_b128 a[28:31], v1 offset:31744
s_waitcnt lgkmcnt(7)
v_mfma_f32_16x16x32_bf16 v[20:23], a[0:3], a[176:179], v[84:87]
s_add_u32 m0, s27, 0x1000
v_exp_f32 v28, v28
s_waitcnt lgkmcnt(6)
v_mfma_f32_16x16x32_bf16 v[20:23], a[4:7], a[180:183], v[20:23]
buffer_load_dwordx4 v3, s[48:51], s7 offen offset:0 sc1 lds
s_waitcnt lgkmcnt(5)
v_mfma_f32_16x16x32_bf16 v[20:23], a[8:11], a[184:187], v[20:23]
v_exp_f32 v29, v29
s_waitcnt lgkmcnt(4)
v_mfma_f32_16x16x32_bf16 v[20:23], a[12:15], a[188:191], v[20:23]
ds_read_b128 a[32:35], v1 offset:16384
v_cvt_pk_bf16_f32 v56, v24, v25
v_cvt_pk_bf16_f32 v57, v26, v27
v_mfma_f32_16x16x32_bf16 v[24:27], a[0:3], a[192:195], v[88:91]
v_exp_f32 v30, v30
v_mfma_f32_16x16x32_bf16 v[24:27], a[4:7], a[196:199], v[24:27]
ds_read_b128 a[36:39], v1 offset:17408
v_cvt_pk_bf16_f32 v60, v28, v29
v_mfma_f32_16x16x32_bf16 v[24:27], a[8:11], a[200:203], v[24:27]
buffer_load_dwordx4 v3, s[48:51], s7 offen offset:1024 sc1 lds
v_mfma_f32_16x16x32_bf16 v[24:27], a[12:15], a[204:207], v[24:27]
ds_read_b128 a[40:43], v1 offset:18432
v_exp_f32 v31, v31
s_nop 0
v_cvt_pk_bf16_f32 v61, v30, v31
v_mfma_f32_16x16x32_bf16 v[28:31], a[0:3], a[208:211], v[92:95]
v_exp_f32 v32, v32
v_mfma_f32_16x16x32_bf16 v[28:31], a[4:7], a[212:215], v[28:31]
ds_read_b128 a[44:47], v1 offset:19456
v_exp_f32 v33, v33
v_mfma_f32_16x16x32_bf16 v[28:31], a[8:11], a[216:219], v[28:31]
buffer_load_dwordx4 v3, s[48:51], s7 offen offset:2048 sc1 lds
v_mfma_f32_16x16x32_bf16 v[28:31], a[12:15], a[220:223], v[28:31]
s_mov_b32 s9, 0x400000
v_exp_f32 v34, v34
v_exp_f32 v35, v35
v_exp_f32 v36, v36
v_exp_f32 v37, v37
v_exp_f32 v38, v38
v_exp_f32 v39, v39
v_cvt_pk_bf16_f32 v54, v36, v37
v_cvt_pk_bf16_f32 v55, v38, v39
s_waitcnt lgkmcnt(7)
v_mfma_f32_16x16x32_bf16 v[36:39], a[16:19], a[176:179], v[84:87]
ds_read_b128 a[48:51], v1 offset:20480
v_cvt_pk_bf16_f32 v50, v32, v33
s_waitcnt lgkmcnt(7)
v_mfma_f32_16x16x32_bf16 v[36:39], a[20:23], a[180:183], v[36:39]
ds_read_b128 a[52:55], v1 offset:21504
v_cvt_pk_bf16_f32 v51, v34, v35
s_waitcnt lgkmcnt(7)
v_mfma_f32_16x16x32_bf16 v[36:39], a[24:27], a[184:187], v[36:39]
buffer_load_dword a244, v8, s[64:67], s9 offen
s_waitcnt lgkmcnt(6)
v_mfma_f32_16x16x32_bf16 v[36:39], a[28:31], a[188:191], v[36:39]
ds_read_b128 a[56:59], v1 offset:22528
v_exp_f32 v40, v40
v_exp_f32 v41, v41
v_exp_f32 v42, v42
v_exp_f32 v43, v43
v_cvt_pk_bf16_f32 v58, v40, v41
v_cvt_pk_bf16_f32 v59, v42, v43
v_mfma_f32_16x16x32_bf16 v[40:43], a[16:19], a[192:195], v[88:91]
buffer_load_dwordx4 v3, s[48:51], s7 offen offset:3072 sc1 lds
v_mfma_f32_16x16x32_bf16 v[40:43], a[20:23], a[196:199], v[40:43]
ds_read_b128 a[60:63], v1 offset:23552
v_xor_b32 v1, 0x8000, v1
v_mfma_f32_16x16x32_bf16 v[40:43], a[24:27], a[200:203], v[40:43]
s_add_u32 s32, s32, 0x8000
v_exp_f32 v44, v44
v_mfma_f32_16x16x32_bf16 v[40:43], a[28:31], a[204:207], v[40:43]
s_add_u32 s7, s7, 0x8000
v_exp_f32 v45, v45
v_exp_f32 v46, v46
v_exp_f32 v47, v47
v_cvt_pk_bf16_f32 v62, v44, v45
v_cvt_pk_bf16_f32 v63, v46, v47
v_mfma_f32_16x16x32_bf16 v[44:47], a[16:19], a[208:211], v[92:95]
s_xor_b32 s27, s27, 0x38000
v_exp_f32 v20, v20
v_mfma_f32_16x16x32_bf16 v[44:47], a[20:23], a[212:215], v[44:47]
v_exp_f32 v21, v21
v_mfma_f32_16x16x32_bf16 v[44:47], a[24:27], a[216:219], v[44:47]
s_waitcnt vmcnt(19) lgkmcnt(0)
v_exp_f32 v22, v22
v_mfma_f32_16x16x32_bf16 v[44:47], a[28:31], a[220:223], v[44:47]
s_barrier
v_cvt_pk_bf16_f32 v68, v20, v21
v_exp_f32 v23, v23
v_exp_f32 v24, v24
v_exp_f32 v25, v25
v_exp_f32 v26, v26
v_exp_f32 v27, v27
v_cvt_pk_bf16_f32 v69, v22, v23
s_branch L_att_l1_0
L_att_nl0_1:
v_mfma_f32_16x16x32_bf16 v[16:19], a[0:3], a[160:163], v[80:83]
v_mfma_f32_16x16x32_bf16 v[16:19], a[4:7], a[164:167], v[16:19]
s_add_u32 m0, s27, 0x0
v_mfma_f32_16x16x32_bf16 v[16:19], a[8:11], a[168:171], v[16:19]
buffer_load_dwordx4 v3, s[48:51], s32 offen offset:0 sc1 lds
v_mfma_f32_16x16x32_bf16 v[16:19], a[12:15], a[172:175], v[16:19]
v_mfma_f32_16x16x32_bf16 v[20:23], a[0:3], a[176:179], v[84:87]
v_mfma_f32_16x16x32_bf16 v[20:23], a[4:7], a[180:183], v[20:23]
v_mfma_f32_16x16x32_bf16 v[20:23], a[8:11], a[184:187], v[20:23]
s_mov_b32 s9, 0x0
v_mfma_f32_16x16x32_bf16 v[20:23], a[12:15], a[188:191], v[20:23]
buffer_load_dword a244, v8, s[72:75], s9 offen
v_mfma_f32_16x16x32_bf16 v[24:27], a[0:3], a[192:195], v[88:91]
s_nop 0
v_exp_f32 v16, v16
v_mfma_f32_16x16x32_bf16 v[24:27], a[4:7], a[196:199], v[24:27]
v_exp_f32 v17, v17
v_mfma_f32_16x16x32_bf16 v[24:27], a[8:11], a[200:203], v[24:27]
v_exp_f32 v18, v18
v_mfma_f32_16x16x32_bf16 v[24:27], a[12:15], a[204:207], v[24:27]
v_exp_f32 v19, v19
v_mfma_f32_16x16x32_bf16 v[28:31], a[0:3], a[208:211], v[92:95]
buffer_load_dwordx4 v3, s[48:51], s32 offen offset:1024 sc1 lds
v_mfma_f32_16x16x32_bf16 v[28:31], a[4:7], a[212:215], v[28:31]
v_exp_f32 v20, v20
v_mfma_f32_16x16x32_bf16 v[28:31], a[8:11], a[216:219], v[28:31]
v_exp_f32 v21, v21
v_mfma_f32_16x16x32_bf16 v[28:31], a[12:15], a[220:223], v[28:31]
v_cvt_pk_bf16_f32 v48, v16, v17
v_cvt_pk_bf16_f32 v49, v18, v19
v_mfma_f32_16x16x32_bf16 v[32:35], a[16:19], a[160:163], v[80:83]
v_exp_f32 v22, v22
v_mfma_f32_16x16x32_bf16 v[32:35], a[20:23], a[164:167], v[32:35]
buffer_load_dwordx4 v3, s[48:51], s32 offen offset:2048 sc1 lds
v_mfma_f32_16x16x32_bf16 v[32:35], a[24:27], a[168:171], v[32:35]
v_cvt_pk_bf16_f32 v52, v20, v21
v_mfma_f32_16x16x32_bf16 v[32:35], a[28:31], a[172:175], v[32:35]
v_mfma_f32_16x16x32_bf16 v[36:39], a[16:19], a[176:179], v[84:87]
v_exp_f32 v23, v23
v_mfma_f32_16x16x32_bf16 v[36:39], a[20:23], a[180:183], v[36:39]
v_cvt_pk_bf16_f32 v53, v22, v23
v_mfma_f32_16x16x32_bf16 v[36:39], a[24:27], a[184:187], v[36:39]
buffer_load_dwordx4 v3, s[48:51], s32 offen offset:3072 sc1 lds
v_mfma_f32_16x16x32_bf16 v[36:39], a[28:31], a[188:191], v[36:39]
v_exp_f32 v24, v24
v_mfma_f32_16x16x32_bf16 v[40:43], a[16:19], a[192:195], v[88:91]
v_mfma_f32_16x16x32_bf16 v[40:43], a[20:23], a[196:199], v[40:43]
v_exp_f32 v25, v25
v_mfma_f32_16x16x32_bf16 v[40:43], a[24:27], a[200:203], v[40:43]
s_mov_b32 s9, 0x0
v_mfma_f32_16x16x32_bf16 v[40:43], a[28:31], a[204:207], v[40:43]
buffer_load_dword a244, v8, s[64:67], s9 offen
v_mfma_f32_16x16x32_bf16 v[44:47], a[16:19], a[208:211], v[92:95]
v_exp_f32 v26, v26
v_mfma_f32_16x16x32_bf16 v[44:47], a[20:23], a[212:215], v[44:47]
v_mfma_f32_16x16x32_bf16 v[44:47], a[24:27], a[216:219], v[44:47]
v_exp_f32 v27, v27
v_mfma_f32_16x16x32_bf16 v[44:47], a[28:31], a[220:223], v[44:47]
s_waitcnt lgkmcnt(0)
ds_read_b128 a[0:3], v1 offset:24576
ds_read_b128 a[4:7], v1 offset:25600
ds_read_b128 a[8:11], v1 offset:26624
ds_read_b128 a[12:15], v1 offset:27648
ds_read_b128 a[16:19], v1 offset:28672
ds_read_b128 a[20:23], v1 offset:29696
ds_read_b128 a[24:27], v1 offset:30720
ds_read_b128 a[28:31], v1 offset:31744
s_waitcnt lgkmcnt(7)
v_mfma_f32_16x16x32_bf16 v[16:19], a[0:3], a[160:163], v[96:99]
ds_read_b128 a[32:35], v1 offset:16384
v_cvt_pk_bf16_f32 v56, v24, v25
s_waitcnt lgkmcnt(7)
v_mfma_f32_16x16x32_bf16 v[16:19], a[4:7], a[164:167], v[16:19]
s_add_u32 m0, s27, 0x1000
v_exp_f32 v28, v28
s_waitcnt lgkmcnt(6)
v_mfma_f32_16x16x32_bf16 v[16:19], a[8:11], a[168:171], v[16:19]
buffer_load_dwordx4 v3, s[48:51], s7 offen offset:0 sc1 lds
s_waitcnt lgkmcnt(5)
v_mfma_f32_16x16x32_bf16 v[16:19], a[12:15], a[172:175], v[16:19]
ds_read_b128 a[36:39], v1 offset:17408
v_cvt_pk_bf16_f32 v57, v26, v27
v_mfma_f32_16x16x32_bf16 v[20:23], a[0:3], a[176:179], v[84:87]
v_exp_f32 v29, v29
v_mfma_f32_16x16x32_bf16 v[20:23], a[4:7], a[180:183], v[20:23]
v_exp_f32 v30, v30
v_mfma_f32_16x16x32_bf16 v[20:23], a[8:11], a[184:187], v[20:23]
ds_read_b128 a[40:43], v1 offset:18432
v_cvt_pk_bf16_f32 v60, v28, v29
v_mfma_f32_16x16x32_bf16 v[20:23], a[12:15], a[188:191], v[20:23]
buffer_load_dwordx4 v3, s[48:51], s7 offen offset:1024 sc1 lds
v_mfma_f32_16x16x32_bf16 v[24:27], a[0:3], a[192:195], v[88:91]
v_exp_f32 v31, v31
v_mfma_f32_16x16x32_bf16 v[24:27], a[4:7], a[196:199], v[24:27]
ds_read_b128 a[44:47], v1 offset:19456
v_cvt_pk_bf16_f32 v61, v30, v31
v_mfma_f32_16x16x32_bf16 v[24:27], a[8:11], a[200:203], v[24:27]
v_exp_f32 v32, v32
v_mfma_f32_16x16x32_bf16 v[24:27], a[12:15], a[204:207], v[24:27]
v_exp_f32 v33, v33
v_mfma_f32_16x16x32_bf16 v[28:31], a[0:3], a[208:211], v[92:95]
v_exp_f32 v34, v34
v_mfma_f32_16x16x32_bf16 v[28:31], a[4:7], a[212:215], v[28:31]
buffer_load_dwordx4 v3, s[48:51], s7 offen offset:2048 sc1 lds
v_mfma_f32_16x16x32_bf16 v[28:31], a[8:11], a[216:219], v[28:31]
ds_read_b128 a[48:51], v1 offset:20480
v_cvt_pk_bf16_f32 v50, v32, v33
v_mfma_f32_16x16x32_bf16 v[28:31], a[12:15], a[220:223], v[28:31]
v_exp_f32 v35, v35
s_nop 0
v_cvt_pk_bf16_f32 v51, v34, v35
s_waitcnt lgkmcnt(8)
v_mfma_f32_16x16x32_bf16 v[32:35], a[16:19], a[160:163], v[100:103]
ds_read_b128 a[52:55], v1 offset:21504
v_exp_f32 v36, v36
s_waitcnt lgkmcnt(8)
v_mfma_f32_16x16x32_bf16 v[32:35], a[20:23], a[164:167], v[32:35]
s_mov_b32 s9, 0x400000
v_exp_f32 v37, v37
s_waitcnt lgkmcnt(7)
v_mfma_f32_16x16x32_bf16 v[32:35], a[24:27], a[168:171], v[32:35]
buffer_load_dword a244, v8, s[64:67], s9 offen
s_waitcnt lgkmcnt(6)
v_mfma_f32_16x16x32_bf16 v[32:35], a[28:31], a[172:175], v[32:35]
ds_read_b128 a[56:59], v1 offset:22528
v_cvt_pk_bf16_f32 v54, v36, v37
v_exp_f32 v38, v38
v_exp_f32 v39, v39
s_nop 0
v_cvt_pk_bf16_f32 v55, v38, v39
v_mfma_f32_16x16x32_bf16 v[36:39], a[16:19], a[176:179], v[84:87]
v_exp_f32 v40, v40
v_mfma_f32_16x16x32_bf16 v[36:39], a[20:23], a[180:183], v[36:39]
v_exp_f32 v41, v41
v_mfma_f32_16x16x32_bf16 v[36:39], a[24:27], a[184:187], v[36:39]
ds_read_b128 a[60:63], v1 offset:23552
v_xor_b32 v1, 0x8000, v1
v_mfma_f32_16x16x32_bf16 v[36:39], a[28:31], a[188:191], v[36:39]
buffer_load_dwordx4 v3, s[48:51], s7 offen offset:3072 sc1 lds
v_exp_f32 v42, v42
v_exp_f32 v43, v43
v_cvt_pk_bf16_f32 v58, v40, v41
v_cvt_pk_bf16_f32 v59, v42, v43
v_mfma_f32_16x16x32_bf16 v[40:43], a[16:19], a[192:195], v[88:91]
s_add_u32 s32, s32, 0x8000
v_exp_f32 v44, v44
v_mfma_f32_16x16x32_bf16 v[40:43], a[20:23], a[196:199], v[40:43]
s_add_u32 s7, s7, 0x8000
v_exp_f32 v45, v45
v_mfma_f32_16x16x32_bf16 v[40:43], a[24:27], a[200:203], v[40:43]
s_xor_b32 s27, s27, 0x38000
v_exp_f32 v46, v46
v_mfma_f32_16x16x32_bf16 v[40:43], a[28:31], a[204:207], v[40:43]
v_exp_f32 v47, v47
v_cvt_pk_bf16_f32 v62, v44, v45
v_cvt_pk_bf16_f32 v63, v46, v47
v_mfma_f32_16x16x32_bf16 v[44:47], a[16:19], a[208:211], v[92:95]
v_exp_f32 v16, v16
v_mfma_f32_16x16x32_bf16 v[44:47], a[20:23], a[212:215], v[44:47]
v_exp_f32 v17, v17
v_mfma_f32_16x16x32_bf16 v[44:47], a[24:27], a[216:219], v[44:47]
s_waitcnt vmcnt(19) lgkmcnt(0)
v_exp_f32 v18, v18
v_mfma_f32_16x16x32_bf16 v[44:47], a[28:31], a[220:223], v[44:47]
s_barrier
v_cvt_pk_bf16_f32 v64, v16, v17
v_exp_f32 v19, v19
v_exp_f32 v20, v20
v_exp_f32 v21, v21
v_exp_f32 v22, v22
v_exp_f32 v23, v23
v_exp_f32 v24, v24
v_exp_f32 v25, v25
v_exp_f32 v26, v26
v_exp_f32 v27, v27
v_cvt_pk_bf16_f32 v65, v18, v19
v_cvt_pk_bf16_f32 v68, v20, v21
v_cvt_pk_bf16_f32 v69, v22, v23
s_branch L_att_l1_1
L_att_seven:
v_mfma_f32_16x16x32_bf16 v[192:195], a[32:35], v[56:59], v[192:195]
v_exp_f32 v30, v30
v_mfma_f32_16x16x32_bf16 v[224:227], a[32:35], v[60:63], v[224:227]
ds_read_b128 a[0:3], v1 offset:8192
v_cvt_pk_bf16_f32 v72, v24, v25
v_mfma_f32_16x16x32_bf16 v[228:231], a[36:39], v[60:63], v[228:231]
ds_read_b128 a[4:7], v1 offset:9216
v_cvt_pk_bf16_f32 v73, v26, v27
v_mfma_f32_16x16x32_bf16 v[196:199], a[36:39], v[56:59], v[196:199]
s_add_u32 m0, s27, 0x0
v_exp_f32 v31, v31
v_mfma_f32_16x16x32_bf16 v[200:203], a[40:43], v[56:59], v[200:203]
ds_read_b128 a[8:11], v1 offset:10240
v_cvt_pk_bf16_f32 v76, v28, v29
v_mfma_f32_16x16x32_bf16 v[232:235], a[40:43], v[60:63], v[232:235]
buffer_load_dwordx4 v3, s[48:51], s32 offen offset:0 sc1 lds
v_mfma_f32_16x16x32_bf16 v[236:239], a[44:47], v[60:63], v[236:239]
v_exp_f32 v40, v40
v_mfma_f32_16x16x32_bf16 v[204:207], a[44:47], v[56:59], v[204:207]
ds_read_b128 a[12:15], v1 offset:11264
v_cvt_pk_bf16_f32 v77, v30, v31
v_mfma_f32_16x16x32_bf16 v[208:211], a[48:51], v[56:59], v[208:211]
ds_read_b128 a[16:19], v1 offset:12288
v_mfma_f32_16x16x32_bf16 v[240:243], a[48:51], v[60:63], v[240:243]
buffer_load_dwordx4 v3, s[48:51], s32 offen offset:1024 sc1 lds
v_mfma_f32_16x16x32_bf16 v[244:247], a[52:55], v[60:63], v[244:247]
ds_read_b128 a[20:23], v1 offset:13312
v_mfma_f32_16x16x32_bf16 v[212:215], a[52:55], v[56:59], v[212:215]
ds_read_b128 a[24:27], v1 offset:14336
v_mfma_f32_16x16x32_bf16 v[216:219], a[56:59], v[56:59], v[216:219]
ds_read_b128 a[28:31], v1 offset:15360
v_mfma_f32_16x16x32_bf16 v[248:251], a[56:59], v[60:63], v[248:251]
ds_read_b128 a[32:35], v1 offset:0
v_exp_f32 v41, v41
v_mfma_f32_16x16x32_bf16 v[252:255], a[60:63], v[60:63], v[252:255]
v_exp_f32 v42, v42
v_mfma_f32_16x16x32_bf16 v[220:223], a[60:63], v[56:59], v[220:223]
s_waitcnt lgkmcnt(5)
v_exp_f32 v43, v43
v_smfmac_f32_16x16x64_bf16 a[228:231], a[232:235], v[56:63], v9
ds_read_b128 a[36:39], v1 offset:1024
v_cvt_pk_bf16_f32 v74, v40, v41
v_mfma_f32_16x16x32_bf16 v[24:27], a[0:3], a[192:195], v[88:91]
ds_read_b128 a[40:43], v1 offset:2048
v_exp_f32 v44, v44
v_mfma_f32_16x16x32_bf16 v[24:27], a[4:7], a[196:199], v[24:27]
buffer_load_dwordx4 v3, s[48:51], s32 offen offset:2048 sc1 lds
v_mfma_f32_16x16x32_bf16 v[24:27], a[8:11], a[200:203], v[24:27]
v_exp_f32 v45, v45
v_mfma_f32_16x16x32_bf16 v[24:27], a[12:15], a[204:207], v[24:27]
ds_read_b128 a[44:47], v1 offset:3072
v_cvt_pk_bf16_f32 v75, v42, v43
v_mfma_f32_16x16x32_bf16 v[28:31], a[0:3], a[208:211], v[92:95]
ds_read_b128 a[48:51], v1 offset:4096
v_exp_f32 v46, v46
v_mfma_f32_16x16x32_bf16 v[28:31], a[4:7], a[212:215], v[28:31]
s_waitcnt lgkmcnt(5)
v_exp_f32 v47, v47
v_mfma_f32_16x16x32_bf16 v[28:31], a[8:11], a[216:219], v[28:31]
ds_read_b128 a[52:55], v1 offset:5120
v_cvt_pk_bf16_f32 v78, v44, v45
v_mfma_f32_16x16x32_bf16 v[28:31], a[12:15], a[220:223], v[28:31]
buffer_load_dwordx4 v3, s[48:51], s32 offen offset:3072 sc1 lds
v_mfma_f32_16x16x32_bf16 v[40:43], a[16:19], a[192:195], v[88:91]
ds_read_b128 a[56:59], v1 offset:6144
s_add_u32 s32, s32, 0x8000
v_mfma_f32_16x16x32_bf16 v[40:43], a[20:23], a[196:199], v[40:43]
ds_read_b128 a[60:63], v1 offset:7168
v_cvt_pk_bf16_f32 v79, v46, v47
v_mfma_f32_16x16x32_bf16 v[40:43], a[24:27], a[200:203], v[40:43]
v_exp_f32 v24, v24
v_mfma_f32_16x16x32_bf16 v[40:43], a[28:31], a[204:207], v[40:43]
v_exp_f32 v25, v25
v_mfma_f32_16x16x32_bf16 v[44:47], a[16:19], a[208:211], v[92:95]
v_exp_f32 v26, v26
v_mfma_f32_16x16x32_bf16 v[44:47], a[20:23], a[212:215], v[44:47]
v_exp_f32 v27, v27
v_mfma_f32_16x16x32_bf16 v[44:47], a[24:27], a[216:219], v[44:47]
v_exp_f32 v28, v28
v_mfma_f32_16x16x32_bf16 v[44:47], a[28:31], a[220:223], v[44:47]
s_waitcnt lgkmcnt(0)
v_exp_f32 v29, v29
v_mfma_f32_16x16x32_bf16 v[192:195], a[32:35], v[72:75], v[192:195]
s_add_u32 m0, s27, 0x1000
v_exp_f32 v30, v30
v_mfma_f32_16x16x32_bf16 v[224:227], a[32:35], v[76:79], v[224:227]
buffer_load_dwordx4 v3, s[48:51], s7 offen offset:0 sc1 lds
v_mfma_f32_16x16x32_bf16 v[228:231], a[36:39], v[76:79], v[228:231]
v_exp_f32 v31, v31
v_mfma_f32_16x16x32_bf16 v[196:199], a[36:39], v[72:75], v[196:199]
ds_read_b128 a[0:3], v1 offset:24576
v_cvt_pk_bf16_f32 v56, v24, v25
v_mfma_f32_16x16x32_bf16 v[200:203], a[40:43], v[72:75], v[200:203]
ds_read_b128 a[4:7], v1 offset:25600
v_cvt_pk_bf16_f32 v57, v26, v27
v_mfma_f32_16x16x32_bf16 v[232:235], a[40:43], v[76:79], v[232:235]
v_exp_f32 v40, v40
v_mfma_f32_16x16x32_bf16 v[236:239], a[44:47], v[76:79], v[236:239]
ds_read_b128 a[8:11], v1 offset:26624
v_cvt_pk_bf16_f32 v60, v28, v29
v_mfma_f32_16x16x32_bf16 v[204:207], a[44:47], v[72:75], v[204:207]
v_exp_f32 v41, v41
v_mfma_f32_16x16x32_bf16 v[208:211], a[48:51], v[72:75], v[208:211]
ds_read_b128 a[12:15], v1 offset:27648
v_cvt_pk_bf16_f32 v61, v30, v31
v_mfma_f32_16x16x32_bf16 v[240:243], a[48:51], v[76:79], v[240:243]
ds_read_b128 a[16:19], v1 offset:28672
v_cvt_pk_bf16_f32 v58, v40, v41
v_mfma_f32_16x16x32_bf16 v[244:247], a[52:55], v[76:79], v[244:247]
v_exp_f32 v42, v42
v_mfma_f32_16x16x32_bf16 v[212:215], a[52:55], v[72:75], v[212:215]
buffer_load_dwordx4 v3, s[48:51], s7 offen offset:1024 sc1 lds
v_mfma_f32_16x16x32_bf16 v[216:219], a[56:59], v[72:75], v[216:219]
ds_read_b128 a[20:23], v1 offset:29696
v_mfma_f32_16x16x32_bf16 v[248:251], a[56:59], v[76:79], v[248:251]
ds_read_b128 a[24:27], v1 offset:30720
v_mfma_f32_16x16x32_bf16 v[252:255], a[60:63], v[76:79], v[252:255]
ds_read_b128 a[28:31], v1 offset:31744
v_mfma_f32_16x16x32_bf16 v[220:223], a[60:63], v[72:75], v[220:223]
s_waitcnt lgkmcnt(4)
v_exp_f32 v43, v43
v_smfmac_f32_16x16x64_bf16 a[228:231], a[232:235], v[72:79], v9
ds_read_b128 a[32:35], v1 offset:16384
v_cvt_pk_bf16_f32 v59, v42, v43
v_mfma_f32_16x16x32_bf16 v[24:27], a[0:3], a[192:195], v[88:91]
ds_read_b128 a[36:39], v1 offset:17408
v_mfma_f32_16x16x32_bf16 v[24:27], a[4:7], a[196:199], v[24:27]
buffer_load_dwordx4 v3, s[48:51], s7 offen offset:2048 sc1 lds
v_mfma_f32_16x16x32_bf16 v[24:27], a[8:11], a[200:203], v[24:27]
ds_read_b128 a[40:43], v1 offset:18432
v_exp_f32 v44, v44
v_mfma_f32_16x16x32_bf16 v[24:27], a[12:15], a[204:207], v[24:27]
ds_read_b128 a[44:47], v1 offset:19456
v_exp_f32 v45, v45
v_mfma_f32_16x16x32_bf16 v[28:31], a[0:3], a[208:211], v[92:95]
ds_read_b128 a[48:51], v1 offset:20480
v_exp_f32 v46, v46
v_mfma_f32_16x16x32_bf16 v[28:31], a[4:7], a[212:215], v[28:31]
s_waitcnt lgkmcnt(5)
v_exp_f32 v47, v47
v_mfma_f32_16x16x32_bf16 v[28:31], a[8:11], a[216:219], v[28:31]
ds_read_b128 a[52:55], v1 offset:21504
v_cvt_pk_bf16_f32 v62, v44, v45
v_mfma_f32_16x16x32_bf16 v[28:31], a[12:15], a[220:223], v[28:31]
ds_read_b128 a[56:59], v1 offset:22528
v_cvt_pk_bf16_f32 v63, v46, v47
v_mfma_f32_16x16x32_bf16 v[40:43], a[16:19], a[192:195], v[88:91]
ds_read_b128 a[60:63], v1 offset:23552
v_xor_b32 v1, 0x8000, v1
v_mfma_f32_16x16x32_bf16 v[40:43], a[20:23], a[196:199], v[40:43]
buffer_load_dwordx4 v3, s[48:51], s7 offen offset:3072 sc1 lds
v_mfma_f32_16x16x32_bf16 v[40:43], a[24:27], a[200:203], v[40:43]
s_add_u32 s7, s7, 0x8000
v_exp_f32 v24, v24
v_mfma_f32_16x16x32_bf16 v[40:43], a[28:31], a[204:207], v[40:43]
s_xor_b32 s27, s27, 0x38000
v_exp_f32 v25, v25
v_mfma_f32_16x16x32_bf16 v[44:47], a[16:19], a[208:211], v[92:95]
v_exp_f32 v26, v26
v_mfma_f32_16x16x32_bf16 v[44:47], a[20:23], a[212:215], v[44:47]
v_exp_f32 v27, v27
v_mfma_f32_16x16x32_bf16 v[44:47], a[24:27], a[216:219], v[44:47]
s_waitcnt vmcnt(16) lgkmcnt(0)
v_exp_f32 v28, v28
v_mfma_f32_16x16x32_bf16 v[44:47], a[28:31], a[220:223], v[44:47]
s_barrier
v_exp_f32 v29, v29
L_att_sodd:
v_mfma_f32_16x16x32_bf16 v[192:195], a[32:35], v[56:59], v[192:195]
v_exp_f32 v30, v30
v_mfma_f32_16x16x32_bf16 v[224:227], a[32:35], v[60:63], v[224:227]
ds_read_b128 a[0:3], v2 offset:8192
v_cvt_pk_bf16_f32 v72, v24, v25
v_mfma_f32_16x16x32_bf16 v[228:231], a[36:39], v[60:63], v[228:231]
ds_read_b128 a[4:7], v2 offset:9216
v_cvt_pk_bf16_f32 v73, v26, v27
v_mfma_f32_16x16x32_bf16 v[196:199], a[36:39], v[56:59], v[196:199]
s_add_u32 m0, s19, 0x0
v_exp_f32 v31, v31
v_mfma_f32_16x16x32_bf16 v[200:203], a[40:43], v[56:59], v[200:203]
ds_read_b128 a[8:11], v2 offset:10240
v_cvt_pk_bf16_f32 v76, v28, v29
v_mfma_f32_16x16x32_bf16 v[232:235], a[40:43], v[60:63], v[232:235]
buffer_load_dwordx4 v3, s[48:51], s32 offen offset:0 sc1 lds
v_mfma_f32_16x16x32_bf16 v[236:239], a[44:47], v[60:63], v[236:239]
v_exp_f32 v40, v40
v_mfma_f32_16x16x32_bf16 v[204:207], a[44:47], v[56:59], v[204:207]
ds_read_b128 a[12:15], v2 offset:11264
v_cvt_pk_bf16_f32 v77, v30, v31
v_mfma_f32_16x16x32_bf16 v[208:211], a[48:51], v[56:59], v[208:211]
ds_read_b128 a[16:19], v2 offset:12288
v_mfma_f32_16x16x32_bf16 v[240:243], a[48:51], v[60:63], v[240:243]
buffer_load_dwordx4 v3, s[48:51], s32 offen offset:1024 sc1 lds
v_mfma_f32_16x16x32_bf16 v[244:247], a[52:55], v[60:63], v[244:247]
ds_read_b128 a[20:23], v2 offset:13312
v_mfma_f32_16x16x32_bf16 v[212:215], a[52:55], v[56:59], v[212:215]
ds_read_b128 a[24:27], v2 offset:14336
v_mfma_f32_16x16x32_bf16 v[216:219], a[56:59], v[56:59], v[216:219]
ds_read_b128 a[28:31], v2 offset:15360
v_mfma_f32_16x16x32_bf16 v[248:251], a[56:59], v[60:63], v[248:251]
ds_read_b128 a[32:35], v2 offset:0
v_exp_f32 v41, v41
v_mfma_f32_16x16x32_bf16 v[252:255], a[60:63], v[60:63], v[252:255]
v_exp_f32 v42, v42
v_mfma_f32_16x16x32_bf16 v[220:223], a[60:63], v[56:59], v[220:223]
s_waitcnt lgkmcnt(5)
v_exp_f32 v43, v43
v_smfmac_f32_16x16x64_bf16 a[228:231], a[232:235], v[56:63], v9
ds_read_b128 a[36:39], v2 offset:1024
v_cvt_pk_bf16_f32 v74, v40, v41
v_mfma_f32_16x16x32_bf16 v[24:27], a[0:3], a[192:195], v[88:91]
ds_read_b128 a[40:43], v2 offset:2048
v_exp_f32 v44, v44
v_mfma_f32_16x16x32_bf16 v[24:27], a[4:7], a[196:199], v[24:27]
buffer_load_dwordx4 v3, s[48:51], s32 offen offset:2048 sc1 lds
v_mfma_f32_16x16x32_bf16 v[24:27], a[8:11], a[200:203], v[24:27]
v_exp_f32 v45, v45
v_mfma_f32_16x16x32_bf16 v[24:27], a[12:15], a[204:207], v[24:27]
ds_read_b128 a[44:47], v2 offset:3072
v_cvt_pk_bf16_f32 v75, v42, v43
v_mfma_f32_16x16x32_bf16 v[28:31], a[0:3], a[208:211], v[92:95]
ds_read_b128 a[48:51], v2 offset:4096
v_exp_f32 v46, v46
v_mfma_f32_16x16x32_bf16 v[28:31], a[4:7], a[212:215], v[28:31]
s_waitcnt lgkmcnt(5)
v_exp_f32 v47, v47
v_mfma_f32_16x16x32_bf16 v[28:31], a[8:11], a[216:219], v[28:31]
ds_read_b128 a[52:55], v2 offset:5120
v_cvt_pk_bf16_f32 v78, v44, v45
v_mfma_f32_16x16x32_bf16 v[28:31], a[12:15], a[220:223], v[28:31]
buffer_load_dwordx4 v3, s[48:51], s32 offen offset:3072 sc1 lds
v_mfma_f32_16x16x32_bf16 v[40:43], a[16:19], a[192:195], v[88:91]
ds_read_b128 a[56:59], v2 offset:6144
s_add_u32 s32, s32, 0x8000
v_mfma_f32_16x16x32_bf16 v[40:43], a[20:23], a[196:199], v[40:43]
ds_read_b128 a[60:63], v2 offset:7168
v_cvt_pk_bf16_f32 v79, v46, v47
v_mfma_f32_16x16x32_bf16 v[40:43], a[24:27], a[200:203], v[40:43]
v_exp_f32 v24, v24
v_mfma_f32_16x16x32_bf16 v[40:43], a[28:31], a[204:207], v[40:43]
v_exp_f32 v25, v25
v_mfma_f32_16x16x32_bf16 v[44:47], a[16:19], a[208:211], v[92:95]
v_exp_f32 v26, v26
v_mfma_f32_16x16x32_bf16 v[44:47], a[20:23], a[212:215], v[44:47]
v_exp_f32 v27, v27
v_mfma_f32_16x16x32_bf16 v[44:47], a[24:27], a[216:219], v[44:47]
v_exp_f32 v28, v28
v_mfma_f32_16x16x32_bf16 v[44:47], a[28:31], a[220:223], v[44:47]
s_waitcnt lgkmcnt(0)
v_exp_f32 v29, v29
v_mfma_f32_16x16x32_bf16 v[192:195], a[32:35], v[72:75], v[192:195]
v_exp_f32 v30, v30
v_mfma_f32_16x16x32_bf16 v[224:227], a[32:35], v[76:79], v[224:227]
v_exp_f32 v31, v31
v_mfma_f32_16x16x32_bf16 v[228:231], a[36:39], v[76:79], v[228:231]
v_exp_f32 v40, v40
v_mfma_f32_16x16x32_bf16 v[196:199], a[36:39], v[72:75], v[196:199]
s_add_u32 m0, s19, 0x1000
v_exp_f32 v41, v41
v_mfma_f32_16x16x32_bf16 v[200:203], a[40:43], v[72:75], v[200:203]
ds_read_b128 a[0:3], v2 offset:24576
v_cvt_pk_bf16_f32 v56, v24, v25
v_mfma_f32_16x16x32_bf16 v[232:235], a[40:43], v[76:79], v[232:235]
buffer_load_dwordx4 v3, s[48:51], s7 offen offset:0 sc1 lds
v_mfma_f32_16x16x32_bf16 v[236:239], a[44:47], v[76:79], v[236:239]
ds_read_b128 a[4:7], v2 offset:25600
v_cvt_pk_bf16_f32 v57, v26, v27
v_mfma_f32_16x16x32_bf16 v[204:207], a[44:47], v[72:75], v[204:207]
ds_read_b128 a[8:11], v2 offset:26624
v_cvt_pk_bf16_f32 v60, v28, v29
v_mfma_f32_16x16x32_bf16 v[208:211], a[48:51], v[72:75], v[208:211]
ds_read_b128 a[12:15], v2 offset:27648
v_cvt_pk_bf16_f32 v61, v30, v31
v_mfma_f32_16x16x32_bf16 v[240:243], a[48:51], v[76:79], v[240:243]
ds_read_b128 a[16:19], v2 offset:28672
v_cvt_pk_bf16_f32 v58, v40, v41
v_mfma_f32_16x16x32_bf16 v[244:247], a[52:55], v[76:79], v[244:247]
buffer_load_dwordx4 v3, s[48:51], s7 offen offset:1024 sc1 lds
v_mfma_f32_16x16x32_bf16 v[212:215], a[52:55], v[72:75], v[212:215]
ds_read_b128 a[20:23], v2 offset:29696
v_mfma_f32_16x16x32_bf16 v[216:219], a[56:59], v[72:75], v[216:219]
v_exp_f32 v42, v42
v_mfma_f32_16x16x32_bf16 v[248:251], a[56:59], v[76:79], v[248:251]
ds_read_b128 a[24:27], v2 offset:30720
v_mfma_f32_16x16x32_bf16 v[252:255], a[60:63], v[76:79], v[252:255]
ds_read_b128 a[28:31], v2 offset:31744
v_exp_f32 v43, v43
v_mfma_f32_16x16x32_bf16 v[220:223], a[60:63], v[72:75], v[220:223]
ds_read_b128 a[32:35], v2 offset:16384
v_cvt_pk_bf16_f32 v59, v42, v43
v_smfmac_f32_16x16x64_bf16 a[228:231], a[232:235], v[72:79], v9
ds_read_b128 a[36:39], v2 offset:17408
s_waitcnt lgkmcnt(6)
v_mfma_f32_16x16x32_bf16 v[24:27], a[0:3], a[192:195], v[88:91]
buffer_load_dwordx4 v3, s[48:51], s7 offen offset:2048 sc1 lds
v_mfma_f32_16x16x32_bf16 v[24:27], a[4:7], a[196:199], v[24:27]
ds_read_b128 a[40:43], v2 offset:18432
v_exp_f32 v44, v44
v_mfma_f32_16x16x32_bf16 v[24:27], a[8:11], a[200:203], v[24:27]
ds_read_b128 a[44:47], v2 offset:19456
v_exp_f32 v45, v45
v_mfma_f32_16x16x32_bf16 v[24:27], a[12:15], a[204:207], v[24:27]
ds_read_b128 a[48:51], v2 offset:20480
v_cvt_pk_bf16_f32 v62, v44, v45
v_mfma_f32_16x16x32_bf16 v[28:31], a[0:3], a[208:211], v[92:95]
v_exp_f32 v46, v46
v_mfma_f32_16x16x32_bf16 v[28:31], a[4:7], a[212:215], v[28:31]
s_waitcnt lgkmcnt(5)
v_exp_f32 v47, v47
v_mfma_f32_16x16x32_bf16 v[28:31], a[8:11], a[216:219], v[28:31]
ds_read_b128 a[52:55], v2 offset:21504
v_cvt_pk_bf16_f32 v63, v46, v47
v_mfma_f32_16x16x32_bf16 v[28:31], a[12:15], a[220:223], v[28:31]
buffer_load_dwordx4 v3, s[48:51], s7 offen offset:3072 sc1 lds
v_mfma_f32_16x16x32_bf16 v[40:43], a[16:19], a[192:195], v[88:91]
ds_read_b128 a[56:59], v2 offset:22528
s_add_u32 s7, s7, 0x8000
v_mfma_f32_16x16x32_bf16 v[40:43], a[20:23], a[196:199], v[40:43]
ds_read_b128 a[60:63], v2 offset:23552
v_xor_b32 v2, 0x38000, v2
v_mfma_f32_16x16x32_bf16 v[40:43], a[24:27], a[200:203], v[40:43]
s_xor_b32 s19, s19, 0x8000
v_exp_f32 v24, v24
v_mfma_f32_16x16x32_bf16 v[40:43], a[28:31], a[204:207], v[40:43]
s_sub_u32 s15, s15, 1
v_exp_f32 v25, v25
v_mfma_f32_16x16x32_bf16 v[44:47], a[16:19], a[208:211], v[92:95]
s_cmp_lg_u32 s15, 0
v_exp_f32 v26, v26
v_mfma_f32_16x16x32_bf16 v[44:47], a[20:23], a[212:215], v[44:47]
v_exp_f32 v27, v27
v_mfma_f32_16x16x32_bf16 v[44:47], a[24:27], a[216:219], v[44:47]
s_waitcnt vmcnt(16) lgkmcnt(0)
v_exp_f32 v28, v28
v_mfma_f32_16x16x32_bf16 v[44:47], a[28:31], a[220:223], v[44:47]
s_barrier
v_exp_f32 v29, v29
s_cbranch_scc1 L_att_seven
s_cmp_ge_u32 s4, 2
s_cbranch_scc1 L_att_sh0_1
L_att_sh0_0:
v_mfma_f32_16x16x32_bf16 v[192:195], a[32:35], v[56:59], v[192:195]
v_exp_f32 v30, v30
v_mfma_f32_16x16x32_bf16 v[224:227], a[32:35], v[60:63], v[224:227]
buffer_load_dword v14, v15, s[84:87], 0 offen offset:192 sc1
v_mfma_f32_16x16x32_bf16 v[228:231], a[36:39], v[60:63], v[228:231]
v_exp_f32 v31, v31
v_mfma_f32_16x16x32_bf16 v[196:199], a[36:39], v[56:59], v[196:199]
s_add_u32 m0, s17, 0x10000
v_exp_f32 v40, v40
v_mfma_f32_16x16x32_bf16 v[200:203], a[40:43], v[56:59], v[200:203]
ds_read_b128 a[0:3], v1 offset:8192
v_cvt_pk_bf16_f32 v72, v24, v25
v_mfma_f32_16x16x32_bf16 v[232:235], a[40:43], v[60:63], v[232:235]
ds_read_b128 a[4:7], v1 offset:9216
v_cvt_pk_bf16_f32 v73, v26, v27
v_mfma_f32_16x16x32_bf16 v[236:239], a[44:47], v[60:63], v[236:239]
buffer_load_dwordx4 v12, s[72:75], 0 offen lds
v_mfma_f32_16x16x32_bf16 v[204:207], a[44:47], v[56:59], v[204:207]
ds_read_b128 a[8:11], v1 offset:10240
v_cvt_pk_bf16_f32 v76, v28, v29
v_mfma_f32_16x16x32_bf16 v[208:211], a[48:51], v[56:59], v[208:211]
buffer_load_dwordx4 v13, s[72:75], 0 offen offset:1024 lds
v_mfma_f32_16x16x32_bf16 v[240:243], a[48:51], v[60:63], v[240:243]
ds_read_b128 a[12:15], v1 offset:11264
v_cvt_pk_bf16_f32 v77, v30, v31
v_mfma_f32_16x16x32_bf16 v[244:247], a[52:55], v[60:63], v[244:247]
buffer_load_dwordx4 v12, s[72:75], s12 offen offset:2048 lds
v_mfma_f32_16x16x32_bf16 v[212:215], a[52:55], v[56:59], v[212:215]
ds_read_b128 a[16:19], v1 offset:12288
v_exp_f32 v41, v41
v_mfma_f32_16x16x32_bf16 v[216:219], a[56:59], v[56:59], v[216:219]
ds_read_b128 a[20:23], v1 offset:13312
v_exp_f32 v42, v42
v_mfma_f32_16x16x32_bf16 v[248:251], a[56:59], v[60:63], v[248:251]
buffer_load_dwordx4 v13, s[72:75], s12 offen offset:3072 lds
v_mfma_f32_16x16x32_bf16 v[252:255], a[60:63], v[60:63], v[252:255]
ds_read_b128 a[24:27], v1 offset:14336
s_waitcnt lgkmcnt(3)
v_mfma_f32_16x16x32_bf16 v[220:223], a[60:63], v[56:59], v[220:223]
ds_read_b128 a[28:31], v1 offset:15360
v_add_u32 v12, 0x20000, v12
v_smfmac_f32_16x16x64_bf16 a[228:231], a[232:235], v[56:63], v9
s_add_u32 m0, s17, 0x14000
v_exp_f32 v43, v43
v_mfma_f32_16x16x32_bf16 v[24:27], a[0:3], a[192:195], v[112:115]
buffer_load_dwordx4 v12, s[72:75], 0 offen lds
v_mfma_f32_16x16x32_bf16 v[24:27], a[4:7], a[196:199], v[24:27]
ds_read_b128 a[32:35], v1 offset:0
v_cvt_pk_bf16_f32 v74, v40, v41
v_mfma_f32_16x16x32_bf16 v[24:27], a[8:11], a[200:203], v[24:27]
ds_read_b128 a[36:39], v1 offset:1024
v_exp_f32 v44, v44
v_mfma_f32_16x16x32_bf16 v[24:27], a[12:15], a[204:207], v[24:27]
ds_read_b128 a[40:43], v1 offset:2048
v_exp_f32 v45, v45
v_mfma_f32_16x16x32_bf16 v[28:31], a[0:3], a[208:211], v[92:95]
ds_read_b128 a[44:47], v1 offset:3072
v_exp_f32 v46, v46
v_mfma_f32_16x16x32_bf16 v[28:31], a[4:7], a[212:215], v[28:31]
s_waitcnt lgkmcnt(4)
v_exp_f32 v47, v47
v_mfma_f32_16x16x32_bf16 v[28:31], a[8:11], a[216:219], v[28:31]
ds_read_b128 a[48:51], v1 offset:4096
v_add_u32 v13, 0x20000, v13
v_mfma_f32_16x16x32_bf16 v[28:31], a[12:15], a[220:223], v[28:31]
buffer_load_dwordx4 v13, s[72:75], 0 offen offset:1024 lds
v_cvt_pk_bf16_f32 v75, v42, v43
v_mfma_f32_16x16x32_bf16 v[40:43], a[16:19], a[192:195], v[116:119]
ds_read_b128 a[52:55], v1 offset:5120
v_exp_f32 v24, v24
v_mfma_f32_16x16x32_bf16 v[40:43], a[20:23], a[196:199], v[40:43]
buffer_load_dwordx4 v12, s[72:75], s12 offen offset:2048 lds
v_mfma_f32_16x16x32_bf16 v[40:43], a[24:27], a[200:203], v[40:43]
ds_read_b128 a[56:59], v1 offset:6144
v_exp_f32 v25, v25
v_mfma_f32_16x16x32_bf16 v[40:43], a[28:31], a[204:207], v[40:43]
ds_read_b128 a[60:63], v1 offset:7168
v_cvt_pk_bf16_f32 v78, v44, v45
v_cvt_pk_bf16_f32 v79, v46, v47
v_mfma_f32_16x16x32_bf16 v[44:47], a[16:19], a[208:211], v[92:95]
buffer_load_dwordx4 v13, s[72:75], s12 offen offset:3072 lds
v_mfma_f32_16x16x32_bf16 v[44:47], a[20:23], a[212:215], v[44:47]
v_exp_f32 v26, v26
v_mfma_f32_16x16x32_bf16 v[44:47], a[24:27], a[216:219], v[44:47]
v_exp_f32 v27, v27
v_mfma_f32_16x16x32_bf16 v[44:47], a[28:31], a[220:223], v[44:47]
s_waitcnt lgkmcnt(0)
v_exp_f32 v28, v28
v_exp_f32 v29, v29
v_mfma_f32_16x16x32_bf16 v[192:195], a[32:35], v[72:75], v[192:195]
ds_read_b128 a[0:3], v1 offset:24576
v_cvt_pk_bf16_f32 v56, v24, v25
v_mfma_f32_16x16x32_bf16 v[224:227], a[32:35], v[76:79], v[224:227]
ds_read_b128 a[4:7], v1 offset:25600
v_add_u32 v12, 0x20000, v12
v_mfma_f32_16x16x32_bf16 v[228:231], a[36:39], v[76:79], v[228:231]
s_add_u32 m0, s16, 0x0
v_exp_f32 v30, v30
v_mfma_f32_16x16x32_bf16 v[196:199], a[36:39], v[72:75], v[196:199]
buffer_load_dwordx4 v12, s[72:75], 0 offen lds
v_mfma_f32_16x16x32_bf16 v[200:203], a[40:43], v[72:75], v[200:203]
ds_read_b128 a[8:11], v1 offset:26624
v_add_u32 v13, 0x20000, v13
v_mfma_f32_16x16x32_bf16 v[232:235], a[40:43], v[76:79], v[232:235]
buffer_load_dwordx4 v13, s[72:75], 0 offen offset:1024 lds
v_mfma_f32_16x16x32_bf16 v[236:239], a[44:47], v[76:79], v[236:239]
ds_read_b128 a[12:15], v1 offset:27648
v_cvt_pk_bf16_f32 v57, v26, v27
v_mfma_f32_16x16x32_bf16 v[204:207], a[44:47], v[72:75], v[204:207]
buffer_load_dwordx4 v12, s[72:75], s12 offen offset:2048 lds
v_mfma_f32_16x16x32_bf16 v[208:211], a[48:51], v[72:75], v[208:211]
ds_read_b128 a[16:19], v1 offset:28672
v_cvt_pk_bf16_f32 v60, v28, v29
v_mfma_f32_16x16x32_bf16 v[240:243], a[48:51], v[76:79], v[240:243]
buffer_load_dwordx4 v13, s[72:75], s12 offen offset:3072 lds
v_mfma_f32_16x16x32_bf16 v[244:247], a[52:55], v[76:79], v[244:247]
ds_read_b128 a[20:23], v1 offset:29696
v_exp_f32 v31, v31
v_mfma_f32_16x16x32_bf16 v[212:215], a[52:55], v[72:75], v[212:215]
ds_read_b128 a[24:27], v1 offset:30720
s_add_u32 m0, s16, 0x4000
v_mfma_f32_16x16x32_bf16 v[216:219], a[56:59], v[72:75], v[216:219]
ds_read_b128 a[28:31], v1 offset:31744
v_add_u32 v12, 0x20000, v12
v_mfma_f32_16x16x32_bf16 v[248:251], a[56:59], v[76:79], v[248:251]
buffer_load_dwordx4 v12, s[72:75], 0 offen lds
v_mfma_f32_16x16x32_bf16 v[252:255], a[60:63], v[76:79], v[252:255]
ds_read_b128 a[32:35], v1 offset:16384
s_waitcnt lgkmcnt(5)
v_mfma_f32_16x16x32_bf16 v[220:223], a[60:63], v[72:75], v[220:223]
ds_read_b128 a[36:39], v1 offset:17408
v_add_u32 v13, 0x20000, v13
v_smfmac_f32_16x16x64_bf16 a[228:231], a[232:235], v[72:79], v9
buffer_load_dwordx4 v13, s[72:75], 0 offen offset:1024 lds
v_cvt_pk_bf16_f32 v61, v30, v31
v_mfma_f32_16x16x32_bf16 v[28:31], a[0:3], a[208:211], v[92:95]
ds_read_b128 a[40:43], v1 offset:18432
v_exp_f32 v40, v40
v_mfma_f32_16x16x32_bf16 v[28:31], a[4:7], a[212:215], v[28:31]
buffer_load_dwordx4 v12, s[72:75], s12 offen offset:2048 lds
v_mfma_f32_16x16x32_bf16 v[28:31], a[8:11], a[216:219], v[28:31]
ds_read_b128 a[44:47], v1 offset:19456
v_exp_f32 v41, v41
v_mfma_f32_16x16x32_bf16 v[28:31], a[12:15], a[220:223], v[28:31]
ds_read_b128 a[48:51], v1 offset:20480
s_waitcnt lgkmcnt(5)
v_exp_f32 v42, v42
v_exp_f32 v43, v43
v_exp_f32 v44, v44
v_exp_f32 v45, v45
v_exp_f32 v46, v46
v_exp_f32 v47, v47
v_cvt_pk_bf16_f32 v62, v44, v45
v_cvt_pk_bf16_f32 v63, v46, v47
v_mfma_f32_16x16x32_bf16 v[44:47], a[16:19], a[208:211], v[92:95]
buffer_load_dwordx4 v13, s[72:75], s12 offen offset:3072 lds
v_mfma_f32_16x16x32_bf16 v[44:47], a[20:23], a[212:215], v[44:47]
ds_read_b128 a[52:55], v1 offset:21504
v_cvt_pk_bf16_f32 v58, v40, v41
v_mfma_f32_16x16x32_bf16 v[44:47], a[24:27], a[216:219], v[44:47]
ds_read_b128 a[56:59], v1 offset:22528
v_cvt_pk_bf16_f32 v59, v42, v43
v_mfma_f32_16x16x32_bf16 v[44:47], a[28:31], a[220:223], v[44:47]
ds_read_b128 a[60:63], v1 offset:23552
v_xor_b32 v1, 0x8000, v1
L_att_h1_0:
s_waitcnt vmcnt(16) lgkmcnt(0)
s_mov_b32 s92, 200000
L_spin_b0:
v_cmp_gt_u32 vcc, 32, v14
s_nop 4
s_cbranch_vccz L_spun_b0
s_sub_u32 s92, s92, 1
s_cbranch_scc1 L_spun_b0
s_sleep 2
buffer_load_dword v14, v15, s[84:87], 0 offen offset:192 sc1
s_waitcnt vmcnt(0)
s_branch L_spin_b0
L_spun_b0:
s_barrier
v_mfma_f32_16x16x32_bf16 v[192:195], a[32:35], v[56:59], v[192:195]
ds_read_b128 a[0:3], v2 offset:8192
v_exp_f32 v28, v28
v_mfma_f32_16x16x32_bf16 v[224:227], a[32:35], v[60:63], v[224:227]
ds_read_b128 a[4:7], v2 offset:9216
v_exp_f32 v29, v29
v_mfma_f32_16x16x32_bf16 v[228:231], a[36:39], v[60:63], v[228:231]
s_add_u32 s101, s101, 0x2000
v_exp_f32 v30, v30
v_mfma_f32_16x16x32_bf16 v[196:199], a[36:39], v[56:59], v[196:199]
buffer_load_dwordx4 a[64:67], v3, s[88:91], s101 offen sc1
v_mfma_f32_16x16x32_bf16 v[200:203], a[40:43], v[56:59], v[200:203]
ds_read_b128 a[8:11], v2 offset:10240
v_exp_f32 v31, v31
v_mfma_f32_16x16x32_bf16 v[232:235], a[40:43], v[60:63], v[232:235]
buffer_load_dwordx4 a[68:71], v3, s[88:91], s101 offen offset:1024 sc1
v_mfma_f32_16x16x32_bf16 v[236:239], a[44:47], v[60:63], v[236:239]
ds_read_b128 a[12:15], v2 offset:11264
s_add_u32 s101, s101, 0x2000
v_mfma_f32_16x16x32_bf16 v[204:207], a[44:47], v[56:59], v[204:207]
buffer_load_dwordx4 a[72:75], v3, s[88:91], s101 offen sc1
v_mfma_f32_16x16x32_bf16 v[208:211], a[48:51], v[56:59], v[208:211]
ds_read_b128 a[16:19], v2 offset:12288
v_cvt_pk_bf16_f32 v76, v28, v29
v_mfma_f32_16x16x32_bf16 v[240:243], a[48:51], v[60:63], v[240:243]
buffer_load_dwordx4 a[76:79], v3, s[88:91], s101 offen offset:1024 sc1
v_mfma_f32_16x16x32_bf16 v[244:247], a[52:55], v[60:63], v[244:247]
ds_read_b128 a[20:23], v2 offset:13312
v_exp_f32 v44, v44
v_mfma_f32_16x16x32_bf16 v[212:215], a[52:55], v[56:59], v[212:215]
ds_read_b128 a[24:27], v2 offset:14336
v_exp_f32 v45, v45
v_mfma_f32_16x16x32_bf16 v[216:219], a[56:59], v[56:59], v[216:219]
ds_read_b128 a[28:31], v2 offset:15360
s_add_u32 s101, s101, 0x2000
v_mfma_f32_16x16x32_bf16 v[248:251], a[56:59], v[60:63], v[248:251]
buffer_load_dwordx4 a[80:83], v3, s[88:91], s101 offen sc1
v_mfma_f32_16x16x32_bf16 v[252:255], a[60:63], v[60:63], v[252:255]
ds_read_b128 a[32:35], v2 offset:0
v_cvt_pk_bf16_f32 v77, v30, v31
v_mfma_f32_16x16x32_bf16 v[220:223], a[60:63], v[56:59], v[220:223]
ds_read_b128 a[36:39], v2 offset:1024
s_waitcnt lgkmcnt(6)
v_smfmac_f32_16x16x64_bf16 a[228:231], a[232:235], v[56:63], v9
buffer_load_dwordx4 a[84:87], v3, s[88:91], s101 offen offset:1024 sc1
v_mfma_f32_16x16x32_bf16 v[28:31], a[0:3], a[208:211], v[92:95]
ds_read_b128 a[40:43], v2 offset:2048
v_exp_f32 v46, v46
v_mfma_f32_16x16x32_bf16 v[28:31], a[4:7], a[212:215], v[28:31]
ds_read_b128 a[44:47], v2 offset:3072
s_add_u32 s101, s101, 0x2000
v_mfma_f32_16x16x32_bf16 v[28:31], a[8:11], a[216:219], v[28:31]
buffer_load_dwordx4 a[88:91], v3, s[88:91], s101 offen sc1
v_mfma_f32_16x16x32_bf16 v[28:31], a[12:15], a[220:223], v[28:31]
ds_read_b128 a[48:51], v2 offset:4096
s_waitcnt lgkmcnt(5)
v_exp_f32 v47, v47
v_cvt_pk_bf16_f32 v78, v44, v45
v_cvt_pk_bf16_f32 v79, v46, v47
v_mfma_f32_16x16x32_bf16 v[44:47], a[16:19], a[208:211], v[92:95]
ds_read_b128 a[52:55], v2 offset:5120
v_mfma_f32_16x16x32_bf16 v[44:47], a[20:23], a[212:215], v[44:47]
buffer_load_dwordx4 a[92:95], v3, s[88:91], s101 offen offset:1024 sc1
v_mfma_f32_16x16x32_bf16 v[44:47], a[24:27], a[216:219], v[44:47]
ds_read_b128 a[56:59], v2 offset:6144
v_mfma_f32_16x16x32_bf16 v[44:47], a[28:31], a[220:223], v[44:47]
ds_read_b128 a[60:63], v2 offset:7168
s_waitcnt lgkmcnt(0)
v_mfma_f32_16x16x32_bf16 v[224:227], a[32:35], v[76:79], v[224:227]
ds_read_b128 a[0:3], v2 offset:24576
s_add_u32 s101, s101, 0x2000
v_mfma_f32_16x16x32_bf16 v[228:231], a[36:39], v[76:79], v[228:231]
buffer_load_dwordx4 a[96:99], v3, s[88:91], s101 offen sc1
v_mfma_f32_16x16x32_bf16 v[232:235], a[40:43], v[76:79], v[232:235]
ds_read_b128 a[4:7], v2 offset:25600
v_exp_f32 v28, v28
v_mfma_f32_16x16x32_bf16 v[236:239], a[44:47], v[76:79], v[236:239]
buffer_load_dwordx4 a[100:103], v3, s[88:91], s101 offen offset:1024 sc1
v_mfma_f32_16x16x32_bf16 v[240:243], a[48:51], v[76:79], v[240:243]
ds_read_b128 a[8:11], v2 offset:26624
s_add_u32 s101, s101, 0x2000
v_mfma_f32_16x16x32_bf16 v[244:247], a[52:55], v[76:79], v[244:247]
buffer_load_dwordx4 a[104:107], v3, s[88:91], s101 offen sc1
v_mfma_f32_16x16x32_bf16 v[248:251], a[56:59], v[76:79], v[248:251]
ds_read_b128 a[12:15], v2 offset:27648
s_waitcnt lgkmcnt(0)
v_mfma_f32_16x16x32_bf16 v[252:255], a[60:63], v[76:79], v[252:255]
buffer_load_dwordx4 a[108:111], v3, s[88:91], s101 offen offset:1024 sc1
ds_read_b128 a[16:19], v2 offset:28672
v_mfma_f32_16x16x32_bf16 a[228:231], a[236:239], v[76:79], a[228:231]
ds_read_b128 a[20:23], v2 offset:29696
s_add_u32 s101, s101, 0x2000
v_exp_f32 v29, v29
v_exp_f32 v30, v30
v_exp_f32 v31, v31
v_cvt_pk_bf16_f32 v60, v28, v29
v_cvt_pk_bf16_f32 v61, v30, v31
v_mfma_f32_16x16x32_bf16 v[28:31], a[0:3], a[208:211], v[120:123]
buffer_load_dwordx4 a[112:115], v3, s[88:91], s101 offen sc1
ds_read_b128 a[24:27], v2 offset:30720
v_mfma_f32_16x16x32_bf16 v[28:31], a[4:7], a[212:215], v[28:31]
ds_read_b128 a[28:31], v2 offset:31744
s_waitcnt lgkmcnt(0)
v_mfma_f32_16x16x32_bf16 v[28:31], a[8:11], a[216:219], v[28:31]
buffer_load_dwordx4 a[116:119], v3, s[88:91], s101 offen offset:1024 sc1
v_mfma_f32_16x16x32_bf16 v[28:31], a[12:15], a[220:223], v[28:31]
ds_read_b128 a[32:35], v2 offset:16384
s_add_u32 s101, s101, 0x2000
v_exp_f32 v44, v44
v_exp_f32 v45, v45
v_exp_f32 v46, v46
v_exp_f32 v47, v47
v_cvt_pk_bf16_f32 v62, v44, v45
v_cvt_pk_bf16_f32 v63, v46, v47
v_mfma_f32_16x16x32_bf16 v[44:47], a[16:19], a[208:211], v[124:127]
buffer_load_dwordx4 a[120:123], v3, s[88:91], s101 offen sc1
v_mfma_f32_16x16x32_bf16 v[44:47], a[20:23], a[212:215], v[44:47]
buffer_load_dwordx4 a[124:127], v3, s[88:91], s101 offen offset:1024 sc1
v_mfma_f32_16x16x32_bf16 v[44:47], a[24:27], a[216:219], v[44:47]
ds_read_b128 a[36:39], v2 offset:17408
v_mfma_f32_16x16x32_bf16 v[44:47], a[28:31], a[220:223], v[44:47]
ds_read_b128 a[40:43], v2 offset:18432
ds_read_b128 a[44:47], v2 offset:19456
ds_read_b128 a[48:51], v2 offset:20480
ds_read_b128 a[52:55], v2 offset:21504
ds_read_b128 a[56:59], v2 offset:22528
ds_read_b128 a[60:63], v2 offset:23552
v_xor_b32 v2, 0x38000, v2
s_waitcnt lgkmcnt(0)
s_barrier
v_accvgpr_read_b32 v6, a228
v_accvgpr_read_b32 v7, a229
v_add_f32 v6, v6, v7
v_cmp_nge_f32 vcc, 0x5f800000, v6
v_rcp_f32 v6, v6
s_or_b64 s[34:35], s[34:35], vcc
v_mfma_f32_16x16x32_bf16 v[224:227], a[32:35], v[60:63], v[224:227]
ds_read_b128 a[32:35], v1 offset:0
v_exp_f32 v28, v28
v_mfma_f32_16x16x32_bf16 v[228:231], a[36:39], v[60:63], v[228:231]
ds_read_b128 a[36:39], v1 offset:1024
v_exp_f32 v29, v29
v_mfma_f32_16x16x32_bf16 v[232:235], a[40:43], v[60:63], v[232:235]
ds_read_b128 a[40:43], v1 offset:2048
v_exp_f32 v30, v30
v_mfma_f32_16x16x32_bf16 v[236:239], a[44:47], v[60:63], v[236:239]
ds_read_b128 a[44:47], v1 offset:3072
v_exp_f32 v31, v31
v_mfma_f32_16x16x32_bf16 v[240:243], a[48:51], v[60:63], v[240:243]
ds_read_b128 a[48:51], v1 offset:4096
v_exp_f32 v44, v44
v_mfma_f32_16x16x32_bf16 v[244:247], a[52:55], v[60:63], v[244:247]
ds_read_b128 a[52:55], v1 offset:5120
v_exp_f32 v45, v45
v_mfma_f32_16x16x32_bf16 v[248:251], a[56:59], v[60:63], v[248:251]
ds_read_b128 a[56:59], v1 offset:6144
v_exp_f32 v46, v46
v_mfma_f32_16x16x32_bf16 v[252:255], a[60:63], v[60:63], v[252:255]
ds_read_b128 a[60:63], v1 offset:7168
v_exp_f32 v47, v47
v_mfma_f32_16x16x32_bf16 a[228:231], a[236:239], v[60:63], a[228:231]
v_cvt_pk_bf16_f32 v76, v28, v29
v_cvt_pk_bf16_f32 v77, v30, v31
v_cvt_pk_bf16_f32 v78, v44, v45
v_cvt_pk_bf16_f32 v79, v46, v47
s_add_u32 s8, s30, 0x0
v_pk_mul_f32 v[192:193], v[192:193], v[6:7] op_sel_hi:[1,0]
v_pk_mul_f32 v[194:195], v[194:195], v[6:7] op_sel_hi:[1,0]
v_pk_mul_f32 v[196:197], v[196:197], v[6:7] op_sel_hi:[1,0]
v_pk_mul_f32 v[198:199], v[198:199], v[6:7] op_sel_hi:[1,0]
v_cvt_pk_bf16_f32 v192, v192, v193
v_cvt_pk_bf16_f32 v193, v194, v195
v_cvt_pk_bf16_f32 v194, v196, v197
v_cvt_pk_bf16_f32 v195, v198, v199
buffer_store_dwordx4 v[192:195], v3, s[88:91], s8 offen sc1
s_add_u32 s8, s30, 0x2000
v_pk_mul_f32 v[200:201], v[200:201], v[6:7] op_sel_hi:[1,0]
v_pk_mul_f32 v[202:203], v[202:203], v[6:7] op_sel_hi:[1,0]
v_pk_mul_f32 v[204:205], v[204:205], v[6:7] op_sel_hi:[1,0]
v_pk_mul_f32 v[206:207], v[206:207], v[6:7] op_sel_hi:[1,0]
v_cvt_pk_bf16_f32 v200, v200, v201
v_cvt_pk_bf16_f32 v201, v202, v203
v_cvt_pk_bf16_f32 v202, v204, v205
v_cvt_pk_bf16_f32 v203, v206, v207
buffer_store_dwordx4 v[200:203], v3, s[88:91], s8 offen sc1
s_waitcnt lgkmcnt(0)
v_mfma_f32_16x16x32_bf16 v[224:227], a[32:35], v[76:79], v[224:227]
s_add_u32 s8, s30, 0x4000
v_mul_f32 v208, v6, v208
v_mfma_f32_16x16x32_bf16 v[228:231], a[36:39], v[76:79], v[228:231]
v_mul_f32 v209, v6, v209
v_mul_f32 v210, v6, v210
v_mfma_f32_16x16x32_bf16 v[232:235], a[40:43], v[76:79], v[232:235]
v_mul_f32 v211, v6, v211
v_mul_f32 v212, v6, v212
v_mfma_f32_16x16x32_bf16 v[236:239], a[44:47], v[76:79], v[236:239]
v_mul_f32 v213, v6, v213
v_mul_f32 v214, v6, v214
v_mfma_f32_16x16x32_bf16 v[240:243], a[48:51], v[76:79], v[240:243]
v_mul_f32 v215, v6, v215
v_cvt_pk_bf16_f32 v208, v208, v209
v_mfma_f32_16x16x32_bf16 v[244:247], a[52:55], v[76:79], v[244:247]
v_cvt_pk_bf16_f32 v209, v210, v211
v_cvt_pk_bf16_f32 v210, v212, v213
v_mfma_f32_16x16x32_bf16 v[248:251], a[56:59], v[76:79], v[248:251]
v_cvt_pk_bf16_f32 v211, v214, v215
buffer_store_dwordx4 v[208:211], v3, s[88:91], s8 offen sc1
v_mfma_f32_16x16x32_bf16 v[252:255], a[60:63], v[76:79], v[252:255]
s_add_u32 s8, s30, 0x6000
v_mul_f32 v216, v6, v216
v_mfma_f32_16x16x32_bf16 a[228:231], a[236:239], v[76:79], a[228:231]
v_mul_f32 v217, v6, v217
v_mul_f32 v218, v6, v218
v_mul_f32 v219, v6, v219
v_mul_f32 v220, v6, v220
v_mul_f32 v221, v6, v221
v_mul_f32 v222, v6, v222
v_mul_f32 v223, v6, v223
v_cvt_pk_bf16_f32 v216, v216, v217
v_cvt_pk_bf16_f32 v217, v218, v219
v_cvt_pk_bf16_f32 v218, v220, v221
v_cvt_pk_bf16_f32 v219, v222, v223
buffer_store_dwordx4 v[216:219], v3, s[88:91], s8 offen sc1
s_branch L_att_fin
L_att_sh0_1:
v_mfma_f32_16x16x32_bf16 v[192:195], a[32:35], v[56:59], v[192:195]
v_exp_f32 v30, v30
v_mfma_f32_16x16x32_bf16 v[224:227], a[32:35], v[60:63], v[224:227]
buffer_load_dword v14, v15, s[84:87], 0 offen offset:192 sc1
v_mfma_f32_16x16x32_bf16 v[228:231], a[36:39], v[60:63], v[228:231]
v_exp_f32 v31, v31
v_mfma_f32_16x16x32_bf16 v[196:199], a[36:39], v[56:59], v[196:199]
s_add_u32 m0, s17, 0x10000
v_exp_f32 v40, v40
v_mfma_f32_16x16x32_bf16 v[200:203], a[40:43], v[56:59], v[200:203]
ds_read_b128 a[0:3], v1 offset:8192
v_cvt_pk_bf16_f32 v72, v24, v25
v_mfma_f32_16x16x32_bf16 v[232:235], a[40:43], v[60:63], v[232:235]
ds_read_b128 a[4:7], v1 offset:9216
v_cvt_pk_bf16_f32 v73, v26, v27
v_mfma_f32_16x16x32_bf16 v[236:239], a[44:47], v[60:63], v[236:239]
buffer_load_dwordx4 v12, s[72:75], 0 offen lds
v_mfma_f32_16x16x32_bf16 v[204:207], a[44:47], v[56:59], v[204:207]
ds_read_b128 a[8:11], v1 offset:10240
v_cvt_pk_bf16_f32 v76, v28, v29
v_mfma_f32_16x16x32_bf16 v[208:211], a[48:51], v[56:59], v[208:211]
buffer_load_dwordx4 v13, s[72:75], 0 offen offset:1024 lds
v_mfma_f32_16x16x32_bf16 v[240:243], a[48:51], v[60:63], v[240:243]
ds_read_b128 a[12:15], v1 offset:11264
v_cvt_pk_bf16_f32 v77, v30, v31
v_mfma_f32_16x16x32_bf16 v[244:247], a[52:55], v[60:63], v[244:247]
buffer_load_dwordx4 v12, s[72:75], s12 offen offset:2048 lds
v_mfma_f32_16x16x32_bf16 v[212:215], a[52:55], v[56:59], v[212:215]
ds_read_b128 a[16:19], v1 offset:12288
v_exp_f32 v41, v41
v_mfma_f32_16x16x32_bf16 v[216:219], a[56:59], v[56:59], v[216:219]
ds_read_b128 a[20:23], v1 offset:13312
v_exp_f32 v42, v42
v_mfma_f32_16x16x32_bf16 v[248:251], a[56:59], v[60:63], v[248:251]
buffer_load_dwordx4 v13, s[72:75], s12 offen offset:3072 lds
v_mfma_f32_16x16x32_bf16 v[252:255], a[60:63], v[60:63], v[252:255]
ds_read_b128 a[24:27], v1 offset:14336
s_waitcnt lgkmcnt(3)
v_mfma_f32_16x16x32_bf16 v[220:223], a[60:63], v[56:59], v[220:223]
ds_read_b128 a[28:31], v1 offset:15360
v_add_u32 v12, 0x20000, v12
v_smfmac_f32_16x16x64_bf16 a[228:231], a[232:235], v[56:63], v9
s_add_u32 m0, s17, 0x14000
v_exp_f32 v43, v43
v_mfma_f32_16x16x32_bf16 v[24:27], a[0:3], a[192:195], v[88:91]
buffer_load_dwordx4 v12, s[72:75], 0 offen lds
v_mfma_f32_16x16x32_bf16 v[24:27], a[4:7], a[196:199], v[24:27]
ds_read_b128 a[32:35], v1 offset:0
v_cvt_pk_bf16_f32 v74, v40, v41
v_mfma_f32_16x16x32_bf16 v[24:27], a[8:11], a[200:203], v[24:27]
ds_read_b128 a[36:39], v1 offset:1024
v_exp_f32 v44, v44
v_mfma_f32_16x16x32_bf16 v[24:27], a[12:15], a[204:207], v[24:27]
ds_read_b128 a[40:43], v1 offset:2048
v_exp_f32 v45, v45
v_mfma_f32_16x16x32_bf16 v[28:31], a[0:3], a[208:211], v[92:95]
ds_read_b128 a[44:47], v1 offset:3072
v_exp_f32 v46, v46
v_mfma_f32_16x16x32_bf16 v[28:31], a[4:7], a[212:215], v[28:31]
s_waitcnt lgkmcnt(4)
v_exp_f32 v47, v47
v_mfma_f32_16x16x32_bf16 v[28:31], a[8:11], a[216:219], v[28:31]
ds_read_b128 a[48:51], v1 offset:4096
v_add_u32 v13, 0x20000, v13
v_mfma_f32_16x16x32_bf16 v[28:31], a[12:15], a[220:223], v[28:31]
buffer_load_dwordx4 v13, s[72:75], 0 offen offset:1024 lds
v_cvt_pk_bf16_f32 v75, v42, v43
v_mfma_f32_16x16x32_bf16 v[40:43], a[16:19], a[192:195], v[88:91]
ds_read_b128 a[52:55], v1 offset:5120
v_exp_f32 v24, v24
v_mfma_f32_16x16x32_bf16 v[40:43], a[20:23], a[196:199], v[40:43]
buffer_load_dwordx4 v12, s[72:75], s12 offen offset:2048 lds
v_mfma_f32_16x16x32_bf16 v[40:43], a[24:27], a[200:203], v[40:43]
ds_read_b128 a[56:59], v1 offset:6144
v_exp_f32 v25, v25
v_mfma_f32_16x16x32_bf16 v[40:43], a[28:31], a[204:207], v[40:43]
ds_read_b128 a[60:63], v1 offset:7168
v_cvt_pk_bf16_f32 v78, v44, v45
v_cvt_pk_bf16_f32 v79, v46, v47
v_mfma_f32_16x16x32_bf16 v[44:47], a[16:19], a[208:211], v[92:95]
buffer_load_dwordx4 v13, s[72:75], s12 offen offset:3072 lds
v_mfma_f32_16x16x32_bf16 v[44:47], a[20:23], a[212:215], v[44:47]
v_exp_f32 v26, v26
v_mfma_f32_16x16x32_bf16 v[44:47], a[24:27], a[216:219], v[44:47]
v_exp_f32 v27, v27
v_mfma_f32_16x16x32_bf16 v[44:47], a[28:31], a[220:223], v[44:47]
s_waitcnt lgkmcnt(0)
v_exp_f32 v28, v28
v_exp_f32 v29, v29
v_mfma_f32_16x16x32_bf16 v[192:195], a[32:35], v[72:75], v[192:195]
s_add_u32 m0, s16, 0x0
v_add_u32 v12, 0x20000, v12
v_cvt_pk_bf16_f32 v56, v24, v25
v_mfma_f32_16x16x32_bf16 v[224:227], a[32:35], v[76:79], v[224:227]
buffer_load_dwordx4 v12, s[72:75], 0 offen lds
v_mfma_f32_16x16x32_bf16 v[228:231], a[36:39], v[76:79], v[228:231]
ds_read_b128 a[0:3], v1 offset:24576
v_cvt_pk_bf16_f32 v57, v26, v27
v_mfma_f32_16x16x32_bf16 v[196:199], a[36:39], v[72:75], v[196:199]
v_exp_f32 v30, v30
v_mfma_f32_16x16x32_bf16 v[200:203], a[40:43], v[72:75], v[200:203]
ds_read_b128 a[4:7], v1 offset:25600
v_cvt_pk_bf16_f32 v60, v28, v29
v_mfma_f32_16x16x32_bf16 v[232:235], a[40:43], v[76:79], v[232:235]
ds_read_b128 a[8:11], v1 offset:26624
v_add_u32 v13, 0x20000, v13
v_mfma_f32_16x16x32_bf16 v[236:239], a[44:47], v[76:79], v[236:239]
buffer_load_dwordx4 v13, s[72:75], 0 offen offset:1024 lds
v_mfma_f32_16x16x32_bf16 v[204:207], a[44:47], v[72:75], v[204:207]
ds_read_b128 a[12:15], v1 offset:27648
v_exp_f32 v31, v31
v_mfma_f32_16x16x32_bf16 v[208:211], a[48:51], v[72:75], v[208:211]
buffer_load_dwordx4 v12, s[72:75], s12 offen offset:2048 lds
v_mfma_f32_16x16x32_bf16 v[240:243], a[48:51], v[76:79], v[240:243]
ds_read_b128 a[16:19], v1 offset:28672
v_exp_f32 v40, v40
v_mfma_f32_16x16x32_bf16 v[244:247], a[52:55], v[76:79], v[244:247]
ds_read_b128 a[20:23], v1 offset:29696
v_cvt_pk_bf16_f32 v61, v30, v31
v_mfma_f32_16x16x32_bf16 v[212:215], a[52:55], v[72:75], v[212:215]
buffer_load_dwordx4 v13, s[72:75], s12 offen offset:3072 lds
v_mfma_f32_16x16x32_bf16 v[216:219], a[56:59], v[72:75], v[216:219]
ds_read_b128 a[24:27], v1 offset:30720
v_exp_f32 v41, v41
v_mfma_f32_16x16x32_bf16 v[248:251], a[56:59], v[76:79], v[248:251]
ds_read_b128 a[28:31], v1 offset:31744
v_exp_f32 v42, v42
v_mfma_f32_16x16x32_bf16 v[252:255], a[60:63], v[76:79], v[252:255]
ds_read_b128 a[32:35], v1 offset:16384
v_cvt_pk_bf16_f32 v58, v40, v41
v_mfma_f32_16x16x32_bf16 v[220:223], a[60:63], v[72:75], v[220:223]
s_waitcnt lgkmcnt(5)
v_exp_f32 v43, v43
v_smfmac_f32_16x16x64_bf16 a[228:231], a[232:235], v[72:79], v9
ds_read_b128 a[36:39], v1 offset:17408
v_add_u32 v12, 0x20000, v12
v_mfma_f32_16x16x32_bf16 v[24:27], a[0:3], a[192:195], v[112:115]
s_add_u32 m0, s16, 0x4000
v_exp_f32 v44, v44
v_mfma_f32_16x16x32_bf16 v[24:27], a[4:7], a[196:199], v[24:27]
buffer_load_dwordx4 v12, s[72:75], 0 offen lds
v_mfma_f32_16x16x32_bf16 v[24:27], a[8:11], a[200:203], v[24:27]
ds_read_b128 a[40:43], v1 offset:18432
v_add_u32 v13, 0x20000, v13
v_mfma_f32_16x16x32_bf16 v[24:27], a[12:15], a[204:207], v[24:27]
buffer_load_dwordx4 v13, s[72:75], 0 offen offset:1024 lds
v_mfma_f32_16x16x32_bf16 v[28:31], a[0:3], a[208:211], v[92:95]
ds_read_b128 a[44:47], v1 offset:19456
v_cvt_pk_bf16_f32 v59, v42, v43
v_mfma_f32_16x16x32_bf16 v[28:31], a[4:7], a[212:215], v[28:31]
ds_read_b128 a[48:51], v1 offset:20480
v_exp_f32 v45, v45
v_mfma_f32_16x16x32_bf16 v[28:31], a[8:11], a[216:219], v[28:31]
s_waitcnt lgkmcnt(5)
v_exp_f32 v46, v46
v_mfma_f32_16x16x32_bf16 v[28:31], a[12:15], a[220:223], v[28:31]
buffer_load_dwordx4 v12, s[72:75], s12 offen offset:2048 lds
v_mfma_f32_16x16x32_bf16 v[40:43], a[16:19], a[192:195], v[116:119]
ds_read_b128 a[52:55], v1 offset:21504
v_exp_f32 v47, v47
v_mfma_f32_16x16x32_bf16 v[40:43], a[20:23], a[196:199], v[40:43]
ds_read_b128 a[56:59], v1 offset:22528
v_exp_f32 v24, v24
v_mfma_f32_16x16x32_bf16 v[40:43], a[24:27], a[200:203], v[40:43]
ds_read_b128 a[60:63], v1 offset:23552
v_xor_b32 v1, 0x8000, v1
v_mfma_f32_16x16x32_bf16 v[40:43], a[28:31], a[204:207], v[40:43]
v_exp_f32 v25, v25
v_cvt_pk_bf16_f32 v62, v44, v45
v_cvt_pk_bf16_f32 v63, v46, v47
v_mfma_f32_16x16x32_bf16 v[44:47], a[16:19], a[208:211], v[92:95]
v_exp_f32 v26, v26
v_mfma_f32_16x16x32_bf16 v[44:47], a[20:23], a[212:215], v[44:47]
buffer_load_dwordx4 v13, s[72:75], s12 offen offset:3072 lds
v_mfma_f32_16x16x32_bf16 v[44:47], a[24:27], a[216:219], v[44:47]
v_exp_f32 v27, v27
v_mfma_f32_16x16x32_bf16 v[44:47], a[28:31], a[220:223], v[44:47]
v_exp_f32 v28, v28
v_exp_f32 v29, v29
L_att_h1_1:
s_waitcnt vmcnt(16) lgkmcnt(0)
s_mov_b32 s92, 200000
L_spin_b1:
v_cmp_gt_u32 vcc, 32, v14
s_nop 4
s_cbranch_vccz L_spun_b1
s_sub_u32 s92, s92, 1
s_cbranch_scc1 L_spun_b1
s_sleep 2
buffer_load_dword v14, v15, s[84:87], 0 offen offset:192 sc1
s_waitcnt vmcnt(0)
s_branch L_spin_b1
L_spun_b1:
s_barrier
v_mfma_f32_16x16x32_bf16 v[192:195], a[32:35], v[56:59], v[192:195]
ds_read_b128 a[0:3], v2 offset:8192
v_cvt_pk_bf16_f32 v72, v24, v25
v_mfma_f32_16x16x32_bf16 v[224:227], a[32:35], v[60:63], v[224:227]
ds_read_b128 a[4:7], v2 offset:9216
v_cvt_pk_bf16_f32 v73, v26, v27
v_mfma_f32_16x16x32_bf16 v[228:231], a[36:39], v[60:63], v[228:231]
s_add_u32 s101, s101, 0x2000
v_exp_f32 v30, v30
v_mfma_f32_16x16x32_bf16 v[196:199], a[36:39], v[56:59], v[196:199]
buffer_load_dwordx4 a[64:67], v3, s[88:91], s101 offen sc1
v_mfma_f32_16x16x32_bf16 v[200:203], a[40:43], v[56:59], v[200:203]
ds_read_b128 a[8:11], v2 offset:10240
v_cvt_pk_bf16_f32 v76, v28, v29
v_mfma_f32_16x16x32_bf16 v[232:235], a[40:43], v[60:63], v[232:235]
buffer_load_dwordx4 a[68:71], v3, s[88:91], s101 offen offset:1024 sc1
v_mfma_f32_16x16x32_bf16 v[236:239], a[44:47], v[60:63], v[236:239]
ds_read_b128 a[12:15], v2 offset:11264
s_add_u32 s101, s101, 0x2000
v_mfma_f32_16x16x32_bf16 v[204:207], a[44:47], v[56:59], v[204:207]
buffer_load_dwordx4 a[72:75], v3, s[88:91], s101 offen sc1
v_mfma_f32_16x16x32_bf16 v[208:211], a[48:51], v[56:59], v[208:211]
ds_read_b128 a[16:19], v2 offset:12288
v_exp_f32 v31, v31
v_mfma_f32_16x16x32_bf16 v[240:243], a[48:51], v[60:63], v[240:243]
buffer_load_dwordx4 a[76:79], v3, s[88:91], s101 offen offset:1024 sc1
v_mfma_f32_16x16x32_bf16 v[244:247], a[52:55], v[60:63], v[244:247]
ds_read_b128 a[20:23], v2 offset:13312
v_exp_f32 v40, v40
v_mfma_f32_16x16x32_bf16 v[212:215], a[52:55], v[56:59], v[212:215]
ds_read_b128 a[24:27], v2 offset:14336
v_exp_f32 v41, v41
v_mfma_f32_16x16x32_bf16 v[216:219], a[56:59], v[56:59], v[216:219]
ds_read_b128 a[28:31], v2 offset:15360
s_add_u32 s101, s101, 0x2000
v_mfma_f32_16x16x32_bf16 v[248:251], a[56:59], v[60:63], v[248:251]
buffer_load_dwordx4 a[80:83], v3, s[88:91], s101 offen sc1
v_mfma_f32_16x16x32_bf16 v[252:255], a[60:63], v[60:63], v[252:255]
ds_read_b128 a[32:35], v2 offset:0
v_cvt_pk_bf16_f32 v77, v30, v31
v_mfma_f32_16x16x32_bf16 v[220:223], a[60:63], v[56:59], v[220:223]
ds_read_b128 a[36:39], v2 offset:1024
s_waitcnt lgkmcnt(6)
v_smfmac_f32_16x16x64_bf16 a[228:231], a[232:235], v[56:63], v9
buffer_load_dwordx4 a[84:87], v3, s[88:91], s101 offen offset:1024 sc1
v_mfma_f32_16x16x32_bf16 v[28:31], a[0:3], a[208:211], v[120:123]
ds_read_b128 a[40:43], v2 offset:2048
v_exp_f32 v42, v42
v_mfma_f32_16x16x32_bf16 v[28:31], a[4:7], a[212:215], v[28:31]
ds_read_b128 a[44:47], v2 offset:3072
s_add_u32 s101, s101, 0x2000
v_mfma_f32_16x16x32_bf16 v[28:31], a[8:11], a[216:219], v[28:31]
buffer_load_dwordx4 a[88:91], v3, s[88:91], s101 offen sc1
v_mfma_f32_16x16x32_bf16 v[28:31], a[12:15], a[220:223], v[28:31]
ds_read_b128 a[48:51], v2 offset:4096
s_waitcnt lgkmcnt(5)
v_exp_f32 v43, v43
v_exp_f32 v44, v44
v_exp_f32 v45, v45
v_exp_f32 v46, v46
v_exp_f32 v47, v47
v_cvt_pk_bf16_f32 v78, v44, v45
v_cvt_pk_bf16_f32 v79, v46, v47
v_mfma_f32_16x16x32_bf16 v[44:47], a[16:19], a[208:211], v[124:127]
ds_read_b128 a[52:55], v2 offset:5120
v_cvt_pk_bf16_f32 v74, v40, v41
v_mfma_f32_16x16x32_bf16 v[44:47], a[20:23], a[212:215], v[44:47]
buffer_load_dwordx4 a[92:95], v3, s[88:91], s101 offen offset:1024 sc1
v_mfma_f32_16x16x32_bf16 v[44:47], a[24:27], a[216:219], v[44:47]
ds_read_b128 a[56:59], v2 offset:6144
v_cvt_pk_bf16_f32 v75, v42, v43
v_mfma_f32_16x16x32_bf16 v[44:47], a[28:31], a[220:223], v[44:47]
ds_read_b128 a[60:63], v2 offset:7168
s_waitcnt lgkmcnt(0)
v_mfma_f32_16x16x32_bf16 v[192:195], a[32:35], v[72:75], v[192:195]
s_add_u32 s101, s101, 0x2000
v_exp_f32 v28, v28
v_mfma_f32_16x16x32_bf16 v[224:227], a[32:35], v[76:79], v[224:227]
buffer_load_dwordx4 a[96:99], v3, s[88:91], s101 offen sc1
v_mfma_f32_16x16x32_bf16 v[228:231], a[36:39], v[76:79], v[228:231]
ds_read_b128 a[32:35], v2 offset:16384
v_exp_f32 v29, v29
v_mfma_f32_16x16x32_bf16 v[196:199], a[36:39], v[72:75], v[196:199]
buffer_load_dwordx4 a[100:103], v3, s[88:91], s101 offen offset:1024 sc1
v_mfma_f32_16x16x32_bf16 v[200:203], a[40:43], v[72:75], v[200:203]
ds_read_b128 a[36:39], v2 offset:17408
s_add_u32 s101, s101, 0x2000
v_mfma_f32_16x16x32_bf16 v[232:235], a[40:43], v[76:79], v[232:235]
buffer_load_dwordx4 a[104:107], v3, s[88:91], s101 offen sc1
v_mfma_f32_16x16x32_bf16 v[236:239], a[44:47], v[76:79], v[236:239]
ds_read_b128 a[40:43], v2 offset:18432
v_exp_f32 v30, v30
v_mfma_f32_16x16x32_bf16 v[204:207], a[44:47], v[72:75], v[204:207]
buffer_load_dwordx4 a[108:111], v3, s[88:91], s101 offen offset:1024 sc1
v_mfma_f32_16x16x32_bf16 v[208:211], a[48:51], v[72:75], v[208:211]
ds_read_b128 a[44:47], v2 offset:19456
s_add_u32 s101, s101, 0x2000
v_mfma_f32_16x16x32_bf16 v[240:243], a[48:51], v[76:79], v[240:243]
buffer_load_dwordx4 a[112:115], v3, s[88:91], s101 offen sc1
v_mfma_f32_16x16x32_bf16 v[244:247], a[52:55], v[76:79], v[244:247]
ds_read_b128 a[48:51], v2 offset:20480
v_exp_f32 v31, v31
v_mfma_f32_16x16x32_bf16 v[212:215], a[52:55], v[72:75], v[212:215]
buffer_load_dwordx4 a[116:119], v3, s[88:91], s101 offen offset:1024 sc1
v_mfma_f32_16x16x32_bf16 v[216:219], a[56:59], v[72:75], v[216:219]
ds_read_b128 a[52:55], v2 offset:21504
s_add_u32 s101, s101, 0x2000
v_mfma_f32_16x16x32_bf16 v[248:251], a[56:59], v[76:79], v[248:251]
buffer_load_dwordx4 a[120:123], v3, s[88:91], s101 offen sc1
v_mfma_f32_16x16x32_bf16 v[252:255], a[60:63], v[76:79], v[252:255]
buffer_load_dwordx4 a[124:127], v3, s[88:91], s101 offen offset:1024 sc1
v_mfma_f32_16x16x32_bf16 v[220:223], a[60:63], v[72:75], v[220:223]
ds_read_b128 a[56:59], v2 offset:22528
v_cvt_pk_bf16_f32 v60, v28, v29
v_smfmac_f32_16x16x64_bf16 a[228:231], a[232:235], v[72:79], v9
ds_read_b128 a[60:63], v2 offset:23552
v_xor_b32 v2, 0x38000, v2
v_exp_f32 v44, v44
v_exp_f32 v45, v45
v_exp_f32 v46, v46
v_exp_f32 v47, v47
v_cvt_pk_bf16_f32 v61, v30, v31
v_cvt_pk_bf16_f32 v62, v44, v45
v_cvt_pk_bf16_f32 v63, v46, v47
s_waitcnt lgkmcnt(0)
s_barrier
v_accvgpr_read_b32 v6, a228
v_accvgpr_read_b32 v7, a229
v_add_f32 v6, v6, v7
v_cmp_nge_f32 vcc, 0x5f800000, v6
v_rcp_f32 v6, v6
s_or_b64 s[34:35], s[34:35], vcc
v_mfma_f32_16x16x32_bf16 v[224:227], a[32:35], v[60:63], v[224:227]
s_add_u32 s8, s30, 0x0
v_mul_f32 v192, v6, v192
v_mfma_f32_16x16x32_bf16 v[228:231], a[36:39], v[60:63], v[228:231]
v_mul_f32 v193, v6, v193
v_mul_f32 v194, v6, v194
v_mfma_f32_16x16x32_bf16 v[232:235], a[40:43], v[60:63], v[232:235]
v_mul_f32 v195, v6, v195
v_mul_f32 v196, v6, v196
v_mfma_f32_16x16x32_bf16 v[236:239], a[44:47], v[60:63], v[236:239]
v_mul_f32 v197, v6, v197
v_mul_f32 v198, v6, v198
v_mfma_f32_16x16x32_bf16 v[240:243], a[48:51], v[60:63], v[240:243]
v_mul_f32 v199, v6, v199
v_cvt_pk_bf16_f32 v192, v192, v193
v_mfma_f32_16x16x32_bf16 v[244:247], a[52:55], v[60:63], v[244:247]
v_cvt_pk_bf16_f32 v193, v194, v195
v_cvt_pk_bf16_f32 v194, v196, v197
v_mfma_f32_16x16x32_bf16 v[248:251], a[56:59], v[60:63], v[248:251]
v_cvt_pk_bf16_f32 v195, v198, v199
buffer_store_dwordx4 v[192:195], v3, s[88:91], s8 offen sc1
v_mfma_f32_16x16x32_bf16 v[252:255], a[60:63], v[60:63], v[252:255]
v_mfma_f32_16x16x32_bf16 a[228:231], a[236:239], v[60:63], a[228:231]
s_add_u32 s8, s30, 0x2000
v_pk_mul_f32 v[200:201], v[200:201], v[6:7] op_sel_hi:[1,0]
v_pk_mul_f32 v[202:203], v[202:203], v[6:7] op_sel_hi:[1,0]
v_pk_mul_f32 v[204:205], v[204:205], v[6:7] op_sel_hi:[1,0]
v_pk_mul_f32 v[206:207], v[206:207], v[6:7] op_sel_hi:[1,0]
v_cvt_pk_bf16_f32 v200, v200, v201
v_cvt_pk_bf16_f32 v201, v202, v203
v_cvt_pk_bf16_f32 v202, v204, v205
v_cvt_pk_bf16_f32 v203, v206, v207
buffer_store_dwordx4 v[200:203], v3, s[88:91], s8 offen sc1
s_add_u32 s8, s30, 0x4000
v_pk_mul_f32 v[208:209], v[208:209], v[6:7] op_sel_hi:[1,0]
v_pk_mul_f32 v[210:211], v[210:211], v[6:7] op_sel_hi:[1,0]
v_pk_mul_f32 v[212:213], v[212:213], v[6:7] op_sel_hi:[1,0]
v_pk_mul_f32 v[214:215], v[214:215], v[6:7] op_sel_hi:[1,0]
v_cvt_pk_bf16_f32 v208, v208, v209
v_cvt_pk_bf16_f32 v209, v210, v211
v_cvt_pk_bf16_f32 v210, v212, v213
v_cvt_pk_bf16_f32 v211, v214, v215
buffer_store_dwordx4 v[208:211], v3, s[88:91], s8 offen sc1
s_add_u32 s8, s30, 0x6000
v_pk_mul_f32 v[216:217], v[216:217], v[6:7] op_sel_hi:[1,0]
v_pk_mul_f32 v[218:219], v[218:219], v[6:7] op_sel_hi:[1,0]
v_pk_mul_f32 v[220:221], v[220:221], v[6:7] op_sel_hi:[1,0]
v_pk_mul_f32 v[222:223], v[222:223], v[6:7] op_sel_hi:[1,0]
v_cvt_pk_bf16_f32 v216, v216, v217
v_cvt_pk_bf16_f32 v217, v218, v219
v_cvt_pk_bf16_f32 v218, v220, v221
v_cvt_pk_bf16_f32 v219, v222, v223
buffer_store_dwordx4 v[216:219], v3, s[88:91], s8 offen sc1
L_att_fin:
v_accvgpr_read_b32 v6, a230
v_accvgpr_read_b32 v7, a231
v_add_f32 v6, v6, v7
v_cmp_nge_f32 vcc, 0x5f800000, v6
v_rcp_f32 v6, v6
s_or_b64 s[34:35], s[34:35], vcc
s_add_u32 s8, s31, 0x0
v_pk_mul_f32 v[224:225], v[224:225], v[6:7] op_sel_hi:[1,0]
v_pk_mul_f32 v[226:227], v[226:227], v[6:7] op_sel_hi:[1,0]
v_pk_mul_f32 v[228:229], v[228:229], v[6:7] op_sel_hi:[1,0]
v_pk_mul_f32 v[230:231], v[230:231], v[6:7] op_sel_hi:[1,0]
v_cvt_pk_bf16_f32 v224, v224, v225
v_cvt_pk_bf16_f32 v225, v226, v227
v_cvt_pk_bf16_f32 v226, v228, v229
v_cvt_pk_bf16_f32 v227, v230, v231
buffer_store_dwordx4 v[224:227], v3, s[88:91], s8 offen sc1
s_add_u32 s8, s31, 0x2000
v_pk_mul_f32 v[232:233], v[232:233], v[6:7] op_sel_hi:[1,0]
v_pk_mul_f32 v[234:235], v[234:235], v[6:7] op_sel_hi:[1,0]
v_pk_mul_f32 v[236:237], v[236:237], v[6:7] op_sel_hi:[1,0]
v_pk_mul_f32 v[238:239], v[238:239], v[6:7] op_sel_hi:[1,0]
v_cvt_pk_bf16_f32 v232, v232, v233
v_cvt_pk_bf16_f32 v233, v234, v235
v_cvt_pk_bf16_f32 v234, v236, v237
v_cvt_pk_bf16_f32 v235, v238, v239
buffer_store_dwordx4 v[232:235], v3, s[88:91], s8 offen sc1
s_add_u32 s8, s31, 0x4000
v_pk_mul_f32 v[240:241], v[240:241], v[6:7] op_sel_hi:[1,0]
v_pk_mul_f32 v[242:243], v[242:243], v[6:7] op_sel_hi:[1,0]
v_pk_mul_f32 v[244:245], v[244:245], v[6:7] op_sel_hi:[1,0]
v_pk_mul_f32 v[246:247], v[246:247], v[6:7] op_sel_hi:[1,0]
v_cvt_pk_bf16_f32 v240, v240, v241
v_cvt_pk_bf16_f32 v241, v242, v243
v_cvt_pk_bf16_f32 v242, v244, v245
v_cvt_pk_bf16_f32 v243, v246, v247
buffer_store_dwordx4 v[240:243], v3, s[88:91], s8 offen sc1
s_add_u32 s8, s31, 0x6000
v_pk_mul_f32 v[248:249], v[248:249], v[6:7] op_sel_hi:[1,0]
v_pk_mul_f32 v[250:251], v[250:251], v[6:7] op_sel_hi:[1,0]
v_pk_mul_f32 v[252:253], v[252:253], v[6:7] op_sel_hi:[1,0]
v_pk_mul_f32 v[254:255], v[254:255], v[6:7] op_sel_hi:[1,0]
v_cvt_pk_bf16_f32 v248, v248, v249
v_cvt_pk_bf16_f32 v249, v250, v251
v_cvt_pk_bf16_f32 v250, v252, v253
v_cvt_pk_bf16_f32 v251, v254, v255
buffer_store_dwordx4 v[248:251], v3, s[88:91], s8 offen sc1
s_cmp_lg_u64 s[34:35], 0
s_cselect_b32 s8, 1, 0
s_lshl_b32 s9, s4, 2
s_add_u32 s9, s9, 24576
v_mov_b32 v4, s9
v_mov_b32 v5, s8
ds_write_b32 v4, v5
v_lshrrev_b32 v17, 4, v0
v_lshlrev_b32 v18, 10, v17
v_and_b32 v17, 1, v17
v_lshl_add_u32 v18, v17, 5, v18
v_bfe_u32 v17, v0, 2, 2
v_lshl_add_u32 v18, v17, 6, v18
v_and_b32 v17, 3, v0
v_lshl_add_u32 v4, v17, 3, v18
s_sub_u32 s8, s16, s17
v_add_u32 v6, s8, v4
v_xor_b32 v7, 32, v6
v_add_u32 v4, 65536, v4
v_xor_b32 v5, 32, v4
v_and_b32 v20, 15, v0
v_lshlrev_b32 v20, 2, v20
s_waitcnt vmcnt(20) lgkmcnt(0)
s_barrier
v_and_b32 v17, 3, v0
v_lshlrev_b32 v17, 2, v17
v_add_u32 v17, 24576, v17
ds_read_b32 v18, v17
s_waitcnt lgkmcnt(0)
v_cmp_ne_u32 vcc, 0, v18
s_cmp_lg_u32 s33, 0
s_cbranch_scc1 L_att_done
s_nop 4
s_cbranch_vccnz L_att_fallback
L_att_done:
ds_read_b64_tr_b16 v[152:153], v4 offset:512
ds_read_b64_tr_b16 v[154:155], v4 offset:4608
ds_read_b64_tr_b16 v[156:157], v4 offset:8704
ds_read_b64_tr_b16 v[158:159], v4 offset:12800
ds_read_b64_tr_b16 v[160:161], v5 offset:512
ds_read_b64_tr_b16 v[162:163], v5 offset:4608
ds_read_b64_tr_b16 v[164:165], v5 offset:8704
ds_read_b64_tr_b16 v[166:167], v5 offset:12800
ds_read_b64_tr_b16 v[168:169], v4 offset:768
ds_read_b64_tr_b16 v[170:171], v4 offset:4864
ds_read_b64_tr_b16 v[172:173], v4 offset:8960
ds_read_b64_tr_b16 v[174:175], v4 offset:13056
ds_read_b64_tr_b16 v[176:177], v5 offset:768
ds_read_b64_tr_b16 v[178:179], v5 offset:4864
ds_read_b64_tr_b16 v[180:181], v5 offset:8960
ds_read_b64_tr_b16 v[182:183], v5 offset:13056
s_lshl_b32 s29, s99, 7
s_lshl_b32 s9, s4, 5
s_add_u32 s29, s29, s9
s_lshl_b32 s9, s29, 2
s_add_u32 s9, s9, 0x3700000
buffer_load_dword v8, v20, s[88:91], s9 offen sc1
buffer_load_dword v9, v20, s[88:91], s9 offen offset:64 sc1
s_waitcnt lgkmcnt(8)
v_mfma_f32_16x16x32_bf16 v[56:59], v[152:155], a[64:67], 0
ds_read_b64_tr_b16 v[184:185], v4 offset:0
v_mov_b32 v88, 0
v_mfma_f32_16x16x32_bf16 v[56:59], v[156:159], a[72:75], v[56:59]
ds_read_b64_tr_b16 v[186:187], v4 offset:4096
v_mov_b32 v89, 0
v_mfma_f32_16x16x32_bf16 v[72:75], v[156:159], a[76:79], 0
ds_read_b64_tr_b16 v[188:189], v4 offset:8192
v_mov_b32 v90, 0
v_mfma_f32_16x16x32_bf16 v[72:75], v[152:155], a[68:71], v[72:75]
ds_read_b64_tr_b16 v[190:191], v4 offset:12288
v_mov_b32 v91, 0
v_mfma_f32_16x16x32_bf16 v[76:79], v[160:163], a[68:71], 0
ds_read_b64_tr_b16 v[192:193], v5 offset:0
v_mfma_f32_16x16x32_bf16 v[76:79], v[164:167], a[76:79], v[76:79]
ds_read_b64_tr_b16 v[194:195], v5 offset:4096
v_mfma_f32_16x16x32_bf16 v[60:63], v[164:167], a[72:75], 0
ds_read_b64_tr_b16 v[196:197], v5 offset:8192
s_waitcnt lgkmcnt(7)
v_mfma_f32_16x16x32_bf16 v[60:63], v[160:163], a[64:67], v[60:63]
ds_read_b64_tr_b16 v[198:199], v5 offset:12288
v_mfma_f32_16x16x32_bf16 v[64:67], v[168:171], a[64:67], 0
ds_read_b64_tr_b16 v[200:201], v4 offset:256
v_mfma_f32_16x16x32_bf16 v[64:67], v[172:175], a[72:75], v[64:67]
ds_read_b64_tr_b16 v[202:203], v4 offset:4352
v_mfma_f32_16x16x32_bf16 v[80:83], v[172:175], a[76:79], 0
ds_read_b64_tr_b16 v[204:205], v4 offset:8448
v_mfma_f32_16x16x32_bf16 v[80:83], v[168:171], a[68:71], v[80:83]
ds_read_b64_tr_b16 v[206:207], v4 offset:12544
v_mfma_f32_16x16x32_bf16 v[84:87], v[176:179], a[68:71], 0
ds_read_b64_tr_b16 v[208:209], v5 offset:256
v_mfma_f32_16x16x32_bf16 v[84:87], v[180:183], a[76:79], v[84:87]
ds_read_b64_tr_b16 v[210:211], v5 offset:4352
s_waitcnt vmcnt(18) lgkmcnt(6)
v_mfma_f32_16x16x32_bf16 v[68:71], v[180:183], a[72:75], 0
ds_read_b64_tr_b16 v[212:213], v5 offset:8448
s_barrier
v_mfma_f32_16x16x32_bf16 v[68:71], v[176:179], a[64:67], v[68:71]
ds_read_b64_tr_b16 v[214:215], v5 offset:12544
v_mfma_f32_16x16x32_bf16 v[24:27], v[184:187], a[64:67], 0
ds_read_b64_tr_b16 v[152:153], v4 offset:16896
s_lshl_b32 s29, s29, 11
v_mfma_f32_16x16x32_bf16 v[24:27], v[188:191], a[72:75], v[24:27]
ds_read_b64_tr_b16 v[154:155], v4 offset:20992
s_lshl_b32 s9, s100, 8
v_mfma_f32_16x16x32_bf16 v[40:43], v[188:191], a[76:79], 0
ds_read_b64_tr_b16 v[156:157], v4 offset:25088
s_add_u32 s29, s29, s9
v_mfma_f32_16x16x32_bf16 v[40:43], v[184:187], a[68:71], v[40:43]
ds_read_b64_tr_b16 v[158:159], v4 offset:29184
s_lshl_b32 s9, s14, 7
v_mfma_f32_16x16x32_bf16 v[44:47], v[192:195], a[68:71], 0
ds_read_b64_tr_b16 v[160:161], v5 offset:16896
s_add_u32 s29, s29, s9
v_mfma_f32_16x16x32_bf16 v[44:47], v[196:199], a[76:79], v[44:47]
ds_read_b64_tr_b16 v[162:163], v5 offset:20992
s_add_u32 s31, s29, 0x8000
v_mfma_f32_16x16x32_bf16 v[28:31], v[196:199], a[72:75], 0
ds_read_b64_tr_b16 v[164:165], v5 offset:25088
s_waitcnt lgkmcnt(7)
v_mfma_f32_16x16x32_bf16 v[28:31], v[192:195], a[64:67], v[28:31]
ds_read_b64_tr_b16 v[166:167], v5 offset:29184
s_lshl_b32 s28, s2, 2
v_mfma_f32_16x16x32_bf16 v[32:35], v[200:203], a[64:67], 0
ds_read_b64_tr_b16 v[168:169], v4 offset:17152
s_add_u32 s28, s28, s4
v_mfma_f32_16x16x32_bf16 v[32:35], v[204:207], a[72:75], v[32:35]
ds_read_b64_tr_b16 v[170:171], v4 offset:21248
s_lshl_b32 s28, s28, 12
v_mfma_f32_16x16x32_bf16 v[48:51], v[204:207], a[76:79], 0
ds_read_b64_tr_b16 v[172:173], v4 offset:25344
s_add_u32 s28, s28, 0x3800000
v_mfma_f32_16x16x32_bf16 v[48:51], v[200:203], a[68:71], v[48:51]
ds_read_b64_tr_b16 v[174:175], v4 offset:29440
s_xor_b32 s30, s28, 0x4000
v_mfma_f32_16x16x32_bf16 v[52:55], v[208:211], a[68:71], 0
ds_read_b64_tr_b16 v[176:177], v5 offset:17152
v_and_b32 v18, 16, v0
v_mfma_f32_16x16x32_bf16 v[52:55], v[212:215], a[76:79], v[52:55]
ds_read_b64_tr_b16 v[178:179], v5 offset:21248
s_waitcnt lgkmcnt(6)
v_mfma_f32_16x16x32_bf16 v[36:39], v[212:215], a[72:75], 0
ds_read_b64_tr_b16 v[180:181], v5 offset:25344
v_lshrrev_b32 v19, 5, v0
v_mfma_f32_16x16x32_bf16 v[36:39], v[208:211], a[64:67], v[36:39]
ds_read_b64_tr_b16 v[182:183], v5 offset:29440
v_lshlrev_b32 v19, 4, v19
v_mfma_f32_16x16x32_bf16 v[56:59], v[152:155], a[80:83], v[56:59]
ds_read_b64_tr_b16 v[184:185], v4 offset:16384
v_mov_b32 v92, 0
v_mfma_f32_16x16x32_bf16 v[56:59], v[156:159], a[88:91], v[56:59]
ds_read_b64_tr_b16 v[186:187], v4 offset:20480
v_mov_b32 v93, 0
v_mfma_f32_16x16x32_bf16 v[72:75], v[156:159], a[92:95], v[72:75]
ds_read_b64_tr_b16 v[188:189], v4 offset:24576
v_mov_b32 v94, 0
v_mfma_f32_16x16x32_bf16 v[72:75], v[152:155], a[84:87], v[72:75]
ds_read_b64_tr_b16 v[190:191], v4 offset:28672
v_mov_b32 v95, 0
v_mfma_f32_16x16x32_bf16 v[76:79], v[160:163], a[84:87], v[76:79]
ds_read_b64_tr_b16 v[192:193], v5 offset:16384
v_lshl_add_u32 v18, v18, 1, v19
v_mfma_f32_16x16x32_bf16 v[76:79], v[164:167], a[92:95], v[76:79]
ds_read_b64_tr_b16 v[194:195], v5 offset:20480
v_lshl_add_u32 v17, v20, 9, v18
v_mfma_f32_16x16x32_bf16 v[60:63], v[164:167], a[88:91], v[60:63]
ds_read_b64_tr_b16 v[196:197], v5 offset:24576
s_waitcnt lgkmcnt(7)
v_mfma_f32_16x16x32_bf16 v[60:63], v[160:163], a[80:83], v[60:63]
ds_read_b64_tr_b16 v[198:199], v5 offset:28672
v_mfma_f32_16x16x32_bf16 v[64:67], v[168:171], a[80:83], v[64:67]
ds_read_b64_tr_b16 v[200:201], v4 offset:16640
v_mfma_f32_16x16x32_bf16 v[64:67], v[172:175], a[88:91], v[64:67]
ds_read_b64_tr_b16 v[202:203], v4 offset:20736
v_mfma_f32_16x16x32_bf16 v[80:83], v[172:175], a[92:95], v[80:83]
ds_read_b64_tr_b16 v[204:205], v4 offset:24832
v_mfma_f32_16x16x32_bf16 v[80:83], v[168:171], a[84:87], v[80:83]
ds_read_b64_tr_b16 v[206:207], v4 offset:28928
v_mfma_f32_16x16x32_bf16 v[84:87], v[176:179], a[84:87], v[84:87]
ds_read_b64_tr_b16 v[208:209], v5 offset:16640
v_mfma_f32_16x16x32_bf16 v[84:87], v[180:183], a[92:95], v[84:87]
ds_read_b64_tr_b16 v[210:211], v5 offset:20736
s_waitcnt vmcnt(2) lgkmcnt(6)
v_mfma_f32_16x16x32_bf16 v[68:71], v[180:183], a[88:91], v[68:71]
ds_read_b64_tr_b16 v[212:213], v5 offset:24832
s_barrier
v_mfma_f32_16x16x32_bf16 v[68:71], v[176:179], a[80:83], v[68:71]
ds_read_b64_tr_b16 v[214:215], v5 offset:28928
s_cmp_lg_u32 s4, 0
s_cbranch_scc1 L_flag_set
s_lshl_b32 s8, s6, 5
s_add_u32 s8, s8, s5
s_lshl_b32 s8, s8, 2
s_add_u32 s8, s8, 0x3704000
v_mov_b32 v21, 1
s_mov_b64 exec, 1
buffer_store_dword v21, off, s[88:91], s8 sc1
s_mov_b64 exec, -1
L_flag_set:
v_mfma_f32_16x16x32_bf16 v[24:27], v[184:187], a[80:83], v[24:27]
ds_read_b64_tr_b16 v[152:153], v6 offset:512
ds_read_b64_tr_b16 v[154:155], v6 offset:4608
v_mfma_f32_16x16x32_bf16 v[24:27], v[188:191], a[88:91], v[24:27]
ds_read_b64_tr_b16 v[156:157], v6 offset:8704
v_add_u32 v12, 0x20000, v12
v_mfma_f32_16x16x32_bf16 v[40:43], v[188:191], a[92:95], v[40:43]
ds_read_b64_tr_b16 v[158:159], v6 offset:12800
s_add_u32 m0, s17, 0x10000
v_mfma_f32_16x16x32_bf16 v[40:43], v[184:187], a[84:87], v[40:43]
buffer_load_dwordx4 v12, s[72:75], 0 offen lds
v_mfma_f32_16x16x32_bf16 v[44:47], v[192:195], a[84:87], v[44:47]
ds_read_b64_tr_b16 v[160:161], v7 offset:512
ds_read_b64_tr_b16 v[162:163], v7 offset:4608
v_mfma_f32_16x16x32_bf16 v[44:47], v[196:199], a[92:95], v[44:47]
ds_read_b64_tr_b16 v[164:165], v7 offset:8704
v_add_u32 v13, 0x20000, v13
v_mfma_f32_16x16x32_bf16 v[28:31], v[196:199], a[88:91], v[28:31]
ds_read_b64_tr_b16 v[166:167], v7 offset:12800
s_waitcnt lgkmcnt(8)
v_mfma_f32_16x16x32_bf16 v[28:31], v[192:195], a[80:83], v[28:31]
buffer_load_dwordx4 v13, s[72:75], 0 offen offset:1024 lds
v_mfma_f32_16x16x32_bf16 v[32:35], v[200:203], a[80:83], v[32:35]
ds_read_b64_tr_b16 v[168:169], v6 offset:768
ds_read_b64_tr_b16 v[170:171], v6 offset:4864
v_mfma_f32_16x16x32_bf16 v[32:35], v[204:207], a[88:91], v[32:35]
ds_read_b64_tr_b16 v[172:173], v6 offset:8960
v_mfma_f32_16x16x32_bf16 v[48:51], v[204:207], a[92:95], v[48:51]
ds_read_b64_tr_b16 v[174:175], v6 offset:13056
v_mfma_f32_16x16x32_bf16 v[48:51], v[200:203], a[84:87], v[48:51]
buffer_load_dwordx4 v12, s[72:75], s12 offen offset:2048 lds
v_mfma_f32_16x16x32_bf16 v[52:55], v[208:211], a[84:87], v[52:55]
ds_read_b64_tr_b16 v[176:177], v7 offset:768
ds_read_b64_tr_b16 v[178:179], v7 offset:4864
v_mfma_f32_16x16x32_bf16 v[52:55], v[212:215], a[92:95], v[52:55]
ds_read_b64_tr_b16 v[180:181], v7 offset:8960
s_waitcnt lgkmcnt(7)
v_mfma_f32_16x16x32_bf16 v[36:39], v[212:215], a[88:91], v[36:39]
ds_read_b64_tr_b16 v[182:183], v7 offset:13056
v_mfma_f32_16x16x32_bf16 v[36:39], v[208:211], a[80:83], v[36:39]
buffer_load_dwordx4 v13, s[72:75], s12 offen offset:3072 lds
v_mfma_f32_16x16x32_bf16 v[56:59], v[152:155], a[96:99], v[56:59]
ds_read_b64_tr_b16 v[184:185], v6 offset:0
ds_read_b64_tr_b16 v[186:187], v6 offset:4096
v_mfma_f32_16x16x32_bf16 v[56:59], v[156:159], a[104:107], v[56:59]
ds_read_b64_tr_b16 v[188:189], v6 offset:8192
v_mov_b32 v96, 0
v_mfma_f32_16x16x32_bf16 v[72:75], v[156:159], a[108:111], v[72:75]
ds_read_b64_tr_b16 v[190:191], v6 offset:12288
s_add_u32 s101, s101, 0x2000
v_mfma_f32_16x16x32_bf16 v[72:75], v[152:155], a[100:103], v[72:75]
buffer_load_dwordx4 a[64:67], v3, s[88:91], s101 offen sc1
v_mfma_f32_16x16x32_bf16 v[76:79], v[160:163], a[100:103], v[76:79]
ds_read_b64_tr_b16 v[192:193], v7 offset:0
ds_read_b64_tr_b16 v[194:195], v7 offset:4096
v_mfma_f32_16x16x32_bf16 v[76:79], v[164:167], a[108:111], v[76:79]
ds_read_b64_tr_b16 v[196:197], v7 offset:8192
v_mov_b32 v97, 0
v_mfma_f32_16x16x32_bf16 v[60:63], v[164:167], a[104:107], v[60:63]
ds_read_b64_tr_b16 v[198:199], v7 offset:12288
s_waitcnt lgkmcnt(8)
v_mfma_f32_16x16x32_bf16 v[60:63], v[160:163], a[96:99], v[60:63]
buffer_load_dwordx4 a[68:71], v3, s[88:91], s101 offen offset:1024 sc1
v_mfma_f32_16x16x32_bf16 v[64:67], v[168:171], a[96:99], v[64:67]
ds_read_b64_tr_b16 v[200:201], v6 offset:256
ds_read_b64_tr_b16 v[202:203], v6 offset:4352
v_mfma_f32_16x16x32_bf16 v[64:67], v[172:175], a[104:107], v[64:67]
ds_read_b64_tr_b16 v[204:205], v6 offset:8448
v_mov_b32 v98, 0
v_mfma_f32_16x16x32_bf16 v[80:83], v[172:175], a[108:111], v[80:83]
ds_read_b64_tr_b16 v[206:207], v6 offset:12544
s_add_u32 s101, s101, 0x2000
v_mfma_f32_16x16x32_bf16 v[80:83], v[168:171], a[100:103], v[80:83]
buffer_load_dwordx4 a[72:75], v3, s[88:91], s101 offen sc1
v_mfma_f32_16x16x32_bf16 v[84:87], v[176:179], a[100:103], v[84:87]
ds_read_b64_tr_b16 v[208:209], v7 offset:256
ds_read_b64_tr_b16 v[210:211], v7 offset:4352
v_mfma_f32_16x16x32_bf16 v[84:87], v[180:183], a[108:111], v[84:87]
ds_read_b64_tr_b16 v[212:213], v7 offset:8448
s_waitcnt vmcnt(17) lgkmcnt(7)
v_mfma_f32_16x16x32_bf16 v[68:71], v[180:183], a[104:107], v[68:71]
ds_read_b64_tr_b16 v[214:215], v7 offset:12544
s_barrier
v_mfma_f32_16x16x32_bf16 v[68:71], v[176:179], a[96:99], v[68:71]
buffer_load_dwordx4 a[76:79], v3, s[88:91], s101 offen offset:1024 sc1
v_mov_b32 v99, 0
v_mfma_f32_16x16x32_bf16 v[24:27], v[184:187], a[96:99], v[24:27]
ds_read_b64_tr_b16 v[152:153], v6 offset:16896
ds_read_b64_tr_b16 v[154:155], v6 offset:20992
v_mfma_f32_16x16x32_bf16 v[24:27], v[188:191], a[104:107], v[24:27]
ds_read_b64_tr_b16 v[156:157], v6 offset:25088
v_add_u32 v12, 0x20000, v12
v_mfma_f32_16x16x32_bf16 v[40:43], v[188:191], a[108:111], v[40:43]
ds_read_b64_tr_b16 v[158:159], v6 offset:29184
s_add_u32 m0, s17, 0x14000
v_mfma_f32_16x16x32_bf16 v[40:43], v[184:187], a[100:103], v[40:43]
buffer_load_dwordx4 v12, s[72:75], 0 offen lds
v_mfma_f32_16x16x32_bf16 v[44:47], v[192:195], a[100:103], v[44:47]
ds_read_b64_tr_b16 v[160:161], v7 offset:16896
ds_read_b64_tr_b16 v[162:163], v7 offset:20992
v_mfma_f32_16x16x32_bf16 v[44:47], v[196:199], a[108:111], v[44:47]
ds_read_b64_tr_b16 v[164:165], v7 offset:25088
v_add_u32 v13, 0x20000, v13
v_mfma_f32_16x16x32_bf16 v[28:31], v[196:199], a[104:107], v[28:31]
ds_read_b64_tr_b16 v[166:167], v7 offset:29184
s_waitcnt lgkmcnt(8)
v_mfma_f32_16x16x32_bf16 v[28:31], v[192:195], a[96:99], v[28:31]
buffer_load_dwordx4 v13, s[72:75], 0 offen offset:1024 lds
v_mfma_f32_16x16x32_bf16 v[32:35], v[200:203], a[96:99], v[32:35]
ds_read_b64_tr_b16 v[168:169], v6 offset:17152
ds_read_b64_tr_b16 v[170:171], v6 offset:21248
v_mfma_f32_16x16x32_bf16 v[32:35], v[204:207], a[104:107], v[32:35]
ds_read_b64_tr_b16 v[172:173], v6 offset:25344
v_mfma_f32_16x16x32_bf16 v[48:51], v[204:207], a[108:111], v[48:51]
ds_read_b64_tr_b16 v[174:175], v6 offset:29440
v_mfma_f32_16x16x32_bf16 v[48:51], v[200:203], a[100:103], v[48:51]
buffer_load_dwordx4 v12, s[72:75], s12 offen offset:2048 lds
v_mfma_f32_16x16x32_bf16 v[52:55], v[208:211], a[100:103], v[52:55]
ds_read_b64_tr_b16 v[176:177], v7 offset:17152
ds_read_b64_tr_b16 v[178:179], v7 offset:21248
v_mfma_f32_16x16x32_bf16 v[52:55], v[212:215], a[108:111], v[52:55]
ds_read_b64_tr_b16 v[180:181], v7 offset:25344
s_waitcnt lgkmcnt(7)
v_mfma_f32_16x16x32_bf16 v[36:39], v[212:215], a[104:107], v[36:39]
ds_read_b64_tr_b16 v[182:183], v7 offset:29440
v_mfma_f32_16x16x32_bf16 v[36:39], v[208:211], a[96:99], v[36:39]
buffer_load_dwordx4 v13, s[72:75], s12 offen offset:3072 lds
v_mfma_f32_16x16x32_bf16 v[56:59], v[152:155], a[112:115], v[56:59]
ds_read_b64_tr_b16 v[184:185], v6 offset:16384
ds_read_b64_tr_b16 v[186:187], v6 offset:20480
v_mfma_f32_16x16x32_bf16 v[56:59], v[156:159], a[120:123], v[56:59]
ds_read_b64_tr_b16 v[188:189], v6 offset:24576
v_mov_b32 v100, 0
v_mfma_f32_16x16x32_bf16 v[72:75], v[156:159], a[124:127], v[72:75]
ds_read_b64_tr_b16 v[190:191], v6 offset:28672
s_add_u32 s101, s101, 0x2000
v_mfma_f32_16x16x32_bf16 v[72:75], v[152:155], a[116:119], v[72:75]
buffer_load_dwordx4 a[80:83], v3, s[88:91], s101 offen sc1
v_mfma_f32_16x16x32_bf16 v[76:79], v[160:163], a[116:119], v[76:79]
ds_read_b64_tr_b16 v[192:193], v7 offset:16384
ds_read_b64_tr_b16 v[194:195], v7 offset:20480
v_mfma_f32_16x16x32_bf16 v[76:79], v[164:167], a[124:127], v[76:79]
ds_read_b64_tr_b16 v[196:197], v7 offset:24576
v_mov_b32 v101, 0
v_mfma_f32_16x16x32_bf16 v[60:63], v[164:167], a[120:123], v[60:63]
ds_read_b64_tr_b16 v[198:199], v7 offset:28672
s_waitcnt lgkmcnt(8)
v_mfma_f32_16x16x32_bf16 v[60:63], v[160:163], a[112:115], v[60:63]
buffer_load_dwordx4 a[84:87], v3, s[88:91], s101 offen offset:1024 sc1
v_mfma_f32_16x16x32_bf16 v[64:67], v[168:171], a[112:115], v[64:67]
ds_read_b64_tr_b16 v[200:201], v6 offset:16640
ds_read_b64_tr_b16 v[202:203], v6 offset:20736
v_mfma_f32_16x16x32_bf16 v[64:67], v[172:175], a[120:123], v[64:67]
ds_read_b64_tr_b16 v[204:205], v6 offset:24832
v_mov_b32 v102, 0
v_mfma_f32_16x16x32_bf16 v[80:83], v[172:175], a[124:127], v[80:83]
ds_read_b64_tr_b16 v[206:207], v6 offset:28928
s_add_u32 s101, s101, 0x2000
v_mfma_f32_16x16x32_bf16 v[80:83], v[168:171], a[116:119], v[80:83]
buffer_load_dwordx4 a[88:91], v3, s[88:91], s101 offen sc1
v_mfma_f32_16x16x32_bf16 v[84:87], v[176:179], a[116:119], v[84:87]
ds_read_b64_tr_b16 v[208:209], v7 offset:16640
ds_read_b64_tr_b16 v[210:211], v7 offset:20736
v_mfma_f32_16x16x32_bf16 v[84:87], v[180:183], a[124:127], v[84:87]
ds_read_b64_tr_b16 v[212:213], v7 offset:24832
s_waitcnt vmcnt(7) lgkmcnt(7)
v_mfma_f32_16x16x32_bf16 v[68:71], v[180:183], a[120:123], v[68:71]
ds_read_b64_tr_b16 v[214:215], v7 offset:28928
s_barrier
v_mfma_f32_16x16x32_bf16 v[68:71], v[176:179], a[112:115], v[68:71]
buffer_load_dwordx4 a[92:95], v3, s[88:91], s101 offen offset:1024 sc1
v_mov_b32 v103, 0
v_mfma_f32_16x16x32_bf16 v[24:27], v[184:187], a[112:115], v[24:27]
ds_read_b64_tr_b16 v[152:153], v4 offset:512
ds_read_b64_tr_b16 v[154:155], v4 offset:4608
v_mfma_f32_16x16x32_bf16 v[24:27], v[188:191], a[120:123], v[24:27]
ds_read_b64_tr_b16 v[156:157], v4 offset:8704
v_add_u32 v12, 0x20000, v12
v_mfma_f32_16x16x32_bf16 v[40:43], v[188:191], a[124:127], v[40:43]
ds_read_b64_tr_b16 v[158:159], v4 offset:12800
s_add_u32 m0, s16, 0x0
v_mfma_f32_16x16x32_bf16 v[40:43], v[184:187], a[116:119], v[40:43]
buffer_load_dwordx4 v12, s[72:75], 0 offen lds
v_mfma_f32_16x16x32_bf16 v[44:47], v[192:195], a[116:119], v[44:47]
ds_read_b64_tr_b16 v[160:161], v5 offset:512
ds_read_b64_tr_b16 v[162:163], v5 offset:4608
v_mfma_f32_16x16x32_bf16 v[44:47], v[196:199], a[124:127], v[44:47]
ds_read_b64_tr_b16 v[164:165], v5 offset:8704
v_add_u32 v13, 0x20000, v13
v_mfma_f32_16x16x32_bf16 v[28:31], v[196:199], a[120:123], v[28:31]
ds_read_b64_tr_b16 v[166:167], v5 offset:12800
s_waitcnt lgkmcnt(8)
v_mfma_f32_16x16x32_bf16 v[28:31], v[192:195], a[112:115], v[28:31]
buffer_load_dwordx4 v13, s[72:75], 0 offen offset:1024 lds
v_mfma_f32_16x16x32_bf16 v[32:35], v[200:203], a[112:115], v[32:35]
ds_read_b64_tr_b16 v[168:169], v4 offset:768
ds_read_b64_tr_b16 v[170:171], v4 offset:4864
v_mfma_f32_16x16x32_bf16 v[32:35], v[204:207], a[120:123], v[32:35]
ds_read_b64_tr_b16 v[172:173], v4 offset:8960
v_mfma_f32_16x16x32_bf16 v[48:51], v[204:207], a[124:127], v[48:51]
ds_read_b64_tr_b16 v[174:175], v4 offset:13056
v_mfma_f32_16x16x32_bf16 v[48:51], v[200:203], a[116:119], v[48:51]
buffer_load_dwordx4 v12, s[72:75], s12 offen offset:2048 lds
v_mfma_f32_16x16x32_bf16 v[52:55], v[208:211], a[116:119], v[52:55]
ds_read_b64_tr_b16 v[176:177], v5 offset:768
ds_read_b64_tr_b16 v[178:179], v5 offset:4864
v_mfma_f32_16x16x32_bf16 v[52:55], v[212:215], a[124:127], v[52:55]
ds_read_b64_tr_b16 v[180:181], v5 offset:8960
s_waitcnt lgkmcnt(7)
v_mfma_f32_16x16x32_bf16 v[36:39], v[212:215], a[120:123], v[36:39]
ds_read_b64_tr_b16 v[182:183], v5 offset:13056
v_mfma_f32_16x16x32_bf16 v[36:39], v[208:211], a[112:115], v[36:39]
buffer_load_dwordx4 v13, s[72:75], s12 offen offset:3072 lds
v_mfma_f32_16x16x32_bf16 v[56:59], v[152:155], a[64:67], v[56:59]
ds_read_b64_tr_b16 v[184:185], v4 offset:0
ds_read_b64_tr_b16 v[186:187], v4 offset:4096
v_mfma_f32_16x16x32_bf16 v[56:59], v[156:159], a[72:75], v[56:59]
ds_read_b64_tr_b16 v[188:189], v4 offset:8192
v_mov_b32 v104, 0
v_mfma_f32_16x16x32_bf16 v[72:75], v[156:159], a[76:79], v[72:75]
ds_read_b64_tr_b16 v[190:191], v4 offset:12288
s_add_u32 s101, s101, 0x2000
v_mfma_f32_16x16x32_bf16 v[72:75], v[152:155], a[68:71], v[72:75]
buffer_load_dwordx4 a[96:99], v3, s[88:91], s101 offen sc1
v_mfma_f32_16x16x32_bf16 v[76:79], v[160:163], a[68:71], v[76:79]
ds_read_b64_tr_b16 v[192:193], v5 offset:0
ds_read_b64_tr_b16 v[194:195], v5 offset:4096
v_mfma_f32_16x16x32_bf16 v[76:79], v[164:167], a[76:79], v[76:79]
ds_read_b64_tr_b16 v[196:197], v5 offset:8192
v_mov_b32 v105, 0
v_mfma_f32_16x16x32_bf16 v[60:63], v[164:167], a[72:75], v[60:63]
ds_read_b64_tr_b16 v[198:199], v5 offset:12288
s_waitcnt lgkmcnt(8)
v_mfma_f32_16x16x32_bf16 v[60:63], v[160:163], a[64:67], v[60:63]
buffer_load_dwordx4 a[100:103], v3, s[88:91], s101 offen offset:1024 sc1
v_mfma_f32_16x16x32_bf16 v[64:67], v[168:171], a[64:67], v[64:67]
ds_read_b64_tr_b16 v[200:201], v4 offset:256
ds_read_b64_tr_b16 v[202:203], v4 offset:4352
v_mfma_f32_16x16x32_bf16 v[64:67], v[172:175], a[72:75], v[64:67]
ds_read_b64_tr_b16 v[204:205], v4 offset:8448
v_mov_b32 v106, 0
v_mfma_f32_16x16x32_bf16 v[80:83], v[172:175], a[76:79], v[80:83]
ds_read_b64_tr_b16 v[206:207], v4 offset:12544
s_add_u32 s101, s101, 0x2000
v_mfma_f32_16x16x32_bf16 v[80:83], v[168:171], a[68:71], v[80:83]
buffer_load_dwordx4 a[104:107], v3, s[88:91], s101 offen sc1
v_mfma_f32_16x16x32_bf16 v[84:87], v[176:179], a[68:71], v[84:87]
ds_read_b64_tr_b16 v[208:209], v5 offset:256
ds_read_b64_tr_b16 v[210:211], v5 offset:4352
v_mfma_f32_16x16x32_bf16 v[84:87], v[180:183], a[76:79], v[84:87]
ds_read_b64_tr_b16 v[212:213], v5 offset:8448
s_waitcnt vmcnt(7) lgkmcnt(7)
v_mfma_f32_16x16x32_bf16 v[68:71], v[180:183], a[72:75], v[68:71]
ds_read_b64_tr_b16 v[214:215], v5 offset:12544
s_barrier
v_mfma_f32_16x16x32_bf16 v[68:71], v[176:179], a[64:67], v[68:71]
buffer_load_dwordx4 a[108:111], v3, s[88:91], s101 offen offset:1024 sc1
v_mov_b32 v107, 0
buffer_load_dword v14, v20, s[88:91], s24 offen sc1
v_mfma_f32_16x16x32_bf16 v[24:27], v[184:187], a[64:67], v[24:27]
ds_read_b64_tr_b16 v[152:153], v4 offset:16896
ds_read_b64_tr_b16 v[154:155], v4 offset:20992
v_mfma_f32_16x16x32_bf16 v[24:27], v[188:191], a[72:75], v[24:27]
ds_read_b64_tr_b16 v[156:157], v4 offset:25088
v_add_u32 v12, 0x20000, v12
v_mfma_f32_16x16x32_bf16 v[40:43], v[188:191], a[76:79], v[40:43]
ds_read_b64_tr_b16 v[158:159], v4 offset:29184
s_add_u32 m0, s16, 0x4000
v_mfma_f32_16x16x32_bf16 v[40:43], v[184:187], a[68:71], v[40:43]
buffer_load_dwordx4 v12, s[72:75], 0 offen lds
v_mfma_f32_16x16x32_bf16 v[44:47], v[192:195], a[68:71], v[44:47]
ds_read_b64_tr_b16 v[160:161], v5 offset:16896
ds_read_b64_tr_b16 v[162:163], v5 offset:20992
v_mfma_f32_16x16x32_bf16 v[44:47], v[196:199], a[76:79], v[44:47]
ds_read_b64_tr_b16 v[164:165], v5 offset:25088
v_add_u32 v13, 0x20000, v13
v_mfma_f32_16x16x32_bf16 v[28:31], v[196:199], a[72:75], v[28:31]
ds_read_b64_tr_b16 v[166:167], v5 offset:29184
s_waitcnt lgkmcnt(8)
v_mfma_f32_16x16x32_bf16 v[28:31], v[192:195], a[64:67], v[28:31]
buffer_load_dwordx4 v13, s[72:75], 0 offen offset:1024 lds
v_mfma_f32_16x16x32_bf16 v[32:35], v[200:203], a[64:67], v[32:35]
ds_read_b64_tr_b16 v[168:169], v4 offset:17152
ds_read_b64_tr_b16 v[170:171], v4 offset:21248
v_mfma_f32_16x16x32_bf16 v[32:35], v[204:207], a[72:75], v[32:35]
ds_read_b64_tr_b16 v[172:173], v4 offset:25344
v_mfma_f32_16x16x32_bf16 v[48:51], v[204:207], a[76:79], v[48:51]
ds_read_b64_tr_b16 v[174:175], v4 offset:29440
v_mfma_f32_16x16x32_bf16 v[48:51], v[200:203], a[68:71], v[48:51]
buffer_load_dwordx4 v12, s[72:75], s12 offen offset:2048 lds
v_mfma_f32_16x16x32_bf16 v[52:55], v[208:211], a[68:71], v[52:55]
ds_read_b64_tr_b16 v[176:177], v5 offset:17152
ds_read_b64_tr_b16 v[178:179], v5 offset:21248
v_mfma_f32_16x16x32_bf16 v[52:55], v[212:215], a[76:79], v[52:55]
ds_read_b64_tr_b16 v[180:181], v5 offset:25344
s_waitcnt lgkmcnt(7)
v_mfma_f32_16x16x32_bf16 v[36:39], v[212:215], a[72:75], v[36:39]
ds_read_b64_tr_b16 v[182:183], v5 offset:29440
v_mfma_f32_16x16x32_bf16 v[36:39], v[208:211], a[64:67], v[36:39]
buffer_load_dwordx4 v13, s[72:75], s12 offen offset:3072 lds
v_mfma_f32_16x16x32_bf16 v[56:59], v[152:155], a[80:83], v[56:59]
ds_read_b64_tr_b16 v[184:185], v4 offset:16384
ds_read_b64_tr_b16 v[186:187], v4 offset:20480
v_mfma_f32_16x16x32_bf16 v[56:59], v[156:159], a[88:91], v[56:59]
ds_read_b64_tr_b16 v[188:189], v4 offset:24576
v_mov_b32 v108, 0
v_mfma_f32_16x16x32_bf16 v[72:75], v[156:159], a[92:95], v[72:75]
ds_read_b64_tr_b16 v[190:191], v4 offset:28672
s_add_u32 s101, s101, 0x2000
v_mfma_f32_16x16x32_bf16 v[72:75], v[152:155], a[84:87], v[72:75]
buffer_load_dwordx4 a[112:115], v3, s[88:91], s101 offen sc1
v_mfma_f32_16x16x32_bf16 v[76:79], v[160:163], a[84:87], v[76:79]
ds_read_b64_tr_b16 v[192:193], v5 offset:16384
ds_read_b64_tr_b16 v[194:195], v5 offset:20480
v_mfma_f32_16x16x32_bf16 v[76:79], v[164:167], a[92:95], v[76:79]
ds_read_b64_tr_b16 v[196:197], v5 offset:24576
v_mov_b32 v109, 0
v_mfma_f32_16x16x32_bf16 v[60:63], v[164:167], a[88:91], v[60:63]
ds_read_b64_tr_b16 v[198:199], v5 offset:28672
s_waitcnt lgkmcnt(8)
v_mfma_f32_16x16x32_bf16 v[60:63], v[160:163], a[80:83], v[60:63]
buffer_load_dwordx4 a[116:119], v3, s[88:91], s101 offen offset:1024 sc1
v_mfma_f32_16x16x32_bf16 v[64:67], v[168:171], a[80:83], v[64:67]
ds_read_b64_tr_b16 v[200:201], v4 offset:16640
ds_read_b64_tr_b16 v[202:203], v4 offset:20736
v_mfma_f32_16x16x32_bf16 v[64:67], v[172:175], a[88:91], v[64:67]
ds_read_b64_tr_b16 v[204:205], v4 offset:24832
v_mov_b32 v110, 0
v_mfma_f32_16x16x32_bf16 v[80:83], v[172:175], a[92:95], v[80:83]
ds_read_b64_tr_b16 v[206:207], v4 offset:28928
s_add_u32 s101, s101, 0x2000
v_mfma_f32_16x16x32_bf16 v[80:83], v[168:171], a[84:87], v[80:83]
buffer_load_dwordx4 a[120:123], v3, s[88:91], s101 offen sc1
v_mfma_f32_16x16x32_bf16 v[84:87], v[176:179], a[84:87], v[84:87]
ds_read_b64_tr_b16 v[208:209], v5 offset:16640
ds_read_b64_tr_b16 v[210:211], v5 offset:20736
v_mfma_f32_16x16x32_bf16 v[84:87], v[180:183], a[92:95], v[84:87]
ds_read_b64_tr_b16 v[212:213], v5 offset:24832
s_waitcnt vmcnt(7) lgkmcnt(7)
v_mfma_f32_16x16x32_bf16 v[68:71], v[180:183], a[88:91], v[68:71]
ds_read_b64_tr_b16 v[214:215], v5 offset:28928
s_barrier
v_mfma_f32_16x16x32_bf16 v[68:71], v[176:179], a[80:83], v[68:71]
buffer_load_dwordx4 a[124:127], v3, s[88:91], s101 offen offset:1024 sc1
v_mov_b32 v111, 0
s_mov_b32 s92, 200000
L_spin_c:
v_cmp_ne_u32 vcc, 1, v14
s_nop 4
s_cbranch_vccz L_spun_c
s_sub_u32 s92, s92, 1
s_cbranch_scc1 L_spun_c
s_sleep 2
buffer_load_dword v14, v20, s[88:91], s24 offen sc1
s_waitcnt vmcnt(0)
s_branch L_spin_c
L_spun_c:
v_mfma_f32_16x16x32_bf16 v[24:27], v[184:187], a[80:83], v[24:27]
ds_read_b64_tr_b16 v[152:153], v6 offset:512
ds_read_b64_tr_b16 v[154:155], v6 offset:4608
v_mfma_f32_16x16x32_bf16 v[24:27], v[188:191], a[88:91], v[24:27]
ds_read_b64_tr_b16 v[156:157], v6 offset:8704
v_add_u32 v12, s25, v12
v_mfma_f32_16x16x32_bf16 v[40:43], v[188:191], a[92:95], v[40:43]
ds_read_b64_tr_b16 v[158:159], v6 offset:12800
s_add_u32 m0, s17, 0x10000
v_mfma_f32_16x16x32_bf16 v[40:43], v[184:187], a[84:87], v[40:43]
buffer_load_dwordx4 v12, s[64:67], 0 offen lds
v_mfma_f32_16x16x32_bf16 v[44:47], v[192:195], a[84:87], v[44:47]
ds_read_b64_tr_b16 v[160:161], v7 offset:512
ds_read_b64_tr_b16 v[162:163], v7 offset:4608
v_mfma_f32_16x16x32_bf16 v[44:47], v[196:199], a[92:95], v[44:47]
ds_read_b64_tr_b16 v[164:165], v7 offset:8704
v_add_u32 v13, s25, v13
v_mfma_f32_16x16x32_bf16 v[28:31], v[196:199], a[88:91], v[28:31]
ds_read_b64_tr_b16 v[166:167], v7 offset:12800
s_waitcnt lgkmcnt(8)
v_mfma_f32_16x16x32_bf16 v[28:31], v[192:195], a[80:83], v[28:31]
buffer_load_dwordx4 v13, s[64:67], 0 offen offset:1024 lds
v_mfma_f32_16x16x32_bf16 v[32:35], v[200:203], a[80:83], v[32:35]
ds_read_b64_tr_b16 v[168:169], v6 offset:768
ds_read_b64_tr_b16 v[170:171], v6 offset:4864
v_mfma_f32_16x16x32_bf16 v[32:35], v[204:207], a[88:91], v[32:35]
ds_read_b64_tr_b16 v[172:173], v6 offset:8960
v_mfma_f32_16x16x32_bf16 v[48:51], v[204:207], a[92:95], v[48:51]
ds_read_b64_tr_b16 v[174:175], v6 offset:13056
v_mfma_f32_16x16x32_bf16 v[48:51], v[200:203], a[84:87], v[48:51]
buffer_load_dwordx4 v12, s[64:67], s12 offen offset:2048 lds
v_mfma_f32_16x16x32_bf16 v[52:55], v[208:211], a[84:87], v[52:55]
ds_read_b64_tr_b16 v[176:177], v7 offset:768
ds_read_b64_tr_b16 v[178:179], v7 offset:4864
v_mfma_f32_16x16x32_bf16 v[52:55], v[212:215], a[92:95], v[52:55]
ds_read_b64_tr_b16 v[180:181], v7 offset:8960
s_waitcnt lgkmcnt(7)
v_mfma_f32_16x16x32_bf16 v[36:39], v[212:215], a[88:91], v[36:39]
ds_read_b64_tr_b16 v[182:183], v7 offset:13056
v_mfma_f32_16x16x32_bf16 v[36:39], v[208:211], a[80:83], v[36:39]
buffer_load_dwordx4 v13, s[64:67], s12 offen offset:3072 lds
v_mfma_f32_16x16x32_bf16 v[56:59], v[152:155], a[96:99], v[56:59]
ds_read_b64_tr_b16 v[184:185], v6 offset:0
ds_read_b64_tr_b16 v[186:187], v6 offset:4096
v_mfma_f32_16x16x32_bf16 v[56:59], v[156:159], a[104:107], v[56:59]
ds_read_b64_tr_b16 v[188:189], v6 offset:8192
v_mov_b32 v112, 0
v_mfma_f32_16x16x32_bf16 v[72:75], v[156:159], a[108:111], v[72:75]
ds_read_b64_tr_b16 v[190:191], v6 offset:12288
s_add_u32 s101, s101, s26
v_mfma_f32_16x16x32_bf16 v[72:75], v[152:155], a[100:103], v[72:75]
buffer_load_dwordx4 a[64:67], v3, s[88:91], s101 offen sc1
v_mfma_f32_16x16x32_bf16 v[76:79], v[160:163], a[100:103], v[76:79]
ds_read_b64_tr_b16 v[192:193], v7 offset:0
ds_read_b64_tr_b16 v[194:195], v7 offset:4096
v_mfma_f32_16x16x32_bf16 v[76:79], v[164:167], a[108:111], v[76:79]
ds_read_b64_tr_b16 v[196:197], v7 offset:8192
v_mov_b32 v113, 0
v_mfma_f32_16x16x32_bf16 v[60:63], v[164:167], a[104:107], v[60:63]
ds_read_b64_tr_b16 v[198:199], v7 offset:12288
s_waitcnt lgkmcnt(8)
v_mfma_f32_16x16x32_bf16 v[60:63], v[160:163], a[96:99], v[60:63]
buffer_load_dwordx4 a[68:71], v3, s[88:91], s101 offen offset:1024 sc1
v_mfma_f32_16x16x32_bf16 v[64:67], v[168:171], a[96:99], v[64:67]
ds_read_b64_tr_b16 v[200:201], v6 offset:256
ds_read_b64_tr_b16 v[202:203], v6 offset:4352
v_mfma_f32_16x16x32_bf16 v[64:67], v[172:175], a[104:107], v[64:67]
ds_read_b64_tr_b16 v[204:205], v6 offset:8448
v_mov_b32 v114, 0
v_mfma_f32_16x16x32_bf16 v[80:83], v[172:175], a[108:111], v[80:83]
ds_read_b64_tr_b16 v[206:207], v6 offset:12544
s_add_u32 s101, s101, 0x2000
v_mfma_f32_16x16x32_bf16 v[80:83], v[168:171], a[100:103], v[80:83]
buffer_load_dwordx4 a[72:75], v3, s[88:91], s101 offen sc1
v_mfma_f32_16x16x32_bf16 v[84:87], v[176:179], a[100:103], v[84:87]
ds_read_b64_tr_b16 v[208:209], v7 offset:256
ds_read_b64_tr_b16 v[210:211], v7 offset:4352
v_mfma_f32_16x16x32_bf16 v[84:87], v[180:183], a[108:111], v[84:87]
ds_read_b64_tr_b16 v[212:213], v7 offset:8448
s_waitcnt vmcnt(7) lgkmcnt(7)
v_mfma_f32_16x16x32_bf16 v[68:71], v[180:183], a[104:107], v[68:71]
ds_read_b64_tr_b16 v[214:215], v7 offset:12544
s_barrier
v_mfma_f32_16x16x32_bf16 v[68:71], v[176:179], a[96:99], v[68:71]
buffer_load_dwordx4 a[76:79], v3, s[88:91], s101 offen offset:1024 sc1
v_mov_b32 v115, 0
v_mfma_f32_16x16x32_bf16 v[24:27], v[184:187], a[96:99], v[24:27]
ds_read_b64_tr_b16 v[152:153], v6 offset:16896
ds_read_b64_tr_b16 v[154:155], v6 offset:20992
v_mfma_f32_16x16x32_bf16 v[24:27], v[188:191], a[104:107], v[24:27]
ds_read_b64_tr_b16 v[156:157], v6 offset:25088
v_add_u32 v12, 0x20000, v12
v_mfma_f32_16x16x32_bf16 v[40:43], v[188:191], a[108:111], v[40:43]
ds_read_b64_tr_b16 v[158:159], v6 offset:29184
s_add_u32 m0, s17, 0x14000
v_mfma_f32_16x16x32_bf16 v[40:43], v[184:187], a[100:103], v[40:43]
buffer_load_dwordx4 v12, s[64:67], 0 offen lds
v_mfma_f32_16x16x32_bf16 v[44:47], v[192:195], a[100:103], v[44:47]
ds_read_b64_tr_b16 v[160:161], v7 offset:16896
ds_read_b64_tr_b16 v[162:163], v7 offset:20992
v_mfma_f32_16x16x32_bf16 v[44:47], v[196:199], a[108:111], v[44:47]
ds_read_b64_tr_b16 v[164:165], v7 offset:25088
v_add_u32 v13, 0x20000, v13
v_mfma_f32_16x16x32_bf16 v[28:31], v[196:199], a[104:107], v[28:31]
ds_read_b64_tr_b16 v[166:167], v7 offset:29184
s_waitcnt lgkmcnt(8)
v_mfma_f32_16x16x32_bf16 v[28:31], v[192:195], a[96:99], v[28:31]
buffer_load_dwordx4 v13, s[64:67], 0 offen offset:1024 lds
v_mfma_f32_16x16x32_bf16 v[32:35], v[200:203], a[96:99], v[32:35]
ds_read_b64_tr_b16 v[168:169], v6 offset:17152
ds_read_b64_tr_b16 v[170:171], v6 offset:21248
v_mfma_f32_16x16x32_bf16 v[32:35], v[204:207], a[104:107], v[32:35]
ds_read_b64_tr_b16 v[172:173], v6 offset:25344
v_mfma_f32_16x16x32_bf16 v[48:51], v[204:207], a[108:111], v[48:51]
ds_read_b64_tr_b16 v[174:175], v6 offset:29440
v_mfma_f32_16x16x32_bf16 v[48:51], v[200:203], a[100:103], v[48:51]
buffer_load_dwordx4 v12, s[64:67], s12 offen offset:2048 lds
v_mfma_f32_16x16x32_bf16 v[52:55], v[208:211], a[100:103], v[52:55]
ds_read_b64_tr_b16 v[176:177], v7 offset:17152
ds_read_b64_tr_b16 v[178:179], v7 offset:21248
v_mfma_f32_16x16x32_bf16 v[52:55], v[212:215], a[108:111], v[52:55]
ds_read_b64_tr_b16 v[180:181], v7 offset:25344
s_waitcnt lgkmcnt(7)
v_mfma_f32_16x16x32_bf16 v[36:39], v[212:215], a[104:107], v[36:39]
ds_read_b64_tr_b16 v[182:183], v7 offset:29440
v_mfma_f32_16x16x32_bf16 v[36:39], v[208:211], a[96:99], v[36:39]
buffer_load_dwordx4 v13, s[64:67], s12 offen offset:3072 lds
v_mfma_f32_16x16x32_bf16 v[56:59], v[152:155], a[112:115], v[56:59]
ds_read_b64_tr_b16 v[184:185], v6 offset:16384
ds_read_b64_tr_b16 v[186:187], v6 offset:20480
v_mfma_f32_16x16x32_bf16 v[56:59], v[156:159], a[120:123], v[56:59]
ds_read_b64_tr_b16 v[188:189], v6 offset:24576
v_mov_b32 v116, 0
v_mfma_f32_16x16x32_bf16 v[72:75], v[156:159], a[124:127], v[72:75]
ds_read_b64_tr_b16 v[190:191], v6 offset:28672
s_add_u32 s101, s101, 0x2000
v_mfma_f32_16x16x32_bf16 v[72:75], v[152:155], a[116:119], v[72:75]
buffer_load_dwordx4 a[80:83], v3, s[88:91], s101 offen sc1
v_mfma_f32_16x16x32_bf16 v[76:79], v[160:163], a[116:119], v[76:79]
ds_read_b64_tr_b16 v[192:193], v7 offset:16384
ds_read_b64_tr_b16 v[194:195], v7 offset:20480
v_mfma_f32_16x16x32_bf16 v[76:79], v[164:167], a[124:127], v[76:79]
ds_read_b64_tr_b16 v[196:197], v7 offset:24576
v_mov_b32 v117, 0
v_mfma_f32_16x16x32_bf16 v[60:63], v[164:167], a[120:123], v[60:63]
ds_read_b64_tr_b16 v[198:199], v7 offset:28672
s_waitcnt lgkmcnt(8)
v_mfma_f32_16x16x32_bf16 v[60:63], v[160:163], a[112:115], v[60:63]
buffer_load_dwordx4 a[84:87], v3, s[88:91], s101 offen offset:1024 sc1
v_mfma_f32_16x16x32_bf16 v[64:67], v[168:171], a[112:115], v[64:67]
ds_read_b64_tr_b16 v[200:201], v6 offset:16640
ds_read_b64_tr_b16 v[202:203], v6 offset:20736
v_mfma_f32_16x16x32_bf16 v[64:67], v[172:175], a[120:123], v[64:67]
ds_read_b64_tr_b16 v[204:205], v6 offset:24832
v_mov_b32 v118, 0
v_mfma_f32_16x16x32_bf16 v[80:83], v[172:175], a[124:127], v[80:83]
ds_read_b64_tr_b16 v[206:207], v6 offset:28928
s_add_u32 s101, s101, 0x2000
v_mfma_f32_16x16x32_bf16 v[80:83], v[168:171], a[116:119], v[80:83]
buffer_load_dwordx4 a[88:91], v3, s[88:91], s101 offen sc1
v_mfma_f32_16x16x32_bf16 v[84:87], v[176:179], a[116:119], v[84:87]
ds_read_b64_tr_b16 v[208:209], v7 offset:16640
ds_read_b64_tr_b16 v[210:211], v7 offset:20736
v_mfma_f32_16x16x32_bf16 v[84:87], v[180:183], a[124:127], v[84:87]
ds_read_b64_tr_b16 v[212:213], v7 offset:24832
s_waitcnt vmcnt(7) lgkmcnt(7)
v_mfma_f32_16x16x32_bf16 v[68:71], v[180:183], a[120:123], v[68:71]
ds_read_b64_tr_b16 v[214:215], v7 offset:28928
s_barrier
v_mfma_f32_16x16x32_bf16 v[68:71], v[176:179], a[112:115], v[68:71]
buffer_load_dwordx4 a[92:95], v3, s[88:91], s101 offen offset:1024 sc1
v_mov_b32 v119, 0
v_mfma_f32_16x16x32_bf16 v[24:27], v[184:187], a[112:115], v[24:27]
ds_read_b64_tr_b16 v[152:153], v4 offset:512
ds_read_b64_tr_b16 v[154:155], v4 offset:4608
v_mfma_f32_16x16x32_bf16 v[24:27], v[188:191], a[120:123], v[24:27]
ds_read_b64_tr_b16 v[156:157], v4 offset:8704
v_add_u32 v12, 0x20000, v12
v_mfma_f32_16x16x32_bf16 v[40:43], v[188:191], a[124:127], v[40:43]
ds_read_b64_tr_b16 v[158:159], v4 offset:12800
s_add_u32 m0, s16, 0x0
v_mfma_f32_16x16x32_bf16 v[40:43], v[184:187], a[116:119], v[40:43]
buffer_load_dwordx4 v12, s[64:67], 0 offen lds
v_mfma_f32_16x16x32_bf16 v[44:47], v[192:195], a[116:119], v[44:47]
ds_read_b64_tr_b16 v[160:161], v5 offset:512
ds_read_b64_tr_b16 v[162:163], v5 offset:4608
v_mfma_f32_16x16x32_bf16 v[44:47], v[196:199], a[124:127], v[44:47]
ds_read_b64_tr_b16 v[164:165], v5 offset:8704
v_add_u32 v13, 0x20000, v13
v_mfma_f32_16x16x32_bf16 v[28:31], v[196:199], a[120:123], v[28:31]
ds_read_b64_tr_b16 v[166:167], v5 offset:12800
s_waitcnt lgkmcnt(8)
v_mfma_f32_16x16x32_bf16 v[28:31], v[192:195], a[112:115], v[28:31]
buffer_load_dwordx4 v13, s[64:67], 0 offen offset:1024 lds
v_mfma_f32_16x16x32_bf16 v[32:35], v[200:203], a[112:115], v[32:35]
ds_read_b64_tr_b16 v[168:169], v4 offset:768
ds_read_b64_tr_b16 v[170:171], v4 offset:4864
v_mfma_f32_16x16x32_bf16 v[32:35], v[204:207], a[120:123], v[32:35]
ds_read_b64_tr_b16 v[172:173], v4 offset:8960
v_mfma_f32_16x16x32_bf16 v[48:51], v[204:207], a[124:127], v[48:51]
ds_read_b64_tr_b16 v[174:175], v4 offset:13056
v_mfma_f32_16x16x32_bf16 v[48:51], v[200:203], a[116:119], v[48:51]
buffer_load_dwordx4 v12, s[64:67], s12 offen offset:2048 lds
v_mfma_f32_16x16x32_bf16 v[52:55], v[208:211], a[116:119], v[52:55]
ds_read_b64_tr_b16 v[176:177], v5 offset:768
ds_read_b64_tr_b16 v[178:179], v5 offset:4864
v_mfma_f32_16x16x32_bf16 v[52:55], v[212:215], a[124:127], v[52:55]
ds_read_b64_tr_b16 v[180:181], v5 offset:8960
s_waitcnt lgkmcnt(7)
v_mfma_f32_16x16x32_bf16 v[36:39], v[212:215], a[120:123], v[36:39]
ds_read_b64_tr_b16 v[182:183], v5 offset:13056
v_mfma_f32_16x16x32_bf16 v[36:39], v[208:211], a[112:115], v[36:39]
buffer_load_dwordx4 v13, s[64:67], s12 offen offset:3072 lds
v_mfma_f32_16x16x32_bf16 v[120:123], v[152:155], a[64:67], 0
ds_read_b64_tr_b16 v[184:185], v4 offset:0
ds_read_b64_tr_b16 v[186:187], v4 offset:4096
v_mfma_f32_16x16x32_bf16 v[120:123], v[156:159], a[72:75], v[120:123]
ds_read_b64_tr_b16 v[188:189], v4 offset:8192
v_mfma_f32_16x16x32_bf16 v[136:139], v[156:159], a[76:79], 0
ds_read_b64_tr_b16 v[190:191], v4 offset:12288
s_add_u32 s101, s101, 0x2000
v_mfma_f32_16x16x32_bf16 v[136:139], v[152:155], a[68:71], v[136:139]
buffer_load_dwordx4 a[96:99], v3, s[88:91], s101 offen sc1
v_mfma_f32_16x16x32_bf16 v[140:143], v[160:163], a[68:71], 0
ds_read_b64_tr_b16 v[192:193], v5 offset:0
ds_read_b64_tr_b16 v[194:195], v5 offset:4096
v_mfma_f32_16x16x32_bf16 v[140:143], v[164:167], a[76:79], v[140:143]
ds_read_b64_tr_b16 v[196:197], v5 offset:8192
v_mfma_f32_16x16x32_bf16 v[124:127], v[164:167], a[72:75], 0
ds_read_b64_tr_b16 v[198:199], v5 offset:12288
s_waitcnt lgkmcnt(8)
v_mfma_f32_16x16x32_bf16 v[124:127], v[160:163], a[64:67], v[124:127]
buffer_load_dwordx4 a[100:103], v3, s[88:91], s101 offen offset:1024 sc1
v_mfma_f32_16x16x32_bf16 v[128:131], v[168:171], a[64:67], 0
ds_read_b64_tr_b16 v[200:201], v4 offset:256
ds_read_b64_tr_b16 v[202:203], v4 offset:4352
v_mfma_f32_16x16x32_bf16 v[128:131], v[172:175], a[72:75], v[128:131]
ds_read_b64_tr_b16 v[204:205], v4 offset:8448
v_mfma_f32_16x16x32_bf16 v[144:147], v[172:175], a[76:79], 0
ds_read_b64_tr_b16 v[206:207], v4 offset:12544
s_add_u32 s101, s101, 0x2000
v_mfma_f32_16x16x32_bf16 v[144:147], v[168:171], a[68:71], v[144:147]
buffer_load_dwordx4 a[104:107], v3, s[88:91], s101 offen sc1
v_mfma_f32_16x16x32_bf16 v[148:151], v[176:179], a[68:71], 0
ds_read_b64_tr_b16 v[208:209], v5 offset:256
ds_read_b64_tr_b16 v[210:211], v5 offset:4352
v_mfma_f32_16x16x32_bf16 v[148:151], v[180:183], a[76:79], v[148:151]
ds_read_b64_tr_b16 v[212:213], v5 offset:8448
s_waitcnt vmcnt(7) lgkmcnt(7)
v_mfma_f32_16x16x32_bf16 v[132:135], v[180:183], a[72:75], 0
ds_read_b64_tr_b16 v[214:215], v5 offset:12544
s_barrier
v_mfma_f32_16x16x32_bf16 v[132:135], v[176:179], a[64:67], v[132:135]
buffer_load_dwordx4 a[108:111], v3, s[88:91], s101 offen offset:1024 sc1
s_mov_b32 s15, 7
L_p4_loop:
v_mfma_f32_16x16x32_bf16 v[88:91], v[184:187], a[64:67], v[88:91]
ds_read_b64_tr_b16 v[152:153], v4 offset:16896
ds_read_b64_tr_b16 v[154:155], v4 offset:20992
v_mfma_f32_16x16x32_bf16 v[88:91], v[188:191], a[72:75], v[88:91]
ds_read_b64_tr_b16 v[156:157], v4 offset:25088
v_add_u32 v12, 0x20000, v12
v_mfma_f32_16x16x32_bf16 v[104:107], v[188:191], a[76:79], v[104:107]
ds_read_b64_tr_b16 v[158:159], v4 offset:29184
s_add_u32 m0, s16, 0x4000
v_mfma_f32_16x16x32_bf16 v[104:107], v[184:187], a[68:71], v[104:107]
buffer_load_dwordx4 v12, s[64:67], 0 offen lds
v_mfma_f32_16x16x32_bf16 v[108:111], v[192:195], a[68:71], v[108:111]
ds_read_b64_tr_b16 v[160:161], v5 offset:16896
ds_read_b64_tr_b16 v[162:163], v5 offset:20992
v_mfma_f32_16x16x32_bf16 v[108:111], v[196:199], a[76:79], v[108:111]
ds_read_b64_tr_b16 v[164:165], v5 offset:25088
v_add_u32 v13, 0x20000, v13
v_mfma_f32_16x16x32_bf16 v[92:95], v[196:199], a[72:75], v[92:95]
ds_read_b64_tr_b16 v[166:167], v5 offset:29184
s_waitcnt lgkmcnt(8)
v_mfma_f32_16x16x32_bf16 v[92:95], v[192:195], a[64:67], v[92:95]
buffer_load_dwordx4 v13, s[64:67], 0 offen offset:1024 lds
v_mfma_f32_16x16x32_bf16 v[96:99], v[200:203], a[64:67], v[96:99]
ds_read_b64_tr_b16 v[168:169], v4 offset:17152
ds_read_b64_tr_b16 v[170:171], v4 offset:21248
v_mfma_f32_16x16x32_bf16 v[96:99], v[204:207], a[72:75], v[96:99]
ds_read_b64_tr_b16 v[172:173], v4 offset:25344
v_mfma_f32_16x16x32_bf16 v[112:115], v[204:207], a[76:79], v[112:115]
ds_read_b64_tr_b16 v[174:175], v4 offset:29440
v_mfma_f32_16x16x32_bf16 v[112:115], v[200:203], a[68:71], v[112:115]
buffer_load_dwordx4 v12, s[64:67], s12 offen offset:2048 lds
v_mfma_f32_16x16x32_bf16 v[116:119], v[208:211], a[68:71], v[116:119]
ds_read_b64_tr_b16 v[176:177], v5 offset:17152
ds_read_b64_tr_b16 v[178:179], v5 offset:21248
v_mfma_f32_16x16x32_bf16 v[116:119], v[212:215], a[76:79], v[116:119]
ds_read_b64_tr_b16 v[180:181], v5 offset:25344
s_waitcnt lgkmcnt(7)
v_mfma_f32_16x16x32_bf16 v[100:103], v[212:215], a[72:75], v[100:103]
ds_read_b64_tr_b16 v[182:183], v5 offset:29440
v_mfma_f32_16x16x32_bf16 v[100:103], v[208:211], a[64:67], v[100:103]
buffer_load_dwordx4 v13, s[64:67], s12 offen offset:3072 lds
v_mfma_f32_16x16x32_bf16 v[120:123], v[152:155], a[80:83], v[120:123]
ds_read_b64_tr_b16 v[184:185], v4 offset:16384
ds_read_b64_tr_b16 v[186:187], v4 offset:20480
v_mfma_f32_16x16x32_bf16 v[120:123], v[156:159], a[88:91], v[120:123]
ds_read_b64_tr_b16 v[188:189], v4 offset:24576
v_mfma_f32_16x16x32_bf16 v[136:139], v[156:159], a[92:95], v[136:139]
ds_read_b64_tr_b16 v[190:191], v4 offset:28672
s_add_u32 s101, s101, 0x2000
v_mfma_f32_16x16x32_bf16 v[136:139], v[152:155], a[84:87], v[136:139]
buffer_load_dwordx4 a[112:115], v3, s[88:91], s101 offen sc1
v_mfma_f32_16x16x32_bf16 v[140:143], v[160:163], a[84:87], v[140:143]
ds_read_b64_tr_b16 v[192:193], v5 offset:16384
ds_read_b64_tr_b16 v[194:195], v5 offset:20480
v_mfma_f32_16x16x32_bf16 v[140:143], v[164:167], a[92:95], v[140:143]
ds_read_b64_tr_b16 v[196:197], v5 offset:24576
v_mfma_f32_16x16x32_bf16 v[124:127], v[164:167], a[88:91], v[124:127]
ds_read_b64_tr_b16 v[198:199], v5 offset:28672
s_waitcnt lgkmcnt(8)
v_mfma_f32_16x16x32_bf16 v[124:127], v[160:163], a[80:83], v[124:127]
buffer_load_dwordx4 a[116:119], v3, s[88:91], s101 offen offset:1024 sc1
v_mfma_f32_16x16x32_bf16 v[128:131], v[168:171], a[80:83], v[128:131]
ds_read_b64_tr_b16 v[200:201], v4 offset:16640
ds_read_b64_tr_b16 v[202:203], v4 offset:20736
v_mfma_f32_16x16x32_bf16 v[128:131], v[172:175], a[88:91], v[128:131]
ds_read_b64_tr_b16 v[204:205], v4 offset:24832
v_mfma_f32_16x16x32_bf16 v[144:147], v[172:175], a[92:95], v[144:147]
ds_read_b64_tr_b16 v[206:207], v4 offset:28928
s_add_u32 s101, s101, 0x2000
v_mfma_f32_16x16x32_bf16 v[144:147], v[168:171], a[84:87], v[144:147]
buffer_load_dwordx4 a[120:123], v3, s[88:91], s101 offen sc1
v_mfma_f32_16x16x32_bf16 v[148:151], v[176:179], a[84:87], v[148:151]
ds_read_b64_tr_b16 v[208:209], v5 offset:16640
ds_read_b64_tr_b16 v[210:211], v5 offset:20736
v_mfma_f32_16x16x32_bf16 v[148:151], v[180:183], a[92:95], v[148:151]
ds_read_b64_tr_b16 v[212:213], v5 offset:24832
s_waitcnt vmcnt(7) lgkmcnt(7)
v_mfma_f32_16x16x32_bf16 v[132:135], v[180:183], a[88:91], v[132:135]
ds_read_b64_tr_b16 v[214:215], v5 offset:28928
s_barrier
v_mfma_f32_16x16x32_bf16 v[132:135], v[176:179], a[80:83], v[132:135]
buffer_load_dwordx4 a[124:127], v3, s[88:91], s101 offen offset:1024 sc1
v_mfma_f32_16x16x32_bf16 v[88:91], v[184:187], a[80:83], v[88:91]
ds_read_b64_tr_b16 v[152:153], v6 offset:512
ds_read_b64_tr_b16 v[154:155], v6 offset:4608
v_mfma_f32_16x16x32_bf16 v[88:91], v[188:191], a[88:91], v[88:91]
ds_read_b64_tr_b16 v[156:157], v6 offset:8704
v_add_u32 v12, 0x20000, v12
v_mfma_f32_16x16x32_bf16 v[104:107], v[188:191], a[92:95], v[104:107]
ds_read_b64_tr_b16 v[158:159], v6 offset:12800
s_add_u32 m0, s17, 0x10000
v_mfma_f32_16x16x32_bf16 v[104:107], v[184:187], a[84:87], v[104:107]
buffer_load_dwordx4 v12, s[64:67], 0 offen lds
v_mfma_f32_16x16x32_bf16 v[108:111], v[192:195], a[84:87], v[108:111]
ds_read_b64_tr_b16 v[160:161], v7 offset:512
ds_read_b64_tr_b16 v[162:163], v7 offset:4608
v_mfma_f32_16x16x32_bf16 v[108:111], v[196:199], a[92:95], v[108:111]
ds_read_b64_tr_b16 v[164:165], v7 offset:8704
v_add_u32 v13, 0x20000, v13
v_mfma_f32_16x16x32_bf16 v[92:95], v[196:199], a[88:91], v[92:95]
ds_read_b64_tr_b16 v[166:167], v7 offset:12800
s_waitcnt lgkmcnt(8)
v_mfma_f32_16x16x32_bf16 v[92:95], v[192:195], a[80:83], v[92:95]
buffer_load_dwordx4 v13, s[64:67], 0 offen offset:1024 lds
v_mfma_f32_16x16x32_bf16 v[96:99], v[200:203], a[80:83], v[96:99]
ds_read_b64_tr_b16 v[168:169], v6 offset:768
ds_read_b64_tr_b16 v[170:171], v6 offset:4864
v_mfma_f32_16x16x32_bf16 v[96:99], v[204:207], a[88:91], v[96:99]
ds_read_b64_tr_b16 v[172:173], v6 offset:8960
v_mfma_f32_16x16x32_bf16 v[112:115], v[204:207], a[92:95], v[112:115]
ds_read_b64_tr_b16 v[174:175], v6 offset:13056
v_mfma_f32_16x16x32_bf16 v[112:115], v[200:203], a[84:87], v[112:115]
buffer_load_dwordx4 v12, s[64:67], s12 offen offset:2048 lds
v_mfma_f32_16x16x32_bf16 v[116:119], v[208:211], a[84:87], v[116:119]
ds_read_b64_tr_b16 v[176:177], v7 offset:768
ds_read_b64_tr_b16 v[178:179], v7 offset:4864
v_mfma_f32_16x16x32_bf16 v[116:119], v[212:215], a[92:95], v[116:119]
ds_read_b64_tr_b16 v[180:181], v7 offset:8960
s_waitcnt lgkmcnt(7)
v_mfma_f32_16x16x32_bf16 v[100:103], v[212:215], a[88:91], v[100:103]
ds_read_b64_tr_b16 v[182:183], v7 offset:13056
v_mfma_f32_16x16x32_bf16 v[100:103], v[208:211], a[80:83], v[100:103]
buffer_load_dwordx4 v13, s[64:67], s12 offen offset:3072 lds
v_mfma_f32_16x16x32_bf16 v[120:123], v[152:155], a[96:99], v[120:123]
ds_read_b64_tr_b16 v[184:185], v6 offset:0
ds_read_b64_tr_b16 v[186:187], v6 offset:4096
v_mfma_f32_16x16x32_bf16 v[120:123], v[156:159], a[104:107], v[120:123]
ds_read_b64_tr_b16 v[188:189], v6 offset:8192
v_mfma_f32_16x16x32_bf16 v[136:139], v[156:159], a[108:111], v[136:139]
ds_read_b64_tr_b16 v[190:191], v6 offset:12288
s_add_u32 s101, s101, 0x2000
v_mfma_f32_16x16x32_bf16 v[136:139], v[152:155], a[100:103], v[136:139]
buffer_load_dwordx4 a[64:67], v3, s[88:91], s101 offen sc1
v_mfma_f32_16x16x32_bf16 v[140:143], v[160:163], a[100:103], v[140:143]
ds_read_b64_tr_b16 v[192:193], v7 offset:0
ds_read_b64_tr_b16 v[194:195], v7 offset:4096
v_mfma_f32_16x16x32_bf16 v[140:143], v[164:167], a[108:111], v[140:143]
ds_read_b64_tr_b16 v[196:197], v7 offset:8192
v_mfma_f32_16x16x32_bf16 v[124:127], v[164:167], a[104:107], v[124:127]
ds_read_b64_tr_b16 v[198:199], v7 offset:12288
s_waitcnt lgkmcnt(8)
v_mfma_f32_16x16x32_bf16 v[124:127], v[160:163], a[96:99], v[124:127]
buffer_load_dwordx4 a[68:71], v3, s[88:91], s101 offen offset:1024 sc1
v_mfma_f32_16x16x32_bf16 v[128:131], v[168:171], a[96:99], v[128:131]
ds_read_b64_tr_b16 v[200:201], v6 offset:256
ds_read_b64_tr_b16 v[202:203], v6 offset:4352
v_mfma_f32_16x16x32_bf16 v[128:131], v[172:175], a[104:107], v[128:131]
ds_read_b64_tr_b16 v[204:205], v6 offset:8448
v_mfma_f32_16x16x32_bf16 v[144:147], v[172:175], a[108:111], v[144:147]
ds_read_b64_tr_b16 v[206:207], v6 offset:12544
s_add_u32 s101, s101, 0x2000
v_mfma_f32_16x16x32_bf16 v[144:147], v[168:171], a[100:103], v[144:147]
buffer_load_dwordx4 a[72:75], v3, s[88:91], s101 offen sc1
v_mfma_f32_16x16x32_bf16 v[148:151], v[176:179], a[100:103], v[148:151]
ds_read_b64_tr_b16 v[208:209], v7 offset:256
ds_read_b64_tr_b16 v[210:211], v7 offset:4352
v_mfma_f32_16x16x32_bf16 v[148:151], v[180:183], a[108:111], v[148:151]
ds_read_b64_tr_b16 v[212:213], v7 offset:8448
s_waitcnt vmcnt(7) lgkmcnt(7)
v_mfma_f32_16x16x32_bf16 v[132:135], v[180:183], a[104:107], v[132:135]
ds_read_b64_tr_b16 v[214:215], v7 offset:12544
s_barrier
v_mfma_f32_16x16x32_bf16 v[132:135], v[176:179], a[96:99], v[132:135]
buffer_load_dwordx4 a[76:79], v3, s[88:91], s101 offen offset:1024 sc1
v_mfma_f32_16x16x32_bf16 v[88:91], v[184:187], a[96:99], v[88:91]
ds_read_b64_tr_b16 v[152:153], v6 offset:16896
ds_read_b64_tr_b16 v[154:155], v6 offset:20992
v_mfma_f32_16x16x32_bf16 v[88:91], v[188:191], a[104:107], v[88:91]
ds_read_b64_tr_b16 v[156:157], v6 offset:25088
v_add_u32 v12, 0x20000, v12
v_mfma_f32_16x16x32_bf16 v[104:107], v[188:191], a[108:111], v[104:107]
ds_read_b64_tr_b16 v[158:159], v6 offset:29184
s_add_u32 m0, s17, 0x14000
v_mfma_f32_16x16x32_bf16 v[104:107], v[184:187], a[100:103], v[104:107]
buffer_load_dwordx4 v12, s[64:67], 0 offen lds
v_mfma_f32_16x16x32_bf16 v[108:111], v[192:195], a[100:103], v[108:111]
ds_read_b64_tr_b16 v[160:161], v7 offset:16896
ds_read_b64_tr_b16 v[162:163], v7 offset:20992
v_mfma_f32_16x16x32_bf16 v[108:111], v[196:199], a[108:111], v[108:111]
ds_read_b64_tr_b16 v[164:165], v7 offset:25088
v_add_u32 v13, 0x20000, v13
v_mfma_f32_16x16x32_bf16 v[92:95], v[196:199], a[104:107], v[92:95]
ds_read_b64_tr_b16 v[166:167], v7 offset:29184
s_waitcnt lgkmcnt(8)
v_mfma_f32_16x16x32_bf16 v[92:95], v[192:195], a[96:99], v[92:95]
buffer_load_dwordx4 v13, s[64:67], 0 offen offset:1024 lds
v_mfma_f32_16x16x32_bf16 v[96:99], v[200:203], a[96:99], v[96:99]
ds_read_b64_tr_b16 v[168:169], v6 offset:17152
ds_read_b64_tr_b16 v[170:171], v6 offset:21248
v_mfma_f32_16x16x32_bf16 v[96:99], v[204:207], a[104:107], v[96:99]
ds_read_b64_tr_b16 v[172:173], v6 offset:25344
v_mfma_f32_16x16x32_bf16 v[112:115], v[204:207], a[108:111], v[112:115]
ds_read_b64_tr_b16 v[174:175], v6 offset:29440
v_mfma_f32_16x16x32_bf16 v[112:115], v[200:203], a[100:103], v[112:115]
buffer_load_dwordx4 v12, s[64:67], s12 offen offset:2048 lds
v_mfma_f32_16x16x32_bf16 v[116:119], v[208:211], a[100:103], v[116:119]
ds_read_b64_tr_b16 v[176:177], v7 offset:17152
ds_read_b64_tr_b16 v[178:179], v7 offset:21248
v_mfma_f32_16x16x32_bf16 v[116:119], v[212:215], a[108:111], v[116:119]
ds_read_b64_tr_b16 v[180:181], v7 offset:25344
s_waitcnt lgkmcnt(7)
v_mfma_f32_16x16x32_bf16 v[100:103], v[212:215], a[104:107], v[100:103]
ds_read_b64_tr_b16 v[182:183], v7 offset:29440
v_mfma_f32_16x16x32_bf16 v[100:103], v[208:211], a[96:99], v[100:103]
buffer_load_dwordx4 v13, s[64:67], s12 offen offset:3072 lds
v_mfma_f32_16x16x32_bf16 v[120:123], v[152:155], a[112:115], v[120:123]
ds_read_b64_tr_b16 v[184:185], v6 offset:16384
ds_read_b64_tr_b16 v[186:187], v6 offset:20480
v_mfma_f32_16x16x32_bf16 v[120:123], v[156:159], a[120:123], v[120:123]
ds_read_b64_tr_b16 v[188:189], v6 offset:24576
v_mfma_f32_16x16x32_bf16 v[136:139], v[156:159], a[124:127], v[136:139]
ds_read_b64_tr_b16 v[190:191], v6 offset:28672
s_add_u32 s101, s101, 0x2000
v_mfma_f32_16x16x32_bf16 v[136:139], v[152:155], a[116:119], v[136:139]
buffer_load_dwordx4 a[80:83], v3, s[88:91], s101 offen sc1
v_mfma_f32_16x16x32_bf16 v[140:143], v[160:163], a[116:119], v[140:143]
ds_read_b64_tr_b16 v[192:193], v7 offset:16384
ds_read_b64_tr_b16 v[194:195], v7 offset:20480
v_mfma_f32_16x16x32_bf16 v[140:143], v[164:167], a[124:127], v[140:143]
ds_read_b64_tr_b16 v[196:197], v7 offset:24576
v_mfma_f32_16x16x32_bf16 v[124:127], v[164:167], a[120:123], v[124:127]
ds_read_b64_tr_b16 v[198:199], v7 offset:28672
s_waitcnt lgkmcnt(8)
v_mfma_f32_16x16x32_bf16 v[124:127], v[160:163], a[112:115], v[124:127]
buffer_load_dwordx4 a[84:87], v3, s[88:91], s101 offen offset:1024 sc1
v_mfma_f32_16x16x32_bf16 v[128:131], v[168:171], a[112:115], v[128:131]
ds_read_b64_tr_b16 v[200:201], v6 offset:16640
ds_read_b64_tr_b16 v[202:203], v6 offset:20736
v_mfma_f32_16x16x32_bf16 v[128:131], v[172:175], a[120:123], v[128:131]
ds_read_b64_tr_b16 v[204:205], v6 offset:24832
v_mfma_f32_16x16x32_bf16 v[144:147], v[172:175], a[124:127], v[144:147]
ds_read_b64_tr_b16 v[206:207], v6 offset:28928
s_add_u32 s101, s101, 0x2000
v_mfma_f32_16x16x32_bf16 v[144:147], v[168:171], a[116:119], v[144:147]
buffer_load_dwordx4 a[88:91], v3, s[88:91], s101 offen sc1
v_mfma_f32_16x16x32_bf16 v[148:151], v[176:179], a[116:119], v[148:151]
ds_read_b64_tr_b16 v[208:209], v7 offset:16640
ds_read_b64_tr_b16 v[210:211], v7 offset:20736
v_mfma_f32_16x16x32_bf16 v[148:151], v[180:183], a[124:127], v[148:151]
ds_read_b64_tr_b16 v[212:213], v7 offset:24832
s_waitcnt vmcnt(7) lgkmcnt(7)
v_mfma_f32_16x16x32_bf16 v[132:135], v[180:183], a[120:123], v[132:135]
ds_read_b64_tr_b16 v[214:215], v7 offset:28928
s_barrier
v_mfma_f32_16x16x32_bf16 v[132:135], v[176:179], a[112:115], v[132:135]
buffer_load_dwordx4 a[92:95], v3, s[88:91], s101 offen offset:1024 sc1
v_mfma_f32_16x16x32_bf16 v[88:91], v[184:187], a[112:115], v[88:91]
ds_read_b64_tr_b16 v[152:153], v4 offset:512
ds_read_b64_tr_b16 v[154:155], v4 offset:4608
v_mfma_f32_16x16x32_bf16 v[88:91], v[188:191], a[120:123], v[88:91]
ds_read_b64_tr_b16 v[156:157], v4 offset:8704
v_add_u32 v12, 0x20000, v12
v_mfma_f32_16x16x32_bf16 v[104:107], v[188:191], a[124:127], v[104:107]
ds_read_b64_tr_b16 v[158:159], v4 offset:12800
s_add_u32 m0, s16, 0x0
v_mfma_f32_16x16x32_bf16 v[104:107], v[184:187], a[116:119], v[104:107]
buffer_load_dwordx4 v12, s[64:67], 0 offen lds
v_mfma_f32_16x16x32_bf16 v[108:111], v[192:195], a[116:119], v[108:111]
ds_read_b64_tr_b16 v[160:161], v5 offset:512
ds_read_b64_tr_b16 v[162:163], v5 offset:4608
v_mfma_f32_16x16x32_bf16 v[108:111], v[196:199], a[124:127], v[108:111]
ds_read_b64_tr_b16 v[164:165], v5 offset:8704
v_add_u32 v13, 0x20000, v13
v_mfma_f32_16x16x32_bf16 v[92:95], v[196:199], a[120:123], v[92:95]
ds_read_b64_tr_b16 v[166:167], v5 offset:12800
s_waitcnt lgkmcnt(8)
v_mfma_f32_16x16x32_bf16 v[92:95], v[192:195], a[112:115], v[92:95]
buffer_load_dwordx4 v13, s[64:67], 0 offen offset:1024 lds
v_mfma_f32_16x16x32_bf16 v[96:99], v[200:203], a[112:115], v[96:99]
ds_read_b64_tr_b16 v[168:169], v4 offset:768
ds_read_b64_tr_b16 v[170:171], v4 offset:4864
v_mfma_f32_16x16x32_bf16 v[96:99], v[204:207], a[120:123], v[96:99]
ds_read_b64_tr_b16 v[172:173], v4 offset:8960
v_mfma_f32_16x16x32_bf16 v[112:115], v[204:207], a[124:127], v[112:115]
ds_read_b64_tr_b16 v[174:175], v4 offset:13056
v_mfma_f32_16x16x32_bf16 v[112:115], v[200:203], a[116:119], v[112:115]
buffer_load_dwordx4 v12, s[64:67], s12 offen offset:2048 lds
v_mfma_f32_16x16x32_bf16 v[116:119], v[208:211], a[116:119], v[116:119]
ds_read_b64_tr_b16 v[176:177], v5 offset:768
ds_read_b64_tr_b16 v[178:179], v5 offset:4864
v_mfma_f32_16x16x32_bf16 v[116:119], v[212:215], a[124:127], v[116:119]
ds_read_b64_tr_b16 v[180:181], v5 offset:8960
s_waitcnt lgkmcnt(7)
v_mfma_f32_16x16x32_bf16 v[100:103], v[212:215], a[120:123], v[100:103]
ds_read_b64_tr_b16 v[182:183], v5 offset:13056
v_mfma_f32_16x16x32_bf16 v[100:103], v[208:211], a[112:115], v[100:103]
buffer_load_dwordx4 v13, s[64:67], s12 offen offset:3072 lds
v_mfma_f32_16x16x32_bf16 v[120:123], v[152:155], a[64:67], v[120:123]
ds_read_b64_tr_b16 v[184:185], v4 offset:0
ds_read_b64_tr_b16 v[186:187], v4 offset:4096
v_mfma_f32_16x16x32_bf16 v[120:123], v[156:159], a[72:75], v[120:123]
ds_read_b64_tr_b16 v[188:189], v4 offset:8192
v_mfma_f32_16x16x32_bf16 v[136:139], v[156:159], a[76:79], v[136:139]
ds_read_b64_tr_b16 v[190:191], v4 offset:12288
s_add_u32 s101, s101, 0x2000
v_mfma_f32_16x16x32_bf16 v[136:139], v[152:155], a[68:71], v[136:139]
buffer_load_dwordx4 a[96:99], v3, s[88:91], s101 offen sc1
v_mfma_f32_16x16x32_bf16 v[140:143], v[160:163], a[68:71], v[140:143]
ds_read_b64_tr_b16 v[192:193], v5 offset:0
ds_read_b64_tr_b16 v[194:195], v5 offset:4096
v_mfma_f32_16x16x32_bf16 v[140:143], v[164:167], a[76:79], v[140:143]
ds_read_b64_tr_b16 v[196:197], v5 offset:8192
v_mfma_f32_16x16x32_bf16 v[124:127], v[164:167], a[72:75], v[124:127]
ds_read_b64_tr_b16 v[198:199], v5 offset:12288
s_waitcnt lgkmcnt(8)
v_mfma_f32_16x16x32_bf16 v[124:127], v[160:163], a[64:67], v[124:127]
buffer_load_dwordx4 a[100:103], v3, s[88:91], s101 offen offset:1024 sc1
v_mfma_f32_16x16x32_bf16 v[128:131], v[168:171], a[64:67], v[128:131]
ds_read_b64_tr_b16 v[200:201], v4 offset:256
ds_read_b64_tr_b16 v[202:203], v4 offset:4352
v_mfma_f32_16x16x32_bf16 v[128:131], v[172:175], a[72:75], v[128:131]
ds_read_b64_tr_b16 v[204:205], v4 offset:8448
s_sub_u32 s15, s15, 1
v_mfma_f32_16x16x32_bf16 v[144:147], v[172:175], a[76:79], v[144:147]
ds_read_b64_tr_b16 v[206:207], v4 offset:12544
s_add_u32 s101, s101, 0x2000
v_mfma_f32_16x16x32_bf16 v[144:147], v[168:171], a[68:71], v[144:147]
buffer_load_dwordx4 a[104:107], v3, s[88:91], s101 offen sc1
v_mfma_f32_16x16x32_bf16 v[148:151], v[176:179], a[68:71], v[148:151]
ds_read_b64_tr_b16 v[208:209], v5 offset:256
ds_read_b64_tr_b16 v[210:211], v5 offset:4352
v_mfma_f32_16x16x32_bf16 v[148:151], v[180:183], a[76:79], v[148:151]
ds_read_b64_tr_b16 v[212:213], v5 offset:8448
s_waitcnt vmcnt(7) lgkmcnt(7)
v_mfma_f32_16x16x32_bf16 v[132:135], v[180:183], a[72:75], v[132:135]
ds_read_b64_tr_b16 v[214:215], v5 offset:12544
s_barrier
v_mfma_f32_16x16x32_bf16 v[132:135], v[176:179], a[64:67], v[132:135]
buffer_load_dwordx4 a[108:111], v3, s[88:91], s101 offen offset:1024 sc1
s_cmp_lg_u32 s15, 0
s_cbranch_scc1 L_p4_loop
v_mfma_f32_16x16x32_bf16 v[88:91], v[184:187], a[64:67], v[88:91]
ds_read_b64_tr_b16 v[152:153], v4 offset:16896
ds_read_b64_tr_b16 v[154:155], v4 offset:20992
s_add_u32 m0, s16, 0x4000
v_add_u32 v12, 0x20000, v12
v_mfma_f32_16x16x32_bf16 v[88:91], v[188:191], a[72:75], v[88:91]
buffer_load_dwordx4 v12, s[64:67], 0 offen lds
v_mfma_f32_16x16x32_bf16 v[104:107], v[188:191], a[76:79], v[104:107]
ds_read_b64_tr_b16 v[156:157], v4 offset:25088
ds_read_b64_tr_b16 v[158:159], v4 offset:29184
v_add_u32 v13, 0x20000, v13
v_mfma_f32_16x16x32_bf16 v[104:107], v[184:187], a[68:71], v[104:107]
buffer_load_dwordx4 v13, s[64:67], 0 offen offset:1024 lds
v_mfma_f32_16x16x32_bf16 v[108:111], v[192:195], a[68:71], v[108:111]
ds_read_b64_tr_b16 v[160:161], v5 offset:16896
ds_read_b64_tr_b16 v[162:163], v5 offset:20992
v_mfma_f32_16x16x32_bf16 v[108:111], v[196:199], a[76:79], v[108:111]
buffer_load_dwordx4 v12, s[64:67], s12 offen offset:2048 lds
v_mfma_f32_16x16x32_bf16 v[92:95], v[196:199], a[72:75], v[92:95]
ds_read_b64_tr_b16 v[164:165], v5 offset:25088
ds_read_b64_tr_b16 v[166:167], v5 offset:29184
s_waitcnt lgkmcnt(8)
v_mfma_f32_16x16x32_bf16 v[92:95], v[192:195], a[64:67], v[92:95]
buffer_load_dwordx4 v13, s[64:67], s12 offen offset:3072 lds
v_mfma_f32_16x16x32_bf16 v[96:99], v[200:203], a[64:67], v[96:99]
ds_read_b64_tr_b16 v[168:169], v4 offset:17152
ds_read_b64_tr_b16 v[170:171], v4 offset:21248
s_add_u32 s101, s101, 0x2000
v_mfma_f32_16x16x32_bf16 v[96:99], v[204:207], a[72:75], v[96:99]
buffer_load_dwordx4 a[112:115], v3, s[88:91], s101 offen sc1
v_mfma_f32_16x16x32_bf16 v[112:115], v[204:207], a[76:79], v[112:115]
ds_read_b64_tr_b16 v[172:173], v4 offset:25344
ds_read_b64_tr_b16 v[174:175], v4 offset:29440
v_mfma_f32_16x16x32_bf16 v[112:115], v[200:203], a[68:71], v[112:115]
buffer_load_dwordx4 a[116:119], v3, s[88:91], s101 offen offset:1024 sc1
v_mfma_f32_16x16x32_bf16 v[116:119], v[208:211], a[68:71], v[116:119]
ds_read_b64_tr_b16 v[176:177], v5 offset:17152
ds_read_b64_tr_b16 v[178:179], v5 offset:21248
s_add_u32 s101, s101, 0x2000
v_mfma_f32_16x16x32_bf16 v[116:119], v[212:215], a[76:79], v[116:119]
buffer_load_dwordx4 a[120:123], v3, s[88:91], s101 offen sc1
s_waitcnt vmcnt(7) lgkmcnt(6)
v_mfma_f32_16x16x32_bf16 v[100:103], v[212:215], a[72:75], v[100:103]
ds_read_b64_tr_b16 v[180:181], v5 offset:25344
ds_read_b64_tr_b16 v[182:183], v5 offset:29440
s_barrier
v_mfma_f32_16x16x32_bf16 v[100:103], v[208:211], a[64:67], v[100:103]
buffer_load_dwordx4 a[124:127], v3, s[88:91], s101 offen offset:1024 sc1
v_mfma_f32_16x16x32_bf16 v[120:123], v[152:155], a[80:83], v[120:123]
ds_read_b64_tr_b16 v[184:185], v6 offset:512
v_sub_f32 v10, 1.0, v8
v_mfma_f32_16x16x32_bf16 v[120:123], v[156:159], a[88:91], v[120:123]
ds_read_b64_tr_b16 v[186:187], v6 offset:4608
v_sub_f32 v11, 1.0, v9
v_mfma_f32_16x16x32_bf16 v[136:139], v[156:159], a[92:95], v[136:139]
ds_read_b64_tr_b16 v[188:189], v6 offset:8704
v_mul_f32 v56, v10, v56
v_mfma_f32_16x16x32_bf16 v[136:139], v[152:155], a[84:87], v[136:139]
ds_read_b64_tr_b16 v[190:191], v6 offset:12800
v_mul_f32 v57, v10, v57
v_mfma_f32_16x16x32_bf16 v[140:143], v[160:163], a[84:87], v[140:143]
ds_read_b64_tr_b16 v[192:193], v7 offset:512
v_mul_f32 v58, v10, v58
v_mfma_f32_16x16x32_bf16 v[140:143], v[164:167], a[92:95], v[140:143]
ds_read_b64_tr_b16 v[194:195], v7 offset:4608
v_mul_f32 v59, v10, v59
v_mfma_f32_16x16x32_bf16 v[124:127], v[164:167], a[88:91], v[124:127]
ds_read_b64_tr_b16 v[196:197], v7 offset:8704
s_waitcnt lgkmcnt(7)
v_mfma_f32_16x16x32_bf16 v[124:127], v[160:163], a[80:83], v[124:127]
ds_read_b64_tr_b16 v[198:199], v7 offset:12800
v_mul_f32 v60, v10, v60
v_mfma_f32_16x16x32_bf16 v[128:131], v[168:171], a[80:83], v[128:131]
ds_read_b64_tr_b16 v[200:201], v6 offset:768
v_mul_f32 v61, v10, v61
v_mfma_f32_16x16x32_bf16 v[128:131], v[172:175], a[88:91], v[128:131]
ds_read_b64_tr_b16 v[202:203], v6 offset:4864
v_mul_f32 v62, v10, v62
v_mfma_f32_16x16x32_bf16 v[144:147], v[172:175], a[92:95], v[144:147]
ds_read_b64_tr_b16 v[204:205], v6 offset:8960
v_mul_f32 v63, v10, v63
v_mfma_f32_16x16x32_bf16 v[144:147], v[168:171], a[84:87], v[144:147]
ds_read_b64_tr_b16 v[206:207], v6 offset:13056
v_mul_f32 v64, v10, v64
v_mfma_f32_16x16x32_bf16 v[148:151], v[176:179], a[84:87], v[148:151]
ds_read_b64_tr_b16 v[208:209], v7 offset:768
v_mul_f32 v65, v10, v65
v_mfma_f32_16x16x32_bf16 v[148:151], v[180:183], a[92:95], v[148:151]
ds_read_b64_tr_b16 v[210:211], v7 offset:4864
s_waitcnt vmcnt(0) lgkmcnt(6)
v_mfma_f32_16x16x32_bf16 v[132:135], v[180:183], a[88:91], v[132:135]
ds_read_b64_tr_b16 v[212:213], v7 offset:8960
s_barrier
v_mfma_f32_16x16x32_bf16 v[132:135], v[176:179], a[80:83], v[132:135]
ds_read_b64_tr_b16 v[214:215], v7 offset:13056
v_mul_f32 v66, v10, v66
v_mul_f32 v67, v10, v67
v_mfma_f32_16x16x32_bf16 v[120:123], v[184:187], a[96:99], v[120:123]
ds_read_b64_tr_b16 v[152:153], v6 offset:16896
v_mul_f32 v68, v10, v68
v_mfma_f32_16x16x32_bf16 v[120:123], v[188:191], a[104:107], v[120:123]
ds_read_b64_tr_b16 v[154:155], v6 offset:20992
v_mul_f32 v69, v10, v69
v_mfma_f32_16x16x32_bf16 v[136:139], v[188:191], a[108:111], v[136:139]
ds_read_b64_tr_b16 v[156:157], v6 offset:25088
v_mul_f32 v70, v10, v70
v_mfma_f32_16x16x32_bf16 v[136:139], v[184:187], a[100:103], v[136:139]
ds_read_b64_tr_b16 v[158:159], v6 offset:29184
v_mul_f32 v71, v10, v71
v_mfma_f32_16x16x32_bf16 v[140:143], v[192:195], a[100:103], v[140:143]
ds_read_b64_tr_b16 v[160:161], v7 offset:16896
v_mul_f32 v72, v11, v72
v_mfma_f32_16x16x32_bf16 v[140:143], v[196:199], a[108:111], v[140:143]
ds_read_b64_tr_b16 v[162:163], v7 offset:20992
v_mul_f32 v73, v11, v73
v_mfma_f32_16x16x32_bf16 v[124:127], v[196:199], a[104:107], v[124:127]
ds_read_b64_tr_b16 v[164:165], v7 offset:25088
s_waitcnt lgkmcnt(7)
v_mfma_f32_16x16x32_bf16 v[124:127], v[192:195], a[96:99], v[124:127]
ds_read_b64_tr_b16 v[166:167], v7 offset:29184
v_mul_f32 v74, v11, v74
v_mfma_f32_16x16x32_bf16 v[128:131], v[200:203], a[96:99], v[128:131]
ds_read_b64_tr_b16 v[168:169], v6 offset:17152
v_mul_f32 v75, v11, v75
v_mfma_f32_16x16x32_bf16 v[128:131], v[204:207], a[104:107], v[128:131]
ds_read_b64_tr_b16 v[170:171], v6 offset:21248
v_mul_f32 v76, v11, v76
v_mfma_f32_16x16x32_bf16 v[144:147], v[204:207], a[108:111], v[144:147]
ds_read_b64_tr_b16 v[172:173], v6 offset:25344
v_mul_f32 v77, v11, v77
v_mfma_f32_16x16x32_bf16 v[144:147], v[200:203], a[100:103], v[144:147]
ds_read_b64_tr_b16 v[174:175], v6 offset:29440
v_mul_f32 v78, v11, v78
v_mfma_f32_16x16x32_bf16 v[148:151], v[208:211], a[100:103], v[148:151]
ds_read_b64_tr_b16 v[176:177], v7 offset:17152
v_mul_f32 v79, v11, v79
v_mfma_f32_16x16x32_bf16 v[148:151], v[212:215], a[108:111], v[148:151]
ds_read_b64_tr_b16 v[178:179], v7 offset:21248
s_waitcnt lgkmcnt(6)
v_mfma_f32_16x16x32_bf16 v[132:135], v[212:215], a[104:107], v[132:135]
ds_read_b64_tr_b16 v[180:181], v7 offset:25344
v_mul_f32 v80, v11, v80
v_mfma_f32_16x16x32_bf16 v[132:135], v[208:211], a[96:99], v[132:135]
ds_read_b64_tr_b16 v[182:183], v7 offset:29440
v_mul_f32 v81, v11, v81
v_mfma_f32_16x16x32_bf16 v[120:123], v[152:155], a[112:115], v[120:123]
ds_read_b64_tr_b16 v[184:185], v4 offset:16384
v_mul_f32 v82, v11, v82
v_mfma_f32_16x16x32_bf16 v[120:123], v[156:159], a[120:123], v[120:123]
ds_read_b64_tr_b16 v[186:187], v4 offset:20480
v_mul_f32 v83, v11, v83
v_mfma_f32_16x16x32_bf16 v[136:139], v[156:159], a[124:127], v[136:139]
ds_read_b64_tr_b16 v[188:189], v4 offset:24576
v_mul_f32 v84, v11, v84
v_mfma_f32_16x16x32_bf16 v[136:139], v[152:155], a[116:119], v[136:139]
ds_read_b64_tr_b16 v[190:191], v4 offset:28672
v_mul_f32 v85, v11, v85
v_mfma_f32_16x16x32_bf16 v[140:143], v[160:163], a[116:119], v[140:143]
ds_read_b64_tr_b16 v[192:193], v5 offset:16384
v_mul_f32 v86, v11, v86
v_mfma_f32_16x16x32_bf16 v[140:143], v[164:167], a[124:127], v[140:143]
ds_read_b64_tr_b16 v[194:195], v5 offset:20480
v_mul_f32 v87, v11, v87
v_mfma_f32_16x16x32_bf16 v[124:127], v[164:167], a[120:123], v[124:127]
ds_read_b64_tr_b16 v[196:197], v5 offset:24576
s_waitcnt lgkmcnt(7)
v_mfma_f32_16x16x32_bf16 v[124:127], v[160:163], a[112:115], v[124:127]
ds_read_b64_tr_b16 v[198:199], v5 offset:28672
v_mul_f32 v24, v10, v24
v_mfma_f32_16x16x32_bf16 v[128:131], v[168:171], a[112:115], v[128:131]
ds_read_b64_tr_b16 v[200:201], v4 offset:16640
v_mul_f32 v25, v10, v25
v_mfma_f32_16x16x32_bf16 v[128:131], v[172:175], a[120:123], v[128:131]
ds_read_b64_tr_b16 v[202:203], v4 offset:20736
v_mul_f32 v26, v10, v26
v_mfma_f32_16x16x32_bf16 v[144:147], v[172:175], a[124:127], v[144:147]
ds_read_b64_tr_b16 v[204:205], v4 offset:24832
v_mul_f32 v27, v10, v27
v_mfma_f32_16x16x32_bf16 v[144:147], v[168:171], a[116:119], v[144:147]
ds_read_b64_tr_b16 v[206:207], v4 offset:28928
v_mul_f32 v28, v10, v28
v_mfma_f32_16x16x32_bf16 v[148:151], v[176:179], a[116:119], v[148:151]
ds_read_b64_tr_b16 v[208:209], v5 offset:16640
v_mul_f32 v29, v10, v29
v_mfma_f32_16x16x32_bf16 v[148:151], v[180:183], a[124:127], v[148:151]
ds_read_b64_tr_b16 v[210:211], v5 offset:20736
s_waitcnt lgkmcnt(6)
v_mfma_f32_16x16x32_bf16 v[132:135], v[180:183], a[120:123], v[132:135]
ds_read_b64_tr_b16 v[212:213], v5 offset:24832
v_mul_f32 v30, v10, v30
v_mfma_f32_16x16x32_bf16 v[132:135], v[176:179], a[112:115], v[132:135]
ds_read_b64_tr_b16 v[214:215], v5 offset:28928
v_mul_f32 v31, v10, v31
v_mfma_f32_16x16x32_bf16 v[88:91], v[184:187], a[80:83], v[88:91]
ds_read_b64_tr_b16 v[152:153], v6 offset:0
v_mfma_f32_16x16x32_bf16 v[88:91], v[188:191], a[88:91], v[88:91]
ds_read_b64_tr_b16 v[154:155], v6 offset:4096
v_mfma_f32_16x16x32_bf16 v[104:107], v[188:191], a[92:95], v[104:107]
ds_read_b64_tr_b16 v[156:157], v6 offset:8192
v_mfma_f32_16x16x32_bf16 v[104:107], v[184:187], a[84:87], v[104:107]
ds_read_b64_tr_b16 v[158:159], v6 offset:12288
v_fmac_f32 v56, v8, v120
v_fmac_f32 v57, v8, v121
v_fmac_f32 v58, v8, v122
v_fmac_f32 v59, v8, v123
v_mfma_f32_16x16x32_bf16 v[108:111], v[192:195], a[84:87], v[108:111]
ds_read_b64_tr_b16 v[160:161], v7 offset:0
v_fmac_f32 v60, v8, v124
v_fmac_f32 v61, v8, v125
v_fmac_f32 v62, v8, v126
v_fmac_f32 v63, v8, v127
v_mfma_f32_16x16x32_bf16 v[108:111], v[196:199], a[92:95], v[108:111]
ds_read_b64_tr_b16 v[162:163], v7 offset:4096
v_cvt_pk_bf16_f32 v56, v56, v57
v_cvt_pk_bf16_f32 v57, v58, v59
v_cvt_pk_bf16_f32 v58, v60, v61
v_cvt_pk_bf16_f32 v59, v62, v63
v_mfma_f32_16x16x32_bf16 v[92:95], v[196:199], a[88:91], v[92:95]
ds_read_b64_tr_b16 v[164:165], v7 offset:8192
s_waitcnt lgkmcnt(7)
buffer_store_dwordx4 v[56:59], v3, s[88:91], s30 offen offset:0 sc1
v_fmac_f32 v64, v8, v128
v_fmac_f32 v65, v8, v129
v_fmac_f32 v66, v8, v130
v_mfma_f32_16x16x32_bf16 v[92:95], v[192:195], a[80:83], v[92:95]
ds_read_b64_tr_b16 v[166:167], v7 offset:12288
v_fmac_f32 v67, v8, v131
v_fmac_f32 v68, v8, v132
v_fmac_f32 v69, v8, v133
v_fmac_f32 v70, v8, v134
v_mfma_f32_16x16x32_bf16 v[96:99], v[200:203], a[80:83], v[96:99]
ds_read_b64_tr_b16 v[168:169], v6 offset:256
v_fmac_f32 v71, v8, v135
v_cvt_pk_bf16_f32 v64, v64, v65
v_cvt_pk_bf16_f32 v65, v66, v67
v_cvt_pk_bf16_f32 v66, v68, v69
v_mfma_f32_16x16x32_bf16 v[96:99], v[204:207], a[88:91], v[96:99]
ds_read_b64_tr_b16 v[170:171], v6 offset:4352
v_cvt_pk_bf16_f32 v67, v70, v71
buffer_store_dwordx4 v[64:67], v3, s[88:91], s30 offen offset:1024 sc1
v_fmac_f32 v72, v9, v136
v_fmac_f32 v73, v9, v137
v_mfma_f32_16x16x32_bf16 v[112:115], v[204:207], a[92:95], v[112:115]
ds_read_b64_tr_b16 v[172:173], v6 offset:8448
v_fmac_f32 v74, v9, v138
v_fmac_f32 v75, v9, v139
v_fmac_f32 v76, v9, v140
v_fmac_f32 v77, v9, v141
v_mfma_f32_16x16x32_bf16 v[112:115], v[200:203], a[84:87], v[112:115]
ds_read_b64_tr_b16 v[174:175], v6 offset:12544
v_fmac_f32 v78, v9, v142
v_fmac_f32 v79, v9, v143
v_cvt_pk_bf16_f32 v72, v72, v73
v_cvt_pk_bf16_f32 v73, v74, v75
v_mfma_f32_16x16x32_bf16 v[116:119], v[208:211], a[84:87], v[116:119]
ds_read_b64_tr_b16 v[176:177], v7 offset:256
v_cvt_pk_bf16_f32 v74, v76, v77
v_cvt_pk_bf16_f32 v75, v78, v79
buffer_store_dwordx4 v[72:75], v3, s[88:91], s30 offen offset:2048 sc1
v_fmac_f32 v80, v9, v144
v_mfma_f32_16x16x32_bf16 v[116:119], v[212:215], a[92:95], v[116:119]
ds_read_b64_tr_b16 v[178:179], v7 offset:4352
s_waitcnt lgkmcnt(6)
v_fmac_f32 v81, v9, v145
v_fmac_f32 v82, v9, v146
v_fmac_f32 v83, v9, v147
v_fmac_f32 v84, v9, v148
v_mfma_f32_16x16x32_bf16 v[100:103], v[212:215], a[88:91], v[100:103]
ds_read_b64_tr_b16 v[180:181], v7 offset:8448
v_fmac_f32 v85, v9, v149
v_fmac_f32 v86, v9, v150
v_fmac_f32 v87, v9, v151
v_cvt_pk_bf16_f32 v80, v80, v81
v_mfma_f32_16x16x32_bf16 v[100:103], v[208:211], a[80:83], v[100:103]
ds_read_b64_tr_b16 v[182:183], v7 offset:12544
v_cvt_pk_bf16_f32 v81, v82, v83
v_cvt_pk_bf16_f32 v82, v84, v85
v_cvt_pk_bf16_f32 v83, v86, v87
buffer_store_dwordx4 v[80:83], v3, s[88:91], s30 offen offset:3072 sc1
v_mfma_f32_16x16x32_bf16 v[88:91], v[152:155], a[96:99], v[88:91]
ds_read_b64_tr_b16 v[184:185], v6 offset:16384
v_mul_f32 v32, v10, v32
v_mfma_f32_16x16x32_bf16 v[88:91], v[156:159], a[104:107], v[88:91]
ds_read_b64_tr_b16 v[186:187], v6 offset:20480
v_mul_f32 v33, v10, v33
v_mfma_f32_16x16x32_bf16 v[104:107], v[156:159], a[108:111], v[104:107]
ds_read_b64_tr_b16 v[188:189], v6 offset:24576
v_mul_f32 v34, v10, v34
v_mfma_f32_16x16x32_bf16 v[104:107], v[152:155], a[100:103], v[104:107]
ds_read_b64_tr_b16 v[190:191], v6 offset:28672
v_mul_f32 v35, v10, v35
v_mfma_f32_16x16x32_bf16 v[108:111], v[160:163], a[100:103], v[108:111]
ds_read_b64_tr_b16 v[192:193], v7 offset:16384
v_mul_f32 v36, v10, v36
v_mfma_f32_16x16x32_bf16 v[108:111], v[164:167], a[108:111], v[108:111]
ds_read_b64_tr_b16 v[194:195], v7 offset:20480
v_mul_f32 v37, v10, v37
v_mfma_f32_16x16x32_bf16 v[92:95], v[164:167], a[104:107], v[92:95]
ds_read_b64_tr_b16 v[196:197], v7 offset:24576
s_waitcnt lgkmcnt(7)
v_mfma_f32_16x16x32_bf16 v[92:95], v[160:163], a[96:99], v[92:95]
ds_read_b64_tr_b16 v[198:199], v7 offset:28672
v_mul_f32 v38, v10, v38
v_mfma_f32_16x16x32_bf16 v[96:99], v[168:171], a[96:99], v[96:99]
ds_read_b64_tr_b16 v[200:201], v6 offset:16640
v_mul_f32 v39, v10, v39
v_mfma_f32_16x16x32_bf16 v[96:99], v[172:175], a[104:107], v[96:99]
ds_read_b64_tr_b16 v[202:203], v6 offset:20736
v_mul_f32 v40, v11, v40
v_mfma_f32_16x16x32_bf16 v[112:115], v[172:175], a[108:111], v[112:115]
ds_read_b64_tr_b16 v[204:205], v6 offset:24832
v_mul_f32 v41, v11, v41
v_mfma_f32_16x16x32_bf16 v[112:115], v[168:171], a[100:103], v[112:115]
ds_read_b64_tr_b16 v[206:207], v6 offset:28928
v_mul_f32 v42, v11, v42
v_mfma_f32_16x16x32_bf16 v[116:119], v[176:179], a[100:103], v[116:119]
ds_read_b64_tr_b16 v[208:209], v7 offset:16640
v_mul_f32 v43, v11, v43
v_mfma_f32_16x16x32_bf16 v[116:119], v[180:183], a[108:111], v[116:119]
ds_read_b64_tr_b16 v[210:211], v7 offset:20736
s_waitcnt lgkmcnt(6)
v_mfma_f32_16x16x32_bf16 v[100:103], v[180:183], a[104:107], v[100:103]
ds_read_b64_tr_b16 v[212:213], v7 offset:24832
v_mul_f32 v44, v11, v44
v_mfma_f32_16x16x32_bf16 v[100:103], v[176:179], a[96:99], v[100:103]
ds_read_b64_tr_b16 v[214:215], v7 offset:28928
v_mul_f32 v45, v11, v45
v_mfma_f32_16x16x32_bf16 v[88:91], v[184:187], a[112:115], v[88:91]
v_mul_f32 v46, v11, v46
v_mul_f32 v47, v11, v47
v_mfma_f32_16x16x32_bf16 v[88:91], v[188:191], a[120:123], v[88:91]
v_mul_f32 v48, v11, v48
v_mul_f32 v49, v11, v49
v_mfma_f32_16x16x32_bf16 v[104:107], v[188:191], a[124:127], v[104:107]
v_mul_f32 v50, v11, v50
v_mul_f32 v51, v11, v51
v_mfma_f32_16x16x32_bf16 v[104:107], v[184:187], a[116:119], v[104:107]
v_mul_f32 v52, v11, v52
v_mul_f32 v53, v11, v53
v_mfma_f32_16x16x32_bf16 v[108:111], v[192:195], a[116:119], v[108:111]
v_mul_f32 v54, v11, v54
v_mul_f32 v55, v11, v55
v_mfma_f32_16x16x32_bf16 v[108:111], v[196:199], a[124:127], v[108:111]
v_mfma_f32_16x16x32_bf16 v[92:95], v[196:199], a[120:123], v[92:95]
s_waitcnt lgkmcnt(0)
v_mfma_f32_16x16x32_bf16 v[92:95], v[192:195], a[112:115], v[92:95]
v_mfma_f32_16x16x32_bf16 v[96:99], v[200:203], a[112:115], v[96:99]
v_mfma_f32_16x16x32_bf16 v[96:99], v[204:207], a[120:123], v[96:99]
v_mfma_f32_16x16x32_bf16 v[112:115], v[204:207], a[124:127], v[112:115]
v_mfma_f32_16x16x32_bf16 v[112:115], v[200:203], a[116:119], v[112:115]
v_mfma_f32_16x16x32_bf16 v[116:119], v[208:211], a[116:119], v[116:119]
v_mfma_f32_16x16x32_bf16 v[116:119], v[212:215], a[124:127], v[116:119]
v_mfma_f32_16x16x32_bf16 v[100:103], v[212:215], a[120:123], v[100:103]
v_mfma_f32_16x16x32_bf16 v[100:103], v[208:211], a[112:115], v[100:103]
buffer_load_dwordx4 v[152:155], v3, s[88:91], s28 offen offset:0 sc1
buffer_load_dwordx4 v[156:159], v3, s[88:91], s28 offen offset:1024 sc1
buffer_load_dwordx4 v[160:163], v3, s[88:91], s28 offen offset:2048 sc1
buffer_load_dwordx4 v[164:167], v3, s[88:91], s28 offen offset:3072 sc1
v_fmac_f32 v24, v8, v88
v_fmac_f32 v25, v8, v89
v_fmac_f32 v26, v8, v90
v_fmac_f32 v27, v8, v91
v_fmac_f32 v28, v8, v92
v_fmac_f32 v29, v8, v93
v_fmac_f32 v30, v8, v94
v_fmac_f32 v31, v8, v95
v_fmac_f32 v32, v8, v96
v_fmac_f32 v33, v8, v97
v_fmac_f32 v34, v8, v98
v_fmac_f32 v35, v8, v99
v_fmac_f32 v36, v8, v100
v_fmac_f32 v37, v8, v101
v_fmac_f32 v38, v8, v102
v_fmac_f32 v39, v8, v103
v_fmac_f32 v40, v9, v104
v_fmac_f32 v41, v9, v105
v_fmac_f32 v42, v9, v106
v_fmac_f32 v43, v9, v107
v_fmac_f32 v44, v9, v108
v_fmac_f32 v45, v9, v109
v_fmac_f32 v46, v9, v110
v_fmac_f32 v47, v9, v111
v_fmac_f32 v48, v9, v112
v_fmac_f32 v49, v9, v113
v_fmac_f32 v50, v9, v114
v_fmac_f32 v51, v9, v115
v_fmac_f32 v52, v9, v116
v_fmac_f32 v53, v9, v117
v_fmac_f32 v54, v9, v118
v_fmac_f32 v55, v9, v119
s_mov_b32 s92, 200000
L_spin_x:
s_waitcnt vmcnt(0)
v_max3_u32 v168, v152, v153, 0
v_max3_u32 v168, v154, v155, v168
v_max3_u32 v168, v156, v157, v168
v_max3_u32 v168, v158, v159, v168
v_max3_u32 v168, v160, v161, v168
v_max3_u32 v168, v162, v163, v168
v_max3_u32 v168, v164, v165, v168
v_max3_u32 v168, v166, v167, v168
v_cmp_eq_u32 vcc, -1, v168
s_sub_u32 s92, s92, 1
s_cbranch_scc1 L_spun_x
s_nop 3
s_cbranch_vccz L_spun_x
s_sleep 2
buffer_load_dwordx4 v[152:155], v3, s[88:91], s28 offen offset:0 sc1
buffer_load_dwordx4 v[156:159], v3, s[88:91], s28 offen offset:1024 sc1
buffer_load_dwordx4 v[160:163], v3, s[88:91], s28 offen offset:2048 sc1
buffer_load_dwordx4 v[164:167], v3, s[88:91], s28 offen offset:3072 sc1
s_branch L_spin_x
L_spun_x:
v_lshlrev_b32 v168, 16, v152
v_and_b32 v169, 0xffff0000, v152
v_pk_add_f32 v[24:25], v[24:25], v[168:169]
v_lshlrev_b32 v168, 16, v153
v_and_b32 v169, 0xffff0000, v153
v_pk_add_f32 v[26:27], v[26:27], v[168:169]
v_lshlrev_b32 v168, 16, v154
v_and_b32 v169, 0xffff0000, v154
v_pk_add_f32 v[28:29], v[28:29], v[168:169]
v_lshlrev_b32 v168, 16, v155
v_and_b32 v169, 0xffff0000, v155
v_pk_add_f32 v[30:31], v[30:31], v[168:169]
v_cvt_pk_bf16_f32 v24, v24, v25
v_cvt_pk_bf16_f32 v25, v26, v27
v_cvt_pk_bf16_f32 v26, v28, v29
v_cvt_pk_bf16_f32 v27, v30, v31
s_nop 1
v_permlane16_swap_b32 v24, v26
v_permlane16_swap_b32 v25, v27
buffer_store_dwordx4 v[24:27], v17, s[80:83], s29 offen offset:0
v_lshlrev_b32 v168, 16, v156
v_and_b32 v169, 0xffff0000, v156
v_pk_add_f32 v[32:33], v[32:33], v[168:169]
v_lshlrev_b32 v168, 16, v157
v_and_b32 v169, 0xffff0000, v157
v_pk_add_f32 v[34:35], v[34:35], v[168:169]
v_lshlrev_b32 v168, 16, v158
v_and_b32 v169, 0xffff0000, v158
v_pk_add_f32 v[36:37], v[36:37], v[168:169]
v_lshlrev_b32 v168, 16, v159
v_and_b32 v169, 0xffff0000, v159
v_pk_add_f32 v[38:39], v[38:39], v[168:169]
v_cvt_pk_bf16_f32 v32, v32, v33
v_cvt_pk_bf16_f32 v33, v34, v35
v_cvt_pk_bf16_f32 v34, v36, v37
v_cvt_pk_bf16_f32 v35, v38, v39
s_nop 1
v_permlane16_swap_b32 v32, v34
v_permlane16_swap_b32 v33, v35
buffer_store_dwordx4 v[32:35], v17, s[80:83], s29 offen offset:64
v_lshlrev_b32 v168, 16, v160
v_and_b32 v169, 0xffff0000, v160
v_pk_add_f32 v[40:41], v[40:41], v[168:169]
v_lshlrev_b32 v168, 16, v161
v_and_b32 v169, 0xffff0000, v161
v_pk_add_f32 v[42:43], v[42:43], v[168:169]
v_lshlrev_b32 v168, 16, v162
v_and_b32 v169, 0xffff0000, v162
v_pk_add_f32 v[44:45], v[44:45], v[168:169]
v_lshlrev_b32 v168, 16, v163
v_and_b32 v169, 0xffff0000, v163
v_pk_add_f32 v[46:47], v[46:47], v[168:169]
v_cvt_pk_bf16_f32 v40, v40, v41
v_cvt_pk_bf16_f32 v41, v42, v43
v_cvt_pk_bf16_f32 v42, v44, v45
v_cvt_pk_bf16_f32 v43, v46, v47
s_nop 1
v_permlane16_swap_b32 v40, v42
v_permlane16_swap_b32 v41, v43
buffer_store_dwordx4 v[40:43], v17, s[80:83], s31 offen offset:0
v_lshlrev_b32 v168, 16, v164
v_and_b32 v169, 0xffff0000, v164
v_pk_add_f32 v[48:49], v[48:49], v[168:169]
v_lshlrev_b32 v168, 16, v165
v_and_b32 v169, 0xffff0000, v165
v_pk_add_f32 v[50:51], v[50:51], v[168:169]
v_lshlrev_b32 v168, 16, v166
v_and_b32 v169, 0xffff0000, v166
v_pk_add_f32 v[52:53], v[52:53], v[168:169]
v_lshlrev_b32 v168, 16, v167
v_and_b32 v169, 0xffff0000, v167
v_pk_add_f32 v[54:55], v[54:55], v[168:169]
v_cvt_pk_bf16_f32 v48, v48, v49
v_cvt_pk_bf16_f32 v49, v50, v51
v_cvt_pk_bf16_f32 v50, v52, v53
v_cvt_pk_bf16_f32 v51, v54, v55
s_nop 1
v_permlane16_swap_b32 v48, v50
v_permlane16_swap_b32 v49, v51
buffer_store_dwordx4 v[48:51], v17, s[80:83], s31 offen offset:64
L_end:
s_endpgm
L_att_fallback:
s_waitcnt vmcnt(0)
s_mov_b32 s33, 1
s_mul_i32 s32, s5, 0x10c400
s_lshl_b32 s19, s4, 13
s_add_u32 s32, s32, s19
s_cmp_eq_u32 s4, 0
s_cselect_b32 s94, 0x200000, 0
s_add_u32 s32, s32, s94
s_sub_u32 s94, 0x8000, s94
s_add_u32 s7, s32, 0x1000
s_add_u32 s27, s19, 131072
v_and_b32 v5, 15, v0
v_lshrrev_b32 v6, 4, v0
v_lshlrev_b32 v6, 2, v6
v_sub_u32 v5, v5, v6
v_mov_b32 v9, 0xf149f2ca
s_lshr_b32 s8, s20, 11
v_add_u32 v96, s8, v5
v_mov_b32 v80, v9
s_lshr_b32 s8, s21, 11
v_add_u32 v97, s8, v5
v_mov_b32 v84, v9
s_lshr_b32 s8, s22, 11
v_add_u32 v98, s8, v5
v_mov_b32 v88, v9
s_lshr_b32 s8, s23, 11
v_add_u32 v99, s8, v5
v_mov_b32 v92, v9
s_sub_u32 s15, 16, s6
s_lshl_b32 s15, s15, 1
L_fb_loop:
s_waitcnt lgkmcnt(0)
s_barrier
s_add_u32 m0, s19, 0x0
s_nop 0
buffer_load_dwordx4 v3, s[48:51], s32 offen offset:0 sc1 lds
buffer_load_dwordx4 v3, s[48:51], s32 offen offset:1024 sc1 lds
buffer_load_dwordx4 v3, s[48:51], s32 offen offset:2048 sc1 lds
buffer_load_dwordx4 v3, s[48:51], s32 offen offset:3072 sc1 lds
s_add_u32 m0, s19, 0x1000
s_nop 0
buffer_load_dwordx4 v3, s[48:51], s7 offen offset:0 sc1 lds
buffer_load_dwordx4 v3, s[48:51], s7 offen offset:1024 sc1 lds
buffer_load_dwordx4 v3, s[48:51], s7 offen offset:2048 sc1 lds
buffer_load_dwordx4 v3, s[48:51], s7 offen offset:3072 sc1 lds
s_add_u32 s32, s32, s94
s_add_u32 s7, s7, s94
s_mov_b32 s94, 0x8000
s_waitcnt vmcnt(0)
s_barrier
ds_read_b128 a[0:3], v3 offset:8192
ds_read_b128 a[4:7], v3 offset:9216
ds_read_b128 a[8:11], v3 offset:10240
ds_read_b128 a[12:15], v3 offset:11264
ds_read_b128 a[16:19], v3 offset:12288
ds_read_b128 a[20:23], v3 offset:13312
ds_read_b128 a[24:27], v3 offset:14336
ds_read_b128 a[28:31], v3 offset:15360
s_waitcnt lgkmcnt(0)
v_mfma_f32_16x16x32_bf16 v[16:19], a[0:3], a[160:163], 0
v_mfma_f32_16x16x32_bf16 v[16:19], a[4:7], a[164:167], v[16:19]
v_mfma_f32_16x16x32_bf16 v[16:19], a[8:11], a[168:171], v[16:19]
v_mfma_f32_16x16x32_bf16 v[16:19], a[12:15], a[172:175], v[16:19]
v_mfma_f32_16x16x32_bf16 v[20:23], a[0:3], a[176:179], 0
v_mfma_f32_16x16x32_bf16 v[20:23], a[4:7], a[180:183], v[20:23]
v_mfma_f32_16x16x32_bf16 v[20:23], a[8:11], a[184:187], v[20:23]
v_mfma_f32_16x16x32_bf16 v[20:23], a[12:15], a[188:191], v[20:23]
v_mfma_f32_16x16x32_bf16 v[24:27], a[0:3], a[192:195], 0
v_mfma_f32_16x16x32_bf16 v[24:27], a[4:7], a[196:199], v[24:27]
v_mfma_f32_16x16x32_bf16 v[24:27], a[8:11], a[200:203], v[24:27]
v_mfma_f32_16x16x32_bf16 v[24:27], a[12:15], a[204:207], v[24:27]
v_mfma_f32_16x16x32_bf16 v[28:31], a[0:3], a[208:211], 0
v_mfma_f32_16x16x32_bf16 v[28:31], a[4:7], a[212:215], v[28:31]
v_mfma_f32_16x16x32_bf16 v[28:31], a[8:11], a[216:219], v[28:31]
v_mfma_f32_16x16x32_bf16 v[28:31], a[12:15], a[220:223], v[28:31]
v_mfma_f32_16x16x32_bf16 v[32:35], a[16:19], a[160:163], 0
v_mfma_f32_16x16x32_bf16 v[32:35], a[20:23], a[164:167], v[32:35]
v_mfma_f32_16x16x32_bf16 v[32:35], a[24:27], a[168:171], v[32:35]
v_mfma_f32_16x16x32_bf16 v[32:35], a[28:31], a[172:175], v[32:35]
v_mfma_f32_16x16x32_bf16 v[36:39], a[16:19], a[176:179], 0
v_mfma_f32_16x16x32_bf16 v[36:39], a[20:23], a[180:183], v[36:39]
v_mfma_f32_16x16x32_bf16 v[36:39], a[24:27], a[184:187], v[36:39]
v_mfma_f32_16x16x32_bf16 v[36:39], a[28:31], a[188:191], v[36:39]
v_mfma_f32_16x16x32_bf16 v[40:43], a[16:19], a[192:195], 0
v_mfma_f32_16x16x32_bf16 v[40:43], a[20:23], a[196:199], v[40:43]
v_mfma_f32_16x16x32_bf16 v[40:43], a[24:27], a[200:203], v[40:43]
v_mfma_f32_16x16x32_bf16 v[40:43], a[28:31], a[204:207], v[40:43]
v_mfma_f32_16x16x32_bf16 v[44:47], a[16:19], a[208:211], 0
v_mfma_f32_16x16x32_bf16 v[44:47], a[20:23], a[212:215], v[44:47]
v_mfma_f32_16x16x32_bf16 v[44:47], a[24:27], a[216:219], v[44:47]
v_mfma_f32_16x16x32_bf16 v[44:47], a[28:31], a[220:223], v[44:47]
s_nop 7
v_cmp_le_i32 s[36:37], 0, v96
v_cmp_le_i32 s[38:39], 1, v96
v_cmp_le_i32 s[40:41], 2, v96
v_cmp_le_i32 s[42:43], 3, v96
s_nop 1
v_cndmask_b32 v16, v9, v16, s[36:37]
v_cndmask_b32 v17, v9, v17, s[38:39]
v_cndmask_b32 v18, v9, v18, s[40:41]
v_cndmask_b32 v19, v9, v19, s[42:43]
v_max3_f32 v80, v80, v16, v17
v_max3_f32 v80, v80, v18, v19
v_cmp_le_i32 s[36:37], 0, v97
v_cmp_le_i32 s[38:39], 1, v97
v_cmp_le_i32 s[40:41], 2, v97
v_cmp_le_i32 s[42:43], 3, v97
s_nop 1
v_cndmask_b32 v20, v9, v20, s[36:37]
v_cndmask_b32 v21, v9, v21, s[38:39]
v_cndmask_b32 v22, v9, v22, s[40:41]
v_cndmask_b32 v23, v9, v23, s[42:43]
v_max3_f32 v84, v84, v20, v21
v_max3_f32 v84, v84, v22, v23
v_cmp_le_i32 s[36:37], 0, v98
v_cmp_le_i32 s[38:39], 1, v98
v_cmp_le_i32 s[40:41], 2, v98
v_cmp_le_i32 s[42:43], 3, v98
s_nop 1
v_cndmask_b32 v24, v9, v24, s[36:37]
v_cndmask_b32 v25, v9, v25, s[38:39]
v_cndmask_b32 v26, v9, v26, s[40:41]
v_cndmask_b32 v27, v9, v27, s[42:43]
v_max3_f32 v88, v88, v24, v25
v_max3_f32 v88, v88, v26, v27
v_cmp_le_i32 s[36:37], 0, v99
v_cmp_le_i32 s[38:39], 1, v99
v_cmp_le_i32 s[40:41], 2, v99
v_cmp_le_i32 s[42:43], 3, v99
s_nop 1
v_cndmask_b32 v28, v9, v28, s[36:37]
v_cndmask_b32 v29, v9, v29, s[38:39]
v_cndmask_b32 v30, v9, v30, s[40:41]
v_cndmask_b32 v31, v9, v31, s[42:43]
v_max3_f32 v92, v92, v28, v29
v_max3_f32 v92, v92, v30, v31
v_cmp_le_i32 s[36:37], 16, v96
v_cmp_le_i32 s[38:39], 17, v96
v_cmp_le_i32 s[40:41], 18, v96
v_cmp_le_i32 s[42:43], 19, v96
s_nop 1
v_cndmask_b32 v32, v9, v32, s[36:37]
v_cndmask_b32 v33, v9, v33, s[38:39]
v_cndmask_b32 v34, v9, v34, s[40:41]
v_cndmask_b32 v35, v9, v35, s[42:43]
v_max3_f32 v80, v80, v32, v33
v_max3_f32 v80, v80, v34, v35
v_cmp_le_i32 s[36:37], 16, v97
v_cmp_le_i32 s[38:39], 17, v97
v_cmp_le_i32 s[40:41], 18, v97
v_cmp_le_i32 s[42:43], 19, v97
s_nop 1
v_cndmask_b32 v36, v9, v36, s[36:37]
v_cndmask_b32 v37, v9, v37, s[38:39]
v_cndmask_b32 v38, v9, v38, s[40:41]
v_cndmask_b32 v39, v9, v39, s[42:43]
v_max3_f32 v84, v84, v36, v37
v_max3_f32 v84, v84, v38, v39
v_cmp_le_i32 s[36:37], 16, v98
v_cmp_le_i32 s[38:39], 17, v98
v_cmp_le_i32 s[40:41], 18, v98
v_cmp_le_i32 s[42:43], 19, v98
s_nop 1
v_cndmask_b32 v40, v9, v40, s[36:37]
v_cndmask_b32 v41, v9, v41, s[38:39]
v_cndmask_b32 v42, v9, v42, s[40:41]
v_cndmask_b32 v43, v9, v43, s[42:43]
v_max3_f32 v88, v88, v40, v41
v_max3_f32 v88, v88, v42, v43
v_cmp_le_i32 s[36:37], 16, v99
v_cmp_le_i32 s[38:39], 17, v99
v_cmp_le_i32 s[40:41], 18, v99
v_cmp_le_i32 s[42:43], 19, v99
s_nop 1
v_cndmask_b32 v44, v9, v44, s[36:37]
v_cndmask_b32 v45, v9, v45, s[38:39]
v_cndmask_b32 v46, v9, v46, s[40:41]
v_cndmask_b32 v47, v9, v47, s[42:43]
v_max3_f32 v92, v92, v44, v45
v_max3_f32 v92, v92, v46, v47
ds_read_b128 a[0:3], v3 offset:24576
ds_read_b128 a[4:7], v3 offset:25600
ds_read_b128 a[8:11], v3 offset:26624
ds_read_b128 a[12:15], v3 offset:27648
ds_read_b128 a[16:19], v3 offset:28672
ds_read_b128 a[20:23], v3 offset:29696
ds_read_b128 a[24:27], v3 offset:30720
ds_read_b128 a[28:31], v3 offset:31744
s_waitcnt lgkmcnt(0)
v_mfma_f32_16x16x32_bf16 v[16:19], a[0:3], a[160:163], 0
v_mfma_f32_16x16x32_bf16 v[16:19], a[4:7], a[164:167], v[16:19]
v_mfma_f32_16x16x32_bf16 v[16:19], a[8:11], a[168:171], v[16:19]
v_mfma_f32_16x16x32_bf16 v[16:19], a[12:15], a[172:175], v[16:19]
v_mfma_f32_16x16x32_bf16 v[20:23], a[0:3], a[176:179], 0
v_mfma_f32_16x16x32_bf16 v[20:23], a[4:7], a[180:183], v[20:23]
v_mfma_f32_16x16x32_bf16 v[20:23], a[8:11], a[184:187], v[20:23]
v_mfma_f32_16x16x32_bf16 v[20:23], a[12:15], a[188:191], v[20:23]
v_mfma_f32_16x16x32_bf16 v[24:27], a[0:3], a[192:195], 0
v_mfma_f32_16x16x32_bf16 v[24:27], a[4:7], a[196:199], v[24:27]
v_mfma_f32_16x16x32_bf16 v[24:27], a[8:11], a[200:203], v[24:27]
v_mfma_f32_16x16x32_bf16 v[24:27], a[12:15], a[204:207], v[24:27]
v_mfma_f32_16x16x32_bf16 v[28:31], a[0:3], a[208:211], 0
v_mfma_f32_16x16x32_bf16 v[28:31], a[4:7], a[212:215], v[28:31]
v_mfma_f32_16x16x32_bf16 v[28:31], a[8:11], a[216:219], v[28:31]
v_mfma_f32_16x16x32_bf16 v[28:31], a[12:15], a[220:223], v[28:31]
v_mfma_f32_16x16x32_bf16 v[32:35], a[16:19], a[160:163], 0
v_mfma_f32_16x16x32_bf16 v[32:35], a[20:23], a[164:167], v[32:35]
v_mfma_f32_16x16x32_bf16 v[32:35], a[24:27], a[168:171], v[32:35]
v_mfma_f32_16x16x32_bf16 v[32:35], a[28:31], a[172:175], v[32:35]
v_mfma_f32_16x16x32_bf16 v[36:39], a[16:19], a[176:179], 0
v_mfma_f32_16x16x32_bf16 v[36:39], a[20:23], a[180:183], v[36:39]
v_mfma_f32_16x16x32_bf16 v[36:39], a[24:27], a[184:187], v[36:39]
v_mfma_f32_16x16x32_bf16 v[36:39], a[28:31], a[188:191], v[36:39]
v_mfma_f32_16x16x32_bf16 v[40:43], a[16:19], a[192:195], 0
v_mfma_f32_16x16x32_bf16 v[40:43], a[20:23], a[196:199], v[40:43]
v_mfma_f32_16x16x32_bf16 v[40:43], a[24:27], a[200:203], v[40:43]
v_mfma_f32_16x16x32_bf16 v[40:43], a[28:31], a[204:207], v[40:43]
v_mfma_f32_16x16x32_bf16 v[44:47], a[16:19], a[208:211], 0
v_mfma_f32_16x16x32_bf16 v[44:47], a[20:23], a[212:215], v[44:47]
v_mfma_f32_16x16x32_bf16 v[44:47], a[24:27], a[216:219], v[44:47]
v_mfma_f32_16x16x32_bf16 v[44:47], a[28:31], a[220:223], v[44:47]
s_nop 7
v_cmp_le_i32 s[36:37], 32, v96
v_cmp_le_i32 s[38:39], 33, v96
v_cmp_le_i32 s[40:41], 34, v96
v_cmp_le_i32 s[42:43], 35, v96
s_nop 1
v_cndmask_b32 v16, v9, v16, s[36:37]
v_cndmask_b32 v17, v9, v17, s[38:39]
v_cndmask_b32 v18, v9, v18, s[40:41]
v_cndmask_b32 v19, v9, v19, s[42:43]
v_max3_f32 v80, v80, v16, v17
v_max3_f32 v80, v80, v18, v19
v_cmp_le_i32 s[36:37], 32, v97
v_cmp_le_i32 s[38:39], 33, v97
v_cmp_le_i32 s[40:41], 34, v97
v_cmp_le_i32 s[42:43], 35, v97
s_nop 1
v_cndmask_b32 v20, v9, v20, s[36:37]
v_cndmask_b32 v21, v9, v21, s[38:39]
v_cndmask_b32 v22, v9, v22, s[40:41]
v_cndmask_b32 v23, v9, v23, s[42:43]
v_max3_f32 v84, v84, v20, v21
v_max3_f32 v84, v84, v22, v23
v_cmp_le_i32 s[36:37], 32, v98
v_cmp_le_i32 s[38:39], 33, v98
v_cmp_le_i32 s[40:41], 34, v98
v_cmp_le_i32 s[42:43], 35, v98
s_nop 1
v_cndmask_b32 v24, v9, v24, s[36:37]
v_cndmask_b32 v25, v9, v25, s[38:39]
v_cndmask_b32 v26, v9, v26, s[40:41]
v_cndmask_b32 v27, v9, v27, s[42:43]
v_max3_f32 v88, v88, v24, v25
v_max3_f32 v88, v88, v26, v27
v_cmp_le_i32 s[36:37], 32, v99
v_cmp_le_i32 s[38:39], 33, v99
v_cmp_le_i32 s[40:41], 34, v99
v_cmp_le_i32 s[42:43], 35, v99
s_nop 1
v_cndmask_b32 v28, v9, v28, s[36:37]
v_cndmask_b32 v29, v9, v29, s[38:39]
v_cndmask_b32 v30, v9, v30, s[40:41]
v_cndmask_b32 v31, v9, v31, s[42:43]
v_max3_f32 v92, v92, v28, v29
v_max3_f32 v92, v92, v30, v31
v_cmp_le_i32 s[36:37], 48, v96
v_cmp_le_i32 s[38:39], 49, v96
v_cmp_le_i32 s[40:41], 50, v96
v_cmp_le_i32 s[42:43], 51, v96
s_nop 1
v_cndmask_b32 v32, v9, v32, s[36:37]
v_cndmask_b32 v33, v9, v33, s[38:39]
v_cndmask_b32 v34, v9, v34, s[40:41]
v_cndmask_b32 v35, v9, v35, s[42:43]
v_max3_f32 v80, v80, v32, v33
v_max3_f32 v80, v80, v34, v35
v_cmp_le_i32 s[36:37], 48, v97
v_cmp_le_i32 s[38:39], 49, v97
v_cmp_le_i32 s[40:41], 50, v97
v_cmp_le_i32 s[42:43], 51, v97
s_nop 1
v_cndmask_b32 v36, v9, v36, s[36:37]
v_cndmask_b32 v37, v9, v37, s[38:39]
v_cndmask_b32 v38, v9, v38, s[40:41]
v_cndmask_b32 v39, v9, v39, s[42:43]
v_max3_f32 v84, v84, v36, v37
v_max3_f32 v84, v84, v38, v39
v_cmp_le_i32 s[36:37], 48, v98
v_cmp_le_i32 s[38:39], 49, v98
v_cmp_le_i32 s[40:41], 50, v98
v_cmp_le_i32 s[42:43], 51, v98
s_nop 1
v_cndmask_b32 v40, v9, v40, s[36:37]
v_cndmask_b32 v41, v9, v41, s[38:39]
v_cndmask_b32 v42, v9, v42, s[40:41]
v_cndmask_b32 v43, v9, v43, s[42:43]
v_max3_f32 v88, v88, v40, v41
v_max3_f32 v88, v88, v42, v43
v_cmp_le_i32 s[36:37], 48, v99
v_cmp_le_i32 s[38:39], 49, v99
v_cmp_le_i32 s[40:41], 50, v99
v_cmp_le_i32 s[42:43], 51, v99
s_nop 1
v_cndmask_b32 v44, v9, v44, s[36:37]
v_cndmask_b32 v45, v9, v45, s[38:39]
v_cndmask_b32 v46, v9, v46, s[40:41]
v_cndmask_b32 v47, v9, v47, s[42:43]
v_max3_f32 v92, v92, v44, v45
v_max3_f32 v92, v92, v46, v47
v_subrev_u32 v96, 64, v96
v_subrev_u32 v97, 64, v97
v_subrev_u32 v98, 64, v98
v_subrev_u32 v99, 64, v99
s_sub_u32 s15, s15, 1
s_cmp_lg_u32 s15, 0
s_cbranch_scc1 L_fb_loop
v_mov_b32 v16, v80
v_mov_b32 v20, v84
v_mov_b32 v24, v88
v_mov_b32 v28, v92
v_permlane16_swap_b32 v16, v80
v_permlane16_swap_b32 v20, v84
v_permlane16_swap_b32 v24, v88
v_permlane16_swap_b32 v28, v92
v_max_f32 v80, v80, v16
v_max_f32 v84, v84, v20
v_max_f32 v88, v88, v24
v_max_f32 v92, v92, v28
v_mov_b32 v16, v80
v_mov_b32 v20, v84
v_mov_b32 v24, v88
v_mov_b32 v28, v92
v_permlane32_swap_b32 v16, v80
v_permlane32_swap_b32 v20, v84
v_permlane32_swap_b32 v24, v88
v_permlane32_swap_b32 v28, v92
v_max_f32 v80, v80, v16
v_max_f32 v84, v84, v20
v_max_f32 v88, v88, v24
v_max_f32 v92, v92, v28
s_barrier
s_mul_i32 s32, s5, 0x10c400
s_lshl_b32 s19, s4, 13
s_add_u32 s32, s32, s19
s_cmp_eq_u32 s4, 0
s_cselect_b32 s94, 0x200000, 0
s_add_u32 s32, s32, s94
s_sub_u32 s94, 0x8000, s94
s_add_u32 s7, s32, 0x1000
s_add_u32 s27, s19, 131072
s_add_u32 m0, s19, 0x0
s_nop 0
buffer_load_dwordx4 v3, s[48:51], s32 offen offset:0 sc1 lds
buffer_load_dwordx4 v3, s[48:51], s32 offen offset:1024 sc1 lds
buffer_load_dwordx4 v3, s[48:51], s32 offen offset:2048 sc1 lds
buffer_load_dwordx4 v3, s[48:51], s32 offen offset:3072 sc1 lds
s_add_u32 m0, s19, 0x1000
s_nop 0
buffer_load_dwordx4 v3, s[48:51], s7 offen offset:0 sc1 lds
buffer_load_dwordx4 v3, s[48:51], s7 offen offset:1024 sc1 lds
buffer_load_dwordx4 v3, s[48:51], s7 offen offset:2048 sc1 lds
buffer_load_dwordx4 v3, s[48:51], s7 offen offset:3072 sc1 lds
s_add_u32 s32, s32, s94
s_add_u32 s7, s7, s94
s_add_u32 m0, s19, 0x18000
s_nop 0
buffer_load_dwordx4 v3, s[48:51], s32 offen offset:0 sc1 lds
buffer_load_dwordx4 v3, s[48:51], s32 offen offset:1024 sc1 lds
buffer_load_dwordx4 v3, s[48:51], s32 offen offset:2048 sc1 lds
buffer_load_dwordx4 v3, s[48:51], s32 offen offset:3072 sc1 lds
s_add_u32 m0, s19, 0x19000
s_nop 0
buffer_load_dwordx4 v3, s[48:51], s7 offen offset:0 sc1 lds
buffer_load_dwordx4 v3, s[48:51], s7 offen offset:1024 sc1 lds
buffer_load_dwordx4 v3, s[48:51], s7 offen offset:2048 sc1 lds
buffer_load_dwordx4 v3, s[48:51], s7 offen offset:3072 sc1 lds
s_add_u32 s32, s32, 0x8000
s_add_u32 s7, s7, 0x8000
s_add_u32 m0, s19, 0x8000
s_nop 0
buffer_load_dwordx4 v3, s[48:51], s32 offen offset:0 sc1 lds
buffer_load_dwordx4 v3, s[48:51], s32 offen offset:1024 sc1 lds
buffer_load_dwordx4 v3, s[48:51], s32 offen offset:2048 sc1 lds
buffer_load_dwordx4 v3, s[48:51], s32 offen offset:3072 sc1 lds
s_add_u32 m0, s19, 0x9000
s_nop 0
buffer_load_dwordx4 v3, s[48:51], s7 offen offset:0 sc1 lds
buffer_load_dwordx4 v3, s[48:51], s7 offen offset:1024 sc1 lds
buffer_load_dwordx4 v3, s[48:51], s7 offen offset:2048 sc1 lds
buffer_load_dwordx4 v3, s[48:51], s7 offen offset:3072 sc1 lds
s_add_u32 s32, s32, 0x8000
s_add_u32 s7, s7, 0x8000
s_bfe_u32 s99, s2, 0x20001
s_lshl_b32 s99, s99, 2
s_lshr_b32 s8, s2, 6
s_add_u32 s99, s99, s8
s_bfe_u32 s100, s2, 0x30003
s_and_b32 s14, s2, 1
s_sub_u32 s24, 15, s99
s_min_u32 s18, s24, s99
s_lshl_b32 s24, s18, 1
s_add_u32 s24, s24, s14
s_lshl_b32 s24, s24, 6
s_add_u32 s24, s24, 0x3704000
s_mov_b32 s12, 14336
s_and_b32 s16, s6, 1
s_lshl_b32 s16, s16, 15
s_add_u32 s16, s16, 98304
s_add_u32 s16, s16, s17
s_lshl_b32 s13, s4, 15
s_lshl_b32 s9, s100, 8
s_add_u32 s13, s13, s9
s_mul_i32 s9, s14, 0x100080
s_add_u32 s13, s13, s9
s_mul_i32 s25, s14, 0x300000
s_sub_u32 s25, s25, 917504
s_mul_i32 s101, s99, 0x142400
s_lshl_b32 s8, s4, 11
s_add_u32 s101, s101, s8
s_lshl_b32 s8, s14, 17
s_add_u32 s101, s101, s8
s_add_u32 s101, s101, 0x21fe000
s_mul_i32 s26, s14, 393216
s_add_u32 s26, s26, 139264
v_mov_b32 v15, s6
v_writelane_b32 v15, s18, 0
v_lshlrev_b32 v15, 2, v15
v_bfe_u32 v12, v0, 2, 2
v_lshlrev_b32 v12, 11, v12
v_lshrrev_b32 v13, 4, v0
v_lshl_add_u32 v12, v13, 6, v12
v_and_b32 v13, 3, v0
v_lshl_add_u32 v12, v13, 4, v12
v_xor_b32 v12, s13, v12
v_xor_b32 v13, 32, v12
v_add_u32 v13, 7168, v13
s_mov_b32 s11, 0xf149f2ca
s_mov_b32 s36, 0xfff0ffff
s_mov_b32 s37, 0xf000ff00
s_mov_b32 s38, 0xffe0fffe
s_mov_b32 s39, 0xe000fe00
s_mov_b32 s40, 0xffc0fffc
s_mov_b32 s41, 0xc000fc00
s_mov_b32 s42, 0xff80fff8
s_mov_b32 s43, 0x8000f800
s_bitcmp1_b32 s4, 0
s_cselect_b32 s8, 0x7f800000, s11
s_cselect_b32 s9, s11, 0x7f800000
v_mov_b32 v1, v3
v_add_u32 v2, 98304, v3
s_mov_b64 s[34:35], 0
v_accvgpr_write_b32 a224, 0
v_accvgpr_write_b32 a225, 0
v_accvgpr_write_b32 a226, 0
v_accvgpr_write_b32 a227, 0
v_accvgpr_write_b32 a228, 0
v_accvgpr_write_b32 a229, 0
v_accvgpr_write_b32 a230, 0
v_accvgpr_write_b32 a231, 0
v_sub_f32 v83, 0, v80
v_sub_f32 v82, 0, v80
v_sub_f32 v81, 0, v80
v_sub_f32 v80, 0, v80
v_min_f32 v103, s8, v80
v_cndmask_b32 v96, v103, v80, s[36:37]
v_cndmask_b32 v97, v103, v80, s[38:39]
v_cndmask_b32 v98, v103, v80, s[40:41]
v_cndmask_b32 v99, v103, v80, s[42:43]
v_cndmask_b32 v100, v9, v103, s[36:37]
v_cndmask_b32 v101, v9, v103, s[38:39]
v_cndmask_b32 v102, v9, v103, s[40:41]
v_cndmask_b32 v103, v9, v103, s[42:43]
v_sub_f32 v87, 0, v84
v_sub_f32 v86, 0, v84
v_sub_f32 v85, 0, v84
v_sub_f32 v84, 0, v84
v_min_f32 v111, s9, v84
v_cndmask_b32 v104, v111, v84, s[36:37]
v_cndmask_b32 v105, v111, v84, s[38:39]
v_cndmask_b32 v106, v111, v84, s[40:41]
v_cndmask_b32 v107, v111, v84, s[42:43]
v_cndmask_b32 v108, v9, v111, s[36:37]
v_cndmask_b32 v109, v9, v111, s[38:39]
v_cndmask_b32 v110, v9, v111, s[40:41]
v_cndmask_b32 v111, v9, v111, s[42:43]
v_sub_f32 v91, 0, v88
v_sub_f32 v90, 0, v88
v_sub_f32 v89, 0, v88
v_sub_f32 v88, 0, v88
v_min_f32 v119, s8, v88
v_cndmask_b32 v112, v119, v88, s[36:37]
v_cndmask_b32 v113, v119, v88, s[38:39]
v_cndmask_b32 v114, v119, v88, s[40:41]
v_cndmask_b32 v115, v119, v88, s[42:43]
v_cndmask_b32 v116, v9, v119, s[36:37]
v_cndmask_b32 v117, v9, v119, s[38:39]
v_cndmask_b32 v118, v9, v119, s[40:41]
v_cndmask_b32 v119, v9, v119, s[42:43]
v_sub_f32 v95, 0, v92
v_sub_f32 v94, 0, v92
v_sub_f32 v93, 0, v92
v_sub_f32 v92, 0, v92
v_min_f32 v127, s9, v92
v_cndmask_b32 v120, v127, v92, s[36:37]
v_cndmask_b32 v121, v127, v92, s[38:39]
v_cndmask_b32 v122, v127, v92, s[40:41]
v_cndmask_b32 v123, v127, v92, s[42:43]
v_cndmask_b32 v124, v9, v127, s[36:37]
v_cndmask_b32 v125, v9, v127, s[38:39]
v_cndmask_b32 v126, v9, v127, s[40:41]
v_cndmask_b32 v127, v9, v127, s[42:43]
v_and_b32 v9, 1, v0
v_mul_u32_u24 v9, 0xaaaa, v9
v_add_u32 v9, 0x4444, v9
v_mov_b32 v128, 0
v_mov_b32 v129, 0
v_mov_b32 v130, 0
v_mov_b32 v131, 0
v_mov_b32 v132, 0
v_mov_b32 v133, 0
v_mov_b32 v134, 0
v_mov_b32 v135, 0
v_mov_b32 v136, 0
v_mov_b32 v137, 0
v_mov_b32 v138, 0
v_mov_b32 v139, 0
v_mov_b32 v140, 0
v_mov_b32 v141, 0
v_mov_b32 v142, 0
v_mov_b32 v143, 0
v_mov_b32 v144, 0
v_mov_b32 v145, 0
v_mov_b32 v146, 0
v_mov_b32 v147, 0
v_mov_b32 v148, 0
v_mov_b32 v149, 0
v_mov_b32 v150, 0
v_mov_b32 v151, 0
v_mov_b32 v152, 0
v_mov_b32 v153, 0
v_mov_b32 v154, 0
v_mov_b32 v155, 0
v_mov_b32 v156, 0
v_mov_b32 v157, 0
v_mov_b32 v158, 0
v_mov_b32 v159, 0
v_mov_b32 v160, 0
v_mov_b32 v161, 0
v_mov_b32 v162, 0
v_mov_b32 v163, 0
v_mov_b32 v164, 0
v_mov_b32 v165, 0
v_mov_b32 v166, 0
v_mov_b32 v167, 0
v_mov_b32 v168, 0
v_mov_b32 v169, 0
v_mov_b32 v170, 0
v_mov_b32 v171, 0
v_mov_b32 v172, 0
v_mov_b32 v173, 0
v_mov_b32 v174, 0
v_mov_b32 v175, 0
v_mov_b32 v176, 0
v_mov_b32 v177, 0
v_mov_b32 v178, 0
v_mov_b32 v179, 0
v_mov_b32 v180, 0
v_mov_b32 v181, 0
v_mov_b32 v182, 0
v_mov_b32 v183, 0
v_mov_b32 v184, 0
v_mov_b32 v185, 0
v_mov_b32 v186, 0
v_mov_b32 v187, 0
v_mov_b32 v188, 0
v_mov_b32 v189, 0
v_mov_b32 v190, 0
v_mov_b32 v191, 0
v_mov_b32 v192, 0
v_mov_b32 v193, 0
v_mov_b32 v194, 0
v_mov_b32 v195, 0
v_mov_b32 v196, 0
v_mov_b32 v197, 0
v_mov_b32 v198, 0
v_mov_b32 v199, 0
v_mov_b32 v200, 0
v_mov_b32 v201, 0
v_mov_b32 v202, 0
v_mov_b32 v203, 0
v_mov_b32 v204, 0
v_mov_b32 v205, 0
v_mov_b32 v206, 0
v_mov_b32 v207, 0
v_mov_b32 v208, 0
v_mov_b32 v209, 0
v_mov_b32 v210, 0
v_mov_b32 v211, 0
v_mov_b32 v212, 0
v_mov_b32 v213, 0
v_mov_b32 v214, 0
v_mov_b32 v215, 0
v_mov_b32 v216, 0
v_mov_b32 v217, 0
v_mov_b32 v218, 0
v_mov_b32 v219, 0
v_mov_b32 v220, 0
v_mov_b32 v221, 0
v_mov_b32 v222, 0
v_mov_b32 v223, 0
v_mov_b32 v224, 0
v_mov_b32 v225, 0
v_mov_b32 v226, 0
v_mov_b32 v227, 0
v_mov_b32 v228, 0
v_mov_b32 v229, 0
v_mov_b32 v230, 0
v_mov_b32 v231, 0
v_mov_b32 v232, 0
v_mov_b32 v233, 0
v_mov_b32 v234, 0
v_mov_b32 v235, 0
v_mov_b32 v236, 0
v_mov_b32 v237, 0
v_mov_b32 v238, 0
v_mov_b32 v239, 0
v_mov_b32 v240, 0
v_mov_b32 v241, 0
v_mov_b32 v242, 0
v_mov_b32 v243, 0
v_mov_b32 v244, 0
v_mov_b32 v245, 0
v_mov_b32 v246, 0
v_mov_b32 v247, 0
v_mov_b32 v248, 0
v_mov_b32 v249, 0
v_mov_b32 v250, 0
v_mov_b32 v251, 0
v_mov_b32 v252, 0
v_mov_b32 v253, 0
v_mov_b32 v254, 0
v_mov_b32 v255, 0
s_waitcnt vmcnt(16)
s_barrier
ds_read_b128 a[0:3], v1 offset:8192
ds_read_b128 a[4:7], v1 offset:9216
ds_read_b128 a[8:11], v1 offset:10240
ds_read_b128 a[12:15], v1 offset:11264
ds_read_b128 a[16:19], v1 offset:12288
ds_read_b128 a[20:23], v1 offset:13312
ds_read_b128 a[24:27], v1 offset:14336
ds_read_b128 a[28:31], v1 offset:15360
s_waitcnt lgkmcnt(0)
s_branch L_att_start
.section .rodata,"a"
.p2align 6
.amdhsa_kernel gated_mix__compressed_kv_cla__sliding_local_dilated__prompt_kernel
  .amdhsa_next_free_vgpr 512
  .amdhsa_next_free_sgpr 102
  .amdhsa_accum_offset 256
  .amdhsa_group_segment_fixed_size 0
  .amdhsa_kernarg_size 104
  .amdhsa_user_sgpr_count 2
  .amdhsa_user_sgpr_kernarg_segment_ptr 1
  .amdhsa_system_sgpr_workgroup_id_x 1
.end_amdhsa_kernel
```

```asm
; @launch grid=(256,1,1) block=(256,1,1) lds=163840
.amdgcn_target "amdgcn-amd-amdhsa--gfx950"
.text
.globl gated_mix__compressed_kv_cla__sliding_local_dilated__prompt_kernel
.p2align 8
.type gated_mix__compressed_kv_cla__sliding_local_dilated__prompt_kernel,@function
gated_mix__compressed_kv_cla__sliding_local_dilated__prompt_kernel:
s_load_dwordx16 s[16:31], s[0:1], 0
s_load_dwordx8 s[32:39], s[0:1], 64
s_load_dwordx2 s[88:89], s[0:1], 96
s_cmp_ge_u32 s2, 256
s_cbranch_scc1 L_end
v_lshrrev_b32 v1, 6, v0
v_and_b32 v0, 63, v0
v_readfirstlane_b32 s4, v1
v_lshlrev_b32 v16, 4, v0
s_lshr_b32 s8, s2, 3
s_lshl_b32 s8, s8, 2
s_add_u32 s8, s8, s4
s_min_u32 s8, s8, 103
s_lshl_b32 s8, s8, 10
s_getpc_b64 s[92:93]
L_here:
s_add_u32 s8, s8, L_page0-L_here
s_add_u32 s92, s92, s8
s_addc_u32 s93, s93, 0
v_add_u32 v60, s92, v16
v_mov_b32 v61, s93
global_load_dword a120, v[60:61], off sc1
s_and_b32 s5, s2, 7
s_lshl_b32 s5, s5, 2
s_bfe_u32 s3, s2, 0x20003
s_add_u32 s5, s5, s3
s_lshr_b32 s6, s2, 5
s_mov_b32 s12, 0x4000
s_mov_b32 s13, 0x8000
s_mov_b32 s14, 0xc000
s_mov_b32 s46, 0x400000
s_mov_b32 s47, 0x20000
s_mov_b32 s50, 0x200000
s_mov_b32 s51, 0x20000
s_mov_b32 s54, 0x800000
s_mov_b32 s55, 0x20000
s_mov_b32 s58, 0x400000
s_mov_b32 s59, 0x20000
s_mov_b32 s62, 0x400000
s_mov_b32 s63, 0x20000
s_mov_b32 s66, 0x800000
s_mov_b32 s67, 0x20000
s_mov_b32 s70, 0x600000
s_mov_b32 s71, 0x20000
s_mov_b32 s74, 0x200000
s_mov_b32 s75, 0x20000
s_mov_b32 s78, 0x800
s_mov_b32 s79, 0x20000
s_mov_b32 s82, 0x400000
s_mov_b32 s83, 0x20000
s_mov_b32 s86, 0x100
s_mov_b32 s87, 0x20000
s_mov_b32 s90, 0x10000000
s_mov_b32 s91, 0x20000
v_bfe_u32 v17, v0, 2, 2
s_lshl_b32 s8, s4, 4
v_add_u32 v17, s8, v17
v_lshlrev_b32 v17, 13, v17
v_lshrrev_b32 v18, 4, v0
v_lshl_add_u32 v17, v18, 6, v17
v_and_b32 v18, 3, v0
v_lshl_add_u32 v17, v18, 4, v17
s_lshl_b32 s8, s5, 8
v_add_u32 v5, s8, v17
v_xor_b32 v6, 32, v5
v_add_u32 v6, 0x10000, v6
v_lshrrev_b32 v17, 4, v0
v_xor_b32 v17, v17, v0
v_and_b32 v17, 7, v17
v_lshlrev_b32 v17, 4, v17
v_lshrrev_b32 v18, 3, v0
v_lshl_add_u32 v2, v18, 10, v17
s_lshl_b32 s8, s6, 18
s_lshl_b32 s9, s4, 16
s_add_u32 s8, s8, s9
v_add_u32 v2, s8, v2
v_xor_b32 v3, 64, v2
v_add_u32 v3, 0x2000, v3
s_lshl_b32 s42, s3, 1
s_add_u32 s42, s42, s6
s_and_b32 s43, s42, 3
s_sub_u32 s43, s43, s3
s_and_b32 s41, s43, 7
s_and_b32 s43, s43, 15
s_mul_i32 s40, s3, -8
s_lshl_b32 s40, 4, s40
s_mul_i32 s42, s42, -8
s_lshl_b32 s42, 4, s42
s_add_u32 s40, s40, 0x21212121
s_sub_u32 s40, s40, s42
s_mov_b32 s40, 0x21212121
s_mov_b32 s41, 0
s_mov_b32 s43, 0
v_lshl_add_u32 v5, s41, 19, v5
v_lshl_add_u32 v6, s41, 19, v6
v_lshl_add_u32 v2, s41, 7, v2
v_lshl_add_u32 v3, s41, 7, v3
s_sub_u32 s10, 15, s6
s_cmp_lt_u32 s5, 16
s_cselect_b32 s10, s6, s10
s_lshl_b32 s10, s10, 4
s_and_b32 s11, s5, 15
s_add_u32 s10, s10, s11
s_lshl_b32 s10, s10, 3
s_lshl_b32 s11, s4, 1
s_add_u32 s10, s10, s11
s_lshl_b32 s100, s10, 11
s_lshl_b32 s101, s10, 2
s_add_u32 s101, s101, 0x3700000
s_lshl_b32 s8, s2, 2
s_add_u32 s8, s8, s4
s_lshl_b32 s8, s8, 11
v_lshrrev_b32 v19, 2, v0
v_lshl_add_u32 v19, v19, 7, s8
s_lshr_b32 s8, s2, 3
s_lshl_b32 s8, s8, 2
s_add_u32 s8, s8, s4
s_lshl_b32 s8, s8, 4
s_and_b32 s9, s2, 7
s_add_u32 s8, s8, s9
s_lshl_b32 s8, s8, 10
v_bfe_u32 v63, v0, 2, 3
v_lshl_add_u32 v63, v63, 7, s8
v_lshrrev_b32 v59, 5, v0
v_lshl_add_u32 v63, v59, 13, v63
v_mov_b32 v62, v19
s_waitcnt lgkmcnt(0)
s_mov_b64 s[48:49], s[18:19]
s_mov_b64 s[56:57], s[22:23]
s_mov_b64 s[60:61], s[24:25]
L_args:
s_mov_b64 s[0:1], s[92:93]
s_mov_b64 s[44:45], s[16:17]
s_mov_b64 s[76:77], s[34:35]
s_mov_b64 s[52:53], s[20:21]
s_mov_b64 s[64:65], s[26:27]
s_mov_b64 s[68:69], s[30:31]
s_mov_b64 s[72:73], s[32:33]
s_mov_b64 s[80:81], s[36:37]
s_mov_b64 s[84:85], s[38:39]
s_lshl_b32 s16, s4, 13
s_add_u32 s16, s16, 0x18000
s_lshl_b32 s17, s4, 12
s_lshl_b32 s18, s4, 10
s_mov_b32 s25, 0x800
s_mov_b32 s26, 0x1000
s_mov_b32 s3, 0
s_mov_b32 s9, 0x0
s_nop 0
buffer_load_dword a120, v63, s[56:59], s9 offen
s_mov_b32 s9, 0x0
s_nop 0
buffer_load_dword a120, v63, s[60:63], s9 offen
s_add_u32 m0, s17, 0x0
s_nop 0
buffer_load_dwordx4 v5, s[56:59], 0 offen lds
s_add_u32 m0, s17, 0x4000
s_nop 0
buffer_load_dwordx4 v5, s[60:63], 0 offen lds
s_add_u32 m0, s17, 0x400
s_nop 0
buffer_load_dwordx4 v5, s[56:59], s13 offen lds
s_add_u32 m0, s17, 0x4400
s_nop 0
buffer_load_dwordx4 v5, s[60:63], s13 offen lds
s_add_u32 m0, s17, 0x800
s_nop 0
buffer_load_dwordx4 v6, s[56:59], 0 offen lds
s_add_u32 m0, s17, 0x4800
s_nop 0
buffer_load_dwordx4 v6, s[60:63], 0 offen lds
s_add_u32 m0, s17, 0xc00
s_nop 0
buffer_load_dwordx4 v6, s[56:59], s13 offen lds
s_add_u32 m0, s17, 0x4c00
s_nop 0
buffer_load_dwordx4 v6, s[60:63], s13 offen lds
s_bfe_u32 s39, s40, 0x80008
s_add_u32 s39, s39, s41
s_and_b32 s39, s39, 7
s_sub_u32 s42, s39, s41
s_mov_b32 s41, s39
v_lshl_add_u32 v5, s42, 19, v5
v_lshl_add_u32 v6, s42, 19, v6
s_add_u32 m0, s16, 0x0
s_nop 0
buffer_load_dwordx4 v2, s[48:51], 0 offen lds
s_add_u32 m0, s16, 0x400
s_nop 0
buffer_load_dwordx4 v3, s[48:51], 0 offen lds
s_add_u32 m0, s16, 0x800
s_nop 0
buffer_load_dwordx4 v2, s[48:51], s12 offen lds
s_add_u32 m0, s16, 0xc00
s_nop 0
buffer_load_dwordx4 v3, s[48:51], s12 offen lds
s_add_u32 m0, s16, 0x1000
s_nop 0
buffer_load_dwordx4 v2, s[48:51], s13 offen lds
s_add_u32 m0, s16, 0x1400
s_nop 0
buffer_load_dwordx4 v3, s[48:51], s13 offen lds
s_add_u32 m0, s16, 0x1800
s_nop 0
buffer_load_dwordx4 v2, s[48:51], s14 offen lds
s_add_u32 m0, s16, 0x1c00
s_nop 0
buffer_load_dwordx4 v3, s[48:51], s14 offen lds
v_lshl_add_u32 v2, s42, 7, v2
v_lshl_add_u32 v3, s42, 7, v3
L_hopA:
s_mov_b32 s95, 1
s_cmp_eq_u32 s4, 0
s_cbranch_scc1 L_padA0
s_cmp_eq_u32 s4, 1
s_cbranch_scc1 L_padA1
s_cmp_eq_u32 s4, 2
s_cbranch_scc1 L_padA2
s_branch L_padA3
L_hopA_ret:
s_mov_b32 s95, 0
v_lshrrev_b32 v17, 4, v0
v_xor_b32 v17, v17, v0
v_and_b32 v17, 7, v17
v_lshlrev_b32 v17, 4, v17
v_lshrrev_b32 v18, 3, v0
v_lshl_add_u32 v22, v18, 11, v17
v_xor_b32 v23, 64, v22
v_add_u32 v23, 0x4000, v23
s_and_b32 s8, s4, 1
s_lshl_b32 s9, s8, 6
s_lshl_b32 s8, s8, 14
v_xor_b32 v4, s9, v22
v_add_u32 v4, s8, v4
s_lshl_b32 s8, s6, 18
s_sub_u32 s9, 15, s6
s_lshl_b32 s9, s9, 18
s_lshl_b32 s10, s4, 15
s_sub_u32 s11, 0x38000, s10
s_add_u32 s20, s8, s10
s_add_u32 s21, s8, s11
s_add_u32 s22, s9, s10
s_add_u32 s23, s9, s11
s_cmp_lt_u32 s4, 2
s_cselect_b32 s24, s8, s9
s_max_u32 s24, s24, 0x8000
s_sub_u32 s24, s24, 0x8000
v_lshrrev_b32 v17, 2, v0
s_lshl_b32 s8, s4, 4
v_add_u32 v17, s8, v17
v_mul_u32_u24 v17, 0x1800, v17
v_and_b32 v18, 3, v0
v_lshlrev_b32 v18, 4, v18
v_and_b32 v19, 32, v0
v_xor_b32 v18, v18, v19
s_lshl_b32 s8, s5, 6
v_add3_u32 v7, v17, v18, s8
v_lshl_add_u32 v22, s43, 7, v22
v_lshl_add_u32 v23, s43, 7, v23
v_lshl_add_u32 v4, s43, 7, v4
v_lshl_add_u32 v7, s43, 18, v7
v_lshl_add_u32 v7, s43, 17, v7
v_and_b32 v17, 15, v0
v_lshrrev_b32 v18, 1, v17
v_lshrrev_b32 v19, 4, v0
v_xor_b32 v18, v18, v19
v_lshlrev_b32 v18, 4, v18
v_lshl_add_u32 v10, v17, 7, v18
v_add_u32 v8, s16, v10
v_xor_b32 v9, 64, v8
s_lshr_b32 s8, s4, 1
s_lshl_b32 s8, s8, 11
s_add_u32 s8, s8, 94208
v_add_u32 v10, s8, v10
v_xor_b32 v11, 64, v10
v_lshrrev_b32 v17, 4, v0
v_lshlrev_b32 v18, 11, v17
v_and_b32 v17, 1, v17
v_lshl_add_u32 v18, v17, 5, v18
v_bfe_u32 v17, v0, 2, 2
v_lshl_add_u32 v18, v17, 6, v18
v_and_b32 v17, 3, v0
v_lshl_add_u32 v12, v17, 3, v18
v_xor_b32 v13, 32, v12
v_lshrrev_b32 v17, 4, v0
v_lshlrev_b32 v18, 9, v17
v_and_b32 v17, 1, v17
v_lshl_add_u32 v18, v17, 5, v18
v_bfe_u32 v17, v0, 2, 2
v_lshl_add_u32 v18, v17, 6, v18
v_and_b32 v17, 3, v0
v_lshl_add_u32 v14, v17, 3, v18
s_and_b32 s8, s4, 1
s_lshl_b32 s8, s8, 5
v_xor_b32 v14, s8, v14
v_add_u32 v14, 81920, v14
v_xor_b32 v15, 32, v14
s_mul_i32 s32, s5, 0x10c400
s_lshl_b32 s19, s4, 13
s_add_u32 s32, s32, s19
s_cmp_eq_u32 s4, 0
s_cselect_b32 s94, 0x200000, 0
s_add_u32 s32, s32, s94
s_sub_u32 s94, 0x8000, s94
s_add_u32 s7, s32, 0x1000
s_add_u32 s27, s19, 131072
s_add_u32 m0, s16, 0x8000
s_nop 0
buffer_load_dwordx4 v2, s[48:51], 0 offen lds
s_add_u32 m0, s16, 0x8400
s_nop 0
buffer_load_dwordx4 v3, s[48:51], 0 offen lds
s_add_u32 m0, s16, 0x8800
s_nop 0
buffer_load_dwordx4 v2, s[48:51], s12 offen lds
s_add_u32 m0, s16, 0x8c00
s_nop 0
buffer_load_dwordx4 v3, s[48:51], s12 offen lds
s_add_u32 m0, s16, 0x9000
s_nop 0
buffer_load_dwordx4 v2, s[48:51], s13 offen lds
s_add_u32 m0, s16, 0x9400
s_nop 0
buffer_load_dwordx4 v3, s[48:51], s13 offen lds
s_add_u32 m0, s16, 0x9800
s_nop 0
buffer_load_dwordx4 v2, s[48:51], s14 offen lds
s_add_u32 m0, s16, 0x9c00
s_nop 0
buffer_load_dwordx4 v3, s[48:51], s14 offen lds
s_bfe_u32 s39, s40, 0x80010
s_add_u32 s39, s39, s41
s_and_b32 s39, s39, 7
s_sub_u32 s42, s39, s41
s_mov_b32 s41, s39
v_lshl_add_u32 v2, s42, 7, v2
v_lshl_add_u32 v3, s42, 7, v3
s_mov_b32 s9, 0x0
s_nop 0
buffer_load_dword a120, v62, s[48:51], s9 offen
v_mov_b32 v19, v62
v_mov_b32 v18, v63
s_cmp_lg_u32 s4, 0
s_cbranch_scc1 L_flag_clr
s_lshl_b32 s8, s6, 5
s_add_u32 s8, s8, s5
s_and_b32 s92, s8, 0xf0
s_mul_i32 s92, s92, 3
s_add_u32 s8, s8, s92
s_lshl_b32 s8, s8, 2
s_add_u32 s8, s8, 0x3704000
v_mov_b32 v17, 0
s_mov_b64 exec, 1
buffer_store_dword v17, off, s[88:91], s8 sc1
s_mov_b64 exec, -1
L_flag_clr:
s_waitcnt vmcnt(9)
s_barrier
s_branch L_main
.p2align 12
L_page0:
L_padA0:
s_branch L_padA4
L_main:
ds_read_b64_tr_b16 a[80:81], v12 offset:0
ds_read_b64_tr_b16 a[82:83], v12 offset:1024
ds_read_b64_tr_b16 a[84:85], v12 offset:8192
ds_read_b64_tr_b16 a[86:87], v12 offset:9216
ds_read_b128 a[0:3], v8 offset:0
ds_read_b128 a[20:23], v9 offset:0
ds_read_b128 a[4:7], v8 offset:2048
ds_read_b128 a[24:27], v9 offset:2048
ds_read_b128 a[8:11], v8 offset:4096
ds_read_b128 a[28:31], v9 offset:4096
ds_read_b128 a[12:15], v8 offset:6144
ds_read_b128 a[32:35], v9 offset:6144
ds_read_b64_tr_b16 a[88:89], v13 offset:0
ds_read_b64_tr_b16 a[90:91], v13 offset:1024
ds_read_b64_tr_b16 a[92:93], v13 offset:8192
ds_read_b64_tr_b16 a[94:95], v13 offset:9216
ds_read_b64_tr_b16 a[96:97], v12 offset:256
ds_read_b64_tr_b16 a[98:99], v12 offset:1280
ds_read_b64_tr_b16 a[100:101], v12 offset:8448
ds_read_b64_tr_b16 a[102:103], v12 offset:9472
s_waitcnt lgkmcnt(0)
L_S0:
v_mfma_f32_16x16x32_bf16 v[24:27], a[80:83], a[0:3], 0
ds_read_b64_tr_b16 a[104:105], v13 offset:256
s_add_u32 m0, s17, 0x8000
v_mfma_f32_16x16x32_bf16 v[24:27], a[84:87], a[20:23], v[24:27]
buffer_load_dwordx4 v5, s[56:59], 0 offen lds
v_mfma_f32_16x16x32_bf16 v[32:35], a[84:87], a[24:27], 0
ds_read_b64_tr_b16 a[106:107], v13 offset:1280
v_mfma_f32_16x16x32_bf16 v[32:35], a[80:83], a[4:7], v[32:35]
ds_read_b64_tr_b16 a[108:109], v13 offset:8448
v_mfma_f32_16x16x32_bf16 v[40:43], a[80:83], a[8:11], 0
ds_read_b64_tr_b16 a[110:111], v13 offset:9472
v_mfma_f32_16x16x32_bf16 v[40:43], a[84:87], a[28:31], v[40:43]
s_add_u32 m0, s17, 0xc000
v_mfma_f32_16x16x32_bf16 v[48:51], a[84:87], a[32:35], 0
buffer_load_dwordx4 v5, s[60:63], 0 offen lds
v_mfma_f32_16x16x32_bf16 v[48:51], a[80:83], a[12:15], v[48:51]
v_mfma_f32_16x16x32_bf16 v[52:55], a[88:91], a[12:15], 0
ds_read_b64_tr_b16 a[80:81], v12 offset:512
v_mfma_f32_16x16x32_bf16 v[52:55], a[92:95], a[32:35], v[52:55]
ds_read_b64_tr_b16 a[82:83], v12 offset:1536
v_mfma_f32_16x16x32_bf16 v[44:47], a[92:95], a[28:31], 0
ds_read_b64_tr_b16 a[84:85], v12 offset:8704
s_add_u32 m0, s17, 0x8400
v_mfma_f32_16x16x32_bf16 v[44:47], a[88:91], a[8:11], v[44:47]
buffer_load_dwordx4 v5, s[56:59], s13 offen lds
v_mfma_f32_16x16x32_bf16 v[36:39], a[88:91], a[4:7], 0
ds_read_b64_tr_b16 a[86:87], v12 offset:9728
v_mfma_f32_16x16x32_bf16 v[36:39], a[92:95], a[24:27], v[36:39]
v_mfma_f32_16x16x32_bf16 v[28:31], a[92:95], a[20:23], 0
v_mfma_f32_16x16x32_bf16 v[28:31], a[88:91], a[0:3], v[28:31]
s_add_u32 m0, s17, 0xc400
v_mfma_f32_16x16x32_bf16 v[56:59], a[96:99], a[0:3], 0
buffer_load_dwordx4 v5, s[60:63], s13 offen lds
v_mfma_f32_16x16x32_bf16 v[56:59], a[100:103], a[20:23], v[56:59]
ds_read_b64_tr_b16 a[88:89], v13 offset:512
v_mfma_f32_16x16x32_bf16 v[64:67], a[100:103], a[24:27], 0
ds_read_b64_tr_b16 a[90:91], v13 offset:1536
v_mfma_f32_16x16x32_bf16 v[64:67], a[96:99], a[4:7], v[64:67]
ds_read_b64_tr_b16 a[92:93], v13 offset:8704
v_mfma_f32_16x16x32_bf16 v[72:75], a[96:99], a[8:11], 0
ds_read_b64_tr_b16 a[94:95], v13 offset:9728
s_add_u32 m0, s17, 0x8800
v_mfma_f32_16x16x32_bf16 v[72:75], a[100:103], a[28:31], v[72:75]
buffer_load_dwordx4 v6, s[56:59], 0 offen lds
v_mfma_f32_16x16x32_bf16 v[80:83], a[100:103], a[32:35], 0
v_mfma_f32_16x16x32_bf16 v[80:83], a[96:99], a[12:15], v[80:83]
s_waitcnt lgkmcnt(10)
v_mfma_f32_16x16x32_bf16 v[84:87], a[104:107], a[12:15], 0
ds_read_b64_tr_b16 a[96:97], v12 offset:768
s_waitcnt lgkmcnt(9)
v_mfma_f32_16x16x32_bf16 v[84:87], a[108:111], a[32:35], v[84:87]
ds_read_b64_tr_b16 a[98:99], v12 offset:1792
s_add_u32 m0, s17, 0xc800
v_mfma_f32_16x16x32_bf16 v[76:79], a[108:111], a[28:31], 0
buffer_load_dwordx4 v6, s[60:63], 0 offen lds
v_mfma_f32_16x16x32_bf16 v[76:79], a[104:107], a[8:11], v[76:79]
ds_read_b64_tr_b16 a[100:101], v12 offset:8960
v_mfma_f32_16x16x32_bf16 v[68:71], a[104:107], a[4:7], 0
ds_read_b64_tr_b16 a[102:103], v12 offset:9984
v_mfma_f32_16x16x32_bf16 v[68:71], a[108:111], a[24:27], v[68:71]
v_mfma_f32_16x16x32_bf16 v[60:63], a[108:111], a[20:23], 0
s_add_u32 m0, s17, 0x8c00
s_waitcnt lgkmcnt(4)
v_mfma_f32_16x16x32_bf16 v[60:63], a[104:107], a[0:3], v[60:63]
buffer_load_dwordx4 v6, s[56:59], s13 offen lds
v_mfma_f32_16x16x32_bf16 v[88:91], a[80:83], a[0:3], 0
ds_read_b64_tr_b16 a[104:105], v13 offset:768
v_mfma_f32_16x16x32_bf16 v[88:91], a[84:87], a[20:23], v[88:91]
ds_read_b64_tr_b16 a[106:107], v13 offset:1792
v_mfma_f32_16x16x32_bf16 v[96:99], a[84:87], a[24:27], 0
ds_read_b64_tr_b16 a[108:109], v13 offset:8960
v_mfma_f32_16x16x32_bf16 v[96:99], a[80:83], a[4:7], v[96:99]
ds_read_b64_tr_b16 a[110:111], v13 offset:9984
s_add_u32 m0, s17, 0xcc00
v_mfma_f32_16x16x32_bf16 v[104:107], a[80:83], a[8:11], 0
buffer_load_dwordx4 v6, s[60:63], s13 offen lds
v_mfma_f32_16x16x32_bf16 v[104:107], a[84:87], a[28:31], v[104:107]
v_lshl_add_u32 v5, s42, 19, v5
v_lshl_add_u32 v6, s42, 19, v6
v_mfma_f32_16x16x32_bf16 v[112:115], a[84:87], a[32:35], 0
v_mfma_f32_16x16x32_bf16 v[112:115], a[80:83], a[12:15], v[112:115]
v_mfma_f32_16x16x32_bf16 v[116:119], a[88:91], a[12:15], 0
ds_read_b64_tr_b16 a[80:81], v12 offset:16384
s_add_u32 m0, s16, 0x0
v_mfma_f32_16x16x32_bf16 v[116:119], a[92:95], a[32:35], v[116:119]
buffer_load_dwordx4 v2, s[48:51], 0 offen lds
v_mfma_f32_16x16x32_bf16 v[108:111], a[92:95], a[28:31], 0
ds_read_b64_tr_b16 a[82:83], v12 offset:17408
v_mfma_f32_16x16x32_bf16 v[108:111], a[88:91], a[8:11], v[108:111]
ds_read_b64_tr_b16 a[84:85], v12 offset:24576
v_mfma_f32_16x16x32_bf16 v[100:103], a[88:91], a[4:7], 0
ds_read_b64_tr_b16 a[86:87], v12 offset:25600
v_mfma_f32_16x16x32_bf16 v[100:103], a[92:95], a[24:27], v[100:103]
s_add_u32 m0, s16, 0x400
v_mfma_f32_16x16x32_bf16 v[92:95], a[92:95], a[20:23], 0
buffer_load_dwordx4 v3, s[48:51], 0 offen lds
v_mfma_f32_16x16x32_bf16 v[92:95], a[88:91], a[0:3], v[92:95]
s_waitcnt lgkmcnt(4)
v_mfma_f32_16x16x32_bf16 v[120:123], a[96:99], a[0:3], 0
ds_read_b64_tr_b16 a[88:89], v13 offset:16384
s_waitcnt vmcnt(11)
v_mfma_f32_16x16x32_bf16 v[120:123], a[100:103], a[20:23], v[120:123]
ds_read_b64_tr_b16 a[90:91], v13 offset:17408
v_mfma_f32_16x16x32_bf16 v[128:131], a[100:103], a[24:27], 0
ds_read_b64_tr_b16 a[92:93], v13 offset:24576
s_add_u32 m0, s16, 0x800
v_mfma_f32_16x16x32_bf16 v[128:131], a[96:99], a[4:7], v[128:131]
buffer_load_dwordx4 v2, s[48:51], s12 offen lds
v_mfma_f32_16x16x32_bf16 v[136:139], a[96:99], a[8:11], 0
ds_read_b64_tr_b16 a[94:95], v13 offset:25600
v_mfma_f32_16x16x32_bf16 v[136:139], a[100:103], a[28:31], v[136:139]
ds_read_b128 a[40:43], v8 offset:32768
v_mfma_f32_16x16x32_bf16 v[144:147], a[100:103], a[32:35], 0
ds_read_b128 a[60:63], v9 offset:32768
v_mfma_f32_16x16x32_bf16 v[144:147], a[96:99], a[12:15], v[144:147]
ds_read_b128 a[44:47], v8 offset:34816
s_add_u32 m0, s16, 0xc00
v_mfma_f32_16x16x32_bf16 v[148:151], a[104:107], a[12:15], 0
buffer_load_dwordx4 v3, s[48:51], s12 offen lds
v_mfma_f32_16x16x32_bf16 v[148:151], a[108:111], a[32:35], v[148:151]
ds_read_b64_tr_b16 a[96:97], v12 offset:16640
v_mfma_f32_16x16x32_bf16 v[140:143], a[108:111], a[28:31], 0
ds_read_b64_tr_b16 a[98:99], v12 offset:17664
v_mfma_f32_16x16x32_bf16 v[140:143], a[104:107], a[8:11], v[140:143]
ds_read_b64_tr_b16 a[100:101], v12 offset:24832
v_mfma_f32_16x16x32_bf16 v[132:135], a[104:107], a[4:7], 0
ds_read_b64_tr_b16 a[102:103], v12 offset:25856
s_add_u32 m0, s16, 0x1000
v_mfma_f32_16x16x32_bf16 v[132:135], a[108:111], a[24:27], v[132:135]
buffer_load_dwordx4 v2, s[48:51], s13 offen lds
v_mfma_f32_16x16x32_bf16 v[124:127], a[108:111], a[20:23], 0
ds_read_b128 a[64:67], v9 offset:34816
v_mfma_f32_16x16x32_bf16 v[124:127], a[104:107], a[0:3], v[124:127]
ds_read_b128 a[48:51], v8 offset:36864
s_waitcnt lgkmcnt(9)
v_mfma_f32_16x16x32_bf16 v[152:155], a[0:3], a[80:83], 0
ds_read_b64_tr_b16 a[104:105], v13 offset:16640
v_mfma_f32_16x16x32_bf16 v[152:155], a[20:23], a[84:87], v[152:155]
ds_read_b64_tr_b16 a[106:107], v13 offset:17664
s_add_u32 m0, s16, 0x1400
v_mfma_f32_16x16x32_bf16 v[156:159], a[24:27], a[84:87], 0
buffer_load_dwordx4 v3, s[48:51], s13 offen lds
v_mfma_f32_16x16x32_bf16 v[156:159], a[4:7], a[80:83], v[156:159]
ds_read_b64_tr_b16 a[108:109], v13 offset:24832
v_mfma_f32_16x16x32_bf16 v[160:163], a[8:11], a[80:83], 0
ds_read_b64_tr_b16 a[110:111], v13 offset:25856
v_mfma_f32_16x16x32_bf16 v[160:163], a[28:31], a[84:87], v[160:163]
ds_read_b128 a[68:71], v9 offset:36864
v_mfma_f32_16x16x32_bf16 v[164:167], a[32:35], a[84:87], 0
ds_read_b128 a[52:55], v8 offset:38912
s_add_u32 m0, s16, 0x1800
v_mfma_f32_16x16x32_bf16 v[164:167], a[12:15], a[80:83], v[164:167]
buffer_load_dwordx4 v2, s[48:51], s14 offen lds
v_mfma_f32_16x16x32_bf16 v[180:183], a[12:15], a[88:91], 0
ds_read_b64_tr_b16 a[80:81], v12 offset:16896
v_mfma_f32_16x16x32_bf16 v[180:183], a[32:35], a[92:95], v[180:183]
ds_read_b64_tr_b16 a[82:83], v12 offset:17920
v_mfma_f32_16x16x32_bf16 v[176:179], a[28:31], a[92:95], 0
ds_read_b64_tr_b16 a[84:85], v12 offset:25088
v_mfma_f32_16x16x32_bf16 v[176:179], a[8:11], a[88:91], v[176:179]
ds_read_b64_tr_b16 a[86:87], v12 offset:26112
s_add_u32 m0, s16, 0x1c00
v_mfma_f32_16x16x32_bf16 v[172:175], a[4:7], a[88:91], 0
buffer_load_dwordx4 v3, s[48:51], s14 offen lds
v_mfma_f32_16x16x32_bf16 v[172:175], a[24:27], a[92:95], v[172:175]
ds_read_b128 a[72:75], v9 offset:38912
s_bfe_u32 s39, s40, 0x80018
v_mfma_f32_16x16x32_bf16 v[168:171], a[20:23], a[92:95], 0
s_add_u32 s39, s39, s41
s_and_b32 s39, s39, 7
s_sub_u32 s42, s39, s41
v_mfma_f32_16x16x32_bf16 v[168:171], a[0:3], a[88:91], v[168:171]
s_waitcnt lgkmcnt(7)
s_mov_b32 s41, s39
v_lshl_add_u32 v2, s42, 7, v2
v_mfma_f32_16x16x32_bf16 v[184:187], a[0:3], a[96:99], 0
ds_read_b64_tr_b16 a[88:89], v13 offset:16896
s_add_u32 m0, s17, 0x10000
v_mfma_f32_16x16x32_bf16 v[184:187], a[20:23], a[100:103], v[184:187]
buffer_load_dwordx4 v5, s[56:59], 0 offen lds
v_mfma_f32_16x16x32_bf16 v[188:191], a[24:27], a[100:103], 0
ds_read_b64_tr_b16 a[90:91], v13 offset:17920
v_lshl_add_u32 v3, s42, 7, v3
v_mfma_f32_16x16x32_bf16 v[188:191], a[4:7], a[96:99], v[188:191]
ds_read_b64_tr_b16 a[92:93], v13 offset:25088
v_mfma_f32_16x16x32_bf16 v[192:195], a[8:11], a[96:99], 0
ds_read_b64_tr_b16 a[94:95], v13 offset:26112
v_mfma_f32_16x16x32_bf16 v[192:195], a[28:31], a[100:103], v[192:195]
s_add_u32 m0, s17, 0x14000
v_mfma_f32_16x16x32_bf16 v[196:199], a[32:35], a[100:103], 0
buffer_load_dwordx4 v5, s[60:63], 0 offen lds
v_mfma_f32_16x16x32_bf16 v[196:199], a[12:15], a[96:99], v[196:199]
v_mfma_f32_16x16x32_bf16 v[212:215], a[12:15], a[104:107], 0
ds_read_b64_tr_b16 a[96:97], v12 offset:17152
v_mfma_f32_16x16x32_bf16 v[212:215], a[32:35], a[108:111], v[212:215]
ds_read_b64_tr_b16 a[98:99], v12 offset:18176
v_mfma_f32_16x16x32_bf16 v[208:211], a[28:31], a[108:111], 0
ds_read_b64_tr_b16 a[100:101], v12 offset:25344
s_add_u32 m0, s17, 0x10400
v_mfma_f32_16x16x32_bf16 v[208:211], a[8:11], a[104:107], v[208:211]
buffer_load_dwordx4 v5, s[56:59], s13 offen lds
v_mfma_f32_16x16x32_bf16 v[204:207], a[4:7], a[104:107], 0
ds_read_b64_tr_b16 a[102:103], v12 offset:26368
v_mfma_f32_16x16x32_bf16 v[204:207], a[24:27], a[108:111], v[204:207]
v_mfma_f32_16x16x32_bf16 v[200:203], a[20:23], a[108:111], 0
v_mfma_f32_16x16x32_bf16 v[200:203], a[0:3], a[104:107], v[200:203]
s_add_u32 m0, s17, 0x14400
s_waitcnt lgkmcnt(4)
v_mfma_f32_16x16x32_bf16 v[248:251], a[0:3], a[80:83], 0
buffer_load_dwordx4 v5, s[60:63], s13 offen lds
v_mfma_f32_16x16x32_bf16 v[248:251], a[20:23], a[84:87], v[248:251]
ds_read_b64_tr_b16 a[104:105], v13 offset:17152
v_mfma_f32_16x16x32_bf16 v[252:255], a[24:27], a[84:87], 0
ds_read_b64_tr_b16 a[106:107], v13 offset:18176
v_mfma_f32_16x16x32_bf16 v[252:255], a[4:7], a[80:83], v[252:255]
ds_read_b64_tr_b16 a[108:109], v13 offset:25344
v_mfma_f32_16x16x32_bf16 v[216:219], a[8:11], a[80:83], 0
ds_read_b64_tr_b16 a[110:111], v13 offset:26368
s_add_u32 m0, s17, 0x10800
v_mfma_f32_16x16x32_bf16 v[216:219], a[28:31], a[84:87], v[216:219]
buffer_load_dwordx4 v6, s[56:59], 0 offen lds
v_mfma_f32_16x16x32_bf16 v[220:223], a[32:35], a[84:87], 0
v_add_u32 v12, 0x8000, v12
v_add_u32 v13, 0x8000, v13
v_mfma_f32_16x16x32_bf16 v[220:223], a[12:15], a[80:83], v[220:223]
v_mfma_f32_16x16x32_bf16 v[236:239], a[12:15], a[88:91], 0
s_waitcnt vmcnt(13) lgkmcnt(0)
v_mfma_f32_16x16x32_bf16 v[236:239], a[32:35], a[92:95], v[236:239]
s_barrier
s_add_u32 m0, s17, 0x14800
v_mfma_f32_16x16x32_bf16 v[232:235], a[28:31], a[92:95], 0
buffer_load_dwordx4 v6, s[60:63], 0 offen lds
v_mfma_f32_16x16x32_bf16 v[232:235], a[8:11], a[88:91], v[232:235]
ds_read_b64_tr_b16 a[80:81], v12 offset:0
v_mfma_f32_16x16x32_bf16 v[228:231], a[4:7], a[88:91], 0
ds_read_b64_tr_b16 a[82:83], v12 offset:1024
v_mfma_f32_16x16x32_bf16 v[228:231], a[24:27], a[92:95], v[228:231]
ds_read_b64_tr_b16 a[84:85], v12 offset:8192
s_waitcnt lgkmcnt(3)
v_mfma_f32_16x16x32_bf16 v[224:227], a[20:23], a[92:95], 0
ds_read_b64_tr_b16 a[86:87], v12 offset:9216
s_add_u32 m0, s17, 0x10c00
v_mfma_f32_16x16x32_bf16 v[224:227], a[0:3], a[88:91], v[224:227]
buffer_load_dwordx4 v6, s[56:59], s13 offen lds
v_mfma_f32_16x16x32_bf16 v[240:243], a[0:3], a[96:99], 0
ds_read_b64_tr_b16 a[88:89], v13 offset:0
v_mfma_f32_16x16x32_bf16 v[240:243], a[20:23], a[100:103], v[240:243]
ds_read_b64_tr_b16 a[90:91], v13 offset:1024
v_mfma_f32_16x16x32_bf16 v[244:247], a[24:27], a[100:103], 0
ds_read_b64_tr_b16 a[92:93], v13 offset:8192
v_mfma_f32_16x16x32_bf16 v[244:247], a[4:7], a[96:99], v[244:247]
ds_read_b64_tr_b16 a[94:95], v13 offset:9216
s_add_u32 m0, s17, 0x14c00
v_mfma_f32_16x16x32_bf16 a[232:235], a[8:11], a[96:99], 0
buffer_load_dwordx4 v6, s[60:63], s13 offen lds
v_mfma_f32_16x16x32_bf16 a[232:235], a[28:31], a[100:103], a[232:235]
v_lshl_add_u32 v5, s42, 19, v5
v_lshl_add_u32 v6, s42, 19, v6
v_mfma_f32_16x16x32_bf16 a[236:239], a[32:35], a[100:103], 0
v_mfma_f32_16x16x32_bf16 a[236:239], a[12:15], a[96:99], a[236:239]
s_waitcnt lgkmcnt(15)
v_mfma_f32_16x16x32_bf16 a[252:255], a[12:15], a[104:107], 0
ds_read_b64_tr_b16 a[96:97], v12 offset:256
s_add_u32 m0, s16, 0x8000
v_mfma_f32_16x16x32_bf16 a[252:255], a[32:35], a[108:111], a[252:255]
buffer_load_dwordx4 v2, s[48:51], 0 offen lds
v_mfma_f32_16x16x32_bf16 a[248:251], a[28:31], a[108:111], 0
ds_read_b64_tr_b16 a[98:99], v12 offset:1280
v_mfma_f32_16x16x32_bf16 a[248:251], a[8:11], a[104:107], a[248:251]
ds_read_b64_tr_b16 a[100:101], v12 offset:8448
v_mfma_f32_16x16x32_bf16 a[244:247], a[4:7], a[104:107], 0
ds_read_b64_tr_b16 a[102:103], v12 offset:9472
v_mfma_f32_16x16x32_bf16 a[244:247], a[24:27], a[108:111], a[244:247]
s_add_u32 m0, s16, 0x8400
v_mfma_f32_16x16x32_bf16 a[240:243], a[20:23], a[108:111], 0
buffer_load_dwordx4 v3, s[48:51], 0 offen lds
v_mfma_f32_16x16x32_bf16 a[240:243], a[0:3], a[104:107], a[240:243]
s_waitcnt lgkmcnt(4)
L_S1:
v_mfma_f32_16x16x32_bf16 v[24:27], a[80:83], a[40:43], v[24:27]
ds_read_b64_tr_b16 a[104:105], v13 offset:256
v_mfma_f32_16x16x32_bf16 v[24:27], a[84:87], a[60:63], v[24:27]
ds_read_b64_tr_b16 a[106:107], v13 offset:1280
v_mfma_f32_16x16x32_bf16 v[32:35], a[84:87], a[64:67], v[32:35]
ds_read_b64_tr_b16 a[108:109], v13 offset:8448
s_add_u32 m0, s16, 0x8800
v_mfma_f32_16x16x32_bf16 v[32:35], a[80:83], a[44:47], v[32:35]
buffer_load_dwordx4 v2, s[48:51], s12 offen lds
v_mfma_f32_16x16x32_bf16 v[40:43], a[80:83], a[48:51], v[40:43]
ds_read_b64_tr_b16 a[110:111], v13 offset:9472
v_mfma_f32_16x16x32_bf16 v[40:43], a[84:87], a[68:71], v[40:43]
v_mfma_f32_16x16x32_bf16 v[48:51], a[84:87], a[72:75], v[48:51]
v_mfma_f32_16x16x32_bf16 v[48:51], a[80:83], a[52:55], v[48:51]
s_add_u32 m0, s16, 0x8c00
v_mfma_f32_16x16x32_bf16 v[52:55], a[88:91], a[52:55], v[52:55]
buffer_load_dwordx4 v3, s[48:51], s12 offen lds
v_mfma_f32_16x16x32_bf16 v[52:55], a[92:95], a[72:75], v[52:55]
ds_read_b64_tr_b16 a[80:81], v12 offset:512
v_mfma_f32_16x16x32_bf16 v[44:47], a[92:95], a[68:71], v[44:47]
ds_read_b64_tr_b16 a[82:83], v12 offset:1536
v_mfma_f32_16x16x32_bf16 v[44:47], a[88:91], a[48:51], v[44:47]
ds_read_b64_tr_b16 a[84:85], v12 offset:8704
v_mfma_f32_16x16x32_bf16 v[36:39], a[88:91], a[44:47], v[36:39]
ds_read_b64_tr_b16 a[86:87], v12 offset:9728
s_add_u32 m0, s16, 0x9000
v_mfma_f32_16x16x32_bf16 v[36:39], a[92:95], a[64:67], v[36:39]
buffer_load_dwordx4 v2, s[48:51], s13 offen lds
v_mfma_f32_16x16x32_bf16 v[28:31], a[92:95], a[60:63], v[28:31]
v_mfma_f32_16x16x32_bf16 v[28:31], a[88:91], a[40:43], v[28:31]
s_waitcnt lgkmcnt(4)
v_mfma_f32_16x16x32_bf16 v[56:59], a[96:99], a[40:43], v[56:59]
ds_read_b64_tr_b16 a[88:89], v13 offset:512
v_mfma_f32_16x16x32_bf16 v[56:59], a[100:103], a[60:63], v[56:59]
ds_read_b64_tr_b16 a[90:91], v13 offset:1536
s_add_u32 m0, s16, 0x9400
v_mfma_f32_16x16x32_bf16 v[64:67], a[100:103], a[64:67], v[64:67]
buffer_load_dwordx4 v3, s[48:51], s13 offen lds
v_mfma_f32_16x16x32_bf16 v[64:67], a[96:99], a[44:47], v[64:67]
ds_read_b64_tr_b16 a[92:93], v13 offset:8704
v_mfma_f32_16x16x32_bf16 v[72:75], a[96:99], a[48:51], v[72:75]
ds_read_b64_tr_b16 a[94:95], v13 offset:9728
v_mfma_f32_16x16x32_bf16 v[72:75], a[100:103], a[68:71], v[72:75]
v_mfma_f32_16x16x32_bf16 v[80:83], a[100:103], a[72:75], v[80:83]
s_add_u32 m0, s16, 0x9800
v_mfma_f32_16x16x32_bf16 v[80:83], a[96:99], a[52:55], v[80:83]
buffer_load_dwordx4 v2, s[48:51], s14 offen lds
v_mfma_f32_16x16x32_bf16 v[84:87], a[104:107], a[52:55], v[84:87]
ds_read_b64_tr_b16 a[96:97], v12 offset:768
v_mfma_f32_16x16x32_bf16 v[84:87], a[108:111], a[72:75], v[84:87]
ds_read_b64_tr_b16 a[98:99], v12 offset:1792
v_mfma_f32_16x16x32_bf16 v[76:79], a[108:111], a[68:71], v[76:79]
ds_read_b64_tr_b16 a[100:101], v12 offset:8960
v_mfma_f32_16x16x32_bf16 v[76:79], a[104:107], a[48:51], v[76:79]
ds_read_b64_tr_b16 a[102:103], v12 offset:9984
s_add_u32 m0, s16, 0x9c00
v_mfma_f32_16x16x32_bf16 v[68:71], a[104:107], a[44:47], v[68:71]
buffer_load_dwordx4 v3, s[48:51], s14 offen lds
v_mfma_f32_16x16x32_bf16 v[68:71], a[108:111], a[64:67], v[68:71]
s_bfe_u32 s39, s40, 0x80000
s_add_u32 s39, s39, s41
s_and_b32 s39, s39, 7
v_mfma_f32_16x16x32_bf16 v[60:63], a[108:111], a[60:63], v[60:63]
s_sub_u32 s42, s39, s41
s_mov_b32 s41, s39
v_lshl_add_u32 v2, s42, 7, v2
v_mfma_f32_16x16x32_bf16 v[60:63], a[104:107], a[40:43], v[60:63]
s_add_u32 m0, s17, 0x0
s_waitcnt lgkmcnt(4)
v_lshl_add_u32 v3, s42, 7, v3
v_mfma_f32_16x16x32_bf16 v[88:91], a[80:83], a[40:43], v[88:91]
ds_read_b64_tr_b16 a[104:105], v13 offset:768
s_waitcnt vmcnt(16)
v_mfma_f32_16x16x32_bf16 v[88:91], a[84:87], a[60:63], v[88:91]
buffer_load_dwordx4 v5, s[56:59], 0 offen lds
v_mfma_f32_16x16x32_bf16 v[96:99], a[84:87], a[64:67], v[96:99]
ds_read_b64_tr_b16 a[106:107], v13 offset:1792
v_mfma_f32_16x16x32_bf16 v[96:99], a[80:83], a[44:47], v[96:99]
ds_read_b64_tr_b16 a[108:109], v13 offset:8960
v_mfma_f32_16x16x32_bf16 v[104:107], a[80:83], a[48:51], v[104:107]
ds_read_b64_tr_b16 a[110:111], v13 offset:9984
v_mfma_f32_16x16x32_bf16 v[104:107], a[84:87], a[68:71], v[104:107]
ds_read_b128 a[0:3], v8 offset:0
s_add_u32 m0, s17, 0x4000
v_mfma_f32_16x16x32_bf16 v[112:115], a[84:87], a[72:75], v[112:115]
buffer_load_dwordx4 v5, s[60:63], 0 offen lds
v_mfma_f32_16x16x32_bf16 v[112:115], a[80:83], a[52:55], v[112:115]
ds_read_b128 a[20:23], v9 offset:0
v_mfma_f32_16x16x32_bf16 v[116:119], a[88:91], a[52:55], v[116:119]
ds_read_b64_tr_b16 a[80:81], v12 offset:16384
v_mfma_f32_16x16x32_bf16 v[116:119], a[92:95], a[72:75], v[116:119]
ds_read_b64_tr_b16 a[82:83], v12 offset:17408
v_mfma_f32_16x16x32_bf16 v[108:111], a[92:95], a[68:71], v[108:111]
ds_read_b64_tr_b16 a[84:85], v12 offset:24576
s_add_u32 m0, s17, 0x400
v_mfma_f32_16x16x32_bf16 v[108:111], a[88:91], a[48:51], v[108:111]
buffer_load_dwordx4 v5, s[56:59], s13 offen lds
v_mfma_f32_16x16x32_bf16 v[100:103], a[88:91], a[44:47], v[100:103]
ds_read_b64_tr_b16 a[86:87], v12 offset:25600
v_mfma_f32_16x16x32_bf16 v[100:103], a[92:95], a[64:67], v[100:103]
ds_read_b128 a[4:7], v8 offset:2048
v_mfma_f32_16x16x32_bf16 v[92:95], a[92:95], a[60:63], v[92:95]
ds_read_b128 a[24:27], v9 offset:2048
s_waitcnt lgkmcnt(8)
v_mfma_f32_16x16x32_bf16 v[92:95], a[88:91], a[40:43], v[92:95]
ds_read_b128 a[8:11], v8 offset:4096
s_add_u32 m0, s17, 0x4400
v_mfma_f32_16x16x32_bf16 v[120:123], a[96:99], a[40:43], v[120:123]
buffer_load_dwordx4 v5, s[60:63], s13 offen lds
v_mfma_f32_16x16x32_bf16 v[120:123], a[100:103], a[60:63], v[120:123]
ds_read_b64_tr_b16 a[88:89], v13 offset:16384
v_mfma_f32_16x16x32_bf16 v[128:131], a[100:103], a[64:67], v[128:131]
ds_read_b64_tr_b16 a[90:91], v13 offset:17408
v_mfma_f32_16x16x32_bf16 v[128:131], a[96:99], a[44:47], v[128:131]
ds_read_b64_tr_b16 a[92:93], v13 offset:24576
v_mfma_f32_16x16x32_bf16 v[136:139], a[96:99], a[48:51], v[136:139]
ds_read_b64_tr_b16 a[94:95], v13 offset:25600
s_add_u32 m0, s17, 0x800
v_mfma_f32_16x16x32_bf16 v[136:139], a[100:103], a[68:71], v[136:139]
buffer_load_dwordx4 v6, s[56:59], 0 offen lds
v_mfma_f32_16x16x32_bf16 v[144:147], a[100:103], a[72:75], v[144:147]
ds_read_b128 a[28:31], v9 offset:4096
v_mfma_f32_16x16x32_bf16 v[144:147], a[96:99], a[52:55], v[144:147]
ds_read_b128 a[12:15], v8 offset:6144
v_mfma_f32_16x16x32_bf16 v[148:151], a[104:107], a[52:55], v[148:151]
ds_read_b64_tr_b16 a[96:97], v12 offset:16640
v_mfma_f32_16x16x32_bf16 v[148:151], a[108:111], a[72:75], v[148:151]
ds_read_b64_tr_b16 a[98:99], v12 offset:17664
s_add_u32 m0, s17, 0x4800
v_mfma_f32_16x16x32_bf16 v[140:143], a[108:111], a[68:71], v[140:143]
buffer_load_dwordx4 v6, s[60:63], 0 offen lds
v_mfma_f32_16x16x32_bf16 v[140:143], a[104:107], a[48:51], v[140:143]
ds_read_b64_tr_b16 a[100:101], v12 offset:24832
v_mfma_f32_16x16x32_bf16 v[132:135], a[104:107], a[44:47], v[132:135]
ds_read_b64_tr_b16 a[102:103], v12 offset:25856
v_mfma_f32_16x16x32_bf16 v[132:135], a[108:111], a[64:67], v[132:135]
ds_read_b128 a[32:35], v9 offset:6144
v_mfma_f32_16x16x32_bf16 v[124:127], a[108:111], a[60:63], v[124:127]
s_add_u32 m0, s17, 0xc00
s_waitcnt lgkmcnt(7)
v_mfma_f32_16x16x32_bf16 v[124:127], a[104:107], a[40:43], v[124:127]
buffer_load_dwordx4 v6, s[56:59], s13 offen lds
v_mfma_f32_16x16x32_bf16 v[152:155], a[40:43], a[80:83], v[152:155]
ds_read_b64_tr_b16 a[104:105], v13 offset:16640
v_mfma_f32_16x16x32_bf16 v[152:155], a[60:63], a[84:87], v[152:155]
ds_read_b64_tr_b16 a[106:107], v13 offset:17664
v_mfma_f32_16x16x32_bf16 v[156:159], a[64:67], a[84:87], v[156:159]
ds_read_b64_tr_b16 a[108:109], v13 offset:24832
v_mfma_f32_16x16x32_bf16 v[156:159], a[44:47], a[80:83], v[156:159]
ds_read_b64_tr_b16 a[110:111], v13 offset:25856
s_add_u32 m0, s17, 0x4c00
v_mfma_f32_16x16x32_bf16 v[160:163], a[48:51], a[80:83], v[160:163]
buffer_load_dwordx4 v6, s[60:63], s13 offen lds
v_mfma_f32_16x16x32_bf16 v[160:163], a[68:71], a[84:87], v[160:163]
v_lshl_add_u32 v5, s42, 19, v5
v_lshl_add_u32 v6, s42, 19, v6
v_mfma_f32_16x16x32_bf16 v[164:167], a[72:75], a[84:87], v[164:167]
v_mfma_f32_16x16x32_bf16 v[164:167], a[52:55], a[80:83], v[164:167]
v_mfma_f32_16x16x32_bf16 v[180:183], a[52:55], a[88:91], v[180:183]
ds_read_b64_tr_b16 a[80:81], v12 offset:16896
s_mov_b32 s9, 0x200000
v_mfma_f32_16x16x32_bf16 v[180:183], a[72:75], a[92:95], v[180:183]
buffer_load_dword a120, v18, s[56:59], s9 offen
v_mfma_f32_16x16x32_bf16 v[176:179], a[68:71], a[92:95], v[176:179]
ds_read_b64_tr_b16 a[82:83], v12 offset:17920
v_mfma_f32_16x16x32_bf16 v[176:179], a[48:51], a[88:91], v[176:179]
ds_read_b64_tr_b16 a[84:85], v12 offset:25088
v_mfma_f32_16x16x32_bf16 v[172:175], a[44:47], a[88:91], v[172:175]
ds_read_b64_tr_b16 a[86:87], v12 offset:26112
v_mfma_f32_16x16x32_bf16 v[172:175], a[64:67], a[92:95], v[172:175]
s_add_u32 m0, s16, 0x0
s_waitcnt lgkmcnt(8)
v_mfma_f32_16x16x32_bf16 v[168:171], a[60:63], a[92:95], v[168:171]
buffer_load_dwordx4 v2, s[48:51], 0 offen lds
v_mfma_f32_16x16x32_bf16 v[168:171], a[40:43], a[88:91], v[168:171]
s_waitcnt lgkmcnt(4)
v_mfma_f32_16x16x32_bf16 v[184:187], a[40:43], a[96:99], v[184:187]
ds_read_b64_tr_b16 a[88:89], v13 offset:16896
v_mfma_f32_16x16x32_bf16 v[184:187], a[60:63], a[100:103], v[184:187]
ds_read_b64_tr_b16 a[90:91], v13 offset:17920
v_mfma_f32_16x16x32_bf16 v[188:191], a[64:67], a[100:103], v[188:191]
ds_read_b64_tr_b16 a[92:93], v13 offset:25088
s_add_u32 m0, s16, 0x400
v_mfma_f32_16x16x32_bf16 v[188:191], a[44:47], a[96:99], v[188:191]
buffer_load_dwordx4 v3, s[48:51], 0 offen lds
v_mfma_f32_16x16x32_bf16 v[192:195], a[48:51], a[96:99], v[192:195]
ds_read_b64_tr_b16 a[94:95], v13 offset:26112
v_mfma_f32_16x16x32_bf16 v[192:195], a[68:71], a[100:103], v[192:195]
v_mfma_f32_16x16x32_bf16 v[196:199], a[72:75], a[100:103], v[196:199]
v_mfma_f32_16x16x32_bf16 v[196:199], a[52:55], a[96:99], v[196:199]
s_add_u32 m0, s16, 0x800
v_mfma_f32_16x16x32_bf16 v[212:215], a[52:55], a[104:107], v[212:215]
buffer_load_dwordx4 v2, s[48:51], s12 offen lds
v_mfma_f32_16x16x32_bf16 v[212:215], a[72:75], a[108:111], v[212:215]
ds_read_b64_tr_b16 a[96:97], v12 offset:17152
v_mfma_f32_16x16x32_bf16 v[208:211], a[68:71], a[108:111], v[208:211]
ds_read_b64_tr_b16 a[98:99], v12 offset:18176
v_mfma_f32_16x16x32_bf16 v[208:211], a[48:51], a[104:107], v[208:211]
ds_read_b64_tr_b16 a[100:101], v12 offset:25344
v_mfma_f32_16x16x32_bf16 v[204:207], a[44:47], a[104:107], v[204:207]
ds_read_b64_tr_b16 a[102:103], v12 offset:26368
s_add_u32 m0, s16, 0xc00
v_mfma_f32_16x16x32_bf16 v[204:207], a[64:67], a[108:111], v[204:207]
buffer_load_dwordx4 v3, s[48:51], s12 offen lds
v_mfma_f32_16x16x32_bf16 v[200:203], a[60:63], a[108:111], v[200:203]
v_mfma_f32_16x16x32_bf16 v[200:203], a[40:43], a[104:107], v[200:203]
s_waitcnt lgkmcnt(4)
v_mfma_f32_16x16x32_bf16 v[248:251], a[40:43], a[80:83], v[248:251]
ds_read_b64_tr_b16 a[104:105], v13 offset:17152
v_mfma_f32_16x16x32_bf16 v[248:251], a[60:63], a[84:87], v[248:251]
ds_read_b64_tr_b16 a[106:107], v13 offset:18176
s_add_u32 m0, s16, 0x1000
v_mfma_f32_16x16x32_bf16 v[252:255], a[64:67], a[84:87], v[252:255]
buffer_load_dwordx4 v2, s[48:51], s13 offen lds
v_mfma_f32_16x16x32_bf16 v[252:255], a[44:47], a[80:83], v[252:255]
ds_read_b64_tr_b16 a[108:109], v13 offset:25344
v_mfma_f32_16x16x32_bf16 v[216:219], a[48:51], a[80:83], v[216:219]
ds_read_b64_tr_b16 a[110:111], v13 offset:26368
v_add_u32 v12, 0x8000, v12
v_mfma_f32_16x16x32_bf16 v[216:219], a[68:71], a[84:87], v[216:219]
v_add_u32 v13, 0x8000, v13
v_mfma_f32_16x16x32_bf16 v[220:223], a[72:75], a[84:87], v[220:223]
s_add_u32 m0, s16, 0x1400
v_mfma_f32_16x16x32_bf16 v[220:223], a[52:55], a[80:83], v[220:223]
buffer_load_dwordx4 v3, s[48:51], s13 offen lds
v_mfma_f32_16x16x32_bf16 v[236:239], a[52:55], a[88:91], v[236:239]
s_waitcnt vmcnt(23) lgkmcnt(0)
v_mfma_f32_16x16x32_bf16 v[236:239], a[72:75], a[92:95], v[236:239]
s_barrier
v_mfma_f32_16x16x32_bf16 v[232:235], a[68:71], a[92:95], v[232:235]
ds_read_b64_tr_b16 a[80:81], v12 offset:0
L_padA1:
s_cmp_eq_u32 s95, 1
s_cbranch_scc1 L_padA5
v_mfma_f32_16x16x32_bf16 v[232:235], a[48:51], a[88:91], v[232:235]
ds_read_b64_tr_b16 a[82:83], v12 offset:1024
s_add_u32 m0, s16, 0x1800
v_mfma_f32_16x16x32_bf16 v[228:231], a[44:47], a[88:91], v[228:231]
buffer_load_dwordx4 v2, s[48:51], s14 offen lds
v_mfma_f32_16x16x32_bf16 v[228:231], a[64:67], a[92:95], v[228:231]
ds_read_b64_tr_b16 a[84:85], v12 offset:8192
v_mfma_f32_16x16x32_bf16 v[224:227], a[60:63], a[92:95], v[224:227]
ds_read_b64_tr_b16 a[86:87], v12 offset:9216
v_mfma_f32_16x16x32_bf16 v[224:227], a[40:43], a[88:91], v[224:227]
s_waitcnt lgkmcnt(4)
v_mfma_f32_16x16x32_bf16 v[240:243], a[40:43], a[96:99], v[240:243]
ds_read_b64_tr_b16 a[88:89], v13 offset:0
s_add_u32 m0, s16, 0x1c00
v_mfma_f32_16x16x32_bf16 v[240:243], a[60:63], a[100:103], v[240:243]
buffer_load_dwordx4 v3, s[48:51], s14 offen lds
v_mfma_f32_16x16x32_bf16 v[244:247], a[64:67], a[100:103], v[244:247]
ds_read_b64_tr_b16 a[90:91], v13 offset:1024
s_bfe_u32 s39, s40, 0x80008
v_mfma_f32_16x16x32_bf16 v[244:247], a[44:47], a[96:99], v[244:247]
ds_read_b64_tr_b16 a[92:93], v13 offset:8192
s_add_u32 s39, s39, s41
v_mfma_f32_16x16x32_bf16 a[232:235], a[48:51], a[96:99], a[232:235]
ds_read_b64_tr_b16 a[94:95], v13 offset:9216
s_and_b32 s39, s39, 7
v_mfma_f32_16x16x32_bf16 a[232:235], a[68:71], a[100:103], a[232:235]
s_mov_b32 s9, 0x200000
s_sub_u32 s42, s39, s41
s_mov_b32 s41, s39
v_mfma_f32_16x16x32_bf16 a[236:239], a[72:75], a[100:103], a[236:239]
buffer_load_dword a120, v18, s[60:63], s9 offen
v_mfma_f32_16x16x32_bf16 a[236:239], a[52:55], a[96:99], a[236:239]
v_lshl_add_u32 v2, s42, 7, v2
v_lshl_add_u32 v3, s42, 7, v3
v_mfma_f32_16x16x32_bf16 a[252:255], a[52:55], a[104:107], a[252:255]
ds_read_b64_tr_b16 a[96:97], v12 offset:256
v_mfma_f32_16x16x32_bf16 a[252:255], a[72:75], a[108:111], a[252:255]
ds_read_b64_tr_b16 a[98:99], v12 offset:1280
v_mfma_f32_16x16x32_bf16 a[248:251], a[68:71], a[108:111], a[248:251]
ds_read_b64_tr_b16 a[100:101], v12 offset:8448
s_add_u32 m0, s17, 0x8000
v_mfma_f32_16x16x32_bf16 a[248:251], a[48:51], a[104:107], a[248:251]
buffer_load_dwordx4 v5, s[56:59], 0 offen lds
v_mfma_f32_16x16x32_bf16 a[244:247], a[44:47], a[104:107], a[244:247]
ds_read_b64_tr_b16 a[102:103], v12 offset:9472
v_mfma_f32_16x16x32_bf16 a[244:247], a[64:67], a[108:111], a[244:247]
v_mfma_f32_16x16x32_bf16 a[240:243], a[60:63], a[108:111], a[240:243]
v_mfma_f32_16x16x32_bf16 a[240:243], a[40:43], a[104:107], a[240:243]
s_add_u32 m0, s17, 0xc000
s_waitcnt lgkmcnt(4)
L_S2:
v_mfma_f32_16x16x32_bf16 v[24:27], a[80:83], a[0:3], v[24:27]
buffer_load_dwordx4 v5, s[60:63], 0 offen lds
v_mfma_f32_16x16x32_bf16 v[24:27], a[84:87], a[20:23], v[24:27]
ds_read_b64_tr_b16 a[104:105], v13 offset:256
s_waitcnt vmcnt(20)
v_mfma_f32_16x16x32_bf16 v[32:35], a[84:87], a[24:27], v[32:35]
ds_read_b64_tr_b16 a[106:107], v13 offset:1280
v_mfma_f32_16x16x32_bf16 v[32:35], a[80:83], a[4:7], v[32:35]
ds_read_b64_tr_b16 a[108:109], v13 offset:8448
v_mfma_f32_16x16x32_bf16 v[40:43], a[80:83], a[8:11], v[40:43]
ds_read_b64_tr_b16 a[110:111], v13 offset:9472
s_add_u32 m0, s17, 0x8400
v_mfma_f32_16x16x32_bf16 v[40:43], a[84:87], a[28:31], v[40:43]
buffer_load_dwordx4 v5, s[56:59], s13 offen lds
v_mfma_f32_16x16x32_bf16 v[48:51], a[84:87], a[32:35], v[48:51]
ds_read_b128 a[40:43], v8 offset:32768
v_mfma_f32_16x16x32_bf16 v[48:51], a[80:83], a[12:15], v[48:51]
ds_read_b128 a[60:63], v9 offset:32768
v_mfma_f32_16x16x32_bf16 v[52:55], a[88:91], a[12:15], v[52:55]
ds_read_b64_tr_b16 a[80:81], v12 offset:512
v_mfma_f32_16x16x32_bf16 v[52:55], a[92:95], a[32:35], v[52:55]
ds_read_b64_tr_b16 a[82:83], v12 offset:1536
s_add_u32 m0, s17, 0xc400
v_mfma_f32_16x16x32_bf16 v[44:47], a[92:95], a[28:31], v[44:47]
buffer_load_dwordx4 v5, s[60:63], s13 offen lds
v_mfma_f32_16x16x32_bf16 v[44:47], a[88:91], a[8:11], v[44:47]
ds_read_b64_tr_b16 a[84:85], v12 offset:8704
v_mfma_f32_16x16x32_bf16 v[36:39], a[88:91], a[4:7], v[36:39]
ds_read_b64_tr_b16 a[86:87], v12 offset:9728
v_mfma_f32_16x16x32_bf16 v[36:39], a[92:95], a[24:27], v[36:39]
ds_read_b128 a[44:47], v8 offset:34816
s_waitcnt lgkmcnt(7)
v_mfma_f32_16x16x32_bf16 v[28:31], a[92:95], a[20:23], v[28:31]
ds_read_b128 a[64:67], v9 offset:34816
s_add_u32 m0, s17, 0x8800
v_mfma_f32_16x16x32_bf16 v[28:31], a[88:91], a[0:3], v[28:31]
buffer_load_dwordx4 v6, s[56:59], 0 offen lds
v_mfma_f32_16x16x32_bf16 v[56:59], a[96:99], a[0:3], v[56:59]
ds_read_b64_tr_b16 a[88:89], v13 offset:512
v_mfma_f32_16x16x32_bf16 v[56:59], a[100:103], a[20:23], v[56:59]
ds_read_b64_tr_b16 a[90:91], v13 offset:1536
v_mfma_f32_16x16x32_bf16 v[64:67], a[100:103], a[24:27], v[64:67]
ds_read_b64_tr_b16 a[92:93], v13 offset:8704
v_mfma_f32_16x16x32_bf16 v[64:67], a[96:99], a[4:7], v[64:67]
ds_read_b64_tr_b16 a[94:95], v13 offset:9728
s_add_u32 m0, s17, 0xc800
v_mfma_f32_16x16x32_bf16 v[72:75], a[96:99], a[8:11], v[72:75]
buffer_load_dwordx4 v6, s[60:63], 0 offen lds
v_mfma_f32_16x16x32_bf16 v[72:75], a[100:103], a[28:31], v[72:75]
ds_read_b128 a[48:51], v8 offset:36864
v_mfma_f32_16x16x32_bf16 v[80:83], a[100:103], a[32:35], v[80:83]
ds_read_b128 a[68:71], v9 offset:36864
v_mfma_f32_16x16x32_bf16 v[80:83], a[96:99], a[12:15], v[80:83]
ds_read_b128 a[52:55], v8 offset:38912
v_mfma_f32_16x16x32_bf16 v[84:87], a[104:107], a[12:15], v[84:87]
ds_read_b64_tr_b16 a[96:97], v12 offset:768
s_add_u32 m0, s17, 0x8c00
v_mfma_f32_16x16x32_bf16 v[84:87], a[108:111], a[32:35], v[84:87]
buffer_load_dwordx4 v6, s[56:59], s13 offen lds
v_mfma_f32_16x16x32_bf16 v[76:79], a[108:111], a[28:31], v[76:79]
ds_read_b64_tr_b16 a[98:99], v12 offset:1792
v_mfma_f32_16x16x32_bf16 v[76:79], a[104:107], a[8:11], v[76:79]
ds_read_b64_tr_b16 a[100:101], v12 offset:8960
v_mfma_f32_16x16x32_bf16 v[68:71], a[104:107], a[4:7], v[68:71]
ds_read_b64_tr_b16 a[102:103], v12 offset:9984
v_mfma_f32_16x16x32_bf16 v[68:71], a[108:111], a[24:27], v[68:71]
ds_read_b128 a[72:75], v9 offset:38912
s_add_u32 m0, s17, 0xcc00
v_mfma_f32_16x16x32_bf16 v[60:63], a[108:111], a[20:23], v[60:63]
buffer_load_dwordx4 v6, s[60:63], s13 offen lds
v_mfma_f32_16x16x32_bf16 v[60:63], a[104:107], a[0:3], v[60:63]
s_waitcnt lgkmcnt(8)
v_lshl_add_u32 v5, s42, 19, v5
v_lshl_add_u32 v6, s42, 19, v6
v_mfma_f32_16x16x32_bf16 v[88:91], a[80:83], a[0:3], v[88:91]
ds_read_b64_tr_b16 a[104:105], v13 offset:768
v_mfma_f32_16x16x32_bf16 v[88:91], a[84:87], a[20:23], v[88:91]
ds_read_b64_tr_b16 a[106:107], v13 offset:1792
v_mfma_f32_16x16x32_bf16 v[96:99], a[84:87], a[24:27], v[96:99]
ds_read_b64_tr_b16 a[108:109], v13 offset:8960
v_mfma_f32_16x16x32_bf16 v[96:99], a[80:83], a[4:7], v[96:99]
ds_read_b64_tr_b16 a[110:111], v13 offset:9984
v_mfma_f32_16x16x32_bf16 v[104:107], a[80:83], a[8:11], v[104:107]
s_add_u32 m0, s16, 0x8000
s_waitcnt lgkmcnt(4)
v_mfma_f32_16x16x32_bf16 v[104:107], a[84:87], a[28:31], v[104:107]
buffer_load_dwordx4 v2, s[48:51], 0 offen lds
v_mfma_f32_16x16x32_bf16 v[112:115], a[84:87], a[32:35], v[112:115]
v_mfma_f32_16x16x32_bf16 v[112:115], a[80:83], a[12:15], v[112:115]
v_mfma_f32_16x16x32_bf16 v[116:119], a[88:91], a[12:15], v[116:119]
ds_read_b64_tr_b16 a[80:81], v12 offset:16384
v_mfma_f32_16x16x32_bf16 v[116:119], a[92:95], a[32:35], v[116:119]
ds_read_b64_tr_b16 a[82:83], v12 offset:17408
v_mfma_f32_16x16x32_bf16 v[108:111], a[92:95], a[28:31], v[108:111]
ds_read_b64_tr_b16 a[84:85], v12 offset:24576
v_mfma_f32_16x16x32_bf16 v[108:111], a[88:91], a[8:11], v[108:111]
ds_read_b64_tr_b16 a[86:87], v12 offset:25600
s_add_u32 m0, s16, 0x8400
v_mfma_f32_16x16x32_bf16 v[100:103], a[88:91], a[4:7], v[100:103]
buffer_load_dwordx4 v3, s[48:51], 0 offen lds
v_mfma_f32_16x16x32_bf16 v[100:103], a[92:95], a[24:27], v[100:103]
v_mfma_f32_16x16x32_bf16 v[92:95], a[92:95], a[20:23], v[92:95]
v_mfma_f32_16x16x32_bf16 v[92:95], a[88:91], a[0:3], v[92:95]
s_waitcnt lgkmcnt(4)
v_mfma_f32_16x16x32_bf16 v[120:123], a[96:99], a[0:3], v[120:123]
ds_read_b64_tr_b16 a[88:89], v13 offset:16384
v_mfma_f32_16x16x32_bf16 v[120:123], a[100:103], a[20:23], v[120:123]
ds_read_b64_tr_b16 a[90:91], v13 offset:17408
v_mfma_f32_16x16x32_bf16 v[128:131], a[100:103], a[24:27], v[128:131]
ds_read_b64_tr_b16 a[92:93], v13 offset:24576
v_mfma_f32_16x16x32_bf16 v[128:131], a[96:99], a[4:7], v[128:131]
ds_read_b64_tr_b16 a[94:95], v13 offset:25600
s_add_u32 m0, s16, 0x8800
v_mfma_f32_16x16x32_bf16 v[136:139], a[96:99], a[8:11], v[136:139]
buffer_load_dwordx4 v2, s[48:51], s12 offen lds
v_mfma_f32_16x16x32_bf16 v[136:139], a[100:103], a[28:31], v[136:139]
v_mfma_f32_16x16x32_bf16 v[144:147], a[100:103], a[32:35], v[144:147]
v_mfma_f32_16x16x32_bf16 v[144:147], a[96:99], a[12:15], v[144:147]
v_mfma_f32_16x16x32_bf16 v[148:151], a[104:107], a[12:15], v[148:151]
ds_read_b64_tr_b16 a[96:97], v12 offset:16640
v_mfma_f32_16x16x32_bf16 v[148:151], a[108:111], a[32:35], v[148:151]
ds_read_b64_tr_b16 a[98:99], v12 offset:17664
v_mfma_f32_16x16x32_bf16 v[140:143], a[108:111], a[28:31], v[140:143]
ds_read_b64_tr_b16 a[100:101], v12 offset:24832
s_add_u32 m0, s16, 0x8c00
v_mfma_f32_16x16x32_bf16 v[140:143], a[104:107], a[8:11], v[140:143]
buffer_load_dwordx4 v3, s[48:51], s12 offen lds
v_mfma_f32_16x16x32_bf16 v[132:135], a[104:107], a[4:7], v[132:135]
ds_read_b64_tr_b16 a[102:103], v12 offset:25856
v_mfma_f32_16x16x32_bf16 v[132:135], a[108:111], a[24:27], v[132:135]
v_mfma_f32_16x16x32_bf16 v[124:127], a[108:111], a[20:23], v[124:127]
v_mfma_f32_16x16x32_bf16 v[124:127], a[104:107], a[0:3], v[124:127]
s_waitcnt lgkmcnt(4)
v_mfma_f32_16x16x32_bf16 v[152:155], a[0:3], a[80:83], v[152:155]
ds_read_b64_tr_b16 a[104:105], v13 offset:16640
v_mfma_f32_16x16x32_bf16 v[152:155], a[20:23], a[84:87], v[152:155]
ds_read_b64_tr_b16 a[106:107], v13 offset:17664
s_add_u32 m0, s16, 0x9000
v_mfma_f32_16x16x32_bf16 v[156:159], a[24:27], a[84:87], v[156:159]
buffer_load_dwordx4 v2, s[48:51], s13 offen lds
v_mfma_f32_16x16x32_bf16 v[156:159], a[4:7], a[80:83], v[156:159]
ds_read_b64_tr_b16 a[108:109], v13 offset:24832
v_mfma_f32_16x16x32_bf16 v[160:163], a[8:11], a[80:83], v[160:163]
ds_read_b64_tr_b16 a[110:111], v13 offset:25856
v_mfma_f32_16x16x32_bf16 v[160:163], a[28:31], a[84:87], v[160:163]
v_mfma_f32_16x16x32_bf16 v[164:167], a[32:35], a[84:87], v[164:167]
v_mfma_f32_16x16x32_bf16 v[164:167], a[12:15], a[80:83], v[164:167]
v_mfma_f32_16x16x32_bf16 v[180:183], a[12:15], a[88:91], v[180:183]
ds_read_b64_tr_b16 a[80:81], v12 offset:16896
v_mfma_f32_16x16x32_bf16 v[180:183], a[32:35], a[92:95], v[180:183]
ds_read_b64_tr_b16 a[82:83], v12 offset:17920
s_add_u32 m0, s16, 0x9400
v_mfma_f32_16x16x32_bf16 v[176:179], a[28:31], a[92:95], v[176:179]
buffer_load_dwordx4 v3, s[48:51], s13 offen lds
v_mfma_f32_16x16x32_bf16 v[176:179], a[8:11], a[88:91], v[176:179]
ds_read_b64_tr_b16 a[84:85], v12 offset:25088
v_mfma_f32_16x16x32_bf16 v[172:175], a[4:7], a[88:91], v[172:175]
ds_read_b64_tr_b16 a[86:87], v12 offset:26112
v_mfma_f32_16x16x32_bf16 v[172:175], a[24:27], a[92:95], v[172:175]
v_mfma_f32_16x16x32_bf16 v[168:171], a[20:23], a[92:95], v[168:171]
v_mfma_f32_16x16x32_bf16 v[168:171], a[0:3], a[88:91], v[168:171]
s_waitcnt lgkmcnt(4)
v_mfma_f32_16x16x32_bf16 v[184:187], a[0:3], a[96:99], v[184:187]
ds_read_b64_tr_b16 a[88:89], v13 offset:16896
s_add_u32 m0, s16, 0x9800
v_mfma_f32_16x16x32_bf16 v[184:187], a[20:23], a[100:103], v[184:187]
buffer_load_dwordx4 v2, s[48:51], s14 offen lds
v_mfma_f32_16x16x32_bf16 v[188:191], a[24:27], a[100:103], v[188:191]
ds_read_b64_tr_b16 a[90:91], v13 offset:17920
v_mfma_f32_16x16x32_bf16 v[188:191], a[4:7], a[96:99], v[188:191]
ds_read_b64_tr_b16 a[92:93], v13 offset:25088
v_mfma_f32_16x16x32_bf16 v[192:195], a[8:11], a[96:99], v[192:195]
ds_read_b64_tr_b16 a[94:95], v13 offset:26112
v_mfma_f32_16x16x32_bf16 v[192:195], a[28:31], a[100:103], v[192:195]
v_mfma_f32_16x16x32_bf16 v[196:199], a[32:35], a[100:103], v[196:199]
v_mfma_f32_16x16x32_bf16 v[196:199], a[12:15], a[96:99], v[196:199]
v_mfma_f32_16x16x32_bf16 v[212:215], a[12:15], a[104:107], v[212:215]
ds_read_b64_tr_b16 a[96:97], v12 offset:17152
s_add_u32 m0, s16, 0x9c00
v_mfma_f32_16x16x32_bf16 v[212:215], a[32:35], a[108:111], v[212:215]
buffer_load_dwordx4 v3, s[48:51], s14 offen lds
v_mfma_f32_16x16x32_bf16 v[208:211], a[28:31], a[108:111], v[208:211]
ds_read_b64_tr_b16 a[98:99], v12 offset:18176
s_bfe_u32 s39, s40, 0x80010
v_mfma_f32_16x16x32_bf16 v[208:211], a[8:11], a[104:107], v[208:211]
ds_read_b64_tr_b16 a[100:101], v12 offset:25344
s_add_u32 s39, s39, s41
v_mfma_f32_16x16x32_bf16 v[204:207], a[4:7], a[104:107], v[204:207]
ds_read_b64_tr_b16 a[102:103], v12 offset:26368
s_and_b32 s39, s39, 7
v_mfma_f32_16x16x32_bf16 v[204:207], a[24:27], a[108:111], v[204:207]
s_sub_u32 s42, s39, s41
s_mov_b32 s41, s39
v_lshl_add_u32 v2, s42, 7, v2
v_mfma_f32_16x16x32_bf16 v[200:203], a[20:23], a[108:111], v[200:203]
v_lshl_add_u32 v3, s42, 7, v3
v_mfma_f32_16x16x32_bf16 v[200:203], a[0:3], a[104:107], v[200:203]
s_mov_b32 s9, 0x0
s_waitcnt lgkmcnt(4)
v_mfma_f32_16x16x32_bf16 v[248:251], a[0:3], a[80:83], v[248:251]
buffer_load_dword a120, v19, s[44:47], s9 offen
v_mfma_f32_16x16x32_bf16 v[248:251], a[20:23], a[84:87], v[248:251]
ds_read_b64_tr_b16 a[104:105], v13 offset:17152
v_mfma_f32_16x16x32_bf16 v[252:255], a[24:27], a[84:87], v[252:255]
ds_read_b64_tr_b16 a[106:107], v13 offset:18176
v_mfma_f32_16x16x32_bf16 v[252:255], a[4:7], a[80:83], v[252:255]
ds_read_b64_tr_b16 a[108:109], v13 offset:25344
v_mfma_f32_16x16x32_bf16 v[216:219], a[8:11], a[80:83], v[216:219]
ds_read_b64_tr_b16 a[110:111], v13 offset:26368
v_add_u32 v12, 0xffff0000, v12
v_mfma_f32_16x16x32_bf16 v[216:219], a[28:31], a[84:87], v[216:219]
v_add_u32 v13, 0xffff0000, v13
v_mfma_f32_16x16x32_bf16 v[220:223], a[32:35], a[84:87], v[220:223]
v_mfma_f32_16x16x32_bf16 v[220:223], a[12:15], a[80:83], v[220:223]
v_mfma_f32_16x16x32_bf16 v[236:239], a[12:15], a[88:91], v[236:239]
s_waitcnt vmcnt(27) lgkmcnt(0)
v_mfma_f32_16x16x32_bf16 v[236:239], a[32:35], a[92:95], v[236:239]
s_barrier
s_add_u32 m0, s17, 0x10000
v_mfma_f32_16x16x32_bf16 v[232:235], a[28:31], a[92:95], v[232:235]
buffer_load_dwordx4 v5, s[56:59], 0 offen lds
v_mfma_f32_16x16x32_bf16 v[232:235], a[8:11], a[88:91], v[232:235]
ds_read_b64_tr_b16 a[80:81], v12 offset:0
v_mfma_f32_16x16x32_bf16 v[228:231], a[4:7], a[88:91], v[228:231]
ds_read_b64_tr_b16 a[82:83], v12 offset:1024
v_mfma_f32_16x16x32_bf16 v[228:231], a[24:27], a[92:95], v[228:231]
ds_read_b64_tr_b16 a[84:85], v12 offset:8192
v_mfma_f32_16x16x32_bf16 v[224:227], a[20:23], a[92:95], v[224:227]
ds_read_b64_tr_b16 a[86:87], v12 offset:9216
v_mfma_f32_16x16x32_bf16 v[224:227], a[0:3], a[88:91], v[224:227]
s_waitcnt lgkmcnt(4)
v_mfma_f32_16x16x32_bf16 v[240:243], a[0:3], a[96:99], v[240:243]
ds_read_b64_tr_b16 a[88:89], v13 offset:0
s_add_u32 m0, s17, 0x14000
v_mfma_f32_16x16x32_bf16 v[240:243], a[20:23], a[100:103], v[240:243]
buffer_load_dwordx4 v5, s[60:63], 0 offen lds
v_mfma_f32_16x16x32_bf16 v[244:247], a[24:27], a[100:103], v[244:247]
ds_read_b64_tr_b16 a[90:91], v13 offset:1024
v_mfma_f32_16x16x32_bf16 v[244:247], a[4:7], a[96:99], v[244:247]
ds_read_b64_tr_b16 a[92:93], v13 offset:8192
v_mfma_f32_16x16x32_bf16 a[232:235], a[8:11], a[96:99], a[232:235]
ds_read_b64_tr_b16 a[94:95], v13 offset:9216
v_mfma_f32_16x16x32_bf16 a[232:235], a[28:31], a[100:103], a[232:235]
v_mfma_f32_16x16x32_bf16 a[236:239], a[32:35], a[100:103], a[236:239]
v_mfma_f32_16x16x32_bf16 a[236:239], a[12:15], a[96:99], a[236:239]
s_add_u32 m0, s17, 0x10400
v_mfma_f32_16x16x32_bf16 a[252:255], a[12:15], a[104:107], a[252:255]
buffer_load_dwordx4 v5, s[56:59], s13 offen lds
v_mfma_f32_16x16x32_bf16 a[252:255], a[32:35], a[108:111], a[252:255]
ds_read_b64_tr_b16 a[96:97], v12 offset:256
v_mfma_f32_16x16x32_bf16 a[248:251], a[28:31], a[108:111], a[248:251]
ds_read_b64_tr_b16 a[98:99], v12 offset:1280
v_mfma_f32_16x16x32_bf16 a[248:251], a[8:11], a[104:107], a[248:251]
ds_read_b64_tr_b16 a[100:101], v12 offset:8448
v_mfma_f32_16x16x32_bf16 a[244:247], a[4:7], a[104:107], a[244:247]
ds_read_b64_tr_b16 a[102:103], v12 offset:9472
v_mfma_f32_16x16x32_bf16 a[244:247], a[24:27], a[108:111], a[244:247]
v_mfma_f32_16x16x32_bf16 a[240:243], a[20:23], a[108:111], a[240:243]
s_add_u32 m0, s17, 0x14400
s_waitcnt lgkmcnt(4)
v_mfma_f32_16x16x32_bf16 a[240:243], a[0:3], a[104:107], a[240:243]
buffer_load_dwordx4 v5, s[60:63], s13 offen lds
L_S3:
v_mfma_f32_16x16x32_bf16 v[24:27], a[80:83], a[40:43], v[24:27]
ds_read_b64_tr_b16 a[104:105], v13 offset:256
s_waitcnt vmcnt(22)
v_mfma_f32_16x16x32_bf16 v[24:27], a[84:87], a[60:63], v[24:27]
ds_read_b64_tr_b16 a[106:107], v13 offset:1280
v_mfma_f32_16x16x32_bf16 v[32:35], a[84:87], a[64:67], v[32:35]
ds_read_b64_tr_b16 a[108:109], v13 offset:8448
v_mfma_f32_16x16x32_bf16 v[32:35], a[80:83], a[44:47], v[32:35]
ds_read_b64_tr_b16 a[110:111], v13 offset:9472
v_mfma_f32_16x16x32_bf16 v[40:43], a[80:83], a[48:51], v[40:43]
ds_read_b128 a[0:3], v8 offset:0
v_mfma_f32_16x16x32_bf16 v[40:43], a[84:87], a[68:71], v[40:43]
ds_read_b128 a[20:23], v9 offset:0
s_add_u32 m0, s17, 0x10800
v_mfma_f32_16x16x32_bf16 v[48:51], a[84:87], a[72:75], v[48:51]
buffer_load_dwordx4 v6, s[56:59], 0 offen lds
v_mfma_f32_16x16x32_bf16 v[48:51], a[80:83], a[52:55], v[48:51]
ds_read_b128 a[4:7], v8 offset:2048
v_mfma_f32_16x16x32_bf16 v[52:55], a[88:91], a[52:55], v[52:55]
ds_read_b64_tr_b16 a[80:81], v12 offset:512
v_mfma_f32_16x16x32_bf16 v[52:55], a[92:95], a[72:75], v[52:55]
ds_read_b64_tr_b16 a[82:83], v12 offset:1536
v_mfma_f32_16x16x32_bf16 v[44:47], a[92:95], a[68:71], v[44:47]
ds_read_b64_tr_b16 a[84:85], v12 offset:8704
v_mfma_f32_16x16x32_bf16 v[44:47], a[88:91], a[48:51], v[44:47]
ds_read_b64_tr_b16 a[86:87], v12 offset:9728
v_mfma_f32_16x16x32_bf16 v[36:39], a[88:91], a[44:47], v[36:39]
ds_read_b128 a[24:27], v9 offset:2048
s_add_u32 m0, s17, 0x14800
v_mfma_f32_16x16x32_bf16 v[36:39], a[92:95], a[64:67], v[36:39]
buffer_load_dwordx4 v6, s[60:63], 0 offen lds
v_mfma_f32_16x16x32_bf16 v[28:31], a[92:95], a[60:63], v[28:31]
ds_read_b128 a[8:11], v8 offset:4096
v_mfma_f32_16x16x32_bf16 v[28:31], a[88:91], a[40:43], v[28:31]
ds_read_b128 a[28:31], v9 offset:4096
s_waitcnt lgkmcnt(10)
v_mfma_f32_16x16x32_bf16 v[56:59], a[96:99], a[40:43], v[56:59]
ds_read_b64_tr_b16 a[88:89], v13 offset:512
v_mfma_f32_16x16x32_bf16 v[56:59], a[100:103], a[60:63], v[56:59]
ds_read_b64_tr_b16 a[90:91], v13 offset:1536
v_mfma_f32_16x16x32_bf16 v[64:67], a[100:103], a[64:67], v[64:67]
ds_read_b64_tr_b16 a[92:93], v13 offset:8704
v_mfma_f32_16x16x32_bf16 v[64:67], a[96:99], a[44:47], v[64:67]
ds_read_b64_tr_b16 a[94:95], v13 offset:9728
s_add_u32 m0, s17, 0x10c00
v_mfma_f32_16x16x32_bf16 v[72:75], a[96:99], a[48:51], v[72:75]
buffer_load_dwordx4 v6, s[56:59], s13 offen lds
v_mfma_f32_16x16x32_bf16 v[72:75], a[100:103], a[68:71], v[72:75]
ds_read_b128 a[12:15], v8 offset:6144
v_mfma_f32_16x16x32_bf16 v[80:83], a[100:103], a[72:75], v[80:83]
ds_read_b128 a[32:35], v9 offset:6144
v_mfma_f32_16x16x32_bf16 v[80:83], a[96:99], a[52:55], v[80:83]
v_mfma_f32_16x16x32_bf16 v[84:87], a[104:107], a[52:55], v[84:87]
ds_read_b64_tr_b16 a[96:97], v12 offset:768
v_mfma_f32_16x16x32_bf16 v[84:87], a[108:111], a[72:75], v[84:87]
ds_read_b64_tr_b16 a[98:99], v12 offset:1792
v_mfma_f32_16x16x32_bf16 v[76:79], a[108:111], a[68:71], v[76:79]
ds_read_b64_tr_b16 a[100:101], v12 offset:8960
s_add_u32 m0, s17, 0x14c00
v_mfma_f32_16x16x32_bf16 v[76:79], a[104:107], a[48:51], v[76:79]
buffer_load_dwordx4 v6, s[60:63], s13 offen lds
v_mfma_f32_16x16x32_bf16 v[68:71], a[104:107], a[44:47], v[68:71]
ds_read_b64_tr_b16 a[102:103], v12 offset:9984
v_lshl_add_u32 v5, s42, 19, v5
v_mfma_f32_16x16x32_bf16 v[68:71], a[108:111], a[64:67], v[68:71]
v_lshl_add_u32 v6, s42, 19, v6
v_mfma_f32_16x16x32_bf16 v[60:63], a[108:111], a[60:63], v[60:63]
v_mfma_f32_16x16x32_bf16 v[60:63], a[104:107], a[40:43], v[60:63]
s_waitcnt lgkmcnt(6)
v_mfma_f32_16x16x32_bf16 v[88:91], a[80:83], a[40:43], v[88:91]
ds_read_b64_tr_b16 a[104:105], v13 offset:768
v_mfma_f32_16x16x32_bf16 v[88:91], a[84:87], a[60:63], v[88:91]
ds_read_b64_tr_b16 a[106:107], v13 offset:1792
s_mov_b32 s9, 0x200000
v_mfma_f32_16x16x32_bf16 v[96:99], a[84:87], a[64:67], v[96:99]
buffer_load_dword a120, v19, s[44:47], s9 offen
v_mfma_f32_16x16x32_bf16 v[96:99], a[80:83], a[44:47], v[96:99]
ds_read_b64_tr_b16 a[108:109], v13 offset:8960
v_mfma_f32_16x16x32_bf16 v[104:107], a[80:83], a[48:51], v[104:107]
ds_read_b64_tr_b16 a[110:111], v13 offset:9984
v_mfma_f32_16x16x32_bf16 v[104:107], a[84:87], a[68:71], v[104:107]
v_mfma_f32_16x16x32_bf16 v[112:115], a[84:87], a[72:75], v[112:115]
v_mfma_f32_16x16x32_bf16 v[112:115], a[80:83], a[52:55], v[112:115]
s_waitcnt lgkmcnt(8)
v_mfma_f32_16x16x32_bf16 v[116:119], a[88:91], a[52:55], v[116:119]
ds_read_b64_tr_b16 a[80:81], v12 offset:16384
s_add_u32 m0, s16, 0x0
v_mfma_f32_16x16x32_bf16 v[116:119], a[92:95], a[72:75], v[116:119]
buffer_load_dwordx4 v2, s[48:51], 0 offen lds
v_mfma_f32_16x16x32_bf16 v[108:111], a[92:95], a[68:71], v[108:111]
ds_read_b64_tr_b16 a[82:83], v12 offset:17408
v_mfma_f32_16x16x32_bf16 v[108:111], a[88:91], a[48:51], v[108:111]
ds_read_b64_tr_b16 a[84:85], v12 offset:24576
v_mfma_f32_16x16x32_bf16 v[100:103], a[88:91], a[44:47], v[100:103]
ds_read_b64_tr_b16 a[86:87], v12 offset:25600
v_mfma_f32_16x16x32_bf16 v[100:103], a[92:95], a[64:67], v[100:103]
v_mfma_f32_16x16x32_bf16 v[92:95], a[92:95], a[60:63], v[92:95]
v_mfma_f32_16x16x32_bf16 v[92:95], a[88:91], a[40:43], v[92:95]
s_add_u32 m0, s16, 0x400
s_waitcnt lgkmcnt(4)
v_mfma_f32_16x16x32_bf16 v[120:123], a[96:99], a[40:43], v[120:123]
buffer_load_dwordx4 v3, s[48:51], 0 offen lds
v_mfma_f32_16x16x32_bf16 v[120:123], a[100:103], a[60:63], v[120:123]
ds_read_b64_tr_b16 a[88:89], v13 offset:16384
v_mfma_f32_16x16x32_bf16 v[128:131], a[100:103], a[64:67], v[128:131]
ds_read_b64_tr_b16 a[90:91], v13 offset:17408
v_mfma_f32_16x16x32_bf16 v[128:131], a[96:99], a[44:47], v[128:131]
ds_read_b64_tr_b16 a[92:93], v13 offset:24576
v_mfma_f32_16x16x32_bf16 v[136:139], a[96:99], a[48:51], v[136:139]
ds_read_b64_tr_b16 a[94:95], v13 offset:25600
v_mfma_f32_16x16x32_bf16 v[136:139], a[100:103], a[68:71], v[136:139]
v_mfma_f32_16x16x32_bf16 v[144:147], a[100:103], a[72:75], v[144:147]
s_add_u32 m0, s16, 0x800
v_mfma_f32_16x16x32_bf16 v[144:147], a[96:99], a[52:55], v[144:147]
buffer_load_dwordx4 v2, s[48:51], s12 offen lds
v_mfma_f32_16x16x32_bf16 v[148:151], a[104:107], a[52:55], v[148:151]
ds_read_b64_tr_b16 a[96:97], v12 offset:16640
v_mfma_f32_16x16x32_bf16 v[148:151], a[108:111], a[72:75], v[148:151]
ds_read_b64_tr_b16 a[98:99], v12 offset:17664
v_mfma_f32_16x16x32_bf16 v[140:143], a[108:111], a[68:71], v[140:143]
ds_read_b64_tr_b16 a[100:101], v12 offset:24832
v_mfma_f32_16x16x32_bf16 v[140:143], a[104:107], a[48:51], v[140:143]
ds_read_b64_tr_b16 a[102:103], v12 offset:25856
v_mfma_f32_16x16x32_bf16 v[132:135], a[104:107], a[44:47], v[132:135]
v_mfma_f32_16x16x32_bf16 v[132:135], a[108:111], a[64:67], v[132:135]
s_add_u32 m0, s16, 0xc00
v_mfma_f32_16x16x32_bf16 v[124:127], a[108:111], a[60:63], v[124:127]
buffer_load_dwordx4 v3, s[48:51], s12 offen lds
v_mfma_f32_16x16x32_bf16 v[124:127], a[104:107], a[40:43], v[124:127]
s_waitcnt lgkmcnt(4)
v_mfma_f32_16x16x32_bf16 v[152:155], a[40:43], a[80:83], v[152:155]
ds_read_b64_tr_b16 a[104:105], v13 offset:16640
v_mfma_f32_16x16x32_bf16 v[152:155], a[60:63], a[84:87], v[152:155]
ds_read_b64_tr_b16 a[106:107], v13 offset:17664
v_mfma_f32_16x16x32_bf16 v[156:159], a[64:67], a[84:87], v[156:159]
ds_read_b64_tr_b16 a[108:109], v13 offset:24832
v_mfma_f32_16x16x32_bf16 v[156:159], a[44:47], a[80:83], v[156:159]
ds_read_b64_tr_b16 a[110:111], v13 offset:25856
v_mfma_f32_16x16x32_bf16 v[160:163], a[48:51], a[80:83], v[160:163]
s_add_u32 m0, s16, 0x1000
v_mfma_f32_16x16x32_bf16 v[160:163], a[68:71], a[84:87], v[160:163]
buffer_load_dwordx4 v2, s[48:51], s13 offen lds
v_mfma_f32_16x16x32_bf16 v[164:167], a[72:75], a[84:87], v[164:167]
v_mfma_f32_16x16x32_bf16 v[164:167], a[52:55], a[80:83], v[164:167]
v_mfma_f32_16x16x32_bf16 v[180:183], a[52:55], a[88:91], v[180:183]
ds_read_b64_tr_b16 a[80:81], v12 offset:16896
v_mfma_f32_16x16x32_bf16 v[180:183], a[72:75], a[92:95], v[180:183]
ds_read_b64_tr_b16 a[82:83], v12 offset:17920
v_mfma_f32_16x16x32_bf16 v[176:179], a[68:71], a[92:95], v[176:179]
ds_read_b64_tr_b16 a[84:85], v12 offset:25088
v_mfma_f32_16x16x32_bf16 v[176:179], a[48:51], a[88:91], v[176:179]
ds_read_b64_tr_b16 a[86:87], v12 offset:26112
s_add_u32 m0, s16, 0x1400
v_mfma_f32_16x16x32_bf16 v[172:175], a[44:47], a[88:91], v[172:175]
buffer_load_dwordx4 v3, s[48:51], s13 offen lds
v_mfma_f32_16x16x32_bf16 v[172:175], a[64:67], a[92:95], v[172:175]
v_mfma_f32_16x16x32_bf16 v[168:171], a[60:63], a[92:95], v[168:171]
v_mfma_f32_16x16x32_bf16 v[168:171], a[40:43], a[88:91], v[168:171]
s_waitcnt lgkmcnt(4)
v_mfma_f32_16x16x32_bf16 v[184:187], a[40:43], a[96:99], v[184:187]
ds_read_b64_tr_b16 a[88:89], v13 offset:16896
v_mfma_f32_16x16x32_bf16 v[184:187], a[60:63], a[100:103], v[184:187]
ds_read_b64_tr_b16 a[90:91], v13 offset:17920
v_mfma_f32_16x16x32_bf16 v[188:191], a[64:67], a[100:103], v[188:191]
ds_read_b64_tr_b16 a[92:93], v13 offset:25088
s_add_u32 m0, s16, 0x1800
v_mfma_f32_16x16x32_bf16 v[188:191], a[44:47], a[96:99], v[188:191]
buffer_load_dwordx4 v2, s[48:51], s14 offen lds
v_mfma_f32_16x16x32_bf16 v[192:195], a[48:51], a[96:99], v[192:195]
ds_read_b64_tr_b16 a[94:95], v13 offset:26112
v_mfma_f32_16x16x32_bf16 v[192:195], a[68:71], a[100:103], v[192:195]
v_mfma_f32_16x16x32_bf16 v[196:199], a[72:75], a[100:103], v[196:199]
v_mfma_f32_16x16x32_bf16 v[196:199], a[52:55], a[96:99], v[196:199]
v_mfma_f32_16x16x32_bf16 v[212:215], a[52:55], a[104:107], v[212:215]
ds_read_b64_tr_b16 a[96:97], v12 offset:17152
v_mfma_f32_16x16x32_bf16 v[212:215], a[72:75], a[108:111], v[212:215]
ds_read_b64_tr_b16 a[98:99], v12 offset:18176
s_add_u32 m0, s16, 0x1c00
v_mfma_f32_16x16x32_bf16 v[208:211], a[68:71], a[108:111], v[208:211]
buffer_load_dwordx4 v3, s[48:51], s14 offen lds
v_mfma_f32_16x16x32_bf16 v[208:211], a[48:51], a[104:107], v[208:211]
ds_read_b64_tr_b16 a[100:101], v12 offset:25344
s_bfe_u32 s39, s40, 0x80018
v_mfma_f32_16x16x32_bf16 v[204:207], a[44:47], a[104:107], v[204:207]
ds_read_b64_tr_b16 a[102:103], v12 offset:26368
s_add_u32 s39, s39, s41
v_mfma_f32_16x16x32_bf16 v[204:207], a[64:67], a[108:111], v[204:207]
s_and_b32 s39, s39, 7
s_sub_u32 s42, s39, s41
s_mov_b32 s41, s39
v_mfma_f32_16x16x32_bf16 v[200:203], a[60:63], a[108:111], v[200:203]
v_lshl_add_u32 v2, s42, 7, v2
v_lshl_add_u32 v3, s42, 7, v3
v_mfma_f32_16x16x32_bf16 v[200:203], a[40:43], a[104:107], v[200:203]
s_waitcnt lgkmcnt(4)
v_mfma_f32_16x16x32_bf16 v[248:251], a[40:43], a[80:83], v[248:251]
ds_read_b64_tr_b16 a[104:105], v13 offset:17152
s_mov_b32 s9, 0x0
v_mfma_f32_16x16x32_bf16 v[248:251], a[60:63], a[84:87], v[248:251]
buffer_load_dword a120, v18, s[52:55], s9 offen
v_mfma_f32_16x16x32_bf16 v[252:255], a[64:67], a[84:87], v[252:255]
ds_read_b64_tr_b16 a[106:107], v13 offset:18176
v_mfma_f32_16x16x32_bf16 v[252:255], a[44:47], a[80:83], v[252:255]
ds_read_b64_tr_b16 a[108:109], v13 offset:25344
v_mfma_f32_16x16x32_bf16 v[216:219], a[48:51], a[80:83], v[216:219]
ds_read_b64_tr_b16 a[110:111], v13 offset:26368
v_add_u32 v12, 0x8000, v12
v_mfma_f32_16x16x32_bf16 v[216:219], a[68:71], a[84:87], v[216:219]
v_add_u32 v13, 0x8000, v13
v_mfma_f32_16x16x32_bf16 v[220:223], a[72:75], a[84:87], v[220:223]
v_mfma_f32_16x16x32_bf16 v[220:223], a[52:55], a[80:83], v[220:223]
v_mfma_f32_16x16x32_bf16 v[236:239], a[52:55], a[88:91], v[236:239]
s_waitcnt vmcnt(27) lgkmcnt(0)
v_mfma_f32_16x16x32_bf16 v[236:239], a[72:75], a[92:95], v[236:239]
s_barrier
s_add_u32 m0, s17, 0x0
v_mfma_f32_16x16x32_bf16 v[232:235], a[68:71], a[92:95], v[232:235]
buffer_load_dwordx4 v5, s[56:59], 0 offen lds
v_mfma_f32_16x16x32_bf16 v[232:235], a[48:51], a[88:91], v[232:235]
ds_read_b64_tr_b16 a[80:81], v12 offset:0
L_padA2:
s_cmp_eq_u32 s95, 1
s_cbranch_scc1 L_padA6
v_mfma_f32_16x16x32_bf16 v[228:231], a[44:47], a[88:91], v[228:231]
ds_read_b64_tr_b16 a[82:83], v12 offset:1024
v_mfma_f32_16x16x32_bf16 v[228:231], a[64:67], a[92:95], v[228:231]
ds_read_b64_tr_b16 a[84:85], v12 offset:8192
v_mfma_f32_16x16x32_bf16 v[224:227], a[60:63], a[92:95], v[224:227]
ds_read_b64_tr_b16 a[86:87], v12 offset:9216
v_mfma_f32_16x16x32_bf16 v[224:227], a[40:43], a[88:91], v[224:227]
s_waitcnt lgkmcnt(4)
v_mfma_f32_16x16x32_bf16 v[240:243], a[40:43], a[96:99], v[240:243]
ds_read_b64_tr_b16 a[88:89], v13 offset:0
s_add_u32 m0, s17, 0x4000
v_mfma_f32_16x16x32_bf16 v[240:243], a[60:63], a[100:103], v[240:243]
buffer_load_dwordx4 v5, s[60:63], 0 offen lds
v_mfma_f32_16x16x32_bf16 v[244:247], a[64:67], a[100:103], v[244:247]
ds_read_b64_tr_b16 a[90:91], v13 offset:1024
v_mfma_f32_16x16x32_bf16 v[244:247], a[44:47], a[96:99], v[244:247]
ds_read_b64_tr_b16 a[92:93], v13 offset:8192
v_mfma_f32_16x16x32_bf16 a[232:235], a[48:51], a[96:99], a[232:235]
ds_read_b64_tr_b16 a[94:95], v13 offset:9216
v_mfma_f32_16x16x32_bf16 a[232:235], a[68:71], a[100:103], a[232:235]
v_mfma_f32_16x16x32_bf16 a[236:239], a[72:75], a[100:103], a[236:239]
v_mfma_f32_16x16x32_bf16 a[236:239], a[52:55], a[96:99], a[236:239]
s_add_u32 m0, s17, 0x400
v_mfma_f32_16x16x32_bf16 a[252:255], a[52:55], a[104:107], a[252:255]
buffer_load_dwordx4 v5, s[56:59], s13 offen lds
v_mfma_f32_16x16x32_bf16 a[252:255], a[72:75], a[108:111], a[252:255]
ds_read_b64_tr_b16 a[96:97], v12 offset:256
v_mfma_f32_16x16x32_bf16 a[248:251], a[68:71], a[108:111], a[248:251]
ds_read_b64_tr_b16 a[98:99], v12 offset:1280
v_mfma_f32_16x16x32_bf16 a[248:251], a[48:51], a[104:107], a[248:251]
ds_read_b64_tr_b16 a[100:101], v12 offset:8448
v_mfma_f32_16x16x32_bf16 a[244:247], a[44:47], a[104:107], a[244:247]
ds_read_b64_tr_b16 a[102:103], v12 offset:9472
v_mfma_f32_16x16x32_bf16 a[244:247], a[64:67], a[108:111], a[244:247]
v_mfma_f32_16x16x32_bf16 a[240:243], a[60:63], a[108:111], a[240:243]
v_mfma_f32_16x16x32_bf16 a[240:243], a[40:43], a[104:107], a[240:243]
s_add_u32 m0, s17, 0x4400
s_waitcnt lgkmcnt(4)
L_S4:
v_mfma_f32_16x16x32_bf16 v[24:27], a[80:83], a[0:3], v[24:27]
buffer_load_dwordx4 v5, s[60:63], s13 offen lds
v_mfma_f32_16x16x32_bf16 v[24:27], a[84:87], a[20:23], v[24:27]
ds_read_b64_tr_b16 a[104:105], v13 offset:256
s_waitcnt vmcnt(23)
v_mfma_f32_16x16x32_bf16 v[32:35], a[84:87], a[24:27], v[32:35]
ds_read_b64_tr_b16 a[106:107], v13 offset:1280
v_mfma_f32_16x16x32_bf16 v[32:35], a[80:83], a[4:7], v[32:35]
ds_read_b64_tr_b16 a[108:109], v13 offset:8448
v_mfma_f32_16x16x32_bf16 v[40:43], a[80:83], a[8:11], v[40:43]
ds_read_b64_tr_b16 a[110:111], v13 offset:9472
v_mfma_f32_16x16x32_bf16 v[40:43], a[84:87], a[28:31], v[40:43]
ds_read_b128 a[40:43], v8 offset:32768
v_mfma_f32_16x16x32_bf16 v[48:51], a[84:87], a[32:35], v[48:51]
ds_read_b128 a[60:63], v9 offset:32768
s_add_u32 m0, s17, 0x800
v_mfma_f32_16x16x32_bf16 v[48:51], a[80:83], a[12:15], v[48:51]
buffer_load_dwordx4 v6, s[56:59], 0 offen lds
v_mfma_f32_16x16x32_bf16 v[52:55], a[88:91], a[12:15], v[52:55]
ds_read_b64_tr_b16 a[80:81], v12 offset:512
v_mfma_f32_16x16x32_bf16 v[52:55], a[92:95], a[32:35], v[52:55]
ds_read_b64_tr_b16 a[82:83], v12 offset:1536
v_mfma_f32_16x16x32_bf16 v[44:47], a[92:95], a[28:31], v[44:47]
ds_read_b64_tr_b16 a[84:85], v12 offset:8704
v_mfma_f32_16x16x32_bf16 v[44:47], a[88:91], a[8:11], v[44:47]
ds_read_b64_tr_b16 a[86:87], v12 offset:9728
v_mfma_f32_16x16x32_bf16 v[36:39], a[88:91], a[4:7], v[36:39]
ds_read_b128 a[44:47], v8 offset:34816
v_mfma_f32_16x16x32_bf16 v[36:39], a[92:95], a[24:27], v[36:39]
ds_read_b128 a[64:67], v9 offset:34816
s_waitcnt lgkmcnt(8)
v_mfma_f32_16x16x32_bf16 v[28:31], a[92:95], a[20:23], v[28:31]
ds_read_b128 a[48:51], v8 offset:36864
s_add_u32 m0, s17, 0x4800
v_mfma_f32_16x16x32_bf16 v[28:31], a[88:91], a[0:3], v[28:31]
buffer_load_dwordx4 v6, s[60:63], 0 offen lds
v_mfma_f32_16x16x32_bf16 v[56:59], a[96:99], a[0:3], v[56:59]
ds_read_b64_tr_b16 a[88:89], v13 offset:512
v_mfma_f32_16x16x32_bf16 v[56:59], a[100:103], a[20:23], v[56:59]
ds_read_b64_tr_b16 a[90:91], v13 offset:1536
v_mfma_f32_16x16x32_bf16 v[64:67], a[100:103], a[24:27], v[64:67]
ds_read_b64_tr_b16 a[92:93], v13 offset:8704
v_mfma_f32_16x16x32_bf16 v[64:67], a[96:99], a[4:7], v[64:67]
ds_read_b64_tr_b16 a[94:95], v13 offset:9728
v_mfma_f32_16x16x32_bf16 v[72:75], a[96:99], a[8:11], v[72:75]
ds_read_b128 a[68:71], v9 offset:36864
v_mfma_f32_16x16x32_bf16 v[72:75], a[100:103], a[28:31], v[72:75]
ds_read_b128 a[52:55], v8 offset:38912
s_add_u32 m0, s17, 0xc00
v_mfma_f32_16x16x32_bf16 v[80:83], a[100:103], a[32:35], v[80:83]
buffer_load_dwordx4 v6, s[56:59], s13 offen lds
v_mfma_f32_16x16x32_bf16 v[80:83], a[96:99], a[12:15], v[80:83]
ds_read_b128 a[72:75], v9 offset:38912
v_mfma_f32_16x16x32_bf16 v[84:87], a[104:107], a[12:15], v[84:87]
ds_read_b64_tr_b16 a[96:97], v12 offset:768
v_mfma_f32_16x16x32_bf16 v[84:87], a[108:111], a[32:35], v[84:87]
ds_read_b64_tr_b16 a[98:99], v12 offset:1792
v_mfma_f32_16x16x32_bf16 v[76:79], a[108:111], a[28:31], v[76:79]
ds_read_b64_tr_b16 a[100:101], v12 offset:8960
v_mfma_f32_16x16x32_bf16 v[76:79], a[104:107], a[8:11], v[76:79]
ds_read_b64_tr_b16 a[102:103], v12 offset:9984
v_mfma_f32_16x16x32_bf16 v[68:71], a[104:107], a[4:7], v[68:71]
s_add_u32 m0, s17, 0x4c00
v_mfma_f32_16x16x32_bf16 v[68:71], a[108:111], a[24:27], v[68:71]
buffer_load_dwordx4 v6, s[60:63], s13 offen lds
v_mfma_f32_16x16x32_bf16 v[60:63], a[108:111], a[20:23], v[60:63]
v_lshl_add_u32 v5, s42, 19, v5
v_lshl_add_u32 v6, s42, 19, v6
v_mfma_f32_16x16x32_bf16 v[60:63], a[104:107], a[0:3], v[60:63]
s_waitcnt lgkmcnt(7)
v_mfma_f32_16x16x32_bf16 v[88:91], a[80:83], a[0:3], v[88:91]
ds_read_b64_tr_b16 a[104:105], v13 offset:768
v_mfma_f32_16x16x32_bf16 v[88:91], a[84:87], a[20:23], v[88:91]
ds_read_b64_tr_b16 a[106:107], v13 offset:1792
v_mfma_f32_16x16x32_bf16 v[96:99], a[84:87], a[24:27], v[96:99]
ds_read_b64_tr_b16 a[108:109], v13 offset:8960
v_mfma_f32_16x16x32_bf16 v[96:99], a[80:83], a[4:7], v[96:99]
ds_read_b64_tr_b16 a[110:111], v13 offset:9984
v_mfma_f32_16x16x32_bf16 v[104:107], a[80:83], a[8:11], v[104:107]
s_add_u32 m0, s16, 0x8000
s_waitcnt lgkmcnt(8)
v_mfma_f32_16x16x32_bf16 v[104:107], a[84:87], a[28:31], v[104:107]
buffer_load_dwordx4 v2, s[48:51], 0 offen lds
v_mfma_f32_16x16x32_bf16 v[112:115], a[84:87], a[32:35], v[112:115]
v_mfma_f32_16x16x32_bf16 v[112:115], a[80:83], a[12:15], v[112:115]
v_mfma_f32_16x16x32_bf16 v[116:119], a[88:91], a[12:15], v[116:119]
ds_read_b64_tr_b16 a[80:81], v12 offset:16384
v_mfma_f32_16x16x32_bf16 v[116:119], a[92:95], a[32:35], v[116:119]
ds_read_b64_tr_b16 a[82:83], v12 offset:17408
v_mfma_f32_16x16x32_bf16 v[108:111], a[92:95], a[28:31], v[108:111]
ds_read_b64_tr_b16 a[84:85], v12 offset:24576
v_mfma_f32_16x16x32_bf16 v[108:111], a[88:91], a[8:11], v[108:111]
ds_read_b64_tr_b16 a[86:87], v12 offset:25600
s_add_u32 m0, s16, 0x8400
v_mfma_f32_16x16x32_bf16 v[100:103], a[88:91], a[4:7], v[100:103]
buffer_load_dwordx4 v3, s[48:51], 0 offen lds
v_mfma_f32_16x16x32_bf16 v[100:103], a[92:95], a[24:27], v[100:103]
v_mfma_f32_16x16x32_bf16 v[92:95], a[92:95], a[20:23], v[92:95]
v_mfma_f32_16x16x32_bf16 v[92:95], a[88:91], a[0:3], v[92:95]
s_waitcnt lgkmcnt(4)
v_mfma_f32_16x16x32_bf16 v[120:123], a[96:99], a[0:3], v[120:123]
ds_read_b64_tr_b16 a[88:89], v13 offset:16384
v_mfma_f32_16x16x32_bf16 v[120:123], a[100:103], a[20:23], v[120:123]
ds_read_b64_tr_b16 a[90:91], v13 offset:17408
v_mfma_f32_16x16x32_bf16 v[128:131], a[100:103], a[24:27], v[128:131]
ds_read_b64_tr_b16 a[92:93], v13 offset:24576
v_mfma_f32_16x16x32_bf16 v[128:131], a[96:99], a[4:7], v[128:131]
ds_read_b64_tr_b16 a[94:95], v13 offset:25600
s_add_u32 m0, s16, 0x8800
v_mfma_f32_16x16x32_bf16 v[136:139], a[96:99], a[8:11], v[136:139]
buffer_load_dwordx4 v2, s[48:51], s12 offen lds
v_mfma_f32_16x16x32_bf16 v[136:139], a[100:103], a[28:31], v[136:139]
v_mfma_f32_16x16x32_bf16 v[144:147], a[100:103], a[32:35], v[144:147]
v_mfma_f32_16x16x32_bf16 v[144:147], a[96:99], a[12:15], v[144:147]
v_mfma_f32_16x16x32_bf16 v[148:151], a[104:107], a[12:15], v[148:151]
ds_read_b64_tr_b16 a[96:97], v12 offset:16640
v_mfma_f32_16x16x32_bf16 v[148:151], a[108:111], a[32:35], v[148:151]
ds_read_b64_tr_b16 a[98:99], v12 offset:17664
v_mfma_f32_16x16x32_bf16 v[140:143], a[108:111], a[28:31], v[140:143]
ds_read_b64_tr_b16 a[100:101], v12 offset:24832
s_add_u32 m0, s16, 0x8c00
v_mfma_f32_16x16x32_bf16 v[140:143], a[104:107], a[8:11], v[140:143]
buffer_load_dwordx4 v3, s[48:51], s12 offen lds
v_mfma_f32_16x16x32_bf16 v[132:135], a[104:107], a[4:7], v[132:135]
ds_read_b64_tr_b16 a[102:103], v12 offset:25856
v_mfma_f32_16x16x32_bf16 v[132:135], a[108:111], a[24:27], v[132:135]
v_mfma_f32_16x16x32_bf16 v[124:127], a[108:111], a[20:23], v[124:127]
v_mfma_f32_16x16x32_bf16 v[124:127], a[104:107], a[0:3], v[124:127]
s_waitcnt lgkmcnt(4)
v_mfma_f32_16x16x32_bf16 v[152:155], a[0:3], a[80:83], v[152:155]
ds_read_b64_tr_b16 a[104:105], v13 offset:16640
v_mfma_f32_16x16x32_bf16 v[152:155], a[20:23], a[84:87], v[152:155]
ds_read_b64_tr_b16 a[106:107], v13 offset:17664
s_add_u32 m0, s16, 0x9000
v_mfma_f32_16x16x32_bf16 v[156:159], a[24:27], a[84:87], v[156:159]
buffer_load_dwordx4 v2, s[48:51], s13 offen lds
v_mfma_f32_16x16x32_bf16 v[156:159], a[4:7], a[80:83], v[156:159]
ds_read_b64_tr_b16 a[108:109], v13 offset:24832
v_mfma_f32_16x16x32_bf16 v[160:163], a[8:11], a[80:83], v[160:163]
ds_read_b64_tr_b16 a[110:111], v13 offset:25856
v_mfma_f32_16x16x32_bf16 v[160:163], a[28:31], a[84:87], v[160:163]
v_mfma_f32_16x16x32_bf16 v[164:167], a[32:35], a[84:87], v[164:167]
v_mfma_f32_16x16x32_bf16 v[164:167], a[12:15], a[80:83], v[164:167]
v_mfma_f32_16x16x32_bf16 v[180:183], a[12:15], a[88:91], v[180:183]
ds_read_b64_tr_b16 a[80:81], v12 offset:16896
v_mfma_f32_16x16x32_bf16 v[180:183], a[32:35], a[92:95], v[180:183]
ds_read_b64_tr_b16 a[82:83], v12 offset:17920
s_add_u32 m0, s16, 0x9400
v_mfma_f32_16x16x32_bf16 v[176:179], a[28:31], a[92:95], v[176:179]
buffer_load_dwordx4 v3, s[48:51], s13 offen lds
v_mfma_f32_16x16x32_bf16 v[176:179], a[8:11], a[88:91], v[176:179]
ds_read_b64_tr_b16 a[84:85], v12 offset:25088
v_mfma_f32_16x16x32_bf16 v[172:175], a[4:7], a[88:91], v[172:175]
ds_read_b64_tr_b16 a[86:87], v12 offset:26112
v_mfma_f32_16x16x32_bf16 v[172:175], a[24:27], a[92:95], v[172:175]
v_mfma_f32_16x16x32_bf16 v[168:171], a[20:23], a[92:95], v[168:171]
v_mfma_f32_16x16x32_bf16 v[168:171], a[0:3], a[88:91], v[168:171]
s_waitcnt lgkmcnt(4)
v_mfma_f32_16x16x32_bf16 v[184:187], a[0:3], a[96:99], v[184:187]
ds_read_b64_tr_b16 a[88:89], v13 offset:16896
s_add_u32 m0, s16, 0x9800
v_mfma_f32_16x16x32_bf16 v[184:187], a[20:23], a[100:103], v[184:187]
buffer_load_dwordx4 v2, s[48:51], s14 offen lds
v_mfma_f32_16x16x32_bf16 v[188:191], a[24:27], a[100:103], v[188:191]
ds_read_b64_tr_b16 a[90:91], v13 offset:17920
v_mfma_f32_16x16x32_bf16 v[188:191], a[4:7], a[96:99], v[188:191]
ds_read_b64_tr_b16 a[92:93], v13 offset:25088
v_mfma_f32_16x16x32_bf16 v[192:195], a[8:11], a[96:99], v[192:195]
ds_read_b64_tr_b16 a[94:95], v13 offset:26112
v_mfma_f32_16x16x32_bf16 v[192:195], a[28:31], a[100:103], v[192:195]
v_mfma_f32_16x16x32_bf16 v[196:199], a[32:35], a[100:103], v[196:199]
v_mfma_f32_16x16x32_bf16 v[196:199], a[12:15], a[96:99], v[196:199]
v_mfma_f32_16x16x32_bf16 v[212:215], a[12:15], a[104:107], v[212:215]
ds_read_b64_tr_b16 a[96:97], v12 offset:17152
s_add_u32 m0, s16, 0x9c00
v_mfma_f32_16x16x32_bf16 v[212:215], a[32:35], a[108:111], v[212:215]
buffer_load_dwordx4 v3, s[48:51], s14 offen lds
v_mfma_f32_16x16x32_bf16 v[208:211], a[28:31], a[108:111], v[208:211]
ds_read_b64_tr_b16 a[98:99], v12 offset:18176
s_sub_u32 s42, s43, s41
v_mfma_f32_16x16x32_bf16 v[208:211], a[8:11], a[104:107], v[208:211]
ds_read_b64_tr_b16 a[100:101], v12 offset:25344
s_mov_b32 s41, s43
v_mfma_f32_16x16x32_bf16 v[204:207], a[4:7], a[104:107], v[204:207]
ds_read_b64_tr_b16 a[102:103], v12 offset:26368
v_mfma_f32_16x16x32_bf16 v[204:207], a[24:27], a[108:111], v[204:207]
v_mfma_f32_16x16x32_bf16 v[200:203], a[20:23], a[108:111], v[200:203]
v_mfma_f32_16x16x32_bf16 v[200:203], a[0:3], a[104:107], v[200:203]
s_mov_b32 s9, 0x0
s_waitcnt lgkmcnt(4)
v_mfma_f32_16x16x32_bf16 v[248:251], a[0:3], a[80:83], v[248:251]
buffer_load_dword a120, v19, s[68:71], s9 offen
v_mfma_f32_16x16x32_bf16 v[248:251], a[20:23], a[84:87], v[248:251]
ds_read_b64_tr_b16 a[104:105], v13 offset:17152
v_mfma_f32_16x16x32_bf16 v[252:255], a[24:27], a[84:87], v[252:255]
ds_read_b64_tr_b16 a[106:107], v13 offset:18176
v_mfma_f32_16x16x32_bf16 v[252:255], a[4:7], a[80:83], v[252:255]
ds_read_b64_tr_b16 a[108:109], v13 offset:25344
v_mfma_f32_16x16x32_bf16 v[216:219], a[8:11], a[80:83], v[216:219]
ds_read_b64_tr_b16 a[110:111], v13 offset:26368
v_add_u32 v12, 0x8000, v12
v_mfma_f32_16x16x32_bf16 v[216:219], a[28:31], a[84:87], v[216:219]
v_add_u32 v13, 0x8000, v13
v_mfma_f32_16x16x32_bf16 v[220:223], a[32:35], a[84:87], v[220:223]
v_mfma_f32_16x16x32_bf16 v[220:223], a[12:15], a[80:83], v[220:223]
v_mfma_f32_16x16x32_bf16 v[236:239], a[12:15], a[88:91], v[236:239]
s_waitcnt vmcnt(27) lgkmcnt(0)
v_mfma_f32_16x16x32_bf16 v[236:239], a[32:35], a[92:95], v[236:239]
s_barrier
s_add_u32 m0, s17, 0x8000
v_mfma_f32_16x16x32_bf16 v[232:235], a[28:31], a[92:95], v[232:235]
buffer_load_dwordx4 v5, s[56:59], 0 offen lds
v_mfma_f32_16x16x32_bf16 v[232:235], a[8:11], a[88:91], v[232:235]
ds_read_b64_tr_b16 a[80:81], v12 offset:0
v_mfma_f32_16x16x32_bf16 v[228:231], a[4:7], a[88:91], v[228:231]
ds_read_b64_tr_b16 a[82:83], v12 offset:1024
v_mfma_f32_16x16x32_bf16 v[228:231], a[24:27], a[92:95], v[228:231]
ds_read_b64_tr_b16 a[84:85], v12 offset:8192
v_mfma_f32_16x16x32_bf16 v[224:227], a[20:23], a[92:95], v[224:227]
ds_read_b64_tr_b16 a[86:87], v12 offset:9216
v_mfma_f32_16x16x32_bf16 v[224:227], a[0:3], a[88:91], v[224:227]
s_add_u32 m0, s17, 0xc000
s_waitcnt lgkmcnt(4)
v_mfma_f32_16x16x32_bf16 v[240:243], a[0:3], a[96:99], v[240:243]
buffer_load_dwordx4 v5, s[60:63], 0 offen lds
v_mfma_f32_16x16x32_bf16 v[240:243], a[20:23], a[100:103], v[240:243]
ds_read_b64_tr_b16 a[88:89], v13 offset:0
v_mfma_f32_16x16x32_bf16 v[244:247], a[24:27], a[100:103], v[244:247]
ds_read_b64_tr_b16 a[90:91], v13 offset:1024
v_mfma_f32_16x16x32_bf16 v[244:247], a[4:7], a[96:99], v[244:247]
ds_read_b64_tr_b16 a[92:93], v13 offset:8192
v_mfma_f32_16x16x32_bf16 a[232:235], a[8:11], a[96:99], a[232:235]
ds_read_b64_tr_b16 a[94:95], v13 offset:9216
v_mfma_f32_16x16x32_bf16 a[232:235], a[28:31], a[100:103], a[232:235]
v_mfma_f32_16x16x32_bf16 a[236:239], a[32:35], a[100:103], a[236:239]
s_add_u32 m0, s17, 0x8400
v_mfma_f32_16x16x32_bf16 a[236:239], a[12:15], a[96:99], a[236:239]
buffer_load_dwordx4 v5, s[56:59], s13 offen lds
v_mfma_f32_16x16x32_bf16 a[252:255], a[12:15], a[104:107], a[252:255]
ds_read_b64_tr_b16 a[96:97], v12 offset:256
v_mfma_f32_16x16x32_bf16 a[252:255], a[32:35], a[108:111], a[252:255]
ds_read_b64_tr_b16 a[98:99], v12 offset:1280
v_mfma_f32_16x16x32_bf16 a[248:251], a[28:31], a[108:111], a[248:251]
ds_read_b64_tr_b16 a[100:101], v12 offset:8448
v_mfma_f32_16x16x32_bf16 a[248:251], a[8:11], a[104:107], a[248:251]
ds_read_b64_tr_b16 a[102:103], v12 offset:9472
v_mfma_f32_16x16x32_bf16 a[244:247], a[4:7], a[104:107], a[244:247]
s_add_u32 m0, s17, 0xc400
v_mfma_f32_16x16x32_bf16 a[244:247], a[24:27], a[108:111], a[244:247]
buffer_load_dwordx4 v5, s[60:63], s13 offen lds
v_mfma_f32_16x16x32_bf16 a[240:243], a[20:23], a[108:111], a[240:243]
v_mfma_f32_16x16x32_bf16 a[240:243], a[0:3], a[104:107], a[240:243]
s_waitcnt lgkmcnt(4)
L_S5:
v_mfma_f32_16x16x32_bf16 v[24:27], a[80:83], a[40:43], v[24:27]
ds_read_b64_tr_b16 a[104:105], v13 offset:256
s_waitcnt vmcnt(22)
v_mfma_f32_16x16x32_bf16 v[24:27], a[84:87], a[60:63], v[24:27]
ds_read_b64_tr_b16 a[106:107], v13 offset:1280
v_mfma_f32_16x16x32_bf16 v[32:35], a[84:87], a[64:67], v[32:35]
ds_read_b64_tr_b16 a[108:109], v13 offset:8448
v_mfma_f32_16x16x32_bf16 v[32:35], a[80:83], a[44:47], v[32:35]
ds_read_b64_tr_b16 a[110:111], v13 offset:9472
s_add_u32 m0, s17, 0x8800
v_mfma_f32_16x16x32_bf16 v[40:43], a[80:83], a[48:51], v[40:43]
buffer_load_dwordx4 v6, s[56:59], 0 offen lds
v_mfma_f32_16x16x32_bf16 v[40:43], a[84:87], a[68:71], v[40:43]
ds_read_b128 a[0:3], v8 offset:0
v_mfma_f32_16x16x32_bf16 v[48:51], a[84:87], a[72:75], v[48:51]
ds_read_b128 a[20:23], v9 offset:0
v_mfma_f32_16x16x32_bf16 v[48:51], a[80:83], a[52:55], v[48:51]
ds_read_b128 a[4:7], v8 offset:2048
v_mfma_f32_16x16x32_bf16 v[52:55], a[88:91], a[52:55], v[52:55]
ds_read_b64_tr_b16 a[80:81], v12 offset:512
v_mfma_f32_16x16x32_bf16 v[52:55], a[92:95], a[72:75], v[52:55]
ds_read_b64_tr_b16 a[82:83], v12 offset:1536
v_mfma_f32_16x16x32_bf16 v[44:47], a[92:95], a[68:71], v[44:47]
ds_read_b64_tr_b16 a[84:85], v12 offset:8704
s_mov_b32 s9, 0x200000
v_mfma_f32_16x16x32_bf16 v[44:47], a[88:91], a[48:51], v[44:47]
buffer_load_dword a120, v18, s[52:55], s9 offen
v_mfma_f32_16x16x32_bf16 v[36:39], a[88:91], a[44:47], v[36:39]
ds_read_b64_tr_b16 a[86:87], v12 offset:9728
v_mfma_f32_16x16x32_bf16 v[36:39], a[92:95], a[64:67], v[36:39]
ds_read_b128 a[24:27], v9 offset:2048
v_mfma_f32_16x16x32_bf16 v[28:31], a[92:95], a[60:63], v[28:31]
ds_read_b128 a[8:11], v8 offset:4096
v_mfma_f32_16x16x32_bf16 v[28:31], a[88:91], a[40:43], v[28:31]
ds_read_b128 a[28:31], v9 offset:4096
s_waitcnt lgkmcnt(10)
v_mfma_f32_16x16x32_bf16 v[56:59], a[96:99], a[40:43], v[56:59]
ds_read_b64_tr_b16 a[88:89], v13 offset:512
s_add_u32 m0, s17, 0xc800
v_mfma_f32_16x16x32_bf16 v[56:59], a[100:103], a[60:63], v[56:59]
buffer_load_dwordx4 v6, s[60:63], 0 offen lds
v_mfma_f32_16x16x32_bf16 v[64:67], a[100:103], a[64:67], v[64:67]
ds_read_b64_tr_b16 a[90:91], v13 offset:1536
v_mfma_f32_16x16x32_bf16 v[64:67], a[96:99], a[44:47], v[64:67]
ds_read_b64_tr_b16 a[92:93], v13 offset:8704
v_mfma_f32_16x16x32_bf16 v[72:75], a[96:99], a[48:51], v[72:75]
ds_read_b64_tr_b16 a[94:95], v13 offset:9728
v_mfma_f32_16x16x32_bf16 v[72:75], a[100:103], a[68:71], v[72:75]
ds_read_b128 a[12:15], v8 offset:6144
v_mfma_f32_16x16x32_bf16 v[80:83], a[100:103], a[72:75], v[80:83]
ds_read_b128 a[32:35], v9 offset:6144
v_mfma_f32_16x16x32_bf16 v[80:83], a[96:99], a[52:55], v[80:83]
s_add_u32 m0, s17, 0x8c00
v_mfma_f32_16x16x32_bf16 v[84:87], a[104:107], a[52:55], v[84:87]
buffer_load_dwordx4 v6, s[56:59], s13 offen lds
v_mfma_f32_16x16x32_bf16 v[84:87], a[108:111], a[72:75], v[84:87]
ds_read_b64_tr_b16 a[96:97], v12 offset:768
v_mfma_f32_16x16x32_bf16 v[76:79], a[108:111], a[68:71], v[76:79]
ds_read_b64_tr_b16 a[98:99], v12 offset:1792
v_mfma_f32_16x16x32_bf16 v[76:79], a[104:107], a[48:51], v[76:79]
ds_read_b64_tr_b16 a[100:101], v12 offset:8960
v_mfma_f32_16x16x32_bf16 v[68:71], a[104:107], a[44:47], v[68:71]
ds_read_b64_tr_b16 a[102:103], v12 offset:9984
v_mfma_f32_16x16x32_bf16 v[68:71], a[108:111], a[64:67], v[68:71]
v_mfma_f32_16x16x32_bf16 v[60:63], a[108:111], a[60:63], v[60:63]
s_add_u32 m0, s17, 0xcc00
s_waitcnt lgkmcnt(6)
v_mfma_f32_16x16x32_bf16 v[60:63], a[104:107], a[40:43], v[60:63]
buffer_load_dwordx4 v6, s[60:63], s13 offen lds
v_mfma_f32_16x16x32_bf16 v[88:91], a[80:83], a[40:43], v[88:91]
ds_read_b64_tr_b16 a[104:105], v13 offset:768
v_lshl_add_u32 v5, s42, 19, v5
v_mfma_f32_16x16x32_bf16 v[88:91], a[84:87], a[60:63], v[88:91]
ds_read_b64_tr_b16 a[106:107], v13 offset:1792
v_lshl_add_u32 v6, s42, 19, v6
v_mfma_f32_16x16x32_bf16 v[96:99], a[84:87], a[64:67], v[96:99]
ds_read_b64_tr_b16 a[108:109], v13 offset:8960
v_mfma_f32_16x16x32_bf16 v[96:99], a[80:83], a[44:47], v[96:99]
ds_read_b64_tr_b16 a[110:111], v13 offset:9984
v_mfma_f32_16x16x32_bf16 v[104:107], a[80:83], a[48:51], v[104:107]
s_add_u32 m0, s16, 0x0
s_waitcnt lgkmcnt(8)
v_mfma_f32_16x16x32_bf16 v[104:107], a[84:87], a[68:71], v[104:107]
buffer_load_dwordx4 v22, s[44:47], s20 offen lds
v_mfma_f32_16x16x32_bf16 v[112:115], a[84:87], a[72:75], v[112:115]
v_mfma_f32_16x16x32_bf16 v[112:115], a[80:83], a[52:55], v[112:115]
v_mfma_f32_16x16x32_bf16 v[116:119], a[88:91], a[52:55], v[116:119]
ds_read_b64_tr_b16 a[80:81], v12 offset:16384
v_mfma_f32_16x16x32_bf16 v[116:119], a[92:95], a[72:75], v[116:119]
ds_read_b64_tr_b16 a[82:83], v12 offset:17408
v_mfma_f32_16x16x32_bf16 v[108:111], a[92:95], a[68:71], v[108:111]
ds_read_b64_tr_b16 a[84:85], v12 offset:24576
v_mfma_f32_16x16x32_bf16 v[108:111], a[88:91], a[48:51], v[108:111]
ds_read_b64_tr_b16 a[86:87], v12 offset:25600
s_add_u32 m0, s16, 0x400
v_mfma_f32_16x16x32_bf16 v[100:103], a[88:91], a[44:47], v[100:103]
buffer_load_dwordx4 v23, s[44:47], s20 offen lds
v_mfma_f32_16x16x32_bf16 v[100:103], a[92:95], a[64:67], v[100:103]
v_mfma_f32_16x16x32_bf16 v[92:95], a[92:95], a[60:63], v[92:95]
v_mfma_f32_16x16x32_bf16 v[92:95], a[88:91], a[40:43], v[92:95]
s_waitcnt lgkmcnt(4)
v_mfma_f32_16x16x32_bf16 v[120:123], a[96:99], a[40:43], v[120:123]
ds_read_b64_tr_b16 a[88:89], v13 offset:16384
v_mfma_f32_16x16x32_bf16 v[120:123], a[100:103], a[60:63], v[120:123]
ds_read_b64_tr_b16 a[90:91], v13 offset:17408
s_mov_b32 s9, 0x200000
v_mfma_f32_16x16x32_bf16 v[128:131], a[100:103], a[64:67], v[128:131]
buffer_load_dword a120, v19, s[68:71], s9 offen
v_mfma_f32_16x16x32_bf16 v[128:131], a[96:99], a[44:47], v[128:131]
ds_read_b64_tr_b16 a[92:93], v13 offset:24576
v_mfma_f32_16x16x32_bf16 v[136:139], a[96:99], a[48:51], v[136:139]
ds_read_b64_tr_b16 a[94:95], v13 offset:25600
v_mfma_f32_16x16x32_bf16 v[136:139], a[100:103], a[68:71], v[136:139]
v_mfma_f32_16x16x32_bf16 v[144:147], a[100:103], a[72:75], v[144:147]
v_mfma_f32_16x16x32_bf16 v[144:147], a[96:99], a[52:55], v[144:147]
v_mfma_f32_16x16x32_bf16 v[148:151], a[104:107], a[52:55], v[148:151]
ds_read_b64_tr_b16 a[96:97], v12 offset:16640
s_add_u32 m0, s16, 0x800
v_mfma_f32_16x16x32_bf16 v[148:151], a[108:111], a[72:75], v[148:151]
buffer_load_dwordx4 v22, s[44:47], s21 offen lds
v_mfma_f32_16x16x32_bf16 v[140:143], a[108:111], a[68:71], v[140:143]
ds_read_b64_tr_b16 a[98:99], v12 offset:17664
v_mfma_f32_16x16x32_bf16 v[140:143], a[104:107], a[48:51], v[140:143]
ds_read_b64_tr_b16 a[100:101], v12 offset:24832
v_mfma_f32_16x16x32_bf16 v[132:135], a[104:107], a[44:47], v[132:135]
ds_read_b64_tr_b16 a[102:103], v12 offset:25856
v_mfma_f32_16x16x32_bf16 v[132:135], a[108:111], a[64:67], v[132:135]
v_mfma_f32_16x16x32_bf16 v[124:127], a[108:111], a[60:63], v[124:127]
v_mfma_f32_16x16x32_bf16 v[124:127], a[104:107], a[40:43], v[124:127]
s_add_u32 m0, s16, 0xc00
s_waitcnt lgkmcnt(4)
v_mfma_f32_16x16x32_bf16 v[152:155], a[40:43], a[80:83], v[152:155]
buffer_load_dwordx4 v23, s[44:47], s21 offen lds
v_mfma_f32_16x16x32_bf16 v[152:155], a[60:63], a[84:87], v[152:155]
ds_read_b64_tr_b16 a[104:105], v13 offset:16640
v_mfma_f32_16x16x32_bf16 v[156:159], a[64:67], a[84:87], v[156:159]
ds_read_b64_tr_b16 a[106:107], v13 offset:17664
v_mfma_f32_16x16x32_bf16 v[156:159], a[44:47], a[80:83], v[156:159]
ds_read_b64_tr_b16 a[108:109], v13 offset:24832
v_mfma_f32_16x16x32_bf16 v[160:163], a[48:51], a[80:83], v[160:163]
ds_read_b64_tr_b16 a[110:111], v13 offset:25856
v_mfma_f32_16x16x32_bf16 v[160:163], a[68:71], a[84:87], v[160:163]
s_add_u32 m0, s16, 0x1000
v_mfma_f32_16x16x32_bf16 v[164:167], a[72:75], a[84:87], v[164:167]
buffer_load_dwordx4 v22, s[44:47], s22 offen lds
v_mfma_f32_16x16x32_bf16 v[164:167], a[52:55], a[80:83], v[164:167]
v_mfma_f32_16x16x32_bf16 v[180:183], a[52:55], a[88:91], v[180:183]
ds_read_b64_tr_b16 a[80:81], v12 offset:16896
v_mfma_f32_16x16x32_bf16 v[180:183], a[72:75], a[92:95], v[180:183]
ds_read_b64_tr_b16 a[82:83], v12 offset:17920
v_mfma_f32_16x16x32_bf16 v[176:179], a[68:71], a[92:95], v[176:179]
ds_read_b64_tr_b16 a[84:85], v12 offset:25088
v_mfma_f32_16x16x32_bf16 v[176:179], a[48:51], a[88:91], v[176:179]
ds_read_b64_tr_b16 a[86:87], v12 offset:26112
v_mfma_f32_16x16x32_bf16 v[172:175], a[44:47], a[88:91], v[172:175]
s_add_u32 m0, s16, 0x1400
v_mfma_f32_16x16x32_bf16 v[172:175], a[64:67], a[92:95], v[172:175]
buffer_load_dwordx4 v23, s[44:47], s22 offen lds
v_mfma_f32_16x16x32_bf16 v[168:171], a[60:63], a[92:95], v[168:171]
v_mfma_f32_16x16x32_bf16 v[168:171], a[40:43], a[88:91], v[168:171]
s_waitcnt lgkmcnt(4)
v_mfma_f32_16x16x32_bf16 v[184:187], a[40:43], a[96:99], v[184:187]
ds_read_b64_tr_b16 a[88:89], v13 offset:16896
v_mfma_f32_16x16x32_bf16 v[184:187], a[60:63], a[100:103], v[184:187]
ds_read_b64_tr_b16 a[90:91], v13 offset:17920
v_mfma_f32_16x16x32_bf16 v[188:191], a[64:67], a[100:103], v[188:191]
ds_read_b64_tr_b16 a[92:93], v13 offset:25088
v_mfma_f32_16x16x32_bf16 v[188:191], a[44:47], a[96:99], v[188:191]
ds_read_b64_tr_b16 a[94:95], v13 offset:26112
s_add_u32 m0, s16, 0x1800
v_mfma_f32_16x16x32_bf16 v[192:195], a[48:51], a[96:99], v[192:195]
buffer_load_dwordx4 v22, s[44:47], s23 offen lds
v_mfma_f32_16x16x32_bf16 v[192:195], a[68:71], a[100:103], v[192:195]
v_mfma_f32_16x16x32_bf16 v[196:199], a[72:75], a[100:103], v[196:199]
v_mfma_f32_16x16x32_bf16 v[196:199], a[52:55], a[96:99], v[196:199]
v_mfma_f32_16x16x32_bf16 v[212:215], a[52:55], a[104:107], v[212:215]
ds_read_b64_tr_b16 a[96:97], v12 offset:17152
v_mfma_f32_16x16x32_bf16 v[212:215], a[72:75], a[108:111], v[212:215]
ds_read_b64_tr_b16 a[98:99], v12 offset:18176
s_add_u32 m0, s16, 0x1c00
v_mfma_f32_16x16x32_bf16 v[208:211], a[68:71], a[108:111], v[208:211]
buffer_load_dwordx4 v23, s[44:47], s23 offen lds
v_mfma_f32_16x16x32_bf16 v[208:211], a[48:51], a[104:107], v[208:211]
ds_read_b64_tr_b16 a[100:101], v12 offset:25344
s_bfe_u32 s39, s40, 0x80008
v_mfma_f32_16x16x32_bf16 v[204:207], a[44:47], a[104:107], v[204:207]
ds_read_b64_tr_b16 a[102:103], v12 offset:26368
s_add_u32 s39, s39, s41
v_mfma_f32_16x16x32_bf16 v[204:207], a[64:67], a[108:111], v[204:207]
s_and_b32 s39, s39, 15
s_sub_u32 s42, s39, s41
s_mov_b32 s41, s39
v_mfma_f32_16x16x32_bf16 v[200:203], a[60:63], a[108:111], v[200:203]
v_lshl_add_u32 v22, s42, 7, v22
v_lshl_add_u32 v23, s42, 7, v23
v_mfma_f32_16x16x32_bf16 v[200:203], a[40:43], a[104:107], v[200:203]
s_waitcnt lgkmcnt(4)
v_mov_b32 v21, s1
v_mfma_f32_16x16x32_bf16 v[248:251], a[40:43], a[80:83], v[248:251]
ds_read_b64_tr_b16 a[104:105], v13 offset:17152
v_add_u32 v20, s0, v16
v_mfma_f32_16x16x32_bf16 v[248:251], a[60:63], a[84:87], v[248:251]
global_load_dword a120, v[20:21], off sc1
v_mfma_f32_16x16x32_bf16 v[252:255], a[64:67], a[84:87], v[252:255]
ds_read_b64_tr_b16 a[106:107], v13 offset:18176
v_mfma_f32_16x16x32_bf16 v[252:255], a[44:47], a[80:83], v[252:255]
ds_read_b64_tr_b16 a[108:109], v13 offset:25344
v_mfma_f32_16x16x32_bf16 v[216:219], a[48:51], a[80:83], v[216:219]
ds_read_b64_tr_b16 a[110:111], v13 offset:26368
v_add_u32 v12, 0xffff0000, v12
v_mfma_f32_16x16x32_bf16 v[216:219], a[68:71], a[84:87], v[216:219]
v_add_u32 v13, 0xffff0000, v13
v_mfma_f32_16x16x32_bf16 v[220:223], a[72:75], a[84:87], v[220:223]
v_mfma_f32_16x16x32_bf16 v[220:223], a[52:55], a[80:83], v[220:223]
v_mfma_f32_16x16x32_bf16 v[236:239], a[52:55], a[88:91], v[236:239]
s_waitcnt vmcnt(28) lgkmcnt(0)
v_mfma_f32_16x16x32_bf16 v[236:239], a[72:75], a[92:95], v[236:239]
s_barrier
s_add_u32 m0, s17, 0x10000
v_mfma_f32_16x16x32_bf16 v[232:235], a[68:71], a[92:95], v[232:235]
buffer_load_dwordx4 v5, s[52:55], 0 offen lds
v_mfma_f32_16x16x32_bf16 v[232:235], a[48:51], a[88:91], v[232:235]
ds_read_b64_tr_b16 a[80:81], v12 offset:0
s_mul_i32 s28, s5, 0x10c400
v_mfma_f32_16x16x32_bf16 v[228:231], a[44:47], a[88:91], v[228:231]
ds_read_b64_tr_b16 a[82:83], v12 offset:1024
s_mov_b32 s48, s88
v_mfma_f32_16x16x32_bf16 v[228:231], a[64:67], a[92:95], v[228:231]
ds_read_b64_tr_b16 a[84:85], v12 offset:8192
s_mov_b32 s49, s89
v_mfma_f32_16x16x32_bf16 v[224:227], a[60:63], a[92:95], v[224:227]
ds_read_b64_tr_b16 a[86:87], v12 offset:9216
s_sub_u32 s11, 16, s6
v_mfma_f32_16x16x32_bf16 v[224:227], a[40:43], a[88:91], v[224:227]
s_waitcnt lgkmcnt(4)
s_lshl_b32 s11, s11, 16
s_add_u32 s11, s11, s28
v_mfma_f32_16x16x32_bf16 v[240:243], a[40:43], a[96:99], v[240:243]
ds_read_b64_tr_b16 a[88:89], v13 offset:0
L_padA3:
s_cmp_eq_u32 s95, 1
s_cbranch_scc1 L_padA7
s_add_u32 m0, s17, 0x10400
v_mfma_f32_16x16x32_bf16 v[240:243], a[60:63], a[100:103], v[240:243]
buffer_load_dwordx4 v5, s[52:55], s13 offen lds
v_mfma_f32_16x16x32_bf16 v[244:247], a[64:67], a[100:103], v[244:247]
ds_read_b64_tr_b16 a[90:91], v13 offset:1024
s_add_u32 s50, s11, 0x2000
v_mfma_f32_16x16x32_bf16 v[244:247], a[44:47], a[96:99], v[244:247]
ds_read_b64_tr_b16 a[92:93], v13 offset:8192
s_lshl_b32 s11, s6, 17
v_mfma_f32_16x16x32_bf16 a[232:235], a[48:51], a[96:99], a[232:235]
ds_read_b64_tr_b16 a[94:95], v13 offset:9216
s_add_u32 s28, s28, s11
v_mfma_f32_16x16x32_bf16 a[232:235], a[68:71], a[100:103], a[232:235]
s_lshl_b32 s11, s4, 15
s_add_u32 s28, s28, s11
s_lshl_b32 s10, s5, 2
v_mfma_f32_16x16x32_bf16 a[236:239], a[72:75], a[100:103], a[236:239]
s_add_u32 s10, s10, 64
v_mfma_f32_16x16x32_bf16 a[236:239], a[52:55], a[96:99], a[236:239]
s_add_u32 m0, s17, 0x10800
v_mfma_f32_16x16x32_bf16 a[252:255], a[52:55], a[104:107], a[252:255]
buffer_load_dwordx4 v6, s[52:55], 0 offen lds
v_mfma_f32_16x16x32_bf16 a[252:255], a[72:75], a[108:111], a[252:255]
ds_read_b64_tr_b16 a[96:97], v12 offset:256
v_mfma_f32_16x16x32_bf16 a[248:251], a[68:71], a[108:111], a[248:251]
ds_read_b64_tr_b16 a[98:99], v12 offset:1280
v_mfma_f32_16x16x32_bf16 a[248:251], a[48:51], a[104:107], a[248:251]
ds_read_b64_tr_b16 a[100:101], v12 offset:8448
v_mfma_f32_16x16x32_bf16 a[244:247], a[44:47], a[104:107], a[244:247]
ds_read_b64_tr_b16 a[102:103], v12 offset:9472
v_mfma_f32_16x16x32_bf16 a[244:247], a[64:67], a[108:111], a[244:247]
v_mfma_f32_16x16x32_bf16 a[240:243], a[60:63], a[108:111], a[240:243]
v_mfma_f32_16x16x32_bf16 a[240:243], a[40:43], a[104:107], a[240:243]
s_add_u32 m0, s17, 0x10c00
s_waitcnt lgkmcnt(4)
L_S6:
v_mfma_f32_16x16x32_bf16 v[24:27], a[80:83], a[0:3], v[24:27]
buffer_load_dwordx4 v6, s[52:55], s13 offen lds
v_mfma_f32_16x16x32_bf16 v[24:27], a[84:87], a[20:23], v[24:27]
ds_read_b64_tr_b16 a[104:105], v13 offset:256
s_waitcnt vmcnt(24)
v_mfma_f32_16x16x32_bf16 v[32:35], a[84:87], a[24:27], v[32:35]
ds_read_b64_tr_b16 a[106:107], v13 offset:1280
v_mfma_f32_16x16x32_bf16 v[32:35], a[80:83], a[4:7], v[32:35]
ds_read_b64_tr_b16 a[108:109], v13 offset:8448
v_mfma_f32_16x16x32_bf16 v[40:43], a[80:83], a[8:11], v[40:43]
ds_read_b64_tr_b16 a[110:111], v13 offset:9472
v_mfma_f32_16x16x32_bf16 v[40:43], a[84:87], a[28:31], v[40:43]
ds_read_b128 a[40:43], v8 offset:32768
v_mfma_f32_16x16x32_bf16 v[48:51], a[84:87], a[32:35], v[48:51]
ds_read_b128 a[60:63], v9 offset:32768
s_add_u32 m0, s18, 0x14000
v_mfma_f32_16x16x32_bf16 v[48:51], a[80:83], a[12:15], v[48:51]
buffer_load_dwordx4 v7, s[68:71], 0 offen lds
v_mfma_f32_16x16x32_bf16 v[52:55], a[88:91], a[12:15], v[52:55]
ds_read_b64_tr_b16 a[80:81], v12 offset:512
v_mfma_f32_16x16x32_bf16 v[52:55], a[92:95], a[32:35], v[52:55]
ds_read_b64_tr_b16 a[82:83], v12 offset:1536
v_mfma_f32_16x16x32_bf16 v[44:47], a[92:95], a[28:31], v[44:47]
ds_read_b64_tr_b16 a[84:85], v12 offset:8704
v_mfma_f32_16x16x32_bf16 v[44:47], a[88:91], a[8:11], v[44:47]
ds_read_b64_tr_b16 a[86:87], v12 offset:9728
v_mfma_f32_16x16x32_bf16 v[36:39], a[88:91], a[4:7], v[36:39]
ds_read_b128 a[44:47], v8 offset:34816
v_mfma_f32_16x16x32_bf16 v[36:39], a[92:95], a[24:27], v[36:39]
ds_read_b128 a[64:67], v9 offset:34816
s_waitcnt lgkmcnt(8)
v_mfma_f32_16x16x32_bf16 v[28:31], a[92:95], a[20:23], v[28:31]
ds_read_b128 a[48:51], v8 offset:36864
s_add_u32 m0, s18, 0x15000
v_mfma_f32_16x16x32_bf16 v[28:31], a[88:91], a[0:3], v[28:31]
buffer_load_dwordx4 v7, s[68:71], s25 offen lds
v_mfma_f32_16x16x32_bf16 v[56:59], a[96:99], a[0:3], v[56:59]
ds_read_b64_tr_b16 a[88:89], v13 offset:512
v_mfma_f32_16x16x32_bf16 v[56:59], a[100:103], a[20:23], v[56:59]
ds_read_b64_tr_b16 a[90:91], v13 offset:1536
v_mfma_f32_16x16x32_bf16 v[64:67], a[100:103], a[24:27], v[64:67]
ds_read_b64_tr_b16 a[92:93], v13 offset:8704
v_mfma_f32_16x16x32_bf16 v[64:67], a[96:99], a[4:7], v[64:67]
ds_read_b64_tr_b16 a[94:95], v13 offset:9728
v_mfma_f32_16x16x32_bf16 v[72:75], a[96:99], a[8:11], v[72:75]
ds_read_b128 a[68:71], v9 offset:36864
v_mfma_f32_16x16x32_bf16 v[72:75], a[100:103], a[28:31], v[72:75]
ds_read_b128 a[52:55], v8 offset:38912
s_add_u32 m0, s18, 0x16000
v_mfma_f32_16x16x32_bf16 v[80:83], a[100:103], a[32:35], v[80:83]
buffer_load_dwordx4 v7, s[68:71], s26 offen lds
v_mfma_f32_16x16x32_bf16 v[80:83], a[96:99], a[12:15], v[80:83]
ds_read_b128 a[72:75], v9 offset:38912
v_mfma_f32_16x16x32_bf16 v[84:87], a[104:107], a[12:15], v[84:87]
ds_read_b64_tr_b16 a[96:97], v12 offset:768
v_mfma_f32_16x16x32_bf16 v[84:87], a[108:111], a[32:35], v[84:87]
ds_read_b64_tr_b16 a[98:99], v12 offset:1792
v_mfma_f32_16x16x32_bf16 v[76:79], a[108:111], a[28:31], v[76:79]
ds_read_b64_tr_b16 a[100:101], v12 offset:8960
v_mfma_f32_16x16x32_bf16 v[76:79], a[104:107], a[8:11], v[76:79]
ds_read_b64_tr_b16 a[102:103], v12 offset:9984
v_mfma_f32_16x16x32_bf16 v[68:71], a[104:107], a[4:7], v[68:71]
s_add_u32 m0, s18, 0x17000
v_mfma_f32_16x16x32_bf16 v[68:71], a[108:111], a[24:27], v[68:71]
buffer_load_dwordx4 v4, s[44:47], s24 offen lds
v_mfma_f32_16x16x32_bf16 v[60:63], a[108:111], a[20:23], v[60:63]
v_lshl_add_u32 v5, s42, 19, v5
v_lshl_add_u32 v6, s42, 19, v6
v_mfma_f32_16x16x32_bf16 v[60:63], a[104:107], a[0:3], v[60:63]
s_waitcnt lgkmcnt(7)
v_lshl_add_u32 v7, s42, 18, v7
v_lshl_add_u32 v7, s42, 17, v7
v_mfma_f32_16x16x32_bf16 v[88:91], a[80:83], a[0:3], v[88:91]
ds_read_b64_tr_b16 a[104:105], v13 offset:768
v_lshl_add_u32 v4, s42, 7, v4
v_mfma_f32_16x16x32_bf16 v[88:91], a[84:87], a[20:23], v[88:91]
ds_read_b64_tr_b16 a[106:107], v13 offset:1792
v_mfma_f32_16x16x32_bf16 v[96:99], a[84:87], a[24:27], v[96:99]
ds_read_b64_tr_b16 a[108:109], v13 offset:8960
v_mfma_f32_16x16x32_bf16 v[96:99], a[80:83], a[4:7], v[96:99]
ds_read_b64_tr_b16 a[110:111], v13 offset:9984
v_mfma_f32_16x16x32_bf16 v[104:107], a[80:83], a[8:11], v[104:107]
s_add_u32 m0, s16, 0x8000
s_waitcnt lgkmcnt(8)
v_mfma_f32_16x16x32_bf16 v[104:107], a[84:87], a[28:31], v[104:107]
buffer_load_dwordx4 v22, s[44:47], s20 offen lds
v_mfma_f32_16x16x32_bf16 v[112:115], a[84:87], a[32:35], v[112:115]
v_mfma_f32_16x16x32_bf16 v[112:115], a[80:83], a[12:15], v[112:115]
v_mfma_f32_16x16x32_bf16 v[116:119], a[88:91], a[12:15], v[116:119]
ds_read_b64_tr_b16 a[80:81], v12 offset:16384
v_mfma_f32_16x16x32_bf16 v[116:119], a[92:95], a[32:35], v[116:119]
ds_read_b64_tr_b16 a[82:83], v12 offset:17408
v_mfma_f32_16x16x32_bf16 v[108:111], a[92:95], a[28:31], v[108:111]
ds_read_b64_tr_b16 a[84:85], v12 offset:24576
v_mfma_f32_16x16x32_bf16 v[108:111], a[88:91], a[8:11], v[108:111]
ds_read_b64_tr_b16 a[86:87], v12 offset:25600
s_add_u32 m0, s16, 0x8400
v_mfma_f32_16x16x32_bf16 v[100:103], a[88:91], a[4:7], v[100:103]
buffer_load_dwordx4 v23, s[44:47], s20 offen lds
v_mfma_f32_16x16x32_bf16 v[100:103], a[92:95], a[24:27], v[100:103]
v_mfma_f32_16x16x32_bf16 v[92:95], a[92:95], a[20:23], v[92:95]
v_mfma_f32_16x16x32_bf16 v[92:95], a[88:91], a[0:3], v[92:95]
s_waitcnt lgkmcnt(4)
v_mfma_f32_16x16x32_bf16 v[120:123], a[96:99], a[0:3], v[120:123]
ds_read_b64_tr_b16 a[88:89], v13 offset:16384
v_mfma_f32_16x16x32_bf16 v[120:123], a[100:103], a[20:23], v[120:123]
ds_read_b64_tr_b16 a[90:91], v13 offset:17408
v_mfma_f32_16x16x32_bf16 v[128:131], a[100:103], a[24:27], v[128:131]
ds_read_b64_tr_b16 a[92:93], v13 offset:24576
v_mfma_f32_16x16x32_bf16 v[128:131], a[96:99], a[4:7], v[128:131]
ds_read_b64_tr_b16 a[94:95], v13 offset:25600
s_add_u32 m0, s16, 0x8800
v_mfma_f32_16x16x32_bf16 v[136:139], a[96:99], a[8:11], v[136:139]
buffer_load_dwordx4 v22, s[44:47], s21 offen lds
v_mfma_f32_16x16x32_bf16 v[136:139], a[100:103], a[28:31], v[136:139]
v_mfma_f32_16x16x32_bf16 v[144:147], a[100:103], a[32:35], v[144:147]
v_mfma_f32_16x16x32_bf16 v[144:147], a[96:99], a[12:15], v[144:147]
v_mfma_f32_16x16x32_bf16 v[148:151], a[104:107], a[12:15], v[148:151]
ds_read_b64_tr_b16 a[96:97], v12 offset:16640
v_mfma_f32_16x16x32_bf16 v[148:151], a[108:111], a[32:35], v[148:151]
ds_read_b64_tr_b16 a[98:99], v12 offset:17664
v_mfma_f32_16x16x32_bf16 v[140:143], a[108:111], a[28:31], v[140:143]
ds_read_b64_tr_b16 a[100:101], v12 offset:24832
s_add_u32 m0, s16, 0x8c00
v_mfma_f32_16x16x32_bf16 v[140:143], a[104:107], a[8:11], v[140:143]
buffer_load_dwordx4 v23, s[44:47], s21 offen lds
v_mfma_f32_16x16x32_bf16 v[132:135], a[104:107], a[4:7], v[132:135]
ds_read_b64_tr_b16 a[102:103], v12 offset:25856
v_mfma_f32_16x16x32_bf16 v[132:135], a[108:111], a[24:27], v[132:135]
v_mfma_f32_16x16x32_bf16 v[124:127], a[108:111], a[20:23], v[124:127]
v_mfma_f32_16x16x32_bf16 v[124:127], a[104:107], a[0:3], v[124:127]
s_waitcnt lgkmcnt(4)
v_mfma_f32_16x16x32_bf16 v[152:155], a[0:3], a[80:83], v[152:155]
ds_read_b64_tr_b16 a[104:105], v13 offset:16640
v_mfma_f32_16x16x32_bf16 v[152:155], a[20:23], a[84:87], v[152:155]
ds_read_b64_tr_b16 a[106:107], v13 offset:17664
s_add_u32 m0, s16, 0x9000
v_mfma_f32_16x16x32_bf16 v[156:159], a[24:27], a[84:87], v[156:159]
buffer_load_dwordx4 v22, s[44:47], s22 offen lds
v_mfma_f32_16x16x32_bf16 v[156:159], a[4:7], a[80:83], v[156:159]
ds_read_b64_tr_b16 a[108:109], v13 offset:24832
v_mfma_f32_16x16x32_bf16 v[160:163], a[8:11], a[80:83], v[160:163]
ds_read_b64_tr_b16 a[110:111], v13 offset:25856
v_mfma_f32_16x16x32_bf16 v[160:163], a[28:31], a[84:87], v[160:163]
v_mfma_f32_16x16x32_bf16 v[164:167], a[32:35], a[84:87], v[164:167]
v_mfma_f32_16x16x32_bf16 v[164:167], a[12:15], a[80:83], v[164:167]
v_mfma_f32_16x16x32_bf16 v[180:183], a[12:15], a[88:91], v[180:183]
ds_read_b64_tr_b16 a[80:81], v12 offset:16896
v_mfma_f32_16x16x32_bf16 v[180:183], a[32:35], a[92:95], v[180:183]
ds_read_b64_tr_b16 a[82:83], v12 offset:17920
s_add_u32 m0, s16, 0x9400
v_mfma_f32_16x16x32_bf16 v[176:179], a[28:31], a[92:95], v[176:179]
buffer_load_dwordx4 v23, s[44:47], s22 offen lds
v_mfma_f32_16x16x32_bf16 v[176:179], a[8:11], a[88:91], v[176:179]
ds_read_b64_tr_b16 a[84:85], v12 offset:25088
v_mfma_f32_16x16x32_bf16 v[172:175], a[4:7], a[88:91], v[172:175]
ds_read_b64_tr_b16 a[86:87], v12 offset:26112
v_mfma_f32_16x16x32_bf16 v[172:175], a[24:27], a[92:95], v[172:175]
v_mfma_f32_16x16x32_bf16 v[168:171], a[20:23], a[92:95], v[168:171]
v_mfma_f32_16x16x32_bf16 v[168:171], a[0:3], a[88:91], v[168:171]
s_waitcnt lgkmcnt(4)
v_mfma_f32_16x16x32_bf16 v[184:187], a[0:3], a[96:99], v[184:187]
ds_read_b64_tr_b16 a[88:89], v13 offset:16896
s_add_u32 m0, s16, 0x9800
v_mfma_f32_16x16x32_bf16 v[184:187], a[20:23], a[100:103], v[184:187]
buffer_load_dwordx4 v22, s[44:47], s23 offen lds
v_mfma_f32_16x16x32_bf16 v[188:191], a[24:27], a[100:103], v[188:191]
ds_read_b64_tr_b16 a[90:91], v13 offset:17920
v_mfma_f32_16x16x32_bf16 v[188:191], a[4:7], a[96:99], v[188:191]
ds_read_b64_tr_b16 a[92:93], v13 offset:25088
v_mfma_f32_16x16x32_bf16 v[192:195], a[8:11], a[96:99], v[192:195]
ds_read_b64_tr_b16 a[94:95], v13 offset:26112
v_mfma_f32_16x16x32_bf16 v[192:195], a[28:31], a[100:103], v[192:195]
v_mfma_f32_16x16x32_bf16 v[196:199], a[32:35], a[100:103], v[196:199]
v_mfma_f32_16x16x32_bf16 v[196:199], a[12:15], a[96:99], v[196:199]
v_mfma_f32_16x16x32_bf16 v[212:215], a[12:15], a[104:107], v[212:215]
ds_read_b64_tr_b16 a[96:97], v12 offset:17152
s_add_u32 m0, s16, 0x9c00
v_mfma_f32_16x16x32_bf16 v[212:215], a[32:35], a[108:111], v[212:215]
buffer_load_dwordx4 v23, s[44:47], s23 offen lds
v_mfma_f32_16x16x32_bf16 v[208:211], a[28:31], a[108:111], v[208:211]
ds_read_b64_tr_b16 a[98:99], v12 offset:18176
s_bfe_u32 s39, s40, 0x80010
v_mfma_f32_16x16x32_bf16 v[208:211], a[8:11], a[104:107], v[208:211]
ds_read_b64_tr_b16 a[100:101], v12 offset:25344
s_add_u32 s39, s39, s41
v_mfma_f32_16x16x32_bf16 v[204:207], a[4:7], a[104:107], v[204:207]
ds_read_b64_tr_b16 a[102:103], v12 offset:26368
s_and_b32 s39, s39, 15
v_mfma_f32_16x16x32_bf16 v[204:207], a[24:27], a[108:111], v[204:207]
s_sub_u32 s42, s39, s41
s_mov_b32 s41, s39
v_lshl_add_u32 v22, s42, 7, v22
v_mfma_f32_16x16x32_bf16 v[200:203], a[20:23], a[108:111], v[200:203]
v_lshl_add_u32 v23, s42, 7, v23
v_mfma_f32_16x16x32_bf16 v[200:203], a[0:3], a[104:107], v[200:203]
s_mov_b32 s9, 0x400000
s_waitcnt lgkmcnt(4)
v_mfma_f32_16x16x32_bf16 v[248:251], a[0:3], a[80:83], v[248:251]
buffer_load_dword a120, v18, s[52:55], s9 offen
v_mfma_f32_16x16x32_bf16 v[248:251], a[20:23], a[84:87], v[248:251]
ds_read_b64_tr_b16 a[104:105], v13 offset:17152
v_mfma_f32_16x16x32_bf16 v[252:255], a[24:27], a[84:87], v[252:255]
ds_read_b64_tr_b16 a[106:107], v13 offset:18176
v_mfma_f32_16x16x32_bf16 v[252:255], a[4:7], a[80:83], v[252:255]
ds_read_b64_tr_b16 a[108:109], v13 offset:25344
v_mfma_f32_16x16x32_bf16 v[216:219], a[8:11], a[80:83], v[216:219]
ds_read_b64_tr_b16 a[110:111], v13 offset:26368
v_add_u32 v12, 0x8000, v12
v_mfma_f32_16x16x32_bf16 v[216:219], a[28:31], a[84:87], v[216:219]
v_add_u32 v13, 0x8000, v13
v_mfma_f32_16x16x32_bf16 v[220:223], a[32:35], a[84:87], v[220:223]
v_mfma_f32_16x16x32_bf16 v[220:223], a[12:15], a[80:83], v[220:223]
v_mfma_f32_16x16x32_bf16 v[236:239], a[12:15], a[88:91], v[236:239]
s_waitcnt vmcnt(27) lgkmcnt(0)
v_mfma_f32_16x16x32_bf16 v[236:239], a[32:35], a[92:95], v[236:239]
s_barrier
s_add_u32 m0, s17, 0x0
v_mfma_f32_16x16x32_bf16 v[232:235], a[28:31], a[92:95], v[232:235]
buffer_load_dwordx4 v5, s[52:55], 0 offen lds
v_mfma_f32_16x16x32_bf16 v[232:235], a[8:11], a[88:91], v[232:235]
ds_read_b64_tr_b16 a[80:81], v12 offset:0
v_mfma_f32_16x16x32_bf16 v[228:231], a[4:7], a[88:91], v[228:231]
ds_read_b64_tr_b16 a[82:83], v12 offset:1024
v_mfma_f32_16x16x32_bf16 v[228:231], a[24:27], a[92:95], v[228:231]
ds_read_b64_tr_b16 a[84:85], v12 offset:8192
v_mfma_f32_16x16x32_bf16 v[224:227], a[20:23], a[92:95], v[224:227]
ds_read_b64_tr_b16 a[86:87], v12 offset:9216
v_mfma_f32_16x16x32_bf16 v[224:227], a[0:3], a[88:91], v[224:227]
s_waitcnt lgkmcnt(4)
v_mfma_f32_16x16x32_bf16 v[240:243], a[0:3], a[96:99], v[240:243]
ds_read_b64_tr_b16 a[88:89], v13 offset:0
s_add_u32 m0, s17, 0x400
v_mfma_f32_16x16x32_bf16 v[240:243], a[20:23], a[100:103], v[240:243]
buffer_load_dwordx4 v5, s[52:55], s13 offen lds
v_mfma_f32_16x16x32_bf16 v[244:247], a[24:27], a[100:103], v[244:247]
ds_read_b64_tr_b16 a[90:91], v13 offset:1024
v_mfma_f32_16x16x32_bf16 v[244:247], a[4:7], a[96:99], v[244:247]
ds_read_b64_tr_b16 a[92:93], v13 offset:8192
v_mfma_f32_16x16x32_bf16 a[232:235], a[8:11], a[96:99], a[232:235]
ds_read_b64_tr_b16 a[94:95], v13 offset:9216
v_mfma_f32_16x16x32_bf16 a[232:235], a[28:31], a[100:103], a[232:235]
v_mfma_f32_16x16x32_bf16 a[236:239], a[32:35], a[100:103], a[236:239]
v_mfma_f32_16x16x32_bf16 a[236:239], a[12:15], a[96:99], a[236:239]
s_add_u32 m0, s17, 0x800
v_mfma_f32_16x16x32_bf16 a[252:255], a[12:15], a[104:107], a[252:255]
buffer_load_dwordx4 v6, s[52:55], 0 offen lds
v_mfma_f32_16x16x32_bf16 a[252:255], a[32:35], a[108:111], a[252:255]
ds_read_b64_tr_b16 a[96:97], v12 offset:256
v_mfma_f32_16x16x32_bf16 a[248:251], a[28:31], a[108:111], a[248:251]
ds_read_b64_tr_b16 a[98:99], v12 offset:1280
v_mfma_f32_16x16x32_bf16 a[248:251], a[8:11], a[104:107], a[248:251]
ds_read_b64_tr_b16 a[100:101], v12 offset:8448
v_mfma_f32_16x16x32_bf16 a[244:247], a[4:7], a[104:107], a[244:247]
ds_read_b64_tr_b16 a[102:103], v12 offset:9472
v_mfma_f32_16x16x32_bf16 a[244:247], a[24:27], a[108:111], a[244:247]
v_mfma_f32_16x16x32_bf16 a[240:243], a[20:23], a[108:111], a[240:243]
s_add_u32 m0, s17, 0xc00
s_waitcnt lgkmcnt(4)
v_mfma_f32_16x16x32_bf16 a[240:243], a[0:3], a[104:107], a[240:243]
buffer_load_dwordx4 v6, s[52:55], s13 offen lds
L_S7:
v_mfma_f32_16x16x32_bf16 v[24:27], a[80:83], a[40:43], v[24:27]
ds_read_b64_tr_b16 a[104:105], v13 offset:256
s_waitcnt vmcnt(22)
v_mfma_f32_16x16x32_bf16 v[24:27], a[84:87], a[60:63], v[24:27]
ds_read_b64_tr_b16 a[106:107], v13 offset:1280
v_mfma_f32_16x16x32_bf16 v[32:35], a[84:87], a[64:67], v[32:35]
ds_read_b64_tr_b16 a[108:109], v13 offset:8448
v_mfma_f32_16x16x32_bf16 v[32:35], a[80:83], a[44:47], v[32:35]
ds_read_b64_tr_b16 a[110:111], v13 offset:9472
v_mfma_f32_16x16x32_bf16 v[40:43], a[80:83], a[48:51], v[40:43]
ds_read_b128 a[0:3], v8 offset:0
v_mfma_f32_16x16x32_bf16 v[40:43], a[84:87], a[68:71], v[40:43]
ds_read_b128 a[20:23], v9 offset:0
s_add_u32 m0, s18, 0x4000
v_mfma_f32_16x16x32_bf16 v[48:51], a[84:87], a[72:75], v[48:51]
buffer_load_dwordx4 v7, s[68:71], 0 offen lds
v_mfma_f32_16x16x32_bf16 v[48:51], a[80:83], a[52:55], v[48:51]
ds_read_b128 a[4:7], v8 offset:2048
v_mfma_f32_16x16x32_bf16 v[52:55], a[88:91], a[52:55], v[52:55]
ds_read_b64_tr_b16 a[80:81], v12 offset:512
v_mfma_f32_16x16x32_bf16 v[52:55], a[92:95], a[72:75], v[52:55]
ds_read_b64_tr_b16 a[82:83], v12 offset:1536
v_mfma_f32_16x16x32_bf16 v[44:47], a[92:95], a[68:71], v[44:47]
ds_read_b64_tr_b16 a[84:85], v12 offset:8704
v_mfma_f32_16x16x32_bf16 v[44:47], a[88:91], a[48:51], v[44:47]
ds_read_b64_tr_b16 a[86:87], v12 offset:9728
v_mfma_f32_16x16x32_bf16 v[36:39], a[88:91], a[44:47], v[36:39]
ds_read_b128 a[24:27], v9 offset:2048
s_add_u32 m0, s18, 0x5000
v_mfma_f32_16x16x32_bf16 v[36:39], a[92:95], a[64:67], v[36:39]
buffer_load_dwordx4 v7, s[68:71], s25 offen lds
v_mfma_f32_16x16x32_bf16 v[28:31], a[92:95], a[60:63], v[28:31]
ds_read_b128 a[8:11], v8 offset:4096
v_mfma_f32_16x16x32_bf16 v[28:31], a[88:91], a[40:43], v[28:31]
ds_read_b128 a[28:31], v9 offset:4096
s_waitcnt lgkmcnt(10)
v_mfma_f32_16x16x32_bf16 v[56:59], a[96:99], a[40:43], v[56:59]
ds_read_b64_tr_b16 a[88:89], v13 offset:512
v_mfma_f32_16x16x32_bf16 v[56:59], a[100:103], a[60:63], v[56:59]
ds_read_b64_tr_b16 a[90:91], v13 offset:1536
v_mfma_f32_16x16x32_bf16 v[64:67], a[100:103], a[64:67], v[64:67]
ds_read_b64_tr_b16 a[92:93], v13 offset:8704
v_mfma_f32_16x16x32_bf16 v[64:67], a[96:99], a[44:47], v[64:67]
ds_read_b64_tr_b16 a[94:95], v13 offset:9728
s_add_u32 m0, s18, 0x6000
v_mfma_f32_16x16x32_bf16 v[72:75], a[96:99], a[48:51], v[72:75]
buffer_load_dwordx4 v7, s[68:71], s26 offen lds
v_cvt_pk_bf16_f32 v24, v24, v25
v_mfma_f32_16x16x32_bf16 v[72:75], a[100:103], a[68:71], v[72:75]
ds_read_b128 a[12:15], v8 offset:6144
v_cvt_pk_bf16_f32 v25, v26, v27
v_mfma_f32_16x16x32_bf16 v[80:83], a[100:103], a[72:75], v[80:83]
ds_read_b128 a[32:35], v9 offset:6144
v_cvt_pk_bf16_f32 v26, v28, v29
v_cvt_pk_bf16_f32 v27, v30, v31
v_mfma_f32_16x16x32_bf16 v[80:83], a[96:99], a[52:55], v[80:83]
v_accvgpr_write_b32 a128, v24
v_accvgpr_write_b32 a129, v25
v_mfma_f32_16x16x32_bf16 v[84:87], a[104:107], a[52:55], v[84:87]
ds_read_b64_tr_b16 a[96:97], v12 offset:768
v_accvgpr_write_b32 a130, v26
v_accvgpr_write_b32 a131, v27
v_mfma_f32_16x16x32_bf16 v[84:87], a[108:111], a[72:75], v[84:87]
ds_read_b64_tr_b16 a[98:99], v12 offset:1792
v_cvt_pk_bf16_f32 v32, v32, v33
v_mfma_f32_16x16x32_bf16 v[76:79], a[108:111], a[68:71], v[76:79]
ds_read_b64_tr_b16 a[100:101], v12 offset:8960
s_add_u32 m0, s18, 0x7000
v_cvt_pk_bf16_f32 v33, v34, v35
v_mfma_f32_16x16x32_bf16 v[76:79], a[104:107], a[48:51], v[76:79]
buffer_load_dwordx4 v4, s[44:47], s24 offen lds
v_mfma_f32_16x16x32_bf16 v[68:71], a[104:107], a[44:47], v[68:71]
ds_read_b64_tr_b16 a[102:103], v12 offset:9984
v_lshl_add_u32 v5, s42, 19, v5
v_cvt_pk_bf16_f32 v34, v36, v37
v_mfma_f32_16x16x32_bf16 v[68:71], a[108:111], a[64:67], v[68:71]
v_lshl_add_u32 v6, s42, 19, v6
v_lshl_add_u32 v7, s42, 18, v7
v_mfma_f32_16x16x32_bf16 v[60:63], a[108:111], a[60:63], v[60:63]
v_lshl_add_u32 v7, s42, 17, v7
v_lshl_add_u32 v4, s42, 7, v4
v_cvt_pk_bf16_f32 v35, v38, v39
v_mfma_f32_16x16x32_bf16 v[60:63], a[104:107], a[40:43], v[60:63]
s_waitcnt lgkmcnt(6)
v_accvgpr_write_b32 a132, v32
v_accvgpr_write_b32 a133, v33
v_mfma_f32_16x16x32_bf16 v[88:91], a[80:83], a[40:43], v[88:91]
ds_read_b64_tr_b16 a[104:105], v13 offset:768
v_accvgpr_write_b32 a134, v34
v_accvgpr_write_b32 a135, v35
v_mfma_f32_16x16x32_bf16 v[88:91], a[84:87], a[60:63], v[88:91]
ds_read_b64_tr_b16 a[106:107], v13 offset:1792
s_mov_b32 s9, 0x400000
v_mfma_f32_16x16x32_bf16 v[96:99], a[84:87], a[64:67], v[96:99]
buffer_load_dword a120, v19, s[68:71], s9 offen
v_cvt_pk_bf16_f32 v40, v40, v41
v_mfma_f32_16x16x32_bf16 v[96:99], a[80:83], a[44:47], v[96:99]
ds_read_b64_tr_b16 a[108:109], v13 offset:8960
v_cvt_pk_bf16_f32 v41, v42, v43
v_mfma_f32_16x16x32_bf16 v[104:107], a[80:83], a[48:51], v[104:107]
ds_read_b64_tr_b16 a[110:111], v13 offset:9984
v_cvt_pk_bf16_f32 v42, v44, v45
v_cvt_pk_bf16_f32 v43, v46, v47
v_mfma_f32_16x16x32_bf16 v[104:107], a[84:87], a[68:71], v[104:107]
v_accvgpr_write_b32 a136, v40
v_accvgpr_write_b32 a137, v41
v_mfma_f32_16x16x32_bf16 v[112:115], a[84:87], a[72:75], v[112:115]
v_accvgpr_write_b32 a138, v42
v_accvgpr_write_b32 a139, v43
v_cvt_pk_bf16_f32 v48, v48, v49
v_mfma_f32_16x16x32_bf16 v[112:115], a[80:83], a[52:55], v[112:115]
s_waitcnt lgkmcnt(8)
v_cvt_pk_bf16_f32 v49, v50, v51
v_cvt_pk_bf16_f32 v50, v52, v53
v_mfma_f32_16x16x32_bf16 v[116:119], a[88:91], a[52:55], v[116:119]
ds_read_b64_tr_b16 a[80:81], v12 offset:16384
s_add_u32 m0, s16, 0x0
v_cvt_pk_bf16_f32 v51, v54, v55
v_mfma_f32_16x16x32_bf16 v[116:119], a[92:95], a[72:75], v[116:119]
buffer_load_dwordx4 v22, s[44:47], s20 offen lds
v_mfma_f32_16x16x32_bf16 v[108:111], a[92:95], a[68:71], v[108:111]
ds_read_b64_tr_b16 a[82:83], v12 offset:17408
v_accvgpr_write_b32 a140, v48
v_accvgpr_write_b32 a141, v49
v_mfma_f32_16x16x32_bf16 v[108:111], a[88:91], a[48:51], v[108:111]
ds_read_b64_tr_b16 a[84:85], v12 offset:24576
v_accvgpr_write_b32 a142, v50
v_mfma_f32_16x16x32_bf16 v[100:103], a[88:91], a[44:47], v[100:103]
ds_read_b64_tr_b16 a[86:87], v12 offset:25600
v_accvgpr_write_b32 a143, v51
v_cvt_pk_bf16_f32 v56, v56, v57
v_mfma_f32_16x16x32_bf16 v[100:103], a[92:95], a[64:67], v[100:103]
v_cvt_pk_bf16_f32 v57, v58, v59
v_cvt_pk_bf16_f32 v58, v60, v61
v_mfma_f32_16x16x32_bf16 v[92:95], a[92:95], a[60:63], v[92:95]
v_cvt_pk_bf16_f32 v59, v62, v63
v_accvgpr_write_b32 a144, v56
v_accvgpr_write_b32 a145, v57
v_mfma_f32_16x16x32_bf16 v[92:95], a[88:91], a[40:43], v[92:95]
s_add_u32 m0, s16, 0x400
s_waitcnt lgkmcnt(4)
v_accvgpr_write_b32 a146, v58
v_mfma_f32_16x16x32_bf16 v[120:123], a[96:99], a[40:43], v[120:123]
buffer_load_dwordx4 v23, s[44:47], s20 offen lds
v_accvgpr_write_b32 a147, v59
v_mfma_f32_16x16x32_bf16 v[120:123], a[100:103], a[60:63], v[120:123]
ds_read_b64_tr_b16 a[88:89], v13 offset:16384
v_cvt_pk_bf16_f32 v64, v64, v65
v_mfma_f32_16x16x32_bf16 v[128:131], a[100:103], a[64:67], v[128:131]
ds_read_b64_tr_b16 a[90:91], v13 offset:17408
v_cvt_pk_bf16_f32 v65, v66, v67
v_cvt_pk_bf16_f32 v66, v68, v69
v_mfma_f32_16x16x32_bf16 v[128:131], a[96:99], a[44:47], v[128:131]
ds_read_b64_tr_b16 a[92:93], v13 offset:24576
v_cvt_pk_bf16_f32 v67, v70, v71
v_mfma_f32_16x16x32_bf16 v[136:139], a[96:99], a[48:51], v[136:139]
ds_read_b64_tr_b16 a[94:95], v13 offset:25600
v_accvgpr_write_b32 a148, v64
v_accvgpr_write_b32 a149, v65
v_mfma_f32_16x16x32_bf16 v[136:139], a[100:103], a[68:71], v[136:139]
v_accvgpr_write_b32 a150, v66
v_accvgpr_write_b32 a151, v67
v_mfma_f32_16x16x32_bf16 v[144:147], a[100:103], a[72:75], v[144:147]
s_add_u32 m0, s16, 0x800
v_cvt_pk_bf16_f32 v72, v72, v73
v_cvt_pk_bf16_f32 v73, v74, v75
v_cvt_pk_bf16_f32 v74, v76, v77
v_mfma_f32_16x16x32_bf16 v[144:147], a[96:99], a[52:55], v[144:147]
buffer_load_dwordx4 v22, s[44:47], s21 offen lds
v_mfma_f32_16x16x32_bf16 v[148:151], a[104:107], a[52:55], v[148:151]
ds_read_b64_tr_b16 a[96:97], v12 offset:16640
v_cvt_pk_bf16_f32 v75, v78, v79
v_accvgpr_write_b32 a152, v72
v_mfma_f32_16x16x32_bf16 v[148:151], a[108:111], a[72:75], v[148:151]
ds_read_b64_tr_b16 a[98:99], v12 offset:17664
v_accvgpr_write_b32 a153, v73
v_mfma_f32_16x16x32_bf16 v[140:143], a[108:111], a[68:71], v[140:143]
ds_read_b64_tr_b16 a[100:101], v12 offset:24832
v_accvgpr_write_b32 a154, v74
v_accvgpr_write_b32 a155, v75
v_mfma_f32_16x16x32_bf16 v[140:143], a[104:107], a[48:51], v[140:143]
ds_read_b64_tr_b16 a[102:103], v12 offset:25856
v_cvt_pk_bf16_f32 v80, v80, v81
v_mfma_f32_16x16x32_bf16 v[132:135], a[104:107], a[44:47], v[132:135]
v_cvt_pk_bf16_f32 v81, v82, v83
v_cvt_pk_bf16_f32 v82, v84, v85
v_cvt_pk_bf16_f32 v83, v86, v87
v_mfma_f32_16x16x32_bf16 v[132:135], a[108:111], a[64:67], v[132:135]
s_add_u32 m0, s16, 0xc00
v_accvgpr_write_b32 a156, v80
v_accvgpr_write_b32 a157, v81
v_mfma_f32_16x16x32_bf16 v[124:127], a[108:111], a[60:63], v[124:127]
buffer_load_dwordx4 v23, s[44:47], s21 offen lds
v_accvgpr_write_b32 a158, v82
v_mfma_f32_16x16x32_bf16 v[124:127], a[104:107], a[40:43], v[124:127]
s_waitcnt lgkmcnt(4)
v_accvgpr_write_b32 a159, v83
v_cvt_pk_bf16_f32 v88, v88, v89
v_mfma_f32_16x16x32_bf16 v[152:155], a[40:43], a[80:83], v[152:155]
ds_read_b64_tr_b16 a[104:105], v13 offset:16640
v_cvt_pk_bf16_f32 v89, v90, v91
v_cvt_pk_bf16_f32 v90, v92, v93
v_mfma_f32_16x16x32_bf16 v[152:155], a[60:63], a[84:87], v[152:155]
ds_read_b64_tr_b16 a[106:107], v13 offset:17664
v_cvt_pk_bf16_f32 v91, v94, v95
v_mfma_f32_16x16x32_bf16 v[156:159], a[64:67], a[84:87], v[156:159]
ds_read_b64_tr_b16 a[108:109], v13 offset:24832
v_accvgpr_write_b32 a160, v88
v_accvgpr_write_b32 a161, v89
v_mfma_f32_16x16x32_bf16 v[156:159], a[44:47], a[80:83], v[156:159]
ds_read_b64_tr_b16 a[110:111], v13 offset:25856
v_accvgpr_write_b32 a162, v90
v_mfma_f32_16x16x32_bf16 v[160:163], a[48:51], a[80:83], v[160:163]
s_add_u32 m0, s16, 0x1000
v_accvgpr_write_b32 a163, v91
v_cvt_pk_bf16_f32 v96, v96, v97
v_cvt_pk_bf16_f32 v97, v98, v99
v_mfma_f32_16x16x32_bf16 v[160:163], a[68:71], a[84:87], v[160:163]
buffer_load_dwordx4 v22, s[44:47], s22 offen lds
v_mfma_f32_16x16x32_bf16 v[164:167], a[72:75], a[84:87], v[164:167]
v_cvt_pk_bf16_f32 v98, v100, v101
v_cvt_pk_bf16_f32 v99, v102, v103
v_accvgpr_write_b32 a164, v96
v_mfma_f32_16x16x32_bf16 v[164:167], a[52:55], a[80:83], v[164:167]
v_accvgpr_write_b32 a165, v97
v_accvgpr_write_b32 a166, v98
v_mfma_f32_16x16x32_bf16 v[180:183], a[52:55], a[88:91], v[180:183]
ds_read_b64_tr_b16 a[80:81], v12 offset:16896
v_accvgpr_write_b32 a167, v99
v_cvt_pk_bf16_f32 v104, v104, v105
v_mfma_f32_16x16x32_bf16 v[180:183], a[72:75], a[92:95], v[180:183]
ds_read_b64_tr_b16 a[82:83], v12 offset:17920
L_padA4:
s_cmp_eq_u32 s95, 1
s_cbranch_scc1 L_padA8
v_cvt_pk_bf16_f32 v105, v106, v107
v_mfma_f32_16x16x32_bf16 v[176:179], a[68:71], a[92:95], v[176:179]
ds_read_b64_tr_b16 a[84:85], v12 offset:25088
v_cvt_pk_bf16_f32 v106, v108, v109
v_cvt_pk_bf16_f32 v107, v110, v111
v_mfma_f32_16x16x32_bf16 v[176:179], a[48:51], a[88:91], v[176:179]
ds_read_b64_tr_b16 a[86:87], v12 offset:26112
s_add_u32 m0, s16, 0x1400
v_mfma_f32_16x16x32_bf16 v[172:175], a[44:47], a[88:91], v[172:175]
buffer_load_dwordx4 v23, s[44:47], s22 offen lds
v_accvgpr_write_b32 a168, v104
v_mfma_f32_16x16x32_bf16 v[172:175], a[64:67], a[92:95], v[172:175]
v_accvgpr_write_b32 a169, v105
v_accvgpr_write_b32 a170, v106
v_mfma_f32_16x16x32_bf16 v[168:171], a[60:63], a[92:95], v[168:171]
v_accvgpr_write_b32 a171, v107
v_cvt_pk_bf16_f32 v112, v112, v113
v_cvt_pk_bf16_f32 v113, v114, v115
v_mfma_f32_16x16x32_bf16 v[168:171], a[40:43], a[88:91], v[168:171]
s_waitcnt lgkmcnt(4)
v_cvt_pk_bf16_f32 v114, v116, v117
v_cvt_pk_bf16_f32 v115, v118, v119
v_mfma_f32_16x16x32_bf16 v[184:187], a[40:43], a[96:99], v[184:187]
ds_read_b64_tr_b16 a[88:89], v13 offset:16896
v_accvgpr_write_b32 a172, v112
v_accvgpr_write_b32 a173, v113
v_mfma_f32_16x16x32_bf16 v[184:187], a[60:63], a[100:103], v[184:187]
ds_read_b64_tr_b16 a[90:91], v13 offset:17920
v_accvgpr_write_b32 a174, v114
v_mfma_f32_16x16x32_bf16 v[188:191], a[64:67], a[100:103], v[188:191]
ds_read_b64_tr_b16 a[92:93], v13 offset:25088
s_add_u32 m0, s16, 0x1800
v_accvgpr_write_b32 a175, v115
v_mfma_f32_16x16x32_bf16 v[188:191], a[44:47], a[96:99], v[188:191]
buffer_load_dwordx4 v22, s[44:47], s23 offen lds
v_mfma_f32_16x16x32_bf16 v[192:195], a[48:51], a[96:99], v[192:195]
ds_read_b64_tr_b16 a[94:95], v13 offset:26112
v_cvt_pk_bf16_f32 v120, v120, v121
v_cvt_pk_bf16_f32 v121, v122, v123
v_mfma_f32_16x16x32_bf16 v[192:195], a[68:71], a[100:103], v[192:195]
v_cvt_pk_bf16_f32 v122, v124, v125
v_cvt_pk_bf16_f32 v123, v126, v127
v_mfma_f32_16x16x32_bf16 v[196:199], a[72:75], a[100:103], v[196:199]
v_accvgpr_write_b32 a176, v120
v_accvgpr_write_b32 a177, v121
v_accvgpr_write_b32 a178, v122
v_mfma_f32_16x16x32_bf16 v[196:199], a[52:55], a[96:99], v[196:199]
v_accvgpr_write_b32 a179, v123
v_cvt_pk_bf16_f32 v128, v128, v129
v_mfma_f32_16x16x32_bf16 v[212:215], a[52:55], a[104:107], v[212:215]
ds_read_b64_tr_b16 a[96:97], v12 offset:17152
v_cvt_pk_bf16_f32 v129, v130, v131
v_cvt_pk_bf16_f32 v130, v132, v133
v_mfma_f32_16x16x32_bf16 v[212:215], a[72:75], a[108:111], v[212:215]
ds_read_b64_tr_b16 a[98:99], v12 offset:18176
s_add_u32 m0, s16, 0x1c00
v_mfma_f32_16x16x32_bf16 v[208:211], a[68:71], a[108:111], v[208:211]
buffer_load_dwordx4 v23, s[44:47], s23 offen lds
v_cvt_pk_bf16_f32 v131, v134, v135
v_mfma_f32_16x16x32_bf16 v[208:211], a[48:51], a[104:107], v[208:211]
ds_read_b64_tr_b16 a[100:101], v12 offset:25344
s_bfe_u32 s39, s40, 0x80018
v_mfma_f32_16x16x32_bf16 v[204:207], a[44:47], a[104:107], v[204:207]
ds_read_b64_tr_b16 a[102:103], v12 offset:26368
s_add_u32 s39, s39, s41
v_accvgpr_write_b32 a180, v128
v_mfma_f32_16x16x32_bf16 v[204:207], a[64:67], a[108:111], v[204:207]
s_and_b32 s39, s39, 15
s_sub_u32 s42, s39, s41
s_mov_b32 s41, s39
v_mfma_f32_16x16x32_bf16 v[200:203], a[60:63], a[108:111], v[200:203]
v_lshl_add_u32 v22, s42, 7, v22
v_lshl_add_u32 v23, s42, 7, v23
v_accvgpr_write_b32 a181, v129
v_mfma_f32_16x16x32_bf16 v[200:203], a[40:43], a[104:107], v[200:203]
s_waitcnt lgkmcnt(4)
v_accvgpr_write_b32 a182, v130
v_accvgpr_write_b32 a183, v131
v_mfma_f32_16x16x32_bf16 v[248:251], a[40:43], a[80:83], v[248:251]
ds_read_b64_tr_b16 a[104:105], v13 offset:17152
s_mov_b32 s9, 0x600000
v_cvt_pk_bf16_f32 v136, v136, v137
v_mfma_f32_16x16x32_bf16 v[248:251], a[60:63], a[84:87], v[248:251]
buffer_load_dword a120, v18, s[52:55], s9 offen
v_mfma_f32_16x16x32_bf16 v[252:255], a[64:67], a[84:87], v[252:255]
ds_read_b64_tr_b16 a[106:107], v13 offset:18176
v_cvt_pk_bf16_f32 v137, v138, v139
v_cvt_pk_bf16_f32 v138, v140, v141
v_mfma_f32_16x16x32_bf16 v[252:255], a[44:47], a[80:83], v[252:255]
ds_read_b64_tr_b16 a[108:109], v13 offset:25344
v_cvt_pk_bf16_f32 v139, v142, v143
v_mfma_f32_16x16x32_bf16 v[216:219], a[48:51], a[80:83], v[216:219]
ds_read_b64_tr_b16 a[110:111], v13 offset:26368
v_add_u32 v12, 0x8000, v12
v_accvgpr_write_b32 a184, v136
v_mfma_f32_16x16x32_bf16 v[216:219], a[68:71], a[84:87], v[216:219]
v_add_u32 v13, 0x8000, v13
v_accvgpr_write_b32 a185, v137
v_mfma_f32_16x16x32_bf16 v[220:223], a[72:75], a[84:87], v[220:223]
v_accvgpr_write_b32 a186, v138
v_accvgpr_write_b32 a187, v139
v_cvt_pk_bf16_f32 v144, v144, v145
v_mfma_f32_16x16x32_bf16 v[220:223], a[52:55], a[80:83], v[220:223]
v_cvt_pk_bf16_f32 v145, v146, v147
v_cvt_pk_bf16_f32 v146, v148, v149
v_mfma_f32_16x16x32_bf16 v[236:239], a[52:55], a[88:91], v[236:239]
s_waitcnt vmcnt(27) lgkmcnt(0)
v_cvt_pk_bf16_f32 v147, v150, v151
v_accvgpr_write_b32 a188, v144
v_accvgpr_write_b32 a189, v145
v_mfma_f32_16x16x32_bf16 v[236:239], a[72:75], a[92:95], v[236:239]
s_barrier
s_add_u32 m0, s17, 0x8000
v_accvgpr_write_b32 a190, v146
v_mfma_f32_16x16x32_bf16 v[232:235], a[68:71], a[92:95], v[232:235]
buffer_load_dwordx4 v5, s[52:55], 0 offen lds
v_accvgpr_write_b32 a191, v147
v_mfma_f32_16x16x32_bf16 v[232:235], a[48:51], a[88:91], v[232:235]
ds_read_b64_tr_b16 a[80:81], v12 offset:0
v_cvt_pk_bf16_f32 v152, v152, v153
v_mfma_f32_16x16x32_bf16 v[228:231], a[44:47], a[88:91], v[228:231]
ds_read_b64_tr_b16 a[82:83], v12 offset:1024
v_cvt_pk_bf16_f32 v153, v154, v155
v_cvt_pk_bf16_f32 v154, v156, v157
v_mfma_f32_16x16x32_bf16 v[228:231], a[64:67], a[92:95], v[228:231]
ds_read_b64_tr_b16 a[84:85], v12 offset:8192
s_waitcnt lgkmcnt(3)
v_mfma_f32_16x16x32_bf16 v[224:227], a[60:63], a[92:95], v[224:227]
ds_read_b64_tr_b16 a[86:87], v12 offset:9216
s_add_u32 m0, s17, 0x8400
v_cvt_pk_bf16_f32 v155, v158, v159
v_mfma_f32_16x16x32_bf16 v[224:227], a[40:43], a[88:91], v[224:227]
buffer_load_dwordx4 v5, s[52:55], s13 offen lds
v_mfma_f32_16x16x32_bf16 v[240:243], a[40:43], a[96:99], v[240:243]
ds_read_b64_tr_b16 a[88:89], v13 offset:0
v_accvgpr_write_b32 a192, v152
v_accvgpr_write_b32 a193, v153
v_mfma_f32_16x16x32_bf16 v[240:243], a[60:63], a[100:103], v[240:243]
ds_read_b64_tr_b16 a[90:91], v13 offset:1024
v_accvgpr_write_b32 a194, v154
v_mfma_f32_16x16x32_bf16 v[244:247], a[64:67], a[100:103], v[244:247]
ds_read_b64_tr_b16 a[92:93], v13 offset:8192
v_accvgpr_write_b32 a195, v155
v_cvt_pk_bf16_f32 v160, v160, v161
v_mfma_f32_16x16x32_bf16 v[244:247], a[44:47], a[96:99], v[244:247]
ds_read_b64_tr_b16 a[94:95], v13 offset:9216
v_cvt_pk_bf16_f32 v161, v162, v163
v_mfma_f32_16x16x32_bf16 a[232:235], a[48:51], a[96:99], a[232:235]
s_add_u32 m0, s17, 0x8800
v_cvt_pk_bf16_f32 v162, v164, v165
v_cvt_pk_bf16_f32 v163, v166, v167
v_accvgpr_write_b32 a196, v160
v_mfma_f32_16x16x32_bf16 a[232:235], a[68:71], a[100:103], a[232:235]
buffer_load_dwordx4 v6, s[52:55], 0 offen lds
v_mfma_f32_16x16x32_bf16 a[236:239], a[72:75], a[100:103], a[236:239]
v_accvgpr_write_b32 a197, v161
v_accvgpr_write_b32 a198, v162
v_accvgpr_write_b32 a199, v163
v_mfma_f32_16x16x32_bf16 a[236:239], a[52:55], a[96:99], a[236:239]
v_cvt_pk_bf16_f32 v168, v168, v169
v_cvt_pk_bf16_f32 v169, v170, v171
v_mfma_f32_16x16x32_bf16 a[252:255], a[52:55], a[104:107], a[252:255]
ds_read_b64_tr_b16 a[96:97], v12 offset:256
v_cvt_pk_bf16_f32 v170, v172, v173
v_cvt_pk_bf16_f32 v171, v174, v175
v_mfma_f32_16x16x32_bf16 a[252:255], a[72:75], a[108:111], a[252:255]
ds_read_b64_tr_b16 a[98:99], v12 offset:1280
v_accvgpr_write_b32 a200, v168
v_mfma_f32_16x16x32_bf16 a[248:251], a[68:71], a[108:111], a[248:251]
ds_read_b64_tr_b16 a[100:101], v12 offset:8448
s_add_u32 m0, s17, 0x8c00
v_accvgpr_write_b32 a201, v169
v_mfma_f32_16x16x32_bf16 a[248:251], a[48:51], a[104:107], a[248:251]
buffer_load_dwordx4 v6, s[52:55], s13 offen lds
v_mfma_f32_16x16x32_bf16 a[244:247], a[44:47], a[104:107], a[244:247]
ds_read_b64_tr_b16 a[102:103], v12 offset:9472
v_accvgpr_write_b32 a202, v170
v_accvgpr_write_b32 a203, v171
v_mfma_f32_16x16x32_bf16 a[244:247], a[64:67], a[108:111], a[244:247]
v_cvt_pk_bf16_f32 v176, v176, v177
v_cvt_pk_bf16_f32 v177, v178, v179
v_mfma_f32_16x16x32_bf16 a[240:243], a[60:63], a[108:111], a[240:243]
v_cvt_pk_bf16_f32 v178, v180, v181
v_cvt_pk_bf16_f32 v179, v182, v183
v_accvgpr_write_b32 a204, v176
v_mfma_f32_16x16x32_bf16 a[240:243], a[40:43], a[104:107], a[240:243]
s_add_u32 m0, s18, 0xc000
s_waitcnt lgkmcnt(4)
v_accvgpr_write_b32 a205, v177
L_S8:
v_mfma_f32_16x16x32_bf16 v[24:27], a[80:83], a[0:3], 0
ds_read_b64_tr_b16 a[104:105], v13 offset:256
s_waitcnt vmcnt(23)
v_accvgpr_write_b32 a206, v178
v_mfma_f32_16x16x32_bf16 v[24:27], a[84:87], a[20:23], v[24:27]
buffer_load_dwordx4 v7, s[68:71], 0 offen lds
v_mfma_f32_16x16x32_bf16 v[32:35], a[84:87], a[24:27], 0
ds_read_b64_tr_b16 a[106:107], v13 offset:1280
v_accvgpr_write_b32 a207, v179
v_cvt_pk_bf16_f32 v184, v184, v185
v_mfma_f32_16x16x32_bf16 v[32:35], a[80:83], a[4:7], v[32:35]
ds_read_b64_tr_b16 a[108:109], v13 offset:8448
v_cvt_pk_bf16_f32 v185, v186, v187
v_mfma_f32_16x16x32_bf16 v[40:43], a[80:83], a[8:11], 0
ds_read_b64_tr_b16 a[110:111], v13 offset:9472
v_cvt_pk_bf16_f32 v186, v188, v189
v_cvt_pk_bf16_f32 v187, v190, v191
v_mfma_f32_16x16x32_bf16 v[40:43], a[84:87], a[28:31], v[40:43]
ds_read_b128 a[40:43], v8 offset:32768
v_accvgpr_write_b32 a208, v184
v_mfma_f32_16x16x32_bf16 v[48:51], a[84:87], a[32:35], 0
ds_read_b128 a[60:63], v9 offset:32768
s_add_u32 s8, s28, 0x2000
v_accvgpr_write_b32 a209, v185
v_mfma_f32_16x16x32_bf16 v[48:51], a[80:83], a[12:15], v[48:51]
buffer_store_dwordx4 a[128:131], v16, s[88:91], s8 offen sc1
v_mfma_f32_16x16x32_bf16 v[52:55], a[88:91], a[12:15], 0
ds_read_b64_tr_b16 a[80:81], v12 offset:512
v_accvgpr_write_b32 a210, v186
v_accvgpr_write_b32 a211, v187
v_mfma_f32_16x16x32_bf16 v[52:55], a[92:95], a[32:35], v[52:55]
ds_read_b64_tr_b16 a[82:83], v12 offset:1536
v_cvt_pk_bf16_f32 v192, v192, v193
v_mfma_f32_16x16x32_bf16 v[44:47], a[92:95], a[28:31], 0
ds_read_b64_tr_b16 a[84:85], v12 offset:8704
v_cvt_pk_bf16_f32 v193, v194, v195
v_cvt_pk_bf16_f32 v194, v196, v197
v_mfma_f32_16x16x32_bf16 v[44:47], a[88:91], a[8:11], v[44:47]
ds_read_b64_tr_b16 a[86:87], v12 offset:9728
v_cvt_pk_bf16_f32 v195, v198, v199
v_mfma_f32_16x16x32_bf16 v[36:39], a[88:91], a[4:7], 0
ds_read_b128 a[44:47], v8 offset:34816
s_add_u32 m0, s18, 0xd000
v_accvgpr_write_b32 a212, v192
v_mfma_f32_16x16x32_bf16 v[36:39], a[92:95], a[24:27], v[36:39]
buffer_load_dwordx4 v7, s[68:71], s25 offen lds
v_mfma_f32_16x16x32_bf16 v[28:31], a[92:95], a[20:23], 0
ds_read_b128 a[64:67], v9 offset:34816
v_accvgpr_write_b32 a213, v193
v_accvgpr_write_b32 a214, v194
v_mfma_f32_16x16x32_bf16 v[28:31], a[88:91], a[0:3], v[28:31]
ds_read_b128 a[48:51], v8 offset:36864
s_waitcnt lgkmcnt(9)
v_mfma_f32_16x16x32_bf16 v[56:59], a[96:99], a[0:3], 0
ds_read_b64_tr_b16 a[88:89], v13 offset:512
v_accvgpr_write_b32 a215, v195
v_cvt_pk_bf16_f32 v200, v200, v201
v_mfma_f32_16x16x32_bf16 v[56:59], a[100:103], a[20:23], v[56:59]
ds_read_b64_tr_b16 a[90:91], v13 offset:1536
v_cvt_pk_bf16_f32 v201, v202, v203
v_mfma_f32_16x16x32_bf16 v[64:67], a[100:103], a[24:27], 0
ds_read_b64_tr_b16 a[92:93], v13 offset:8704
s_add_u32 m0, s18, 0xe000
v_cvt_pk_bf16_f32 v202, v204, v205
v_mfma_f32_16x16x32_bf16 v[64:67], a[96:99], a[4:7], v[64:67]
buffer_load_dwordx4 v7, s[68:71], s26 offen lds
v_mfma_f32_16x16x32_bf16 v[72:75], a[96:99], a[8:11], 0
ds_read_b64_tr_b16 a[94:95], v13 offset:9728
v_cvt_pk_bf16_f32 v203, v206, v207
v_accvgpr_write_b32 a216, v200
v_mfma_f32_16x16x32_bf16 v[72:75], a[100:103], a[28:31], v[72:75]
ds_read_b128 a[68:71], v9 offset:36864
v_accvgpr_write_b32 a217, v201
v_mfma_f32_16x16x32_bf16 v[80:83], a[100:103], a[32:35], 0
ds_read_b128 a[52:55], v8 offset:38912
v_accvgpr_write_b32 a218, v202
v_accvgpr_write_b32 a219, v203
v_mfma_f32_16x16x32_bf16 v[80:83], a[96:99], a[12:15], v[80:83]
ds_read_b128 a[72:75], v9 offset:38912
v_cvt_pk_bf16_f32 v208, v208, v209
v_mfma_f32_16x16x32_bf16 v[84:87], a[104:107], a[12:15], 0
ds_read_b64_tr_b16 a[96:97], v12 offset:768
s_add_u32 m0, s18, 0xf000
v_cvt_pk_bf16_f32 v209, v210, v211
v_mfma_f32_16x16x32_bf16 v[84:87], a[108:111], a[32:35], v[84:87]
buffer_load_dwordx4 v4, s[44:47], s24 offen lds
v_mfma_f32_16x16x32_bf16 v[76:79], a[108:111], a[28:31], 0
ds_read_b64_tr_b16 a[98:99], v12 offset:1792
v_lshl_add_u32 v5, s42, 19, v5
v_cvt_pk_bf16_f32 v210, v212, v213
v_mfma_f32_16x16x32_bf16 v[76:79], a[104:107], a[8:11], v[76:79]
ds_read_b64_tr_b16 a[100:101], v12 offset:8960
v_lshl_add_u32 v6, s42, 19, v6
v_mfma_f32_16x16x32_bf16 v[68:71], a[104:107], a[4:7], 0
ds_read_b64_tr_b16 a[102:103], v12 offset:9984
s_waitcnt lgkmcnt(7)
v_cvt_pk_bf16_f32 v211, v214, v215
v_mfma_f32_16x16x32_bf16 v[68:71], a[108:111], a[24:27], v[68:71]
ds_read_b128 a[16:19], v10
s_waitcnt lgkmcnt(5)
v_mfma_f32_16x16x32_bf16 v[60:63], a[108:111], a[20:23], 0
ds_read_b128 a[36:39], v11
s_add_u32 m0, s16, 0x8000
v_accvgpr_write_b32 a220, v208
v_mfma_f32_16x16x32_bf16 v[60:63], a[104:107], a[0:3], v[60:63]
buffer_load_dwordx4 v22, s[44:47], s20 offen lds
v_mfma_f32_16x16x32_bf16 v[88:91], a[80:83], a[0:3], 0
ds_read_b64_tr_b16 a[104:105], v13 offset:768
v_lshl_add_u32 v7, s42, 18, v7
v_accvgpr_write_b32 a221, v209
v_mfma_f32_16x16x32_bf16 v[88:91], a[84:87], a[20:23], v[88:91]
ds_read_b64_tr_b16 a[106:107], v13 offset:1792
v_lshl_add_u32 v7, s42, 17, v7
v_mfma_f32_16x16x32_bf16 v[96:99], a[84:87], a[24:27], 0
ds_read_b64_tr_b16 a[108:109], v13 offset:8960
v_lshl_add_u32 v4, s42, 7, v4
v_accvgpr_write_b32 a222, v210
v_mfma_f32_16x16x32_bf16 v[96:99], a[80:83], a[4:7], v[96:99]
ds_read_b64_tr_b16 a[110:111], v13 offset:9984
s_add_u32 m0, s16, 0x8400
v_mfma_f32_16x16x32_bf16 v[104:107], a[80:83], a[8:11], 0
buffer_load_dwordx4 v23, s[44:47], s20 offen lds
v_accvgpr_write_b32 a223, v211
v_mfma_f32_16x16x32_bf16 v[104:107], a[84:87], a[28:31], v[104:107]
v_cvt_pk_bf16_f32 v248, v248, v249
v_cvt_pk_bf16_f32 v249, v250, v251
v_mfma_f32_16x16x32_bf16 v[112:115], a[84:87], a[32:35], 0
v_cvt_pk_bf16_f32 v250, v252, v253
v_cvt_pk_bf16_f32 v251, v254, v255
v_accvgpr_write_b32 a224, v248
v_mfma_f32_16x16x32_bf16 v[112:115], a[80:83], a[12:15], v[112:115]
v_accvgpr_write_b32 a225, v249
v_accvgpr_write_b32 a226, v250
v_mfma_f32_16x16x32_bf16 v[116:119], a[88:91], a[12:15], 0
ds_read_b64_tr_b16 a[80:81], v14 offset:0
v_accvgpr_write_b32 a227, v251
v_cvt_pk_bf16_f32 v216, v216, v217
v_mfma_f32_16x16x32_bf16 v[116:119], a[92:95], a[32:35], v[116:119]
ds_read_b64_tr_b16 a[82:83], v14 offset:256
s_add_u32 s8, s28, 0x3000
v_mfma_f32_16x16x32_bf16 v[108:111], a[92:95], a[28:31], 0
buffer_store_dwordx4 a[132:135], v16, s[88:91], s8 offen sc1
v_cvt_pk_bf16_f32 v217, v218, v219
v_mfma_f32_16x16x32_bf16 v[108:111], a[88:91], a[8:11], v[108:111]
ds_read_b64_tr_b16 a[84:85], v14 offset:2048
v_cvt_pk_bf16_f32 v218, v220, v221
v_mfma_f32_16x16x32_bf16 v[100:103], a[88:91], a[4:7], 0
ds_read_b64_tr_b16 a[86:87], v14 offset:2304
v_cvt_pk_bf16_f32 v219, v222, v223
v_accvgpr_write_b32 a228, v216
v_mfma_f32_16x16x32_bf16 v[100:103], a[92:95], a[24:27], v[100:103]
v_accvgpr_write_b32 a229, v217
v_accvgpr_write_b32 a230, v218
v_mfma_f32_16x16x32_bf16 v[92:95], a[92:95], a[20:23], 0
v_accvgpr_write_b32 a231, v219
v_cvt_pk_bf16_f32 v224, v224, v225
v_cvt_pk_bf16_f32 v225, v226, v227
v_mfma_f32_16x16x32_bf16 v[92:95], a[88:91], a[0:3], v[92:95]
s_add_u32 m0, s16, 0x8800
s_waitcnt lgkmcnt(4)
v_cvt_pk_bf16_f32 v226, v228, v229
v_mfma_f32_16x16x32_bf16 v[120:123], a[96:99], a[0:3], 0
buffer_load_dwordx4 v22, s[44:47], s21 offen lds
v_cvt_pk_bf16_f32 v227, v230, v231
v_mfma_f32_16x16x32_bf16 v[120:123], a[100:103], a[20:23], v[120:123]
ds_read_b64_tr_b16 a[88:89], v15 offset:0
v_accvgpr_write_b32 a112, v224
v_mfma_f32_16x16x32_bf16 v[128:131], a[100:103], a[24:27], 0
ds_read_b64_tr_b16 a[90:91], v15 offset:256
v_accvgpr_write_b32 a113, v225
v_accvgpr_write_b32 a114, v226
v_mfma_f32_16x16x32_bf16 v[128:131], a[96:99], a[4:7], v[128:131]
ds_read_b64_tr_b16 a[92:93], v15 offset:2048
v_accvgpr_write_b32 a115, v227
v_mfma_f32_16x16x32_bf16 v[136:139], a[96:99], a[8:11], 0
ds_read_b64_tr_b16 a[94:95], v15 offset:2304
v_cvt_pk_bf16_f32 v232, v232, v233
v_cvt_pk_bf16_f32 v233, v234, v235
v_mfma_f32_16x16x32_bf16 v[136:139], a[100:103], a[28:31], v[136:139]
s_add_u32 m0, s16, 0x8c00
v_cvt_pk_bf16_f32 v234, v236, v237
v_cvt_pk_bf16_f32 v235, v238, v239
v_mfma_f32_16x16x32_bf16 v[144:147], a[100:103], a[32:35], 0
buffer_load_dwordx4 v23, s[44:47], s21 offen lds
v_accvgpr_write_b32 a116, v232
v_mfma_f32_16x16x32_bf16 v[144:147], a[96:99], a[12:15], v[144:147]
v_accvgpr_write_b32 a117, v233
v_accvgpr_write_b32 a118, v234
v_mfma_f32_16x16x32_bf16 v[148:151], a[104:107], a[12:15], 0
ds_read_b64_tr_b16 a[96:97], v14 offset:4096
v_accvgpr_write_b32 a119, v235
v_cvt_pk_bf16_f32 v240, v240, v241
v_mfma_f32_16x16x32_bf16 v[148:151], a[108:111], a[32:35], v[148:151]
ds_read_b64_tr_b16 a[98:99], v14 offset:4352
v_cvt_pk_bf16_f32 v241, v242, v243
v_mfma_f32_16x16x32_bf16 v[140:143], a[108:111], a[28:31], 0
ds_read_b64_tr_b16 a[100:101], v14 offset:6144
v_cvt_pk_bf16_f32 v242, v244, v245
v_cvt_pk_bf16_f32 v243, v246, v247
v_mfma_f32_16x16x32_bf16 v[140:143], a[104:107], a[8:11], v[140:143]
ds_read_b64_tr_b16 a[102:103], v14 offset:6400
s_add_u32 m0, s16, 0x9000
v_mfma_f32_16x16x32_bf16 v[132:135], a[104:107], a[4:7], 0
buffer_load_dwordx4 v22, s[44:47], s22 offen lds
v_accvgpr_write_b32 a124, v240
v_mfma_f32_16x16x32_bf16 v[132:135], a[108:111], a[24:27], v[132:135]
v_accvgpr_write_b32 a125, v241
v_accvgpr_write_b32 a126, v242
v_mfma_f32_16x16x32_bf16 v[124:127], a[108:111], a[20:23], 0
v_accvgpr_write_b32 a127, v243
v_accvgpr_read_b32 v2, a232
v_accvgpr_read_b32 v3, a233
v_mfma_f32_16x16x32_bf16 v[124:127], a[104:107], a[0:3], v[124:127]
s_waitcnt lgkmcnt(4)
v_cvt_pk_bf16_f32 v2, v2, v3
v_accvgpr_write_b32 a232, v2
v_mfma_f32_16x16x32_bf16 v[152:155], a[80:83], a[0:3], 0
ds_read_b64_tr_b16 a[104:105], v15 offset:4096
v_accvgpr_read_b32 v2, a234
v_accvgpr_read_b32 v3, a235
v_mfma_f32_16x16x32_bf16 v[152:155], a[84:87], a[20:23], v[152:155]
ds_read_b64_tr_b16 a[106:107], v15 offset:4352
s_add_u32 m0, s16, 0x9400
v_mfma_f32_16x16x32_bf16 v[160:163], a[84:87], a[24:27], 0
buffer_load_dwordx4 v23, s[44:47], s22 offen lds
v_cvt_pk_bf16_f32 v2, v2, v3
v_mfma_f32_16x16x32_bf16 v[160:163], a[80:83], a[4:7], v[160:163]
ds_read_b64_tr_b16 a[108:109], v15 offset:6144
v_accvgpr_write_b32 a233, v2
v_mfma_f32_16x16x32_bf16 v[168:171], a[80:83], a[8:11], 0
ds_read_b64_tr_b16 a[110:111], v15 offset:6400
v_accvgpr_read_b32 v2, a236
v_accvgpr_read_b32 v3, a237
v_mfma_f32_16x16x32_bf16 v[168:171], a[84:87], a[28:31], v[168:171]
v_cvt_pk_bf16_f32 v2, v2, v3
v_accvgpr_write_b32 a234, v2
v_mfma_f32_16x16x32_bf16 v[176:179], a[84:87], a[32:35], 0
v_accvgpr_read_b32 v2, a238
v_accvgpr_read_b32 v3, a239
v_cvt_pk_bf16_f32 v2, v2, v3
v_mfma_f32_16x16x32_bf16 v[176:179], a[80:83], a[12:15], v[176:179]
s_add_u32 m0, s16, 0x9800
v_accvgpr_write_b32 a235, v2
v_accvgpr_read_b32 v2, a240
v_mfma_f32_16x16x32_bf16 v[180:183], a[88:91], a[12:15], 0
buffer_load_dwordx4 v22, s[44:47], s23 offen lds
v_accvgpr_read_b32 v3, a241
v_mfma_f32_16x16x32_bf16 v[180:183], a[92:95], a[32:35], v[180:183]
ds_read_b64_tr_b16 a[80:81], v14 offset:8192
v_cvt_pk_bf16_f32 v2, v2, v3
v_mfma_f32_16x16x32_bf16 v[172:175], a[92:95], a[28:31], 0
ds_read_b64_tr_b16 a[82:83], v14 offset:8448
v_accvgpr_write_b32 a240, v2
v_accvgpr_read_b32 v2, a242
v_mfma_f32_16x16x32_bf16 v[172:175], a[88:91], a[8:11], v[172:175]
ds_read_b64_tr_b16 a[84:85], v14 offset:10240
v_accvgpr_read_b32 v3, a243
v_mfma_f32_16x16x32_bf16 v[164:167], a[88:91], a[4:7], 0
ds_read_b64_tr_b16 a[86:87], v14 offset:10496
v_cvt_pk_bf16_f32 v2, v2, v3
v_accvgpr_write_b32 a241, v2
v_mfma_f32_16x16x32_bf16 v[164:167], a[92:95], a[24:27], v[164:167]
s_add_u32 m0, s16, 0x9c00
v_accvgpr_read_b32 v2, a244
v_accvgpr_read_b32 v3, a245
v_mfma_f32_16x16x32_bf16 v[156:159], a[92:95], a[20:23], 0
buffer_load_dwordx4 v23, s[44:47], s23 offen lds
v_cvt_pk_bf16_f32 v2, v2, v3
v_mfma_f32_16x16x32_bf16 v[156:159], a[88:91], a[0:3], v[156:159]
s_waitcnt lgkmcnt(4)
s_bfe_u32 s39, s40, 0x80000
s_add_u32 s39, s39, s41
v_mfma_f32_16x16x32_bf16 v[184:187], a[96:99], a[0:3], 0
ds_read_b64_tr_b16 a[88:89], v15 offset:8192
s_and_b32 s39, s39, 15
v_accvgpr_write_b32 a242, v2
v_mfma_f32_16x16x32_bf16 v[184:187], a[100:103], a[20:23], v[184:187]
ds_read_b64_tr_b16 a[90:91], v15 offset:8448
s_sub_u32 s42, s39, s41
v_mfma_f32_16x16x32_bf16 v[192:195], a[100:103], a[24:27], 0
ds_read_b64_tr_b16 a[92:93], v15 offset:10240
s_mov_b32 s41, s39
v_accvgpr_read_b32 v2, a246
v_mfma_f32_16x16x32_bf16 v[192:195], a[96:99], a[4:7], v[192:195]
ds_read_b64_tr_b16 a[94:95], v15 offset:10496
s_add_u32 s8, s28, 0x6000
v_mfma_f32_16x16x32_bf16 v[200:203], a[96:99], a[8:11], 0
buffer_store_dwordx4 a[136:139], v16, s[88:91], s8 offen sc1
v_accvgpr_read_b32 v3, a247
v_mfma_f32_16x16x32_bf16 v[200:203], a[100:103], a[28:31], v[200:203]
v_add_u32 v12, 0xffff0000, v12
v_add_u32 v13, 0xffff0000, v13
v_mfma_f32_16x16x32_bf16 v[208:211], a[100:103], a[32:35], 0
v_add_u32 v14, 0xffff0000, v14
v_add_u32 v15, 0xffff0000, v15
v_cvt_pk_bf16_f32 v2, v2, v3
v_mfma_f32_16x16x32_bf16 v[208:211], a[96:99], a[12:15], v[208:211]
v_add_u32 v10, 0xffff0000, v10
v_add_u32 v11, 0xffff0000, v11
v_mfma_f32_16x16x32_bf16 v[248:251], a[96:99], a[16:19], 0
v_lshl_add_u32 v22, s42, 7, v22
v_lshl_add_u32 v23, s42, 7, v23
v_accvgpr_write_b32 a243, v2
v_mfma_f32_16x16x32_bf16 v[248:251], a[100:103], a[36:39], v[248:251]
v_accvgpr_read_b32 v2, a248
v_accvgpr_read_b32 v3, a249
v_mfma_f32_16x16x32_bf16 v[212:215], a[104:107], a[12:15], 0
s_waitcnt vmcnt(29) lgkmcnt(0)
v_cvt_pk_bf16_f32 v2, v2, v3
v_accvgpr_write_b32 a248, v2
v_accvgpr_read_b32 v2, a250
v_mfma_f32_16x16x32_bf16 v[212:215], a[108:111], a[32:35], v[212:215]
s_barrier
s_add_u32 m0, s17, 0x10000
v_accvgpr_read_b32 v3, a251
v_mfma_f32_16x16x32_bf16 v[204:207], a[108:111], a[28:31], 0
buffer_load_dwordx4 v5, s[52:55], 0 offen lds
v_cvt_pk_bf16_f32 v2, v2, v3
v_mfma_f32_16x16x32_bf16 v[204:207], a[104:107], a[8:11], v[204:207]
ds_read_b64_tr_b16 a[96:97], v12 offset:0
v_accvgpr_write_b32 a249, v2
v_mfma_f32_16x16x32_bf16 v[196:199], a[104:107], a[4:7], 0
ds_read_b64_tr_b16 a[98:99], v12 offset:1024
v_accvgpr_read_b32 v2, a252
v_accvgpr_read_b32 v3, a253
v_mfma_f32_16x16x32_bf16 v[196:199], a[108:111], a[24:27], v[196:199]
ds_read_b64_tr_b16 a[100:101], v12 offset:8192
v_cvt_pk_bf16_f32 v2, v2, v3
v_mfma_f32_16x16x32_bf16 v[188:191], a[108:111], a[20:23], 0
ds_read_b64_tr_b16 a[102:103], v12 offset:9216
v_accvgpr_write_b32 a250, v2
v_accvgpr_read_b32 v2, a254
v_mfma_f32_16x16x32_bf16 v[188:191], a[104:107], a[0:3], v[188:191]
L_padA5:
s_cmp_eq_u32 s95, 1
s_cbranch_scc1 L_padA9
s_add_u32 m0, s17, 0x10400
s_waitcnt lgkmcnt(4)
v_accvgpr_read_b32 v3, a255
v_mfma_f32_16x16x32_bf16 v[216:219], a[0:3], a[80:83], 0
buffer_load_dwordx4 v5, s[52:55], s13 offen lds
v_cvt_pk_bf16_f32 v2, v2, v3
v_mfma_f32_16x16x32_bf16 v[216:219], a[20:23], a[84:87], v[216:219]
ds_read_b64_tr_b16 a[104:105], v13 offset:0
v_accvgpr_write_b32 a251, v2
v_mfma_f32_16x16x32_bf16 v[224:227], a[24:27], a[84:87], 0
ds_read_b64_tr_b16 a[106:107], v13 offset:1024
v_mfma_f32_16x16x32_bf16 v[224:227], a[4:7], a[80:83], v[224:227]
ds_read_b64_tr_b16 a[108:109], v13 offset:8192
v_mfma_f32_16x16x32_bf16 v[232:235], a[8:11], a[80:83], 0
ds_read_b64_tr_b16 a[110:111], v13 offset:9216
v_mfma_f32_16x16x32_bf16 v[232:235], a[28:31], a[84:87], v[232:235]
s_add_u32 m0, s17, 0x10800
v_mfma_f32_16x16x32_bf16 v[240:243], a[32:35], a[84:87], 0
buffer_load_dwordx4 v6, s[52:55], 0 offen lds
v_mfma_f32_16x16x32_bf16 v[240:243], a[12:15], a[80:83], v[240:243]
v_mfma_f32_16x16x32_bf16 v[252:255], a[16:19], a[80:83], 0
v_mfma_f32_16x16x32_bf16 v[252:255], a[36:39], a[84:87], v[252:255]
v_mfma_f32_16x16x32_bf16 v[244:247], a[12:15], a[88:91], 0
ds_read_b64_tr_b16 a[80:81], v12 offset:256
v_mfma_f32_16x16x32_bf16 v[244:247], a[32:35], a[92:95], v[244:247]
ds_read_b64_tr_b16 a[82:83], v12 offset:1280
s_add_u32 m0, s17, 0x10c00
v_mfma_f32_16x16x32_bf16 v[236:239], a[28:31], a[92:95], 0
buffer_load_dwordx4 v6, s[52:55], s13 offen lds
v_mfma_f32_16x16x32_bf16 v[236:239], a[8:11], a[88:91], v[236:239]
ds_read_b64_tr_b16 a[84:85], v12 offset:8448
v_mfma_f32_16x16x32_bf16 v[228:231], a[4:7], a[88:91], 0
ds_read_b64_tr_b16 a[86:87], v12 offset:9472
v_mfma_f32_16x16x32_bf16 v[228:231], a[24:27], a[92:95], v[228:231]
v_mfma_f32_16x16x32_bf16 v[220:223], a[20:23], a[92:95], 0
v_mfma_f32_16x16x32_bf16 v[220:223], a[0:3], a[88:91], v[220:223]
s_add_u32 m0, s18, 0x14000
s_waitcnt lgkmcnt(4)
L_S9:
v_mfma_f32_16x16x32_bf16 v[24:27], a[96:99], a[40:43], v[24:27]
buffer_load_dwordx4 v7, s[68:71], 0 offen lds
v_mfma_f32_16x16x32_bf16 v[24:27], a[100:103], a[60:63], v[24:27]
ds_read_b64_tr_b16 a[88:89], v13 offset:256
s_waitcnt vmcnt(25)
v_mfma_f32_16x16x32_bf16 v[32:35], a[100:103], a[64:67], v[32:35]
ds_read_b64_tr_b16 a[90:91], v13 offset:1280
v_mfma_f32_16x16x32_bf16 v[32:35], a[96:99], a[44:47], v[32:35]
ds_read_b64_tr_b16 a[92:93], v13 offset:8448
v_mfma_f32_16x16x32_bf16 v[40:43], a[96:99], a[48:51], v[40:43]
ds_read_b64_tr_b16 a[94:95], v13 offset:9472
v_mfma_f32_16x16x32_bf16 v[40:43], a[100:103], a[68:71], v[40:43]
ds_read_b128 a[0:3], v8 offset:0
s_add_u32 s8, s28, 0x7000
v_mfma_f32_16x16x32_bf16 v[48:51], a[100:103], a[72:75], v[48:51]
buffer_store_dwordx4 a[140:143], v16, s[88:91], s8 offen sc1
v_mfma_f32_16x16x32_bf16 v[48:51], a[96:99], a[52:55], v[48:51]
ds_read_b128 a[20:23], v9 offset:0
v_mfma_f32_16x16x32_bf16 v[52:55], a[104:107], a[52:55], v[52:55]
ds_read_b64_tr_b16 a[96:97], v12 offset:512
v_mfma_f32_16x16x32_bf16 v[52:55], a[108:111], a[72:75], v[52:55]
ds_read_b64_tr_b16 a[98:99], v12 offset:1536
v_mfma_f32_16x16x32_bf16 v[44:47], a[108:111], a[68:71], v[44:47]
ds_read_b64_tr_b16 a[100:101], v12 offset:8704
v_mfma_f32_16x16x32_bf16 v[44:47], a[104:107], a[48:51], v[44:47]
ds_read_b64_tr_b16 a[102:103], v12 offset:9728
s_add_u32 m0, s18, 0x15000
v_mfma_f32_16x16x32_bf16 v[36:39], a[104:107], a[44:47], v[36:39]
buffer_load_dwordx4 v7, s[68:71], s25 offen lds
v_mfma_f32_16x16x32_bf16 v[36:39], a[108:111], a[64:67], v[36:39]
ds_read_b128 a[4:7], v8 offset:2048
v_mfma_f32_16x16x32_bf16 v[28:31], a[108:111], a[60:63], v[28:31]
ds_read_b128 a[24:27], v9 offset:2048
v_mfma_f32_16x16x32_bf16 v[28:31], a[104:107], a[40:43], v[28:31]
ds_read_b128 a[8:11], v8 offset:4096
s_waitcnt lgkmcnt(9)
v_mfma_f32_16x16x32_bf16 v[56:59], a[80:83], a[40:43], v[56:59]
ds_read_b64_tr_b16 a[104:105], v13 offset:512
v_mfma_f32_16x16x32_bf16 v[56:59], a[84:87], a[60:63], v[56:59]
ds_read_b64_tr_b16 a[106:107], v13 offset:1536
s_add_u32 m0, s18, 0x16000
v_mfma_f32_16x16x32_bf16 v[64:67], a[84:87], a[64:67], v[64:67]
buffer_load_dwordx4 v7, s[68:71], s26 offen lds
v_mfma_f32_16x16x32_bf16 v[64:67], a[80:83], a[44:47], v[64:67]
ds_read_b64_tr_b16 a[108:109], v13 offset:8704
v_mfma_f32_16x16x32_bf16 v[72:75], a[80:83], a[48:51], v[72:75]
ds_read_b64_tr_b16 a[110:111], v13 offset:9728
v_mfma_f32_16x16x32_bf16 v[72:75], a[84:87], a[68:71], v[72:75]
ds_read_b128 a[28:31], v9 offset:4096
v_mfma_f32_16x16x32_bf16 v[80:83], a[84:87], a[72:75], v[80:83]
ds_read_b128 a[12:15], v8 offset:6144
v_mfma_f32_16x16x32_bf16 v[80:83], a[80:83], a[52:55], v[80:83]
ds_read_b128 a[32:35], v9 offset:6144
s_add_u32 m0, s18, 0x17000
v_mfma_f32_16x16x32_bf16 v[84:87], a[88:91], a[52:55], v[84:87]
buffer_load_dwordx4 v4, s[44:47], s24 offen lds
v_mfma_f32_16x16x32_bf16 v[84:87], a[92:95], a[72:75], v[84:87]
ds_read_b64_tr_b16 a[80:81], v12 offset:768
v_lshl_add_u32 v5, s42, 19, v5
v_mfma_f32_16x16x32_bf16 v[76:79], a[92:95], a[68:71], v[76:79]
ds_read_b64_tr_b16 a[82:83], v12 offset:1792
v_lshl_add_u32 v6, s42, 19, v6
v_mfma_f32_16x16x32_bf16 v[76:79], a[88:91], a[48:51], v[76:79]
ds_read_b64_tr_b16 a[84:85], v12 offset:8960
v_lshl_add_u32 v7, s42, 18, v7
v_mfma_f32_16x16x32_bf16 v[68:71], a[88:91], a[44:47], v[68:71]
ds_read_b64_tr_b16 a[86:87], v12 offset:9984
s_waitcnt lgkmcnt(4)
v_mfma_f32_16x16x32_bf16 v[68:71], a[92:95], a[64:67], v[68:71]
ds_read_b128 a[56:59], v10
s_add_u32 m0, s16, 0x0
v_mfma_f32_16x16x32_bf16 v[60:63], a[92:95], a[60:63], v[60:63]
buffer_load_dwordx4 v22, s[44:47], s20 offen lds
v_mfma_f32_16x16x32_bf16 v[60:63], a[88:91], a[40:43], v[60:63]
ds_read_b128 a[76:79], v11
s_waitcnt lgkmcnt(9)
v_mfma_f32_16x16x32_bf16 v[88:91], a[96:99], a[40:43], v[88:91]
ds_read_b64_tr_b16 a[88:89], v13 offset:768
v_lshl_add_u32 v7, s42, 17, v7
v_mfma_f32_16x16x32_bf16 v[88:91], a[100:103], a[60:63], v[88:91]
ds_read_b64_tr_b16 a[90:91], v13 offset:1792
v_lshl_add_u32 v4, s42, 7, v4
v_mfma_f32_16x16x32_bf16 v[96:99], a[100:103], a[64:67], v[96:99]
ds_read_b64_tr_b16 a[92:93], v13 offset:8960
v_mfma_f32_16x16x32_bf16 v[96:99], a[96:99], a[44:47], v[96:99]
ds_read_b64_tr_b16 a[94:95], v13 offset:9984
s_add_u32 m0, s16, 0x400
v_mfma_f32_16x16x32_bf16 v[104:107], a[96:99], a[48:51], v[104:107]
buffer_load_dwordx4 v23, s[44:47], s20 offen lds
v_mfma_f32_16x16x32_bf16 v[104:107], a[100:103], a[68:71], v[104:107]
v_mfma_f32_16x16x32_bf16 v[112:115], a[100:103], a[72:75], v[112:115]
v_mfma_f32_16x16x32_bf16 v[112:115], a[96:99], a[52:55], v[112:115]
v_mfma_f32_16x16x32_bf16 v[116:119], a[104:107], a[52:55], v[116:119]
ds_read_b64_tr_b16 a[96:97], v14 offset:0
v_mfma_f32_16x16x32_bf16 v[116:119], a[108:111], a[72:75], v[116:119]
ds_read_b64_tr_b16 a[98:99], v14 offset:256
s_add_u32 s8, s28, 0x2400
v_mfma_f32_16x16x32_bf16 v[108:111], a[108:111], a[68:71], v[108:111]
buffer_store_dwordx4 a[144:147], v16, s[88:91], s8 offen sc1
v_mfma_f32_16x16x32_bf16 v[108:111], a[104:107], a[48:51], v[108:111]
ds_read_b64_tr_b16 a[100:101], v14 offset:2048
v_mfma_f32_16x16x32_bf16 v[100:103], a[104:107], a[44:47], v[100:103]
ds_read_b64_tr_b16 a[102:103], v14 offset:2304
v_mfma_f32_16x16x32_bf16 v[100:103], a[108:111], a[64:67], v[100:103]
v_mfma_f32_16x16x32_bf16 v[92:95], a[108:111], a[60:63], v[92:95]
v_mfma_f32_16x16x32_bf16 v[92:95], a[104:107], a[40:43], v[92:95]
s_add_u32 m0, s16, 0x800
s_waitcnt lgkmcnt(4)
v_mfma_f32_16x16x32_bf16 v[120:123], a[80:83], a[40:43], v[120:123]
buffer_load_dwordx4 v22, s[44:47], s21 offen lds
v_mfma_f32_16x16x32_bf16 v[120:123], a[84:87], a[60:63], v[120:123]
ds_read_b64_tr_b16 a[104:105], v15 offset:0
v_mfma_f32_16x16x32_bf16 v[128:131], a[84:87], a[64:67], v[128:131]
ds_read_b64_tr_b16 a[106:107], v15 offset:256
v_mfma_f32_16x16x32_bf16 v[128:131], a[80:83], a[44:47], v[128:131]
ds_read_b64_tr_b16 a[108:109], v15 offset:2048
v_mfma_f32_16x16x32_bf16 v[136:139], a[80:83], a[48:51], v[136:139]
ds_read_b64_tr_b16 a[110:111], v15 offset:2304
v_mfma_f32_16x16x32_bf16 v[136:139], a[84:87], a[68:71], v[136:139]
s_add_u32 m0, s16, 0xc00
v_mfma_f32_16x16x32_bf16 v[144:147], a[84:87], a[72:75], v[144:147]
buffer_load_dwordx4 v23, s[44:47], s21 offen lds
v_mfma_f32_16x16x32_bf16 v[144:147], a[80:83], a[52:55], v[144:147]
v_mfma_f32_16x16x32_bf16 v[148:151], a[88:91], a[52:55], v[148:151]
ds_read_b64_tr_b16 a[80:81], v14 offset:4096
v_mfma_f32_16x16x32_bf16 v[148:151], a[92:95], a[72:75], v[148:151]
ds_read_b64_tr_b16 a[82:83], v14 offset:4352
v_mfma_f32_16x16x32_bf16 v[140:143], a[92:95], a[68:71], v[140:143]
ds_read_b64_tr_b16 a[84:85], v14 offset:6144
v_mfma_f32_16x16x32_bf16 v[140:143], a[88:91], a[48:51], v[140:143]
ds_read_b64_tr_b16 a[86:87], v14 offset:6400
s_add_u32 m0, s16, 0x1000
v_mfma_f32_16x16x32_bf16 v[132:135], a[88:91], a[44:47], v[132:135]
buffer_load_dwordx4 v22, s[44:47], s22 offen lds
v_mfma_f32_16x16x32_bf16 v[132:135], a[92:95], a[64:67], v[132:135]
v_mfma_f32_16x16x32_bf16 v[124:127], a[92:95], a[60:63], v[124:127]
v_mfma_f32_16x16x32_bf16 v[124:127], a[88:91], a[40:43], v[124:127]
s_waitcnt lgkmcnt(4)
v_mfma_f32_16x16x32_bf16 v[152:155], a[96:99], a[40:43], v[152:155]
ds_read_b64_tr_b16 a[88:89], v15 offset:4096
v_mfma_f32_16x16x32_bf16 v[152:155], a[100:103], a[60:63], v[152:155]
ds_read_b64_tr_b16 a[90:91], v15 offset:4352
s_add_u32 m0, s16, 0x1400
v_mfma_f32_16x16x32_bf16 v[160:163], a[100:103], a[64:67], v[160:163]
buffer_load_dwordx4 v23, s[44:47], s22 offen lds
v_mfma_f32_16x16x32_bf16 v[160:163], a[96:99], a[44:47], v[160:163]
ds_read_b64_tr_b16 a[92:93], v15 offset:6144
v_mfma_f32_16x16x32_bf16 v[168:171], a[96:99], a[48:51], v[168:171]
ds_read_b64_tr_b16 a[94:95], v15 offset:6400
v_mfma_f32_16x16x32_bf16 v[168:171], a[100:103], a[68:71], v[168:171]
v_mfma_f32_16x16x32_bf16 v[176:179], a[100:103], a[72:75], v[176:179]
v_mfma_f32_16x16x32_bf16 v[176:179], a[96:99], a[52:55], v[176:179]
s_add_u32 m0, s16, 0x1800
v_mfma_f32_16x16x32_bf16 v[180:183], a[104:107], a[52:55], v[180:183]
buffer_load_dwordx4 v22, s[44:47], s23 offen lds
v_mfma_f32_16x16x32_bf16 v[180:183], a[108:111], a[72:75], v[180:183]
ds_read_b64_tr_b16 a[96:97], v14 offset:8192
v_mfma_f32_16x16x32_bf16 v[172:175], a[108:111], a[68:71], v[172:175]
ds_read_b64_tr_b16 a[98:99], v14 offset:8448
v_mfma_f32_16x16x32_bf16 v[172:175], a[104:107], a[48:51], v[172:175]
ds_read_b64_tr_b16 a[100:101], v14 offset:10240
v_mfma_f32_16x16x32_bf16 v[164:167], a[104:107], a[44:47], v[164:167]
ds_read_b64_tr_b16 a[102:103], v14 offset:10496
v_mfma_f32_16x16x32_bf16 v[164:167], a[108:111], a[64:67], v[164:167]
s_add_u32 m0, s16, 0x1c00
v_mfma_f32_16x16x32_bf16 v[156:159], a[108:111], a[60:63], v[156:159]
buffer_load_dwordx4 v23, s[44:47], s23 offen lds
v_mfma_f32_16x16x32_bf16 v[156:159], a[104:107], a[40:43], v[156:159]
s_waitcnt lgkmcnt(4)
s_bfe_u32 s39, s40, 0x80008
s_add_u32 s39, s39, s41
v_mfma_f32_16x16x32_bf16 v[184:187], a[80:83], a[40:43], v[184:187]
ds_read_b64_tr_b16 a[104:105], v15 offset:8192
s_and_b32 s39, s39, 15
v_mfma_f32_16x16x32_bf16 v[184:187], a[84:87], a[60:63], v[184:187]
ds_read_b64_tr_b16 a[106:107], v15 offset:8448
s_sub_u32 s42, s39, s41
v_mfma_f32_16x16x32_bf16 v[192:195], a[84:87], a[64:67], v[192:195]
ds_read_b64_tr_b16 a[108:109], v15 offset:10240
s_mov_b32 s41, s39
v_mfma_f32_16x16x32_bf16 v[192:195], a[80:83], a[44:47], v[192:195]
ds_read_b64_tr_b16 a[110:111], v15 offset:10496
s_add_u32 s8, s28, 0x3400
v_mfma_f32_16x16x32_bf16 v[200:203], a[80:83], a[48:51], v[200:203]
buffer_store_dwordx4 a[148:151], v16, s[88:91], s8 offen sc1
v_mfma_f32_16x16x32_bf16 v[200:203], a[84:87], a[68:71], v[200:203]
v_add_u32 v12, 0x8000, v12
v_add_u32 v13, 0x8000, v13
v_mfma_f32_16x16x32_bf16 v[208:211], a[84:87], a[72:75], v[208:211]
v_add_u32 v14, 0x8000, v14
v_add_u32 v15, 0x8000, v15
v_mfma_f32_16x16x32_bf16 v[208:211], a[80:83], a[52:55], v[208:211]
v_add_u32 v10, 0x8000, v10
v_add_u32 v11, 0x8000, v11
v_mfma_f32_16x16x32_bf16 v[248:251], a[80:83], a[56:59], v[248:251]
v_lshl_add_u32 v22, s42, 7, v22
v_lshl_add_u32 v23, s42, 7, v23
v_mfma_f32_16x16x32_bf16 v[248:251], a[84:87], a[76:79], v[248:251]
v_mfma_f32_16x16x32_bf16 v[212:215], a[88:91], a[52:55], v[212:215]
s_waitcnt vmcnt(29) lgkmcnt(0)
v_mfma_f32_16x16x32_bf16 v[212:215], a[92:95], a[72:75], v[212:215]
s_barrier
s_add_u32 m0, s17, 0x0
v_mfma_f32_16x16x32_bf16 v[204:207], a[92:95], a[68:71], v[204:207]
buffer_load_dwordx4 v5, s[52:55], 0 offen lds
v_mfma_f32_16x16x32_bf16 v[204:207], a[88:91], a[48:51], v[204:207]
ds_read_b64_tr_b16 a[80:81], v12 offset:0
v_mfma_f32_16x16x32_bf16 v[196:199], a[88:91], a[44:47], v[196:199]
ds_read_b64_tr_b16 a[82:83], v12 offset:1024
v_mfma_f32_16x16x32_bf16 v[196:199], a[92:95], a[64:67], v[196:199]
ds_read_b64_tr_b16 a[84:85], v12 offset:8192
s_waitcnt lgkmcnt(3)
v_mfma_f32_16x16x32_bf16 v[188:191], a[92:95], a[60:63], v[188:191]
ds_read_b64_tr_b16 a[86:87], v12 offset:9216
s_add_u32 m0, s17, 0x400
v_mfma_f32_16x16x32_bf16 v[188:191], a[88:91], a[40:43], v[188:191]
buffer_load_dwordx4 v5, s[52:55], s13 offen lds
v_mfma_f32_16x16x32_bf16 v[216:219], a[40:43], a[96:99], v[216:219]
ds_read_b64_tr_b16 a[88:89], v13 offset:0
v_mfma_f32_16x16x32_bf16 v[216:219], a[60:63], a[100:103], v[216:219]
ds_read_b64_tr_b16 a[90:91], v13 offset:1024
v_mfma_f32_16x16x32_bf16 v[224:227], a[64:67], a[100:103], v[224:227]
ds_read_b64_tr_b16 a[92:93], v13 offset:8192
v_mfma_f32_16x16x32_bf16 v[224:227], a[44:47], a[96:99], v[224:227]
ds_read_b64_tr_b16 a[94:95], v13 offset:9216
v_mfma_f32_16x16x32_bf16 v[232:235], a[48:51], a[96:99], v[232:235]
s_add_u32 m0, s17, 0x800
v_mfma_f32_16x16x32_bf16 v[232:235], a[68:71], a[100:103], v[232:235]
buffer_load_dwordx4 v6, s[52:55], 0 offen lds
v_mfma_f32_16x16x32_bf16 v[240:243], a[72:75], a[100:103], v[240:243]
v_mfma_f32_16x16x32_bf16 v[240:243], a[52:55], a[96:99], v[240:243]
v_mfma_f32_16x16x32_bf16 v[252:255], a[56:59], a[96:99], v[252:255]
v_mfma_f32_16x16x32_bf16 v[252:255], a[76:79], a[100:103], v[252:255]
v_mfma_f32_16x16x32_bf16 v[244:247], a[52:55], a[104:107], v[244:247]
ds_read_b64_tr_b16 a[96:97], v12 offset:256
s_add_u32 m0, s17, 0xc00
v_mfma_f32_16x16x32_bf16 v[244:247], a[72:75], a[108:111], v[244:247]
buffer_load_dwordx4 v6, s[52:55], s13 offen lds
v_mfma_f32_16x16x32_bf16 v[236:239], a[68:71], a[108:111], v[236:239]
ds_read_b64_tr_b16 a[98:99], v12 offset:1280
v_mfma_f32_16x16x32_bf16 v[236:239], a[48:51], a[104:107], v[236:239]
ds_read_b64_tr_b16 a[100:101], v12 offset:8448
v_mfma_f32_16x16x32_bf16 v[228:231], a[44:47], a[104:107], v[228:231]
ds_read_b64_tr_b16 a[102:103], v12 offset:9472
v_mfma_f32_16x16x32_bf16 v[228:231], a[64:67], a[108:111], v[228:231]
v_add_u32 v20, s0, v16
v_mov_b32 v21, s1
v_mfma_f32_16x16x32_bf16 v[220:223], a[60:63], a[108:111], v[220:223]
global_load_dword a120, v[20:21], off sc1
v_mfma_f32_16x16x32_bf16 v[220:223], a[40:43], a[104:107], v[220:223]
s_waitcnt lgkmcnt(4)
L_S10:
v_mfma_f32_16x16x32_bf16 v[24:27], a[80:83], a[0:3], v[24:27]
ds_read_b64_tr_b16 a[104:105], v13 offset:256
s_waitcnt vmcnt(25)
v_mfma_f32_16x16x32_bf16 v[24:27], a[84:87], a[20:23], v[24:27]
ds_read_b64_tr_b16 a[106:107], v13 offset:1280
v_mfma_f32_16x16x32_bf16 v[32:35], a[84:87], a[24:27], v[32:35]
ds_read_b64_tr_b16 a[108:109], v13 offset:8448
v_mfma_f32_16x16x32_bf16 v[32:35], a[80:83], a[4:7], v[32:35]
ds_read_b64_tr_b16 a[110:111], v13 offset:9472
s_add_u32 m0, s18, 0x4000
v_mfma_f32_16x16x32_bf16 v[40:43], a[80:83], a[8:11], v[40:43]
buffer_load_dwordx4 v7, s[68:71], 0 offen lds
v_mfma_f32_16x16x32_bf16 v[40:43], a[84:87], a[28:31], v[40:43]
ds_read_b128 a[40:43], v8 offset:32768
v_mfma_f32_16x16x32_bf16 v[48:51], a[84:87], a[32:35], v[48:51]
ds_read_b128 a[60:63], v9 offset:32768
v_mfma_f32_16x16x32_bf16 v[48:51], a[80:83], a[12:15], v[48:51]
ds_read_b128 a[44:47], v8 offset:34816
v_mfma_f32_16x16x32_bf16 v[52:55], a[88:91], a[12:15], v[52:55]
ds_read_b64_tr_b16 a[80:81], v12 offset:512
v_mfma_f32_16x16x32_bf16 v[52:55], a[92:95], a[32:35], v[52:55]
ds_read_b64_tr_b16 a[82:83], v12 offset:1536
s_add_u32 m0, s18, 0x5000
v_mfma_f32_16x16x32_bf16 v[44:47], a[92:95], a[28:31], v[44:47]
buffer_load_dwordx4 v7, s[68:71], s25 offen lds
v_mfma_f32_16x16x32_bf16 v[44:47], a[88:91], a[8:11], v[44:47]
ds_read_b64_tr_b16 a[84:85], v12 offset:8704
v_mfma_f32_16x16x32_bf16 v[36:39], a[88:91], a[4:7], v[36:39]
ds_read_b64_tr_b16 a[86:87], v12 offset:9728
v_mfma_f32_16x16x32_bf16 v[36:39], a[92:95], a[24:27], v[36:39]
ds_read_b128 a[64:67], v9 offset:34816
s_waitcnt lgkmcnt(8)
v_mfma_f32_16x16x32_bf16 v[28:31], a[92:95], a[20:23], v[28:31]
ds_read_b128 a[48:51], v8 offset:36864
s_add_u32 m0, s18, 0x6000
v_mfma_f32_16x16x32_bf16 v[28:31], a[88:91], a[0:3], v[28:31]
buffer_load_dwordx4 v7, s[68:71], s26 offen lds
v_mfma_f32_16x16x32_bf16 v[56:59], a[96:99], a[0:3], v[56:59]
ds_read_b64_tr_b16 a[88:89], v13 offset:512
v_mfma_f32_16x16x32_bf16 v[56:59], a[100:103], a[20:23], v[56:59]
ds_read_b64_tr_b16 a[90:91], v13 offset:1536
v_mfma_f32_16x16x32_bf16 v[64:67], a[100:103], a[24:27], v[64:67]
ds_read_b64_tr_b16 a[92:93], v13 offset:8704
v_mfma_f32_16x16x32_bf16 v[64:67], a[96:99], a[4:7], v[64:67]
ds_read_b64_tr_b16 a[94:95], v13 offset:9728
v_mfma_f32_16x16x32_bf16 v[72:75], a[96:99], a[8:11], v[72:75]
ds_read_b128 a[68:71], v9 offset:36864
s_add_u32 m0, s18, 0x7000
v_mfma_f32_16x16x32_bf16 v[72:75], a[100:103], a[28:31], v[72:75]
buffer_load_dwordx4 v4, s[44:47], s24 offen lds
v_mfma_f32_16x16x32_bf16 v[80:83], a[100:103], a[32:35], v[80:83]
ds_read_b128 a[52:55], v8 offset:38912
v_lshl_add_u32 v5, s42, 19, v5
v_mfma_f32_16x16x32_bf16 v[80:83], a[96:99], a[12:15], v[80:83]
ds_read_b128 a[72:75], v9 offset:38912
v_lshl_add_u32 v6, s42, 19, v6
v_mfma_f32_16x16x32_bf16 v[84:87], a[104:107], a[12:15], v[84:87]
ds_read_b64_tr_b16 a[96:97], v12 offset:768
v_lshl_add_u32 v7, s42, 18, v7
v_mfma_f32_16x16x32_bf16 v[84:87], a[108:111], a[32:35], v[84:87]
ds_read_b64_tr_b16 a[98:99], v12 offset:1792
v_lshl_add_u32 v7, s42, 17, v7
v_mfma_f32_16x16x32_bf16 v[76:79], a[108:111], a[28:31], v[76:79]
ds_read_b64_tr_b16 a[100:101], v12 offset:8960
s_add_u32 s8, s28, 0x6400
v_mfma_f32_16x16x32_bf16 v[76:79], a[104:107], a[8:11], v[76:79]
buffer_store_dwordx4 a[152:155], v16, s[88:91], s8 offen sc1
v_mfma_f32_16x16x32_bf16 v[68:71], a[104:107], a[4:7], v[68:71]
ds_read_b64_tr_b16 a[102:103], v12 offset:9984
v_lshl_add_u32 v4, s42, 7, v4
v_mfma_f32_16x16x32_bf16 v[68:71], a[108:111], a[24:27], v[68:71]
ds_read_b128 a[16:19], v10
v_mfma_f32_16x16x32_bf16 v[60:63], a[108:111], a[20:23], v[60:63]
ds_read_b128 a[36:39], v11
v_mfma_f32_16x16x32_bf16 v[60:63], a[104:107], a[0:3], v[60:63]
s_waitcnt lgkmcnt(6)
s_waitcnt lgkmcnt(9)
v_mfma_f32_16x16x32_bf16 v[88:91], a[80:83], a[0:3], v[88:91]
ds_read_b64_tr_b16 a[104:105], v13 offset:768
s_add_u32 m0, s16, 0x8000
v_mfma_f32_16x16x32_bf16 v[88:91], a[84:87], a[20:23], v[88:91]
buffer_load_dwordx4 v22, s[44:47], s20 offen lds
v_mfma_f32_16x16x32_bf16 v[96:99], a[84:87], a[24:27], v[96:99]
ds_read_b64_tr_b16 a[106:107], v13 offset:1792
v_mfma_f32_16x16x32_bf16 v[96:99], a[80:83], a[4:7], v[96:99]
ds_read_b64_tr_b16 a[108:109], v13 offset:8960
v_mfma_f32_16x16x32_bf16 v[104:107], a[80:83], a[8:11], v[104:107]
ds_read_b64_tr_b16 a[110:111], v13 offset:9984
v_mfma_f32_16x16x32_bf16 v[104:107], a[84:87], a[28:31], v[104:107]
s_add_u32 m0, s16, 0x8400
v_mfma_f32_16x16x32_bf16 v[112:115], a[84:87], a[32:35], v[112:115]
buffer_load_dwordx4 v23, s[44:47], s20 offen lds
v_mfma_f32_16x16x32_bf16 v[112:115], a[80:83], a[12:15], v[112:115]
v_mfma_f32_16x16x32_bf16 v[116:119], a[88:91], a[12:15], v[116:119]
ds_read_b64_tr_b16 a[80:81], v14 offset:0
v_mfma_f32_16x16x32_bf16 v[116:119], a[92:95], a[32:35], v[116:119]
ds_read_b64_tr_b16 a[82:83], v14 offset:256
v_mfma_f32_16x16x32_bf16 v[108:111], a[92:95], a[28:31], v[108:111]
ds_read_b64_tr_b16 a[84:85], v14 offset:2048
v_mfma_f32_16x16x32_bf16 v[108:111], a[88:91], a[8:11], v[108:111]
ds_read_b64_tr_b16 a[86:87], v14 offset:2304
s_add_u32 m0, s16, 0x8800
v_mfma_f32_16x16x32_bf16 v[100:103], a[88:91], a[4:7], v[100:103]
buffer_load_dwordx4 v22, s[44:47], s21 offen lds
v_mfma_f32_16x16x32_bf16 v[100:103], a[92:95], a[24:27], v[100:103]
v_mfma_f32_16x16x32_bf16 v[92:95], a[92:95], a[20:23], v[92:95]
v_mfma_f32_16x16x32_bf16 v[92:95], a[88:91], a[0:3], v[92:95]
s_waitcnt lgkmcnt(4)
v_mfma_f32_16x16x32_bf16 v[120:123], a[96:99], a[0:3], v[120:123]
ds_read_b64_tr_b16 a[88:89], v15 offset:0
v_mfma_f32_16x16x32_bf16 v[120:123], a[100:103], a[20:23], v[120:123]
ds_read_b64_tr_b16 a[90:91], v15 offset:256
s_add_u32 m0, s16, 0x8c00
v_mfma_f32_16x16x32_bf16 v[128:131], a[100:103], a[24:27], v[128:131]
buffer_load_dwordx4 v23, s[44:47], s21 offen lds
v_mfma_f32_16x16x32_bf16 v[128:131], a[96:99], a[4:7], v[128:131]
ds_read_b64_tr_b16 a[92:93], v15 offset:2048
v_mfma_f32_16x16x32_bf16 v[136:139], a[96:99], a[8:11], v[136:139]
ds_read_b64_tr_b16 a[94:95], v15 offset:2304
v_mfma_f32_16x16x32_bf16 v[136:139], a[100:103], a[28:31], v[136:139]
v_mfma_f32_16x16x32_bf16 v[144:147], a[100:103], a[32:35], v[144:147]
s_add_u32 s8, s28, 0x7400
v_mfma_f32_16x16x32_bf16 v[144:147], a[96:99], a[12:15], v[144:147]
buffer_store_dwordx4 a[156:159], v16, s[88:91], s8 offen sc1
v_mfma_f32_16x16x32_bf16 v[148:151], a[104:107], a[12:15], v[148:151]
ds_read_b64_tr_b16 a[96:97], v14 offset:4096
v_mfma_f32_16x16x32_bf16 v[148:151], a[108:111], a[32:35], v[148:151]
ds_read_b64_tr_b16 a[98:99], v14 offset:4352
v_mfma_f32_16x16x32_bf16 v[140:143], a[108:111], a[28:31], v[140:143]
ds_read_b64_tr_b16 a[100:101], v14 offset:6144
v_mfma_f32_16x16x32_bf16 v[140:143], a[104:107], a[8:11], v[140:143]
ds_read_b64_tr_b16 a[102:103], v14 offset:6400
v_mfma_f32_16x16x32_bf16 v[132:135], a[104:107], a[4:7], v[132:135]
s_add_u32 m0, s16, 0x9000
v_mfma_f32_16x16x32_bf16 v[132:135], a[108:111], a[24:27], v[132:135]
buffer_load_dwordx4 v22, s[44:47], s22 offen lds
v_mfma_f32_16x16x32_bf16 v[124:127], a[108:111], a[20:23], v[124:127]
v_mfma_f32_16x16x32_bf16 v[124:127], a[104:107], a[0:3], v[124:127]
s_waitcnt lgkmcnt(4)
v_mfma_f32_16x16x32_bf16 v[152:155], a[80:83], a[0:3], v[152:155]
ds_read_b64_tr_b16 a[104:105], v15 offset:4096
v_mfma_f32_16x16x32_bf16 v[152:155], a[84:87], a[20:23], v[152:155]
ds_read_b64_tr_b16 a[106:107], v15 offset:4352
v_mfma_f32_16x16x32_bf16 v[160:163], a[84:87], a[24:27], v[160:163]
ds_read_b64_tr_b16 a[108:109], v15 offset:6144
s_add_u32 m0, s16, 0x9400
v_mfma_f32_16x16x32_bf16 v[160:163], a[80:83], a[4:7], v[160:163]
buffer_load_dwordx4 v23, s[44:47], s22 offen lds
v_mfma_f32_16x16x32_bf16 v[168:171], a[80:83], a[8:11], v[168:171]
ds_read_b64_tr_b16 a[110:111], v15 offset:6400
v_mfma_f32_16x16x32_bf16 v[168:171], a[84:87], a[28:31], v[168:171]
v_mfma_f32_16x16x32_bf16 v[176:179], a[84:87], a[32:35], v[176:179]
v_mfma_f32_16x16x32_bf16 v[176:179], a[80:83], a[12:15], v[176:179]
s_add_u32 m0, s16, 0x9800
v_mfma_f32_16x16x32_bf16 v[180:183], a[88:91], a[12:15], v[180:183]
buffer_load_dwordx4 v22, s[44:47], s23 offen lds
v_mfma_f32_16x16x32_bf16 v[180:183], a[92:95], a[32:35], v[180:183]
ds_read_b64_tr_b16 a[80:81], v14 offset:8192
v_mfma_f32_16x16x32_bf16 v[172:175], a[92:95], a[28:31], v[172:175]
ds_read_b64_tr_b16 a[82:83], v14 offset:8448
v_mfma_f32_16x16x32_bf16 v[172:175], a[88:91], a[8:11], v[172:175]
ds_read_b64_tr_b16 a[84:85], v14 offset:10240
v_mfma_f32_16x16x32_bf16 v[164:167], a[88:91], a[4:7], v[164:167]
ds_read_b64_tr_b16 a[86:87], v14 offset:10496
v_mfma_f32_16x16x32_bf16 v[164:167], a[92:95], a[24:27], v[164:167]
s_add_u32 m0, s16, 0x9c00
v_mfma_f32_16x16x32_bf16 v[156:159], a[92:95], a[20:23], v[156:159]
buffer_load_dwordx4 v23, s[44:47], s23 offen lds
v_mfma_f32_16x16x32_bf16 v[156:159], a[88:91], a[0:3], v[156:159]
s_waitcnt lgkmcnt(4)
s_bfe_u32 s39, s40, 0x80010
s_add_u32 s39, s39, s41
v_mfma_f32_16x16x32_bf16 v[184:187], a[96:99], a[0:3], v[184:187]
ds_read_b64_tr_b16 a[88:89], v15 offset:8192
s_and_b32 s39, s39, 15
v_mfma_f32_16x16x32_bf16 v[184:187], a[100:103], a[20:23], v[184:187]
ds_read_b64_tr_b16 a[90:91], v15 offset:8448
s_sub_u32 s42, s39, s41
v_mfma_f32_16x16x32_bf16 v[192:195], a[100:103], a[24:27], v[192:195]
ds_read_b64_tr_b16 a[92:93], v15 offset:10240
s_mov_b32 s41, s39
v_mfma_f32_16x16x32_bf16 v[192:195], a[96:99], a[4:7], v[192:195]
ds_read_b64_tr_b16 a[94:95], v15 offset:10496
s_add_u32 s8, s28, 0x2800
v_mfma_f32_16x16x32_bf16 v[200:203], a[96:99], a[8:11], v[200:203]
buffer_store_dwordx4 a[160:163], v16, s[88:91], s8 offen sc1
v_mfma_f32_16x16x32_bf16 v[200:203], a[100:103], a[28:31], v[200:203]
v_add_u32 v12, 0x8000, v12
v_add_u32 v13, 0x8000, v13
v_mfma_f32_16x16x32_bf16 v[208:211], a[100:103], a[32:35], v[208:211]
v_add_u32 v14, 0x8000, v14
v_add_u32 v15, 0x8000, v15
v_mfma_f32_16x16x32_bf16 v[208:211], a[96:99], a[12:15], v[208:211]
v_add_u32 v10, 0x8000, v10
v_add_u32 v11, 0x8000, v11
v_mfma_f32_16x16x32_bf16 v[248:251], a[96:99], a[16:19], v[248:251]
v_lshl_add_u32 v22, s42, 7, v22
v_lshl_add_u32 v23, s42, 7, v23
v_mfma_f32_16x16x32_bf16 v[248:251], a[100:103], a[36:39], v[248:251]
v_mfma_f32_16x16x32_bf16 v[212:215], a[104:107], a[12:15], v[212:215]
s_waitcnt vmcnt(30) lgkmcnt(0)
v_mfma_f32_16x16x32_bf16 v[212:215], a[108:111], a[32:35], v[212:215]
s_barrier
s_add_u32 m0, s17, 0x8000
v_mfma_f32_16x16x32_bf16 v[204:207], a[108:111], a[28:31], v[204:207]
buffer_load_dwordx4 v5, s[52:55], 0 offen lds
v_mfma_f32_16x16x32_bf16 v[204:207], a[104:107], a[8:11], v[204:207]
ds_read_b64_tr_b16 a[96:97], v12 offset:0
v_mfma_f32_16x16x32_bf16 v[196:199], a[104:107], a[4:7], v[196:199]
ds_read_b64_tr_b16 a[98:99], v12 offset:1024
v_mfma_f32_16x16x32_bf16 v[196:199], a[108:111], a[24:27], v[196:199]
ds_read_b64_tr_b16 a[100:101], v12 offset:8192
v_mfma_f32_16x16x32_bf16 v[188:191], a[108:111], a[20:23], v[188:191]
ds_read_b64_tr_b16 a[102:103], v12 offset:9216
v_mfma_f32_16x16x32_bf16 v[188:191], a[104:107], a[0:3], v[188:191]
s_add_u32 m0, s17, 0x8400
s_waitcnt lgkmcnt(4)
v_mfma_f32_16x16x32_bf16 v[216:219], a[0:3], a[80:83], v[216:219]
buffer_load_dwordx4 v5, s[52:55], s13 offen lds
v_mfma_f32_16x16x32_bf16 v[216:219], a[20:23], a[84:87], v[216:219]
ds_read_b64_tr_b16 a[104:105], v13 offset:0
v_mfma_f32_16x16x32_bf16 v[224:227], a[24:27], a[84:87], v[224:227]
ds_read_b64_tr_b16 a[106:107], v13 offset:1024
v_mfma_f32_16x16x32_bf16 v[224:227], a[4:7], a[80:83], v[224:227]
ds_read_b64_tr_b16 a[108:109], v13 offset:8192
v_mfma_f32_16x16x32_bf16 v[232:235], a[8:11], a[80:83], v[232:235]
ds_read_b64_tr_b16 a[110:111], v13 offset:9216
v_mfma_f32_16x16x32_bf16 v[232:235], a[28:31], a[84:87], v[232:235]
s_add_u32 m0, s17, 0x8800
v_mfma_f32_16x16x32_bf16 v[240:243], a[32:35], a[84:87], v[240:243]
buffer_load_dwordx4 v6, s[52:55], 0 offen lds
v_mfma_f32_16x16x32_bf16 v[240:243], a[12:15], a[80:83], v[240:243]
v_mfma_f32_16x16x32_bf16 v[252:255], a[16:19], a[80:83], v[252:255]
v_mfma_f32_16x16x32_bf16 v[252:255], a[36:39], a[84:87], v[252:255]
v_mfma_f32_16x16x32_bf16 v[244:247], a[12:15], a[88:91], v[244:247]
ds_read_b64_tr_b16 a[80:81], v12 offset:256
v_mfma_f32_16x16x32_bf16 v[244:247], a[32:35], a[92:95], v[244:247]
ds_read_b64_tr_b16 a[82:83], v12 offset:1280
s_add_u32 m0, s17, 0x8c00
v_mfma_f32_16x16x32_bf16 v[236:239], a[28:31], a[92:95], v[236:239]
buffer_load_dwordx4 v6, s[52:55], s13 offen lds
v_mfma_f32_16x16x32_bf16 v[236:239], a[8:11], a[88:91], v[236:239]
ds_read_b64_tr_b16 a[84:85], v12 offset:8448
L_padA6:
s_cmp_eq_u32 s95, 1
s_cbranch_scc1 L_padA10
v_mfma_f32_16x16x32_bf16 v[228:231], a[4:7], a[88:91], v[228:231]
ds_read_b64_tr_b16 a[86:87], v12 offset:9472
v_mfma_f32_16x16x32_bf16 v[228:231], a[24:27], a[92:95], v[228:231]
v_mfma_f32_16x16x32_bf16 v[220:223], a[20:23], a[92:95], v[220:223]
v_mfma_f32_16x16x32_bf16 v[220:223], a[0:3], a[88:91], v[220:223]
s_add_u32 m0, s18, 0xc000
s_waitcnt lgkmcnt(4)
L_S11:
v_mfma_f32_16x16x32_bf16 v[24:27], a[96:99], a[40:43], v[24:27]
buffer_load_dwordx4 v7, s[68:71], 0 offen lds
v_mfma_f32_16x16x32_bf16 v[24:27], a[100:103], a[60:63], v[24:27]
ds_read_b64_tr_b16 a[88:89], v13 offset:256
s_waitcnt vmcnt(26)
v_mfma_f32_16x16x32_bf16 v[32:35], a[100:103], a[64:67], v[32:35]
ds_read_b64_tr_b16 a[90:91], v13 offset:1280
v_mfma_f32_16x16x32_bf16 v[32:35], a[96:99], a[44:47], v[32:35]
ds_read_b64_tr_b16 a[92:93], v13 offset:8448
v_mfma_f32_16x16x32_bf16 v[40:43], a[96:99], a[48:51], v[40:43]
ds_read_b64_tr_b16 a[94:95], v13 offset:9472
v_mfma_f32_16x16x32_bf16 v[40:43], a[100:103], a[68:71], v[40:43]
ds_read_b128 a[0:3], v8 offset:0
s_add_u32 s8, s28, 0x3800
v_mfma_f32_16x16x32_bf16 v[48:51], a[100:103], a[72:75], v[48:51]
buffer_store_dwordx4 a[164:167], v16, s[88:91], s8 offen sc1
v_mfma_f32_16x16x32_bf16 v[48:51], a[96:99], a[52:55], v[48:51]
ds_read_b128 a[20:23], v9 offset:0
v_mfma_f32_16x16x32_bf16 v[52:55], a[104:107], a[52:55], v[52:55]
ds_read_b64_tr_b16 a[96:97], v12 offset:512
v_mfma_f32_16x16x32_bf16 v[52:55], a[108:111], a[72:75], v[52:55]
ds_read_b64_tr_b16 a[98:99], v12 offset:1536
v_mfma_f32_16x16x32_bf16 v[44:47], a[108:111], a[68:71], v[44:47]
ds_read_b64_tr_b16 a[100:101], v12 offset:8704
v_mfma_f32_16x16x32_bf16 v[44:47], a[104:107], a[48:51], v[44:47]
ds_read_b64_tr_b16 a[102:103], v12 offset:9728
s_add_u32 m0, s18, 0xd000
v_mfma_f32_16x16x32_bf16 v[36:39], a[104:107], a[44:47], v[36:39]
buffer_load_dwordx4 v7, s[68:71], s25 offen lds
v_mfma_f32_16x16x32_bf16 v[36:39], a[108:111], a[64:67], v[36:39]
ds_read_b128 a[4:7], v8 offset:2048
v_mfma_f32_16x16x32_bf16 v[28:31], a[108:111], a[60:63], v[28:31]
ds_read_b128 a[24:27], v9 offset:2048
v_mfma_f32_16x16x32_bf16 v[28:31], a[104:107], a[40:43], v[28:31]
ds_read_b128 a[8:11], v8 offset:4096
s_waitcnt lgkmcnt(9)
v_mfma_f32_16x16x32_bf16 v[56:59], a[80:83], a[40:43], v[56:59]
ds_read_b64_tr_b16 a[104:105], v13 offset:512
v_mfma_f32_16x16x32_bf16 v[56:59], a[84:87], a[60:63], v[56:59]
ds_read_b64_tr_b16 a[106:107], v13 offset:1536
s_add_u32 m0, s18, 0xe000
v_mfma_f32_16x16x32_bf16 v[64:67], a[84:87], a[64:67], v[64:67]
buffer_load_dwordx4 v7, s[68:71], s26 offen lds
v_mfma_f32_16x16x32_bf16 v[64:67], a[80:83], a[44:47], v[64:67]
ds_read_b64_tr_b16 a[108:109], v13 offset:8704
v_mfma_f32_16x16x32_bf16 v[72:75], a[80:83], a[48:51], v[72:75]
ds_read_b64_tr_b16 a[110:111], v13 offset:9728
v_mfma_f32_16x16x32_bf16 v[72:75], a[84:87], a[68:71], v[72:75]
ds_read_b128 a[28:31], v9 offset:4096
v_mfma_f32_16x16x32_bf16 v[80:83], a[84:87], a[72:75], v[80:83]
ds_read_b128 a[12:15], v8 offset:6144
v_mfma_f32_16x16x32_bf16 v[80:83], a[80:83], a[52:55], v[80:83]
ds_read_b128 a[32:35], v9 offset:6144
s_add_u32 m0, s18, 0xf000
v_mfma_f32_16x16x32_bf16 v[84:87], a[88:91], a[52:55], v[84:87]
buffer_load_dwordx4 v4, s[44:47], s24 offen lds
v_mfma_f32_16x16x32_bf16 v[84:87], a[92:95], a[72:75], v[84:87]
ds_read_b64_tr_b16 a[80:81], v12 offset:768
v_lshl_add_u32 v5, s42, 19, v5
v_mfma_f32_16x16x32_bf16 v[76:79], a[92:95], a[68:71], v[76:79]
ds_read_b64_tr_b16 a[82:83], v12 offset:1792
v_lshl_add_u32 v6, s42, 19, v6
v_mfma_f32_16x16x32_bf16 v[76:79], a[88:91], a[48:51], v[76:79]
ds_read_b64_tr_b16 a[84:85], v12 offset:8960
v_lshl_add_u32 v7, s42, 18, v7
v_mfma_f32_16x16x32_bf16 v[68:71], a[88:91], a[44:47], v[68:71]
ds_read_b64_tr_b16 a[86:87], v12 offset:9984
s_waitcnt lgkmcnt(4)
v_mfma_f32_16x16x32_bf16 v[68:71], a[92:95], a[64:67], v[68:71]
ds_read_b128 a[56:59], v10
s_add_u32 m0, s16, 0x0
v_mfma_f32_16x16x32_bf16 v[60:63], a[92:95], a[60:63], v[60:63]
buffer_load_dwordx4 v22, s[44:47], s20 offen lds
v_mfma_f32_16x16x32_bf16 v[60:63], a[88:91], a[40:43], v[60:63]
ds_read_b128 a[76:79], v11
s_waitcnt lgkmcnt(9)
v_mfma_f32_16x16x32_bf16 v[88:91], a[96:99], a[40:43], v[88:91]
ds_read_b64_tr_b16 a[88:89], v13 offset:768
v_lshl_add_u32 v7, s42, 17, v7
v_mfma_f32_16x16x32_bf16 v[88:91], a[100:103], a[60:63], v[88:91]
ds_read_b64_tr_b16 a[90:91], v13 offset:1792
v_lshl_add_u32 v4, s42, 7, v4
v_mfma_f32_16x16x32_bf16 v[96:99], a[100:103], a[64:67], v[96:99]
ds_read_b64_tr_b16 a[92:93], v13 offset:8960
v_mfma_f32_16x16x32_bf16 v[96:99], a[96:99], a[44:47], v[96:99]
ds_read_b64_tr_b16 a[94:95], v13 offset:9984
s_add_u32 m0, s16, 0x400
v_mfma_f32_16x16x32_bf16 v[104:107], a[96:99], a[48:51], v[104:107]
buffer_load_dwordx4 v23, s[44:47], s20 offen lds
v_mfma_f32_16x16x32_bf16 v[104:107], a[100:103], a[68:71], v[104:107]
v_mfma_f32_16x16x32_bf16 v[112:115], a[100:103], a[72:75], v[112:115]
v_mfma_f32_16x16x32_bf16 v[112:115], a[96:99], a[52:55], v[112:115]
v_mfma_f32_16x16x32_bf16 v[116:119], a[104:107], a[52:55], v[116:119]
ds_read_b64_tr_b16 a[96:97], v14 offset:0
v_mfma_f32_16x16x32_bf16 v[116:119], a[108:111], a[72:75], v[116:119]
ds_read_b64_tr_b16 a[98:99], v14 offset:256
s_add_u32 s8, s28, 0x6800
v_mfma_f32_16x16x32_bf16 v[108:111], a[108:111], a[68:71], v[108:111]
buffer_store_dwordx4 a[168:171], v16, s[88:91], s8 offen sc1
v_mfma_f32_16x16x32_bf16 v[108:111], a[104:107], a[48:51], v[108:111]
ds_read_b64_tr_b16 a[100:101], v14 offset:2048
v_mfma_f32_16x16x32_bf16 v[100:103], a[104:107], a[44:47], v[100:103]
ds_read_b64_tr_b16 a[102:103], v14 offset:2304
v_mfma_f32_16x16x32_bf16 v[100:103], a[108:111], a[64:67], v[100:103]
v_mfma_f32_16x16x32_bf16 v[92:95], a[108:111], a[60:63], v[92:95]
v_mfma_f32_16x16x32_bf16 v[92:95], a[104:107], a[40:43], v[92:95]
s_add_u32 m0, s16, 0x800
s_waitcnt lgkmcnt(4)
v_mfma_f32_16x16x32_bf16 v[120:123], a[80:83], a[40:43], v[120:123]
buffer_load_dwordx4 v22, s[44:47], s21 offen lds
v_mfma_f32_16x16x32_bf16 v[120:123], a[84:87], a[60:63], v[120:123]
ds_read_b64_tr_b16 a[104:105], v15 offset:0
v_mfma_f32_16x16x32_bf16 v[128:131], a[84:87], a[64:67], v[128:131]
ds_read_b64_tr_b16 a[106:107], v15 offset:256
v_mfma_f32_16x16x32_bf16 v[128:131], a[80:83], a[44:47], v[128:131]
ds_read_b64_tr_b16 a[108:109], v15 offset:2048
v_mfma_f32_16x16x32_bf16 v[136:139], a[80:83], a[48:51], v[136:139]
ds_read_b64_tr_b16 a[110:111], v15 offset:2304
v_mfma_f32_16x16x32_bf16 v[136:139], a[84:87], a[68:71], v[136:139]
s_add_u32 m0, s16, 0xc00
v_mfma_f32_16x16x32_bf16 v[144:147], a[84:87], a[72:75], v[144:147]
buffer_load_dwordx4 v23, s[44:47], s21 offen lds
v_mfma_f32_16x16x32_bf16 v[144:147], a[80:83], a[52:55], v[144:147]
v_mfma_f32_16x16x32_bf16 v[148:151], a[88:91], a[52:55], v[148:151]
ds_read_b64_tr_b16 a[80:81], v14 offset:4096
v_mfma_f32_16x16x32_bf16 v[148:151], a[92:95], a[72:75], v[148:151]
ds_read_b64_tr_b16 a[82:83], v14 offset:4352
v_mfma_f32_16x16x32_bf16 v[140:143], a[92:95], a[68:71], v[140:143]
ds_read_b64_tr_b16 a[84:85], v14 offset:6144
v_mfma_f32_16x16x32_bf16 v[140:143], a[88:91], a[48:51], v[140:143]
ds_read_b64_tr_b16 a[86:87], v14 offset:6400
s_add_u32 m0, s16, 0x1000
v_mfma_f32_16x16x32_bf16 v[132:135], a[88:91], a[44:47], v[132:135]
buffer_load_dwordx4 v22, s[44:47], s22 offen lds
v_mfma_f32_16x16x32_bf16 v[132:135], a[92:95], a[64:67], v[132:135]
v_mfma_f32_16x16x32_bf16 v[124:127], a[92:95], a[60:63], v[124:127]
v_mfma_f32_16x16x32_bf16 v[124:127], a[88:91], a[40:43], v[124:127]
s_waitcnt lgkmcnt(4)
v_mfma_f32_16x16x32_bf16 v[152:155], a[96:99], a[40:43], v[152:155]
ds_read_b64_tr_b16 a[88:89], v15 offset:4096
v_mfma_f32_16x16x32_bf16 v[152:155], a[100:103], a[60:63], v[152:155]
ds_read_b64_tr_b16 a[90:91], v15 offset:4352
s_add_u32 m0, s16, 0x1400
v_mfma_f32_16x16x32_bf16 v[160:163], a[100:103], a[64:67], v[160:163]
buffer_load_dwordx4 v23, s[44:47], s22 offen lds
v_mfma_f32_16x16x32_bf16 v[160:163], a[96:99], a[44:47], v[160:163]
ds_read_b64_tr_b16 a[92:93], v15 offset:6144
v_mfma_f32_16x16x32_bf16 v[168:171], a[96:99], a[48:51], v[168:171]
ds_read_b64_tr_b16 a[94:95], v15 offset:6400
v_mfma_f32_16x16x32_bf16 v[168:171], a[100:103], a[68:71], v[168:171]
v_mfma_f32_16x16x32_bf16 v[176:179], a[100:103], a[72:75], v[176:179]
v_mfma_f32_16x16x32_bf16 v[176:179], a[96:99], a[52:55], v[176:179]
s_add_u32 m0, s16, 0x1800
v_mfma_f32_16x16x32_bf16 v[180:183], a[104:107], a[52:55], v[180:183]
buffer_load_dwordx4 v22, s[44:47], s23 offen lds
v_mfma_f32_16x16x32_bf16 v[180:183], a[108:111], a[72:75], v[180:183]
ds_read_b64_tr_b16 a[96:97], v14 offset:8192
v_mfma_f32_16x16x32_bf16 v[172:175], a[108:111], a[68:71], v[172:175]
ds_read_b64_tr_b16 a[98:99], v14 offset:8448
v_mfma_f32_16x16x32_bf16 v[172:175], a[104:107], a[48:51], v[172:175]
ds_read_b64_tr_b16 a[100:101], v14 offset:10240
v_mfma_f32_16x16x32_bf16 v[164:167], a[104:107], a[44:47], v[164:167]
ds_read_b64_tr_b16 a[102:103], v14 offset:10496
v_mfma_f32_16x16x32_bf16 v[164:167], a[108:111], a[64:67], v[164:167]
s_add_u32 m0, s16, 0x1c00
v_mfma_f32_16x16x32_bf16 v[156:159], a[108:111], a[60:63], v[156:159]
buffer_load_dwordx4 v23, s[44:47], s23 offen lds
v_mfma_f32_16x16x32_bf16 v[156:159], a[104:107], a[40:43], v[156:159]
s_waitcnt lgkmcnt(4)
s_bfe_u32 s39, s40, 0x80018
s_add_u32 s39, s39, s41
v_mfma_f32_16x16x32_bf16 v[184:187], a[80:83], a[40:43], v[184:187]
ds_read_b64_tr_b16 a[104:105], v15 offset:8192
s_and_b32 s39, s39, 15
v_mfma_f32_16x16x32_bf16 v[184:187], a[84:87], a[60:63], v[184:187]
ds_read_b64_tr_b16 a[106:107], v15 offset:8448
s_sub_u32 s42, s39, s41
v_mfma_f32_16x16x32_bf16 v[192:195], a[84:87], a[64:67], v[192:195]
ds_read_b64_tr_b16 a[108:109], v15 offset:10240
s_mov_b32 s41, s39
v_mfma_f32_16x16x32_bf16 v[192:195], a[80:83], a[44:47], v[192:195]
ds_read_b64_tr_b16 a[110:111], v15 offset:10496
s_add_u32 s8, s28, 0x7800
v_mfma_f32_16x16x32_bf16 v[200:203], a[80:83], a[48:51], v[200:203]
buffer_store_dwordx4 a[172:175], v16, s[88:91], s8 offen sc1
v_mfma_f32_16x16x32_bf16 v[200:203], a[84:87], a[68:71], v[200:203]
v_add_u32 v12, 0xffff0000, v12
v_add_u32 v13, 0xffff0000, v13
v_mfma_f32_16x16x32_bf16 v[208:211], a[84:87], a[72:75], v[208:211]
v_add_u32 v14, 0xffff0000, v14
v_add_u32 v15, 0xffff0000, v15
v_mfma_f32_16x16x32_bf16 v[208:211], a[80:83], a[52:55], v[208:211]
v_add_u32 v10, 0xffff0000, v10
v_add_u32 v11, 0xffff0000, v11
v_mfma_f32_16x16x32_bf16 v[248:251], a[80:83], a[56:59], v[248:251]
v_lshl_add_u32 v22, s42, 7, v22
v_lshl_add_u32 v23, s42, 7, v23
v_mfma_f32_16x16x32_bf16 v[248:251], a[84:87], a[76:79], v[248:251]
v_mfma_f32_16x16x32_bf16 v[212:215], a[88:91], a[52:55], v[212:215]
s_waitcnt vmcnt(30) lgkmcnt(0)
v_mfma_f32_16x16x32_bf16 v[212:215], a[92:95], a[72:75], v[212:215]
s_barrier
s_add_u32 m0, s17, 0x10000
v_mfma_f32_16x16x32_bf16 v[204:207], a[92:95], a[68:71], v[204:207]
buffer_load_dwordx4 v5, s[52:55], 0 offen lds
v_mfma_f32_16x16x32_bf16 v[204:207], a[88:91], a[48:51], v[204:207]
ds_read_b64_tr_b16 a[80:81], v12 offset:0
v_mfma_f32_16x16x32_bf16 v[196:199], a[88:91], a[44:47], v[196:199]
ds_read_b64_tr_b16 a[82:83], v12 offset:1024
v_mfma_f32_16x16x32_bf16 v[196:199], a[92:95], a[64:67], v[196:199]
ds_read_b64_tr_b16 a[84:85], v12 offset:8192
s_waitcnt lgkmcnt(3)
v_mfma_f32_16x16x32_bf16 v[188:191], a[92:95], a[60:63], v[188:191]
ds_read_b64_tr_b16 a[86:87], v12 offset:9216
s_add_u32 m0, s17, 0x10400
v_mfma_f32_16x16x32_bf16 v[188:191], a[88:91], a[40:43], v[188:191]
buffer_load_dwordx4 v5, s[52:55], s13 offen lds
v_mfma_f32_16x16x32_bf16 v[216:219], a[40:43], a[96:99], v[216:219]
ds_read_b64_tr_b16 a[88:89], v13 offset:0
v_mfma_f32_16x16x32_bf16 v[216:219], a[60:63], a[100:103], v[216:219]
ds_read_b64_tr_b16 a[90:91], v13 offset:1024
v_mfma_f32_16x16x32_bf16 v[224:227], a[64:67], a[100:103], v[224:227]
ds_read_b64_tr_b16 a[92:93], v13 offset:8192
v_mfma_f32_16x16x32_bf16 v[224:227], a[44:47], a[96:99], v[224:227]
ds_read_b64_tr_b16 a[94:95], v13 offset:9216
v_mfma_f32_16x16x32_bf16 v[232:235], a[48:51], a[96:99], v[232:235]
s_add_u32 m0, s17, 0x10800
v_mfma_f32_16x16x32_bf16 v[232:235], a[68:71], a[100:103], v[232:235]
buffer_load_dwordx4 v6, s[52:55], 0 offen lds
v_mfma_f32_16x16x32_bf16 v[240:243], a[72:75], a[100:103], v[240:243]
v_mfma_f32_16x16x32_bf16 v[240:243], a[52:55], a[96:99], v[240:243]
v_mfma_f32_16x16x32_bf16 v[252:255], a[56:59], a[96:99], v[252:255]
v_mfma_f32_16x16x32_bf16 v[252:255], a[76:79], a[100:103], v[252:255]
v_mfma_f32_16x16x32_bf16 v[244:247], a[52:55], a[104:107], v[244:247]
ds_read_b64_tr_b16 a[96:97], v12 offset:256
s_add_u32 m0, s17, 0x10c00
v_mfma_f32_16x16x32_bf16 v[244:247], a[72:75], a[108:111], v[244:247]
buffer_load_dwordx4 v6, s[52:55], s13 offen lds
v_mfma_f32_16x16x32_bf16 v[236:239], a[68:71], a[108:111], v[236:239]
ds_read_b64_tr_b16 a[98:99], v12 offset:1280
v_mfma_f32_16x16x32_bf16 v[236:239], a[48:51], a[104:107], v[236:239]
ds_read_b64_tr_b16 a[100:101], v12 offset:8448
v_mfma_f32_16x16x32_bf16 v[228:231], a[44:47], a[104:107], v[228:231]
ds_read_b64_tr_b16 a[102:103], v12 offset:9472
v_mfma_f32_16x16x32_bf16 v[228:231], a[64:67], a[108:111], v[228:231]
s_add_u32 s8, s28, 0x2c00
v_mfma_f32_16x16x32_bf16 v[220:223], a[60:63], a[108:111], v[220:223]
buffer_store_dwordx4 a[176:179], v16, s[88:91], s8 offen sc1
v_mfma_f32_16x16x32_bf16 v[220:223], a[40:43], a[104:107], v[220:223]
s_waitcnt lgkmcnt(4)
L_S12:
v_mfma_f32_16x16x32_bf16 v[24:27], a[80:83], a[0:3], v[24:27]
ds_read_b64_tr_b16 a[104:105], v13 offset:256
s_waitcnt vmcnt(25)
v_mfma_f32_16x16x32_bf16 v[24:27], a[84:87], a[20:23], v[24:27]
ds_read_b64_tr_b16 a[106:107], v13 offset:1280
v_mfma_f32_16x16x32_bf16 v[32:35], a[84:87], a[24:27], v[32:35]
ds_read_b64_tr_b16 a[108:109], v13 offset:8448
v_mfma_f32_16x16x32_bf16 v[32:35], a[80:83], a[4:7], v[32:35]
ds_read_b64_tr_b16 a[110:111], v13 offset:9472
s_add_u32 m0, s18, 0x14000
v_mfma_f32_16x16x32_bf16 v[40:43], a[80:83], a[8:11], v[40:43]
buffer_load_dwordx4 v7, s[68:71], 0 offen lds
v_mfma_f32_16x16x32_bf16 v[40:43], a[84:87], a[28:31], v[40:43]
ds_read_b128 a[40:43], v8 offset:32768
v_mfma_f32_16x16x32_bf16 v[48:51], a[84:87], a[32:35], v[48:51]
ds_read_b128 a[60:63], v9 offset:32768
v_mfma_f32_16x16x32_bf16 v[48:51], a[80:83], a[12:15], v[48:51]
ds_read_b128 a[44:47], v8 offset:34816
v_mfma_f32_16x16x32_bf16 v[52:55], a[88:91], a[12:15], v[52:55]
ds_read_b64_tr_b16 a[80:81], v12 offset:512
v_mfma_f32_16x16x32_bf16 v[52:55], a[92:95], a[32:35], v[52:55]
ds_read_b64_tr_b16 a[82:83], v12 offset:1536
s_add_u32 m0, s18, 0x15000
v_mfma_f32_16x16x32_bf16 v[44:47], a[92:95], a[28:31], v[44:47]
buffer_load_dwordx4 v7, s[68:71], s25 offen lds
v_mfma_f32_16x16x32_bf16 v[44:47], a[88:91], a[8:11], v[44:47]
ds_read_b64_tr_b16 a[84:85], v12 offset:8704
v_mfma_f32_16x16x32_bf16 v[36:39], a[88:91], a[4:7], v[36:39]
ds_read_b64_tr_b16 a[86:87], v12 offset:9728
v_mfma_f32_16x16x32_bf16 v[36:39], a[92:95], a[24:27], v[36:39]
ds_read_b128 a[64:67], v9 offset:34816
s_waitcnt lgkmcnt(8)
v_mfma_f32_16x16x32_bf16 v[28:31], a[92:95], a[20:23], v[28:31]
ds_read_b128 a[48:51], v8 offset:36864
s_add_u32 m0, s18, 0x16000
v_mfma_f32_16x16x32_bf16 v[28:31], a[88:91], a[0:3], v[28:31]
buffer_load_dwordx4 v7, s[68:71], s26 offen lds
v_mfma_f32_16x16x32_bf16 v[56:59], a[96:99], a[0:3], v[56:59]
ds_read_b64_tr_b16 a[88:89], v13 offset:512
v_mfma_f32_16x16x32_bf16 v[56:59], a[100:103], a[20:23], v[56:59]
ds_read_b64_tr_b16 a[90:91], v13 offset:1536
v_mfma_f32_16x16x32_bf16 v[64:67], a[100:103], a[24:27], v[64:67]
ds_read_b64_tr_b16 a[92:93], v13 offset:8704
v_mfma_f32_16x16x32_bf16 v[64:67], a[96:99], a[4:7], v[64:67]
ds_read_b64_tr_b16 a[94:95], v13 offset:9728
v_mfma_f32_16x16x32_bf16 v[72:75], a[96:99], a[8:11], v[72:75]
ds_read_b128 a[68:71], v9 offset:36864
s_add_u32 m0, s18, 0x17000
v_mfma_f32_16x16x32_bf16 v[72:75], a[100:103], a[28:31], v[72:75]
buffer_load_dwordx4 v4, s[44:47], s24 offen lds
v_mfma_f32_16x16x32_bf16 v[80:83], a[100:103], a[32:35], v[80:83]
ds_read_b128 a[52:55], v8 offset:38912
v_lshl_add_u32 v5, s42, 19, v5
v_mfma_f32_16x16x32_bf16 v[80:83], a[96:99], a[12:15], v[80:83]
ds_read_b128 a[72:75], v9 offset:38912
v_lshl_add_u32 v6, s42, 19, v6
v_mfma_f32_16x16x32_bf16 v[84:87], a[104:107], a[12:15], v[84:87]
ds_read_b64_tr_b16 a[96:97], v12 offset:768
v_lshl_add_u32 v7, s42, 18, v7
v_mfma_f32_16x16x32_bf16 v[84:87], a[108:111], a[32:35], v[84:87]
ds_read_b64_tr_b16 a[98:99], v12 offset:1792
v_lshl_add_u32 v7, s42, 17, v7
v_mfma_f32_16x16x32_bf16 v[76:79], a[108:111], a[28:31], v[76:79]
ds_read_b64_tr_b16 a[100:101], v12 offset:8960
s_add_u32 s8, s28, 0x3c00
v_mfma_f32_16x16x32_bf16 v[76:79], a[104:107], a[8:11], v[76:79]
buffer_store_dwordx4 a[180:183], v16, s[88:91], s8 offen sc1
v_mfma_f32_16x16x32_bf16 v[68:71], a[104:107], a[4:7], v[68:71]
ds_read_b64_tr_b16 a[102:103], v12 offset:9984
v_lshl_add_u32 v4, s42, 7, v4
v_mfma_f32_16x16x32_bf16 v[68:71], a[108:111], a[24:27], v[68:71]
ds_read_b128 a[16:19], v10
v_mfma_f32_16x16x32_bf16 v[60:63], a[108:111], a[20:23], v[60:63]
ds_read_b128 a[36:39], v11
v_mfma_f32_16x16x32_bf16 v[60:63], a[104:107], a[0:3], v[60:63]
s_waitcnt lgkmcnt(6)
s_waitcnt lgkmcnt(9)
v_mfma_f32_16x16x32_bf16 v[88:91], a[80:83], a[0:3], v[88:91]
ds_read_b64_tr_b16 a[104:105], v13 offset:768
s_add_u32 m0, s16, 0x8000
v_mfma_f32_16x16x32_bf16 v[88:91], a[84:87], a[20:23], v[88:91]
buffer_load_dwordx4 v22, s[44:47], s20 offen lds
v_mfma_f32_16x16x32_bf16 v[96:99], a[84:87], a[24:27], v[96:99]
ds_read_b64_tr_b16 a[106:107], v13 offset:1792
v_mfma_f32_16x16x32_bf16 v[96:99], a[80:83], a[4:7], v[96:99]
ds_read_b64_tr_b16 a[108:109], v13 offset:8960
v_mfma_f32_16x16x32_bf16 v[104:107], a[80:83], a[8:11], v[104:107]
ds_read_b64_tr_b16 a[110:111], v13 offset:9984
v_mfma_f32_16x16x32_bf16 v[104:107], a[84:87], a[28:31], v[104:107]
s_add_u32 m0, s16, 0x8400
v_mfma_f32_16x16x32_bf16 v[112:115], a[84:87], a[32:35], v[112:115]
buffer_load_dwordx4 v23, s[44:47], s20 offen lds
v_mfma_f32_16x16x32_bf16 v[112:115], a[80:83], a[12:15], v[112:115]
v_mfma_f32_16x16x32_bf16 v[116:119], a[88:91], a[12:15], v[116:119]
ds_read_b64_tr_b16 a[80:81], v14 offset:0
v_mfma_f32_16x16x32_bf16 v[116:119], a[92:95], a[32:35], v[116:119]
ds_read_b64_tr_b16 a[82:83], v14 offset:256
v_mfma_f32_16x16x32_bf16 v[108:111], a[92:95], a[28:31], v[108:111]
ds_read_b64_tr_b16 a[84:85], v14 offset:2048
v_mfma_f32_16x16x32_bf16 v[108:111], a[88:91], a[8:11], v[108:111]
ds_read_b64_tr_b16 a[86:87], v14 offset:2304
s_add_u32 m0, s16, 0x8800
v_mfma_f32_16x16x32_bf16 v[100:103], a[88:91], a[4:7], v[100:103]
buffer_load_dwordx4 v22, s[44:47], s21 offen lds
v_mfma_f32_16x16x32_bf16 v[100:103], a[92:95], a[24:27], v[100:103]
v_mfma_f32_16x16x32_bf16 v[92:95], a[92:95], a[20:23], v[92:95]
v_mfma_f32_16x16x32_bf16 v[92:95], a[88:91], a[0:3], v[92:95]
s_waitcnt lgkmcnt(4)
v_mfma_f32_16x16x32_bf16 v[120:123], a[96:99], a[0:3], v[120:123]
ds_read_b64_tr_b16 a[88:89], v15 offset:0
v_mfma_f32_16x16x32_bf16 v[120:123], a[100:103], a[20:23], v[120:123]
ds_read_b64_tr_b16 a[90:91], v15 offset:256
s_add_u32 m0, s16, 0x8c00
v_mfma_f32_16x16x32_bf16 v[128:131], a[100:103], a[24:27], v[128:131]
buffer_load_dwordx4 v23, s[44:47], s21 offen lds
v_mfma_f32_16x16x32_bf16 v[128:131], a[96:99], a[4:7], v[128:131]
ds_read_b64_tr_b16 a[92:93], v15 offset:2048
v_mfma_f32_16x16x32_bf16 v[136:139], a[96:99], a[8:11], v[136:139]
ds_read_b64_tr_b16 a[94:95], v15 offset:2304
v_mfma_f32_16x16x32_bf16 v[136:139], a[100:103], a[28:31], v[136:139]
v_mfma_f32_16x16x32_bf16 v[144:147], a[100:103], a[32:35], v[144:147]
s_add_u32 s8, s28, 0x6c00
v_mfma_f32_16x16x32_bf16 v[144:147], a[96:99], a[12:15], v[144:147]
buffer_store_dwordx4 a[184:187], v16, s[88:91], s8 offen sc1
v_mfma_f32_16x16x32_bf16 v[148:151], a[104:107], a[12:15], v[148:151]
ds_read_b64_tr_b16 a[96:97], v14 offset:4096
v_mfma_f32_16x16x32_bf16 v[148:151], a[108:111], a[32:35], v[148:151]
ds_read_b64_tr_b16 a[98:99], v14 offset:4352
v_mfma_f32_16x16x32_bf16 v[140:143], a[108:111], a[28:31], v[140:143]
ds_read_b64_tr_b16 a[100:101], v14 offset:6144
v_mfma_f32_16x16x32_bf16 v[140:143], a[104:107], a[8:11], v[140:143]
ds_read_b64_tr_b16 a[102:103], v14 offset:6400
v_mfma_f32_16x16x32_bf16 v[132:135], a[104:107], a[4:7], v[132:135]
s_add_u32 m0, s16, 0x9000
v_mfma_f32_16x16x32_bf16 v[132:135], a[108:111], a[24:27], v[132:135]
buffer_load_dwordx4 v22, s[44:47], s22 offen lds
v_mfma_f32_16x16x32_bf16 v[124:127], a[108:111], a[20:23], v[124:127]
v_mfma_f32_16x16x32_bf16 v[124:127], a[104:107], a[0:3], v[124:127]
s_waitcnt lgkmcnt(4)
v_mfma_f32_16x16x32_bf16 v[152:155], a[80:83], a[0:3], v[152:155]
ds_read_b64_tr_b16 a[104:105], v15 offset:4096
v_mfma_f32_16x16x32_bf16 v[152:155], a[84:87], a[20:23], v[152:155]
ds_read_b64_tr_b16 a[106:107], v15 offset:4352
v_mfma_f32_16x16x32_bf16 v[160:163], a[84:87], a[24:27], v[160:163]
ds_read_b64_tr_b16 a[108:109], v15 offset:6144
s_add_u32 m0, s16, 0x9400
v_mfma_f32_16x16x32_bf16 v[160:163], a[80:83], a[4:7], v[160:163]
buffer_load_dwordx4 v23, s[44:47], s22 offen lds
v_mfma_f32_16x16x32_bf16 v[168:171], a[80:83], a[8:11], v[168:171]
ds_read_b64_tr_b16 a[110:111], v15 offset:6400
v_mfma_f32_16x16x32_bf16 v[168:171], a[84:87], a[28:31], v[168:171]
v_mfma_f32_16x16x32_bf16 v[176:179], a[84:87], a[32:35], v[176:179]
v_mfma_f32_16x16x32_bf16 v[176:179], a[80:83], a[12:15], v[176:179]
s_add_u32 m0, s16, 0x9800
v_mfma_f32_16x16x32_bf16 v[180:183], a[88:91], a[12:15], v[180:183]
buffer_load_dwordx4 v22, s[44:47], s23 offen lds
v_mfma_f32_16x16x32_bf16 v[180:183], a[92:95], a[32:35], v[180:183]
ds_read_b64_tr_b16 a[80:81], v14 offset:8192
v_mfma_f32_16x16x32_bf16 v[172:175], a[92:95], a[28:31], v[172:175]
ds_read_b64_tr_b16 a[82:83], v14 offset:8448
v_mfma_f32_16x16x32_bf16 v[172:175], a[88:91], a[8:11], v[172:175]
ds_read_b64_tr_b16 a[84:85], v14 offset:10240
v_mfma_f32_16x16x32_bf16 v[164:167], a[88:91], a[4:7], v[164:167]
ds_read_b64_tr_b16 a[86:87], v14 offset:10496
v_mfma_f32_16x16x32_bf16 v[164:167], a[92:95], a[24:27], v[164:167]
s_add_u32 m0, s16, 0x9c00
v_mfma_f32_16x16x32_bf16 v[156:159], a[92:95], a[20:23], v[156:159]
buffer_load_dwordx4 v23, s[44:47], s23 offen lds
v_mfma_f32_16x16x32_bf16 v[156:159], a[88:91], a[0:3], v[156:159]
s_waitcnt lgkmcnt(4)
s_bfe_u32 s39, s40, 0x80000
s_add_u32 s39, s39, s41
v_mfma_f32_16x16x32_bf16 v[184:187], a[96:99], a[0:3], v[184:187]
ds_read_b64_tr_b16 a[88:89], v15 offset:8192
s_and_b32 s39, s39, 15
v_mfma_f32_16x16x32_bf16 v[184:187], a[100:103], a[20:23], v[184:187]
ds_read_b64_tr_b16 a[90:91], v15 offset:8448
s_sub_u32 s42, s39, s41
v_mfma_f32_16x16x32_bf16 v[192:195], a[100:103], a[24:27], v[192:195]
ds_read_b64_tr_b16 a[92:93], v15 offset:10240
s_mov_b32 s41, s39
v_mfma_f32_16x16x32_bf16 v[192:195], a[96:99], a[4:7], v[192:195]
ds_read_b64_tr_b16 a[94:95], v15 offset:10496
s_add_u32 s8, s28, 0x7c00
v_mfma_f32_16x16x32_bf16 v[200:203], a[96:99], a[8:11], v[200:203]
buffer_store_dwordx4 a[188:191], v16, s[88:91], s8 offen sc1
v_mfma_f32_16x16x32_bf16 v[200:203], a[100:103], a[28:31], v[200:203]
v_add_u32 v12, 0x8000, v12
v_add_u32 v13, 0x8000, v13
v_mfma_f32_16x16x32_bf16 v[208:211], a[100:103], a[32:35], v[208:211]
v_add_u32 v14, 0x8000, v14
v_add_u32 v15, 0x8000, v15
v_mfma_f32_16x16x32_bf16 v[208:211], a[96:99], a[12:15], v[208:211]
v_add_u32 v10, 0x8000, v10
v_add_u32 v11, 0x8000, v11
v_mfma_f32_16x16x32_bf16 v[248:251], a[96:99], a[16:19], v[248:251]
v_lshl_add_u32 v22, s42, 7, v22
v_lshl_add_u32 v23, s42, 7, v23
v_mfma_f32_16x16x32_bf16 v[248:251], a[100:103], a[36:39], v[248:251]
v_mfma_f32_16x16x32_bf16 v[212:215], a[104:107], a[12:15], v[212:215]
s_waitcnt vmcnt(30) lgkmcnt(0)
v_mfma_f32_16x16x32_bf16 v[212:215], a[108:111], a[32:35], v[212:215]
s_barrier
s_add_u32 m0, s17, 0x0
v_mfma_f32_16x16x32_bf16 v[204:207], a[108:111], a[28:31], v[204:207]
buffer_load_dwordx4 v5, s[52:55], 0 offen lds
v_mfma_f32_16x16x32_bf16 v[204:207], a[104:107], a[8:11], v[204:207]
ds_read_b64_tr_b16 a[96:97], v12 offset:0
v_mfma_f32_16x16x32_bf16 v[196:199], a[104:107], a[4:7], v[196:199]
ds_read_b64_tr_b16 a[98:99], v12 offset:1024
v_mfma_f32_16x16x32_bf16 v[196:199], a[108:111], a[24:27], v[196:199]
ds_read_b64_tr_b16 a[100:101], v12 offset:8192
v_mfma_f32_16x16x32_bf16 v[188:191], a[108:111], a[20:23], v[188:191]
ds_read_b64_tr_b16 a[102:103], v12 offset:9216
v_mfma_f32_16x16x32_bf16 v[188:191], a[104:107], a[0:3], v[188:191]
s_add_u32 m0, s17, 0x400
s_waitcnt lgkmcnt(4)
v_mfma_f32_16x16x32_bf16 v[216:219], a[0:3], a[80:83], v[216:219]
buffer_load_dwordx4 v5, s[52:55], s13 offen lds
v_mfma_f32_16x16x32_bf16 v[216:219], a[20:23], a[84:87], v[216:219]
ds_read_b64_tr_b16 a[104:105], v13 offset:0
v_mfma_f32_16x16x32_bf16 v[224:227], a[24:27], a[84:87], v[224:227]
ds_read_b64_tr_b16 a[106:107], v13 offset:1024
v_mfma_f32_16x16x32_bf16 v[224:227], a[4:7], a[80:83], v[224:227]
ds_read_b64_tr_b16 a[108:109], v13 offset:8192
v_mfma_f32_16x16x32_bf16 v[232:235], a[8:11], a[80:83], v[232:235]
ds_read_b64_tr_b16 a[110:111], v13 offset:9216
v_mfma_f32_16x16x32_bf16 v[232:235], a[28:31], a[84:87], v[232:235]
s_add_u32 m0, s17, 0x800
v_mfma_f32_16x16x32_bf16 v[240:243], a[32:35], a[84:87], v[240:243]
buffer_load_dwordx4 v6, s[52:55], 0 offen lds
v_mfma_f32_16x16x32_bf16 v[240:243], a[12:15], a[80:83], v[240:243]
v_mfma_f32_16x16x32_bf16 v[252:255], a[16:19], a[80:83], v[252:255]
v_mfma_f32_16x16x32_bf16 v[252:255], a[36:39], a[84:87], v[252:255]
v_mfma_f32_16x16x32_bf16 v[244:247], a[12:15], a[88:91], v[244:247]
ds_read_b64_tr_b16 a[80:81], v12 offset:256
v_mfma_f32_16x16x32_bf16 v[244:247], a[32:35], a[92:95], v[244:247]
ds_read_b64_tr_b16 a[82:83], v12 offset:1280
s_add_u32 m0, s17, 0xc00
v_mfma_f32_16x16x32_bf16 v[236:239], a[28:31], a[92:95], v[236:239]
buffer_load_dwordx4 v6, s[52:55], s13 offen lds
v_mfma_f32_16x16x32_bf16 v[236:239], a[8:11], a[88:91], v[236:239]
ds_read_b64_tr_b16 a[84:85], v12 offset:8448
v_mfma_f32_16x16x32_bf16 v[228:231], a[4:7], a[88:91], v[228:231]
ds_read_b64_tr_b16 a[86:87], v12 offset:9472
v_mfma_f32_16x16x32_bf16 v[228:231], a[24:27], a[92:95], v[228:231]
v_mfma_f32_16x16x32_bf16 v[220:223], a[20:23], a[92:95], v[220:223]
v_mfma_f32_16x16x32_bf16 v[220:223], a[0:3], a[88:91], v[220:223]
s_add_u32 m0, s18, 0x4000
s_waitcnt lgkmcnt(4)
L_S13:
v_mfma_f32_16x16x32_bf16 v[24:27], a[96:99], a[40:43], v[24:27]
buffer_load_dwordx4 v7, s[68:71], 0 offen lds
v_mfma_f32_16x16x32_bf16 v[24:27], a[100:103], a[60:63], v[24:27]
ds_read_b64_tr_b16 a[88:89], v13 offset:256
s_waitcnt vmcnt(26)
v_mfma_f32_16x16x32_bf16 v[32:35], a[100:103], a[64:67], v[32:35]
ds_read_b64_tr_b16 a[90:91], v13 offset:1280
v_mfma_f32_16x16x32_bf16 v[32:35], a[96:99], a[44:47], v[32:35]
ds_read_b64_tr_b16 a[92:93], v13 offset:8448
v_mfma_f32_16x16x32_bf16 v[40:43], a[96:99], a[48:51], v[40:43]
ds_read_b64_tr_b16 a[94:95], v13 offset:9472
v_mfma_f32_16x16x32_bf16 v[40:43], a[100:103], a[68:71], v[40:43]
ds_read_b128 a[0:3], v8 offset:0
s_add_u32 s8, s28, 0x4000
v_mfma_f32_16x16x32_bf16 v[48:51], a[100:103], a[72:75], v[48:51]
buffer_store_dwordx4 a[192:195], v16, s[88:91], s8 offen sc1
v_mfma_f32_16x16x32_bf16 v[48:51], a[96:99], a[52:55], v[48:51]
ds_read_b128 a[20:23], v9 offset:0
L_padA7:
s_cmp_eq_u32 s95, 1
s_cbranch_scc1 L_padA11
v_mfma_f32_16x16x32_bf16 v[52:55], a[104:107], a[52:55], v[52:55]
ds_read_b64_tr_b16 a[96:97], v12 offset:512
v_mfma_f32_16x16x32_bf16 v[52:55], a[108:111], a[72:75], v[52:55]
ds_read_b64_tr_b16 a[98:99], v12 offset:1536
v_mfma_f32_16x16x32_bf16 v[44:47], a[108:111], a[68:71], v[44:47]
ds_read_b64_tr_b16 a[100:101], v12 offset:8704
v_mfma_f32_16x16x32_bf16 v[44:47], a[104:107], a[48:51], v[44:47]
ds_read_b64_tr_b16 a[102:103], v12 offset:9728
s_add_u32 m0, s18, 0x5000
v_mfma_f32_16x16x32_bf16 v[36:39], a[104:107], a[44:47], v[36:39]
buffer_load_dwordx4 v7, s[68:71], s25 offen lds
v_mfma_f32_16x16x32_bf16 v[36:39], a[108:111], a[64:67], v[36:39]
ds_read_b128 a[4:7], v8 offset:2048
v_mfma_f32_16x16x32_bf16 v[28:31], a[108:111], a[60:63], v[28:31]
ds_read_b128 a[24:27], v9 offset:2048
v_mfma_f32_16x16x32_bf16 v[28:31], a[104:107], a[40:43], v[28:31]
ds_read_b128 a[8:11], v8 offset:4096
s_waitcnt lgkmcnt(9)
v_mfma_f32_16x16x32_bf16 v[56:59], a[80:83], a[40:43], v[56:59]
ds_read_b64_tr_b16 a[104:105], v13 offset:512
v_mfma_f32_16x16x32_bf16 v[56:59], a[84:87], a[60:63], v[56:59]
ds_read_b64_tr_b16 a[106:107], v13 offset:1536
s_add_u32 m0, s18, 0x6000
v_mfma_f32_16x16x32_bf16 v[64:67], a[84:87], a[64:67], v[64:67]
buffer_load_dwordx4 v7, s[68:71], s26 offen lds
v_mfma_f32_16x16x32_bf16 v[64:67], a[80:83], a[44:47], v[64:67]
ds_read_b64_tr_b16 a[108:109], v13 offset:8704
v_mfma_f32_16x16x32_bf16 v[72:75], a[80:83], a[48:51], v[72:75]
ds_read_b64_tr_b16 a[110:111], v13 offset:9728
v_mfma_f32_16x16x32_bf16 v[72:75], a[84:87], a[68:71], v[72:75]
ds_read_b128 a[28:31], v9 offset:4096
v_mfma_f32_16x16x32_bf16 v[80:83], a[84:87], a[72:75], v[80:83]
ds_read_b128 a[12:15], v8 offset:6144
v_mfma_f32_16x16x32_bf16 v[80:83], a[80:83], a[52:55], v[80:83]
ds_read_b128 a[32:35], v9 offset:6144
s_add_u32 m0, s18, 0x7000
v_mfma_f32_16x16x32_bf16 v[84:87], a[88:91], a[52:55], v[84:87]
buffer_load_dwordx4 v4, s[44:47], s24 offen lds
v_mfma_f32_16x16x32_bf16 v[84:87], a[92:95], a[72:75], v[84:87]
ds_read_b64_tr_b16 a[80:81], v12 offset:768
v_lshl_add_u32 v5, s42, 19, v5
v_mfma_f32_16x16x32_bf16 v[76:79], a[92:95], a[68:71], v[76:79]
ds_read_b64_tr_b16 a[82:83], v12 offset:1792
v_lshl_add_u32 v6, s42, 19, v6
v_mfma_f32_16x16x32_bf16 v[76:79], a[88:91], a[48:51], v[76:79]
ds_read_b64_tr_b16 a[84:85], v12 offset:8960
v_lshl_add_u32 v7, s42, 18, v7
v_mfma_f32_16x16x32_bf16 v[68:71], a[88:91], a[44:47], v[68:71]
ds_read_b64_tr_b16 a[86:87], v12 offset:9984
s_waitcnt lgkmcnt(4)
v_mfma_f32_16x16x32_bf16 v[68:71], a[92:95], a[64:67], v[68:71]
ds_read_b128 a[56:59], v10
s_add_u32 m0, s16, 0x0
v_mfma_f32_16x16x32_bf16 v[60:63], a[92:95], a[60:63], v[60:63]
buffer_load_dwordx4 v22, s[44:47], s20 offen lds
v_mfma_f32_16x16x32_bf16 v[60:63], a[88:91], a[40:43], v[60:63]
ds_read_b128 a[76:79], v11
s_waitcnt lgkmcnt(9)
v_mfma_f32_16x16x32_bf16 v[88:91], a[96:99], a[40:43], v[88:91]
ds_read_b64_tr_b16 a[88:89], v13 offset:768
v_lshl_add_u32 v7, s42, 17, v7
v_mfma_f32_16x16x32_bf16 v[88:91], a[100:103], a[60:63], v[88:91]
ds_read_b64_tr_b16 a[90:91], v13 offset:1792
v_lshl_add_u32 v4, s42, 7, v4
v_mfma_f32_16x16x32_bf16 v[96:99], a[100:103], a[64:67], v[96:99]
ds_read_b64_tr_b16 a[92:93], v13 offset:8960
v_mfma_f32_16x16x32_bf16 v[96:99], a[96:99], a[44:47], v[96:99]
ds_read_b64_tr_b16 a[94:95], v13 offset:9984
s_add_u32 m0, s16, 0x400
v_mfma_f32_16x16x32_bf16 v[104:107], a[96:99], a[48:51], v[104:107]
buffer_load_dwordx4 v23, s[44:47], s20 offen lds
v_mfma_f32_16x16x32_bf16 v[104:107], a[100:103], a[68:71], v[104:107]
v_mfma_f32_16x16x32_bf16 v[112:115], a[100:103], a[72:75], v[112:115]
v_mfma_f32_16x16x32_bf16 v[112:115], a[96:99], a[52:55], v[112:115]
v_mfma_f32_16x16x32_bf16 v[116:119], a[104:107], a[52:55], v[116:119]
ds_read_b64_tr_b16 a[96:97], v14 offset:0
v_mfma_f32_16x16x32_bf16 v[116:119], a[108:111], a[72:75], v[116:119]
ds_read_b64_tr_b16 a[98:99], v14 offset:256
s_add_u32 s8, s28, 0x8000
v_mfma_f32_16x16x32_bf16 v[108:111], a[108:111], a[68:71], v[108:111]
buffer_store_dwordx4 a[196:199], v16, s[88:91], s8 offen sc1
v_mfma_f32_16x16x32_bf16 v[108:111], a[104:107], a[48:51], v[108:111]
ds_read_b64_tr_b16 a[100:101], v14 offset:2048
v_mfma_f32_16x16x32_bf16 v[100:103], a[104:107], a[44:47], v[100:103]
ds_read_b64_tr_b16 a[102:103], v14 offset:2304
v_mfma_f32_16x16x32_bf16 v[100:103], a[108:111], a[64:67], v[100:103]
v_mfma_f32_16x16x32_bf16 v[92:95], a[108:111], a[60:63], v[92:95]
v_mfma_f32_16x16x32_bf16 v[92:95], a[104:107], a[40:43], v[92:95]
s_add_u32 m0, s16, 0x800
s_waitcnt lgkmcnt(4)
v_mfma_f32_16x16x32_bf16 v[120:123], a[80:83], a[40:43], v[120:123]
buffer_load_dwordx4 v22, s[44:47], s21 offen lds
v_mfma_f32_16x16x32_bf16 v[120:123], a[84:87], a[60:63], v[120:123]
ds_read_b64_tr_b16 a[104:105], v15 offset:0
v_mfma_f32_16x16x32_bf16 v[128:131], a[84:87], a[64:67], v[128:131]
ds_read_b64_tr_b16 a[106:107], v15 offset:256
v_mfma_f32_16x16x32_bf16 v[128:131], a[80:83], a[44:47], v[128:131]
ds_read_b64_tr_b16 a[108:109], v15 offset:2048
v_mfma_f32_16x16x32_bf16 v[136:139], a[80:83], a[48:51], v[136:139]
ds_read_b64_tr_b16 a[110:111], v15 offset:2304
v_mfma_f32_16x16x32_bf16 v[136:139], a[84:87], a[68:71], v[136:139]
s_add_u32 m0, s16, 0xc00
v_mfma_f32_16x16x32_bf16 v[144:147], a[84:87], a[72:75], v[144:147]
buffer_load_dwordx4 v23, s[44:47], s21 offen lds
v_mfma_f32_16x16x32_bf16 v[144:147], a[80:83], a[52:55], v[144:147]
v_mfma_f32_16x16x32_bf16 v[148:151], a[88:91], a[52:55], v[148:151]
ds_read_b64_tr_b16 a[80:81], v14 offset:4096
v_mfma_f32_16x16x32_bf16 v[148:151], a[92:95], a[72:75], v[148:151]
ds_read_b64_tr_b16 a[82:83], v14 offset:4352
v_mfma_f32_16x16x32_bf16 v[140:143], a[92:95], a[68:71], v[140:143]
ds_read_b64_tr_b16 a[84:85], v14 offset:6144
v_mfma_f32_16x16x32_bf16 v[140:143], a[88:91], a[48:51], v[140:143]
ds_read_b64_tr_b16 a[86:87], v14 offset:6400
s_add_u32 m0, s16, 0x1000
v_mfma_f32_16x16x32_bf16 v[132:135], a[88:91], a[44:47], v[132:135]
buffer_load_dwordx4 v22, s[44:47], s22 offen lds
v_mfma_f32_16x16x32_bf16 v[132:135], a[92:95], a[64:67], v[132:135]
v_mfma_f32_16x16x32_bf16 v[124:127], a[92:95], a[60:63], v[124:127]
v_mfma_f32_16x16x32_bf16 v[124:127], a[88:91], a[40:43], v[124:127]
s_waitcnt lgkmcnt(4)
v_mfma_f32_16x16x32_bf16 v[152:155], a[96:99], a[40:43], v[152:155]
ds_read_b64_tr_b16 a[88:89], v15 offset:4096
v_mfma_f32_16x16x32_bf16 v[152:155], a[100:103], a[60:63], v[152:155]
ds_read_b64_tr_b16 a[90:91], v15 offset:4352
s_add_u32 m0, s16, 0x1400
v_mfma_f32_16x16x32_bf16 v[160:163], a[100:103], a[64:67], v[160:163]
buffer_load_dwordx4 v23, s[44:47], s22 offen lds
v_mfma_f32_16x16x32_bf16 v[160:163], a[96:99], a[44:47], v[160:163]
ds_read_b64_tr_b16 a[92:93], v15 offset:6144
v_mfma_f32_16x16x32_bf16 v[168:171], a[96:99], a[48:51], v[168:171]
ds_read_b64_tr_b16 a[94:95], v15 offset:6400
v_mfma_f32_16x16x32_bf16 v[168:171], a[100:103], a[68:71], v[168:171]
v_mfma_f32_16x16x32_bf16 v[176:179], a[100:103], a[72:75], v[176:179]
v_mfma_f32_16x16x32_bf16 v[176:179], a[96:99], a[52:55], v[176:179]
s_add_u32 m0, s16, 0x1800
v_mfma_f32_16x16x32_bf16 v[180:183], a[104:107], a[52:55], v[180:183]
buffer_load_dwordx4 v22, s[44:47], s23 offen lds
v_mfma_f32_16x16x32_bf16 v[180:183], a[108:111], a[72:75], v[180:183]
ds_read_b64_tr_b16 a[96:97], v14 offset:8192
v_mfma_f32_16x16x32_bf16 v[172:175], a[108:111], a[68:71], v[172:175]
ds_read_b64_tr_b16 a[98:99], v14 offset:8448
v_mfma_f32_16x16x32_bf16 v[172:175], a[104:107], a[48:51], v[172:175]
ds_read_b64_tr_b16 a[100:101], v14 offset:10240
v_mfma_f32_16x16x32_bf16 v[164:167], a[104:107], a[44:47], v[164:167]
ds_read_b64_tr_b16 a[102:103], v14 offset:10496
v_mfma_f32_16x16x32_bf16 v[164:167], a[108:111], a[64:67], v[164:167]
s_add_u32 m0, s16, 0x1c00
v_mfma_f32_16x16x32_bf16 v[156:159], a[108:111], a[60:63], v[156:159]
buffer_load_dwordx4 v23, s[44:47], s23 offen lds
v_mfma_f32_16x16x32_bf16 v[156:159], a[104:107], a[40:43], v[156:159]
s_waitcnt lgkmcnt(4)
s_bfe_u32 s39, s40, 0x80008
s_add_u32 s39, s39, s41
v_mfma_f32_16x16x32_bf16 v[184:187], a[80:83], a[40:43], v[184:187]
ds_read_b64_tr_b16 a[104:105], v15 offset:8192
s_and_b32 s39, s39, 15
v_mfma_f32_16x16x32_bf16 v[184:187], a[84:87], a[60:63], v[184:187]
ds_read_b64_tr_b16 a[106:107], v15 offset:8448
s_sub_u32 s42, s39, s41
v_mfma_f32_16x16x32_bf16 v[192:195], a[84:87], a[64:67], v[192:195]
ds_read_b64_tr_b16 a[108:109], v15 offset:10240
s_mov_b32 s41, s39
v_mfma_f32_16x16x32_bf16 v[192:195], a[80:83], a[44:47], v[192:195]
ds_read_b64_tr_b16 a[110:111], v15 offset:10496
s_add_u32 s8, s28, 0x4400
v_mfma_f32_16x16x32_bf16 v[200:203], a[80:83], a[48:51], v[200:203]
buffer_store_dwordx4 a[200:203], v16, s[88:91], s8 offen sc1
v_mfma_f32_16x16x32_bf16 v[200:203], a[84:87], a[68:71], v[200:203]
v_add_u32 v12, 0x8000, v12
v_add_u32 v13, 0x8000, v13
v_mfma_f32_16x16x32_bf16 v[208:211], a[84:87], a[72:75], v[208:211]
v_add_u32 v14, 0x8000, v14
v_add_u32 v15, 0x8000, v15
v_mfma_f32_16x16x32_bf16 v[208:211], a[80:83], a[52:55], v[208:211]
v_add_u32 v10, 0x8000, v10
v_add_u32 v11, 0x8000, v11
v_mfma_f32_16x16x32_bf16 v[248:251], a[80:83], a[56:59], v[248:251]
v_lshl_add_u32 v22, s42, 7, v22
v_lshl_add_u32 v23, s42, 7, v23
v_mfma_f32_16x16x32_bf16 v[248:251], a[84:87], a[76:79], v[248:251]
v_mfma_f32_16x16x32_bf16 v[212:215], a[88:91], a[52:55], v[212:215]
s_waitcnt vmcnt(30) lgkmcnt(0)
v_mfma_f32_16x16x32_bf16 v[212:215], a[92:95], a[72:75], v[212:215]
s_barrier
s_add_u32 m0, s17, 0x8000
v_mfma_f32_16x16x32_bf16 v[204:207], a[92:95], a[68:71], v[204:207]
buffer_load_dwordx4 v5, s[52:55], 0 offen lds
v_mfma_f32_16x16x32_bf16 v[204:207], a[88:91], a[48:51], v[204:207]
ds_read_b64_tr_b16 a[80:81], v12 offset:0
v_mfma_f32_16x16x32_bf16 v[196:199], a[88:91], a[44:47], v[196:199]
ds_read_b64_tr_b16 a[82:83], v12 offset:1024
v_mfma_f32_16x16x32_bf16 v[196:199], a[92:95], a[64:67], v[196:199]
ds_read_b64_tr_b16 a[84:85], v12 offset:8192
s_waitcnt lgkmcnt(3)
v_mfma_f32_16x16x32_bf16 v[188:191], a[92:95], a[60:63], v[188:191]
ds_read_b64_tr_b16 a[86:87], v12 offset:9216
s_add_u32 m0, s17, 0x8400
v_mfma_f32_16x16x32_bf16 v[188:191], a[88:91], a[40:43], v[188:191]
buffer_load_dwordx4 v5, s[52:55], s13 offen lds
v_mfma_f32_16x16x32_bf16 v[216:219], a[40:43], a[96:99], v[216:219]
ds_read_b64_tr_b16 a[88:89], v13 offset:0
v_mfma_f32_16x16x32_bf16 v[216:219], a[60:63], a[100:103], v[216:219]
ds_read_b64_tr_b16 a[90:91], v13 offset:1024
v_mfma_f32_16x16x32_bf16 v[224:227], a[64:67], a[100:103], v[224:227]
ds_read_b64_tr_b16 a[92:93], v13 offset:8192
v_mfma_f32_16x16x32_bf16 v[224:227], a[44:47], a[96:99], v[224:227]
ds_read_b64_tr_b16 a[94:95], v13 offset:9216
v_mfma_f32_16x16x32_bf16 v[232:235], a[48:51], a[96:99], v[232:235]
s_add_u32 m0, s17, 0x8800
v_mfma_f32_16x16x32_bf16 v[232:235], a[68:71], a[100:103], v[232:235]
buffer_load_dwordx4 v6, s[52:55], 0 offen lds
v_mfma_f32_16x16x32_bf16 v[240:243], a[72:75], a[100:103], v[240:243]
v_mfma_f32_16x16x32_bf16 v[240:243], a[52:55], a[96:99], v[240:243]
v_mfma_f32_16x16x32_bf16 v[252:255], a[56:59], a[96:99], v[252:255]
v_mfma_f32_16x16x32_bf16 v[252:255], a[76:79], a[100:103], v[252:255]
v_mfma_f32_16x16x32_bf16 v[244:247], a[52:55], a[104:107], v[244:247]
ds_read_b64_tr_b16 a[96:97], v12 offset:256
s_add_u32 m0, s17, 0x8c00
v_mfma_f32_16x16x32_bf16 v[244:247], a[72:75], a[108:111], v[244:247]
buffer_load_dwordx4 v6, s[52:55], s13 offen lds
v_mfma_f32_16x16x32_bf16 v[236:239], a[68:71], a[108:111], v[236:239]
ds_read_b64_tr_b16 a[98:99], v12 offset:1280
v_mfma_f32_16x16x32_bf16 v[236:239], a[48:51], a[104:107], v[236:239]
ds_read_b64_tr_b16 a[100:101], v12 offset:8448
v_mfma_f32_16x16x32_bf16 v[228:231], a[44:47], a[104:107], v[228:231]
ds_read_b64_tr_b16 a[102:103], v12 offset:9472
v_mfma_f32_16x16x32_bf16 v[228:231], a[64:67], a[108:111], v[228:231]
v_add_u32 v20, s0, v16
v_mov_b32 v21, s1
v_mfma_f32_16x16x32_bf16 v[220:223], a[60:63], a[108:111], v[220:223]
global_load_dword a120, v[20:21], off sc1
v_mfma_f32_16x16x32_bf16 v[220:223], a[40:43], a[104:107], v[220:223]
s_waitcnt lgkmcnt(4)
L_S14:
v_mfma_f32_16x16x32_bf16 v[24:27], a[80:83], a[0:3], v[24:27]
ds_read_b64_tr_b16 a[104:105], v13 offset:256
s_waitcnt vmcnt(25)
v_mfma_f32_16x16x32_bf16 v[24:27], a[84:87], a[20:23], v[24:27]
ds_read_b64_tr_b16 a[106:107], v13 offset:1280
v_mfma_f32_16x16x32_bf16 v[32:35], a[84:87], a[24:27], v[32:35]
ds_read_b64_tr_b16 a[108:109], v13 offset:8448
v_mfma_f32_16x16x32_bf16 v[32:35], a[80:83], a[4:7], v[32:35]
ds_read_b64_tr_b16 a[110:111], v13 offset:9472
s_add_u32 m0, s18, 0xc000
v_mfma_f32_16x16x32_bf16 v[40:43], a[80:83], a[8:11], v[40:43]
buffer_load_dwordx4 v7, s[68:71], 0 offen lds
v_mfma_f32_16x16x32_bf16 v[40:43], a[84:87], a[28:31], v[40:43]
ds_read_b128 a[40:43], v8 offset:32768
v_mfma_f32_16x16x32_bf16 v[48:51], a[84:87], a[32:35], v[48:51]
ds_read_b128 a[60:63], v9 offset:32768
v_mfma_f32_16x16x32_bf16 v[48:51], a[80:83], a[12:15], v[48:51]
ds_read_b128 a[44:47], v8 offset:34816
v_mfma_f32_16x16x32_bf16 v[52:55], a[88:91], a[12:15], v[52:55]
ds_read_b64_tr_b16 a[80:81], v12 offset:512
v_mfma_f32_16x16x32_bf16 v[52:55], a[92:95], a[32:35], v[52:55]
ds_read_b64_tr_b16 a[82:83], v12 offset:1536
s_add_u32 m0, s18, 0xd000
v_mfma_f32_16x16x32_bf16 v[44:47], a[92:95], a[28:31], v[44:47]
buffer_load_dwordx4 v7, s[68:71], s25 offen lds
v_mfma_f32_16x16x32_bf16 v[44:47], a[88:91], a[8:11], v[44:47]
ds_read_b64_tr_b16 a[84:85], v12 offset:8704
v_mfma_f32_16x16x32_bf16 v[36:39], a[88:91], a[4:7], v[36:39]
ds_read_b64_tr_b16 a[86:87], v12 offset:9728
v_mfma_f32_16x16x32_bf16 v[36:39], a[92:95], a[24:27], v[36:39]
ds_read_b128 a[64:67], v9 offset:34816
s_waitcnt lgkmcnt(8)
v_mfma_f32_16x16x32_bf16 v[28:31], a[92:95], a[20:23], v[28:31]
ds_read_b128 a[48:51], v8 offset:36864
s_add_u32 m0, s18, 0xe000
v_mfma_f32_16x16x32_bf16 v[28:31], a[88:91], a[0:3], v[28:31]
buffer_load_dwordx4 v7, s[68:71], s26 offen lds
v_mfma_f32_16x16x32_bf16 v[56:59], a[96:99], a[0:3], v[56:59]
ds_read_b64_tr_b16 a[88:89], v13 offset:512
v_mfma_f32_16x16x32_bf16 v[56:59], a[100:103], a[20:23], v[56:59]
ds_read_b64_tr_b16 a[90:91], v13 offset:1536
v_mfma_f32_16x16x32_bf16 v[64:67], a[100:103], a[24:27], v[64:67]
ds_read_b64_tr_b16 a[92:93], v13 offset:8704
v_mfma_f32_16x16x32_bf16 v[64:67], a[96:99], a[4:7], v[64:67]
ds_read_b64_tr_b16 a[94:95], v13 offset:9728
v_mfma_f32_16x16x32_bf16 v[72:75], a[96:99], a[8:11], v[72:75]
ds_read_b128 a[68:71], v9 offset:36864
s_add_u32 m0, s18, 0xf000
v_mfma_f32_16x16x32_bf16 v[72:75], a[100:103], a[28:31], v[72:75]
buffer_load_dwordx4 v4, s[44:47], s24 offen lds
v_mfma_f32_16x16x32_bf16 v[80:83], a[100:103], a[32:35], v[80:83]
ds_read_b128 a[52:55], v8 offset:38912
v_lshl_add_u32 v5, s42, 19, v5
v_mfma_f32_16x16x32_bf16 v[80:83], a[96:99], a[12:15], v[80:83]
ds_read_b128 a[72:75], v9 offset:38912
v_lshl_add_u32 v6, s42, 19, v6
v_mfma_f32_16x16x32_bf16 v[84:87], a[104:107], a[12:15], v[84:87]
ds_read_b64_tr_b16 a[96:97], v12 offset:768
v_lshl_add_u32 v7, s42, 18, v7
v_mfma_f32_16x16x32_bf16 v[84:87], a[108:111], a[32:35], v[84:87]
ds_read_b64_tr_b16 a[98:99], v12 offset:1792
v_lshl_add_u32 v7, s42, 17, v7
v_mfma_f32_16x16x32_bf16 v[76:79], a[108:111], a[28:31], v[76:79]
ds_read_b64_tr_b16 a[100:101], v12 offset:8960
s_add_u32 s8, s28, 0x8400
v_mfma_f32_16x16x32_bf16 v[76:79], a[104:107], a[8:11], v[76:79]
buffer_store_dwordx4 a[204:207], v16, s[88:91], s8 offen sc1
v_mfma_f32_16x16x32_bf16 v[68:71], a[104:107], a[4:7], v[68:71]
ds_read_b64_tr_b16 a[102:103], v12 offset:9984
v_lshl_add_u32 v4, s42, 7, v4
v_mfma_f32_16x16x32_bf16 v[68:71], a[108:111], a[24:27], v[68:71]
ds_read_b128 a[16:19], v10
v_mfma_f32_16x16x32_bf16 v[60:63], a[108:111], a[20:23], v[60:63]
ds_read_b128 a[36:39], v11
v_mfma_f32_16x16x32_bf16 v[60:63], a[104:107], a[0:3], v[60:63]
s_waitcnt lgkmcnt(6)
s_waitcnt lgkmcnt(9)
v_mfma_f32_16x16x32_bf16 v[88:91], a[80:83], a[0:3], v[88:91]
ds_read_b64_tr_b16 a[104:105], v13 offset:768
s_add_u32 m0, s16, 0x8000
v_mfma_f32_16x16x32_bf16 v[88:91], a[84:87], a[20:23], v[88:91]
buffer_load_dwordx4 v22, s[44:47], s20 offen lds
v_mfma_f32_16x16x32_bf16 v[96:99], a[84:87], a[24:27], v[96:99]
ds_read_b64_tr_b16 a[106:107], v13 offset:1792
v_mfma_f32_16x16x32_bf16 v[96:99], a[80:83], a[4:7], v[96:99]
ds_read_b64_tr_b16 a[108:109], v13 offset:8960
v_mfma_f32_16x16x32_bf16 v[104:107], a[80:83], a[8:11], v[104:107]
ds_read_b64_tr_b16 a[110:111], v13 offset:9984
v_mfma_f32_16x16x32_bf16 v[104:107], a[84:87], a[28:31], v[104:107]
s_add_u32 m0, s16, 0x8400
v_mfma_f32_16x16x32_bf16 v[112:115], a[84:87], a[32:35], v[112:115]
buffer_load_dwordx4 v23, s[44:47], s20 offen lds
v_mfma_f32_16x16x32_bf16 v[112:115], a[80:83], a[12:15], v[112:115]
v_mfma_f32_16x16x32_bf16 v[116:119], a[88:91], a[12:15], v[116:119]
ds_read_b64_tr_b16 a[80:81], v14 offset:0
v_mfma_f32_16x16x32_bf16 v[116:119], a[92:95], a[32:35], v[116:119]
ds_read_b64_tr_b16 a[82:83], v14 offset:256
v_mfma_f32_16x16x32_bf16 v[108:111], a[92:95], a[28:31], v[108:111]
ds_read_b64_tr_b16 a[84:85], v14 offset:2048
v_mfma_f32_16x16x32_bf16 v[108:111], a[88:91], a[8:11], v[108:111]
ds_read_b64_tr_b16 a[86:87], v14 offset:2304
s_add_u32 m0, s16, 0x8800
v_mfma_f32_16x16x32_bf16 v[100:103], a[88:91], a[4:7], v[100:103]
buffer_load_dwordx4 v22, s[44:47], s21 offen lds
v_mfma_f32_16x16x32_bf16 v[100:103], a[92:95], a[24:27], v[100:103]
v_mfma_f32_16x16x32_bf16 v[92:95], a[92:95], a[20:23], v[92:95]
v_mfma_f32_16x16x32_bf16 v[92:95], a[88:91], a[0:3], v[92:95]
s_waitcnt lgkmcnt(4)
v_mfma_f32_16x16x32_bf16 v[120:123], a[96:99], a[0:3], v[120:123]
ds_read_b64_tr_b16 a[88:89], v15 offset:0
v_mfma_f32_16x16x32_bf16 v[120:123], a[100:103], a[20:23], v[120:123]
ds_read_b64_tr_b16 a[90:91], v15 offset:256
s_add_u32 m0, s16, 0x8c00
v_mfma_f32_16x16x32_bf16 v[128:131], a[100:103], a[24:27], v[128:131]
buffer_load_dwordx4 v23, s[44:47], s21 offen lds
v_mfma_f32_16x16x32_bf16 v[128:131], a[96:99], a[4:7], v[128:131]
ds_read_b64_tr_b16 a[92:93], v15 offset:2048
v_mfma_f32_16x16x32_bf16 v[136:139], a[96:99], a[8:11], v[136:139]
ds_read_b64_tr_b16 a[94:95], v15 offset:2304
v_mfma_f32_16x16x32_bf16 v[136:139], a[100:103], a[28:31], v[136:139]
v_mfma_f32_16x16x32_bf16 v[144:147], a[100:103], a[32:35], v[144:147]
s_add_u32 s8, s28, 0x4800
v_mfma_f32_16x16x32_bf16 v[144:147], a[96:99], a[12:15], v[144:147]
buffer_store_dwordx4 a[208:211], v16, s[88:91], s8 offen sc1
v_mfma_f32_16x16x32_bf16 v[148:151], a[104:107], a[12:15], v[148:151]
ds_read_b64_tr_b16 a[96:97], v14 offset:4096
v_mfma_f32_16x16x32_bf16 v[148:151], a[108:111], a[32:35], v[148:151]
ds_read_b64_tr_b16 a[98:99], v14 offset:4352
v_mfma_f32_16x16x32_bf16 v[140:143], a[108:111], a[28:31], v[140:143]
ds_read_b64_tr_b16 a[100:101], v14 offset:6144
v_mfma_f32_16x16x32_bf16 v[140:143], a[104:107], a[8:11], v[140:143]
ds_read_b64_tr_b16 a[102:103], v14 offset:6400
v_mfma_f32_16x16x32_bf16 v[132:135], a[104:107], a[4:7], v[132:135]
s_add_u32 m0, s16, 0x9000
v_mfma_f32_16x16x32_bf16 v[132:135], a[108:111], a[24:27], v[132:135]
buffer_load_dwordx4 v22, s[44:47], s22 offen lds
v_mfma_f32_16x16x32_bf16 v[124:127], a[108:111], a[20:23], v[124:127]
v_mfma_f32_16x16x32_bf16 v[124:127], a[104:107], a[0:3], v[124:127]
s_waitcnt lgkmcnt(4)
v_mfma_f32_16x16x32_bf16 v[152:155], a[80:83], a[0:3], v[152:155]
ds_read_b64_tr_b16 a[104:105], v15 offset:4096
v_mfma_f32_16x16x32_bf16 v[152:155], a[84:87], a[20:23], v[152:155]
ds_read_b64_tr_b16 a[106:107], v15 offset:4352
v_mfma_f32_16x16x32_bf16 v[160:163], a[84:87], a[24:27], v[160:163]
ds_read_b64_tr_b16 a[108:109], v15 offset:6144
s_add_u32 m0, s16, 0x9400
v_mfma_f32_16x16x32_bf16 v[160:163], a[80:83], a[4:7], v[160:163]
buffer_load_dwordx4 v23, s[44:47], s22 offen lds
v_mfma_f32_16x16x32_bf16 v[168:171], a[80:83], a[8:11], v[168:171]
ds_read_b64_tr_b16 a[110:111], v15 offset:6400
v_mfma_f32_16x16x32_bf16 v[168:171], a[84:87], a[28:31], v[168:171]
v_mfma_f32_16x16x32_bf16 v[176:179], a[84:87], a[32:35], v[176:179]
v_mfma_f32_16x16x32_bf16 v[176:179], a[80:83], a[12:15], v[176:179]
s_add_u32 m0, s16, 0x9800
v_mfma_f32_16x16x32_bf16 v[180:183], a[88:91], a[12:15], v[180:183]
buffer_load_dwordx4 v22, s[44:47], s23 offen lds
v_mfma_f32_16x16x32_bf16 v[180:183], a[92:95], a[32:35], v[180:183]
ds_read_b64_tr_b16 a[80:81], v14 offset:8192
v_mfma_f32_16x16x32_bf16 v[172:175], a[92:95], a[28:31], v[172:175]
ds_read_b64_tr_b16 a[82:83], v14 offset:8448
v_mfma_f32_16x16x32_bf16 v[172:175], a[88:91], a[8:11], v[172:175]
ds_read_b64_tr_b16 a[84:85], v14 offset:10240
v_mfma_f32_16x16x32_bf16 v[164:167], a[88:91], a[4:7], v[164:167]
ds_read_b64_tr_b16 a[86:87], v14 offset:10496
v_mfma_f32_16x16x32_bf16 v[164:167], a[92:95], a[24:27], v[164:167]
s_add_u32 m0, s16, 0x9c00
v_mfma_f32_16x16x32_bf16 v[156:159], a[92:95], a[20:23], v[156:159]
buffer_load_dwordx4 v23, s[44:47], s23 offen lds
v_mfma_f32_16x16x32_bf16 v[156:159], a[88:91], a[0:3], v[156:159]
s_waitcnt lgkmcnt(4)
s_bfe_u32 s39, s40, 0x80010
s_add_u32 s39, s39, s41
v_mfma_f32_16x16x32_bf16 v[184:187], a[96:99], a[0:3], v[184:187]
ds_read_b64_tr_b16 a[88:89], v15 offset:8192
s_and_b32 s39, s39, 15
v_mfma_f32_16x16x32_bf16 v[184:187], a[100:103], a[20:23], v[184:187]
ds_read_b64_tr_b16 a[90:91], v15 offset:8448
s_sub_u32 s42, s39, s41
v_mfma_f32_16x16x32_bf16 v[192:195], a[100:103], a[24:27], v[192:195]
ds_read_b64_tr_b16 a[92:93], v15 offset:10240
s_mov_b32 s41, s39
v_mfma_f32_16x16x32_bf16 v[192:195], a[96:99], a[4:7], v[192:195]
ds_read_b64_tr_b16 a[94:95], v15 offset:10496
s_add_u32 s8, s28, 0x8800
v_mfma_f32_16x16x32_bf16 v[200:203], a[96:99], a[8:11], v[200:203]
buffer_store_dwordx4 a[212:215], v16, s[88:91], s8 offen sc1
v_mfma_f32_16x16x32_bf16 v[200:203], a[100:103], a[28:31], v[200:203]
v_add_u32 v12, 0xffff0000, v12
v_add_u32 v13, 0xffff0000, v13
v_mfma_f32_16x16x32_bf16 v[208:211], a[100:103], a[32:35], v[208:211]
v_add_u32 v14, 0xffff0000, v14
v_add_u32 v15, 0xffff0000, v15
v_mfma_f32_16x16x32_bf16 v[208:211], a[96:99], a[12:15], v[208:211]
v_add_u32 v10, 0xffff0000, v10
v_add_u32 v11, 0xffff0000, v11
v_mfma_f32_16x16x32_bf16 v[248:251], a[96:99], a[16:19], v[248:251]
v_lshl_add_u32 v22, s42, 7, v22
v_lshl_add_u32 v23, s42, 7, v23
v_mfma_f32_16x16x32_bf16 v[248:251], a[100:103], a[36:39], v[248:251]
v_mfma_f32_16x16x32_bf16 v[212:215], a[104:107], a[12:15], v[212:215]
s_waitcnt vmcnt(30) lgkmcnt(0)
v_mfma_f32_16x16x32_bf16 v[212:215], a[108:111], a[32:35], v[212:215]
s_barrier
s_add_u32 m0, s17, 0x10000
v_mfma_f32_16x16x32_bf16 v[204:207], a[108:111], a[28:31], v[204:207]
buffer_load_dwordx4 v5, s[52:55], 0 offen lds
v_mfma_f32_16x16x32_bf16 v[204:207], a[104:107], a[8:11], v[204:207]
ds_read_b64_tr_b16 a[96:97], v12 offset:0
v_mfma_f32_16x16x32_bf16 v[196:199], a[104:107], a[4:7], v[196:199]
ds_read_b64_tr_b16 a[98:99], v12 offset:1024
v_mfma_f32_16x16x32_bf16 v[196:199], a[108:111], a[24:27], v[196:199]
ds_read_b64_tr_b16 a[100:101], v12 offset:8192
v_mfma_f32_16x16x32_bf16 v[188:191], a[108:111], a[20:23], v[188:191]
ds_read_b64_tr_b16 a[102:103], v12 offset:9216
v_mfma_f32_16x16x32_bf16 v[188:191], a[104:107], a[0:3], v[188:191]
s_add_u32 m0, s17, 0x10400
s_waitcnt lgkmcnt(4)
v_mfma_f32_16x16x32_bf16 v[216:219], a[0:3], a[80:83], v[216:219]
buffer_load_dwordx4 v5, s[52:55], s13 offen lds
v_mfma_f32_16x16x32_bf16 v[216:219], a[20:23], a[84:87], v[216:219]
ds_read_b64_tr_b16 a[104:105], v13 offset:0
v_mfma_f32_16x16x32_bf16 v[224:227], a[24:27], a[84:87], v[224:227]
ds_read_b64_tr_b16 a[106:107], v13 offset:1024
v_mfma_f32_16x16x32_bf16 v[224:227], a[4:7], a[80:83], v[224:227]
ds_read_b64_tr_b16 a[108:109], v13 offset:8192
v_mfma_f32_16x16x32_bf16 v[232:235], a[8:11], a[80:83], v[232:235]
ds_read_b64_tr_b16 a[110:111], v13 offset:9216
v_mfma_f32_16x16x32_bf16 v[232:235], a[28:31], a[84:87], v[232:235]
s_add_u32 m0, s17, 0x10800
v_mfma_f32_16x16x32_bf16 v[240:243], a[32:35], a[84:87], v[240:243]
buffer_load_dwordx4 v6, s[52:55], 0 offen lds
v_mfma_f32_16x16x32_bf16 v[240:243], a[12:15], a[80:83], v[240:243]
v_mfma_f32_16x16x32_bf16 v[252:255], a[16:19], a[80:83], v[252:255]
v_mfma_f32_16x16x32_bf16 v[252:255], a[36:39], a[84:87], v[252:255]
v_mfma_f32_16x16x32_bf16 v[244:247], a[12:15], a[88:91], v[244:247]
ds_read_b64_tr_b16 a[80:81], v12 offset:256
v_mfma_f32_16x16x32_bf16 v[244:247], a[32:35], a[92:95], v[244:247]
ds_read_b64_tr_b16 a[82:83], v12 offset:1280
s_add_u32 m0, s17, 0x10c00
v_mfma_f32_16x16x32_bf16 v[236:239], a[28:31], a[92:95], v[236:239]
buffer_load_dwordx4 v6, s[52:55], s13 offen lds
v_mfma_f32_16x16x32_bf16 v[236:239], a[8:11], a[88:91], v[236:239]
ds_read_b64_tr_b16 a[84:85], v12 offset:8448
v_mfma_f32_16x16x32_bf16 v[228:231], a[4:7], a[88:91], v[228:231]
ds_read_b64_tr_b16 a[86:87], v12 offset:9472
v_mfma_f32_16x16x32_bf16 v[228:231], a[24:27], a[92:95], v[228:231]
v_mfma_f32_16x16x32_bf16 v[220:223], a[20:23], a[92:95], v[220:223]
v_mfma_f32_16x16x32_bf16 v[220:223], a[0:3], a[88:91], v[220:223]
s_add_u32 m0, s18, 0x14000
s_waitcnt lgkmcnt(4)
L_S15:
v_mfma_f32_16x16x32_bf16 v[24:27], a[96:99], a[40:43], v[24:27]
buffer_load_dwordx4 v7, s[68:71], 0 offen lds
v_mfma_f32_16x16x32_bf16 v[24:27], a[100:103], a[60:63], v[24:27]
ds_read_b64_tr_b16 a[88:89], v13 offset:256
s_waitcnt vmcnt(26)
v_mfma_f32_16x16x32_bf16 v[32:35], a[100:103], a[64:67], v[32:35]
ds_read_b64_tr_b16 a[90:91], v13 offset:1280
v_mfma_f32_16x16x32_bf16 v[32:35], a[96:99], a[44:47], v[32:35]
ds_read_b64_tr_b16 a[92:93], v13 offset:8448
v_mfma_f32_16x16x32_bf16 v[40:43], a[96:99], a[48:51], v[40:43]
ds_read_b64_tr_b16 a[94:95], v13 offset:9472
v_mfma_f32_16x16x32_bf16 v[40:43], a[100:103], a[68:71], v[40:43]
ds_read_b128 a[0:3], v8 offset:0
s_add_u32 s8, s28, 0x4c00
v_mfma_f32_16x16x32_bf16 v[48:51], a[100:103], a[72:75], v[48:51]
buffer_store_dwordx4 a[216:219], v16, s[88:91], s8 offen sc1
v_mfma_f32_16x16x32_bf16 v[48:51], a[96:99], a[52:55], v[48:51]
ds_read_b128 a[20:23], v9 offset:0
v_mfma_f32_16x16x32_bf16 v[52:55], a[104:107], a[52:55], v[52:55]
ds_read_b64_tr_b16 a[96:97], v12 offset:512
v_mfma_f32_16x16x32_bf16 v[52:55], a[108:111], a[72:75], v[52:55]
ds_read_b64_tr_b16 a[98:99], v12 offset:1536
v_mfma_f32_16x16x32_bf16 v[44:47], a[108:111], a[68:71], v[44:47]
ds_read_b64_tr_b16 a[100:101], v12 offset:8704
v_mfma_f32_16x16x32_bf16 v[44:47], a[104:107], a[48:51], v[44:47]
ds_read_b64_tr_b16 a[102:103], v12 offset:9728
s_add_u32 m0, s18, 0x15000
v_mfma_f32_16x16x32_bf16 v[36:39], a[104:107], a[44:47], v[36:39]
buffer_load_dwordx4 v7, s[68:71], s25 offen lds
v_mfma_f32_16x16x32_bf16 v[36:39], a[108:111], a[64:67], v[36:39]
ds_read_b128 a[4:7], v8 offset:2048
v_mfma_f32_16x16x32_bf16 v[28:31], a[108:111], a[60:63], v[28:31]
ds_read_b128 a[24:27], v9 offset:2048
v_mfma_f32_16x16x32_bf16 v[28:31], a[104:107], a[40:43], v[28:31]
ds_read_b128 a[8:11], v8 offset:4096
s_waitcnt lgkmcnt(9)
v_mfma_f32_16x16x32_bf16 v[56:59], a[80:83], a[40:43], v[56:59]
ds_read_b64_tr_b16 a[104:105], v13 offset:512
v_mfma_f32_16x16x32_bf16 v[56:59], a[84:87], a[60:63], v[56:59]
ds_read_b64_tr_b16 a[106:107], v13 offset:1536
s_add_u32 m0, s18, 0x16000
v_mfma_f32_16x16x32_bf16 v[64:67], a[84:87], a[64:67], v[64:67]
buffer_load_dwordx4 v7, s[68:71], s26 offen lds
v_mfma_f32_16x16x32_bf16 v[64:67], a[80:83], a[44:47], v[64:67]
ds_read_b64_tr_b16 a[108:109], v13 offset:8704
L_padA8:
s_cmp_eq_u32 s95, 1
s_cbranch_scc1 L_padA12
v_mfma_f32_16x16x32_bf16 v[72:75], a[80:83], a[48:51], v[72:75]
ds_read_b64_tr_b16 a[110:111], v13 offset:9728
v_mfma_f32_16x16x32_bf16 v[72:75], a[84:87], a[68:71], v[72:75]
ds_read_b128 a[28:31], v9 offset:4096
v_mfma_f32_16x16x32_bf16 v[80:83], a[84:87], a[72:75], v[80:83]
ds_read_b128 a[12:15], v8 offset:6144
v_mfma_f32_16x16x32_bf16 v[80:83], a[80:83], a[52:55], v[80:83]
ds_read_b128 a[32:35], v9 offset:6144
s_add_u32 m0, s18, 0x17000
v_mfma_f32_16x16x32_bf16 v[84:87], a[88:91], a[52:55], v[84:87]
buffer_load_dwordx4 v4, s[44:47], s24 offen lds
v_mfma_f32_16x16x32_bf16 v[84:87], a[92:95], a[72:75], v[84:87]
ds_read_b64_tr_b16 a[80:81], v12 offset:768
v_lshl_add_u32 v5, s42, 19, v5
v_mfma_f32_16x16x32_bf16 v[76:79], a[92:95], a[68:71], v[76:79]
ds_read_b64_tr_b16 a[82:83], v12 offset:1792
v_lshl_add_u32 v6, s42, 19, v6
v_mfma_f32_16x16x32_bf16 v[76:79], a[88:91], a[48:51], v[76:79]
ds_read_b64_tr_b16 a[84:85], v12 offset:8960
v_lshl_add_u32 v7, s42, 18, v7
v_mfma_f32_16x16x32_bf16 v[68:71], a[88:91], a[44:47], v[68:71]
ds_read_b64_tr_b16 a[86:87], v12 offset:9984
s_waitcnt lgkmcnt(4)
v_mfma_f32_16x16x32_bf16 v[68:71], a[92:95], a[64:67], v[68:71]
ds_read_b128 a[56:59], v10
s_add_u32 m0, s16, 0x0
v_mfma_f32_16x16x32_bf16 v[60:63], a[92:95], a[60:63], v[60:63]
buffer_load_dwordx4 v22, s[44:47], s20 offen lds
v_mfma_f32_16x16x32_bf16 v[60:63], a[88:91], a[40:43], v[60:63]
ds_read_b128 a[76:79], v11
s_waitcnt lgkmcnt(9)
v_mfma_f32_16x16x32_bf16 v[88:91], a[96:99], a[40:43], v[88:91]
ds_read_b64_tr_b16 a[88:89], v13 offset:768
v_lshl_add_u32 v7, s42, 17, v7
v_mfma_f32_16x16x32_bf16 v[88:91], a[100:103], a[60:63], v[88:91]
ds_read_b64_tr_b16 a[90:91], v13 offset:1792
v_lshl_add_u32 v4, s42, 7, v4
v_mfma_f32_16x16x32_bf16 v[96:99], a[100:103], a[64:67], v[96:99]
ds_read_b64_tr_b16 a[92:93], v13 offset:8960
v_mfma_f32_16x16x32_bf16 v[96:99], a[96:99], a[44:47], v[96:99]
ds_read_b64_tr_b16 a[94:95], v13 offset:9984
s_add_u32 m0, s16, 0x400
v_mfma_f32_16x16x32_bf16 v[104:107], a[96:99], a[48:51], v[104:107]
buffer_load_dwordx4 v23, s[44:47], s20 offen lds
v_mfma_f32_16x16x32_bf16 v[104:107], a[100:103], a[68:71], v[104:107]
v_mfma_f32_16x16x32_bf16 v[112:115], a[100:103], a[72:75], v[112:115]
v_mfma_f32_16x16x32_bf16 v[112:115], a[96:99], a[52:55], v[112:115]
v_mfma_f32_16x16x32_bf16 v[116:119], a[104:107], a[52:55], v[116:119]
ds_read_b64_tr_b16 a[96:97], v14 offset:0
v_mfma_f32_16x16x32_bf16 v[116:119], a[108:111], a[72:75], v[116:119]
ds_read_b64_tr_b16 a[98:99], v14 offset:256
s_add_u32 s8, s28, 0x8c00
v_mfma_f32_16x16x32_bf16 v[108:111], a[108:111], a[68:71], v[108:111]
buffer_store_dwordx4 a[220:223], v16, s[88:91], s8 offen sc1
v_mfma_f32_16x16x32_bf16 v[108:111], a[104:107], a[48:51], v[108:111]
ds_read_b64_tr_b16 a[100:101], v14 offset:2048
v_mfma_f32_16x16x32_bf16 v[100:103], a[104:107], a[44:47], v[100:103]
ds_read_b64_tr_b16 a[102:103], v14 offset:2304
v_mfma_f32_16x16x32_bf16 v[100:103], a[108:111], a[64:67], v[100:103]
v_mfma_f32_16x16x32_bf16 v[92:95], a[108:111], a[60:63], v[92:95]
v_mfma_f32_16x16x32_bf16 v[92:95], a[104:107], a[40:43], v[92:95]
s_add_u32 m0, s16, 0x800
s_waitcnt lgkmcnt(4)
v_mfma_f32_16x16x32_bf16 v[120:123], a[80:83], a[40:43], v[120:123]
buffer_load_dwordx4 v22, s[44:47], s21 offen lds
v_mfma_f32_16x16x32_bf16 v[120:123], a[84:87], a[60:63], v[120:123]
ds_read_b64_tr_b16 a[104:105], v15 offset:0
v_mfma_f32_16x16x32_bf16 v[128:131], a[84:87], a[64:67], v[128:131]
ds_read_b64_tr_b16 a[106:107], v15 offset:256
v_mfma_f32_16x16x32_bf16 v[128:131], a[80:83], a[44:47], v[128:131]
ds_read_b64_tr_b16 a[108:109], v15 offset:2048
v_mfma_f32_16x16x32_bf16 v[136:139], a[80:83], a[48:51], v[136:139]
ds_read_b64_tr_b16 a[110:111], v15 offset:2304
v_mfma_f32_16x16x32_bf16 v[136:139], a[84:87], a[68:71], v[136:139]
s_add_u32 m0, s16, 0xc00
v_mfma_f32_16x16x32_bf16 v[144:147], a[84:87], a[72:75], v[144:147]
buffer_load_dwordx4 v23, s[44:47], s21 offen lds
v_mfma_f32_16x16x32_bf16 v[144:147], a[80:83], a[52:55], v[144:147]
v_mfma_f32_16x16x32_bf16 v[148:151], a[88:91], a[52:55], v[148:151]
ds_read_b64_tr_b16 a[80:81], v14 offset:4096
v_mfma_f32_16x16x32_bf16 v[148:151], a[92:95], a[72:75], v[148:151]
ds_read_b64_tr_b16 a[82:83], v14 offset:4352
v_mfma_f32_16x16x32_bf16 v[140:143], a[92:95], a[68:71], v[140:143]
ds_read_b64_tr_b16 a[84:85], v14 offset:6144
v_mfma_f32_16x16x32_bf16 v[140:143], a[88:91], a[48:51], v[140:143]
ds_read_b64_tr_b16 a[86:87], v14 offset:6400
s_add_u32 m0, s16, 0x1000
v_mfma_f32_16x16x32_bf16 v[132:135], a[88:91], a[44:47], v[132:135]
buffer_load_dwordx4 v22, s[44:47], s22 offen lds
v_mfma_f32_16x16x32_bf16 v[132:135], a[92:95], a[64:67], v[132:135]
v_mfma_f32_16x16x32_bf16 v[124:127], a[92:95], a[60:63], v[124:127]
v_mfma_f32_16x16x32_bf16 v[124:127], a[88:91], a[40:43], v[124:127]
s_waitcnt lgkmcnt(4)
v_mfma_f32_16x16x32_bf16 v[152:155], a[96:99], a[40:43], v[152:155]
ds_read_b64_tr_b16 a[88:89], v15 offset:4096
v_mfma_f32_16x16x32_bf16 v[152:155], a[100:103], a[60:63], v[152:155]
ds_read_b64_tr_b16 a[90:91], v15 offset:4352
s_add_u32 m0, s16, 0x1400
v_mfma_f32_16x16x32_bf16 v[160:163], a[100:103], a[64:67], v[160:163]
buffer_load_dwordx4 v23, s[44:47], s22 offen lds
v_mfma_f32_16x16x32_bf16 v[160:163], a[96:99], a[44:47], v[160:163]
ds_read_b64_tr_b16 a[92:93], v15 offset:6144
v_mfma_f32_16x16x32_bf16 v[168:171], a[96:99], a[48:51], v[168:171]
ds_read_b64_tr_b16 a[94:95], v15 offset:6400
v_mfma_f32_16x16x32_bf16 v[168:171], a[100:103], a[68:71], v[168:171]
v_mfma_f32_16x16x32_bf16 v[176:179], a[100:103], a[72:75], v[176:179]
v_mfma_f32_16x16x32_bf16 v[176:179], a[96:99], a[52:55], v[176:179]
s_add_u32 m0, s16, 0x1800
v_mfma_f32_16x16x32_bf16 v[180:183], a[104:107], a[52:55], v[180:183]
buffer_load_dwordx4 v22, s[44:47], s23 offen lds
v_mfma_f32_16x16x32_bf16 v[180:183], a[108:111], a[72:75], v[180:183]
ds_read_b64_tr_b16 a[96:97], v14 offset:8192
v_mfma_f32_16x16x32_bf16 v[172:175], a[108:111], a[68:71], v[172:175]
ds_read_b64_tr_b16 a[98:99], v14 offset:8448
v_mfma_f32_16x16x32_bf16 v[172:175], a[104:107], a[48:51], v[172:175]
ds_read_b64_tr_b16 a[100:101], v14 offset:10240
v_mfma_f32_16x16x32_bf16 v[164:167], a[104:107], a[44:47], v[164:167]
ds_read_b64_tr_b16 a[102:103], v14 offset:10496
v_mfma_f32_16x16x32_bf16 v[164:167], a[108:111], a[64:67], v[164:167]
s_add_u32 m0, s16, 0x1c00
v_mfma_f32_16x16x32_bf16 v[156:159], a[108:111], a[60:63], v[156:159]
buffer_load_dwordx4 v23, s[44:47], s23 offen lds
v_mfma_f32_16x16x32_bf16 v[156:159], a[104:107], a[40:43], v[156:159]
s_waitcnt lgkmcnt(4)
s_bfe_u32 s39, s40, 0x80018
s_add_u32 s39, s39, s41
v_mfma_f32_16x16x32_bf16 v[184:187], a[80:83], a[40:43], v[184:187]
ds_read_b64_tr_b16 a[104:105], v15 offset:8192
s_and_b32 s39, s39, 15
v_mfma_f32_16x16x32_bf16 v[184:187], a[84:87], a[60:63], v[184:187]
ds_read_b64_tr_b16 a[106:107], v15 offset:8448
s_sub_u32 s42, s39, s41
v_mfma_f32_16x16x32_bf16 v[192:195], a[84:87], a[64:67], v[192:195]
ds_read_b64_tr_b16 a[108:109], v15 offset:10240
s_mov_b32 s41, s39
v_mfma_f32_16x16x32_bf16 v[192:195], a[80:83], a[44:47], v[192:195]
ds_read_b64_tr_b16 a[110:111], v15 offset:10496
s_add_u32 s8, s28, 0x5000
v_mfma_f32_16x16x32_bf16 v[200:203], a[80:83], a[48:51], v[200:203]
buffer_store_dwordx4 a[224:227], v16, s[88:91], s8 offen sc1
v_mfma_f32_16x16x32_bf16 v[200:203], a[84:87], a[68:71], v[200:203]
v_add_u32 v12, 0x8000, v12
v_add_u32 v13, 0x8000, v13
v_mfma_f32_16x16x32_bf16 v[208:211], a[84:87], a[72:75], v[208:211]
v_add_u32 v14, 0x8000, v14
v_add_u32 v15, 0x8000, v15
v_mfma_f32_16x16x32_bf16 v[208:211], a[80:83], a[52:55], v[208:211]
v_add_u32 v10, 0x8000, v10
v_add_u32 v11, 0x8000, v11
v_mfma_f32_16x16x32_bf16 v[248:251], a[80:83], a[56:59], v[248:251]
v_lshl_add_u32 v22, s42, 7, v22
v_lshl_add_u32 v23, s42, 7, v23
v_mfma_f32_16x16x32_bf16 v[248:251], a[84:87], a[76:79], v[248:251]
v_mfma_f32_16x16x32_bf16 v[212:215], a[88:91], a[52:55], v[212:215]
s_waitcnt vmcnt(30) lgkmcnt(0)
v_mfma_f32_16x16x32_bf16 v[212:215], a[92:95], a[72:75], v[212:215]
s_barrier
s_add_u32 m0, s17, 0x0
v_mfma_f32_16x16x32_bf16 v[204:207], a[92:95], a[68:71], v[204:207]
buffer_load_dwordx4 v5, s[52:55], 0 offen lds
v_mfma_f32_16x16x32_bf16 v[204:207], a[88:91], a[48:51], v[204:207]
ds_read_b64_tr_b16 a[80:81], v12 offset:0
v_mfma_f32_16x16x32_bf16 v[196:199], a[88:91], a[44:47], v[196:199]
ds_read_b64_tr_b16 a[82:83], v12 offset:1024
v_mfma_f32_16x16x32_bf16 v[196:199], a[92:95], a[64:67], v[196:199]
ds_read_b64_tr_b16 a[84:85], v12 offset:8192
v_mfma_f32_16x16x32_bf16 v[188:191], a[92:95], a[60:63], v[188:191]
ds_read_b64_tr_b16 a[86:87], v12 offset:9216
v_mfma_f32_16x16x32_bf16 v[188:191], a[88:91], a[40:43], v[188:191]
s_add_u32 m0, s17, 0x400
s_waitcnt lgkmcnt(4)
v_mfma_f32_16x16x32_bf16 v[216:219], a[40:43], a[96:99], v[216:219]
buffer_load_dwordx4 v5, s[52:55], s13 offen lds
v_mfma_f32_16x16x32_bf16 v[216:219], a[60:63], a[100:103], v[216:219]
ds_read_b64_tr_b16 a[88:89], v13 offset:0
v_mfma_f32_16x16x32_bf16 v[224:227], a[64:67], a[100:103], v[224:227]
ds_read_b64_tr_b16 a[90:91], v13 offset:1024
v_mfma_f32_16x16x32_bf16 v[224:227], a[44:47], a[96:99], v[224:227]
ds_read_b64_tr_b16 a[92:93], v13 offset:8192
v_mfma_f32_16x16x32_bf16 v[232:235], a[48:51], a[96:99], v[232:235]
ds_read_b64_tr_b16 a[94:95], v13 offset:9216
v_mfma_f32_16x16x32_bf16 v[232:235], a[68:71], a[100:103], v[232:235]
s_add_u32 m0, s17, 0x800
v_mfma_f32_16x16x32_bf16 v[240:243], a[72:75], a[100:103], v[240:243]
buffer_load_dwordx4 v6, s[52:55], 0 offen lds
v_mfma_f32_16x16x32_bf16 v[240:243], a[52:55], a[96:99], v[240:243]
v_mfma_f32_16x16x32_bf16 v[252:255], a[56:59], a[96:99], v[252:255]
v_mfma_f32_16x16x32_bf16 v[252:255], a[76:79], a[100:103], v[252:255]
v_mfma_f32_16x16x32_bf16 v[244:247], a[52:55], a[104:107], v[244:247]
ds_read_b64_tr_b16 a[96:97], v12 offset:256
v_mfma_f32_16x16x32_bf16 v[244:247], a[72:75], a[108:111], v[244:247]
ds_read_b64_tr_b16 a[98:99], v12 offset:1280
s_add_u32 m0, s17, 0xc00
v_mfma_f32_16x16x32_bf16 v[236:239], a[68:71], a[108:111], v[236:239]
buffer_load_dwordx4 v6, s[52:55], s13 offen lds
v_mfma_f32_16x16x32_bf16 v[236:239], a[48:51], a[104:107], v[236:239]
ds_read_b64_tr_b16 a[100:101], v12 offset:8448
v_mfma_f32_16x16x32_bf16 v[228:231], a[44:47], a[104:107], v[228:231]
ds_read_b64_tr_b16 a[102:103], v12 offset:9472
v_mfma_f32_16x16x32_bf16 v[228:231], a[64:67], a[108:111], v[228:231]
v_mfma_f32_16x16x32_bf16 v[220:223], a[60:63], a[108:111], v[220:223]
v_mfma_f32_16x16x32_bf16 v[220:223], a[40:43], a[104:107], v[220:223]
s_add_u32 m0, s18, 0x4000
s_waitcnt lgkmcnt(4)
L_S16:
v_mfma_f32_16x16x32_bf16 v[24:27], a[80:83], a[0:3], v[24:27]
buffer_load_dwordx4 v7, s[68:71], 0 offen lds
v_mfma_f32_16x16x32_bf16 v[24:27], a[84:87], a[20:23], v[24:27]
ds_read_b64_tr_b16 a[104:105], v13 offset:256
s_waitcnt vmcnt(25)
v_mfma_f32_16x16x32_bf16 v[32:35], a[84:87], a[24:27], v[32:35]
ds_read_b64_tr_b16 a[106:107], v13 offset:1280
v_mfma_f32_16x16x32_bf16 v[32:35], a[80:83], a[4:7], v[32:35]
ds_read_b64_tr_b16 a[108:109], v13 offset:8448
v_mfma_f32_16x16x32_bf16 v[40:43], a[80:83], a[8:11], v[40:43]
ds_read_b64_tr_b16 a[110:111], v13 offset:9472
v_mfma_f32_16x16x32_bf16 v[40:43], a[84:87], a[28:31], v[40:43]
ds_read_b128 a[40:43], v8 offset:32768
s_add_u32 s8, s28, 0x9000
v_mfma_f32_16x16x32_bf16 v[48:51], a[84:87], a[32:35], v[48:51]
buffer_store_dwordx4 a[228:231], v16, s[88:91], s8 offen sc1
v_mfma_f32_16x16x32_bf16 v[48:51], a[80:83], a[12:15], v[48:51]
ds_read_b128 a[60:63], v9 offset:32768
v_mfma_f32_16x16x32_bf16 v[52:55], a[88:91], a[12:15], v[52:55]
ds_read_b64_tr_b16 a[80:81], v12 offset:512
v_mfma_f32_16x16x32_bf16 v[52:55], a[92:95], a[32:35], v[52:55]
ds_read_b64_tr_b16 a[82:83], v12 offset:1536
v_mfma_f32_16x16x32_bf16 v[44:47], a[92:95], a[28:31], v[44:47]
ds_read_b64_tr_b16 a[84:85], v12 offset:8704
v_mfma_f32_16x16x32_bf16 v[44:47], a[88:91], a[8:11], v[44:47]
ds_read_b64_tr_b16 a[86:87], v12 offset:9728
s_add_u32 m0, s18, 0x5000
v_mfma_f32_16x16x32_bf16 v[36:39], a[88:91], a[4:7], v[36:39]
buffer_load_dwordx4 v7, s[68:71], s25 offen lds
v_mfma_f32_16x16x32_bf16 v[36:39], a[92:95], a[24:27], v[36:39]
ds_read_b128 a[44:47], v8 offset:34816
v_mfma_f32_16x16x32_bf16 v[28:31], a[92:95], a[20:23], v[28:31]
ds_read_b128 a[64:67], v9 offset:34816
v_mfma_f32_16x16x32_bf16 v[28:31], a[88:91], a[0:3], v[28:31]
ds_read_b128 a[48:51], v8 offset:36864
s_waitcnt lgkmcnt(9)
v_mfma_f32_16x16x32_bf16 v[56:59], a[96:99], a[0:3], v[56:59]
ds_read_b64_tr_b16 a[88:89], v13 offset:512
v_mfma_f32_16x16x32_bf16 v[56:59], a[100:103], a[20:23], v[56:59]
ds_read_b64_tr_b16 a[90:91], v13 offset:1536
s_add_u32 m0, s18, 0x6000
v_mfma_f32_16x16x32_bf16 v[64:67], a[100:103], a[24:27], v[64:67]
buffer_load_dwordx4 v7, s[68:71], s26 offen lds
v_mfma_f32_16x16x32_bf16 v[64:67], a[96:99], a[4:7], v[64:67]
ds_read_b64_tr_b16 a[92:93], v13 offset:8704
v_mfma_f32_16x16x32_bf16 v[72:75], a[96:99], a[8:11], v[72:75]
ds_read_b64_tr_b16 a[94:95], v13 offset:9728
v_mfma_f32_16x16x32_bf16 v[72:75], a[100:103], a[28:31], v[72:75]
ds_read_b128 a[68:71], v9 offset:36864
v_mfma_f32_16x16x32_bf16 v[80:83], a[100:103], a[32:35], v[80:83]
ds_read_b128 a[52:55], v8 offset:38912
v_mfma_f32_16x16x32_bf16 v[80:83], a[96:99], a[12:15], v[80:83]
ds_read_b128 a[72:75], v9 offset:38912
s_add_u32 m0, s18, 0x7000
v_mfma_f32_16x16x32_bf16 v[84:87], a[104:107], a[12:15], v[84:87]
buffer_load_dwordx4 v4, s[44:47], s24 offen lds
v_mfma_f32_16x16x32_bf16 v[84:87], a[108:111], a[32:35], v[84:87]
ds_read_b64_tr_b16 a[96:97], v12 offset:768
v_lshl_add_u32 v5, s42, 19, v5
v_mfma_f32_16x16x32_bf16 v[76:79], a[108:111], a[28:31], v[76:79]
ds_read_b64_tr_b16 a[98:99], v12 offset:1792
v_lshl_add_u32 v6, s42, 19, v6
v_mfma_f32_16x16x32_bf16 v[76:79], a[104:107], a[8:11], v[76:79]
ds_read_b64_tr_b16 a[100:101], v12 offset:8960
v_lshl_add_u32 v7, s42, 18, v7
v_mfma_f32_16x16x32_bf16 v[68:71], a[104:107], a[4:7], v[68:71]
ds_read_b64_tr_b16 a[102:103], v12 offset:9984
s_waitcnt lgkmcnt(4)
v_mfma_f32_16x16x32_bf16 v[68:71], a[108:111], a[24:27], v[68:71]
ds_read_b128 a[16:19], v10
s_add_u32 m0, s16, 0x8000
v_mfma_f32_16x16x32_bf16 v[60:63], a[108:111], a[20:23], v[60:63]
buffer_load_dwordx4 v22, s[44:47], s20 offen lds
v_mfma_f32_16x16x32_bf16 v[60:63], a[104:107], a[0:3], v[60:63]
ds_read_b128 a[36:39], v11
s_waitcnt lgkmcnt(9)
v_mfma_f32_16x16x32_bf16 v[88:91], a[80:83], a[0:3], v[88:91]
ds_read_b64_tr_b16 a[104:105], v13 offset:768
v_lshl_add_u32 v7, s42, 17, v7
v_mfma_f32_16x16x32_bf16 v[88:91], a[84:87], a[20:23], v[88:91]
ds_read_b64_tr_b16 a[106:107], v13 offset:1792
v_lshl_add_u32 v4, s42, 7, v4
v_mfma_f32_16x16x32_bf16 v[96:99], a[84:87], a[24:27], v[96:99]
ds_read_b64_tr_b16 a[108:109], v13 offset:8960
v_mfma_f32_16x16x32_bf16 v[96:99], a[80:83], a[4:7], v[96:99]
ds_read_b64_tr_b16 a[110:111], v13 offset:9984
s_add_u32 m0, s16, 0x8400
v_mfma_f32_16x16x32_bf16 v[104:107], a[80:83], a[8:11], v[104:107]
buffer_load_dwordx4 v23, s[44:47], s20 offen lds
v_mfma_f32_16x16x32_bf16 v[104:107], a[84:87], a[28:31], v[104:107]
v_mfma_f32_16x16x32_bf16 v[112:115], a[84:87], a[32:35], v[112:115]
v_mfma_f32_16x16x32_bf16 v[112:115], a[80:83], a[12:15], v[112:115]
v_mfma_f32_16x16x32_bf16 v[116:119], a[88:91], a[12:15], v[116:119]
ds_read_b64_tr_b16 a[80:81], v14 offset:0
v_mfma_f32_16x16x32_bf16 v[116:119], a[92:95], a[32:35], v[116:119]
ds_read_b64_tr_b16 a[82:83], v14 offset:256
s_add_u32 s8, s28, 0x5400
v_mfma_f32_16x16x32_bf16 v[108:111], a[92:95], a[28:31], v[108:111]
buffer_store_dwordx4 a[112:115], v16, s[88:91], s8 offen sc1
v_mfma_f32_16x16x32_bf16 v[108:111], a[88:91], a[8:11], v[108:111]
ds_read_b64_tr_b16 a[84:85], v14 offset:2048
v_mfma_f32_16x16x32_bf16 v[100:103], a[88:91], a[4:7], v[100:103]
ds_read_b64_tr_b16 a[86:87], v14 offset:2304
v_mfma_f32_16x16x32_bf16 v[100:103], a[92:95], a[24:27], v[100:103]
v_mfma_f32_16x16x32_bf16 v[92:95], a[92:95], a[20:23], v[92:95]
v_mfma_f32_16x16x32_bf16 v[92:95], a[88:91], a[0:3], v[92:95]
s_add_u32 m0, s16, 0x8800
s_waitcnt lgkmcnt(4)
v_mfma_f32_16x16x32_bf16 v[120:123], a[96:99], a[0:3], v[120:123]
buffer_load_dwordx4 v22, s[44:47], s21 offen lds
v_mfma_f32_16x16x32_bf16 v[120:123], a[100:103], a[20:23], v[120:123]
ds_read_b64_tr_b16 a[88:89], v15 offset:0
v_mfma_f32_16x16x32_bf16 v[128:131], a[100:103], a[24:27], v[128:131]
ds_read_b64_tr_b16 a[90:91], v15 offset:256
v_mfma_f32_16x16x32_bf16 v[128:131], a[96:99], a[4:7], v[128:131]
ds_read_b64_tr_b16 a[92:93], v15 offset:2048
v_mfma_f32_16x16x32_bf16 v[136:139], a[96:99], a[8:11], v[136:139]
ds_read_b64_tr_b16 a[94:95], v15 offset:2304
v_mfma_f32_16x16x32_bf16 v[136:139], a[100:103], a[28:31], v[136:139]
s_add_u32 m0, s16, 0x8c00
v_mfma_f32_16x16x32_bf16 v[144:147], a[100:103], a[32:35], v[144:147]
buffer_load_dwordx4 v23, s[44:47], s21 offen lds
v_mfma_f32_16x16x32_bf16 v[144:147], a[96:99], a[12:15], v[144:147]
v_mfma_f32_16x16x32_bf16 v[148:151], a[104:107], a[12:15], v[148:151]
ds_read_b64_tr_b16 a[96:97], v14 offset:4096
v_mfma_f32_16x16x32_bf16 v[148:151], a[108:111], a[32:35], v[148:151]
ds_read_b64_tr_b16 a[98:99], v14 offset:4352
v_mfma_f32_16x16x32_bf16 v[140:143], a[108:111], a[28:31], v[140:143]
ds_read_b64_tr_b16 a[100:101], v14 offset:6144
v_mfma_f32_16x16x32_bf16 v[140:143], a[104:107], a[8:11], v[140:143]
ds_read_b64_tr_b16 a[102:103], v14 offset:6400
s_add_u32 m0, s16, 0x9000
v_mfma_f32_16x16x32_bf16 v[132:135], a[104:107], a[4:7], v[132:135]
buffer_load_dwordx4 v22, s[44:47], s22 offen lds
v_mfma_f32_16x16x32_bf16 v[132:135], a[108:111], a[24:27], v[132:135]
v_mfma_f32_16x16x32_bf16 v[124:127], a[108:111], a[20:23], v[124:127]
v_mfma_f32_16x16x32_bf16 v[124:127], a[104:107], a[0:3], v[124:127]
s_waitcnt lgkmcnt(4)
v_mfma_f32_16x16x32_bf16 v[152:155], a[80:83], a[0:3], v[152:155]
ds_read_b64_tr_b16 a[104:105], v15 offset:4096
v_mfma_f32_16x16x32_bf16 v[152:155], a[84:87], a[20:23], v[152:155]
ds_read_b64_tr_b16 a[106:107], v15 offset:4352
s_add_u32 m0, s16, 0x9400
v_mfma_f32_16x16x32_bf16 v[160:163], a[84:87], a[24:27], v[160:163]
buffer_load_dwordx4 v23, s[44:47], s22 offen lds
v_mfma_f32_16x16x32_bf16 v[160:163], a[80:83], a[4:7], v[160:163]
ds_read_b64_tr_b16 a[108:109], v15 offset:6144
v_mfma_f32_16x16x32_bf16 v[168:171], a[80:83], a[8:11], v[168:171]
ds_read_b64_tr_b16 a[110:111], v15 offset:6400
v_mfma_f32_16x16x32_bf16 v[168:171], a[84:87], a[28:31], v[168:171]
v_mfma_f32_16x16x32_bf16 v[176:179], a[84:87], a[32:35], v[176:179]
v_mfma_f32_16x16x32_bf16 v[176:179], a[80:83], a[12:15], v[176:179]
s_add_u32 m0, s16, 0x9800
v_mfma_f32_16x16x32_bf16 v[180:183], a[88:91], a[12:15], v[180:183]
buffer_load_dwordx4 v22, s[44:47], s23 offen lds
v_mfma_f32_16x16x32_bf16 v[180:183], a[92:95], a[32:35], v[180:183]
ds_read_b64_tr_b16 a[80:81], v14 offset:8192
v_mfma_f32_16x16x32_bf16 v[172:175], a[92:95], a[28:31], v[172:175]
ds_read_b64_tr_b16 a[82:83], v14 offset:8448
v_mfma_f32_16x16x32_bf16 v[172:175], a[88:91], a[8:11], v[172:175]
ds_read_b64_tr_b16 a[84:85], v14 offset:10240
v_mfma_f32_16x16x32_bf16 v[164:167], a[88:91], a[4:7], v[164:167]
ds_read_b64_tr_b16 a[86:87], v14 offset:10496
v_mfma_f32_16x16x32_bf16 v[164:167], a[92:95], a[24:27], v[164:167]
s_add_u32 m0, s16, 0x9c00
v_mfma_f32_16x16x32_bf16 v[156:159], a[92:95], a[20:23], v[156:159]
buffer_load_dwordx4 v23, s[44:47], s23 offen lds
v_mfma_f32_16x16x32_bf16 v[156:159], a[88:91], a[0:3], v[156:159]
s_waitcnt lgkmcnt(4)
s_bfe_u32 s39, s40, 0x80000
s_add_u32 s39, s39, s41
v_mfma_f32_16x16x32_bf16 v[184:187], a[96:99], a[0:3], v[184:187]
ds_read_b64_tr_b16 a[88:89], v15 offset:8192
s_and_b32 s39, s39, 15
v_mfma_f32_16x16x32_bf16 v[184:187], a[100:103], a[20:23], v[184:187]
ds_read_b64_tr_b16 a[90:91], v15 offset:8448
s_sub_u32 s42, s39, s41
v_mfma_f32_16x16x32_bf16 v[192:195], a[100:103], a[24:27], v[192:195]
ds_read_b64_tr_b16 a[92:93], v15 offset:10240
s_mov_b32 s41, s39
v_mfma_f32_16x16x32_bf16 v[192:195], a[96:99], a[4:7], v[192:195]
ds_read_b64_tr_b16 a[94:95], v15 offset:10496
s_add_u32 s8, s28, 0x9400
v_mfma_f32_16x16x32_bf16 v[200:203], a[96:99], a[8:11], v[200:203]
buffer_store_dwordx4 a[116:119], v16, s[88:91], s8 offen sc1
v_mfma_f32_16x16x32_bf16 v[200:203], a[100:103], a[28:31], v[200:203]
v_add_u32 v12, 0x8000, v12
v_add_u32 v13, 0x8000, v13
v_mfma_f32_16x16x32_bf16 v[208:211], a[100:103], a[32:35], v[208:211]
v_add_u32 v14, 0x8000, v14
v_add_u32 v15, 0x8000, v15
v_mfma_f32_16x16x32_bf16 v[208:211], a[96:99], a[12:15], v[208:211]
v_add_u32 v10, 0x8000, v10
v_add_u32 v11, 0x8000, v11
v_mfma_f32_16x16x32_bf16 v[248:251], a[96:99], a[16:19], v[248:251]
v_lshl_add_u32 v22, s42, 7, v22
v_lshl_add_u32 v23, s42, 7, v23
v_mfma_f32_16x16x32_bf16 v[248:251], a[100:103], a[36:39], v[248:251]
v_mfma_f32_16x16x32_bf16 v[212:215], a[104:107], a[12:15], v[212:215]
s_waitcnt vmcnt(29) lgkmcnt(0)
v_mfma_f32_16x16x32_bf16 v[212:215], a[108:111], a[32:35], v[212:215]
s_barrier
s_add_u32 m0, s17, 0x8000
v_mfma_f32_16x16x32_bf16 v[204:207], a[108:111], a[28:31], v[204:207]
buffer_load_dwordx4 v5, s[52:55], 0 offen lds
v_mfma_f32_16x16x32_bf16 v[204:207], a[104:107], a[8:11], v[204:207]
ds_read_b64_tr_b16 a[96:97], v12 offset:0
v_mfma_f32_16x16x32_bf16 v[196:199], a[104:107], a[4:7], v[196:199]
ds_read_b64_tr_b16 a[98:99], v12 offset:1024
v_mfma_f32_16x16x32_bf16 v[196:199], a[108:111], a[24:27], v[196:199]
ds_read_b64_tr_b16 a[100:101], v12 offset:8192
s_waitcnt lgkmcnt(3)
v_mfma_f32_16x16x32_bf16 v[188:191], a[108:111], a[20:23], v[188:191]
ds_read_b64_tr_b16 a[102:103], v12 offset:9216
s_add_u32 m0, s17, 0x8400
v_mfma_f32_16x16x32_bf16 v[188:191], a[104:107], a[0:3], v[188:191]
buffer_load_dwordx4 v5, s[52:55], s13 offen lds
v_mfma_f32_16x16x32_bf16 v[216:219], a[0:3], a[80:83], v[216:219]
ds_read_b64_tr_b16 a[104:105], v13 offset:0
v_mfma_f32_16x16x32_bf16 v[216:219], a[20:23], a[84:87], v[216:219]
ds_read_b64_tr_b16 a[106:107], v13 offset:1024
v_mfma_f32_16x16x32_bf16 v[224:227], a[24:27], a[84:87], v[224:227]
ds_read_b64_tr_b16 a[108:109], v13 offset:8192
v_mfma_f32_16x16x32_bf16 v[224:227], a[4:7], a[80:83], v[224:227]
ds_read_b64_tr_b16 a[110:111], v13 offset:9216
v_mfma_f32_16x16x32_bf16 v[232:235], a[8:11], a[80:83], v[232:235]
s_add_u32 m0, s17, 0x8800
v_mfma_f32_16x16x32_bf16 v[232:235], a[28:31], a[84:87], v[232:235]
buffer_load_dwordx4 v6, s[52:55], 0 offen lds
v_mfma_f32_16x16x32_bf16 v[240:243], a[32:35], a[84:87], v[240:243]
v_mfma_f32_16x16x32_bf16 v[240:243], a[12:15], a[80:83], v[240:243]
v_mfma_f32_16x16x32_bf16 v[252:255], a[16:19], a[80:83], v[252:255]
v_mfma_f32_16x16x32_bf16 v[252:255], a[36:39], a[84:87], v[252:255]
v_mfma_f32_16x16x32_bf16 v[244:247], a[12:15], a[88:91], v[244:247]
ds_read_b64_tr_b16 a[80:81], v12 offset:256
s_add_u32 m0, s17, 0x8c00
v_mfma_f32_16x16x32_bf16 v[244:247], a[32:35], a[92:95], v[244:247]
buffer_load_dwordx4 v6, s[52:55], s13 offen lds
v_mfma_f32_16x16x32_bf16 v[236:239], a[28:31], a[92:95], v[236:239]
ds_read_b64_tr_b16 a[82:83], v12 offset:1280
v_mfma_f32_16x16x32_bf16 v[236:239], a[8:11], a[88:91], v[236:239]
ds_read_b64_tr_b16 a[84:85], v12 offset:8448
v_mfma_f32_16x16x32_bf16 v[228:231], a[4:7], a[88:91], v[228:231]
ds_read_b64_tr_b16 a[86:87], v12 offset:9472
v_mfma_f32_16x16x32_bf16 v[228:231], a[24:27], a[92:95], v[228:231]
s_add_u32 s8, s28, 0x5800
v_mfma_f32_16x16x32_bf16 v[220:223], a[20:23], a[92:95], v[220:223]
buffer_store_dwordx4 a[124:127], v16, s[88:91], s8 offen sc1
v_mfma_f32_16x16x32_bf16 v[220:223], a[0:3], a[88:91], v[220:223]
s_waitcnt lgkmcnt(4)
L_S17:
v_mfma_f32_16x16x32_bf16 v[24:27], a[96:99], a[40:43], v[24:27]
ds_read_b64_tr_b16 a[88:89], v13 offset:256
s_waitcnt vmcnt(25)
v_mfma_f32_16x16x32_bf16 v[24:27], a[100:103], a[60:63], v[24:27]
ds_read_b64_tr_b16 a[90:91], v13 offset:1280
v_mfma_f32_16x16x32_bf16 v[32:35], a[100:103], a[64:67], v[32:35]
ds_read_b64_tr_b16 a[92:93], v13 offset:8448
v_mfma_f32_16x16x32_bf16 v[32:35], a[96:99], a[44:47], v[32:35]
ds_read_b64_tr_b16 a[94:95], v13 offset:9472
s_add_u32 m0, s18, 0xc000
v_mfma_f32_16x16x32_bf16 v[40:43], a[96:99], a[48:51], v[40:43]
buffer_load_dwordx4 v7, s[68:71], 0 offen lds
v_mfma_f32_16x16x32_bf16 v[40:43], a[100:103], a[68:71], v[40:43]
ds_read_b128 a[0:3], v8 offset:0
v_mfma_f32_16x16x32_bf16 v[48:51], a[100:103], a[72:75], v[48:51]
ds_read_b128 a[20:23], v9 offset:0
v_mfma_f32_16x16x32_bf16 v[48:51], a[96:99], a[52:55], v[48:51]
ds_read_b128 a[4:7], v8 offset:2048
v_mfma_f32_16x16x32_bf16 v[52:55], a[104:107], a[52:55], v[52:55]
ds_read_b64_tr_b16 a[96:97], v12 offset:512
v_mfma_f32_16x16x32_bf16 v[52:55], a[108:111], a[72:75], v[52:55]
ds_read_b64_tr_b16 a[98:99], v12 offset:1536
s_add_u32 m0, s18, 0xd000
v_mfma_f32_16x16x32_bf16 v[44:47], a[108:111], a[68:71], v[44:47]
buffer_load_dwordx4 v7, s[68:71], s25 offen lds
v_mfma_f32_16x16x32_bf16 v[44:47], a[104:107], a[48:51], v[44:47]
ds_read_b64_tr_b16 a[100:101], v12 offset:8704
v_mfma_f32_16x16x32_bf16 v[36:39], a[104:107], a[44:47], v[36:39]
ds_read_b64_tr_b16 a[102:103], v12 offset:9728
v_mfma_f32_16x16x32_bf16 v[36:39], a[108:111], a[64:67], v[36:39]
ds_read_b128 a[24:27], v9 offset:2048
s_waitcnt lgkmcnt(8)
v_mfma_f32_16x16x32_bf16 v[28:31], a[108:111], a[60:63], v[28:31]
ds_read_b128 a[8:11], v8 offset:4096
s_add_u32 m0, s18, 0xe000
v_mfma_f32_16x16x32_bf16 v[28:31], a[104:107], a[40:43], v[28:31]
buffer_load_dwordx4 v7, s[68:71], s26 offen lds
v_mfma_f32_16x16x32_bf16 v[56:59], a[80:83], a[40:43], v[56:59]
ds_read_b64_tr_b16 a[104:105], v13 offset:512
v_mfma_f32_16x16x32_bf16 v[56:59], a[84:87], a[60:63], v[56:59]
ds_read_b64_tr_b16 a[106:107], v13 offset:1536
v_mfma_f32_16x16x32_bf16 v[64:67], a[84:87], a[64:67], v[64:67]
ds_read_b64_tr_b16 a[108:109], v13 offset:8704
v_mfma_f32_16x16x32_bf16 v[64:67], a[80:83], a[44:47], v[64:67]
ds_read_b64_tr_b16 a[110:111], v13 offset:9728
v_mfma_f32_16x16x32_bf16 v[72:75], a[80:83], a[48:51], v[72:75]
ds_read_b128 a[28:31], v9 offset:4096
s_add_u32 m0, s18, 0xf000
v_mfma_f32_16x16x32_bf16 v[72:75], a[84:87], a[68:71], v[72:75]
buffer_load_dwordx4 v4, s[44:47], s24 offen lds
v_mfma_f32_16x16x32_bf16 v[80:83], a[84:87], a[72:75], v[80:83]
ds_read_b128 a[12:15], v8 offset:6144
v_lshl_add_u32 v5, s42, 19, v5
v_mfma_f32_16x16x32_bf16 v[80:83], a[80:83], a[52:55], v[80:83]
ds_read_b128 a[32:35], v9 offset:6144
v_lshl_add_u32 v6, s42, 19, v6
v_mfma_f32_16x16x32_bf16 v[84:87], a[88:91], a[52:55], v[84:87]
ds_read_b64_tr_b16 a[80:81], v12 offset:768
v_lshl_add_u32 v7, s42, 18, v7
v_mfma_f32_16x16x32_bf16 v[84:87], a[92:95], a[72:75], v[84:87]
ds_read_b64_tr_b16 a[82:83], v12 offset:1792
v_lshl_add_u32 v7, s42, 17, v7
v_mfma_f32_16x16x32_bf16 v[76:79], a[92:95], a[68:71], v[76:79]
ds_read_b64_tr_b16 a[84:85], v12 offset:8960
s_add_u32 s8, s28, 0x9800
v_mfma_f32_16x16x32_bf16 v[76:79], a[88:91], a[48:51], v[76:79]
buffer_store_dwordx4 a[232:235], v16, s[88:91], s8 offen sc1
v_mfma_f32_16x16x32_bf16 v[68:71], a[88:91], a[44:47], v[68:71]
ds_read_b64_tr_b16 a[86:87], v12 offset:9984
v_lshl_add_u32 v4, s42, 7, v4
v_mfma_f32_16x16x32_bf16 v[68:71], a[92:95], a[64:67], v[68:71]
ds_read_b128 a[56:59], v10
L_padA9:
s_cmp_eq_u32 s95, 1
s_cbranch_scc1 L_padA13
v_mfma_f32_16x16x32_bf16 v[60:63], a[92:95], a[60:63], v[60:63]
ds_read_b128 a[76:79], v11
v_mfma_f32_16x16x32_bf16 v[60:63], a[88:91], a[40:43], v[60:63]
s_waitcnt lgkmcnt(6)
s_waitcnt lgkmcnt(9)
v_mfma_f32_16x16x32_bf16 v[88:91], a[96:99], a[40:43], v[88:91]
ds_read_b64_tr_b16 a[88:89], v13 offset:768
s_add_u32 m0, s16, 0x0
v_mfma_f32_16x16x32_bf16 v[88:91], a[100:103], a[60:63], v[88:91]
buffer_load_dwordx4 v22, s[44:47], s20 offen lds
v_mfma_f32_16x16x32_bf16 v[96:99], a[100:103], a[64:67], v[96:99]
ds_read_b64_tr_b16 a[90:91], v13 offset:1792
v_mfma_f32_16x16x32_bf16 v[96:99], a[96:99], a[44:47], v[96:99]
ds_read_b64_tr_b16 a[92:93], v13 offset:8960
v_mfma_f32_16x16x32_bf16 v[104:107], a[96:99], a[48:51], v[104:107]
ds_read_b64_tr_b16 a[94:95], v13 offset:9984
v_mfma_f32_16x16x32_bf16 v[104:107], a[100:103], a[68:71], v[104:107]
s_add_u32 m0, s16, 0x400
v_mfma_f32_16x16x32_bf16 v[112:115], a[100:103], a[72:75], v[112:115]
buffer_load_dwordx4 v23, s[44:47], s20 offen lds
v_mfma_f32_16x16x32_bf16 v[112:115], a[96:99], a[52:55], v[112:115]
v_mfma_f32_16x16x32_bf16 v[116:119], a[104:107], a[52:55], v[116:119]
ds_read_b64_tr_b16 a[96:97], v14 offset:0
v_mfma_f32_16x16x32_bf16 v[116:119], a[108:111], a[72:75], v[116:119]
ds_read_b64_tr_b16 a[98:99], v14 offset:256
v_mfma_f32_16x16x32_bf16 v[108:111], a[108:111], a[68:71], v[108:111]
ds_read_b64_tr_b16 a[100:101], v14 offset:2048
v_mfma_f32_16x16x32_bf16 v[108:111], a[104:107], a[48:51], v[108:111]
ds_read_b64_tr_b16 a[102:103], v14 offset:2304
s_add_u32 m0, s16, 0x800
v_mfma_f32_16x16x32_bf16 v[100:103], a[104:107], a[44:47], v[100:103]
buffer_load_dwordx4 v22, s[44:47], s21 offen lds
v_mfma_f32_16x16x32_bf16 v[100:103], a[108:111], a[64:67], v[100:103]
v_mfma_f32_16x16x32_bf16 v[92:95], a[108:111], a[60:63], v[92:95]
v_mfma_f32_16x16x32_bf16 v[92:95], a[104:107], a[40:43], v[92:95]
s_waitcnt lgkmcnt(4)
v_mfma_f32_16x16x32_bf16 v[120:123], a[80:83], a[40:43], v[120:123]
ds_read_b64_tr_b16 a[104:105], v15 offset:0
v_mfma_f32_16x16x32_bf16 v[120:123], a[84:87], a[60:63], v[120:123]
ds_read_b64_tr_b16 a[106:107], v15 offset:256
s_add_u32 m0, s16, 0xc00
v_mfma_f32_16x16x32_bf16 v[128:131], a[84:87], a[64:67], v[128:131]
buffer_load_dwordx4 v23, s[44:47], s21 offen lds
v_mfma_f32_16x16x32_bf16 v[128:131], a[80:83], a[44:47], v[128:131]
ds_read_b64_tr_b16 a[108:109], v15 offset:2048
v_mfma_f32_16x16x32_bf16 v[136:139], a[80:83], a[48:51], v[136:139]
ds_read_b64_tr_b16 a[110:111], v15 offset:2304
v_mfma_f32_16x16x32_bf16 v[136:139], a[84:87], a[68:71], v[136:139]
v_mfma_f32_16x16x32_bf16 v[144:147], a[84:87], a[72:75], v[144:147]
s_add_u32 s8, s28, 0x5c00
v_mfma_f32_16x16x32_bf16 v[144:147], a[80:83], a[52:55], v[144:147]
buffer_store_dwordx4 a[240:243], v16, s[88:91], s8 offen sc1
v_mfma_f32_16x16x32_bf16 v[148:151], a[88:91], a[52:55], v[148:151]
ds_read_b64_tr_b16 a[80:81], v14 offset:4096
v_mfma_f32_16x16x32_bf16 v[148:151], a[92:95], a[72:75], v[148:151]
ds_read_b64_tr_b16 a[82:83], v14 offset:4352
v_mfma_f32_16x16x32_bf16 v[140:143], a[92:95], a[68:71], v[140:143]
ds_read_b64_tr_b16 a[84:85], v14 offset:6144
v_mfma_f32_16x16x32_bf16 v[140:143], a[88:91], a[48:51], v[140:143]
ds_read_b64_tr_b16 a[86:87], v14 offset:6400
v_mfma_f32_16x16x32_bf16 v[132:135], a[88:91], a[44:47], v[132:135]
s_add_u32 m0, s16, 0x1000
v_mfma_f32_16x16x32_bf16 v[132:135], a[92:95], a[64:67], v[132:135]
buffer_load_dwordx4 v22, s[44:47], s22 offen lds
v_mfma_f32_16x16x32_bf16 v[124:127], a[92:95], a[60:63], v[124:127]
v_mfma_f32_16x16x32_bf16 v[124:127], a[88:91], a[40:43], v[124:127]
s_waitcnt lgkmcnt(4)
v_mfma_f32_16x16x32_bf16 v[152:155], a[96:99], a[40:43], v[152:155]
ds_read_b64_tr_b16 a[88:89], v15 offset:4096
v_mfma_f32_16x16x32_bf16 v[152:155], a[100:103], a[60:63], v[152:155]
ds_read_b64_tr_b16 a[90:91], v15 offset:4352
v_mfma_f32_16x16x32_bf16 v[160:163], a[100:103], a[64:67], v[160:163]
ds_read_b64_tr_b16 a[92:93], v15 offset:6144
s_add_u32 m0, s16, 0x1400
v_mfma_f32_16x16x32_bf16 v[160:163], a[96:99], a[44:47], v[160:163]
buffer_load_dwordx4 v23, s[44:47], s22 offen lds
v_mfma_f32_16x16x32_bf16 v[168:171], a[96:99], a[48:51], v[168:171]
ds_read_b64_tr_b16 a[94:95], v15 offset:6400
v_mfma_f32_16x16x32_bf16 v[168:171], a[100:103], a[68:71], v[168:171]
v_mfma_f32_16x16x32_bf16 v[176:179], a[100:103], a[72:75], v[176:179]
v_mfma_f32_16x16x32_bf16 v[176:179], a[96:99], a[52:55], v[176:179]
s_add_u32 m0, s16, 0x1800
v_mfma_f32_16x16x32_bf16 v[180:183], a[104:107], a[52:55], v[180:183]
buffer_load_dwordx4 v22, s[44:47], s23 offen lds
v_mfma_f32_16x16x32_bf16 v[180:183], a[108:111], a[72:75], v[180:183]
ds_read_b64_tr_b16 a[96:97], v14 offset:8192
v_mfma_f32_16x16x32_bf16 v[172:175], a[108:111], a[68:71], v[172:175]
ds_read_b64_tr_b16 a[98:99], v14 offset:8448
v_mfma_f32_16x16x32_bf16 v[172:175], a[104:107], a[48:51], v[172:175]
ds_read_b64_tr_b16 a[100:101], v14 offset:10240
v_mfma_f32_16x16x32_bf16 v[164:167], a[104:107], a[44:47], v[164:167]
ds_read_b64_tr_b16 a[102:103], v14 offset:10496
v_mfma_f32_16x16x32_bf16 v[164:167], a[108:111], a[64:67], v[164:167]
s_add_u32 m0, s16, 0x1c00
v_mfma_f32_16x16x32_bf16 v[156:159], a[108:111], a[60:63], v[156:159]
buffer_load_dwordx4 v23, s[44:47], s23 offen lds
v_mfma_f32_16x16x32_bf16 v[156:159], a[104:107], a[40:43], v[156:159]
s_waitcnt lgkmcnt(4)
s_bfe_u32 s39, s40, 0x80008
s_add_u32 s39, s39, s41
v_mfma_f32_16x16x32_bf16 v[184:187], a[80:83], a[40:43], v[184:187]
ds_read_b64_tr_b16 a[104:105], v15 offset:8192
s_and_b32 s39, s39, 15
v_mfma_f32_16x16x32_bf16 v[184:187], a[84:87], a[60:63], v[184:187]
ds_read_b64_tr_b16 a[106:107], v15 offset:8448
s_sub_u32 s42, s39, s41
v_mfma_f32_16x16x32_bf16 v[192:195], a[84:87], a[64:67], v[192:195]
ds_read_b64_tr_b16 a[108:109], v15 offset:10240
s_mov_b32 s41, s39
v_mfma_f32_16x16x32_bf16 v[192:195], a[80:83], a[44:47], v[192:195]
ds_read_b64_tr_b16 a[110:111], v15 offset:10496
s_add_u32 s8, s28, 0x9c00
v_mfma_f32_16x16x32_bf16 v[200:203], a[80:83], a[48:51], v[200:203]
buffer_store_dwordx4 a[248:251], v16, s[88:91], s8 offen sc1
v_mfma_f32_16x16x32_bf16 v[200:203], a[84:87], a[68:71], v[200:203]
v_add_u32 v12, 0xffff0000, v12
v_add_u32 v13, 0xffff0000, v13
v_mfma_f32_16x16x32_bf16 v[208:211], a[84:87], a[72:75], v[208:211]
v_add_u32 v14, 0xffff0000, v14
v_add_u32 v15, 0xffff0000, v15
v_mfma_f32_16x16x32_bf16 v[208:211], a[80:83], a[52:55], v[208:211]
v_add_u32 v10, 0xffff0000, v10
v_add_u32 v11, 0xffff0000, v11
v_mfma_f32_16x16x32_bf16 v[248:251], a[80:83], a[56:59], v[248:251]
v_lshl_add_u32 v22, s42, 7, v22
v_lshl_add_u32 v23, s42, 7, v23
v_mfma_f32_16x16x32_bf16 v[248:251], a[84:87], a[76:79], v[248:251]
v_mfma_f32_16x16x32_bf16 v[212:215], a[88:91], a[52:55], v[212:215]
s_waitcnt vmcnt(30) lgkmcnt(0)
v_mfma_f32_16x16x32_bf16 v[212:215], a[92:95], a[72:75], v[212:215]
s_barrier
s_add_u32 m0, s17, 0x10000
v_mfma_f32_16x16x32_bf16 v[204:207], a[92:95], a[68:71], v[204:207]
buffer_load_dwordx4 v5, s[52:55], 0 offen lds
v_mfma_f32_16x16x32_bf16 v[204:207], a[88:91], a[48:51], v[204:207]
ds_read_b64_tr_b16 a[80:81], v12 offset:0
v_mfma_f32_16x16x32_bf16 v[196:199], a[88:91], a[44:47], v[196:199]
ds_read_b64_tr_b16 a[82:83], v12 offset:1024
v_mfma_f32_16x16x32_bf16 v[196:199], a[92:95], a[64:67], v[196:199]
ds_read_b64_tr_b16 a[84:85], v12 offset:8192
s_waitcnt lgkmcnt(3)
v_mfma_f32_16x16x32_bf16 v[188:191], a[92:95], a[60:63], v[188:191]
ds_read_b64_tr_b16 a[86:87], v12 offset:9216
s_add_u32 m0, s17, 0x10400
v_mfma_f32_16x16x32_bf16 v[188:191], a[88:91], a[40:43], v[188:191]
buffer_load_dwordx4 v5, s[52:55], s13 offen lds
v_mfma_f32_16x16x32_bf16 v[216:219], a[40:43], a[96:99], v[216:219]
ds_read_b64_tr_b16 a[88:89], v13 offset:0
v_mfma_f32_16x16x32_bf16 v[216:219], a[60:63], a[100:103], v[216:219]
ds_read_b64_tr_b16 a[90:91], v13 offset:1024
v_mfma_f32_16x16x32_bf16 v[224:227], a[64:67], a[100:103], v[224:227]
ds_read_b64_tr_b16 a[92:93], v13 offset:8192
v_mfma_f32_16x16x32_bf16 v[224:227], a[44:47], a[96:99], v[224:227]
ds_read_b64_tr_b16 a[94:95], v13 offset:9216
v_mfma_f32_16x16x32_bf16 v[232:235], a[48:51], a[96:99], v[232:235]
s_add_u32 m0, s17, 0x10800
v_mfma_f32_16x16x32_bf16 v[232:235], a[68:71], a[100:103], v[232:235]
buffer_load_dwordx4 v6, s[52:55], 0 offen lds
v_mfma_f32_16x16x32_bf16 v[240:243], a[72:75], a[100:103], v[240:243]
v_mfma_f32_16x16x32_bf16 v[240:243], a[52:55], a[96:99], v[240:243]
v_mfma_f32_16x16x32_bf16 v[252:255], a[56:59], a[96:99], v[252:255]
v_mfma_f32_16x16x32_bf16 v[252:255], a[76:79], a[100:103], v[252:255]
v_mfma_f32_16x16x32_bf16 v[244:247], a[52:55], a[104:107], v[244:247]
ds_read_b64_tr_b16 a[96:97], v12 offset:256
s_add_u32 m0, s17, 0x10c00
v_mfma_f32_16x16x32_bf16 v[244:247], a[72:75], a[108:111], v[244:247]
buffer_load_dwordx4 v6, s[52:55], s13 offen lds
v_mfma_f32_16x16x32_bf16 v[236:239], a[68:71], a[108:111], v[236:239]
ds_read_b64_tr_b16 a[98:99], v12 offset:1280
v_mfma_f32_16x16x32_bf16 v[236:239], a[48:51], a[104:107], v[236:239]
ds_read_b64_tr_b16 a[100:101], v12 offset:8448
v_mfma_f32_16x16x32_bf16 v[228:231], a[44:47], a[104:107], v[228:231]
ds_read_b64_tr_b16 a[102:103], v12 offset:9472
v_mfma_f32_16x16x32_bf16 v[228:231], a[64:67], a[108:111], v[228:231]
v_mfma_f32_16x16x32_bf16 v[220:223], a[60:63], a[108:111], v[220:223]
buffer_load_dwordx4 a[128:131], v16, s[44:47], s100 offen offset:0
v_mfma_f32_16x16x32_bf16 v[220:223], a[40:43], a[104:107], v[220:223]
s_waitcnt lgkmcnt(4)
L_S18:
v_mfma_f32_16x16x32_bf16 v[24:27], a[80:83], a[0:3], v[24:27]
ds_read_b64_tr_b16 a[104:105], v13 offset:256
s_waitcnt vmcnt(26)
v_mfma_f32_16x16x32_bf16 v[24:27], a[84:87], a[20:23], v[24:27]
ds_read_b64_tr_b16 a[106:107], v13 offset:1280
v_mfma_f32_16x16x32_bf16 v[32:35], a[84:87], a[24:27], v[32:35]
ds_read_b64_tr_b16 a[108:109], v13 offset:8448
v_mfma_f32_16x16x32_bf16 v[32:35], a[80:83], a[4:7], v[32:35]
ds_read_b64_tr_b16 a[110:111], v13 offset:9472
s_add_u32 m0, s18, 0x14000
v_mfma_f32_16x16x32_bf16 v[40:43], a[80:83], a[8:11], v[40:43]
buffer_load_dwordx4 v7, s[68:71], 0 offen lds
v_mfma_f32_16x16x32_bf16 v[40:43], a[84:87], a[28:31], v[40:43]
ds_read_b128 a[40:43], v8 offset:32768
v_mfma_f32_16x16x32_bf16 v[48:51], a[84:87], a[32:35], v[48:51]
ds_read_b128 a[60:63], v9 offset:32768
v_mfma_f32_16x16x32_bf16 v[48:51], a[80:83], a[12:15], v[48:51]
ds_read_b128 a[44:47], v8 offset:34816
v_mfma_f32_16x16x32_bf16 v[52:55], a[88:91], a[12:15], v[52:55]
ds_read_b64_tr_b16 a[80:81], v12 offset:512
v_mfma_f32_16x16x32_bf16 v[52:55], a[92:95], a[32:35], v[52:55]
ds_read_b64_tr_b16 a[82:83], v12 offset:1536
s_add_u32 m0, s18, 0x15000
v_mfma_f32_16x16x32_bf16 v[44:47], a[92:95], a[28:31], v[44:47]
buffer_load_dwordx4 v7, s[68:71], s25 offen lds
v_mfma_f32_16x16x32_bf16 v[44:47], a[88:91], a[8:11], v[44:47]
ds_read_b64_tr_b16 a[84:85], v12 offset:8704
v_mfma_f32_16x16x32_bf16 v[36:39], a[88:91], a[4:7], v[36:39]
ds_read_b64_tr_b16 a[86:87], v12 offset:9728
v_mfma_f32_16x16x32_bf16 v[36:39], a[92:95], a[24:27], v[36:39]
ds_read_b128 a[64:67], v9 offset:34816
s_waitcnt lgkmcnt(8)
v_mfma_f32_16x16x32_bf16 v[28:31], a[92:95], a[20:23], v[28:31]
ds_read_b128 a[48:51], v8 offset:36864
s_add_u32 m0, s18, 0x16000
v_mfma_f32_16x16x32_bf16 v[28:31], a[88:91], a[0:3], v[28:31]
buffer_load_dwordx4 v7, s[68:71], s26 offen lds
v_mfma_f32_16x16x32_bf16 v[56:59], a[96:99], a[0:3], v[56:59]
ds_read_b64_tr_b16 a[88:89], v13 offset:512
v_mfma_f32_16x16x32_bf16 v[56:59], a[100:103], a[20:23], v[56:59]
ds_read_b64_tr_b16 a[90:91], v13 offset:1536
v_mfma_f32_16x16x32_bf16 v[64:67], a[100:103], a[24:27], v[64:67]
ds_read_b64_tr_b16 a[92:93], v13 offset:8704
v_mfma_f32_16x16x32_bf16 v[64:67], a[96:99], a[4:7], v[64:67]
ds_read_b64_tr_b16 a[94:95], v13 offset:9728
v_mfma_f32_16x16x32_bf16 v[72:75], a[96:99], a[8:11], v[72:75]
ds_read_b128 a[68:71], v9 offset:36864
s_add_u32 m0, s18, 0x17000
v_mfma_f32_16x16x32_bf16 v[72:75], a[100:103], a[28:31], v[72:75]
buffer_load_dwordx4 v4, s[44:47], s24 offen lds
v_mfma_f32_16x16x32_bf16 v[80:83], a[100:103], a[32:35], v[80:83]
ds_read_b128 a[52:55], v8 offset:38912
v_lshl_add_u32 v5, s42, 19, v5
v_mfma_f32_16x16x32_bf16 v[80:83], a[96:99], a[12:15], v[80:83]
ds_read_b128 a[72:75], v9 offset:38912
v_lshl_add_u32 v6, s42, 19, v6
v_mfma_f32_16x16x32_bf16 v[84:87], a[104:107], a[12:15], v[84:87]
ds_read_b64_tr_b16 a[96:97], v12 offset:768
v_lshl_add_u32 v7, s42, 18, v7
v_mfma_f32_16x16x32_bf16 v[84:87], a[108:111], a[32:35], v[84:87]
ds_read_b64_tr_b16 a[98:99], v12 offset:1792
v_lshl_add_u32 v7, s42, 17, v7
v_mfma_f32_16x16x32_bf16 v[76:79], a[108:111], a[28:31], v[76:79]
ds_read_b64_tr_b16 a[100:101], v12 offset:8960
v_lshl_add_u32 v4, s42, 7, v4
v_mfma_f32_16x16x32_bf16 v[76:79], a[104:107], a[8:11], v[76:79]
buffer_load_dwordx4 a[132:135], v16, s[44:47], s100 offen offset:1024
v_mfma_f32_16x16x32_bf16 v[68:71], a[104:107], a[4:7], v[68:71]
ds_read_b64_tr_b16 a[102:103], v12 offset:9984
v_mfma_f32_16x16x32_bf16 v[68:71], a[108:111], a[24:27], v[68:71]
ds_read_b128 a[16:19], v10
v_mfma_f32_16x16x32_bf16 v[60:63], a[108:111], a[20:23], v[60:63]
ds_read_b128 a[36:39], v11
v_mfma_f32_16x16x32_bf16 v[60:63], a[104:107], a[0:3], v[60:63]
s_waitcnt lgkmcnt(6)
s_waitcnt lgkmcnt(9)
v_mfma_f32_16x16x32_bf16 v[88:91], a[80:83], a[0:3], v[88:91]
ds_read_b64_tr_b16 a[104:105], v13 offset:768
s_add_u32 m0, s16, 0x8000
v_mfma_f32_16x16x32_bf16 v[88:91], a[84:87], a[20:23], v[88:91]
buffer_load_dwordx4 v22, s[44:47], s20 offen lds
v_mfma_f32_16x16x32_bf16 v[96:99], a[84:87], a[24:27], v[96:99]
ds_read_b64_tr_b16 a[106:107], v13 offset:1792
v_mfma_f32_16x16x32_bf16 v[96:99], a[80:83], a[4:7], v[96:99]
ds_read_b64_tr_b16 a[108:109], v13 offset:8960
v_mfma_f32_16x16x32_bf16 v[104:107], a[80:83], a[8:11], v[104:107]
ds_read_b64_tr_b16 a[110:111], v13 offset:9984
v_mfma_f32_16x16x32_bf16 v[104:107], a[84:87], a[28:31], v[104:107]
s_add_u32 m0, s16, 0x8400
v_mfma_f32_16x16x32_bf16 v[112:115], a[84:87], a[32:35], v[112:115]
buffer_load_dwordx4 v23, s[44:47], s20 offen lds
v_mfma_f32_16x16x32_bf16 v[112:115], a[80:83], a[12:15], v[112:115]
v_mfma_f32_16x16x32_bf16 v[116:119], a[88:91], a[12:15], v[116:119]
ds_read_b64_tr_b16 a[80:81], v14 offset:0
v_mfma_f32_16x16x32_bf16 v[116:119], a[92:95], a[32:35], v[116:119]
ds_read_b64_tr_b16 a[82:83], v14 offset:256
v_mfma_f32_16x16x32_bf16 v[108:111], a[92:95], a[28:31], v[108:111]
ds_read_b64_tr_b16 a[84:85], v14 offset:2048
v_mfma_f32_16x16x32_bf16 v[108:111], a[88:91], a[8:11], v[108:111]
ds_read_b64_tr_b16 a[86:87], v14 offset:2304
s_add_u32 m0, s16, 0x8800
v_mfma_f32_16x16x32_bf16 v[100:103], a[88:91], a[4:7], v[100:103]
buffer_load_dwordx4 v22, s[44:47], s21 offen lds
v_mfma_f32_16x16x32_bf16 v[100:103], a[92:95], a[24:27], v[100:103]
v_mfma_f32_16x16x32_bf16 v[92:95], a[92:95], a[20:23], v[92:95]
v_mfma_f32_16x16x32_bf16 v[92:95], a[88:91], a[0:3], v[92:95]
s_waitcnt lgkmcnt(4)
v_mfma_f32_16x16x32_bf16 v[120:123], a[96:99], a[0:3], v[120:123]
ds_read_b64_tr_b16 a[88:89], v15 offset:0
v_mfma_f32_16x16x32_bf16 v[120:123], a[100:103], a[20:23], v[120:123]
ds_read_b64_tr_b16 a[90:91], v15 offset:256
s_add_u32 m0, s16, 0x8c00
v_mfma_f32_16x16x32_bf16 v[128:131], a[100:103], a[24:27], v[128:131]
buffer_load_dwordx4 v23, s[44:47], s21 offen lds
v_mfma_f32_16x16x32_bf16 v[128:131], a[96:99], a[4:7], v[128:131]
ds_read_b64_tr_b16 a[92:93], v15 offset:2048
v_mfma_f32_16x16x32_bf16 v[136:139], a[96:99], a[8:11], v[136:139]
ds_read_b64_tr_b16 a[94:95], v15 offset:2304
v_mfma_f32_16x16x32_bf16 v[136:139], a[100:103], a[28:31], v[136:139]
v_mfma_f32_16x16x32_bf16 v[144:147], a[100:103], a[32:35], v[144:147]
v_mfma_f32_16x16x32_bf16 v[144:147], a[96:99], a[12:15], v[144:147]
buffer_load_dwordx4 a[136:139], v16, s[44:47], s100 offen offset:2048
v_mfma_f32_16x16x32_bf16 v[148:151], a[104:107], a[12:15], v[148:151]
ds_read_b64_tr_b16 a[96:97], v14 offset:4096
v_mfma_f32_16x16x32_bf16 v[148:151], a[108:111], a[32:35], v[148:151]
ds_read_b64_tr_b16 a[98:99], v14 offset:4352
v_mfma_f32_16x16x32_bf16 v[140:143], a[108:111], a[28:31], v[140:143]
ds_read_b64_tr_b16 a[100:101], v14 offset:6144
v_mfma_f32_16x16x32_bf16 v[140:143], a[104:107], a[8:11], v[140:143]
ds_read_b64_tr_b16 a[102:103], v14 offset:6400
v_mfma_f32_16x16x32_bf16 v[132:135], a[104:107], a[4:7], v[132:135]
s_add_u32 m0, s16, 0x9000
v_mfma_f32_16x16x32_bf16 v[132:135], a[108:111], a[24:27], v[132:135]
buffer_load_dwordx4 v22, s[44:47], s22 offen lds
v_mfma_f32_16x16x32_bf16 v[124:127], a[108:111], a[20:23], v[124:127]
v_mfma_f32_16x16x32_bf16 v[124:127], a[104:107], a[0:3], v[124:127]
s_waitcnt lgkmcnt(4)
v_mfma_f32_16x16x32_bf16 v[152:155], a[80:83], a[0:3], v[152:155]
ds_read_b64_tr_b16 a[104:105], v15 offset:4096
v_mfma_f32_16x16x32_bf16 v[152:155], a[84:87], a[20:23], v[152:155]
ds_read_b64_tr_b16 a[106:107], v15 offset:4352
v_mfma_f32_16x16x32_bf16 v[160:163], a[84:87], a[24:27], v[160:163]
ds_read_b64_tr_b16 a[108:109], v15 offset:6144
s_add_u32 m0, s16, 0x9400
v_mfma_f32_16x16x32_bf16 v[160:163], a[80:83], a[4:7], v[160:163]
buffer_load_dwordx4 v23, s[44:47], s22 offen lds
v_mfma_f32_16x16x32_bf16 v[168:171], a[80:83], a[8:11], v[168:171]
ds_read_b64_tr_b16 a[110:111], v15 offset:6400
v_mfma_f32_16x16x32_bf16 v[168:171], a[84:87], a[28:31], v[168:171]
v_mfma_f32_16x16x32_bf16 v[176:179], a[84:87], a[32:35], v[176:179]
v_mfma_f32_16x16x32_bf16 v[176:179], a[80:83], a[12:15], v[176:179]
s_add_u32 m0, s16, 0x9800
v_mfma_f32_16x16x32_bf16 v[180:183], a[88:91], a[12:15], v[180:183]
buffer_load_dwordx4 v22, s[44:47], s23 offen lds
v_mfma_f32_16x16x32_bf16 v[180:183], a[92:95], a[32:35], v[180:183]
ds_read_b64_tr_b16 a[80:81], v14 offset:8192
v_mfma_f32_16x16x32_bf16 v[172:175], a[92:95], a[28:31], v[172:175]
ds_read_b64_tr_b16 a[82:83], v14 offset:8448
v_mfma_f32_16x16x32_bf16 v[172:175], a[88:91], a[8:11], v[172:175]
ds_read_b64_tr_b16 a[84:85], v14 offset:10240
v_mfma_f32_16x16x32_bf16 v[164:167], a[88:91], a[4:7], v[164:167]
ds_read_b64_tr_b16 a[86:87], v14 offset:10496
v_mfma_f32_16x16x32_bf16 v[164:167], a[92:95], a[24:27], v[164:167]
s_add_u32 m0, s16, 0x9c00
v_mfma_f32_16x16x32_bf16 v[156:159], a[92:95], a[20:23], v[156:159]
buffer_load_dwordx4 v23, s[44:47], s23 offen lds
v_mfma_f32_16x16x32_bf16 v[156:159], a[88:91], a[0:3], v[156:159]
s_waitcnt lgkmcnt(4)
s_bfe_u32 s39, s40, 0x80010
s_add_u32 s39, s39, s41
v_mfma_f32_16x16x32_bf16 v[184:187], a[96:99], a[0:3], v[184:187]
ds_read_b64_tr_b16 a[88:89], v15 offset:8192
s_and_b32 s39, s39, 15
v_mfma_f32_16x16x32_bf16 v[184:187], a[100:103], a[20:23], v[184:187]
ds_read_b64_tr_b16 a[90:91], v15 offset:8448
s_sub_u32 s42, s39, s41
v_mfma_f32_16x16x32_bf16 v[192:195], a[100:103], a[24:27], v[192:195]
ds_read_b64_tr_b16 a[92:93], v15 offset:10240
v_mov_b32 v21, s1
v_mfma_f32_16x16x32_bf16 v[192:195], a[96:99], a[4:7], v[192:195]
ds_read_b64_tr_b16 a[94:95], v15 offset:10496
v_add_u32 v20, s0, v16
v_mfma_f32_16x16x32_bf16 v[200:203], a[96:99], a[8:11], v[200:203]
global_load_dword a120, v[20:21], off sc1
v_mfma_f32_16x16x32_bf16 v[200:203], a[100:103], a[28:31], v[200:203]
s_mov_b32 s41, s39
v_add_u32 v12, 0x8000, v12
v_add_u32 v13, 0x8000, v13
v_mfma_f32_16x16x32_bf16 v[208:211], a[100:103], a[32:35], v[208:211]
v_add_u32 v14, 0x8000, v14
v_add_u32 v15, 0x8000, v15
v_mfma_f32_16x16x32_bf16 v[208:211], a[96:99], a[12:15], v[208:211]
v_add_u32 v10, 0x8000, v10
v_add_u32 v11, 0x8000, v11
v_mfma_f32_16x16x32_bf16 v[248:251], a[96:99], a[16:19], v[248:251]
v_lshl_add_u32 v22, s42, 7, v22
v_lshl_add_u32 v23, s42, 7, v23
v_mfma_f32_16x16x32_bf16 v[248:251], a[100:103], a[36:39], v[248:251]
v_mfma_f32_16x16x32_bf16 v[212:215], a[104:107], a[12:15], v[212:215]
s_waitcnt vmcnt(20) lgkmcnt(0)
v_mfma_f32_16x16x32_bf16 v[212:215], a[108:111], a[32:35], v[212:215]
s_barrier
s_add_u32 m0, s17, 0x0
s_cmp_lg_u32 s4, 0
s_cbranch_scc1 L_sig_kv
v_mov_b32 v20, 1
s_mov_b64 exec, 1
buffer_atomic_add v20, off, s[84:87], s10 sc1
s_mov_b64 exec, -1
L_sig_kv:
v_mfma_f32_16x16x32_bf16 v[204:207], a[108:111], a[28:31], v[204:207]
buffer_load_dwordx4 v5, s[52:55], 0 offen lds
v_mfma_f32_16x16x32_bf16 v[204:207], a[104:107], a[8:11], v[204:207]
ds_read_b64_tr_b16 a[96:97], v12 offset:0
v_mfma_f32_16x16x32_bf16 v[196:199], a[104:107], a[4:7], v[196:199]
ds_read_b64_tr_b16 a[98:99], v12 offset:1024
v_mfma_f32_16x16x32_bf16 v[196:199], a[108:111], a[24:27], v[196:199]
ds_read_b64_tr_b16 a[100:101], v12 offset:8192
v_mfma_f32_16x16x32_bf16 v[188:191], a[108:111], a[20:23], v[188:191]
ds_read_b64_tr_b16 a[102:103], v12 offset:9216
v_mfma_f32_16x16x32_bf16 v[188:191], a[104:107], a[0:3], v[188:191]
s_add_u32 m0, s17, 0x400
s_waitcnt lgkmcnt(4)
v_mfma_f32_16x16x32_bf16 v[216:219], a[0:3], a[80:83], v[216:219]
buffer_load_dwordx4 v5, s[52:55], s13 offen lds
v_mfma_f32_16x16x32_bf16 v[216:219], a[20:23], a[84:87], v[216:219]
ds_read_b64_tr_b16 a[104:105], v13 offset:0
v_mfma_f32_16x16x32_bf16 v[224:227], a[24:27], a[84:87], v[224:227]
ds_read_b64_tr_b16 a[106:107], v13 offset:1024
v_mfma_f32_16x16x32_bf16 v[224:227], a[4:7], a[80:83], v[224:227]
ds_read_b64_tr_b16 a[108:109], v13 offset:8192
v_mfma_f32_16x16x32_bf16 v[232:235], a[8:11], a[80:83], v[232:235]
ds_read_b64_tr_b16 a[110:111], v13 offset:9216
v_mfma_f32_16x16x32_bf16 v[232:235], a[28:31], a[84:87], v[232:235]
s_add_u32 m0, s17, 0x800
v_mfma_f32_16x16x32_bf16 v[240:243], a[32:35], a[84:87], v[240:243]
buffer_load_dwordx4 v6, s[52:55], 0 offen lds
v_mfma_f32_16x16x32_bf16 v[240:243], a[12:15], a[80:83], v[240:243]
v_mfma_f32_16x16x32_bf16 v[252:255], a[16:19], a[80:83], v[252:255]
v_mfma_f32_16x16x32_bf16 v[252:255], a[36:39], a[84:87], v[252:255]
v_mfma_f32_16x16x32_bf16 v[244:247], a[12:15], a[88:91], v[244:247]
ds_read_b64_tr_b16 a[80:81], v12 offset:256
v_mfma_f32_16x16x32_bf16 v[244:247], a[32:35], a[92:95], v[244:247]
ds_read_b64_tr_b16 a[82:83], v12 offset:1280
s_add_u32 m0, s17, 0xc00
v_mfma_f32_16x16x32_bf16 v[236:239], a[28:31], a[92:95], v[236:239]
buffer_load_dwordx4 v6, s[52:55], s13 offen lds
v_mfma_f32_16x16x32_bf16 v[236:239], a[8:11], a[88:91], v[236:239]
ds_read_b64_tr_b16 a[84:85], v12 offset:8448
v_mfma_f32_16x16x32_bf16 v[228:231], a[4:7], a[88:91], v[228:231]
ds_read_b64_tr_b16 a[86:87], v12 offset:9472
v_mfma_f32_16x16x32_bf16 v[228:231], a[24:27], a[92:95], v[228:231]
v_mfma_f32_16x16x32_bf16 v[220:223], a[20:23], a[92:95], v[220:223]
v_mfma_f32_16x16x32_bf16 v[220:223], a[0:3], a[88:91], v[220:223]
s_add_u32 m0, s18, 0x4000
s_waitcnt lgkmcnt(4)
L_S19:
v_mfma_f32_16x16x32_bf16 v[24:27], a[96:99], a[40:43], v[24:27]
buffer_load_dwordx4 v7, s[68:71], 0 offen lds
v_mfma_f32_16x16x32_bf16 v[24:27], a[100:103], a[60:63], v[24:27]
ds_read_b64_tr_b16 a[88:89], v13 offset:256
s_waitcnt vmcnt(26)
v_mfma_f32_16x16x32_bf16 v[32:35], a[100:103], a[64:67], v[32:35]
ds_read_b64_tr_b16 a[90:91], v13 offset:1280
v_mfma_f32_16x16x32_bf16 v[32:35], a[96:99], a[44:47], v[32:35]
ds_read_b64_tr_b16 a[92:93], v13 offset:8448
v_mfma_f32_16x16x32_bf16 v[40:43], a[96:99], a[48:51], v[40:43]
ds_read_b64_tr_b16 a[94:95], v13 offset:9472
v_mfma_f32_16x16x32_bf16 v[40:43], a[100:103], a[68:71], v[40:43]
ds_read_b128 a[0:3], v8 offset:0
v_mfma_f32_16x16x32_bf16 v[48:51], a[100:103], a[72:75], v[48:51]
buffer_load_dwordx4 a[140:143], v16, s[44:47], s100 offen offset:3072
v_mfma_f32_16x16x32_bf16 v[48:51], a[96:99], a[52:55], v[48:51]
ds_read_b128 a[20:23], v9 offset:0
v_mfma_f32_16x16x32_bf16 v[52:55], a[104:107], a[52:55], v[52:55]
ds_read_b64_tr_b16 a[96:97], v12 offset:512
v_mfma_f32_16x16x32_bf16 v[52:55], a[108:111], a[72:75], v[52:55]
ds_read_b64_tr_b16 a[98:99], v12 offset:1536
v_mfma_f32_16x16x32_bf16 v[44:47], a[108:111], a[68:71], v[44:47]
ds_read_b64_tr_b16 a[100:101], v12 offset:8704
v_mfma_f32_16x16x32_bf16 v[44:47], a[104:107], a[48:51], v[44:47]
ds_read_b64_tr_b16 a[102:103], v12 offset:9728
s_add_u32 m0, s18, 0x5000
v_mfma_f32_16x16x32_bf16 v[36:39], a[104:107], a[44:47], v[36:39]
buffer_load_dwordx4 v7, s[68:71], s25 offen lds
v_mfma_f32_16x16x32_bf16 v[36:39], a[108:111], a[64:67], v[36:39]
ds_read_b128 a[4:7], v8 offset:2048
v_mfma_f32_16x16x32_bf16 v[28:31], a[108:111], a[60:63], v[28:31]
ds_read_b128 a[24:27], v9 offset:2048
v_mfma_f32_16x16x32_bf16 v[28:31], a[104:107], a[40:43], v[28:31]
ds_read_b128 a[8:11], v8 offset:4096
s_waitcnt lgkmcnt(9)
v_mfma_f32_16x16x32_bf16 v[56:59], a[80:83], a[40:43], v[56:59]
ds_read_b64_tr_b16 a[104:105], v13 offset:512
v_mfma_f32_16x16x32_bf16 v[56:59], a[84:87], a[60:63], v[56:59]
ds_read_b64_tr_b16 a[106:107], v13 offset:1536
s_add_u32 m0, s18, 0x6000
v_mfma_f32_16x16x32_bf16 v[64:67], a[84:87], a[64:67], v[64:67]
buffer_load_dwordx4 v7, s[68:71], s26 offen lds
v_mfma_f32_16x16x32_bf16 v[64:67], a[80:83], a[44:47], v[64:67]
ds_read_b64_tr_b16 a[108:109], v13 offset:8704
v_mfma_f32_16x16x32_bf16 v[72:75], a[80:83], a[48:51], v[72:75]
ds_read_b64_tr_b16 a[110:111], v13 offset:9728
v_mfma_f32_16x16x32_bf16 v[72:75], a[84:87], a[68:71], v[72:75]
ds_read_b128 a[28:31], v9 offset:4096
v_mfma_f32_16x16x32_bf16 v[80:83], a[84:87], a[72:75], v[80:83]
ds_read_b128 a[12:15], v8 offset:6144
v_mfma_f32_16x16x32_bf16 v[80:83], a[80:83], a[52:55], v[80:83]
ds_read_b128 a[32:35], v9 offset:6144
s_add_u32 m0, s18, 0x7000
v_mfma_f32_16x16x32_bf16 v[84:87], a[88:91], a[52:55], v[84:87]
buffer_load_dwordx4 v4, s[44:47], s24 offen lds
v_mfma_f32_16x16x32_bf16 v[84:87], a[92:95], a[72:75], v[84:87]
ds_read_b64_tr_b16 a[80:81], v12 offset:768
v_lshl_add_u32 v5, s42, 19, v5
v_mfma_f32_16x16x32_bf16 v[76:79], a[92:95], a[68:71], v[76:79]
ds_read_b64_tr_b16 a[82:83], v12 offset:1792
v_lshl_add_u32 v6, s42, 19, v6
v_mfma_f32_16x16x32_bf16 v[76:79], a[88:91], a[48:51], v[76:79]
ds_read_b64_tr_b16 a[84:85], v12 offset:8960
v_lshl_add_u32 v7, s42, 18, v7
v_mfma_f32_16x16x32_bf16 v[68:71], a[88:91], a[44:47], v[68:71]
ds_read_b64_tr_b16 a[86:87], v12 offset:9984
s_waitcnt lgkmcnt(4)
v_mfma_f32_16x16x32_bf16 v[68:71], a[92:95], a[64:67], v[68:71]
ds_read_b128 a[56:59], v10
s_add_u32 m0, s16, 0x0
v_mfma_f32_16x16x32_bf16 v[60:63], a[92:95], a[60:63], v[60:63]
buffer_load_dwordx4 v22, s[44:47], s20 offen lds
v_mfma_f32_16x16x32_bf16 v[60:63], a[88:91], a[40:43], v[60:63]
ds_read_b128 a[76:79], v11
s_waitcnt lgkmcnt(9)
v_mfma_f32_16x16x32_bf16 v[88:91], a[96:99], a[40:43], v[88:91]
ds_read_b64_tr_b16 a[88:89], v13 offset:768
v_lshl_add_u32 v7, s42, 17, v7
v_mfma_f32_16x16x32_bf16 v[88:91], a[100:103], a[60:63], v[88:91]
ds_read_b64_tr_b16 a[90:91], v13 offset:1792
v_lshl_add_u32 v4, s42, 7, v4
v_mfma_f32_16x16x32_bf16 v[96:99], a[100:103], a[64:67], v[96:99]
ds_read_b64_tr_b16 a[92:93], v13 offset:8960
v_mfma_f32_16x16x32_bf16 v[96:99], a[96:99], a[44:47], v[96:99]
ds_read_b64_tr_b16 a[94:95], v13 offset:9984
s_add_u32 m0, s16, 0x400
v_mfma_f32_16x16x32_bf16 v[104:107], a[96:99], a[48:51], v[104:107]
buffer_load_dwordx4 v23, s[44:47], s20 offen lds
v_mfma_f32_16x16x32_bf16 v[104:107], a[100:103], a[68:71], v[104:107]
v_mfma_f32_16x16x32_bf16 v[112:115], a[100:103], a[72:75], v[112:115]
v_mfma_f32_16x16x32_bf16 v[112:115], a[96:99], a[52:55], v[112:115]
v_mfma_f32_16x16x32_bf16 v[116:119], a[104:107], a[52:55], v[116:119]
ds_read_b64_tr_b16 a[96:97], v14 offset:0
v_mfma_f32_16x16x32_bf16 v[116:119], a[108:111], a[72:75], v[116:119]
ds_read_b64_tr_b16 a[98:99], v14 offset:256
v_mfma_f32_16x16x32_bf16 v[108:111], a[108:111], a[68:71], v[108:111]
buffer_load_dwordx4 a[144:147], v16, s[76:79], 0 offen offset:0
v_mfma_f32_16x16x32_bf16 v[108:111], a[104:107], a[48:51], v[108:111]
ds_read_b64_tr_b16 a[100:101], v14 offset:2048
v_mfma_f32_16x16x32_bf16 v[100:103], a[104:107], a[44:47], v[100:103]
ds_read_b64_tr_b16 a[102:103], v14 offset:2304
v_mfma_f32_16x16x32_bf16 v[100:103], a[108:111], a[64:67], v[100:103]
L_padA10:
s_cmp_eq_u32 s95, 1
s_cbranch_scc1 L_hopA_ret
v_mfma_f32_16x16x32_bf16 v[92:95], a[108:111], a[60:63], v[92:95]
v_mfma_f32_16x16x32_bf16 v[92:95], a[104:107], a[40:43], v[92:95]
s_add_u32 m0, s16, 0x800
s_waitcnt lgkmcnt(4)
v_mfma_f32_16x16x32_bf16 v[120:123], a[80:83], a[40:43], v[120:123]
buffer_load_dwordx4 v22, s[44:47], s21 offen lds
v_mfma_f32_16x16x32_bf16 v[120:123], a[84:87], a[60:63], v[120:123]
ds_read_b64_tr_b16 a[104:105], v15 offset:0
v_mfma_f32_16x16x32_bf16 v[128:131], a[84:87], a[64:67], v[128:131]
ds_read_b64_tr_b16 a[106:107], v15 offset:256
v_mfma_f32_16x16x32_bf16 v[128:131], a[80:83], a[44:47], v[128:131]
ds_read_b64_tr_b16 a[108:109], v15 offset:2048
v_mfma_f32_16x16x32_bf16 v[136:139], a[80:83], a[48:51], v[136:139]
ds_read_b64_tr_b16 a[110:111], v15 offset:2304
v_mfma_f32_16x16x32_bf16 v[136:139], a[84:87], a[68:71], v[136:139]
s_add_u32 m0, s16, 0xc00
v_mfma_f32_16x16x32_bf16 v[144:147], a[84:87], a[72:75], v[144:147]
buffer_load_dwordx4 v23, s[44:47], s21 offen lds
v_mfma_f32_16x16x32_bf16 v[144:147], a[80:83], a[52:55], v[144:147]
v_mfma_f32_16x16x32_bf16 v[148:151], a[88:91], a[52:55], v[148:151]
ds_read_b64_tr_b16 a[80:81], v14 offset:4096
v_mfma_f32_16x16x32_bf16 v[148:151], a[92:95], a[72:75], v[148:151]
ds_read_b64_tr_b16 a[82:83], v14 offset:4352
v_mfma_f32_16x16x32_bf16 v[140:143], a[92:95], a[68:71], v[140:143]
ds_read_b64_tr_b16 a[84:85], v14 offset:6144
v_mfma_f32_16x16x32_bf16 v[140:143], a[88:91], a[48:51], v[140:143]
ds_read_b64_tr_b16 a[86:87], v14 offset:6400
s_add_u32 m0, s16, 0x1000
v_mfma_f32_16x16x32_bf16 v[132:135], a[88:91], a[44:47], v[132:135]
buffer_load_dwordx4 v22, s[44:47], s22 offen lds
v_mfma_f32_16x16x32_bf16 v[132:135], a[92:95], a[64:67], v[132:135]
v_mfma_f32_16x16x32_bf16 v[124:127], a[92:95], a[60:63], v[124:127]
v_mfma_f32_16x16x32_bf16 v[124:127], a[88:91], a[40:43], v[124:127]
s_waitcnt lgkmcnt(4)
v_mfma_f32_16x16x32_bf16 v[152:155], a[96:99], a[40:43], v[152:155]
ds_read_b64_tr_b16 a[88:89], v15 offset:4096
v_mfma_f32_16x16x32_bf16 v[152:155], a[100:103], a[60:63], v[152:155]
ds_read_b64_tr_b16 a[90:91], v15 offset:4352
s_add_u32 m0, s16, 0x1400
v_mfma_f32_16x16x32_bf16 v[160:163], a[100:103], a[64:67], v[160:163]
buffer_load_dwordx4 v23, s[44:47], s22 offen lds
v_mfma_f32_16x16x32_bf16 v[160:163], a[96:99], a[44:47], v[160:163]
ds_read_b64_tr_b16 a[92:93], v15 offset:6144
v_mfma_f32_16x16x32_bf16 v[168:171], a[96:99], a[48:51], v[168:171]
ds_read_b64_tr_b16 a[94:95], v15 offset:6400
v_mfma_f32_16x16x32_bf16 v[168:171], a[100:103], a[68:71], v[168:171]
v_mfma_f32_16x16x32_bf16 v[176:179], a[100:103], a[72:75], v[176:179]
v_mfma_f32_16x16x32_bf16 v[176:179], a[96:99], a[52:55], v[176:179]
s_add_u32 m0, s16, 0x1800
v_mfma_f32_16x16x32_bf16 v[180:183], a[104:107], a[52:55], v[180:183]
buffer_load_dwordx4 v22, s[44:47], s23 offen lds
v_mfma_f32_16x16x32_bf16 v[180:183], a[108:111], a[72:75], v[180:183]
ds_read_b64_tr_b16 a[96:97], v14 offset:8192
v_mfma_f32_16x16x32_bf16 v[172:175], a[108:111], a[68:71], v[172:175]
ds_read_b64_tr_b16 a[98:99], v14 offset:8448
v_mfma_f32_16x16x32_bf16 v[172:175], a[104:107], a[48:51], v[172:175]
ds_read_b64_tr_b16 a[100:101], v14 offset:10240
v_mfma_f32_16x16x32_bf16 v[164:167], a[104:107], a[44:47], v[164:167]
ds_read_b64_tr_b16 a[102:103], v14 offset:10496
v_mfma_f32_16x16x32_bf16 v[164:167], a[108:111], a[64:67], v[164:167]
s_add_u32 m0, s16, 0x1c00
v_mfma_f32_16x16x32_bf16 v[156:159], a[108:111], a[60:63], v[156:159]
buffer_load_dwordx4 v23, s[44:47], s23 offen lds
v_mfma_f32_16x16x32_bf16 v[156:159], a[104:107], a[40:43], v[156:159]
s_waitcnt lgkmcnt(4)
s_bfe_u32 s39, s40, 0x80018
s_add_u32 s39, s39, s41
v_mfma_f32_16x16x32_bf16 v[184:187], a[80:83], a[40:43], v[184:187]
ds_read_b64_tr_b16 a[104:105], v15 offset:8192
s_and_b32 s39, s39, 15
v_mfma_f32_16x16x32_bf16 v[184:187], a[84:87], a[60:63], v[184:187]
ds_read_b64_tr_b16 a[106:107], v15 offset:8448
s_sub_u32 s42, s39, s41
v_mfma_f32_16x16x32_bf16 v[192:195], a[84:87], a[64:67], v[192:195]
ds_read_b64_tr_b16 a[108:109], v15 offset:10240
s_mov_b32 s41, s39
v_mfma_f32_16x16x32_bf16 v[192:195], a[80:83], a[44:47], v[192:195]
ds_read_b64_tr_b16 a[110:111], v15 offset:10496
v_add_u32 v12, 0x8000, v12
v_mfma_f32_16x16x32_bf16 v[200:203], a[80:83], a[48:51], v[200:203]
buffer_load_dwordx4 a[148:151], v16, s[76:79], 0 offen offset:1024
v_mfma_f32_16x16x32_bf16 v[200:203], a[84:87], a[68:71], v[200:203]
v_add_u32 v13, 0x8000, v13
v_add_u32 v14, 0x8000, v14
v_mfma_f32_16x16x32_bf16 v[208:211], a[84:87], a[72:75], v[208:211]
v_add_u32 v15, 0x8000, v15
v_add_u32 v10, 0x8000, v10
v_mfma_f32_16x16x32_bf16 v[208:211], a[80:83], a[52:55], v[208:211]
v_add_u32 v11, 0x8000, v11
v_lshl_add_u32 v22, s42, 7, v22
v_mfma_f32_16x16x32_bf16 v[248:251], a[80:83], a[56:59], v[248:251]
v_lshl_add_u32 v23, s42, 7, v23
v_mfma_f32_16x16x32_bf16 v[248:251], a[84:87], a[76:79], v[248:251]
v_mfma_f32_16x16x32_bf16 v[212:215], a[88:91], a[52:55], v[212:215]
s_waitcnt vmcnt(30) lgkmcnt(0)
v_mfma_f32_16x16x32_bf16 v[212:215], a[92:95], a[72:75], v[212:215]
s_barrier
s_add_u32 m0, s17, 0x8000
v_mfma_f32_16x16x32_bf16 v[204:207], a[92:95], a[68:71], v[204:207]
buffer_load_dwordx4 v5, s[52:55], 0 offen lds
v_mfma_f32_16x16x32_bf16 v[204:207], a[88:91], a[48:51], v[204:207]
ds_read_b64_tr_b16 a[80:81], v12 offset:0
v_mfma_f32_16x16x32_bf16 v[196:199], a[88:91], a[44:47], v[196:199]
ds_read_b64_tr_b16 a[82:83], v12 offset:1024
v_mfma_f32_16x16x32_bf16 v[196:199], a[92:95], a[64:67], v[196:199]
ds_read_b64_tr_b16 a[84:85], v12 offset:8192
v_mfma_f32_16x16x32_bf16 v[188:191], a[92:95], a[60:63], v[188:191]
ds_read_b64_tr_b16 a[86:87], v12 offset:9216
v_mfma_f32_16x16x32_bf16 v[188:191], a[88:91], a[40:43], v[188:191]
s_waitcnt lgkmcnt(4)
v_mfma_f32_16x16x32_bf16 v[216:219], a[40:43], a[96:99], v[216:219]
ds_read_b64_tr_b16 a[88:89], v13 offset:0
s_add_u32 m0, s17, 0x8400
v_mfma_f32_16x16x32_bf16 v[216:219], a[60:63], a[100:103], v[216:219]
buffer_load_dwordx4 v5, s[52:55], s13 offen lds
v_mfma_f32_16x16x32_bf16 v[224:227], a[64:67], a[100:103], v[224:227]
ds_read_b64_tr_b16 a[90:91], v13 offset:1024
v_mfma_f32_16x16x32_bf16 v[224:227], a[44:47], a[96:99], v[224:227]
ds_read_b64_tr_b16 a[92:93], v13 offset:8192
v_mfma_f32_16x16x32_bf16 v[232:235], a[48:51], a[96:99], v[232:235]
ds_read_b64_tr_b16 a[94:95], v13 offset:9216
v_mfma_f32_16x16x32_bf16 v[232:235], a[68:71], a[100:103], v[232:235]
v_mfma_f32_16x16x32_bf16 v[240:243], a[72:75], a[100:103], v[240:243]
v_mfma_f32_16x16x32_bf16 v[240:243], a[52:55], a[96:99], v[240:243]
s_add_u32 m0, s17, 0x8800
v_mfma_f32_16x16x32_bf16 v[252:255], a[56:59], a[96:99], v[252:255]
buffer_load_dwordx4 v6, s[52:55], 0 offen lds
v_mfma_f32_16x16x32_bf16 v[252:255], a[76:79], a[100:103], v[252:255]
v_mfma_f32_16x16x32_bf16 v[244:247], a[52:55], a[104:107], v[244:247]
ds_read_b64_tr_b16 a[96:97], v12 offset:256
v_mfma_f32_16x16x32_bf16 v[244:247], a[72:75], a[108:111], v[244:247]
ds_read_b64_tr_b16 a[98:99], v12 offset:1280
v_mfma_f32_16x16x32_bf16 v[236:239], a[68:71], a[108:111], v[236:239]
ds_read_b64_tr_b16 a[100:101], v12 offset:8448
v_mfma_f32_16x16x32_bf16 v[236:239], a[48:51], a[104:107], v[236:239]
ds_read_b64_tr_b16 a[102:103], v12 offset:9472
v_mfma_f32_16x16x32_bf16 v[228:231], a[44:47], a[104:107], v[228:231]
s_add_u32 m0, s17, 0x8c00
v_mfma_f32_16x16x32_bf16 v[228:231], a[64:67], a[108:111], v[228:231]
buffer_load_dwordx4 v6, s[52:55], s13 offen lds
v_mfma_f32_16x16x32_bf16 v[220:223], a[60:63], a[108:111], v[220:223]
v_mfma_f32_16x16x32_bf16 v[220:223], a[40:43], a[104:107], v[220:223]
s_waitcnt lgkmcnt(4)
L_S20:
v_mfma_f32_16x16x32_bf16 v[24:27], a[80:83], a[0:3], v[24:27]
ds_read_b64_tr_b16 a[104:105], v13 offset:256
s_waitcnt vmcnt(24)
v_mfma_f32_16x16x32_bf16 v[24:27], a[84:87], a[20:23], v[24:27]
ds_read_b64_tr_b16 a[106:107], v13 offset:1280
v_mfma_f32_16x16x32_bf16 v[32:35], a[84:87], a[24:27], v[32:35]
ds_read_b64_tr_b16 a[108:109], v13 offset:8448
v_mfma_f32_16x16x32_bf16 v[32:35], a[80:83], a[4:7], v[32:35]
ds_read_b64_tr_b16 a[110:111], v13 offset:9472
s_add_u32 m0, s18, 0xc000
v_mfma_f32_16x16x32_bf16 v[40:43], a[80:83], a[8:11], v[40:43]
buffer_load_dwordx4 v7, s[68:71], 0 offen lds
v_mfma_f32_16x16x32_bf16 v[40:43], a[84:87], a[28:31], v[40:43]
ds_read_b128 a[40:43], v8 offset:32768
v_mfma_f32_16x16x32_bf16 v[48:51], a[84:87], a[32:35], v[48:51]
ds_read_b128 a[60:63], v9 offset:32768
v_mfma_f32_16x16x32_bf16 v[48:51], a[80:83], a[12:15], v[48:51]
ds_read_b128 a[44:47], v8 offset:34816
v_mfma_f32_16x16x32_bf16 v[52:55], a[88:91], a[12:15], v[52:55]
ds_read_b64_tr_b16 a[80:81], v12 offset:512
v_mfma_f32_16x16x32_bf16 v[52:55], a[92:95], a[32:35], v[52:55]
ds_read_b64_tr_b16 a[82:83], v12 offset:1536
v_mfma_f32_16x16x32_bf16 v[44:47], a[92:95], a[28:31], v[44:47]
ds_read_b64_tr_b16 a[84:85], v12 offset:8704
s_add_u32 m0, s18, 0xd000
v_mfma_f32_16x16x32_bf16 v[44:47], a[88:91], a[8:11], v[44:47]
buffer_load_dwordx4 v7, s[68:71], s25 offen lds
v_mfma_f32_16x16x32_bf16 v[36:39], a[88:91], a[4:7], v[36:39]
ds_read_b64_tr_b16 a[86:87], v12 offset:9728
v_mfma_f32_16x16x32_bf16 v[36:39], a[92:95], a[24:27], v[36:39]
ds_read_b128 a[64:67], v9 offset:34816
v_mfma_f32_16x16x32_bf16 v[28:31], a[92:95], a[20:23], v[28:31]
ds_read_b128 a[48:51], v8 offset:36864
v_mfma_f32_16x16x32_bf16 v[28:31], a[88:91], a[0:3], v[28:31]
ds_read_b128 a[68:71], v9 offset:36864
s_waitcnt lgkmcnt(10)
v_mfma_f32_16x16x32_bf16 v[56:59], a[96:99], a[0:3], v[56:59]
ds_read_b64_tr_b16 a[88:89], v13 offset:512
v_mfma_f32_16x16x32_bf16 v[56:59], a[100:103], a[20:23], v[56:59]
ds_read_b64_tr_b16 a[90:91], v13 offset:1536
s_add_u32 m0, s18, 0xe000
v_mfma_f32_16x16x32_bf16 v[64:67], a[100:103], a[24:27], v[64:67]
buffer_load_dwordx4 v7, s[68:71], s26 offen lds
v_mfma_f32_16x16x32_bf16 v[64:67], a[96:99], a[4:7], v[64:67]
ds_read_b64_tr_b16 a[92:93], v13 offset:8704
v_mfma_f32_16x16x32_bf16 v[72:75], a[96:99], a[8:11], v[72:75]
ds_read_b64_tr_b16 a[94:95], v13 offset:9728
v_mfma_f32_16x16x32_bf16 v[72:75], a[100:103], a[28:31], v[72:75]
ds_read_b128 a[52:55], v8 offset:38912
v_mfma_f32_16x16x32_bf16 v[80:83], a[100:103], a[32:35], v[80:83]
ds_read_b128 a[72:75], v9 offset:38912
v_mfma_f32_16x16x32_bf16 v[80:83], a[96:99], a[12:15], v[80:83]
ds_read_b128 a[16:19], v10
v_mfma_f32_16x16x32_bf16 v[84:87], a[104:107], a[12:15], v[84:87]
ds_read_b64_tr_b16 a[96:97], v12 offset:768
s_add_u32 m0, s18, 0xf000
v_mfma_f32_16x16x32_bf16 v[84:87], a[108:111], a[32:35], v[84:87]
buffer_load_dwordx4 v4, s[44:47], s24 offen lds
v_mfma_f32_16x16x32_bf16 v[76:79], a[108:111], a[28:31], v[76:79]
ds_read_b64_tr_b16 a[98:99], v12 offset:1792
v_lshl_add_u32 v5, s42, 19, v5
v_mfma_f32_16x16x32_bf16 v[76:79], a[104:107], a[8:11], v[76:79]
ds_read_b64_tr_b16 a[100:101], v12 offset:8960
v_lshl_add_u32 v6, s42, 19, v6
v_mfma_f32_16x16x32_bf16 v[68:71], a[104:107], a[4:7], v[68:71]
ds_read_b64_tr_b16 a[102:103], v12 offset:9984
v_lshl_add_u32 v7, s42, 18, v7
v_mfma_f32_16x16x32_bf16 v[68:71], a[108:111], a[24:27], v[68:71]
ds_read_b128 a[36:39], v11
v_lshl_add_u32 v7, s42, 17, v7
v_mfma_f32_16x16x32_bf16 v[60:63], a[108:111], a[20:23], v[60:63]
v_lshl_add_u32 v4, s42, 7, v4
s_waitcnt vmcnt(15)
v_accvgpr_read_b32 v18, a144
v_mfma_f32_16x16x32_bf16 v[60:63], a[104:107], a[0:3], v[60:63]
s_waitcnt lgkmcnt(6)
s_waitcnt lgkmcnt(8)
v_lshlrev_b32 v1, 16, v18
v_mfma_f32_16x16x32_bf16 v[88:91], a[80:83], a[0:3], v[88:91]
ds_read_b64_tr_b16 a[104:105], v13 offset:768
s_add_u32 m0, s16, 0x8000
v_mfma_f32_16x16x32_bf16 v[88:91], a[84:87], a[20:23], v[88:91]
buffer_load_dwordx4 v22, s[44:47], s20 offen lds
v_mfma_f32_16x16x32_bf16 v[96:99], a[84:87], a[24:27], v[96:99]
ds_read_b64_tr_b16 a[106:107], v13 offset:1792
v_and_b32 v18, 0xffff0000, v18
v_mfma_f32_16x16x32_bf16 v[96:99], a[80:83], a[4:7], v[96:99]
ds_read_b64_tr_b16 a[108:109], v13 offset:8960
v_accvgpr_read_b32 v21, a128
v_mfma_f32_16x16x32_bf16 v[104:107], a[80:83], a[8:11], v[104:107]
ds_read_b64_tr_b16 a[110:111], v13 offset:9984
v_lshlrev_b32 v20, 16, v21
v_mfma_f32_16x16x32_bf16 v[104:107], a[84:87], a[28:31], v[104:107]
v_and_b32 v21, 0xffff0000, v21
v_mul_f32 v2, v1, v20
v_mfma_f32_16x16x32_bf16 v[112:115], a[84:87], a[32:35], v[112:115]
v_fmac_f32 v2, v18, v21
v_accvgpr_read_b32 v21, a136
v_mfma_f32_16x16x32_bf16 v[112:115], a[80:83], a[12:15], v[112:115]
s_add_u32 m0, s16, 0x8400
v_lshlrev_b32 v20, 16, v21
v_and_b32 v21, 0xffff0000, v21
v_mfma_f32_16x16x32_bf16 v[116:119], a[88:91], a[12:15], v[116:119]
buffer_load_dwordx4 v23, s[44:47], s20 offen lds
v_mfma_f32_16x16x32_bf16 v[116:119], a[92:95], a[32:35], v[116:119]
ds_read_b64_tr_b16 a[80:81], v14 offset:0
v_mul_f32 v3, v1, v20
v_mfma_f32_16x16x32_bf16 v[108:111], a[92:95], a[28:31], v[108:111]
ds_read_b64_tr_b16 a[82:83], v14 offset:256
v_fmac_f32 v3, v18, v21
v_mfma_f32_16x16x32_bf16 v[108:111], a[88:91], a[8:11], v[108:111]
ds_read_b64_tr_b16 a[84:85], v14 offset:2048
v_accvgpr_read_b32 v18, a145
v_mfma_f32_16x16x32_bf16 v[100:103], a[88:91], a[4:7], v[100:103]
ds_read_b64_tr_b16 a[86:87], v14 offset:2304
v_lshlrev_b32 v1, 16, v18
v_mfma_f32_16x16x32_bf16 v[100:103], a[92:95], a[24:27], v[100:103]
v_and_b32 v18, 0xffff0000, v18
v_accvgpr_read_b32 v21, a129
v_mfma_f32_16x16x32_bf16 v[92:95], a[92:95], a[20:23], v[92:95]
s_add_u32 m0, s16, 0x8800
s_waitcnt lgkmcnt(4)
v_lshlrev_b32 v20, 16, v21
v_mfma_f32_16x16x32_bf16 v[92:95], a[88:91], a[0:3], v[92:95]
buffer_load_dwordx4 v22, s[44:47], s21 offen lds
v_mfma_f32_16x16x32_bf16 v[120:123], a[96:99], a[0:3], v[120:123]
ds_read_b64_tr_b16 a[88:89], v15 offset:0
v_and_b32 v21, 0xffff0000, v21
v_mfma_f32_16x16x32_bf16 v[120:123], a[100:103], a[20:23], v[120:123]
ds_read_b64_tr_b16 a[90:91], v15 offset:256
v_fmac_f32 v2, v1, v20
v_mfma_f32_16x16x32_bf16 v[128:131], a[100:103], a[24:27], v[128:131]
ds_read_b64_tr_b16 a[92:93], v15 offset:2048
v_fmac_f32 v2, v18, v21
v_mfma_f32_16x16x32_bf16 v[128:131], a[96:99], a[4:7], v[128:131]
ds_read_b64_tr_b16 a[94:95], v15 offset:2304
v_accvgpr_read_b32 v21, a137
v_mfma_f32_16x16x32_bf16 v[136:139], a[96:99], a[8:11], v[136:139]
v_lshlrev_b32 v20, 16, v21
v_and_b32 v21, 0xffff0000, v21
v_mfma_f32_16x16x32_bf16 v[136:139], a[100:103], a[28:31], v[136:139]
s_add_u32 m0, s16, 0x8c00
v_fmac_f32 v3, v1, v20
v_fmac_f32 v3, v18, v21
v_mfma_f32_16x16x32_bf16 v[144:147], a[100:103], a[32:35], v[144:147]
buffer_load_dwordx4 v23, s[44:47], s21 offen lds
v_mfma_f32_16x16x32_bf16 v[144:147], a[96:99], a[12:15], v[144:147]
v_accvgpr_read_b32 v18, a146
v_lshlrev_b32 v1, 16, v18
v_mfma_f32_16x16x32_bf16 v[148:151], a[104:107], a[12:15], v[148:151]
ds_read_b64_tr_b16 a[96:97], v14 offset:4096
v_and_b32 v18, 0xffff0000, v18
v_mfma_f32_16x16x32_bf16 v[148:151], a[108:111], a[32:35], v[148:151]
ds_read_b64_tr_b16 a[98:99], v14 offset:4352
v_accvgpr_read_b32 v21, a130
v_mfma_f32_16x16x32_bf16 v[140:143], a[108:111], a[28:31], v[140:143]
ds_read_b64_tr_b16 a[100:101], v14 offset:6144
v_lshlrev_b32 v20, 16, v21
v_mfma_f32_16x16x32_bf16 v[140:143], a[104:107], a[8:11], v[140:143]
ds_read_b64_tr_b16 a[102:103], v14 offset:6400
v_and_b32 v21, 0xffff0000, v21
v_mfma_f32_16x16x32_bf16 v[132:135], a[104:107], a[4:7], v[132:135]
s_add_u32 m0, s16, 0x9000
v_fmac_f32 v2, v1, v20
v_fmac_f32 v2, v18, v21
v_mfma_f32_16x16x32_bf16 v[132:135], a[108:111], a[24:27], v[132:135]
buffer_load_dwordx4 v22, s[44:47], s22 offen lds
v_mfma_f32_16x16x32_bf16 v[124:127], a[108:111], a[20:23], v[124:127]
v_accvgpr_read_b32 v21, a138
v_lshlrev_b32 v20, 16, v21
v_mfma_f32_16x16x32_bf16 v[124:127], a[104:107], a[0:3], v[124:127]
s_waitcnt lgkmcnt(4)
v_and_b32 v21, 0xffff0000, v21
v_fmac_f32 v3, v1, v20
v_mfma_f32_16x16x32_bf16 v[152:155], a[80:83], a[0:3], v[152:155]
ds_read_b64_tr_b16 a[104:105], v15 offset:4096
v_fmac_f32 v3, v18, v21
v_mfma_f32_16x16x32_bf16 v[152:155], a[84:87], a[20:23], v[152:155]
ds_read_b64_tr_b16 a[106:107], v15 offset:4352
v_accvgpr_read_b32 v18, a147
v_mfma_f32_16x16x32_bf16 v[160:163], a[84:87], a[24:27], v[160:163]
ds_read_b64_tr_b16 a[108:109], v15 offset:6144
v_lshlrev_b32 v1, 16, v18
v_mfma_f32_16x16x32_bf16 v[160:163], a[80:83], a[4:7], v[160:163]
ds_read_b64_tr_b16 a[110:111], v15 offset:6400
s_add_u32 m0, s16, 0x9400
v_mfma_f32_16x16x32_bf16 v[168:171], a[80:83], a[8:11], v[168:171]
buffer_load_dwordx4 v23, s[44:47], s22 offen lds
v_mfma_f32_16x16x32_bf16 v[168:171], a[84:87], a[28:31], v[168:171]
v_and_b32 v18, 0xffff0000, v18
v_accvgpr_read_b32 v21, a131
v_mfma_f32_16x16x32_bf16 v[176:179], a[84:87], a[32:35], v[176:179]
v_lshlrev_b32 v20, 16, v21
v_and_b32 v21, 0xffff0000, v21
v_mfma_f32_16x16x32_bf16 v[176:179], a[80:83], a[12:15], v[176:179]
v_fmac_f32 v2, v1, v20
v_fmac_f32 v2, v18, v21
v_mfma_f32_16x16x32_bf16 v[180:183], a[88:91], a[12:15], v[180:183]
ds_read_b64_tr_b16 a[80:81], v14 offset:8192
v_accvgpr_read_b32 v21, a139
v_mfma_f32_16x16x32_bf16 v[180:183], a[92:95], a[32:35], v[180:183]
ds_read_b64_tr_b16 a[82:83], v14 offset:8448
v_lshlrev_b32 v20, 16, v21
v_mfma_f32_16x16x32_bf16 v[172:175], a[92:95], a[28:31], v[172:175]
ds_read_b64_tr_b16 a[84:85], v14 offset:10240
s_add_u32 m0, s16, 0x9800
v_mfma_f32_16x16x32_bf16 v[172:175], a[88:91], a[8:11], v[172:175]
buffer_load_dwordx4 v22, s[44:47], s23 offen lds
v_mfma_f32_16x16x32_bf16 v[164:167], a[88:91], a[4:7], v[164:167]
ds_read_b64_tr_b16 a[86:87], v14 offset:10496
v_and_b32 v21, 0xffff0000, v21
v_mfma_f32_16x16x32_bf16 v[164:167], a[92:95], a[24:27], v[164:167]
v_fmac_f32 v3, v1, v20
v_fmac_f32 v3, v18, v21
v_mfma_f32_16x16x32_bf16 v[156:159], a[92:95], a[20:23], v[156:159]
s_waitcnt vmcnt(15)
v_accvgpr_read_b32 v18, a148
v_lshlrev_b32 v1, 16, v18
v_mfma_f32_16x16x32_bf16 v[156:159], a[88:91], a[0:3], v[156:159]
s_waitcnt lgkmcnt(4)
v_and_b32 v18, 0xffff0000, v18
v_accvgpr_read_b32 v21, a132
v_mfma_f32_16x16x32_bf16 v[184:187], a[96:99], a[0:3], v[184:187]
ds_read_b64_tr_b16 a[88:89], v15 offset:8192
v_lshlrev_b32 v20, 16, v21
v_mfma_f32_16x16x32_bf16 v[184:187], a[100:103], a[20:23], v[184:187]
ds_read_b64_tr_b16 a[90:91], v15 offset:8448
s_add_u32 m0, s16, 0x9c00
v_mfma_f32_16x16x32_bf16 v[192:195], a[100:103], a[24:27], v[192:195]
buffer_load_dwordx4 v23, s[44:47], s23 offen lds
v_mfma_f32_16x16x32_bf16 v[192:195], a[96:99], a[4:7], v[192:195]
ds_read_b64_tr_b16 a[92:93], v15 offset:10240
v_and_b32 v21, 0xffff0000, v21
v_mfma_f32_16x16x32_bf16 v[200:203], a[96:99], a[8:11], v[200:203]
ds_read_b64_tr_b16 a[94:95], v15 offset:10496
v_add_u32 v12, 0xffff0000, v12
v_mfma_f32_16x16x32_bf16 v[200:203], a[100:103], a[28:31], v[200:203]
v_add_u32 v13, 0xffff0000, v13
v_add_u32 v14, 0xffff0000, v14
v_mfma_f32_16x16x32_bf16 v[208:211], a[100:103], a[32:35], v[208:211]
v_add_u32 v15, 0xffff0000, v15
v_add_u32 v10, 0xffff0000, v10
v_mfma_f32_16x16x32_bf16 v[208:211], a[96:99], a[12:15], v[208:211]
v_add_u32 v11, 0xffff0000, v11
v_fmac_f32 v2, v1, v20
v_mfma_f32_16x16x32_bf16 v[248:251], a[96:99], a[16:19], v[248:251]
v_fmac_f32 v2, v18, v21
v_accvgpr_read_b32 v21, a140
v_mfma_f32_16x16x32_bf16 v[248:251], a[100:103], a[36:39], v[248:251]
v_lshlrev_b32 v20, 16, v21
v_and_b32 v21, 0xffff0000, v21
v_mfma_f32_16x16x32_bf16 v[212:215], a[104:107], a[12:15], v[212:215]
s_waitcnt vmcnt(26) lgkmcnt(0)
v_fmac_f32 v3, v1, v20
v_fmac_f32 v3, v18, v21
v_mfma_f32_16x16x32_bf16 v[212:215], a[108:111], a[32:35], v[212:215]
s_barrier
s_add_u32 m0, s17, 0x10000
v_accvgpr_read_b32 v18, a149
v_mfma_f32_16x16x32_bf16 v[204:207], a[108:111], a[28:31], v[204:207]
buffer_load_dwordx4 v5, s[52:55], 0 offen lds
v_mfma_f32_16x16x32_bf16 v[204:207], a[104:107], a[8:11], v[204:207]
ds_read_b64_tr_b16 a[96:97], v12 offset:0
v_lshlrev_b32 v1, 16, v18
v_mfma_f32_16x16x32_bf16 v[196:199], a[104:107], a[4:7], v[196:199]
ds_read_b64_tr_b16 a[98:99], v12 offset:1024
v_and_b32 v18, 0xffff0000, v18
v_mfma_f32_16x16x32_bf16 v[196:199], a[108:111], a[24:27], v[196:199]
ds_read_b64_tr_b16 a[100:101], v12 offset:8192
v_accvgpr_read_b32 v21, a133
v_mfma_f32_16x16x32_bf16 v[188:191], a[108:111], a[20:23], v[188:191]
ds_read_b64_tr_b16 a[102:103], v12 offset:9216
v_lshlrev_b32 v20, 16, v21
v_mfma_f32_16x16x32_bf16 v[188:191], a[104:107], a[0:3], v[188:191]
s_waitcnt lgkmcnt(4)
v_and_b32 v21, 0xffff0000, v21
v_fmac_f32 v2, v1, v20
v_mfma_f32_16x16x32_bf16 v[216:219], a[0:3], a[80:83], v[216:219]
ds_read_b64_tr_b16 a[104:105], v13 offset:0
s_add_u32 m0, s17, 0x10400
v_mfma_f32_16x16x32_bf16 v[216:219], a[20:23], a[84:87], v[216:219]
buffer_load_dwordx4 v5, s[52:55], s13 offen lds
v_mfma_f32_16x16x32_bf16 v[224:227], a[24:27], a[84:87], v[224:227]
ds_read_b64_tr_b16 a[106:107], v13 offset:1024
v_fmac_f32 v2, v18, v21
v_mfma_f32_16x16x32_bf16 v[224:227], a[4:7], a[80:83], v[224:227]
ds_read_b64_tr_b16 a[108:109], v13 offset:8192
v_accvgpr_read_b32 v21, a141
v_mfma_f32_16x16x32_bf16 v[232:235], a[8:11], a[80:83], v[232:235]
ds_read_b64_tr_b16 a[110:111], v13 offset:9216
v_lshlrev_b32 v20, 16, v21
v_mfma_f32_16x16x32_bf16 v[232:235], a[28:31], a[84:87], v[232:235]
s_lshl_b32 s15, s2, 2
v_and_b32 v21, 0xffff0000, v21
v_fmac_f32 v3, v1, v20
v_mfma_f32_16x16x32_bf16 v[240:243], a[32:35], a[84:87], v[240:243]
s_add_u32 s15, s15, s4
v_fmac_f32 v3, v18, v21
v_accvgpr_read_b32 v18, a150
v_mfma_f32_16x16x32_bf16 v[240:243], a[12:15], a[80:83], v[240:243]
s_lshl_b32 s15, s15, 12
v_lshlrev_b32 v1, 16, v18
v_and_b32 v18, 0xffff0000, v18
v_mfma_f32_16x16x32_bf16 v[252:255], a[16:19], a[80:83], v[252:255]
s_add_u32 m0, s17, 0x10800
v_accvgpr_read_b32 v21, a134
v_lshlrev_b32 v20, 16, v21
v_mfma_f32_16x16x32_bf16 v[252:255], a[36:39], a[84:87], v[252:255]
buffer_load_dwordx4 v6, s[52:55], 0 offen lds
v_mfma_f32_16x16x32_bf16 v[244:247], a[12:15], a[88:91], v[244:247]
ds_read_b64_tr_b16 a[80:81], v12 offset:256
v_and_b32 v21, 0xffff0000, v21
v_mfma_f32_16x16x32_bf16 v[244:247], a[32:35], a[92:95], v[244:247]
ds_read_b64_tr_b16 a[82:83], v12 offset:1280
v_fmac_f32 v2, v1, v20
v_mfma_f32_16x16x32_bf16 v[236:239], a[28:31], a[92:95], v[236:239]
ds_read_b64_tr_b16 a[84:85], v12 offset:8448
v_fmac_f32 v2, v18, v21
v_mfma_f32_16x16x32_bf16 v[236:239], a[8:11], a[88:91], v[236:239]
ds_read_b64_tr_b16 a[86:87], v12 offset:9472
v_accvgpr_read_b32 v21, a142
v_mfma_f32_16x16x32_bf16 v[228:231], a[4:7], a[88:91], v[228:231]
s_add_u32 s15, s15, 0x3800000
v_lshlrev_b32 v20, 16, v21
v_and_b32 v21, 0xffff0000, v21
v_mfma_f32_16x16x32_bf16 v[228:231], a[24:27], a[92:95], v[228:231]
v_fmac_f32 v3, v1, v20
v_fmac_f32 v3, v18, v21
v_mfma_f32_16x16x32_bf16 v[220:223], a[20:23], a[92:95], v[220:223]
s_add_u32 m0, s17, 0x10c00
s_waitcnt lgkmcnt(4)
v_accvgpr_read_b32 v18, a151
v_mfma_f32_16x16x32_bf16 v[220:223], a[0:3], a[88:91], v[220:223]
buffer_load_dwordx4 v6, s[52:55], s13 offen lds
L_S21:
v_mfma_f32_16x16x32_bf16 v[24:27], a[96:99], a[40:43], v[24:27]
ds_read_b64_tr_b16 a[88:89], v13 offset:256
s_waitcnt vmcnt(21)
v_mfma_f32_16x16x32_bf16 v[24:27], a[100:103], a[60:63], v[24:27]
ds_read_b64_tr_b16 a[90:91], v13 offset:1280
v_lshlrev_b32 v1, 16, v18
v_mfma_f32_16x16x32_bf16 v[32:35], a[100:103], a[64:67], v[32:35]
ds_read_b64_tr_b16 a[92:93], v13 offset:8448
v_and_b32 v18, 0xffff0000, v18
v_mfma_f32_16x16x32_bf16 v[32:35], a[96:99], a[44:47], v[32:35]
ds_read_b64_tr_b16 a[94:95], v13 offset:9472
v_accvgpr_read_b32 v21, a135
v_mfma_f32_16x16x32_bf16 v[40:43], a[96:99], a[48:51], v[40:43]
ds_read_b128 a[0:3], v8 offset:0
v_lshlrev_b32 v20, 16, v21
v_mfma_f32_16x16x32_bf16 v[40:43], a[100:103], a[68:71], v[40:43]
ds_read_b128 a[20:23], v9 offset:0
v_and_b32 v21, 0xffff0000, v21
v_mfma_f32_16x16x32_bf16 v[48:51], a[100:103], a[72:75], v[48:51]
ds_read_b128 a[4:7], v8 offset:2048
s_add_u32 m0, s18, 0x14000
v_mfma_f32_16x16x32_bf16 v[48:51], a[96:99], a[52:55], v[48:51]
buffer_load_dwordx4 v7, s[68:71], 0 offen lds
v_mfma_f32_16x16x32_bf16 v[52:55], a[104:107], a[52:55], v[52:55]
ds_read_b64_tr_b16 a[96:97], v12 offset:512
v_fmac_f32 v2, v1, v20
v_mfma_f32_16x16x32_bf16 v[52:55], a[108:111], a[72:75], v[52:55]
ds_read_b64_tr_b16 a[98:99], v12 offset:1536
v_fmac_f32 v2, v18, v21
v_mfma_f32_16x16x32_bf16 v[44:47], a[108:111], a[68:71], v[44:47]
ds_read_b64_tr_b16 a[100:101], v12 offset:8704
v_accvgpr_read_b32 v21, a143
v_mfma_f32_16x16x32_bf16 v[44:47], a[104:107], a[48:51], v[44:47]
ds_read_b64_tr_b16 a[102:103], v12 offset:9728
v_lshlrev_b32 v20, 16, v21
v_mfma_f32_16x16x32_bf16 v[36:39], a[104:107], a[44:47], v[36:39]
ds_read_b128 a[24:27], v9 offset:2048
v_and_b32 v21, 0xffff0000, v21
v_mfma_f32_16x16x32_bf16 v[36:39], a[108:111], a[64:67], v[36:39]
ds_read_b128 a[8:11], v8 offset:4096
s_waitcnt lgkmcnt(9)
v_mfma_f32_16x16x32_bf16 v[28:31], a[108:111], a[60:63], v[28:31]
ds_read_b128 a[28:31], v9 offset:4096
s_add_u32 m0, s18, 0x15000
v_mfma_f32_16x16x32_bf16 v[28:31], a[104:107], a[40:43], v[28:31]
buffer_load_dwordx4 v7, s[68:71], s25 offen lds
v_mfma_f32_16x16x32_bf16 v[56:59], a[80:83], a[40:43], v[56:59]
ds_read_b64_tr_b16 a[104:105], v13 offset:512
v_fmac_f32 v3, v1, v20
v_mfma_f32_16x16x32_bf16 v[56:59], a[84:87], a[60:63], v[56:59]
ds_read_b64_tr_b16 a[106:107], v13 offset:1536
v_fmac_f32 v3, v18, v21
v_mfma_f32_16x16x32_bf16 v[64:67], a[84:87], a[64:67], v[64:67]
ds_read_b64_tr_b16 a[108:109], v13 offset:8704
v_add_f32_dpp v2, v2, v2 row_ror:8 row_mask:0xf bank_mask:0xf
v_mfma_f32_16x16x32_bf16 v[64:67], a[80:83], a[44:47], v[64:67]
ds_read_b64_tr_b16 a[110:111], v13 offset:9728
v_add_f32_dpp v3, v3, v3 row_ror:8 row_mask:0xf bank_mask:0xf
v_mfma_f32_16x16x32_bf16 v[72:75], a[80:83], a[48:51], v[72:75]
ds_read_b128 a[12:15], v8 offset:6144
v_add_f32_dpp v2, v2, v2 row_ror:4 row_mask:0xf bank_mask:0xf
v_mfma_f32_16x16x32_bf16 v[72:75], a[84:87], a[68:71], v[72:75]
ds_read_b128 a[32:35], v9 offset:6144
v_add_f32_dpp v3, v3, v3 row_ror:4 row_mask:0xf bank_mask:0xf
v_mfma_f32_16x16x32_bf16 v[80:83], a[84:87], a[72:75], v[80:83]
ds_read_b128 a[56:59], v10
s_add_u32 m0, s18, 0x16000
v_mfma_f32_16x16x32_bf16 v[80:83], a[80:83], a[52:55], v[80:83]
buffer_load_dwordx4 v7, s[68:71], s26 offen lds
v_mfma_f32_16x16x32_bf16 v[84:87], a[88:91], a[52:55], v[84:87]
ds_read_b64_tr_b16 a[80:81], v12 offset:768
v_add_f32_dpp v2, v2, v2 row_ror:2 row_mask:0xf bank_mask:0xf
v_mfma_f32_16x16x32_bf16 v[84:87], a[92:95], a[72:75], v[84:87]
ds_read_b64_tr_b16 a[82:83], v12 offset:1792
L_padA11:
s_cmp_eq_u32 s95, 1
s_cbranch_scc1 L_hopA_ret
v_add_f32_dpp v3, v3, v3 row_ror:2 row_mask:0xf bank_mask:0xf
v_mfma_f32_16x16x32_bf16 v[76:79], a[92:95], a[68:71], v[76:79]
ds_read_b64_tr_b16 a[84:85], v12 offset:8960
v_add_f32_dpp v2, v2, v2 row_ror:1 row_mask:0xf bank_mask:0xf
v_mfma_f32_16x16x32_bf16 v[76:79], a[88:91], a[48:51], v[76:79]
ds_read_b64_tr_b16 a[86:87], v12 offset:9984
v_add_f32_dpp v3, v3, v3 row_ror:1 row_mask:0xf bank_mask:0xf
v_mfma_f32_16x16x32_bf16 v[68:71], a[88:91], a[44:47], v[68:71]
ds_read_b128 a[76:79], v11
v_mov_b32 v1, v2
v_mfma_f32_16x16x32_bf16 v[68:71], a[92:95], a[64:67], v[68:71]
v_mov_b32 v18, v3
v_accvgpr_write_b32 a116, -1
v_mfma_f32_16x16x32_bf16 v[60:63], a[92:95], a[60:63], v[60:63]
s_add_u32 m0, s18, 0x17000
s_waitcnt lgkmcnt(8)
v_permlane16_swap_b32 v1, v2
v_mfma_f32_16x16x32_bf16 v[60:63], a[88:91], a[40:43], v[60:63]
buffer_load_dwordx4 v4, s[44:47], s24 offen lds
v_mfma_f32_16x16x32_bf16 v[88:91], a[96:99], a[40:43], v[88:91]
ds_read_b64_tr_b16 a[88:89], v13 offset:768
v_permlane16_swap_b32 v18, v3
v_mfma_f32_16x16x32_bf16 v[88:91], a[100:103], a[60:63], v[88:91]
ds_read_b64_tr_b16 a[90:91], v13 offset:1792
v_add_f32 v2, v2, v1
v_mfma_f32_16x16x32_bf16 v[96:99], a[100:103], a[64:67], v[96:99]
ds_read_b64_tr_b16 a[92:93], v13 offset:8960
v_add_f32 v3, v3, v18
v_mfma_f32_16x16x32_bf16 v[96:99], a[96:99], a[44:47], v[96:99]
ds_read_b64_tr_b16 a[94:95], v13 offset:9984
v_mov_b32 v1, v2
v_mfma_f32_16x16x32_bf16 v[104:107], a[96:99], a[48:51], v[104:107]
v_mov_b32 v18, v3
v_accvgpr_write_b32 a117, -1
v_mfma_f32_16x16x32_bf16 v[104:107], a[100:103], a[68:71], v[104:107]
v_permlane32_swap_b32 v1, v2
v_permlane32_swap_b32 v18, v3
v_mfma_f32_16x16x32_bf16 v[112:115], a[100:103], a[72:75], v[112:115]
v_add_f32 v2, v2, v1
v_add_f32 v3, v3, v18
v_mfma_f32_16x16x32_bf16 v[112:115], a[96:99], a[52:55], v[112:115]
buffer_load_dword v23, off, s[84:87], s10 sc1
v_mfma_f32_16x16x32_bf16 v[116:119], a[104:107], a[52:55], v[116:119]
ds_read_b64_tr_b16 a[96:97], v14 offset:0
v_mul_f32 v2, 0xbfb8aa3b, v2
v_mfma_f32_16x16x32_bf16 v[116:119], a[108:111], a[72:75], v[116:119]
ds_read_b64_tr_b16 a[98:99], v14 offset:256
v_mul_f32 v3, 0xbfb8aa3b, v3
v_mfma_f32_16x16x32_bf16 v[108:111], a[108:111], a[68:71], v[108:111]
ds_read_b64_tr_b16 a[100:101], v14 offset:2048
v_accvgpr_write_b32 a118, -1
v_mfma_f32_16x16x32_bf16 v[108:111], a[104:107], a[48:51], v[108:111]
ds_read_b64_tr_b16 a[102:103], v14 offset:2304
v_accvgpr_write_b32 a119, -1
v_mfma_f32_16x16x32_bf16 v[100:103], a[104:107], a[44:47], v[100:103]
v_exp_f32 v2, v2
v_mfma_f32_16x16x32_bf16 v[100:103], a[108:111], a[64:67], v[100:103]
v_exp_f32 v3, v3
v_mfma_f32_16x16x32_bf16 v[92:95], a[108:111], a[60:63], v[92:95]
v_add_f32 v2, 1.0, v2
v_add_f32 v3, 1.0, v3
v_mfma_f32_16x16x32_bf16 v[92:95], a[104:107], a[40:43], v[92:95]
s_waitcnt lgkmcnt(4)
v_rcp_f32 v2, v2
v_mfma_f32_16x16x32_bf16 v[120:123], a[80:83], a[40:43], v[120:123]
ds_read_b64_tr_b16 a[104:105], v15 offset:0
v_mfma_f32_16x16x32_bf16 v[120:123], a[84:87], a[60:63], v[120:123]
ds_read_b64_tr_b16 a[106:107], v15 offset:256
v_mfma_f32_16x16x32_bf16 v[128:131], a[84:87], a[64:67], v[128:131]
ds_read_b64_tr_b16 a[108:109], v15 offset:2048
v_mfma_f32_16x16x32_bf16 v[128:131], a[80:83], a[44:47], v[128:131]
ds_read_b64_tr_b16 a[110:111], v15 offset:2304
v_mfma_f32_16x16x32_bf16 v[136:139], a[80:83], a[48:51], v[136:139]
v_rcp_f32 v3, v3
v_mfma_f32_16x16x32_bf16 v[136:139], a[84:87], a[68:71], v[136:139]
buffer_store_dwordx2 v[2:3], off, s[88:91], s101 sc1
v_mfma_f32_16x16x32_bf16 v[144:147], a[84:87], a[72:75], v[144:147]
v_mfma_f32_16x16x32_bf16 v[144:147], a[80:83], a[52:55], v[144:147]
v_mfma_f32_16x16x32_bf16 v[148:151], a[88:91], a[52:55], v[148:151]
ds_read_b64_tr_b16 a[80:81], v14 offset:4096
v_mfma_f32_16x16x32_bf16 v[148:151], a[92:95], a[72:75], v[148:151]
ds_read_b64_tr_b16 a[82:83], v14 offset:4352
v_mfma_f32_16x16x32_bf16 v[140:143], a[92:95], a[68:71], v[140:143]
ds_read_b64_tr_b16 a[84:85], v14 offset:6144
v_mfma_f32_16x16x32_bf16 v[140:143], a[88:91], a[48:51], v[140:143]
ds_read_b64_tr_b16 a[86:87], v14 offset:6400
v_mfma_f32_16x16x32_bf16 v[132:135], a[88:91], a[44:47], v[132:135]
v_mfma_f32_16x16x32_bf16 v[132:135], a[92:95], a[64:67], v[132:135]
v_mfma_f32_16x16x32_bf16 v[124:127], a[92:95], a[60:63], v[124:127]
v_mfma_f32_16x16x32_bf16 v[124:127], a[88:91], a[40:43], v[124:127]
s_waitcnt lgkmcnt(4)
v_mfma_f32_16x16x32_bf16 v[152:155], a[96:99], a[40:43], v[152:155]
ds_read_b64_tr_b16 a[88:89], v15 offset:4096
v_mfma_f32_16x16x32_bf16 v[152:155], a[100:103], a[60:63], v[152:155]
ds_read_b64_tr_b16 a[90:91], v15 offset:4352
v_mfma_f32_16x16x32_bf16 v[160:163], a[100:103], a[64:67], v[160:163]
ds_read_b64_tr_b16 a[92:93], v15 offset:6144
v_mfma_f32_16x16x32_bf16 v[160:163], a[96:99], a[44:47], v[160:163]
ds_read_b64_tr_b16 a[94:95], v15 offset:6400
v_mfma_f32_16x16x32_bf16 v[168:171], a[96:99], a[48:51], v[168:171]
v_mfma_f32_16x16x32_bf16 v[168:171], a[100:103], a[68:71], v[168:171]
v_mfma_f32_16x16x32_bf16 v[176:179], a[100:103], a[72:75], v[176:179]
v_mfma_f32_16x16x32_bf16 v[176:179], a[96:99], a[52:55], v[176:179]
v_mfma_f32_16x16x32_bf16 v[180:183], a[104:107], a[52:55], v[180:183]
ds_read_b64_tr_b16 a[96:97], v14 offset:8192
v_mfma_f32_16x16x32_bf16 v[180:183], a[108:111], a[72:75], v[180:183]
ds_read_b64_tr_b16 a[98:99], v14 offset:8448
v_mfma_f32_16x16x32_bf16 v[172:175], a[108:111], a[68:71], v[172:175]
ds_read_b64_tr_b16 a[100:101], v14 offset:10240
v_mfma_f32_16x16x32_bf16 v[172:175], a[104:107], a[48:51], v[172:175]
ds_read_b64_tr_b16 a[102:103], v14 offset:10496
v_mfma_f32_16x16x32_bf16 v[164:167], a[104:107], a[44:47], v[164:167]
v_mfma_f32_16x16x32_bf16 v[164:167], a[108:111], a[64:67], v[164:167]
v_mfma_f32_16x16x32_bf16 v[156:159], a[108:111], a[60:63], v[156:159]
v_mfma_f32_16x16x32_bf16 v[156:159], a[104:107], a[40:43], v[156:159]
s_waitcnt lgkmcnt(4)
v_mfma_f32_16x16x32_bf16 v[184:187], a[80:83], a[40:43], v[184:187]
ds_read_b64_tr_b16 a[104:105], v15 offset:8192
v_mfma_f32_16x16x32_bf16 v[184:187], a[84:87], a[60:63], v[184:187]
ds_read_b64_tr_b16 a[106:107], v15 offset:8448
v_mfma_f32_16x16x32_bf16 v[192:195], a[84:87], a[64:67], v[192:195]
ds_read_b64_tr_b16 a[108:109], v15 offset:10240
v_mfma_f32_16x16x32_bf16 v[192:195], a[80:83], a[44:47], v[192:195]
ds_read_b64_tr_b16 a[110:111], v15 offset:10496
v_add_u32 v12, 0x8000, v12
v_mfma_f32_16x16x32_bf16 v[200:203], a[80:83], a[48:51], v[200:203]
v_add_u32 v13, 0x8000, v13
v_add_u32 v14, 0x8000, v14
v_mfma_f32_16x16x32_bf16 v[200:203], a[84:87], a[68:71], v[200:203]
v_add_u32 v15, 0x8000, v15
v_add_u32 v10, 0x8000, v10
v_mfma_f32_16x16x32_bf16 v[208:211], a[84:87], a[72:75], v[208:211]
v_add_u32 v11, 0x8000, v11
v_mfma_f32_16x16x32_bf16 v[208:211], a[80:83], a[52:55], v[208:211]
v_mfma_f32_16x16x32_bf16 v[248:251], a[80:83], a[56:59], v[248:251]
v_mfma_f32_16x16x32_bf16 v[248:251], a[84:87], a[76:79], v[248:251]
v_mfma_f32_16x16x32_bf16 v[212:215], a[88:91], a[52:55], v[212:215]
s_waitcnt vmcnt(1) lgkmcnt(0)
s_mov_b32 s92, 200000
L_spin_kv:
v_readfirstlane_b32 s93, v23
s_nop 1
s_cmp_ge_u32 s93, 8
s_cbranch_scc1 L_spun_kv
s_sub_u32 s92, s92, 1
s_cbranch_scc1 L_spun_kv
s_sleep 4
buffer_load_dword v23, off, s[84:87], s10 sc1
s_waitcnt vmcnt(0)
s_branch L_spin_kv
L_spun_kv:
v_mfma_f32_16x16x32_bf16 v[212:215], a[92:95], a[72:75], v[212:215]
s_barrier
s_add_u32 m0, s19, 0x0
v_mfma_f32_16x16x32_bf16 v[204:207], a[92:95], a[68:71], v[204:207]
buffer_load_dwordx4 v16, s[48:51], s32 offen offset:0 sc1 lds
v_mov_b32 v3, v16
v_mfma_f32_16x16x32_bf16 v[204:207], a[88:91], a[48:51], v[204:207]
ds_read_b64_tr_b16 a[80:81], v12 offset:0
v_mov_b32 v22, 0x3f803f80
v_mfma_f32_16x16x32_bf16 v[196:199], a[88:91], a[44:47], v[196:199]
ds_read_b64_tr_b16 a[82:83], v12 offset:1024
s_mov_b32 s33, 0
v_mfma_f32_16x16x32_bf16 v[196:199], a[92:95], a[64:67], v[196:199]
ds_read_b64_tr_b16 a[84:85], v12 offset:8192
v_accvgpr_write_b32 a240, v22
v_mfma_f32_16x16x32_bf16 v[188:191], a[92:95], a[60:63], v[188:191]
ds_read_b64_tr_b16 a[86:87], v12 offset:9216
v_accvgpr_write_b32 a241, v22
v_mfma_f32_16x16x32_bf16 v[188:191], a[88:91], a[40:43], v[188:191]
s_waitcnt lgkmcnt(4)
v_accvgpr_write_b32 a242, v22
v_accvgpr_write_b32 a243, v22
v_mfma_f32_16x16x32_bf16 v[216:219], a[40:43], a[96:99], v[216:219]
buffer_load_dwordx4 v16, s[48:51], s32 offen offset:1024 sc1 lds
v_mfma_f32_16x16x32_bf16 v[216:219], a[60:63], a[100:103], v[216:219]
ds_read_b64_tr_b16 a[88:89], v13 offset:0
s_mov_b32 s36, 0x33333333
v_mfma_f32_16x16x32_bf16 v[224:227], a[64:67], a[100:103], v[224:227]
ds_read_b64_tr_b16 a[90:91], v13 offset:1024
s_mov_b32 s37, 0xcccccccc
v_cndmask_b32 v4, 0, v22, s[36:37]
v_mfma_f32_16x16x32_bf16 v[224:227], a[44:47], a[96:99], v[224:227]
ds_read_b64_tr_b16 a[92:93], v13 offset:8192
v_accvgpr_write_b32 a232, v4
v_mfma_f32_16x16x32_bf16 v[232:235], a[48:51], a[96:99], v[232:235]
ds_read_b64_tr_b16 a[94:95], v13 offset:9216
v_accvgpr_write_b32 a233, v4
v_mfma_f32_16x16x32_bf16 v[232:235], a[68:71], a[100:103], v[232:235]
v_accvgpr_write_b32 a234, v4
v_accvgpr_write_b32 a235, v4
v_mfma_f32_16x16x32_bf16 v[240:243], a[72:75], a[100:103], v[240:243]
s_mov_b32 s36, 0x44444444
s_mov_b32 s37, 0x44444444
v_cndmask_b32 v4, 0, v22, s[36:37]
v_mfma_f32_16x16x32_bf16 v[240:243], a[52:55], a[96:99], v[240:243]
buffer_load_dwordx4 v16, s[48:51], s32 offen offset:2048 sc1 lds
v_mfma_f32_16x16x32_bf16 v[252:255], a[56:59], a[96:99], v[252:255]
v_accvgpr_write_b32 a236, v4
v_accvgpr_write_b32 a237, v4
v_mfma_f32_16x16x32_bf16 v[252:255], a[76:79], a[100:103], v[252:255]
v_accvgpr_write_b32 a238, v4
v_accvgpr_write_b32 a239, v4
v_mfma_f32_16x16x32_bf16 v[244:247], a[52:55], a[104:107], v[244:247]
ds_read_b64_tr_b16 a[96:97], v12 offset:256
v_mov_b32 v1, v3
v_add_u32 v2, 98304, v3
v_mfma_f32_16x16x32_bf16 v[244:247], a[72:75], a[108:111], v[244:247]
ds_read_b64_tr_b16 a[98:99], v12 offset:1280
s_mov_b64 s[34:35], 0
v_mfma_f32_16x16x32_bf16 v[236:239], a[68:71], a[108:111], v[236:239]
ds_read_b64_tr_b16 a[100:101], v12 offset:8448
v_accvgpr_write_b32 a224, 0
v_mfma_f32_16x16x32_bf16 v[236:239], a[48:51], a[104:107], v[236:239]
ds_read_b64_tr_b16 a[102:103], v12 offset:9472
v_accvgpr_write_b32 a225, 0
v_mfma_f32_16x16x32_bf16 v[228:231], a[44:47], a[104:107], v[228:231]
buffer_load_dwordx4 v16, s[48:51], s32 offen offset:3072 sc1 lds
v_mfma_f32_16x16x32_bf16 v[228:231], a[64:67], a[108:111], v[228:231]
v_accvgpr_write_b32 a226, 0
v_accvgpr_write_b32 a227, 0
v_mfma_f32_16x16x32_bf16 v[220:223], a[60:63], a[108:111], v[220:223]
v_accvgpr_write_b32 a228, 0
v_accvgpr_write_b32 a229, 0
v_mfma_f32_16x16x32_bf16 v[220:223], a[40:43], a[104:107], v[220:223]
s_waitcnt lgkmcnt(4)
v_accvgpr_write_b32 a230, 0
v_accvgpr_write_b32 a231, 0
L_S22:
v_mfma_f32_16x16x32_bf16 v[24:27], a[80:83], a[0:3], v[24:27]
ds_read_b64_tr_b16 a[104:105], v13 offset:256
s_waitcnt vmcnt(14)
s_mul_i32 s8, s6, 0x142400
v_mfma_f32_16x16x32_bf16 v[24:27], a[84:87], a[20:23], v[24:27]
ds_read_b64_tr_b16 a[106:107], v13 offset:1280
s_add_u32 m0, s19, 0x1000
v_mfma_f32_16x16x32_bf16 v[32:35], a[84:87], a[24:27], v[32:35]
buffer_load_dwordx4 v16, s[48:51], s7 offen offset:0 sc1 lds
v_mfma_f32_16x16x32_bf16 v[32:35], a[80:83], a[4:7], v[32:35]
ds_read_b64_tr_b16 a[108:109], v13 offset:8448
s_sub_u32 s9, 0x12e1c00, s8
v_mfma_f32_16x16x32_bf16 v[40:43], a[80:83], a[8:11], v[40:43]
ds_read_b64_tr_b16 a[110:111], v13 offset:9472
s_lshl_b32 s11, s5, 13
v_mfma_f32_16x16x32_bf16 v[40:43], a[84:87], a[28:31], v[40:43]
ds_read_b128 a[40:43], v8 offset:32768
s_add_u32 s11, s11, 0x2200000
v_mfma_f32_16x16x32_bf16 v[48:51], a[84:87], a[32:35], v[48:51]
ds_read_b128 a[60:63], v9 offset:32768
s_add_u32 s8, s8, s11
v_mfma_f32_16x16x32_bf16 v[48:51], a[80:83], a[12:15], v[48:51]
ds_read_b128 a[44:47], v8 offset:34816
s_add_u32 s9, s9, s11
v_mfma_f32_16x16x32_bf16 v[52:55], a[88:91], a[12:15], v[52:55]
ds_read_b64_tr_b16 a[80:81], v12 offset:512
s_lshl_b32 s11, s4, 10
s_add_u32 s44, s8, s11
v_mfma_f32_16x16x32_bf16 v[52:55], a[92:95], a[32:35], v[52:55]
buffer_load_dwordx4 v16, s[48:51], s7 offen offset:1024 sc1 lds
v_mfma_f32_16x16x32_bf16 v[44:47], a[92:95], a[28:31], v[44:47]
ds_read_b64_tr_b16 a[82:83], v12 offset:1536
s_add_u32 s46, s9, s11
v_mfma_f32_16x16x32_bf16 v[44:47], a[88:91], a[8:11], v[44:47]
ds_read_b64_tr_b16 a[84:85], v12 offset:8704
s_sub_u32 s11, 0x1c00, s11
v_mfma_f32_16x16x32_bf16 v[36:39], a[88:91], a[4:7], v[36:39]
ds_read_b64_tr_b16 a[86:87], v12 offset:9728
s_add_u32 s45, s8, s11
v_mfma_f32_16x16x32_bf16 v[36:39], a[92:95], a[24:27], v[36:39]
ds_read_b128 a[64:67], v9 offset:34816
s_add_u32 s47, s9, s11
v_mfma_f32_16x16x32_bf16 v[28:31], a[92:95], a[20:23], v[28:31]
ds_read_b128 a[48:51], v8 offset:36864
s_mul_i32 s8, s5, 0x6000
v_mfma_f32_16x16x32_bf16 v[28:31], a[88:91], a[0:3], v[28:31]
ds_read_b128 a[68:71], v9 offset:36864
s_waitcnt lgkmcnt(10)
v_mfma_f32_16x16x32_bf16 v[56:59], a[96:99], a[0:3], v[56:59]
buffer_load_dwordx4 v16, s[48:51], s7 offen offset:2048 sc1 lds
s_add_u32 s8, s8, 0x40000
v_mfma_f32_16x16x32_bf16 v[56:59], a[100:103], a[20:23], v[56:59]
ds_read_b64_tr_b16 a[88:89], v13 offset:512
s_add_u32 s28, s44, s8
v_mfma_f32_16x16x32_bf16 v[64:67], a[100:103], a[24:27], v[64:67]
ds_read_b64_tr_b16 a[90:91], v13 offset:1536
s_add_u32 s29, s45, s8
v_mfma_f32_16x16x32_bf16 v[64:67], a[96:99], a[4:7], v[64:67]
ds_read_b64_tr_b16 a[92:93], v13 offset:8704
s_add_u32 s30, s46, s8
v_mfma_f32_16x16x32_bf16 v[72:75], a[96:99], a[8:11], v[72:75]
ds_read_b64_tr_b16 a[94:95], v13 offset:9728
s_add_u32 s31, s47, s8
v_mfma_f32_16x16x32_bf16 v[72:75], a[100:103], a[28:31], v[72:75]
ds_read_b128 a[52:55], v8 offset:38912
s_lshl_b32 s8, s4, 11
v_mfma_f32_16x16x32_bf16 v[80:83], a[100:103], a[32:35], v[80:83]
buffer_load_dwordx4 v16, s[48:51], s7 offen offset:3072 sc1 lds
v_mfma_f32_16x16x32_bf16 v[80:83], a[96:99], a[12:15], v[80:83]
ds_read_b128 a[72:75], v9 offset:38912
s_add_u32 s32, s32, s94
v_mfma_f32_16x16x32_bf16 v[84:87], a[104:107], a[12:15], v[84:87]
ds_read_b64_tr_b16 a[96:97], v12 offset:768
s_add_u32 s7, s7, s94
s_add_u32 s9, s8, 131072
v_mfma_f32_16x16x32_bf16 v[84:87], a[108:111], a[32:35], v[84:87]
ds_read_b64_tr_b16 a[98:99], v12 offset:1792
v_add_u32 v4, s9, v16
v_mfma_f32_16x16x32_bf16 v[76:79], a[108:111], a[28:31], v[76:79]
ds_read_b64_tr_b16 a[100:101], v12 offset:8960
s_sub_u32 s9, 145408, s8
v_mfma_f32_16x16x32_bf16 v[76:79], a[104:107], a[8:11], v[76:79]
ds_read_b64_tr_b16 a[102:103], v12 offset:9984
v_mfma_f32_16x16x32_bf16 v[68:71], a[104:107], a[4:7], v[68:71]
ds_read_b128 a[16:19], v10
s_add_u32 m0, s19, 0x18000
v_mfma_f32_16x16x32_bf16 v[68:71], a[108:111], a[24:27], v[68:71]
buffer_load_dwordx4 v16, s[48:51], s32 offen offset:0 sc1 lds
v_mfma_f32_16x16x32_bf16 v[60:63], a[108:111], a[20:23], v[60:63]
ds_read_b128 a[36:39], v11
v_mfma_f32_16x16x32_bf16 v[60:63], a[104:107], a[0:3], v[60:63]
s_waitcnt lgkmcnt(8)
s_cmp_eq_u32 s4, 0
s_cselect_b32 s8, 131072, s9
v_mfma_f32_16x16x32_bf16 v[88:91], a[80:83], a[0:3], v[88:91]
ds_read_b64_tr_b16 a[104:105], v13 offset:768
v_add_u32 v5, s8, v16
v_mfma_f32_16x16x32_bf16 v[88:91], a[84:87], a[20:23], v[88:91]
ds_read_b64_tr_b16 a[106:107], v13 offset:1792
v_mfma_f32_16x16x32_bf16 v[96:99], a[84:87], a[24:27], v[96:99]
ds_read_b64_tr_b16 a[108:109], v13 offset:8960
v_mfma_f32_16x16x32_bf16 v[96:99], a[80:83], a[4:7], v[96:99]
ds_read_b64_tr_b16 a[110:111], v13 offset:9984
v_mfma_f32_16x16x32_bf16 v[104:107], a[80:83], a[8:11], v[104:107]
buffer_load_dwordx4 v16, s[48:51], s32 offen offset:1024 sc1 lds
v_mfma_f32_16x16x32_bf16 v[104:107], a[84:87], a[28:31], v[104:107]
s_cmp_eq_u32 s4, 3
s_cselect_b32 s8, 0, 8
s_add_u32 s9, s9, s8
v_mfma_f32_16x16x32_bf16 v[112:115], a[84:87], a[32:35], v[112:115]
v_add_u32 v6, s9, v16
v_xor_b32 v7, 8, v6
v_mfma_f32_16x16x32_bf16 v[112:115], a[80:83], a[12:15], v[112:115]
s_lshr_b32 s8, s4, 1
s_lshl_b32 s8, s8, 14
s_and_b32 s9, s4, 1
v_mfma_f32_16x16x32_bf16 v[116:119], a[88:91], a[12:15], v[116:119]
ds_read_b64_tr_b16 a[80:81], v14 offset:0
s_lshl_b32 s9, s9, 3
s_xor_b32 s9, s9, 131080
v_mfma_f32_16x16x32_bf16 v[116:119], a[92:95], a[32:35], v[116:119]
ds_read_b64_tr_b16 a[82:83], v14 offset:256
s_add_u32 s8, s8, s9
v_mfma_f32_16x16x32_bf16 v[108:111], a[92:95], a[28:31], v[108:111]
ds_read_b64_tr_b16 a[84:85], v14 offset:2048
v_add_u32 v22, s8, v16
v_mfma_f32_16x16x32_bf16 v[108:111], a[88:91], a[8:11], v[108:111]
buffer_load_dwordx4 v16, s[48:51], s32 offen offset:2048 sc1 lds
v_mfma_f32_16x16x32_bf16 v[100:103], a[88:91], a[4:7], v[100:103]
ds_read_b64_tr_b16 a[86:87], v14 offset:2304
s_bfe_u32 s99, s2, 0x20001
v_mfma_f32_16x16x32_bf16 v[100:103], a[92:95], a[24:27], v[100:103]
s_lshl_b32 s99, s99, 2
s_lshr_b32 s8, s2, 6
s_add_u32 s99, s99, s8
v_mfma_f32_16x16x32_bf16 v[92:95], a[92:95], a[20:23], v[92:95]
s_bfe_u32 s100, s2, 0x30003
s_and_b32 s14, s2, 1
s_sub_u32 s24, 15, s99
v_mfma_f32_16x16x32_bf16 v[92:95], a[88:91], a[0:3], v[92:95]
s_waitcnt lgkmcnt(4)
s_min_u32 s18, s24, s99
s_lshl_b32 s24, s18, 1
v_mfma_f32_16x16x32_bf16 v[120:123], a[96:99], a[0:3], v[120:123]
ds_read_b64_tr_b16 a[88:89], v15 offset:0
s_add_u32 s24, s24, s14
s_lshl_b32 s24, s24, 8
v_mfma_f32_16x16x32_bf16 v[120:123], a[100:103], a[20:23], v[120:123]
buffer_load_dwordx4 v16, s[48:51], s32 offen offset:3072 sc1 lds
v_mfma_f32_16x16x32_bf16 v[128:131], a[100:103], a[24:27], v[128:131]
ds_read_b64_tr_b16 a[90:91], v15 offset:256
s_add_u32 s24, s24, 0x3704000
v_mfma_f32_16x16x32_bf16 v[128:131], a[96:99], a[4:7], v[128:131]
ds_read_b64_tr_b16 a[92:93], v15 offset:2048
s_mov_b32 s12, 14336
v_mfma_f32_16x16x32_bf16 v[136:139], a[96:99], a[8:11], v[136:139]
ds_read_b64_tr_b16 a[94:95], v15 offset:2304
s_and_b32 s16, s6, 1
v_mfma_f32_16x16x32_bf16 v[136:139], a[100:103], a[28:31], v[136:139]
s_lshl_b32 s16, s16, 15
s_add_u32 s16, s16, 98304
s_add_u32 s16, s16, s17
v_mfma_f32_16x16x32_bf16 v[144:147], a[100:103], a[32:35], v[144:147]
s_lshl_b32 s13, s4, 15
s_lshl_b32 s9, s100, 8
s_add_u32 s13, s13, s9
v_mfma_f32_16x16x32_bf16 v[144:147], a[96:99], a[12:15], v[144:147]
s_add_u32 m0, s19, 0x19000
s_mul_i32 s9, s14, 0x100080
s_add_u32 s13, s13, s9
v_mfma_f32_16x16x32_bf16 v[148:151], a[104:107], a[12:15], v[148:151]
buffer_load_dwordx4 v16, s[48:51], s7 offen offset:0 sc1 lds
s_mul_i32 s25, s14, 0x300000
v_mfma_f32_16x16x32_bf16 v[148:151], a[108:111], a[32:35], v[148:151]
ds_read_b64_tr_b16 a[96:97], v14 offset:4096
s_sub_u32 s25, s25, 917504
v_mfma_f32_16x16x32_bf16 v[140:143], a[108:111], a[28:31], v[140:143]
ds_read_b64_tr_b16 a[98:99], v14 offset:4352
s_mul_i32 s101, s99, 0x142400
v_mfma_f32_16x16x32_bf16 v[140:143], a[104:107], a[8:11], v[140:143]
ds_read_b64_tr_b16 a[100:101], v14 offset:6144
s_lshl_b32 s8, s4, 11
v_mfma_f32_16x16x32_bf16 v[132:135], a[104:107], a[4:7], v[132:135]
ds_read_b64_tr_b16 a[102:103], v14 offset:6400
s_add_u32 s101, s101, s8
v_mfma_f32_16x16x32_bf16 v[132:135], a[108:111], a[24:27], v[132:135]
s_lshl_b32 s8, s14, 17
s_add_u32 s101, s101, s8
s_add_u32 s101, s101, 0x21fe000
v_mfma_f32_16x16x32_bf16 v[124:127], a[108:111], a[20:23], v[124:127]
s_waitcnt lgkmcnt(4)
s_mul_i32 s26, s14, 393216
s_add_u32 s26, s26, 139264
v_mfma_f32_16x16x32_bf16 v[124:127], a[104:107], a[0:3], v[124:127]
buffer_load_dwordx4 v16, s[48:51], s7 offen offset:1024 sc1 lds
v_mfma_f32_16x16x32_bf16 v[152:155], a[80:83], a[0:3], v[152:155]
ds_read_b64_tr_b16 a[104:105], v15 offset:4096
s_mov_b32 s52, 0x3e0293ee
s_mov_b32 s53, 0x3e0293ee
v_mfma_f32_16x16x32_bf16 v[152:155], a[84:87], a[20:23], v[152:155]
ds_read_b64_tr_b16 a[106:107], v15 offset:4352
s_mov_b32 s54, 0x3e8293ee
v_mfma_f32_16x16x32_bf16 v[160:163], a[84:87], a[24:27], v[160:163]
ds_read_b64_tr_b16 a[108:109], v15 offset:6144
v_mfma_f32_16x16x32_bf16 v[160:163], a[80:83], a[4:7], v[160:163]
ds_read_b64_tr_b16 a[110:111], v15 offset:6400
v_mfma_f32_16x16x32_bf16 v[168:171], a[80:83], a[8:11], v[168:171]
s_or_b32 s55, s6, s4
s_cselect_b32 s55, 0, 0xf149f2ca
s_mov_b32 s56, 0x50000
v_mfma_f32_16x16x32_bf16 v[168:171], a[84:87], a[28:31], v[168:171]
buffer_load_dwordx4 v16, s[48:51], s7 offen offset:2048 sc1 lds
v_mfma_f32_16x16x32_bf16 v[176:179], a[84:87], a[32:35], v[176:179]
s_mov_b32 s57, 0x5550055
s_mov_b32 s58, 0xa0000
s_mov_b32 s59, 0xaaa00aa
v_mfma_f32_16x16x32_bf16 v[176:179], a[80:83], a[12:15], v[176:179]
s_mov_b32 s60, 0x150001
s_mov_b32 s61, 0x15550155
s_mov_b32 s62, 0x2a0002
v_mfma_f32_16x16x32_bf16 v[180:183], a[88:91], a[12:15], v[180:183]
ds_read_b64_tr_b16 a[80:81], v14 offset:8192
s_mov_b32 s63, 0x2aaa02aa
s_mov_b32 s68, 0x55505555
v_mfma_f32_16x16x32_bf16 v[180:183], a[92:95], a[32:35], v[180:183]
ds_read_b64_tr_b16 a[82:83], v14 offset:8448
s_mov_b32 s69, 0x50005500
v_mfma_f32_16x16x32_bf16 v[172:175], a[92:95], a[28:31], v[172:175]
ds_read_b64_tr_b16 a[84:85], v14 offset:10240
s_mov_b32 s70, 0xaaa0aaaa
v_mfma_f32_16x16x32_bf16 v[172:175], a[88:91], a[8:11], v[172:175]
ds_read_b64_tr_b16 a[86:87], v14 offset:10496
s_mov_b32 s71, 0xa000aa00
v_mfma_f32_16x16x32_bf16 v[164:167], a[88:91], a[4:7], v[164:167]
buffer_load_dwordx4 v16, s[48:51], s7 offen offset:3072 sc1 lds
v_mfma_f32_16x16x32_bf16 v[164:167], a[92:95], a[24:27], v[164:167]
s_add_u32 s32, s32, 0x8000
s_add_u32 s7, s7, 0x8000
s_mov_b32 s76, 0x55405554
v_mfma_f32_16x16x32_bf16 v[156:159], a[92:95], a[20:23], v[156:159]
s_mov_b32 s77, 0x40005400
s_mov_b32 s78, 0xaa80aaa8
s_mov_b32 s79, 0x8000a800
v_mfma_f32_16x16x32_bf16 v[156:159], a[88:91], a[0:3], v[156:159]
s_waitcnt lgkmcnt(4)
s_mov_b32 s11, 0xf149f2ca
s_mov_b32 s36, 0xfff0ffff
v_mfma_f32_16x16x32_bf16 v[184:187], a[96:99], a[0:3], v[184:187]
ds_read_b64_tr_b16 a[88:89], v15 offset:8192
s_mov_b32 s37, 0xf000ff00
s_mov_b32 s38, 0xffe0fffe
v_mfma_f32_16x16x32_bf16 v[184:187], a[100:103], a[20:23], v[184:187]
ds_read_b64_tr_b16 a[90:91], v15 offset:8448
v_mov_b32 v21, s1
v_mfma_f32_16x16x32_bf16 v[192:195], a[100:103], a[24:27], v[192:195]
ds_read_b64_tr_b16 a[92:93], v15 offset:10240
v_add_u32 v20, s0, v16
v_mfma_f32_16x16x32_bf16 v[192:195], a[96:99], a[4:7], v[192:195]
global_load_dword a120, v[20:21], off sc1
v_mfma_f32_16x16x32_bf16 v[200:203], a[96:99], a[8:11], v[200:203]
ds_read_b64_tr_b16 a[94:95], v15 offset:10496
v_add_u32 v12, 0x8000, v12
v_mfma_f32_16x16x32_bf16 v[200:203], a[100:103], a[28:31], v[200:203]
s_mov_b32 s39, 0xe000fe00
v_add_u32 v13, 0x8000, v13
v_add_u32 v14, 0x8000, v14
v_mfma_f32_16x16x32_bf16 v[208:211], a[100:103], a[32:35], v[208:211]
s_mov_b32 s40, 0xffc0fffc
v_add_u32 v15, 0x8000, v15
v_add_u32 v10, 0x8000, v10
v_mfma_f32_16x16x32_bf16 v[208:211], a[96:99], a[12:15], v[208:211]
s_mov_b32 s41, 0xc000fc00
s_mov_b32 s42, 0xff80fff8
v_add_u32 v11, 0x8000, v11
v_mfma_f32_16x16x32_bf16 v[248:251], a[96:99], a[16:19], v[248:251]
s_mov_b32 s43, 0x8000f800
s_bitcmp1_b32 s4, 0
s_cselect_b32 s8, 0x7f800000, s11
s_cselect_b32 s9, s11, 0x7f800000
v_mfma_f32_16x16x32_bf16 v[248:251], a[100:103], a[36:39], v[248:251]
v_mfma_f32_16x16x32_bf16 v[212:215], a[104:107], a[12:15], v[212:215]
s_waitcnt vmcnt(19) lgkmcnt(0)
v_mfma_f32_16x16x32_bf16 v[212:215], a[108:111], a[32:35], v[212:215]
s_barrier
s_add_u32 m0, s19, 0x8000
v_mfma_f32_16x16x32_bf16 v[204:207], a[108:111], a[28:31], v[204:207]
buffer_load_dwordx4 v16, s[48:51], s32 offen offset:0 sc1 lds
v_mfma_f32_16x16x32_bf16 v[204:207], a[104:107], a[8:11], v[204:207]
ds_read_b64_tr_b16 a[96:97], v14 offset:4096
v_mfma_f32_16x16x32_bf16 v[196:199], a[104:107], a[4:7], v[196:199]
ds_read_b64_tr_b16 a[98:99], v14 offset:4352
v_mfma_f32_16x16x32_bf16 v[196:199], a[108:111], a[24:27], v[196:199]
ds_read_b64_tr_b16 a[100:101], v14 offset:6144
v_mfma_f32_16x16x32_bf16 v[188:191], a[108:111], a[20:23], v[188:191]
ds_read_b64_tr_b16 a[102:103], v14 offset:6400
s_waitcnt lgkmcnt(4)
v_mfma_f32_16x16x32_bf16 v[188:191], a[104:107], a[0:3], v[188:191]
buffer_load_dwordx4 v16, s[48:51], s32 offen offset:1024 sc1 lds
v_mfma_f32_16x16x32_bf16 v[216:219], a[0:3], a[80:83], v[216:219]
ds_read_b64_tr_b16 a[104:105], v15 offset:4096
v_mfma_f32_16x16x32_bf16 v[216:219], a[20:23], a[84:87], v[216:219]
ds_read_b64_tr_b16 a[106:107], v15 offset:4352
v_mfma_f32_16x16x32_bf16 v[224:227], a[24:27], a[84:87], v[224:227]
ds_read_b64_tr_b16 a[108:109], v15 offset:6144
v_mfma_f32_16x16x32_bf16 v[224:227], a[4:7], a[80:83], v[224:227]
ds_read_b64_tr_b16 a[110:111], v15 offset:6400
v_mfma_f32_16x16x32_bf16 v[232:235], a[8:11], a[80:83], v[232:235]
buffer_store_dwordx4 a[116:119], v16, s[88:91], s15 offen offset:0 sc1
v_mfma_f32_16x16x32_bf16 v[232:235], a[28:31], a[84:87], v[232:235]
ds_read_b128 a[56:59], v10
v_mfma_f32_16x16x32_bf16 v[240:243], a[32:35], a[84:87], v[240:243]
ds_read_b128 a[76:79], v11
v_mfma_f32_16x16x32_bf16 v[240:243], a[12:15], a[80:83], v[240:243]
v_mfma_f32_16x16x32_bf16 v[252:255], a[16:19], a[80:83], v[252:255]
v_mfma_f32_16x16x32_bf16 v[252:255], a[36:39], a[84:87], v[252:255]
buffer_load_dwordx4 v16, s[48:51], s32 offen offset:2048 sc1 lds
v_mfma_f32_16x16x32_bf16 v[244:247], a[12:15], a[88:91], v[244:247]
ds_read_b64_tr_b16 a[80:81], v14 offset:8192
v_mfma_f32_16x16x32_bf16 v[244:247], a[32:35], a[92:95], v[244:247]
ds_read_b64_tr_b16 a[82:83], v14 offset:8448
v_mfma_f32_16x16x32_bf16 v[236:239], a[28:31], a[92:95], v[236:239]
ds_read_b64_tr_b16 a[84:85], v14 offset:10240
v_mfma_f32_16x16x32_bf16 v[236:239], a[8:11], a[88:91], v[236:239]
ds_read_b64_tr_b16 a[86:87], v14 offset:10496
v_mfma_f32_16x16x32_bf16 v[228:231], a[4:7], a[88:91], v[228:231]
buffer_load_dwordx4 v16, s[48:51], s32 offen offset:3072 sc1 lds
v_mfma_f32_16x16x32_bf16 v[228:231], a[24:27], a[92:95], v[228:231]
v_mfma_f32_16x16x32_bf16 v[220:223], a[20:23], a[92:95], v[220:223]
v_mfma_f32_16x16x32_bf16 v[220:223], a[0:3], a[88:91], v[220:223]
s_waitcnt lgkmcnt(6)
L_S23:
v_mfma_f32_16x16x32_bf16 v[184:187], a[96:99], a[40:43], v[184:187]
ds_read_b64_tr_b16 a[88:89], v15 offset:8192
v_mov_b32 v8, v19
v_mov_b32 v9, 0xf149f2ca
v_mfma_f32_16x16x32_bf16 v[184:187], a[100:103], a[60:63], v[184:187]
buffer_store_dwordx4 a[116:119], v16, s[88:91], s15 offen offset:1024 sc1
v_mfma_f32_16x16x32_bf16 v[192:195], a[100:103], a[64:67], v[192:195]
ds_read_b64_tr_b16 a[90:91], v15 offset:8448
L_padA12:
s_cmp_eq_u32 s95, 1
s_cbranch_scc1 L_hopA_ret
v_mfma_f32_16x16x32_bf16 v[192:195], a[96:99], a[44:47], v[192:195]
ds_read_b64_tr_b16 a[92:93], v15 offset:10240
v_mfma_f32_16x16x32_bf16 v[200:203], a[96:99], a[48:51], v[200:203]
ds_read_b64_tr_b16 a[94:95], v15 offset:10496
v_mfma_f32_16x16x32_bf16 v[200:203], a[100:103], a[68:71], v[200:203]
s_add_u32 m0, s19, 0x9000
v_mfma_f32_16x16x32_bf16 v[208:211], a[100:103], a[72:75], v[208:211]
buffer_load_dwordx4 v16, s[48:51], s7 offen offset:0 sc1 lds
v_mfma_f32_16x16x32_bf16 v[208:211], a[96:99], a[52:55], v[208:211]
s_waitcnt lgkmcnt(9)
v_mfma_f32_16x16x32_bf16 v[248:251], a[96:99], a[56:59], v[248:251]
s_waitcnt lgkmcnt(8)
v_mfma_f32_16x16x32_bf16 v[248:251], a[100:103], a[76:79], v[248:251]
v_mfma_f32_16x16x32_bf16 v[212:215], a[104:107], a[52:55], v[212:215]
ds_read_b64_tr_b16 a[96:97], v14 offset:0
v_mfma_f32_16x16x32_bf16 v[212:215], a[108:111], a[72:75], v[212:215]
buffer_load_dwordx4 v16, s[48:51], s7 offen offset:1024 sc1 lds
v_mfma_f32_16x16x32_bf16 v[204:207], a[108:111], a[68:71], v[204:207]
ds_read_b64_tr_b16 a[98:99], v14 offset:256
v_mfma_f32_16x16x32_bf16 v[204:207], a[104:107], a[48:51], v[204:207]
ds_read_b64_tr_b16 a[100:101], v14 offset:2048
v_mfma_f32_16x16x32_bf16 v[196:199], a[104:107], a[44:47], v[196:199]
ds_read_b64_tr_b16 a[102:103], v14 offset:2304
v_mfma_f32_16x16x32_bf16 v[196:199], a[108:111], a[64:67], v[196:199]
v_mfma_f32_16x16x32_bf16 v[188:191], a[108:111], a[60:63], v[188:191]
buffer_store_dwordx4 a[116:119], v16, s[88:91], s15 offen offset:2048 sc1
v_mfma_f32_16x16x32_bf16 v[188:191], a[104:107], a[40:43], v[188:191]
s_waitcnt lgkmcnt(4)
v_mfma_f32_16x16x32_bf16 v[216:219], a[40:43], a[80:83], v[216:219]
ds_read_b64_tr_b16 a[104:105], v15 offset:0
v_mfma_f32_16x16x32_bf16 v[216:219], a[60:63], a[84:87], v[216:219]
ds_read_b64_tr_b16 a[106:107], v15 offset:256
v_mfma_f32_16x16x32_bf16 v[224:227], a[64:67], a[84:87], v[224:227]
ds_read_b64_tr_b16 a[108:109], v15 offset:2048
v_mfma_f32_16x16x32_bf16 v[224:227], a[44:47], a[80:83], v[224:227]
buffer_load_dwordx4 v16, s[48:51], s7 offen offset:2048 sc1 lds
v_mfma_f32_16x16x32_bf16 v[232:235], a[48:51], a[80:83], v[232:235]
ds_read_b64_tr_b16 a[110:111], v15 offset:2304
v_cvt_pk_bf16_f32 v248, v248, v249
v_mfma_f32_16x16x32_bf16 v[232:235], a[68:71], a[84:87], v[232:235]
v_cvt_pk_bf16_f32 v249, v250, v251
v_cvt_pk_bf16_f32 v184, v184, v185
v_mfma_f32_16x16x32_bf16 v[240:243], a[72:75], a[84:87], v[240:243]
v_cvt_pk_bf16_f32 v185, v186, v187
v_cvt_pk_bf16_f32 v186, v188, v189
v_cvt_pk_bf16_f32 v187, v190, v191
v_mfma_f32_16x16x32_bf16 v[240:243], a[52:55], a[80:83], v[240:243]
v_cvt_pk_bf16_f32 v192, v192, v193
v_cvt_pk_bf16_f32 v193, v194, v195
v_mfma_f32_16x16x32_bf16 v[252:255], a[56:59], a[80:83], v[252:255]
buffer_load_dwordx4 v16, s[48:51], s7 offen offset:3072 sc1 lds
v_mfma_f32_16x16x32_bf16 v[252:255], a[76:79], a[84:87], v[252:255]
s_add_u32 s32, s32, 0x8000
s_add_u32 s7, s7, 0x8000
v_cvt_pk_bf16_f32 v194, v196, v197
v_mfma_f32_16x16x32_bf16 v[244:247], a[52:55], a[88:91], v[244:247]
ds_read_b64_tr_b16 a[80:81], v12 offset:0
v_cvt_pk_bf16_f32 v195, v198, v199
v_cvt_pk_bf16_f32 v200, v200, v201
v_mfma_f32_16x16x32_bf16 v[244:247], a[72:75], a[92:95], v[244:247]
ds_read_b64_tr_b16 a[82:83], v12 offset:1024
v_cvt_pk_bf16_f32 v201, v202, v203
v_mfma_f32_16x16x32_bf16 v[236:239], a[68:71], a[92:95], v[236:239]
ds_read_b64_tr_b16 a[84:85], v12 offset:8192
v_cvt_pk_bf16_f32 v202, v204, v205
v_mfma_f32_16x16x32_bf16 v[236:239], a[48:51], a[88:91], v[236:239]
buffer_store_dwordx4 a[116:119], v16, s[88:91], s15 offen offset:3072 sc1
v_mfma_f32_16x16x32_bf16 v[228:231], a[44:47], a[88:91], v[228:231]
ds_read_b64_tr_b16 a[86:87], v12 offset:9216
v_cvt_pk_bf16_f32 v203, v206, v207
v_cvt_pk_bf16_f32 v208, v208, v209
v_mfma_f32_16x16x32_bf16 v[228:231], a[64:67], a[92:95], v[228:231]
v_cvt_pk_bf16_f32 v209, v210, v211
v_cvt_pk_bf16_f32 v210, v212, v213
v_mfma_f32_16x16x32_bf16 v[220:223], a[60:63], a[92:95], v[220:223]
v_cvt_pk_bf16_f32 v211, v214, v215
v_mfma_f32_16x16x32_bf16 v[220:223], a[40:43], a[88:91], v[220:223]
s_waitcnt lgkmcnt(4)
v_mfma_f32_16x16x32_bf16 v[152:155], a[96:99], a[40:43], v[152:155]
ds_read_b64_tr_b16 a[88:89], v13 offset:0
v_mfma_f32_16x16x32_bf16 v[152:155], a[100:103], a[60:63], v[152:155]
ds_read_b64_tr_b16 a[90:91], v13 offset:1024
v_mfma_f32_16x16x32_bf16 v[160:163], a[100:103], a[64:67], v[160:163]
ds_read_b64_tr_b16 a[92:93], v13 offset:8192
v_mfma_f32_16x16x32_bf16 v[160:163], a[96:99], a[44:47], v[160:163]
ds_read_b64_tr_b16 a[94:95], v13 offset:9216
v_mfma_f32_16x16x32_bf16 v[168:171], a[96:99], a[48:51], v[168:171]
ds_write_b64 v22, v[248:249]
v_mfma_f32_16x16x32_bf16 v[168:171], a[100:103], a[68:71], v[168:171]
ds_write_b128 v5, v[192:195] offset:2048
v_mfma_f32_16x16x32_bf16 v[176:179], a[100:103], a[72:75], v[176:179]
ds_write_b128 v5, v[208:211] offset:18432
v_mfma_f32_16x16x32_bf16 v[176:179], a[96:99], a[52:55], v[176:179]
ds_write_b128 v4, v[184:187] offset:2048
v_mfma_f32_16x16x32_bf16 v[180:183], a[104:107], a[52:55], v[180:183]
ds_read_b64_tr_b16 a[96:97], v12 offset:256
v_mfma_f32_16x16x32_bf16 v[180:183], a[108:111], a[72:75], v[180:183]
ds_read_b64_tr_b16 a[98:99], v12 offset:1280
v_mfma_f32_16x16x32_bf16 v[172:175], a[108:111], a[68:71], v[172:175]
ds_read_b64_tr_b16 a[100:101], v12 offset:8448
v_mfma_f32_16x16x32_bf16 v[172:175], a[104:107], a[48:51], v[172:175]
ds_read_b64_tr_b16 a[102:103], v12 offset:9472
v_mfma_f32_16x16x32_bf16 v[164:167], a[104:107], a[44:47], v[164:167]
ds_write_b128 v4, v[200:203] offset:18432
v_cvt_pk_bf16_f32 v252, v252, v253
v_mfma_f32_16x16x32_bf16 v[164:167], a[108:111], a[64:67], v[164:167]
v_cvt_pk_bf16_f32 v253, v254, v255
v_cvt_pk_bf16_f32 v219, v218, v219
v_mfma_f32_16x16x32_bf16 v[156:159], a[108:111], a[60:63], v[156:159]
v_cvt_pk_bf16_f32 v218, v216, v217
v_cvt_pk_bf16_f32 v223, v222, v223
v_mfma_f32_16x16x32_bf16 v[156:159], a[104:107], a[40:43], v[156:159]
s_waitcnt lgkmcnt(4)
v_cvt_pk_bf16_f32 v222, v220, v221
v_cvt_pk_bf16_f32 v227, v226, v227
v_mfma_f32_16x16x32_bf16 v[24:27], a[80:83], a[40:43], v[24:27]
ds_read_b64_tr_b16 a[104:105], v13 offset:256
v_cvt_pk_bf16_f32 v226, v224, v225
v_cvt_pk_bf16_f32 v231, v230, v231
v_mfma_f32_16x16x32_bf16 v[24:27], a[84:87], a[60:63], v[24:27]
ds_read_b64_tr_b16 a[106:107], v13 offset:1280
v_cvt_pk_bf16_f32 v230, v228, v229
v_mfma_f32_16x16x32_bf16 v[32:35], a[84:87], a[64:67], v[32:35]
ds_read_b64_tr_b16 a[108:109], v13 offset:8448
v_cvt_pk_bf16_f32 v235, v234, v235
v_mfma_f32_16x16x32_bf16 v[32:35], a[80:83], a[44:47], v[32:35]
ds_read_b64_tr_b16 a[110:111], v13 offset:9472
v_cvt_pk_bf16_f32 v234, v232, v233
v_mfma_f32_16x16x32_bf16 v[40:43], a[80:83], a[48:51], v[40:43]
v_cvt_pk_bf16_f32 v239, v238, v239
v_cvt_pk_bf16_f32 v238, v236, v237
v_cvt_pk_bf16_f32 v243, v242, v243
v_mfma_f32_16x16x32_bf16 v[40:43], a[84:87], a[68:71], v[40:43]
v_cvt_pk_bf16_f32 v242, v240, v241
v_cvt_pk_bf16_f32 v247, v246, v247
v_mfma_f32_16x16x32_bf16 v[48:51], a[84:87], a[72:75], v[48:51]
v_cvt_pk_bf16_f32 v246, v244, v245
v_mfma_f32_16x16x32_bf16 v[48:51], a[80:83], a[52:55], v[48:51]
ds_write_b64 v22, v[252:253] offset:1024
v_mfma_f32_16x16x32_bf16 v[52:55], a[88:91], a[52:55], v[52:55]
ds_read_b64_tr_b16 a[80:81], v12 offset:512
v_mfma_f32_16x16x32_bf16 v[52:55], a[92:95], a[72:75], v[52:55]
ds_read_b64_tr_b16 a[82:83], v12 offset:1536
v_mfma_f32_16x16x32_bf16 v[44:47], a[92:95], a[68:71], v[44:47]
ds_read_b64_tr_b16 a[84:85], v12 offset:8704
v_mfma_f32_16x16x32_bf16 v[44:47], a[88:91], a[48:51], v[44:47]
ds_read_b64_tr_b16 a[86:87], v12 offset:9728
v_mfma_f32_16x16x32_bf16 v[36:39], a[88:91], a[44:47], v[36:39]
ds_write_b64 v5, v[226:227] offset:3072
v_mfma_f32_16x16x32_bf16 v[36:39], a[92:95], a[64:67], v[36:39]
ds_write_b64 v5, v[230:231] offset:3080
v_mfma_f32_16x16x32_bf16 v[28:31], a[92:95], a[60:63], v[28:31]
ds_write_b64 v5, v[242:243] offset:19456
v_mfma_f32_16x16x32_bf16 v[28:31], a[88:91], a[40:43], v[28:31]
s_waitcnt lgkmcnt(4)
v_mfma_f32_16x16x32_bf16 v[56:59], a[96:99], a[40:43], v[56:59]
ds_read_b64_tr_b16 a[88:89], v13 offset:512
v_mfma_f32_16x16x32_bf16 v[56:59], a[100:103], a[60:63], v[56:59]
ds_read_b64_tr_b16 a[90:91], v13 offset:1536
v_mfma_f32_16x16x32_bf16 v[64:67], a[100:103], a[64:67], v[64:67]
ds_read_b64_tr_b16 a[92:93], v13 offset:8704
v_mfma_f32_16x16x32_bf16 v[64:67], a[96:99], a[44:47], v[64:67]
ds_read_b64_tr_b16 a[94:95], v13 offset:9728
v_mfma_f32_16x16x32_bf16 v[72:75], a[96:99], a[48:51], v[72:75]
ds_write_b64 v5, v[246:247] offset:19464
v_mfma_f32_16x16x32_bf16 v[72:75], a[100:103], a[68:71], v[72:75]
ds_write_b64 v4, v[218:219] offset:3072
v_mfma_f32_16x16x32_bf16 v[80:83], a[100:103], a[72:75], v[80:83]
ds_write_b64 v4, v[222:223] offset:3080
v_mfma_f32_16x16x32_bf16 v[80:83], a[96:99], a[52:55], v[80:83]
ds_write_b64 v4, v[234:235] offset:19456
v_mfma_f32_16x16x32_bf16 v[84:87], a[104:107], a[52:55], v[84:87]
ds_read_b64_tr_b16 a[96:97], v12 offset:768
v_mfma_f32_16x16x32_bf16 v[84:87], a[108:111], a[72:75], v[84:87]
ds_read_b64_tr_b16 a[98:99], v12 offset:1792
v_mfma_f32_16x16x32_bf16 v[76:79], a[108:111], a[68:71], v[76:79]
ds_read_b64_tr_b16 a[100:101], v12 offset:8960
v_mfma_f32_16x16x32_bf16 v[76:79], a[104:107], a[48:51], v[76:79]
ds_read_b64_tr_b16 a[102:103], v12 offset:9984
v_mfma_f32_16x16x32_bf16 v[68:71], a[104:107], a[44:47], v[68:71]
ds_write_b64 v4, v[238:239] offset:19464
v_cvt_pk_bf16_f32 v152, v152, v153
v_mfma_f32_16x16x32_bf16 v[68:71], a[108:111], a[64:67], v[68:71]
v_cvt_pk_bf16_f32 v153, v154, v155
v_cvt_pk_bf16_f32 v154, v156, v157
v_mfma_f32_16x16x32_bf16 v[60:63], a[108:111], a[60:63], v[60:63]
v_cvt_pk_bf16_f32 v155, v158, v159
v_cvt_pk_bf16_f32 v160, v160, v161
v_mfma_f32_16x16x32_bf16 v[60:63], a[104:107], a[40:43], v[60:63]
s_waitcnt lgkmcnt(4)
v_cvt_pk_bf16_f32 v161, v162, v163
v_cvt_pk_bf16_f32 v162, v164, v165
v_mfma_f32_16x16x32_bf16 v[88:91], a[80:83], a[40:43], v[88:91]
ds_read_b64_tr_b16 a[104:105], v13 offset:768
v_cvt_pk_bf16_f32 v163, v166, v167
v_cvt_pk_bf16_f32 v168, v168, v169
v_mfma_f32_16x16x32_bf16 v[88:91], a[84:87], a[60:63], v[88:91]
ds_read_b64_tr_b16 a[106:107], v13 offset:1792
v_cvt_pk_bf16_f32 v169, v170, v171
v_mfma_f32_16x16x32_bf16 v[96:99], a[84:87], a[64:67], v[96:99]
ds_read_b64_tr_b16 a[108:109], v13 offset:8960
v_cvt_pk_bf16_f32 v170, v172, v173
v_mfma_f32_16x16x32_bf16 v[96:99], a[80:83], a[44:47], v[96:99]
ds_read_b64_tr_b16 a[110:111], v13 offset:9984
v_cvt_pk_bf16_f32 v171, v174, v175
v_mfma_f32_16x16x32_bf16 v[104:107], a[80:83], a[48:51], v[104:107]
v_cvt_pk_bf16_f32 v176, v176, v177
v_cvt_pk_bf16_f32 v177, v178, v179
v_cvt_pk_bf16_f32 v178, v180, v181
v_mfma_f32_16x16x32_bf16 v[104:107], a[84:87], a[68:71], v[104:107]
v_cvt_pk_bf16_f32 v179, v182, v183
v_mfma_f32_16x16x32_bf16 v[112:115], a[84:87], a[72:75], v[112:115]
v_mfma_f32_16x16x32_bf16 v[112:115], a[80:83], a[52:55], v[112:115]
v_mfma_f32_16x16x32_bf16 v[116:119], a[88:91], a[52:55], v[116:119]
v_mfma_f32_16x16x32_bf16 v[116:119], a[92:95], a[72:75], v[116:119]
v_mfma_f32_16x16x32_bf16 v[108:111], a[92:95], a[68:71], v[108:111]
v_mfma_f32_16x16x32_bf16 v[108:111], a[88:91], a[48:51], v[108:111]
v_mov_b32 v15, s6
v_writelane_b32 v15, s18, 0
v_mfma_f32_16x16x32_bf16 v[100:103], a[88:91], a[44:47], v[100:103]
v_lshlrev_b32 v15, 2, v15
v_bfe_u32 v12, v0, 2, 2
v_lshlrev_b32 v12, 11, v12
v_mfma_f32_16x16x32_bf16 v[100:103], a[92:95], a[64:67], v[100:103]
v_lshrrev_b32 v13, 4, v0
v_lshl_add_u32 v12, v13, 6, v12
v_mfma_f32_16x16x32_bf16 v[92:95], a[92:95], a[60:63], v[92:95]
v_and_b32 v13, 3, v0
v_lshl_add_u32 v12, v13, 4, v12
v_mfma_f32_16x16x32_bf16 v[92:95], a[88:91], a[40:43], v[92:95]
s_waitcnt lgkmcnt(0)
v_xor_b32 v12, s13, v12
v_xor_b32 v13, 32, v12
v_mfma_f32_16x16x32_bf16 v[120:123], a[96:99], a[40:43], v[120:123]
v_add_u32 v13, 7168, v13
v_mul_f32 v24, s52, v24
v_mul_f32 v25, s52, v25
v_mfma_f32_16x16x32_bf16 v[120:123], a[100:103], a[60:63], v[120:123]
v_mul_f32 v26, s52, v26
v_mul_f32 v27, s52, v27
v_mfma_f32_16x16x32_bf16 v[128:131], a[100:103], a[64:67], v[128:131]
v_mul_f32 v28, s52, v28
v_mul_f32 v29, s52, v29
v_mfma_f32_16x16x32_bf16 v[128:131], a[96:99], a[44:47], v[128:131]
v_mul_f32 v30, s52, v30
v_mul_f32 v31, s52, v31
v_mfma_f32_16x16x32_bf16 v[136:139], a[96:99], a[48:51], v[136:139]
v_cvt_pk_bf16_f32 v24, v24, v25
v_cvt_pk_bf16_f32 v25, v26, v27
v_cvt_pk_bf16_f32 v26, v28, v29
v_mfma_f32_16x16x32_bf16 v[136:139], a[100:103], a[68:71], v[136:139]
v_cvt_pk_bf16_f32 v27, v30, v31
v_accvgpr_write_b32 a160, v24
v_mfma_f32_16x16x32_bf16 v[144:147], a[100:103], a[72:75], v[144:147]
v_accvgpr_write_b32 a161, v25
v_accvgpr_write_b32 a162, v26
v_mfma_f32_16x16x32_bf16 v[144:147], a[96:99], a[52:55], v[144:147]
v_accvgpr_write_b32 a163, v27
v_mul_f32 v32, s52, v32
v_mfma_f32_16x16x32_bf16 v[148:151], a[104:107], a[52:55], v[148:151]
v_mul_f32 v33, s52, v33
v_mul_f32 v34, s52, v34
v_mul_f32 v35, s52, v35
v_mfma_f32_16x16x32_bf16 v[148:151], a[108:111], a[72:75], v[148:151]
v_mul_f32 v36, s52, v36
v_mul_f32 v37, s52, v37
v_mfma_f32_16x16x32_bf16 v[140:143], a[108:111], a[68:71], v[140:143]
v_mul_f32 v38, s52, v38
v_mul_f32 v39, s52, v39
v_mfma_f32_16x16x32_bf16 v[140:143], a[104:107], a[48:51], v[140:143]
v_cvt_pk_bf16_f32 v32, v32, v33
v_cvt_pk_bf16_f32 v33, v34, v35
v_mfma_f32_16x16x32_bf16 v[132:135], a[104:107], a[44:47], v[132:135]
v_cvt_pk_bf16_f32 v34, v36, v37
v_cvt_pk_bf16_f32 v35, v38, v39
v_accvgpr_write_b32 a176, v32
v_mfma_f32_16x16x32_bf16 v[132:135], a[108:111], a[64:67], v[132:135]
v_accvgpr_write_b32 a177, v33
v_accvgpr_write_b32 a178, v34
v_mfma_f32_16x16x32_bf16 v[124:127], a[108:111], a[60:63], v[124:127]
v_accvgpr_write_b32 a179, v35
v_mfma_f32_16x16x32_bf16 v[124:127], a[104:107], a[40:43], v[124:127]
L_trans:
s_waitcnt vmcnt(21) lgkmcnt(0)
s_barrier
ds_read_b64 v[188:189], v4 offset:8
ds_read_b64 v[190:191], v4 offset:0
ds_read_b64 v[216:217], v4 offset:1032
ds_read_b64 v[220:221], v4 offset:1024
ds_read_b64 v[196:197], v6 offset:0
ds_read_b64 v[198:199], v7 offset:0
ds_read_b64 v[224:225], v6 offset:1024
ds_read_b64 v[228:229], v7 offset:1024
ds_read_b64 v[204:205], v4 offset:16392
ds_read_b64 v[206:207], v4 offset:16384
ds_read_b64 v[232:233], v4 offset:17416
ds_read_b64 v[236:237], v4 offset:17408
ds_read_b64 v[212:213], v6 offset:16384
ds_read_b64 v[214:215], v7 offset:16384
ds_read_b64 v[240:241], v6 offset:17408
ds_read_b64 v[244:245], v7 offset:17408
ds_read_b128 a[0:3], v1 offset:8192
ds_read_b128 a[4:7], v1 offset:9216
ds_read_b128 a[8:11], v1 offset:10240
ds_read_b128 a[12:15], v1 offset:11264
ds_read_b128 a[16:19], v1 offset:12288
ds_read_b128 a[20:23], v1 offset:13312
ds_read_b128 a[24:27], v1 offset:14336
ds_read_b128 a[28:31], v1 offset:15360
L_hopB:
s_mov_b32 s95, 0
v_pk_mul_f32 v[40:41], v[40:41], s[52:53]
v_pk_mul_f32 v[42:43], v[42:43], s[52:53]
v_pk_mul_f32 v[44:45], v[44:45], s[52:53]
v_pk_mul_f32 v[46:47], v[46:47], s[52:53]
v_cvt_pk_bf16_f32 v40, v40, v41
v_cvt_pk_bf16_f32 v41, v42, v43
v_cvt_pk_bf16_f32 v42, v44, v45
v_cvt_pk_bf16_f32 v43, v46, v47
v_accvgpr_write_b32 a192, v40
v_accvgpr_write_b32 a193, v41
v_accvgpr_write_b32 a194, v42
v_accvgpr_write_b32 a195, v43
v_pk_mul_f32 v[48:49], v[48:49], s[52:53]
v_pk_mul_f32 v[50:51], v[50:51], s[52:53]
v_pk_mul_f32 v[52:53], v[52:53], s[52:53]
v_pk_mul_f32 v[54:55], v[54:55], s[52:53]
v_cvt_pk_bf16_f32 v48, v48, v49
v_cvt_pk_bf16_f32 v49, v50, v51
v_cvt_pk_bf16_f32 v50, v52, v53
v_cvt_pk_bf16_f32 v51, v54, v55
v_accvgpr_write_b32 a208, v48
v_accvgpr_write_b32 a209, v49
v_accvgpr_write_b32 a210, v50
v_accvgpr_write_b32 a211, v51
v_mov_b32 v47, s55
v_cndmask_b32 v36, v9, 0, s[56:57]
v_cndmask_b32 v40, v9, 0, s[68:69]
v_min_f32 v32, s55, v36
v_cndmask_b32 v44, v47, 0, s[36:37]
v_cndmask_b32 v37, v9, 0, s[58:59]
v_cndmask_b32 v41, v9, 0, s[70:71]
v_min_f32 v33, s55, v37
v_cndmask_b32 v45, v47, 0, s[38:39]
v_cndmask_b32 v38, v9, 0, s[60:61]
v_cndmask_b32 v42, v9, 0, s[76:77]
v_min_f32 v34, s55, v38
v_cndmask_b32 v46, v47, 0, s[40:41]
v_cndmask_b32 v39, v9, 0, s[62:63]
v_cndmask_b32 v43, v9, 0, s[78:79]
v_min_f32 v35, s55, v39
v_cndmask_b32 v47, v47, 0, s[42:43]
v_pk_mul_f32 v[56:57], v[56:57], s[52:53]
v_pk_mul_f32 v[58:59], v[58:59], s[52:53]
v_pk_mul_f32 v[60:61], v[60:61], s[52:53]
v_pk_mul_f32 v[62:63], v[62:63], s[52:53]
v_cvt_pk_bf16_f32 v56, v56, v57
v_cvt_pk_bf16_f32 v57, v58, v59
v_cvt_pk_bf16_f32 v58, v60, v61
v_cvt_pk_bf16_f32 v59, v62, v63
v_accvgpr_write_b32 a164, v56
v_accvgpr_write_b32 a165, v57
v_accvgpr_write_b32 a166, v58
v_accvgpr_write_b32 a167, v59
v_pk_mul_f32 v[64:65], v[64:65], s[52:53]
v_pk_mul_f32 v[66:67], v[66:67], s[52:53]
v_pk_mul_f32 v[68:69], v[68:69], s[52:53]
v_pk_mul_f32 v[70:71], v[70:71], s[52:53]
v_cvt_pk_bf16_f32 v64, v64, v65
v_cvt_pk_bf16_f32 v65, v66, v67
v_cvt_pk_bf16_f32 v66, v68, v69
v_cvt_pk_bf16_f32 v67, v70, v71
v_accvgpr_write_b32 a180, v64
v_accvgpr_write_b32 a181, v65
v_accvgpr_write_b32 a182, v66
v_accvgpr_write_b32 a183, v67
v_pk_mul_f32 v[72:73], v[72:73], s[52:53]
v_pk_mul_f32 v[74:75], v[74:75], s[52:53]
v_pk_mul_f32 v[76:77], v[76:77], s[52:53]
v_pk_mul_f32 v[78:79], v[78:79], s[52:53]
v_cvt_pk_bf16_f32 v72, v72, v73
v_cvt_pk_bf16_f32 v73, v74, v75
v_cvt_pk_bf16_f32 v74, v76, v77
v_cvt_pk_bf16_f32 v75, v78, v79
v_accvgpr_write_b32 a196, v72
v_accvgpr_write_b32 a197, v73
v_accvgpr_write_b32 a198, v74
v_accvgpr_write_b32 a199, v75
v_pk_mul_f32 v[80:81], v[80:81], s[52:53]
v_pk_mul_f32 v[82:83], v[82:83], s[52:53]
v_pk_mul_f32 v[84:85], v[84:85], s[52:53]
v_pk_mul_f32 v[86:87], v[86:87], s[52:53]
v_cvt_pk_bf16_f32 v80, v80, v81
v_cvt_pk_bf16_f32 v81, v82, v83
v_cvt_pk_bf16_f32 v82, v84, v85
v_cvt_pk_bf16_f32 v83, v86, v87
v_accvgpr_write_b32 a212, v80
v_accvgpr_write_b32 a213, v81
v_accvgpr_write_b32 a214, v82
v_accvgpr_write_b32 a215, v83
v_pk_mul_f32 v[88:89], v[88:89], s[52:53]
v_pk_mul_f32 v[90:91], v[90:91], s[52:53]
v_pk_mul_f32 v[92:93], v[92:93], s[52:53]
v_pk_mul_f32 v[94:95], v[94:95], s[52:53]
v_cvt_pk_bf16_f32 v88, v88, v89
v_cvt_pk_bf16_f32 v89, v90, v91
v_cvt_pk_bf16_f32 v90, v92, v93
v_cvt_pk_bf16_f32 v91, v94, v95
v_accvgpr_write_b32 a168, v88
v_accvgpr_write_b32 a169, v89
v_accvgpr_write_b32 a170, v90
v_accvgpr_write_b32 a171, v91
v_pk_mul_f32 v[96:97], v[96:97], s[52:53]
v_pk_mul_f32 v[98:99], v[98:99], s[52:53]
v_pk_mul_f32 v[100:101], v[100:101], s[52:53]
v_pk_mul_f32 v[102:103], v[102:103], s[52:53]
v_cvt_pk_bf16_f32 v96, v96, v97
v_cvt_pk_bf16_f32 v97, v98, v99
v_cvt_pk_bf16_f32 v98, v100, v101
v_cvt_pk_bf16_f32 v99, v102, v103
v_accvgpr_write_b32 a184, v96
v_accvgpr_write_b32 a185, v97
v_accvgpr_write_b32 a186, v98
v_accvgpr_write_b32 a187, v99
v_pk_mul_f32 v[104:105], v[104:105], s[52:53]
v_pk_mul_f32 v[106:107], v[106:107], s[52:53]
v_pk_mul_f32 v[108:109], v[108:109], s[52:53]
v_pk_mul_f32 v[110:111], v[110:111], s[52:53]
v_cvt_pk_bf16_f32 v104, v104, v105
v_cvt_pk_bf16_f32 v105, v106, v107
v_cvt_pk_bf16_f32 v106, v108, v109
v_cvt_pk_bf16_f32 v107, v110, v111
v_accvgpr_write_b32 a200, v104
v_accvgpr_write_b32 a201, v105
v_accvgpr_write_b32 a202, v106
v_accvgpr_write_b32 a203, v107
v_pk_mul_f32 v[112:113], v[112:113], s[52:53]
v_pk_mul_f32 v[114:115], v[114:115], s[52:53]
v_pk_mul_f32 v[116:117], v[116:117], s[52:53]
v_pk_mul_f32 v[118:119], v[118:119], s[52:53]
v_cvt_pk_bf16_f32 v112, v112, v113
v_cvt_pk_bf16_f32 v113, v114, v115
v_cvt_pk_bf16_f32 v114, v116, v117
v_cvt_pk_bf16_f32 v115, v118, v119
v_accvgpr_write_b32 a216, v112
v_accvgpr_write_b32 a217, v113
v_accvgpr_write_b32 a218, v114
v_accvgpr_write_b32 a219, v115
v_pk_mul_f32 v[120:121], v[120:121], s[52:53]
v_pk_mul_f32 v[122:123], v[122:123], s[52:53]
v_pk_mul_f32 v[124:125], v[124:125], s[52:53]
v_pk_mul_f32 v[126:127], v[126:127], s[52:53]
v_cvt_pk_bf16_f32 v120, v120, v121
v_cvt_pk_bf16_f32 v121, v122, v123
v_cvt_pk_bf16_f32 v122, v124, v125
v_cvt_pk_bf16_f32 v123, v126, v127
v_accvgpr_write_b32 a172, v120
v_accvgpr_write_b32 a173, v121
v_accvgpr_write_b32 a174, v122
v_accvgpr_write_b32 a175, v123
v_pk_mul_f32 v[128:129], v[128:129], s[52:53]
v_pk_mul_f32 v[130:131], v[130:131], s[52:53]
v_pk_mul_f32 v[132:133], v[132:133], s[52:53]
v_pk_mul_f32 v[134:135], v[134:135], s[52:53]
v_cvt_pk_bf16_f32 v128, v128, v129
v_cvt_pk_bf16_f32 v129, v130, v131
v_cvt_pk_bf16_f32 v130, v132, v133
v_cvt_pk_bf16_f32 v131, v134, v135
v_accvgpr_write_b32 a188, v128
v_accvgpr_write_b32 a189, v129
v_accvgpr_write_b32 a190, v130
v_accvgpr_write_b32 a191, v131
v_pk_mul_f32 v[136:137], v[136:137], s[52:53]
v_pk_mul_f32 v[138:139], v[138:139], s[52:53]
v_pk_mul_f32 v[140:141], v[140:141], s[52:53]
v_pk_mul_f32 v[142:143], v[142:143], s[52:53]
v_cvt_pk_bf16_f32 v136, v136, v137
v_cvt_pk_bf16_f32 v137, v138, v139
v_cvt_pk_bf16_f32 v138, v140, v141
v_cvt_pk_bf16_f32 v139, v142, v143
v_accvgpr_write_b32 a204, v136
v_accvgpr_write_b32 a205, v137
v_accvgpr_write_b32 a206, v138
v_accvgpr_write_b32 a207, v139
v_pk_mul_f32 v[144:145], v[144:145], s[52:53]
v_pk_mul_f32 v[146:147], v[146:147], s[52:53]
v_pk_mul_f32 v[148:149], v[148:149], s[52:53]
v_pk_mul_f32 v[150:151], v[150:151], s[52:53]
v_cvt_pk_bf16_f32 v144, v144, v145
v_cvt_pk_bf16_f32 v145, v146, v147
v_cvt_pk_bf16_f32 v146, v148, v149
v_cvt_pk_bf16_f32 v147, v150, v151
v_accvgpr_write_b32 a220, v144
v_accvgpr_write_b32 a221, v145
v_accvgpr_write_b32 a222, v146
v_accvgpr_write_b32 a223, v147
s_waitcnt lgkmcnt(0)
s_barrier
v_mfma_f32_16x16x32_bf16 v[52:55], v[184:187], v[152:155], v[40:43]
v_mov_b32 v140, 0
v_mov_b32 v141, 0
v_mfma_f32_16x16x32_bf16 v[48:51], v[188:191], v[152:155], v[32:35]
v_mov_b32 v142, 0
v_mov_b32 v143, 0
v_mfma_f32_16x16x32_bf16 v[60:63], v[192:195], v[160:163], v[40:43]
v_mov_b32 v144, 0
v_mov_b32 v145, 0
v_mfma_f32_16x16x32_bf16 v[56:59], v[196:199], v[160:163], v[36:39]
v_mov_b32 v146, 0
v_mov_b32 v147, 0
v_mfma_f32_16x16x32_bf16 v[68:71], v[200:203], v[168:171], v[40:43]
v_mov_b32 v148, 0
v_mov_b32 v149, 0
v_mfma_f32_16x16x32_bf16 v[64:67], v[204:207], v[168:171], v[36:39]
v_max3_f32 v136, v48, v49, v50
v_max3_f32 v136, v136, v51, v52
v_mfma_f32_16x16x32_bf16 v[76:79], v[208:211], v[176:179], v[40:43]
v_max3_f32 v136, v136, v53, v54
v_max_f32 v136, v136, v55
v_mfma_f32_16x16x32_bf16 v[72:75], v[212:215], v[176:179], v[36:39]
v_max3_f32 v137, v56, v57, v58
v_max3_f32 v137, v137, v59, v60
v_mfma_f32_16x16x32_bf16 v[16:19], a[0:3], a[160:163], v[44:47]
v_max3_f32 v137, v137, v61, v62
v_max_f32 v137, v137, v63
v_mfma_f32_16x16x32_bf16 v[16:19], a[4:7], a[164:167], v[16:19]
v_max3_f32 v138, v64, v65, v66
v_max3_f32 v138, v138, v67, v68
v_mfma_f32_16x16x32_bf16 v[16:19], a[8:11], a[168:171], v[16:19]
v_max3_f32 v138, v138, v69, v70
v_max_f32 v138, v138, v71
v_mfma_f32_16x16x32_bf16 v[16:19], a[12:15], a[172:175], v[16:19]
v_max3_f32 v139, v72, v73, v74
v_max3_f32 v139, v139, v75, v76
v_mfma_f32_16x16x32_bf16 v[20:23], a[0:3], a[176:179], 0
v_max3_f32 v139, v139, v77, v78
v_max_f32 v139, v139, v79
v_mfma_f32_16x16x32_bf16 v[20:23], a[4:7], a[180:183], v[20:23]
L_padA13:
s_cmp_eq_u32 s95, 1
s_cbranch_scc1 L_hopA_ret
v_mov_b32 v150, 0
v_mov_b32 v151, 0
v_mfma_f32_16x16x32_bf16 v[20:23], a[8:11], a[184:187], v[20:23]
v_mov_b32 v248, 0
v_mov_b32 v249, 0
v_mfma_f32_16x16x32_bf16 v[20:23], a[12:15], a[188:191], v[20:23]
v_mov_b32 v250, 0
v_mov_b32 v251, 0
v_mfma_f32_16x16x32_bf16 v[24:27], a[0:3], a[192:195], 0
v_mov_b32 v252, 0
v_mov_b32 v253, 0
v_mfma_f32_16x16x32_bf16 v[24:27], a[4:7], a[196:199], v[24:27]
v_mov_b32 v254, 0
v_mov_b32 v255, 0
v_mfma_f32_16x16x32_bf16 v[24:27], a[8:11], a[200:203], v[24:27]
v_max3_f32 v80, v16, v17, v18
v_max_f32 v80, v80, v19
v_mfma_f32_16x16x32_bf16 v[24:27], a[12:15], a[204:207], v[24:27]
v_max3_f32 v84, v20, v21, v22
v_max_f32 v84, v84, v23
v_mfma_f32_16x16x32_bf16 v[28:31], a[0:3], a[208:211], 0
v_mov_b32 v128, v136
v_mov_b32 v129, v137
v_mfma_f32_16x16x32_bf16 v[28:31], a[4:7], a[212:215], v[28:31]
v_mov_b32 v130, v138
v_mov_b32 v131, v139
v_mfma_f32_16x16x32_bf16 v[28:31], a[8:11], a[216:219], v[28:31]
v_permlane16_swap_b32 v128, v136
v_permlane16_swap_b32 v129, v137
v_mfma_f32_16x16x32_bf16 v[28:31], a[12:15], a[220:223], v[28:31]
v_permlane16_swap_b32 v130, v138
v_permlane16_swap_b32 v131, v139
v_max_f32 v136, v136, v128
v_max_f32 v137, v137, v129
v_max_f32 v138, v138, v130
v_max_f32 v139, v139, v131
v_max3_f32 v88, v24, v25, v26
v_max_f32 v88, v88, v27
v_mov_b32 v128, v136
v_mov_b32 v129, v137
v_mov_b32 v130, v138
v_mov_b32 v131, v139
v_max3_f32 v92, v28, v29, v30
v_max_f32 v92, v92, v31
v_permlane32_swap_b32 v128, v136
v_permlane32_swap_b32 v129, v137
v_permlane32_swap_b32 v130, v138
v_permlane32_swap_b32 v131, v139
v_max_f32 v136, v136, v128
v_max_f32 v137, v137, v129
v_max_f32 v138, v138, v130
v_max_f32 v139, v139, v131
v_mul_f32 v136, s54, v136
v_mul_f32 v137, s54, v137
v_mul_f32 v138, s54, v138
v_mul_f32 v139, s54, v139
v_fma_f32 v48, v48, s54, -v136
v_fma_f32 v49, v49, s54, -v136
v_fma_f32 v50, v50, s54, -v136
v_fma_f32 v51, v51, s54, -v136
v_fma_f32 v52, v52, s54, -v136
v_fma_f32 v53, v53, s54, -v136
v_fma_f32 v54, v54, s54, -v136
v_fma_f32 v55, v55, s54, -v136
v_exp_f32 v48, v48
v_exp_f32 v49, v49
v_exp_f32 v50, v50
v_exp_f32 v51, v51
v_exp_f32 v52, v52
v_exp_f32 v53, v53
v_exp_f32 v54, v54
v_exp_f32 v55, v55
v_fma_f32 v56, v56, s54, -v137
v_fma_f32 v57, v57, s54, -v137
v_fma_f32 v58, v58, s54, -v137
v_fma_f32 v59, v59, s54, -v137
v_fma_f32 v60, v60, s54, -v137
v_fma_f32 v61, v61, s54, -v137
v_fma_f32 v62, v62, s54, -v137
v_fma_f32 v63, v63, s54, -v137
v_exp_f32 v56, v56
v_exp_f32 v57, v57
v_exp_f32 v58, v58
v_exp_f32 v59, v59
v_exp_f32 v60, v60
v_exp_f32 v61, v61
v_exp_f32 v62, v62
v_exp_f32 v63, v63
v_fma_f32 v64, v64, s54, -v138
v_fma_f32 v65, v65, s54, -v138
v_fma_f32 v66, v66, s54, -v138
v_fma_f32 v67, v67, s54, -v138
v_fma_f32 v68, v68, s54, -v138
v_fma_f32 v69, v69, s54, -v138
v_fma_f32 v70, v70, s54, -v138
v_fma_f32 v71, v71, s54, -v138
v_exp_f32 v64, v64
v_exp_f32 v65, v65
v_exp_f32 v66, v66
v_exp_f32 v67, v67
v_exp_f32 v68, v68
v_exp_f32 v69, v69
v_exp_f32 v70, v70
v_exp_f32 v71, v71
v_fma_f32 v72, v72, s54, -v139
v_fma_f32 v73, v73, s54, -v139
v_fma_f32 v74, v74, s54, -v139
v_fma_f32 v75, v75, s54, -v139
v_fma_f32 v76, v76, s54, -v139
v_fma_f32 v77, v77, s54, -v139
v_fma_f32 v78, v78, s54, -v139
v_fma_f32 v79, v79, s54, -v139
v_exp_f32 v72, v72
v_exp_f32 v73, v73
v_exp_f32 v74, v74
v_exp_f32 v75, v75
v_exp_f32 v76, v76
v_exp_f32 v77, v77
v_exp_f32 v78, v78
v_exp_f32 v79, v79
v_cvt_pk_bf16_f32 v48, v48, v49
v_cvt_pk_bf16_f32 v49, v50, v51
v_cvt_pk_bf16_f32 v50, v52, v53
v_cvt_pk_bf16_f32 v51, v54, v55
v_cvt_pk_bf16_f32 v56, v56, v57
v_cvt_pk_bf16_f32 v57, v58, v59
v_cvt_pk_bf16_f32 v58, v60, v61
v_cvt_pk_bf16_f32 v59, v62, v63
v_cvt_pk_bf16_f32 v64, v64, v65
v_cvt_pk_bf16_f32 v65, v66, v67
v_cvt_pk_bf16_f32 v66, v68, v69
v_cvt_pk_bf16_f32 v67, v70, v71
v_cvt_pk_bf16_f32 v72, v72, v73
v_cvt_pk_bf16_f32 v73, v74, v75
v_cvt_pk_bf16_f32 v74, v76, v77
v_cvt_pk_bf16_f32 v75, v78, v79
v_mfma_f32_16x16x32_bf16 v[156:159], a[240:243], v[48:51], 0
v_mov_b32 v128, v80
v_mov_b32 v129, v84
v_mfma_f32_16x16x32_bf16 v[164:167], a[240:243], v[56:59], 0
v_mov_b32 v130, v88
v_mov_b32 v131, v92
v_mfma_f32_16x16x32_bf16 v[172:175], a[240:243], v[64:67], 0
v_permlane16_swap_b32 v128, v80
v_permlane16_swap_b32 v129, v84
v_mfma_f32_16x16x32_bf16 v[180:183], a[240:243], v[72:75], 0
v_permlane16_swap_b32 v130, v88
v_permlane16_swap_b32 v131, v92
v_mfma_f32_16x16x32_bf16 v[184:187], v[216:219], v[48:51], 0
v_max_f32 v80, v80, v128
v_max_f32 v84, v84, v129
v_mfma_f32_16x16x32_bf16 v[188:191], v[220:223], v[48:51], 0
v_max_f32 v88, v88, v130
v_max_f32 v92, v92, v131
v_mfma_f32_16x16x32_bf16 v[192:195], v[224:227], v[56:59], 0
v_mov_b32 v128, v80
v_mov_b32 v129, v84
v_mfma_f32_16x16x32_bf16 v[196:199], v[228:231], v[56:59], 0
v_mov_b32 v130, v88
v_mov_b32 v131, v92
v_mfma_f32_16x16x32_bf16 v[200:203], v[232:235], v[64:67], 0
v_permlane32_swap_b32 v128, v80
v_permlane32_swap_b32 v129, v84
v_mfma_f32_16x16x32_bf16 v[204:207], v[236:239], v[64:67], 0
v_permlane32_swap_b32 v130, v88
v_permlane32_swap_b32 v131, v92
v_mfma_f32_16x16x32_bf16 v[208:211], v[240:243], v[72:75], 0
v_max_f32 v80, v80, v128
v_max_f32 v84, v84, v129
v_mfma_f32_16x16x32_bf16 v[212:215], v[244:247], v[72:75], 0
v_max_f32 v88, v88, v130
v_max_f32 v92, v92, v131
v_rcp_f32 v128, v156
v_rcp_f32 v130, v164
v_rcp_f32 v132, v172
v_rcp_f32 v134, v180
v_sub_f32 v83, 0, v80
v_sub_f32 v82, 0, v80
v_sub_f32 v81, 0, v80
v_sub_f32 v80, 0, v80
v_min_f32 v103, s8, v80
v_cndmask_b32 v96, v103, v80, s[36:37]
v_cndmask_b32 v97, v103, v80, s[38:39]
v_cndmask_b32 v98, v103, v80, s[40:41]
v_cndmask_b32 v99, v103, v80, s[42:43]
v_cndmask_b32 v100, v9, v103, s[36:37]
v_cndmask_b32 v101, v9, v103, s[38:39]
v_cndmask_b32 v102, v9, v103, s[40:41]
v_cndmask_b32 v103, v9, v103, s[42:43]
v_pk_mul_f32 v[184:185], v[184:185], v[128:129] op_sel_hi:[1,0]
v_pk_mul_f32 v[186:187], v[186:187], v[128:129] op_sel_hi:[1,0]
v_pk_mul_f32 v[188:189], v[188:189], v[128:129] op_sel_hi:[1,0]
v_pk_mul_f32 v[190:191], v[190:191], v[128:129] op_sel_hi:[1,0]
v_pk_mul_f32 v[192:193], v[192:193], v[130:131] op_sel_hi:[1,0]
v_pk_mul_f32 v[194:195], v[194:195], v[130:131] op_sel_hi:[1,0]
v_pk_mul_f32 v[196:197], v[196:197], v[130:131] op_sel_hi:[1,0]
v_pk_mul_f32 v[198:199], v[198:199], v[130:131] op_sel_hi:[1,0]
v_pk_mul_f32 v[200:201], v[200:201], v[132:133] op_sel_hi:[1,0]
v_pk_mul_f32 v[202:203], v[202:203], v[132:133] op_sel_hi:[1,0]
v_pk_mul_f32 v[204:205], v[204:205], v[132:133] op_sel_hi:[1,0]
v_pk_mul_f32 v[206:207], v[206:207], v[132:133] op_sel_hi:[1,0]
v_pk_mul_f32 v[208:209], v[208:209], v[134:135] op_sel_hi:[1,0]
v_pk_mul_f32 v[210:211], v[210:211], v[134:135] op_sel_hi:[1,0]
v_pk_mul_f32 v[212:213], v[212:213], v[134:135] op_sel_hi:[1,0]
v_pk_mul_f32 v[214:215], v[214:215], v[134:135] op_sel_hi:[1,0]
s_bitcmp1_b32 s4, 0
s_cbranch_scc1 L_ob_odd
v_cvt_pk_bf16_f32 v32, v184, v185
v_cvt_pk_bf16_f32 v33, v186, v187
v_cvt_pk_bf16_f32 v34, v188, v189
v_cvt_pk_bf16_f32 v35, v190, v191
v_cvt_pk_bf16_f32 v36, v192, v193
v_cvt_pk_bf16_f32 v37, v194, v195
v_cvt_pk_bf16_f32 v38, v196, v197
v_cvt_pk_bf16_f32 v39, v198, v199
v_cvt_pk_bf16_f32 v40, v200, v201
v_cvt_pk_bf16_f32 v41, v202, v203
v_cvt_pk_bf16_f32 v42, v204, v205
v_cvt_pk_bf16_f32 v43, v206, v207
v_cvt_pk_bf16_f32 v44, v208, v209
v_cvt_pk_bf16_f32 v45, v210, v211
v_cvt_pk_bf16_f32 v46, v212, v213
v_cvt_pk_bf16_f32 v47, v214, v215
s_branch L_ob_packed
L_ob_odd:
v_cvt_pk_bf16_f32 v35, v186, v187
v_cvt_pk_bf16_f32 v34, v184, v185
v_cvt_pk_bf16_f32 v32, v188, v189
v_cvt_pk_bf16_f32 v33, v190, v191
v_cvt_pk_bf16_f32 v39, v194, v195
v_cvt_pk_bf16_f32 v38, v192, v193
v_cvt_pk_bf16_f32 v36, v196, v197
v_cvt_pk_bf16_f32 v37, v198, v199
v_cvt_pk_bf16_f32 v43, v202, v203
v_cvt_pk_bf16_f32 v42, v200, v201
v_cvt_pk_bf16_f32 v40, v204, v205
v_cvt_pk_bf16_f32 v41, v206, v207
v_cvt_pk_bf16_f32 v47, v210, v211
v_cvt_pk_bf16_f32 v46, v208, v209
v_cvt_pk_bf16_f32 v44, v212, v213
v_cvt_pk_bf16_f32 v45, v214, v215
L_ob_packed:
buffer_store_dwordx4 v[32:35], v3, s[88:91], s44 offen sc1
v_sub_f32 v87, 0, v84
v_sub_f32 v86, 0, v84
v_sub_f32 v85, 0, v84
v_sub_f32 v84, 0, v84
v_min_f32 v111, s9, v84
v_cndmask_b32 v104, v111, v84, s[36:37]
v_cndmask_b32 v105, v111, v84, s[38:39]
v_cndmask_b32 v106, v111, v84, s[40:41]
v_cndmask_b32 v107, v111, v84, s[42:43]
v_cndmask_b32 v108, v9, v111, s[36:37]
v_cndmask_b32 v109, v9, v111, s[38:39]
v_cndmask_b32 v110, v9, v111, s[40:41]
v_cndmask_b32 v111, v9, v111, s[42:43]
v_sub_f32 v91, 0, v88
v_sub_f32 v90, 0, v88
v_sub_f32 v89, 0, v88
v_sub_f32 v88, 0, v88
v_min_f32 v119, s8, v88
v_cndmask_b32 v112, v119, v88, s[36:37]
v_cndmask_b32 v113, v119, v88, s[38:39]
v_cndmask_b32 v114, v119, v88, s[40:41]
v_cndmask_b32 v115, v119, v88, s[42:43]
v_cndmask_b32 v116, v9, v119, s[36:37]
v_cndmask_b32 v117, v9, v119, s[38:39]
buffer_store_dwordx4 v[36:39], v3, s[88:91], s45 offen sc1
v_cndmask_b32 v118, v9, v119, s[40:41]
v_cndmask_b32 v119, v9, v119, s[42:43]
v_sub_f32 v95, 0, v92
v_sub_f32 v94, 0, v92
v_sub_f32 v93, 0, v92
v_sub_f32 v92, 0, v92
v_min_f32 v127, s9, v92
v_cndmask_b32 v120, v127, v92, s[36:37]
v_cndmask_b32 v121, v127, v92, s[38:39]
v_cndmask_b32 v122, v127, v92, s[40:41]
v_cndmask_b32 v123, v127, v92, s[42:43]
v_cndmask_b32 v124, v9, v127, s[36:37]
v_cndmask_b32 v125, v9, v127, s[38:39]
v_cndmask_b32 v126, v9, v127, s[40:41]
v_cndmask_b32 v127, v9, v127, s[42:43]
v_and_b32 v9, 1, v0
v_mul_u32_u24 v9, 0xaaaa, v9
v_add_u32 v9, 0x4444, v9
v_mov_b64 v[128:129], 0
v_mov_b64 v[130:131], 0
v_mov_b64 v[132:133], 0
v_mov_b64 v[134:135], 0
v_mov_b64 v[136:137], 0
v_mov_b64 v[138:139], 0
buffer_store_dwordx4 v[40:43], v3, s[88:91], s46 offen sc1
v_mov_b64 v[152:153], 0
v_mov_b64 v[154:155], 0
v_mov_b64 v[156:157], 0
v_mov_b64 v[158:159], 0
v_mov_b64 v[160:161], 0
v_mov_b64 v[162:163], 0
v_mov_b64 v[164:165], 0
v_mov_b64 v[166:167], 0
v_mov_b64 v[168:169], 0
v_mov_b64 v[170:171], 0
v_mov_b64 v[172:173], 0
v_mov_b64 v[174:175], 0
v_mov_b64 v[176:177], 0
v_mov_b64 v[178:179], 0
v_mov_b64 v[180:181], 0
v_mov_b64 v[182:183], 0
v_mov_b64 v[184:185], 0
v_mov_b64 v[186:187], 0
v_mov_b64 v[188:189], 0
v_mov_b64 v[190:191], 0
v_mov_b64 v[192:193], 0
v_mov_b64 v[194:195], 0
v_mov_b64 v[196:197], 0
v_mov_b64 v[198:199], 0
buffer_store_dwordx4 v[44:47], v3, s[88:91], s47 offen sc1
v_mov_b64 v[200:201], 0
v_mov_b64 v[202:203], 0
v_mov_b64 v[204:205], 0
v_mov_b64 v[206:207], 0
v_mov_b64 v[208:209], 0
v_mov_b64 v[210:211], 0
v_mov_b64 v[212:213], 0
v_mov_b64 v[214:215], 0
v_mov_b64 v[216:217], 0
v_mov_b64 v[218:219], 0
v_mov_b64 v[220:221], 0
v_mov_b64 v[222:223], 0
v_mov_b64 v[224:225], 0
v_mov_b64 v[226:227], 0
v_mov_b64 v[228:229], 0
v_mov_b64 v[230:231], 0
v_mov_b64 v[232:233], 0
v_mov_b64 v[234:235], 0
v_mov_b64 v[236:237], 0
v_mov_b64 v[238:239], 0
v_mov_b64 v[240:241], 0
v_mov_b64 v[242:243], 0
v_mov_b64 v[244:245], 0
v_mov_b64 v[246:247], 0
L_att_start:
s_mov_b32 s15, s6
s_cmp_eq_u32 s6, 0
s_cbranch_scc1 L_att_j0
v_mfma_f32_16x16x32_bf16 v[16:19], a[0:3], a[160:163], v[80:83]
v_mfma_f32_16x16x32_bf16 v[16:19], a[4:7], a[164:167], v[16:19]
v_mfma_f32_16x16x32_bf16 v[16:19], a[8:11], a[168:171], v[16:19]
s_add_u32 m0, s27, 0x0
v_mfma_f32_16x16x32_bf16 v[16:19], a[12:15], a[172:175], v[16:19]
buffer_load_dwordx4 v3, s[48:51], s32 offen offset:0 sc1 lds
v_mfma_f32_16x16x32_bf16 v[20:23], a[0:3], a[176:179], v[84:87]
v_mfma_f32_16x16x32_bf16 v[20:23], a[4:7], a[180:183], v[20:23]
v_mfma_f32_16x16x32_bf16 v[20:23], a[8:11], a[184:187], v[20:23]
v_mfma_f32_16x16x32_bf16 v[20:23], a[12:15], a[188:191], v[20:23]
s_nop 2
v_exp_f32 v16, v16
v_mfma_f32_16x16x32_bf16 v[24:27], a[0:3], a[192:195], v[88:91]
s_nop 0
v_exp_f32 v17, v17
v_mfma_f32_16x16x32_bf16 v[24:27], a[4:7], a[196:199], v[24:27]
v_exp_f32 v18, v18
v_mfma_f32_16x16x32_bf16 v[24:27], a[8:11], a[200:203], v[24:27]
buffer_load_dwordx4 v3, s[48:51], s32 offen offset:1024 sc1 lds
v_mfma_f32_16x16x32_bf16 v[24:27], a[12:15], a[204:207], v[24:27]
v_exp_f32 v19, v19
v_mfma_f32_16x16x32_bf16 v[28:31], a[0:3], a[208:211], v[92:95]
v_exp_f32 v20, v20
v_mfma_f32_16x16x32_bf16 v[28:31], a[4:7], a[212:215], v[28:31]
v_cvt_pk_bf16_f32 v48, v16, v17
v_cvt_pk_bf16_f32 v49, v18, v19
v_mfma_f32_16x16x32_bf16 v[28:31], a[8:11], a[216:219], v[28:31]
v_exp_f32 v21, v21
v_mfma_f32_16x16x32_bf16 v[28:31], a[12:15], a[220:223], v[28:31]
v_cvt_pk_bf16_f32 v52, v20, v21
v_mfma_f32_16x16x32_bf16 v[32:35], a[16:19], a[160:163], v[80:83]
v_exp_f32 v22, v22
v_mfma_f32_16x16x32_bf16 v[32:35], a[20:23], a[164:167], v[32:35]
v_mfma_f32_16x16x32_bf16 v[32:35], a[24:27], a[168:171], v[32:35]
buffer_load_dwordx4 v3, s[48:51], s32 offen offset:2048 sc1 lds
v_mfma_f32_16x16x32_bf16 v[32:35], a[28:31], a[172:175], v[32:35]
v_mfma_f32_16x16x32_bf16 v[36:39], a[16:19], a[176:179], v[84:87]
v_exp_f32 v23, v23
v_mfma_f32_16x16x32_bf16 v[36:39], a[20:23], a[180:183], v[36:39]
v_cvt_pk_bf16_f32 v53, v22, v23
v_mfma_f32_16x16x32_bf16 v[36:39], a[24:27], a[184:187], v[36:39]
v_exp_f32 v24, v24
v_mfma_f32_16x16x32_bf16 v[36:39], a[28:31], a[188:191], v[36:39]
v_mfma_f32_16x16x32_bf16 v[40:43], a[16:19], a[192:195], v[88:91]
v_exp_f32 v25, v25
v_mfma_f32_16x16x32_bf16 v[40:43], a[20:23], a[196:199], v[40:43]
buffer_load_dwordx4 v3, s[48:51], s32 offen offset:3072 sc1 lds
v_mfma_f32_16x16x32_bf16 v[40:43], a[24:27], a[200:203], v[40:43]
s_add_u32 s32, s32, 0x8000
v_mfma_f32_16x16x32_bf16 v[40:43], a[28:31], a[204:207], v[40:43]
v_mfma_f32_16x16x32_bf16 v[44:47], a[16:19], a[208:211], v[92:95]
v_exp_f32 v26, v26
v_mfma_f32_16x16x32_bf16 v[44:47], a[20:23], a[212:215], v[44:47]
v_mfma_f32_16x16x32_bf16 v[44:47], a[24:27], a[216:219], v[44:47]
v_exp_f32 v27, v27
v_mfma_f32_16x16x32_bf16 v[44:47], a[28:31], a[220:223], v[44:47]
s_waitcnt lgkmcnt(0)
ds_read_b128 a[0:3], v1 offset:24576
ds_read_b128 a[4:7], v1 offset:25600
ds_read_b128 a[8:11], v1 offset:26624
ds_read_b128 a[12:15], v1 offset:27648
ds_read_b128 a[16:19], v1 offset:28672
ds_read_b128 a[20:23], v1 offset:29696
ds_read_b128 a[24:27], v1 offset:30720
ds_read_b128 a[28:31], v1 offset:31744
s_waitcnt lgkmcnt(7)
v_mfma_f32_16x16x32_bf16 v[16:19], a[0:3], a[160:163], v[80:83]
ds_read_b128 a[32:35], v1 offset:16384
v_cvt_pk_bf16_f32 v56, v24, v25
s_waitcnt lgkmcnt(7)
v_mfma_f32_16x16x32_bf16 v[16:19], a[4:7], a[164:167], v[16:19]
v_exp_f32 v28, v28
s_waitcnt lgkmcnt(6)
v_mfma_f32_16x16x32_bf16 v[16:19], a[8:11], a[168:171], v[16:19]
s_add_u32 m0, s27, 0x1000
v_exp_f32 v29, v29
s_waitcnt lgkmcnt(5)
v_mfma_f32_16x16x32_bf16 v[16:19], a[12:15], a[172:175], v[16:19]
buffer_load_dwordx4 v3, s[48:51], s7 offen offset:0 sc1 lds
v_mfma_f32_16x16x32_bf16 v[20:23], a[0:3], a[176:179], v[84:87]
ds_read_b128 a[36:39], v1 offset:17408
v_cvt_pk_bf16_f32 v57, v26, v27
v_mfma_f32_16x16x32_bf16 v[20:23], a[4:7], a[180:183], v[20:23]
v_exp_f32 v30, v30
v_mfma_f32_16x16x32_bf16 v[20:23], a[8:11], a[184:187], v[20:23]
ds_read_b128 a[40:43], v1 offset:18432
v_cvt_pk_bf16_f32 v60, v28, v29
v_mfma_f32_16x16x32_bf16 v[20:23], a[12:15], a[188:191], v[20:23]
v_exp_f32 v31, v31
v_mfma_f32_16x16x32_bf16 v[24:27], a[0:3], a[192:195], v[88:91]
v_exp_f32 v32, v32
v_mfma_f32_16x16x32_bf16 v[24:27], a[4:7], a[196:199], v[24:27]
ds_read_b128 a[44:47], v1 offset:19456
v_cvt_pk_bf16_f32 v61, v30, v31
v_mfma_f32_16x16x32_bf16 v[24:27], a[8:11], a[200:203], v[24:27]
buffer_load_dwordx4 v3, s[48:51], s7 offen offset:1024 sc1 lds
v_mfma_f32_16x16x32_bf16 v[24:27], a[12:15], a[204:207], v[24:27]
v_exp_f32 v33, v33
v_mfma_f32_16x16x32_bf16 v[28:31], a[0:3], a[208:211], v[92:95]
v_exp_f32 v34, v34
v_mfma_f32_16x16x32_bf16 v[28:31], a[4:7], a[212:215], v[28:31]
ds_read_b128 a[48:51], v1 offset:20480
v_cvt_pk_bf16_f32 v50, v32, v33
v_mfma_f32_16x16x32_bf16 v[28:31], a[8:11], a[216:219], v[28:31]
v_exp_f32 v35, v35
v_mfma_f32_16x16x32_bf16 v[28:31], a[12:15], a[220:223], v[28:31]
v_exp_f32 v36, v36
v_cvt_pk_bf16_f32 v51, v34, v35
s_waitcnt lgkmcnt(8)
v_mfma_f32_16x16x32_bf16 v[32:35], a[16:19], a[160:163], v[80:83]
buffer_load_dwordx4 v3, s[48:51], s7 offen offset:2048 sc1 lds
s_waitcnt lgkmcnt(7)
v_mfma_f32_16x16x32_bf16 v[32:35], a[20:23], a[164:167], v[32:35]
ds_read_b128 a[52:55], v1 offset:21504
v_exp_f32 v37, v37
s_waitcnt lgkmcnt(7)
v_mfma_f32_16x16x32_bf16 v[32:35], a[24:27], a[168:171], v[32:35]
v_exp_f32 v38, v38
s_waitcnt lgkmcnt(6)
v_mfma_f32_16x16x32_bf16 v[32:35], a[28:31], a[172:175], v[32:35]
ds_read_b128 a[56:59], v1 offset:22528
v_cvt_pk_bf16_f32 v54, v36, v37
v_exp_f32 v39, v39
s_nop 0
v_cvt_pk_bf16_f32 v55, v38, v39
v_mfma_f32_16x16x32_bf16 v[36:39], a[16:19], a[176:179], v[84:87]
v_exp_f32 v40, v40
v_mfma_f32_16x16x32_bf16 v[36:39], a[20:23], a[180:183], v[36:39]
v_exp_f32 v41, v41
v_mfma_f32_16x16x32_bf16 v[36:39], a[24:27], a[184:187], v[36:39]
ds_read_b128 a[60:63], v1 offset:23552
v_xor_b32 v1, 0x8000, v1
v_mfma_f32_16x16x32_bf16 v[36:39], a[28:31], a[188:191], v[36:39]
buffer_load_dwordx4 v3, s[48:51], s7 offen offset:3072 sc1 lds
v_exp_f32 v42, v42
v_exp_f32 v43, v43
v_cvt_pk_bf16_f32 v58, v40, v41
v_cvt_pk_bf16_f32 v59, v42, v43
v_mfma_f32_16x16x32_bf16 v[40:43], a[16:19], a[192:195], v[88:91]
s_add_u32 s7, s7, 0x8000
v_exp_f32 v44, v44
v_mfma_f32_16x16x32_bf16 v[40:43], a[20:23], a[196:199], v[40:43]
s_xor_b32 s27, s27, 0x38000
v_exp_f32 v45, v45
v_mfma_f32_16x16x32_bf16 v[40:43], a[24:27], a[200:203], v[40:43]
v_exp_f32 v46, v46
v_mfma_f32_16x16x32_bf16 v[40:43], a[28:31], a[204:207], v[40:43]
v_exp_f32 v47, v47
v_cvt_pk_bf16_f32 v62, v44, v45
v_cvt_pk_bf16_f32 v63, v46, v47
v_mfma_f32_16x16x32_bf16 v[44:47], a[16:19], a[208:211], v[92:95]
v_exp_f32 v16, v16
v_mfma_f32_16x16x32_bf16 v[44:47], a[20:23], a[212:215], v[44:47]
v_exp_f32 v17, v17
v_mfma_f32_16x16x32_bf16 v[44:47], a[24:27], a[216:219], v[44:47]
s_waitcnt vmcnt(8) lgkmcnt(0)
v_exp_f32 v18, v18
v_mfma_f32_16x16x32_bf16 v[44:47], a[28:31], a[220:223], v[44:47]
s_barrier
v_cvt_pk_bf16_f32 v64, v16, v17
v_exp_f32 v19, v19
v_exp_f32 v20, v20
v_exp_f32 v21, v21
v_exp_f32 v22, v22
v_exp_f32 v23, v23
v_exp_f32 v24, v24
v_exp_f32 v25, v25
v_exp_f32 v26, v26
v_exp_f32 v27, v27
v_cvt_pk_bf16_f32 v65, v18, v19
v_cvt_pk_bf16_f32 v68, v20, v21
v_cvt_pk_bf16_f32 v69, v22, v23
s_cmp_lg_u32 s33, 0
s_cbranch_scc1 L_sig_bd
s_lshl_b32 s8, s6, 2
s_add_u32 s8, s8, 192
s_cmp_lg_u32 s4, 0
s_cbranch_scc1 L_sig_bd
v_mov_b32 v4, 1
s_mov_b64 exec, 1
buffer_atomic_add v4, off, s[84:87], s8 sc1
s_mov_b64 exec, -1
L_sig_bd:
s_getreg_b32 s8, hwreg(HW_REG_HW_ID, 5, 1)
s_cmp_lg_u32 s8, 0
s_cbranch_scc1 L_att_dodd1
s_branch L_att_dodd0
L_att_deven0:
v_mfma_f32_16x16x32_bf16 v[128:131], a[32:35], v[48:51], v[128:131]
ds_read_b128 a[0:3], v1 offset:8192
v_cvt_pk_bf16_f32 v72, v24, v25
v_mfma_f32_16x16x32_bf16 v[160:163], a[32:35], v[52:55], v[160:163]
v_exp_f32 v28, v28
v_mfma_f32_16x16x32_bf16 v[192:195], a[32:35], v[56:59], v[192:195]
v_cvt_pk_bf16_f32 v73, v26, v27
v_mfma_f32_16x16x32_bf16 v[224:227], a[32:35], v[60:63], v[224:227]
ds_read_b128 a[4:7], v1 offset:9216
v_mfma_f32_16x16x32_bf16 v[228:231], a[36:39], v[60:63], v[228:231]
v_exp_f32 v29, v29
v_mfma_f32_16x16x32_bf16 v[196:199], a[36:39], v[56:59], v[196:199]
v_exp_f32 v30, v30
v_mfma_f32_16x16x32_bf16 v[164:167], a[36:39], v[52:55], v[164:167]
s_add_u32 m0, s27, 0x0
v_cvt_pk_bf16_f32 v76, v28, v29
v_mfma_f32_16x16x32_bf16 v[132:135], a[36:39], v[48:51], v[132:135]
buffer_load_dwordx4 v3, s[48:51], s32 offen offset:0 sc1 lds
v_mfma_f32_16x16x32_bf16 v[136:139], a[40:43], v[48:51], v[136:139]
ds_read_b128 a[8:11], v1 offset:10240
v_mfma_f32_16x16x32_bf16 v[168:171], a[40:43], v[52:55], v[168:171]
v_exp_f32 v31, v31
v_mfma_f32_16x16x32_bf16 v[200:203], a[40:43], v[56:59], v[200:203]
v_exp_f32 v32, v32
v_mfma_f32_16x16x32_bf16 v[232:235], a[40:43], v[60:63], v[232:235]
ds_read_b128 a[12:15], v1 offset:11264
v_cvt_pk_bf16_f32 v77, v30, v31
v_mfma_f32_16x16x32_bf16 v[236:239], a[44:47], v[60:63], v[236:239]
v_mfma_f32_16x16x32_bf16 v[204:207], a[44:47], v[56:59], v[204:207]
v_exp_f32 v33, v33
v_mfma_f32_16x16x32_bf16 v[172:175], a[44:47], v[52:55], v[172:175]
v_exp_f32 v34, v34
v_mfma_f32_16x16x32_bf16 v[140:143], a[44:47], v[48:51], v[140:143]
ds_read_b128 a[16:19], v1 offset:12288
v_cvt_pk_bf16_f32 v66, v32, v33
v_mfma_f32_16x16x32_bf16 v[144:147], a[48:51], v[48:51], v[144:147]
v_mfma_f32_16x16x32_bf16 v[176:179], a[48:51], v[52:55], v[176:179]
v_exp_f32 v35, v35
v_mfma_f32_16x16x32_bf16 v[208:211], a[48:51], v[56:59], v[208:211]
v_exp_f32 v36, v36
v_mfma_f32_16x16x32_bf16 v[240:243], a[48:51], v[60:63], v[240:243]
ds_read_b128 a[20:23], v1 offset:13312
v_cvt_pk_bf16_f32 v67, v34, v35
v_mfma_f32_16x16x32_bf16 v[244:247], a[52:55], v[60:63], v[244:247]
v_exp_f32 v37, v37
v_mfma_f32_16x16x32_bf16 v[212:215], a[52:55], v[56:59], v[212:215]
v_cvt_pk_bf16_f32 v70, v36, v37
v_mfma_f32_16x16x32_bf16 v[180:183], a[52:55], v[52:55], v[180:183]
ds_read_b128 a[24:27], v1 offset:14336
v_mfma_f32_16x16x32_bf16 v[148:151], a[52:55], v[48:51], v[148:151]
buffer_load_dwordx4 v3, s[48:51], s32 offen offset:1024 sc1 lds
v_mfma_f32_16x16x32_bf16 v[152:155], a[56:59], v[48:51], v[152:155]
v_exp_f32 v38, v38
v_mfma_f32_16x16x32_bf16 v[184:187], a[56:59], v[52:55], v[184:187]
v_exp_f32 v39, v39
v_mfma_f32_16x16x32_bf16 v[216:219], a[56:59], v[56:59], v[216:219]
ds_read_b128 a[28:31], v1 offset:15360
v_cvt_pk_bf16_f32 v71, v38, v39
v_mfma_f32_16x16x32_bf16 v[248:251], a[56:59], v[60:63], v[248:251]
v_mfma_f32_16x16x32_bf16 v[252:255], a[60:63], v[60:63], v[252:255]
v_exp_f32 v40, v40
v_mfma_f32_16x16x32_bf16 v[220:223], a[60:63], v[56:59], v[220:223]
v_exp_f32 v41, v41
v_mfma_f32_16x16x32_bf16 v[188:191], a[60:63], v[52:55], v[188:191]
ds_read_b128 a[32:35], v1 offset:0
v_cvt_pk_bf16_f32 v74, v40, v41
v_mfma_f32_16x16x32_bf16 v[156:159], a[60:63], v[48:51], v[156:159]
v_smfmac_f32_16x16x64_bf16 a[224:227], a[232:235], v[48:55], v9
v_exp_f32 v42, v42
v_smfmac_f32_16x16x64_bf16 a[228:231], a[232:235], v[56:63], v9
s_waitcnt lgkmcnt(5)
v_exp_f32 v43, v43
v_mfma_f32_16x16x32_bf16 v[16:19], a[0:3], a[160:163], v[80:83]
ds_read_b128 a[36:39], v1 offset:1024
v_cvt_pk_bf16_f32 v75, v42, v43
v_mfma_f32_16x16x32_bf16 v[16:19], a[4:7], a[164:167], v[16:19]
v_exp_f32 v44, v44
v_mfma_f32_16x16x32_bf16 v[16:19], a[8:11], a[168:171], v[16:19]
v_mfma_f32_16x16x32_bf16 v[16:19], a[12:15], a[172:175], v[16:19]
v_exp_f32 v45, v45
v_mfma_f32_16x16x32_bf16 v[20:23], a[0:3], a[176:179], v[84:87]
ds_read_b128 a[40:43], v1 offset:2048
v_cvt_pk_bf16_f32 v78, v44, v45
v_mfma_f32_16x16x32_bf16 v[20:23], a[4:7], a[180:183], v[20:23]
buffer_load_dwordx4 v3, s[48:51], s32 offen offset:2048 sc1 lds
v_mfma_f32_16x16x32_bf16 v[20:23], a[8:11], a[184:187], v[20:23]
v_exp_f32 v46, v46
v_mfma_f32_16x16x32_bf16 v[20:23], a[12:15], a[188:191], v[20:23]
ds_read_b128 a[44:47], v1 offset:3072
v_mfma_f32_16x16x32_bf16 v[24:27], a[0:3], a[192:195], v[88:91]
v_mfma_f32_16x16x32_bf16 v[24:27], a[4:7], a[196:199], v[24:27]
v_exp_f32 v47, v47
v_mfma_f32_16x16x32_bf16 v[24:27], a[8:11], a[200:203], v[24:27]
v_exp_f32 v16, v16
v_mfma_f32_16x16x32_bf16 v[24:27], a[12:15], a[204:207], v[24:27]
ds_read_b128 a[48:51], v1 offset:4096
v_cvt_pk_bf16_f32 v79, v46, v47
v_mfma_f32_16x16x32_bf16 v[28:31], a[0:3], a[208:211], v[92:95]
v_mfma_f32_16x16x32_bf16 v[28:31], a[4:7], a[212:215], v[28:31]
v_exp_f32 v17, v17
v_mfma_f32_16x16x32_bf16 v[28:31], a[8:11], a[216:219], v[28:31]
s_waitcnt lgkmcnt(5)
v_exp_f32 v18, v18
v_mfma_f32_16x16x32_bf16 v[28:31], a[12:15], a[220:223], v[28:31]
ds_read_b128 a[52:55], v1 offset:5120
v_cvt_pk_bf16_f32 v48, v16, v17
v_mfma_f32_16x16x32_bf16 v[32:35], a[16:19], a[160:163], v[80:83]
v_mfma_f32_16x16x32_bf16 v[32:35], a[20:23], a[164:167], v[32:35]
v_exp_f32 v19, v19
v_mfma_f32_16x16x32_bf16 v[32:35], a[24:27], a[168:171], v[32:35]
v_exp_f32 v20, v20
v_mfma_f32_16x16x32_bf16 v[32:35], a[28:31], a[172:175], v[32:35]
ds_read_b128 a[56:59], v1 offset:6144
v_cvt_pk_bf16_f32 v49, v18, v19
v_mfma_f32_16x16x32_bf16 v[36:39], a[16:19], a[176:179], v[84:87]
v_exp_f32 v21, v21
v_mfma_f32_16x16x32_bf16 v[36:39], a[20:23], a[180:183], v[36:39]
buffer_load_dwordx4 v3, s[48:51], s32 offen offset:3072 sc1 lds
v_mfma_f32_16x16x32_bf16 v[36:39], a[24:27], a[184:187], v[36:39]
s_add_u32 s32, s32, 0x8000
v_cvt_pk_bf16_f32 v52, v20, v21
v_mfma_f32_16x16x32_bf16 v[36:39], a[28:31], a[188:191], v[36:39]
ds_read_b128 a[60:63], v1 offset:7168
v_mfma_f32_16x16x32_bf16 v[40:43], a[16:19], a[192:195], v[88:91]
v_exp_f32 v22, v22
v_mfma_f32_16x16x32_bf16 v[40:43], a[20:23], a[196:199], v[40:43]
v_exp_f32 v23, v23
v_mfma_f32_16x16x32_bf16 v[40:43], a[24:27], a[200:203], v[40:43]
v_cvt_pk_bf16_f32 v53, v22, v23
v_mfma_f32_16x16x32_bf16 v[40:43], a[28:31], a[204:207], v[40:43]
v_exp_f32 v24, v24
v_mfma_f32_16x16x32_bf16 v[44:47], a[16:19], a[208:211], v[92:95]
v_exp_f32 v25, v25
v_mfma_f32_16x16x32_bf16 v[44:47], a[20:23], a[212:215], v[44:47]
v_exp_f32 v26, v26
v_mfma_f32_16x16x32_bf16 v[44:47], a[24:27], a[216:219], v[44:47]
v_exp_f32 v27, v27
v_mfma_f32_16x16x32_bf16 v[44:47], a[28:31], a[220:223], v[44:47]
s_waitcnt lgkmcnt(0)
v_mfma_f32_16x16x32_bf16 v[128:131], a[32:35], v[64:67], v[128:131]
ds_read_b128 a[0:3], v1 offset:24576
v_cvt_pk_bf16_f32 v56, v24, v25
v_mfma_f32_16x16x32_bf16 v[160:163], a[32:35], v[68:71], v[160:163]
v_exp_f32 v28, v28
v_mfma_f32_16x16x32_bf16 v[192:195], a[32:35], v[72:75], v[192:195]
v_cvt_pk_bf16_f32 v57, v26, v27
v_mfma_f32_16x16x32_bf16 v[224:227], a[32:35], v[76:79], v[224:227]
ds_read_b128 a[4:7], v1 offset:25600
v_mfma_f32_16x16x32_bf16 v[228:231], a[36:39], v[76:79], v[228:231]
v_exp_f32 v29, v29
v_mfma_f32_16x16x32_bf16 v[196:199], a[36:39], v[72:75], v[196:199]
v_exp_f32 v30, v30
v_mfma_f32_16x16x32_bf16 v[164:167], a[36:39], v[68:71], v[164:167]
s_add_u32 m0, s27, 0x1000
v_cvt_pk_bf16_f32 v60, v28, v29
v_mfma_f32_16x16x32_bf16 v[132:135], a[36:39], v[64:67], v[132:135]
buffer_load_dwordx4 v3, s[48:51], s7 offen offset:0 sc1 lds
v_mfma_f32_16x16x32_bf16 v[136:139], a[40:43], v[64:67], v[136:139]
ds_read_b128 a[8:11], v1 offset:26624
v_mfma_f32_16x16x32_bf16 v[168:171], a[40:43], v[68:71], v[168:171]
v_exp_f32 v31, v31
v_mfma_f32_16x16x32_bf16 v[200:203], a[40:43], v[72:75], v[200:203]
v_exp_f32 v32, v32
v_mfma_f32_16x16x32_bf16 v[232:235], a[40:43], v[76:79], v[232:235]
ds_read_b128 a[12:15], v1 offset:27648
v_cvt_pk_bf16_f32 v61, v30, v31
v_mfma_f32_16x16x32_bf16 v[236:239], a[44:47], v[76:79], v[236:239]
v_mfma_f32_16x16x32_bf16 v[204:207], a[44:47], v[72:75], v[204:207]
v_exp_f32 v33, v33
v_mfma_f32_16x16x32_bf16 v[172:175], a[44:47], v[68:71], v[172:175]
v_exp_f32 v34, v34
v_mfma_f32_16x16x32_bf16 v[140:143], a[44:47], v[64:67], v[140:143]
ds_read_b128 a[16:19], v1 offset:28672
v_cvt_pk_bf16_f32 v50, v32, v33
v_mfma_f32_16x16x32_bf16 v[144:147], a[48:51], v[64:67], v[144:147]
v_mfma_f32_16x16x32_bf16 v[176:179], a[48:51], v[68:71], v[176:179]
v_exp_f32 v35, v35
v_mfma_f32_16x16x32_bf16 v[208:211], a[48:51], v[72:75], v[208:211]
ds_read_b128 a[20:23], v1 offset:29696
v_cvt_pk_bf16_f32 v51, v34, v35
v_mfma_f32_16x16x32_bf16 v[240:243], a[48:51], v[76:79], v[240:243]
v_exp_f32 v36, v36
v_mfma_f32_16x16x32_bf16 v[244:247], a[52:55], v[76:79], v[244:247]
v_exp_f32 v37, v37
v_mfma_f32_16x16x32_bf16 v[212:215], a[52:55], v[72:75], v[212:215]
v_cvt_pk_bf16_f32 v54, v36, v37
v_mfma_f32_16x16x32_bf16 v[180:183], a[52:55], v[68:71], v[180:183]
buffer_load_dwordx4 v3, s[48:51], s7 offen offset:1024 sc1 lds
v_mfma_f32_16x16x32_bf16 v[148:151], a[52:55], v[64:67], v[148:151]
ds_read_b128 a[24:27], v1 offset:30720
v_mfma_f32_16x16x32_bf16 v[152:155], a[56:59], v[64:67], v[152:155]
v_exp_f32 v38, v38
v_mfma_f32_16x16x32_bf16 v[184:187], a[56:59], v[68:71], v[184:187]
v_exp_f32 v39, v39
v_mfma_f32_16x16x32_bf16 v[216:219], a[56:59], v[72:75], v[216:219]
ds_read_b128 a[28:31], v1 offset:31744
v_cvt_pk_bf16_f32 v55, v38, v39
v_mfma_f32_16x16x32_bf16 v[248:251], a[56:59], v[76:79], v[248:251]
v_mfma_f32_16x16x32_bf16 v[252:255], a[60:63], v[76:79], v[252:255]
v_exp_f32 v40, v40
v_mfma_f32_16x16x32_bf16 v[220:223], a[60:63], v[72:75], v[220:223]
v_exp_f32 v41, v41
v_mfma_f32_16x16x32_bf16 v[188:191], a[60:63], v[68:71], v[188:191]
ds_read_b128 a[32:35], v1 offset:16384
v_cvt_pk_bf16_f32 v58, v40, v41
v_mfma_f32_16x16x32_bf16 v[156:159], a[60:63], v[64:67], v[156:159]
v_smfmac_f32_16x16x64_bf16 a[224:227], a[232:235], v[64:71], v9
s_waitcnt lgkmcnt(5)
v_exp_f32 v42, v42
v_smfmac_f32_16x16x64_bf16 a[228:231], a[232:235], v[72:79], v9
ds_read_b128 a[36:39], v1 offset:17408
v_mfma_f32_16x16x32_bf16 v[16:19], a[0:3], a[160:163], v[80:83]
v_exp_f32 v43, v43
v_mfma_f32_16x16x32_bf16 v[16:19], a[4:7], a[164:167], v[16:19]
v_exp_f32 v44, v44
v_mfma_f32_16x16x32_bf16 v[16:19], a[8:11], a[168:171], v[16:19]
v_cvt_pk_bf16_f32 v59, v42, v43
v_mfma_f32_16x16x32_bf16 v[16:19], a[12:15], a[172:175], v[16:19]
ds_read_b128 a[40:43], v1 offset:18432
v_mfma_f32_16x16x32_bf16 v[20:23], a[0:3], a[176:179], v[84:87]
buffer_load_dwordx4 v3, s[48:51], s7 offen offset:2048 sc1 lds
v_mfma_f32_16x16x32_bf16 v[20:23], a[4:7], a[180:183], v[20:23]
v_exp_f32 v45, v45
v_mfma_f32_16x16x32_bf16 v[20:23], a[8:11], a[184:187], v[20:23]
v_exp_f32 v46, v46
v_mfma_f32_16x16x32_bf16 v[20:23], a[12:15], a[188:191], v[20:23]
ds_read_b128 a[44:47], v1 offset:19456
v_cvt_pk_bf16_f32 v62, v44, v45
v_mfma_f32_16x16x32_bf16 v[24:27], a[0:3], a[192:195], v[88:91]
v_mfma_f32_16x16x32_bf16 v[24:27], a[4:7], a[196:199], v[24:27]
v_exp_f32 v47, v47
v_mfma_f32_16x16x32_bf16 v[24:27], a[8:11], a[200:203], v[24:27]
v_exp_f32 v16, v16
v_mfma_f32_16x16x32_bf16 v[24:27], a[12:15], a[204:207], v[24:27]
ds_read_b128 a[48:51], v1 offset:20480
v_cvt_pk_bf16_f32 v63, v46, v47
v_mfma_f32_16x16x32_bf16 v[28:31], a[0:3], a[208:211], v[92:95]
v_mfma_f32_16x16x32_bf16 v[28:31], a[4:7], a[212:215], v[28:31]
v_exp_f32 v17, v17
v_mfma_f32_16x16x32_bf16 v[28:31], a[8:11], a[216:219], v[28:31]
ds_read_b128 a[52:55], v1 offset:21504
v_cvt_pk_bf16_f32 v64, v16, v17
v_mfma_f32_16x16x32_bf16 v[28:31], a[12:15], a[220:223], v[28:31]
s_waitcnt lgkmcnt(6)
v_exp_f32 v18, v18
v_mfma_f32_16x16x32_bf16 v[32:35], a[16:19], a[160:163], v[80:83]
v_mfma_f32_16x16x32_bf16 v[32:35], a[20:23], a[164:167], v[32:35]
v_exp_f32 v19, v19
v_mfma_f32_16x16x32_bf16 v[32:35], a[24:27], a[168:171], v[32:35]
ds_read_b128 a[56:59], v1 offset:22528
v_cvt_pk_bf16_f32 v65, v18, v19
v_mfma_f32_16x16x32_bf16 v[32:35], a[28:31], a[172:175], v[32:35]
buffer_load_dwordx4 v3, s[48:51], s7 offen offset:3072 sc1 lds
v_mfma_f32_16x16x32_bf16 v[36:39], a[16:19], a[176:179], v[84:87]
s_add_u32 s7, s7, 0x8000
v_exp_f32 v20, v20
v_mfma_f32_16x16x32_bf16 v[36:39], a[20:23], a[180:183], v[36:39]
s_xor_b32 s27, s27, 0x38000
v_exp_f32 v21, v21
v_mfma_f32_16x16x32_bf16 v[36:39], a[24:27], a[184:187], v[36:39]
ds_read_b128 a[60:63], v1 offset:23552
v_xor_b32 v1, 0x8000, v1
v_mfma_f32_16x16x32_bf16 v[36:39], a[28:31], a[188:191], v[36:39]
v_cvt_pk_bf16_f32 v68, v20, v21
v_mfma_f32_16x16x32_bf16 v[40:43], a[16:19], a[192:195], v[88:91]
v_exp_f32 v22, v22
v_mfma_f32_16x16x32_bf16 v[40:43], a[20:23], a[196:199], v[40:43]
v_exp_f32 v23, v23
v_mfma_f32_16x16x32_bf16 v[40:43], a[24:27], a[200:203], v[40:43]
v_cvt_pk_bf16_f32 v69, v22, v23
v_mfma_f32_16x16x32_bf16 v[40:43], a[28:31], a[204:207], v[40:43]
v_exp_f32 v24, v24
v_mfma_f32_16x16x32_bf16 v[44:47], a[16:19], a[208:211], v[92:95]
v_exp_f32 v25, v25
v_mfma_f32_16x16x32_bf16 v[44:47], a[20:23], a[212:215], v[44:47]
v_exp_f32 v26, v26
v_mfma_f32_16x16x32_bf16 v[44:47], a[24:27], a[216:219], v[44:47]
s_waitcnt vmcnt(16) lgkmcnt(0)
v_exp_f32 v27, v27
v_mfma_f32_16x16x32_bf16 v[44:47], a[28:31], a[220:223], v[44:47]
s_barrier
L_att_dodd0:
v_mfma_f32_16x16x32_bf16 v[128:131], a[32:35], v[48:51], v[128:131]
ds_read_b128 a[0:3], v2 offset:8192
v_cvt_pk_bf16_f32 v72, v24, v25
v_mfma_f32_16x16x32_bf16 v[160:163], a[32:35], v[52:55], v[160:163]
v_exp_f32 v28, v28
v_mfma_f32_16x16x32_bf16 v[192:195], a[32:35], v[56:59], v[192:195]
v_cvt_pk_bf16_f32 v73, v26, v27
v_mfma_f32_16x16x32_bf16 v[224:227], a[32:35], v[60:63], v[224:227]
ds_read_b128 a[4:7], v2 offset:9216
v_mfma_f32_16x16x32_bf16 v[228:231], a[36:39], v[60:63], v[228:231]
v_exp_f32 v29, v29
v_mfma_f32_16x16x32_bf16 v[196:199], a[36:39], v[56:59], v[196:199]
v_exp_f32 v30, v30
v_mfma_f32_16x16x32_bf16 v[164:167], a[36:39], v[52:55], v[164:167]
s_add_u32 m0, s19, 0x0
v_cvt_pk_bf16_f32 v76, v28, v29
v_mfma_f32_16x16x32_bf16 v[132:135], a[36:39], v[48:51], v[132:135]
buffer_load_dwordx4 v3, s[48:51], s32 offen offset:0 sc1 lds
v_mfma_f32_16x16x32_bf16 v[136:139], a[40:43], v[48:51], v[136:139]
ds_read_b128 a[8:11], v2 offset:10240
v_mfma_f32_16x16x32_bf16 v[168:171], a[40:43], v[52:55], v[168:171]
v_exp_f32 v31, v31
v_mfma_f32_16x16x32_bf16 v[200:203], a[40:43], v[56:59], v[200:203]
v_exp_f32 v32, v32
v_mfma_f32_16x16x32_bf16 v[232:235], a[40:43], v[60:63], v[232:235]
ds_read_b128 a[12:15], v2 offset:11264
v_cvt_pk_bf16_f32 v77, v30, v31
v_mfma_f32_16x16x32_bf16 v[236:239], a[44:47], v[60:63], v[236:239]
v_mfma_f32_16x16x32_bf16 v[204:207], a[44:47], v[56:59], v[204:207]
v_exp_f32 v33, v33
v_mfma_f32_16x16x32_bf16 v[172:175], a[44:47], v[52:55], v[172:175]
v_exp_f32 v34, v34
v_mfma_f32_16x16x32_bf16 v[140:143], a[44:47], v[48:51], v[140:143]
ds_read_b128 a[16:19], v2 offset:12288
v_cvt_pk_bf16_f32 v66, v32, v33
v_mfma_f32_16x16x32_bf16 v[144:147], a[48:51], v[48:51], v[144:147]
v_mfma_f32_16x16x32_bf16 v[176:179], a[48:51], v[52:55], v[176:179]
v_exp_f32 v35, v35
v_mfma_f32_16x16x32_bf16 v[208:211], a[48:51], v[56:59], v[208:211]
v_exp_f32 v36, v36
v_mfma_f32_16x16x32_bf16 v[240:243], a[48:51], v[60:63], v[240:243]
ds_read_b128 a[20:23], v2 offset:13312
v_cvt_pk_bf16_f32 v67, v34, v35
v_mfma_f32_16x16x32_bf16 v[244:247], a[52:55], v[60:63], v[244:247]
v_exp_f32 v37, v37
v_mfma_f32_16x16x32_bf16 v[212:215], a[52:55], v[56:59], v[212:215]
v_cvt_pk_bf16_f32 v70, v36, v37
v_mfma_f32_16x16x32_bf16 v[180:183], a[52:55], v[52:55], v[180:183]
ds_read_b128 a[24:27], v2 offset:14336
v_mfma_f32_16x16x32_bf16 v[148:151], a[52:55], v[48:51], v[148:151]
buffer_load_dwordx4 v3, s[48:51], s32 offen offset:1024 sc1 lds
v_mfma_f32_16x16x32_bf16 v[152:155], a[56:59], v[48:51], v[152:155]
v_exp_f32 v38, v38
v_mfma_f32_16x16x32_bf16 v[184:187], a[56:59], v[52:55], v[184:187]
v_exp_f32 v39, v39
v_mfma_f32_16x16x32_bf16 v[216:219], a[56:59], v[56:59], v[216:219]
ds_read_b128 a[28:31], v2 offset:15360
v_cvt_pk_bf16_f32 v71, v38, v39
v_mfma_f32_16x16x32_bf16 v[248:251], a[56:59], v[60:63], v[248:251]
v_mfma_f32_16x16x32_bf16 v[252:255], a[60:63], v[60:63], v[252:255]
v_exp_f32 v40, v40
v_mfma_f32_16x16x32_bf16 v[220:223], a[60:63], v[56:59], v[220:223]
v_exp_f32 v41, v41
v_mfma_f32_16x16x32_bf16 v[188:191], a[60:63], v[52:55], v[188:191]
ds_read_b128 a[32:35], v2 offset:0
v_cvt_pk_bf16_f32 v74, v40, v41
v_mfma_f32_16x16x32_bf16 v[156:159], a[60:63], v[48:51], v[156:159]
v_smfmac_f32_16x16x64_bf16 a[224:227], a[232:235], v[48:55], v9
v_exp_f32 v42, v42
v_smfmac_f32_16x16x64_bf16 a[228:231], a[232:235], v[56:63], v9
s_waitcnt lgkmcnt(5)
v_exp_f32 v43, v43
v_mfma_f32_16x16x32_bf16 v[16:19], a[0:3], a[160:163], v[80:83]
ds_read_b128 a[36:39], v2 offset:1024
v_cvt_pk_bf16_f32 v75, v42, v43
v_mfma_f32_16x16x32_bf16 v[16:19], a[4:7], a[164:167], v[16:19]
v_exp_f32 v44, v44
v_mfma_f32_16x16x32_bf16 v[16:19], a[8:11], a[168:171], v[16:19]
v_mfma_f32_16x16x32_bf16 v[16:19], a[12:15], a[172:175], v[16:19]
v_exp_f32 v45, v45
v_mfma_f32_16x16x32_bf16 v[20:23], a[0:3], a[176:179], v[84:87]
ds_read_b128 a[40:43], v2 offset:2048
v_cvt_pk_bf16_f32 v78, v44, v45
v_mfma_f32_16x16x32_bf16 v[20:23], a[4:7], a[180:183], v[20:23]
buffer_load_dwordx4 v3, s[48:51], s32 offen offset:2048 sc1 lds
v_mfma_f32_16x16x32_bf16 v[20:23], a[8:11], a[184:187], v[20:23]
v_exp_f32 v46, v46
v_mfma_f32_16x16x32_bf16 v[20:23], a[12:15], a[188:191], v[20:23]
ds_read_b128 a[44:47], v2 offset:3072
v_mfma_f32_16x16x32_bf16 v[24:27], a[0:3], a[192:195], v[88:91]
v_mfma_f32_16x16x32_bf16 v[24:27], a[4:7], a[196:199], v[24:27]
v_exp_f32 v47, v47
v_mfma_f32_16x16x32_bf16 v[24:27], a[8:11], a[200:203], v[24:27]
v_exp_f32 v16, v16
v_mfma_f32_16x16x32_bf16 v[24:27], a[12:15], a[204:207], v[24:27]
ds_read_b128 a[48:51], v2 offset:4096
v_cvt_pk_bf16_f32 v79, v46, v47
v_mfma_f32_16x16x32_bf16 v[28:31], a[0:3], a[208:211], v[92:95]
v_mfma_f32_16x16x32_bf16 v[28:31], a[4:7], a[212:215], v[28:31]
v_exp_f32 v17, v17
v_mfma_f32_16x16x32_bf16 v[28:31], a[8:11], a[216:219], v[28:31]
s_waitcnt lgkmcnt(5)
v_exp_f32 v18, v18
v_mfma_f32_16x16x32_bf16 v[28:31], a[12:15], a[220:223], v[28:31]
ds_read_b128 a[52:55], v2 offset:5120
v_cvt_pk_bf16_f32 v48, v16, v17
v_mfma_f32_16x16x32_bf16 v[32:35], a[16:19], a[160:163], v[80:83]
v_mfma_f32_16x16x32_bf16 v[32:35], a[20:23], a[164:167], v[32:35]
v_exp_f32 v19, v19
v_mfma_f32_16x16x32_bf16 v[32:35], a[24:27], a[168:171], v[32:35]
v_exp_f32 v20, v20
v_mfma_f32_16x16x32_bf16 v[32:35], a[28:31], a[172:175], v[32:35]
ds_read_b128 a[56:59], v2 offset:6144
v_cvt_pk_bf16_f32 v49, v18, v19
v_mfma_f32_16x16x32_bf16 v[36:39], a[16:19], a[176:179], v[84:87]
v_exp_f32 v21, v21
v_mfma_f32_16x16x32_bf16 v[36:39], a[20:23], a[180:183], v[36:39]
buffer_load_dwordx4 v3, s[48:51], s32 offen offset:3072 sc1 lds
v_mfma_f32_16x16x32_bf16 v[36:39], a[24:27], a[184:187], v[36:39]
s_add_u32 s32, s32, 0x8000
v_cvt_pk_bf16_f32 v52, v20, v21
v_mfma_f32_16x16x32_bf16 v[36:39], a[28:31], a[188:191], v[36:39]
ds_read_b128 a[60:63], v2 offset:7168
v_mfma_f32_16x16x32_bf16 v[40:43], a[16:19], a[192:195], v[88:91]
v_exp_f32 v22, v22
v_mfma_f32_16x16x32_bf16 v[40:43], a[20:23], a[196:199], v[40:43]
v_exp_f32 v23, v23
v_mfma_f32_16x16x32_bf16 v[40:43], a[24:27], a[200:203], v[40:43]
v_cvt_pk_bf16_f32 v53, v22, v23
v_mfma_f32_16x16x32_bf16 v[40:43], a[28:31], a[204:207], v[40:43]
v_exp_f32 v24, v24
v_mfma_f32_16x16x32_bf16 v[44:47], a[16:19], a[208:211], v[92:95]
v_exp_f32 v25, v25
v_mfma_f32_16x16x32_bf16 v[44:47], a[20:23], a[212:215], v[44:47]
v_exp_f32 v26, v26
v_mfma_f32_16x16x32_bf16 v[44:47], a[24:27], a[216:219], v[44:47]
v_exp_f32 v27, v27
v_mfma_f32_16x16x32_bf16 v[44:47], a[28:31], a[220:223], v[44:47]
s_waitcnt lgkmcnt(0)
v_mfma_f32_16x16x32_bf16 v[128:131], a[32:35], v[64:67], v[128:131]
ds_read_b128 a[0:3], v2 offset:24576
v_cvt_pk_bf16_f32 v56, v24, v25
v_mfma_f32_16x16x32_bf16 v[160:163], a[32:35], v[68:71], v[160:163]
v_exp_f32 v28, v28
v_mfma_f32_16x16x32_bf16 v[192:195], a[32:35], v[72:75], v[192:195]
v_cvt_pk_bf16_f32 v57, v26, v27
v_mfma_f32_16x16x32_bf16 v[224:227], a[32:35], v[76:79], v[224:227]
ds_read_b128 a[4:7], v2 offset:25600
v_mfma_f32_16x16x32_bf16 v[228:231], a[36:39], v[76:79], v[228:231]
v_exp_f32 v29, v29
v_mfma_f32_16x16x32_bf16 v[196:199], a[36:39], v[72:75], v[196:199]
v_exp_f32 v30, v30
v_mfma_f32_16x16x32_bf16 v[164:167], a[36:39], v[68:71], v[164:167]
s_add_u32 m0, s19, 0x1000
v_cvt_pk_bf16_f32 v60, v28, v29
v_mfma_f32_16x16x32_bf16 v[132:135], a[36:39], v[64:67], v[132:135]
buffer_load_dwordx4 v3, s[48:51], s7 offen offset:0 sc1 lds
v_mfma_f32_16x16x32_bf16 v[136:139], a[40:43], v[64:67], v[136:139]
ds_read_b128 a[8:11], v2 offset:26624
v_mfma_f32_16x16x32_bf16 v[168:171], a[40:43], v[68:71], v[168:171]
v_exp_f32 v31, v31
v_mfma_f32_16x16x32_bf16 v[200:203], a[40:43], v[72:75], v[200:203]
v_exp_f32 v32, v32
v_mfma_f32_16x16x32_bf16 v[232:235], a[40:43], v[76:79], v[232:235]
ds_read_b128 a[12:15], v2 offset:27648
v_cvt_pk_bf16_f32 v61, v30, v31
v_mfma_f32_16x16x32_bf16 v[236:239], a[44:47], v[76:79], v[236:239]
v_mfma_f32_16x16x32_bf16 v[204:207], a[44:47], v[72:75], v[204:207]
v_exp_f32 v33, v33
v_mfma_f32_16x16x32_bf16 v[172:175], a[44:47], v[68:71], v[172:175]
v_exp_f32 v34, v34
v_mfma_f32_16x16x32_bf16 v[140:143], a[44:47], v[64:67], v[140:143]
ds_read_b128 a[16:19], v2 offset:28672
v_cvt_pk_bf16_f32 v50, v32, v33
v_mfma_f32_16x16x32_bf16 v[144:147], a[48:51], v[64:67], v[144:147]
v_exp_f32 v35, v35
v_mfma_f32_16x16x32_bf16 v[176:179], a[48:51], v[68:71], v[176:179]
v_cvt_pk_bf16_f32 v51, v34, v35
v_mfma_f32_16x16x32_bf16 v[208:211], a[48:51], v[72:75], v[208:211]
ds_read_b128 a[20:23], v2 offset:29696
v_mfma_f32_16x16x32_bf16 v[240:243], a[48:51], v[76:79], v[240:243]
v_exp_f32 v36, v36
v_mfma_f32_16x16x32_bf16 v[244:247], a[52:55], v[76:79], v[244:247]
v_exp_f32 v37, v37
v_mfma_f32_16x16x32_bf16 v[212:215], a[52:55], v[72:75], v[212:215]
v_cvt_pk_bf16_f32 v54, v36, v37
v_mfma_f32_16x16x32_bf16 v[180:183], a[52:55], v[68:71], v[180:183]
buffer_load_dwordx4 v3, s[48:51], s7 offen offset:1024 sc1 lds
v_mfma_f32_16x16x32_bf16 v[148:151], a[52:55], v[64:67], v[148:151]
ds_read_b128 a[24:27], v2 offset:30720
v_mfma_f32_16x16x32_bf16 v[152:155], a[56:59], v[64:67], v[152:155]
v_exp_f32 v38, v38
v_mfma_f32_16x16x32_bf16 v[184:187], a[56:59], v[68:71], v[184:187]
v_exp_f32 v39, v39
v_mfma_f32_16x16x32_bf16 v[216:219], a[56:59], v[72:75], v[216:219]
ds_read_b128 a[28:31], v2 offset:31744
v_cvt_pk_bf16_f32 v55, v38, v39
v_mfma_f32_16x16x32_bf16 v[248:251], a[56:59], v[76:79], v[248:251]
v_exp_f32 v40, v40
v_mfma_f32_16x16x32_bf16 v[252:255], a[60:63], v[76:79], v[252:255]
v_mfma_f32_16x16x32_bf16 v[220:223], a[60:63], v[72:75], v[220:223]
v_exp_f32 v41, v41
v_mfma_f32_16x16x32_bf16 v[188:191], a[60:63], v[68:71], v[188:191]
ds_read_b128 a[32:35], v2 offset:16384
v_cvt_pk_bf16_f32 v58, v40, v41
v_mfma_f32_16x16x32_bf16 v[156:159], a[60:63], v[64:67], v[156:159]
v_exp_f32 v42, v42
v_smfmac_f32_16x16x64_bf16 a[224:227], a[232:235], v[64:71], v9
s_waitcnt lgkmcnt(5)
v_smfmac_f32_16x16x64_bf16 a[228:231], a[232:235], v[72:79], v9
ds_read_b128 a[36:39], v2 offset:17408
v_mfma_f32_16x16x32_bf16 v[16:19], a[0:3], a[160:163], v[80:83]
v_exp_f32 v43, v43
v_mfma_f32_16x16x32_bf16 v[16:19], a[4:7], a[164:167], v[16:19]
v_exp_f32 v44, v44
v_mfma_f32_16x16x32_bf16 v[16:19], a[8:11], a[168:171], v[16:19]
buffer_load_dwordx4 v3, s[48:51], s7 offen offset:2048 sc1 lds
v_mfma_f32_16x16x32_bf16 v[16:19], a[12:15], a[172:175], v[16:19]
ds_read_b128 a[40:43], v2 offset:18432
v_cvt_pk_bf16_f32 v59, v42, v43
v_mfma_f32_16x16x32_bf16 v[20:23], a[0:3], a[176:179], v[84:87]
v_exp_f32 v45, v45
v_mfma_f32_16x16x32_bf16 v[20:23], a[4:7], a[180:183], v[20:23]
v_cvt_pk_bf16_f32 v62, v44, v45
v_mfma_f32_16x16x32_bf16 v[20:23], a[8:11], a[184:187], v[20:23]
v_exp_f32 v46, v46
v_mfma_f32_16x16x32_bf16 v[20:23], a[12:15], a[188:191], v[20:23]
ds_read_b128 a[44:47], v2 offset:19456
v_mfma_f32_16x16x32_bf16 v[24:27], a[0:3], a[192:195], v[88:91]
v_exp_f32 v47, v47
v_mfma_f32_16x16x32_bf16 v[24:27], a[4:7], a[196:199], v[24:27]
v_cvt_pk_bf16_f32 v63, v46, v47
v_mfma_f32_16x16x32_bf16 v[24:27], a[8:11], a[200:203], v[24:27]
v_exp_f32 v16, v16
v_mfma_f32_16x16x32_bf16 v[24:27], a[12:15], a[204:207], v[24:27]
ds_read_b128 a[48:51], v2 offset:20480
v_mfma_f32_16x16x32_bf16 v[28:31], a[0:3], a[208:211], v[92:95]
v_exp_f32 v17, v17
v_mfma_f32_16x16x32_bf16 v[28:31], a[4:7], a[212:215], v[28:31]
v_exp_f32 v18, v18
v_mfma_f32_16x16x32_bf16 v[28:31], a[8:11], a[216:219], v[28:31]
ds_read_b128 a[52:55], v2 offset:21504
v_cvt_pk_bf16_f32 v64, v16, v17
v_mfma_f32_16x16x32_bf16 v[28:31], a[12:15], a[220:223], v[28:31]
s_waitcnt lgkmcnt(6)
v_mfma_f32_16x16x32_bf16 v[32:35], a[16:19], a[160:163], v[80:83]
v_exp_f32 v19, v19
v_mfma_f32_16x16x32_bf16 v[32:35], a[20:23], a[164:167], v[32:35]
buffer_load_dwordx4 v3, s[48:51], s7 offen offset:3072 sc1 lds
v_mfma_f32_16x16x32_bf16 v[32:35], a[24:27], a[168:171], v[32:35]
ds_read_b128 a[56:59], v2 offset:22528
v_cvt_pk_bf16_f32 v65, v18, v19
v_mfma_f32_16x16x32_bf16 v[32:35], a[28:31], a[172:175], v[32:35]
s_add_u32 s7, s7, 0x8000
v_exp_f32 v20, v20
v_mfma_f32_16x16x32_bf16 v[36:39], a[16:19], a[176:179], v[84:87]
s_xor_b32 s19, s19, 0x8000
v_mfma_f32_16x16x32_bf16 v[36:39], a[20:23], a[180:183], v[36:39]
s_sub_u32 s15, s15, 1
v_exp_f32 v21, v21
v_mfma_f32_16x16x32_bf16 v[36:39], a[24:27], a[184:187], v[36:39]
ds_read_b128 a[60:63], v2 offset:23552
v_xor_b32 v2, 0x38000, v2
v_mfma_f32_16x16x32_bf16 v[36:39], a[28:31], a[188:191], v[36:39]
s_cmp_lg_u32 s15, 0
v_exp_f32 v22, v22
v_mfma_f32_16x16x32_bf16 v[40:43], a[16:19], a[192:195], v[88:91]
v_exp_f32 v23, v23
v_mfma_f32_16x16x32_bf16 v[40:43], a[20:23], a[196:199], v[40:43]
v_cvt_pk_bf16_f32 v68, v20, v21
v_cvt_pk_bf16_f32 v69, v22, v23
v_mfma_f32_16x16x32_bf16 v[40:43], a[24:27], a[200:203], v[40:43]
v_exp_f32 v24, v24
v_mfma_f32_16x16x32_bf16 v[40:43], a[28:31], a[204:207], v[40:43]
v_exp_f32 v25, v25
v_mfma_f32_16x16x32_bf16 v[44:47], a[16:19], a[208:211], v[92:95]
v_exp_f32 v26, v26
v_mfma_f32_16x16x32_bf16 v[44:47], a[20:23], a[212:215], v[44:47]
v_exp_f32 v27, v27
v_mfma_f32_16x16x32_bf16 v[44:47], a[24:27], a[216:219], v[44:47]
s_waitcnt vmcnt(16) lgkmcnt(0)
v_mfma_f32_16x16x32_bf16 v[44:47], a[28:31], a[220:223], v[44:47]
s_barrier
s_cbranch_scc1 L_att_deven0
s_branch L_att_ddone
L_att_deven1:
v_mfma_f32_16x16x32_bf16 v[128:131], a[32:35], v[48:51], v[128:131]
ds_read_b128 a[0:3], v1 offset:8192
v_cvt_pk_bf16_f32 v72, v24, v25
v_mfma_f32_16x16x32_bf16 v[160:163], a[32:35], v[52:55], v[160:163]
v_exp_f32 v28, v28
v_mfma_f32_16x16x32_bf16 v[192:195], a[32:35], v[56:59], v[192:195]
v_cvt_pk_bf16_f32 v73, v26, v27
v_mfma_f32_16x16x32_bf16 v[224:227], a[32:35], v[60:63], v[224:227]
ds_read_b128 a[4:7], v1 offset:9216
v_mfma_f32_16x16x32_bf16 v[228:231], a[36:39], v[60:63], v[228:231]
v_exp_f32 v29, v29
v_mfma_f32_16x16x32_bf16 v[196:199], a[36:39], v[56:59], v[196:199]
v_exp_f32 v30, v30
v_mfma_f32_16x16x32_bf16 v[164:167], a[36:39], v[52:55], v[164:167]
s_add_u32 m0, s27, 0x0
v_cvt_pk_bf16_f32 v76, v28, v29
v_mfma_f32_16x16x32_bf16 v[132:135], a[36:39], v[48:51], v[132:135]
buffer_load_dwordx4 v3, s[48:51], s32 offen offset:0 sc1 lds
v_mfma_f32_16x16x32_bf16 v[136:139], a[40:43], v[48:51], v[136:139]
ds_read_b128 a[8:11], v1 offset:10240
v_mfma_f32_16x16x32_bf16 v[168:171], a[40:43], v[52:55], v[168:171]
v_exp_f32 v31, v31
v_mfma_f32_16x16x32_bf16 v[200:203], a[40:43], v[56:59], v[200:203]
v_exp_f32 v32, v32
v_mfma_f32_16x16x32_bf16 v[232:235], a[40:43], v[60:63], v[232:235]
ds_read_b128 a[12:15], v1 offset:11264
v_cvt_pk_bf16_f32 v77, v30, v31
v_mfma_f32_16x16x32_bf16 v[236:239], a[44:47], v[60:63], v[236:239]
v_mfma_f32_16x16x32_bf16 v[204:207], a[44:47], v[56:59], v[204:207]
v_exp_f32 v33, v33
v_mfma_f32_16x16x32_bf16 v[172:175], a[44:47], v[52:55], v[172:175]
v_exp_f32 v34, v34
v_mfma_f32_16x16x32_bf16 v[140:143], a[44:47], v[48:51], v[140:143]
ds_read_b128 a[16:19], v1 offset:12288
v_cvt_pk_bf16_f32 v66, v32, v33
v_mfma_f32_16x16x32_bf16 v[144:147], a[48:51], v[48:51], v[144:147]
v_mfma_f32_16x16x32_bf16 v[176:179], a[48:51], v[52:55], v[176:179]
v_exp_f32 v35, v35
v_mfma_f32_16x16x32_bf16 v[208:211], a[48:51], v[56:59], v[208:211]
v_exp_f32 v36, v36
v_mfma_f32_16x16x32_bf16 v[240:243], a[48:51], v[60:63], v[240:243]
ds_read_b128 a[20:23], v1 offset:13312
v_cvt_pk_bf16_f32 v67, v34, v35
v_mfma_f32_16x16x32_bf16 v[244:247], a[52:55], v[60:63], v[244:247]
v_exp_f32 v37, v37
v_mfma_f32_16x16x32_bf16 v[212:215], a[52:55], v[56:59], v[212:215]
v_cvt_pk_bf16_f32 v70, v36, v37
v_mfma_f32_16x16x32_bf16 v[180:183], a[52:55], v[52:55], v[180:183]
ds_read_b128 a[24:27], v1 offset:14336
v_mfma_f32_16x16x32_bf16 v[148:151], a[52:55], v[48:51], v[148:151]
buffer_load_dwordx4 v3, s[48:51], s32 offen offset:1024 sc1 lds
v_mfma_f32_16x16x32_bf16 v[152:155], a[56:59], v[48:51], v[152:155]
v_exp_f32 v38, v38
v_mfma_f32_16x16x32_bf16 v[184:187], a[56:59], v[52:55], v[184:187]
v_exp_f32 v39, v39
v_mfma_f32_16x16x32_bf16 v[216:219], a[56:59], v[56:59], v[216:219]
ds_read_b128 a[28:31], v1 offset:15360
v_cvt_pk_bf16_f32 v71, v38, v39
v_mfma_f32_16x16x32_bf16 v[248:251], a[56:59], v[60:63], v[248:251]
v_mfma_f32_16x16x32_bf16 v[252:255], a[60:63], v[60:63], v[252:255]
v_exp_f32 v40, v40
v_mfma_f32_16x16x32_bf16 v[220:223], a[60:63], v[56:59], v[220:223]
v_exp_f32 v41, v41
v_mfma_f32_16x16x32_bf16 v[188:191], a[60:63], v[52:55], v[188:191]
ds_read_b128 a[32:35], v1 offset:0
v_cvt_pk_bf16_f32 v74, v40, v41
v_mfma_f32_16x16x32_bf16 v[156:159], a[60:63], v[48:51], v[156:159]
v_smfmac_f32_16x16x64_bf16 a[224:227], a[232:235], v[48:55], v9
v_exp_f32 v42, v42
v_smfmac_f32_16x16x64_bf16 a[228:231], a[232:235], v[56:63], v9
s_waitcnt lgkmcnt(5)
v_exp_f32 v43, v43
v_mfma_f32_16x16x32_bf16 v[16:19], a[0:3], a[160:163], v[80:83]
ds_read_b128 a[36:39], v1 offset:1024
v_cvt_pk_bf16_f32 v75, v42, v43
v_mfma_f32_16x16x32_bf16 v[16:19], a[4:7], a[164:167], v[16:19]
v_exp_f32 v44, v44
v_mfma_f32_16x16x32_bf16 v[16:19], a[8:11], a[168:171], v[16:19]
v_mfma_f32_16x16x32_bf16 v[16:19], a[12:15], a[172:175], v[16:19]
v_exp_f32 v45, v45
v_mfma_f32_16x16x32_bf16 v[20:23], a[0:3], a[176:179], v[84:87]
ds_read_b128 a[40:43], v1 offset:2048
v_cvt_pk_bf16_f32 v78, v44, v45
v_mfma_f32_16x16x32_bf16 v[20:23], a[4:7], a[180:183], v[20:23]
buffer_load_dwordx4 v3, s[48:51], s32 offen offset:2048 sc1 lds
v_mfma_f32_16x16x32_bf16 v[20:23], a[8:11], a[184:187], v[20:23]
v_exp_f32 v46, v46
v_mfma_f32_16x16x32_bf16 v[20:23], a[12:15], a[188:191], v[20:23]
ds_read_b128 a[44:47], v1 offset:3072
v_mfma_f32_16x16x32_bf16 v[24:27], a[0:3], a[192:195], v[88:91]
v_mfma_f32_16x16x32_bf16 v[24:27], a[4:7], a[196:199], v[24:27]
v_exp_f32 v47, v47
v_mfma_f32_16x16x32_bf16 v[24:27], a[8:11], a[200:203], v[24:27]
v_exp_f32 v16, v16
v_mfma_f32_16x16x32_bf16 v[24:27], a[12:15], a[204:207], v[24:27]
ds_read_b128 a[48:51], v1 offset:4096
v_cvt_pk_bf16_f32 v79, v46, v47
v_mfma_f32_16x16x32_bf16 v[28:31], a[0:3], a[208:211], v[92:95]
v_mfma_f32_16x16x32_bf16 v[28:31], a[4:7], a[212:215], v[28:31]
v_exp_f32 v17, v17
v_mfma_f32_16x16x32_bf16 v[28:31], a[8:11], a[216:219], v[28:31]
s_waitcnt lgkmcnt(5)
v_exp_f32 v18, v18
v_mfma_f32_16x16x32_bf16 v[28:31], a[12:15], a[220:223], v[28:31]
ds_read_b128 a[52:55], v1 offset:5120
v_cvt_pk_bf16_f32 v48, v16, v17
v_mfma_f32_16x16x32_bf16 v[32:35], a[16:19], a[160:163], v[80:83]
v_mfma_f32_16x16x32_bf16 v[32:35], a[20:23], a[164:167], v[32:35]
v_exp_f32 v19, v19
v_mfma_f32_16x16x32_bf16 v[32:35], a[24:27], a[168:171], v[32:35]
v_exp_f32 v20, v20
v_mfma_f32_16x16x32_bf16 v[32:35], a[28:31], a[172:175], v[32:35]
ds_read_b128 a[56:59], v1 offset:6144
v_cvt_pk_bf16_f32 v49, v18, v19
v_mfma_f32_16x16x32_bf16 v[36:39], a[16:19], a[176:179], v[84:87]
v_exp_f32 v21, v21
v_mfma_f32_16x16x32_bf16 v[36:39], a[20:23], a[180:183], v[36:39]
buffer_load_dwordx4 v3, s[48:51], s32 offen offset:3072 sc1 lds
v_mfma_f32_16x16x32_bf16 v[36:39], a[24:27], a[184:187], v[36:39]
s_add_u32 s32, s32, 0x8000
v_cvt_pk_bf16_f32 v52, v20, v21
v_mfma_f32_16x16x32_bf16 v[36:39], a[28:31], a[188:191], v[36:39]
ds_read_b128 a[60:63], v1 offset:7168
v_mfma_f32_16x16x32_bf16 v[40:43], a[16:19], a[192:195], v[88:91]
v_exp_f32 v22, v22
v_mfma_f32_16x16x32_bf16 v[40:43], a[20:23], a[196:199], v[40:43]
v_exp_f32 v23, v23
v_mfma_f32_16x16x32_bf16 v[40:43], a[24:27], a[200:203], v[40:43]
v_cvt_pk_bf16_f32 v53, v22, v23
v_mfma_f32_16x16x32_bf16 v[40:43], a[28:31], a[204:207], v[40:43]
v_exp_f32 v24, v24
v_mfma_f32_16x16x32_bf16 v[44:47], a[16:19], a[208:211], v[92:95]
v_exp_f32 v25, v25
v_mfma_f32_16x16x32_bf16 v[44:47], a[20:23], a[212:215], v[44:47]
v_exp_f32 v26, v26
v_mfma_f32_16x16x32_bf16 v[44:47], a[24:27], a[216:219], v[44:47]
v_exp_f32 v27, v27
v_mfma_f32_16x16x32_bf16 v[44:47], a[28:31], a[220:223], v[44:47]
s_waitcnt lgkmcnt(0)
v_mfma_f32_16x16x32_bf16 v[128:131], a[32:35], v[64:67], v[128:131]
ds_read_b128 a[0:3], v1 offset:24576
v_cvt_pk_bf16_f32 v56, v24, v25
v_mfma_f32_16x16x32_bf16 v[160:163], a[32:35], v[68:71], v[160:163]
v_exp_f32 v28, v28
v_mfma_f32_16x16x32_bf16 v[192:195], a[32:35], v[72:75], v[192:195]
v_cvt_pk_bf16_f32 v57, v26, v27
v_mfma_f32_16x16x32_bf16 v[224:227], a[32:35], v[76:79], v[224:227]
ds_read_b128 a[4:7], v1 offset:25600
v_mfma_f32_16x16x32_bf16 v[228:231], a[36:39], v[76:79], v[228:231]
v_exp_f32 v29, v29
v_mfma_f32_16x16x32_bf16 v[196:199], a[36:39], v[72:75], v[196:199]
v_exp_f32 v30, v30
v_mfma_f32_16x16x32_bf16 v[164:167], a[36:39], v[68:71], v[164:167]
s_add_u32 m0, s27, 0x1000
v_cvt_pk_bf16_f32 v60, v28, v29
v_mfma_f32_16x16x32_bf16 v[132:135], a[36:39], v[64:67], v[132:135]
buffer_load_dwordx4 v3, s[48:51], s7 offen offset:0 sc1 lds
v_mfma_f32_16x16x32_bf16 v[136:139], a[40:43], v[64:67], v[136:139]
ds_read_b128 a[8:11], v1 offset:26624
v_mfma_f32_16x16x32_bf16 v[168:171], a[40:43], v[68:71], v[168:171]
v_exp_f32 v31, v31
v_mfma_f32_16x16x32_bf16 v[200:203], a[40:43], v[72:75], v[200:203]
v_exp_f32 v32, v32
v_mfma_f32_16x16x32_bf16 v[232:235], a[40:43], v[76:79], v[232:235]
ds_read_b128 a[12:15], v1 offset:27648
v_cvt_pk_bf16_f32 v61, v30, v31
v_mfma_f32_16x16x32_bf16 v[236:239], a[44:47], v[76:79], v[236:239]
v_mfma_f32_16x16x32_bf16 v[204:207], a[44:47], v[72:75], v[204:207]
v_exp_f32 v33, v33
v_mfma_f32_16x16x32_bf16 v[172:175], a[44:47], v[68:71], v[172:175]
v_exp_f32 v34, v34
v_mfma_f32_16x16x32_bf16 v[140:143], a[44:47], v[64:67], v[140:143]
ds_read_b128 a[16:19], v1 offset:28672
v_cvt_pk_bf16_f32 v50, v32, v33
v_mfma_f32_16x16x32_bf16 v[144:147], a[48:51], v[64:67], v[144:147]
v_mfma_f32_16x16x32_bf16 v[176:179], a[48:51], v[68:71], v[176:179]
v_exp_f32 v35, v35
v_mfma_f32_16x16x32_bf16 v[208:211], a[48:51], v[72:75], v[208:211]
ds_read_b128 a[20:23], v1 offset:29696
v_cvt_pk_bf16_f32 v51, v34, v35
v_mfma_f32_16x16x32_bf16 v[240:243], a[48:51], v[76:79], v[240:243]
v_exp_f32 v36, v36
v_mfma_f32_16x16x32_bf16 v[244:247], a[52:55], v[76:79], v[244:247]
v_exp_f32 v37, v37
v_mfma_f32_16x16x32_bf16 v[212:215], a[52:55], v[72:75], v[212:215]
v_cvt_pk_bf16_f32 v54, v36, v37
v_mfma_f32_16x16x32_bf16 v[180:183], a[52:55], v[68:71], v[180:183]
buffer_load_dwordx4 v3, s[48:51], s7 offen offset:1024 sc1 lds
v_mfma_f32_16x16x32_bf16 v[148:151], a[52:55], v[64:67], v[148:151]
ds_read_b128 a[24:27], v1 offset:30720
v_mfma_f32_16x16x32_bf16 v[152:155], a[56:59], v[64:67], v[152:155]
v_exp_f32 v38, v38
v_mfma_f32_16x16x32_bf16 v[184:187], a[56:59], v[68:71], v[184:187]
v_exp_f32 v39, v39
v_mfma_f32_16x16x32_bf16 v[216:219], a[56:59], v[72:75], v[216:219]
ds_read_b128 a[28:31], v1 offset:31744
v_cvt_pk_bf16_f32 v55, v38, v39
v_mfma_f32_16x16x32_bf16 v[248:251], a[56:59], v[76:79], v[248:251]
v_mfma_f32_16x16x32_bf16 v[252:255], a[60:63], v[76:79], v[252:255]
v_exp_f32 v40, v40
v_mfma_f32_16x16x32_bf16 v[220:223], a[60:63], v[72:75], v[220:223]
v_exp_f32 v41, v41
v_mfma_f32_16x16x32_bf16 v[188:191], a[60:63], v[68:71], v[188:191]
ds_read_b128 a[32:35], v1 offset:16384
v_cvt_pk_bf16_f32 v58, v40, v41
v_mfma_f32_16x16x32_bf16 v[156:159], a[60:63], v[64:67], v[156:159]
v_smfmac_f32_16x16x64_bf16 a[224:227], a[232:235], v[64:71], v9
s_waitcnt lgkmcnt(5)
v_exp_f32 v42, v42
v_smfmac_f32_16x16x64_bf16 a[228:231], a[232:235], v[72:79], v9
ds_read_b128 a[36:39], v1 offset:17408
v_mfma_f32_16x16x32_bf16 v[16:19], a[0:3], a[160:163], v[80:83]
v_exp_f32 v43, v43
v_mfma_f32_16x16x32_bf16 v[16:19], a[4:7], a[164:167], v[16:19]
v_exp_f32 v44, v44
v_mfma_f32_16x16x32_bf16 v[16:19], a[8:11], a[168:171], v[16:19]
v_cvt_pk_bf16_f32 v59, v42, v43
v_mfma_f32_16x16x32_bf16 v[16:19], a[12:15], a[172:175], v[16:19]
ds_read_b128 a[40:43], v1 offset:18432
v_mfma_f32_16x16x32_bf16 v[20:23], a[0:3], a[176:179], v[84:87]
buffer_load_dwordx4 v3, s[48:51], s7 offen offset:2048 sc1 lds
v_mfma_f32_16x16x32_bf16 v[20:23], a[4:7], a[180:183], v[20:23]
v_exp_f32 v45, v45
v_mfma_f32_16x16x32_bf16 v[20:23], a[8:11], a[184:187], v[20:23]
v_exp_f32 v46, v46
v_mfma_f32_16x16x32_bf16 v[20:23], a[12:15], a[188:191], v[20:23]
ds_read_b128 a[44:47], v1 offset:19456
v_cvt_pk_bf16_f32 v62, v44, v45
v_mfma_f32_16x16x32_bf16 v[24:27], a[0:3], a[192:195], v[88:91]
v_mfma_f32_16x16x32_bf16 v[24:27], a[4:7], a[196:199], v[24:27]
v_exp_f32 v47, v47
v_mfma_f32_16x16x32_bf16 v[24:27], a[8:11], a[200:203], v[24:27]
v_exp_f32 v16, v16
v_mfma_f32_16x16x32_bf16 v[24:27], a[12:15], a[204:207], v[24:27]
ds_read_b128 a[48:51], v1 offset:20480
v_cvt_pk_bf16_f32 v63, v46, v47
v_mfma_f32_16x16x32_bf16 v[28:31], a[0:3], a[208:211], v[92:95]
v_mfma_f32_16x16x32_bf16 v[28:31], a[4:7], a[212:215], v[28:31]
v_exp_f32 v17, v17
v_mfma_f32_16x16x32_bf16 v[28:31], a[8:11], a[216:219], v[28:31]
ds_read_b128 a[52:55], v1 offset:21504
v_cvt_pk_bf16_f32 v64, v16, v17
v_mfma_f32_16x16x32_bf16 v[28:31], a[12:15], a[220:223], v[28:31]
s_waitcnt lgkmcnt(6)
v_exp_f32 v18, v18
v_mfma_f32_16x16x32_bf16 v[32:35], a[16:19], a[160:163], v[80:83]
v_mfma_f32_16x16x32_bf16 v[32:35], a[20:23], a[164:167], v[32:35]
v_exp_f32 v19, v19
v_mfma_f32_16x16x32_bf16 v[32:35], a[24:27], a[168:171], v[32:35]
ds_read_b128 a[56:59], v1 offset:22528
v_cvt_pk_bf16_f32 v65, v18, v19
v_mfma_f32_16x16x32_bf16 v[32:35], a[28:31], a[172:175], v[32:35]
buffer_load_dwordx4 v3, s[48:51], s7 offen offset:3072 sc1 lds
v_mfma_f32_16x16x32_bf16 v[36:39], a[16:19], a[176:179], v[84:87]
s_add_u32 s7, s7, 0x8000
v_exp_f32 v20, v20
v_mfma_f32_16x16x32_bf16 v[36:39], a[20:23], a[180:183], v[36:39]
s_xor_b32 s27, s27, 0x38000
v_exp_f32 v21, v21
v_mfma_f32_16x16x32_bf16 v[36:39], a[24:27], a[184:187], v[36:39]
ds_read_b128 a[60:63], v1 offset:23552
v_xor_b32 v1, 0x8000, v1
v_mfma_f32_16x16x32_bf16 v[36:39], a[28:31], a[188:191], v[36:39]
v_cvt_pk_bf16_f32 v68, v20, v21
v_mfma_f32_16x16x32_bf16 v[40:43], a[16:19], a[192:195], v[88:91]
v_exp_f32 v22, v22
v_mfma_f32_16x16x32_bf16 v[40:43], a[20:23], a[196:199], v[40:43]
v_exp_f32 v23, v23
v_mfma_f32_16x16x32_bf16 v[40:43], a[24:27], a[200:203], v[40:43]
v_cvt_pk_bf16_f32 v69, v22, v23
v_mfma_f32_16x16x32_bf16 v[40:43], a[28:31], a[204:207], v[40:43]
v_exp_f32 v24, v24
v_mfma_f32_16x16x32_bf16 v[44:47], a[16:19], a[208:211], v[92:95]
s_waitcnt vmcnt(16) lgkmcnt(0)
v_exp_f32 v25, v25
v_mfma_f32_16x16x32_bf16 v[44:47], a[20:23], a[212:215], v[44:47]
s_barrier
v_exp_f32 v26, v26
v_mfma_f32_16x16x32_bf16 v[44:47], a[24:27], a[216:219], v[44:47]
v_exp_f32 v27, v27
v_mfma_f32_16x16x32_bf16 v[44:47], a[28:31], a[220:223], v[44:47]
L_att_dodd1:
v_mfma_f32_16x16x32_bf16 v[128:131], a[32:35], v[48:51], v[128:131]
ds_read_b128 a[0:3], v2 offset:8192
v_cvt_pk_bf16_f32 v72, v24, v25
v_mfma_f32_16x16x32_bf16 v[160:163], a[32:35], v[52:55], v[160:163]
v_exp_f32 v28, v28
v_mfma_f32_16x16x32_bf16 v[192:195], a[32:35], v[56:59], v[192:195]
v_cvt_pk_bf16_f32 v73, v26, v27
v_mfma_f32_16x16x32_bf16 v[224:227], a[32:35], v[60:63], v[224:227]
ds_read_b128 a[4:7], v2 offset:9216
v_mfma_f32_16x16x32_bf16 v[228:231], a[36:39], v[60:63], v[228:231]
v_exp_f32 v29, v29
v_mfma_f32_16x16x32_bf16 v[196:199], a[36:39], v[56:59], v[196:199]
v_exp_f32 v30, v30
v_mfma_f32_16x16x32_bf16 v[164:167], a[36:39], v[52:55], v[164:167]
s_add_u32 m0, s19, 0x0
v_cvt_pk_bf16_f32 v76, v28, v29
v_mfma_f32_16x16x32_bf16 v[132:135], a[36:39], v[48:51], v[132:135]
buffer_load_dwordx4 v3, s[48:51], s32 offen offset:0 sc1 lds
v_mfma_f32_16x16x32_bf16 v[136:139], a[40:43], v[48:51], v[136:139]
ds_read_b128 a[8:11], v2 offset:10240
v_mfma_f32_16x16x32_bf16 v[168:171], a[40:43], v[52:55], v[168:171]
v_exp_f32 v31, v31
v_mfma_f32_16x16x32_bf16 v[200:203], a[40:43], v[56:59], v[200:203]
v_exp_f32 v32, v32
v_mfma_f32_16x16x32_bf16 v[232:235], a[40:43], v[60:63], v[232:235]
ds_read_b128 a[12:15], v2 offset:11264
v_cvt_pk_bf16_f32 v77, v30, v31
v_mfma_f32_16x16x32_bf16 v[236:239], a[44:47], v[60:63], v[236:239]
v_mfma_f32_16x16x32_bf16 v[204:207], a[44:47], v[56:59], v[204:207]
v_exp_f32 v33, v33
v_mfma_f32_16x16x32_bf16 v[172:175], a[44:47], v[52:55], v[172:175]
v_exp_f32 v34, v34
v_mfma_f32_16x16x32_bf16 v[140:143], a[44:47], v[48:51], v[140:143]
ds_read_b128 a[16:19], v2 offset:12288
v_cvt_pk_bf16_f32 v66, v32, v33
v_mfma_f32_16x16x32_bf16 v[144:147], a[48:51], v[48:51], v[144:147]
v_mfma_f32_16x16x32_bf16 v[176:179], a[48:51], v[52:55], v[176:179]
v_exp_f32 v35, v35
v_mfma_f32_16x16x32_bf16 v[208:211], a[48:51], v[56:59], v[208:211]
v_exp_f32 v36, v36
v_mfma_f32_16x16x32_bf16 v[240:243], a[48:51], v[60:63], v[240:243]
ds_read_b128 a[20:23], v2 offset:13312
v_cvt_pk_bf16_f32 v67, v34, v35
v_mfma_f32_16x16x32_bf16 v[244:247], a[52:55], v[60:63], v[244:247]
v_exp_f32 v37, v37
v_mfma_f32_16x16x32_bf16 v[212:215], a[52:55], v[56:59], v[212:215]
v_cvt_pk_bf16_f32 v70, v36, v37
v_mfma_f32_16x16x32_bf16 v[180:183], a[52:55], v[52:55], v[180:183]
ds_read_b128 a[24:27], v2 offset:14336
v_mfma_f32_16x16x32_bf16 v[148:151], a[52:55], v[48:51], v[148:151]
buffer_load_dwordx4 v3, s[48:51], s32 offen offset:1024 sc1 lds
v_mfma_f32_16x16x32_bf16 v[152:155], a[56:59], v[48:51], v[152:155]
v_exp_f32 v38, v38
v_mfma_f32_16x16x32_bf16 v[184:187], a[56:59], v[52:55], v[184:187]
v_exp_f32 v39, v39
v_mfma_f32_16x16x32_bf16 v[216:219], a[56:59], v[56:59], v[216:219]
ds_read_b128 a[28:31], v2 offset:15360
v_cvt_pk_bf16_f32 v71, v38, v39
v_mfma_f32_16x16x32_bf16 v[248:251], a[56:59], v[60:63], v[248:251]
v_mfma_f32_16x16x32_bf16 v[252:255], a[60:63], v[60:63], v[252:255]
v_exp_f32 v40, v40
v_mfma_f32_16x16x32_bf16 v[220:223], a[60:63], v[56:59], v[220:223]
v_exp_f32 v41, v41
v_mfma_f32_16x16x32_bf16 v[188:191], a[60:63], v[52:55], v[188:191]
ds_read_b128 a[32:35], v2 offset:0
v_cvt_pk_bf16_f32 v74, v40, v41
v_mfma_f32_16x16x32_bf16 v[156:159], a[60:63], v[48:51], v[156:159]
v_smfmac_f32_16x16x64_bf16 a[224:227], a[232:235], v[48:55], v9
v_exp_f32 v42, v42
v_smfmac_f32_16x16x64_bf16 a[228:231], a[232:235], v[56:63], v9
s_waitcnt lgkmcnt(5)
v_exp_f32 v43, v43
v_mfma_f32_16x16x32_bf16 v[16:19], a[0:3], a[160:163], v[80:83]
ds_read_b128 a[36:39], v2 offset:1024
v_cvt_pk_bf16_f32 v75, v42, v43
v_mfma_f32_16x16x32_bf16 v[16:19], a[4:7], a[164:167], v[16:19]
v_exp_f32 v44, v44
v_mfma_f32_16x16x32_bf16 v[16:19], a[8:11], a[168:171], v[16:19]
v_mfma_f32_16x16x32_bf16 v[16:19], a[12:15], a[172:175], v[16:19]
v_exp_f32 v45, v45
v_mfma_f32_16x16x32_bf16 v[20:23], a[0:3], a[176:179], v[84:87]
ds_read_b128 a[40:43], v2 offset:2048
v_cvt_pk_bf16_f32 v78, v44, v45
v_mfma_f32_16x16x32_bf16 v[20:23], a[4:7], a[180:183], v[20:23]
buffer_load_dwordx4 v3, s[48:51], s32 offen offset:2048 sc1 lds
v_mfma_f32_16x16x32_bf16 v[20:23], a[8:11], a[184:187], v[20:23]
v_exp_f32 v46, v46
v_mfma_f32_16x16x32_bf16 v[20:23], a[12:15], a[188:191], v[20:23]
ds_read_b128 a[44:47], v2 offset:3072
v_mfma_f32_16x16x32_bf16 v[24:27], a[0:3], a[192:195], v[88:91]
v_mfma_f32_16x16x32_bf16 v[24:27], a[4:7], a[196:199], v[24:27]
v_exp_f32 v47, v47
v_mfma_f32_16x16x32_bf16 v[24:27], a[8:11], a[200:203], v[24:27]
v_exp_f32 v16, v16
v_mfma_f32_16x16x32_bf16 v[24:27], a[12:15], a[204:207], v[24:27]
ds_read_b128 a[48:51], v2 offset:4096
v_cvt_pk_bf16_f32 v79, v46, v47
v_mfma_f32_16x16x32_bf16 v[28:31], a[0:3], a[208:211], v[92:95]
v_mfma_f32_16x16x32_bf16 v[28:31], a[4:7], a[212:215], v[28:31]
v_exp_f32 v17, v17
v_mfma_f32_16x16x32_bf16 v[28:31], a[8:11], a[216:219], v[28:31]
s_waitcnt lgkmcnt(5)
v_exp_f32 v18, v18
v_mfma_f32_16x16x32_bf16 v[28:31], a[12:15], a[220:223], v[28:31]
ds_read_b128 a[52:55], v2 offset:5120
v_cvt_pk_bf16_f32 v48, v16, v17
v_mfma_f32_16x16x32_bf16 v[32:35], a[16:19], a[160:163], v[80:83]
v_mfma_f32_16x16x32_bf16 v[32:35], a[20:23], a[164:167], v[32:35]
v_exp_f32 v19, v19
v_mfma_f32_16x16x32_bf16 v[32:35], a[24:27], a[168:171], v[32:35]
v_exp_f32 v20, v20
v_mfma_f32_16x16x32_bf16 v[32:35], a[28:31], a[172:175], v[32:35]
ds_read_b128 a[56:59], v2 offset:6144
v_cvt_pk_bf16_f32 v49, v18, v19
v_mfma_f32_16x16x32_bf16 v[36:39], a[16:19], a[176:179], v[84:87]
v_exp_f32 v21, v21
v_mfma_f32_16x16x32_bf16 v[36:39], a[20:23], a[180:183], v[36:39]
buffer_load_dwordx4 v3, s[48:51], s32 offen offset:3072 sc1 lds
v_mfma_f32_16x16x32_bf16 v[36:39], a[24:27], a[184:187], v[36:39]
s_add_u32 s32, s32, 0x8000
v_cvt_pk_bf16_f32 v52, v20, v21
v_mfma_f32_16x16x32_bf16 v[36:39], a[28:31], a[188:191], v[36:39]
ds_read_b128 a[60:63], v2 offset:7168
v_mfma_f32_16x16x32_bf16 v[40:43], a[16:19], a[192:195], v[88:91]
v_exp_f32 v22, v22
v_mfma_f32_16x16x32_bf16 v[40:43], a[20:23], a[196:199], v[40:43]
v_exp_f32 v23, v23
v_mfma_f32_16x16x32_bf16 v[40:43], a[24:27], a[200:203], v[40:43]
v_cvt_pk_bf16_f32 v53, v22, v23
v_mfma_f32_16x16x32_bf16 v[40:43], a[28:31], a[204:207], v[40:43]
v_exp_f32 v24, v24
v_mfma_f32_16x16x32_bf16 v[44:47], a[16:19], a[208:211], v[92:95]
v_exp_f32 v25, v25
v_mfma_f32_16x16x32_bf16 v[44:47], a[20:23], a[212:215], v[44:47]
v_exp_f32 v26, v26
v_mfma_f32_16x16x32_bf16 v[44:47], a[24:27], a[216:219], v[44:47]
v_exp_f32 v27, v27
v_mfma_f32_16x16x32_bf16 v[44:47], a[28:31], a[220:223], v[44:47]
s_waitcnt lgkmcnt(0)
v_mfma_f32_16x16x32_bf16 v[128:131], a[32:35], v[64:67], v[128:131]
ds_read_b128 a[0:3], v2 offset:24576
v_cvt_pk_bf16_f32 v56, v24, v25
v_mfma_f32_16x16x32_bf16 v[160:163], a[32:35], v[68:71], v[160:163]
v_exp_f32 v28, v28
v_mfma_f32_16x16x32_bf16 v[192:195], a[32:35], v[72:75], v[192:195]
v_cvt_pk_bf16_f32 v57, v26, v27
v_mfma_f32_16x16x32_bf16 v[224:227], a[32:35], v[76:79], v[224:227]
ds_read_b128 a[4:7], v2 offset:25600
v_mfma_f32_16x16x32_bf16 v[228:231], a[36:39], v[76:79], v[228:231]
v_exp_f32 v29, v29
v_mfma_f32_16x16x32_bf16 v[196:199], a[36:39], v[72:75], v[196:199]
v_exp_f32 v30, v30
v_mfma_f32_16x16x32_bf16 v[164:167], a[36:39], v[68:71], v[164:167]
s_add_u32 m0, s19, 0x1000
v_cvt_pk_bf16_f32 v60, v28, v29
v_mfma_f32_16x16x32_bf16 v[132:135], a[36:39], v[64:67], v[132:135]
buffer_load_dwordx4 v3, s[48:51], s7 offen offset:0 sc1 lds
v_mfma_f32_16x16x32_bf16 v[136:139], a[40:43], v[64:67], v[136:139]
ds_read_b128 a[8:11], v2 offset:26624
v_mfma_f32_16x16x32_bf16 v[168:171], a[40:43], v[68:71], v[168:171]
v_exp_f32 v31, v31
v_mfma_f32_16x16x32_bf16 v[200:203], a[40:43], v[72:75], v[200:203]
v_exp_f32 v32, v32
v_mfma_f32_16x16x32_bf16 v[232:235], a[40:43], v[76:79], v[232:235]
ds_read_b128 a[12:15], v2 offset:27648
v_cvt_pk_bf16_f32 v61, v30, v31
v_mfma_f32_16x16x32_bf16 v[236:239], a[44:47], v[76:79], v[236:239]
v_mfma_f32_16x16x32_bf16 v[204:207], a[44:47], v[72:75], v[204:207]
v_exp_f32 v33, v33
v_mfma_f32_16x16x32_bf16 v[172:175], a[44:47], v[68:71], v[172:175]
v_exp_f32 v34, v34
v_mfma_f32_16x16x32_bf16 v[140:143], a[44:47], v[64:67], v[140:143]
ds_read_b128 a[16:19], v2 offset:28672
v_cvt_pk_bf16_f32 v50, v32, v33
v_mfma_f32_16x16x32_bf16 v[144:147], a[48:51], v[64:67], v[144:147]
v_exp_f32 v35, v35
v_mfma_f32_16x16x32_bf16 v[176:179], a[48:51], v[68:71], v[176:179]
v_cvt_pk_bf16_f32 v51, v34, v35
v_mfma_f32_16x16x32_bf16 v[208:211], a[48:51], v[72:75], v[208:211]
ds_read_b128 a[20:23], v2 offset:29696
v_mfma_f32_16x16x32_bf16 v[240:243], a[48:51], v[76:79], v[240:243]
v_exp_f32 v36, v36
v_mfma_f32_16x16x32_bf16 v[244:247], a[52:55], v[76:79], v[244:247]
v_exp_f32 v37, v37
v_mfma_f32_16x16x32_bf16 v[212:215], a[52:55], v[72:75], v[212:215]
v_cvt_pk_bf16_f32 v54, v36, v37
v_mfma_f32_16x16x32_bf16 v[180:183], a[52:55], v[68:71], v[180:183]
buffer_load_dwordx4 v3, s[48:51], s7 offen offset:1024 sc1 lds
v_mfma_f32_16x16x32_bf16 v[148:151], a[52:55], v[64:67], v[148:151]
ds_read_b128 a[24:27], v2 offset:30720
v_mfma_f32_16x16x32_bf16 v[152:155], a[56:59], v[64:67], v[152:155]
v_exp_f32 v38, v38
v_mfma_f32_16x16x32_bf16 v[184:187], a[56:59], v[68:71], v[184:187]
v_exp_f32 v39, v39
v_mfma_f32_16x16x32_bf16 v[216:219], a[56:59], v[72:75], v[216:219]
ds_read_b128 a[28:31], v2 offset:31744
v_cvt_pk_bf16_f32 v55, v38, v39
v_mfma_f32_16x16x32_bf16 v[248:251], a[56:59], v[76:79], v[248:251]
v_exp_f32 v40, v40
v_mfma_f32_16x16x32_bf16 v[252:255], a[60:63], v[76:79], v[252:255]
v_mfma_f32_16x16x32_bf16 v[220:223], a[60:63], v[72:75], v[220:223]
v_exp_f32 v41, v41
v_mfma_f32_16x16x32_bf16 v[188:191], a[60:63], v[68:71], v[188:191]
ds_read_b128 a[32:35], v2 offset:16384
v_cvt_pk_bf16_f32 v58, v40, v41
v_mfma_f32_16x16x32_bf16 v[156:159], a[60:63], v[64:67], v[156:159]
v_exp_f32 v42, v42
v_smfmac_f32_16x16x64_bf16 a[224:227], a[232:235], v[64:71], v9
s_waitcnt lgkmcnt(5)
v_smfmac_f32_16x16x64_bf16 a[228:231], a[232:235], v[72:79], v9
ds_read_b128 a[36:39], v2 offset:17408
v_mfma_f32_16x16x32_bf16 v[16:19], a[0:3], a[160:163], v[80:83]
v_exp_f32 v43, v43
v_mfma_f32_16x16x32_bf16 v[16:19], a[4:7], a[164:167], v[16:19]
v_exp_f32 v44, v44
v_mfma_f32_16x16x32_bf16 v[16:19], a[8:11], a[168:171], v[16:19]
buffer_load_dwordx4 v3, s[48:51], s7 offen offset:2048 sc1 lds
v_mfma_f32_16x16x32_bf16 v[16:19], a[12:15], a[172:175], v[16:19]
ds_read_b128 a[40:43], v2 offset:18432
v_cvt_pk_bf16_f32 v59, v42, v43
v_mfma_f32_16x16x32_bf16 v[20:23], a[0:3], a[176:179], v[84:87]
v_exp_f32 v45, v45
v_mfma_f32_16x16x32_bf16 v[20:23], a[4:7], a[180:183], v[20:23]
v_cvt_pk_bf16_f32 v62, v44, v45
v_mfma_f32_16x16x32_bf16 v[20:23], a[8:11], a[184:187], v[20:23]
v_exp_f32 v46, v46
v_mfma_f32_16x16x32_bf16 v[20:23], a[12:15], a[188:191], v[20:23]
ds_read_b128 a[44:47], v2 offset:19456
v_mfma_f32_16x16x32_bf16 v[24:27], a[0:3], a[192:195], v[88:91]
v_exp_f32 v47, v47
v_mfma_f32_16x16x32_bf16 v[24:27], a[4:7], a[196:199], v[24:27]
v_cvt_pk_bf16_f32 v63, v46, v47
v_mfma_f32_16x16x32_bf16 v[24:27], a[8:11], a[200:203], v[24:27]
v_exp_f32 v16, v16
v_mfma_f32_16x16x32_bf16 v[24:27], a[12:15], a[204:207], v[24:27]
ds_read_b128 a[48:51], v2 offset:20480
v_mfma_f32_16x16x32_bf16 v[28:31], a[0:3], a[208:211], v[92:95]
v_exp_f32 v17, v17
v_mfma_f32_16x16x32_bf16 v[28:31], a[4:7], a[212:215], v[28:31]
v_exp_f32 v18, v18
v_mfma_f32_16x16x32_bf16 v[28:31], a[8:11], a[216:219], v[28:31]
ds_read_b128 a[52:55], v2 offset:21504
v_cvt_pk_bf16_f32 v64, v16, v17
v_mfma_f32_16x16x32_bf16 v[28:31], a[12:15], a[220:223], v[28:31]
s_waitcnt lgkmcnt(6)
v_mfma_f32_16x16x32_bf16 v[32:35], a[16:19], a[160:163], v[80:83]
v_exp_f32 v19, v19
v_mfma_f32_16x16x32_bf16 v[32:35], a[20:23], a[164:167], v[32:35]
buffer_load_dwordx4 v3, s[48:51], s7 offen offset:3072 sc1 lds
v_mfma_f32_16x16x32_bf16 v[32:35], a[24:27], a[168:171], v[32:35]
ds_read_b128 a[56:59], v2 offset:22528
v_cvt_pk_bf16_f32 v65, v18, v19
v_mfma_f32_16x16x32_bf16 v[32:35], a[28:31], a[172:175], v[32:35]
s_add_u32 s7, s7, 0x8000
v_exp_f32 v20, v20
v_mfma_f32_16x16x32_bf16 v[36:39], a[16:19], a[176:179], v[84:87]
s_xor_b32 s19, s19, 0x8000
v_mfma_f32_16x16x32_bf16 v[36:39], a[20:23], a[180:183], v[36:39]
s_sub_u32 s15, s15, 1
v_exp_f32 v21, v21
v_mfma_f32_16x16x32_bf16 v[36:39], a[24:27], a[184:187], v[36:39]
ds_read_b128 a[60:63], v2 offset:23552
v_xor_b32 v2, 0x38000, v2
v_mfma_f32_16x16x32_bf16 v[36:39], a[28:31], a[188:191], v[36:39]
s_cmp_lg_u32 s15, 0
v_exp_f32 v22, v22
v_mfma_f32_16x16x32_bf16 v[40:43], a[16:19], a[192:195], v[88:91]
v_exp_f32 v23, v23
v_mfma_f32_16x16x32_bf16 v[40:43], a[20:23], a[196:199], v[40:43]
v_cvt_pk_bf16_f32 v68, v20, v21
v_cvt_pk_bf16_f32 v69, v22, v23
v_mfma_f32_16x16x32_bf16 v[40:43], a[24:27], a[200:203], v[40:43]
v_exp_f32 v24, v24
v_mfma_f32_16x16x32_bf16 v[40:43], a[28:31], a[204:207], v[40:43]
v_exp_f32 v25, v25
v_mfma_f32_16x16x32_bf16 v[44:47], a[16:19], a[208:211], v[92:95]
s_waitcnt vmcnt(16) lgkmcnt(0)
v_exp_f32 v26, v26
v_mfma_f32_16x16x32_bf16 v[44:47], a[20:23], a[212:215], v[44:47]
s_barrier
v_exp_f32 v27, v27
v_mfma_f32_16x16x32_bf16 v[44:47], a[24:27], a[216:219], v[44:47]
v_mfma_f32_16x16x32_bf16 v[44:47], a[28:31], a[220:223], v[44:47]
s_cbranch_scc1 L_att_deven1
L_att_ddone:
s_cmp_ge_u32 s4, 2
s_cbranch_scc1 L_att_dl0_1
L_att_dl0_0:
v_mfma_f32_16x16x32_bf16 v[128:131], a[32:35], v[48:51], v[128:131]
ds_read_b128 a[0:3], v1 offset:8192
v_cvt_pk_bf16_f32 v72, v24, v25
v_mfma_f32_16x16x32_bf16 v[160:163], a[32:35], v[52:55], v[160:163]
v_exp_f32 v28, v28
v_mfma_f32_16x16x32_bf16 v[192:195], a[32:35], v[56:59], v[192:195]
v_cvt_pk_bf16_f32 v73, v26, v27
v_mfma_f32_16x16x32_bf16 v[224:227], a[32:35], v[60:63], v[224:227]
ds_read_b128 a[4:7], v1 offset:9216
v_mfma_f32_16x16x32_bf16 v[228:231], a[36:39], v[60:63], v[228:231]
s_add_u32 m0, s27, 0x0
v_exp_f32 v29, v29
v_mfma_f32_16x16x32_bf16 v[196:199], a[36:39], v[56:59], v[196:199]
buffer_load_dwordx4 v3, s[48:51], s32 offen offset:0 sc1 lds
v_mfma_f32_16x16x32_bf16 v[164:167], a[36:39], v[52:55], v[164:167]
v_exp_f32 v30, v30
v_mfma_f32_16x16x32_bf16 v[132:135], a[36:39], v[48:51], v[132:135]
ds_read_b128 a[8:11], v1 offset:10240
v_cvt_pk_bf16_f32 v76, v28, v29
v_mfma_f32_16x16x32_bf16 v[136:139], a[40:43], v[48:51], v[136:139]
v_mfma_f32_16x16x32_bf16 v[168:171], a[40:43], v[52:55], v[168:171]
v_exp_f32 v31, v31
v_mfma_f32_16x16x32_bf16 v[200:203], a[40:43], v[56:59], v[200:203]
v_exp_f32 v32, v32
v_mfma_f32_16x16x32_bf16 v[232:235], a[40:43], v[60:63], v[232:235]
ds_read_b128 a[12:15], v1 offset:11264
v_cvt_pk_bf16_f32 v77, v30, v31
v_mfma_f32_16x16x32_bf16 v[236:239], a[44:47], v[60:63], v[236:239]
v_exp_f32 v33, v33
v_mfma_f32_16x16x32_bf16 v[204:207], a[44:47], v[56:59], v[204:207]
v_cvt_pk_bf16_f32 v66, v32, v33
v_mfma_f32_16x16x32_bf16 v[172:175], a[44:47], v[52:55], v[172:175]
s_mov_b32 s9, 0x0
v_exp_f32 v34, v34
v_mfma_f32_16x16x32_bf16 v[140:143], a[44:47], v[48:51], v[140:143]
ds_read_b128 a[16:19], v1 offset:12288
v_mfma_f32_16x16x32_bf16 v[144:147], a[48:51], v[48:51], v[144:147]
buffer_load_dword a244, v8, s[72:75], s9 offen
v_mfma_f32_16x16x32_bf16 v[176:179], a[48:51], v[52:55], v[176:179]
v_exp_f32 v35, v35
v_mfma_f32_16x16x32_bf16 v[208:211], a[48:51], v[56:59], v[208:211]
v_exp_f32 v36, v36
v_mfma_f32_16x16x32_bf16 v[240:243], a[48:51], v[60:63], v[240:243]
ds_read_b128 a[20:23], v1 offset:13312
v_cvt_pk_bf16_f32 v67, v34, v35
v_mfma_f32_16x16x32_bf16 v[244:247], a[52:55], v[60:63], v[244:247]
v_mfma_f32_16x16x32_bf16 v[212:215], a[52:55], v[56:59], v[212:215]
v_exp_f32 v37, v37
v_mfma_f32_16x16x32_bf16 v[180:183], a[52:55], v[52:55], v[180:183]
ds_read_b128 a[24:27], v1 offset:14336
v_cvt_pk_bf16_f32 v70, v36, v37
v_mfma_f32_16x16x32_bf16 v[148:151], a[52:55], v[48:51], v[148:151]
v_exp_f32 v38, v38
v_mfma_f32_16x16x32_bf16 v[152:155], a[56:59], v[48:51], v[152:155]
v_mfma_f32_16x16x32_bf16 v[184:187], a[56:59], v[52:55], v[184:187]
v_exp_f32 v39, v39
v_mfma_f32_16x16x32_bf16 v[216:219], a[56:59], v[56:59], v[216:219]
buffer_load_dwordx4 v3, s[48:51], s32 offen offset:1024 sc1 lds
v_mfma_f32_16x16x32_bf16 v[248:251], a[56:59], v[60:63], v[248:251]
ds_read_b128 a[28:31], v1 offset:15360
v_cvt_pk_bf16_f32 v71, v38, v39
v_mfma_f32_16x16x32_bf16 v[252:255], a[60:63], v[60:63], v[252:255]
v_exp_f32 v40, v40
v_mfma_f32_16x16x32_bf16 v[220:223], a[60:63], v[56:59], v[220:223]
v_exp_f32 v41, v41
v_mfma_f32_16x16x32_bf16 v[188:191], a[60:63], v[52:55], v[188:191]
ds_read_b128 a[32:35], v1 offset:0
v_cvt_pk_bf16_f32 v74, v40, v41
v_mfma_f32_16x16x32_bf16 v[156:159], a[60:63], v[48:51], v[156:159]
v_smfmac_f32_16x16x64_bf16 a[224:227], a[232:235], v[48:55], v9
v_exp_f32 v42, v42
v_smfmac_f32_16x16x64_bf16 a[228:231], a[232:235], v[56:63], v9
s_waitcnt lgkmcnt(5)
v_exp_f32 v43, v43
v_mfma_f32_16x16x32_bf16 v[16:19], a[0:3], a[160:163], v[96:99]
ds_read_b128 a[36:39], v1 offset:1024
v_cvt_pk_bf16_f32 v75, v42, v43
v_mfma_f32_16x16x32_bf16 v[16:19], a[4:7], a[164:167], v[16:19]
v_exp_f32 v44, v44
v_mfma_f32_16x16x32_bf16 v[16:19], a[8:11], a[168:171], v[16:19]
v_mfma_f32_16x16x32_bf16 v[16:19], a[12:15], a[172:175], v[16:19]
buffer_load_dwordx4 v3, s[48:51], s32 offen offset:2048 sc1 lds
v_mfma_f32_16x16x32_bf16 v[20:23], a[0:3], a[176:179], v[84:87]
ds_read_b128 a[40:43], v1 offset:2048
v_mfma_f32_16x16x32_bf16 v[20:23], a[4:7], a[180:183], v[20:23]
v_exp_f32 v45, v45
v_mfma_f32_16x16x32_bf16 v[20:23], a[8:11], a[184:187], v[20:23]
v_exp_f32 v46, v46
v_mfma_f32_16x16x32_bf16 v[20:23], a[12:15], a[188:191], v[20:23]
ds_read_b128 a[44:47], v1 offset:3072
v_cvt_pk_bf16_f32 v78, v44, v45
v_mfma_f32_16x16x32_bf16 v[24:27], a[0:3], a[192:195], v[88:91]
v_mfma_f32_16x16x32_bf16 v[24:27], a[4:7], a[196:199], v[24:27]
v_exp_f32 v47, v47
v_mfma_f32_16x16x32_bf16 v[24:27], a[8:11], a[200:203], v[24:27]
v_exp_f32 v16, v16
v_mfma_f32_16x16x32_bf16 v[24:27], a[12:15], a[204:207], v[24:27]
ds_read_b128 a[48:51], v1 offset:4096
v_cvt_pk_bf16_f32 v79, v46, v47
v_mfma_f32_16x16x32_bf16 v[28:31], a[0:3], a[208:211], v[92:95]
v_exp_f32 v17, v17
v_mfma_f32_16x16x32_bf16 v[28:31], a[4:7], a[212:215], v[28:31]
s_waitcnt lgkmcnt(5)
v_cvt_pk_bf16_f32 v48, v16, v17
v_mfma_f32_16x16x32_bf16 v[28:31], a[8:11], a[216:219], v[28:31]
buffer_load_dwordx4 v3, s[48:51], s32 offen offset:3072 sc1 lds
v_mfma_f32_16x16x32_bf16 v[28:31], a[12:15], a[220:223], v[28:31]
ds_read_b128 a[52:55], v1 offset:5120
v_mfma_f32_16x16x32_bf16 v[32:35], a[16:19], a[160:163], v[100:103]
v_exp_f32 v18, v18
v_mfma_f32_16x16x32_bf16 v[32:35], a[20:23], a[164:167], v[32:35]
v_exp_f32 v19, v19
v_mfma_f32_16x16x32_bf16 v[32:35], a[24:27], a[168:171], v[32:35]
v_exp_f32 v20, v20
v_mfma_f32_16x16x32_bf16 v[32:35], a[28:31], a[172:175], v[32:35]
ds_read_b128 a[56:59], v1 offset:6144
v_cvt_pk_bf16_f32 v49, v18, v19
v_mfma_f32_16x16x32_bf16 v[36:39], a[16:19], a[176:179], v[84:87]
v_mfma_f32_16x16x32_bf16 v[36:39], a[20:23], a[180:183], v[36:39]
v_exp_f32 v21, v21
v_mfma_f32_16x16x32_bf16 v[36:39], a[24:27], a[184:187], v[36:39]
s_mov_b32 s9, 0x0
v_exp_f32 v22, v22
v_mfma_f32_16x16x32_bf16 v[36:39], a[28:31], a[188:191], v[36:39]
ds_read_b128 a[60:63], v1 offset:7168
v_cvt_pk_bf16_f32 v52, v20, v21
v_mfma_f32_16x16x32_bf16 v[40:43], a[16:19], a[192:195], v[88:91]
buffer_load_dword a244, v8, s[64:67], s9 offen
v_mfma_f32_16x16x32_bf16 v[40:43], a[20:23], a[196:199], v[40:43]
v_mfma_f32_16x16x32_bf16 v[40:43], a[24:27], a[200:203], v[40:43]
v_exp_f32 v23, v23
v_mfma_f32_16x16x32_bf16 v[40:43], a[28:31], a[204:207], v[40:43]
v_exp_f32 v24, v24
v_mfma_f32_16x16x32_bf16 v[44:47], a[16:19], a[208:211], v[92:95]
v_exp_f32 v25, v25
v_mfma_f32_16x16x32_bf16 v[44:47], a[20:23], a[212:215], v[44:47]
v_exp_f32 v26, v26
v_mfma_f32_16x16x32_bf16 v[44:47], a[24:27], a[216:219], v[44:47]
v_exp_f32 v27, v27
v_mfma_f32_16x16x32_bf16 v[44:47], a[28:31], a[220:223], v[44:47]
s_waitcnt lgkmcnt(0)
v_cvt_pk_bf16_f32 v53, v22, v23
v_mfma_f32_16x16x32_bf16 v[128:131], a[32:35], v[64:67], v[128:131]
ds_read_b128 a[0:3], v1 offset:24576
v_cvt_pk_bf16_f32 v56, v24, v25
v_mfma_f32_16x16x32_bf16 v[160:163], a[32:35], v[68:71], v[160:163]
v_exp_f32 v28, v28
v_mfma_f32_16x16x32_bf16 v[192:195], a[32:35], v[72:75], v[192:195]
v_cvt_pk_bf16_f32 v57, v26, v27
v_mfma_f32_16x16x32_bf16 v[224:227], a[32:35], v[76:79], v[224:227]
ds_read_b128 a[4:7], v1 offset:25600
v_mfma_f32_16x16x32_bf16 v[228:231], a[36:39], v[76:79], v[228:231]
s_add_u32 m0, s27, 0x1000
v_exp_f32 v29, v29
v_mfma_f32_16x16x32_bf16 v[196:199], a[36:39], v[72:75], v[196:199]
buffer_load_dwordx4 v3, s[48:51], s7 offen offset:0 sc1 lds
v_mfma_f32_16x16x32_bf16 v[164:167], a[36:39], v[68:71], v[164:167]
ds_read_b128 a[8:11], v1 offset:26624
v_cvt_pk_bf16_f32 v60, v28, v29
v_mfma_f32_16x16x32_bf16 v[132:135], a[36:39], v[64:67], v[132:135]
v_exp_f32 v30, v30
v_mfma_f32_16x16x32_bf16 v[136:139], a[40:43], v[64:67], v[136:139]
v_exp_f32 v31, v31
v_mfma_f32_16x16x32_bf16 v[168:171], a[40:43], v[68:71], v[168:171]
ds_read_b128 a[12:15], v1 offset:27648
v_cvt_pk_bf16_f32 v61, v30, v31
v_mfma_f32_16x16x32_bf16 v[200:203], a[40:43], v[72:75], v[200:203]
v_mfma_f32_16x16x32_bf16 v[232:235], a[40:43], v[76:79], v[232:235]
v_exp_f32 v32, v32
v_mfma_f32_16x16x32_bf16 v[236:239], a[44:47], v[76:79], v[236:239]
v_exp_f32 v33, v33
v_mfma_f32_16x16x32_bf16 v[204:207], a[44:47], v[72:75], v[204:207]
ds_read_b128 a[16:19], v1 offset:28672
v_cvt_pk_bf16_f32 v50, v32, v33
v_mfma_f32_16x16x32_bf16 v[172:175], a[44:47], v[68:71], v[172:175]
v_exp_f32 v34, v34
v_mfma_f32_16x16x32_bf16 v[140:143], a[44:47], v[64:67], v[140:143]
buffer_load_dwordx4 v3, s[48:51], s7 offen offset:1024 sc1 lds
v_mfma_f32_16x16x32_bf16 v[144:147], a[48:51], v[64:67], v[144:147]
ds_read_b128 a[20:23], v1 offset:29696
v_mfma_f32_16x16x32_bf16 v[176:179], a[48:51], v[68:71], v[176:179]
v_mfma_f32_16x16x32_bf16 v[208:211], a[48:51], v[72:75], v[208:211]
v_exp_f32 v35, v35
v_mfma_f32_16x16x32_bf16 v[240:243], a[48:51], v[76:79], v[240:243]
ds_read_b128 a[24:27], v1 offset:30720
v_cvt_pk_bf16_f32 v51, v34, v35
v_mfma_f32_16x16x32_bf16 v[244:247], a[52:55], v[76:79], v[244:247]
v_exp_f32 v36, v36
v_mfma_f32_16x16x32_bf16 v[212:215], a[52:55], v[72:75], v[212:215]
v_exp_f32 v37, v37
v_mfma_f32_16x16x32_bf16 v[180:183], a[52:55], v[68:71], v[180:183]
ds_read_b128 a[28:31], v1 offset:31744
v_cvt_pk_bf16_f32 v54, v36, v37
v_mfma_f32_16x16x32_bf16 v[148:151], a[52:55], v[64:67], v[148:151]
v_mfma_f32_16x16x32_bf16 v[152:155], a[56:59], v[64:67], v[152:155]
v_exp_f32 v38, v38
v_mfma_f32_16x16x32_bf16 v[184:187], a[56:59], v[68:71], v[184:187]
v_exp_f32 v39, v39
v_mfma_f32_16x16x32_bf16 v[216:219], a[56:59], v[72:75], v[216:219]
buffer_load_dwordx4 v3, s[48:51], s7 offen offset:2048 sc1 lds
v_mfma_f32_16x16x32_bf16 v[248:251], a[56:59], v[76:79], v[248:251]
ds_read_b128 a[32:35], v1 offset:16384
v_cvt_pk_bf16_f32 v55, v38, v39
v_mfma_f32_16x16x32_bf16 v[252:255], a[60:63], v[76:79], v[252:255]
v_exp_f32 v40, v40
v_mfma_f32_16x16x32_bf16 v[220:223], a[60:63], v[72:75], v[220:223]
ds_read_b128 a[36:39], v1 offset:17408
v_mfma_f32_16x16x32_bf16 v[188:191], a[60:63], v[68:71], v[188:191]
v_mfma_f32_16x16x32_bf16 v[156:159], a[60:63], v[64:67], v[156:159]
v_exp_f32 v41, v41
v_smfmac_f32_16x16x64_bf16 a[224:227], a[232:235], v[64:71], v9
ds_read_b128 a[40:43], v1 offset:18432
v_cvt_pk_bf16_f32 v58, v40, v41
v_smfmac_f32_16x16x64_bf16 a[228:231], a[232:235], v[72:79], v9
s_waitcnt lgkmcnt(7)
v_exp_f32 v42, v42
v_mfma_f32_16x16x32_bf16 v[20:23], a[0:3], a[176:179], v[84:87]
s_mov_b32 s9, 0x400000
v_exp_f32 v43, v43
v_mfma_f32_16x16x32_bf16 v[20:23], a[4:7], a[180:183], v[20:23]
ds_read_b128 a[44:47], v1 offset:19456
v_cvt_pk_bf16_f32 v59, v42, v43
v_mfma_f32_16x16x32_bf16 v[20:23], a[8:11], a[184:187], v[20:23]
buffer_load_dword a244, v8, s[64:67], s9 offen
v_mfma_f32_16x16x32_bf16 v[20:23], a[12:15], a[188:191], v[20:23]
v_mfma_f32_16x16x32_bf16 v[24:27], a[0:3], a[192:195], v[88:91]
v_exp_f32 v44, v44
v_mfma_f32_16x16x32_bf16 v[24:27], a[4:7], a[196:199], v[24:27]
ds_read_b128 a[48:51], v1 offset:20480
v_mfma_f32_16x16x32_bf16 v[24:27], a[8:11], a[200:203], v[24:27]
v_exp_f32 v45, v45
v_mfma_f32_16x16x32_bf16 v[24:27], a[12:15], a[204:207], v[24:27]
v_exp_f32 v46, v46
v_mfma_f32_16x16x32_bf16 v[28:31], a[0:3], a[208:211], v[92:95]
ds_read_b128 a[52:55], v1 offset:21504
v_cvt_pk_bf16_f32 v62, v44, v45
v_mfma_f32_16x16x32_bf16 v[28:31], a[4:7], a[212:215], v[28:31]
v_mfma_f32_16x16x32_bf16 v[28:31], a[8:11], a[216:219], v[28:31]
s_waitcnt lgkmcnt(6)
v_exp_f32 v47, v47
v_mfma_f32_16x16x32_bf16 v[28:31], a[12:15], a[220:223], v[28:31]
ds_read_b128 a[56:59], v1 offset:22528
v_cvt_pk_bf16_f32 v63, v46, v47
v_mfma_f32_16x16x32_bf16 v[36:39], a[16:19], a[176:179], v[84:87]
buffer_load_dwordx4 v3, s[48:51], s7 offen offset:3072 sc1 lds
v_mfma_f32_16x16x32_bf16 v[36:39], a[20:23], a[180:183], v[36:39]
s_add_u32 s32, s32, 0x8000
v_exp_f32 v20, v20
v_mfma_f32_16x16x32_bf16 v[36:39], a[24:27], a[184:187], v[36:39]
ds_read_b128 a[60:63], v1 offset:23552
v_xor_b32 v1, 0x8000, v1
v_mfma_f32_16x16x32_bf16 v[36:39], a[28:31], a[188:191], v[36:39]
s_add_u32 s7, s7, 0x8000
v_exp_f32 v21, v21
v_mfma_f32_16x16x32_bf16 v[40:43], a[16:19], a[192:195], v[88:91]
s_xor_b32 s27, s27, 0x38000
v_cvt_pk_bf16_f32 v68, v20, v21
v_mfma_f32_16x16x32_bf16 v[40:43], a[20:23], a[196:199], v[40:43]
v_exp_f32 v22, v22
v_mfma_f32_16x16x32_bf16 v[40:43], a[24:27], a[200:203], v[40:43]
v_exp_f32 v23, v23
v_mfma_f32_16x16x32_bf16 v[40:43], a[28:31], a[204:207], v[40:43]
v_exp_f32 v24, v24
v_mfma_f32_16x16x32_bf16 v[44:47], a[16:19], a[208:211], v[92:95]
v_exp_f32 v25, v25
v_mfma_f32_16x16x32_bf16 v[44:47], a[20:23], a[212:215], v[44:47]
v_exp_f32 v26, v26
v_mfma_f32_16x16x32_bf16 v[44:47], a[24:27], a[216:219], v[44:47]
s_waitcnt vmcnt(19) lgkmcnt(0)
v_exp_f32 v27, v27
v_mfma_f32_16x16x32_bf16 v[44:47], a[28:31], a[220:223], v[44:47]
s_barrier
v_cvt_pk_bf16_f32 v69, v22, v23
L_att_l1_0:
v_mfma_f32_16x16x32_bf16 v[128:131], a[32:35], v[48:51], v[128:131]
ds_read_b128 a[0:3], v2 offset:8192
v_cvt_pk_bf16_f32 v72, v24, v25
v_mfma_f32_16x16x32_bf16 v[160:163], a[32:35], v[52:55], v[160:163]
s_lshr_b32 s44, s2, 6
v_exp_f32 v28, v28
v_mfma_f32_16x16x32_bf16 v[192:195], a[32:35], v[56:59], v[192:195]
s_add_u32 m0, s19, 0x0
s_lshl_b32 s45, s44, 1
v_cvt_pk_bf16_f32 v73, v26, v27
v_mfma_f32_16x16x32_bf16 v[224:227], a[32:35], v[60:63], v[224:227]
ds_read_b128 a[4:7], v2 offset:9216
s_add_u32 s45, s45, s100
v_mfma_f32_16x16x32_bf16 v[228:231], a[36:39], v[60:63], v[228:231]
buffer_load_dwordx4 v3, s[48:51], s32 offen offset:0 sc1 lds
v_mfma_f32_16x16x32_bf16 v[196:199], a[36:39], v[56:59], v[196:199]
s_and_b32 s60, s45, 3
v_exp_f32 v29, v29
v_mfma_f32_16x16x32_bf16 v[164:167], a[36:39], v[52:55], v[164:167]
ds_read_b128 a[8:11], v2 offset:10240
v_cvt_pk_bf16_f32 v76, v28, v29
v_mfma_f32_16x16x32_bf16 v[132:135], a[36:39], v[48:51], v[132:135]
s_sub_u32 s60, s60, s44
v_exp_f32 v30, v30
v_mfma_f32_16x16x32_bf16 v[136:139], a[40:43], v[48:51], v[136:139]
s_lshl_b32 s60, s60, 14
s_and_b32 s60, s60, 0x7c000
s_lshl_b32 s61, s60, 3
v_mfma_f32_16x16x32_bf16 v[168:171], a[40:43], v[52:55], v[168:171]
ds_read_b128 a[12:15], v2 offset:11264
s_add_u32 s62, s61, s12
v_mfma_f32_16x16x32_bf16 v[200:203], a[40:43], v[56:59], v[200:203]
s_mul_i32 s44, s44, -8
v_exp_f32 v31, v31
v_mfma_f32_16x16x32_bf16 v[232:235], a[40:43], v[60:63], v[232:235]
s_lshl_b32 s44, 4, s44
v_exp_f32 v36, v36
v_mfma_f32_16x16x32_bf16 v[236:239], a[44:47], v[60:63], v[236:239]
s_mov_b32 s9, 0x200000
s_mul_i32 s45, s45, -8
v_cvt_pk_bf16_f32 v77, v30, v31
v_mfma_f32_16x16x32_bf16 v[204:207], a[44:47], v[56:59], v[204:207]
ds_read_b128 a[16:19], v2 offset:12288
s_lshl_b32 s45, 4, s45
v_mfma_f32_16x16x32_bf16 v[172:175], a[44:47], v[52:55], v[172:175]
buffer_load_dword a244, v8, s[64:67], s9 offen
v_mfma_f32_16x16x32_bf16 v[140:143], a[44:47], v[48:51], v[140:143]
s_add_u32 s44, s44, 0x21212121
v_exp_f32 v37, v37
v_mfma_f32_16x16x32_bf16 v[144:147], a[48:51], v[48:51], v[144:147]
ds_read_b128 a[20:23], v2 offset:13312
v_cvt_pk_bf16_f32 v70, v36, v37
v_mfma_f32_16x16x32_bf16 v[176:179], a[48:51], v[52:55], v[176:179]
s_sub_u32 s44, s44, s45
v_exp_f32 v38, v38
v_mfma_f32_16x16x32_bf16 v[208:211], a[48:51], v[56:59], v[208:211]
s_bfe_u32 s56, s44, 0x80000
s_lshl_b32 s56, s56, 14
s_bfe_u32 s57, s44, 0x80008
v_mfma_f32_16x16x32_bf16 v[240:243], a[48:51], v[60:63], v[240:243]
ds_read_b128 a[24:27], v2 offset:14336
s_lshl_b32 s57, s57, 14
v_mfma_f32_16x16x32_bf16 v[244:247], a[52:55], v[60:63], v[244:247]
s_bfe_u32 s58, s44, 0x80010
v_exp_f32 v39, v39
v_mfma_f32_16x16x32_bf16 v[212:215], a[52:55], v[56:59], v[212:215]
s_lshl_b32 s58, s58, 14
v_exp_f32 v40, v40
v_mfma_f32_16x16x32_bf16 v[180:183], a[52:55], v[52:55], v[180:183]
s_bfe_u32 s59, s44, 0x80018
s_lshl_b32 s59, s59, 14
v_cvt_pk_bf16_f32 v71, v38, v39
v_mfma_f32_16x16x32_bf16 v[148:151], a[52:55], v[48:51], v[148:151]
buffer_load_dwordx4 v3, s[48:51], s32 offen offset:1024 sc1 lds
v_mfma_f32_16x16x32_bf16 v[152:155], a[56:59], v[48:51], v[152:155]
ds_read_b128 a[28:31], v2 offset:15360
v_mfma_f32_16x16x32_bf16 v[184:187], a[56:59], v[52:55], v[184:187]
v_exp_f32 v41, v41
v_mfma_f32_16x16x32_bf16 v[216:219], a[56:59], v[56:59], v[216:219]
ds_read_b128 a[32:35], v2 offset:0
v_cvt_pk_bf16_f32 v74, v40, v41
v_mfma_f32_16x16x32_bf16 v[248:251], a[56:59], v[60:63], v[248:251]
v_exp_f32 v42, v42
v_mfma_f32_16x16x32_bf16 v[252:255], a[60:63], v[60:63], v[252:255]
v_mfma_f32_16x16x32_bf16 v[220:223], a[60:63], v[56:59], v[220:223]
ds_read_b128 a[36:39], v2 offset:1024
v_mfma_f32_16x16x32_bf16 v[188:191], a[60:63], v[52:55], v[188:191]
v_exp_f32 v43, v43
v_mfma_f32_16x16x32_bf16 v[156:159], a[60:63], v[48:51], v[156:159]
s_waitcnt lgkmcnt(6)
v_exp_f32 v44, v44
v_smfmac_f32_16x16x64_bf16 a[224:227], a[232:235], v[48:55], v9
buffer_load_dwordx4 v3, s[48:51], s32 offen offset:2048 sc1 lds
v_smfmac_f32_16x16x64_bf16 a[228:231], a[232:235], v[56:63], v9
ds_read_b128 a[40:43], v2 offset:2048
v_cvt_pk_bf16_f32 v75, v42, v43
v_mfma_f32_16x16x32_bf16 v[20:23], a[0:3], a[176:179], v[84:87]
v_mfma_f32_16x16x32_bf16 v[20:23], a[4:7], a[180:183], v[20:23]
v_exp_f32 v45, v45
v_mfma_f32_16x16x32_bf16 v[20:23], a[8:11], a[184:187], v[20:23]
ds_read_b128 a[44:47], v2 offset:3072
v_cvt_pk_bf16_f32 v78, v44, v45
v_mfma_f32_16x16x32_bf16 v[20:23], a[12:15], a[188:191], v[20:23]
v_exp_f32 v46, v46
v_mfma_f32_16x16x32_bf16 v[24:27], a[0:3], a[192:195], v[88:91]
v_mfma_f32_16x16x32_bf16 v[24:27], a[4:7], a[196:199], v[24:27]
ds_read_b128 a[48:51], v2 offset:4096
v_mfma_f32_16x16x32_bf16 v[24:27], a[8:11], a[200:203], v[24:27]
v_exp_f32 v47, v47
v_mfma_f32_16x16x32_bf16 v[24:27], a[12:15], a[204:207], v[24:27]
s_nop 0
v_exp_f32 v20, v20
v_mfma_f32_16x16x32_bf16 v[28:31], a[0:3], a[208:211], v[92:95]
buffer_load_dwordx4 v3, s[48:51], s32 offen offset:3072 sc1 lds
v_mfma_f32_16x16x32_bf16 v[28:31], a[4:7], a[212:215], v[28:31]
ds_read_b128 a[52:55], v2 offset:5120
v_cvt_pk_bf16_f32 v79, v46, v47
v_mfma_f32_16x16x32_bf16 v[28:31], a[8:11], a[216:219], v[28:31]
v_mfma_f32_16x16x32_bf16 v[28:31], a[12:15], a[220:223], v[28:31]
s_waitcnt lgkmcnt(6)
v_exp_f32 v21, v21
v_mfma_f32_16x16x32_bf16 v[36:39], a[16:19], a[176:179], v[84:87]
ds_read_b128 a[56:59], v2 offset:6144
v_cvt_pk_bf16_f32 v52, v20, v21
v_mfma_f32_16x16x32_bf16 v[36:39], a[20:23], a[180:183], v[36:39]
v_exp_f32 v22, v22
v_mfma_f32_16x16x32_bf16 v[36:39], a[24:27], a[184:187], v[36:39]
v_mfma_f32_16x16x32_bf16 v[36:39], a[28:31], a[188:191], v[36:39]
ds_read_b128 a[60:63], v2 offset:7168
v_mfma_f32_16x16x32_bf16 v[40:43], a[16:19], a[192:195], v[88:91]
s_mov_b32 s9, 0x600000
v_exp_f32 v23, v23
v_mfma_f32_16x16x32_bf16 v[40:43], a[20:23], a[196:199], v[40:43]
buffer_load_dword a244, v8, s[64:67], s9 offen
v_mfma_f32_16x16x32_bf16 v[40:43], a[24:27], a[200:203], v[40:43]
v_exp_f32 v24, v24
v_mfma_f32_16x16x32_bf16 v[40:43], a[28:31], a[204:207], v[40:43]
v_cvt_pk_bf16_f32 v53, v22, v23
v_mfma_f32_16x16x32_bf16 v[44:47], a[16:19], a[208:211], v[92:95]
v_exp_f32 v25, v25
v_mfma_f32_16x16x32_bf16 v[44:47], a[20:23], a[212:215], v[44:47]
v_exp_f32 v26, v26
v_mfma_f32_16x16x32_bf16 v[44:47], a[24:27], a[216:219], v[44:47]
v_exp_f32 v27, v27
v_mfma_f32_16x16x32_bf16 v[44:47], a[28:31], a[220:223], v[44:47]
s_waitcnt lgkmcnt(0)
v_mfma_f32_16x16x32_bf16 v[160:163], a[32:35], v[68:71], v[160:163]
ds_read_b128 a[0:3], v2 offset:24576
v_cvt_pk_bf16_f32 v56, v24, v25
v_mfma_f32_16x16x32_bf16 v[192:195], a[32:35], v[72:75], v[192:195]
v_exp_f32 v28, v28
v_mfma_f32_16x16x32_bf16 v[224:227], a[32:35], v[76:79], v[224:227]
ds_read_b128 a[4:7], v2 offset:25600
v_cvt_pk_bf16_f32 v57, v26, v27
v_mfma_f32_16x16x32_bf16 v[228:231], a[36:39], v[76:79], v[228:231]
s_add_u32 m0, s19, 0x1000
v_mfma_f32_16x16x32_bf16 v[196:199], a[36:39], v[72:75], v[196:199]
buffer_load_dwordx4 v3, s[48:51], s7 offen offset:0 sc1 lds
v_mfma_f32_16x16x32_bf16 v[164:167], a[36:39], v[68:71], v[164:167]
ds_read_b128 a[8:11], v2 offset:26624
v_mfma_f32_16x16x32_bf16 v[168:171], a[40:43], v[68:71], v[168:171]
v_exp_f32 v29, v29
v_mfma_f32_16x16x32_bf16 v[200:203], a[40:43], v[72:75], v[200:203]
v_exp_f32 v30, v30
v_mfma_f32_16x16x32_bf16 v[232:235], a[40:43], v[76:79], v[232:235]
ds_read_b128 a[12:15], v2 offset:27648
v_cvt_pk_bf16_f32 v60, v28, v29
v_mfma_f32_16x16x32_bf16 v[236:239], a[44:47], v[76:79], v[236:239]
v_exp_f32 v31, v31
v_mfma_f32_16x16x32_bf16 v[204:207], a[44:47], v[72:75], v[204:207]
v_exp_f32 v36, v36
v_mfma_f32_16x16x32_bf16 v[172:175], a[44:47], v[68:71], v[172:175]
ds_read_b128 a[16:19], v2 offset:28672
v_cvt_pk_bf16_f32 v61, v30, v31
v_mfma_f32_16x16x32_bf16 v[176:179], a[48:51], v[68:71], v[176:179]
buffer_load_dwordx4 v3, s[48:51], s7 offen offset:1024 sc1 lds
v_mfma_f32_16x16x32_bf16 v[208:211], a[48:51], v[72:75], v[208:211]
ds_read_b128 a[20:23], v2 offset:29696
v_mfma_f32_16x16x32_bf16 v[240:243], a[48:51], v[76:79], v[240:243]
v_mfma_f32_16x16x32_bf16 v[244:247], a[52:55], v[76:79], v[244:247]
v_exp_f32 v37, v37
v_mfma_f32_16x16x32_bf16 v[212:215], a[52:55], v[72:75], v[212:215]
ds_read_b128 a[24:27], v2 offset:30720
v_cvt_pk_bf16_f32 v54, v36, v37
v_mfma_f32_16x16x32_bf16 v[180:183], a[52:55], v[68:71], v[180:183]
v_exp_f32 v38, v38
v_mfma_f32_16x16x32_bf16 v[184:187], a[56:59], v[68:71], v[184:187]
v_exp_f32 v39, v39
v_mfma_f32_16x16x32_bf16 v[216:219], a[56:59], v[72:75], v[216:219]
ds_read_b128 a[28:31], v2 offset:31744
v_cvt_pk_bf16_f32 v55, v38, v39
v_mfma_f32_16x16x32_bf16 v[248:251], a[56:59], v[76:79], v[248:251]
v_exp_f32 v40, v40
v_mfma_f32_16x16x32_bf16 v[252:255], a[60:63], v[76:79], v[252:255]
buffer_load_dwordx4 v3, s[48:51], s7 offen offset:2048 sc1 lds
v_mfma_f32_16x16x32_bf16 v[220:223], a[60:63], v[72:75], v[220:223]
ds_read_b128 a[32:35], v2 offset:16384
v_mfma_f32_16x16x32_bf16 v[188:191], a[60:63], v[68:71], v[188:191]
v_exp_f32 v41, v41
v_mfma_f32_16x16x32_bf16 a[224:227], a[236:239], v[68:71], a[224:227]
ds_read_b128 a[36:39], v2 offset:17408
v_cvt_pk_bf16_f32 v58, v40, v41
v_smfmac_f32_16x16x64_bf16 a[228:231], a[232:235], v[72:79], v9
s_waitcnt lgkmcnt(6)
v_exp_f32 v42, v42
v_mfma_f32_16x16x32_bf16 v[20:23], a[0:3], a[176:179], v[104:107]
v_exp_f32 v43, v43
v_mfma_f32_16x16x32_bf16 v[20:23], a[4:7], a[180:183], v[20:23]
ds_read_b128 a[40:43], v2 offset:18432
v_cvt_pk_bf16_f32 v59, v42, v43
v_mfma_f32_16x16x32_bf16 v[20:23], a[8:11], a[184:187], v[20:23]
v_exp_f32 v44, v44
v_mfma_f32_16x16x32_bf16 v[20:23], a[12:15], a[188:191], v[20:23]
buffer_load_dwordx4 v3, s[48:51], s7 offen offset:3072 sc1 lds
v_mfma_f32_16x16x32_bf16 v[24:27], a[0:3], a[192:195], v[88:91]
ds_read_b128 a[44:47], v2 offset:19456
v_mfma_f32_16x16x32_bf16 v[24:27], a[4:7], a[196:199], v[24:27]
v_exp_f32 v45, v45
v_mfma_f32_16x16x32_bf16 v[24:27], a[8:11], a[200:203], v[24:27]
v_exp_f32 v46, v46
v_mfma_f32_16x16x32_bf16 v[24:27], a[12:15], a[204:207], v[24:27]
ds_read_b128 a[48:51], v2 offset:20480
v_add_u32 v4, s0, v3
v_mfma_f32_16x16x32_bf16 v[28:31], a[0:3], a[208:211], v[92:95]
v_cvt_pk_bf16_f32 v62, v44, v45
v_mfma_f32_16x16x32_bf16 v[28:31], a[4:7], a[212:215], v[28:31]
ds_read_b128 a[52:55], v2 offset:21504
v_mov_b32 v5, s1
v_mfma_f32_16x16x32_bf16 v[28:31], a[8:11], a[216:219], v[28:31]
s_waitcnt lgkmcnt(6)
v_exp_f32 v47, v47
v_mfma_f32_16x16x32_bf16 v[28:31], a[12:15], a[220:223], v[28:31]
global_load_dword a244, v[4:5], off sc1
v_mfma_f32_16x16x32_bf16 v[36:39], a[16:19], a[176:179], v[108:111]
ds_read_b128 a[56:59], v2 offset:22528
v_cvt_pk_bf16_f32 v63, v46, v47
v_mfma_f32_16x16x32_bf16 v[36:39], a[20:23], a[180:183], v[36:39]
s_add_u32 s32, s32, 0x8000
v_exp_f32 v20, v20
v_mfma_f32_16x16x32_bf16 v[36:39], a[24:27], a[184:187], v[36:39]
s_add_u32 s7, s7, 0x8000
v_exp_f32 v21, v21
v_mfma_f32_16x16x32_bf16 v[36:39], a[28:31], a[188:191], v[36:39]
ds_read_b128 a[60:63], v2 offset:23552
v_xor_b32 v2, 0x38000, v2
v_mfma_f32_16x16x32_bf16 v[40:43], a[16:19], a[192:195], v[88:91]
s_xor_b32 s19, s19, 0x8000
v_exp_f32 v22, v22
v_mfma_f32_16x16x32_bf16 v[40:43], a[20:23], a[196:199], v[40:43]
s_sub_u32 s15, 7, s6
v_exp_f32 v23, v23
v_mfma_f32_16x16x32_bf16 v[40:43], a[24:27], a[200:203], v[40:43]
s_lshl_b32 s15, s15, 1
v_exp_f32 v24, v24
v_mfma_f32_16x16x32_bf16 v[40:43], a[28:31], a[204:207], v[40:43]
v_exp_f32 v25, v25
v_mfma_f32_16x16x32_bf16 v[44:47], a[16:19], a[208:211], v[92:95]
v_exp_f32 v26, v26
v_mfma_f32_16x16x32_bf16 v[44:47], a[20:23], a[212:215], v[44:47]
v_exp_f32 v27, v27
v_mfma_f32_16x16x32_bf16 v[44:47], a[24:27], a[216:219], v[44:47]
s_waitcnt vmcnt(22) lgkmcnt(0)
v_cvt_pk_bf16_f32 v68, v20, v21
v_cvt_pk_bf16_f32 v69, v22, v23
v_mfma_f32_16x16x32_bf16 v[44:47], a[28:31], a[220:223], v[44:47]
s_barrier
s_cbranch_scc0 L_att_lh0_0
v_mfma_f32_16x16x32_bf16 v[160:163], a[32:35], v[52:55], v[160:163]
ds_read_b128 a[0:3], v1 offset:8192
v_cvt_pk_bf16_f32 v72, v24, v25
v_mfma_f32_16x16x32_bf16 v[192:195], a[32:35], v[56:59], v[192:195]
v_exp_f32 v28, v28
v_mfma_f32_16x16x32_bf16 v[224:227], a[32:35], v[60:63], v[224:227]
ds_read_b128 a[4:7], v1 offset:9216
v_cvt_pk_bf16_f32 v73, v26, v27
v_mfma_f32_16x16x32_bf16 v[228:231], a[36:39], v[60:63], v[228:231]
s_add_u32 m0, s27, 0x0
v_exp_f32 v29, v29
v_mfma_f32_16x16x32_bf16 v[196:199], a[36:39], v[56:59], v[196:199]
buffer_load_dwordx4 v3, s[48:51], s32 offen offset:0 sc1 lds
v_mfma_f32_16x16x32_bf16 v[164:167], a[36:39], v[52:55], v[164:167]
ds_read_b128 a[8:11], v1 offset:10240
v_cvt_pk_bf16_f32 v76, v28, v29
v_mfma_f32_16x16x32_bf16 v[168:171], a[40:43], v[52:55], v[168:171]
ds_read_b128 a[12:15], v1 offset:11264
v_accvgpr_read_b32 v6, a224
v_mfma_f32_16x16x32_bf16 v[200:203], a[40:43], v[56:59], v[200:203]
v_exp_f32 v30, v30
v_mfma_f32_16x16x32_bf16 v[232:235], a[40:43], v[60:63], v[232:235]
v_exp_f32 v31, v31
v_mfma_f32_16x16x32_bf16 v[236:239], a[44:47], v[60:63], v[236:239]
ds_read_b128 a[16:19], v1 offset:12288
v_cvt_pk_bf16_f32 v77, v30, v31
v_mfma_f32_16x16x32_bf16 v[204:207], a[44:47], v[56:59], v[204:207]
v_exp_f32 v36, v36
v_mfma_f32_16x16x32_bf16 v[172:175], a[44:47], v[52:55], v[172:175]
ds_read_b128 a[20:23], v1 offset:13312
v_accvgpr_read_b32 v7, a225
v_mfma_f32_16x16x32_bf16 v[176:179], a[48:51], v[52:55], v[176:179]
v_exp_f32 v37, v37
v_mfma_f32_16x16x32_bf16 v[208:211], a[48:51], v[56:59], v[208:211]
ds_read_b128 a[24:27], v1 offset:14336
v_cvt_pk_bf16_f32 v70, v36, v37
v_mfma_f32_16x16x32_bf16 v[240:243], a[48:51], v[60:63], v[240:243]
buffer_load_dwordx4 v3, s[48:51], s32 offen offset:1024 sc1 lds
v_mfma_f32_16x16x32_bf16 v[244:247], a[52:55], v[60:63], v[244:247]
v_exp_f32 v38, v38
v_mfma_f32_16x16x32_bf16 v[212:215], a[52:55], v[56:59], v[212:215]
ds_read_b128 a[28:31], v1 offset:15360
v_add_f32 v6, v6, v7
v_mfma_f32_16x16x32_bf16 v[180:183], a[52:55], v[52:55], v[180:183]
v_exp_f32 v39, v39
v_mfma_f32_16x16x32_bf16 v[184:187], a[56:59], v[52:55], v[184:187]
ds_read_b128 a[32:35], v1 offset:0
v_cvt_pk_bf16_f32 v71, v38, v39
v_mfma_f32_16x16x32_bf16 v[216:219], a[56:59], v[56:59], v[216:219]
v_exp_f32 v40, v40
v_mfma_f32_16x16x32_bf16 v[248:251], a[56:59], v[60:63], v[248:251]
ds_read_b128 a[36:39], v1 offset:1024
v_cmp_nge_f32 vcc, 0x5f800000, v6
v_mfma_f32_16x16x32_bf16 v[252:255], a[60:63], v[60:63], v[252:255]
v_exp_f32 v41, v41
v_mfma_f32_16x16x32_bf16 v[220:223], a[60:63], v[56:59], v[220:223]
v_exp_f32 v42, v42
v_mfma_f32_16x16x32_bf16 v[188:191], a[60:63], v[52:55], v[188:191]
ds_read_b128 a[40:43], v1 offset:2048
v_cvt_pk_bf16_f32 v74, v40, v41
v_mfma_f32_16x16x32_bf16 a[224:227], a[236:239], v[52:55], a[224:227]
buffer_load_dwordx4 v3, s[48:51], s32 offen offset:2048 sc1 lds
v_smfmac_f32_16x16x64_bf16 a[228:231], a[232:235], v[56:63], v9
ds_read_b128 a[44:47], v1 offset:3072
s_waitcnt lgkmcnt(8)
v_mfma_f32_16x16x32_bf16 v[24:27], a[0:3], a[192:195], v[88:91]
v_exp_f32 v43, v43
v_mfma_f32_16x16x32_bf16 v[24:27], a[4:7], a[196:199], v[24:27]
ds_read_b128 a[48:51], v1 offset:4096
v_cvt_pk_bf16_f32 v75, v42, v43
v_mfma_f32_16x16x32_bf16 v[24:27], a[8:11], a[200:203], v[24:27]
v_exp_f32 v44, v44
v_mfma_f32_16x16x32_bf16 v[24:27], a[12:15], a[204:207], v[24:27]
v_exp_f32 v45, v45
v_mfma_f32_16x16x32_bf16 v[28:31], a[0:3], a[208:211], v[92:95]
ds_read_b128 a[52:55], v1 offset:5120
v_cvt_pk_bf16_f32 v78, v44, v45
v_mfma_f32_16x16x32_bf16 v[28:31], a[4:7], a[212:215], v[28:31]
v_exp_f32 v46, v46
v_mfma_f32_16x16x32_bf16 v[28:31], a[8:11], a[216:219], v[28:31]
ds_read_b128 a[56:59], v1 offset:6144
v_mfma_f32_16x16x32_bf16 v[28:31], a[12:15], a[220:223], v[28:31]
s_waitcnt lgkmcnt(7)
v_exp_f32 v47, v47
v_mfma_f32_16x16x32_bf16 v[40:43], a[16:19], a[192:195], v[88:91]
buffer_load_dwordx4 v3, s[48:51], s32 offen offset:3072 sc1 lds
v_mfma_f32_16x16x32_bf16 v[40:43], a[20:23], a[196:199], v[40:43]
ds_read_b128 a[60:63], v1 offset:7168
v_cvt_pk_bf16_f32 v79, v46, v47
v_mfma_f32_16x16x32_bf16 v[40:43], a[24:27], a[200:203], v[40:43]
s_add_u32 s32, s32, 0x8000
v_exp_f32 v24, v24
v_mfma_f32_16x16x32_bf16 v[40:43], a[28:31], a[204:207], v[40:43]
v_exp_f32 v25, v25
v_mfma_f32_16x16x32_bf16 v[44:47], a[16:19], a[208:211], v[92:95]
v_exp_f32 v26, v26
v_mfma_f32_16x16x32_bf16 v[44:47], a[20:23], a[212:215], v[44:47]
v_exp_f32 v27, v27
v_mfma_f32_16x16x32_bf16 v[44:47], a[24:27], a[216:219], v[44:47]
v_exp_f32 v28, v28
v_mfma_f32_16x16x32_bf16 v[44:47], a[28:31], a[220:223], v[44:47]
s_waitcnt lgkmcnt(0)
v_exp_f32 v29, v29
v_mfma_f32_16x16x32_bf16 v[160:163], a[32:35], v[68:71], v[160:163]
ds_read_b128 a[0:3], v1 offset:24576
v_cvt_pk_bf16_f32 v56, v24, v25
v_mfma_f32_16x16x32_bf16 v[192:195], a[32:35], v[72:75], v[192:195]
v_exp_f32 v30, v30
v_mfma_f32_16x16x32_bf16 v[224:227], a[32:35], v[76:79], v[224:227]
ds_read_b128 a[4:7], v1 offset:25600
v_cvt_pk_bf16_f32 v57, v26, v27
v_mfma_f32_16x16x32_bf16 v[228:231], a[36:39], v[76:79], v[228:231]
s_add_u32 m0, s27, 0x1000
v_cvt_pk_bf16_f32 v60, v28, v29
v_mfma_f32_16x16x32_bf16 v[196:199], a[36:39], v[72:75], v[196:199]
buffer_load_dwordx4 v3, s[48:51], s7 offen offset:0 sc1 lds
v_mfma_f32_16x16x32_bf16 v[164:167], a[36:39], v[68:71], v[164:167]
ds_read_b128 a[8:11], v1 offset:26624
v_mfma_f32_16x16x32_bf16 v[168:171], a[40:43], v[68:71], v[168:171]
ds_read_b128 a[12:15], v1 offset:27648
v_mfma_f32_16x16x32_bf16 v[200:203], a[40:43], v[72:75], v[200:203]
v_exp_f32 v31, v31
v_mfma_f32_16x16x32_bf16 v[232:235], a[40:43], v[76:79], v[232:235]
v_exp_f32 v40, v40
v_mfma_f32_16x16x32_bf16 v[236:239], a[44:47], v[76:79], v[236:239]
ds_read_b128 a[16:19], v1 offset:28672
v_cvt_pk_bf16_f32 v61, v30, v31
v_mfma_f32_16x16x32_bf16 v[204:207], a[44:47], v[72:75], v[204:207]
v_exp_f32 v41, v41
v_mfma_f32_16x16x32_bf16 v[172:175], a[44:47], v[68:71], v[172:175]
ds_read_b128 a[20:23], v1 offset:29696
v_cvt_pk_bf16_f32 v58, v40, v41
v_mfma_f32_16x16x32_bf16 v[176:179], a[48:51], v[68:71], v[176:179]
v_rcp_f32 v6, v6
v_mfma_f32_16x16x32_bf16 v[208:211], a[48:51], v[72:75], v[208:211]
buffer_load_dwordx4 v3, s[48:51], s7 offen offset:1024 sc1 lds
v_mfma_f32_16x16x32_bf16 v[240:243], a[48:51], v[76:79], v[240:243]
ds_read_b128 a[24:27], v1 offset:30720
s_or_b64 s[34:35], s[34:35], vcc
v_mfma_f32_16x16x32_bf16 v[244:247], a[52:55], v[76:79], v[244:247]
ds_read_b128 a[28:31], v1 offset:31744
s_add_u32 s8, s28, 0x0
v_mfma_f32_16x16x32_bf16 v[212:215], a[52:55], v[72:75], v[212:215]
v_exp_f32 v42, v42
v_mfma_f32_16x16x32_bf16 v[180:183], a[52:55], v[68:71], v[180:183]
v_exp_f32 v43, v43
v_mfma_f32_16x16x32_bf16 v[184:187], a[56:59], v[68:71], v[184:187]
ds_read_b128 a[32:35], v1 offset:16384
v_cvt_pk_bf16_f32 v59, v42, v43
v_mfma_f32_16x16x32_bf16 v[216:219], a[56:59], v[72:75], v[216:219]
v_exp_f32 v44, v44
v_mfma_f32_16x16x32_bf16 v[248:251], a[56:59], v[76:79], v[248:251]
ds_read_b128 a[36:39], v1 offset:17408
v_mul_f32 v128, v6, v128
v_mfma_f32_16x16x32_bf16 v[252:255], a[60:63], v[76:79], v[252:255]
v_mul_f32 v129, v6, v129
v_mul_f32 v130, v6, v130
v_mfma_f32_16x16x32_bf16 v[220:223], a[60:63], v[72:75], v[220:223]
ds_read_b128 a[40:43], v1 offset:18432
v_mul_f32 v131, v6, v131
v_mfma_f32_16x16x32_bf16 v[188:191], a[60:63], v[68:71], v[188:191]
buffer_load_dwordx4 v3, s[48:51], s7 offen offset:2048 sc1 lds
v_mfma_f32_16x16x32_bf16 a[224:227], a[236:239], v[68:71], a[224:227]
ds_read_b128 a[44:47], v1 offset:19456
v_mul_f32 v132, v6, v132
v_smfmac_f32_16x16x64_bf16 a[228:231], a[232:235], v[72:79], v9
s_waitcnt lgkmcnt(8)
v_exp_f32 v45, v45
v_mfma_f32_16x16x32_bf16 v[24:27], a[0:3], a[192:195], v[88:91]
v_exp_f32 v46, v46
v_mfma_f32_16x16x32_bf16 v[24:27], a[4:7], a[196:199], v[24:27]
ds_read_b128 a[48:51], v1 offset:20480
v_cvt_pk_bf16_f32 v62, v44, v45
v_mfma_f32_16x16x32_bf16 v[24:27], a[8:11], a[200:203], v[24:27]
v_exp_f32 v47, v47
v_mfma_f32_16x16x32_bf16 v[24:27], a[12:15], a[204:207], v[24:27]
ds_read_b128 a[52:55], v1 offset:21504
v_cvt_pk_bf16_f32 v63, v46, v47
v_mfma_f32_16x16x32_bf16 v[28:31], a[0:3], a[208:211], v[92:95]
v_mul_f32 v133, v6, v133
v_mul_f32 v134, v6, v134
v_mfma_f32_16x16x32_bf16 v[28:31], a[4:7], a[212:215], v[28:31]
ds_read_b128 a[56:59], v1 offset:22528
v_mul_f32 v135, v6, v135
v_mfma_f32_16x16x32_bf16 v[28:31], a[8:11], a[216:219], v[28:31]
buffer_load_dwordx4 v3, s[48:51], s7 offen offset:3072 sc1 lds
v_mfma_f32_16x16x32_bf16 v[28:31], a[12:15], a[220:223], v[28:31]
ds_read_b128 a[60:63], v1 offset:23552
s_waitcnt lgkmcnt(8)
v_mfma_f32_16x16x32_bf16 v[40:43], a[16:19], a[192:195], v[88:91]
s_add_u32 s7, s7, 0x8000
v_xor_b32 v1, 0x8000, v1
v_cvt_pk_bf16_f32 v128, v128, v129
v_mfma_f32_16x16x32_bf16 v[40:43], a[20:23], a[196:199], v[40:43]
s_xor_b32 s27, s27, 0x38000
v_exp_f32 v24, v24
v_mfma_f32_16x16x32_bf16 v[40:43], a[24:27], a[200:203], v[40:43]
v_exp_f32 v25, v25
v_mfma_f32_16x16x32_bf16 v[40:43], a[28:31], a[204:207], v[40:43]
v_exp_f32 v26, v26
v_mfma_f32_16x16x32_bf16 v[44:47], a[16:19], a[208:211], v[92:95]
v_exp_f32 v27, v27
v_mfma_f32_16x16x32_bf16 v[44:47], a[20:23], a[212:215], v[44:47]
v_exp_f32 v28, v28
v_mfma_f32_16x16x32_bf16 v[44:47], a[24:27], a[216:219], v[44:47]
s_waitcnt vmcnt(19) lgkmcnt(0)
v_exp_f32 v29, v29
v_mfma_f32_16x16x32_bf16 v[44:47], a[28:31], a[220:223], v[44:47]
s_barrier
v_cvt_pk_bf16_f32 v129, v130, v131
v_cvt_pk_bf16_f32 v130, v132, v133
v_cvt_pk_bf16_f32 v131, v134, v135
buffer_store_dwordx4 v[128:131], v3, s[88:91], s8 offen sc1
s_add_u32 s8, s28, 0x2000
v_mul_f32 v136, v6, v136
v_mul_f32 v137, v6, v137
v_mul_f32 v138, v6, v138
v_mul_f32 v139, v6, v139
v_mul_f32 v140, v6, v140
v_mul_f32 v141, v6, v141
v_mul_f32 v142, v6, v142
v_mul_f32 v143, v6, v143
v_cvt_pk_bf16_f32 v136, v136, v137
v_cvt_pk_bf16_f32 v137, v138, v139
v_cvt_pk_bf16_f32 v138, v140, v141
v_cvt_pk_bf16_f32 v139, v142, v143
buffer_store_dwordx4 v[136:139], v3, s[88:91], s8 offen sc1
s_add_u32 s8, s28, 0x4000
v_mul_f32 v144, v6, v144
v_mul_f32 v145, v6, v145
v_mul_f32 v146, v6, v146
v_mul_f32 v147, v6, v147
v_mul_f32 v148, v6, v148
v_mul_f32 v149, v6, v149
v_mul_f32 v150, v6, v150
v_mul_f32 v151, v6, v151
v_cvt_pk_bf16_f32 v144, v144, v145
v_cvt_pk_bf16_f32 v145, v146, v147
v_cvt_pk_bf16_f32 v146, v148, v149
v_cvt_pk_bf16_f32 v147, v150, v151
buffer_store_dwordx4 v[144:147], v3, s[88:91], s8 offen sc1
s_add_u32 s8, s28, 0x6000
v_mul_f32 v152, v6, v152
v_mul_f32 v153, v6, v153
v_mul_f32 v154, v6, v154
v_mul_f32 v155, v6, v155
v_mul_f32 v156, v6, v156
v_mul_f32 v157, v6, v157
v_mul_f32 v158, v6, v158
v_mul_f32 v159, v6, v159
v_cvt_pk_bf16_f32 v152, v152, v153
v_cvt_pk_bf16_f32 v153, v154, v155
v_cvt_pk_bf16_f32 v154, v156, v157
v_cvt_pk_bf16_f32 v155, v158, v159
buffer_store_dwordx4 v[152:155], v3, s[88:91], s8 offen sc1
v_accvgpr_read_b32 v6, a226
v_accvgpr_read_b32 v7, a227
v_add_f32 v6, v6, v7
v_cmp_nge_f32 vcc, 0x5f800000, v6
v_rcp_f32 v6, v6
s_or_b64 s[34:35], s[34:35], vcc
s_add_u32 s8, s29, 0x0
v_pk_mul_f32 v[160:161], v[160:161], v[6:7] op_sel_hi:[1,0]
v_pk_mul_f32 v[162:163], v[162:163], v[6:7] op_sel_hi:[1,0]
v_pk_mul_f32 v[164:165], v[164:165], v[6:7] op_sel_hi:[1,0]
v_pk_mul_f32 v[166:167], v[166:167], v[6:7] op_sel_hi:[1,0]
v_cvt_pk_bf16_f32 v160, v160, v161
v_cvt_pk_bf16_f32 v161, v162, v163
v_cvt_pk_bf16_f32 v162, v164, v165
v_cvt_pk_bf16_f32 v163, v166, v167
buffer_store_dwordx4 v[160:163], v3, s[88:91], s8 offen sc1
s_add_u32 s8, s29, 0x2000
v_pk_mul_f32 v[168:169], v[168:169], v[6:7] op_sel_hi:[1,0]
v_pk_mul_f32 v[170:171], v[170:171], v[6:7] op_sel_hi:[1,0]
v_pk_mul_f32 v[172:173], v[172:173], v[6:7] op_sel_hi:[1,0]
v_pk_mul_f32 v[174:175], v[174:175], v[6:7] op_sel_hi:[1,0]
v_cvt_pk_bf16_f32 v168, v168, v169
v_cvt_pk_bf16_f32 v169, v170, v171
v_cvt_pk_bf16_f32 v170, v172, v173
v_cvt_pk_bf16_f32 v171, v174, v175
buffer_store_dwordx4 v[168:171], v3, s[88:91], s8 offen sc1
s_add_u32 s8, s29, 0x4000
v_pk_mul_f32 v[176:177], v[176:177], v[6:7] op_sel_hi:[1,0]
v_pk_mul_f32 v[178:179], v[178:179], v[6:7] op_sel_hi:[1,0]
v_pk_mul_f32 v[180:181], v[180:181], v[6:7] op_sel_hi:[1,0]
v_pk_mul_f32 v[182:183], v[182:183], v[6:7] op_sel_hi:[1,0]
v_cvt_pk_bf16_f32 v176, v176, v177
v_cvt_pk_bf16_f32 v177, v178, v179
v_cvt_pk_bf16_f32 v178, v180, v181
v_cvt_pk_bf16_f32 v179, v182, v183
buffer_store_dwordx4 v[176:179], v3, s[88:91], s8 offen sc1
s_add_u32 s8, s29, 0x6000
v_pk_mul_f32 v[184:185], v[184:185], v[6:7] op_sel_hi:[1,0]
v_pk_mul_f32 v[186:187], v[186:187], v[6:7] op_sel_hi:[1,0]
v_pk_mul_f32 v[188:189], v[188:189], v[6:7] op_sel_hi:[1,0]
v_pk_mul_f32 v[190:191], v[190:191], v[6:7] op_sel_hi:[1,0]
v_cvt_pk_bf16_f32 v184, v184, v185
v_cvt_pk_bf16_f32 v185, v186, v187
v_cvt_pk_bf16_f32 v186, v188, v189
v_cvt_pk_bf16_f32 v187, v190, v191
buffer_store_dwordx4 v[184:187], v3, s[88:91], s8 offen sc1
s_getreg_b32 s8, hwreg(HW_REG_HW_ID, 5, 1)
s_cmp_lg_u32 s8, 0
s_cbranch_scc1 L_att_sodd1
s_branch L_att_sodd0
L_att_lh0_0:
v_mfma_f32_16x16x32_bf16 v[160:163], a[32:35], v[52:55], v[160:163]
v_exp_f32 v28, v28
v_mfma_f32_16x16x32_bf16 v[192:195], a[32:35], v[56:59], v[192:195]
buffer_load_dword v14, v15, s[84:87], 0 offen offset:192 sc1
v_mfma_f32_16x16x32_bf16 v[224:227], a[32:35], v[60:63], v[224:227]
v_exp_f32 v29, v29
v_mfma_f32_16x16x32_bf16 v[228:231], a[36:39], v[60:63], v[228:231]
v_exp_f32 v30, v30
v_mfma_f32_16x16x32_bf16 v[196:199], a[36:39], v[56:59], v[196:199]
s_add_u32 m0, s17, 0x10000
v_exp_f32 v31, v31
v_mfma_f32_16x16x32_bf16 v[164:167], a[36:39], v[52:55], v[164:167]
ds_read_b128 a[0:3], v1 offset:8192
v_cvt_pk_bf16_f32 v72, v24, v25
v_mfma_f32_16x16x32_bf16 v[168:171], a[40:43], v[52:55], v[168:171]
ds_read_b128 a[4:7], v1 offset:9216
v_cvt_pk_bf16_f32 v73, v26, v27
v_mfma_f32_16x16x32_bf16 v[200:203], a[40:43], v[56:59], v[200:203]
buffer_load_dwordx4 v12, s[72:75], 0 offen lds
v_mfma_f32_16x16x32_bf16 v[232:235], a[40:43], v[60:63], v[232:235]
ds_read_b128 a[8:11], v1 offset:10240
v_cvt_pk_bf16_f32 v76, v28, v29
v_mfma_f32_16x16x32_bf16 v[236:239], a[44:47], v[60:63], v[236:239]
v_exp_f32 v36, v36
v_mfma_f32_16x16x32_bf16 v[204:207], a[44:47], v[56:59], v[204:207]
v_exp_f32 v37, v37
v_mfma_f32_16x16x32_bf16 v[172:175], a[44:47], v[52:55], v[172:175]
ds_read_b128 a[12:15], v1 offset:11264
v_cvt_pk_bf16_f32 v77, v30, v31
v_mfma_f32_16x16x32_bf16 v[176:179], a[48:51], v[52:55], v[176:179]
buffer_load_dwordx4 v13, s[72:75], 0 offen offset:1024 lds
v_mfma_f32_16x16x32_bf16 v[208:211], a[48:51], v[56:59], v[208:211]
ds_read_b128 a[16:19], v1 offset:12288
v_cvt_pk_bf16_f32 v70, v36, v37
v_mfma_f32_16x16x32_bf16 v[240:243], a[48:51], v[60:63], v[240:243]
ds_read_b128 a[20:23], v1 offset:13312
v_exp_f32 v38, v38
v_mfma_f32_16x16x32_bf16 v[244:247], a[52:55], v[60:63], v[244:247]
ds_read_b128 a[24:27], v1 offset:14336
v_exp_f32 v39, v39
v_mfma_f32_16x16x32_bf16 v[212:215], a[52:55], v[56:59], v[212:215]
v_exp_f32 v40, v40
v_mfma_f32_16x16x32_bf16 v[180:183], a[52:55], v[52:55], v[180:183]
buffer_load_dwordx4 v12, s[72:75], s12 offen offset:2048 lds
v_mfma_f32_16x16x32_bf16 v[184:187], a[56:59], v[52:55], v[184:187]
ds_read_b128 a[28:31], v1 offset:15360
v_exp_f32 v41, v41
v_mfma_f32_16x16x32_bf16 v[216:219], a[56:59], v[56:59], v[216:219]
buffer_load_dwordx4 v13, s[72:75], s12 offen offset:3072 lds
v_mfma_f32_16x16x32_bf16 v[248:251], a[56:59], v[60:63], v[248:251]
s_add_u32 m0, s17, 0x14000
v_exp_f32 v42, v42
v_mfma_f32_16x16x32_bf16 v[252:255], a[60:63], v[60:63], v[252:255]
ds_read_b128 a[32:35], v1 offset:0
v_cvt_pk_bf16_f32 v71, v38, v39
v_mfma_f32_16x16x32_bf16 v[220:223], a[60:63], v[56:59], v[220:223]
ds_read_b128 a[36:39], v1 offset:1024
v_add_u32 v12, 0x20000, v12
v_mfma_f32_16x16x32_bf16 v[188:191], a[60:63], v[52:55], v[188:191]
buffer_load_dwordx4 v12, s[72:75], 0 offen lds
v_mfma_f32_16x16x32_bf16 a[224:227], a[236:239], v[52:55], a[224:227]
ds_read_b128 a[40:43], v1 offset:2048
v_exp_f32 v43, v43
v_smfmac_f32_16x16x64_bf16 a[228:231], a[232:235], v[56:63], v9
s_waitcnt lgkmcnt(7)
v_exp_f32 v44, v44
v_mfma_f32_16x16x32_bf16 v[24:27], a[0:3], a[192:195], v[112:115]
ds_read_b128 a[44:47], v1 offset:3072
v_exp_f32 v45, v45
v_mfma_f32_16x16x32_bf16 v[24:27], a[4:7], a[196:199], v[24:27]
ds_read_b128 a[48:51], v1 offset:4096
v_add_u32 v13, 0x20000, v13
v_mfma_f32_16x16x32_bf16 v[24:27], a[8:11], a[200:203], v[24:27]
v_exp_f32 v46, v46
v_mfma_f32_16x16x32_bf16 v[24:27], a[12:15], a[204:207], v[24:27]
buffer_load_dwordx4 v13, s[72:75], 0 offen offset:1024 lds
v_mfma_f32_16x16x32_bf16 v[28:31], a[0:3], a[208:211], v[92:95]
v_exp_f32 v47, v47
v_mfma_f32_16x16x32_bf16 v[28:31], a[4:7], a[212:215], v[28:31]
ds_read_b128 a[52:55], v1 offset:5120
v_cvt_pk_bf16_f32 v74, v40, v41
v_mfma_f32_16x16x32_bf16 v[28:31], a[8:11], a[216:219], v[28:31]
ds_read_b128 a[56:59], v1 offset:6144
v_cvt_pk_bf16_f32 v75, v42, v43
v_mfma_f32_16x16x32_bf16 v[28:31], a[12:15], a[220:223], v[28:31]
s_waitcnt lgkmcnt(7)
v_exp_f32 v24, v24
v_mfma_f32_16x16x32_bf16 v[40:43], a[16:19], a[192:195], v[116:119]
buffer_load_dwordx4 v12, s[72:75], s12 offen offset:2048 lds
v_mfma_f32_16x16x32_bf16 v[40:43], a[20:23], a[196:199], v[40:43]
ds_read_b128 a[60:63], v1 offset:7168
v_cvt_pk_bf16_f32 v78, v44, v45
v_mfma_f32_16x16x32_bf16 v[40:43], a[24:27], a[200:203], v[40:43]
v_exp_f32 v25, v25
v_mfma_f32_16x16x32_bf16 v[40:43], a[28:31], a[204:207], v[40:43]
buffer_load_dwordx4 v13, s[72:75], s12 offen offset:3072 lds
v_cvt_pk_bf16_f32 v79, v46, v47
v_mfma_f32_16x16x32_bf16 v[44:47], a[16:19], a[208:211], v[92:95]
v_exp_f32 v26, v26
v_mfma_f32_16x16x32_bf16 v[44:47], a[20:23], a[212:215], v[44:47]
v_exp_f32 v27, v27
v_mfma_f32_16x16x32_bf16 v[44:47], a[24:27], a[216:219], v[44:47]
v_exp_f32 v28, v28
v_mfma_f32_16x16x32_bf16 v[44:47], a[28:31], a[220:223], v[44:47]
s_waitcnt lgkmcnt(0)
v_exp_f32 v29, v29
v_mfma_f32_16x16x32_bf16 v[160:163], a[32:35], v[68:71], v[160:163]
ds_read_b128 a[0:3], v1 offset:24576
v_cvt_pk_bf16_f32 v56, v24, v25
v_mfma_f32_16x16x32_bf16 v[192:195], a[32:35], v[72:75], v[192:195]
ds_read_b128 a[4:7], v1 offset:25600
v_add_u32 v12, 0x20000, v12
v_mfma_f32_16x16x32_bf16 v[224:227], a[32:35], v[76:79], v[224:227]
s_add_u32 m0, s16, 0x0
v_exp_f32 v30, v30
v_mfma_f32_16x16x32_bf16 v[228:231], a[36:39], v[76:79], v[228:231]
buffer_load_dwordx4 v12, s[72:75], 0 offen lds
v_mfma_f32_16x16x32_bf16 v[196:199], a[36:39], v[72:75], v[196:199]
ds_read_b128 a[8:11], v1 offset:26624
v_add_u32 v13, 0x20000, v13
v_mfma_f32_16x16x32_bf16 v[164:167], a[36:39], v[68:71], v[164:167]
buffer_load_dwordx4 v13, s[72:75], 0 offen offset:1024 lds
v_mfma_f32_16x16x32_bf16 v[168:171], a[40:43], v[68:71], v[168:171]
ds_read_b128 a[12:15], v1 offset:27648
v_cvt_pk_bf16_f32 v57, v26, v27
v_mfma_f32_16x16x32_bf16 v[200:203], a[40:43], v[72:75], v[200:203]
v_exp_f32 v31, v31
v_mfma_f32_16x16x32_bf16 v[232:235], a[40:43], v[76:79], v[232:235]
ds_read_b128 a[16:19], v1 offset:28672
v_cvt_pk_bf16_f32 v60, v28, v29
v_mfma_f32_16x16x32_bf16 v[236:239], a[44:47], v[76:79], v[236:239]
buffer_load_dwordx4 v12, s[72:75], s12 offen offset:2048 lds
v_mfma_f32_16x16x32_bf16 v[204:207], a[44:47], v[72:75], v[204:207]
ds_read_b128 a[20:23], v1 offset:29696
v_cvt_pk_bf16_f32 v61, v30, v31
v_mfma_f32_16x16x32_bf16 v[172:175], a[44:47], v[68:71], v[172:175]
buffer_load_dwordx4 v13, s[72:75], s12 offen offset:3072 lds
v_mfma_f32_16x16x32_bf16 v[176:179], a[48:51], v[68:71], v[176:179]
ds_read_b128 a[24:27], v1 offset:30720
v_mfma_f32_16x16x32_bf16 v[208:211], a[48:51], v[72:75], v[208:211]
ds_read_b128 a[28:31], v1 offset:31744
v_mfma_f32_16x16x32_bf16 v[240:243], a[48:51], v[76:79], v[240:243]
v_exp_f32 v40, v40
v_mfma_f32_16x16x32_bf16 v[244:247], a[52:55], v[76:79], v[244:247]
s_add_u32 m0, s16, 0x4000
v_exp_f32 v41, v41
v_mfma_f32_16x16x32_bf16 v[212:215], a[52:55], v[72:75], v[212:215]
ds_read_b128 a[32:35], v1 offset:16384
v_cvt_pk_bf16_f32 v58, v40, v41
v_mfma_f32_16x16x32_bf16 v[180:183], a[52:55], v[68:71], v[180:183]
ds_read_b128 a[36:39], v1 offset:17408
v_add_u32 v12, 0x20000, v12
v_mfma_f32_16x16x32_bf16 v[184:187], a[56:59], v[68:71], v[184:187]
buffer_load_dwordx4 v12, s[72:75], 0 offen lds
v_mfma_f32_16x16x32_bf16 v[216:219], a[56:59], v[72:75], v[216:219]
ds_read_b128 a[40:43], v1 offset:18432
v_mfma_f32_16x16x32_bf16 v[248:251], a[56:59], v[76:79], v[248:251]
v_exp_f32 v42, v42
v_mfma_f32_16x16x32_bf16 v[252:255], a[60:63], v[76:79], v[252:255]
ds_read_b128 a[44:47], v1 offset:19456
v_add_u32 v13, 0x20000, v13
v_mfma_f32_16x16x32_bf16 v[220:223], a[60:63], v[72:75], v[220:223]
buffer_load_dwordx4 v13, s[72:75], 0 offen offset:1024 lds
v_mfma_f32_16x16x32_bf16 v[188:191], a[60:63], v[68:71], v[188:191]
ds_read_b128 a[48:51], v1 offset:20480
v_exp_f32 v43, v43
v_mfma_f32_16x16x32_bf16 a[224:227], a[236:239], v[68:71], a[224:227]
s_waitcnt lgkmcnt(9)
v_exp_f32 v44, v44
v_smfmac_f32_16x16x64_bf16 a[228:231], a[232:235], v[72:79], v9
ds_read_b128 a[52:55], v1 offset:21504
v_exp_f32 v45, v45
v_mfma_f32_16x16x32_bf16 v[28:31], a[0:3], a[208:211], v[92:95]
buffer_load_dwordx4 v12, s[72:75], s12 offen offset:2048 lds
v_mfma_f32_16x16x32_bf16 v[28:31], a[4:7], a[212:215], v[28:31]
ds_read_b128 a[56:59], v1 offset:22528
v_exp_f32 v46, v46
v_mfma_f32_16x16x32_bf16 v[28:31], a[8:11], a[216:219], v[28:31]
ds_read_b128 a[60:63], v1 offset:23552
v_xor_b32 v1, 0x8000, v1
v_mfma_f32_16x16x32_bf16 v[28:31], a[12:15], a[220:223], v[28:31]
s_waitcnt lgkmcnt(8)
v_exp_f32 v47, v47
v_cvt_pk_bf16_f32 v62, v44, v45
v_cvt_pk_bf16_f32 v63, v46, v47
v_mfma_f32_16x16x32_bf16 v[44:47], a[16:19], a[208:211], v[92:95]
buffer_load_dwordx4 v13, s[72:75], s12 offen offset:3072 lds
v_mfma_f32_16x16x32_bf16 v[44:47], a[20:23], a[212:215], v[44:47]
v_cvt_pk_bf16_f32 v59, v42, v43
v_mfma_f32_16x16x32_bf16 v[44:47], a[24:27], a[216:219], v[44:47]
v_mfma_f32_16x16x32_bf16 v[44:47], a[28:31], a[220:223], v[44:47]
v_accvgpr_read_b32 v6, a224
v_accvgpr_read_b32 v7, a225
v_add_f32 v6, v6, v7
v_cmp_nge_f32 vcc, 0x5f800000, v6
v_rcp_f32 v6, v6
s_or_b64 s[34:35], s[34:35], vcc
s_add_u32 s8, s28, 0x0
v_pk_mul_f32 v[128:129], v[128:129], v[6:7] op_sel_hi:[1,0]
v_pk_mul_f32 v[130:131], v[130:131], v[6:7] op_sel_hi:[1,0]
v_pk_mul_f32 v[132:133], v[132:133], v[6:7] op_sel_hi:[1,0]
v_pk_mul_f32 v[134:135], v[134:135], v[6:7] op_sel_hi:[1,0]
v_cvt_pk_bf16_f32 v128, v128, v129
v_cvt_pk_bf16_f32 v129, v130, v131
v_cvt_pk_bf16_f32 v130, v132, v133
v_cvt_pk_bf16_f32 v131, v134, v135
buffer_store_dwordx4 v[128:131], v3, s[88:91], s8 offen sc1
s_add_u32 s8, s28, 0x2000
v_pk_mul_f32 v[136:137], v[136:137], v[6:7] op_sel_hi:[1,0]
v_pk_mul_f32 v[138:139], v[138:139], v[6:7] op_sel_hi:[1,0]
v_pk_mul_f32 v[140:141], v[140:141], v[6:7] op_sel_hi:[1,0]
v_pk_mul_f32 v[142:143], v[142:143], v[6:7] op_sel_hi:[1,0]
v_cvt_pk_bf16_f32 v136, v136, v137
v_cvt_pk_bf16_f32 v137, v138, v139
v_cvt_pk_bf16_f32 v138, v140, v141
v_cvt_pk_bf16_f32 v139, v142, v143
buffer_store_dwordx4 v[136:139], v3, s[88:91], s8 offen sc1
s_add_u32 s8, s28, 0x4000
v_pk_mul_f32 v[144:145], v[144:145], v[6:7] op_sel_hi:[1,0]
v_pk_mul_f32 v[146:147], v[146:147], v[6:7] op_sel_hi:[1,0]
v_pk_mul_f32 v[148:149], v[148:149], v[6:7] op_sel_hi:[1,0]
v_pk_mul_f32 v[150:151], v[150:151], v[6:7] op_sel_hi:[1,0]
v_cvt_pk_bf16_f32 v144, v144, v145
v_cvt_pk_bf16_f32 v145, v146, v147
v_cvt_pk_bf16_f32 v146, v148, v149
v_cvt_pk_bf16_f32 v147, v150, v151
buffer_store_dwordx4 v[144:147], v3, s[88:91], s8 offen sc1
s_add_u32 s8, s28, 0x6000
v_pk_mul_f32 v[152:153], v[152:153], v[6:7] op_sel_hi:[1,0]
v_pk_mul_f32 v[154:155], v[154:155], v[6:7] op_sel_hi:[1,0]
v_pk_mul_f32 v[156:157], v[156:157], v[6:7] op_sel_hi:[1,0]
v_pk_mul_f32 v[158:159], v[158:159], v[6:7] op_sel_hi:[1,0]
v_cvt_pk_bf16_f32 v152, v152, v153
v_cvt_pk_bf16_f32 v153, v154, v155
v_cvt_pk_bf16_f32 v154, v156, v157
v_cvt_pk_bf16_f32 v155, v158, v159
buffer_store_dwordx4 v[152:155], v3, s[88:91], s8 offen sc1
v_accvgpr_read_b32 v6, a226
v_accvgpr_read_b32 v7, a227
v_add_f32 v6, v6, v7
v_cmp_nge_f32 vcc, 0x5f800000, v6
v_rcp_f32 v6, v6
s_or_b64 s[34:35], s[34:35], vcc
s_add_u32 s8, s29, 0x0
v_pk_mul_f32 v[160:161], v[160:161], v[6:7] op_sel_hi:[1,0]
v_pk_mul_f32 v[162:163], v[162:163], v[6:7] op_sel_hi:[1,0]
v_pk_mul_f32 v[164:165], v[164:165], v[6:7] op_sel_hi:[1,0]
v_pk_mul_f32 v[166:167], v[166:167], v[6:7] op_sel_hi:[1,0]
v_cvt_pk_bf16_f32 v160, v160, v161
v_cvt_pk_bf16_f32 v161, v162, v163
v_cvt_pk_bf16_f32 v162, v164, v165
v_cvt_pk_bf16_f32 v163, v166, v167
buffer_store_dwordx4 v[160:163], v3, s[88:91], s8 offen sc1
s_add_u32 s8, s29, 0x2000
v_pk_mul_f32 v[168:169], v[168:169], v[6:7] op_sel_hi:[1,0]
v_pk_mul_f32 v[170:171], v[170:171], v[6:7] op_sel_hi:[1,0]
v_pk_mul_f32 v[172:173], v[172:173], v[6:7] op_sel_hi:[1,0]
v_pk_mul_f32 v[174:175], v[174:175], v[6:7] op_sel_hi:[1,0]
v_cvt_pk_bf16_f32 v168, v168, v169
v_cvt_pk_bf16_f32 v169, v170, v171
v_cvt_pk_bf16_f32 v170, v172, v173
v_cvt_pk_bf16_f32 v171, v174, v175
buffer_store_dwordx4 v[168:171], v3, s[88:91], s8 offen sc1
s_add_u32 s8, s29, 0x4000
v_pk_mul_f32 v[176:177], v[176:177], v[6:7] op_sel_hi:[1,0]
v_pk_mul_f32 v[178:179], v[178:179], v[6:7] op_sel_hi:[1,0]
v_pk_mul_f32 v[180:181], v[180:181], v[6:7] op_sel_hi:[1,0]
v_pk_mul_f32 v[182:183], v[182:183], v[6:7] op_sel_hi:[1,0]
v_cvt_pk_bf16_f32 v176, v176, v177
v_cvt_pk_bf16_f32 v177, v178, v179
v_cvt_pk_bf16_f32 v178, v180, v181
v_cvt_pk_bf16_f32 v179, v182, v183
buffer_store_dwordx4 v[176:179], v3, s[88:91], s8 offen sc1
s_add_u32 s8, s29, 0x6000
v_pk_mul_f32 v[184:185], v[184:185], v[6:7] op_sel_hi:[1,0]
v_pk_mul_f32 v[186:187], v[186:187], v[6:7] op_sel_hi:[1,0]
v_pk_mul_f32 v[188:189], v[188:189], v[6:7] op_sel_hi:[1,0]
v_pk_mul_f32 v[190:191], v[190:191], v[6:7] op_sel_hi:[1,0]
v_cvt_pk_bf16_f32 v184, v184, v185
v_cvt_pk_bf16_f32 v185, v186, v187
v_cvt_pk_bf16_f32 v186, v188, v189
v_cvt_pk_bf16_f32 v187, v190, v191
buffer_store_dwordx4 v[184:187], v3, s[88:91], s8 offen sc1
s_branch L_att_h1_0
L_att_dl0_1:
v_mfma_f32_16x16x32_bf16 v[128:131], a[32:35], v[48:51], v[128:131]
ds_read_b128 a[0:3], v1 offset:8192
v_cvt_pk_bf16_f32 v72, v24, v25
v_mfma_f32_16x16x32_bf16 v[160:163], a[32:35], v[52:55], v[160:163]
v_exp_f32 v28, v28
v_mfma_f32_16x16x32_bf16 v[192:195], a[32:35], v[56:59], v[192:195]
v_cvt_pk_bf16_f32 v73, v26, v27
v_mfma_f32_16x16x32_bf16 v[224:227], a[32:35], v[60:63], v[224:227]
ds_read_b128 a[4:7], v1 offset:9216
v_mfma_f32_16x16x32_bf16 v[228:231], a[36:39], v[60:63], v[228:231]
s_add_u32 m0, s27, 0x0
v_exp_f32 v29, v29
v_mfma_f32_16x16x32_bf16 v[196:199], a[36:39], v[56:59], v[196:199]
buffer_load_dwordx4 v3, s[48:51], s32 offen offset:0 sc1 lds
v_mfma_f32_16x16x32_bf16 v[164:167], a[36:39], v[52:55], v[164:167]
v_exp_f32 v30, v30
v_mfma_f32_16x16x32_bf16 v[132:135], a[36:39], v[48:51], v[132:135]
ds_read_b128 a[8:11], v1 offset:10240
v_cvt_pk_bf16_f32 v76, v28, v29
v_mfma_f32_16x16x32_bf16 v[136:139], a[40:43], v[48:51], v[136:139]
v_mfma_f32_16x16x32_bf16 v[168:171], a[40:43], v[52:55], v[168:171]
v_exp_f32 v31, v31
v_mfma_f32_16x16x32_bf16 v[200:203], a[40:43], v[56:59], v[200:203]
v_exp_f32 v32, v32
v_mfma_f32_16x16x32_bf16 v[232:235], a[40:43], v[60:63], v[232:235]
ds_read_b128 a[12:15], v1 offset:11264
v_cvt_pk_bf16_f32 v77, v30, v31
v_mfma_f32_16x16x32_bf16 v[236:239], a[44:47], v[60:63], v[236:239]
v_exp_f32 v33, v33
v_mfma_f32_16x16x32_bf16 v[204:207], a[44:47], v[56:59], v[204:207]
v_cvt_pk_bf16_f32 v66, v32, v33
v_mfma_f32_16x16x32_bf16 v[172:175], a[44:47], v[52:55], v[172:175]
s_mov_b32 s9, 0x0
v_exp_f32 v34, v34
v_mfma_f32_16x16x32_bf16 v[140:143], a[44:47], v[48:51], v[140:143]
ds_read_b128 a[16:19], v1 offset:12288
v_mfma_f32_16x16x32_bf16 v[144:147], a[48:51], v[48:51], v[144:147]
buffer_load_dword a244, v8, s[72:75], s9 offen
v_mfma_f32_16x16x32_bf16 v[176:179], a[48:51], v[52:55], v[176:179]
v_exp_f32 v35, v35
v_mfma_f32_16x16x32_bf16 v[208:211], a[48:51], v[56:59], v[208:211]
v_exp_f32 v36, v36
v_mfma_f32_16x16x32_bf16 v[240:243], a[48:51], v[60:63], v[240:243]
ds_read_b128 a[20:23], v1 offset:13312
v_cvt_pk_bf16_f32 v67, v34, v35
v_mfma_f32_16x16x32_bf16 v[244:247], a[52:55], v[60:63], v[244:247]
v_mfma_f32_16x16x32_bf16 v[212:215], a[52:55], v[56:59], v[212:215]
v_exp_f32 v37, v37
v_mfma_f32_16x16x32_bf16 v[180:183], a[52:55], v[52:55], v[180:183]
ds_read_b128 a[24:27], v1 offset:14336
v_cvt_pk_bf16_f32 v70, v36, v37
v_mfma_f32_16x16x32_bf16 v[148:151], a[52:55], v[48:51], v[148:151]
v_exp_f32 v38, v38
v_mfma_f32_16x16x32_bf16 v[152:155], a[56:59], v[48:51], v[152:155]
v_mfma_f32_16x16x32_bf16 v[184:187], a[56:59], v[52:55], v[184:187]
v_exp_f32 v39, v39
v_mfma_f32_16x16x32_bf16 v[216:219], a[56:59], v[56:59], v[216:219]
buffer_load_dwordx4 v3, s[48:51], s32 offen offset:1024 sc1 lds
v_mfma_f32_16x16x32_bf16 v[248:251], a[56:59], v[60:63], v[248:251]
ds_read_b128 a[28:31], v1 offset:15360
v_cvt_pk_bf16_f32 v71, v38, v39
v_mfma_f32_16x16x32_bf16 v[252:255], a[60:63], v[60:63], v[252:255]
v_exp_f32 v40, v40
v_mfma_f32_16x16x32_bf16 v[220:223], a[60:63], v[56:59], v[220:223]
v_exp_f32 v41, v41
v_mfma_f32_16x16x32_bf16 v[188:191], a[60:63], v[52:55], v[188:191]
ds_read_b128 a[32:35], v1 offset:0
v_cvt_pk_bf16_f32 v74, v40, v41
v_mfma_f32_16x16x32_bf16 v[156:159], a[60:63], v[48:51], v[156:159]
v_smfmac_f32_16x16x64_bf16 a[224:227], a[232:235], v[48:55], v9
v_exp_f32 v42, v42
v_smfmac_f32_16x16x64_bf16 a[228:231], a[232:235], v[56:63], v9
s_waitcnt lgkmcnt(5)
v_exp_f32 v43, v43
v_mfma_f32_16x16x32_bf16 v[16:19], a[0:3], a[160:163], v[80:83]
ds_read_b128 a[36:39], v1 offset:1024
v_cvt_pk_bf16_f32 v75, v42, v43
v_mfma_f32_16x16x32_bf16 v[16:19], a[4:7], a[164:167], v[16:19]
v_exp_f32 v44, v44
v_mfma_f32_16x16x32_bf16 v[16:19], a[8:11], a[168:171], v[16:19]
v_mfma_f32_16x16x32_bf16 v[16:19], a[12:15], a[172:175], v[16:19]
buffer_load_dwordx4 v3, s[48:51], s32 offen offset:2048 sc1 lds
v_mfma_f32_16x16x32_bf16 v[20:23], a[0:3], a[176:179], v[84:87]
ds_read_b128 a[40:43], v1 offset:2048
v_mfma_f32_16x16x32_bf16 v[20:23], a[4:7], a[180:183], v[20:23]
v_exp_f32 v45, v45
v_mfma_f32_16x16x32_bf16 v[20:23], a[8:11], a[184:187], v[20:23]
v_exp_f32 v46, v46
v_mfma_f32_16x16x32_bf16 v[20:23], a[12:15], a[188:191], v[20:23]
ds_read_b128 a[44:47], v1 offset:3072
v_cvt_pk_bf16_f32 v78, v44, v45
v_mfma_f32_16x16x32_bf16 v[24:27], a[0:3], a[192:195], v[88:91]
v_mfma_f32_16x16x32_bf16 v[24:27], a[4:7], a[196:199], v[24:27]
v_exp_f32 v47, v47
v_mfma_f32_16x16x32_bf16 v[24:27], a[8:11], a[200:203], v[24:27]
v_exp_f32 v16, v16
v_mfma_f32_16x16x32_bf16 v[24:27], a[12:15], a[204:207], v[24:27]
ds_read_b128 a[48:51], v1 offset:4096
v_cvt_pk_bf16_f32 v79, v46, v47
v_mfma_f32_16x16x32_bf16 v[28:31], a[0:3], a[208:211], v[92:95]
v_exp_f32 v17, v17
v_mfma_f32_16x16x32_bf16 v[28:31], a[4:7], a[212:215], v[28:31]
s_waitcnt lgkmcnt(5)
v_cvt_pk_bf16_f32 v48, v16, v17
v_mfma_f32_16x16x32_bf16 v[28:31], a[8:11], a[216:219], v[28:31]
buffer_load_dwordx4 v3, s[48:51], s32 offen offset:3072 sc1 lds
v_mfma_f32_16x16x32_bf16 v[28:31], a[12:15], a[220:223], v[28:31]
ds_read_b128 a[52:55], v1 offset:5120
v_mfma_f32_16x16x32_bf16 v[32:35], a[16:19], a[160:163], v[80:83]
v_exp_f32 v18, v18
v_mfma_f32_16x16x32_bf16 v[32:35], a[20:23], a[164:167], v[32:35]
v_exp_f32 v19, v19
v_mfma_f32_16x16x32_bf16 v[32:35], a[24:27], a[168:171], v[32:35]
v_exp_f32 v20, v20
v_mfma_f32_16x16x32_bf16 v[32:35], a[28:31], a[172:175], v[32:35]
ds_read_b128 a[56:59], v1 offset:6144
v_cvt_pk_bf16_f32 v49, v18, v19
v_mfma_f32_16x16x32_bf16 v[36:39], a[16:19], a[176:179], v[84:87]
v_mfma_f32_16x16x32_bf16 v[36:39], a[20:23], a[180:183], v[36:39]
v_exp_f32 v21, v21
v_mfma_f32_16x16x32_bf16 v[36:39], a[24:27], a[184:187], v[36:39]
s_mov_b32 s9, 0x0
v_exp_f32 v22, v22
v_mfma_f32_16x16x32_bf16 v[36:39], a[28:31], a[188:191], v[36:39]
ds_read_b128 a[60:63], v1 offset:7168
v_cvt_pk_bf16_f32 v52, v20, v21
v_mfma_f32_16x16x32_bf16 v[40:43], a[16:19], a[192:195], v[88:91]
buffer_load_dword a244, v8, s[64:67], s9 offen
v_mfma_f32_16x16x32_bf16 v[40:43], a[20:23], a[196:199], v[40:43]
v_mfma_f32_16x16x32_bf16 v[40:43], a[24:27], a[200:203], v[40:43]
v_exp_f32 v23, v23
v_mfma_f32_16x16x32_bf16 v[40:43], a[28:31], a[204:207], v[40:43]
v_exp_f32 v24, v24
v_mfma_f32_16x16x32_bf16 v[44:47], a[16:19], a[208:211], v[92:95]
v_exp_f32 v25, v25
v_mfma_f32_16x16x32_bf16 v[44:47], a[20:23], a[212:215], v[44:47]
v_exp_f32 v26, v26
v_mfma_f32_16x16x32_bf16 v[44:47], a[24:27], a[216:219], v[44:47]
v_exp_f32 v27, v27
v_mfma_f32_16x16x32_bf16 v[44:47], a[28:31], a[220:223], v[44:47]
s_waitcnt lgkmcnt(0)
v_cvt_pk_bf16_f32 v53, v22, v23
v_mfma_f32_16x16x32_bf16 v[128:131], a[32:35], v[64:67], v[128:131]
ds_read_b128 a[0:3], v1 offset:24576
v_cvt_pk_bf16_f32 v56, v24, v25
v_mfma_f32_16x16x32_bf16 v[160:163], a[32:35], v[68:71], v[160:163]
v_exp_f32 v28, v28
v_mfma_f32_16x16x32_bf16 v[192:195], a[32:35], v[72:75], v[192:195]
v_cvt_pk_bf16_f32 v57, v26, v27
v_mfma_f32_16x16x32_bf16 v[224:227], a[32:35], v[76:79], v[224:227]
ds_read_b128 a[4:7], v1 offset:25600
v_mfma_f32_16x16x32_bf16 v[228:231], a[36:39], v[76:79], v[228:231]
v_exp_f32 v29, v29
v_mfma_f32_16x16x32_bf16 v[196:199], a[36:39], v[72:75], v[196:199]
s_add_u32 m0, s27, 0x1000
v_exp_f32 v30, v30
v_mfma_f32_16x16x32_bf16 v[164:167], a[36:39], v[68:71], v[164:167]
buffer_load_dwordx4 v3, s[48:51], s7 offen offset:0 sc1 lds
v_mfma_f32_16x16x32_bf16 v[132:135], a[36:39], v[64:67], v[132:135]
ds_read_b128 a[8:11], v1 offset:26624
v_cvt_pk_bf16_f32 v60, v28, v29
v_mfma_f32_16x16x32_bf16 v[136:139], a[40:43], v[64:67], v[136:139]
v_mfma_f32_16x16x32_bf16 v[168:171], a[40:43], v[68:71], v[168:171]
v_exp_f32 v31, v31
v_mfma_f32_16x16x32_bf16 v[200:203], a[40:43], v[72:75], v[200:203]
v_exp_f32 v32, v32
v_mfma_f32_16x16x32_bf16 v[232:235], a[40:43], v[76:79], v[232:235]
ds_read_b128 a[12:15], v1 offset:27648
v_cvt_pk_bf16_f32 v61, v30, v31
v_mfma_f32_16x16x32_bf16 v[236:239], a[44:47], v[76:79], v[236:239]
v_mfma_f32_16x16x32_bf16 v[204:207], a[44:47], v[72:75], v[204:207]
v_exp_f32 v33, v33
v_mfma_f32_16x16x32_bf16 v[172:175], a[44:47], v[68:71], v[172:175]
v_exp_f32 v34, v34
v_mfma_f32_16x16x32_bf16 v[140:143], a[44:47], v[64:67], v[140:143]
ds_read_b128 a[16:19], v1 offset:28672
v_cvt_pk_bf16_f32 v50, v32, v33
v_mfma_f32_16x16x32_bf16 v[144:147], a[48:51], v[64:67], v[144:147]
v_exp_f32 v35, v35
v_mfma_f32_16x16x32_bf16 v[176:179], a[48:51], v[68:71], v[176:179]
v_cvt_pk_bf16_f32 v51, v34, v35
v_mfma_f32_16x16x32_bf16 v[208:211], a[48:51], v[72:75], v[208:211]
buffer_load_dwordx4 v3, s[48:51], s7 offen offset:1024 sc1 lds
v_mfma_f32_16x16x32_bf16 v[240:243], a[48:51], v[76:79], v[240:243]
ds_read_b128 a[20:23], v1 offset:29696
v_mfma_f32_16x16x32_bf16 v[244:247], a[52:55], v[76:79], v[244:247]
v_exp_f32 v36, v36
v_mfma_f32_16x16x32_bf16 v[212:215], a[52:55], v[72:75], v[212:215]
v_exp_f32 v37, v37
v_mfma_f32_16x16x32_bf16 v[180:183], a[52:55], v[68:71], v[180:183]
ds_read_b128 a[24:27], v1 offset:30720
v_cvt_pk_bf16_f32 v54, v36, v37
v_mfma_f32_16x16x32_bf16 v[148:151], a[52:55], v[64:67], v[148:151]
v_mfma_f32_16x16x32_bf16 v[152:155], a[56:59], v[64:67], v[152:155]
v_exp_f32 v38, v38
v_mfma_f32_16x16x32_bf16 v[184:187], a[56:59], v[68:71], v[184:187]
v_exp_f32 v39, v39
v_mfma_f32_16x16x32_bf16 v[216:219], a[56:59], v[72:75], v[216:219]
ds_read_b128 a[28:31], v1 offset:31744
v_cvt_pk_bf16_f32 v55, v38, v39
v_mfma_f32_16x16x32_bf16 v[248:251], a[56:59], v[76:79], v[248:251]
v_exp_f32 v40, v40
v_mfma_f32_16x16x32_bf16 v[252:255], a[60:63], v[76:79], v[252:255]
v_mfma_f32_16x16x32_bf16 v[220:223], a[60:63], v[72:75], v[220:223]
v_exp_f32 v41, v41
v_mfma_f32_16x16x32_bf16 v[188:191], a[60:63], v[68:71], v[188:191]
buffer_load_dwordx4 v3, s[48:51], s7 offen offset:2048 sc1 lds
v_mfma_f32_16x16x32_bf16 v[156:159], a[60:63], v[64:67], v[156:159]
ds_read_b128 a[32:35], v1 offset:16384
v_cvt_pk_bf16_f32 v58, v40, v41
v_smfmac_f32_16x16x64_bf16 a[224:227], a[232:235], v[64:71], v9
s_waitcnt lgkmcnt(5)
v_exp_f32 v42, v42
v_smfmac_f32_16x16x64_bf16 a[228:231], a[232:235], v[72:79], v9
ds_read_b128 a[36:39], v1 offset:17408
v_mfma_f32_16x16x32_bf16 v[16:19], a[0:3], a[160:163], v[96:99]
v_mfma_f32_16x16x32_bf16 v[16:19], a[4:7], a[164:167], v[16:19]
v_exp_f32 v43, v43
v_mfma_f32_16x16x32_bf16 v[16:19], a[8:11], a[168:171], v[16:19]
v_exp_f32 v44, v44
v_mfma_f32_16x16x32_bf16 v[16:19], a[12:15], a[172:175], v[16:19]
ds_read_b128 a[40:43], v1 offset:18432
v_cvt_pk_bf16_f32 v59, v42, v43
v_mfma_f32_16x16x32_bf16 v[20:23], a[0:3], a[176:179], v[84:87]
v_exp_f32 v45, v45
v_mfma_f32_16x16x32_bf16 v[20:23], a[4:7], a[180:183], v[20:23]
v_cvt_pk_bf16_f32 v62, v44, v45
v_mfma_f32_16x16x32_bf16 v[20:23], a[8:11], a[184:187], v[20:23]
s_mov_b32 s9, 0x400000
v_exp_f32 v46, v46
v_mfma_f32_16x16x32_bf16 v[20:23], a[12:15], a[188:191], v[20:23]
ds_read_b128 a[44:47], v1 offset:19456
v_mfma_f32_16x16x32_bf16 v[24:27], a[0:3], a[192:195], v[88:91]
buffer_load_dword a244, v8, s[64:67], s9 offen
v_mfma_f32_16x16x32_bf16 v[24:27], a[4:7], a[196:199], v[24:27]
v_exp_f32 v47, v47
v_mfma_f32_16x16x32_bf16 v[24:27], a[8:11], a[200:203], v[24:27]
v_cvt_pk_bf16_f32 v63, v46, v47
v_mfma_f32_16x16x32_bf16 v[24:27], a[12:15], a[204:207], v[24:27]
ds_read_b128 a[48:51], v1 offset:20480
v_mfma_f32_16x16x32_bf16 v[28:31], a[0:3], a[208:211], v[92:95]
v_exp_f32 v16, v16
v_mfma_f32_16x16x32_bf16 v[28:31], a[4:7], a[212:215], v[28:31]
v_exp_f32 v17, v17
v_mfma_f32_16x16x32_bf16 v[28:31], a[8:11], a[216:219], v[28:31]
ds_read_b128 a[52:55], v1 offset:21504
v_cvt_pk_bf16_f32 v64, v16, v17
v_mfma_f32_16x16x32_bf16 v[28:31], a[12:15], a[220:223], v[28:31]
s_waitcnt lgkmcnt(6)
v_exp_f32 v18, v18
v_mfma_f32_16x16x32_bf16 v[32:35], a[16:19], a[160:163], v[100:103]
v_mfma_f32_16x16x32_bf16 v[32:35], a[20:23], a[164:167], v[32:35]
v_exp_f32 v19, v19
v_mfma_f32_16x16x32_bf16 v[32:35], a[24:27], a[168:171], v[32:35]
ds_read_b128 a[56:59], v1 offset:22528
v_cvt_pk_bf16_f32 v65, v18, v19
v_mfma_f32_16x16x32_bf16 v[32:35], a[28:31], a[172:175], v[32:35]
v_exp_f32 v20, v20
v_mfma_f32_16x16x32_bf16 v[36:39], a[16:19], a[176:179], v[84:87]
buffer_load_dwordx4 v3, s[48:51], s7 offen offset:3072 sc1 lds
v_mfma_f32_16x16x32_bf16 v[36:39], a[20:23], a[180:183], v[36:39]
s_add_u32 s32, s32, 0x8000
v_mfma_f32_16x16x32_bf16 v[36:39], a[24:27], a[184:187], v[36:39]
ds_read_b128 a[60:63], v1 offset:23552
v_xor_b32 v1, 0x8000, v1
v_mfma_f32_16x16x32_bf16 v[36:39], a[28:31], a[188:191], v[36:39]
s_add_u32 s7, s7, 0x8000
v_exp_f32 v21, v21
v_mfma_f32_16x16x32_bf16 v[40:43], a[16:19], a[192:195], v[88:91]
s_xor_b32 s27, s27, 0x38000
v_exp_f32 v22, v22
v_mfma_f32_16x16x32_bf16 v[40:43], a[20:23], a[196:199], v[40:43]
v_exp_f32 v23, v23
v_mfma_f32_16x16x32_bf16 v[40:43], a[24:27], a[200:203], v[40:43]
v_cvt_pk_bf16_f32 v68, v20, v21
v_cvt_pk_bf16_f32 v69, v22, v23
v_mfma_f32_16x16x32_bf16 v[40:43], a[28:31], a[204:207], v[40:43]
v_exp_f32 v24, v24
v_mfma_f32_16x16x32_bf16 v[44:47], a[16:19], a[208:211], v[92:95]
v_exp_f32 v25, v25
v_mfma_f32_16x16x32_bf16 v[44:47], a[20:23], a[212:215], v[44:47]
v_exp_f32 v26, v26
v_mfma_f32_16x16x32_bf16 v[44:47], a[24:27], a[216:219], v[44:47]
s_waitcnt vmcnt(19) lgkmcnt(0)
v_exp_f32 v27, v27
v_mfma_f32_16x16x32_bf16 v[44:47], a[28:31], a[220:223], v[44:47]
s_barrier
L_att_l1_1:
v_mfma_f32_16x16x32_bf16 v[128:131], a[32:35], v[48:51], v[128:131]
ds_read_b128 a[0:3], v2 offset:8192
v_cvt_pk_bf16_f32 v72, v24, v25
v_mfma_f32_16x16x32_bf16 v[160:163], a[32:35], v[52:55], v[160:163]
s_lshr_b32 s44, s2, 6
v_exp_f32 v28, v28
v_mfma_f32_16x16x32_bf16 v[192:195], a[32:35], v[56:59], v[192:195]
s_add_u32 m0, s19, 0x0
s_lshl_b32 s45, s44, 1
v_cvt_pk_bf16_f32 v73, v26, v27
v_mfma_f32_16x16x32_bf16 v[224:227], a[32:35], v[60:63], v[224:227]
ds_read_b128 a[4:7], v2 offset:9216
s_add_u32 s45, s45, s100
v_mfma_f32_16x16x32_bf16 v[228:231], a[36:39], v[60:63], v[228:231]
buffer_load_dwordx4 v3, s[48:51], s32 offen offset:0 sc1 lds
v_mfma_f32_16x16x32_bf16 v[196:199], a[36:39], v[56:59], v[196:199]
s_and_b32 s60, s45, 3
v_exp_f32 v29, v29
v_mfma_f32_16x16x32_bf16 v[164:167], a[36:39], v[52:55], v[164:167]
ds_read_b128 a[8:11], v2 offset:10240
v_cvt_pk_bf16_f32 v76, v28, v29
v_mfma_f32_16x16x32_bf16 v[132:135], a[36:39], v[48:51], v[132:135]
s_sub_u32 s60, s60, s44
v_exp_f32 v30, v30
v_mfma_f32_16x16x32_bf16 v[136:139], a[40:43], v[48:51], v[136:139]
s_lshl_b32 s60, s60, 14
v_exp_f32 v31, v31
v_mfma_f32_16x16x32_bf16 v[168:171], a[40:43], v[52:55], v[168:171]
ds_read_b128 a[12:15], v2 offset:11264
v_cvt_pk_bf16_f32 v77, v30, v31
v_mfma_f32_16x16x32_bf16 v[200:203], a[40:43], v[56:59], v[200:203]
s_and_b32 s60, s60, 0x7c000
s_lshl_b32 s61, s60, 3
s_add_u32 s62, s61, s12
v_mfma_f32_16x16x32_bf16 v[232:235], a[40:43], v[60:63], v[232:235]
s_mul_i32 s44, s44, -8
v_exp_f32 v32, v32
v_mfma_f32_16x16x32_bf16 v[236:239], a[44:47], v[60:63], v[236:239]
s_mov_b32 s9, 0x200000
v_exp_f32 v33, v33
v_mfma_f32_16x16x32_bf16 v[204:207], a[44:47], v[56:59], v[204:207]
ds_read_b128 a[16:19], v2 offset:12288
v_cvt_pk_bf16_f32 v66, v32, v33
v_mfma_f32_16x16x32_bf16 v[172:175], a[44:47], v[52:55], v[172:175]
buffer_load_dword a244, v8, s[64:67], s9 offen
v_mfma_f32_16x16x32_bf16 v[140:143], a[44:47], v[48:51], v[140:143]
s_lshl_b32 s44, 4, s44
v_exp_f32 v34, v34
v_mfma_f32_16x16x32_bf16 v[144:147], a[48:51], v[48:51], v[144:147]
ds_read_b128 a[20:23], v2 offset:13312
s_mul_i32 s45, s45, -8
v_mfma_f32_16x16x32_bf16 v[176:179], a[48:51], v[52:55], v[176:179]
s_lshl_b32 s45, 4, s45
v_exp_f32 v35, v35
v_mfma_f32_16x16x32_bf16 v[208:211], a[48:51], v[56:59], v[208:211]
s_add_u32 s44, s44, 0x21212121
s_sub_u32 s44, s44, s45
v_cvt_pk_bf16_f32 v67, v34, v35
v_mfma_f32_16x16x32_bf16 v[240:243], a[48:51], v[60:63], v[240:243]
ds_read_b128 a[24:27], v2 offset:14336
s_bfe_u32 s56, s44, 0x80000
v_mfma_f32_16x16x32_bf16 v[244:247], a[52:55], v[60:63], v[244:247]
s_lshl_b32 s56, s56, 14
v_exp_f32 v36, v36
v_mfma_f32_16x16x32_bf16 v[212:215], a[52:55], v[56:59], v[212:215]
s_bfe_u32 s57, s44, 0x80008
v_exp_f32 v37, v37
v_mfma_f32_16x16x32_bf16 v[180:183], a[52:55], v[52:55], v[180:183]
s_lshl_b32 s57, s57, 14
v_exp_f32 v38, v38
v_mfma_f32_16x16x32_bf16 v[148:151], a[52:55], v[48:51], v[148:151]
buffer_load_dwordx4 v3, s[48:51], s32 offen offset:1024 sc1 lds
v_mfma_f32_16x16x32_bf16 v[152:155], a[56:59], v[48:51], v[152:155]
ds_read_b128 a[28:31], v2 offset:15360
v_cvt_pk_bf16_f32 v70, v36, v37
v_mfma_f32_16x16x32_bf16 v[184:187], a[56:59], v[52:55], v[184:187]
s_bfe_u32 s58, s44, 0x80010
s_lshl_b32 s58, s58, 14
s_bfe_u32 s59, s44, 0x80018
v_mfma_f32_16x16x32_bf16 v[216:219], a[56:59], v[56:59], v[216:219]
ds_read_b128 a[32:35], v2 offset:0
s_lshl_b32 s59, s59, 14
v_mfma_f32_16x16x32_bf16 v[248:251], a[56:59], v[60:63], v[248:251]
v_exp_f32 v39, v39
v_mfma_f32_16x16x32_bf16 v[252:255], a[60:63], v[60:63], v[252:255]
v_exp_f32 v40, v40
v_mfma_f32_16x16x32_bf16 v[220:223], a[60:63], v[56:59], v[220:223]
ds_read_b128 a[36:39], v2 offset:1024
v_cvt_pk_bf16_f32 v71, v38, v39
v_mfma_f32_16x16x32_bf16 v[188:191], a[60:63], v[52:55], v[188:191]
v_exp_f32 v41, v41
v_mfma_f32_16x16x32_bf16 v[156:159], a[60:63], v[48:51], v[156:159]
s_waitcnt lgkmcnt(6)
v_exp_f32 v42, v42
v_smfmac_f32_16x16x64_bf16 a[224:227], a[232:235], v[48:55], v9
buffer_load_dwordx4 v3, s[48:51], s32 offen offset:2048 sc1 lds
v_smfmac_f32_16x16x64_bf16 a[228:231], a[232:235], v[56:63], v9
ds_read_b128 a[40:43], v2 offset:2048
v_cvt_pk_bf16_f32 v74, v40, v41
v_mfma_f32_16x16x32_bf16 v[20:23], a[0:3], a[176:179], v[104:107]
v_mfma_f32_16x16x32_bf16 v[20:23], a[4:7], a[180:183], v[20:23]
v_exp_f32 v43, v43
v_mfma_f32_16x16x32_bf16 v[20:23], a[8:11], a[184:187], v[20:23]
ds_read_b128 a[44:47], v2 offset:3072
v_cvt_pk_bf16_f32 v75, v42, v43
v_mfma_f32_16x16x32_bf16 v[20:23], a[12:15], a[188:191], v[20:23]
v_exp_f32 v44, v44
v_mfma_f32_16x16x32_bf16 v[24:27], a[0:3], a[192:195], v[88:91]
v_exp_f32 v45, v45
v_mfma_f32_16x16x32_bf16 v[24:27], a[4:7], a[196:199], v[24:27]
ds_read_b128 a[48:51], v2 offset:4096
v_cvt_pk_bf16_f32 v78, v44, v45
v_mfma_f32_16x16x32_bf16 v[24:27], a[8:11], a[200:203], v[24:27]
v_mfma_f32_16x16x32_bf16 v[24:27], a[12:15], a[204:207], v[24:27]
v_exp_f32 v46, v46
v_mfma_f32_16x16x32_bf16 v[28:31], a[0:3], a[208:211], v[92:95]
buffer_load_dwordx4 v3, s[48:51], s32 offen offset:3072 sc1 lds
v_mfma_f32_16x16x32_bf16 v[28:31], a[4:7], a[212:215], v[28:31]
ds_read_b128 a[52:55], v2 offset:5120
v_mfma_f32_16x16x32_bf16 v[28:31], a[8:11], a[216:219], v[28:31]
v_exp_f32 v47, v47
v_mfma_f32_16x16x32_bf16 v[28:31], a[12:15], a[220:223], v[28:31]
s_waitcnt lgkmcnt(6)
v_exp_f32 v20, v20
v_mfma_f32_16x16x32_bf16 v[36:39], a[16:19], a[176:179], v[108:111]
ds_read_b128 a[56:59], v2 offset:6144
v_cvt_pk_bf16_f32 v79, v46, v47
v_mfma_f32_16x16x32_bf16 v[36:39], a[20:23], a[180:183], v[36:39]
v_exp_f32 v21, v21
v_mfma_f32_16x16x32_bf16 v[36:39], a[24:27], a[184:187], v[36:39]
v_cvt_pk_bf16_f32 v52, v20, v21
v_mfma_f32_16x16x32_bf16 v[36:39], a[28:31], a[188:191], v[36:39]
ds_read_b128 a[60:63], v2 offset:7168
v_mfma_f32_16x16x32_bf16 v[40:43], a[16:19], a[192:195], v[88:91]
s_mov_b32 s9, 0x600000
v_exp_f32 v22, v22
v_mfma_f32_16x16x32_bf16 v[40:43], a[20:23], a[196:199], v[40:43]
buffer_load_dword a244, v8, s[64:67], s9 offen
v_mfma_f32_16x16x32_bf16 v[40:43], a[24:27], a[200:203], v[40:43]
v_exp_f32 v23, v23
v_mfma_f32_16x16x32_bf16 v[40:43], a[28:31], a[204:207], v[40:43]
v_exp_f32 v24, v24
v_mfma_f32_16x16x32_bf16 v[44:47], a[16:19], a[208:211], v[92:95]
v_exp_f32 v25, v25
v_mfma_f32_16x16x32_bf16 v[44:47], a[20:23], a[212:215], v[44:47]
v_exp_f32 v26, v26
v_mfma_f32_16x16x32_bf16 v[44:47], a[24:27], a[216:219], v[44:47]
v_exp_f32 v27, v27
v_mfma_f32_16x16x32_bf16 v[44:47], a[28:31], a[220:223], v[44:47]
s_waitcnt lgkmcnt(0)
v_cvt_pk_bf16_f32 v53, v22, v23
v_mfma_f32_16x16x32_bf16 v[128:131], a[32:35], v[64:67], v[128:131]
ds_read_b128 a[0:3], v2 offset:24576
v_cvt_pk_bf16_f32 v56, v24, v25
v_mfma_f32_16x16x32_bf16 v[160:163], a[32:35], v[68:71], v[160:163]
v_exp_f32 v28, v28
v_mfma_f32_16x16x32_bf16 v[192:195], a[32:35], v[72:75], v[192:195]
ds_read_b128 a[4:7], v2 offset:25600
v_cvt_pk_bf16_f32 v57, v26, v27
v_mfma_f32_16x16x32_bf16 v[224:227], a[32:35], v[76:79], v[224:227]
s_add_u32 m0, s19, 0x1000
v_mfma_f32_16x16x32_bf16 v[228:231], a[36:39], v[76:79], v[228:231]
buffer_load_dwordx4 v3, s[48:51], s7 offen offset:0 sc1 lds
v_mfma_f32_16x16x32_bf16 v[196:199], a[36:39], v[72:75], v[196:199]
ds_read_b128 a[8:11], v2 offset:26624
v_mfma_f32_16x16x32_bf16 v[164:167], a[36:39], v[68:71], v[164:167]
v_exp_f32 v29, v29
v_mfma_f32_16x16x32_bf16 v[132:135], a[36:39], v[64:67], v[132:135]
v_exp_f32 v30, v30
v_mfma_f32_16x16x32_bf16 v[136:139], a[40:43], v[64:67], v[136:139]
ds_read_b128 a[12:15], v2 offset:27648
v_cvt_pk_bf16_f32 v60, v28, v29
v_mfma_f32_16x16x32_bf16 v[168:171], a[40:43], v[68:71], v[168:171]
v_exp_f32 v31, v31
v_mfma_f32_16x16x32_bf16 v[200:203], a[40:43], v[72:75], v[200:203]
v_exp_f32 v36, v36
v_mfma_f32_16x16x32_bf16 v[232:235], a[40:43], v[76:79], v[232:235]
ds_read_b128 a[16:19], v2 offset:28672
v_cvt_pk_bf16_f32 v61, v30, v31
v_mfma_f32_16x16x32_bf16 v[236:239], a[44:47], v[76:79], v[236:239]
buffer_load_dwordx4 v3, s[48:51], s7 offen offset:1024 sc1 lds
v_mfma_f32_16x16x32_bf16 v[204:207], a[44:47], v[72:75], v[204:207]
ds_read_b128 a[20:23], v2 offset:29696
v_mfma_f32_16x16x32_bf16 v[172:175], a[44:47], v[68:71], v[172:175]
v_mfma_f32_16x16x32_bf16 v[140:143], a[44:47], v[64:67], v[140:143]
v_exp_f32 v37, v37
v_mfma_f32_16x16x32_bf16 v[144:147], a[48:51], v[64:67], v[144:147]
ds_read_b128 a[24:27], v2 offset:30720
v_cvt_pk_bf16_f32 v54, v36, v37
v_mfma_f32_16x16x32_bf16 v[176:179], a[48:51], v[68:71], v[176:179]
v_exp_f32 v38, v38
v_mfma_f32_16x16x32_bf16 v[208:211], a[48:51], v[72:75], v[208:211]
v_exp_f32 v39, v39
v_mfma_f32_16x16x32_bf16 v[240:243], a[48:51], v[76:79], v[240:243]
ds_read_b128 a[28:31], v2 offset:31744
v_cvt_pk_bf16_f32 v55, v38, v39
v_mfma_f32_16x16x32_bf16 v[244:247], a[52:55], v[76:79], v[244:247]
v_exp_f32 v40, v40
v_mfma_f32_16x16x32_bf16 v[212:215], a[52:55], v[72:75], v[212:215]
buffer_load_dwordx4 v3, s[48:51], s7 offen offset:2048 sc1 lds
v_mfma_f32_16x16x32_bf16 v[180:183], a[52:55], v[68:71], v[180:183]
ds_read_b128 a[32:35], v2 offset:16384
v_mfma_f32_16x16x32_bf16 v[148:151], a[52:55], v[64:67], v[148:151]
v_mfma_f32_16x16x32_bf16 v[152:155], a[56:59], v[64:67], v[152:155]
ds_read_b128 a[36:39], v2 offset:17408
v_mfma_f32_16x16x32_bf16 v[184:187], a[56:59], v[68:71], v[184:187]
v_exp_f32 v41, v41
v_mfma_f32_16x16x32_bf16 v[216:219], a[56:59], v[72:75], v[216:219]
v_exp_f32 v42, v42
v_mfma_f32_16x16x32_bf16 v[248:251], a[56:59], v[76:79], v[248:251]
ds_read_b128 a[40:43], v2 offset:18432
v_cvt_pk_bf16_f32 v58, v40, v41
v_mfma_f32_16x16x32_bf16 v[252:255], a[60:63], v[76:79], v[252:255]
v_exp_f32 v43, v43
v_mfma_f32_16x16x32_bf16 v[220:223], a[60:63], v[72:75], v[220:223]
buffer_load_dwordx4 v3, s[48:51], s7 offen offset:3072 sc1 lds
v_mfma_f32_16x16x32_bf16 v[188:191], a[60:63], v[68:71], v[188:191]
ds_read_b128 a[44:47], v2 offset:19456
v_cvt_pk_bf16_f32 v59, v42, v43
v_mfma_f32_16x16x32_bf16 v[156:159], a[60:63], v[64:67], v[156:159]
v_exp_f32 v44, v44
v_smfmac_f32_16x16x64_bf16 a[224:227], a[232:235], v[64:71], v9
s_waitcnt lgkmcnt(8)
v_exp_f32 v45, v45
v_smfmac_f32_16x16x64_bf16 a[228:231], a[232:235], v[72:79], v9
ds_read_b128 a[48:51], v2 offset:20480
v_add_u32 v4, s0, v3
v_mfma_f32_16x16x32_bf16 v[24:27], a[0:3], a[192:195], v[88:91]
v_cvt_pk_bf16_f32 v62, v44, v45
v_mfma_f32_16x16x32_bf16 v[24:27], a[4:7], a[196:199], v[24:27]
ds_read_b128 a[52:55], v2 offset:21504
v_mov_b32 v5, s1
v_mfma_f32_16x16x32_bf16 v[24:27], a[8:11], a[200:203], v[24:27]
v_exp_f32 v46, v46
v_mfma_f32_16x16x32_bf16 v[24:27], a[12:15], a[204:207], v[24:27]
global_load_dword a244, v[4:5], off sc1
v_mfma_f32_16x16x32_bf16 v[28:31], a[0:3], a[208:211], v[92:95]
ds_read_b128 a[56:59], v2 offset:22528
v_mfma_f32_16x16x32_bf16 v[28:31], a[4:7], a[212:215], v[28:31]
s_add_u32 s32, s32, 0x8000
v_exp_f32 v47, v47
v_mfma_f32_16x16x32_bf16 v[28:31], a[8:11], a[216:219], v[28:31]
s_waitcnt lgkmcnt(7)
v_cvt_pk_bf16_f32 v63, v46, v47
v_mfma_f32_16x16x32_bf16 v[28:31], a[12:15], a[220:223], v[28:31]
ds_read_b128 a[60:63], v2 offset:23552
s_add_u32 s7, s7, 0x8000
v_mfma_f32_16x16x32_bf16 v[40:43], a[16:19], a[192:195], v[88:91]
s_xor_b32 s19, s19, 0x8000
v_xor_b32 v2, 0x38000, v2
v_mfma_f32_16x16x32_bf16 v[40:43], a[20:23], a[196:199], v[40:43]
s_sub_u32 s15, 7, s6
v_exp_f32 v24, v24
v_mfma_f32_16x16x32_bf16 v[40:43], a[24:27], a[200:203], v[40:43]
s_lshl_b32 s15, s15, 1
v_exp_f32 v25, v25
v_mfma_f32_16x16x32_bf16 v[40:43], a[28:31], a[204:207], v[40:43]
v_exp_f32 v26, v26
v_mfma_f32_16x16x32_bf16 v[44:47], a[16:19], a[208:211], v[92:95]
v_exp_f32 v27, v27
v_mfma_f32_16x16x32_bf16 v[44:47], a[20:23], a[212:215], v[44:47]
v_exp_f32 v28, v28
v_mfma_f32_16x16x32_bf16 v[44:47], a[24:27], a[216:219], v[44:47]
s_waitcnt vmcnt(22) lgkmcnt(0)
v_exp_f32 v29, v29
v_mfma_f32_16x16x32_bf16 v[44:47], a[28:31], a[220:223], v[44:47]
s_barrier
s_cbranch_scc0 L_att_lh0_1
v_mfma_f32_16x16x32_bf16 v[160:163], a[32:35], v[52:55], v[160:163]
ds_read_b128 a[0:3], v1 offset:8192
v_cvt_pk_bf16_f32 v72, v24, v25
v_mfma_f32_16x16x32_bf16 v[192:195], a[32:35], v[56:59], v[192:195]
v_exp_f32 v30, v30
v_mfma_f32_16x16x32_bf16 v[224:227], a[32:35], v[60:63], v[224:227]
ds_read_b128 a[4:7], v1 offset:9216
v_cvt_pk_bf16_f32 v73, v26, v27
v_mfma_f32_16x16x32_bf16 v[228:231], a[36:39], v[60:63], v[228:231]
s_add_u32 m0, s27, 0x0
v_cvt_pk_bf16_f32 v76, v28, v29
v_accvgpr_read_b32 v6, a224
v_mfma_f32_16x16x32_bf16 v[196:199], a[36:39], v[56:59], v[196:199]
buffer_load_dwordx4 v3, s[48:51], s32 offen offset:0 sc1 lds
v_mfma_f32_16x16x32_bf16 v[164:167], a[36:39], v[52:55], v[164:167]
ds_read_b128 a[8:11], v1 offset:10240
v_accvgpr_read_b32 v7, a225
v_mfma_f32_16x16x32_bf16 v[168:171], a[40:43], v[52:55], v[168:171]
ds_read_b128 a[12:15], v1 offset:11264
v_add_f32 v6, v6, v7
v_mfma_f32_16x16x32_bf16 v[200:203], a[40:43], v[56:59], v[200:203]
v_exp_f32 v31, v31
v_mfma_f32_16x16x32_bf16 v[232:235], a[40:43], v[60:63], v[232:235]
v_exp_f32 v40, v40
v_mfma_f32_16x16x32_bf16 v[236:239], a[44:47], v[60:63], v[236:239]
ds_read_b128 a[16:19], v1 offset:12288
v_cvt_pk_bf16_f32 v77, v30, v31
v_mfma_f32_16x16x32_bf16 v[204:207], a[44:47], v[56:59], v[204:207]
v_cmp_nge_f32 vcc, 0x5f800000, v6
v_mfma_f32_16x16x32_bf16 v[172:175], a[44:47], v[52:55], v[172:175]
ds_read_b128 a[20:23], v1 offset:13312
v_mfma_f32_16x16x32_bf16 v[176:179], a[48:51], v[52:55], v[176:179]
v_exp_f32 v41, v41
v_mfma_f32_16x16x32_bf16 v[208:211], a[48:51], v[56:59], v[208:211]
ds_read_b128 a[24:27], v1 offset:14336
v_cvt_pk_bf16_f32 v74, v40, v41
v_mfma_f32_16x16x32_bf16 v[240:243], a[48:51], v[60:63], v[240:243]
buffer_load_dwordx4 v3, s[48:51], s32 offen offset:1024 sc1 lds
v_mfma_f32_16x16x32_bf16 v[244:247], a[52:55], v[60:63], v[244:247]
v_exp_f32 v42, v42
v_mfma_f32_16x16x32_bf16 v[212:215], a[52:55], v[56:59], v[212:215]
ds_read_b128 a[28:31], v1 offset:15360
v_mfma_f32_16x16x32_bf16 v[180:183], a[52:55], v[52:55], v[180:183]
v_exp_f32 v43, v43
v_mfma_f32_16x16x32_bf16 v[184:187], a[56:59], v[52:55], v[184:187]
ds_read_b128 a[32:35], v1 offset:0
v_cvt_pk_bf16_f32 v75, v42, v43
v_mfma_f32_16x16x32_bf16 v[216:219], a[56:59], v[56:59], v[216:219]
v_rcp_f32 v6, v6
v_mfma_f32_16x16x32_bf16 v[248:251], a[56:59], v[60:63], v[248:251]
ds_read_b128 a[36:39], v1 offset:1024
s_or_b64 s[34:35], s[34:35], vcc
v_mfma_f32_16x16x32_bf16 v[252:255], a[60:63], v[60:63], v[252:255]
s_add_u32 s8, s28, 0x0
v_exp_f32 v44, v44
v_mfma_f32_16x16x32_bf16 v[220:223], a[60:63], v[56:59], v[220:223]
v_exp_f32 v45, v45
v_mfma_f32_16x16x32_bf16 v[188:191], a[60:63], v[52:55], v[188:191]
ds_read_b128 a[40:43], v1 offset:2048
v_cvt_pk_bf16_f32 v78, v44, v45
v_mfma_f32_16x16x32_bf16 a[224:227], a[236:239], v[52:55], a[224:227]
buffer_load_dwordx4 v3, s[48:51], s32 offen offset:2048 sc1 lds
v_smfmac_f32_16x16x64_bf16 a[228:231], a[232:235], v[56:63], v9
ds_read_b128 a[44:47], v1 offset:3072
s_waitcnt lgkmcnt(8)
v_mfma_f32_16x16x32_bf16 v[24:27], a[0:3], a[192:195], v[88:91]
v_exp_f32 v46, v46
v_mfma_f32_16x16x32_bf16 v[24:27], a[4:7], a[196:199], v[24:27]
ds_read_b128 a[48:51], v1 offset:4096
v_mul_f32 v128, v6, v128
v_mfma_f32_16x16x32_bf16 v[24:27], a[8:11], a[200:203], v[24:27]
v_mul_f32 v129, v6, v129
v_mul_f32 v130, v6, v130
v_mfma_f32_16x16x32_bf16 v[24:27], a[12:15], a[204:207], v[24:27]
v_exp_f32 v47, v47
v_mfma_f32_16x16x32_bf16 v[28:31], a[0:3], a[208:211], v[92:95]
ds_read_b128 a[52:55], v1 offset:5120
v_cvt_pk_bf16_f32 v79, v46, v47
v_mfma_f32_16x16x32_bf16 v[28:31], a[4:7], a[212:215], v[28:31]
v_mul_f32 v131, v6, v131
v_mul_f32 v132, v6, v132
v_mfma_f32_16x16x32_bf16 v[28:31], a[8:11], a[216:219], v[28:31]
ds_read_b128 a[56:59], v1 offset:6144
v_mul_f32 v133, v6, v133
v_mfma_f32_16x16x32_bf16 v[28:31], a[12:15], a[220:223], v[28:31]
s_waitcnt lgkmcnt(7)
v_exp_f32 v24, v24
v_mfma_f32_16x16x32_bf16 v[40:43], a[16:19], a[192:195], v[88:91]
buffer_load_dwordx4 v3, s[48:51], s32 offen offset:3072 sc1 lds
v_mfma_f32_16x16x32_bf16 v[40:43], a[20:23], a[196:199], v[40:43]
ds_read_b128 a[60:63], v1 offset:7168
v_mul_f32 v134, v6, v134
v_mfma_f32_16x16x32_bf16 v[40:43], a[24:27], a[200:203], v[40:43]
s_add_u32 s32, s32, 0x8000
v_exp_f32 v25, v25
v_mfma_f32_16x16x32_bf16 v[40:43], a[28:31], a[204:207], v[40:43]
v_exp_f32 v26, v26
v_mfma_f32_16x16x32_bf16 v[44:47], a[16:19], a[208:211], v[92:95]
v_exp_f32 v27, v27
v_mfma_f32_16x16x32_bf16 v[44:47], a[20:23], a[212:215], v[44:47]
v_exp_f32 v28, v28
v_mfma_f32_16x16x32_bf16 v[44:47], a[24:27], a[216:219], v[44:47]
v_exp_f32 v29, v29
v_mfma_f32_16x16x32_bf16 v[44:47], a[28:31], a[220:223], v[44:47]
s_waitcnt lgkmcnt(0)
v_mul_f32 v135, v6, v135
v_cvt_pk_bf16_f32 v128, v128, v129
v_mfma_f32_16x16x32_bf16 v[192:195], a[32:35], v[72:75], v[192:195]
s_add_u32 m0, s27, 0x1000
v_exp_f32 v30, v30
v_mfma_f32_16x16x32_bf16 v[224:227], a[32:35], v[76:79], v[224:227]
buffer_load_dwordx4 v3, s[48:51], s7 offen offset:0 sc1 lds
v_mfma_f32_16x16x32_bf16 v[228:231], a[36:39], v[76:79], v[228:231]
v_exp_f32 v31, v31
v_mfma_f32_16x16x32_bf16 v[196:199], a[36:39], v[72:75], v[196:199]
ds_read_b128 a[0:3], v1 offset:24576
v_cvt_pk_bf16_f32 v56, v24, v25
v_mfma_f32_16x16x32_bf16 v[200:203], a[40:43], v[72:75], v[200:203]
ds_read_b128 a[4:7], v1 offset:25600
v_cvt_pk_bf16_f32 v57, v26, v27
v_mfma_f32_16x16x32_bf16 v[232:235], a[40:43], v[76:79], v[232:235]
v_exp_f32 v40, v40
v_mfma_f32_16x16x32_bf16 v[236:239], a[44:47], v[76:79], v[236:239]
ds_read_b128 a[8:11], v1 offset:26624
v_cvt_pk_bf16_f32 v60, v28, v29
v_mfma_f32_16x16x32_bf16 v[204:207], a[44:47], v[72:75], v[204:207]
v_exp_f32 v41, v41
v_mfma_f32_16x16x32_bf16 v[208:211], a[48:51], v[72:75], v[208:211]
ds_read_b128 a[12:15], v1 offset:27648
v_cvt_pk_bf16_f32 v61, v30, v31
v_mfma_f32_16x16x32_bf16 v[240:243], a[48:51], v[76:79], v[240:243]
ds_read_b128 a[16:19], v1 offset:28672
v_cvt_pk_bf16_f32 v58, v40, v41
v_mfma_f32_16x16x32_bf16 v[244:247], a[52:55], v[76:79], v[244:247]
v_exp_f32 v42, v42
v_mfma_f32_16x16x32_bf16 v[212:215], a[52:55], v[72:75], v[212:215]
buffer_load_dwordx4 v3, s[48:51], s7 offen offset:1024 sc1 lds
v_mfma_f32_16x16x32_bf16 v[216:219], a[56:59], v[72:75], v[216:219]
ds_read_b128 a[20:23], v1 offset:29696
v_cvt_pk_bf16_f32 v129, v130, v131
v_mfma_f32_16x16x32_bf16 v[248:251], a[56:59], v[76:79], v[248:251]
ds_read_b128 a[24:27], v1 offset:30720
v_cvt_pk_bf16_f32 v130, v132, v133
v_mfma_f32_16x16x32_bf16 v[252:255], a[60:63], v[76:79], v[252:255]
ds_read_b128 a[28:31], v1 offset:31744
v_cvt_pk_bf16_f32 v131, v134, v135
v_mfma_f32_16x16x32_bf16 v[220:223], a[60:63], v[72:75], v[220:223]
s_waitcnt lgkmcnt(4)
v_exp_f32 v43, v43
v_smfmac_f32_16x16x64_bf16 a[228:231], a[232:235], v[72:79], v9
ds_read_b128 a[32:35], v1 offset:16384
v_cvt_pk_bf16_f32 v59, v42, v43
v_mfma_f32_16x16x32_bf16 v[24:27], a[0:3], a[192:195], v[88:91]
ds_read_b128 a[36:39], v1 offset:17408
buffer_store_dwordx4 v[128:131], v3, s[88:91], s8 offen sc1
v_mfma_f32_16x16x32_bf16 v[24:27], a[4:7], a[196:199], v[24:27]
buffer_load_dwordx4 v3, s[48:51], s7 offen offset:2048 sc1 lds
v_mfma_f32_16x16x32_bf16 v[24:27], a[8:11], a[200:203], v[24:27]
ds_read_b128 a[40:43], v1 offset:18432
v_exp_f32 v44, v44
v_mfma_f32_16x16x32_bf16 v[24:27], a[12:15], a[204:207], v[24:27]
ds_read_b128 a[44:47], v1 offset:19456
v_exp_f32 v45, v45
v_mfma_f32_16x16x32_bf16 v[28:31], a[0:3], a[208:211], v[92:95]
ds_read_b128 a[48:51], v1 offset:20480
v_exp_f32 v46, v46
v_mfma_f32_16x16x32_bf16 v[28:31], a[4:7], a[212:215], v[28:31]
s_waitcnt lgkmcnt(5)
v_exp_f32 v47, v47
v_mfma_f32_16x16x32_bf16 v[28:31], a[8:11], a[216:219], v[28:31]
ds_read_b128 a[52:55], v1 offset:21504
v_cvt_pk_bf16_f32 v62, v44, v45
v_mfma_f32_16x16x32_bf16 v[28:31], a[12:15], a[220:223], v[28:31]
ds_read_b128 a[56:59], v1 offset:22528
v_cvt_pk_bf16_f32 v63, v46, v47
v_mfma_f32_16x16x32_bf16 v[40:43], a[16:19], a[192:195], v[88:91]
ds_read_b128 a[60:63], v1 offset:23552
v_xor_b32 v1, 0x8000, v1
v_mfma_f32_16x16x32_bf16 v[40:43], a[20:23], a[196:199], v[40:43]
buffer_load_dwordx4 v3, s[48:51], s7 offen offset:3072 sc1 lds
v_mfma_f32_16x16x32_bf16 v[40:43], a[24:27], a[200:203], v[40:43]
s_add_u32 s7, s7, 0x8000
v_exp_f32 v24, v24
v_mfma_f32_16x16x32_bf16 v[40:43], a[28:31], a[204:207], v[40:43]
s_xor_b32 s27, s27, 0x38000
v_exp_f32 v25, v25
v_mfma_f32_16x16x32_bf16 v[44:47], a[16:19], a[208:211], v[92:95]
s_add_u32 s8, s28, 0x2000
v_exp_f32 v26, v26
v_mfma_f32_16x16x32_bf16 v[44:47], a[20:23], a[212:215], v[44:47]
v_exp_f32 v27, v27
v_mfma_f32_16x16x32_bf16 v[44:47], a[24:27], a[216:219], v[44:47]
s_waitcnt vmcnt(19) lgkmcnt(0)
v_exp_f32 v28, v28
v_mfma_f32_16x16x32_bf16 v[44:47], a[28:31], a[220:223], v[44:47]
s_barrier
v_exp_f32 v29, v29
v_mul_f32 v136, v6, v136
v_mul_f32 v137, v6, v137
v_mul_f32 v138, v6, v138
v_mul_f32 v139, v6, v139
v_mul_f32 v140, v6, v140
v_mul_f32 v141, v6, v141
v_mul_f32 v142, v6, v142
v_mul_f32 v143, v6, v143
v_cvt_pk_bf16_f32 v136, v136, v137
v_cvt_pk_bf16_f32 v137, v138, v139
v_cvt_pk_bf16_f32 v138, v140, v141
v_cvt_pk_bf16_f32 v139, v142, v143
buffer_store_dwordx4 v[136:139], v3, s[88:91], s8 offen sc1
s_add_u32 s8, s28, 0x4000
v_mul_f32 v144, v6, v144
v_mul_f32 v145, v6, v145
v_mul_f32 v146, v6, v146
v_mul_f32 v147, v6, v147
v_mul_f32 v148, v6, v148
v_mul_f32 v149, v6, v149
v_mul_f32 v150, v6, v150
v_mul_f32 v151, v6, v151
v_cvt_pk_bf16_f32 v144, v144, v145
v_cvt_pk_bf16_f32 v145, v146, v147
v_cvt_pk_bf16_f32 v146, v148, v149
v_cvt_pk_bf16_f32 v147, v150, v151
buffer_store_dwordx4 v[144:147], v3, s[88:91], s8 offen sc1
s_add_u32 s8, s28, 0x6000
v_mul_f32 v152, v6, v152
v_mul_f32 v153, v6, v153
v_mul_f32 v154, v6, v154
v_mul_f32 v155, v6, v155
v_mul_f32 v156, v6, v156
v_mul_f32 v157, v6, v157
v_mul_f32 v158, v6, v158
v_mul_f32 v159, v6, v159
v_cvt_pk_bf16_f32 v152, v152, v153
v_cvt_pk_bf16_f32 v153, v154, v155
v_cvt_pk_bf16_f32 v154, v156, v157
v_cvt_pk_bf16_f32 v155, v158, v159
buffer_store_dwordx4 v[152:155], v3, s[88:91], s8 offen sc1
v_accvgpr_read_b32 v6, a226
v_accvgpr_read_b32 v7, a227
v_add_f32 v6, v6, v7
v_cmp_nge_f32 vcc, 0x5f800000, v6
v_rcp_f32 v6, v6
s_or_b64 s[34:35], s[34:35], vcc
s_add_u32 s8, s29, 0x0
v_pk_mul_f32 v[160:161], v[160:161], v[6:7] op_sel_hi:[1,0]
v_pk_mul_f32 v[162:163], v[162:163], v[6:7] op_sel_hi:[1,0]
v_pk_mul_f32 v[164:165], v[164:165], v[6:7] op_sel_hi:[1,0]
v_pk_mul_f32 v[166:167], v[166:167], v[6:7] op_sel_hi:[1,0]
v_cvt_pk_bf16_f32 v160, v160, v161
v_cvt_pk_bf16_f32 v161, v162, v163
v_cvt_pk_bf16_f32 v162, v164, v165
v_cvt_pk_bf16_f32 v163, v166, v167
buffer_store_dwordx4 v[160:163], v3, s[88:91], s8 offen sc1
s_add_u32 s8, s29, 0x2000
v_pk_mul_f32 v[168:169], v[168:169], v[6:7] op_sel_hi:[1,0]
v_pk_mul_f32 v[170:171], v[170:171], v[6:7] op_sel_hi:[1,0]
v_pk_mul_f32 v[172:173], v[172:173], v[6:7] op_sel_hi:[1,0]
v_pk_mul_f32 v[174:175], v[174:175], v[6:7] op_sel_hi:[1,0]
v_cvt_pk_bf16_f32 v168, v168, v169
v_cvt_pk_bf16_f32 v169, v170, v171
v_cvt_pk_bf16_f32 v170, v172, v173
v_cvt_pk_bf16_f32 v171, v174, v175
buffer_store_dwordx4 v[168:171], v3, s[88:91], s8 offen sc1
s_add_u32 s8, s29, 0x4000
v_pk_mul_f32 v[176:177], v[176:177], v[6:7] op_sel_hi:[1,0]
v_pk_mul_f32 v[178:179], v[178:179], v[6:7] op_sel_hi:[1,0]
v_pk_mul_f32 v[180:181], v[180:181], v[6:7] op_sel_hi:[1,0]
v_pk_mul_f32 v[182:183], v[182:183], v[6:7] op_sel_hi:[1,0]
v_cvt_pk_bf16_f32 v176, v176, v177
v_cvt_pk_bf16_f32 v177, v178, v179
v_cvt_pk_bf16_f32 v178, v180, v181
v_cvt_pk_bf16_f32 v179, v182, v183
buffer_store_dwordx4 v[176:179], v3, s[88:91], s8 offen sc1
s_add_u32 s8, s29, 0x6000
v_pk_mul_f32 v[184:185], v[184:185], v[6:7] op_sel_hi:[1,0]
v_pk_mul_f32 v[186:187], v[186:187], v[6:7] op_sel_hi:[1,0]
v_pk_mul_f32 v[188:189], v[188:189], v[6:7] op_sel_hi:[1,0]
v_pk_mul_f32 v[190:191], v[190:191], v[6:7] op_sel_hi:[1,0]
v_cvt_pk_bf16_f32 v184, v184, v185
v_cvt_pk_bf16_f32 v185, v186, v187
v_cvt_pk_bf16_f32 v186, v188, v189
v_cvt_pk_bf16_f32 v187, v190, v191
buffer_store_dwordx4 v[184:187], v3, s[88:91], s8 offen sc1
s_getreg_b32 s8, hwreg(HW_REG_HW_ID, 5, 1)
s_cmp_lg_u32 s8, 0
s_cbranch_scc1 L_att_sodd1
s_branch L_att_sodd0
L_att_lh0_1:
v_mfma_f32_16x16x32_bf16 v[160:163], a[32:35], v[52:55], v[160:163]
ds_read_b128 a[0:3], v1 offset:8192
v_cvt_pk_bf16_f32 v72, v24, v25
v_mfma_f32_16x16x32_bf16 v[192:195], a[32:35], v[56:59], v[192:195]
v_exp_f32 v30, v30
v_mfma_f32_16x16x32_bf16 v[224:227], a[32:35], v[60:63], v[224:227]
buffer_load_dword v14, v15, s[84:87], 0 offen offset:192 sc1
v_mfma_f32_16x16x32_bf16 v[228:231], a[36:39], v[60:63], v[228:231]
ds_read_b128 a[4:7], v1 offset:9216
v_cvt_pk_bf16_f32 v73, v26, v27
v_mfma_f32_16x16x32_bf16 v[196:199], a[36:39], v[56:59], v[196:199]
ds_read_b128 a[8:11], v1 offset:10240
v_cvt_pk_bf16_f32 v76, v28, v29
v_mfma_f32_16x16x32_bf16 v[164:167], a[36:39], v[52:55], v[164:167]
s_add_u32 m0, s17, 0x10000
v_exp_f32 v31, v31
v_mfma_f32_16x16x32_bf16 v[168:171], a[40:43], v[52:55], v[168:171]
buffer_load_dwordx4 v12, s[72:75], 0 offen lds
v_mfma_f32_16x16x32_bf16 v[200:203], a[40:43], v[56:59], v[200:203]
ds_read_b128 a[12:15], v1 offset:11264
v_cvt_pk_bf16_f32 v77, v30, v31
v_mfma_f32_16x16x32_bf16 v[232:235], a[40:43], v[60:63], v[232:235]
v_exp_f32 v40, v40
v_mfma_f32_16x16x32_bf16 v[236:239], a[44:47], v[60:63], v[236:239]
ds_read_b128 a[16:19], v1 offset:12288
v_mfma_f32_16x16x32_bf16 v[204:207], a[44:47], v[56:59], v[204:207]
v_exp_f32 v41, v41
v_mfma_f32_16x16x32_bf16 v[172:175], a[44:47], v[52:55], v[172:175]
buffer_load_dwordx4 v13, s[72:75], 0 offen offset:1024 lds
v_mfma_f32_16x16x32_bf16 v[176:179], a[48:51], v[52:55], v[176:179]
ds_read_b128 a[20:23], v1 offset:13312
v_cvt_pk_bf16_f32 v74, v40, v41
v_mfma_f32_16x16x32_bf16 v[208:211], a[48:51], v[56:59], v[208:211]
ds_read_b128 a[24:27], v1 offset:14336
v_mfma_f32_16x16x32_bf16 v[240:243], a[48:51], v[60:63], v[240:243]
v_exp_f32 v42, v42
v_mfma_f32_16x16x32_bf16 v[244:247], a[52:55], v[60:63], v[244:247]
buffer_load_dwordx4 v12, s[72:75], s12 offen offset:2048 lds
v_mfma_f32_16x16x32_bf16 v[212:215], a[52:55], v[56:59], v[212:215]
ds_read_b128 a[28:31], v1 offset:15360
v_mfma_f32_16x16x32_bf16 v[180:183], a[52:55], v[52:55], v[180:183]
v_exp_f32 v43, v43
v_mfma_f32_16x16x32_bf16 v[184:187], a[56:59], v[52:55], v[184:187]
ds_read_b128 a[32:35], v1 offset:0
v_cvt_pk_bf16_f32 v75, v42, v43
v_mfma_f32_16x16x32_bf16 v[216:219], a[56:59], v[56:59], v[216:219]
v_exp_f32 v44, v44
v_mfma_f32_16x16x32_bf16 v[248:251], a[56:59], v[60:63], v[248:251]
buffer_load_dwordx4 v13, s[72:75], s12 offen offset:3072 lds
v_mfma_f32_16x16x32_bf16 v[252:255], a[60:63], v[60:63], v[252:255]
ds_read_b128 a[36:39], v1 offset:1024
v_mfma_f32_16x16x32_bf16 v[220:223], a[60:63], v[56:59], v[220:223]
s_add_u32 m0, s17, 0x14000
v_exp_f32 v45, v45
v_mfma_f32_16x16x32_bf16 v[188:191], a[60:63], v[52:55], v[188:191]
ds_read_b128 a[40:43], v1 offset:2048
v_add_u32 v12, 0x20000, v12
v_mfma_f32_16x16x32_bf16 a[224:227], a[236:239], v[52:55], a[224:227]
buffer_load_dwordx4 v12, s[72:75], 0 offen lds
v_smfmac_f32_16x16x64_bf16 a[228:231], a[232:235], v[56:63], v9
ds_read_b128 a[44:47], v1 offset:3072
s_waitcnt lgkmcnt(8)
v_mfma_f32_16x16x32_bf16 v[24:27], a[0:3], a[192:195], v[88:91]
v_exp_f32 v46, v46
v_mfma_f32_16x16x32_bf16 v[24:27], a[4:7], a[196:199], v[24:27]
ds_read_b128 a[48:51], v1 offset:4096
v_add_u32 v13, 0x20000, v13
v_mfma_f32_16x16x32_bf16 v[24:27], a[8:11], a[200:203], v[24:27]
buffer_load_dwordx4 v13, s[72:75], 0 offen offset:1024 lds
v_mfma_f32_16x16x32_bf16 v[24:27], a[12:15], a[204:207], v[24:27]
v_exp_f32 v47, v47
v_mfma_f32_16x16x32_bf16 v[28:31], a[0:3], a[208:211], v[92:95]
ds_read_b128 a[52:55], v1 offset:5120
v_cvt_pk_bf16_f32 v78, v44, v45
v_mfma_f32_16x16x32_bf16 v[28:31], a[4:7], a[212:215], v[28:31]
s_waitcnt lgkmcnt(6)
v_cvt_pk_bf16_f32 v79, v46, v47
v_mfma_f32_16x16x32_bf16 v[28:31], a[8:11], a[216:219], v[28:31]
ds_read_b128 a[56:59], v1 offset:6144
v_mfma_f32_16x16x32_bf16 v[28:31], a[12:15], a[220:223], v[28:31]
buffer_load_dwordx4 v12, s[72:75], s12 offen offset:2048 lds
v_mfma_f32_16x16x32_bf16 v[40:43], a[16:19], a[192:195], v[88:91]
ds_read_b128 a[60:63], v1 offset:7168
v_mfma_f32_16x16x32_bf16 v[40:43], a[20:23], a[196:199], v[40:43]
v_exp_f32 v24, v24
v_mfma_f32_16x16x32_bf16 v[40:43], a[24:27], a[200:203], v[40:43]
v_exp_f32 v25, v25
v_mfma_f32_16x16x32_bf16 v[40:43], a[28:31], a[204:207], v[40:43]
buffer_load_dwordx4 v13, s[72:75], s12 offen offset:3072 lds
v_mfma_f32_16x16x32_bf16 v[44:47], a[16:19], a[208:211], v[92:95]
v_exp_f32 v26, v26
v_mfma_f32_16x16x32_bf16 v[44:47], a[20:23], a[212:215], v[44:47]
v_exp_f32 v27, v27
v_mfma_f32_16x16x32_bf16 v[44:47], a[24:27], a[216:219], v[44:47]
v_exp_f32 v28, v28
v_mfma_f32_16x16x32_bf16 v[44:47], a[28:31], a[220:223], v[44:47]
s_waitcnt lgkmcnt(0)
v_exp_f32 v29, v29
v_mfma_f32_16x16x32_bf16 v[192:195], a[32:35], v[72:75], v[192:195]
s_add_u32 m0, s16, 0x0
v_add_u32 v12, 0x20000, v12
v_cvt_pk_bf16_f32 v56, v24, v25
v_mfma_f32_16x16x32_bf16 v[224:227], a[32:35], v[76:79], v[224:227]
buffer_load_dwordx4 v12, s[72:75], 0 offen lds
v_mfma_f32_16x16x32_bf16 v[228:231], a[36:39], v[76:79], v[228:231]
ds_read_b128 a[0:3], v1 offset:24576
v_cvt_pk_bf16_f32 v57, v26, v27
v_mfma_f32_16x16x32_bf16 v[196:199], a[36:39], v[72:75], v[196:199]
v_exp_f32 v30, v30
v_mfma_f32_16x16x32_bf16 v[200:203], a[40:43], v[72:75], v[200:203]
ds_read_b128 a[4:7], v1 offset:25600
v_cvt_pk_bf16_f32 v60, v28, v29
v_mfma_f32_16x16x32_bf16 v[232:235], a[40:43], v[76:79], v[232:235]
ds_read_b128 a[8:11], v1 offset:26624
v_add_u32 v13, 0x20000, v13
v_mfma_f32_16x16x32_bf16 v[236:239], a[44:47], v[76:79], v[236:239]
buffer_load_dwordx4 v13, s[72:75], 0 offen offset:1024 lds
v_mfma_f32_16x16x32_bf16 v[204:207], a[44:47], v[72:75], v[204:207]
ds_read_b128 a[12:15], v1 offset:27648
v_exp_f32 v31, v31
v_mfma_f32_16x16x32_bf16 v[208:211], a[48:51], v[72:75], v[208:211]
buffer_load_dwordx4 v12, s[72:75], s12 offen offset:2048 lds
v_mfma_f32_16x16x32_bf16 v[240:243], a[48:51], v[76:79], v[240:243]
ds_read_b128 a[16:19], v1 offset:28672
v_exp_f32 v40, v40
v_mfma_f32_16x16x32_bf16 v[244:247], a[52:55], v[76:79], v[244:247]
ds_read_b128 a[20:23], v1 offset:29696
v_cvt_pk_bf16_f32 v61, v30, v31
v_mfma_f32_16x16x32_bf16 v[212:215], a[52:55], v[72:75], v[212:215]
buffer_load_dwordx4 v13, s[72:75], s12 offen offset:3072 lds
v_mfma_f32_16x16x32_bf16 v[216:219], a[56:59], v[72:75], v[216:219]
ds_read_b128 a[24:27], v1 offset:30720
v_exp_f32 v41, v41
v_mfma_f32_16x16x32_bf16 v[248:251], a[56:59], v[76:79], v[248:251]
ds_read_b128 a[28:31], v1 offset:31744
v_exp_f32 v42, v42
v_mfma_f32_16x16x32_bf16 v[252:255], a[60:63], v[76:79], v[252:255]
ds_read_b128 a[32:35], v1 offset:16384
v_cvt_pk_bf16_f32 v58, v40, v41
v_mfma_f32_16x16x32_bf16 v[220:223], a[60:63], v[72:75], v[220:223]
s_waitcnt lgkmcnt(5)
v_exp_f32 v43, v43
v_smfmac_f32_16x16x64_bf16 a[228:231], a[232:235], v[72:79], v9
ds_read_b128 a[36:39], v1 offset:17408
v_add_u32 v12, 0x20000, v12
v_mfma_f32_16x16x32_bf16 v[24:27], a[0:3], a[192:195], v[112:115]
s_add_u32 m0, s16, 0x4000
v_exp_f32 v44, v44
v_mfma_f32_16x16x32_bf16 v[24:27], a[4:7], a[196:199], v[24:27]
buffer_load_dwordx4 v12, s[72:75], 0 offen lds
v_mfma_f32_16x16x32_bf16 v[24:27], a[8:11], a[200:203], v[24:27]
ds_read_b128 a[40:43], v1 offset:18432
v_add_u32 v13, 0x20000, v13
v_mfma_f32_16x16x32_bf16 v[24:27], a[12:15], a[204:207], v[24:27]
buffer_load_dwordx4 v13, s[72:75], 0 offen offset:1024 lds
v_mfma_f32_16x16x32_bf16 v[28:31], a[0:3], a[208:211], v[92:95]
ds_read_b128 a[44:47], v1 offset:19456
v_cvt_pk_bf16_f32 v59, v42, v43
v_mfma_f32_16x16x32_bf16 v[28:31], a[4:7], a[212:215], v[28:31]
ds_read_b128 a[48:51], v1 offset:20480
v_exp_f32 v45, v45
v_mfma_f32_16x16x32_bf16 v[28:31], a[8:11], a[216:219], v[28:31]
s_waitcnt lgkmcnt(5)
v_exp_f32 v46, v46
v_mfma_f32_16x16x32_bf16 v[28:31], a[12:15], a[220:223], v[28:31]
buffer_load_dwordx4 v12, s[72:75], s12 offen offset:2048 lds
v_mfma_f32_16x16x32_bf16 v[40:43], a[16:19], a[192:195], v[116:119]
ds_read_b128 a[52:55], v1 offset:21504
v_exp_f32 v47, v47
v_mfma_f32_16x16x32_bf16 v[40:43], a[20:23], a[196:199], v[40:43]
ds_read_b128 a[56:59], v1 offset:22528
v_exp_f32 v24, v24
v_mfma_f32_16x16x32_bf16 v[40:43], a[24:27], a[200:203], v[40:43]
ds_read_b128 a[60:63], v1 offset:23552
v_xor_b32 v1, 0x8000, v1
v_mfma_f32_16x16x32_bf16 v[40:43], a[28:31], a[204:207], v[40:43]
v_exp_f32 v25, v25
v_cvt_pk_bf16_f32 v62, v44, v45
v_cvt_pk_bf16_f32 v63, v46, v47
v_mfma_f32_16x16x32_bf16 v[44:47], a[16:19], a[208:211], v[92:95]
v_exp_f32 v26, v26
v_mfma_f32_16x16x32_bf16 v[44:47], a[20:23], a[212:215], v[44:47]
buffer_load_dwordx4 v13, s[72:75], s12 offen offset:3072 lds
v_mfma_f32_16x16x32_bf16 v[44:47], a[24:27], a[216:219], v[44:47]
v_exp_f32 v27, v27
v_mfma_f32_16x16x32_bf16 v[44:47], a[28:31], a[220:223], v[44:47]
v_exp_f32 v28, v28
v_exp_f32 v29, v29
v_accvgpr_read_b32 v6, a224
v_accvgpr_read_b32 v7, a225
v_add_f32 v6, v6, v7
v_cmp_nge_f32 vcc, 0x5f800000, v6
v_rcp_f32 v6, v6
s_or_b64 s[34:35], s[34:35], vcc
s_add_u32 s8, s28, 0x0
v_pk_mul_f32 v[128:129], v[128:129], v[6:7] op_sel_hi:[1,0]
v_pk_mul_f32 v[130:131], v[130:131], v[6:7] op_sel_hi:[1,0]
v_pk_mul_f32 v[132:133], v[132:133], v[6:7] op_sel_hi:[1,0]
v_pk_mul_f32 v[134:135], v[134:135], v[6:7] op_sel_hi:[1,0]
v_cvt_pk_bf16_f32 v128, v128, v129
v_cvt_pk_bf16_f32 v129, v130, v131
v_cvt_pk_bf16_f32 v130, v132, v133
v_cvt_pk_bf16_f32 v131, v134, v135
buffer_store_dwordx4 v[128:131], v3, s[88:91], s8 offen sc1
s_add_u32 s8, s28, 0x2000
v_pk_mul_f32 v[136:137], v[136:137], v[6:7] op_sel_hi:[1,0]
v_pk_mul_f32 v[138:139], v[138:139], v[6:7] op_sel_hi:[1,0]
v_pk_mul_f32 v[140:141], v[140:141], v[6:7] op_sel_hi:[1,0]
v_pk_mul_f32 v[142:143], v[142:143], v[6:7] op_sel_hi:[1,0]
v_cvt_pk_bf16_f32 v136, v136, v137
v_cvt_pk_bf16_f32 v137, v138, v139
v_cvt_pk_bf16_f32 v138, v140, v141
v_cvt_pk_bf16_f32 v139, v142, v143
buffer_store_dwordx4 v[136:139], v3, s[88:91], s8 offen sc1
s_add_u32 s8, s28, 0x4000
v_pk_mul_f32 v[144:145], v[144:145], v[6:7] op_sel_hi:[1,0]
v_pk_mul_f32 v[146:147], v[146:147], v[6:7] op_sel_hi:[1,0]
v_pk_mul_f32 v[148:149], v[148:149], v[6:7] op_sel_hi:[1,0]
v_pk_mul_f32 v[150:151], v[150:151], v[6:7] op_sel_hi:[1,0]
v_cvt_pk_bf16_f32 v144, v144, v145
v_cvt_pk_bf16_f32 v145, v146, v147
v_cvt_pk_bf16_f32 v146, v148, v149
v_cvt_pk_bf16_f32 v147, v150, v151
buffer_store_dwordx4 v[144:147], v3, s[88:91], s8 offen sc1
s_add_u32 s8, s28, 0x6000
v_pk_mul_f32 v[152:153], v[152:153], v[6:7] op_sel_hi:[1,0]
v_pk_mul_f32 v[154:155], v[154:155], v[6:7] op_sel_hi:[1,0]
v_pk_mul_f32 v[156:157], v[156:157], v[6:7] op_sel_hi:[1,0]
v_pk_mul_f32 v[158:159], v[158:159], v[6:7] op_sel_hi:[1,0]
v_cvt_pk_bf16_f32 v152, v152, v153
v_cvt_pk_bf16_f32 v153, v154, v155
v_cvt_pk_bf16_f32 v154, v156, v157
v_cvt_pk_bf16_f32 v155, v158, v159
buffer_store_dwordx4 v[152:155], v3, s[88:91], s8 offen sc1
v_accvgpr_read_b32 v6, a226
v_accvgpr_read_b32 v7, a227
v_add_f32 v6, v6, v7
v_cmp_nge_f32 vcc, 0x5f800000, v6
v_rcp_f32 v6, v6
s_or_b64 s[34:35], s[34:35], vcc
s_add_u32 s8, s29, 0x0
v_pk_mul_f32 v[160:161], v[160:161], v[6:7] op_sel_hi:[1,0]
v_pk_mul_f32 v[162:163], v[162:163], v[6:7] op_sel_hi:[1,0]
v_pk_mul_f32 v[164:165], v[164:165], v[6:7] op_sel_hi:[1,0]
v_pk_mul_f32 v[166:167], v[166:167], v[6:7] op_sel_hi:[1,0]
v_cvt_pk_bf16_f32 v160, v160, v161
v_cvt_pk_bf16_f32 v161, v162, v163
v_cvt_pk_bf16_f32 v162, v164, v165
v_cvt_pk_bf16_f32 v163, v166, v167
buffer_store_dwordx4 v[160:163], v3, s[88:91], s8 offen sc1
s_add_u32 s8, s29, 0x2000
v_pk_mul_f32 v[168:169], v[168:169], v[6:7] op_sel_hi:[1,0]
v_pk_mul_f32 v[170:171], v[170:171], v[6:7] op_sel_hi:[1,0]
v_pk_mul_f32 v[172:173], v[172:173], v[6:7] op_sel_hi:[1,0]
v_pk_mul_f32 v[174:175], v[174:175], v[6:7] op_sel_hi:[1,0]
v_cvt_pk_bf16_f32 v168, v168, v169
v_cvt_pk_bf16_f32 v169, v170, v171
v_cvt_pk_bf16_f32 v170, v172, v173
v_cvt_pk_bf16_f32 v171, v174, v175
buffer_store_dwordx4 v[168:171], v3, s[88:91], s8 offen sc1
s_add_u32 s8, s29, 0x4000
v_pk_mul_f32 v[176:177], v[176:177], v[6:7] op_sel_hi:[1,0]
v_pk_mul_f32 v[178:179], v[178:179], v[6:7] op_sel_hi:[1,0]
v_pk_mul_f32 v[180:181], v[180:181], v[6:7] op_sel_hi:[1,0]
v_pk_mul_f32 v[182:183], v[182:183], v[6:7] op_sel_hi:[1,0]
v_cvt_pk_bf16_f32 v176, v176, v177
v_cvt_pk_bf16_f32 v177, v178, v179
v_cvt_pk_bf16_f32 v178, v180, v181
v_cvt_pk_bf16_f32 v179, v182, v183
buffer_store_dwordx4 v[176:179], v3, s[88:91], s8 offen sc1
s_add_u32 s8, s29, 0x6000
v_pk_mul_f32 v[184:185], v[184:185], v[6:7] op_sel_hi:[1,0]
v_pk_mul_f32 v[186:187], v[186:187], v[6:7] op_sel_hi:[1,0]
v_pk_mul_f32 v[188:189], v[188:189], v[6:7] op_sel_hi:[1,0]
v_pk_mul_f32 v[190:191], v[190:191], v[6:7] op_sel_hi:[1,0]
v_cvt_pk_bf16_f32 v184, v184, v185
v_cvt_pk_bf16_f32 v185, v186, v187
v_cvt_pk_bf16_f32 v186, v188, v189
v_cvt_pk_bf16_f32 v187, v190, v191
buffer_store_dwordx4 v[184:187], v3, s[88:91], s8 offen sc1
s_branch L_att_h1_1
L_att_j0:
s_cmp_ge_u32 s4, 2
s_cbranch_scc1 L_att_nl0_1
L_att_nl0_0:
v_mfma_f32_16x16x32_bf16 v[16:19], a[0:3], a[160:163], v[96:99]
v_mfma_f32_16x16x32_bf16 v[16:19], a[4:7], a[164:167], v[16:19]
s_add_u32 m0, s27, 0x0
v_mfma_f32_16x16x32_bf16 v[16:19], a[8:11], a[168:171], v[16:19]
buffer_load_dwordx4 v3, s[48:51], s32 offen offset:0 sc1 lds
v_mfma_f32_16x16x32_bf16 v[16:19], a[12:15], a[172:175], v[16:19]
v_mfma_f32_16x16x32_bf16 v[20:23], a[0:3], a[176:179], v[84:87]
v_mfma_f32_16x16x32_bf16 v[20:23], a[4:7], a[180:183], v[20:23]
v_mfma_f32_16x16x32_bf16 v[20:23], a[8:11], a[184:187], v[20:23]
s_mov_b32 s9, 0x0
v_mfma_f32_16x16x32_bf16 v[20:23], a[12:15], a[188:191], v[20:23]
buffer_load_dword a244, v8, s[72:75], s9 offen
v_mfma_f32_16x16x32_bf16 v[24:27], a[0:3], a[192:195], v[88:91]
s_nop 0
v_exp_f32 v16, v16
v_mfma_f32_16x16x32_bf16 v[24:27], a[4:7], a[196:199], v[24:27]
v_exp_f32 v17, v17
v_mfma_f32_16x16x32_bf16 v[24:27], a[8:11], a[200:203], v[24:27]
v_exp_f32 v18, v18
v_mfma_f32_16x16x32_bf16 v[24:27], a[12:15], a[204:207], v[24:27]
v_exp_f32 v19, v19
v_mfma_f32_16x16x32_bf16 v[28:31], a[0:3], a[208:211], v[92:95]
buffer_load_dwordx4 v3, s[48:51], s32 offen offset:1024 sc1 lds
v_mfma_f32_16x16x32_bf16 v[28:31], a[4:7], a[212:215], v[28:31]
v_exp_f32 v20, v20
v_mfma_f32_16x16x32_bf16 v[28:31], a[8:11], a[216:219], v[28:31]
v_exp_f32 v21, v21
v_mfma_f32_16x16x32_bf16 v[28:31], a[12:15], a[220:223], v[28:31]
v_cvt_pk_bf16_f32 v48, v16, v17
v_cvt_pk_bf16_f32 v49, v18, v19
v_mfma_f32_16x16x32_bf16 v[32:35], a[16:19], a[160:163], v[100:103]
v_exp_f32 v22, v22
v_mfma_f32_16x16x32_bf16 v[32:35], a[20:23], a[164:167], v[32:35]
buffer_load_dwordx4 v3, s[48:51], s32 offen offset:2048 sc1 lds
v_mfma_f32_16x16x32_bf16 v[32:35], a[24:27], a[168:171], v[32:35]
v_cvt_pk_bf16_f32 v52, v20, v21
v_mfma_f32_16x16x32_bf16 v[32:35], a[28:31], a[172:175], v[32:35]
v_mfma_f32_16x16x32_bf16 v[36:39], a[16:19], a[176:179], v[84:87]
v_exp_f32 v23, v23
v_mfma_f32_16x16x32_bf16 v[36:39], a[20:23], a[180:183], v[36:39]
v_cvt_pk_bf16_f32 v53, v22, v23
v_mfma_f32_16x16x32_bf16 v[36:39], a[24:27], a[184:187], v[36:39]
buffer_load_dwordx4 v3, s[48:51], s32 offen offset:3072 sc1 lds
v_mfma_f32_16x16x32_bf16 v[36:39], a[28:31], a[188:191], v[36:39]
v_exp_f32 v24, v24
v_mfma_f32_16x16x32_bf16 v[40:43], a[16:19], a[192:195], v[88:91]
v_mfma_f32_16x16x32_bf16 v[40:43], a[20:23], a[196:199], v[40:43]
v_exp_f32 v25, v25
v_mfma_f32_16x16x32_bf16 v[40:43], a[24:27], a[200:203], v[40:43]
s_mov_b32 s9, 0x0
v_mfma_f32_16x16x32_bf16 v[40:43], a[28:31], a[204:207], v[40:43]
buffer_load_dword a244, v8, s[64:67], s9 offen
v_mfma_f32_16x16x32_bf16 v[44:47], a[16:19], a[208:211], v[92:95]
v_exp_f32 v26, v26
v_mfma_f32_16x16x32_bf16 v[44:47], a[20:23], a[212:215], v[44:47]
v_mfma_f32_16x16x32_bf16 v[44:47], a[24:27], a[216:219], v[44:47]
v_exp_f32 v27, v27
v_mfma_f32_16x16x32_bf16 v[44:47], a[28:31], a[220:223], v[44:47]
s_waitcnt lgkmcnt(0)
ds_read_b128 a[0:3], v1 offset:24576
ds_read_b128 a[4:7], v1 offset:25600
ds_read_b128 a[8:11], v1 offset:26624
ds_read_b128 a[12:15], v1 offset:27648
ds_read_b128 a[16:19], v1 offset:28672
ds_read_b128 a[20:23], v1 offset:29696
ds_read_b128 a[24:27], v1 offset:30720
ds_read_b128 a[28:31], v1 offset:31744
s_waitcnt lgkmcnt(7)
v_mfma_f32_16x16x32_bf16 v[20:23], a[0:3], a[176:179], v[84:87]
s_add_u32 m0, s27, 0x1000
v_exp_f32 v28, v28
s_waitcnt lgkmcnt(6)
v_mfma_f32_16x16x32_bf16 v[20:23], a[4:7], a[180:183], v[20:23]
buffer_load_dwordx4 v3, s[48:51], s7 offen offset:0 sc1 lds
s_waitcnt lgkmcnt(5)
v_mfma_f32_16x16x32_bf16 v[20:23], a[8:11], a[184:187], v[20:23]
v_exp_f32 v29, v29
s_waitcnt lgkmcnt(4)
v_mfma_f32_16x16x32_bf16 v[20:23], a[12:15], a[188:191], v[20:23]
ds_read_b128 a[32:35], v1 offset:16384
v_cvt_pk_bf16_f32 v56, v24, v25
v_cvt_pk_bf16_f32 v57, v26, v27
v_mfma_f32_16x16x32_bf16 v[24:27], a[0:3], a[192:195], v[88:91]
v_exp_f32 v30, v30
v_mfma_f32_16x16x32_bf16 v[24:27], a[4:7], a[196:199], v[24:27]
ds_read_b128 a[36:39], v1 offset:17408
v_cvt_pk_bf16_f32 v60, v28, v29
v_mfma_f32_16x16x32_bf16 v[24:27], a[8:11], a[200:203], v[24:27]
buffer_load_dwordx4 v3, s[48:51], s7 offen offset:1024 sc1 lds
v_mfma_f32_16x16x32_bf16 v[24:27], a[12:15], a[204:207], v[24:27]
ds_read_b128 a[40:43], v1 offset:18432
v_exp_f32 v31, v31
s_nop 0
v_cvt_pk_bf16_f32 v61, v30, v31
v_mfma_f32_16x16x32_bf16 v[28:31], a[0:3], a[208:211], v[92:95]
v_exp_f32 v32, v32
v_mfma_f32_16x16x32_bf16 v[28:31], a[4:7], a[212:215], v[28:31]
ds_read_b128 a[44:47], v1 offset:19456
v_exp_f32 v33, v33
v_mfma_f32_16x16x32_bf16 v[28:31], a[8:11], a[216:219], v[28:31]
buffer_load_dwordx4 v3, s[48:51], s7 offen offset:2048 sc1 lds
v_mfma_f32_16x16x32_bf16 v[28:31], a[12:15], a[220:223], v[28:31]
s_mov_b32 s9, 0x400000
v_exp_f32 v34, v34
v_exp_f32 v35, v35
v_exp_f32 v36, v36
v_exp_f32 v37, v37
v_exp_f32 v38, v38
v_exp_f32 v39, v39
v_cvt_pk_bf16_f32 v54, v36, v37
v_cvt_pk_bf16_f32 v55, v38, v39
s_waitcnt lgkmcnt(7)
v_mfma_f32_16x16x32_bf16 v[36:39], a[16:19], a[176:179], v[84:87]
ds_read_b128 a[48:51], v1 offset:20480
v_cvt_pk_bf16_f32 v50, v32, v33
s_waitcnt lgkmcnt(7)
v_mfma_f32_16x16x32_bf16 v[36:39], a[20:23], a[180:183], v[36:39]
ds_read_b128 a[52:55], v1 offset:21504
v_cvt_pk_bf16_f32 v51, v34, v35
s_waitcnt lgkmcnt(7)
v_mfma_f32_16x16x32_bf16 v[36:39], a[24:27], a[184:187], v[36:39]
buffer_load_dword a244, v8, s[64:67], s9 offen
s_waitcnt lgkmcnt(6)
v_mfma_f32_16x16x32_bf16 v[36:39], a[28:31], a[188:191], v[36:39]
ds_read_b128 a[56:59], v1 offset:22528
v_exp_f32 v40, v40
v_exp_f32 v41, v41
v_exp_f32 v42, v42
v_exp_f32 v43, v43
v_cvt_pk_bf16_f32 v58, v40, v41
v_cvt_pk_bf16_f32 v59, v42, v43
v_mfma_f32_16x16x32_bf16 v[40:43], a[16:19], a[192:195], v[88:91]
buffer_load_dwordx4 v3, s[48:51], s7 offen offset:3072 sc1 lds
v_mfma_f32_16x16x32_bf16 v[40:43], a[20:23], a[196:199], v[40:43]
ds_read_b128 a[60:63], v1 offset:23552
v_xor_b32 v1, 0x8000, v1
v_mfma_f32_16x16x32_bf16 v[40:43], a[24:27], a[200:203], v[40:43]
s_add_u32 s32, s32, 0x8000
v_exp_f32 v44, v44
v_mfma_f32_16x16x32_bf16 v[40:43], a[28:31], a[204:207], v[40:43]
s_add_u32 s7, s7, 0x8000
v_exp_f32 v45, v45
v_exp_f32 v46, v46
v_exp_f32 v47, v47
v_cvt_pk_bf16_f32 v62, v44, v45
v_cvt_pk_bf16_f32 v63, v46, v47
v_mfma_f32_16x16x32_bf16 v[44:47], a[16:19], a[208:211], v[92:95]
s_xor_b32 s27, s27, 0x38000
v_exp_f32 v20, v20
v_mfma_f32_16x16x32_bf16 v[44:47], a[20:23], a[212:215], v[44:47]
v_exp_f32 v21, v21
v_mfma_f32_16x16x32_bf16 v[44:47], a[24:27], a[216:219], v[44:47]
s_waitcnt vmcnt(11) lgkmcnt(0)
v_exp_f32 v22, v22
v_mfma_f32_16x16x32_bf16 v[44:47], a[28:31], a[220:223], v[44:47]
s_barrier
v_cvt_pk_bf16_f32 v68, v20, v21
v_exp_f32 v23, v23
v_exp_f32 v24, v24
v_exp_f32 v25, v25
v_exp_f32 v26, v26
v_exp_f32 v27, v27
v_cvt_pk_bf16_f32 v69, v22, v23
s_cmp_lg_u32 s33, 0
s_cbranch_scc1 L_sig_bn0
s_lshl_b32 s8, s6, 2
s_add_u32 s8, s8, 192
s_cmp_lg_u32 s4, 0
s_cbranch_scc1 L_sig_bn0
v_mov_b32 v4, 1
s_mov_b64 exec, 1
buffer_atomic_add v4, off, s[84:87], s8 sc1
s_mov_b64 exec, -1
L_sig_bn0:
s_branch L_att_l1_0
L_att_nl0_1:
v_mfma_f32_16x16x32_bf16 v[16:19], a[0:3], a[160:163], v[80:83]
v_mfma_f32_16x16x32_bf16 v[16:19], a[4:7], a[164:167], v[16:19]
s_add_u32 m0, s27, 0x0
v_mfma_f32_16x16x32_bf16 v[16:19], a[8:11], a[168:171], v[16:19]
buffer_load_dwordx4 v3, s[48:51], s32 offen offset:0 sc1 lds
v_mfma_f32_16x16x32_bf16 v[16:19], a[12:15], a[172:175], v[16:19]
v_mfma_f32_16x16x32_bf16 v[20:23], a[0:3], a[176:179], v[84:87]
v_mfma_f32_16x16x32_bf16 v[20:23], a[4:7], a[180:183], v[20:23]
v_mfma_f32_16x16x32_bf16 v[20:23], a[8:11], a[184:187], v[20:23]
s_mov_b32 s9, 0x0
v_mfma_f32_16x16x32_bf16 v[20:23], a[12:15], a[188:191], v[20:23]
buffer_load_dword a244, v8, s[72:75], s9 offen
v_mfma_f32_16x16x32_bf16 v[24:27], a[0:3], a[192:195], v[88:91]
s_nop 0
v_exp_f32 v16, v16
v_mfma_f32_16x16x32_bf16 v[24:27], a[4:7], a[196:199], v[24:27]
v_exp_f32 v17, v17
v_mfma_f32_16x16x32_bf16 v[24:27], a[8:11], a[200:203], v[24:27]
v_exp_f32 v18, v18
v_mfma_f32_16x16x32_bf16 v[24:27], a[12:15], a[204:207], v[24:27]
v_exp_f32 v19, v19
v_mfma_f32_16x16x32_bf16 v[28:31], a[0:3], a[208:211], v[92:95]
buffer_load_dwordx4 v3, s[48:51], s32 offen offset:1024 sc1 lds
v_mfma_f32_16x16x32_bf16 v[28:31], a[4:7], a[212:215], v[28:31]
v_exp_f32 v20, v20
v_mfma_f32_16x16x32_bf16 v[28:31], a[8:11], a[216:219], v[28:31]
v_exp_f32 v21, v21
v_mfma_f32_16x16x32_bf16 v[28:31], a[12:15], a[220:223], v[28:31]
v_cvt_pk_bf16_f32 v48, v16, v17
v_cvt_pk_bf16_f32 v49, v18, v19
v_mfma_f32_16x16x32_bf16 v[32:35], a[16:19], a[160:163], v[80:83]
v_exp_f32 v22, v22
v_mfma_f32_16x16x32_bf16 v[32:35], a[20:23], a[164:167], v[32:35]
buffer_load_dwordx4 v3, s[48:51], s32 offen offset:2048 sc1 lds
v_mfma_f32_16x16x32_bf16 v[32:35], a[24:27], a[168:171], v[32:35]
v_cvt_pk_bf16_f32 v52, v20, v21
v_mfma_f32_16x16x32_bf16 v[32:35], a[28:31], a[172:175], v[32:35]
v_mfma_f32_16x16x32_bf16 v[36:39], a[16:19], a[176:179], v[84:87]
v_exp_f32 v23, v23
v_mfma_f32_16x16x32_bf16 v[36:39], a[20:23], a[180:183], v[36:39]
v_cvt_pk_bf16_f32 v53, v22, v23
v_mfma_f32_16x16x32_bf16 v[36:39], a[24:27], a[184:187], v[36:39]
buffer_load_dwordx4 v3, s[48:51], s32 offen offset:3072 sc1 lds
v_mfma_f32_16x16x32_bf16 v[36:39], a[28:31], a[188:191], v[36:39]
v_exp_f32 v24, v24
v_mfma_f32_16x16x32_bf16 v[40:43], a[16:19], a[192:195], v[88:91]
v_mfma_f32_16x16x32_bf16 v[40:43], a[20:23], a[196:199], v[40:43]
v_exp_f32 v25, v25
v_mfma_f32_16x16x32_bf16 v[40:43], a[24:27], a[200:203], v[40:43]
s_mov_b32 s9, 0x0
v_mfma_f32_16x16x32_bf16 v[40:43], a[28:31], a[204:207], v[40:43]
buffer_load_dword a244, v8, s[64:67], s9 offen
v_mfma_f32_16x16x32_bf16 v[44:47], a[16:19], a[208:211], v[92:95]
v_exp_f32 v26, v26
v_mfma_f32_16x16x32_bf16 v[44:47], a[20:23], a[212:215], v[44:47]
v_mfma_f32_16x16x32_bf16 v[44:47], a[24:27], a[216:219], v[44:47]
v_exp_f32 v27, v27
v_mfma_f32_16x16x32_bf16 v[44:47], a[28:31], a[220:223], v[44:47]
s_waitcnt lgkmcnt(0)
ds_read_b128 a[0:3], v1 offset:24576
ds_read_b128 a[4:7], v1 offset:25600
ds_read_b128 a[8:11], v1 offset:26624
ds_read_b128 a[12:15], v1 offset:27648
ds_read_b128 a[16:19], v1 offset:28672
ds_read_b128 a[20:23], v1 offset:29696
ds_read_b128 a[24:27], v1 offset:30720
ds_read_b128 a[28:31], v1 offset:31744
s_waitcnt lgkmcnt(7)
v_mfma_f32_16x16x32_bf16 v[16:19], a[0:3], a[160:163], v[96:99]
ds_read_b128 a[32:35], v1 offset:16384
v_cvt_pk_bf16_f32 v56, v24, v25
s_waitcnt lgkmcnt(7)
v_mfma_f32_16x16x32_bf16 v[16:19], a[4:7], a[164:167], v[16:19]
s_add_u32 m0, s27, 0x1000
v_exp_f32 v28, v28
s_waitcnt lgkmcnt(6)
v_mfma_f32_16x16x32_bf16 v[16:19], a[8:11], a[168:171], v[16:19]
buffer_load_dwordx4 v3, s[48:51], s7 offen offset:0 sc1 lds
s_waitcnt lgkmcnt(5)
v_mfma_f32_16x16x32_bf16 v[16:19], a[12:15], a[172:175], v[16:19]
ds_read_b128 a[36:39], v1 offset:17408
v_cvt_pk_bf16_f32 v57, v26, v27
v_mfma_f32_16x16x32_bf16 v[20:23], a[0:3], a[176:179], v[84:87]
v_exp_f32 v29, v29
v_mfma_f32_16x16x32_bf16 v[20:23], a[4:7], a[180:183], v[20:23]
v_exp_f32 v30, v30
v_mfma_f32_16x16x32_bf16 v[20:23], a[8:11], a[184:187], v[20:23]
ds_read_b128 a[40:43], v1 offset:18432
v_cvt_pk_bf16_f32 v60, v28, v29
v_mfma_f32_16x16x32_bf16 v[20:23], a[12:15], a[188:191], v[20:23]
buffer_load_dwordx4 v3, s[48:51], s7 offen offset:1024 sc1 lds
v_mfma_f32_16x16x32_bf16 v[24:27], a[0:3], a[192:195], v[88:91]
v_exp_f32 v31, v31
v_mfma_f32_16x16x32_bf16 v[24:27], a[4:7], a[196:199], v[24:27]
ds_read_b128 a[44:47], v1 offset:19456
v_cvt_pk_bf16_f32 v61, v30, v31
v_mfma_f32_16x16x32_bf16 v[24:27], a[8:11], a[200:203], v[24:27]
v_exp_f32 v32, v32
v_mfma_f32_16x16x32_bf16 v[24:27], a[12:15], a[204:207], v[24:27]
v_exp_f32 v33, v33
v_mfma_f32_16x16x32_bf16 v[28:31], a[0:3], a[208:211], v[92:95]
v_exp_f32 v34, v34
v_mfma_f32_16x16x32_bf16 v[28:31], a[4:7], a[212:215], v[28:31]
buffer_load_dwordx4 v3, s[48:51], s7 offen offset:2048 sc1 lds
v_mfma_f32_16x16x32_bf16 v[28:31], a[8:11], a[216:219], v[28:31]
ds_read_b128 a[48:51], v1 offset:20480
v_cvt_pk_bf16_f32 v50, v32, v33
v_mfma_f32_16x16x32_bf16 v[28:31], a[12:15], a[220:223], v[28:31]
v_exp_f32 v35, v35
s_nop 0
v_cvt_pk_bf16_f32 v51, v34, v35
s_waitcnt lgkmcnt(8)
v_mfma_f32_16x16x32_bf16 v[32:35], a[16:19], a[160:163], v[100:103]
ds_read_b128 a[52:55], v1 offset:21504
v_exp_f32 v36, v36
s_waitcnt lgkmcnt(8)
v_mfma_f32_16x16x32_bf16 v[32:35], a[20:23], a[164:167], v[32:35]
s_mov_b32 s9, 0x400000
v_exp_f32 v37, v37
s_waitcnt lgkmcnt(7)
v_mfma_f32_16x16x32_bf16 v[32:35], a[24:27], a[168:171], v[32:35]
buffer_load_dword a244, v8, s[64:67], s9 offen
s_waitcnt lgkmcnt(6)
v_mfma_f32_16x16x32_bf16 v[32:35], a[28:31], a[172:175], v[32:35]
ds_read_b128 a[56:59], v1 offset:22528
v_cvt_pk_bf16_f32 v54, v36, v37
v_exp_f32 v38, v38
v_exp_f32 v39, v39
s_nop 0
v_cvt_pk_bf16_f32 v55, v38, v39
v_mfma_f32_16x16x32_bf16 v[36:39], a[16:19], a[176:179], v[84:87]
v_exp_f32 v40, v40
v_mfma_f32_16x16x32_bf16 v[36:39], a[20:23], a[180:183], v[36:39]
v_exp_f32 v41, v41
v_mfma_f32_16x16x32_bf16 v[36:39], a[24:27], a[184:187], v[36:39]
ds_read_b128 a[60:63], v1 offset:23552
v_xor_b32 v1, 0x8000, v1
v_mfma_f32_16x16x32_bf16 v[36:39], a[28:31], a[188:191], v[36:39]
buffer_load_dwordx4 v3, s[48:51], s7 offen offset:3072 sc1 lds
v_exp_f32 v42, v42
v_exp_f32 v43, v43
v_cvt_pk_bf16_f32 v58, v40, v41
v_cvt_pk_bf16_f32 v59, v42, v43
v_mfma_f32_16x16x32_bf16 v[40:43], a[16:19], a[192:195], v[88:91]
s_add_u32 s32, s32, 0x8000
v_exp_f32 v44, v44
v_mfma_f32_16x16x32_bf16 v[40:43], a[20:23], a[196:199], v[40:43]
s_add_u32 s7, s7, 0x8000
v_exp_f32 v45, v45
v_mfma_f32_16x16x32_bf16 v[40:43], a[24:27], a[200:203], v[40:43]
s_xor_b32 s27, s27, 0x38000
v_exp_f32 v46, v46
v_mfma_f32_16x16x32_bf16 v[40:43], a[28:31], a[204:207], v[40:43]
v_exp_f32 v47, v47
v_cvt_pk_bf16_f32 v62, v44, v45
v_cvt_pk_bf16_f32 v63, v46, v47
v_mfma_f32_16x16x32_bf16 v[44:47], a[16:19], a[208:211], v[92:95]
v_exp_f32 v16, v16
v_mfma_f32_16x16x32_bf16 v[44:47], a[20:23], a[212:215], v[44:47]
v_exp_f32 v17, v17
v_mfma_f32_16x16x32_bf16 v[44:47], a[24:27], a[216:219], v[44:47]
s_waitcnt vmcnt(11) lgkmcnt(0)
v_exp_f32 v18, v18
v_mfma_f32_16x16x32_bf16 v[44:47], a[28:31], a[220:223], v[44:47]
s_barrier
v_cvt_pk_bf16_f32 v64, v16, v17
v_exp_f32 v19, v19
v_exp_f32 v20, v20
v_exp_f32 v21, v21
v_exp_f32 v22, v22
v_exp_f32 v23, v23
v_exp_f32 v24, v24
v_exp_f32 v25, v25
v_exp_f32 v26, v26
v_exp_f32 v27, v27
v_cvt_pk_bf16_f32 v65, v18, v19
v_cvt_pk_bf16_f32 v68, v20, v21
v_cvt_pk_bf16_f32 v69, v22, v23
s_cmp_lg_u32 s33, 0
s_cbranch_scc1 L_sig_bn1
s_lshl_b32 s8, s6, 2
s_add_u32 s8, s8, 192
s_cmp_lg_u32 s4, 0
s_cbranch_scc1 L_sig_bn1
v_mov_b32 v4, 1
s_mov_b64 exec, 1
buffer_atomic_add v4, off, s[84:87], s8 sc1
s_mov_b64 exec, -1
L_sig_bn1:
s_branch L_att_l1_1
L_att_seven0:
v_mfma_f32_16x16x32_bf16 v[192:195], a[32:35], v[56:59], v[192:195]
v_exp_f32 v30, v30
v_mfma_f32_16x16x32_bf16 v[224:227], a[32:35], v[60:63], v[224:227]
ds_read_b128 a[0:3], v1 offset:8192
v_cvt_pk_bf16_f32 v72, v24, v25
v_mfma_f32_16x16x32_bf16 v[228:231], a[36:39], v[60:63], v[228:231]
ds_read_b128 a[4:7], v1 offset:9216
v_cvt_pk_bf16_f32 v73, v26, v27
v_mfma_f32_16x16x32_bf16 v[196:199], a[36:39], v[56:59], v[196:199]
s_add_u32 m0, s27, 0x0
v_exp_f32 v31, v31
v_mfma_f32_16x16x32_bf16 v[200:203], a[40:43], v[56:59], v[200:203]
ds_read_b128 a[8:11], v1 offset:10240
v_cvt_pk_bf16_f32 v76, v28, v29
v_mfma_f32_16x16x32_bf16 v[232:235], a[40:43], v[60:63], v[232:235]
buffer_load_dwordx4 v3, s[48:51], s32 offen offset:0 sc1 lds
v_mfma_f32_16x16x32_bf16 v[236:239], a[44:47], v[60:63], v[236:239]
v_exp_f32 v40, v40
v_mfma_f32_16x16x32_bf16 v[204:207], a[44:47], v[56:59], v[204:207]
ds_read_b128 a[12:15], v1 offset:11264
v_cvt_pk_bf16_f32 v77, v30, v31
v_mfma_f32_16x16x32_bf16 v[208:211], a[48:51], v[56:59], v[208:211]
ds_read_b128 a[16:19], v1 offset:12288
v_mfma_f32_16x16x32_bf16 v[240:243], a[48:51], v[60:63], v[240:243]
buffer_load_dwordx4 v3, s[48:51], s32 offen offset:1024 sc1 lds
v_mfma_f32_16x16x32_bf16 v[244:247], a[52:55], v[60:63], v[244:247]
ds_read_b128 a[20:23], v1 offset:13312
v_mfma_f32_16x16x32_bf16 v[212:215], a[52:55], v[56:59], v[212:215]
ds_read_b128 a[24:27], v1 offset:14336
v_mfma_f32_16x16x32_bf16 v[216:219], a[56:59], v[56:59], v[216:219]
ds_read_b128 a[28:31], v1 offset:15360
v_mfma_f32_16x16x32_bf16 v[248:251], a[56:59], v[60:63], v[248:251]
ds_read_b128 a[32:35], v1 offset:0
v_exp_f32 v41, v41
v_mfma_f32_16x16x32_bf16 v[252:255], a[60:63], v[60:63], v[252:255]
v_exp_f32 v42, v42
v_mfma_f32_16x16x32_bf16 v[220:223], a[60:63], v[56:59], v[220:223]
s_waitcnt lgkmcnt(5)
v_exp_f32 v43, v43
v_smfmac_f32_16x16x64_bf16 a[228:231], a[232:235], v[56:63], v9
ds_read_b128 a[36:39], v1 offset:1024
v_cvt_pk_bf16_f32 v74, v40, v41
v_mfma_f32_16x16x32_bf16 v[24:27], a[0:3], a[192:195], v[88:91]
ds_read_b128 a[40:43], v1 offset:2048
v_exp_f32 v44, v44
v_mfma_f32_16x16x32_bf16 v[24:27], a[4:7], a[196:199], v[24:27]
buffer_load_dwordx4 v3, s[48:51], s32 offen offset:2048 sc1 lds
v_mfma_f32_16x16x32_bf16 v[24:27], a[8:11], a[200:203], v[24:27]
v_exp_f32 v45, v45
v_mfma_f32_16x16x32_bf16 v[24:27], a[12:15], a[204:207], v[24:27]
ds_read_b128 a[44:47], v1 offset:3072
v_cvt_pk_bf16_f32 v75, v42, v43
v_mfma_f32_16x16x32_bf16 v[28:31], a[0:3], a[208:211], v[92:95]
ds_read_b128 a[48:51], v1 offset:4096
v_exp_f32 v46, v46
v_mfma_f32_16x16x32_bf16 v[28:31], a[4:7], a[212:215], v[28:31]
s_waitcnt lgkmcnt(5)
v_exp_f32 v47, v47
v_mfma_f32_16x16x32_bf16 v[28:31], a[8:11], a[216:219], v[28:31]
ds_read_b128 a[52:55], v1 offset:5120
v_cvt_pk_bf16_f32 v78, v44, v45
v_mfma_f32_16x16x32_bf16 v[28:31], a[12:15], a[220:223], v[28:31]
buffer_load_dwordx4 v3, s[48:51], s32 offen offset:3072 sc1 lds
v_mfma_f32_16x16x32_bf16 v[40:43], a[16:19], a[192:195], v[88:91]
ds_read_b128 a[56:59], v1 offset:6144
s_add_u32 s32, s32, 0x8000
v_mfma_f32_16x16x32_bf16 v[40:43], a[20:23], a[196:199], v[40:43]
ds_read_b128 a[60:63], v1 offset:7168
v_cvt_pk_bf16_f32 v79, v46, v47
v_mfma_f32_16x16x32_bf16 v[40:43], a[24:27], a[200:203], v[40:43]
v_exp_f32 v24, v24
v_mfma_f32_16x16x32_bf16 v[40:43], a[28:31], a[204:207], v[40:43]
v_exp_f32 v25, v25
v_mfma_f32_16x16x32_bf16 v[44:47], a[16:19], a[208:211], v[92:95]
v_exp_f32 v26, v26
v_mfma_f32_16x16x32_bf16 v[44:47], a[20:23], a[212:215], v[44:47]
v_exp_f32 v27, v27
v_mfma_f32_16x16x32_bf16 v[44:47], a[24:27], a[216:219], v[44:47]
v_exp_f32 v28, v28
v_mfma_f32_16x16x32_bf16 v[44:47], a[28:31], a[220:223], v[44:47]
s_waitcnt lgkmcnt(0)
v_exp_f32 v29, v29
v_mfma_f32_16x16x32_bf16 v[192:195], a[32:35], v[72:75], v[192:195]
s_add_u32 m0, s27, 0x1000
v_exp_f32 v30, v30
v_mfma_f32_16x16x32_bf16 v[224:227], a[32:35], v[76:79], v[224:227]
buffer_load_dwordx4 v3, s[48:51], s7 offen offset:0 sc1 lds
v_mfma_f32_16x16x32_bf16 v[228:231], a[36:39], v[76:79], v[228:231]
v_exp_f32 v31, v31
v_mfma_f32_16x16x32_bf16 v[196:199], a[36:39], v[72:75], v[196:199]
ds_read_b128 a[0:3], v1 offset:24576
v_cvt_pk_bf16_f32 v56, v24, v25
v_mfma_f32_16x16x32_bf16 v[200:203], a[40:43], v[72:75], v[200:203]
ds_read_b128 a[4:7], v1 offset:25600
v_cvt_pk_bf16_f32 v57, v26, v27
v_mfma_f32_16x16x32_bf16 v[232:235], a[40:43], v[76:79], v[232:235]
v_exp_f32 v40, v40
v_mfma_f32_16x16x32_bf16 v[236:239], a[44:47], v[76:79], v[236:239]
ds_read_b128 a[8:11], v1 offset:26624
v_cvt_pk_bf16_f32 v60, v28, v29
v_mfma_f32_16x16x32_bf16 v[204:207], a[44:47], v[72:75], v[204:207]
v_exp_f32 v41, v41
v_mfma_f32_16x16x32_bf16 v[208:211], a[48:51], v[72:75], v[208:211]
ds_read_b128 a[12:15], v1 offset:27648
v_cvt_pk_bf16_f32 v61, v30, v31
v_mfma_f32_16x16x32_bf16 v[240:243], a[48:51], v[76:79], v[240:243]
ds_read_b128 a[16:19], v1 offset:28672
v_cvt_pk_bf16_f32 v58, v40, v41
v_mfma_f32_16x16x32_bf16 v[244:247], a[52:55], v[76:79], v[244:247]
v_exp_f32 v42, v42
v_mfma_f32_16x16x32_bf16 v[212:215], a[52:55], v[72:75], v[212:215]
buffer_load_dwordx4 v3, s[48:51], s7 offen offset:1024 sc1 lds
v_mfma_f32_16x16x32_bf16 v[216:219], a[56:59], v[72:75], v[216:219]
ds_read_b128 a[20:23], v1 offset:29696
v_mfma_f32_16x16x32_bf16 v[248:251], a[56:59], v[76:79], v[248:251]
ds_read_b128 a[24:27], v1 offset:30720
v_mfma_f32_16x16x32_bf16 v[252:255], a[60:63], v[76:79], v[252:255]
ds_read_b128 a[28:31], v1 offset:31744
v_mfma_f32_16x16x32_bf16 v[220:223], a[60:63], v[72:75], v[220:223]
s_waitcnt lgkmcnt(4)
v_exp_f32 v43, v43
v_smfmac_f32_16x16x64_bf16 a[228:231], a[232:235], v[72:79], v9
ds_read_b128 a[32:35], v1 offset:16384
v_cvt_pk_bf16_f32 v59, v42, v43
v_mfma_f32_16x16x32_bf16 v[24:27], a[0:3], a[192:195], v[88:91]
ds_read_b128 a[36:39], v1 offset:17408
v_mfma_f32_16x16x32_bf16 v[24:27], a[4:7], a[196:199], v[24:27]
buffer_load_dwordx4 v3, s[48:51], s7 offen offset:2048 sc1 lds
v_mfma_f32_16x16x32_bf16 v[24:27], a[8:11], a[200:203], v[24:27]
ds_read_b128 a[40:43], v1 offset:18432
v_exp_f32 v44, v44
v_mfma_f32_16x16x32_bf16 v[24:27], a[12:15], a[204:207], v[24:27]
ds_read_b128 a[44:47], v1 offset:19456
v_exp_f32 v45, v45
v_mfma_f32_16x16x32_bf16 v[28:31], a[0:3], a[208:211], v[92:95]
ds_read_b128 a[48:51], v1 offset:20480
v_exp_f32 v46, v46
v_mfma_f32_16x16x32_bf16 v[28:31], a[4:7], a[212:215], v[28:31]
s_waitcnt lgkmcnt(5)
v_exp_f32 v47, v47
v_mfma_f32_16x16x32_bf16 v[28:31], a[8:11], a[216:219], v[28:31]
ds_read_b128 a[52:55], v1 offset:21504
v_cvt_pk_bf16_f32 v62, v44, v45
v_mfma_f32_16x16x32_bf16 v[28:31], a[12:15], a[220:223], v[28:31]
ds_read_b128 a[56:59], v1 offset:22528
v_cvt_pk_bf16_f32 v63, v46, v47
v_mfma_f32_16x16x32_bf16 v[40:43], a[16:19], a[192:195], v[88:91]
ds_read_b128 a[60:63], v1 offset:23552
v_xor_b32 v1, 0x8000, v1
v_mfma_f32_16x16x32_bf16 v[40:43], a[20:23], a[196:199], v[40:43]
buffer_load_dwordx4 v3, s[48:51], s7 offen offset:3072 sc1 lds
v_mfma_f32_16x16x32_bf16 v[40:43], a[24:27], a[200:203], v[40:43]
s_add_u32 s7, s7, 0x8000
v_exp_f32 v24, v24
v_mfma_f32_16x16x32_bf16 v[40:43], a[28:31], a[204:207], v[40:43]
s_xor_b32 s27, s27, 0x38000
v_exp_f32 v25, v25
v_mfma_f32_16x16x32_bf16 v[44:47], a[16:19], a[208:211], v[92:95]
v_exp_f32 v26, v26
v_mfma_f32_16x16x32_bf16 v[44:47], a[20:23], a[212:215], v[44:47]
v_exp_f32 v27, v27
v_mfma_f32_16x16x32_bf16 v[44:47], a[24:27], a[216:219], v[44:47]
s_waitcnt vmcnt(16) lgkmcnt(0)
v_exp_f32 v28, v28
v_mfma_f32_16x16x32_bf16 v[44:47], a[28:31], a[220:223], v[44:47]
s_barrier
v_exp_f32 v29, v29
L_att_sodd0:
v_mfma_f32_16x16x32_bf16 v[192:195], a[32:35], v[56:59], v[192:195]
v_exp_f32 v30, v30
v_mfma_f32_16x16x32_bf16 v[224:227], a[32:35], v[60:63], v[224:227]
ds_read_b128 a[0:3], v2 offset:8192
v_cvt_pk_bf16_f32 v72, v24, v25
v_mfma_f32_16x16x32_bf16 v[228:231], a[36:39], v[60:63], v[228:231]
ds_read_b128 a[4:7], v2 offset:9216
v_cvt_pk_bf16_f32 v73, v26, v27
v_mfma_f32_16x16x32_bf16 v[196:199], a[36:39], v[56:59], v[196:199]
s_add_u32 m0, s19, 0x0
v_exp_f32 v31, v31
v_mfma_f32_16x16x32_bf16 v[200:203], a[40:43], v[56:59], v[200:203]
ds_read_b128 a[8:11], v2 offset:10240
v_cvt_pk_bf16_f32 v76, v28, v29
v_mfma_f32_16x16x32_bf16 v[232:235], a[40:43], v[60:63], v[232:235]
buffer_load_dwordx4 v3, s[48:51], s32 offen offset:0 sc1 lds
v_mfma_f32_16x16x32_bf16 v[236:239], a[44:47], v[60:63], v[236:239]
v_exp_f32 v40, v40
v_mfma_f32_16x16x32_bf16 v[204:207], a[44:47], v[56:59], v[204:207]
ds_read_b128 a[12:15], v2 offset:11264
v_cvt_pk_bf16_f32 v77, v30, v31
v_mfma_f32_16x16x32_bf16 v[208:211], a[48:51], v[56:59], v[208:211]
ds_read_b128 a[16:19], v2 offset:12288
v_mfma_f32_16x16x32_bf16 v[240:243], a[48:51], v[60:63], v[240:243]
buffer_load_dwordx4 v3, s[48:51], s32 offen offset:1024 sc1 lds
v_mfma_f32_16x16x32_bf16 v[244:247], a[52:55], v[60:63], v[244:247]
ds_read_b128 a[20:23], v2 offset:13312
v_mfma_f32_16x16x32_bf16 v[212:215], a[52:55], v[56:59], v[212:215]
ds_read_b128 a[24:27], v2 offset:14336
v_mfma_f32_16x16x32_bf16 v[216:219], a[56:59], v[56:59], v[216:219]
ds_read_b128 a[28:31], v2 offset:15360
v_mfma_f32_16x16x32_bf16 v[248:251], a[56:59], v[60:63], v[248:251]
ds_read_b128 a[32:35], v2 offset:0
v_exp_f32 v41, v41
v_mfma_f32_16x16x32_bf16 v[252:255], a[60:63], v[60:63], v[252:255]
v_exp_f32 v42, v42
v_mfma_f32_16x16x32_bf16 v[220:223], a[60:63], v[56:59], v[220:223]
s_waitcnt lgkmcnt(5)
v_exp_f32 v43, v43
v_smfmac_f32_16x16x64_bf16 a[228:231], a[232:235], v[56:63], v9
ds_read_b128 a[36:39], v2 offset:1024
v_cvt_pk_bf16_f32 v74, v40, v41
v_mfma_f32_16x16x32_bf16 v[24:27], a[0:3], a[192:195], v[88:91]
ds_read_b128 a[40:43], v2 offset:2048
v_exp_f32 v44, v44
v_mfma_f32_16x16x32_bf16 v[24:27], a[4:7], a[196:199], v[24:27]
buffer_load_dwordx4 v3, s[48:51], s32 offen offset:2048 sc1 lds
v_mfma_f32_16x16x32_bf16 v[24:27], a[8:11], a[200:203], v[24:27]
v_exp_f32 v45, v45
v_mfma_f32_16x16x32_bf16 v[24:27], a[12:15], a[204:207], v[24:27]
ds_read_b128 a[44:47], v2 offset:3072
v_cvt_pk_bf16_f32 v75, v42, v43
v_mfma_f32_16x16x32_bf16 v[28:31], a[0:3], a[208:211], v[92:95]
ds_read_b128 a[48:51], v2 offset:4096
v_exp_f32 v46, v46
v_mfma_f32_16x16x32_bf16 v[28:31], a[4:7], a[212:215], v[28:31]
s_waitcnt lgkmcnt(5)
v_exp_f32 v47, v47
v_mfma_f32_16x16x32_bf16 v[28:31], a[8:11], a[216:219], v[28:31]
ds_read_b128 a[52:55], v2 offset:5120
v_cvt_pk_bf16_f32 v78, v44, v45
v_mfma_f32_16x16x32_bf16 v[28:31], a[12:15], a[220:223], v[28:31]
buffer_load_dwordx4 v3, s[48:51], s32 offen offset:3072 sc1 lds
v_mfma_f32_16x16x32_bf16 v[40:43], a[16:19], a[192:195], v[88:91]
ds_read_b128 a[56:59], v2 offset:6144
s_add_u32 s32, s32, 0x8000
v_mfma_f32_16x16x32_bf16 v[40:43], a[20:23], a[196:199], v[40:43]
ds_read_b128 a[60:63], v2 offset:7168
v_cvt_pk_bf16_f32 v79, v46, v47
v_mfma_f32_16x16x32_bf16 v[40:43], a[24:27], a[200:203], v[40:43]
v_exp_f32 v24, v24
v_mfma_f32_16x16x32_bf16 v[40:43], a[28:31], a[204:207], v[40:43]
v_exp_f32 v25, v25
v_mfma_f32_16x16x32_bf16 v[44:47], a[16:19], a[208:211], v[92:95]
v_exp_f32 v26, v26
v_mfma_f32_16x16x32_bf16 v[44:47], a[20:23], a[212:215], v[44:47]
v_exp_f32 v27, v27
v_mfma_f32_16x16x32_bf16 v[44:47], a[24:27], a[216:219], v[44:47]
v_exp_f32 v28, v28
v_mfma_f32_16x16x32_bf16 v[44:47], a[28:31], a[220:223], v[44:47]
s_waitcnt lgkmcnt(0)
v_exp_f32 v29, v29
v_mfma_f32_16x16x32_bf16 v[192:195], a[32:35], v[72:75], v[192:195]
v_exp_f32 v30, v30
v_mfma_f32_16x16x32_bf16 v[224:227], a[32:35], v[76:79], v[224:227]
v_exp_f32 v31, v31
v_mfma_f32_16x16x32_bf16 v[228:231], a[36:39], v[76:79], v[228:231]
v_exp_f32 v40, v40
v_mfma_f32_16x16x32_bf16 v[196:199], a[36:39], v[72:75], v[196:199]
s_add_u32 m0, s19, 0x1000
v_exp_f32 v41, v41
v_mfma_f32_16x16x32_bf16 v[200:203], a[40:43], v[72:75], v[200:203]
ds_read_b128 a[0:3], v2 offset:24576
v_cvt_pk_bf16_f32 v56, v24, v25
v_mfma_f32_16x16x32_bf16 v[232:235], a[40:43], v[76:79], v[232:235]
buffer_load_dwordx4 v3, s[48:51], s7 offen offset:0 sc1 lds
v_mfma_f32_16x16x32_bf16 v[236:239], a[44:47], v[76:79], v[236:239]
ds_read_b128 a[4:7], v2 offset:25600
v_cvt_pk_bf16_f32 v57, v26, v27
v_mfma_f32_16x16x32_bf16 v[204:207], a[44:47], v[72:75], v[204:207]
ds_read_b128 a[8:11], v2 offset:26624
v_cvt_pk_bf16_f32 v60, v28, v29
v_mfma_f32_16x16x32_bf16 v[208:211], a[48:51], v[72:75], v[208:211]
ds_read_b128 a[12:15], v2 offset:27648
v_cvt_pk_bf16_f32 v61, v30, v31
v_mfma_f32_16x16x32_bf16 v[240:243], a[48:51], v[76:79], v[240:243]
ds_read_b128 a[16:19], v2 offset:28672
v_cvt_pk_bf16_f32 v58, v40, v41
v_mfma_f32_16x16x32_bf16 v[244:247], a[52:55], v[76:79], v[244:247]
buffer_load_dwordx4 v3, s[48:51], s7 offen offset:1024 sc1 lds
v_mfma_f32_16x16x32_bf16 v[212:215], a[52:55], v[72:75], v[212:215]
ds_read_b128 a[20:23], v2 offset:29696
v_mfma_f32_16x16x32_bf16 v[216:219], a[56:59], v[72:75], v[216:219]
v_exp_f32 v42, v42
v_mfma_f32_16x16x32_bf16 v[248:251], a[56:59], v[76:79], v[248:251]
ds_read_b128 a[24:27], v2 offset:30720
v_mfma_f32_16x16x32_bf16 v[252:255], a[60:63], v[76:79], v[252:255]
ds_read_b128 a[28:31], v2 offset:31744
v_exp_f32 v43, v43
v_mfma_f32_16x16x32_bf16 v[220:223], a[60:63], v[72:75], v[220:223]
ds_read_b128 a[32:35], v2 offset:16384
v_cvt_pk_bf16_f32 v59, v42, v43
v_smfmac_f32_16x16x64_bf16 a[228:231], a[232:235], v[72:79], v9
ds_read_b128 a[36:39], v2 offset:17408
s_waitcnt lgkmcnt(6)
v_mfma_f32_16x16x32_bf16 v[24:27], a[0:3], a[192:195], v[88:91]
buffer_load_dwordx4 v3, s[48:51], s7 offen offset:2048 sc1 lds
v_mfma_f32_16x16x32_bf16 v[24:27], a[4:7], a[196:199], v[24:27]
ds_read_b128 a[40:43], v2 offset:18432
v_exp_f32 v44, v44
v_mfma_f32_16x16x32_bf16 v[24:27], a[8:11], a[200:203], v[24:27]
ds_read_b128 a[44:47], v2 offset:19456
v_exp_f32 v45, v45
v_mfma_f32_16x16x32_bf16 v[24:27], a[12:15], a[204:207], v[24:27]
ds_read_b128 a[48:51], v2 offset:20480
v_cvt_pk_bf16_f32 v62, v44, v45
v_mfma_f32_16x16x32_bf16 v[28:31], a[0:3], a[208:211], v[92:95]
v_exp_f32 v46, v46
v_mfma_f32_16x16x32_bf16 v[28:31], a[4:7], a[212:215], v[28:31]
s_waitcnt lgkmcnt(5)
v_exp_f32 v47, v47
v_mfma_f32_16x16x32_bf16 v[28:31], a[8:11], a[216:219], v[28:31]
ds_read_b128 a[52:55], v2 offset:21504
v_cvt_pk_bf16_f32 v63, v46, v47
v_mfma_f32_16x16x32_bf16 v[28:31], a[12:15], a[220:223], v[28:31]
buffer_load_dwordx4 v3, s[48:51], s7 offen offset:3072 sc1 lds
v_mfma_f32_16x16x32_bf16 v[40:43], a[16:19], a[192:195], v[88:91]
ds_read_b128 a[56:59], v2 offset:22528
s_add_u32 s7, s7, 0x8000
v_mfma_f32_16x16x32_bf16 v[40:43], a[20:23], a[196:199], v[40:43]
ds_read_b128 a[60:63], v2 offset:23552
v_xor_b32 v2, 0x38000, v2
v_mfma_f32_16x16x32_bf16 v[40:43], a[24:27], a[200:203], v[40:43]
s_xor_b32 s19, s19, 0x8000
v_exp_f32 v24, v24
v_mfma_f32_16x16x32_bf16 v[40:43], a[28:31], a[204:207], v[40:43]
s_sub_u32 s15, s15, 1
v_exp_f32 v25, v25
v_mfma_f32_16x16x32_bf16 v[44:47], a[16:19], a[208:211], v[92:95]
s_cmp_lg_u32 s15, 0
v_exp_f32 v26, v26
v_mfma_f32_16x16x32_bf16 v[44:47], a[20:23], a[212:215], v[44:47]
v_exp_f32 v27, v27
v_mfma_f32_16x16x32_bf16 v[44:47], a[24:27], a[216:219], v[44:47]
s_waitcnt vmcnt(16) lgkmcnt(0)
v_exp_f32 v28, v28
v_mfma_f32_16x16x32_bf16 v[44:47], a[28:31], a[220:223], v[44:47]
s_barrier
v_exp_f32 v29, v29
s_cbranch_scc1 L_att_seven0
s_branch L_att_sdone
L_att_seven1:
v_mfma_f32_16x16x32_bf16 v[192:195], a[32:35], v[56:59], v[192:195]
v_exp_f32 v30, v30
v_mfma_f32_16x16x32_bf16 v[224:227], a[32:35], v[60:63], v[224:227]
ds_read_b128 a[0:3], v1 offset:8192
v_cvt_pk_bf16_f32 v72, v24, v25
v_mfma_f32_16x16x32_bf16 v[228:231], a[36:39], v[60:63], v[228:231]
ds_read_b128 a[4:7], v1 offset:9216
v_cvt_pk_bf16_f32 v73, v26, v27
v_mfma_f32_16x16x32_bf16 v[196:199], a[36:39], v[56:59], v[196:199]
s_add_u32 m0, s27, 0x0
v_exp_f32 v31, v31
v_mfma_f32_16x16x32_bf16 v[200:203], a[40:43], v[56:59], v[200:203]
ds_read_b128 a[8:11], v1 offset:10240
v_cvt_pk_bf16_f32 v76, v28, v29
v_mfma_f32_16x16x32_bf16 v[232:235], a[40:43], v[60:63], v[232:235]
buffer_load_dwordx4 v3, s[48:51], s32 offen offset:0 sc1 lds
v_mfma_f32_16x16x32_bf16 v[236:239], a[44:47], v[60:63], v[236:239]
v_exp_f32 v40, v40
v_mfma_f32_16x16x32_bf16 v[204:207], a[44:47], v[56:59], v[204:207]
ds_read_b128 a[12:15], v1 offset:11264
v_cvt_pk_bf16_f32 v77, v30, v31
v_mfma_f32_16x16x32_bf16 v[208:211], a[48:51], v[56:59], v[208:211]
ds_read_b128 a[16:19], v1 offset:12288
v_mfma_f32_16x16x32_bf16 v[240:243], a[48:51], v[60:63], v[240:243]
buffer_load_dwordx4 v3, s[48:51], s32 offen offset:1024 sc1 lds
v_mfma_f32_16x16x32_bf16 v[244:247], a[52:55], v[60:63], v[244:247]
ds_read_b128 a[20:23], v1 offset:13312
v_mfma_f32_16x16x32_bf16 v[212:215], a[52:55], v[56:59], v[212:215]
ds_read_b128 a[24:27], v1 offset:14336
v_mfma_f32_16x16x32_bf16 v[216:219], a[56:59], v[56:59], v[216:219]
ds_read_b128 a[28:31], v1 offset:15360
v_mfma_f32_16x16x32_bf16 v[248:251], a[56:59], v[60:63], v[248:251]
ds_read_b128 a[32:35], v1 offset:0
v_exp_f32 v41, v41
v_mfma_f32_16x16x32_bf16 v[252:255], a[60:63], v[60:63], v[252:255]
v_exp_f32 v42, v42
v_mfma_f32_16x16x32_bf16 v[220:223], a[60:63], v[56:59], v[220:223]
s_waitcnt lgkmcnt(5)
v_exp_f32 v43, v43
v_smfmac_f32_16x16x64_bf16 a[228:231], a[232:235], v[56:63], v9
ds_read_b128 a[36:39], v1 offset:1024
v_cvt_pk_bf16_f32 v74, v40, v41
v_mfma_f32_16x16x32_bf16 v[24:27], a[0:3], a[192:195], v[88:91]
ds_read_b128 a[40:43], v1 offset:2048
v_exp_f32 v44, v44
v_mfma_f32_16x16x32_bf16 v[24:27], a[4:7], a[196:199], v[24:27]
buffer_load_dwordx4 v3, s[48:51], s32 offen offset:2048 sc1 lds
v_mfma_f32_16x16x32_bf16 v[24:27], a[8:11], a[200:203], v[24:27]
v_exp_f32 v45, v45
v_mfma_f32_16x16x32_bf16 v[24:27], a[12:15], a[204:207], v[24:27]
ds_read_b128 a[44:47], v1 offset:3072
v_cvt_pk_bf16_f32 v75, v42, v43
v_mfma_f32_16x16x32_bf16 v[28:31], a[0:3], a[208:211], v[92:95]
ds_read_b128 a[48:51], v1 offset:4096
v_exp_f32 v46, v46
v_mfma_f32_16x16x32_bf16 v[28:31], a[4:7], a[212:215], v[28:31]
s_waitcnt lgkmcnt(5)
v_exp_f32 v47, v47
v_mfma_f32_16x16x32_bf16 v[28:31], a[8:11], a[216:219], v[28:31]
ds_read_b128 a[52:55], v1 offset:5120
v_cvt_pk_bf16_f32 v78, v44, v45
v_mfma_f32_16x16x32_bf16 v[28:31], a[12:15], a[220:223], v[28:31]
buffer_load_dwordx4 v3, s[48:51], s32 offen offset:3072 sc1 lds
v_mfma_f32_16x16x32_bf16 v[40:43], a[16:19], a[192:195], v[88:91]
ds_read_b128 a[56:59], v1 offset:6144
s_add_u32 s32, s32, 0x8000
v_mfma_f32_16x16x32_bf16 v[40:43], a[20:23], a[196:199], v[40:43]
ds_read_b128 a[60:63], v1 offset:7168
v_cvt_pk_bf16_f32 v79, v46, v47
v_mfma_f32_16x16x32_bf16 v[40:43], a[24:27], a[200:203], v[40:43]
v_exp_f32 v24, v24
v_mfma_f32_16x16x32_bf16 v[40:43], a[28:31], a[204:207], v[40:43]
v_exp_f32 v25, v25
v_mfma_f32_16x16x32_bf16 v[44:47], a[16:19], a[208:211], v[92:95]
v_exp_f32 v26, v26
v_mfma_f32_16x16x32_bf16 v[44:47], a[20:23], a[212:215], v[44:47]
v_exp_f32 v27, v27
v_mfma_f32_16x16x32_bf16 v[44:47], a[24:27], a[216:219], v[44:47]
v_exp_f32 v28, v28
v_mfma_f32_16x16x32_bf16 v[44:47], a[28:31], a[220:223], v[44:47]
s_waitcnt lgkmcnt(0)
v_exp_f32 v29, v29
v_mfma_f32_16x16x32_bf16 v[192:195], a[32:35], v[72:75], v[192:195]
s_add_u32 m0, s27, 0x1000
v_exp_f32 v30, v30
v_mfma_f32_16x16x32_bf16 v[224:227], a[32:35], v[76:79], v[224:227]
buffer_load_dwordx4 v3, s[48:51], s7 offen offset:0 sc1 lds
v_mfma_f32_16x16x32_bf16 v[228:231], a[36:39], v[76:79], v[228:231]
v_exp_f32 v31, v31
v_mfma_f32_16x16x32_bf16 v[196:199], a[36:39], v[72:75], v[196:199]
ds_read_b128 a[0:3], v1 offset:24576
v_cvt_pk_bf16_f32 v56, v24, v25
v_mfma_f32_16x16x32_bf16 v[200:203], a[40:43], v[72:75], v[200:203]
ds_read_b128 a[4:7], v1 offset:25600
v_cvt_pk_bf16_f32 v57, v26, v27
v_mfma_f32_16x16x32_bf16 v[232:235], a[40:43], v[76:79], v[232:235]
v_exp_f32 v40, v40
v_mfma_f32_16x16x32_bf16 v[236:239], a[44:47], v[76:79], v[236:239]
ds_read_b128 a[8:11], v1 offset:26624
v_cvt_pk_bf16_f32 v60, v28, v29
v_mfma_f32_16x16x32_bf16 v[204:207], a[44:47], v[72:75], v[204:207]
v_exp_f32 v41, v41
v_mfma_f32_16x16x32_bf16 v[208:211], a[48:51], v[72:75], v[208:211]
ds_read_b128 a[12:15], v1 offset:27648
v_cvt_pk_bf16_f32 v61, v30, v31
v_mfma_f32_16x16x32_bf16 v[240:243], a[48:51], v[76:79], v[240:243]
ds_read_b128 a[16:19], v1 offset:28672
v_cvt_pk_bf16_f32 v58, v40, v41
v_mfma_f32_16x16x32_bf16 v[244:247], a[52:55], v[76:79], v[244:247]
v_exp_f32 v42, v42
v_mfma_f32_16x16x32_bf16 v[212:215], a[52:55], v[72:75], v[212:215]
buffer_load_dwordx4 v3, s[48:51], s7 offen offset:1024 sc1 lds
v_mfma_f32_16x16x32_bf16 v[216:219], a[56:59], v[72:75], v[216:219]
ds_read_b128 a[20:23], v1 offset:29696
v_mfma_f32_16x16x32_bf16 v[248:251], a[56:59], v[76:79], v[248:251]
ds_read_b128 a[24:27], v1 offset:30720
v_mfma_f32_16x16x32_bf16 v[252:255], a[60:63], v[76:79], v[252:255]
ds_read_b128 a[28:31], v1 offset:31744
v_mfma_f32_16x16x32_bf16 v[220:223], a[60:63], v[72:75], v[220:223]
s_waitcnt lgkmcnt(4)
v_exp_f32 v43, v43
v_smfmac_f32_16x16x64_bf16 a[228:231], a[232:235], v[72:79], v9
ds_read_b128 a[32:35], v1 offset:16384
v_cvt_pk_bf16_f32 v59, v42, v43
v_mfma_f32_16x16x32_bf16 v[24:27], a[0:3], a[192:195], v[88:91]
ds_read_b128 a[36:39], v1 offset:17408
v_mfma_f32_16x16x32_bf16 v[24:27], a[4:7], a[196:199], v[24:27]
buffer_load_dwordx4 v3, s[48:51], s7 offen offset:2048 sc1 lds
v_mfma_f32_16x16x32_bf16 v[24:27], a[8:11], a[200:203], v[24:27]
ds_read_b128 a[40:43], v1 offset:18432
v_exp_f32 v44, v44
v_mfma_f32_16x16x32_bf16 v[24:27], a[12:15], a[204:207], v[24:27]
ds_read_b128 a[44:47], v1 offset:19456
v_exp_f32 v45, v45
v_mfma_f32_16x16x32_bf16 v[28:31], a[0:3], a[208:211], v[92:95]
ds_read_b128 a[48:51], v1 offset:20480
v_exp_f32 v46, v46
v_mfma_f32_16x16x32_bf16 v[28:31], a[4:7], a[212:215], v[28:31]
s_waitcnt lgkmcnt(5)
v_exp_f32 v47, v47
v_mfma_f32_16x16x32_bf16 v[28:31], a[8:11], a[216:219], v[28:31]
ds_read_b128 a[52:55], v1 offset:21504
v_cvt_pk_bf16_f32 v62, v44, v45
v_mfma_f32_16x16x32_bf16 v[28:31], a[12:15], a[220:223], v[28:31]
ds_read_b128 a[56:59], v1 offset:22528
v_cvt_pk_bf16_f32 v63, v46, v47
v_mfma_f32_16x16x32_bf16 v[40:43], a[16:19], a[192:195], v[88:91]
ds_read_b128 a[60:63], v1 offset:23552
v_xor_b32 v1, 0x8000, v1
v_mfma_f32_16x16x32_bf16 v[40:43], a[20:23], a[196:199], v[40:43]
buffer_load_dwordx4 v3, s[48:51], s7 offen offset:3072 sc1 lds
v_mfma_f32_16x16x32_bf16 v[40:43], a[24:27], a[200:203], v[40:43]
s_add_u32 s7, s7, 0x8000
v_exp_f32 v24, v24
v_mfma_f32_16x16x32_bf16 v[40:43], a[28:31], a[204:207], v[40:43]
s_xor_b32 s27, s27, 0x38000
v_exp_f32 v25, v25
v_mfma_f32_16x16x32_bf16 v[44:47], a[16:19], a[208:211], v[92:95]
s_waitcnt vmcnt(16) lgkmcnt(0)
v_exp_f32 v26, v26
v_mfma_f32_16x16x32_bf16 v[44:47], a[20:23], a[212:215], v[44:47]
s_barrier
v_exp_f32 v27, v27
v_mfma_f32_16x16x32_bf16 v[44:47], a[24:27], a[216:219], v[44:47]
v_exp_f32 v28, v28
v_mfma_f32_16x16x32_bf16 v[44:47], a[28:31], a[220:223], v[44:47]
v_exp_f32 v29, v29
L_att_sodd1:
v_mfma_f32_16x16x32_bf16 v[192:195], a[32:35], v[56:59], v[192:195]
v_exp_f32 v30, v30
v_mfma_f32_16x16x32_bf16 v[224:227], a[32:35], v[60:63], v[224:227]
ds_read_b128 a[0:3], v2 offset:8192
v_cvt_pk_bf16_f32 v72, v24, v25
v_mfma_f32_16x16x32_bf16 v[228:231], a[36:39], v[60:63], v[228:231]
ds_read_b128 a[4:7], v2 offset:9216
v_cvt_pk_bf16_f32 v73, v26, v27
v_mfma_f32_16x16x32_bf16 v[196:199], a[36:39], v[56:59], v[196:199]
s_add_u32 m0, s19, 0x0
v_exp_f32 v31, v31
v_mfma_f32_16x16x32_bf16 v[200:203], a[40:43], v[56:59], v[200:203]
ds_read_b128 a[8:11], v2 offset:10240
v_cvt_pk_bf16_f32 v76, v28, v29
v_mfma_f32_16x16x32_bf16 v[232:235], a[40:43], v[60:63], v[232:235]
buffer_load_dwordx4 v3, s[48:51], s32 offen offset:0 sc1 lds
v_mfma_f32_16x16x32_bf16 v[236:239], a[44:47], v[60:63], v[236:239]
v_exp_f32 v40, v40
v_mfma_f32_16x16x32_bf16 v[204:207], a[44:47], v[56:59], v[204:207]
ds_read_b128 a[12:15], v2 offset:11264
v_cvt_pk_bf16_f32 v77, v30, v31
v_mfma_f32_16x16x32_bf16 v[208:211], a[48:51], v[56:59], v[208:211]
ds_read_b128 a[16:19], v2 offset:12288
v_mfma_f32_16x16x32_bf16 v[240:243], a[48:51], v[60:63], v[240:243]
buffer_load_dwordx4 v3, s[48:51], s32 offen offset:1024 sc1 lds
v_mfma_f32_16x16x32_bf16 v[244:247], a[52:55], v[60:63], v[244:247]
ds_read_b128 a[20:23], v2 offset:13312
v_mfma_f32_16x16x32_bf16 v[212:215], a[52:55], v[56:59], v[212:215]
ds_read_b128 a[24:27], v2 offset:14336
v_mfma_f32_16x16x32_bf16 v[216:219], a[56:59], v[56:59], v[216:219]
ds_read_b128 a[28:31], v2 offset:15360
v_mfma_f32_16x16x32_bf16 v[248:251], a[56:59], v[60:63], v[248:251]
ds_read_b128 a[32:35], v2 offset:0
v_exp_f32 v41, v41
v_mfma_f32_16x16x32_bf16 v[252:255], a[60:63], v[60:63], v[252:255]
v_exp_f32 v42, v42
v_mfma_f32_16x16x32_bf16 v[220:223], a[60:63], v[56:59], v[220:223]
s_waitcnt lgkmcnt(5)
v_exp_f32 v43, v43
v_smfmac_f32_16x16x64_bf16 a[228:231], a[232:235], v[56:63], v9
ds_read_b128 a[36:39], v2 offset:1024
v_cvt_pk_bf16_f32 v74, v40, v41
v_mfma_f32_16x16x32_bf16 v[24:27], a[0:3], a[192:195], v[88:91]
ds_read_b128 a[40:43], v2 offset:2048
v_exp_f32 v44, v44
v_mfma_f32_16x16x32_bf16 v[24:27], a[4:7], a[196:199], v[24:27]
buffer_load_dwordx4 v3, s[48:51], s32 offen offset:2048 sc1 lds
v_mfma_f32_16x16x32_bf16 v[24:27], a[8:11], a[200:203], v[24:27]
v_exp_f32 v45, v45
v_mfma_f32_16x16x32_bf16 v[24:27], a[12:15], a[204:207], v[24:27]
ds_read_b128 a[44:47], v2 offset:3072
v_cvt_pk_bf16_f32 v75, v42, v43
v_mfma_f32_16x16x32_bf16 v[28:31], a[0:3], a[208:211], v[92:95]
ds_read_b128 a[48:51], v2 offset:4096
v_exp_f32 v46, v46
v_mfma_f32_16x16x32_bf16 v[28:31], a[4:7], a[212:215], v[28:31]
s_waitcnt lgkmcnt(5)
v_exp_f32 v47, v47
v_mfma_f32_16x16x32_bf16 v[28:31], a[8:11], a[216:219], v[28:31]
ds_read_b128 a[52:55], v2 offset:5120
v_cvt_pk_bf16_f32 v78, v44, v45
v_mfma_f32_16x16x32_bf16 v[28:31], a[12:15], a[220:223], v[28:31]
buffer_load_dwordx4 v3, s[48:51], s32 offen offset:3072 sc1 lds
v_mfma_f32_16x16x32_bf16 v[40:43], a[16:19], a[192:195], v[88:91]
ds_read_b128 a[56:59], v2 offset:6144
s_add_u32 s32, s32, 0x8000
v_mfma_f32_16x16x32_bf16 v[40:43], a[20:23], a[196:199], v[40:43]
ds_read_b128 a[60:63], v2 offset:7168
v_cvt_pk_bf16_f32 v79, v46, v47
v_mfma_f32_16x16x32_bf16 v[40:43], a[24:27], a[200:203], v[40:43]
v_exp_f32 v24, v24
v_mfma_f32_16x16x32_bf16 v[40:43], a[28:31], a[204:207], v[40:43]
v_exp_f32 v25, v25
v_mfma_f32_16x16x32_bf16 v[44:47], a[16:19], a[208:211], v[92:95]
v_exp_f32 v26, v26
v_mfma_f32_16x16x32_bf16 v[44:47], a[20:23], a[212:215], v[44:47]
v_exp_f32 v27, v27
v_mfma_f32_16x16x32_bf16 v[44:47], a[24:27], a[216:219], v[44:47]
v_exp_f32 v28, v28
v_mfma_f32_16x16x32_bf16 v[44:47], a[28:31], a[220:223], v[44:47]
s_waitcnt lgkmcnt(0)
v_exp_f32 v29, v29
v_mfma_f32_16x16x32_bf16 v[192:195], a[32:35], v[72:75], v[192:195]
v_exp_f32 v30, v30
v_mfma_f32_16x16x32_bf16 v[224:227], a[32:35], v[76:79], v[224:227]
v_exp_f32 v31, v31
v_mfma_f32_16x16x32_bf16 v[228:231], a[36:39], v[76:79], v[228:231]
v_exp_f32 v40, v40
v_mfma_f32_16x16x32_bf16 v[196:199], a[36:39], v[72:75], v[196:199]
s_add_u32 m0, s19, 0x1000
v_exp_f32 v41, v41
v_mfma_f32_16x16x32_bf16 v[200:203], a[40:43], v[72:75], v[200:203]
ds_read_b128 a[0:3], v2 offset:24576
v_cvt_pk_bf16_f32 v56, v24, v25
v_mfma_f32_16x16x32_bf16 v[232:235], a[40:43], v[76:79], v[232:235]
buffer_load_dwordx4 v3, s[48:51], s7 offen offset:0 sc1 lds
v_mfma_f32_16x16x32_bf16 v[236:239], a[44:47], v[76:79], v[236:239]
ds_read_b128 a[4:7], v2 offset:25600
v_cvt_pk_bf16_f32 v57, v26, v27
v_mfma_f32_16x16x32_bf16 v[204:207], a[44:47], v[72:75], v[204:207]
ds_read_b128 a[8:11], v2 offset:26624
v_cvt_pk_bf16_f32 v60, v28, v29
v_mfma_f32_16x16x32_bf16 v[208:211], a[48:51], v[72:75], v[208:211]
ds_read_b128 a[12:15], v2 offset:27648
v_cvt_pk_bf16_f32 v61, v30, v31
v_mfma_f32_16x16x32_bf16 v[240:243], a[48:51], v[76:79], v[240:243]
ds_read_b128 a[16:19], v2 offset:28672
v_cvt_pk_bf16_f32 v58, v40, v41
v_mfma_f32_16x16x32_bf16 v[244:247], a[52:55], v[76:79], v[244:247]
buffer_load_dwordx4 v3, s[48:51], s7 offen offset:1024 sc1 lds
v_mfma_f32_16x16x32_bf16 v[212:215], a[52:55], v[72:75], v[212:215]
ds_read_b128 a[20:23], v2 offset:29696
v_mfma_f32_16x16x32_bf16 v[216:219], a[56:59], v[72:75], v[216:219]
v_exp_f32 v42, v42
v_mfma_f32_16x16x32_bf16 v[248:251], a[56:59], v[76:79], v[248:251]
ds_read_b128 a[24:27], v2 offset:30720
v_mfma_f32_16x16x32_bf16 v[252:255], a[60:63], v[76:79], v[252:255]
ds_read_b128 a[28:31], v2 offset:31744
v_exp_f32 v43, v43
v_mfma_f32_16x16x32_bf16 v[220:223], a[60:63], v[72:75], v[220:223]
ds_read_b128 a[32:35], v2 offset:16384
v_cvt_pk_bf16_f32 v59, v42, v43
v_smfmac_f32_16x16x64_bf16 a[228:231], a[232:235], v[72:79], v9
ds_read_b128 a[36:39], v2 offset:17408
s_waitcnt lgkmcnt(6)
v_mfma_f32_16x16x32_bf16 v[24:27], a[0:3], a[192:195], v[88:91]
buffer_load_dwordx4 v3, s[48:51], s7 offen offset:2048 sc1 lds
v_mfma_f32_16x16x32_bf16 v[24:27], a[4:7], a[196:199], v[24:27]
ds_read_b128 a[40:43], v2 offset:18432
v_exp_f32 v44, v44
v_mfma_f32_16x16x32_bf16 v[24:27], a[8:11], a[200:203], v[24:27]
ds_read_b128 a[44:47], v2 offset:19456
v_exp_f32 v45, v45
v_mfma_f32_16x16x32_bf16 v[24:27], a[12:15], a[204:207], v[24:27]
ds_read_b128 a[48:51], v2 offset:20480
v_cvt_pk_bf16_f32 v62, v44, v45
v_mfma_f32_16x16x32_bf16 v[28:31], a[0:3], a[208:211], v[92:95]
v_exp_f32 v46, v46
v_mfma_f32_16x16x32_bf16 v[28:31], a[4:7], a[212:215], v[28:31]
s_waitcnt lgkmcnt(5)
v_exp_f32 v47, v47
v_mfma_f32_16x16x32_bf16 v[28:31], a[8:11], a[216:219], v[28:31]
ds_read_b128 a[52:55], v2 offset:21504
v_cvt_pk_bf16_f32 v63, v46, v47
v_mfma_f32_16x16x32_bf16 v[28:31], a[12:15], a[220:223], v[28:31]
buffer_load_dwordx4 v3, s[48:51], s7 offen offset:3072 sc1 lds
v_mfma_f32_16x16x32_bf16 v[40:43], a[16:19], a[192:195], v[88:91]
ds_read_b128 a[56:59], v2 offset:22528
s_add_u32 s7, s7, 0x8000
v_mfma_f32_16x16x32_bf16 v[40:43], a[20:23], a[196:199], v[40:43]
ds_read_b128 a[60:63], v2 offset:23552
v_xor_b32 v2, 0x38000, v2
v_mfma_f32_16x16x32_bf16 v[40:43], a[24:27], a[200:203], v[40:43]
s_xor_b32 s19, s19, 0x8000
v_exp_f32 v24, v24
v_mfma_f32_16x16x32_bf16 v[40:43], a[28:31], a[204:207], v[40:43]
s_sub_u32 s15, s15, 1
v_exp_f32 v25, v25
v_mfma_f32_16x16x32_bf16 v[44:47], a[16:19], a[208:211], v[92:95]
s_cmp_lg_u32 s15, 0
s_waitcnt vmcnt(16) lgkmcnt(0)
v_exp_f32 v26, v26
v_mfma_f32_16x16x32_bf16 v[44:47], a[20:23], a[212:215], v[44:47]
s_barrier
v_exp_f32 v27, v27
v_mfma_f32_16x16x32_bf16 v[44:47], a[24:27], a[216:219], v[44:47]
v_exp_f32 v28, v28
v_mfma_f32_16x16x32_bf16 v[44:47], a[28:31], a[220:223], v[44:47]
v_exp_f32 v29, v29
s_cbranch_scc1 L_att_seven1
L_att_sdone:
s_cmp_ge_u32 s4, 2
s_cbranch_scc1 L_att_sh0_1
L_att_sh0_0:
v_mfma_f32_16x16x32_bf16 v[192:195], a[32:35], v[56:59], v[192:195]
v_exp_f32 v30, v30
v_mfma_f32_16x16x32_bf16 v[224:227], a[32:35], v[60:63], v[224:227]
buffer_load_dword v14, v15, s[84:87], 0 offen offset:192 sc1
v_mfma_f32_16x16x32_bf16 v[228:231], a[36:39], v[60:63], v[228:231]
v_exp_f32 v31, v31
v_mfma_f32_16x16x32_bf16 v[196:199], a[36:39], v[56:59], v[196:199]
s_add_u32 m0, s17, 0x10000
v_exp_f32 v40, v40
v_mfma_f32_16x16x32_bf16 v[200:203], a[40:43], v[56:59], v[200:203]
ds_read_b128 a[0:3], v1 offset:8192
v_cvt_pk_bf16_f32 v72, v24, v25
v_mfma_f32_16x16x32_bf16 v[232:235], a[40:43], v[60:63], v[232:235]
ds_read_b128 a[4:7], v1 offset:9216
v_cvt_pk_bf16_f32 v73, v26, v27
v_mfma_f32_16x16x32_bf16 v[236:239], a[44:47], v[60:63], v[236:239]
buffer_load_dwordx4 v12, s[72:75], 0 offen lds
v_mfma_f32_16x16x32_bf16 v[204:207], a[44:47], v[56:59], v[204:207]
ds_read_b128 a[8:11], v1 offset:10240
v_cvt_pk_bf16_f32 v76, v28, v29
v_mfma_f32_16x16x32_bf16 v[208:211], a[48:51], v[56:59], v[208:211]
buffer_load_dwordx4 v13, s[72:75], 0 offen offset:1024 lds
v_mfma_f32_16x16x32_bf16 v[240:243], a[48:51], v[60:63], v[240:243]
ds_read_b128 a[12:15], v1 offset:11264
v_cvt_pk_bf16_f32 v77, v30, v31
v_mfma_f32_16x16x32_bf16 v[244:247], a[52:55], v[60:63], v[244:247]
buffer_load_dwordx4 v12, s[72:75], s12 offen offset:2048 lds
v_mfma_f32_16x16x32_bf16 v[212:215], a[52:55], v[56:59], v[212:215]
ds_read_b128 a[16:19], v1 offset:12288
v_exp_f32 v41, v41
v_mfma_f32_16x16x32_bf16 v[216:219], a[56:59], v[56:59], v[216:219]
ds_read_b128 a[20:23], v1 offset:13312
v_exp_f32 v42, v42
v_mfma_f32_16x16x32_bf16 v[248:251], a[56:59], v[60:63], v[248:251]
buffer_load_dwordx4 v13, s[72:75], s12 offen offset:3072 lds
v_mfma_f32_16x16x32_bf16 v[252:255], a[60:63], v[60:63], v[252:255]
ds_read_b128 a[24:27], v1 offset:14336
s_waitcnt lgkmcnt(3)
v_mfma_f32_16x16x32_bf16 v[220:223], a[60:63], v[56:59], v[220:223]
ds_read_b128 a[28:31], v1 offset:15360
v_add_u32 v12, 0x20000, v12
v_smfmac_f32_16x16x64_bf16 a[228:231], a[232:235], v[56:63], v9
s_add_u32 m0, s17, 0x14000
v_exp_f32 v43, v43
v_mfma_f32_16x16x32_bf16 v[24:27], a[0:3], a[192:195], v[112:115]
buffer_load_dwordx4 v12, s[72:75], 0 offen lds
v_mfma_f32_16x16x32_bf16 v[24:27], a[4:7], a[196:199], v[24:27]
ds_read_b128 a[32:35], v1 offset:0
v_cvt_pk_bf16_f32 v74, v40, v41
v_mfma_f32_16x16x32_bf16 v[24:27], a[8:11], a[200:203], v[24:27]
ds_read_b128 a[36:39], v1 offset:1024
v_exp_f32 v44, v44
v_mfma_f32_16x16x32_bf16 v[24:27], a[12:15], a[204:207], v[24:27]
ds_read_b128 a[40:43], v1 offset:2048
v_exp_f32 v45, v45
v_mfma_f32_16x16x32_bf16 v[28:31], a[0:3], a[208:211], v[92:95]
ds_read_b128 a[44:47], v1 offset:3072
v_exp_f32 v46, v46
v_mfma_f32_16x16x32_bf16 v[28:31], a[4:7], a[212:215], v[28:31]
s_waitcnt lgkmcnt(4)
v_exp_f32 v47, v47
v_mfma_f32_16x16x32_bf16 v[28:31], a[8:11], a[216:219], v[28:31]
ds_read_b128 a[48:51], v1 offset:4096
v_add_u32 v13, 0x20000, v13
v_mfma_f32_16x16x32_bf16 v[28:31], a[12:15], a[220:223], v[28:31]
buffer_load_dwordx4 v13, s[72:75], 0 offen offset:1024 lds
v_cvt_pk_bf16_f32 v75, v42, v43
v_mfma_f32_16x16x32_bf16 v[40:43], a[16:19], a[192:195], v[116:119]
ds_read_b128 a[52:55], v1 offset:5120
v_exp_f32 v24, v24
v_mfma_f32_16x16x32_bf16 v[40:43], a[20:23], a[196:199], v[40:43]
buffer_load_dwordx4 v12, s[72:75], s12 offen offset:2048 lds
v_mfma_f32_16x16x32_bf16 v[40:43], a[24:27], a[200:203], v[40:43]
ds_read_b128 a[56:59], v1 offset:6144
v_exp_f32 v25, v25
v_mfma_f32_16x16x32_bf16 v[40:43], a[28:31], a[204:207], v[40:43]
ds_read_b128 a[60:63], v1 offset:7168
v_cvt_pk_bf16_f32 v78, v44, v45
v_cvt_pk_bf16_f32 v79, v46, v47
v_mfma_f32_16x16x32_bf16 v[44:47], a[16:19], a[208:211], v[92:95]
buffer_load_dwordx4 v13, s[72:75], s12 offen offset:3072 lds
v_mfma_f32_16x16x32_bf16 v[44:47], a[20:23], a[212:215], v[44:47]
v_exp_f32 v26, v26
v_mfma_f32_16x16x32_bf16 v[44:47], a[24:27], a[216:219], v[44:47]
v_exp_f32 v27, v27
v_mfma_f32_16x16x32_bf16 v[44:47], a[28:31], a[220:223], v[44:47]
s_waitcnt lgkmcnt(0)
v_exp_f32 v28, v28
v_exp_f32 v29, v29
v_mfma_f32_16x16x32_bf16 v[192:195], a[32:35], v[72:75], v[192:195]
ds_read_b128 a[0:3], v1 offset:24576
v_cvt_pk_bf16_f32 v56, v24, v25
v_mfma_f32_16x16x32_bf16 v[224:227], a[32:35], v[76:79], v[224:227]
ds_read_b128 a[4:7], v1 offset:25600
v_add_u32 v12, 0x20000, v12
v_mfma_f32_16x16x32_bf16 v[228:231], a[36:39], v[76:79], v[228:231]
s_add_u32 m0, s16, 0x0
v_exp_f32 v30, v30
v_mfma_f32_16x16x32_bf16 v[196:199], a[36:39], v[72:75], v[196:199]
buffer_load_dwordx4 v12, s[72:75], 0 offen lds
v_mfma_f32_16x16x32_bf16 v[200:203], a[40:43], v[72:75], v[200:203]
ds_read_b128 a[8:11], v1 offset:26624
v_add_u32 v13, 0x20000, v13
v_mfma_f32_16x16x32_bf16 v[232:235], a[40:43], v[76:79], v[232:235]
buffer_load_dwordx4 v13, s[72:75], 0 offen offset:1024 lds
v_mfma_f32_16x16x32_bf16 v[236:239], a[44:47], v[76:79], v[236:239]
ds_read_b128 a[12:15], v1 offset:27648
v_cvt_pk_bf16_f32 v57, v26, v27
v_mfma_f32_16x16x32_bf16 v[204:207], a[44:47], v[72:75], v[204:207]
buffer_load_dwordx4 v12, s[72:75], s12 offen offset:2048 lds
v_mfma_f32_16x16x32_bf16 v[208:211], a[48:51], v[72:75], v[208:211]
ds_read_b128 a[16:19], v1 offset:28672
v_cvt_pk_bf16_f32 v60, v28, v29
v_mfma_f32_16x16x32_bf16 v[240:243], a[48:51], v[76:79], v[240:243]
buffer_load_dwordx4 v13, s[72:75], s12 offen offset:3072 lds
v_mfma_f32_16x16x32_bf16 v[244:247], a[52:55], v[76:79], v[244:247]
ds_read_b128 a[20:23], v1 offset:29696
v_exp_f32 v31, v31
v_mfma_f32_16x16x32_bf16 v[212:215], a[52:55], v[72:75], v[212:215]
ds_read_b128 a[24:27], v1 offset:30720
s_add_u32 m0, s16, 0x4000
v_mfma_f32_16x16x32_bf16 v[216:219], a[56:59], v[72:75], v[216:219]
ds_read_b128 a[28:31], v1 offset:31744
v_add_u32 v12, 0x20000, v12
v_mfma_f32_16x16x32_bf16 v[248:251], a[56:59], v[76:79], v[248:251]
buffer_load_dwordx4 v12, s[72:75], 0 offen lds
v_mfma_f32_16x16x32_bf16 v[252:255], a[60:63], v[76:79], v[252:255]
ds_read_b128 a[32:35], v1 offset:16384
s_waitcnt lgkmcnt(5)
v_mfma_f32_16x16x32_bf16 v[220:223], a[60:63], v[72:75], v[220:223]
ds_read_b128 a[36:39], v1 offset:17408
v_add_u32 v13, 0x20000, v13
v_smfmac_f32_16x16x64_bf16 a[228:231], a[232:235], v[72:79], v9
buffer_load_dwordx4 v13, s[72:75], 0 offen offset:1024 lds
v_cvt_pk_bf16_f32 v61, v30, v31
v_mfma_f32_16x16x32_bf16 v[28:31], a[0:3], a[208:211], v[92:95]
ds_read_b128 a[40:43], v1 offset:18432
v_exp_f32 v40, v40
v_mfma_f32_16x16x32_bf16 v[28:31], a[4:7], a[212:215], v[28:31]
buffer_load_dwordx4 v12, s[72:75], s12 offen offset:2048 lds
v_mfma_f32_16x16x32_bf16 v[28:31], a[8:11], a[216:219], v[28:31]
ds_read_b128 a[44:47], v1 offset:19456
v_exp_f32 v41, v41
v_mfma_f32_16x16x32_bf16 v[28:31], a[12:15], a[220:223], v[28:31]
ds_read_b128 a[48:51], v1 offset:20480
s_waitcnt lgkmcnt(5)
v_exp_f32 v42, v42
v_exp_f32 v43, v43
v_exp_f32 v44, v44
v_exp_f32 v45, v45
v_exp_f32 v46, v46
v_exp_f32 v47, v47
v_cvt_pk_bf16_f32 v62, v44, v45
v_cvt_pk_bf16_f32 v63, v46, v47
v_mfma_f32_16x16x32_bf16 v[44:47], a[16:19], a[208:211], v[92:95]
buffer_load_dwordx4 v13, s[72:75], s12 offen offset:3072 lds
v_mfma_f32_16x16x32_bf16 v[44:47], a[20:23], a[212:215], v[44:47]
ds_read_b128 a[52:55], v1 offset:21504
v_cvt_pk_bf16_f32 v58, v40, v41
v_mfma_f32_16x16x32_bf16 v[44:47], a[24:27], a[216:219], v[44:47]
ds_read_b128 a[56:59], v1 offset:22528
v_cvt_pk_bf16_f32 v59, v42, v43
v_mfma_f32_16x16x32_bf16 v[44:47], a[28:31], a[220:223], v[44:47]
ds_read_b128 a[60:63], v1 offset:23552
v_xor_b32 v1, 0x8000, v1
L_att_h1_0:
s_waitcnt vmcnt(16) lgkmcnt(0)
s_mov_b32 s92, 200000
L_spin_b0:
v_cmp_gt_u32 vcc, 32, v14
s_nop 4
s_cbranch_vccz L_spun_b0
s_sub_u32 s92, s92, 1
s_cbranch_scc1 L_spun_b0
s_sleep 6
buffer_load_dword v14, v15, s[84:87], 0 offen offset:192 sc1
s_waitcnt vmcnt(0)
s_branch L_spin_b0
L_spun_b0:
s_barrier
v_mfma_f32_16x16x32_bf16 v[192:195], a[32:35], v[56:59], v[192:195]
ds_read_b128 a[0:3], v2 offset:8192
v_exp_f32 v28, v28
v_mfma_f32_16x16x32_bf16 v[224:227], a[32:35], v[60:63], v[224:227]
ds_read_b128 a[4:7], v2 offset:9216
v_exp_f32 v29, v29
v_mfma_f32_16x16x32_bf16 v[228:231], a[36:39], v[60:63], v[228:231]
s_add_u32 s101, s101, 0x2000
v_exp_f32 v30, v30
v_mfma_f32_16x16x32_bf16 v[196:199], a[36:39], v[56:59], v[196:199]
buffer_load_dwordx4 a[64:67], v3, s[88:91], s101 offen sc1
v_mfma_f32_16x16x32_bf16 v[200:203], a[40:43], v[56:59], v[200:203]
ds_read_b128 a[8:11], v2 offset:10240
v_exp_f32 v31, v31
v_mfma_f32_16x16x32_bf16 v[232:235], a[40:43], v[60:63], v[232:235]
buffer_load_dwordx4 a[68:71], v3, s[88:91], s101 offen offset:1024 sc1
v_mfma_f32_16x16x32_bf16 v[236:239], a[44:47], v[60:63], v[236:239]
ds_read_b128 a[12:15], v2 offset:11264
s_add_u32 s101, s101, 0x2000
v_mfma_f32_16x16x32_bf16 v[204:207], a[44:47], v[56:59], v[204:207]
buffer_load_dwordx4 a[72:75], v3, s[88:91], s101 offen sc1
v_mfma_f32_16x16x32_bf16 v[208:211], a[48:51], v[56:59], v[208:211]
ds_read_b128 a[16:19], v2 offset:12288
v_cvt_pk_bf16_f32 v76, v28, v29
v_mfma_f32_16x16x32_bf16 v[240:243], a[48:51], v[60:63], v[240:243]
buffer_load_dwordx4 a[76:79], v3, s[88:91], s101 offen offset:1024 sc1
v_mfma_f32_16x16x32_bf16 v[244:247], a[52:55], v[60:63], v[244:247]
ds_read_b128 a[20:23], v2 offset:13312
v_exp_f32 v44, v44
v_mfma_f32_16x16x32_bf16 v[212:215], a[52:55], v[56:59], v[212:215]
ds_read_b128 a[24:27], v2 offset:14336
v_exp_f32 v45, v45
v_mfma_f32_16x16x32_bf16 v[216:219], a[56:59], v[56:59], v[216:219]
ds_read_b128 a[28:31], v2 offset:15360
s_add_u32 s101, s101, 0x2000
v_mfma_f32_16x16x32_bf16 v[248:251], a[56:59], v[60:63], v[248:251]
buffer_load_dwordx4 a[80:83], v3, s[88:91], s101 offen sc1
v_mfma_f32_16x16x32_bf16 v[252:255], a[60:63], v[60:63], v[252:255]
ds_read_b128 a[32:35], v2 offset:0
v_cvt_pk_bf16_f32 v77, v30, v31
v_mfma_f32_16x16x32_bf16 v[220:223], a[60:63], v[56:59], v[220:223]
ds_read_b128 a[36:39], v2 offset:1024
s_waitcnt lgkmcnt(6)
v_smfmac_f32_16x16x64_bf16 a[228:231], a[232:235], v[56:63], v9
buffer_load_dwordx4 a[84:87], v3, s[88:91], s101 offen offset:1024 sc1
v_mfma_f32_16x16x32_bf16 v[28:31], a[0:3], a[208:211], v[92:95]
ds_read_b128 a[40:43], v2 offset:2048
v_exp_f32 v46, v46
v_mfma_f32_16x16x32_bf16 v[28:31], a[4:7], a[212:215], v[28:31]
ds_read_b128 a[44:47], v2 offset:3072
s_add_u32 s101, s101, 0x2000
v_mfma_f32_16x16x32_bf16 v[28:31], a[8:11], a[216:219], v[28:31]
buffer_load_dwordx4 a[88:91], v3, s[88:91], s101 offen sc1
v_mfma_f32_16x16x32_bf16 v[28:31], a[12:15], a[220:223], v[28:31]
ds_read_b128 a[48:51], v2 offset:4096
s_waitcnt lgkmcnt(5)
v_exp_f32 v47, v47
v_cvt_pk_bf16_f32 v78, v44, v45
v_cvt_pk_bf16_f32 v79, v46, v47
v_mfma_f32_16x16x32_bf16 v[44:47], a[16:19], a[208:211], v[92:95]
ds_read_b128 a[52:55], v2 offset:5120
v_mfma_f32_16x16x32_bf16 v[44:47], a[20:23], a[212:215], v[44:47]
buffer_load_dwordx4 a[92:95], v3, s[88:91], s101 offen offset:1024 sc1
v_mfma_f32_16x16x32_bf16 v[44:47], a[24:27], a[216:219], v[44:47]
ds_read_b128 a[56:59], v2 offset:6144
v_mfma_f32_16x16x32_bf16 v[44:47], a[28:31], a[220:223], v[44:47]
ds_read_b128 a[60:63], v2 offset:7168
s_waitcnt lgkmcnt(0)
v_mfma_f32_16x16x32_bf16 v[224:227], a[32:35], v[76:79], v[224:227]
ds_read_b128 a[0:3], v2 offset:24576
s_add_u32 s101, s101, 0x2000
v_mfma_f32_16x16x32_bf16 v[228:231], a[36:39], v[76:79], v[228:231]
buffer_load_dwordx4 a[96:99], v3, s[88:91], s101 offen sc1
v_mfma_f32_16x16x32_bf16 v[232:235], a[40:43], v[76:79], v[232:235]
ds_read_b128 a[4:7], v2 offset:25600
v_exp_f32 v28, v28
v_mfma_f32_16x16x32_bf16 v[236:239], a[44:47], v[76:79], v[236:239]
buffer_load_dwordx4 a[100:103], v3, s[88:91], s101 offen offset:1024 sc1
v_mfma_f32_16x16x32_bf16 v[240:243], a[48:51], v[76:79], v[240:243]
ds_read_b128 a[8:11], v2 offset:26624
s_add_u32 s101, s101, 0x2000
v_mfma_f32_16x16x32_bf16 v[244:247], a[52:55], v[76:79], v[244:247]
buffer_load_dwordx4 a[104:107], v3, s[88:91], s101 offen sc1
v_mfma_f32_16x16x32_bf16 v[248:251], a[56:59], v[76:79], v[248:251]
ds_read_b128 a[12:15], v2 offset:27648
s_waitcnt lgkmcnt(0)
v_mfma_f32_16x16x32_bf16 v[252:255], a[60:63], v[76:79], v[252:255]
buffer_load_dwordx4 a[108:111], v3, s[88:91], s101 offen offset:1024 sc1
ds_read_b128 a[16:19], v2 offset:28672
v_mfma_f32_16x16x32_bf16 a[228:231], a[236:239], v[76:79], a[228:231]
ds_read_b128 a[20:23], v2 offset:29696
s_add_u32 s101, s101, 0x2000
v_exp_f32 v29, v29
v_exp_f32 v30, v30
v_exp_f32 v31, v31
v_cvt_pk_bf16_f32 v60, v28, v29
v_cvt_pk_bf16_f32 v61, v30, v31
v_mfma_f32_16x16x32_bf16 v[28:31], a[0:3], a[208:211], v[120:123]
buffer_load_dwordx4 a[112:115], v3, s[88:91], s101 offen sc1
ds_read_b128 a[24:27], v2 offset:30720
v_mfma_f32_16x16x32_bf16 v[28:31], a[4:7], a[212:215], v[28:31]
ds_read_b128 a[28:31], v2 offset:31744
s_waitcnt lgkmcnt(0)
v_mfma_f32_16x16x32_bf16 v[28:31], a[8:11], a[216:219], v[28:31]
buffer_load_dwordx4 a[116:119], v3, s[88:91], s101 offen offset:1024 sc1
v_mfma_f32_16x16x32_bf16 v[28:31], a[12:15], a[220:223], v[28:31]
ds_read_b128 a[32:35], v2 offset:16384
s_add_u32 s101, s101, 0x2000
v_exp_f32 v44, v44
v_exp_f32 v45, v45
v_exp_f32 v46, v46
v_exp_f32 v47, v47
v_cvt_pk_bf16_f32 v62, v44, v45
v_cvt_pk_bf16_f32 v63, v46, v47
v_mfma_f32_16x16x32_bf16 v[44:47], a[16:19], a[208:211], v[124:127]
buffer_load_dwordx4 a[120:123], v3, s[88:91], s101 offen sc1
v_mfma_f32_16x16x32_bf16 v[44:47], a[20:23], a[212:215], v[44:47]
buffer_load_dwordx4 a[124:127], v3, s[88:91], s101 offen offset:1024 sc1
v_mfma_f32_16x16x32_bf16 v[44:47], a[24:27], a[216:219], v[44:47]
ds_read_b128 a[36:39], v2 offset:17408
v_mfma_f32_16x16x32_bf16 v[44:47], a[28:31], a[220:223], v[44:47]
ds_read_b128 a[40:43], v2 offset:18432
ds_read_b128 a[44:47], v2 offset:19456
ds_read_b128 a[48:51], v2 offset:20480
ds_read_b128 a[52:55], v2 offset:21504
ds_read_b128 a[56:59], v2 offset:22528
ds_read_b128 a[60:63], v2 offset:23552
v_xor_b32 v2, 0x38000, v2
s_waitcnt lgkmcnt(0)
s_barrier
v_accvgpr_read_b32 v6, a228
v_accvgpr_read_b32 v7, a229
v_add_f32 v6, v6, v7
v_cmp_nge_f32 vcc, 0x5f800000, v6
v_rcp_f32 v6, v6
s_or_b64 s[34:35], s[34:35], vcc
v_mfma_f32_16x16x32_bf16 v[224:227], a[32:35], v[60:63], v[224:227]
ds_read_b128 a[32:35], v1 offset:0
v_exp_f32 v28, v28
v_mfma_f32_16x16x32_bf16 v[228:231], a[36:39], v[60:63], v[228:231]
ds_read_b128 a[36:39], v1 offset:1024
v_exp_f32 v29, v29
v_mfma_f32_16x16x32_bf16 v[232:235], a[40:43], v[60:63], v[232:235]
ds_read_b128 a[40:43], v1 offset:2048
v_exp_f32 v30, v30
v_mfma_f32_16x16x32_bf16 v[236:239], a[44:47], v[60:63], v[236:239]
ds_read_b128 a[44:47], v1 offset:3072
v_exp_f32 v31, v31
v_mfma_f32_16x16x32_bf16 v[240:243], a[48:51], v[60:63], v[240:243]
ds_read_b128 a[48:51], v1 offset:4096
v_exp_f32 v44, v44
v_mfma_f32_16x16x32_bf16 v[244:247], a[52:55], v[60:63], v[244:247]
ds_read_b128 a[52:55], v1 offset:5120
v_exp_f32 v45, v45
v_mfma_f32_16x16x32_bf16 v[248:251], a[56:59], v[60:63], v[248:251]
ds_read_b128 a[56:59], v1 offset:6144
v_exp_f32 v46, v46
v_mfma_f32_16x16x32_bf16 v[252:255], a[60:63], v[60:63], v[252:255]
ds_read_b128 a[60:63], v1 offset:7168
v_exp_f32 v47, v47
v_mfma_f32_16x16x32_bf16 a[228:231], a[236:239], v[60:63], a[228:231]
v_cvt_pk_bf16_f32 v76, v28, v29
v_cvt_pk_bf16_f32 v77, v30, v31
v_cvt_pk_bf16_f32 v78, v44, v45
v_cvt_pk_bf16_f32 v79, v46, v47
s_add_u32 s8, s30, 0x0
v_pk_mul_f32 v[192:193], v[192:193], v[6:7] op_sel_hi:[1,0]
v_pk_mul_f32 v[194:195], v[194:195], v[6:7] op_sel_hi:[1,0]
v_pk_mul_f32 v[196:197], v[196:197], v[6:7] op_sel_hi:[1,0]
v_pk_mul_f32 v[198:199], v[198:199], v[6:7] op_sel_hi:[1,0]
v_cvt_pk_bf16_f32 v192, v192, v193
v_cvt_pk_bf16_f32 v193, v194, v195
v_cvt_pk_bf16_f32 v194, v196, v197
v_cvt_pk_bf16_f32 v195, v198, v199
buffer_store_dwordx4 v[192:195], v3, s[88:91], s8 offen sc1
s_add_u32 s8, s30, 0x2000
v_pk_mul_f32 v[200:201], v[200:201], v[6:7] op_sel_hi:[1,0]
v_pk_mul_f32 v[202:203], v[202:203], v[6:7] op_sel_hi:[1,0]
v_pk_mul_f32 v[204:205], v[204:205], v[6:7] op_sel_hi:[1,0]
v_pk_mul_f32 v[206:207], v[206:207], v[6:7] op_sel_hi:[1,0]
v_cvt_pk_bf16_f32 v200, v200, v201
v_cvt_pk_bf16_f32 v201, v202, v203
v_cvt_pk_bf16_f32 v202, v204, v205
v_cvt_pk_bf16_f32 v203, v206, v207
buffer_store_dwordx4 v[200:203], v3, s[88:91], s8 offen sc1
s_waitcnt lgkmcnt(0)
v_mfma_f32_16x16x32_bf16 v[224:227], a[32:35], v[76:79], v[224:227]
s_add_u32 s8, s30, 0x4000
v_mul_f32 v208, v6, v208
v_mfma_f32_16x16x32_bf16 v[228:231], a[36:39], v[76:79], v[228:231]
v_mul_f32 v209, v6, v209
v_mul_f32 v210, v6, v210
v_mfma_f32_16x16x32_bf16 v[232:235], a[40:43], v[76:79], v[232:235]
v_mul_f32 v211, v6, v211
v_mul_f32 v212, v6, v212
v_mfma_f32_16x16x32_bf16 v[236:239], a[44:47], v[76:79], v[236:239]
v_mul_f32 v213, v6, v213
v_mul_f32 v214, v6, v214
v_mfma_f32_16x16x32_bf16 v[240:243], a[48:51], v[76:79], v[240:243]
v_mul_f32 v215, v6, v215
v_cvt_pk_bf16_f32 v208, v208, v209
v_mfma_f32_16x16x32_bf16 v[244:247], a[52:55], v[76:79], v[244:247]
v_cvt_pk_bf16_f32 v209, v210, v211
v_cvt_pk_bf16_f32 v210, v212, v213
v_mfma_f32_16x16x32_bf16 v[248:251], a[56:59], v[76:79], v[248:251]
v_cvt_pk_bf16_f32 v211, v214, v215
buffer_store_dwordx4 v[208:211], v3, s[88:91], s8 offen sc1
v_mfma_f32_16x16x32_bf16 v[252:255], a[60:63], v[76:79], v[252:255]
s_add_u32 s8, s30, 0x6000
v_mul_f32 v216, v6, v216
v_mfma_f32_16x16x32_bf16 a[228:231], a[236:239], v[76:79], a[228:231]
v_mul_f32 v217, v6, v217
v_mul_f32 v218, v6, v218
v_mul_f32 v219, v6, v219
v_mul_f32 v220, v6, v220
v_mul_f32 v221, v6, v221
v_mul_f32 v222, v6, v222
v_mul_f32 v223, v6, v223
v_cvt_pk_bf16_f32 v216, v216, v217
v_cvt_pk_bf16_f32 v217, v218, v219
v_cvt_pk_bf16_f32 v218, v220, v221
v_cvt_pk_bf16_f32 v219, v222, v223
buffer_store_dwordx4 v[216:219], v3, s[88:91], s8 offen sc1
s_branch L_att_fin
L_att_sh0_1:
v_mfma_f32_16x16x32_bf16 v[192:195], a[32:35], v[56:59], v[192:195]
v_exp_f32 v30, v30
v_mfma_f32_16x16x32_bf16 v[224:227], a[32:35], v[60:63], v[224:227]
buffer_load_dword v14, v15, s[84:87], 0 offen offset:192 sc1
v_mfma_f32_16x16x32_bf16 v[228:231], a[36:39], v[60:63], v[228:231]
v_exp_f32 v31, v31
v_mfma_f32_16x16x32_bf16 v[196:199], a[36:39], v[56:59], v[196:199]
s_add_u32 m0, s17, 0x10000
v_exp_f32 v40, v40
v_mfma_f32_16x16x32_bf16 v[200:203], a[40:43], v[56:59], v[200:203]
ds_read_b128 a[0:3], v1 offset:8192
v_cvt_pk_bf16_f32 v72, v24, v25
v_mfma_f32_16x16x32_bf16 v[232:235], a[40:43], v[60:63], v[232:235]
ds_read_b128 a[4:7], v1 offset:9216
v_cvt_pk_bf16_f32 v73, v26, v27
v_mfma_f32_16x16x32_bf16 v[236:239], a[44:47], v[60:63], v[236:239]
buffer_load_dwordx4 v12, s[72:75], 0 offen lds
v_mfma_f32_16x16x32_bf16 v[204:207], a[44:47], v[56:59], v[204:207]
ds_read_b128 a[8:11], v1 offset:10240
v_cvt_pk_bf16_f32 v76, v28, v29
v_mfma_f32_16x16x32_bf16 v[208:211], a[48:51], v[56:59], v[208:211]
buffer_load_dwordx4 v13, s[72:75], 0 offen offset:1024 lds
v_mfma_f32_16x16x32_bf16 v[240:243], a[48:51], v[60:63], v[240:243]
ds_read_b128 a[12:15], v1 offset:11264
v_cvt_pk_bf16_f32 v77, v30, v31
v_mfma_f32_16x16x32_bf16 v[244:247], a[52:55], v[60:63], v[244:247]
buffer_load_dwordx4 v12, s[72:75], s12 offen offset:2048 lds
v_mfma_f32_16x16x32_bf16 v[212:215], a[52:55], v[56:59], v[212:215]
ds_read_b128 a[16:19], v1 offset:12288
v_exp_f32 v41, v41
v_mfma_f32_16x16x32_bf16 v[216:219], a[56:59], v[56:59], v[216:219]
ds_read_b128 a[20:23], v1 offset:13312
v_exp_f32 v42, v42
v_mfma_f32_16x16x32_bf16 v[248:251], a[56:59], v[60:63], v[248:251]
buffer_load_dwordx4 v13, s[72:75], s12 offen offset:3072 lds
v_mfma_f32_16x16x32_bf16 v[252:255], a[60:63], v[60:63], v[252:255]
ds_read_b128 a[24:27], v1 offset:14336
s_waitcnt lgkmcnt(3)
v_mfma_f32_16x16x32_bf16 v[220:223], a[60:63], v[56:59], v[220:223]
ds_read_b128 a[28:31], v1 offset:15360
v_add_u32 v12, 0x20000, v12
v_smfmac_f32_16x16x64_bf16 a[228:231], a[232:235], v[56:63], v9
s_add_u32 m0, s17, 0x14000
v_exp_f32 v43, v43
v_mfma_f32_16x16x32_bf16 v[24:27], a[0:3], a[192:195], v[88:91]
buffer_load_dwordx4 v12, s[72:75], 0 offen lds
v_mfma_f32_16x16x32_bf16 v[24:27], a[4:7], a[196:199], v[24:27]
ds_read_b128 a[32:35], v1 offset:0
v_cvt_pk_bf16_f32 v74, v40, v41
v_mfma_f32_16x16x32_bf16 v[24:27], a[8:11], a[200:203], v[24:27]
ds_read_b128 a[36:39], v1 offset:1024
v_exp_f32 v44, v44
v_mfma_f32_16x16x32_bf16 v[24:27], a[12:15], a[204:207], v[24:27]
ds_read_b128 a[40:43], v1 offset:2048
v_exp_f32 v45, v45
v_mfma_f32_16x16x32_bf16 v[28:31], a[0:3], a[208:211], v[92:95]
ds_read_b128 a[44:47], v1 offset:3072
v_exp_f32 v46, v46
v_mfma_f32_16x16x32_bf16 v[28:31], a[4:7], a[212:215], v[28:31]
s_waitcnt lgkmcnt(4)
v_exp_f32 v47, v47
v_mfma_f32_16x16x32_bf16 v[28:31], a[8:11], a[216:219], v[28:31]
ds_read_b128 a[48:51], v1 offset:4096
v_add_u32 v13, 0x20000, v13
v_mfma_f32_16x16x32_bf16 v[28:31], a[12:15], a[220:223], v[28:31]
buffer_load_dwordx4 v13, s[72:75], 0 offen offset:1024 lds
v_cvt_pk_bf16_f32 v75, v42, v43
v_mfma_f32_16x16x32_bf16 v[40:43], a[16:19], a[192:195], v[88:91]
ds_read_b128 a[52:55], v1 offset:5120
v_exp_f32 v24, v24
v_mfma_f32_16x16x32_bf16 v[40:43], a[20:23], a[196:199], v[40:43]
buffer_load_dwordx4 v12, s[72:75], s12 offen offset:2048 lds
v_mfma_f32_16x16x32_bf16 v[40:43], a[24:27], a[200:203], v[40:43]
ds_read_b128 a[56:59], v1 offset:6144
v_exp_f32 v25, v25
v_mfma_f32_16x16x32_bf16 v[40:43], a[28:31], a[204:207], v[40:43]
ds_read_b128 a[60:63], v1 offset:7168
v_cvt_pk_bf16_f32 v78, v44, v45
v_cvt_pk_bf16_f32 v79, v46, v47
v_mfma_f32_16x16x32_bf16 v[44:47], a[16:19], a[208:211], v[92:95]
buffer_load_dwordx4 v13, s[72:75], s12 offen offset:3072 lds
v_mfma_f32_16x16x32_bf16 v[44:47], a[20:23], a[212:215], v[44:47]
v_exp_f32 v26, v26
v_mfma_f32_16x16x32_bf16 v[44:47], a[24:27], a[216:219], v[44:47]
v_exp_f32 v27, v27
v_mfma_f32_16x16x32_bf16 v[44:47], a[28:31], a[220:223], v[44:47]
s_waitcnt lgkmcnt(0)
v_exp_f32 v28, v28
v_exp_f32 v29, v29
v_mfma_f32_16x16x32_bf16 v[192:195], a[32:35], v[72:75], v[192:195]
s_add_u32 m0, s16, 0x0
v_add_u32 v12, 0x20000, v12
v_cvt_pk_bf16_f32 v56, v24, v25
v_mfma_f32_16x16x32_bf16 v[224:227], a[32:35], v[76:79], v[224:227]
buffer_load_dwordx4 v12, s[72:75], 0 offen lds
v_mfma_f32_16x16x32_bf16 v[228:231], a[36:39], v[76:79], v[228:231]
ds_read_b128 a[0:3], v1 offset:24576
v_cvt_pk_bf16_f32 v57, v26, v27
v_mfma_f32_16x16x32_bf16 v[196:199], a[36:39], v[72:75], v[196:199]
v_exp_f32 v30, v30
v_mfma_f32_16x16x32_bf16 v[200:203], a[40:43], v[72:75], v[200:203]
ds_read_b128 a[4:7], v1 offset:25600
v_cvt_pk_bf16_f32 v60, v28, v29
v_mfma_f32_16x16x32_bf16 v[232:235], a[40:43], v[76:79], v[232:235]
ds_read_b128 a[8:11], v1 offset:26624
v_add_u32 v13, 0x20000, v13
v_mfma_f32_16x16x32_bf16 v[236:239], a[44:47], v[76:79], v[236:239]
buffer_load_dwordx4 v13, s[72:75], 0 offen offset:1024 lds
v_mfma_f32_16x16x32_bf16 v[204:207], a[44:47], v[72:75], v[204:207]
ds_read_b128 a[12:15], v1 offset:27648
v_exp_f32 v31, v31
v_mfma_f32_16x16x32_bf16 v[208:211], a[48:51], v[72:75], v[208:211]
buffer_load_dwordx4 v12, s[72:75], s12 offen offset:2048 lds
v_mfma_f32_16x16x32_bf16 v[240:243], a[48:51], v[76:79], v[240:243]
ds_read_b128 a[16:19], v1 offset:28672
v_exp_f32 v40, v40
v_mfma_f32_16x16x32_bf16 v[244:247], a[52:55], v[76:79], v[244:247]
ds_read_b128 a[20:23], v1 offset:29696
v_cvt_pk_bf16_f32 v61, v30, v31
v_mfma_f32_16x16x32_bf16 v[212:215], a[52:55], v[72:75], v[212:215]
buffer_load_dwordx4 v13, s[72:75], s12 offen offset:3072 lds
v_mfma_f32_16x16x32_bf16 v[216:219], a[56:59], v[72:75], v[216:219]
ds_read_b128 a[24:27], v1 offset:30720
v_exp_f32 v41, v41
v_mfma_f32_16x16x32_bf16 v[248:251], a[56:59], v[76:79], v[248:251]
ds_read_b128 a[28:31], v1 offset:31744
v_exp_f32 v42, v42
v_mfma_f32_16x16x32_bf16 v[252:255], a[60:63], v[76:79], v[252:255]
ds_read_b128 a[32:35], v1 offset:16384
v_cvt_pk_bf16_f32 v58, v40, v41
v_mfma_f32_16x16x32_bf16 v[220:223], a[60:63], v[72:75], v[220:223]
s_waitcnt lgkmcnt(5)
v_exp_f32 v43, v43
v_smfmac_f32_16x16x64_bf16 a[228:231], a[232:235], v[72:79], v9
ds_read_b128 a[36:39], v1 offset:17408
v_add_u32 v12, 0x20000, v12
v_mfma_f32_16x16x32_bf16 v[24:27], a[0:3], a[192:195], v[112:115]
s_add_u32 m0, s16, 0x4000
v_exp_f32 v44, v44
v_mfma_f32_16x16x32_bf16 v[24:27], a[4:7], a[196:199], v[24:27]
buffer_load_dwordx4 v12, s[72:75], 0 offen lds
v_mfma_f32_16x16x32_bf16 v[24:27], a[8:11], a[200:203], v[24:27]
ds_read_b128 a[40:43], v1 offset:18432
v_add_u32 v13, 0x20000, v13
v_mfma_f32_16x16x32_bf16 v[24:27], a[12:15], a[204:207], v[24:27]
buffer_load_dwordx4 v13, s[72:75], 0 offen offset:1024 lds
v_mfma_f32_16x16x32_bf16 v[28:31], a[0:3], a[208:211], v[92:95]
ds_read_b128 a[44:47], v1 offset:19456
v_cvt_pk_bf16_f32 v59, v42, v43
v_mfma_f32_16x16x32_bf16 v[28:31], a[4:7], a[212:215], v[28:31]
ds_read_b128 a[48:51], v1 offset:20480
v_exp_f32 v45, v45
v_mfma_f32_16x16x32_bf16 v[28:31], a[8:11], a[216:219], v[28:31]
s_waitcnt lgkmcnt(5)
v_exp_f32 v46, v46
v_mfma_f32_16x16x32_bf16 v[28:31], a[12:15], a[220:223], v[28:31]
buffer_load_dwordx4 v12, s[72:75], s12 offen offset:2048 lds
v_mfma_f32_16x16x32_bf16 v[40:43], a[16:19], a[192:195], v[116:119]
ds_read_b128 a[52:55], v1 offset:21504
v_exp_f32 v47, v47
v_mfma_f32_16x16x32_bf16 v[40:43], a[20:23], a[196:199], v[40:43]
ds_read_b128 a[56:59], v1 offset:22528
v_exp_f32 v24, v24
v_mfma_f32_16x16x32_bf16 v[40:43], a[24:27], a[200:203], v[40:43]
ds_read_b128 a[60:63], v1 offset:23552
v_xor_b32 v1, 0x8000, v1
v_mfma_f32_16x16x32_bf16 v[40:43], a[28:31], a[204:207], v[40:43]
v_exp_f32 v25, v25
v_cvt_pk_bf16_f32 v62, v44, v45
v_cvt_pk_bf16_f32 v63, v46, v47
v_mfma_f32_16x16x32_bf16 v[44:47], a[16:19], a[208:211], v[92:95]
v_exp_f32 v26, v26
v_mfma_f32_16x16x32_bf16 v[44:47], a[20:23], a[212:215], v[44:47]
buffer_load_dwordx4 v13, s[72:75], s12 offen offset:3072 lds
v_mfma_f32_16x16x32_bf16 v[44:47], a[24:27], a[216:219], v[44:47]
v_exp_f32 v27, v27
v_mfma_f32_16x16x32_bf16 v[44:47], a[28:31], a[220:223], v[44:47]
v_exp_f32 v28, v28
v_exp_f32 v29, v29
L_att_h1_1:
s_waitcnt vmcnt(16) lgkmcnt(0)
s_mov_b32 s92, 200000
L_spin_b1:
v_cmp_gt_u32 vcc, 32, v14
s_nop 4
s_cbranch_vccz L_spun_b1
s_sub_u32 s92, s92, 1
s_cbranch_scc1 L_spun_b1
s_sleep 6
buffer_load_dword v14, v15, s[84:87], 0 offen offset:192 sc1
s_waitcnt vmcnt(0)
s_branch L_spin_b1
L_spun_b1:
s_barrier
v_mfma_f32_16x16x32_bf16 v[192:195], a[32:35], v[56:59], v[192:195]
ds_read_b128 a[0:3], v2 offset:8192
v_cvt_pk_bf16_f32 v72, v24, v25
v_mfma_f32_16x16x32_bf16 v[224:227], a[32:35], v[60:63], v[224:227]
ds_read_b128 a[4:7], v2 offset:9216
v_cvt_pk_bf16_f32 v73, v26, v27
v_mfma_f32_16x16x32_bf16 v[228:231], a[36:39], v[60:63], v[228:231]
s_add_u32 s101, s101, 0x2000
v_exp_f32 v30, v30
v_mfma_f32_16x16x32_bf16 v[196:199], a[36:39], v[56:59], v[196:199]
buffer_load_dwordx4 a[64:67], v3, s[88:91], s101 offen sc1
v_mfma_f32_16x16x32_bf16 v[200:203], a[40:43], v[56:59], v[200:203]
ds_read_b128 a[8:11], v2 offset:10240
v_cvt_pk_bf16_f32 v76, v28, v29
v_mfma_f32_16x16x32_bf16 v[232:235], a[40:43], v[60:63], v[232:235]
buffer_load_dwordx4 a[68:71], v3, s[88:91], s101 offen offset:1024 sc1
v_mfma_f32_16x16x32_bf16 v[236:239], a[44:47], v[60:63], v[236:239]
ds_read_b128 a[12:15], v2 offset:11264
s_add_u32 s101, s101, 0x2000
v_mfma_f32_16x16x32_bf16 v[204:207], a[44:47], v[56:59], v[204:207]
buffer_load_dwordx4 a[72:75], v3, s[88:91], s101 offen sc1
v_mfma_f32_16x16x32_bf16 v[208:211], a[48:51], v[56:59], v[208:211]
ds_read_b128 a[16:19], v2 offset:12288
v_exp_f32 v31, v31
v_mfma_f32_16x16x32_bf16 v[240:243], a[48:51], v[60:63], v[240:243]
buffer_load_dwordx4 a[76:79], v3, s[88:91], s101 offen offset:1024 sc1
v_mfma_f32_16x16x32_bf16 v[244:247], a[52:55], v[60:63], v[244:247]
ds_read_b128 a[20:23], v2 offset:13312
v_exp_f32 v40, v40
v_mfma_f32_16x16x32_bf16 v[212:215], a[52:55], v[56:59], v[212:215]
ds_read_b128 a[24:27], v2 offset:14336
v_exp_f32 v41, v41
v_mfma_f32_16x16x32_bf16 v[216:219], a[56:59], v[56:59], v[216:219]
ds_read_b128 a[28:31], v2 offset:15360
s_add_u32 s101, s101, 0x2000
v_mfma_f32_16x16x32_bf16 v[248:251], a[56:59], v[60:63], v[248:251]
buffer_load_dwordx4 a[80:83], v3, s[88:91], s101 offen sc1
v_mfma_f32_16x16x32_bf16 v[252:255], a[60:63], v[60:63], v[252:255]
ds_read_b128 a[32:35], v2 offset:0
v_cvt_pk_bf16_f32 v77, v30, v31
v_mfma_f32_16x16x32_bf16 v[220:223], a[60:63], v[56:59], v[220:223]
ds_read_b128 a[36:39], v2 offset:1024
s_waitcnt lgkmcnt(6)
v_smfmac_f32_16x16x64_bf16 a[228:231], a[232:235], v[56:63], v9
buffer_load_dwordx4 a[84:87], v3, s[88:91], s101 offen offset:1024 sc1
v_mfma_f32_16x16x32_bf16 v[28:31], a[0:3], a[208:211], v[120:123]
ds_read_b128 a[40:43], v2 offset:2048
v_exp_f32 v42, v42
v_mfma_f32_16x16x32_bf16 v[28:31], a[4:7], a[212:215], v[28:31]
ds_read_b128 a[44:47], v2 offset:3072
s_add_u32 s101, s101, 0x2000
v_mfma_f32_16x16x32_bf16 v[28:31], a[8:11], a[216:219], v[28:31]
buffer_load_dwordx4 a[88:91], v3, s[88:91], s101 offen sc1
v_mfma_f32_16x16x32_bf16 v[28:31], a[12:15], a[220:223], v[28:31]
ds_read_b128 a[48:51], v2 offset:4096
s_waitcnt lgkmcnt(5)
v_exp_f32 v43, v43
v_exp_f32 v44, v44
v_exp_f32 v45, v45
v_exp_f32 v46, v46
v_exp_f32 v47, v47
v_cvt_pk_bf16_f32 v78, v44, v45
v_cvt_pk_bf16_f32 v79, v46, v47
v_mfma_f32_16x16x32_bf16 v[44:47], a[16:19], a[208:211], v[124:127]
ds_read_b128 a[52:55], v2 offset:5120
v_cvt_pk_bf16_f32 v74, v40, v41
v_mfma_f32_16x16x32_bf16 v[44:47], a[20:23], a[212:215], v[44:47]
buffer_load_dwordx4 a[92:95], v3, s[88:91], s101 offen offset:1024 sc1
v_mfma_f32_16x16x32_bf16 v[44:47], a[24:27], a[216:219], v[44:47]
ds_read_b128 a[56:59], v2 offset:6144
v_cvt_pk_bf16_f32 v75, v42, v43
v_mfma_f32_16x16x32_bf16 v[44:47], a[28:31], a[220:223], v[44:47]
ds_read_b128 a[60:63], v2 offset:7168
s_waitcnt lgkmcnt(0)
v_mfma_f32_16x16x32_bf16 v[192:195], a[32:35], v[72:75], v[192:195]
s_add_u32 s101, s101, 0x2000
v_exp_f32 v28, v28
v_mfma_f32_16x16x32_bf16 v[224:227], a[32:35], v[76:79], v[224:227]
buffer_load_dwordx4 a[96:99], v3, s[88:91], s101 offen sc1
v_mfma_f32_16x16x32_bf16 v[228:231], a[36:39], v[76:79], v[228:231]
ds_read_b128 a[32:35], v2 offset:16384
v_exp_f32 v29, v29
v_mfma_f32_16x16x32_bf16 v[196:199], a[36:39], v[72:75], v[196:199]
buffer_load_dwordx4 a[100:103], v3, s[88:91], s101 offen offset:1024 sc1
v_mfma_f32_16x16x32_bf16 v[200:203], a[40:43], v[72:75], v[200:203]
ds_read_b128 a[36:39], v2 offset:17408
s_add_u32 s101, s101, 0x2000
v_mfma_f32_16x16x32_bf16 v[232:235], a[40:43], v[76:79], v[232:235]
buffer_load_dwordx4 a[104:107], v3, s[88:91], s101 offen sc1
v_mfma_f32_16x16x32_bf16 v[236:239], a[44:47], v[76:79], v[236:239]
ds_read_b128 a[40:43], v2 offset:18432
v_exp_f32 v30, v30
v_mfma_f32_16x16x32_bf16 v[204:207], a[44:47], v[72:75], v[204:207]
buffer_load_dwordx4 a[108:111], v3, s[88:91], s101 offen offset:1024 sc1
v_mfma_f32_16x16x32_bf16 v[208:211], a[48:51], v[72:75], v[208:211]
ds_read_b128 a[44:47], v2 offset:19456
s_add_u32 s101, s101, 0x2000
v_mfma_f32_16x16x32_bf16 v[240:243], a[48:51], v[76:79], v[240:243]
buffer_load_dwordx4 a[112:115], v3, s[88:91], s101 offen sc1
v_mfma_f32_16x16x32_bf16 v[244:247], a[52:55], v[76:79], v[244:247]
ds_read_b128 a[48:51], v2 offset:20480
v_exp_f32 v31, v31
v_mfma_f32_16x16x32_bf16 v[212:215], a[52:55], v[72:75], v[212:215]
buffer_load_dwordx4 a[116:119], v3, s[88:91], s101 offen offset:1024 sc1
v_mfma_f32_16x16x32_bf16 v[216:219], a[56:59], v[72:75], v[216:219]
ds_read_b128 a[52:55], v2 offset:21504
s_add_u32 s101, s101, 0x2000
v_mfma_f32_16x16x32_bf16 v[248:251], a[56:59], v[76:79], v[248:251]
buffer_load_dwordx4 a[120:123], v3, s[88:91], s101 offen sc1
v_mfma_f32_16x16x32_bf16 v[252:255], a[60:63], v[76:79], v[252:255]
buffer_load_dwordx4 a[124:127], v3, s[88:91], s101 offen offset:1024 sc1
v_mfma_f32_16x16x32_bf16 v[220:223], a[60:63], v[72:75], v[220:223]
ds_read_b128 a[56:59], v2 offset:22528
v_cvt_pk_bf16_f32 v60, v28, v29
v_smfmac_f32_16x16x64_bf16 a[228:231], a[232:235], v[72:79], v9
ds_read_b128 a[60:63], v2 offset:23552
v_xor_b32 v2, 0x38000, v2
v_exp_f32 v44, v44
v_exp_f32 v45, v45
v_exp_f32 v46, v46
v_exp_f32 v47, v47
v_cvt_pk_bf16_f32 v61, v30, v31
v_cvt_pk_bf16_f32 v62, v44, v45
v_cvt_pk_bf16_f32 v63, v46, v47
s_waitcnt lgkmcnt(0)
s_barrier
v_accvgpr_read_b32 v6, a228
v_accvgpr_read_b32 v7, a229
v_add_f32 v6, v6, v7
v_cmp_nge_f32 vcc, 0x5f800000, v6
v_rcp_f32 v6, v6
s_or_b64 s[34:35], s[34:35], vcc
v_mfma_f32_16x16x32_bf16 v[224:227], a[32:35], v[60:63], v[224:227]
s_add_u32 s8, s30, 0x0
v_mul_f32 v192, v6, v192
v_mfma_f32_16x16x32_bf16 v[228:231], a[36:39], v[60:63], v[228:231]
v_mul_f32 v193, v6, v193
v_mul_f32 v194, v6, v194
v_mfma_f32_16x16x32_bf16 v[232:235], a[40:43], v[60:63], v[232:235]
v_mul_f32 v195, v6, v195
v_mul_f32 v196, v6, v196
v_mfma_f32_16x16x32_bf16 v[236:239], a[44:47], v[60:63], v[236:239]
v_mul_f32 v197, v6, v197
v_mul_f32 v198, v6, v198
v_mfma_f32_16x16x32_bf16 v[240:243], a[48:51], v[60:63], v[240:243]
v_mul_f32 v199, v6, v199
v_cvt_pk_bf16_f32 v192, v192, v193
v_mfma_f32_16x16x32_bf16 v[244:247], a[52:55], v[60:63], v[244:247]
v_cvt_pk_bf16_f32 v193, v194, v195
v_cvt_pk_bf16_f32 v194, v196, v197
v_mfma_f32_16x16x32_bf16 v[248:251], a[56:59], v[60:63], v[248:251]
v_cvt_pk_bf16_f32 v195, v198, v199
buffer_store_dwordx4 v[192:195], v3, s[88:91], s8 offen sc1
v_mfma_f32_16x16x32_bf16 v[252:255], a[60:63], v[60:63], v[252:255]
v_mfma_f32_16x16x32_bf16 a[228:231], a[236:239], v[60:63], a[228:231]
s_add_u32 s8, s30, 0x2000
v_pk_mul_f32 v[200:201], v[200:201], v[6:7] op_sel_hi:[1,0]
v_pk_mul_f32 v[202:203], v[202:203], v[6:7] op_sel_hi:[1,0]
v_pk_mul_f32 v[204:205], v[204:205], v[6:7] op_sel_hi:[1,0]
v_pk_mul_f32 v[206:207], v[206:207], v[6:7] op_sel_hi:[1,0]
v_cvt_pk_bf16_f32 v200, v200, v201
v_cvt_pk_bf16_f32 v201, v202, v203
v_cvt_pk_bf16_f32 v202, v204, v205
v_cvt_pk_bf16_f32 v203, v206, v207
buffer_store_dwordx4 v[200:203], v3, s[88:91], s8 offen sc1
s_add_u32 s8, s30, 0x4000
v_pk_mul_f32 v[208:209], v[208:209], v[6:7] op_sel_hi:[1,0]
v_pk_mul_f32 v[210:211], v[210:211], v[6:7] op_sel_hi:[1,0]
v_pk_mul_f32 v[212:213], v[212:213], v[6:7] op_sel_hi:[1,0]
v_pk_mul_f32 v[214:215], v[214:215], v[6:7] op_sel_hi:[1,0]
v_cvt_pk_bf16_f32 v208, v208, v209
v_cvt_pk_bf16_f32 v209, v210, v211
v_cvt_pk_bf16_f32 v210, v212, v213
v_cvt_pk_bf16_f32 v211, v214, v215
buffer_store_dwordx4 v[208:211], v3, s[88:91], s8 offen sc1
s_add_u32 s8, s30, 0x6000
v_pk_mul_f32 v[216:217], v[216:217], v[6:7] op_sel_hi:[1,0]
v_pk_mul_f32 v[218:219], v[218:219], v[6:7] op_sel_hi:[1,0]
v_pk_mul_f32 v[220:221], v[220:221], v[6:7] op_sel_hi:[1,0]
v_pk_mul_f32 v[222:223], v[222:223], v[6:7] op_sel_hi:[1,0]
v_cvt_pk_bf16_f32 v216, v216, v217
v_cvt_pk_bf16_f32 v217, v218, v219
v_cvt_pk_bf16_f32 v218, v220, v221
v_cvt_pk_bf16_f32 v219, v222, v223
buffer_store_dwordx4 v[216:219], v3, s[88:91], s8 offen sc1
L_att_fin:
v_accvgpr_read_b32 v6, a230
v_accvgpr_read_b32 v7, a231
v_add_f32 v6, v6, v7
v_cmp_nge_f32 vcc, 0x5f800000, v6
v_rcp_f32 v6, v6
s_or_b64 s[34:35], s[34:35], vcc
s_add_u32 s8, s31, 0x0
v_pk_mul_f32 v[224:225], v[224:225], v[6:7] op_sel_hi:[1,0]
v_pk_mul_f32 v[226:227], v[226:227], v[6:7] op_sel_hi:[1,0]
v_pk_mul_f32 v[228:229], v[228:229], v[6:7] op_sel_hi:[1,0]
v_pk_mul_f32 v[230:231], v[230:231], v[6:7] op_sel_hi:[1,0]
v_cvt_pk_bf16_f32 v224, v224, v225
v_cvt_pk_bf16_f32 v225, v226, v227
v_cvt_pk_bf16_f32 v226, v228, v229
v_cvt_pk_bf16_f32 v227, v230, v231
buffer_store_dwordx4 v[224:227], v3, s[88:91], s8 offen sc1
s_add_u32 s8, s31, 0x2000
v_pk_mul_f32 v[232:233], v[232:233], v[6:7] op_sel_hi:[1,0]
v_pk_mul_f32 v[234:235], v[234:235], v[6:7] op_sel_hi:[1,0]
v_pk_mul_f32 v[236:237], v[236:237], v[6:7] op_sel_hi:[1,0]
v_pk_mul_f32 v[238:239], v[238:239], v[6:7] op_sel_hi:[1,0]
v_cvt_pk_bf16_f32 v232, v232, v233
v_cvt_pk_bf16_f32 v233, v234, v235
v_cvt_pk_bf16_f32 v234, v236, v237
v_cvt_pk_bf16_f32 v235, v238, v239
buffer_store_dwordx4 v[232:235], v3, s[88:91], s8 offen sc1
s_add_u32 s8, s31, 0x4000
v_pk_mul_f32 v[240:241], v[240:241], v[6:7] op_sel_hi:[1,0]
v_pk_mul_f32 v[242:243], v[242:243], v[6:7] op_sel_hi:[1,0]
v_pk_mul_f32 v[244:245], v[244:245], v[6:7] op_sel_hi:[1,0]
v_pk_mul_f32 v[246:247], v[246:247], v[6:7] op_sel_hi:[1,0]
v_cvt_pk_bf16_f32 v240, v240, v241
v_cvt_pk_bf16_f32 v241, v242, v243
v_cvt_pk_bf16_f32 v242, v244, v245
v_cvt_pk_bf16_f32 v243, v246, v247
buffer_store_dwordx4 v[240:243], v3, s[88:91], s8 offen sc1
s_add_u32 s8, s31, 0x6000
v_pk_mul_f32 v[248:249], v[248:249], v[6:7] op_sel_hi:[1,0]
v_pk_mul_f32 v[250:251], v[250:251], v[6:7] op_sel_hi:[1,0]
v_pk_mul_f32 v[252:253], v[252:253], v[6:7] op_sel_hi:[1,0]
v_pk_mul_f32 v[254:255], v[254:255], v[6:7] op_sel_hi:[1,0]
v_cvt_pk_bf16_f32 v248, v248, v249
v_cvt_pk_bf16_f32 v249, v250, v251
v_cvt_pk_bf16_f32 v250, v252, v253
v_cvt_pk_bf16_f32 v251, v254, v255
buffer_store_dwordx4 v[248:251], v3, s[88:91], s8 offen sc1
s_cmp_lg_u64 s[34:35], 0
s_cselect_b32 s8, 1, 0
s_lshl_b32 s9, s4, 2
s_add_u32 s9, s9, 24576
v_mov_b32 v4, s9
v_mov_b32 v5, s8
ds_write_b32 v4, v5
v_lshrrev_b32 v17, 4, v0
v_lshlrev_b32 v18, 10, v17
v_and_b32 v17, 1, v17
v_lshl_add_u32 v18, v17, 5, v18
v_bfe_u32 v17, v0, 2, 2
v_lshl_add_u32 v18, v17, 6, v18
v_and_b32 v17, 3, v0
v_lshl_add_u32 v4, v17, 3, v18
s_sub_u32 s8, s16, s17
v_add_u32 v6, s8, v4
v_xor_b32 v7, 32, v6
v_add_u32 v4, 65536, v4
v_xor_b32 v5, 32, v4
v_and_b32 v20, 15, v0
v_lshlrev_b32 v20, 2, v20
s_waitcnt vmcnt(20) lgkmcnt(0)
s_barrier
v_and_b32 v17, 3, v0
v_lshlrev_b32 v17, 2, v17
v_add_u32 v17, 24576, v17
ds_read_b32 v18, v17
s_waitcnt lgkmcnt(0)
v_cmp_ne_u32 vcc, 0, v18
s_cmp_lg_u32 s33, 0
s_cbranch_scc1 L_att_done
s_nop 4
s_cbranch_vccnz L_att_fallback
L_att_done:
ds_read_b64_tr_b16 v[152:153], v4 offset:512
ds_read_b64_tr_b16 v[154:155], v4 offset:4608
ds_read_b64_tr_b16 v[156:157], v4 offset:8704
ds_read_b64_tr_b16 v[158:159], v4 offset:12800
ds_read_b64_tr_b16 v[160:161], v5 offset:512
ds_read_b64_tr_b16 v[162:163], v5 offset:4608
ds_read_b64_tr_b16 v[164:165], v5 offset:8704
ds_read_b64_tr_b16 v[166:167], v5 offset:12800
ds_read_b64_tr_b16 v[168:169], v4 offset:768
ds_read_b64_tr_b16 v[170:171], v4 offset:4864
ds_read_b64_tr_b16 v[172:173], v4 offset:8960
ds_read_b64_tr_b16 v[174:175], v4 offset:13056
ds_read_b64_tr_b16 v[176:177], v5 offset:768
ds_read_b64_tr_b16 v[178:179], v5 offset:4864
ds_read_b64_tr_b16 v[180:181], v5 offset:8960
ds_read_b64_tr_b16 v[182:183], v5 offset:13056
s_lshl_b32 s29, s99, 7
s_lshl_b32 s9, s4, 5
s_add_u32 s29, s29, s9
s_lshl_b32 s9, s29, 2
s_add_u32 s9, s9, 0x3700000
buffer_load_dword v8, v20, s[88:91], s9 offen sc1
buffer_load_dword v9, v20, s[88:91], s9 offen offset:64 sc1
s_waitcnt lgkmcnt(8)
v_mfma_f32_16x16x32_bf16 v[56:59], v[152:155], a[64:67], 0
ds_read_b64_tr_b16 v[184:185], v4 offset:0
v_mov_b32 v88, 0
v_mfma_f32_16x16x32_bf16 v[56:59], v[156:159], a[72:75], v[56:59]
ds_read_b64_tr_b16 v[186:187], v4 offset:4096
v_mov_b32 v89, 0
v_mfma_f32_16x16x32_bf16 v[72:75], v[156:159], a[76:79], 0
ds_read_b64_tr_b16 v[188:189], v4 offset:8192
v_mov_b32 v90, 0
v_mfma_f32_16x16x32_bf16 v[72:75], v[152:155], a[68:71], v[72:75]
ds_read_b64_tr_b16 v[190:191], v4 offset:12288
v_mov_b32 v91, 0
v_mfma_f32_16x16x32_bf16 v[76:79], v[160:163], a[68:71], 0
ds_read_b64_tr_b16 v[192:193], v5 offset:0
v_mov_b32 v92, 0
v_mfma_f32_16x16x32_bf16 v[76:79], v[164:167], a[76:79], v[76:79]
ds_read_b64_tr_b16 v[194:195], v5 offset:4096
v_mov_b32 v93, 0
v_mfma_f32_16x16x32_bf16 v[60:63], v[164:167], a[72:75], 0
ds_read_b64_tr_b16 v[196:197], v5 offset:8192
s_waitcnt lgkmcnt(7)
v_mfma_f32_16x16x32_bf16 v[60:63], v[160:163], a[64:67], v[60:63]
ds_read_b64_tr_b16 v[198:199], v5 offset:12288
v_mov_b32 v94, 0
v_mfma_f32_16x16x32_bf16 v[64:67], v[168:171], a[64:67], 0
ds_read_b64_tr_b16 v[200:201], v4 offset:256
v_mov_b32 v95, 0
v_mfma_f32_16x16x32_bf16 v[64:67], v[172:175], a[72:75], v[64:67]
ds_read_b64_tr_b16 v[202:203], v4 offset:4352
v_mov_b32 v96, 0
v_mfma_f32_16x16x32_bf16 v[80:83], v[172:175], a[76:79], 0
ds_read_b64_tr_b16 v[204:205], v4 offset:8448
v_mov_b32 v97, 0
v_mfma_f32_16x16x32_bf16 v[80:83], v[168:171], a[68:71], v[80:83]
ds_read_b64_tr_b16 v[206:207], v4 offset:12544
v_mov_b32 v98, 0
v_mfma_f32_16x16x32_bf16 v[84:87], v[176:179], a[68:71], 0
ds_read_b64_tr_b16 v[208:209], v5 offset:256
v_mov_b32 v99, 0
v_mfma_f32_16x16x32_bf16 v[84:87], v[180:183], a[76:79], v[84:87]
ds_read_b64_tr_b16 v[210:211], v5 offset:4352
s_waitcnt vmcnt(2) lgkmcnt(6)
v_mfma_f32_16x16x32_bf16 v[68:71], v[180:183], a[72:75], 0
ds_read_b64_tr_b16 v[212:213], v5 offset:8448
s_barrier
v_mfma_f32_16x16x32_bf16 v[68:71], v[176:179], a[64:67], v[68:71]
ds_read_b64_tr_b16 v[214:215], v5 offset:12544
s_cmp_lg_u32 s4, 0
s_cbranch_scc1 L_flag_set
s_lshl_b32 s8, s6, 5
s_add_u32 s8, s8, s5
s_and_b32 s92, s8, 0xf0
s_mul_i32 s92, s92, 3
s_add_u32 s8, s8, s92
s_lshl_b32 s8, s8, 2
s_add_u32 s8, s8, 0x3704000
v_mov_b32 v21, 1
s_mov_b64 exec, 1
buffer_store_dword v21, off, s[88:91], s8 sc1
s_mov_b64 exec, -1
L_flag_set:
v_mfma_f32_16x16x32_bf16 v[24:27], v[184:187], a[64:67], 0
ds_read_b64_tr_b16 v[152:153], v4 offset:16896
s_lshl_b32 s29, s29, 11
v_mfma_f32_16x16x32_bf16 v[24:27], v[188:191], a[72:75], v[24:27]
ds_read_b64_tr_b16 v[154:155], v4 offset:20992
s_lshl_b32 s9, s100, 8
v_mfma_f32_16x16x32_bf16 v[40:43], v[188:191], a[76:79], 0
ds_read_b64_tr_b16 v[156:157], v4 offset:25088
s_add_u32 s29, s29, s9
v_mfma_f32_16x16x32_bf16 v[40:43], v[184:187], a[68:71], v[40:43]
ds_read_b64_tr_b16 v[158:159], v4 offset:29184
s_lshl_b32 s9, s14, 7
v_mfma_f32_16x16x32_bf16 v[44:47], v[192:195], a[68:71], 0
ds_read_b64_tr_b16 v[160:161], v5 offset:16896
s_add_u32 s29, s29, s9
v_mfma_f32_16x16x32_bf16 v[44:47], v[196:199], a[76:79], v[44:47]
ds_read_b64_tr_b16 v[162:163], v5 offset:20992
s_add_u32 s31, s29, 0x8000
v_mfma_f32_16x16x32_bf16 v[28:31], v[196:199], a[72:75], 0
ds_read_b64_tr_b16 v[164:165], v5 offset:25088
s_waitcnt lgkmcnt(7)
v_mfma_f32_16x16x32_bf16 v[28:31], v[192:195], a[64:67], v[28:31]
ds_read_b64_tr_b16 v[166:167], v5 offset:29184
s_lshl_b32 s28, s2, 2
v_mfma_f32_16x16x32_bf16 v[32:35], v[200:203], a[64:67], 0
ds_read_b64_tr_b16 v[168:169], v4 offset:17152
s_add_u32 s28, s28, s4
v_mfma_f32_16x16x32_bf16 v[32:35], v[204:207], a[72:75], v[32:35]
ds_read_b64_tr_b16 v[170:171], v4 offset:21248
s_lshl_b32 s28, s28, 12
v_mfma_f32_16x16x32_bf16 v[48:51], v[204:207], a[76:79], 0
ds_read_b64_tr_b16 v[172:173], v4 offset:25344
s_add_u32 s28, s28, 0x3800000
v_mfma_f32_16x16x32_bf16 v[48:51], v[200:203], a[68:71], v[48:51]
ds_read_b64_tr_b16 v[174:175], v4 offset:29440
s_xor_b32 s30, s28, 0x4000
v_mfma_f32_16x16x32_bf16 v[52:55], v[208:211], a[68:71], 0
ds_read_b64_tr_b16 v[176:177], v5 offset:17152
v_and_b32 v18, 16, v0
v_mfma_f32_16x16x32_bf16 v[52:55], v[212:215], a[76:79], v[52:55]
ds_read_b64_tr_b16 v[178:179], v5 offset:21248
s_waitcnt lgkmcnt(6)
v_mfma_f32_16x16x32_bf16 v[36:39], v[212:215], a[72:75], 0
ds_read_b64_tr_b16 v[180:181], v5 offset:25344
v_lshrrev_b32 v19, 5, v0
v_mfma_f32_16x16x32_bf16 v[36:39], v[208:211], a[64:67], v[36:39]
ds_read_b64_tr_b16 v[182:183], v5 offset:29440
v_lshlrev_b32 v19, 4, v19
v_mfma_f32_16x16x32_bf16 v[56:59], v[152:155], a[80:83], v[56:59]
ds_read_b64_tr_b16 v[184:185], v4 offset:16384
v_mov_b32 v100, 0
v_mfma_f32_16x16x32_bf16 v[56:59], v[156:159], a[88:91], v[56:59]
ds_read_b64_tr_b16 v[186:187], v4 offset:20480
v_mov_b32 v101, 0
v_mfma_f32_16x16x32_bf16 v[72:75], v[156:159], a[92:95], v[72:75]
ds_read_b64_tr_b16 v[188:189], v4 offset:24576
v_mov_b32 v102, 0
v_mfma_f32_16x16x32_bf16 v[72:75], v[152:155], a[84:87], v[72:75]
ds_read_b64_tr_b16 v[190:191], v4 offset:28672
v_mov_b32 v103, 0
v_mfma_f32_16x16x32_bf16 v[76:79], v[160:163], a[84:87], v[76:79]
ds_read_b64_tr_b16 v[192:193], v5 offset:16384
v_mov_b32 v104, 0
v_mfma_f32_16x16x32_bf16 v[76:79], v[164:167], a[92:95], v[76:79]
ds_read_b64_tr_b16 v[194:195], v5 offset:20480
v_mov_b32 v105, 0
v_mfma_f32_16x16x32_bf16 v[60:63], v[164:167], a[88:91], v[60:63]
ds_read_b64_tr_b16 v[196:197], v5 offset:24576
s_waitcnt lgkmcnt(7)
v_mfma_f32_16x16x32_bf16 v[60:63], v[160:163], a[80:83], v[60:63]
ds_read_b64_tr_b16 v[198:199], v5 offset:28672
v_mov_b32 v106, 0
v_mfma_f32_16x16x32_bf16 v[64:67], v[168:171], a[80:83], v[64:67]
ds_read_b64_tr_b16 v[200:201], v4 offset:16640
v_mov_b32 v107, 0
v_mfma_f32_16x16x32_bf16 v[64:67], v[172:175], a[88:91], v[64:67]
ds_read_b64_tr_b16 v[202:203], v4 offset:20736
v_mov_b32 v108, 0
v_mfma_f32_16x16x32_bf16 v[80:83], v[172:175], a[92:95], v[80:83]
ds_read_b64_tr_b16 v[204:205], v4 offset:24832
v_mov_b32 v109, 0
v_mfma_f32_16x16x32_bf16 v[80:83], v[168:171], a[84:87], v[80:83]
ds_read_b64_tr_b16 v[206:207], v4 offset:28928
v_lshl_add_u32 v18, v18, 1, v19
v_mfma_f32_16x16x32_bf16 v[84:87], v[176:179], a[84:87], v[84:87]
ds_read_b64_tr_b16 v[208:209], v5 offset:16640
v_lshl_add_u32 v17, v20, 9, v18
v_mfma_f32_16x16x32_bf16 v[84:87], v[180:183], a[92:95], v[84:87]
ds_read_b64_tr_b16 v[210:211], v5 offset:20736
s_waitcnt vmcnt(14) lgkmcnt(6)
v_mfma_f32_16x16x32_bf16 v[68:71], v[180:183], a[88:91], v[68:71]
ds_read_b64_tr_b16 v[212:213], v5 offset:24832
s_barrier
v_mfma_f32_16x16x32_bf16 v[68:71], v[176:179], a[80:83], v[68:71]
ds_read_b64_tr_b16 v[214:215], v5 offset:28928
v_mfma_f32_16x16x32_bf16 v[24:27], v[184:187], a[80:83], v[24:27]
ds_read_b64_tr_b16 v[152:153], v6 offset:512
ds_read_b64_tr_b16 v[154:155], v6 offset:4608
v_mfma_f32_16x16x32_bf16 v[24:27], v[188:191], a[88:91], v[24:27]
ds_read_b64_tr_b16 v[156:157], v6 offset:8704
v_add_u32 v12, 0x20000, v12
v_mfma_f32_16x16x32_bf16 v[40:43], v[188:191], a[92:95], v[40:43]
ds_read_b64_tr_b16 v[158:159], v6 offset:12800
s_add_u32 m0, s17, 0x10000
v_mfma_f32_16x16x32_bf16 v[40:43], v[184:187], a[84:87], v[40:43]
buffer_load_dwordx4 v12, s[72:75], 0 offen lds
v_mfma_f32_16x16x32_bf16 v[44:47], v[192:195], a[84:87], v[44:47]
ds_read_b64_tr_b16 v[160:161], v7 offset:512
ds_read_b64_tr_b16 v[162:163], v7 offset:4608
v_mfma_f32_16x16x32_bf16 v[44:47], v[196:199], a[92:95], v[44:47]
ds_read_b64_tr_b16 v[164:165], v7 offset:8704
v_add_u32 v13, 0x20000, v13
v_mfma_f32_16x16x32_bf16 v[28:31], v[196:199], a[88:91], v[28:31]
ds_read_b64_tr_b16 v[166:167], v7 offset:12800
s_waitcnt lgkmcnt(8)
v_mfma_f32_16x16x32_bf16 v[28:31], v[192:195], a[80:83], v[28:31]
buffer_load_dwordx4 v13, s[72:75], 0 offen offset:1024 lds
v_mfma_f32_16x16x32_bf16 v[32:35], v[200:203], a[80:83], v[32:35]
ds_read_b64_tr_b16 v[168:169], v6 offset:768
ds_read_b64_tr_b16 v[170:171], v6 offset:4864
v_mfma_f32_16x16x32_bf16 v[32:35], v[204:207], a[88:91], v[32:35]
ds_read_b64_tr_b16 v[172:173], v6 offset:8960
v_mfma_f32_16x16x32_bf16 v[48:51], v[204:207], a[92:95], v[48:51]
ds_read_b64_tr_b16 v[174:175], v6 offset:13056
v_mfma_f32_16x16x32_bf16 v[48:51], v[200:203], a[84:87], v[48:51]
buffer_load_dwordx4 v12, s[72:75], s12 offen offset:2048 lds
v_mfma_f32_16x16x32_bf16 v[52:55], v[208:211], a[84:87], v[52:55]
ds_read_b64_tr_b16 v[176:177], v7 offset:768
ds_read_b64_tr_b16 v[178:179], v7 offset:4864
v_mfma_f32_16x16x32_bf16 v[52:55], v[212:215], a[92:95], v[52:55]
ds_read_b64_tr_b16 v[180:181], v7 offset:8960
s_waitcnt lgkmcnt(7)
v_mfma_f32_16x16x32_bf16 v[36:39], v[212:215], a[88:91], v[36:39]
ds_read_b64_tr_b16 v[182:183], v7 offset:13056
v_mfma_f32_16x16x32_bf16 v[36:39], v[208:211], a[80:83], v[36:39]
buffer_load_dwordx4 v13, s[72:75], s12 offen offset:3072 lds
v_mfma_f32_16x16x32_bf16 v[56:59], v[152:155], a[96:99], v[56:59]
ds_read_b64_tr_b16 v[184:185], v6 offset:0
ds_read_b64_tr_b16 v[186:187], v6 offset:4096
v_mfma_f32_16x16x32_bf16 v[56:59], v[156:159], a[104:107], v[56:59]
ds_read_b64_tr_b16 v[188:189], v6 offset:8192
v_mov_b32 v110, 0
v_mfma_f32_16x16x32_bf16 v[72:75], v[156:159], a[108:111], v[72:75]
ds_read_b64_tr_b16 v[190:191], v6 offset:12288
s_add_u32 s101, s101, 0x2000
v_mfma_f32_16x16x32_bf16 v[72:75], v[152:155], a[100:103], v[72:75]
buffer_load_dwordx4 a[64:67], v3, s[88:91], s101 offen sc1
v_mfma_f32_16x16x32_bf16 v[76:79], v[160:163], a[100:103], v[76:79]
ds_read_b64_tr_b16 v[192:193], v7 offset:0
ds_read_b64_tr_b16 v[194:195], v7 offset:4096
v_mfma_f32_16x16x32_bf16 v[76:79], v[164:167], a[108:111], v[76:79]
ds_read_b64_tr_b16 v[196:197], v7 offset:8192
v_mov_b32 v111, 0
v_mfma_f32_16x16x32_bf16 v[60:63], v[164:167], a[104:107], v[60:63]
ds_read_b64_tr_b16 v[198:199], v7 offset:12288
s_waitcnt lgkmcnt(8)
v_mfma_f32_16x16x32_bf16 v[60:63], v[160:163], a[96:99], v[60:63]
buffer_load_dwordx4 a[68:71], v3, s[88:91], s101 offen offset:1024 sc1
v_mfma_f32_16x16x32_bf16 v[64:67], v[168:171], a[96:99], v[64:67]
ds_read_b64_tr_b16 v[200:201], v6 offset:256
ds_read_b64_tr_b16 v[202:203], v6 offset:4352
v_mfma_f32_16x16x32_bf16 v[64:67], v[172:175], a[104:107], v[64:67]
ds_read_b64_tr_b16 v[204:205], v6 offset:8448
v_mov_b32 v112, 0
v_mfma_f32_16x16x32_bf16 v[80:83], v[172:175], a[108:111], v[80:83]
ds_read_b64_tr_b16 v[206:207], v6 offset:12544
s_add_u32 s101, s101, 0x2000
v_mfma_f32_16x16x32_bf16 v[80:83], v[168:171], a[100:103], v[80:83]
buffer_load_dwordx4 a[72:75], v3, s[88:91], s101 offen sc1
v_mfma_f32_16x16x32_bf16 v[84:87], v[176:179], a[100:103], v[84:87]
ds_read_b64_tr_b16 v[208:209], v7 offset:256
ds_read_b64_tr_b16 v[210:211], v7 offset:4352
v_mfma_f32_16x16x32_bf16 v[84:87], v[180:183], a[108:111], v[84:87]
ds_read_b64_tr_b16 v[212:213], v7 offset:8448
s_waitcnt vmcnt(17) lgkmcnt(7)
v_mfma_f32_16x16x32_bf16 v[68:71], v[180:183], a[104:107], v[68:71]
ds_read_b64_tr_b16 v[214:215], v7 offset:12544
s_barrier
v_mfma_f32_16x16x32_bf16 v[68:71], v[176:179], a[96:99], v[68:71]
buffer_load_dwordx4 a[76:79], v3, s[88:91], s101 offen offset:1024 sc1
v_mfma_f32_16x16x32_bf16 v[24:27], v[184:187], a[96:99], v[24:27]
ds_read_b64_tr_b16 v[152:153], v6 offset:16896
ds_read_b64_tr_b16 v[154:155], v6 offset:20992
v_mfma_f32_16x16x32_bf16 v[24:27], v[188:191], a[104:107], v[24:27]
ds_read_b64_tr_b16 v[156:157], v6 offset:25088
v_add_u32 v12, 0x20000, v12
v_mfma_f32_16x16x32_bf16 v[40:43], v[188:191], a[108:111], v[40:43]
ds_read_b64_tr_b16 v[158:159], v6 offset:29184
s_add_u32 m0, s17, 0x14000
v_mfma_f32_16x16x32_bf16 v[40:43], v[184:187], a[100:103], v[40:43]
buffer_load_dwordx4 v12, s[72:75], 0 offen lds
v_mfma_f32_16x16x32_bf16 v[44:47], v[192:195], a[100:103], v[44:47]
ds_read_b64_tr_b16 v[160:161], v7 offset:16896
ds_read_b64_tr_b16 v[162:163], v7 offset:20992
v_mfma_f32_16x16x32_bf16 v[44:47], v[196:199], a[108:111], v[44:47]
ds_read_b64_tr_b16 v[164:165], v7 offset:25088
v_add_u32 v13, 0x20000, v13
v_mfma_f32_16x16x32_bf16 v[28:31], v[196:199], a[104:107], v[28:31]
ds_read_b64_tr_b16 v[166:167], v7 offset:29184
s_waitcnt lgkmcnt(8)
v_mfma_f32_16x16x32_bf16 v[28:31], v[192:195], a[96:99], v[28:31]
buffer_load_dwordx4 v13, s[72:75], 0 offen offset:1024 lds
v_mfma_f32_16x16x32_bf16 v[32:35], v[200:203], a[96:99], v[32:35]
ds_read_b64_tr_b16 v[168:169], v6 offset:17152
ds_read_b64_tr_b16 v[170:171], v6 offset:21248
v_mfma_f32_16x16x32_bf16 v[32:35], v[204:207], a[104:107], v[32:35]
ds_read_b64_tr_b16 v[172:173], v6 offset:25344
v_mfma_f32_16x16x32_bf16 v[48:51], v[204:207], a[108:111], v[48:51]
ds_read_b64_tr_b16 v[174:175], v6 offset:29440
v_mfma_f32_16x16x32_bf16 v[48:51], v[200:203], a[100:103], v[48:51]
buffer_load_dwordx4 v12, s[72:75], s12 offen offset:2048 lds
v_mfma_f32_16x16x32_bf16 v[52:55], v[208:211], a[100:103], v[52:55]
ds_read_b64_tr_b16 v[176:177], v7 offset:17152
ds_read_b64_tr_b16 v[178:179], v7 offset:21248
v_mfma_f32_16x16x32_bf16 v[52:55], v[212:215], a[108:111], v[52:55]
ds_read_b64_tr_b16 v[180:181], v7 offset:25344
s_waitcnt lgkmcnt(7)
v_mfma_f32_16x16x32_bf16 v[36:39], v[212:215], a[104:107], v[36:39]
ds_read_b64_tr_b16 v[182:183], v7 offset:29440
v_mfma_f32_16x16x32_bf16 v[36:39], v[208:211], a[96:99], v[36:39]
buffer_load_dwordx4 v13, s[72:75], s12 offen offset:3072 lds
v_mfma_f32_16x16x32_bf16 v[56:59], v[152:155], a[112:115], v[56:59]
ds_read_b64_tr_b16 v[184:185], v6 offset:16384
ds_read_b64_tr_b16 v[186:187], v6 offset:20480
v_mfma_f32_16x16x32_bf16 v[56:59], v[156:159], a[120:123], v[56:59]
ds_read_b64_tr_b16 v[188:189], v6 offset:24576
v_mov_b32 v113, 0
v_mfma_f32_16x16x32_bf16 v[72:75], v[156:159], a[124:127], v[72:75]
ds_read_b64_tr_b16 v[190:191], v6 offset:28672
s_add_u32 s101, s101, 0x2000
v_mfma_f32_16x16x32_bf16 v[72:75], v[152:155], a[116:119], v[72:75]
buffer_load_dwordx4 a[80:83], v3, s[88:91], s101 offen sc1
v_mfma_f32_16x16x32_bf16 v[76:79], v[160:163], a[116:119], v[76:79]
ds_read_b64_tr_b16 v[192:193], v7 offset:16384
ds_read_b64_tr_b16 v[194:195], v7 offset:20480
v_mfma_f32_16x16x32_bf16 v[76:79], v[164:167], a[124:127], v[76:79]
ds_read_b64_tr_b16 v[196:197], v7 offset:24576
v_mov_b32 v114, 0
v_mfma_f32_16x16x32_bf16 v[60:63], v[164:167], a[120:123], v[60:63]
ds_read_b64_tr_b16 v[198:199], v7 offset:28672
s_waitcnt lgkmcnt(8)
v_mfma_f32_16x16x32_bf16 v[60:63], v[160:163], a[112:115], v[60:63]
buffer_load_dwordx4 a[84:87], v3, s[88:91], s101 offen offset:1024 sc1
v_mfma_f32_16x16x32_bf16 v[64:67], v[168:171], a[112:115], v[64:67]
ds_read_b64_tr_b16 v[200:201], v6 offset:16640
ds_read_b64_tr_b16 v[202:203], v6 offset:20736
v_mfma_f32_16x16x32_bf16 v[64:67], v[172:175], a[120:123], v[64:67]
ds_read_b64_tr_b16 v[204:205], v6 offset:24832
v_mov_b32 v115, 0
v_mfma_f32_16x16x32_bf16 v[80:83], v[172:175], a[124:127], v[80:83]
ds_read_b64_tr_b16 v[206:207], v6 offset:28928
s_add_u32 s101, s101, 0x2000
v_mfma_f32_16x16x32_bf16 v[80:83], v[168:171], a[116:119], v[80:83]
buffer_load_dwordx4 a[88:91], v3, s[88:91], s101 offen sc1
v_mfma_f32_16x16x32_bf16 v[84:87], v[176:179], a[116:119], v[84:87]
ds_read_b64_tr_b16 v[208:209], v7 offset:16640
ds_read_b64_tr_b16 v[210:211], v7 offset:20736
v_mfma_f32_16x16x32_bf16 v[84:87], v[180:183], a[124:127], v[84:87]
ds_read_b64_tr_b16 v[212:213], v7 offset:24832
s_waitcnt vmcnt(7) lgkmcnt(7)
v_mfma_f32_16x16x32_bf16 v[68:71], v[180:183], a[120:123], v[68:71]
ds_read_b64_tr_b16 v[214:215], v7 offset:28928
s_barrier
v_mfma_f32_16x16x32_bf16 v[68:71], v[176:179], a[112:115], v[68:71]
buffer_load_dwordx4 a[92:95], v3, s[88:91], s101 offen offset:1024 sc1
v_mfma_f32_16x16x32_bf16 v[24:27], v[184:187], a[112:115], v[24:27]
ds_read_b64_tr_b16 v[152:153], v4 offset:512
ds_read_b64_tr_b16 v[154:155], v4 offset:4608
v_mfma_f32_16x16x32_bf16 v[24:27], v[188:191], a[120:123], v[24:27]
ds_read_b64_tr_b16 v[156:157], v4 offset:8704
v_add_u32 v12, 0x20000, v12
v_mfma_f32_16x16x32_bf16 v[40:43], v[188:191], a[124:127], v[40:43]
ds_read_b64_tr_b16 v[158:159], v4 offset:12800
s_add_u32 m0, s16, 0x0
v_mfma_f32_16x16x32_bf16 v[40:43], v[184:187], a[116:119], v[40:43]
buffer_load_dwordx4 v12, s[72:75], 0 offen lds
v_mfma_f32_16x16x32_bf16 v[44:47], v[192:195], a[116:119], v[44:47]
ds_read_b64_tr_b16 v[160:161], v5 offset:512
ds_read_b64_tr_b16 v[162:163], v5 offset:4608
v_mfma_f32_16x16x32_bf16 v[44:47], v[196:199], a[124:127], v[44:47]
ds_read_b64_tr_b16 v[164:165], v5 offset:8704
v_add_u32 v13, 0x20000, v13
v_mfma_f32_16x16x32_bf16 v[28:31], v[196:199], a[120:123], v[28:31]
ds_read_b64_tr_b16 v[166:167], v5 offset:12800
s_waitcnt lgkmcnt(8)
v_mfma_f32_16x16x32_bf16 v[28:31], v[192:195], a[112:115], v[28:31]
buffer_load_dwordx4 v13, s[72:75], 0 offen offset:1024 lds
v_mfma_f32_16x16x32_bf16 v[32:35], v[200:203], a[112:115], v[32:35]
ds_read_b64_tr_b16 v[168:169], v4 offset:768
ds_read_b64_tr_b16 v[170:171], v4 offset:4864
v_mfma_f32_16x16x32_bf16 v[32:35], v[204:207], a[120:123], v[32:35]
ds_read_b64_tr_b16 v[172:173], v4 offset:8960
v_mfma_f32_16x16x32_bf16 v[48:51], v[204:207], a[124:127], v[48:51]
ds_read_b64_tr_b16 v[174:175], v4 offset:13056
v_mfma_f32_16x16x32_bf16 v[48:51], v[200:203], a[116:119], v[48:51]
buffer_load_dwordx4 v12, s[72:75], s12 offen offset:2048 lds
v_mfma_f32_16x16x32_bf16 v[52:55], v[208:211], a[116:119], v[52:55]
ds_read_b64_tr_b16 v[176:177], v5 offset:768
ds_read_b64_tr_b16 v[178:179], v5 offset:4864
v_mfma_f32_16x16x32_bf16 v[52:55], v[212:215], a[124:127], v[52:55]
ds_read_b64_tr_b16 v[180:181], v5 offset:8960
s_waitcnt lgkmcnt(7)
v_mfma_f32_16x16x32_bf16 v[36:39], v[212:215], a[120:123], v[36:39]
ds_read_b64_tr_b16 v[182:183], v5 offset:13056
v_mfma_f32_16x16x32_bf16 v[36:39], v[208:211], a[112:115], v[36:39]
buffer_load_dwordx4 v13, s[72:75], s12 offen offset:3072 lds
v_mfma_f32_16x16x32_bf16 v[56:59], v[152:155], a[64:67], v[56:59]
ds_read_b64_tr_b16 v[184:185], v4 offset:0
ds_read_b64_tr_b16 v[186:187], v4 offset:4096
v_mfma_f32_16x16x32_bf16 v[56:59], v[156:159], a[72:75], v[56:59]
ds_read_b64_tr_b16 v[188:189], v4 offset:8192
v_mov_b32 v116, 0
v_mfma_f32_16x16x32_bf16 v[72:75], v[156:159], a[76:79], v[72:75]
ds_read_b64_tr_b16 v[190:191], v4 offset:12288
s_add_u32 s101, s101, 0x2000
v_mfma_f32_16x16x32_bf16 v[72:75], v[152:155], a[68:71], v[72:75]
buffer_load_dwordx4 a[96:99], v3, s[88:91], s101 offen sc1
v_mfma_f32_16x16x32_bf16 v[76:79], v[160:163], a[68:71], v[76:79]
ds_read_b64_tr_b16 v[192:193], v5 offset:0
ds_read_b64_tr_b16 v[194:195], v5 offset:4096
v_mfma_f32_16x16x32_bf16 v[76:79], v[164:167], a[76:79], v[76:79]
ds_read_b64_tr_b16 v[196:197], v5 offset:8192
v_mov_b32 v117, 0
v_mfma_f32_16x16x32_bf16 v[60:63], v[164:167], a[72:75], v[60:63]
ds_read_b64_tr_b16 v[198:199], v5 offset:12288
s_waitcnt lgkmcnt(8)
v_mfma_f32_16x16x32_bf16 v[60:63], v[160:163], a[64:67], v[60:63]
buffer_load_dwordx4 a[100:103], v3, s[88:91], s101 offen offset:1024 sc1
v_mfma_f32_16x16x32_bf16 v[64:67], v[168:171], a[64:67], v[64:67]
ds_read_b64_tr_b16 v[200:201], v4 offset:256
ds_read_b64_tr_b16 v[202:203], v4 offset:4352
v_mfma_f32_16x16x32_bf16 v[64:67], v[172:175], a[72:75], v[64:67]
ds_read_b64_tr_b16 v[204:205], v4 offset:8448
v_mfma_f32_16x16x32_bf16 v[80:83], v[172:175], a[76:79], v[80:83]
ds_read_b64_tr_b16 v[206:207], v4 offset:12544
s_add_u32 s101, s101, 0x2000
v_mfma_f32_16x16x32_bf16 v[80:83], v[168:171], a[68:71], v[80:83]
buffer_load_dwordx4 a[104:107], v3, s[88:91], s101 offen sc1
v_mfma_f32_16x16x32_bf16 v[84:87], v[176:179], a[68:71], v[84:87]
ds_read_b64_tr_b16 v[208:209], v5 offset:256
ds_read_b64_tr_b16 v[210:211], v5 offset:4352
v_mfma_f32_16x16x32_bf16 v[84:87], v[180:183], a[76:79], v[84:87]
ds_read_b64_tr_b16 v[212:213], v5 offset:8448
s_waitcnt vmcnt(7) lgkmcnt(7)
v_mfma_f32_16x16x32_bf16 v[68:71], v[180:183], a[72:75], v[68:71]
ds_read_b64_tr_b16 v[214:215], v5 offset:12544
s_barrier
v_mfma_f32_16x16x32_bf16 v[68:71], v[176:179], a[64:67], v[68:71]
buffer_load_dwordx4 a[108:111], v3, s[88:91], s101 offen offset:1024 sc1
buffer_load_dword v14, v20, s[88:91], s24 offen sc1
v_mfma_f32_16x16x32_bf16 v[24:27], v[184:187], a[64:67], v[24:27]
ds_read_b64_tr_b16 v[152:153], v4 offset:16896
ds_read_b64_tr_b16 v[154:155], v4 offset:20992
v_mfma_f32_16x16x32_bf16 v[24:27], v[188:191], a[72:75], v[24:27]
ds_read_b64_tr_b16 v[156:157], v4 offset:25088
v_add_u32 v12, 0x20000, v12
v_mfma_f32_16x16x32_bf16 v[40:43], v[188:191], a[76:79], v[40:43]
ds_read_b64_tr_b16 v[158:159], v4 offset:29184
s_add_u32 m0, s16, 0x4000
v_mfma_f32_16x16x32_bf16 v[40:43], v[184:187], a[68:71], v[40:43]
buffer_load_dwordx4 v12, s[72:75], 0 offen lds
v_mfma_f32_16x16x32_bf16 v[44:47], v[192:195], a[68:71], v[44:47]
ds_read_b64_tr_b16 v[160:161], v5 offset:16896
ds_read_b64_tr_b16 v[162:163], v5 offset:20992
v_mfma_f32_16x16x32_bf16 v[44:47], v[196:199], a[76:79], v[44:47]
ds_read_b64_tr_b16 v[164:165], v5 offset:25088
v_add_u32 v13, 0x20000, v13
v_mfma_f32_16x16x32_bf16 v[28:31], v[196:199], a[72:75], v[28:31]
ds_read_b64_tr_b16 v[166:167], v5 offset:29184
s_waitcnt lgkmcnt(8)
v_mfma_f32_16x16x32_bf16 v[28:31], v[192:195], a[64:67], v[28:31]
buffer_load_dwordx4 v13, s[72:75], 0 offen offset:1024 lds
v_mfma_f32_16x16x32_bf16 v[32:35], v[200:203], a[64:67], v[32:35]
ds_read_b64_tr_b16 v[168:169], v4 offset:17152
ds_read_b64_tr_b16 v[170:171], v4 offset:21248
v_mfma_f32_16x16x32_bf16 v[32:35], v[204:207], a[72:75], v[32:35]
ds_read_b64_tr_b16 v[172:173], v4 offset:25344
v_mfma_f32_16x16x32_bf16 v[48:51], v[204:207], a[76:79], v[48:51]
ds_read_b64_tr_b16 v[174:175], v4 offset:29440
v_mfma_f32_16x16x32_bf16 v[48:51], v[200:203], a[68:71], v[48:51]
buffer_load_dwordx4 v12, s[72:75], s12 offen offset:2048 lds
v_mfma_f32_16x16x32_bf16 v[52:55], v[208:211], a[68:71], v[52:55]
ds_read_b64_tr_b16 v[176:177], v5 offset:17152
ds_read_b64_tr_b16 v[178:179], v5 offset:21248
v_mfma_f32_16x16x32_bf16 v[52:55], v[212:215], a[76:79], v[52:55]
ds_read_b64_tr_b16 v[180:181], v5 offset:25344
s_waitcnt lgkmcnt(7)
v_mfma_f32_16x16x32_bf16 v[36:39], v[212:215], a[72:75], v[36:39]
ds_read_b64_tr_b16 v[182:183], v5 offset:29440
v_mfma_f32_16x16x32_bf16 v[36:39], v[208:211], a[64:67], v[36:39]
buffer_load_dwordx4 v13, s[72:75], s12 offen offset:3072 lds
v_mfma_f32_16x16x32_bf16 v[56:59], v[152:155], a[80:83], v[56:59]
ds_read_b64_tr_b16 v[184:185], v4 offset:16384
ds_read_b64_tr_b16 v[186:187], v4 offset:20480
v_mfma_f32_16x16x32_bf16 v[56:59], v[156:159], a[88:91], v[56:59]
ds_read_b64_tr_b16 v[188:189], v4 offset:24576
v_mov_b32 v118, 0
v_mfma_f32_16x16x32_bf16 v[72:75], v[156:159], a[92:95], v[72:75]
ds_read_b64_tr_b16 v[190:191], v4 offset:28672
s_add_u32 s101, s101, 0x2000
v_mfma_f32_16x16x32_bf16 v[72:75], v[152:155], a[84:87], v[72:75]
buffer_load_dwordx4 a[112:115], v3, s[88:91], s101 offen sc1
v_mfma_f32_16x16x32_bf16 v[76:79], v[160:163], a[84:87], v[76:79]
ds_read_b64_tr_b16 v[192:193], v5 offset:16384
ds_read_b64_tr_b16 v[194:195], v5 offset:20480
v_mfma_f32_16x16x32_bf16 v[76:79], v[164:167], a[92:95], v[76:79]
ds_read_b64_tr_b16 v[196:197], v5 offset:24576
v_mov_b32 v119, 0
v_mfma_f32_16x16x32_bf16 v[60:63], v[164:167], a[88:91], v[60:63]
ds_read_b64_tr_b16 v[198:199], v5 offset:28672
s_waitcnt lgkmcnt(8)
v_mfma_f32_16x16x32_bf16 v[60:63], v[160:163], a[80:83], v[60:63]
buffer_load_dwordx4 a[116:119], v3, s[88:91], s101 offen offset:1024 sc1
v_mfma_f32_16x16x32_bf16 v[64:67], v[168:171], a[80:83], v[64:67]
ds_read_b64_tr_b16 v[200:201], v4 offset:16640
ds_read_b64_tr_b16 v[202:203], v4 offset:20736
v_mfma_f32_16x16x32_bf16 v[64:67], v[172:175], a[88:91], v[64:67]
ds_read_b64_tr_b16 v[204:205], v4 offset:24832
v_mfma_f32_16x16x32_bf16 v[80:83], v[172:175], a[92:95], v[80:83]
ds_read_b64_tr_b16 v[206:207], v4 offset:28928
s_add_u32 s101, s101, 0x2000
v_mfma_f32_16x16x32_bf16 v[80:83], v[168:171], a[84:87], v[80:83]
buffer_load_dwordx4 a[120:123], v3, s[88:91], s101 offen sc1
v_mfma_f32_16x16x32_bf16 v[84:87], v[176:179], a[84:87], v[84:87]
ds_read_b64_tr_b16 v[208:209], v5 offset:16640
ds_read_b64_tr_b16 v[210:211], v5 offset:20736
v_mfma_f32_16x16x32_bf16 v[84:87], v[180:183], a[92:95], v[84:87]
ds_read_b64_tr_b16 v[212:213], v5 offset:24832
s_waitcnt vmcnt(7) lgkmcnt(7)
v_mfma_f32_16x16x32_bf16 v[68:71], v[180:183], a[88:91], v[68:71]
ds_read_b64_tr_b16 v[214:215], v5 offset:28928
s_barrier
v_mfma_f32_16x16x32_bf16 v[68:71], v[176:179], a[80:83], v[68:71]
buffer_load_dwordx4 a[124:127], v3, s[88:91], s101 offen offset:1024 sc1
s_mov_b32 s92, 200000
L_spin_c:
v_cmp_ne_u32 vcc, 1, v14
s_nop 4
s_cbranch_vccz L_spun_c
s_sub_u32 s92, s92, 1
s_cbranch_scc1 L_spun_c
s_sleep 6
buffer_load_dword v14, v20, s[88:91], s24 offen sc1
s_waitcnt vmcnt(0)
s_branch L_spin_c
L_spun_c:
v_mfma_f32_16x16x32_bf16 v[24:27], v[184:187], a[80:83], v[24:27]
ds_read_b64_tr_b16 v[152:153], v6 offset:512
ds_read_b64_tr_b16 v[154:155], v6 offset:4608
v_mfma_f32_16x16x32_bf16 v[24:27], v[188:191], a[88:91], v[24:27]
ds_read_b64_tr_b16 v[156:157], v6 offset:8704
v_add_u32 v12, s25, v12
v_mfma_f32_16x16x32_bf16 v[40:43], v[188:191], a[92:95], v[40:43]
ds_read_b64_tr_b16 v[158:159], v6 offset:12800
s_add_u32 m0, s17, 0x10000
v_mfma_f32_16x16x32_bf16 v[40:43], v[184:187], a[84:87], v[40:43]
buffer_load_dwordx4 v12, s[64:67], s61 offen lds
v_mfma_f32_16x16x32_bf16 v[44:47], v[192:195], a[84:87], v[44:47]
ds_read_b64_tr_b16 v[160:161], v7 offset:512
ds_read_b64_tr_b16 v[162:163], v7 offset:4608
v_mfma_f32_16x16x32_bf16 v[44:47], v[196:199], a[92:95], v[44:47]
ds_read_b64_tr_b16 v[164:165], v7 offset:8704
v_add_u32 v13, s25, v13
v_mfma_f32_16x16x32_bf16 v[28:31], v[196:199], a[88:91], v[28:31]
ds_read_b64_tr_b16 v[166:167], v7 offset:12800
s_waitcnt lgkmcnt(8)
v_mfma_f32_16x16x32_bf16 v[28:31], v[192:195], a[80:83], v[28:31]
buffer_load_dwordx4 v13, s[64:67], s61 offen offset:1024 lds
v_mfma_f32_16x16x32_bf16 v[32:35], v[200:203], a[80:83], v[32:35]
ds_read_b64_tr_b16 v[168:169], v6 offset:768
ds_read_b64_tr_b16 v[170:171], v6 offset:4864
v_mfma_f32_16x16x32_bf16 v[32:35], v[204:207], a[88:91], v[32:35]
ds_read_b64_tr_b16 v[172:173], v6 offset:8960
s_add_u32 s63, s101, s26
v_mfma_f32_16x16x32_bf16 v[48:51], v[204:207], a[92:95], v[48:51]
ds_read_b64_tr_b16 v[174:175], v6 offset:13056
s_add_u32 s101, s63, s60
v_mfma_f32_16x16x32_bf16 v[48:51], v[200:203], a[84:87], v[48:51]
buffer_load_dwordx4 v12, s[64:67], s62 offen offset:2048 lds
v_mfma_f32_16x16x32_bf16 v[52:55], v[208:211], a[84:87], v[52:55]
ds_read_b64_tr_b16 v[176:177], v7 offset:768
ds_read_b64_tr_b16 v[178:179], v7 offset:4864
v_mfma_f32_16x16x32_bf16 v[52:55], v[212:215], a[92:95], v[52:55]
ds_read_b64_tr_b16 v[180:181], v7 offset:8960
s_waitcnt lgkmcnt(7)
v_mfma_f32_16x16x32_bf16 v[36:39], v[212:215], a[88:91], v[36:39]
ds_read_b64_tr_b16 v[182:183], v7 offset:13056
v_mfma_f32_16x16x32_bf16 v[36:39], v[208:211], a[80:83], v[36:39]
buffer_load_dwordx4 v13, s[64:67], s62 offen offset:3072 lds
v_mfma_f32_16x16x32_bf16 v[56:59], v[152:155], a[96:99], v[56:59]
ds_read_b64_tr_b16 v[184:185], v6 offset:0
ds_read_b64_tr_b16 v[186:187], v6 offset:4096
v_mfma_f32_16x16x32_bf16 v[56:59], v[156:159], a[104:107], v[56:59]
ds_read_b64_tr_b16 v[188:189], v6 offset:8192
s_add_u32 s60, s60, s57
v_mfma_f32_16x16x32_bf16 v[72:75], v[156:159], a[108:111], v[72:75]
ds_read_b64_tr_b16 v[190:191], v6 offset:12288
s_and_b32 s60, s60, 0x7c000
v_mfma_f32_16x16x32_bf16 v[72:75], v[152:155], a[100:103], v[72:75]
buffer_load_dwordx4 a[64:67], v3, s[88:91], s101 offen sc1
v_mfma_f32_16x16x32_bf16 v[76:79], v[160:163], a[100:103], v[76:79]
ds_read_b64_tr_b16 v[192:193], v7 offset:0
ds_read_b64_tr_b16 v[194:195], v7 offset:4096
v_mfma_f32_16x16x32_bf16 v[76:79], v[164:167], a[108:111], v[76:79]
ds_read_b64_tr_b16 v[196:197], v7 offset:8192
s_lshl_b32 s61, s60, 3
v_mfma_f32_16x16x32_bf16 v[60:63], v[164:167], a[104:107], v[60:63]
ds_read_b64_tr_b16 v[198:199], v7 offset:12288
s_waitcnt lgkmcnt(8)
v_mfma_f32_16x16x32_bf16 v[60:63], v[160:163], a[96:99], v[60:63]
buffer_load_dwordx4 a[68:71], v3, s[88:91], s101 offen offset:1024 sc1
v_mfma_f32_16x16x32_bf16 v[64:67], v[168:171], a[96:99], v[64:67]
ds_read_b64_tr_b16 v[200:201], v6 offset:256
ds_read_b64_tr_b16 v[202:203], v6 offset:4352
v_mfma_f32_16x16x32_bf16 v[64:67], v[172:175], a[104:107], v[64:67]
ds_read_b64_tr_b16 v[204:205], v6 offset:8448
s_add_u32 s62, s61, s12
v_mfma_f32_16x16x32_bf16 v[80:83], v[172:175], a[108:111], v[80:83]
ds_read_b64_tr_b16 v[206:207], v6 offset:12544
s_add_u32 s101, s101, 0x2000
v_mfma_f32_16x16x32_bf16 v[80:83], v[168:171], a[100:103], v[80:83]
buffer_load_dwordx4 a[72:75], v3, s[88:91], s101 offen sc1
v_mfma_f32_16x16x32_bf16 v[84:87], v[176:179], a[100:103], v[84:87]
ds_read_b64_tr_b16 v[208:209], v7 offset:256
ds_read_b64_tr_b16 v[210:211], v7 offset:4352
v_mfma_f32_16x16x32_bf16 v[84:87], v[180:183], a[108:111], v[84:87]
ds_read_b64_tr_b16 v[212:213], v7 offset:8448
s_waitcnt vmcnt(7) lgkmcnt(7)
v_mfma_f32_16x16x32_bf16 v[68:71], v[180:183], a[104:107], v[68:71]
ds_read_b64_tr_b16 v[214:215], v7 offset:12544
s_barrier
v_mfma_f32_16x16x32_bf16 v[68:71], v[176:179], a[96:99], v[68:71]
buffer_load_dwordx4 a[76:79], v3, s[88:91], s101 offen offset:1024 sc1
v_mfma_f32_16x16x32_bf16 v[24:27], v[184:187], a[96:99], v[24:27]
ds_read_b64_tr_b16 v[152:153], v6 offset:16896
ds_read_b64_tr_b16 v[154:155], v6 offset:20992
v_mfma_f32_16x16x32_bf16 v[24:27], v[188:191], a[104:107], v[24:27]
ds_read_b64_tr_b16 v[156:157], v6 offset:25088
s_add_u32 s101, s63, s60
v_mfma_f32_16x16x32_bf16 v[40:43], v[188:191], a[108:111], v[40:43]
ds_read_b64_tr_b16 v[158:159], v6 offset:29184
s_add_u32 m0, s17, 0x14000
v_mfma_f32_16x16x32_bf16 v[40:43], v[184:187], a[100:103], v[40:43]
buffer_load_dwordx4 v12, s[64:67], s61 offen lds
v_mfma_f32_16x16x32_bf16 v[44:47], v[192:195], a[100:103], v[44:47]
ds_read_b64_tr_b16 v[160:161], v7 offset:16896
ds_read_b64_tr_b16 v[162:163], v7 offset:20992
v_mfma_f32_16x16x32_bf16 v[44:47], v[196:199], a[108:111], v[44:47]
ds_read_b64_tr_b16 v[164:165], v7 offset:25088
v_mfma_f32_16x16x32_bf16 v[28:31], v[196:199], a[104:107], v[28:31]
ds_read_b64_tr_b16 v[166:167], v7 offset:29184
s_waitcnt lgkmcnt(8)
v_mfma_f32_16x16x32_bf16 v[28:31], v[192:195], a[96:99], v[28:31]
buffer_load_dwordx4 v13, s[64:67], s61 offen offset:1024 lds
v_mfma_f32_16x16x32_bf16 v[32:35], v[200:203], a[96:99], v[32:35]
ds_read_b64_tr_b16 v[168:169], v6 offset:17152
ds_read_b64_tr_b16 v[170:171], v6 offset:21248
v_mfma_f32_16x16x32_bf16 v[32:35], v[204:207], a[104:107], v[32:35]
ds_read_b64_tr_b16 v[172:173], v6 offset:25344
v_mfma_f32_16x16x32_bf16 v[48:51], v[204:207], a[108:111], v[48:51]
ds_read_b64_tr_b16 v[174:175], v6 offset:29440
v_mfma_f32_16x16x32_bf16 v[48:51], v[200:203], a[100:103], v[48:51]
buffer_load_dwordx4 v12, s[64:67], s62 offen offset:2048 lds
v_mfma_f32_16x16x32_bf16 v[52:55], v[208:211], a[100:103], v[52:55]
ds_read_b64_tr_b16 v[176:177], v7 offset:17152
ds_read_b64_tr_b16 v[178:179], v7 offset:21248
v_mfma_f32_16x16x32_bf16 v[52:55], v[212:215], a[108:111], v[52:55]
ds_read_b64_tr_b16 v[180:181], v7 offset:25344
s_waitcnt lgkmcnt(7)
v_mfma_f32_16x16x32_bf16 v[36:39], v[212:215], a[104:107], v[36:39]
ds_read_b64_tr_b16 v[182:183], v7 offset:29440
v_mfma_f32_16x16x32_bf16 v[36:39], v[208:211], a[96:99], v[36:39]
buffer_load_dwordx4 v13, s[64:67], s62 offen offset:3072 lds
v_mfma_f32_16x16x32_bf16 v[56:59], v[152:155], a[112:115], v[56:59]
ds_read_b64_tr_b16 v[184:185], v6 offset:16384
ds_read_b64_tr_b16 v[186:187], v6 offset:20480
v_mfma_f32_16x16x32_bf16 v[56:59], v[156:159], a[120:123], v[56:59]
ds_read_b64_tr_b16 v[188:189], v6 offset:24576
s_add_u32 s60, s60, s58
v_mfma_f32_16x16x32_bf16 v[72:75], v[156:159], a[124:127], v[72:75]
ds_read_b64_tr_b16 v[190:191], v6 offset:28672
s_and_b32 s60, s60, 0x7c000
v_mfma_f32_16x16x32_bf16 v[72:75], v[152:155], a[116:119], v[72:75]
buffer_load_dwordx4 a[80:83], v3, s[88:91], s101 offen sc1
v_mfma_f32_16x16x32_bf16 v[76:79], v[160:163], a[116:119], v[76:79]
ds_read_b64_tr_b16 v[192:193], v7 offset:16384
ds_read_b64_tr_b16 v[194:195], v7 offset:20480
v_mfma_f32_16x16x32_bf16 v[76:79], v[164:167], a[124:127], v[76:79]
ds_read_b64_tr_b16 v[196:197], v7 offset:24576
s_lshl_b32 s61, s60, 3
v_mfma_f32_16x16x32_bf16 v[60:63], v[164:167], a[120:123], v[60:63]
ds_read_b64_tr_b16 v[198:199], v7 offset:28672
s_waitcnt lgkmcnt(8)
v_mfma_f32_16x16x32_bf16 v[60:63], v[160:163], a[112:115], v[60:63]
buffer_load_dwordx4 a[84:87], v3, s[88:91], s101 offen offset:1024 sc1
v_mfma_f32_16x16x32_bf16 v[64:67], v[168:171], a[112:115], v[64:67]
ds_read_b64_tr_b16 v[200:201], v6 offset:16640
ds_read_b64_tr_b16 v[202:203], v6 offset:20736
v_mfma_f32_16x16x32_bf16 v[64:67], v[172:175], a[120:123], v[64:67]
ds_read_b64_tr_b16 v[204:205], v6 offset:24832
s_add_u32 s62, s61, s12
v_mfma_f32_16x16x32_bf16 v[80:83], v[172:175], a[124:127], v[80:83]
ds_read_b64_tr_b16 v[206:207], v6 offset:28928
s_add_u32 s101, s101, 0x2000
v_mfma_f32_16x16x32_bf16 v[80:83], v[168:171], a[116:119], v[80:83]
buffer_load_dwordx4 a[88:91], v3, s[88:91], s101 offen sc1
v_mfma_f32_16x16x32_bf16 v[84:87], v[176:179], a[116:119], v[84:87]
ds_read_b64_tr_b16 v[208:209], v7 offset:16640
ds_read_b64_tr_b16 v[210:211], v7 offset:20736
v_mfma_f32_16x16x32_bf16 v[84:87], v[180:183], a[124:127], v[84:87]
ds_read_b64_tr_b16 v[212:213], v7 offset:24832
s_waitcnt vmcnt(7) lgkmcnt(7)
v_mfma_f32_16x16x32_bf16 v[68:71], v[180:183], a[120:123], v[68:71]
ds_read_b64_tr_b16 v[214:215], v7 offset:28928
s_barrier
v_mfma_f32_16x16x32_bf16 v[68:71], v[176:179], a[112:115], v[68:71]
buffer_load_dwordx4 a[92:95], v3, s[88:91], s101 offen offset:1024 sc1
v_mfma_f32_16x16x32_bf16 v[24:27], v[184:187], a[112:115], v[24:27]
ds_read_b64_tr_b16 v[152:153], v4 offset:512
ds_read_b64_tr_b16 v[154:155], v4 offset:4608
v_mfma_f32_16x16x32_bf16 v[24:27], v[188:191], a[120:123], v[24:27]
ds_read_b64_tr_b16 v[156:157], v4 offset:8704
s_add_u32 s101, s63, s60
v_mfma_f32_16x16x32_bf16 v[40:43], v[188:191], a[124:127], v[40:43]
ds_read_b64_tr_b16 v[158:159], v4 offset:12800
s_add_u32 m0, s16, 0x0
v_mfma_f32_16x16x32_bf16 v[40:43], v[184:187], a[116:119], v[40:43]
buffer_load_dwordx4 v12, s[64:67], s61 offen lds
v_mfma_f32_16x16x32_bf16 v[44:47], v[192:195], a[116:119], v[44:47]
ds_read_b64_tr_b16 v[160:161], v5 offset:512
ds_read_b64_tr_b16 v[162:163], v5 offset:4608
v_mfma_f32_16x16x32_bf16 v[44:47], v[196:199], a[124:127], v[44:47]
ds_read_b64_tr_b16 v[164:165], v5 offset:8704
v_mfma_f32_16x16x32_bf16 v[28:31], v[196:199], a[120:123], v[28:31]
ds_read_b64_tr_b16 v[166:167], v5 offset:12800
s_waitcnt lgkmcnt(8)
v_mfma_f32_16x16x32_bf16 v[28:31], v[192:195], a[112:115], v[28:31]
buffer_load_dwordx4 v13, s[64:67], s61 offen offset:1024 lds
v_mfma_f32_16x16x32_bf16 v[32:35], v[200:203], a[112:115], v[32:35]
ds_read_b64_tr_b16 v[168:169], v4 offset:768
ds_read_b64_tr_b16 v[170:171], v4 offset:4864
v_mfma_f32_16x16x32_bf16 v[32:35], v[204:207], a[120:123], v[32:35]
ds_read_b64_tr_b16 v[172:173], v4 offset:8960
v_mfma_f32_16x16x32_bf16 v[48:51], v[204:207], a[124:127], v[48:51]
ds_read_b64_tr_b16 v[174:175], v4 offset:13056
v_mfma_f32_16x16x32_bf16 v[48:51], v[200:203], a[116:119], v[48:51]
buffer_load_dwordx4 v12, s[64:67], s62 offen offset:2048 lds
v_mfma_f32_16x16x32_bf16 v[52:55], v[208:211], a[116:119], v[52:55]
ds_read_b64_tr_b16 v[176:177], v5 offset:768
ds_read_b64_tr_b16 v[178:179], v5 offset:4864
v_mfma_f32_16x16x32_bf16 v[52:55], v[212:215], a[124:127], v[52:55]
ds_read_b64_tr_b16 v[180:181], v5 offset:8960
s_waitcnt lgkmcnt(7)
v_mfma_f32_16x16x32_bf16 v[36:39], v[212:215], a[120:123], v[36:39]
ds_read_b64_tr_b16 v[182:183], v5 offset:13056
v_mfma_f32_16x16x32_bf16 v[36:39], v[208:211], a[112:115], v[36:39]
buffer_load_dwordx4 v13, s[64:67], s62 offen offset:3072 lds
v_mfma_f32_16x16x32_bf16 v[120:123], v[152:155], a[64:67], 0
ds_read_b64_tr_b16 v[184:185], v4 offset:0
ds_read_b64_tr_b16 v[186:187], v4 offset:4096
v_mfma_f32_16x16x32_bf16 v[120:123], v[156:159], a[72:75], v[120:123]
ds_read_b64_tr_b16 v[188:189], v4 offset:8192
s_add_u32 s60, s60, s59
v_mfma_f32_16x16x32_bf16 v[136:139], v[156:159], a[76:79], 0
ds_read_b64_tr_b16 v[190:191], v4 offset:12288
s_and_b32 s60, s60, 0x7c000
v_mfma_f32_16x16x32_bf16 v[136:139], v[152:155], a[68:71], v[136:139]
buffer_load_dwordx4 a[96:99], v3, s[88:91], s101 offen sc1
v_mfma_f32_16x16x32_bf16 v[140:143], v[160:163], a[68:71], 0
ds_read_b64_tr_b16 v[192:193], v5 offset:0
ds_read_b64_tr_b16 v[194:195], v5 offset:4096
v_mfma_f32_16x16x32_bf16 v[140:143], v[164:167], a[76:79], v[140:143]
ds_read_b64_tr_b16 v[196:197], v5 offset:8192
s_lshl_b32 s61, s60, 3
v_mfma_f32_16x16x32_bf16 v[124:127], v[164:167], a[72:75], 0
ds_read_b64_tr_b16 v[198:199], v5 offset:12288
s_waitcnt lgkmcnt(8)
v_mfma_f32_16x16x32_bf16 v[124:127], v[160:163], a[64:67], v[124:127]
buffer_load_dwordx4 a[100:103], v3, s[88:91], s101 offen offset:1024 sc1
v_mfma_f32_16x16x32_bf16 v[128:131], v[168:171], a[64:67], 0
ds_read_b64_tr_b16 v[200:201], v4 offset:256
ds_read_b64_tr_b16 v[202:203], v4 offset:4352
v_mfma_f32_16x16x32_bf16 v[128:131], v[172:175], a[72:75], v[128:131]
ds_read_b64_tr_b16 v[204:205], v4 offset:8448
s_add_u32 s62, s61, s12
v_mfma_f32_16x16x32_bf16 v[144:147], v[172:175], a[76:79], 0
ds_read_b64_tr_b16 v[206:207], v4 offset:12544
s_add_u32 s101, s101, 0x2000
v_mfma_f32_16x16x32_bf16 v[144:147], v[168:171], a[68:71], v[144:147]
buffer_load_dwordx4 a[104:107], v3, s[88:91], s101 offen sc1
v_mfma_f32_16x16x32_bf16 v[148:151], v[176:179], a[68:71], 0
ds_read_b64_tr_b16 v[208:209], v5 offset:256
ds_read_b64_tr_b16 v[210:211], v5 offset:4352
v_mfma_f32_16x16x32_bf16 v[148:151], v[180:183], a[76:79], v[148:151]
ds_read_b64_tr_b16 v[212:213], v5 offset:8448
s_waitcnt vmcnt(7) lgkmcnt(7)
v_mfma_f32_16x16x32_bf16 v[132:135], v[180:183], a[72:75], 0
ds_read_b64_tr_b16 v[214:215], v5 offset:12544
s_barrier
v_mfma_f32_16x16x32_bf16 v[132:135], v[176:179], a[64:67], v[132:135]
buffer_load_dwordx4 a[108:111], v3, s[88:91], s101 offen offset:1024 sc1
s_mov_b32 s15, 7
L_p4_loop:
v_mfma_f32_16x16x32_bf16 v[88:91], v[184:187], a[64:67], v[88:91]
ds_read_b64_tr_b16 v[152:153], v4 offset:16896
ds_read_b64_tr_b16 v[154:155], v4 offset:20992
v_mfma_f32_16x16x32_bf16 v[88:91], v[188:191], a[72:75], v[88:91]
ds_read_b64_tr_b16 v[156:157], v4 offset:25088
s_add_u32 s101, s63, s60
v_mfma_f32_16x16x32_bf16 v[104:107], v[188:191], a[76:79], v[104:107]
ds_read_b64_tr_b16 v[158:159], v4 offset:29184
s_add_u32 m0, s16, 0x4000
v_mfma_f32_16x16x32_bf16 v[104:107], v[184:187], a[68:71], v[104:107]
buffer_load_dwordx4 v12, s[64:67], s61 offen lds
v_mfma_f32_16x16x32_bf16 v[108:111], v[192:195], a[68:71], v[108:111]
ds_read_b64_tr_b16 v[160:161], v5 offset:16896
ds_read_b64_tr_b16 v[162:163], v5 offset:20992
v_mfma_f32_16x16x32_bf16 v[108:111], v[196:199], a[76:79], v[108:111]
ds_read_b64_tr_b16 v[164:165], v5 offset:25088
v_mfma_f32_16x16x32_bf16 v[92:95], v[196:199], a[72:75], v[92:95]
ds_read_b64_tr_b16 v[166:167], v5 offset:29184
s_waitcnt lgkmcnt(8)
v_mfma_f32_16x16x32_bf16 v[92:95], v[192:195], a[64:67], v[92:95]
buffer_load_dwordx4 v13, s[64:67], s61 offen offset:1024 lds
v_mfma_f32_16x16x32_bf16 v[96:99], v[200:203], a[64:67], v[96:99]
ds_read_b64_tr_b16 v[168:169], v4 offset:17152
ds_read_b64_tr_b16 v[170:171], v4 offset:21248
v_mfma_f32_16x16x32_bf16 v[96:99], v[204:207], a[72:75], v[96:99]
ds_read_b64_tr_b16 v[172:173], v4 offset:25344
v_mfma_f32_16x16x32_bf16 v[112:115], v[204:207], a[76:79], v[112:115]
ds_read_b64_tr_b16 v[174:175], v4 offset:29440
v_mfma_f32_16x16x32_bf16 v[112:115], v[200:203], a[68:71], v[112:115]
buffer_load_dwordx4 v12, s[64:67], s62 offen offset:2048 lds
v_mfma_f32_16x16x32_bf16 v[116:119], v[208:211], a[68:71], v[116:119]
ds_read_b64_tr_b16 v[176:177], v5 offset:17152
ds_read_b64_tr_b16 v[178:179], v5 offset:21248
v_mfma_f32_16x16x32_bf16 v[116:119], v[212:215], a[76:79], v[116:119]
ds_read_b64_tr_b16 v[180:181], v5 offset:25344
s_waitcnt lgkmcnt(7)
v_mfma_f32_16x16x32_bf16 v[100:103], v[212:215], a[72:75], v[100:103]
ds_read_b64_tr_b16 v[182:183], v5 offset:29440
v_mfma_f32_16x16x32_bf16 v[100:103], v[208:211], a[64:67], v[100:103]
buffer_load_dwordx4 v13, s[64:67], s62 offen offset:3072 lds
v_mfma_f32_16x16x32_bf16 v[120:123], v[152:155], a[80:83], v[120:123]
ds_read_b64_tr_b16 v[184:185], v4 offset:16384
ds_read_b64_tr_b16 v[186:187], v4 offset:20480
v_mfma_f32_16x16x32_bf16 v[120:123], v[156:159], a[88:91], v[120:123]
ds_read_b64_tr_b16 v[188:189], v4 offset:24576
s_add_u32 s60, s60, s56
v_mfma_f32_16x16x32_bf16 v[136:139], v[156:159], a[92:95], v[136:139]
ds_read_b64_tr_b16 v[190:191], v4 offset:28672
s_and_b32 s60, s60, 0x7c000
v_mfma_f32_16x16x32_bf16 v[136:139], v[152:155], a[84:87], v[136:139]
buffer_load_dwordx4 a[112:115], v3, s[88:91], s101 offen sc1
v_mfma_f32_16x16x32_bf16 v[140:143], v[160:163], a[84:87], v[140:143]
ds_read_b64_tr_b16 v[192:193], v5 offset:16384
ds_read_b64_tr_b16 v[194:195], v5 offset:20480
v_mfma_f32_16x16x32_bf16 v[140:143], v[164:167], a[92:95], v[140:143]
ds_read_b64_tr_b16 v[196:197], v5 offset:24576
s_lshl_b32 s61, s60, 3
v_mfma_f32_16x16x32_bf16 v[124:127], v[164:167], a[88:91], v[124:127]
ds_read_b64_tr_b16 v[198:199], v5 offset:28672
s_waitcnt lgkmcnt(8)
v_mfma_f32_16x16x32_bf16 v[124:127], v[160:163], a[80:83], v[124:127]
buffer_load_dwordx4 a[116:119], v3, s[88:91], s101 offen offset:1024 sc1
v_mfma_f32_16x16x32_bf16 v[128:131], v[168:171], a[80:83], v[128:131]
ds_read_b64_tr_b16 v[200:201], v4 offset:16640
ds_read_b64_tr_b16 v[202:203], v4 offset:20736
v_mfma_f32_16x16x32_bf16 v[128:131], v[172:175], a[88:91], v[128:131]
ds_read_b64_tr_b16 v[204:205], v4 offset:24832
s_add_u32 s62, s61, s12
v_mfma_f32_16x16x32_bf16 v[144:147], v[172:175], a[92:95], v[144:147]
ds_read_b64_tr_b16 v[206:207], v4 offset:28928
s_add_u32 s101, s101, 0x2000
v_mfma_f32_16x16x32_bf16 v[144:147], v[168:171], a[84:87], v[144:147]
buffer_load_dwordx4 a[120:123], v3, s[88:91], s101 offen sc1
v_mfma_f32_16x16x32_bf16 v[148:151], v[176:179], a[84:87], v[148:151]
ds_read_b64_tr_b16 v[208:209], v5 offset:16640
ds_read_b64_tr_b16 v[210:211], v5 offset:20736
v_mfma_f32_16x16x32_bf16 v[148:151], v[180:183], a[92:95], v[148:151]
ds_read_b64_tr_b16 v[212:213], v5 offset:24832
s_waitcnt vmcnt(7) lgkmcnt(7)
v_mfma_f32_16x16x32_bf16 v[132:135], v[180:183], a[88:91], v[132:135]
ds_read_b64_tr_b16 v[214:215], v5 offset:28928
s_barrier
v_mfma_f32_16x16x32_bf16 v[132:135], v[176:179], a[80:83], v[132:135]
buffer_load_dwordx4 a[124:127], v3, s[88:91], s101 offen offset:1024 sc1
v_mfma_f32_16x16x32_bf16 v[88:91], v[184:187], a[80:83], v[88:91]
ds_read_b64_tr_b16 v[152:153], v6 offset:512
ds_read_b64_tr_b16 v[154:155], v6 offset:4608
v_mfma_f32_16x16x32_bf16 v[88:91], v[188:191], a[88:91], v[88:91]
ds_read_b64_tr_b16 v[156:157], v6 offset:8704
s_add_u32 s101, s63, s60
v_mfma_f32_16x16x32_bf16 v[104:107], v[188:191], a[92:95], v[104:107]
ds_read_b64_tr_b16 v[158:159], v6 offset:12800
s_add_u32 m0, s17, 0x10000
v_mfma_f32_16x16x32_bf16 v[104:107], v[184:187], a[84:87], v[104:107]
buffer_load_dwordx4 v12, s[64:67], s61 offen lds
v_mfma_f32_16x16x32_bf16 v[108:111], v[192:195], a[84:87], v[108:111]
ds_read_b64_tr_b16 v[160:161], v7 offset:512
ds_read_b64_tr_b16 v[162:163], v7 offset:4608
v_mfma_f32_16x16x32_bf16 v[108:111], v[196:199], a[92:95], v[108:111]
ds_read_b64_tr_b16 v[164:165], v7 offset:8704
v_mfma_f32_16x16x32_bf16 v[92:95], v[196:199], a[88:91], v[92:95]
ds_read_b64_tr_b16 v[166:167], v7 offset:12800
s_waitcnt lgkmcnt(8)
v_mfma_f32_16x16x32_bf16 v[92:95], v[192:195], a[80:83], v[92:95]
buffer_load_dwordx4 v13, s[64:67], s61 offen offset:1024 lds
v_mfma_f32_16x16x32_bf16 v[96:99], v[200:203], a[80:83], v[96:99]
ds_read_b64_tr_b16 v[168:169], v6 offset:768
ds_read_b64_tr_b16 v[170:171], v6 offset:4864
v_mfma_f32_16x16x32_bf16 v[96:99], v[204:207], a[88:91], v[96:99]
ds_read_b64_tr_b16 v[172:173], v6 offset:8960
v_mfma_f32_16x16x32_bf16 v[112:115], v[204:207], a[92:95], v[112:115]
ds_read_b64_tr_b16 v[174:175], v6 offset:13056
v_mfma_f32_16x16x32_bf16 v[112:115], v[200:203], a[84:87], v[112:115]
buffer_load_dwordx4 v12, s[64:67], s62 offen offset:2048 lds
v_mfma_f32_16x16x32_bf16 v[116:119], v[208:211], a[84:87], v[116:119]
ds_read_b64_tr_b16 v[176:177], v7 offset:768
ds_read_b64_tr_b16 v[178:179], v7 offset:4864
v_mfma_f32_16x16x32_bf16 v[116:119], v[212:215], a[92:95], v[116:119]
ds_read_b64_tr_b16 v[180:181], v7 offset:8960
s_waitcnt lgkmcnt(7)
v_mfma_f32_16x16x32_bf16 v[100:103], v[212:215], a[88:91], v[100:103]
ds_read_b64_tr_b16 v[182:183], v7 offset:13056
v_mfma_f32_16x16x32_bf16 v[100:103], v[208:211], a[80:83], v[100:103]
buffer_load_dwordx4 v13, s[64:67], s62 offen offset:3072 lds
v_mfma_f32_16x16x32_bf16 v[120:123], v[152:155], a[96:99], v[120:123]
ds_read_b64_tr_b16 v[184:185], v6 offset:0
ds_read_b64_tr_b16 v[186:187], v6 offset:4096
v_mfma_f32_16x16x32_bf16 v[120:123], v[156:159], a[104:107], v[120:123]
ds_read_b64_tr_b16 v[188:189], v6 offset:8192
s_add_u32 s60, s60, s57
v_mfma_f32_16x16x32_bf16 v[136:139], v[156:159], a[108:111], v[136:139]
ds_read_b64_tr_b16 v[190:191], v6 offset:12288
s_and_b32 s60, s60, 0x7c000
v_mfma_f32_16x16x32_bf16 v[136:139], v[152:155], a[100:103], v[136:139]
buffer_load_dwordx4 a[64:67], v3, s[88:91], s101 offen sc1
v_mfma_f32_16x16x32_bf16 v[140:143], v[160:163], a[100:103], v[140:143]
ds_read_b64_tr_b16 v[192:193], v7 offset:0
ds_read_b64_tr_b16 v[194:195], v7 offset:4096
v_mfma_f32_16x16x32_bf16 v[140:143], v[164:167], a[108:111], v[140:143]
ds_read_b64_tr_b16 v[196:197], v7 offset:8192
s_lshl_b32 s61, s60, 3
v_mfma_f32_16x16x32_bf16 v[124:127], v[164:167], a[104:107], v[124:127]
ds_read_b64_tr_b16 v[198:199], v7 offset:12288
s_waitcnt lgkmcnt(8)
v_mfma_f32_16x16x32_bf16 v[124:127], v[160:163], a[96:99], v[124:127]
buffer_load_dwordx4 a[68:71], v3, s[88:91], s101 offen offset:1024 sc1
v_mfma_f32_16x16x32_bf16 v[128:131], v[168:171], a[96:99], v[128:131]
ds_read_b64_tr_b16 v[200:201], v6 offset:256
ds_read_b64_tr_b16 v[202:203], v6 offset:4352
v_mfma_f32_16x16x32_bf16 v[128:131], v[172:175], a[104:107], v[128:131]
ds_read_b64_tr_b16 v[204:205], v6 offset:8448
s_add_u32 s62, s61, s12
v_mfma_f32_16x16x32_bf16 v[144:147], v[172:175], a[108:111], v[144:147]
ds_read_b64_tr_b16 v[206:207], v6 offset:12544
s_add_u32 s101, s101, 0x2000
v_mfma_f32_16x16x32_bf16 v[144:147], v[168:171], a[100:103], v[144:147]
buffer_load_dwordx4 a[72:75], v3, s[88:91], s101 offen sc1
v_mfma_f32_16x16x32_bf16 v[148:151], v[176:179], a[100:103], v[148:151]
ds_read_b64_tr_b16 v[208:209], v7 offset:256
ds_read_b64_tr_b16 v[210:211], v7 offset:4352
v_mfma_f32_16x16x32_bf16 v[148:151], v[180:183], a[108:111], v[148:151]
ds_read_b64_tr_b16 v[212:213], v7 offset:8448
s_waitcnt vmcnt(7) lgkmcnt(7)
v_mfma_f32_16x16x32_bf16 v[132:135], v[180:183], a[104:107], v[132:135]
ds_read_b64_tr_b16 v[214:215], v7 offset:12544
s_barrier
v_mfma_f32_16x16x32_bf16 v[132:135], v[176:179], a[96:99], v[132:135]
buffer_load_dwordx4 a[76:79], v3, s[88:91], s101 offen offset:1024 sc1
v_mfma_f32_16x16x32_bf16 v[88:91], v[184:187], a[96:99], v[88:91]
ds_read_b64_tr_b16 v[152:153], v6 offset:16896
ds_read_b64_tr_b16 v[154:155], v6 offset:20992
v_mfma_f32_16x16x32_bf16 v[88:91], v[188:191], a[104:107], v[88:91]
ds_read_b64_tr_b16 v[156:157], v6 offset:25088
s_add_u32 s101, s63, s60
v_mfma_f32_16x16x32_bf16 v[104:107], v[188:191], a[108:111], v[104:107]
ds_read_b64_tr_b16 v[158:159], v6 offset:29184
s_add_u32 m0, s17, 0x14000
v_mfma_f32_16x16x32_bf16 v[104:107], v[184:187], a[100:103], v[104:107]
buffer_load_dwordx4 v12, s[64:67], s61 offen lds
v_mfma_f32_16x16x32_bf16 v[108:111], v[192:195], a[100:103], v[108:111]
ds_read_b64_tr_b16 v[160:161], v7 offset:16896
ds_read_b64_tr_b16 v[162:163], v7 offset:20992
v_mfma_f32_16x16x32_bf16 v[108:111], v[196:199], a[108:111], v[108:111]
ds_read_b64_tr_b16 v[164:165], v7 offset:25088
v_mfma_f32_16x16x32_bf16 v[92:95], v[196:199], a[104:107], v[92:95]
ds_read_b64_tr_b16 v[166:167], v7 offset:29184
s_waitcnt lgkmcnt(8)
v_mfma_f32_16x16x32_bf16 v[92:95], v[192:195], a[96:99], v[92:95]
buffer_load_dwordx4 v13, s[64:67], s61 offen offset:1024 lds
v_mfma_f32_16x16x32_bf16 v[96:99], v[200:203], a[96:99], v[96:99]
ds_read_b64_tr_b16 v[168:169], v6 offset:17152
ds_read_b64_tr_b16 v[170:171], v6 offset:21248
v_mfma_f32_16x16x32_bf16 v[96:99], v[204:207], a[104:107], v[96:99]
ds_read_b64_tr_b16 v[172:173], v6 offset:25344
v_mfma_f32_16x16x32_bf16 v[112:115], v[204:207], a[108:111], v[112:115]
ds_read_b64_tr_b16 v[174:175], v6 offset:29440
v_mfma_f32_16x16x32_bf16 v[112:115], v[200:203], a[100:103], v[112:115]
buffer_load_dwordx4 v12, s[64:67], s62 offen offset:2048 lds
v_mfma_f32_16x16x32_bf16 v[116:119], v[208:211], a[100:103], v[116:119]
ds_read_b64_tr_b16 v[176:177], v7 offset:17152
ds_read_b64_tr_b16 v[178:179], v7 offset:21248
v_mfma_f32_16x16x32_bf16 v[116:119], v[212:215], a[108:111], v[116:119]
ds_read_b64_tr_b16 v[180:181], v7 offset:25344
s_waitcnt lgkmcnt(7)
v_mfma_f32_16x16x32_bf16 v[100:103], v[212:215], a[104:107], v[100:103]
ds_read_b64_tr_b16 v[182:183], v7 offset:29440
v_mfma_f32_16x16x32_bf16 v[100:103], v[208:211], a[96:99], v[100:103]
buffer_load_dwordx4 v13, s[64:67], s62 offen offset:3072 lds
v_mfma_f32_16x16x32_bf16 v[120:123], v[152:155], a[112:115], v[120:123]
ds_read_b64_tr_b16 v[184:185], v6 offset:16384
ds_read_b64_tr_b16 v[186:187], v6 offset:20480
v_mfma_f32_16x16x32_bf16 v[120:123], v[156:159], a[120:123], v[120:123]
ds_read_b64_tr_b16 v[188:189], v6 offset:24576
s_add_u32 s60, s60, s58
v_mfma_f32_16x16x32_bf16 v[136:139], v[156:159], a[124:127], v[136:139]
ds_read_b64_tr_b16 v[190:191], v6 offset:28672
s_and_b32 s60, s60, 0x7c000
v_mfma_f32_16x16x32_bf16 v[136:139], v[152:155], a[116:119], v[136:139]
buffer_load_dwordx4 a[80:83], v3, s[88:91], s101 offen sc1
v_mfma_f32_16x16x32_bf16 v[140:143], v[160:163], a[116:119], v[140:143]
ds_read_b64_tr_b16 v[192:193], v7 offset:16384
ds_read_b64_tr_b16 v[194:195], v7 offset:20480
v_mfma_f32_16x16x32_bf16 v[140:143], v[164:167], a[124:127], v[140:143]
ds_read_b64_tr_b16 v[196:197], v7 offset:24576
s_lshl_b32 s61, s60, 3
v_mfma_f32_16x16x32_bf16 v[124:127], v[164:167], a[120:123], v[124:127]
ds_read_b64_tr_b16 v[198:199], v7 offset:28672
s_waitcnt lgkmcnt(8)
v_mfma_f32_16x16x32_bf16 v[124:127], v[160:163], a[112:115], v[124:127]
buffer_load_dwordx4 a[84:87], v3, s[88:91], s101 offen offset:1024 sc1
v_mfma_f32_16x16x32_bf16 v[128:131], v[168:171], a[112:115], v[128:131]
ds_read_b64_tr_b16 v[200:201], v6 offset:16640
ds_read_b64_tr_b16 v[202:203], v6 offset:20736
v_mfma_f32_16x16x32_bf16 v[128:131], v[172:175], a[120:123], v[128:131]
ds_read_b64_tr_b16 v[204:205], v6 offset:24832
s_add_u32 s62, s61, s12
v_mfma_f32_16x16x32_bf16 v[144:147], v[172:175], a[124:127], v[144:147]
ds_read_b64_tr_b16 v[206:207], v6 offset:28928
s_add_u32 s101, s101, 0x2000
v_mfma_f32_16x16x32_bf16 v[144:147], v[168:171], a[116:119], v[144:147]
buffer_load_dwordx4 a[88:91], v3, s[88:91], s101 offen sc1
v_mfma_f32_16x16x32_bf16 v[148:151], v[176:179], a[116:119], v[148:151]
ds_read_b64_tr_b16 v[208:209], v7 offset:16640
ds_read_b64_tr_b16 v[210:211], v7 offset:20736
v_mfma_f32_16x16x32_bf16 v[148:151], v[180:183], a[124:127], v[148:151]
ds_read_b64_tr_b16 v[212:213], v7 offset:24832
s_waitcnt vmcnt(7) lgkmcnt(7)
v_mfma_f32_16x16x32_bf16 v[132:135], v[180:183], a[120:123], v[132:135]
ds_read_b64_tr_b16 v[214:215], v7 offset:28928
s_barrier
v_mfma_f32_16x16x32_bf16 v[132:135], v[176:179], a[112:115], v[132:135]
buffer_load_dwordx4 a[92:95], v3, s[88:91], s101 offen offset:1024 sc1
v_mfma_f32_16x16x32_bf16 v[88:91], v[184:187], a[112:115], v[88:91]
ds_read_b64_tr_b16 v[152:153], v4 offset:512
ds_read_b64_tr_b16 v[154:155], v4 offset:4608
v_mfma_f32_16x16x32_bf16 v[88:91], v[188:191], a[120:123], v[88:91]
ds_read_b64_tr_b16 v[156:157], v4 offset:8704
s_add_u32 s101, s63, s60
v_mfma_f32_16x16x32_bf16 v[104:107], v[188:191], a[124:127], v[104:107]
ds_read_b64_tr_b16 v[158:159], v4 offset:12800
s_add_u32 m0, s16, 0x0
v_mfma_f32_16x16x32_bf16 v[104:107], v[184:187], a[116:119], v[104:107]
buffer_load_dwordx4 v12, s[64:67], s61 offen lds
v_mfma_f32_16x16x32_bf16 v[108:111], v[192:195], a[116:119], v[108:111]
ds_read_b64_tr_b16 v[160:161], v5 offset:512
ds_read_b64_tr_b16 v[162:163], v5 offset:4608
v_mfma_f32_16x16x32_bf16 v[108:111], v[196:199], a[124:127], v[108:111]
ds_read_b64_tr_b16 v[164:165], v5 offset:8704
s_sub_u32 s15, s15, 1
v_mfma_f32_16x16x32_bf16 v[92:95], v[196:199], a[120:123], v[92:95]
ds_read_b64_tr_b16 v[166:167], v5 offset:12800
s_waitcnt lgkmcnt(8)
v_mfma_f32_16x16x32_bf16 v[92:95], v[192:195], a[112:115], v[92:95]
buffer_load_dwordx4 v13, s[64:67], s61 offen offset:1024 lds
v_mfma_f32_16x16x32_bf16 v[96:99], v[200:203], a[112:115], v[96:99]
ds_read_b64_tr_b16 v[168:169], v4 offset:768
ds_read_b64_tr_b16 v[170:171], v4 offset:4864
v_mfma_f32_16x16x32_bf16 v[96:99], v[204:207], a[120:123], v[96:99]
ds_read_b64_tr_b16 v[172:173], v4 offset:8960
v_mfma_f32_16x16x32_bf16 v[112:115], v[204:207], a[124:127], v[112:115]
ds_read_b64_tr_b16 v[174:175], v4 offset:13056
v_mfma_f32_16x16x32_bf16 v[112:115], v[200:203], a[116:119], v[112:115]
buffer_load_dwordx4 v12, s[64:67], s62 offen offset:2048 lds
v_mfma_f32_16x16x32_bf16 v[116:119], v[208:211], a[116:119], v[116:119]
ds_read_b64_tr_b16 v[176:177], v5 offset:768
ds_read_b64_tr_b16 v[178:179], v5 offset:4864
v_mfma_f32_16x16x32_bf16 v[116:119], v[212:215], a[124:127], v[116:119]
ds_read_b64_tr_b16 v[180:181], v5 offset:8960
s_waitcnt lgkmcnt(7)
v_mfma_f32_16x16x32_bf16 v[100:103], v[212:215], a[120:123], v[100:103]
ds_read_b64_tr_b16 v[182:183], v5 offset:13056
v_mfma_f32_16x16x32_bf16 v[100:103], v[208:211], a[112:115], v[100:103]
buffer_load_dwordx4 v13, s[64:67], s62 offen offset:3072 lds
v_mfma_f32_16x16x32_bf16 v[120:123], v[152:155], a[64:67], v[120:123]
ds_read_b64_tr_b16 v[184:185], v4 offset:0
ds_read_b64_tr_b16 v[186:187], v4 offset:4096
v_mfma_f32_16x16x32_bf16 v[120:123], v[156:159], a[72:75], v[120:123]
ds_read_b64_tr_b16 v[188:189], v4 offset:8192
s_add_u32 s60, s60, s59
v_mfma_f32_16x16x32_bf16 v[136:139], v[156:159], a[76:79], v[136:139]
ds_read_b64_tr_b16 v[190:191], v4 offset:12288
s_and_b32 s60, s60, 0x7c000
v_mfma_f32_16x16x32_bf16 v[136:139], v[152:155], a[68:71], v[136:139]
buffer_load_dwordx4 a[96:99], v3, s[88:91], s101 offen sc1
v_mfma_f32_16x16x32_bf16 v[140:143], v[160:163], a[68:71], v[140:143]
ds_read_b64_tr_b16 v[192:193], v5 offset:0
ds_read_b64_tr_b16 v[194:195], v5 offset:4096
v_mfma_f32_16x16x32_bf16 v[140:143], v[164:167], a[76:79], v[140:143]
ds_read_b64_tr_b16 v[196:197], v5 offset:8192
s_lshl_b32 s61, s60, 3
v_mfma_f32_16x16x32_bf16 v[124:127], v[164:167], a[72:75], v[124:127]
ds_read_b64_tr_b16 v[198:199], v5 offset:12288
s_waitcnt lgkmcnt(8)
v_mfma_f32_16x16x32_bf16 v[124:127], v[160:163], a[64:67], v[124:127]
buffer_load_dwordx4 a[100:103], v3, s[88:91], s101 offen offset:1024 sc1
v_mfma_f32_16x16x32_bf16 v[128:131], v[168:171], a[64:67], v[128:131]
ds_read_b64_tr_b16 v[200:201], v4 offset:256
ds_read_b64_tr_b16 v[202:203], v4 offset:4352
v_mfma_f32_16x16x32_bf16 v[128:131], v[172:175], a[72:75], v[128:131]
ds_read_b64_tr_b16 v[204:205], v4 offset:8448
s_add_u32 s62, s61, s12
v_mfma_f32_16x16x32_bf16 v[144:147], v[172:175], a[76:79], v[144:147]
ds_read_b64_tr_b16 v[206:207], v4 offset:12544
s_add_u32 s101, s101, 0x2000
v_mfma_f32_16x16x32_bf16 v[144:147], v[168:171], a[68:71], v[144:147]
buffer_load_dwordx4 a[104:107], v3, s[88:91], s101 offen sc1
v_mfma_f32_16x16x32_bf16 v[148:151], v[176:179], a[68:71], v[148:151]
ds_read_b64_tr_b16 v[208:209], v5 offset:256
ds_read_b64_tr_b16 v[210:211], v5 offset:4352
v_mfma_f32_16x16x32_bf16 v[148:151], v[180:183], a[76:79], v[148:151]
ds_read_b64_tr_b16 v[212:213], v5 offset:8448
s_waitcnt vmcnt(7) lgkmcnt(7)
v_mfma_f32_16x16x32_bf16 v[132:135], v[180:183], a[72:75], v[132:135]
ds_read_b64_tr_b16 v[214:215], v5 offset:12544
s_barrier
v_mfma_f32_16x16x32_bf16 v[132:135], v[176:179], a[64:67], v[132:135]
buffer_load_dwordx4 a[108:111], v3, s[88:91], s101 offen offset:1024 sc1
s_cmp_lg_u32 s15, 0
s_cbranch_scc1 L_p4_loop
s_add_u32 s101, s63, s60
v_mfma_f32_16x16x32_bf16 v[88:91], v[184:187], a[64:67], v[88:91]
ds_read_b64_tr_b16 v[152:153], v4 offset:16896
ds_read_b64_tr_b16 v[154:155], v4 offset:20992
s_add_u32 m0, s16, 0x4000
v_mfma_f32_16x16x32_bf16 v[88:91], v[188:191], a[72:75], v[88:91]
buffer_load_dwordx4 v12, s[64:67], s61 offen lds
v_mfma_f32_16x16x32_bf16 v[104:107], v[188:191], a[76:79], v[104:107]
ds_read_b64_tr_b16 v[156:157], v4 offset:25088
ds_read_b64_tr_b16 v[158:159], v4 offset:29184
v_mfma_f32_16x16x32_bf16 v[104:107], v[184:187], a[68:71], v[104:107]
buffer_load_dwordx4 v13, s[64:67], s61 offen offset:1024 lds
v_mfma_f32_16x16x32_bf16 v[108:111], v[192:195], a[68:71], v[108:111]
ds_read_b64_tr_b16 v[160:161], v5 offset:16896
ds_read_b64_tr_b16 v[162:163], v5 offset:20992
v_mfma_f32_16x16x32_bf16 v[108:111], v[196:199], a[76:79], v[108:111]
buffer_load_dwordx4 v12, s[64:67], s62 offen offset:2048 lds
v_mfma_f32_16x16x32_bf16 v[92:95], v[196:199], a[72:75], v[92:95]
ds_read_b64_tr_b16 v[164:165], v5 offset:25088
ds_read_b64_tr_b16 v[166:167], v5 offset:29184
s_waitcnt lgkmcnt(8)
v_mfma_f32_16x16x32_bf16 v[92:95], v[192:195], a[64:67], v[92:95]
buffer_load_dwordx4 v13, s[64:67], s62 offen offset:3072 lds
v_mfma_f32_16x16x32_bf16 v[96:99], v[200:203], a[64:67], v[96:99]
ds_read_b64_tr_b16 v[168:169], v4 offset:17152
ds_read_b64_tr_b16 v[170:171], v4 offset:21248
v_mfma_f32_16x16x32_bf16 v[96:99], v[204:207], a[72:75], v[96:99]
buffer_load_dwordx4 a[112:115], v3, s[88:91], s101 offen sc1
v_mfma_f32_16x16x32_bf16 v[112:115], v[204:207], a[76:79], v[112:115]
ds_read_b64_tr_b16 v[172:173], v4 offset:25344
ds_read_b64_tr_b16 v[174:175], v4 offset:29440
v_mfma_f32_16x16x32_bf16 v[112:115], v[200:203], a[68:71], v[112:115]
buffer_load_dwordx4 a[116:119], v3, s[88:91], s101 offen offset:1024 sc1
v_mfma_f32_16x16x32_bf16 v[116:119], v[208:211], a[68:71], v[116:119]
ds_read_b64_tr_b16 v[176:177], v5 offset:17152
ds_read_b64_tr_b16 v[178:179], v5 offset:21248
s_add_u32 s101, s101, 0x2000
v_mfma_f32_16x16x32_bf16 v[116:119], v[212:215], a[76:79], v[116:119]
buffer_load_dwordx4 a[120:123], v3, s[88:91], s101 offen sc1
s_waitcnt vmcnt(7) lgkmcnt(6)
v_mfma_f32_16x16x32_bf16 v[100:103], v[212:215], a[72:75], v[100:103]
ds_read_b64_tr_b16 v[180:181], v5 offset:25344
ds_read_b64_tr_b16 v[182:183], v5 offset:29440
s_barrier
v_mfma_f32_16x16x32_bf16 v[100:103], v[208:211], a[64:67], v[100:103]
buffer_load_dwordx4 a[124:127], v3, s[88:91], s101 offen offset:1024 sc1
v_mfma_f32_16x16x32_bf16 v[120:123], v[152:155], a[80:83], v[120:123]
ds_read_b64_tr_b16 v[184:185], v6 offset:512
v_sub_f32 v10, 1.0, v8
v_mfma_f32_16x16x32_bf16 v[120:123], v[156:159], a[88:91], v[120:123]
ds_read_b64_tr_b16 v[186:187], v6 offset:4608
v_sub_f32 v11, 1.0, v9
v_mfma_f32_16x16x32_bf16 v[136:139], v[156:159], a[92:95], v[136:139]
ds_read_b64_tr_b16 v[188:189], v6 offset:8704
v_mul_f32 v56, v10, v56
v_mfma_f32_16x16x32_bf16 v[136:139], v[152:155], a[84:87], v[136:139]
ds_read_b64_tr_b16 v[190:191], v6 offset:12800
v_mul_f32 v57, v10, v57
v_mfma_f32_16x16x32_bf16 v[140:143], v[160:163], a[84:87], v[140:143]
ds_read_b64_tr_b16 v[192:193], v7 offset:512
v_mul_f32 v58, v10, v58
v_mfma_f32_16x16x32_bf16 v[140:143], v[164:167], a[92:95], v[140:143]
ds_read_b64_tr_b16 v[194:195], v7 offset:4608
v_mul_f32 v59, v10, v59
v_mfma_f32_16x16x32_bf16 v[124:127], v[164:167], a[88:91], v[124:127]
ds_read_b64_tr_b16 v[196:197], v7 offset:8704
s_waitcnt lgkmcnt(7)
v_mfma_f32_16x16x32_bf16 v[124:127], v[160:163], a[80:83], v[124:127]
ds_read_b64_tr_b16 v[198:199], v7 offset:12800
v_mul_f32 v60, v10, v60
v_mfma_f32_16x16x32_bf16 v[128:131], v[168:171], a[80:83], v[128:131]
ds_read_b64_tr_b16 v[200:201], v6 offset:768
v_mul_f32 v61, v10, v61
v_mfma_f32_16x16x32_bf16 v[128:131], v[172:175], a[88:91], v[128:131]
ds_read_b64_tr_b16 v[202:203], v6 offset:4864
v_mul_f32 v62, v10, v62
v_mfma_f32_16x16x32_bf16 v[144:147], v[172:175], a[92:95], v[144:147]
ds_read_b64_tr_b16 v[204:205], v6 offset:8960
v_mul_f32 v63, v10, v63
v_mfma_f32_16x16x32_bf16 v[144:147], v[168:171], a[84:87], v[144:147]
ds_read_b64_tr_b16 v[206:207], v6 offset:13056
v_mul_f32 v64, v10, v64
v_mfma_f32_16x16x32_bf16 v[148:151], v[176:179], a[84:87], v[148:151]
ds_read_b64_tr_b16 v[208:209], v7 offset:768
v_mul_f32 v65, v10, v65
v_mfma_f32_16x16x32_bf16 v[148:151], v[180:183], a[92:95], v[148:151]
ds_read_b64_tr_b16 v[210:211], v7 offset:4864
s_waitcnt vmcnt(0) lgkmcnt(6)
v_mfma_f32_16x16x32_bf16 v[132:135], v[180:183], a[88:91], v[132:135]
ds_read_b64_tr_b16 v[212:213], v7 offset:8960
s_barrier
v_mfma_f32_16x16x32_bf16 v[132:135], v[176:179], a[80:83], v[132:135]
ds_read_b64_tr_b16 v[214:215], v7 offset:13056
v_mul_f32 v66, v10, v66
v_mul_f32 v67, v10, v67
v_mfma_f32_16x16x32_bf16 v[120:123], v[184:187], a[96:99], v[120:123]
ds_read_b64_tr_b16 v[152:153], v6 offset:16896
v_mul_f32 v68, v10, v68
v_mfma_f32_16x16x32_bf16 v[120:123], v[188:191], a[104:107], v[120:123]
ds_read_b64_tr_b16 v[154:155], v6 offset:20992
v_mul_f32 v69, v10, v69
v_mfma_f32_16x16x32_bf16 v[136:139], v[188:191], a[108:111], v[136:139]
ds_read_b64_tr_b16 v[156:157], v6 offset:25088
v_mul_f32 v70, v10, v70
v_mfma_f32_16x16x32_bf16 v[136:139], v[184:187], a[100:103], v[136:139]
ds_read_b64_tr_b16 v[158:159], v6 offset:29184
v_mul_f32 v71, v10, v71
v_mfma_f32_16x16x32_bf16 v[140:143], v[192:195], a[100:103], v[140:143]
ds_read_b64_tr_b16 v[160:161], v7 offset:16896
v_mul_f32 v72, v11, v72
v_mfma_f32_16x16x32_bf16 v[140:143], v[196:199], a[108:111], v[140:143]
ds_read_b64_tr_b16 v[162:163], v7 offset:20992
v_mul_f32 v73, v11, v73
v_mfma_f32_16x16x32_bf16 v[124:127], v[196:199], a[104:107], v[124:127]
ds_read_b64_tr_b16 v[164:165], v7 offset:25088
s_waitcnt lgkmcnt(7)
v_mfma_f32_16x16x32_bf16 v[124:127], v[192:195], a[96:99], v[124:127]
ds_read_b64_tr_b16 v[166:167], v7 offset:29184
v_mul_f32 v74, v11, v74
v_mfma_f32_16x16x32_bf16 v[128:131], v[200:203], a[96:99], v[128:131]
ds_read_b64_tr_b16 v[168:169], v6 offset:17152
v_mul_f32 v75, v11, v75
v_mfma_f32_16x16x32_bf16 v[128:131], v[204:207], a[104:107], v[128:131]
ds_read_b64_tr_b16 v[170:171], v6 offset:21248
v_mul_f32 v76, v11, v76
v_mfma_f32_16x16x32_bf16 v[144:147], v[204:207], a[108:111], v[144:147]
ds_read_b64_tr_b16 v[172:173], v6 offset:25344
v_mul_f32 v77, v11, v77
v_mfma_f32_16x16x32_bf16 v[144:147], v[200:203], a[100:103], v[144:147]
ds_read_b64_tr_b16 v[174:175], v6 offset:29440
v_mul_f32 v78, v11, v78
v_mfma_f32_16x16x32_bf16 v[148:151], v[208:211], a[100:103], v[148:151]
ds_read_b64_tr_b16 v[176:177], v7 offset:17152
v_mul_f32 v79, v11, v79
v_mfma_f32_16x16x32_bf16 v[148:151], v[212:215], a[108:111], v[148:151]
ds_read_b64_tr_b16 v[178:179], v7 offset:21248
s_waitcnt lgkmcnt(6)
v_mfma_f32_16x16x32_bf16 v[132:135], v[212:215], a[104:107], v[132:135]
ds_read_b64_tr_b16 v[180:181], v7 offset:25344
v_mul_f32 v80, v11, v80
v_mfma_f32_16x16x32_bf16 v[132:135], v[208:211], a[96:99], v[132:135]
ds_read_b64_tr_b16 v[182:183], v7 offset:29440
v_mul_f32 v81, v11, v81
v_mfma_f32_16x16x32_bf16 v[120:123], v[152:155], a[112:115], v[120:123]
ds_read_b64_tr_b16 v[184:185], v4 offset:16384
v_mul_f32 v82, v11, v82
v_mfma_f32_16x16x32_bf16 v[120:123], v[156:159], a[120:123], v[120:123]
ds_read_b64_tr_b16 v[186:187], v4 offset:20480
v_mul_f32 v83, v11, v83
v_mfma_f32_16x16x32_bf16 v[136:139], v[156:159], a[124:127], v[136:139]
ds_read_b64_tr_b16 v[188:189], v4 offset:24576
v_mul_f32 v84, v11, v84
v_mfma_f32_16x16x32_bf16 v[136:139], v[152:155], a[116:119], v[136:139]
ds_read_b64_tr_b16 v[190:191], v4 offset:28672
v_mul_f32 v85, v11, v85
v_mfma_f32_16x16x32_bf16 v[140:143], v[160:163], a[116:119], v[140:143]
ds_read_b64_tr_b16 v[192:193], v5 offset:16384
v_mul_f32 v86, v11, v86
v_mfma_f32_16x16x32_bf16 v[140:143], v[164:167], a[124:127], v[140:143]
ds_read_b64_tr_b16 v[194:195], v5 offset:20480
v_mul_f32 v87, v11, v87
v_mfma_f32_16x16x32_bf16 v[124:127], v[164:167], a[120:123], v[124:127]
ds_read_b64_tr_b16 v[196:197], v5 offset:24576
s_waitcnt lgkmcnt(7)
v_mfma_f32_16x16x32_bf16 v[124:127], v[160:163], a[112:115], v[124:127]
ds_read_b64_tr_b16 v[198:199], v5 offset:28672
v_mul_f32 v24, v10, v24
v_mfma_f32_16x16x32_bf16 v[128:131], v[168:171], a[112:115], v[128:131]
ds_read_b64_tr_b16 v[200:201], v4 offset:16640
v_mul_f32 v25, v10, v25
v_mfma_f32_16x16x32_bf16 v[128:131], v[172:175], a[120:123], v[128:131]
ds_read_b64_tr_b16 v[202:203], v4 offset:20736
v_mul_f32 v26, v10, v26
v_mfma_f32_16x16x32_bf16 v[144:147], v[172:175], a[124:127], v[144:147]
ds_read_b64_tr_b16 v[204:205], v4 offset:24832
v_mul_f32 v27, v10, v27
v_mfma_f32_16x16x32_bf16 v[144:147], v[168:171], a[116:119], v[144:147]
ds_read_b64_tr_b16 v[206:207], v4 offset:28928
v_mul_f32 v28, v10, v28
v_mfma_f32_16x16x32_bf16 v[148:151], v[176:179], a[116:119], v[148:151]
ds_read_b64_tr_b16 v[208:209], v5 offset:16640
v_mul_f32 v29, v10, v29
v_mfma_f32_16x16x32_bf16 v[148:151], v[180:183], a[124:127], v[148:151]
ds_read_b64_tr_b16 v[210:211], v5 offset:20736
s_waitcnt lgkmcnt(6)
v_mfma_f32_16x16x32_bf16 v[132:135], v[180:183], a[120:123], v[132:135]
ds_read_b64_tr_b16 v[212:213], v5 offset:24832
v_mul_f32 v30, v10, v30
v_mfma_f32_16x16x32_bf16 v[132:135], v[176:179], a[112:115], v[132:135]
ds_read_b64_tr_b16 v[214:215], v5 offset:28928
v_mul_f32 v31, v10, v31
v_mfma_f32_16x16x32_bf16 v[88:91], v[184:187], a[80:83], v[88:91]
ds_read_b64_tr_b16 v[152:153], v6 offset:0
v_mfma_f32_16x16x32_bf16 v[88:91], v[188:191], a[88:91], v[88:91]
ds_read_b64_tr_b16 v[154:155], v6 offset:4096
v_mfma_f32_16x16x32_bf16 v[104:107], v[188:191], a[92:95], v[104:107]
ds_read_b64_tr_b16 v[156:157], v6 offset:8192
v_mfma_f32_16x16x32_bf16 v[104:107], v[184:187], a[84:87], v[104:107]
ds_read_b64_tr_b16 v[158:159], v6 offset:12288
v_fmac_f32 v56, v8, v120
v_fmac_f32 v57, v8, v121
v_fmac_f32 v58, v8, v122
v_fmac_f32 v59, v8, v123
v_mfma_f32_16x16x32_bf16 v[108:111], v[192:195], a[84:87], v[108:111]
ds_read_b64_tr_b16 v[160:161], v7 offset:0
v_fmac_f32 v60, v8, v124
v_fmac_f32 v61, v8, v125
v_fmac_f32 v62, v8, v126
v_fmac_f32 v63, v8, v127
v_mfma_f32_16x16x32_bf16 v[108:111], v[196:199], a[92:95], v[108:111]
ds_read_b64_tr_b16 v[162:163], v7 offset:4096
v_cvt_pk_bf16_f32 v56, v56, v57
v_cvt_pk_bf16_f32 v57, v58, v59
v_cvt_pk_bf16_f32 v58, v60, v61
v_cvt_pk_bf16_f32 v59, v62, v63
v_mfma_f32_16x16x32_bf16 v[92:95], v[196:199], a[88:91], v[92:95]
ds_read_b64_tr_b16 v[164:165], v7 offset:8192
s_waitcnt lgkmcnt(7)
buffer_store_dwordx4 v[56:59], v3, s[88:91], s30 offen offset:0 sc1
v_fmac_f32 v64, v8, v128
v_fmac_f32 v65, v8, v129
v_fmac_f32 v66, v8, v130
v_mfma_f32_16x16x32_bf16 v[92:95], v[192:195], a[80:83], v[92:95]
ds_read_b64_tr_b16 v[166:167], v7 offset:12288
v_fmac_f32 v67, v8, v131
v_fmac_f32 v68, v8, v132
v_fmac_f32 v69, v8, v133
v_fmac_f32 v70, v8, v134
v_mfma_f32_16x16x32_bf16 v[96:99], v[200:203], a[80:83], v[96:99]
ds_read_b64_tr_b16 v[168:169], v6 offset:256
v_fmac_f32 v71, v8, v135
v_cvt_pk_bf16_f32 v64, v64, v65
v_cvt_pk_bf16_f32 v65, v66, v67
v_cvt_pk_bf16_f32 v66, v68, v69
v_mfma_f32_16x16x32_bf16 v[96:99], v[204:207], a[88:91], v[96:99]
ds_read_b64_tr_b16 v[170:171], v6 offset:4352
v_cvt_pk_bf16_f32 v67, v70, v71
buffer_store_dwordx4 v[64:67], v3, s[88:91], s30 offen offset:1024 sc1
v_fmac_f32 v72, v9, v136
v_fmac_f32 v73, v9, v137
v_mfma_f32_16x16x32_bf16 v[112:115], v[204:207], a[92:95], v[112:115]
ds_read_b64_tr_b16 v[172:173], v6 offset:8448
v_fmac_f32 v74, v9, v138
v_fmac_f32 v75, v9, v139
v_fmac_f32 v76, v9, v140
v_fmac_f32 v77, v9, v141
v_mfma_f32_16x16x32_bf16 v[112:115], v[200:203], a[84:87], v[112:115]
ds_read_b64_tr_b16 v[174:175], v6 offset:12544
v_fmac_f32 v78, v9, v142
v_fmac_f32 v79, v9, v143
v_cvt_pk_bf16_f32 v72, v72, v73
v_cvt_pk_bf16_f32 v73, v74, v75
v_mfma_f32_16x16x32_bf16 v[116:119], v[208:211], a[84:87], v[116:119]
ds_read_b64_tr_b16 v[176:177], v7 offset:256
v_cvt_pk_bf16_f32 v74, v76, v77
v_cvt_pk_bf16_f32 v75, v78, v79
buffer_store_dwordx4 v[72:75], v3, s[88:91], s30 offen offset:2048 sc1
v_fmac_f32 v80, v9, v144
v_mfma_f32_16x16x32_bf16 v[116:119], v[212:215], a[92:95], v[116:119]
ds_read_b64_tr_b16 v[178:179], v7 offset:4352
s_waitcnt lgkmcnt(6)
v_fmac_f32 v81, v9, v145
v_fmac_f32 v82, v9, v146
v_fmac_f32 v83, v9, v147
v_fmac_f32 v84, v9, v148
v_mfma_f32_16x16x32_bf16 v[100:103], v[212:215], a[88:91], v[100:103]
ds_read_b64_tr_b16 v[180:181], v7 offset:8448
v_fmac_f32 v85, v9, v149
v_fmac_f32 v86, v9, v150
v_fmac_f32 v87, v9, v151
v_cvt_pk_bf16_f32 v80, v80, v81
v_mfma_f32_16x16x32_bf16 v[100:103], v[208:211], a[80:83], v[100:103]
ds_read_b64_tr_b16 v[182:183], v7 offset:12544
v_cvt_pk_bf16_f32 v81, v82, v83
v_cvt_pk_bf16_f32 v82, v84, v85
v_cvt_pk_bf16_f32 v83, v86, v87
buffer_store_dwordx4 v[80:83], v3, s[88:91], s30 offen offset:3072 sc1
v_mfma_f32_16x16x32_bf16 v[88:91], v[152:155], a[96:99], v[88:91]
ds_read_b64_tr_b16 v[184:185], v6 offset:16384
v_mul_f32 v32, v10, v32
v_mfma_f32_16x16x32_bf16 v[88:91], v[156:159], a[104:107], v[88:91]
ds_read_b64_tr_b16 v[186:187], v6 offset:20480
v_mul_f32 v33, v10, v33
v_mfma_f32_16x16x32_bf16 v[104:107], v[156:159], a[108:111], v[104:107]
ds_read_b64_tr_b16 v[188:189], v6 offset:24576
v_mul_f32 v34, v10, v34
v_mfma_f32_16x16x32_bf16 v[104:107], v[152:155], a[100:103], v[104:107]
ds_read_b64_tr_b16 v[190:191], v6 offset:28672
v_mul_f32 v35, v10, v35
v_mfma_f32_16x16x32_bf16 v[108:111], v[160:163], a[100:103], v[108:111]
ds_read_b64_tr_b16 v[192:193], v7 offset:16384
v_mul_f32 v36, v10, v36
v_mfma_f32_16x16x32_bf16 v[108:111], v[164:167], a[108:111], v[108:111]
ds_read_b64_tr_b16 v[194:195], v7 offset:20480
v_mul_f32 v37, v10, v37
v_mfma_f32_16x16x32_bf16 v[92:95], v[164:167], a[104:107], v[92:95]
ds_read_b64_tr_b16 v[196:197], v7 offset:24576
s_waitcnt lgkmcnt(7)
v_mfma_f32_16x16x32_bf16 v[92:95], v[160:163], a[96:99], v[92:95]
ds_read_b64_tr_b16 v[198:199], v7 offset:28672
v_mul_f32 v38, v10, v38
v_mfma_f32_16x16x32_bf16 v[96:99], v[168:171], a[96:99], v[96:99]
ds_read_b64_tr_b16 v[200:201], v6 offset:16640
v_mul_f32 v39, v10, v39
v_mfma_f32_16x16x32_bf16 v[96:99], v[172:175], a[104:107], v[96:99]
ds_read_b64_tr_b16 v[202:203], v6 offset:20736
v_mul_f32 v40, v11, v40
v_mfma_f32_16x16x32_bf16 v[112:115], v[172:175], a[108:111], v[112:115]
ds_read_b64_tr_b16 v[204:205], v6 offset:24832
v_mul_f32 v41, v11, v41
v_mfma_f32_16x16x32_bf16 v[112:115], v[168:171], a[100:103], v[112:115]
ds_read_b64_tr_b16 v[206:207], v6 offset:28928
v_mul_f32 v42, v11, v42
v_mfma_f32_16x16x32_bf16 v[116:119], v[176:179], a[100:103], v[116:119]
ds_read_b64_tr_b16 v[208:209], v7 offset:16640
v_mul_f32 v43, v11, v43
v_mfma_f32_16x16x32_bf16 v[116:119], v[180:183], a[108:111], v[116:119]
ds_read_b64_tr_b16 v[210:211], v7 offset:20736
s_waitcnt lgkmcnt(6)
v_mfma_f32_16x16x32_bf16 v[100:103], v[180:183], a[104:107], v[100:103]
ds_read_b64_tr_b16 v[212:213], v7 offset:24832
v_mul_f32 v44, v11, v44
v_mfma_f32_16x16x32_bf16 v[100:103], v[176:179], a[96:99], v[100:103]
ds_read_b64_tr_b16 v[214:215], v7 offset:28928
v_mul_f32 v45, v11, v45
v_mfma_f32_16x16x32_bf16 v[88:91], v[184:187], a[112:115], v[88:91]
v_mul_f32 v46, v11, v46
v_mul_f32 v47, v11, v47
v_mfma_f32_16x16x32_bf16 v[88:91], v[188:191], a[120:123], v[88:91]
v_mul_f32 v48, v11, v48
v_mul_f32 v49, v11, v49
v_mfma_f32_16x16x32_bf16 v[104:107], v[188:191], a[124:127], v[104:107]
v_mul_f32 v50, v11, v50
v_mul_f32 v51, v11, v51
v_mfma_f32_16x16x32_bf16 v[104:107], v[184:187], a[116:119], v[104:107]
v_mul_f32 v52, v11, v52
v_mul_f32 v53, v11, v53
v_mfma_f32_16x16x32_bf16 v[108:111], v[192:195], a[116:119], v[108:111]
v_mul_f32 v54, v11, v54
v_mul_f32 v55, v11, v55
v_mfma_f32_16x16x32_bf16 v[108:111], v[196:199], a[124:127], v[108:111]
v_mfma_f32_16x16x32_bf16 v[92:95], v[196:199], a[120:123], v[92:95]
s_waitcnt lgkmcnt(0)
v_mfma_f32_16x16x32_bf16 v[92:95], v[192:195], a[112:115], v[92:95]
v_mfma_f32_16x16x32_bf16 v[96:99], v[200:203], a[112:115], v[96:99]
v_mfma_f32_16x16x32_bf16 v[96:99], v[204:207], a[120:123], v[96:99]
v_mfma_f32_16x16x32_bf16 v[112:115], v[204:207], a[124:127], v[112:115]
v_mfma_f32_16x16x32_bf16 v[112:115], v[200:203], a[116:119], v[112:115]
v_mfma_f32_16x16x32_bf16 v[116:119], v[208:211], a[116:119], v[116:119]
v_mfma_f32_16x16x32_bf16 v[116:119], v[212:215], a[124:127], v[116:119]
v_mfma_f32_16x16x32_bf16 v[100:103], v[212:215], a[120:123], v[100:103]
v_mfma_f32_16x16x32_bf16 v[100:103], v[208:211], a[112:115], v[100:103]
buffer_load_dwordx4 v[152:155], v3, s[88:91], s28 offen offset:0 sc1
buffer_load_dwordx4 v[156:159], v3, s[88:91], s28 offen offset:1024 sc1
buffer_load_dwordx4 v[160:163], v3, s[88:91], s28 offen offset:2048 sc1
buffer_load_dwordx4 v[164:167], v3, s[88:91], s28 offen offset:3072 sc1
v_fmac_f32 v24, v8, v88
v_fmac_f32 v25, v8, v89
v_fmac_f32 v26, v8, v90
v_fmac_f32 v27, v8, v91
v_fmac_f32 v28, v8, v92
v_fmac_f32 v29, v8, v93
v_fmac_f32 v30, v8, v94
v_fmac_f32 v31, v8, v95
v_fmac_f32 v32, v8, v96
v_fmac_f32 v33, v8, v97
v_fmac_f32 v34, v8, v98
v_fmac_f32 v35, v8, v99
v_fmac_f32 v36, v8, v100
v_fmac_f32 v37, v8, v101
v_fmac_f32 v38, v8, v102
v_fmac_f32 v39, v8, v103
v_fmac_f32 v40, v9, v104
v_fmac_f32 v41, v9, v105
v_fmac_f32 v42, v9, v106
v_fmac_f32 v43, v9, v107
v_fmac_f32 v44, v9, v108
v_fmac_f32 v45, v9, v109
v_fmac_f32 v46, v9, v110
v_fmac_f32 v47, v9, v111
v_fmac_f32 v48, v9, v112
v_fmac_f32 v49, v9, v113
v_fmac_f32 v50, v9, v114
v_fmac_f32 v51, v9, v115
v_fmac_f32 v52, v9, v116
v_fmac_f32 v53, v9, v117
v_fmac_f32 v54, v9, v118
v_fmac_f32 v55, v9, v119
s_mov_b32 s92, 200000
L_spin_x:
s_waitcnt vmcnt(0)
v_max3_u32 v168, v152, v153, 0
v_max3_u32 v168, v154, v155, v168
v_max3_u32 v168, v156, v157, v168
v_max3_u32 v168, v158, v159, v168
v_max3_u32 v168, v160, v161, v168
v_max3_u32 v168, v162, v163, v168
v_max3_u32 v168, v164, v165, v168
v_max3_u32 v168, v166, v167, v168
v_cmp_eq_u32 vcc, -1, v168
s_sub_u32 s92, s92, 1
s_cbranch_scc1 L_spun_x
s_nop 3
s_cbranch_vccz L_spun_x
s_sleep 2
buffer_load_dwordx4 v[152:155], v3, s[88:91], s28 offen offset:0 sc1
buffer_load_dwordx4 v[156:159], v3, s[88:91], s28 offen offset:1024 sc1
buffer_load_dwordx4 v[160:163], v3, s[88:91], s28 offen offset:2048 sc1
buffer_load_dwordx4 v[164:167], v3, s[88:91], s28 offen offset:3072 sc1
s_branch L_spin_x
L_spun_x:
v_lshlrev_b32 v168, 16, v152
v_and_b32 v169, 0xffff0000, v152
v_pk_add_f32 v[24:25], v[24:25], v[168:169]
v_lshlrev_b32 v168, 16, v153
v_and_b32 v169, 0xffff0000, v153
v_pk_add_f32 v[26:27], v[26:27], v[168:169]
v_lshlrev_b32 v168, 16, v154
v_and_b32 v169, 0xffff0000, v154
v_pk_add_f32 v[28:29], v[28:29], v[168:169]
v_lshlrev_b32 v168, 16, v155
v_and_b32 v169, 0xffff0000, v155
v_pk_add_f32 v[30:31], v[30:31], v[168:169]
v_cvt_pk_bf16_f32 v24, v24, v25
v_cvt_pk_bf16_f32 v25, v26, v27
v_cvt_pk_bf16_f32 v26, v28, v29
v_cvt_pk_bf16_f32 v27, v30, v31
s_nop 1
v_permlane16_swap_b32 v24, v26
v_permlane16_swap_b32 v25, v27
buffer_store_dwordx4 v[24:27], v17, s[80:83], s29 offen offset:0
v_lshlrev_b32 v168, 16, v156
v_and_b32 v169, 0xffff0000, v156
v_pk_add_f32 v[32:33], v[32:33], v[168:169]
v_lshlrev_b32 v168, 16, v157
v_and_b32 v169, 0xffff0000, v157
v_pk_add_f32 v[34:35], v[34:35], v[168:169]
v_lshlrev_b32 v168, 16, v158
v_and_b32 v169, 0xffff0000, v158
v_pk_add_f32 v[36:37], v[36:37], v[168:169]
v_lshlrev_b32 v168, 16, v159
v_and_b32 v169, 0xffff0000, v159
v_pk_add_f32 v[38:39], v[38:39], v[168:169]
v_cvt_pk_bf16_f32 v32, v32, v33
v_cvt_pk_bf16_f32 v33, v34, v35
v_cvt_pk_bf16_f32 v34, v36, v37
v_cvt_pk_bf16_f32 v35, v38, v39
s_nop 1
v_permlane16_swap_b32 v32, v34
v_permlane16_swap_b32 v33, v35
buffer_store_dwordx4 v[32:35], v17, s[80:83], s29 offen offset:64
v_lshlrev_b32 v168, 16, v160
v_and_b32 v169, 0xffff0000, v160
v_pk_add_f32 v[40:41], v[40:41], v[168:169]
v_lshlrev_b32 v168, 16, v161
v_and_b32 v169, 0xffff0000, v161
v_pk_add_f32 v[42:43], v[42:43], v[168:169]
v_lshlrev_b32 v168, 16, v162
v_and_b32 v169, 0xffff0000, v162
v_pk_add_f32 v[44:45], v[44:45], v[168:169]
v_lshlrev_b32 v168, 16, v163
v_and_b32 v169, 0xffff0000, v163
v_pk_add_f32 v[46:47], v[46:47], v[168:169]
v_cvt_pk_bf16_f32 v40, v40, v41
v_cvt_pk_bf16_f32 v41, v42, v43
v_cvt_pk_bf16_f32 v42, v44, v45
v_cvt_pk_bf16_f32 v43, v46, v47
s_nop 1
v_permlane16_swap_b32 v40, v42
v_permlane16_swap_b32 v41, v43
buffer_store_dwordx4 v[40:43], v17, s[80:83], s31 offen offset:0
v_lshlrev_b32 v168, 16, v164
v_and_b32 v169, 0xffff0000, v164
v_pk_add_f32 v[48:49], v[48:49], v[168:169]
v_lshlrev_b32 v168, 16, v165
v_and_b32 v169, 0xffff0000, v165
v_pk_add_f32 v[50:51], v[50:51], v[168:169]
v_lshlrev_b32 v168, 16, v166
v_and_b32 v169, 0xffff0000, v166
v_pk_add_f32 v[52:53], v[52:53], v[168:169]
v_lshlrev_b32 v168, 16, v167
v_and_b32 v169, 0xffff0000, v167
v_pk_add_f32 v[54:55], v[54:55], v[168:169]
v_cvt_pk_bf16_f32 v48, v48, v49
v_cvt_pk_bf16_f32 v49, v50, v51
v_cvt_pk_bf16_f32 v50, v52, v53
v_cvt_pk_bf16_f32 v51, v54, v55
s_nop 1
v_permlane16_swap_b32 v48, v50
v_permlane16_swap_b32 v49, v51
buffer_store_dwordx4 v[48:51], v17, s[80:83], s31 offen offset:64
L_end:
s_endpgm
L_att_fallback:
s_waitcnt vmcnt(0)
s_mov_b32 s33, 1
s_mul_i32 s32, s5, 0x10c400
s_lshl_b32 s19, s4, 13
s_add_u32 s32, s32, s19
s_cmp_eq_u32 s4, 0
s_cselect_b32 s94, 0x200000, 0
s_add_u32 s32, s32, s94
s_sub_u32 s94, 0x8000, s94
s_add_u32 s7, s32, 0x1000
s_add_u32 s27, s19, 131072
v_and_b32 v5, 15, v0
v_lshrrev_b32 v6, 4, v0
v_lshlrev_b32 v6, 2, v6
v_sub_u32 v5, v5, v6
v_mov_b32 v9, 0xf149f2ca
s_lshr_b32 s8, s20, 11
v_add_u32 v96, s8, v5
v_mov_b32 v80, v9
s_lshr_b32 s8, s21, 11
v_add_u32 v97, s8, v5
v_mov_b32 v84, v9
s_lshr_b32 s8, s22, 11
v_add_u32 v98, s8, v5
v_mov_b32 v88, v9
s_lshr_b32 s8, s23, 11
v_add_u32 v99, s8, v5
v_mov_b32 v92, v9
s_sub_u32 s15, 16, s6
s_lshl_b32 s15, s15, 1
L_fb_loop:
s_waitcnt lgkmcnt(0)
s_barrier
s_add_u32 m0, s19, 0x0
s_nop 0
buffer_load_dwordx4 v3, s[48:51], s32 offen offset:0 sc1 lds
buffer_load_dwordx4 v3, s[48:51], s32 offen offset:1024 sc1 lds
buffer_load_dwordx4 v3, s[48:51], s32 offen offset:2048 sc1 lds
buffer_load_dwordx4 v3, s[48:51], s32 offen offset:3072 sc1 lds
s_add_u32 m0, s19, 0x1000
s_nop 0
buffer_load_dwordx4 v3, s[48:51], s7 offen offset:0 sc1 lds
buffer_load_dwordx4 v3, s[48:51], s7 offen offset:1024 sc1 lds
buffer_load_dwordx4 v3, s[48:51], s7 offen offset:2048 sc1 lds
buffer_load_dwordx4 v3, s[48:51], s7 offen offset:3072 sc1 lds
s_add_u32 s32, s32, s94
s_add_u32 s7, s7, s94
s_mov_b32 s94, 0x8000
s_waitcnt vmcnt(0)
s_barrier
ds_read_b128 a[0:3], v3 offset:8192
ds_read_b128 a[4:7], v3 offset:9216
ds_read_b128 a[8:11], v3 offset:10240
ds_read_b128 a[12:15], v3 offset:11264
ds_read_b128 a[16:19], v3 offset:12288
ds_read_b128 a[20:23], v3 offset:13312
ds_read_b128 a[24:27], v3 offset:14336
ds_read_b128 a[28:31], v3 offset:15360
s_waitcnt lgkmcnt(0)
v_mfma_f32_16x16x32_bf16 v[16:19], a[0:3], a[160:163], 0
v_mfma_f32_16x16x32_bf16 v[16:19], a[4:7], a[164:167], v[16:19]
v_mfma_f32_16x16x32_bf16 v[16:19], a[8:11], a[168:171], v[16:19]
v_mfma_f32_16x16x32_bf16 v[16:19], a[12:15], a[172:175], v[16:19]
v_mfma_f32_16x16x32_bf16 v[20:23], a[0:3], a[176:179], 0
v_mfma_f32_16x16x32_bf16 v[20:23], a[4:7], a[180:183], v[20:23]
v_mfma_f32_16x16x32_bf16 v[20:23], a[8:11], a[184:187], v[20:23]
v_mfma_f32_16x16x32_bf16 v[20:23], a[12:15], a[188:191], v[20:23]
v_mfma_f32_16x16x32_bf16 v[24:27], a[0:3], a[192:195], 0
v_mfma_f32_16x16x32_bf16 v[24:27], a[4:7], a[196:199], v[24:27]
v_mfma_f32_16x16x32_bf16 v[24:27], a[8:11], a[200:203], v[24:27]
v_mfma_f32_16x16x32_bf16 v[24:27], a[12:15], a[204:207], v[24:27]
v_mfma_f32_16x16x32_bf16 v[28:31], a[0:3], a[208:211], 0
v_mfma_f32_16x16x32_bf16 v[28:31], a[4:7], a[212:215], v[28:31]
v_mfma_f32_16x16x32_bf16 v[28:31], a[8:11], a[216:219], v[28:31]
v_mfma_f32_16x16x32_bf16 v[28:31], a[12:15], a[220:223], v[28:31]
v_mfma_f32_16x16x32_bf16 v[32:35], a[16:19], a[160:163], 0
v_mfma_f32_16x16x32_bf16 v[32:35], a[20:23], a[164:167], v[32:35]
v_mfma_f32_16x16x32_bf16 v[32:35], a[24:27], a[168:171], v[32:35]
v_mfma_f32_16x16x32_bf16 v[32:35], a[28:31], a[172:175], v[32:35]
v_mfma_f32_16x16x32_bf16 v[36:39], a[16:19], a[176:179], 0
v_mfma_f32_16x16x32_bf16 v[36:39], a[20:23], a[180:183], v[36:39]
v_mfma_f32_16x16x32_bf16 v[36:39], a[24:27], a[184:187], v[36:39]
v_mfma_f32_16x16x32_bf16 v[36:39], a[28:31], a[188:191], v[36:39]
v_mfma_f32_16x16x32_bf16 v[40:43], a[16:19], a[192:195], 0
v_mfma_f32_16x16x32_bf16 v[40:43], a[20:23], a[196:199], v[40:43]
v_mfma_f32_16x16x32_bf16 v[40:43], a[24:27], a[200:203], v[40:43]
v_mfma_f32_16x16x32_bf16 v[40:43], a[28:31], a[204:207], v[40:43]
v_mfma_f32_16x16x32_bf16 v[44:47], a[16:19], a[208:211], 0
v_mfma_f32_16x16x32_bf16 v[44:47], a[20:23], a[212:215], v[44:47]
v_mfma_f32_16x16x32_bf16 v[44:47], a[24:27], a[216:219], v[44:47]
v_mfma_f32_16x16x32_bf16 v[44:47], a[28:31], a[220:223], v[44:47]
s_nop 7
v_cmp_le_i32 s[36:37], 0, v96
v_cmp_le_i32 s[38:39], 1, v96
v_cmp_le_i32 s[40:41], 2, v96
v_cmp_le_i32 s[42:43], 3, v96
s_nop 1
v_cndmask_b32 v16, v9, v16, s[36:37]
v_cndmask_b32 v17, v9, v17, s[38:39]
v_cndmask_b32 v18, v9, v18, s[40:41]
v_cndmask_b32 v19, v9, v19, s[42:43]
v_max3_f32 v80, v80, v16, v17
v_max3_f32 v80, v80, v18, v19
v_cmp_le_i32 s[36:37], 0, v97
v_cmp_le_i32 s[38:39], 1, v97
v_cmp_le_i32 s[40:41], 2, v97
v_cmp_le_i32 s[42:43], 3, v97
s_nop 1
v_cndmask_b32 v20, v9, v20, s[36:37]
v_cndmask_b32 v21, v9, v21, s[38:39]
v_cndmask_b32 v22, v9, v22, s[40:41]
v_cndmask_b32 v23, v9, v23, s[42:43]
v_max3_f32 v84, v84, v20, v21
v_max3_f32 v84, v84, v22, v23
v_cmp_le_i32 s[36:37], 0, v98
v_cmp_le_i32 s[38:39], 1, v98
v_cmp_le_i32 s[40:41], 2, v98
v_cmp_le_i32 s[42:43], 3, v98
s_nop 1
v_cndmask_b32 v24, v9, v24, s[36:37]
v_cndmask_b32 v25, v9, v25, s[38:39]
v_cndmask_b32 v26, v9, v26, s[40:41]
v_cndmask_b32 v27, v9, v27, s[42:43]
v_max3_f32 v88, v88, v24, v25
v_max3_f32 v88, v88, v26, v27
v_cmp_le_i32 s[36:37], 0, v99
v_cmp_le_i32 s[38:39], 1, v99
v_cmp_le_i32 s[40:41], 2, v99
v_cmp_le_i32 s[42:43], 3, v99
s_nop 1
v_cndmask_b32 v28, v9, v28, s[36:37]
v_cndmask_b32 v29, v9, v29, s[38:39]
v_cndmask_b32 v30, v9, v30, s[40:41]
v_cndmask_b32 v31, v9, v31, s[42:43]
v_max3_f32 v92, v92, v28, v29
v_max3_f32 v92, v92, v30, v31
v_cmp_le_i32 s[36:37], 16, v96
v_cmp_le_i32 s[38:39], 17, v96
v_cmp_le_i32 s[40:41], 18, v96
v_cmp_le_i32 s[42:43], 19, v96
s_nop 1
v_cndmask_b32 v32, v9, v32, s[36:37]
v_cndmask_b32 v33, v9, v33, s[38:39]
v_cndmask_b32 v34, v9, v34, s[40:41]
v_cndmask_b32 v35, v9, v35, s[42:43]
v_max3_f32 v80, v80, v32, v33
v_max3_f32 v80, v80, v34, v35
v_cmp_le_i32 s[36:37], 16, v97
v_cmp_le_i32 s[38:39], 17, v97
v_cmp_le_i32 s[40:41], 18, v97
v_cmp_le_i32 s[42:43], 19, v97
s_nop 1
v_cndmask_b32 v36, v9, v36, s[36:37]
v_cndmask_b32 v37, v9, v37, s[38:39]
v_cndmask_b32 v38, v9, v38, s[40:41]
v_cndmask_b32 v39, v9, v39, s[42:43]
v_max3_f32 v84, v84, v36, v37
v_max3_f32 v84, v84, v38, v39
v_cmp_le_i32 s[36:37], 16, v98
v_cmp_le_i32 s[38:39], 17, v98
v_cmp_le_i32 s[40:41], 18, v98
v_cmp_le_i32 s[42:43], 19, v98
s_nop 1
v_cndmask_b32 v40, v9, v40, s[36:37]
v_cndmask_b32 v41, v9, v41, s[38:39]
v_cndmask_b32 v42, v9, v42, s[40:41]
v_cndmask_b32 v43, v9, v43, s[42:43]
v_max3_f32 v88, v88, v40, v41
v_max3_f32 v88, v88, v42, v43
v_cmp_le_i32 s[36:37], 16, v99
v_cmp_le_i32 s[38:39], 17, v99
v_cmp_le_i32 s[40:41], 18, v99
v_cmp_le_i32 s[42:43], 19, v99
s_nop 1
v_cndmask_b32 v44, v9, v44, s[36:37]
v_cndmask_b32 v45, v9, v45, s[38:39]
v_cndmask_b32 v46, v9, v46, s[40:41]
v_cndmask_b32 v47, v9, v47, s[42:43]
v_max3_f32 v92, v92, v44, v45
v_max3_f32 v92, v92, v46, v47
ds_read_b128 a[0:3], v3 offset:24576
ds_read_b128 a[4:7], v3 offset:25600
ds_read_b128 a[8:11], v3 offset:26624
ds_read_b128 a[12:15], v3 offset:27648
ds_read_b128 a[16:19], v3 offset:28672
ds_read_b128 a[20:23], v3 offset:29696
ds_read_b128 a[24:27], v3 offset:30720
ds_read_b128 a[28:31], v3 offset:31744
s_waitcnt lgkmcnt(0)
v_mfma_f32_16x16x32_bf16 v[16:19], a[0:3], a[160:163], 0
v_mfma_f32_16x16x32_bf16 v[16:19], a[4:7], a[164:167], v[16:19]
v_mfma_f32_16x16x32_bf16 v[16:19], a[8:11], a[168:171], v[16:19]
v_mfma_f32_16x16x32_bf16 v[16:19], a[12:15], a[172:175], v[16:19]
v_mfma_f32_16x16x32_bf16 v[20:23], a[0:3], a[176:179], 0
v_mfma_f32_16x16x32_bf16 v[20:23], a[4:7], a[180:183], v[20:23]
v_mfma_f32_16x16x32_bf16 v[20:23], a[8:11], a[184:187], v[20:23]
v_mfma_f32_16x16x32_bf16 v[20:23], a[12:15], a[188:191], v[20:23]
v_mfma_f32_16x16x32_bf16 v[24:27], a[0:3], a[192:195], 0
v_mfma_f32_16x16x32_bf16 v[24:27], a[4:7], a[196:199], v[24:27]
v_mfma_f32_16x16x32_bf16 v[24:27], a[8:11], a[200:203], v[24:27]
v_mfma_f32_16x16x32_bf16 v[24:27], a[12:15], a[204:207], v[24:27]
v_mfma_f32_16x16x32_bf16 v[28:31], a[0:3], a[208:211], 0
v_mfma_f32_16x16x32_bf16 v[28:31], a[4:7], a[212:215], v[28:31]
v_mfma_f32_16x16x32_bf16 v[28:31], a[8:11], a[216:219], v[28:31]
v_mfma_f32_16x16x32_bf16 v[28:31], a[12:15], a[220:223], v[28:31]
v_mfma_f32_16x16x32_bf16 v[32:35], a[16:19], a[160:163], 0
v_mfma_f32_16x16x32_bf16 v[32:35], a[20:23], a[164:167], v[32:35]
v_mfma_f32_16x16x32_bf16 v[32:35], a[24:27], a[168:171], v[32:35]
v_mfma_f32_16x16x32_bf16 v[32:35], a[28:31], a[172:175], v[32:35]
v_mfma_f32_16x16x32_bf16 v[36:39], a[16:19], a[176:179], 0
v_mfma_f32_16x16x32_bf16 v[36:39], a[20:23], a[180:183], v[36:39]
v_mfma_f32_16x16x32_bf16 v[36:39], a[24:27], a[184:187], v[36:39]
v_mfma_f32_16x16x32_bf16 v[36:39], a[28:31], a[188:191], v[36:39]
v_mfma_f32_16x16x32_bf16 v[40:43], a[16:19], a[192:195], 0
v_mfma_f32_16x16x32_bf16 v[40:43], a[20:23], a[196:199], v[40:43]
v_mfma_f32_16x16x32_bf16 v[40:43], a[24:27], a[200:203], v[40:43]
v_mfma_f32_16x16x32_bf16 v[40:43], a[28:31], a[204:207], v[40:43]
v_mfma_f32_16x16x32_bf16 v[44:47], a[16:19], a[208:211], 0
v_mfma_f32_16x16x32_bf16 v[44:47], a[20:23], a[212:215], v[44:47]
v_mfma_f32_16x16x32_bf16 v[44:47], a[24:27], a[216:219], v[44:47]
v_mfma_f32_16x16x32_bf16 v[44:47], a[28:31], a[220:223], v[44:47]
s_nop 7
v_cmp_le_i32 s[36:37], 32, v96
v_cmp_le_i32 s[38:39], 33, v96
v_cmp_le_i32 s[40:41], 34, v96
v_cmp_le_i32 s[42:43], 35, v96
s_nop 1
v_cndmask_b32 v16, v9, v16, s[36:37]
v_cndmask_b32 v17, v9, v17, s[38:39]
v_cndmask_b32 v18, v9, v18, s[40:41]
v_cndmask_b32 v19, v9, v19, s[42:43]
v_max3_f32 v80, v80, v16, v17
v_max3_f32 v80, v80, v18, v19
v_cmp_le_i32 s[36:37], 32, v97
v_cmp_le_i32 s[38:39], 33, v97
v_cmp_le_i32 s[40:41], 34, v97
v_cmp_le_i32 s[42:43], 35, v97
s_nop 1
v_cndmask_b32 v20, v9, v20, s[36:37]
v_cndmask_b32 v21, v9, v21, s[38:39]
v_cndmask_b32 v22, v9, v22, s[40:41]
v_cndmask_b32 v23, v9, v23, s[42:43]
v_max3_f32 v84, v84, v20, v21
v_max3_f32 v84, v84, v22, v23
v_cmp_le_i32 s[36:37], 32, v98
v_cmp_le_i32 s[38:39], 33, v98
v_cmp_le_i32 s[40:41], 34, v98
v_cmp_le_i32 s[42:43], 35, v98
s_nop 1
v_cndmask_b32 v24, v9, v24, s[36:37]
v_cndmask_b32 v25, v9, v25, s[38:39]
v_cndmask_b32 v26, v9, v26, s[40:41]
v_cndmask_b32 v27, v9, v27, s[42:43]
v_max3_f32 v88, v88, v24, v25
v_max3_f32 v88, v88, v26, v27
v_cmp_le_i32 s[36:37], 32, v99
v_cmp_le_i32 s[38:39], 33, v99
v_cmp_le_i32 s[40:41], 34, v99
v_cmp_le_i32 s[42:43], 35, v99
s_nop 1
v_cndmask_b32 v28, v9, v28, s[36:37]
v_cndmask_b32 v29, v9, v29, s[38:39]
v_cndmask_b32 v30, v9, v30, s[40:41]
v_cndmask_b32 v31, v9, v31, s[42:43]
v_max3_f32 v92, v92, v28, v29
v_max3_f32 v92, v92, v30, v31
v_cmp_le_i32 s[36:37], 48, v96
v_cmp_le_i32 s[38:39], 49, v96
v_cmp_le_i32 s[40:41], 50, v96
v_cmp_le_i32 s[42:43], 51, v96
s_nop 1
v_cndmask_b32 v32, v9, v32, s[36:37]
v_cndmask_b32 v33, v9, v33, s[38:39]
v_cndmask_b32 v34, v9, v34, s[40:41]
v_cndmask_b32 v35, v9, v35, s[42:43]
v_max3_f32 v80, v80, v32, v33
v_max3_f32 v80, v80, v34, v35
v_cmp_le_i32 s[36:37], 48, v97
v_cmp_le_i32 s[38:39], 49, v97
v_cmp_le_i32 s[40:41], 50, v97
v_cmp_le_i32 s[42:43], 51, v97
s_nop 1
v_cndmask_b32 v36, v9, v36, s[36:37]
v_cndmask_b32 v37, v9, v37, s[38:39]
v_cndmask_b32 v38, v9, v38, s[40:41]
v_cndmask_b32 v39, v9, v39, s[42:43]
v_max3_f32 v84, v84, v36, v37
v_max3_f32 v84, v84, v38, v39
v_cmp_le_i32 s[36:37], 48, v98
v_cmp_le_i32 s[38:39], 49, v98
v_cmp_le_i32 s[40:41], 50, v98
v_cmp_le_i32 s[42:43], 51, v98
s_nop 1
v_cndmask_b32 v40, v9, v40, s[36:37]
v_cndmask_b32 v41, v9, v41, s[38:39]
v_cndmask_b32 v42, v9, v42, s[40:41]
v_cndmask_b32 v43, v9, v43, s[42:43]
v_max3_f32 v88, v88, v40, v41
v_max3_f32 v88, v88, v42, v43
v_cmp_le_i32 s[36:37], 48, v99
v_cmp_le_i32 s[38:39], 49, v99
v_cmp_le_i32 s[40:41], 50, v99
v_cmp_le_i32 s[42:43], 51, v99
s_nop 1
v_cndmask_b32 v44, v9, v44, s[36:37]
v_cndmask_b32 v45, v9, v45, s[38:39]
v_cndmask_b32 v46, v9, v46, s[40:41]
v_cndmask_b32 v47, v9, v47, s[42:43]
v_max3_f32 v92, v92, v44, v45
v_max3_f32 v92, v92, v46, v47
v_subrev_u32 v96, 64, v96
v_subrev_u32 v97, 64, v97
v_subrev_u32 v98, 64, v98
v_subrev_u32 v99, 64, v99
s_sub_u32 s15, s15, 1
s_cmp_lg_u32 s15, 0
s_cbranch_scc1 L_fb_loop
v_mov_b32 v16, v80
v_mov_b32 v20, v84
v_mov_b32 v24, v88
v_mov_b32 v28, v92
v_permlane16_swap_b32 v16, v80
v_permlane16_swap_b32 v20, v84
v_permlane16_swap_b32 v24, v88
v_permlane16_swap_b32 v28, v92
v_max_f32 v80, v80, v16
v_max_f32 v84, v84, v20
v_max_f32 v88, v88, v24
v_max_f32 v92, v92, v28
v_mov_b32 v16, v80
v_mov_b32 v20, v84
v_mov_b32 v24, v88
v_mov_b32 v28, v92
v_permlane32_swap_b32 v16, v80
v_permlane32_swap_b32 v20, v84
v_permlane32_swap_b32 v24, v88
v_permlane32_swap_b32 v28, v92
v_max_f32 v80, v80, v16
v_max_f32 v84, v84, v20
v_max_f32 v88, v88, v24
v_max_f32 v92, v92, v28
s_barrier
s_mul_i32 s32, s5, 0x10c400
s_lshl_b32 s19, s4, 13
s_add_u32 s32, s32, s19
s_cmp_eq_u32 s4, 0
s_cselect_b32 s94, 0x200000, 0
s_add_u32 s32, s32, s94
s_sub_u32 s94, 0x8000, s94
s_add_u32 s7, s32, 0x1000
s_add_u32 s27, s19, 131072
s_add_u32 m0, s19, 0x0
s_nop 0
buffer_load_dwordx4 v3, s[48:51], s32 offen offset:0 sc1 lds
buffer_load_dwordx4 v3, s[48:51], s32 offen offset:1024 sc1 lds
buffer_load_dwordx4 v3, s[48:51], s32 offen offset:2048 sc1 lds
buffer_load_dwordx4 v3, s[48:51], s32 offen offset:3072 sc1 lds
s_add_u32 m0, s19, 0x1000
s_nop 0
buffer_load_dwordx4 v3, s[48:51], s7 offen offset:0 sc1 lds
buffer_load_dwordx4 v3, s[48:51], s7 offen offset:1024 sc1 lds
buffer_load_dwordx4 v3, s[48:51], s7 offen offset:2048 sc1 lds
buffer_load_dwordx4 v3, s[48:51], s7 offen offset:3072 sc1 lds
s_add_u32 s32, s32, s94
s_add_u32 s7, s7, s94
s_add_u32 m0, s19, 0x18000
s_nop 0
buffer_load_dwordx4 v3, s[48:51], s32 offen offset:0 sc1 lds
buffer_load_dwordx4 v3, s[48:51], s32 offen offset:1024 sc1 lds
buffer_load_dwordx4 v3, s[48:51], s32 offen offset:2048 sc1 lds
buffer_load_dwordx4 v3, s[48:51], s32 offen offset:3072 sc1 lds
s_add_u32 m0, s19, 0x19000
s_nop 0
buffer_load_dwordx4 v3, s[48:51], s7 offen offset:0 sc1 lds
buffer_load_dwordx4 v3, s[48:51], s7 offen offset:1024 sc1 lds
buffer_load_dwordx4 v3, s[48:51], s7 offen offset:2048 sc1 lds
buffer_load_dwordx4 v3, s[48:51], s7 offen offset:3072 sc1 lds
s_add_u32 s32, s32, 0x8000
s_add_u32 s7, s7, 0x8000
s_add_u32 m0, s19, 0x8000
s_nop 0
buffer_load_dwordx4 v3, s[48:51], s32 offen offset:0 sc1 lds
buffer_load_dwordx4 v3, s[48:51], s32 offen offset:1024 sc1 lds
buffer_load_dwordx4 v3, s[48:51], s32 offen offset:2048 sc1 lds
buffer_load_dwordx4 v3, s[48:51], s32 offen offset:3072 sc1 lds
s_add_u32 m0, s19, 0x9000
s_nop 0
buffer_load_dwordx4 v3, s[48:51], s7 offen offset:0 sc1 lds
buffer_load_dwordx4 v3, s[48:51], s7 offen offset:1024 sc1 lds
buffer_load_dwordx4 v3, s[48:51], s7 offen offset:2048 sc1 lds
buffer_load_dwordx4 v3, s[48:51], s7 offen offset:3072 sc1 lds
s_add_u32 s32, s32, 0x8000
s_add_u32 s7, s7, 0x8000
s_bfe_u32 s99, s2, 0x20001
s_lshl_b32 s99, s99, 2
s_lshr_b32 s8, s2, 6
s_add_u32 s99, s99, s8
s_bfe_u32 s100, s2, 0x30003
s_and_b32 s14, s2, 1
s_sub_u32 s24, 15, s99
s_min_u32 s18, s24, s99
s_lshl_b32 s24, s18, 1
s_add_u32 s24, s24, s14
s_lshl_b32 s24, s24, 8
s_add_u32 s24, s24, 0x3704000
s_mov_b32 s12, 14336
s_and_b32 s16, s6, 1
s_lshl_b32 s16, s16, 15
s_add_u32 s16, s16, 98304
s_add_u32 s16, s16, s17
s_lshl_b32 s13, s4, 15
s_lshl_b32 s9, s100, 8
s_add_u32 s13, s13, s9
s_mul_i32 s9, s14, 0x100080
s_add_u32 s13, s13, s9
s_mul_i32 s25, s14, 0x300000
s_sub_u32 s25, s25, 917504
s_mul_i32 s101, s99, 0x142400
s_lshl_b32 s8, s4, 11
s_add_u32 s101, s101, s8
s_lshl_b32 s8, s14, 17
s_add_u32 s101, s101, s8
s_add_u32 s101, s101, 0x21fe000
s_mul_i32 s26, s14, 393216
s_add_u32 s26, s26, 139264
v_mov_b32 v15, s6
v_writelane_b32 v15, s18, 0
v_lshlrev_b32 v15, 2, v15
v_bfe_u32 v12, v0, 2, 2
v_lshlrev_b32 v12, 11, v12
v_lshrrev_b32 v13, 4, v0
v_lshl_add_u32 v12, v13, 6, v12
v_and_b32 v13, 3, v0
v_lshl_add_u32 v12, v13, 4, v12
v_xor_b32 v12, s13, v12
v_xor_b32 v13, 32, v12
v_add_u32 v13, 7168, v13
s_mov_b32 s11, 0xf149f2ca
s_mov_b32 s36, 0xfff0ffff
s_mov_b32 s37, 0xf000ff00
s_mov_b32 s38, 0xffe0fffe
s_mov_b32 s39, 0xe000fe00
s_mov_b32 s40, 0xffc0fffc
s_mov_b32 s41, 0xc000fc00
s_mov_b32 s42, 0xff80fff8
s_mov_b32 s43, 0x8000f800
s_bitcmp1_b32 s4, 0
s_cselect_b32 s8, 0x7f800000, s11
s_cselect_b32 s9, s11, 0x7f800000
v_mov_b32 v1, v3
v_add_u32 v2, 98304, v3
s_mov_b64 s[34:35], 0
v_accvgpr_write_b32 a224, 0
v_accvgpr_write_b32 a225, 0
v_accvgpr_write_b32 a226, 0
v_accvgpr_write_b32 a227, 0
v_accvgpr_write_b32 a228, 0
v_accvgpr_write_b32 a229, 0
v_accvgpr_write_b32 a230, 0
v_accvgpr_write_b32 a231, 0
v_sub_f32 v83, 0, v80
v_sub_f32 v82, 0, v80
v_sub_f32 v81, 0, v80
v_sub_f32 v80, 0, v80
v_min_f32 v103, s8, v80
v_cndmask_b32 v96, v103, v80, s[36:37]
v_cndmask_b32 v97, v103, v80, s[38:39]
v_cndmask_b32 v98, v103, v80, s[40:41]
v_cndmask_b32 v99, v103, v80, s[42:43]
v_cndmask_b32 v100, v9, v103, s[36:37]
v_cndmask_b32 v101, v9, v103, s[38:39]
v_cndmask_b32 v102, v9, v103, s[40:41]
v_cndmask_b32 v103, v9, v103, s[42:43]
v_sub_f32 v87, 0, v84
v_sub_f32 v86, 0, v84
v_sub_f32 v85, 0, v84
v_sub_f32 v84, 0, v84
v_min_f32 v111, s9, v84
v_cndmask_b32 v104, v111, v84, s[36:37]
v_cndmask_b32 v105, v111, v84, s[38:39]
v_cndmask_b32 v106, v111, v84, s[40:41]
v_cndmask_b32 v107, v111, v84, s[42:43]
v_cndmask_b32 v108, v9, v111, s[36:37]
v_cndmask_b32 v109, v9, v111, s[38:39]
v_cndmask_b32 v110, v9, v111, s[40:41]
v_cndmask_b32 v111, v9, v111, s[42:43]
v_sub_f32 v91, 0, v88
v_sub_f32 v90, 0, v88
v_sub_f32 v89, 0, v88
v_sub_f32 v88, 0, v88
v_min_f32 v119, s8, v88
v_cndmask_b32 v112, v119, v88, s[36:37]
v_cndmask_b32 v113, v119, v88, s[38:39]
v_cndmask_b32 v114, v119, v88, s[40:41]
v_cndmask_b32 v115, v119, v88, s[42:43]
v_cndmask_b32 v116, v9, v119, s[36:37]
v_cndmask_b32 v117, v9, v119, s[38:39]
v_cndmask_b32 v118, v9, v119, s[40:41]
v_cndmask_b32 v119, v9, v119, s[42:43]
v_sub_f32 v95, 0, v92
v_sub_f32 v94, 0, v92
v_sub_f32 v93, 0, v92
v_sub_f32 v92, 0, v92
v_min_f32 v127, s9, v92
v_cndmask_b32 v120, v127, v92, s[36:37]
v_cndmask_b32 v121, v127, v92, s[38:39]
v_cndmask_b32 v122, v127, v92, s[40:41]
v_cndmask_b32 v123, v127, v92, s[42:43]
v_cndmask_b32 v124, v9, v127, s[36:37]
v_cndmask_b32 v125, v9, v127, s[38:39]
v_cndmask_b32 v126, v9, v127, s[40:41]
v_cndmask_b32 v127, v9, v127, s[42:43]
v_and_b32 v9, 1, v0
v_mul_u32_u24 v9, 0xaaaa, v9
v_add_u32 v9, 0x4444, v9
v_mov_b32 v128, 0
v_mov_b32 v129, 0
v_mov_b32 v130, 0
v_mov_b32 v131, 0
v_mov_b32 v132, 0
v_mov_b32 v133, 0
v_mov_b32 v134, 0
v_mov_b32 v135, 0
v_mov_b32 v136, 0
v_mov_b32 v137, 0
v_mov_b32 v138, 0
v_mov_b32 v139, 0
v_mov_b32 v140, 0
v_mov_b32 v141, 0
v_mov_b32 v142, 0
v_mov_b32 v143, 0
v_mov_b32 v144, 0
v_mov_b32 v145, 0
v_mov_b32 v146, 0
v_mov_b32 v147, 0
v_mov_b32 v148, 0
v_mov_b32 v149, 0
v_mov_b32 v150, 0
v_mov_b32 v151, 0
v_mov_b32 v152, 0
v_mov_b32 v153, 0
v_mov_b32 v154, 0
v_mov_b32 v155, 0
v_mov_b32 v156, 0
v_mov_b32 v157, 0
v_mov_b32 v158, 0
v_mov_b32 v159, 0
v_mov_b32 v160, 0
v_mov_b32 v161, 0
v_mov_b32 v162, 0
v_mov_b32 v163, 0
v_mov_b32 v164, 0
v_mov_b32 v165, 0
v_mov_b32 v166, 0
v_mov_b32 v167, 0
v_mov_b32 v168, 0
v_mov_b32 v169, 0
v_mov_b32 v170, 0
v_mov_b32 v171, 0
v_mov_b32 v172, 0
v_mov_b32 v173, 0
v_mov_b32 v174, 0
v_mov_b32 v175, 0
v_mov_b32 v176, 0
v_mov_b32 v177, 0
v_mov_b32 v178, 0
v_mov_b32 v179, 0
v_mov_b32 v180, 0
v_mov_b32 v181, 0
v_mov_b32 v182, 0
v_mov_b32 v183, 0
v_mov_b32 v184, 0
v_mov_b32 v185, 0
v_mov_b32 v186, 0
v_mov_b32 v187, 0
v_mov_b32 v188, 0
v_mov_b32 v189, 0
v_mov_b32 v190, 0
v_mov_b32 v191, 0
v_mov_b32 v192, 0
v_mov_b32 v193, 0
v_mov_b32 v194, 0
v_mov_b32 v195, 0
v_mov_b32 v196, 0
v_mov_b32 v197, 0
v_mov_b32 v198, 0
v_mov_b32 v199, 0
v_mov_b32 v200, 0
v_mov_b32 v201, 0
v_mov_b32 v202, 0
v_mov_b32 v203, 0
v_mov_b32 v204, 0
v_mov_b32 v205, 0
v_mov_b32 v206, 0
v_mov_b32 v207, 0
v_mov_b32 v208, 0
v_mov_b32 v209, 0
v_mov_b32 v210, 0
v_mov_b32 v211, 0
v_mov_b32 v212, 0
v_mov_b32 v213, 0
v_mov_b32 v214, 0
v_mov_b32 v215, 0
v_mov_b32 v216, 0
v_mov_b32 v217, 0
v_mov_b32 v218, 0
v_mov_b32 v219, 0
v_mov_b32 v220, 0
v_mov_b32 v221, 0
v_mov_b32 v222, 0
v_mov_b32 v223, 0
v_mov_b32 v224, 0
v_mov_b32 v225, 0
v_mov_b32 v226, 0
v_mov_b32 v227, 0
v_mov_b32 v228, 0
v_mov_b32 v229, 0
v_mov_b32 v230, 0
v_mov_b32 v231, 0
v_mov_b32 v232, 0
v_mov_b32 v233, 0
v_mov_b32 v234, 0
v_mov_b32 v235, 0
v_mov_b32 v236, 0
v_mov_b32 v237, 0
v_mov_b32 v238, 0
v_mov_b32 v239, 0
v_mov_b32 v240, 0
v_mov_b32 v241, 0
v_mov_b32 v242, 0
v_mov_b32 v243, 0
v_mov_b32 v244, 0
v_mov_b32 v245, 0
v_mov_b32 v246, 0
v_mov_b32 v247, 0
v_mov_b32 v248, 0
v_mov_b32 v249, 0
v_mov_b32 v250, 0
v_mov_b32 v251, 0
v_mov_b32 v252, 0
v_mov_b32 v253, 0
v_mov_b32 v254, 0
v_mov_b32 v255, 0
s_waitcnt vmcnt(16)
s_barrier
ds_read_b128 a[0:3], v1 offset:8192
ds_read_b128 a[4:7], v1 offset:9216
ds_read_b128 a[8:11], v1 offset:10240
ds_read_b128 a[12:15], v1 offset:11264
ds_read_b128 a[16:19], v1 offset:12288
ds_read_b128 a[20:23], v1 offset:13312
ds_read_b128 a[24:27], v1 offset:14336
ds_read_b128 a[28:31], v1 offset:15360
s_waitcnt lgkmcnt(0)
s_branch L_att_start
.section .rodata,"a"
.p2align 6
.amdhsa_kernel gated_mix__compressed_kv_cla__sliding_local_dilated__prompt_kernel
  .amdhsa_next_free_vgpr 512
  .amdhsa_next_free_sgpr 102
  .amdhsa_accum_offset 256
  .amdhsa_group_segment_fixed_size 0
  .amdhsa_kernarg_size 104
  .amdhsa_user_sgpr_count 2
  .amdhsa_user_sgpr_kernarg_segment_ptr 1
  .amdhsa_system_sgpr_workgroup_id_x 1
.end_amdhsa_kernel
```

```asm
; @launch grid=(256,1,1) block=(256,1,1) lds=163840
.amdgcn_target "amdgcn-amd-amdhsa--gfx950"
.text
.globl gated_mix__compressed_kv_cla__sliding_local_dilated__prompt_kernel
.p2align 8
.type gated_mix__compressed_kv_cla__sliding_local_dilated__prompt_kernel,@function
gated_mix__compressed_kv_cla__sliding_local_dilated__prompt_kernel:
s_load_dwordx16 s[16:31], s[0:1], 0
s_load_dwordx8 s[32:39], s[0:1], 64
s_load_dwordx2 s[88:89], s[0:1], 96
s_cmp_ge_u32 s2, 256
s_cbranch_scc1 L_end
v_lshrrev_b32 v1, 6, v0
v_and_b32 v0, 63, v0
v_readfirstlane_b32 s4, v1
v_lshlrev_b32 v16, 4, v0
s_lshr_b32 s8, s2, 3
s_lshl_b32 s8, s8, 2
s_add_u32 s8, s8, s4
s_min_u32 s8, s8, 101
s_lshl_b32 s8, s8, 10
s_getpc_b64 s[92:93]
L_here:
s_add_u32 s8, s8, L_page0-L_here
s_add_u32 s92, s92, s8
s_addc_u32 s93, s93, 0
v_add_u32 v60, s92, v16
v_mov_b32 v61, s93
global_load_dword a120, v[60:61], off sc1
s_and_b32 s5, s2, 7
s_lshl_b32 s5, s5, 2
s_bfe_u32 s3, s2, 0x20003
s_add_u32 s5, s5, s3
s_lshr_b32 s6, s2, 5
s_mov_b32 s12, 0x4000
s_mov_b32 s13, 0x8000
s_mov_b32 s14, 0xc000
s_mov_b32 s46, 0x400000
s_mov_b32 s47, 0x20000
s_mov_b32 s50, 0x200000
s_mov_b32 s51, 0x20000
s_mov_b32 s54, 0x800000
s_mov_b32 s55, 0x20000
s_mov_b32 s58, 0x400000
s_mov_b32 s59, 0x20000
s_mov_b32 s62, 0x400000
s_mov_b32 s63, 0x20000
s_mov_b32 s66, 0x800000
s_mov_b32 s67, 0x20000
s_mov_b32 s70, 0x600000
s_mov_b32 s71, 0x20000
s_mov_b32 s74, 0x200000
s_mov_b32 s75, 0x20000
s_mov_b32 s78, 0x800
s_mov_b32 s79, 0x20000
s_mov_b32 s82, 0x400000
s_mov_b32 s83, 0x20000
s_mov_b32 s86, 0x100
s_mov_b32 s87, 0x20000
s_mov_b32 s90, 0x10000000
s_mov_b32 s91, 0x20000
v_bfe_u32 v17, v0, 2, 2
s_lshl_b32 s8, s4, 4
v_add_u32 v17, s8, v17
v_lshlrev_b32 v17, 13, v17
v_lshrrev_b32 v18, 4, v0
v_lshl_add_u32 v17, v18, 6, v17
v_and_b32 v18, 3, v0
v_lshl_add_u32 v17, v18, 4, v17
s_lshl_b32 s8, s5, 8
v_add_u32 v5, s8, v17
v_xor_b32 v6, 32, v5
v_add_u32 v6, 0x10000, v6
v_lshrrev_b32 v17, 4, v0
v_xor_b32 v17, v17, v0
v_and_b32 v17, 7, v17
v_lshlrev_b32 v17, 4, v17
v_lshrrev_b32 v18, 3, v0
v_lshl_add_u32 v2, v18, 10, v17
s_lshl_b32 s8, s6, 18
s_lshl_b32 s9, s4, 16
s_add_u32 s8, s8, s9
v_add_u32 v2, s8, v2
v_xor_b32 v3, 64, v2
v_add_u32 v3, 0x2000, v3
s_mov_b32 s41, 0
s_mov_b32 s43, 0
v_lshl_add_u32 v5, s41, 19, v5
v_lshl_add_u32 v6, s41, 19, v6
v_lshl_add_u32 v2, s41, 7, v2
v_lshl_add_u32 v3, s41, 7, v3
s_sub_u32 s10, 15, s6
s_cmp_lt_u32 s5, 16
s_cselect_b32 s10, s6, s10
s_lshl_b32 s10, s10, 4
s_and_b32 s11, s5, 15
s_add_u32 s10, s10, s11
s_lshl_b32 s10, s10, 3
s_lshl_b32 s11, s4, 1
s_add_u32 s10, s10, s11
s_lshl_b32 s100, s10, 11
s_lshl_b32 s101, s10, 2
s_add_u32 s101, s101, 0x3700000
s_lshl_b32 s8, s2, 2
s_add_u32 s8, s8, s4
s_lshl_b32 s8, s8, 11
v_lshrrev_b32 v19, 2, v0
v_lshl_add_u32 v19, v19, 7, s8
s_lshr_b32 s8, s2, 3
s_lshl_b32 s8, s8, 2
s_add_u32 s8, s8, s4
s_lshl_b32 s8, s8, 4
s_and_b32 s9, s2, 7
s_add_u32 s8, s8, s9
s_lshl_b32 s8, s8, 10
v_bfe_u32 v63, v0, 2, 3
v_lshl_add_u32 v63, v63, 7, s8
v_lshrrev_b32 v59, 5, v0
v_lshl_add_u32 v63, v59, 13, v63
v_mov_b32 v62, v19
s_waitcnt lgkmcnt(0)
s_mov_b64 s[48:49], s[18:19]
s_mov_b64 s[56:57], s[22:23]
s_mov_b64 s[60:61], s[24:25]
L_args:
s_mov_b64 s[0:1], s[92:93]
s_mov_b64 s[44:45], s[16:17]
s_mov_b64 s[76:77], s[34:35]
s_mov_b64 s[52:53], s[20:21]
s_mov_b64 s[64:65], s[26:27]
s_mov_b64 s[68:69], s[30:31]
s_mov_b64 s[72:73], s[32:33]
s_mov_b64 s[80:81], s[36:37]
s_mov_b64 s[84:85], s[38:39]
s_lshl_b32 s16, s4, 13
s_add_u32 s16, s16, 0x18000
s_lshl_b32 s17, s4, 12
s_lshl_b32 s18, s4, 10
s_mov_b32 s25, 0x800
s_mov_b32 s26, 0x1000
s_mov_b32 s3, 0
s_mov_b32 s9, 0x0
s_nop 0
buffer_load_dword a120, v63, s[56:59], s9 offen
s_mov_b32 s9, 0x0
s_nop 0
buffer_load_dword a120, v63, s[60:63], s9 offen
s_add_u32 m0, s17, 0x0
s_nop 0
buffer_load_dwordx4 v5, s[56:59], 0 offen lds
s_add_u32 m0, s17, 0x4000
s_nop 0
buffer_load_dwordx4 v5, s[60:63], 0 offen lds
s_add_u32 m0, s17, 0x400
s_nop 0
buffer_load_dwordx4 v5, s[56:59], s13 offen lds
s_add_u32 m0, s17, 0x4400
s_nop 0
buffer_load_dwordx4 v5, s[60:63], s13 offen lds
s_add_u32 m0, s17, 0x800
s_nop 0
buffer_load_dwordx4 v6, s[56:59], 0 offen lds
s_add_u32 m0, s17, 0x4800
s_nop 0
buffer_load_dwordx4 v6, s[60:63], 0 offen lds
s_add_u32 m0, s17, 0xc00
s_nop 0
buffer_load_dwordx4 v6, s[56:59], s13 offen lds
s_add_u32 m0, s17, 0x4c00
s_nop 0
buffer_load_dwordx4 v6, s[60:63], s13 offen lds
s_mov_b32 s42, 1
s_mov_b32 s41, 7
v_lshl_add_u32 v5, s42, 19, v5
v_lshl_add_u32 v6, s42, 19, v6
s_add_u32 m0, s16, 0x0
s_nop 0
buffer_load_dwordx4 v2, s[48:51], 0 offen lds
s_add_u32 m0, s16, 0x400
s_nop 0
buffer_load_dwordx4 v3, s[48:51], 0 offen lds
s_add_u32 m0, s16, 0x800
s_nop 0
buffer_load_dwordx4 v2, s[48:51], s12 offen lds
s_add_u32 m0, s16, 0xc00
s_nop 0
buffer_load_dwordx4 v3, s[48:51], s12 offen lds
s_add_u32 m0, s16, 0x1000
s_nop 0
buffer_load_dwordx4 v2, s[48:51], s13 offen lds
s_add_u32 m0, s16, 0x1400
s_nop 0
buffer_load_dwordx4 v3, s[48:51], s13 offen lds
s_add_u32 m0, s16, 0x1800
s_nop 0
buffer_load_dwordx4 v2, s[48:51], s14 offen lds
s_add_u32 m0, s16, 0x1c00
s_nop 0
buffer_load_dwordx4 v3, s[48:51], s14 offen lds
v_lshl_add_u32 v2, s42, 7, v2
v_lshl_add_u32 v3, s42, 7, v3
L_hopA:
s_mov_b32 s95, 1
s_cmp_eq_u32 s4, 0
s_cbranch_scc1 L_padA0
s_cmp_eq_u32 s4, 1
s_cbranch_scc1 L_padA1
s_cmp_eq_u32 s4, 2
s_cbranch_scc1 L_padA2
s_branch L_padA3
L_hopA_ret:
s_mov_b32 s95, 0
v_lshrrev_b32 v17, 4, v0
v_xor_b32 v17, v17, v0
v_and_b32 v17, 7, v17
v_lshlrev_b32 v17, 4, v17
v_lshrrev_b32 v18, 3, v0
v_lshl_add_u32 v22, v18, 11, v17
v_xor_b32 v23, 64, v22
v_add_u32 v23, 0x4000, v23
s_lshl_b32 s8, s6, 18
s_sub_u32 s9, 15, s6
s_lshl_b32 s9, s9, 18
s_lshl_b32 s10, s4, 15
s_sub_u32 s11, 0x38000, s10
s_add_u32 s20, s8, s10
s_add_u32 s21, s8, s11
s_add_u32 s22, s9, s10
s_add_u32 s23, s9, s11
s_lshl_b32 s10, s5, 15
s_add_u32 s10, s10, 0x3c00000
s_lshr_b32 s8, s8, 7
s_lshr_b32 s9, s9, 7
s_add_u32 s8, s8, s10
s_add_u32 s9, s9, s10
v_add_u32 v10, s8, v16
v_add_u32 v11, s9, v16
s_cmp_lt_u32 s4, 2
s_cselect_b32 s8, s8, s9
s_and_b32 s9, s4, 1
s_lshl_b32 s9, s9, 10
s_add_u32 s8, s8, s9
v_add_u32 v4, s8, v16
v_lshrrev_b32 v17, 2, v0
s_lshl_b32 s8, s4, 4
v_add_u32 v17, s8, v17
v_mul_u32_u24 v17, 0x1800, v17
v_and_b32 v18, 3, v0
v_lshlrev_b32 v18, 4, v18
v_and_b32 v19, 32, v0
v_xor_b32 v18, v18, v19
s_lshl_b32 s8, s5, 6
v_add3_u32 v7, v17, v18, s8
v_lshl_add_u32 v22, s43, 7, v22
v_lshl_add_u32 v23, s43, 7, v23
v_lshl_add_u32 v7, s43, 18, v7
v_lshl_add_u32 v7, s43, 17, v7
v_and_b32 v17, 15, v0
v_lshrrev_b32 v18, 1, v17
v_lshrrev_b32 v19, 4, v0
v_xor_b32 v18, v18, v19
v_lshlrev_b32 v18, 4, v18
v_lshl_add_u32 v8, v17, 7, v18
v_add_u32 v8, s16, v8
v_xor_b32 v9, 64, v8
v_lshrrev_b32 v17, 4, v0
v_lshlrev_b32 v18, 11, v17
v_and_b32 v17, 1, v17
v_lshl_add_u32 v18, v17, 5, v18
v_bfe_u32 v17, v0, 2, 2
v_lshl_add_u32 v18, v17, 6, v18
v_and_b32 v17, 3, v0
v_lshl_add_u32 v12, v17, 3, v18
v_xor_b32 v13, 32, v12
v_lshrrev_b32 v17, 4, v0
v_lshlrev_b32 v18, 9, v17
v_and_b32 v17, 1, v17
v_lshl_add_u32 v18, v17, 5, v18
v_bfe_u32 v17, v0, 2, 2
v_lshl_add_u32 v18, v17, 6, v18
v_and_b32 v17, 3, v0
v_lshl_add_u32 v14, v17, 3, v18
v_accvgpr_write_b32 a64, -1
v_accvgpr_write_b32 a65, -1
v_accvgpr_write_b32 a66, -1
v_accvgpr_write_b32 a67, -1
v_add_u32 v14, 81920, v14
v_xor_b32 v15, 32, v14
s_mul_i32 s32, s5, 0x10c400
s_lshl_b32 s19, s4, 13
s_add_u32 s32, s32, s19
s_cmp_eq_u32 s4, 0
s_cselect_b32 s94, 0x200000, 0
s_add_u32 s32, s32, s94
s_sub_u32 s94, 0x8000, s94
s_add_u32 s7, s32, 0x1000
s_add_u32 s27, s19, 131072
s_add_u32 m0, s16, 0x8000
s_nop 0
buffer_load_dwordx4 v2, s[48:51], 0 offen lds
s_add_u32 m0, s16, 0x8400
s_nop 0
buffer_load_dwordx4 v3, s[48:51], 0 offen lds
s_add_u32 m0, s16, 0x8800
s_nop 0
buffer_load_dwordx4 v2, s[48:51], s12 offen lds
s_add_u32 m0, s16, 0x8c00
s_nop 0
buffer_load_dwordx4 v3, s[48:51], s12 offen lds
s_add_u32 m0, s16, 0x9000
s_nop 0
buffer_load_dwordx4 v2, s[48:51], s13 offen lds
s_add_u32 m0, s16, 0x9400
s_nop 0
buffer_load_dwordx4 v3, s[48:51], s13 offen lds
s_add_u32 m0, s16, 0x9800
s_nop 0
buffer_load_dwordx4 v2, s[48:51], s14 offen lds
s_add_u32 m0, s16, 0x9c00
s_nop 0
buffer_load_dwordx4 v3, s[48:51], s14 offen lds
v_lshl_add_u32 v2, s42, 7, v2
v_lshl_add_u32 v3, s42, 7, v3
s_mov_b32 s9, 0x0
s_nop 0
buffer_load_dword a120, v62, s[48:51], s9 offen
v_mov_b32 v19, v62
v_mov_b32 v18, v63
s_cmp_lg_u32 s4, 0
s_cbranch_scc1 L_flag_clr
s_lshl_b32 s8, s6, 5
s_add_u32 s8, s8, s5
s_and_b32 s92, s8, 0xf0
s_mul_i32 s92, s92, 3
s_add_u32 s8, s8, s92
s_lshl_b32 s8, s8, 2
s_add_u32 s8, s8, 0x3704000
v_mov_b32 v17, 0
s_mov_b64 exec, 1
buffer_store_dword v17, off, s[88:91], s8 sc1
s_mov_b64 exec, -1
L_flag_clr:
s_waitcnt vmcnt(9)
s_barrier
s_branch L_main
.p2align 12
L_page0:
L_padA0:
s_branch L_padA4
L_main:
ds_read_b64_tr_b16 a[80:81], v12 offset:0
ds_read_b64_tr_b16 a[82:83], v12 offset:1024
ds_read_b64_tr_b16 a[84:85], v12 offset:8192
ds_read_b64_tr_b16 a[86:87], v12 offset:9216
ds_read_b128 a[0:3], v8 offset:0
ds_read_b128 a[16:19], v9 offset:0
ds_read_b128 a[4:7], v8 offset:2048
ds_read_b128 a[20:23], v9 offset:2048
ds_read_b128 a[8:11], v8 offset:4096
ds_read_b128 a[24:27], v9 offset:4096
ds_read_b128 a[12:15], v8 offset:6144
ds_read_b128 a[28:31], v9 offset:6144
ds_read_b64_tr_b16 a[88:89], v13 offset:0
ds_read_b64_tr_b16 a[90:91], v13 offset:1024
ds_read_b64_tr_b16 a[92:93], v13 offset:8192
ds_read_b64_tr_b16 a[94:95], v13 offset:9216
ds_read_b64_tr_b16 a[96:97], v12 offset:256
ds_read_b64_tr_b16 a[98:99], v12 offset:1280
ds_read_b64_tr_b16 a[100:101], v12 offset:8448
ds_read_b64_tr_b16 a[102:103], v12 offset:9472
s_waitcnt lgkmcnt(0)
L_S0:
v_mfma_f32_16x16x32_bf16 v[24:27], a[80:83], a[0:3], 0
ds_read_b64_tr_b16 a[104:105], v13 offset:256
s_add_u32 m0, s17, 0x8000
v_mfma_f32_16x16x32_bf16 v[24:27], a[84:87], a[16:19], v[24:27]
buffer_load_dwordx4 v5, s[56:59], 0 offen lds
v_mfma_f32_16x16x32_bf16 v[32:35], a[84:87], a[20:23], 0
ds_read_b64_tr_b16 a[106:107], v13 offset:1280
v_mfma_f32_16x16x32_bf16 v[32:35], a[80:83], a[4:7], v[32:35]
ds_read_b64_tr_b16 a[108:109], v13 offset:8448
v_mfma_f32_16x16x32_bf16 v[40:43], a[80:83], a[8:11], 0
ds_read_b64_tr_b16 a[110:111], v13 offset:9472
v_mfma_f32_16x16x32_bf16 v[40:43], a[84:87], a[24:27], v[40:43]
s_add_u32 m0, s17, 0xc000
v_mfma_f32_16x16x32_bf16 v[48:51], a[84:87], a[28:31], 0
buffer_load_dwordx4 v5, s[60:63], 0 offen lds
v_mfma_f32_16x16x32_bf16 v[48:51], a[80:83], a[12:15], v[48:51]
v_mfma_f32_16x16x32_bf16 v[52:55], a[88:91], a[12:15], 0
ds_read_b64_tr_b16 a[80:81], v12 offset:512
v_mfma_f32_16x16x32_bf16 v[52:55], a[92:95], a[28:31], v[52:55]
ds_read_b64_tr_b16 a[82:83], v12 offset:1536
v_mfma_f32_16x16x32_bf16 v[44:47], a[92:95], a[24:27], 0
ds_read_b64_tr_b16 a[84:85], v12 offset:8704
s_add_u32 m0, s17, 0x8400
v_mfma_f32_16x16x32_bf16 v[44:47], a[88:91], a[8:11], v[44:47]
buffer_load_dwordx4 v5, s[56:59], s13 offen lds
v_mfma_f32_16x16x32_bf16 v[36:39], a[88:91], a[4:7], 0
ds_read_b64_tr_b16 a[86:87], v12 offset:9728
v_mfma_f32_16x16x32_bf16 v[36:39], a[92:95], a[20:23], v[36:39]
v_mfma_f32_16x16x32_bf16 v[28:31], a[92:95], a[16:19], 0
v_mfma_f32_16x16x32_bf16 v[28:31], a[88:91], a[0:3], v[28:31]
s_add_u32 m0, s17, 0xc400
v_mfma_f32_16x16x32_bf16 v[56:59], a[96:99], a[0:3], 0
buffer_load_dwordx4 v5, s[60:63], s13 offen lds
v_mfma_f32_16x16x32_bf16 v[56:59], a[100:103], a[16:19], v[56:59]
ds_read_b64_tr_b16 a[88:89], v13 offset:512
v_mfma_f32_16x16x32_bf16 v[64:67], a[100:103], a[20:23], 0
ds_read_b64_tr_b16 a[90:91], v13 offset:1536
v_mfma_f32_16x16x32_bf16 v[64:67], a[96:99], a[4:7], v[64:67]
ds_read_b64_tr_b16 a[92:93], v13 offset:8704
v_mfma_f32_16x16x32_bf16 v[72:75], a[96:99], a[8:11], 0
ds_read_b64_tr_b16 a[94:95], v13 offset:9728
s_add_u32 m0, s17, 0x8800
v_mfma_f32_16x16x32_bf16 v[72:75], a[100:103], a[24:27], v[72:75]
buffer_load_dwordx4 v6, s[56:59], 0 offen lds
v_mfma_f32_16x16x32_bf16 v[80:83], a[100:103], a[28:31], 0
v_mfma_f32_16x16x32_bf16 v[80:83], a[96:99], a[12:15], v[80:83]
s_waitcnt lgkmcnt(10)
v_mfma_f32_16x16x32_bf16 v[84:87], a[104:107], a[12:15], 0
ds_read_b64_tr_b16 a[96:97], v12 offset:768
s_waitcnt lgkmcnt(9)
v_mfma_f32_16x16x32_bf16 v[84:87], a[108:111], a[28:31], v[84:87]
ds_read_b64_tr_b16 a[98:99], v12 offset:1792
s_add_u32 m0, s17, 0xc800
v_mfma_f32_16x16x32_bf16 v[76:79], a[108:111], a[24:27], 0
buffer_load_dwordx4 v6, s[60:63], 0 offen lds
v_mfma_f32_16x16x32_bf16 v[76:79], a[104:107], a[8:11], v[76:79]
ds_read_b64_tr_b16 a[100:101], v12 offset:8960
v_mfma_f32_16x16x32_bf16 v[68:71], a[104:107], a[4:7], 0
ds_read_b64_tr_b16 a[102:103], v12 offset:9984
v_mfma_f32_16x16x32_bf16 v[68:71], a[108:111], a[20:23], v[68:71]
v_mfma_f32_16x16x32_bf16 v[60:63], a[108:111], a[16:19], 0
s_add_u32 m0, s17, 0x8c00
s_waitcnt lgkmcnt(4)
v_mfma_f32_16x16x32_bf16 v[60:63], a[104:107], a[0:3], v[60:63]
buffer_load_dwordx4 v6, s[56:59], s13 offen lds
v_mfma_f32_16x16x32_bf16 v[88:91], a[80:83], a[0:3], 0
ds_read_b64_tr_b16 a[104:105], v13 offset:768
v_mfma_f32_16x16x32_bf16 v[88:91], a[84:87], a[16:19], v[88:91]
ds_read_b64_tr_b16 a[106:107], v13 offset:1792
v_mfma_f32_16x16x32_bf16 v[96:99], a[84:87], a[20:23], 0
ds_read_b64_tr_b16 a[108:109], v13 offset:8960
v_mfma_f32_16x16x32_bf16 v[96:99], a[80:83], a[4:7], v[96:99]
ds_read_b64_tr_b16 a[110:111], v13 offset:9984
s_add_u32 m0, s17, 0xcc00
v_mfma_f32_16x16x32_bf16 v[104:107], a[80:83], a[8:11], 0
buffer_load_dwordx4 v6, s[60:63], s13 offen lds
v_mfma_f32_16x16x32_bf16 v[104:107], a[84:87], a[24:27], v[104:107]
v_lshl_add_u32 v5, s42, 19, v5
v_lshl_add_u32 v6, s42, 19, v6
v_mfma_f32_16x16x32_bf16 v[112:115], a[84:87], a[28:31], 0
v_mfma_f32_16x16x32_bf16 v[112:115], a[80:83], a[12:15], v[112:115]
v_mfma_f32_16x16x32_bf16 v[116:119], a[88:91], a[12:15], 0
ds_read_b64_tr_b16 a[80:81], v12 offset:16384
s_add_u32 m0, s16, 0x0
v_mfma_f32_16x16x32_bf16 v[116:119], a[92:95], a[28:31], v[116:119]
buffer_load_dwordx4 v2, s[48:51], 0 offen lds
v_mfma_f32_16x16x32_bf16 v[108:111], a[92:95], a[24:27], 0
ds_read_b64_tr_b16 a[82:83], v12 offset:17408
v_mfma_f32_16x16x32_bf16 v[108:111], a[88:91], a[8:11], v[108:111]
ds_read_b64_tr_b16 a[84:85], v12 offset:24576
v_mfma_f32_16x16x32_bf16 v[100:103], a[88:91], a[4:7], 0
ds_read_b64_tr_b16 a[86:87], v12 offset:25600
v_mfma_f32_16x16x32_bf16 v[100:103], a[92:95], a[20:23], v[100:103]
s_add_u32 m0, s16, 0x400
v_mfma_f32_16x16x32_bf16 v[92:95], a[92:95], a[16:19], 0
buffer_load_dwordx4 v3, s[48:51], 0 offen lds
v_mfma_f32_16x16x32_bf16 v[92:95], a[88:91], a[0:3], v[92:95]
s_waitcnt lgkmcnt(4)
v_mfma_f32_16x16x32_bf16 v[120:123], a[96:99], a[0:3], 0
ds_read_b64_tr_b16 a[88:89], v13 offset:16384
s_waitcnt vmcnt(11)
v_mfma_f32_16x16x32_bf16 v[120:123], a[100:103], a[16:19], v[120:123]
ds_read_b64_tr_b16 a[90:91], v13 offset:17408
v_mfma_f32_16x16x32_bf16 v[128:131], a[100:103], a[20:23], 0
ds_read_b64_tr_b16 a[92:93], v13 offset:24576
s_add_u32 m0, s16, 0x800
v_mfma_f32_16x16x32_bf16 v[128:131], a[96:99], a[4:7], v[128:131]
buffer_load_dwordx4 v2, s[48:51], s12 offen lds
v_mfma_f32_16x16x32_bf16 v[136:139], a[96:99], a[8:11], 0
ds_read_b64_tr_b16 a[94:95], v13 offset:25600
v_mfma_f32_16x16x32_bf16 v[136:139], a[100:103], a[24:27], v[136:139]
ds_read_b128 a[32:35], v8 offset:32768
v_mfma_f32_16x16x32_bf16 v[144:147], a[100:103], a[28:31], 0
ds_read_b128 a[48:51], v9 offset:32768
v_mfma_f32_16x16x32_bf16 v[144:147], a[96:99], a[12:15], v[144:147]
ds_read_b128 a[36:39], v8 offset:34816
s_add_u32 m0, s16, 0xc00
v_mfma_f32_16x16x32_bf16 v[148:151], a[104:107], a[12:15], 0
buffer_load_dwordx4 v3, s[48:51], s12 offen lds
v_mfma_f32_16x16x32_bf16 v[148:151], a[108:111], a[28:31], v[148:151]
ds_read_b64_tr_b16 a[96:97], v12 offset:16640
v_mfma_f32_16x16x32_bf16 v[140:143], a[108:111], a[24:27], 0
ds_read_b64_tr_b16 a[98:99], v12 offset:17664
v_mfma_f32_16x16x32_bf16 v[140:143], a[104:107], a[8:11], v[140:143]
ds_read_b64_tr_b16 a[100:101], v12 offset:24832
v_mfma_f32_16x16x32_bf16 v[132:135], a[104:107], a[4:7], 0
ds_read_b64_tr_b16 a[102:103], v12 offset:25856
s_add_u32 m0, s16, 0x1000
v_mfma_f32_16x16x32_bf16 v[132:135], a[108:111], a[20:23], v[132:135]
buffer_load_dwordx4 v2, s[48:51], s13 offen lds
v_mfma_f32_16x16x32_bf16 v[124:127], a[108:111], a[16:19], 0
ds_read_b128 a[52:55], v9 offset:34816
v_mfma_f32_16x16x32_bf16 v[124:127], a[104:107], a[0:3], v[124:127]
ds_read_b128 a[40:43], v8 offset:36864
s_waitcnt lgkmcnt(9)
v_mfma_f32_16x16x32_bf16 v[152:155], a[0:3], a[80:83], 0
ds_read_b64_tr_b16 a[104:105], v13 offset:16640
v_mfma_f32_16x16x32_bf16 v[152:155], a[16:19], a[84:87], v[152:155]
ds_read_b64_tr_b16 a[106:107], v13 offset:17664
s_add_u32 m0, s16, 0x1400
v_mfma_f32_16x16x32_bf16 v[156:159], a[20:23], a[84:87], 0
buffer_load_dwordx4 v3, s[48:51], s13 offen lds
v_mfma_f32_16x16x32_bf16 v[156:159], a[4:7], a[80:83], v[156:159]
ds_read_b64_tr_b16 a[108:109], v13 offset:24832
v_mfma_f32_16x16x32_bf16 v[160:163], a[8:11], a[80:83], 0
ds_read_b64_tr_b16 a[110:111], v13 offset:25856
v_mfma_f32_16x16x32_bf16 v[160:163], a[24:27], a[84:87], v[160:163]
ds_read_b128 a[56:59], v9 offset:36864
v_mfma_f32_16x16x32_bf16 v[164:167], a[28:31], a[84:87], 0
ds_read_b128 a[44:47], v8 offset:38912
s_add_u32 m0, s16, 0x1800
v_mfma_f32_16x16x32_bf16 v[164:167], a[12:15], a[80:83], v[164:167]
buffer_load_dwordx4 v2, s[48:51], s14 offen lds
v_mfma_f32_16x16x32_bf16 v[180:183], a[12:15], a[88:91], 0
ds_read_b64_tr_b16 a[80:81], v12 offset:16896
v_mfma_f32_16x16x32_bf16 v[180:183], a[28:31], a[92:95], v[180:183]
ds_read_b64_tr_b16 a[82:83], v12 offset:17920
v_mfma_f32_16x16x32_bf16 v[176:179], a[24:27], a[92:95], 0
ds_read_b64_tr_b16 a[84:85], v12 offset:25088
v_mfma_f32_16x16x32_bf16 v[176:179], a[8:11], a[88:91], v[176:179]
ds_read_b64_tr_b16 a[86:87], v12 offset:26112
s_add_u32 m0, s16, 0x1c00
v_mfma_f32_16x16x32_bf16 v[172:175], a[4:7], a[88:91], 0
buffer_load_dwordx4 v3, s[48:51], s14 offen lds
v_mfma_f32_16x16x32_bf16 v[172:175], a[20:23], a[92:95], v[172:175]
ds_read_b128 a[60:63], v9 offset:38912
v_lshl_add_u32 v2, s42, 7, v2
v_mfma_f32_16x16x32_bf16 v[168:171], a[16:19], a[92:95], 0
v_lshl_add_u32 v3, s42, 7, v3
v_mfma_f32_16x16x32_bf16 v[168:171], a[0:3], a[88:91], v[168:171]
s_waitcnt lgkmcnt(7)
v_mfma_f32_16x16x32_bf16 v[184:187], a[0:3], a[96:99], 0
ds_read_b64_tr_b16 a[88:89], v13 offset:16896
s_add_u32 m0, s17, 0x10000
v_mfma_f32_16x16x32_bf16 v[184:187], a[16:19], a[100:103], v[184:187]
buffer_load_dwordx4 v5, s[56:59], 0 offen lds
v_mfma_f32_16x16x32_bf16 v[188:191], a[20:23], a[100:103], 0
ds_read_b64_tr_b16 a[90:91], v13 offset:17920
v_mfma_f32_16x16x32_bf16 v[188:191], a[4:7], a[96:99], v[188:191]
ds_read_b64_tr_b16 a[92:93], v13 offset:25088
v_mfma_f32_16x16x32_bf16 v[192:195], a[8:11], a[96:99], 0
ds_read_b64_tr_b16 a[94:95], v13 offset:26112
v_mfma_f32_16x16x32_bf16 v[192:195], a[24:27], a[100:103], v[192:195]
s_add_u32 m0, s17, 0x14000
v_mfma_f32_16x16x32_bf16 v[196:199], a[28:31], a[100:103], 0
buffer_load_dwordx4 v5, s[60:63], 0 offen lds
v_mfma_f32_16x16x32_bf16 v[196:199], a[12:15], a[96:99], v[196:199]
v_mfma_f32_16x16x32_bf16 v[212:215], a[12:15], a[104:107], 0
ds_read_b64_tr_b16 a[96:97], v12 offset:17152
v_mfma_f32_16x16x32_bf16 v[212:215], a[28:31], a[108:111], v[212:215]
ds_read_b64_tr_b16 a[98:99], v12 offset:18176
v_mfma_f32_16x16x32_bf16 v[208:211], a[24:27], a[108:111], 0
ds_read_b64_tr_b16 a[100:101], v12 offset:25344
s_add_u32 m0, s17, 0x10400
v_mfma_f32_16x16x32_bf16 v[208:211], a[8:11], a[104:107], v[208:211]
buffer_load_dwordx4 v5, s[56:59], s13 offen lds
v_mfma_f32_16x16x32_bf16 v[204:207], a[4:7], a[104:107], 0
ds_read_b64_tr_b16 a[102:103], v12 offset:26368
v_mfma_f32_16x16x32_bf16 v[204:207], a[20:23], a[108:111], v[204:207]
v_mfma_f32_16x16x32_bf16 v[200:203], a[16:19], a[108:111], 0
v_mfma_f32_16x16x32_bf16 v[200:203], a[0:3], a[104:107], v[200:203]
s_add_u32 m0, s17, 0x14400
s_waitcnt lgkmcnt(4)
v_mfma_f32_16x16x32_bf16 v[216:219], a[0:3], a[80:83], 0
buffer_load_dwordx4 v5, s[60:63], s13 offen lds
v_mfma_f32_16x16x32_bf16 v[216:219], a[16:19], a[84:87], v[216:219]
ds_read_b64_tr_b16 a[104:105], v13 offset:17152
v_mfma_f32_16x16x32_bf16 v[220:223], a[20:23], a[84:87], 0
ds_read_b64_tr_b16 a[106:107], v13 offset:18176
v_mfma_f32_16x16x32_bf16 v[220:223], a[4:7], a[80:83], v[220:223]
ds_read_b64_tr_b16 a[108:109], v13 offset:25344
v_mfma_f32_16x16x32_bf16 v[224:227], a[8:11], a[80:83], 0
ds_read_b64_tr_b16 a[110:111], v13 offset:26368
s_add_u32 m0, s17, 0x10800
v_mfma_f32_16x16x32_bf16 v[224:227], a[24:27], a[84:87], v[224:227]
buffer_load_dwordx4 v6, s[56:59], 0 offen lds
v_mfma_f32_16x16x32_bf16 v[228:231], a[28:31], a[84:87], 0
v_add_u32 v12, 0x8000, v12
v_add_u32 v13, 0x8000, v13
v_mfma_f32_16x16x32_bf16 v[228:231], a[12:15], a[80:83], v[228:231]
v_mfma_f32_16x16x32_bf16 v[244:247], a[12:15], a[88:91], 0
s_waitcnt vmcnt(13) lgkmcnt(0)
v_mfma_f32_16x16x32_bf16 v[244:247], a[28:31], a[92:95], v[244:247]
s_barrier
s_add_u32 m0, s17, 0x14800
v_mfma_f32_16x16x32_bf16 v[240:243], a[24:27], a[92:95], 0
buffer_load_dwordx4 v6, s[60:63], 0 offen lds
v_mfma_f32_16x16x32_bf16 v[240:243], a[8:11], a[88:91], v[240:243]
ds_read_b64_tr_b16 a[80:81], v12 offset:0
v_mfma_f32_16x16x32_bf16 v[236:239], a[4:7], a[88:91], 0
ds_read_b64_tr_b16 a[82:83], v12 offset:1024
v_mfma_f32_16x16x32_bf16 v[236:239], a[20:23], a[92:95], v[236:239]
ds_read_b64_tr_b16 a[84:85], v12 offset:8192
s_waitcnt lgkmcnt(3)
v_mfma_f32_16x16x32_bf16 v[232:235], a[16:19], a[92:95], 0
ds_read_b64_tr_b16 a[86:87], v12 offset:9216
s_add_u32 m0, s17, 0x10c00
v_mfma_f32_16x16x32_bf16 v[232:235], a[0:3], a[88:91], v[232:235]
buffer_load_dwordx4 v6, s[56:59], s13 offen lds
v_mfma_f32_16x16x32_bf16 v[248:251], a[0:3], a[96:99], 0
ds_read_b64_tr_b16 a[88:89], v13 offset:0
v_mfma_f32_16x16x32_bf16 v[248:251], a[16:19], a[100:103], v[248:251]
ds_read_b64_tr_b16 a[90:91], v13 offset:1024
v_mfma_f32_16x16x32_bf16 v[252:255], a[20:23], a[100:103], 0
ds_read_b64_tr_b16 a[92:93], v13 offset:8192
v_mfma_f32_16x16x32_bf16 v[252:255], a[4:7], a[96:99], v[252:255]
ds_read_b64_tr_b16 a[94:95], v13 offset:9216
s_add_u32 m0, s17, 0x14c00
v_mfma_f32_16x16x32_bf16 a[232:235], a[8:11], a[96:99], 0
buffer_load_dwordx4 v6, s[60:63], s13 offen lds
v_mfma_f32_16x16x32_bf16 a[232:235], a[24:27], a[100:103], a[232:235]
v_lshl_add_u32 v5, s42, 19, v5
v_lshl_add_u32 v6, s42, 19, v6
v_mfma_f32_16x16x32_bf16 a[236:239], a[28:31], a[100:103], 0
v_mfma_f32_16x16x32_bf16 a[236:239], a[12:15], a[96:99], a[236:239]
s_waitcnt lgkmcnt(15)
v_mfma_f32_16x16x32_bf16 a[252:255], a[12:15], a[104:107], 0
ds_read_b64_tr_b16 a[96:97], v12 offset:256
s_add_u32 m0, s16, 0x8000
v_mfma_f32_16x16x32_bf16 a[252:255], a[28:31], a[108:111], a[252:255]
buffer_load_dwordx4 v2, s[48:51], 0 offen lds
v_mfma_f32_16x16x32_bf16 a[248:251], a[24:27], a[108:111], 0
ds_read_b64_tr_b16 a[98:99], v12 offset:1280
v_mfma_f32_16x16x32_bf16 a[248:251], a[8:11], a[104:107], a[248:251]
ds_read_b64_tr_b16 a[100:101], v12 offset:8448
v_mfma_f32_16x16x32_bf16 a[244:247], a[4:7], a[104:107], 0
ds_read_b64_tr_b16 a[102:103], v12 offset:9472
v_mfma_f32_16x16x32_bf16 a[244:247], a[20:23], a[108:111], a[244:247]
s_add_u32 m0, s16, 0x8400
v_mfma_f32_16x16x32_bf16 a[240:243], a[16:19], a[108:111], 0
buffer_load_dwordx4 v3, s[48:51], 0 offen lds
v_mfma_f32_16x16x32_bf16 a[240:243], a[0:3], a[104:107], a[240:243]
s_waitcnt lgkmcnt(4)
L_S1:
v_mfma_f32_16x16x32_bf16 v[24:27], a[80:83], a[32:35], v[24:27]
ds_read_b64_tr_b16 a[104:105], v13 offset:256
v_mfma_f32_16x16x32_bf16 v[24:27], a[84:87], a[48:51], v[24:27]
ds_read_b64_tr_b16 a[106:107], v13 offset:1280
v_mfma_f32_16x16x32_bf16 v[32:35], a[84:87], a[52:55], v[32:35]
ds_read_b64_tr_b16 a[108:109], v13 offset:8448
s_add_u32 m0, s16, 0x8800
v_mfma_f32_16x16x32_bf16 v[32:35], a[80:83], a[36:39], v[32:35]
buffer_load_dwordx4 v2, s[48:51], s12 offen lds
v_mfma_f32_16x16x32_bf16 v[40:43], a[80:83], a[40:43], v[40:43]
ds_read_b64_tr_b16 a[110:111], v13 offset:9472
v_mfma_f32_16x16x32_bf16 v[40:43], a[84:87], a[56:59], v[40:43]
v_mfma_f32_16x16x32_bf16 v[48:51], a[84:87], a[60:63], v[48:51]
v_mfma_f32_16x16x32_bf16 v[48:51], a[80:83], a[44:47], v[48:51]
s_add_u32 m0, s16, 0x8c00
v_mfma_f32_16x16x32_bf16 v[52:55], a[88:91], a[44:47], v[52:55]
buffer_load_dwordx4 v3, s[48:51], s12 offen lds
v_mfma_f32_16x16x32_bf16 v[52:55], a[92:95], a[60:63], v[52:55]
ds_read_b64_tr_b16 a[80:81], v12 offset:512
v_mfma_f32_16x16x32_bf16 v[44:47], a[92:95], a[56:59], v[44:47]
ds_read_b64_tr_b16 a[82:83], v12 offset:1536
v_mfma_f32_16x16x32_bf16 v[44:47], a[88:91], a[40:43], v[44:47]
ds_read_b64_tr_b16 a[84:85], v12 offset:8704
v_mfma_f32_16x16x32_bf16 v[36:39], a[88:91], a[36:39], v[36:39]
ds_read_b64_tr_b16 a[86:87], v12 offset:9728
s_add_u32 m0, s16, 0x9000
v_mfma_f32_16x16x32_bf16 v[36:39], a[92:95], a[52:55], v[36:39]
buffer_load_dwordx4 v2, s[48:51], s13 offen lds
v_mfma_f32_16x16x32_bf16 v[28:31], a[92:95], a[48:51], v[28:31]
v_mfma_f32_16x16x32_bf16 v[28:31], a[88:91], a[32:35], v[28:31]
s_waitcnt lgkmcnt(4)
v_mfma_f32_16x16x32_bf16 v[56:59], a[96:99], a[32:35], v[56:59]
ds_read_b64_tr_b16 a[88:89], v13 offset:512
v_mfma_f32_16x16x32_bf16 v[56:59], a[100:103], a[48:51], v[56:59]
ds_read_b64_tr_b16 a[90:91], v13 offset:1536
s_add_u32 m0, s16, 0x9400
v_mfma_f32_16x16x32_bf16 v[64:67], a[100:103], a[52:55], v[64:67]
buffer_load_dwordx4 v3, s[48:51], s13 offen lds
v_mfma_f32_16x16x32_bf16 v[64:67], a[96:99], a[36:39], v[64:67]
ds_read_b64_tr_b16 a[92:93], v13 offset:8704
v_mfma_f32_16x16x32_bf16 v[72:75], a[96:99], a[40:43], v[72:75]
ds_read_b64_tr_b16 a[94:95], v13 offset:9728
v_mfma_f32_16x16x32_bf16 v[72:75], a[100:103], a[56:59], v[72:75]
v_mfma_f32_16x16x32_bf16 v[80:83], a[100:103], a[60:63], v[80:83]
s_add_u32 m0, s16, 0x9800
v_mfma_f32_16x16x32_bf16 v[80:83], a[96:99], a[44:47], v[80:83]
buffer_load_dwordx4 v2, s[48:51], s14 offen lds
v_mfma_f32_16x16x32_bf16 v[84:87], a[104:107], a[44:47], v[84:87]
ds_read_b64_tr_b16 a[96:97], v12 offset:768
v_mfma_f32_16x16x32_bf16 v[84:87], a[108:111], a[60:63], v[84:87]
ds_read_b64_tr_b16 a[98:99], v12 offset:1792
v_mfma_f32_16x16x32_bf16 v[76:79], a[108:111], a[56:59], v[76:79]
ds_read_b64_tr_b16 a[100:101], v12 offset:8960
v_mfma_f32_16x16x32_bf16 v[76:79], a[104:107], a[40:43], v[76:79]
ds_read_b64_tr_b16 a[102:103], v12 offset:9984
s_add_u32 m0, s16, 0x9c00
v_mfma_f32_16x16x32_bf16 v[68:71], a[104:107], a[36:39], v[68:71]
buffer_load_dwordx4 v3, s[48:51], s14 offen lds
v_mfma_f32_16x16x32_bf16 v[68:71], a[108:111], a[52:55], v[68:71]
v_lshl_add_u32 v2, s42, 7, v2
v_lshl_add_u32 v3, s42, 7, v3
v_mfma_f32_16x16x32_bf16 v[60:63], a[108:111], a[48:51], v[60:63]
v_mfma_f32_16x16x32_bf16 v[60:63], a[104:107], a[32:35], v[60:63]
s_add_u32 m0, s17, 0x0
s_waitcnt lgkmcnt(4)
v_mfma_f32_16x16x32_bf16 v[88:91], a[80:83], a[32:35], v[88:91]
ds_read_b64_tr_b16 a[104:105], v13 offset:768
s_waitcnt vmcnt(16)
v_mfma_f32_16x16x32_bf16 v[88:91], a[84:87], a[48:51], v[88:91]
buffer_load_dwordx4 v5, s[56:59], 0 offen lds
v_mfma_f32_16x16x32_bf16 v[96:99], a[84:87], a[52:55], v[96:99]
ds_read_b64_tr_b16 a[106:107], v13 offset:1792
v_mfma_f32_16x16x32_bf16 v[96:99], a[80:83], a[36:39], v[96:99]
ds_read_b64_tr_b16 a[108:109], v13 offset:8960
v_mfma_f32_16x16x32_bf16 v[104:107], a[80:83], a[40:43], v[104:107]
ds_read_b64_tr_b16 a[110:111], v13 offset:9984
v_mfma_f32_16x16x32_bf16 v[104:107], a[84:87], a[56:59], v[104:107]
ds_read_b128 a[0:3], v8 offset:0
s_add_u32 m0, s17, 0x4000
v_mfma_f32_16x16x32_bf16 v[112:115], a[84:87], a[60:63], v[112:115]
buffer_load_dwordx4 v5, s[60:63], 0 offen lds
v_mfma_f32_16x16x32_bf16 v[112:115], a[80:83], a[44:47], v[112:115]
ds_read_b128 a[16:19], v9 offset:0
v_mfma_f32_16x16x32_bf16 v[116:119], a[88:91], a[44:47], v[116:119]
ds_read_b64_tr_b16 a[80:81], v12 offset:16384
v_mfma_f32_16x16x32_bf16 v[116:119], a[92:95], a[60:63], v[116:119]
ds_read_b64_tr_b16 a[82:83], v12 offset:17408
v_mfma_f32_16x16x32_bf16 v[108:111], a[92:95], a[56:59], v[108:111]
ds_read_b64_tr_b16 a[84:85], v12 offset:24576
s_add_u32 m0, s17, 0x400
v_mfma_f32_16x16x32_bf16 v[108:111], a[88:91], a[40:43], v[108:111]
buffer_load_dwordx4 v5, s[56:59], s13 offen lds
v_mfma_f32_16x16x32_bf16 v[100:103], a[88:91], a[36:39], v[100:103]
ds_read_b64_tr_b16 a[86:87], v12 offset:25600
v_mfma_f32_16x16x32_bf16 v[100:103], a[92:95], a[52:55], v[100:103]
ds_read_b128 a[4:7], v8 offset:2048
v_mfma_f32_16x16x32_bf16 v[92:95], a[92:95], a[48:51], v[92:95]
ds_read_b128 a[20:23], v9 offset:2048
s_waitcnt lgkmcnt(8)
v_mfma_f32_16x16x32_bf16 v[92:95], a[88:91], a[32:35], v[92:95]
ds_read_b128 a[8:11], v8 offset:4096
s_add_u32 m0, s17, 0x4400
v_mfma_f32_16x16x32_bf16 v[120:123], a[96:99], a[32:35], v[120:123]
buffer_load_dwordx4 v5, s[60:63], s13 offen lds
v_mfma_f32_16x16x32_bf16 v[120:123], a[100:103], a[48:51], v[120:123]
ds_read_b64_tr_b16 a[88:89], v13 offset:16384
v_mfma_f32_16x16x32_bf16 v[128:131], a[100:103], a[52:55], v[128:131]
ds_read_b64_tr_b16 a[90:91], v13 offset:17408
v_mfma_f32_16x16x32_bf16 v[128:131], a[96:99], a[36:39], v[128:131]
ds_read_b64_tr_b16 a[92:93], v13 offset:24576
v_mfma_f32_16x16x32_bf16 v[136:139], a[96:99], a[40:43], v[136:139]
ds_read_b64_tr_b16 a[94:95], v13 offset:25600
s_add_u32 m0, s17, 0x800
v_mfma_f32_16x16x32_bf16 v[136:139], a[100:103], a[56:59], v[136:139]
buffer_load_dwordx4 v6, s[56:59], 0 offen lds
v_mfma_f32_16x16x32_bf16 v[144:147], a[100:103], a[60:63], v[144:147]
ds_read_b128 a[24:27], v9 offset:4096
v_mfma_f32_16x16x32_bf16 v[144:147], a[96:99], a[44:47], v[144:147]
ds_read_b128 a[12:15], v8 offset:6144
v_mfma_f32_16x16x32_bf16 v[148:151], a[104:107], a[44:47], v[148:151]
ds_read_b64_tr_b16 a[96:97], v12 offset:16640
v_mfma_f32_16x16x32_bf16 v[148:151], a[108:111], a[60:63], v[148:151]
ds_read_b64_tr_b16 a[98:99], v12 offset:17664
s_add_u32 m0, s17, 0x4800
v_mfma_f32_16x16x32_bf16 v[140:143], a[108:111], a[56:59], v[140:143]
buffer_load_dwordx4 v6, s[60:63], 0 offen lds
v_mfma_f32_16x16x32_bf16 v[140:143], a[104:107], a[40:43], v[140:143]
ds_read_b64_tr_b16 a[100:101], v12 offset:24832
v_mfma_f32_16x16x32_bf16 v[132:135], a[104:107], a[36:39], v[132:135]
ds_read_b64_tr_b16 a[102:103], v12 offset:25856
v_mfma_f32_16x16x32_bf16 v[132:135], a[108:111], a[52:55], v[132:135]
ds_read_b128 a[28:31], v9 offset:6144
v_mfma_f32_16x16x32_bf16 v[124:127], a[108:111], a[48:51], v[124:127]
s_add_u32 m0, s17, 0xc00
s_waitcnt lgkmcnt(7)
v_mfma_f32_16x16x32_bf16 v[124:127], a[104:107], a[32:35], v[124:127]
buffer_load_dwordx4 v6, s[56:59], s13 offen lds
v_mfma_f32_16x16x32_bf16 v[152:155], a[32:35], a[80:83], v[152:155]
ds_read_b64_tr_b16 a[104:105], v13 offset:16640
v_mfma_f32_16x16x32_bf16 v[152:155], a[48:51], a[84:87], v[152:155]
ds_read_b64_tr_b16 a[106:107], v13 offset:17664
v_mfma_f32_16x16x32_bf16 v[156:159], a[52:55], a[84:87], v[156:159]
ds_read_b64_tr_b16 a[108:109], v13 offset:24832
v_mfma_f32_16x16x32_bf16 v[156:159], a[36:39], a[80:83], v[156:159]
ds_read_b64_tr_b16 a[110:111], v13 offset:25856
s_add_u32 m0, s17, 0x4c00
v_mfma_f32_16x16x32_bf16 v[160:163], a[40:43], a[80:83], v[160:163]
buffer_load_dwordx4 v6, s[60:63], s13 offen lds
v_mfma_f32_16x16x32_bf16 v[160:163], a[56:59], a[84:87], v[160:163]
v_lshl_add_u32 v5, s42, 19, v5
v_lshl_add_u32 v6, s42, 19, v6
v_mfma_f32_16x16x32_bf16 v[164:167], a[60:63], a[84:87], v[164:167]
v_mfma_f32_16x16x32_bf16 v[164:167], a[44:47], a[80:83], v[164:167]
v_mfma_f32_16x16x32_bf16 v[180:183], a[44:47], a[88:91], v[180:183]
ds_read_b64_tr_b16 a[80:81], v12 offset:16896
s_mov_b32 s9, 0x200000
v_mfma_f32_16x16x32_bf16 v[180:183], a[60:63], a[92:95], v[180:183]
buffer_load_dword a120, v18, s[56:59], s9 offen
v_mfma_f32_16x16x32_bf16 v[176:179], a[56:59], a[92:95], v[176:179]
ds_read_b64_tr_b16 a[82:83], v12 offset:17920
v_mfma_f32_16x16x32_bf16 v[176:179], a[40:43], a[88:91], v[176:179]
ds_read_b64_tr_b16 a[84:85], v12 offset:25088
v_mfma_f32_16x16x32_bf16 v[172:175], a[36:39], a[88:91], v[172:175]
ds_read_b64_tr_b16 a[86:87], v12 offset:26112
v_mfma_f32_16x16x32_bf16 v[172:175], a[52:55], a[92:95], v[172:175]
s_add_u32 m0, s16, 0x0
s_waitcnt lgkmcnt(8)
v_mfma_f32_16x16x32_bf16 v[168:171], a[48:51], a[92:95], v[168:171]
buffer_load_dwordx4 v2, s[48:51], 0 offen lds
v_mfma_f32_16x16x32_bf16 v[168:171], a[32:35], a[88:91], v[168:171]
s_waitcnt lgkmcnt(4)
v_mfma_f32_16x16x32_bf16 v[184:187], a[32:35], a[96:99], v[184:187]
ds_read_b64_tr_b16 a[88:89], v13 offset:16896
v_mfma_f32_16x16x32_bf16 v[184:187], a[48:51], a[100:103], v[184:187]
ds_read_b64_tr_b16 a[90:91], v13 offset:17920
v_mfma_f32_16x16x32_bf16 v[188:191], a[52:55], a[100:103], v[188:191]
ds_read_b64_tr_b16 a[92:93], v13 offset:25088
s_add_u32 m0, s16, 0x400
v_mfma_f32_16x16x32_bf16 v[188:191], a[36:39], a[96:99], v[188:191]
buffer_load_dwordx4 v3, s[48:51], 0 offen lds
v_mfma_f32_16x16x32_bf16 v[192:195], a[40:43], a[96:99], v[192:195]
ds_read_b64_tr_b16 a[94:95], v13 offset:26112
v_mfma_f32_16x16x32_bf16 v[192:195], a[56:59], a[100:103], v[192:195]
v_mfma_f32_16x16x32_bf16 v[196:199], a[60:63], a[100:103], v[196:199]
v_mfma_f32_16x16x32_bf16 v[196:199], a[44:47], a[96:99], v[196:199]
s_add_u32 m0, s16, 0x800
v_mfma_f32_16x16x32_bf16 v[212:215], a[44:47], a[104:107], v[212:215]
buffer_load_dwordx4 v2, s[48:51], s12 offen lds
v_mfma_f32_16x16x32_bf16 v[212:215], a[60:63], a[108:111], v[212:215]
ds_read_b64_tr_b16 a[96:97], v12 offset:17152
v_mfma_f32_16x16x32_bf16 v[208:211], a[56:59], a[108:111], v[208:211]
ds_read_b64_tr_b16 a[98:99], v12 offset:18176
v_mfma_f32_16x16x32_bf16 v[208:211], a[40:43], a[104:107], v[208:211]
ds_read_b64_tr_b16 a[100:101], v12 offset:25344
v_mfma_f32_16x16x32_bf16 v[204:207], a[36:39], a[104:107], v[204:207]
ds_read_b64_tr_b16 a[102:103], v12 offset:26368
s_add_u32 m0, s16, 0xc00
v_mfma_f32_16x16x32_bf16 v[204:207], a[52:55], a[108:111], v[204:207]
buffer_load_dwordx4 v3, s[48:51], s12 offen lds
v_mfma_f32_16x16x32_bf16 v[200:203], a[48:51], a[108:111], v[200:203]
v_mfma_f32_16x16x32_bf16 v[200:203], a[32:35], a[104:107], v[200:203]
s_waitcnt lgkmcnt(4)
v_mfma_f32_16x16x32_bf16 v[216:219], a[32:35], a[80:83], v[216:219]
ds_read_b64_tr_b16 a[104:105], v13 offset:17152
v_mfma_f32_16x16x32_bf16 v[216:219], a[48:51], a[84:87], v[216:219]
ds_read_b64_tr_b16 a[106:107], v13 offset:18176
s_add_u32 m0, s16, 0x1000
v_mfma_f32_16x16x32_bf16 v[220:223], a[52:55], a[84:87], v[220:223]
buffer_load_dwordx4 v2, s[48:51], s13 offen lds
v_mfma_f32_16x16x32_bf16 v[220:223], a[36:39], a[80:83], v[220:223]
ds_read_b64_tr_b16 a[108:109], v13 offset:25344
v_mfma_f32_16x16x32_bf16 v[224:227], a[40:43], a[80:83], v[224:227]
ds_read_b64_tr_b16 a[110:111], v13 offset:26368
v_add_u32 v12, 0x8000, v12
v_mfma_f32_16x16x32_bf16 v[224:227], a[56:59], a[84:87], v[224:227]
v_add_u32 v13, 0x8000, v13
v_mfma_f32_16x16x32_bf16 v[228:231], a[60:63], a[84:87], v[228:231]
s_add_u32 m0, s16, 0x1400
v_mfma_f32_16x16x32_bf16 v[228:231], a[44:47], a[80:83], v[228:231]
buffer_load_dwordx4 v3, s[48:51], s13 offen lds
v_mfma_f32_16x16x32_bf16 v[244:247], a[44:47], a[88:91], v[244:247]
s_waitcnt vmcnt(23) lgkmcnt(0)
v_mfma_f32_16x16x32_bf16 v[244:247], a[60:63], a[92:95], v[244:247]
s_barrier
v_mfma_f32_16x16x32_bf16 v[240:243], a[56:59], a[92:95], v[240:243]
ds_read_b64_tr_b16 a[80:81], v12 offset:0
v_mfma_f32_16x16x32_bf16 v[240:243], a[40:43], a[88:91], v[240:243]
ds_read_b64_tr_b16 a[82:83], v12 offset:1024
s_add_u32 m0, s16, 0x1800
v_mfma_f32_16x16x32_bf16 v[236:239], a[36:39], a[88:91], v[236:239]
buffer_load_dwordx4 v2, s[48:51], s14 offen lds
v_mfma_f32_16x16x32_bf16 v[236:239], a[52:55], a[92:95], v[236:239]
ds_read_b64_tr_b16 a[84:85], v12 offset:8192
v_mfma_f32_16x16x32_bf16 v[232:235], a[48:51], a[92:95], v[232:235]
ds_read_b64_tr_b16 a[86:87], v12 offset:9216
v_mfma_f32_16x16x32_bf16 v[232:235], a[32:35], a[88:91], v[232:235]
L_padA1:
s_cmp_eq_u32 s95, 1
s_cbranch_scc1 L_padA5
s_waitcnt lgkmcnt(4)
v_mfma_f32_16x16x32_bf16 v[248:251], a[32:35], a[96:99], v[248:251]
ds_read_b64_tr_b16 a[88:89], v13 offset:0
s_add_u32 m0, s16, 0x1c00
v_mfma_f32_16x16x32_bf16 v[248:251], a[48:51], a[100:103], v[248:251]
buffer_load_dwordx4 v3, s[48:51], s14 offen lds
v_mfma_f32_16x16x32_bf16 v[252:255], a[52:55], a[100:103], v[252:255]
ds_read_b64_tr_b16 a[90:91], v13 offset:1024
v_lshl_add_u32 v2, s42, 7, v2
v_mfma_f32_16x16x32_bf16 v[252:255], a[36:39], a[96:99], v[252:255]
ds_read_b64_tr_b16 a[92:93], v13 offset:8192
v_lshl_add_u32 v3, s42, 7, v3
v_mfma_f32_16x16x32_bf16 a[232:235], a[40:43], a[96:99], a[232:235]
ds_read_b64_tr_b16 a[94:95], v13 offset:9216
v_mfma_f32_16x16x32_bf16 a[232:235], a[56:59], a[100:103], a[232:235]
s_mov_b32 s9, 0x200000
v_mfma_f32_16x16x32_bf16 a[236:239], a[60:63], a[100:103], a[236:239]
buffer_load_dword a120, v18, s[60:63], s9 offen
v_mfma_f32_16x16x32_bf16 a[236:239], a[44:47], a[96:99], a[236:239]
v_mfma_f32_16x16x32_bf16 a[252:255], a[44:47], a[104:107], a[252:255]
ds_read_b64_tr_b16 a[96:97], v12 offset:256
v_mfma_f32_16x16x32_bf16 a[252:255], a[60:63], a[108:111], a[252:255]
ds_read_b64_tr_b16 a[98:99], v12 offset:1280
v_mfma_f32_16x16x32_bf16 a[248:251], a[56:59], a[108:111], a[248:251]
ds_read_b64_tr_b16 a[100:101], v12 offset:8448
s_add_u32 m0, s17, 0x8000
v_mfma_f32_16x16x32_bf16 a[248:251], a[40:43], a[104:107], a[248:251]
buffer_load_dwordx4 v5, s[56:59], 0 offen lds
v_mfma_f32_16x16x32_bf16 a[244:247], a[36:39], a[104:107], a[244:247]
ds_read_b64_tr_b16 a[102:103], v12 offset:9472
v_mfma_f32_16x16x32_bf16 a[244:247], a[52:55], a[108:111], a[244:247]
v_mfma_f32_16x16x32_bf16 a[240:243], a[48:51], a[108:111], a[240:243]
v_mfma_f32_16x16x32_bf16 a[240:243], a[32:35], a[104:107], a[240:243]
s_add_u32 m0, s17, 0xc000
s_waitcnt lgkmcnt(4)
L_S2:
v_mfma_f32_16x16x32_bf16 v[24:27], a[80:83], a[0:3], v[24:27]
buffer_load_dwordx4 v5, s[60:63], 0 offen lds
v_mfma_f32_16x16x32_bf16 v[24:27], a[84:87], a[16:19], v[24:27]
ds_read_b64_tr_b16 a[104:105], v13 offset:256
s_waitcnt vmcnt(20)
v_mfma_f32_16x16x32_bf16 v[32:35], a[84:87], a[20:23], v[32:35]
ds_read_b64_tr_b16 a[106:107], v13 offset:1280
v_mfma_f32_16x16x32_bf16 v[32:35], a[80:83], a[4:7], v[32:35]
ds_read_b64_tr_b16 a[108:109], v13 offset:8448
v_mfma_f32_16x16x32_bf16 v[40:43], a[80:83], a[8:11], v[40:43]
ds_read_b64_tr_b16 a[110:111], v13 offset:9472
s_add_u32 m0, s17, 0x8400
v_mfma_f32_16x16x32_bf16 v[40:43], a[84:87], a[24:27], v[40:43]
buffer_load_dwordx4 v5, s[56:59], s13 offen lds
v_mfma_f32_16x16x32_bf16 v[48:51], a[84:87], a[28:31], v[48:51]
ds_read_b128 a[32:35], v8 offset:32768
v_mfma_f32_16x16x32_bf16 v[48:51], a[80:83], a[12:15], v[48:51]
ds_read_b128 a[48:51], v9 offset:32768
v_mfma_f32_16x16x32_bf16 v[52:55], a[88:91], a[12:15], v[52:55]
ds_read_b64_tr_b16 a[80:81], v12 offset:512
v_mfma_f32_16x16x32_bf16 v[52:55], a[92:95], a[28:31], v[52:55]
ds_read_b64_tr_b16 a[82:83], v12 offset:1536
s_add_u32 m0, s17, 0xc400
v_mfma_f32_16x16x32_bf16 v[44:47], a[92:95], a[24:27], v[44:47]
buffer_load_dwordx4 v5, s[60:63], s13 offen lds
v_mfma_f32_16x16x32_bf16 v[44:47], a[88:91], a[8:11], v[44:47]
ds_read_b64_tr_b16 a[84:85], v12 offset:8704
v_mfma_f32_16x16x32_bf16 v[36:39], a[88:91], a[4:7], v[36:39]
ds_read_b64_tr_b16 a[86:87], v12 offset:9728
v_mfma_f32_16x16x32_bf16 v[36:39], a[92:95], a[20:23], v[36:39]
ds_read_b128 a[36:39], v8 offset:34816
s_waitcnt lgkmcnt(7)
v_mfma_f32_16x16x32_bf16 v[28:31], a[92:95], a[16:19], v[28:31]
ds_read_b128 a[52:55], v9 offset:34816
s_add_u32 m0, s17, 0x8800
v_mfma_f32_16x16x32_bf16 v[28:31], a[88:91], a[0:3], v[28:31]
buffer_load_dwordx4 v6, s[56:59], 0 offen lds
v_mfma_f32_16x16x32_bf16 v[56:59], a[96:99], a[0:3], v[56:59]
ds_read_b64_tr_b16 a[88:89], v13 offset:512
v_mfma_f32_16x16x32_bf16 v[56:59], a[100:103], a[16:19], v[56:59]
ds_read_b64_tr_b16 a[90:91], v13 offset:1536
v_mfma_f32_16x16x32_bf16 v[64:67], a[100:103], a[20:23], v[64:67]
ds_read_b64_tr_b16 a[92:93], v13 offset:8704
v_mfma_f32_16x16x32_bf16 v[64:67], a[96:99], a[4:7], v[64:67]
ds_read_b64_tr_b16 a[94:95], v13 offset:9728
s_add_u32 m0, s17, 0xc800
v_mfma_f32_16x16x32_bf16 v[72:75], a[96:99], a[8:11], v[72:75]
buffer_load_dwordx4 v6, s[60:63], 0 offen lds
v_mfma_f32_16x16x32_bf16 v[72:75], a[100:103], a[24:27], v[72:75]
ds_read_b128 a[40:43], v8 offset:36864
v_mfma_f32_16x16x32_bf16 v[80:83], a[100:103], a[28:31], v[80:83]
ds_read_b128 a[56:59], v9 offset:36864
v_mfma_f32_16x16x32_bf16 v[80:83], a[96:99], a[12:15], v[80:83]
ds_read_b128 a[44:47], v8 offset:38912
v_mfma_f32_16x16x32_bf16 v[84:87], a[104:107], a[12:15], v[84:87]
ds_read_b64_tr_b16 a[96:97], v12 offset:768
s_add_u32 m0, s17, 0x8c00
v_mfma_f32_16x16x32_bf16 v[84:87], a[108:111], a[28:31], v[84:87]
buffer_load_dwordx4 v6, s[56:59], s13 offen lds
v_mfma_f32_16x16x32_bf16 v[76:79], a[108:111], a[24:27], v[76:79]
ds_read_b64_tr_b16 a[98:99], v12 offset:1792
v_mfma_f32_16x16x32_bf16 v[76:79], a[104:107], a[8:11], v[76:79]
ds_read_b64_tr_b16 a[100:101], v12 offset:8960
v_mfma_f32_16x16x32_bf16 v[68:71], a[104:107], a[4:7], v[68:71]
ds_read_b64_tr_b16 a[102:103], v12 offset:9984
v_mfma_f32_16x16x32_bf16 v[68:71], a[108:111], a[20:23], v[68:71]
ds_read_b128 a[60:63], v9 offset:38912
s_add_u32 m0, s17, 0xcc00
v_mfma_f32_16x16x32_bf16 v[60:63], a[108:111], a[16:19], v[60:63]
buffer_load_dwordx4 v6, s[60:63], s13 offen lds
v_mfma_f32_16x16x32_bf16 v[60:63], a[104:107], a[0:3], v[60:63]
s_waitcnt lgkmcnt(8)
v_lshl_add_u32 v5, s42, 19, v5
v_lshl_add_u32 v6, s42, 19, v6
v_mfma_f32_16x16x32_bf16 v[88:91], a[80:83], a[0:3], v[88:91]
ds_read_b64_tr_b16 a[104:105], v13 offset:768
v_mfma_f32_16x16x32_bf16 v[88:91], a[84:87], a[16:19], v[88:91]
ds_read_b64_tr_b16 a[106:107], v13 offset:1792
v_mfma_f32_16x16x32_bf16 v[96:99], a[84:87], a[20:23], v[96:99]
ds_read_b64_tr_b16 a[108:109], v13 offset:8960
v_mfma_f32_16x16x32_bf16 v[96:99], a[80:83], a[4:7], v[96:99]
ds_read_b64_tr_b16 a[110:111], v13 offset:9984
v_mfma_f32_16x16x32_bf16 v[104:107], a[80:83], a[8:11], v[104:107]
s_add_u32 m0, s16, 0x8000
s_waitcnt lgkmcnt(4)
v_mfma_f32_16x16x32_bf16 v[104:107], a[84:87], a[24:27], v[104:107]
buffer_load_dwordx4 v2, s[48:51], 0 offen lds
v_mfma_f32_16x16x32_bf16 v[112:115], a[84:87], a[28:31], v[112:115]
v_mfma_f32_16x16x32_bf16 v[112:115], a[80:83], a[12:15], v[112:115]
v_mfma_f32_16x16x32_bf16 v[116:119], a[88:91], a[12:15], v[116:119]
ds_read_b64_tr_b16 a[80:81], v12 offset:16384
v_mfma_f32_16x16x32_bf16 v[116:119], a[92:95], a[28:31], v[116:119]
ds_read_b64_tr_b16 a[82:83], v12 offset:17408
v_mfma_f32_16x16x32_bf16 v[108:111], a[92:95], a[24:27], v[108:111]
ds_read_b64_tr_b16 a[84:85], v12 offset:24576
v_mfma_f32_16x16x32_bf16 v[108:111], a[88:91], a[8:11], v[108:111]
ds_read_b64_tr_b16 a[86:87], v12 offset:25600
s_add_u32 m0, s16, 0x8400
v_mfma_f32_16x16x32_bf16 v[100:103], a[88:91], a[4:7], v[100:103]
buffer_load_dwordx4 v3, s[48:51], 0 offen lds
v_mfma_f32_16x16x32_bf16 v[100:103], a[92:95], a[20:23], v[100:103]
v_mfma_f32_16x16x32_bf16 v[92:95], a[92:95], a[16:19], v[92:95]
v_mfma_f32_16x16x32_bf16 v[92:95], a[88:91], a[0:3], v[92:95]
s_waitcnt lgkmcnt(4)
v_mfma_f32_16x16x32_bf16 v[120:123], a[96:99], a[0:3], v[120:123]
ds_read_b64_tr_b16 a[88:89], v13 offset:16384
v_mfma_f32_16x16x32_bf16 v[120:123], a[100:103], a[16:19], v[120:123]
ds_read_b64_tr_b16 a[90:91], v13 offset:17408
v_mfma_f32_16x16x32_bf16 v[128:131], a[100:103], a[20:23], v[128:131]
ds_read_b64_tr_b16 a[92:93], v13 offset:24576
v_mfma_f32_16x16x32_bf16 v[128:131], a[96:99], a[4:7], v[128:131]
ds_read_b64_tr_b16 a[94:95], v13 offset:25600
s_add_u32 m0, s16, 0x8800
v_mfma_f32_16x16x32_bf16 v[136:139], a[96:99], a[8:11], v[136:139]
buffer_load_dwordx4 v2, s[48:51], s12 offen lds
v_mfma_f32_16x16x32_bf16 v[136:139], a[100:103], a[24:27], v[136:139]
v_mfma_f32_16x16x32_bf16 v[144:147], a[100:103], a[28:31], v[144:147]
v_mfma_f32_16x16x32_bf16 v[144:147], a[96:99], a[12:15], v[144:147]
v_mfma_f32_16x16x32_bf16 v[148:151], a[104:107], a[12:15], v[148:151]
ds_read_b64_tr_b16 a[96:97], v12 offset:16640
v_mfma_f32_16x16x32_bf16 v[148:151], a[108:111], a[28:31], v[148:151]
ds_read_b64_tr_b16 a[98:99], v12 offset:17664
v_mfma_f32_16x16x32_bf16 v[140:143], a[108:111], a[24:27], v[140:143]
ds_read_b64_tr_b16 a[100:101], v12 offset:24832
s_add_u32 m0, s16, 0x8c00
v_mfma_f32_16x16x32_bf16 v[140:143], a[104:107], a[8:11], v[140:143]
buffer_load_dwordx4 v3, s[48:51], s12 offen lds
v_mfma_f32_16x16x32_bf16 v[132:135], a[104:107], a[4:7], v[132:135]
ds_read_b64_tr_b16 a[102:103], v12 offset:25856
v_mfma_f32_16x16x32_bf16 v[132:135], a[108:111], a[20:23], v[132:135]
v_mfma_f32_16x16x32_bf16 v[124:127], a[108:111], a[16:19], v[124:127]
v_mfma_f32_16x16x32_bf16 v[124:127], a[104:107], a[0:3], v[124:127]
s_waitcnt lgkmcnt(4)
v_mfma_f32_16x16x32_bf16 v[152:155], a[0:3], a[80:83], v[152:155]
ds_read_b64_tr_b16 a[104:105], v13 offset:16640
v_mfma_f32_16x16x32_bf16 v[152:155], a[16:19], a[84:87], v[152:155]
ds_read_b64_tr_b16 a[106:107], v13 offset:17664
s_add_u32 m0, s16, 0x9000
v_mfma_f32_16x16x32_bf16 v[156:159], a[20:23], a[84:87], v[156:159]
buffer_load_dwordx4 v2, s[48:51], s13 offen lds
v_mfma_f32_16x16x32_bf16 v[156:159], a[4:7], a[80:83], v[156:159]
ds_read_b64_tr_b16 a[108:109], v13 offset:24832
v_mfma_f32_16x16x32_bf16 v[160:163], a[8:11], a[80:83], v[160:163]
ds_read_b64_tr_b16 a[110:111], v13 offset:25856
v_mfma_f32_16x16x32_bf16 v[160:163], a[24:27], a[84:87], v[160:163]
v_mfma_f32_16x16x32_bf16 v[164:167], a[28:31], a[84:87], v[164:167]
v_mfma_f32_16x16x32_bf16 v[164:167], a[12:15], a[80:83], v[164:167]
v_mfma_f32_16x16x32_bf16 v[180:183], a[12:15], a[88:91], v[180:183]
ds_read_b64_tr_b16 a[80:81], v12 offset:16896
v_mfma_f32_16x16x32_bf16 v[180:183], a[28:31], a[92:95], v[180:183]
ds_read_b64_tr_b16 a[82:83], v12 offset:17920
s_add_u32 m0, s16, 0x9400
v_mfma_f32_16x16x32_bf16 v[176:179], a[24:27], a[92:95], v[176:179]
buffer_load_dwordx4 v3, s[48:51], s13 offen lds
v_mfma_f32_16x16x32_bf16 v[176:179], a[8:11], a[88:91], v[176:179]
ds_read_b64_tr_b16 a[84:85], v12 offset:25088
v_mfma_f32_16x16x32_bf16 v[172:175], a[4:7], a[88:91], v[172:175]
ds_read_b64_tr_b16 a[86:87], v12 offset:26112
v_mfma_f32_16x16x32_bf16 v[172:175], a[20:23], a[92:95], v[172:175]
v_mfma_f32_16x16x32_bf16 v[168:171], a[16:19], a[92:95], v[168:171]
v_mfma_f32_16x16x32_bf16 v[168:171], a[0:3], a[88:91], v[168:171]
s_waitcnt lgkmcnt(4)
v_mfma_f32_16x16x32_bf16 v[184:187], a[0:3], a[96:99], v[184:187]
ds_read_b64_tr_b16 a[88:89], v13 offset:16896
s_add_u32 m0, s16, 0x9800
v_mfma_f32_16x16x32_bf16 v[184:187], a[16:19], a[100:103], v[184:187]
buffer_load_dwordx4 v2, s[48:51], s14 offen lds
v_mfma_f32_16x16x32_bf16 v[188:191], a[20:23], a[100:103], v[188:191]
ds_read_b64_tr_b16 a[90:91], v13 offset:17920
v_mfma_f32_16x16x32_bf16 v[188:191], a[4:7], a[96:99], v[188:191]
ds_read_b64_tr_b16 a[92:93], v13 offset:25088
v_mfma_f32_16x16x32_bf16 v[192:195], a[8:11], a[96:99], v[192:195]
ds_read_b64_tr_b16 a[94:95], v13 offset:26112
v_mfma_f32_16x16x32_bf16 v[192:195], a[24:27], a[100:103], v[192:195]
v_mfma_f32_16x16x32_bf16 v[196:199], a[28:31], a[100:103], v[196:199]
v_mfma_f32_16x16x32_bf16 v[196:199], a[12:15], a[96:99], v[196:199]
v_mfma_f32_16x16x32_bf16 v[212:215], a[12:15], a[104:107], v[212:215]
ds_read_b64_tr_b16 a[96:97], v12 offset:17152
s_add_u32 m0, s16, 0x9c00
v_mfma_f32_16x16x32_bf16 v[212:215], a[28:31], a[108:111], v[212:215]
buffer_load_dwordx4 v3, s[48:51], s14 offen lds
v_mfma_f32_16x16x32_bf16 v[208:211], a[24:27], a[108:111], v[208:211]
ds_read_b64_tr_b16 a[98:99], v12 offset:18176
v_lshl_add_u32 v2, s42, 7, v2
v_mfma_f32_16x16x32_bf16 v[208:211], a[8:11], a[104:107], v[208:211]
ds_read_b64_tr_b16 a[100:101], v12 offset:25344
v_lshl_add_u32 v3, s42, 7, v3
v_mfma_f32_16x16x32_bf16 v[204:207], a[4:7], a[104:107], v[204:207]
ds_read_b64_tr_b16 a[102:103], v12 offset:26368
v_mfma_f32_16x16x32_bf16 v[204:207], a[20:23], a[108:111], v[204:207]
v_mfma_f32_16x16x32_bf16 v[200:203], a[16:19], a[108:111], v[200:203]
v_mfma_f32_16x16x32_bf16 v[200:203], a[0:3], a[104:107], v[200:203]
s_mov_b32 s9, 0x0
s_waitcnt lgkmcnt(4)
v_mfma_f32_16x16x32_bf16 v[216:219], a[0:3], a[80:83], v[216:219]
buffer_load_dword a120, v19, s[44:47], s9 offen
v_mfma_f32_16x16x32_bf16 v[216:219], a[16:19], a[84:87], v[216:219]
ds_read_b64_tr_b16 a[104:105], v13 offset:17152
v_mfma_f32_16x16x32_bf16 v[220:223], a[20:23], a[84:87], v[220:223]
ds_read_b64_tr_b16 a[106:107], v13 offset:18176
v_mfma_f32_16x16x32_bf16 v[220:223], a[4:7], a[80:83], v[220:223]
ds_read_b64_tr_b16 a[108:109], v13 offset:25344
v_mfma_f32_16x16x32_bf16 v[224:227], a[8:11], a[80:83], v[224:227]
ds_read_b64_tr_b16 a[110:111], v13 offset:26368
v_add_u32 v12, 0xffff0000, v12
v_mfma_f32_16x16x32_bf16 v[224:227], a[24:27], a[84:87], v[224:227]
v_add_u32 v13, 0xffff0000, v13
v_mfma_f32_16x16x32_bf16 v[228:231], a[28:31], a[84:87], v[228:231]
v_mfma_f32_16x16x32_bf16 v[228:231], a[12:15], a[80:83], v[228:231]
v_mfma_f32_16x16x32_bf16 v[244:247], a[12:15], a[88:91], v[244:247]
s_waitcnt vmcnt(27) lgkmcnt(0)
v_mfma_f32_16x16x32_bf16 v[244:247], a[28:31], a[92:95], v[244:247]
s_barrier
s_add_u32 m0, s17, 0x10000
v_mfma_f32_16x16x32_bf16 v[240:243], a[24:27], a[92:95], v[240:243]
buffer_load_dwordx4 v5, s[56:59], 0 offen lds
v_mfma_f32_16x16x32_bf16 v[240:243], a[8:11], a[88:91], v[240:243]
ds_read_b64_tr_b16 a[80:81], v12 offset:0
v_mfma_f32_16x16x32_bf16 v[236:239], a[4:7], a[88:91], v[236:239]
ds_read_b64_tr_b16 a[82:83], v12 offset:1024
v_mfma_f32_16x16x32_bf16 v[236:239], a[20:23], a[92:95], v[236:239]
ds_read_b64_tr_b16 a[84:85], v12 offset:8192
v_mfma_f32_16x16x32_bf16 v[232:235], a[16:19], a[92:95], v[232:235]
ds_read_b64_tr_b16 a[86:87], v12 offset:9216
v_mfma_f32_16x16x32_bf16 v[232:235], a[0:3], a[88:91], v[232:235]
s_waitcnt lgkmcnt(4)
v_mfma_f32_16x16x32_bf16 v[248:251], a[0:3], a[96:99], v[248:251]
ds_read_b64_tr_b16 a[88:89], v13 offset:0
s_add_u32 m0, s17, 0x14000
v_mfma_f32_16x16x32_bf16 v[248:251], a[16:19], a[100:103], v[248:251]
buffer_load_dwordx4 v5, s[60:63], 0 offen lds
v_mfma_f32_16x16x32_bf16 v[252:255], a[20:23], a[100:103], v[252:255]
ds_read_b64_tr_b16 a[90:91], v13 offset:1024
v_mfma_f32_16x16x32_bf16 v[252:255], a[4:7], a[96:99], v[252:255]
ds_read_b64_tr_b16 a[92:93], v13 offset:8192
v_mfma_f32_16x16x32_bf16 a[232:235], a[8:11], a[96:99], a[232:235]
ds_read_b64_tr_b16 a[94:95], v13 offset:9216
v_mfma_f32_16x16x32_bf16 a[232:235], a[24:27], a[100:103], a[232:235]
v_mfma_f32_16x16x32_bf16 a[236:239], a[28:31], a[100:103], a[236:239]
v_mfma_f32_16x16x32_bf16 a[236:239], a[12:15], a[96:99], a[236:239]
s_add_u32 m0, s17, 0x10400
v_mfma_f32_16x16x32_bf16 a[252:255], a[12:15], a[104:107], a[252:255]
buffer_load_dwordx4 v5, s[56:59], s13 offen lds
v_mfma_f32_16x16x32_bf16 a[252:255], a[28:31], a[108:111], a[252:255]
ds_read_b64_tr_b16 a[96:97], v12 offset:256
v_mfma_f32_16x16x32_bf16 a[248:251], a[24:27], a[108:111], a[248:251]
ds_read_b64_tr_b16 a[98:99], v12 offset:1280
v_mfma_f32_16x16x32_bf16 a[248:251], a[8:11], a[104:107], a[248:251]
ds_read_b64_tr_b16 a[100:101], v12 offset:8448
v_mfma_f32_16x16x32_bf16 a[244:247], a[4:7], a[104:107], a[244:247]
ds_read_b64_tr_b16 a[102:103], v12 offset:9472
v_mfma_f32_16x16x32_bf16 a[244:247], a[20:23], a[108:111], a[244:247]
v_mfma_f32_16x16x32_bf16 a[240:243], a[16:19], a[108:111], a[240:243]
s_add_u32 m0, s17, 0x14400
s_waitcnt lgkmcnt(4)
v_mfma_f32_16x16x32_bf16 a[240:243], a[0:3], a[104:107], a[240:243]
buffer_load_dwordx4 v5, s[60:63], s13 offen lds
L_S3:
v_mfma_f32_16x16x32_bf16 v[24:27], a[80:83], a[32:35], v[24:27]
ds_read_b64_tr_b16 a[104:105], v13 offset:256
s_waitcnt vmcnt(22)
v_mfma_f32_16x16x32_bf16 v[24:27], a[84:87], a[48:51], v[24:27]
ds_read_b64_tr_b16 a[106:107], v13 offset:1280
v_mfma_f32_16x16x32_bf16 v[32:35], a[84:87], a[52:55], v[32:35]
ds_read_b64_tr_b16 a[108:109], v13 offset:8448
v_mfma_f32_16x16x32_bf16 v[32:35], a[80:83], a[36:39], v[32:35]
ds_read_b64_tr_b16 a[110:111], v13 offset:9472
v_mfma_f32_16x16x32_bf16 v[40:43], a[80:83], a[40:43], v[40:43]
ds_read_b128 a[0:3], v8 offset:0
v_mfma_f32_16x16x32_bf16 v[40:43], a[84:87], a[56:59], v[40:43]
ds_read_b128 a[16:19], v9 offset:0
s_add_u32 m0, s17, 0x10800
v_mfma_f32_16x16x32_bf16 v[48:51], a[84:87], a[60:63], v[48:51]
buffer_load_dwordx4 v6, s[56:59], 0 offen lds
v_mfma_f32_16x16x32_bf16 v[48:51], a[80:83], a[44:47], v[48:51]
ds_read_b128 a[4:7], v8 offset:2048
v_mfma_f32_16x16x32_bf16 v[52:55], a[88:91], a[44:47], v[52:55]
ds_read_b64_tr_b16 a[80:81], v12 offset:512
v_mfma_f32_16x16x32_bf16 v[52:55], a[92:95], a[60:63], v[52:55]
ds_read_b64_tr_b16 a[82:83], v12 offset:1536
v_mfma_f32_16x16x32_bf16 v[44:47], a[92:95], a[56:59], v[44:47]
ds_read_b64_tr_b16 a[84:85], v12 offset:8704
v_mfma_f32_16x16x32_bf16 v[44:47], a[88:91], a[40:43], v[44:47]
ds_read_b64_tr_b16 a[86:87], v12 offset:9728
v_mfma_f32_16x16x32_bf16 v[36:39], a[88:91], a[36:39], v[36:39]
ds_read_b128 a[20:23], v9 offset:2048
s_add_u32 m0, s17, 0x14800
v_mfma_f32_16x16x32_bf16 v[36:39], a[92:95], a[52:55], v[36:39]
buffer_load_dwordx4 v6, s[60:63], 0 offen lds
v_mfma_f32_16x16x32_bf16 v[28:31], a[92:95], a[48:51], v[28:31]
ds_read_b128 a[8:11], v8 offset:4096
v_mfma_f32_16x16x32_bf16 v[28:31], a[88:91], a[32:35], v[28:31]
ds_read_b128 a[24:27], v9 offset:4096
s_waitcnt lgkmcnt(10)
v_mfma_f32_16x16x32_bf16 v[56:59], a[96:99], a[32:35], v[56:59]
ds_read_b64_tr_b16 a[88:89], v13 offset:512
v_mfma_f32_16x16x32_bf16 v[56:59], a[100:103], a[48:51], v[56:59]
ds_read_b64_tr_b16 a[90:91], v13 offset:1536
v_mfma_f32_16x16x32_bf16 v[64:67], a[100:103], a[52:55], v[64:67]
ds_read_b64_tr_b16 a[92:93], v13 offset:8704
v_mfma_f32_16x16x32_bf16 v[64:67], a[96:99], a[36:39], v[64:67]
ds_read_b64_tr_b16 a[94:95], v13 offset:9728
s_add_u32 m0, s17, 0x10c00
v_mfma_f32_16x16x32_bf16 v[72:75], a[96:99], a[40:43], v[72:75]
buffer_load_dwordx4 v6, s[56:59], s13 offen lds
v_mfma_f32_16x16x32_bf16 v[72:75], a[100:103], a[56:59], v[72:75]
ds_read_b128 a[12:15], v8 offset:6144
v_mfma_f32_16x16x32_bf16 v[80:83], a[100:103], a[60:63], v[80:83]
ds_read_b128 a[28:31], v9 offset:6144
v_mfma_f32_16x16x32_bf16 v[80:83], a[96:99], a[44:47], v[80:83]
v_mfma_f32_16x16x32_bf16 v[84:87], a[104:107], a[44:47], v[84:87]
ds_read_b64_tr_b16 a[96:97], v12 offset:768
v_mfma_f32_16x16x32_bf16 v[84:87], a[108:111], a[60:63], v[84:87]
ds_read_b64_tr_b16 a[98:99], v12 offset:1792
v_mfma_f32_16x16x32_bf16 v[76:79], a[108:111], a[56:59], v[76:79]
ds_read_b64_tr_b16 a[100:101], v12 offset:8960
s_add_u32 m0, s17, 0x14c00
v_mfma_f32_16x16x32_bf16 v[76:79], a[104:107], a[40:43], v[76:79]
buffer_load_dwordx4 v6, s[60:63], s13 offen lds
v_mfma_f32_16x16x32_bf16 v[68:71], a[104:107], a[36:39], v[68:71]
ds_read_b64_tr_b16 a[102:103], v12 offset:9984
v_lshl_add_u32 v5, s42, 19, v5
v_mfma_f32_16x16x32_bf16 v[68:71], a[108:111], a[52:55], v[68:71]
v_lshl_add_u32 v6, s42, 19, v6
v_mfma_f32_16x16x32_bf16 v[60:63], a[108:111], a[48:51], v[60:63]
v_mfma_f32_16x16x32_bf16 v[60:63], a[104:107], a[32:35], v[60:63]
s_waitcnt lgkmcnt(6)
v_mfma_f32_16x16x32_bf16 v[88:91], a[80:83], a[32:35], v[88:91]
ds_read_b64_tr_b16 a[104:105], v13 offset:768
v_mfma_f32_16x16x32_bf16 v[88:91], a[84:87], a[48:51], v[88:91]
ds_read_b64_tr_b16 a[106:107], v13 offset:1792
s_mov_b32 s9, 0x200000
v_mfma_f32_16x16x32_bf16 v[96:99], a[84:87], a[52:55], v[96:99]
buffer_load_dword a120, v19, s[44:47], s9 offen
v_mfma_f32_16x16x32_bf16 v[96:99], a[80:83], a[36:39], v[96:99]
ds_read_b64_tr_b16 a[108:109], v13 offset:8960
v_mfma_f32_16x16x32_bf16 v[104:107], a[80:83], a[40:43], v[104:107]
ds_read_b64_tr_b16 a[110:111], v13 offset:9984
v_mfma_f32_16x16x32_bf16 v[104:107], a[84:87], a[56:59], v[104:107]
v_mfma_f32_16x16x32_bf16 v[112:115], a[84:87], a[60:63], v[112:115]
v_mfma_f32_16x16x32_bf16 v[112:115], a[80:83], a[44:47], v[112:115]
s_waitcnt lgkmcnt(8)
v_mfma_f32_16x16x32_bf16 v[116:119], a[88:91], a[44:47], v[116:119]
ds_read_b64_tr_b16 a[80:81], v12 offset:16384
s_add_u32 m0, s16, 0x0
v_mfma_f32_16x16x32_bf16 v[116:119], a[92:95], a[60:63], v[116:119]
buffer_load_dwordx4 v2, s[48:51], 0 offen lds
v_mfma_f32_16x16x32_bf16 v[108:111], a[92:95], a[56:59], v[108:111]
ds_read_b64_tr_b16 a[82:83], v12 offset:17408
v_mfma_f32_16x16x32_bf16 v[108:111], a[88:91], a[40:43], v[108:111]
ds_read_b64_tr_b16 a[84:85], v12 offset:24576
v_mfma_f32_16x16x32_bf16 v[100:103], a[88:91], a[36:39], v[100:103]
ds_read_b64_tr_b16 a[86:87], v12 offset:25600
v_mfma_f32_16x16x32_bf16 v[100:103], a[92:95], a[52:55], v[100:103]
v_mfma_f32_16x16x32_bf16 v[92:95], a[92:95], a[48:51], v[92:95]
v_mfma_f32_16x16x32_bf16 v[92:95], a[88:91], a[32:35], v[92:95]
s_add_u32 m0, s16, 0x400
s_waitcnt lgkmcnt(4)
v_mfma_f32_16x16x32_bf16 v[120:123], a[96:99], a[32:35], v[120:123]
buffer_load_dwordx4 v3, s[48:51], 0 offen lds
v_mfma_f32_16x16x32_bf16 v[120:123], a[100:103], a[48:51], v[120:123]
ds_read_b64_tr_b16 a[88:89], v13 offset:16384
v_mfma_f32_16x16x32_bf16 v[128:131], a[100:103], a[52:55], v[128:131]
ds_read_b64_tr_b16 a[90:91], v13 offset:17408
v_mfma_f32_16x16x32_bf16 v[128:131], a[96:99], a[36:39], v[128:131]
ds_read_b64_tr_b16 a[92:93], v13 offset:24576
v_mfma_f32_16x16x32_bf16 v[136:139], a[96:99], a[40:43], v[136:139]
ds_read_b64_tr_b16 a[94:95], v13 offset:25600
v_mfma_f32_16x16x32_bf16 v[136:139], a[100:103], a[56:59], v[136:139]
v_mfma_f32_16x16x32_bf16 v[144:147], a[100:103], a[60:63], v[144:147]
s_add_u32 m0, s16, 0x800
v_mfma_f32_16x16x32_bf16 v[144:147], a[96:99], a[44:47], v[144:147]
buffer_load_dwordx4 v2, s[48:51], s12 offen lds
v_mfma_f32_16x16x32_bf16 v[148:151], a[104:107], a[44:47], v[148:151]
ds_read_b64_tr_b16 a[96:97], v12 offset:16640
v_mfma_f32_16x16x32_bf16 v[148:151], a[108:111], a[60:63], v[148:151]
ds_read_b64_tr_b16 a[98:99], v12 offset:17664
v_mfma_f32_16x16x32_bf16 v[140:143], a[108:111], a[56:59], v[140:143]
ds_read_b64_tr_b16 a[100:101], v12 offset:24832
v_mfma_f32_16x16x32_bf16 v[140:143], a[104:107], a[40:43], v[140:143]
ds_read_b64_tr_b16 a[102:103], v12 offset:25856
v_mfma_f32_16x16x32_bf16 v[132:135], a[104:107], a[36:39], v[132:135]
v_mfma_f32_16x16x32_bf16 v[132:135], a[108:111], a[52:55], v[132:135]
s_add_u32 m0, s16, 0xc00
v_mfma_f32_16x16x32_bf16 v[124:127], a[108:111], a[48:51], v[124:127]
buffer_load_dwordx4 v3, s[48:51], s12 offen lds
v_mfma_f32_16x16x32_bf16 v[124:127], a[104:107], a[32:35], v[124:127]
s_waitcnt lgkmcnt(4)
v_mfma_f32_16x16x32_bf16 v[152:155], a[32:35], a[80:83], v[152:155]
ds_read_b64_tr_b16 a[104:105], v13 offset:16640
v_mfma_f32_16x16x32_bf16 v[152:155], a[48:51], a[84:87], v[152:155]
ds_read_b64_tr_b16 a[106:107], v13 offset:17664
v_mfma_f32_16x16x32_bf16 v[156:159], a[52:55], a[84:87], v[156:159]
ds_read_b64_tr_b16 a[108:109], v13 offset:24832
v_mfma_f32_16x16x32_bf16 v[156:159], a[36:39], a[80:83], v[156:159]
ds_read_b64_tr_b16 a[110:111], v13 offset:25856
v_mfma_f32_16x16x32_bf16 v[160:163], a[40:43], a[80:83], v[160:163]
s_add_u32 m0, s16, 0x1000
v_mfma_f32_16x16x32_bf16 v[160:163], a[56:59], a[84:87], v[160:163]
buffer_load_dwordx4 v2, s[48:51], s13 offen lds
v_mfma_f32_16x16x32_bf16 v[164:167], a[60:63], a[84:87], v[164:167]
v_mfma_f32_16x16x32_bf16 v[164:167], a[44:47], a[80:83], v[164:167]
v_mfma_f32_16x16x32_bf16 v[180:183], a[44:47], a[88:91], v[180:183]
ds_read_b64_tr_b16 a[80:81], v12 offset:16896
v_mfma_f32_16x16x32_bf16 v[180:183], a[60:63], a[92:95], v[180:183]
ds_read_b64_tr_b16 a[82:83], v12 offset:17920
v_mfma_f32_16x16x32_bf16 v[176:179], a[56:59], a[92:95], v[176:179]
ds_read_b64_tr_b16 a[84:85], v12 offset:25088
v_mfma_f32_16x16x32_bf16 v[176:179], a[40:43], a[88:91], v[176:179]
ds_read_b64_tr_b16 a[86:87], v12 offset:26112
s_add_u32 m0, s16, 0x1400
v_mfma_f32_16x16x32_bf16 v[172:175], a[36:39], a[88:91], v[172:175]
buffer_load_dwordx4 v3, s[48:51], s13 offen lds
v_mfma_f32_16x16x32_bf16 v[172:175], a[52:55], a[92:95], v[172:175]
v_mfma_f32_16x16x32_bf16 v[168:171], a[48:51], a[92:95], v[168:171]
v_mfma_f32_16x16x32_bf16 v[168:171], a[32:35], a[88:91], v[168:171]
s_waitcnt lgkmcnt(4)
v_mfma_f32_16x16x32_bf16 v[184:187], a[32:35], a[96:99], v[184:187]
ds_read_b64_tr_b16 a[88:89], v13 offset:16896
v_mfma_f32_16x16x32_bf16 v[184:187], a[48:51], a[100:103], v[184:187]
ds_read_b64_tr_b16 a[90:91], v13 offset:17920
v_mfma_f32_16x16x32_bf16 v[188:191], a[52:55], a[100:103], v[188:191]
ds_read_b64_tr_b16 a[92:93], v13 offset:25088
s_add_u32 m0, s16, 0x1800
v_mfma_f32_16x16x32_bf16 v[188:191], a[36:39], a[96:99], v[188:191]
buffer_load_dwordx4 v2, s[48:51], s14 offen lds
v_mfma_f32_16x16x32_bf16 v[192:195], a[40:43], a[96:99], v[192:195]
ds_read_b64_tr_b16 a[94:95], v13 offset:26112
v_mfma_f32_16x16x32_bf16 v[192:195], a[56:59], a[100:103], v[192:195]
v_mfma_f32_16x16x32_bf16 v[196:199], a[60:63], a[100:103], v[196:199]
v_mfma_f32_16x16x32_bf16 v[196:199], a[44:47], a[96:99], v[196:199]
v_mfma_f32_16x16x32_bf16 v[212:215], a[44:47], a[104:107], v[212:215]
ds_read_b64_tr_b16 a[96:97], v12 offset:17152
v_mfma_f32_16x16x32_bf16 v[212:215], a[60:63], a[108:111], v[212:215]
ds_read_b64_tr_b16 a[98:99], v12 offset:18176
s_add_u32 m0, s16, 0x1c00
v_mfma_f32_16x16x32_bf16 v[208:211], a[56:59], a[108:111], v[208:211]
buffer_load_dwordx4 v3, s[48:51], s14 offen lds
v_mfma_f32_16x16x32_bf16 v[208:211], a[40:43], a[104:107], v[208:211]
ds_read_b64_tr_b16 a[100:101], v12 offset:25344
v_lshl_add_u32 v2, s42, 7, v2
v_mfma_f32_16x16x32_bf16 v[204:207], a[36:39], a[104:107], v[204:207]
ds_read_b64_tr_b16 a[102:103], v12 offset:26368
v_lshl_add_u32 v3, s42, 7, v3
v_mfma_f32_16x16x32_bf16 v[204:207], a[52:55], a[108:111], v[204:207]
v_mfma_f32_16x16x32_bf16 v[200:203], a[48:51], a[108:111], v[200:203]
v_mfma_f32_16x16x32_bf16 v[200:203], a[32:35], a[104:107], v[200:203]
s_waitcnt lgkmcnt(4)
v_mfma_f32_16x16x32_bf16 v[216:219], a[32:35], a[80:83], v[216:219]
ds_read_b64_tr_b16 a[104:105], v13 offset:17152
s_mov_b32 s9, 0x0
v_mfma_f32_16x16x32_bf16 v[216:219], a[48:51], a[84:87], v[216:219]
buffer_load_dword a120, v18, s[52:55], s9 offen
v_mfma_f32_16x16x32_bf16 v[220:223], a[52:55], a[84:87], v[220:223]
ds_read_b64_tr_b16 a[106:107], v13 offset:18176
v_mfma_f32_16x16x32_bf16 v[220:223], a[36:39], a[80:83], v[220:223]
ds_read_b64_tr_b16 a[108:109], v13 offset:25344
v_mfma_f32_16x16x32_bf16 v[224:227], a[40:43], a[80:83], v[224:227]
ds_read_b64_tr_b16 a[110:111], v13 offset:26368
v_add_u32 v12, 0x8000, v12
v_mfma_f32_16x16x32_bf16 v[224:227], a[56:59], a[84:87], v[224:227]
v_add_u32 v13, 0x8000, v13
v_mfma_f32_16x16x32_bf16 v[228:231], a[60:63], a[84:87], v[228:231]
v_mfma_f32_16x16x32_bf16 v[228:231], a[44:47], a[80:83], v[228:231]
v_mfma_f32_16x16x32_bf16 v[244:247], a[44:47], a[88:91], v[244:247]
s_waitcnt vmcnt(27) lgkmcnt(0)
v_mfma_f32_16x16x32_bf16 v[244:247], a[60:63], a[92:95], v[244:247]
s_barrier
s_add_u32 m0, s17, 0x0
v_mfma_f32_16x16x32_bf16 v[240:243], a[56:59], a[92:95], v[240:243]
buffer_load_dwordx4 v5, s[56:59], 0 offen lds
v_mfma_f32_16x16x32_bf16 v[240:243], a[40:43], a[88:91], v[240:243]
ds_read_b64_tr_b16 a[80:81], v12 offset:0
v_mfma_f32_16x16x32_bf16 v[236:239], a[36:39], a[88:91], v[236:239]
ds_read_b64_tr_b16 a[82:83], v12 offset:1024
v_mfma_f32_16x16x32_bf16 v[236:239], a[52:55], a[92:95], v[236:239]
ds_read_b64_tr_b16 a[84:85], v12 offset:8192
v_mfma_f32_16x16x32_bf16 v[232:235], a[48:51], a[92:95], v[232:235]
ds_read_b64_tr_b16 a[86:87], v12 offset:9216
v_mfma_f32_16x16x32_bf16 v[232:235], a[32:35], a[88:91], v[232:235]
s_waitcnt lgkmcnt(4)
v_mfma_f32_16x16x32_bf16 v[248:251], a[32:35], a[96:99], v[248:251]
ds_read_b64_tr_b16 a[88:89], v13 offset:0
s_add_u32 m0, s17, 0x4000
v_mfma_f32_16x16x32_bf16 v[248:251], a[48:51], a[100:103], v[248:251]
buffer_load_dwordx4 v5, s[60:63], 0 offen lds
v_mfma_f32_16x16x32_bf16 v[252:255], a[52:55], a[100:103], v[252:255]
ds_read_b64_tr_b16 a[90:91], v13 offset:1024
v_mfma_f32_16x16x32_bf16 v[252:255], a[36:39], a[96:99], v[252:255]
ds_read_b64_tr_b16 a[92:93], v13 offset:8192
v_mfma_f32_16x16x32_bf16 a[232:235], a[40:43], a[96:99], a[232:235]
ds_read_b64_tr_b16 a[94:95], v13 offset:9216
v_mfma_f32_16x16x32_bf16 a[232:235], a[56:59], a[100:103], a[232:235]
L_padA2:
s_cmp_eq_u32 s95, 1
s_cbranch_scc1 L_padA6
v_mfma_f32_16x16x32_bf16 a[236:239], a[60:63], a[100:103], a[236:239]
v_mfma_f32_16x16x32_bf16 a[236:239], a[44:47], a[96:99], a[236:239]
s_add_u32 m0, s17, 0x400
v_mfma_f32_16x16x32_bf16 a[252:255], a[44:47], a[104:107], a[252:255]
buffer_load_dwordx4 v5, s[56:59], s13 offen lds
v_mfma_f32_16x16x32_bf16 a[252:255], a[60:63], a[108:111], a[252:255]
ds_read_b64_tr_b16 a[96:97], v12 offset:256
v_mfma_f32_16x16x32_bf16 a[248:251], a[56:59], a[108:111], a[248:251]
ds_read_b64_tr_b16 a[98:99], v12 offset:1280
v_mfma_f32_16x16x32_bf16 a[248:251], a[40:43], a[104:107], a[248:251]
ds_read_b64_tr_b16 a[100:101], v12 offset:8448
v_mfma_f32_16x16x32_bf16 a[244:247], a[36:39], a[104:107], a[244:247]
ds_read_b64_tr_b16 a[102:103], v12 offset:9472
v_mfma_f32_16x16x32_bf16 a[244:247], a[52:55], a[108:111], a[244:247]
v_mfma_f32_16x16x32_bf16 a[240:243], a[48:51], a[108:111], a[240:243]
v_mfma_f32_16x16x32_bf16 a[240:243], a[32:35], a[104:107], a[240:243]
s_add_u32 m0, s17, 0x4400
s_waitcnt lgkmcnt(4)
L_S4:
v_mfma_f32_16x16x32_bf16 v[24:27], a[80:83], a[0:3], v[24:27]
buffer_load_dwordx4 v5, s[60:63], s13 offen lds
v_mfma_f32_16x16x32_bf16 v[24:27], a[84:87], a[16:19], v[24:27]
ds_read_b64_tr_b16 a[104:105], v13 offset:256
s_waitcnt vmcnt(23)
v_mfma_f32_16x16x32_bf16 v[32:35], a[84:87], a[20:23], v[32:35]
ds_read_b64_tr_b16 a[106:107], v13 offset:1280
v_mfma_f32_16x16x32_bf16 v[32:35], a[80:83], a[4:7], v[32:35]
ds_read_b64_tr_b16 a[108:109], v13 offset:8448
v_mfma_f32_16x16x32_bf16 v[40:43], a[80:83], a[8:11], v[40:43]
ds_read_b64_tr_b16 a[110:111], v13 offset:9472
v_mfma_f32_16x16x32_bf16 v[40:43], a[84:87], a[24:27], v[40:43]
ds_read_b128 a[32:35], v8 offset:32768
v_mfma_f32_16x16x32_bf16 v[48:51], a[84:87], a[28:31], v[48:51]
ds_read_b128 a[48:51], v9 offset:32768
s_add_u32 m0, s17, 0x800
v_mfma_f32_16x16x32_bf16 v[48:51], a[80:83], a[12:15], v[48:51]
buffer_load_dwordx4 v6, s[56:59], 0 offen lds
v_mfma_f32_16x16x32_bf16 v[52:55], a[88:91], a[12:15], v[52:55]
ds_read_b64_tr_b16 a[80:81], v12 offset:512
v_mfma_f32_16x16x32_bf16 v[52:55], a[92:95], a[28:31], v[52:55]
ds_read_b64_tr_b16 a[82:83], v12 offset:1536
v_mfma_f32_16x16x32_bf16 v[44:47], a[92:95], a[24:27], v[44:47]
ds_read_b64_tr_b16 a[84:85], v12 offset:8704
v_mfma_f32_16x16x32_bf16 v[44:47], a[88:91], a[8:11], v[44:47]
ds_read_b64_tr_b16 a[86:87], v12 offset:9728
v_mfma_f32_16x16x32_bf16 v[36:39], a[88:91], a[4:7], v[36:39]
ds_read_b128 a[36:39], v8 offset:34816
v_mfma_f32_16x16x32_bf16 v[36:39], a[92:95], a[20:23], v[36:39]
ds_read_b128 a[52:55], v9 offset:34816
s_waitcnt lgkmcnt(8)
v_mfma_f32_16x16x32_bf16 v[28:31], a[92:95], a[16:19], v[28:31]
ds_read_b128 a[40:43], v8 offset:36864
s_add_u32 m0, s17, 0x4800
v_mfma_f32_16x16x32_bf16 v[28:31], a[88:91], a[0:3], v[28:31]
buffer_load_dwordx4 v6, s[60:63], 0 offen lds
v_mfma_f32_16x16x32_bf16 v[56:59], a[96:99], a[0:3], v[56:59]
ds_read_b64_tr_b16 a[88:89], v13 offset:512
v_mfma_f32_16x16x32_bf16 v[56:59], a[100:103], a[16:19], v[56:59]
ds_read_b64_tr_b16 a[90:91], v13 offset:1536
v_mfma_f32_16x16x32_bf16 v[64:67], a[100:103], a[20:23], v[64:67]
ds_read_b64_tr_b16 a[92:93], v13 offset:8704
v_mfma_f32_16x16x32_bf16 v[64:67], a[96:99], a[4:7], v[64:67]
ds_read_b64_tr_b16 a[94:95], v13 offset:9728
v_mfma_f32_16x16x32_bf16 v[72:75], a[96:99], a[8:11], v[72:75]
ds_read_b128 a[56:59], v9 offset:36864
v_mfma_f32_16x16x32_bf16 v[72:75], a[100:103], a[24:27], v[72:75]
ds_read_b128 a[44:47], v8 offset:38912
s_add_u32 m0, s17, 0xc00
v_mfma_f32_16x16x32_bf16 v[80:83], a[100:103], a[28:31], v[80:83]
buffer_load_dwordx4 v6, s[56:59], s13 offen lds
v_mfma_f32_16x16x32_bf16 v[80:83], a[96:99], a[12:15], v[80:83]
ds_read_b128 a[60:63], v9 offset:38912
v_mfma_f32_16x16x32_bf16 v[84:87], a[104:107], a[12:15], v[84:87]
ds_read_b64_tr_b16 a[96:97], v12 offset:768
v_mfma_f32_16x16x32_bf16 v[84:87], a[108:111], a[28:31], v[84:87]
ds_read_b64_tr_b16 a[98:99], v12 offset:1792
v_mfma_f32_16x16x32_bf16 v[76:79], a[108:111], a[24:27], v[76:79]
ds_read_b64_tr_b16 a[100:101], v12 offset:8960
v_mfma_f32_16x16x32_bf16 v[76:79], a[104:107], a[8:11], v[76:79]
ds_read_b64_tr_b16 a[102:103], v12 offset:9984
v_mfma_f32_16x16x32_bf16 v[68:71], a[104:107], a[4:7], v[68:71]
s_add_u32 m0, s17, 0x4c00
v_mfma_f32_16x16x32_bf16 v[68:71], a[108:111], a[20:23], v[68:71]
buffer_load_dwordx4 v6, s[60:63], s13 offen lds
v_mfma_f32_16x16x32_bf16 v[60:63], a[108:111], a[16:19], v[60:63]
v_lshl_add_u32 v5, s42, 19, v5
v_lshl_add_u32 v6, s42, 19, v6
v_mfma_f32_16x16x32_bf16 v[60:63], a[104:107], a[0:3], v[60:63]
s_waitcnt lgkmcnt(7)
v_mfma_f32_16x16x32_bf16 v[88:91], a[80:83], a[0:3], v[88:91]
ds_read_b64_tr_b16 a[104:105], v13 offset:768
v_mfma_f32_16x16x32_bf16 v[88:91], a[84:87], a[16:19], v[88:91]
ds_read_b64_tr_b16 a[106:107], v13 offset:1792
v_mfma_f32_16x16x32_bf16 v[96:99], a[84:87], a[20:23], v[96:99]
ds_read_b64_tr_b16 a[108:109], v13 offset:8960
v_mfma_f32_16x16x32_bf16 v[96:99], a[80:83], a[4:7], v[96:99]
ds_read_b64_tr_b16 a[110:111], v13 offset:9984
v_mfma_f32_16x16x32_bf16 v[104:107], a[80:83], a[8:11], v[104:107]
s_add_u32 m0, s16, 0x8000
s_waitcnt lgkmcnt(8)
v_mfma_f32_16x16x32_bf16 v[104:107], a[84:87], a[24:27], v[104:107]
buffer_load_dwordx4 v2, s[48:51], 0 offen lds
v_mfma_f32_16x16x32_bf16 v[112:115], a[84:87], a[28:31], v[112:115]
v_mfma_f32_16x16x32_bf16 v[112:115], a[80:83], a[12:15], v[112:115]
v_mfma_f32_16x16x32_bf16 v[116:119], a[88:91], a[12:15], v[116:119]
ds_read_b64_tr_b16 a[80:81], v12 offset:16384
v_mfma_f32_16x16x32_bf16 v[116:119], a[92:95], a[28:31], v[116:119]
ds_read_b64_tr_b16 a[82:83], v12 offset:17408
v_mfma_f32_16x16x32_bf16 v[108:111], a[92:95], a[24:27], v[108:111]
ds_read_b64_tr_b16 a[84:85], v12 offset:24576
v_mfma_f32_16x16x32_bf16 v[108:111], a[88:91], a[8:11], v[108:111]
ds_read_b64_tr_b16 a[86:87], v12 offset:25600
s_add_u32 m0, s16, 0x8400
v_mfma_f32_16x16x32_bf16 v[100:103], a[88:91], a[4:7], v[100:103]
buffer_load_dwordx4 v3, s[48:51], 0 offen lds
v_mfma_f32_16x16x32_bf16 v[100:103], a[92:95], a[20:23], v[100:103]
v_mfma_f32_16x16x32_bf16 v[92:95], a[92:95], a[16:19], v[92:95]
v_mfma_f32_16x16x32_bf16 v[92:95], a[88:91], a[0:3], v[92:95]
s_waitcnt lgkmcnt(4)
v_mfma_f32_16x16x32_bf16 v[120:123], a[96:99], a[0:3], v[120:123]
ds_read_b64_tr_b16 a[88:89], v13 offset:16384
v_mfma_f32_16x16x32_bf16 v[120:123], a[100:103], a[16:19], v[120:123]
ds_read_b64_tr_b16 a[90:91], v13 offset:17408
v_mfma_f32_16x16x32_bf16 v[128:131], a[100:103], a[20:23], v[128:131]
ds_read_b64_tr_b16 a[92:93], v13 offset:24576
v_mfma_f32_16x16x32_bf16 v[128:131], a[96:99], a[4:7], v[128:131]
ds_read_b64_tr_b16 a[94:95], v13 offset:25600
s_add_u32 m0, s16, 0x8800
v_mfma_f32_16x16x32_bf16 v[136:139], a[96:99], a[8:11], v[136:139]
buffer_load_dwordx4 v2, s[48:51], s12 offen lds
v_mfma_f32_16x16x32_bf16 v[136:139], a[100:103], a[24:27], v[136:139]
v_mfma_f32_16x16x32_bf16 v[144:147], a[100:103], a[28:31], v[144:147]
v_mfma_f32_16x16x32_bf16 v[144:147], a[96:99], a[12:15], v[144:147]
v_mfma_f32_16x16x32_bf16 v[148:151], a[104:107], a[12:15], v[148:151]
ds_read_b64_tr_b16 a[96:97], v12 offset:16640
v_mfma_f32_16x16x32_bf16 v[148:151], a[108:111], a[28:31], v[148:151]
ds_read_b64_tr_b16 a[98:99], v12 offset:17664
v_mfma_f32_16x16x32_bf16 v[140:143], a[108:111], a[24:27], v[140:143]
ds_read_b64_tr_b16 a[100:101], v12 offset:24832
s_add_u32 m0, s16, 0x8c00
v_mfma_f32_16x16x32_bf16 v[140:143], a[104:107], a[8:11], v[140:143]
buffer_load_dwordx4 v3, s[48:51], s12 offen lds
v_mfma_f32_16x16x32_bf16 v[132:135], a[104:107], a[4:7], v[132:135]
ds_read_b64_tr_b16 a[102:103], v12 offset:25856
v_mfma_f32_16x16x32_bf16 v[132:135], a[108:111], a[20:23], v[132:135]
v_mfma_f32_16x16x32_bf16 v[124:127], a[108:111], a[16:19], v[124:127]
v_mfma_f32_16x16x32_bf16 v[124:127], a[104:107], a[0:3], v[124:127]
s_waitcnt lgkmcnt(4)
v_mfma_f32_16x16x32_bf16 v[152:155], a[0:3], a[80:83], v[152:155]
ds_read_b64_tr_b16 a[104:105], v13 offset:16640
v_mfma_f32_16x16x32_bf16 v[152:155], a[16:19], a[84:87], v[152:155]
ds_read_b64_tr_b16 a[106:107], v13 offset:17664
s_add_u32 m0, s16, 0x9000
v_mfma_f32_16x16x32_bf16 v[156:159], a[20:23], a[84:87], v[156:159]
buffer_load_dwordx4 v2, s[48:51], s13 offen lds
v_mfma_f32_16x16x32_bf16 v[156:159], a[4:7], a[80:83], v[156:159]
ds_read_b64_tr_b16 a[108:109], v13 offset:24832
v_mfma_f32_16x16x32_bf16 v[160:163], a[8:11], a[80:83], v[160:163]
ds_read_b64_tr_b16 a[110:111], v13 offset:25856
v_mfma_f32_16x16x32_bf16 v[160:163], a[24:27], a[84:87], v[160:163]
v_mfma_f32_16x16x32_bf16 v[164:167], a[28:31], a[84:87], v[164:167]
v_mfma_f32_16x16x32_bf16 v[164:167], a[12:15], a[80:83], v[164:167]
v_mfma_f32_16x16x32_bf16 v[180:183], a[12:15], a[88:91], v[180:183]
ds_read_b64_tr_b16 a[80:81], v12 offset:16896
v_mfma_f32_16x16x32_bf16 v[180:183], a[28:31], a[92:95], v[180:183]
ds_read_b64_tr_b16 a[82:83], v12 offset:17920
s_add_u32 m0, s16, 0x9400
v_mfma_f32_16x16x32_bf16 v[176:179], a[24:27], a[92:95], v[176:179]
buffer_load_dwordx4 v3, s[48:51], s13 offen lds
v_mfma_f32_16x16x32_bf16 v[176:179], a[8:11], a[88:91], v[176:179]
ds_read_b64_tr_b16 a[84:85], v12 offset:25088
v_mfma_f32_16x16x32_bf16 v[172:175], a[4:7], a[88:91], v[172:175]
ds_read_b64_tr_b16 a[86:87], v12 offset:26112
v_mfma_f32_16x16x32_bf16 v[172:175], a[20:23], a[92:95], v[172:175]
v_mfma_f32_16x16x32_bf16 v[168:171], a[16:19], a[92:95], v[168:171]
v_mfma_f32_16x16x32_bf16 v[168:171], a[0:3], a[88:91], v[168:171]
s_waitcnt lgkmcnt(4)
v_mfma_f32_16x16x32_bf16 v[184:187], a[0:3], a[96:99], v[184:187]
ds_read_b64_tr_b16 a[88:89], v13 offset:16896
s_add_u32 m0, s16, 0x9800
v_mfma_f32_16x16x32_bf16 v[184:187], a[16:19], a[100:103], v[184:187]
buffer_load_dwordx4 v2, s[48:51], s14 offen lds
v_mfma_f32_16x16x32_bf16 v[188:191], a[20:23], a[100:103], v[188:191]
ds_read_b64_tr_b16 a[90:91], v13 offset:17920
v_mfma_f32_16x16x32_bf16 v[188:191], a[4:7], a[96:99], v[188:191]
ds_read_b64_tr_b16 a[92:93], v13 offset:25088
v_mfma_f32_16x16x32_bf16 v[192:195], a[8:11], a[96:99], v[192:195]
ds_read_b64_tr_b16 a[94:95], v13 offset:26112
v_mfma_f32_16x16x32_bf16 v[192:195], a[24:27], a[100:103], v[192:195]
v_mfma_f32_16x16x32_bf16 v[196:199], a[28:31], a[100:103], v[196:199]
v_mfma_f32_16x16x32_bf16 v[196:199], a[12:15], a[96:99], v[196:199]
v_mfma_f32_16x16x32_bf16 v[212:215], a[12:15], a[104:107], v[212:215]
ds_read_b64_tr_b16 a[96:97], v12 offset:17152
s_add_u32 m0, s16, 0x9c00
v_mfma_f32_16x16x32_bf16 v[212:215], a[28:31], a[108:111], v[212:215]
buffer_load_dwordx4 v3, s[48:51], s14 offen lds
v_mfma_f32_16x16x32_bf16 v[208:211], a[24:27], a[108:111], v[208:211]
ds_read_b64_tr_b16 a[98:99], v12 offset:18176
s_sub_u32 s42, s43, s41
v_mfma_f32_16x16x32_bf16 v[208:211], a[8:11], a[104:107], v[208:211]
ds_read_b64_tr_b16 a[100:101], v12 offset:25344
s_mov_b32 s41, s43
v_mfma_f32_16x16x32_bf16 v[204:207], a[4:7], a[104:107], v[204:207]
ds_read_b64_tr_b16 a[102:103], v12 offset:26368
v_mfma_f32_16x16x32_bf16 v[204:207], a[20:23], a[108:111], v[204:207]
v_mfma_f32_16x16x32_bf16 v[200:203], a[16:19], a[108:111], v[200:203]
v_mfma_f32_16x16x32_bf16 v[200:203], a[0:3], a[104:107], v[200:203]
s_mov_b32 s9, 0x0
s_waitcnt lgkmcnt(4)
v_mfma_f32_16x16x32_bf16 v[216:219], a[0:3], a[80:83], v[216:219]
buffer_load_dword a120, v19, s[68:71], s9 offen
v_mfma_f32_16x16x32_bf16 v[216:219], a[16:19], a[84:87], v[216:219]
ds_read_b64_tr_b16 a[104:105], v13 offset:17152
v_mfma_f32_16x16x32_bf16 v[220:223], a[20:23], a[84:87], v[220:223]
ds_read_b64_tr_b16 a[106:107], v13 offset:18176
v_mfma_f32_16x16x32_bf16 v[220:223], a[4:7], a[80:83], v[220:223]
ds_read_b64_tr_b16 a[108:109], v13 offset:25344
v_mfma_f32_16x16x32_bf16 v[224:227], a[8:11], a[80:83], v[224:227]
ds_read_b64_tr_b16 a[110:111], v13 offset:26368
v_add_u32 v12, 0x8000, v12
v_mfma_f32_16x16x32_bf16 v[224:227], a[24:27], a[84:87], v[224:227]
v_add_u32 v13, 0x8000, v13
v_mfma_f32_16x16x32_bf16 v[228:231], a[28:31], a[84:87], v[228:231]
v_mfma_f32_16x16x32_bf16 v[228:231], a[12:15], a[80:83], v[228:231]
v_mfma_f32_16x16x32_bf16 v[244:247], a[12:15], a[88:91], v[244:247]
s_waitcnt vmcnt(27) lgkmcnt(0)
v_mfma_f32_16x16x32_bf16 v[244:247], a[28:31], a[92:95], v[244:247]
s_barrier
s_add_u32 m0, s17, 0x8000
v_mfma_f32_16x16x32_bf16 v[240:243], a[24:27], a[92:95], v[240:243]
buffer_load_dwordx4 v5, s[56:59], 0 offen lds
v_mfma_f32_16x16x32_bf16 v[240:243], a[8:11], a[88:91], v[240:243]
ds_read_b64_tr_b16 a[80:81], v12 offset:0
v_mfma_f32_16x16x32_bf16 v[236:239], a[4:7], a[88:91], v[236:239]
ds_read_b64_tr_b16 a[82:83], v12 offset:1024
v_mfma_f32_16x16x32_bf16 v[236:239], a[20:23], a[92:95], v[236:239]
ds_read_b64_tr_b16 a[84:85], v12 offset:8192
v_mfma_f32_16x16x32_bf16 v[232:235], a[16:19], a[92:95], v[232:235]
ds_read_b64_tr_b16 a[86:87], v12 offset:9216
v_mfma_f32_16x16x32_bf16 v[232:235], a[0:3], a[88:91], v[232:235]
s_add_u32 m0, s17, 0xc000
s_waitcnt lgkmcnt(4)
v_mfma_f32_16x16x32_bf16 v[248:251], a[0:3], a[96:99], v[248:251]
buffer_load_dwordx4 v5, s[60:63], 0 offen lds
v_mfma_f32_16x16x32_bf16 v[248:251], a[16:19], a[100:103], v[248:251]
ds_read_b64_tr_b16 a[88:89], v13 offset:0
v_mfma_f32_16x16x32_bf16 v[252:255], a[20:23], a[100:103], v[252:255]
ds_read_b64_tr_b16 a[90:91], v13 offset:1024
v_mfma_f32_16x16x32_bf16 v[252:255], a[4:7], a[96:99], v[252:255]
ds_read_b64_tr_b16 a[92:93], v13 offset:8192
v_mfma_f32_16x16x32_bf16 a[232:235], a[8:11], a[96:99], a[232:235]
ds_read_b64_tr_b16 a[94:95], v13 offset:9216
v_mfma_f32_16x16x32_bf16 a[232:235], a[24:27], a[100:103], a[232:235]
v_mfma_f32_16x16x32_bf16 a[236:239], a[28:31], a[100:103], a[236:239]
s_add_u32 m0, s17, 0x8400
v_mfma_f32_16x16x32_bf16 a[236:239], a[12:15], a[96:99], a[236:239]
buffer_load_dwordx4 v5, s[56:59], s13 offen lds
v_mfma_f32_16x16x32_bf16 a[252:255], a[12:15], a[104:107], a[252:255]
ds_read_b64_tr_b16 a[96:97], v12 offset:256
v_mfma_f32_16x16x32_bf16 a[252:255], a[28:31], a[108:111], a[252:255]
ds_read_b64_tr_b16 a[98:99], v12 offset:1280
v_mfma_f32_16x16x32_bf16 a[248:251], a[24:27], a[108:111], a[248:251]
ds_read_b64_tr_b16 a[100:101], v12 offset:8448
v_mfma_f32_16x16x32_bf16 a[248:251], a[8:11], a[104:107], a[248:251]
ds_read_b64_tr_b16 a[102:103], v12 offset:9472
v_mfma_f32_16x16x32_bf16 a[244:247], a[4:7], a[104:107], a[244:247]
s_add_u32 m0, s17, 0xc400
v_mfma_f32_16x16x32_bf16 a[244:247], a[20:23], a[108:111], a[244:247]
buffer_load_dwordx4 v5, s[60:63], s13 offen lds
v_mfma_f32_16x16x32_bf16 a[240:243], a[16:19], a[108:111], a[240:243]
v_mfma_f32_16x16x32_bf16 a[240:243], a[0:3], a[104:107], a[240:243]
s_waitcnt lgkmcnt(4)
L_S5:
v_mfma_f32_16x16x32_bf16 v[24:27], a[80:83], a[32:35], v[24:27]
ds_read_b64_tr_b16 a[104:105], v13 offset:256
s_waitcnt vmcnt(22)
v_mfma_f32_16x16x32_bf16 v[24:27], a[84:87], a[48:51], v[24:27]
ds_read_b64_tr_b16 a[106:107], v13 offset:1280
v_mfma_f32_16x16x32_bf16 v[32:35], a[84:87], a[52:55], v[32:35]
ds_read_b64_tr_b16 a[108:109], v13 offset:8448
v_mfma_f32_16x16x32_bf16 v[32:35], a[80:83], a[36:39], v[32:35]
ds_read_b64_tr_b16 a[110:111], v13 offset:9472
s_add_u32 m0, s17, 0x8800
v_mfma_f32_16x16x32_bf16 v[40:43], a[80:83], a[40:43], v[40:43]
buffer_load_dwordx4 v6, s[56:59], 0 offen lds
v_mfma_f32_16x16x32_bf16 v[40:43], a[84:87], a[56:59], v[40:43]
ds_read_b128 a[0:3], v8 offset:0
v_mfma_f32_16x16x32_bf16 v[48:51], a[84:87], a[60:63], v[48:51]
ds_read_b128 a[16:19], v9 offset:0
v_mfma_f32_16x16x32_bf16 v[48:51], a[80:83], a[44:47], v[48:51]
ds_read_b128 a[4:7], v8 offset:2048
v_mfma_f32_16x16x32_bf16 v[52:55], a[88:91], a[44:47], v[52:55]
ds_read_b64_tr_b16 a[80:81], v12 offset:512
v_mfma_f32_16x16x32_bf16 v[52:55], a[92:95], a[60:63], v[52:55]
ds_read_b64_tr_b16 a[82:83], v12 offset:1536
v_mfma_f32_16x16x32_bf16 v[44:47], a[92:95], a[56:59], v[44:47]
ds_read_b64_tr_b16 a[84:85], v12 offset:8704
s_mov_b32 s9, 0x200000
v_mfma_f32_16x16x32_bf16 v[44:47], a[88:91], a[40:43], v[44:47]
buffer_load_dword a120, v18, s[52:55], s9 offen
v_mfma_f32_16x16x32_bf16 v[36:39], a[88:91], a[36:39], v[36:39]
ds_read_b64_tr_b16 a[86:87], v12 offset:9728
v_mfma_f32_16x16x32_bf16 v[36:39], a[92:95], a[52:55], v[36:39]
ds_read_b128 a[20:23], v9 offset:2048
v_mfma_f32_16x16x32_bf16 v[28:31], a[92:95], a[48:51], v[28:31]
ds_read_b128 a[8:11], v8 offset:4096
v_mfma_f32_16x16x32_bf16 v[28:31], a[88:91], a[32:35], v[28:31]
ds_read_b128 a[24:27], v9 offset:4096
s_waitcnt lgkmcnt(10)
v_mfma_f32_16x16x32_bf16 v[56:59], a[96:99], a[32:35], v[56:59]
ds_read_b64_tr_b16 a[88:89], v13 offset:512
s_add_u32 m0, s17, 0xc800
v_mfma_f32_16x16x32_bf16 v[56:59], a[100:103], a[48:51], v[56:59]
buffer_load_dwordx4 v6, s[60:63], 0 offen lds
v_mfma_f32_16x16x32_bf16 v[64:67], a[100:103], a[52:55], v[64:67]
ds_read_b64_tr_b16 a[90:91], v13 offset:1536
v_mfma_f32_16x16x32_bf16 v[64:67], a[96:99], a[36:39], v[64:67]
ds_read_b64_tr_b16 a[92:93], v13 offset:8704
v_mfma_f32_16x16x32_bf16 v[72:75], a[96:99], a[40:43], v[72:75]
ds_read_b64_tr_b16 a[94:95], v13 offset:9728
v_mfma_f32_16x16x32_bf16 v[72:75], a[100:103], a[56:59], v[72:75]
ds_read_b128 a[12:15], v8 offset:6144
v_mfma_f32_16x16x32_bf16 v[80:83], a[100:103], a[60:63], v[80:83]
ds_read_b128 a[28:31], v9 offset:6144
v_mfma_f32_16x16x32_bf16 v[80:83], a[96:99], a[44:47], v[80:83]
s_add_u32 m0, s17, 0x8c00
v_mfma_f32_16x16x32_bf16 v[84:87], a[104:107], a[44:47], v[84:87]
buffer_load_dwordx4 v6, s[56:59], s13 offen lds
v_mfma_f32_16x16x32_bf16 v[84:87], a[108:111], a[60:63], v[84:87]
ds_read_b64_tr_b16 a[96:97], v12 offset:768
v_mfma_f32_16x16x32_bf16 v[76:79], a[108:111], a[56:59], v[76:79]
ds_read_b64_tr_b16 a[98:99], v12 offset:1792
v_mfma_f32_16x16x32_bf16 v[76:79], a[104:107], a[40:43], v[76:79]
ds_read_b64_tr_b16 a[100:101], v12 offset:8960
v_mfma_f32_16x16x32_bf16 v[68:71], a[104:107], a[36:39], v[68:71]
ds_read_b64_tr_b16 a[102:103], v12 offset:9984
v_mfma_f32_16x16x32_bf16 v[68:71], a[108:111], a[52:55], v[68:71]
v_mfma_f32_16x16x32_bf16 v[60:63], a[108:111], a[48:51], v[60:63]
s_add_u32 m0, s17, 0xcc00
s_waitcnt lgkmcnt(6)
v_mfma_f32_16x16x32_bf16 v[60:63], a[104:107], a[32:35], v[60:63]
buffer_load_dwordx4 v6, s[60:63], s13 offen lds
v_mfma_f32_16x16x32_bf16 v[88:91], a[80:83], a[32:35], v[88:91]
ds_read_b64_tr_b16 a[104:105], v13 offset:768
v_lshl_add_u32 v5, s42, 19, v5
v_mfma_f32_16x16x32_bf16 v[88:91], a[84:87], a[48:51], v[88:91]
ds_read_b64_tr_b16 a[106:107], v13 offset:1792
v_lshl_add_u32 v6, s42, 19, v6
v_mfma_f32_16x16x32_bf16 v[96:99], a[84:87], a[52:55], v[96:99]
ds_read_b64_tr_b16 a[108:109], v13 offset:8960
v_mfma_f32_16x16x32_bf16 v[96:99], a[80:83], a[36:39], v[96:99]
ds_read_b64_tr_b16 a[110:111], v13 offset:9984
v_mfma_f32_16x16x32_bf16 v[104:107], a[80:83], a[40:43], v[104:107]
s_add_u32 m0, s16, 0x0
s_waitcnt lgkmcnt(8)
v_mfma_f32_16x16x32_bf16 v[104:107], a[84:87], a[56:59], v[104:107]
buffer_load_dwordx4 v22, s[44:47], s20 offen lds
v_mfma_f32_16x16x32_bf16 v[112:115], a[84:87], a[60:63], v[112:115]
v_mfma_f32_16x16x32_bf16 v[112:115], a[80:83], a[44:47], v[112:115]
v_mfma_f32_16x16x32_bf16 v[116:119], a[88:91], a[44:47], v[116:119]
ds_read_b64_tr_b16 a[80:81], v12 offset:16384
v_mfma_f32_16x16x32_bf16 v[116:119], a[92:95], a[60:63], v[116:119]
ds_read_b64_tr_b16 a[82:83], v12 offset:17408
v_mfma_f32_16x16x32_bf16 v[108:111], a[92:95], a[56:59], v[108:111]
ds_read_b64_tr_b16 a[84:85], v12 offset:24576
v_mfma_f32_16x16x32_bf16 v[108:111], a[88:91], a[40:43], v[108:111]
ds_read_b64_tr_b16 a[86:87], v12 offset:25600
s_add_u32 m0, s16, 0x400
v_mfma_f32_16x16x32_bf16 v[100:103], a[88:91], a[36:39], v[100:103]
buffer_load_dwordx4 v23, s[44:47], s20 offen lds
v_mfma_f32_16x16x32_bf16 v[100:103], a[92:95], a[52:55], v[100:103]
v_mfma_f32_16x16x32_bf16 v[92:95], a[92:95], a[48:51], v[92:95]
v_mfma_f32_16x16x32_bf16 v[92:95], a[88:91], a[32:35], v[92:95]
s_waitcnt lgkmcnt(4)
v_mfma_f32_16x16x32_bf16 v[120:123], a[96:99], a[32:35], v[120:123]
ds_read_b64_tr_b16 a[88:89], v13 offset:16384
v_mfma_f32_16x16x32_bf16 v[120:123], a[100:103], a[48:51], v[120:123]
ds_read_b64_tr_b16 a[90:91], v13 offset:17408
s_mov_b32 s9, 0x200000
v_mfma_f32_16x16x32_bf16 v[128:131], a[100:103], a[52:55], v[128:131]
buffer_load_dword a120, v19, s[68:71], s9 offen
v_mfma_f32_16x16x32_bf16 v[128:131], a[96:99], a[36:39], v[128:131]
ds_read_b64_tr_b16 a[92:93], v13 offset:24576
v_mfma_f32_16x16x32_bf16 v[136:139], a[96:99], a[40:43], v[136:139]
ds_read_b64_tr_b16 a[94:95], v13 offset:25600
v_mfma_f32_16x16x32_bf16 v[136:139], a[100:103], a[56:59], v[136:139]
v_mfma_f32_16x16x32_bf16 v[144:147], a[100:103], a[60:63], v[144:147]
v_mfma_f32_16x16x32_bf16 v[144:147], a[96:99], a[44:47], v[144:147]
v_mfma_f32_16x16x32_bf16 v[148:151], a[104:107], a[44:47], v[148:151]
ds_read_b64_tr_b16 a[96:97], v12 offset:16640
s_add_u32 m0, s16, 0x800
v_mfma_f32_16x16x32_bf16 v[148:151], a[108:111], a[60:63], v[148:151]
buffer_load_dwordx4 v22, s[44:47], s21 offen lds
v_mfma_f32_16x16x32_bf16 v[140:143], a[108:111], a[56:59], v[140:143]
ds_read_b64_tr_b16 a[98:99], v12 offset:17664
v_mfma_f32_16x16x32_bf16 v[140:143], a[104:107], a[40:43], v[140:143]
ds_read_b64_tr_b16 a[100:101], v12 offset:24832
v_mfma_f32_16x16x32_bf16 v[132:135], a[104:107], a[36:39], v[132:135]
ds_read_b64_tr_b16 a[102:103], v12 offset:25856
v_mfma_f32_16x16x32_bf16 v[132:135], a[108:111], a[52:55], v[132:135]
v_mfma_f32_16x16x32_bf16 v[124:127], a[108:111], a[48:51], v[124:127]
v_mfma_f32_16x16x32_bf16 v[124:127], a[104:107], a[32:35], v[124:127]
s_add_u32 m0, s16, 0xc00
s_waitcnt lgkmcnt(4)
v_mfma_f32_16x16x32_bf16 v[152:155], a[32:35], a[80:83], v[152:155]
buffer_load_dwordx4 v23, s[44:47], s21 offen lds
v_mfma_f32_16x16x32_bf16 v[152:155], a[48:51], a[84:87], v[152:155]
ds_read_b64_tr_b16 a[104:105], v13 offset:16640
v_mfma_f32_16x16x32_bf16 v[156:159], a[52:55], a[84:87], v[156:159]
ds_read_b64_tr_b16 a[106:107], v13 offset:17664
v_mfma_f32_16x16x32_bf16 v[156:159], a[36:39], a[80:83], v[156:159]
ds_read_b64_tr_b16 a[108:109], v13 offset:24832
v_mfma_f32_16x16x32_bf16 v[160:163], a[40:43], a[80:83], v[160:163]
ds_read_b64_tr_b16 a[110:111], v13 offset:25856
v_mfma_f32_16x16x32_bf16 v[160:163], a[56:59], a[84:87], v[160:163]
s_add_u32 m0, s16, 0x1000
v_mfma_f32_16x16x32_bf16 v[164:167], a[60:63], a[84:87], v[164:167]
buffer_load_dwordx4 v22, s[44:47], s22 offen lds
v_mfma_f32_16x16x32_bf16 v[164:167], a[44:47], a[80:83], v[164:167]
v_mfma_f32_16x16x32_bf16 v[180:183], a[44:47], a[88:91], v[180:183]
ds_read_b64_tr_b16 a[80:81], v12 offset:16896
v_mfma_f32_16x16x32_bf16 v[180:183], a[60:63], a[92:95], v[180:183]
ds_read_b64_tr_b16 a[82:83], v12 offset:17920
v_mfma_f32_16x16x32_bf16 v[176:179], a[56:59], a[92:95], v[176:179]
ds_read_b64_tr_b16 a[84:85], v12 offset:25088
v_mfma_f32_16x16x32_bf16 v[176:179], a[40:43], a[88:91], v[176:179]
ds_read_b64_tr_b16 a[86:87], v12 offset:26112
v_mfma_f32_16x16x32_bf16 v[172:175], a[36:39], a[88:91], v[172:175]
s_add_u32 m0, s16, 0x1400
v_mfma_f32_16x16x32_bf16 v[172:175], a[52:55], a[92:95], v[172:175]
buffer_load_dwordx4 v23, s[44:47], s22 offen lds
v_mfma_f32_16x16x32_bf16 v[168:171], a[48:51], a[92:95], v[168:171]
v_mfma_f32_16x16x32_bf16 v[168:171], a[32:35], a[88:91], v[168:171]
s_waitcnt lgkmcnt(4)
v_mfma_f32_16x16x32_bf16 v[184:187], a[32:35], a[96:99], v[184:187]
ds_read_b64_tr_b16 a[88:89], v13 offset:16896
v_mfma_f32_16x16x32_bf16 v[184:187], a[48:51], a[100:103], v[184:187]
ds_read_b64_tr_b16 a[90:91], v13 offset:17920
v_mfma_f32_16x16x32_bf16 v[188:191], a[52:55], a[100:103], v[188:191]
ds_read_b64_tr_b16 a[92:93], v13 offset:25088
v_mfma_f32_16x16x32_bf16 v[188:191], a[36:39], a[96:99], v[188:191]
ds_read_b64_tr_b16 a[94:95], v13 offset:26112
s_add_u32 m0, s16, 0x1800
v_mfma_f32_16x16x32_bf16 v[192:195], a[40:43], a[96:99], v[192:195]
buffer_load_dwordx4 v22, s[44:47], s23 offen lds
v_mfma_f32_16x16x32_bf16 v[192:195], a[56:59], a[100:103], v[192:195]
v_mfma_f32_16x16x32_bf16 v[196:199], a[60:63], a[100:103], v[196:199]
v_mfma_f32_16x16x32_bf16 v[196:199], a[44:47], a[96:99], v[196:199]
v_mfma_f32_16x16x32_bf16 v[212:215], a[44:47], a[104:107], v[212:215]
ds_read_b64_tr_b16 a[96:97], v12 offset:17152
v_mfma_f32_16x16x32_bf16 v[212:215], a[60:63], a[108:111], v[212:215]
ds_read_b64_tr_b16 a[98:99], v12 offset:18176
s_add_u32 m0, s16, 0x1c00
v_mfma_f32_16x16x32_bf16 v[208:211], a[56:59], a[108:111], v[208:211]
buffer_load_dwordx4 v23, s[44:47], s23 offen lds
v_mfma_f32_16x16x32_bf16 v[208:211], a[40:43], a[104:107], v[208:211]
ds_read_b64_tr_b16 a[100:101], v12 offset:25344
s_mov_b32 s42, 1
v_mfma_f32_16x16x32_bf16 v[204:207], a[36:39], a[104:107], v[204:207]
ds_read_b64_tr_b16 a[102:103], v12 offset:26368
v_lshl_add_u32 v22, s42, 7, v22
v_mfma_f32_16x16x32_bf16 v[204:207], a[52:55], a[108:111], v[204:207]
v_lshl_add_u32 v23, s42, 7, v23
v_mfma_f32_16x16x32_bf16 v[200:203], a[48:51], a[108:111], v[200:203]
v_mfma_f32_16x16x32_bf16 v[200:203], a[32:35], a[104:107], v[200:203]
s_waitcnt lgkmcnt(4)
v_mov_b32 v21, s1
v_mfma_f32_16x16x32_bf16 v[216:219], a[32:35], a[80:83], v[216:219]
ds_read_b64_tr_b16 a[104:105], v13 offset:17152
v_add_u32 v20, s0, v16
v_mfma_f32_16x16x32_bf16 v[216:219], a[48:51], a[84:87], v[216:219]
global_load_dword a120, v[20:21], off sc1
v_mfma_f32_16x16x32_bf16 v[220:223], a[52:55], a[84:87], v[220:223]
ds_read_b64_tr_b16 a[106:107], v13 offset:18176
v_mfma_f32_16x16x32_bf16 v[220:223], a[36:39], a[80:83], v[220:223]
ds_read_b64_tr_b16 a[108:109], v13 offset:25344
v_mfma_f32_16x16x32_bf16 v[224:227], a[40:43], a[80:83], v[224:227]
ds_read_b64_tr_b16 a[110:111], v13 offset:26368
v_add_u32 v12, 0xffff0000, v12
v_mfma_f32_16x16x32_bf16 v[224:227], a[56:59], a[84:87], v[224:227]
v_add_u32 v13, 0xffff0000, v13
v_mfma_f32_16x16x32_bf16 v[228:231], a[60:63], a[84:87], v[228:231]
v_mfma_f32_16x16x32_bf16 v[228:231], a[44:47], a[80:83], v[228:231]
v_mfma_f32_16x16x32_bf16 v[244:247], a[44:47], a[88:91], v[244:247]
s_waitcnt vmcnt(28) lgkmcnt(0)
v_mfma_f32_16x16x32_bf16 v[244:247], a[60:63], a[92:95], v[244:247]
s_barrier
s_add_u32 m0, s17, 0x10000
v_mfma_f32_16x16x32_bf16 v[240:243], a[56:59], a[92:95], v[240:243]
buffer_load_dwordx4 v5, s[52:55], 0 offen lds
v_mfma_f32_16x16x32_bf16 v[240:243], a[40:43], a[88:91], v[240:243]
ds_read_b64_tr_b16 a[80:81], v12 offset:0
s_mul_i32 s28, s5, 0x10c400
v_mfma_f32_16x16x32_bf16 v[236:239], a[36:39], a[88:91], v[236:239]
ds_read_b64_tr_b16 a[82:83], v12 offset:1024
s_mov_b32 s48, s88
v_mfma_f32_16x16x32_bf16 v[236:239], a[52:55], a[92:95], v[236:239]
ds_read_b64_tr_b16 a[84:85], v12 offset:8192
s_mov_b32 s49, s89
v_mfma_f32_16x16x32_bf16 v[232:235], a[48:51], a[92:95], v[232:235]
ds_read_b64_tr_b16 a[86:87], v12 offset:9216
s_sub_u32 s11, 16, s6
v_mfma_f32_16x16x32_bf16 v[232:235], a[32:35], a[88:91], v[232:235]
s_waitcnt lgkmcnt(4)
s_lshl_b32 s11, s11, 16
s_add_u32 s11, s11, s28
v_mfma_f32_16x16x32_bf16 v[248:251], a[32:35], a[96:99], v[248:251]
ds_read_b64_tr_b16 a[88:89], v13 offset:0
s_add_u32 m0, s17, 0x10400
v_mfma_f32_16x16x32_bf16 v[248:251], a[48:51], a[100:103], v[248:251]
buffer_load_dwordx4 v5, s[52:55], s13 offen lds
v_mfma_f32_16x16x32_bf16 v[252:255], a[52:55], a[100:103], v[252:255]
ds_read_b64_tr_b16 a[90:91], v13 offset:1024
s_add_u32 s50, s11, 0x2000
v_mfma_f32_16x16x32_bf16 v[252:255], a[36:39], a[96:99], v[252:255]
ds_read_b64_tr_b16 a[92:93], v13 offset:8192
s_lshl_b32 s11, s6, 17
v_mfma_f32_16x16x32_bf16 a[232:235], a[40:43], a[96:99], a[232:235]
ds_read_b64_tr_b16 a[94:95], v13 offset:9216
s_add_u32 s28, s28, s11
v_mfma_f32_16x16x32_bf16 a[232:235], a[56:59], a[100:103], a[232:235]
s_lshl_b32 s11, s4, 15
s_add_u32 s28, s28, s11
s_lshl_b32 s10, s5, 2
v_mfma_f32_16x16x32_bf16 a[236:239], a[60:63], a[100:103], a[236:239]
s_add_u32 s10, s10, 64
v_mfma_f32_16x16x32_bf16 a[236:239], a[44:47], a[96:99], a[236:239]
s_add_u32 m0, s17, 0x10800
L_padA3:
s_cmp_eq_u32 s95, 1
s_cbranch_scc1 L_padA7
v_mfma_f32_16x16x32_bf16 a[252:255], a[44:47], a[104:107], a[252:255]
buffer_load_dwordx4 v6, s[52:55], 0 offen lds
v_mfma_f32_16x16x32_bf16 a[252:255], a[60:63], a[108:111], a[252:255]
ds_read_b64_tr_b16 a[96:97], v12 offset:256
v_mfma_f32_16x16x32_bf16 a[248:251], a[56:59], a[108:111], a[248:251]
ds_read_b64_tr_b16 a[98:99], v12 offset:1280
v_mfma_f32_16x16x32_bf16 a[248:251], a[40:43], a[104:107], a[248:251]
ds_read_b64_tr_b16 a[100:101], v12 offset:8448
v_mfma_f32_16x16x32_bf16 a[244:247], a[36:39], a[104:107], a[244:247]
ds_read_b64_tr_b16 a[102:103], v12 offset:9472
v_mfma_f32_16x16x32_bf16 a[244:247], a[52:55], a[108:111], a[244:247]
v_mfma_f32_16x16x32_bf16 a[240:243], a[48:51], a[108:111], a[240:243]
v_mfma_f32_16x16x32_bf16 a[240:243], a[32:35], a[104:107], a[240:243]
s_add_u32 m0, s17, 0x10c00
s_waitcnt lgkmcnt(4)
L_S6:
v_mfma_f32_16x16x32_bf16 v[24:27], a[80:83], a[0:3], v[24:27]
buffer_load_dwordx4 v6, s[52:55], s13 offen lds
v_mfma_f32_16x16x32_bf16 v[24:27], a[84:87], a[16:19], v[24:27]
ds_read_b64_tr_b16 a[104:105], v13 offset:256
s_waitcnt vmcnt(24)
v_mfma_f32_16x16x32_bf16 v[32:35], a[84:87], a[20:23], v[32:35]
ds_read_b64_tr_b16 a[106:107], v13 offset:1280
v_mfma_f32_16x16x32_bf16 v[32:35], a[80:83], a[4:7], v[32:35]
ds_read_b64_tr_b16 a[108:109], v13 offset:8448
v_mfma_f32_16x16x32_bf16 v[40:43], a[80:83], a[8:11], v[40:43]
ds_read_b64_tr_b16 a[110:111], v13 offset:9472
v_mfma_f32_16x16x32_bf16 v[40:43], a[84:87], a[24:27], v[40:43]
ds_read_b128 a[32:35], v8 offset:32768
v_mfma_f32_16x16x32_bf16 v[48:51], a[84:87], a[28:31], v[48:51]
ds_read_b128 a[48:51], v9 offset:32768
s_add_u32 m0, s18, 0x14000
v_mfma_f32_16x16x32_bf16 v[48:51], a[80:83], a[12:15], v[48:51]
buffer_load_dwordx4 v7, s[68:71], 0 offen lds
v_mfma_f32_16x16x32_bf16 v[52:55], a[88:91], a[12:15], v[52:55]
ds_read_b64_tr_b16 a[80:81], v12 offset:512
v_mfma_f32_16x16x32_bf16 v[52:55], a[92:95], a[28:31], v[52:55]
ds_read_b64_tr_b16 a[82:83], v12 offset:1536
v_mfma_f32_16x16x32_bf16 v[44:47], a[92:95], a[24:27], v[44:47]
ds_read_b64_tr_b16 a[84:85], v12 offset:8704
v_mfma_f32_16x16x32_bf16 v[44:47], a[88:91], a[8:11], v[44:47]
ds_read_b64_tr_b16 a[86:87], v12 offset:9728
v_mfma_f32_16x16x32_bf16 v[36:39], a[88:91], a[4:7], v[36:39]
ds_read_b128 a[36:39], v8 offset:34816
v_mfma_f32_16x16x32_bf16 v[36:39], a[92:95], a[20:23], v[36:39]
ds_read_b128 a[52:55], v9 offset:34816
s_waitcnt lgkmcnt(8)
v_mfma_f32_16x16x32_bf16 v[28:31], a[92:95], a[16:19], v[28:31]
ds_read_b128 a[40:43], v8 offset:36864
s_add_u32 m0, s18, 0x15000
v_mfma_f32_16x16x32_bf16 v[28:31], a[88:91], a[0:3], v[28:31]
buffer_load_dwordx4 v7, s[68:71], s25 offen lds
v_mfma_f32_16x16x32_bf16 v[56:59], a[96:99], a[0:3], v[56:59]
ds_read_b64_tr_b16 a[88:89], v13 offset:512
v_mfma_f32_16x16x32_bf16 v[56:59], a[100:103], a[16:19], v[56:59]
ds_read_b64_tr_b16 a[90:91], v13 offset:1536
v_mfma_f32_16x16x32_bf16 v[64:67], a[100:103], a[20:23], v[64:67]
ds_read_b64_tr_b16 a[92:93], v13 offset:8704
v_mfma_f32_16x16x32_bf16 v[64:67], a[96:99], a[4:7], v[64:67]
ds_read_b64_tr_b16 a[94:95], v13 offset:9728
v_mfma_f32_16x16x32_bf16 v[72:75], a[96:99], a[8:11], v[72:75]
ds_read_b128 a[56:59], v9 offset:36864
v_mfma_f32_16x16x32_bf16 v[72:75], a[100:103], a[24:27], v[72:75]
ds_read_b128 a[44:47], v8 offset:38912
s_add_u32 m0, s18, 0x16000
v_mfma_f32_16x16x32_bf16 v[80:83], a[100:103], a[28:31], v[80:83]
buffer_load_dwordx4 v7, s[68:71], s26 offen lds
v_mfma_f32_16x16x32_bf16 v[80:83], a[96:99], a[12:15], v[80:83]
ds_read_b128 a[60:63], v9 offset:38912
v_lshl_add_u32 v5, s42, 19, v5
v_mfma_f32_16x16x32_bf16 v[84:87], a[104:107], a[12:15], v[84:87]
ds_read_b64_tr_b16 a[96:97], v12 offset:768
v_lshl_add_u32 v6, s42, 19, v6
v_mfma_f32_16x16x32_bf16 v[84:87], a[108:111], a[28:31], v[84:87]
ds_read_b64_tr_b16 a[98:99], v12 offset:1792
v_lshl_add_u32 v7, s42, 18, v7
v_mfma_f32_16x16x32_bf16 v[76:79], a[108:111], a[24:27], v[76:79]
ds_read_b64_tr_b16 a[100:101], v12 offset:8960
v_lshl_add_u32 v7, s42, 17, v7
v_mfma_f32_16x16x32_bf16 v[76:79], a[104:107], a[8:11], v[76:79]
ds_read_b64_tr_b16 a[102:103], v12 offset:9984
v_mfma_f32_16x16x32_bf16 v[68:71], a[104:107], a[4:7], v[68:71]
v_mfma_f32_16x16x32_bf16 v[68:71], a[108:111], a[20:23], v[68:71]
buffer_store_dwordx4 a[64:67], v4, s[88:91], 0 offen sc1
v_mfma_f32_16x16x32_bf16 v[60:63], a[108:111], a[16:19], v[60:63]
v_mfma_f32_16x16x32_bf16 v[60:63], a[104:107], a[0:3], v[60:63]
s_waitcnt lgkmcnt(7)
v_mfma_f32_16x16x32_bf16 v[88:91], a[80:83], a[0:3], v[88:91]
ds_read_b64_tr_b16 a[104:105], v13 offset:768
v_mfma_f32_16x16x32_bf16 v[88:91], a[84:87], a[16:19], v[88:91]
ds_read_b64_tr_b16 a[106:107], v13 offset:1792
v_mfma_f32_16x16x32_bf16 v[96:99], a[84:87], a[20:23], v[96:99]
ds_read_b64_tr_b16 a[108:109], v13 offset:8960
v_mfma_f32_16x16x32_bf16 v[96:99], a[80:83], a[4:7], v[96:99]
ds_read_b64_tr_b16 a[110:111], v13 offset:9984
v_mfma_f32_16x16x32_bf16 v[104:107], a[80:83], a[8:11], v[104:107]
s_add_u32 m0, s16, 0x8000
s_waitcnt lgkmcnt(8)
v_mfma_f32_16x16x32_bf16 v[104:107], a[84:87], a[24:27], v[104:107]
buffer_load_dwordx4 v22, s[44:47], s20 offen lds
v_mfma_f32_16x16x32_bf16 v[112:115], a[84:87], a[28:31], v[112:115]
v_mfma_f32_16x16x32_bf16 v[112:115], a[80:83], a[12:15], v[112:115]
v_mfma_f32_16x16x32_bf16 v[116:119], a[88:91], a[12:15], v[116:119]
ds_read_b64_tr_b16 a[80:81], v12 offset:16384
v_mfma_f32_16x16x32_bf16 v[116:119], a[92:95], a[28:31], v[116:119]
ds_read_b64_tr_b16 a[82:83], v12 offset:17408
v_mfma_f32_16x16x32_bf16 v[108:111], a[92:95], a[24:27], v[108:111]
ds_read_b64_tr_b16 a[84:85], v12 offset:24576
v_mfma_f32_16x16x32_bf16 v[108:111], a[88:91], a[8:11], v[108:111]
ds_read_b64_tr_b16 a[86:87], v12 offset:25600
s_add_u32 m0, s16, 0x8400
v_mfma_f32_16x16x32_bf16 v[100:103], a[88:91], a[4:7], v[100:103]
buffer_load_dwordx4 v23, s[44:47], s20 offen lds
v_mfma_f32_16x16x32_bf16 v[100:103], a[92:95], a[20:23], v[100:103]
v_mfma_f32_16x16x32_bf16 v[92:95], a[92:95], a[16:19], v[92:95]
v_mfma_f32_16x16x32_bf16 v[92:95], a[88:91], a[0:3], v[92:95]
s_waitcnt lgkmcnt(4)
v_mfma_f32_16x16x32_bf16 v[120:123], a[96:99], a[0:3], v[120:123]
ds_read_b64_tr_b16 a[88:89], v13 offset:16384
v_mfma_f32_16x16x32_bf16 v[120:123], a[100:103], a[16:19], v[120:123]
ds_read_b64_tr_b16 a[90:91], v13 offset:17408
v_mfma_f32_16x16x32_bf16 v[128:131], a[100:103], a[20:23], v[128:131]
ds_read_b64_tr_b16 a[92:93], v13 offset:24576
v_mfma_f32_16x16x32_bf16 v[128:131], a[96:99], a[4:7], v[128:131]
ds_read_b64_tr_b16 a[94:95], v13 offset:25600
s_add_u32 m0, s16, 0x8800
v_mfma_f32_16x16x32_bf16 v[136:139], a[96:99], a[8:11], v[136:139]
buffer_load_dwordx4 v22, s[44:47], s21 offen lds
v_mfma_f32_16x16x32_bf16 v[136:139], a[100:103], a[24:27], v[136:139]
v_mfma_f32_16x16x32_bf16 v[144:147], a[100:103], a[28:31], v[144:147]
v_mfma_f32_16x16x32_bf16 v[144:147], a[96:99], a[12:15], v[144:147]
v_mfma_f32_16x16x32_bf16 v[148:151], a[104:107], a[12:15], v[148:151]
ds_read_b64_tr_b16 a[96:97], v12 offset:16640
v_mfma_f32_16x16x32_bf16 v[148:151], a[108:111], a[28:31], v[148:151]
ds_read_b64_tr_b16 a[98:99], v12 offset:17664
v_mfma_f32_16x16x32_bf16 v[140:143], a[108:111], a[24:27], v[140:143]
ds_read_b64_tr_b16 a[100:101], v12 offset:24832
s_add_u32 m0, s16, 0x8c00
v_mfma_f32_16x16x32_bf16 v[140:143], a[104:107], a[8:11], v[140:143]
buffer_load_dwordx4 v23, s[44:47], s21 offen lds
v_mfma_f32_16x16x32_bf16 v[132:135], a[104:107], a[4:7], v[132:135]
ds_read_b64_tr_b16 a[102:103], v12 offset:25856
v_mfma_f32_16x16x32_bf16 v[132:135], a[108:111], a[20:23], v[132:135]
v_mfma_f32_16x16x32_bf16 v[124:127], a[108:111], a[16:19], v[124:127]
v_mfma_f32_16x16x32_bf16 v[124:127], a[104:107], a[0:3], v[124:127]
s_waitcnt lgkmcnt(4)
v_mfma_f32_16x16x32_bf16 v[152:155], a[0:3], a[80:83], v[152:155]
ds_read_b64_tr_b16 a[104:105], v13 offset:16640
v_mfma_f32_16x16x32_bf16 v[152:155], a[16:19], a[84:87], v[152:155]
ds_read_b64_tr_b16 a[106:107], v13 offset:17664
s_add_u32 m0, s16, 0x9000
v_mfma_f32_16x16x32_bf16 v[156:159], a[20:23], a[84:87], v[156:159]
buffer_load_dwordx4 v22, s[44:47], s22 offen lds
v_mfma_f32_16x16x32_bf16 v[156:159], a[4:7], a[80:83], v[156:159]
ds_read_b64_tr_b16 a[108:109], v13 offset:24832
v_mfma_f32_16x16x32_bf16 v[160:163], a[8:11], a[80:83], v[160:163]
ds_read_b64_tr_b16 a[110:111], v13 offset:25856
v_mfma_f32_16x16x32_bf16 v[160:163], a[24:27], a[84:87], v[160:163]
v_mfma_f32_16x16x32_bf16 v[164:167], a[28:31], a[84:87], v[164:167]
v_mfma_f32_16x16x32_bf16 v[164:167], a[12:15], a[80:83], v[164:167]
v_mfma_f32_16x16x32_bf16 v[180:183], a[12:15], a[88:91], v[180:183]
ds_read_b64_tr_b16 a[80:81], v12 offset:16896
v_mfma_f32_16x16x32_bf16 v[180:183], a[28:31], a[92:95], v[180:183]
ds_read_b64_tr_b16 a[82:83], v12 offset:17920
s_add_u32 m0, s16, 0x9400
v_mfma_f32_16x16x32_bf16 v[176:179], a[24:27], a[92:95], v[176:179]
buffer_load_dwordx4 v23, s[44:47], s22 offen lds
v_mfma_f32_16x16x32_bf16 v[176:179], a[8:11], a[88:91], v[176:179]
ds_read_b64_tr_b16 a[84:85], v12 offset:25088
v_mfma_f32_16x16x32_bf16 v[172:175], a[4:7], a[88:91], v[172:175]
ds_read_b64_tr_b16 a[86:87], v12 offset:26112
v_mfma_f32_16x16x32_bf16 v[172:175], a[20:23], a[92:95], v[172:175]
v_mfma_f32_16x16x32_bf16 v[168:171], a[16:19], a[92:95], v[168:171]
v_mfma_f32_16x16x32_bf16 v[168:171], a[0:3], a[88:91], v[168:171]
s_waitcnt lgkmcnt(4)
v_mfma_f32_16x16x32_bf16 v[184:187], a[0:3], a[96:99], v[184:187]
ds_read_b64_tr_b16 a[88:89], v13 offset:16896
s_add_u32 m0, s16, 0x9800
v_mfma_f32_16x16x32_bf16 v[184:187], a[16:19], a[100:103], v[184:187]
buffer_load_dwordx4 v22, s[44:47], s23 offen lds
v_mfma_f32_16x16x32_bf16 v[188:191], a[20:23], a[100:103], v[188:191]
ds_read_b64_tr_b16 a[90:91], v13 offset:17920
v_mfma_f32_16x16x32_bf16 v[188:191], a[4:7], a[96:99], v[188:191]
ds_read_b64_tr_b16 a[92:93], v13 offset:25088
v_mfma_f32_16x16x32_bf16 v[192:195], a[8:11], a[96:99], v[192:195]
ds_read_b64_tr_b16 a[94:95], v13 offset:26112
v_mfma_f32_16x16x32_bf16 v[192:195], a[24:27], a[100:103], v[192:195]
v_mfma_f32_16x16x32_bf16 v[196:199], a[28:31], a[100:103], v[196:199]
v_mfma_f32_16x16x32_bf16 v[196:199], a[12:15], a[96:99], v[196:199]
v_mfma_f32_16x16x32_bf16 v[212:215], a[12:15], a[104:107], v[212:215]
ds_read_b64_tr_b16 a[96:97], v12 offset:17152
s_add_u32 m0, s16, 0x9c00
v_mfma_f32_16x16x32_bf16 v[212:215], a[28:31], a[108:111], v[212:215]
buffer_load_dwordx4 v23, s[44:47], s23 offen lds
v_mfma_f32_16x16x32_bf16 v[208:211], a[24:27], a[108:111], v[208:211]
ds_read_b64_tr_b16 a[98:99], v12 offset:18176
v_lshl_add_u32 v22, s42, 7, v22
v_mfma_f32_16x16x32_bf16 v[208:211], a[8:11], a[104:107], v[208:211]
ds_read_b64_tr_b16 a[100:101], v12 offset:25344
v_lshl_add_u32 v23, s42, 7, v23
v_mfma_f32_16x16x32_bf16 v[204:207], a[4:7], a[104:107], v[204:207]
ds_read_b64_tr_b16 a[102:103], v12 offset:26368
v_mfma_f32_16x16x32_bf16 v[204:207], a[20:23], a[108:111], v[204:207]
v_mfma_f32_16x16x32_bf16 v[200:203], a[16:19], a[108:111], v[200:203]
v_mfma_f32_16x16x32_bf16 v[200:203], a[0:3], a[104:107], v[200:203]
s_mov_b32 s9, 0x400000
s_waitcnt lgkmcnt(4)
v_mfma_f32_16x16x32_bf16 v[216:219], a[0:3], a[80:83], v[216:219]
buffer_load_dword a120, v18, s[52:55], s9 offen
v_mfma_f32_16x16x32_bf16 v[216:219], a[16:19], a[84:87], v[216:219]
ds_read_b64_tr_b16 a[104:105], v13 offset:17152
v_mfma_f32_16x16x32_bf16 v[220:223], a[20:23], a[84:87], v[220:223]
ds_read_b64_tr_b16 a[106:107], v13 offset:18176
v_mfma_f32_16x16x32_bf16 v[220:223], a[4:7], a[80:83], v[220:223]
ds_read_b64_tr_b16 a[108:109], v13 offset:25344
v_mfma_f32_16x16x32_bf16 v[224:227], a[8:11], a[80:83], v[224:227]
ds_read_b64_tr_b16 a[110:111], v13 offset:26368
v_add_u32 v12, 0x8000, v12
v_mfma_f32_16x16x32_bf16 v[224:227], a[24:27], a[84:87], v[224:227]
v_add_u32 v13, 0x8000, v13
v_mfma_f32_16x16x32_bf16 v[228:231], a[28:31], a[84:87], v[228:231]
v_mfma_f32_16x16x32_bf16 v[228:231], a[12:15], a[80:83], v[228:231]
v_mfma_f32_16x16x32_bf16 v[244:247], a[12:15], a[88:91], v[244:247]
s_waitcnt vmcnt(27) lgkmcnt(0)
v_mfma_f32_16x16x32_bf16 v[244:247], a[28:31], a[92:95], v[244:247]
s_barrier
s_add_u32 m0, s17, 0x0
v_mfma_f32_16x16x32_bf16 v[240:243], a[24:27], a[92:95], v[240:243]
buffer_load_dwordx4 v5, s[52:55], 0 offen lds
v_mfma_f32_16x16x32_bf16 v[240:243], a[8:11], a[88:91], v[240:243]
ds_read_b64_tr_b16 a[80:81], v12 offset:0
v_mfma_f32_16x16x32_bf16 v[236:239], a[4:7], a[88:91], v[236:239]
ds_read_b64_tr_b16 a[82:83], v12 offset:1024
v_mfma_f32_16x16x32_bf16 v[236:239], a[20:23], a[92:95], v[236:239]
ds_read_b64_tr_b16 a[84:85], v12 offset:8192
v_mfma_f32_16x16x32_bf16 v[232:235], a[16:19], a[92:95], v[232:235]
ds_read_b64_tr_b16 a[86:87], v12 offset:9216
v_mfma_f32_16x16x32_bf16 v[232:235], a[0:3], a[88:91], v[232:235]
s_waitcnt lgkmcnt(4)
v_mfma_f32_16x16x32_bf16 v[248:251], a[0:3], a[96:99], v[248:251]
ds_read_b64_tr_b16 a[88:89], v13 offset:0
s_add_u32 m0, s17, 0x400
v_mfma_f32_16x16x32_bf16 v[248:251], a[16:19], a[100:103], v[248:251]
buffer_load_dwordx4 v5, s[52:55], s13 offen lds
v_mfma_f32_16x16x32_bf16 v[252:255], a[20:23], a[100:103], v[252:255]
ds_read_b64_tr_b16 a[90:91], v13 offset:1024
v_mfma_f32_16x16x32_bf16 v[252:255], a[4:7], a[96:99], v[252:255]
ds_read_b64_tr_b16 a[92:93], v13 offset:8192
v_mfma_f32_16x16x32_bf16 a[232:235], a[8:11], a[96:99], a[232:235]
ds_read_b64_tr_b16 a[94:95], v13 offset:9216
v_mfma_f32_16x16x32_bf16 a[232:235], a[24:27], a[100:103], a[232:235]
v_mfma_f32_16x16x32_bf16 a[236:239], a[28:31], a[100:103], a[236:239]
v_mfma_f32_16x16x32_bf16 a[236:239], a[12:15], a[96:99], a[236:239]
s_add_u32 m0, s17, 0x800
v_mfma_f32_16x16x32_bf16 a[252:255], a[12:15], a[104:107], a[252:255]
buffer_load_dwordx4 v6, s[52:55], 0 offen lds
v_mfma_f32_16x16x32_bf16 a[252:255], a[28:31], a[108:111], a[252:255]
ds_read_b64_tr_b16 a[96:97], v12 offset:256
v_mfma_f32_16x16x32_bf16 a[248:251], a[24:27], a[108:111], a[248:251]
ds_read_b64_tr_b16 a[98:99], v12 offset:1280
v_mfma_f32_16x16x32_bf16 a[248:251], a[8:11], a[104:107], a[248:251]
ds_read_b64_tr_b16 a[100:101], v12 offset:8448
v_mfma_f32_16x16x32_bf16 a[244:247], a[4:7], a[104:107], a[244:247]
ds_read_b64_tr_b16 a[102:103], v12 offset:9472
v_mfma_f32_16x16x32_bf16 a[244:247], a[20:23], a[108:111], a[244:247]
v_mfma_f32_16x16x32_bf16 a[240:243], a[16:19], a[108:111], a[240:243]
v_mfma_f32_16x16x32_bf16 a[240:243], a[0:3], a[104:107], a[240:243]
s_add_u32 m0, s17, 0xc00
s_waitcnt lgkmcnt(4)
L_S7:
v_mfma_f32_16x16x32_bf16 v[24:27], a[80:83], a[32:35], v[24:27]
buffer_load_dwordx4 v6, s[52:55], s13 offen lds
v_mfma_f32_16x16x32_bf16 v[24:27], a[84:87], a[48:51], v[24:27]
ds_read_b64_tr_b16 a[104:105], v13 offset:256
s_waitcnt vmcnt(22)
v_mfma_f32_16x16x32_bf16 v[32:35], a[84:87], a[52:55], v[32:35]
ds_read_b64_tr_b16 a[106:107], v13 offset:1280
v_mfma_f32_16x16x32_bf16 v[32:35], a[80:83], a[36:39], v[32:35]
ds_read_b64_tr_b16 a[108:109], v13 offset:8448
v_mfma_f32_16x16x32_bf16 v[40:43], a[80:83], a[40:43], v[40:43]
ds_read_b64_tr_b16 a[110:111], v13 offset:9472
v_mfma_f32_16x16x32_bf16 v[40:43], a[84:87], a[56:59], v[40:43]
ds_read_b128 a[0:3], v8 offset:0
v_mfma_f32_16x16x32_bf16 v[48:51], a[84:87], a[60:63], v[48:51]
ds_read_b128 a[16:19], v9 offset:0
s_add_u32 m0, s18, 0x4000
v_mfma_f32_16x16x32_bf16 v[48:51], a[80:83], a[44:47], v[48:51]
buffer_load_dwordx4 v7, s[68:71], 0 offen lds
v_mfma_f32_16x16x32_bf16 v[52:55], a[88:91], a[44:47], v[52:55]
ds_read_b64_tr_b16 a[80:81], v12 offset:512
v_mfma_f32_16x16x32_bf16 v[52:55], a[92:95], a[60:63], v[52:55]
ds_read_b64_tr_b16 a[82:83], v12 offset:1536
v_mfma_f32_16x16x32_bf16 v[44:47], a[92:95], a[56:59], v[44:47]
ds_read_b64_tr_b16 a[84:85], v12 offset:8704
v_mfma_f32_16x16x32_bf16 v[44:47], a[88:91], a[40:43], v[44:47]
ds_read_b64_tr_b16 a[86:87], v12 offset:9728
v_mfma_f32_16x16x32_bf16 v[36:39], a[88:91], a[36:39], v[36:39]
ds_read_b128 a[4:7], v8 offset:2048
v_mfma_f32_16x16x32_bf16 v[36:39], a[92:95], a[52:55], v[36:39]
ds_read_b128 a[20:23], v9 offset:2048
s_waitcnt lgkmcnt(8)
v_mfma_f32_16x16x32_bf16 v[28:31], a[92:95], a[48:51], v[28:31]
ds_read_b128 a[8:11], v8 offset:4096
s_add_u32 m0, s18, 0x5000
v_mfma_f32_16x16x32_bf16 v[28:31], a[88:91], a[32:35], v[28:31]
buffer_load_dwordx4 v7, s[68:71], s25 offen lds
v_mfma_f32_16x16x32_bf16 v[56:59], a[96:99], a[32:35], v[56:59]
ds_read_b64_tr_b16 a[88:89], v13 offset:512
v_mfma_f32_16x16x32_bf16 v[56:59], a[100:103], a[48:51], v[56:59]
ds_read_b64_tr_b16 a[90:91], v13 offset:1536
v_mfma_f32_16x16x32_bf16 v[64:67], a[100:103], a[52:55], v[64:67]
ds_read_b64_tr_b16 a[92:93], v13 offset:8704
v_mfma_f32_16x16x32_bf16 v[64:67], a[96:99], a[36:39], v[64:67]
ds_read_b64_tr_b16 a[94:95], v13 offset:9728
v_cvt_pk_bf16_f32 v24, v24, v25
v_cvt_pk_bf16_f32 v25, v26, v27
v_mfma_f32_16x16x32_bf16 v[72:75], a[96:99], a[40:43], v[72:75]
ds_read_b128 a[24:27], v9 offset:4096
v_cvt_pk_bf16_f32 v26, v28, v29
v_mfma_f32_16x16x32_bf16 v[72:75], a[100:103], a[56:59], v[72:75]
ds_read_b128 a[12:15], v8 offset:6144
s_add_u32 m0, s18, 0x6000
v_mfma_f32_16x16x32_bf16 v[80:83], a[100:103], a[60:63], v[80:83]
buffer_load_dwordx4 v7, s[68:71], s26 offen lds
v_cvt_pk_bf16_f32 v27, v30, v31
v_mfma_f32_16x16x32_bf16 v[80:83], a[96:99], a[44:47], v[80:83]
ds_read_b128 a[28:31], v9 offset:6144
v_lshl_add_u32 v5, s42, 19, v5
v_mfma_f32_16x16x32_bf16 v[84:87], a[104:107], a[44:47], v[84:87]
ds_read_b64_tr_b16 a[96:97], v12 offset:768
v_lshl_add_u32 v6, s42, 19, v6
v_mfma_f32_16x16x32_bf16 v[84:87], a[108:111], a[60:63], v[84:87]
ds_read_b64_tr_b16 a[98:99], v12 offset:1792
v_lshl_add_u32 v7, s42, 18, v7
v_accvgpr_write_b32 a128, v24
v_mfma_f32_16x16x32_bf16 v[76:79], a[108:111], a[56:59], v[76:79]
ds_read_b64_tr_b16 a[100:101], v12 offset:8960
v_lshl_add_u32 v7, s42, 17, v7
v_mfma_f32_16x16x32_bf16 v[76:79], a[104:107], a[40:43], v[76:79]
ds_read_b64_tr_b16 a[102:103], v12 offset:9984
v_accvgpr_write_b32 a129, v25
v_mfma_f32_16x16x32_bf16 v[68:71], a[104:107], a[36:39], v[68:71]
s_mov_b32 s9, 0x400000
v_accvgpr_write_b32 a130, v26
v_accvgpr_write_b32 a131, v27
v_cvt_pk_bf16_f32 v32, v32, v33
v_mfma_f32_16x16x32_bf16 v[68:71], a[108:111], a[52:55], v[68:71]
buffer_load_dword a120, v19, s[68:71], s9 offen
v_mfma_f32_16x16x32_bf16 v[60:63], a[108:111], a[48:51], v[60:63]
v_cvt_pk_bf16_f32 v33, v34, v35
v_cvt_pk_bf16_f32 v34, v36, v37
v_mfma_f32_16x16x32_bf16 v[60:63], a[104:107], a[32:35], v[60:63]
s_waitcnt lgkmcnt(7)
v_cvt_pk_bf16_f32 v35, v38, v39
v_accvgpr_write_b32 a132, v32
v_accvgpr_write_b32 a133, v33
v_mfma_f32_16x16x32_bf16 v[88:91], a[80:83], a[32:35], v[88:91]
ds_read_b64_tr_b16 a[104:105], v13 offset:768
v_accvgpr_write_b32 a134, v34
v_mfma_f32_16x16x32_bf16 v[88:91], a[84:87], a[48:51], v[88:91]
ds_read_b64_tr_b16 a[106:107], v13 offset:1792
v_accvgpr_write_b32 a135, v35
v_mfma_f32_16x16x32_bf16 v[96:99], a[84:87], a[52:55], v[96:99]
ds_read_b64_tr_b16 a[108:109], v13 offset:8960
v_cvt_pk_bf16_f32 v40, v40, v41
v_cvt_pk_bf16_f32 v41, v42, v43
v_mfma_f32_16x16x32_bf16 v[96:99], a[80:83], a[36:39], v[96:99]
ds_read_b64_tr_b16 a[110:111], v13 offset:9984
v_cvt_pk_bf16_f32 v42, v44, v45
v_mfma_f32_16x16x32_bf16 v[104:107], a[80:83], a[40:43], v[104:107]
s_add_u32 m0, s16, 0x0
s_waitcnt lgkmcnt(8)
v_cvt_pk_bf16_f32 v43, v46, v47
v_mfma_f32_16x16x32_bf16 v[104:107], a[84:87], a[56:59], v[104:107]
buffer_load_dwordx4 v22, s[44:47], s20 offen lds
v_accvgpr_write_b32 a136, v40
v_mfma_f32_16x16x32_bf16 v[112:115], a[84:87], a[60:63], v[112:115]
v_accvgpr_write_b32 a137, v41
v_accvgpr_write_b32 a138, v42
v_mfma_f32_16x16x32_bf16 v[112:115], a[80:83], a[44:47], v[112:115]
v_accvgpr_write_b32 a139, v43
v_cvt_pk_bf16_f32 v48, v48, v49
v_mfma_f32_16x16x32_bf16 v[116:119], a[88:91], a[44:47], v[116:119]
ds_read_b64_tr_b16 a[80:81], v12 offset:16384
v_cvt_pk_bf16_f32 v49, v50, v51
v_cvt_pk_bf16_f32 v50, v52, v53
v_mfma_f32_16x16x32_bf16 v[116:119], a[92:95], a[60:63], v[116:119]
ds_read_b64_tr_b16 a[82:83], v12 offset:17408
v_cvt_pk_bf16_f32 v51, v54, v55
v_mfma_f32_16x16x32_bf16 v[108:111], a[92:95], a[56:59], v[108:111]
ds_read_b64_tr_b16 a[84:85], v12 offset:24576
v_accvgpr_write_b32 a140, v48
v_mfma_f32_16x16x32_bf16 v[108:111], a[88:91], a[40:43], v[108:111]
ds_read_b64_tr_b16 a[86:87], v12 offset:25600
s_add_u32 m0, s16, 0x400
v_accvgpr_write_b32 a141, v49
v_mfma_f32_16x16x32_bf16 v[100:103], a[88:91], a[36:39], v[100:103]
buffer_load_dwordx4 v23, s[44:47], s20 offen lds
v_mfma_f32_16x16x32_bf16 v[100:103], a[92:95], a[52:55], v[100:103]
v_accvgpr_write_b32 a142, v50
v_accvgpr_write_b32 a143, v51
v_mfma_f32_16x16x32_bf16 v[92:95], a[92:95], a[48:51], v[92:95]
v_cvt_pk_bf16_f32 v56, v56, v57
v_cvt_pk_bf16_f32 v57, v58, v59
v_cvt_pk_bf16_f32 v58, v60, v61
v_mfma_f32_16x16x32_bf16 v[92:95], a[88:91], a[32:35], v[92:95]
s_waitcnt lgkmcnt(4)
v_cvt_pk_bf16_f32 v59, v62, v63
v_accvgpr_write_b32 a144, v56
v_mfma_f32_16x16x32_bf16 v[120:123], a[96:99], a[32:35], v[120:123]
ds_read_b64_tr_b16 a[88:89], v13 offset:16384
v_accvgpr_write_b32 a145, v57
v_mfma_f32_16x16x32_bf16 v[120:123], a[100:103], a[48:51], v[120:123]
ds_read_b64_tr_b16 a[90:91], v13 offset:17408
v_accvgpr_write_b32 a146, v58
v_accvgpr_write_b32 a147, v59
v_mfma_f32_16x16x32_bf16 v[128:131], a[100:103], a[52:55], v[128:131]
ds_read_b64_tr_b16 a[92:93], v13 offset:24576
v_cvt_pk_bf16_f32 v64, v64, v65
v_mfma_f32_16x16x32_bf16 v[128:131], a[96:99], a[36:39], v[128:131]
ds_read_b64_tr_b16 a[94:95], v13 offset:25600
s_add_u32 m0, s16, 0x800
v_mfma_f32_16x16x32_bf16 v[136:139], a[96:99], a[40:43], v[136:139]
buffer_load_dwordx4 v22, s[44:47], s21 offen lds
v_cvt_pk_bf16_f32 v65, v66, v67
v_mfma_f32_16x16x32_bf16 v[136:139], a[100:103], a[56:59], v[136:139]
v_cvt_pk_bf16_f32 v66, v68, v69
v_cvt_pk_bf16_f32 v67, v70, v71
v_mfma_f32_16x16x32_bf16 v[144:147], a[100:103], a[60:63], v[144:147]
v_accvgpr_write_b32 a148, v64
v_accvgpr_write_b32 a149, v65
v_mfma_f32_16x16x32_bf16 v[144:147], a[96:99], a[44:47], v[144:147]
v_accvgpr_write_b32 a150, v66
v_accvgpr_write_b32 a151, v67
v_cvt_pk_bf16_f32 v72, v72, v73
v_mfma_f32_16x16x32_bf16 v[148:151], a[104:107], a[44:47], v[148:151]
ds_read_b64_tr_b16 a[96:97], v12 offset:16640
v_cvt_pk_bf16_f32 v73, v74, v75
v_mfma_f32_16x16x32_bf16 v[148:151], a[108:111], a[60:63], v[148:151]
ds_read_b64_tr_b16 a[98:99], v12 offset:17664
v_cvt_pk_bf16_f32 v74, v76, v77
v_mfma_f32_16x16x32_bf16 v[140:143], a[108:111], a[56:59], v[140:143]
ds_read_b64_tr_b16 a[100:101], v12 offset:24832
s_add_u32 m0, s16, 0xc00
v_cvt_pk_bf16_f32 v75, v78, v79
v_mfma_f32_16x16x32_bf16 v[140:143], a[104:107], a[40:43], v[140:143]
buffer_load_dwordx4 v23, s[44:47], s21 offen lds
v_mfma_f32_16x16x32_bf16 v[132:135], a[104:107], a[36:39], v[132:135]
ds_read_b64_tr_b16 a[102:103], v12 offset:25856
v_accvgpr_write_b32 a152, v72
v_mfma_f32_16x16x32_bf16 v[132:135], a[108:111], a[52:55], v[132:135]
v_accvgpr_write_b32 a153, v73
v_accvgpr_write_b32 a154, v74
v_accvgpr_write_b32 a155, v75
v_mfma_f32_16x16x32_bf16 v[124:127], a[108:111], a[48:51], v[124:127]
v_cvt_pk_bf16_f32 v80, v80, v81
v_cvt_pk_bf16_f32 v81, v82, v83
v_mfma_f32_16x16x32_bf16 v[124:127], a[104:107], a[32:35], v[124:127]
s_waitcnt lgkmcnt(4)
v_cvt_pk_bf16_f32 v82, v84, v85
v_cvt_pk_bf16_f32 v83, v86, v87
v_mfma_f32_16x16x32_bf16 v[152:155], a[32:35], a[80:83], v[152:155]
ds_read_b64_tr_b16 a[104:105], v13 offset:16640
v_accvgpr_write_b32 a156, v80
v_accvgpr_write_b32 a157, v81
v_mfma_f32_16x16x32_bf16 v[152:155], a[48:51], a[84:87], v[152:155]
ds_read_b64_tr_b16 a[106:107], v13 offset:17664
s_add_u32 m0, s16, 0x1000
v_mfma_f32_16x16x32_bf16 v[156:159], a[52:55], a[84:87], v[156:159]
buffer_load_dwordx4 v22, s[44:47], s22 offen lds
v_mfma_f32_16x16x32_bf16 v[156:159], a[36:39], a[80:83], v[156:159]
ds_read_b64_tr_b16 a[108:109], v13 offset:24832
v_accvgpr_write_b32 a158, v82
v_accvgpr_write_b32 a159, v83
v_mfma_f32_16x16x32_bf16 v[160:163], a[40:43], a[80:83], v[160:163]
ds_read_b64_tr_b16 a[110:111], v13 offset:25856
v_cvt_pk_bf16_f32 v88, v88, v89
v_mfma_f32_16x16x32_bf16 v[160:163], a[56:59], a[84:87], v[160:163]
v_cvt_pk_bf16_f32 v89, v90, v91
v_cvt_pk_bf16_f32 v90, v92, v93
v_mfma_f32_16x16x32_bf16 v[164:167], a[60:63], a[84:87], v[164:167]
v_cvt_pk_bf16_f32 v91, v94, v95
v_accvgpr_write_b32 a160, v88
v_accvgpr_write_b32 a161, v89
v_mfma_f32_16x16x32_bf16 v[164:167], a[44:47], a[80:83], v[164:167]
v_accvgpr_write_b32 a162, v90
v_accvgpr_write_b32 a163, v91
v_mfma_f32_16x16x32_bf16 v[180:183], a[44:47], a[88:91], v[180:183]
ds_read_b64_tr_b16 a[80:81], v12 offset:16896
v_cvt_pk_bf16_f32 v96, v96, v97
v_mfma_f32_16x16x32_bf16 v[180:183], a[60:63], a[92:95], v[180:183]
ds_read_b64_tr_b16 a[82:83], v12 offset:17920
s_add_u32 m0, s16, 0x1400
v_cvt_pk_bf16_f32 v97, v98, v99
v_mfma_f32_16x16x32_bf16 v[176:179], a[56:59], a[92:95], v[176:179]
buffer_load_dwordx4 v23, s[44:47], s22 offen lds
v_mfma_f32_16x16x32_bf16 v[176:179], a[40:43], a[88:91], v[176:179]
ds_read_b64_tr_b16 a[84:85], v12 offset:25088
v_cvt_pk_bf16_f32 v98, v100, v101
v_mfma_f32_16x16x32_bf16 v[172:175], a[36:39], a[88:91], v[172:175]
ds_read_b64_tr_b16 a[86:87], v12 offset:26112
v_cvt_pk_bf16_f32 v99, v102, v103
v_accvgpr_write_b32 a164, v96
v_mfma_f32_16x16x32_bf16 v[172:175], a[52:55], a[92:95], v[172:175]
v_accvgpr_write_b32 a165, v97
v_accvgpr_write_b32 a166, v98
v_mfma_f32_16x16x32_bf16 v[168:171], a[48:51], a[92:95], v[168:171]
v_accvgpr_write_b32 a167, v99
v_cvt_pk_bf16_f32 v104, v104, v105
v_mfma_f32_16x16x32_bf16 v[168:171], a[32:35], a[88:91], v[168:171]
s_waitcnt lgkmcnt(4)
v_cvt_pk_bf16_f32 v105, v106, v107
v_cvt_pk_bf16_f32 v106, v108, v109
v_cvt_pk_bf16_f32 v107, v110, v111
v_mfma_f32_16x16x32_bf16 v[184:187], a[32:35], a[96:99], v[184:187]
ds_read_b64_tr_b16 a[88:89], v13 offset:16896
s_add_u32 m0, s16, 0x1800
v_mfma_f32_16x16x32_bf16 v[184:187], a[48:51], a[100:103], v[184:187]
buffer_load_dwordx4 v22, s[44:47], s23 offen lds
v_mfma_f32_16x16x32_bf16 v[188:191], a[52:55], a[100:103], v[188:191]
ds_read_b64_tr_b16 a[90:91], v13 offset:17920
v_accvgpr_write_b32 a168, v104
v_accvgpr_write_b32 a169, v105
v_mfma_f32_16x16x32_bf16 v[188:191], a[36:39], a[96:99], v[188:191]
ds_read_b64_tr_b16 a[92:93], v13 offset:25088
v_accvgpr_write_b32 a170, v106
v_mfma_f32_16x16x32_bf16 v[192:195], a[40:43], a[96:99], v[192:195]
ds_read_b64_tr_b16 a[94:95], v13 offset:26112
v_accvgpr_write_b32 a171, v107
v_mfma_f32_16x16x32_bf16 v[192:195], a[56:59], a[100:103], v[192:195]
L_padA4:
s_cmp_eq_u32 s95, 1
s_cbranch_scc1 L_padA8
v_cvt_pk_bf16_f32 v112, v112, v113
v_cvt_pk_bf16_f32 v113, v114, v115
v_cvt_pk_bf16_f32 v114, v116, v117
v_mfma_f32_16x16x32_bf16 v[196:199], a[60:63], a[100:103], v[196:199]
v_cvt_pk_bf16_f32 v115, v118, v119
v_accvgpr_write_b32 a172, v112
v_mfma_f32_16x16x32_bf16 v[196:199], a[44:47], a[96:99], v[196:199]
v_accvgpr_write_b32 a173, v113
v_accvgpr_write_b32 a174, v114
v_mfma_f32_16x16x32_bf16 v[212:215], a[44:47], a[104:107], v[212:215]
ds_read_b64_tr_b16 a[96:97], v12 offset:17152
s_add_u32 m0, s16, 0x1c00
v_accvgpr_write_b32 a175, v115
v_mfma_f32_16x16x32_bf16 v[212:215], a[60:63], a[108:111], v[212:215]
buffer_load_dwordx4 v23, s[44:47], s23 offen lds
v_mfma_f32_16x16x32_bf16 v[208:211], a[56:59], a[108:111], v[208:211]
ds_read_b64_tr_b16 a[98:99], v12 offset:18176
v_lshl_add_u32 v22, s42, 7, v22
v_mfma_f32_16x16x32_bf16 v[208:211], a[40:43], a[104:107], v[208:211]
ds_read_b64_tr_b16 a[100:101], v12 offset:25344
v_lshl_add_u32 v23, s42, 7, v23
v_cvt_pk_bf16_f32 v120, v120, v121
v_mfma_f32_16x16x32_bf16 v[204:207], a[36:39], a[104:107], v[204:207]
ds_read_b64_tr_b16 a[102:103], v12 offset:26368
v_cvt_pk_bf16_f32 v121, v122, v123
v_mfma_f32_16x16x32_bf16 v[204:207], a[52:55], a[108:111], v[204:207]
v_cvt_pk_bf16_f32 v122, v124, v125
v_cvt_pk_bf16_f32 v123, v126, v127
v_mfma_f32_16x16x32_bf16 v[200:203], a[48:51], a[108:111], v[200:203]
v_accvgpr_write_b32 a176, v120
v_accvgpr_write_b32 a177, v121
v_accvgpr_write_b32 a178, v122
v_mfma_f32_16x16x32_bf16 v[200:203], a[32:35], a[104:107], v[200:203]
s_mov_b32 s9, 0x600000
s_waitcnt lgkmcnt(4)
v_accvgpr_write_b32 a179, v123
v_mfma_f32_16x16x32_bf16 v[216:219], a[32:35], a[80:83], v[216:219]
buffer_load_dword a120, v18, s[52:55], s9 offen
v_mfma_f32_16x16x32_bf16 v[216:219], a[48:51], a[84:87], v[216:219]
ds_read_b64_tr_b16 a[104:105], v13 offset:17152
v_cvt_pk_bf16_f32 v128, v128, v129
v_cvt_pk_bf16_f32 v129, v130, v131
v_mfma_f32_16x16x32_bf16 v[220:223], a[52:55], a[84:87], v[220:223]
ds_read_b64_tr_b16 a[106:107], v13 offset:18176
v_cvt_pk_bf16_f32 v130, v132, v133
v_mfma_f32_16x16x32_bf16 v[220:223], a[36:39], a[80:83], v[220:223]
ds_read_b64_tr_b16 a[108:109], v13 offset:25344
v_cvt_pk_bf16_f32 v131, v134, v135
v_mfma_f32_16x16x32_bf16 v[224:227], a[40:43], a[80:83], v[224:227]
ds_read_b64_tr_b16 a[110:111], v13 offset:26368
v_add_u32 v12, 0x8000, v12
v_accvgpr_write_b32 a180, v128
v_mfma_f32_16x16x32_bf16 v[224:227], a[56:59], a[84:87], v[224:227]
v_add_u32 v13, 0x8000, v13
v_accvgpr_write_b32 a181, v129
v_mfma_f32_16x16x32_bf16 v[228:231], a[60:63], a[84:87], v[228:231]
v_accvgpr_write_b32 a182, v130
v_accvgpr_write_b32 a183, v131
v_mfma_f32_16x16x32_bf16 v[228:231], a[44:47], a[80:83], v[228:231]
v_cvt_pk_bf16_f32 v136, v136, v137
v_cvt_pk_bf16_f32 v137, v138, v139
v_cvt_pk_bf16_f32 v138, v140, v141
v_mfma_f32_16x16x32_bf16 v[244:247], a[44:47], a[88:91], v[244:247]
s_waitcnt vmcnt(27) lgkmcnt(0)
v_cvt_pk_bf16_f32 v139, v142, v143
v_accvgpr_write_b32 a184, v136
v_mfma_f32_16x16x32_bf16 v[244:247], a[60:63], a[92:95], v[244:247]
s_barrier
s_add_u32 m0, s17, 0x8000
v_accvgpr_write_b32 a185, v137
v_mfma_f32_16x16x32_bf16 v[240:243], a[56:59], a[92:95], v[240:243]
buffer_load_dwordx4 v5, s[52:55], 0 offen lds
v_accvgpr_write_b32 a186, v138
v_mfma_f32_16x16x32_bf16 v[240:243], a[40:43], a[88:91], v[240:243]
ds_read_b64_tr_b16 a[80:81], v12 offset:0
v_accvgpr_write_b32 a187, v139
v_mfma_f32_16x16x32_bf16 v[236:239], a[36:39], a[88:91], v[236:239]
ds_read_b64_tr_b16 a[82:83], v12 offset:1024
v_cvt_pk_bf16_f32 v144, v144, v145
v_mfma_f32_16x16x32_bf16 v[236:239], a[52:55], a[92:95], v[236:239]
ds_read_b64_tr_b16 a[84:85], v12 offset:8192
v_cvt_pk_bf16_f32 v145, v146, v147
v_cvt_pk_bf16_f32 v146, v148, v149
v_mfma_f32_16x16x32_bf16 v[232:235], a[48:51], a[92:95], v[232:235]
ds_read_b64_tr_b16 a[86:87], v12 offset:9216
v_cvt_pk_bf16_f32 v147, v150, v151
v_mfma_f32_16x16x32_bf16 v[232:235], a[32:35], a[88:91], v[232:235]
s_add_u32 m0, s17, 0x8400
s_waitcnt lgkmcnt(4)
v_accvgpr_write_b32 a188, v144
v_mfma_f32_16x16x32_bf16 v[248:251], a[32:35], a[96:99], v[248:251]
buffer_load_dwordx4 v5, s[52:55], s13 offen lds
v_accvgpr_write_b32 a189, v145
v_mfma_f32_16x16x32_bf16 v[248:251], a[48:51], a[100:103], v[248:251]
ds_read_b64_tr_b16 a[88:89], v13 offset:0
v_accvgpr_write_b32 a190, v146
v_mfma_f32_16x16x32_bf16 v[252:255], a[52:55], a[100:103], v[252:255]
ds_read_b64_tr_b16 a[90:91], v13 offset:1024
v_accvgpr_write_b32 a191, v147
v_mfma_f32_16x16x32_bf16 v[252:255], a[36:39], a[96:99], v[252:255]
ds_read_b64_tr_b16 a[92:93], v13 offset:8192
v_cvt_pk_bf16_f32 v152, v152, v153
v_cvt_pk_bf16_f32 v153, v154, v155
v_mfma_f32_16x16x32_bf16 a[232:235], a[40:43], a[96:99], a[232:235]
ds_read_b64_tr_b16 a[94:95], v13 offset:9216
v_cvt_pk_bf16_f32 v154, v156, v157
v_mfma_f32_16x16x32_bf16 a[232:235], a[56:59], a[100:103], a[232:235]
v_cvt_pk_bf16_f32 v155, v158, v159
v_accvgpr_write_b32 a192, v152
v_mfma_f32_16x16x32_bf16 a[236:239], a[60:63], a[100:103], a[236:239]
s_add_u32 m0, s17, 0x8800
v_accvgpr_write_b32 a193, v153
v_accvgpr_write_b32 a194, v154
v_accvgpr_write_b32 a195, v155
v_mfma_f32_16x16x32_bf16 a[236:239], a[44:47], a[96:99], a[236:239]
buffer_load_dwordx4 v6, s[52:55], 0 offen lds
v_mfma_f32_16x16x32_bf16 a[252:255], a[44:47], a[104:107], a[252:255]
ds_read_b64_tr_b16 a[96:97], v12 offset:256
v_cvt_pk_bf16_f32 v160, v160, v161
v_mfma_f32_16x16x32_bf16 a[252:255], a[60:63], a[108:111], a[252:255]
ds_read_b64_tr_b16 a[98:99], v12 offset:1280
v_cvt_pk_bf16_f32 v161, v162, v163
v_cvt_pk_bf16_f32 v162, v164, v165
v_mfma_f32_16x16x32_bf16 a[248:251], a[56:59], a[108:111], a[248:251]
ds_read_b64_tr_b16 a[100:101], v12 offset:8448
v_cvt_pk_bf16_f32 v163, v166, v167
v_mfma_f32_16x16x32_bf16 a[248:251], a[40:43], a[104:107], a[248:251]
ds_read_b64_tr_b16 a[102:103], v12 offset:9472
v_accvgpr_write_b32 a196, v160
v_mfma_f32_16x16x32_bf16 a[244:247], a[36:39], a[104:107], a[244:247]
v_accvgpr_write_b32 a197, v161
v_accvgpr_write_b32 a198, v162
v_accvgpr_write_b32 a199, v163
v_mfma_f32_16x16x32_bf16 a[244:247], a[52:55], a[108:111], a[244:247]
s_add_u32 m0, s17, 0x8c00
v_cvt_pk_bf16_f32 v168, v168, v169
v_cvt_pk_bf16_f32 v169, v170, v171
v_mfma_f32_16x16x32_bf16 a[240:243], a[48:51], a[108:111], a[240:243]
buffer_load_dwordx4 v6, s[52:55], s13 offen lds
v_mfma_f32_16x16x32_bf16 a[240:243], a[32:35], a[104:107], a[240:243]
s_waitcnt lgkmcnt(4)
v_cvt_pk_bf16_f32 v170, v172, v173
v_cvt_pk_bf16_f32 v171, v174, v175
v_accvgpr_write_b32 a200, v168
L_S8:
v_mfma_f32_16x16x32_bf16 v[24:27], a[80:83], a[0:3], 0
ds_read_b64_tr_b16 a[104:105], v13 offset:256
s_waitcnt vmcnt(22)
v_mfma_f32_16x16x32_bf16 v[24:27], a[84:87], a[16:19], v[24:27]
ds_read_b64_tr_b16 a[106:107], v13 offset:1280
v_accvgpr_write_b32 a201, v169
v_mfma_f32_16x16x32_bf16 v[32:35], a[84:87], a[20:23], 0
ds_read_b64_tr_b16 a[108:109], v13 offset:8448
v_accvgpr_write_b32 a202, v170
v_accvgpr_write_b32 a203, v171
v_mfma_f32_16x16x32_bf16 v[32:35], a[80:83], a[4:7], v[32:35]
ds_read_b64_tr_b16 a[110:111], v13 offset:9472
v_cvt_pk_bf16_f32 v176, v176, v177
v_mfma_f32_16x16x32_bf16 v[40:43], a[80:83], a[8:11], 0
ds_read_b128 a[32:35], v8 offset:32768
s_add_u32 m0, s18, 0xc000
v_mfma_f32_16x16x32_bf16 v[40:43], a[84:87], a[24:27], v[40:43]
buffer_load_dwordx4 v7, s[68:71], 0 offen lds
v_cvt_pk_bf16_f32 v177, v178, v179
v_mfma_f32_16x16x32_bf16 v[48:51], a[84:87], a[28:31], 0
ds_read_b128 a[48:51], v9 offset:32768
v_cvt_pk_bf16_f32 v178, v180, v181
v_mfma_f32_16x16x32_bf16 v[48:51], a[80:83], a[12:15], v[48:51]
ds_read_b128 a[36:39], v8 offset:34816
v_cvt_pk_bf16_f32 v179, v182, v183
v_mfma_f32_16x16x32_bf16 v[52:55], a[88:91], a[12:15], 0
ds_read_b64_tr_b16 a[80:81], v12 offset:512
v_accvgpr_write_b32 a204, v176
v_accvgpr_write_b32 a205, v177
v_mfma_f32_16x16x32_bf16 v[52:55], a[92:95], a[28:31], v[52:55]
ds_read_b64_tr_b16 a[82:83], v12 offset:1536
v_accvgpr_write_b32 a206, v178
v_mfma_f32_16x16x32_bf16 v[44:47], a[92:95], a[24:27], 0
ds_read_b64_tr_b16 a[84:85], v12 offset:8704
s_add_u32 s8, s28, 0x2000
v_mfma_f32_16x16x32_bf16 v[44:47], a[88:91], a[8:11], v[44:47]
buffer_store_dwordx4 a[128:131], v16, s[88:91], s8 offen sc1
v_accvgpr_write_b32 a207, v179
v_mfma_f32_16x16x32_bf16 v[36:39], a[88:91], a[4:7], 0
ds_read_b64_tr_b16 a[86:87], v12 offset:9728
v_cvt_pk_bf16_f32 v184, v184, v185
v_mfma_f32_16x16x32_bf16 v[36:39], a[92:95], a[20:23], v[36:39]
ds_read_b128 a[52:55], v9 offset:34816
v_cvt_pk_bf16_f32 v185, v186, v187
v_mfma_f32_16x16x32_bf16 v[28:31], a[92:95], a[16:19], 0
ds_read_b128 a[40:43], v8 offset:36864
v_cvt_pk_bf16_f32 v186, v188, v189
v_cvt_pk_bf16_f32 v187, v190, v191
v_mfma_f32_16x16x32_bf16 v[28:31], a[88:91], a[0:3], v[28:31]
ds_read_b128 a[56:59], v9 offset:36864
s_waitcnt lgkmcnt(10)
v_mfma_f32_16x16x32_bf16 v[56:59], a[96:99], a[0:3], 0
ds_read_b64_tr_b16 a[88:89], v13 offset:512
v_accvgpr_write_b32 a208, v184
v_mfma_f32_16x16x32_bf16 v[56:59], a[100:103], a[16:19], v[56:59]
ds_read_b64_tr_b16 a[90:91], v13 offset:1536
s_add_u32 m0, s18, 0xd000
v_accvgpr_write_b32 a209, v185
v_mfma_f32_16x16x32_bf16 v[64:67], a[100:103], a[20:23], 0
buffer_load_dwordx4 v7, s[68:71], s25 offen lds
v_mfma_f32_16x16x32_bf16 v[64:67], a[96:99], a[4:7], v[64:67]
ds_read_b64_tr_b16 a[92:93], v13 offset:8704
v_accvgpr_write_b32 a210, v186
v_mfma_f32_16x16x32_bf16 v[72:75], a[96:99], a[8:11], 0
ds_read_b64_tr_b16 a[94:95], v13 offset:9728
v_accvgpr_write_b32 a211, v187
v_cvt_pk_bf16_f32 v192, v192, v193
v_mfma_f32_16x16x32_bf16 v[72:75], a[100:103], a[24:27], v[72:75]
ds_read_b128 a[44:47], v8 offset:38912
v_cvt_pk_bf16_f32 v193, v194, v195
v_mfma_f32_16x16x32_bf16 v[80:83], a[100:103], a[28:31], 0
ds_read_b128 a[60:63], v9 offset:38912
v_cvt_pk_bf16_f32 v194, v196, v197
v_mfma_f32_16x16x32_bf16 v[80:83], a[96:99], a[12:15], v[80:83]
v_cvt_pk_bf16_f32 v195, v198, v199
v_accvgpr_write_b32 a212, v192
v_accvgpr_write_b32 a213, v193
v_mfma_f32_16x16x32_bf16 v[84:87], a[104:107], a[12:15], 0
ds_read_b64_tr_b16 a[96:97], v12 offset:768
s_add_u32 m0, s18, 0xe000
v_mfma_f32_16x16x32_bf16 v[84:87], a[108:111], a[28:31], v[84:87]
buffer_load_dwordx4 v7, s[68:71], s26 offen lds
v_mfma_f32_16x16x32_bf16 v[76:79], a[108:111], a[24:27], 0
ds_read_b64_tr_b16 a[98:99], v12 offset:1792
v_lshl_add_u32 v5, s42, 19, v5
v_accvgpr_write_b32 a214, v194
v_mfma_f32_16x16x32_bf16 v[76:79], a[104:107], a[8:11], v[76:79]
ds_read_b64_tr_b16 a[100:101], v12 offset:8960
v_lshl_add_u32 v6, s42, 19, v6
v_mfma_f32_16x16x32_bf16 v[68:71], a[104:107], a[4:7], 0
ds_read_b64_tr_b16 a[102:103], v12 offset:9984
v_lshl_add_u32 v7, s42, 18, v7
v_mfma_f32_16x16x32_bf16 v[68:71], a[108:111], a[20:23], v[68:71]
v_lshl_add_u32 v7, s42, 17, v7
v_accvgpr_write_b32 a215, v195
v_cvt_pk_bf16_f32 v200, v200, v201
v_mfma_f32_16x16x32_bf16 v[60:63], a[108:111], a[16:19], 0
v_cvt_pk_bf16_f32 v201, v202, v203
v_cvt_pk_bf16_f32 v202, v204, v205
v_mfma_f32_16x16x32_bf16 v[60:63], a[104:107], a[0:3], v[60:63]
s_add_u32 m0, s16, 0x8000
s_waitcnt lgkmcnt(4)
s_waitcnt lgkmcnt(6)
v_mfma_f32_16x16x32_bf16 v[88:91], a[80:83], a[0:3], 0
buffer_load_dwordx4 v22, s[44:47], s20 offen lds
v_cvt_pk_bf16_f32 v203, v206, v207
v_mfma_f32_16x16x32_bf16 v[88:91], a[84:87], a[16:19], v[88:91]
ds_read_b64_tr_b16 a[104:105], v13 offset:768
v_accvgpr_write_b32 a216, v200
v_mfma_f32_16x16x32_bf16 v[96:99], a[84:87], a[20:23], 0
ds_read_b64_tr_b16 a[106:107], v13 offset:1792
v_accvgpr_write_b32 a217, v201
v_mfma_f32_16x16x32_bf16 v[96:99], a[80:83], a[4:7], v[96:99]
ds_read_b64_tr_b16 a[108:109], v13 offset:8960
v_accvgpr_write_b32 a218, v202
v_accvgpr_write_b32 a219, v203
v_mfma_f32_16x16x32_bf16 v[104:107], a[80:83], a[8:11], 0
ds_read_b64_tr_b16 a[110:111], v13 offset:9984
s_add_u32 m0, s16, 0x8400
v_mfma_f32_16x16x32_bf16 v[104:107], a[84:87], a[24:27], v[104:107]
buffer_load_dwordx4 v23, s[44:47], s20 offen lds
v_mfma_f32_16x16x32_bf16 v[112:115], a[84:87], a[28:31], 0
v_cvt_pk_bf16_f32 v208, v208, v209
v_cvt_pk_bf16_f32 v209, v210, v211
v_cvt_pk_bf16_f32 v210, v212, v213
v_mfma_f32_16x16x32_bf16 v[112:115], a[80:83], a[12:15], v[112:115]
v_cvt_pk_bf16_f32 v211, v214, v215
v_accvgpr_write_b32 a220, v208
v_mfma_f32_16x16x32_bf16 v[116:119], a[88:91], a[12:15], 0
ds_read_b64_tr_b16 a[80:81], v14 offset:0
v_accvgpr_write_b32 a221, v209
v_mfma_f32_16x16x32_bf16 v[116:119], a[92:95], a[28:31], v[116:119]
ds_read_b64_tr_b16 a[82:83], v14 offset:256
v_accvgpr_write_b32 a222, v210
v_accvgpr_write_b32 a223, v211
v_mfma_f32_16x16x32_bf16 v[108:111], a[92:95], a[24:27], 0
ds_read_b64_tr_b16 a[84:85], v14 offset:2048
s_add_u32 m0, s16, 0x8800
v_mfma_f32_16x16x32_bf16 v[108:111], a[88:91], a[8:11], v[108:111]
buffer_load_dwordx4 v22, s[44:47], s21 offen lds
v_mfma_f32_16x16x32_bf16 v[100:103], a[88:91], a[4:7], 0
ds_read_b64_tr_b16 a[86:87], v14 offset:2304
v_cvt_pk_bf16_f32 v216, v216, v217
v_cvt_pk_bf16_f32 v217, v218, v219
v_mfma_f32_16x16x32_bf16 v[100:103], a[92:95], a[20:23], v[100:103]
v_cvt_pk_bf16_f32 v218, v220, v221
v_cvt_pk_bf16_f32 v219, v222, v223
v_mfma_f32_16x16x32_bf16 v[92:95], a[92:95], a[16:19], 0
v_accvgpr_write_b32 a224, v216
v_accvgpr_write_b32 a225, v217
v_mfma_f32_16x16x32_bf16 v[92:95], a[88:91], a[0:3], v[92:95]
s_add_u32 s8, s28, 0x3000
s_waitcnt lgkmcnt(4)
v_accvgpr_write_b32 a226, v218
v_accvgpr_write_b32 a227, v219
v_mfma_f32_16x16x32_bf16 v[120:123], a[96:99], a[0:3], 0
buffer_store_dwordx4 a[132:135], v16, s[88:91], s8 offen sc1
v_mfma_f32_16x16x32_bf16 v[120:123], a[100:103], a[16:19], v[120:123]
ds_read_b64_tr_b16 a[88:89], v15 offset:0
v_cvt_pk_bf16_f32 v224, v224, v225
v_mfma_f32_16x16x32_bf16 v[128:131], a[100:103], a[20:23], 0
ds_read_b64_tr_b16 a[90:91], v15 offset:256
v_cvt_pk_bf16_f32 v225, v226, v227
v_cvt_pk_bf16_f32 v226, v228, v229
v_mfma_f32_16x16x32_bf16 v[128:131], a[96:99], a[4:7], v[128:131]
ds_read_b64_tr_b16 a[92:93], v15 offset:2048
v_cvt_pk_bf16_f32 v227, v230, v231
v_mfma_f32_16x16x32_bf16 v[136:139], a[96:99], a[8:11], 0
ds_read_b64_tr_b16 a[94:95], v15 offset:2304
v_accvgpr_write_b32 a228, v224
v_mfma_f32_16x16x32_bf16 v[136:139], a[100:103], a[24:27], v[136:139]
s_add_u32 m0, s16, 0x8c00
v_accvgpr_write_b32 a229, v225
v_accvgpr_write_b32 a230, v226
v_accvgpr_write_b32 a231, v227
v_mfma_f32_16x16x32_bf16 v[144:147], a[100:103], a[28:31], 0
buffer_load_dwordx4 v23, s[44:47], s21 offen lds
v_mfma_f32_16x16x32_bf16 v[144:147], a[96:99], a[12:15], v[144:147]
v_cvt_pk_bf16_f32 v232, v232, v233
v_cvt_pk_bf16_f32 v233, v234, v235
v_mfma_f32_16x16x32_bf16 v[148:151], a[104:107], a[12:15], 0
ds_read_b64_tr_b16 a[96:97], v14 offset:4096
v_cvt_pk_bf16_f32 v234, v236, v237
v_cvt_pk_bf16_f32 v235, v238, v239
v_mfma_f32_16x16x32_bf16 v[148:151], a[108:111], a[28:31], v[148:151]
ds_read_b64_tr_b16 a[98:99], v14 offset:4352
v_accvgpr_write_b32 a112, v232
v_mfma_f32_16x16x32_bf16 v[140:143], a[108:111], a[24:27], 0
ds_read_b64_tr_b16 a[100:101], v14 offset:6144
v_accvgpr_write_b32 a113, v233
v_mfma_f32_16x16x32_bf16 v[140:143], a[104:107], a[8:11], v[140:143]
ds_read_b64_tr_b16 a[102:103], v14 offset:6400
s_add_u32 m0, s16, 0x9000
v_accvgpr_write_b32 a114, v234
v_mfma_f32_16x16x32_bf16 v[132:135], a[104:107], a[4:7], 0
buffer_load_dwordx4 v22, s[44:47], s22 offen lds
v_mfma_f32_16x16x32_bf16 v[132:135], a[108:111], a[20:23], v[132:135]
v_accvgpr_write_b32 a115, v235
v_cvt_pk_bf16_f32 v240, v240, v241
v_mfma_f32_16x16x32_bf16 v[124:127], a[108:111], a[16:19], 0
v_cvt_pk_bf16_f32 v241, v242, v243
v_cvt_pk_bf16_f32 v242, v244, v245
v_cvt_pk_bf16_f32 v243, v246, v247
v_mfma_f32_16x16x32_bf16 v[124:127], a[104:107], a[0:3], v[124:127]
s_waitcnt lgkmcnt(4)
v_accvgpr_write_b32 a116, v240
v_accvgpr_write_b32 a117, v241
v_mfma_f32_16x16x32_bf16 v[152:155], a[80:83], a[0:3], 0
ds_read_b64_tr_b16 a[104:105], v15 offset:4096
s_add_u32 m0, s16, 0x9400
v_mfma_f32_16x16x32_bf16 v[152:155], a[84:87], a[16:19], v[152:155]
buffer_load_dwordx4 v23, s[44:47], s22 offen lds
v_accvgpr_write_b32 a118, v242
v_mfma_f32_16x16x32_bf16 v[160:163], a[84:87], a[20:23], 0
ds_read_b64_tr_b16 a[106:107], v15 offset:4352
v_accvgpr_write_b32 a119, v243
v_mfma_f32_16x16x32_bf16 v[160:163], a[80:83], a[4:7], v[160:163]
ds_read_b64_tr_b16 a[108:109], v15 offset:6144
v_cvt_pk_bf16_f32 v248, v248, v249
v_mfma_f32_16x16x32_bf16 v[168:171], a[80:83], a[8:11], 0
ds_read_b64_tr_b16 a[110:111], v15 offset:6400
v_cvt_pk_bf16_f32 v249, v250, v251
v_cvt_pk_bf16_f32 v250, v252, v253
v_mfma_f32_16x16x32_bf16 v[168:171], a[84:87], a[24:27], v[168:171]
v_cvt_pk_bf16_f32 v251, v254, v255
v_accvgpr_write_b32 a124, v248
v_mfma_f32_16x16x32_bf16 v[176:179], a[84:87], a[28:31], 0
s_add_u32 m0, s16, 0x9800
v_accvgpr_write_b32 a125, v249
v_accvgpr_write_b32 a126, v250
v_mfma_f32_16x16x32_bf16 v[176:179], a[80:83], a[12:15], v[176:179]
buffer_load_dwordx4 v22, s[44:47], s23 offen lds
v_accvgpr_write_b32 a127, v251
v_mfma_f32_16x16x32_bf16 v[180:183], a[88:91], a[12:15], 0
ds_read_b64_tr_b16 a[80:81], v14 offset:8192
v_accvgpr_read_b32 v2, a232
v_mfma_f32_16x16x32_bf16 v[180:183], a[92:95], a[28:31], v[180:183]
ds_read_b64_tr_b16 a[82:83], v14 offset:8448
v_accvgpr_read_b32 v3, a233
v_mfma_f32_16x16x32_bf16 v[172:175], a[92:95], a[24:27], 0
ds_read_b64_tr_b16 a[84:85], v14 offset:10240
v_cvt_pk_bf16_f32 v2, v2, v3
v_accvgpr_write_b32 a232, v2
v_mfma_f32_16x16x32_bf16 v[172:175], a[88:91], a[8:11], v[172:175]
ds_read_b64_tr_b16 a[86:87], v14 offset:10496
s_add_u32 m0, s16, 0x9c00
v_mfma_f32_16x16x32_bf16 v[164:167], a[88:91], a[4:7], 0
buffer_load_dwordx4 v23, s[44:47], s23 offen lds
v_mfma_f32_16x16x32_bf16 v[164:167], a[92:95], a[20:23], v[164:167]
v_lshl_add_u32 v22, s42, 7, v22
v_lshl_add_u32 v23, s42, 7, v23
v_accvgpr_read_b32 v2, a234
v_mfma_f32_16x16x32_bf16 v[156:159], a[92:95], a[16:19], 0
v_accvgpr_read_b32 v3, a235
v_cvt_pk_bf16_f32 v2, v2, v3
v_mfma_f32_16x16x32_bf16 v[156:159], a[88:91], a[0:3], v[156:159]
s_waitcnt lgkmcnt(4)
v_accvgpr_write_b32 a233, v2
v_accvgpr_read_b32 v2, a236
v_mfma_f32_16x16x32_bf16 v[184:187], a[96:99], a[0:3], 0
ds_read_b64_tr_b16 a[88:89], v15 offset:8192
v_accvgpr_read_b32 v3, a237
v_cvt_pk_bf16_f32 v2, v2, v3
v_mfma_f32_16x16x32_bf16 v[184:187], a[100:103], a[16:19], v[184:187]
ds_read_b64_tr_b16 a[90:91], v15 offset:8448
s_add_u32 s8, s28, 0x6000
v_mfma_f32_16x16x32_bf16 v[192:195], a[100:103], a[20:23], 0
buffer_store_dwordx4 a[136:139], v16, s[88:91], s8 offen sc1
v_mfma_f32_16x16x32_bf16 v[192:195], a[96:99], a[4:7], v[192:195]
ds_read_b64_tr_b16 a[92:93], v15 offset:10240
v_accvgpr_write_b32 a234, v2
v_accvgpr_read_b32 v2, a238
v_mfma_f32_16x16x32_bf16 v[200:203], a[96:99], a[8:11], 0
ds_read_b64_tr_b16 a[94:95], v15 offset:10496
v_add_u32 v12, 0xffff0000, v12
v_mfma_f32_16x16x32_bf16 v[200:203], a[100:103], a[24:27], v[200:203]
v_add_u32 v13, 0xffff0000, v13
v_add_u32 v14, 0xffff0000, v14
v_mfma_f32_16x16x32_bf16 v[208:211], a[100:103], a[28:31], 0
v_add_u32 v15, 0xffff0000, v15
v_accvgpr_read_b32 v3, a239
v_cvt_pk_bf16_f32 v2, v2, v3
v_mfma_f32_16x16x32_bf16 v[208:211], a[96:99], a[12:15], v[208:211]
v_accvgpr_write_b32 a235, v2
v_accvgpr_read_b32 v2, a240
v_mfma_f32_16x16x32_bf16 v[212:215], a[104:107], a[12:15], 0
s_waitcnt vmcnt(28) lgkmcnt(0)
v_accvgpr_read_b32 v3, a241
v_cvt_pk_bf16_f32 v2, v2, v3
v_mfma_f32_16x16x32_bf16 v[212:215], a[108:111], a[28:31], v[212:215]
s_barrier
s_add_u32 m0, s17, 0x10000
v_accvgpr_write_b32 a240, v2
v_accvgpr_read_b32 v2, a242
v_mfma_f32_16x16x32_bf16 v[204:207], a[108:111], a[24:27], 0
buffer_load_dwordx4 v5, s[52:55], 0 offen lds
v_mfma_f32_16x16x32_bf16 v[204:207], a[104:107], a[8:11], v[204:207]
ds_read_b64_tr_b16 a[96:97], v12 offset:0
v_accvgpr_read_b32 v3, a243
v_mfma_f32_16x16x32_bf16 v[196:199], a[104:107], a[4:7], 0
ds_read_b64_tr_b16 a[98:99], v12 offset:1024
v_cvt_pk_bf16_f32 v2, v2, v3
v_accvgpr_write_b32 a241, v2
v_mfma_f32_16x16x32_bf16 v[196:199], a[108:111], a[20:23], v[196:199]
ds_read_b64_tr_b16 a[100:101], v12 offset:8192
v_accvgpr_read_b32 v2, a244
v_mfma_f32_16x16x32_bf16 v[188:191], a[108:111], a[16:19], 0
ds_read_b64_tr_b16 a[102:103], v12 offset:9216
v_accvgpr_read_b32 v3, a245
v_mfma_f32_16x16x32_bf16 v[188:191], a[104:107], a[0:3], v[188:191]
s_add_u32 m0, s17, 0x10400
s_waitcnt lgkmcnt(4)
v_cvt_pk_bf16_f32 v2, v2, v3
v_accvgpr_write_b32 a242, v2
v_mfma_f32_16x16x32_bf16 v[216:219], a[0:3], a[80:83], 0
buffer_load_dwordx4 v5, s[52:55], s13 offen lds
v_mfma_f32_16x16x32_bf16 v[216:219], a[16:19], a[84:87], v[216:219]
ds_read_b64_tr_b16 a[104:105], v13 offset:0
v_accvgpr_read_b32 v2, a246
v_mfma_f32_16x16x32_bf16 v[224:227], a[20:23], a[84:87], 0
ds_read_b64_tr_b16 a[106:107], v13 offset:1024
v_accvgpr_read_b32 v3, a247
v_cvt_pk_bf16_f32 v2, v2, v3
v_mfma_f32_16x16x32_bf16 v[224:227], a[4:7], a[80:83], v[224:227]
ds_read_b64_tr_b16 a[108:109], v13 offset:8192
v_accvgpr_write_b32 a243, v2
v_mfma_f32_16x16x32_bf16 v[232:235], a[8:11], a[80:83], 0
ds_read_b64_tr_b16 a[110:111], v13 offset:9216
v_accvgpr_read_b32 v2, a248
v_mfma_f32_16x16x32_bf16 v[232:235], a[24:27], a[84:87], v[232:235]
v_accvgpr_read_b32 v3, a249
v_cvt_pk_bf16_f32 v2, v2, v3
v_accvgpr_write_b32 a248, v2
v_mfma_f32_16x16x32_bf16 v[240:243], a[28:31], a[84:87], 0
s_add_u32 m0, s17, 0x10800
v_accvgpr_read_b32 v2, a250
v_accvgpr_read_b32 v3, a251
v_mfma_f32_16x16x32_bf16 v[240:243], a[12:15], a[80:83], v[240:243]
buffer_load_dwordx4 v6, s[52:55], 0 offen lds
v_mfma_f32_16x16x32_bf16 v[244:247], a[12:15], a[88:91], 0
ds_read_b64_tr_b16 a[80:81], v12 offset:256
v_cvt_pk_bf16_f32 v2, v2, v3
v_accvgpr_write_b32 a249, v2
v_mfma_f32_16x16x32_bf16 v[244:247], a[28:31], a[92:95], v[244:247]
ds_read_b64_tr_b16 a[82:83], v12 offset:1280
v_accvgpr_read_b32 v2, a252
v_mfma_f32_16x16x32_bf16 v[236:239], a[24:27], a[92:95], 0
ds_read_b64_tr_b16 a[84:85], v12 offset:8448
v_accvgpr_read_b32 v3, a253
v_mfma_f32_16x16x32_bf16 v[236:239], a[8:11], a[88:91], v[236:239]
ds_read_b64_tr_b16 a[86:87], v12 offset:9472
v_cvt_pk_bf16_f32 v2, v2, v3
v_accvgpr_write_b32 a250, v2
v_mfma_f32_16x16x32_bf16 v[228:231], a[4:7], a[88:91], 0
v_accvgpr_read_b32 v2, a254
v_accvgpr_read_b32 v3, a255
v_mfma_f32_16x16x32_bf16 v[228:231], a[20:23], a[92:95], v[228:231]
s_add_u32 m0, s17, 0x10c00
v_cvt_pk_bf16_f32 v2, v2, v3
v_accvgpr_write_b32 a251, v2
v_mfma_f32_16x16x32_bf16 v[220:223], a[16:19], a[92:95], 0
buffer_load_dwordx4 v6, s[52:55], s13 offen lds
v_mfma_f32_16x16x32_bf16 v[220:223], a[0:3], a[88:91], v[220:223]
s_waitcnt lgkmcnt(4)
L_S9:
v_mfma_f32_16x16x32_bf16 v[24:27], a[96:99], a[32:35], v[24:27]
ds_read_b64_tr_b16 a[88:89], v13 offset:256
s_waitcnt vmcnt(23)
v_mfma_f32_16x16x32_bf16 v[24:27], a[100:103], a[48:51], v[24:27]
ds_read_b64_tr_b16 a[90:91], v13 offset:1280
L_padA5:
s_cmp_eq_u32 s95, 1
s_cbranch_scc1 L_padA9
v_mfma_f32_16x16x32_bf16 v[32:35], a[100:103], a[52:55], v[32:35]
ds_read_b64_tr_b16 a[92:93], v13 offset:8448
v_mfma_f32_16x16x32_bf16 v[32:35], a[96:99], a[36:39], v[32:35]
ds_read_b64_tr_b16 a[94:95], v13 offset:9472
v_mfma_f32_16x16x32_bf16 v[40:43], a[96:99], a[40:43], v[40:43]
ds_read_b128 a[0:3], v8 offset:0
s_add_u32 m0, s18, 0x14000
v_mfma_f32_16x16x32_bf16 v[40:43], a[100:103], a[56:59], v[40:43]
buffer_load_dwordx4 v7, s[68:71], 0 offen lds
v_mfma_f32_16x16x32_bf16 v[48:51], a[100:103], a[60:63], v[48:51]
ds_read_b128 a[16:19], v9 offset:0
v_mfma_f32_16x16x32_bf16 v[48:51], a[96:99], a[44:47], v[48:51]
ds_read_b128 a[4:7], v8 offset:2048
v_mfma_f32_16x16x32_bf16 v[52:55], a[104:107], a[44:47], v[52:55]
ds_read_b64_tr_b16 a[96:97], v12 offset:512
v_mfma_f32_16x16x32_bf16 v[52:55], a[108:111], a[60:63], v[52:55]
ds_read_b64_tr_b16 a[98:99], v12 offset:1536
v_mfma_f32_16x16x32_bf16 v[44:47], a[108:111], a[56:59], v[44:47]
ds_read_b64_tr_b16 a[100:101], v12 offset:8704
s_add_u32 s8, s28, 0x7000
v_mfma_f32_16x16x32_bf16 v[44:47], a[104:107], a[40:43], v[44:47]
buffer_store_dwordx4 a[140:143], v16, s[88:91], s8 offen sc1
v_mfma_f32_16x16x32_bf16 v[36:39], a[104:107], a[36:39], v[36:39]
ds_read_b64_tr_b16 a[102:103], v12 offset:9728
v_mfma_f32_16x16x32_bf16 v[36:39], a[108:111], a[52:55], v[36:39]
ds_read_b128 a[20:23], v9 offset:2048
v_mfma_f32_16x16x32_bf16 v[28:31], a[108:111], a[48:51], v[28:31]
ds_read_b128 a[8:11], v8 offset:4096
v_mfma_f32_16x16x32_bf16 v[28:31], a[104:107], a[32:35], v[28:31]
ds_read_b128 a[24:27], v9 offset:4096
s_waitcnt lgkmcnt(10)
v_mfma_f32_16x16x32_bf16 v[56:59], a[80:83], a[32:35], v[56:59]
ds_read_b64_tr_b16 a[104:105], v13 offset:512
v_mfma_f32_16x16x32_bf16 v[56:59], a[84:87], a[48:51], v[56:59]
ds_read_b64_tr_b16 a[106:107], v13 offset:1536
s_add_u32 m0, s18, 0x15000
v_mfma_f32_16x16x32_bf16 v[64:67], a[84:87], a[52:55], v[64:67]
buffer_load_dwordx4 v7, s[68:71], s25 offen lds
v_mfma_f32_16x16x32_bf16 v[64:67], a[80:83], a[36:39], v[64:67]
ds_read_b64_tr_b16 a[108:109], v13 offset:8704
v_mfma_f32_16x16x32_bf16 v[72:75], a[80:83], a[40:43], v[72:75]
ds_read_b64_tr_b16 a[110:111], v13 offset:9728
v_mfma_f32_16x16x32_bf16 v[72:75], a[84:87], a[56:59], v[72:75]
ds_read_b128 a[12:15], v8 offset:6144
v_mfma_f32_16x16x32_bf16 v[80:83], a[84:87], a[60:63], v[80:83]
ds_read_b128 a[28:31], v9 offset:6144
v_mfma_f32_16x16x32_bf16 v[80:83], a[80:83], a[44:47], v[80:83]
v_mfma_f32_16x16x32_bf16 v[84:87], a[88:91], a[44:47], v[84:87]
ds_read_b64_tr_b16 a[80:81], v12 offset:768
s_add_u32 m0, s18, 0x16000
v_mfma_f32_16x16x32_bf16 v[84:87], a[92:95], a[60:63], v[84:87]
buffer_load_dwordx4 v7, s[68:71], s26 offen lds
v_mfma_f32_16x16x32_bf16 v[76:79], a[92:95], a[56:59], v[76:79]
ds_read_b64_tr_b16 a[82:83], v12 offset:1792
v_lshl_add_u32 v5, s42, 19, v5
v_mfma_f32_16x16x32_bf16 v[76:79], a[88:91], a[40:43], v[76:79]
ds_read_b64_tr_b16 a[84:85], v12 offset:8960
v_lshl_add_u32 v6, s42, 19, v6
v_mfma_f32_16x16x32_bf16 v[68:71], a[88:91], a[36:39], v[68:71]
ds_read_b64_tr_b16 a[86:87], v12 offset:9984
v_lshl_add_u32 v7, s42, 18, v7
v_mfma_f32_16x16x32_bf16 v[68:71], a[92:95], a[52:55], v[68:71]
v_lshl_add_u32 v7, s42, 17, v7
v_mfma_f32_16x16x32_bf16 v[60:63], a[92:95], a[48:51], v[60:63]
v_mfma_f32_16x16x32_bf16 v[60:63], a[88:91], a[32:35], v[60:63]
s_add_u32 m0, s16, 0x0
s_waitcnt lgkmcnt(4)
s_waitcnt lgkmcnt(6)
v_mfma_f32_16x16x32_bf16 v[88:91], a[96:99], a[32:35], v[88:91]
buffer_load_dwordx4 v22, s[44:47], s20 offen lds
v_mfma_f32_16x16x32_bf16 v[88:91], a[100:103], a[48:51], v[88:91]
ds_read_b64_tr_b16 a[88:89], v13 offset:768
v_mfma_f32_16x16x32_bf16 v[96:99], a[100:103], a[52:55], v[96:99]
ds_read_b64_tr_b16 a[90:91], v13 offset:1792
v_mfma_f32_16x16x32_bf16 v[96:99], a[96:99], a[36:39], v[96:99]
ds_read_b64_tr_b16 a[92:93], v13 offset:8960
v_mfma_f32_16x16x32_bf16 v[104:107], a[96:99], a[40:43], v[104:107]
ds_read_b64_tr_b16 a[94:95], v13 offset:9984
s_add_u32 m0, s16, 0x400
v_mfma_f32_16x16x32_bf16 v[104:107], a[100:103], a[56:59], v[104:107]
buffer_load_dwordx4 v23, s[44:47], s20 offen lds
v_mfma_f32_16x16x32_bf16 v[112:115], a[100:103], a[60:63], v[112:115]
v_mfma_f32_16x16x32_bf16 v[112:115], a[96:99], a[44:47], v[112:115]
v_mfma_f32_16x16x32_bf16 v[116:119], a[104:107], a[44:47], v[116:119]
ds_read_b64_tr_b16 a[96:97], v14 offset:0
v_mfma_f32_16x16x32_bf16 v[116:119], a[108:111], a[60:63], v[116:119]
ds_read_b64_tr_b16 a[98:99], v14 offset:256
v_mfma_f32_16x16x32_bf16 v[108:111], a[108:111], a[56:59], v[108:111]
ds_read_b64_tr_b16 a[100:101], v14 offset:2048
s_add_u32 m0, s16, 0x800
v_mfma_f32_16x16x32_bf16 v[108:111], a[104:107], a[40:43], v[108:111]
buffer_load_dwordx4 v22, s[44:47], s21 offen lds
v_mfma_f32_16x16x32_bf16 v[100:103], a[104:107], a[36:39], v[100:103]
ds_read_b64_tr_b16 a[102:103], v14 offset:2304
v_mfma_f32_16x16x32_bf16 v[100:103], a[108:111], a[52:55], v[100:103]
v_mfma_f32_16x16x32_bf16 v[92:95], a[108:111], a[48:51], v[92:95]
v_mfma_f32_16x16x32_bf16 v[92:95], a[104:107], a[32:35], v[92:95]
s_add_u32 s8, s28, 0x2400
s_waitcnt lgkmcnt(4)
v_mfma_f32_16x16x32_bf16 v[120:123], a[80:83], a[32:35], v[120:123]
buffer_store_dwordx4 a[144:147], v16, s[88:91], s8 offen sc1
v_mfma_f32_16x16x32_bf16 v[120:123], a[84:87], a[48:51], v[120:123]
ds_read_b64_tr_b16 a[104:105], v15 offset:0
v_mfma_f32_16x16x32_bf16 v[128:131], a[84:87], a[52:55], v[128:131]
ds_read_b64_tr_b16 a[106:107], v15 offset:256
v_mfma_f32_16x16x32_bf16 v[128:131], a[80:83], a[36:39], v[128:131]
ds_read_b64_tr_b16 a[108:109], v15 offset:2048
v_mfma_f32_16x16x32_bf16 v[136:139], a[80:83], a[40:43], v[136:139]
ds_read_b64_tr_b16 a[110:111], v15 offset:2304
v_mfma_f32_16x16x32_bf16 v[136:139], a[84:87], a[56:59], v[136:139]
s_add_u32 m0, s16, 0xc00
v_mfma_f32_16x16x32_bf16 v[144:147], a[84:87], a[60:63], v[144:147]
buffer_load_dwordx4 v23, s[44:47], s21 offen lds
v_mfma_f32_16x16x32_bf16 v[144:147], a[80:83], a[44:47], v[144:147]
v_mfma_f32_16x16x32_bf16 v[148:151], a[88:91], a[44:47], v[148:151]
ds_read_b64_tr_b16 a[80:81], v14 offset:4096
v_mfma_f32_16x16x32_bf16 v[148:151], a[92:95], a[60:63], v[148:151]
ds_read_b64_tr_b16 a[82:83], v14 offset:4352
v_mfma_f32_16x16x32_bf16 v[140:143], a[92:95], a[56:59], v[140:143]
ds_read_b64_tr_b16 a[84:85], v14 offset:6144
v_mfma_f32_16x16x32_bf16 v[140:143], a[88:91], a[40:43], v[140:143]
ds_read_b64_tr_b16 a[86:87], v14 offset:6400
s_add_u32 m0, s16, 0x1000
v_mfma_f32_16x16x32_bf16 v[132:135], a[88:91], a[36:39], v[132:135]
buffer_load_dwordx4 v22, s[44:47], s22 offen lds
v_mfma_f32_16x16x32_bf16 v[132:135], a[92:95], a[52:55], v[132:135]
v_mfma_f32_16x16x32_bf16 v[124:127], a[92:95], a[48:51], v[124:127]
v_mfma_f32_16x16x32_bf16 v[124:127], a[88:91], a[32:35], v[124:127]
s_waitcnt lgkmcnt(4)
v_mfma_f32_16x16x32_bf16 v[152:155], a[96:99], a[32:35], v[152:155]
ds_read_b64_tr_b16 a[88:89], v15 offset:4096
s_add_u32 m0, s16, 0x1400
v_mfma_f32_16x16x32_bf16 v[152:155], a[100:103], a[48:51], v[152:155]
buffer_load_dwordx4 v23, s[44:47], s22 offen lds
v_mfma_f32_16x16x32_bf16 v[160:163], a[100:103], a[52:55], v[160:163]
ds_read_b64_tr_b16 a[90:91], v15 offset:4352
v_mfma_f32_16x16x32_bf16 v[160:163], a[96:99], a[36:39], v[160:163]
ds_read_b64_tr_b16 a[92:93], v15 offset:6144
v_mfma_f32_16x16x32_bf16 v[168:171], a[96:99], a[40:43], v[168:171]
ds_read_b64_tr_b16 a[94:95], v15 offset:6400
v_mfma_f32_16x16x32_bf16 v[168:171], a[100:103], a[56:59], v[168:171]
v_mfma_f32_16x16x32_bf16 v[176:179], a[100:103], a[60:63], v[176:179]
s_add_u32 m0, s16, 0x1800
v_mfma_f32_16x16x32_bf16 v[176:179], a[96:99], a[44:47], v[176:179]
buffer_load_dwordx4 v22, s[44:47], s23 offen lds
v_mfma_f32_16x16x32_bf16 v[180:183], a[104:107], a[44:47], v[180:183]
ds_read_b64_tr_b16 a[96:97], v14 offset:8192
v_mfma_f32_16x16x32_bf16 v[180:183], a[108:111], a[60:63], v[180:183]
ds_read_b64_tr_b16 a[98:99], v14 offset:8448
v_mfma_f32_16x16x32_bf16 v[172:175], a[108:111], a[56:59], v[172:175]
ds_read_b64_tr_b16 a[100:101], v14 offset:10240
v_mfma_f32_16x16x32_bf16 v[172:175], a[104:107], a[40:43], v[172:175]
ds_read_b64_tr_b16 a[102:103], v14 offset:10496
s_add_u32 m0, s16, 0x1c00
v_mfma_f32_16x16x32_bf16 v[164:167], a[104:107], a[36:39], v[164:167]
buffer_load_dwordx4 v23, s[44:47], s23 offen lds
v_mfma_f32_16x16x32_bf16 v[164:167], a[108:111], a[52:55], v[164:167]
v_lshl_add_u32 v22, s42, 7, v22
v_lshl_add_u32 v23, s42, 7, v23
v_mfma_f32_16x16x32_bf16 v[156:159], a[108:111], a[48:51], v[156:159]
v_mfma_f32_16x16x32_bf16 v[156:159], a[104:107], a[32:35], v[156:159]
s_waitcnt lgkmcnt(4)
v_mfma_f32_16x16x32_bf16 v[184:187], a[80:83], a[32:35], v[184:187]
ds_read_b64_tr_b16 a[104:105], v15 offset:8192
v_mfma_f32_16x16x32_bf16 v[184:187], a[84:87], a[48:51], v[184:187]
ds_read_b64_tr_b16 a[106:107], v15 offset:8448
s_add_u32 s8, s28, 0x3400
v_mfma_f32_16x16x32_bf16 v[192:195], a[84:87], a[52:55], v[192:195]
buffer_store_dwordx4 a[148:151], v16, s[88:91], s8 offen sc1
v_mfma_f32_16x16x32_bf16 v[192:195], a[80:83], a[36:39], v[192:195]
ds_read_b64_tr_b16 a[108:109], v15 offset:10240
v_mfma_f32_16x16x32_bf16 v[200:203], a[80:83], a[40:43], v[200:203]
ds_read_b64_tr_b16 a[110:111], v15 offset:10496
v_add_u32 v12, 0x8000, v12
v_mfma_f32_16x16x32_bf16 v[200:203], a[84:87], a[56:59], v[200:203]
v_add_u32 v13, 0x8000, v13
v_add_u32 v14, 0x8000, v14
v_mfma_f32_16x16x32_bf16 v[208:211], a[84:87], a[60:63], v[208:211]
v_add_u32 v15, 0x8000, v15
v_mfma_f32_16x16x32_bf16 v[208:211], a[80:83], a[44:47], v[208:211]
v_mfma_f32_16x16x32_bf16 v[212:215], a[88:91], a[44:47], v[212:215]
s_waitcnt vmcnt(28) lgkmcnt(0)
v_mfma_f32_16x16x32_bf16 v[212:215], a[92:95], a[60:63], v[212:215]
s_barrier
s_add_u32 m0, s17, 0x0
v_mfma_f32_16x16x32_bf16 v[204:207], a[92:95], a[56:59], v[204:207]
buffer_load_dwordx4 v5, s[52:55], 0 offen lds
v_mfma_f32_16x16x32_bf16 v[204:207], a[88:91], a[40:43], v[204:207]
ds_read_b64_tr_b16 a[80:81], v12 offset:0
v_mfma_f32_16x16x32_bf16 v[196:199], a[88:91], a[36:39], v[196:199]
ds_read_b64_tr_b16 a[82:83], v12 offset:1024
v_mfma_f32_16x16x32_bf16 v[196:199], a[92:95], a[52:55], v[196:199]
ds_read_b64_tr_b16 a[84:85], v12 offset:8192
v_mfma_f32_16x16x32_bf16 v[188:191], a[92:95], a[48:51], v[188:191]
ds_read_b64_tr_b16 a[86:87], v12 offset:9216
v_mfma_f32_16x16x32_bf16 v[188:191], a[88:91], a[32:35], v[188:191]
s_add_u32 m0, s17, 0x400
s_waitcnt lgkmcnt(4)
v_mfma_f32_16x16x32_bf16 v[216:219], a[32:35], a[96:99], v[216:219]
buffer_load_dwordx4 v5, s[52:55], s13 offen lds
v_mfma_f32_16x16x32_bf16 v[216:219], a[48:51], a[100:103], v[216:219]
ds_read_b64_tr_b16 a[88:89], v13 offset:0
v_mfma_f32_16x16x32_bf16 v[224:227], a[52:55], a[100:103], v[224:227]
ds_read_b64_tr_b16 a[90:91], v13 offset:1024
v_mfma_f32_16x16x32_bf16 v[224:227], a[36:39], a[96:99], v[224:227]
ds_read_b64_tr_b16 a[92:93], v13 offset:8192
v_mfma_f32_16x16x32_bf16 v[232:235], a[40:43], a[96:99], v[232:235]
ds_read_b64_tr_b16 a[94:95], v13 offset:9216
v_mfma_f32_16x16x32_bf16 v[232:235], a[56:59], a[100:103], v[232:235]
s_add_u32 m0, s17, 0x800
v_mfma_f32_16x16x32_bf16 v[240:243], a[60:63], a[100:103], v[240:243]
buffer_load_dwordx4 v6, s[52:55], 0 offen lds
v_mfma_f32_16x16x32_bf16 v[240:243], a[44:47], a[96:99], v[240:243]
v_mfma_f32_16x16x32_bf16 v[244:247], a[44:47], a[104:107], v[244:247]
ds_read_b64_tr_b16 a[96:97], v12 offset:256
v_mfma_f32_16x16x32_bf16 v[244:247], a[60:63], a[108:111], v[244:247]
ds_read_b64_tr_b16 a[98:99], v12 offset:1280
v_mfma_f32_16x16x32_bf16 v[236:239], a[56:59], a[108:111], v[236:239]
ds_read_b64_tr_b16 a[100:101], v12 offset:8448
v_mov_b32 v21, s1
v_mfma_f32_16x16x32_bf16 v[236:239], a[40:43], a[104:107], v[236:239]
ds_read_b64_tr_b16 a[102:103], v12 offset:9472
v_add_u32 v20, s0, v16
v_mfma_f32_16x16x32_bf16 v[228:231], a[36:39], a[104:107], v[228:231]
global_load_dword a120, v[20:21], off sc1
v_mfma_f32_16x16x32_bf16 v[228:231], a[52:55], a[108:111], v[228:231]
v_mfma_f32_16x16x32_bf16 v[220:223], a[48:51], a[108:111], v[220:223]
v_mfma_f32_16x16x32_bf16 v[220:223], a[32:35], a[104:107], v[220:223]
s_waitcnt lgkmcnt(4)
L_S10:
v_mfma_f32_16x16x32_bf16 v[24:27], a[80:83], a[0:3], v[24:27]
ds_read_b64_tr_b16 a[104:105], v13 offset:256
s_waitcnt vmcnt(23)
v_mfma_f32_16x16x32_bf16 v[24:27], a[84:87], a[16:19], v[24:27]
ds_read_b64_tr_b16 a[106:107], v13 offset:1280
s_add_u32 m0, s17, 0xc00
v_mfma_f32_16x16x32_bf16 v[32:35], a[84:87], a[20:23], v[32:35]
buffer_load_dwordx4 v6, s[52:55], s13 offen lds
v_mfma_f32_16x16x32_bf16 v[32:35], a[80:83], a[4:7], v[32:35]
ds_read_b64_tr_b16 a[108:109], v13 offset:8448
v_mfma_f32_16x16x32_bf16 v[40:43], a[80:83], a[8:11], v[40:43]
ds_read_b64_tr_b16 a[110:111], v13 offset:9472
v_mfma_f32_16x16x32_bf16 v[40:43], a[84:87], a[24:27], v[40:43]
ds_read_b128 a[32:35], v8 offset:32768
v_mfma_f32_16x16x32_bf16 v[48:51], a[84:87], a[28:31], v[48:51]
ds_read_b128 a[48:51], v9 offset:32768
v_mfma_f32_16x16x32_bf16 v[48:51], a[80:83], a[12:15], v[48:51]
ds_read_b128 a[36:39], v8 offset:34816
s_add_u32 m0, s18, 0x4000
v_mfma_f32_16x16x32_bf16 v[52:55], a[88:91], a[12:15], v[52:55]
buffer_load_dwordx4 v7, s[68:71], 0 offen lds
v_mfma_f32_16x16x32_bf16 v[52:55], a[92:95], a[28:31], v[52:55]
ds_read_b64_tr_b16 a[80:81], v12 offset:512
v_mfma_f32_16x16x32_bf16 v[44:47], a[92:95], a[24:27], v[44:47]
ds_read_b64_tr_b16 a[82:83], v12 offset:1536
v_mfma_f32_16x16x32_bf16 v[44:47], a[88:91], a[8:11], v[44:47]
ds_read_b64_tr_b16 a[84:85], v12 offset:8704
v_mfma_f32_16x16x32_bf16 v[36:39], a[88:91], a[4:7], v[36:39]
ds_read_b64_tr_b16 a[86:87], v12 offset:9728
v_mfma_f32_16x16x32_bf16 v[36:39], a[92:95], a[20:23], v[36:39]
ds_read_b128 a[52:55], v9 offset:34816
s_add_u32 m0, s18, 0x5000
v_mfma_f32_16x16x32_bf16 v[28:31], a[92:95], a[16:19], v[28:31]
buffer_load_dwordx4 v7, s[68:71], s25 offen lds
v_mfma_f32_16x16x32_bf16 v[28:31], a[88:91], a[0:3], v[28:31]
ds_read_b128 a[40:43], v8 offset:36864
s_waitcnt lgkmcnt(9)
v_mfma_f32_16x16x32_bf16 v[56:59], a[96:99], a[0:3], v[56:59]
ds_read_b64_tr_b16 a[88:89], v13 offset:512
v_mfma_f32_16x16x32_bf16 v[56:59], a[100:103], a[16:19], v[56:59]
ds_read_b64_tr_b16 a[90:91], v13 offset:1536
v_mfma_f32_16x16x32_bf16 v[64:67], a[100:103], a[20:23], v[64:67]
ds_read_b64_tr_b16 a[92:93], v13 offset:8704
v_mfma_f32_16x16x32_bf16 v[64:67], a[96:99], a[4:7], v[64:67]
ds_read_b64_tr_b16 a[94:95], v13 offset:9728
s_add_u32 m0, s18, 0x6000
v_mfma_f32_16x16x32_bf16 v[72:75], a[96:99], a[8:11], v[72:75]
buffer_load_dwordx4 v7, s[68:71], s26 offen lds
v_mfma_f32_16x16x32_bf16 v[72:75], a[100:103], a[24:27], v[72:75]
ds_read_b128 a[56:59], v9 offset:36864
v_lshl_add_u32 v5, s42, 19, v5
v_mfma_f32_16x16x32_bf16 v[80:83], a[100:103], a[28:31], v[80:83]
ds_read_b128 a[44:47], v8 offset:38912
v_lshl_add_u32 v6, s42, 19, v6
v_mfma_f32_16x16x32_bf16 v[80:83], a[96:99], a[12:15], v[80:83]
ds_read_b128 a[60:63], v9 offset:38912
v_lshl_add_u32 v7, s42, 18, v7
v_mfma_f32_16x16x32_bf16 v[84:87], a[104:107], a[12:15], v[84:87]
ds_read_b64_tr_b16 a[96:97], v12 offset:768
v_lshl_add_u32 v7, s42, 17, v7
v_mfma_f32_16x16x32_bf16 v[84:87], a[108:111], a[28:31], v[84:87]
ds_read_b64_tr_b16 a[98:99], v12 offset:1792
s_add_u32 s8, s28, 0x6400
v_mfma_f32_16x16x32_bf16 v[76:79], a[108:111], a[24:27], v[76:79]
buffer_store_dwordx4 a[152:155], v16, s[88:91], s8 offen sc1
v_mfma_f32_16x16x32_bf16 v[76:79], a[104:107], a[8:11], v[76:79]
ds_read_b64_tr_b16 a[100:101], v12 offset:8960
v_mfma_f32_16x16x32_bf16 v[68:71], a[104:107], a[4:7], v[68:71]
ds_read_b64_tr_b16 a[102:103], v12 offset:9984
v_mfma_f32_16x16x32_bf16 v[68:71], a[108:111], a[20:23], v[68:71]
v_mfma_f32_16x16x32_bf16 v[60:63], a[108:111], a[16:19], v[60:63]
v_mfma_f32_16x16x32_bf16 v[60:63], a[104:107], a[0:3], v[60:63]
s_add_u32 m0, s16, 0x8000
s_waitcnt lgkmcnt(4)
s_waitcnt lgkmcnt(7)
v_mfma_f32_16x16x32_bf16 v[88:91], a[80:83], a[0:3], v[88:91]
buffer_load_dwordx4 v22, s[44:47], s20 offen lds
v_mfma_f32_16x16x32_bf16 v[88:91], a[84:87], a[16:19], v[88:91]
ds_read_b64_tr_b16 a[104:105], v13 offset:768
v_mfma_f32_16x16x32_bf16 v[96:99], a[84:87], a[20:23], v[96:99]
ds_read_b64_tr_b16 a[106:107], v13 offset:1792
v_mfma_f32_16x16x32_bf16 v[96:99], a[80:83], a[4:7], v[96:99]
ds_read_b64_tr_b16 a[108:109], v13 offset:8960
v_mfma_f32_16x16x32_bf16 v[104:107], a[80:83], a[8:11], v[104:107]
ds_read_b64_tr_b16 a[110:111], v13 offset:9984
s_add_u32 m0, s16, 0x8400
v_mfma_f32_16x16x32_bf16 v[104:107], a[84:87], a[24:27], v[104:107]
buffer_load_dwordx4 v23, s[44:47], s20 offen lds
v_mfma_f32_16x16x32_bf16 v[112:115], a[84:87], a[28:31], v[112:115]
v_mfma_f32_16x16x32_bf16 v[112:115], a[80:83], a[12:15], v[112:115]
v_mfma_f32_16x16x32_bf16 v[116:119], a[88:91], a[12:15], v[116:119]
ds_read_b64_tr_b16 a[80:81], v14 offset:0
v_mfma_f32_16x16x32_bf16 v[116:119], a[92:95], a[28:31], v[116:119]
ds_read_b64_tr_b16 a[82:83], v14 offset:256
v_mfma_f32_16x16x32_bf16 v[108:111], a[92:95], a[24:27], v[108:111]
ds_read_b64_tr_b16 a[84:85], v14 offset:2048
s_add_u32 m0, s16, 0x8800
v_mfma_f32_16x16x32_bf16 v[108:111], a[88:91], a[8:11], v[108:111]
buffer_load_dwordx4 v22, s[44:47], s21 offen lds
v_mfma_f32_16x16x32_bf16 v[100:103], a[88:91], a[4:7], v[100:103]
ds_read_b64_tr_b16 a[86:87], v14 offset:2304
v_mfma_f32_16x16x32_bf16 v[100:103], a[92:95], a[20:23], v[100:103]
v_mfma_f32_16x16x32_bf16 v[92:95], a[92:95], a[16:19], v[92:95]
v_mfma_f32_16x16x32_bf16 v[92:95], a[88:91], a[0:3], v[92:95]
s_add_u32 m0, s16, 0x8c00
s_waitcnt lgkmcnt(4)
v_mfma_f32_16x16x32_bf16 v[120:123], a[96:99], a[0:3], v[120:123]
buffer_load_dwordx4 v23, s[44:47], s21 offen lds
v_mfma_f32_16x16x32_bf16 v[120:123], a[100:103], a[16:19], v[120:123]
ds_read_b64_tr_b16 a[88:89], v15 offset:0
v_mfma_f32_16x16x32_bf16 v[128:131], a[100:103], a[20:23], v[128:131]
ds_read_b64_tr_b16 a[90:91], v15 offset:256
v_mfma_f32_16x16x32_bf16 v[128:131], a[96:99], a[4:7], v[128:131]
ds_read_b64_tr_b16 a[92:93], v15 offset:2048
v_mfma_f32_16x16x32_bf16 v[136:139], a[96:99], a[8:11], v[136:139]
ds_read_b64_tr_b16 a[94:95], v15 offset:2304
v_mfma_f32_16x16x32_bf16 v[136:139], a[100:103], a[24:27], v[136:139]
s_add_u32 s8, s28, 0x7400
v_mfma_f32_16x16x32_bf16 v[144:147], a[100:103], a[28:31], v[144:147]
buffer_store_dwordx4 a[156:159], v16, s[88:91], s8 offen sc1
v_mfma_f32_16x16x32_bf16 v[144:147], a[96:99], a[12:15], v[144:147]
v_mfma_f32_16x16x32_bf16 v[148:151], a[104:107], a[12:15], v[148:151]
ds_read_b64_tr_b16 a[96:97], v14 offset:4096
v_mfma_f32_16x16x32_bf16 v[148:151], a[108:111], a[28:31], v[148:151]
ds_read_b64_tr_b16 a[98:99], v14 offset:4352
v_mfma_f32_16x16x32_bf16 v[140:143], a[108:111], a[24:27], v[140:143]
ds_read_b64_tr_b16 a[100:101], v14 offset:6144
v_mfma_f32_16x16x32_bf16 v[140:143], a[104:107], a[8:11], v[140:143]
ds_read_b64_tr_b16 a[102:103], v14 offset:6400
s_add_u32 m0, s16, 0x9000
v_mfma_f32_16x16x32_bf16 v[132:135], a[104:107], a[4:7], v[132:135]
buffer_load_dwordx4 v22, s[44:47], s22 offen lds
v_mfma_f32_16x16x32_bf16 v[132:135], a[108:111], a[20:23], v[132:135]
v_mfma_f32_16x16x32_bf16 v[124:127], a[108:111], a[16:19], v[124:127]
v_mfma_f32_16x16x32_bf16 v[124:127], a[104:107], a[0:3], v[124:127]
s_waitcnt lgkmcnt(4)
v_mfma_f32_16x16x32_bf16 v[152:155], a[80:83], a[0:3], v[152:155]
ds_read_b64_tr_b16 a[104:105], v15 offset:4096
s_add_u32 m0, s16, 0x9400
v_mfma_f32_16x16x32_bf16 v[152:155], a[84:87], a[16:19], v[152:155]
buffer_load_dwordx4 v23, s[44:47], s22 offen lds
v_mfma_f32_16x16x32_bf16 v[160:163], a[84:87], a[20:23], v[160:163]
ds_read_b64_tr_b16 a[106:107], v15 offset:4352
v_mfma_f32_16x16x32_bf16 v[160:163], a[80:83], a[4:7], v[160:163]
ds_read_b64_tr_b16 a[108:109], v15 offset:6144
v_mfma_f32_16x16x32_bf16 v[168:171], a[80:83], a[8:11], v[168:171]
ds_read_b64_tr_b16 a[110:111], v15 offset:6400
v_mfma_f32_16x16x32_bf16 v[168:171], a[84:87], a[24:27], v[168:171]
v_mfma_f32_16x16x32_bf16 v[176:179], a[84:87], a[28:31], v[176:179]
s_add_u32 m0, s16, 0x9800
v_mfma_f32_16x16x32_bf16 v[176:179], a[80:83], a[12:15], v[176:179]
buffer_load_dwordx4 v22, s[44:47], s23 offen lds
v_mfma_f32_16x16x32_bf16 v[180:183], a[88:91], a[12:15], v[180:183]
ds_read_b64_tr_b16 a[80:81], v14 offset:8192
v_mfma_f32_16x16x32_bf16 v[180:183], a[92:95], a[28:31], v[180:183]
ds_read_b64_tr_b16 a[82:83], v14 offset:8448
v_mfma_f32_16x16x32_bf16 v[172:175], a[92:95], a[24:27], v[172:175]
ds_read_b64_tr_b16 a[84:85], v14 offset:10240
v_mfma_f32_16x16x32_bf16 v[172:175], a[88:91], a[8:11], v[172:175]
ds_read_b64_tr_b16 a[86:87], v14 offset:10496
s_add_u32 m0, s16, 0x9c00
v_mfma_f32_16x16x32_bf16 v[164:167], a[88:91], a[4:7], v[164:167]
buffer_load_dwordx4 v23, s[44:47], s23 offen lds
v_mfma_f32_16x16x32_bf16 v[164:167], a[92:95], a[20:23], v[164:167]
v_lshl_add_u32 v22, s42, 7, v22
v_lshl_add_u32 v23, s42, 7, v23
v_mfma_f32_16x16x32_bf16 v[156:159], a[92:95], a[16:19], v[156:159]
v_mfma_f32_16x16x32_bf16 v[156:159], a[88:91], a[0:3], v[156:159]
s_waitcnt lgkmcnt(4)
v_mfma_f32_16x16x32_bf16 v[184:187], a[96:99], a[0:3], v[184:187]
ds_read_b64_tr_b16 a[88:89], v15 offset:8192
v_mfma_f32_16x16x32_bf16 v[184:187], a[100:103], a[16:19], v[184:187]
ds_read_b64_tr_b16 a[90:91], v15 offset:8448
s_add_u32 s8, s28, 0x2800
v_mfma_f32_16x16x32_bf16 v[192:195], a[100:103], a[20:23], v[192:195]
buffer_store_dwordx4 a[160:163], v16, s[88:91], s8 offen sc1
v_mfma_f32_16x16x32_bf16 v[192:195], a[96:99], a[4:7], v[192:195]
ds_read_b64_tr_b16 a[92:93], v15 offset:10240
v_mfma_f32_16x16x32_bf16 v[200:203], a[96:99], a[8:11], v[200:203]
ds_read_b64_tr_b16 a[94:95], v15 offset:10496
v_add_u32 v12, 0x8000, v12
v_mfma_f32_16x16x32_bf16 v[200:203], a[100:103], a[24:27], v[200:203]
v_add_u32 v13, 0x8000, v13
v_add_u32 v14, 0x8000, v14
v_mfma_f32_16x16x32_bf16 v[208:211], a[100:103], a[28:31], v[208:211]
v_add_u32 v15, 0x8000, v15
v_mfma_f32_16x16x32_bf16 v[208:211], a[96:99], a[12:15], v[208:211]
v_mfma_f32_16x16x32_bf16 v[212:215], a[104:107], a[12:15], v[212:215]
s_waitcnt vmcnt(29) lgkmcnt(0)
v_mfma_f32_16x16x32_bf16 v[212:215], a[108:111], a[28:31], v[212:215]
s_barrier
s_add_u32 m0, s17, 0x8000
v_mfma_f32_16x16x32_bf16 v[204:207], a[108:111], a[24:27], v[204:207]
buffer_load_dwordx4 v5, s[52:55], 0 offen lds
v_mfma_f32_16x16x32_bf16 v[204:207], a[104:107], a[8:11], v[204:207]
ds_read_b64_tr_b16 a[96:97], v12 offset:0
v_mfma_f32_16x16x32_bf16 v[196:199], a[104:107], a[4:7], v[196:199]
ds_read_b64_tr_b16 a[98:99], v12 offset:1024
v_mfma_f32_16x16x32_bf16 v[196:199], a[108:111], a[20:23], v[196:199]
ds_read_b64_tr_b16 a[100:101], v12 offset:8192
v_mfma_f32_16x16x32_bf16 v[188:191], a[108:111], a[16:19], v[188:191]
ds_read_b64_tr_b16 a[102:103], v12 offset:9216
v_mfma_f32_16x16x32_bf16 v[188:191], a[104:107], a[0:3], v[188:191]
s_add_u32 m0, s17, 0x8400
s_waitcnt lgkmcnt(4)
v_mfma_f32_16x16x32_bf16 v[216:219], a[0:3], a[80:83], v[216:219]
buffer_load_dwordx4 v5, s[52:55], s13 offen lds
v_mfma_f32_16x16x32_bf16 v[216:219], a[16:19], a[84:87], v[216:219]
ds_read_b64_tr_b16 a[104:105], v13 offset:0
v_mfma_f32_16x16x32_bf16 v[224:227], a[20:23], a[84:87], v[224:227]
ds_read_b64_tr_b16 a[106:107], v13 offset:1024
v_mfma_f32_16x16x32_bf16 v[224:227], a[4:7], a[80:83], v[224:227]
ds_read_b64_tr_b16 a[108:109], v13 offset:8192
v_mfma_f32_16x16x32_bf16 v[232:235], a[8:11], a[80:83], v[232:235]
ds_read_b64_tr_b16 a[110:111], v13 offset:9216
v_mfma_f32_16x16x32_bf16 v[232:235], a[24:27], a[84:87], v[232:235]
v_mfma_f32_16x16x32_bf16 v[240:243], a[28:31], a[84:87], v[240:243]
s_add_u32 m0, s17, 0x8800
v_mfma_f32_16x16x32_bf16 v[240:243], a[12:15], a[80:83], v[240:243]
buffer_load_dwordx4 v6, s[52:55], 0 offen lds
v_mfma_f32_16x16x32_bf16 v[244:247], a[12:15], a[88:91], v[244:247]
ds_read_b64_tr_b16 a[80:81], v12 offset:256
v_mfma_f32_16x16x32_bf16 v[244:247], a[28:31], a[92:95], v[244:247]
ds_read_b64_tr_b16 a[82:83], v12 offset:1280
v_mfma_f32_16x16x32_bf16 v[236:239], a[24:27], a[92:95], v[236:239]
ds_read_b64_tr_b16 a[84:85], v12 offset:8448
v_mfma_f32_16x16x32_bf16 v[236:239], a[8:11], a[88:91], v[236:239]
ds_read_b64_tr_b16 a[86:87], v12 offset:9472
v_mfma_f32_16x16x32_bf16 v[228:231], a[4:7], a[88:91], v[228:231]
v_mfma_f32_16x16x32_bf16 v[228:231], a[20:23], a[92:95], v[228:231]
s_add_u32 m0, s17, 0x8c00
v_mfma_f32_16x16x32_bf16 v[220:223], a[16:19], a[92:95], v[220:223]
buffer_load_dwordx4 v6, s[52:55], s13 offen lds
v_mfma_f32_16x16x32_bf16 v[220:223], a[0:3], a[88:91], v[220:223]
s_waitcnt lgkmcnt(4)
L_S11:
v_mfma_f32_16x16x32_bf16 v[24:27], a[96:99], a[32:35], v[24:27]
ds_read_b64_tr_b16 a[88:89], v13 offset:256
s_waitcnt vmcnt(24)
v_mfma_f32_16x16x32_bf16 v[24:27], a[100:103], a[48:51], v[24:27]
ds_read_b64_tr_b16 a[90:91], v13 offset:1280
v_mfma_f32_16x16x32_bf16 v[32:35], a[100:103], a[52:55], v[32:35]
ds_read_b64_tr_b16 a[92:93], v13 offset:8448
v_mfma_f32_16x16x32_bf16 v[32:35], a[96:99], a[36:39], v[32:35]
ds_read_b64_tr_b16 a[94:95], v13 offset:9472
v_mfma_f32_16x16x32_bf16 v[40:43], a[96:99], a[40:43], v[40:43]
ds_read_b128 a[0:3], v8 offset:0
s_add_u32 m0, s18, 0xc000
v_mfma_f32_16x16x32_bf16 v[40:43], a[100:103], a[56:59], v[40:43]
buffer_load_dwordx4 v7, s[68:71], 0 offen lds
v_mfma_f32_16x16x32_bf16 v[48:51], a[100:103], a[60:63], v[48:51]
ds_read_b128 a[16:19], v9 offset:0
v_mfma_f32_16x16x32_bf16 v[48:51], a[96:99], a[44:47], v[48:51]
ds_read_b128 a[4:7], v8 offset:2048
v_mfma_f32_16x16x32_bf16 v[52:55], a[104:107], a[44:47], v[52:55]
ds_read_b64_tr_b16 a[96:97], v12 offset:512
v_mfma_f32_16x16x32_bf16 v[52:55], a[108:111], a[60:63], v[52:55]
ds_read_b64_tr_b16 a[98:99], v12 offset:1536
v_mfma_f32_16x16x32_bf16 v[44:47], a[108:111], a[56:59], v[44:47]
ds_read_b64_tr_b16 a[100:101], v12 offset:8704
s_add_u32 s8, s28, 0x3800
v_mfma_f32_16x16x32_bf16 v[44:47], a[104:107], a[40:43], v[44:47]
buffer_store_dwordx4 a[164:167], v16, s[88:91], s8 offen sc1
v_mfma_f32_16x16x32_bf16 v[36:39], a[104:107], a[36:39], v[36:39]
ds_read_b64_tr_b16 a[102:103], v12 offset:9728
v_mfma_f32_16x16x32_bf16 v[36:39], a[108:111], a[52:55], v[36:39]
ds_read_b128 a[20:23], v9 offset:2048
v_mfma_f32_16x16x32_bf16 v[28:31], a[108:111], a[48:51], v[28:31]
ds_read_b128 a[8:11], v8 offset:4096
v_mfma_f32_16x16x32_bf16 v[28:31], a[104:107], a[32:35], v[28:31]
ds_read_b128 a[24:27], v9 offset:4096
s_waitcnt lgkmcnt(10)
v_mfma_f32_16x16x32_bf16 v[56:59], a[80:83], a[32:35], v[56:59]
ds_read_b64_tr_b16 a[104:105], v13 offset:512
v_mfma_f32_16x16x32_bf16 v[56:59], a[84:87], a[48:51], v[56:59]
ds_read_b64_tr_b16 a[106:107], v13 offset:1536
s_add_u32 m0, s18, 0xd000
v_mfma_f32_16x16x32_bf16 v[64:67], a[84:87], a[52:55], v[64:67]
buffer_load_dwordx4 v7, s[68:71], s25 offen lds
v_mfma_f32_16x16x32_bf16 v[64:67], a[80:83], a[36:39], v[64:67]
ds_read_b64_tr_b16 a[108:109], v13 offset:8704
v_mfma_f32_16x16x32_bf16 v[72:75], a[80:83], a[40:43], v[72:75]
ds_read_b64_tr_b16 a[110:111], v13 offset:9728
v_mfma_f32_16x16x32_bf16 v[72:75], a[84:87], a[56:59], v[72:75]
ds_read_b128 a[12:15], v8 offset:6144
v_mfma_f32_16x16x32_bf16 v[80:83], a[84:87], a[60:63], v[80:83]
ds_read_b128 a[28:31], v9 offset:6144
v_mfma_f32_16x16x32_bf16 v[80:83], a[80:83], a[44:47], v[80:83]
v_mfma_f32_16x16x32_bf16 v[84:87], a[88:91], a[44:47], v[84:87]
ds_read_b64_tr_b16 a[80:81], v12 offset:768
s_add_u32 m0, s18, 0xe000
v_mfma_f32_16x16x32_bf16 v[84:87], a[92:95], a[60:63], v[84:87]
buffer_load_dwordx4 v7, s[68:71], s26 offen lds
v_mfma_f32_16x16x32_bf16 v[76:79], a[92:95], a[56:59], v[76:79]
ds_read_b64_tr_b16 a[82:83], v12 offset:1792
v_lshl_add_u32 v5, s42, 19, v5
v_mfma_f32_16x16x32_bf16 v[76:79], a[88:91], a[40:43], v[76:79]
ds_read_b64_tr_b16 a[84:85], v12 offset:8960
v_lshl_add_u32 v6, s42, 19, v6
v_mfma_f32_16x16x32_bf16 v[68:71], a[88:91], a[36:39], v[68:71]
ds_read_b64_tr_b16 a[86:87], v12 offset:9984
v_lshl_add_u32 v7, s42, 18, v7
v_mfma_f32_16x16x32_bf16 v[68:71], a[92:95], a[52:55], v[68:71]
L_padA6:
s_cmp_eq_u32 s95, 1
s_cbranch_scc1 L_padA10
v_lshl_add_u32 v7, s42, 17, v7
v_mfma_f32_16x16x32_bf16 v[60:63], a[92:95], a[48:51], v[60:63]
v_mfma_f32_16x16x32_bf16 v[60:63], a[88:91], a[32:35], v[60:63]
s_add_u32 m0, s16, 0x0
s_waitcnt lgkmcnt(4)
s_waitcnt lgkmcnt(6)
v_mfma_f32_16x16x32_bf16 v[88:91], a[96:99], a[32:35], v[88:91]
buffer_load_dwordx4 v22, s[44:47], s20 offen lds
v_mfma_f32_16x16x32_bf16 v[88:91], a[100:103], a[48:51], v[88:91]
ds_read_b64_tr_b16 a[88:89], v13 offset:768
v_mfma_f32_16x16x32_bf16 v[96:99], a[100:103], a[52:55], v[96:99]
ds_read_b64_tr_b16 a[90:91], v13 offset:1792
v_mfma_f32_16x16x32_bf16 v[96:99], a[96:99], a[36:39], v[96:99]
ds_read_b64_tr_b16 a[92:93], v13 offset:8960
v_mfma_f32_16x16x32_bf16 v[104:107], a[96:99], a[40:43], v[104:107]
ds_read_b64_tr_b16 a[94:95], v13 offset:9984
s_add_u32 m0, s16, 0x400
v_mfma_f32_16x16x32_bf16 v[104:107], a[100:103], a[56:59], v[104:107]
buffer_load_dwordx4 v23, s[44:47], s20 offen lds
v_mfma_f32_16x16x32_bf16 v[112:115], a[100:103], a[60:63], v[112:115]
v_mfma_f32_16x16x32_bf16 v[112:115], a[96:99], a[44:47], v[112:115]
v_mfma_f32_16x16x32_bf16 v[116:119], a[104:107], a[44:47], v[116:119]
ds_read_b64_tr_b16 a[96:97], v14 offset:0
v_mfma_f32_16x16x32_bf16 v[116:119], a[108:111], a[60:63], v[116:119]
ds_read_b64_tr_b16 a[98:99], v14 offset:256
v_mfma_f32_16x16x32_bf16 v[108:111], a[108:111], a[56:59], v[108:111]
ds_read_b64_tr_b16 a[100:101], v14 offset:2048
s_add_u32 m0, s16, 0x800
v_mfma_f32_16x16x32_bf16 v[108:111], a[104:107], a[40:43], v[108:111]
buffer_load_dwordx4 v22, s[44:47], s21 offen lds
v_mfma_f32_16x16x32_bf16 v[100:103], a[104:107], a[36:39], v[100:103]
ds_read_b64_tr_b16 a[102:103], v14 offset:2304
v_mfma_f32_16x16x32_bf16 v[100:103], a[108:111], a[52:55], v[100:103]
v_mfma_f32_16x16x32_bf16 v[92:95], a[108:111], a[48:51], v[92:95]
v_mfma_f32_16x16x32_bf16 v[92:95], a[104:107], a[32:35], v[92:95]
s_add_u32 s8, s28, 0x6800
s_waitcnt lgkmcnt(4)
v_mfma_f32_16x16x32_bf16 v[120:123], a[80:83], a[32:35], v[120:123]
buffer_store_dwordx4 a[168:171], v16, s[88:91], s8 offen sc1
v_mfma_f32_16x16x32_bf16 v[120:123], a[84:87], a[48:51], v[120:123]
ds_read_b64_tr_b16 a[104:105], v15 offset:0
v_mfma_f32_16x16x32_bf16 v[128:131], a[84:87], a[52:55], v[128:131]
ds_read_b64_tr_b16 a[106:107], v15 offset:256
v_mfma_f32_16x16x32_bf16 v[128:131], a[80:83], a[36:39], v[128:131]
ds_read_b64_tr_b16 a[108:109], v15 offset:2048
v_mfma_f32_16x16x32_bf16 v[136:139], a[80:83], a[40:43], v[136:139]
ds_read_b64_tr_b16 a[110:111], v15 offset:2304
v_mfma_f32_16x16x32_bf16 v[136:139], a[84:87], a[56:59], v[136:139]
s_add_u32 m0, s16, 0xc00
v_mfma_f32_16x16x32_bf16 v[144:147], a[84:87], a[60:63], v[144:147]
buffer_load_dwordx4 v23, s[44:47], s21 offen lds
v_mfma_f32_16x16x32_bf16 v[144:147], a[80:83], a[44:47], v[144:147]
v_mfma_f32_16x16x32_bf16 v[148:151], a[88:91], a[44:47], v[148:151]
ds_read_b64_tr_b16 a[80:81], v14 offset:4096
v_mfma_f32_16x16x32_bf16 v[148:151], a[92:95], a[60:63], v[148:151]
ds_read_b64_tr_b16 a[82:83], v14 offset:4352
v_mfma_f32_16x16x32_bf16 v[140:143], a[92:95], a[56:59], v[140:143]
ds_read_b64_tr_b16 a[84:85], v14 offset:6144
v_mfma_f32_16x16x32_bf16 v[140:143], a[88:91], a[40:43], v[140:143]
ds_read_b64_tr_b16 a[86:87], v14 offset:6400
s_add_u32 m0, s16, 0x1000
v_mfma_f32_16x16x32_bf16 v[132:135], a[88:91], a[36:39], v[132:135]
buffer_load_dwordx4 v22, s[44:47], s22 offen lds
v_mfma_f32_16x16x32_bf16 v[132:135], a[92:95], a[52:55], v[132:135]
v_mfma_f32_16x16x32_bf16 v[124:127], a[92:95], a[48:51], v[124:127]
v_mfma_f32_16x16x32_bf16 v[124:127], a[88:91], a[32:35], v[124:127]
s_waitcnt lgkmcnt(4)
v_mfma_f32_16x16x32_bf16 v[152:155], a[96:99], a[32:35], v[152:155]
ds_read_b64_tr_b16 a[88:89], v15 offset:4096
s_add_u32 m0, s16, 0x1400
v_mfma_f32_16x16x32_bf16 v[152:155], a[100:103], a[48:51], v[152:155]
buffer_load_dwordx4 v23, s[44:47], s22 offen lds
v_mfma_f32_16x16x32_bf16 v[160:163], a[100:103], a[52:55], v[160:163]
ds_read_b64_tr_b16 a[90:91], v15 offset:4352
v_mfma_f32_16x16x32_bf16 v[160:163], a[96:99], a[36:39], v[160:163]
ds_read_b64_tr_b16 a[92:93], v15 offset:6144
v_mfma_f32_16x16x32_bf16 v[168:171], a[96:99], a[40:43], v[168:171]
ds_read_b64_tr_b16 a[94:95], v15 offset:6400
v_mfma_f32_16x16x32_bf16 v[168:171], a[100:103], a[56:59], v[168:171]
v_mfma_f32_16x16x32_bf16 v[176:179], a[100:103], a[60:63], v[176:179]
s_add_u32 m0, s16, 0x1800
v_mfma_f32_16x16x32_bf16 v[176:179], a[96:99], a[44:47], v[176:179]
buffer_load_dwordx4 v22, s[44:47], s23 offen lds
v_mfma_f32_16x16x32_bf16 v[180:183], a[104:107], a[44:47], v[180:183]
ds_read_b64_tr_b16 a[96:97], v14 offset:8192
v_mfma_f32_16x16x32_bf16 v[180:183], a[108:111], a[60:63], v[180:183]
ds_read_b64_tr_b16 a[98:99], v14 offset:8448
v_mfma_f32_16x16x32_bf16 v[172:175], a[108:111], a[56:59], v[172:175]
ds_read_b64_tr_b16 a[100:101], v14 offset:10240
v_mfma_f32_16x16x32_bf16 v[172:175], a[104:107], a[40:43], v[172:175]
ds_read_b64_tr_b16 a[102:103], v14 offset:10496
s_add_u32 m0, s16, 0x1c00
v_mfma_f32_16x16x32_bf16 v[164:167], a[104:107], a[36:39], v[164:167]
buffer_load_dwordx4 v23, s[44:47], s23 offen lds
v_mfma_f32_16x16x32_bf16 v[164:167], a[108:111], a[52:55], v[164:167]
v_lshl_add_u32 v22, s42, 7, v22
v_lshl_add_u32 v23, s42, 7, v23
v_mfma_f32_16x16x32_bf16 v[156:159], a[108:111], a[48:51], v[156:159]
v_mfma_f32_16x16x32_bf16 v[156:159], a[104:107], a[32:35], v[156:159]
s_waitcnt lgkmcnt(4)
v_mfma_f32_16x16x32_bf16 v[184:187], a[80:83], a[32:35], v[184:187]
ds_read_b64_tr_b16 a[104:105], v15 offset:8192
v_mfma_f32_16x16x32_bf16 v[184:187], a[84:87], a[48:51], v[184:187]
ds_read_b64_tr_b16 a[106:107], v15 offset:8448
s_add_u32 s8, s28, 0x7800
v_mfma_f32_16x16x32_bf16 v[192:195], a[84:87], a[52:55], v[192:195]
buffer_store_dwordx4 a[172:175], v16, s[88:91], s8 offen sc1
v_mfma_f32_16x16x32_bf16 v[192:195], a[80:83], a[36:39], v[192:195]
ds_read_b64_tr_b16 a[108:109], v15 offset:10240
v_mfma_f32_16x16x32_bf16 v[200:203], a[80:83], a[40:43], v[200:203]
ds_read_b64_tr_b16 a[110:111], v15 offset:10496
v_add_u32 v12, 0xffff0000, v12
v_mfma_f32_16x16x32_bf16 v[200:203], a[84:87], a[56:59], v[200:203]
v_add_u32 v13, 0xffff0000, v13
v_add_u32 v14, 0xffff0000, v14
v_mfma_f32_16x16x32_bf16 v[208:211], a[84:87], a[60:63], v[208:211]
v_add_u32 v15, 0xffff0000, v15
v_mfma_f32_16x16x32_bf16 v[208:211], a[80:83], a[44:47], v[208:211]
v_mfma_f32_16x16x32_bf16 v[212:215], a[88:91], a[44:47], v[212:215]
s_waitcnt vmcnt(29) lgkmcnt(0)
v_mfma_f32_16x16x32_bf16 v[212:215], a[92:95], a[60:63], v[212:215]
s_barrier
s_add_u32 m0, s17, 0x10000
v_mfma_f32_16x16x32_bf16 v[204:207], a[92:95], a[56:59], v[204:207]
buffer_load_dwordx4 v5, s[52:55], 0 offen lds
v_mfma_f32_16x16x32_bf16 v[204:207], a[88:91], a[40:43], v[204:207]
ds_read_b64_tr_b16 a[80:81], v12 offset:0
v_mfma_f32_16x16x32_bf16 v[196:199], a[88:91], a[36:39], v[196:199]
ds_read_b64_tr_b16 a[82:83], v12 offset:1024
v_mfma_f32_16x16x32_bf16 v[196:199], a[92:95], a[52:55], v[196:199]
ds_read_b64_tr_b16 a[84:85], v12 offset:8192
v_mfma_f32_16x16x32_bf16 v[188:191], a[92:95], a[48:51], v[188:191]
ds_read_b64_tr_b16 a[86:87], v12 offset:9216
v_mfma_f32_16x16x32_bf16 v[188:191], a[88:91], a[32:35], v[188:191]
s_add_u32 m0, s17, 0x10400
s_waitcnt lgkmcnt(4)
v_mfma_f32_16x16x32_bf16 v[216:219], a[32:35], a[96:99], v[216:219]
buffer_load_dwordx4 v5, s[52:55], s13 offen lds
v_mfma_f32_16x16x32_bf16 v[216:219], a[48:51], a[100:103], v[216:219]
ds_read_b64_tr_b16 a[88:89], v13 offset:0
v_mfma_f32_16x16x32_bf16 v[224:227], a[52:55], a[100:103], v[224:227]
ds_read_b64_tr_b16 a[90:91], v13 offset:1024
v_mfma_f32_16x16x32_bf16 v[224:227], a[36:39], a[96:99], v[224:227]
ds_read_b64_tr_b16 a[92:93], v13 offset:8192
v_mfma_f32_16x16x32_bf16 v[232:235], a[40:43], a[96:99], v[232:235]
ds_read_b64_tr_b16 a[94:95], v13 offset:9216
v_mfma_f32_16x16x32_bf16 v[232:235], a[56:59], a[100:103], v[232:235]
s_add_u32 m0, s17, 0x10800
v_mfma_f32_16x16x32_bf16 v[240:243], a[60:63], a[100:103], v[240:243]
buffer_load_dwordx4 v6, s[52:55], 0 offen lds
v_mfma_f32_16x16x32_bf16 v[240:243], a[44:47], a[96:99], v[240:243]
v_mfma_f32_16x16x32_bf16 v[244:247], a[44:47], a[104:107], v[244:247]
ds_read_b64_tr_b16 a[96:97], v12 offset:256
v_mfma_f32_16x16x32_bf16 v[244:247], a[60:63], a[108:111], v[244:247]
ds_read_b64_tr_b16 a[98:99], v12 offset:1280
v_mfma_f32_16x16x32_bf16 v[236:239], a[56:59], a[108:111], v[236:239]
ds_read_b64_tr_b16 a[100:101], v12 offset:8448
v_mfma_f32_16x16x32_bf16 v[236:239], a[40:43], a[104:107], v[236:239]
ds_read_b64_tr_b16 a[102:103], v12 offset:9472
s_add_u32 s8, s28, 0x2c00
v_mfma_f32_16x16x32_bf16 v[228:231], a[36:39], a[104:107], v[228:231]
buffer_store_dwordx4 a[176:179], v16, s[88:91], s8 offen sc1
v_mfma_f32_16x16x32_bf16 v[228:231], a[52:55], a[108:111], v[228:231]
v_mfma_f32_16x16x32_bf16 v[220:223], a[48:51], a[108:111], v[220:223]
v_mfma_f32_16x16x32_bf16 v[220:223], a[32:35], a[104:107], v[220:223]
s_waitcnt lgkmcnt(4)
L_S12:
v_mfma_f32_16x16x32_bf16 v[24:27], a[80:83], a[0:3], v[24:27]
ds_read_b64_tr_b16 a[104:105], v13 offset:256
s_waitcnt vmcnt(23)
v_mfma_f32_16x16x32_bf16 v[24:27], a[84:87], a[16:19], v[24:27]
ds_read_b64_tr_b16 a[106:107], v13 offset:1280
s_add_u32 m0, s17, 0x10c00
v_mfma_f32_16x16x32_bf16 v[32:35], a[84:87], a[20:23], v[32:35]
buffer_load_dwordx4 v6, s[52:55], s13 offen lds
v_mfma_f32_16x16x32_bf16 v[32:35], a[80:83], a[4:7], v[32:35]
ds_read_b64_tr_b16 a[108:109], v13 offset:8448
v_mfma_f32_16x16x32_bf16 v[40:43], a[80:83], a[8:11], v[40:43]
ds_read_b64_tr_b16 a[110:111], v13 offset:9472
v_mfma_f32_16x16x32_bf16 v[40:43], a[84:87], a[24:27], v[40:43]
ds_read_b128 a[32:35], v8 offset:32768
v_mfma_f32_16x16x32_bf16 v[48:51], a[84:87], a[28:31], v[48:51]
ds_read_b128 a[48:51], v9 offset:32768
v_mfma_f32_16x16x32_bf16 v[48:51], a[80:83], a[12:15], v[48:51]
ds_read_b128 a[36:39], v8 offset:34816
s_add_u32 m0, s18, 0x14000
v_mfma_f32_16x16x32_bf16 v[52:55], a[88:91], a[12:15], v[52:55]
buffer_load_dwordx4 v7, s[68:71], 0 offen lds
v_mfma_f32_16x16x32_bf16 v[52:55], a[92:95], a[28:31], v[52:55]
ds_read_b64_tr_b16 a[80:81], v12 offset:512
v_mfma_f32_16x16x32_bf16 v[44:47], a[92:95], a[24:27], v[44:47]
ds_read_b64_tr_b16 a[82:83], v12 offset:1536
v_mfma_f32_16x16x32_bf16 v[44:47], a[88:91], a[8:11], v[44:47]
ds_read_b64_tr_b16 a[84:85], v12 offset:8704
v_mfma_f32_16x16x32_bf16 v[36:39], a[88:91], a[4:7], v[36:39]
ds_read_b64_tr_b16 a[86:87], v12 offset:9728
v_mfma_f32_16x16x32_bf16 v[36:39], a[92:95], a[20:23], v[36:39]
ds_read_b128 a[52:55], v9 offset:34816
s_add_u32 m0, s18, 0x15000
v_mfma_f32_16x16x32_bf16 v[28:31], a[92:95], a[16:19], v[28:31]
buffer_load_dwordx4 v7, s[68:71], s25 offen lds
v_mfma_f32_16x16x32_bf16 v[28:31], a[88:91], a[0:3], v[28:31]
ds_read_b128 a[40:43], v8 offset:36864
s_waitcnt lgkmcnt(9)
v_mfma_f32_16x16x32_bf16 v[56:59], a[96:99], a[0:3], v[56:59]
ds_read_b64_tr_b16 a[88:89], v13 offset:512
v_mfma_f32_16x16x32_bf16 v[56:59], a[100:103], a[16:19], v[56:59]
ds_read_b64_tr_b16 a[90:91], v13 offset:1536
v_mfma_f32_16x16x32_bf16 v[64:67], a[100:103], a[20:23], v[64:67]
ds_read_b64_tr_b16 a[92:93], v13 offset:8704
v_mfma_f32_16x16x32_bf16 v[64:67], a[96:99], a[4:7], v[64:67]
ds_read_b64_tr_b16 a[94:95], v13 offset:9728
s_add_u32 m0, s18, 0x16000
v_mfma_f32_16x16x32_bf16 v[72:75], a[96:99], a[8:11], v[72:75]
buffer_load_dwordx4 v7, s[68:71], s26 offen lds
v_mfma_f32_16x16x32_bf16 v[72:75], a[100:103], a[24:27], v[72:75]
ds_read_b128 a[56:59], v9 offset:36864
v_lshl_add_u32 v5, s42, 19, v5
v_mfma_f32_16x16x32_bf16 v[80:83], a[100:103], a[28:31], v[80:83]
ds_read_b128 a[44:47], v8 offset:38912
v_lshl_add_u32 v6, s42, 19, v6
v_mfma_f32_16x16x32_bf16 v[80:83], a[96:99], a[12:15], v[80:83]
ds_read_b128 a[60:63], v9 offset:38912
v_lshl_add_u32 v7, s42, 18, v7
v_mfma_f32_16x16x32_bf16 v[84:87], a[104:107], a[12:15], v[84:87]
ds_read_b64_tr_b16 a[96:97], v12 offset:768
v_lshl_add_u32 v7, s42, 17, v7
v_mfma_f32_16x16x32_bf16 v[84:87], a[108:111], a[28:31], v[84:87]
ds_read_b64_tr_b16 a[98:99], v12 offset:1792
s_add_u32 s8, s28, 0x3c00
v_mfma_f32_16x16x32_bf16 v[76:79], a[108:111], a[24:27], v[76:79]
buffer_store_dwordx4 a[180:183], v16, s[88:91], s8 offen sc1
v_mfma_f32_16x16x32_bf16 v[76:79], a[104:107], a[8:11], v[76:79]
ds_read_b64_tr_b16 a[100:101], v12 offset:8960
v_mfma_f32_16x16x32_bf16 v[68:71], a[104:107], a[4:7], v[68:71]
ds_read_b64_tr_b16 a[102:103], v12 offset:9984
v_mfma_f32_16x16x32_bf16 v[68:71], a[108:111], a[20:23], v[68:71]
v_mfma_f32_16x16x32_bf16 v[60:63], a[108:111], a[16:19], v[60:63]
v_mfma_f32_16x16x32_bf16 v[60:63], a[104:107], a[0:3], v[60:63]
s_add_u32 m0, s16, 0x8000
s_waitcnt lgkmcnt(4)
s_waitcnt lgkmcnt(7)
v_mfma_f32_16x16x32_bf16 v[88:91], a[80:83], a[0:3], v[88:91]
buffer_load_dwordx4 v22, s[44:47], s20 offen lds
v_mfma_f32_16x16x32_bf16 v[88:91], a[84:87], a[16:19], v[88:91]
ds_read_b64_tr_b16 a[104:105], v13 offset:768
v_mfma_f32_16x16x32_bf16 v[96:99], a[84:87], a[20:23], v[96:99]
ds_read_b64_tr_b16 a[106:107], v13 offset:1792
v_mfma_f32_16x16x32_bf16 v[96:99], a[80:83], a[4:7], v[96:99]
ds_read_b64_tr_b16 a[108:109], v13 offset:8960
v_mfma_f32_16x16x32_bf16 v[104:107], a[80:83], a[8:11], v[104:107]
ds_read_b64_tr_b16 a[110:111], v13 offset:9984
s_add_u32 m0, s16, 0x8400
v_mfma_f32_16x16x32_bf16 v[104:107], a[84:87], a[24:27], v[104:107]
buffer_load_dwordx4 v23, s[44:47], s20 offen lds
v_mfma_f32_16x16x32_bf16 v[112:115], a[84:87], a[28:31], v[112:115]
v_mfma_f32_16x16x32_bf16 v[112:115], a[80:83], a[12:15], v[112:115]
v_mfma_f32_16x16x32_bf16 v[116:119], a[88:91], a[12:15], v[116:119]
ds_read_b64_tr_b16 a[80:81], v14 offset:0
v_mfma_f32_16x16x32_bf16 v[116:119], a[92:95], a[28:31], v[116:119]
ds_read_b64_tr_b16 a[82:83], v14 offset:256
v_mfma_f32_16x16x32_bf16 v[108:111], a[92:95], a[24:27], v[108:111]
ds_read_b64_tr_b16 a[84:85], v14 offset:2048
s_add_u32 m0, s16, 0x8800
v_mfma_f32_16x16x32_bf16 v[108:111], a[88:91], a[8:11], v[108:111]
buffer_load_dwordx4 v22, s[44:47], s21 offen lds
v_mfma_f32_16x16x32_bf16 v[100:103], a[88:91], a[4:7], v[100:103]
ds_read_b64_tr_b16 a[86:87], v14 offset:2304
v_mfma_f32_16x16x32_bf16 v[100:103], a[92:95], a[20:23], v[100:103]
v_mfma_f32_16x16x32_bf16 v[92:95], a[92:95], a[16:19], v[92:95]
v_mfma_f32_16x16x32_bf16 v[92:95], a[88:91], a[0:3], v[92:95]
s_add_u32 m0, s16, 0x8c00
s_waitcnt lgkmcnt(4)
v_mfma_f32_16x16x32_bf16 v[120:123], a[96:99], a[0:3], v[120:123]
buffer_load_dwordx4 v23, s[44:47], s21 offen lds
v_mfma_f32_16x16x32_bf16 v[120:123], a[100:103], a[16:19], v[120:123]
ds_read_b64_tr_b16 a[88:89], v15 offset:0
v_mfma_f32_16x16x32_bf16 v[128:131], a[100:103], a[20:23], v[128:131]
ds_read_b64_tr_b16 a[90:91], v15 offset:256
v_mfma_f32_16x16x32_bf16 v[128:131], a[96:99], a[4:7], v[128:131]
ds_read_b64_tr_b16 a[92:93], v15 offset:2048
v_mfma_f32_16x16x32_bf16 v[136:139], a[96:99], a[8:11], v[136:139]
ds_read_b64_tr_b16 a[94:95], v15 offset:2304
v_mfma_f32_16x16x32_bf16 v[136:139], a[100:103], a[24:27], v[136:139]
s_add_u32 s8, s28, 0x6c00
v_mfma_f32_16x16x32_bf16 v[144:147], a[100:103], a[28:31], v[144:147]
buffer_store_dwordx4 a[184:187], v16, s[88:91], s8 offen sc1
v_mfma_f32_16x16x32_bf16 v[144:147], a[96:99], a[12:15], v[144:147]
v_mfma_f32_16x16x32_bf16 v[148:151], a[104:107], a[12:15], v[148:151]
ds_read_b64_tr_b16 a[96:97], v14 offset:4096
v_mfma_f32_16x16x32_bf16 v[148:151], a[108:111], a[28:31], v[148:151]
ds_read_b64_tr_b16 a[98:99], v14 offset:4352
v_mfma_f32_16x16x32_bf16 v[140:143], a[108:111], a[24:27], v[140:143]
ds_read_b64_tr_b16 a[100:101], v14 offset:6144
v_mfma_f32_16x16x32_bf16 v[140:143], a[104:107], a[8:11], v[140:143]
ds_read_b64_tr_b16 a[102:103], v14 offset:6400
s_add_u32 m0, s16, 0x9000
v_mfma_f32_16x16x32_bf16 v[132:135], a[104:107], a[4:7], v[132:135]
buffer_load_dwordx4 v22, s[44:47], s22 offen lds
v_mfma_f32_16x16x32_bf16 v[132:135], a[108:111], a[20:23], v[132:135]
v_mfma_f32_16x16x32_bf16 v[124:127], a[108:111], a[16:19], v[124:127]
v_mfma_f32_16x16x32_bf16 v[124:127], a[104:107], a[0:3], v[124:127]
s_waitcnt lgkmcnt(4)
v_mfma_f32_16x16x32_bf16 v[152:155], a[80:83], a[0:3], v[152:155]
ds_read_b64_tr_b16 a[104:105], v15 offset:4096
s_add_u32 m0, s16, 0x9400
v_mfma_f32_16x16x32_bf16 v[152:155], a[84:87], a[16:19], v[152:155]
buffer_load_dwordx4 v23, s[44:47], s22 offen lds
v_mfma_f32_16x16x32_bf16 v[160:163], a[84:87], a[20:23], v[160:163]
ds_read_b64_tr_b16 a[106:107], v15 offset:4352
v_mfma_f32_16x16x32_bf16 v[160:163], a[80:83], a[4:7], v[160:163]
ds_read_b64_tr_b16 a[108:109], v15 offset:6144
v_mfma_f32_16x16x32_bf16 v[168:171], a[80:83], a[8:11], v[168:171]
ds_read_b64_tr_b16 a[110:111], v15 offset:6400
v_mfma_f32_16x16x32_bf16 v[168:171], a[84:87], a[24:27], v[168:171]
v_mfma_f32_16x16x32_bf16 v[176:179], a[84:87], a[28:31], v[176:179]
s_add_u32 m0, s16, 0x9800
v_mfma_f32_16x16x32_bf16 v[176:179], a[80:83], a[12:15], v[176:179]
buffer_load_dwordx4 v22, s[44:47], s23 offen lds
v_mfma_f32_16x16x32_bf16 v[180:183], a[88:91], a[12:15], v[180:183]
ds_read_b64_tr_b16 a[80:81], v14 offset:8192
v_mfma_f32_16x16x32_bf16 v[180:183], a[92:95], a[28:31], v[180:183]
ds_read_b64_tr_b16 a[82:83], v14 offset:8448
v_mfma_f32_16x16x32_bf16 v[172:175], a[92:95], a[24:27], v[172:175]
ds_read_b64_tr_b16 a[84:85], v14 offset:10240
v_mfma_f32_16x16x32_bf16 v[172:175], a[88:91], a[8:11], v[172:175]
ds_read_b64_tr_b16 a[86:87], v14 offset:10496
s_add_u32 m0, s16, 0x9c00
v_mfma_f32_16x16x32_bf16 v[164:167], a[88:91], a[4:7], v[164:167]
buffer_load_dwordx4 v23, s[44:47], s23 offen lds
v_mfma_f32_16x16x32_bf16 v[164:167], a[92:95], a[20:23], v[164:167]
v_lshl_add_u32 v22, s42, 7, v22
v_lshl_add_u32 v23, s42, 7, v23
v_mfma_f32_16x16x32_bf16 v[156:159], a[92:95], a[16:19], v[156:159]
v_mfma_f32_16x16x32_bf16 v[156:159], a[88:91], a[0:3], v[156:159]
s_waitcnt lgkmcnt(4)
v_mfma_f32_16x16x32_bf16 v[184:187], a[96:99], a[0:3], v[184:187]
ds_read_b64_tr_b16 a[88:89], v15 offset:8192
v_mfma_f32_16x16x32_bf16 v[184:187], a[100:103], a[16:19], v[184:187]
ds_read_b64_tr_b16 a[90:91], v15 offset:8448
s_add_u32 s8, s28, 0x7c00
v_mfma_f32_16x16x32_bf16 v[192:195], a[100:103], a[20:23], v[192:195]
buffer_store_dwordx4 a[188:191], v16, s[88:91], s8 offen sc1
v_mfma_f32_16x16x32_bf16 v[192:195], a[96:99], a[4:7], v[192:195]
ds_read_b64_tr_b16 a[92:93], v15 offset:10240
v_mfma_f32_16x16x32_bf16 v[200:203], a[96:99], a[8:11], v[200:203]
ds_read_b64_tr_b16 a[94:95], v15 offset:10496
v_add_u32 v12, 0x8000, v12
v_mfma_f32_16x16x32_bf16 v[200:203], a[100:103], a[24:27], v[200:203]
v_add_u32 v13, 0x8000, v13
v_add_u32 v14, 0x8000, v14
v_mfma_f32_16x16x32_bf16 v[208:211], a[100:103], a[28:31], v[208:211]
v_add_u32 v15, 0x8000, v15
v_mfma_f32_16x16x32_bf16 v[208:211], a[96:99], a[12:15], v[208:211]
v_mfma_f32_16x16x32_bf16 v[212:215], a[104:107], a[12:15], v[212:215]
s_waitcnt vmcnt(29) lgkmcnt(0)
v_mfma_f32_16x16x32_bf16 v[212:215], a[108:111], a[28:31], v[212:215]
s_barrier
s_add_u32 m0, s17, 0x0
v_mfma_f32_16x16x32_bf16 v[204:207], a[108:111], a[24:27], v[204:207]
buffer_load_dwordx4 v5, s[52:55], 0 offen lds
v_mfma_f32_16x16x32_bf16 v[204:207], a[104:107], a[8:11], v[204:207]
ds_read_b64_tr_b16 a[96:97], v12 offset:0
v_mfma_f32_16x16x32_bf16 v[196:199], a[104:107], a[4:7], v[196:199]
ds_read_b64_tr_b16 a[98:99], v12 offset:1024
v_mfma_f32_16x16x32_bf16 v[196:199], a[108:111], a[20:23], v[196:199]
ds_read_b64_tr_b16 a[100:101], v12 offset:8192
v_mfma_f32_16x16x32_bf16 v[188:191], a[108:111], a[16:19], v[188:191]
ds_read_b64_tr_b16 a[102:103], v12 offset:9216
v_mfma_f32_16x16x32_bf16 v[188:191], a[104:107], a[0:3], v[188:191]
s_add_u32 m0, s17, 0x400
s_waitcnt lgkmcnt(4)
v_mfma_f32_16x16x32_bf16 v[216:219], a[0:3], a[80:83], v[216:219]
buffer_load_dwordx4 v5, s[52:55], s13 offen lds
v_mfma_f32_16x16x32_bf16 v[216:219], a[16:19], a[84:87], v[216:219]
ds_read_b64_tr_b16 a[104:105], v13 offset:0
v_mfma_f32_16x16x32_bf16 v[224:227], a[20:23], a[84:87], v[224:227]
ds_read_b64_tr_b16 a[106:107], v13 offset:1024
v_mfma_f32_16x16x32_bf16 v[224:227], a[4:7], a[80:83], v[224:227]
ds_read_b64_tr_b16 a[108:109], v13 offset:8192
v_mfma_f32_16x16x32_bf16 v[232:235], a[8:11], a[80:83], v[232:235]
ds_read_b64_tr_b16 a[110:111], v13 offset:9216
v_mfma_f32_16x16x32_bf16 v[232:235], a[24:27], a[84:87], v[232:235]
v_mfma_f32_16x16x32_bf16 v[240:243], a[28:31], a[84:87], v[240:243]
s_add_u32 m0, s17, 0x800
v_mfma_f32_16x16x32_bf16 v[240:243], a[12:15], a[80:83], v[240:243]
buffer_load_dwordx4 v6, s[52:55], 0 offen lds
v_mfma_f32_16x16x32_bf16 v[244:247], a[12:15], a[88:91], v[244:247]
ds_read_b64_tr_b16 a[80:81], v12 offset:256
v_mfma_f32_16x16x32_bf16 v[244:247], a[28:31], a[92:95], v[244:247]
ds_read_b64_tr_b16 a[82:83], v12 offset:1280
v_mfma_f32_16x16x32_bf16 v[236:239], a[24:27], a[92:95], v[236:239]
ds_read_b64_tr_b16 a[84:85], v12 offset:8448
v_mfma_f32_16x16x32_bf16 v[236:239], a[8:11], a[88:91], v[236:239]
ds_read_b64_tr_b16 a[86:87], v12 offset:9472
v_mfma_f32_16x16x32_bf16 v[228:231], a[4:7], a[88:91], v[228:231]
v_mfma_f32_16x16x32_bf16 v[228:231], a[20:23], a[92:95], v[228:231]
s_add_u32 m0, s17, 0xc00
v_mfma_f32_16x16x32_bf16 v[220:223], a[16:19], a[92:95], v[220:223]
buffer_load_dwordx4 v6, s[52:55], s13 offen lds
v_mfma_f32_16x16x32_bf16 v[220:223], a[0:3], a[88:91], v[220:223]
s_waitcnt lgkmcnt(4)
L_S13:
v_mfma_f32_16x16x32_bf16 v[24:27], a[96:99], a[32:35], v[24:27]
ds_read_b64_tr_b16 a[88:89], v13 offset:256
s_waitcnt vmcnt(24)
v_mfma_f32_16x16x32_bf16 v[24:27], a[100:103], a[48:51], v[24:27]
ds_read_b64_tr_b16 a[90:91], v13 offset:1280
v_mfma_f32_16x16x32_bf16 v[32:35], a[100:103], a[52:55], v[32:35]
ds_read_b64_tr_b16 a[92:93], v13 offset:8448
v_mfma_f32_16x16x32_bf16 v[32:35], a[96:99], a[36:39], v[32:35]
ds_read_b64_tr_b16 a[94:95], v13 offset:9472
v_mfma_f32_16x16x32_bf16 v[40:43], a[96:99], a[40:43], v[40:43]
ds_read_b128 a[0:3], v8 offset:0
s_add_u32 m0, s18, 0x4000
v_mfma_f32_16x16x32_bf16 v[40:43], a[100:103], a[56:59], v[40:43]
buffer_load_dwordx4 v7, s[68:71], 0 offen lds
v_mfma_f32_16x16x32_bf16 v[48:51], a[100:103], a[60:63], v[48:51]
ds_read_b128 a[16:19], v9 offset:0
v_mfma_f32_16x16x32_bf16 v[48:51], a[96:99], a[44:47], v[48:51]
ds_read_b128 a[4:7], v8 offset:2048
v_mfma_f32_16x16x32_bf16 v[52:55], a[104:107], a[44:47], v[52:55]
ds_read_b64_tr_b16 a[96:97], v12 offset:512
v_mfma_f32_16x16x32_bf16 v[52:55], a[108:111], a[60:63], v[52:55]
ds_read_b64_tr_b16 a[98:99], v12 offset:1536
v_mfma_f32_16x16x32_bf16 v[44:47], a[108:111], a[56:59], v[44:47]
ds_read_b64_tr_b16 a[100:101], v12 offset:8704
s_add_u32 s8, s28, 0x4000
v_mfma_f32_16x16x32_bf16 v[44:47], a[104:107], a[40:43], v[44:47]
buffer_store_dwordx4 a[192:195], v16, s[88:91], s8 offen sc1
v_mfma_f32_16x16x32_bf16 v[36:39], a[104:107], a[36:39], v[36:39]
ds_read_b64_tr_b16 a[102:103], v12 offset:9728
v_mfma_f32_16x16x32_bf16 v[36:39], a[108:111], a[52:55], v[36:39]
ds_read_b128 a[20:23], v9 offset:2048
v_mfma_f32_16x16x32_bf16 v[28:31], a[108:111], a[48:51], v[28:31]
ds_read_b128 a[8:11], v8 offset:4096
v_mfma_f32_16x16x32_bf16 v[28:31], a[104:107], a[32:35], v[28:31]
ds_read_b128 a[24:27], v9 offset:4096
s_waitcnt lgkmcnt(10)
v_mfma_f32_16x16x32_bf16 v[56:59], a[80:83], a[32:35], v[56:59]
ds_read_b64_tr_b16 a[104:105], v13 offset:512
v_mfma_f32_16x16x32_bf16 v[56:59], a[84:87], a[48:51], v[56:59]
ds_read_b64_tr_b16 a[106:107], v13 offset:1536
s_add_u32 m0, s18, 0x5000
v_mfma_f32_16x16x32_bf16 v[64:67], a[84:87], a[52:55], v[64:67]
buffer_load_dwordx4 v7, s[68:71], s25 offen lds
v_mfma_f32_16x16x32_bf16 v[64:67], a[80:83], a[36:39], v[64:67]
ds_read_b64_tr_b16 a[108:109], v13 offset:8704
v_mfma_f32_16x16x32_bf16 v[72:75], a[80:83], a[40:43], v[72:75]
ds_read_b64_tr_b16 a[110:111], v13 offset:9728
v_mfma_f32_16x16x32_bf16 v[72:75], a[84:87], a[56:59], v[72:75]
ds_read_b128 a[12:15], v8 offset:6144
v_mfma_f32_16x16x32_bf16 v[80:83], a[84:87], a[60:63], v[80:83]
ds_read_b128 a[28:31], v9 offset:6144
v_mfma_f32_16x16x32_bf16 v[80:83], a[80:83], a[44:47], v[80:83]
v_mfma_f32_16x16x32_bf16 v[84:87], a[88:91], a[44:47], v[84:87]
ds_read_b64_tr_b16 a[80:81], v12 offset:768
s_add_u32 m0, s18, 0x6000
v_mfma_f32_16x16x32_bf16 v[84:87], a[92:95], a[60:63], v[84:87]
buffer_load_dwordx4 v7, s[68:71], s26 offen lds
v_mfma_f32_16x16x32_bf16 v[76:79], a[92:95], a[56:59], v[76:79]
ds_read_b64_tr_b16 a[82:83], v12 offset:1792
v_lshl_add_u32 v5, s42, 19, v5
v_mfma_f32_16x16x32_bf16 v[76:79], a[88:91], a[40:43], v[76:79]
ds_read_b64_tr_b16 a[84:85], v12 offset:8960
v_lshl_add_u32 v6, s42, 19, v6
v_mfma_f32_16x16x32_bf16 v[68:71], a[88:91], a[36:39], v[68:71]
ds_read_b64_tr_b16 a[86:87], v12 offset:9984
v_lshl_add_u32 v7, s42, 18, v7
v_mfma_f32_16x16x32_bf16 v[68:71], a[92:95], a[52:55], v[68:71]
v_lshl_add_u32 v7, s42, 17, v7
v_mfma_f32_16x16x32_bf16 v[60:63], a[92:95], a[48:51], v[60:63]
v_mfma_f32_16x16x32_bf16 v[60:63], a[88:91], a[32:35], v[60:63]
s_add_u32 m0, s16, 0x0
s_waitcnt lgkmcnt(4)
s_waitcnt lgkmcnt(6)
v_mfma_f32_16x16x32_bf16 v[88:91], a[96:99], a[32:35], v[88:91]
buffer_load_dwordx4 v22, s[44:47], s20 offen lds
v_mfma_f32_16x16x32_bf16 v[88:91], a[100:103], a[48:51], v[88:91]
ds_read_b64_tr_b16 a[88:89], v13 offset:768
v_mfma_f32_16x16x32_bf16 v[96:99], a[100:103], a[52:55], v[96:99]
ds_read_b64_tr_b16 a[90:91], v13 offset:1792
v_mfma_f32_16x16x32_bf16 v[96:99], a[96:99], a[36:39], v[96:99]
ds_read_b64_tr_b16 a[92:93], v13 offset:8960
v_mfma_f32_16x16x32_bf16 v[104:107], a[96:99], a[40:43], v[104:107]
ds_read_b64_tr_b16 a[94:95], v13 offset:9984
s_add_u32 m0, s16, 0x400
v_mfma_f32_16x16x32_bf16 v[104:107], a[100:103], a[56:59], v[104:107]
buffer_load_dwordx4 v23, s[44:47], s20 offen lds
v_mfma_f32_16x16x32_bf16 v[112:115], a[100:103], a[60:63], v[112:115]
v_mfma_f32_16x16x32_bf16 v[112:115], a[96:99], a[44:47], v[112:115]
v_mfma_f32_16x16x32_bf16 v[116:119], a[104:107], a[44:47], v[116:119]
ds_read_b64_tr_b16 a[96:97], v14 offset:0
v_mfma_f32_16x16x32_bf16 v[116:119], a[108:111], a[60:63], v[116:119]
ds_read_b64_tr_b16 a[98:99], v14 offset:256
v_mfma_f32_16x16x32_bf16 v[108:111], a[108:111], a[56:59], v[108:111]
ds_read_b64_tr_b16 a[100:101], v14 offset:2048
s_add_u32 m0, s16, 0x800
v_mfma_f32_16x16x32_bf16 v[108:111], a[104:107], a[40:43], v[108:111]
buffer_load_dwordx4 v22, s[44:47], s21 offen lds
v_mfma_f32_16x16x32_bf16 v[100:103], a[104:107], a[36:39], v[100:103]
ds_read_b64_tr_b16 a[102:103], v14 offset:2304
v_mfma_f32_16x16x32_bf16 v[100:103], a[108:111], a[52:55], v[100:103]
v_mfma_f32_16x16x32_bf16 v[92:95], a[108:111], a[48:51], v[92:95]
v_mfma_f32_16x16x32_bf16 v[92:95], a[104:107], a[32:35], v[92:95]
s_add_u32 s8, s28, 0x8000
s_waitcnt lgkmcnt(4)
v_mfma_f32_16x16x32_bf16 v[120:123], a[80:83], a[32:35], v[120:123]
buffer_store_dwordx4 a[196:199], v16, s[88:91], s8 offen sc1
v_mfma_f32_16x16x32_bf16 v[120:123], a[84:87], a[48:51], v[120:123]
ds_read_b64_tr_b16 a[104:105], v15 offset:0
v_mfma_f32_16x16x32_bf16 v[128:131], a[84:87], a[52:55], v[128:131]
ds_read_b64_tr_b16 a[106:107], v15 offset:256
v_mfma_f32_16x16x32_bf16 v[128:131], a[80:83], a[36:39], v[128:131]
ds_read_b64_tr_b16 a[108:109], v15 offset:2048
v_mfma_f32_16x16x32_bf16 v[136:139], a[80:83], a[40:43], v[136:139]
ds_read_b64_tr_b16 a[110:111], v15 offset:2304
v_mfma_f32_16x16x32_bf16 v[136:139], a[84:87], a[56:59], v[136:139]
s_add_u32 m0, s16, 0xc00
v_mfma_f32_16x16x32_bf16 v[144:147], a[84:87], a[60:63], v[144:147]
buffer_load_dwordx4 v23, s[44:47], s21 offen lds
v_mfma_f32_16x16x32_bf16 v[144:147], a[80:83], a[44:47], v[144:147]
L_padA7:
s_cmp_eq_u32 s95, 1
s_cbranch_scc1 L_padA11
v_mfma_f32_16x16x32_bf16 v[148:151], a[88:91], a[44:47], v[148:151]
ds_read_b64_tr_b16 a[80:81], v14 offset:4096
v_mfma_f32_16x16x32_bf16 v[148:151], a[92:95], a[60:63], v[148:151]
ds_read_b64_tr_b16 a[82:83], v14 offset:4352
v_mfma_f32_16x16x32_bf16 v[140:143], a[92:95], a[56:59], v[140:143]
ds_read_b64_tr_b16 a[84:85], v14 offset:6144
v_mfma_f32_16x16x32_bf16 v[140:143], a[88:91], a[40:43], v[140:143]
ds_read_b64_tr_b16 a[86:87], v14 offset:6400
s_add_u32 m0, s16, 0x1000
v_mfma_f32_16x16x32_bf16 v[132:135], a[88:91], a[36:39], v[132:135]
buffer_load_dwordx4 v22, s[44:47], s22 offen lds
v_mfma_f32_16x16x32_bf16 v[132:135], a[92:95], a[52:55], v[132:135]
v_mfma_f32_16x16x32_bf16 v[124:127], a[92:95], a[48:51], v[124:127]
v_mfma_f32_16x16x32_bf16 v[124:127], a[88:91], a[32:35], v[124:127]
s_waitcnt lgkmcnt(4)
v_mfma_f32_16x16x32_bf16 v[152:155], a[96:99], a[32:35], v[152:155]
ds_read_b64_tr_b16 a[88:89], v15 offset:4096
s_add_u32 m0, s16, 0x1400
v_mfma_f32_16x16x32_bf16 v[152:155], a[100:103], a[48:51], v[152:155]
buffer_load_dwordx4 v23, s[44:47], s22 offen lds
v_mfma_f32_16x16x32_bf16 v[160:163], a[100:103], a[52:55], v[160:163]
ds_read_b64_tr_b16 a[90:91], v15 offset:4352
v_mfma_f32_16x16x32_bf16 v[160:163], a[96:99], a[36:39], v[160:163]
ds_read_b64_tr_b16 a[92:93], v15 offset:6144
v_mfma_f32_16x16x32_bf16 v[168:171], a[96:99], a[40:43], v[168:171]
ds_read_b64_tr_b16 a[94:95], v15 offset:6400
v_mfma_f32_16x16x32_bf16 v[168:171], a[100:103], a[56:59], v[168:171]
v_mfma_f32_16x16x32_bf16 v[176:179], a[100:103], a[60:63], v[176:179]
s_add_u32 m0, s16, 0x1800
v_mfma_f32_16x16x32_bf16 v[176:179], a[96:99], a[44:47], v[176:179]
buffer_load_dwordx4 v22, s[44:47], s23 offen lds
v_mfma_f32_16x16x32_bf16 v[180:183], a[104:107], a[44:47], v[180:183]
ds_read_b64_tr_b16 a[96:97], v14 offset:8192
v_mfma_f32_16x16x32_bf16 v[180:183], a[108:111], a[60:63], v[180:183]
ds_read_b64_tr_b16 a[98:99], v14 offset:8448
v_mfma_f32_16x16x32_bf16 v[172:175], a[108:111], a[56:59], v[172:175]
ds_read_b64_tr_b16 a[100:101], v14 offset:10240
v_mfma_f32_16x16x32_bf16 v[172:175], a[104:107], a[40:43], v[172:175]
ds_read_b64_tr_b16 a[102:103], v14 offset:10496
s_add_u32 m0, s16, 0x1c00
v_mfma_f32_16x16x32_bf16 v[164:167], a[104:107], a[36:39], v[164:167]
buffer_load_dwordx4 v23, s[44:47], s23 offen lds
v_mfma_f32_16x16x32_bf16 v[164:167], a[108:111], a[52:55], v[164:167]
v_lshl_add_u32 v22, s42, 7, v22
v_lshl_add_u32 v23, s42, 7, v23
v_mfma_f32_16x16x32_bf16 v[156:159], a[108:111], a[48:51], v[156:159]
v_mfma_f32_16x16x32_bf16 v[156:159], a[104:107], a[32:35], v[156:159]
s_waitcnt lgkmcnt(4)
v_mfma_f32_16x16x32_bf16 v[184:187], a[80:83], a[32:35], v[184:187]
ds_read_b64_tr_b16 a[104:105], v15 offset:8192
v_mfma_f32_16x16x32_bf16 v[184:187], a[84:87], a[48:51], v[184:187]
ds_read_b64_tr_b16 a[106:107], v15 offset:8448
s_add_u32 s8, s28, 0x4400
v_mfma_f32_16x16x32_bf16 v[192:195], a[84:87], a[52:55], v[192:195]
buffer_store_dwordx4 a[200:203], v16, s[88:91], s8 offen sc1
v_mfma_f32_16x16x32_bf16 v[192:195], a[80:83], a[36:39], v[192:195]
ds_read_b64_tr_b16 a[108:109], v15 offset:10240
v_mfma_f32_16x16x32_bf16 v[200:203], a[80:83], a[40:43], v[200:203]
ds_read_b64_tr_b16 a[110:111], v15 offset:10496
v_add_u32 v12, 0x8000, v12
v_mfma_f32_16x16x32_bf16 v[200:203], a[84:87], a[56:59], v[200:203]
v_add_u32 v13, 0x8000, v13
v_add_u32 v14, 0x8000, v14
v_mfma_f32_16x16x32_bf16 v[208:211], a[84:87], a[60:63], v[208:211]
v_add_u32 v15, 0x8000, v15
v_mfma_f32_16x16x32_bf16 v[208:211], a[80:83], a[44:47], v[208:211]
v_mfma_f32_16x16x32_bf16 v[212:215], a[88:91], a[44:47], v[212:215]
s_waitcnt vmcnt(29) lgkmcnt(0)
v_mfma_f32_16x16x32_bf16 v[212:215], a[92:95], a[60:63], v[212:215]
s_barrier
s_add_u32 m0, s17, 0x8000
v_mfma_f32_16x16x32_bf16 v[204:207], a[92:95], a[56:59], v[204:207]
buffer_load_dwordx4 v5, s[52:55], 0 offen lds
v_mfma_f32_16x16x32_bf16 v[204:207], a[88:91], a[40:43], v[204:207]
ds_read_b64_tr_b16 a[80:81], v12 offset:0
v_mfma_f32_16x16x32_bf16 v[196:199], a[88:91], a[36:39], v[196:199]
ds_read_b64_tr_b16 a[82:83], v12 offset:1024
v_mfma_f32_16x16x32_bf16 v[196:199], a[92:95], a[52:55], v[196:199]
ds_read_b64_tr_b16 a[84:85], v12 offset:8192
v_mfma_f32_16x16x32_bf16 v[188:191], a[92:95], a[48:51], v[188:191]
ds_read_b64_tr_b16 a[86:87], v12 offset:9216
v_mfma_f32_16x16x32_bf16 v[188:191], a[88:91], a[32:35], v[188:191]
s_add_u32 m0, s17, 0x8400
s_waitcnt lgkmcnt(4)
v_mfma_f32_16x16x32_bf16 v[216:219], a[32:35], a[96:99], v[216:219]
buffer_load_dwordx4 v5, s[52:55], s13 offen lds
v_mfma_f32_16x16x32_bf16 v[216:219], a[48:51], a[100:103], v[216:219]
ds_read_b64_tr_b16 a[88:89], v13 offset:0
v_mfma_f32_16x16x32_bf16 v[224:227], a[52:55], a[100:103], v[224:227]
ds_read_b64_tr_b16 a[90:91], v13 offset:1024
v_mfma_f32_16x16x32_bf16 v[224:227], a[36:39], a[96:99], v[224:227]
ds_read_b64_tr_b16 a[92:93], v13 offset:8192
v_mfma_f32_16x16x32_bf16 v[232:235], a[40:43], a[96:99], v[232:235]
ds_read_b64_tr_b16 a[94:95], v13 offset:9216
v_mfma_f32_16x16x32_bf16 v[232:235], a[56:59], a[100:103], v[232:235]
s_add_u32 m0, s17, 0x8800
v_mfma_f32_16x16x32_bf16 v[240:243], a[60:63], a[100:103], v[240:243]
buffer_load_dwordx4 v6, s[52:55], 0 offen lds
v_mfma_f32_16x16x32_bf16 v[240:243], a[44:47], a[96:99], v[240:243]
v_mfma_f32_16x16x32_bf16 v[244:247], a[44:47], a[104:107], v[244:247]
ds_read_b64_tr_b16 a[96:97], v12 offset:256
v_mfma_f32_16x16x32_bf16 v[244:247], a[60:63], a[108:111], v[244:247]
ds_read_b64_tr_b16 a[98:99], v12 offset:1280
v_mfma_f32_16x16x32_bf16 v[236:239], a[56:59], a[108:111], v[236:239]
ds_read_b64_tr_b16 a[100:101], v12 offset:8448
v_mov_b32 v21, s1
v_mfma_f32_16x16x32_bf16 v[236:239], a[40:43], a[104:107], v[236:239]
ds_read_b64_tr_b16 a[102:103], v12 offset:9472
v_add_u32 v20, s0, v16
v_mfma_f32_16x16x32_bf16 v[228:231], a[36:39], a[104:107], v[228:231]
global_load_dword a120, v[20:21], off sc1
v_mfma_f32_16x16x32_bf16 v[228:231], a[52:55], a[108:111], v[228:231]
v_mfma_f32_16x16x32_bf16 v[220:223], a[48:51], a[108:111], v[220:223]
v_mfma_f32_16x16x32_bf16 v[220:223], a[32:35], a[104:107], v[220:223]
s_waitcnt lgkmcnt(4)
L_S14:
v_mfma_f32_16x16x32_bf16 v[24:27], a[80:83], a[0:3], v[24:27]
ds_read_b64_tr_b16 a[104:105], v13 offset:256
s_waitcnt vmcnt(23)
v_mfma_f32_16x16x32_bf16 v[24:27], a[84:87], a[16:19], v[24:27]
ds_read_b64_tr_b16 a[106:107], v13 offset:1280
s_add_u32 m0, s17, 0x8c00
v_mfma_f32_16x16x32_bf16 v[32:35], a[84:87], a[20:23], v[32:35]
buffer_load_dwordx4 v6, s[52:55], s13 offen lds
v_mfma_f32_16x16x32_bf16 v[32:35], a[80:83], a[4:7], v[32:35]
ds_read_b64_tr_b16 a[108:109], v13 offset:8448
v_mfma_f32_16x16x32_bf16 v[40:43], a[80:83], a[8:11], v[40:43]
ds_read_b64_tr_b16 a[110:111], v13 offset:9472
v_mfma_f32_16x16x32_bf16 v[40:43], a[84:87], a[24:27], v[40:43]
ds_read_b128 a[32:35], v8 offset:32768
v_mfma_f32_16x16x32_bf16 v[48:51], a[84:87], a[28:31], v[48:51]
ds_read_b128 a[48:51], v9 offset:32768
v_mfma_f32_16x16x32_bf16 v[48:51], a[80:83], a[12:15], v[48:51]
ds_read_b128 a[36:39], v8 offset:34816
s_add_u32 m0, s18, 0xc000
v_mfma_f32_16x16x32_bf16 v[52:55], a[88:91], a[12:15], v[52:55]
buffer_load_dwordx4 v7, s[68:71], 0 offen lds
v_mfma_f32_16x16x32_bf16 v[52:55], a[92:95], a[28:31], v[52:55]
ds_read_b64_tr_b16 a[80:81], v12 offset:512
v_mfma_f32_16x16x32_bf16 v[44:47], a[92:95], a[24:27], v[44:47]
ds_read_b64_tr_b16 a[82:83], v12 offset:1536
v_mfma_f32_16x16x32_bf16 v[44:47], a[88:91], a[8:11], v[44:47]
ds_read_b64_tr_b16 a[84:85], v12 offset:8704
v_mfma_f32_16x16x32_bf16 v[36:39], a[88:91], a[4:7], v[36:39]
ds_read_b64_tr_b16 a[86:87], v12 offset:9728
v_mfma_f32_16x16x32_bf16 v[36:39], a[92:95], a[20:23], v[36:39]
ds_read_b128 a[52:55], v9 offset:34816
s_add_u32 m0, s18, 0xd000
v_mfma_f32_16x16x32_bf16 v[28:31], a[92:95], a[16:19], v[28:31]
buffer_load_dwordx4 v7, s[68:71], s25 offen lds
v_mfma_f32_16x16x32_bf16 v[28:31], a[88:91], a[0:3], v[28:31]
ds_read_b128 a[40:43], v8 offset:36864
s_waitcnt lgkmcnt(9)
v_mfma_f32_16x16x32_bf16 v[56:59], a[96:99], a[0:3], v[56:59]
ds_read_b64_tr_b16 a[88:89], v13 offset:512
v_mfma_f32_16x16x32_bf16 v[56:59], a[100:103], a[16:19], v[56:59]
ds_read_b64_tr_b16 a[90:91], v13 offset:1536
v_mfma_f32_16x16x32_bf16 v[64:67], a[100:103], a[20:23], v[64:67]
ds_read_b64_tr_b16 a[92:93], v13 offset:8704
v_mfma_f32_16x16x32_bf16 v[64:67], a[96:99], a[4:7], v[64:67]
ds_read_b64_tr_b16 a[94:95], v13 offset:9728
s_add_u32 m0, s18, 0xe000
v_mfma_f32_16x16x32_bf16 v[72:75], a[96:99], a[8:11], v[72:75]
buffer_load_dwordx4 v7, s[68:71], s26 offen lds
v_mfma_f32_16x16x32_bf16 v[72:75], a[100:103], a[24:27], v[72:75]
ds_read_b128 a[56:59], v9 offset:36864
v_lshl_add_u32 v5, s42, 19, v5
v_mfma_f32_16x16x32_bf16 v[80:83], a[100:103], a[28:31], v[80:83]
ds_read_b128 a[44:47], v8 offset:38912
v_lshl_add_u32 v6, s42, 19, v6
v_mfma_f32_16x16x32_bf16 v[80:83], a[96:99], a[12:15], v[80:83]
ds_read_b128 a[60:63], v9 offset:38912
v_lshl_add_u32 v7, s42, 18, v7
v_mfma_f32_16x16x32_bf16 v[84:87], a[104:107], a[12:15], v[84:87]
ds_read_b64_tr_b16 a[96:97], v12 offset:768
v_lshl_add_u32 v7, s42, 17, v7
v_mfma_f32_16x16x32_bf16 v[84:87], a[108:111], a[28:31], v[84:87]
ds_read_b64_tr_b16 a[98:99], v12 offset:1792
s_add_u32 s8, s28, 0x8400
v_mfma_f32_16x16x32_bf16 v[76:79], a[108:111], a[24:27], v[76:79]
buffer_store_dwordx4 a[204:207], v16, s[88:91], s8 offen sc1
v_mfma_f32_16x16x32_bf16 v[76:79], a[104:107], a[8:11], v[76:79]
ds_read_b64_tr_b16 a[100:101], v12 offset:8960
v_mfma_f32_16x16x32_bf16 v[68:71], a[104:107], a[4:7], v[68:71]
ds_read_b64_tr_b16 a[102:103], v12 offset:9984
v_mfma_f32_16x16x32_bf16 v[68:71], a[108:111], a[20:23], v[68:71]
v_mfma_f32_16x16x32_bf16 v[60:63], a[108:111], a[16:19], v[60:63]
v_mfma_f32_16x16x32_bf16 v[60:63], a[104:107], a[0:3], v[60:63]
s_add_u32 m0, s16, 0x8000
s_waitcnt lgkmcnt(4)
s_waitcnt lgkmcnt(7)
v_mfma_f32_16x16x32_bf16 v[88:91], a[80:83], a[0:3], v[88:91]
buffer_load_dwordx4 v22, s[44:47], s20 offen lds
v_mfma_f32_16x16x32_bf16 v[88:91], a[84:87], a[16:19], v[88:91]
ds_read_b64_tr_b16 a[104:105], v13 offset:768
v_mfma_f32_16x16x32_bf16 v[96:99], a[84:87], a[20:23], v[96:99]
ds_read_b64_tr_b16 a[106:107], v13 offset:1792
v_mfma_f32_16x16x32_bf16 v[96:99], a[80:83], a[4:7], v[96:99]
ds_read_b64_tr_b16 a[108:109], v13 offset:8960
v_mfma_f32_16x16x32_bf16 v[104:107], a[80:83], a[8:11], v[104:107]
ds_read_b64_tr_b16 a[110:111], v13 offset:9984
s_add_u32 m0, s16, 0x8400
v_mfma_f32_16x16x32_bf16 v[104:107], a[84:87], a[24:27], v[104:107]
buffer_load_dwordx4 v23, s[44:47], s20 offen lds
v_mfma_f32_16x16x32_bf16 v[112:115], a[84:87], a[28:31], v[112:115]
v_mfma_f32_16x16x32_bf16 v[112:115], a[80:83], a[12:15], v[112:115]
v_mfma_f32_16x16x32_bf16 v[116:119], a[88:91], a[12:15], v[116:119]
ds_read_b64_tr_b16 a[80:81], v14 offset:0
v_mfma_f32_16x16x32_bf16 v[116:119], a[92:95], a[28:31], v[116:119]
ds_read_b64_tr_b16 a[82:83], v14 offset:256
v_mfma_f32_16x16x32_bf16 v[108:111], a[92:95], a[24:27], v[108:111]
ds_read_b64_tr_b16 a[84:85], v14 offset:2048
s_add_u32 m0, s16, 0x8800
v_mfma_f32_16x16x32_bf16 v[108:111], a[88:91], a[8:11], v[108:111]
buffer_load_dwordx4 v22, s[44:47], s21 offen lds
v_mfma_f32_16x16x32_bf16 v[100:103], a[88:91], a[4:7], v[100:103]
ds_read_b64_tr_b16 a[86:87], v14 offset:2304
v_mfma_f32_16x16x32_bf16 v[100:103], a[92:95], a[20:23], v[100:103]
v_mfma_f32_16x16x32_bf16 v[92:95], a[92:95], a[16:19], v[92:95]
v_mfma_f32_16x16x32_bf16 v[92:95], a[88:91], a[0:3], v[92:95]
s_add_u32 m0, s16, 0x8c00
s_waitcnt lgkmcnt(4)
v_mfma_f32_16x16x32_bf16 v[120:123], a[96:99], a[0:3], v[120:123]
buffer_load_dwordx4 v23, s[44:47], s21 offen lds
v_mfma_f32_16x16x32_bf16 v[120:123], a[100:103], a[16:19], v[120:123]
ds_read_b64_tr_b16 a[88:89], v15 offset:0
v_mfma_f32_16x16x32_bf16 v[128:131], a[100:103], a[20:23], v[128:131]
ds_read_b64_tr_b16 a[90:91], v15 offset:256
v_mfma_f32_16x16x32_bf16 v[128:131], a[96:99], a[4:7], v[128:131]
ds_read_b64_tr_b16 a[92:93], v15 offset:2048
v_mfma_f32_16x16x32_bf16 v[136:139], a[96:99], a[8:11], v[136:139]
ds_read_b64_tr_b16 a[94:95], v15 offset:2304
v_mfma_f32_16x16x32_bf16 v[136:139], a[100:103], a[24:27], v[136:139]
s_add_u32 s8, s28, 0x4800
v_mfma_f32_16x16x32_bf16 v[144:147], a[100:103], a[28:31], v[144:147]
buffer_store_dwordx4 a[208:211], v16, s[88:91], s8 offen sc1
v_mfma_f32_16x16x32_bf16 v[144:147], a[96:99], a[12:15], v[144:147]
v_mfma_f32_16x16x32_bf16 v[148:151], a[104:107], a[12:15], v[148:151]
ds_read_b64_tr_b16 a[96:97], v14 offset:4096
v_mfma_f32_16x16x32_bf16 v[148:151], a[108:111], a[28:31], v[148:151]
ds_read_b64_tr_b16 a[98:99], v14 offset:4352
v_mfma_f32_16x16x32_bf16 v[140:143], a[108:111], a[24:27], v[140:143]
ds_read_b64_tr_b16 a[100:101], v14 offset:6144
v_mfma_f32_16x16x32_bf16 v[140:143], a[104:107], a[8:11], v[140:143]
ds_read_b64_tr_b16 a[102:103], v14 offset:6400
s_add_u32 m0, s16, 0x9000
v_mfma_f32_16x16x32_bf16 v[132:135], a[104:107], a[4:7], v[132:135]
buffer_load_dwordx4 v22, s[44:47], s22 offen lds
v_mfma_f32_16x16x32_bf16 v[132:135], a[108:111], a[20:23], v[132:135]
v_mfma_f32_16x16x32_bf16 v[124:127], a[108:111], a[16:19], v[124:127]
v_mfma_f32_16x16x32_bf16 v[124:127], a[104:107], a[0:3], v[124:127]
s_waitcnt lgkmcnt(4)
v_mfma_f32_16x16x32_bf16 v[152:155], a[80:83], a[0:3], v[152:155]
ds_read_b64_tr_b16 a[104:105], v15 offset:4096
s_add_u32 m0, s16, 0x9400
v_mfma_f32_16x16x32_bf16 v[152:155], a[84:87], a[16:19], v[152:155]
buffer_load_dwordx4 v23, s[44:47], s22 offen lds
v_mfma_f32_16x16x32_bf16 v[160:163], a[84:87], a[20:23], v[160:163]
ds_read_b64_tr_b16 a[106:107], v15 offset:4352
v_mfma_f32_16x16x32_bf16 v[160:163], a[80:83], a[4:7], v[160:163]
ds_read_b64_tr_b16 a[108:109], v15 offset:6144
v_mfma_f32_16x16x32_bf16 v[168:171], a[80:83], a[8:11], v[168:171]
ds_read_b64_tr_b16 a[110:111], v15 offset:6400
v_mfma_f32_16x16x32_bf16 v[168:171], a[84:87], a[24:27], v[168:171]
v_mfma_f32_16x16x32_bf16 v[176:179], a[84:87], a[28:31], v[176:179]
s_add_u32 m0, s16, 0x9800
v_mfma_f32_16x16x32_bf16 v[176:179], a[80:83], a[12:15], v[176:179]
buffer_load_dwordx4 v22, s[44:47], s23 offen lds
v_mfma_f32_16x16x32_bf16 v[180:183], a[88:91], a[12:15], v[180:183]
ds_read_b64_tr_b16 a[80:81], v14 offset:8192
v_mfma_f32_16x16x32_bf16 v[180:183], a[92:95], a[28:31], v[180:183]
ds_read_b64_tr_b16 a[82:83], v14 offset:8448
v_mfma_f32_16x16x32_bf16 v[172:175], a[92:95], a[24:27], v[172:175]
ds_read_b64_tr_b16 a[84:85], v14 offset:10240
v_mfma_f32_16x16x32_bf16 v[172:175], a[88:91], a[8:11], v[172:175]
ds_read_b64_tr_b16 a[86:87], v14 offset:10496
s_add_u32 m0, s16, 0x9c00
v_mfma_f32_16x16x32_bf16 v[164:167], a[88:91], a[4:7], v[164:167]
buffer_load_dwordx4 v23, s[44:47], s23 offen lds
v_mfma_f32_16x16x32_bf16 v[164:167], a[92:95], a[20:23], v[164:167]
v_lshl_add_u32 v22, s42, 7, v22
v_lshl_add_u32 v23, s42, 7, v23
v_mfma_f32_16x16x32_bf16 v[156:159], a[92:95], a[16:19], v[156:159]
v_mfma_f32_16x16x32_bf16 v[156:159], a[88:91], a[0:3], v[156:159]
s_waitcnt lgkmcnt(4)
v_mfma_f32_16x16x32_bf16 v[184:187], a[96:99], a[0:3], v[184:187]
ds_read_b64_tr_b16 a[88:89], v15 offset:8192
v_mfma_f32_16x16x32_bf16 v[184:187], a[100:103], a[16:19], v[184:187]
ds_read_b64_tr_b16 a[90:91], v15 offset:8448
s_add_u32 s8, s28, 0x8800
v_mfma_f32_16x16x32_bf16 v[192:195], a[100:103], a[20:23], v[192:195]
buffer_store_dwordx4 a[212:215], v16, s[88:91], s8 offen sc1
v_mfma_f32_16x16x32_bf16 v[192:195], a[96:99], a[4:7], v[192:195]
ds_read_b64_tr_b16 a[92:93], v15 offset:10240
v_mfma_f32_16x16x32_bf16 v[200:203], a[96:99], a[8:11], v[200:203]
ds_read_b64_tr_b16 a[94:95], v15 offset:10496
v_add_u32 v12, 0xffff0000, v12
v_mfma_f32_16x16x32_bf16 v[200:203], a[100:103], a[24:27], v[200:203]
v_add_u32 v13, 0xffff0000, v13
v_add_u32 v14, 0xffff0000, v14
v_mfma_f32_16x16x32_bf16 v[208:211], a[100:103], a[28:31], v[208:211]
v_add_u32 v15, 0xffff0000, v15
v_mfma_f32_16x16x32_bf16 v[208:211], a[96:99], a[12:15], v[208:211]
v_mfma_f32_16x16x32_bf16 v[212:215], a[104:107], a[12:15], v[212:215]
s_waitcnt vmcnt(29) lgkmcnt(0)
v_mfma_f32_16x16x32_bf16 v[212:215], a[108:111], a[28:31], v[212:215]
s_barrier
s_add_u32 m0, s17, 0x10000
v_mfma_f32_16x16x32_bf16 v[204:207], a[108:111], a[24:27], v[204:207]
buffer_load_dwordx4 v5, s[52:55], 0 offen lds
v_mfma_f32_16x16x32_bf16 v[204:207], a[104:107], a[8:11], v[204:207]
ds_read_b64_tr_b16 a[96:97], v12 offset:0
v_mfma_f32_16x16x32_bf16 v[196:199], a[104:107], a[4:7], v[196:199]
ds_read_b64_tr_b16 a[98:99], v12 offset:1024
v_mfma_f32_16x16x32_bf16 v[196:199], a[108:111], a[20:23], v[196:199]
ds_read_b64_tr_b16 a[100:101], v12 offset:8192
v_mfma_f32_16x16x32_bf16 v[188:191], a[108:111], a[16:19], v[188:191]
ds_read_b64_tr_b16 a[102:103], v12 offset:9216
v_mfma_f32_16x16x32_bf16 v[188:191], a[104:107], a[0:3], v[188:191]
s_add_u32 m0, s17, 0x10400
s_waitcnt lgkmcnt(4)
v_mfma_f32_16x16x32_bf16 v[216:219], a[0:3], a[80:83], v[216:219]
buffer_load_dwordx4 v5, s[52:55], s13 offen lds
v_mfma_f32_16x16x32_bf16 v[216:219], a[16:19], a[84:87], v[216:219]
ds_read_b64_tr_b16 a[104:105], v13 offset:0
v_mfma_f32_16x16x32_bf16 v[224:227], a[20:23], a[84:87], v[224:227]
ds_read_b64_tr_b16 a[106:107], v13 offset:1024
v_mfma_f32_16x16x32_bf16 v[224:227], a[4:7], a[80:83], v[224:227]
ds_read_b64_tr_b16 a[108:109], v13 offset:8192
v_mfma_f32_16x16x32_bf16 v[232:235], a[8:11], a[80:83], v[232:235]
ds_read_b64_tr_b16 a[110:111], v13 offset:9216
v_mfma_f32_16x16x32_bf16 v[232:235], a[24:27], a[84:87], v[232:235]
v_mfma_f32_16x16x32_bf16 v[240:243], a[28:31], a[84:87], v[240:243]
s_add_u32 m0, s17, 0x10800
v_mfma_f32_16x16x32_bf16 v[240:243], a[12:15], a[80:83], v[240:243]
buffer_load_dwordx4 v6, s[52:55], 0 offen lds
v_mfma_f32_16x16x32_bf16 v[244:247], a[12:15], a[88:91], v[244:247]
ds_read_b64_tr_b16 a[80:81], v12 offset:256
v_mfma_f32_16x16x32_bf16 v[244:247], a[28:31], a[92:95], v[244:247]
ds_read_b64_tr_b16 a[82:83], v12 offset:1280
v_mfma_f32_16x16x32_bf16 v[236:239], a[24:27], a[92:95], v[236:239]
ds_read_b64_tr_b16 a[84:85], v12 offset:8448
v_mfma_f32_16x16x32_bf16 v[236:239], a[8:11], a[88:91], v[236:239]
ds_read_b64_tr_b16 a[86:87], v12 offset:9472
v_mfma_f32_16x16x32_bf16 v[228:231], a[4:7], a[88:91], v[228:231]
v_mfma_f32_16x16x32_bf16 v[228:231], a[20:23], a[92:95], v[228:231]
s_add_u32 m0, s17, 0x10c00
v_mfma_f32_16x16x32_bf16 v[220:223], a[16:19], a[92:95], v[220:223]
buffer_load_dwordx4 v6, s[52:55], s13 offen lds
v_mfma_f32_16x16x32_bf16 v[220:223], a[0:3], a[88:91], v[220:223]
s_waitcnt lgkmcnt(4)
L_S15:
v_mfma_f32_16x16x32_bf16 v[24:27], a[96:99], a[32:35], v[24:27]
ds_read_b64_tr_b16 a[88:89], v13 offset:256
s_waitcnt vmcnt(24)
v_mfma_f32_16x16x32_bf16 v[24:27], a[100:103], a[48:51], v[24:27]
ds_read_b64_tr_b16 a[90:91], v13 offset:1280
v_mfma_f32_16x16x32_bf16 v[32:35], a[100:103], a[52:55], v[32:35]
ds_read_b64_tr_b16 a[92:93], v13 offset:8448
v_mfma_f32_16x16x32_bf16 v[32:35], a[96:99], a[36:39], v[32:35]
ds_read_b64_tr_b16 a[94:95], v13 offset:9472
v_mfma_f32_16x16x32_bf16 v[40:43], a[96:99], a[40:43], v[40:43]
ds_read_b128 a[0:3], v8 offset:0
s_add_u32 m0, s18, 0x14000
v_mfma_f32_16x16x32_bf16 v[40:43], a[100:103], a[56:59], v[40:43]
buffer_load_dwordx4 v7, s[68:71], 0 offen lds
v_mfma_f32_16x16x32_bf16 v[48:51], a[100:103], a[60:63], v[48:51]
ds_read_b128 a[16:19], v9 offset:0
v_mfma_f32_16x16x32_bf16 v[48:51], a[96:99], a[44:47], v[48:51]
ds_read_b128 a[4:7], v8 offset:2048
v_mfma_f32_16x16x32_bf16 v[52:55], a[104:107], a[44:47], v[52:55]
ds_read_b64_tr_b16 a[96:97], v12 offset:512
v_mfma_f32_16x16x32_bf16 v[52:55], a[108:111], a[60:63], v[52:55]
ds_read_b64_tr_b16 a[98:99], v12 offset:1536
v_mfma_f32_16x16x32_bf16 v[44:47], a[108:111], a[56:59], v[44:47]
ds_read_b64_tr_b16 a[100:101], v12 offset:8704
s_add_u32 s8, s28, 0x4c00
v_mfma_f32_16x16x32_bf16 v[44:47], a[104:107], a[40:43], v[44:47]
buffer_store_dwordx4 a[216:219], v16, s[88:91], s8 offen sc1
v_mfma_f32_16x16x32_bf16 v[36:39], a[104:107], a[36:39], v[36:39]
ds_read_b64_tr_b16 a[102:103], v12 offset:9728
v_mfma_f32_16x16x32_bf16 v[36:39], a[108:111], a[52:55], v[36:39]
ds_read_b128 a[20:23], v9 offset:2048
v_mfma_f32_16x16x32_bf16 v[28:31], a[108:111], a[48:51], v[28:31]
ds_read_b128 a[8:11], v8 offset:4096
v_mfma_f32_16x16x32_bf16 v[28:31], a[104:107], a[32:35], v[28:31]
ds_read_b128 a[24:27], v9 offset:4096
s_waitcnt lgkmcnt(10)
v_mfma_f32_16x16x32_bf16 v[56:59], a[80:83], a[32:35], v[56:59]
ds_read_b64_tr_b16 a[104:105], v13 offset:512
v_mfma_f32_16x16x32_bf16 v[56:59], a[84:87], a[48:51], v[56:59]
ds_read_b64_tr_b16 a[106:107], v13 offset:1536
s_add_u32 m0, s18, 0x15000
v_mfma_f32_16x16x32_bf16 v[64:67], a[84:87], a[52:55], v[64:67]
buffer_load_dwordx4 v7, s[68:71], s25 offen lds
v_mfma_f32_16x16x32_bf16 v[64:67], a[80:83], a[36:39], v[64:67]
ds_read_b64_tr_b16 a[108:109], v13 offset:8704
v_mfma_f32_16x16x32_bf16 v[72:75], a[80:83], a[40:43], v[72:75]
ds_read_b64_tr_b16 a[110:111], v13 offset:9728
v_mfma_f32_16x16x32_bf16 v[72:75], a[84:87], a[56:59], v[72:75]
ds_read_b128 a[12:15], v8 offset:6144
v_mfma_f32_16x16x32_bf16 v[80:83], a[84:87], a[60:63], v[80:83]
ds_read_b128 a[28:31], v9 offset:6144
v_mfma_f32_16x16x32_bf16 v[80:83], a[80:83], a[44:47], v[80:83]
v_mfma_f32_16x16x32_bf16 v[84:87], a[88:91], a[44:47], v[84:87]
ds_read_b64_tr_b16 a[80:81], v12 offset:768
s_add_u32 m0, s18, 0x16000
v_mfma_f32_16x16x32_bf16 v[84:87], a[92:95], a[60:63], v[84:87]
buffer_load_dwordx4 v7, s[68:71], s26 offen lds
v_mfma_f32_16x16x32_bf16 v[76:79], a[92:95], a[56:59], v[76:79]
ds_read_b64_tr_b16 a[82:83], v12 offset:1792
v_lshl_add_u32 v5, s42, 19, v5
v_mfma_f32_16x16x32_bf16 v[76:79], a[88:91], a[40:43], v[76:79]
ds_read_b64_tr_b16 a[84:85], v12 offset:8960
v_lshl_add_u32 v6, s42, 19, v6
v_mfma_f32_16x16x32_bf16 v[68:71], a[88:91], a[36:39], v[68:71]
ds_read_b64_tr_b16 a[86:87], v12 offset:9984
v_lshl_add_u32 v7, s42, 18, v7
v_mfma_f32_16x16x32_bf16 v[68:71], a[92:95], a[52:55], v[68:71]
v_lshl_add_u32 v7, s42, 17, v7
v_mfma_f32_16x16x32_bf16 v[60:63], a[92:95], a[48:51], v[60:63]
v_mfma_f32_16x16x32_bf16 v[60:63], a[88:91], a[32:35], v[60:63]
s_add_u32 m0, s16, 0x0
s_waitcnt lgkmcnt(4)
s_waitcnt lgkmcnt(6)
v_mfma_f32_16x16x32_bf16 v[88:91], a[96:99], a[32:35], v[88:91]
buffer_load_dwordx4 v22, s[44:47], s20 offen lds
v_mfma_f32_16x16x32_bf16 v[88:91], a[100:103], a[48:51], v[88:91]
ds_read_b64_tr_b16 a[88:89], v13 offset:768
v_mfma_f32_16x16x32_bf16 v[96:99], a[100:103], a[52:55], v[96:99]
ds_read_b64_tr_b16 a[90:91], v13 offset:1792
v_mfma_f32_16x16x32_bf16 v[96:99], a[96:99], a[36:39], v[96:99]
ds_read_b64_tr_b16 a[92:93], v13 offset:8960
v_mfma_f32_16x16x32_bf16 v[104:107], a[96:99], a[40:43], v[104:107]
ds_read_b64_tr_b16 a[94:95], v13 offset:9984
s_add_u32 m0, s16, 0x400
v_mfma_f32_16x16x32_bf16 v[104:107], a[100:103], a[56:59], v[104:107]
buffer_load_dwordx4 v23, s[44:47], s20 offen lds
v_mfma_f32_16x16x32_bf16 v[112:115], a[100:103], a[60:63], v[112:115]
v_mfma_f32_16x16x32_bf16 v[112:115], a[96:99], a[44:47], v[112:115]
v_mfma_f32_16x16x32_bf16 v[116:119], a[104:107], a[44:47], v[116:119]
ds_read_b64_tr_b16 a[96:97], v14 offset:0
v_mfma_f32_16x16x32_bf16 v[116:119], a[108:111], a[60:63], v[116:119]
ds_read_b64_tr_b16 a[98:99], v14 offset:256
v_mfma_f32_16x16x32_bf16 v[108:111], a[108:111], a[56:59], v[108:111]
ds_read_b64_tr_b16 a[100:101], v14 offset:2048
s_add_u32 m0, s16, 0x800
v_mfma_f32_16x16x32_bf16 v[108:111], a[104:107], a[40:43], v[108:111]
buffer_load_dwordx4 v22, s[44:47], s21 offen lds
v_mfma_f32_16x16x32_bf16 v[100:103], a[104:107], a[36:39], v[100:103]
ds_read_b64_tr_b16 a[102:103], v14 offset:2304
v_mfma_f32_16x16x32_bf16 v[100:103], a[108:111], a[52:55], v[100:103]
v_mfma_f32_16x16x32_bf16 v[92:95], a[108:111], a[48:51], v[92:95]
v_mfma_f32_16x16x32_bf16 v[92:95], a[104:107], a[32:35], v[92:95]
s_add_u32 s8, s28, 0x8c00
s_waitcnt lgkmcnt(4)
v_mfma_f32_16x16x32_bf16 v[120:123], a[80:83], a[32:35], v[120:123]
buffer_store_dwordx4 a[220:223], v16, s[88:91], s8 offen sc1
v_mfma_f32_16x16x32_bf16 v[120:123], a[84:87], a[48:51], v[120:123]
ds_read_b64_tr_b16 a[104:105], v15 offset:0
v_mfma_f32_16x16x32_bf16 v[128:131], a[84:87], a[52:55], v[128:131]
ds_read_b64_tr_b16 a[106:107], v15 offset:256
v_mfma_f32_16x16x32_bf16 v[128:131], a[80:83], a[36:39], v[128:131]
ds_read_b64_tr_b16 a[108:109], v15 offset:2048
v_mfma_f32_16x16x32_bf16 v[136:139], a[80:83], a[40:43], v[136:139]
ds_read_b64_tr_b16 a[110:111], v15 offset:2304
v_mfma_f32_16x16x32_bf16 v[136:139], a[84:87], a[56:59], v[136:139]
s_add_u32 m0, s16, 0xc00
v_mfma_f32_16x16x32_bf16 v[144:147], a[84:87], a[60:63], v[144:147]
buffer_load_dwordx4 v23, s[44:47], s21 offen lds
v_mfma_f32_16x16x32_bf16 v[144:147], a[80:83], a[44:47], v[144:147]
v_mfma_f32_16x16x32_bf16 v[148:151], a[88:91], a[44:47], v[148:151]
ds_read_b64_tr_b16 a[80:81], v14 offset:4096
v_mfma_f32_16x16x32_bf16 v[148:151], a[92:95], a[60:63], v[148:151]
ds_read_b64_tr_b16 a[82:83], v14 offset:4352
v_mfma_f32_16x16x32_bf16 v[140:143], a[92:95], a[56:59], v[140:143]
ds_read_b64_tr_b16 a[84:85], v14 offset:6144
v_mfma_f32_16x16x32_bf16 v[140:143], a[88:91], a[40:43], v[140:143]
ds_read_b64_tr_b16 a[86:87], v14 offset:6400
s_add_u32 m0, s16, 0x1000
v_mfma_f32_16x16x32_bf16 v[132:135], a[88:91], a[36:39], v[132:135]
buffer_load_dwordx4 v22, s[44:47], s22 offen lds
v_mfma_f32_16x16x32_bf16 v[132:135], a[92:95], a[52:55], v[132:135]
v_mfma_f32_16x16x32_bf16 v[124:127], a[92:95], a[48:51], v[124:127]
v_mfma_f32_16x16x32_bf16 v[124:127], a[88:91], a[32:35], v[124:127]
s_waitcnt lgkmcnt(4)
v_mfma_f32_16x16x32_bf16 v[152:155], a[96:99], a[32:35], v[152:155]
ds_read_b64_tr_b16 a[88:89], v15 offset:4096
s_add_u32 m0, s16, 0x1400
v_mfma_f32_16x16x32_bf16 v[152:155], a[100:103], a[48:51], v[152:155]
buffer_load_dwordx4 v23, s[44:47], s22 offen lds
v_mfma_f32_16x16x32_bf16 v[160:163], a[100:103], a[52:55], v[160:163]
ds_read_b64_tr_b16 a[90:91], v15 offset:4352
v_mfma_f32_16x16x32_bf16 v[160:163], a[96:99], a[36:39], v[160:163]
ds_read_b64_tr_b16 a[92:93], v15 offset:6144
v_mfma_f32_16x16x32_bf16 v[168:171], a[96:99], a[40:43], v[168:171]
ds_read_b64_tr_b16 a[94:95], v15 offset:6400
v_mfma_f32_16x16x32_bf16 v[168:171], a[100:103], a[56:59], v[168:171]
v_mfma_f32_16x16x32_bf16 v[176:179], a[100:103], a[60:63], v[176:179]
s_add_u32 m0, s16, 0x1800
v_mfma_f32_16x16x32_bf16 v[176:179], a[96:99], a[44:47], v[176:179]
buffer_load_dwordx4 v22, s[44:47], s23 offen lds
v_mfma_f32_16x16x32_bf16 v[180:183], a[104:107], a[44:47], v[180:183]
ds_read_b64_tr_b16 a[96:97], v14 offset:8192
v_mfma_f32_16x16x32_bf16 v[180:183], a[108:111], a[60:63], v[180:183]
ds_read_b64_tr_b16 a[98:99], v14 offset:8448
v_mfma_f32_16x16x32_bf16 v[172:175], a[108:111], a[56:59], v[172:175]
ds_read_b64_tr_b16 a[100:101], v14 offset:10240
v_mfma_f32_16x16x32_bf16 v[172:175], a[104:107], a[40:43], v[172:175]
ds_read_b64_tr_b16 a[102:103], v14 offset:10496
s_add_u32 m0, s16, 0x1c00
v_mfma_f32_16x16x32_bf16 v[164:167], a[104:107], a[36:39], v[164:167]
buffer_load_dwordx4 v23, s[44:47], s23 offen lds
v_mfma_f32_16x16x32_bf16 v[164:167], a[108:111], a[52:55], v[164:167]
v_lshl_add_u32 v22, s42, 7, v22
v_lshl_add_u32 v23, s42, 7, v23
v_mfma_f32_16x16x32_bf16 v[156:159], a[108:111], a[48:51], v[156:159]
v_mfma_f32_16x16x32_bf16 v[156:159], a[104:107], a[32:35], v[156:159]
s_waitcnt lgkmcnt(4)
v_mfma_f32_16x16x32_bf16 v[184:187], a[80:83], a[32:35], v[184:187]
ds_read_b64_tr_b16 a[104:105], v15 offset:8192
v_mfma_f32_16x16x32_bf16 v[184:187], a[84:87], a[48:51], v[184:187]
ds_read_b64_tr_b16 a[106:107], v15 offset:8448
s_add_u32 s8, s28, 0x5000
v_mfma_f32_16x16x32_bf16 v[192:195], a[84:87], a[52:55], v[192:195]
buffer_store_dwordx4 a[224:227], v16, s[88:91], s8 offen sc1
v_mfma_f32_16x16x32_bf16 v[192:195], a[80:83], a[36:39], v[192:195]
ds_read_b64_tr_b16 a[108:109], v15 offset:10240
L_padA8:
s_cmp_eq_u32 s95, 1
s_cbranch_scc1 L_padA12
v_mfma_f32_16x16x32_bf16 v[200:203], a[80:83], a[40:43], v[200:203]
ds_read_b64_tr_b16 a[110:111], v15 offset:10496
v_add_u32 v12, 0x8000, v12
v_mfma_f32_16x16x32_bf16 v[200:203], a[84:87], a[56:59], v[200:203]
v_add_u32 v13, 0x8000, v13
v_add_u32 v14, 0x8000, v14
v_mfma_f32_16x16x32_bf16 v[208:211], a[84:87], a[60:63], v[208:211]
v_add_u32 v15, 0x8000, v15
v_mfma_f32_16x16x32_bf16 v[208:211], a[80:83], a[44:47], v[208:211]
v_mfma_f32_16x16x32_bf16 v[212:215], a[88:91], a[44:47], v[212:215]
s_waitcnt vmcnt(29) lgkmcnt(0)
v_mfma_f32_16x16x32_bf16 v[212:215], a[92:95], a[60:63], v[212:215]
s_barrier
s_add_u32 m0, s17, 0x0
v_mfma_f32_16x16x32_bf16 v[204:207], a[92:95], a[56:59], v[204:207]
buffer_load_dwordx4 v5, s[52:55], 0 offen lds
v_mfma_f32_16x16x32_bf16 v[204:207], a[88:91], a[40:43], v[204:207]
ds_read_b64_tr_b16 a[80:81], v12 offset:0
v_mfma_f32_16x16x32_bf16 v[196:199], a[88:91], a[36:39], v[196:199]
ds_read_b64_tr_b16 a[82:83], v12 offset:1024
v_mfma_f32_16x16x32_bf16 v[196:199], a[92:95], a[52:55], v[196:199]
ds_read_b64_tr_b16 a[84:85], v12 offset:8192
v_mfma_f32_16x16x32_bf16 v[188:191], a[92:95], a[48:51], v[188:191]
ds_read_b64_tr_b16 a[86:87], v12 offset:9216
v_mfma_f32_16x16x32_bf16 v[188:191], a[88:91], a[32:35], v[188:191]
s_add_u32 m0, s17, 0x400
s_waitcnt lgkmcnt(4)
v_mfma_f32_16x16x32_bf16 v[216:219], a[32:35], a[96:99], v[216:219]
buffer_load_dwordx4 v5, s[52:55], s13 offen lds
v_mfma_f32_16x16x32_bf16 v[216:219], a[48:51], a[100:103], v[216:219]
ds_read_b64_tr_b16 a[88:89], v13 offset:0
v_mfma_f32_16x16x32_bf16 v[224:227], a[52:55], a[100:103], v[224:227]
ds_read_b64_tr_b16 a[90:91], v13 offset:1024
v_mfma_f32_16x16x32_bf16 v[224:227], a[36:39], a[96:99], v[224:227]
ds_read_b64_tr_b16 a[92:93], v13 offset:8192
v_mfma_f32_16x16x32_bf16 v[232:235], a[40:43], a[96:99], v[232:235]
ds_read_b64_tr_b16 a[94:95], v13 offset:9216
v_mfma_f32_16x16x32_bf16 v[232:235], a[56:59], a[100:103], v[232:235]
v_mfma_f32_16x16x32_bf16 v[240:243], a[60:63], a[100:103], v[240:243]
s_add_u32 m0, s17, 0x800
v_mfma_f32_16x16x32_bf16 v[240:243], a[44:47], a[96:99], v[240:243]
buffer_load_dwordx4 v6, s[52:55], 0 offen lds
v_mfma_f32_16x16x32_bf16 v[244:247], a[44:47], a[104:107], v[244:247]
ds_read_b64_tr_b16 a[96:97], v12 offset:256
v_mfma_f32_16x16x32_bf16 v[244:247], a[60:63], a[108:111], v[244:247]
ds_read_b64_tr_b16 a[98:99], v12 offset:1280
v_mfma_f32_16x16x32_bf16 v[236:239], a[56:59], a[108:111], v[236:239]
ds_read_b64_tr_b16 a[100:101], v12 offset:8448
v_mfma_f32_16x16x32_bf16 v[236:239], a[40:43], a[104:107], v[236:239]
ds_read_b64_tr_b16 a[102:103], v12 offset:9472
v_mfma_f32_16x16x32_bf16 v[228:231], a[36:39], a[104:107], v[228:231]
v_mfma_f32_16x16x32_bf16 v[228:231], a[52:55], a[108:111], v[228:231]
s_add_u32 m0, s17, 0xc00
v_mfma_f32_16x16x32_bf16 v[220:223], a[48:51], a[108:111], v[220:223]
buffer_load_dwordx4 v6, s[52:55], s13 offen lds
v_mfma_f32_16x16x32_bf16 v[220:223], a[32:35], a[104:107], v[220:223]
s_waitcnt lgkmcnt(4)
L_S16:
v_mfma_f32_16x16x32_bf16 v[24:27], a[80:83], a[0:3], v[24:27]
ds_read_b64_tr_b16 a[104:105], v13 offset:256
s_waitcnt vmcnt(23)
v_mfma_f32_16x16x32_bf16 v[24:27], a[84:87], a[16:19], v[24:27]
ds_read_b64_tr_b16 a[106:107], v13 offset:1280
v_mfma_f32_16x16x32_bf16 v[32:35], a[84:87], a[20:23], v[32:35]
ds_read_b64_tr_b16 a[108:109], v13 offset:8448
v_mfma_f32_16x16x32_bf16 v[32:35], a[80:83], a[4:7], v[32:35]
ds_read_b64_tr_b16 a[110:111], v13 offset:9472
v_mfma_f32_16x16x32_bf16 v[40:43], a[80:83], a[8:11], v[40:43]
ds_read_b128 a[32:35], v8 offset:32768
s_add_u32 m0, s18, 0x4000
v_mfma_f32_16x16x32_bf16 v[40:43], a[84:87], a[24:27], v[40:43]
buffer_load_dwordx4 v7, s[68:71], 0 offen lds
v_mfma_f32_16x16x32_bf16 v[48:51], a[84:87], a[28:31], v[48:51]
ds_read_b128 a[48:51], v9 offset:32768
v_mfma_f32_16x16x32_bf16 v[48:51], a[80:83], a[12:15], v[48:51]
ds_read_b128 a[36:39], v8 offset:34816
v_mfma_f32_16x16x32_bf16 v[52:55], a[88:91], a[12:15], v[52:55]
ds_read_b64_tr_b16 a[80:81], v12 offset:512
v_mfma_f32_16x16x32_bf16 v[52:55], a[92:95], a[28:31], v[52:55]
ds_read_b64_tr_b16 a[82:83], v12 offset:1536
v_mfma_f32_16x16x32_bf16 v[44:47], a[92:95], a[24:27], v[44:47]
ds_read_b64_tr_b16 a[84:85], v12 offset:8704
s_add_u32 s8, s28, 0x9000
v_mfma_f32_16x16x32_bf16 v[44:47], a[88:91], a[8:11], v[44:47]
buffer_store_dwordx4 a[228:231], v16, s[88:91], s8 offen sc1
v_mfma_f32_16x16x32_bf16 v[36:39], a[88:91], a[4:7], v[36:39]
ds_read_b64_tr_b16 a[86:87], v12 offset:9728
v_mfma_f32_16x16x32_bf16 v[36:39], a[92:95], a[20:23], v[36:39]
ds_read_b128 a[52:55], v9 offset:34816
v_mfma_f32_16x16x32_bf16 v[28:31], a[92:95], a[16:19], v[28:31]
ds_read_b128 a[40:43], v8 offset:36864
v_mfma_f32_16x16x32_bf16 v[28:31], a[88:91], a[0:3], v[28:31]
ds_read_b128 a[56:59], v9 offset:36864
s_waitcnt lgkmcnt(10)
v_mfma_f32_16x16x32_bf16 v[56:59], a[96:99], a[0:3], v[56:59]
ds_read_b64_tr_b16 a[88:89], v13 offset:512
v_mfma_f32_16x16x32_bf16 v[56:59], a[100:103], a[16:19], v[56:59]
ds_read_b64_tr_b16 a[90:91], v13 offset:1536
s_add_u32 m0, s18, 0x5000
v_mfma_f32_16x16x32_bf16 v[64:67], a[100:103], a[20:23], v[64:67]
buffer_load_dwordx4 v7, s[68:71], s25 offen lds
v_mfma_f32_16x16x32_bf16 v[64:67], a[96:99], a[4:7], v[64:67]
ds_read_b64_tr_b16 a[92:93], v13 offset:8704
v_mfma_f32_16x16x32_bf16 v[72:75], a[96:99], a[8:11], v[72:75]
ds_read_b64_tr_b16 a[94:95], v13 offset:9728
v_mfma_f32_16x16x32_bf16 v[72:75], a[100:103], a[24:27], v[72:75]
ds_read_b128 a[44:47], v8 offset:38912
v_mfma_f32_16x16x32_bf16 v[80:83], a[100:103], a[28:31], v[80:83]
ds_read_b128 a[60:63], v9 offset:38912
v_mfma_f32_16x16x32_bf16 v[80:83], a[96:99], a[12:15], v[80:83]
v_mfma_f32_16x16x32_bf16 v[84:87], a[104:107], a[12:15], v[84:87]
ds_read_b64_tr_b16 a[96:97], v12 offset:768
s_add_u32 m0, s18, 0x6000
v_mfma_f32_16x16x32_bf16 v[84:87], a[108:111], a[28:31], v[84:87]
buffer_load_dwordx4 v7, s[68:71], s26 offen lds
v_mfma_f32_16x16x32_bf16 v[76:79], a[108:111], a[24:27], v[76:79]
ds_read_b64_tr_b16 a[98:99], v12 offset:1792
v_lshl_add_u32 v5, s42, 19, v5
v_mfma_f32_16x16x32_bf16 v[76:79], a[104:107], a[8:11], v[76:79]
ds_read_b64_tr_b16 a[100:101], v12 offset:8960
v_lshl_add_u32 v6, s42, 19, v6
v_mfma_f32_16x16x32_bf16 v[68:71], a[104:107], a[4:7], v[68:71]
ds_read_b64_tr_b16 a[102:103], v12 offset:9984
v_lshl_add_u32 v7, s42, 18, v7
v_mfma_f32_16x16x32_bf16 v[68:71], a[108:111], a[20:23], v[68:71]
v_lshl_add_u32 v7, s42, 17, v7
v_mfma_f32_16x16x32_bf16 v[60:63], a[108:111], a[16:19], v[60:63]
v_mfma_f32_16x16x32_bf16 v[60:63], a[104:107], a[0:3], v[60:63]
s_add_u32 m0, s16, 0x8000
s_waitcnt lgkmcnt(4)
s_waitcnt lgkmcnt(6)
v_mfma_f32_16x16x32_bf16 v[88:91], a[80:83], a[0:3], v[88:91]
buffer_load_dwordx4 v22, s[44:47], s20 offen lds
v_mfma_f32_16x16x32_bf16 v[88:91], a[84:87], a[16:19], v[88:91]
ds_read_b64_tr_b16 a[104:105], v13 offset:768
v_mfma_f32_16x16x32_bf16 v[96:99], a[84:87], a[20:23], v[96:99]
ds_read_b64_tr_b16 a[106:107], v13 offset:1792
v_mfma_f32_16x16x32_bf16 v[96:99], a[80:83], a[4:7], v[96:99]
ds_read_b64_tr_b16 a[108:109], v13 offset:8960
v_mfma_f32_16x16x32_bf16 v[104:107], a[80:83], a[8:11], v[104:107]
ds_read_b64_tr_b16 a[110:111], v13 offset:9984
s_add_u32 m0, s16, 0x8400
v_mfma_f32_16x16x32_bf16 v[104:107], a[84:87], a[24:27], v[104:107]
buffer_load_dwordx4 v23, s[44:47], s20 offen lds
v_mfma_f32_16x16x32_bf16 v[112:115], a[84:87], a[28:31], v[112:115]
v_mfma_f32_16x16x32_bf16 v[112:115], a[80:83], a[12:15], v[112:115]
v_mfma_f32_16x16x32_bf16 v[116:119], a[88:91], a[12:15], v[116:119]
ds_read_b64_tr_b16 a[80:81], v14 offset:0
v_mfma_f32_16x16x32_bf16 v[116:119], a[92:95], a[28:31], v[116:119]
ds_read_b64_tr_b16 a[82:83], v14 offset:256
v_mfma_f32_16x16x32_bf16 v[108:111], a[92:95], a[24:27], v[108:111]
ds_read_b64_tr_b16 a[84:85], v14 offset:2048
s_add_u32 m0, s16, 0x8800
v_mfma_f32_16x16x32_bf16 v[108:111], a[88:91], a[8:11], v[108:111]
buffer_load_dwordx4 v22, s[44:47], s21 offen lds
v_mfma_f32_16x16x32_bf16 v[100:103], a[88:91], a[4:7], v[100:103]
ds_read_b64_tr_b16 a[86:87], v14 offset:2304
v_mfma_f32_16x16x32_bf16 v[100:103], a[92:95], a[20:23], v[100:103]
v_mfma_f32_16x16x32_bf16 v[92:95], a[92:95], a[16:19], v[92:95]
v_mfma_f32_16x16x32_bf16 v[92:95], a[88:91], a[0:3], v[92:95]
s_add_u32 s8, s28, 0x5400
s_waitcnt lgkmcnt(4)
v_mfma_f32_16x16x32_bf16 v[120:123], a[96:99], a[0:3], v[120:123]
buffer_store_dwordx4 a[112:115], v16, s[88:91], s8 offen sc1
v_mfma_f32_16x16x32_bf16 v[120:123], a[100:103], a[16:19], v[120:123]
ds_read_b64_tr_b16 a[88:89], v15 offset:0
v_mfma_f32_16x16x32_bf16 v[128:131], a[100:103], a[20:23], v[128:131]
ds_read_b64_tr_b16 a[90:91], v15 offset:256
v_mfma_f32_16x16x32_bf16 v[128:131], a[96:99], a[4:7], v[128:131]
ds_read_b64_tr_b16 a[92:93], v15 offset:2048
v_mfma_f32_16x16x32_bf16 v[136:139], a[96:99], a[8:11], v[136:139]
ds_read_b64_tr_b16 a[94:95], v15 offset:2304
v_mfma_f32_16x16x32_bf16 v[136:139], a[100:103], a[24:27], v[136:139]
s_add_u32 m0, s16, 0x8c00
v_mfma_f32_16x16x32_bf16 v[144:147], a[100:103], a[28:31], v[144:147]
buffer_load_dwordx4 v23, s[44:47], s21 offen lds
v_mfma_f32_16x16x32_bf16 v[144:147], a[96:99], a[12:15], v[144:147]
v_mfma_f32_16x16x32_bf16 v[148:151], a[104:107], a[12:15], v[148:151]
ds_read_b64_tr_b16 a[96:97], v14 offset:4096
v_mfma_f32_16x16x32_bf16 v[148:151], a[108:111], a[28:31], v[148:151]
ds_read_b64_tr_b16 a[98:99], v14 offset:4352
v_mfma_f32_16x16x32_bf16 v[140:143], a[108:111], a[24:27], v[140:143]
ds_read_b64_tr_b16 a[100:101], v14 offset:6144
v_mfma_f32_16x16x32_bf16 v[140:143], a[104:107], a[8:11], v[140:143]
ds_read_b64_tr_b16 a[102:103], v14 offset:6400
s_add_u32 m0, s16, 0x9000
v_mfma_f32_16x16x32_bf16 v[132:135], a[104:107], a[4:7], v[132:135]
buffer_load_dwordx4 v22, s[44:47], s22 offen lds
v_mfma_f32_16x16x32_bf16 v[132:135], a[108:111], a[20:23], v[132:135]
v_mfma_f32_16x16x32_bf16 v[124:127], a[108:111], a[16:19], v[124:127]
v_mfma_f32_16x16x32_bf16 v[124:127], a[104:107], a[0:3], v[124:127]
s_waitcnt lgkmcnt(4)
v_mfma_f32_16x16x32_bf16 v[152:155], a[80:83], a[0:3], v[152:155]
ds_read_b64_tr_b16 a[104:105], v15 offset:4096
s_add_u32 m0, s16, 0x9400
v_mfma_f32_16x16x32_bf16 v[152:155], a[84:87], a[16:19], v[152:155]
buffer_load_dwordx4 v23, s[44:47], s22 offen lds
v_mfma_f32_16x16x32_bf16 v[160:163], a[84:87], a[20:23], v[160:163]
ds_read_b64_tr_b16 a[106:107], v15 offset:4352
v_mfma_f32_16x16x32_bf16 v[160:163], a[80:83], a[4:7], v[160:163]
ds_read_b64_tr_b16 a[108:109], v15 offset:6144
v_mfma_f32_16x16x32_bf16 v[168:171], a[80:83], a[8:11], v[168:171]
ds_read_b64_tr_b16 a[110:111], v15 offset:6400
v_mfma_f32_16x16x32_bf16 v[168:171], a[84:87], a[24:27], v[168:171]
v_mfma_f32_16x16x32_bf16 v[176:179], a[84:87], a[28:31], v[176:179]
s_add_u32 m0, s16, 0x9800
v_mfma_f32_16x16x32_bf16 v[176:179], a[80:83], a[12:15], v[176:179]
buffer_load_dwordx4 v22, s[44:47], s23 offen lds
v_mfma_f32_16x16x32_bf16 v[180:183], a[88:91], a[12:15], v[180:183]
ds_read_b64_tr_b16 a[80:81], v14 offset:8192
v_mfma_f32_16x16x32_bf16 v[180:183], a[92:95], a[28:31], v[180:183]
ds_read_b64_tr_b16 a[82:83], v14 offset:8448
v_mfma_f32_16x16x32_bf16 v[172:175], a[92:95], a[24:27], v[172:175]
ds_read_b64_tr_b16 a[84:85], v14 offset:10240
v_mfma_f32_16x16x32_bf16 v[172:175], a[88:91], a[8:11], v[172:175]
ds_read_b64_tr_b16 a[86:87], v14 offset:10496
s_add_u32 m0, s16, 0x9c00
v_mfma_f32_16x16x32_bf16 v[164:167], a[88:91], a[4:7], v[164:167]
buffer_load_dwordx4 v23, s[44:47], s23 offen lds
v_mfma_f32_16x16x32_bf16 v[164:167], a[92:95], a[20:23], v[164:167]
v_lshl_add_u32 v22, s42, 7, v22
v_lshl_add_u32 v23, s42, 7, v23
v_mfma_f32_16x16x32_bf16 v[156:159], a[92:95], a[16:19], v[156:159]
v_mfma_f32_16x16x32_bf16 v[156:159], a[88:91], a[0:3], v[156:159]
s_waitcnt lgkmcnt(4)
v_mfma_f32_16x16x32_bf16 v[184:187], a[96:99], a[0:3], v[184:187]
ds_read_b64_tr_b16 a[88:89], v15 offset:8192
v_mfma_f32_16x16x32_bf16 v[184:187], a[100:103], a[16:19], v[184:187]
ds_read_b64_tr_b16 a[90:91], v15 offset:8448
s_add_u32 s8, s28, 0x9400
v_mfma_f32_16x16x32_bf16 v[192:195], a[100:103], a[20:23], v[192:195]
buffer_store_dwordx4 a[116:119], v16, s[88:91], s8 offen sc1
v_mfma_f32_16x16x32_bf16 v[192:195], a[96:99], a[4:7], v[192:195]
ds_read_b64_tr_b16 a[92:93], v15 offset:10240
v_mfma_f32_16x16x32_bf16 v[200:203], a[96:99], a[8:11], v[200:203]
ds_read_b64_tr_b16 a[94:95], v15 offset:10496
v_add_u32 v12, 0x8000, v12
v_mfma_f32_16x16x32_bf16 v[200:203], a[100:103], a[24:27], v[200:203]
v_add_u32 v13, 0x8000, v13
v_add_u32 v14, 0x8000, v14
v_mfma_f32_16x16x32_bf16 v[208:211], a[100:103], a[28:31], v[208:211]
v_add_u32 v15, 0x8000, v15
v_mfma_f32_16x16x32_bf16 v[208:211], a[96:99], a[12:15], v[208:211]
v_mfma_f32_16x16x32_bf16 v[212:215], a[104:107], a[12:15], v[212:215]
s_waitcnt vmcnt(28) lgkmcnt(0)
v_mfma_f32_16x16x32_bf16 v[212:215], a[108:111], a[28:31], v[212:215]
s_barrier
s_add_u32 m0, s17, 0x8000
v_mfma_f32_16x16x32_bf16 v[204:207], a[108:111], a[24:27], v[204:207]
buffer_load_dwordx4 v5, s[52:55], 0 offen lds
v_mfma_f32_16x16x32_bf16 v[204:207], a[104:107], a[8:11], v[204:207]
ds_read_b64_tr_b16 a[96:97], v12 offset:0
v_mfma_f32_16x16x32_bf16 v[196:199], a[104:107], a[4:7], v[196:199]
ds_read_b64_tr_b16 a[98:99], v12 offset:1024
v_mfma_f32_16x16x32_bf16 v[196:199], a[108:111], a[20:23], v[196:199]
ds_read_b64_tr_b16 a[100:101], v12 offset:8192
v_mfma_f32_16x16x32_bf16 v[188:191], a[108:111], a[16:19], v[188:191]
ds_read_b64_tr_b16 a[102:103], v12 offset:9216
v_mfma_f32_16x16x32_bf16 v[188:191], a[104:107], a[0:3], v[188:191]
s_add_u32 m0, s17, 0x8400
s_waitcnt lgkmcnt(4)
v_mfma_f32_16x16x32_bf16 v[216:219], a[0:3], a[80:83], v[216:219]
buffer_load_dwordx4 v5, s[52:55], s13 offen lds
v_mfma_f32_16x16x32_bf16 v[216:219], a[16:19], a[84:87], v[216:219]
ds_read_b64_tr_b16 a[104:105], v13 offset:0
v_mfma_f32_16x16x32_bf16 v[224:227], a[20:23], a[84:87], v[224:227]
ds_read_b64_tr_b16 a[106:107], v13 offset:1024
v_mfma_f32_16x16x32_bf16 v[224:227], a[4:7], a[80:83], v[224:227]
ds_read_b64_tr_b16 a[108:109], v13 offset:8192
v_mfma_f32_16x16x32_bf16 v[232:235], a[8:11], a[80:83], v[232:235]
ds_read_b64_tr_b16 a[110:111], v13 offset:9216
v_mfma_f32_16x16x32_bf16 v[232:235], a[24:27], a[84:87], v[232:235]
s_add_u32 m0, s17, 0x8800
v_mfma_f32_16x16x32_bf16 v[240:243], a[28:31], a[84:87], v[240:243]
buffer_load_dwordx4 v6, s[52:55], 0 offen lds
v_mfma_f32_16x16x32_bf16 v[240:243], a[12:15], a[80:83], v[240:243]
v_mfma_f32_16x16x32_bf16 v[244:247], a[12:15], a[88:91], v[244:247]
ds_read_b64_tr_b16 a[80:81], v12 offset:256
v_mfma_f32_16x16x32_bf16 v[244:247], a[28:31], a[92:95], v[244:247]
ds_read_b64_tr_b16 a[82:83], v12 offset:1280
v_mfma_f32_16x16x32_bf16 v[236:239], a[24:27], a[92:95], v[236:239]
ds_read_b64_tr_b16 a[84:85], v12 offset:8448
v_mfma_f32_16x16x32_bf16 v[236:239], a[8:11], a[88:91], v[236:239]
ds_read_b64_tr_b16 a[86:87], v12 offset:9472
s_add_u32 s8, s28, 0x5800
v_mfma_f32_16x16x32_bf16 v[228:231], a[4:7], a[88:91], v[228:231]
buffer_store_dwordx4 a[124:127], v16, s[88:91], s8 offen sc1
v_mfma_f32_16x16x32_bf16 v[228:231], a[20:23], a[92:95], v[228:231]
v_mfma_f32_16x16x32_bf16 v[220:223], a[16:19], a[92:95], v[220:223]
v_mfma_f32_16x16x32_bf16 v[220:223], a[0:3], a[88:91], v[220:223]
s_waitcnt lgkmcnt(4)
L_S17:
v_mfma_f32_16x16x32_bf16 v[24:27], a[96:99], a[32:35], v[24:27]
ds_read_b64_tr_b16 a[88:89], v13 offset:256
s_waitcnt vmcnt(23)
v_mfma_f32_16x16x32_bf16 v[24:27], a[100:103], a[48:51], v[24:27]
ds_read_b64_tr_b16 a[90:91], v13 offset:1280
s_add_u32 m0, s17, 0x8c00
v_mfma_f32_16x16x32_bf16 v[32:35], a[100:103], a[52:55], v[32:35]
buffer_load_dwordx4 v6, s[52:55], s13 offen lds
v_mfma_f32_16x16x32_bf16 v[32:35], a[96:99], a[36:39], v[32:35]
ds_read_b64_tr_b16 a[92:93], v13 offset:8448
v_mfma_f32_16x16x32_bf16 v[40:43], a[96:99], a[40:43], v[40:43]
ds_read_b64_tr_b16 a[94:95], v13 offset:9472
v_mfma_f32_16x16x32_bf16 v[40:43], a[100:103], a[56:59], v[40:43]
ds_read_b128 a[0:3], v8 offset:0
v_mfma_f32_16x16x32_bf16 v[48:51], a[100:103], a[60:63], v[48:51]
ds_read_b128 a[16:19], v9 offset:0
v_mfma_f32_16x16x32_bf16 v[48:51], a[96:99], a[44:47], v[48:51]
ds_read_b128 a[4:7], v8 offset:2048
s_add_u32 m0, s18, 0xc000
v_mfma_f32_16x16x32_bf16 v[52:55], a[104:107], a[44:47], v[52:55]
buffer_load_dwordx4 v7, s[68:71], 0 offen lds
v_mfma_f32_16x16x32_bf16 v[52:55], a[108:111], a[60:63], v[52:55]
ds_read_b64_tr_b16 a[96:97], v12 offset:512
v_mfma_f32_16x16x32_bf16 v[44:47], a[108:111], a[56:59], v[44:47]
ds_read_b64_tr_b16 a[98:99], v12 offset:1536
v_mfma_f32_16x16x32_bf16 v[44:47], a[104:107], a[40:43], v[44:47]
ds_read_b64_tr_b16 a[100:101], v12 offset:8704
v_mfma_f32_16x16x32_bf16 v[36:39], a[104:107], a[36:39], v[36:39]
ds_read_b64_tr_b16 a[102:103], v12 offset:9728
v_mfma_f32_16x16x32_bf16 v[36:39], a[108:111], a[52:55], v[36:39]
ds_read_b128 a[20:23], v9 offset:2048
s_add_u32 m0, s18, 0xd000
v_mfma_f32_16x16x32_bf16 v[28:31], a[108:111], a[48:51], v[28:31]
buffer_load_dwordx4 v7, s[68:71], s25 offen lds
v_mfma_f32_16x16x32_bf16 v[28:31], a[104:107], a[32:35], v[28:31]
ds_read_b128 a[8:11], v8 offset:4096
s_waitcnt lgkmcnt(9)
v_mfma_f32_16x16x32_bf16 v[56:59], a[80:83], a[32:35], v[56:59]
ds_read_b64_tr_b16 a[104:105], v13 offset:512
v_mfma_f32_16x16x32_bf16 v[56:59], a[84:87], a[48:51], v[56:59]
ds_read_b64_tr_b16 a[106:107], v13 offset:1536
v_mfma_f32_16x16x32_bf16 v[64:67], a[84:87], a[52:55], v[64:67]
ds_read_b64_tr_b16 a[108:109], v13 offset:8704
v_mfma_f32_16x16x32_bf16 v[64:67], a[80:83], a[36:39], v[64:67]
ds_read_b64_tr_b16 a[110:111], v13 offset:9728
s_add_u32 m0, s18, 0xe000
v_mfma_f32_16x16x32_bf16 v[72:75], a[80:83], a[40:43], v[72:75]
buffer_load_dwordx4 v7, s[68:71], s26 offen lds
v_mfma_f32_16x16x32_bf16 v[72:75], a[84:87], a[56:59], v[72:75]
ds_read_b128 a[24:27], v9 offset:4096
v_lshl_add_u32 v5, s42, 19, v5
v_mfma_f32_16x16x32_bf16 v[80:83], a[84:87], a[60:63], v[80:83]
ds_read_b128 a[12:15], v8 offset:6144
v_lshl_add_u32 v6, s42, 19, v6
v_mfma_f32_16x16x32_bf16 v[80:83], a[80:83], a[44:47], v[80:83]
ds_read_b128 a[28:31], v9 offset:6144
v_lshl_add_u32 v7, s42, 18, v7
v_mfma_f32_16x16x32_bf16 v[84:87], a[88:91], a[44:47], v[84:87]
ds_read_b64_tr_b16 a[80:81], v12 offset:768
v_lshl_add_u32 v7, s42, 17, v7
v_mfma_f32_16x16x32_bf16 v[84:87], a[92:95], a[60:63], v[84:87]
ds_read_b64_tr_b16 a[82:83], v12 offset:1792
s_add_u32 s8, s28, 0x9800
v_mfma_f32_16x16x32_bf16 v[76:79], a[92:95], a[56:59], v[76:79]
buffer_store_dwordx4 a[232:235], v16, s[88:91], s8 offen sc1
v_mfma_f32_16x16x32_bf16 v[76:79], a[88:91], a[40:43], v[76:79]
ds_read_b64_tr_b16 a[84:85], v12 offset:8960
v_mfma_f32_16x16x32_bf16 v[68:71], a[88:91], a[36:39], v[68:71]
ds_read_b64_tr_b16 a[86:87], v12 offset:9984
v_mfma_f32_16x16x32_bf16 v[68:71], a[92:95], a[52:55], v[68:71]
v_mfma_f32_16x16x32_bf16 v[60:63], a[92:95], a[48:51], v[60:63]
v_mfma_f32_16x16x32_bf16 v[60:63], a[88:91], a[32:35], v[60:63]
s_add_u32 m0, s16, 0x0
s_waitcnt lgkmcnt(4)
s_waitcnt lgkmcnt(7)
v_mfma_f32_16x16x32_bf16 v[88:91], a[96:99], a[32:35], v[88:91]
buffer_load_dwordx4 v22, s[44:47], s20 offen lds
v_mfma_f32_16x16x32_bf16 v[88:91], a[100:103], a[48:51], v[88:91]
ds_read_b64_tr_b16 a[88:89], v13 offset:768
v_mfma_f32_16x16x32_bf16 v[96:99], a[100:103], a[52:55], v[96:99]
ds_read_b64_tr_b16 a[90:91], v13 offset:1792
v_mfma_f32_16x16x32_bf16 v[96:99], a[96:99], a[36:39], v[96:99]
ds_read_b64_tr_b16 a[92:93], v13 offset:8960
v_mfma_f32_16x16x32_bf16 v[104:107], a[96:99], a[40:43], v[104:107]
ds_read_b64_tr_b16 a[94:95], v13 offset:9984
s_add_u32 m0, s16, 0x400
v_mfma_f32_16x16x32_bf16 v[104:107], a[100:103], a[56:59], v[104:107]
buffer_load_dwordx4 v23, s[44:47], s20 offen lds
v_mfma_f32_16x16x32_bf16 v[112:115], a[100:103], a[60:63], v[112:115]
v_mfma_f32_16x16x32_bf16 v[112:115], a[96:99], a[44:47], v[112:115]
v_mfma_f32_16x16x32_bf16 v[116:119], a[104:107], a[44:47], v[116:119]
ds_read_b64_tr_b16 a[96:97], v14 offset:0
v_mfma_f32_16x16x32_bf16 v[116:119], a[108:111], a[60:63], v[116:119]
ds_read_b64_tr_b16 a[98:99], v14 offset:256
v_mfma_f32_16x16x32_bf16 v[108:111], a[108:111], a[56:59], v[108:111]
ds_read_b64_tr_b16 a[100:101], v14 offset:2048
s_add_u32 m0, s16, 0x800
v_mfma_f32_16x16x32_bf16 v[108:111], a[104:107], a[40:43], v[108:111]
buffer_load_dwordx4 v22, s[44:47], s21 offen lds
v_mfma_f32_16x16x32_bf16 v[100:103], a[104:107], a[36:39], v[100:103]
ds_read_b64_tr_b16 a[102:103], v14 offset:2304
v_mfma_f32_16x16x32_bf16 v[100:103], a[108:111], a[52:55], v[100:103]
v_mfma_f32_16x16x32_bf16 v[92:95], a[108:111], a[48:51], v[92:95]
v_mfma_f32_16x16x32_bf16 v[92:95], a[104:107], a[32:35], v[92:95]
s_add_u32 m0, s16, 0xc00
s_waitcnt lgkmcnt(4)
v_mfma_f32_16x16x32_bf16 v[120:123], a[80:83], a[32:35], v[120:123]
buffer_load_dwordx4 v23, s[44:47], s21 offen lds
v_mfma_f32_16x16x32_bf16 v[120:123], a[84:87], a[48:51], v[120:123]
ds_read_b64_tr_b16 a[104:105], v15 offset:0
v_mfma_f32_16x16x32_bf16 v[128:131], a[84:87], a[52:55], v[128:131]
ds_read_b64_tr_b16 a[106:107], v15 offset:256
v_mfma_f32_16x16x32_bf16 v[128:131], a[80:83], a[36:39], v[128:131]
ds_read_b64_tr_b16 a[108:109], v15 offset:2048
v_mfma_f32_16x16x32_bf16 v[136:139], a[80:83], a[40:43], v[136:139]
ds_read_b64_tr_b16 a[110:111], v15 offset:2304
v_mfma_f32_16x16x32_bf16 v[136:139], a[84:87], a[56:59], v[136:139]
s_add_u32 s8, s28, 0x5c00
v_mfma_f32_16x16x32_bf16 v[144:147], a[84:87], a[60:63], v[144:147]
buffer_store_dwordx4 a[240:243], v16, s[88:91], s8 offen sc1
v_mfma_f32_16x16x32_bf16 v[144:147], a[80:83], a[44:47], v[144:147]
v_mfma_f32_16x16x32_bf16 v[148:151], a[88:91], a[44:47], v[148:151]
ds_read_b64_tr_b16 a[80:81], v14 offset:4096
v_mfma_f32_16x16x32_bf16 v[148:151], a[92:95], a[60:63], v[148:151]
ds_read_b64_tr_b16 a[82:83], v14 offset:4352
v_mfma_f32_16x16x32_bf16 v[140:143], a[92:95], a[56:59], v[140:143]
ds_read_b64_tr_b16 a[84:85], v14 offset:6144
v_mfma_f32_16x16x32_bf16 v[140:143], a[88:91], a[40:43], v[140:143]
ds_read_b64_tr_b16 a[86:87], v14 offset:6400
s_add_u32 m0, s16, 0x1000
v_mfma_f32_16x16x32_bf16 v[132:135], a[88:91], a[36:39], v[132:135]
buffer_load_dwordx4 v22, s[44:47], s22 offen lds
v_mfma_f32_16x16x32_bf16 v[132:135], a[92:95], a[52:55], v[132:135]
v_mfma_f32_16x16x32_bf16 v[124:127], a[92:95], a[48:51], v[124:127]
v_mfma_f32_16x16x32_bf16 v[124:127], a[88:91], a[32:35], v[124:127]
s_waitcnt lgkmcnt(4)
v_mfma_f32_16x16x32_bf16 v[152:155], a[96:99], a[32:35], v[152:155]
ds_read_b64_tr_b16 a[88:89], v15 offset:4096
s_add_u32 m0, s16, 0x1400
v_mfma_f32_16x16x32_bf16 v[152:155], a[100:103], a[48:51], v[152:155]
buffer_load_dwordx4 v23, s[44:47], s22 offen lds
v_mfma_f32_16x16x32_bf16 v[160:163], a[100:103], a[52:55], v[160:163]
ds_read_b64_tr_b16 a[90:91], v15 offset:4352
v_mfma_f32_16x16x32_bf16 v[160:163], a[96:99], a[36:39], v[160:163]
ds_read_b64_tr_b16 a[92:93], v15 offset:6144
v_mfma_f32_16x16x32_bf16 v[168:171], a[96:99], a[40:43], v[168:171]
ds_read_b64_tr_b16 a[94:95], v15 offset:6400
v_mfma_f32_16x16x32_bf16 v[168:171], a[100:103], a[56:59], v[168:171]
v_mfma_f32_16x16x32_bf16 v[176:179], a[100:103], a[60:63], v[176:179]
s_add_u32 m0, s16, 0x1800
v_mfma_f32_16x16x32_bf16 v[176:179], a[96:99], a[44:47], v[176:179]
buffer_load_dwordx4 v22, s[44:47], s23 offen lds
v_mfma_f32_16x16x32_bf16 v[180:183], a[104:107], a[44:47], v[180:183]
ds_read_b64_tr_b16 a[96:97], v14 offset:8192
v_mfma_f32_16x16x32_bf16 v[180:183], a[108:111], a[60:63], v[180:183]
ds_read_b64_tr_b16 a[98:99], v14 offset:8448
v_mfma_f32_16x16x32_bf16 v[172:175], a[108:111], a[56:59], v[172:175]
ds_read_b64_tr_b16 a[100:101], v14 offset:10240
v_mfma_f32_16x16x32_bf16 v[172:175], a[104:107], a[40:43], v[172:175]
ds_read_b64_tr_b16 a[102:103], v14 offset:10496
s_add_u32 m0, s16, 0x1c00
v_mfma_f32_16x16x32_bf16 v[164:167], a[104:107], a[36:39], v[164:167]
buffer_load_dwordx4 v23, s[44:47], s23 offen lds
v_mfma_f32_16x16x32_bf16 v[164:167], a[108:111], a[52:55], v[164:167]
v_lshl_add_u32 v22, s42, 7, v22
v_lshl_add_u32 v23, s42, 7, v23
v_mfma_f32_16x16x32_bf16 v[156:159], a[108:111], a[48:51], v[156:159]
v_mfma_f32_16x16x32_bf16 v[156:159], a[104:107], a[32:35], v[156:159]
s_waitcnt lgkmcnt(4)
v_mfma_f32_16x16x32_bf16 v[184:187], a[80:83], a[32:35], v[184:187]
ds_read_b64_tr_b16 a[104:105], v15 offset:8192
v_mfma_f32_16x16x32_bf16 v[184:187], a[84:87], a[48:51], v[184:187]
ds_read_b64_tr_b16 a[106:107], v15 offset:8448
s_add_u32 s8, s28, 0x9c00
v_mfma_f32_16x16x32_bf16 v[192:195], a[84:87], a[52:55], v[192:195]
buffer_store_dwordx4 a[248:251], v16, s[88:91], s8 offen sc1
v_mfma_f32_16x16x32_bf16 v[192:195], a[80:83], a[36:39], v[192:195]
ds_read_b64_tr_b16 a[108:109], v15 offset:10240
v_mfma_f32_16x16x32_bf16 v[200:203], a[80:83], a[40:43], v[200:203]
ds_read_b64_tr_b16 a[110:111], v15 offset:10496
v_add_u32 v12, 0xffff0000, v12
v_mfma_f32_16x16x32_bf16 v[200:203], a[84:87], a[56:59], v[200:203]
v_add_u32 v13, 0xffff0000, v13
v_add_u32 v14, 0xffff0000, v14
v_mfma_f32_16x16x32_bf16 v[208:211], a[84:87], a[60:63], v[208:211]
v_add_u32 v15, 0xffff0000, v15
v_mfma_f32_16x16x32_bf16 v[208:211], a[80:83], a[44:47], v[208:211]
v_mfma_f32_16x16x32_bf16 v[212:215], a[88:91], a[44:47], v[212:215]
s_waitcnt vmcnt(29) lgkmcnt(0)
v_mfma_f32_16x16x32_bf16 v[212:215], a[92:95], a[60:63], v[212:215]
s_barrier
s_add_u32 m0, s17, 0x10000
v_mfma_f32_16x16x32_bf16 v[204:207], a[92:95], a[56:59], v[204:207]
buffer_load_dwordx4 v5, s[52:55], 0 offen lds
v_mfma_f32_16x16x32_bf16 v[204:207], a[88:91], a[40:43], v[204:207]
ds_read_b64_tr_b16 a[80:81], v12 offset:0
v_mfma_f32_16x16x32_bf16 v[196:199], a[88:91], a[36:39], v[196:199]
ds_read_b64_tr_b16 a[82:83], v12 offset:1024
v_mfma_f32_16x16x32_bf16 v[196:199], a[92:95], a[52:55], v[196:199]
ds_read_b64_tr_b16 a[84:85], v12 offset:8192
v_mfma_f32_16x16x32_bf16 v[188:191], a[92:95], a[48:51], v[188:191]
ds_read_b64_tr_b16 a[86:87], v12 offset:9216
v_mfma_f32_16x16x32_bf16 v[188:191], a[88:91], a[32:35], v[188:191]
s_add_u32 m0, s17, 0x10400
s_waitcnt lgkmcnt(4)
v_mfma_f32_16x16x32_bf16 v[216:219], a[32:35], a[96:99], v[216:219]
buffer_load_dwordx4 v5, s[52:55], s13 offen lds
v_mfma_f32_16x16x32_bf16 v[216:219], a[48:51], a[100:103], v[216:219]
ds_read_b64_tr_b16 a[88:89], v13 offset:0
v_mfma_f32_16x16x32_bf16 v[224:227], a[52:55], a[100:103], v[224:227]
ds_read_b64_tr_b16 a[90:91], v13 offset:1024
v_mfma_f32_16x16x32_bf16 v[224:227], a[36:39], a[96:99], v[224:227]
ds_read_b64_tr_b16 a[92:93], v13 offset:8192
v_mfma_f32_16x16x32_bf16 v[232:235], a[40:43], a[96:99], v[232:235]
ds_read_b64_tr_b16 a[94:95], v13 offset:9216
v_mfma_f32_16x16x32_bf16 v[232:235], a[56:59], a[100:103], v[232:235]
s_add_u32 m0, s17, 0x10800
v_mfma_f32_16x16x32_bf16 v[240:243], a[60:63], a[100:103], v[240:243]
buffer_load_dwordx4 v6, s[52:55], 0 offen lds
v_mfma_f32_16x16x32_bf16 v[240:243], a[44:47], a[96:99], v[240:243]
v_mfma_f32_16x16x32_bf16 v[244:247], a[44:47], a[104:107], v[244:247]
ds_read_b64_tr_b16 a[96:97], v12 offset:256
v_mfma_f32_16x16x32_bf16 v[244:247], a[60:63], a[108:111], v[244:247]
ds_read_b64_tr_b16 a[98:99], v12 offset:1280
v_mfma_f32_16x16x32_bf16 v[236:239], a[56:59], a[108:111], v[236:239]
ds_read_b64_tr_b16 a[100:101], v12 offset:8448
v_mfma_f32_16x16x32_bf16 v[236:239], a[40:43], a[104:107], v[236:239]
ds_read_b64_tr_b16 a[102:103], v12 offset:9472
v_mfma_f32_16x16x32_bf16 v[228:231], a[36:39], a[104:107], v[228:231]
buffer_load_dwordx4 a[128:131], v16, s[44:47], s100 offen offset:0
v_mfma_f32_16x16x32_bf16 v[228:231], a[52:55], a[108:111], v[228:231]
v_mfma_f32_16x16x32_bf16 v[220:223], a[48:51], a[108:111], v[220:223]
L_padA9:
s_cmp_eq_u32 s95, 1
s_cbranch_scc1 L_hopA_ret
v_mfma_f32_16x16x32_bf16 v[220:223], a[32:35], a[104:107], v[220:223]
s_waitcnt lgkmcnt(4)
L_S18:
v_mfma_f32_16x16x32_bf16 v[24:27], a[80:83], a[0:3], v[24:27]
ds_read_b64_tr_b16 a[104:105], v13 offset:256
s_waitcnt vmcnt(24)
v_mfma_f32_16x16x32_bf16 v[24:27], a[84:87], a[16:19], v[24:27]
ds_read_b64_tr_b16 a[106:107], v13 offset:1280
s_add_u32 m0, s17, 0x10c00
v_mfma_f32_16x16x32_bf16 v[32:35], a[84:87], a[20:23], v[32:35]
buffer_load_dwordx4 v6, s[52:55], s13 offen lds
v_mfma_f32_16x16x32_bf16 v[32:35], a[80:83], a[4:7], v[32:35]
ds_read_b64_tr_b16 a[108:109], v13 offset:8448
v_mfma_f32_16x16x32_bf16 v[40:43], a[80:83], a[8:11], v[40:43]
ds_read_b64_tr_b16 a[110:111], v13 offset:9472
v_mfma_f32_16x16x32_bf16 v[40:43], a[84:87], a[24:27], v[40:43]
ds_read_b128 a[32:35], v8 offset:32768
v_mfma_f32_16x16x32_bf16 v[48:51], a[84:87], a[28:31], v[48:51]
ds_read_b128 a[48:51], v9 offset:32768
v_mfma_f32_16x16x32_bf16 v[48:51], a[80:83], a[12:15], v[48:51]
ds_read_b128 a[36:39], v8 offset:34816
s_add_u32 m0, s18, 0x14000
v_mfma_f32_16x16x32_bf16 v[52:55], a[88:91], a[12:15], v[52:55]
buffer_load_dwordx4 v7, s[68:71], 0 offen lds
v_mfma_f32_16x16x32_bf16 v[52:55], a[92:95], a[28:31], v[52:55]
ds_read_b64_tr_b16 a[80:81], v12 offset:512
v_mfma_f32_16x16x32_bf16 v[44:47], a[92:95], a[24:27], v[44:47]
ds_read_b64_tr_b16 a[82:83], v12 offset:1536
v_mfma_f32_16x16x32_bf16 v[44:47], a[88:91], a[8:11], v[44:47]
ds_read_b64_tr_b16 a[84:85], v12 offset:8704
v_mfma_f32_16x16x32_bf16 v[36:39], a[88:91], a[4:7], v[36:39]
ds_read_b64_tr_b16 a[86:87], v12 offset:9728
v_mfma_f32_16x16x32_bf16 v[36:39], a[92:95], a[20:23], v[36:39]
ds_read_b128 a[52:55], v9 offset:34816
s_add_u32 m0, s18, 0x15000
v_mfma_f32_16x16x32_bf16 v[28:31], a[92:95], a[16:19], v[28:31]
buffer_load_dwordx4 v7, s[68:71], s25 offen lds
v_mfma_f32_16x16x32_bf16 v[28:31], a[88:91], a[0:3], v[28:31]
ds_read_b128 a[40:43], v8 offset:36864
s_waitcnt lgkmcnt(9)
v_mfma_f32_16x16x32_bf16 v[56:59], a[96:99], a[0:3], v[56:59]
ds_read_b64_tr_b16 a[88:89], v13 offset:512
v_mfma_f32_16x16x32_bf16 v[56:59], a[100:103], a[16:19], v[56:59]
ds_read_b64_tr_b16 a[90:91], v13 offset:1536
v_mfma_f32_16x16x32_bf16 v[64:67], a[100:103], a[20:23], v[64:67]
ds_read_b64_tr_b16 a[92:93], v13 offset:8704
v_mfma_f32_16x16x32_bf16 v[64:67], a[96:99], a[4:7], v[64:67]
ds_read_b64_tr_b16 a[94:95], v13 offset:9728
s_add_u32 m0, s18, 0x16000
v_mfma_f32_16x16x32_bf16 v[72:75], a[96:99], a[8:11], v[72:75]
buffer_load_dwordx4 v7, s[68:71], s26 offen lds
v_mfma_f32_16x16x32_bf16 v[72:75], a[100:103], a[24:27], v[72:75]
ds_read_b128 a[56:59], v9 offset:36864
v_lshl_add_u32 v5, s42, 19, v5
v_mfma_f32_16x16x32_bf16 v[80:83], a[100:103], a[28:31], v[80:83]
ds_read_b128 a[44:47], v8 offset:38912
v_lshl_add_u32 v6, s42, 19, v6
v_mfma_f32_16x16x32_bf16 v[80:83], a[96:99], a[12:15], v[80:83]
ds_read_b128 a[60:63], v9 offset:38912
v_lshl_add_u32 v7, s42, 18, v7
v_mfma_f32_16x16x32_bf16 v[84:87], a[104:107], a[12:15], v[84:87]
ds_read_b64_tr_b16 a[96:97], v12 offset:768
v_lshl_add_u32 v7, s42, 17, v7
v_mfma_f32_16x16x32_bf16 v[84:87], a[108:111], a[28:31], v[84:87]
ds_read_b64_tr_b16 a[98:99], v12 offset:1792
v_mfma_f32_16x16x32_bf16 v[76:79], a[108:111], a[24:27], v[76:79]
buffer_load_dwordx4 a[132:135], v16, s[44:47], s100 offen offset:1024
v_mfma_f32_16x16x32_bf16 v[76:79], a[104:107], a[8:11], v[76:79]
ds_read_b64_tr_b16 a[100:101], v12 offset:8960
v_mfma_f32_16x16x32_bf16 v[68:71], a[104:107], a[4:7], v[68:71]
ds_read_b64_tr_b16 a[102:103], v12 offset:9984
v_mfma_f32_16x16x32_bf16 v[68:71], a[108:111], a[20:23], v[68:71]
v_mfma_f32_16x16x32_bf16 v[60:63], a[108:111], a[16:19], v[60:63]
v_mfma_f32_16x16x32_bf16 v[60:63], a[104:107], a[0:3], v[60:63]
s_add_u32 m0, s16, 0x8000
s_waitcnt lgkmcnt(4)
s_waitcnt lgkmcnt(7)
v_mfma_f32_16x16x32_bf16 v[88:91], a[80:83], a[0:3], v[88:91]
buffer_load_dwordx4 v22, s[44:47], s20 offen lds
v_mfma_f32_16x16x32_bf16 v[88:91], a[84:87], a[16:19], v[88:91]
ds_read_b64_tr_b16 a[104:105], v13 offset:768
v_mfma_f32_16x16x32_bf16 v[96:99], a[84:87], a[20:23], v[96:99]
ds_read_b64_tr_b16 a[106:107], v13 offset:1792
v_mfma_f32_16x16x32_bf16 v[96:99], a[80:83], a[4:7], v[96:99]
ds_read_b64_tr_b16 a[108:109], v13 offset:8960
v_mfma_f32_16x16x32_bf16 v[104:107], a[80:83], a[8:11], v[104:107]
ds_read_b64_tr_b16 a[110:111], v13 offset:9984
s_add_u32 m0, s16, 0x8400
v_mfma_f32_16x16x32_bf16 v[104:107], a[84:87], a[24:27], v[104:107]
buffer_load_dwordx4 v23, s[44:47], s20 offen lds
v_mfma_f32_16x16x32_bf16 v[112:115], a[84:87], a[28:31], v[112:115]
v_mfma_f32_16x16x32_bf16 v[112:115], a[80:83], a[12:15], v[112:115]
v_mfma_f32_16x16x32_bf16 v[116:119], a[88:91], a[12:15], v[116:119]
ds_read_b64_tr_b16 a[80:81], v14 offset:0
v_mfma_f32_16x16x32_bf16 v[116:119], a[92:95], a[28:31], v[116:119]
ds_read_b64_tr_b16 a[82:83], v14 offset:256
v_mfma_f32_16x16x32_bf16 v[108:111], a[92:95], a[24:27], v[108:111]
ds_read_b64_tr_b16 a[84:85], v14 offset:2048
s_add_u32 m0, s16, 0x8800
v_mfma_f32_16x16x32_bf16 v[108:111], a[88:91], a[8:11], v[108:111]
buffer_load_dwordx4 v22, s[44:47], s21 offen lds
v_mfma_f32_16x16x32_bf16 v[100:103], a[88:91], a[4:7], v[100:103]
ds_read_b64_tr_b16 a[86:87], v14 offset:2304
v_mfma_f32_16x16x32_bf16 v[100:103], a[92:95], a[20:23], v[100:103]
v_mfma_f32_16x16x32_bf16 v[92:95], a[92:95], a[16:19], v[92:95]
v_mfma_f32_16x16x32_bf16 v[92:95], a[88:91], a[0:3], v[92:95]
s_add_u32 m0, s16, 0x8c00
s_waitcnt lgkmcnt(4)
v_mfma_f32_16x16x32_bf16 v[120:123], a[96:99], a[0:3], v[120:123]
buffer_load_dwordx4 v23, s[44:47], s21 offen lds
v_mfma_f32_16x16x32_bf16 v[120:123], a[100:103], a[16:19], v[120:123]
ds_read_b64_tr_b16 a[88:89], v15 offset:0
v_mfma_f32_16x16x32_bf16 v[128:131], a[100:103], a[20:23], v[128:131]
ds_read_b64_tr_b16 a[90:91], v15 offset:256
v_mfma_f32_16x16x32_bf16 v[128:131], a[96:99], a[4:7], v[128:131]
ds_read_b64_tr_b16 a[92:93], v15 offset:2048
v_mfma_f32_16x16x32_bf16 v[136:139], a[96:99], a[8:11], v[136:139]
ds_read_b64_tr_b16 a[94:95], v15 offset:2304
v_mfma_f32_16x16x32_bf16 v[136:139], a[100:103], a[24:27], v[136:139]
v_mfma_f32_16x16x32_bf16 v[144:147], a[100:103], a[28:31], v[144:147]
buffer_load_dwordx4 a[136:139], v16, s[44:47], s100 offen offset:2048
v_mfma_f32_16x16x32_bf16 v[144:147], a[96:99], a[12:15], v[144:147]
v_mfma_f32_16x16x32_bf16 v[148:151], a[104:107], a[12:15], v[148:151]
ds_read_b64_tr_b16 a[96:97], v14 offset:4096
v_mfma_f32_16x16x32_bf16 v[148:151], a[108:111], a[28:31], v[148:151]
ds_read_b64_tr_b16 a[98:99], v14 offset:4352
v_mfma_f32_16x16x32_bf16 v[140:143], a[108:111], a[24:27], v[140:143]
ds_read_b64_tr_b16 a[100:101], v14 offset:6144
v_mfma_f32_16x16x32_bf16 v[140:143], a[104:107], a[8:11], v[140:143]
ds_read_b64_tr_b16 a[102:103], v14 offset:6400
s_add_u32 m0, s16, 0x9000
v_mfma_f32_16x16x32_bf16 v[132:135], a[104:107], a[4:7], v[132:135]
buffer_load_dwordx4 v22, s[44:47], s22 offen lds
v_mfma_f32_16x16x32_bf16 v[132:135], a[108:111], a[20:23], v[132:135]
v_mfma_f32_16x16x32_bf16 v[124:127], a[108:111], a[16:19], v[124:127]
v_mfma_f32_16x16x32_bf16 v[124:127], a[104:107], a[0:3], v[124:127]
s_waitcnt lgkmcnt(4)
v_mfma_f32_16x16x32_bf16 v[152:155], a[80:83], a[0:3], v[152:155]
ds_read_b64_tr_b16 a[104:105], v15 offset:4096
s_add_u32 m0, s16, 0x9400
v_mfma_f32_16x16x32_bf16 v[152:155], a[84:87], a[16:19], v[152:155]
buffer_load_dwordx4 v23, s[44:47], s22 offen lds
v_mfma_f32_16x16x32_bf16 v[160:163], a[84:87], a[20:23], v[160:163]
ds_read_b64_tr_b16 a[106:107], v15 offset:4352
v_mfma_f32_16x16x32_bf16 v[160:163], a[80:83], a[4:7], v[160:163]
ds_read_b64_tr_b16 a[108:109], v15 offset:6144
v_mfma_f32_16x16x32_bf16 v[168:171], a[80:83], a[8:11], v[168:171]
ds_read_b64_tr_b16 a[110:111], v15 offset:6400
v_mfma_f32_16x16x32_bf16 v[168:171], a[84:87], a[24:27], v[168:171]
v_mfma_f32_16x16x32_bf16 v[176:179], a[84:87], a[28:31], v[176:179]
s_add_u32 m0, s16, 0x9800
v_mfma_f32_16x16x32_bf16 v[176:179], a[80:83], a[12:15], v[176:179]
buffer_load_dwordx4 v22, s[44:47], s23 offen lds
v_mfma_f32_16x16x32_bf16 v[180:183], a[88:91], a[12:15], v[180:183]
ds_read_b64_tr_b16 a[80:81], v14 offset:8192
v_mfma_f32_16x16x32_bf16 v[180:183], a[92:95], a[28:31], v[180:183]
ds_read_b64_tr_b16 a[82:83], v14 offset:8448
v_mfma_f32_16x16x32_bf16 v[172:175], a[92:95], a[24:27], v[172:175]
ds_read_b64_tr_b16 a[84:85], v14 offset:10240
v_mfma_f32_16x16x32_bf16 v[172:175], a[88:91], a[8:11], v[172:175]
ds_read_b64_tr_b16 a[86:87], v14 offset:10496
s_add_u32 m0, s16, 0x9c00
v_mfma_f32_16x16x32_bf16 v[164:167], a[88:91], a[4:7], v[164:167]
buffer_load_dwordx4 v23, s[44:47], s23 offen lds
v_mfma_f32_16x16x32_bf16 v[164:167], a[92:95], a[20:23], v[164:167]
v_lshl_add_u32 v22, s42, 7, v22
v_lshl_add_u32 v23, s42, 7, v23
v_mfma_f32_16x16x32_bf16 v[156:159], a[92:95], a[16:19], v[156:159]
v_mfma_f32_16x16x32_bf16 v[156:159], a[88:91], a[0:3], v[156:159]
s_waitcnt lgkmcnt(4)
v_mfma_f32_16x16x32_bf16 v[184:187], a[96:99], a[0:3], v[184:187]
ds_read_b64_tr_b16 a[88:89], v15 offset:8192
v_mov_b32 v21, s1
v_mfma_f32_16x16x32_bf16 v[184:187], a[100:103], a[16:19], v[184:187]
ds_read_b64_tr_b16 a[90:91], v15 offset:8448
v_add_u32 v20, s0, v16
v_mfma_f32_16x16x32_bf16 v[192:195], a[100:103], a[20:23], v[192:195]
global_load_dword a120, v[20:21], off sc1
v_mfma_f32_16x16x32_bf16 v[192:195], a[96:99], a[4:7], v[192:195]
ds_read_b64_tr_b16 a[92:93], v15 offset:10240
v_mfma_f32_16x16x32_bf16 v[200:203], a[96:99], a[8:11], v[200:203]
ds_read_b64_tr_b16 a[94:95], v15 offset:10496
v_add_u32 v12, 0x8000, v12
v_mfma_f32_16x16x32_bf16 v[200:203], a[100:103], a[24:27], v[200:203]
v_add_u32 v13, 0x8000, v13
v_add_u32 v14, 0x8000, v14
v_mfma_f32_16x16x32_bf16 v[208:211], a[100:103], a[28:31], v[208:211]
v_add_u32 v15, 0x8000, v15
v_mfma_f32_16x16x32_bf16 v[208:211], a[96:99], a[12:15], v[208:211]
v_mfma_f32_16x16x32_bf16 v[212:215], a[104:107], a[12:15], v[212:215]
s_waitcnt vmcnt(19) lgkmcnt(0)
v_mfma_f32_16x16x32_bf16 v[212:215], a[108:111], a[28:31], v[212:215]
s_barrier
s_add_u32 m0, s17, 0x0
s_cmp_lg_u32 s4, 0
s_cbranch_scc1 L_sig_kv
v_mov_b32 v20, 1
s_mov_b64 exec, 1
buffer_atomic_add v20, off, s[84:87], s10 sc1
s_mov_b64 exec, -1
L_sig_kv:
v_mfma_f32_16x16x32_bf16 v[204:207], a[108:111], a[24:27], v[204:207]
buffer_load_dwordx4 v5, s[52:55], 0 offen lds
v_mfma_f32_16x16x32_bf16 v[204:207], a[104:107], a[8:11], v[204:207]
ds_read_b64_tr_b16 a[96:97], v12 offset:0
v_mfma_f32_16x16x32_bf16 v[196:199], a[104:107], a[4:7], v[196:199]
ds_read_b64_tr_b16 a[98:99], v12 offset:1024
v_mfma_f32_16x16x32_bf16 v[196:199], a[108:111], a[20:23], v[196:199]
ds_read_b64_tr_b16 a[100:101], v12 offset:8192
v_mfma_f32_16x16x32_bf16 v[188:191], a[108:111], a[16:19], v[188:191]
ds_read_b64_tr_b16 a[102:103], v12 offset:9216
v_mfma_f32_16x16x32_bf16 v[188:191], a[104:107], a[0:3], v[188:191]
s_add_u32 m0, s17, 0x400
s_waitcnt lgkmcnt(4)
v_mfma_f32_16x16x32_bf16 v[216:219], a[0:3], a[80:83], v[216:219]
buffer_load_dwordx4 v5, s[52:55], s13 offen lds
v_mfma_f32_16x16x32_bf16 v[216:219], a[16:19], a[84:87], v[216:219]
ds_read_b64_tr_b16 a[104:105], v13 offset:0
v_mfma_f32_16x16x32_bf16 v[224:227], a[20:23], a[84:87], v[224:227]
ds_read_b64_tr_b16 a[106:107], v13 offset:1024
v_mfma_f32_16x16x32_bf16 v[224:227], a[4:7], a[80:83], v[224:227]
ds_read_b64_tr_b16 a[108:109], v13 offset:8192
v_mfma_f32_16x16x32_bf16 v[232:235], a[8:11], a[80:83], v[232:235]
ds_read_b64_tr_b16 a[110:111], v13 offset:9216
v_mfma_f32_16x16x32_bf16 v[232:235], a[24:27], a[84:87], v[232:235]
v_mfma_f32_16x16x32_bf16 v[240:243], a[28:31], a[84:87], v[240:243]
s_add_u32 m0, s17, 0x800
v_mfma_f32_16x16x32_bf16 v[240:243], a[12:15], a[80:83], v[240:243]
buffer_load_dwordx4 v6, s[52:55], 0 offen lds
v_mfma_f32_16x16x32_bf16 v[244:247], a[12:15], a[88:91], v[244:247]
ds_read_b64_tr_b16 a[80:81], v12 offset:256
v_mfma_f32_16x16x32_bf16 v[244:247], a[28:31], a[92:95], v[244:247]
ds_read_b64_tr_b16 a[82:83], v12 offset:1280
v_mfma_f32_16x16x32_bf16 v[236:239], a[24:27], a[92:95], v[236:239]
ds_read_b64_tr_b16 a[84:85], v12 offset:8448
v_mfma_f32_16x16x32_bf16 v[236:239], a[8:11], a[88:91], v[236:239]
ds_read_b64_tr_b16 a[86:87], v12 offset:9472
v_mfma_f32_16x16x32_bf16 v[228:231], a[4:7], a[88:91], v[228:231]
v_mfma_f32_16x16x32_bf16 v[228:231], a[20:23], a[92:95], v[228:231]
s_add_u32 m0, s17, 0xc00
v_mfma_f32_16x16x32_bf16 v[220:223], a[16:19], a[92:95], v[220:223]
buffer_load_dwordx4 v6, s[52:55], s13 offen lds
v_mfma_f32_16x16x32_bf16 v[220:223], a[0:3], a[88:91], v[220:223]
s_waitcnt lgkmcnt(4)
L_S19:
v_mfma_f32_16x16x32_bf16 v[24:27], a[96:99], a[32:35], v[24:27]
ds_read_b64_tr_b16 a[88:89], v13 offset:256
s_waitcnt vmcnt(24)
v_mfma_f32_16x16x32_bf16 v[24:27], a[100:103], a[48:51], v[24:27]
ds_read_b64_tr_b16 a[90:91], v13 offset:1280
v_mfma_f32_16x16x32_bf16 v[32:35], a[100:103], a[52:55], v[32:35]
ds_read_b64_tr_b16 a[92:93], v13 offset:8448
v_mfma_f32_16x16x32_bf16 v[32:35], a[96:99], a[36:39], v[32:35]
ds_read_b64_tr_b16 a[94:95], v13 offset:9472
v_mfma_f32_16x16x32_bf16 v[40:43], a[96:99], a[40:43], v[40:43]
ds_read_b128 a[0:3], v8 offset:0
s_add_u32 m0, s18, 0x4000
v_mfma_f32_16x16x32_bf16 v[40:43], a[100:103], a[56:59], v[40:43]
buffer_load_dwordx4 v7, s[68:71], 0 offen lds
v_mfma_f32_16x16x32_bf16 v[48:51], a[100:103], a[60:63], v[48:51]
ds_read_b128 a[16:19], v9 offset:0
v_mfma_f32_16x16x32_bf16 v[48:51], a[96:99], a[44:47], v[48:51]
ds_read_b128 a[4:7], v8 offset:2048
v_mfma_f32_16x16x32_bf16 v[52:55], a[104:107], a[44:47], v[52:55]
ds_read_b64_tr_b16 a[96:97], v12 offset:512
v_mfma_f32_16x16x32_bf16 v[52:55], a[108:111], a[60:63], v[52:55]
ds_read_b64_tr_b16 a[98:99], v12 offset:1536
v_mfma_f32_16x16x32_bf16 v[44:47], a[108:111], a[56:59], v[44:47]
ds_read_b64_tr_b16 a[100:101], v12 offset:8704
v_mfma_f32_16x16x32_bf16 v[44:47], a[104:107], a[40:43], v[44:47]
buffer_load_dwordx4 a[140:143], v16, s[44:47], s100 offen offset:3072
v_mfma_f32_16x16x32_bf16 v[36:39], a[104:107], a[36:39], v[36:39]
ds_read_b64_tr_b16 a[102:103], v12 offset:9728
v_mfma_f32_16x16x32_bf16 v[36:39], a[108:111], a[52:55], v[36:39]
ds_read_b128 a[20:23], v9 offset:2048
v_mfma_f32_16x16x32_bf16 v[28:31], a[108:111], a[48:51], v[28:31]
ds_read_b128 a[8:11], v8 offset:4096
v_mfma_f32_16x16x32_bf16 v[28:31], a[104:107], a[32:35], v[28:31]
ds_read_b128 a[24:27], v9 offset:4096
s_waitcnt lgkmcnt(10)
v_mfma_f32_16x16x32_bf16 v[56:59], a[80:83], a[32:35], v[56:59]
ds_read_b64_tr_b16 a[104:105], v13 offset:512
v_mfma_f32_16x16x32_bf16 v[56:59], a[84:87], a[48:51], v[56:59]
ds_read_b64_tr_b16 a[106:107], v13 offset:1536
s_add_u32 m0, s18, 0x5000
v_mfma_f32_16x16x32_bf16 v[64:67], a[84:87], a[52:55], v[64:67]
buffer_load_dwordx4 v7, s[68:71], s25 offen lds
v_mfma_f32_16x16x32_bf16 v[64:67], a[80:83], a[36:39], v[64:67]
ds_read_b64_tr_b16 a[108:109], v13 offset:8704
v_mfma_f32_16x16x32_bf16 v[72:75], a[80:83], a[40:43], v[72:75]
ds_read_b64_tr_b16 a[110:111], v13 offset:9728
v_mfma_f32_16x16x32_bf16 v[72:75], a[84:87], a[56:59], v[72:75]
ds_read_b128 a[12:15], v8 offset:6144
v_mfma_f32_16x16x32_bf16 v[80:83], a[84:87], a[60:63], v[80:83]
ds_read_b128 a[28:31], v9 offset:6144
v_mfma_f32_16x16x32_bf16 v[80:83], a[80:83], a[44:47], v[80:83]
v_mfma_f32_16x16x32_bf16 v[84:87], a[88:91], a[44:47], v[84:87]
ds_read_b64_tr_b16 a[80:81], v12 offset:768
s_add_u32 m0, s18, 0x6000
v_mfma_f32_16x16x32_bf16 v[84:87], a[92:95], a[60:63], v[84:87]
buffer_load_dwordx4 v7, s[68:71], s26 offen lds
v_mfma_f32_16x16x32_bf16 v[76:79], a[92:95], a[56:59], v[76:79]
ds_read_b64_tr_b16 a[82:83], v12 offset:1792
v_lshl_add_u32 v5, s42, 19, v5
v_mfma_f32_16x16x32_bf16 v[76:79], a[88:91], a[40:43], v[76:79]
ds_read_b64_tr_b16 a[84:85], v12 offset:8960
v_lshl_add_u32 v6, s42, 19, v6
v_mfma_f32_16x16x32_bf16 v[68:71], a[88:91], a[36:39], v[68:71]
ds_read_b64_tr_b16 a[86:87], v12 offset:9984
v_lshl_add_u32 v7, s42, 18, v7
v_mfma_f32_16x16x32_bf16 v[68:71], a[92:95], a[52:55], v[68:71]
v_lshl_add_u32 v7, s42, 17, v7
v_mfma_f32_16x16x32_bf16 v[60:63], a[92:95], a[48:51], v[60:63]
v_mfma_f32_16x16x32_bf16 v[60:63], a[88:91], a[32:35], v[60:63]
s_add_u32 m0, s16, 0x0
s_waitcnt lgkmcnt(4)
s_waitcnt lgkmcnt(6)
v_mfma_f32_16x16x32_bf16 v[88:91], a[96:99], a[32:35], v[88:91]
buffer_load_dwordx4 v22, s[44:47], s20 offen lds
v_mfma_f32_16x16x32_bf16 v[88:91], a[100:103], a[48:51], v[88:91]
ds_read_b64_tr_b16 a[88:89], v13 offset:768
v_mfma_f32_16x16x32_bf16 v[96:99], a[100:103], a[52:55], v[96:99]
ds_read_b64_tr_b16 a[90:91], v13 offset:1792
v_mfma_f32_16x16x32_bf16 v[96:99], a[96:99], a[36:39], v[96:99]
ds_read_b64_tr_b16 a[92:93], v13 offset:8960
v_mfma_f32_16x16x32_bf16 v[104:107], a[96:99], a[40:43], v[104:107]
ds_read_b64_tr_b16 a[94:95], v13 offset:9984
s_add_u32 m0, s16, 0x400
v_mfma_f32_16x16x32_bf16 v[104:107], a[100:103], a[56:59], v[104:107]
buffer_load_dwordx4 v23, s[44:47], s20 offen lds
v_mfma_f32_16x16x32_bf16 v[112:115], a[100:103], a[60:63], v[112:115]
v_mfma_f32_16x16x32_bf16 v[112:115], a[96:99], a[44:47], v[112:115]
v_mfma_f32_16x16x32_bf16 v[116:119], a[104:107], a[44:47], v[116:119]
ds_read_b64_tr_b16 a[96:97], v14 offset:0
v_mfma_f32_16x16x32_bf16 v[116:119], a[108:111], a[60:63], v[116:119]
ds_read_b64_tr_b16 a[98:99], v14 offset:256
v_mfma_f32_16x16x32_bf16 v[108:111], a[108:111], a[56:59], v[108:111]
ds_read_b64_tr_b16 a[100:101], v14 offset:2048
s_add_u32 m0, s16, 0x800
v_mfma_f32_16x16x32_bf16 v[108:111], a[104:107], a[40:43], v[108:111]
buffer_load_dwordx4 v22, s[44:47], s21 offen lds
v_mfma_f32_16x16x32_bf16 v[100:103], a[104:107], a[36:39], v[100:103]
ds_read_b64_tr_b16 a[102:103], v14 offset:2304
v_mfma_f32_16x16x32_bf16 v[100:103], a[108:111], a[52:55], v[100:103]
v_mfma_f32_16x16x32_bf16 v[92:95], a[108:111], a[48:51], v[92:95]
v_mfma_f32_16x16x32_bf16 v[92:95], a[104:107], a[32:35], v[92:95]
s_waitcnt lgkmcnt(4)
v_mfma_f32_16x16x32_bf16 v[120:123], a[80:83], a[32:35], v[120:123]
buffer_load_dwordx4 a[144:147], v16, s[76:79], 0 offen offset:0
v_mfma_f32_16x16x32_bf16 v[120:123], a[84:87], a[48:51], v[120:123]
ds_read_b64_tr_b16 a[104:105], v15 offset:0
v_mfma_f32_16x16x32_bf16 v[128:131], a[84:87], a[52:55], v[128:131]
ds_read_b64_tr_b16 a[106:107], v15 offset:256
v_mfma_f32_16x16x32_bf16 v[128:131], a[80:83], a[36:39], v[128:131]
ds_read_b64_tr_b16 a[108:109], v15 offset:2048
v_mfma_f32_16x16x32_bf16 v[136:139], a[80:83], a[40:43], v[136:139]
ds_read_b64_tr_b16 a[110:111], v15 offset:2304
v_mfma_f32_16x16x32_bf16 v[136:139], a[84:87], a[56:59], v[136:139]
s_add_u32 m0, s16, 0xc00
v_mfma_f32_16x16x32_bf16 v[144:147], a[84:87], a[60:63], v[144:147]
buffer_load_dwordx4 v23, s[44:47], s21 offen lds
v_mfma_f32_16x16x32_bf16 v[144:147], a[80:83], a[44:47], v[144:147]
v_mfma_f32_16x16x32_bf16 v[148:151], a[88:91], a[44:47], v[148:151]
ds_read_b64_tr_b16 a[80:81], v14 offset:4096
v_mfma_f32_16x16x32_bf16 v[148:151], a[92:95], a[60:63], v[148:151]
ds_read_b64_tr_b16 a[82:83], v14 offset:4352
v_mfma_f32_16x16x32_bf16 v[140:143], a[92:95], a[56:59], v[140:143]
ds_read_b64_tr_b16 a[84:85], v14 offset:6144
v_mfma_f32_16x16x32_bf16 v[140:143], a[88:91], a[40:43], v[140:143]
ds_read_b64_tr_b16 a[86:87], v14 offset:6400
s_add_u32 m0, s16, 0x1000
v_mfma_f32_16x16x32_bf16 v[132:135], a[88:91], a[36:39], v[132:135]
buffer_load_dwordx4 v22, s[44:47], s22 offen lds
v_mfma_f32_16x16x32_bf16 v[132:135], a[92:95], a[52:55], v[132:135]
v_mfma_f32_16x16x32_bf16 v[124:127], a[92:95], a[48:51], v[124:127]
v_mfma_f32_16x16x32_bf16 v[124:127], a[88:91], a[32:35], v[124:127]
s_waitcnt lgkmcnt(4)
v_mfma_f32_16x16x32_bf16 v[152:155], a[96:99], a[32:35], v[152:155]
ds_read_b64_tr_b16 a[88:89], v15 offset:4096
s_add_u32 m0, s16, 0x1400
v_mfma_f32_16x16x32_bf16 v[152:155], a[100:103], a[48:51], v[152:155]
buffer_load_dwordx4 v23, s[44:47], s22 offen lds
v_mfma_f32_16x16x32_bf16 v[160:163], a[100:103], a[52:55], v[160:163]
ds_read_b64_tr_b16 a[90:91], v15 offset:4352
v_mfma_f32_16x16x32_bf16 v[160:163], a[96:99], a[36:39], v[160:163]
ds_read_b64_tr_b16 a[92:93], v15 offset:6144
v_mfma_f32_16x16x32_bf16 v[168:171], a[96:99], a[40:43], v[168:171]
ds_read_b64_tr_b16 a[94:95], v15 offset:6400
v_mfma_f32_16x16x32_bf16 v[168:171], a[100:103], a[56:59], v[168:171]
v_mfma_f32_16x16x32_bf16 v[176:179], a[100:103], a[60:63], v[176:179]
s_add_u32 m0, s16, 0x1800
v_mfma_f32_16x16x32_bf16 v[176:179], a[96:99], a[44:47], v[176:179]
buffer_load_dwordx4 v22, s[44:47], s23 offen lds
v_mfma_f32_16x16x32_bf16 v[180:183], a[104:107], a[44:47], v[180:183]
ds_read_b64_tr_b16 a[96:97], v14 offset:8192
v_mfma_f32_16x16x32_bf16 v[180:183], a[108:111], a[60:63], v[180:183]
ds_read_b64_tr_b16 a[98:99], v14 offset:8448
v_mfma_f32_16x16x32_bf16 v[172:175], a[108:111], a[56:59], v[172:175]
ds_read_b64_tr_b16 a[100:101], v14 offset:10240
v_mfma_f32_16x16x32_bf16 v[172:175], a[104:107], a[40:43], v[172:175]
ds_read_b64_tr_b16 a[102:103], v14 offset:10496
s_add_u32 m0, s16, 0x1c00
v_mfma_f32_16x16x32_bf16 v[164:167], a[104:107], a[36:39], v[164:167]
buffer_load_dwordx4 v23, s[44:47], s23 offen lds
v_mfma_f32_16x16x32_bf16 v[164:167], a[108:111], a[52:55], v[164:167]
v_lshl_add_u32 v22, s42, 7, v22
v_lshl_add_u32 v23, s42, 7, v23
v_mfma_f32_16x16x32_bf16 v[156:159], a[108:111], a[48:51], v[156:159]
v_mfma_f32_16x16x32_bf16 v[156:159], a[104:107], a[32:35], v[156:159]
s_waitcnt lgkmcnt(4)
v_mfma_f32_16x16x32_bf16 v[184:187], a[80:83], a[32:35], v[184:187]
ds_read_b64_tr_b16 a[104:105], v15 offset:8192
v_mfma_f32_16x16x32_bf16 v[184:187], a[84:87], a[48:51], v[184:187]
ds_read_b64_tr_b16 a[106:107], v15 offset:8448
v_mfma_f32_16x16x32_bf16 v[192:195], a[84:87], a[52:55], v[192:195]
buffer_load_dwordx4 a[148:151], v16, s[76:79], 0 offen offset:1024
v_mfma_f32_16x16x32_bf16 v[192:195], a[80:83], a[36:39], v[192:195]
ds_read_b64_tr_b16 a[108:109], v15 offset:10240
v_mfma_f32_16x16x32_bf16 v[200:203], a[80:83], a[40:43], v[200:203]
ds_read_b64_tr_b16 a[110:111], v15 offset:10496
v_add_u32 v12, 0x8000, v12
v_mfma_f32_16x16x32_bf16 v[200:203], a[84:87], a[56:59], v[200:203]
v_add_u32 v13, 0x8000, v13
v_add_u32 v14, 0x8000, v14
v_mfma_f32_16x16x32_bf16 v[208:211], a[84:87], a[60:63], v[208:211]
v_add_u32 v15, 0x8000, v15
v_mfma_f32_16x16x32_bf16 v[208:211], a[80:83], a[44:47], v[208:211]
v_mfma_f32_16x16x32_bf16 v[212:215], a[88:91], a[44:47], v[212:215]
s_waitcnt vmcnt(29) lgkmcnt(0)
v_mfma_f32_16x16x32_bf16 v[212:215], a[92:95], a[60:63], v[212:215]
s_barrier
s_add_u32 m0, s17, 0x8000
v_mfma_f32_16x16x32_bf16 v[204:207], a[92:95], a[56:59], v[204:207]
buffer_load_dwordx4 v5, s[52:55], 0 offen lds
v_mfma_f32_16x16x32_bf16 v[204:207], a[88:91], a[40:43], v[204:207]
ds_read_b64_tr_b16 a[80:81], v12 offset:0
v_mfma_f32_16x16x32_bf16 v[196:199], a[88:91], a[36:39], v[196:199]
ds_read_b64_tr_b16 a[82:83], v12 offset:1024
v_mfma_f32_16x16x32_bf16 v[196:199], a[92:95], a[52:55], v[196:199]
ds_read_b64_tr_b16 a[84:85], v12 offset:8192
v_mfma_f32_16x16x32_bf16 v[188:191], a[92:95], a[48:51], v[188:191]
ds_read_b64_tr_b16 a[86:87], v12 offset:9216
v_mfma_f32_16x16x32_bf16 v[188:191], a[88:91], a[32:35], v[188:191]
s_waitcnt lgkmcnt(4)
v_mfma_f32_16x16x32_bf16 v[216:219], a[32:35], a[96:99], v[216:219]
ds_read_b64_tr_b16 a[88:89], v13 offset:0
s_add_u32 m0, s17, 0x8400
v_mfma_f32_16x16x32_bf16 v[216:219], a[48:51], a[100:103], v[216:219]
buffer_load_dwordx4 v5, s[52:55], s13 offen lds
v_mfma_f32_16x16x32_bf16 v[224:227], a[52:55], a[100:103], v[224:227]
ds_read_b64_tr_b16 a[90:91], v13 offset:1024
v_mfma_f32_16x16x32_bf16 v[224:227], a[36:39], a[96:99], v[224:227]
ds_read_b64_tr_b16 a[92:93], v13 offset:8192
v_mfma_f32_16x16x32_bf16 v[232:235], a[40:43], a[96:99], v[232:235]
ds_read_b64_tr_b16 a[94:95], v13 offset:9216
v_mfma_f32_16x16x32_bf16 v[232:235], a[56:59], a[100:103], v[232:235]
v_mfma_f32_16x16x32_bf16 v[240:243], a[60:63], a[100:103], v[240:243]
v_mfma_f32_16x16x32_bf16 v[240:243], a[44:47], a[96:99], v[240:243]
v_mfma_f32_16x16x32_bf16 v[244:247], a[44:47], a[104:107], v[244:247]
ds_read_b64_tr_b16 a[96:97], v12 offset:256
s_add_u32 m0, s17, 0x8800
v_mfma_f32_16x16x32_bf16 v[244:247], a[60:63], a[108:111], v[244:247]
buffer_load_dwordx4 v6, s[52:55], 0 offen lds
v_mfma_f32_16x16x32_bf16 v[236:239], a[56:59], a[108:111], v[236:239]
ds_read_b64_tr_b16 a[98:99], v12 offset:1280
v_mfma_f32_16x16x32_bf16 v[236:239], a[40:43], a[104:107], v[236:239]
ds_read_b64_tr_b16 a[100:101], v12 offset:8448
v_mfma_f32_16x16x32_bf16 v[228:231], a[36:39], a[104:107], v[228:231]
ds_read_b64_tr_b16 a[102:103], v12 offset:9472
v_mfma_f32_16x16x32_bf16 v[228:231], a[52:55], a[108:111], v[228:231]
v_mfma_f32_16x16x32_bf16 v[220:223], a[48:51], a[108:111], v[220:223]
v_mfma_f32_16x16x32_bf16 v[220:223], a[32:35], a[104:107], v[220:223]
s_add_u32 m0, s17, 0x8c00
s_waitcnt lgkmcnt(4)
L_S20:
v_mfma_f32_16x16x32_bf16 v[24:27], a[80:83], a[0:3], v[24:27]
ds_read_b64_tr_b16 a[104:105], v13 offset:256
s_waitcnt vmcnt(22)
v_mfma_f32_16x16x32_bf16 v[24:27], a[84:87], a[16:19], v[24:27]
buffer_load_dwordx4 v6, s[52:55], s13 offen lds
v_mfma_f32_16x16x32_bf16 v[32:35], a[84:87], a[20:23], v[32:35]
ds_read_b64_tr_b16 a[106:107], v13 offset:1280
v_mfma_f32_16x16x32_bf16 v[32:35], a[80:83], a[4:7], v[32:35]
ds_read_b64_tr_b16 a[108:109], v13 offset:8448
v_mfma_f32_16x16x32_bf16 v[40:43], a[80:83], a[8:11], v[40:43]
ds_read_b64_tr_b16 a[110:111], v13 offset:9472
v_mfma_f32_16x16x32_bf16 v[40:43], a[84:87], a[24:27], v[40:43]
ds_read_b128 a[32:35], v8 offset:32768
v_mfma_f32_16x16x32_bf16 v[48:51], a[84:87], a[28:31], v[48:51]
ds_read_b128 a[48:51], v9 offset:32768
v_mfma_f32_16x16x32_bf16 v[48:51], a[80:83], a[12:15], v[48:51]
ds_read_b128 a[36:39], v8 offset:34816
s_add_u32 m0, s18, 0xc000
v_mfma_f32_16x16x32_bf16 v[52:55], a[88:91], a[12:15], v[52:55]
buffer_load_dwordx4 v7, s[68:71], 0 offen lds
v_mfma_f32_16x16x32_bf16 v[52:55], a[92:95], a[28:31], v[52:55]
ds_read_b64_tr_b16 a[80:81], v12 offset:512
v_mfma_f32_16x16x32_bf16 v[44:47], a[92:95], a[24:27], v[44:47]
ds_read_b64_tr_b16 a[82:83], v12 offset:1536
v_mfma_f32_16x16x32_bf16 v[44:47], a[88:91], a[8:11], v[44:47]
ds_read_b64_tr_b16 a[84:85], v12 offset:8704
v_mfma_f32_16x16x32_bf16 v[36:39], a[88:91], a[4:7], v[36:39]
ds_read_b64_tr_b16 a[86:87], v12 offset:9728
v_mfma_f32_16x16x32_bf16 v[36:39], a[92:95], a[20:23], v[36:39]
ds_read_b128 a[52:55], v9 offset:34816
v_mfma_f32_16x16x32_bf16 v[28:31], a[92:95], a[16:19], v[28:31]
ds_read_b128 a[40:43], v8 offset:36864
s_waitcnt lgkmcnt(9)
v_mfma_f32_16x16x32_bf16 v[28:31], a[88:91], a[0:3], v[28:31]
ds_read_b128 a[56:59], v9 offset:36864
s_add_u32 m0, s18, 0xd000
v_mfma_f32_16x16x32_bf16 v[56:59], a[96:99], a[0:3], v[56:59]
buffer_load_dwordx4 v7, s[68:71], s25 offen lds
v_mfma_f32_16x16x32_bf16 v[56:59], a[100:103], a[16:19], v[56:59]
ds_read_b64_tr_b16 a[88:89], v13 offset:512
v_mfma_f32_16x16x32_bf16 v[64:67], a[100:103], a[20:23], v[64:67]
ds_read_b64_tr_b16 a[90:91], v13 offset:1536
v_mfma_f32_16x16x32_bf16 v[64:67], a[96:99], a[4:7], v[64:67]
ds_read_b64_tr_b16 a[92:93], v13 offset:8704
v_mfma_f32_16x16x32_bf16 v[72:75], a[96:99], a[8:11], v[72:75]
ds_read_b64_tr_b16 a[94:95], v13 offset:9728
v_mfma_f32_16x16x32_bf16 v[72:75], a[100:103], a[24:27], v[72:75]
ds_read_b128 a[44:47], v8 offset:38912
v_mfma_f32_16x16x32_bf16 v[80:83], a[100:103], a[28:31], v[80:83]
ds_read_b128 a[60:63], v9 offset:38912
v_mfma_f32_16x16x32_bf16 v[80:83], a[96:99], a[12:15], v[80:83]
s_add_u32 m0, s18, 0xe000
v_mfma_f32_16x16x32_bf16 v[84:87], a[104:107], a[12:15], v[84:87]
buffer_load_dwordx4 v7, s[68:71], s26 offen lds
v_mfma_f32_16x16x32_bf16 v[84:87], a[108:111], a[28:31], v[84:87]
ds_read_b64_tr_b16 a[96:97], v12 offset:768
v_lshl_add_u32 v5, s42, 19, v5
v_mfma_f32_16x16x32_bf16 v[76:79], a[108:111], a[24:27], v[76:79]
ds_read_b64_tr_b16 a[98:99], v12 offset:1792
L_padA10:
s_cmp_eq_u32 s95, 1
s_cbranch_scc1 L_hopA_ret
v_lshl_add_u32 v6, s42, 19, v6
v_mfma_f32_16x16x32_bf16 v[76:79], a[104:107], a[8:11], v[76:79]
ds_read_b64_tr_b16 a[100:101], v12 offset:8960
v_lshl_add_u32 v7, s42, 18, v7
v_mfma_f32_16x16x32_bf16 v[68:71], a[104:107], a[4:7], v[68:71]
ds_read_b64_tr_b16 a[102:103], v12 offset:9984
v_lshl_add_u32 v7, s42, 17, v7
v_mfma_f32_16x16x32_bf16 v[68:71], a[108:111], a[20:23], v[68:71]
s_waitcnt vmcnt(13)
v_accvgpr_read_b32 v18, a144
v_lshlrev_b32 v1, 16, v18
v_mfma_f32_16x16x32_bf16 v[60:63], a[108:111], a[16:19], v[60:63]
v_and_b32 v18, 0xffff0000, v18
v_accvgpr_read_b32 v21, a128
v_mfma_f32_16x16x32_bf16 v[60:63], a[104:107], a[0:3], v[60:63]
s_add_u32 m0, s16, 0x8000
s_waitcnt lgkmcnt(4)
s_waitcnt lgkmcnt(6)
v_mfma_f32_16x16x32_bf16 v[88:91], a[80:83], a[0:3], v[88:91]
buffer_load_dwordx4 v22, s[44:47], s20 offen lds
v_mfma_f32_16x16x32_bf16 v[88:91], a[84:87], a[16:19], v[88:91]
ds_read_b64_tr_b16 a[104:105], v13 offset:768
v_lshlrev_b32 v20, 16, v21
v_mfma_f32_16x16x32_bf16 v[96:99], a[84:87], a[20:23], v[96:99]
ds_read_b64_tr_b16 a[106:107], v13 offset:1792
v_and_b32 v21, 0xffff0000, v21
v_mfma_f32_16x16x32_bf16 v[96:99], a[80:83], a[4:7], v[96:99]
ds_read_b64_tr_b16 a[108:109], v13 offset:8960
v_mul_f32 v2, v1, v20
v_mfma_f32_16x16x32_bf16 v[104:107], a[80:83], a[8:11], v[104:107]
ds_read_b64_tr_b16 a[110:111], v13 offset:9984
v_fmac_f32 v2, v18, v21
v_mfma_f32_16x16x32_bf16 v[104:107], a[84:87], a[24:27], v[104:107]
v_accvgpr_read_b32 v21, a136
v_lshlrev_b32 v20, 16, v21
v_mfma_f32_16x16x32_bf16 v[112:115], a[84:87], a[28:31], v[112:115]
s_add_u32 m0, s16, 0x8400
v_and_b32 v21, 0xffff0000, v21
v_mul_f32 v3, v1, v20
v_mfma_f32_16x16x32_bf16 v[112:115], a[80:83], a[12:15], v[112:115]
buffer_load_dwordx4 v23, s[44:47], s20 offen lds
v_mfma_f32_16x16x32_bf16 v[116:119], a[88:91], a[12:15], v[116:119]
ds_read_b64_tr_b16 a[80:81], v14 offset:0
v_fmac_f32 v3, v18, v21
v_mfma_f32_16x16x32_bf16 v[116:119], a[92:95], a[28:31], v[116:119]
ds_read_b64_tr_b16 a[82:83], v14 offset:256
v_accvgpr_read_b32 v18, a145
v_mfma_f32_16x16x32_bf16 v[108:111], a[92:95], a[24:27], v[108:111]
ds_read_b64_tr_b16 a[84:85], v14 offset:2048
v_lshlrev_b32 v1, 16, v18
v_mfma_f32_16x16x32_bf16 v[108:111], a[88:91], a[8:11], v[108:111]
ds_read_b64_tr_b16 a[86:87], v14 offset:2304
v_and_b32 v18, 0xffff0000, v18
v_mfma_f32_16x16x32_bf16 v[100:103], a[88:91], a[4:7], v[100:103]
v_accvgpr_read_b32 v21, a129
v_lshlrev_b32 v20, 16, v21
v_mfma_f32_16x16x32_bf16 v[100:103], a[92:95], a[20:23], v[100:103]
s_add_u32 m0, s16, 0x8800
v_and_b32 v21, 0xffff0000, v21
v_fmac_f32 v2, v1, v20
v_mfma_f32_16x16x32_bf16 v[92:95], a[92:95], a[16:19], v[92:95]
buffer_load_dwordx4 v22, s[44:47], s21 offen lds
v_mfma_f32_16x16x32_bf16 v[92:95], a[88:91], a[0:3], v[92:95]
s_waitcnt lgkmcnt(4)
v_fmac_f32 v2, v18, v21
v_accvgpr_read_b32 v21, a137
v_mfma_f32_16x16x32_bf16 v[120:123], a[96:99], a[0:3], v[120:123]
ds_read_b64_tr_b16 a[88:89], v15 offset:0
v_lshlrev_b32 v20, 16, v21
v_mfma_f32_16x16x32_bf16 v[120:123], a[100:103], a[16:19], v[120:123]
ds_read_b64_tr_b16 a[90:91], v15 offset:256
v_and_b32 v21, 0xffff0000, v21
v_mfma_f32_16x16x32_bf16 v[128:131], a[100:103], a[20:23], v[128:131]
ds_read_b64_tr_b16 a[92:93], v15 offset:2048
v_fmac_f32 v3, v1, v20
v_mfma_f32_16x16x32_bf16 v[128:131], a[96:99], a[4:7], v[128:131]
ds_read_b64_tr_b16 a[94:95], v15 offset:2304
v_fmac_f32 v3, v18, v21
v_mfma_f32_16x16x32_bf16 v[136:139], a[96:99], a[8:11], v[136:139]
s_add_u32 m0, s16, 0x8c00
v_accvgpr_read_b32 v18, a146
v_lshlrev_b32 v1, 16, v18
v_mfma_f32_16x16x32_bf16 v[136:139], a[100:103], a[24:27], v[136:139]
buffer_load_dwordx4 v23, s[44:47], s21 offen lds
v_mfma_f32_16x16x32_bf16 v[144:147], a[100:103], a[28:31], v[144:147]
v_and_b32 v18, 0xffff0000, v18
v_accvgpr_read_b32 v21, a130
v_mfma_f32_16x16x32_bf16 v[144:147], a[96:99], a[12:15], v[144:147]
v_lshlrev_b32 v20, 16, v21
v_and_b32 v21, 0xffff0000, v21
v_mfma_f32_16x16x32_bf16 v[148:151], a[104:107], a[12:15], v[148:151]
ds_read_b64_tr_b16 a[96:97], v14 offset:4096
v_fmac_f32 v2, v1, v20
v_mfma_f32_16x16x32_bf16 v[148:151], a[108:111], a[28:31], v[148:151]
ds_read_b64_tr_b16 a[98:99], v14 offset:4352
v_fmac_f32 v2, v18, v21
v_mfma_f32_16x16x32_bf16 v[140:143], a[108:111], a[24:27], v[140:143]
ds_read_b64_tr_b16 a[100:101], v14 offset:6144
v_accvgpr_read_b32 v21, a138
v_mfma_f32_16x16x32_bf16 v[140:143], a[104:107], a[8:11], v[140:143]
ds_read_b64_tr_b16 a[102:103], v14 offset:6400
s_add_u32 m0, s16, 0x9000
v_mfma_f32_16x16x32_bf16 v[132:135], a[104:107], a[4:7], v[132:135]
buffer_load_dwordx4 v22, s[44:47], s22 offen lds
v_mfma_f32_16x16x32_bf16 v[132:135], a[108:111], a[20:23], v[132:135]
v_lshlrev_b32 v20, 16, v21
v_and_b32 v21, 0xffff0000, v21
v_mfma_f32_16x16x32_bf16 v[124:127], a[108:111], a[16:19], v[124:127]
v_fmac_f32 v3, v1, v20
v_fmac_f32 v3, v18, v21
v_mfma_f32_16x16x32_bf16 v[124:127], a[104:107], a[0:3], v[124:127]
s_waitcnt lgkmcnt(4)
v_accvgpr_read_b32 v18, a147
v_lshlrev_b32 v1, 16, v18
v_mfma_f32_16x16x32_bf16 v[152:155], a[80:83], a[0:3], v[152:155]
ds_read_b64_tr_b16 a[104:105], v15 offset:4096
v_and_b32 v18, 0xffff0000, v18
v_mfma_f32_16x16x32_bf16 v[152:155], a[84:87], a[16:19], v[152:155]
ds_read_b64_tr_b16 a[106:107], v15 offset:4352
v_accvgpr_read_b32 v21, a131
v_mfma_f32_16x16x32_bf16 v[160:163], a[84:87], a[20:23], v[160:163]
ds_read_b64_tr_b16 a[108:109], v15 offset:6144
s_add_u32 m0, s16, 0x9400
v_mfma_f32_16x16x32_bf16 v[160:163], a[80:83], a[4:7], v[160:163]
buffer_load_dwordx4 v23, s[44:47], s22 offen lds
v_mfma_f32_16x16x32_bf16 v[168:171], a[80:83], a[8:11], v[168:171]
ds_read_b64_tr_b16 a[110:111], v15 offset:6400
v_lshlrev_b32 v20, 16, v21
v_mfma_f32_16x16x32_bf16 v[168:171], a[84:87], a[24:27], v[168:171]
v_and_b32 v21, 0xffff0000, v21
v_fmac_f32 v2, v1, v20
v_mfma_f32_16x16x32_bf16 v[176:179], a[84:87], a[28:31], v[176:179]
v_fmac_f32 v2, v18, v21
v_accvgpr_read_b32 v21, a139
v_mfma_f32_16x16x32_bf16 v[176:179], a[80:83], a[12:15], v[176:179]
v_lshlrev_b32 v20, 16, v21
v_and_b32 v21, 0xffff0000, v21
v_mfma_f32_16x16x32_bf16 v[180:183], a[88:91], a[12:15], v[180:183]
ds_read_b64_tr_b16 a[80:81], v14 offset:8192
v_fmac_f32 v3, v1, v20
v_mfma_f32_16x16x32_bf16 v[180:183], a[92:95], a[28:31], v[180:183]
ds_read_b64_tr_b16 a[82:83], v14 offset:8448
s_add_u32 m0, s16, 0x9800
v_mfma_f32_16x16x32_bf16 v[172:175], a[92:95], a[24:27], v[172:175]
buffer_load_dwordx4 v22, s[44:47], s23 offen lds
v_mfma_f32_16x16x32_bf16 v[172:175], a[88:91], a[8:11], v[172:175]
ds_read_b64_tr_b16 a[84:85], v14 offset:10240
v_fmac_f32 v3, v18, v21
v_mfma_f32_16x16x32_bf16 v[164:167], a[88:91], a[4:7], v[164:167]
ds_read_b64_tr_b16 a[86:87], v14 offset:10496
s_waitcnt vmcnt(14)
v_accvgpr_read_b32 v18, a148
v_mfma_f32_16x16x32_bf16 v[164:167], a[92:95], a[20:23], v[164:167]
v_lshlrev_b32 v1, 16, v18
v_and_b32 v18, 0xffff0000, v18
v_mfma_f32_16x16x32_bf16 v[156:159], a[92:95], a[16:19], v[156:159]
v_accvgpr_read_b32 v21, a132
v_lshlrev_b32 v20, 16, v21
v_mfma_f32_16x16x32_bf16 v[156:159], a[88:91], a[0:3], v[156:159]
s_waitcnt lgkmcnt(4)
v_and_b32 v21, 0xffff0000, v21
v_fmac_f32 v2, v1, v20
v_mfma_f32_16x16x32_bf16 v[184:187], a[96:99], a[0:3], v[184:187]
ds_read_b64_tr_b16 a[88:89], v15 offset:8192
s_add_u32 m0, s16, 0x9c00
v_mfma_f32_16x16x32_bf16 v[184:187], a[100:103], a[16:19], v[184:187]
buffer_load_dwordx4 v23, s[44:47], s23 offen lds
v_mfma_f32_16x16x32_bf16 v[192:195], a[100:103], a[20:23], v[192:195]
ds_read_b64_tr_b16 a[90:91], v15 offset:8448
v_fmac_f32 v2, v18, v21
v_mfma_f32_16x16x32_bf16 v[192:195], a[96:99], a[4:7], v[192:195]
ds_read_b64_tr_b16 a[92:93], v15 offset:10240
v_accvgpr_read_b32 v21, a140
v_mfma_f32_16x16x32_bf16 v[200:203], a[96:99], a[8:11], v[200:203]
ds_read_b64_tr_b16 a[94:95], v15 offset:10496
v_add_u32 v12, 0xffff0000, v12
v_mfma_f32_16x16x32_bf16 v[200:203], a[100:103], a[24:27], v[200:203]
v_add_u32 v13, 0xffff0000, v13
v_add_u32 v14, 0xffff0000, v14
v_mfma_f32_16x16x32_bf16 v[208:211], a[100:103], a[28:31], v[208:211]
v_add_u32 v15, 0xffff0000, v15
v_lshlrev_b32 v20, 16, v21
v_mfma_f32_16x16x32_bf16 v[208:211], a[96:99], a[12:15], v[208:211]
v_and_b32 v21, 0xffff0000, v21
v_fmac_f32 v3, v1, v20
v_mfma_f32_16x16x32_bf16 v[212:215], a[104:107], a[12:15], v[212:215]
s_waitcnt vmcnt(25) lgkmcnt(0)
v_fmac_f32 v3, v18, v21
v_accvgpr_read_b32 v18, a149
v_mfma_f32_16x16x32_bf16 v[212:215], a[108:111], a[28:31], v[212:215]
s_barrier
s_add_u32 m0, s17, 0x10000
v_lshlrev_b32 v1, 16, v18
v_mfma_f32_16x16x32_bf16 v[204:207], a[108:111], a[24:27], v[204:207]
buffer_load_dwordx4 v5, s[52:55], 0 offen lds
v_mfma_f32_16x16x32_bf16 v[204:207], a[104:107], a[8:11], v[204:207]
ds_read_b64_tr_b16 a[96:97], v12 offset:0
v_and_b32 v18, 0xffff0000, v18
v_mfma_f32_16x16x32_bf16 v[196:199], a[104:107], a[4:7], v[196:199]
ds_read_b64_tr_b16 a[98:99], v12 offset:1024
v_accvgpr_read_b32 v21, a133
v_mfma_f32_16x16x32_bf16 v[196:199], a[108:111], a[20:23], v[196:199]
ds_read_b64_tr_b16 a[100:101], v12 offset:8192
v_lshlrev_b32 v20, 16, v21
v_mfma_f32_16x16x32_bf16 v[188:191], a[108:111], a[16:19], v[188:191]
ds_read_b64_tr_b16 a[102:103], v12 offset:9216
v_and_b32 v21, 0xffff0000, v21
v_mfma_f32_16x16x32_bf16 v[188:191], a[104:107], a[0:3], v[188:191]
s_waitcnt lgkmcnt(4)
v_fmac_f32 v2, v1, v20
v_fmac_f32 v2, v18, v21
v_mfma_f32_16x16x32_bf16 v[216:219], a[0:3], a[80:83], v[216:219]
ds_read_b64_tr_b16 a[104:105], v13 offset:0
v_accvgpr_read_b32 v21, a141
v_mfma_f32_16x16x32_bf16 v[216:219], a[16:19], a[84:87], v[216:219]
ds_read_b64_tr_b16 a[106:107], v13 offset:1024
s_add_u32 m0, s17, 0x10400
v_mfma_f32_16x16x32_bf16 v[224:227], a[20:23], a[84:87], v[224:227]
buffer_load_dwordx4 v5, s[52:55], s13 offen lds
v_mfma_f32_16x16x32_bf16 v[224:227], a[4:7], a[80:83], v[224:227]
ds_read_b64_tr_b16 a[108:109], v13 offset:8192
v_lshlrev_b32 v20, 16, v21
v_mfma_f32_16x16x32_bf16 v[232:235], a[8:11], a[80:83], v[232:235]
ds_read_b64_tr_b16 a[110:111], v13 offset:9216
v_and_b32 v21, 0xffff0000, v21
v_mfma_f32_16x16x32_bf16 v[232:235], a[24:27], a[84:87], v[232:235]
s_lshl_b32 s15, s2, 2
v_fmac_f32 v3, v1, v20
v_fmac_f32 v3, v18, v21
v_mfma_f32_16x16x32_bf16 v[240:243], a[28:31], a[84:87], v[240:243]
s_add_u32 s15, s15, s4
v_accvgpr_read_b32 v18, a150
v_lshlrev_b32 v1, 16, v18
v_mfma_f32_16x16x32_bf16 v[240:243], a[12:15], a[80:83], v[240:243]
s_lshl_b32 s15, s15, 12
v_and_b32 v18, 0xffff0000, v18
v_accvgpr_read_b32 v21, a134
v_mfma_f32_16x16x32_bf16 v[244:247], a[12:15], a[88:91], v[244:247]
ds_read_b64_tr_b16 a[80:81], v12 offset:256
v_lshlrev_b32 v20, 16, v21
v_mfma_f32_16x16x32_bf16 v[244:247], a[28:31], a[92:95], v[244:247]
ds_read_b64_tr_b16 a[82:83], v12 offset:1280
v_and_b32 v21, 0xffff0000, v21
v_mfma_f32_16x16x32_bf16 v[236:239], a[24:27], a[92:95], v[236:239]
ds_read_b64_tr_b16 a[84:85], v12 offset:8448
s_add_u32 m0, s17, 0x10800
v_mfma_f32_16x16x32_bf16 v[236:239], a[8:11], a[88:91], v[236:239]
buffer_load_dwordx4 v6, s[52:55], 0 offen lds
v_mfma_f32_16x16x32_bf16 v[228:231], a[4:7], a[88:91], v[228:231]
ds_read_b64_tr_b16 a[86:87], v12 offset:9472
v_fmac_f32 v2, v1, v20
v_mfma_f32_16x16x32_bf16 v[228:231], a[20:23], a[92:95], v[228:231]
s_add_u32 s15, s15, 0x3800000
v_fmac_f32 v2, v18, v21
v_accvgpr_read_b32 v21, a142
v_mfma_f32_16x16x32_bf16 v[220:223], a[16:19], a[92:95], v[220:223]
v_lshlrev_b32 v20, 16, v21
v_and_b32 v21, 0xffff0000, v21
v_mfma_f32_16x16x32_bf16 v[220:223], a[0:3], a[88:91], v[220:223]
s_waitcnt lgkmcnt(4)
v_fmac_f32 v3, v1, v20
v_fmac_f32 v3, v18, v21
L_S21:
v_mfma_f32_16x16x32_bf16 v[24:27], a[96:99], a[32:35], v[24:27]
ds_read_b64_tr_b16 a[88:89], v13 offset:256
s_waitcnt vmcnt(19)
v_mfma_f32_16x16x32_bf16 v[24:27], a[100:103], a[48:51], v[24:27]
ds_read_b64_tr_b16 a[90:91], v13 offset:1280
v_accvgpr_read_b32 v18, a151
v_mfma_f32_16x16x32_bf16 v[32:35], a[100:103], a[52:55], v[32:35]
ds_read_b64_tr_b16 a[92:93], v13 offset:8448
s_add_u32 m0, s17, 0x10c00
v_mfma_f32_16x16x32_bf16 v[32:35], a[96:99], a[36:39], v[32:35]
buffer_load_dwordx4 v6, s[52:55], s13 offen lds
v_mfma_f32_16x16x32_bf16 v[40:43], a[96:99], a[40:43], v[40:43]
ds_read_b64_tr_b16 a[94:95], v13 offset:9472
v_lshlrev_b32 v1, 16, v18
v_mfma_f32_16x16x32_bf16 v[40:43], a[100:103], a[56:59], v[40:43]
ds_read_b128 a[0:3], v8 offset:0
v_and_b32 v18, 0xffff0000, v18
v_mfma_f32_16x16x32_bf16 v[48:51], a[100:103], a[60:63], v[48:51]
ds_read_b128 a[16:19], v9 offset:0
v_accvgpr_read_b32 v21, a135
v_mfma_f32_16x16x32_bf16 v[48:51], a[96:99], a[44:47], v[48:51]
ds_read_b128 a[4:7], v8 offset:2048
v_lshlrev_b32 v20, 16, v21
v_mfma_f32_16x16x32_bf16 v[52:55], a[104:107], a[44:47], v[52:55]
ds_read_b64_tr_b16 a[96:97], v12 offset:512
v_and_b32 v21, 0xffff0000, v21
v_mfma_f32_16x16x32_bf16 v[52:55], a[108:111], a[60:63], v[52:55]
ds_read_b64_tr_b16 a[98:99], v12 offset:1536
v_fmac_f32 v2, v1, v20
v_mfma_f32_16x16x32_bf16 v[44:47], a[108:111], a[56:59], v[44:47]
ds_read_b64_tr_b16 a[100:101], v12 offset:8704
v_fmac_f32 v2, v18, v21
v_mfma_f32_16x16x32_bf16 v[44:47], a[104:107], a[40:43], v[44:47]
ds_read_b64_tr_b16 a[102:103], v12 offset:9728
s_add_u32 m0, s18, 0x14000
v_mfma_f32_16x16x32_bf16 v[36:39], a[104:107], a[36:39], v[36:39]
buffer_load_dwordx4 v7, s[68:71], 0 offen lds
v_mfma_f32_16x16x32_bf16 v[36:39], a[108:111], a[52:55], v[36:39]
ds_read_b128 a[20:23], v9 offset:2048
v_accvgpr_read_b32 v21, a143
v_mfma_f32_16x16x32_bf16 v[28:31], a[108:111], a[48:51], v[28:31]
ds_read_b128 a[8:11], v8 offset:4096
v_lshlrev_b32 v20, 16, v21
v_mfma_f32_16x16x32_bf16 v[28:31], a[104:107], a[32:35], v[28:31]
ds_read_b128 a[24:27], v9 offset:4096
s_waitcnt lgkmcnt(10)
v_mfma_f32_16x16x32_bf16 v[56:59], a[80:83], a[32:35], v[56:59]
ds_read_b64_tr_b16 a[104:105], v13 offset:512
v_and_b32 v21, 0xffff0000, v21
v_mfma_f32_16x16x32_bf16 v[56:59], a[84:87], a[48:51], v[56:59]
ds_read_b64_tr_b16 a[106:107], v13 offset:1536
v_fmac_f32 v3, v1, v20
v_mfma_f32_16x16x32_bf16 v[64:67], a[84:87], a[52:55], v[64:67]
ds_read_b64_tr_b16 a[108:109], v13 offset:8704
v_fmac_f32 v3, v18, v21
v_mfma_f32_16x16x32_bf16 v[64:67], a[80:83], a[36:39], v[64:67]
ds_read_b64_tr_b16 a[110:111], v13 offset:9728
s_add_u32 m0, s18, 0x15000
v_mfma_f32_16x16x32_bf16 v[72:75], a[80:83], a[40:43], v[72:75]
buffer_load_dwordx4 v7, s[68:71], s25 offen lds
v_mfma_f32_16x16x32_bf16 v[72:75], a[84:87], a[56:59], v[72:75]
ds_read_b128 a[12:15], v8 offset:6144
v_add_f32_dpp v2, v2, v2 row_ror:8 row_mask:0xf bank_mask:0xf
v_mfma_f32_16x16x32_bf16 v[80:83], a[84:87], a[60:63], v[80:83]
ds_read_b128 a[28:31], v9 offset:6144
v_add_f32_dpp v3, v3, v3 row_ror:8 row_mask:0xf bank_mask:0xf
v_mfma_f32_16x16x32_bf16 v[80:83], a[80:83], a[44:47], v[80:83]
v_add_f32_dpp v2, v2, v2 row_ror:4 row_mask:0xf bank_mask:0xf
v_add_f32_dpp v3, v3, v3 row_ror:4 row_mask:0xf bank_mask:0xf
v_mfma_f32_16x16x32_bf16 v[84:87], a[88:91], a[44:47], v[84:87]
ds_read_b64_tr_b16 a[80:81], v12 offset:768
v_add_f32_dpp v2, v2, v2 row_ror:2 row_mask:0xf bank_mask:0xf
v_mfma_f32_16x16x32_bf16 v[84:87], a[92:95], a[60:63], v[84:87]
ds_read_b64_tr_b16 a[82:83], v12 offset:1792
v_add_f32_dpp v3, v3, v3 row_ror:2 row_mask:0xf bank_mask:0xf
v_mfma_f32_16x16x32_bf16 v[76:79], a[92:95], a[56:59], v[76:79]
ds_read_b64_tr_b16 a[84:85], v12 offset:8960
v_add_f32_dpp v2, v2, v2 row_ror:1 row_mask:0xf bank_mask:0xf
v_mfma_f32_16x16x32_bf16 v[76:79], a[88:91], a[40:43], v[76:79]
ds_read_b64_tr_b16 a[86:87], v12 offset:9984
v_add_f32_dpp v3, v3, v3 row_ror:1 row_mask:0xf bank_mask:0xf
v_mfma_f32_16x16x32_bf16 v[68:71], a[88:91], a[36:39], v[68:71]
s_add_u32 m0, s18, 0x16000
v_mov_b32 v1, v2
v_mov_b32 v18, v3
v_mfma_f32_16x16x32_bf16 v[68:71], a[92:95], a[52:55], v[68:71]
buffer_load_dwordx4 v7, s[68:71], s26 offen lds
v_mfma_f32_16x16x32_bf16 v[60:63], a[92:95], a[48:51], v[60:63]
v_permlane16_swap_b32 v1, v2
v_permlane16_swap_b32 v18, v3
v_mfma_f32_16x16x32_bf16 v[60:63], a[88:91], a[32:35], v[60:63]
s_waitcnt lgkmcnt(6)
v_add_f32 v2, v2, v1
v_add_f32 v3, v3, v18
v_mfma_f32_16x16x32_bf16 v[88:91], a[96:99], a[32:35], v[88:91]
ds_read_b64_tr_b16 a[88:89], v13 offset:768
v_mov_b32 v1, v2
v_mfma_f32_16x16x32_bf16 v[88:91], a[100:103], a[48:51], v[88:91]
ds_read_b64_tr_b16 a[90:91], v13 offset:1792
v_mov_b32 v18, v3
v_mfma_f32_16x16x32_bf16 v[96:99], a[100:103], a[52:55], v[96:99]
ds_read_b64_tr_b16 a[92:93], v13 offset:8960
v_permlane32_swap_b32 v1, v2
v_mfma_f32_16x16x32_bf16 v[96:99], a[96:99], a[36:39], v[96:99]
ds_read_b64_tr_b16 a[94:95], v13 offset:9984
v_permlane32_swap_b32 v18, v3
v_mfma_f32_16x16x32_bf16 v[104:107], a[96:99], a[40:43], v[104:107]
v_add_f32 v2, v2, v1
v_add_f32 v3, v3, v18
v_mfma_f32_16x16x32_bf16 v[104:107], a[100:103], a[56:59], v[104:107]
buffer_load_dword v23, off, s[84:87], s10 sc1
v_mfma_f32_16x16x32_bf16 v[112:115], a[100:103], a[60:63], v[112:115]
v_mul_f32 v2, 0xbfb8aa3b, v2
v_mul_f32 v3, 0xbfb8aa3b, v3
v_mfma_f32_16x16x32_bf16 v[112:115], a[96:99], a[44:47], v[112:115]
v_exp_f32 v2, v2
v_mfma_f32_16x16x32_bf16 v[116:119], a[104:107], a[44:47], v[116:119]
ds_read_b64_tr_b16 a[96:97], v14 offset:0
v_mfma_f32_16x16x32_bf16 v[116:119], a[108:111], a[60:63], v[116:119]
ds_read_b64_tr_b16 a[98:99], v14 offset:256
v_mfma_f32_16x16x32_bf16 v[108:111], a[108:111], a[56:59], v[108:111]
ds_read_b64_tr_b16 a[100:101], v14 offset:2048
v_mfma_f32_16x16x32_bf16 v[108:111], a[104:107], a[40:43], v[108:111]
ds_read_b64_tr_b16 a[102:103], v14 offset:2304
v_mfma_f32_16x16x32_bf16 v[100:103], a[104:107], a[36:39], v[100:103]
v_exp_f32 v3, v3
v_mfma_f32_16x16x32_bf16 v[100:103], a[108:111], a[52:55], v[100:103]
v_add_f32 v2, 1.0, v2
v_add_f32 v3, 1.0, v3
v_mfma_f32_16x16x32_bf16 v[92:95], a[108:111], a[48:51], v[92:95]
v_rcp_f32 v2, v2
v_mfma_f32_16x16x32_bf16 v[92:95], a[104:107], a[32:35], v[92:95]
s_waitcnt lgkmcnt(4)
v_rcp_f32 v3, v3
v_mfma_f32_16x16x32_bf16 v[120:123], a[80:83], a[32:35], v[120:123]
ds_read_b64_tr_b16 a[104:105], v15 offset:0
v_mfma_f32_16x16x32_bf16 v[120:123], a[84:87], a[48:51], v[120:123]
ds_read_b64_tr_b16 a[106:107], v15 offset:256
v_mfma_f32_16x16x32_bf16 v[128:131], a[84:87], a[52:55], v[128:131]
ds_read_b64_tr_b16 a[108:109], v15 offset:2048
v_mfma_f32_16x16x32_bf16 v[128:131], a[80:83], a[36:39], v[128:131]
ds_read_b64_tr_b16 a[110:111], v15 offset:2304
v_mfma_f32_16x16x32_bf16 v[136:139], a[80:83], a[40:43], v[136:139]
buffer_store_dwordx2 v[2:3], off, s[88:91], s101 sc1
v_mfma_f32_16x16x32_bf16 v[136:139], a[84:87], a[56:59], v[136:139]
v_mfma_f32_16x16x32_bf16 v[144:147], a[84:87], a[60:63], v[144:147]
v_mfma_f32_16x16x32_bf16 v[144:147], a[80:83], a[44:47], v[144:147]
v_mfma_f32_16x16x32_bf16 v[148:151], a[88:91], a[44:47], v[148:151]
ds_read_b64_tr_b16 a[80:81], v14 offset:4096
v_mfma_f32_16x16x32_bf16 v[148:151], a[92:95], a[60:63], v[148:151]
ds_read_b64_tr_b16 a[82:83], v14 offset:4352
v_mfma_f32_16x16x32_bf16 v[140:143], a[92:95], a[56:59], v[140:143]
ds_read_b64_tr_b16 a[84:85], v14 offset:6144
v_mfma_f32_16x16x32_bf16 v[140:143], a[88:91], a[40:43], v[140:143]
ds_read_b64_tr_b16 a[86:87], v14 offset:6400
v_mfma_f32_16x16x32_bf16 v[132:135], a[88:91], a[36:39], v[132:135]
v_mfma_f32_16x16x32_bf16 v[132:135], a[92:95], a[52:55], v[132:135]
v_mfma_f32_16x16x32_bf16 v[124:127], a[92:95], a[48:51], v[124:127]
v_mfma_f32_16x16x32_bf16 v[124:127], a[88:91], a[32:35], v[124:127]
s_waitcnt lgkmcnt(4)
v_mfma_f32_16x16x32_bf16 v[152:155], a[96:99], a[32:35], v[152:155]
ds_read_b64_tr_b16 a[88:89], v15 offset:4096
v_mfma_f32_16x16x32_bf16 v[152:155], a[100:103], a[48:51], v[152:155]
ds_read_b64_tr_b16 a[90:91], v15 offset:4352
v_mfma_f32_16x16x32_bf16 v[160:163], a[100:103], a[52:55], v[160:163]
ds_read_b64_tr_b16 a[92:93], v15 offset:6144
v_mfma_f32_16x16x32_bf16 v[160:163], a[96:99], a[36:39], v[160:163]
ds_read_b64_tr_b16 a[94:95], v15 offset:6400
v_mfma_f32_16x16x32_bf16 v[168:171], a[96:99], a[40:43], v[168:171]
v_mfma_f32_16x16x32_bf16 v[168:171], a[100:103], a[56:59], v[168:171]
v_mfma_f32_16x16x32_bf16 v[176:179], a[100:103], a[60:63], v[176:179]
v_mfma_f32_16x16x32_bf16 v[176:179], a[96:99], a[44:47], v[176:179]
v_mfma_f32_16x16x32_bf16 v[180:183], a[104:107], a[44:47], v[180:183]
ds_read_b64_tr_b16 a[96:97], v14 offset:8192
v_mfma_f32_16x16x32_bf16 v[180:183], a[108:111], a[60:63], v[180:183]
ds_read_b64_tr_b16 a[98:99], v14 offset:8448
v_mfma_f32_16x16x32_bf16 v[172:175], a[108:111], a[56:59], v[172:175]
ds_read_b64_tr_b16 a[100:101], v14 offset:10240
v_mfma_f32_16x16x32_bf16 v[172:175], a[104:107], a[40:43], v[172:175]
ds_read_b64_tr_b16 a[102:103], v14 offset:10496
v_mfma_f32_16x16x32_bf16 v[164:167], a[104:107], a[36:39], v[164:167]
v_mfma_f32_16x16x32_bf16 v[164:167], a[108:111], a[52:55], v[164:167]
v_mfma_f32_16x16x32_bf16 v[156:159], a[108:111], a[48:51], v[156:159]
v_mfma_f32_16x16x32_bf16 v[156:159], a[104:107], a[32:35], v[156:159]
s_waitcnt lgkmcnt(4)
v_mfma_f32_16x16x32_bf16 v[184:187], a[80:83], a[32:35], v[184:187]
ds_read_b64_tr_b16 a[104:105], v15 offset:8192
v_mfma_f32_16x16x32_bf16 v[184:187], a[84:87], a[48:51], v[184:187]
ds_read_b64_tr_b16 a[106:107], v15 offset:8448
v_mfma_f32_16x16x32_bf16 v[192:195], a[84:87], a[52:55], v[192:195]
ds_read_b64_tr_b16 a[108:109], v15 offset:10240
v_mfma_f32_16x16x32_bf16 v[192:195], a[80:83], a[36:39], v[192:195]
ds_read_b64_tr_b16 a[110:111], v15 offset:10496
v_add_u32 v12, 0x8000, v12
v_mfma_f32_16x16x32_bf16 v[200:203], a[80:83], a[40:43], v[200:203]
v_add_u32 v13, 0x8000, v13
v_add_u32 v14, 0x8000, v14
v_mfma_f32_16x16x32_bf16 v[200:203], a[84:87], a[56:59], v[200:203]
v_add_u32 v15, 0x8000, v15
v_mfma_f32_16x16x32_bf16 v[208:211], a[84:87], a[60:63], v[208:211]
v_mfma_f32_16x16x32_bf16 v[208:211], a[80:83], a[44:47], v[208:211]
v_mfma_f32_16x16x32_bf16 v[212:215], a[88:91], a[44:47], v[212:215]
s_waitcnt vmcnt(1) lgkmcnt(0)
s_mov_b32 s92, 200000
L_spin_kv:
v_readfirstlane_b32 s93, v23
s_nop 1
s_cmp_ge_u32 s93, 8
s_cbranch_scc1 L_spun_kv
s_sub_u32 s92, s92, 1
s_cbranch_scc1 L_spun_kv
s_sleep 4
buffer_load_dword v23, off, s[84:87], s10 sc1
s_waitcnt vmcnt(0)
s_branch L_spin_kv
L_spun_kv:
v_mfma_f32_16x16x32_bf16 v[212:215], a[92:95], a[60:63], v[212:215]
s_barrier
s_add_u32 m0, s19, 0x0
v_mfma_f32_16x16x32_bf16 v[204:207], a[92:95], a[56:59], v[204:207]
buffer_load_dwordx4 v16, s[48:51], s32 offen offset:0 sc1 lds
v_mfma_f32_16x16x32_bf16 v[204:207], a[88:91], a[40:43], v[204:207]
ds_read_b64_tr_b16 a[80:81], v12 offset:0
v_mov_b32 v3, v16
v_mfma_f32_16x16x32_bf16 v[196:199], a[88:91], a[36:39], v[196:199]
ds_read_b64_tr_b16 a[82:83], v12 offset:1024
v_mov_b32 v22, 0x3f803f80
v_mfma_f32_16x16x32_bf16 v[196:199], a[92:95], a[52:55], v[196:199]
ds_read_b64_tr_b16 a[84:85], v12 offset:8192
s_mov_b32 s33, 0
v_mfma_f32_16x16x32_bf16 v[188:191], a[92:95], a[48:51], v[188:191]
ds_read_b64_tr_b16 a[86:87], v12 offset:9216
v_accvgpr_write_b32 a240, v22
v_mfma_f32_16x16x32_bf16 v[188:191], a[88:91], a[32:35], v[188:191]
s_waitcnt lgkmcnt(4)
v_accvgpr_write_b32 a241, v22
v_accvgpr_write_b32 a242, v22
v_mfma_f32_16x16x32_bf16 v[216:219], a[32:35], a[96:99], v[216:219]
buffer_load_dwordx4 v16, s[48:51], s32 offen offset:1024 sc1 lds
v_accvgpr_write_b32 a243, v22
v_mfma_f32_16x16x32_bf16 v[216:219], a[48:51], a[100:103], v[216:219]
ds_read_b64_tr_b16 a[88:89], v13 offset:0
s_mov_b32 s36, 0x33333333
v_mfma_f32_16x16x32_bf16 v[224:227], a[52:55], a[100:103], v[224:227]
ds_read_b64_tr_b16 a[90:91], v13 offset:1024
s_mov_b32 s37, 0xcccccccc
v_mfma_f32_16x16x32_bf16 v[224:227], a[36:39], a[96:99], v[224:227]
ds_read_b64_tr_b16 a[92:93], v13 offset:8192
v_cndmask_b32 v4, 0, v22, s[36:37]
v_mfma_f32_16x16x32_bf16 v[232:235], a[40:43], a[96:99], v[232:235]
ds_read_b64_tr_b16 a[94:95], v13 offset:9216
v_accvgpr_write_b32 a232, v4
v_mfma_f32_16x16x32_bf16 v[232:235], a[56:59], a[100:103], v[232:235]
v_accvgpr_write_b32 a233, v4
v_accvgpr_write_b32 a234, v4
v_mfma_f32_16x16x32_bf16 v[240:243], a[60:63], a[100:103], v[240:243]
v_accvgpr_write_b32 a235, v4
v_mfma_f32_16x16x32_bf16 v[240:243], a[44:47], a[96:99], v[240:243]
buffer_load_dwordx4 v16, s[48:51], s32 offen offset:2048 sc1 lds
v_mfma_f32_16x16x32_bf16 v[244:247], a[44:47], a[104:107], v[244:247]
ds_read_b64_tr_b16 a[96:97], v12 offset:256
s_mov_b32 s36, 0x44444444
s_mov_b32 s37, 0x44444444
v_mfma_f32_16x16x32_bf16 v[244:247], a[60:63], a[108:111], v[244:247]
ds_read_b64_tr_b16 a[98:99], v12 offset:1280
v_cndmask_b32 v4, 0, v22, s[36:37]
v_mfma_f32_16x16x32_bf16 v[236:239], a[56:59], a[108:111], v[236:239]
ds_read_b64_tr_b16 a[100:101], v12 offset:8448
v_accvgpr_write_b32 a236, v4
v_mfma_f32_16x16x32_bf16 v[236:239], a[40:43], a[104:107], v[236:239]
ds_read_b64_tr_b16 a[102:103], v12 offset:9472
v_accvgpr_write_b32 a237, v4
v_mfma_f32_16x16x32_bf16 v[228:231], a[36:39], a[104:107], v[228:231]
v_accvgpr_write_b32 a238, v4
v_accvgpr_write_b32 a239, v4
v_mfma_f32_16x16x32_bf16 v[228:231], a[52:55], a[108:111], v[228:231]
v_mov_b32 v1, v3
v_add_u32 v2, 98304, v3
v_mfma_f32_16x16x32_bf16 v[220:223], a[48:51], a[108:111], v[220:223]
buffer_load_dwordx4 v16, s[48:51], s32 offen offset:3072 sc1 lds
v_mfma_f32_16x16x32_bf16 v[220:223], a[32:35], a[104:107], v[220:223]
s_waitcnt lgkmcnt(4)
s_mov_b64 s[34:35], 0
v_accvgpr_write_b32 a224, 0
L_S22:
v_mfma_f32_16x16x32_bf16 v[24:27], a[80:83], a[0:3], v[24:27]
ds_read_b64_tr_b16 a[104:105], v13 offset:256
s_waitcnt vmcnt(13)
v_accvgpr_write_b32 a225, 0
v_mfma_f32_16x16x32_bf16 v[24:27], a[84:87], a[16:19], v[24:27]
ds_read_b64_tr_b16 a[106:107], v13 offset:1280
v_accvgpr_write_b32 a226, 0
v_mfma_f32_16x16x32_bf16 v[32:35], a[84:87], a[20:23], v[32:35]
ds_read_b64_tr_b16 a[108:109], v13 offset:8448
v_accvgpr_write_b32 a227, 0
v_mfma_f32_16x16x32_bf16 v[32:35], a[80:83], a[4:7], v[32:35]
ds_read_b64_tr_b16 a[110:111], v13 offset:9472
v_accvgpr_write_b32 a228, 0
v_mfma_f32_16x16x32_bf16 v[40:43], a[80:83], a[8:11], v[40:43]
ds_read_b128 a[32:35], v8 offset:32768
s_add_u32 m0, s19, 0x1000
v_mfma_f32_16x16x32_bf16 v[40:43], a[84:87], a[24:27], v[40:43]
buffer_load_dwordx4 v16, s[48:51], s7 offen offset:0 sc1 lds
v_mfma_f32_16x16x32_bf16 v[48:51], a[84:87], a[28:31], v[48:51]
ds_read_b128 a[48:51], v9 offset:32768
v_accvgpr_write_b32 a229, 0
v_mfma_f32_16x16x32_bf16 v[48:51], a[80:83], a[12:15], v[48:51]
ds_read_b128 a[36:39], v8 offset:34816
L_padA11:
s_cmp_eq_u32 s95, 1
s_cbranch_scc1 L_hopA_ret
v_accvgpr_write_b32 a230, 0
v_mfma_f32_16x16x32_bf16 v[52:55], a[88:91], a[12:15], v[52:55]
ds_read_b64_tr_b16 a[80:81], v12 offset:512
v_accvgpr_write_b32 a231, 0
v_mfma_f32_16x16x32_bf16 v[52:55], a[92:95], a[28:31], v[52:55]
ds_read_b64_tr_b16 a[82:83], v12 offset:1536
s_mul_i32 s8, s6, 0x142400
v_mfma_f32_16x16x32_bf16 v[44:47], a[92:95], a[24:27], v[44:47]
ds_read_b64_tr_b16 a[84:85], v12 offset:8704
s_sub_u32 s9, 0x12e1c00, s8
v_mfma_f32_16x16x32_bf16 v[44:47], a[88:91], a[8:11], v[44:47]
buffer_load_dwordx4 v16, s[48:51], s7 offen offset:1024 sc1 lds
v_mfma_f32_16x16x32_bf16 v[36:39], a[88:91], a[4:7], v[36:39]
ds_read_b64_tr_b16 a[86:87], v12 offset:9728
s_lshl_b32 s11, s5, 13
v_mfma_f32_16x16x32_bf16 v[36:39], a[92:95], a[20:23], v[36:39]
ds_read_b128 a[52:55], v9 offset:34816
s_add_u32 s11, s11, 0x2200000
v_mfma_f32_16x16x32_bf16 v[28:31], a[92:95], a[16:19], v[28:31]
ds_read_b128 a[40:43], v8 offset:36864
s_add_u32 s8, s8, s11
v_mfma_f32_16x16x32_bf16 v[28:31], a[88:91], a[0:3], v[28:31]
ds_read_b128 a[56:59], v9 offset:36864
s_waitcnt lgkmcnt(10)
v_mfma_f32_16x16x32_bf16 v[56:59], a[96:99], a[0:3], v[56:59]
ds_read_b64_tr_b16 a[88:89], v13 offset:512
s_add_u32 s9, s9, s11
s_lshl_b32 s11, s4, 10
v_mfma_f32_16x16x32_bf16 v[56:59], a[100:103], a[16:19], v[56:59]
ds_read_b64_tr_b16 a[90:91], v13 offset:1536
s_add_u32 s44, s8, s11
v_mfma_f32_16x16x32_bf16 v[64:67], a[100:103], a[20:23], v[64:67]
buffer_load_dwordx4 v16, s[48:51], s7 offen offset:2048 sc1 lds
v_mfma_f32_16x16x32_bf16 v[64:67], a[96:99], a[4:7], v[64:67]
ds_read_b64_tr_b16 a[92:93], v13 offset:8704
s_add_u32 s46, s9, s11
v_mfma_f32_16x16x32_bf16 v[72:75], a[96:99], a[8:11], v[72:75]
ds_read_b64_tr_b16 a[94:95], v13 offset:9728
s_sub_u32 s11, 0x1c00, s11
v_mfma_f32_16x16x32_bf16 v[72:75], a[100:103], a[24:27], v[72:75]
ds_read_b128 a[44:47], v8 offset:38912
s_add_u32 s45, s8, s11
v_mfma_f32_16x16x32_bf16 v[80:83], a[100:103], a[28:31], v[80:83]
ds_read_b128 a[60:63], v9 offset:38912
s_add_u32 s47, s9, s11
v_mfma_f32_16x16x32_bf16 v[80:83], a[96:99], a[12:15], v[80:83]
s_mul_i32 s8, s5, 0x6000
s_add_u32 s8, s8, 0x40000
s_add_u32 s28, s44, s8
v_mfma_f32_16x16x32_bf16 v[84:87], a[104:107], a[12:15], v[84:87]
ds_read_b64_tr_b16 a[96:97], v12 offset:768
s_add_u32 s29, s45, s8
s_add_u32 s30, s46, s8
v_mfma_f32_16x16x32_bf16 v[84:87], a[108:111], a[28:31], v[84:87]
buffer_load_dwordx4 v16, s[48:51], s7 offen offset:3072 sc1 lds
v_mfma_f32_16x16x32_bf16 v[76:79], a[108:111], a[24:27], v[76:79]
ds_read_b64_tr_b16 a[98:99], v12 offset:1792
s_add_u32 s32, s32, s94
v_mfma_f32_16x16x32_bf16 v[76:79], a[104:107], a[8:11], v[76:79]
ds_read_b64_tr_b16 a[100:101], v12 offset:8960
s_add_u32 s7, s7, s94
v_mfma_f32_16x16x32_bf16 v[68:71], a[104:107], a[4:7], v[68:71]
ds_read_b64_tr_b16 a[102:103], v12 offset:9984
s_add_u32 s31, s47, s8
v_mfma_f32_16x16x32_bf16 v[68:71], a[108:111], a[20:23], v[68:71]
s_lshl_b32 s8, s4, 11
s_add_u32 s9, s8, 131072
v_add_u32 v4, s9, v16
v_mfma_f32_16x16x32_bf16 v[60:63], a[108:111], a[16:19], v[60:63]
s_sub_u32 s9, 145408, s8
s_cmp_eq_u32 s4, 0
s_cselect_b32 s8, 131072, s9
v_mfma_f32_16x16x32_bf16 v[60:63], a[104:107], a[0:3], v[60:63]
s_add_u32 m0, s19, 0x18000
s_waitcnt lgkmcnt(6)
v_add_u32 v5, s8, v16
v_mfma_f32_16x16x32_bf16 v[88:91], a[80:83], a[0:3], v[88:91]
buffer_load_dwordx4 v16, s[48:51], s32 offen offset:0 sc1 lds
v_add_u32 v6, s9, v16
v_mfma_f32_16x16x32_bf16 v[88:91], a[84:87], a[16:19], v[88:91]
ds_read_b64_tr_b16 a[104:105], v13 offset:768
v_add_u32 v22, 0x800, v10
v_mfma_f32_16x16x32_bf16 v[96:99], a[84:87], a[20:23], v[96:99]
ds_read_b64_tr_b16 a[106:107], v13 offset:1792
s_mov_b32 s8, 0x800
v_mfma_f32_16x16x32_bf16 v[96:99], a[80:83], a[4:7], v[96:99]
ds_read_b64_tr_b16 a[108:109], v13 offset:8960
v_mfma_f32_16x16x32_bf16 v[104:107], a[80:83], a[8:11], v[104:107]
ds_read_b64_tr_b16 a[110:111], v13 offset:9984
v_mfma_f32_16x16x32_bf16 v[104:107], a[84:87], a[24:27], v[104:107]
s_cmp_eq_u32 s6, 0
s_cselect_b32 s8, 0xffff8800, s8
v_add_u32 v7, s8, v11
v_mfma_f32_16x16x32_bf16 v[112:115], a[84:87], a[28:31], v[112:115]
buffer_load_dwordx4 v16, s[48:51], s32 offen offset:1024 sc1 lds
v_mfma_f32_16x16x32_bf16 v[112:115], a[80:83], a[12:15], v[112:115]
s_bfe_u32 s99, s2, 0x20001
s_lshl_b32 s99, s99, 2
s_lshr_b32 s8, s2, 6
v_mfma_f32_16x16x32_bf16 v[116:119], a[88:91], a[12:15], v[116:119]
ds_read_b64_tr_b16 a[80:81], v14 offset:0
s_add_u32 s99, s99, s8
s_bfe_u32 s100, s2, 0x30003
v_mfma_f32_16x16x32_bf16 v[116:119], a[92:95], a[28:31], v[116:119]
ds_read_b64_tr_b16 a[82:83], v14 offset:256
s_and_b32 s14, s2, 1
v_mfma_f32_16x16x32_bf16 v[108:111], a[92:95], a[24:27], v[108:111]
ds_read_b64_tr_b16 a[84:85], v14 offset:2048
s_sub_u32 s24, 15, s99
v_mfma_f32_16x16x32_bf16 v[108:111], a[88:91], a[8:11], v[108:111]
ds_read_b64_tr_b16 a[86:87], v14 offset:2304
s_min_u32 s18, s24, s99
v_mfma_f32_16x16x32_bf16 v[100:103], a[88:91], a[4:7], v[100:103]
buffer_load_dwordx4 v16, s[48:51], s32 offen offset:2048 sc1 lds
v_mfma_f32_16x16x32_bf16 v[100:103], a[92:95], a[20:23], v[100:103]
s_lshl_b32 s24, s18, 1
s_add_u32 s24, s24, s14
s_lshl_b32 s24, s24, 8
v_mfma_f32_16x16x32_bf16 v[92:95], a[92:95], a[16:19], v[92:95]
s_add_u32 s24, s24, 0x3704000
s_mov_b32 s12, 14336
s_and_b32 s16, s6, 1
v_mfma_f32_16x16x32_bf16 v[92:95], a[88:91], a[0:3], v[92:95]
s_waitcnt lgkmcnt(4)
s_lshl_b32 s16, s16, 15
s_add_u32 s16, s16, 98304
v_mfma_f32_16x16x32_bf16 v[120:123], a[96:99], a[0:3], v[120:123]
ds_read_b64_tr_b16 a[88:89], v15 offset:0
s_add_u32 s16, s16, s17
s_lshl_b32 s13, s4, 15
v_mfma_f32_16x16x32_bf16 v[120:123], a[100:103], a[16:19], v[120:123]
ds_read_b64_tr_b16 a[90:91], v15 offset:256
s_lshl_b32 s9, s100, 8
v_mfma_f32_16x16x32_bf16 v[128:131], a[100:103], a[20:23], v[128:131]
buffer_load_dwordx4 v16, s[48:51], s32 offen offset:3072 sc1 lds
v_mfma_f32_16x16x32_bf16 v[128:131], a[96:99], a[4:7], v[128:131]
ds_read_b64_tr_b16 a[92:93], v15 offset:2048
s_add_u32 s13, s13, s9
v_mfma_f32_16x16x32_bf16 v[136:139], a[96:99], a[8:11], v[136:139]
ds_read_b64_tr_b16 a[94:95], v15 offset:2304
s_mul_i32 s9, s14, 0x100080
v_mfma_f32_16x16x32_bf16 v[136:139], a[100:103], a[24:27], v[136:139]
s_add_u32 s13, s13, s9
s_mul_i32 s25, s14, 0x300000
s_sub_u32 s25, s25, 917504
v_mfma_f32_16x16x32_bf16 v[144:147], a[100:103], a[28:31], v[144:147]
s_mul_i32 s101, s99, 0x142400
s_lshl_b32 s8, s4, 11
s_add_u32 s101, s101, s8
v_mfma_f32_16x16x32_bf16 v[144:147], a[96:99], a[12:15], v[144:147]
s_add_u32 m0, s19, 0x19000
s_lshl_b32 s8, s14, 17
s_add_u32 s101, s101, s8
v_mfma_f32_16x16x32_bf16 v[148:151], a[104:107], a[12:15], v[148:151]
buffer_load_dwordx4 v16, s[48:51], s7 offen offset:0 sc1 lds
s_add_u32 s101, s101, 0x21fe000
v_mfma_f32_16x16x32_bf16 v[148:151], a[108:111], a[28:31], v[148:151]
ds_read_b64_tr_b16 a[96:97], v14 offset:4096
s_mul_i32 s26, s14, 393216
v_mfma_f32_16x16x32_bf16 v[140:143], a[108:111], a[24:27], v[140:143]
ds_read_b64_tr_b16 a[98:99], v14 offset:4352
s_add_u32 s26, s26, 139264
v_mfma_f32_16x16x32_bf16 v[140:143], a[104:107], a[8:11], v[140:143]
ds_read_b64_tr_b16 a[100:101], v14 offset:6144
s_mov_b32 s52, 0x3e0293ee
v_mfma_f32_16x16x32_bf16 v[132:135], a[104:107], a[4:7], v[132:135]
ds_read_b64_tr_b16 a[102:103], v14 offset:6400
s_mov_b32 s53, 0x3e0293ee
v_mfma_f32_16x16x32_bf16 v[132:135], a[108:111], a[20:23], v[132:135]
s_mov_b32 s54, 0x3e8293ee
s_or_b32 s55, s6, s4
s_cselect_b32 s55, 0, 0xf149f2ca
v_mfma_f32_16x16x32_bf16 v[124:127], a[108:111], a[16:19], v[124:127]
s_waitcnt lgkmcnt(4)
s_mov_b32 s56, 0x50000
s_mov_b32 s57, 0x5550055
v_mfma_f32_16x16x32_bf16 v[124:127], a[104:107], a[0:3], v[124:127]
buffer_load_dwordx4 v16, s[48:51], s7 offen offset:1024 sc1 lds
v_mfma_f32_16x16x32_bf16 v[152:155], a[80:83], a[0:3], v[152:155]
ds_read_b64_tr_b16 a[104:105], v15 offset:4096
s_mov_b32 s58, 0xa0000
s_mov_b32 s59, 0xaaa00aa
v_mfma_f32_16x16x32_bf16 v[152:155], a[84:87], a[16:19], v[152:155]
ds_read_b64_tr_b16 a[106:107], v15 offset:4352
s_mov_b32 s60, 0x150001
v_mfma_f32_16x16x32_bf16 v[160:163], a[84:87], a[20:23], v[160:163]
ds_read_b64_tr_b16 a[108:109], v15 offset:6144
s_mov_b32 s61, 0x15550155
v_mfma_f32_16x16x32_bf16 v[160:163], a[80:83], a[4:7], v[160:163]
ds_read_b64_tr_b16 a[110:111], v15 offset:6400
s_mov_b32 s62, 0x2a0002
v_mfma_f32_16x16x32_bf16 v[168:171], a[80:83], a[8:11], v[168:171]
s_mov_b32 s63, 0x2aaa02aa
s_mov_b32 s68, 0x55505555
s_mov_b32 s69, 0x50005500
v_mfma_f32_16x16x32_bf16 v[168:171], a[84:87], a[24:27], v[168:171]
buffer_load_dwordx4 v16, s[48:51], s7 offen offset:2048 sc1 lds
v_mfma_f32_16x16x32_bf16 v[176:179], a[84:87], a[28:31], v[176:179]
s_mov_b32 s70, 0xaaa0aaaa
s_mov_b32 s71, 0xa000aa00
s_mov_b32 s76, 0x55405554
v_mfma_f32_16x16x32_bf16 v[176:179], a[80:83], a[12:15], v[176:179]
s_mov_b32 s77, 0x40005400
s_mov_b32 s78, 0xaa80aaa8
s_mov_b32 s79, 0x8000a800
v_mfma_f32_16x16x32_bf16 v[180:183], a[88:91], a[12:15], v[180:183]
ds_read_b64_tr_b16 a[80:81], v14 offset:8192
s_mov_b32 s11, 0xf149f2ca
s_mov_b32 s36, 0xfff0ffff
v_mfma_f32_16x16x32_bf16 v[180:183], a[92:95], a[28:31], v[180:183]
ds_read_b64_tr_b16 a[82:83], v14 offset:8448
s_mov_b32 s37, 0xf000ff00
v_mfma_f32_16x16x32_bf16 v[172:175], a[92:95], a[24:27], v[172:175]
ds_read_b64_tr_b16 a[84:85], v14 offset:10240
s_mov_b32 s38, 0xffe0fffe
v_mfma_f32_16x16x32_bf16 v[172:175], a[88:91], a[8:11], v[172:175]
buffer_load_dwordx4 v16, s[48:51], s7 offen offset:3072 sc1 lds
v_mfma_f32_16x16x32_bf16 v[164:167], a[88:91], a[4:7], v[164:167]
ds_read_b64_tr_b16 a[86:87], v14 offset:10496
s_add_u32 s32, s32, 0x8000
v_mfma_f32_16x16x32_bf16 v[164:167], a[92:95], a[20:23], v[164:167]
s_add_u32 s7, s7, 0x8000
s_mov_b32 s39, 0xe000fe00
s_mov_b32 s40, 0xffc0fffc
v_mfma_f32_16x16x32_bf16 v[156:159], a[92:95], a[16:19], v[156:159]
s_mov_b32 s41, 0xc000fc00
s_mov_b32 s42, 0xff80fff8
s_mov_b32 s43, 0x8000f800
v_mfma_f32_16x16x32_bf16 v[156:159], a[88:91], a[0:3], v[156:159]
s_waitcnt lgkmcnt(4)
v_mov_b32 v21, s1
v_mfma_f32_16x16x32_bf16 v[184:187], a[96:99], a[0:3], v[184:187]
ds_read_b64_tr_b16 a[88:89], v15 offset:8192
v_add_u32 v20, s0, v16
v_mfma_f32_16x16x32_bf16 v[184:187], a[100:103], a[16:19], v[184:187]
global_load_dword a120, v[20:21], off sc1
v_mfma_f32_16x16x32_bf16 v[192:195], a[100:103], a[20:23], v[192:195]
ds_read_b64_tr_b16 a[90:91], v15 offset:8448
v_mfma_f32_16x16x32_bf16 v[192:195], a[96:99], a[4:7], v[192:195]
ds_read_b64_tr_b16 a[92:93], v15 offset:10240
v_mfma_f32_16x16x32_bf16 v[200:203], a[96:99], a[8:11], v[200:203]
ds_read_b64_tr_b16 a[94:95], v15 offset:10496
v_add_u32 v12, 0x8000, v12
v_mfma_f32_16x16x32_bf16 v[200:203], a[100:103], a[24:27], v[200:203]
v_add_u32 v13, 0x8000, v13
v_add_u32 v14, 0x8000, v14
v_mfma_f32_16x16x32_bf16 v[208:211], a[100:103], a[28:31], v[208:211]
v_add_u32 v15, 0x8000, v15
v_mfma_f32_16x16x32_bf16 v[208:211], a[96:99], a[12:15], v[208:211]
s_bitcmp1_b32 s4, 0
s_cselect_b32 s8, 0x7f800000, s11
s_cselect_b32 s9, s11, 0x7f800000
v_mfma_f32_16x16x32_bf16 v[212:215], a[104:107], a[12:15], v[212:215]
s_waitcnt vmcnt(19) lgkmcnt(0)
v_mfma_f32_16x16x32_bf16 v[212:215], a[108:111], a[28:31], v[212:215]
s_barrier
s_add_u32 m0, s19, 0x8000
v_mfma_f32_16x16x32_bf16 v[204:207], a[108:111], a[24:27], v[204:207]
buffer_load_dwordx4 v16, s[48:51], s32 offen offset:0 sc1 lds
v_mfma_f32_16x16x32_bf16 v[204:207], a[104:107], a[8:11], v[204:207]
ds_read_b64_tr_b16 a[96:97], v14 offset:4096
v_mfma_f32_16x16x32_bf16 v[196:199], a[104:107], a[4:7], v[196:199]
ds_read_b64_tr_b16 a[98:99], v14 offset:4352
v_mfma_f32_16x16x32_bf16 v[196:199], a[108:111], a[20:23], v[196:199]
ds_read_b64_tr_b16 a[100:101], v14 offset:6144
v_mfma_f32_16x16x32_bf16 v[188:191], a[108:111], a[16:19], v[188:191]
buffer_load_dwordx4 v16, s[48:51], s32 offen offset:1024 sc1 lds
v_mfma_f32_16x16x32_bf16 v[188:191], a[104:107], a[0:3], v[188:191]
ds_read_b64_tr_b16 a[102:103], v14 offset:6400
s_waitcnt lgkmcnt(4)
v_mfma_f32_16x16x32_bf16 v[216:219], a[0:3], a[80:83], v[216:219]
ds_read_b64_tr_b16 a[104:105], v15 offset:4096
v_mfma_f32_16x16x32_bf16 v[216:219], a[16:19], a[84:87], v[216:219]
ds_read_b64_tr_b16 a[106:107], v15 offset:4352
v_mfma_f32_16x16x32_bf16 v[224:227], a[20:23], a[84:87], v[224:227]
ds_read_b64_tr_b16 a[108:109], v15 offset:6144
v_mfma_f32_16x16x32_bf16 v[224:227], a[4:7], a[80:83], v[224:227]
buffer_store_dwordx4 a[64:67], v16, s[88:91], s15 offen offset:0 sc1
v_mfma_f32_16x16x32_bf16 v[232:235], a[8:11], a[80:83], v[232:235]
ds_read_b64_tr_b16 a[110:111], v15 offset:6400
v_mfma_f32_16x16x32_bf16 v[232:235], a[24:27], a[84:87], v[232:235]
v_mfma_f32_16x16x32_bf16 v[240:243], a[28:31], a[84:87], v[240:243]
v_mfma_f32_16x16x32_bf16 v[240:243], a[12:15], a[80:83], v[240:243]
buffer_load_dwordx4 v16, s[48:51], s32 offen offset:2048 sc1 lds
v_mfma_f32_16x16x32_bf16 v[244:247], a[12:15], a[88:91], v[244:247]
ds_read_b64_tr_b16 a[80:81], v14 offset:8192
v_mfma_f32_16x16x32_bf16 v[244:247], a[28:31], a[92:95], v[244:247]
ds_read_b64_tr_b16 a[82:83], v14 offset:8448
v_mfma_f32_16x16x32_bf16 v[236:239], a[24:27], a[92:95], v[236:239]
ds_read_b64_tr_b16 a[84:85], v14 offset:10240
v_mfma_f32_16x16x32_bf16 v[236:239], a[8:11], a[88:91], v[236:239]
ds_read_b64_tr_b16 a[86:87], v14 offset:10496
v_mfma_f32_16x16x32_bf16 v[228:231], a[4:7], a[88:91], v[228:231]
buffer_load_dwordx4 v16, s[48:51], s32 offen offset:3072 sc1 lds
v_mfma_f32_16x16x32_bf16 v[228:231], a[20:23], a[92:95], v[228:231]
v_mfma_f32_16x16x32_bf16 v[220:223], a[16:19], a[92:95], v[220:223]
v_mfma_f32_16x16x32_bf16 v[220:223], a[0:3], a[88:91], v[220:223]
s_waitcnt lgkmcnt(4)
L_S23:
v_mfma_f32_16x16x32_bf16 v[184:187], a[96:99], a[32:35], v[184:187]
buffer_store_dwordx4 a[64:67], v16, s[88:91], s15 offen offset:1024 sc1
v_mfma_f32_16x16x32_bf16 v[184:187], a[100:103], a[48:51], v[184:187]
ds_read_b64_tr_b16 a[88:89], v15 offset:8192
v_mov_b32 v8, v19
v_mfma_f32_16x16x32_bf16 v[192:195], a[100:103], a[52:55], v[192:195]
ds_read_b64_tr_b16 a[90:91], v15 offset:8448
v_mov_b32 v9, 0xf149f2ca
v_mov_b32 v248, 0xffff
v_mfma_f32_16x16x32_bf16 v[192:195], a[96:99], a[36:39], v[192:195]
ds_read_b64_tr_b16 a[92:93], v15 offset:10240
v_mov_b32 v249, 0xffff0000
v_mfma_f32_16x16x32_bf16 v[200:203], a[96:99], a[40:43], v[200:203]
ds_read_b64_tr_b16 a[94:95], v15 offset:10496
s_add_u32 m0, s19, 0x9000
v_mfma_f32_16x16x32_bf16 v[200:203], a[100:103], a[56:59], v[200:203]
buffer_load_dwordx4 v16, s[48:51], s7 offen offset:0 sc1 lds
v_mfma_f32_16x16x32_bf16 v[208:211], a[100:103], a[60:63], v[208:211]
v_cndmask_b32 v252, 0, v248, s[56:57]
v_cndmask_b32 v252, v252, v249, s[58:59]
v_mfma_f32_16x16x32_bf16 v[208:211], a[96:99], a[44:47], v[208:211]
v_cndmask_b32 v253, 0, v248, s[60:61]
v_cndmask_b32 v253, v253, v249, s[62:63]
v_mfma_f32_16x16x32_bf16 v[212:215], a[104:107], a[44:47], v[212:215]
ds_read_b64_tr_b16 a[96:97], v14 offset:0
v_cndmask_b32 v254, 0, v248, s[68:69]
v_cndmask_b32 v254, v254, v249, s[70:71]
v_mfma_f32_16x16x32_bf16 v[212:215], a[108:111], a[60:63], v[212:215]
buffer_load_dwordx4 v16, s[48:51], s7 offen offset:1024 sc1 lds
v_mfma_f32_16x16x32_bf16 v[204:207], a[108:111], a[56:59], v[204:207]
ds_read_b64_tr_b16 a[98:99], v14 offset:256
v_cndmask_b32 v255, 0, v248, s[76:77]
v_mfma_f32_16x16x32_bf16 v[204:207], a[104:107], a[40:43], v[204:207]
ds_read_b64_tr_b16 a[100:101], v14 offset:2048
v_cndmask_b32 v255, v255, v249, s[78:79]
v_mfma_f32_16x16x32_bf16 v[196:199], a[104:107], a[36:39], v[196:199]
ds_read_b64_tr_b16 a[102:103], v14 offset:2304
v_cndmask_b32 v248, v9, 0, s[68:69]
v_mfma_f32_16x16x32_bf16 v[196:199], a[108:111], a[52:55], v[196:199]
v_cndmask_b32 v249, v9, 0, s[70:71]
v_cndmask_b32 v250, v9, 0, s[76:77]
v_mfma_f32_16x16x32_bf16 v[188:191], a[108:111], a[48:51], v[188:191]
buffer_store_dwordx4 a[64:67], v16, s[88:91], s15 offen offset:2048 sc1
v_cndmask_b32 v251, v9, 0, s[78:79]
v_mfma_f32_16x16x32_bf16 v[188:191], a[104:107], a[32:35], v[188:191]
s_waitcnt lgkmcnt(4)
v_mfma_f32_16x16x32_bf16 v[216:219], a[32:35], a[80:83], v[216:219]
ds_read_b64_tr_b16 a[104:105], v15 offset:0
v_mfma_f32_16x16x32_bf16 v[216:219], a[48:51], a[84:87], v[216:219]
ds_read_b64_tr_b16 a[106:107], v15 offset:256
v_mfma_f32_16x16x32_bf16 v[224:227], a[52:55], a[84:87], v[224:227]
buffer_load_dwordx4 v16, s[48:51], s7 offen offset:2048 sc1 lds
v_mfma_f32_16x16x32_bf16 v[224:227], a[36:39], a[80:83], v[224:227]
ds_read_b64_tr_b16 a[108:109], v15 offset:2048
v_cvt_pk_bf16_f32 v192, v192, v193
v_mfma_f32_16x16x32_bf16 v[232:235], a[40:43], a[80:83], v[232:235]
ds_read_b64_tr_b16 a[110:111], v15 offset:2304
v_cvt_pk_bf16_f32 v193, v194, v195
v_cvt_pk_bf16_f32 v194, v196, v197
v_mfma_f32_16x16x32_bf16 v[232:235], a[56:59], a[84:87], v[232:235]
v_cvt_pk_bf16_f32 v195, v198, v199
v_cvt_pk_bf16_f32 v208, v208, v209
v_mfma_f32_16x16x32_bf16 v[240:243], a[60:63], a[84:87], v[240:243]
v_cvt_pk_bf16_f32 v209, v210, v211
v_cvt_pk_bf16_f32 v210, v212, v213
v_mfma_f32_16x16x32_bf16 v[240:243], a[44:47], a[80:83], v[240:243]
buffer_load_dwordx4 v16, s[48:51], s7 offen offset:3072 sc1 lds
v_mfma_f32_16x16x32_bf16 v[244:247], a[44:47], a[88:91], v[244:247]
ds_read_b64_tr_b16 a[80:81], v12 offset:0
s_add_u32 s32, s32, 0x8000
v_mfma_f32_16x16x32_bf16 v[244:247], a[60:63], a[92:95], v[244:247]
ds_read_b64_tr_b16 a[82:83], v12 offset:1024
s_add_u32 s7, s7, 0x8000
v_mfma_f32_16x16x32_bf16 v[236:239], a[56:59], a[92:95], v[236:239]
ds_read_b64_tr_b16 a[84:85], v12 offset:8192
v_cvt_pk_bf16_f32 v211, v214, v215
v_mfma_f32_16x16x32_bf16 v[236:239], a[40:43], a[88:91], v[236:239]
buffer_store_dwordx4 a[64:67], v16, s[88:91], s15 offen offset:3072 sc1
v_mfma_f32_16x16x32_bf16 v[228:231], a[36:39], a[88:91], v[228:231]
ds_read_b64_tr_b16 a[86:87], v12 offset:9216
v_mfma_f32_16x16x32_bf16 v[228:231], a[52:55], a[92:95], v[228:231]
s_cmp_lg_u32 s4, 0
s_cbranch_scc1 L_hx0
buffer_store_dwordx4 v[192:195], v22, s[88:91], 0 offen offset:0 sc1
buffer_store_dwordx4 v[208:211], v7, s[88:91], 0 offen offset:0 sc1
L_hx0:
v_mfma_f32_16x16x32_bf16 v[220:223], a[48:51], a[92:95], v[220:223]
v_cvt_pk_bf16_f32 v184, v184, v185
v_cvt_pk_bf16_f32 v185, v186, v187
v_mfma_f32_16x16x32_bf16 v[220:223], a[32:35], a[88:91], v[220:223]
s_waitcnt lgkmcnt(4)
v_cvt_pk_bf16_f32 v186, v188, v189
v_cvt_pk_bf16_f32 v187, v190, v191
v_mfma_f32_16x16x32_bf16 v[152:155], a[96:99], a[32:35], v[152:155]
ds_read_b64_tr_b16 a[88:89], v13 offset:0
v_cvt_pk_bf16_f32 v200, v200, v201
v_cvt_pk_bf16_f32 v201, v202, v203
v_mfma_f32_16x16x32_bf16 v[152:155], a[100:103], a[48:51], v[152:155]
ds_read_b64_tr_b16 a[90:91], v13 offset:1024
v_cvt_pk_bf16_f32 v202, v204, v205
v_mfma_f32_16x16x32_bf16 v[160:163], a[100:103], a[52:55], v[160:163]
ds_read_b64_tr_b16 a[92:93], v13 offset:8192
v_cvt_pk_bf16_f32 v203, v206, v207
v_mfma_f32_16x16x32_bf16 v[160:163], a[96:99], a[36:39], v[160:163]
ds_read_b64_tr_b16 a[94:95], v13 offset:9216
v_mfma_f32_16x16x32_bf16 v[168:171], a[96:99], a[40:43], v[168:171]
ds_write_b128 v5, v[192:195] offset:2048
v_mfma_f32_16x16x32_bf16 v[168:171], a[100:103], a[56:59], v[168:171]
ds_write_b128 v5, v[208:211] offset:18432
v_mfma_f32_16x16x32_bf16 v[176:179], a[100:103], a[60:63], v[176:179]
ds_write_b128 v4, v[184:187] offset:2048
v_mfma_f32_16x16x32_bf16 v[176:179], a[96:99], a[44:47], v[176:179]
ds_write_b128 v4, v[200:203] offset:18432
v_mfma_f32_16x16x32_bf16 v[180:183], a[104:107], a[44:47], v[180:183]
ds_read_b64_tr_b16 a[96:97], v12 offset:256
v_cvt_pk_bf16_f32 v231, v230, v231
v_mfma_f32_16x16x32_bf16 v[180:183], a[108:111], a[60:63], v[180:183]
ds_read_b64_tr_b16 a[98:99], v12 offset:1280
v_cvt_pk_bf16_f32 v230, v228, v229
v_mfma_f32_16x16x32_bf16 v[172:175], a[108:111], a[56:59], v[172:175]
ds_read_b64_tr_b16 a[100:101], v12 offset:8448
v_cvt_pk_bf16_f32 v228, v224, v225
v_mfma_f32_16x16x32_bf16 v[172:175], a[104:107], a[40:43], v[172:175]
ds_read_b64_tr_b16 a[102:103], v12 offset:9472
v_cvt_pk_bf16_f32 v229, v226, v227
v_mfma_f32_16x16x32_bf16 v[164:167], a[104:107], a[36:39], v[164:167]
v_cvt_pk_bf16_f32 v227, v226, v227
v_cvt_pk_bf16_f32 v226, v224, v225
v_cvt_pk_bf16_f32 v247, v246, v247
v_mfma_f32_16x16x32_bf16 v[164:167], a[108:111], a[52:55], v[164:167]
v_cvt_pk_bf16_f32 v246, v244, v245
v_cvt_pk_bf16_f32 v244, v240, v241
v_mfma_f32_16x16x32_bf16 v[156:159], a[108:111], a[48:51], v[156:159]
v_cvt_pk_bf16_f32 v245, v242, v243
v_cvt_pk_bf16_f32 v243, v242, v243
v_mfma_f32_16x16x32_bf16 v[156:159], a[104:107], a[32:35], v[156:159]
s_waitcnt lgkmcnt(4)
v_cvt_pk_bf16_f32 v242, v240, v241
v_mfma_f32_16x16x32_bf16 v[24:27], a[80:83], a[32:35], v[24:27]
ds_read_b64_tr_b16 a[104:105], v13 offset:256
v_mfma_f32_16x16x32_bf16 v[24:27], a[84:87], a[48:51], v[24:27]
ds_read_b64_tr_b16 a[106:107], v13 offset:1280
v_mfma_f32_16x16x32_bf16 v[32:35], a[84:87], a[52:55], v[32:35]
ds_read_b64_tr_b16 a[108:109], v13 offset:8448
v_mfma_f32_16x16x32_bf16 v[32:35], a[80:83], a[36:39], v[32:35]
ds_read_b64_tr_b16 a[110:111], v13 offset:9472
v_mfma_f32_16x16x32_bf16 v[40:43], a[80:83], a[40:43], v[40:43]
s_cmp_lg_u32 s4, 0
s_cbranch_scc1 L_hx1
buffer_store_dwordx4 v[228:231], v22, s[88:91], 0 offen offset:1024 sc1
buffer_store_dwordx4 v[244:247], v7, s[88:91], 0 offen offset:1024 sc1
L_hx1:
v_mfma_f32_16x16x32_bf16 v[40:43], a[84:87], a[56:59], v[40:43]
v_cvt_pk_bf16_f32 v223, v222, v223
v_cvt_pk_bf16_f32 v222, v220, v221
v_mfma_f32_16x16x32_bf16 v[48:51], a[84:87], a[60:63], v[48:51]
v_cvt_pk_bf16_f32 v220, v216, v217
v_cvt_pk_bf16_f32 v221, v218, v219
v_mfma_f32_16x16x32_bf16 v[48:51], a[80:83], a[44:47], v[48:51]
v_cvt_pk_bf16_f32 v219, v218, v219
v_cvt_pk_bf16_f32 v218, v216, v217
v_mfma_f32_16x16x32_bf16 v[52:55], a[88:91], a[44:47], v[52:55]
ds_read_b64_tr_b16 a[80:81], v12 offset:512
v_cvt_pk_bf16_f32 v239, v238, v239
v_cvt_pk_bf16_f32 v238, v236, v237
v_mfma_f32_16x16x32_bf16 v[52:55], a[92:95], a[60:63], v[52:55]
ds_read_b64_tr_b16 a[82:83], v12 offset:1536
v_cvt_pk_bf16_f32 v236, v232, v233
v_mfma_f32_16x16x32_bf16 v[44:47], a[92:95], a[56:59], v[44:47]
ds_read_b64_tr_b16 a[84:85], v12 offset:8704
v_cvt_pk_bf16_f32 v237, v234, v235
v_mfma_f32_16x16x32_bf16 v[44:47], a[88:91], a[40:43], v[44:47]
ds_read_b64_tr_b16 a[86:87], v12 offset:9728
v_cvt_pk_bf16_f32 v235, v234, v235
v_mfma_f32_16x16x32_bf16 v[36:39], a[88:91], a[36:39], v[36:39]
v_cvt_pk_bf16_f32 v234, v232, v233
v_mfma_f32_16x16x32_bf16 v[36:39], a[92:95], a[52:55], v[36:39]
ds_write_b128 v5, v[228:231] offset:3072
v_mfma_f32_16x16x32_bf16 v[28:31], a[92:95], a[48:51], v[28:31]
ds_write_b128 v5, v[244:247] offset:19456
v_mfma_f32_16x16x32_bf16 v[28:31], a[88:91], a[32:35], v[28:31]
s_waitcnt lgkmcnt(4)
v_mfma_f32_16x16x32_bf16 v[56:59], a[96:99], a[32:35], v[56:59]
ds_read_b64_tr_b16 a[88:89], v13 offset:512
v_mfma_f32_16x16x32_bf16 v[56:59], a[100:103], a[48:51], v[56:59]
ds_read_b64_tr_b16 a[90:91], v13 offset:1536
v_mfma_f32_16x16x32_bf16 v[64:67], a[100:103], a[52:55], v[64:67]
ds_read_b64_tr_b16 a[92:93], v13 offset:8704
v_mfma_f32_16x16x32_bf16 v[64:67], a[96:99], a[36:39], v[64:67]
ds_read_b64_tr_b16 a[94:95], v13 offset:9728
v_mfma_f32_16x16x32_bf16 v[72:75], a[96:99], a[40:43], v[72:75]
ds_write_b128 v4, v[220:223] offset:3072
v_mfma_f32_16x16x32_bf16 v[72:75], a[100:103], a[56:59], v[72:75]
ds_write_b128 v4, v[236:239] offset:19456
v_mfma_f32_16x16x32_bf16 v[80:83], a[100:103], a[60:63], v[80:83]
v_cvt_pk_bf16_f32 v152, v152, v153
v_cvt_pk_bf16_f32 v153, v154, v155
v_mfma_f32_16x16x32_bf16 v[80:83], a[96:99], a[44:47], v[80:83]
v_cvt_pk_bf16_f32 v154, v156, v157
v_cvt_pk_bf16_f32 v155, v158, v159
v_mfma_f32_16x16x32_bf16 v[84:87], a[104:107], a[44:47], v[84:87]
ds_read_b64_tr_b16 a[96:97], v12 offset:768
v_cvt_pk_bf16_f32 v160, v160, v161
v_mfma_f32_16x16x32_bf16 v[84:87], a[108:111], a[60:63], v[84:87]
ds_read_b64_tr_b16 a[98:99], v12 offset:1792
v_cvt_pk_bf16_f32 v161, v162, v163
v_mfma_f32_16x16x32_bf16 v[76:79], a[108:111], a[56:59], v[76:79]
ds_read_b64_tr_b16 a[100:101], v12 offset:8960
v_cvt_pk_bf16_f32 v162, v164, v165
v_cvt_pk_bf16_f32 v163, v166, v167
v_mfma_f32_16x16x32_bf16 v[76:79], a[104:107], a[40:43], v[76:79]
ds_read_b64_tr_b16 a[102:103], v12 offset:9984
v_cvt_pk_bf16_f32 v168, v168, v169
v_mfma_f32_16x16x32_bf16 v[68:71], a[104:107], a[36:39], v[68:71]
v_cvt_pk_bf16_f32 v169, v170, v171
v_cvt_pk_bf16_f32 v170, v172, v173
v_mfma_f32_16x16x32_bf16 v[68:71], a[108:111], a[52:55], v[68:71]
v_cvt_pk_bf16_f32 v171, v174, v175
v_cvt_pk_bf16_f32 v176, v176, v177
v_mfma_f32_16x16x32_bf16 v[60:63], a[108:111], a[48:51], v[60:63]
v_cvt_pk_bf16_f32 v177, v178, v179
v_cvt_pk_bf16_f32 v178, v180, v181
v_mfma_f32_16x16x32_bf16 v[60:63], a[104:107], a[32:35], v[60:63]
s_waitcnt lgkmcnt(4)
v_cvt_pk_bf16_f32 v179, v182, v183
v_mfma_f32_16x16x32_bf16 v[88:91], a[80:83], a[32:35], v[88:91]
ds_read_b64_tr_b16 a[104:105], v13 offset:768
v_mfma_f32_16x16x32_bf16 v[88:91], a[84:87], a[48:51], v[88:91]
ds_read_b64_tr_b16 a[106:107], v13 offset:1792
v_mfma_f32_16x16x32_bf16 v[96:99], a[84:87], a[52:55], v[96:99]
ds_read_b64_tr_b16 a[108:109], v13 offset:8960
v_mfma_f32_16x16x32_bf16 v[96:99], a[80:83], a[36:39], v[96:99]
ds_read_b64_tr_b16 a[110:111], v13 offset:9984
v_mfma_f32_16x16x32_bf16 v[104:107], a[80:83], a[40:43], v[104:107]
v_mfma_f32_16x16x32_bf16 v[104:107], a[84:87], a[56:59], v[104:107]
v_mfma_f32_16x16x32_bf16 v[112:115], a[84:87], a[60:63], v[112:115]
v_mfma_f32_16x16x32_bf16 v[112:115], a[80:83], a[44:47], v[112:115]
v_mfma_f32_16x16x32_bf16 v[116:119], a[88:91], a[44:47], v[116:119]
v_mfma_f32_16x16x32_bf16 v[116:119], a[92:95], a[60:63], v[116:119]
v_mfma_f32_16x16x32_bf16 v[108:111], a[92:95], a[56:59], v[108:111]
v_mfma_f32_16x16x32_bf16 v[108:111], a[88:91], a[40:43], v[108:111]
v_mov_b32 v15, s6
v_writelane_b32 v15, s18, 0
v_mfma_f32_16x16x32_bf16 v[100:103], a[88:91], a[36:39], v[100:103]
v_lshlrev_b32 v15, 2, v15
v_bfe_u32 v12, v0, 2, 2
v_lshlrev_b32 v12, 11, v12
v_mfma_f32_16x16x32_bf16 v[100:103], a[92:95], a[52:55], v[100:103]
L_padA12:
s_cmp_eq_u32 s95, 1
s_cbranch_scc1 L_hopA_ret
v_lshrrev_b32 v13, 4, v0
v_lshl_add_u32 v12, v13, 6, v12
v_mfma_f32_16x16x32_bf16 v[92:95], a[92:95], a[48:51], v[92:95]
v_and_b32 v13, 3, v0
v_lshl_add_u32 v12, v13, 4, v12
v_mfma_f32_16x16x32_bf16 v[92:95], a[88:91], a[32:35], v[92:95]
s_waitcnt lgkmcnt(0)
v_xor_b32 v12, s13, v12
v_xor_b32 v13, 32, v12
v_mfma_f32_16x16x32_bf16 v[120:123], a[96:99], a[32:35], v[120:123]
v_add_u32 v13, 7168, v13
v_mul_f32 v24, s52, v24
v_mfma_f32_16x16x32_bf16 v[120:123], a[100:103], a[48:51], v[120:123]
v_mul_f32 v25, s52, v25
v_mul_f32 v26, s52, v26
v_mfma_f32_16x16x32_bf16 v[128:131], a[100:103], a[52:55], v[128:131]
v_mul_f32 v27, s52, v27
v_mul_f32 v28, s52, v28
v_mul_f32 v29, s52, v29
v_mfma_f32_16x16x32_bf16 v[128:131], a[96:99], a[36:39], v[128:131]
v_mul_f32 v30, s52, v30
v_mul_f32 v31, s52, v31
v_mfma_f32_16x16x32_bf16 v[136:139], a[96:99], a[40:43], v[136:139]
v_cvt_pk_bf16_f32 v24, v24, v25
v_cvt_pk_bf16_f32 v25, v26, v27
v_mfma_f32_16x16x32_bf16 v[136:139], a[100:103], a[56:59], v[136:139]
v_cvt_pk_bf16_f32 v26, v28, v29
v_cvt_pk_bf16_f32 v27, v30, v31
v_mfma_f32_16x16x32_bf16 v[144:147], a[100:103], a[60:63], v[144:147]
v_accvgpr_write_b32 a160, v24
v_accvgpr_write_b32 a161, v25
v_mfma_f32_16x16x32_bf16 v[144:147], a[96:99], a[44:47], v[144:147]
v_accvgpr_write_b32 a162, v26
v_accvgpr_write_b32 a163, v27
v_mfma_f32_16x16x32_bf16 v[148:151], a[104:107], a[44:47], v[148:151]
v_mul_f32 v32, s52, v32
v_mul_f32 v33, s52, v33
v_mul_f32 v34, s52, v34
v_mfma_f32_16x16x32_bf16 v[148:151], a[108:111], a[60:63], v[148:151]
v_mul_f32 v35, s52, v35
v_mul_f32 v36, s52, v36
v_mfma_f32_16x16x32_bf16 v[140:143], a[108:111], a[56:59], v[140:143]
v_mul_f32 v37, s52, v37
v_mul_f32 v38, s52, v38
v_mfma_f32_16x16x32_bf16 v[140:143], a[104:107], a[40:43], v[140:143]
v_mul_f32 v39, s52, v39
v_cvt_pk_bf16_f32 v32, v32, v33
v_mfma_f32_16x16x32_bf16 v[132:135], a[104:107], a[36:39], v[132:135]
v_cvt_pk_bf16_f32 v33, v34, v35
v_cvt_pk_bf16_f32 v34, v36, v37
v_mfma_f32_16x16x32_bf16 v[132:135], a[108:111], a[52:55], v[132:135]
v_cvt_pk_bf16_f32 v35, v38, v39
v_accvgpr_write_b32 a176, v32
v_mfma_f32_16x16x32_bf16 v[124:127], a[108:111], a[48:51], v[124:127]
v_accvgpr_write_b32 a177, v33
v_accvgpr_write_b32 a178, v34
v_accvgpr_write_b32 a179, v35
v_mfma_f32_16x16x32_bf16 v[124:127], a[104:107], a[32:35], v[124:127]
L_trans:
s_waitcnt vmcnt(21) lgkmcnt(0)
s_barrier
s_cmp_eq_u32 s4, 0
s_cbranch_scc1 L_hx_ld
ds_read_b128 v[188:191], v4 offset:0
ds_read_b64 v[216:217], v4 offset:1024
ds_read_b64 v[220:221], v4 offset:1032
ds_read_b128 v[204:207], v4 offset:16384
ds_read_b64 v[232:233], v4 offset:17408
ds_read_b64 v[236:237], v4 offset:17416
s_branch L_hx_rd
L_hx_ld:
buffer_load_dwordx4 v[188:191], v10, s[88:91], 0 offen sc1
buffer_load_dwordx2 v[216:217], v10, s[88:91], 0 offen offset:1024 sc1
buffer_load_dwordx2 v[220:221], v10, s[88:91], 0 offen offset:1032 sc1
buffer_load_dwordx4 v[204:207], v11, s[88:91], 0 offen sc1
buffer_load_dwordx2 v[232:233], v11, s[88:91], 0 offen offset:1024 sc1
buffer_load_dwordx2 v[236:237], v11, s[88:91], 0 offen offset:1032 sc1
L_hx_rd:
ds_read_b128 v[196:199], v6 offset:0
ds_read_b64 v[224:225], v6 offset:1024
ds_read_b64 v[228:229], v6 offset:1032
ds_read_b128 v[212:215], v6 offset:16384
ds_read_b64 v[240:241], v6 offset:17408
ds_read_b64 v[244:245], v6 offset:17416
ds_read_b128 a[0:3], v1 offset:8192
ds_read_b128 a[4:7], v1 offset:9216
ds_read_b128 a[8:11], v1 offset:10240
ds_read_b128 a[12:15], v1 offset:11264
ds_read_b128 a[16:19], v1 offset:12288
ds_read_b128 a[20:23], v1 offset:13312
ds_read_b128 a[24:27], v1 offset:14336
ds_read_b128 a[28:31], v1 offset:15360
L_hopB:
s_mov_b32 s95, 0
v_pk_mul_f32 v[40:41], v[40:41], s[52:53]
v_pk_mul_f32 v[42:43], v[42:43], s[52:53]
v_pk_mul_f32 v[44:45], v[44:45], s[52:53]
v_pk_mul_f32 v[46:47], v[46:47], s[52:53]
v_cvt_pk_bf16_f32 v40, v40, v41
v_cvt_pk_bf16_f32 v41, v42, v43
v_cvt_pk_bf16_f32 v42, v44, v45
v_cvt_pk_bf16_f32 v43, v46, v47
v_accvgpr_write_b32 a192, v40
v_accvgpr_write_b32 a193, v41
v_accvgpr_write_b32 a194, v42
v_accvgpr_write_b32 a195, v43
v_pk_mul_f32 v[48:49], v[48:49], s[52:53]
v_pk_mul_f32 v[50:51], v[50:51], s[52:53]
v_pk_mul_f32 v[52:53], v[52:53], s[52:53]
v_pk_mul_f32 v[54:55], v[54:55], s[52:53]
v_cvt_pk_bf16_f32 v48, v48, v49
v_cvt_pk_bf16_f32 v49, v50, v51
v_cvt_pk_bf16_f32 v50, v52, v53
v_cvt_pk_bf16_f32 v51, v54, v55
v_accvgpr_write_b32 a208, v48
v_accvgpr_write_b32 a209, v49
v_accvgpr_write_b32 a210, v50
v_accvgpr_write_b32 a211, v51
v_mov_b32 v47, s55
v_cndmask_b32 v36, v9, 0, s[56:57]
v_min_f32 v32, s55, v36
v_cndmask_b32 v44, v47, 0, s[36:37]
v_cndmask_b32 v37, v9, 0, s[58:59]
v_min_f32 v33, s55, v37
v_cndmask_b32 v45, v47, 0, s[38:39]
v_cndmask_b32 v38, v9, 0, s[60:61]
v_min_f32 v34, s55, v38
v_cndmask_b32 v46, v47, 0, s[40:41]
v_cndmask_b32 v39, v9, 0, s[62:63]
v_min_f32 v35, s55, v39
v_cndmask_b32 v47, v47, 0, s[42:43]
v_pk_mul_f32 v[56:57], v[56:57], s[52:53]
v_pk_mul_f32 v[58:59], v[58:59], s[52:53]
v_pk_mul_f32 v[60:61], v[60:61], s[52:53]
v_pk_mul_f32 v[62:63], v[62:63], s[52:53]
v_cvt_pk_bf16_f32 v56, v56, v57
v_cvt_pk_bf16_f32 v57, v58, v59
v_cvt_pk_bf16_f32 v58, v60, v61
v_cvt_pk_bf16_f32 v59, v62, v63
v_accvgpr_write_b32 a164, v56
v_accvgpr_write_b32 a165, v57
v_accvgpr_write_b32 a166, v58
v_accvgpr_write_b32 a167, v59
v_pk_mul_f32 v[64:65], v[64:65], s[52:53]
v_pk_mul_f32 v[66:67], v[66:67], s[52:53]
v_pk_mul_f32 v[68:69], v[68:69], s[52:53]
v_pk_mul_f32 v[70:71], v[70:71], s[52:53]
v_cvt_pk_bf16_f32 v64, v64, v65
v_cvt_pk_bf16_f32 v65, v66, v67
v_cvt_pk_bf16_f32 v66, v68, v69
v_cvt_pk_bf16_f32 v67, v70, v71
v_accvgpr_write_b32 a180, v64
v_accvgpr_write_b32 a181, v65
v_accvgpr_write_b32 a182, v66
v_accvgpr_write_b32 a183, v67
v_pk_mul_f32 v[72:73], v[72:73], s[52:53]
v_pk_mul_f32 v[74:75], v[74:75], s[52:53]
v_pk_mul_f32 v[76:77], v[76:77], s[52:53]
v_pk_mul_f32 v[78:79], v[78:79], s[52:53]
v_cvt_pk_bf16_f32 v72, v72, v73
v_cvt_pk_bf16_f32 v73, v74, v75
v_cvt_pk_bf16_f32 v74, v76, v77
v_cvt_pk_bf16_f32 v75, v78, v79
v_accvgpr_write_b32 a196, v72
v_accvgpr_write_b32 a197, v73
v_accvgpr_write_b32 a198, v74
v_accvgpr_write_b32 a199, v75
v_pk_mul_f32 v[80:81], v[80:81], s[52:53]
v_pk_mul_f32 v[82:83], v[82:83], s[52:53]
v_pk_mul_f32 v[84:85], v[84:85], s[52:53]
v_pk_mul_f32 v[86:87], v[86:87], s[52:53]
v_cvt_pk_bf16_f32 v80, v80, v81
v_cvt_pk_bf16_f32 v81, v82, v83
v_cvt_pk_bf16_f32 v82, v84, v85
v_cvt_pk_bf16_f32 v83, v86, v87
v_accvgpr_write_b32 a212, v80
v_accvgpr_write_b32 a213, v81
v_accvgpr_write_b32 a214, v82
v_accvgpr_write_b32 a215, v83
v_pk_mul_f32 v[88:89], v[88:89], s[52:53]
v_pk_mul_f32 v[90:91], v[90:91], s[52:53]
v_pk_mul_f32 v[92:93], v[92:93], s[52:53]
v_pk_mul_f32 v[94:95], v[94:95], s[52:53]
v_cvt_pk_bf16_f32 v88, v88, v89
v_cvt_pk_bf16_f32 v89, v90, v91
v_cvt_pk_bf16_f32 v90, v92, v93
v_cvt_pk_bf16_f32 v91, v94, v95
v_accvgpr_write_b32 a168, v88
v_accvgpr_write_b32 a169, v89
v_accvgpr_write_b32 a170, v90
v_accvgpr_write_b32 a171, v91
v_pk_mul_f32 v[96:97], v[96:97], s[52:53]
v_pk_mul_f32 v[98:99], v[98:99], s[52:53]
v_pk_mul_f32 v[100:101], v[100:101], s[52:53]
v_pk_mul_f32 v[102:103], v[102:103], s[52:53]
v_cvt_pk_bf16_f32 v96, v96, v97
v_cvt_pk_bf16_f32 v97, v98, v99
v_cvt_pk_bf16_f32 v98, v100, v101
v_cvt_pk_bf16_f32 v99, v102, v103
v_accvgpr_write_b32 a184, v96
v_accvgpr_write_b32 a185, v97
v_accvgpr_write_b32 a186, v98
v_accvgpr_write_b32 a187, v99
v_pk_mul_f32 v[104:105], v[104:105], s[52:53]
v_pk_mul_f32 v[106:107], v[106:107], s[52:53]
v_pk_mul_f32 v[108:109], v[108:109], s[52:53]
v_pk_mul_f32 v[110:111], v[110:111], s[52:53]
v_cvt_pk_bf16_f32 v104, v104, v105
v_cvt_pk_bf16_f32 v105, v106, v107
v_cvt_pk_bf16_f32 v106, v108, v109
v_cvt_pk_bf16_f32 v107, v110, v111
v_accvgpr_write_b32 a200, v104
v_accvgpr_write_b32 a201, v105
v_accvgpr_write_b32 a202, v106
v_accvgpr_write_b32 a203, v107
v_pk_mul_f32 v[112:113], v[112:113], s[52:53]
v_pk_mul_f32 v[114:115], v[114:115], s[52:53]
v_pk_mul_f32 v[116:117], v[116:117], s[52:53]
v_pk_mul_f32 v[118:119], v[118:119], s[52:53]
v_cvt_pk_bf16_f32 v112, v112, v113
v_cvt_pk_bf16_f32 v113, v114, v115
v_cvt_pk_bf16_f32 v114, v116, v117
v_cvt_pk_bf16_f32 v115, v118, v119
v_accvgpr_write_b32 a216, v112
v_accvgpr_write_b32 a217, v113
v_accvgpr_write_b32 a218, v114
v_accvgpr_write_b32 a219, v115
v_pk_mul_f32 v[120:121], v[120:121], s[52:53]
v_pk_mul_f32 v[122:123], v[122:123], s[52:53]
v_pk_mul_f32 v[124:125], v[124:125], s[52:53]
v_pk_mul_f32 v[126:127], v[126:127], s[52:53]
v_cvt_pk_bf16_f32 v120, v120, v121
v_cvt_pk_bf16_f32 v121, v122, v123
v_cvt_pk_bf16_f32 v122, v124, v125
v_cvt_pk_bf16_f32 v123, v126, v127
v_accvgpr_write_b32 a172, v120
v_accvgpr_write_b32 a173, v121
v_accvgpr_write_b32 a174, v122
v_accvgpr_write_b32 a175, v123
v_pk_mul_f32 v[128:129], v[128:129], s[52:53]
v_pk_mul_f32 v[130:131], v[130:131], s[52:53]
v_pk_mul_f32 v[132:133], v[132:133], s[52:53]
v_pk_mul_f32 v[134:135], v[134:135], s[52:53]
v_cvt_pk_bf16_f32 v128, v128, v129
v_cvt_pk_bf16_f32 v129, v130, v131
v_cvt_pk_bf16_f32 v130, v132, v133
v_cvt_pk_bf16_f32 v131, v134, v135
v_accvgpr_write_b32 a188, v128
v_accvgpr_write_b32 a189, v129
v_accvgpr_write_b32 a190, v130
v_accvgpr_write_b32 a191, v131
v_pk_mul_f32 v[136:137], v[136:137], s[52:53]
v_pk_mul_f32 v[138:139], v[138:139], s[52:53]
v_pk_mul_f32 v[140:141], v[140:141], s[52:53]
v_pk_mul_f32 v[142:143], v[142:143], s[52:53]
v_cvt_pk_bf16_f32 v136, v136, v137
v_cvt_pk_bf16_f32 v137, v138, v139
v_cvt_pk_bf16_f32 v138, v140, v141
v_cvt_pk_bf16_f32 v139, v142, v143
v_accvgpr_write_b32 a204, v136
v_accvgpr_write_b32 a205, v137
v_accvgpr_write_b32 a206, v138
v_accvgpr_write_b32 a207, v139
v_pk_mul_f32 v[144:145], v[144:145], s[52:53]
v_pk_mul_f32 v[146:147], v[146:147], s[52:53]
v_pk_mul_f32 v[148:149], v[148:149], s[52:53]
v_pk_mul_f32 v[150:151], v[150:151], s[52:53]
v_cvt_pk_bf16_f32 v144, v144, v145
v_cvt_pk_bf16_f32 v145, v146, v147
v_cvt_pk_bf16_f32 v146, v148, v149
v_cvt_pk_bf16_f32 v147, v150, v151
v_accvgpr_write_b32 a220, v144
v_accvgpr_write_b32 a221, v145
v_accvgpr_write_b32 a222, v146
v_accvgpr_write_b32 a223, v147
s_cmp_lg_u32 s4, 0
s_cbranch_scc1 L_spun_hx
s_mov_b32 s92, 200000
L_spin_hx:
s_waitcnt vmcnt(0)
v_max3_u32 v128, v188, v189, 0
v_max3_u32 v128, v190, v191, v128
v_max3_u32 v128, v216, v217, v128
v_max3_u32 v128, v220, v221, v128
v_max3_u32 v128, v204, v205, v128
v_max3_u32 v128, v206, v207, v128
v_max3_u32 v128, v232, v233, v128
v_max3_u32 v128, v236, v237, v128
v_cmp_eq_u32 vcc, -1, v128
s_sub_u32 s92, s92, 1
s_cbranch_scc1 L_spun_hx
s_nop 3
s_cbranch_vccz L_spun_hx
s_sleep 2
buffer_load_dwordx4 v[188:191], v10, s[88:91], 0 offen sc1
buffer_load_dwordx2 v[216:217], v10, s[88:91], 0 offen offset:1024 sc1
buffer_load_dwordx2 v[220:221], v10, s[88:91], 0 offen offset:1032 sc1
buffer_load_dwordx4 v[204:207], v11, s[88:91], 0 offen sc1
buffer_load_dwordx2 v[232:233], v11, s[88:91], 0 offen offset:1024 sc1
buffer_load_dwordx2 v[236:237], v11, s[88:91], 0 offen offset:1032 sc1
s_branch L_spin_hx
L_spun_hx:
s_waitcnt lgkmcnt(0)
s_barrier
v_mfma_f32_16x16x32_bf16 v[52:55], v[184:187], v[152:155], v[248:251]
v_mov_b32 v140, 0
v_mov_b32 v141, 0
v_mfma_f32_16x16x32_bf16 v[48:51], v[188:191], v[152:155], v[32:35]
v_mov_b32 v142, 0
v_mov_b32 v143, 0
v_mfma_f32_16x16x32_bf16 v[60:63], v[192:195], v[160:163], v[248:251]
v_mov_b32 v144, 0
v_mov_b32 v145, 0
v_mfma_f32_16x16x32_bf16 v[56:59], v[196:199], v[160:163], v[36:39]
v_mov_b32 v146, 0
v_mov_b32 v147, 0
v_mfma_f32_16x16x32_bf16 v[68:71], v[200:203], v[168:171], v[248:251]
v_mov_b32 v148, 0
v_mov_b32 v149, 0
v_mfma_f32_16x16x32_bf16 v[64:67], v[204:207], v[168:171], v[36:39]
v_max3_f32 v52, v48, v49, v52
v_max3_f32 v54, v50, v51, v54
v_mfma_f32_16x16x32_bf16 v[76:79], v[208:211], v[176:179], v[248:251]
v_max_f32 v52, v52, v53
v_max_f32 v53, v54, v55
v_mfma_f32_16x16x32_bf16 v[72:75], v[212:215], v[176:179], v[36:39]
v_max_f32 v136, v52, v53
v_max3_f32 v60, v56, v57, v60
v_mfma_f32_16x16x32_bf16 v[16:19], a[0:3], a[160:163], v[44:47]
v_max3_f32 v62, v58, v59, v62
v_max_f32 v60, v60, v61
v_mfma_f32_16x16x32_bf16 v[16:19], a[4:7], a[164:167], v[16:19]
v_max_f32 v61, v62, v63
v_max_f32 v137, v60, v61
v_mfma_f32_16x16x32_bf16 v[16:19], a[8:11], a[168:171], v[16:19]
v_max3_f32 v68, v64, v65, v68
v_max3_f32 v70, v66, v67, v70
v_mfma_f32_16x16x32_bf16 v[16:19], a[12:15], a[172:175], v[16:19]
v_max_f32 v68, v68, v69
v_max_f32 v69, v70, v71
v_mfma_f32_16x16x32_bf16 v[20:23], a[0:3], a[176:179], 0
v_max_f32 v138, v68, v69
v_max3_f32 v76, v72, v73, v76
v_mfma_f32_16x16x32_bf16 v[20:23], a[4:7], a[180:183], v[20:23]
v_max3_f32 v78, v74, v75, v78
v_max_f32 v76, v76, v77
v_mfma_f32_16x16x32_bf16 v[20:23], a[8:11], a[184:187], v[20:23]
v_max_f32 v77, v78, v79
v_max_f32 v139, v76, v77
v_mfma_f32_16x16x32_bf16 v[20:23], a[12:15], a[188:191], v[20:23]
v_mov_b32 v150, 0
v_mov_b32 v151, 0
v_mfma_f32_16x16x32_bf16 v[24:27], a[0:3], a[192:195], 0
v_mov_b32 v248, 0
v_mov_b32 v249, 0
v_mfma_f32_16x16x32_bf16 v[24:27], a[4:7], a[196:199], v[24:27]
v_mov_b32 v250, 0
v_mov_b32 v251, 0
v_mfma_f32_16x16x32_bf16 v[24:27], a[8:11], a[200:203], v[24:27]
v_max3_f32 v80, v16, v17, v18
v_max_f32 v80, v80, v19
v_mfma_f32_16x16x32_bf16 v[24:27], a[12:15], a[204:207], v[24:27]
v_max3_f32 v84, v20, v21, v22
v_max_f32 v84, v84, v23
v_mfma_f32_16x16x32_bf16 v[28:31], a[0:3], a[208:211], 0
v_mov_b32 v128, v136
v_mov_b32 v129, v137
v_mfma_f32_16x16x32_bf16 v[28:31], a[4:7], a[212:215], v[28:31]
v_mov_b32 v130, v138
v_mov_b32 v131, v139
v_mfma_f32_16x16x32_bf16 v[28:31], a[8:11], a[216:219], v[28:31]
v_permlane16_swap_b32 v128, v136
v_permlane16_swap_b32 v129, v137
v_mfma_f32_16x16x32_bf16 v[28:31], a[12:15], a[220:223], v[28:31]
v_permlane16_swap_b32 v130, v138
v_permlane16_swap_b32 v131, v139
v_max_f32 v136, v136, v128
v_max_f32 v137, v137, v129
v_max_f32 v138, v138, v130
v_max_f32 v139, v139, v131
v_max3_f32 v88, v24, v25, v26
v_max_f32 v88, v88, v27
v_mov_b32 v128, v136
v_mov_b32 v129, v137
v_mov_b32 v130, v138
v_mov_b32 v131, v139
v_max3_f32 v92, v28, v29, v30
v_max_f32 v92, v92, v31
v_permlane32_swap_b32 v128, v136
v_permlane32_swap_b32 v129, v137
v_permlane32_swap_b32 v130, v138
v_permlane32_swap_b32 v131, v139
v_max_f32 v136, v136, v128
v_max_f32 v137, v137, v129
v_max_f32 v138, v138, v130
v_max_f32 v139, v139, v131
v_mul_f32 v136, s54, v136
v_mul_f32 v137, s54, v137
v_mul_f32 v138, s54, v138
v_mul_f32 v139, s54, v139
v_fma_f32 v52, v52, s54, -v136
v_fma_f32 v53, v53, s54, -v136
v_fma_f32 v60, v60, s54, -v137
v_fma_f32 v61, v61, s54, -v137
v_fma_f32 v68, v68, s54, -v138
v_fma_f32 v69, v69, s54, -v138
v_fma_f32 v76, v76, s54, -v139
v_fma_f32 v77, v77, s54, -v139
v_exp_f32 v52, v52
v_exp_f32 v53, v53
v_exp_f32 v60, v60
v_exp_f32 v61, v61
v_exp_f32 v68, v68
v_exp_f32 v69, v69
v_exp_f32 v76, v76
v_exp_f32 v77, v77
v_cvt_pk_bf16_f32 v52, v52, v52
v_cvt_pk_bf16_f32 v53, v53, v53
v_cvt_pk_bf16_f32 v60, v60, v60
v_cvt_pk_bf16_f32 v61, v61, v61
v_cvt_pk_bf16_f32 v68, v68, v68
v_cvt_pk_bf16_f32 v69, v69, v69
v_cvt_pk_bf16_f32 v76, v76, v76
v_cvt_pk_bf16_f32 v77, v77, v77
v_and_b32 v48, v252, v52
v_and_b32 v49, v253, v53
v_and_b32 v50, v254, v52
v_and_b32 v51, v255, v53
v_and_b32 v56, v252, v60
v_and_b32 v57, v253, v61
v_and_b32 v58, v254, v60
v_and_b32 v59, v255, v61
v_and_b32 v64, v252, v68
v_and_b32 v65, v253, v69
v_and_b32 v66, v254, v68
v_and_b32 v67, v255, v69
v_and_b32 v72, v252, v76
v_and_b32 v73, v253, v77
v_and_b32 v74, v254, v76
v_and_b32 v75, v255, v77
v_mfma_f32_16x16x32_bf16 v[156:159], a[240:243], v[48:51], 0
v_mov_b32 v128, v80
v_mov_b32 v129, v84
v_mfma_f32_16x16x32_bf16 v[164:167], a[240:243], v[56:59], 0
v_mov_b32 v130, v88
v_mov_b32 v131, v92
v_mfma_f32_16x16x32_bf16 v[172:175], a[240:243], v[64:67], 0
v_permlane16_swap_b32 v128, v80
v_permlane16_swap_b32 v129, v84
v_mfma_f32_16x16x32_bf16 v[180:183], a[240:243], v[72:75], 0
v_permlane16_swap_b32 v130, v88
v_permlane16_swap_b32 v131, v92
v_mfma_f32_16x16x32_bf16 v[184:187], v[216:219], v[48:51], 0
v_max_f32 v80, v80, v128
v_max_f32 v84, v84, v129
v_mfma_f32_16x16x32_bf16 v[188:191], v[220:223], v[48:51], 0
v_max_f32 v88, v88, v130
v_max_f32 v92, v92, v131
v_mfma_f32_16x16x32_bf16 v[192:195], v[224:227], v[56:59], 0
v_mov_b32 v128, v80
v_mov_b32 v129, v84
v_mfma_f32_16x16x32_bf16 v[196:199], v[228:231], v[56:59], 0
v_mov_b32 v130, v88
v_mov_b32 v131, v92
v_mfma_f32_16x16x32_bf16 v[200:203], v[232:235], v[64:67], 0
v_permlane32_swap_b32 v128, v80
v_permlane32_swap_b32 v129, v84
v_mfma_f32_16x16x32_bf16 v[204:207], v[236:239], v[64:67], 0
v_permlane32_swap_b32 v130, v88
v_permlane32_swap_b32 v131, v92
v_mfma_f32_16x16x32_bf16 v[208:211], v[240:243], v[72:75], 0
v_max_f32 v80, v80, v128
v_max_f32 v84, v84, v129
v_mfma_f32_16x16x32_bf16 v[212:215], v[244:247], v[72:75], 0
v_max_f32 v88, v88, v130
v_max_f32 v92, v92, v131
v_rcp_f32 v128, v156
v_rcp_f32 v130, v164
v_rcp_f32 v132, v172
v_rcp_f32 v134, v180
v_sub_f32 v83, 0, v80
v_sub_f32 v82, 0, v80
v_sub_f32 v81, 0, v80
v_sub_f32 v80, 0, v80
v_min_f32 v103, s8, v80
v_cndmask_b32 v96, v103, v80, s[36:37]
v_cndmask_b32 v97, v103, v80, s[38:39]
v_cndmask_b32 v98, v103, v80, s[40:41]
v_cndmask_b32 v99, v103, v80, s[42:43]
v_cndmask_b32 v100, v9, v103, s[36:37]
v_cndmask_b32 v101, v9, v103, s[38:39]
v_cndmask_b32 v102, v9, v103, s[40:41]
v_cndmask_b32 v103, v9, v103, s[42:43]
v_pk_mul_f32 v[184:185], v[184:185], v[128:129] op_sel_hi:[1,0]
v_pk_mul_f32 v[186:187], v[186:187], v[128:129] op_sel_hi:[1,0]
v_pk_mul_f32 v[188:189], v[188:189], v[128:129] op_sel_hi:[1,0]
v_pk_mul_f32 v[190:191], v[190:191], v[128:129] op_sel_hi:[1,0]
v_pk_mul_f32 v[192:193], v[192:193], v[130:131] op_sel_hi:[1,0]
v_pk_mul_f32 v[194:195], v[194:195], v[130:131] op_sel_hi:[1,0]
v_pk_mul_f32 v[196:197], v[196:197], v[130:131] op_sel_hi:[1,0]
v_pk_mul_f32 v[198:199], v[198:199], v[130:131] op_sel_hi:[1,0]
v_pk_mul_f32 v[200:201], v[200:201], v[132:133] op_sel_hi:[1,0]
v_pk_mul_f32 v[202:203], v[202:203], v[132:133] op_sel_hi:[1,0]
v_pk_mul_f32 v[204:205], v[204:205], v[132:133] op_sel_hi:[1,0]
v_pk_mul_f32 v[206:207], v[206:207], v[132:133] op_sel_hi:[1,0]
v_pk_mul_f32 v[208:209], v[208:209], v[134:135] op_sel_hi:[1,0]
v_pk_mul_f32 v[210:211], v[210:211], v[134:135] op_sel_hi:[1,0]
v_pk_mul_f32 v[212:213], v[212:213], v[134:135] op_sel_hi:[1,0]
v_pk_mul_f32 v[214:215], v[214:215], v[134:135] op_sel_hi:[1,0]
v_cvt_pk_bf16_f32 v32, v184, v185
v_cvt_pk_bf16_f32 v33, v186, v187
v_cvt_pk_bf16_f32 v34, v188, v189
v_cvt_pk_bf16_f32 v35, v190, v191
v_cvt_pk_bf16_f32 v36, v192, v193
v_cvt_pk_bf16_f32 v37, v194, v195
v_cvt_pk_bf16_f32 v38, v196, v197
v_cvt_pk_bf16_f32 v39, v198, v199
v_cvt_pk_bf16_f32 v40, v200, v201
v_cvt_pk_bf16_f32 v41, v202, v203
v_cvt_pk_bf16_f32 v42, v204, v205
v_cvt_pk_bf16_f32 v43, v206, v207
v_cvt_pk_bf16_f32 v44, v208, v209
v_cvt_pk_bf16_f32 v45, v210, v211
v_cvt_pk_bf16_f32 v46, v212, v213
v_cvt_pk_bf16_f32 v47, v214, v215
buffer_store_dwordx4 v[32:35], v3, s[88:91], s44 offen sc1
v_sub_f32 v87, 0, v84
v_sub_f32 v86, 0, v84
v_sub_f32 v85, 0, v84
v_sub_f32 v84, 0, v84
v_min_f32 v111, s9, v84
v_cndmask_b32 v104, v111, v84, s[36:37]
v_cndmask_b32 v105, v111, v84, s[38:39]
v_cndmask_b32 v106, v111, v84, s[40:41]
v_cndmask_b32 v107, v111, v84, s[42:43]
v_cndmask_b32 v108, v9, v111, s[36:37]
v_cndmask_b32 v109, v9, v111, s[38:39]
v_cndmask_b32 v110, v9, v111, s[40:41]
v_cndmask_b32 v111, v9, v111, s[42:43]
v_sub_f32 v91, 0, v88
v_sub_f32 v90, 0, v88
v_sub_f32 v89, 0, v88
v_sub_f32 v88, 0, v88
v_min_f32 v119, s8, v88
v_cndmask_b32 v112, v119, v88, s[36:37]
v_cndmask_b32 v113, v119, v88, s[38:39]
v_cndmask_b32 v114, v119, v88, s[40:41]
v_cndmask_b32 v115, v119, v88, s[42:43]
v_cndmask_b32 v116, v9, v119, s[36:37]
buffer_store_dwordx4 v[36:39], v3, s[88:91], s45 offen sc1
v_cndmask_b32 v117, v9, v119, s[38:39]
v_cndmask_b32 v118, v9, v119, s[40:41]
v_cndmask_b32 v119, v9, v119, s[42:43]
v_sub_f32 v95, 0, v92
v_sub_f32 v94, 0, v92
v_sub_f32 v93, 0, v92
v_sub_f32 v92, 0, v92
v_min_f32 v127, s9, v92
v_cndmask_b32 v120, v127, v92, s[36:37]
v_cndmask_b32 v121, v127, v92, s[38:39]
v_cndmask_b32 v122, v127, v92, s[40:41]
v_cndmask_b32 v123, v127, v92, s[42:43]
v_cndmask_b32 v124, v9, v127, s[36:37]
v_cndmask_b32 v125, v9, v127, s[38:39]
v_cndmask_b32 v126, v9, v127, s[40:41]
v_cndmask_b32 v127, v9, v127, s[42:43]
v_and_b32 v9, 1, v0
v_mul_u32_u24 v9, 0xaaaa, v9
v_add_u32 v9, 0x4444, v9
v_mov_b64 v[128:129], 0
v_mov_b64 v[130:131], 0
v_mov_b64 v[132:133], 0
v_mov_b64 v[134:135], 0
v_mov_b64 v[136:137], 0
buffer_store_dwordx4 v[40:43], v3, s[88:91], s46 offen sc1
v_mov_b64 v[138:139], 0
v_mov_b64 v[152:153], 0
v_mov_b64 v[154:155], 0
v_mov_b64 v[156:157], 0
v_mov_b64 v[158:159], 0
v_mov_b64 v[160:161], 0
v_mov_b64 v[162:163], 0
v_mov_b64 v[164:165], 0
v_mov_b64 v[166:167], 0
v_mov_b64 v[168:169], 0
v_mov_b64 v[170:171], 0
v_mov_b64 v[172:173], 0
v_mov_b64 v[174:175], 0
v_mov_b64 v[176:177], 0
v_mov_b64 v[178:179], 0
v_mov_b64 v[180:181], 0
v_mov_b64 v[182:183], 0
v_mov_b64 v[184:185], 0
v_mov_b64 v[186:187], 0
v_mov_b64 v[188:189], 0
v_mov_b64 v[190:191], 0
v_mov_b64 v[192:193], 0
v_mov_b64 v[194:195], 0
buffer_store_dwordx4 v[44:47], v3, s[88:91], s47 offen sc1
v_mov_b64 v[196:197], 0
v_mov_b64 v[198:199], 0
v_mov_b64 v[200:201], 0
v_mov_b64 v[202:203], 0
v_mov_b64 v[204:205], 0
v_mov_b64 v[206:207], 0
v_mov_b64 v[208:209], 0
v_mov_b64 v[210:211], 0
v_mov_b64 v[212:213], 0
v_mov_b64 v[214:215], 0
v_mov_b64 v[216:217], 0
v_mov_b64 v[218:219], 0
v_mov_b64 v[220:221], 0
v_mov_b64 v[222:223], 0
v_mov_b64 v[224:225], 0
v_mov_b64 v[226:227], 0
v_mov_b64 v[228:229], 0
v_mov_b64 v[230:231], 0
v_mov_b64 v[232:233], 0
v_mov_b64 v[234:235], 0
v_mov_b64 v[236:237], 0
v_mov_b64 v[238:239], 0
v_mov_b64 v[252:253], 0
v_mov_b64 v[254:255], 0
L_att_start:
s_mov_b32 s15, s6
s_cmp_eq_u32 s6, 0
s_cbranch_scc1 L_att_j0
v_mfma_f32_16x16x32_bf16 v[16:19], a[0:3], a[160:163], v[80:83]
ds_read_b128 a[128:131], v1 offset:24576
v_mov_b32 v240, 0
v_mfma_f32_16x16x32_bf16 v[16:19], a[4:7], a[164:167], v[16:19]
ds_read_b128 a[132:135], v1 offset:25600
v_mov_b32 v241, 0
v_mfma_f32_16x16x32_bf16 v[16:19], a[8:11], a[168:171], v[16:19]
ds_read_b128 a[136:139], v1 offset:26624
s_add_u32 m0, s27, 0x0
v_mfma_f32_16x16x32_bf16 v[16:19], a[12:15], a[172:175], v[16:19]
buffer_load_dwordx4 v3, s[48:51], s32 offen offset:0 sc1 lds
v_mfma_f32_16x16x32_bf16 v[20:23], a[0:3], a[176:179], v[84:87]
ds_read_b128 a[140:143], v1 offset:27648
v_mov_b32 v242, 0
v_mfma_f32_16x16x32_bf16 v[20:23], a[4:7], a[180:183], v[20:23]
ds_read_b128 a[144:147], v1 offset:28672
v_mov_b32 v243, 0
v_mfma_f32_16x16x32_bf16 v[20:23], a[8:11], a[184:187], v[20:23]
ds_read_b128 a[148:151], v1 offset:29696
v_mov_b32 v244, 0
v_mfma_f32_16x16x32_bf16 v[20:23], a[12:15], a[188:191], v[20:23]
ds_read_b128 a[152:155], v1 offset:30720
v_mov_b32 v245, 0
v_mfma_f32_16x16x32_bf16 v[24:27], a[0:3], a[192:195], v[88:91]
ds_read_b128 a[156:159], v1 offset:31744
v_exp_f32 v16, v16
v_mfma_f32_16x16x32_bf16 v[24:27], a[4:7], a[196:199], v[24:27]
v_exp_f32 v17, v17
v_mfma_f32_16x16x32_bf16 v[24:27], a[8:11], a[200:203], v[24:27]
buffer_load_dwordx4 v3, s[48:51], s32 offen offset:1024 sc1 lds
v_mfma_f32_16x16x32_bf16 v[24:27], a[12:15], a[204:207], v[24:27]
v_exp_f32 v18, v18
v_mfma_f32_16x16x32_bf16 v[28:31], a[0:3], a[208:211], v[92:95]
v_exp_f32 v19, v19
v_mfma_f32_16x16x32_bf16 v[28:31], a[4:7], a[212:215], v[28:31]
v_exp_f32 v20, v20
v_mfma_f32_16x16x32_bf16 v[28:31], a[8:11], a[216:219], v[28:31]
v_cvt_pk_bf16_f32 v48, v16, v17
v_cvt_pk_bf16_f32 v49, v18, v19
v_mfma_f32_16x16x32_bf16 v[28:31], a[12:15], a[220:223], v[28:31]
v_exp_f32 v21, v21
v_mfma_f32_16x16x32_bf16 v[32:35], a[16:19], a[160:163], v[80:83]
v_exp_f32 v22, v22
v_mfma_f32_16x16x32_bf16 v[32:35], a[20:23], a[164:167], v[32:35]
v_exp_f32 v23, v23
v_mfma_f32_16x16x32_bf16 v[32:35], a[24:27], a[168:171], v[32:35]
buffer_load_dwordx4 v3, s[48:51], s32 offen offset:2048 sc1 lds
v_mfma_f32_16x16x32_bf16 v[32:35], a[28:31], a[172:175], v[32:35]
v_exp_f32 v24, v24
v_mfma_f32_16x16x32_bf16 v[36:39], a[16:19], a[176:179], v[84:87]
v_exp_f32 v25, v25
v_mfma_f32_16x16x32_bf16 v[36:39], a[20:23], a[180:183], v[36:39]
v_cvt_pk_bf16_f32 v52, v20, v21
v_cvt_pk_bf16_f32 v53, v22, v23
v_mfma_f32_16x16x32_bf16 v[36:39], a[24:27], a[184:187], v[36:39]
v_exp_f32 v26, v26
v_mfma_f32_16x16x32_bf16 v[36:39], a[28:31], a[188:191], v[36:39]
v_exp_f32 v27, v27
v_mfma_f32_16x16x32_bf16 v[40:43], a[16:19], a[192:195], v[88:91]
v_exp_f32 v28, v28
v_mfma_f32_16x16x32_bf16 v[40:43], a[20:23], a[196:199], v[40:43]
buffer_load_dwordx4 v3, s[48:51], s32 offen offset:3072 sc1 lds
v_mfma_f32_16x16x32_bf16 v[40:43], a[24:27], a[200:203], v[40:43]
s_add_u32 s32, s32, 0x8000
v_exp_f32 v29, v29
v_mfma_f32_16x16x32_bf16 v[40:43], a[28:31], a[204:207], v[40:43]
v_exp_f32 v30, v30
v_mfma_f32_16x16x32_bf16 v[44:47], a[16:19], a[208:211], v[92:95]
v_exp_f32 v31, v31
v_mfma_f32_16x16x32_bf16 v[44:47], a[20:23], a[212:215], v[44:47]
v_exp_f32 v32, v32
v_mfma_f32_16x16x32_bf16 v[44:47], a[24:27], a[216:219], v[44:47]
v_exp_f32 v33, v33
v_mfma_f32_16x16x32_bf16 v[44:47], a[28:31], a[220:223], v[44:47]
s_waitcnt lgkmcnt(0)
v_cvt_pk_bf16_f32 v56, v24, v25
v_cvt_pk_bf16_f32 v57, v26, v27
v_mov_b32 v246, 0
v_mov_b32 v247, 0
v_mfma_f32_16x16x32_bf16 v[16:19], a[128:131], a[160:163], v[80:83]
ds_read_b128 a[32:35], v1 offset:16384
v_cvt_pk_bf16_f32 v60, v28, v29
v_mfma_f32_16x16x32_bf16 v[16:19], a[132:135], a[164:167], v[16:19]
v_exp_f32 v34, v34
v_mfma_f32_16x16x32_bf16 v[16:19], a[136:139], a[168:171], v[16:19]
s_add_u32 m0, s27, 0x1000
v_exp_f32 v35, v35
v_mfma_f32_16x16x32_bf16 v[16:19], a[140:143], a[172:175], v[16:19]
buffer_load_dwordx4 v3, s[48:51], s7 offen offset:0 sc1 lds
v_mfma_f32_16x16x32_bf16 v[20:23], a[128:131], a[176:179], v[84:87]
ds_read_b128 a[36:39], v1 offset:17408
v_cvt_pk_bf16_f32 v61, v30, v31
v_mfma_f32_16x16x32_bf16 v[20:23], a[132:135], a[180:183], v[20:23]
v_exp_f32 v36, v36
v_mfma_f32_16x16x32_bf16 v[20:23], a[136:139], a[184:187], v[20:23]
ds_read_b128 a[40:43], v1 offset:18432
v_cvt_pk_bf16_f32 v50, v32, v33
v_mfma_f32_16x16x32_bf16 v[20:23], a[140:143], a[188:191], v[20:23]
v_exp_f32 v37, v37
v_mfma_f32_16x16x32_bf16 v[24:27], a[128:131], a[192:195], v[88:91]
v_exp_f32 v38, v38
v_mfma_f32_16x16x32_bf16 v[24:27], a[132:135], a[196:199], v[24:27]
ds_read_b128 a[44:47], v1 offset:19456
v_cvt_pk_bf16_f32 v51, v34, v35
v_mfma_f32_16x16x32_bf16 v[24:27], a[136:139], a[200:203], v[24:27]
buffer_load_dwordx4 v3, s[48:51], s7 offen offset:1024 sc1 lds
v_mfma_f32_16x16x32_bf16 v[24:27], a[140:143], a[204:207], v[24:27]
v_exp_f32 v39, v39
v_mfma_f32_16x16x32_bf16 v[28:31], a[128:131], a[208:211], v[92:95]
v_exp_f32 v40, v40
v_mfma_f32_16x16x32_bf16 v[28:31], a[132:135], a[212:215], v[28:31]
ds_read_b128 a[48:51], v1 offset:20480
v_cvt_pk_bf16_f32 v54, v36, v37
v_mfma_f32_16x16x32_bf16 v[28:31], a[136:139], a[216:219], v[28:31]
v_exp_f32 v41, v41
v_mfma_f32_16x16x32_bf16 v[28:31], a[140:143], a[220:223], v[28:31]
v_exp_f32 v42, v42
v_mfma_f32_16x16x32_bf16 v[32:35], a[144:147], a[160:163], v[80:83]
buffer_load_dwordx4 v3, s[48:51], s7 offen offset:2048 sc1 lds
v_mfma_f32_16x16x32_bf16 v[32:35], a[148:151], a[164:167], v[32:35]
ds_read_b128 a[52:55], v1 offset:21504
v_cvt_pk_bf16_f32 v55, v38, v39
v_mfma_f32_16x16x32_bf16 v[32:35], a[152:155], a[168:171], v[32:35]
v_exp_f32 v43, v43
v_mfma_f32_16x16x32_bf16 v[32:35], a[156:159], a[172:175], v[32:35]
ds_read_b128 a[56:59], v1 offset:22528
v_cvt_pk_bf16_f32 v58, v40, v41
v_mfma_f32_16x16x32_bf16 v[36:39], a[144:147], a[176:179], v[84:87]
v_exp_f32 v44, v44
v_mfma_f32_16x16x32_bf16 v[36:39], a[148:151], a[180:183], v[36:39]
v_exp_f32 v45, v45
v_mfma_f32_16x16x32_bf16 v[36:39], a[152:155], a[184:187], v[36:39]
ds_read_b128 a[60:63], v1 offset:23552
v_xor_b32 v1, 0x8000, v1
v_mfma_f32_16x16x32_bf16 v[36:39], a[156:159], a[188:191], v[36:39]
buffer_load_dwordx4 v3, s[48:51], s7 offen offset:3072 sc1 lds
v_cvt_pk_bf16_f32 v59, v42, v43
v_mfma_f32_16x16x32_bf16 v[40:43], a[144:147], a[192:195], v[88:91]
s_add_u32 s7, s7, 0x8000
v_exp_f32 v46, v46
v_mfma_f32_16x16x32_bf16 v[40:43], a[148:151], a[196:199], v[40:43]
s_xor_b32 s27, s27, 0x38000
v_exp_f32 v47, v47
v_mfma_f32_16x16x32_bf16 v[40:43], a[152:155], a[200:203], v[40:43]
v_exp_f32 v16, v16
v_mfma_f32_16x16x32_bf16 v[40:43], a[156:159], a[204:207], v[40:43]
v_exp_f32 v17, v17
v_cvt_pk_bf16_f32 v62, v44, v45
v_cvt_pk_bf16_f32 v63, v46, v47
v_mfma_f32_16x16x32_bf16 v[44:47], a[144:147], a[208:211], v[92:95]
v_exp_f32 v18, v18
v_mfma_f32_16x16x32_bf16 v[44:47], a[148:151], a[212:215], v[44:47]
v_exp_f32 v19, v19
v_mfma_f32_16x16x32_bf16 v[44:47], a[152:155], a[216:219], v[44:47]
s_waitcnt vmcnt(8) lgkmcnt(0)
v_exp_f32 v20, v20
v_mfma_f32_16x16x32_bf16 v[44:47], a[156:159], a[220:223], v[44:47]
s_barrier
v_cvt_pk_bf16_f32 v64, v16, v17
v_exp_f32 v21, v21
v_exp_f32 v22, v22
v_exp_f32 v23, v23
v_exp_f32 v24, v24
v_exp_f32 v25, v25
v_exp_f32 v26, v26
v_exp_f32 v27, v27
v_cvt_pk_bf16_f32 v65, v18, v19
v_cvt_pk_bf16_f32 v68, v20, v21
v_cvt_pk_bf16_f32 v69, v22, v23
s_cmp_lg_u32 s33, 0
s_cbranch_scc1 L_sig_bd
s_lshl_b32 s8, s6, 2
s_add_u32 s8, s8, 192
s_cmp_lg_u32 s4, 0
s_cbranch_scc1 L_sig_bd
v_mov_b32 v4, 1
s_mov_b64 exec, 1
buffer_atomic_add v4, off, s[84:87], s8 sc1
s_mov_b64 exec, -1
L_sig_bd:
s_getreg_b32 s8, hwreg(HW_REG_HW_ID, 5, 1)
s_cmp_lg_u32 s8, 0
s_cbranch_scc1 L_att_dodd1
s_branch L_att_dodd0
L_att_deven0:
v_mfma_f32_16x16x32_bf16 v[128:131], a[32:35], v[48:51], v[128:131]
ds_read_b128 a[0:3], v1 offset:8192
v_cvt_pk_bf16_f32 v72, v24, v25
v_mfma_f32_16x16x32_bf16 v[160:163], a[32:35], v[52:55], v[160:163]
v_exp_f32 v28, v28
v_mfma_f32_16x16x32_bf16 v[192:195], a[32:35], v[56:59], v[192:195]
v_cvt_pk_bf16_f32 v73, v26, v27
v_mfma_f32_16x16x32_bf16 v[224:227], a[32:35], v[60:63], v[224:227]
ds_read_b128 a[4:7], v1 offset:9216
v_mfma_f32_16x16x32_bf16 v[228:231], a[36:39], v[60:63], v[228:231]
v_exp_f32 v29, v29
v_mfma_f32_16x16x32_bf16 v[196:199], a[36:39], v[56:59], v[196:199]
v_exp_f32 v30, v30
v_mfma_f32_16x16x32_bf16 v[164:167], a[36:39], v[52:55], v[164:167]
s_add_u32 m0, s27, 0x0
v_cvt_pk_bf16_f32 v76, v28, v29
v_mfma_f32_16x16x32_bf16 v[132:135], a[36:39], v[48:51], v[132:135]
buffer_load_dwordx4 v3, s[48:51], s32 offen offset:0 sc1 lds
v_mfma_f32_16x16x32_bf16 v[136:139], a[40:43], v[48:51], v[136:139]
ds_read_b128 a[8:11], v1 offset:10240
v_mfma_f32_16x16x32_bf16 v[168:171], a[40:43], v[52:55], v[168:171]
v_exp_f32 v31, v31
v_mfma_f32_16x16x32_bf16 v[200:203], a[40:43], v[56:59], v[200:203]
v_exp_f32 v32, v32
v_mfma_f32_16x16x32_bf16 v[232:235], a[40:43], v[60:63], v[232:235]
ds_read_b128 a[12:15], v1 offset:11264
v_cvt_pk_bf16_f32 v77, v30, v31
v_mfma_f32_16x16x32_bf16 v[236:239], a[44:47], v[60:63], v[236:239]
v_mfma_f32_16x16x32_bf16 v[204:207], a[44:47], v[56:59], v[204:207]
v_exp_f32 v33, v33
v_mfma_f32_16x16x32_bf16 v[172:175], a[44:47], v[52:55], v[172:175]
v_exp_f32 v34, v34
v_mfma_f32_16x16x32_bf16 v[140:143], a[44:47], v[48:51], v[140:143]
ds_read_b128 a[16:19], v1 offset:12288
v_cvt_pk_bf16_f32 v66, v32, v33
v_mfma_f32_16x16x32_bf16 v[144:147], a[48:51], v[48:51], v[144:147]
v_mfma_f32_16x16x32_bf16 v[176:179], a[48:51], v[52:55], v[176:179]
v_exp_f32 v35, v35
v_mfma_f32_16x16x32_bf16 v[208:211], a[48:51], v[56:59], v[208:211]
v_exp_f32 v36, v36
v_mfma_f32_16x16x32_bf16 v[240:243], a[48:51], v[60:63], v[240:243]
ds_read_b128 a[20:23], v1 offset:13312
v_cvt_pk_bf16_f32 v67, v34, v35
v_mfma_f32_16x16x32_bf16 v[244:247], a[52:55], v[60:63], v[244:247]
v_exp_f32 v37, v37
v_mfma_f32_16x16x32_bf16 v[212:215], a[52:55], v[56:59], v[212:215]
v_cvt_pk_bf16_f32 v70, v36, v37
v_mfma_f32_16x16x32_bf16 v[180:183], a[52:55], v[52:55], v[180:183]
ds_read_b128 a[24:27], v1 offset:14336
v_mfma_f32_16x16x32_bf16 v[148:151], a[52:55], v[48:51], v[148:151]
buffer_load_dwordx4 v3, s[48:51], s32 offen offset:1024 sc1 lds
v_mfma_f32_16x16x32_bf16 v[152:155], a[56:59], v[48:51], v[152:155]
v_exp_f32 v38, v38
v_mfma_f32_16x16x32_bf16 v[184:187], a[56:59], v[52:55], v[184:187]
v_exp_f32 v39, v39
v_mfma_f32_16x16x32_bf16 v[216:219], a[56:59], v[56:59], v[216:219]
ds_read_b128 a[28:31], v1 offset:15360
v_cvt_pk_bf16_f32 v71, v38, v39
v_mfma_f32_16x16x32_bf16 v[248:251], a[56:59], v[60:63], v[248:251]
v_mfma_f32_16x16x32_bf16 v[252:255], a[60:63], v[60:63], v[252:255]
v_exp_f32 v40, v40
v_mfma_f32_16x16x32_bf16 v[220:223], a[60:63], v[56:59], v[220:223]
v_exp_f32 v41, v41
v_mfma_f32_16x16x32_bf16 v[188:191], a[60:63], v[52:55], v[188:191]
ds_read_b128 a[32:35], v1 offset:0
v_cvt_pk_bf16_f32 v74, v40, v41
v_mfma_f32_16x16x32_bf16 v[156:159], a[60:63], v[48:51], v[156:159]
v_smfmac_f32_16x16x64_bf16 a[224:227], a[232:235], v[48:55], v9
v_exp_f32 v42, v42
v_smfmac_f32_16x16x64_bf16 a[228:231], a[232:235], v[56:63], v9
s_waitcnt lgkmcnt(5)
v_exp_f32 v43, v43
v_mfma_f32_16x16x32_bf16 v[16:19], a[0:3], a[160:163], v[80:83]
ds_read_b128 a[36:39], v1 offset:1024
v_cvt_pk_bf16_f32 v75, v42, v43
v_mfma_f32_16x16x32_bf16 v[16:19], a[4:7], a[164:167], v[16:19]
v_exp_f32 v44, v44
v_mfma_f32_16x16x32_bf16 v[16:19], a[8:11], a[168:171], v[16:19]
v_mfma_f32_16x16x32_bf16 v[16:19], a[12:15], a[172:175], v[16:19]
v_exp_f32 v45, v45
v_mfma_f32_16x16x32_bf16 v[20:23], a[0:3], a[176:179], v[84:87]
ds_read_b128 a[40:43], v1 offset:2048
v_cvt_pk_bf16_f32 v78, v44, v45
v_mfma_f32_16x16x32_bf16 v[20:23], a[4:7], a[180:183], v[20:23]
buffer_load_dwordx4 v3, s[48:51], s32 offen offset:2048 sc1 lds
v_mfma_f32_16x16x32_bf16 v[20:23], a[8:11], a[184:187], v[20:23]
v_exp_f32 v46, v46
v_mfma_f32_16x16x32_bf16 v[20:23], a[12:15], a[188:191], v[20:23]
ds_read_b128 a[44:47], v1 offset:3072
v_mfma_f32_16x16x32_bf16 v[24:27], a[0:3], a[192:195], v[88:91]
v_mfma_f32_16x16x32_bf16 v[24:27], a[4:7], a[196:199], v[24:27]
v_exp_f32 v47, v47
v_mfma_f32_16x16x32_bf16 v[24:27], a[8:11], a[200:203], v[24:27]
v_exp_f32 v16, v16
v_mfma_f32_16x16x32_bf16 v[24:27], a[12:15], a[204:207], v[24:27]
ds_read_b128 a[48:51], v1 offset:4096
v_cvt_pk_bf16_f32 v79, v46, v47
v_mfma_f32_16x16x32_bf16 v[28:31], a[0:3], a[208:211], v[92:95]
v_mfma_f32_16x16x32_bf16 v[28:31], a[4:7], a[212:215], v[28:31]
v_exp_f32 v17, v17
v_mfma_f32_16x16x32_bf16 v[28:31], a[8:11], a[216:219], v[28:31]
s_waitcnt lgkmcnt(5)
v_exp_f32 v18, v18
v_mfma_f32_16x16x32_bf16 v[28:31], a[12:15], a[220:223], v[28:31]
ds_read_b128 a[52:55], v1 offset:5120
v_cvt_pk_bf16_f32 v48, v16, v17
v_mfma_f32_16x16x32_bf16 v[32:35], a[16:19], a[160:163], v[80:83]
v_mfma_f32_16x16x32_bf16 v[32:35], a[20:23], a[164:167], v[32:35]
v_exp_f32 v19, v19
v_mfma_f32_16x16x32_bf16 v[32:35], a[24:27], a[168:171], v[32:35]
v_exp_f32 v20, v20
v_mfma_f32_16x16x32_bf16 v[32:35], a[28:31], a[172:175], v[32:35]
ds_read_b128 a[56:59], v1 offset:6144
v_cvt_pk_bf16_f32 v49, v18, v19
v_mfma_f32_16x16x32_bf16 v[36:39], a[16:19], a[176:179], v[84:87]
v_exp_f32 v21, v21
v_mfma_f32_16x16x32_bf16 v[36:39], a[20:23], a[180:183], v[36:39]
buffer_load_dwordx4 v3, s[48:51], s32 offen offset:3072 sc1 lds
v_mfma_f32_16x16x32_bf16 v[36:39], a[24:27], a[184:187], v[36:39]
s_add_u32 s32, s32, 0x8000
v_cvt_pk_bf16_f32 v52, v20, v21
v_mfma_f32_16x16x32_bf16 v[36:39], a[28:31], a[188:191], v[36:39]
ds_read_b128 a[60:63], v1 offset:7168
v_mfma_f32_16x16x32_bf16 v[40:43], a[16:19], a[192:195], v[88:91]
v_exp_f32 v22, v22
v_mfma_f32_16x16x32_bf16 v[40:43], a[20:23], a[196:199], v[40:43]
v_exp_f32 v23, v23
v_mfma_f32_16x16x32_bf16 v[40:43], a[24:27], a[200:203], v[40:43]
v_cvt_pk_bf16_f32 v53, v22, v23
v_mfma_f32_16x16x32_bf16 v[40:43], a[28:31], a[204:207], v[40:43]
v_exp_f32 v24, v24
v_mfma_f32_16x16x32_bf16 v[44:47], a[16:19], a[208:211], v[92:95]
v_exp_f32 v25, v25
v_mfma_f32_16x16x32_bf16 v[44:47], a[20:23], a[212:215], v[44:47]
v_exp_f32 v26, v26
v_mfma_f32_16x16x32_bf16 v[44:47], a[24:27], a[216:219], v[44:47]
v_exp_f32 v27, v27
v_mfma_f32_16x16x32_bf16 v[44:47], a[28:31], a[220:223], v[44:47]
s_waitcnt lgkmcnt(0)
v_mfma_f32_16x16x32_bf16 v[128:131], a[32:35], v[64:67], v[128:131]
ds_read_b128 a[0:3], v1 offset:24576
v_cvt_pk_bf16_f32 v56, v24, v25
v_mfma_f32_16x16x32_bf16 v[160:163], a[32:35], v[68:71], v[160:163]
v_exp_f32 v28, v28
v_mfma_f32_16x16x32_bf16 v[192:195], a[32:35], v[72:75], v[192:195]
v_cvt_pk_bf16_f32 v57, v26, v27
v_mfma_f32_16x16x32_bf16 v[224:227], a[32:35], v[76:79], v[224:227]
ds_read_b128 a[4:7], v1 offset:25600
v_mfma_f32_16x16x32_bf16 v[228:231], a[36:39], v[76:79], v[228:231]
v_exp_f32 v29, v29
v_mfma_f32_16x16x32_bf16 v[196:199], a[36:39], v[72:75], v[196:199]
v_exp_f32 v30, v30
v_mfma_f32_16x16x32_bf16 v[164:167], a[36:39], v[68:71], v[164:167]
s_add_u32 m0, s27, 0x1000
v_cvt_pk_bf16_f32 v60, v28, v29
v_mfma_f32_16x16x32_bf16 v[132:135], a[36:39], v[64:67], v[132:135]
buffer_load_dwordx4 v3, s[48:51], s7 offen offset:0 sc1 lds
v_mfma_f32_16x16x32_bf16 v[136:139], a[40:43], v[64:67], v[136:139]
ds_read_b128 a[8:11], v1 offset:26624
v_mfma_f32_16x16x32_bf16 v[168:171], a[40:43], v[68:71], v[168:171]
v_exp_f32 v31, v31
v_mfma_f32_16x16x32_bf16 v[200:203], a[40:43], v[72:75], v[200:203]
v_exp_f32 v32, v32
v_mfma_f32_16x16x32_bf16 v[232:235], a[40:43], v[76:79], v[232:235]
ds_read_b128 a[12:15], v1 offset:27648
v_cvt_pk_bf16_f32 v61, v30, v31
v_mfma_f32_16x16x32_bf16 v[236:239], a[44:47], v[76:79], v[236:239]
v_mfma_f32_16x16x32_bf16 v[204:207], a[44:47], v[72:75], v[204:207]
v_exp_f32 v33, v33
v_mfma_f32_16x16x32_bf16 v[172:175], a[44:47], v[68:71], v[172:175]
v_exp_f32 v34, v34
v_mfma_f32_16x16x32_bf16 v[140:143], a[44:47], v[64:67], v[140:143]
ds_read_b128 a[16:19], v1 offset:28672
v_cvt_pk_bf16_f32 v50, v32, v33
v_mfma_f32_16x16x32_bf16 v[144:147], a[48:51], v[64:67], v[144:147]
v_mfma_f32_16x16x32_bf16 v[176:179], a[48:51], v[68:71], v[176:179]
v_exp_f32 v35, v35
v_mfma_f32_16x16x32_bf16 v[208:211], a[48:51], v[72:75], v[208:211]
ds_read_b128 a[20:23], v1 offset:29696
v_cvt_pk_bf16_f32 v51, v34, v35
v_mfma_f32_16x16x32_bf16 v[240:243], a[48:51], v[76:79], v[240:243]
v_exp_f32 v36, v36
v_mfma_f32_16x16x32_bf16 v[244:247], a[52:55], v[76:79], v[244:247]
v_exp_f32 v37, v37
v_mfma_f32_16x16x32_bf16 v[212:215], a[52:55], v[72:75], v[212:215]
v_cvt_pk_bf16_f32 v54, v36, v37
v_mfma_f32_16x16x32_bf16 v[180:183], a[52:55], v[68:71], v[180:183]
buffer_load_dwordx4 v3, s[48:51], s7 offen offset:1024 sc1 lds
v_mfma_f32_16x16x32_bf16 v[148:151], a[52:55], v[64:67], v[148:151]
ds_read_b128 a[24:27], v1 offset:30720
v_mfma_f32_16x16x32_bf16 v[152:155], a[56:59], v[64:67], v[152:155]
v_exp_f32 v38, v38
v_mfma_f32_16x16x32_bf16 v[184:187], a[56:59], v[68:71], v[184:187]
v_exp_f32 v39, v39
v_mfma_f32_16x16x32_bf16 v[216:219], a[56:59], v[72:75], v[216:219]
ds_read_b128 a[28:31], v1 offset:31744
v_cvt_pk_bf16_f32 v55, v38, v39
v_mfma_f32_16x16x32_bf16 v[248:251], a[56:59], v[76:79], v[248:251]
v_mfma_f32_16x16x32_bf16 v[252:255], a[60:63], v[76:79], v[252:255]
v_exp_f32 v40, v40
v_mfma_f32_16x16x32_bf16 v[220:223], a[60:63], v[72:75], v[220:223]
v_exp_f32 v41, v41
v_mfma_f32_16x16x32_bf16 v[188:191], a[60:63], v[68:71], v[188:191]
ds_read_b128 a[32:35], v1 offset:16384
v_cvt_pk_bf16_f32 v58, v40, v41
v_mfma_f32_16x16x32_bf16 v[156:159], a[60:63], v[64:67], v[156:159]
v_smfmac_f32_16x16x64_bf16 a[224:227], a[232:235], v[64:71], v9
s_waitcnt lgkmcnt(5)
v_exp_f32 v42, v42
v_smfmac_f32_16x16x64_bf16 a[228:231], a[232:235], v[72:79], v9
ds_read_b128 a[36:39], v1 offset:17408
v_mfma_f32_16x16x32_bf16 v[16:19], a[0:3], a[160:163], v[80:83]
v_exp_f32 v43, v43
v_mfma_f32_16x16x32_bf16 v[16:19], a[4:7], a[164:167], v[16:19]
v_exp_f32 v44, v44
v_mfma_f32_16x16x32_bf16 v[16:19], a[8:11], a[168:171], v[16:19]
v_cvt_pk_bf16_f32 v59, v42, v43
v_mfma_f32_16x16x32_bf16 v[16:19], a[12:15], a[172:175], v[16:19]
ds_read_b128 a[40:43], v1 offset:18432
v_mfma_f32_16x16x32_bf16 v[20:23], a[0:3], a[176:179], v[84:87]
buffer_load_dwordx4 v3, s[48:51], s7 offen offset:2048 sc1 lds
v_mfma_f32_16x16x32_bf16 v[20:23], a[4:7], a[180:183], v[20:23]
v_exp_f32 v45, v45
v_mfma_f32_16x16x32_bf16 v[20:23], a[8:11], a[184:187], v[20:23]
v_exp_f32 v46, v46
v_mfma_f32_16x16x32_bf16 v[20:23], a[12:15], a[188:191], v[20:23]
ds_read_b128 a[44:47], v1 offset:19456
v_cvt_pk_bf16_f32 v62, v44, v45
v_mfma_f32_16x16x32_bf16 v[24:27], a[0:3], a[192:195], v[88:91]
v_mfma_f32_16x16x32_bf16 v[24:27], a[4:7], a[196:199], v[24:27]
v_exp_f32 v47, v47
v_mfma_f32_16x16x32_bf16 v[24:27], a[8:11], a[200:203], v[24:27]
v_exp_f32 v16, v16
v_mfma_f32_16x16x32_bf16 v[24:27], a[12:15], a[204:207], v[24:27]
ds_read_b128 a[48:51], v1 offset:20480
v_cvt_pk_bf16_f32 v63, v46, v47
v_mfma_f32_16x16x32_bf16 v[28:31], a[0:3], a[208:211], v[92:95]
v_mfma_f32_16x16x32_bf16 v[28:31], a[4:7], a[212:215], v[28:31]
v_exp_f32 v17, v17
v_mfma_f32_16x16x32_bf16 v[28:31], a[8:11], a[216:219], v[28:31]
ds_read_b128 a[52:55], v1 offset:21504
v_cvt_pk_bf16_f32 v64, v16, v17
v_mfma_f32_16x16x32_bf16 v[28:31], a[12:15], a[220:223], v[28:31]
s_waitcnt lgkmcnt(6)
v_exp_f32 v18, v18
v_mfma_f32_16x16x32_bf16 v[32:35], a[16:19], a[160:163], v[80:83]
v_mfma_f32_16x16x32_bf16 v[32:35], a[20:23], a[164:167], v[32:35]
v_exp_f32 v19, v19
v_mfma_f32_16x16x32_bf16 v[32:35], a[24:27], a[168:171], v[32:35]
ds_read_b128 a[56:59], v1 offset:22528
v_cvt_pk_bf16_f32 v65, v18, v19
v_mfma_f32_16x16x32_bf16 v[32:35], a[28:31], a[172:175], v[32:35]
buffer_load_dwordx4 v3, s[48:51], s7 offen offset:3072 sc1 lds
v_mfma_f32_16x16x32_bf16 v[36:39], a[16:19], a[176:179], v[84:87]
s_add_u32 s7, s7, 0x8000
v_exp_f32 v20, v20
v_mfma_f32_16x16x32_bf16 v[36:39], a[20:23], a[180:183], v[36:39]
s_xor_b32 s27, s27, 0x38000
v_exp_f32 v21, v21
v_mfma_f32_16x16x32_bf16 v[36:39], a[24:27], a[184:187], v[36:39]
ds_read_b128 a[60:63], v1 offset:23552
v_xor_b32 v1, 0x8000, v1
v_mfma_f32_16x16x32_bf16 v[36:39], a[28:31], a[188:191], v[36:39]
v_cvt_pk_bf16_f32 v68, v20, v21
v_mfma_f32_16x16x32_bf16 v[40:43], a[16:19], a[192:195], v[88:91]
v_exp_f32 v22, v22
v_mfma_f32_16x16x32_bf16 v[40:43], a[20:23], a[196:199], v[40:43]
v_exp_f32 v23, v23
v_mfma_f32_16x16x32_bf16 v[40:43], a[24:27], a[200:203], v[40:43]
v_cvt_pk_bf16_f32 v69, v22, v23
v_mfma_f32_16x16x32_bf16 v[40:43], a[28:31], a[204:207], v[40:43]
v_exp_f32 v24, v24
v_mfma_f32_16x16x32_bf16 v[44:47], a[16:19], a[208:211], v[92:95]
v_exp_f32 v25, v25
v_mfma_f32_16x16x32_bf16 v[44:47], a[20:23], a[212:215], v[44:47]
v_exp_f32 v26, v26
v_mfma_f32_16x16x32_bf16 v[44:47], a[24:27], a[216:219], v[44:47]
s_waitcnt vmcnt(16) lgkmcnt(0)
v_exp_f32 v27, v27
v_mfma_f32_16x16x32_bf16 v[44:47], a[28:31], a[220:223], v[44:47]
s_barrier
L_att_dodd0:
v_mfma_f32_16x16x32_bf16 v[128:131], a[32:35], v[48:51], v[128:131]
ds_read_b128 a[0:3], v2 offset:8192
v_cvt_pk_bf16_f32 v72, v24, v25
v_mfma_f32_16x16x32_bf16 v[160:163], a[32:35], v[52:55], v[160:163]
v_exp_f32 v28, v28
v_mfma_f32_16x16x32_bf16 v[192:195], a[32:35], v[56:59], v[192:195]
v_cvt_pk_bf16_f32 v73, v26, v27
v_mfma_f32_16x16x32_bf16 v[224:227], a[32:35], v[60:63], v[224:227]
ds_read_b128 a[4:7], v2 offset:9216
v_mfma_f32_16x16x32_bf16 v[228:231], a[36:39], v[60:63], v[228:231]
v_exp_f32 v29, v29
v_mfma_f32_16x16x32_bf16 v[196:199], a[36:39], v[56:59], v[196:199]
v_exp_f32 v30, v30
v_mfma_f32_16x16x32_bf16 v[164:167], a[36:39], v[52:55], v[164:167]
s_add_u32 m0, s19, 0x0
v_cvt_pk_bf16_f32 v76, v28, v29
v_mfma_f32_16x16x32_bf16 v[132:135], a[36:39], v[48:51], v[132:135]
buffer_load_dwordx4 v3, s[48:51], s32 offen offset:0 sc1 lds
v_mfma_f32_16x16x32_bf16 v[136:139], a[40:43], v[48:51], v[136:139]
ds_read_b128 a[8:11], v2 offset:10240
v_mfma_f32_16x16x32_bf16 v[168:171], a[40:43], v[52:55], v[168:171]
v_exp_f32 v31, v31
v_mfma_f32_16x16x32_bf16 v[200:203], a[40:43], v[56:59], v[200:203]
v_exp_f32 v32, v32
v_mfma_f32_16x16x32_bf16 v[232:235], a[40:43], v[60:63], v[232:235]
ds_read_b128 a[12:15], v2 offset:11264
v_cvt_pk_bf16_f32 v77, v30, v31
v_mfma_f32_16x16x32_bf16 v[236:239], a[44:47], v[60:63], v[236:239]
v_mfma_f32_16x16x32_bf16 v[204:207], a[44:47], v[56:59], v[204:207]
v_exp_f32 v33, v33
v_mfma_f32_16x16x32_bf16 v[172:175], a[44:47], v[52:55], v[172:175]
v_exp_f32 v34, v34
v_mfma_f32_16x16x32_bf16 v[140:143], a[44:47], v[48:51], v[140:143]
ds_read_b128 a[16:19], v2 offset:12288
v_cvt_pk_bf16_f32 v66, v32, v33
v_mfma_f32_16x16x32_bf16 v[144:147], a[48:51], v[48:51], v[144:147]
v_mfma_f32_16x16x32_bf16 v[176:179], a[48:51], v[52:55], v[176:179]
v_exp_f32 v35, v35
v_mfma_f32_16x16x32_bf16 v[208:211], a[48:51], v[56:59], v[208:211]
v_exp_f32 v36, v36
v_mfma_f32_16x16x32_bf16 v[240:243], a[48:51], v[60:63], v[240:243]
ds_read_b128 a[20:23], v2 offset:13312
v_cvt_pk_bf16_f32 v67, v34, v35
v_mfma_f32_16x16x32_bf16 v[244:247], a[52:55], v[60:63], v[244:247]
v_exp_f32 v37, v37
v_mfma_f32_16x16x32_bf16 v[212:215], a[52:55], v[56:59], v[212:215]
v_cvt_pk_bf16_f32 v70, v36, v37
v_mfma_f32_16x16x32_bf16 v[180:183], a[52:55], v[52:55], v[180:183]
ds_read_b128 a[24:27], v2 offset:14336
v_mfma_f32_16x16x32_bf16 v[148:151], a[52:55], v[48:51], v[148:151]
buffer_load_dwordx4 v3, s[48:51], s32 offen offset:1024 sc1 lds
v_mfma_f32_16x16x32_bf16 v[152:155], a[56:59], v[48:51], v[152:155]
v_exp_f32 v38, v38
v_mfma_f32_16x16x32_bf16 v[184:187], a[56:59], v[52:55], v[184:187]
v_exp_f32 v39, v39
v_mfma_f32_16x16x32_bf16 v[216:219], a[56:59], v[56:59], v[216:219]
ds_read_b128 a[28:31], v2 offset:15360
v_cvt_pk_bf16_f32 v71, v38, v39
v_mfma_f32_16x16x32_bf16 v[248:251], a[56:59], v[60:63], v[248:251]
v_mfma_f32_16x16x32_bf16 v[252:255], a[60:63], v[60:63], v[252:255]
v_exp_f32 v40, v40
v_mfma_f32_16x16x32_bf16 v[220:223], a[60:63], v[56:59], v[220:223]
v_exp_f32 v41, v41
v_mfma_f32_16x16x32_bf16 v[188:191], a[60:63], v[52:55], v[188:191]
ds_read_b128 a[32:35], v2 offset:0
v_cvt_pk_bf16_f32 v74, v40, v41
v_mfma_f32_16x16x32_bf16 v[156:159], a[60:63], v[48:51], v[156:159]
v_smfmac_f32_16x16x64_bf16 a[224:227], a[232:235], v[48:55], v9
v_exp_f32 v42, v42
v_smfmac_f32_16x16x64_bf16 a[228:231], a[232:235], v[56:63], v9
s_waitcnt lgkmcnt(5)
v_exp_f32 v43, v43
v_mfma_f32_16x16x32_bf16 v[16:19], a[0:3], a[160:163], v[80:83]
ds_read_b128 a[36:39], v2 offset:1024
v_cvt_pk_bf16_f32 v75, v42, v43
v_mfma_f32_16x16x32_bf16 v[16:19], a[4:7], a[164:167], v[16:19]
v_exp_f32 v44, v44
v_mfma_f32_16x16x32_bf16 v[16:19], a[8:11], a[168:171], v[16:19]
v_mfma_f32_16x16x32_bf16 v[16:19], a[12:15], a[172:175], v[16:19]
v_exp_f32 v45, v45
v_mfma_f32_16x16x32_bf16 v[20:23], a[0:3], a[176:179], v[84:87]
ds_read_b128 a[40:43], v2 offset:2048
v_cvt_pk_bf16_f32 v78, v44, v45
v_mfma_f32_16x16x32_bf16 v[20:23], a[4:7], a[180:183], v[20:23]
buffer_load_dwordx4 v3, s[48:51], s32 offen offset:2048 sc1 lds
v_mfma_f32_16x16x32_bf16 v[20:23], a[8:11], a[184:187], v[20:23]
v_exp_f32 v46, v46
v_mfma_f32_16x16x32_bf16 v[20:23], a[12:15], a[188:191], v[20:23]
ds_read_b128 a[44:47], v2 offset:3072
v_mfma_f32_16x16x32_bf16 v[24:27], a[0:3], a[192:195], v[88:91]
v_mfma_f32_16x16x32_bf16 v[24:27], a[4:7], a[196:199], v[24:27]
v_exp_f32 v47, v47
v_mfma_f32_16x16x32_bf16 v[24:27], a[8:11], a[200:203], v[24:27]
v_exp_f32 v16, v16
v_mfma_f32_16x16x32_bf16 v[24:27], a[12:15], a[204:207], v[24:27]
ds_read_b128 a[48:51], v2 offset:4096
v_cvt_pk_bf16_f32 v79, v46, v47
v_mfma_f32_16x16x32_bf16 v[28:31], a[0:3], a[208:211], v[92:95]
v_mfma_f32_16x16x32_bf16 v[28:31], a[4:7], a[212:215], v[28:31]
v_exp_f32 v17, v17
v_mfma_f32_16x16x32_bf16 v[28:31], a[8:11], a[216:219], v[28:31]
s_waitcnt lgkmcnt(5)
v_exp_f32 v18, v18
v_mfma_f32_16x16x32_bf16 v[28:31], a[12:15], a[220:223], v[28:31]
ds_read_b128 a[52:55], v2 offset:5120
v_cvt_pk_bf16_f32 v48, v16, v17
v_mfma_f32_16x16x32_bf16 v[32:35], a[16:19], a[160:163], v[80:83]
v_mfma_f32_16x16x32_bf16 v[32:35], a[20:23], a[164:167], v[32:35]
v_exp_f32 v19, v19
v_mfma_f32_16x16x32_bf16 v[32:35], a[24:27], a[168:171], v[32:35]
v_exp_f32 v20, v20
v_mfma_f32_16x16x32_bf16 v[32:35], a[28:31], a[172:175], v[32:35]
ds_read_b128 a[56:59], v2 offset:6144
v_cvt_pk_bf16_f32 v49, v18, v19
v_mfma_f32_16x16x32_bf16 v[36:39], a[16:19], a[176:179], v[84:87]
v_exp_f32 v21, v21
v_mfma_f32_16x16x32_bf16 v[36:39], a[20:23], a[180:183], v[36:39]
buffer_load_dwordx4 v3, s[48:51], s32 offen offset:3072 sc1 lds
v_mfma_f32_16x16x32_bf16 v[36:39], a[24:27], a[184:187], v[36:39]
s_add_u32 s32, s32, 0x8000
v_cvt_pk_bf16_f32 v52, v20, v21
v_mfma_f32_16x16x32_bf16 v[36:39], a[28:31], a[188:191], v[36:39]
ds_read_b128 a[60:63], v2 offset:7168
v_mfma_f32_16x16x32_bf16 v[40:43], a[16:19], a[192:195], v[88:91]
v_exp_f32 v22, v22
v_mfma_f32_16x16x32_bf16 v[40:43], a[20:23], a[196:199], v[40:43]
v_exp_f32 v23, v23
v_mfma_f32_16x16x32_bf16 v[40:43], a[24:27], a[200:203], v[40:43]
v_cvt_pk_bf16_f32 v53, v22, v23
v_mfma_f32_16x16x32_bf16 v[40:43], a[28:31], a[204:207], v[40:43]
v_exp_f32 v24, v24
v_mfma_f32_16x16x32_bf16 v[44:47], a[16:19], a[208:211], v[92:95]
v_exp_f32 v25, v25
v_mfma_f32_16x16x32_bf16 v[44:47], a[20:23], a[212:215], v[44:47]
v_exp_f32 v26, v26
v_mfma_f32_16x16x32_bf16 v[44:47], a[24:27], a[216:219], v[44:47]
v_exp_f32 v27, v27
v_mfma_f32_16x16x32_bf16 v[44:47], a[28:31], a[220:223], v[44:47]
s_waitcnt lgkmcnt(0)
v_mfma_f32_16x16x32_bf16 v[128:131], a[32:35], v[64:67], v[128:131]
ds_read_b128 a[0:3], v2 offset:24576
v_cvt_pk_bf16_f32 v56, v24, v25
v_mfma_f32_16x16x32_bf16 v[160:163], a[32:35], v[68:71], v[160:163]
v_exp_f32 v28, v28
v_mfma_f32_16x16x32_bf16 v[192:195], a[32:35], v[72:75], v[192:195]
v_cvt_pk_bf16_f32 v57, v26, v27
v_mfma_f32_16x16x32_bf16 v[224:227], a[32:35], v[76:79], v[224:227]
ds_read_b128 a[4:7], v2 offset:25600
v_mfma_f32_16x16x32_bf16 v[228:231], a[36:39], v[76:79], v[228:231]
v_exp_f32 v29, v29
v_mfma_f32_16x16x32_bf16 v[196:199], a[36:39], v[72:75], v[196:199]
v_exp_f32 v30, v30
v_mfma_f32_16x16x32_bf16 v[164:167], a[36:39], v[68:71], v[164:167]
s_add_u32 m0, s19, 0x1000
v_cvt_pk_bf16_f32 v60, v28, v29
v_mfma_f32_16x16x32_bf16 v[132:135], a[36:39], v[64:67], v[132:135]
buffer_load_dwordx4 v3, s[48:51], s7 offen offset:0 sc1 lds
v_mfma_f32_16x16x32_bf16 v[136:139], a[40:43], v[64:67], v[136:139]
ds_read_b128 a[8:11], v2 offset:26624
v_mfma_f32_16x16x32_bf16 v[168:171], a[40:43], v[68:71], v[168:171]
v_exp_f32 v31, v31
v_mfma_f32_16x16x32_bf16 v[200:203], a[40:43], v[72:75], v[200:203]
v_exp_f32 v32, v32
v_mfma_f32_16x16x32_bf16 v[232:235], a[40:43], v[76:79], v[232:235]
ds_read_b128 a[12:15], v2 offset:27648
v_cvt_pk_bf16_f32 v61, v30, v31
v_mfma_f32_16x16x32_bf16 v[236:239], a[44:47], v[76:79], v[236:239]
v_mfma_f32_16x16x32_bf16 v[204:207], a[44:47], v[72:75], v[204:207]
v_exp_f32 v33, v33
v_mfma_f32_16x16x32_bf16 v[172:175], a[44:47], v[68:71], v[172:175]
v_exp_f32 v34, v34
v_mfma_f32_16x16x32_bf16 v[140:143], a[44:47], v[64:67], v[140:143]
ds_read_b128 a[16:19], v2 offset:28672
v_cvt_pk_bf16_f32 v50, v32, v33
v_mfma_f32_16x16x32_bf16 v[144:147], a[48:51], v[64:67], v[144:147]
v_exp_f32 v35, v35
v_mfma_f32_16x16x32_bf16 v[176:179], a[48:51], v[68:71], v[176:179]
v_cvt_pk_bf16_f32 v51, v34, v35
v_mfma_f32_16x16x32_bf16 v[208:211], a[48:51], v[72:75], v[208:211]
ds_read_b128 a[20:23], v2 offset:29696
v_mfma_f32_16x16x32_bf16 v[240:243], a[48:51], v[76:79], v[240:243]
v_exp_f32 v36, v36
v_mfma_f32_16x16x32_bf16 v[244:247], a[52:55], v[76:79], v[244:247]
v_exp_f32 v37, v37
v_mfma_f32_16x16x32_bf16 v[212:215], a[52:55], v[72:75], v[212:215]
v_cvt_pk_bf16_f32 v54, v36, v37
v_mfma_f32_16x16x32_bf16 v[180:183], a[52:55], v[68:71], v[180:183]
buffer_load_dwordx4 v3, s[48:51], s7 offen offset:1024 sc1 lds
v_mfma_f32_16x16x32_bf16 v[148:151], a[52:55], v[64:67], v[148:151]
ds_read_b128 a[24:27], v2 offset:30720
v_mfma_f32_16x16x32_bf16 v[152:155], a[56:59], v[64:67], v[152:155]
v_exp_f32 v38, v38
v_mfma_f32_16x16x32_bf16 v[184:187], a[56:59], v[68:71], v[184:187]
v_exp_f32 v39, v39
v_mfma_f32_16x16x32_bf16 v[216:219], a[56:59], v[72:75], v[216:219]
ds_read_b128 a[28:31], v2 offset:31744
v_cvt_pk_bf16_f32 v55, v38, v39
v_mfma_f32_16x16x32_bf16 v[248:251], a[56:59], v[76:79], v[248:251]
v_exp_f32 v40, v40
v_mfma_f32_16x16x32_bf16 v[252:255], a[60:63], v[76:79], v[252:255]
v_mfma_f32_16x16x32_bf16 v[220:223], a[60:63], v[72:75], v[220:223]
v_exp_f32 v41, v41
v_mfma_f32_16x16x32_bf16 v[188:191], a[60:63], v[68:71], v[188:191]
ds_read_b128 a[32:35], v2 offset:16384
v_cvt_pk_bf16_f32 v58, v40, v41
v_mfma_f32_16x16x32_bf16 v[156:159], a[60:63], v[64:67], v[156:159]
v_exp_f32 v42, v42
v_smfmac_f32_16x16x64_bf16 a[224:227], a[232:235], v[64:71], v9
s_waitcnt lgkmcnt(5)
v_smfmac_f32_16x16x64_bf16 a[228:231], a[232:235], v[72:79], v9
ds_read_b128 a[36:39], v2 offset:17408
v_mfma_f32_16x16x32_bf16 v[16:19], a[0:3], a[160:163], v[80:83]
v_exp_f32 v43, v43
v_mfma_f32_16x16x32_bf16 v[16:19], a[4:7], a[164:167], v[16:19]
v_exp_f32 v44, v44
v_mfma_f32_16x16x32_bf16 v[16:19], a[8:11], a[168:171], v[16:19]
buffer_load_dwordx4 v3, s[48:51], s7 offen offset:2048 sc1 lds
v_mfma_f32_16x16x32_bf16 v[16:19], a[12:15], a[172:175], v[16:19]
ds_read_b128 a[40:43], v2 offset:18432
v_cvt_pk_bf16_f32 v59, v42, v43
v_mfma_f32_16x16x32_bf16 v[20:23], a[0:3], a[176:179], v[84:87]
v_exp_f32 v45, v45
v_mfma_f32_16x16x32_bf16 v[20:23], a[4:7], a[180:183], v[20:23]
v_cvt_pk_bf16_f32 v62, v44, v45
v_mfma_f32_16x16x32_bf16 v[20:23], a[8:11], a[184:187], v[20:23]
v_exp_f32 v46, v46
v_mfma_f32_16x16x32_bf16 v[20:23], a[12:15], a[188:191], v[20:23]
ds_read_b128 a[44:47], v2 offset:19456
v_mfma_f32_16x16x32_bf16 v[24:27], a[0:3], a[192:195], v[88:91]
v_exp_f32 v47, v47
v_mfma_f32_16x16x32_bf16 v[24:27], a[4:7], a[196:199], v[24:27]
v_cvt_pk_bf16_f32 v63, v46, v47
v_mfma_f32_16x16x32_bf16 v[24:27], a[8:11], a[200:203], v[24:27]
v_exp_f32 v16, v16
v_mfma_f32_16x16x32_bf16 v[24:27], a[12:15], a[204:207], v[24:27]
ds_read_b128 a[48:51], v2 offset:20480
v_mfma_f32_16x16x32_bf16 v[28:31], a[0:3], a[208:211], v[92:95]
v_exp_f32 v17, v17
v_mfma_f32_16x16x32_bf16 v[28:31], a[4:7], a[212:215], v[28:31]
v_exp_f32 v18, v18
v_mfma_f32_16x16x32_bf16 v[28:31], a[8:11], a[216:219], v[28:31]
ds_read_b128 a[52:55], v2 offset:21504
v_cvt_pk_bf16_f32 v64, v16, v17
v_mfma_f32_16x16x32_bf16 v[28:31], a[12:15], a[220:223], v[28:31]
s_waitcnt lgkmcnt(6)
v_mfma_f32_16x16x32_bf16 v[32:35], a[16:19], a[160:163], v[80:83]
v_exp_f32 v19, v19
v_mfma_f32_16x16x32_bf16 v[32:35], a[20:23], a[164:167], v[32:35]
buffer_load_dwordx4 v3, s[48:51], s7 offen offset:3072 sc1 lds
v_mfma_f32_16x16x32_bf16 v[32:35], a[24:27], a[168:171], v[32:35]
ds_read_b128 a[56:59], v2 offset:22528
v_cvt_pk_bf16_f32 v65, v18, v19
v_mfma_f32_16x16x32_bf16 v[32:35], a[28:31], a[172:175], v[32:35]
s_add_u32 s7, s7, 0x8000
v_exp_f32 v20, v20
v_mfma_f32_16x16x32_bf16 v[36:39], a[16:19], a[176:179], v[84:87]
s_xor_b32 s19, s19, 0x8000
v_mfma_f32_16x16x32_bf16 v[36:39], a[20:23], a[180:183], v[36:39]
s_sub_u32 s15, s15, 1
v_exp_f32 v21, v21
v_mfma_f32_16x16x32_bf16 v[36:39], a[24:27], a[184:187], v[36:39]
ds_read_b128 a[60:63], v2 offset:23552
v_xor_b32 v2, 0x38000, v2
v_mfma_f32_16x16x32_bf16 v[36:39], a[28:31], a[188:191], v[36:39]
s_cmp_lg_u32 s15, 0
v_exp_f32 v22, v22
v_mfma_f32_16x16x32_bf16 v[40:43], a[16:19], a[192:195], v[88:91]
v_exp_f32 v23, v23
v_mfma_f32_16x16x32_bf16 v[40:43], a[20:23], a[196:199], v[40:43]
v_cvt_pk_bf16_f32 v68, v20, v21
v_cvt_pk_bf16_f32 v69, v22, v23
v_mfma_f32_16x16x32_bf16 v[40:43], a[24:27], a[200:203], v[40:43]
v_exp_f32 v24, v24
v_mfma_f32_16x16x32_bf16 v[40:43], a[28:31], a[204:207], v[40:43]
v_exp_f32 v25, v25
v_mfma_f32_16x16x32_bf16 v[44:47], a[16:19], a[208:211], v[92:95]
v_exp_f32 v26, v26
v_mfma_f32_16x16x32_bf16 v[44:47], a[20:23], a[212:215], v[44:47]
v_exp_f32 v27, v27
v_mfma_f32_16x16x32_bf16 v[44:47], a[24:27], a[216:219], v[44:47]
s_waitcnt vmcnt(16) lgkmcnt(0)
v_mfma_f32_16x16x32_bf16 v[44:47], a[28:31], a[220:223], v[44:47]
s_barrier
s_cbranch_scc1 L_att_deven0
s_branch L_att_ddone
L_att_deven1:
v_mfma_f32_16x16x32_bf16 v[128:131], a[32:35], v[48:51], v[128:131]
ds_read_b128 a[0:3], v1 offset:8192
v_cvt_pk_bf16_f32 v72, v24, v25
v_mfma_f32_16x16x32_bf16 v[160:163], a[32:35], v[52:55], v[160:163]
v_exp_f32 v28, v28
v_mfma_f32_16x16x32_bf16 v[192:195], a[32:35], v[56:59], v[192:195]
v_cvt_pk_bf16_f32 v73, v26, v27
v_mfma_f32_16x16x32_bf16 v[224:227], a[32:35], v[60:63], v[224:227]
ds_read_b128 a[4:7], v1 offset:9216
v_mfma_f32_16x16x32_bf16 v[228:231], a[36:39], v[60:63], v[228:231]
v_exp_f32 v29, v29
v_mfma_f32_16x16x32_bf16 v[196:199], a[36:39], v[56:59], v[196:199]
v_exp_f32 v30, v30
v_mfma_f32_16x16x32_bf16 v[164:167], a[36:39], v[52:55], v[164:167]
s_add_u32 m0, s27, 0x0
v_cvt_pk_bf16_f32 v76, v28, v29
v_mfma_f32_16x16x32_bf16 v[132:135], a[36:39], v[48:51], v[132:135]
buffer_load_dwordx4 v3, s[48:51], s32 offen offset:0 sc1 lds
v_mfma_f32_16x16x32_bf16 v[136:139], a[40:43], v[48:51], v[136:139]
ds_read_b128 a[8:11], v1 offset:10240
v_mfma_f32_16x16x32_bf16 v[168:171], a[40:43], v[52:55], v[168:171]
v_exp_f32 v31, v31
v_mfma_f32_16x16x32_bf16 v[200:203], a[40:43], v[56:59], v[200:203]
v_exp_f32 v32, v32
v_mfma_f32_16x16x32_bf16 v[232:235], a[40:43], v[60:63], v[232:235]
ds_read_b128 a[12:15], v1 offset:11264
v_cvt_pk_bf16_f32 v77, v30, v31
v_mfma_f32_16x16x32_bf16 v[236:239], a[44:47], v[60:63], v[236:239]
v_mfma_f32_16x16x32_bf16 v[204:207], a[44:47], v[56:59], v[204:207]
v_exp_f32 v33, v33
v_mfma_f32_16x16x32_bf16 v[172:175], a[44:47], v[52:55], v[172:175]
v_exp_f32 v34, v34
v_mfma_f32_16x16x32_bf16 v[140:143], a[44:47], v[48:51], v[140:143]
ds_read_b128 a[16:19], v1 offset:12288
v_cvt_pk_bf16_f32 v66, v32, v33
v_mfma_f32_16x16x32_bf16 v[144:147], a[48:51], v[48:51], v[144:147]
v_mfma_f32_16x16x32_bf16 v[176:179], a[48:51], v[52:55], v[176:179]
v_exp_f32 v35, v35
v_mfma_f32_16x16x32_bf16 v[208:211], a[48:51], v[56:59], v[208:211]
v_exp_f32 v36, v36
v_mfma_f32_16x16x32_bf16 v[240:243], a[48:51], v[60:63], v[240:243]
ds_read_b128 a[20:23], v1 offset:13312
v_cvt_pk_bf16_f32 v67, v34, v35
v_mfma_f32_16x16x32_bf16 v[244:247], a[52:55], v[60:63], v[244:247]
v_exp_f32 v37, v37
v_mfma_f32_16x16x32_bf16 v[212:215], a[52:55], v[56:59], v[212:215]
v_cvt_pk_bf16_f32 v70, v36, v37
v_mfma_f32_16x16x32_bf16 v[180:183], a[52:55], v[52:55], v[180:183]
ds_read_b128 a[24:27], v1 offset:14336
v_mfma_f32_16x16x32_bf16 v[148:151], a[52:55], v[48:51], v[148:151]
buffer_load_dwordx4 v3, s[48:51], s32 offen offset:1024 sc1 lds
v_mfma_f32_16x16x32_bf16 v[152:155], a[56:59], v[48:51], v[152:155]
v_exp_f32 v38, v38
v_mfma_f32_16x16x32_bf16 v[184:187], a[56:59], v[52:55], v[184:187]
v_exp_f32 v39, v39
v_mfma_f32_16x16x32_bf16 v[216:219], a[56:59], v[56:59], v[216:219]
ds_read_b128 a[28:31], v1 offset:15360
v_cvt_pk_bf16_f32 v71, v38, v39
v_mfma_f32_16x16x32_bf16 v[248:251], a[56:59], v[60:63], v[248:251]
v_mfma_f32_16x16x32_bf16 v[252:255], a[60:63], v[60:63], v[252:255]
v_exp_f32 v40, v40
v_mfma_f32_16x16x32_bf16 v[220:223], a[60:63], v[56:59], v[220:223]
v_exp_f32 v41, v41
v_mfma_f32_16x16x32_bf16 v[188:191], a[60:63], v[52:55], v[188:191]
ds_read_b128 a[32:35], v1 offset:0
v_cvt_pk_bf16_f32 v74, v40, v41
v_mfma_f32_16x16x32_bf16 v[156:159], a[60:63], v[48:51], v[156:159]
v_smfmac_f32_16x16x64_bf16 a[224:227], a[232:235], v[48:55], v9
v_exp_f32 v42, v42
v_smfmac_f32_16x16x64_bf16 a[228:231], a[232:235], v[56:63], v9
s_waitcnt lgkmcnt(5)
v_exp_f32 v43, v43
v_mfma_f32_16x16x32_bf16 v[16:19], a[0:3], a[160:163], v[80:83]
ds_read_b128 a[36:39], v1 offset:1024
v_cvt_pk_bf16_f32 v75, v42, v43
v_mfma_f32_16x16x32_bf16 v[16:19], a[4:7], a[164:167], v[16:19]
v_exp_f32 v44, v44
v_mfma_f32_16x16x32_bf16 v[16:19], a[8:11], a[168:171], v[16:19]
v_mfma_f32_16x16x32_bf16 v[16:19], a[12:15], a[172:175], v[16:19]
v_exp_f32 v45, v45
v_mfma_f32_16x16x32_bf16 v[20:23], a[0:3], a[176:179], v[84:87]
ds_read_b128 a[40:43], v1 offset:2048
v_cvt_pk_bf16_f32 v78, v44, v45
v_mfma_f32_16x16x32_bf16 v[20:23], a[4:7], a[180:183], v[20:23]
buffer_load_dwordx4 v3, s[48:51], s32 offen offset:2048 sc1 lds
v_mfma_f32_16x16x32_bf16 v[20:23], a[8:11], a[184:187], v[20:23]
v_exp_f32 v46, v46
v_mfma_f32_16x16x32_bf16 v[20:23], a[12:15], a[188:191], v[20:23]
ds_read_b128 a[44:47], v1 offset:3072
v_mfma_f32_16x16x32_bf16 v[24:27], a[0:3], a[192:195], v[88:91]
v_mfma_f32_16x16x32_bf16 v[24:27], a[4:7], a[196:199], v[24:27]
v_exp_f32 v47, v47
v_mfma_f32_16x16x32_bf16 v[24:27], a[8:11], a[200:203], v[24:27]
v_exp_f32 v16, v16
v_mfma_f32_16x16x32_bf16 v[24:27], a[12:15], a[204:207], v[24:27]
ds_read_b128 a[48:51], v1 offset:4096
v_cvt_pk_bf16_f32 v79, v46, v47
v_mfma_f32_16x16x32_bf16 v[28:31], a[0:3], a[208:211], v[92:95]
v_mfma_f32_16x16x32_bf16 v[28:31], a[4:7], a[212:215], v[28:31]
v_exp_f32 v17, v17
v_mfma_f32_16x16x32_bf16 v[28:31], a[8:11], a[216:219], v[28:31]
s_waitcnt lgkmcnt(5)
v_exp_f32 v18, v18
v_mfma_f32_16x16x32_bf16 v[28:31], a[12:15], a[220:223], v[28:31]
ds_read_b128 a[52:55], v1 offset:5120
v_cvt_pk_bf16_f32 v48, v16, v17
v_mfma_f32_16x16x32_bf16 v[32:35], a[16:19], a[160:163], v[80:83]
v_mfma_f32_16x16x32_bf16 v[32:35], a[20:23], a[164:167], v[32:35]
v_exp_f32 v19, v19
v_mfma_f32_16x16x32_bf16 v[32:35], a[24:27], a[168:171], v[32:35]
v_exp_f32 v20, v20
v_mfma_f32_16x16x32_bf16 v[32:35], a[28:31], a[172:175], v[32:35]
ds_read_b128 a[56:59], v1 offset:6144
v_cvt_pk_bf16_f32 v49, v18, v19
v_mfma_f32_16x16x32_bf16 v[36:39], a[16:19], a[176:179], v[84:87]
v_exp_f32 v21, v21
v_mfma_f32_16x16x32_bf16 v[36:39], a[20:23], a[180:183], v[36:39]
buffer_load_dwordx4 v3, s[48:51], s32 offen offset:3072 sc1 lds
v_mfma_f32_16x16x32_bf16 v[36:39], a[24:27], a[184:187], v[36:39]
s_add_u32 s32, s32, 0x8000
v_cvt_pk_bf16_f32 v52, v20, v21
v_mfma_f32_16x16x32_bf16 v[36:39], a[28:31], a[188:191], v[36:39]
ds_read_b128 a[60:63], v1 offset:7168
v_mfma_f32_16x16x32_bf16 v[40:43], a[16:19], a[192:195], v[88:91]
v_exp_f32 v22, v22
v_mfma_f32_16x16x32_bf16 v[40:43], a[20:23], a[196:199], v[40:43]
v_exp_f32 v23, v23
v_mfma_f32_16x16x32_bf16 v[40:43], a[24:27], a[200:203], v[40:43]
v_cvt_pk_bf16_f32 v53, v22, v23
v_mfma_f32_16x16x32_bf16 v[40:43], a[28:31], a[204:207], v[40:43]
v_exp_f32 v24, v24
v_mfma_f32_16x16x32_bf16 v[44:47], a[16:19], a[208:211], v[92:95]
v_exp_f32 v25, v25
v_mfma_f32_16x16x32_bf16 v[44:47], a[20:23], a[212:215], v[44:47]
v_exp_f32 v26, v26
v_mfma_f32_16x16x32_bf16 v[44:47], a[24:27], a[216:219], v[44:47]
v_exp_f32 v27, v27
v_mfma_f32_16x16x32_bf16 v[44:47], a[28:31], a[220:223], v[44:47]
s_waitcnt lgkmcnt(0)
v_mfma_f32_16x16x32_bf16 v[128:131], a[32:35], v[64:67], v[128:131]
ds_read_b128 a[0:3], v1 offset:24576
v_cvt_pk_bf16_f32 v56, v24, v25
v_mfma_f32_16x16x32_bf16 v[160:163], a[32:35], v[68:71], v[160:163]
v_exp_f32 v28, v28
v_mfma_f32_16x16x32_bf16 v[192:195], a[32:35], v[72:75], v[192:195]
v_cvt_pk_bf16_f32 v57, v26, v27
v_mfma_f32_16x16x32_bf16 v[224:227], a[32:35], v[76:79], v[224:227]
ds_read_b128 a[4:7], v1 offset:25600
v_mfma_f32_16x16x32_bf16 v[228:231], a[36:39], v[76:79], v[228:231]
v_exp_f32 v29, v29
v_mfma_f32_16x16x32_bf16 v[196:199], a[36:39], v[72:75], v[196:199]
v_exp_f32 v30, v30
v_mfma_f32_16x16x32_bf16 v[164:167], a[36:39], v[68:71], v[164:167]
s_add_u32 m0, s27, 0x1000
v_cvt_pk_bf16_f32 v60, v28, v29
v_mfma_f32_16x16x32_bf16 v[132:135], a[36:39], v[64:67], v[132:135]
buffer_load_dwordx4 v3, s[48:51], s7 offen offset:0 sc1 lds
v_mfma_f32_16x16x32_bf16 v[136:139], a[40:43], v[64:67], v[136:139]
ds_read_b128 a[8:11], v1 offset:26624
v_mfma_f32_16x16x32_bf16 v[168:171], a[40:43], v[68:71], v[168:171]
v_exp_f32 v31, v31
v_mfma_f32_16x16x32_bf16 v[200:203], a[40:43], v[72:75], v[200:203]
v_exp_f32 v32, v32
v_mfma_f32_16x16x32_bf16 v[232:235], a[40:43], v[76:79], v[232:235]
ds_read_b128 a[12:15], v1 offset:27648
v_cvt_pk_bf16_f32 v61, v30, v31
v_mfma_f32_16x16x32_bf16 v[236:239], a[44:47], v[76:79], v[236:239]
v_mfma_f32_16x16x32_bf16 v[204:207], a[44:47], v[72:75], v[204:207]
v_exp_f32 v33, v33
v_mfma_f32_16x16x32_bf16 v[172:175], a[44:47], v[68:71], v[172:175]
v_exp_f32 v34, v34
v_mfma_f32_16x16x32_bf16 v[140:143], a[44:47], v[64:67], v[140:143]
ds_read_b128 a[16:19], v1 offset:28672
v_cvt_pk_bf16_f32 v50, v32, v33
v_mfma_f32_16x16x32_bf16 v[144:147], a[48:51], v[64:67], v[144:147]
v_mfma_f32_16x16x32_bf16 v[176:179], a[48:51], v[68:71], v[176:179]
v_exp_f32 v35, v35
v_mfma_f32_16x16x32_bf16 v[208:211], a[48:51], v[72:75], v[208:211]
ds_read_b128 a[20:23], v1 offset:29696
v_cvt_pk_bf16_f32 v51, v34, v35
v_mfma_f32_16x16x32_bf16 v[240:243], a[48:51], v[76:79], v[240:243]
v_exp_f32 v36, v36
v_mfma_f32_16x16x32_bf16 v[244:247], a[52:55], v[76:79], v[244:247]
v_exp_f32 v37, v37
v_mfma_f32_16x16x32_bf16 v[212:215], a[52:55], v[72:75], v[212:215]
v_cvt_pk_bf16_f32 v54, v36, v37
v_mfma_f32_16x16x32_bf16 v[180:183], a[52:55], v[68:71], v[180:183]
buffer_load_dwordx4 v3, s[48:51], s7 offen offset:1024 sc1 lds
v_mfma_f32_16x16x32_bf16 v[148:151], a[52:55], v[64:67], v[148:151]
ds_read_b128 a[24:27], v1 offset:30720
v_mfma_f32_16x16x32_bf16 v[152:155], a[56:59], v[64:67], v[152:155]
v_exp_f32 v38, v38
v_mfma_f32_16x16x32_bf16 v[184:187], a[56:59], v[68:71], v[184:187]
v_exp_f32 v39, v39
v_mfma_f32_16x16x32_bf16 v[216:219], a[56:59], v[72:75], v[216:219]
ds_read_b128 a[28:31], v1 offset:31744
v_cvt_pk_bf16_f32 v55, v38, v39
v_mfma_f32_16x16x32_bf16 v[248:251], a[56:59], v[76:79], v[248:251]
v_mfma_f32_16x16x32_bf16 v[252:255], a[60:63], v[76:79], v[252:255]
v_exp_f32 v40, v40
v_mfma_f32_16x16x32_bf16 v[220:223], a[60:63], v[72:75], v[220:223]
v_exp_f32 v41, v41
v_mfma_f32_16x16x32_bf16 v[188:191], a[60:63], v[68:71], v[188:191]
ds_read_b128 a[32:35], v1 offset:16384
v_cvt_pk_bf16_f32 v58, v40, v41
v_mfma_f32_16x16x32_bf16 v[156:159], a[60:63], v[64:67], v[156:159]
v_smfmac_f32_16x16x64_bf16 a[224:227], a[232:235], v[64:71], v9
s_waitcnt lgkmcnt(5)
v_exp_f32 v42, v42
v_smfmac_f32_16x16x64_bf16 a[228:231], a[232:235], v[72:79], v9
ds_read_b128 a[36:39], v1 offset:17408
v_mfma_f32_16x16x32_bf16 v[16:19], a[0:3], a[160:163], v[80:83]
v_exp_f32 v43, v43
v_mfma_f32_16x16x32_bf16 v[16:19], a[4:7], a[164:167], v[16:19]
v_exp_f32 v44, v44
v_mfma_f32_16x16x32_bf16 v[16:19], a[8:11], a[168:171], v[16:19]
v_cvt_pk_bf16_f32 v59, v42, v43
v_mfma_f32_16x16x32_bf16 v[16:19], a[12:15], a[172:175], v[16:19]
ds_read_b128 a[40:43], v1 offset:18432
v_mfma_f32_16x16x32_bf16 v[20:23], a[0:3], a[176:179], v[84:87]
buffer_load_dwordx4 v3, s[48:51], s7 offen offset:2048 sc1 lds
v_mfma_f32_16x16x32_bf16 v[20:23], a[4:7], a[180:183], v[20:23]
v_exp_f32 v45, v45
v_mfma_f32_16x16x32_bf16 v[20:23], a[8:11], a[184:187], v[20:23]
v_exp_f32 v46, v46
v_mfma_f32_16x16x32_bf16 v[20:23], a[12:15], a[188:191], v[20:23]
ds_read_b128 a[44:47], v1 offset:19456
v_cvt_pk_bf16_f32 v62, v44, v45
v_mfma_f32_16x16x32_bf16 v[24:27], a[0:3], a[192:195], v[88:91]
v_mfma_f32_16x16x32_bf16 v[24:27], a[4:7], a[196:199], v[24:27]
v_exp_f32 v47, v47
v_mfma_f32_16x16x32_bf16 v[24:27], a[8:11], a[200:203], v[24:27]
v_exp_f32 v16, v16
v_mfma_f32_16x16x32_bf16 v[24:27], a[12:15], a[204:207], v[24:27]
ds_read_b128 a[48:51], v1 offset:20480
v_cvt_pk_bf16_f32 v63, v46, v47
v_mfma_f32_16x16x32_bf16 v[28:31], a[0:3], a[208:211], v[92:95]
v_mfma_f32_16x16x32_bf16 v[28:31], a[4:7], a[212:215], v[28:31]
v_exp_f32 v17, v17
v_mfma_f32_16x16x32_bf16 v[28:31], a[8:11], a[216:219], v[28:31]
ds_read_b128 a[52:55], v1 offset:21504
v_cvt_pk_bf16_f32 v64, v16, v17
v_mfma_f32_16x16x32_bf16 v[28:31], a[12:15], a[220:223], v[28:31]
s_waitcnt lgkmcnt(6)
v_exp_f32 v18, v18
v_mfma_f32_16x16x32_bf16 v[32:35], a[16:19], a[160:163], v[80:83]
v_mfma_f32_16x16x32_bf16 v[32:35], a[20:23], a[164:167], v[32:35]
v_exp_f32 v19, v19
v_mfma_f32_16x16x32_bf16 v[32:35], a[24:27], a[168:171], v[32:35]
ds_read_b128 a[56:59], v1 offset:22528
v_cvt_pk_bf16_f32 v65, v18, v19
v_mfma_f32_16x16x32_bf16 v[32:35], a[28:31], a[172:175], v[32:35]
buffer_load_dwordx4 v3, s[48:51], s7 offen offset:3072 sc1 lds
v_mfma_f32_16x16x32_bf16 v[36:39], a[16:19], a[176:179], v[84:87]
s_add_u32 s7, s7, 0x8000
v_exp_f32 v20, v20
v_mfma_f32_16x16x32_bf16 v[36:39], a[20:23], a[180:183], v[36:39]
s_xor_b32 s27, s27, 0x38000
v_exp_f32 v21, v21
v_mfma_f32_16x16x32_bf16 v[36:39], a[24:27], a[184:187], v[36:39]
ds_read_b128 a[60:63], v1 offset:23552
v_xor_b32 v1, 0x8000, v1
v_mfma_f32_16x16x32_bf16 v[36:39], a[28:31], a[188:191], v[36:39]
v_cvt_pk_bf16_f32 v68, v20, v21
v_mfma_f32_16x16x32_bf16 v[40:43], a[16:19], a[192:195], v[88:91]
v_exp_f32 v22, v22
v_mfma_f32_16x16x32_bf16 v[40:43], a[20:23], a[196:199], v[40:43]
v_exp_f32 v23, v23
v_mfma_f32_16x16x32_bf16 v[40:43], a[24:27], a[200:203], v[40:43]
v_cvt_pk_bf16_f32 v69, v22, v23
v_mfma_f32_16x16x32_bf16 v[40:43], a[28:31], a[204:207], v[40:43]
v_exp_f32 v24, v24
v_mfma_f32_16x16x32_bf16 v[44:47], a[16:19], a[208:211], v[92:95]
s_waitcnt vmcnt(16) lgkmcnt(0)
v_exp_f32 v25, v25
v_mfma_f32_16x16x32_bf16 v[44:47], a[20:23], a[212:215], v[44:47]
s_barrier
v_exp_f32 v26, v26
v_mfma_f32_16x16x32_bf16 v[44:47], a[24:27], a[216:219], v[44:47]
v_exp_f32 v27, v27
v_mfma_f32_16x16x32_bf16 v[44:47], a[28:31], a[220:223], v[44:47]
L_att_dodd1:
v_mfma_f32_16x16x32_bf16 v[128:131], a[32:35], v[48:51], v[128:131]
ds_read_b128 a[0:3], v2 offset:8192
v_cvt_pk_bf16_f32 v72, v24, v25
v_mfma_f32_16x16x32_bf16 v[160:163], a[32:35], v[52:55], v[160:163]
v_exp_f32 v28, v28
v_mfma_f32_16x16x32_bf16 v[192:195], a[32:35], v[56:59], v[192:195]
v_cvt_pk_bf16_f32 v73, v26, v27
v_mfma_f32_16x16x32_bf16 v[224:227], a[32:35], v[60:63], v[224:227]
ds_read_b128 a[4:7], v2 offset:9216
v_mfma_f32_16x16x32_bf16 v[228:231], a[36:39], v[60:63], v[228:231]
v_exp_f32 v29, v29
v_mfma_f32_16x16x32_bf16 v[196:199], a[36:39], v[56:59], v[196:199]
v_exp_f32 v30, v30
v_mfma_f32_16x16x32_bf16 v[164:167], a[36:39], v[52:55], v[164:167]
s_add_u32 m0, s19, 0x0
v_cvt_pk_bf16_f32 v76, v28, v29
v_mfma_f32_16x16x32_bf16 v[132:135], a[36:39], v[48:51], v[132:135]
buffer_load_dwordx4 v3, s[48:51], s32 offen offset:0 sc1 lds
v_mfma_f32_16x16x32_bf16 v[136:139], a[40:43], v[48:51], v[136:139]
ds_read_b128 a[8:11], v2 offset:10240
v_mfma_f32_16x16x32_bf16 v[168:171], a[40:43], v[52:55], v[168:171]
v_exp_f32 v31, v31
v_mfma_f32_16x16x32_bf16 v[200:203], a[40:43], v[56:59], v[200:203]
v_exp_f32 v32, v32
v_mfma_f32_16x16x32_bf16 v[232:235], a[40:43], v[60:63], v[232:235]
ds_read_b128 a[12:15], v2 offset:11264
v_cvt_pk_bf16_f32 v77, v30, v31
v_mfma_f32_16x16x32_bf16 v[236:239], a[44:47], v[60:63], v[236:239]
v_mfma_f32_16x16x32_bf16 v[204:207], a[44:47], v[56:59], v[204:207]
v_exp_f32 v33, v33
v_mfma_f32_16x16x32_bf16 v[172:175], a[44:47], v[52:55], v[172:175]
v_exp_f32 v34, v34
v_mfma_f32_16x16x32_bf16 v[140:143], a[44:47], v[48:51], v[140:143]
ds_read_b128 a[16:19], v2 offset:12288
v_cvt_pk_bf16_f32 v66, v32, v33
v_mfma_f32_16x16x32_bf16 v[144:147], a[48:51], v[48:51], v[144:147]
v_mfma_f32_16x16x32_bf16 v[176:179], a[48:51], v[52:55], v[176:179]
v_exp_f32 v35, v35
v_mfma_f32_16x16x32_bf16 v[208:211], a[48:51], v[56:59], v[208:211]
v_exp_f32 v36, v36
v_mfma_f32_16x16x32_bf16 v[240:243], a[48:51], v[60:63], v[240:243]
ds_read_b128 a[20:23], v2 offset:13312
v_cvt_pk_bf16_f32 v67, v34, v35
v_mfma_f32_16x16x32_bf16 v[244:247], a[52:55], v[60:63], v[244:247]
v_exp_f32 v37, v37
v_mfma_f32_16x16x32_bf16 v[212:215], a[52:55], v[56:59], v[212:215]
v_cvt_pk_bf16_f32 v70, v36, v37
v_mfma_f32_16x16x32_bf16 v[180:183], a[52:55], v[52:55], v[180:183]
ds_read_b128 a[24:27], v2 offset:14336
v_mfma_f32_16x16x32_bf16 v[148:151], a[52:55], v[48:51], v[148:151]
buffer_load_dwordx4 v3, s[48:51], s32 offen offset:1024 sc1 lds
v_mfma_f32_16x16x32_bf16 v[152:155], a[56:59], v[48:51], v[152:155]
v_exp_f32 v38, v38
v_mfma_f32_16x16x32_bf16 v[184:187], a[56:59], v[52:55], v[184:187]
v_exp_f32 v39, v39
v_mfma_f32_16x16x32_bf16 v[216:219], a[56:59], v[56:59], v[216:219]
ds_read_b128 a[28:31], v2 offset:15360
v_cvt_pk_bf16_f32 v71, v38, v39
v_mfma_f32_16x16x32_bf16 v[248:251], a[56:59], v[60:63], v[248:251]
v_mfma_f32_16x16x32_bf16 v[252:255], a[60:63], v[60:63], v[252:255]
v_exp_f32 v40, v40
v_mfma_f32_16x16x32_bf16 v[220:223], a[60:63], v[56:59], v[220:223]
v_exp_f32 v41, v41
v_mfma_f32_16x16x32_bf16 v[188:191], a[60:63], v[52:55], v[188:191]
ds_read_b128 a[32:35], v2 offset:0
v_cvt_pk_bf16_f32 v74, v40, v41
v_mfma_f32_16x16x32_bf16 v[156:159], a[60:63], v[48:51], v[156:159]
v_smfmac_f32_16x16x64_bf16 a[224:227], a[232:235], v[48:55], v9
v_exp_f32 v42, v42
v_smfmac_f32_16x16x64_bf16 a[228:231], a[232:235], v[56:63], v9
s_waitcnt lgkmcnt(5)
v_exp_f32 v43, v43
v_mfma_f32_16x16x32_bf16 v[16:19], a[0:3], a[160:163], v[80:83]
ds_read_b128 a[36:39], v2 offset:1024
v_cvt_pk_bf16_f32 v75, v42, v43
v_mfma_f32_16x16x32_bf16 v[16:19], a[4:7], a[164:167], v[16:19]
v_exp_f32 v44, v44
v_mfma_f32_16x16x32_bf16 v[16:19], a[8:11], a[168:171], v[16:19]
v_mfma_f32_16x16x32_bf16 v[16:19], a[12:15], a[172:175], v[16:19]
v_exp_f32 v45, v45
v_mfma_f32_16x16x32_bf16 v[20:23], a[0:3], a[176:179], v[84:87]
ds_read_b128 a[40:43], v2 offset:2048
v_cvt_pk_bf16_f32 v78, v44, v45
v_mfma_f32_16x16x32_bf16 v[20:23], a[4:7], a[180:183], v[20:23]
buffer_load_dwordx4 v3, s[48:51], s32 offen offset:2048 sc1 lds
v_mfma_f32_16x16x32_bf16 v[20:23], a[8:11], a[184:187], v[20:23]
v_exp_f32 v46, v46
v_mfma_f32_16x16x32_bf16 v[20:23], a[12:15], a[188:191], v[20:23]
ds_read_b128 a[44:47], v2 offset:3072
v_mfma_f32_16x16x32_bf16 v[24:27], a[0:3], a[192:195], v[88:91]
v_mfma_f32_16x16x32_bf16 v[24:27], a[4:7], a[196:199], v[24:27]
v_exp_f32 v47, v47
v_mfma_f32_16x16x32_bf16 v[24:27], a[8:11], a[200:203], v[24:27]
v_exp_f32 v16, v16
v_mfma_f32_16x16x32_bf16 v[24:27], a[12:15], a[204:207], v[24:27]
ds_read_b128 a[48:51], v2 offset:4096
v_cvt_pk_bf16_f32 v79, v46, v47
v_mfma_f32_16x16x32_bf16 v[28:31], a[0:3], a[208:211], v[92:95]
v_mfma_f32_16x16x32_bf16 v[28:31], a[4:7], a[212:215], v[28:31]
v_exp_f32 v17, v17
v_mfma_f32_16x16x32_bf16 v[28:31], a[8:11], a[216:219], v[28:31]
s_waitcnt lgkmcnt(5)
v_exp_f32 v18, v18
v_mfma_f32_16x16x32_bf16 v[28:31], a[12:15], a[220:223], v[28:31]
ds_read_b128 a[52:55], v2 offset:5120
v_cvt_pk_bf16_f32 v48, v16, v17
v_mfma_f32_16x16x32_bf16 v[32:35], a[16:19], a[160:163], v[80:83]
v_mfma_f32_16x16x32_bf16 v[32:35], a[20:23], a[164:167], v[32:35]
v_exp_f32 v19, v19
v_mfma_f32_16x16x32_bf16 v[32:35], a[24:27], a[168:171], v[32:35]
v_exp_f32 v20, v20
v_mfma_f32_16x16x32_bf16 v[32:35], a[28:31], a[172:175], v[32:35]
ds_read_b128 a[56:59], v2 offset:6144
v_cvt_pk_bf16_f32 v49, v18, v19
v_mfma_f32_16x16x32_bf16 v[36:39], a[16:19], a[176:179], v[84:87]
v_exp_f32 v21, v21
v_mfma_f32_16x16x32_bf16 v[36:39], a[20:23], a[180:183], v[36:39]
buffer_load_dwordx4 v3, s[48:51], s32 offen offset:3072 sc1 lds
v_mfma_f32_16x16x32_bf16 v[36:39], a[24:27], a[184:187], v[36:39]
s_add_u32 s32, s32, 0x8000
v_cvt_pk_bf16_f32 v52, v20, v21
v_mfma_f32_16x16x32_bf16 v[36:39], a[28:31], a[188:191], v[36:39]
ds_read_b128 a[60:63], v2 offset:7168
v_mfma_f32_16x16x32_bf16 v[40:43], a[16:19], a[192:195], v[88:91]
v_exp_f32 v22, v22
v_mfma_f32_16x16x32_bf16 v[40:43], a[20:23], a[196:199], v[40:43]
v_exp_f32 v23, v23
v_mfma_f32_16x16x32_bf16 v[40:43], a[24:27], a[200:203], v[40:43]
v_cvt_pk_bf16_f32 v53, v22, v23
v_mfma_f32_16x16x32_bf16 v[40:43], a[28:31], a[204:207], v[40:43]
v_exp_f32 v24, v24
v_mfma_f32_16x16x32_bf16 v[44:47], a[16:19], a[208:211], v[92:95]
v_exp_f32 v25, v25
v_mfma_f32_16x16x32_bf16 v[44:47], a[20:23], a[212:215], v[44:47]
v_exp_f32 v26, v26
v_mfma_f32_16x16x32_bf16 v[44:47], a[24:27], a[216:219], v[44:47]
v_exp_f32 v27, v27
v_mfma_f32_16x16x32_bf16 v[44:47], a[28:31], a[220:223], v[44:47]
s_waitcnt lgkmcnt(0)
v_mfma_f32_16x16x32_bf16 v[128:131], a[32:35], v[64:67], v[128:131]
ds_read_b128 a[0:3], v2 offset:24576
v_cvt_pk_bf16_f32 v56, v24, v25
v_mfma_f32_16x16x32_bf16 v[160:163], a[32:35], v[68:71], v[160:163]
v_exp_f32 v28, v28
v_mfma_f32_16x16x32_bf16 v[192:195], a[32:35], v[72:75], v[192:195]
v_cvt_pk_bf16_f32 v57, v26, v27
v_mfma_f32_16x16x32_bf16 v[224:227], a[32:35], v[76:79], v[224:227]
ds_read_b128 a[4:7], v2 offset:25600
v_mfma_f32_16x16x32_bf16 v[228:231], a[36:39], v[76:79], v[228:231]
v_exp_f32 v29, v29
v_mfma_f32_16x16x32_bf16 v[196:199], a[36:39], v[72:75], v[196:199]
v_exp_f32 v30, v30
v_mfma_f32_16x16x32_bf16 v[164:167], a[36:39], v[68:71], v[164:167]
s_add_u32 m0, s19, 0x1000
v_cvt_pk_bf16_f32 v60, v28, v29
v_mfma_f32_16x16x32_bf16 v[132:135], a[36:39], v[64:67], v[132:135]
buffer_load_dwordx4 v3, s[48:51], s7 offen offset:0 sc1 lds
v_mfma_f32_16x16x32_bf16 v[136:139], a[40:43], v[64:67], v[136:139]
ds_read_b128 a[8:11], v2 offset:26624
v_mfma_f32_16x16x32_bf16 v[168:171], a[40:43], v[68:71], v[168:171]
v_exp_f32 v31, v31
v_mfma_f32_16x16x32_bf16 v[200:203], a[40:43], v[72:75], v[200:203]
v_exp_f32 v32, v32
v_mfma_f32_16x16x32_bf16 v[232:235], a[40:43], v[76:79], v[232:235]
ds_read_b128 a[12:15], v2 offset:27648
v_cvt_pk_bf16_f32 v61, v30, v31
v_mfma_f32_16x16x32_bf16 v[236:239], a[44:47], v[76:79], v[236:239]
v_mfma_f32_16x16x32_bf16 v[204:207], a[44:47], v[72:75], v[204:207]
v_exp_f32 v33, v33
v_mfma_f32_16x16x32_bf16 v[172:175], a[44:47], v[68:71], v[172:175]
v_exp_f32 v34, v34
v_mfma_f32_16x16x32_bf16 v[140:143], a[44:47], v[64:67], v[140:143]
ds_read_b128 a[16:19], v2 offset:28672
v_cvt_pk_bf16_f32 v50, v32, v33
v_mfma_f32_16x16x32_bf16 v[144:147], a[48:51], v[64:67], v[144:147]
v_exp_f32 v35, v35
v_mfma_f32_16x16x32_bf16 v[176:179], a[48:51], v[68:71], v[176:179]
v_cvt_pk_bf16_f32 v51, v34, v35
v_mfma_f32_16x16x32_bf16 v[208:211], a[48:51], v[72:75], v[208:211]
ds_read_b128 a[20:23], v2 offset:29696
v_mfma_f32_16x16x32_bf16 v[240:243], a[48:51], v[76:79], v[240:243]
v_exp_f32 v36, v36
v_mfma_f32_16x16x32_bf16 v[244:247], a[52:55], v[76:79], v[244:247]
v_exp_f32 v37, v37
v_mfma_f32_16x16x32_bf16 v[212:215], a[52:55], v[72:75], v[212:215]
v_cvt_pk_bf16_f32 v54, v36, v37
v_mfma_f32_16x16x32_bf16 v[180:183], a[52:55], v[68:71], v[180:183]
buffer_load_dwordx4 v3, s[48:51], s7 offen offset:1024 sc1 lds
v_mfma_f32_16x16x32_bf16 v[148:151], a[52:55], v[64:67], v[148:151]
ds_read_b128 a[24:27], v2 offset:30720
v_mfma_f32_16x16x32_bf16 v[152:155], a[56:59], v[64:67], v[152:155]
v_exp_f32 v38, v38
v_mfma_f32_16x16x32_bf16 v[184:187], a[56:59], v[68:71], v[184:187]
v_exp_f32 v39, v39
v_mfma_f32_16x16x32_bf16 v[216:219], a[56:59], v[72:75], v[216:219]
ds_read_b128 a[28:31], v2 offset:31744
v_cvt_pk_bf16_f32 v55, v38, v39
v_mfma_f32_16x16x32_bf16 v[248:251], a[56:59], v[76:79], v[248:251]
v_exp_f32 v40, v40
v_mfma_f32_16x16x32_bf16 v[252:255], a[60:63], v[76:79], v[252:255]
v_mfma_f32_16x16x32_bf16 v[220:223], a[60:63], v[72:75], v[220:223]
v_exp_f32 v41, v41
v_mfma_f32_16x16x32_bf16 v[188:191], a[60:63], v[68:71], v[188:191]
ds_read_b128 a[32:35], v2 offset:16384
v_cvt_pk_bf16_f32 v58, v40, v41
v_mfma_f32_16x16x32_bf16 v[156:159], a[60:63], v[64:67], v[156:159]
v_exp_f32 v42, v42
v_smfmac_f32_16x16x64_bf16 a[224:227], a[232:235], v[64:71], v9
s_waitcnt lgkmcnt(5)
v_smfmac_f32_16x16x64_bf16 a[228:231], a[232:235], v[72:79], v9
ds_read_b128 a[36:39], v2 offset:17408
v_mfma_f32_16x16x32_bf16 v[16:19], a[0:3], a[160:163], v[80:83]
v_exp_f32 v43, v43
v_mfma_f32_16x16x32_bf16 v[16:19], a[4:7], a[164:167], v[16:19]
v_exp_f32 v44, v44
v_mfma_f32_16x16x32_bf16 v[16:19], a[8:11], a[168:171], v[16:19]
buffer_load_dwordx4 v3, s[48:51], s7 offen offset:2048 sc1 lds
v_mfma_f32_16x16x32_bf16 v[16:19], a[12:15], a[172:175], v[16:19]
ds_read_b128 a[40:43], v2 offset:18432
v_cvt_pk_bf16_f32 v59, v42, v43
v_mfma_f32_16x16x32_bf16 v[20:23], a[0:3], a[176:179], v[84:87]
v_exp_f32 v45, v45
v_mfma_f32_16x16x32_bf16 v[20:23], a[4:7], a[180:183], v[20:23]
v_cvt_pk_bf16_f32 v62, v44, v45
v_mfma_f32_16x16x32_bf16 v[20:23], a[8:11], a[184:187], v[20:23]
v_exp_f32 v46, v46
v_mfma_f32_16x16x32_bf16 v[20:23], a[12:15], a[188:191], v[20:23]
ds_read_b128 a[44:47], v2 offset:19456
v_mfma_f32_16x16x32_bf16 v[24:27], a[0:3], a[192:195], v[88:91]
v_exp_f32 v47, v47
v_mfma_f32_16x16x32_bf16 v[24:27], a[4:7], a[196:199], v[24:27]
v_cvt_pk_bf16_f32 v63, v46, v47
v_mfma_f32_16x16x32_bf16 v[24:27], a[8:11], a[200:203], v[24:27]
v_exp_f32 v16, v16
v_mfma_f32_16x16x32_bf16 v[24:27], a[12:15], a[204:207], v[24:27]
ds_read_b128 a[48:51], v2 offset:20480
v_mfma_f32_16x16x32_bf16 v[28:31], a[0:3], a[208:211], v[92:95]
v_exp_f32 v17, v17
v_mfma_f32_16x16x32_bf16 v[28:31], a[4:7], a[212:215], v[28:31]
v_exp_f32 v18, v18
v_mfma_f32_16x16x32_bf16 v[28:31], a[8:11], a[216:219], v[28:31]
ds_read_b128 a[52:55], v2 offset:21504
v_cvt_pk_bf16_f32 v64, v16, v17
v_mfma_f32_16x16x32_bf16 v[28:31], a[12:15], a[220:223], v[28:31]
s_waitcnt lgkmcnt(6)
v_mfma_f32_16x16x32_bf16 v[32:35], a[16:19], a[160:163], v[80:83]
v_exp_f32 v19, v19
v_mfma_f32_16x16x32_bf16 v[32:35], a[20:23], a[164:167], v[32:35]
buffer_load_dwordx4 v3, s[48:51], s7 offen offset:3072 sc1 lds
v_mfma_f32_16x16x32_bf16 v[32:35], a[24:27], a[168:171], v[32:35]
ds_read_b128 a[56:59], v2 offset:22528
v_cvt_pk_bf16_f32 v65, v18, v19
v_mfma_f32_16x16x32_bf16 v[32:35], a[28:31], a[172:175], v[32:35]
s_add_u32 s7, s7, 0x8000
v_exp_f32 v20, v20
v_mfma_f32_16x16x32_bf16 v[36:39], a[16:19], a[176:179], v[84:87]
s_xor_b32 s19, s19, 0x8000
v_mfma_f32_16x16x32_bf16 v[36:39], a[20:23], a[180:183], v[36:39]
s_sub_u32 s15, s15, 1
v_exp_f32 v21, v21
v_mfma_f32_16x16x32_bf16 v[36:39], a[24:27], a[184:187], v[36:39]
ds_read_b128 a[60:63], v2 offset:23552
v_xor_b32 v2, 0x38000, v2
v_mfma_f32_16x16x32_bf16 v[36:39], a[28:31], a[188:191], v[36:39]
s_cmp_lg_u32 s15, 0
v_exp_f32 v22, v22
v_mfma_f32_16x16x32_bf16 v[40:43], a[16:19], a[192:195], v[88:91]
v_exp_f32 v23, v23
v_mfma_f32_16x16x32_bf16 v[40:43], a[20:23], a[196:199], v[40:43]
v_cvt_pk_bf16_f32 v68, v20, v21
v_cvt_pk_bf16_f32 v69, v22, v23
v_mfma_f32_16x16x32_bf16 v[40:43], a[24:27], a[200:203], v[40:43]
v_exp_f32 v24, v24
v_mfma_f32_16x16x32_bf16 v[40:43], a[28:31], a[204:207], v[40:43]
v_exp_f32 v25, v25
v_mfma_f32_16x16x32_bf16 v[44:47], a[16:19], a[208:211], v[92:95]
s_waitcnt vmcnt(16) lgkmcnt(0)
v_exp_f32 v26, v26
v_mfma_f32_16x16x32_bf16 v[44:47], a[20:23], a[212:215], v[44:47]
s_barrier
v_exp_f32 v27, v27
v_mfma_f32_16x16x32_bf16 v[44:47], a[24:27], a[216:219], v[44:47]
v_mfma_f32_16x16x32_bf16 v[44:47], a[28:31], a[220:223], v[44:47]
s_cbranch_scc1 L_att_deven1
L_att_ddone:
s_cmp_ge_u32 s4, 2
s_cbranch_scc1 L_att_dl0_1
L_att_dl0_0:
v_mfma_f32_16x16x32_bf16 v[128:131], a[32:35], v[48:51], v[128:131]
ds_read_b128 a[0:3], v1 offset:8192
v_cvt_pk_bf16_f32 v72, v24, v25
v_mfma_f32_16x16x32_bf16 v[160:163], a[32:35], v[52:55], v[160:163]
v_exp_f32 v28, v28
v_mfma_f32_16x16x32_bf16 v[192:195], a[32:35], v[56:59], v[192:195]
v_cvt_pk_bf16_f32 v73, v26, v27
v_mfma_f32_16x16x32_bf16 v[224:227], a[32:35], v[60:63], v[224:227]
ds_read_b128 a[4:7], v1 offset:9216
v_mfma_f32_16x16x32_bf16 v[228:231], a[36:39], v[60:63], v[228:231]
s_add_u32 m0, s27, 0x0
v_exp_f32 v29, v29
v_mfma_f32_16x16x32_bf16 v[196:199], a[36:39], v[56:59], v[196:199]
buffer_load_dwordx4 v3, s[48:51], s32 offen offset:0 sc1 lds
v_mfma_f32_16x16x32_bf16 v[164:167], a[36:39], v[52:55], v[164:167]
v_exp_f32 v30, v30
v_mfma_f32_16x16x32_bf16 v[132:135], a[36:39], v[48:51], v[132:135]
ds_read_b128 a[8:11], v1 offset:10240
v_cvt_pk_bf16_f32 v76, v28, v29
v_mfma_f32_16x16x32_bf16 v[136:139], a[40:43], v[48:51], v[136:139]
v_mfma_f32_16x16x32_bf16 v[168:171], a[40:43], v[52:55], v[168:171]
v_exp_f32 v31, v31
v_mfma_f32_16x16x32_bf16 v[200:203], a[40:43], v[56:59], v[200:203]
v_exp_f32 v32, v32
v_mfma_f32_16x16x32_bf16 v[232:235], a[40:43], v[60:63], v[232:235]
ds_read_b128 a[12:15], v1 offset:11264
v_cvt_pk_bf16_f32 v77, v30, v31
v_mfma_f32_16x16x32_bf16 v[236:239], a[44:47], v[60:63], v[236:239]
v_exp_f32 v33, v33
v_mfma_f32_16x16x32_bf16 v[204:207], a[44:47], v[56:59], v[204:207]
v_cvt_pk_bf16_f32 v66, v32, v33
v_mfma_f32_16x16x32_bf16 v[172:175], a[44:47], v[52:55], v[172:175]
s_mov_b32 s9, 0x0
v_exp_f32 v34, v34
v_mfma_f32_16x16x32_bf16 v[140:143], a[44:47], v[48:51], v[140:143]
ds_read_b128 a[16:19], v1 offset:12288
v_mfma_f32_16x16x32_bf16 v[144:147], a[48:51], v[48:51], v[144:147]
buffer_load_dword a244, v8, s[72:75], s9 offen
v_mfma_f32_16x16x32_bf16 v[176:179], a[48:51], v[52:55], v[176:179]
v_exp_f32 v35, v35
v_mfma_f32_16x16x32_bf16 v[208:211], a[48:51], v[56:59], v[208:211]
v_exp_f32 v36, v36
v_mfma_f32_16x16x32_bf16 v[240:243], a[48:51], v[60:63], v[240:243]
ds_read_b128 a[20:23], v1 offset:13312
v_cvt_pk_bf16_f32 v67, v34, v35
v_mfma_f32_16x16x32_bf16 v[244:247], a[52:55], v[60:63], v[244:247]
v_mfma_f32_16x16x32_bf16 v[212:215], a[52:55], v[56:59], v[212:215]
v_exp_f32 v37, v37
v_mfma_f32_16x16x32_bf16 v[180:183], a[52:55], v[52:55], v[180:183]
ds_read_b128 a[24:27], v1 offset:14336
v_cvt_pk_bf16_f32 v70, v36, v37
v_mfma_f32_16x16x32_bf16 v[148:151], a[52:55], v[48:51], v[148:151]
v_exp_f32 v38, v38
v_mfma_f32_16x16x32_bf16 v[152:155], a[56:59], v[48:51], v[152:155]
v_mfma_f32_16x16x32_bf16 v[184:187], a[56:59], v[52:55], v[184:187]
v_exp_f32 v39, v39
v_mfma_f32_16x16x32_bf16 v[216:219], a[56:59], v[56:59], v[216:219]
buffer_load_dwordx4 v3, s[48:51], s32 offen offset:1024 sc1 lds
v_mfma_f32_16x16x32_bf16 v[248:251], a[56:59], v[60:63], v[248:251]
ds_read_b128 a[28:31], v1 offset:15360
v_cvt_pk_bf16_f32 v71, v38, v39
v_mfma_f32_16x16x32_bf16 v[252:255], a[60:63], v[60:63], v[252:255]
v_exp_f32 v40, v40
v_mfma_f32_16x16x32_bf16 v[220:223], a[60:63], v[56:59], v[220:223]
v_exp_f32 v41, v41
v_mfma_f32_16x16x32_bf16 v[188:191], a[60:63], v[52:55], v[188:191]
ds_read_b128 a[32:35], v1 offset:0
v_cvt_pk_bf16_f32 v74, v40, v41
v_mfma_f32_16x16x32_bf16 v[156:159], a[60:63], v[48:51], v[156:159]
v_smfmac_f32_16x16x64_bf16 a[224:227], a[232:235], v[48:55], v9
v_exp_f32 v42, v42
v_smfmac_f32_16x16x64_bf16 a[228:231], a[232:235], v[56:63], v9
s_waitcnt lgkmcnt(5)
v_exp_f32 v43, v43
v_mfma_f32_16x16x32_bf16 v[16:19], a[0:3], a[160:163], v[96:99]
ds_read_b128 a[36:39], v1 offset:1024
v_cvt_pk_bf16_f32 v75, v42, v43
v_mfma_f32_16x16x32_bf16 v[16:19], a[4:7], a[164:167], v[16:19]
v_exp_f32 v44, v44
v_mfma_f32_16x16x32_bf16 v[16:19], a[8:11], a[168:171], v[16:19]
v_mfma_f32_16x16x32_bf16 v[16:19], a[12:15], a[172:175], v[16:19]
buffer_load_dwordx4 v3, s[48:51], s32 offen offset:2048 sc1 lds
v_mfma_f32_16x16x32_bf16 v[20:23], a[0:3], a[176:179], v[84:87]
ds_read_b128 a[40:43], v1 offset:2048
v_mfma_f32_16x16x32_bf16 v[20:23], a[4:7], a[180:183], v[20:23]
v_exp_f32 v45, v45
v_mfma_f32_16x16x32_bf16 v[20:23], a[8:11], a[184:187], v[20:23]
v_exp_f32 v46, v46
v_mfma_f32_16x16x32_bf16 v[20:23], a[12:15], a[188:191], v[20:23]
ds_read_b128 a[44:47], v1 offset:3072
v_cvt_pk_bf16_f32 v78, v44, v45
v_mfma_f32_16x16x32_bf16 v[24:27], a[0:3], a[192:195], v[88:91]
v_mfma_f32_16x16x32_bf16 v[24:27], a[4:7], a[196:199], v[24:27]
v_exp_f32 v47, v47
v_mfma_f32_16x16x32_bf16 v[24:27], a[8:11], a[200:203], v[24:27]
v_exp_f32 v16, v16
v_mfma_f32_16x16x32_bf16 v[24:27], a[12:15], a[204:207], v[24:27]
ds_read_b128 a[48:51], v1 offset:4096
v_cvt_pk_bf16_f32 v79, v46, v47
v_mfma_f32_16x16x32_bf16 v[28:31], a[0:3], a[208:211], v[92:95]
v_exp_f32 v17, v17
v_mfma_f32_16x16x32_bf16 v[28:31], a[4:7], a[212:215], v[28:31]
s_waitcnt lgkmcnt(5)
v_cvt_pk_bf16_f32 v48, v16, v17
v_mfma_f32_16x16x32_bf16 v[28:31], a[8:11], a[216:219], v[28:31]
buffer_load_dwordx4 v3, s[48:51], s32 offen offset:3072 sc1 lds
v_mfma_f32_16x16x32_bf16 v[28:31], a[12:15], a[220:223], v[28:31]
ds_read_b128 a[52:55], v1 offset:5120
v_mfma_f32_16x16x32_bf16 v[32:35], a[16:19], a[160:163], v[100:103]
v_exp_f32 v18, v18
v_mfma_f32_16x16x32_bf16 v[32:35], a[20:23], a[164:167], v[32:35]
v_exp_f32 v19, v19
v_mfma_f32_16x16x32_bf16 v[32:35], a[24:27], a[168:171], v[32:35]
v_exp_f32 v20, v20
v_mfma_f32_16x16x32_bf16 v[32:35], a[28:31], a[172:175], v[32:35]
ds_read_b128 a[56:59], v1 offset:6144
v_cvt_pk_bf16_f32 v49, v18, v19
v_mfma_f32_16x16x32_bf16 v[36:39], a[16:19], a[176:179], v[84:87]
v_mfma_f32_16x16x32_bf16 v[36:39], a[20:23], a[180:183], v[36:39]
v_exp_f32 v21, v21
v_mfma_f32_16x16x32_bf16 v[36:39], a[24:27], a[184:187], v[36:39]
s_mov_b32 s9, 0x0
v_exp_f32 v22, v22
v_mfma_f32_16x16x32_bf16 v[36:39], a[28:31], a[188:191], v[36:39]
ds_read_b128 a[60:63], v1 offset:7168
v_cvt_pk_bf16_f32 v52, v20, v21
v_mfma_f32_16x16x32_bf16 v[40:43], a[16:19], a[192:195], v[88:91]
buffer_load_dword a244, v8, s[64:67], s9 offen
v_mfma_f32_16x16x32_bf16 v[40:43], a[20:23], a[196:199], v[40:43]
v_mfma_f32_16x16x32_bf16 v[40:43], a[24:27], a[200:203], v[40:43]
v_exp_f32 v23, v23
v_mfma_f32_16x16x32_bf16 v[40:43], a[28:31], a[204:207], v[40:43]
v_exp_f32 v24, v24
v_mfma_f32_16x16x32_bf16 v[44:47], a[16:19], a[208:211], v[92:95]
v_exp_f32 v25, v25
v_mfma_f32_16x16x32_bf16 v[44:47], a[20:23], a[212:215], v[44:47]
v_exp_f32 v26, v26
v_mfma_f32_16x16x32_bf16 v[44:47], a[24:27], a[216:219], v[44:47]
v_exp_f32 v27, v27
v_mfma_f32_16x16x32_bf16 v[44:47], a[28:31], a[220:223], v[44:47]
s_waitcnt lgkmcnt(0)
v_cvt_pk_bf16_f32 v53, v22, v23
v_mfma_f32_16x16x32_bf16 v[128:131], a[32:35], v[64:67], v[128:131]
ds_read_b128 a[0:3], v1 offset:24576
v_cvt_pk_bf16_f32 v56, v24, v25
v_mfma_f32_16x16x32_bf16 v[160:163], a[32:35], v[68:71], v[160:163]
v_exp_f32 v28, v28
v_mfma_f32_16x16x32_bf16 v[192:195], a[32:35], v[72:75], v[192:195]
v_cvt_pk_bf16_f32 v57, v26, v27
v_mfma_f32_16x16x32_bf16 v[224:227], a[32:35], v[76:79], v[224:227]
ds_read_b128 a[4:7], v1 offset:25600
v_mfma_f32_16x16x32_bf16 v[228:231], a[36:39], v[76:79], v[228:231]
s_add_u32 m0, s27, 0x1000
v_exp_f32 v29, v29
v_mfma_f32_16x16x32_bf16 v[196:199], a[36:39], v[72:75], v[196:199]
buffer_load_dwordx4 v3, s[48:51], s7 offen offset:0 sc1 lds
v_mfma_f32_16x16x32_bf16 v[164:167], a[36:39], v[68:71], v[164:167]
ds_read_b128 a[8:11], v1 offset:26624
v_cvt_pk_bf16_f32 v60, v28, v29
v_mfma_f32_16x16x32_bf16 v[132:135], a[36:39], v[64:67], v[132:135]
v_exp_f32 v30, v30
v_mfma_f32_16x16x32_bf16 v[136:139], a[40:43], v[64:67], v[136:139]
v_exp_f32 v31, v31
v_mfma_f32_16x16x32_bf16 v[168:171], a[40:43], v[68:71], v[168:171]
ds_read_b128 a[12:15], v1 offset:27648
v_cvt_pk_bf16_f32 v61, v30, v31
v_mfma_f32_16x16x32_bf16 v[200:203], a[40:43], v[72:75], v[200:203]
v_mfma_f32_16x16x32_bf16 v[232:235], a[40:43], v[76:79], v[232:235]
v_exp_f32 v32, v32
v_mfma_f32_16x16x32_bf16 v[236:239], a[44:47], v[76:79], v[236:239]
v_exp_f32 v33, v33
v_mfma_f32_16x16x32_bf16 v[204:207], a[44:47], v[72:75], v[204:207]
ds_read_b128 a[16:19], v1 offset:28672
v_cvt_pk_bf16_f32 v50, v32, v33
v_mfma_f32_16x16x32_bf16 v[172:175], a[44:47], v[68:71], v[172:175]
v_exp_f32 v34, v34
v_mfma_f32_16x16x32_bf16 v[140:143], a[44:47], v[64:67], v[140:143]
buffer_load_dwordx4 v3, s[48:51], s7 offen offset:1024 sc1 lds
v_mfma_f32_16x16x32_bf16 v[144:147], a[48:51], v[64:67], v[144:147]
ds_read_b128 a[20:23], v1 offset:29696
v_mfma_f32_16x16x32_bf16 v[176:179], a[48:51], v[68:71], v[176:179]
v_mfma_f32_16x16x32_bf16 v[208:211], a[48:51], v[72:75], v[208:211]
v_exp_f32 v35, v35
v_mfma_f32_16x16x32_bf16 v[240:243], a[48:51], v[76:79], v[240:243]
ds_read_b128 a[24:27], v1 offset:30720
v_cvt_pk_bf16_f32 v51, v34, v35
v_mfma_f32_16x16x32_bf16 v[244:247], a[52:55], v[76:79], v[244:247]
v_exp_f32 v36, v36
v_mfma_f32_16x16x32_bf16 v[212:215], a[52:55], v[72:75], v[212:215]
v_exp_f32 v37, v37
v_mfma_f32_16x16x32_bf16 v[180:183], a[52:55], v[68:71], v[180:183]
ds_read_b128 a[28:31], v1 offset:31744
v_cvt_pk_bf16_f32 v54, v36, v37
v_mfma_f32_16x16x32_bf16 v[148:151], a[52:55], v[64:67], v[148:151]
v_mfma_f32_16x16x32_bf16 v[152:155], a[56:59], v[64:67], v[152:155]
v_exp_f32 v38, v38
v_mfma_f32_16x16x32_bf16 v[184:187], a[56:59], v[68:71], v[184:187]
v_exp_f32 v39, v39
v_mfma_f32_16x16x32_bf16 v[216:219], a[56:59], v[72:75], v[216:219]
buffer_load_dwordx4 v3, s[48:51], s7 offen offset:2048 sc1 lds
v_mfma_f32_16x16x32_bf16 v[248:251], a[56:59], v[76:79], v[248:251]
ds_read_b128 a[32:35], v1 offset:16384
v_cvt_pk_bf16_f32 v55, v38, v39
v_mfma_f32_16x16x32_bf16 v[252:255], a[60:63], v[76:79], v[252:255]
v_exp_f32 v40, v40
v_mfma_f32_16x16x32_bf16 v[220:223], a[60:63], v[72:75], v[220:223]
ds_read_b128 a[36:39], v1 offset:17408
v_mfma_f32_16x16x32_bf16 v[188:191], a[60:63], v[68:71], v[188:191]
v_mfma_f32_16x16x32_bf16 v[156:159], a[60:63], v[64:67], v[156:159]
v_exp_f32 v41, v41
v_smfmac_f32_16x16x64_bf16 a[224:227], a[232:235], v[64:71], v9
ds_read_b128 a[40:43], v1 offset:18432
v_cvt_pk_bf16_f32 v58, v40, v41
v_smfmac_f32_16x16x64_bf16 a[228:231], a[232:235], v[72:79], v9
s_waitcnt lgkmcnt(7)
v_exp_f32 v42, v42
v_mfma_f32_16x16x32_bf16 v[20:23], a[0:3], a[176:179], v[84:87]
s_mov_b32 s9, 0x400000
v_exp_f32 v43, v43
v_mfma_f32_16x16x32_bf16 v[20:23], a[4:7], a[180:183], v[20:23]
ds_read_b128 a[44:47], v1 offset:19456
v_cvt_pk_bf16_f32 v59, v42, v43
v_mfma_f32_16x16x32_bf16 v[20:23], a[8:11], a[184:187], v[20:23]
buffer_load_dword a244, v8, s[64:67], s9 offen
v_mfma_f32_16x16x32_bf16 v[20:23], a[12:15], a[188:191], v[20:23]
v_mfma_f32_16x16x32_bf16 v[24:27], a[0:3], a[192:195], v[88:91]
v_exp_f32 v44, v44
v_mfma_f32_16x16x32_bf16 v[24:27], a[4:7], a[196:199], v[24:27]
ds_read_b128 a[48:51], v1 offset:20480
v_mfma_f32_16x16x32_bf16 v[24:27], a[8:11], a[200:203], v[24:27]
v_exp_f32 v45, v45
v_mfma_f32_16x16x32_bf16 v[24:27], a[12:15], a[204:207], v[24:27]
v_exp_f32 v46, v46
v_mfma_f32_16x16x32_bf16 v[28:31], a[0:3], a[208:211], v[92:95]
ds_read_b128 a[52:55], v1 offset:21504
v_cvt_pk_bf16_f32 v62, v44, v45
v_mfma_f32_16x16x32_bf16 v[28:31], a[4:7], a[212:215], v[28:31]
v_mfma_f32_16x16x32_bf16 v[28:31], a[8:11], a[216:219], v[28:31]
s_waitcnt lgkmcnt(6)
v_exp_f32 v47, v47
v_mfma_f32_16x16x32_bf16 v[28:31], a[12:15], a[220:223], v[28:31]
ds_read_b128 a[56:59], v1 offset:22528
v_cvt_pk_bf16_f32 v63, v46, v47
v_mfma_f32_16x16x32_bf16 v[36:39], a[16:19], a[176:179], v[84:87]
buffer_load_dwordx4 v3, s[48:51], s7 offen offset:3072 sc1 lds
v_mfma_f32_16x16x32_bf16 v[36:39], a[20:23], a[180:183], v[36:39]
s_add_u32 s32, s32, 0x8000
v_exp_f32 v20, v20
v_mfma_f32_16x16x32_bf16 v[36:39], a[24:27], a[184:187], v[36:39]
ds_read_b128 a[60:63], v1 offset:23552
v_xor_b32 v1, 0x8000, v1
v_mfma_f32_16x16x32_bf16 v[36:39], a[28:31], a[188:191], v[36:39]
s_add_u32 s7, s7, 0x8000
v_exp_f32 v21, v21
v_mfma_f32_16x16x32_bf16 v[40:43], a[16:19], a[192:195], v[88:91]
s_xor_b32 s27, s27, 0x38000
v_cvt_pk_bf16_f32 v68, v20, v21
v_mfma_f32_16x16x32_bf16 v[40:43], a[20:23], a[196:199], v[40:43]
v_exp_f32 v22, v22
v_mfma_f32_16x16x32_bf16 v[40:43], a[24:27], a[200:203], v[40:43]
v_exp_f32 v23, v23
v_mfma_f32_16x16x32_bf16 v[40:43], a[28:31], a[204:207], v[40:43]
v_exp_f32 v24, v24
v_mfma_f32_16x16x32_bf16 v[44:47], a[16:19], a[208:211], v[92:95]
v_exp_f32 v25, v25
v_mfma_f32_16x16x32_bf16 v[44:47], a[20:23], a[212:215], v[44:47]
v_exp_f32 v26, v26
v_mfma_f32_16x16x32_bf16 v[44:47], a[24:27], a[216:219], v[44:47]
s_waitcnt vmcnt(19) lgkmcnt(0)
v_exp_f32 v27, v27
v_mfma_f32_16x16x32_bf16 v[44:47], a[28:31], a[220:223], v[44:47]
s_barrier
v_cvt_pk_bf16_f32 v69, v22, v23
L_att_l1_0:
v_mfma_f32_16x16x32_bf16 v[128:131], a[32:35], v[48:51], v[128:131]
ds_read_b128 a[0:3], v2 offset:8192
v_cvt_pk_bf16_f32 v72, v24, v25
v_mfma_f32_16x16x32_bf16 v[160:163], a[32:35], v[52:55], v[160:163]
s_lshr_b32 s44, s2, 6
v_exp_f32 v28, v28
v_mfma_f32_16x16x32_bf16 v[192:195], a[32:35], v[56:59], v[192:195]
s_add_u32 m0, s19, 0x0
s_lshl_b32 s45, s44, 1
v_cvt_pk_bf16_f32 v73, v26, v27
v_mfma_f32_16x16x32_bf16 v[224:227], a[32:35], v[60:63], v[224:227]
ds_read_b128 a[4:7], v2 offset:9216
s_add_u32 s45, s45, s100
v_mfma_f32_16x16x32_bf16 v[228:231], a[36:39], v[60:63], v[228:231]
buffer_load_dwordx4 v3, s[48:51], s32 offen offset:0 sc1 lds
v_mfma_f32_16x16x32_bf16 v[196:199], a[36:39], v[56:59], v[196:199]
s_and_b32 s60, s45, 3
v_exp_f32 v29, v29
v_mfma_f32_16x16x32_bf16 v[164:167], a[36:39], v[52:55], v[164:167]
ds_read_b128 a[8:11], v2 offset:10240
v_cvt_pk_bf16_f32 v76, v28, v29
v_mfma_f32_16x16x32_bf16 v[132:135], a[36:39], v[48:51], v[132:135]
s_sub_u32 s60, s60, s44
v_exp_f32 v30, v30
v_mfma_f32_16x16x32_bf16 v[136:139], a[40:43], v[48:51], v[136:139]
s_lshl_b32 s60, s60, 14
s_and_b32 s60, s60, 0x7c000
s_lshl_b32 s61, s60, 3
v_mfma_f32_16x16x32_bf16 v[168:171], a[40:43], v[52:55], v[168:171]
ds_read_b128 a[12:15], v2 offset:11264
s_add_u32 s62, s61, s12
v_mfma_f32_16x16x32_bf16 v[200:203], a[40:43], v[56:59], v[200:203]
s_mul_i32 s44, s44, -8
v_exp_f32 v31, v31
v_mfma_f32_16x16x32_bf16 v[232:235], a[40:43], v[60:63], v[232:235]
s_lshl_b32 s44, 4, s44
v_exp_f32 v36, v36
v_mfma_f32_16x16x32_bf16 v[236:239], a[44:47], v[60:63], v[236:239]
s_mov_b32 s9, 0x200000
s_mul_i32 s45, s45, -8
v_cvt_pk_bf16_f32 v77, v30, v31
v_mfma_f32_16x16x32_bf16 v[204:207], a[44:47], v[56:59], v[204:207]
ds_read_b128 a[16:19], v2 offset:12288
s_lshl_b32 s45, 4, s45
v_mfma_f32_16x16x32_bf16 v[172:175], a[44:47], v[52:55], v[172:175]
buffer_load_dword a244, v8, s[64:67], s9 offen
v_mfma_f32_16x16x32_bf16 v[140:143], a[44:47], v[48:51], v[140:143]
s_add_u32 s44, s44, 0x21212121
v_exp_f32 v37, v37
v_mfma_f32_16x16x32_bf16 v[144:147], a[48:51], v[48:51], v[144:147]
ds_read_b128 a[20:23], v2 offset:13312
v_cvt_pk_bf16_f32 v70, v36, v37
v_mfma_f32_16x16x32_bf16 v[176:179], a[48:51], v[52:55], v[176:179]
s_sub_u32 s44, s44, s45
v_exp_f32 v38, v38
v_mfma_f32_16x16x32_bf16 v[208:211], a[48:51], v[56:59], v[208:211]
s_bfe_u32 s56, s44, 0x80000
s_lshl_b32 s56, s56, 14
s_bfe_u32 s57, s44, 0x80008
v_mfma_f32_16x16x32_bf16 v[240:243], a[48:51], v[60:63], v[240:243]
ds_read_b128 a[24:27], v2 offset:14336
s_lshl_b32 s57, s57, 14
v_mfma_f32_16x16x32_bf16 v[244:247], a[52:55], v[60:63], v[244:247]
s_bfe_u32 s58, s44, 0x80010
v_exp_f32 v39, v39
v_mfma_f32_16x16x32_bf16 v[212:215], a[52:55], v[56:59], v[212:215]
s_lshl_b32 s58, s58, 14
v_exp_f32 v40, v40
v_mfma_f32_16x16x32_bf16 v[180:183], a[52:55], v[52:55], v[180:183]
s_bfe_u32 s59, s44, 0x80018
s_lshl_b32 s59, s59, 14
v_cvt_pk_bf16_f32 v71, v38, v39
v_mfma_f32_16x16x32_bf16 v[148:151], a[52:55], v[48:51], v[148:151]
buffer_load_dwordx4 v3, s[48:51], s32 offen offset:1024 sc1 lds
v_mfma_f32_16x16x32_bf16 v[152:155], a[56:59], v[48:51], v[152:155]
ds_read_b128 a[28:31], v2 offset:15360
v_mfma_f32_16x16x32_bf16 v[184:187], a[56:59], v[52:55], v[184:187]
v_exp_f32 v41, v41
v_mfma_f32_16x16x32_bf16 v[216:219], a[56:59], v[56:59], v[216:219]
ds_read_b128 a[32:35], v2 offset:0
v_cvt_pk_bf16_f32 v74, v40, v41
v_mfma_f32_16x16x32_bf16 v[248:251], a[56:59], v[60:63], v[248:251]
v_exp_f32 v42, v42
v_mfma_f32_16x16x32_bf16 v[252:255], a[60:63], v[60:63], v[252:255]
v_mfma_f32_16x16x32_bf16 v[220:223], a[60:63], v[56:59], v[220:223]
ds_read_b128 a[36:39], v2 offset:1024
v_mfma_f32_16x16x32_bf16 v[188:191], a[60:63], v[52:55], v[188:191]
v_exp_f32 v43, v43
v_mfma_f32_16x16x32_bf16 v[156:159], a[60:63], v[48:51], v[156:159]
s_waitcnt lgkmcnt(6)
v_exp_f32 v44, v44
v_smfmac_f32_16x16x64_bf16 a[224:227], a[232:235], v[48:55], v9
buffer_load_dwordx4 v3, s[48:51], s32 offen offset:2048 sc1 lds
v_smfmac_f32_16x16x64_bf16 a[228:231], a[232:235], v[56:63], v9
ds_read_b128 a[40:43], v2 offset:2048
v_cvt_pk_bf16_f32 v75, v42, v43
v_mfma_f32_16x16x32_bf16 v[20:23], a[0:3], a[176:179], v[84:87]
v_mfma_f32_16x16x32_bf16 v[20:23], a[4:7], a[180:183], v[20:23]
v_exp_f32 v45, v45
v_mfma_f32_16x16x32_bf16 v[20:23], a[8:11], a[184:187], v[20:23]
ds_read_b128 a[44:47], v2 offset:3072
v_cvt_pk_bf16_f32 v78, v44, v45
v_mfma_f32_16x16x32_bf16 v[20:23], a[12:15], a[188:191], v[20:23]
v_exp_f32 v46, v46
v_mfma_f32_16x16x32_bf16 v[24:27], a[0:3], a[192:195], v[88:91]
v_mfma_f32_16x16x32_bf16 v[24:27], a[4:7], a[196:199], v[24:27]
ds_read_b128 a[48:51], v2 offset:4096
v_mfma_f32_16x16x32_bf16 v[24:27], a[8:11], a[200:203], v[24:27]
v_exp_f32 v47, v47
v_mfma_f32_16x16x32_bf16 v[24:27], a[12:15], a[204:207], v[24:27]
s_nop 0
v_exp_f32 v20, v20
v_mfma_f32_16x16x32_bf16 v[28:31], a[0:3], a[208:211], v[92:95]
buffer_load_dwordx4 v3, s[48:51], s32 offen offset:3072 sc1 lds
v_mfma_f32_16x16x32_bf16 v[28:31], a[4:7], a[212:215], v[28:31]
ds_read_b128 a[52:55], v2 offset:5120
v_cvt_pk_bf16_f32 v79, v46, v47
v_mfma_f32_16x16x32_bf16 v[28:31], a[8:11], a[216:219], v[28:31]
v_mfma_f32_16x16x32_bf16 v[28:31], a[12:15], a[220:223], v[28:31]
s_waitcnt lgkmcnt(6)
v_exp_f32 v21, v21
v_mfma_f32_16x16x32_bf16 v[36:39], a[16:19], a[176:179], v[84:87]
ds_read_b128 a[56:59], v2 offset:6144
v_cvt_pk_bf16_f32 v52, v20, v21
v_mfma_f32_16x16x32_bf16 v[36:39], a[20:23], a[180:183], v[36:39]
v_exp_f32 v22, v22
v_mfma_f32_16x16x32_bf16 v[36:39], a[24:27], a[184:187], v[36:39]
v_mfma_f32_16x16x32_bf16 v[36:39], a[28:31], a[188:191], v[36:39]
ds_read_b128 a[60:63], v2 offset:7168
v_mfma_f32_16x16x32_bf16 v[40:43], a[16:19], a[192:195], v[88:91]
s_mov_b32 s9, 0x600000
v_exp_f32 v23, v23
v_mfma_f32_16x16x32_bf16 v[40:43], a[20:23], a[196:199], v[40:43]
buffer_load_dword a244, v8, s[64:67], s9 offen
v_mfma_f32_16x16x32_bf16 v[40:43], a[24:27], a[200:203], v[40:43]
v_exp_f32 v24, v24
v_mfma_f32_16x16x32_bf16 v[40:43], a[28:31], a[204:207], v[40:43]
v_cvt_pk_bf16_f32 v53, v22, v23
v_mfma_f32_16x16x32_bf16 v[44:47], a[16:19], a[208:211], v[92:95]
v_exp_f32 v25, v25
v_mfma_f32_16x16x32_bf16 v[44:47], a[20:23], a[212:215], v[44:47]
v_exp_f32 v26, v26
v_mfma_f32_16x16x32_bf16 v[44:47], a[24:27], a[216:219], v[44:47]
v_exp_f32 v27, v27
v_mfma_f32_16x16x32_bf16 v[44:47], a[28:31], a[220:223], v[44:47]
s_waitcnt lgkmcnt(0)
v_mfma_f32_16x16x32_bf16 v[160:163], a[32:35], v[68:71], v[160:163]
ds_read_b128 a[0:3], v2 offset:24576
v_cvt_pk_bf16_f32 v56, v24, v25
v_mfma_f32_16x16x32_bf16 v[192:195], a[32:35], v[72:75], v[192:195]
v_exp_f32 v28, v28
v_mfma_f32_16x16x32_bf16 v[224:227], a[32:35], v[76:79], v[224:227]
ds_read_b128 a[4:7], v2 offset:25600
v_cvt_pk_bf16_f32 v57, v26, v27
v_mfma_f32_16x16x32_bf16 v[228:231], a[36:39], v[76:79], v[228:231]
s_add_u32 m0, s19, 0x1000
v_mfma_f32_16x16x32_bf16 v[196:199], a[36:39], v[72:75], v[196:199]
buffer_load_dwordx4 v3, s[48:51], s7 offen offset:0 sc1 lds
v_mfma_f32_16x16x32_bf16 v[164:167], a[36:39], v[68:71], v[164:167]
ds_read_b128 a[8:11], v2 offset:26624
v_mfma_f32_16x16x32_bf16 v[168:171], a[40:43], v[68:71], v[168:171]
v_exp_f32 v29, v29
v_mfma_f32_16x16x32_bf16 v[200:203], a[40:43], v[72:75], v[200:203]
v_exp_f32 v30, v30
v_mfma_f32_16x16x32_bf16 v[232:235], a[40:43], v[76:79], v[232:235]
ds_read_b128 a[12:15], v2 offset:27648
v_cvt_pk_bf16_f32 v60, v28, v29
v_mfma_f32_16x16x32_bf16 v[236:239], a[44:47], v[76:79], v[236:239]
v_exp_f32 v31, v31
v_mfma_f32_16x16x32_bf16 v[204:207], a[44:47], v[72:75], v[204:207]
v_exp_f32 v36, v36
v_mfma_f32_16x16x32_bf16 v[172:175], a[44:47], v[68:71], v[172:175]
ds_read_b128 a[16:19], v2 offset:28672
v_cvt_pk_bf16_f32 v61, v30, v31
v_mfma_f32_16x16x32_bf16 v[176:179], a[48:51], v[68:71], v[176:179]
buffer_load_dwordx4 v3, s[48:51], s7 offen offset:1024 sc1 lds
v_mfma_f32_16x16x32_bf16 v[208:211], a[48:51], v[72:75], v[208:211]
ds_read_b128 a[20:23], v2 offset:29696
v_mfma_f32_16x16x32_bf16 v[240:243], a[48:51], v[76:79], v[240:243]
v_mfma_f32_16x16x32_bf16 v[244:247], a[52:55], v[76:79], v[244:247]
v_exp_f32 v37, v37
v_mfma_f32_16x16x32_bf16 v[212:215], a[52:55], v[72:75], v[212:215]
ds_read_b128 a[24:27], v2 offset:30720
v_cvt_pk_bf16_f32 v54, v36, v37
v_mfma_f32_16x16x32_bf16 v[180:183], a[52:55], v[68:71], v[180:183]
v_exp_f32 v38, v38
v_mfma_f32_16x16x32_bf16 v[184:187], a[56:59], v[68:71], v[184:187]
v_exp_f32 v39, v39
v_mfma_f32_16x16x32_bf16 v[216:219], a[56:59], v[72:75], v[216:219]
ds_read_b128 a[28:31], v2 offset:31744
v_cvt_pk_bf16_f32 v55, v38, v39
v_mfma_f32_16x16x32_bf16 v[248:251], a[56:59], v[76:79], v[248:251]
v_exp_f32 v40, v40
v_mfma_f32_16x16x32_bf16 v[252:255], a[60:63], v[76:79], v[252:255]
buffer_load_dwordx4 v3, s[48:51], s7 offen offset:2048 sc1 lds
v_mfma_f32_16x16x32_bf16 v[220:223], a[60:63], v[72:75], v[220:223]
ds_read_b128 a[32:35], v2 offset:16384
v_mfma_f32_16x16x32_bf16 v[188:191], a[60:63], v[68:71], v[188:191]
v_exp_f32 v41, v41
v_mfma_f32_16x16x32_bf16 a[224:227], a[236:239], v[68:71], a[224:227]
ds_read_b128 a[36:39], v2 offset:17408
v_cvt_pk_bf16_f32 v58, v40, v41
v_smfmac_f32_16x16x64_bf16 a[228:231], a[232:235], v[72:79], v9
s_waitcnt lgkmcnt(6)
v_exp_f32 v42, v42
v_mfma_f32_16x16x32_bf16 v[20:23], a[0:3], a[176:179], v[104:107]
v_exp_f32 v43, v43
v_mfma_f32_16x16x32_bf16 v[20:23], a[4:7], a[180:183], v[20:23]
ds_read_b128 a[40:43], v2 offset:18432
v_cvt_pk_bf16_f32 v59, v42, v43
v_mfma_f32_16x16x32_bf16 v[20:23], a[8:11], a[184:187], v[20:23]
v_exp_f32 v44, v44
v_mfma_f32_16x16x32_bf16 v[20:23], a[12:15], a[188:191], v[20:23]
buffer_load_dwordx4 v3, s[48:51], s7 offen offset:3072 sc1 lds
v_mfma_f32_16x16x32_bf16 v[24:27], a[0:3], a[192:195], v[88:91]
ds_read_b128 a[44:47], v2 offset:19456
v_mfma_f32_16x16x32_bf16 v[24:27], a[4:7], a[196:199], v[24:27]
v_exp_f32 v45, v45
v_mfma_f32_16x16x32_bf16 v[24:27], a[8:11], a[200:203], v[24:27]
v_exp_f32 v46, v46
v_mfma_f32_16x16x32_bf16 v[24:27], a[12:15], a[204:207], v[24:27]
ds_read_b128 a[48:51], v2 offset:20480
v_add_u32 v4, s0, v3
v_mfma_f32_16x16x32_bf16 v[28:31], a[0:3], a[208:211], v[92:95]
v_cvt_pk_bf16_f32 v62, v44, v45
v_mfma_f32_16x16x32_bf16 v[28:31], a[4:7], a[212:215], v[28:31]
ds_read_b128 a[52:55], v2 offset:21504
v_mov_b32 v5, s1
v_mfma_f32_16x16x32_bf16 v[28:31], a[8:11], a[216:219], v[28:31]
s_waitcnt lgkmcnt(6)
v_exp_f32 v47, v47
v_mfma_f32_16x16x32_bf16 v[28:31], a[12:15], a[220:223], v[28:31]
global_load_dword a244, v[4:5], off sc1
v_mfma_f32_16x16x32_bf16 v[36:39], a[16:19], a[176:179], v[108:111]
ds_read_b128 a[56:59], v2 offset:22528
v_cvt_pk_bf16_f32 v63, v46, v47
v_mfma_f32_16x16x32_bf16 v[36:39], a[20:23], a[180:183], v[36:39]
s_add_u32 s32, s32, 0x8000
v_exp_f32 v20, v20
v_mfma_f32_16x16x32_bf16 v[36:39], a[24:27], a[184:187], v[36:39]
s_add_u32 s7, s7, 0x8000
v_exp_f32 v21, v21
v_mfma_f32_16x16x32_bf16 v[36:39], a[28:31], a[188:191], v[36:39]
ds_read_b128 a[60:63], v2 offset:23552
v_xor_b32 v2, 0x38000, v2
v_mfma_f32_16x16x32_bf16 v[40:43], a[16:19], a[192:195], v[88:91]
s_xor_b32 s19, s19, 0x8000
v_exp_f32 v22, v22
v_mfma_f32_16x16x32_bf16 v[40:43], a[20:23], a[196:199], v[40:43]
s_sub_u32 s15, 7, s6
v_exp_f32 v23, v23
v_mfma_f32_16x16x32_bf16 v[40:43], a[24:27], a[200:203], v[40:43]
s_lshl_b32 s15, s15, 1
v_exp_f32 v24, v24
v_mfma_f32_16x16x32_bf16 v[40:43], a[28:31], a[204:207], v[40:43]
v_exp_f32 v25, v25
v_mfma_f32_16x16x32_bf16 v[44:47], a[16:19], a[208:211], v[92:95]
v_exp_f32 v26, v26
v_mfma_f32_16x16x32_bf16 v[44:47], a[20:23], a[212:215], v[44:47]
v_exp_f32 v27, v27
v_mfma_f32_16x16x32_bf16 v[44:47], a[24:27], a[216:219], v[44:47]
s_waitcnt vmcnt(22) lgkmcnt(0)
v_cvt_pk_bf16_f32 v68, v20, v21
v_cvt_pk_bf16_f32 v69, v22, v23
v_mfma_f32_16x16x32_bf16 v[44:47], a[28:31], a[220:223], v[44:47]
s_barrier
s_cbranch_scc0 L_att_lh0_0
v_mfma_f32_16x16x32_bf16 v[160:163], a[32:35], v[52:55], v[160:163]
ds_read_b128 a[0:3], v1 offset:8192
v_cvt_pk_bf16_f32 v72, v24, v25
v_mfma_f32_16x16x32_bf16 v[192:195], a[32:35], v[56:59], v[192:195]
v_exp_f32 v28, v28
v_mfma_f32_16x16x32_bf16 v[224:227], a[32:35], v[60:63], v[224:227]
ds_read_b128 a[4:7], v1 offset:9216
v_cvt_pk_bf16_f32 v73, v26, v27
v_mfma_f32_16x16x32_bf16 v[228:231], a[36:39], v[60:63], v[228:231]
s_add_u32 m0, s27, 0x0
v_exp_f32 v29, v29
v_mfma_f32_16x16x32_bf16 v[196:199], a[36:39], v[56:59], v[196:199]
buffer_load_dwordx4 v3, s[48:51], s32 offen offset:0 sc1 lds
v_mfma_f32_16x16x32_bf16 v[164:167], a[36:39], v[52:55], v[164:167]
ds_read_b128 a[8:11], v1 offset:10240
v_cvt_pk_bf16_f32 v76, v28, v29
v_mfma_f32_16x16x32_bf16 v[168:171], a[40:43], v[52:55], v[168:171]
ds_read_b128 a[12:15], v1 offset:11264
v_accvgpr_read_b32 v6, a224
v_mfma_f32_16x16x32_bf16 v[200:203], a[40:43], v[56:59], v[200:203]
v_exp_f32 v30, v30
v_mfma_f32_16x16x32_bf16 v[232:235], a[40:43], v[60:63], v[232:235]
v_exp_f32 v31, v31
v_mfma_f32_16x16x32_bf16 v[236:239], a[44:47], v[60:63], v[236:239]
ds_read_b128 a[16:19], v1 offset:12288
v_cvt_pk_bf16_f32 v77, v30, v31
v_mfma_f32_16x16x32_bf16 v[204:207], a[44:47], v[56:59], v[204:207]
v_exp_f32 v36, v36
v_mfma_f32_16x16x32_bf16 v[172:175], a[44:47], v[52:55], v[172:175]
ds_read_b128 a[20:23], v1 offset:13312
v_accvgpr_read_b32 v7, a225
v_mfma_f32_16x16x32_bf16 v[176:179], a[48:51], v[52:55], v[176:179]
v_exp_f32 v37, v37
v_mfma_f32_16x16x32_bf16 v[208:211], a[48:51], v[56:59], v[208:211]
ds_read_b128 a[24:27], v1 offset:14336
v_cvt_pk_bf16_f32 v70, v36, v37
v_mfma_f32_16x16x32_bf16 v[240:243], a[48:51], v[60:63], v[240:243]
buffer_load_dwordx4 v3, s[48:51], s32 offen offset:1024 sc1 lds
v_mfma_f32_16x16x32_bf16 v[244:247], a[52:55], v[60:63], v[244:247]
v_exp_f32 v38, v38
v_mfma_f32_16x16x32_bf16 v[212:215], a[52:55], v[56:59], v[212:215]
ds_read_b128 a[28:31], v1 offset:15360
v_add_f32 v6, v6, v7
v_mfma_f32_16x16x32_bf16 v[180:183], a[52:55], v[52:55], v[180:183]
v_exp_f32 v39, v39
v_mfma_f32_16x16x32_bf16 v[184:187], a[56:59], v[52:55], v[184:187]
ds_read_b128 a[32:35], v1 offset:0
v_cvt_pk_bf16_f32 v71, v38, v39
v_mfma_f32_16x16x32_bf16 v[216:219], a[56:59], v[56:59], v[216:219]
v_exp_f32 v40, v40
v_mfma_f32_16x16x32_bf16 v[248:251], a[56:59], v[60:63], v[248:251]
ds_read_b128 a[36:39], v1 offset:1024
v_cmp_nge_f32 vcc, 0x5f800000, v6
v_mfma_f32_16x16x32_bf16 v[252:255], a[60:63], v[60:63], v[252:255]
v_exp_f32 v41, v41
v_mfma_f32_16x16x32_bf16 v[220:223], a[60:63], v[56:59], v[220:223]
v_exp_f32 v42, v42
v_mfma_f32_16x16x32_bf16 v[188:191], a[60:63], v[52:55], v[188:191]
ds_read_b128 a[40:43], v1 offset:2048
v_cvt_pk_bf16_f32 v74, v40, v41
v_mfma_f32_16x16x32_bf16 a[224:227], a[236:239], v[52:55], a[224:227]
buffer_load_dwordx4 v3, s[48:51], s32 offen offset:2048 sc1 lds
v_smfmac_f32_16x16x64_bf16 a[228:231], a[232:235], v[56:63], v9
ds_read_b128 a[44:47], v1 offset:3072
s_waitcnt lgkmcnt(8)
v_mfma_f32_16x16x32_bf16 v[24:27], a[0:3], a[192:195], v[88:91]
v_exp_f32 v43, v43
v_mfma_f32_16x16x32_bf16 v[24:27], a[4:7], a[196:199], v[24:27]
ds_read_b128 a[48:51], v1 offset:4096
v_cvt_pk_bf16_f32 v75, v42, v43
v_mfma_f32_16x16x32_bf16 v[24:27], a[8:11], a[200:203], v[24:27]
v_exp_f32 v44, v44
v_mfma_f32_16x16x32_bf16 v[24:27], a[12:15], a[204:207], v[24:27]
v_exp_f32 v45, v45
v_mfma_f32_16x16x32_bf16 v[28:31], a[0:3], a[208:211], v[92:95]
ds_read_b128 a[52:55], v1 offset:5120
v_cvt_pk_bf16_f32 v78, v44, v45
v_mfma_f32_16x16x32_bf16 v[28:31], a[4:7], a[212:215], v[28:31]
v_exp_f32 v46, v46
v_mfma_f32_16x16x32_bf16 v[28:31], a[8:11], a[216:219], v[28:31]
ds_read_b128 a[56:59], v1 offset:6144
v_mfma_f32_16x16x32_bf16 v[28:31], a[12:15], a[220:223], v[28:31]
s_waitcnt lgkmcnt(7)
v_exp_f32 v47, v47
v_mfma_f32_16x16x32_bf16 v[40:43], a[16:19], a[192:195], v[88:91]
buffer_load_dwordx4 v3, s[48:51], s32 offen offset:3072 sc1 lds
v_mfma_f32_16x16x32_bf16 v[40:43], a[20:23], a[196:199], v[40:43]
ds_read_b128 a[60:63], v1 offset:7168
v_cvt_pk_bf16_f32 v79, v46, v47
v_mfma_f32_16x16x32_bf16 v[40:43], a[24:27], a[200:203], v[40:43]
s_add_u32 s32, s32, 0x8000
v_exp_f32 v24, v24
v_mfma_f32_16x16x32_bf16 v[40:43], a[28:31], a[204:207], v[40:43]
v_exp_f32 v25, v25
v_mfma_f32_16x16x32_bf16 v[44:47], a[16:19], a[208:211], v[92:95]
v_exp_f32 v26, v26
v_mfma_f32_16x16x32_bf16 v[44:47], a[20:23], a[212:215], v[44:47]
v_exp_f32 v27, v27
v_mfma_f32_16x16x32_bf16 v[44:47], a[24:27], a[216:219], v[44:47]
v_exp_f32 v28, v28
v_mfma_f32_16x16x32_bf16 v[44:47], a[28:31], a[220:223], v[44:47]
s_waitcnt lgkmcnt(0)
v_exp_f32 v29, v29
v_mfma_f32_16x16x32_bf16 v[160:163], a[32:35], v[68:71], v[160:163]
ds_read_b128 a[0:3], v1 offset:24576
v_cvt_pk_bf16_f32 v56, v24, v25
v_mfma_f32_16x16x32_bf16 v[192:195], a[32:35], v[72:75], v[192:195]
v_exp_f32 v30, v30
v_mfma_f32_16x16x32_bf16 v[224:227], a[32:35], v[76:79], v[224:227]
ds_read_b128 a[4:7], v1 offset:25600
v_cvt_pk_bf16_f32 v57, v26, v27
v_mfma_f32_16x16x32_bf16 v[228:231], a[36:39], v[76:79], v[228:231]
s_add_u32 m0, s27, 0x1000
v_cvt_pk_bf16_f32 v60, v28, v29
v_mfma_f32_16x16x32_bf16 v[196:199], a[36:39], v[72:75], v[196:199]
buffer_load_dwordx4 v3, s[48:51], s7 offen offset:0 sc1 lds
v_mfma_f32_16x16x32_bf16 v[164:167], a[36:39], v[68:71], v[164:167]
ds_read_b128 a[8:11], v1 offset:26624
v_mfma_f32_16x16x32_bf16 v[168:171], a[40:43], v[68:71], v[168:171]
ds_read_b128 a[12:15], v1 offset:27648
v_mfma_f32_16x16x32_bf16 v[200:203], a[40:43], v[72:75], v[200:203]
v_exp_f32 v31, v31
v_mfma_f32_16x16x32_bf16 v[232:235], a[40:43], v[76:79], v[232:235]
v_exp_f32 v40, v40
v_mfma_f32_16x16x32_bf16 v[236:239], a[44:47], v[76:79], v[236:239]
ds_read_b128 a[16:19], v1 offset:28672
v_cvt_pk_bf16_f32 v61, v30, v31
v_mfma_f32_16x16x32_bf16 v[204:207], a[44:47], v[72:75], v[204:207]
v_exp_f32 v41, v41
v_mfma_f32_16x16x32_bf16 v[172:175], a[44:47], v[68:71], v[172:175]
ds_read_b128 a[20:23], v1 offset:29696
v_cvt_pk_bf16_f32 v58, v40, v41
v_mfma_f32_16x16x32_bf16 v[176:179], a[48:51], v[68:71], v[176:179]
v_rcp_f32 v6, v6
v_mfma_f32_16x16x32_bf16 v[208:211], a[48:51], v[72:75], v[208:211]
buffer_load_dwordx4 v3, s[48:51], s7 offen offset:1024 sc1 lds
v_mfma_f32_16x16x32_bf16 v[240:243], a[48:51], v[76:79], v[240:243]
ds_read_b128 a[24:27], v1 offset:30720
s_or_b64 s[34:35], s[34:35], vcc
v_mfma_f32_16x16x32_bf16 v[244:247], a[52:55], v[76:79], v[244:247]
ds_read_b128 a[28:31], v1 offset:31744
s_add_u32 s8, s28, 0x0
v_mfma_f32_16x16x32_bf16 v[212:215], a[52:55], v[72:75], v[212:215]
v_exp_f32 v42, v42
v_mfma_f32_16x16x32_bf16 v[180:183], a[52:55], v[68:71], v[180:183]
v_exp_f32 v43, v43
v_mfma_f32_16x16x32_bf16 v[184:187], a[56:59], v[68:71], v[184:187]
ds_read_b128 a[32:35], v1 offset:16384
v_cvt_pk_bf16_f32 v59, v42, v43
v_mfma_f32_16x16x32_bf16 v[216:219], a[56:59], v[72:75], v[216:219]
v_exp_f32 v44, v44
v_mfma_f32_16x16x32_bf16 v[248:251], a[56:59], v[76:79], v[248:251]
ds_read_b128 a[36:39], v1 offset:17408
v_mul_f32 v128, v6, v128
v_mfma_f32_16x16x32_bf16 v[252:255], a[60:63], v[76:79], v[252:255]
v_mul_f32 v129, v6, v129
v_mul_f32 v130, v6, v130
v_mfma_f32_16x16x32_bf16 v[220:223], a[60:63], v[72:75], v[220:223]
ds_read_b128 a[40:43], v1 offset:18432
v_mul_f32 v131, v6, v131
v_mfma_f32_16x16x32_bf16 v[188:191], a[60:63], v[68:71], v[188:191]
buffer_load_dwordx4 v3, s[48:51], s7 offen offset:2048 sc1 lds
v_mfma_f32_16x16x32_bf16 a[224:227], a[236:239], v[68:71], a[224:227]
ds_read_b128 a[44:47], v1 offset:19456
v_mul_f32 v132, v6, v132
v_smfmac_f32_16x16x64_bf16 a[228:231], a[232:235], v[72:79], v9
s_waitcnt lgkmcnt(8)
v_exp_f32 v45, v45
v_mfma_f32_16x16x32_bf16 v[24:27], a[0:3], a[192:195], v[88:91]
v_exp_f32 v46, v46
v_mfma_f32_16x16x32_bf16 v[24:27], a[4:7], a[196:199], v[24:27]
ds_read_b128 a[48:51], v1 offset:20480
v_cvt_pk_bf16_f32 v62, v44, v45
v_mfma_f32_16x16x32_bf16 v[24:27], a[8:11], a[200:203], v[24:27]
v_exp_f32 v47, v47
v_mfma_f32_16x16x32_bf16 v[24:27], a[12:15], a[204:207], v[24:27]
ds_read_b128 a[52:55], v1 offset:21504
v_cvt_pk_bf16_f32 v63, v46, v47
v_mfma_f32_16x16x32_bf16 v[28:31], a[0:3], a[208:211], v[92:95]
v_mul_f32 v133, v6, v133
v_mul_f32 v134, v6, v134
v_mfma_f32_16x16x32_bf16 v[28:31], a[4:7], a[212:215], v[28:31]
ds_read_b128 a[56:59], v1 offset:22528
v_mul_f32 v135, v6, v135
v_mfma_f32_16x16x32_bf16 v[28:31], a[8:11], a[216:219], v[28:31]
buffer_load_dwordx4 v3, s[48:51], s7 offen offset:3072 sc1 lds
v_mfma_f32_16x16x32_bf16 v[28:31], a[12:15], a[220:223], v[28:31]
ds_read_b128 a[60:63], v1 offset:23552
s_waitcnt lgkmcnt(8)
v_mfma_f32_16x16x32_bf16 v[40:43], a[16:19], a[192:195], v[88:91]
s_add_u32 s7, s7, 0x8000
v_xor_b32 v1, 0x8000, v1
v_cvt_pk_bf16_f32 v128, v128, v129
v_mfma_f32_16x16x32_bf16 v[40:43], a[20:23], a[196:199], v[40:43]
s_xor_b32 s27, s27, 0x38000
v_exp_f32 v24, v24
v_mfma_f32_16x16x32_bf16 v[40:43], a[24:27], a[200:203], v[40:43]
v_exp_f32 v25, v25
v_mfma_f32_16x16x32_bf16 v[40:43], a[28:31], a[204:207], v[40:43]
v_exp_f32 v26, v26
v_mfma_f32_16x16x32_bf16 v[44:47], a[16:19], a[208:211], v[92:95]
v_exp_f32 v27, v27
v_mfma_f32_16x16x32_bf16 v[44:47], a[20:23], a[212:215], v[44:47]
v_exp_f32 v28, v28
v_mfma_f32_16x16x32_bf16 v[44:47], a[24:27], a[216:219], v[44:47]
s_waitcnt vmcnt(19) lgkmcnt(0)
v_exp_f32 v29, v29
v_mfma_f32_16x16x32_bf16 v[44:47], a[28:31], a[220:223], v[44:47]
s_barrier
v_cvt_pk_bf16_f32 v129, v130, v131
v_cvt_pk_bf16_f32 v130, v132, v133
v_cvt_pk_bf16_f32 v131, v134, v135
buffer_store_dwordx4 v[128:131], v3, s[88:91], s8 offen sc1
s_add_u32 s8, s28, 0x2000
v_mul_f32 v136, v6, v136
v_mul_f32 v137, v6, v137
v_mul_f32 v138, v6, v138
v_mul_f32 v139, v6, v139
v_mul_f32 v140, v6, v140
v_mul_f32 v141, v6, v141
v_mul_f32 v142, v6, v142
v_mul_f32 v143, v6, v143
v_cvt_pk_bf16_f32 v136, v136, v137
v_cvt_pk_bf16_f32 v137, v138, v139
v_cvt_pk_bf16_f32 v138, v140, v141
v_cvt_pk_bf16_f32 v139, v142, v143
buffer_store_dwordx4 v[136:139], v3, s[88:91], s8 offen sc1
s_add_u32 s8, s28, 0x4000
v_mul_f32 v144, v6, v144
v_mul_f32 v145, v6, v145
v_mul_f32 v146, v6, v146
v_mul_f32 v147, v6, v147
v_mul_f32 v148, v6, v148
v_mul_f32 v149, v6, v149
v_mul_f32 v150, v6, v150
v_mul_f32 v151, v6, v151
v_cvt_pk_bf16_f32 v144, v144, v145
v_cvt_pk_bf16_f32 v145, v146, v147
v_cvt_pk_bf16_f32 v146, v148, v149
v_cvt_pk_bf16_f32 v147, v150, v151
buffer_store_dwordx4 v[144:147], v3, s[88:91], s8 offen sc1
s_add_u32 s8, s28, 0x6000
v_mul_f32 v152, v6, v152
v_mul_f32 v153, v6, v153
v_mul_f32 v154, v6, v154
v_mul_f32 v155, v6, v155
v_mul_f32 v156, v6, v156
v_mul_f32 v157, v6, v157
v_mul_f32 v158, v6, v158
v_mul_f32 v159, v6, v159
v_cvt_pk_bf16_f32 v152, v152, v153
v_cvt_pk_bf16_f32 v153, v154, v155
v_cvt_pk_bf16_f32 v154, v156, v157
v_cvt_pk_bf16_f32 v155, v158, v159
buffer_store_dwordx4 v[152:155], v3, s[88:91], s8 offen sc1
v_accvgpr_read_b32 v6, a226
v_accvgpr_read_b32 v7, a227
v_add_f32 v6, v6, v7
v_cmp_nge_f32 vcc, 0x5f800000, v6
v_rcp_f32 v6, v6
s_or_b64 s[34:35], s[34:35], vcc
s_add_u32 s8, s29, 0x0
v_pk_mul_f32 v[160:161], v[160:161], v[6:7] op_sel_hi:[1,0]
v_pk_mul_f32 v[162:163], v[162:163], v[6:7] op_sel_hi:[1,0]
v_pk_mul_f32 v[164:165], v[164:165], v[6:7] op_sel_hi:[1,0]
v_pk_mul_f32 v[166:167], v[166:167], v[6:7] op_sel_hi:[1,0]
v_cvt_pk_bf16_f32 v160, v160, v161
v_cvt_pk_bf16_f32 v161, v162, v163
v_cvt_pk_bf16_f32 v162, v164, v165
v_cvt_pk_bf16_f32 v163, v166, v167
buffer_store_dwordx4 v[160:163], v3, s[88:91], s8 offen sc1
s_add_u32 s8, s29, 0x2000
v_pk_mul_f32 v[168:169], v[168:169], v[6:7] op_sel_hi:[1,0]
v_pk_mul_f32 v[170:171], v[170:171], v[6:7] op_sel_hi:[1,0]
v_pk_mul_f32 v[172:173], v[172:173], v[6:7] op_sel_hi:[1,0]
v_pk_mul_f32 v[174:175], v[174:175], v[6:7] op_sel_hi:[1,0]
v_cvt_pk_bf16_f32 v168, v168, v169
v_cvt_pk_bf16_f32 v169, v170, v171
v_cvt_pk_bf16_f32 v170, v172, v173
v_cvt_pk_bf16_f32 v171, v174, v175
buffer_store_dwordx4 v[168:171], v3, s[88:91], s8 offen sc1
s_add_u32 s8, s29, 0x4000
v_pk_mul_f32 v[176:177], v[176:177], v[6:7] op_sel_hi:[1,0]
v_pk_mul_f32 v[178:179], v[178:179], v[6:7] op_sel_hi:[1,0]
v_pk_mul_f32 v[180:181], v[180:181], v[6:7] op_sel_hi:[1,0]
v_pk_mul_f32 v[182:183], v[182:183], v[6:7] op_sel_hi:[1,0]
v_cvt_pk_bf16_f32 v176, v176, v177
v_cvt_pk_bf16_f32 v177, v178, v179
v_cvt_pk_bf16_f32 v178, v180, v181
v_cvt_pk_bf16_f32 v179, v182, v183
buffer_store_dwordx4 v[176:179], v3, s[88:91], s8 offen sc1
s_add_u32 s8, s29, 0x6000
v_pk_mul_f32 v[184:185], v[184:185], v[6:7] op_sel_hi:[1,0]
v_pk_mul_f32 v[186:187], v[186:187], v[6:7] op_sel_hi:[1,0]
v_pk_mul_f32 v[188:189], v[188:189], v[6:7] op_sel_hi:[1,0]
v_pk_mul_f32 v[190:191], v[190:191], v[6:7] op_sel_hi:[1,0]
v_cvt_pk_bf16_f32 v184, v184, v185
v_cvt_pk_bf16_f32 v185, v186, v187
v_cvt_pk_bf16_f32 v186, v188, v189
v_cvt_pk_bf16_f32 v187, v190, v191
buffer_store_dwordx4 v[184:187], v3, s[88:91], s8 offen sc1
s_getreg_b32 s8, hwreg(HW_REG_HW_ID, 5, 1)
s_cmp_lg_u32 s8, 0
s_cbranch_scc1 L_att_sodd1
s_branch L_att_sodd0
L_att_lh0_0:
v_mfma_f32_16x16x32_bf16 v[160:163], a[32:35], v[52:55], v[160:163]
v_exp_f32 v28, v28
v_mfma_f32_16x16x32_bf16 v[192:195], a[32:35], v[56:59], v[192:195]
buffer_load_dword v14, v15, s[84:87], 0 offen offset:192 sc1
v_mfma_f32_16x16x32_bf16 v[224:227], a[32:35], v[60:63], v[224:227]
v_exp_f32 v29, v29
v_mfma_f32_16x16x32_bf16 v[228:231], a[36:39], v[60:63], v[228:231]
v_exp_f32 v30, v30
v_mfma_f32_16x16x32_bf16 v[196:199], a[36:39], v[56:59], v[196:199]
s_add_u32 m0, s17, 0x10000
v_exp_f32 v31, v31
v_mfma_f32_16x16x32_bf16 v[164:167], a[36:39], v[52:55], v[164:167]
ds_read_b128 a[0:3], v1 offset:8192
v_cvt_pk_bf16_f32 v72, v24, v25
v_mfma_f32_16x16x32_bf16 v[168:171], a[40:43], v[52:55], v[168:171]
ds_read_b128 a[4:7], v1 offset:9216
v_cvt_pk_bf16_f32 v73, v26, v27
v_mfma_f32_16x16x32_bf16 v[200:203], a[40:43], v[56:59], v[200:203]
buffer_load_dwordx4 v12, s[72:75], 0 offen lds
v_mfma_f32_16x16x32_bf16 v[232:235], a[40:43], v[60:63], v[232:235]
ds_read_b128 a[8:11], v1 offset:10240
v_cvt_pk_bf16_f32 v76, v28, v29
v_mfma_f32_16x16x32_bf16 v[236:239], a[44:47], v[60:63], v[236:239]
v_exp_f32 v36, v36
v_mfma_f32_16x16x32_bf16 v[204:207], a[44:47], v[56:59], v[204:207]
v_exp_f32 v37, v37
v_mfma_f32_16x16x32_bf16 v[172:175], a[44:47], v[52:55], v[172:175]
ds_read_b128 a[12:15], v1 offset:11264
v_cvt_pk_bf16_f32 v77, v30, v31
v_mfma_f32_16x16x32_bf16 v[176:179], a[48:51], v[52:55], v[176:179]
buffer_load_dwordx4 v13, s[72:75], 0 offen offset:1024 lds
v_mfma_f32_16x16x32_bf16 v[208:211], a[48:51], v[56:59], v[208:211]
ds_read_b128 a[16:19], v1 offset:12288
v_cvt_pk_bf16_f32 v70, v36, v37
v_mfma_f32_16x16x32_bf16 v[240:243], a[48:51], v[60:63], v[240:243]
ds_read_b128 a[20:23], v1 offset:13312
v_exp_f32 v38, v38
v_mfma_f32_16x16x32_bf16 v[244:247], a[52:55], v[60:63], v[244:247]
ds_read_b128 a[24:27], v1 offset:14336
v_exp_f32 v39, v39
v_mfma_f32_16x16x32_bf16 v[212:215], a[52:55], v[56:59], v[212:215]
v_exp_f32 v40, v40
v_mfma_f32_16x16x32_bf16 v[180:183], a[52:55], v[52:55], v[180:183]
buffer_load_dwordx4 v12, s[72:75], s12 offen offset:2048 lds
v_mfma_f32_16x16x32_bf16 v[184:187], a[56:59], v[52:55], v[184:187]
ds_read_b128 a[28:31], v1 offset:15360
v_exp_f32 v41, v41
v_mfma_f32_16x16x32_bf16 v[216:219], a[56:59], v[56:59], v[216:219]
buffer_load_dwordx4 v13, s[72:75], s12 offen offset:3072 lds
v_mfma_f32_16x16x32_bf16 v[248:251], a[56:59], v[60:63], v[248:251]
s_add_u32 m0, s17, 0x14000
v_exp_f32 v42, v42
v_mfma_f32_16x16x32_bf16 v[252:255], a[60:63], v[60:63], v[252:255]
ds_read_b128 a[32:35], v1 offset:0
v_cvt_pk_bf16_f32 v71, v38, v39
v_mfma_f32_16x16x32_bf16 v[220:223], a[60:63], v[56:59], v[220:223]
ds_read_b128 a[36:39], v1 offset:1024
v_add_u32 v12, 0x20000, v12
v_mfma_f32_16x16x32_bf16 v[188:191], a[60:63], v[52:55], v[188:191]
buffer_load_dwordx4 v12, s[72:75], 0 offen lds
v_mfma_f32_16x16x32_bf16 a[224:227], a[236:239], v[52:55], a[224:227]
ds_read_b128 a[40:43], v1 offset:2048
v_exp_f32 v43, v43
v_smfmac_f32_16x16x64_bf16 a[228:231], a[232:235], v[56:63], v9
s_waitcnt lgkmcnt(7)
v_exp_f32 v44, v44
v_mfma_f32_16x16x32_bf16 v[24:27], a[0:3], a[192:195], v[112:115]
ds_read_b128 a[44:47], v1 offset:3072
v_exp_f32 v45, v45
v_mfma_f32_16x16x32_bf16 v[24:27], a[4:7], a[196:199], v[24:27]
ds_read_b128 a[48:51], v1 offset:4096
v_add_u32 v13, 0x20000, v13
v_mfma_f32_16x16x32_bf16 v[24:27], a[8:11], a[200:203], v[24:27]
v_exp_f32 v46, v46
v_mfma_f32_16x16x32_bf16 v[24:27], a[12:15], a[204:207], v[24:27]
buffer_load_dwordx4 v13, s[72:75], 0 offen offset:1024 lds
v_mfma_f32_16x16x32_bf16 v[28:31], a[0:3], a[208:211], v[92:95]
v_exp_f32 v47, v47
v_mfma_f32_16x16x32_bf16 v[28:31], a[4:7], a[212:215], v[28:31]
ds_read_b128 a[52:55], v1 offset:5120
v_cvt_pk_bf16_f32 v74, v40, v41
v_mfma_f32_16x16x32_bf16 v[28:31], a[8:11], a[216:219], v[28:31]
ds_read_b128 a[56:59], v1 offset:6144
v_cvt_pk_bf16_f32 v75, v42, v43
v_mfma_f32_16x16x32_bf16 v[28:31], a[12:15], a[220:223], v[28:31]
s_waitcnt lgkmcnt(7)
v_exp_f32 v24, v24
v_mfma_f32_16x16x32_bf16 v[40:43], a[16:19], a[192:195], v[116:119]
buffer_load_dwordx4 v12, s[72:75], s12 offen offset:2048 lds
v_mfma_f32_16x16x32_bf16 v[40:43], a[20:23], a[196:199], v[40:43]
ds_read_b128 a[60:63], v1 offset:7168
v_cvt_pk_bf16_f32 v78, v44, v45
v_mfma_f32_16x16x32_bf16 v[40:43], a[24:27], a[200:203], v[40:43]
v_exp_f32 v25, v25
v_mfma_f32_16x16x32_bf16 v[40:43], a[28:31], a[204:207], v[40:43]
buffer_load_dwordx4 v13, s[72:75], s12 offen offset:3072 lds
v_cvt_pk_bf16_f32 v79, v46, v47
v_mfma_f32_16x16x32_bf16 v[44:47], a[16:19], a[208:211], v[92:95]
v_exp_f32 v26, v26
v_mfma_f32_16x16x32_bf16 v[44:47], a[20:23], a[212:215], v[44:47]
v_exp_f32 v27, v27
v_mfma_f32_16x16x32_bf16 v[44:47], a[24:27], a[216:219], v[44:47]
v_exp_f32 v28, v28
v_mfma_f32_16x16x32_bf16 v[44:47], a[28:31], a[220:223], v[44:47]
s_waitcnt lgkmcnt(0)
v_exp_f32 v29, v29
v_mfma_f32_16x16x32_bf16 v[160:163], a[32:35], v[68:71], v[160:163]
ds_read_b128 a[0:3], v1 offset:24576
v_cvt_pk_bf16_f32 v56, v24, v25
v_mfma_f32_16x16x32_bf16 v[192:195], a[32:35], v[72:75], v[192:195]
ds_read_b128 a[4:7], v1 offset:25600
v_add_u32 v12, 0x20000, v12
v_mfma_f32_16x16x32_bf16 v[224:227], a[32:35], v[76:79], v[224:227]
s_add_u32 m0, s16, 0x0
v_exp_f32 v30, v30
v_mfma_f32_16x16x32_bf16 v[228:231], a[36:39], v[76:79], v[228:231]
buffer_load_dwordx4 v12, s[72:75], 0 offen lds
v_mfma_f32_16x16x32_bf16 v[196:199], a[36:39], v[72:75], v[196:199]
ds_read_b128 a[8:11], v1 offset:26624
v_add_u32 v13, 0x20000, v13
v_mfma_f32_16x16x32_bf16 v[164:167], a[36:39], v[68:71], v[164:167]
buffer_load_dwordx4 v13, s[72:75], 0 offen offset:1024 lds
v_mfma_f32_16x16x32_bf16 v[168:171], a[40:43], v[68:71], v[168:171]
ds_read_b128 a[12:15], v1 offset:27648
v_cvt_pk_bf16_f32 v57, v26, v27
v_mfma_f32_16x16x32_bf16 v[200:203], a[40:43], v[72:75], v[200:203]
v_exp_f32 v31, v31
v_mfma_f32_16x16x32_bf16 v[232:235], a[40:43], v[76:79], v[232:235]
ds_read_b128 a[16:19], v1 offset:28672
v_cvt_pk_bf16_f32 v60, v28, v29
v_mfma_f32_16x16x32_bf16 v[236:239], a[44:47], v[76:79], v[236:239]
buffer_load_dwordx4 v12, s[72:75], s12 offen offset:2048 lds
v_mfma_f32_16x16x32_bf16 v[204:207], a[44:47], v[72:75], v[204:207]
ds_read_b128 a[20:23], v1 offset:29696
v_cvt_pk_bf16_f32 v61, v30, v31
v_mfma_f32_16x16x32_bf16 v[172:175], a[44:47], v[68:71], v[172:175]
buffer_load_dwordx4 v13, s[72:75], s12 offen offset:3072 lds
v_mfma_f32_16x16x32_bf16 v[176:179], a[48:51], v[68:71], v[176:179]
ds_read_b128 a[24:27], v1 offset:30720
v_mfma_f32_16x16x32_bf16 v[208:211], a[48:51], v[72:75], v[208:211]
ds_read_b128 a[28:31], v1 offset:31744
v_mfma_f32_16x16x32_bf16 v[240:243], a[48:51], v[76:79], v[240:243]
v_exp_f32 v40, v40
v_mfma_f32_16x16x32_bf16 v[244:247], a[52:55], v[76:79], v[244:247]
s_add_u32 m0, s16, 0x4000
v_exp_f32 v41, v41
v_mfma_f32_16x16x32_bf16 v[212:215], a[52:55], v[72:75], v[212:215]
ds_read_b128 a[32:35], v1 offset:16384
v_cvt_pk_bf16_f32 v58, v40, v41
v_mfma_f32_16x16x32_bf16 v[180:183], a[52:55], v[68:71], v[180:183]
ds_read_b128 a[36:39], v1 offset:17408
v_add_u32 v12, 0x20000, v12
v_mfma_f32_16x16x32_bf16 v[184:187], a[56:59], v[68:71], v[184:187]
buffer_load_dwordx4 v12, s[72:75], 0 offen lds
v_mfma_f32_16x16x32_bf16 v[216:219], a[56:59], v[72:75], v[216:219]
ds_read_b128 a[40:43], v1 offset:18432
v_mfma_f32_16x16x32_bf16 v[248:251], a[56:59], v[76:79], v[248:251]
v_exp_f32 v42, v42
v_mfma_f32_16x16x32_bf16 v[252:255], a[60:63], v[76:79], v[252:255]
ds_read_b128 a[44:47], v1 offset:19456
v_add_u32 v13, 0x20000, v13
v_mfma_f32_16x16x32_bf16 v[220:223], a[60:63], v[72:75], v[220:223]
buffer_load_dwordx4 v13, s[72:75], 0 offen offset:1024 lds
v_mfma_f32_16x16x32_bf16 v[188:191], a[60:63], v[68:71], v[188:191]
ds_read_b128 a[48:51], v1 offset:20480
v_exp_f32 v43, v43
v_mfma_f32_16x16x32_bf16 a[224:227], a[236:239], v[68:71], a[224:227]
s_waitcnt lgkmcnt(9)
v_exp_f32 v44, v44
v_smfmac_f32_16x16x64_bf16 a[228:231], a[232:235], v[72:79], v9
ds_read_b128 a[52:55], v1 offset:21504
v_exp_f32 v45, v45
v_mfma_f32_16x16x32_bf16 v[28:31], a[0:3], a[208:211], v[92:95]
buffer_load_dwordx4 v12, s[72:75], s12 offen offset:2048 lds
v_mfma_f32_16x16x32_bf16 v[28:31], a[4:7], a[212:215], v[28:31]
ds_read_b128 a[56:59], v1 offset:22528
v_exp_f32 v46, v46
v_mfma_f32_16x16x32_bf16 v[28:31], a[8:11], a[216:219], v[28:31]
ds_read_b128 a[60:63], v1 offset:23552
v_xor_b32 v1, 0x8000, v1
v_mfma_f32_16x16x32_bf16 v[28:31], a[12:15], a[220:223], v[28:31]
s_waitcnt lgkmcnt(8)
v_exp_f32 v47, v47
v_cvt_pk_bf16_f32 v62, v44, v45
v_cvt_pk_bf16_f32 v63, v46, v47
v_mfma_f32_16x16x32_bf16 v[44:47], a[16:19], a[208:211], v[92:95]
buffer_load_dwordx4 v13, s[72:75], s12 offen offset:3072 lds
v_mfma_f32_16x16x32_bf16 v[44:47], a[20:23], a[212:215], v[44:47]
v_cvt_pk_bf16_f32 v59, v42, v43
v_mfma_f32_16x16x32_bf16 v[44:47], a[24:27], a[216:219], v[44:47]
v_mfma_f32_16x16x32_bf16 v[44:47], a[28:31], a[220:223], v[44:47]
v_accvgpr_read_b32 v6, a224
v_accvgpr_read_b32 v7, a225
v_add_f32 v6, v6, v7
v_cmp_nge_f32 vcc, 0x5f800000, v6
v_rcp_f32 v6, v6
s_or_b64 s[34:35], s[34:35], vcc
s_add_u32 s8, s28, 0x0
v_pk_mul_f32 v[128:129], v[128:129], v[6:7] op_sel_hi:[1,0]
v_pk_mul_f32 v[130:131], v[130:131], v[6:7] op_sel_hi:[1,0]
v_pk_mul_f32 v[132:133], v[132:133], v[6:7] op_sel_hi:[1,0]
v_pk_mul_f32 v[134:135], v[134:135], v[6:7] op_sel_hi:[1,0]
v_cvt_pk_bf16_f32 v128, v128, v129
v_cvt_pk_bf16_f32 v129, v130, v131
v_cvt_pk_bf16_f32 v130, v132, v133
v_cvt_pk_bf16_f32 v131, v134, v135
buffer_store_dwordx4 v[128:131], v3, s[88:91], s8 offen sc1
s_add_u32 s8, s28, 0x2000
v_pk_mul_f32 v[136:137], v[136:137], v[6:7] op_sel_hi:[1,0]
v_pk_mul_f32 v[138:139], v[138:139], v[6:7] op_sel_hi:[1,0]
v_pk_mul_f32 v[140:141], v[140:141], v[6:7] op_sel_hi:[1,0]
v_pk_mul_f32 v[142:143], v[142:143], v[6:7] op_sel_hi:[1,0]
v_cvt_pk_bf16_f32 v136, v136, v137
v_cvt_pk_bf16_f32 v137, v138, v139
v_cvt_pk_bf16_f32 v138, v140, v141
v_cvt_pk_bf16_f32 v139, v142, v143
buffer_store_dwordx4 v[136:139], v3, s[88:91], s8 offen sc1
s_add_u32 s8, s28, 0x4000
v_pk_mul_f32 v[144:145], v[144:145], v[6:7] op_sel_hi:[1,0]
v_pk_mul_f32 v[146:147], v[146:147], v[6:7] op_sel_hi:[1,0]
v_pk_mul_f32 v[148:149], v[148:149], v[6:7] op_sel_hi:[1,0]
v_pk_mul_f32 v[150:151], v[150:151], v[6:7] op_sel_hi:[1,0]
v_cvt_pk_bf16_f32 v144, v144, v145
v_cvt_pk_bf16_f32 v145, v146, v147
v_cvt_pk_bf16_f32 v146, v148, v149
v_cvt_pk_bf16_f32 v147, v150, v151
buffer_store_dwordx4 v[144:147], v3, s[88:91], s8 offen sc1
s_add_u32 s8, s28, 0x6000
v_pk_mul_f32 v[152:153], v[152:153], v[6:7] op_sel_hi:[1,0]
v_pk_mul_f32 v[154:155], v[154:155], v[6:7] op_sel_hi:[1,0]
v_pk_mul_f32 v[156:157], v[156:157], v[6:7] op_sel_hi:[1,0]
v_pk_mul_f32 v[158:159], v[158:159], v[6:7] op_sel_hi:[1,0]
v_cvt_pk_bf16_f32 v152, v152, v153
v_cvt_pk_bf16_f32 v153, v154, v155
v_cvt_pk_bf16_f32 v154, v156, v157
v_cvt_pk_bf16_f32 v155, v158, v159
buffer_store_dwordx4 v[152:155], v3, s[88:91], s8 offen sc1
v_accvgpr_read_b32 v6, a226
v_accvgpr_read_b32 v7, a227
v_add_f32 v6, v6, v7
v_cmp_nge_f32 vcc, 0x5f800000, v6
v_rcp_f32 v6, v6
s_or_b64 s[34:35], s[34:35], vcc
s_add_u32 s8, s29, 0x0
v_pk_mul_f32 v[160:161], v[160:161], v[6:7] op_sel_hi:[1,0]
v_pk_mul_f32 v[162:163], v[162:163], v[6:7] op_sel_hi:[1,0]
v_pk_mul_f32 v[164:165], v[164:165], v[6:7] op_sel_hi:[1,0]
v_pk_mul_f32 v[166:167], v[166:167], v[6:7] op_sel_hi:[1,0]
v_cvt_pk_bf16_f32 v160, v160, v161
v_cvt_pk_bf16_f32 v161, v162, v163
v_cvt_pk_bf16_f32 v162, v164, v165
v_cvt_pk_bf16_f32 v163, v166, v167
buffer_store_dwordx4 v[160:163], v3, s[88:91], s8 offen sc1
s_add_u32 s8, s29, 0x2000
v_pk_mul_f32 v[168:169], v[168:169], v[6:7] op_sel_hi:[1,0]
v_pk_mul_f32 v[170:171], v[170:171], v[6:7] op_sel_hi:[1,0]
v_pk_mul_f32 v[172:173], v[172:173], v[6:7] op_sel_hi:[1,0]
v_pk_mul_f32 v[174:175], v[174:175], v[6:7] op_sel_hi:[1,0]
v_cvt_pk_bf16_f32 v168, v168, v169
v_cvt_pk_bf16_f32 v169, v170, v171
v_cvt_pk_bf16_f32 v170, v172, v173
v_cvt_pk_bf16_f32 v171, v174, v175
buffer_store_dwordx4 v[168:171], v3, s[88:91], s8 offen sc1
s_add_u32 s8, s29, 0x4000
v_pk_mul_f32 v[176:177], v[176:177], v[6:7] op_sel_hi:[1,0]
v_pk_mul_f32 v[178:179], v[178:179], v[6:7] op_sel_hi:[1,0]
v_pk_mul_f32 v[180:181], v[180:181], v[6:7] op_sel_hi:[1,0]
v_pk_mul_f32 v[182:183], v[182:183], v[6:7] op_sel_hi:[1,0]
v_cvt_pk_bf16_f32 v176, v176, v177
v_cvt_pk_bf16_f32 v177, v178, v179
v_cvt_pk_bf16_f32 v178, v180, v181
v_cvt_pk_bf16_f32 v179, v182, v183
buffer_store_dwordx4 v[176:179], v3, s[88:91], s8 offen sc1
s_add_u32 s8, s29, 0x6000
v_pk_mul_f32 v[184:185], v[184:185], v[6:7] op_sel_hi:[1,0]
v_pk_mul_f32 v[186:187], v[186:187], v[6:7] op_sel_hi:[1,0]
v_pk_mul_f32 v[188:189], v[188:189], v[6:7] op_sel_hi:[1,0]
v_pk_mul_f32 v[190:191], v[190:191], v[6:7] op_sel_hi:[1,0]
v_cvt_pk_bf16_f32 v184, v184, v185
v_cvt_pk_bf16_f32 v185, v186, v187
v_cvt_pk_bf16_f32 v186, v188, v189
v_cvt_pk_bf16_f32 v187, v190, v191
buffer_store_dwordx4 v[184:187], v3, s[88:91], s8 offen sc1
s_branch L_att_h1_0
L_att_dl0_1:
v_mfma_f32_16x16x32_bf16 v[128:131], a[32:35], v[48:51], v[128:131]
ds_read_b128 a[0:3], v1 offset:8192
v_cvt_pk_bf16_f32 v72, v24, v25
v_mfma_f32_16x16x32_bf16 v[160:163], a[32:35], v[52:55], v[160:163]
v_exp_f32 v28, v28
v_mfma_f32_16x16x32_bf16 v[192:195], a[32:35], v[56:59], v[192:195]
v_cvt_pk_bf16_f32 v73, v26, v27
v_mfma_f32_16x16x32_bf16 v[224:227], a[32:35], v[60:63], v[224:227]
ds_read_b128 a[4:7], v1 offset:9216
v_mfma_f32_16x16x32_bf16 v[228:231], a[36:39], v[60:63], v[228:231]
s_add_u32 m0, s27, 0x0
v_exp_f32 v29, v29
v_mfma_f32_16x16x32_bf16 v[196:199], a[36:39], v[56:59], v[196:199]
buffer_load_dwordx4 v3, s[48:51], s32 offen offset:0 sc1 lds
v_mfma_f32_16x16x32_bf16 v[164:167], a[36:39], v[52:55], v[164:167]
v_exp_f32 v30, v30
v_mfma_f32_16x16x32_bf16 v[132:135], a[36:39], v[48:51], v[132:135]
ds_read_b128 a[8:11], v1 offset:10240
v_cvt_pk_bf16_f32 v76, v28, v29
v_mfma_f32_16x16x32_bf16 v[136:139], a[40:43], v[48:51], v[136:139]
v_mfma_f32_16x16x32_bf16 v[168:171], a[40:43], v[52:55], v[168:171]
v_exp_f32 v31, v31
v_mfma_f32_16x16x32_bf16 v[200:203], a[40:43], v[56:59], v[200:203]
v_exp_f32 v32, v32
v_mfma_f32_16x16x32_bf16 v[232:235], a[40:43], v[60:63], v[232:235]
ds_read_b128 a[12:15], v1 offset:11264
v_cvt_pk_bf16_f32 v77, v30, v31
v_mfma_f32_16x16x32_bf16 v[236:239], a[44:47], v[60:63], v[236:239]
v_exp_f32 v33, v33
v_mfma_f32_16x16x32_bf16 v[204:207], a[44:47], v[56:59], v[204:207]
v_cvt_pk_bf16_f32 v66, v32, v33
v_mfma_f32_16x16x32_bf16 v[172:175], a[44:47], v[52:55], v[172:175]
s_mov_b32 s9, 0x0
v_exp_f32 v34, v34
v_mfma_f32_16x16x32_bf16 v[140:143], a[44:47], v[48:51], v[140:143]
ds_read_b128 a[16:19], v1 offset:12288
v_mfma_f32_16x16x32_bf16 v[144:147], a[48:51], v[48:51], v[144:147]
buffer_load_dword a244, v8, s[72:75], s9 offen
v_mfma_f32_16x16x32_bf16 v[176:179], a[48:51], v[52:55], v[176:179]
v_exp_f32 v35, v35
v_mfma_f32_16x16x32_bf16 v[208:211], a[48:51], v[56:59], v[208:211]
v_exp_f32 v36, v36
v_mfma_f32_16x16x32_bf16 v[240:243], a[48:51], v[60:63], v[240:243]
ds_read_b128 a[20:23], v1 offset:13312
v_cvt_pk_bf16_f32 v67, v34, v35
v_mfma_f32_16x16x32_bf16 v[244:247], a[52:55], v[60:63], v[244:247]
v_mfma_f32_16x16x32_bf16 v[212:215], a[52:55], v[56:59], v[212:215]
v_exp_f32 v37, v37
v_mfma_f32_16x16x32_bf16 v[180:183], a[52:55], v[52:55], v[180:183]
ds_read_b128 a[24:27], v1 offset:14336
v_cvt_pk_bf16_f32 v70, v36, v37
v_mfma_f32_16x16x32_bf16 v[148:151], a[52:55], v[48:51], v[148:151]
v_exp_f32 v38, v38
v_mfma_f32_16x16x32_bf16 v[152:155], a[56:59], v[48:51], v[152:155]
v_mfma_f32_16x16x32_bf16 v[184:187], a[56:59], v[52:55], v[184:187]
v_exp_f32 v39, v39
v_mfma_f32_16x16x32_bf16 v[216:219], a[56:59], v[56:59], v[216:219]
buffer_load_dwordx4 v3, s[48:51], s32 offen offset:1024 sc1 lds
v_mfma_f32_16x16x32_bf16 v[248:251], a[56:59], v[60:63], v[248:251]
ds_read_b128 a[28:31], v1 offset:15360
v_cvt_pk_bf16_f32 v71, v38, v39
v_mfma_f32_16x16x32_bf16 v[252:255], a[60:63], v[60:63], v[252:255]
v_exp_f32 v40, v40
v_mfma_f32_16x16x32_bf16 v[220:223], a[60:63], v[56:59], v[220:223]
v_exp_f32 v41, v41
v_mfma_f32_16x16x32_bf16 v[188:191], a[60:63], v[52:55], v[188:191]
ds_read_b128 a[32:35], v1 offset:0
v_cvt_pk_bf16_f32 v74, v40, v41
v_mfma_f32_16x16x32_bf16 v[156:159], a[60:63], v[48:51], v[156:159]
v_smfmac_f32_16x16x64_bf16 a[224:227], a[232:235], v[48:55], v9
v_exp_f32 v42, v42
v_smfmac_f32_16x16x64_bf16 a[228:231], a[232:235], v[56:63], v9
s_waitcnt lgkmcnt(5)
v_exp_f32 v43, v43
v_mfma_f32_16x16x32_bf16 v[16:19], a[0:3], a[160:163], v[80:83]
ds_read_b128 a[36:39], v1 offset:1024
v_cvt_pk_bf16_f32 v75, v42, v43
v_mfma_f32_16x16x32_bf16 v[16:19], a[4:7], a[164:167], v[16:19]
v_exp_f32 v44, v44
v_mfma_f32_16x16x32_bf16 v[16:19], a[8:11], a[168:171], v[16:19]
v_mfma_f32_16x16x32_bf16 v[16:19], a[12:15], a[172:175], v[16:19]
buffer_load_dwordx4 v3, s[48:51], s32 offen offset:2048 sc1 lds
v_mfma_f32_16x16x32_bf16 v[20:23], a[0:3], a[176:179], v[84:87]
ds_read_b128 a[40:43], v1 offset:2048
v_mfma_f32_16x16x32_bf16 v[20:23], a[4:7], a[180:183], v[20:23]
v_exp_f32 v45, v45
v_mfma_f32_16x16x32_bf16 v[20:23], a[8:11], a[184:187], v[20:23]
v_exp_f32 v46, v46
v_mfma_f32_16x16x32_bf16 v[20:23], a[12:15], a[188:191], v[20:23]
ds_read_b128 a[44:47], v1 offset:3072
v_cvt_pk_bf16_f32 v78, v44, v45
v_mfma_f32_16x16x32_bf16 v[24:27], a[0:3], a[192:195], v[88:91]
v_mfma_f32_16x16x32_bf16 v[24:27], a[4:7], a[196:199], v[24:27]
v_exp_f32 v47, v47
v_mfma_f32_16x16x32_bf16 v[24:27], a[8:11], a[200:203], v[24:27]
v_exp_f32 v16, v16
v_mfma_f32_16x16x32_bf16 v[24:27], a[12:15], a[204:207], v[24:27]
ds_read_b128 a[48:51], v1 offset:4096
v_cvt_pk_bf16_f32 v79, v46, v47
v_mfma_f32_16x16x32_bf16 v[28:31], a[0:3], a[208:211], v[92:95]
v_exp_f32 v17, v17
v_mfma_f32_16x16x32_bf16 v[28:31], a[4:7], a[212:215], v[28:31]
s_waitcnt lgkmcnt(5)
v_cvt_pk_bf16_f32 v48, v16, v17
v_mfma_f32_16x16x32_bf16 v[28:31], a[8:11], a[216:219], v[28:31]
buffer_load_dwordx4 v3, s[48:51], s32 offen offset:3072 sc1 lds
v_mfma_f32_16x16x32_bf16 v[28:31], a[12:15], a[220:223], v[28:31]
ds_read_b128 a[52:55], v1 offset:5120
v_mfma_f32_16x16x32_bf16 v[32:35], a[16:19], a[160:163], v[80:83]
v_exp_f32 v18, v18
v_mfma_f32_16x16x32_bf16 v[32:35], a[20:23], a[164:167], v[32:35]
v_exp_f32 v19, v19
v_mfma_f32_16x16x32_bf16 v[32:35], a[24:27], a[168:171], v[32:35]
v_exp_f32 v20, v20
v_mfma_f32_16x16x32_bf16 v[32:35], a[28:31], a[172:175], v[32:35]
ds_read_b128 a[56:59], v1 offset:6144
v_cvt_pk_bf16_f32 v49, v18, v19
v_mfma_f32_16x16x32_bf16 v[36:39], a[16:19], a[176:179], v[84:87]
v_mfma_f32_16x16x32_bf16 v[36:39], a[20:23], a[180:183], v[36:39]
v_exp_f32 v21, v21
v_mfma_f32_16x16x32_bf16 v[36:39], a[24:27], a[184:187], v[36:39]
s_mov_b32 s9, 0x0
v_exp_f32 v22, v22
v_mfma_f32_16x16x32_bf16 v[36:39], a[28:31], a[188:191], v[36:39]
ds_read_b128 a[60:63], v1 offset:7168
v_cvt_pk_bf16_f32 v52, v20, v21
v_mfma_f32_16x16x32_bf16 v[40:43], a[16:19], a[192:195], v[88:91]
buffer_load_dword a244, v8, s[64:67], s9 offen
v_mfma_f32_16x16x32_bf16 v[40:43], a[20:23], a[196:199], v[40:43]
v_mfma_f32_16x16x32_bf16 v[40:43], a[24:27], a[200:203], v[40:43]
v_exp_f32 v23, v23
v_mfma_f32_16x16x32_bf16 v[40:43], a[28:31], a[204:207], v[40:43]
v_exp_f32 v24, v24
v_mfma_f32_16x16x32_bf16 v[44:47], a[16:19], a[208:211], v[92:95]
v_exp_f32 v25, v25
v_mfma_f32_16x16x32_bf16 v[44:47], a[20:23], a[212:215], v[44:47]
v_exp_f32 v26, v26
v_mfma_f32_16x16x32_bf16 v[44:47], a[24:27], a[216:219], v[44:47]
v_exp_f32 v27, v27
v_mfma_f32_16x16x32_bf16 v[44:47], a[28:31], a[220:223], v[44:47]
s_waitcnt lgkmcnt(0)
v_cvt_pk_bf16_f32 v53, v22, v23
v_mfma_f32_16x16x32_bf16 v[128:131], a[32:35], v[64:67], v[128:131]
ds_read_b128 a[0:3], v1 offset:24576
v_cvt_pk_bf16_f32 v56, v24, v25
v_mfma_f32_16x16x32_bf16 v[160:163], a[32:35], v[68:71], v[160:163]
v_exp_f32 v28, v28
v_mfma_f32_16x16x32_bf16 v[192:195], a[32:35], v[72:75], v[192:195]
v_cvt_pk_bf16_f32 v57, v26, v27
v_mfma_f32_16x16x32_bf16 v[224:227], a[32:35], v[76:79], v[224:227]
ds_read_b128 a[4:7], v1 offset:25600
v_mfma_f32_16x16x32_bf16 v[228:231], a[36:39], v[76:79], v[228:231]
v_exp_f32 v29, v29
v_mfma_f32_16x16x32_bf16 v[196:199], a[36:39], v[72:75], v[196:199]
s_add_u32 m0, s27, 0x1000
v_exp_f32 v30, v30
v_mfma_f32_16x16x32_bf16 v[164:167], a[36:39], v[68:71], v[164:167]
buffer_load_dwordx4 v3, s[48:51], s7 offen offset:0 sc1 lds
v_mfma_f32_16x16x32_bf16 v[132:135], a[36:39], v[64:67], v[132:135]
ds_read_b128 a[8:11], v1 offset:26624
v_cvt_pk_bf16_f32 v60, v28, v29
v_mfma_f32_16x16x32_bf16 v[136:139], a[40:43], v[64:67], v[136:139]
v_mfma_f32_16x16x32_bf16 v[168:171], a[40:43], v[68:71], v[168:171]
v_exp_f32 v31, v31
v_mfma_f32_16x16x32_bf16 v[200:203], a[40:43], v[72:75], v[200:203]
v_exp_f32 v32, v32
v_mfma_f32_16x16x32_bf16 v[232:235], a[40:43], v[76:79], v[232:235]
ds_read_b128 a[12:15], v1 offset:27648
v_cvt_pk_bf16_f32 v61, v30, v31
v_mfma_f32_16x16x32_bf16 v[236:239], a[44:47], v[76:79], v[236:239]
v_mfma_f32_16x16x32_bf16 v[204:207], a[44:47], v[72:75], v[204:207]
v_exp_f32 v33, v33
v_mfma_f32_16x16x32_bf16 v[172:175], a[44:47], v[68:71], v[172:175]
v_exp_f32 v34, v34
v_mfma_f32_16x16x32_bf16 v[140:143], a[44:47], v[64:67], v[140:143]
ds_read_b128 a[16:19], v1 offset:28672
v_cvt_pk_bf16_f32 v50, v32, v33
v_mfma_f32_16x16x32_bf16 v[144:147], a[48:51], v[64:67], v[144:147]
v_exp_f32 v35, v35
v_mfma_f32_16x16x32_bf16 v[176:179], a[48:51], v[68:71], v[176:179]
v_cvt_pk_bf16_f32 v51, v34, v35
v_mfma_f32_16x16x32_bf16 v[208:211], a[48:51], v[72:75], v[208:211]
buffer_load_dwordx4 v3, s[48:51], s7 offen offset:1024 sc1 lds
v_mfma_f32_16x16x32_bf16 v[240:243], a[48:51], v[76:79], v[240:243]
ds_read_b128 a[20:23], v1 offset:29696
v_mfma_f32_16x16x32_bf16 v[244:247], a[52:55], v[76:79], v[244:247]
v_exp_f32 v36, v36
v_mfma_f32_16x16x32_bf16 v[212:215], a[52:55], v[72:75], v[212:215]
v_exp_f32 v37, v37
v_mfma_f32_16x16x32_bf16 v[180:183], a[52:55], v[68:71], v[180:183]
ds_read_b128 a[24:27], v1 offset:30720
v_cvt_pk_bf16_f32 v54, v36, v37
v_mfma_f32_16x16x32_bf16 v[148:151], a[52:55], v[64:67], v[148:151]
v_mfma_f32_16x16x32_bf16 v[152:155], a[56:59], v[64:67], v[152:155]
v_exp_f32 v38, v38
v_mfma_f32_16x16x32_bf16 v[184:187], a[56:59], v[68:71], v[184:187]
v_exp_f32 v39, v39
v_mfma_f32_16x16x32_bf16 v[216:219], a[56:59], v[72:75], v[216:219]
ds_read_b128 a[28:31], v1 offset:31744
v_cvt_pk_bf16_f32 v55, v38, v39
v_mfma_f32_16x16x32_bf16 v[248:251], a[56:59], v[76:79], v[248:251]
v_exp_f32 v40, v40
v_mfma_f32_16x16x32_bf16 v[252:255], a[60:63], v[76:79], v[252:255]
v_mfma_f32_16x16x32_bf16 v[220:223], a[60:63], v[72:75], v[220:223]
v_exp_f32 v41, v41
v_mfma_f32_16x16x32_bf16 v[188:191], a[60:63], v[68:71], v[188:191]
buffer_load_dwordx4 v3, s[48:51], s7 offen offset:2048 sc1 lds
v_mfma_f32_16x16x32_bf16 v[156:159], a[60:63], v[64:67], v[156:159]
ds_read_b128 a[32:35], v1 offset:16384
v_cvt_pk_bf16_f32 v58, v40, v41
v_smfmac_f32_16x16x64_bf16 a[224:227], a[232:235], v[64:71], v9
s_waitcnt lgkmcnt(5)
v_exp_f32 v42, v42
v_smfmac_f32_16x16x64_bf16 a[228:231], a[232:235], v[72:79], v9
ds_read_b128 a[36:39], v1 offset:17408
v_mfma_f32_16x16x32_bf16 v[16:19], a[0:3], a[160:163], v[96:99]
v_mfma_f32_16x16x32_bf16 v[16:19], a[4:7], a[164:167], v[16:19]
v_exp_f32 v43, v43
v_mfma_f32_16x16x32_bf16 v[16:19], a[8:11], a[168:171], v[16:19]
v_exp_f32 v44, v44
v_mfma_f32_16x16x32_bf16 v[16:19], a[12:15], a[172:175], v[16:19]
ds_read_b128 a[40:43], v1 offset:18432
v_cvt_pk_bf16_f32 v59, v42, v43
v_mfma_f32_16x16x32_bf16 v[20:23], a[0:3], a[176:179], v[84:87]
v_exp_f32 v45, v45
v_mfma_f32_16x16x32_bf16 v[20:23], a[4:7], a[180:183], v[20:23]
v_cvt_pk_bf16_f32 v62, v44, v45
v_mfma_f32_16x16x32_bf16 v[20:23], a[8:11], a[184:187], v[20:23]
s_mov_b32 s9, 0x400000
v_exp_f32 v46, v46
v_mfma_f32_16x16x32_bf16 v[20:23], a[12:15], a[188:191], v[20:23]
ds_read_b128 a[44:47], v1 offset:19456
v_mfma_f32_16x16x32_bf16 v[24:27], a[0:3], a[192:195], v[88:91]
buffer_load_dword a244, v8, s[64:67], s9 offen
v_mfma_f32_16x16x32_bf16 v[24:27], a[4:7], a[196:199], v[24:27]
v_exp_f32 v47, v47
v_mfma_f32_16x16x32_bf16 v[24:27], a[8:11], a[200:203], v[24:27]
v_cvt_pk_bf16_f32 v63, v46, v47
v_mfma_f32_16x16x32_bf16 v[24:27], a[12:15], a[204:207], v[24:27]
ds_read_b128 a[48:51], v1 offset:20480
v_mfma_f32_16x16x32_bf16 v[28:31], a[0:3], a[208:211], v[92:95]
v_exp_f32 v16, v16
v_mfma_f32_16x16x32_bf16 v[28:31], a[4:7], a[212:215], v[28:31]
v_exp_f32 v17, v17
v_mfma_f32_16x16x32_bf16 v[28:31], a[8:11], a[216:219], v[28:31]
ds_read_b128 a[52:55], v1 offset:21504
v_cvt_pk_bf16_f32 v64, v16, v17
v_mfma_f32_16x16x32_bf16 v[28:31], a[12:15], a[220:223], v[28:31]
s_waitcnt lgkmcnt(6)
v_exp_f32 v18, v18
v_mfma_f32_16x16x32_bf16 v[32:35], a[16:19], a[160:163], v[100:103]
v_mfma_f32_16x16x32_bf16 v[32:35], a[20:23], a[164:167], v[32:35]
v_exp_f32 v19, v19
v_mfma_f32_16x16x32_bf16 v[32:35], a[24:27], a[168:171], v[32:35]
ds_read_b128 a[56:59], v1 offset:22528
v_cvt_pk_bf16_f32 v65, v18, v19
v_mfma_f32_16x16x32_bf16 v[32:35], a[28:31], a[172:175], v[32:35]
v_exp_f32 v20, v20
v_mfma_f32_16x16x32_bf16 v[36:39], a[16:19], a[176:179], v[84:87]
buffer_load_dwordx4 v3, s[48:51], s7 offen offset:3072 sc1 lds
v_mfma_f32_16x16x32_bf16 v[36:39], a[20:23], a[180:183], v[36:39]
s_add_u32 s32, s32, 0x8000
v_mfma_f32_16x16x32_bf16 v[36:39], a[24:27], a[184:187], v[36:39]
ds_read_b128 a[60:63], v1 offset:23552
v_xor_b32 v1, 0x8000, v1
v_mfma_f32_16x16x32_bf16 v[36:39], a[28:31], a[188:191], v[36:39]
s_add_u32 s7, s7, 0x8000
v_exp_f32 v21, v21
v_mfma_f32_16x16x32_bf16 v[40:43], a[16:19], a[192:195], v[88:91]
s_xor_b32 s27, s27, 0x38000
v_exp_f32 v22, v22
v_mfma_f32_16x16x32_bf16 v[40:43], a[20:23], a[196:199], v[40:43]
v_exp_f32 v23, v23
v_mfma_f32_16x16x32_bf16 v[40:43], a[24:27], a[200:203], v[40:43]
v_cvt_pk_bf16_f32 v68, v20, v21
v_cvt_pk_bf16_f32 v69, v22, v23
v_mfma_f32_16x16x32_bf16 v[40:43], a[28:31], a[204:207], v[40:43]
v_exp_f32 v24, v24
v_mfma_f32_16x16x32_bf16 v[44:47], a[16:19], a[208:211], v[92:95]
v_exp_f32 v25, v25
v_mfma_f32_16x16x32_bf16 v[44:47], a[20:23], a[212:215], v[44:47]
v_exp_f32 v26, v26
v_mfma_f32_16x16x32_bf16 v[44:47], a[24:27], a[216:219], v[44:47]
s_waitcnt vmcnt(19) lgkmcnt(0)
v_exp_f32 v27, v27
v_mfma_f32_16x16x32_bf16 v[44:47], a[28:31], a[220:223], v[44:47]
s_barrier
L_att_l1_1:
v_mfma_f32_16x16x32_bf16 v[128:131], a[32:35], v[48:51], v[128:131]
ds_read_b128 a[0:3], v2 offset:8192
v_cvt_pk_bf16_f32 v72, v24, v25
v_mfma_f32_16x16x32_bf16 v[160:163], a[32:35], v[52:55], v[160:163]
s_lshr_b32 s44, s2, 6
v_exp_f32 v28, v28
v_mfma_f32_16x16x32_bf16 v[192:195], a[32:35], v[56:59], v[192:195]
s_add_u32 m0, s19, 0x0
s_lshl_b32 s45, s44, 1
v_cvt_pk_bf16_f32 v73, v26, v27
v_mfma_f32_16x16x32_bf16 v[224:227], a[32:35], v[60:63], v[224:227]
ds_read_b128 a[4:7], v2 offset:9216
s_add_u32 s45, s45, s100
v_mfma_f32_16x16x32_bf16 v[228:231], a[36:39], v[60:63], v[228:231]
buffer_load_dwordx4 v3, s[48:51], s32 offen offset:0 sc1 lds
v_mfma_f32_16x16x32_bf16 v[196:199], a[36:39], v[56:59], v[196:199]
s_and_b32 s60, s45, 3
v_exp_f32 v29, v29
v_mfma_f32_16x16x32_bf16 v[164:167], a[36:39], v[52:55], v[164:167]
ds_read_b128 a[8:11], v2 offset:10240
v_cvt_pk_bf16_f32 v76, v28, v29
v_mfma_f32_16x16x32_bf16 v[132:135], a[36:39], v[48:51], v[132:135]
s_sub_u32 s60, s60, s44
v_exp_f32 v30, v30
v_mfma_f32_16x16x32_bf16 v[136:139], a[40:43], v[48:51], v[136:139]
s_lshl_b32 s60, s60, 14
v_exp_f32 v31, v31
v_mfma_f32_16x16x32_bf16 v[168:171], a[40:43], v[52:55], v[168:171]
ds_read_b128 a[12:15], v2 offset:11264
v_cvt_pk_bf16_f32 v77, v30, v31
v_mfma_f32_16x16x32_bf16 v[200:203], a[40:43], v[56:59], v[200:203]
s_and_b32 s60, s60, 0x7c000
s_lshl_b32 s61, s60, 3
s_add_u32 s62, s61, s12
v_mfma_f32_16x16x32_bf16 v[232:235], a[40:43], v[60:63], v[232:235]
s_mul_i32 s44, s44, -8
v_exp_f32 v32, v32
v_mfma_f32_16x16x32_bf16 v[236:239], a[44:47], v[60:63], v[236:239]
s_mov_b32 s9, 0x200000
v_exp_f32 v33, v33
v_mfma_f32_16x16x32_bf16 v[204:207], a[44:47], v[56:59], v[204:207]
ds_read_b128 a[16:19], v2 offset:12288
v_cvt_pk_bf16_f32 v66, v32, v33
v_mfma_f32_16x16x32_bf16 v[172:175], a[44:47], v[52:55], v[172:175]
buffer_load_dword a244, v8, s[64:67], s9 offen
v_mfma_f32_16x16x32_bf16 v[140:143], a[44:47], v[48:51], v[140:143]
s_lshl_b32 s44, 4, s44
v_exp_f32 v34, v34
v_mfma_f32_16x16x32_bf16 v[144:147], a[48:51], v[48:51], v[144:147]
ds_read_b128 a[20:23], v2 offset:13312
s_mul_i32 s45, s45, -8
v_mfma_f32_16x16x32_bf16 v[176:179], a[48:51], v[52:55], v[176:179]
s_lshl_b32 s45, 4, s45
v_exp_f32 v35, v35
v_mfma_f32_16x16x32_bf16 v[208:211], a[48:51], v[56:59], v[208:211]
s_add_u32 s44, s44, 0x21212121
s_sub_u32 s44, s44, s45
v_cvt_pk_bf16_f32 v67, v34, v35
v_mfma_f32_16x16x32_bf16 v[240:243], a[48:51], v[60:63], v[240:243]
ds_read_b128 a[24:27], v2 offset:14336
s_bfe_u32 s56, s44, 0x80000
v_mfma_f32_16x16x32_bf16 v[244:247], a[52:55], v[60:63], v[244:247]
s_lshl_b32 s56, s56, 14
v_exp_f32 v36, v36
v_mfma_f32_16x16x32_bf16 v[212:215], a[52:55], v[56:59], v[212:215]
s_bfe_u32 s57, s44, 0x80008
v_exp_f32 v37, v37
v_mfma_f32_16x16x32_bf16 v[180:183], a[52:55], v[52:55], v[180:183]
s_lshl_b32 s57, s57, 14
v_exp_f32 v38, v38
v_mfma_f32_16x16x32_bf16 v[148:151], a[52:55], v[48:51], v[148:151]
buffer_load_dwordx4 v3, s[48:51], s32 offen offset:1024 sc1 lds
v_mfma_f32_16x16x32_bf16 v[152:155], a[56:59], v[48:51], v[152:155]
ds_read_b128 a[28:31], v2 offset:15360
v_cvt_pk_bf16_f32 v70, v36, v37
v_mfma_f32_16x16x32_bf16 v[184:187], a[56:59], v[52:55], v[184:187]
s_bfe_u32 s58, s44, 0x80010
s_lshl_b32 s58, s58, 14
s_bfe_u32 s59, s44, 0x80018
v_mfma_f32_16x16x32_bf16 v[216:219], a[56:59], v[56:59], v[216:219]
ds_read_b128 a[32:35], v2 offset:0
s_lshl_b32 s59, s59, 14
v_mfma_f32_16x16x32_bf16 v[248:251], a[56:59], v[60:63], v[248:251]
v_exp_f32 v39, v39
v_mfma_f32_16x16x32_bf16 v[252:255], a[60:63], v[60:63], v[252:255]
v_exp_f32 v40, v40
v_mfma_f32_16x16x32_bf16 v[220:223], a[60:63], v[56:59], v[220:223]
ds_read_b128 a[36:39], v2 offset:1024
v_cvt_pk_bf16_f32 v71, v38, v39
v_mfma_f32_16x16x32_bf16 v[188:191], a[60:63], v[52:55], v[188:191]
v_exp_f32 v41, v41
v_mfma_f32_16x16x32_bf16 v[156:159], a[60:63], v[48:51], v[156:159]
s_waitcnt lgkmcnt(6)
v_exp_f32 v42, v42
v_smfmac_f32_16x16x64_bf16 a[224:227], a[232:235], v[48:55], v9
buffer_load_dwordx4 v3, s[48:51], s32 offen offset:2048 sc1 lds
v_smfmac_f32_16x16x64_bf16 a[228:231], a[232:235], v[56:63], v9
ds_read_b128 a[40:43], v2 offset:2048
v_cvt_pk_bf16_f32 v74, v40, v41
v_mfma_f32_16x16x32_bf16 v[20:23], a[0:3], a[176:179], v[104:107]
v_mfma_f32_16x16x32_bf16 v[20:23], a[4:7], a[180:183], v[20:23]
v_exp_f32 v43, v43
v_mfma_f32_16x16x32_bf16 v[20:23], a[8:11], a[184:187], v[20:23]
ds_read_b128 a[44:47], v2 offset:3072
v_cvt_pk_bf16_f32 v75, v42, v43
v_mfma_f32_16x16x32_bf16 v[20:23], a[12:15], a[188:191], v[20:23]
v_exp_f32 v44, v44
v_mfma_f32_16x16x32_bf16 v[24:27], a[0:3], a[192:195], v[88:91]
v_exp_f32 v45, v45
v_mfma_f32_16x16x32_bf16 v[24:27], a[4:7], a[196:199], v[24:27]
ds_read_b128 a[48:51], v2 offset:4096
v_cvt_pk_bf16_f32 v78, v44, v45
v_mfma_f32_16x16x32_bf16 v[24:27], a[8:11], a[200:203], v[24:27]
v_mfma_f32_16x16x32_bf16 v[24:27], a[12:15], a[204:207], v[24:27]
v_exp_f32 v46, v46
v_mfma_f32_16x16x32_bf16 v[28:31], a[0:3], a[208:211], v[92:95]
buffer_load_dwordx4 v3, s[48:51], s32 offen offset:3072 sc1 lds
v_mfma_f32_16x16x32_bf16 v[28:31], a[4:7], a[212:215], v[28:31]
ds_read_b128 a[52:55], v2 offset:5120
v_mfma_f32_16x16x32_bf16 v[28:31], a[8:11], a[216:219], v[28:31]
v_exp_f32 v47, v47
v_mfma_f32_16x16x32_bf16 v[28:31], a[12:15], a[220:223], v[28:31]
s_waitcnt lgkmcnt(6)
v_exp_f32 v20, v20
v_mfma_f32_16x16x32_bf16 v[36:39], a[16:19], a[176:179], v[108:111]
ds_read_b128 a[56:59], v2 offset:6144
v_cvt_pk_bf16_f32 v79, v46, v47
v_mfma_f32_16x16x32_bf16 v[36:39], a[20:23], a[180:183], v[36:39]
v_exp_f32 v21, v21
v_mfma_f32_16x16x32_bf16 v[36:39], a[24:27], a[184:187], v[36:39]
v_cvt_pk_bf16_f32 v52, v20, v21
v_mfma_f32_16x16x32_bf16 v[36:39], a[28:31], a[188:191], v[36:39]
ds_read_b128 a[60:63], v2 offset:7168
v_mfma_f32_16x16x32_bf16 v[40:43], a[16:19], a[192:195], v[88:91]
s_mov_b32 s9, 0x600000
v_exp_f32 v22, v22
v_mfma_f32_16x16x32_bf16 v[40:43], a[20:23], a[196:199], v[40:43]
buffer_load_dword a244, v8, s[64:67], s9 offen
v_mfma_f32_16x16x32_bf16 v[40:43], a[24:27], a[200:203], v[40:43]
v_exp_f32 v23, v23
v_mfma_f32_16x16x32_bf16 v[40:43], a[28:31], a[204:207], v[40:43]
v_exp_f32 v24, v24
v_mfma_f32_16x16x32_bf16 v[44:47], a[16:19], a[208:211], v[92:95]
v_exp_f32 v25, v25
v_mfma_f32_16x16x32_bf16 v[44:47], a[20:23], a[212:215], v[44:47]
v_exp_f32 v26, v26
v_mfma_f32_16x16x32_bf16 v[44:47], a[24:27], a[216:219], v[44:47]
v_exp_f32 v27, v27
v_mfma_f32_16x16x32_bf16 v[44:47], a[28:31], a[220:223], v[44:47]
s_waitcnt lgkmcnt(0)
v_cvt_pk_bf16_f32 v53, v22, v23
v_mfma_f32_16x16x32_bf16 v[128:131], a[32:35], v[64:67], v[128:131]
ds_read_b128 a[0:3], v2 offset:24576
v_cvt_pk_bf16_f32 v56, v24, v25
v_mfma_f32_16x16x32_bf16 v[160:163], a[32:35], v[68:71], v[160:163]
v_exp_f32 v28, v28
v_mfma_f32_16x16x32_bf16 v[192:195], a[32:35], v[72:75], v[192:195]
ds_read_b128 a[4:7], v2 offset:25600
v_cvt_pk_bf16_f32 v57, v26, v27
v_mfma_f32_16x16x32_bf16 v[224:227], a[32:35], v[76:79], v[224:227]
s_add_u32 m0, s19, 0x1000
v_mfma_f32_16x16x32_bf16 v[228:231], a[36:39], v[76:79], v[228:231]
buffer_load_dwordx4 v3, s[48:51], s7 offen offset:0 sc1 lds
v_mfma_f32_16x16x32_bf16 v[196:199], a[36:39], v[72:75], v[196:199]
ds_read_b128 a[8:11], v2 offset:26624
v_mfma_f32_16x16x32_bf16 v[164:167], a[36:39], v[68:71], v[164:167]
v_exp_f32 v29, v29
v_mfma_f32_16x16x32_bf16 v[132:135], a[36:39], v[64:67], v[132:135]
v_exp_f32 v30, v30
v_mfma_f32_16x16x32_bf16 v[136:139], a[40:43], v[64:67], v[136:139]
ds_read_b128 a[12:15], v2 offset:27648
v_cvt_pk_bf16_f32 v60, v28, v29
v_mfma_f32_16x16x32_bf16 v[168:171], a[40:43], v[68:71], v[168:171]
v_exp_f32 v31, v31
v_mfma_f32_16x16x32_bf16 v[200:203], a[40:43], v[72:75], v[200:203]
v_exp_f32 v36, v36
v_mfma_f32_16x16x32_bf16 v[232:235], a[40:43], v[76:79], v[232:235]
ds_read_b128 a[16:19], v2 offset:28672
v_cvt_pk_bf16_f32 v61, v30, v31
v_mfma_f32_16x16x32_bf16 v[236:239], a[44:47], v[76:79], v[236:239]
buffer_load_dwordx4 v3, s[48:51], s7 offen offset:1024 sc1 lds
v_mfma_f32_16x16x32_bf16 v[204:207], a[44:47], v[72:75], v[204:207]
ds_read_b128 a[20:23], v2 offset:29696
v_mfma_f32_16x16x32_bf16 v[172:175], a[44:47], v[68:71], v[172:175]
v_mfma_f32_16x16x32_bf16 v[140:143], a[44:47], v[64:67], v[140:143]
v_exp_f32 v37, v37
v_mfma_f32_16x16x32_bf16 v[144:147], a[48:51], v[64:67], v[144:147]
ds_read_b128 a[24:27], v2 offset:30720
v_cvt_pk_bf16_f32 v54, v36, v37
v_mfma_f32_16x16x32_bf16 v[176:179], a[48:51], v[68:71], v[176:179]
v_exp_f32 v38, v38
v_mfma_f32_16x16x32_bf16 v[208:211], a[48:51], v[72:75], v[208:211]
v_exp_f32 v39, v39
v_mfma_f32_16x16x32_bf16 v[240:243], a[48:51], v[76:79], v[240:243]
ds_read_b128 a[28:31], v2 offset:31744
v_cvt_pk_bf16_f32 v55, v38, v39
v_mfma_f32_16x16x32_bf16 v[244:247], a[52:55], v[76:79], v[244:247]
v_exp_f32 v40, v40
v_mfma_f32_16x16x32_bf16 v[212:215], a[52:55], v[72:75], v[212:215]
buffer_load_dwordx4 v3, s[48:51], s7 offen offset:2048 sc1 lds
v_mfma_f32_16x16x32_bf16 v[180:183], a[52:55], v[68:71], v[180:183]
ds_read_b128 a[32:35], v2 offset:16384
v_mfma_f32_16x16x32_bf16 v[148:151], a[52:55], v[64:67], v[148:151]
v_mfma_f32_16x16x32_bf16 v[152:155], a[56:59], v[64:67], v[152:155]
ds_read_b128 a[36:39], v2 offset:17408
v_mfma_f32_16x16x32_bf16 v[184:187], a[56:59], v[68:71], v[184:187]
v_exp_f32 v41, v41
v_mfma_f32_16x16x32_bf16 v[216:219], a[56:59], v[72:75], v[216:219]
v_exp_f32 v42, v42
v_mfma_f32_16x16x32_bf16 v[248:251], a[56:59], v[76:79], v[248:251]
ds_read_b128 a[40:43], v2 offset:18432
v_cvt_pk_bf16_f32 v58, v40, v41
v_mfma_f32_16x16x32_bf16 v[252:255], a[60:63], v[76:79], v[252:255]
v_exp_f32 v43, v43
v_mfma_f32_16x16x32_bf16 v[220:223], a[60:63], v[72:75], v[220:223]
buffer_load_dwordx4 v3, s[48:51], s7 offen offset:3072 sc1 lds
v_mfma_f32_16x16x32_bf16 v[188:191], a[60:63], v[68:71], v[188:191]
ds_read_b128 a[44:47], v2 offset:19456
v_cvt_pk_bf16_f32 v59, v42, v43
v_mfma_f32_16x16x32_bf16 v[156:159], a[60:63], v[64:67], v[156:159]
v_exp_f32 v44, v44
v_smfmac_f32_16x16x64_bf16 a[224:227], a[232:235], v[64:71], v9
s_waitcnt lgkmcnt(8)
v_exp_f32 v45, v45
v_smfmac_f32_16x16x64_bf16 a[228:231], a[232:235], v[72:79], v9
ds_read_b128 a[48:51], v2 offset:20480
v_add_u32 v4, s0, v3
v_mfma_f32_16x16x32_bf16 v[24:27], a[0:3], a[192:195], v[88:91]
v_cvt_pk_bf16_f32 v62, v44, v45
v_mfma_f32_16x16x32_bf16 v[24:27], a[4:7], a[196:199], v[24:27]
ds_read_b128 a[52:55], v2 offset:21504
v_mov_b32 v5, s1
v_mfma_f32_16x16x32_bf16 v[24:27], a[8:11], a[200:203], v[24:27]
v_exp_f32 v46, v46
v_mfma_f32_16x16x32_bf16 v[24:27], a[12:15], a[204:207], v[24:27]
global_load_dword a244, v[4:5], off sc1
v_mfma_f32_16x16x32_bf16 v[28:31], a[0:3], a[208:211], v[92:95]
ds_read_b128 a[56:59], v2 offset:22528
v_mfma_f32_16x16x32_bf16 v[28:31], a[4:7], a[212:215], v[28:31]
s_add_u32 s32, s32, 0x8000
v_exp_f32 v47, v47
v_mfma_f32_16x16x32_bf16 v[28:31], a[8:11], a[216:219], v[28:31]
s_waitcnt lgkmcnt(7)
v_cvt_pk_bf16_f32 v63, v46, v47
v_mfma_f32_16x16x32_bf16 v[28:31], a[12:15], a[220:223], v[28:31]
ds_read_b128 a[60:63], v2 offset:23552
s_add_u32 s7, s7, 0x8000
v_mfma_f32_16x16x32_bf16 v[40:43], a[16:19], a[192:195], v[88:91]
s_xor_b32 s19, s19, 0x8000
v_xor_b32 v2, 0x38000, v2
v_mfma_f32_16x16x32_bf16 v[40:43], a[20:23], a[196:199], v[40:43]
s_sub_u32 s15, 7, s6
v_exp_f32 v24, v24
v_mfma_f32_16x16x32_bf16 v[40:43], a[24:27], a[200:203], v[40:43]
s_lshl_b32 s15, s15, 1
v_exp_f32 v25, v25
v_mfma_f32_16x16x32_bf16 v[40:43], a[28:31], a[204:207], v[40:43]
v_exp_f32 v26, v26
v_mfma_f32_16x16x32_bf16 v[44:47], a[16:19], a[208:211], v[92:95]
v_exp_f32 v27, v27
v_mfma_f32_16x16x32_bf16 v[44:47], a[20:23], a[212:215], v[44:47]
v_exp_f32 v28, v28
v_mfma_f32_16x16x32_bf16 v[44:47], a[24:27], a[216:219], v[44:47]
s_waitcnt vmcnt(22) lgkmcnt(0)
v_exp_f32 v29, v29
v_mfma_f32_16x16x32_bf16 v[44:47], a[28:31], a[220:223], v[44:47]
s_barrier
s_cbranch_scc0 L_att_lh0_1
v_mfma_f32_16x16x32_bf16 v[160:163], a[32:35], v[52:55], v[160:163]
ds_read_b128 a[0:3], v1 offset:8192
v_cvt_pk_bf16_f32 v72, v24, v25
v_mfma_f32_16x16x32_bf16 v[192:195], a[32:35], v[56:59], v[192:195]
v_exp_f32 v30, v30
v_mfma_f32_16x16x32_bf16 v[224:227], a[32:35], v[60:63], v[224:227]
ds_read_b128 a[4:7], v1 offset:9216
v_cvt_pk_bf16_f32 v73, v26, v27
v_mfma_f32_16x16x32_bf16 v[228:231], a[36:39], v[60:63], v[228:231]
s_add_u32 m0, s27, 0x0
v_cvt_pk_bf16_f32 v76, v28, v29
v_accvgpr_read_b32 v6, a224
v_mfma_f32_16x16x32_bf16 v[196:199], a[36:39], v[56:59], v[196:199]
buffer_load_dwordx4 v3, s[48:51], s32 offen offset:0 sc1 lds
v_mfma_f32_16x16x32_bf16 v[164:167], a[36:39], v[52:55], v[164:167]
ds_read_b128 a[8:11], v1 offset:10240
v_accvgpr_read_b32 v7, a225
v_mfma_f32_16x16x32_bf16 v[168:171], a[40:43], v[52:55], v[168:171]
ds_read_b128 a[12:15], v1 offset:11264
v_add_f32 v6, v6, v7
v_mfma_f32_16x16x32_bf16 v[200:203], a[40:43], v[56:59], v[200:203]
v_exp_f32 v31, v31
v_mfma_f32_16x16x32_bf16 v[232:235], a[40:43], v[60:63], v[232:235]
v_exp_f32 v40, v40
v_mfma_f32_16x16x32_bf16 v[236:239], a[44:47], v[60:63], v[236:239]
ds_read_b128 a[16:19], v1 offset:12288
v_cvt_pk_bf16_f32 v77, v30, v31
v_mfma_f32_16x16x32_bf16 v[204:207], a[44:47], v[56:59], v[204:207]
v_cmp_nge_f32 vcc, 0x5f800000, v6
v_mfma_f32_16x16x32_bf16 v[172:175], a[44:47], v[52:55], v[172:175]
ds_read_b128 a[20:23], v1 offset:13312
v_mfma_f32_16x16x32_bf16 v[176:179], a[48:51], v[52:55], v[176:179]
v_exp_f32 v41, v41
v_mfma_f32_16x16x32_bf16 v[208:211], a[48:51], v[56:59], v[208:211]
ds_read_b128 a[24:27], v1 offset:14336
v_cvt_pk_bf16_f32 v74, v40, v41
v_mfma_f32_16x16x32_bf16 v[240:243], a[48:51], v[60:63], v[240:243]
buffer_load_dwordx4 v3, s[48:51], s32 offen offset:1024 sc1 lds
v_mfma_f32_16x16x32_bf16 v[244:247], a[52:55], v[60:63], v[244:247]
v_exp_f32 v42, v42
v_mfma_f32_16x16x32_bf16 v[212:215], a[52:55], v[56:59], v[212:215]
ds_read_b128 a[28:31], v1 offset:15360
v_mfma_f32_16x16x32_bf16 v[180:183], a[52:55], v[52:55], v[180:183]
v_exp_f32 v43, v43
v_mfma_f32_16x16x32_bf16 v[184:187], a[56:59], v[52:55], v[184:187]
ds_read_b128 a[32:35], v1 offset:0
v_cvt_pk_bf16_f32 v75, v42, v43
v_mfma_f32_16x16x32_bf16 v[216:219], a[56:59], v[56:59], v[216:219]
v_rcp_f32 v6, v6
v_mfma_f32_16x16x32_bf16 v[248:251], a[56:59], v[60:63], v[248:251]
ds_read_b128 a[36:39], v1 offset:1024
s_or_b64 s[34:35], s[34:35], vcc
v_mfma_f32_16x16x32_bf16 v[252:255], a[60:63], v[60:63], v[252:255]
s_add_u32 s8, s28, 0x0
v_exp_f32 v44, v44
v_mfma_f32_16x16x32_bf16 v[220:223], a[60:63], v[56:59], v[220:223]
v_exp_f32 v45, v45
v_mfma_f32_16x16x32_bf16 v[188:191], a[60:63], v[52:55], v[188:191]
ds_read_b128 a[40:43], v1 offset:2048
v_cvt_pk_bf16_f32 v78, v44, v45
v_mfma_f32_16x16x32_bf16 a[224:227], a[236:239], v[52:55], a[224:227]
buffer_load_dwordx4 v3, s[48:51], s32 offen offset:2048 sc1 lds
v_smfmac_f32_16x16x64_bf16 a[228:231], a[232:235], v[56:63], v9
ds_read_b128 a[44:47], v1 offset:3072
s_waitcnt lgkmcnt(8)
v_mfma_f32_16x16x32_bf16 v[24:27], a[0:3], a[192:195], v[88:91]
v_exp_f32 v46, v46
v_mfma_f32_16x16x32_bf16 v[24:27], a[4:7], a[196:199], v[24:27]
ds_read_b128 a[48:51], v1 offset:4096
v_mul_f32 v128, v6, v128
v_mfma_f32_16x16x32_bf16 v[24:27], a[8:11], a[200:203], v[24:27]
v_mul_f32 v129, v6, v129
v_mul_f32 v130, v6, v130
v_mfma_f32_16x16x32_bf16 v[24:27], a[12:15], a[204:207], v[24:27]
v_exp_f32 v47, v47
v_mfma_f32_16x16x32_bf16 v[28:31], a[0:3], a[208:211], v[92:95]
ds_read_b128 a[52:55], v1 offset:5120
v_cvt_pk_bf16_f32 v79, v46, v47
v_mfma_f32_16x16x32_bf16 v[28:31], a[4:7], a[212:215], v[28:31]
v_mul_f32 v131, v6, v131
v_mul_f32 v132, v6, v132
v_mfma_f32_16x16x32_bf16 v[28:31], a[8:11], a[216:219], v[28:31]
ds_read_b128 a[56:59], v1 offset:6144
v_mul_f32 v133, v6, v133
v_mfma_f32_16x16x32_bf16 v[28:31], a[12:15], a[220:223], v[28:31]
s_waitcnt lgkmcnt(7)
v_exp_f32 v24, v24
v_mfma_f32_16x16x32_bf16 v[40:43], a[16:19], a[192:195], v[88:91]
buffer_load_dwordx4 v3, s[48:51], s32 offen offset:3072 sc1 lds
v_mfma_f32_16x16x32_bf16 v[40:43], a[20:23], a[196:199], v[40:43]
ds_read_b128 a[60:63], v1 offset:7168
v_mul_f32 v134, v6, v134
v_mfma_f32_16x16x32_bf16 v[40:43], a[24:27], a[200:203], v[40:43]
s_add_u32 s32, s32, 0x8000
v_exp_f32 v25, v25
v_mfma_f32_16x16x32_bf16 v[40:43], a[28:31], a[204:207], v[40:43]
v_exp_f32 v26, v26
v_mfma_f32_16x16x32_bf16 v[44:47], a[16:19], a[208:211], v[92:95]
v_exp_f32 v27, v27
v_mfma_f32_16x16x32_bf16 v[44:47], a[20:23], a[212:215], v[44:47]
v_exp_f32 v28, v28
v_mfma_f32_16x16x32_bf16 v[44:47], a[24:27], a[216:219], v[44:47]
v_exp_f32 v29, v29
v_mfma_f32_16x16x32_bf16 v[44:47], a[28:31], a[220:223], v[44:47]
s_waitcnt lgkmcnt(0)
v_mul_f32 v135, v6, v135
v_cvt_pk_bf16_f32 v128, v128, v129
v_mfma_f32_16x16x32_bf16 v[192:195], a[32:35], v[72:75], v[192:195]
s_add_u32 m0, s27, 0x1000
v_exp_f32 v30, v30
v_mfma_f32_16x16x32_bf16 v[224:227], a[32:35], v[76:79], v[224:227]
buffer_load_dwordx4 v3, s[48:51], s7 offen offset:0 sc1 lds
v_mfma_f32_16x16x32_bf16 v[228:231], a[36:39], v[76:79], v[228:231]
v_exp_f32 v31, v31
v_mfma_f32_16x16x32_bf16 v[196:199], a[36:39], v[72:75], v[196:199]
ds_read_b128 a[0:3], v1 offset:24576
v_cvt_pk_bf16_f32 v56, v24, v25
v_mfma_f32_16x16x32_bf16 v[200:203], a[40:43], v[72:75], v[200:203]
ds_read_b128 a[4:7], v1 offset:25600
v_cvt_pk_bf16_f32 v57, v26, v27
v_mfma_f32_16x16x32_bf16 v[232:235], a[40:43], v[76:79], v[232:235]
v_exp_f32 v40, v40
v_mfma_f32_16x16x32_bf16 v[236:239], a[44:47], v[76:79], v[236:239]
ds_read_b128 a[8:11], v1 offset:26624
v_cvt_pk_bf16_f32 v60, v28, v29
v_mfma_f32_16x16x32_bf16 v[204:207], a[44:47], v[72:75], v[204:207]
v_exp_f32 v41, v41
v_mfma_f32_16x16x32_bf16 v[208:211], a[48:51], v[72:75], v[208:211]
ds_read_b128 a[12:15], v1 offset:27648
v_cvt_pk_bf16_f32 v61, v30, v31
v_mfma_f32_16x16x32_bf16 v[240:243], a[48:51], v[76:79], v[240:243]
ds_read_b128 a[16:19], v1 offset:28672
v_cvt_pk_bf16_f32 v58, v40, v41
v_mfma_f32_16x16x32_bf16 v[244:247], a[52:55], v[76:79], v[244:247]
v_exp_f32 v42, v42
v_mfma_f32_16x16x32_bf16 v[212:215], a[52:55], v[72:75], v[212:215]
buffer_load_dwordx4 v3, s[48:51], s7 offen offset:1024 sc1 lds
v_mfma_f32_16x16x32_bf16 v[216:219], a[56:59], v[72:75], v[216:219]
ds_read_b128 a[20:23], v1 offset:29696
v_cvt_pk_bf16_f32 v129, v130, v131
v_mfma_f32_16x16x32_bf16 v[248:251], a[56:59], v[76:79], v[248:251]
ds_read_b128 a[24:27], v1 offset:30720
v_cvt_pk_bf16_f32 v130, v132, v133
v_mfma_f32_16x16x32_bf16 v[252:255], a[60:63], v[76:79], v[252:255]
ds_read_b128 a[28:31], v1 offset:31744
v_cvt_pk_bf16_f32 v131, v134, v135
v_mfma_f32_16x16x32_bf16 v[220:223], a[60:63], v[72:75], v[220:223]
s_waitcnt lgkmcnt(4)
v_exp_f32 v43, v43
v_smfmac_f32_16x16x64_bf16 a[228:231], a[232:235], v[72:79], v9
ds_read_b128 a[32:35], v1 offset:16384
v_cvt_pk_bf16_f32 v59, v42, v43
v_mfma_f32_16x16x32_bf16 v[24:27], a[0:3], a[192:195], v[88:91]
ds_read_b128 a[36:39], v1 offset:17408
buffer_store_dwordx4 v[128:131], v3, s[88:91], s8 offen sc1
v_mfma_f32_16x16x32_bf16 v[24:27], a[4:7], a[196:199], v[24:27]
buffer_load_dwordx4 v3, s[48:51], s7 offen offset:2048 sc1 lds
v_mfma_f32_16x16x32_bf16 v[24:27], a[8:11], a[200:203], v[24:27]
ds_read_b128 a[40:43], v1 offset:18432
v_exp_f32 v44, v44
v_mfma_f32_16x16x32_bf16 v[24:27], a[12:15], a[204:207], v[24:27]
ds_read_b128 a[44:47], v1 offset:19456
v_exp_f32 v45, v45
v_mfma_f32_16x16x32_bf16 v[28:31], a[0:3], a[208:211], v[92:95]
ds_read_b128 a[48:51], v1 offset:20480
v_exp_f32 v46, v46
v_mfma_f32_16x16x32_bf16 v[28:31], a[4:7], a[212:215], v[28:31]
s_waitcnt lgkmcnt(5)
v_exp_f32 v47, v47
v_mfma_f32_16x16x32_bf16 v[28:31], a[8:11], a[216:219], v[28:31]
ds_read_b128 a[52:55], v1 offset:21504
v_cvt_pk_bf16_f32 v62, v44, v45
v_mfma_f32_16x16x32_bf16 v[28:31], a[12:15], a[220:223], v[28:31]
ds_read_b128 a[56:59], v1 offset:22528
v_cvt_pk_bf16_f32 v63, v46, v47
v_mfma_f32_16x16x32_bf16 v[40:43], a[16:19], a[192:195], v[88:91]
ds_read_b128 a[60:63], v1 offset:23552
v_xor_b32 v1, 0x8000, v1
v_mfma_f32_16x16x32_bf16 v[40:43], a[20:23], a[196:199], v[40:43]
buffer_load_dwordx4 v3, s[48:51], s7 offen offset:3072 sc1 lds
v_mfma_f32_16x16x32_bf16 v[40:43], a[24:27], a[200:203], v[40:43]
s_add_u32 s7, s7, 0x8000
v_exp_f32 v24, v24
v_mfma_f32_16x16x32_bf16 v[40:43], a[28:31], a[204:207], v[40:43]
s_xor_b32 s27, s27, 0x38000
v_exp_f32 v25, v25
v_mfma_f32_16x16x32_bf16 v[44:47], a[16:19], a[208:211], v[92:95]
s_add_u32 s8, s28, 0x2000
v_exp_f32 v26, v26
v_mfma_f32_16x16x32_bf16 v[44:47], a[20:23], a[212:215], v[44:47]
v_exp_f32 v27, v27
v_mfma_f32_16x16x32_bf16 v[44:47], a[24:27], a[216:219], v[44:47]
s_waitcnt vmcnt(19) lgkmcnt(0)
v_exp_f32 v28, v28
v_mfma_f32_16x16x32_bf16 v[44:47], a[28:31], a[220:223], v[44:47]
s_barrier
v_exp_f32 v29, v29
v_mul_f32 v136, v6, v136
v_mul_f32 v137, v6, v137
v_mul_f32 v138, v6, v138
v_mul_f32 v139, v6, v139
v_mul_f32 v140, v6, v140
v_mul_f32 v141, v6, v141
v_mul_f32 v142, v6, v142
v_mul_f32 v143, v6, v143
v_cvt_pk_bf16_f32 v136, v136, v137
v_cvt_pk_bf16_f32 v137, v138, v139
v_cvt_pk_bf16_f32 v138, v140, v141
v_cvt_pk_bf16_f32 v139, v142, v143
buffer_store_dwordx4 v[136:139], v3, s[88:91], s8 offen sc1
s_add_u32 s8, s28, 0x4000
v_mul_f32 v144, v6, v144
v_mul_f32 v145, v6, v145
v_mul_f32 v146, v6, v146
v_mul_f32 v147, v6, v147
v_mul_f32 v148, v6, v148
v_mul_f32 v149, v6, v149
v_mul_f32 v150, v6, v150
v_mul_f32 v151, v6, v151
v_cvt_pk_bf16_f32 v144, v144, v145
v_cvt_pk_bf16_f32 v145, v146, v147
v_cvt_pk_bf16_f32 v146, v148, v149
v_cvt_pk_bf16_f32 v147, v150, v151
buffer_store_dwordx4 v[144:147], v3, s[88:91], s8 offen sc1
s_add_u32 s8, s28, 0x6000
v_mul_f32 v152, v6, v152
v_mul_f32 v153, v6, v153
v_mul_f32 v154, v6, v154
v_mul_f32 v155, v6, v155
v_mul_f32 v156, v6, v156
v_mul_f32 v157, v6, v157
v_mul_f32 v158, v6, v158
v_mul_f32 v159, v6, v159
v_cvt_pk_bf16_f32 v152, v152, v153
v_cvt_pk_bf16_f32 v153, v154, v155
v_cvt_pk_bf16_f32 v154, v156, v157
v_cvt_pk_bf16_f32 v155, v158, v159
buffer_store_dwordx4 v[152:155], v3, s[88:91], s8 offen sc1
v_accvgpr_read_b32 v6, a226
v_accvgpr_read_b32 v7, a227
v_add_f32 v6, v6, v7
v_cmp_nge_f32 vcc, 0x5f800000, v6
v_rcp_f32 v6, v6
s_or_b64 s[34:35], s[34:35], vcc
s_add_u32 s8, s29, 0x0
v_pk_mul_f32 v[160:161], v[160:161], v[6:7] op_sel_hi:[1,0]
v_pk_mul_f32 v[162:163], v[162:163], v[6:7] op_sel_hi:[1,0]
v_pk_mul_f32 v[164:165], v[164:165], v[6:7] op_sel_hi:[1,0]
v_pk_mul_f32 v[166:167], v[166:167], v[6:7] op_sel_hi:[1,0]
v_cvt_pk_bf16_f32 v160, v160, v161
v_cvt_pk_bf16_f32 v161, v162, v163
v_cvt_pk_bf16_f32 v162, v164, v165
v_cvt_pk_bf16_f32 v163, v166, v167
buffer_store_dwordx4 v[160:163], v3, s[88:91], s8 offen sc1
s_add_u32 s8, s29, 0x2000
v_pk_mul_f32 v[168:169], v[168:169], v[6:7] op_sel_hi:[1,0]
v_pk_mul_f32 v[170:171], v[170:171], v[6:7] op_sel_hi:[1,0]
v_pk_mul_f32 v[172:173], v[172:173], v[6:7] op_sel_hi:[1,0]
v_pk_mul_f32 v[174:175], v[174:175], v[6:7] op_sel_hi:[1,0]
v_cvt_pk_bf16_f32 v168, v168, v169
v_cvt_pk_bf16_f32 v169, v170, v171
v_cvt_pk_bf16_f32 v170, v172, v173
v_cvt_pk_bf16_f32 v171, v174, v175
buffer_store_dwordx4 v[168:171], v3, s[88:91], s8 offen sc1
s_add_u32 s8, s29, 0x4000
v_pk_mul_f32 v[176:177], v[176:177], v[6:7] op_sel_hi:[1,0]
v_pk_mul_f32 v[178:179], v[178:179], v[6:7] op_sel_hi:[1,0]
v_pk_mul_f32 v[180:181], v[180:181], v[6:7] op_sel_hi:[1,0]
v_pk_mul_f32 v[182:183], v[182:183], v[6:7] op_sel_hi:[1,0]
v_cvt_pk_bf16_f32 v176, v176, v177
v_cvt_pk_bf16_f32 v177, v178, v179
v_cvt_pk_bf16_f32 v178, v180, v181
v_cvt_pk_bf16_f32 v179, v182, v183
buffer_store_dwordx4 v[176:179], v3, s[88:91], s8 offen sc1
s_add_u32 s8, s29, 0x6000
v_pk_mul_f32 v[184:185], v[184:185], v[6:7] op_sel_hi:[1,0]
v_pk_mul_f32 v[186:187], v[186:187], v[6:7] op_sel_hi:[1,0]
v_pk_mul_f32 v[188:189], v[188:189], v[6:7] op_sel_hi:[1,0]
v_pk_mul_f32 v[190:191], v[190:191], v[6:7] op_sel_hi:[1,0]
v_cvt_pk_bf16_f32 v184, v184, v185
v_cvt_pk_bf16_f32 v185, v186, v187
v_cvt_pk_bf16_f32 v186, v188, v189
v_cvt_pk_bf16_f32 v187, v190, v191
buffer_store_dwordx4 v[184:187], v3, s[88:91], s8 offen sc1
s_getreg_b32 s8, hwreg(HW_REG_HW_ID, 5, 1)
s_cmp_lg_u32 s8, 0
s_cbranch_scc1 L_att_sodd1
s_branch L_att_sodd0
L_att_lh0_1:
v_mfma_f32_16x16x32_bf16 v[160:163], a[32:35], v[52:55], v[160:163]
ds_read_b128 a[0:3], v1 offset:8192
v_cvt_pk_bf16_f32 v72, v24, v25
v_mfma_f32_16x16x32_bf16 v[192:195], a[32:35], v[56:59], v[192:195]
v_exp_f32 v30, v30
v_mfma_f32_16x16x32_bf16 v[224:227], a[32:35], v[60:63], v[224:227]
buffer_load_dword v14, v15, s[84:87], 0 offen offset:192 sc1
v_mfma_f32_16x16x32_bf16 v[228:231], a[36:39], v[60:63], v[228:231]
ds_read_b128 a[4:7], v1 offset:9216
v_cvt_pk_bf16_f32 v73, v26, v27
v_mfma_f32_16x16x32_bf16 v[196:199], a[36:39], v[56:59], v[196:199]
ds_read_b128 a[8:11], v1 offset:10240
v_cvt_pk_bf16_f32 v76, v28, v29
v_mfma_f32_16x16x32_bf16 v[164:167], a[36:39], v[52:55], v[164:167]
s_add_u32 m0, s17, 0x10000
v_exp_f32 v31, v31
v_mfma_f32_16x16x32_bf16 v[168:171], a[40:43], v[52:55], v[168:171]
buffer_load_dwordx4 v12, s[72:75], 0 offen lds
v_mfma_f32_16x16x32_bf16 v[200:203], a[40:43], v[56:59], v[200:203]
ds_read_b128 a[12:15], v1 offset:11264
v_cvt_pk_bf16_f32 v77, v30, v31
v_mfma_f32_16x16x32_bf16 v[232:235], a[40:43], v[60:63], v[232:235]
v_exp_f32 v40, v40
v_mfma_f32_16x16x32_bf16 v[236:239], a[44:47], v[60:63], v[236:239]
ds_read_b128 a[16:19], v1 offset:12288
v_mfma_f32_16x16x32_bf16 v[204:207], a[44:47], v[56:59], v[204:207]
v_exp_f32 v41, v41
v_mfma_f32_16x16x32_bf16 v[172:175], a[44:47], v[52:55], v[172:175]
buffer_load_dwordx4 v13, s[72:75], 0 offen offset:1024 lds
v_mfma_f32_16x16x32_bf16 v[176:179], a[48:51], v[52:55], v[176:179]
ds_read_b128 a[20:23], v1 offset:13312
v_cvt_pk_bf16_f32 v74, v40, v41
v_mfma_f32_16x16x32_bf16 v[208:211], a[48:51], v[56:59], v[208:211]
ds_read_b128 a[24:27], v1 offset:14336
v_mfma_f32_16x16x32_bf16 v[240:243], a[48:51], v[60:63], v[240:243]
v_exp_f32 v42, v42
v_mfma_f32_16x16x32_bf16 v[244:247], a[52:55], v[60:63], v[244:247]
buffer_load_dwordx4 v12, s[72:75], s12 offen offset:2048 lds
v_mfma_f32_16x16x32_bf16 v[212:215], a[52:55], v[56:59], v[212:215]
ds_read_b128 a[28:31], v1 offset:15360
v_mfma_f32_16x16x32_bf16 v[180:183], a[52:55], v[52:55], v[180:183]
v_exp_f32 v43, v43
v_mfma_f32_16x16x32_bf16 v[184:187], a[56:59], v[52:55], v[184:187]
ds_read_b128 a[32:35], v1 offset:0
v_cvt_pk_bf16_f32 v75, v42, v43
v_mfma_f32_16x16x32_bf16 v[216:219], a[56:59], v[56:59], v[216:219]
v_exp_f32 v44, v44
v_mfma_f32_16x16x32_bf16 v[248:251], a[56:59], v[60:63], v[248:251]
buffer_load_dwordx4 v13, s[72:75], s12 offen offset:3072 lds
v_mfma_f32_16x16x32_bf16 v[252:255], a[60:63], v[60:63], v[252:255]
ds_read_b128 a[36:39], v1 offset:1024
v_mfma_f32_16x16x32_bf16 v[220:223], a[60:63], v[56:59], v[220:223]
s_add_u32 m0, s17, 0x14000
v_exp_f32 v45, v45
v_mfma_f32_16x16x32_bf16 v[188:191], a[60:63], v[52:55], v[188:191]
ds_read_b128 a[40:43], v1 offset:2048
v_add_u32 v12, 0x20000, v12
v_mfma_f32_16x16x32_bf16 a[224:227], a[236:239], v[52:55], a[224:227]
buffer_load_dwordx4 v12, s[72:75], 0 offen lds
v_smfmac_f32_16x16x64_bf16 a[228:231], a[232:235], v[56:63], v9
ds_read_b128 a[44:47], v1 offset:3072
s_waitcnt lgkmcnt(8)
v_mfma_f32_16x16x32_bf16 v[24:27], a[0:3], a[192:195], v[88:91]
v_exp_f32 v46, v46
v_mfma_f32_16x16x32_bf16 v[24:27], a[4:7], a[196:199], v[24:27]
ds_read_b128 a[48:51], v1 offset:4096
v_add_u32 v13, 0x20000, v13
v_mfma_f32_16x16x32_bf16 v[24:27], a[8:11], a[200:203], v[24:27]
buffer_load_dwordx4 v13, s[72:75], 0 offen offset:1024 lds
v_mfma_f32_16x16x32_bf16 v[24:27], a[12:15], a[204:207], v[24:27]
v_exp_f32 v47, v47
v_mfma_f32_16x16x32_bf16 v[28:31], a[0:3], a[208:211], v[92:95]
ds_read_b128 a[52:55], v1 offset:5120
v_cvt_pk_bf16_f32 v78, v44, v45
v_mfma_f32_16x16x32_bf16 v[28:31], a[4:7], a[212:215], v[28:31]
s_waitcnt lgkmcnt(6)
v_cvt_pk_bf16_f32 v79, v46, v47
v_mfma_f32_16x16x32_bf16 v[28:31], a[8:11], a[216:219], v[28:31]
ds_read_b128 a[56:59], v1 offset:6144
v_mfma_f32_16x16x32_bf16 v[28:31], a[12:15], a[220:223], v[28:31]
buffer_load_dwordx4 v12, s[72:75], s12 offen offset:2048 lds
v_mfma_f32_16x16x32_bf16 v[40:43], a[16:19], a[192:195], v[88:91]
ds_read_b128 a[60:63], v1 offset:7168
v_mfma_f32_16x16x32_bf16 v[40:43], a[20:23], a[196:199], v[40:43]
v_exp_f32 v24, v24
v_mfma_f32_16x16x32_bf16 v[40:43], a[24:27], a[200:203], v[40:43]
v_exp_f32 v25, v25
v_mfma_f32_16x16x32_bf16 v[40:43], a[28:31], a[204:207], v[40:43]
buffer_load_dwordx4 v13, s[72:75], s12 offen offset:3072 lds
v_mfma_f32_16x16x32_bf16 v[44:47], a[16:19], a[208:211], v[92:95]
v_exp_f32 v26, v26
v_mfma_f32_16x16x32_bf16 v[44:47], a[20:23], a[212:215], v[44:47]
v_exp_f32 v27, v27
v_mfma_f32_16x16x32_bf16 v[44:47], a[24:27], a[216:219], v[44:47]
v_exp_f32 v28, v28
v_mfma_f32_16x16x32_bf16 v[44:47], a[28:31], a[220:223], v[44:47]
s_waitcnt lgkmcnt(0)
v_exp_f32 v29, v29
v_mfma_f32_16x16x32_bf16 v[192:195], a[32:35], v[72:75], v[192:195]
s_add_u32 m0, s16, 0x0
v_add_u32 v12, 0x20000, v12
v_cvt_pk_bf16_f32 v56, v24, v25
v_mfma_f32_16x16x32_bf16 v[224:227], a[32:35], v[76:79], v[224:227]
buffer_load_dwordx4 v12, s[72:75], 0 offen lds
v_mfma_f32_16x16x32_bf16 v[228:231], a[36:39], v[76:79], v[228:231]
ds_read_b128 a[0:3], v1 offset:24576
v_cvt_pk_bf16_f32 v57, v26, v27
v_mfma_f32_16x16x32_bf16 v[196:199], a[36:39], v[72:75], v[196:199]
v_exp_f32 v30, v30
v_mfma_f32_16x16x32_bf16 v[200:203], a[40:43], v[72:75], v[200:203]
ds_read_b128 a[4:7], v1 offset:25600
v_cvt_pk_bf16_f32 v60, v28, v29
v_mfma_f32_16x16x32_bf16 v[232:235], a[40:43], v[76:79], v[232:235]
ds_read_b128 a[8:11], v1 offset:26624
v_add_u32 v13, 0x20000, v13
v_mfma_f32_16x16x32_bf16 v[236:239], a[44:47], v[76:79], v[236:239]
buffer_load_dwordx4 v13, s[72:75], 0 offen offset:1024 lds
v_mfma_f32_16x16x32_bf16 v[204:207], a[44:47], v[72:75], v[204:207]
ds_read_b128 a[12:15], v1 offset:27648
v_exp_f32 v31, v31
v_mfma_f32_16x16x32_bf16 v[208:211], a[48:51], v[72:75], v[208:211]
buffer_load_dwordx4 v12, s[72:75], s12 offen offset:2048 lds
v_mfma_f32_16x16x32_bf16 v[240:243], a[48:51], v[76:79], v[240:243]
ds_read_b128 a[16:19], v1 offset:28672
v_exp_f32 v40, v40
v_mfma_f32_16x16x32_bf16 v[244:247], a[52:55], v[76:79], v[244:247]
ds_read_b128 a[20:23], v1 offset:29696
v_cvt_pk_bf16_f32 v61, v30, v31
v_mfma_f32_16x16x32_bf16 v[212:215], a[52:55], v[72:75], v[212:215]
buffer_load_dwordx4 v13, s[72:75], s12 offen offset:3072 lds
v_mfma_f32_16x16x32_bf16 v[216:219], a[56:59], v[72:75], v[216:219]
ds_read_b128 a[24:27], v1 offset:30720
v_exp_f32 v41, v41
v_mfma_f32_16x16x32_bf16 v[248:251], a[56:59], v[76:79], v[248:251]
ds_read_b128 a[28:31], v1 offset:31744
v_exp_f32 v42, v42
v_mfma_f32_16x16x32_bf16 v[252:255], a[60:63], v[76:79], v[252:255]
ds_read_b128 a[32:35], v1 offset:16384
v_cvt_pk_bf16_f32 v58, v40, v41
v_mfma_f32_16x16x32_bf16 v[220:223], a[60:63], v[72:75], v[220:223]
s_waitcnt lgkmcnt(5)
v_exp_f32 v43, v43
v_smfmac_f32_16x16x64_bf16 a[228:231], a[232:235], v[72:79], v9
ds_read_b128 a[36:39], v1 offset:17408
v_add_u32 v12, 0x20000, v12
v_mfma_f32_16x16x32_bf16 v[24:27], a[0:3], a[192:195], v[112:115]
s_add_u32 m0, s16, 0x4000
v_exp_f32 v44, v44
v_mfma_f32_16x16x32_bf16 v[24:27], a[4:7], a[196:199], v[24:27]
buffer_load_dwordx4 v12, s[72:75], 0 offen lds
v_mfma_f32_16x16x32_bf16 v[24:27], a[8:11], a[200:203], v[24:27]
ds_read_b128 a[40:43], v1 offset:18432
v_add_u32 v13, 0x20000, v13
v_mfma_f32_16x16x32_bf16 v[24:27], a[12:15], a[204:207], v[24:27]
buffer_load_dwordx4 v13, s[72:75], 0 offen offset:1024 lds
v_mfma_f32_16x16x32_bf16 v[28:31], a[0:3], a[208:211], v[92:95]
ds_read_b128 a[44:47], v1 offset:19456
v_cvt_pk_bf16_f32 v59, v42, v43
v_mfma_f32_16x16x32_bf16 v[28:31], a[4:7], a[212:215], v[28:31]
ds_read_b128 a[48:51], v1 offset:20480
v_exp_f32 v45, v45
v_mfma_f32_16x16x32_bf16 v[28:31], a[8:11], a[216:219], v[28:31]
s_waitcnt lgkmcnt(5)
v_exp_f32 v46, v46
v_mfma_f32_16x16x32_bf16 v[28:31], a[12:15], a[220:223], v[28:31]
buffer_load_dwordx4 v12, s[72:75], s12 offen offset:2048 lds
v_mfma_f32_16x16x32_bf16 v[40:43], a[16:19], a[192:195], v[116:119]
ds_read_b128 a[52:55], v1 offset:21504
v_exp_f32 v47, v47
v_mfma_f32_16x16x32_bf16 v[40:43], a[20:23], a[196:199], v[40:43]
ds_read_b128 a[56:59], v1 offset:22528
v_exp_f32 v24, v24
v_mfma_f32_16x16x32_bf16 v[40:43], a[24:27], a[200:203], v[40:43]
ds_read_b128 a[60:63], v1 offset:23552
v_xor_b32 v1, 0x8000, v1
v_mfma_f32_16x16x32_bf16 v[40:43], a[28:31], a[204:207], v[40:43]
v_exp_f32 v25, v25
v_cvt_pk_bf16_f32 v62, v44, v45
v_cvt_pk_bf16_f32 v63, v46, v47
v_mfma_f32_16x16x32_bf16 v[44:47], a[16:19], a[208:211], v[92:95]
v_exp_f32 v26, v26
v_mfma_f32_16x16x32_bf16 v[44:47], a[20:23], a[212:215], v[44:47]
buffer_load_dwordx4 v13, s[72:75], s12 offen offset:3072 lds
v_mfma_f32_16x16x32_bf16 v[44:47], a[24:27], a[216:219], v[44:47]
v_exp_f32 v27, v27
v_mfma_f32_16x16x32_bf16 v[44:47], a[28:31], a[220:223], v[44:47]
v_exp_f32 v28, v28
v_exp_f32 v29, v29
v_accvgpr_read_b32 v6, a224
v_accvgpr_read_b32 v7, a225
v_add_f32 v6, v6, v7
v_cmp_nge_f32 vcc, 0x5f800000, v6
v_rcp_f32 v6, v6
s_or_b64 s[34:35], s[34:35], vcc
s_add_u32 s8, s28, 0x0
v_pk_mul_f32 v[128:129], v[128:129], v[6:7] op_sel_hi:[1,0]
v_pk_mul_f32 v[130:131], v[130:131], v[6:7] op_sel_hi:[1,0]
v_pk_mul_f32 v[132:133], v[132:133], v[6:7] op_sel_hi:[1,0]
v_pk_mul_f32 v[134:135], v[134:135], v[6:7] op_sel_hi:[1,0]
v_cvt_pk_bf16_f32 v128, v128, v129
v_cvt_pk_bf16_f32 v129, v130, v131
v_cvt_pk_bf16_f32 v130, v132, v133
v_cvt_pk_bf16_f32 v131, v134, v135
buffer_store_dwordx4 v[128:131], v3, s[88:91], s8 offen sc1
s_add_u32 s8, s28, 0x2000
v_pk_mul_f32 v[136:137], v[136:137], v[6:7] op_sel_hi:[1,0]
v_pk_mul_f32 v[138:139], v[138:139], v[6:7] op_sel_hi:[1,0]
v_pk_mul_f32 v[140:141], v[140:141], v[6:7] op_sel_hi:[1,0]
v_pk_mul_f32 v[142:143], v[142:143], v[6:7] op_sel_hi:[1,0]
v_cvt_pk_bf16_f32 v136, v136, v137
v_cvt_pk_bf16_f32 v137, v138, v139
v_cvt_pk_bf16_f32 v138, v140, v141
v_cvt_pk_bf16_f32 v139, v142, v143
buffer_store_dwordx4 v[136:139], v3, s[88:91], s8 offen sc1
s_add_u32 s8, s28, 0x4000
v_pk_mul_f32 v[144:145], v[144:145], v[6:7] op_sel_hi:[1,0]
v_pk_mul_f32 v[146:147], v[146:147], v[6:7] op_sel_hi:[1,0]
v_pk_mul_f32 v[148:149], v[148:149], v[6:7] op_sel_hi:[1,0]
v_pk_mul_f32 v[150:151], v[150:151], v[6:7] op_sel_hi:[1,0]
v_cvt_pk_bf16_f32 v144, v144, v145
v_cvt_pk_bf16_f32 v145, v146, v147
v_cvt_pk_bf16_f32 v146, v148, v149
v_cvt_pk_bf16_f32 v147, v150, v151
buffer_store_dwordx4 v[144:147], v3, s[88:91], s8 offen sc1
s_add_u32 s8, s28, 0x6000
v_pk_mul_f32 v[152:153], v[152:153], v[6:7] op_sel_hi:[1,0]
v_pk_mul_f32 v[154:155], v[154:155], v[6:7] op_sel_hi:[1,0]
v_pk_mul_f32 v[156:157], v[156:157], v[6:7] op_sel_hi:[1,0]
v_pk_mul_f32 v[158:159], v[158:159], v[6:7] op_sel_hi:[1,0]
v_cvt_pk_bf16_f32 v152, v152, v153
v_cvt_pk_bf16_f32 v153, v154, v155
v_cvt_pk_bf16_f32 v154, v156, v157
v_cvt_pk_bf16_f32 v155, v158, v159
buffer_store_dwordx4 v[152:155], v3, s[88:91], s8 offen sc1
v_accvgpr_read_b32 v6, a226
v_accvgpr_read_b32 v7, a227
v_add_f32 v6, v6, v7
v_cmp_nge_f32 vcc, 0x5f800000, v6
v_rcp_f32 v6, v6
s_or_b64 s[34:35], s[34:35], vcc
s_add_u32 s8, s29, 0x0
v_pk_mul_f32 v[160:161], v[160:161], v[6:7] op_sel_hi:[1,0]
v_pk_mul_f32 v[162:163], v[162:163], v[6:7] op_sel_hi:[1,0]
v_pk_mul_f32 v[164:165], v[164:165], v[6:7] op_sel_hi:[1,0]
v_pk_mul_f32 v[166:167], v[166:167], v[6:7] op_sel_hi:[1,0]
v_cvt_pk_bf16_f32 v160, v160, v161
v_cvt_pk_bf16_f32 v161, v162, v163
v_cvt_pk_bf16_f32 v162, v164, v165
v_cvt_pk_bf16_f32 v163, v166, v167
buffer_store_dwordx4 v[160:163], v3, s[88:91], s8 offen sc1
s_add_u32 s8, s29, 0x2000
v_pk_mul_f32 v[168:169], v[168:169], v[6:7] op_sel_hi:[1,0]
v_pk_mul_f32 v[170:171], v[170:171], v[6:7] op_sel_hi:[1,0]
v_pk_mul_f32 v[172:173], v[172:173], v[6:7] op_sel_hi:[1,0]
v_pk_mul_f32 v[174:175], v[174:175], v[6:7] op_sel_hi:[1,0]
v_cvt_pk_bf16_f32 v168, v168, v169
v_cvt_pk_bf16_f32 v169, v170, v171
v_cvt_pk_bf16_f32 v170, v172, v173
v_cvt_pk_bf16_f32 v171, v174, v175
buffer_store_dwordx4 v[168:171], v3, s[88:91], s8 offen sc1
s_add_u32 s8, s29, 0x4000
v_pk_mul_f32 v[176:177], v[176:177], v[6:7] op_sel_hi:[1,0]
v_pk_mul_f32 v[178:179], v[178:179], v[6:7] op_sel_hi:[1,0]
v_pk_mul_f32 v[180:181], v[180:181], v[6:7] op_sel_hi:[1,0]
v_pk_mul_f32 v[182:183], v[182:183], v[6:7] op_sel_hi:[1,0]
v_cvt_pk_bf16_f32 v176, v176, v177
v_cvt_pk_bf16_f32 v177, v178, v179
v_cvt_pk_bf16_f32 v178, v180, v181
v_cvt_pk_bf16_f32 v179, v182, v183
buffer_store_dwordx4 v[176:179], v3, s[88:91], s8 offen sc1
s_add_u32 s8, s29, 0x6000
v_pk_mul_f32 v[184:185], v[184:185], v[6:7] op_sel_hi:[1,0]
v_pk_mul_f32 v[186:187], v[186:187], v[6:7] op_sel_hi:[1,0]
v_pk_mul_f32 v[188:189], v[188:189], v[6:7] op_sel_hi:[1,0]
v_pk_mul_f32 v[190:191], v[190:191], v[6:7] op_sel_hi:[1,0]
v_cvt_pk_bf16_f32 v184, v184, v185
v_cvt_pk_bf16_f32 v185, v186, v187
v_cvt_pk_bf16_f32 v186, v188, v189
v_cvt_pk_bf16_f32 v187, v190, v191
buffer_store_dwordx4 v[184:187], v3, s[88:91], s8 offen sc1
s_branch L_att_h1_1
L_att_j0:
s_cmp_ge_u32 s4, 2
s_cbranch_scc1 L_att_nl0_1
L_att_nl0_0:
v_mfma_f32_16x16x32_bf16 v[16:19], a[0:3], a[160:163], v[96:99]
ds_read_b128 a[128:131], v1 offset:24576
v_mov_b32 v240, 0
v_mfma_f32_16x16x32_bf16 v[16:19], a[4:7], a[164:167], v[16:19]
ds_read_b128 a[132:135], v1 offset:25600
s_add_u32 m0, s27, 0x0
v_mfma_f32_16x16x32_bf16 v[16:19], a[8:11], a[168:171], v[16:19]
buffer_load_dwordx4 v3, s[48:51], s32 offen offset:0 sc1 lds
v_mfma_f32_16x16x32_bf16 v[16:19], a[12:15], a[172:175], v[16:19]
ds_read_b128 a[136:139], v1 offset:26624
v_mov_b32 v241, 0
v_mfma_f32_16x16x32_bf16 v[20:23], a[0:3], a[176:179], v[84:87]
ds_read_b128 a[140:143], v1 offset:27648
v_mov_b32 v242, 0
v_mfma_f32_16x16x32_bf16 v[20:23], a[4:7], a[180:183], v[20:23]
ds_read_b128 a[144:147], v1 offset:28672
v_mov_b32 v243, 0
v_mfma_f32_16x16x32_bf16 v[20:23], a[8:11], a[184:187], v[20:23]
ds_read_b128 a[148:151], v1 offset:29696
s_mov_b32 s9, 0x0
v_mfma_f32_16x16x32_bf16 v[20:23], a[12:15], a[188:191], v[20:23]
buffer_load_dword a244, v8, s[72:75], s9 offen
v_mfma_f32_16x16x32_bf16 v[24:27], a[0:3], a[192:195], v[88:91]
ds_read_b128 a[152:155], v1 offset:30720
v_mov_b32 v244, 0
v_mfma_f32_16x16x32_bf16 v[24:27], a[4:7], a[196:199], v[24:27]
ds_read_b128 a[156:159], v1 offset:31744
v_exp_f32 v16, v16
v_mfma_f32_16x16x32_bf16 v[24:27], a[8:11], a[200:203], v[24:27]
v_exp_f32 v17, v17
v_mfma_f32_16x16x32_bf16 v[24:27], a[12:15], a[204:207], v[24:27]
v_exp_f32 v18, v18
v_mfma_f32_16x16x32_bf16 v[28:31], a[0:3], a[208:211], v[92:95]
buffer_load_dwordx4 v3, s[48:51], s32 offen offset:1024 sc1 lds
v_mfma_f32_16x16x32_bf16 v[28:31], a[4:7], a[212:215], v[28:31]
v_exp_f32 v19, v19
v_mfma_f32_16x16x32_bf16 v[28:31], a[8:11], a[216:219], v[28:31]
v_exp_f32 v20, v20
v_mfma_f32_16x16x32_bf16 v[28:31], a[12:15], a[220:223], v[28:31]
v_exp_f32 v21, v21
v_mfma_f32_16x16x32_bf16 v[32:35], a[16:19], a[160:163], v[100:103]
v_exp_f32 v22, v22
v_mfma_f32_16x16x32_bf16 v[32:35], a[20:23], a[164:167], v[32:35]
buffer_load_dwordx4 v3, s[48:51], s32 offen offset:2048 sc1 lds
v_mfma_f32_16x16x32_bf16 v[32:35], a[24:27], a[168:171], v[32:35]
v_exp_f32 v23, v23
v_mfma_f32_16x16x32_bf16 v[32:35], a[28:31], a[172:175], v[32:35]
v_exp_f32 v24, v24
v_mfma_f32_16x16x32_bf16 v[36:39], a[16:19], a[176:179], v[84:87]
v_exp_f32 v25, v25
v_mfma_f32_16x16x32_bf16 v[36:39], a[20:23], a[180:183], v[36:39]
v_exp_f32 v26, v26
v_mfma_f32_16x16x32_bf16 v[36:39], a[24:27], a[184:187], v[36:39]
buffer_load_dwordx4 v3, s[48:51], s32 offen offset:3072 sc1 lds
v_mfma_f32_16x16x32_bf16 v[36:39], a[28:31], a[188:191], v[36:39]
v_exp_f32 v27, v27
v_mfma_f32_16x16x32_bf16 v[40:43], a[16:19], a[192:195], v[88:91]
v_exp_f32 v28, v28
v_mfma_f32_16x16x32_bf16 v[40:43], a[20:23], a[196:199], v[40:43]
v_exp_f32 v29, v29
v_mfma_f32_16x16x32_bf16 v[40:43], a[24:27], a[200:203], v[40:43]
s_mov_b32 s9, 0x0
v_exp_f32 v30, v30
v_mfma_f32_16x16x32_bf16 v[40:43], a[28:31], a[204:207], v[40:43]
buffer_load_dword a244, v8, s[64:67], s9 offen
v_mfma_f32_16x16x32_bf16 v[44:47], a[16:19], a[208:211], v[92:95]
v_exp_f32 v31, v31
v_mfma_f32_16x16x32_bf16 v[44:47], a[20:23], a[212:215], v[44:47]
v_exp_f32 v32, v32
v_mfma_f32_16x16x32_bf16 v[44:47], a[24:27], a[216:219], v[44:47]
v_exp_f32 v33, v33
v_mfma_f32_16x16x32_bf16 v[44:47], a[28:31], a[220:223], v[44:47]
s_waitcnt lgkmcnt(0)
v_cvt_pk_bf16_f32 v48, v16, v17
v_cvt_pk_bf16_f32 v49, v18, v19
v_cvt_pk_bf16_f32 v52, v20, v21
v_cvt_pk_bf16_f32 v53, v22, v23
v_cvt_pk_bf16_f32 v56, v24, v25
v_cvt_pk_bf16_f32 v57, v26, v27
v_mov_b32 v245, 0
v_mov_b32 v246, 0
v_mov_b32 v247, 0
v_mfma_f32_16x16x32_bf16 v[20:23], a[128:131], a[176:179], v[84:87]
s_add_u32 m0, s27, 0x1000
v_exp_f32 v34, v34
v_mfma_f32_16x16x32_bf16 v[20:23], a[132:135], a[180:183], v[20:23]
buffer_load_dwordx4 v3, s[48:51], s7 offen offset:0 sc1 lds
v_mfma_f32_16x16x32_bf16 v[20:23], a[136:139], a[184:187], v[20:23]
v_exp_f32 v35, v35
v_mfma_f32_16x16x32_bf16 v[20:23], a[140:143], a[188:191], v[20:23]
ds_read_b128 a[32:35], v1 offset:16384
v_cvt_pk_bf16_f32 v60, v28, v29
v_mfma_f32_16x16x32_bf16 v[24:27], a[128:131], a[192:195], v[88:91]
v_exp_f32 v36, v36
v_mfma_f32_16x16x32_bf16 v[24:27], a[132:135], a[196:199], v[24:27]
ds_read_b128 a[36:39], v1 offset:17408
v_cvt_pk_bf16_f32 v61, v30, v31
v_mfma_f32_16x16x32_bf16 v[24:27], a[136:139], a[200:203], v[24:27]
buffer_load_dwordx4 v3, s[48:51], s7 offen offset:1024 sc1 lds
v_mfma_f32_16x16x32_bf16 v[24:27], a[140:143], a[204:207], v[24:27]
ds_read_b128 a[40:43], v1 offset:18432
v_cvt_pk_bf16_f32 v50, v32, v33
v_mfma_f32_16x16x32_bf16 v[28:31], a[128:131], a[208:211], v[92:95]
v_exp_f32 v37, v37
v_mfma_f32_16x16x32_bf16 v[28:31], a[132:135], a[212:215], v[28:31]
ds_read_b128 a[44:47], v1 offset:19456
v_cvt_pk_bf16_f32 v51, v34, v35
v_mfma_f32_16x16x32_bf16 v[28:31], a[136:139], a[216:219], v[28:31]
buffer_load_dwordx4 v3, s[48:51], s7 offen offset:2048 sc1 lds
v_mfma_f32_16x16x32_bf16 v[28:31], a[140:143], a[220:223], v[28:31]
s_mov_b32 s9, 0x400000
v_exp_f32 v38, v38
v_exp_f32 v39, v39
v_cvt_pk_bf16_f32 v54, v36, v37
v_cvt_pk_bf16_f32 v55, v38, v39
v_mfma_f32_16x16x32_bf16 v[36:39], a[144:147], a[176:179], v[84:87]
ds_read_b128 a[48:51], v1 offset:20480
v_exp_f32 v40, v40
v_mfma_f32_16x16x32_bf16 v[36:39], a[148:151], a[180:183], v[36:39]
ds_read_b128 a[52:55], v1 offset:21504
v_exp_f32 v41, v41
v_mfma_f32_16x16x32_bf16 v[36:39], a[152:155], a[184:187], v[36:39]
buffer_load_dword a244, v8, s[64:67], s9 offen
v_mfma_f32_16x16x32_bf16 v[36:39], a[156:159], a[188:191], v[36:39]
ds_read_b128 a[56:59], v1 offset:22528
v_cvt_pk_bf16_f32 v58, v40, v41
v_exp_f32 v42, v42
v_exp_f32 v43, v43
s_nop 0
v_cvt_pk_bf16_f32 v59, v42, v43
v_mfma_f32_16x16x32_bf16 v[40:43], a[144:147], a[192:195], v[88:91]
buffer_load_dwordx4 v3, s[48:51], s7 offen offset:3072 sc1 lds
v_mfma_f32_16x16x32_bf16 v[40:43], a[148:151], a[196:199], v[40:43]
ds_read_b128 a[60:63], v1 offset:23552
v_xor_b32 v1, 0x8000, v1
v_mfma_f32_16x16x32_bf16 v[40:43], a[152:155], a[200:203], v[40:43]
s_add_u32 s32, s32, 0x8000
v_exp_f32 v44, v44
v_mfma_f32_16x16x32_bf16 v[40:43], a[156:159], a[204:207], v[40:43]
s_add_u32 s7, s7, 0x8000
v_exp_f32 v45, v45
v_exp_f32 v46, v46
v_exp_f32 v47, v47
v_cvt_pk_bf16_f32 v62, v44, v45
v_cvt_pk_bf16_f32 v63, v46, v47
v_mfma_f32_16x16x32_bf16 v[44:47], a[144:147], a[208:211], v[92:95]
s_xor_b32 s27, s27, 0x38000
v_exp_f32 v20, v20
v_mfma_f32_16x16x32_bf16 v[44:47], a[148:151], a[212:215], v[44:47]
v_exp_f32 v21, v21
v_mfma_f32_16x16x32_bf16 v[44:47], a[152:155], a[216:219], v[44:47]
s_waitcnt vmcnt(11) lgkmcnt(0)
v_exp_f32 v22, v22
v_mfma_f32_16x16x32_bf16 v[44:47], a[156:159], a[220:223], v[44:47]
s_barrier
v_cvt_pk_bf16_f32 v68, v20, v21
v_exp_f32 v23, v23
v_exp_f32 v24, v24
v_exp_f32 v25, v25
v_exp_f32 v26, v26
v_exp_f32 v27, v27
v_cvt_pk_bf16_f32 v69, v22, v23
s_cmp_lg_u32 s33, 0
s_cbranch_scc1 L_sig_bn0
s_lshl_b32 s8, s6, 2
s_add_u32 s8, s8, 192
s_cmp_lg_u32 s4, 0
s_cbranch_scc1 L_sig_bn0
v_mov_b32 v4, 1
s_mov_b64 exec, 1
buffer_atomic_add v4, off, s[84:87], s8 sc1
s_mov_b64 exec, -1
L_sig_bn0:
s_branch L_att_l1_0
L_att_nl0_1:
v_mfma_f32_16x16x32_bf16 v[16:19], a[0:3], a[160:163], v[80:83]
ds_read_b128 a[128:131], v1 offset:24576
v_mov_b32 v240, 0
v_mfma_f32_16x16x32_bf16 v[16:19], a[4:7], a[164:167], v[16:19]
ds_read_b128 a[132:135], v1 offset:25600
s_add_u32 m0, s27, 0x0
v_mfma_f32_16x16x32_bf16 v[16:19], a[8:11], a[168:171], v[16:19]
buffer_load_dwordx4 v3, s[48:51], s32 offen offset:0 sc1 lds
v_mfma_f32_16x16x32_bf16 v[16:19], a[12:15], a[172:175], v[16:19]
ds_read_b128 a[136:139], v1 offset:26624
v_mov_b32 v241, 0
v_mfma_f32_16x16x32_bf16 v[20:23], a[0:3], a[176:179], v[84:87]
ds_read_b128 a[140:143], v1 offset:27648
v_mov_b32 v242, 0
v_mfma_f32_16x16x32_bf16 v[20:23], a[4:7], a[180:183], v[20:23]
ds_read_b128 a[144:147], v1 offset:28672
v_mov_b32 v243, 0
v_mfma_f32_16x16x32_bf16 v[20:23], a[8:11], a[184:187], v[20:23]
ds_read_b128 a[148:151], v1 offset:29696
s_mov_b32 s9, 0x0
v_mfma_f32_16x16x32_bf16 v[20:23], a[12:15], a[188:191], v[20:23]
buffer_load_dword a244, v8, s[72:75], s9 offen
v_mfma_f32_16x16x32_bf16 v[24:27], a[0:3], a[192:195], v[88:91]
ds_read_b128 a[152:155], v1 offset:30720
v_mov_b32 v244, 0
v_mfma_f32_16x16x32_bf16 v[24:27], a[4:7], a[196:199], v[24:27]
ds_read_b128 a[156:159], v1 offset:31744
v_exp_f32 v16, v16
v_mfma_f32_16x16x32_bf16 v[24:27], a[8:11], a[200:203], v[24:27]
v_exp_f32 v17, v17
v_mfma_f32_16x16x32_bf16 v[24:27], a[12:15], a[204:207], v[24:27]
v_exp_f32 v18, v18
v_mfma_f32_16x16x32_bf16 v[28:31], a[0:3], a[208:211], v[92:95]
buffer_load_dwordx4 v3, s[48:51], s32 offen offset:1024 sc1 lds
v_mfma_f32_16x16x32_bf16 v[28:31], a[4:7], a[212:215], v[28:31]
v_exp_f32 v19, v19
v_mfma_f32_16x16x32_bf16 v[28:31], a[8:11], a[216:219], v[28:31]
v_exp_f32 v20, v20
v_mfma_f32_16x16x32_bf16 v[28:31], a[12:15], a[220:223], v[28:31]
v_exp_f32 v21, v21
v_mfma_f32_16x16x32_bf16 v[32:35], a[16:19], a[160:163], v[80:83]
v_exp_f32 v22, v22
v_mfma_f32_16x16x32_bf16 v[32:35], a[20:23], a[164:167], v[32:35]
buffer_load_dwordx4 v3, s[48:51], s32 offen offset:2048 sc1 lds
v_mfma_f32_16x16x32_bf16 v[32:35], a[24:27], a[168:171], v[32:35]
v_exp_f32 v23, v23
v_mfma_f32_16x16x32_bf16 v[32:35], a[28:31], a[172:175], v[32:35]
v_exp_f32 v24, v24
v_mfma_f32_16x16x32_bf16 v[36:39], a[16:19], a[176:179], v[84:87]
v_exp_f32 v25, v25
v_mfma_f32_16x16x32_bf16 v[36:39], a[20:23], a[180:183], v[36:39]
v_exp_f32 v26, v26
v_mfma_f32_16x16x32_bf16 v[36:39], a[24:27], a[184:187], v[36:39]
buffer_load_dwordx4 v3, s[48:51], s32 offen offset:3072 sc1 lds
v_mfma_f32_16x16x32_bf16 v[36:39], a[28:31], a[188:191], v[36:39]
v_exp_f32 v27, v27
v_mfma_f32_16x16x32_bf16 v[40:43], a[16:19], a[192:195], v[88:91]
v_exp_f32 v28, v28
v_mfma_f32_16x16x32_bf16 v[40:43], a[20:23], a[196:199], v[40:43]
v_exp_f32 v29, v29
v_mfma_f32_16x16x32_bf16 v[40:43], a[24:27], a[200:203], v[40:43]
s_mov_b32 s9, 0x0
v_exp_f32 v30, v30
v_mfma_f32_16x16x32_bf16 v[40:43], a[28:31], a[204:207], v[40:43]
buffer_load_dword a244, v8, s[64:67], s9 offen
v_mfma_f32_16x16x32_bf16 v[44:47], a[16:19], a[208:211], v[92:95]
v_exp_f32 v31, v31
v_mfma_f32_16x16x32_bf16 v[44:47], a[20:23], a[212:215], v[44:47]
v_exp_f32 v32, v32
v_mfma_f32_16x16x32_bf16 v[44:47], a[24:27], a[216:219], v[44:47]
v_exp_f32 v33, v33
v_mfma_f32_16x16x32_bf16 v[44:47], a[28:31], a[220:223], v[44:47]
s_waitcnt lgkmcnt(0)
v_cvt_pk_bf16_f32 v48, v16, v17
v_cvt_pk_bf16_f32 v49, v18, v19
v_cvt_pk_bf16_f32 v52, v20, v21
v_cvt_pk_bf16_f32 v53, v22, v23
v_cvt_pk_bf16_f32 v56, v24, v25
v_cvt_pk_bf16_f32 v57, v26, v27
v_mov_b32 v245, 0
v_mov_b32 v246, 0
v_mov_b32 v247, 0
v_mfma_f32_16x16x32_bf16 v[16:19], a[128:131], a[160:163], v[96:99]
ds_read_b128 a[32:35], v1 offset:16384
v_cvt_pk_bf16_f32 v60, v28, v29
v_mfma_f32_16x16x32_bf16 v[16:19], a[132:135], a[164:167], v[16:19]
s_add_u32 m0, s27, 0x1000
v_exp_f32 v34, v34
v_mfma_f32_16x16x32_bf16 v[16:19], a[136:139], a[168:171], v[16:19]
buffer_load_dwordx4 v3, s[48:51], s7 offen offset:0 sc1 lds
v_mfma_f32_16x16x32_bf16 v[16:19], a[140:143], a[172:175], v[16:19]
ds_read_b128 a[36:39], v1 offset:17408
v_cvt_pk_bf16_f32 v61, v30, v31
v_mfma_f32_16x16x32_bf16 v[20:23], a[128:131], a[176:179], v[84:87]
v_exp_f32 v35, v35
v_mfma_f32_16x16x32_bf16 v[20:23], a[132:135], a[180:183], v[20:23]
v_exp_f32 v36, v36
v_mfma_f32_16x16x32_bf16 v[20:23], a[136:139], a[184:187], v[20:23]
ds_read_b128 a[40:43], v1 offset:18432
v_cvt_pk_bf16_f32 v50, v32, v33
v_mfma_f32_16x16x32_bf16 v[20:23], a[140:143], a[188:191], v[20:23]
buffer_load_dwordx4 v3, s[48:51], s7 offen offset:1024 sc1 lds
v_mfma_f32_16x16x32_bf16 v[24:27], a[128:131], a[192:195], v[88:91]
v_exp_f32 v37, v37
v_mfma_f32_16x16x32_bf16 v[24:27], a[132:135], a[196:199], v[24:27]
ds_read_b128 a[44:47], v1 offset:19456
v_cvt_pk_bf16_f32 v51, v34, v35
v_mfma_f32_16x16x32_bf16 v[24:27], a[136:139], a[200:203], v[24:27]
v_exp_f32 v38, v38
v_mfma_f32_16x16x32_bf16 v[24:27], a[140:143], a[204:207], v[24:27]
v_exp_f32 v39, v39
v_mfma_f32_16x16x32_bf16 v[28:31], a[128:131], a[208:211], v[92:95]
v_exp_f32 v40, v40
v_mfma_f32_16x16x32_bf16 v[28:31], a[132:135], a[212:215], v[28:31]
buffer_load_dwordx4 v3, s[48:51], s7 offen offset:2048 sc1 lds
v_mfma_f32_16x16x32_bf16 v[28:31], a[136:139], a[216:219], v[28:31]
ds_read_b128 a[48:51], v1 offset:20480
v_cvt_pk_bf16_f32 v54, v36, v37
v_mfma_f32_16x16x32_bf16 v[28:31], a[140:143], a[220:223], v[28:31]
v_exp_f32 v41, v41
v_mfma_f32_16x16x32_bf16 v[32:35], a[144:147], a[160:163], v[100:103]
ds_read_b128 a[52:55], v1 offset:21504
v_cvt_pk_bf16_f32 v55, v38, v39
v_mfma_f32_16x16x32_bf16 v[32:35], a[148:151], a[164:167], v[32:35]
s_mov_b32 s9, 0x400000
v_exp_f32 v42, v42
v_mfma_f32_16x16x32_bf16 v[32:35], a[152:155], a[168:171], v[32:35]
buffer_load_dword a244, v8, s[64:67], s9 offen
v_mfma_f32_16x16x32_bf16 v[32:35], a[156:159], a[172:175], v[32:35]
ds_read_b128 a[56:59], v1 offset:22528
v_cvt_pk_bf16_f32 v58, v40, v41
v_mfma_f32_16x16x32_bf16 v[36:39], a[144:147], a[176:179], v[84:87]
v_exp_f32 v43, v43
v_mfma_f32_16x16x32_bf16 v[36:39], a[148:151], a[180:183], v[36:39]
v_exp_f32 v44, v44
v_mfma_f32_16x16x32_bf16 v[36:39], a[152:155], a[184:187], v[36:39]
ds_read_b128 a[60:63], v1 offset:23552
v_xor_b32 v1, 0x8000, v1
v_mfma_f32_16x16x32_bf16 v[36:39], a[156:159], a[188:191], v[36:39]
buffer_load_dwordx4 v3, s[48:51], s7 offen offset:3072 sc1 lds
v_cvt_pk_bf16_f32 v59, v42, v43
v_mfma_f32_16x16x32_bf16 v[40:43], a[144:147], a[192:195], v[88:91]
s_add_u32 s32, s32, 0x8000
v_exp_f32 v45, v45
v_mfma_f32_16x16x32_bf16 v[40:43], a[148:151], a[196:199], v[40:43]
s_add_u32 s7, s7, 0x8000
v_exp_f32 v46, v46
v_mfma_f32_16x16x32_bf16 v[40:43], a[152:155], a[200:203], v[40:43]
s_xor_b32 s27, s27, 0x38000
v_exp_f32 v47, v47
v_mfma_f32_16x16x32_bf16 v[40:43], a[156:159], a[204:207], v[40:43]
v_exp_f32 v16, v16
v_cvt_pk_bf16_f32 v62, v44, v45
v_cvt_pk_bf16_f32 v63, v46, v47
v_mfma_f32_16x16x32_bf16 v[44:47], a[144:147], a[208:211], v[92:95]
v_exp_f32 v17, v17
v_mfma_f32_16x16x32_bf16 v[44:47], a[148:151], a[212:215], v[44:47]
v_exp_f32 v18, v18
v_mfma_f32_16x16x32_bf16 v[44:47], a[152:155], a[216:219], v[44:47]
s_waitcnt vmcnt(11) lgkmcnt(0)
v_exp_f32 v19, v19
v_mfma_f32_16x16x32_bf16 v[44:47], a[156:159], a[220:223], v[44:47]
s_barrier
v_cvt_pk_bf16_f32 v64, v16, v17
v_exp_f32 v20, v20
v_exp_f32 v21, v21
v_exp_f32 v22, v22
v_exp_f32 v23, v23
v_exp_f32 v24, v24
v_exp_f32 v25, v25
v_exp_f32 v26, v26
v_exp_f32 v27, v27
v_cvt_pk_bf16_f32 v65, v18, v19
v_cvt_pk_bf16_f32 v68, v20, v21
v_cvt_pk_bf16_f32 v69, v22, v23
s_cmp_lg_u32 s33, 0
s_cbranch_scc1 L_sig_bn1
s_lshl_b32 s8, s6, 2
s_add_u32 s8, s8, 192
s_cmp_lg_u32 s4, 0
s_cbranch_scc1 L_sig_bn1
v_mov_b32 v4, 1
s_mov_b64 exec, 1
buffer_atomic_add v4, off, s[84:87], s8 sc1
s_mov_b64 exec, -1
L_sig_bn1:
s_branch L_att_l1_1
L_att_seven0:
v_mfma_f32_16x16x32_bf16 v[192:195], a[32:35], v[56:59], v[192:195]
v_exp_f32 v30, v30
v_mfma_f32_16x16x32_bf16 v[224:227], a[32:35], v[60:63], v[224:227]
ds_read_b128 a[0:3], v1 offset:8192
v_cvt_pk_bf16_f32 v72, v24, v25
v_mfma_f32_16x16x32_bf16 v[228:231], a[36:39], v[60:63], v[228:231]
ds_read_b128 a[4:7], v1 offset:9216
v_cvt_pk_bf16_f32 v73, v26, v27
v_mfma_f32_16x16x32_bf16 v[196:199], a[36:39], v[56:59], v[196:199]
s_add_u32 m0, s27, 0x0
v_exp_f32 v31, v31
v_mfma_f32_16x16x32_bf16 v[200:203], a[40:43], v[56:59], v[200:203]
ds_read_b128 a[8:11], v1 offset:10240
v_cvt_pk_bf16_f32 v76, v28, v29
v_mfma_f32_16x16x32_bf16 v[232:235], a[40:43], v[60:63], v[232:235]
buffer_load_dwordx4 v3, s[48:51], s32 offen offset:0 sc1 lds
v_mfma_f32_16x16x32_bf16 v[236:239], a[44:47], v[60:63], v[236:239]
v_exp_f32 v40, v40
v_mfma_f32_16x16x32_bf16 v[204:207], a[44:47], v[56:59], v[204:207]
ds_read_b128 a[12:15], v1 offset:11264
v_cvt_pk_bf16_f32 v77, v30, v31
v_mfma_f32_16x16x32_bf16 v[208:211], a[48:51], v[56:59], v[208:211]
ds_read_b128 a[16:19], v1 offset:12288
v_mfma_f32_16x16x32_bf16 v[240:243], a[48:51], v[60:63], v[240:243]
buffer_load_dwordx4 v3, s[48:51], s32 offen offset:1024 sc1 lds
v_mfma_f32_16x16x32_bf16 v[244:247], a[52:55], v[60:63], v[244:247]
ds_read_b128 a[20:23], v1 offset:13312
v_mfma_f32_16x16x32_bf16 v[212:215], a[52:55], v[56:59], v[212:215]
ds_read_b128 a[24:27], v1 offset:14336
v_mfma_f32_16x16x32_bf16 v[216:219], a[56:59], v[56:59], v[216:219]
ds_read_b128 a[28:31], v1 offset:15360
v_mfma_f32_16x16x32_bf16 v[248:251], a[56:59], v[60:63], v[248:251]
ds_read_b128 a[32:35], v1 offset:0
v_exp_f32 v41, v41
v_mfma_f32_16x16x32_bf16 v[252:255], a[60:63], v[60:63], v[252:255]
v_exp_f32 v42, v42
v_mfma_f32_16x16x32_bf16 v[220:223], a[60:63], v[56:59], v[220:223]
s_waitcnt lgkmcnt(5)
v_exp_f32 v43, v43
v_smfmac_f32_16x16x64_bf16 a[228:231], a[232:235], v[56:63], v9
ds_read_b128 a[36:39], v1 offset:1024
v_cvt_pk_bf16_f32 v74, v40, v41
v_mfma_f32_16x16x32_bf16 v[24:27], a[0:3], a[192:195], v[88:91]
ds_read_b128 a[40:43], v1 offset:2048
v_exp_f32 v44, v44
v_mfma_f32_16x16x32_bf16 v[24:27], a[4:7], a[196:199], v[24:27]
buffer_load_dwordx4 v3, s[48:51], s32 offen offset:2048 sc1 lds
v_mfma_f32_16x16x32_bf16 v[24:27], a[8:11], a[200:203], v[24:27]
v_exp_f32 v45, v45
v_mfma_f32_16x16x32_bf16 v[24:27], a[12:15], a[204:207], v[24:27]
ds_read_b128 a[44:47], v1 offset:3072
v_cvt_pk_bf16_f32 v75, v42, v43
v_mfma_f32_16x16x32_bf16 v[28:31], a[0:3], a[208:211], v[92:95]
ds_read_b128 a[48:51], v1 offset:4096
v_exp_f32 v46, v46
v_mfma_f32_16x16x32_bf16 v[28:31], a[4:7], a[212:215], v[28:31]
s_waitcnt lgkmcnt(5)
v_exp_f32 v47, v47
v_mfma_f32_16x16x32_bf16 v[28:31], a[8:11], a[216:219], v[28:31]
ds_read_b128 a[52:55], v1 offset:5120
v_cvt_pk_bf16_f32 v78, v44, v45
v_mfma_f32_16x16x32_bf16 v[28:31], a[12:15], a[220:223], v[28:31]
buffer_load_dwordx4 v3, s[48:51], s32 offen offset:3072 sc1 lds
v_mfma_f32_16x16x32_bf16 v[40:43], a[16:19], a[192:195], v[88:91]
ds_read_b128 a[56:59], v1 offset:6144
s_add_u32 s32, s32, 0x8000
v_mfma_f32_16x16x32_bf16 v[40:43], a[20:23], a[196:199], v[40:43]
ds_read_b128 a[60:63], v1 offset:7168
v_cvt_pk_bf16_f32 v79, v46, v47
v_mfma_f32_16x16x32_bf16 v[40:43], a[24:27], a[200:203], v[40:43]
v_exp_f32 v24, v24
v_mfma_f32_16x16x32_bf16 v[40:43], a[28:31], a[204:207], v[40:43]
v_exp_f32 v25, v25
v_mfma_f32_16x16x32_bf16 v[44:47], a[16:19], a[208:211], v[92:95]
v_exp_f32 v26, v26
v_mfma_f32_16x16x32_bf16 v[44:47], a[20:23], a[212:215], v[44:47]
v_exp_f32 v27, v27
v_mfma_f32_16x16x32_bf16 v[44:47], a[24:27], a[216:219], v[44:47]
v_exp_f32 v28, v28
v_mfma_f32_16x16x32_bf16 v[44:47], a[28:31], a[220:223], v[44:47]
s_waitcnt lgkmcnt(0)
v_exp_f32 v29, v29
v_mfma_f32_16x16x32_bf16 v[192:195], a[32:35], v[72:75], v[192:195]
s_add_u32 m0, s27, 0x1000
v_exp_f32 v30, v30
v_mfma_f32_16x16x32_bf16 v[224:227], a[32:35], v[76:79], v[224:227]
buffer_load_dwordx4 v3, s[48:51], s7 offen offset:0 sc1 lds
v_mfma_f32_16x16x32_bf16 v[228:231], a[36:39], v[76:79], v[228:231]
v_exp_f32 v31, v31
v_mfma_f32_16x16x32_bf16 v[196:199], a[36:39], v[72:75], v[196:199]
ds_read_b128 a[0:3], v1 offset:24576
v_cvt_pk_bf16_f32 v56, v24, v25
v_mfma_f32_16x16x32_bf16 v[200:203], a[40:43], v[72:75], v[200:203]
ds_read_b128 a[4:7], v1 offset:25600
v_cvt_pk_bf16_f32 v57, v26, v27
v_mfma_f32_16x16x32_bf16 v[232:235], a[40:43], v[76:79], v[232:235]
v_exp_f32 v40, v40
v_mfma_f32_16x16x32_bf16 v[236:239], a[44:47], v[76:79], v[236:239]
ds_read_b128 a[8:11], v1 offset:26624
v_cvt_pk_bf16_f32 v60, v28, v29
v_mfma_f32_16x16x32_bf16 v[204:207], a[44:47], v[72:75], v[204:207]
v_exp_f32 v41, v41
v_mfma_f32_16x16x32_bf16 v[208:211], a[48:51], v[72:75], v[208:211]
ds_read_b128 a[12:15], v1 offset:27648
v_cvt_pk_bf16_f32 v61, v30, v31
v_mfma_f32_16x16x32_bf16 v[240:243], a[48:51], v[76:79], v[240:243]
ds_read_b128 a[16:19], v1 offset:28672
v_cvt_pk_bf16_f32 v58, v40, v41
v_mfma_f32_16x16x32_bf16 v[244:247], a[52:55], v[76:79], v[244:247]
v_exp_f32 v42, v42
v_mfma_f32_16x16x32_bf16 v[212:215], a[52:55], v[72:75], v[212:215]
buffer_load_dwordx4 v3, s[48:51], s7 offen offset:1024 sc1 lds
v_mfma_f32_16x16x32_bf16 v[216:219], a[56:59], v[72:75], v[216:219]
ds_read_b128 a[20:23], v1 offset:29696
v_mfma_f32_16x16x32_bf16 v[248:251], a[56:59], v[76:79], v[248:251]
ds_read_b128 a[24:27], v1 offset:30720
v_mfma_f32_16x16x32_bf16 v[252:255], a[60:63], v[76:79], v[252:255]
ds_read_b128 a[28:31], v1 offset:31744
v_mfma_f32_16x16x32_bf16 v[220:223], a[60:63], v[72:75], v[220:223]
s_waitcnt lgkmcnt(4)
v_exp_f32 v43, v43
v_smfmac_f32_16x16x64_bf16 a[228:231], a[232:235], v[72:79], v9
ds_read_b128 a[32:35], v1 offset:16384
v_cvt_pk_bf16_f32 v59, v42, v43
v_mfma_f32_16x16x32_bf16 v[24:27], a[0:3], a[192:195], v[88:91]
ds_read_b128 a[36:39], v1 offset:17408
v_mfma_f32_16x16x32_bf16 v[24:27], a[4:7], a[196:199], v[24:27]
buffer_load_dwordx4 v3, s[48:51], s7 offen offset:2048 sc1 lds
v_mfma_f32_16x16x32_bf16 v[24:27], a[8:11], a[200:203], v[24:27]
ds_read_b128 a[40:43], v1 offset:18432
v_exp_f32 v44, v44
v_mfma_f32_16x16x32_bf16 v[24:27], a[12:15], a[204:207], v[24:27]
ds_read_b128 a[44:47], v1 offset:19456
v_exp_f32 v45, v45
v_mfma_f32_16x16x32_bf16 v[28:31], a[0:3], a[208:211], v[92:95]
ds_read_b128 a[48:51], v1 offset:20480
v_exp_f32 v46, v46
v_mfma_f32_16x16x32_bf16 v[28:31], a[4:7], a[212:215], v[28:31]
s_waitcnt lgkmcnt(5)
v_exp_f32 v47, v47
v_mfma_f32_16x16x32_bf16 v[28:31], a[8:11], a[216:219], v[28:31]
ds_read_b128 a[52:55], v1 offset:21504
v_cvt_pk_bf16_f32 v62, v44, v45
v_mfma_f32_16x16x32_bf16 v[28:31], a[12:15], a[220:223], v[28:31]
ds_read_b128 a[56:59], v1 offset:22528
v_cvt_pk_bf16_f32 v63, v46, v47
v_mfma_f32_16x16x32_bf16 v[40:43], a[16:19], a[192:195], v[88:91]
ds_read_b128 a[60:63], v1 offset:23552
v_xor_b32 v1, 0x8000, v1
v_mfma_f32_16x16x32_bf16 v[40:43], a[20:23], a[196:199], v[40:43]
buffer_load_dwordx4 v3, s[48:51], s7 offen offset:3072 sc1 lds
v_mfma_f32_16x16x32_bf16 v[40:43], a[24:27], a[200:203], v[40:43]
s_add_u32 s7, s7, 0x8000
v_exp_f32 v24, v24
v_mfma_f32_16x16x32_bf16 v[40:43], a[28:31], a[204:207], v[40:43]
s_xor_b32 s27, s27, 0x38000
v_exp_f32 v25, v25
v_mfma_f32_16x16x32_bf16 v[44:47], a[16:19], a[208:211], v[92:95]
v_exp_f32 v26, v26
v_mfma_f32_16x16x32_bf16 v[44:47], a[20:23], a[212:215], v[44:47]
v_exp_f32 v27, v27
v_mfma_f32_16x16x32_bf16 v[44:47], a[24:27], a[216:219], v[44:47]
s_waitcnt vmcnt(16) lgkmcnt(0)
v_exp_f32 v28, v28
v_mfma_f32_16x16x32_bf16 v[44:47], a[28:31], a[220:223], v[44:47]
s_barrier
v_exp_f32 v29, v29
L_att_sodd0:
v_mfma_f32_16x16x32_bf16 v[192:195], a[32:35], v[56:59], v[192:195]
v_exp_f32 v30, v30
v_mfma_f32_16x16x32_bf16 v[224:227], a[32:35], v[60:63], v[224:227]
ds_read_b128 a[0:3], v2 offset:8192
v_cvt_pk_bf16_f32 v72, v24, v25
v_mfma_f32_16x16x32_bf16 v[228:231], a[36:39], v[60:63], v[228:231]
ds_read_b128 a[4:7], v2 offset:9216
v_cvt_pk_bf16_f32 v73, v26, v27
v_mfma_f32_16x16x32_bf16 v[196:199], a[36:39], v[56:59], v[196:199]
s_add_u32 m0, s19, 0x0
v_exp_f32 v31, v31
v_mfma_f32_16x16x32_bf16 v[200:203], a[40:43], v[56:59], v[200:203]
ds_read_b128 a[8:11], v2 offset:10240
v_cvt_pk_bf16_f32 v76, v28, v29
v_mfma_f32_16x16x32_bf16 v[232:235], a[40:43], v[60:63], v[232:235]
buffer_load_dwordx4 v3, s[48:51], s32 offen offset:0 sc1 lds
v_mfma_f32_16x16x32_bf16 v[236:239], a[44:47], v[60:63], v[236:239]
v_exp_f32 v40, v40
v_mfma_f32_16x16x32_bf16 v[204:207], a[44:47], v[56:59], v[204:207]
ds_read_b128 a[12:15], v2 offset:11264
v_cvt_pk_bf16_f32 v77, v30, v31
v_mfma_f32_16x16x32_bf16 v[208:211], a[48:51], v[56:59], v[208:211]
ds_read_b128 a[16:19], v2 offset:12288
v_mfma_f32_16x16x32_bf16 v[240:243], a[48:51], v[60:63], v[240:243]
buffer_load_dwordx4 v3, s[48:51], s32 offen offset:1024 sc1 lds
v_mfma_f32_16x16x32_bf16 v[244:247], a[52:55], v[60:63], v[244:247]
ds_read_b128 a[20:23], v2 offset:13312
v_mfma_f32_16x16x32_bf16 v[212:215], a[52:55], v[56:59], v[212:215]
ds_read_b128 a[24:27], v2 offset:14336
v_mfma_f32_16x16x32_bf16 v[216:219], a[56:59], v[56:59], v[216:219]
ds_read_b128 a[28:31], v2 offset:15360
v_mfma_f32_16x16x32_bf16 v[248:251], a[56:59], v[60:63], v[248:251]
ds_read_b128 a[32:35], v2 offset:0
v_exp_f32 v41, v41
v_mfma_f32_16x16x32_bf16 v[252:255], a[60:63], v[60:63], v[252:255]
v_exp_f32 v42, v42
v_mfma_f32_16x16x32_bf16 v[220:223], a[60:63], v[56:59], v[220:223]
s_waitcnt lgkmcnt(5)
v_exp_f32 v43, v43
v_smfmac_f32_16x16x64_bf16 a[228:231], a[232:235], v[56:63], v9
ds_read_b128 a[36:39], v2 offset:1024
v_cvt_pk_bf16_f32 v74, v40, v41
v_mfma_f32_16x16x32_bf16 v[24:27], a[0:3], a[192:195], v[88:91]
ds_read_b128 a[40:43], v2 offset:2048
v_exp_f32 v44, v44
v_mfma_f32_16x16x32_bf16 v[24:27], a[4:7], a[196:199], v[24:27]
buffer_load_dwordx4 v3, s[48:51], s32 offen offset:2048 sc1 lds
v_mfma_f32_16x16x32_bf16 v[24:27], a[8:11], a[200:203], v[24:27]
v_exp_f32 v45, v45
v_mfma_f32_16x16x32_bf16 v[24:27], a[12:15], a[204:207], v[24:27]
ds_read_b128 a[44:47], v2 offset:3072
v_cvt_pk_bf16_f32 v75, v42, v43
v_mfma_f32_16x16x32_bf16 v[28:31], a[0:3], a[208:211], v[92:95]
ds_read_b128 a[48:51], v2 offset:4096
v_exp_f32 v46, v46
v_mfma_f32_16x16x32_bf16 v[28:31], a[4:7], a[212:215], v[28:31]
s_waitcnt lgkmcnt(5)
v_exp_f32 v47, v47
v_mfma_f32_16x16x32_bf16 v[28:31], a[8:11], a[216:219], v[28:31]
ds_read_b128 a[52:55], v2 offset:5120
v_cvt_pk_bf16_f32 v78, v44, v45
v_mfma_f32_16x16x32_bf16 v[28:31], a[12:15], a[220:223], v[28:31]
buffer_load_dwordx4 v3, s[48:51], s32 offen offset:3072 sc1 lds
v_mfma_f32_16x16x32_bf16 v[40:43], a[16:19], a[192:195], v[88:91]
ds_read_b128 a[56:59], v2 offset:6144
s_add_u32 s32, s32, 0x8000
v_mfma_f32_16x16x32_bf16 v[40:43], a[20:23], a[196:199], v[40:43]
ds_read_b128 a[60:63], v2 offset:7168
v_cvt_pk_bf16_f32 v79, v46, v47
v_mfma_f32_16x16x32_bf16 v[40:43], a[24:27], a[200:203], v[40:43]
v_exp_f32 v24, v24
v_mfma_f32_16x16x32_bf16 v[40:43], a[28:31], a[204:207], v[40:43]
v_exp_f32 v25, v25
v_mfma_f32_16x16x32_bf16 v[44:47], a[16:19], a[208:211], v[92:95]
v_exp_f32 v26, v26
v_mfma_f32_16x16x32_bf16 v[44:47], a[20:23], a[212:215], v[44:47]
v_exp_f32 v27, v27
v_mfma_f32_16x16x32_bf16 v[44:47], a[24:27], a[216:219], v[44:47]
v_exp_f32 v28, v28
v_mfma_f32_16x16x32_bf16 v[44:47], a[28:31], a[220:223], v[44:47]
s_waitcnt lgkmcnt(0)
v_exp_f32 v29, v29
v_mfma_f32_16x16x32_bf16 v[192:195], a[32:35], v[72:75], v[192:195]
v_exp_f32 v30, v30
v_mfma_f32_16x16x32_bf16 v[224:227], a[32:35], v[76:79], v[224:227]
v_exp_f32 v31, v31
v_mfma_f32_16x16x32_bf16 v[228:231], a[36:39], v[76:79], v[228:231]
v_exp_f32 v40, v40
v_mfma_f32_16x16x32_bf16 v[196:199], a[36:39], v[72:75], v[196:199]
s_add_u32 m0, s19, 0x1000
v_exp_f32 v41, v41
v_mfma_f32_16x16x32_bf16 v[200:203], a[40:43], v[72:75], v[200:203]
ds_read_b128 a[0:3], v2 offset:24576
v_cvt_pk_bf16_f32 v56, v24, v25
v_mfma_f32_16x16x32_bf16 v[232:235], a[40:43], v[76:79], v[232:235]
buffer_load_dwordx4 v3, s[48:51], s7 offen offset:0 sc1 lds
v_mfma_f32_16x16x32_bf16 v[236:239], a[44:47], v[76:79], v[236:239]
ds_read_b128 a[4:7], v2 offset:25600
v_cvt_pk_bf16_f32 v57, v26, v27
v_mfma_f32_16x16x32_bf16 v[204:207], a[44:47], v[72:75], v[204:207]
ds_read_b128 a[8:11], v2 offset:26624
v_cvt_pk_bf16_f32 v60, v28, v29
v_mfma_f32_16x16x32_bf16 v[208:211], a[48:51], v[72:75], v[208:211]
ds_read_b128 a[12:15], v2 offset:27648
v_cvt_pk_bf16_f32 v61, v30, v31
v_mfma_f32_16x16x32_bf16 v[240:243], a[48:51], v[76:79], v[240:243]
ds_read_b128 a[16:19], v2 offset:28672
v_cvt_pk_bf16_f32 v58, v40, v41
v_mfma_f32_16x16x32_bf16 v[244:247], a[52:55], v[76:79], v[244:247]
buffer_load_dwordx4 v3, s[48:51], s7 offen offset:1024 sc1 lds
v_mfma_f32_16x16x32_bf16 v[212:215], a[52:55], v[72:75], v[212:215]
ds_read_b128 a[20:23], v2 offset:29696
v_mfma_f32_16x16x32_bf16 v[216:219], a[56:59], v[72:75], v[216:219]
v_exp_f32 v42, v42
v_mfma_f32_16x16x32_bf16 v[248:251], a[56:59], v[76:79], v[248:251]
ds_read_b128 a[24:27], v2 offset:30720
v_mfma_f32_16x16x32_bf16 v[252:255], a[60:63], v[76:79], v[252:255]
ds_read_b128 a[28:31], v2 offset:31744
v_exp_f32 v43, v43
v_mfma_f32_16x16x32_bf16 v[220:223], a[60:63], v[72:75], v[220:223]
ds_read_b128 a[32:35], v2 offset:16384
v_cvt_pk_bf16_f32 v59, v42, v43
v_smfmac_f32_16x16x64_bf16 a[228:231], a[232:235], v[72:79], v9
ds_read_b128 a[36:39], v2 offset:17408
s_waitcnt lgkmcnt(6)
v_mfma_f32_16x16x32_bf16 v[24:27], a[0:3], a[192:195], v[88:91]
buffer_load_dwordx4 v3, s[48:51], s7 offen offset:2048 sc1 lds
v_mfma_f32_16x16x32_bf16 v[24:27], a[4:7], a[196:199], v[24:27]
ds_read_b128 a[40:43], v2 offset:18432
v_exp_f32 v44, v44
v_mfma_f32_16x16x32_bf16 v[24:27], a[8:11], a[200:203], v[24:27]
ds_read_b128 a[44:47], v2 offset:19456
v_exp_f32 v45, v45
v_mfma_f32_16x16x32_bf16 v[24:27], a[12:15], a[204:207], v[24:27]
ds_read_b128 a[48:51], v2 offset:20480
v_cvt_pk_bf16_f32 v62, v44, v45
v_mfma_f32_16x16x32_bf16 v[28:31], a[0:3], a[208:211], v[92:95]
v_exp_f32 v46, v46
v_mfma_f32_16x16x32_bf16 v[28:31], a[4:7], a[212:215], v[28:31]
s_waitcnt lgkmcnt(5)
v_exp_f32 v47, v47
v_mfma_f32_16x16x32_bf16 v[28:31], a[8:11], a[216:219], v[28:31]
ds_read_b128 a[52:55], v2 offset:21504
v_cvt_pk_bf16_f32 v63, v46, v47
v_mfma_f32_16x16x32_bf16 v[28:31], a[12:15], a[220:223], v[28:31]
buffer_load_dwordx4 v3, s[48:51], s7 offen offset:3072 sc1 lds
v_mfma_f32_16x16x32_bf16 v[40:43], a[16:19], a[192:195], v[88:91]
ds_read_b128 a[56:59], v2 offset:22528
s_add_u32 s7, s7, 0x8000
v_mfma_f32_16x16x32_bf16 v[40:43], a[20:23], a[196:199], v[40:43]
ds_read_b128 a[60:63], v2 offset:23552
v_xor_b32 v2, 0x38000, v2
v_mfma_f32_16x16x32_bf16 v[40:43], a[24:27], a[200:203], v[40:43]
s_xor_b32 s19, s19, 0x8000
v_exp_f32 v24, v24
v_mfma_f32_16x16x32_bf16 v[40:43], a[28:31], a[204:207], v[40:43]
s_sub_u32 s15, s15, 1
v_exp_f32 v25, v25
v_mfma_f32_16x16x32_bf16 v[44:47], a[16:19], a[208:211], v[92:95]
s_cmp_lg_u32 s15, 0
v_exp_f32 v26, v26
v_mfma_f32_16x16x32_bf16 v[44:47], a[20:23], a[212:215], v[44:47]
v_exp_f32 v27, v27
v_mfma_f32_16x16x32_bf16 v[44:47], a[24:27], a[216:219], v[44:47]
s_waitcnt vmcnt(16) lgkmcnt(0)
v_exp_f32 v28, v28
v_mfma_f32_16x16x32_bf16 v[44:47], a[28:31], a[220:223], v[44:47]
s_barrier
v_exp_f32 v29, v29
s_cbranch_scc1 L_att_seven0
s_branch L_att_sdone
L_att_seven1:
v_mfma_f32_16x16x32_bf16 v[192:195], a[32:35], v[56:59], v[192:195]
v_exp_f32 v30, v30
v_mfma_f32_16x16x32_bf16 v[224:227], a[32:35], v[60:63], v[224:227]
ds_read_b128 a[0:3], v1 offset:8192
v_cvt_pk_bf16_f32 v72, v24, v25
v_mfma_f32_16x16x32_bf16 v[228:231], a[36:39], v[60:63], v[228:231]
ds_read_b128 a[4:7], v1 offset:9216
v_cvt_pk_bf16_f32 v73, v26, v27
v_mfma_f32_16x16x32_bf16 v[196:199], a[36:39], v[56:59], v[196:199]
s_add_u32 m0, s27, 0x0
v_exp_f32 v31, v31
v_mfma_f32_16x16x32_bf16 v[200:203], a[40:43], v[56:59], v[200:203]
ds_read_b128 a[8:11], v1 offset:10240
v_cvt_pk_bf16_f32 v76, v28, v29
v_mfma_f32_16x16x32_bf16 v[232:235], a[40:43], v[60:63], v[232:235]
buffer_load_dwordx4 v3, s[48:51], s32 offen offset:0 sc1 lds
v_mfma_f32_16x16x32_bf16 v[236:239], a[44:47], v[60:63], v[236:239]
v_exp_f32 v40, v40
v_mfma_f32_16x16x32_bf16 v[204:207], a[44:47], v[56:59], v[204:207]
ds_read_b128 a[12:15], v1 offset:11264
v_cvt_pk_bf16_f32 v77, v30, v31
v_mfma_f32_16x16x32_bf16 v[208:211], a[48:51], v[56:59], v[208:211]
ds_read_b128 a[16:19], v1 offset:12288
v_mfma_f32_16x16x32_bf16 v[240:243], a[48:51], v[60:63], v[240:243]
buffer_load_dwordx4 v3, s[48:51], s32 offen offset:1024 sc1 lds
v_mfma_f32_16x16x32_bf16 v[244:247], a[52:55], v[60:63], v[244:247]
ds_read_b128 a[20:23], v1 offset:13312
v_mfma_f32_16x16x32_bf16 v[212:215], a[52:55], v[56:59], v[212:215]
ds_read_b128 a[24:27], v1 offset:14336
v_mfma_f32_16x16x32_bf16 v[216:219], a[56:59], v[56:59], v[216:219]
ds_read_b128 a[28:31], v1 offset:15360
v_mfma_f32_16x16x32_bf16 v[248:251], a[56:59], v[60:63], v[248:251]
ds_read_b128 a[32:35], v1 offset:0
v_exp_f32 v41, v41
v_mfma_f32_16x16x32_bf16 v[252:255], a[60:63], v[60:63], v[252:255]
v_exp_f32 v42, v42
v_mfma_f32_16x16x32_bf16 v[220:223], a[60:63], v[56:59], v[220:223]
s_waitcnt lgkmcnt(5)
v_exp_f32 v43, v43
v_smfmac_f32_16x16x64_bf16 a[228:231], a[232:235], v[56:63], v9
ds_read_b128 a[36:39], v1 offset:1024
v_cvt_pk_bf16_f32 v74, v40, v41
v_mfma_f32_16x16x32_bf16 v[24:27], a[0:3], a[192:195], v[88:91]
ds_read_b128 a[40:43], v1 offset:2048
v_exp_f32 v44, v44
v_mfma_f32_16x16x32_bf16 v[24:27], a[4:7], a[196:199], v[24:27]
buffer_load_dwordx4 v3, s[48:51], s32 offen offset:2048 sc1 lds
v_mfma_f32_16x16x32_bf16 v[24:27], a[8:11], a[200:203], v[24:27]
v_exp_f32 v45, v45
v_mfma_f32_16x16x32_bf16 v[24:27], a[12:15], a[204:207], v[24:27]
ds_read_b128 a[44:47], v1 offset:3072
v_cvt_pk_bf16_f32 v75, v42, v43
v_mfma_f32_16x16x32_bf16 v[28:31], a[0:3], a[208:211], v[92:95]
ds_read_b128 a[48:51], v1 offset:4096
v_exp_f32 v46, v46
v_mfma_f32_16x16x32_bf16 v[28:31], a[4:7], a[212:215], v[28:31]
s_waitcnt lgkmcnt(5)
v_exp_f32 v47, v47
v_mfma_f32_16x16x32_bf16 v[28:31], a[8:11], a[216:219], v[28:31]
ds_read_b128 a[52:55], v1 offset:5120
v_cvt_pk_bf16_f32 v78, v44, v45
v_mfma_f32_16x16x32_bf16 v[28:31], a[12:15], a[220:223], v[28:31]
buffer_load_dwordx4 v3, s[48:51], s32 offen offset:3072 sc1 lds
v_mfma_f32_16x16x32_bf16 v[40:43], a[16:19], a[192:195], v[88:91]
ds_read_b128 a[56:59], v1 offset:6144
s_add_u32 s32, s32, 0x8000
v_mfma_f32_16x16x32_bf16 v[40:43], a[20:23], a[196:199], v[40:43]
ds_read_b128 a[60:63], v1 offset:7168
v_cvt_pk_bf16_f32 v79, v46, v47
v_mfma_f32_16x16x32_bf16 v[40:43], a[24:27], a[200:203], v[40:43]
v_exp_f32 v24, v24
v_mfma_f32_16x16x32_bf16 v[40:43], a[28:31], a[204:207], v[40:43]
v_exp_f32 v25, v25
v_mfma_f32_16x16x32_bf16 v[44:47], a[16:19], a[208:211], v[92:95]
v_exp_f32 v26, v26
v_mfma_f32_16x16x32_bf16 v[44:47], a[20:23], a[212:215], v[44:47]
v_exp_f32 v27, v27
v_mfma_f32_16x16x32_bf16 v[44:47], a[24:27], a[216:219], v[44:47]
v_exp_f32 v28, v28
v_mfma_f32_16x16x32_bf16 v[44:47], a[28:31], a[220:223], v[44:47]
s_waitcnt lgkmcnt(0)
v_exp_f32 v29, v29
v_mfma_f32_16x16x32_bf16 v[192:195], a[32:35], v[72:75], v[192:195]
s_add_u32 m0, s27, 0x1000
v_exp_f32 v30, v30
v_mfma_f32_16x16x32_bf16 v[224:227], a[32:35], v[76:79], v[224:227]
buffer_load_dwordx4 v3, s[48:51], s7 offen offset:0 sc1 lds
v_mfma_f32_16x16x32_bf16 v[228:231], a[36:39], v[76:79], v[228:231]
v_exp_f32 v31, v31
v_mfma_f32_16x16x32_bf16 v[196:199], a[36:39], v[72:75], v[196:199]
ds_read_b128 a[0:3], v1 offset:24576
v_cvt_pk_bf16_f32 v56, v24, v25
v_mfma_f32_16x16x32_bf16 v[200:203], a[40:43], v[72:75], v[200:203]
ds_read_b128 a[4:7], v1 offset:25600
v_cvt_pk_bf16_f32 v57, v26, v27
v_mfma_f32_16x16x32_bf16 v[232:235], a[40:43], v[76:79], v[232:235]
v_exp_f32 v40, v40
v_mfma_f32_16x16x32_bf16 v[236:239], a[44:47], v[76:79], v[236:239]
ds_read_b128 a[8:11], v1 offset:26624
v_cvt_pk_bf16_f32 v60, v28, v29
v_mfma_f32_16x16x32_bf16 v[204:207], a[44:47], v[72:75], v[204:207]
v_exp_f32 v41, v41
v_mfma_f32_16x16x32_bf16 v[208:211], a[48:51], v[72:75], v[208:211]
ds_read_b128 a[12:15], v1 offset:27648
v_cvt_pk_bf16_f32 v61, v30, v31
v_mfma_f32_16x16x32_bf16 v[240:243], a[48:51], v[76:79], v[240:243]
ds_read_b128 a[16:19], v1 offset:28672
v_cvt_pk_bf16_f32 v58, v40, v41
v_mfma_f32_16x16x32_bf16 v[244:247], a[52:55], v[76:79], v[244:247]
v_exp_f32 v42, v42
v_mfma_f32_16x16x32_bf16 v[212:215], a[52:55], v[72:75], v[212:215]
buffer_load_dwordx4 v3, s[48:51], s7 offen offset:1024 sc1 lds
v_mfma_f32_16x16x32_bf16 v[216:219], a[56:59], v[72:75], v[216:219]
ds_read_b128 a[20:23], v1 offset:29696
v_mfma_f32_16x16x32_bf16 v[248:251], a[56:59], v[76:79], v[248:251]
ds_read_b128 a[24:27], v1 offset:30720
v_mfma_f32_16x16x32_bf16 v[252:255], a[60:63], v[76:79], v[252:255]
ds_read_b128 a[28:31], v1 offset:31744
v_mfma_f32_16x16x32_bf16 v[220:223], a[60:63], v[72:75], v[220:223]
s_waitcnt lgkmcnt(4)
v_exp_f32 v43, v43
v_smfmac_f32_16x16x64_bf16 a[228:231], a[232:235], v[72:79], v9
ds_read_b128 a[32:35], v1 offset:16384
v_cvt_pk_bf16_f32 v59, v42, v43
v_mfma_f32_16x16x32_bf16 v[24:27], a[0:3], a[192:195], v[88:91]
ds_read_b128 a[36:39], v1 offset:17408
v_mfma_f32_16x16x32_bf16 v[24:27], a[4:7], a[196:199], v[24:27]
buffer_load_dwordx4 v3, s[48:51], s7 offen offset:2048 sc1 lds
v_mfma_f32_16x16x32_bf16 v[24:27], a[8:11], a[200:203], v[24:27]
ds_read_b128 a[40:43], v1 offset:18432
v_exp_f32 v44, v44
v_mfma_f32_16x16x32_bf16 v[24:27], a[12:15], a[204:207], v[24:27]
ds_read_b128 a[44:47], v1 offset:19456
v_exp_f32 v45, v45
v_mfma_f32_16x16x32_bf16 v[28:31], a[0:3], a[208:211], v[92:95]
ds_read_b128 a[48:51], v1 offset:20480
v_exp_f32 v46, v46
v_mfma_f32_16x16x32_bf16 v[28:31], a[4:7], a[212:215], v[28:31]
s_waitcnt lgkmcnt(5)
v_exp_f32 v47, v47
v_mfma_f32_16x16x32_bf16 v[28:31], a[8:11], a[216:219], v[28:31]
ds_read_b128 a[52:55], v1 offset:21504
v_cvt_pk_bf16_f32 v62, v44, v45
v_mfma_f32_16x16x32_bf16 v[28:31], a[12:15], a[220:223], v[28:31]
ds_read_b128 a[56:59], v1 offset:22528
v_cvt_pk_bf16_f32 v63, v46, v47
v_mfma_f32_16x16x32_bf16 v[40:43], a[16:19], a[192:195], v[88:91]
ds_read_b128 a[60:63], v1 offset:23552
v_xor_b32 v1, 0x8000, v1
v_mfma_f32_16x16x32_bf16 v[40:43], a[20:23], a[196:199], v[40:43]
buffer_load_dwordx4 v3, s[48:51], s7 offen offset:3072 sc1 lds
v_mfma_f32_16x16x32_bf16 v[40:43], a[24:27], a[200:203], v[40:43]
s_add_u32 s7, s7, 0x8000
v_exp_f32 v24, v24
v_mfma_f32_16x16x32_bf16 v[40:43], a[28:31], a[204:207], v[40:43]
s_xor_b32 s27, s27, 0x38000
v_exp_f32 v25, v25
v_mfma_f32_16x16x32_bf16 v[44:47], a[16:19], a[208:211], v[92:95]
s_waitcnt vmcnt(16) lgkmcnt(0)
v_exp_f32 v26, v26
v_mfma_f32_16x16x32_bf16 v[44:47], a[20:23], a[212:215], v[44:47]
s_barrier
v_exp_f32 v27, v27
v_mfma_f32_16x16x32_bf16 v[44:47], a[24:27], a[216:219], v[44:47]
v_exp_f32 v28, v28
v_mfma_f32_16x16x32_bf16 v[44:47], a[28:31], a[220:223], v[44:47]
v_exp_f32 v29, v29
L_att_sodd1:
v_mfma_f32_16x16x32_bf16 v[192:195], a[32:35], v[56:59], v[192:195]
v_exp_f32 v30, v30
v_mfma_f32_16x16x32_bf16 v[224:227], a[32:35], v[60:63], v[224:227]
ds_read_b128 a[0:3], v2 offset:8192
v_cvt_pk_bf16_f32 v72, v24, v25
v_mfma_f32_16x16x32_bf16 v[228:231], a[36:39], v[60:63], v[228:231]
ds_read_b128 a[4:7], v2 offset:9216
v_cvt_pk_bf16_f32 v73, v26, v27
v_mfma_f32_16x16x32_bf16 v[196:199], a[36:39], v[56:59], v[196:199]
s_add_u32 m0, s19, 0x0
v_exp_f32 v31, v31
v_mfma_f32_16x16x32_bf16 v[200:203], a[40:43], v[56:59], v[200:203]
ds_read_b128 a[8:11], v2 offset:10240
v_cvt_pk_bf16_f32 v76, v28, v29
v_mfma_f32_16x16x32_bf16 v[232:235], a[40:43], v[60:63], v[232:235]
buffer_load_dwordx4 v3, s[48:51], s32 offen offset:0 sc1 lds
v_mfma_f32_16x16x32_bf16 v[236:239], a[44:47], v[60:63], v[236:239]
v_exp_f32 v40, v40
v_mfma_f32_16x16x32_bf16 v[204:207], a[44:47], v[56:59], v[204:207]
ds_read_b128 a[12:15], v2 offset:11264
v_cvt_pk_bf16_f32 v77, v30, v31
v_mfma_f32_16x16x32_bf16 v[208:211], a[48:51], v[56:59], v[208:211]
ds_read_b128 a[16:19], v2 offset:12288
v_mfma_f32_16x16x32_bf16 v[240:243], a[48:51], v[60:63], v[240:243]
buffer_load_dwordx4 v3, s[48:51], s32 offen offset:1024 sc1 lds
v_mfma_f32_16x16x32_bf16 v[244:247], a[52:55], v[60:63], v[244:247]
ds_read_b128 a[20:23], v2 offset:13312
v_mfma_f32_16x16x32_bf16 v[212:215], a[52:55], v[56:59], v[212:215]
ds_read_b128 a[24:27], v2 offset:14336
v_mfma_f32_16x16x32_bf16 v[216:219], a[56:59], v[56:59], v[216:219]
ds_read_b128 a[28:31], v2 offset:15360
v_mfma_f32_16x16x32_bf16 v[248:251], a[56:59], v[60:63], v[248:251]
ds_read_b128 a[32:35], v2 offset:0
v_exp_f32 v41, v41
v_mfma_f32_16x16x32_bf16 v[252:255], a[60:63], v[60:63], v[252:255]
v_exp_f32 v42, v42
v_mfma_f32_16x16x32_bf16 v[220:223], a[60:63], v[56:59], v[220:223]
s_waitcnt lgkmcnt(5)
v_exp_f32 v43, v43
v_smfmac_f32_16x16x64_bf16 a[228:231], a[232:235], v[56:63], v9
ds_read_b128 a[36:39], v2 offset:1024
v_cvt_pk_bf16_f32 v74, v40, v41
v_mfma_f32_16x16x32_bf16 v[24:27], a[0:3], a[192:195], v[88:91]
ds_read_b128 a[40:43], v2 offset:2048
v_exp_f32 v44, v44
v_mfma_f32_16x16x32_bf16 v[24:27], a[4:7], a[196:199], v[24:27]
buffer_load_dwordx4 v3, s[48:51], s32 offen offset:2048 sc1 lds
v_mfma_f32_16x16x32_bf16 v[24:27], a[8:11], a[200:203], v[24:27]
v_exp_f32 v45, v45
v_mfma_f32_16x16x32_bf16 v[24:27], a[12:15], a[204:207], v[24:27]
ds_read_b128 a[44:47], v2 offset:3072
v_cvt_pk_bf16_f32 v75, v42, v43
v_mfma_f32_16x16x32_bf16 v[28:31], a[0:3], a[208:211], v[92:95]
ds_read_b128 a[48:51], v2 offset:4096
v_exp_f32 v46, v46
v_mfma_f32_16x16x32_bf16 v[28:31], a[4:7], a[212:215], v[28:31]
s_waitcnt lgkmcnt(5)
v_exp_f32 v47, v47
v_mfma_f32_16x16x32_bf16 v[28:31], a[8:11], a[216:219], v[28:31]
ds_read_b128 a[52:55], v2 offset:5120
v_cvt_pk_bf16_f32 v78, v44, v45
v_mfma_f32_16x16x32_bf16 v[28:31], a[12:15], a[220:223], v[28:31]
buffer_load_dwordx4 v3, s[48:51], s32 offen offset:3072 sc1 lds
v_mfma_f32_16x16x32_bf16 v[40:43], a[16:19], a[192:195], v[88:91]
ds_read_b128 a[56:59], v2 offset:6144
s_add_u32 s32, s32, 0x8000
v_mfma_f32_16x16x32_bf16 v[40:43], a[20:23], a[196:199], v[40:43]
ds_read_b128 a[60:63], v2 offset:7168
v_cvt_pk_bf16_f32 v79, v46, v47
v_mfma_f32_16x16x32_bf16 v[40:43], a[24:27], a[200:203], v[40:43]
v_exp_f32 v24, v24
v_mfma_f32_16x16x32_bf16 v[40:43], a[28:31], a[204:207], v[40:43]
v_exp_f32 v25, v25
v_mfma_f32_16x16x32_bf16 v[44:47], a[16:19], a[208:211], v[92:95]
v_exp_f32 v26, v26
v_mfma_f32_16x16x32_bf16 v[44:47], a[20:23], a[212:215], v[44:47]
v_exp_f32 v27, v27
v_mfma_f32_16x16x32_bf16 v[44:47], a[24:27], a[216:219], v[44:47]
v_exp_f32 v28, v28
v_mfma_f32_16x16x32_bf16 v[44:47], a[28:31], a[220:223], v[44:47]
s_waitcnt lgkmcnt(0)
v_exp_f32 v29, v29
v_mfma_f32_16x16x32_bf16 v[192:195], a[32:35], v[72:75], v[192:195]
v_exp_f32 v30, v30
v_mfma_f32_16x16x32_bf16 v[224:227], a[32:35], v[76:79], v[224:227]
v_exp_f32 v31, v31
v_mfma_f32_16x16x32_bf16 v[228:231], a[36:39], v[76:79], v[228:231]
v_exp_f32 v40, v40
v_mfma_f32_16x16x32_bf16 v[196:199], a[36:39], v[72:75], v[196:199]
s_add_u32 m0, s19, 0x1000
v_exp_f32 v41, v41
v_mfma_f32_16x16x32_bf16 v[200:203], a[40:43], v[72:75], v[200:203]
ds_read_b128 a[0:3], v2 offset:24576
v_cvt_pk_bf16_f32 v56, v24, v25
v_mfma_f32_16x16x32_bf16 v[232:235], a[40:43], v[76:79], v[232:235]
buffer_load_dwordx4 v3, s[48:51], s7 offen offset:0 sc1 lds
v_mfma_f32_16x16x32_bf16 v[236:239], a[44:47], v[76:79], v[236:239]
ds_read_b128 a[4:7], v2 offset:25600
v_cvt_pk_bf16_f32 v57, v26, v27
v_mfma_f32_16x16x32_bf16 v[204:207], a[44:47], v[72:75], v[204:207]
ds_read_b128 a[8:11], v2 offset:26624
v_cvt_pk_bf16_f32 v60, v28, v29
v_mfma_f32_16x16x32_bf16 v[208:211], a[48:51], v[72:75], v[208:211]
ds_read_b128 a[12:15], v2 offset:27648
v_cvt_pk_bf16_f32 v61, v30, v31
v_mfma_f32_16x16x32_bf16 v[240:243], a[48:51], v[76:79], v[240:243]
ds_read_b128 a[16:19], v2 offset:28672
v_cvt_pk_bf16_f32 v58, v40, v41
v_mfma_f32_16x16x32_bf16 v[244:247], a[52:55], v[76:79], v[244:247]
buffer_load_dwordx4 v3, s[48:51], s7 offen offset:1024 sc1 lds
v_mfma_f32_16x16x32_bf16 v[212:215], a[52:55], v[72:75], v[212:215]
ds_read_b128 a[20:23], v2 offset:29696
v_mfma_f32_16x16x32_bf16 v[216:219], a[56:59], v[72:75], v[216:219]
v_exp_f32 v42, v42
v_mfma_f32_16x16x32_bf16 v[248:251], a[56:59], v[76:79], v[248:251]
ds_read_b128 a[24:27], v2 offset:30720
v_mfma_f32_16x16x32_bf16 v[252:255], a[60:63], v[76:79], v[252:255]
ds_read_b128 a[28:31], v2 offset:31744
v_exp_f32 v43, v43
v_mfma_f32_16x16x32_bf16 v[220:223], a[60:63], v[72:75], v[220:223]
ds_read_b128 a[32:35], v2 offset:16384
v_cvt_pk_bf16_f32 v59, v42, v43
v_smfmac_f32_16x16x64_bf16 a[228:231], a[232:235], v[72:79], v9
ds_read_b128 a[36:39], v2 offset:17408
s_waitcnt lgkmcnt(6)
v_mfma_f32_16x16x32_bf16 v[24:27], a[0:3], a[192:195], v[88:91]
buffer_load_dwordx4 v3, s[48:51], s7 offen offset:2048 sc1 lds
v_mfma_f32_16x16x32_bf16 v[24:27], a[4:7], a[196:199], v[24:27]
ds_read_b128 a[40:43], v2 offset:18432
v_exp_f32 v44, v44
v_mfma_f32_16x16x32_bf16 v[24:27], a[8:11], a[200:203], v[24:27]
ds_read_b128 a[44:47], v2 offset:19456
v_exp_f32 v45, v45
v_mfma_f32_16x16x32_bf16 v[24:27], a[12:15], a[204:207], v[24:27]
ds_read_b128 a[48:51], v2 offset:20480
v_cvt_pk_bf16_f32 v62, v44, v45
v_mfma_f32_16x16x32_bf16 v[28:31], a[0:3], a[208:211], v[92:95]
v_exp_f32 v46, v46
v_mfma_f32_16x16x32_bf16 v[28:31], a[4:7], a[212:215], v[28:31]
s_waitcnt lgkmcnt(5)
v_exp_f32 v47, v47
v_mfma_f32_16x16x32_bf16 v[28:31], a[8:11], a[216:219], v[28:31]
ds_read_b128 a[52:55], v2 offset:21504
v_cvt_pk_bf16_f32 v63, v46, v47
v_mfma_f32_16x16x32_bf16 v[28:31], a[12:15], a[220:223], v[28:31]
buffer_load_dwordx4 v3, s[48:51], s7 offen offset:3072 sc1 lds
v_mfma_f32_16x16x32_bf16 v[40:43], a[16:19], a[192:195], v[88:91]
ds_read_b128 a[56:59], v2 offset:22528
s_add_u32 s7, s7, 0x8000
v_mfma_f32_16x16x32_bf16 v[40:43], a[20:23], a[196:199], v[40:43]
ds_read_b128 a[60:63], v2 offset:23552
v_xor_b32 v2, 0x38000, v2
v_mfma_f32_16x16x32_bf16 v[40:43], a[24:27], a[200:203], v[40:43]
s_xor_b32 s19, s19, 0x8000
v_exp_f32 v24, v24
v_mfma_f32_16x16x32_bf16 v[40:43], a[28:31], a[204:207], v[40:43]
s_sub_u32 s15, s15, 1
v_exp_f32 v25, v25
v_mfma_f32_16x16x32_bf16 v[44:47], a[16:19], a[208:211], v[92:95]
s_cmp_lg_u32 s15, 0
s_waitcnt vmcnt(16) lgkmcnt(0)
v_exp_f32 v26, v26
v_mfma_f32_16x16x32_bf16 v[44:47], a[20:23], a[212:215], v[44:47]
s_barrier
v_exp_f32 v27, v27
v_mfma_f32_16x16x32_bf16 v[44:47], a[24:27], a[216:219], v[44:47]
v_exp_f32 v28, v28
v_mfma_f32_16x16x32_bf16 v[44:47], a[28:31], a[220:223], v[44:47]
v_exp_f32 v29, v29
s_cbranch_scc1 L_att_seven1
L_att_sdone:
s_cmp_ge_u32 s4, 2
s_cbranch_scc1 L_att_sh0_1
L_att_sh0_0:
v_mfma_f32_16x16x32_bf16 v[192:195], a[32:35], v[56:59], v[192:195]
v_exp_f32 v30, v30
v_mfma_f32_16x16x32_bf16 v[224:227], a[32:35], v[60:63], v[224:227]
buffer_load_dword v14, v15, s[84:87], 0 offen offset:192 sc1
v_mfma_f32_16x16x32_bf16 v[228:231], a[36:39], v[60:63], v[228:231]
v_exp_f32 v31, v31
v_mfma_f32_16x16x32_bf16 v[196:199], a[36:39], v[56:59], v[196:199]
s_add_u32 m0, s17, 0x10000
v_exp_f32 v40, v40
v_mfma_f32_16x16x32_bf16 v[200:203], a[40:43], v[56:59], v[200:203]
ds_read_b128 a[0:3], v1 offset:8192
v_cvt_pk_bf16_f32 v72, v24, v25
v_mfma_f32_16x16x32_bf16 v[232:235], a[40:43], v[60:63], v[232:235]
ds_read_b128 a[4:7], v1 offset:9216
v_cvt_pk_bf16_f32 v73, v26, v27
v_mfma_f32_16x16x32_bf16 v[236:239], a[44:47], v[60:63], v[236:239]
buffer_load_dwordx4 v12, s[72:75], 0 offen lds
v_mfma_f32_16x16x32_bf16 v[204:207], a[44:47], v[56:59], v[204:207]
ds_read_b128 a[8:11], v1 offset:10240
v_cvt_pk_bf16_f32 v76, v28, v29
v_mfma_f32_16x16x32_bf16 v[208:211], a[48:51], v[56:59], v[208:211]
buffer_load_dwordx4 v13, s[72:75], 0 offen offset:1024 lds
v_mfma_f32_16x16x32_bf16 v[240:243], a[48:51], v[60:63], v[240:243]
ds_read_b128 a[12:15], v1 offset:11264
v_cvt_pk_bf16_f32 v77, v30, v31
v_mfma_f32_16x16x32_bf16 v[244:247], a[52:55], v[60:63], v[244:247]
buffer_load_dwordx4 v12, s[72:75], s12 offen offset:2048 lds
v_mfma_f32_16x16x32_bf16 v[212:215], a[52:55], v[56:59], v[212:215]
ds_read_b128 a[16:19], v1 offset:12288
v_exp_f32 v41, v41
v_mfma_f32_16x16x32_bf16 v[216:219], a[56:59], v[56:59], v[216:219]
ds_read_b128 a[20:23], v1 offset:13312
v_exp_f32 v42, v42
v_mfma_f32_16x16x32_bf16 v[248:251], a[56:59], v[60:63], v[248:251]
buffer_load_dwordx4 v13, s[72:75], s12 offen offset:3072 lds
v_mfma_f32_16x16x32_bf16 v[252:255], a[60:63], v[60:63], v[252:255]
ds_read_b128 a[24:27], v1 offset:14336
s_waitcnt lgkmcnt(3)
v_mfma_f32_16x16x32_bf16 v[220:223], a[60:63], v[56:59], v[220:223]
ds_read_b128 a[28:31], v1 offset:15360
v_add_u32 v12, 0x20000, v12
v_smfmac_f32_16x16x64_bf16 a[228:231], a[232:235], v[56:63], v9
s_add_u32 m0, s17, 0x14000
v_exp_f32 v43, v43
v_mfma_f32_16x16x32_bf16 v[24:27], a[0:3], a[192:195], v[112:115]
buffer_load_dwordx4 v12, s[72:75], 0 offen lds
v_mfma_f32_16x16x32_bf16 v[24:27], a[4:7], a[196:199], v[24:27]
ds_read_b128 a[32:35], v1 offset:0
v_cvt_pk_bf16_f32 v74, v40, v41
v_mfma_f32_16x16x32_bf16 v[24:27], a[8:11], a[200:203], v[24:27]
ds_read_b128 a[36:39], v1 offset:1024
v_exp_f32 v44, v44
v_mfma_f32_16x16x32_bf16 v[24:27], a[12:15], a[204:207], v[24:27]
ds_read_b128 a[40:43], v1 offset:2048
v_exp_f32 v45, v45
v_mfma_f32_16x16x32_bf16 v[28:31], a[0:3], a[208:211], v[92:95]
ds_read_b128 a[44:47], v1 offset:3072
v_exp_f32 v46, v46
v_mfma_f32_16x16x32_bf16 v[28:31], a[4:7], a[212:215], v[28:31]
s_waitcnt lgkmcnt(4)
v_exp_f32 v47, v47
v_mfma_f32_16x16x32_bf16 v[28:31], a[8:11], a[216:219], v[28:31]
ds_read_b128 a[48:51], v1 offset:4096
v_add_u32 v13, 0x20000, v13
v_mfma_f32_16x16x32_bf16 v[28:31], a[12:15], a[220:223], v[28:31]
buffer_load_dwordx4 v13, s[72:75], 0 offen offset:1024 lds
v_cvt_pk_bf16_f32 v75, v42, v43
v_mfma_f32_16x16x32_bf16 v[40:43], a[16:19], a[192:195], v[116:119]
ds_read_b128 a[52:55], v1 offset:5120
v_exp_f32 v24, v24
v_mfma_f32_16x16x32_bf16 v[40:43], a[20:23], a[196:199], v[40:43]
buffer_load_dwordx4 v12, s[72:75], s12 offen offset:2048 lds
v_mfma_f32_16x16x32_bf16 v[40:43], a[24:27], a[200:203], v[40:43]
ds_read_b128 a[56:59], v1 offset:6144
v_exp_f32 v25, v25
v_mfma_f32_16x16x32_bf16 v[40:43], a[28:31], a[204:207], v[40:43]
ds_read_b128 a[60:63], v1 offset:7168
v_cvt_pk_bf16_f32 v78, v44, v45
v_cvt_pk_bf16_f32 v79, v46, v47
v_mfma_f32_16x16x32_bf16 v[44:47], a[16:19], a[208:211], v[92:95]
buffer_load_dwordx4 v13, s[72:75], s12 offen offset:3072 lds
v_mfma_f32_16x16x32_bf16 v[44:47], a[20:23], a[212:215], v[44:47]
v_exp_f32 v26, v26
v_mfma_f32_16x16x32_bf16 v[44:47], a[24:27], a[216:219], v[44:47]
v_exp_f32 v27, v27
v_mfma_f32_16x16x32_bf16 v[44:47], a[28:31], a[220:223], v[44:47]
s_waitcnt lgkmcnt(0)
v_exp_f32 v28, v28
v_exp_f32 v29, v29
v_mfma_f32_16x16x32_bf16 v[192:195], a[32:35], v[72:75], v[192:195]
ds_read_b128 a[0:3], v1 offset:24576
v_cvt_pk_bf16_f32 v56, v24, v25
v_mfma_f32_16x16x32_bf16 v[224:227], a[32:35], v[76:79], v[224:227]
ds_read_b128 a[4:7], v1 offset:25600
v_add_u32 v12, 0x20000, v12
v_mfma_f32_16x16x32_bf16 v[228:231], a[36:39], v[76:79], v[228:231]
s_add_u32 m0, s16, 0x0
v_exp_f32 v30, v30
v_mfma_f32_16x16x32_bf16 v[196:199], a[36:39], v[72:75], v[196:199]
buffer_load_dwordx4 v12, s[72:75], 0 offen lds
v_mfma_f32_16x16x32_bf16 v[200:203], a[40:43], v[72:75], v[200:203]
ds_read_b128 a[8:11], v1 offset:26624
v_add_u32 v13, 0x20000, v13
v_mfma_f32_16x16x32_bf16 v[232:235], a[40:43], v[76:79], v[232:235]
buffer_load_dwordx4 v13, s[72:75], 0 offen offset:1024 lds
v_mfma_f32_16x16x32_bf16 v[236:239], a[44:47], v[76:79], v[236:239]
ds_read_b128 a[12:15], v1 offset:27648
v_cvt_pk_bf16_f32 v57, v26, v27
v_mfma_f32_16x16x32_bf16 v[204:207], a[44:47], v[72:75], v[204:207]
buffer_load_dwordx4 v12, s[72:75], s12 offen offset:2048 lds
v_mfma_f32_16x16x32_bf16 v[208:211], a[48:51], v[72:75], v[208:211]
ds_read_b128 a[16:19], v1 offset:28672
v_cvt_pk_bf16_f32 v60, v28, v29
v_mfma_f32_16x16x32_bf16 v[240:243], a[48:51], v[76:79], v[240:243]
buffer_load_dwordx4 v13, s[72:75], s12 offen offset:3072 lds
v_mfma_f32_16x16x32_bf16 v[244:247], a[52:55], v[76:79], v[244:247]
ds_read_b128 a[20:23], v1 offset:29696
v_exp_f32 v31, v31
v_mfma_f32_16x16x32_bf16 v[212:215], a[52:55], v[72:75], v[212:215]
ds_read_b128 a[24:27], v1 offset:30720
s_add_u32 m0, s16, 0x4000
v_mfma_f32_16x16x32_bf16 v[216:219], a[56:59], v[72:75], v[216:219]
ds_read_b128 a[28:31], v1 offset:31744
v_add_u32 v12, 0x20000, v12
v_mfma_f32_16x16x32_bf16 v[248:251], a[56:59], v[76:79], v[248:251]
buffer_load_dwordx4 v12, s[72:75], 0 offen lds
v_mfma_f32_16x16x32_bf16 v[252:255], a[60:63], v[76:79], v[252:255]
ds_read_b128 a[32:35], v1 offset:16384
s_waitcnt lgkmcnt(5)
v_mfma_f32_16x16x32_bf16 v[220:223], a[60:63], v[72:75], v[220:223]
ds_read_b128 a[36:39], v1 offset:17408
v_add_u32 v13, 0x20000, v13
v_smfmac_f32_16x16x64_bf16 a[228:231], a[232:235], v[72:79], v9
buffer_load_dwordx4 v13, s[72:75], 0 offen offset:1024 lds
v_cvt_pk_bf16_f32 v61, v30, v31
v_mfma_f32_16x16x32_bf16 v[28:31], a[0:3], a[208:211], v[92:95]
ds_read_b128 a[40:43], v1 offset:18432
v_exp_f32 v40, v40
v_mfma_f32_16x16x32_bf16 v[28:31], a[4:7], a[212:215], v[28:31]
buffer_load_dwordx4 v12, s[72:75], s12 offen offset:2048 lds
v_mfma_f32_16x16x32_bf16 v[28:31], a[8:11], a[216:219], v[28:31]
ds_read_b128 a[44:47], v1 offset:19456
v_exp_f32 v41, v41
v_mfma_f32_16x16x32_bf16 v[28:31], a[12:15], a[220:223], v[28:31]
ds_read_b128 a[48:51], v1 offset:20480
s_waitcnt lgkmcnt(5)
v_exp_f32 v42, v42
v_exp_f32 v43, v43
v_exp_f32 v44, v44
v_exp_f32 v45, v45
v_exp_f32 v46, v46
v_exp_f32 v47, v47
v_cvt_pk_bf16_f32 v62, v44, v45
v_cvt_pk_bf16_f32 v63, v46, v47
v_mfma_f32_16x16x32_bf16 v[44:47], a[16:19], a[208:211], v[92:95]
buffer_load_dwordx4 v13, s[72:75], s12 offen offset:3072 lds
v_mfma_f32_16x16x32_bf16 v[44:47], a[20:23], a[212:215], v[44:47]
ds_read_b128 a[52:55], v1 offset:21504
v_cvt_pk_bf16_f32 v58, v40, v41
v_mfma_f32_16x16x32_bf16 v[44:47], a[24:27], a[216:219], v[44:47]
ds_read_b128 a[56:59], v1 offset:22528
v_cvt_pk_bf16_f32 v59, v42, v43
v_mfma_f32_16x16x32_bf16 v[44:47], a[28:31], a[220:223], v[44:47]
ds_read_b128 a[60:63], v1 offset:23552
v_xor_b32 v1, 0x8000, v1
L_att_h1_0:
s_waitcnt vmcnt(16) lgkmcnt(0)
s_mov_b32 s92, 200000
L_spin_b0:
v_cmp_gt_u32 vcc, 32, v14
s_nop 4
s_cbranch_vccz L_spun_b0
s_sub_u32 s92, s92, 1
s_cbranch_scc1 L_spun_b0
s_sleep 6
buffer_load_dword v14, v15, s[84:87], 0 offen offset:192 sc1
s_waitcnt vmcnt(0)
s_branch L_spin_b0
L_spun_b0:
s_barrier
v_mfma_f32_16x16x32_bf16 v[192:195], a[32:35], v[56:59], v[192:195]
ds_read_b128 a[0:3], v2 offset:8192
v_exp_f32 v28, v28
v_mfma_f32_16x16x32_bf16 v[224:227], a[32:35], v[60:63], v[224:227]
ds_read_b128 a[4:7], v2 offset:9216
v_exp_f32 v29, v29
v_mfma_f32_16x16x32_bf16 v[228:231], a[36:39], v[60:63], v[228:231]
s_add_u32 s101, s101, 0x2000
v_exp_f32 v30, v30
v_mfma_f32_16x16x32_bf16 v[196:199], a[36:39], v[56:59], v[196:199]
buffer_load_dwordx4 a[64:67], v3, s[88:91], s101 offen sc1
v_mfma_f32_16x16x32_bf16 v[200:203], a[40:43], v[56:59], v[200:203]
ds_read_b128 a[8:11], v2 offset:10240
v_exp_f32 v31, v31
v_mfma_f32_16x16x32_bf16 v[232:235], a[40:43], v[60:63], v[232:235]
buffer_load_dwordx4 a[68:71], v3, s[88:91], s101 offen offset:1024 sc1
v_mfma_f32_16x16x32_bf16 v[236:239], a[44:47], v[60:63], v[236:239]
ds_read_b128 a[12:15], v2 offset:11264
s_add_u32 s101, s101, 0x2000
v_mfma_f32_16x16x32_bf16 v[204:207], a[44:47], v[56:59], v[204:207]
buffer_load_dwordx4 a[72:75], v3, s[88:91], s101 offen sc1
v_mfma_f32_16x16x32_bf16 v[208:211], a[48:51], v[56:59], v[208:211]
ds_read_b128 a[16:19], v2 offset:12288
v_cvt_pk_bf16_f32 v76, v28, v29
v_mfma_f32_16x16x32_bf16 v[240:243], a[48:51], v[60:63], v[240:243]
buffer_load_dwordx4 a[76:79], v3, s[88:91], s101 offen offset:1024 sc1
v_mfma_f32_16x16x32_bf16 v[244:247], a[52:55], v[60:63], v[244:247]
ds_read_b128 a[20:23], v2 offset:13312
v_exp_f32 v44, v44
v_mfma_f32_16x16x32_bf16 v[212:215], a[52:55], v[56:59], v[212:215]
ds_read_b128 a[24:27], v2 offset:14336
v_exp_f32 v45, v45
v_mfma_f32_16x16x32_bf16 v[216:219], a[56:59], v[56:59], v[216:219]
ds_read_b128 a[28:31], v2 offset:15360
s_add_u32 s101, s101, 0x2000
v_mfma_f32_16x16x32_bf16 v[248:251], a[56:59], v[60:63], v[248:251]
buffer_load_dwordx4 a[80:83], v3, s[88:91], s101 offen sc1
v_mfma_f32_16x16x32_bf16 v[252:255], a[60:63], v[60:63], v[252:255]
ds_read_b128 a[32:35], v2 offset:0
v_cvt_pk_bf16_f32 v77, v30, v31
v_mfma_f32_16x16x32_bf16 v[220:223], a[60:63], v[56:59], v[220:223]
ds_read_b128 a[36:39], v2 offset:1024
s_waitcnt lgkmcnt(6)
v_smfmac_f32_16x16x64_bf16 a[228:231], a[232:235], v[56:63], v9
buffer_load_dwordx4 a[84:87], v3, s[88:91], s101 offen offset:1024 sc1
v_mfma_f32_16x16x32_bf16 v[28:31], a[0:3], a[208:211], v[92:95]
ds_read_b128 a[40:43], v2 offset:2048
v_exp_f32 v46, v46
v_mfma_f32_16x16x32_bf16 v[28:31], a[4:7], a[212:215], v[28:31]
ds_read_b128 a[44:47], v2 offset:3072
s_add_u32 s101, s101, 0x2000
v_mfma_f32_16x16x32_bf16 v[28:31], a[8:11], a[216:219], v[28:31]
buffer_load_dwordx4 a[88:91], v3, s[88:91], s101 offen sc1
v_mfma_f32_16x16x32_bf16 v[28:31], a[12:15], a[220:223], v[28:31]
ds_read_b128 a[48:51], v2 offset:4096
s_waitcnt lgkmcnt(5)
v_exp_f32 v47, v47
v_cvt_pk_bf16_f32 v78, v44, v45
v_cvt_pk_bf16_f32 v79, v46, v47
v_mfma_f32_16x16x32_bf16 v[44:47], a[16:19], a[208:211], v[92:95]
ds_read_b128 a[52:55], v2 offset:5120
v_mfma_f32_16x16x32_bf16 v[44:47], a[20:23], a[212:215], v[44:47]
buffer_load_dwordx4 a[92:95], v3, s[88:91], s101 offen offset:1024 sc1
v_mfma_f32_16x16x32_bf16 v[44:47], a[24:27], a[216:219], v[44:47]
ds_read_b128 a[56:59], v2 offset:6144
v_mfma_f32_16x16x32_bf16 v[44:47], a[28:31], a[220:223], v[44:47]
ds_read_b128 a[60:63], v2 offset:7168
s_waitcnt lgkmcnt(0)
v_mfma_f32_16x16x32_bf16 v[224:227], a[32:35], v[76:79], v[224:227]
ds_read_b128 a[0:3], v2 offset:24576
s_add_u32 s101, s101, 0x2000
v_mfma_f32_16x16x32_bf16 v[228:231], a[36:39], v[76:79], v[228:231]
buffer_load_dwordx4 a[96:99], v3, s[88:91], s101 offen sc1
v_mfma_f32_16x16x32_bf16 v[232:235], a[40:43], v[76:79], v[232:235]
ds_read_b128 a[4:7], v2 offset:25600
v_exp_f32 v28, v28
v_mfma_f32_16x16x32_bf16 v[236:239], a[44:47], v[76:79], v[236:239]
buffer_load_dwordx4 a[100:103], v3, s[88:91], s101 offen offset:1024 sc1
v_mfma_f32_16x16x32_bf16 v[240:243], a[48:51], v[76:79], v[240:243]
ds_read_b128 a[8:11], v2 offset:26624
s_add_u32 s101, s101, 0x2000
v_mfma_f32_16x16x32_bf16 v[244:247], a[52:55], v[76:79], v[244:247]
buffer_load_dwordx4 a[104:107], v3, s[88:91], s101 offen sc1
v_mfma_f32_16x16x32_bf16 v[248:251], a[56:59], v[76:79], v[248:251]
ds_read_b128 a[12:15], v2 offset:27648
s_waitcnt lgkmcnt(0)
v_mfma_f32_16x16x32_bf16 v[252:255], a[60:63], v[76:79], v[252:255]
buffer_load_dwordx4 a[108:111], v3, s[88:91], s101 offen offset:1024 sc1
ds_read_b128 a[16:19], v2 offset:28672
v_mfma_f32_16x16x32_bf16 a[228:231], a[236:239], v[76:79], a[228:231]
ds_read_b128 a[20:23], v2 offset:29696
s_add_u32 s101, s101, 0x2000
v_exp_f32 v29, v29
v_exp_f32 v30, v30
v_exp_f32 v31, v31
v_cvt_pk_bf16_f32 v60, v28, v29
v_cvt_pk_bf16_f32 v61, v30, v31
v_mfma_f32_16x16x32_bf16 v[28:31], a[0:3], a[208:211], v[120:123]
buffer_load_dwordx4 a[112:115], v3, s[88:91], s101 offen sc1
ds_read_b128 a[24:27], v2 offset:30720
v_mfma_f32_16x16x32_bf16 v[28:31], a[4:7], a[212:215], v[28:31]
ds_read_b128 a[28:31], v2 offset:31744
s_waitcnt lgkmcnt(0)
v_mfma_f32_16x16x32_bf16 v[28:31], a[8:11], a[216:219], v[28:31]
buffer_load_dwordx4 a[116:119], v3, s[88:91], s101 offen offset:1024 sc1
v_mfma_f32_16x16x32_bf16 v[28:31], a[12:15], a[220:223], v[28:31]
ds_read_b128 a[32:35], v2 offset:16384
s_add_u32 s101, s101, 0x2000
v_exp_f32 v44, v44
v_exp_f32 v45, v45
v_exp_f32 v46, v46
v_exp_f32 v47, v47
v_cvt_pk_bf16_f32 v62, v44, v45
v_cvt_pk_bf16_f32 v63, v46, v47
v_mfma_f32_16x16x32_bf16 v[44:47], a[16:19], a[208:211], v[124:127]
buffer_load_dwordx4 a[120:123], v3, s[88:91], s101 offen sc1
v_mfma_f32_16x16x32_bf16 v[44:47], a[20:23], a[212:215], v[44:47]
buffer_load_dwordx4 a[124:127], v3, s[88:91], s101 offen offset:1024 sc1
v_mfma_f32_16x16x32_bf16 v[44:47], a[24:27], a[216:219], v[44:47]
ds_read_b128 a[36:39], v2 offset:17408
v_mfma_f32_16x16x32_bf16 v[44:47], a[28:31], a[220:223], v[44:47]
ds_read_b128 a[40:43], v2 offset:18432
ds_read_b128 a[44:47], v2 offset:19456
ds_read_b128 a[48:51], v2 offset:20480
ds_read_b128 a[52:55], v2 offset:21504
ds_read_b128 a[56:59], v2 offset:22528
ds_read_b128 a[60:63], v2 offset:23552
v_xor_b32 v2, 0x38000, v2
s_waitcnt lgkmcnt(0)
s_barrier
v_accvgpr_read_b32 v6, a228
v_accvgpr_read_b32 v7, a229
v_add_f32 v6, v6, v7
v_cmp_nge_f32 vcc, 0x5f800000, v6
v_rcp_f32 v6, v6
s_or_b64 s[34:35], s[34:35], vcc
v_mfma_f32_16x16x32_bf16 v[224:227], a[32:35], v[60:63], v[224:227]
ds_read_b128 a[32:35], v1 offset:0
v_exp_f32 v28, v28
v_mfma_f32_16x16x32_bf16 v[228:231], a[36:39], v[60:63], v[228:231]
ds_read_b128 a[36:39], v1 offset:1024
v_exp_f32 v29, v29
v_mfma_f32_16x16x32_bf16 v[232:235], a[40:43], v[60:63], v[232:235]
ds_read_b128 a[40:43], v1 offset:2048
v_exp_f32 v30, v30
v_mfma_f32_16x16x32_bf16 v[236:239], a[44:47], v[60:63], v[236:239]
ds_read_b128 a[44:47], v1 offset:3072
v_exp_f32 v31, v31
v_mfma_f32_16x16x32_bf16 v[240:243], a[48:51], v[60:63], v[240:243]
ds_read_b128 a[48:51], v1 offset:4096
v_exp_f32 v44, v44
v_mfma_f32_16x16x32_bf16 v[244:247], a[52:55], v[60:63], v[244:247]
ds_read_b128 a[52:55], v1 offset:5120
v_exp_f32 v45, v45
v_mfma_f32_16x16x32_bf16 v[248:251], a[56:59], v[60:63], v[248:251]
ds_read_b128 a[56:59], v1 offset:6144
v_exp_f32 v46, v46
v_mfma_f32_16x16x32_bf16 v[252:255], a[60:63], v[60:63], v[252:255]
ds_read_b128 a[60:63], v1 offset:7168
v_exp_f32 v47, v47
v_mfma_f32_16x16x32_bf16 a[228:231], a[236:239], v[60:63], a[228:231]
v_cvt_pk_bf16_f32 v76, v28, v29
v_cvt_pk_bf16_f32 v77, v30, v31
v_cvt_pk_bf16_f32 v78, v44, v45
v_cvt_pk_bf16_f32 v79, v46, v47
s_add_u32 s8, s30, 0x0
v_pk_mul_f32 v[192:193], v[192:193], v[6:7] op_sel_hi:[1,0]
v_pk_mul_f32 v[194:195], v[194:195], v[6:7] op_sel_hi:[1,0]
v_pk_mul_f32 v[196:197], v[196:197], v[6:7] op_sel_hi:[1,0]
v_pk_mul_f32 v[198:199], v[198:199], v[6:7] op_sel_hi:[1,0]
v_cvt_pk_bf16_f32 v192, v192, v193
v_cvt_pk_bf16_f32 v193, v194, v195
v_cvt_pk_bf16_f32 v194, v196, v197
v_cvt_pk_bf16_f32 v195, v198, v199
buffer_store_dwordx4 v[192:195], v3, s[88:91], s8 offen sc1
s_add_u32 s8, s30, 0x2000
v_pk_mul_f32 v[200:201], v[200:201], v[6:7] op_sel_hi:[1,0]
v_pk_mul_f32 v[202:203], v[202:203], v[6:7] op_sel_hi:[1,0]
v_pk_mul_f32 v[204:205], v[204:205], v[6:7] op_sel_hi:[1,0]
v_pk_mul_f32 v[206:207], v[206:207], v[6:7] op_sel_hi:[1,0]
v_cvt_pk_bf16_f32 v200, v200, v201
v_cvt_pk_bf16_f32 v201, v202, v203
v_cvt_pk_bf16_f32 v202, v204, v205
v_cvt_pk_bf16_f32 v203, v206, v207
buffer_store_dwordx4 v[200:203], v3, s[88:91], s8 offen sc1
s_waitcnt lgkmcnt(0)
v_mfma_f32_16x16x32_bf16 v[224:227], a[32:35], v[76:79], v[224:227]
s_add_u32 s8, s30, 0x4000
v_mul_f32 v208, v6, v208
v_mfma_f32_16x16x32_bf16 v[228:231], a[36:39], v[76:79], v[228:231]
v_mul_f32 v209, v6, v209
v_mul_f32 v210, v6, v210
v_mfma_f32_16x16x32_bf16 v[232:235], a[40:43], v[76:79], v[232:235]
v_mul_f32 v211, v6, v211
v_mul_f32 v212, v6, v212
v_mfma_f32_16x16x32_bf16 v[236:239], a[44:47], v[76:79], v[236:239]
v_mul_f32 v213, v6, v213
v_mul_f32 v214, v6, v214
v_mfma_f32_16x16x32_bf16 v[240:243], a[48:51], v[76:79], v[240:243]
v_mul_f32 v215, v6, v215
v_cvt_pk_bf16_f32 v208, v208, v209
v_mfma_f32_16x16x32_bf16 v[244:247], a[52:55], v[76:79], v[244:247]
v_cvt_pk_bf16_f32 v209, v210, v211
v_cvt_pk_bf16_f32 v210, v212, v213
v_mfma_f32_16x16x32_bf16 v[248:251], a[56:59], v[76:79], v[248:251]
v_cvt_pk_bf16_f32 v211, v214, v215
buffer_store_dwordx4 v[208:211], v3, s[88:91], s8 offen sc1
v_mfma_f32_16x16x32_bf16 v[252:255], a[60:63], v[76:79], v[252:255]
s_add_u32 s8, s30, 0x6000
v_mul_f32 v216, v6, v216
v_mfma_f32_16x16x32_bf16 a[228:231], a[236:239], v[76:79], a[228:231]
v_mul_f32 v217, v6, v217
v_mul_f32 v218, v6, v218
v_mul_f32 v219, v6, v219
v_mul_f32 v220, v6, v220
v_mul_f32 v221, v6, v221
v_mul_f32 v222, v6, v222
v_mul_f32 v223, v6, v223
v_cvt_pk_bf16_f32 v216, v216, v217
v_cvt_pk_bf16_f32 v217, v218, v219
v_cvt_pk_bf16_f32 v218, v220, v221
v_cvt_pk_bf16_f32 v219, v222, v223
buffer_store_dwordx4 v[216:219], v3, s[88:91], s8 offen sc1
s_branch L_att_fin
L_att_sh0_1:
v_mfma_f32_16x16x32_bf16 v[192:195], a[32:35], v[56:59], v[192:195]
v_exp_f32 v30, v30
v_mfma_f32_16x16x32_bf16 v[224:227], a[32:35], v[60:63], v[224:227]
buffer_load_dword v14, v15, s[84:87], 0 offen offset:192 sc1
v_mfma_f32_16x16x32_bf16 v[228:231], a[36:39], v[60:63], v[228:231]
v_exp_f32 v31, v31
v_mfma_f32_16x16x32_bf16 v[196:199], a[36:39], v[56:59], v[196:199]
s_add_u32 m0, s17, 0x10000
v_exp_f32 v40, v40
v_mfma_f32_16x16x32_bf16 v[200:203], a[40:43], v[56:59], v[200:203]
ds_read_b128 a[0:3], v1 offset:8192
v_cvt_pk_bf16_f32 v72, v24, v25
v_mfma_f32_16x16x32_bf16 v[232:235], a[40:43], v[60:63], v[232:235]
ds_read_b128 a[4:7], v1 offset:9216
v_cvt_pk_bf16_f32 v73, v26, v27
v_mfma_f32_16x16x32_bf16 v[236:239], a[44:47], v[60:63], v[236:239]
buffer_load_dwordx4 v12, s[72:75], 0 offen lds
v_mfma_f32_16x16x32_bf16 v[204:207], a[44:47], v[56:59], v[204:207]
ds_read_b128 a[8:11], v1 offset:10240
v_cvt_pk_bf16_f32 v76, v28, v29
v_mfma_f32_16x16x32_bf16 v[208:211], a[48:51], v[56:59], v[208:211]
buffer_load_dwordx4 v13, s[72:75], 0 offen offset:1024 lds
v_mfma_f32_16x16x32_bf16 v[240:243], a[48:51], v[60:63], v[240:243]
ds_read_b128 a[12:15], v1 offset:11264
v_cvt_pk_bf16_f32 v77, v30, v31
v_mfma_f32_16x16x32_bf16 v[244:247], a[52:55], v[60:63], v[244:247]
buffer_load_dwordx4 v12, s[72:75], s12 offen offset:2048 lds
v_mfma_f32_16x16x32_bf16 v[212:215], a[52:55], v[56:59], v[212:215]
ds_read_b128 a[16:19], v1 offset:12288
v_exp_f32 v41, v41
v_mfma_f32_16x16x32_bf16 v[216:219], a[56:59], v[56:59], v[216:219]
ds_read_b128 a[20:23], v1 offset:13312
v_exp_f32 v42, v42
v_mfma_f32_16x16x32_bf16 v[248:251], a[56:59], v[60:63], v[248:251]
buffer_load_dwordx4 v13, s[72:75], s12 offen offset:3072 lds
v_mfma_f32_16x16x32_bf16 v[252:255], a[60:63], v[60:63], v[252:255]
ds_read_b128 a[24:27], v1 offset:14336
s_waitcnt lgkmcnt(3)
v_mfma_f32_16x16x32_bf16 v[220:223], a[60:63], v[56:59], v[220:223]
ds_read_b128 a[28:31], v1 offset:15360
v_add_u32 v12, 0x20000, v12
v_smfmac_f32_16x16x64_bf16 a[228:231], a[232:235], v[56:63], v9
s_add_u32 m0, s17, 0x14000
v_exp_f32 v43, v43
v_mfma_f32_16x16x32_bf16 v[24:27], a[0:3], a[192:195], v[88:91]
buffer_load_dwordx4 v12, s[72:75], 0 offen lds
v_mfma_f32_16x16x32_bf16 v[24:27], a[4:7], a[196:199], v[24:27]
ds_read_b128 a[32:35], v1 offset:0
v_cvt_pk_bf16_f32 v74, v40, v41
v_mfma_f32_16x16x32_bf16 v[24:27], a[8:11], a[200:203], v[24:27]
ds_read_b128 a[36:39], v1 offset:1024
v_exp_f32 v44, v44
v_mfma_f32_16x16x32_bf16 v[24:27], a[12:15], a[204:207], v[24:27]
ds_read_b128 a[40:43], v1 offset:2048
v_exp_f32 v45, v45
v_mfma_f32_16x16x32_bf16 v[28:31], a[0:3], a[208:211], v[92:95]
ds_read_b128 a[44:47], v1 offset:3072
v_exp_f32 v46, v46
v_mfma_f32_16x16x32_bf16 v[28:31], a[4:7], a[212:215], v[28:31]
s_waitcnt lgkmcnt(4)
v_exp_f32 v47, v47
v_mfma_f32_16x16x32_bf16 v[28:31], a[8:11], a[216:219], v[28:31]
ds_read_b128 a[48:51], v1 offset:4096
v_add_u32 v13, 0x20000, v13
v_mfma_f32_16x16x32_bf16 v[28:31], a[12:15], a[220:223], v[28:31]
buffer_load_dwordx4 v13, s[72:75], 0 offen offset:1024 lds
v_cvt_pk_bf16_f32 v75, v42, v43
v_mfma_f32_16x16x32_bf16 v[40:43], a[16:19], a[192:195], v[88:91]
ds_read_b128 a[52:55], v1 offset:5120
v_exp_f32 v24, v24
v_mfma_f32_16x16x32_bf16 v[40:43], a[20:23], a[196:199], v[40:43]
buffer_load_dwordx4 v12, s[72:75], s12 offen offset:2048 lds
v_mfma_f32_16x16x32_bf16 v[40:43], a[24:27], a[200:203], v[40:43]
ds_read_b128 a[56:59], v1 offset:6144
v_exp_f32 v25, v25
v_mfma_f32_16x16x32_bf16 v[40:43], a[28:31], a[204:207], v[40:43]
ds_read_b128 a[60:63], v1 offset:7168
v_cvt_pk_bf16_f32 v78, v44, v45
v_cvt_pk_bf16_f32 v79, v46, v47
v_mfma_f32_16x16x32_bf16 v[44:47], a[16:19], a[208:211], v[92:95]
buffer_load_dwordx4 v13, s[72:75], s12 offen offset:3072 lds
v_mfma_f32_16x16x32_bf16 v[44:47], a[20:23], a[212:215], v[44:47]
v_exp_f32 v26, v26
v_mfma_f32_16x16x32_bf16 v[44:47], a[24:27], a[216:219], v[44:47]
v_exp_f32 v27, v27
v_mfma_f32_16x16x32_bf16 v[44:47], a[28:31], a[220:223], v[44:47]
s_waitcnt lgkmcnt(0)
v_exp_f32 v28, v28
v_exp_f32 v29, v29
v_mfma_f32_16x16x32_bf16 v[192:195], a[32:35], v[72:75], v[192:195]
s_add_u32 m0, s16, 0x0
v_add_u32 v12, 0x20000, v12
v_cvt_pk_bf16_f32 v56, v24, v25
v_mfma_f32_16x16x32_bf16 v[224:227], a[32:35], v[76:79], v[224:227]
buffer_load_dwordx4 v12, s[72:75], 0 offen lds
v_mfma_f32_16x16x32_bf16 v[228:231], a[36:39], v[76:79], v[228:231]
ds_read_b128 a[0:3], v1 offset:24576
v_cvt_pk_bf16_f32 v57, v26, v27
v_mfma_f32_16x16x32_bf16 v[196:199], a[36:39], v[72:75], v[196:199]
v_exp_f32 v30, v30
v_mfma_f32_16x16x32_bf16 v[200:203], a[40:43], v[72:75], v[200:203]
ds_read_b128 a[4:7], v1 offset:25600
v_cvt_pk_bf16_f32 v60, v28, v29
v_mfma_f32_16x16x32_bf16 v[232:235], a[40:43], v[76:79], v[232:235]
ds_read_b128 a[8:11], v1 offset:26624
v_add_u32 v13, 0x20000, v13
v_mfma_f32_16x16x32_bf16 v[236:239], a[44:47], v[76:79], v[236:239]
buffer_load_dwordx4 v13, s[72:75], 0 offen offset:1024 lds
v_mfma_f32_16x16x32_bf16 v[204:207], a[44:47], v[72:75], v[204:207]
ds_read_b128 a[12:15], v1 offset:27648
v_exp_f32 v31, v31
v_mfma_f32_16x16x32_bf16 v[208:211], a[48:51], v[72:75], v[208:211]
buffer_load_dwordx4 v12, s[72:75], s12 offen offset:2048 lds
v_mfma_f32_16x16x32_bf16 v[240:243], a[48:51], v[76:79], v[240:243]
ds_read_b128 a[16:19], v1 offset:28672
v_exp_f32 v40, v40
v_mfma_f32_16x16x32_bf16 v[244:247], a[52:55], v[76:79], v[244:247]
ds_read_b128 a[20:23], v1 offset:29696
v_cvt_pk_bf16_f32 v61, v30, v31
v_mfma_f32_16x16x32_bf16 v[212:215], a[52:55], v[72:75], v[212:215]
buffer_load_dwordx4 v13, s[72:75], s12 offen offset:3072 lds
v_mfma_f32_16x16x32_bf16 v[216:219], a[56:59], v[72:75], v[216:219]
ds_read_b128 a[24:27], v1 offset:30720
v_exp_f32 v41, v41
v_mfma_f32_16x16x32_bf16 v[248:251], a[56:59], v[76:79], v[248:251]
ds_read_b128 a[28:31], v1 offset:31744
v_exp_f32 v42, v42
v_mfma_f32_16x16x32_bf16 v[252:255], a[60:63], v[76:79], v[252:255]
ds_read_b128 a[32:35], v1 offset:16384
v_cvt_pk_bf16_f32 v58, v40, v41
v_mfma_f32_16x16x32_bf16 v[220:223], a[60:63], v[72:75], v[220:223]
s_waitcnt lgkmcnt(5)
v_exp_f32 v43, v43
v_smfmac_f32_16x16x64_bf16 a[228:231], a[232:235], v[72:79], v9
ds_read_b128 a[36:39], v1 offset:17408
v_add_u32 v12, 0x20000, v12
v_mfma_f32_16x16x32_bf16 v[24:27], a[0:3], a[192:195], v[112:115]
s_add_u32 m0, s16, 0x4000
v_exp_f32 v44, v44
v_mfma_f32_16x16x32_bf16 v[24:27], a[4:7], a[196:199], v[24:27]
buffer_load_dwordx4 v12, s[72:75], 0 offen lds
v_mfma_f32_16x16x32_bf16 v[24:27], a[8:11], a[200:203], v[24:27]
ds_read_b128 a[40:43], v1 offset:18432
v_add_u32 v13, 0x20000, v13
v_mfma_f32_16x16x32_bf16 v[24:27], a[12:15], a[204:207], v[24:27]
buffer_load_dwordx4 v13, s[72:75], 0 offen offset:1024 lds
v_mfma_f32_16x16x32_bf16 v[28:31], a[0:3], a[208:211], v[92:95]
ds_read_b128 a[44:47], v1 offset:19456
v_cvt_pk_bf16_f32 v59, v42, v43
v_mfma_f32_16x16x32_bf16 v[28:31], a[4:7], a[212:215], v[28:31]
ds_read_b128 a[48:51], v1 offset:20480
v_exp_f32 v45, v45
v_mfma_f32_16x16x32_bf16 v[28:31], a[8:11], a[216:219], v[28:31]
s_waitcnt lgkmcnt(5)
v_exp_f32 v46, v46
v_mfma_f32_16x16x32_bf16 v[28:31], a[12:15], a[220:223], v[28:31]
buffer_load_dwordx4 v12, s[72:75], s12 offen offset:2048 lds
v_mfma_f32_16x16x32_bf16 v[40:43], a[16:19], a[192:195], v[116:119]
ds_read_b128 a[52:55], v1 offset:21504
v_exp_f32 v47, v47
v_mfma_f32_16x16x32_bf16 v[40:43], a[20:23], a[196:199], v[40:43]
ds_read_b128 a[56:59], v1 offset:22528
v_exp_f32 v24, v24
v_mfma_f32_16x16x32_bf16 v[40:43], a[24:27], a[200:203], v[40:43]
ds_read_b128 a[60:63], v1 offset:23552
v_xor_b32 v1, 0x8000, v1
v_mfma_f32_16x16x32_bf16 v[40:43], a[28:31], a[204:207], v[40:43]
v_exp_f32 v25, v25
v_cvt_pk_bf16_f32 v62, v44, v45
v_cvt_pk_bf16_f32 v63, v46, v47
v_mfma_f32_16x16x32_bf16 v[44:47], a[16:19], a[208:211], v[92:95]
v_exp_f32 v26, v26
v_mfma_f32_16x16x32_bf16 v[44:47], a[20:23], a[212:215], v[44:47]
buffer_load_dwordx4 v13, s[72:75], s12 offen offset:3072 lds
v_mfma_f32_16x16x32_bf16 v[44:47], a[24:27], a[216:219], v[44:47]
v_exp_f32 v27, v27
v_mfma_f32_16x16x32_bf16 v[44:47], a[28:31], a[220:223], v[44:47]
v_exp_f32 v28, v28
v_exp_f32 v29, v29
L_att_h1_1:
s_waitcnt vmcnt(16) lgkmcnt(0)
s_mov_b32 s92, 200000
L_spin_b1:
v_cmp_gt_u32 vcc, 32, v14
s_nop 4
s_cbranch_vccz L_spun_b1
s_sub_u32 s92, s92, 1
s_cbranch_scc1 L_spun_b1
s_sleep 6
buffer_load_dword v14, v15, s[84:87], 0 offen offset:192 sc1
s_waitcnt vmcnt(0)
s_branch L_spin_b1
L_spun_b1:
s_barrier
v_mfma_f32_16x16x32_bf16 v[192:195], a[32:35], v[56:59], v[192:195]
ds_read_b128 a[0:3], v2 offset:8192
v_cvt_pk_bf16_f32 v72, v24, v25
v_mfma_f32_16x16x32_bf16 v[224:227], a[32:35], v[60:63], v[224:227]
ds_read_b128 a[4:7], v2 offset:9216
v_cvt_pk_bf16_f32 v73, v26, v27
v_mfma_f32_16x16x32_bf16 v[228:231], a[36:39], v[60:63], v[228:231]
s_add_u32 s101, s101, 0x2000
v_exp_f32 v30, v30
v_mfma_f32_16x16x32_bf16 v[196:199], a[36:39], v[56:59], v[196:199]
buffer_load_dwordx4 a[64:67], v3, s[88:91], s101 offen sc1
v_mfma_f32_16x16x32_bf16 v[200:203], a[40:43], v[56:59], v[200:203]
ds_read_b128 a[8:11], v2 offset:10240
v_cvt_pk_bf16_f32 v76, v28, v29
v_mfma_f32_16x16x32_bf16 v[232:235], a[40:43], v[60:63], v[232:235]
buffer_load_dwordx4 a[68:71], v3, s[88:91], s101 offen offset:1024 sc1
v_mfma_f32_16x16x32_bf16 v[236:239], a[44:47], v[60:63], v[236:239]
ds_read_b128 a[12:15], v2 offset:11264
s_add_u32 s101, s101, 0x2000
v_mfma_f32_16x16x32_bf16 v[204:207], a[44:47], v[56:59], v[204:207]
buffer_load_dwordx4 a[72:75], v3, s[88:91], s101 offen sc1
v_mfma_f32_16x16x32_bf16 v[208:211], a[48:51], v[56:59], v[208:211]
ds_read_b128 a[16:19], v2 offset:12288
v_exp_f32 v31, v31
v_mfma_f32_16x16x32_bf16 v[240:243], a[48:51], v[60:63], v[240:243]
buffer_load_dwordx4 a[76:79], v3, s[88:91], s101 offen offset:1024 sc1
v_mfma_f32_16x16x32_bf16 v[244:247], a[52:55], v[60:63], v[244:247]
ds_read_b128 a[20:23], v2 offset:13312
v_exp_f32 v40, v40
v_mfma_f32_16x16x32_bf16 v[212:215], a[52:55], v[56:59], v[212:215]
ds_read_b128 a[24:27], v2 offset:14336
v_exp_f32 v41, v41
v_mfma_f32_16x16x32_bf16 v[216:219], a[56:59], v[56:59], v[216:219]
ds_read_b128 a[28:31], v2 offset:15360
s_add_u32 s101, s101, 0x2000
v_mfma_f32_16x16x32_bf16 v[248:251], a[56:59], v[60:63], v[248:251]
buffer_load_dwordx4 a[80:83], v3, s[88:91], s101 offen sc1
v_mfma_f32_16x16x32_bf16 v[252:255], a[60:63], v[60:63], v[252:255]
ds_read_b128 a[32:35], v2 offset:0
v_cvt_pk_bf16_f32 v77, v30, v31
v_mfma_f32_16x16x32_bf16 v[220:223], a[60:63], v[56:59], v[220:223]
ds_read_b128 a[36:39], v2 offset:1024
s_waitcnt lgkmcnt(6)
v_smfmac_f32_16x16x64_bf16 a[228:231], a[232:235], v[56:63], v9
buffer_load_dwordx4 a[84:87], v3, s[88:91], s101 offen offset:1024 sc1
v_mfma_f32_16x16x32_bf16 v[28:31], a[0:3], a[208:211], v[120:123]
ds_read_b128 a[40:43], v2 offset:2048
v_exp_f32 v42, v42
v_mfma_f32_16x16x32_bf16 v[28:31], a[4:7], a[212:215], v[28:31]
ds_read_b128 a[44:47], v2 offset:3072
s_add_u32 s101, s101, 0x2000
v_mfma_f32_16x16x32_bf16 v[28:31], a[8:11], a[216:219], v[28:31]
buffer_load_dwordx4 a[88:91], v3, s[88:91], s101 offen sc1
v_mfma_f32_16x16x32_bf16 v[28:31], a[12:15], a[220:223], v[28:31]
ds_read_b128 a[48:51], v2 offset:4096
s_waitcnt lgkmcnt(5)
v_exp_f32 v43, v43
v_exp_f32 v44, v44
v_exp_f32 v45, v45
v_exp_f32 v46, v46
v_exp_f32 v47, v47
v_cvt_pk_bf16_f32 v78, v44, v45
v_cvt_pk_bf16_f32 v79, v46, v47
v_mfma_f32_16x16x32_bf16 v[44:47], a[16:19], a[208:211], v[124:127]
ds_read_b128 a[52:55], v2 offset:5120
v_cvt_pk_bf16_f32 v74, v40, v41
v_mfma_f32_16x16x32_bf16 v[44:47], a[20:23], a[212:215], v[44:47]
buffer_load_dwordx4 a[92:95], v3, s[88:91], s101 offen offset:1024 sc1
v_mfma_f32_16x16x32_bf16 v[44:47], a[24:27], a[216:219], v[44:47]
ds_read_b128 a[56:59], v2 offset:6144
v_cvt_pk_bf16_f32 v75, v42, v43
v_mfma_f32_16x16x32_bf16 v[44:47], a[28:31], a[220:223], v[44:47]
ds_read_b128 a[60:63], v2 offset:7168
s_waitcnt lgkmcnt(0)
v_mfma_f32_16x16x32_bf16 v[192:195], a[32:35], v[72:75], v[192:195]
s_add_u32 s101, s101, 0x2000
v_exp_f32 v28, v28
v_mfma_f32_16x16x32_bf16 v[224:227], a[32:35], v[76:79], v[224:227]
buffer_load_dwordx4 a[96:99], v3, s[88:91], s101 offen sc1
v_mfma_f32_16x16x32_bf16 v[228:231], a[36:39], v[76:79], v[228:231]
ds_read_b128 a[32:35], v2 offset:16384
v_exp_f32 v29, v29
v_mfma_f32_16x16x32_bf16 v[196:199], a[36:39], v[72:75], v[196:199]
buffer_load_dwordx4 a[100:103], v3, s[88:91], s101 offen offset:1024 sc1
v_mfma_f32_16x16x32_bf16 v[200:203], a[40:43], v[72:75], v[200:203]
ds_read_b128 a[36:39], v2 offset:17408
s_add_u32 s101, s101, 0x2000
v_mfma_f32_16x16x32_bf16 v[232:235], a[40:43], v[76:79], v[232:235]
buffer_load_dwordx4 a[104:107], v3, s[88:91], s101 offen sc1
v_mfma_f32_16x16x32_bf16 v[236:239], a[44:47], v[76:79], v[236:239]
ds_read_b128 a[40:43], v2 offset:18432
v_exp_f32 v30, v30
v_mfma_f32_16x16x32_bf16 v[204:207], a[44:47], v[72:75], v[204:207]
buffer_load_dwordx4 a[108:111], v3, s[88:91], s101 offen offset:1024 sc1
v_mfma_f32_16x16x32_bf16 v[208:211], a[48:51], v[72:75], v[208:211]
ds_read_b128 a[44:47], v2 offset:19456
s_add_u32 s101, s101, 0x2000
v_mfma_f32_16x16x32_bf16 v[240:243], a[48:51], v[76:79], v[240:243]
buffer_load_dwordx4 a[112:115], v3, s[88:91], s101 offen sc1
v_mfma_f32_16x16x32_bf16 v[244:247], a[52:55], v[76:79], v[244:247]
ds_read_b128 a[48:51], v2 offset:20480
v_exp_f32 v31, v31
v_mfma_f32_16x16x32_bf16 v[212:215], a[52:55], v[72:75], v[212:215]
buffer_load_dwordx4 a[116:119], v3, s[88:91], s101 offen offset:1024 sc1
v_mfma_f32_16x16x32_bf16 v[216:219], a[56:59], v[72:75], v[216:219]
ds_read_b128 a[52:55], v2 offset:21504
s_add_u32 s101, s101, 0x2000
v_mfma_f32_16x16x32_bf16 v[248:251], a[56:59], v[76:79], v[248:251]
buffer_load_dwordx4 a[120:123], v3, s[88:91], s101 offen sc1
v_mfma_f32_16x16x32_bf16 v[252:255], a[60:63], v[76:79], v[252:255]
buffer_load_dwordx4 a[124:127], v3, s[88:91], s101 offen offset:1024 sc1
v_mfma_f32_16x16x32_bf16 v[220:223], a[60:63], v[72:75], v[220:223]
ds_read_b128 a[56:59], v2 offset:22528
v_cvt_pk_bf16_f32 v60, v28, v29
v_smfmac_f32_16x16x64_bf16 a[228:231], a[232:235], v[72:79], v9
ds_read_b128 a[60:63], v2 offset:23552
v_xor_b32 v2, 0x38000, v2
v_exp_f32 v44, v44
v_exp_f32 v45, v45
v_exp_f32 v46, v46
v_exp_f32 v47, v47
v_cvt_pk_bf16_f32 v61, v30, v31
v_cvt_pk_bf16_f32 v62, v44, v45
v_cvt_pk_bf16_f32 v63, v46, v47
s_waitcnt lgkmcnt(0)
s_barrier
v_accvgpr_read_b32 v6, a228
v_accvgpr_read_b32 v7, a229
v_add_f32 v6, v6, v7
v_cmp_nge_f32 vcc, 0x5f800000, v6
v_rcp_f32 v6, v6
s_or_b64 s[34:35], s[34:35], vcc
v_mfma_f32_16x16x32_bf16 v[224:227], a[32:35], v[60:63], v[224:227]
s_add_u32 s8, s30, 0x0
v_mul_f32 v192, v6, v192
v_mfma_f32_16x16x32_bf16 v[228:231], a[36:39], v[60:63], v[228:231]
v_mul_f32 v193, v6, v193
v_mul_f32 v194, v6, v194
v_mfma_f32_16x16x32_bf16 v[232:235], a[40:43], v[60:63], v[232:235]
v_mul_f32 v195, v6, v195
v_mul_f32 v196, v6, v196
v_mfma_f32_16x16x32_bf16 v[236:239], a[44:47], v[60:63], v[236:239]
v_mul_f32 v197, v6, v197
v_mul_f32 v198, v6, v198
v_mfma_f32_16x16x32_bf16 v[240:243], a[48:51], v[60:63], v[240:243]
v_mul_f32 v199, v6, v199
v_cvt_pk_bf16_f32 v192, v192, v193
v_mfma_f32_16x16x32_bf16 v[244:247], a[52:55], v[60:63], v[244:247]
v_cvt_pk_bf16_f32 v193, v194, v195
v_cvt_pk_bf16_f32 v194, v196, v197
v_mfma_f32_16x16x32_bf16 v[248:251], a[56:59], v[60:63], v[248:251]
v_cvt_pk_bf16_f32 v195, v198, v199
buffer_store_dwordx4 v[192:195], v3, s[88:91], s8 offen sc1
v_mfma_f32_16x16x32_bf16 v[252:255], a[60:63], v[60:63], v[252:255]
v_mfma_f32_16x16x32_bf16 a[228:231], a[236:239], v[60:63], a[228:231]
s_add_u32 s8, s30, 0x2000
v_pk_mul_f32 v[200:201], v[200:201], v[6:7] op_sel_hi:[1,0]
v_pk_mul_f32 v[202:203], v[202:203], v[6:7] op_sel_hi:[1,0]
v_pk_mul_f32 v[204:205], v[204:205], v[6:7] op_sel_hi:[1,0]
v_pk_mul_f32 v[206:207], v[206:207], v[6:7] op_sel_hi:[1,0]
v_cvt_pk_bf16_f32 v200, v200, v201
v_cvt_pk_bf16_f32 v201, v202, v203
v_cvt_pk_bf16_f32 v202, v204, v205
v_cvt_pk_bf16_f32 v203, v206, v207
buffer_store_dwordx4 v[200:203], v3, s[88:91], s8 offen sc1
s_add_u32 s8, s30, 0x4000
v_pk_mul_f32 v[208:209], v[208:209], v[6:7] op_sel_hi:[1,0]
v_pk_mul_f32 v[210:211], v[210:211], v[6:7] op_sel_hi:[1,0]
v_pk_mul_f32 v[212:213], v[212:213], v[6:7] op_sel_hi:[1,0]
v_pk_mul_f32 v[214:215], v[214:215], v[6:7] op_sel_hi:[1,0]
v_cvt_pk_bf16_f32 v208, v208, v209
v_cvt_pk_bf16_f32 v209, v210, v211
v_cvt_pk_bf16_f32 v210, v212, v213
v_cvt_pk_bf16_f32 v211, v214, v215
buffer_store_dwordx4 v[208:211], v3, s[88:91], s8 offen sc1
s_add_u32 s8, s30, 0x6000
v_pk_mul_f32 v[216:217], v[216:217], v[6:7] op_sel_hi:[1,0]
v_pk_mul_f32 v[218:219], v[218:219], v[6:7] op_sel_hi:[1,0]
v_pk_mul_f32 v[220:221], v[220:221], v[6:7] op_sel_hi:[1,0]
v_pk_mul_f32 v[222:223], v[222:223], v[6:7] op_sel_hi:[1,0]
v_cvt_pk_bf16_f32 v216, v216, v217
v_cvt_pk_bf16_f32 v217, v218, v219
v_cvt_pk_bf16_f32 v218, v220, v221
v_cvt_pk_bf16_f32 v219, v222, v223
buffer_store_dwordx4 v[216:219], v3, s[88:91], s8 offen sc1
L_att_fin:
v_accvgpr_read_b32 v6, a230
v_accvgpr_read_b32 v7, a231
v_add_f32 v6, v6, v7
v_cmp_nge_f32 vcc, 0x5f800000, v6
v_rcp_f32 v6, v6
s_or_b64 s[34:35], s[34:35], vcc
s_add_u32 s8, s31, 0x0
v_pk_mul_f32 v[224:225], v[224:225], v[6:7] op_sel_hi:[1,0]
v_pk_mul_f32 v[226:227], v[226:227], v[6:7] op_sel_hi:[1,0]
v_pk_mul_f32 v[228:229], v[228:229], v[6:7] op_sel_hi:[1,0]
v_pk_mul_f32 v[230:231], v[230:231], v[6:7] op_sel_hi:[1,0]
v_cvt_pk_bf16_f32 v224, v224, v225
v_cvt_pk_bf16_f32 v225, v226, v227
v_cvt_pk_bf16_f32 v226, v228, v229
v_cvt_pk_bf16_f32 v227, v230, v231
buffer_store_dwordx4 v[224:227], v3, s[88:91], s8 offen sc1
s_add_u32 s8, s31, 0x2000
v_pk_mul_f32 v[232:233], v[232:233], v[6:7] op_sel_hi:[1,0]
v_pk_mul_f32 v[234:235], v[234:235], v[6:7] op_sel_hi:[1,0]
v_pk_mul_f32 v[236:237], v[236:237], v[6:7] op_sel_hi:[1,0]
v_pk_mul_f32 v[238:239], v[238:239], v[6:7] op_sel_hi:[1,0]
v_cvt_pk_bf16_f32 v232, v232, v233
v_cvt_pk_bf16_f32 v233, v234, v235
v_cvt_pk_bf16_f32 v234, v236, v237
v_cvt_pk_bf16_f32 v235, v238, v239
buffer_store_dwordx4 v[232:235], v3, s[88:91], s8 offen sc1
s_add_u32 s8, s31, 0x4000
v_pk_mul_f32 v[240:241], v[240:241], v[6:7] op_sel_hi:[1,0]
v_pk_mul_f32 v[242:243], v[242:243], v[6:7] op_sel_hi:[1,0]
v_pk_mul_f32 v[244:245], v[244:245], v[6:7] op_sel_hi:[1,0]
v_pk_mul_f32 v[246:247], v[246:247], v[6:7] op_sel_hi:[1,0]
v_cvt_pk_bf16_f32 v240, v240, v241
v_cvt_pk_bf16_f32 v241, v242, v243
v_cvt_pk_bf16_f32 v242, v244, v245
v_cvt_pk_bf16_f32 v243, v246, v247
buffer_store_dwordx4 v[240:243], v3, s[88:91], s8 offen sc1
s_add_u32 s8, s31, 0x6000
v_pk_mul_f32 v[248:249], v[248:249], v[6:7] op_sel_hi:[1,0]
v_pk_mul_f32 v[250:251], v[250:251], v[6:7] op_sel_hi:[1,0]
v_pk_mul_f32 v[252:253], v[252:253], v[6:7] op_sel_hi:[1,0]
v_pk_mul_f32 v[254:255], v[254:255], v[6:7] op_sel_hi:[1,0]
v_cvt_pk_bf16_f32 v248, v248, v249
v_cvt_pk_bf16_f32 v249, v250, v251
v_cvt_pk_bf16_f32 v250, v252, v253
v_cvt_pk_bf16_f32 v251, v254, v255
buffer_store_dwordx4 v[248:251], v3, s[88:91], s8 offen sc1
s_cmp_lg_u64 s[34:35], 0
s_cselect_b32 s8, 1, 0
s_lshl_b32 s9, s4, 2
s_add_u32 s9, s9, 24576
v_mov_b32 v4, s9
v_mov_b32 v5, s8
ds_write_b32 v4, v5
v_lshrrev_b32 v17, 4, v0
v_lshlrev_b32 v18, 10, v17
v_and_b32 v17, 1, v17
v_lshl_add_u32 v18, v17, 5, v18
v_bfe_u32 v17, v0, 2, 2
v_lshl_add_u32 v18, v17, 6, v18
v_and_b32 v17, 3, v0
v_lshl_add_u32 v4, v17, 3, v18
s_sub_u32 s8, s16, s17
v_add_u32 v6, s8, v4
v_xor_b32 v7, 32, v6
v_add_u32 v4, 65536, v4
v_xor_b32 v5, 32, v4
v_and_b32 v20, 15, v0
v_lshlrev_b32 v20, 2, v20
s_waitcnt vmcnt(20) lgkmcnt(0)
s_barrier
v_and_b32 v17, 3, v0
v_lshlrev_b32 v17, 2, v17
v_add_u32 v17, 24576, v17
ds_read_b32 v18, v17
s_waitcnt lgkmcnt(0)
v_cmp_ne_u32 vcc, 0, v18
s_cmp_lg_u32 s33, 0
s_cbranch_scc1 L_att_done
s_nop 4
s_cbranch_vccnz L_att_fallback
L_att_done:
ds_read_b64_tr_b16 v[152:153], v4 offset:512
ds_read_b64_tr_b16 v[154:155], v4 offset:4608
ds_read_b64_tr_b16 v[156:157], v4 offset:8704
ds_read_b64_tr_b16 v[158:159], v4 offset:12800
ds_read_b64_tr_b16 v[160:161], v5 offset:512
ds_read_b64_tr_b16 v[162:163], v5 offset:4608
ds_read_b64_tr_b16 v[164:165], v5 offset:8704
ds_read_b64_tr_b16 v[166:167], v5 offset:12800
ds_read_b64_tr_b16 v[168:169], v4 offset:768
ds_read_b64_tr_b16 v[170:171], v4 offset:4864
ds_read_b64_tr_b16 v[172:173], v4 offset:8960
ds_read_b64_tr_b16 v[174:175], v4 offset:13056
ds_read_b64_tr_b16 v[176:177], v5 offset:768
ds_read_b64_tr_b16 v[178:179], v5 offset:4864
ds_read_b64_tr_b16 v[180:181], v5 offset:8960
ds_read_b64_tr_b16 v[182:183], v5 offset:13056
s_lshl_b32 s29, s99, 7
s_lshl_b32 s9, s4, 5
s_add_u32 s29, s29, s9
s_lshl_b32 s9, s29, 2
s_add_u32 s9, s9, 0x3700000
buffer_load_dword v8, v20, s[88:91], s9 offen sc1
buffer_load_dword v9, v20, s[88:91], s9 offen offset:64 sc1
s_waitcnt lgkmcnt(8)
v_mfma_f32_16x16x32_bf16 v[56:59], v[152:155], a[64:67], 0
ds_read_b64_tr_b16 v[184:185], v4 offset:0
v_mov_b32 v88, 0
v_mfma_f32_16x16x32_bf16 v[56:59], v[156:159], a[72:75], v[56:59]
ds_read_b64_tr_b16 v[186:187], v4 offset:4096
v_mov_b32 v89, 0
v_mfma_f32_16x16x32_bf16 v[72:75], v[156:159], a[76:79], 0
ds_read_b64_tr_b16 v[188:189], v4 offset:8192
v_mov_b32 v90, 0
v_mfma_f32_16x16x32_bf16 v[72:75], v[152:155], a[68:71], v[72:75]
ds_read_b64_tr_b16 v[190:191], v4 offset:12288
v_mov_b32 v91, 0
v_mfma_f32_16x16x32_bf16 v[76:79], v[160:163], a[68:71], 0
ds_read_b64_tr_b16 v[192:193], v5 offset:0
v_mov_b32 v92, 0
v_mfma_f32_16x16x32_bf16 v[76:79], v[164:167], a[76:79], v[76:79]
ds_read_b64_tr_b16 v[194:195], v5 offset:4096
v_mov_b32 v93, 0
v_mfma_f32_16x16x32_bf16 v[60:63], v[164:167], a[72:75], 0
ds_read_b64_tr_b16 v[196:197], v5 offset:8192
s_waitcnt lgkmcnt(7)
v_mfma_f32_16x16x32_bf16 v[60:63], v[160:163], a[64:67], v[60:63]
ds_read_b64_tr_b16 v[198:199], v5 offset:12288
v_mov_b32 v94, 0
v_mfma_f32_16x16x32_bf16 v[64:67], v[168:171], a[64:67], 0
ds_read_b64_tr_b16 v[200:201], v4 offset:256
v_mov_b32 v95, 0
v_mfma_f32_16x16x32_bf16 v[64:67], v[172:175], a[72:75], v[64:67]
ds_read_b64_tr_b16 v[202:203], v4 offset:4352
v_mov_b32 v96, 0
v_mfma_f32_16x16x32_bf16 v[80:83], v[172:175], a[76:79], 0
ds_read_b64_tr_b16 v[204:205], v4 offset:8448
v_mov_b32 v97, 0
v_mfma_f32_16x16x32_bf16 v[80:83], v[168:171], a[68:71], v[80:83]
ds_read_b64_tr_b16 v[206:207], v4 offset:12544
v_mov_b32 v98, 0
v_mfma_f32_16x16x32_bf16 v[84:87], v[176:179], a[68:71], 0
ds_read_b64_tr_b16 v[208:209], v5 offset:256
v_mov_b32 v99, 0
v_mfma_f32_16x16x32_bf16 v[84:87], v[180:183], a[76:79], v[84:87]
ds_read_b64_tr_b16 v[210:211], v5 offset:4352
s_waitcnt vmcnt(2) lgkmcnt(6)
v_mfma_f32_16x16x32_bf16 v[68:71], v[180:183], a[72:75], 0
ds_read_b64_tr_b16 v[212:213], v5 offset:8448
s_barrier
v_mfma_f32_16x16x32_bf16 v[68:71], v[176:179], a[64:67], v[68:71]
ds_read_b64_tr_b16 v[214:215], v5 offset:12544
s_cmp_lg_u32 s4, 0
s_cbranch_scc1 L_flag_set
s_lshl_b32 s8, s6, 5
s_add_u32 s8, s8, s5
s_and_b32 s92, s8, 0xf0
s_mul_i32 s92, s92, 3
s_add_u32 s8, s8, s92
s_lshl_b32 s8, s8, 2
s_add_u32 s8, s8, 0x3704000
v_mov_b32 v21, 1
s_mov_b64 exec, 1
buffer_store_dword v21, off, s[88:91], s8 sc1
s_mov_b64 exec, -1
L_flag_set:
v_mfma_f32_16x16x32_bf16 v[24:27], v[184:187], a[64:67], 0
ds_read_b64_tr_b16 v[152:153], v4 offset:16896
s_lshl_b32 s29, s29, 11
v_mfma_f32_16x16x32_bf16 v[24:27], v[188:191], a[72:75], v[24:27]
ds_read_b64_tr_b16 v[154:155], v4 offset:20992
s_lshl_b32 s9, s100, 8
v_mfma_f32_16x16x32_bf16 v[40:43], v[188:191], a[76:79], 0
ds_read_b64_tr_b16 v[156:157], v4 offset:25088
s_add_u32 s29, s29, s9
v_mfma_f32_16x16x32_bf16 v[40:43], v[184:187], a[68:71], v[40:43]
ds_read_b64_tr_b16 v[158:159], v4 offset:29184
s_lshl_b32 s9, s14, 7
v_mfma_f32_16x16x32_bf16 v[44:47], v[192:195], a[68:71], 0
ds_read_b64_tr_b16 v[160:161], v5 offset:16896
s_add_u32 s29, s29, s9
v_mfma_f32_16x16x32_bf16 v[44:47], v[196:199], a[76:79], v[44:47]
ds_read_b64_tr_b16 v[162:163], v5 offset:20992
s_add_u32 s31, s29, 0x8000
v_mfma_f32_16x16x32_bf16 v[28:31], v[196:199], a[72:75], 0
ds_read_b64_tr_b16 v[164:165], v5 offset:25088
s_waitcnt lgkmcnt(7)
v_mfma_f32_16x16x32_bf16 v[28:31], v[192:195], a[64:67], v[28:31]
ds_read_b64_tr_b16 v[166:167], v5 offset:29184
s_lshl_b32 s28, s2, 2
v_mfma_f32_16x16x32_bf16 v[32:35], v[200:203], a[64:67], 0
ds_read_b64_tr_b16 v[168:169], v4 offset:17152
s_add_u32 s28, s28, s4
v_mfma_f32_16x16x32_bf16 v[32:35], v[204:207], a[72:75], v[32:35]
ds_read_b64_tr_b16 v[170:171], v4 offset:21248
s_lshl_b32 s28, s28, 12
v_mfma_f32_16x16x32_bf16 v[48:51], v[204:207], a[76:79], 0
ds_read_b64_tr_b16 v[172:173], v4 offset:25344
s_add_u32 s28, s28, 0x3800000
v_mfma_f32_16x16x32_bf16 v[48:51], v[200:203], a[68:71], v[48:51]
ds_read_b64_tr_b16 v[174:175], v4 offset:29440
s_xor_b32 s30, s28, 0x4000
v_mfma_f32_16x16x32_bf16 v[52:55], v[208:211], a[68:71], 0
ds_read_b64_tr_b16 v[176:177], v5 offset:17152
v_and_b32 v18, 16, v0
v_mfma_f32_16x16x32_bf16 v[52:55], v[212:215], a[76:79], v[52:55]
ds_read_b64_tr_b16 v[178:179], v5 offset:21248
s_waitcnt lgkmcnt(6)
v_mfma_f32_16x16x32_bf16 v[36:39], v[212:215], a[72:75], 0
ds_read_b64_tr_b16 v[180:181], v5 offset:25344
v_lshrrev_b32 v19, 5, v0
v_mfma_f32_16x16x32_bf16 v[36:39], v[208:211], a[64:67], v[36:39]
ds_read_b64_tr_b16 v[182:183], v5 offset:29440
v_lshlrev_b32 v19, 4, v19
v_mfma_f32_16x16x32_bf16 v[56:59], v[152:155], a[80:83], v[56:59]
ds_read_b64_tr_b16 v[184:185], v4 offset:16384
v_mov_b32 v100, 0
v_mfma_f32_16x16x32_bf16 v[56:59], v[156:159], a[88:91], v[56:59]
ds_read_b64_tr_b16 v[186:187], v4 offset:20480
v_mov_b32 v101, 0
v_mfma_f32_16x16x32_bf16 v[72:75], v[156:159], a[92:95], v[72:75]
ds_read_b64_tr_b16 v[188:189], v4 offset:24576
v_mov_b32 v102, 0
v_mfma_f32_16x16x32_bf16 v[72:75], v[152:155], a[84:87], v[72:75]
ds_read_b64_tr_b16 v[190:191], v4 offset:28672
v_mov_b32 v103, 0
v_mfma_f32_16x16x32_bf16 v[76:79], v[160:163], a[84:87], v[76:79]
ds_read_b64_tr_b16 v[192:193], v5 offset:16384
v_mov_b32 v104, 0
v_mfma_f32_16x16x32_bf16 v[76:79], v[164:167], a[92:95], v[76:79]
ds_read_b64_tr_b16 v[194:195], v5 offset:20480
v_mov_b32 v105, 0
v_mfma_f32_16x16x32_bf16 v[60:63], v[164:167], a[88:91], v[60:63]
ds_read_b64_tr_b16 v[196:197], v5 offset:24576
s_waitcnt lgkmcnt(7)
v_mfma_f32_16x16x32_bf16 v[60:63], v[160:163], a[80:83], v[60:63]
ds_read_b64_tr_b16 v[198:199], v5 offset:28672
v_mov_b32 v106, 0
v_mfma_f32_16x16x32_bf16 v[64:67], v[168:171], a[80:83], v[64:67]
ds_read_b64_tr_b16 v[200:201], v4 offset:16640
v_mov_b32 v107, 0
v_mfma_f32_16x16x32_bf16 v[64:67], v[172:175], a[88:91], v[64:67]
ds_read_b64_tr_b16 v[202:203], v4 offset:20736
v_mov_b32 v108, 0
v_mfma_f32_16x16x32_bf16 v[80:83], v[172:175], a[92:95], v[80:83]
ds_read_b64_tr_b16 v[204:205], v4 offset:24832
v_mov_b32 v109, 0
v_mfma_f32_16x16x32_bf16 v[80:83], v[168:171], a[84:87], v[80:83]
ds_read_b64_tr_b16 v[206:207], v4 offset:28928
v_lshl_add_u32 v18, v18, 1, v19
v_mfma_f32_16x16x32_bf16 v[84:87], v[176:179], a[84:87], v[84:87]
ds_read_b64_tr_b16 v[208:209], v5 offset:16640
v_lshl_add_u32 v17, v20, 9, v18
v_mfma_f32_16x16x32_bf16 v[84:87], v[180:183], a[92:95], v[84:87]
ds_read_b64_tr_b16 v[210:211], v5 offset:20736
s_waitcnt vmcnt(14) lgkmcnt(6)
v_mfma_f32_16x16x32_bf16 v[68:71], v[180:183], a[88:91], v[68:71]
ds_read_b64_tr_b16 v[212:213], v5 offset:24832
s_barrier
v_mfma_f32_16x16x32_bf16 v[68:71], v[176:179], a[80:83], v[68:71]
ds_read_b64_tr_b16 v[214:215], v5 offset:28928
v_mfma_f32_16x16x32_bf16 v[24:27], v[184:187], a[80:83], v[24:27]
ds_read_b64_tr_b16 v[152:153], v6 offset:512
ds_read_b64_tr_b16 v[154:155], v6 offset:4608
v_mfma_f32_16x16x32_bf16 v[24:27], v[188:191], a[88:91], v[24:27]
ds_read_b64_tr_b16 v[156:157], v6 offset:8704
v_add_u32 v12, 0x20000, v12
v_mfma_f32_16x16x32_bf16 v[40:43], v[188:191], a[92:95], v[40:43]
ds_read_b64_tr_b16 v[158:159], v6 offset:12800
s_add_u32 m0, s17, 0x10000
v_mfma_f32_16x16x32_bf16 v[40:43], v[184:187], a[84:87], v[40:43]
buffer_load_dwordx4 v12, s[72:75], 0 offen lds
v_mfma_f32_16x16x32_bf16 v[44:47], v[192:195], a[84:87], v[44:47]
ds_read_b64_tr_b16 v[160:161], v7 offset:512
ds_read_b64_tr_b16 v[162:163], v7 offset:4608
v_mfma_f32_16x16x32_bf16 v[44:47], v[196:199], a[92:95], v[44:47]
ds_read_b64_tr_b16 v[164:165], v7 offset:8704
v_add_u32 v13, 0x20000, v13
v_mfma_f32_16x16x32_bf16 v[28:31], v[196:199], a[88:91], v[28:31]
ds_read_b64_tr_b16 v[166:167], v7 offset:12800
s_waitcnt lgkmcnt(8)
v_mfma_f32_16x16x32_bf16 v[28:31], v[192:195], a[80:83], v[28:31]
buffer_load_dwordx4 v13, s[72:75], 0 offen offset:1024 lds
v_mfma_f32_16x16x32_bf16 v[32:35], v[200:203], a[80:83], v[32:35]
ds_read_b64_tr_b16 v[168:169], v6 offset:768
ds_read_b64_tr_b16 v[170:171], v6 offset:4864
v_mfma_f32_16x16x32_bf16 v[32:35], v[204:207], a[88:91], v[32:35]
ds_read_b64_tr_b16 v[172:173], v6 offset:8960
v_mfma_f32_16x16x32_bf16 v[48:51], v[204:207], a[92:95], v[48:51]
ds_read_b64_tr_b16 v[174:175], v6 offset:13056
v_mfma_f32_16x16x32_bf16 v[48:51], v[200:203], a[84:87], v[48:51]
buffer_load_dwordx4 v12, s[72:75], s12 offen offset:2048 lds
v_mfma_f32_16x16x32_bf16 v[52:55], v[208:211], a[84:87], v[52:55]
ds_read_b64_tr_b16 v[176:177], v7 offset:768
ds_read_b64_tr_b16 v[178:179], v7 offset:4864
v_mfma_f32_16x16x32_bf16 v[52:55], v[212:215], a[92:95], v[52:55]
ds_read_b64_tr_b16 v[180:181], v7 offset:8960
s_waitcnt lgkmcnt(7)
v_mfma_f32_16x16x32_bf16 v[36:39], v[212:215], a[88:91], v[36:39]
ds_read_b64_tr_b16 v[182:183], v7 offset:13056
v_mfma_f32_16x16x32_bf16 v[36:39], v[208:211], a[80:83], v[36:39]
buffer_load_dwordx4 v13, s[72:75], s12 offen offset:3072 lds
v_mfma_f32_16x16x32_bf16 v[56:59], v[152:155], a[96:99], v[56:59]
ds_read_b64_tr_b16 v[184:185], v6 offset:0
ds_read_b64_tr_b16 v[186:187], v6 offset:4096
v_mfma_f32_16x16x32_bf16 v[56:59], v[156:159], a[104:107], v[56:59]
ds_read_b64_tr_b16 v[188:189], v6 offset:8192
v_mov_b32 v110, 0
v_mfma_f32_16x16x32_bf16 v[72:75], v[156:159], a[108:111], v[72:75]
ds_read_b64_tr_b16 v[190:191], v6 offset:12288
s_add_u32 s101, s101, 0x2000
v_mfma_f32_16x16x32_bf16 v[72:75], v[152:155], a[100:103], v[72:75]
buffer_load_dwordx4 a[64:67], v3, s[88:91], s101 offen sc1
v_mfma_f32_16x16x32_bf16 v[76:79], v[160:163], a[100:103], v[76:79]
ds_read_b64_tr_b16 v[192:193], v7 offset:0
ds_read_b64_tr_b16 v[194:195], v7 offset:4096
v_mfma_f32_16x16x32_bf16 v[76:79], v[164:167], a[108:111], v[76:79]
ds_read_b64_tr_b16 v[196:197], v7 offset:8192
v_mov_b32 v111, 0
v_mfma_f32_16x16x32_bf16 v[60:63], v[164:167], a[104:107], v[60:63]
ds_read_b64_tr_b16 v[198:199], v7 offset:12288
s_waitcnt lgkmcnt(8)
v_mfma_f32_16x16x32_bf16 v[60:63], v[160:163], a[96:99], v[60:63]
buffer_load_dwordx4 a[68:71], v3, s[88:91], s101 offen offset:1024 sc1
v_mfma_f32_16x16x32_bf16 v[64:67], v[168:171], a[96:99], v[64:67]
ds_read_b64_tr_b16 v[200:201], v6 offset:256
ds_read_b64_tr_b16 v[202:203], v6 offset:4352
v_mfma_f32_16x16x32_bf16 v[64:67], v[172:175], a[104:107], v[64:67]
ds_read_b64_tr_b16 v[204:205], v6 offset:8448
v_mov_b32 v112, 0
v_mfma_f32_16x16x32_bf16 v[80:83], v[172:175], a[108:111], v[80:83]
ds_read_b64_tr_b16 v[206:207], v6 offset:12544
s_add_u32 s101, s101, 0x2000
v_mfma_f32_16x16x32_bf16 v[80:83], v[168:171], a[100:103], v[80:83]
buffer_load_dwordx4 a[72:75], v3, s[88:91], s101 offen sc1
v_mfma_f32_16x16x32_bf16 v[84:87], v[176:179], a[100:103], v[84:87]
ds_read_b64_tr_b16 v[208:209], v7 offset:256
ds_read_b64_tr_b16 v[210:211], v7 offset:4352
v_mfma_f32_16x16x32_bf16 v[84:87], v[180:183], a[108:111], v[84:87]
ds_read_b64_tr_b16 v[212:213], v7 offset:8448
s_waitcnt vmcnt(17) lgkmcnt(7)
v_mfma_f32_16x16x32_bf16 v[68:71], v[180:183], a[104:107], v[68:71]
ds_read_b64_tr_b16 v[214:215], v7 offset:12544
s_barrier
v_mfma_f32_16x16x32_bf16 v[68:71], v[176:179], a[96:99], v[68:71]
buffer_load_dwordx4 a[76:79], v3, s[88:91], s101 offen offset:1024 sc1
v_mfma_f32_16x16x32_bf16 v[24:27], v[184:187], a[96:99], v[24:27]
ds_read_b64_tr_b16 v[152:153], v6 offset:16896
ds_read_b64_tr_b16 v[154:155], v6 offset:20992
v_mfma_f32_16x16x32_bf16 v[24:27], v[188:191], a[104:107], v[24:27]
ds_read_b64_tr_b16 v[156:157], v6 offset:25088
v_add_u32 v12, 0x20000, v12
v_mfma_f32_16x16x32_bf16 v[40:43], v[188:191], a[108:111], v[40:43]
ds_read_b64_tr_b16 v[158:159], v6 offset:29184
s_add_u32 m0, s17, 0x14000
v_mfma_f32_16x16x32_bf16 v[40:43], v[184:187], a[100:103], v[40:43]
buffer_load_dwordx4 v12, s[72:75], 0 offen lds
v_mfma_f32_16x16x32_bf16 v[44:47], v[192:195], a[100:103], v[44:47]
ds_read_b64_tr_b16 v[160:161], v7 offset:16896
ds_read_b64_tr_b16 v[162:163], v7 offset:20992
v_mfma_f32_16x16x32_bf16 v[44:47], v[196:199], a[108:111], v[44:47]
ds_read_b64_tr_b16 v[164:165], v7 offset:25088
v_add_u32 v13, 0x20000, v13
v_mfma_f32_16x16x32_bf16 v[28:31], v[196:199], a[104:107], v[28:31]
ds_read_b64_tr_b16 v[166:167], v7 offset:29184
s_waitcnt lgkmcnt(8)
v_mfma_f32_16x16x32_bf16 v[28:31], v[192:195], a[96:99], v[28:31]
buffer_load_dwordx4 v13, s[72:75], 0 offen offset:1024 lds
v_mfma_f32_16x16x32_bf16 v[32:35], v[200:203], a[96:99], v[32:35]
ds_read_b64_tr_b16 v[168:169], v6 offset:17152
ds_read_b64_tr_b16 v[170:171], v6 offset:21248
v_mfma_f32_16x16x32_bf16 v[32:35], v[204:207], a[104:107], v[32:35]
ds_read_b64_tr_b16 v[172:173], v6 offset:25344
v_mfma_f32_16x16x32_bf16 v[48:51], v[204:207], a[108:111], v[48:51]
ds_read_b64_tr_b16 v[174:175], v6 offset:29440
v_mfma_f32_16x16x32_bf16 v[48:51], v[200:203], a[100:103], v[48:51]
buffer_load_dwordx4 v12, s[72:75], s12 offen offset:2048 lds
v_mfma_f32_16x16x32_bf16 v[52:55], v[208:211], a[100:103], v[52:55]
ds_read_b64_tr_b16 v[176:177], v7 offset:17152
ds_read_b64_tr_b16 v[178:179], v7 offset:21248
v_mfma_f32_16x16x32_bf16 v[52:55], v[212:215], a[108:111], v[52:55]
ds_read_b64_tr_b16 v[180:181], v7 offset:25344
s_waitcnt lgkmcnt(7)
v_mfma_f32_16x16x32_bf16 v[36:39], v[212:215], a[104:107], v[36:39]
ds_read_b64_tr_b16 v[182:183], v7 offset:29440
v_mfma_f32_16x16x32_bf16 v[36:39], v[208:211], a[96:99], v[36:39]
buffer_load_dwordx4 v13, s[72:75], s12 offen offset:3072 lds
v_mfma_f32_16x16x32_bf16 v[56:59], v[152:155], a[112:115], v[56:59]
ds_read_b64_tr_b16 v[184:185], v6 offset:16384
ds_read_b64_tr_b16 v[186:187], v6 offset:20480
v_mfma_f32_16x16x32_bf16 v[56:59], v[156:159], a[120:123], v[56:59]
ds_read_b64_tr_b16 v[188:189], v6 offset:24576
v_mov_b32 v113, 0
v_mfma_f32_16x16x32_bf16 v[72:75], v[156:159], a[124:127], v[72:75]
ds_read_b64_tr_b16 v[190:191], v6 offset:28672
s_add_u32 s101, s101, 0x2000
v_mfma_f32_16x16x32_bf16 v[72:75], v[152:155], a[116:119], v[72:75]
buffer_load_dwordx4 a[80:83], v3, s[88:91], s101 offen sc1
v_mfma_f32_16x16x32_bf16 v[76:79], v[160:163], a[116:119], v[76:79]
ds_read_b64_tr_b16 v[192:193], v7 offset:16384
ds_read_b64_tr_b16 v[194:195], v7 offset:20480
v_mfma_f32_16x16x32_bf16 v[76:79], v[164:167], a[124:127], v[76:79]
ds_read_b64_tr_b16 v[196:197], v7 offset:24576
v_mov_b32 v114, 0
v_mfma_f32_16x16x32_bf16 v[60:63], v[164:167], a[120:123], v[60:63]
ds_read_b64_tr_b16 v[198:199], v7 offset:28672
s_waitcnt lgkmcnt(8)
v_mfma_f32_16x16x32_bf16 v[60:63], v[160:163], a[112:115], v[60:63]
buffer_load_dwordx4 a[84:87], v3, s[88:91], s101 offen offset:1024 sc1
v_mfma_f32_16x16x32_bf16 v[64:67], v[168:171], a[112:115], v[64:67]
ds_read_b64_tr_b16 v[200:201], v6 offset:16640
ds_read_b64_tr_b16 v[202:203], v6 offset:20736
v_mfma_f32_16x16x32_bf16 v[64:67], v[172:175], a[120:123], v[64:67]
ds_read_b64_tr_b16 v[204:205], v6 offset:24832
v_mov_b32 v115, 0
v_mfma_f32_16x16x32_bf16 v[80:83], v[172:175], a[124:127], v[80:83]
ds_read_b64_tr_b16 v[206:207], v6 offset:28928
s_add_u32 s101, s101, 0x2000
v_mfma_f32_16x16x32_bf16 v[80:83], v[168:171], a[116:119], v[80:83]
buffer_load_dwordx4 a[88:91], v3, s[88:91], s101 offen sc1
v_mfma_f32_16x16x32_bf16 v[84:87], v[176:179], a[116:119], v[84:87]
ds_read_b64_tr_b16 v[208:209], v7 offset:16640
ds_read_b64_tr_b16 v[210:211], v7 offset:20736
v_mfma_f32_16x16x32_bf16 v[84:87], v[180:183], a[124:127], v[84:87]
ds_read_b64_tr_b16 v[212:213], v7 offset:24832
s_waitcnt vmcnt(7) lgkmcnt(7)
v_mfma_f32_16x16x32_bf16 v[68:71], v[180:183], a[120:123], v[68:71]
ds_read_b64_tr_b16 v[214:215], v7 offset:28928
s_barrier
v_mfma_f32_16x16x32_bf16 v[68:71], v[176:179], a[112:115], v[68:71]
buffer_load_dwordx4 a[92:95], v3, s[88:91], s101 offen offset:1024 sc1
v_mfma_f32_16x16x32_bf16 v[24:27], v[184:187], a[112:115], v[24:27]
ds_read_b64_tr_b16 v[152:153], v4 offset:512
ds_read_b64_tr_b16 v[154:155], v4 offset:4608
v_mfma_f32_16x16x32_bf16 v[24:27], v[188:191], a[120:123], v[24:27]
ds_read_b64_tr_b16 v[156:157], v4 offset:8704
v_add_u32 v12, 0x20000, v12
v_mfma_f32_16x16x32_bf16 v[40:43], v[188:191], a[124:127], v[40:43]
ds_read_b64_tr_b16 v[158:159], v4 offset:12800
s_add_u32 m0, s16, 0x0
v_mfma_f32_16x16x32_bf16 v[40:43], v[184:187], a[116:119], v[40:43]
buffer_load_dwordx4 v12, s[72:75], 0 offen lds
v_mfma_f32_16x16x32_bf16 v[44:47], v[192:195], a[116:119], v[44:47]
ds_read_b64_tr_b16 v[160:161], v5 offset:512
ds_read_b64_tr_b16 v[162:163], v5 offset:4608
v_mfma_f32_16x16x32_bf16 v[44:47], v[196:199], a[124:127], v[44:47]
ds_read_b64_tr_b16 v[164:165], v5 offset:8704
v_add_u32 v13, 0x20000, v13
v_mfma_f32_16x16x32_bf16 v[28:31], v[196:199], a[120:123], v[28:31]
ds_read_b64_tr_b16 v[166:167], v5 offset:12800
s_waitcnt lgkmcnt(8)
v_mfma_f32_16x16x32_bf16 v[28:31], v[192:195], a[112:115], v[28:31]
buffer_load_dwordx4 v13, s[72:75], 0 offen offset:1024 lds
v_mfma_f32_16x16x32_bf16 v[32:35], v[200:203], a[112:115], v[32:35]
ds_read_b64_tr_b16 v[168:169], v4 offset:768
ds_read_b64_tr_b16 v[170:171], v4 offset:4864
v_mfma_f32_16x16x32_bf16 v[32:35], v[204:207], a[120:123], v[32:35]
ds_read_b64_tr_b16 v[172:173], v4 offset:8960
v_mfma_f32_16x16x32_bf16 v[48:51], v[204:207], a[124:127], v[48:51]
ds_read_b64_tr_b16 v[174:175], v4 offset:13056
v_mfma_f32_16x16x32_bf16 v[48:51], v[200:203], a[116:119], v[48:51]
buffer_load_dwordx4 v12, s[72:75], s12 offen offset:2048 lds
v_mfma_f32_16x16x32_bf16 v[52:55], v[208:211], a[116:119], v[52:55]
ds_read_b64_tr_b16 v[176:177], v5 offset:768
ds_read_b64_tr_b16 v[178:179], v5 offset:4864
v_mfma_f32_16x16x32_bf16 v[52:55], v[212:215], a[124:127], v[52:55]
ds_read_b64_tr_b16 v[180:181], v5 offset:8960
s_waitcnt lgkmcnt(7)
v_mfma_f32_16x16x32_bf16 v[36:39], v[212:215], a[120:123], v[36:39]
ds_read_b64_tr_b16 v[182:183], v5 offset:13056
v_mfma_f32_16x16x32_bf16 v[36:39], v[208:211], a[112:115], v[36:39]
buffer_load_dwordx4 v13, s[72:75], s12 offen offset:3072 lds
v_mfma_f32_16x16x32_bf16 v[56:59], v[152:155], a[64:67], v[56:59]
ds_read_b64_tr_b16 v[184:185], v4 offset:0
ds_read_b64_tr_b16 v[186:187], v4 offset:4096
v_mfma_f32_16x16x32_bf16 v[56:59], v[156:159], a[72:75], v[56:59]
ds_read_b64_tr_b16 v[188:189], v4 offset:8192
v_mov_b32 v116, 0
v_mfma_f32_16x16x32_bf16 v[72:75], v[156:159], a[76:79], v[72:75]
ds_read_b64_tr_b16 v[190:191], v4 offset:12288
s_add_u32 s101, s101, 0x2000
v_mfma_f32_16x16x32_bf16 v[72:75], v[152:155], a[68:71], v[72:75]
buffer_load_dwordx4 a[96:99], v3, s[88:91], s101 offen sc1
v_mfma_f32_16x16x32_bf16 v[76:79], v[160:163], a[68:71], v[76:79]
ds_read_b64_tr_b16 v[192:193], v5 offset:0
ds_read_b64_tr_b16 v[194:195], v5 offset:4096
v_mfma_f32_16x16x32_bf16 v[76:79], v[164:167], a[76:79], v[76:79]
ds_read_b64_tr_b16 v[196:197], v5 offset:8192
v_mov_b32 v117, 0
v_mfma_f32_16x16x32_bf16 v[60:63], v[164:167], a[72:75], v[60:63]
ds_read_b64_tr_b16 v[198:199], v5 offset:12288
s_waitcnt lgkmcnt(8)
v_mfma_f32_16x16x32_bf16 v[60:63], v[160:163], a[64:67], v[60:63]
buffer_load_dwordx4 a[100:103], v3, s[88:91], s101 offen offset:1024 sc1
v_mfma_f32_16x16x32_bf16 v[64:67], v[168:171], a[64:67], v[64:67]
ds_read_b64_tr_b16 v[200:201], v4 offset:256
ds_read_b64_tr_b16 v[202:203], v4 offset:4352
v_mfma_f32_16x16x32_bf16 v[64:67], v[172:175], a[72:75], v[64:67]
ds_read_b64_tr_b16 v[204:205], v4 offset:8448
v_mfma_f32_16x16x32_bf16 v[80:83], v[172:175], a[76:79], v[80:83]
ds_read_b64_tr_b16 v[206:207], v4 offset:12544
s_add_u32 s101, s101, 0x2000
v_mfma_f32_16x16x32_bf16 v[80:83], v[168:171], a[68:71], v[80:83]
buffer_load_dwordx4 a[104:107], v3, s[88:91], s101 offen sc1
v_mfma_f32_16x16x32_bf16 v[84:87], v[176:179], a[68:71], v[84:87]
ds_read_b64_tr_b16 v[208:209], v5 offset:256
ds_read_b64_tr_b16 v[210:211], v5 offset:4352
v_mfma_f32_16x16x32_bf16 v[84:87], v[180:183], a[76:79], v[84:87]
ds_read_b64_tr_b16 v[212:213], v5 offset:8448
s_waitcnt vmcnt(7) lgkmcnt(7)
v_mfma_f32_16x16x32_bf16 v[68:71], v[180:183], a[72:75], v[68:71]
ds_read_b64_tr_b16 v[214:215], v5 offset:12544
s_barrier
v_mfma_f32_16x16x32_bf16 v[68:71], v[176:179], a[64:67], v[68:71]
buffer_load_dwordx4 a[108:111], v3, s[88:91], s101 offen offset:1024 sc1
buffer_load_dword v14, v20, s[88:91], s24 offen sc1
v_mfma_f32_16x16x32_bf16 v[24:27], v[184:187], a[64:67], v[24:27]
ds_read_b64_tr_b16 v[152:153], v4 offset:16896
ds_read_b64_tr_b16 v[154:155], v4 offset:20992
v_mfma_f32_16x16x32_bf16 v[24:27], v[188:191], a[72:75], v[24:27]
ds_read_b64_tr_b16 v[156:157], v4 offset:25088
v_add_u32 v12, 0x20000, v12
v_mfma_f32_16x16x32_bf16 v[40:43], v[188:191], a[76:79], v[40:43]
ds_read_b64_tr_b16 v[158:159], v4 offset:29184
s_add_u32 m0, s16, 0x4000
v_mfma_f32_16x16x32_bf16 v[40:43], v[184:187], a[68:71], v[40:43]
buffer_load_dwordx4 v12, s[72:75], 0 offen lds
v_mfma_f32_16x16x32_bf16 v[44:47], v[192:195], a[68:71], v[44:47]
ds_read_b64_tr_b16 v[160:161], v5 offset:16896
ds_read_b64_tr_b16 v[162:163], v5 offset:20992
v_mfma_f32_16x16x32_bf16 v[44:47], v[196:199], a[76:79], v[44:47]
ds_read_b64_tr_b16 v[164:165], v5 offset:25088
v_add_u32 v13, 0x20000, v13
v_mfma_f32_16x16x32_bf16 v[28:31], v[196:199], a[72:75], v[28:31]
ds_read_b64_tr_b16 v[166:167], v5 offset:29184
s_waitcnt lgkmcnt(8)
v_mfma_f32_16x16x32_bf16 v[28:31], v[192:195], a[64:67], v[28:31]
buffer_load_dwordx4 v13, s[72:75], 0 offen offset:1024 lds
v_mfma_f32_16x16x32_bf16 v[32:35], v[200:203], a[64:67], v[32:35]
ds_read_b64_tr_b16 v[168:169], v4 offset:17152
ds_read_b64_tr_b16 v[170:171], v4 offset:21248
v_mfma_f32_16x16x32_bf16 v[32:35], v[204:207], a[72:75], v[32:35]
ds_read_b64_tr_b16 v[172:173], v4 offset:25344
v_mfma_f32_16x16x32_bf16 v[48:51], v[204:207], a[76:79], v[48:51]
ds_read_b64_tr_b16 v[174:175], v4 offset:29440
v_mfma_f32_16x16x32_bf16 v[48:51], v[200:203], a[68:71], v[48:51]
buffer_load_dwordx4 v12, s[72:75], s12 offen offset:2048 lds
v_mfma_f32_16x16x32_bf16 v[52:55], v[208:211], a[68:71], v[52:55]
ds_read_b64_tr_b16 v[176:177], v5 offset:17152
ds_read_b64_tr_b16 v[178:179], v5 offset:21248
v_mfma_f32_16x16x32_bf16 v[52:55], v[212:215], a[76:79], v[52:55]
ds_read_b64_tr_b16 v[180:181], v5 offset:25344
s_waitcnt lgkmcnt(7)
v_mfma_f32_16x16x32_bf16 v[36:39], v[212:215], a[72:75], v[36:39]
ds_read_b64_tr_b16 v[182:183], v5 offset:29440
v_mfma_f32_16x16x32_bf16 v[36:39], v[208:211], a[64:67], v[36:39]
buffer_load_dwordx4 v13, s[72:75], s12 offen offset:3072 lds
v_mfma_f32_16x16x32_bf16 v[56:59], v[152:155], a[80:83], v[56:59]
ds_read_b64_tr_b16 v[184:185], v4 offset:16384
ds_read_b64_tr_b16 v[186:187], v4 offset:20480
v_mfma_f32_16x16x32_bf16 v[56:59], v[156:159], a[88:91], v[56:59]
ds_read_b64_tr_b16 v[188:189], v4 offset:24576
v_mov_b32 v118, 0
v_mfma_f32_16x16x32_bf16 v[72:75], v[156:159], a[92:95], v[72:75]
ds_read_b64_tr_b16 v[190:191], v4 offset:28672
s_add_u32 s101, s101, 0x2000
v_mfma_f32_16x16x32_bf16 v[72:75], v[152:155], a[84:87], v[72:75]
buffer_load_dwordx4 a[112:115], v3, s[88:91], s101 offen sc1
v_mfma_f32_16x16x32_bf16 v[76:79], v[160:163], a[84:87], v[76:79]
ds_read_b64_tr_b16 v[192:193], v5 offset:16384
ds_read_b64_tr_b16 v[194:195], v5 offset:20480
v_mfma_f32_16x16x32_bf16 v[76:79], v[164:167], a[92:95], v[76:79]
ds_read_b64_tr_b16 v[196:197], v5 offset:24576
v_mov_b32 v119, 0
v_mfma_f32_16x16x32_bf16 v[60:63], v[164:167], a[88:91], v[60:63]
ds_read_b64_tr_b16 v[198:199], v5 offset:28672
s_waitcnt lgkmcnt(8)
v_mfma_f32_16x16x32_bf16 v[60:63], v[160:163], a[80:83], v[60:63]
buffer_load_dwordx4 a[116:119], v3, s[88:91], s101 offen offset:1024 sc1
v_mfma_f32_16x16x32_bf16 v[64:67], v[168:171], a[80:83], v[64:67]
ds_read_b64_tr_b16 v[200:201], v4 offset:16640
ds_read_b64_tr_b16 v[202:203], v4 offset:20736
v_mfma_f32_16x16x32_bf16 v[64:67], v[172:175], a[88:91], v[64:67]
ds_read_b64_tr_b16 v[204:205], v4 offset:24832
v_mfma_f32_16x16x32_bf16 v[80:83], v[172:175], a[92:95], v[80:83]
ds_read_b64_tr_b16 v[206:207], v4 offset:28928
s_add_u32 s101, s101, 0x2000
v_mfma_f32_16x16x32_bf16 v[80:83], v[168:171], a[84:87], v[80:83]
buffer_load_dwordx4 a[120:123], v3, s[88:91], s101 offen sc1
v_mfma_f32_16x16x32_bf16 v[84:87], v[176:179], a[84:87], v[84:87]
ds_read_b64_tr_b16 v[208:209], v5 offset:16640
ds_read_b64_tr_b16 v[210:211], v5 offset:20736
v_mfma_f32_16x16x32_bf16 v[84:87], v[180:183], a[92:95], v[84:87]
ds_read_b64_tr_b16 v[212:213], v5 offset:24832
s_waitcnt vmcnt(7) lgkmcnt(7)
v_mfma_f32_16x16x32_bf16 v[68:71], v[180:183], a[88:91], v[68:71]
ds_read_b64_tr_b16 v[214:215], v5 offset:28928
s_barrier
v_mfma_f32_16x16x32_bf16 v[68:71], v[176:179], a[80:83], v[68:71]
buffer_load_dwordx4 a[124:127], v3, s[88:91], s101 offen offset:1024 sc1
s_mov_b32 s92, 200000
L_spin_c:
v_cmp_ne_u32 vcc, 1, v14
s_nop 4
s_cbranch_vccz L_spun_c
s_sub_u32 s92, s92, 1
s_cbranch_scc1 L_spun_c
s_sleep 6
buffer_load_dword v14, v20, s[88:91], s24 offen sc1
s_waitcnt vmcnt(0)
s_branch L_spin_c
L_spun_c:
v_mfma_f32_16x16x32_bf16 v[24:27], v[184:187], a[80:83], v[24:27]
ds_read_b64_tr_b16 v[152:153], v6 offset:512
ds_read_b64_tr_b16 v[154:155], v6 offset:4608
v_mfma_f32_16x16x32_bf16 v[24:27], v[188:191], a[88:91], v[24:27]
ds_read_b64_tr_b16 v[156:157], v6 offset:8704
v_add_u32 v12, s25, v12
v_mfma_f32_16x16x32_bf16 v[40:43], v[188:191], a[92:95], v[40:43]
ds_read_b64_tr_b16 v[158:159], v6 offset:12800
s_add_u32 m0, s17, 0x10000
v_mfma_f32_16x16x32_bf16 v[40:43], v[184:187], a[84:87], v[40:43]
buffer_load_dwordx4 v12, s[64:67], s61 offen lds
v_mfma_f32_16x16x32_bf16 v[44:47], v[192:195], a[84:87], v[44:47]
ds_read_b64_tr_b16 v[160:161], v7 offset:512
ds_read_b64_tr_b16 v[162:163], v7 offset:4608
v_mfma_f32_16x16x32_bf16 v[44:47], v[196:199], a[92:95], v[44:47]
ds_read_b64_tr_b16 v[164:165], v7 offset:8704
v_add_u32 v13, s25, v13
v_mfma_f32_16x16x32_bf16 v[28:31], v[196:199], a[88:91], v[28:31]
ds_read_b64_tr_b16 v[166:167], v7 offset:12800
s_waitcnt lgkmcnt(8)
v_mfma_f32_16x16x32_bf16 v[28:31], v[192:195], a[80:83], v[28:31]
buffer_load_dwordx4 v13, s[64:67], s61 offen offset:1024 lds
v_mfma_f32_16x16x32_bf16 v[32:35], v[200:203], a[80:83], v[32:35]
ds_read_b64_tr_b16 v[168:169], v6 offset:768
ds_read_b64_tr_b16 v[170:171], v6 offset:4864
v_mfma_f32_16x16x32_bf16 v[32:35], v[204:207], a[88:91], v[32:35]
ds_read_b64_tr_b16 v[172:173], v6 offset:8960
s_add_u32 s63, s101, s26
v_mfma_f32_16x16x32_bf16 v[48:51], v[204:207], a[92:95], v[48:51]
ds_read_b64_tr_b16 v[174:175], v6 offset:13056
s_add_u32 s101, s63, s60
v_mfma_f32_16x16x32_bf16 v[48:51], v[200:203], a[84:87], v[48:51]
buffer_load_dwordx4 v12, s[64:67], s62 offen offset:2048 lds
v_mfma_f32_16x16x32_bf16 v[52:55], v[208:211], a[84:87], v[52:55]
ds_read_b64_tr_b16 v[176:177], v7 offset:768
ds_read_b64_tr_b16 v[178:179], v7 offset:4864
v_mfma_f32_16x16x32_bf16 v[52:55], v[212:215], a[92:95], v[52:55]
ds_read_b64_tr_b16 v[180:181], v7 offset:8960
s_waitcnt lgkmcnt(7)
v_mfma_f32_16x16x32_bf16 v[36:39], v[212:215], a[88:91], v[36:39]
ds_read_b64_tr_b16 v[182:183], v7 offset:13056
v_mfma_f32_16x16x32_bf16 v[36:39], v[208:211], a[80:83], v[36:39]
buffer_load_dwordx4 v13, s[64:67], s62 offen offset:3072 lds
v_mfma_f32_16x16x32_bf16 v[56:59], v[152:155], a[96:99], v[56:59]
ds_read_b64_tr_b16 v[184:185], v6 offset:0
ds_read_b64_tr_b16 v[186:187], v6 offset:4096
v_mfma_f32_16x16x32_bf16 v[56:59], v[156:159], a[104:107], v[56:59]
ds_read_b64_tr_b16 v[188:189], v6 offset:8192
s_add_u32 s60, s60, s57
v_mfma_f32_16x16x32_bf16 v[72:75], v[156:159], a[108:111], v[72:75]
ds_read_b64_tr_b16 v[190:191], v6 offset:12288
s_and_b32 s60, s60, 0x7c000
v_mfma_f32_16x16x32_bf16 v[72:75], v[152:155], a[100:103], v[72:75]
buffer_load_dwordx4 a[64:67], v3, s[88:91], s101 offen sc1
v_mfma_f32_16x16x32_bf16 v[76:79], v[160:163], a[100:103], v[76:79]
ds_read_b64_tr_b16 v[192:193], v7 offset:0
ds_read_b64_tr_b16 v[194:195], v7 offset:4096
v_mfma_f32_16x16x32_bf16 v[76:79], v[164:167], a[108:111], v[76:79]
ds_read_b64_tr_b16 v[196:197], v7 offset:8192
s_lshl_b32 s61, s60, 3
v_mfma_f32_16x16x32_bf16 v[60:63], v[164:167], a[104:107], v[60:63]
ds_read_b64_tr_b16 v[198:199], v7 offset:12288
s_waitcnt lgkmcnt(8)
v_mfma_f32_16x16x32_bf16 v[60:63], v[160:163], a[96:99], v[60:63]
buffer_load_dwordx4 a[68:71], v3, s[88:91], s101 offen offset:1024 sc1
v_mfma_f32_16x16x32_bf16 v[64:67], v[168:171], a[96:99], v[64:67]
ds_read_b64_tr_b16 v[200:201], v6 offset:256
ds_read_b64_tr_b16 v[202:203], v6 offset:4352
v_mfma_f32_16x16x32_bf16 v[64:67], v[172:175], a[104:107], v[64:67]
ds_read_b64_tr_b16 v[204:205], v6 offset:8448
s_add_u32 s62, s61, s12
v_mfma_f32_16x16x32_bf16 v[80:83], v[172:175], a[108:111], v[80:83]
ds_read_b64_tr_b16 v[206:207], v6 offset:12544
s_add_u32 s101, s101, 0x2000
v_mfma_f32_16x16x32_bf16 v[80:83], v[168:171], a[100:103], v[80:83]
buffer_load_dwordx4 a[72:75], v3, s[88:91], s101 offen sc1
v_mfma_f32_16x16x32_bf16 v[84:87], v[176:179], a[100:103], v[84:87]
ds_read_b64_tr_b16 v[208:209], v7 offset:256
ds_read_b64_tr_b16 v[210:211], v7 offset:4352
v_mfma_f32_16x16x32_bf16 v[84:87], v[180:183], a[108:111], v[84:87]
ds_read_b64_tr_b16 v[212:213], v7 offset:8448
s_waitcnt vmcnt(7) lgkmcnt(7)
v_mfma_f32_16x16x32_bf16 v[68:71], v[180:183], a[104:107], v[68:71]
ds_read_b64_tr_b16 v[214:215], v7 offset:12544
s_barrier
v_mfma_f32_16x16x32_bf16 v[68:71], v[176:179], a[96:99], v[68:71]
buffer_load_dwordx4 a[76:79], v3, s[88:91], s101 offen offset:1024 sc1
v_mfma_f32_16x16x32_bf16 v[24:27], v[184:187], a[96:99], v[24:27]
ds_read_b64_tr_b16 v[152:153], v6 offset:16896
ds_read_b64_tr_b16 v[154:155], v6 offset:20992
v_mfma_f32_16x16x32_bf16 v[24:27], v[188:191], a[104:107], v[24:27]
ds_read_b64_tr_b16 v[156:157], v6 offset:25088
s_add_u32 s101, s63, s60
v_mfma_f32_16x16x32_bf16 v[40:43], v[188:191], a[108:111], v[40:43]
ds_read_b64_tr_b16 v[158:159], v6 offset:29184
s_add_u32 m0, s17, 0x14000
v_mfma_f32_16x16x32_bf16 v[40:43], v[184:187], a[100:103], v[40:43]
buffer_load_dwordx4 v12, s[64:67], s61 offen lds
v_mfma_f32_16x16x32_bf16 v[44:47], v[192:195], a[100:103], v[44:47]
ds_read_b64_tr_b16 v[160:161], v7 offset:16896
ds_read_b64_tr_b16 v[162:163], v7 offset:20992
v_mfma_f32_16x16x32_bf16 v[44:47], v[196:199], a[108:111], v[44:47]
ds_read_b64_tr_b16 v[164:165], v7 offset:25088
v_mfma_f32_16x16x32_bf16 v[28:31], v[196:199], a[104:107], v[28:31]
ds_read_b64_tr_b16 v[166:167], v7 offset:29184
s_waitcnt lgkmcnt(8)
v_mfma_f32_16x16x32_bf16 v[28:31], v[192:195], a[96:99], v[28:31]
buffer_load_dwordx4 v13, s[64:67], s61 offen offset:1024 lds
v_mfma_f32_16x16x32_bf16 v[32:35], v[200:203], a[96:99], v[32:35]
ds_read_b64_tr_b16 v[168:169], v6 offset:17152
ds_read_b64_tr_b16 v[170:171], v6 offset:21248
v_mfma_f32_16x16x32_bf16 v[32:35], v[204:207], a[104:107], v[32:35]
ds_read_b64_tr_b16 v[172:173], v6 offset:25344
v_mfma_f32_16x16x32_bf16 v[48:51], v[204:207], a[108:111], v[48:51]
ds_read_b64_tr_b16 v[174:175], v6 offset:29440
v_mfma_f32_16x16x32_bf16 v[48:51], v[200:203], a[100:103], v[48:51]
buffer_load_dwordx4 v12, s[64:67], s62 offen offset:2048 lds
v_mfma_f32_16x16x32_bf16 v[52:55], v[208:211], a[100:103], v[52:55]
ds_read_b64_tr_b16 v[176:177], v7 offset:17152
ds_read_b64_tr_b16 v[178:179], v7 offset:21248
v_mfma_f32_16x16x32_bf16 v[52:55], v[212:215], a[108:111], v[52:55]
ds_read_b64_tr_b16 v[180:181], v7 offset:25344
s_waitcnt lgkmcnt(7)
v_mfma_f32_16x16x32_bf16 v[36:39], v[212:215], a[104:107], v[36:39]
ds_read_b64_tr_b16 v[182:183], v7 offset:29440
v_mfma_f32_16x16x32_bf16 v[36:39], v[208:211], a[96:99], v[36:39]
buffer_load_dwordx4 v13, s[64:67], s62 offen offset:3072 lds
v_mfma_f32_16x16x32_bf16 v[56:59], v[152:155], a[112:115], v[56:59]
ds_read_b64_tr_b16 v[184:185], v6 offset:16384
ds_read_b64_tr_b16 v[186:187], v6 offset:20480
v_mfma_f32_16x16x32_bf16 v[56:59], v[156:159], a[120:123], v[56:59]
ds_read_b64_tr_b16 v[188:189], v6 offset:24576
s_add_u32 s60, s60, s58
v_mfma_f32_16x16x32_bf16 v[72:75], v[156:159], a[124:127], v[72:75]
ds_read_b64_tr_b16 v[190:191], v6 offset:28672
s_and_b32 s60, s60, 0x7c000
v_mfma_f32_16x16x32_bf16 v[72:75], v[152:155], a[116:119], v[72:75]
buffer_load_dwordx4 a[80:83], v3, s[88:91], s101 offen sc1
v_mfma_f32_16x16x32_bf16 v[76:79], v[160:163], a[116:119], v[76:79]
ds_read_b64_tr_b16 v[192:193], v7 offset:16384
ds_read_b64_tr_b16 v[194:195], v7 offset:20480
v_mfma_f32_16x16x32_bf16 v[76:79], v[164:167], a[124:127], v[76:79]
ds_read_b64_tr_b16 v[196:197], v7 offset:24576
s_lshl_b32 s61, s60, 3
v_mfma_f32_16x16x32_bf16 v[60:63], v[164:167], a[120:123], v[60:63]
ds_read_b64_tr_b16 v[198:199], v7 offset:28672
s_waitcnt lgkmcnt(8)
v_mfma_f32_16x16x32_bf16 v[60:63], v[160:163], a[112:115], v[60:63]
buffer_load_dwordx4 a[84:87], v3, s[88:91], s101 offen offset:1024 sc1
v_mfma_f32_16x16x32_bf16 v[64:67], v[168:171], a[112:115], v[64:67]
ds_read_b64_tr_b16 v[200:201], v6 offset:16640
ds_read_b64_tr_b16 v[202:203], v6 offset:20736
v_mfma_f32_16x16x32_bf16 v[64:67], v[172:175], a[120:123], v[64:67]
ds_read_b64_tr_b16 v[204:205], v6 offset:24832
s_add_u32 s62, s61, s12
v_mfma_f32_16x16x32_bf16 v[80:83], v[172:175], a[124:127], v[80:83]
ds_read_b64_tr_b16 v[206:207], v6 offset:28928
s_add_u32 s101, s101, 0x2000
v_mfma_f32_16x16x32_bf16 v[80:83], v[168:171], a[116:119], v[80:83]
buffer_load_dwordx4 a[88:91], v3, s[88:91], s101 offen sc1
v_mfma_f32_16x16x32_bf16 v[84:87], v[176:179], a[116:119], v[84:87]
ds_read_b64_tr_b16 v[208:209], v7 offset:16640
ds_read_b64_tr_b16 v[210:211], v7 offset:20736
v_mfma_f32_16x16x32_bf16 v[84:87], v[180:183], a[124:127], v[84:87]
ds_read_b64_tr_b16 v[212:213], v7 offset:24832
s_waitcnt vmcnt(7) lgkmcnt(7)
v_mfma_f32_16x16x32_bf16 v[68:71], v[180:183], a[120:123], v[68:71]
ds_read_b64_tr_b16 v[214:215], v7 offset:28928
s_barrier
v_mfma_f32_16x16x32_bf16 v[68:71], v[176:179], a[112:115], v[68:71]
buffer_load_dwordx4 a[92:95], v3, s[88:91], s101 offen offset:1024 sc1
v_mfma_f32_16x16x32_bf16 v[24:27], v[184:187], a[112:115], v[24:27]
ds_read_b64_tr_b16 v[152:153], v4 offset:512
ds_read_b64_tr_b16 v[154:155], v4 offset:4608
v_mfma_f32_16x16x32_bf16 v[24:27], v[188:191], a[120:123], v[24:27]
ds_read_b64_tr_b16 v[156:157], v4 offset:8704
s_add_u32 s101, s63, s60
v_mfma_f32_16x16x32_bf16 v[40:43], v[188:191], a[124:127], v[40:43]
ds_read_b64_tr_b16 v[158:159], v4 offset:12800
s_add_u32 m0, s16, 0x0
v_mfma_f32_16x16x32_bf16 v[40:43], v[184:187], a[116:119], v[40:43]
buffer_load_dwordx4 v12, s[64:67], s61 offen lds
v_mfma_f32_16x16x32_bf16 v[44:47], v[192:195], a[116:119], v[44:47]
ds_read_b64_tr_b16 v[160:161], v5 offset:512
ds_read_b64_tr_b16 v[162:163], v5 offset:4608
v_mfma_f32_16x16x32_bf16 v[44:47], v[196:199], a[124:127], v[44:47]
ds_read_b64_tr_b16 v[164:165], v5 offset:8704
v_mfma_f32_16x16x32_bf16 v[28:31], v[196:199], a[120:123], v[28:31]
ds_read_b64_tr_b16 v[166:167], v5 offset:12800
s_waitcnt lgkmcnt(8)
v_mfma_f32_16x16x32_bf16 v[28:31], v[192:195], a[112:115], v[28:31]
buffer_load_dwordx4 v13, s[64:67], s61 offen offset:1024 lds
v_mfma_f32_16x16x32_bf16 v[32:35], v[200:203], a[112:115], v[32:35]
ds_read_b64_tr_b16 v[168:169], v4 offset:768
ds_read_b64_tr_b16 v[170:171], v4 offset:4864
v_mfma_f32_16x16x32_bf16 v[32:35], v[204:207], a[120:123], v[32:35]
ds_read_b64_tr_b16 v[172:173], v4 offset:8960
v_mfma_f32_16x16x32_bf16 v[48:51], v[204:207], a[124:127], v[48:51]
ds_read_b64_tr_b16 v[174:175], v4 offset:13056
v_mfma_f32_16x16x32_bf16 v[48:51], v[200:203], a[116:119], v[48:51]
buffer_load_dwordx4 v12, s[64:67], s62 offen offset:2048 lds
v_mfma_f32_16x16x32_bf16 v[52:55], v[208:211], a[116:119], v[52:55]
ds_read_b64_tr_b16 v[176:177], v5 offset:768
ds_read_b64_tr_b16 v[178:179], v5 offset:4864
v_mfma_f32_16x16x32_bf16 v[52:55], v[212:215], a[124:127], v[52:55]
ds_read_b64_tr_b16 v[180:181], v5 offset:8960
s_waitcnt lgkmcnt(7)
v_mfma_f32_16x16x32_bf16 v[36:39], v[212:215], a[120:123], v[36:39]
ds_read_b64_tr_b16 v[182:183], v5 offset:13056
v_mfma_f32_16x16x32_bf16 v[36:39], v[208:211], a[112:115], v[36:39]
buffer_load_dwordx4 v13, s[64:67], s62 offen offset:3072 lds
v_mfma_f32_16x16x32_bf16 v[120:123], v[152:155], a[64:67], 0
ds_read_b64_tr_b16 v[184:185], v4 offset:0
ds_read_b64_tr_b16 v[186:187], v4 offset:4096
v_mfma_f32_16x16x32_bf16 v[120:123], v[156:159], a[72:75], v[120:123]
ds_read_b64_tr_b16 v[188:189], v4 offset:8192
s_add_u32 s60, s60, s59
v_mfma_f32_16x16x32_bf16 v[136:139], v[156:159], a[76:79], 0
ds_read_b64_tr_b16 v[190:191], v4 offset:12288
s_and_b32 s60, s60, 0x7c000
v_mfma_f32_16x16x32_bf16 v[136:139], v[152:155], a[68:71], v[136:139]
buffer_load_dwordx4 a[96:99], v3, s[88:91], s101 offen sc1
v_mfma_f32_16x16x32_bf16 v[140:143], v[160:163], a[68:71], 0
ds_read_b64_tr_b16 v[192:193], v5 offset:0
ds_read_b64_tr_b16 v[194:195], v5 offset:4096
v_mfma_f32_16x16x32_bf16 v[140:143], v[164:167], a[76:79], v[140:143]
ds_read_b64_tr_b16 v[196:197], v5 offset:8192
s_lshl_b32 s61, s60, 3
v_mfma_f32_16x16x32_bf16 v[124:127], v[164:167], a[72:75], 0
ds_read_b64_tr_b16 v[198:199], v5 offset:12288
s_waitcnt lgkmcnt(8)
v_mfma_f32_16x16x32_bf16 v[124:127], v[160:163], a[64:67], v[124:127]
buffer_load_dwordx4 a[100:103], v3, s[88:91], s101 offen offset:1024 sc1
v_mfma_f32_16x16x32_bf16 v[128:131], v[168:171], a[64:67], 0
ds_read_b64_tr_b16 v[200:201], v4 offset:256
ds_read_b64_tr_b16 v[202:203], v4 offset:4352
v_mfma_f32_16x16x32_bf16 v[128:131], v[172:175], a[72:75], v[128:131]
ds_read_b64_tr_b16 v[204:205], v4 offset:8448
s_add_u32 s62, s61, s12
v_mfma_f32_16x16x32_bf16 v[144:147], v[172:175], a[76:79], 0
ds_read_b64_tr_b16 v[206:207], v4 offset:12544
s_add_u32 s101, s101, 0x2000
v_mfma_f32_16x16x32_bf16 v[144:147], v[168:171], a[68:71], v[144:147]
buffer_load_dwordx4 a[104:107], v3, s[88:91], s101 offen sc1
v_mfma_f32_16x16x32_bf16 v[148:151], v[176:179], a[68:71], 0
ds_read_b64_tr_b16 v[208:209], v5 offset:256
ds_read_b64_tr_b16 v[210:211], v5 offset:4352
v_mfma_f32_16x16x32_bf16 v[148:151], v[180:183], a[76:79], v[148:151]
ds_read_b64_tr_b16 v[212:213], v5 offset:8448
s_waitcnt vmcnt(7) lgkmcnt(7)
v_mfma_f32_16x16x32_bf16 v[132:135], v[180:183], a[72:75], 0
ds_read_b64_tr_b16 v[214:215], v5 offset:12544
s_barrier
v_mfma_f32_16x16x32_bf16 v[132:135], v[176:179], a[64:67], v[132:135]
buffer_load_dwordx4 a[108:111], v3, s[88:91], s101 offen offset:1024 sc1
s_mov_b32 s15, 7
L_p4_loop:
v_mfma_f32_16x16x32_bf16 v[88:91], v[184:187], a[64:67], v[88:91]
ds_read_b64_tr_b16 v[152:153], v4 offset:16896
ds_read_b64_tr_b16 v[154:155], v4 offset:20992
v_mfma_f32_16x16x32_bf16 v[88:91], v[188:191], a[72:75], v[88:91]
ds_read_b64_tr_b16 v[156:157], v4 offset:25088
s_add_u32 s101, s63, s60
v_mfma_f32_16x16x32_bf16 v[104:107], v[188:191], a[76:79], v[104:107]
ds_read_b64_tr_b16 v[158:159], v4 offset:29184
s_add_u32 m0, s16, 0x4000
v_mfma_f32_16x16x32_bf16 v[104:107], v[184:187], a[68:71], v[104:107]
buffer_load_dwordx4 v12, s[64:67], s61 offen lds
v_mfma_f32_16x16x32_bf16 v[108:111], v[192:195], a[68:71], v[108:111]
ds_read_b64_tr_b16 v[160:161], v5 offset:16896
ds_read_b64_tr_b16 v[162:163], v5 offset:20992
v_mfma_f32_16x16x32_bf16 v[108:111], v[196:199], a[76:79], v[108:111]
ds_read_b64_tr_b16 v[164:165], v5 offset:25088
v_mfma_f32_16x16x32_bf16 v[92:95], v[196:199], a[72:75], v[92:95]
ds_read_b64_tr_b16 v[166:167], v5 offset:29184
s_waitcnt lgkmcnt(8)
v_mfma_f32_16x16x32_bf16 v[92:95], v[192:195], a[64:67], v[92:95]
buffer_load_dwordx4 v13, s[64:67], s61 offen offset:1024 lds
v_mfma_f32_16x16x32_bf16 v[96:99], v[200:203], a[64:67], v[96:99]
ds_read_b64_tr_b16 v[168:169], v4 offset:17152
ds_read_b64_tr_b16 v[170:171], v4 offset:21248
v_mfma_f32_16x16x32_bf16 v[96:99], v[204:207], a[72:75], v[96:99]
ds_read_b64_tr_b16 v[172:173], v4 offset:25344
v_mfma_f32_16x16x32_bf16 v[112:115], v[204:207], a[76:79], v[112:115]
ds_read_b64_tr_b16 v[174:175], v4 offset:29440
v_mfma_f32_16x16x32_bf16 v[112:115], v[200:203], a[68:71], v[112:115]
buffer_load_dwordx4 v12, s[64:67], s62 offen offset:2048 lds
v_mfma_f32_16x16x32_bf16 v[116:119], v[208:211], a[68:71], v[116:119]
ds_read_b64_tr_b16 v[176:177], v5 offset:17152
ds_read_b64_tr_b16 v[178:179], v5 offset:21248
v_mfma_f32_16x16x32_bf16 v[116:119], v[212:215], a[76:79], v[116:119]
ds_read_b64_tr_b16 v[180:181], v5 offset:25344
s_waitcnt lgkmcnt(7)
v_mfma_f32_16x16x32_bf16 v[100:103], v[212:215], a[72:75], v[100:103]
ds_read_b64_tr_b16 v[182:183], v5 offset:29440
v_mfma_f32_16x16x32_bf16 v[100:103], v[208:211], a[64:67], v[100:103]
buffer_load_dwordx4 v13, s[64:67], s62 offen offset:3072 lds
v_mfma_f32_16x16x32_bf16 v[120:123], v[152:155], a[80:83], v[120:123]
ds_read_b64_tr_b16 v[184:185], v4 offset:16384
ds_read_b64_tr_b16 v[186:187], v4 offset:20480
v_mfma_f32_16x16x32_bf16 v[120:123], v[156:159], a[88:91], v[120:123]
ds_read_b64_tr_b16 v[188:189], v4 offset:24576
s_add_u32 s60, s60, s56
v_mfma_f32_16x16x32_bf16 v[136:139], v[156:159], a[92:95], v[136:139]
ds_read_b64_tr_b16 v[190:191], v4 offset:28672
s_and_b32 s60, s60, 0x7c000
v_mfma_f32_16x16x32_bf16 v[136:139], v[152:155], a[84:87], v[136:139]
buffer_load_dwordx4 a[112:115], v3, s[88:91], s101 offen sc1
v_mfma_f32_16x16x32_bf16 v[140:143], v[160:163], a[84:87], v[140:143]
ds_read_b64_tr_b16 v[192:193], v5 offset:16384
ds_read_b64_tr_b16 v[194:195], v5 offset:20480
v_mfma_f32_16x16x32_bf16 v[140:143], v[164:167], a[92:95], v[140:143]
ds_read_b64_tr_b16 v[196:197], v5 offset:24576
s_lshl_b32 s61, s60, 3
v_mfma_f32_16x16x32_bf16 v[124:127], v[164:167], a[88:91], v[124:127]
ds_read_b64_tr_b16 v[198:199], v5 offset:28672
s_waitcnt lgkmcnt(8)
v_mfma_f32_16x16x32_bf16 v[124:127], v[160:163], a[80:83], v[124:127]
buffer_load_dwordx4 a[116:119], v3, s[88:91], s101 offen offset:1024 sc1
v_mfma_f32_16x16x32_bf16 v[128:131], v[168:171], a[80:83], v[128:131]
ds_read_b64_tr_b16 v[200:201], v4 offset:16640
ds_read_b64_tr_b16 v[202:203], v4 offset:20736
v_mfma_f32_16x16x32_bf16 v[128:131], v[172:175], a[88:91], v[128:131]
ds_read_b64_tr_b16 v[204:205], v4 offset:24832
s_add_u32 s62, s61, s12
v_mfma_f32_16x16x32_bf16 v[144:147], v[172:175], a[92:95], v[144:147]
ds_read_b64_tr_b16 v[206:207], v4 offset:28928
s_add_u32 s101, s101, 0x2000
v_mfma_f32_16x16x32_bf16 v[144:147], v[168:171], a[84:87], v[144:147]
buffer_load_dwordx4 a[120:123], v3, s[88:91], s101 offen sc1
v_mfma_f32_16x16x32_bf16 v[148:151], v[176:179], a[84:87], v[148:151]
ds_read_b64_tr_b16 v[208:209], v5 offset:16640
ds_read_b64_tr_b16 v[210:211], v5 offset:20736
v_mfma_f32_16x16x32_bf16 v[148:151], v[180:183], a[92:95], v[148:151]
ds_read_b64_tr_b16 v[212:213], v5 offset:24832
s_waitcnt vmcnt(7) lgkmcnt(7)
v_mfma_f32_16x16x32_bf16 v[132:135], v[180:183], a[88:91], v[132:135]
ds_read_b64_tr_b16 v[214:215], v5 offset:28928
s_barrier
v_mfma_f32_16x16x32_bf16 v[132:135], v[176:179], a[80:83], v[132:135]
buffer_load_dwordx4 a[124:127], v3, s[88:91], s101 offen offset:1024 sc1
v_mfma_f32_16x16x32_bf16 v[88:91], v[184:187], a[80:83], v[88:91]
ds_read_b64_tr_b16 v[152:153], v6 offset:512
ds_read_b64_tr_b16 v[154:155], v6 offset:4608
v_mfma_f32_16x16x32_bf16 v[88:91], v[188:191], a[88:91], v[88:91]
ds_read_b64_tr_b16 v[156:157], v6 offset:8704
s_add_u32 s101, s63, s60
v_mfma_f32_16x16x32_bf16 v[104:107], v[188:191], a[92:95], v[104:107]
ds_read_b64_tr_b16 v[158:159], v6 offset:12800
s_add_u32 m0, s17, 0x10000
v_mfma_f32_16x16x32_bf16 v[104:107], v[184:187], a[84:87], v[104:107]
buffer_load_dwordx4 v12, s[64:67], s61 offen lds
v_mfma_f32_16x16x32_bf16 v[108:111], v[192:195], a[84:87], v[108:111]
ds_read_b64_tr_b16 v[160:161], v7 offset:512
ds_read_b64_tr_b16 v[162:163], v7 offset:4608
v_mfma_f32_16x16x32_bf16 v[108:111], v[196:199], a[92:95], v[108:111]
ds_read_b64_tr_b16 v[164:165], v7 offset:8704
v_mfma_f32_16x16x32_bf16 v[92:95], v[196:199], a[88:91], v[92:95]
ds_read_b64_tr_b16 v[166:167], v7 offset:12800
s_waitcnt lgkmcnt(8)
v_mfma_f32_16x16x32_bf16 v[92:95], v[192:195], a[80:83], v[92:95]
buffer_load_dwordx4 v13, s[64:67], s61 offen offset:1024 lds
v_mfma_f32_16x16x32_bf16 v[96:99], v[200:203], a[80:83], v[96:99]
ds_read_b64_tr_b16 v[168:169], v6 offset:768
ds_read_b64_tr_b16 v[170:171], v6 offset:4864
v_mfma_f32_16x16x32_bf16 v[96:99], v[204:207], a[88:91], v[96:99]
ds_read_b64_tr_b16 v[172:173], v6 offset:8960
v_mfma_f32_16x16x32_bf16 v[112:115], v[204:207], a[92:95], v[112:115]
ds_read_b64_tr_b16 v[174:175], v6 offset:13056
v_mfma_f32_16x16x32_bf16 v[112:115], v[200:203], a[84:87], v[112:115]
buffer_load_dwordx4 v12, s[64:67], s62 offen offset:2048 lds
v_mfma_f32_16x16x32_bf16 v[116:119], v[208:211], a[84:87], v[116:119]
ds_read_b64_tr_b16 v[176:177], v7 offset:768
ds_read_b64_tr_b16 v[178:179], v7 offset:4864
v_mfma_f32_16x16x32_bf16 v[116:119], v[212:215], a[92:95], v[116:119]
ds_read_b64_tr_b16 v[180:181], v7 offset:8960
s_waitcnt lgkmcnt(7)
v_mfma_f32_16x16x32_bf16 v[100:103], v[212:215], a[88:91], v[100:103]
ds_read_b64_tr_b16 v[182:183], v7 offset:13056
v_mfma_f32_16x16x32_bf16 v[100:103], v[208:211], a[80:83], v[100:103]
buffer_load_dwordx4 v13, s[64:67], s62 offen offset:3072 lds
v_mfma_f32_16x16x32_bf16 v[120:123], v[152:155], a[96:99], v[120:123]
ds_read_b64_tr_b16 v[184:185], v6 offset:0
ds_read_b64_tr_b16 v[186:187], v6 offset:4096
v_mfma_f32_16x16x32_bf16 v[120:123], v[156:159], a[104:107], v[120:123]
ds_read_b64_tr_b16 v[188:189], v6 offset:8192
s_add_u32 s60, s60, s57
v_mfma_f32_16x16x32_bf16 v[136:139], v[156:159], a[108:111], v[136:139]
ds_read_b64_tr_b16 v[190:191], v6 offset:12288
s_and_b32 s60, s60, 0x7c000
v_mfma_f32_16x16x32_bf16 v[136:139], v[152:155], a[100:103], v[136:139]
buffer_load_dwordx4 a[64:67], v3, s[88:91], s101 offen sc1
v_mfma_f32_16x16x32_bf16 v[140:143], v[160:163], a[100:103], v[140:143]
ds_read_b64_tr_b16 v[192:193], v7 offset:0
ds_read_b64_tr_b16 v[194:195], v7 offset:4096
v_mfma_f32_16x16x32_bf16 v[140:143], v[164:167], a[108:111], v[140:143]
ds_read_b64_tr_b16 v[196:197], v7 offset:8192
s_lshl_b32 s61, s60, 3
v_mfma_f32_16x16x32_bf16 v[124:127], v[164:167], a[104:107], v[124:127]
ds_read_b64_tr_b16 v[198:199], v7 offset:12288
s_waitcnt lgkmcnt(8)
v_mfma_f32_16x16x32_bf16 v[124:127], v[160:163], a[96:99], v[124:127]
buffer_load_dwordx4 a[68:71], v3, s[88:91], s101 offen offset:1024 sc1
v_mfma_f32_16x16x32_bf16 v[128:131], v[168:171], a[96:99], v[128:131]
ds_read_b64_tr_b16 v[200:201], v6 offset:256
ds_read_b64_tr_b16 v[202:203], v6 offset:4352
v_mfma_f32_16x16x32_bf16 v[128:131], v[172:175], a[104:107], v[128:131]
ds_read_b64_tr_b16 v[204:205], v6 offset:8448
s_add_u32 s62, s61, s12
v_mfma_f32_16x16x32_bf16 v[144:147], v[172:175], a[108:111], v[144:147]
ds_read_b64_tr_b16 v[206:207], v6 offset:12544
s_add_u32 s101, s101, 0x2000
v_mfma_f32_16x16x32_bf16 v[144:147], v[168:171], a[100:103], v[144:147]
buffer_load_dwordx4 a[72:75], v3, s[88:91], s101 offen sc1
v_mfma_f32_16x16x32_bf16 v[148:151], v[176:179], a[100:103], v[148:151]
ds_read_b64_tr_b16 v[208:209], v7 offset:256
ds_read_b64_tr_b16 v[210:211], v7 offset:4352
v_mfma_f32_16x16x32_bf16 v[148:151], v[180:183], a[108:111], v[148:151]
ds_read_b64_tr_b16 v[212:213], v7 offset:8448
s_waitcnt vmcnt(7) lgkmcnt(7)
v_mfma_f32_16x16x32_bf16 v[132:135], v[180:183], a[104:107], v[132:135]
ds_read_b64_tr_b16 v[214:215], v7 offset:12544
s_barrier
v_mfma_f32_16x16x32_bf16 v[132:135], v[176:179], a[96:99], v[132:135]
buffer_load_dwordx4 a[76:79], v3, s[88:91], s101 offen offset:1024 sc1
v_mfma_f32_16x16x32_bf16 v[88:91], v[184:187], a[96:99], v[88:91]
ds_read_b64_tr_b16 v[152:153], v6 offset:16896
ds_read_b64_tr_b16 v[154:155], v6 offset:20992
v_mfma_f32_16x16x32_bf16 v[88:91], v[188:191], a[104:107], v[88:91]
ds_read_b64_tr_b16 v[156:157], v6 offset:25088
s_add_u32 s101, s63, s60
v_mfma_f32_16x16x32_bf16 v[104:107], v[188:191], a[108:111], v[104:107]
ds_read_b64_tr_b16 v[158:159], v6 offset:29184
s_add_u32 m0, s17, 0x14000
v_mfma_f32_16x16x32_bf16 v[104:107], v[184:187], a[100:103], v[104:107]
buffer_load_dwordx4 v12, s[64:67], s61 offen lds
v_mfma_f32_16x16x32_bf16 v[108:111], v[192:195], a[100:103], v[108:111]
ds_read_b64_tr_b16 v[160:161], v7 offset:16896
ds_read_b64_tr_b16 v[162:163], v7 offset:20992
v_mfma_f32_16x16x32_bf16 v[108:111], v[196:199], a[108:111], v[108:111]
ds_read_b64_tr_b16 v[164:165], v7 offset:25088
v_mfma_f32_16x16x32_bf16 v[92:95], v[196:199], a[104:107], v[92:95]
ds_read_b64_tr_b16 v[166:167], v7 offset:29184
s_waitcnt lgkmcnt(8)
v_mfma_f32_16x16x32_bf16 v[92:95], v[192:195], a[96:99], v[92:95]
buffer_load_dwordx4 v13, s[64:67], s61 offen offset:1024 lds
v_mfma_f32_16x16x32_bf16 v[96:99], v[200:203], a[96:99], v[96:99]
ds_read_b64_tr_b16 v[168:169], v6 offset:17152
ds_read_b64_tr_b16 v[170:171], v6 offset:21248
v_mfma_f32_16x16x32_bf16 v[96:99], v[204:207], a[104:107], v[96:99]
ds_read_b64_tr_b16 v[172:173], v6 offset:25344
v_mfma_f32_16x16x32_bf16 v[112:115], v[204:207], a[108:111], v[112:115]
ds_read_b64_tr_b16 v[174:175], v6 offset:29440
v_mfma_f32_16x16x32_bf16 v[112:115], v[200:203], a[100:103], v[112:115]
buffer_load_dwordx4 v12, s[64:67], s62 offen offset:2048 lds
v_mfma_f32_16x16x32_bf16 v[116:119], v[208:211], a[100:103], v[116:119]
ds_read_b64_tr_b16 v[176:177], v7 offset:17152
ds_read_b64_tr_b16 v[178:179], v7 offset:21248
v_mfma_f32_16x16x32_bf16 v[116:119], v[212:215], a[108:111], v[116:119]
ds_read_b64_tr_b16 v[180:181], v7 offset:25344
s_waitcnt lgkmcnt(7)
v_mfma_f32_16x16x32_bf16 v[100:103], v[212:215], a[104:107], v[100:103]
ds_read_b64_tr_b16 v[182:183], v7 offset:29440
v_mfma_f32_16x16x32_bf16 v[100:103], v[208:211], a[96:99], v[100:103]
buffer_load_dwordx4 v13, s[64:67], s62 offen offset:3072 lds
v_mfma_f32_16x16x32_bf16 v[120:123], v[152:155], a[112:115], v[120:123]
ds_read_b64_tr_b16 v[184:185], v6 offset:16384
ds_read_b64_tr_b16 v[186:187], v6 offset:20480
v_mfma_f32_16x16x32_bf16 v[120:123], v[156:159], a[120:123], v[120:123]
ds_read_b64_tr_b16 v[188:189], v6 offset:24576
s_add_u32 s60, s60, s58
v_mfma_f32_16x16x32_bf16 v[136:139], v[156:159], a[124:127], v[136:139]
ds_read_b64_tr_b16 v[190:191], v6 offset:28672
s_and_b32 s60, s60, 0x7c000
v_mfma_f32_16x16x32_bf16 v[136:139], v[152:155], a[116:119], v[136:139]
buffer_load_dwordx4 a[80:83], v3, s[88:91], s101 offen sc1
v_mfma_f32_16x16x32_bf16 v[140:143], v[160:163], a[116:119], v[140:143]
ds_read_b64_tr_b16 v[192:193], v7 offset:16384
ds_read_b64_tr_b16 v[194:195], v7 offset:20480
v_mfma_f32_16x16x32_bf16 v[140:143], v[164:167], a[124:127], v[140:143]
ds_read_b64_tr_b16 v[196:197], v7 offset:24576
s_lshl_b32 s61, s60, 3
v_mfma_f32_16x16x32_bf16 v[124:127], v[164:167], a[120:123], v[124:127]
ds_read_b64_tr_b16 v[198:199], v7 offset:28672
s_waitcnt lgkmcnt(8)
v_mfma_f32_16x16x32_bf16 v[124:127], v[160:163], a[112:115], v[124:127]
buffer_load_dwordx4 a[84:87], v3, s[88:91], s101 offen offset:1024 sc1
v_mfma_f32_16x16x32_bf16 v[128:131], v[168:171], a[112:115], v[128:131]
ds_read_b64_tr_b16 v[200:201], v6 offset:16640
ds_read_b64_tr_b16 v[202:203], v6 offset:20736
v_mfma_f32_16x16x32_bf16 v[128:131], v[172:175], a[120:123], v[128:131]
ds_read_b64_tr_b16 v[204:205], v6 offset:24832
s_add_u32 s62, s61, s12
v_mfma_f32_16x16x32_bf16 v[144:147], v[172:175], a[124:127], v[144:147]
ds_read_b64_tr_b16 v[206:207], v6 offset:28928
s_add_u32 s101, s101, 0x2000
v_mfma_f32_16x16x32_bf16 v[144:147], v[168:171], a[116:119], v[144:147]
buffer_load_dwordx4 a[88:91], v3, s[88:91], s101 offen sc1
v_mfma_f32_16x16x32_bf16 v[148:151], v[176:179], a[116:119], v[148:151]
ds_read_b64_tr_b16 v[208:209], v7 offset:16640
ds_read_b64_tr_b16 v[210:211], v7 offset:20736
v_mfma_f32_16x16x32_bf16 v[148:151], v[180:183], a[124:127], v[148:151]
ds_read_b64_tr_b16 v[212:213], v7 offset:24832
s_waitcnt vmcnt(7) lgkmcnt(7)
v_mfma_f32_16x16x32_bf16 v[132:135], v[180:183], a[120:123], v[132:135]
ds_read_b64_tr_b16 v[214:215], v7 offset:28928
s_barrier
v_mfma_f32_16x16x32_bf16 v[132:135], v[176:179], a[112:115], v[132:135]
buffer_load_dwordx4 a[92:95], v3, s[88:91], s101 offen offset:1024 sc1
v_mfma_f32_16x16x32_bf16 v[88:91], v[184:187], a[112:115], v[88:91]
ds_read_b64_tr_b16 v[152:153], v4 offset:512
ds_read_b64_tr_b16 v[154:155], v4 offset:4608
v_mfma_f32_16x16x32_bf16 v[88:91], v[188:191], a[120:123], v[88:91]
ds_read_b64_tr_b16 v[156:157], v4 offset:8704
s_add_u32 s101, s63, s60
v_mfma_f32_16x16x32_bf16 v[104:107], v[188:191], a[124:127], v[104:107]
ds_read_b64_tr_b16 v[158:159], v4 offset:12800
s_add_u32 m0, s16, 0x0
v_mfma_f32_16x16x32_bf16 v[104:107], v[184:187], a[116:119], v[104:107]
buffer_load_dwordx4 v12, s[64:67], s61 offen lds
v_mfma_f32_16x16x32_bf16 v[108:111], v[192:195], a[116:119], v[108:111]
ds_read_b64_tr_b16 v[160:161], v5 offset:512
ds_read_b64_tr_b16 v[162:163], v5 offset:4608
v_mfma_f32_16x16x32_bf16 v[108:111], v[196:199], a[124:127], v[108:111]
ds_read_b64_tr_b16 v[164:165], v5 offset:8704
s_sub_u32 s15, s15, 1
v_mfma_f32_16x16x32_bf16 v[92:95], v[196:199], a[120:123], v[92:95]
ds_read_b64_tr_b16 v[166:167], v5 offset:12800
s_waitcnt lgkmcnt(8)
v_mfma_f32_16x16x32_bf16 v[92:95], v[192:195], a[112:115], v[92:95]
buffer_load_dwordx4 v13, s[64:67], s61 offen offset:1024 lds
v_mfma_f32_16x16x32_bf16 v[96:99], v[200:203], a[112:115], v[96:99]
ds_read_b64_tr_b16 v[168:169], v4 offset:768
ds_read_b64_tr_b16 v[170:171], v4 offset:4864
v_mfma_f32_16x16x32_bf16 v[96:99], v[204:207], a[120:123], v[96:99]
ds_read_b64_tr_b16 v[172:173], v4 offset:8960
v_mfma_f32_16x16x32_bf16 v[112:115], v[204:207], a[124:127], v[112:115]
ds_read_b64_tr_b16 v[174:175], v4 offset:13056
v_mfma_f32_16x16x32_bf16 v[112:115], v[200:203], a[116:119], v[112:115]
buffer_load_dwordx4 v12, s[64:67], s62 offen offset:2048 lds
v_mfma_f32_16x16x32_bf16 v[116:119], v[208:211], a[116:119], v[116:119]
ds_read_b64_tr_b16 v[176:177], v5 offset:768
ds_read_b64_tr_b16 v[178:179], v5 offset:4864
v_mfma_f32_16x16x32_bf16 v[116:119], v[212:215], a[124:127], v[116:119]
ds_read_b64_tr_b16 v[180:181], v5 offset:8960
s_waitcnt lgkmcnt(7)
v_mfma_f32_16x16x32_bf16 v[100:103], v[212:215], a[120:123], v[100:103]
ds_read_b64_tr_b16 v[182:183], v5 offset:13056
v_mfma_f32_16x16x32_bf16 v[100:103], v[208:211], a[112:115], v[100:103]
buffer_load_dwordx4 v13, s[64:67], s62 offen offset:3072 lds
v_mfma_f32_16x16x32_bf16 v[120:123], v[152:155], a[64:67], v[120:123]
ds_read_b64_tr_b16 v[184:185], v4 offset:0
ds_read_b64_tr_b16 v[186:187], v4 offset:4096
v_mfma_f32_16x16x32_bf16 v[120:123], v[156:159], a[72:75], v[120:123]
ds_read_b64_tr_b16 v[188:189], v4 offset:8192
s_add_u32 s60, s60, s59
v_mfma_f32_16x16x32_bf16 v[136:139], v[156:159], a[76:79], v[136:139]
ds_read_b64_tr_b16 v[190:191], v4 offset:12288
s_and_b32 s60, s60, 0x7c000
v_mfma_f32_16x16x32_bf16 v[136:139], v[152:155], a[68:71], v[136:139]
buffer_load_dwordx4 a[96:99], v3, s[88:91], s101 offen sc1
v_mfma_f32_16x16x32_bf16 v[140:143], v[160:163], a[68:71], v[140:143]
ds_read_b64_tr_b16 v[192:193], v5 offset:0
ds_read_b64_tr_b16 v[194:195], v5 offset:4096
v_mfma_f32_16x16x32_bf16 v[140:143], v[164:167], a[76:79], v[140:143]
ds_read_b64_tr_b16 v[196:197], v5 offset:8192
s_lshl_b32 s61, s60, 3
v_mfma_f32_16x16x32_bf16 v[124:127], v[164:167], a[72:75], v[124:127]
ds_read_b64_tr_b16 v[198:199], v5 offset:12288
s_waitcnt lgkmcnt(8)
v_mfma_f32_16x16x32_bf16 v[124:127], v[160:163], a[64:67], v[124:127]
buffer_load_dwordx4 a[100:103], v3, s[88:91], s101 offen offset:1024 sc1
v_mfma_f32_16x16x32_bf16 v[128:131], v[168:171], a[64:67], v[128:131]
ds_read_b64_tr_b16 v[200:201], v4 offset:256
ds_read_b64_tr_b16 v[202:203], v4 offset:4352
v_mfma_f32_16x16x32_bf16 v[128:131], v[172:175], a[72:75], v[128:131]
ds_read_b64_tr_b16 v[204:205], v4 offset:8448
s_add_u32 s62, s61, s12
v_mfma_f32_16x16x32_bf16 v[144:147], v[172:175], a[76:79], v[144:147]
ds_read_b64_tr_b16 v[206:207], v4 offset:12544
s_add_u32 s101, s101, 0x2000
v_mfma_f32_16x16x32_bf16 v[144:147], v[168:171], a[68:71], v[144:147]
buffer_load_dwordx4 a[104:107], v3, s[88:91], s101 offen sc1
v_mfma_f32_16x16x32_bf16 v[148:151], v[176:179], a[68:71], v[148:151]
ds_read_b64_tr_b16 v[208:209], v5 offset:256
ds_read_b64_tr_b16 v[210:211], v5 offset:4352
v_mfma_f32_16x16x32_bf16 v[148:151], v[180:183], a[76:79], v[148:151]
ds_read_b64_tr_b16 v[212:213], v5 offset:8448
s_waitcnt vmcnt(7) lgkmcnt(7)
v_mfma_f32_16x16x32_bf16 v[132:135], v[180:183], a[72:75], v[132:135]
ds_read_b64_tr_b16 v[214:215], v5 offset:12544
s_barrier
v_mfma_f32_16x16x32_bf16 v[132:135], v[176:179], a[64:67], v[132:135]
buffer_load_dwordx4 a[108:111], v3, s[88:91], s101 offen offset:1024 sc1
s_cmp_lg_u32 s15, 0
s_cbranch_scc1 L_p4_loop
s_add_u32 s101, s63, s60
v_mfma_f32_16x16x32_bf16 v[88:91], v[184:187], a[64:67], v[88:91]
ds_read_b64_tr_b16 v[152:153], v4 offset:16896
ds_read_b64_tr_b16 v[154:155], v4 offset:20992
s_add_u32 m0, s16, 0x4000
v_mfma_f32_16x16x32_bf16 v[88:91], v[188:191], a[72:75], v[88:91]
buffer_load_dwordx4 v12, s[64:67], s61 offen lds
v_mfma_f32_16x16x32_bf16 v[104:107], v[188:191], a[76:79], v[104:107]
ds_read_b64_tr_b16 v[156:157], v4 offset:25088
ds_read_b64_tr_b16 v[158:159], v4 offset:29184
v_mfma_f32_16x16x32_bf16 v[104:107], v[184:187], a[68:71], v[104:107]
buffer_load_dwordx4 v13, s[64:67], s61 offen offset:1024 lds
v_mfma_f32_16x16x32_bf16 v[108:111], v[192:195], a[68:71], v[108:111]
ds_read_b64_tr_b16 v[160:161], v5 offset:16896
ds_read_b64_tr_b16 v[162:163], v5 offset:20992
v_mfma_f32_16x16x32_bf16 v[108:111], v[196:199], a[76:79], v[108:111]
buffer_load_dwordx4 v12, s[64:67], s62 offen offset:2048 lds
v_mfma_f32_16x16x32_bf16 v[92:95], v[196:199], a[72:75], v[92:95]
ds_read_b64_tr_b16 v[164:165], v5 offset:25088
ds_read_b64_tr_b16 v[166:167], v5 offset:29184
s_waitcnt lgkmcnt(8)
v_mfma_f32_16x16x32_bf16 v[92:95], v[192:195], a[64:67], v[92:95]
buffer_load_dwordx4 v13, s[64:67], s62 offen offset:3072 lds
v_mfma_f32_16x16x32_bf16 v[96:99], v[200:203], a[64:67], v[96:99]
ds_read_b64_tr_b16 v[168:169], v4 offset:17152
ds_read_b64_tr_b16 v[170:171], v4 offset:21248
v_mfma_f32_16x16x32_bf16 v[96:99], v[204:207], a[72:75], v[96:99]
buffer_load_dwordx4 a[112:115], v3, s[88:91], s101 offen sc1
v_mfma_f32_16x16x32_bf16 v[112:115], v[204:207], a[76:79], v[112:115]
ds_read_b64_tr_b16 v[172:173], v4 offset:25344
ds_read_b64_tr_b16 v[174:175], v4 offset:29440
v_mfma_f32_16x16x32_bf16 v[112:115], v[200:203], a[68:71], v[112:115]
buffer_load_dwordx4 a[116:119], v3, s[88:91], s101 offen offset:1024 sc1
v_mfma_f32_16x16x32_bf16 v[116:119], v[208:211], a[68:71], v[116:119]
ds_read_b64_tr_b16 v[176:177], v5 offset:17152
ds_read_b64_tr_b16 v[178:179], v5 offset:21248
s_add_u32 s101, s101, 0x2000
v_mfma_f32_16x16x32_bf16 v[116:119], v[212:215], a[76:79], v[116:119]
buffer_load_dwordx4 a[120:123], v3, s[88:91], s101 offen sc1
s_waitcnt vmcnt(7) lgkmcnt(6)
v_mfma_f32_16x16x32_bf16 v[100:103], v[212:215], a[72:75], v[100:103]
ds_read_b64_tr_b16 v[180:181], v5 offset:25344
ds_read_b64_tr_b16 v[182:183], v5 offset:29440
s_barrier
v_mfma_f32_16x16x32_bf16 v[100:103], v[208:211], a[64:67], v[100:103]
buffer_load_dwordx4 a[124:127], v3, s[88:91], s101 offen offset:1024 sc1
v_mfma_f32_16x16x32_bf16 v[120:123], v[152:155], a[80:83], v[120:123]
ds_read_b64_tr_b16 v[184:185], v6 offset:512
v_sub_f32 v10, 1.0, v8
v_mfma_f32_16x16x32_bf16 v[120:123], v[156:159], a[88:91], v[120:123]
ds_read_b64_tr_b16 v[186:187], v6 offset:4608
v_sub_f32 v11, 1.0, v9
v_mfma_f32_16x16x32_bf16 v[136:139], v[156:159], a[92:95], v[136:139]
ds_read_b64_tr_b16 v[188:189], v6 offset:8704
v_mul_f32 v56, v10, v56
v_mfma_f32_16x16x32_bf16 v[136:139], v[152:155], a[84:87], v[136:139]
ds_read_b64_tr_b16 v[190:191], v6 offset:12800
v_mul_f32 v57, v10, v57
v_mfma_f32_16x16x32_bf16 v[140:143], v[160:163], a[84:87], v[140:143]
ds_read_b64_tr_b16 v[192:193], v7 offset:512
v_mul_f32 v58, v10, v58
v_mfma_f32_16x16x32_bf16 v[140:143], v[164:167], a[92:95], v[140:143]
ds_read_b64_tr_b16 v[194:195], v7 offset:4608
v_mul_f32 v59, v10, v59
v_mfma_f32_16x16x32_bf16 v[124:127], v[164:167], a[88:91], v[124:127]
ds_read_b64_tr_b16 v[196:197], v7 offset:8704
s_waitcnt lgkmcnt(7)
v_mfma_f32_16x16x32_bf16 v[124:127], v[160:163], a[80:83], v[124:127]
ds_read_b64_tr_b16 v[198:199], v7 offset:12800
v_mul_f32 v60, v10, v60
v_mfma_f32_16x16x32_bf16 v[128:131], v[168:171], a[80:83], v[128:131]
ds_read_b64_tr_b16 v[200:201], v6 offset:768
v_mul_f32 v61, v10, v61
v_mfma_f32_16x16x32_bf16 v[128:131], v[172:175], a[88:91], v[128:131]
ds_read_b64_tr_b16 v[202:203], v6 offset:4864
v_mul_f32 v62, v10, v62
v_mfma_f32_16x16x32_bf16 v[144:147], v[172:175], a[92:95], v[144:147]
ds_read_b64_tr_b16 v[204:205], v6 offset:8960
v_mul_f32 v63, v10, v63
v_mfma_f32_16x16x32_bf16 v[144:147], v[168:171], a[84:87], v[144:147]
ds_read_b64_tr_b16 v[206:207], v6 offset:13056
v_mul_f32 v64, v10, v64
v_mfma_f32_16x16x32_bf16 v[148:151], v[176:179], a[84:87], v[148:151]
ds_read_b64_tr_b16 v[208:209], v7 offset:768
v_mul_f32 v65, v10, v65
v_mfma_f32_16x16x32_bf16 v[148:151], v[180:183], a[92:95], v[148:151]
ds_read_b64_tr_b16 v[210:211], v7 offset:4864
s_waitcnt vmcnt(0) lgkmcnt(6)
v_mfma_f32_16x16x32_bf16 v[132:135], v[180:183], a[88:91], v[132:135]
ds_read_b64_tr_b16 v[212:213], v7 offset:8960
s_barrier
v_mfma_f32_16x16x32_bf16 v[132:135], v[176:179], a[80:83], v[132:135]
ds_read_b64_tr_b16 v[214:215], v7 offset:13056
v_mul_f32 v66, v10, v66
v_mul_f32 v67, v10, v67
v_mfma_f32_16x16x32_bf16 v[120:123], v[184:187], a[96:99], v[120:123]
ds_read_b64_tr_b16 v[152:153], v6 offset:16896
v_mul_f32 v68, v10, v68
v_mfma_f32_16x16x32_bf16 v[120:123], v[188:191], a[104:107], v[120:123]
ds_read_b64_tr_b16 v[154:155], v6 offset:20992
v_mul_f32 v69, v10, v69
v_mfma_f32_16x16x32_bf16 v[136:139], v[188:191], a[108:111], v[136:139]
ds_read_b64_tr_b16 v[156:157], v6 offset:25088
v_mul_f32 v70, v10, v70
v_mfma_f32_16x16x32_bf16 v[136:139], v[184:187], a[100:103], v[136:139]
ds_read_b64_tr_b16 v[158:159], v6 offset:29184
v_mul_f32 v71, v10, v71
v_mfma_f32_16x16x32_bf16 v[140:143], v[192:195], a[100:103], v[140:143]
ds_read_b64_tr_b16 v[160:161], v7 offset:16896
v_mul_f32 v72, v11, v72
v_mfma_f32_16x16x32_bf16 v[140:143], v[196:199], a[108:111], v[140:143]
ds_read_b64_tr_b16 v[162:163], v7 offset:20992
v_mul_f32 v73, v11, v73
v_mfma_f32_16x16x32_bf16 v[124:127], v[196:199], a[104:107], v[124:127]
ds_read_b64_tr_b16 v[164:165], v7 offset:25088
s_waitcnt lgkmcnt(7)
v_mfma_f32_16x16x32_bf16 v[124:127], v[192:195], a[96:99], v[124:127]
ds_read_b64_tr_b16 v[166:167], v7 offset:29184
v_mul_f32 v74, v11, v74
v_mfma_f32_16x16x32_bf16 v[128:131], v[200:203], a[96:99], v[128:131]
ds_read_b64_tr_b16 v[168:169], v6 offset:17152
v_mul_f32 v75, v11, v75
v_mfma_f32_16x16x32_bf16 v[128:131], v[204:207], a[104:107], v[128:131]
ds_read_b64_tr_b16 v[170:171], v6 offset:21248
v_mul_f32 v76, v11, v76
v_mfma_f32_16x16x32_bf16 v[144:147], v[204:207], a[108:111], v[144:147]
ds_read_b64_tr_b16 v[172:173], v6 offset:25344
v_mul_f32 v77, v11, v77
v_mfma_f32_16x16x32_bf16 v[144:147], v[200:203], a[100:103], v[144:147]
ds_read_b64_tr_b16 v[174:175], v6 offset:29440
v_mul_f32 v78, v11, v78
v_mfma_f32_16x16x32_bf16 v[148:151], v[208:211], a[100:103], v[148:151]
ds_read_b64_tr_b16 v[176:177], v7 offset:17152
v_mul_f32 v79, v11, v79
v_mfma_f32_16x16x32_bf16 v[148:151], v[212:215], a[108:111], v[148:151]
ds_read_b64_tr_b16 v[178:179], v7 offset:21248
s_waitcnt lgkmcnt(6)
v_mfma_f32_16x16x32_bf16 v[132:135], v[212:215], a[104:107], v[132:135]
ds_read_b64_tr_b16 v[180:181], v7 offset:25344
v_mul_f32 v80, v11, v80
v_mfma_f32_16x16x32_bf16 v[132:135], v[208:211], a[96:99], v[132:135]
ds_read_b64_tr_b16 v[182:183], v7 offset:29440
v_mul_f32 v81, v11, v81
v_mfma_f32_16x16x32_bf16 v[120:123], v[152:155], a[112:115], v[120:123]
ds_read_b64_tr_b16 v[184:185], v4 offset:16384
v_mul_f32 v82, v11, v82
v_mfma_f32_16x16x32_bf16 v[120:123], v[156:159], a[120:123], v[120:123]
ds_read_b64_tr_b16 v[186:187], v4 offset:20480
v_mul_f32 v83, v11, v83
v_mfma_f32_16x16x32_bf16 v[136:139], v[156:159], a[124:127], v[136:139]
ds_read_b64_tr_b16 v[188:189], v4 offset:24576
v_mul_f32 v84, v11, v84
v_mfma_f32_16x16x32_bf16 v[136:139], v[152:155], a[116:119], v[136:139]
ds_read_b64_tr_b16 v[190:191], v4 offset:28672
v_mul_f32 v85, v11, v85
v_mfma_f32_16x16x32_bf16 v[140:143], v[160:163], a[116:119], v[140:143]
ds_read_b64_tr_b16 v[192:193], v5 offset:16384
v_mul_f32 v86, v11, v86
v_mfma_f32_16x16x32_bf16 v[140:143], v[164:167], a[124:127], v[140:143]
ds_read_b64_tr_b16 v[194:195], v5 offset:20480
v_mul_f32 v87, v11, v87
v_mfma_f32_16x16x32_bf16 v[124:127], v[164:167], a[120:123], v[124:127]
ds_read_b64_tr_b16 v[196:197], v5 offset:24576
s_waitcnt lgkmcnt(7)
v_mfma_f32_16x16x32_bf16 v[124:127], v[160:163], a[112:115], v[124:127]
ds_read_b64_tr_b16 v[198:199], v5 offset:28672
v_mul_f32 v24, v10, v24
v_mfma_f32_16x16x32_bf16 v[128:131], v[168:171], a[112:115], v[128:131]
ds_read_b64_tr_b16 v[200:201], v4 offset:16640
v_mul_f32 v25, v10, v25
v_mfma_f32_16x16x32_bf16 v[128:131], v[172:175], a[120:123], v[128:131]
ds_read_b64_tr_b16 v[202:203], v4 offset:20736
v_mul_f32 v26, v10, v26
v_mfma_f32_16x16x32_bf16 v[144:147], v[172:175], a[124:127], v[144:147]
ds_read_b64_tr_b16 v[204:205], v4 offset:24832
v_mul_f32 v27, v10, v27
v_mfma_f32_16x16x32_bf16 v[144:147], v[168:171], a[116:119], v[144:147]
ds_read_b64_tr_b16 v[206:207], v4 offset:28928
v_mul_f32 v28, v10, v28
v_mfma_f32_16x16x32_bf16 v[148:151], v[176:179], a[116:119], v[148:151]
ds_read_b64_tr_b16 v[208:209], v5 offset:16640
v_mul_f32 v29, v10, v29
v_mfma_f32_16x16x32_bf16 v[148:151], v[180:183], a[124:127], v[148:151]
ds_read_b64_tr_b16 v[210:211], v5 offset:20736
s_waitcnt lgkmcnt(6)
v_mfma_f32_16x16x32_bf16 v[132:135], v[180:183], a[120:123], v[132:135]
ds_read_b64_tr_b16 v[212:213], v5 offset:24832
v_mul_f32 v30, v10, v30
v_mfma_f32_16x16x32_bf16 v[132:135], v[176:179], a[112:115], v[132:135]
ds_read_b64_tr_b16 v[214:215], v5 offset:28928
v_mul_f32 v31, v10, v31
v_mfma_f32_16x16x32_bf16 v[88:91], v[184:187], a[80:83], v[88:91]
ds_read_b64_tr_b16 v[152:153], v6 offset:0
v_mfma_f32_16x16x32_bf16 v[88:91], v[188:191], a[88:91], v[88:91]
ds_read_b64_tr_b16 v[154:155], v6 offset:4096
v_mfma_f32_16x16x32_bf16 v[104:107], v[188:191], a[92:95], v[104:107]
ds_read_b64_tr_b16 v[156:157], v6 offset:8192
v_mfma_f32_16x16x32_bf16 v[104:107], v[184:187], a[84:87], v[104:107]
ds_read_b64_tr_b16 v[158:159], v6 offset:12288
v_fmac_f32 v56, v8, v120
v_fmac_f32 v57, v8, v121
v_fmac_f32 v58, v8, v122
v_fmac_f32 v59, v8, v123
v_mfma_f32_16x16x32_bf16 v[108:111], v[192:195], a[84:87], v[108:111]
ds_read_b64_tr_b16 v[160:161], v7 offset:0
v_fmac_f32 v60, v8, v124
v_fmac_f32 v61, v8, v125
v_fmac_f32 v62, v8, v126
v_fmac_f32 v63, v8, v127
v_mfma_f32_16x16x32_bf16 v[108:111], v[196:199], a[92:95], v[108:111]
ds_read_b64_tr_b16 v[162:163], v7 offset:4096
v_cvt_pk_bf16_f32 v56, v56, v57
v_cvt_pk_bf16_f32 v57, v58, v59
v_cvt_pk_bf16_f32 v58, v60, v61
v_cvt_pk_bf16_f32 v59, v62, v63
v_mfma_f32_16x16x32_bf16 v[92:95], v[196:199], a[88:91], v[92:95]
ds_read_b64_tr_b16 v[164:165], v7 offset:8192
s_waitcnt lgkmcnt(7)
buffer_store_dwordx4 v[56:59], v3, s[88:91], s30 offen offset:0 sc1
v_fmac_f32 v64, v8, v128
v_fmac_f32 v65, v8, v129
v_fmac_f32 v66, v8, v130
v_mfma_f32_16x16x32_bf16 v[92:95], v[192:195], a[80:83], v[92:95]
ds_read_b64_tr_b16 v[166:167], v7 offset:12288
v_fmac_f32 v67, v8, v131
v_fmac_f32 v68, v8, v132
v_fmac_f32 v69, v8, v133
v_fmac_f32 v70, v8, v134
v_mfma_f32_16x16x32_bf16 v[96:99], v[200:203], a[80:83], v[96:99]
ds_read_b64_tr_b16 v[168:169], v6 offset:256
v_fmac_f32 v71, v8, v135
v_cvt_pk_bf16_f32 v64, v64, v65
v_cvt_pk_bf16_f32 v65, v66, v67
v_cvt_pk_bf16_f32 v66, v68, v69
v_mfma_f32_16x16x32_bf16 v[96:99], v[204:207], a[88:91], v[96:99]
ds_read_b64_tr_b16 v[170:171], v6 offset:4352
v_cvt_pk_bf16_f32 v67, v70, v71
buffer_store_dwordx4 v[64:67], v3, s[88:91], s30 offen offset:1024 sc1
v_fmac_f32 v72, v9, v136
v_fmac_f32 v73, v9, v137
v_mfma_f32_16x16x32_bf16 v[112:115], v[204:207], a[92:95], v[112:115]
ds_read_b64_tr_b16 v[172:173], v6 offset:8448
v_fmac_f32 v74, v9, v138
v_fmac_f32 v75, v9, v139
v_fmac_f32 v76, v9, v140
v_fmac_f32 v77, v9, v141
v_mfma_f32_16x16x32_bf16 v[112:115], v[200:203], a[84:87], v[112:115]
ds_read_b64_tr_b16 v[174:175], v6 offset:12544
v_fmac_f32 v78, v9, v142
v_fmac_f32 v79, v9, v143
v_cvt_pk_bf16_f32 v72, v72, v73
v_cvt_pk_bf16_f32 v73, v74, v75
v_mfma_f32_16x16x32_bf16 v[116:119], v[208:211], a[84:87], v[116:119]
ds_read_b64_tr_b16 v[176:177], v7 offset:256
v_cvt_pk_bf16_f32 v74, v76, v77
v_cvt_pk_bf16_f32 v75, v78, v79
buffer_store_dwordx4 v[72:75], v3, s[88:91], s30 offen offset:2048 sc1
v_fmac_f32 v80, v9, v144
v_mfma_f32_16x16x32_bf16 v[116:119], v[212:215], a[92:95], v[116:119]
ds_read_b64_tr_b16 v[178:179], v7 offset:4352
s_waitcnt lgkmcnt(6)
v_fmac_f32 v81, v9, v145
v_fmac_f32 v82, v9, v146
v_fmac_f32 v83, v9, v147
v_fmac_f32 v84, v9, v148
v_mfma_f32_16x16x32_bf16 v[100:103], v[212:215], a[88:91], v[100:103]
ds_read_b64_tr_b16 v[180:181], v7 offset:8448
v_fmac_f32 v85, v9, v149
v_fmac_f32 v86, v9, v150
v_fmac_f32 v87, v9, v151
v_cvt_pk_bf16_f32 v80, v80, v81
v_mfma_f32_16x16x32_bf16 v[100:103], v[208:211], a[80:83], v[100:103]
ds_read_b64_tr_b16 v[182:183], v7 offset:12544
v_cvt_pk_bf16_f32 v81, v82, v83
v_cvt_pk_bf16_f32 v82, v84, v85
v_cvt_pk_bf16_f32 v83, v86, v87
buffer_store_dwordx4 v[80:83], v3, s[88:91], s30 offen offset:3072 sc1
v_mfma_f32_16x16x32_bf16 v[88:91], v[152:155], a[96:99], v[88:91]
ds_read_b64_tr_b16 v[184:185], v6 offset:16384
v_mul_f32 v32, v10, v32
v_mfma_f32_16x16x32_bf16 v[88:91], v[156:159], a[104:107], v[88:91]
ds_read_b64_tr_b16 v[186:187], v6 offset:20480
v_mul_f32 v33, v10, v33
v_mfma_f32_16x16x32_bf16 v[104:107], v[156:159], a[108:111], v[104:107]
ds_read_b64_tr_b16 v[188:189], v6 offset:24576
v_mul_f32 v34, v10, v34
v_mfma_f32_16x16x32_bf16 v[104:107], v[152:155], a[100:103], v[104:107]
ds_read_b64_tr_b16 v[190:191], v6 offset:28672
v_mul_f32 v35, v10, v35
v_mfma_f32_16x16x32_bf16 v[108:111], v[160:163], a[100:103], v[108:111]
ds_read_b64_tr_b16 v[192:193], v7 offset:16384
v_mul_f32 v36, v10, v36
v_mfma_f32_16x16x32_bf16 v[108:111], v[164:167], a[108:111], v[108:111]
ds_read_b64_tr_b16 v[194:195], v7 offset:20480
v_mul_f32 v37, v10, v37
v_mfma_f32_16x16x32_bf16 v[92:95], v[164:167], a[104:107], v[92:95]
ds_read_b64_tr_b16 v[196:197], v7 offset:24576
s_waitcnt lgkmcnt(7)
v_mfma_f32_16x16x32_bf16 v[92:95], v[160:163], a[96:99], v[92:95]
ds_read_b64_tr_b16 v[198:199], v7 offset:28672
v_mul_f32 v38, v10, v38
v_mfma_f32_16x16x32_bf16 v[96:99], v[168:171], a[96:99], v[96:99]
ds_read_b64_tr_b16 v[200:201], v6 offset:16640
v_mul_f32 v39, v10, v39
v_mfma_f32_16x16x32_bf16 v[96:99], v[172:175], a[104:107], v[96:99]
ds_read_b64_tr_b16 v[202:203], v6 offset:20736
v_mul_f32 v40, v11, v40
v_mfma_f32_16x16x32_bf16 v[112:115], v[172:175], a[108:111], v[112:115]
ds_read_b64_tr_b16 v[204:205], v6 offset:24832
v_mul_f32 v41, v11, v41
v_mfma_f32_16x16x32_bf16 v[112:115], v[168:171], a[100:103], v[112:115]
ds_read_b64_tr_b16 v[206:207], v6 offset:28928
v_mul_f32 v42, v11, v42
v_mfma_f32_16x16x32_bf16 v[116:119], v[176:179], a[100:103], v[116:119]
ds_read_b64_tr_b16 v[208:209], v7 offset:16640
v_mul_f32 v43, v11, v43
v_mfma_f32_16x16x32_bf16 v[116:119], v[180:183], a[108:111], v[116:119]
ds_read_b64_tr_b16 v[210:211], v7 offset:20736
s_waitcnt lgkmcnt(6)
v_mfma_f32_16x16x32_bf16 v[100:103], v[180:183], a[104:107], v[100:103]
ds_read_b64_tr_b16 v[212:213], v7 offset:24832
v_mul_f32 v44, v11, v44
v_mfma_f32_16x16x32_bf16 v[100:103], v[176:179], a[96:99], v[100:103]
ds_read_b64_tr_b16 v[214:215], v7 offset:28928
v_mul_f32 v45, v11, v45
v_mfma_f32_16x16x32_bf16 v[88:91], v[184:187], a[112:115], v[88:91]
v_mul_f32 v46, v11, v46
v_mul_f32 v47, v11, v47
v_mfma_f32_16x16x32_bf16 v[88:91], v[188:191], a[120:123], v[88:91]
v_mul_f32 v48, v11, v48
v_mul_f32 v49, v11, v49
v_mfma_f32_16x16x32_bf16 v[104:107], v[188:191], a[124:127], v[104:107]
v_mul_f32 v50, v11, v50
v_mul_f32 v51, v11, v51
v_mfma_f32_16x16x32_bf16 v[104:107], v[184:187], a[116:119], v[104:107]
v_mul_f32 v52, v11, v52
v_mul_f32 v53, v11, v53
v_mfma_f32_16x16x32_bf16 v[108:111], v[192:195], a[116:119], v[108:111]
v_mul_f32 v54, v11, v54
v_mul_f32 v55, v11, v55
v_mfma_f32_16x16x32_bf16 v[108:111], v[196:199], a[124:127], v[108:111]
v_mfma_f32_16x16x32_bf16 v[92:95], v[196:199], a[120:123], v[92:95]
s_waitcnt lgkmcnt(0)
v_mfma_f32_16x16x32_bf16 v[92:95], v[192:195], a[112:115], v[92:95]
v_mfma_f32_16x16x32_bf16 v[96:99], v[200:203], a[112:115], v[96:99]
v_mfma_f32_16x16x32_bf16 v[96:99], v[204:207], a[120:123], v[96:99]
v_mfma_f32_16x16x32_bf16 v[112:115], v[204:207], a[124:127], v[112:115]
v_mfma_f32_16x16x32_bf16 v[112:115], v[200:203], a[116:119], v[112:115]
v_mfma_f32_16x16x32_bf16 v[116:119], v[208:211], a[116:119], v[116:119]
v_mfma_f32_16x16x32_bf16 v[116:119], v[212:215], a[124:127], v[116:119]
v_mfma_f32_16x16x32_bf16 v[100:103], v[212:215], a[120:123], v[100:103]
v_mfma_f32_16x16x32_bf16 v[100:103], v[208:211], a[112:115], v[100:103]
buffer_load_dwordx4 v[152:155], v3, s[88:91], s28 offen offset:0 sc1
buffer_load_dwordx4 v[156:159], v3, s[88:91], s28 offen offset:1024 sc1
buffer_load_dwordx4 v[160:163], v3, s[88:91], s28 offen offset:2048 sc1
buffer_load_dwordx4 v[164:167], v3, s[88:91], s28 offen offset:3072 sc1
v_fmac_f32 v24, v8, v88
v_fmac_f32 v25, v8, v89
v_fmac_f32 v26, v8, v90
v_fmac_f32 v27, v8, v91
v_fmac_f32 v28, v8, v92
v_fmac_f32 v29, v8, v93
v_fmac_f32 v30, v8, v94
v_fmac_f32 v31, v8, v95
v_fmac_f32 v32, v8, v96
v_fmac_f32 v33, v8, v97
v_fmac_f32 v34, v8, v98
v_fmac_f32 v35, v8, v99
v_fmac_f32 v36, v8, v100
v_fmac_f32 v37, v8, v101
v_fmac_f32 v38, v8, v102
v_fmac_f32 v39, v8, v103
v_fmac_f32 v40, v9, v104
v_fmac_f32 v41, v9, v105
v_fmac_f32 v42, v9, v106
v_fmac_f32 v43, v9, v107
v_fmac_f32 v44, v9, v108
v_fmac_f32 v45, v9, v109
v_fmac_f32 v46, v9, v110
v_fmac_f32 v47, v9, v111
v_fmac_f32 v48, v9, v112
v_fmac_f32 v49, v9, v113
v_fmac_f32 v50, v9, v114
v_fmac_f32 v51, v9, v115
v_fmac_f32 v52, v9, v116
v_fmac_f32 v53, v9, v117
v_fmac_f32 v54, v9, v118
v_fmac_f32 v55, v9, v119
s_mov_b32 s92, 200000
L_spin_x:
s_waitcnt vmcnt(0)
v_max3_u32 v168, v152, v153, 0
v_max3_u32 v168, v154, v155, v168
v_max3_u32 v168, v156, v157, v168
v_max3_u32 v168, v158, v159, v168
v_max3_u32 v168, v160, v161, v168
v_max3_u32 v168, v162, v163, v168
v_max3_u32 v168, v164, v165, v168
v_max3_u32 v168, v166, v167, v168
v_cmp_eq_u32 vcc, -1, v168
s_sub_u32 s92, s92, 1
s_cbranch_scc1 L_spun_x
s_nop 3
s_cbranch_vccz L_spun_x
s_sleep 2
buffer_load_dwordx4 v[152:155], v3, s[88:91], s28 offen offset:0 sc1
buffer_load_dwordx4 v[156:159], v3, s[88:91], s28 offen offset:1024 sc1
buffer_load_dwordx4 v[160:163], v3, s[88:91], s28 offen offset:2048 sc1
buffer_load_dwordx4 v[164:167], v3, s[88:91], s28 offen offset:3072 sc1
s_branch L_spin_x
L_spun_x:
v_lshlrev_b32 v168, 16, v152
v_and_b32 v169, 0xffff0000, v152
v_pk_add_f32 v[24:25], v[24:25], v[168:169]
v_lshlrev_b32 v168, 16, v153
v_and_b32 v169, 0xffff0000, v153
v_pk_add_f32 v[26:27], v[26:27], v[168:169]
v_lshlrev_b32 v168, 16, v154
v_and_b32 v169, 0xffff0000, v154
v_pk_add_f32 v[28:29], v[28:29], v[168:169]
v_lshlrev_b32 v168, 16, v155
v_and_b32 v169, 0xffff0000, v155
v_pk_add_f32 v[30:31], v[30:31], v[168:169]
v_cvt_pk_bf16_f32 v24, v24, v25
v_cvt_pk_bf16_f32 v25, v26, v27
v_cvt_pk_bf16_f32 v26, v28, v29
v_cvt_pk_bf16_f32 v27, v30, v31
s_nop 1
v_permlane16_swap_b32 v24, v26
v_permlane16_swap_b32 v25, v27
buffer_store_dwordx4 v[24:27], v17, s[80:83], s29 offen offset:0
v_lshlrev_b32 v168, 16, v156
v_and_b32 v169, 0xffff0000, v156
v_pk_add_f32 v[32:33], v[32:33], v[168:169]
v_lshlrev_b32 v168, 16, v157
v_and_b32 v169, 0xffff0000, v157
v_pk_add_f32 v[34:35], v[34:35], v[168:169]
v_lshlrev_b32 v168, 16, v158
v_and_b32 v169, 0xffff0000, v158
v_pk_add_f32 v[36:37], v[36:37], v[168:169]
v_lshlrev_b32 v168, 16, v159
v_and_b32 v169, 0xffff0000, v159
v_pk_add_f32 v[38:39], v[38:39], v[168:169]
v_cvt_pk_bf16_f32 v32, v32, v33
v_cvt_pk_bf16_f32 v33, v34, v35
v_cvt_pk_bf16_f32 v34, v36, v37
v_cvt_pk_bf16_f32 v35, v38, v39
s_nop 1
v_permlane16_swap_b32 v32, v34
v_permlane16_swap_b32 v33, v35
buffer_store_dwordx4 v[32:35], v17, s[80:83], s29 offen offset:64
v_lshlrev_b32 v168, 16, v160
v_and_b32 v169, 0xffff0000, v160
v_pk_add_f32 v[40:41], v[40:41], v[168:169]
v_lshlrev_b32 v168, 16, v161
v_and_b32 v169, 0xffff0000, v161
v_pk_add_f32 v[42:43], v[42:43], v[168:169]
v_lshlrev_b32 v168, 16, v162
v_and_b32 v169, 0xffff0000, v162
v_pk_add_f32 v[44:45], v[44:45], v[168:169]
v_lshlrev_b32 v168, 16, v163
v_and_b32 v169, 0xffff0000, v163
v_pk_add_f32 v[46:47], v[46:47], v[168:169]
v_cvt_pk_bf16_f32 v40, v40, v41
v_cvt_pk_bf16_f32 v41, v42, v43
v_cvt_pk_bf16_f32 v42, v44, v45
v_cvt_pk_bf16_f32 v43, v46, v47
s_nop 1
v_permlane16_swap_b32 v40, v42
v_permlane16_swap_b32 v41, v43
buffer_store_dwordx4 v[40:43], v17, s[80:83], s31 offen offset:0
v_lshlrev_b32 v168, 16, v164
v_and_b32 v169, 0xffff0000, v164
v_pk_add_f32 v[48:49], v[48:49], v[168:169]
v_lshlrev_b32 v168, 16, v165
v_and_b32 v169, 0xffff0000, v165
v_pk_add_f32 v[50:51], v[50:51], v[168:169]
v_lshlrev_b32 v168, 16, v166
v_and_b32 v169, 0xffff0000, v166
v_pk_add_f32 v[52:53], v[52:53], v[168:169]
v_lshlrev_b32 v168, 16, v167
v_and_b32 v169, 0xffff0000, v167
v_pk_add_f32 v[54:55], v[54:55], v[168:169]
v_cvt_pk_bf16_f32 v48, v48, v49
v_cvt_pk_bf16_f32 v49, v50, v51
v_cvt_pk_bf16_f32 v50, v52, v53
v_cvt_pk_bf16_f32 v51, v54, v55
s_nop 1
v_permlane16_swap_b32 v48, v50
v_permlane16_swap_b32 v49, v51
buffer_store_dwordx4 v[48:51], v17, s[80:83], s31 offen offset:64
L_end:
s_endpgm
L_att_fallback:
s_waitcnt vmcnt(0)
s_mov_b32 s33, 1
s_mul_i32 s32, s5, 0x10c400
s_lshl_b32 s19, s4, 13
s_add_u32 s32, s32, s19
s_cmp_eq_u32 s4, 0
s_cselect_b32 s94, 0x200000, 0
s_add_u32 s32, s32, s94
s_sub_u32 s94, 0x8000, s94
s_add_u32 s7, s32, 0x1000
s_add_u32 s27, s19, 131072
v_and_b32 v5, 15, v0
v_lshrrev_b32 v6, 4, v0
v_lshlrev_b32 v6, 2, v6
v_sub_u32 v5, v5, v6
v_mov_b32 v9, 0xf149f2ca
s_lshr_b32 s8, s20, 11
v_add_u32 v96, s8, v5
v_mov_b32 v80, v9
s_lshr_b32 s8, s21, 11
v_add_u32 v97, s8, v5
v_mov_b32 v84, v9
s_lshr_b32 s8, s22, 11
v_add_u32 v98, s8, v5
v_mov_b32 v88, v9
s_lshr_b32 s8, s23, 11
v_add_u32 v99, s8, v5
v_mov_b32 v92, v9
s_sub_u32 s15, 16, s6
s_lshl_b32 s15, s15, 1
L_fb_loop:
s_waitcnt lgkmcnt(0)
s_barrier
s_add_u32 m0, s19, 0x0
s_nop 0
buffer_load_dwordx4 v3, s[48:51], s32 offen offset:0 sc1 lds
buffer_load_dwordx4 v3, s[48:51], s32 offen offset:1024 sc1 lds
buffer_load_dwordx4 v3, s[48:51], s32 offen offset:2048 sc1 lds
buffer_load_dwordx4 v3, s[48:51], s32 offen offset:3072 sc1 lds
s_add_u32 m0, s19, 0x1000
s_nop 0
buffer_load_dwordx4 v3, s[48:51], s7 offen offset:0 sc1 lds
buffer_load_dwordx4 v3, s[48:51], s7 offen offset:1024 sc1 lds
buffer_load_dwordx4 v3, s[48:51], s7 offen offset:2048 sc1 lds
buffer_load_dwordx4 v3, s[48:51], s7 offen offset:3072 sc1 lds
s_add_u32 s32, s32, s94
s_add_u32 s7, s7, s94
s_mov_b32 s94, 0x8000
s_waitcnt vmcnt(0)
s_barrier
ds_read_b128 a[0:3], v3 offset:8192
ds_read_b128 a[4:7], v3 offset:9216
ds_read_b128 a[8:11], v3 offset:10240
ds_read_b128 a[12:15], v3 offset:11264
ds_read_b128 a[16:19], v3 offset:12288
ds_read_b128 a[20:23], v3 offset:13312
ds_read_b128 a[24:27], v3 offset:14336
ds_read_b128 a[28:31], v3 offset:15360
s_waitcnt lgkmcnt(0)
v_mfma_f32_16x16x32_bf16 v[16:19], a[0:3], a[160:163], 0
v_mfma_f32_16x16x32_bf16 v[16:19], a[4:7], a[164:167], v[16:19]
v_mfma_f32_16x16x32_bf16 v[16:19], a[8:11], a[168:171], v[16:19]
v_mfma_f32_16x16x32_bf16 v[16:19], a[12:15], a[172:175], v[16:19]
v_mfma_f32_16x16x32_bf16 v[20:23], a[0:3], a[176:179], 0
v_mfma_f32_16x16x32_bf16 v[20:23], a[4:7], a[180:183], v[20:23]
v_mfma_f32_16x16x32_bf16 v[20:23], a[8:11], a[184:187], v[20:23]
v_mfma_f32_16x16x32_bf16 v[20:23], a[12:15], a[188:191], v[20:23]
v_mfma_f32_16x16x32_bf16 v[24:27], a[0:3], a[192:195], 0
v_mfma_f32_16x16x32_bf16 v[24:27], a[4:7], a[196:199], v[24:27]
v_mfma_f32_16x16x32_bf16 v[24:27], a[8:11], a[200:203], v[24:27]
v_mfma_f32_16x16x32_bf16 v[24:27], a[12:15], a[204:207], v[24:27]
v_mfma_f32_16x16x32_bf16 v[28:31], a[0:3], a[208:211], 0
v_mfma_f32_16x16x32_bf16 v[28:31], a[4:7], a[212:215], v[28:31]
v_mfma_f32_16x16x32_bf16 v[28:31], a[8:11], a[216:219], v[28:31]
v_mfma_f32_16x16x32_bf16 v[28:31], a[12:15], a[220:223], v[28:31]
v_mfma_f32_16x16x32_bf16 v[32:35], a[16:19], a[160:163], 0
v_mfma_f32_16x16x32_bf16 v[32:35], a[20:23], a[164:167], v[32:35]
v_mfma_f32_16x16x32_bf16 v[32:35], a[24:27], a[168:171], v[32:35]
v_mfma_f32_16x16x32_bf16 v[32:35], a[28:31], a[172:175], v[32:35]
v_mfma_f32_16x16x32_bf16 v[36:39], a[16:19], a[176:179], 0
v_mfma_f32_16x16x32_bf16 v[36:39], a[20:23], a[180:183], v[36:39]
v_mfma_f32_16x16x32_bf16 v[36:39], a[24:27], a[184:187], v[36:39]
v_mfma_f32_16x16x32_bf16 v[36:39], a[28:31], a[188:191], v[36:39]
v_mfma_f32_16x16x32_bf16 v[40:43], a[16:19], a[192:195], 0
v_mfma_f32_16x16x32_bf16 v[40:43], a[20:23], a[196:199], v[40:43]
v_mfma_f32_16x16x32_bf16 v[40:43], a[24:27], a[200:203], v[40:43]
v_mfma_f32_16x16x32_bf16 v[40:43], a[28:31], a[204:207], v[40:43]
v_mfma_f32_16x16x32_bf16 v[44:47], a[16:19], a[208:211], 0
v_mfma_f32_16x16x32_bf16 v[44:47], a[20:23], a[212:215], v[44:47]
v_mfma_f32_16x16x32_bf16 v[44:47], a[24:27], a[216:219], v[44:47]
v_mfma_f32_16x16x32_bf16 v[44:47], a[28:31], a[220:223], v[44:47]
s_nop 7
v_cmp_le_i32 s[36:37], 0, v96
v_cmp_le_i32 s[38:39], 1, v96
v_cmp_le_i32 s[40:41], 2, v96
v_cmp_le_i32 s[42:43], 3, v96
s_nop 1
v_cndmask_b32 v16, v9, v16, s[36:37]
v_cndmask_b32 v17, v9, v17, s[38:39]
v_cndmask_b32 v18, v9, v18, s[40:41]
v_cndmask_b32 v19, v9, v19, s[42:43]
v_max3_f32 v80, v80, v16, v17
v_max3_f32 v80, v80, v18, v19
v_cmp_le_i32 s[36:37], 0, v97
v_cmp_le_i32 s[38:39], 1, v97
v_cmp_le_i32 s[40:41], 2, v97
v_cmp_le_i32 s[42:43], 3, v97
s_nop 1
v_cndmask_b32 v20, v9, v20, s[36:37]
v_cndmask_b32 v21, v9, v21, s[38:39]
v_cndmask_b32 v22, v9, v22, s[40:41]
v_cndmask_b32 v23, v9, v23, s[42:43]
v_max3_f32 v84, v84, v20, v21
v_max3_f32 v84, v84, v22, v23
v_cmp_le_i32 s[36:37], 0, v98
v_cmp_le_i32 s[38:39], 1, v98
v_cmp_le_i32 s[40:41], 2, v98
v_cmp_le_i32 s[42:43], 3, v98
s_nop 1
v_cndmask_b32 v24, v9, v24, s[36:37]
v_cndmask_b32 v25, v9, v25, s[38:39]
v_cndmask_b32 v26, v9, v26, s[40:41]
v_cndmask_b32 v27, v9, v27, s[42:43]
v_max3_f32 v88, v88, v24, v25
v_max3_f32 v88, v88, v26, v27
v_cmp_le_i32 s[36:37], 0, v99
v_cmp_le_i32 s[38:39], 1, v99
v_cmp_le_i32 s[40:41], 2, v99
v_cmp_le_i32 s[42:43], 3, v99
s_nop 1
v_cndmask_b32 v28, v9, v28, s[36:37]
v_cndmask_b32 v29, v9, v29, s[38:39]
v_cndmask_b32 v30, v9, v30, s[40:41]
v_cndmask_b32 v31, v9, v31, s[42:43]
v_max3_f32 v92, v92, v28, v29
v_max3_f32 v92, v92, v30, v31
v_cmp_le_i32 s[36:37], 16, v96
v_cmp_le_i32 s[38:39], 17, v96
v_cmp_le_i32 s[40:41], 18, v96
v_cmp_le_i32 s[42:43], 19, v96
s_nop 1
v_cndmask_b32 v32, v9, v32, s[36:37]
v_cndmask_b32 v33, v9, v33, s[38:39]
v_cndmask_b32 v34, v9, v34, s[40:41]
v_cndmask_b32 v35, v9, v35, s[42:43]
v_max3_f32 v80, v80, v32, v33
v_max3_f32 v80, v80, v34, v35
v_cmp_le_i32 s[36:37], 16, v97
v_cmp_le_i32 s[38:39], 17, v97
v_cmp_le_i32 s[40:41], 18, v97
v_cmp_le_i32 s[42:43], 19, v97
s_nop 1
v_cndmask_b32 v36, v9, v36, s[36:37]
v_cndmask_b32 v37, v9, v37, s[38:39]
v_cndmask_b32 v38, v9, v38, s[40:41]
v_cndmask_b32 v39, v9, v39, s[42:43]
v_max3_f32 v84, v84, v36, v37
v_max3_f32 v84, v84, v38, v39
v_cmp_le_i32 s[36:37], 16, v98
v_cmp_le_i32 s[38:39], 17, v98
v_cmp_le_i32 s[40:41], 18, v98
v_cmp_le_i32 s[42:43], 19, v98
s_nop 1
v_cndmask_b32 v40, v9, v40, s[36:37]
v_cndmask_b32 v41, v9, v41, s[38:39]
v_cndmask_b32 v42, v9, v42, s[40:41]
v_cndmask_b32 v43, v9, v43, s[42:43]
v_max3_f32 v88, v88, v40, v41
v_max3_f32 v88, v88, v42, v43
v_cmp_le_i32 s[36:37], 16, v99
v_cmp_le_i32 s[38:39], 17, v99
v_cmp_le_i32 s[40:41], 18, v99
v_cmp_le_i32 s[42:43], 19, v99
s_nop 1
v_cndmask_b32 v44, v9, v44, s[36:37]
v_cndmask_b32 v45, v9, v45, s[38:39]
v_cndmask_b32 v46, v9, v46, s[40:41]
v_cndmask_b32 v47, v9, v47, s[42:43]
v_max3_f32 v92, v92, v44, v45
v_max3_f32 v92, v92, v46, v47
ds_read_b128 a[0:3], v3 offset:24576
ds_read_b128 a[4:7], v3 offset:25600
ds_read_b128 a[8:11], v3 offset:26624
ds_read_b128 a[12:15], v3 offset:27648
ds_read_b128 a[16:19], v3 offset:28672
ds_read_b128 a[20:23], v3 offset:29696
ds_read_b128 a[24:27], v3 offset:30720
ds_read_b128 a[28:31], v3 offset:31744
s_waitcnt lgkmcnt(0)
v_mfma_f32_16x16x32_bf16 v[16:19], a[0:3], a[160:163], 0
v_mfma_f32_16x16x32_bf16 v[16:19], a[4:7], a[164:167], v[16:19]
v_mfma_f32_16x16x32_bf16 v[16:19], a[8:11], a[168:171], v[16:19]
v_mfma_f32_16x16x32_bf16 v[16:19], a[12:15], a[172:175], v[16:19]
v_mfma_f32_16x16x32_bf16 v[20:23], a[0:3], a[176:179], 0
v_mfma_f32_16x16x32_bf16 v[20:23], a[4:7], a[180:183], v[20:23]
v_mfma_f32_16x16x32_bf16 v[20:23], a[8:11], a[184:187], v[20:23]
v_mfma_f32_16x16x32_bf16 v[20:23], a[12:15], a[188:191], v[20:23]
v_mfma_f32_16x16x32_bf16 v[24:27], a[0:3], a[192:195], 0
v_mfma_f32_16x16x32_bf16 v[24:27], a[4:7], a[196:199], v[24:27]
v_mfma_f32_16x16x32_bf16 v[24:27], a[8:11], a[200:203], v[24:27]
v_mfma_f32_16x16x32_bf16 v[24:27], a[12:15], a[204:207], v[24:27]
v_mfma_f32_16x16x32_bf16 v[28:31], a[0:3], a[208:211], 0
v_mfma_f32_16x16x32_bf16 v[28:31], a[4:7], a[212:215], v[28:31]
v_mfma_f32_16x16x32_bf16 v[28:31], a[8:11], a[216:219], v[28:31]
v_mfma_f32_16x16x32_bf16 v[28:31], a[12:15], a[220:223], v[28:31]
v_mfma_f32_16x16x32_bf16 v[32:35], a[16:19], a[160:163], 0
v_mfma_f32_16x16x32_bf16 v[32:35], a[20:23], a[164:167], v[32:35]
v_mfma_f32_16x16x32_bf16 v[32:35], a[24:27], a[168:171], v[32:35]
v_mfma_f32_16x16x32_bf16 v[32:35], a[28:31], a[172:175], v[32:35]
v_mfma_f32_16x16x32_bf16 v[36:39], a[16:19], a[176:179], 0
v_mfma_f32_16x16x32_bf16 v[36:39], a[20:23], a[180:183], v[36:39]
v_mfma_f32_16x16x32_bf16 v[36:39], a[24:27], a[184:187], v[36:39]
v_mfma_f32_16x16x32_bf16 v[36:39], a[28:31], a[188:191], v[36:39]
v_mfma_f32_16x16x32_bf16 v[40:43], a[16:19], a[192:195], 0
v_mfma_f32_16x16x32_bf16 v[40:43], a[20:23], a[196:199], v[40:43]
v_mfma_f32_16x16x32_bf16 v[40:43], a[24:27], a[200:203], v[40:43]
v_mfma_f32_16x16x32_bf16 v[40:43], a[28:31], a[204:207], v[40:43]
v_mfma_f32_16x16x32_bf16 v[44:47], a[16:19], a[208:211], 0
v_mfma_f32_16x16x32_bf16 v[44:47], a[20:23], a[212:215], v[44:47]
v_mfma_f32_16x16x32_bf16 v[44:47], a[24:27], a[216:219], v[44:47]
v_mfma_f32_16x16x32_bf16 v[44:47], a[28:31], a[220:223], v[44:47]
s_nop 7
v_cmp_le_i32 s[36:37], 32, v96
v_cmp_le_i32 s[38:39], 33, v96
v_cmp_le_i32 s[40:41], 34, v96
v_cmp_le_i32 s[42:43], 35, v96
s_nop 1
v_cndmask_b32 v16, v9, v16, s[36:37]
v_cndmask_b32 v17, v9, v17, s[38:39]
v_cndmask_b32 v18, v9, v18, s[40:41]
v_cndmask_b32 v19, v9, v19, s[42:43]
v_max3_f32 v80, v80, v16, v17
v_max3_f32 v80, v80, v18, v19
v_cmp_le_i32 s[36:37], 32, v97
v_cmp_le_i32 s[38:39], 33, v97
v_cmp_le_i32 s[40:41], 34, v97
v_cmp_le_i32 s[42:43], 35, v97
s_nop 1
v_cndmask_b32 v20, v9, v20, s[36:37]
v_cndmask_b32 v21, v9, v21, s[38:39]
v_cndmask_b32 v22, v9, v22, s[40:41]
v_cndmask_b32 v23, v9, v23, s[42:43]
v_max3_f32 v84, v84, v20, v21
v_max3_f32 v84, v84, v22, v23
v_cmp_le_i32 s[36:37], 32, v98
v_cmp_le_i32 s[38:39], 33, v98
v_cmp_le_i32 s[40:41], 34, v98
v_cmp_le_i32 s[42:43], 35, v98
s_nop 1
v_cndmask_b32 v24, v9, v24, s[36:37]
v_cndmask_b32 v25, v9, v25, s[38:39]
v_cndmask_b32 v26, v9, v26, s[40:41]
v_cndmask_b32 v27, v9, v27, s[42:43]
v_max3_f32 v88, v88, v24, v25
v_max3_f32 v88, v88, v26, v27
v_cmp_le_i32 s[36:37], 32, v99
v_cmp_le_i32 s[38:39], 33, v99
v_cmp_le_i32 s[40:41], 34, v99
v_cmp_le_i32 s[42:43], 35, v99
s_nop 1
v_cndmask_b32 v28, v9, v28, s[36:37]
v_cndmask_b32 v29, v9, v29, s[38:39]
v_cndmask_b32 v30, v9, v30, s[40:41]
v_cndmask_b32 v31, v9, v31, s[42:43]
v_max3_f32 v92, v92, v28, v29
v_max3_f32 v92, v92, v30, v31
v_cmp_le_i32 s[36:37], 48, v96
v_cmp_le_i32 s[38:39], 49, v96
v_cmp_le_i32 s[40:41], 50, v96
v_cmp_le_i32 s[42:43], 51, v96
s_nop 1
v_cndmask_b32 v32, v9, v32, s[36:37]
v_cndmask_b32 v33, v9, v33, s[38:39]
v_cndmask_b32 v34, v9, v34, s[40:41]
v_cndmask_b32 v35, v9, v35, s[42:43]
v_max3_f32 v80, v80, v32, v33
v_max3_f32 v80, v80, v34, v35
v_cmp_le_i32 s[36:37], 48, v97
v_cmp_le_i32 s[38:39], 49, v97
v_cmp_le_i32 s[40:41], 50, v97
v_cmp_le_i32 s[42:43], 51, v97
s_nop 1
v_cndmask_b32 v36, v9, v36, s[36:37]
v_cndmask_b32 v37, v9, v37, s[38:39]
v_cndmask_b32 v38, v9, v38, s[40:41]
v_cndmask_b32 v39, v9, v39, s[42:43]
v_max3_f32 v84, v84, v36, v37
v_max3_f32 v84, v84, v38, v39
v_cmp_le_i32 s[36:37], 48, v98
v_cmp_le_i32 s[38:39], 49, v98
v_cmp_le_i32 s[40:41], 50, v98
v_cmp_le_i32 s[42:43], 51, v98
s_nop 1
v_cndmask_b32 v40, v9, v40, s[36:37]
v_cndmask_b32 v41, v9, v41, s[38:39]
v_cndmask_b32 v42, v9, v42, s[40:41]
v_cndmask_b32 v43, v9, v43, s[42:43]
v_max3_f32 v88, v88, v40, v41
v_max3_f32 v88, v88, v42, v43
v_cmp_le_i32 s[36:37], 48, v99
v_cmp_le_i32 s[38:39], 49, v99
v_cmp_le_i32 s[40:41], 50, v99
v_cmp_le_i32 s[42:43], 51, v99
s_nop 1
v_cndmask_b32 v44, v9, v44, s[36:37]
v_cndmask_b32 v45, v9, v45, s[38:39]
v_cndmask_b32 v46, v9, v46, s[40:41]
v_cndmask_b32 v47, v9, v47, s[42:43]
v_max3_f32 v92, v92, v44, v45
v_max3_f32 v92, v92, v46, v47
v_subrev_u32 v96, 64, v96
v_subrev_u32 v97, 64, v97
v_subrev_u32 v98, 64, v98
v_subrev_u32 v99, 64, v99
s_sub_u32 s15, s15, 1
s_cmp_lg_u32 s15, 0
s_cbranch_scc1 L_fb_loop
v_mov_b32 v16, v80
v_mov_b32 v20, v84
v_mov_b32 v24, v88
v_mov_b32 v28, v92
v_permlane16_swap_b32 v16, v80
v_permlane16_swap_b32 v20, v84
v_permlane16_swap_b32 v24, v88
v_permlane16_swap_b32 v28, v92
v_max_f32 v80, v80, v16
v_max_f32 v84, v84, v20
v_max_f32 v88, v88, v24
v_max_f32 v92, v92, v28
v_mov_b32 v16, v80
v_mov_b32 v20, v84
v_mov_b32 v24, v88
v_mov_b32 v28, v92
v_permlane32_swap_b32 v16, v80
v_permlane32_swap_b32 v20, v84
v_permlane32_swap_b32 v24, v88
v_permlane32_swap_b32 v28, v92
v_max_f32 v80, v80, v16
v_max_f32 v84, v84, v20
v_max_f32 v88, v88, v24
v_max_f32 v92, v92, v28
s_barrier
s_mul_i32 s32, s5, 0x10c400
s_lshl_b32 s19, s4, 13
s_add_u32 s32, s32, s19
s_cmp_eq_u32 s4, 0
s_cselect_b32 s94, 0x200000, 0
s_add_u32 s32, s32, s94
s_sub_u32 s94, 0x8000, s94
s_add_u32 s7, s32, 0x1000
s_add_u32 s27, s19, 131072
s_add_u32 m0, s19, 0x0
s_nop 0
buffer_load_dwordx4 v3, s[48:51], s32 offen offset:0 sc1 lds
buffer_load_dwordx4 v3, s[48:51], s32 offen offset:1024 sc1 lds
buffer_load_dwordx4 v3, s[48:51], s32 offen offset:2048 sc1 lds
buffer_load_dwordx4 v3, s[48:51], s32 offen offset:3072 sc1 lds
s_add_u32 m0, s19, 0x1000
s_nop 0
buffer_load_dwordx4 v3, s[48:51], s7 offen offset:0 sc1 lds
buffer_load_dwordx4 v3, s[48:51], s7 offen offset:1024 sc1 lds
buffer_load_dwordx4 v3, s[48:51], s7 offen offset:2048 sc1 lds
buffer_load_dwordx4 v3, s[48:51], s7 offen offset:3072 sc1 lds
s_add_u32 s32, s32, s94
s_add_u32 s7, s7, s94
s_add_u32 m0, s19, 0x18000
s_nop 0
buffer_load_dwordx4 v3, s[48:51], s32 offen offset:0 sc1 lds
buffer_load_dwordx4 v3, s[48:51], s32 offen offset:1024 sc1 lds
buffer_load_dwordx4 v3, s[48:51], s32 offen offset:2048 sc1 lds
buffer_load_dwordx4 v3, s[48:51], s32 offen offset:3072 sc1 lds
s_add_u32 m0, s19, 0x19000
s_nop 0
buffer_load_dwordx4 v3, s[48:51], s7 offen offset:0 sc1 lds
buffer_load_dwordx4 v3, s[48:51], s7 offen offset:1024 sc1 lds
buffer_load_dwordx4 v3, s[48:51], s7 offen offset:2048 sc1 lds
buffer_load_dwordx4 v3, s[48:51], s7 offen offset:3072 sc1 lds
s_add_u32 s32, s32, 0x8000
s_add_u32 s7, s7, 0x8000
s_add_u32 m0, s19, 0x8000
s_nop 0
buffer_load_dwordx4 v3, s[48:51], s32 offen offset:0 sc1 lds
buffer_load_dwordx4 v3, s[48:51], s32 offen offset:1024 sc1 lds
buffer_load_dwordx4 v3, s[48:51], s32 offen offset:2048 sc1 lds
buffer_load_dwordx4 v3, s[48:51], s32 offen offset:3072 sc1 lds
s_add_u32 m0, s19, 0x9000
s_nop 0
buffer_load_dwordx4 v3, s[48:51], s7 offen offset:0 sc1 lds
buffer_load_dwordx4 v3, s[48:51], s7 offen offset:1024 sc1 lds
buffer_load_dwordx4 v3, s[48:51], s7 offen offset:2048 sc1 lds
buffer_load_dwordx4 v3, s[48:51], s7 offen offset:3072 sc1 lds
s_add_u32 s32, s32, 0x8000
s_add_u32 s7, s7, 0x8000
s_bfe_u32 s99, s2, 0x20001
s_lshl_b32 s99, s99, 2
s_lshr_b32 s8, s2, 6
s_add_u32 s99, s99, s8
s_bfe_u32 s100, s2, 0x30003
s_and_b32 s14, s2, 1
s_sub_u32 s24, 15, s99
s_min_u32 s18, s24, s99
s_lshl_b32 s24, s18, 1
s_add_u32 s24, s24, s14
s_lshl_b32 s24, s24, 8
s_add_u32 s24, s24, 0x3704000
s_mov_b32 s12, 14336
s_and_b32 s16, s6, 1
s_lshl_b32 s16, s16, 15
s_add_u32 s16, s16, 98304
s_add_u32 s16, s16, s17
s_lshl_b32 s13, s4, 15
s_lshl_b32 s9, s100, 8
s_add_u32 s13, s13, s9
s_mul_i32 s9, s14, 0x100080
s_add_u32 s13, s13, s9
s_mul_i32 s25, s14, 0x300000
s_sub_u32 s25, s25, 917504
s_mul_i32 s101, s99, 0x142400
s_lshl_b32 s8, s4, 11
s_add_u32 s101, s101, s8
s_lshl_b32 s8, s14, 17
s_add_u32 s101, s101, s8
s_add_u32 s101, s101, 0x21fe000
s_mul_i32 s26, s14, 393216
s_add_u32 s26, s26, 139264
v_mov_b32 v15, s6
v_writelane_b32 v15, s18, 0
v_lshlrev_b32 v15, 2, v15
v_bfe_u32 v12, v0, 2, 2
v_lshlrev_b32 v12, 11, v12
v_lshrrev_b32 v13, 4, v0
v_lshl_add_u32 v12, v13, 6, v12
v_and_b32 v13, 3, v0
v_lshl_add_u32 v12, v13, 4, v12
v_xor_b32 v12, s13, v12
v_xor_b32 v13, 32, v12
v_add_u32 v13, 7168, v13
s_mov_b32 s11, 0xf149f2ca
s_mov_b32 s36, 0xfff0ffff
s_mov_b32 s37, 0xf000ff00
s_mov_b32 s38, 0xffe0fffe
s_mov_b32 s39, 0xe000fe00
s_mov_b32 s40, 0xffc0fffc
s_mov_b32 s41, 0xc000fc00
s_mov_b32 s42, 0xff80fff8
s_mov_b32 s43, 0x8000f800
s_bitcmp1_b32 s4, 0
s_cselect_b32 s8, 0x7f800000, s11
s_cselect_b32 s9, s11, 0x7f800000
v_mov_b32 v1, v3
v_add_u32 v2, 98304, v3
s_mov_b64 s[34:35], 0
v_accvgpr_write_b32 a224, 0
v_accvgpr_write_b32 a225, 0
v_accvgpr_write_b32 a226, 0
v_accvgpr_write_b32 a227, 0
v_accvgpr_write_b32 a228, 0
v_accvgpr_write_b32 a229, 0
v_accvgpr_write_b32 a230, 0
v_accvgpr_write_b32 a231, 0
v_sub_f32 v83, 0, v80
v_sub_f32 v82, 0, v80
v_sub_f32 v81, 0, v80
v_sub_f32 v80, 0, v80
v_min_f32 v103, s8, v80
v_cndmask_b32 v96, v103, v80, s[36:37]
v_cndmask_b32 v97, v103, v80, s[38:39]
v_cndmask_b32 v98, v103, v80, s[40:41]
v_cndmask_b32 v99, v103, v80, s[42:43]
v_cndmask_b32 v100, v9, v103, s[36:37]
v_cndmask_b32 v101, v9, v103, s[38:39]
v_cndmask_b32 v102, v9, v103, s[40:41]
v_cndmask_b32 v103, v9, v103, s[42:43]
v_sub_f32 v87, 0, v84
v_sub_f32 v86, 0, v84
v_sub_f32 v85, 0, v84
v_sub_f32 v84, 0, v84
v_min_f32 v111, s9, v84
v_cndmask_b32 v104, v111, v84, s[36:37]
v_cndmask_b32 v105, v111, v84, s[38:39]
v_cndmask_b32 v106, v111, v84, s[40:41]
v_cndmask_b32 v107, v111, v84, s[42:43]
v_cndmask_b32 v108, v9, v111, s[36:37]
v_cndmask_b32 v109, v9, v111, s[38:39]
v_cndmask_b32 v110, v9, v111, s[40:41]
v_cndmask_b32 v111, v9, v111, s[42:43]
v_sub_f32 v91, 0, v88
v_sub_f32 v90, 0, v88
v_sub_f32 v89, 0, v88
v_sub_f32 v88, 0, v88
v_min_f32 v119, s8, v88
v_cndmask_b32 v112, v119, v88, s[36:37]
v_cndmask_b32 v113, v119, v88, s[38:39]
v_cndmask_b32 v114, v119, v88, s[40:41]
v_cndmask_b32 v115, v119, v88, s[42:43]
v_cndmask_b32 v116, v9, v119, s[36:37]
v_cndmask_b32 v117, v9, v119, s[38:39]
v_cndmask_b32 v118, v9, v119, s[40:41]
v_cndmask_b32 v119, v9, v119, s[42:43]
v_sub_f32 v95, 0, v92
v_sub_f32 v94, 0, v92
v_sub_f32 v93, 0, v92
v_sub_f32 v92, 0, v92
v_min_f32 v127, s9, v92
v_cndmask_b32 v120, v127, v92, s[36:37]
v_cndmask_b32 v121, v127, v92, s[38:39]
v_cndmask_b32 v122, v127, v92, s[40:41]
v_cndmask_b32 v123, v127, v92, s[42:43]
v_cndmask_b32 v124, v9, v127, s[36:37]
v_cndmask_b32 v125, v9, v127, s[38:39]
v_cndmask_b32 v126, v9, v127, s[40:41]
v_cndmask_b32 v127, v9, v127, s[42:43]
v_and_b32 v9, 1, v0
v_mul_u32_u24 v9, 0xaaaa, v9
v_add_u32 v9, 0x4444, v9
v_mov_b32 v128, 0
v_mov_b32 v129, 0
v_mov_b32 v130, 0
v_mov_b32 v131, 0
v_mov_b32 v132, 0
v_mov_b32 v133, 0
v_mov_b32 v134, 0
v_mov_b32 v135, 0
v_mov_b32 v136, 0
v_mov_b32 v137, 0
v_mov_b32 v138, 0
v_mov_b32 v139, 0
v_mov_b32 v140, 0
v_mov_b32 v141, 0
v_mov_b32 v142, 0
v_mov_b32 v143, 0
v_mov_b32 v144, 0
v_mov_b32 v145, 0
v_mov_b32 v146, 0
v_mov_b32 v147, 0
v_mov_b32 v148, 0
v_mov_b32 v149, 0
v_mov_b32 v150, 0
v_mov_b32 v151, 0
v_mov_b32 v152, 0
v_mov_b32 v153, 0
v_mov_b32 v154, 0
v_mov_b32 v155, 0
v_mov_b32 v156, 0
v_mov_b32 v157, 0
v_mov_b32 v158, 0
v_mov_b32 v159, 0
v_mov_b32 v160, 0
v_mov_b32 v161, 0
v_mov_b32 v162, 0
v_mov_b32 v163, 0
v_mov_b32 v164, 0
v_mov_b32 v165, 0
v_mov_b32 v166, 0
v_mov_b32 v167, 0
v_mov_b32 v168, 0
v_mov_b32 v169, 0
v_mov_b32 v170, 0
v_mov_b32 v171, 0
v_mov_b32 v172, 0
v_mov_b32 v173, 0
v_mov_b32 v174, 0
v_mov_b32 v175, 0
v_mov_b32 v176, 0
v_mov_b32 v177, 0
v_mov_b32 v178, 0
v_mov_b32 v179, 0
v_mov_b32 v180, 0
v_mov_b32 v181, 0
v_mov_b32 v182, 0
v_mov_b32 v183, 0
v_mov_b32 v184, 0
v_mov_b32 v185, 0
v_mov_b32 v186, 0
v_mov_b32 v187, 0
v_mov_b32 v188, 0
v_mov_b32 v189, 0
v_mov_b32 v190, 0
v_mov_b32 v191, 0
v_mov_b32 v192, 0
v_mov_b32 v193, 0
v_mov_b32 v194, 0
v_mov_b32 v195, 0
v_mov_b32 v196, 0
v_mov_b32 v197, 0
v_mov_b32 v198, 0
v_mov_b32 v199, 0
v_mov_b32 v200, 0
v_mov_b32 v201, 0
v_mov_b32 v202, 0
v_mov_b32 v203, 0
v_mov_b32 v204, 0
v_mov_b32 v205, 0
v_mov_b32 v206, 0
v_mov_b32 v207, 0
v_mov_b32 v208, 0
v_mov_b32 v209, 0
v_mov_b32 v210, 0
v_mov_b32 v211, 0
v_mov_b32 v212, 0
v_mov_b32 v213, 0
v_mov_b32 v214, 0
v_mov_b32 v215, 0
v_mov_b32 v216, 0
v_mov_b32 v217, 0
v_mov_b32 v218, 0
v_mov_b32 v219, 0
v_mov_b32 v220, 0
v_mov_b32 v221, 0
v_mov_b32 v222, 0
v_mov_b32 v223, 0
v_mov_b32 v224, 0
v_mov_b32 v225, 0
v_mov_b32 v226, 0
v_mov_b32 v227, 0
v_mov_b32 v228, 0
v_mov_b32 v229, 0
v_mov_b32 v230, 0
v_mov_b32 v231, 0
v_mov_b32 v232, 0
v_mov_b32 v233, 0
v_mov_b32 v234, 0
v_mov_b32 v235, 0
v_mov_b32 v236, 0
v_mov_b32 v237, 0
v_mov_b32 v238, 0
v_mov_b32 v239, 0
v_mov_b32 v240, 0
v_mov_b32 v241, 0
v_mov_b32 v242, 0
v_mov_b32 v243, 0
v_mov_b32 v244, 0
v_mov_b32 v245, 0
v_mov_b32 v246, 0
v_mov_b32 v247, 0
v_mov_b32 v248, 0
v_mov_b32 v249, 0
v_mov_b32 v250, 0
v_mov_b32 v251, 0
v_mov_b32 v252, 0
v_mov_b32 v253, 0
v_mov_b32 v254, 0
v_mov_b32 v255, 0
s_waitcnt vmcnt(16)
s_barrier
ds_read_b128 a[0:3], v1 offset:8192
ds_read_b128 a[4:7], v1 offset:9216
ds_read_b128 a[8:11], v1 offset:10240
ds_read_b128 a[12:15], v1 offset:11264
ds_read_b128 a[16:19], v1 offset:12288
ds_read_b128 a[20:23], v1 offset:13312
ds_read_b128 a[24:27], v1 offset:14336
ds_read_b128 a[28:31], v1 offset:15360
s_waitcnt lgkmcnt(0)
s_branch L_att_start
.section .rodata,"a"
.p2align 6
.amdhsa_kernel gated_mix__compressed_kv_cla__sliding_local_dilated__prompt_kernel
  .amdhsa_next_free_vgpr 512
  .amdhsa_next_free_sgpr 102
  .amdhsa_accum_offset 256
  .amdhsa_group_segment_fixed_size 0
  .amdhsa_kernarg_size 104
  .amdhsa_user_sgpr_count 2
  .amdhsa_user_sgpr_kernarg_segment_ptr 1
  .amdhsa_system_sgpr_workgroup_id_x 1
.end_amdhsa_kernel
```

```asm
; @launch grid=(256,1,1) block=(256,1,1) lds=163840
.amdgcn_target "amdgcn-amd-amdhsa--gfx950"
.text
.globl gated_mix__compressed_kv_cla__sliding_local_dilated__prompt_kernel
.p2align 8
.type gated_mix__compressed_kv_cla__sliding_local_dilated__prompt_kernel,@function
gated_mix__compressed_kv_cla__sliding_local_dilated__prompt_kernel:
s_load_dwordx16 s[16:31], s[0:1], 0
s_load_dwordx8 s[32:39], s[0:1], 64
s_load_dwordx2 s[88:89], s[0:1], 96
s_cmp_ge_u32 s2, 256
s_cbranch_scc1 L_end
v_lshrrev_b32 v1, 6, v0
v_and_b32 v0, 63, v0
v_readfirstlane_b32 s4, v1
v_lshlrev_b32 v16, 4, v0
s_lshr_b32 s8, s2, 3
s_lshl_b32 s8, s8, 2
s_add_u32 s8, s8, s4
s_min_u32 s8, s8, 101
s_lshl_b32 s8, s8, 10
s_getpc_b64 s[92:93]
L_here:
s_add_u32 s8, s8, L_page0-L_here
s_add_u32 s92, s92, s8
s_addc_u32 s93, s93, 0
v_add_u32 v60, s92, v16
v_mov_b32 v61, s93
global_load_dword a120, v[60:61], off sc1
s_and_b32 s5, s2, 7
s_lshl_b32 s5, s5, 2
s_lshr_b32 s5, 0x75643120, s5
s_and_b32 s5, s5, 7
s_lshl_b32 s5, s5, 2
s_bfe_u32 s3, s2, 0x20003
s_add_u32 s5, s5, s3
s_lshr_b32 s6, s2, 5
s_mov_b32 s12, 0x4000
s_mov_b32 s13, 0x8000
s_mov_b32 s14, 0xc000
s_mov_b32 s46, 0x400000
s_mov_b32 s47, 0x20000
s_mov_b32 s50, 0x200000
s_mov_b32 s51, 0x20000
s_mov_b32 s54, 0x800000
s_mov_b32 s55, 0x20000
s_mov_b32 s58, 0x400000
s_mov_b32 s59, 0x20000
s_mov_b32 s62, 0x400000
s_mov_b32 s63, 0x20000
s_mov_b32 s66, 0x800000
s_mov_b32 s67, 0x20000
s_mov_b32 s70, 0x600000
s_mov_b32 s71, 0x20000
s_mov_b32 s74, 0x200000
s_mov_b32 s75, 0x20000
s_mov_b32 s78, 0x800
s_mov_b32 s79, 0x20000
s_mov_b32 s82, 0x400000
s_mov_b32 s83, 0x20000
s_mov_b32 s86, 0x100
s_mov_b32 s87, 0x20000
s_mov_b32 s90, 0x10000000
s_mov_b32 s91, 0x20000
v_bfe_u32 v17, v0, 2, 2
s_lshl_b32 s8, s4, 4
v_add_u32 v17, s8, v17
v_lshlrev_b32 v17, 13, v17
v_lshrrev_b32 v18, 4, v0
v_lshl_add_u32 v17, v18, 6, v17
v_and_b32 v18, 3, v0
v_lshl_add_u32 v17, v18, 4, v17
s_lshl_b32 s8, s5, 8
v_add_u32 v5, s8, v17
v_xor_b32 v6, 32, v5
v_add_u32 v6, 0x10000, v6
v_lshrrev_b32 v17, 4, v0
v_xor_b32 v17, v17, v0
v_and_b32 v17, 7, v17
v_lshlrev_b32 v17, 4, v17
v_lshrrev_b32 v18, 3, v0
v_lshl_add_u32 v2, v18, 10, v17
s_lshl_b32 s8, s6, 18
s_lshl_b32 s9, s4, 16
s_add_u32 s8, s8, s9
v_add_u32 v2, s8, v2
v_xor_b32 v3, 64, v2
v_add_u32 v3, 0x2000, v3
s_mov_b32 s41, 0
s_mov_b32 s43, 0
v_lshl_add_u32 v5, s41, 19, v5
v_lshl_add_u32 v6, s41, 19, v6
v_lshl_add_u32 v2, s41, 7, v2
v_lshl_add_u32 v3, s41, 7, v3
s_sub_u32 s10, 15, s6
s_cmp_lt_u32 s5, 16
s_cselect_b32 s10, s6, s10
s_lshl_b32 s10, s10, 4
s_and_b32 s11, s5, 15
s_add_u32 s10, s10, s11
s_lshl_b32 s10, s10, 3
s_lshl_b32 s11, s4, 1
s_add_u32 s10, s10, s11
s_lshl_b32 s100, s10, 11
s_lshl_b32 s101, s10, 2
s_add_u32 s101, s101, 0x3700000
s_lshl_b32 s8, s2, 2
s_add_u32 s8, s8, s4
s_lshl_b32 s8, s8, 11
v_lshrrev_b32 v19, 2, v0
v_lshl_add_u32 v19, v19, 7, s8
s_lshr_b32 s8, s2, 3
s_lshl_b32 s8, s8, 2
s_add_u32 s8, s8, s4
s_lshl_b32 s8, s8, 4
s_lshr_b32 s9, s5, 2
s_add_u32 s8, s8, s9
s_lshl_b32 s8, s8, 10
v_bfe_u32 v63, v0, 2, 3
v_lshl_add_u32 v63, v63, 7, s8
v_lshrrev_b32 v59, 5, v0
v_lshl_add_u32 v63, v59, 13, v63
v_mov_b32 v62, v19
s_waitcnt lgkmcnt(0)
s_mov_b64 s[48:49], s[18:19]
s_mov_b64 s[56:57], s[22:23]
s_mov_b64 s[60:61], s[24:25]
L_args:
s_mov_b64 s[0:1], s[92:93]
s_mov_b64 s[44:45], s[16:17]
s_mov_b64 s[76:77], s[34:35]
s_mov_b64 s[52:53], s[20:21]
s_mov_b64 s[64:65], s[26:27]
s_mov_b64 s[68:69], s[30:31]
s_mov_b64 s[72:73], s[32:33]
s_mov_b64 s[80:81], s[36:37]
s_mov_b64 s[84:85], s[38:39]
s_lshl_b32 s16, s4, 13
s_add_u32 s16, s16, 0x18000
s_lshl_b32 s17, s4, 12
s_lshl_b32 s18, s4, 10
s_mov_b32 s25, 0x800
s_mov_b32 s26, 0x1000
s_mov_b32 s3, 0
s_mov_b32 s9, 0x0
s_nop 0
buffer_load_dword a120, v63, s[56:59], s9 offen
s_mov_b32 s9, 0x0
s_nop 0
buffer_load_dword a120, v63, s[60:63], s9 offen
s_add_u32 m0, s17, 0x0
s_nop 0
buffer_load_dwordx4 v5, s[56:59], 0 offen lds
s_add_u32 m0, s17, 0x4000
s_nop 0
buffer_load_dwordx4 v5, s[60:63], 0 offen lds
s_add_u32 m0, s17, 0x400
s_nop 0
buffer_load_dwordx4 v5, s[56:59], s13 offen lds
s_add_u32 m0, s17, 0x4400
s_nop 0
buffer_load_dwordx4 v5, s[60:63], s13 offen lds
s_add_u32 m0, s17, 0x800
s_nop 0
buffer_load_dwordx4 v6, s[56:59], 0 offen lds
s_add_u32 m0, s17, 0x4800
s_nop 0
buffer_load_dwordx4 v6, s[60:63], 0 offen lds
s_add_u32 m0, s17, 0xc00
s_nop 0
buffer_load_dwordx4 v6, s[56:59], s13 offen lds
s_add_u32 m0, s17, 0x4c00
s_nop 0
buffer_load_dwordx4 v6, s[60:63], s13 offen lds
s_mov_b32 s42, 1
s_mov_b32 s41, 7
v_lshl_add_u32 v5, s42, 19, v5
v_lshl_add_u32 v6, s42, 19, v6
s_add_u32 m0, s16, 0x0
s_nop 0
buffer_load_dwordx4 v2, s[48:51], 0 offen lds
s_add_u32 m0, s16, 0x400
s_nop 0
buffer_load_dwordx4 v3, s[48:51], 0 offen lds
s_add_u32 m0, s16, 0x800
s_nop 0
buffer_load_dwordx4 v2, s[48:51], s12 offen lds
s_add_u32 m0, s16, 0xc00
s_nop 0
buffer_load_dwordx4 v3, s[48:51], s12 offen lds
s_add_u32 m0, s16, 0x1000
s_nop 0
buffer_load_dwordx4 v2, s[48:51], s13 offen lds
s_add_u32 m0, s16, 0x1400
s_nop 0
buffer_load_dwordx4 v3, s[48:51], s13 offen lds
s_add_u32 m0, s16, 0x1800
s_nop 0
buffer_load_dwordx4 v2, s[48:51], s14 offen lds
s_add_u32 m0, s16, 0x1c00
s_nop 0
buffer_load_dwordx4 v3, s[48:51], s14 offen lds
v_lshl_add_u32 v2, s42, 7, v2
v_lshl_add_u32 v3, s42, 7, v3
v_lshrrev_b32 v17, 4, v0
v_xor_b32 v17, v17, v0
v_and_b32 v17, 7, v17
v_lshlrev_b32 v17, 4, v17
v_lshrrev_b32 v18, 3, v0
v_lshl_add_u32 v22, v18, 11, v17
v_xor_b32 v23, 64, v22
v_add_u32 v23, 0x4000, v23
s_lshl_b32 s8, s6, 18
s_sub_u32 s9, 15, s6
s_lshl_b32 s9, s9, 18
s_lshl_b32 s10, s4, 15
s_sub_u32 s11, 0x38000, s10
s_add_u32 s20, s8, s10
s_add_u32 s21, s8, s11
s_add_u32 s22, s9, s10
s_add_u32 s23, s9, s11
s_lshl_b32 s10, s5, 15
s_add_u32 s10, s10, 0x3c00000
s_lshr_b32 s8, s8, 7
s_lshr_b32 s9, s9, 7
s_add_u32 s8, s8, s10
s_add_u32 s9, s9, s10
v_add_u32 v10, s8, v16
v_add_u32 v11, s9, v16
s_cmp_lt_u32 s4, 2
s_cselect_b32 s8, s8, s9
s_and_b32 s9, s4, 1
s_lshl_b32 s9, s9, 10
s_add_u32 s8, s8, s9
v_add_u32 v4, s8, v16
v_lshrrev_b32 v17, 2, v0
s_lshl_b32 s8, s4, 4
v_add_u32 v17, s8, v17
v_mul_u32_u24 v17, 0x1800, v17
v_and_b32 v18, 3, v0
v_lshlrev_b32 v18, 4, v18
v_and_b32 v19, 32, v0
v_xor_b32 v18, v18, v19
s_lshl_b32 s8, s5, 6
v_add3_u32 v7, v17, v18, s8
v_lshl_add_u32 v22, s43, 7, v22
v_lshl_add_u32 v23, s43, 7, v23
v_lshl_add_u32 v7, s43, 18, v7
v_lshl_add_u32 v7, s43, 17, v7
v_and_b32 v17, 15, v0
v_lshrrev_b32 v18, 1, v17
v_lshrrev_b32 v19, 4, v0
v_xor_b32 v18, v18, v19
v_lshlrev_b32 v18, 4, v18
v_lshl_add_u32 v8, v17, 7, v18
v_add_u32 v8, s16, v8
v_xor_b32 v9, 64, v8
v_lshrrev_b32 v17, 4, v0
v_lshlrev_b32 v18, 11, v17
v_and_b32 v17, 1, v17
v_lshl_add_u32 v18, v17, 5, v18
v_bfe_u32 v17, v0, 2, 2
v_lshl_add_u32 v18, v17, 6, v18
v_and_b32 v17, 3, v0
v_lshl_add_u32 v12, v17, 3, v18
v_xor_b32 v13, 32, v12
v_lshrrev_b32 v17, 4, v0
v_lshlrev_b32 v18, 9, v17
v_and_b32 v17, 1, v17
v_lshl_add_u32 v18, v17, 5, v18
v_bfe_u32 v17, v0, 2, 2
v_lshl_add_u32 v18, v17, 6, v18
v_and_b32 v17, 3, v0
v_lshl_add_u32 v14, v17, 3, v18
v_accvgpr_write_b32 a64, -1
v_accvgpr_write_b32 a65, -1
v_accvgpr_write_b32 a66, -1
v_accvgpr_write_b32 a67, -1
v_add_u32 v14, 81920, v14
v_xor_b32 v15, 32, v14
s_mul_i32 s32, s5, 0x10c400
s_lshl_b32 s19, s4, 13
s_add_u32 s32, s32, s19
s_cmp_eq_u32 s4, 0
s_cselect_b32 s94, 0x200000, 0
s_add_u32 s32, s32, s94
s_sub_u32 s94, 0x8000, s94
s_add_u32 s7, s32, 0x1000
s_add_u32 s27, s19, 131072
s_add_u32 m0, s16, 0x8000
s_nop 0
buffer_load_dwordx4 v2, s[48:51], 0 offen lds
s_add_u32 m0, s16, 0x8400
s_nop 0
buffer_load_dwordx4 v3, s[48:51], 0 offen lds
s_add_u32 m0, s16, 0x8800
s_nop 0
buffer_load_dwordx4 v2, s[48:51], s12 offen lds
s_add_u32 m0, s16, 0x8c00
s_nop 0
buffer_load_dwordx4 v3, s[48:51], s12 offen lds
s_add_u32 m0, s16, 0x9000
s_nop 0
buffer_load_dwordx4 v2, s[48:51], s13 offen lds
s_add_u32 m0, s16, 0x9400
s_nop 0
buffer_load_dwordx4 v3, s[48:51], s13 offen lds
s_add_u32 m0, s16, 0x9800
s_nop 0
buffer_load_dwordx4 v2, s[48:51], s14 offen lds
s_add_u32 m0, s16, 0x9c00
s_nop 0
buffer_load_dwordx4 v3, s[48:51], s14 offen lds
v_lshl_add_u32 v2, s42, 7, v2
v_lshl_add_u32 v3, s42, 7, v3
s_mov_b32 s9, 0x0
s_nop 0
buffer_load_dword a120, v62, s[48:51], s9 offen
L_hopA:
s_mov_b32 s95, 1
s_cmp_eq_u32 s4, 0
s_cbranch_scc1 L_padA0
s_cmp_eq_u32 s4, 1
s_cbranch_scc1 L_padA1
s_cmp_eq_u32 s4, 2
s_cbranch_scc1 L_padA2
s_branch L_padA3
L_hopA_ret:
s_mov_b32 s95, 0
v_mov_b32 v19, v62
v_mov_b32 v18, v63
s_cmp_lg_u32 s4, 0
s_cbranch_scc1 L_flag_clr
s_lshl_b32 s8, s6, 5
s_add_u32 s8, s8, s5
s_and_b32 s92, s8, 0xf0
s_mul_i32 s92, s92, 3
s_add_u32 s8, s8, s92
s_lshl_b32 s8, s8, 2
s_add_u32 s8, s8, 0x3704000
v_mov_b32 v17, 0
s_mov_b64 exec, 1
buffer_store_dword v17, off, s[88:91], s8 sc1
s_mov_b64 exec, -1
L_flag_clr:
s_waitcnt vmcnt(9)
s_barrier
s_branch L_main
.p2align 12
L_page0:
L_padA0:
s_branch L_padA4
L_main:
ds_read_b64_tr_b16 a[80:81], v12 offset:0
ds_read_b64_tr_b16 a[82:83], v12 offset:1024
ds_read_b64_tr_b16 a[84:85], v12 offset:8192
ds_read_b64_tr_b16 a[86:87], v12 offset:9216
ds_read_b128 a[0:3], v8 offset:0
ds_read_b128 a[16:19], v9 offset:0
ds_read_b128 a[4:7], v8 offset:2048
ds_read_b128 a[20:23], v9 offset:2048
ds_read_b128 a[8:11], v8 offset:4096
ds_read_b128 a[24:27], v9 offset:4096
ds_read_b128 a[12:15], v8 offset:6144
ds_read_b128 a[28:31], v9 offset:6144
ds_read_b64_tr_b16 a[88:89], v13 offset:0
ds_read_b64_tr_b16 a[90:91], v13 offset:1024
ds_read_b64_tr_b16 a[92:93], v13 offset:8192
ds_read_b64_tr_b16 a[94:95], v13 offset:9216
ds_read_b64_tr_b16 a[96:97], v12 offset:256
ds_read_b64_tr_b16 a[98:99], v12 offset:1280
ds_read_b64_tr_b16 a[100:101], v12 offset:8448
ds_read_b64_tr_b16 a[102:103], v12 offset:9472
s_waitcnt lgkmcnt(0)
L_S0:
v_mfma_f32_16x16x32_bf16 v[24:27], a[80:83], a[0:3], 0
ds_read_b64_tr_b16 a[104:105], v13 offset:256
s_add_u32 m0, s17, 0x8000
v_mfma_f32_16x16x32_bf16 v[24:27], a[84:87], a[16:19], v[24:27]
buffer_load_dwordx4 v5, s[56:59], 0 offen lds
v_mfma_f32_16x16x32_bf16 v[32:35], a[84:87], a[20:23], 0
ds_read_b64_tr_b16 a[106:107], v13 offset:1280
v_mfma_f32_16x16x32_bf16 v[32:35], a[80:83], a[4:7], v[32:35]
ds_read_b64_tr_b16 a[108:109], v13 offset:8448
v_mfma_f32_16x16x32_bf16 v[40:43], a[80:83], a[8:11], 0
ds_read_b64_tr_b16 a[110:111], v13 offset:9472
v_mfma_f32_16x16x32_bf16 v[40:43], a[84:87], a[24:27], v[40:43]
s_add_u32 m0, s17, 0xc000
v_mfma_f32_16x16x32_bf16 v[48:51], a[84:87], a[28:31], 0
buffer_load_dwordx4 v5, s[60:63], 0 offen lds
v_mfma_f32_16x16x32_bf16 v[48:51], a[80:83], a[12:15], v[48:51]
v_mfma_f32_16x16x32_bf16 v[52:55], a[88:91], a[12:15], 0
ds_read_b64_tr_b16 a[80:81], v12 offset:512
v_mfma_f32_16x16x32_bf16 v[52:55], a[92:95], a[28:31], v[52:55]
ds_read_b64_tr_b16 a[82:83], v12 offset:1536
v_mfma_f32_16x16x32_bf16 v[44:47], a[92:95], a[24:27], 0
ds_read_b64_tr_b16 a[84:85], v12 offset:8704
s_add_u32 m0, s17, 0x8400
v_mfma_f32_16x16x32_bf16 v[44:47], a[88:91], a[8:11], v[44:47]
buffer_load_dwordx4 v5, s[56:59], s13 offen lds
v_mfma_f32_16x16x32_bf16 v[36:39], a[88:91], a[4:7], 0
ds_read_b64_tr_b16 a[86:87], v12 offset:9728
v_mfma_f32_16x16x32_bf16 v[36:39], a[92:95], a[20:23], v[36:39]
v_mfma_f32_16x16x32_bf16 v[28:31], a[92:95], a[16:19], 0
v_mfma_f32_16x16x32_bf16 v[28:31], a[88:91], a[0:3], v[28:31]
s_add_u32 m0, s17, 0xc400
v_mfma_f32_16x16x32_bf16 v[56:59], a[96:99], a[0:3], 0
buffer_load_dwordx4 v5, s[60:63], s13 offen lds
v_mfma_f32_16x16x32_bf16 v[56:59], a[100:103], a[16:19], v[56:59]
ds_read_b64_tr_b16 a[88:89], v13 offset:512
v_mfma_f32_16x16x32_bf16 v[64:67], a[100:103], a[20:23], 0
ds_read_b64_tr_b16 a[90:91], v13 offset:1536
v_mfma_f32_16x16x32_bf16 v[64:67], a[96:99], a[4:7], v[64:67]
ds_read_b64_tr_b16 a[92:93], v13 offset:8704
v_mfma_f32_16x16x32_bf16 v[72:75], a[96:99], a[8:11], 0
ds_read_b64_tr_b16 a[94:95], v13 offset:9728
s_add_u32 m0, s17, 0x8800
v_mfma_f32_16x16x32_bf16 v[72:75], a[100:103], a[24:27], v[72:75]
buffer_load_dwordx4 v6, s[56:59], 0 offen lds
v_mfma_f32_16x16x32_bf16 v[80:83], a[100:103], a[28:31], 0
v_mfma_f32_16x16x32_bf16 v[80:83], a[96:99], a[12:15], v[80:83]
s_waitcnt lgkmcnt(10)
v_mfma_f32_16x16x32_bf16 v[84:87], a[104:107], a[12:15], 0
ds_read_b64_tr_b16 a[96:97], v12 offset:768
s_waitcnt lgkmcnt(9)
v_mfma_f32_16x16x32_bf16 v[84:87], a[108:111], a[28:31], v[84:87]
ds_read_b64_tr_b16 a[98:99], v12 offset:1792
s_add_u32 m0, s17, 0xc800
v_mfma_f32_16x16x32_bf16 v[76:79], a[108:111], a[24:27], 0
buffer_load_dwordx4 v6, s[60:63], 0 offen lds
v_mfma_f32_16x16x32_bf16 v[76:79], a[104:107], a[8:11], v[76:79]
ds_read_b64_tr_b16 a[100:101], v12 offset:8960
v_mfma_f32_16x16x32_bf16 v[68:71], a[104:107], a[4:7], 0
ds_read_b64_tr_b16 a[102:103], v12 offset:9984
v_mfma_f32_16x16x32_bf16 v[68:71], a[108:111], a[20:23], v[68:71]
v_mfma_f32_16x16x32_bf16 v[60:63], a[108:111], a[16:19], 0
s_add_u32 m0, s17, 0x8c00
s_waitcnt lgkmcnt(4)
v_mfma_f32_16x16x32_bf16 v[60:63], a[104:107], a[0:3], v[60:63]
buffer_load_dwordx4 v6, s[56:59], s13 offen lds
v_mfma_f32_16x16x32_bf16 v[88:91], a[80:83], a[0:3], 0
ds_read_b64_tr_b16 a[104:105], v13 offset:768
v_mfma_f32_16x16x32_bf16 v[88:91], a[84:87], a[16:19], v[88:91]
ds_read_b64_tr_b16 a[106:107], v13 offset:1792
v_mfma_f32_16x16x32_bf16 v[96:99], a[84:87], a[20:23], 0
ds_read_b64_tr_b16 a[108:109], v13 offset:8960
v_mfma_f32_16x16x32_bf16 v[96:99], a[80:83], a[4:7], v[96:99]
ds_read_b64_tr_b16 a[110:111], v13 offset:9984
s_add_u32 m0, s17, 0xcc00
v_mfma_f32_16x16x32_bf16 v[104:107], a[80:83], a[8:11], 0
buffer_load_dwordx4 v6, s[60:63], s13 offen lds
v_mfma_f32_16x16x32_bf16 v[104:107], a[84:87], a[24:27], v[104:107]
v_lshl_add_u32 v5, s42, 19, v5
v_lshl_add_u32 v6, s42, 19, v6
v_mfma_f32_16x16x32_bf16 v[112:115], a[84:87], a[28:31], 0
v_mfma_f32_16x16x32_bf16 v[112:115], a[80:83], a[12:15], v[112:115]
v_mfma_f32_16x16x32_bf16 v[116:119], a[88:91], a[12:15], 0
ds_read_b64_tr_b16 a[80:81], v12 offset:16384
s_add_u32 m0, s16, 0x0
v_mfma_f32_16x16x32_bf16 v[116:119], a[92:95], a[28:31], v[116:119]
buffer_load_dwordx4 v2, s[48:51], 0 offen lds
v_mfma_f32_16x16x32_bf16 v[108:111], a[92:95], a[24:27], 0
ds_read_b64_tr_b16 a[82:83], v12 offset:17408
v_mfma_f32_16x16x32_bf16 v[108:111], a[88:91], a[8:11], v[108:111]
ds_read_b64_tr_b16 a[84:85], v12 offset:24576
v_mfma_f32_16x16x32_bf16 v[100:103], a[88:91], a[4:7], 0
ds_read_b64_tr_b16 a[86:87], v12 offset:25600
v_mfma_f32_16x16x32_bf16 v[100:103], a[92:95], a[20:23], v[100:103]
s_add_u32 m0, s16, 0x400
v_mfma_f32_16x16x32_bf16 v[92:95], a[92:95], a[16:19], 0
buffer_load_dwordx4 v3, s[48:51], 0 offen lds
v_mfma_f32_16x16x32_bf16 v[92:95], a[88:91], a[0:3], v[92:95]
s_waitcnt lgkmcnt(4)
v_mfma_f32_16x16x32_bf16 v[120:123], a[96:99], a[0:3], 0
ds_read_b64_tr_b16 a[88:89], v13 offset:16384
s_waitcnt vmcnt(11)
v_mfma_f32_16x16x32_bf16 v[120:123], a[100:103], a[16:19], v[120:123]
ds_read_b64_tr_b16 a[90:91], v13 offset:17408
v_mfma_f32_16x16x32_bf16 v[128:131], a[100:103], a[20:23], 0
ds_read_b64_tr_b16 a[92:93], v13 offset:24576
s_add_u32 m0, s16, 0x800
v_mfma_f32_16x16x32_bf16 v[128:131], a[96:99], a[4:7], v[128:131]
buffer_load_dwordx4 v2, s[48:51], s12 offen lds
v_mfma_f32_16x16x32_bf16 v[136:139], a[96:99], a[8:11], 0
ds_read_b64_tr_b16 a[94:95], v13 offset:25600
v_mfma_f32_16x16x32_bf16 v[136:139], a[100:103], a[24:27], v[136:139]
ds_read_b128 a[32:35], v8 offset:32768
v_mfma_f32_16x16x32_bf16 v[144:147], a[100:103], a[28:31], 0
ds_read_b128 a[48:51], v9 offset:32768
v_mfma_f32_16x16x32_bf16 v[144:147], a[96:99], a[12:15], v[144:147]
ds_read_b128 a[36:39], v8 offset:34816
s_add_u32 m0, s16, 0xc00
v_mfma_f32_16x16x32_bf16 v[148:151], a[104:107], a[12:15], 0
buffer_load_dwordx4 v3, s[48:51], s12 offen lds
v_mfma_f32_16x16x32_bf16 v[148:151], a[108:111], a[28:31], v[148:151]
ds_read_b64_tr_b16 a[96:97], v12 offset:16640
v_mfma_f32_16x16x32_bf16 v[140:143], a[108:111], a[24:27], 0
ds_read_b64_tr_b16 a[98:99], v12 offset:17664
v_mfma_f32_16x16x32_bf16 v[140:143], a[104:107], a[8:11], v[140:143]
ds_read_b64_tr_b16 a[100:101], v12 offset:24832
v_mfma_f32_16x16x32_bf16 v[132:135], a[104:107], a[4:7], 0
ds_read_b64_tr_b16 a[102:103], v12 offset:25856
s_add_u32 m0, s16, 0x1000
v_mfma_f32_16x16x32_bf16 v[132:135], a[108:111], a[20:23], v[132:135]
buffer_load_dwordx4 v2, s[48:51], s13 offen lds
v_mfma_f32_16x16x32_bf16 v[124:127], a[108:111], a[16:19], 0
ds_read_b128 a[52:55], v9 offset:34816
v_mfma_f32_16x16x32_bf16 v[124:127], a[104:107], a[0:3], v[124:127]
ds_read_b128 a[40:43], v8 offset:36864
s_waitcnt lgkmcnt(9)
v_mfma_f32_16x16x32_bf16 v[152:155], a[0:3], a[80:83], 0
ds_read_b64_tr_b16 a[104:105], v13 offset:16640
v_mfma_f32_16x16x32_bf16 v[152:155], a[16:19], a[84:87], v[152:155]
ds_read_b64_tr_b16 a[106:107], v13 offset:17664
s_add_u32 m0, s16, 0x1400
v_mfma_f32_16x16x32_bf16 v[156:159], a[20:23], a[84:87], 0
buffer_load_dwordx4 v3, s[48:51], s13 offen lds
v_mfma_f32_16x16x32_bf16 v[156:159], a[4:7], a[80:83], v[156:159]
ds_read_b64_tr_b16 a[108:109], v13 offset:24832
v_mfma_f32_16x16x32_bf16 v[160:163], a[8:11], a[80:83], 0
ds_read_b64_tr_b16 a[110:111], v13 offset:25856
v_mfma_f32_16x16x32_bf16 v[160:163], a[24:27], a[84:87], v[160:163]
ds_read_b128 a[56:59], v9 offset:36864
v_mfma_f32_16x16x32_bf16 v[164:167], a[28:31], a[84:87], 0
ds_read_b128 a[44:47], v8 offset:38912
s_add_u32 m0, s16, 0x1800
v_mfma_f32_16x16x32_bf16 v[164:167], a[12:15], a[80:83], v[164:167]
buffer_load_dwordx4 v2, s[48:51], s14 offen lds
v_mfma_f32_16x16x32_bf16 v[180:183], a[12:15], a[88:91], 0
ds_read_b64_tr_b16 a[80:81], v12 offset:16896
v_mfma_f32_16x16x32_bf16 v[180:183], a[28:31], a[92:95], v[180:183]
ds_read_b64_tr_b16 a[82:83], v12 offset:17920
v_mfma_f32_16x16x32_bf16 v[176:179], a[24:27], a[92:95], 0
ds_read_b64_tr_b16 a[84:85], v12 offset:25088
v_mfma_f32_16x16x32_bf16 v[176:179], a[8:11], a[88:91], v[176:179]
ds_read_b64_tr_b16 a[86:87], v12 offset:26112
s_add_u32 m0, s16, 0x1c00
v_mfma_f32_16x16x32_bf16 v[172:175], a[4:7], a[88:91], 0
buffer_load_dwordx4 v3, s[48:51], s14 offen lds
v_mfma_f32_16x16x32_bf16 v[172:175], a[20:23], a[92:95], v[172:175]
ds_read_b128 a[60:63], v9 offset:38912
v_lshl_add_u32 v2, s42, 7, v2
v_mfma_f32_16x16x32_bf16 v[168:171], a[16:19], a[92:95], 0
v_lshl_add_u32 v3, s42, 7, v3
v_mfma_f32_16x16x32_bf16 v[168:171], a[0:3], a[88:91], v[168:171]
s_waitcnt lgkmcnt(7)
v_mfma_f32_16x16x32_bf16 v[184:187], a[0:3], a[96:99], 0
ds_read_b64_tr_b16 a[88:89], v13 offset:16896
s_add_u32 m0, s17, 0x10000
v_mfma_f32_16x16x32_bf16 v[184:187], a[16:19], a[100:103], v[184:187]
buffer_load_dwordx4 v5, s[56:59], 0 offen lds
v_mfma_f32_16x16x32_bf16 v[188:191], a[20:23], a[100:103], 0
ds_read_b64_tr_b16 a[90:91], v13 offset:17920
v_mfma_f32_16x16x32_bf16 v[188:191], a[4:7], a[96:99], v[188:191]
ds_read_b64_tr_b16 a[92:93], v13 offset:25088
v_mfma_f32_16x16x32_bf16 v[192:195], a[8:11], a[96:99], 0
ds_read_b64_tr_b16 a[94:95], v13 offset:26112
v_mfma_f32_16x16x32_bf16 v[192:195], a[24:27], a[100:103], v[192:195]
s_add_u32 m0, s17, 0x14000
v_mfma_f32_16x16x32_bf16 v[196:199], a[28:31], a[100:103], 0
buffer_load_dwordx4 v5, s[60:63], 0 offen lds
v_mfma_f32_16x16x32_bf16 v[196:199], a[12:15], a[96:99], v[196:199]
v_mfma_f32_16x16x32_bf16 v[212:215], a[12:15], a[104:107], 0
ds_read_b64_tr_b16 a[96:97], v12 offset:17152
v_mfma_f32_16x16x32_bf16 v[212:215], a[28:31], a[108:111], v[212:215]
ds_read_b64_tr_b16 a[98:99], v12 offset:18176
v_mfma_f32_16x16x32_bf16 v[208:211], a[24:27], a[108:111], 0
ds_read_b64_tr_b16 a[100:101], v12 offset:25344
s_add_u32 m0, s17, 0x10400
v_mfma_f32_16x16x32_bf16 v[208:211], a[8:11], a[104:107], v[208:211]
buffer_load_dwordx4 v5, s[56:59], s13 offen lds
v_mfma_f32_16x16x32_bf16 v[204:207], a[4:7], a[104:107], 0
ds_read_b64_tr_b16 a[102:103], v12 offset:26368
v_mfma_f32_16x16x32_bf16 v[204:207], a[20:23], a[108:111], v[204:207]
v_mfma_f32_16x16x32_bf16 v[200:203], a[16:19], a[108:111], 0
v_mfma_f32_16x16x32_bf16 v[200:203], a[0:3], a[104:107], v[200:203]
s_add_u32 m0, s17, 0x14400
s_waitcnt lgkmcnt(4)
v_mfma_f32_16x16x32_bf16 v[216:219], a[0:3], a[80:83], 0
buffer_load_dwordx4 v5, s[60:63], s13 offen lds
v_mfma_f32_16x16x32_bf16 v[216:219], a[16:19], a[84:87], v[216:219]
ds_read_b64_tr_b16 a[104:105], v13 offset:17152
v_mfma_f32_16x16x32_bf16 v[220:223], a[20:23], a[84:87], 0
ds_read_b64_tr_b16 a[106:107], v13 offset:18176
v_mfma_f32_16x16x32_bf16 v[220:223], a[4:7], a[80:83], v[220:223]
ds_read_b64_tr_b16 a[108:109], v13 offset:25344
v_mfma_f32_16x16x32_bf16 v[224:227], a[8:11], a[80:83], 0
ds_read_b64_tr_b16 a[110:111], v13 offset:26368
s_add_u32 m0, s17, 0x10800
v_mfma_f32_16x16x32_bf16 v[224:227], a[24:27], a[84:87], v[224:227]
buffer_load_dwordx4 v6, s[56:59], 0 offen lds
v_mfma_f32_16x16x32_bf16 v[228:231], a[28:31], a[84:87], 0
v_add_u32 v12, 0x8000, v12
v_add_u32 v13, 0x8000, v13
v_mfma_f32_16x16x32_bf16 v[228:231], a[12:15], a[80:83], v[228:231]
v_mfma_f32_16x16x32_bf16 v[244:247], a[12:15], a[88:91], 0
s_waitcnt vmcnt(13) lgkmcnt(0)
v_mfma_f32_16x16x32_bf16 v[244:247], a[28:31], a[92:95], v[244:247]
s_barrier
s_add_u32 m0, s17, 0x14800
v_mfma_f32_16x16x32_bf16 v[240:243], a[24:27], a[92:95], 0
buffer_load_dwordx4 v6, s[60:63], 0 offen lds
v_mfma_f32_16x16x32_bf16 v[240:243], a[8:11], a[88:91], v[240:243]
ds_read_b64_tr_b16 a[80:81], v12 offset:0
v_mfma_f32_16x16x32_bf16 v[236:239], a[4:7], a[88:91], 0
ds_read_b64_tr_b16 a[82:83], v12 offset:1024
v_mfma_f32_16x16x32_bf16 v[236:239], a[20:23], a[92:95], v[236:239]
ds_read_b64_tr_b16 a[84:85], v12 offset:8192
s_waitcnt lgkmcnt(3)
v_mfma_f32_16x16x32_bf16 v[232:235], a[16:19], a[92:95], 0
ds_read_b64_tr_b16 a[86:87], v12 offset:9216
s_add_u32 m0, s17, 0x10c00
v_mfma_f32_16x16x32_bf16 v[232:235], a[0:3], a[88:91], v[232:235]
buffer_load_dwordx4 v6, s[56:59], s13 offen lds
v_mfma_f32_16x16x32_bf16 v[248:251], a[0:3], a[96:99], 0
ds_read_b64_tr_b16 a[88:89], v13 offset:0
v_mfma_f32_16x16x32_bf16 v[248:251], a[16:19], a[100:103], v[248:251]
ds_read_b64_tr_b16 a[90:91], v13 offset:1024
v_mfma_f32_16x16x32_bf16 v[252:255], a[20:23], a[100:103], 0
ds_read_b64_tr_b16 a[92:93], v13 offset:8192
v_mfma_f32_16x16x32_bf16 v[252:255], a[4:7], a[96:99], v[252:255]
ds_read_b64_tr_b16 a[94:95], v13 offset:9216
s_add_u32 m0, s17, 0x14c00
v_mfma_f32_16x16x32_bf16 a[232:235], a[8:11], a[96:99], 0
buffer_load_dwordx4 v6, s[60:63], s13 offen lds
v_mfma_f32_16x16x32_bf16 a[232:235], a[24:27], a[100:103], a[232:235]
v_lshl_add_u32 v5, s42, 19, v5
v_lshl_add_u32 v6, s42, 19, v6
v_mfma_f32_16x16x32_bf16 a[236:239], a[28:31], a[100:103], 0
v_mfma_f32_16x16x32_bf16 a[236:239], a[12:15], a[96:99], a[236:239]
s_waitcnt lgkmcnt(15)
v_mfma_f32_16x16x32_bf16 a[252:255], a[12:15], a[104:107], 0
ds_read_b64_tr_b16 a[96:97], v12 offset:256
s_add_u32 m0, s16, 0x8000
v_mfma_f32_16x16x32_bf16 a[252:255], a[28:31], a[108:111], a[252:255]
buffer_load_dwordx4 v2, s[48:51], 0 offen lds
v_mfma_f32_16x16x32_bf16 a[248:251], a[24:27], a[108:111], 0
ds_read_b64_tr_b16 a[98:99], v12 offset:1280
v_mfma_f32_16x16x32_bf16 a[248:251], a[8:11], a[104:107], a[248:251]
ds_read_b64_tr_b16 a[100:101], v12 offset:8448
v_mfma_f32_16x16x32_bf16 a[244:247], a[4:7], a[104:107], 0
ds_read_b64_tr_b16 a[102:103], v12 offset:9472
v_mfma_f32_16x16x32_bf16 a[244:247], a[20:23], a[108:111], a[244:247]
s_add_u32 m0, s16, 0x8400
v_mfma_f32_16x16x32_bf16 a[240:243], a[16:19], a[108:111], 0
buffer_load_dwordx4 v3, s[48:51], 0 offen lds
v_mfma_f32_16x16x32_bf16 a[240:243], a[0:3], a[104:107], a[240:243]
s_waitcnt lgkmcnt(4)
L_S1:
v_mfma_f32_16x16x32_bf16 v[24:27], a[80:83], a[32:35], v[24:27]
ds_read_b64_tr_b16 a[104:105], v13 offset:256
v_mfma_f32_16x16x32_bf16 v[24:27], a[84:87], a[48:51], v[24:27]
ds_read_b64_tr_b16 a[106:107], v13 offset:1280
v_mfma_f32_16x16x32_bf16 v[32:35], a[84:87], a[52:55], v[32:35]
ds_read_b64_tr_b16 a[108:109], v13 offset:8448
s_add_u32 m0, s16, 0x8800
v_mfma_f32_16x16x32_bf16 v[32:35], a[80:83], a[36:39], v[32:35]
buffer_load_dwordx4 v2, s[48:51], s12 offen lds
v_mfma_f32_16x16x32_bf16 v[40:43], a[80:83], a[40:43], v[40:43]
ds_read_b64_tr_b16 a[110:111], v13 offset:9472
v_mfma_f32_16x16x32_bf16 v[40:43], a[84:87], a[56:59], v[40:43]
v_mfma_f32_16x16x32_bf16 v[48:51], a[84:87], a[60:63], v[48:51]
v_mfma_f32_16x16x32_bf16 v[48:51], a[80:83], a[44:47], v[48:51]
s_add_u32 m0, s16, 0x8c00
v_mfma_f32_16x16x32_bf16 v[52:55], a[88:91], a[44:47], v[52:55]
buffer_load_dwordx4 v3, s[48:51], s12 offen lds
v_mfma_f32_16x16x32_bf16 v[52:55], a[92:95], a[60:63], v[52:55]
ds_read_b64_tr_b16 a[80:81], v12 offset:512
v_mfma_f32_16x16x32_bf16 v[44:47], a[92:95], a[56:59], v[44:47]
ds_read_b64_tr_b16 a[82:83], v12 offset:1536
v_mfma_f32_16x16x32_bf16 v[44:47], a[88:91], a[40:43], v[44:47]
ds_read_b64_tr_b16 a[84:85], v12 offset:8704
v_mfma_f32_16x16x32_bf16 v[36:39], a[88:91], a[36:39], v[36:39]
ds_read_b64_tr_b16 a[86:87], v12 offset:9728
s_add_u32 m0, s16, 0x9000
v_mfma_f32_16x16x32_bf16 v[36:39], a[92:95], a[52:55], v[36:39]
buffer_load_dwordx4 v2, s[48:51], s13 offen lds
v_mfma_f32_16x16x32_bf16 v[28:31], a[92:95], a[48:51], v[28:31]
v_mfma_f32_16x16x32_bf16 v[28:31], a[88:91], a[32:35], v[28:31]
s_waitcnt lgkmcnt(4)
v_mfma_f32_16x16x32_bf16 v[56:59], a[96:99], a[32:35], v[56:59]
ds_read_b64_tr_b16 a[88:89], v13 offset:512
v_mfma_f32_16x16x32_bf16 v[56:59], a[100:103], a[48:51], v[56:59]
ds_read_b64_tr_b16 a[90:91], v13 offset:1536
s_add_u32 m0, s16, 0x9400
v_mfma_f32_16x16x32_bf16 v[64:67], a[100:103], a[52:55], v[64:67]
buffer_load_dwordx4 v3, s[48:51], s13 offen lds
v_mfma_f32_16x16x32_bf16 v[64:67], a[96:99], a[36:39], v[64:67]
ds_read_b64_tr_b16 a[92:93], v13 offset:8704
v_mfma_f32_16x16x32_bf16 v[72:75], a[96:99], a[40:43], v[72:75]
ds_read_b64_tr_b16 a[94:95], v13 offset:9728
v_mfma_f32_16x16x32_bf16 v[72:75], a[100:103], a[56:59], v[72:75]
v_mfma_f32_16x16x32_bf16 v[80:83], a[100:103], a[60:63], v[80:83]
s_add_u32 m0, s16, 0x9800
v_mfma_f32_16x16x32_bf16 v[80:83], a[96:99], a[44:47], v[80:83]
buffer_load_dwordx4 v2, s[48:51], s14 offen lds
v_mfma_f32_16x16x32_bf16 v[84:87], a[104:107], a[44:47], v[84:87]
ds_read_b64_tr_b16 a[96:97], v12 offset:768
v_mfma_f32_16x16x32_bf16 v[84:87], a[108:111], a[60:63], v[84:87]
ds_read_b64_tr_b16 a[98:99], v12 offset:1792
v_mfma_f32_16x16x32_bf16 v[76:79], a[108:111], a[56:59], v[76:79]
ds_read_b64_tr_b16 a[100:101], v12 offset:8960
v_mfma_f32_16x16x32_bf16 v[76:79], a[104:107], a[40:43], v[76:79]
ds_read_b64_tr_b16 a[102:103], v12 offset:9984
s_add_u32 m0, s16, 0x9c00
v_mfma_f32_16x16x32_bf16 v[68:71], a[104:107], a[36:39], v[68:71]
buffer_load_dwordx4 v3, s[48:51], s14 offen lds
v_mfma_f32_16x16x32_bf16 v[68:71], a[108:111], a[52:55], v[68:71]
v_lshl_add_u32 v2, s42, 7, v2
v_lshl_add_u32 v3, s42, 7, v3
v_mfma_f32_16x16x32_bf16 v[60:63], a[108:111], a[48:51], v[60:63]
v_mfma_f32_16x16x32_bf16 v[60:63], a[104:107], a[32:35], v[60:63]
s_add_u32 m0, s17, 0x0
s_waitcnt lgkmcnt(4)
v_mfma_f32_16x16x32_bf16 v[88:91], a[80:83], a[32:35], v[88:91]
ds_read_b64_tr_b16 a[104:105], v13 offset:768
s_waitcnt vmcnt(16)
v_mfma_f32_16x16x32_bf16 v[88:91], a[84:87], a[48:51], v[88:91]
buffer_load_dwordx4 v5, s[56:59], 0 offen lds
v_mfma_f32_16x16x32_bf16 v[96:99], a[84:87], a[52:55], v[96:99]
ds_read_b64_tr_b16 a[106:107], v13 offset:1792
v_mfma_f32_16x16x32_bf16 v[96:99], a[80:83], a[36:39], v[96:99]
ds_read_b64_tr_b16 a[108:109], v13 offset:8960
v_mfma_f32_16x16x32_bf16 v[104:107], a[80:83], a[40:43], v[104:107]
ds_read_b64_tr_b16 a[110:111], v13 offset:9984
v_mfma_f32_16x16x32_bf16 v[104:107], a[84:87], a[56:59], v[104:107]
ds_read_b128 a[0:3], v8 offset:0
s_add_u32 m0, s17, 0x4000
v_mfma_f32_16x16x32_bf16 v[112:115], a[84:87], a[60:63], v[112:115]
buffer_load_dwordx4 v5, s[60:63], 0 offen lds
v_mfma_f32_16x16x32_bf16 v[112:115], a[80:83], a[44:47], v[112:115]
ds_read_b128 a[16:19], v9 offset:0
v_mfma_f32_16x16x32_bf16 v[116:119], a[88:91], a[44:47], v[116:119]
ds_read_b64_tr_b16 a[80:81], v12 offset:16384
v_mfma_f32_16x16x32_bf16 v[116:119], a[92:95], a[60:63], v[116:119]
ds_read_b64_tr_b16 a[82:83], v12 offset:17408
v_mfma_f32_16x16x32_bf16 v[108:111], a[92:95], a[56:59], v[108:111]
ds_read_b64_tr_b16 a[84:85], v12 offset:24576
s_add_u32 m0, s17, 0x400
v_mfma_f32_16x16x32_bf16 v[108:111], a[88:91], a[40:43], v[108:111]
buffer_load_dwordx4 v5, s[56:59], s13 offen lds
v_mfma_f32_16x16x32_bf16 v[100:103], a[88:91], a[36:39], v[100:103]
ds_read_b64_tr_b16 a[86:87], v12 offset:25600
v_mfma_f32_16x16x32_bf16 v[100:103], a[92:95], a[52:55], v[100:103]
ds_read_b128 a[4:7], v8 offset:2048
v_mfma_f32_16x16x32_bf16 v[92:95], a[92:95], a[48:51], v[92:95]
ds_read_b128 a[20:23], v9 offset:2048
s_waitcnt lgkmcnt(8)
v_mfma_f32_16x16x32_bf16 v[92:95], a[88:91], a[32:35], v[92:95]
ds_read_b128 a[8:11], v8 offset:4096
s_add_u32 m0, s17, 0x4400
v_mfma_f32_16x16x32_bf16 v[120:123], a[96:99], a[32:35], v[120:123]
buffer_load_dwordx4 v5, s[60:63], s13 offen lds
v_mfma_f32_16x16x32_bf16 v[120:123], a[100:103], a[48:51], v[120:123]
ds_read_b64_tr_b16 a[88:89], v13 offset:16384
v_mfma_f32_16x16x32_bf16 v[128:131], a[100:103], a[52:55], v[128:131]
ds_read_b64_tr_b16 a[90:91], v13 offset:17408
v_mfma_f32_16x16x32_bf16 v[128:131], a[96:99], a[36:39], v[128:131]
ds_read_b64_tr_b16 a[92:93], v13 offset:24576
v_mfma_f32_16x16x32_bf16 v[136:139], a[96:99], a[40:43], v[136:139]
ds_read_b64_tr_b16 a[94:95], v13 offset:25600
s_add_u32 m0, s17, 0x800
v_mfma_f32_16x16x32_bf16 v[136:139], a[100:103], a[56:59], v[136:139]
buffer_load_dwordx4 v6, s[56:59], 0 offen lds
v_mfma_f32_16x16x32_bf16 v[144:147], a[100:103], a[60:63], v[144:147]
ds_read_b128 a[24:27], v9 offset:4096
v_mfma_f32_16x16x32_bf16 v[144:147], a[96:99], a[44:47], v[144:147]
ds_read_b128 a[12:15], v8 offset:6144
v_mfma_f32_16x16x32_bf16 v[148:151], a[104:107], a[44:47], v[148:151]
ds_read_b64_tr_b16 a[96:97], v12 offset:16640
v_mfma_f32_16x16x32_bf16 v[148:151], a[108:111], a[60:63], v[148:151]
ds_read_b64_tr_b16 a[98:99], v12 offset:17664
s_add_u32 m0, s17, 0x4800
v_mfma_f32_16x16x32_bf16 v[140:143], a[108:111], a[56:59], v[140:143]
buffer_load_dwordx4 v6, s[60:63], 0 offen lds
v_mfma_f32_16x16x32_bf16 v[140:143], a[104:107], a[40:43], v[140:143]
ds_read_b64_tr_b16 a[100:101], v12 offset:24832
v_mfma_f32_16x16x32_bf16 v[132:135], a[104:107], a[36:39], v[132:135]
ds_read_b64_tr_b16 a[102:103], v12 offset:25856
v_mfma_f32_16x16x32_bf16 v[132:135], a[108:111], a[52:55], v[132:135]
ds_read_b128 a[28:31], v9 offset:6144
v_mfma_f32_16x16x32_bf16 v[124:127], a[108:111], a[48:51], v[124:127]
s_add_u32 m0, s17, 0xc00
s_waitcnt lgkmcnt(7)
v_mfma_f32_16x16x32_bf16 v[124:127], a[104:107], a[32:35], v[124:127]
buffer_load_dwordx4 v6, s[56:59], s13 offen lds
v_mfma_f32_16x16x32_bf16 v[152:155], a[32:35], a[80:83], v[152:155]
ds_read_b64_tr_b16 a[104:105], v13 offset:16640
v_mfma_f32_16x16x32_bf16 v[152:155], a[48:51], a[84:87], v[152:155]
ds_read_b64_tr_b16 a[106:107], v13 offset:17664
v_mfma_f32_16x16x32_bf16 v[156:159], a[52:55], a[84:87], v[156:159]
ds_read_b64_tr_b16 a[108:109], v13 offset:24832
v_mfma_f32_16x16x32_bf16 v[156:159], a[36:39], a[80:83], v[156:159]
ds_read_b64_tr_b16 a[110:111], v13 offset:25856
s_add_u32 m0, s17, 0x4c00
v_mfma_f32_16x16x32_bf16 v[160:163], a[40:43], a[80:83], v[160:163]
buffer_load_dwordx4 v6, s[60:63], s13 offen lds
v_mfma_f32_16x16x32_bf16 v[160:163], a[56:59], a[84:87], v[160:163]
v_lshl_add_u32 v5, s42, 19, v5
v_lshl_add_u32 v6, s42, 19, v6
v_mfma_f32_16x16x32_bf16 v[164:167], a[60:63], a[84:87], v[164:167]
v_mfma_f32_16x16x32_bf16 v[164:167], a[44:47], a[80:83], v[164:167]
v_mfma_f32_16x16x32_bf16 v[180:183], a[44:47], a[88:91], v[180:183]
ds_read_b64_tr_b16 a[80:81], v12 offset:16896
s_mov_b32 s9, 0x200000
v_mfma_f32_16x16x32_bf16 v[180:183], a[60:63], a[92:95], v[180:183]
buffer_load_dword a120, v18, s[56:59], s9 offen
v_mfma_f32_16x16x32_bf16 v[176:179], a[56:59], a[92:95], v[176:179]
ds_read_b64_tr_b16 a[82:83], v12 offset:17920
v_mfma_f32_16x16x32_bf16 v[176:179], a[40:43], a[88:91], v[176:179]
ds_read_b64_tr_b16 a[84:85], v12 offset:25088
v_mfma_f32_16x16x32_bf16 v[172:175], a[36:39], a[88:91], v[172:175]
ds_read_b64_tr_b16 a[86:87], v12 offset:26112
v_mfma_f32_16x16x32_bf16 v[172:175], a[52:55], a[92:95], v[172:175]
s_add_u32 m0, s16, 0x0
s_waitcnt lgkmcnt(8)
v_mfma_f32_16x16x32_bf16 v[168:171], a[48:51], a[92:95], v[168:171]
buffer_load_dwordx4 v2, s[48:51], 0 offen lds
v_mfma_f32_16x16x32_bf16 v[168:171], a[32:35], a[88:91], v[168:171]
s_waitcnt lgkmcnt(4)
v_mfma_f32_16x16x32_bf16 v[184:187], a[32:35], a[96:99], v[184:187]
ds_read_b64_tr_b16 a[88:89], v13 offset:16896
v_mfma_f32_16x16x32_bf16 v[184:187], a[48:51], a[100:103], v[184:187]
ds_read_b64_tr_b16 a[90:91], v13 offset:17920
v_mfma_f32_16x16x32_bf16 v[188:191], a[52:55], a[100:103], v[188:191]
ds_read_b64_tr_b16 a[92:93], v13 offset:25088
s_add_u32 m0, s16, 0x400
v_mfma_f32_16x16x32_bf16 v[188:191], a[36:39], a[96:99], v[188:191]
buffer_load_dwordx4 v3, s[48:51], 0 offen lds
v_mfma_f32_16x16x32_bf16 v[192:195], a[40:43], a[96:99], v[192:195]
ds_read_b64_tr_b16 a[94:95], v13 offset:26112
v_mfma_f32_16x16x32_bf16 v[192:195], a[56:59], a[100:103], v[192:195]
v_mfma_f32_16x16x32_bf16 v[196:199], a[60:63], a[100:103], v[196:199]
v_mfma_f32_16x16x32_bf16 v[196:199], a[44:47], a[96:99], v[196:199]
s_add_u32 m0, s16, 0x800
v_mfma_f32_16x16x32_bf16 v[212:215], a[44:47], a[104:107], v[212:215]
buffer_load_dwordx4 v2, s[48:51], s12 offen lds
v_mfma_f32_16x16x32_bf16 v[212:215], a[60:63], a[108:111], v[212:215]
ds_read_b64_tr_b16 a[96:97], v12 offset:17152
v_mfma_f32_16x16x32_bf16 v[208:211], a[56:59], a[108:111], v[208:211]
ds_read_b64_tr_b16 a[98:99], v12 offset:18176
v_mfma_f32_16x16x32_bf16 v[208:211], a[40:43], a[104:107], v[208:211]
ds_read_b64_tr_b16 a[100:101], v12 offset:25344
v_mfma_f32_16x16x32_bf16 v[204:207], a[36:39], a[104:107], v[204:207]
ds_read_b64_tr_b16 a[102:103], v12 offset:26368
s_add_u32 m0, s16, 0xc00
v_mfma_f32_16x16x32_bf16 v[204:207], a[52:55], a[108:111], v[204:207]
buffer_load_dwordx4 v3, s[48:51], s12 offen lds
v_mfma_f32_16x16x32_bf16 v[200:203], a[48:51], a[108:111], v[200:203]
v_mfma_f32_16x16x32_bf16 v[200:203], a[32:35], a[104:107], v[200:203]
s_waitcnt lgkmcnt(4)
v_mfma_f32_16x16x32_bf16 v[216:219], a[32:35], a[80:83], v[216:219]
ds_read_b64_tr_b16 a[104:105], v13 offset:17152
v_mfma_f32_16x16x32_bf16 v[216:219], a[48:51], a[84:87], v[216:219]
ds_read_b64_tr_b16 a[106:107], v13 offset:18176
s_add_u32 m0, s16, 0x1000
v_mfma_f32_16x16x32_bf16 v[220:223], a[52:55], a[84:87], v[220:223]
buffer_load_dwordx4 v2, s[48:51], s13 offen lds
v_mfma_f32_16x16x32_bf16 v[220:223], a[36:39], a[80:83], v[220:223]
ds_read_b64_tr_b16 a[108:109], v13 offset:25344
v_mfma_f32_16x16x32_bf16 v[224:227], a[40:43], a[80:83], v[224:227]
ds_read_b64_tr_b16 a[110:111], v13 offset:26368
v_add_u32 v12, 0x8000, v12
v_mfma_f32_16x16x32_bf16 v[224:227], a[56:59], a[84:87], v[224:227]
v_add_u32 v13, 0x8000, v13
v_mfma_f32_16x16x32_bf16 v[228:231], a[60:63], a[84:87], v[228:231]
s_add_u32 m0, s16, 0x1400
v_mfma_f32_16x16x32_bf16 v[228:231], a[44:47], a[80:83], v[228:231]
buffer_load_dwordx4 v3, s[48:51], s13 offen lds
v_mfma_f32_16x16x32_bf16 v[244:247], a[44:47], a[88:91], v[244:247]
s_waitcnt vmcnt(23) lgkmcnt(0)
v_mfma_f32_16x16x32_bf16 v[244:247], a[60:63], a[92:95], v[244:247]
s_barrier
v_mfma_f32_16x16x32_bf16 v[240:243], a[56:59], a[92:95], v[240:243]
ds_read_b64_tr_b16 a[80:81], v12 offset:0
v_mfma_f32_16x16x32_bf16 v[240:243], a[40:43], a[88:91], v[240:243]
ds_read_b64_tr_b16 a[82:83], v12 offset:1024
s_add_u32 m0, s16, 0x1800
v_mfma_f32_16x16x32_bf16 v[236:239], a[36:39], a[88:91], v[236:239]
buffer_load_dwordx4 v2, s[48:51], s14 offen lds
v_mfma_f32_16x16x32_bf16 v[236:239], a[52:55], a[92:95], v[236:239]
ds_read_b64_tr_b16 a[84:85], v12 offset:8192
v_mfma_f32_16x16x32_bf16 v[232:235], a[48:51], a[92:95], v[232:235]
ds_read_b64_tr_b16 a[86:87], v12 offset:9216
v_mfma_f32_16x16x32_bf16 v[232:235], a[32:35], a[88:91], v[232:235]
L_padA1:
s_cmp_eq_u32 s95, 1
s_cbranch_scc1 L_padA5
s_waitcnt lgkmcnt(4)
v_mfma_f32_16x16x32_bf16 v[248:251], a[32:35], a[96:99], v[248:251]
ds_read_b64_tr_b16 a[88:89], v13 offset:0
s_add_u32 m0, s16, 0x1c00
v_mfma_f32_16x16x32_bf16 v[248:251], a[48:51], a[100:103], v[248:251]
buffer_load_dwordx4 v3, s[48:51], s14 offen lds
v_mfma_f32_16x16x32_bf16 v[252:255], a[52:55], a[100:103], v[252:255]
ds_read_b64_tr_b16 a[90:91], v13 offset:1024
v_lshl_add_u32 v2, s42, 7, v2
v_mfma_f32_16x16x32_bf16 v[252:255], a[36:39], a[96:99], v[252:255]
ds_read_b64_tr_b16 a[92:93], v13 offset:8192
v_lshl_add_u32 v3, s42, 7, v3
v_mfma_f32_16x16x32_bf16 a[232:235], a[40:43], a[96:99], a[232:235]
ds_read_b64_tr_b16 a[94:95], v13 offset:9216
v_mfma_f32_16x16x32_bf16 a[232:235], a[56:59], a[100:103], a[232:235]
s_mov_b32 s9, 0x200000
v_mfma_f32_16x16x32_bf16 a[236:239], a[60:63], a[100:103], a[236:239]
buffer_load_dword a120, v18, s[60:63], s9 offen
v_mfma_f32_16x16x32_bf16 a[236:239], a[44:47], a[96:99], a[236:239]
v_mfma_f32_16x16x32_bf16 a[252:255], a[44:47], a[104:107], a[252:255]
ds_read_b64_tr_b16 a[96:97], v12 offset:256
v_mfma_f32_16x16x32_bf16 a[252:255], a[60:63], a[108:111], a[252:255]
ds_read_b64_tr_b16 a[98:99], v12 offset:1280
v_mfma_f32_16x16x32_bf16 a[248:251], a[56:59], a[108:111], a[248:251]
ds_read_b64_tr_b16 a[100:101], v12 offset:8448
s_add_u32 m0, s17, 0x8000
v_mfma_f32_16x16x32_bf16 a[248:251], a[40:43], a[104:107], a[248:251]
buffer_load_dwordx4 v5, s[56:59], 0 offen lds
v_mfma_f32_16x16x32_bf16 a[244:247], a[36:39], a[104:107], a[244:247]
ds_read_b64_tr_b16 a[102:103], v12 offset:9472
v_mfma_f32_16x16x32_bf16 a[244:247], a[52:55], a[108:111], a[244:247]
v_mfma_f32_16x16x32_bf16 a[240:243], a[48:51], a[108:111], a[240:243]
v_mfma_f32_16x16x32_bf16 a[240:243], a[32:35], a[104:107], a[240:243]
s_add_u32 m0, s17, 0xc000
s_waitcnt lgkmcnt(4)
L_S2:
v_mfma_f32_16x16x32_bf16 v[24:27], a[80:83], a[0:3], v[24:27]
buffer_load_dwordx4 v5, s[60:63], 0 offen lds
v_mfma_f32_16x16x32_bf16 v[24:27], a[84:87], a[16:19], v[24:27]
ds_read_b64_tr_b16 a[104:105], v13 offset:256
s_waitcnt vmcnt(20)
v_mfma_f32_16x16x32_bf16 v[32:35], a[84:87], a[20:23], v[32:35]
ds_read_b64_tr_b16 a[106:107], v13 offset:1280
v_mfma_f32_16x16x32_bf16 v[32:35], a[80:83], a[4:7], v[32:35]
ds_read_b64_tr_b16 a[108:109], v13 offset:8448
v_mfma_f32_16x16x32_bf16 v[40:43], a[80:83], a[8:11], v[40:43]
ds_read_b64_tr_b16 a[110:111], v13 offset:9472
s_add_u32 m0, s17, 0x8400
v_mfma_f32_16x16x32_bf16 v[40:43], a[84:87], a[24:27], v[40:43]
buffer_load_dwordx4 v5, s[56:59], s13 offen lds
v_mfma_f32_16x16x32_bf16 v[48:51], a[84:87], a[28:31], v[48:51]
ds_read_b128 a[32:35], v8 offset:32768
v_mfma_f32_16x16x32_bf16 v[48:51], a[80:83], a[12:15], v[48:51]
ds_read_b128 a[48:51], v9 offset:32768
v_mfma_f32_16x16x32_bf16 v[52:55], a[88:91], a[12:15], v[52:55]
ds_read_b64_tr_b16 a[80:81], v12 offset:512
v_mfma_f32_16x16x32_bf16 v[52:55], a[92:95], a[28:31], v[52:55]
ds_read_b64_tr_b16 a[82:83], v12 offset:1536
s_add_u32 m0, s17, 0xc400
v_mfma_f32_16x16x32_bf16 v[44:47], a[92:95], a[24:27], v[44:47]
buffer_load_dwordx4 v5, s[60:63], s13 offen lds
v_mfma_f32_16x16x32_bf16 v[44:47], a[88:91], a[8:11], v[44:47]
ds_read_b64_tr_b16 a[84:85], v12 offset:8704
v_mfma_f32_16x16x32_bf16 v[36:39], a[88:91], a[4:7], v[36:39]
ds_read_b64_tr_b16 a[86:87], v12 offset:9728
v_mfma_f32_16x16x32_bf16 v[36:39], a[92:95], a[20:23], v[36:39]
ds_read_b128 a[36:39], v8 offset:34816
s_waitcnt lgkmcnt(7)
v_mfma_f32_16x16x32_bf16 v[28:31], a[92:95], a[16:19], v[28:31]
ds_read_b128 a[52:55], v9 offset:34816
s_add_u32 m0, s17, 0x8800
v_mfma_f32_16x16x32_bf16 v[28:31], a[88:91], a[0:3], v[28:31]
buffer_load_dwordx4 v6, s[56:59], 0 offen lds
v_mfma_f32_16x16x32_bf16 v[56:59], a[96:99], a[0:3], v[56:59]
ds_read_b64_tr_b16 a[88:89], v13 offset:512
v_mfma_f32_16x16x32_bf16 v[56:59], a[100:103], a[16:19], v[56:59]
ds_read_b64_tr_b16 a[90:91], v13 offset:1536
v_mfma_f32_16x16x32_bf16 v[64:67], a[100:103], a[20:23], v[64:67]
ds_read_b64_tr_b16 a[92:93], v13 offset:8704
v_mfma_f32_16x16x32_bf16 v[64:67], a[96:99], a[4:7], v[64:67]
ds_read_b64_tr_b16 a[94:95], v13 offset:9728
s_add_u32 m0, s17, 0xc800
v_mfma_f32_16x16x32_bf16 v[72:75], a[96:99], a[8:11], v[72:75]
buffer_load_dwordx4 v6, s[60:63], 0 offen lds
v_mfma_f32_16x16x32_bf16 v[72:75], a[100:103], a[24:27], v[72:75]
ds_read_b128 a[40:43], v8 offset:36864
v_mfma_f32_16x16x32_bf16 v[80:83], a[100:103], a[28:31], v[80:83]
ds_read_b128 a[56:59], v9 offset:36864
v_mfma_f32_16x16x32_bf16 v[80:83], a[96:99], a[12:15], v[80:83]
ds_read_b128 a[44:47], v8 offset:38912
v_mfma_f32_16x16x32_bf16 v[84:87], a[104:107], a[12:15], v[84:87]
ds_read_b64_tr_b16 a[96:97], v12 offset:768
s_add_u32 m0, s17, 0x8c00
v_mfma_f32_16x16x32_bf16 v[84:87], a[108:111], a[28:31], v[84:87]
buffer_load_dwordx4 v6, s[56:59], s13 offen lds
v_mfma_f32_16x16x32_bf16 v[76:79], a[108:111], a[24:27], v[76:79]
ds_read_b64_tr_b16 a[98:99], v12 offset:1792
v_mfma_f32_16x16x32_bf16 v[76:79], a[104:107], a[8:11], v[76:79]
ds_read_b64_tr_b16 a[100:101], v12 offset:8960
v_mfma_f32_16x16x32_bf16 v[68:71], a[104:107], a[4:7], v[68:71]
ds_read_b64_tr_b16 a[102:103], v12 offset:9984
v_mfma_f32_16x16x32_bf16 v[68:71], a[108:111], a[20:23], v[68:71]
ds_read_b128 a[60:63], v9 offset:38912
s_add_u32 m0, s17, 0xcc00
v_mfma_f32_16x16x32_bf16 v[60:63], a[108:111], a[16:19], v[60:63]
buffer_load_dwordx4 v6, s[60:63], s13 offen lds
v_mfma_f32_16x16x32_bf16 v[60:63], a[104:107], a[0:3], v[60:63]
s_waitcnt lgkmcnt(8)
v_lshl_add_u32 v5, s42, 19, v5
v_lshl_add_u32 v6, s42, 19, v6
v_mfma_f32_16x16x32_bf16 v[88:91], a[80:83], a[0:3], v[88:91]
ds_read_b64_tr_b16 a[104:105], v13 offset:768
v_mfma_f32_16x16x32_bf16 v[88:91], a[84:87], a[16:19], v[88:91]
ds_read_b64_tr_b16 a[106:107], v13 offset:1792
v_mfma_f32_16x16x32_bf16 v[96:99], a[84:87], a[20:23], v[96:99]
ds_read_b64_tr_b16 a[108:109], v13 offset:8960
v_mfma_f32_16x16x32_bf16 v[96:99], a[80:83], a[4:7], v[96:99]
ds_read_b64_tr_b16 a[110:111], v13 offset:9984
v_mfma_f32_16x16x32_bf16 v[104:107], a[80:83], a[8:11], v[104:107]
s_add_u32 m0, s16, 0x8000
s_waitcnt lgkmcnt(4)
v_mfma_f32_16x16x32_bf16 v[104:107], a[84:87], a[24:27], v[104:107]
buffer_load_dwordx4 v2, s[48:51], 0 offen lds
v_mfma_f32_16x16x32_bf16 v[112:115], a[84:87], a[28:31], v[112:115]
v_mfma_f32_16x16x32_bf16 v[112:115], a[80:83], a[12:15], v[112:115]
v_mfma_f32_16x16x32_bf16 v[116:119], a[88:91], a[12:15], v[116:119]
ds_read_b64_tr_b16 a[80:81], v12 offset:16384
v_mfma_f32_16x16x32_bf16 v[116:119], a[92:95], a[28:31], v[116:119]
ds_read_b64_tr_b16 a[82:83], v12 offset:17408
v_mfma_f32_16x16x32_bf16 v[108:111], a[92:95], a[24:27], v[108:111]
ds_read_b64_tr_b16 a[84:85], v12 offset:24576
v_mfma_f32_16x16x32_bf16 v[108:111], a[88:91], a[8:11], v[108:111]
ds_read_b64_tr_b16 a[86:87], v12 offset:25600
s_add_u32 m0, s16, 0x8400
v_mfma_f32_16x16x32_bf16 v[100:103], a[88:91], a[4:7], v[100:103]
buffer_load_dwordx4 v3, s[48:51], 0 offen lds
v_mfma_f32_16x16x32_bf16 v[100:103], a[92:95], a[20:23], v[100:103]
v_mfma_f32_16x16x32_bf16 v[92:95], a[92:95], a[16:19], v[92:95]
v_mfma_f32_16x16x32_bf16 v[92:95], a[88:91], a[0:3], v[92:95]
s_waitcnt lgkmcnt(4)
v_mfma_f32_16x16x32_bf16 v[120:123], a[96:99], a[0:3], v[120:123]
ds_read_b64_tr_b16 a[88:89], v13 offset:16384
v_mfma_f32_16x16x32_bf16 v[120:123], a[100:103], a[16:19], v[120:123]
ds_read_b64_tr_b16 a[90:91], v13 offset:17408
v_mfma_f32_16x16x32_bf16 v[128:131], a[100:103], a[20:23], v[128:131]
ds_read_b64_tr_b16 a[92:93], v13 offset:24576
v_mfma_f32_16x16x32_bf16 v[128:131], a[96:99], a[4:7], v[128:131]
ds_read_b64_tr_b16 a[94:95], v13 offset:25600
s_add_u32 m0, s16, 0x8800
v_mfma_f32_16x16x32_bf16 v[136:139], a[96:99], a[8:11], v[136:139]
buffer_load_dwordx4 v2, s[48:51], s12 offen lds
v_mfma_f32_16x16x32_bf16 v[136:139], a[100:103], a[24:27], v[136:139]
v_mfma_f32_16x16x32_bf16 v[144:147], a[100:103], a[28:31], v[144:147]
v_mfma_f32_16x16x32_bf16 v[144:147], a[96:99], a[12:15], v[144:147]
v_mfma_f32_16x16x32_bf16 v[148:151], a[104:107], a[12:15], v[148:151]
ds_read_b64_tr_b16 a[96:97], v12 offset:16640
v_mfma_f32_16x16x32_bf16 v[148:151], a[108:111], a[28:31], v[148:151]
ds_read_b64_tr_b16 a[98:99], v12 offset:17664
v_mfma_f32_16x16x32_bf16 v[140:143], a[108:111], a[24:27], v[140:143]
ds_read_b64_tr_b16 a[100:101], v12 offset:24832
s_add_u32 m0, s16, 0x8c00
v_mfma_f32_16x16x32_bf16 v[140:143], a[104:107], a[8:11], v[140:143]
buffer_load_dwordx4 v3, s[48:51], s12 offen lds
v_mfma_f32_16x16x32_bf16 v[132:135], a[104:107], a[4:7], v[132:135]
ds_read_b64_tr_b16 a[102:103], v12 offset:25856
v_mfma_f32_16x16x32_bf16 v[132:135], a[108:111], a[20:23], v[132:135]
v_mfma_f32_16x16x32_bf16 v[124:127], a[108:111], a[16:19], v[124:127]
v_mfma_f32_16x16x32_bf16 v[124:127], a[104:107], a[0:3], v[124:127]
s_waitcnt lgkmcnt(4)
v_mfma_f32_16x16x32_bf16 v[152:155], a[0:3], a[80:83], v[152:155]
ds_read_b64_tr_b16 a[104:105], v13 offset:16640
v_mfma_f32_16x16x32_bf16 v[152:155], a[16:19], a[84:87], v[152:155]
ds_read_b64_tr_b16 a[106:107], v13 offset:17664
s_add_u32 m0, s16, 0x9000
v_mfma_f32_16x16x32_bf16 v[156:159], a[20:23], a[84:87], v[156:159]
buffer_load_dwordx4 v2, s[48:51], s13 offen lds
v_mfma_f32_16x16x32_bf16 v[156:159], a[4:7], a[80:83], v[156:159]
ds_read_b64_tr_b16 a[108:109], v13 offset:24832
v_mfma_f32_16x16x32_bf16 v[160:163], a[8:11], a[80:83], v[160:163]
ds_read_b64_tr_b16 a[110:111], v13 offset:25856
v_mfma_f32_16x16x32_bf16 v[160:163], a[24:27], a[84:87], v[160:163]
v_mfma_f32_16x16x32_bf16 v[164:167], a[28:31], a[84:87], v[164:167]
v_mfma_f32_16x16x32_bf16 v[164:167], a[12:15], a[80:83], v[164:167]
v_mfma_f32_16x16x32_bf16 v[180:183], a[12:15], a[88:91], v[180:183]
ds_read_b64_tr_b16 a[80:81], v12 offset:16896
v_mfma_f32_16x16x32_bf16 v[180:183], a[28:31], a[92:95], v[180:183]
ds_read_b64_tr_b16 a[82:83], v12 offset:17920
s_add_u32 m0, s16, 0x9400
v_mfma_f32_16x16x32_bf16 v[176:179], a[24:27], a[92:95], v[176:179]
buffer_load_dwordx4 v3, s[48:51], s13 offen lds
v_mfma_f32_16x16x32_bf16 v[176:179], a[8:11], a[88:91], v[176:179]
ds_read_b64_tr_b16 a[84:85], v12 offset:25088
v_mfma_f32_16x16x32_bf16 v[172:175], a[4:7], a[88:91], v[172:175]
ds_read_b64_tr_b16 a[86:87], v12 offset:26112
v_mfma_f32_16x16x32_bf16 v[172:175], a[20:23], a[92:95], v[172:175]
v_mfma_f32_16x16x32_bf16 v[168:171], a[16:19], a[92:95], v[168:171]
v_mfma_f32_16x16x32_bf16 v[168:171], a[0:3], a[88:91], v[168:171]
s_waitcnt lgkmcnt(4)
v_mfma_f32_16x16x32_bf16 v[184:187], a[0:3], a[96:99], v[184:187]
ds_read_b64_tr_b16 a[88:89], v13 offset:16896
s_add_u32 m0, s16, 0x9800
v_mfma_f32_16x16x32_bf16 v[184:187], a[16:19], a[100:103], v[184:187]
buffer_load_dwordx4 v2, s[48:51], s14 offen lds
v_mfma_f32_16x16x32_bf16 v[188:191], a[20:23], a[100:103], v[188:191]
ds_read_b64_tr_b16 a[90:91], v13 offset:17920
v_mfma_f32_16x16x32_bf16 v[188:191], a[4:7], a[96:99], v[188:191]
ds_read_b64_tr_b16 a[92:93], v13 offset:25088
v_mfma_f32_16x16x32_bf16 v[192:195], a[8:11], a[96:99], v[192:195]
ds_read_b64_tr_b16 a[94:95], v13 offset:26112
v_mfma_f32_16x16x32_bf16 v[192:195], a[24:27], a[100:103], v[192:195]
v_mfma_f32_16x16x32_bf16 v[196:199], a[28:31], a[100:103], v[196:199]
v_mfma_f32_16x16x32_bf16 v[196:199], a[12:15], a[96:99], v[196:199]
v_mfma_f32_16x16x32_bf16 v[212:215], a[12:15], a[104:107], v[212:215]
ds_read_b64_tr_b16 a[96:97], v12 offset:17152
s_add_u32 m0, s16, 0x9c00
v_mfma_f32_16x16x32_bf16 v[212:215], a[28:31], a[108:111], v[212:215]
buffer_load_dwordx4 v3, s[48:51], s14 offen lds
v_mfma_f32_16x16x32_bf16 v[208:211], a[24:27], a[108:111], v[208:211]
ds_read_b64_tr_b16 a[98:99], v12 offset:18176
v_lshl_add_u32 v2, s42, 7, v2
v_mfma_f32_16x16x32_bf16 v[208:211], a[8:11], a[104:107], v[208:211]
ds_read_b64_tr_b16 a[100:101], v12 offset:25344
v_lshl_add_u32 v3, s42, 7, v3
v_mfma_f32_16x16x32_bf16 v[204:207], a[4:7], a[104:107], v[204:207]
ds_read_b64_tr_b16 a[102:103], v12 offset:26368
v_mfma_f32_16x16x32_bf16 v[204:207], a[20:23], a[108:111], v[204:207]
v_mfma_f32_16x16x32_bf16 v[200:203], a[16:19], a[108:111], v[200:203]
v_mfma_f32_16x16x32_bf16 v[200:203], a[0:3], a[104:107], v[200:203]
s_mov_b32 s9, 0x0
s_waitcnt lgkmcnt(4)
v_mfma_f32_16x16x32_bf16 v[216:219], a[0:3], a[80:83], v[216:219]
buffer_load_dword a120, v19, s[44:47], s9 offen
v_mfma_f32_16x16x32_bf16 v[216:219], a[16:19], a[84:87], v[216:219]
ds_read_b64_tr_b16 a[104:105], v13 offset:17152
v_mfma_f32_16x16x32_bf16 v[220:223], a[20:23], a[84:87], v[220:223]
ds_read_b64_tr_b16 a[106:107], v13 offset:18176
v_mfma_f32_16x16x32_bf16 v[220:223], a[4:7], a[80:83], v[220:223]
ds_read_b64_tr_b16 a[108:109], v13 offset:25344
v_mfma_f32_16x16x32_bf16 v[224:227], a[8:11], a[80:83], v[224:227]
ds_read_b64_tr_b16 a[110:111], v13 offset:26368
v_add_u32 v12, 0xffff0000, v12
v_mfma_f32_16x16x32_bf16 v[224:227], a[24:27], a[84:87], v[224:227]
v_add_u32 v13, 0xffff0000, v13
v_mfma_f32_16x16x32_bf16 v[228:231], a[28:31], a[84:87], v[228:231]
v_mfma_f32_16x16x32_bf16 v[228:231], a[12:15], a[80:83], v[228:231]
v_mfma_f32_16x16x32_bf16 v[244:247], a[12:15], a[88:91], v[244:247]
s_waitcnt vmcnt(27) lgkmcnt(0)
v_mfma_f32_16x16x32_bf16 v[244:247], a[28:31], a[92:95], v[244:247]
s_barrier
s_add_u32 m0, s17, 0x10000
v_mfma_f32_16x16x32_bf16 v[240:243], a[24:27], a[92:95], v[240:243]
buffer_load_dwordx4 v5, s[56:59], 0 offen lds
v_mfma_f32_16x16x32_bf16 v[240:243], a[8:11], a[88:91], v[240:243]
ds_read_b64_tr_b16 a[80:81], v12 offset:0
v_mfma_f32_16x16x32_bf16 v[236:239], a[4:7], a[88:91], v[236:239]
ds_read_b64_tr_b16 a[82:83], v12 offset:1024
v_mfma_f32_16x16x32_bf16 v[236:239], a[20:23], a[92:95], v[236:239]
ds_read_b64_tr_b16 a[84:85], v12 offset:8192
v_mfma_f32_16x16x32_bf16 v[232:235], a[16:19], a[92:95], v[232:235]
ds_read_b64_tr_b16 a[86:87], v12 offset:9216
v_mfma_f32_16x16x32_bf16 v[232:235], a[0:3], a[88:91], v[232:235]
s_waitcnt lgkmcnt(4)
v_mfma_f32_16x16x32_bf16 v[248:251], a[0:3], a[96:99], v[248:251]
ds_read_b64_tr_b16 a[88:89], v13 offset:0
s_add_u32 m0, s17, 0x14000
v_mfma_f32_16x16x32_bf16 v[248:251], a[16:19], a[100:103], v[248:251]
buffer_load_dwordx4 v5, s[60:63], 0 offen lds
v_mfma_f32_16x16x32_bf16 v[252:255], a[20:23], a[100:103], v[252:255]
ds_read_b64_tr_b16 a[90:91], v13 offset:1024
v_mfma_f32_16x16x32_bf16 v[252:255], a[4:7], a[96:99], v[252:255]
ds_read_b64_tr_b16 a[92:93], v13 offset:8192
v_mfma_f32_16x16x32_bf16 a[232:235], a[8:11], a[96:99], a[232:235]
ds_read_b64_tr_b16 a[94:95], v13 offset:9216
v_mfma_f32_16x16x32_bf16 a[232:235], a[24:27], a[100:103], a[232:235]
v_mfma_f32_16x16x32_bf16 a[236:239], a[28:31], a[100:103], a[236:239]
v_mfma_f32_16x16x32_bf16 a[236:239], a[12:15], a[96:99], a[236:239]
s_add_u32 m0, s17, 0x10400
v_mfma_f32_16x16x32_bf16 a[252:255], a[12:15], a[104:107], a[252:255]
buffer_load_dwordx4 v5, s[56:59], s13 offen lds
v_mfma_f32_16x16x32_bf16 a[252:255], a[28:31], a[108:111], a[252:255]
ds_read_b64_tr_b16 a[96:97], v12 offset:256
v_mfma_f32_16x16x32_bf16 a[248:251], a[24:27], a[108:111], a[248:251]
ds_read_b64_tr_b16 a[98:99], v12 offset:1280
v_mfma_f32_16x16x32_bf16 a[248:251], a[8:11], a[104:107], a[248:251]
ds_read_b64_tr_b16 a[100:101], v12 offset:8448
v_mfma_f32_16x16x32_bf16 a[244:247], a[4:7], a[104:107], a[244:247]
ds_read_b64_tr_b16 a[102:103], v12 offset:9472
v_mfma_f32_16x16x32_bf16 a[244:247], a[20:23], a[108:111], a[244:247]
v_mfma_f32_16x16x32_bf16 a[240:243], a[16:19], a[108:111], a[240:243]
s_add_u32 m0, s17, 0x14400
s_waitcnt lgkmcnt(4)
v_mfma_f32_16x16x32_bf16 a[240:243], a[0:3], a[104:107], a[240:243]
buffer_load_dwordx4 v5, s[60:63], s13 offen lds
L_S3:
v_mfma_f32_16x16x32_bf16 v[24:27], a[80:83], a[32:35], v[24:27]
ds_read_b64_tr_b16 a[104:105], v13 offset:256
s_waitcnt vmcnt(22)
v_mfma_f32_16x16x32_bf16 v[24:27], a[84:87], a[48:51], v[24:27]
ds_read_b64_tr_b16 a[106:107], v13 offset:1280
v_mfma_f32_16x16x32_bf16 v[32:35], a[84:87], a[52:55], v[32:35]
ds_read_b64_tr_b16 a[108:109], v13 offset:8448
v_mfma_f32_16x16x32_bf16 v[32:35], a[80:83], a[36:39], v[32:35]
ds_read_b64_tr_b16 a[110:111], v13 offset:9472
v_mfma_f32_16x16x32_bf16 v[40:43], a[80:83], a[40:43], v[40:43]
ds_read_b128 a[0:3], v8 offset:0
v_mfma_f32_16x16x32_bf16 v[40:43], a[84:87], a[56:59], v[40:43]
ds_read_b128 a[16:19], v9 offset:0
s_add_u32 m0, s17, 0x10800
v_mfma_f32_16x16x32_bf16 v[48:51], a[84:87], a[60:63], v[48:51]
buffer_load_dwordx4 v6, s[56:59], 0 offen lds
v_mfma_f32_16x16x32_bf16 v[48:51], a[80:83], a[44:47], v[48:51]
ds_read_b128 a[4:7], v8 offset:2048
v_mfma_f32_16x16x32_bf16 v[52:55], a[88:91], a[44:47], v[52:55]
ds_read_b64_tr_b16 a[80:81], v12 offset:512
v_mfma_f32_16x16x32_bf16 v[52:55], a[92:95], a[60:63], v[52:55]
ds_read_b64_tr_b16 a[82:83], v12 offset:1536
v_mfma_f32_16x16x32_bf16 v[44:47], a[92:95], a[56:59], v[44:47]
ds_read_b64_tr_b16 a[84:85], v12 offset:8704
v_mfma_f32_16x16x32_bf16 v[44:47], a[88:91], a[40:43], v[44:47]
ds_read_b64_tr_b16 a[86:87], v12 offset:9728
v_mfma_f32_16x16x32_bf16 v[36:39], a[88:91], a[36:39], v[36:39]
ds_read_b128 a[20:23], v9 offset:2048
s_add_u32 m0, s17, 0x14800
v_mfma_f32_16x16x32_bf16 v[36:39], a[92:95], a[52:55], v[36:39]
buffer_load_dwordx4 v6, s[60:63], 0 offen lds
v_mfma_f32_16x16x32_bf16 v[28:31], a[92:95], a[48:51], v[28:31]
ds_read_b128 a[8:11], v8 offset:4096
v_mfma_f32_16x16x32_bf16 v[28:31], a[88:91], a[32:35], v[28:31]
ds_read_b128 a[24:27], v9 offset:4096
s_waitcnt lgkmcnt(10)
v_mfma_f32_16x16x32_bf16 v[56:59], a[96:99], a[32:35], v[56:59]
ds_read_b64_tr_b16 a[88:89], v13 offset:512
v_mfma_f32_16x16x32_bf16 v[56:59], a[100:103], a[48:51], v[56:59]
ds_read_b64_tr_b16 a[90:91], v13 offset:1536
v_mfma_f32_16x16x32_bf16 v[64:67], a[100:103], a[52:55], v[64:67]
ds_read_b64_tr_b16 a[92:93], v13 offset:8704
v_mfma_f32_16x16x32_bf16 v[64:67], a[96:99], a[36:39], v[64:67]
ds_read_b64_tr_b16 a[94:95], v13 offset:9728
s_add_u32 m0, s17, 0x10c00
v_mfma_f32_16x16x32_bf16 v[72:75], a[96:99], a[40:43], v[72:75]
buffer_load_dwordx4 v6, s[56:59], s13 offen lds
v_mfma_f32_16x16x32_bf16 v[72:75], a[100:103], a[56:59], v[72:75]
ds_read_b128 a[12:15], v8 offset:6144
v_mfma_f32_16x16x32_bf16 v[80:83], a[100:103], a[60:63], v[80:83]
ds_read_b128 a[28:31], v9 offset:6144
v_mfma_f32_16x16x32_bf16 v[80:83], a[96:99], a[44:47], v[80:83]
v_mfma_f32_16x16x32_bf16 v[84:87], a[104:107], a[44:47], v[84:87]
ds_read_b64_tr_b16 a[96:97], v12 offset:768
v_mfma_f32_16x16x32_bf16 v[84:87], a[108:111], a[60:63], v[84:87]
ds_read_b64_tr_b16 a[98:99], v12 offset:1792
v_mfma_f32_16x16x32_bf16 v[76:79], a[108:111], a[56:59], v[76:79]
ds_read_b64_tr_b16 a[100:101], v12 offset:8960
s_add_u32 m0, s17, 0x14c00
v_mfma_f32_16x16x32_bf16 v[76:79], a[104:107], a[40:43], v[76:79]
buffer_load_dwordx4 v6, s[60:63], s13 offen lds
v_mfma_f32_16x16x32_bf16 v[68:71], a[104:107], a[36:39], v[68:71]
ds_read_b64_tr_b16 a[102:103], v12 offset:9984
v_lshl_add_u32 v5, s42, 19, v5
v_mfma_f32_16x16x32_bf16 v[68:71], a[108:111], a[52:55], v[68:71]
v_lshl_add_u32 v6, s42, 19, v6
v_mfma_f32_16x16x32_bf16 v[60:63], a[108:111], a[48:51], v[60:63]
v_mfma_f32_16x16x32_bf16 v[60:63], a[104:107], a[32:35], v[60:63]
s_waitcnt lgkmcnt(6)
v_mfma_f32_16x16x32_bf16 v[88:91], a[80:83], a[32:35], v[88:91]
ds_read_b64_tr_b16 a[104:105], v13 offset:768
v_mfma_f32_16x16x32_bf16 v[88:91], a[84:87], a[48:51], v[88:91]
ds_read_b64_tr_b16 a[106:107], v13 offset:1792
s_mov_b32 s9, 0x200000
v_mfma_f32_16x16x32_bf16 v[96:99], a[84:87], a[52:55], v[96:99]
buffer_load_dword a120, v19, s[44:47], s9 offen
v_mfma_f32_16x16x32_bf16 v[96:99], a[80:83], a[36:39], v[96:99]
ds_read_b64_tr_b16 a[108:109], v13 offset:8960
v_mfma_f32_16x16x32_bf16 v[104:107], a[80:83], a[40:43], v[104:107]
ds_read_b64_tr_b16 a[110:111], v13 offset:9984
v_mfma_f32_16x16x32_bf16 v[104:107], a[84:87], a[56:59], v[104:107]
v_mfma_f32_16x16x32_bf16 v[112:115], a[84:87], a[60:63], v[112:115]
v_mfma_f32_16x16x32_bf16 v[112:115], a[80:83], a[44:47], v[112:115]
s_waitcnt lgkmcnt(8)
v_mfma_f32_16x16x32_bf16 v[116:119], a[88:91], a[44:47], v[116:119]
ds_read_b64_tr_b16 a[80:81], v12 offset:16384
s_add_u32 m0, s16, 0x0
v_mfma_f32_16x16x32_bf16 v[116:119], a[92:95], a[60:63], v[116:119]
buffer_load_dwordx4 v2, s[48:51], 0 offen lds
v_mfma_f32_16x16x32_bf16 v[108:111], a[92:95], a[56:59], v[108:111]
ds_read_b64_tr_b16 a[82:83], v12 offset:17408
v_mfma_f32_16x16x32_bf16 v[108:111], a[88:91], a[40:43], v[108:111]
ds_read_b64_tr_b16 a[84:85], v12 offset:24576
v_mfma_f32_16x16x32_bf16 v[100:103], a[88:91], a[36:39], v[100:103]
ds_read_b64_tr_b16 a[86:87], v12 offset:25600
v_mfma_f32_16x16x32_bf16 v[100:103], a[92:95], a[52:55], v[100:103]
v_mfma_f32_16x16x32_bf16 v[92:95], a[92:95], a[48:51], v[92:95]
v_mfma_f32_16x16x32_bf16 v[92:95], a[88:91], a[32:35], v[92:95]
s_add_u32 m0, s16, 0x400
s_waitcnt lgkmcnt(4)
v_mfma_f32_16x16x32_bf16 v[120:123], a[96:99], a[32:35], v[120:123]
buffer_load_dwordx4 v3, s[48:51], 0 offen lds
v_mfma_f32_16x16x32_bf16 v[120:123], a[100:103], a[48:51], v[120:123]
ds_read_b64_tr_b16 a[88:89], v13 offset:16384
v_mfma_f32_16x16x32_bf16 v[128:131], a[100:103], a[52:55], v[128:131]
ds_read_b64_tr_b16 a[90:91], v13 offset:17408
v_mfma_f32_16x16x32_bf16 v[128:131], a[96:99], a[36:39], v[128:131]
ds_read_b64_tr_b16 a[92:93], v13 offset:24576
v_mfma_f32_16x16x32_bf16 v[136:139], a[96:99], a[40:43], v[136:139]
ds_read_b64_tr_b16 a[94:95], v13 offset:25600
v_mfma_f32_16x16x32_bf16 v[136:139], a[100:103], a[56:59], v[136:139]
v_mfma_f32_16x16x32_bf16 v[144:147], a[100:103], a[60:63], v[144:147]
s_add_u32 m0, s16, 0x800
v_mfma_f32_16x16x32_bf16 v[144:147], a[96:99], a[44:47], v[144:147]
buffer_load_dwordx4 v2, s[48:51], s12 offen lds
v_mfma_f32_16x16x32_bf16 v[148:151], a[104:107], a[44:47], v[148:151]
ds_read_b64_tr_b16 a[96:97], v12 offset:16640
v_mfma_f32_16x16x32_bf16 v[148:151], a[108:111], a[60:63], v[148:151]
ds_read_b64_tr_b16 a[98:99], v12 offset:17664
v_mfma_f32_16x16x32_bf16 v[140:143], a[108:111], a[56:59], v[140:143]
ds_read_b64_tr_b16 a[100:101], v12 offset:24832
v_mfma_f32_16x16x32_bf16 v[140:143], a[104:107], a[40:43], v[140:143]
ds_read_b64_tr_b16 a[102:103], v12 offset:25856
v_mfma_f32_16x16x32_bf16 v[132:135], a[104:107], a[36:39], v[132:135]
v_mfma_f32_16x16x32_bf16 v[132:135], a[108:111], a[52:55], v[132:135]
s_add_u32 m0, s16, 0xc00
v_mfma_f32_16x16x32_bf16 v[124:127], a[108:111], a[48:51], v[124:127]
buffer_load_dwordx4 v3, s[48:51], s12 offen lds
v_mfma_f32_16x16x32_bf16 v[124:127], a[104:107], a[32:35], v[124:127]
s_waitcnt lgkmcnt(4)
v_mfma_f32_16x16x32_bf16 v[152:155], a[32:35], a[80:83], v[152:155]
ds_read_b64_tr_b16 a[104:105], v13 offset:16640
v_mfma_f32_16x16x32_bf16 v[152:155], a[48:51], a[84:87], v[152:155]
ds_read_b64_tr_b16 a[106:107], v13 offset:17664
v_mfma_f32_16x16x32_bf16 v[156:159], a[52:55], a[84:87], v[156:159]
ds_read_b64_tr_b16 a[108:109], v13 offset:24832
v_mfma_f32_16x16x32_bf16 v[156:159], a[36:39], a[80:83], v[156:159]
ds_read_b64_tr_b16 a[110:111], v13 offset:25856
v_mfma_f32_16x16x32_bf16 v[160:163], a[40:43], a[80:83], v[160:163]
s_add_u32 m0, s16, 0x1000
v_mfma_f32_16x16x32_bf16 v[160:163], a[56:59], a[84:87], v[160:163]
buffer_load_dwordx4 v2, s[48:51], s13 offen lds
v_mfma_f32_16x16x32_bf16 v[164:167], a[60:63], a[84:87], v[164:167]
v_mfma_f32_16x16x32_bf16 v[164:167], a[44:47], a[80:83], v[164:167]
v_mfma_f32_16x16x32_bf16 v[180:183], a[44:47], a[88:91], v[180:183]
ds_read_b64_tr_b16 a[80:81], v12 offset:16896
v_mfma_f32_16x16x32_bf16 v[180:183], a[60:63], a[92:95], v[180:183]
ds_read_b64_tr_b16 a[82:83], v12 offset:17920
v_mfma_f32_16x16x32_bf16 v[176:179], a[56:59], a[92:95], v[176:179]
ds_read_b64_tr_b16 a[84:85], v12 offset:25088
v_mfma_f32_16x16x32_bf16 v[176:179], a[40:43], a[88:91], v[176:179]
ds_read_b64_tr_b16 a[86:87], v12 offset:26112
s_add_u32 m0, s16, 0x1400
v_mfma_f32_16x16x32_bf16 v[172:175], a[36:39], a[88:91], v[172:175]
buffer_load_dwordx4 v3, s[48:51], s13 offen lds
v_mfma_f32_16x16x32_bf16 v[172:175], a[52:55], a[92:95], v[172:175]
v_mfma_f32_16x16x32_bf16 v[168:171], a[48:51], a[92:95], v[168:171]
v_mfma_f32_16x16x32_bf16 v[168:171], a[32:35], a[88:91], v[168:171]
s_waitcnt lgkmcnt(4)
v_mfma_f32_16x16x32_bf16 v[184:187], a[32:35], a[96:99], v[184:187]
ds_read_b64_tr_b16 a[88:89], v13 offset:16896
v_mfma_f32_16x16x32_bf16 v[184:187], a[48:51], a[100:103], v[184:187]
ds_read_b64_tr_b16 a[90:91], v13 offset:17920
v_mfma_f32_16x16x32_bf16 v[188:191], a[52:55], a[100:103], v[188:191]
ds_read_b64_tr_b16 a[92:93], v13 offset:25088
s_add_u32 m0, s16, 0x1800
v_mfma_f32_16x16x32_bf16 v[188:191], a[36:39], a[96:99], v[188:191]
buffer_load_dwordx4 v2, s[48:51], s14 offen lds
v_mfma_f32_16x16x32_bf16 v[192:195], a[40:43], a[96:99], v[192:195]
ds_read_b64_tr_b16 a[94:95], v13 offset:26112
v_mfma_f32_16x16x32_bf16 v[192:195], a[56:59], a[100:103], v[192:195]
v_mfma_f32_16x16x32_bf16 v[196:199], a[60:63], a[100:103], v[196:199]
v_mfma_f32_16x16x32_bf16 v[196:199], a[44:47], a[96:99], v[196:199]
v_mfma_f32_16x16x32_bf16 v[212:215], a[44:47], a[104:107], v[212:215]
ds_read_b64_tr_b16 a[96:97], v12 offset:17152
v_mfma_f32_16x16x32_bf16 v[212:215], a[60:63], a[108:111], v[212:215]
ds_read_b64_tr_b16 a[98:99], v12 offset:18176
s_add_u32 m0, s16, 0x1c00
v_mfma_f32_16x16x32_bf16 v[208:211], a[56:59], a[108:111], v[208:211]
buffer_load_dwordx4 v3, s[48:51], s14 offen lds
v_mfma_f32_16x16x32_bf16 v[208:211], a[40:43], a[104:107], v[208:211]
ds_read_b64_tr_b16 a[100:101], v12 offset:25344
v_lshl_add_u32 v2, s42, 7, v2
v_mfma_f32_16x16x32_bf16 v[204:207], a[36:39], a[104:107], v[204:207]
ds_read_b64_tr_b16 a[102:103], v12 offset:26368
v_lshl_add_u32 v3, s42, 7, v3
v_mfma_f32_16x16x32_bf16 v[204:207], a[52:55], a[108:111], v[204:207]
v_mfma_f32_16x16x32_bf16 v[200:203], a[48:51], a[108:111], v[200:203]
v_mfma_f32_16x16x32_bf16 v[200:203], a[32:35], a[104:107], v[200:203]
s_waitcnt lgkmcnt(4)
v_mfma_f32_16x16x32_bf16 v[216:219], a[32:35], a[80:83], v[216:219]
ds_read_b64_tr_b16 a[104:105], v13 offset:17152
s_mov_b32 s9, 0x0
v_mfma_f32_16x16x32_bf16 v[216:219], a[48:51], a[84:87], v[216:219]
buffer_load_dword a120, v18, s[52:55], s9 offen
v_mfma_f32_16x16x32_bf16 v[220:223], a[52:55], a[84:87], v[220:223]
ds_read_b64_tr_b16 a[106:107], v13 offset:18176
v_mfma_f32_16x16x32_bf16 v[220:223], a[36:39], a[80:83], v[220:223]
ds_read_b64_tr_b16 a[108:109], v13 offset:25344
v_mfma_f32_16x16x32_bf16 v[224:227], a[40:43], a[80:83], v[224:227]
ds_read_b64_tr_b16 a[110:111], v13 offset:26368
v_add_u32 v12, 0x8000, v12
v_mfma_f32_16x16x32_bf16 v[224:227], a[56:59], a[84:87], v[224:227]
v_add_u32 v13, 0x8000, v13
v_mfma_f32_16x16x32_bf16 v[228:231], a[60:63], a[84:87], v[228:231]
v_mfma_f32_16x16x32_bf16 v[228:231], a[44:47], a[80:83], v[228:231]
v_mfma_f32_16x16x32_bf16 v[244:247], a[44:47], a[88:91], v[244:247]
s_waitcnt vmcnt(27) lgkmcnt(0)
v_mfma_f32_16x16x32_bf16 v[244:247], a[60:63], a[92:95], v[244:247]
s_barrier
s_add_u32 m0, s17, 0x0
v_mfma_f32_16x16x32_bf16 v[240:243], a[56:59], a[92:95], v[240:243]
buffer_load_dwordx4 v5, s[56:59], 0 offen lds
v_mfma_f32_16x16x32_bf16 v[240:243], a[40:43], a[88:91], v[240:243]
ds_read_b64_tr_b16 a[80:81], v12 offset:0
v_mfma_f32_16x16x32_bf16 v[236:239], a[36:39], a[88:91], v[236:239]
ds_read_b64_tr_b16 a[82:83], v12 offset:1024
v_mfma_f32_16x16x32_bf16 v[236:239], a[52:55], a[92:95], v[236:239]
ds_read_b64_tr_b16 a[84:85], v12 offset:8192
v_mfma_f32_16x16x32_bf16 v[232:235], a[48:51], a[92:95], v[232:235]
ds_read_b64_tr_b16 a[86:87], v12 offset:9216
v_mfma_f32_16x16x32_bf16 v[232:235], a[32:35], a[88:91], v[232:235]
s_waitcnt lgkmcnt(4)
v_mfma_f32_16x16x32_bf16 v[248:251], a[32:35], a[96:99], v[248:251]
ds_read_b64_tr_b16 a[88:89], v13 offset:0
s_add_u32 m0, s17, 0x4000
v_mfma_f32_16x16x32_bf16 v[248:251], a[48:51], a[100:103], v[248:251]
buffer_load_dwordx4 v5, s[60:63], 0 offen lds
v_mfma_f32_16x16x32_bf16 v[252:255], a[52:55], a[100:103], v[252:255]
ds_read_b64_tr_b16 a[90:91], v13 offset:1024
v_mfma_f32_16x16x32_bf16 v[252:255], a[36:39], a[96:99], v[252:255]
ds_read_b64_tr_b16 a[92:93], v13 offset:8192
v_mfma_f32_16x16x32_bf16 a[232:235], a[40:43], a[96:99], a[232:235]
ds_read_b64_tr_b16 a[94:95], v13 offset:9216
v_mfma_f32_16x16x32_bf16 a[232:235], a[56:59], a[100:103], a[232:235]
L_padA2:
s_cmp_eq_u32 s95, 1
s_cbranch_scc1 L_padA6
v_mfma_f32_16x16x32_bf16 a[236:239], a[60:63], a[100:103], a[236:239]
v_mfma_f32_16x16x32_bf16 a[236:239], a[44:47], a[96:99], a[236:239]
s_add_u32 m0, s17, 0x400
v_mfma_f32_16x16x32_bf16 a[252:255], a[44:47], a[104:107], a[252:255]
buffer_load_dwordx4 v5, s[56:59], s13 offen lds
v_mfma_f32_16x16x32_bf16 a[252:255], a[60:63], a[108:111], a[252:255]
ds_read_b64_tr_b16 a[96:97], v12 offset:256
v_mfma_f32_16x16x32_bf16 a[248:251], a[56:59], a[108:111], a[248:251]
ds_read_b64_tr_b16 a[98:99], v12 offset:1280
v_mfma_f32_16x16x32_bf16 a[248:251], a[40:43], a[104:107], a[248:251]
ds_read_b64_tr_b16 a[100:101], v12 offset:8448
v_mfma_f32_16x16x32_bf16 a[244:247], a[36:39], a[104:107], a[244:247]
ds_read_b64_tr_b16 a[102:103], v12 offset:9472
v_mfma_f32_16x16x32_bf16 a[244:247], a[52:55], a[108:111], a[244:247]
v_mfma_f32_16x16x32_bf16 a[240:243], a[48:51], a[108:111], a[240:243]
v_mfma_f32_16x16x32_bf16 a[240:243], a[32:35], a[104:107], a[240:243]
s_add_u32 m0, s17, 0x4400
s_waitcnt lgkmcnt(4)
L_S4:
v_mfma_f32_16x16x32_bf16 v[24:27], a[80:83], a[0:3], v[24:27]
buffer_load_dwordx4 v5, s[60:63], s13 offen lds
v_mfma_f32_16x16x32_bf16 v[24:27], a[84:87], a[16:19], v[24:27]
ds_read_b64_tr_b16 a[104:105], v13 offset:256
s_waitcnt vmcnt(23)
v_mfma_f32_16x16x32_bf16 v[32:35], a[84:87], a[20:23], v[32:35]
ds_read_b64_tr_b16 a[106:107], v13 offset:1280
v_mfma_f32_16x16x32_bf16 v[32:35], a[80:83], a[4:7], v[32:35]
ds_read_b64_tr_b16 a[108:109], v13 offset:8448
v_mfma_f32_16x16x32_bf16 v[40:43], a[80:83], a[8:11], v[40:43]
ds_read_b64_tr_b16 a[110:111], v13 offset:9472
v_mfma_f32_16x16x32_bf16 v[40:43], a[84:87], a[24:27], v[40:43]
ds_read_b128 a[32:35], v8 offset:32768
v_mfma_f32_16x16x32_bf16 v[48:51], a[84:87], a[28:31], v[48:51]
ds_read_b128 a[48:51], v9 offset:32768
s_add_u32 m0, s17, 0x800
v_mfma_f32_16x16x32_bf16 v[48:51], a[80:83], a[12:15], v[48:51]
buffer_load_dwordx4 v6, s[56:59], 0 offen lds
v_mfma_f32_16x16x32_bf16 v[52:55], a[88:91], a[12:15], v[52:55]
ds_read_b64_tr_b16 a[80:81], v12 offset:512
v_mfma_f32_16x16x32_bf16 v[52:55], a[92:95], a[28:31], v[52:55]
ds_read_b64_tr_b16 a[82:83], v12 offset:1536
v_mfma_f32_16x16x32_bf16 v[44:47], a[92:95], a[24:27], v[44:47]
ds_read_b64_tr_b16 a[84:85], v12 offset:8704
v_mfma_f32_16x16x32_bf16 v[44:47], a[88:91], a[8:11], v[44:47]
ds_read_b64_tr_b16 a[86:87], v12 offset:9728
v_mfma_f32_16x16x32_bf16 v[36:39], a[88:91], a[4:7], v[36:39]
ds_read_b128 a[36:39], v8 offset:34816
v_mfma_f32_16x16x32_bf16 v[36:39], a[92:95], a[20:23], v[36:39]
ds_read_b128 a[52:55], v9 offset:34816
s_waitcnt lgkmcnt(8)
v_mfma_f32_16x16x32_bf16 v[28:31], a[92:95], a[16:19], v[28:31]
ds_read_b128 a[40:43], v8 offset:36864
s_add_u32 m0, s17, 0x4800
v_mfma_f32_16x16x32_bf16 v[28:31], a[88:91], a[0:3], v[28:31]
buffer_load_dwordx4 v6, s[60:63], 0 offen lds
v_mfma_f32_16x16x32_bf16 v[56:59], a[96:99], a[0:3], v[56:59]
ds_read_b64_tr_b16 a[88:89], v13 offset:512
v_mfma_f32_16x16x32_bf16 v[56:59], a[100:103], a[16:19], v[56:59]
ds_read_b64_tr_b16 a[90:91], v13 offset:1536
v_mfma_f32_16x16x32_bf16 v[64:67], a[100:103], a[20:23], v[64:67]
ds_read_b64_tr_b16 a[92:93], v13 offset:8704
v_mfma_f32_16x16x32_bf16 v[64:67], a[96:99], a[4:7], v[64:67]
ds_read_b64_tr_b16 a[94:95], v13 offset:9728
v_mfma_f32_16x16x32_bf16 v[72:75], a[96:99], a[8:11], v[72:75]
ds_read_b128 a[56:59], v9 offset:36864
v_mfma_f32_16x16x32_bf16 v[72:75], a[100:103], a[24:27], v[72:75]
ds_read_b128 a[44:47], v8 offset:38912
s_add_u32 m0, s17, 0xc00
v_mfma_f32_16x16x32_bf16 v[80:83], a[100:103], a[28:31], v[80:83]
buffer_load_dwordx4 v6, s[56:59], s13 offen lds
v_mfma_f32_16x16x32_bf16 v[80:83], a[96:99], a[12:15], v[80:83]
ds_read_b128 a[60:63], v9 offset:38912
v_mfma_f32_16x16x32_bf16 v[84:87], a[104:107], a[12:15], v[84:87]
ds_read_b64_tr_b16 a[96:97], v12 offset:768
v_mfma_f32_16x16x32_bf16 v[84:87], a[108:111], a[28:31], v[84:87]
ds_read_b64_tr_b16 a[98:99], v12 offset:1792
v_mfma_f32_16x16x32_bf16 v[76:79], a[108:111], a[24:27], v[76:79]
ds_read_b64_tr_b16 a[100:101], v12 offset:8960
v_mfma_f32_16x16x32_bf16 v[76:79], a[104:107], a[8:11], v[76:79]
ds_read_b64_tr_b16 a[102:103], v12 offset:9984
v_mfma_f32_16x16x32_bf16 v[68:71], a[104:107], a[4:7], v[68:71]
s_add_u32 m0, s17, 0x4c00
v_mfma_f32_16x16x32_bf16 v[68:71], a[108:111], a[20:23], v[68:71]
buffer_load_dwordx4 v6, s[60:63], s13 offen lds
v_mfma_f32_16x16x32_bf16 v[60:63], a[108:111], a[16:19], v[60:63]
v_lshl_add_u32 v5, s42, 19, v5
v_lshl_add_u32 v6, s42, 19, v6
v_mfma_f32_16x16x32_bf16 v[60:63], a[104:107], a[0:3], v[60:63]
s_waitcnt lgkmcnt(7)
v_mfma_f32_16x16x32_bf16 v[88:91], a[80:83], a[0:3], v[88:91]
ds_read_b64_tr_b16 a[104:105], v13 offset:768
v_mfma_f32_16x16x32_bf16 v[88:91], a[84:87], a[16:19], v[88:91]
ds_read_b64_tr_b16 a[106:107], v13 offset:1792
v_mfma_f32_16x16x32_bf16 v[96:99], a[84:87], a[20:23], v[96:99]
ds_read_b64_tr_b16 a[108:109], v13 offset:8960
v_mfma_f32_16x16x32_bf16 v[96:99], a[80:83], a[4:7], v[96:99]
ds_read_b64_tr_b16 a[110:111], v13 offset:9984
v_mfma_f32_16x16x32_bf16 v[104:107], a[80:83], a[8:11], v[104:107]
s_add_u32 m0, s16, 0x8000
s_waitcnt lgkmcnt(8)
v_mfma_f32_16x16x32_bf16 v[104:107], a[84:87], a[24:27], v[104:107]
buffer_load_dwordx4 v2, s[48:51], 0 offen lds
v_mfma_f32_16x16x32_bf16 v[112:115], a[84:87], a[28:31], v[112:115]
v_mfma_f32_16x16x32_bf16 v[112:115], a[80:83], a[12:15], v[112:115]
v_mfma_f32_16x16x32_bf16 v[116:119], a[88:91], a[12:15], v[116:119]
ds_read_b64_tr_b16 a[80:81], v12 offset:16384
v_mfma_f32_16x16x32_bf16 v[116:119], a[92:95], a[28:31], v[116:119]
ds_read_b64_tr_b16 a[82:83], v12 offset:17408
v_mfma_f32_16x16x32_bf16 v[108:111], a[92:95], a[24:27], v[108:111]
ds_read_b64_tr_b16 a[84:85], v12 offset:24576
v_mfma_f32_16x16x32_bf16 v[108:111], a[88:91], a[8:11], v[108:111]
ds_read_b64_tr_b16 a[86:87], v12 offset:25600
s_add_u32 m0, s16, 0x8400
v_mfma_f32_16x16x32_bf16 v[100:103], a[88:91], a[4:7], v[100:103]
buffer_load_dwordx4 v3, s[48:51], 0 offen lds
v_mfma_f32_16x16x32_bf16 v[100:103], a[92:95], a[20:23], v[100:103]
v_mfma_f32_16x16x32_bf16 v[92:95], a[92:95], a[16:19], v[92:95]
v_mfma_f32_16x16x32_bf16 v[92:95], a[88:91], a[0:3], v[92:95]
s_waitcnt lgkmcnt(4)
v_mfma_f32_16x16x32_bf16 v[120:123], a[96:99], a[0:3], v[120:123]
ds_read_b64_tr_b16 a[88:89], v13 offset:16384
v_mfma_f32_16x16x32_bf16 v[120:123], a[100:103], a[16:19], v[120:123]
ds_read_b64_tr_b16 a[90:91], v13 offset:17408
v_mfma_f32_16x16x32_bf16 v[128:131], a[100:103], a[20:23], v[128:131]
ds_read_b64_tr_b16 a[92:93], v13 offset:24576
v_mfma_f32_16x16x32_bf16 v[128:131], a[96:99], a[4:7], v[128:131]
ds_read_b64_tr_b16 a[94:95], v13 offset:25600
s_add_u32 m0, s16, 0x8800
v_mfma_f32_16x16x32_bf16 v[136:139], a[96:99], a[8:11], v[136:139]
buffer_load_dwordx4 v2, s[48:51], s12 offen lds
v_mfma_f32_16x16x32_bf16 v[136:139], a[100:103], a[24:27], v[136:139]
v_mfma_f32_16x16x32_bf16 v[144:147], a[100:103], a[28:31], v[144:147]
v_mfma_f32_16x16x32_bf16 v[144:147], a[96:99], a[12:15], v[144:147]
v_mfma_f32_16x16x32_bf16 v[148:151], a[104:107], a[12:15], v[148:151]
ds_read_b64_tr_b16 a[96:97], v12 offset:16640
v_mfma_f32_16x16x32_bf16 v[148:151], a[108:111], a[28:31], v[148:151]
ds_read_b64_tr_b16 a[98:99], v12 offset:17664
v_mfma_f32_16x16x32_bf16 v[140:143], a[108:111], a[24:27], v[140:143]
ds_read_b64_tr_b16 a[100:101], v12 offset:24832
s_add_u32 m0, s16, 0x8c00
v_mfma_f32_16x16x32_bf16 v[140:143], a[104:107], a[8:11], v[140:143]
buffer_load_dwordx4 v3, s[48:51], s12 offen lds
v_mfma_f32_16x16x32_bf16 v[132:135], a[104:107], a[4:7], v[132:135]
ds_read_b64_tr_b16 a[102:103], v12 offset:25856
v_mfma_f32_16x16x32_bf16 v[132:135], a[108:111], a[20:23], v[132:135]
v_mfma_f32_16x16x32_bf16 v[124:127], a[108:111], a[16:19], v[124:127]
v_mfma_f32_16x16x32_bf16 v[124:127], a[104:107], a[0:3], v[124:127]
s_waitcnt lgkmcnt(4)
v_mfma_f32_16x16x32_bf16 v[152:155], a[0:3], a[80:83], v[152:155]
ds_read_b64_tr_b16 a[104:105], v13 offset:16640
v_mfma_f32_16x16x32_bf16 v[152:155], a[16:19], a[84:87], v[152:155]
ds_read_b64_tr_b16 a[106:107], v13 offset:17664
s_add_u32 m0, s16, 0x9000
v_mfma_f32_16x16x32_bf16 v[156:159], a[20:23], a[84:87], v[156:159]
buffer_load_dwordx4 v2, s[48:51], s13 offen lds
v_mfma_f32_16x16x32_bf16 v[156:159], a[4:7], a[80:83], v[156:159]
ds_read_b64_tr_b16 a[108:109], v13 offset:24832
v_mfma_f32_16x16x32_bf16 v[160:163], a[8:11], a[80:83], v[160:163]
ds_read_b64_tr_b16 a[110:111], v13 offset:25856
v_mfma_f32_16x16x32_bf16 v[160:163], a[24:27], a[84:87], v[160:163]
v_mfma_f32_16x16x32_bf16 v[164:167], a[28:31], a[84:87], v[164:167]
v_mfma_f32_16x16x32_bf16 v[164:167], a[12:15], a[80:83], v[164:167]
v_mfma_f32_16x16x32_bf16 v[180:183], a[12:15], a[88:91], v[180:183]
ds_read_b64_tr_b16 a[80:81], v12 offset:16896
v_mfma_f32_16x16x32_bf16 v[180:183], a[28:31], a[92:95], v[180:183]
ds_read_b64_tr_b16 a[82:83], v12 offset:17920
s_add_u32 m0, s16, 0x9400
v_mfma_f32_16x16x32_bf16 v[176:179], a[24:27], a[92:95], v[176:179]
buffer_load_dwordx4 v3, s[48:51], s13 offen lds
v_mfma_f32_16x16x32_bf16 v[176:179], a[8:11], a[88:91], v[176:179]
ds_read_b64_tr_b16 a[84:85], v12 offset:25088
v_mfma_f32_16x16x32_bf16 v[172:175], a[4:7], a[88:91], v[172:175]
ds_read_b64_tr_b16 a[86:87], v12 offset:26112
v_mfma_f32_16x16x32_bf16 v[172:175], a[20:23], a[92:95], v[172:175]
v_mfma_f32_16x16x32_bf16 v[168:171], a[16:19], a[92:95], v[168:171]
v_mfma_f32_16x16x32_bf16 v[168:171], a[0:3], a[88:91], v[168:171]
s_waitcnt lgkmcnt(4)
v_mfma_f32_16x16x32_bf16 v[184:187], a[0:3], a[96:99], v[184:187]
ds_read_b64_tr_b16 a[88:89], v13 offset:16896
s_add_u32 m0, s16, 0x9800
v_mfma_f32_16x16x32_bf16 v[184:187], a[16:19], a[100:103], v[184:187]
buffer_load_dwordx4 v2, s[48:51], s14 offen lds
v_mfma_f32_16x16x32_bf16 v[188:191], a[20:23], a[100:103], v[188:191]
ds_read_b64_tr_b16 a[90:91], v13 offset:17920
v_mfma_f32_16x16x32_bf16 v[188:191], a[4:7], a[96:99], v[188:191]
ds_read_b64_tr_b16 a[92:93], v13 offset:25088
v_mfma_f32_16x16x32_bf16 v[192:195], a[8:11], a[96:99], v[192:195]
ds_read_b64_tr_b16 a[94:95], v13 offset:26112
v_mfma_f32_16x16x32_bf16 v[192:195], a[24:27], a[100:103], v[192:195]
v_mfma_f32_16x16x32_bf16 v[196:199], a[28:31], a[100:103], v[196:199]
v_mfma_f32_16x16x32_bf16 v[196:199], a[12:15], a[96:99], v[196:199]
v_mfma_f32_16x16x32_bf16 v[212:215], a[12:15], a[104:107], v[212:215]
ds_read_b64_tr_b16 a[96:97], v12 offset:17152
s_add_u32 m0, s16, 0x9c00
v_mfma_f32_16x16x32_bf16 v[212:215], a[28:31], a[108:111], v[212:215]
buffer_load_dwordx4 v3, s[48:51], s14 offen lds
v_mfma_f32_16x16x32_bf16 v[208:211], a[24:27], a[108:111], v[208:211]
ds_read_b64_tr_b16 a[98:99], v12 offset:18176
s_sub_u32 s42, s43, s41
v_mfma_f32_16x16x32_bf16 v[208:211], a[8:11], a[104:107], v[208:211]
ds_read_b64_tr_b16 a[100:101], v12 offset:25344
s_mov_b32 s41, s43
v_mfma_f32_16x16x32_bf16 v[204:207], a[4:7], a[104:107], v[204:207]
ds_read_b64_tr_b16 a[102:103], v12 offset:26368
v_mfma_f32_16x16x32_bf16 v[204:207], a[20:23], a[108:111], v[204:207]
v_mfma_f32_16x16x32_bf16 v[200:203], a[16:19], a[108:111], v[200:203]
v_mfma_f32_16x16x32_bf16 v[200:203], a[0:3], a[104:107], v[200:203]
s_mov_b32 s9, 0x0
s_waitcnt lgkmcnt(4)
v_mfma_f32_16x16x32_bf16 v[216:219], a[0:3], a[80:83], v[216:219]
buffer_load_dword a120, v19, s[68:71], s9 offen
v_mfma_f32_16x16x32_bf16 v[216:219], a[16:19], a[84:87], v[216:219]
ds_read_b64_tr_b16 a[104:105], v13 offset:17152
v_mfma_f32_16x16x32_bf16 v[220:223], a[20:23], a[84:87], v[220:223]
ds_read_b64_tr_b16 a[106:107], v13 offset:18176
v_mfma_f32_16x16x32_bf16 v[220:223], a[4:7], a[80:83], v[220:223]
ds_read_b64_tr_b16 a[108:109], v13 offset:25344
v_mfma_f32_16x16x32_bf16 v[224:227], a[8:11], a[80:83], v[224:227]
ds_read_b64_tr_b16 a[110:111], v13 offset:26368
v_add_u32 v12, 0x8000, v12
v_mfma_f32_16x16x32_bf16 v[224:227], a[24:27], a[84:87], v[224:227]
v_add_u32 v13, 0x8000, v13
v_mfma_f32_16x16x32_bf16 v[228:231], a[28:31], a[84:87], v[228:231]
v_mfma_f32_16x16x32_bf16 v[228:231], a[12:15], a[80:83], v[228:231]
v_mfma_f32_16x16x32_bf16 v[244:247], a[12:15], a[88:91], v[244:247]
s_waitcnt vmcnt(27) lgkmcnt(0)
v_mfma_f32_16x16x32_bf16 v[244:247], a[28:31], a[92:95], v[244:247]
s_barrier
s_add_u32 m0, s17, 0x8000
v_mfma_f32_16x16x32_bf16 v[240:243], a[24:27], a[92:95], v[240:243]
buffer_load_dwordx4 v5, s[56:59], 0 offen lds
v_mfma_f32_16x16x32_bf16 v[240:243], a[8:11], a[88:91], v[240:243]
ds_read_b64_tr_b16 a[80:81], v12 offset:0
v_mfma_f32_16x16x32_bf16 v[236:239], a[4:7], a[88:91], v[236:239]
ds_read_b64_tr_b16 a[82:83], v12 offset:1024
v_mfma_f32_16x16x32_bf16 v[236:239], a[20:23], a[92:95], v[236:239]
ds_read_b64_tr_b16 a[84:85], v12 offset:8192
v_mfma_f32_16x16x32_bf16 v[232:235], a[16:19], a[92:95], v[232:235]
ds_read_b64_tr_b16 a[86:87], v12 offset:9216
v_mfma_f32_16x16x32_bf16 v[232:235], a[0:3], a[88:91], v[232:235]
s_add_u32 m0, s17, 0xc000
s_waitcnt lgkmcnt(4)
v_mfma_f32_16x16x32_bf16 v[248:251], a[0:3], a[96:99], v[248:251]
buffer_load_dwordx4 v5, s[60:63], 0 offen lds
v_mfma_f32_16x16x32_bf16 v[248:251], a[16:19], a[100:103], v[248:251]
ds_read_b64_tr_b16 a[88:89], v13 offset:0
v_mfma_f32_16x16x32_bf16 v[252:255], a[20:23], a[100:103], v[252:255]
ds_read_b64_tr_b16 a[90:91], v13 offset:1024
v_mfma_f32_16x16x32_bf16 v[252:255], a[4:7], a[96:99], v[252:255]
ds_read_b64_tr_b16 a[92:93], v13 offset:8192
v_mfma_f32_16x16x32_bf16 a[232:235], a[8:11], a[96:99], a[232:235]
ds_read_b64_tr_b16 a[94:95], v13 offset:9216
v_mfma_f32_16x16x32_bf16 a[232:235], a[24:27], a[100:103], a[232:235]
v_mfma_f32_16x16x32_bf16 a[236:239], a[28:31], a[100:103], a[236:239]
s_add_u32 m0, s17, 0x8400
v_mfma_f32_16x16x32_bf16 a[236:239], a[12:15], a[96:99], a[236:239]
buffer_load_dwordx4 v5, s[56:59], s13 offen lds
v_mfma_f32_16x16x32_bf16 a[252:255], a[12:15], a[104:107], a[252:255]
ds_read_b64_tr_b16 a[96:97], v12 offset:256
v_mfma_f32_16x16x32_bf16 a[252:255], a[28:31], a[108:111], a[252:255]
ds_read_b64_tr_b16 a[98:99], v12 offset:1280
v_mfma_f32_16x16x32_bf16 a[248:251], a[24:27], a[108:111], a[248:251]
ds_read_b64_tr_b16 a[100:101], v12 offset:8448
v_mfma_f32_16x16x32_bf16 a[248:251], a[8:11], a[104:107], a[248:251]
ds_read_b64_tr_b16 a[102:103], v12 offset:9472
v_mfma_f32_16x16x32_bf16 a[244:247], a[4:7], a[104:107], a[244:247]
s_add_u32 m0, s17, 0xc400
v_mfma_f32_16x16x32_bf16 a[244:247], a[20:23], a[108:111], a[244:247]
buffer_load_dwordx4 v5, s[60:63], s13 offen lds
v_mfma_f32_16x16x32_bf16 a[240:243], a[16:19], a[108:111], a[240:243]
v_mfma_f32_16x16x32_bf16 a[240:243], a[0:3], a[104:107], a[240:243]
s_waitcnt lgkmcnt(4)
L_S5:
v_mfma_f32_16x16x32_bf16 v[24:27], a[80:83], a[32:35], v[24:27]
ds_read_b64_tr_b16 a[104:105], v13 offset:256
s_waitcnt vmcnt(22)
v_mfma_f32_16x16x32_bf16 v[24:27], a[84:87], a[48:51], v[24:27]
ds_read_b64_tr_b16 a[106:107], v13 offset:1280
v_mfma_f32_16x16x32_bf16 v[32:35], a[84:87], a[52:55], v[32:35]
ds_read_b64_tr_b16 a[108:109], v13 offset:8448
v_mfma_f32_16x16x32_bf16 v[32:35], a[80:83], a[36:39], v[32:35]
ds_read_b64_tr_b16 a[110:111], v13 offset:9472
s_add_u32 m0, s17, 0x8800
v_mfma_f32_16x16x32_bf16 v[40:43], a[80:83], a[40:43], v[40:43]
buffer_load_dwordx4 v6, s[56:59], 0 offen lds
v_mfma_f32_16x16x32_bf16 v[40:43], a[84:87], a[56:59], v[40:43]
ds_read_b128 a[0:3], v8 offset:0
v_mfma_f32_16x16x32_bf16 v[48:51], a[84:87], a[60:63], v[48:51]
ds_read_b128 a[16:19], v9 offset:0
v_mfma_f32_16x16x32_bf16 v[48:51], a[80:83], a[44:47], v[48:51]
ds_read_b128 a[4:7], v8 offset:2048
v_mfma_f32_16x16x32_bf16 v[52:55], a[88:91], a[44:47], v[52:55]
ds_read_b64_tr_b16 a[80:81], v12 offset:512
v_mfma_f32_16x16x32_bf16 v[52:55], a[92:95], a[60:63], v[52:55]
ds_read_b64_tr_b16 a[82:83], v12 offset:1536
v_mfma_f32_16x16x32_bf16 v[44:47], a[92:95], a[56:59], v[44:47]
ds_read_b64_tr_b16 a[84:85], v12 offset:8704
s_mov_b32 s9, 0x200000
v_mfma_f32_16x16x32_bf16 v[44:47], a[88:91], a[40:43], v[44:47]
buffer_load_dword a120, v18, s[52:55], s9 offen
v_mfma_f32_16x16x32_bf16 v[36:39], a[88:91], a[36:39], v[36:39]
ds_read_b64_tr_b16 a[86:87], v12 offset:9728
v_mfma_f32_16x16x32_bf16 v[36:39], a[92:95], a[52:55], v[36:39]
ds_read_b128 a[20:23], v9 offset:2048
v_mfma_f32_16x16x32_bf16 v[28:31], a[92:95], a[48:51], v[28:31]
ds_read_b128 a[8:11], v8 offset:4096
v_mfma_f32_16x16x32_bf16 v[28:31], a[88:91], a[32:35], v[28:31]
ds_read_b128 a[24:27], v9 offset:4096
s_waitcnt lgkmcnt(10)
v_mfma_f32_16x16x32_bf16 v[56:59], a[96:99], a[32:35], v[56:59]
ds_read_b64_tr_b16 a[88:89], v13 offset:512
s_add_u32 m0, s17, 0xc800
v_mfma_f32_16x16x32_bf16 v[56:59], a[100:103], a[48:51], v[56:59]
buffer_load_dwordx4 v6, s[60:63], 0 offen lds
v_mfma_f32_16x16x32_bf16 v[64:67], a[100:103], a[52:55], v[64:67]
ds_read_b64_tr_b16 a[90:91], v13 offset:1536
v_mfma_f32_16x16x32_bf16 v[64:67], a[96:99], a[36:39], v[64:67]
ds_read_b64_tr_b16 a[92:93], v13 offset:8704
v_mfma_f32_16x16x32_bf16 v[72:75], a[96:99], a[40:43], v[72:75]
ds_read_b64_tr_b16 a[94:95], v13 offset:9728
v_mfma_f32_16x16x32_bf16 v[72:75], a[100:103], a[56:59], v[72:75]
ds_read_b128 a[12:15], v8 offset:6144
v_mfma_f32_16x16x32_bf16 v[80:83], a[100:103], a[60:63], v[80:83]
ds_read_b128 a[28:31], v9 offset:6144
v_mfma_f32_16x16x32_bf16 v[80:83], a[96:99], a[44:47], v[80:83]
s_add_u32 m0, s17, 0x8c00
v_mfma_f32_16x16x32_bf16 v[84:87], a[104:107], a[44:47], v[84:87]
buffer_load_dwordx4 v6, s[56:59], s13 offen lds
v_mfma_f32_16x16x32_bf16 v[84:87], a[108:111], a[60:63], v[84:87]
ds_read_b64_tr_b16 a[96:97], v12 offset:768
v_mfma_f32_16x16x32_bf16 v[76:79], a[108:111], a[56:59], v[76:79]
ds_read_b64_tr_b16 a[98:99], v12 offset:1792
v_mfma_f32_16x16x32_bf16 v[76:79], a[104:107], a[40:43], v[76:79]
ds_read_b64_tr_b16 a[100:101], v12 offset:8960
v_mfma_f32_16x16x32_bf16 v[68:71], a[104:107], a[36:39], v[68:71]
ds_read_b64_tr_b16 a[102:103], v12 offset:9984
v_mfma_f32_16x16x32_bf16 v[68:71], a[108:111], a[52:55], v[68:71]
v_mfma_f32_16x16x32_bf16 v[60:63], a[108:111], a[48:51], v[60:63]
s_add_u32 m0, s17, 0xcc00
s_waitcnt lgkmcnt(6)
v_mfma_f32_16x16x32_bf16 v[60:63], a[104:107], a[32:35], v[60:63]
buffer_load_dwordx4 v6, s[60:63], s13 offen lds
v_mfma_f32_16x16x32_bf16 v[88:91], a[80:83], a[32:35], v[88:91]
ds_read_b64_tr_b16 a[104:105], v13 offset:768
v_lshl_add_u32 v5, s42, 19, v5
v_mfma_f32_16x16x32_bf16 v[88:91], a[84:87], a[48:51], v[88:91]
ds_read_b64_tr_b16 a[106:107], v13 offset:1792
v_lshl_add_u32 v6, s42, 19, v6
v_mfma_f32_16x16x32_bf16 v[96:99], a[84:87], a[52:55], v[96:99]
ds_read_b64_tr_b16 a[108:109], v13 offset:8960
v_mfma_f32_16x16x32_bf16 v[96:99], a[80:83], a[36:39], v[96:99]
ds_read_b64_tr_b16 a[110:111], v13 offset:9984
v_mfma_f32_16x16x32_bf16 v[104:107], a[80:83], a[40:43], v[104:107]
s_add_u32 m0, s16, 0x0
s_waitcnt lgkmcnt(8)
v_mfma_f32_16x16x32_bf16 v[104:107], a[84:87], a[56:59], v[104:107]
buffer_load_dwordx4 v22, s[44:47], s20 offen lds
v_mfma_f32_16x16x32_bf16 v[112:115], a[84:87], a[60:63], v[112:115]
v_mfma_f32_16x16x32_bf16 v[112:115], a[80:83], a[44:47], v[112:115]
v_mfma_f32_16x16x32_bf16 v[116:119], a[88:91], a[44:47], v[116:119]
ds_read_b64_tr_b16 a[80:81], v12 offset:16384
v_mfma_f32_16x16x32_bf16 v[116:119], a[92:95], a[60:63], v[116:119]
ds_read_b64_tr_b16 a[82:83], v12 offset:17408
v_mfma_f32_16x16x32_bf16 v[108:111], a[92:95], a[56:59], v[108:111]
ds_read_b64_tr_b16 a[84:85], v12 offset:24576
v_mfma_f32_16x16x32_bf16 v[108:111], a[88:91], a[40:43], v[108:111]
ds_read_b64_tr_b16 a[86:87], v12 offset:25600
s_add_u32 m0, s16, 0x400
v_mfma_f32_16x16x32_bf16 v[100:103], a[88:91], a[36:39], v[100:103]
buffer_load_dwordx4 v23, s[44:47], s20 offen lds
v_mfma_f32_16x16x32_bf16 v[100:103], a[92:95], a[52:55], v[100:103]
v_mfma_f32_16x16x32_bf16 v[92:95], a[92:95], a[48:51], v[92:95]
v_mfma_f32_16x16x32_bf16 v[92:95], a[88:91], a[32:35], v[92:95]
s_waitcnt lgkmcnt(4)
v_mfma_f32_16x16x32_bf16 v[120:123], a[96:99], a[32:35], v[120:123]
ds_read_b64_tr_b16 a[88:89], v13 offset:16384
v_mfma_f32_16x16x32_bf16 v[120:123], a[100:103], a[48:51], v[120:123]
ds_read_b64_tr_b16 a[90:91], v13 offset:17408
s_mov_b32 s9, 0x200000
v_mfma_f32_16x16x32_bf16 v[128:131], a[100:103], a[52:55], v[128:131]
buffer_load_dword a120, v19, s[68:71], s9 offen
v_mfma_f32_16x16x32_bf16 v[128:131], a[96:99], a[36:39], v[128:131]
ds_read_b64_tr_b16 a[92:93], v13 offset:24576
v_mfma_f32_16x16x32_bf16 v[136:139], a[96:99], a[40:43], v[136:139]
ds_read_b64_tr_b16 a[94:95], v13 offset:25600
v_mfma_f32_16x16x32_bf16 v[136:139], a[100:103], a[56:59], v[136:139]
v_mfma_f32_16x16x32_bf16 v[144:147], a[100:103], a[60:63], v[144:147]
v_mfma_f32_16x16x32_bf16 v[144:147], a[96:99], a[44:47], v[144:147]
v_mfma_f32_16x16x32_bf16 v[148:151], a[104:107], a[44:47], v[148:151]
ds_read_b64_tr_b16 a[96:97], v12 offset:16640
s_add_u32 m0, s16, 0x800
v_mfma_f32_16x16x32_bf16 v[148:151], a[108:111], a[60:63], v[148:151]
buffer_load_dwordx4 v22, s[44:47], s21 offen lds
v_mfma_f32_16x16x32_bf16 v[140:143], a[108:111], a[56:59], v[140:143]
ds_read_b64_tr_b16 a[98:99], v12 offset:17664
v_mfma_f32_16x16x32_bf16 v[140:143], a[104:107], a[40:43], v[140:143]
ds_read_b64_tr_b16 a[100:101], v12 offset:24832
v_mfma_f32_16x16x32_bf16 v[132:135], a[104:107], a[36:39], v[132:135]
ds_read_b64_tr_b16 a[102:103], v12 offset:25856
v_mfma_f32_16x16x32_bf16 v[132:135], a[108:111], a[52:55], v[132:135]
v_mfma_f32_16x16x32_bf16 v[124:127], a[108:111], a[48:51], v[124:127]
v_mfma_f32_16x16x32_bf16 v[124:127], a[104:107], a[32:35], v[124:127]
s_add_u32 m0, s16, 0xc00
s_waitcnt lgkmcnt(4)
v_mfma_f32_16x16x32_bf16 v[152:155], a[32:35], a[80:83], v[152:155]
buffer_load_dwordx4 v23, s[44:47], s21 offen lds
v_mfma_f32_16x16x32_bf16 v[152:155], a[48:51], a[84:87], v[152:155]
ds_read_b64_tr_b16 a[104:105], v13 offset:16640
v_mfma_f32_16x16x32_bf16 v[156:159], a[52:55], a[84:87], v[156:159]
ds_read_b64_tr_b16 a[106:107], v13 offset:17664
v_mfma_f32_16x16x32_bf16 v[156:159], a[36:39], a[80:83], v[156:159]
ds_read_b64_tr_b16 a[108:109], v13 offset:24832
v_mfma_f32_16x16x32_bf16 v[160:163], a[40:43], a[80:83], v[160:163]
ds_read_b64_tr_b16 a[110:111], v13 offset:25856
v_mfma_f32_16x16x32_bf16 v[160:163], a[56:59], a[84:87], v[160:163]
s_add_u32 m0, s16, 0x1000
v_mfma_f32_16x16x32_bf16 v[164:167], a[60:63], a[84:87], v[164:167]
buffer_load_dwordx4 v22, s[44:47], s22 offen lds
v_mfma_f32_16x16x32_bf16 v[164:167], a[44:47], a[80:83], v[164:167]
v_mfma_f32_16x16x32_bf16 v[180:183], a[44:47], a[88:91], v[180:183]
ds_read_b64_tr_b16 a[80:81], v12 offset:16896
v_mfma_f32_16x16x32_bf16 v[180:183], a[60:63], a[92:95], v[180:183]
ds_read_b64_tr_b16 a[82:83], v12 offset:17920
v_mfma_f32_16x16x32_bf16 v[176:179], a[56:59], a[92:95], v[176:179]
ds_read_b64_tr_b16 a[84:85], v12 offset:25088
v_mfma_f32_16x16x32_bf16 v[176:179], a[40:43], a[88:91], v[176:179]
ds_read_b64_tr_b16 a[86:87], v12 offset:26112
v_mfma_f32_16x16x32_bf16 v[172:175], a[36:39], a[88:91], v[172:175]
s_add_u32 m0, s16, 0x1400
v_mfma_f32_16x16x32_bf16 v[172:175], a[52:55], a[92:95], v[172:175]
buffer_load_dwordx4 v23, s[44:47], s22 offen lds
v_mfma_f32_16x16x32_bf16 v[168:171], a[48:51], a[92:95], v[168:171]
v_mfma_f32_16x16x32_bf16 v[168:171], a[32:35], a[88:91], v[168:171]
s_waitcnt lgkmcnt(4)
v_mfma_f32_16x16x32_bf16 v[184:187], a[32:35], a[96:99], v[184:187]
ds_read_b64_tr_b16 a[88:89], v13 offset:16896
v_mfma_f32_16x16x32_bf16 v[184:187], a[48:51], a[100:103], v[184:187]
ds_read_b64_tr_b16 a[90:91], v13 offset:17920
v_mfma_f32_16x16x32_bf16 v[188:191], a[52:55], a[100:103], v[188:191]
ds_read_b64_tr_b16 a[92:93], v13 offset:25088
v_mfma_f32_16x16x32_bf16 v[188:191], a[36:39], a[96:99], v[188:191]
ds_read_b64_tr_b16 a[94:95], v13 offset:26112
s_add_u32 m0, s16, 0x1800
v_mfma_f32_16x16x32_bf16 v[192:195], a[40:43], a[96:99], v[192:195]
buffer_load_dwordx4 v22, s[44:47], s23 offen lds
v_mfma_f32_16x16x32_bf16 v[192:195], a[56:59], a[100:103], v[192:195]
v_mfma_f32_16x16x32_bf16 v[196:199], a[60:63], a[100:103], v[196:199]
v_mfma_f32_16x16x32_bf16 v[196:199], a[44:47], a[96:99], v[196:199]
v_mfma_f32_16x16x32_bf16 v[212:215], a[44:47], a[104:107], v[212:215]
ds_read_b64_tr_b16 a[96:97], v12 offset:17152
v_mfma_f32_16x16x32_bf16 v[212:215], a[60:63], a[108:111], v[212:215]
ds_read_b64_tr_b16 a[98:99], v12 offset:18176
s_add_u32 m0, s16, 0x1c00
v_mfma_f32_16x16x32_bf16 v[208:211], a[56:59], a[108:111], v[208:211]
buffer_load_dwordx4 v23, s[44:47], s23 offen lds
v_mfma_f32_16x16x32_bf16 v[208:211], a[40:43], a[104:107], v[208:211]
ds_read_b64_tr_b16 a[100:101], v12 offset:25344
s_mov_b32 s42, 1
v_mfma_f32_16x16x32_bf16 v[204:207], a[36:39], a[104:107], v[204:207]
ds_read_b64_tr_b16 a[102:103], v12 offset:26368
v_lshl_add_u32 v22, s42, 7, v22
v_mfma_f32_16x16x32_bf16 v[204:207], a[52:55], a[108:111], v[204:207]
v_lshl_add_u32 v23, s42, 7, v23
v_mfma_f32_16x16x32_bf16 v[200:203], a[48:51], a[108:111], v[200:203]
v_mfma_f32_16x16x32_bf16 v[200:203], a[32:35], a[104:107], v[200:203]
s_waitcnt lgkmcnt(4)
v_mov_b32 v21, s1
v_mfma_f32_16x16x32_bf16 v[216:219], a[32:35], a[80:83], v[216:219]
ds_read_b64_tr_b16 a[104:105], v13 offset:17152
v_add_u32 v20, s0, v16
v_mfma_f32_16x16x32_bf16 v[216:219], a[48:51], a[84:87], v[216:219]
global_load_dword a120, v[20:21], off sc1
v_mfma_f32_16x16x32_bf16 v[220:223], a[52:55], a[84:87], v[220:223]
ds_read_b64_tr_b16 a[106:107], v13 offset:18176
v_mfma_f32_16x16x32_bf16 v[220:223], a[36:39], a[80:83], v[220:223]
ds_read_b64_tr_b16 a[108:109], v13 offset:25344
v_mfma_f32_16x16x32_bf16 v[224:227], a[40:43], a[80:83], v[224:227]
ds_read_b64_tr_b16 a[110:111], v13 offset:26368
v_add_u32 v12, 0xffff0000, v12
v_mfma_f32_16x16x32_bf16 v[224:227], a[56:59], a[84:87], v[224:227]
v_add_u32 v13, 0xffff0000, v13
v_mfma_f32_16x16x32_bf16 v[228:231], a[60:63], a[84:87], v[228:231]
v_mfma_f32_16x16x32_bf16 v[228:231], a[44:47], a[80:83], v[228:231]
v_mfma_f32_16x16x32_bf16 v[244:247], a[44:47], a[88:91], v[244:247]
s_waitcnt vmcnt(28) lgkmcnt(0)
v_mfma_f32_16x16x32_bf16 v[244:247], a[60:63], a[92:95], v[244:247]
s_barrier
s_add_u32 m0, s17, 0x10000
v_mfma_f32_16x16x32_bf16 v[240:243], a[56:59], a[92:95], v[240:243]
buffer_load_dwordx4 v5, s[52:55], 0 offen lds
v_mfma_f32_16x16x32_bf16 v[240:243], a[40:43], a[88:91], v[240:243]
ds_read_b64_tr_b16 a[80:81], v12 offset:0
s_mul_i32 s28, s5, 0x10c400
v_mfma_f32_16x16x32_bf16 v[236:239], a[36:39], a[88:91], v[236:239]
ds_read_b64_tr_b16 a[82:83], v12 offset:1024
s_mov_b32 s48, s88
v_mfma_f32_16x16x32_bf16 v[236:239], a[52:55], a[92:95], v[236:239]
ds_read_b64_tr_b16 a[84:85], v12 offset:8192
s_mov_b32 s49, s89
v_mfma_f32_16x16x32_bf16 v[232:235], a[48:51], a[92:95], v[232:235]
ds_read_b64_tr_b16 a[86:87], v12 offset:9216
s_sub_u32 s11, 16, s6
v_mfma_f32_16x16x32_bf16 v[232:235], a[32:35], a[88:91], v[232:235]
s_waitcnt lgkmcnt(4)
s_lshl_b32 s11, s11, 16
s_add_u32 s11, s11, s28
v_mfma_f32_16x16x32_bf16 v[248:251], a[32:35], a[96:99], v[248:251]
ds_read_b64_tr_b16 a[88:89], v13 offset:0
s_add_u32 m0, s17, 0x10400
v_mfma_f32_16x16x32_bf16 v[248:251], a[48:51], a[100:103], v[248:251]
buffer_load_dwordx4 v5, s[52:55], s13 offen lds
v_mfma_f32_16x16x32_bf16 v[252:255], a[52:55], a[100:103], v[252:255]
ds_read_b64_tr_b16 a[90:91], v13 offset:1024
s_add_u32 s50, s11, 0x2000
v_mfma_f32_16x16x32_bf16 v[252:255], a[36:39], a[96:99], v[252:255]
ds_read_b64_tr_b16 a[92:93], v13 offset:8192
s_lshl_b32 s11, s6, 17
v_mfma_f32_16x16x32_bf16 a[232:235], a[40:43], a[96:99], a[232:235]
ds_read_b64_tr_b16 a[94:95], v13 offset:9216
s_add_u32 s28, s28, s11
v_mfma_f32_16x16x32_bf16 a[232:235], a[56:59], a[100:103], a[232:235]
s_lshl_b32 s11, s4, 15
s_add_u32 s28, s28, s11
s_lshl_b32 s10, s5, 2
v_mfma_f32_16x16x32_bf16 a[236:239], a[60:63], a[100:103], a[236:239]
s_add_u32 s10, s10, 64
v_mfma_f32_16x16x32_bf16 a[236:239], a[44:47], a[96:99], a[236:239]
s_add_u32 m0, s17, 0x10800
L_padA3:
s_cmp_eq_u32 s95, 1
s_cbranch_scc1 L_padA7
v_mfma_f32_16x16x32_bf16 a[252:255], a[44:47], a[104:107], a[252:255]
buffer_load_dwordx4 v6, s[52:55], 0 offen lds
v_mfma_f32_16x16x32_bf16 a[252:255], a[60:63], a[108:111], a[252:255]
ds_read_b64_tr_b16 a[96:97], v12 offset:256
v_mfma_f32_16x16x32_bf16 a[248:251], a[56:59], a[108:111], a[248:251]
ds_read_b64_tr_b16 a[98:99], v12 offset:1280
v_mfma_f32_16x16x32_bf16 a[248:251], a[40:43], a[104:107], a[248:251]
ds_read_b64_tr_b16 a[100:101], v12 offset:8448
v_mfma_f32_16x16x32_bf16 a[244:247], a[36:39], a[104:107], a[244:247]
ds_read_b64_tr_b16 a[102:103], v12 offset:9472
v_mfma_f32_16x16x32_bf16 a[244:247], a[52:55], a[108:111], a[244:247]
v_mfma_f32_16x16x32_bf16 a[240:243], a[48:51], a[108:111], a[240:243]
v_mfma_f32_16x16x32_bf16 a[240:243], a[32:35], a[104:107], a[240:243]
s_add_u32 m0, s17, 0x10c00
s_waitcnt lgkmcnt(4)
L_S6:
v_mfma_f32_16x16x32_bf16 v[24:27], a[80:83], a[0:3], v[24:27]
buffer_load_dwordx4 v6, s[52:55], s13 offen lds
v_mfma_f32_16x16x32_bf16 v[24:27], a[84:87], a[16:19], v[24:27]
ds_read_b64_tr_b16 a[104:105], v13 offset:256
s_waitcnt vmcnt(24)
v_mfma_f32_16x16x32_bf16 v[32:35], a[84:87], a[20:23], v[32:35]
ds_read_b64_tr_b16 a[106:107], v13 offset:1280
v_mfma_f32_16x16x32_bf16 v[32:35], a[80:83], a[4:7], v[32:35]
ds_read_b64_tr_b16 a[108:109], v13 offset:8448
v_mfma_f32_16x16x32_bf16 v[40:43], a[80:83], a[8:11], v[40:43]
ds_read_b64_tr_b16 a[110:111], v13 offset:9472
v_mfma_f32_16x16x32_bf16 v[40:43], a[84:87], a[24:27], v[40:43]
ds_read_b128 a[32:35], v8 offset:32768
v_mfma_f32_16x16x32_bf16 v[48:51], a[84:87], a[28:31], v[48:51]
ds_read_b128 a[48:51], v9 offset:32768
s_add_u32 m0, s18, 0x14000
v_mfma_f32_16x16x32_bf16 v[48:51], a[80:83], a[12:15], v[48:51]
buffer_load_dwordx4 v7, s[68:71], 0 offen lds
v_mfma_f32_16x16x32_bf16 v[52:55], a[88:91], a[12:15], v[52:55]
ds_read_b64_tr_b16 a[80:81], v12 offset:512
v_mfma_f32_16x16x32_bf16 v[52:55], a[92:95], a[28:31], v[52:55]
ds_read_b64_tr_b16 a[82:83], v12 offset:1536
v_mfma_f32_16x16x32_bf16 v[44:47], a[92:95], a[24:27], v[44:47]
ds_read_b64_tr_b16 a[84:85], v12 offset:8704
v_mfma_f32_16x16x32_bf16 v[44:47], a[88:91], a[8:11], v[44:47]
ds_read_b64_tr_b16 a[86:87], v12 offset:9728
v_mfma_f32_16x16x32_bf16 v[36:39], a[88:91], a[4:7], v[36:39]
ds_read_b128 a[36:39], v8 offset:34816
v_mfma_f32_16x16x32_bf16 v[36:39], a[92:95], a[20:23], v[36:39]
ds_read_b128 a[52:55], v9 offset:34816
s_waitcnt lgkmcnt(8)
v_mfma_f32_16x16x32_bf16 v[28:31], a[92:95], a[16:19], v[28:31]
ds_read_b128 a[40:43], v8 offset:36864
s_add_u32 m0, s18, 0x15000
v_mfma_f32_16x16x32_bf16 v[28:31], a[88:91], a[0:3], v[28:31]
buffer_load_dwordx4 v7, s[68:71], s25 offen lds
v_mfma_f32_16x16x32_bf16 v[56:59], a[96:99], a[0:3], v[56:59]
ds_read_b64_tr_b16 a[88:89], v13 offset:512
v_mfma_f32_16x16x32_bf16 v[56:59], a[100:103], a[16:19], v[56:59]
ds_read_b64_tr_b16 a[90:91], v13 offset:1536
v_mfma_f32_16x16x32_bf16 v[64:67], a[100:103], a[20:23], v[64:67]
ds_read_b64_tr_b16 a[92:93], v13 offset:8704
v_mfma_f32_16x16x32_bf16 v[64:67], a[96:99], a[4:7], v[64:67]
ds_read_b64_tr_b16 a[94:95], v13 offset:9728
v_mfma_f32_16x16x32_bf16 v[72:75], a[96:99], a[8:11], v[72:75]
ds_read_b128 a[56:59], v9 offset:36864
v_mfma_f32_16x16x32_bf16 v[72:75], a[100:103], a[24:27], v[72:75]
ds_read_b128 a[44:47], v8 offset:38912
s_add_u32 m0, s18, 0x16000
v_mfma_f32_16x16x32_bf16 v[80:83], a[100:103], a[28:31], v[80:83]
buffer_load_dwordx4 v7, s[68:71], s26 offen lds
v_mfma_f32_16x16x32_bf16 v[80:83], a[96:99], a[12:15], v[80:83]
ds_read_b128 a[60:63], v9 offset:38912
v_lshl_add_u32 v5, s42, 19, v5
v_mfma_f32_16x16x32_bf16 v[84:87], a[104:107], a[12:15], v[84:87]
ds_read_b64_tr_b16 a[96:97], v12 offset:768
v_lshl_add_u32 v6, s42, 19, v6
v_mfma_f32_16x16x32_bf16 v[84:87], a[108:111], a[28:31], v[84:87]
ds_read_b64_tr_b16 a[98:99], v12 offset:1792
v_lshl_add_u32 v7, s42, 18, v7
v_mfma_f32_16x16x32_bf16 v[76:79], a[108:111], a[24:27], v[76:79]
ds_read_b64_tr_b16 a[100:101], v12 offset:8960
v_lshl_add_u32 v7, s42, 17, v7
v_mfma_f32_16x16x32_bf16 v[76:79], a[104:107], a[8:11], v[76:79]
ds_read_b64_tr_b16 a[102:103], v12 offset:9984
v_mfma_f32_16x16x32_bf16 v[68:71], a[104:107], a[4:7], v[68:71]
v_mfma_f32_16x16x32_bf16 v[68:71], a[108:111], a[20:23], v[68:71]
buffer_store_dwordx4 a[64:67], v4, s[88:91], 0 offen sc1
v_mfma_f32_16x16x32_bf16 v[60:63], a[108:111], a[16:19], v[60:63]
v_mfma_f32_16x16x32_bf16 v[60:63], a[104:107], a[0:3], v[60:63]
s_waitcnt lgkmcnt(7)
v_mfma_f32_16x16x32_bf16 v[88:91], a[80:83], a[0:3], v[88:91]
ds_read_b64_tr_b16 a[104:105], v13 offset:768
v_mfma_f32_16x16x32_bf16 v[88:91], a[84:87], a[16:19], v[88:91]
ds_read_b64_tr_b16 a[106:107], v13 offset:1792
v_mfma_f32_16x16x32_bf16 v[96:99], a[84:87], a[20:23], v[96:99]
ds_read_b64_tr_b16 a[108:109], v13 offset:8960
v_mfma_f32_16x16x32_bf16 v[96:99], a[80:83], a[4:7], v[96:99]
ds_read_b64_tr_b16 a[110:111], v13 offset:9984
v_mfma_f32_16x16x32_bf16 v[104:107], a[80:83], a[8:11], v[104:107]
s_add_u32 m0, s16, 0x8000
s_waitcnt lgkmcnt(8)
v_mfma_f32_16x16x32_bf16 v[104:107], a[84:87], a[24:27], v[104:107]
buffer_load_dwordx4 v22, s[44:47], s20 offen lds
v_mfma_f32_16x16x32_bf16 v[112:115], a[84:87], a[28:31], v[112:115]
v_mfma_f32_16x16x32_bf16 v[112:115], a[80:83], a[12:15], v[112:115]
v_mfma_f32_16x16x32_bf16 v[116:119], a[88:91], a[12:15], v[116:119]
ds_read_b64_tr_b16 a[80:81], v12 offset:16384
v_mfma_f32_16x16x32_bf16 v[116:119], a[92:95], a[28:31], v[116:119]
ds_read_b64_tr_b16 a[82:83], v12 offset:17408
v_mfma_f32_16x16x32_bf16 v[108:111], a[92:95], a[24:27], v[108:111]
ds_read_b64_tr_b16 a[84:85], v12 offset:24576
v_mfma_f32_16x16x32_bf16 v[108:111], a[88:91], a[8:11], v[108:111]
ds_read_b64_tr_b16 a[86:87], v12 offset:25600
s_add_u32 m0, s16, 0x8400
v_mfma_f32_16x16x32_bf16 v[100:103], a[88:91], a[4:7], v[100:103]
buffer_load_dwordx4 v23, s[44:47], s20 offen lds
v_mfma_f32_16x16x32_bf16 v[100:103], a[92:95], a[20:23], v[100:103]
v_mfma_f32_16x16x32_bf16 v[92:95], a[92:95], a[16:19], v[92:95]
v_mfma_f32_16x16x32_bf16 v[92:95], a[88:91], a[0:3], v[92:95]
s_waitcnt lgkmcnt(4)
v_mfma_f32_16x16x32_bf16 v[120:123], a[96:99], a[0:3], v[120:123]
ds_read_b64_tr_b16 a[88:89], v13 offset:16384
v_mfma_f32_16x16x32_bf16 v[120:123], a[100:103], a[16:19], v[120:123]
ds_read_b64_tr_b16 a[90:91], v13 offset:17408
v_mfma_f32_16x16x32_bf16 v[128:131], a[100:103], a[20:23], v[128:131]
ds_read_b64_tr_b16 a[92:93], v13 offset:24576
v_mfma_f32_16x16x32_bf16 v[128:131], a[96:99], a[4:7], v[128:131]
ds_read_b64_tr_b16 a[94:95], v13 offset:25600
s_add_u32 m0, s16, 0x8800
v_mfma_f32_16x16x32_bf16 v[136:139], a[96:99], a[8:11], v[136:139]
buffer_load_dwordx4 v22, s[44:47], s21 offen lds
v_mfma_f32_16x16x32_bf16 v[136:139], a[100:103], a[24:27], v[136:139]
v_mfma_f32_16x16x32_bf16 v[144:147], a[100:103], a[28:31], v[144:147]
v_mfma_f32_16x16x32_bf16 v[144:147], a[96:99], a[12:15], v[144:147]
v_mfma_f32_16x16x32_bf16 v[148:151], a[104:107], a[12:15], v[148:151]
ds_read_b64_tr_b16 a[96:97], v12 offset:16640
v_mfma_f32_16x16x32_bf16 v[148:151], a[108:111], a[28:31], v[148:151]
ds_read_b64_tr_b16 a[98:99], v12 offset:17664
v_mfma_f32_16x16x32_bf16 v[140:143], a[108:111], a[24:27], v[140:143]
ds_read_b64_tr_b16 a[100:101], v12 offset:24832
s_add_u32 m0, s16, 0x8c00
v_mfma_f32_16x16x32_bf16 v[140:143], a[104:107], a[8:11], v[140:143]
buffer_load_dwordx4 v23, s[44:47], s21 offen lds
v_mfma_f32_16x16x32_bf16 v[132:135], a[104:107], a[4:7], v[132:135]
ds_read_b64_tr_b16 a[102:103], v12 offset:25856
v_mfma_f32_16x16x32_bf16 v[132:135], a[108:111], a[20:23], v[132:135]
v_mfma_f32_16x16x32_bf16 v[124:127], a[108:111], a[16:19], v[124:127]
v_mfma_f32_16x16x32_bf16 v[124:127], a[104:107], a[0:3], v[124:127]
s_waitcnt lgkmcnt(4)
v_mfma_f32_16x16x32_bf16 v[152:155], a[0:3], a[80:83], v[152:155]
ds_read_b64_tr_b16 a[104:105], v13 offset:16640
v_mfma_f32_16x16x32_bf16 v[152:155], a[16:19], a[84:87], v[152:155]
ds_read_b64_tr_b16 a[106:107], v13 offset:17664
s_add_u32 m0, s16, 0x9000
v_mfma_f32_16x16x32_bf16 v[156:159], a[20:23], a[84:87], v[156:159]
buffer_load_dwordx4 v22, s[44:47], s22 offen lds
v_mfma_f32_16x16x32_bf16 v[156:159], a[4:7], a[80:83], v[156:159]
ds_read_b64_tr_b16 a[108:109], v13 offset:24832
v_mfma_f32_16x16x32_bf16 v[160:163], a[8:11], a[80:83], v[160:163]
ds_read_b64_tr_b16 a[110:111], v13 offset:25856
v_mfma_f32_16x16x32_bf16 v[160:163], a[24:27], a[84:87], v[160:163]
v_mfma_f32_16x16x32_bf16 v[164:167], a[28:31], a[84:87], v[164:167]
v_mfma_f32_16x16x32_bf16 v[164:167], a[12:15], a[80:83], v[164:167]
v_mfma_f32_16x16x32_bf16 v[180:183], a[12:15], a[88:91], v[180:183]
ds_read_b64_tr_b16 a[80:81], v12 offset:16896
v_mfma_f32_16x16x32_bf16 v[180:183], a[28:31], a[92:95], v[180:183]
ds_read_b64_tr_b16 a[82:83], v12 offset:17920
s_add_u32 m0, s16, 0x9400
v_mfma_f32_16x16x32_bf16 v[176:179], a[24:27], a[92:95], v[176:179]
buffer_load_dwordx4 v23, s[44:47], s22 offen lds
v_mfma_f32_16x16x32_bf16 v[176:179], a[8:11], a[88:91], v[176:179]
ds_read_b64_tr_b16 a[84:85], v12 offset:25088
v_mfma_f32_16x16x32_bf16 v[172:175], a[4:7], a[88:91], v[172:175]
ds_read_b64_tr_b16 a[86:87], v12 offset:26112
v_mfma_f32_16x16x32_bf16 v[172:175], a[20:23], a[92:95], v[172:175]
v_mfma_f32_16x16x32_bf16 v[168:171], a[16:19], a[92:95], v[168:171]
v_mfma_f32_16x16x32_bf16 v[168:171], a[0:3], a[88:91], v[168:171]
s_waitcnt lgkmcnt(4)
v_mfma_f32_16x16x32_bf16 v[184:187], a[0:3], a[96:99], v[184:187]
ds_read_b64_tr_b16 a[88:89], v13 offset:16896
s_add_u32 m0, s16, 0x9800
v_mfma_f32_16x16x32_bf16 v[184:187], a[16:19], a[100:103], v[184:187]
buffer_load_dwordx4 v22, s[44:47], s23 offen lds
v_mfma_f32_16x16x32_bf16 v[188:191], a[20:23], a[100:103], v[188:191]
ds_read_b64_tr_b16 a[90:91], v13 offset:17920
v_mfma_f32_16x16x32_bf16 v[188:191], a[4:7], a[96:99], v[188:191]
ds_read_b64_tr_b16 a[92:93], v13 offset:25088
v_mfma_f32_16x16x32_bf16 v[192:195], a[8:11], a[96:99], v[192:195]
ds_read_b64_tr_b16 a[94:95], v13 offset:26112
v_mfma_f32_16x16x32_bf16 v[192:195], a[24:27], a[100:103], v[192:195]
v_mfma_f32_16x16x32_bf16 v[196:199], a[28:31], a[100:103], v[196:199]
v_mfma_f32_16x16x32_bf16 v[196:199], a[12:15], a[96:99], v[196:199]
v_mfma_f32_16x16x32_bf16 v[212:215], a[12:15], a[104:107], v[212:215]
ds_read_b64_tr_b16 a[96:97], v12 offset:17152
s_add_u32 m0, s16, 0x9c00
v_mfma_f32_16x16x32_bf16 v[212:215], a[28:31], a[108:111], v[212:215]
buffer_load_dwordx4 v23, s[44:47], s23 offen lds
v_mfma_f32_16x16x32_bf16 v[208:211], a[24:27], a[108:111], v[208:211]
ds_read_b64_tr_b16 a[98:99], v12 offset:18176
v_lshl_add_u32 v22, s42, 7, v22
v_mfma_f32_16x16x32_bf16 v[208:211], a[8:11], a[104:107], v[208:211]
ds_read_b64_tr_b16 a[100:101], v12 offset:25344
v_lshl_add_u32 v23, s42, 7, v23
v_mfma_f32_16x16x32_bf16 v[204:207], a[4:7], a[104:107], v[204:207]
ds_read_b64_tr_b16 a[102:103], v12 offset:26368
v_mfma_f32_16x16x32_bf16 v[204:207], a[20:23], a[108:111], v[204:207]
v_mfma_f32_16x16x32_bf16 v[200:203], a[16:19], a[108:111], v[200:203]
v_mfma_f32_16x16x32_bf16 v[200:203], a[0:3], a[104:107], v[200:203]
s_mov_b32 s9, 0x400000
s_waitcnt lgkmcnt(4)
v_mfma_f32_16x16x32_bf16 v[216:219], a[0:3], a[80:83], v[216:219]
buffer_load_dword a120, v18, s[52:55], s9 offen
v_mfma_f32_16x16x32_bf16 v[216:219], a[16:19], a[84:87], v[216:219]
ds_read_b64_tr_b16 a[104:105], v13 offset:17152
v_mfma_f32_16x16x32_bf16 v[220:223], a[20:23], a[84:87], v[220:223]
ds_read_b64_tr_b16 a[106:107], v13 offset:18176
v_mfma_f32_16x16x32_bf16 v[220:223], a[4:7], a[80:83], v[220:223]
ds_read_b64_tr_b16 a[108:109], v13 offset:25344
v_mfma_f32_16x16x32_bf16 v[224:227], a[8:11], a[80:83], v[224:227]
ds_read_b64_tr_b16 a[110:111], v13 offset:26368
v_add_u32 v12, 0x8000, v12
v_mfma_f32_16x16x32_bf16 v[224:227], a[24:27], a[84:87], v[224:227]
v_add_u32 v13, 0x8000, v13
v_mfma_f32_16x16x32_bf16 v[228:231], a[28:31], a[84:87], v[228:231]
v_mfma_f32_16x16x32_bf16 v[228:231], a[12:15], a[80:83], v[228:231]
v_mfma_f32_16x16x32_bf16 v[244:247], a[12:15], a[88:91], v[244:247]
s_waitcnt vmcnt(27) lgkmcnt(0)
v_mfma_f32_16x16x32_bf16 v[244:247], a[28:31], a[92:95], v[244:247]
s_barrier
s_add_u32 m0, s17, 0x0
v_mfma_f32_16x16x32_bf16 v[240:243], a[24:27], a[92:95], v[240:243]
buffer_load_dwordx4 v5, s[52:55], 0 offen lds
v_mfma_f32_16x16x32_bf16 v[240:243], a[8:11], a[88:91], v[240:243]
ds_read_b64_tr_b16 a[80:81], v12 offset:0
v_mfma_f32_16x16x32_bf16 v[236:239], a[4:7], a[88:91], v[236:239]
ds_read_b64_tr_b16 a[82:83], v12 offset:1024
v_mfma_f32_16x16x32_bf16 v[236:239], a[20:23], a[92:95], v[236:239]
ds_read_b64_tr_b16 a[84:85], v12 offset:8192
v_mfma_f32_16x16x32_bf16 v[232:235], a[16:19], a[92:95], v[232:235]
ds_read_b64_tr_b16 a[86:87], v12 offset:9216
v_mfma_f32_16x16x32_bf16 v[232:235], a[0:3], a[88:91], v[232:235]
s_waitcnt lgkmcnt(4)
v_mfma_f32_16x16x32_bf16 v[248:251], a[0:3], a[96:99], v[248:251]
ds_read_b64_tr_b16 a[88:89], v13 offset:0
s_add_u32 m0, s17, 0x400
v_mfma_f32_16x16x32_bf16 v[248:251], a[16:19], a[100:103], v[248:251]
buffer_load_dwordx4 v5, s[52:55], s13 offen lds
v_mfma_f32_16x16x32_bf16 v[252:255], a[20:23], a[100:103], v[252:255]
ds_read_b64_tr_b16 a[90:91], v13 offset:1024
v_mfma_f32_16x16x32_bf16 v[252:255], a[4:7], a[96:99], v[252:255]
ds_read_b64_tr_b16 a[92:93], v13 offset:8192
v_mfma_f32_16x16x32_bf16 a[232:235], a[8:11], a[96:99], a[232:235]
ds_read_b64_tr_b16 a[94:95], v13 offset:9216
v_mfma_f32_16x16x32_bf16 a[232:235], a[24:27], a[100:103], a[232:235]
v_mfma_f32_16x16x32_bf16 a[236:239], a[28:31], a[100:103], a[236:239]
v_mfma_f32_16x16x32_bf16 a[236:239], a[12:15], a[96:99], a[236:239]
s_add_u32 m0, s17, 0x800
v_mfma_f32_16x16x32_bf16 a[252:255], a[12:15], a[104:107], a[252:255]
buffer_load_dwordx4 v6, s[52:55], 0 offen lds
v_mfma_f32_16x16x32_bf16 a[252:255], a[28:31], a[108:111], a[252:255]
ds_read_b64_tr_b16 a[96:97], v12 offset:256
v_mfma_f32_16x16x32_bf16 a[248:251], a[24:27], a[108:111], a[248:251]
ds_read_b64_tr_b16 a[98:99], v12 offset:1280
v_mfma_f32_16x16x32_bf16 a[248:251], a[8:11], a[104:107], a[248:251]
ds_read_b64_tr_b16 a[100:101], v12 offset:8448
v_mfma_f32_16x16x32_bf16 a[244:247], a[4:7], a[104:107], a[244:247]
ds_read_b64_tr_b16 a[102:103], v12 offset:9472
v_mfma_f32_16x16x32_bf16 a[244:247], a[20:23], a[108:111], a[244:247]
v_mfma_f32_16x16x32_bf16 a[240:243], a[16:19], a[108:111], a[240:243]
v_mfma_f32_16x16x32_bf16 a[240:243], a[0:3], a[104:107], a[240:243]
s_add_u32 m0, s17, 0xc00
s_waitcnt lgkmcnt(4)
L_S7:
v_mfma_f32_16x16x32_bf16 v[24:27], a[80:83], a[32:35], v[24:27]
buffer_load_dwordx4 v6, s[52:55], s13 offen lds
v_mfma_f32_16x16x32_bf16 v[24:27], a[84:87], a[48:51], v[24:27]
ds_read_b64_tr_b16 a[104:105], v13 offset:256
s_waitcnt vmcnt(22)
v_mfma_f32_16x16x32_bf16 v[32:35], a[84:87], a[52:55], v[32:35]
ds_read_b64_tr_b16 a[106:107], v13 offset:1280
v_mfma_f32_16x16x32_bf16 v[32:35], a[80:83], a[36:39], v[32:35]
ds_read_b64_tr_b16 a[108:109], v13 offset:8448
v_mfma_f32_16x16x32_bf16 v[40:43], a[80:83], a[40:43], v[40:43]
ds_read_b64_tr_b16 a[110:111], v13 offset:9472
v_mfma_f32_16x16x32_bf16 v[40:43], a[84:87], a[56:59], v[40:43]
ds_read_b128 a[0:3], v8 offset:0
v_mfma_f32_16x16x32_bf16 v[48:51], a[84:87], a[60:63], v[48:51]
ds_read_b128 a[16:19], v9 offset:0
s_add_u32 m0, s18, 0x4000
v_mfma_f32_16x16x32_bf16 v[48:51], a[80:83], a[44:47], v[48:51]
buffer_load_dwordx4 v7, s[68:71], 0 offen lds
v_mfma_f32_16x16x32_bf16 v[52:55], a[88:91], a[44:47], v[52:55]
ds_read_b64_tr_b16 a[80:81], v12 offset:512
v_mfma_f32_16x16x32_bf16 v[52:55], a[92:95], a[60:63], v[52:55]
ds_read_b64_tr_b16 a[82:83], v12 offset:1536
v_mfma_f32_16x16x32_bf16 v[44:47], a[92:95], a[56:59], v[44:47]
ds_read_b64_tr_b16 a[84:85], v12 offset:8704
v_mfma_f32_16x16x32_bf16 v[44:47], a[88:91], a[40:43], v[44:47]
ds_read_b64_tr_b16 a[86:87], v12 offset:9728
v_mfma_f32_16x16x32_bf16 v[36:39], a[88:91], a[36:39], v[36:39]
ds_read_b128 a[4:7], v8 offset:2048
v_mfma_f32_16x16x32_bf16 v[36:39], a[92:95], a[52:55], v[36:39]
ds_read_b128 a[20:23], v9 offset:2048
s_waitcnt lgkmcnt(8)
v_mfma_f32_16x16x32_bf16 v[28:31], a[92:95], a[48:51], v[28:31]
ds_read_b128 a[8:11], v8 offset:4096
s_add_u32 m0, s18, 0x5000
v_mfma_f32_16x16x32_bf16 v[28:31], a[88:91], a[32:35], v[28:31]
buffer_load_dwordx4 v7, s[68:71], s25 offen lds
v_mfma_f32_16x16x32_bf16 v[56:59], a[96:99], a[32:35], v[56:59]
ds_read_b64_tr_b16 a[88:89], v13 offset:512
v_mfma_f32_16x16x32_bf16 v[56:59], a[100:103], a[48:51], v[56:59]
ds_read_b64_tr_b16 a[90:91], v13 offset:1536
v_mfma_f32_16x16x32_bf16 v[64:67], a[100:103], a[52:55], v[64:67]
ds_read_b64_tr_b16 a[92:93], v13 offset:8704
v_mfma_f32_16x16x32_bf16 v[64:67], a[96:99], a[36:39], v[64:67]
ds_read_b64_tr_b16 a[94:95], v13 offset:9728
v_cvt_pk_bf16_f32 v24, v24, v25
v_cvt_pk_bf16_f32 v25, v26, v27
v_mfma_f32_16x16x32_bf16 v[72:75], a[96:99], a[40:43], v[72:75]
ds_read_b128 a[24:27], v9 offset:4096
v_cvt_pk_bf16_f32 v26, v28, v29
v_mfma_f32_16x16x32_bf16 v[72:75], a[100:103], a[56:59], v[72:75]
ds_read_b128 a[12:15], v8 offset:6144
s_add_u32 m0, s18, 0x6000
v_mfma_f32_16x16x32_bf16 v[80:83], a[100:103], a[60:63], v[80:83]
buffer_load_dwordx4 v7, s[68:71], s26 offen lds
v_cvt_pk_bf16_f32 v27, v30, v31
v_mfma_f32_16x16x32_bf16 v[80:83], a[96:99], a[44:47], v[80:83]
ds_read_b128 a[28:31], v9 offset:6144
v_lshl_add_u32 v5, s42, 19, v5
v_mfma_f32_16x16x32_bf16 v[84:87], a[104:107], a[44:47], v[84:87]
ds_read_b64_tr_b16 a[96:97], v12 offset:768
v_lshl_add_u32 v6, s42, 19, v6
v_mfma_f32_16x16x32_bf16 v[84:87], a[108:111], a[60:63], v[84:87]
ds_read_b64_tr_b16 a[98:99], v12 offset:1792
v_lshl_add_u32 v7, s42, 18, v7
v_accvgpr_write_b32 a128, v24
v_mfma_f32_16x16x32_bf16 v[76:79], a[108:111], a[56:59], v[76:79]
ds_read_b64_tr_b16 a[100:101], v12 offset:8960
v_lshl_add_u32 v7, s42, 17, v7
v_mfma_f32_16x16x32_bf16 v[76:79], a[104:107], a[40:43], v[76:79]
ds_read_b64_tr_b16 a[102:103], v12 offset:9984
v_accvgpr_write_b32 a129, v25
v_mfma_f32_16x16x32_bf16 v[68:71], a[104:107], a[36:39], v[68:71]
s_mov_b32 s9, 0x400000
v_accvgpr_write_b32 a130, v26
v_accvgpr_write_b32 a131, v27
v_cvt_pk_bf16_f32 v32, v32, v33
v_mfma_f32_16x16x32_bf16 v[68:71], a[108:111], a[52:55], v[68:71]
buffer_load_dword a120, v19, s[68:71], s9 offen
v_mfma_f32_16x16x32_bf16 v[60:63], a[108:111], a[48:51], v[60:63]
v_cvt_pk_bf16_f32 v33, v34, v35
v_cvt_pk_bf16_f32 v34, v36, v37
v_mfma_f32_16x16x32_bf16 v[60:63], a[104:107], a[32:35], v[60:63]
s_waitcnt lgkmcnt(7)
v_cvt_pk_bf16_f32 v35, v38, v39
v_accvgpr_write_b32 a132, v32
v_accvgpr_write_b32 a133, v33
v_mfma_f32_16x16x32_bf16 v[88:91], a[80:83], a[32:35], v[88:91]
ds_read_b64_tr_b16 a[104:105], v13 offset:768
v_accvgpr_write_b32 a134, v34
v_mfma_f32_16x16x32_bf16 v[88:91], a[84:87], a[48:51], v[88:91]
ds_read_b64_tr_b16 a[106:107], v13 offset:1792
v_accvgpr_write_b32 a135, v35
v_mfma_f32_16x16x32_bf16 v[96:99], a[84:87], a[52:55], v[96:99]
ds_read_b64_tr_b16 a[108:109], v13 offset:8960
v_cvt_pk_bf16_f32 v40, v40, v41
v_cvt_pk_bf16_f32 v41, v42, v43
v_mfma_f32_16x16x32_bf16 v[96:99], a[80:83], a[36:39], v[96:99]
ds_read_b64_tr_b16 a[110:111], v13 offset:9984
v_cvt_pk_bf16_f32 v42, v44, v45
v_mfma_f32_16x16x32_bf16 v[104:107], a[80:83], a[40:43], v[104:107]
s_add_u32 m0, s16, 0x0
s_waitcnt lgkmcnt(8)
v_cvt_pk_bf16_f32 v43, v46, v47
v_mfma_f32_16x16x32_bf16 v[104:107], a[84:87], a[56:59], v[104:107]
buffer_load_dwordx4 v22, s[44:47], s20 offen lds
v_accvgpr_write_b32 a136, v40
v_mfma_f32_16x16x32_bf16 v[112:115], a[84:87], a[60:63], v[112:115]
v_accvgpr_write_b32 a137, v41
v_accvgpr_write_b32 a138, v42
v_mfma_f32_16x16x32_bf16 v[112:115], a[80:83], a[44:47], v[112:115]
v_accvgpr_write_b32 a139, v43
v_cvt_pk_bf16_f32 v48, v48, v49
v_mfma_f32_16x16x32_bf16 v[116:119], a[88:91], a[44:47], v[116:119]
ds_read_b64_tr_b16 a[80:81], v12 offset:16384
v_cvt_pk_bf16_f32 v49, v50, v51
v_cvt_pk_bf16_f32 v50, v52, v53
v_mfma_f32_16x16x32_bf16 v[116:119], a[92:95], a[60:63], v[116:119]
ds_read_b64_tr_b16 a[82:83], v12 offset:17408
v_cvt_pk_bf16_f32 v51, v54, v55
v_mfma_f32_16x16x32_bf16 v[108:111], a[92:95], a[56:59], v[108:111]
ds_read_b64_tr_b16 a[84:85], v12 offset:24576
v_accvgpr_write_b32 a140, v48
v_mfma_f32_16x16x32_bf16 v[108:111], a[88:91], a[40:43], v[108:111]
ds_read_b64_tr_b16 a[86:87], v12 offset:25600
s_add_u32 m0, s16, 0x400
v_accvgpr_write_b32 a141, v49
v_mfma_f32_16x16x32_bf16 v[100:103], a[88:91], a[36:39], v[100:103]
buffer_load_dwordx4 v23, s[44:47], s20 offen lds
v_mfma_f32_16x16x32_bf16 v[100:103], a[92:95], a[52:55], v[100:103]
v_accvgpr_write_b32 a142, v50
v_accvgpr_write_b32 a143, v51
v_mfma_f32_16x16x32_bf16 v[92:95], a[92:95], a[48:51], v[92:95]
v_cvt_pk_bf16_f32 v56, v56, v57
v_cvt_pk_bf16_f32 v57, v58, v59
v_cvt_pk_bf16_f32 v58, v60, v61
v_mfma_f32_16x16x32_bf16 v[92:95], a[88:91], a[32:35], v[92:95]
s_waitcnt lgkmcnt(4)
v_cvt_pk_bf16_f32 v59, v62, v63
v_accvgpr_write_b32 a144, v56
v_mfma_f32_16x16x32_bf16 v[120:123], a[96:99], a[32:35], v[120:123]
ds_read_b64_tr_b16 a[88:89], v13 offset:16384
v_accvgpr_write_b32 a145, v57
v_mfma_f32_16x16x32_bf16 v[120:123], a[100:103], a[48:51], v[120:123]
ds_read_b64_tr_b16 a[90:91], v13 offset:17408
v_accvgpr_write_b32 a146, v58
v_accvgpr_write_b32 a147, v59
v_mfma_f32_16x16x32_bf16 v[128:131], a[100:103], a[52:55], v[128:131]
ds_read_b64_tr_b16 a[92:93], v13 offset:24576
v_cvt_pk_bf16_f32 v64, v64, v65
v_mfma_f32_16x16x32_bf16 v[128:131], a[96:99], a[36:39], v[128:131]
ds_read_b64_tr_b16 a[94:95], v13 offset:25600
s_add_u32 m0, s16, 0x800
v_mfma_f32_16x16x32_bf16 v[136:139], a[96:99], a[40:43], v[136:139]
buffer_load_dwordx4 v22, s[44:47], s21 offen lds
v_cvt_pk_bf16_f32 v65, v66, v67
v_mfma_f32_16x16x32_bf16 v[136:139], a[100:103], a[56:59], v[136:139]
v_cvt_pk_bf16_f32 v66, v68, v69
v_cvt_pk_bf16_f32 v67, v70, v71
v_mfma_f32_16x16x32_bf16 v[144:147], a[100:103], a[60:63], v[144:147]
v_accvgpr_write_b32 a148, v64
v_accvgpr_write_b32 a149, v65
v_mfma_f32_16x16x32_bf16 v[144:147], a[96:99], a[44:47], v[144:147]
v_accvgpr_write_b32 a150, v66
v_accvgpr_write_b32 a151, v67
v_cvt_pk_bf16_f32 v72, v72, v73
v_mfma_f32_16x16x32_bf16 v[148:151], a[104:107], a[44:47], v[148:151]
ds_read_b64_tr_b16 a[96:97], v12 offset:16640
v_cvt_pk_bf16_f32 v73, v74, v75
v_mfma_f32_16x16x32_bf16 v[148:151], a[108:111], a[60:63], v[148:151]
ds_read_b64_tr_b16 a[98:99], v12 offset:17664
v_cvt_pk_bf16_f32 v74, v76, v77
v_mfma_f32_16x16x32_bf16 v[140:143], a[108:111], a[56:59], v[140:143]
ds_read_b64_tr_b16 a[100:101], v12 offset:24832
s_add_u32 m0, s16, 0xc00
v_cvt_pk_bf16_f32 v75, v78, v79
v_mfma_f32_16x16x32_bf16 v[140:143], a[104:107], a[40:43], v[140:143]
buffer_load_dwordx4 v23, s[44:47], s21 offen lds
v_mfma_f32_16x16x32_bf16 v[132:135], a[104:107], a[36:39], v[132:135]
ds_read_b64_tr_b16 a[102:103], v12 offset:25856
v_accvgpr_write_b32 a152, v72
v_mfma_f32_16x16x32_bf16 v[132:135], a[108:111], a[52:55], v[132:135]
v_accvgpr_write_b32 a153, v73
v_accvgpr_write_b32 a154, v74
v_accvgpr_write_b32 a155, v75
v_mfma_f32_16x16x32_bf16 v[124:127], a[108:111], a[48:51], v[124:127]
v_cvt_pk_bf16_f32 v80, v80, v81
v_cvt_pk_bf16_f32 v81, v82, v83
v_mfma_f32_16x16x32_bf16 v[124:127], a[104:107], a[32:35], v[124:127]
s_waitcnt lgkmcnt(4)
v_cvt_pk_bf16_f32 v82, v84, v85
v_cvt_pk_bf16_f32 v83, v86, v87
v_mfma_f32_16x16x32_bf16 v[152:155], a[32:35], a[80:83], v[152:155]
ds_read_b64_tr_b16 a[104:105], v13 offset:16640
v_accvgpr_write_b32 a156, v80
v_accvgpr_write_b32 a157, v81
v_mfma_f32_16x16x32_bf16 v[152:155], a[48:51], a[84:87], v[152:155]
ds_read_b64_tr_b16 a[106:107], v13 offset:17664
s_add_u32 m0, s16, 0x1000
v_mfma_f32_16x16x32_bf16 v[156:159], a[52:55], a[84:87], v[156:159]
buffer_load_dwordx4 v22, s[44:47], s22 offen lds
v_mfma_f32_16x16x32_bf16 v[156:159], a[36:39], a[80:83], v[156:159]
ds_read_b64_tr_b16 a[108:109], v13 offset:24832
v_accvgpr_write_b32 a158, v82
v_accvgpr_write_b32 a159, v83
v_mfma_f32_16x16x32_bf16 v[160:163], a[40:43], a[80:83], v[160:163]
ds_read_b64_tr_b16 a[110:111], v13 offset:25856
v_cvt_pk_bf16_f32 v88, v88, v89
v_mfma_f32_16x16x32_bf16 v[160:163], a[56:59], a[84:87], v[160:163]
v_cvt_pk_bf16_f32 v89, v90, v91
v_cvt_pk_bf16_f32 v90, v92, v93
v_mfma_f32_16x16x32_bf16 v[164:167], a[60:63], a[84:87], v[164:167]
v_cvt_pk_bf16_f32 v91, v94, v95
v_accvgpr_write_b32 a160, v88
v_accvgpr_write_b32 a161, v89
v_mfma_f32_16x16x32_bf16 v[164:167], a[44:47], a[80:83], v[164:167]
v_accvgpr_write_b32 a162, v90
v_accvgpr_write_b32 a163, v91
v_mfma_f32_16x16x32_bf16 v[180:183], a[44:47], a[88:91], v[180:183]
ds_read_b64_tr_b16 a[80:81], v12 offset:16896
v_cvt_pk_bf16_f32 v96, v96, v97
v_mfma_f32_16x16x32_bf16 v[180:183], a[60:63], a[92:95], v[180:183]
ds_read_b64_tr_b16 a[82:83], v12 offset:17920
s_add_u32 m0, s16, 0x1400
v_cvt_pk_bf16_f32 v97, v98, v99
v_mfma_f32_16x16x32_bf16 v[176:179], a[56:59], a[92:95], v[176:179]
buffer_load_dwordx4 v23, s[44:47], s22 offen lds
v_mfma_f32_16x16x32_bf16 v[176:179], a[40:43], a[88:91], v[176:179]
ds_read_b64_tr_b16 a[84:85], v12 offset:25088
v_cvt_pk_bf16_f32 v98, v100, v101
v_mfma_f32_16x16x32_bf16 v[172:175], a[36:39], a[88:91], v[172:175]
ds_read_b64_tr_b16 a[86:87], v12 offset:26112
v_cvt_pk_bf16_f32 v99, v102, v103
v_accvgpr_write_b32 a164, v96
v_mfma_f32_16x16x32_bf16 v[172:175], a[52:55], a[92:95], v[172:175]
v_accvgpr_write_b32 a165, v97
v_accvgpr_write_b32 a166, v98
v_mfma_f32_16x16x32_bf16 v[168:171], a[48:51], a[92:95], v[168:171]
v_accvgpr_write_b32 a167, v99
v_cvt_pk_bf16_f32 v104, v104, v105
v_mfma_f32_16x16x32_bf16 v[168:171], a[32:35], a[88:91], v[168:171]
s_waitcnt lgkmcnt(4)
v_cvt_pk_bf16_f32 v105, v106, v107
v_cvt_pk_bf16_f32 v106, v108, v109
v_cvt_pk_bf16_f32 v107, v110, v111
v_mfma_f32_16x16x32_bf16 v[184:187], a[32:35], a[96:99], v[184:187]
ds_read_b64_tr_b16 a[88:89], v13 offset:16896
s_add_u32 m0, s16, 0x1800
v_mfma_f32_16x16x32_bf16 v[184:187], a[48:51], a[100:103], v[184:187]
buffer_load_dwordx4 v22, s[44:47], s23 offen lds
v_mfma_f32_16x16x32_bf16 v[188:191], a[52:55], a[100:103], v[188:191]
ds_read_b64_tr_b16 a[90:91], v13 offset:17920
v_accvgpr_write_b32 a168, v104
v_accvgpr_write_b32 a169, v105
v_mfma_f32_16x16x32_bf16 v[188:191], a[36:39], a[96:99], v[188:191]
ds_read_b64_tr_b16 a[92:93], v13 offset:25088
v_accvgpr_write_b32 a170, v106
v_mfma_f32_16x16x32_bf16 v[192:195], a[40:43], a[96:99], v[192:195]
ds_read_b64_tr_b16 a[94:95], v13 offset:26112
v_accvgpr_write_b32 a171, v107
v_mfma_f32_16x16x32_bf16 v[192:195], a[56:59], a[100:103], v[192:195]
L_padA4:
s_cmp_eq_u32 s95, 1
s_cbranch_scc1 L_padA8
v_cvt_pk_bf16_f32 v112, v112, v113
v_cvt_pk_bf16_f32 v113, v114, v115
v_cvt_pk_bf16_f32 v114, v116, v117
v_mfma_f32_16x16x32_bf16 v[196:199], a[60:63], a[100:103], v[196:199]
v_cvt_pk_bf16_f32 v115, v118, v119
v_accvgpr_write_b32 a172, v112
v_mfma_f32_16x16x32_bf16 v[196:199], a[44:47], a[96:99], v[196:199]
v_accvgpr_write_b32 a173, v113
v_accvgpr_write_b32 a174, v114
v_mfma_f32_16x16x32_bf16 v[212:215], a[44:47], a[104:107], v[212:215]
ds_read_b64_tr_b16 a[96:97], v12 offset:17152
s_add_u32 m0, s16, 0x1c00
v_accvgpr_write_b32 a175, v115
v_mfma_f32_16x16x32_bf16 v[212:215], a[60:63], a[108:111], v[212:215]
buffer_load_dwordx4 v23, s[44:47], s23 offen lds
v_mfma_f32_16x16x32_bf16 v[208:211], a[56:59], a[108:111], v[208:211]
ds_read_b64_tr_b16 a[98:99], v12 offset:18176
v_lshl_add_u32 v22, s42, 7, v22
v_mfma_f32_16x16x32_bf16 v[208:211], a[40:43], a[104:107], v[208:211]
ds_read_b64_tr_b16 a[100:101], v12 offset:25344
v_lshl_add_u32 v23, s42, 7, v23
v_cvt_pk_bf16_f32 v120, v120, v121
v_mfma_f32_16x16x32_bf16 v[204:207], a[36:39], a[104:107], v[204:207]
ds_read_b64_tr_b16 a[102:103], v12 offset:26368
v_cvt_pk_bf16_f32 v121, v122, v123
v_mfma_f32_16x16x32_bf16 v[204:207], a[52:55], a[108:111], v[204:207]
v_cvt_pk_bf16_f32 v122, v124, v125
v_cvt_pk_bf16_f32 v123, v126, v127
v_mfma_f32_16x16x32_bf16 v[200:203], a[48:51], a[108:111], v[200:203]
v_accvgpr_write_b32 a176, v120
v_accvgpr_write_b32 a177, v121
v_accvgpr_write_b32 a178, v122
v_mfma_f32_16x16x32_bf16 v[200:203], a[32:35], a[104:107], v[200:203]
s_mov_b32 s9, 0x600000
s_waitcnt lgkmcnt(4)
v_accvgpr_write_b32 a179, v123
v_mfma_f32_16x16x32_bf16 v[216:219], a[32:35], a[80:83], v[216:219]
buffer_load_dword a120, v18, s[52:55], s9 offen
v_mfma_f32_16x16x32_bf16 v[216:219], a[48:51], a[84:87], v[216:219]
ds_read_b64_tr_b16 a[104:105], v13 offset:17152
v_cvt_pk_bf16_f32 v128, v128, v129
v_cvt_pk_bf16_f32 v129, v130, v131
v_mfma_f32_16x16x32_bf16 v[220:223], a[52:55], a[84:87], v[220:223]
ds_read_b64_tr_b16 a[106:107], v13 offset:18176
v_cvt_pk_bf16_f32 v130, v132, v133
v_mfma_f32_16x16x32_bf16 v[220:223], a[36:39], a[80:83], v[220:223]
ds_read_b64_tr_b16 a[108:109], v13 offset:25344
v_cvt_pk_bf16_f32 v131, v134, v135
v_mfma_f32_16x16x32_bf16 v[224:227], a[40:43], a[80:83], v[224:227]
ds_read_b64_tr_b16 a[110:111], v13 offset:26368
v_add_u32 v12, 0x8000, v12
v_accvgpr_write_b32 a180, v128
v_mfma_f32_16x16x32_bf16 v[224:227], a[56:59], a[84:87], v[224:227]
v_add_u32 v13, 0x8000, v13
v_accvgpr_write_b32 a181, v129
v_mfma_f32_16x16x32_bf16 v[228:231], a[60:63], a[84:87], v[228:231]
v_accvgpr_write_b32 a182, v130
v_accvgpr_write_b32 a183, v131
v_mfma_f32_16x16x32_bf16 v[228:231], a[44:47], a[80:83], v[228:231]
v_cvt_pk_bf16_f32 v136, v136, v137
v_cvt_pk_bf16_f32 v137, v138, v139
v_cvt_pk_bf16_f32 v138, v140, v141
v_mfma_f32_16x16x32_bf16 v[244:247], a[44:47], a[88:91], v[244:247]
s_waitcnt vmcnt(27) lgkmcnt(0)
v_cvt_pk_bf16_f32 v139, v142, v143
v_accvgpr_write_b32 a184, v136
v_mfma_f32_16x16x32_bf16 v[244:247], a[60:63], a[92:95], v[244:247]
s_barrier
s_add_u32 m0, s17, 0x8000
v_accvgpr_write_b32 a185, v137
v_mfma_f32_16x16x32_bf16 v[240:243], a[56:59], a[92:95], v[240:243]
buffer_load_dwordx4 v5, s[52:55], 0 offen lds
v_accvgpr_write_b32 a186, v138
v_mfma_f32_16x16x32_bf16 v[240:243], a[40:43], a[88:91], v[240:243]
ds_read_b64_tr_b16 a[80:81], v12 offset:0
v_accvgpr_write_b32 a187, v139
v_mfma_f32_16x16x32_bf16 v[236:239], a[36:39], a[88:91], v[236:239]
ds_read_b64_tr_b16 a[82:83], v12 offset:1024
v_cvt_pk_bf16_f32 v144, v144, v145
v_mfma_f32_16x16x32_bf16 v[236:239], a[52:55], a[92:95], v[236:239]
ds_read_b64_tr_b16 a[84:85], v12 offset:8192
v_cvt_pk_bf16_f32 v145, v146, v147
v_cvt_pk_bf16_f32 v146, v148, v149
v_mfma_f32_16x16x32_bf16 v[232:235], a[48:51], a[92:95], v[232:235]
ds_read_b64_tr_b16 a[86:87], v12 offset:9216
v_cvt_pk_bf16_f32 v147, v150, v151
v_mfma_f32_16x16x32_bf16 v[232:235], a[32:35], a[88:91], v[232:235]
s_add_u32 m0, s17, 0x8400
s_waitcnt lgkmcnt(4)
v_accvgpr_write_b32 a188, v144
v_mfma_f32_16x16x32_bf16 v[248:251], a[32:35], a[96:99], v[248:251]
buffer_load_dwordx4 v5, s[52:55], s13 offen lds
v_accvgpr_write_b32 a189, v145
v_mfma_f32_16x16x32_bf16 v[248:251], a[48:51], a[100:103], v[248:251]
ds_read_b64_tr_b16 a[88:89], v13 offset:0
v_accvgpr_write_b32 a190, v146
v_mfma_f32_16x16x32_bf16 v[252:255], a[52:55], a[100:103], v[252:255]
ds_read_b64_tr_b16 a[90:91], v13 offset:1024
v_accvgpr_write_b32 a191, v147
v_mfma_f32_16x16x32_bf16 v[252:255], a[36:39], a[96:99], v[252:255]
ds_read_b64_tr_b16 a[92:93], v13 offset:8192
v_cvt_pk_bf16_f32 v152, v152, v153
v_cvt_pk_bf16_f32 v153, v154, v155
v_mfma_f32_16x16x32_bf16 a[232:235], a[40:43], a[96:99], a[232:235]
ds_read_b64_tr_b16 a[94:95], v13 offset:9216
v_cvt_pk_bf16_f32 v154, v156, v157
v_mfma_f32_16x16x32_bf16 a[232:235], a[56:59], a[100:103], a[232:235]
v_cvt_pk_bf16_f32 v155, v158, v159
v_accvgpr_write_b32 a192, v152
v_mfma_f32_16x16x32_bf16 a[236:239], a[60:63], a[100:103], a[236:239]
s_add_u32 m0, s17, 0x8800
v_accvgpr_write_b32 a193, v153
v_accvgpr_write_b32 a194, v154
v_accvgpr_write_b32 a195, v155
v_mfma_f32_16x16x32_bf16 a[236:239], a[44:47], a[96:99], a[236:239]
buffer_load_dwordx4 v6, s[52:55], 0 offen lds
v_mfma_f32_16x16x32_bf16 a[252:255], a[44:47], a[104:107], a[252:255]
ds_read_b64_tr_b16 a[96:97], v12 offset:256
v_cvt_pk_bf16_f32 v160, v160, v161
v_mfma_f32_16x16x32_bf16 a[252:255], a[60:63], a[108:111], a[252:255]
ds_read_b64_tr_b16 a[98:99], v12 offset:1280
v_cvt_pk_bf16_f32 v161, v162, v163
v_cvt_pk_bf16_f32 v162, v164, v165
v_mfma_f32_16x16x32_bf16 a[248:251], a[56:59], a[108:111], a[248:251]
ds_read_b64_tr_b16 a[100:101], v12 offset:8448
v_cvt_pk_bf16_f32 v163, v166, v167
v_mfma_f32_16x16x32_bf16 a[248:251], a[40:43], a[104:107], a[248:251]
ds_read_b64_tr_b16 a[102:103], v12 offset:9472
v_accvgpr_write_b32 a196, v160
v_mfma_f32_16x16x32_bf16 a[244:247], a[36:39], a[104:107], a[244:247]
v_accvgpr_write_b32 a197, v161
v_accvgpr_write_b32 a198, v162
v_accvgpr_write_b32 a199, v163
v_mfma_f32_16x16x32_bf16 a[244:247], a[52:55], a[108:111], a[244:247]
s_add_u32 m0, s17, 0x8c00
v_cvt_pk_bf16_f32 v168, v168, v169
v_cvt_pk_bf16_f32 v169, v170, v171
v_mfma_f32_16x16x32_bf16 a[240:243], a[48:51], a[108:111], a[240:243]
buffer_load_dwordx4 v6, s[52:55], s13 offen lds
v_mfma_f32_16x16x32_bf16 a[240:243], a[32:35], a[104:107], a[240:243]
s_waitcnt lgkmcnt(4)
v_cvt_pk_bf16_f32 v170, v172, v173
v_cvt_pk_bf16_f32 v171, v174, v175
v_accvgpr_write_b32 a200, v168
L_S8:
v_mfma_f32_16x16x32_bf16 v[24:27], a[80:83], a[0:3], 0
ds_read_b64_tr_b16 a[104:105], v13 offset:256
s_waitcnt vmcnt(22)
v_mfma_f32_16x16x32_bf16 v[24:27], a[84:87], a[16:19], v[24:27]
ds_read_b64_tr_b16 a[106:107], v13 offset:1280
v_accvgpr_write_b32 a201, v169
v_mfma_f32_16x16x32_bf16 v[32:35], a[84:87], a[20:23], 0
ds_read_b64_tr_b16 a[108:109], v13 offset:8448
v_accvgpr_write_b32 a202, v170
v_accvgpr_write_b32 a203, v171
v_mfma_f32_16x16x32_bf16 v[32:35], a[80:83], a[4:7], v[32:35]
ds_read_b64_tr_b16 a[110:111], v13 offset:9472
v_cvt_pk_bf16_f32 v176, v176, v177
v_mfma_f32_16x16x32_bf16 v[40:43], a[80:83], a[8:11], 0
ds_read_b128 a[32:35], v8 offset:32768
s_add_u32 m0, s18, 0xc000
v_mfma_f32_16x16x32_bf16 v[40:43], a[84:87], a[24:27], v[40:43]
buffer_load_dwordx4 v7, s[68:71], 0 offen lds
v_cvt_pk_bf16_f32 v177, v178, v179
v_mfma_f32_16x16x32_bf16 v[48:51], a[84:87], a[28:31], 0
ds_read_b128 a[48:51], v9 offset:32768
v_cvt_pk_bf16_f32 v178, v180, v181
v_mfma_f32_16x16x32_bf16 v[48:51], a[80:83], a[12:15], v[48:51]
ds_read_b128 a[36:39], v8 offset:34816
v_cvt_pk_bf16_f32 v179, v182, v183
v_mfma_f32_16x16x32_bf16 v[52:55], a[88:91], a[12:15], 0
ds_read_b64_tr_b16 a[80:81], v12 offset:512
v_accvgpr_write_b32 a204, v176
v_accvgpr_write_b32 a205, v177
v_mfma_f32_16x16x32_bf16 v[52:55], a[92:95], a[28:31], v[52:55]
ds_read_b64_tr_b16 a[82:83], v12 offset:1536
v_accvgpr_write_b32 a206, v178
v_mfma_f32_16x16x32_bf16 v[44:47], a[92:95], a[24:27], 0
ds_read_b64_tr_b16 a[84:85], v12 offset:8704
s_add_u32 s8, s28, 0x2000
v_mfma_f32_16x16x32_bf16 v[44:47], a[88:91], a[8:11], v[44:47]
buffer_store_dwordx4 a[128:131], v16, s[88:91], s8 offen sc1
v_accvgpr_write_b32 a207, v179
v_mfma_f32_16x16x32_bf16 v[36:39], a[88:91], a[4:7], 0
ds_read_b64_tr_b16 a[86:87], v12 offset:9728
v_cvt_pk_bf16_f32 v184, v184, v185
v_mfma_f32_16x16x32_bf16 v[36:39], a[92:95], a[20:23], v[36:39]
ds_read_b128 a[52:55], v9 offset:34816
v_cvt_pk_bf16_f32 v185, v186, v187
v_mfma_f32_16x16x32_bf16 v[28:31], a[92:95], a[16:19], 0
ds_read_b128 a[40:43], v8 offset:36864
v_cvt_pk_bf16_f32 v186, v188, v189
v_cvt_pk_bf16_f32 v187, v190, v191
v_mfma_f32_16x16x32_bf16 v[28:31], a[88:91], a[0:3], v[28:31]
ds_read_b128 a[56:59], v9 offset:36864
s_waitcnt lgkmcnt(10)
v_mfma_f32_16x16x32_bf16 v[56:59], a[96:99], a[0:3], 0
ds_read_b64_tr_b16 a[88:89], v13 offset:512
v_accvgpr_write_b32 a208, v184
v_mfma_f32_16x16x32_bf16 v[56:59], a[100:103], a[16:19], v[56:59]
ds_read_b64_tr_b16 a[90:91], v13 offset:1536
s_add_u32 m0, s18, 0xd000
v_accvgpr_write_b32 a209, v185
v_mfma_f32_16x16x32_bf16 v[64:67], a[100:103], a[20:23], 0
buffer_load_dwordx4 v7, s[68:71], s25 offen lds
v_mfma_f32_16x16x32_bf16 v[64:67], a[96:99], a[4:7], v[64:67]
ds_read_b64_tr_b16 a[92:93], v13 offset:8704
v_accvgpr_write_b32 a210, v186
v_mfma_f32_16x16x32_bf16 v[72:75], a[96:99], a[8:11], 0
ds_read_b64_tr_b16 a[94:95], v13 offset:9728
v_accvgpr_write_b32 a211, v187
v_cvt_pk_bf16_f32 v192, v192, v193
v_mfma_f32_16x16x32_bf16 v[72:75], a[100:103], a[24:27], v[72:75]
ds_read_b128 a[44:47], v8 offset:38912
v_cvt_pk_bf16_f32 v193, v194, v195
v_mfma_f32_16x16x32_bf16 v[80:83], a[100:103], a[28:31], 0
ds_read_b128 a[60:63], v9 offset:38912
v_cvt_pk_bf16_f32 v194, v196, v197
v_mfma_f32_16x16x32_bf16 v[80:83], a[96:99], a[12:15], v[80:83]
v_cvt_pk_bf16_f32 v195, v198, v199
v_accvgpr_write_b32 a212, v192
v_accvgpr_write_b32 a213, v193
v_mfma_f32_16x16x32_bf16 v[84:87], a[104:107], a[12:15], 0
ds_read_b64_tr_b16 a[96:97], v12 offset:768
s_add_u32 m0, s18, 0xe000
v_mfma_f32_16x16x32_bf16 v[84:87], a[108:111], a[28:31], v[84:87]
buffer_load_dwordx4 v7, s[68:71], s26 offen lds
v_mfma_f32_16x16x32_bf16 v[76:79], a[108:111], a[24:27], 0
ds_read_b64_tr_b16 a[98:99], v12 offset:1792
v_lshl_add_u32 v5, s42, 19, v5
v_accvgpr_write_b32 a214, v194
v_mfma_f32_16x16x32_bf16 v[76:79], a[104:107], a[8:11], v[76:79]
ds_read_b64_tr_b16 a[100:101], v12 offset:8960
v_lshl_add_u32 v6, s42, 19, v6
v_mfma_f32_16x16x32_bf16 v[68:71], a[104:107], a[4:7], 0
ds_read_b64_tr_b16 a[102:103], v12 offset:9984
v_lshl_add_u32 v7, s42, 18, v7
v_mfma_f32_16x16x32_bf16 v[68:71], a[108:111], a[20:23], v[68:71]
v_lshl_add_u32 v7, s42, 17, v7
v_accvgpr_write_b32 a215, v195
v_cvt_pk_bf16_f32 v200, v200, v201
v_mfma_f32_16x16x32_bf16 v[60:63], a[108:111], a[16:19], 0
v_cvt_pk_bf16_f32 v201, v202, v203
v_cvt_pk_bf16_f32 v202, v204, v205
v_mfma_f32_16x16x32_bf16 v[60:63], a[104:107], a[0:3], v[60:63]
s_add_u32 m0, s16, 0x8000
s_waitcnt lgkmcnt(4)
s_waitcnt lgkmcnt(6)
v_mfma_f32_16x16x32_bf16 v[88:91], a[80:83], a[0:3], 0
buffer_load_dwordx4 v22, s[44:47], s20 offen lds
v_cvt_pk_bf16_f32 v203, v206, v207
v_mfma_f32_16x16x32_bf16 v[88:91], a[84:87], a[16:19], v[88:91]
ds_read_b64_tr_b16 a[104:105], v13 offset:768
v_accvgpr_write_b32 a216, v200
v_mfma_f32_16x16x32_bf16 v[96:99], a[84:87], a[20:23], 0
ds_read_b64_tr_b16 a[106:107], v13 offset:1792
v_accvgpr_write_b32 a217, v201
v_mfma_f32_16x16x32_bf16 v[96:99], a[80:83], a[4:7], v[96:99]
ds_read_b64_tr_b16 a[108:109], v13 offset:8960
v_accvgpr_write_b32 a218, v202
v_accvgpr_write_b32 a219, v203
v_mfma_f32_16x16x32_bf16 v[104:107], a[80:83], a[8:11], 0
ds_read_b64_tr_b16 a[110:111], v13 offset:9984
s_add_u32 m0, s16, 0x8400
v_mfma_f32_16x16x32_bf16 v[104:107], a[84:87], a[24:27], v[104:107]
buffer_load_dwordx4 v23, s[44:47], s20 offen lds
v_mfma_f32_16x16x32_bf16 v[112:115], a[84:87], a[28:31], 0
v_cvt_pk_bf16_f32 v208, v208, v209
v_cvt_pk_bf16_f32 v209, v210, v211
v_cvt_pk_bf16_f32 v210, v212, v213
v_mfma_f32_16x16x32_bf16 v[112:115], a[80:83], a[12:15], v[112:115]
v_cvt_pk_bf16_f32 v211, v214, v215
v_accvgpr_write_b32 a220, v208
v_mfma_f32_16x16x32_bf16 v[116:119], a[88:91], a[12:15], 0
ds_read_b64_tr_b16 a[80:81], v14 offset:0
v_accvgpr_write_b32 a221, v209
v_mfma_f32_16x16x32_bf16 v[116:119], a[92:95], a[28:31], v[116:119]
ds_read_b64_tr_b16 a[82:83], v14 offset:256
v_accvgpr_write_b32 a222, v210
v_accvgpr_write_b32 a223, v211
v_mfma_f32_16x16x32_bf16 v[108:111], a[92:95], a[24:27], 0
ds_read_b64_tr_b16 a[84:85], v14 offset:2048
s_add_u32 m0, s16, 0x8800
v_mfma_f32_16x16x32_bf16 v[108:111], a[88:91], a[8:11], v[108:111]
buffer_load_dwordx4 v22, s[44:47], s21 offen lds
v_mfma_f32_16x16x32_bf16 v[100:103], a[88:91], a[4:7], 0
ds_read_b64_tr_b16 a[86:87], v14 offset:2304
v_cvt_pk_bf16_f32 v216, v216, v217
v_cvt_pk_bf16_f32 v217, v218, v219
v_mfma_f32_16x16x32_bf16 v[100:103], a[92:95], a[20:23], v[100:103]
v_cvt_pk_bf16_f32 v218, v220, v221
v_cvt_pk_bf16_f32 v219, v222, v223
v_mfma_f32_16x16x32_bf16 v[92:95], a[92:95], a[16:19], 0
v_accvgpr_write_b32 a224, v216
v_accvgpr_write_b32 a225, v217
v_mfma_f32_16x16x32_bf16 v[92:95], a[88:91], a[0:3], v[92:95]
s_add_u32 s8, s28, 0x3000
s_waitcnt lgkmcnt(4)
v_accvgpr_write_b32 a226, v218
v_accvgpr_write_b32 a227, v219
v_mfma_f32_16x16x32_bf16 v[120:123], a[96:99], a[0:3], 0
buffer_store_dwordx4 a[132:135], v16, s[88:91], s8 offen sc1
v_mfma_f32_16x16x32_bf16 v[120:123], a[100:103], a[16:19], v[120:123]
ds_read_b64_tr_b16 a[88:89], v15 offset:0
v_cvt_pk_bf16_f32 v224, v224, v225
v_mfma_f32_16x16x32_bf16 v[128:131], a[100:103], a[20:23], 0
ds_read_b64_tr_b16 a[90:91], v15 offset:256
v_cvt_pk_bf16_f32 v225, v226, v227
v_cvt_pk_bf16_f32 v226, v228, v229
v_mfma_f32_16x16x32_bf16 v[128:131], a[96:99], a[4:7], v[128:131]
ds_read_b64_tr_b16 a[92:93], v15 offset:2048
v_cvt_pk_bf16_f32 v227, v230, v231
v_mfma_f32_16x16x32_bf16 v[136:139], a[96:99], a[8:11], 0
ds_read_b64_tr_b16 a[94:95], v15 offset:2304
v_accvgpr_write_b32 a228, v224
v_mfma_f32_16x16x32_bf16 v[136:139], a[100:103], a[24:27], v[136:139]
s_add_u32 m0, s16, 0x8c00
v_accvgpr_write_b32 a229, v225
v_accvgpr_write_b32 a230, v226
v_accvgpr_write_b32 a231, v227
v_mfma_f32_16x16x32_bf16 v[144:147], a[100:103], a[28:31], 0
buffer_load_dwordx4 v23, s[44:47], s21 offen lds
v_mfma_f32_16x16x32_bf16 v[144:147], a[96:99], a[12:15], v[144:147]
v_cvt_pk_bf16_f32 v232, v232, v233
v_cvt_pk_bf16_f32 v233, v234, v235
v_mfma_f32_16x16x32_bf16 v[148:151], a[104:107], a[12:15], 0
ds_read_b64_tr_b16 a[96:97], v14 offset:4096
v_cvt_pk_bf16_f32 v234, v236, v237
v_cvt_pk_bf16_f32 v235, v238, v239
v_mfma_f32_16x16x32_bf16 v[148:151], a[108:111], a[28:31], v[148:151]
ds_read_b64_tr_b16 a[98:99], v14 offset:4352
v_accvgpr_write_b32 a112, v232
v_mfma_f32_16x16x32_bf16 v[140:143], a[108:111], a[24:27], 0
ds_read_b64_tr_b16 a[100:101], v14 offset:6144
v_accvgpr_write_b32 a113, v233
v_mfma_f32_16x16x32_bf16 v[140:143], a[104:107], a[8:11], v[140:143]
ds_read_b64_tr_b16 a[102:103], v14 offset:6400
s_add_u32 m0, s16, 0x9000
v_accvgpr_write_b32 a114, v234
v_mfma_f32_16x16x32_bf16 v[132:135], a[104:107], a[4:7], 0
buffer_load_dwordx4 v22, s[44:47], s22 offen lds
v_mfma_f32_16x16x32_bf16 v[132:135], a[108:111], a[20:23], v[132:135]
v_accvgpr_write_b32 a115, v235
v_cvt_pk_bf16_f32 v240, v240, v241
v_mfma_f32_16x16x32_bf16 v[124:127], a[108:111], a[16:19], 0
v_cvt_pk_bf16_f32 v241, v242, v243
v_cvt_pk_bf16_f32 v242, v244, v245
v_cvt_pk_bf16_f32 v243, v246, v247
v_mfma_f32_16x16x32_bf16 v[124:127], a[104:107], a[0:3], v[124:127]
s_waitcnt lgkmcnt(4)
v_accvgpr_write_b32 a116, v240
v_accvgpr_write_b32 a117, v241
v_mfma_f32_16x16x32_bf16 v[152:155], a[80:83], a[0:3], 0
ds_read_b64_tr_b16 a[104:105], v15 offset:4096
s_add_u32 m0, s16, 0x9400
v_mfma_f32_16x16x32_bf16 v[152:155], a[84:87], a[16:19], v[152:155]
buffer_load_dwordx4 v23, s[44:47], s22 offen lds
v_accvgpr_write_b32 a118, v242
v_mfma_f32_16x16x32_bf16 v[160:163], a[84:87], a[20:23], 0
ds_read_b64_tr_b16 a[106:107], v15 offset:4352
v_accvgpr_write_b32 a119, v243
v_mfma_f32_16x16x32_bf16 v[160:163], a[80:83], a[4:7], v[160:163]
ds_read_b64_tr_b16 a[108:109], v15 offset:6144
v_cvt_pk_bf16_f32 v248, v248, v249
v_mfma_f32_16x16x32_bf16 v[168:171], a[80:83], a[8:11], 0
ds_read_b64_tr_b16 a[110:111], v15 offset:6400
v_cvt_pk_bf16_f32 v249, v250, v251
v_cvt_pk_bf16_f32 v250, v252, v253
v_mfma_f32_16x16x32_bf16 v[168:171], a[84:87], a[24:27], v[168:171]
v_cvt_pk_bf16_f32 v251, v254, v255
v_accvgpr_write_b32 a124, v248
v_mfma_f32_16x16x32_bf16 v[176:179], a[84:87], a[28:31], 0
s_add_u32 m0, s16, 0x9800
v_accvgpr_write_b32 a125, v249
v_accvgpr_write_b32 a126, v250
v_mfma_f32_16x16x32_bf16 v[176:179], a[80:83], a[12:15], v[176:179]
buffer_load_dwordx4 v22, s[44:47], s23 offen lds
v_accvgpr_write_b32 a127, v251
v_mfma_f32_16x16x32_bf16 v[180:183], a[88:91], a[12:15], 0
ds_read_b64_tr_b16 a[80:81], v14 offset:8192
v_accvgpr_read_b32 v2, a232
v_mfma_f32_16x16x32_bf16 v[180:183], a[92:95], a[28:31], v[180:183]
ds_read_b64_tr_b16 a[82:83], v14 offset:8448
v_accvgpr_read_b32 v3, a233
v_mfma_f32_16x16x32_bf16 v[172:175], a[92:95], a[24:27], 0
ds_read_b64_tr_b16 a[84:85], v14 offset:10240
v_cvt_pk_bf16_f32 v2, v2, v3
v_accvgpr_write_b32 a232, v2
v_mfma_f32_16x16x32_bf16 v[172:175], a[88:91], a[8:11], v[172:175]
ds_read_b64_tr_b16 a[86:87], v14 offset:10496
s_add_u32 m0, s16, 0x9c00
v_mfma_f32_16x16x32_bf16 v[164:167], a[88:91], a[4:7], 0
buffer_load_dwordx4 v23, s[44:47], s23 offen lds
v_mfma_f32_16x16x32_bf16 v[164:167], a[92:95], a[20:23], v[164:167]
v_lshl_add_u32 v22, s42, 7, v22
v_lshl_add_u32 v23, s42, 7, v23
v_accvgpr_read_b32 v2, a234
v_mfma_f32_16x16x32_bf16 v[156:159], a[92:95], a[16:19], 0
v_accvgpr_read_b32 v3, a235
v_cvt_pk_bf16_f32 v2, v2, v3
v_mfma_f32_16x16x32_bf16 v[156:159], a[88:91], a[0:3], v[156:159]
s_waitcnt lgkmcnt(4)
v_accvgpr_write_b32 a233, v2
v_accvgpr_read_b32 v2, a236
v_mfma_f32_16x16x32_bf16 v[184:187], a[96:99], a[0:3], 0
ds_read_b64_tr_b16 a[88:89], v15 offset:8192
v_accvgpr_read_b32 v3, a237
v_cvt_pk_bf16_f32 v2, v2, v3
v_mfma_f32_16x16x32_bf16 v[184:187], a[100:103], a[16:19], v[184:187]
ds_read_b64_tr_b16 a[90:91], v15 offset:8448
s_add_u32 s8, s28, 0x6000
v_mfma_f32_16x16x32_bf16 v[192:195], a[100:103], a[20:23], 0
buffer_store_dwordx4 a[136:139], v16, s[88:91], s8 offen sc1
v_mfma_f32_16x16x32_bf16 v[192:195], a[96:99], a[4:7], v[192:195]
ds_read_b64_tr_b16 a[92:93], v15 offset:10240
v_accvgpr_write_b32 a234, v2
v_accvgpr_read_b32 v2, a238
v_mfma_f32_16x16x32_bf16 v[200:203], a[96:99], a[8:11], 0
ds_read_b64_tr_b16 a[94:95], v15 offset:10496
v_add_u32 v12, 0xffff0000, v12
v_mfma_f32_16x16x32_bf16 v[200:203], a[100:103], a[24:27], v[200:203]
v_add_u32 v13, 0xffff0000, v13
v_add_u32 v14, 0xffff0000, v14
v_mfma_f32_16x16x32_bf16 v[208:211], a[100:103], a[28:31], 0
v_add_u32 v15, 0xffff0000, v15
v_accvgpr_read_b32 v3, a239
v_cvt_pk_bf16_f32 v2, v2, v3
v_mfma_f32_16x16x32_bf16 v[208:211], a[96:99], a[12:15], v[208:211]
v_accvgpr_write_b32 a235, v2
v_accvgpr_read_b32 v2, a240
v_mfma_f32_16x16x32_bf16 v[212:215], a[104:107], a[12:15], 0
s_waitcnt vmcnt(28) lgkmcnt(0)
v_accvgpr_read_b32 v3, a241
v_cvt_pk_bf16_f32 v2, v2, v3
v_mfma_f32_16x16x32_bf16 v[212:215], a[108:111], a[28:31], v[212:215]
s_barrier
s_add_u32 m0, s17, 0x10000
v_accvgpr_write_b32 a240, v2
v_accvgpr_read_b32 v2, a242
v_mfma_f32_16x16x32_bf16 v[204:207], a[108:111], a[24:27], 0
buffer_load_dwordx4 v5, s[52:55], 0 offen lds
v_mfma_f32_16x16x32_bf16 v[204:207], a[104:107], a[8:11], v[204:207]
ds_read_b64_tr_b16 a[96:97], v12 offset:0
v_accvgpr_read_b32 v3, a243
v_mfma_f32_16x16x32_bf16 v[196:199], a[104:107], a[4:7], 0
ds_read_b64_tr_b16 a[98:99], v12 offset:1024
v_cvt_pk_bf16_f32 v2, v2, v3
v_accvgpr_write_b32 a241, v2
v_mfma_f32_16x16x32_bf16 v[196:199], a[108:111], a[20:23], v[196:199]
ds_read_b64_tr_b16 a[100:101], v12 offset:8192
v_accvgpr_read_b32 v2, a244
v_mfma_f32_16x16x32_bf16 v[188:191], a[108:111], a[16:19], 0
ds_read_b64_tr_b16 a[102:103], v12 offset:9216
v_accvgpr_read_b32 v3, a245
v_mfma_f32_16x16x32_bf16 v[188:191], a[104:107], a[0:3], v[188:191]
s_add_u32 m0, s17, 0x10400
s_waitcnt lgkmcnt(4)
v_cvt_pk_bf16_f32 v2, v2, v3
v_accvgpr_write_b32 a242, v2
v_mfma_f32_16x16x32_bf16 v[216:219], a[0:3], a[80:83], 0
buffer_load_dwordx4 v5, s[52:55], s13 offen lds
v_mfma_f32_16x16x32_bf16 v[216:219], a[16:19], a[84:87], v[216:219]
ds_read_b64_tr_b16 a[104:105], v13 offset:0
v_accvgpr_read_b32 v2, a246
v_mfma_f32_16x16x32_bf16 v[224:227], a[20:23], a[84:87], 0
ds_read_b64_tr_b16 a[106:107], v13 offset:1024
v_accvgpr_read_b32 v3, a247
v_cvt_pk_bf16_f32 v2, v2, v3
v_mfma_f32_16x16x32_bf16 v[224:227], a[4:7], a[80:83], v[224:227]
ds_read_b64_tr_b16 a[108:109], v13 offset:8192
v_accvgpr_write_b32 a243, v2
v_mfma_f32_16x16x32_bf16 v[232:235], a[8:11], a[80:83], 0
ds_read_b64_tr_b16 a[110:111], v13 offset:9216
v_accvgpr_read_b32 v2, a248
v_mfma_f32_16x16x32_bf16 v[232:235], a[24:27], a[84:87], v[232:235]
v_accvgpr_read_b32 v3, a249
v_cvt_pk_bf16_f32 v2, v2, v3
v_accvgpr_write_b32 a248, v2
v_mfma_f32_16x16x32_bf16 v[240:243], a[28:31], a[84:87], 0
s_add_u32 m0, s17, 0x10800
v_accvgpr_read_b32 v2, a250
v_accvgpr_read_b32 v3, a251
v_mfma_f32_16x16x32_bf16 v[240:243], a[12:15], a[80:83], v[240:243]
buffer_load_dwordx4 v6, s[52:55], 0 offen lds
v_mfma_f32_16x16x32_bf16 v[244:247], a[12:15], a[88:91], 0
ds_read_b64_tr_b16 a[80:81], v12 offset:256
v_cvt_pk_bf16_f32 v2, v2, v3
v_accvgpr_write_b32 a249, v2
v_mfma_f32_16x16x32_bf16 v[244:247], a[28:31], a[92:95], v[244:247]
ds_read_b64_tr_b16 a[82:83], v12 offset:1280
v_accvgpr_read_b32 v2, a252
v_mfma_f32_16x16x32_bf16 v[236:239], a[24:27], a[92:95], 0
ds_read_b64_tr_b16 a[84:85], v12 offset:8448
v_accvgpr_read_b32 v3, a253
v_mfma_f32_16x16x32_bf16 v[236:239], a[8:11], a[88:91], v[236:239]
ds_read_b64_tr_b16 a[86:87], v12 offset:9472
v_cvt_pk_bf16_f32 v2, v2, v3
v_accvgpr_write_b32 a250, v2
v_mfma_f32_16x16x32_bf16 v[228:231], a[4:7], a[88:91], 0
v_accvgpr_read_b32 v2, a254
v_accvgpr_read_b32 v3, a255
v_mfma_f32_16x16x32_bf16 v[228:231], a[20:23], a[92:95], v[228:231]
s_add_u32 m0, s17, 0x10c00
v_cvt_pk_bf16_f32 v2, v2, v3
v_accvgpr_write_b32 a251, v2
v_mfma_f32_16x16x32_bf16 v[220:223], a[16:19], a[92:95], 0
buffer_load_dwordx4 v6, s[52:55], s13 offen lds
v_mfma_f32_16x16x32_bf16 v[220:223], a[0:3], a[88:91], v[220:223]
s_waitcnt lgkmcnt(4)
L_S9:
v_mfma_f32_16x16x32_bf16 v[24:27], a[96:99], a[32:35], v[24:27]
ds_read_b64_tr_b16 a[88:89], v13 offset:256
s_waitcnt vmcnt(23)
v_mfma_f32_16x16x32_bf16 v[24:27], a[100:103], a[48:51], v[24:27]
ds_read_b64_tr_b16 a[90:91], v13 offset:1280
L_padA5:
s_cmp_eq_u32 s95, 1
s_cbranch_scc1 L_padA9
v_mfma_f32_16x16x32_bf16 v[32:35], a[100:103], a[52:55], v[32:35]
ds_read_b64_tr_b16 a[92:93], v13 offset:8448
v_mfma_f32_16x16x32_bf16 v[32:35], a[96:99], a[36:39], v[32:35]
ds_read_b64_tr_b16 a[94:95], v13 offset:9472
v_mfma_f32_16x16x32_bf16 v[40:43], a[96:99], a[40:43], v[40:43]
ds_read_b128 a[0:3], v8 offset:0
s_add_u32 m0, s18, 0x14000
v_mfma_f32_16x16x32_bf16 v[40:43], a[100:103], a[56:59], v[40:43]
buffer_load_dwordx4 v7, s[68:71], 0 offen lds
v_mfma_f32_16x16x32_bf16 v[48:51], a[100:103], a[60:63], v[48:51]
ds_read_b128 a[16:19], v9 offset:0
v_mfma_f32_16x16x32_bf16 v[48:51], a[96:99], a[44:47], v[48:51]
ds_read_b128 a[4:7], v8 offset:2048
v_mfma_f32_16x16x32_bf16 v[52:55], a[104:107], a[44:47], v[52:55]
ds_read_b64_tr_b16 a[96:97], v12 offset:512
v_mfma_f32_16x16x32_bf16 v[52:55], a[108:111], a[60:63], v[52:55]
ds_read_b64_tr_b16 a[98:99], v12 offset:1536
v_mfma_f32_16x16x32_bf16 v[44:47], a[108:111], a[56:59], v[44:47]
ds_read_b64_tr_b16 a[100:101], v12 offset:8704
s_add_u32 s8, s28, 0x7000
v_mfma_f32_16x16x32_bf16 v[44:47], a[104:107], a[40:43], v[44:47]
buffer_store_dwordx4 a[140:143], v16, s[88:91], s8 offen sc1
v_mfma_f32_16x16x32_bf16 v[36:39], a[104:107], a[36:39], v[36:39]
ds_read_b64_tr_b16 a[102:103], v12 offset:9728
v_mfma_f32_16x16x32_bf16 v[36:39], a[108:111], a[52:55], v[36:39]
ds_read_b128 a[20:23], v9 offset:2048
v_mfma_f32_16x16x32_bf16 v[28:31], a[108:111], a[48:51], v[28:31]
ds_read_b128 a[8:11], v8 offset:4096
v_mfma_f32_16x16x32_bf16 v[28:31], a[104:107], a[32:35], v[28:31]
ds_read_b128 a[24:27], v9 offset:4096
s_waitcnt lgkmcnt(10)
v_mfma_f32_16x16x32_bf16 v[56:59], a[80:83], a[32:35], v[56:59]
ds_read_b64_tr_b16 a[104:105], v13 offset:512
v_mfma_f32_16x16x32_bf16 v[56:59], a[84:87], a[48:51], v[56:59]
ds_read_b64_tr_b16 a[106:107], v13 offset:1536
s_add_u32 m0, s18, 0x15000
v_mfma_f32_16x16x32_bf16 v[64:67], a[84:87], a[52:55], v[64:67]
buffer_load_dwordx4 v7, s[68:71], s25 offen lds
v_mfma_f32_16x16x32_bf16 v[64:67], a[80:83], a[36:39], v[64:67]
ds_read_b64_tr_b16 a[108:109], v13 offset:8704
v_mfma_f32_16x16x32_bf16 v[72:75], a[80:83], a[40:43], v[72:75]
ds_read_b64_tr_b16 a[110:111], v13 offset:9728
v_mfma_f32_16x16x32_bf16 v[72:75], a[84:87], a[56:59], v[72:75]
ds_read_b128 a[12:15], v8 offset:6144
v_mfma_f32_16x16x32_bf16 v[80:83], a[84:87], a[60:63], v[80:83]
ds_read_b128 a[28:31], v9 offset:6144
v_mfma_f32_16x16x32_bf16 v[80:83], a[80:83], a[44:47], v[80:83]
v_mfma_f32_16x16x32_bf16 v[84:87], a[88:91], a[44:47], v[84:87]
ds_read_b64_tr_b16 a[80:81], v12 offset:768
s_add_u32 m0, s18, 0x16000
v_mfma_f32_16x16x32_bf16 v[84:87], a[92:95], a[60:63], v[84:87]
buffer_load_dwordx4 v7, s[68:71], s26 offen lds
v_mfma_f32_16x16x32_bf16 v[76:79], a[92:95], a[56:59], v[76:79]
ds_read_b64_tr_b16 a[82:83], v12 offset:1792
v_lshl_add_u32 v5, s42, 19, v5
v_mfma_f32_16x16x32_bf16 v[76:79], a[88:91], a[40:43], v[76:79]
ds_read_b64_tr_b16 a[84:85], v12 offset:8960
v_lshl_add_u32 v6, s42, 19, v6
v_mfma_f32_16x16x32_bf16 v[68:71], a[88:91], a[36:39], v[68:71]
ds_read_b64_tr_b16 a[86:87], v12 offset:9984
v_lshl_add_u32 v7, s42, 18, v7
v_mfma_f32_16x16x32_bf16 v[68:71], a[92:95], a[52:55], v[68:71]
v_lshl_add_u32 v7, s42, 17, v7
v_mfma_f32_16x16x32_bf16 v[60:63], a[92:95], a[48:51], v[60:63]
v_mfma_f32_16x16x32_bf16 v[60:63], a[88:91], a[32:35], v[60:63]
s_add_u32 m0, s16, 0x0
s_waitcnt lgkmcnt(4)
s_waitcnt lgkmcnt(6)
v_mfma_f32_16x16x32_bf16 v[88:91], a[96:99], a[32:35], v[88:91]
buffer_load_dwordx4 v22, s[44:47], s20 offen lds
v_mfma_f32_16x16x32_bf16 v[88:91], a[100:103], a[48:51], v[88:91]
ds_read_b64_tr_b16 a[88:89], v13 offset:768
v_mfma_f32_16x16x32_bf16 v[96:99], a[100:103], a[52:55], v[96:99]
ds_read_b64_tr_b16 a[90:91], v13 offset:1792
v_mfma_f32_16x16x32_bf16 v[96:99], a[96:99], a[36:39], v[96:99]
ds_read_b64_tr_b16 a[92:93], v13 offset:8960
v_mfma_f32_16x16x32_bf16 v[104:107], a[96:99], a[40:43], v[104:107]
ds_read_b64_tr_b16 a[94:95], v13 offset:9984
s_add_u32 m0, s16, 0x400
v_mfma_f32_16x16x32_bf16 v[104:107], a[100:103], a[56:59], v[104:107]
buffer_load_dwordx4 v23, s[44:47], s20 offen lds
v_mfma_f32_16x16x32_bf16 v[112:115], a[100:103], a[60:63], v[112:115]
v_mfma_f32_16x16x32_bf16 v[112:115], a[96:99], a[44:47], v[112:115]
v_mfma_f32_16x16x32_bf16 v[116:119], a[104:107], a[44:47], v[116:119]
ds_read_b64_tr_b16 a[96:97], v14 offset:0
v_mfma_f32_16x16x32_bf16 v[116:119], a[108:111], a[60:63], v[116:119]
ds_read_b64_tr_b16 a[98:99], v14 offset:256
v_mfma_f32_16x16x32_bf16 v[108:111], a[108:111], a[56:59], v[108:111]
ds_read_b64_tr_b16 a[100:101], v14 offset:2048
s_add_u32 m0, s16, 0x800
v_mfma_f32_16x16x32_bf16 v[108:111], a[104:107], a[40:43], v[108:111]
buffer_load_dwordx4 v22, s[44:47], s21 offen lds
v_mfma_f32_16x16x32_bf16 v[100:103], a[104:107], a[36:39], v[100:103]
ds_read_b64_tr_b16 a[102:103], v14 offset:2304
v_mfma_f32_16x16x32_bf16 v[100:103], a[108:111], a[52:55], v[100:103]
v_mfma_f32_16x16x32_bf16 v[92:95], a[108:111], a[48:51], v[92:95]
v_mfma_f32_16x16x32_bf16 v[92:95], a[104:107], a[32:35], v[92:95]
s_add_u32 s8, s28, 0x2400
s_waitcnt lgkmcnt(4)
v_mfma_f32_16x16x32_bf16 v[120:123], a[80:83], a[32:35], v[120:123]
buffer_store_dwordx4 a[144:147], v16, s[88:91], s8 offen sc1
v_mfma_f32_16x16x32_bf16 v[120:123], a[84:87], a[48:51], v[120:123]
ds_read_b64_tr_b16 a[104:105], v15 offset:0
v_mfma_f32_16x16x32_bf16 v[128:131], a[84:87], a[52:55], v[128:131]
ds_read_b64_tr_b16 a[106:107], v15 offset:256
v_mfma_f32_16x16x32_bf16 v[128:131], a[80:83], a[36:39], v[128:131]
ds_read_b64_tr_b16 a[108:109], v15 offset:2048
v_mfma_f32_16x16x32_bf16 v[136:139], a[80:83], a[40:43], v[136:139]
ds_read_b64_tr_b16 a[110:111], v15 offset:2304
v_mfma_f32_16x16x32_bf16 v[136:139], a[84:87], a[56:59], v[136:139]
s_add_u32 m0, s16, 0xc00
v_mfma_f32_16x16x32_bf16 v[144:147], a[84:87], a[60:63], v[144:147]
buffer_load_dwordx4 v23, s[44:47], s21 offen lds
v_mfma_f32_16x16x32_bf16 v[144:147], a[80:83], a[44:47], v[144:147]
v_mfma_f32_16x16x32_bf16 v[148:151], a[88:91], a[44:47], v[148:151]
ds_read_b64_tr_b16 a[80:81], v14 offset:4096
v_mfma_f32_16x16x32_bf16 v[148:151], a[92:95], a[60:63], v[148:151]
ds_read_b64_tr_b16 a[82:83], v14 offset:4352
v_mfma_f32_16x16x32_bf16 v[140:143], a[92:95], a[56:59], v[140:143]
ds_read_b64_tr_b16 a[84:85], v14 offset:6144
v_mfma_f32_16x16x32_bf16 v[140:143], a[88:91], a[40:43], v[140:143]
ds_read_b64_tr_b16 a[86:87], v14 offset:6400
s_add_u32 m0, s16, 0x1000
v_mfma_f32_16x16x32_bf16 v[132:135], a[88:91], a[36:39], v[132:135]
buffer_load_dwordx4 v22, s[44:47], s22 offen lds
v_mfma_f32_16x16x32_bf16 v[132:135], a[92:95], a[52:55], v[132:135]
v_mfma_f32_16x16x32_bf16 v[124:127], a[92:95], a[48:51], v[124:127]
v_mfma_f32_16x16x32_bf16 v[124:127], a[88:91], a[32:35], v[124:127]
s_waitcnt lgkmcnt(4)
v_mfma_f32_16x16x32_bf16 v[152:155], a[96:99], a[32:35], v[152:155]
ds_read_b64_tr_b16 a[88:89], v15 offset:4096
s_add_u32 m0, s16, 0x1400
v_mfma_f32_16x16x32_bf16 v[152:155], a[100:103], a[48:51], v[152:155]
buffer_load_dwordx4 v23, s[44:47], s22 offen lds
v_mfma_f32_16x16x32_bf16 v[160:163], a[100:103], a[52:55], v[160:163]
ds_read_b64_tr_b16 a[90:91], v15 offset:4352
v_mfma_f32_16x16x32_bf16 v[160:163], a[96:99], a[36:39], v[160:163]
ds_read_b64_tr_b16 a[92:93], v15 offset:6144
v_mfma_f32_16x16x32_bf16 v[168:171], a[96:99], a[40:43], v[168:171]
ds_read_b64_tr_b16 a[94:95], v15 offset:6400
v_mfma_f32_16x16x32_bf16 v[168:171], a[100:103], a[56:59], v[168:171]
v_mfma_f32_16x16x32_bf16 v[176:179], a[100:103], a[60:63], v[176:179]
s_add_u32 m0, s16, 0x1800
v_mfma_f32_16x16x32_bf16 v[176:179], a[96:99], a[44:47], v[176:179]
buffer_load_dwordx4 v22, s[44:47], s23 offen lds
v_mfma_f32_16x16x32_bf16 v[180:183], a[104:107], a[44:47], v[180:183]
ds_read_b64_tr_b16 a[96:97], v14 offset:8192
v_mfma_f32_16x16x32_bf16 v[180:183], a[108:111], a[60:63], v[180:183]
ds_read_b64_tr_b16 a[98:99], v14 offset:8448
v_mfma_f32_16x16x32_bf16 v[172:175], a[108:111], a[56:59], v[172:175]
ds_read_b64_tr_b16 a[100:101], v14 offset:10240
v_mfma_f32_16x16x32_bf16 v[172:175], a[104:107], a[40:43], v[172:175]
ds_read_b64_tr_b16 a[102:103], v14 offset:10496
s_add_u32 m0, s16, 0x1c00
v_mfma_f32_16x16x32_bf16 v[164:167], a[104:107], a[36:39], v[164:167]
buffer_load_dwordx4 v23, s[44:47], s23 offen lds
v_mfma_f32_16x16x32_bf16 v[164:167], a[108:111], a[52:55], v[164:167]
v_lshl_add_u32 v22, s42, 7, v22
v_lshl_add_u32 v23, s42, 7, v23
v_mfma_f32_16x16x32_bf16 v[156:159], a[108:111], a[48:51], v[156:159]
v_mfma_f32_16x16x32_bf16 v[156:159], a[104:107], a[32:35], v[156:159]
s_waitcnt lgkmcnt(4)
v_mfma_f32_16x16x32_bf16 v[184:187], a[80:83], a[32:35], v[184:187]
ds_read_b64_tr_b16 a[104:105], v15 offset:8192
v_mfma_f32_16x16x32_bf16 v[184:187], a[84:87], a[48:51], v[184:187]
ds_read_b64_tr_b16 a[106:107], v15 offset:8448
s_add_u32 s8, s28, 0x3400
v_mfma_f32_16x16x32_bf16 v[192:195], a[84:87], a[52:55], v[192:195]
buffer_store_dwordx4 a[148:151], v16, s[88:91], s8 offen sc1
v_mfma_f32_16x16x32_bf16 v[192:195], a[80:83], a[36:39], v[192:195]
ds_read_b64_tr_b16 a[108:109], v15 offset:10240
v_mfma_f32_16x16x32_bf16 v[200:203], a[80:83], a[40:43], v[200:203]
ds_read_b64_tr_b16 a[110:111], v15 offset:10496
v_add_u32 v12, 0x8000, v12
v_mfma_f32_16x16x32_bf16 v[200:203], a[84:87], a[56:59], v[200:203]
v_add_u32 v13, 0x8000, v13
v_add_u32 v14, 0x8000, v14
v_mfma_f32_16x16x32_bf16 v[208:211], a[84:87], a[60:63], v[208:211]
v_add_u32 v15, 0x8000, v15
v_mfma_f32_16x16x32_bf16 v[208:211], a[80:83], a[44:47], v[208:211]
v_mfma_f32_16x16x32_bf16 v[212:215], a[88:91], a[44:47], v[212:215]
s_waitcnt vmcnt(28) lgkmcnt(0)
v_mfma_f32_16x16x32_bf16 v[212:215], a[92:95], a[60:63], v[212:215]
s_barrier
s_add_u32 m0, s17, 0x0
v_mfma_f32_16x16x32_bf16 v[204:207], a[92:95], a[56:59], v[204:207]
buffer_load_dwordx4 v5, s[52:55], 0 offen lds
v_mfma_f32_16x16x32_bf16 v[204:207], a[88:91], a[40:43], v[204:207]
ds_read_b64_tr_b16 a[80:81], v12 offset:0
v_mfma_f32_16x16x32_bf16 v[196:199], a[88:91], a[36:39], v[196:199]
ds_read_b64_tr_b16 a[82:83], v12 offset:1024
v_mfma_f32_16x16x32_bf16 v[196:199], a[92:95], a[52:55], v[196:199]
ds_read_b64_tr_b16 a[84:85], v12 offset:8192
v_mfma_f32_16x16x32_bf16 v[188:191], a[92:95], a[48:51], v[188:191]
ds_read_b64_tr_b16 a[86:87], v12 offset:9216
v_mfma_f32_16x16x32_bf16 v[188:191], a[88:91], a[32:35], v[188:191]
s_add_u32 m0, s17, 0x400
s_waitcnt lgkmcnt(4)
v_mfma_f32_16x16x32_bf16 v[216:219], a[32:35], a[96:99], v[216:219]
buffer_load_dwordx4 v5, s[52:55], s13 offen lds
v_mfma_f32_16x16x32_bf16 v[216:219], a[48:51], a[100:103], v[216:219]
ds_read_b64_tr_b16 a[88:89], v13 offset:0
v_mfma_f32_16x16x32_bf16 v[224:227], a[52:55], a[100:103], v[224:227]
ds_read_b64_tr_b16 a[90:91], v13 offset:1024
v_mfma_f32_16x16x32_bf16 v[224:227], a[36:39], a[96:99], v[224:227]
ds_read_b64_tr_b16 a[92:93], v13 offset:8192
v_mfma_f32_16x16x32_bf16 v[232:235], a[40:43], a[96:99], v[232:235]
ds_read_b64_tr_b16 a[94:95], v13 offset:9216
v_mfma_f32_16x16x32_bf16 v[232:235], a[56:59], a[100:103], v[232:235]
s_add_u32 m0, s17, 0x800
v_mfma_f32_16x16x32_bf16 v[240:243], a[60:63], a[100:103], v[240:243]
buffer_load_dwordx4 v6, s[52:55], 0 offen lds
v_mfma_f32_16x16x32_bf16 v[240:243], a[44:47], a[96:99], v[240:243]
v_mfma_f32_16x16x32_bf16 v[244:247], a[44:47], a[104:107], v[244:247]
ds_read_b64_tr_b16 a[96:97], v12 offset:256
v_mfma_f32_16x16x32_bf16 v[244:247], a[60:63], a[108:111], v[244:247]
ds_read_b64_tr_b16 a[98:99], v12 offset:1280
v_mfma_f32_16x16x32_bf16 v[236:239], a[56:59], a[108:111], v[236:239]
ds_read_b64_tr_b16 a[100:101], v12 offset:8448
v_mov_b32 v21, s1
v_mfma_f32_16x16x32_bf16 v[236:239], a[40:43], a[104:107], v[236:239]
ds_read_b64_tr_b16 a[102:103], v12 offset:9472
v_add_u32 v20, s0, v16
v_mfma_f32_16x16x32_bf16 v[228:231], a[36:39], a[104:107], v[228:231]
global_load_dword a120, v[20:21], off sc1
v_mfma_f32_16x16x32_bf16 v[228:231], a[52:55], a[108:111], v[228:231]
v_mfma_f32_16x16x32_bf16 v[220:223], a[48:51], a[108:111], v[220:223]
v_mfma_f32_16x16x32_bf16 v[220:223], a[32:35], a[104:107], v[220:223]
s_waitcnt lgkmcnt(4)
L_S10:
v_mfma_f32_16x16x32_bf16 v[24:27], a[80:83], a[0:3], v[24:27]
ds_read_b64_tr_b16 a[104:105], v13 offset:256
s_waitcnt vmcnt(23)
v_mfma_f32_16x16x32_bf16 v[24:27], a[84:87], a[16:19], v[24:27]
ds_read_b64_tr_b16 a[106:107], v13 offset:1280
s_add_u32 m0, s17, 0xc00
v_mfma_f32_16x16x32_bf16 v[32:35], a[84:87], a[20:23], v[32:35]
buffer_load_dwordx4 v6, s[52:55], s13 offen lds
v_mfma_f32_16x16x32_bf16 v[32:35], a[80:83], a[4:7], v[32:35]
ds_read_b64_tr_b16 a[108:109], v13 offset:8448
v_mfma_f32_16x16x32_bf16 v[40:43], a[80:83], a[8:11], v[40:43]
ds_read_b64_tr_b16 a[110:111], v13 offset:9472
v_mfma_f32_16x16x32_bf16 v[40:43], a[84:87], a[24:27], v[40:43]
ds_read_b128 a[32:35], v8 offset:32768
v_mfma_f32_16x16x32_bf16 v[48:51], a[84:87], a[28:31], v[48:51]
ds_read_b128 a[48:51], v9 offset:32768
v_mfma_f32_16x16x32_bf16 v[48:51], a[80:83], a[12:15], v[48:51]
ds_read_b128 a[36:39], v8 offset:34816
s_add_u32 m0, s18, 0x4000
v_mfma_f32_16x16x32_bf16 v[52:55], a[88:91], a[12:15], v[52:55]
buffer_load_dwordx4 v7, s[68:71], 0 offen lds
v_mfma_f32_16x16x32_bf16 v[52:55], a[92:95], a[28:31], v[52:55]
ds_read_b64_tr_b16 a[80:81], v12 offset:512
v_mfma_f32_16x16x32_bf16 v[44:47], a[92:95], a[24:27], v[44:47]
ds_read_b64_tr_b16 a[82:83], v12 offset:1536
v_mfma_f32_16x16x32_bf16 v[44:47], a[88:91], a[8:11], v[44:47]
ds_read_b64_tr_b16 a[84:85], v12 offset:8704
v_mfma_f32_16x16x32_bf16 v[36:39], a[88:91], a[4:7], v[36:39]
ds_read_b64_tr_b16 a[86:87], v12 offset:9728
v_mfma_f32_16x16x32_bf16 v[36:39], a[92:95], a[20:23], v[36:39]
ds_read_b128 a[52:55], v9 offset:34816
s_add_u32 m0, s18, 0x5000
v_mfma_f32_16x16x32_bf16 v[28:31], a[92:95], a[16:19], v[28:31]
buffer_load_dwordx4 v7, s[68:71], s25 offen lds
v_mfma_f32_16x16x32_bf16 v[28:31], a[88:91], a[0:3], v[28:31]
ds_read_b128 a[40:43], v8 offset:36864
s_waitcnt lgkmcnt(9)
v_mfma_f32_16x16x32_bf16 v[56:59], a[96:99], a[0:3], v[56:59]
ds_read_b64_tr_b16 a[88:89], v13 offset:512
v_mfma_f32_16x16x32_bf16 v[56:59], a[100:103], a[16:19], v[56:59]
ds_read_b64_tr_b16 a[90:91], v13 offset:1536
v_mfma_f32_16x16x32_bf16 v[64:67], a[100:103], a[20:23], v[64:67]
ds_read_b64_tr_b16 a[92:93], v13 offset:8704
v_mfma_f32_16x16x32_bf16 v[64:67], a[96:99], a[4:7], v[64:67]
ds_read_b64_tr_b16 a[94:95], v13 offset:9728
s_add_u32 m0, s18, 0x6000
v_mfma_f32_16x16x32_bf16 v[72:75], a[96:99], a[8:11], v[72:75]
buffer_load_dwordx4 v7, s[68:71], s26 offen lds
v_mfma_f32_16x16x32_bf16 v[72:75], a[100:103], a[24:27], v[72:75]
ds_read_b128 a[56:59], v9 offset:36864
v_lshl_add_u32 v5, s42, 19, v5
v_mfma_f32_16x16x32_bf16 v[80:83], a[100:103], a[28:31], v[80:83]
ds_read_b128 a[44:47], v8 offset:38912
v_lshl_add_u32 v6, s42, 19, v6
v_mfma_f32_16x16x32_bf16 v[80:83], a[96:99], a[12:15], v[80:83]
ds_read_b128 a[60:63], v9 offset:38912
v_lshl_add_u32 v7, s42, 18, v7
v_mfma_f32_16x16x32_bf16 v[84:87], a[104:107], a[12:15], v[84:87]
ds_read_b64_tr_b16 a[96:97], v12 offset:768
v_lshl_add_u32 v7, s42, 17, v7
v_mfma_f32_16x16x32_bf16 v[84:87], a[108:111], a[28:31], v[84:87]
ds_read_b64_tr_b16 a[98:99], v12 offset:1792
s_add_u32 s8, s28, 0x6400
v_mfma_f32_16x16x32_bf16 v[76:79], a[108:111], a[24:27], v[76:79]
buffer_store_dwordx4 a[152:155], v16, s[88:91], s8 offen sc1
v_mfma_f32_16x16x32_bf16 v[76:79], a[104:107], a[8:11], v[76:79]
ds_read_b64_tr_b16 a[100:101], v12 offset:8960
v_mfma_f32_16x16x32_bf16 v[68:71], a[104:107], a[4:7], v[68:71]
ds_read_b64_tr_b16 a[102:103], v12 offset:9984
v_mfma_f32_16x16x32_bf16 v[68:71], a[108:111], a[20:23], v[68:71]
v_mfma_f32_16x16x32_bf16 v[60:63], a[108:111], a[16:19], v[60:63]
v_mfma_f32_16x16x32_bf16 v[60:63], a[104:107], a[0:3], v[60:63]
s_add_u32 m0, s16, 0x8000
s_waitcnt lgkmcnt(4)
s_waitcnt lgkmcnt(7)
v_mfma_f32_16x16x32_bf16 v[88:91], a[80:83], a[0:3], v[88:91]
buffer_load_dwordx4 v22, s[44:47], s20 offen lds
v_mfma_f32_16x16x32_bf16 v[88:91], a[84:87], a[16:19], v[88:91]
ds_read_b64_tr_b16 a[104:105], v13 offset:768
v_mfma_f32_16x16x32_bf16 v[96:99], a[84:87], a[20:23], v[96:99]
ds_read_b64_tr_b16 a[106:107], v13 offset:1792
v_mfma_f32_16x16x32_bf16 v[96:99], a[80:83], a[4:7], v[96:99]
ds_read_b64_tr_b16 a[108:109], v13 offset:8960
v_mfma_f32_16x16x32_bf16 v[104:107], a[80:83], a[8:11], v[104:107]
ds_read_b64_tr_b16 a[110:111], v13 offset:9984
s_add_u32 m0, s16, 0x8400
v_mfma_f32_16x16x32_bf16 v[104:107], a[84:87], a[24:27], v[104:107]
buffer_load_dwordx4 v23, s[44:47], s20 offen lds
v_mfma_f32_16x16x32_bf16 v[112:115], a[84:87], a[28:31], v[112:115]
v_mfma_f32_16x16x32_bf16 v[112:115], a[80:83], a[12:15], v[112:115]
v_mfma_f32_16x16x32_bf16 v[116:119], a[88:91], a[12:15], v[116:119]
ds_read_b64_tr_b16 a[80:81], v14 offset:0
v_mfma_f32_16x16x32_bf16 v[116:119], a[92:95], a[28:31], v[116:119]
ds_read_b64_tr_b16 a[82:83], v14 offset:256
v_mfma_f32_16x16x32_bf16 v[108:111], a[92:95], a[24:27], v[108:111]
ds_read_b64_tr_b16 a[84:85], v14 offset:2048
s_add_u32 m0, s16, 0x8800
v_mfma_f32_16x16x32_bf16 v[108:111], a[88:91], a[8:11], v[108:111]
buffer_load_dwordx4 v22, s[44:47], s21 offen lds
v_mfma_f32_16x16x32_bf16 v[100:103], a[88:91], a[4:7], v[100:103]
ds_read_b64_tr_b16 a[86:87], v14 offset:2304
v_mfma_f32_16x16x32_bf16 v[100:103], a[92:95], a[20:23], v[100:103]
v_mfma_f32_16x16x32_bf16 v[92:95], a[92:95], a[16:19], v[92:95]
v_mfma_f32_16x16x32_bf16 v[92:95], a[88:91], a[0:3], v[92:95]
s_add_u32 m0, s16, 0x8c00
s_waitcnt lgkmcnt(4)
v_mfma_f32_16x16x32_bf16 v[120:123], a[96:99], a[0:3], v[120:123]
buffer_load_dwordx4 v23, s[44:47], s21 offen lds
v_mfma_f32_16x16x32_bf16 v[120:123], a[100:103], a[16:19], v[120:123]
ds_read_b64_tr_b16 a[88:89], v15 offset:0
v_mfma_f32_16x16x32_bf16 v[128:131], a[100:103], a[20:23], v[128:131]
ds_read_b64_tr_b16 a[90:91], v15 offset:256
v_mfma_f32_16x16x32_bf16 v[128:131], a[96:99], a[4:7], v[128:131]
ds_read_b64_tr_b16 a[92:93], v15 offset:2048
v_mfma_f32_16x16x32_bf16 v[136:139], a[96:99], a[8:11], v[136:139]
ds_read_b64_tr_b16 a[94:95], v15 offset:2304
v_mfma_f32_16x16x32_bf16 v[136:139], a[100:103], a[24:27], v[136:139]
s_add_u32 s8, s28, 0x7400
v_mfma_f32_16x16x32_bf16 v[144:147], a[100:103], a[28:31], v[144:147]
buffer_store_dwordx4 a[156:159], v16, s[88:91], s8 offen sc1
v_mfma_f32_16x16x32_bf16 v[144:147], a[96:99], a[12:15], v[144:147]
v_mfma_f32_16x16x32_bf16 v[148:151], a[104:107], a[12:15], v[148:151]
ds_read_b64_tr_b16 a[96:97], v14 offset:4096
v_mfma_f32_16x16x32_bf16 v[148:151], a[108:111], a[28:31], v[148:151]
ds_read_b64_tr_b16 a[98:99], v14 offset:4352
v_mfma_f32_16x16x32_bf16 v[140:143], a[108:111], a[24:27], v[140:143]
ds_read_b64_tr_b16 a[100:101], v14 offset:6144
v_mfma_f32_16x16x32_bf16 v[140:143], a[104:107], a[8:11], v[140:143]
ds_read_b64_tr_b16 a[102:103], v14 offset:6400
s_add_u32 m0, s16, 0x9000
v_mfma_f32_16x16x32_bf16 v[132:135], a[104:107], a[4:7], v[132:135]
buffer_load_dwordx4 v22, s[44:47], s22 offen lds
v_mfma_f32_16x16x32_bf16 v[132:135], a[108:111], a[20:23], v[132:135]
v_mfma_f32_16x16x32_bf16 v[124:127], a[108:111], a[16:19], v[124:127]
v_mfma_f32_16x16x32_bf16 v[124:127], a[104:107], a[0:3], v[124:127]
s_waitcnt lgkmcnt(4)
v_mfma_f32_16x16x32_bf16 v[152:155], a[80:83], a[0:3], v[152:155]
ds_read_b64_tr_b16 a[104:105], v15 offset:4096
s_add_u32 m0, s16, 0x9400
v_mfma_f32_16x16x32_bf16 v[152:155], a[84:87], a[16:19], v[152:155]
buffer_load_dwordx4 v23, s[44:47], s22 offen lds
v_mfma_f32_16x16x32_bf16 v[160:163], a[84:87], a[20:23], v[160:163]
ds_read_b64_tr_b16 a[106:107], v15 offset:4352
v_mfma_f32_16x16x32_bf16 v[160:163], a[80:83], a[4:7], v[160:163]
ds_read_b64_tr_b16 a[108:109], v15 offset:6144
v_mfma_f32_16x16x32_bf16 v[168:171], a[80:83], a[8:11], v[168:171]
ds_read_b64_tr_b16 a[110:111], v15 offset:6400
v_mfma_f32_16x16x32_bf16 v[168:171], a[84:87], a[24:27], v[168:171]
v_mfma_f32_16x16x32_bf16 v[176:179], a[84:87], a[28:31], v[176:179]
s_add_u32 m0, s16, 0x9800
v_mfma_f32_16x16x32_bf16 v[176:179], a[80:83], a[12:15], v[176:179]
buffer_load_dwordx4 v22, s[44:47], s23 offen lds
v_mfma_f32_16x16x32_bf16 v[180:183], a[88:91], a[12:15], v[180:183]
ds_read_b64_tr_b16 a[80:81], v14 offset:8192
v_mfma_f32_16x16x32_bf16 v[180:183], a[92:95], a[28:31], v[180:183]
ds_read_b64_tr_b16 a[82:83], v14 offset:8448
v_mfma_f32_16x16x32_bf16 v[172:175], a[92:95], a[24:27], v[172:175]
ds_read_b64_tr_b16 a[84:85], v14 offset:10240
v_mfma_f32_16x16x32_bf16 v[172:175], a[88:91], a[8:11], v[172:175]
ds_read_b64_tr_b16 a[86:87], v14 offset:10496
s_add_u32 m0, s16, 0x9c00
v_mfma_f32_16x16x32_bf16 v[164:167], a[88:91], a[4:7], v[164:167]
buffer_load_dwordx4 v23, s[44:47], s23 offen lds
v_mfma_f32_16x16x32_bf16 v[164:167], a[92:95], a[20:23], v[164:167]
v_lshl_add_u32 v22, s42, 7, v22
v_lshl_add_u32 v23, s42, 7, v23
v_mfma_f32_16x16x32_bf16 v[156:159], a[92:95], a[16:19], v[156:159]
v_mfma_f32_16x16x32_bf16 v[156:159], a[88:91], a[0:3], v[156:159]
s_waitcnt lgkmcnt(4)
v_mfma_f32_16x16x32_bf16 v[184:187], a[96:99], a[0:3], v[184:187]
ds_read_b64_tr_b16 a[88:89], v15 offset:8192
v_mfma_f32_16x16x32_bf16 v[184:187], a[100:103], a[16:19], v[184:187]
ds_read_b64_tr_b16 a[90:91], v15 offset:8448
s_add_u32 s8, s28, 0x2800
v_mfma_f32_16x16x32_bf16 v[192:195], a[100:103], a[20:23], v[192:195]
buffer_store_dwordx4 a[160:163], v16, s[88:91], s8 offen sc1
v_mfma_f32_16x16x32_bf16 v[192:195], a[96:99], a[4:7], v[192:195]
ds_read_b64_tr_b16 a[92:93], v15 offset:10240
v_mfma_f32_16x16x32_bf16 v[200:203], a[96:99], a[8:11], v[200:203]
ds_read_b64_tr_b16 a[94:95], v15 offset:10496
v_add_u32 v12, 0x8000, v12
v_mfma_f32_16x16x32_bf16 v[200:203], a[100:103], a[24:27], v[200:203]
v_add_u32 v13, 0x8000, v13
v_add_u32 v14, 0x8000, v14
v_mfma_f32_16x16x32_bf16 v[208:211], a[100:103], a[28:31], v[208:211]
v_add_u32 v15, 0x8000, v15
v_mfma_f32_16x16x32_bf16 v[208:211], a[96:99], a[12:15], v[208:211]
v_mfma_f32_16x16x32_bf16 v[212:215], a[104:107], a[12:15], v[212:215]
s_waitcnt vmcnt(29) lgkmcnt(0)
v_mfma_f32_16x16x32_bf16 v[212:215], a[108:111], a[28:31], v[212:215]
s_barrier
s_add_u32 m0, s17, 0x8000
v_mfma_f32_16x16x32_bf16 v[204:207], a[108:111], a[24:27], v[204:207]
buffer_load_dwordx4 v5, s[52:55], 0 offen lds
v_mfma_f32_16x16x32_bf16 v[204:207], a[104:107], a[8:11], v[204:207]
ds_read_b64_tr_b16 a[96:97], v12 offset:0
v_mfma_f32_16x16x32_bf16 v[196:199], a[104:107], a[4:7], v[196:199]
ds_read_b64_tr_b16 a[98:99], v12 offset:1024
v_mfma_f32_16x16x32_bf16 v[196:199], a[108:111], a[20:23], v[196:199]
ds_read_b64_tr_b16 a[100:101], v12 offset:8192
v_mfma_f32_16x16x32_bf16 v[188:191], a[108:111], a[16:19], v[188:191]
ds_read_b64_tr_b16 a[102:103], v12 offset:9216
v_mfma_f32_16x16x32_bf16 v[188:191], a[104:107], a[0:3], v[188:191]
s_add_u32 m0, s17, 0x8400
s_waitcnt lgkmcnt(4)
v_mfma_f32_16x16x32_bf16 v[216:219], a[0:3], a[80:83], v[216:219]
buffer_load_dwordx4 v5, s[52:55], s13 offen lds
v_mfma_f32_16x16x32_bf16 v[216:219], a[16:19], a[84:87], v[216:219]
ds_read_b64_tr_b16 a[104:105], v13 offset:0
v_mfma_f32_16x16x32_bf16 v[224:227], a[20:23], a[84:87], v[224:227]
ds_read_b64_tr_b16 a[106:107], v13 offset:1024
v_mfma_f32_16x16x32_bf16 v[224:227], a[4:7], a[80:83], v[224:227]
ds_read_b64_tr_b16 a[108:109], v13 offset:8192
v_mfma_f32_16x16x32_bf16 v[232:235], a[8:11], a[80:83], v[232:235]
ds_read_b64_tr_b16 a[110:111], v13 offset:9216
v_mfma_f32_16x16x32_bf16 v[232:235], a[24:27], a[84:87], v[232:235]
v_mfma_f32_16x16x32_bf16 v[240:243], a[28:31], a[84:87], v[240:243]
s_add_u32 m0, s17, 0x8800
v_mfma_f32_16x16x32_bf16 v[240:243], a[12:15], a[80:83], v[240:243]
buffer_load_dwordx4 v6, s[52:55], 0 offen lds
v_mfma_f32_16x16x32_bf16 v[244:247], a[12:15], a[88:91], v[244:247]
ds_read_b64_tr_b16 a[80:81], v12 offset:256
v_mfma_f32_16x16x32_bf16 v[244:247], a[28:31], a[92:95], v[244:247]
ds_read_b64_tr_b16 a[82:83], v12 offset:1280
v_mfma_f32_16x16x32_bf16 v[236:239], a[24:27], a[92:95], v[236:239]
ds_read_b64_tr_b16 a[84:85], v12 offset:8448
v_mfma_f32_16x16x32_bf16 v[236:239], a[8:11], a[88:91], v[236:239]
ds_read_b64_tr_b16 a[86:87], v12 offset:9472
v_mfma_f32_16x16x32_bf16 v[228:231], a[4:7], a[88:91], v[228:231]
v_mfma_f32_16x16x32_bf16 v[228:231], a[20:23], a[92:95], v[228:231]
s_add_u32 m0, s17, 0x8c00
v_mfma_f32_16x16x32_bf16 v[220:223], a[16:19], a[92:95], v[220:223]
buffer_load_dwordx4 v6, s[52:55], s13 offen lds
v_mfma_f32_16x16x32_bf16 v[220:223], a[0:3], a[88:91], v[220:223]
s_waitcnt lgkmcnt(4)
L_S11:
v_mfma_f32_16x16x32_bf16 v[24:27], a[96:99], a[32:35], v[24:27]
ds_read_b64_tr_b16 a[88:89], v13 offset:256
s_waitcnt vmcnt(24)
v_mfma_f32_16x16x32_bf16 v[24:27], a[100:103], a[48:51], v[24:27]
ds_read_b64_tr_b16 a[90:91], v13 offset:1280
v_mfma_f32_16x16x32_bf16 v[32:35], a[100:103], a[52:55], v[32:35]
ds_read_b64_tr_b16 a[92:93], v13 offset:8448
v_mfma_f32_16x16x32_bf16 v[32:35], a[96:99], a[36:39], v[32:35]
ds_read_b64_tr_b16 a[94:95], v13 offset:9472
v_mfma_f32_16x16x32_bf16 v[40:43], a[96:99], a[40:43], v[40:43]
ds_read_b128 a[0:3], v8 offset:0
s_add_u32 m0, s18, 0xc000
v_mfma_f32_16x16x32_bf16 v[40:43], a[100:103], a[56:59], v[40:43]
buffer_load_dwordx4 v7, s[68:71], 0 offen lds
v_mfma_f32_16x16x32_bf16 v[48:51], a[100:103], a[60:63], v[48:51]
ds_read_b128 a[16:19], v9 offset:0
v_mfma_f32_16x16x32_bf16 v[48:51], a[96:99], a[44:47], v[48:51]
ds_read_b128 a[4:7], v8 offset:2048
v_mfma_f32_16x16x32_bf16 v[52:55], a[104:107], a[44:47], v[52:55]
ds_read_b64_tr_b16 a[96:97], v12 offset:512
v_mfma_f32_16x16x32_bf16 v[52:55], a[108:111], a[60:63], v[52:55]
ds_read_b64_tr_b16 a[98:99], v12 offset:1536
v_mfma_f32_16x16x32_bf16 v[44:47], a[108:111], a[56:59], v[44:47]
ds_read_b64_tr_b16 a[100:101], v12 offset:8704
s_add_u32 s8, s28, 0x3800
v_mfma_f32_16x16x32_bf16 v[44:47], a[104:107], a[40:43], v[44:47]
buffer_store_dwordx4 a[164:167], v16, s[88:91], s8 offen sc1
v_mfma_f32_16x16x32_bf16 v[36:39], a[104:107], a[36:39], v[36:39]
ds_read_b64_tr_b16 a[102:103], v12 offset:9728
v_mfma_f32_16x16x32_bf16 v[36:39], a[108:111], a[52:55], v[36:39]
ds_read_b128 a[20:23], v9 offset:2048
v_mfma_f32_16x16x32_bf16 v[28:31], a[108:111], a[48:51], v[28:31]
ds_read_b128 a[8:11], v8 offset:4096
v_mfma_f32_16x16x32_bf16 v[28:31], a[104:107], a[32:35], v[28:31]
ds_read_b128 a[24:27], v9 offset:4096
s_waitcnt lgkmcnt(10)
v_mfma_f32_16x16x32_bf16 v[56:59], a[80:83], a[32:35], v[56:59]
ds_read_b64_tr_b16 a[104:105], v13 offset:512
v_mfma_f32_16x16x32_bf16 v[56:59], a[84:87], a[48:51], v[56:59]
ds_read_b64_tr_b16 a[106:107], v13 offset:1536
s_add_u32 m0, s18, 0xd000
v_mfma_f32_16x16x32_bf16 v[64:67], a[84:87], a[52:55], v[64:67]
buffer_load_dwordx4 v7, s[68:71], s25 offen lds
v_mfma_f32_16x16x32_bf16 v[64:67], a[80:83], a[36:39], v[64:67]
ds_read_b64_tr_b16 a[108:109], v13 offset:8704
v_mfma_f32_16x16x32_bf16 v[72:75], a[80:83], a[40:43], v[72:75]
ds_read_b64_tr_b16 a[110:111], v13 offset:9728
v_mfma_f32_16x16x32_bf16 v[72:75], a[84:87], a[56:59], v[72:75]
ds_read_b128 a[12:15], v8 offset:6144
v_mfma_f32_16x16x32_bf16 v[80:83], a[84:87], a[60:63], v[80:83]
ds_read_b128 a[28:31], v9 offset:6144
v_mfma_f32_16x16x32_bf16 v[80:83], a[80:83], a[44:47], v[80:83]
v_mfma_f32_16x16x32_bf16 v[84:87], a[88:91], a[44:47], v[84:87]
ds_read_b64_tr_b16 a[80:81], v12 offset:768
s_add_u32 m0, s18, 0xe000
v_mfma_f32_16x16x32_bf16 v[84:87], a[92:95], a[60:63], v[84:87]
buffer_load_dwordx4 v7, s[68:71], s26 offen lds
v_mfma_f32_16x16x32_bf16 v[76:79], a[92:95], a[56:59], v[76:79]
ds_read_b64_tr_b16 a[82:83], v12 offset:1792
v_lshl_add_u32 v5, s42, 19, v5
v_mfma_f32_16x16x32_bf16 v[76:79], a[88:91], a[40:43], v[76:79]
ds_read_b64_tr_b16 a[84:85], v12 offset:8960
v_lshl_add_u32 v6, s42, 19, v6
v_mfma_f32_16x16x32_bf16 v[68:71], a[88:91], a[36:39], v[68:71]
ds_read_b64_tr_b16 a[86:87], v12 offset:9984
v_lshl_add_u32 v7, s42, 18, v7
v_mfma_f32_16x16x32_bf16 v[68:71], a[92:95], a[52:55], v[68:71]
L_padA6:
s_cmp_eq_u32 s95, 1
s_cbranch_scc1 L_padA10
v_lshl_add_u32 v7, s42, 17, v7
v_mfma_f32_16x16x32_bf16 v[60:63], a[92:95], a[48:51], v[60:63]
v_mfma_f32_16x16x32_bf16 v[60:63], a[88:91], a[32:35], v[60:63]
s_add_u32 m0, s16, 0x0
s_waitcnt lgkmcnt(4)
s_waitcnt lgkmcnt(6)
v_mfma_f32_16x16x32_bf16 v[88:91], a[96:99], a[32:35], v[88:91]
buffer_load_dwordx4 v22, s[44:47], s20 offen lds
v_mfma_f32_16x16x32_bf16 v[88:91], a[100:103], a[48:51], v[88:91]
ds_read_b64_tr_b16 a[88:89], v13 offset:768
v_mfma_f32_16x16x32_bf16 v[96:99], a[100:103], a[52:55], v[96:99]
ds_read_b64_tr_b16 a[90:91], v13 offset:1792
v_mfma_f32_16x16x32_bf16 v[96:99], a[96:99], a[36:39], v[96:99]
ds_read_b64_tr_b16 a[92:93], v13 offset:8960
v_mfma_f32_16x16x32_bf16 v[104:107], a[96:99], a[40:43], v[104:107]
ds_read_b64_tr_b16 a[94:95], v13 offset:9984
s_add_u32 m0, s16, 0x400
v_mfma_f32_16x16x32_bf16 v[104:107], a[100:103], a[56:59], v[104:107]
buffer_load_dwordx4 v23, s[44:47], s20 offen lds
v_mfma_f32_16x16x32_bf16 v[112:115], a[100:103], a[60:63], v[112:115]
v_mfma_f32_16x16x32_bf16 v[112:115], a[96:99], a[44:47], v[112:115]
v_mfma_f32_16x16x32_bf16 v[116:119], a[104:107], a[44:47], v[116:119]
ds_read_b64_tr_b16 a[96:97], v14 offset:0
v_mfma_f32_16x16x32_bf16 v[116:119], a[108:111], a[60:63], v[116:119]
ds_read_b64_tr_b16 a[98:99], v14 offset:256
v_mfma_f32_16x16x32_bf16 v[108:111], a[108:111], a[56:59], v[108:111]
ds_read_b64_tr_b16 a[100:101], v14 offset:2048
s_add_u32 m0, s16, 0x800
v_mfma_f32_16x16x32_bf16 v[108:111], a[104:107], a[40:43], v[108:111]
buffer_load_dwordx4 v22, s[44:47], s21 offen lds
v_mfma_f32_16x16x32_bf16 v[100:103], a[104:107], a[36:39], v[100:103]
ds_read_b64_tr_b16 a[102:103], v14 offset:2304
v_mfma_f32_16x16x32_bf16 v[100:103], a[108:111], a[52:55], v[100:103]
v_mfma_f32_16x16x32_bf16 v[92:95], a[108:111], a[48:51], v[92:95]
v_mfma_f32_16x16x32_bf16 v[92:95], a[104:107], a[32:35], v[92:95]
s_add_u32 s8, s28, 0x6800
s_waitcnt lgkmcnt(4)
v_mfma_f32_16x16x32_bf16 v[120:123], a[80:83], a[32:35], v[120:123]
buffer_store_dwordx4 a[168:171], v16, s[88:91], s8 offen sc1
v_mfma_f32_16x16x32_bf16 v[120:123], a[84:87], a[48:51], v[120:123]
ds_read_b64_tr_b16 a[104:105], v15 offset:0
v_mfma_f32_16x16x32_bf16 v[128:131], a[84:87], a[52:55], v[128:131]
ds_read_b64_tr_b16 a[106:107], v15 offset:256
v_mfma_f32_16x16x32_bf16 v[128:131], a[80:83], a[36:39], v[128:131]
ds_read_b64_tr_b16 a[108:109], v15 offset:2048
v_mfma_f32_16x16x32_bf16 v[136:139], a[80:83], a[40:43], v[136:139]
ds_read_b64_tr_b16 a[110:111], v15 offset:2304
v_mfma_f32_16x16x32_bf16 v[136:139], a[84:87], a[56:59], v[136:139]
s_add_u32 m0, s16, 0xc00
v_mfma_f32_16x16x32_bf16 v[144:147], a[84:87], a[60:63], v[144:147]
buffer_load_dwordx4 v23, s[44:47], s21 offen lds
v_mfma_f32_16x16x32_bf16 v[144:147], a[80:83], a[44:47], v[144:147]
v_mfma_f32_16x16x32_bf16 v[148:151], a[88:91], a[44:47], v[148:151]
ds_read_b64_tr_b16 a[80:81], v14 offset:4096
v_mfma_f32_16x16x32_bf16 v[148:151], a[92:95], a[60:63], v[148:151]
ds_read_b64_tr_b16 a[82:83], v14 offset:4352
v_mfma_f32_16x16x32_bf16 v[140:143], a[92:95], a[56:59], v[140:143]
ds_read_b64_tr_b16 a[84:85], v14 offset:6144
v_mfma_f32_16x16x32_bf16 v[140:143], a[88:91], a[40:43], v[140:143]
ds_read_b64_tr_b16 a[86:87], v14 offset:6400
s_add_u32 m0, s16, 0x1000
v_mfma_f32_16x16x32_bf16 v[132:135], a[88:91], a[36:39], v[132:135]
buffer_load_dwordx4 v22, s[44:47], s22 offen lds
v_mfma_f32_16x16x32_bf16 v[132:135], a[92:95], a[52:55], v[132:135]
v_mfma_f32_16x16x32_bf16 v[124:127], a[92:95], a[48:51], v[124:127]
v_mfma_f32_16x16x32_bf16 v[124:127], a[88:91], a[32:35], v[124:127]
s_waitcnt lgkmcnt(4)
v_mfma_f32_16x16x32_bf16 v[152:155], a[96:99], a[32:35], v[152:155]
ds_read_b64_tr_b16 a[88:89], v15 offset:4096
s_add_u32 m0, s16, 0x1400
v_mfma_f32_16x16x32_bf16 v[152:155], a[100:103], a[48:51], v[152:155]
buffer_load_dwordx4 v23, s[44:47], s22 offen lds
v_mfma_f32_16x16x32_bf16 v[160:163], a[100:103], a[52:55], v[160:163]
ds_read_b64_tr_b16 a[90:91], v15 offset:4352
v_mfma_f32_16x16x32_bf16 v[160:163], a[96:99], a[36:39], v[160:163]
ds_read_b64_tr_b16 a[92:93], v15 offset:6144
v_mfma_f32_16x16x32_bf16 v[168:171], a[96:99], a[40:43], v[168:171]
ds_read_b64_tr_b16 a[94:95], v15 offset:6400
v_mfma_f32_16x16x32_bf16 v[168:171], a[100:103], a[56:59], v[168:171]
v_mfma_f32_16x16x32_bf16 v[176:179], a[100:103], a[60:63], v[176:179]
s_add_u32 m0, s16, 0x1800
v_mfma_f32_16x16x32_bf16 v[176:179], a[96:99], a[44:47], v[176:179]
buffer_load_dwordx4 v22, s[44:47], s23 offen lds
v_mfma_f32_16x16x32_bf16 v[180:183], a[104:107], a[44:47], v[180:183]
ds_read_b64_tr_b16 a[96:97], v14 offset:8192
v_mfma_f32_16x16x32_bf16 v[180:183], a[108:111], a[60:63], v[180:183]
ds_read_b64_tr_b16 a[98:99], v14 offset:8448
v_mfma_f32_16x16x32_bf16 v[172:175], a[108:111], a[56:59], v[172:175]
ds_read_b64_tr_b16 a[100:101], v14 offset:10240
v_mfma_f32_16x16x32_bf16 v[172:175], a[104:107], a[40:43], v[172:175]
ds_read_b64_tr_b16 a[102:103], v14 offset:10496
s_add_u32 m0, s16, 0x1c00
v_mfma_f32_16x16x32_bf16 v[164:167], a[104:107], a[36:39], v[164:167]
buffer_load_dwordx4 v23, s[44:47], s23 offen lds
v_mfma_f32_16x16x32_bf16 v[164:167], a[108:111], a[52:55], v[164:167]
v_lshl_add_u32 v22, s42, 7, v22
v_lshl_add_u32 v23, s42, 7, v23
v_mfma_f32_16x16x32_bf16 v[156:159], a[108:111], a[48:51], v[156:159]
v_mfma_f32_16x16x32_bf16 v[156:159], a[104:107], a[32:35], v[156:159]
s_waitcnt lgkmcnt(4)
v_mfma_f32_16x16x32_bf16 v[184:187], a[80:83], a[32:35], v[184:187]
ds_read_b64_tr_b16 a[104:105], v15 offset:8192
v_mfma_f32_16x16x32_bf16 v[184:187], a[84:87], a[48:51], v[184:187]
ds_read_b64_tr_b16 a[106:107], v15 offset:8448
s_add_u32 s8, s28, 0x7800
v_mfma_f32_16x16x32_bf16 v[192:195], a[84:87], a[52:55], v[192:195]
buffer_store_dwordx4 a[172:175], v16, s[88:91], s8 offen sc1
v_mfma_f32_16x16x32_bf16 v[192:195], a[80:83], a[36:39], v[192:195]
ds_read_b64_tr_b16 a[108:109], v15 offset:10240
v_mfma_f32_16x16x32_bf16 v[200:203], a[80:83], a[40:43], v[200:203]
ds_read_b64_tr_b16 a[110:111], v15 offset:10496
v_add_u32 v12, 0xffff0000, v12
v_mfma_f32_16x16x32_bf16 v[200:203], a[84:87], a[56:59], v[200:203]
v_add_u32 v13, 0xffff0000, v13
v_add_u32 v14, 0xffff0000, v14
v_mfma_f32_16x16x32_bf16 v[208:211], a[84:87], a[60:63], v[208:211]
v_add_u32 v15, 0xffff0000, v15
v_mfma_f32_16x16x32_bf16 v[208:211], a[80:83], a[44:47], v[208:211]
v_mfma_f32_16x16x32_bf16 v[212:215], a[88:91], a[44:47], v[212:215]
s_waitcnt vmcnt(29) lgkmcnt(0)
v_mfma_f32_16x16x32_bf16 v[212:215], a[92:95], a[60:63], v[212:215]
s_barrier
s_add_u32 m0, s17, 0x10000
v_mfma_f32_16x16x32_bf16 v[204:207], a[92:95], a[56:59], v[204:207]
buffer_load_dwordx4 v5, s[52:55], 0 offen lds
v_mfma_f32_16x16x32_bf16 v[204:207], a[88:91], a[40:43], v[204:207]
ds_read_b64_tr_b16 a[80:81], v12 offset:0
v_mfma_f32_16x16x32_bf16 v[196:199], a[88:91], a[36:39], v[196:199]
ds_read_b64_tr_b16 a[82:83], v12 offset:1024
v_mfma_f32_16x16x32_bf16 v[196:199], a[92:95], a[52:55], v[196:199]
ds_read_b64_tr_b16 a[84:85], v12 offset:8192
v_mfma_f32_16x16x32_bf16 v[188:191], a[92:95], a[48:51], v[188:191]
ds_read_b64_tr_b16 a[86:87], v12 offset:9216
v_mfma_f32_16x16x32_bf16 v[188:191], a[88:91], a[32:35], v[188:191]
s_add_u32 m0, s17, 0x10400
s_waitcnt lgkmcnt(4)
v_mfma_f32_16x16x32_bf16 v[216:219], a[32:35], a[96:99], v[216:219]
buffer_load_dwordx4 v5, s[52:55], s13 offen lds
v_mfma_f32_16x16x32_bf16 v[216:219], a[48:51], a[100:103], v[216:219]
ds_read_b64_tr_b16 a[88:89], v13 offset:0
v_mfma_f32_16x16x32_bf16 v[224:227], a[52:55], a[100:103], v[224:227]
ds_read_b64_tr_b16 a[90:91], v13 offset:1024
v_mfma_f32_16x16x32_bf16 v[224:227], a[36:39], a[96:99], v[224:227]
ds_read_b64_tr_b16 a[92:93], v13 offset:8192
v_mfma_f32_16x16x32_bf16 v[232:235], a[40:43], a[96:99], v[232:235]
ds_read_b64_tr_b16 a[94:95], v13 offset:9216
v_mfma_f32_16x16x32_bf16 v[232:235], a[56:59], a[100:103], v[232:235]
s_add_u32 m0, s17, 0x10800
v_mfma_f32_16x16x32_bf16 v[240:243], a[60:63], a[100:103], v[240:243]
buffer_load_dwordx4 v6, s[52:55], 0 offen lds
v_mfma_f32_16x16x32_bf16 v[240:243], a[44:47], a[96:99], v[240:243]
v_mfma_f32_16x16x32_bf16 v[244:247], a[44:47], a[104:107], v[244:247]
ds_read_b64_tr_b16 a[96:97], v12 offset:256
v_mfma_f32_16x16x32_bf16 v[244:247], a[60:63], a[108:111], v[244:247]
ds_read_b64_tr_b16 a[98:99], v12 offset:1280
v_mfma_f32_16x16x32_bf16 v[236:239], a[56:59], a[108:111], v[236:239]
ds_read_b64_tr_b16 a[100:101], v12 offset:8448
v_mfma_f32_16x16x32_bf16 v[236:239], a[40:43], a[104:107], v[236:239]
ds_read_b64_tr_b16 a[102:103], v12 offset:9472
s_add_u32 s8, s28, 0x2c00
v_mfma_f32_16x16x32_bf16 v[228:231], a[36:39], a[104:107], v[228:231]
buffer_store_dwordx4 a[176:179], v16, s[88:91], s8 offen sc1
v_mfma_f32_16x16x32_bf16 v[228:231], a[52:55], a[108:111], v[228:231]
v_mfma_f32_16x16x32_bf16 v[220:223], a[48:51], a[108:111], v[220:223]
v_mfma_f32_16x16x32_bf16 v[220:223], a[32:35], a[104:107], v[220:223]
s_waitcnt lgkmcnt(4)
L_S12:
v_mfma_f32_16x16x32_bf16 v[24:27], a[80:83], a[0:3], v[24:27]
ds_read_b64_tr_b16 a[104:105], v13 offset:256
s_waitcnt vmcnt(23)
v_mfma_f32_16x16x32_bf16 v[24:27], a[84:87], a[16:19], v[24:27]
ds_read_b64_tr_b16 a[106:107], v13 offset:1280
s_add_u32 m0, s17, 0x10c00
v_mfma_f32_16x16x32_bf16 v[32:35], a[84:87], a[20:23], v[32:35]
buffer_load_dwordx4 v6, s[52:55], s13 offen lds
v_mfma_f32_16x16x32_bf16 v[32:35], a[80:83], a[4:7], v[32:35]
ds_read_b64_tr_b16 a[108:109], v13 offset:8448
v_mfma_f32_16x16x32_bf16 v[40:43], a[80:83], a[8:11], v[40:43]
ds_read_b64_tr_b16 a[110:111], v13 offset:9472
v_mfma_f32_16x16x32_bf16 v[40:43], a[84:87], a[24:27], v[40:43]
ds_read_b128 a[32:35], v8 offset:32768
v_mfma_f32_16x16x32_bf16 v[48:51], a[84:87], a[28:31], v[48:51]
ds_read_b128 a[48:51], v9 offset:32768
v_mfma_f32_16x16x32_bf16 v[48:51], a[80:83], a[12:15], v[48:51]
ds_read_b128 a[36:39], v8 offset:34816
s_add_u32 m0, s18, 0x14000
v_mfma_f32_16x16x32_bf16 v[52:55], a[88:91], a[12:15], v[52:55]
buffer_load_dwordx4 v7, s[68:71], 0 offen lds
v_mfma_f32_16x16x32_bf16 v[52:55], a[92:95], a[28:31], v[52:55]
ds_read_b64_tr_b16 a[80:81], v12 offset:512
v_mfma_f32_16x16x32_bf16 v[44:47], a[92:95], a[24:27], v[44:47]
ds_read_b64_tr_b16 a[82:83], v12 offset:1536
v_mfma_f32_16x16x32_bf16 v[44:47], a[88:91], a[8:11], v[44:47]
ds_read_b64_tr_b16 a[84:85], v12 offset:8704
v_mfma_f32_16x16x32_bf16 v[36:39], a[88:91], a[4:7], v[36:39]
ds_read_b64_tr_b16 a[86:87], v12 offset:9728
v_mfma_f32_16x16x32_bf16 v[36:39], a[92:95], a[20:23], v[36:39]
ds_read_b128 a[52:55], v9 offset:34816
s_add_u32 m0, s18, 0x15000
v_mfma_f32_16x16x32_bf16 v[28:31], a[92:95], a[16:19], v[28:31]
buffer_load_dwordx4 v7, s[68:71], s25 offen lds
v_mfma_f32_16x16x32_bf16 v[28:31], a[88:91], a[0:3], v[28:31]
ds_read_b128 a[40:43], v8 offset:36864
s_waitcnt lgkmcnt(9)
v_mfma_f32_16x16x32_bf16 v[56:59], a[96:99], a[0:3], v[56:59]
ds_read_b64_tr_b16 a[88:89], v13 offset:512
v_mfma_f32_16x16x32_bf16 v[56:59], a[100:103], a[16:19], v[56:59]
ds_read_b64_tr_b16 a[90:91], v13 offset:1536
v_mfma_f32_16x16x32_bf16 v[64:67], a[100:103], a[20:23], v[64:67]
ds_read_b64_tr_b16 a[92:93], v13 offset:8704
v_mfma_f32_16x16x32_bf16 v[64:67], a[96:99], a[4:7], v[64:67]
ds_read_b64_tr_b16 a[94:95], v13 offset:9728
s_add_u32 m0, s18, 0x16000
v_mfma_f32_16x16x32_bf16 v[72:75], a[96:99], a[8:11], v[72:75]
buffer_load_dwordx4 v7, s[68:71], s26 offen lds
v_mfma_f32_16x16x32_bf16 v[72:75], a[100:103], a[24:27], v[72:75]
ds_read_b128 a[56:59], v9 offset:36864
v_lshl_add_u32 v5, s42, 19, v5
v_mfma_f32_16x16x32_bf16 v[80:83], a[100:103], a[28:31], v[80:83]
ds_read_b128 a[44:47], v8 offset:38912
v_lshl_add_u32 v6, s42, 19, v6
v_mfma_f32_16x16x32_bf16 v[80:83], a[96:99], a[12:15], v[80:83]
ds_read_b128 a[60:63], v9 offset:38912
v_lshl_add_u32 v7, s42, 18, v7
v_mfma_f32_16x16x32_bf16 v[84:87], a[104:107], a[12:15], v[84:87]
ds_read_b64_tr_b16 a[96:97], v12 offset:768
v_lshl_add_u32 v7, s42, 17, v7
v_mfma_f32_16x16x32_bf16 v[84:87], a[108:111], a[28:31], v[84:87]
ds_read_b64_tr_b16 a[98:99], v12 offset:1792
s_add_u32 s8, s28, 0x3c00
v_mfma_f32_16x16x32_bf16 v[76:79], a[108:111], a[24:27], v[76:79]
buffer_store_dwordx4 a[180:183], v16, s[88:91], s8 offen sc1
v_mfma_f32_16x16x32_bf16 v[76:79], a[104:107], a[8:11], v[76:79]
ds_read_b64_tr_b16 a[100:101], v12 offset:8960
v_mfma_f32_16x16x32_bf16 v[68:71], a[104:107], a[4:7], v[68:71]
ds_read_b64_tr_b16 a[102:103], v12 offset:9984
v_mfma_f32_16x16x32_bf16 v[68:71], a[108:111], a[20:23], v[68:71]
v_mfma_f32_16x16x32_bf16 v[60:63], a[108:111], a[16:19], v[60:63]
v_mfma_f32_16x16x32_bf16 v[60:63], a[104:107], a[0:3], v[60:63]
s_add_u32 m0, s16, 0x8000
s_waitcnt lgkmcnt(4)
s_waitcnt lgkmcnt(7)
v_mfma_f32_16x16x32_bf16 v[88:91], a[80:83], a[0:3], v[88:91]
buffer_load_dwordx4 v22, s[44:47], s20 offen lds
v_mfma_f32_16x16x32_bf16 v[88:91], a[84:87], a[16:19], v[88:91]
ds_read_b64_tr_b16 a[104:105], v13 offset:768
v_mfma_f32_16x16x32_bf16 v[96:99], a[84:87], a[20:23], v[96:99]
ds_read_b64_tr_b16 a[106:107], v13 offset:1792
v_mfma_f32_16x16x32_bf16 v[96:99], a[80:83], a[4:7], v[96:99]
ds_read_b64_tr_b16 a[108:109], v13 offset:8960
v_mfma_f32_16x16x32_bf16 v[104:107], a[80:83], a[8:11], v[104:107]
ds_read_b64_tr_b16 a[110:111], v13 offset:9984
s_add_u32 m0, s16, 0x8400
v_mfma_f32_16x16x32_bf16 v[104:107], a[84:87], a[24:27], v[104:107]
buffer_load_dwordx4 v23, s[44:47], s20 offen lds
v_mfma_f32_16x16x32_bf16 v[112:115], a[84:87], a[28:31], v[112:115]
v_mfma_f32_16x16x32_bf16 v[112:115], a[80:83], a[12:15], v[112:115]
v_mfma_f32_16x16x32_bf16 v[116:119], a[88:91], a[12:15], v[116:119]
ds_read_b64_tr_b16 a[80:81], v14 offset:0
v_mfma_f32_16x16x32_bf16 v[116:119], a[92:95], a[28:31], v[116:119]
ds_read_b64_tr_b16 a[82:83], v14 offset:256
v_mfma_f32_16x16x32_bf16 v[108:111], a[92:95], a[24:27], v[108:111]
ds_read_b64_tr_b16 a[84:85], v14 offset:2048
s_add_u32 m0, s16, 0x8800
v_mfma_f32_16x16x32_bf16 v[108:111], a[88:91], a[8:11], v[108:111]
buffer_load_dwordx4 v22, s[44:47], s21 offen lds
v_mfma_f32_16x16x32_bf16 v[100:103], a[88:91], a[4:7], v[100:103]
ds_read_b64_tr_b16 a[86:87], v14 offset:2304
v_mfma_f32_16x16x32_bf16 v[100:103], a[92:95], a[20:23], v[100:103]
v_mfma_f32_16x16x32_bf16 v[92:95], a[92:95], a[16:19], v[92:95]
v_mfma_f32_16x16x32_bf16 v[92:95], a[88:91], a[0:3], v[92:95]
s_add_u32 m0, s16, 0x8c00
s_waitcnt lgkmcnt(4)
v_mfma_f32_16x16x32_bf16 v[120:123], a[96:99], a[0:3], v[120:123]
buffer_load_dwordx4 v23, s[44:47], s21 offen lds
v_mfma_f32_16x16x32_bf16 v[120:123], a[100:103], a[16:19], v[120:123]
ds_read_b64_tr_b16 a[88:89], v15 offset:0
v_mfma_f32_16x16x32_bf16 v[128:131], a[100:103], a[20:23], v[128:131]
ds_read_b64_tr_b16 a[90:91], v15 offset:256
v_mfma_f32_16x16x32_bf16 v[128:131], a[96:99], a[4:7], v[128:131]
ds_read_b64_tr_b16 a[92:93], v15 offset:2048
v_mfma_f32_16x16x32_bf16 v[136:139], a[96:99], a[8:11], v[136:139]
ds_read_b64_tr_b16 a[94:95], v15 offset:2304
v_mfma_f32_16x16x32_bf16 v[136:139], a[100:103], a[24:27], v[136:139]
s_add_u32 s8, s28, 0x6c00
v_mfma_f32_16x16x32_bf16 v[144:147], a[100:103], a[28:31], v[144:147]
buffer_store_dwordx4 a[184:187], v16, s[88:91], s8 offen sc1
v_mfma_f32_16x16x32_bf16 v[144:147], a[96:99], a[12:15], v[144:147]
v_mfma_f32_16x16x32_bf16 v[148:151], a[104:107], a[12:15], v[148:151]
ds_read_b64_tr_b16 a[96:97], v14 offset:4096
v_mfma_f32_16x16x32_bf16 v[148:151], a[108:111], a[28:31], v[148:151]
ds_read_b64_tr_b16 a[98:99], v14 offset:4352
v_mfma_f32_16x16x32_bf16 v[140:143], a[108:111], a[24:27], v[140:143]
ds_read_b64_tr_b16 a[100:101], v14 offset:6144
v_mfma_f32_16x16x32_bf16 v[140:143], a[104:107], a[8:11], v[140:143]
ds_read_b64_tr_b16 a[102:103], v14 offset:6400
s_add_u32 m0, s16, 0x9000
v_mfma_f32_16x16x32_bf16 v[132:135], a[104:107], a[4:7], v[132:135]
buffer_load_dwordx4 v22, s[44:47], s22 offen lds
v_mfma_f32_16x16x32_bf16 v[132:135], a[108:111], a[20:23], v[132:135]
v_mfma_f32_16x16x32_bf16 v[124:127], a[108:111], a[16:19], v[124:127]
v_mfma_f32_16x16x32_bf16 v[124:127], a[104:107], a[0:3], v[124:127]
s_waitcnt lgkmcnt(4)
v_mfma_f32_16x16x32_bf16 v[152:155], a[80:83], a[0:3], v[152:155]
ds_read_b64_tr_b16 a[104:105], v15 offset:4096
s_add_u32 m0, s16, 0x9400
v_mfma_f32_16x16x32_bf16 v[152:155], a[84:87], a[16:19], v[152:155]
buffer_load_dwordx4 v23, s[44:47], s22 offen lds
v_mfma_f32_16x16x32_bf16 v[160:163], a[84:87], a[20:23], v[160:163]
ds_read_b64_tr_b16 a[106:107], v15 offset:4352
v_mfma_f32_16x16x32_bf16 v[160:163], a[80:83], a[4:7], v[160:163]
ds_read_b64_tr_b16 a[108:109], v15 offset:6144
v_mfma_f32_16x16x32_bf16 v[168:171], a[80:83], a[8:11], v[168:171]
ds_read_b64_tr_b16 a[110:111], v15 offset:6400
v_mfma_f32_16x16x32_bf16 v[168:171], a[84:87], a[24:27], v[168:171]
v_mfma_f32_16x16x32_bf16 v[176:179], a[84:87], a[28:31], v[176:179]
s_add_u32 m0, s16, 0x9800
v_mfma_f32_16x16x32_bf16 v[176:179], a[80:83], a[12:15], v[176:179]
buffer_load_dwordx4 v22, s[44:47], s23 offen lds
v_mfma_f32_16x16x32_bf16 v[180:183], a[88:91], a[12:15], v[180:183]
ds_read_b64_tr_b16 a[80:81], v14 offset:8192
v_mfma_f32_16x16x32_bf16 v[180:183], a[92:95], a[28:31], v[180:183]
ds_read_b64_tr_b16 a[82:83], v14 offset:8448
v_mfma_f32_16x16x32_bf16 v[172:175], a[92:95], a[24:27], v[172:175]
ds_read_b64_tr_b16 a[84:85], v14 offset:10240
v_mfma_f32_16x16x32_bf16 v[172:175], a[88:91], a[8:11], v[172:175]
ds_read_b64_tr_b16 a[86:87], v14 offset:10496
s_add_u32 m0, s16, 0x9c00
v_mfma_f32_16x16x32_bf16 v[164:167], a[88:91], a[4:7], v[164:167]
buffer_load_dwordx4 v23, s[44:47], s23 offen lds
v_mfma_f32_16x16x32_bf16 v[164:167], a[92:95], a[20:23], v[164:167]
v_lshl_add_u32 v22, s42, 7, v22
v_lshl_add_u32 v23, s42, 7, v23
v_mfma_f32_16x16x32_bf16 v[156:159], a[92:95], a[16:19], v[156:159]
v_mfma_f32_16x16x32_bf16 v[156:159], a[88:91], a[0:3], v[156:159]
s_waitcnt lgkmcnt(4)
v_mfma_f32_16x16x32_bf16 v[184:187], a[96:99], a[0:3], v[184:187]
ds_read_b64_tr_b16 a[88:89], v15 offset:8192
v_mfma_f32_16x16x32_bf16 v[184:187], a[100:103], a[16:19], v[184:187]
ds_read_b64_tr_b16 a[90:91], v15 offset:8448
s_add_u32 s8, s28, 0x7c00
v_mfma_f32_16x16x32_bf16 v[192:195], a[100:103], a[20:23], v[192:195]
buffer_store_dwordx4 a[188:191], v16, s[88:91], s8 offen sc1
v_mfma_f32_16x16x32_bf16 v[192:195], a[96:99], a[4:7], v[192:195]
ds_read_b64_tr_b16 a[92:93], v15 offset:10240
v_mfma_f32_16x16x32_bf16 v[200:203], a[96:99], a[8:11], v[200:203]
ds_read_b64_tr_b16 a[94:95], v15 offset:10496
v_add_u32 v12, 0x8000, v12
v_mfma_f32_16x16x32_bf16 v[200:203], a[100:103], a[24:27], v[200:203]
v_add_u32 v13, 0x8000, v13
v_add_u32 v14, 0x8000, v14
v_mfma_f32_16x16x32_bf16 v[208:211], a[100:103], a[28:31], v[208:211]
v_add_u32 v15, 0x8000, v15
v_mfma_f32_16x16x32_bf16 v[208:211], a[96:99], a[12:15], v[208:211]
v_mfma_f32_16x16x32_bf16 v[212:215], a[104:107], a[12:15], v[212:215]
s_waitcnt vmcnt(29) lgkmcnt(0)
v_mfma_f32_16x16x32_bf16 v[212:215], a[108:111], a[28:31], v[212:215]
s_barrier
s_add_u32 m0, s17, 0x0
v_mfma_f32_16x16x32_bf16 v[204:207], a[108:111], a[24:27], v[204:207]
buffer_load_dwordx4 v5, s[52:55], 0 offen lds
v_mfma_f32_16x16x32_bf16 v[204:207], a[104:107], a[8:11], v[204:207]
ds_read_b64_tr_b16 a[96:97], v12 offset:0
v_mfma_f32_16x16x32_bf16 v[196:199], a[104:107], a[4:7], v[196:199]
ds_read_b64_tr_b16 a[98:99], v12 offset:1024
v_mfma_f32_16x16x32_bf16 v[196:199], a[108:111], a[20:23], v[196:199]
ds_read_b64_tr_b16 a[100:101], v12 offset:8192
v_mfma_f32_16x16x32_bf16 v[188:191], a[108:111], a[16:19], v[188:191]
ds_read_b64_tr_b16 a[102:103], v12 offset:9216
v_mfma_f32_16x16x32_bf16 v[188:191], a[104:107], a[0:3], v[188:191]
s_add_u32 m0, s17, 0x400
s_waitcnt lgkmcnt(4)
v_mfma_f32_16x16x32_bf16 v[216:219], a[0:3], a[80:83], v[216:219]
buffer_load_dwordx4 v5, s[52:55], s13 offen lds
v_mfma_f32_16x16x32_bf16 v[216:219], a[16:19], a[84:87], v[216:219]
ds_read_b64_tr_b16 a[104:105], v13 offset:0
v_mfma_f32_16x16x32_bf16 v[224:227], a[20:23], a[84:87], v[224:227]
ds_read_b64_tr_b16 a[106:107], v13 offset:1024
v_mfma_f32_16x16x32_bf16 v[224:227], a[4:7], a[80:83], v[224:227]
ds_read_b64_tr_b16 a[108:109], v13 offset:8192
v_mfma_f32_16x16x32_bf16 v[232:235], a[8:11], a[80:83], v[232:235]
ds_read_b64_tr_b16 a[110:111], v13 offset:9216
v_mfma_f32_16x16x32_bf16 v[232:235], a[24:27], a[84:87], v[232:235]
v_mfma_f32_16x16x32_bf16 v[240:243], a[28:31], a[84:87], v[240:243]
s_add_u32 m0, s17, 0x800
v_mfma_f32_16x16x32_bf16 v[240:243], a[12:15], a[80:83], v[240:243]
buffer_load_dwordx4 v6, s[52:55], 0 offen lds
v_mfma_f32_16x16x32_bf16 v[244:247], a[12:15], a[88:91], v[244:247]
ds_read_b64_tr_b16 a[80:81], v12 offset:256
v_mfma_f32_16x16x32_bf16 v[244:247], a[28:31], a[92:95], v[244:247]
ds_read_b64_tr_b16 a[82:83], v12 offset:1280
v_mfma_f32_16x16x32_bf16 v[236:239], a[24:27], a[92:95], v[236:239]
ds_read_b64_tr_b16 a[84:85], v12 offset:8448
v_mfma_f32_16x16x32_bf16 v[236:239], a[8:11], a[88:91], v[236:239]
ds_read_b64_tr_b16 a[86:87], v12 offset:9472
v_mfma_f32_16x16x32_bf16 v[228:231], a[4:7], a[88:91], v[228:231]
v_mfma_f32_16x16x32_bf16 v[228:231], a[20:23], a[92:95], v[228:231]
s_add_u32 m0, s17, 0xc00
v_mfma_f32_16x16x32_bf16 v[220:223], a[16:19], a[92:95], v[220:223]
buffer_load_dwordx4 v6, s[52:55], s13 offen lds
v_mfma_f32_16x16x32_bf16 v[220:223], a[0:3], a[88:91], v[220:223]
s_waitcnt lgkmcnt(4)
L_S13:
v_mfma_f32_16x16x32_bf16 v[24:27], a[96:99], a[32:35], v[24:27]
ds_read_b64_tr_b16 a[88:89], v13 offset:256
s_waitcnt vmcnt(24)
v_mfma_f32_16x16x32_bf16 v[24:27], a[100:103], a[48:51], v[24:27]
ds_read_b64_tr_b16 a[90:91], v13 offset:1280
v_mfma_f32_16x16x32_bf16 v[32:35], a[100:103], a[52:55], v[32:35]
ds_read_b64_tr_b16 a[92:93], v13 offset:8448
v_mfma_f32_16x16x32_bf16 v[32:35], a[96:99], a[36:39], v[32:35]
ds_read_b64_tr_b16 a[94:95], v13 offset:9472
v_mfma_f32_16x16x32_bf16 v[40:43], a[96:99], a[40:43], v[40:43]
ds_read_b128 a[0:3], v8 offset:0
s_add_u32 m0, s18, 0x4000
v_mfma_f32_16x16x32_bf16 v[40:43], a[100:103], a[56:59], v[40:43]
buffer_load_dwordx4 v7, s[68:71], 0 offen lds
v_mfma_f32_16x16x32_bf16 v[48:51], a[100:103], a[60:63], v[48:51]
ds_read_b128 a[16:19], v9 offset:0
v_mfma_f32_16x16x32_bf16 v[48:51], a[96:99], a[44:47], v[48:51]
ds_read_b128 a[4:7], v8 offset:2048
v_mfma_f32_16x16x32_bf16 v[52:55], a[104:107], a[44:47], v[52:55]
ds_read_b64_tr_b16 a[96:97], v12 offset:512
v_mfma_f32_16x16x32_bf16 v[52:55], a[108:111], a[60:63], v[52:55]
ds_read_b64_tr_b16 a[98:99], v12 offset:1536
v_mfma_f32_16x16x32_bf16 v[44:47], a[108:111], a[56:59], v[44:47]
ds_read_b64_tr_b16 a[100:101], v12 offset:8704
s_add_u32 s8, s28, 0x4000
v_mfma_f32_16x16x32_bf16 v[44:47], a[104:107], a[40:43], v[44:47]
buffer_store_dwordx4 a[192:195], v16, s[88:91], s8 offen sc1
v_mfma_f32_16x16x32_bf16 v[36:39], a[104:107], a[36:39], v[36:39]
ds_read_b64_tr_b16 a[102:103], v12 offset:9728
v_mfma_f32_16x16x32_bf16 v[36:39], a[108:111], a[52:55], v[36:39]
ds_read_b128 a[20:23], v9 offset:2048
v_mfma_f32_16x16x32_bf16 v[28:31], a[108:111], a[48:51], v[28:31]
ds_read_b128 a[8:11], v8 offset:4096
v_mfma_f32_16x16x32_bf16 v[28:31], a[104:107], a[32:35], v[28:31]
ds_read_b128 a[24:27], v9 offset:4096
s_waitcnt lgkmcnt(10)
v_mfma_f32_16x16x32_bf16 v[56:59], a[80:83], a[32:35], v[56:59]
ds_read_b64_tr_b16 a[104:105], v13 offset:512
v_mfma_f32_16x16x32_bf16 v[56:59], a[84:87], a[48:51], v[56:59]
ds_read_b64_tr_b16 a[106:107], v13 offset:1536
s_add_u32 m0, s18, 0x5000
v_mfma_f32_16x16x32_bf16 v[64:67], a[84:87], a[52:55], v[64:67]
buffer_load_dwordx4 v7, s[68:71], s25 offen lds
v_mfma_f32_16x16x32_bf16 v[64:67], a[80:83], a[36:39], v[64:67]
ds_read_b64_tr_b16 a[108:109], v13 offset:8704
v_mfma_f32_16x16x32_bf16 v[72:75], a[80:83], a[40:43], v[72:75]
ds_read_b64_tr_b16 a[110:111], v13 offset:9728
v_mfma_f32_16x16x32_bf16 v[72:75], a[84:87], a[56:59], v[72:75]
ds_read_b128 a[12:15], v8 offset:6144
v_mfma_f32_16x16x32_bf16 v[80:83], a[84:87], a[60:63], v[80:83]
ds_read_b128 a[28:31], v9 offset:6144
v_mfma_f32_16x16x32_bf16 v[80:83], a[80:83], a[44:47], v[80:83]
v_mfma_f32_16x16x32_bf16 v[84:87], a[88:91], a[44:47], v[84:87]
ds_read_b64_tr_b16 a[80:81], v12 offset:768
s_add_u32 m0, s18, 0x6000
v_mfma_f32_16x16x32_bf16 v[84:87], a[92:95], a[60:63], v[84:87]
buffer_load_dwordx4 v7, s[68:71], s26 offen lds
v_mfma_f32_16x16x32_bf16 v[76:79], a[92:95], a[56:59], v[76:79]
ds_read_b64_tr_b16 a[82:83], v12 offset:1792
v_lshl_add_u32 v5, s42, 19, v5
v_mfma_f32_16x16x32_bf16 v[76:79], a[88:91], a[40:43], v[76:79]
ds_read_b64_tr_b16 a[84:85], v12 offset:8960
v_lshl_add_u32 v6, s42, 19, v6
v_mfma_f32_16x16x32_bf16 v[68:71], a[88:91], a[36:39], v[68:71]
ds_read_b64_tr_b16 a[86:87], v12 offset:9984
v_lshl_add_u32 v7, s42, 18, v7
v_mfma_f32_16x16x32_bf16 v[68:71], a[92:95], a[52:55], v[68:71]
v_lshl_add_u32 v7, s42, 17, v7
v_mfma_f32_16x16x32_bf16 v[60:63], a[92:95], a[48:51], v[60:63]
v_mfma_f32_16x16x32_bf16 v[60:63], a[88:91], a[32:35], v[60:63]
s_add_u32 m0, s16, 0x0
s_waitcnt lgkmcnt(4)
s_waitcnt lgkmcnt(6)
v_mfma_f32_16x16x32_bf16 v[88:91], a[96:99], a[32:35], v[88:91]
buffer_load_dwordx4 v22, s[44:47], s20 offen lds
v_mfma_f32_16x16x32_bf16 v[88:91], a[100:103], a[48:51], v[88:91]
ds_read_b64_tr_b16 a[88:89], v13 offset:768
v_mfma_f32_16x16x32_bf16 v[96:99], a[100:103], a[52:55], v[96:99]
ds_read_b64_tr_b16 a[90:91], v13 offset:1792
v_mfma_f32_16x16x32_bf16 v[96:99], a[96:99], a[36:39], v[96:99]
ds_read_b64_tr_b16 a[92:93], v13 offset:8960
v_mfma_f32_16x16x32_bf16 v[104:107], a[96:99], a[40:43], v[104:107]
ds_read_b64_tr_b16 a[94:95], v13 offset:9984
s_add_u32 m0, s16, 0x400
v_mfma_f32_16x16x32_bf16 v[104:107], a[100:103], a[56:59], v[104:107]
buffer_load_dwordx4 v23, s[44:47], s20 offen lds
v_mfma_f32_16x16x32_bf16 v[112:115], a[100:103], a[60:63], v[112:115]
v_mfma_f32_16x16x32_bf16 v[112:115], a[96:99], a[44:47], v[112:115]
v_mfma_f32_16x16x32_bf16 v[116:119], a[104:107], a[44:47], v[116:119]
ds_read_b64_tr_b16 a[96:97], v14 offset:0
v_mfma_f32_16x16x32_bf16 v[116:119], a[108:111], a[60:63], v[116:119]
ds_read_b64_tr_b16 a[98:99], v14 offset:256
v_mfma_f32_16x16x32_bf16 v[108:111], a[108:111], a[56:59], v[108:111]
ds_read_b64_tr_b16 a[100:101], v14 offset:2048
s_add_u32 m0, s16, 0x800
v_mfma_f32_16x16x32_bf16 v[108:111], a[104:107], a[40:43], v[108:111]
buffer_load_dwordx4 v22, s[44:47], s21 offen lds
v_mfma_f32_16x16x32_bf16 v[100:103], a[104:107], a[36:39], v[100:103]
ds_read_b64_tr_b16 a[102:103], v14 offset:2304
v_mfma_f32_16x16x32_bf16 v[100:103], a[108:111], a[52:55], v[100:103]
v_mfma_f32_16x16x32_bf16 v[92:95], a[108:111], a[48:51], v[92:95]
v_mfma_f32_16x16x32_bf16 v[92:95], a[104:107], a[32:35], v[92:95]
s_add_u32 s8, s28, 0x8000
s_waitcnt lgkmcnt(4)
v_mfma_f32_16x16x32_bf16 v[120:123], a[80:83], a[32:35], v[120:123]
buffer_store_dwordx4 a[196:199], v16, s[88:91], s8 offen sc1
v_mfma_f32_16x16x32_bf16 v[120:123], a[84:87], a[48:51], v[120:123]
ds_read_b64_tr_b16 a[104:105], v15 offset:0
v_mfma_f32_16x16x32_bf16 v[128:131], a[84:87], a[52:55], v[128:131]
ds_read_b64_tr_b16 a[106:107], v15 offset:256
v_mfma_f32_16x16x32_bf16 v[128:131], a[80:83], a[36:39], v[128:131]
ds_read_b64_tr_b16 a[108:109], v15 offset:2048
v_mfma_f32_16x16x32_bf16 v[136:139], a[80:83], a[40:43], v[136:139]
ds_read_b64_tr_b16 a[110:111], v15 offset:2304
v_mfma_f32_16x16x32_bf16 v[136:139], a[84:87], a[56:59], v[136:139]
s_add_u32 m0, s16, 0xc00
v_mfma_f32_16x16x32_bf16 v[144:147], a[84:87], a[60:63], v[144:147]
buffer_load_dwordx4 v23, s[44:47], s21 offen lds
v_mfma_f32_16x16x32_bf16 v[144:147], a[80:83], a[44:47], v[144:147]
L_padA7:
s_cmp_eq_u32 s95, 1
s_cbranch_scc1 L_padA11
v_mfma_f32_16x16x32_bf16 v[148:151], a[88:91], a[44:47], v[148:151]
ds_read_b64_tr_b16 a[80:81], v14 offset:4096
v_mfma_f32_16x16x32_bf16 v[148:151], a[92:95], a[60:63], v[148:151]
ds_read_b64_tr_b16 a[82:83], v14 offset:4352
v_mfma_f32_16x16x32_bf16 v[140:143], a[92:95], a[56:59], v[140:143]
ds_read_b64_tr_b16 a[84:85], v14 offset:6144
v_mfma_f32_16x16x32_bf16 v[140:143], a[88:91], a[40:43], v[140:143]
ds_read_b64_tr_b16 a[86:87], v14 offset:6400
s_add_u32 m0, s16, 0x1000
v_mfma_f32_16x16x32_bf16 v[132:135], a[88:91], a[36:39], v[132:135]
buffer_load_dwordx4 v22, s[44:47], s22 offen lds
v_mfma_f32_16x16x32_bf16 v[132:135], a[92:95], a[52:55], v[132:135]
v_mfma_f32_16x16x32_bf16 v[124:127], a[92:95], a[48:51], v[124:127]
v_mfma_f32_16x16x32_bf16 v[124:127], a[88:91], a[32:35], v[124:127]
s_waitcnt lgkmcnt(4)
v_mfma_f32_16x16x32_bf16 v[152:155], a[96:99], a[32:35], v[152:155]
ds_read_b64_tr_b16 a[88:89], v15 offset:4096
s_add_u32 m0, s16, 0x1400
v_mfma_f32_16x16x32_bf16 v[152:155], a[100:103], a[48:51], v[152:155]
buffer_load_dwordx4 v23, s[44:47], s22 offen lds
v_mfma_f32_16x16x32_bf16 v[160:163], a[100:103], a[52:55], v[160:163]
ds_read_b64_tr_b16 a[90:91], v15 offset:4352
v_mfma_f32_16x16x32_bf16 v[160:163], a[96:99], a[36:39], v[160:163]
ds_read_b64_tr_b16 a[92:93], v15 offset:6144
v_mfma_f32_16x16x32_bf16 v[168:171], a[96:99], a[40:43], v[168:171]
ds_read_b64_tr_b16 a[94:95], v15 offset:6400
v_mfma_f32_16x16x32_bf16 v[168:171], a[100:103], a[56:59], v[168:171]
v_mfma_f32_16x16x32_bf16 v[176:179], a[100:103], a[60:63], v[176:179]
s_add_u32 m0, s16, 0x1800
v_mfma_f32_16x16x32_bf16 v[176:179], a[96:99], a[44:47], v[176:179]
buffer_load_dwordx4 v22, s[44:47], s23 offen lds
v_mfma_f32_16x16x32_bf16 v[180:183], a[104:107], a[44:47], v[180:183]
ds_read_b64_tr_b16 a[96:97], v14 offset:8192
v_mfma_f32_16x16x32_bf16 v[180:183], a[108:111], a[60:63], v[180:183]
ds_read_b64_tr_b16 a[98:99], v14 offset:8448
v_mfma_f32_16x16x32_bf16 v[172:175], a[108:111], a[56:59], v[172:175]
ds_read_b64_tr_b16 a[100:101], v14 offset:10240
v_mfma_f32_16x16x32_bf16 v[172:175], a[104:107], a[40:43], v[172:175]
ds_read_b64_tr_b16 a[102:103], v14 offset:10496
s_add_u32 m0, s16, 0x1c00
v_mfma_f32_16x16x32_bf16 v[164:167], a[104:107], a[36:39], v[164:167]
buffer_load_dwordx4 v23, s[44:47], s23 offen lds
v_mfma_f32_16x16x32_bf16 v[164:167], a[108:111], a[52:55], v[164:167]
v_lshl_add_u32 v22, s42, 7, v22
v_lshl_add_u32 v23, s42, 7, v23
v_mfma_f32_16x16x32_bf16 v[156:159], a[108:111], a[48:51], v[156:159]
v_mfma_f32_16x16x32_bf16 v[156:159], a[104:107], a[32:35], v[156:159]
s_waitcnt lgkmcnt(4)
v_mfma_f32_16x16x32_bf16 v[184:187], a[80:83], a[32:35], v[184:187]
ds_read_b64_tr_b16 a[104:105], v15 offset:8192
v_mfma_f32_16x16x32_bf16 v[184:187], a[84:87], a[48:51], v[184:187]
ds_read_b64_tr_b16 a[106:107], v15 offset:8448
s_add_u32 s8, s28, 0x4400
v_mfma_f32_16x16x32_bf16 v[192:195], a[84:87], a[52:55], v[192:195]
buffer_store_dwordx4 a[200:203], v16, s[88:91], s8 offen sc1
v_mfma_f32_16x16x32_bf16 v[192:195], a[80:83], a[36:39], v[192:195]
ds_read_b64_tr_b16 a[108:109], v15 offset:10240
v_mfma_f32_16x16x32_bf16 v[200:203], a[80:83], a[40:43], v[200:203]
ds_read_b64_tr_b16 a[110:111], v15 offset:10496
v_add_u32 v12, 0x8000, v12
v_mfma_f32_16x16x32_bf16 v[200:203], a[84:87], a[56:59], v[200:203]
v_add_u32 v13, 0x8000, v13
v_add_u32 v14, 0x8000, v14
v_mfma_f32_16x16x32_bf16 v[208:211], a[84:87], a[60:63], v[208:211]
v_add_u32 v15, 0x8000, v15
v_mfma_f32_16x16x32_bf16 v[208:211], a[80:83], a[44:47], v[208:211]
v_mfma_f32_16x16x32_bf16 v[212:215], a[88:91], a[44:47], v[212:215]
s_waitcnt vmcnt(29) lgkmcnt(0)
v_mfma_f32_16x16x32_bf16 v[212:215], a[92:95], a[60:63], v[212:215]
s_barrier
s_add_u32 m0, s17, 0x8000
v_mfma_f32_16x16x32_bf16 v[204:207], a[92:95], a[56:59], v[204:207]
buffer_load_dwordx4 v5, s[52:55], 0 offen lds
v_mfma_f32_16x16x32_bf16 v[204:207], a[88:91], a[40:43], v[204:207]
ds_read_b64_tr_b16 a[80:81], v12 offset:0
v_mfma_f32_16x16x32_bf16 v[196:199], a[88:91], a[36:39], v[196:199]
ds_read_b64_tr_b16 a[82:83], v12 offset:1024
v_mfma_f32_16x16x32_bf16 v[196:199], a[92:95], a[52:55], v[196:199]
ds_read_b64_tr_b16 a[84:85], v12 offset:8192
v_mfma_f32_16x16x32_bf16 v[188:191], a[92:95], a[48:51], v[188:191]
ds_read_b64_tr_b16 a[86:87], v12 offset:9216
v_mfma_f32_16x16x32_bf16 v[188:191], a[88:91], a[32:35], v[188:191]
s_add_u32 m0, s17, 0x8400
s_waitcnt lgkmcnt(4)
v_mfma_f32_16x16x32_bf16 v[216:219], a[32:35], a[96:99], v[216:219]
buffer_load_dwordx4 v5, s[52:55], s13 offen lds
v_mfma_f32_16x16x32_bf16 v[216:219], a[48:51], a[100:103], v[216:219]
ds_read_b64_tr_b16 a[88:89], v13 offset:0
v_mfma_f32_16x16x32_bf16 v[224:227], a[52:55], a[100:103], v[224:227]
ds_read_b64_tr_b16 a[90:91], v13 offset:1024
v_mfma_f32_16x16x32_bf16 v[224:227], a[36:39], a[96:99], v[224:227]
ds_read_b64_tr_b16 a[92:93], v13 offset:8192
v_mfma_f32_16x16x32_bf16 v[232:235], a[40:43], a[96:99], v[232:235]
ds_read_b64_tr_b16 a[94:95], v13 offset:9216
v_mfma_f32_16x16x32_bf16 v[232:235], a[56:59], a[100:103], v[232:235]
s_add_u32 m0, s17, 0x8800
v_mfma_f32_16x16x32_bf16 v[240:243], a[60:63], a[100:103], v[240:243]
buffer_load_dwordx4 v6, s[52:55], 0 offen lds
v_mfma_f32_16x16x32_bf16 v[240:243], a[44:47], a[96:99], v[240:243]
v_mfma_f32_16x16x32_bf16 v[244:247], a[44:47], a[104:107], v[244:247]
ds_read_b64_tr_b16 a[96:97], v12 offset:256
v_mfma_f32_16x16x32_bf16 v[244:247], a[60:63], a[108:111], v[244:247]
ds_read_b64_tr_b16 a[98:99], v12 offset:1280
v_mfma_f32_16x16x32_bf16 v[236:239], a[56:59], a[108:111], v[236:239]
ds_read_b64_tr_b16 a[100:101], v12 offset:8448
v_mov_b32 v21, s1
v_mfma_f32_16x16x32_bf16 v[236:239], a[40:43], a[104:107], v[236:239]
ds_read_b64_tr_b16 a[102:103], v12 offset:9472
v_add_u32 v20, s0, v16
v_mfma_f32_16x16x32_bf16 v[228:231], a[36:39], a[104:107], v[228:231]
global_load_dword a120, v[20:21], off sc1
v_mfma_f32_16x16x32_bf16 v[228:231], a[52:55], a[108:111], v[228:231]
v_mfma_f32_16x16x32_bf16 v[220:223], a[48:51], a[108:111], v[220:223]
v_mfma_f32_16x16x32_bf16 v[220:223], a[32:35], a[104:107], v[220:223]
s_waitcnt lgkmcnt(4)
L_S14:
v_mfma_f32_16x16x32_bf16 v[24:27], a[80:83], a[0:3], v[24:27]
ds_read_b64_tr_b16 a[104:105], v13 offset:256
s_waitcnt vmcnt(23)
v_mfma_f32_16x16x32_bf16 v[24:27], a[84:87], a[16:19], v[24:27]
ds_read_b64_tr_b16 a[106:107], v13 offset:1280
s_add_u32 m0, s17, 0x8c00
v_mfma_f32_16x16x32_bf16 v[32:35], a[84:87], a[20:23], v[32:35]
buffer_load_dwordx4 v6, s[52:55], s13 offen lds
v_mfma_f32_16x16x32_bf16 v[32:35], a[80:83], a[4:7], v[32:35]
ds_read_b64_tr_b16 a[108:109], v13 offset:8448
v_mfma_f32_16x16x32_bf16 v[40:43], a[80:83], a[8:11], v[40:43]
ds_read_b64_tr_b16 a[110:111], v13 offset:9472
v_mfma_f32_16x16x32_bf16 v[40:43], a[84:87], a[24:27], v[40:43]
ds_read_b128 a[32:35], v8 offset:32768
v_mfma_f32_16x16x32_bf16 v[48:51], a[84:87], a[28:31], v[48:51]
ds_read_b128 a[48:51], v9 offset:32768
v_mfma_f32_16x16x32_bf16 v[48:51], a[80:83], a[12:15], v[48:51]
ds_read_b128 a[36:39], v8 offset:34816
s_add_u32 m0, s18, 0xc000
v_mfma_f32_16x16x32_bf16 v[52:55], a[88:91], a[12:15], v[52:55]
buffer_load_dwordx4 v7, s[68:71], 0 offen lds
v_mfma_f32_16x16x32_bf16 v[52:55], a[92:95], a[28:31], v[52:55]
ds_read_b64_tr_b16 a[80:81], v12 offset:512
v_mfma_f32_16x16x32_bf16 v[44:47], a[92:95], a[24:27], v[44:47]
ds_read_b64_tr_b16 a[82:83], v12 offset:1536
v_mfma_f32_16x16x32_bf16 v[44:47], a[88:91], a[8:11], v[44:47]
ds_read_b64_tr_b16 a[84:85], v12 offset:8704
v_mfma_f32_16x16x32_bf16 v[36:39], a[88:91], a[4:7], v[36:39]
ds_read_b64_tr_b16 a[86:87], v12 offset:9728
v_mfma_f32_16x16x32_bf16 v[36:39], a[92:95], a[20:23], v[36:39]
ds_read_b128 a[52:55], v9 offset:34816
s_add_u32 m0, s18, 0xd000
v_mfma_f32_16x16x32_bf16 v[28:31], a[92:95], a[16:19], v[28:31]
buffer_load_dwordx4 v7, s[68:71], s25 offen lds
v_mfma_f32_16x16x32_bf16 v[28:31], a[88:91], a[0:3], v[28:31]
ds_read_b128 a[40:43], v8 offset:36864
s_waitcnt lgkmcnt(9)
v_mfma_f32_16x16x32_bf16 v[56:59], a[96:99], a[0:3], v[56:59]
ds_read_b64_tr_b16 a[88:89], v13 offset:512
v_mfma_f32_16x16x32_bf16 v[56:59], a[100:103], a[16:19], v[56:59]
ds_read_b64_tr_b16 a[90:91], v13 offset:1536
v_mfma_f32_16x16x32_bf16 v[64:67], a[100:103], a[20:23], v[64:67]
ds_read_b64_tr_b16 a[92:93], v13 offset:8704
v_mfma_f32_16x16x32_bf16 v[64:67], a[96:99], a[4:7], v[64:67]
ds_read_b64_tr_b16 a[94:95], v13 offset:9728
s_add_u32 m0, s18, 0xe000
v_mfma_f32_16x16x32_bf16 v[72:75], a[96:99], a[8:11], v[72:75]
buffer_load_dwordx4 v7, s[68:71], s26 offen lds
v_mfma_f32_16x16x32_bf16 v[72:75], a[100:103], a[24:27], v[72:75]
ds_read_b128 a[56:59], v9 offset:36864
v_lshl_add_u32 v5, s42, 19, v5
v_mfma_f32_16x16x32_bf16 v[80:83], a[100:103], a[28:31], v[80:83]
ds_read_b128 a[44:47], v8 offset:38912
v_lshl_add_u32 v6, s42, 19, v6
v_mfma_f32_16x16x32_bf16 v[80:83], a[96:99], a[12:15], v[80:83]
ds_read_b128 a[60:63], v9 offset:38912
v_lshl_add_u32 v7, s42, 18, v7
v_mfma_f32_16x16x32_bf16 v[84:87], a[104:107], a[12:15], v[84:87]
ds_read_b64_tr_b16 a[96:97], v12 offset:768
v_lshl_add_u32 v7, s42, 17, v7
v_mfma_f32_16x16x32_bf16 v[84:87], a[108:111], a[28:31], v[84:87]
ds_read_b64_tr_b16 a[98:99], v12 offset:1792
s_add_u32 s8, s28, 0x8400
v_mfma_f32_16x16x32_bf16 v[76:79], a[108:111], a[24:27], v[76:79]
buffer_store_dwordx4 a[204:207], v16, s[88:91], s8 offen sc1
v_mfma_f32_16x16x32_bf16 v[76:79], a[104:107], a[8:11], v[76:79]
ds_read_b64_tr_b16 a[100:101], v12 offset:8960
v_mfma_f32_16x16x32_bf16 v[68:71], a[104:107], a[4:7], v[68:71]
ds_read_b64_tr_b16 a[102:103], v12 offset:9984
v_mfma_f32_16x16x32_bf16 v[68:71], a[108:111], a[20:23], v[68:71]
v_mfma_f32_16x16x32_bf16 v[60:63], a[108:111], a[16:19], v[60:63]
v_mfma_f32_16x16x32_bf16 v[60:63], a[104:107], a[0:3], v[60:63]
s_add_u32 m0, s16, 0x8000
s_waitcnt lgkmcnt(4)
s_waitcnt lgkmcnt(7)
v_mfma_f32_16x16x32_bf16 v[88:91], a[80:83], a[0:3], v[88:91]
buffer_load_dwordx4 v22, s[44:47], s20 offen lds
v_mfma_f32_16x16x32_bf16 v[88:91], a[84:87], a[16:19], v[88:91]
ds_read_b64_tr_b16 a[104:105], v13 offset:768
v_mfma_f32_16x16x32_bf16 v[96:99], a[84:87], a[20:23], v[96:99]
ds_read_b64_tr_b16 a[106:107], v13 offset:1792
v_mfma_f32_16x16x32_bf16 v[96:99], a[80:83], a[4:7], v[96:99]
ds_read_b64_tr_b16 a[108:109], v13 offset:8960
v_mfma_f32_16x16x32_bf16 v[104:107], a[80:83], a[8:11], v[104:107]
ds_read_b64_tr_b16 a[110:111], v13 offset:9984
s_add_u32 m0, s16, 0x8400
v_mfma_f32_16x16x32_bf16 v[104:107], a[84:87], a[24:27], v[104:107]
buffer_load_dwordx4 v23, s[44:47], s20 offen lds
v_mfma_f32_16x16x32_bf16 v[112:115], a[84:87], a[28:31], v[112:115]
v_mfma_f32_16x16x32_bf16 v[112:115], a[80:83], a[12:15], v[112:115]
v_mfma_f32_16x16x32_bf16 v[116:119], a[88:91], a[12:15], v[116:119]
ds_read_b64_tr_b16 a[80:81], v14 offset:0
v_mfma_f32_16x16x32_bf16 v[116:119], a[92:95], a[28:31], v[116:119]
ds_read_b64_tr_b16 a[82:83], v14 offset:256
v_mfma_f32_16x16x32_bf16 v[108:111], a[92:95], a[24:27], v[108:111]
ds_read_b64_tr_b16 a[84:85], v14 offset:2048
s_add_u32 m0, s16, 0x8800
v_mfma_f32_16x16x32_bf16 v[108:111], a[88:91], a[8:11], v[108:111]
buffer_load_dwordx4 v22, s[44:47], s21 offen lds
v_mfma_f32_16x16x32_bf16 v[100:103], a[88:91], a[4:7], v[100:103]
ds_read_b64_tr_b16 a[86:87], v14 offset:2304
v_mfma_f32_16x16x32_bf16 v[100:103], a[92:95], a[20:23], v[100:103]
v_mfma_f32_16x16x32_bf16 v[92:95], a[92:95], a[16:19], v[92:95]
v_mfma_f32_16x16x32_bf16 v[92:95], a[88:91], a[0:3], v[92:95]
s_add_u32 m0, s16, 0x8c00
s_waitcnt lgkmcnt(4)
v_mfma_f32_16x16x32_bf16 v[120:123], a[96:99], a[0:3], v[120:123]
buffer_load_dwordx4 v23, s[44:47], s21 offen lds
v_mfma_f32_16x16x32_bf16 v[120:123], a[100:103], a[16:19], v[120:123]
ds_read_b64_tr_b16 a[88:89], v15 offset:0
v_mfma_f32_16x16x32_bf16 v[128:131], a[100:103], a[20:23], v[128:131]
ds_read_b64_tr_b16 a[90:91], v15 offset:256
v_mfma_f32_16x16x32_bf16 v[128:131], a[96:99], a[4:7], v[128:131]
ds_read_b64_tr_b16 a[92:93], v15 offset:2048
v_mfma_f32_16x16x32_bf16 v[136:139], a[96:99], a[8:11], v[136:139]
ds_read_b64_tr_b16 a[94:95], v15 offset:2304
v_mfma_f32_16x16x32_bf16 v[136:139], a[100:103], a[24:27], v[136:139]
s_add_u32 s8, s28, 0x4800
v_mfma_f32_16x16x32_bf16 v[144:147], a[100:103], a[28:31], v[144:147]
buffer_store_dwordx4 a[208:211], v16, s[88:91], s8 offen sc1
v_mfma_f32_16x16x32_bf16 v[144:147], a[96:99], a[12:15], v[144:147]
v_mfma_f32_16x16x32_bf16 v[148:151], a[104:107], a[12:15], v[148:151]
ds_read_b64_tr_b16 a[96:97], v14 offset:4096
v_mfma_f32_16x16x32_bf16 v[148:151], a[108:111], a[28:31], v[148:151]
ds_read_b64_tr_b16 a[98:99], v14 offset:4352
v_mfma_f32_16x16x32_bf16 v[140:143], a[108:111], a[24:27], v[140:143]
ds_read_b64_tr_b16 a[100:101], v14 offset:6144
v_mfma_f32_16x16x32_bf16 v[140:143], a[104:107], a[8:11], v[140:143]
ds_read_b64_tr_b16 a[102:103], v14 offset:6400
s_add_u32 m0, s16, 0x9000
v_mfma_f32_16x16x32_bf16 v[132:135], a[104:107], a[4:7], v[132:135]
buffer_load_dwordx4 v22, s[44:47], s22 offen lds
v_mfma_f32_16x16x32_bf16 v[132:135], a[108:111], a[20:23], v[132:135]
v_mfma_f32_16x16x32_bf16 v[124:127], a[108:111], a[16:19], v[124:127]
v_mfma_f32_16x16x32_bf16 v[124:127], a[104:107], a[0:3], v[124:127]
s_waitcnt lgkmcnt(4)
v_mfma_f32_16x16x32_bf16 v[152:155], a[80:83], a[0:3], v[152:155]
ds_read_b64_tr_b16 a[104:105], v15 offset:4096
s_add_u32 m0, s16, 0x9400
v_mfma_f32_16x16x32_bf16 v[152:155], a[84:87], a[16:19], v[152:155]
buffer_load_dwordx4 v23, s[44:47], s22 offen lds
v_mfma_f32_16x16x32_bf16 v[160:163], a[84:87], a[20:23], v[160:163]
ds_read_b64_tr_b16 a[106:107], v15 offset:4352
v_mfma_f32_16x16x32_bf16 v[160:163], a[80:83], a[4:7], v[160:163]
ds_read_b64_tr_b16 a[108:109], v15 offset:6144
v_mfma_f32_16x16x32_bf16 v[168:171], a[80:83], a[8:11], v[168:171]
ds_read_b64_tr_b16 a[110:111], v15 offset:6400
v_mfma_f32_16x16x32_bf16 v[168:171], a[84:87], a[24:27], v[168:171]
v_mfma_f32_16x16x32_bf16 v[176:179], a[84:87], a[28:31], v[176:179]
s_add_u32 m0, s16, 0x9800
v_mfma_f32_16x16x32_bf16 v[176:179], a[80:83], a[12:15], v[176:179]
buffer_load_dwordx4 v22, s[44:47], s23 offen lds
v_mfma_f32_16x16x32_bf16 v[180:183], a[88:91], a[12:15], v[180:183]
ds_read_b64_tr_b16 a[80:81], v14 offset:8192
v_mfma_f32_16x16x32_bf16 v[180:183], a[92:95], a[28:31], v[180:183]
ds_read_b64_tr_b16 a[82:83], v14 offset:8448
v_mfma_f32_16x16x32_bf16 v[172:175], a[92:95], a[24:27], v[172:175]
ds_read_b64_tr_b16 a[84:85], v14 offset:10240
v_mfma_f32_16x16x32_bf16 v[172:175], a[88:91], a[8:11], v[172:175]
ds_read_b64_tr_b16 a[86:87], v14 offset:10496
s_add_u32 m0, s16, 0x9c00
v_mfma_f32_16x16x32_bf16 v[164:167], a[88:91], a[4:7], v[164:167]
buffer_load_dwordx4 v23, s[44:47], s23 offen lds
v_mfma_f32_16x16x32_bf16 v[164:167], a[92:95], a[20:23], v[164:167]
v_lshl_add_u32 v22, s42, 7, v22
v_lshl_add_u32 v23, s42, 7, v23
v_mfma_f32_16x16x32_bf16 v[156:159], a[92:95], a[16:19], v[156:159]
v_mfma_f32_16x16x32_bf16 v[156:159], a[88:91], a[0:3], v[156:159]
s_waitcnt lgkmcnt(4)
v_mfma_f32_16x16x32_bf16 v[184:187], a[96:99], a[0:3], v[184:187]
ds_read_b64_tr_b16 a[88:89], v15 offset:8192
v_mfma_f32_16x16x32_bf16 v[184:187], a[100:103], a[16:19], v[184:187]
ds_read_b64_tr_b16 a[90:91], v15 offset:8448
s_add_u32 s8, s28, 0x8800
v_mfma_f32_16x16x32_bf16 v[192:195], a[100:103], a[20:23], v[192:195]
buffer_store_dwordx4 a[212:215], v16, s[88:91], s8 offen sc1
v_mfma_f32_16x16x32_bf16 v[192:195], a[96:99], a[4:7], v[192:195]
ds_read_b64_tr_b16 a[92:93], v15 offset:10240
v_mfma_f32_16x16x32_bf16 v[200:203], a[96:99], a[8:11], v[200:203]
ds_read_b64_tr_b16 a[94:95], v15 offset:10496
v_add_u32 v12, 0xffff0000, v12
v_mfma_f32_16x16x32_bf16 v[200:203], a[100:103], a[24:27], v[200:203]
v_add_u32 v13, 0xffff0000, v13
v_add_u32 v14, 0xffff0000, v14
v_mfma_f32_16x16x32_bf16 v[208:211], a[100:103], a[28:31], v[208:211]
v_add_u32 v15, 0xffff0000, v15
v_mfma_f32_16x16x32_bf16 v[208:211], a[96:99], a[12:15], v[208:211]
v_mfma_f32_16x16x32_bf16 v[212:215], a[104:107], a[12:15], v[212:215]
s_waitcnt vmcnt(29) lgkmcnt(0)
v_mfma_f32_16x16x32_bf16 v[212:215], a[108:111], a[28:31], v[212:215]
s_barrier
s_add_u32 m0, s17, 0x10000
v_mfma_f32_16x16x32_bf16 v[204:207], a[108:111], a[24:27], v[204:207]
buffer_load_dwordx4 v5, s[52:55], 0 offen lds
v_mfma_f32_16x16x32_bf16 v[204:207], a[104:107], a[8:11], v[204:207]
ds_read_b64_tr_b16 a[96:97], v12 offset:0
v_mfma_f32_16x16x32_bf16 v[196:199], a[104:107], a[4:7], v[196:199]
ds_read_b64_tr_b16 a[98:99], v12 offset:1024
v_mfma_f32_16x16x32_bf16 v[196:199], a[108:111], a[20:23], v[196:199]
ds_read_b64_tr_b16 a[100:101], v12 offset:8192
v_mfma_f32_16x16x32_bf16 v[188:191], a[108:111], a[16:19], v[188:191]
ds_read_b64_tr_b16 a[102:103], v12 offset:9216
v_mfma_f32_16x16x32_bf16 v[188:191], a[104:107], a[0:3], v[188:191]
s_add_u32 m0, s17, 0x10400
s_waitcnt lgkmcnt(4)
v_mfma_f32_16x16x32_bf16 v[216:219], a[0:3], a[80:83], v[216:219]
buffer_load_dwordx4 v5, s[52:55], s13 offen lds
v_mfma_f32_16x16x32_bf16 v[216:219], a[16:19], a[84:87], v[216:219]
ds_read_b64_tr_b16 a[104:105], v13 offset:0
v_mfma_f32_16x16x32_bf16 v[224:227], a[20:23], a[84:87], v[224:227]
ds_read_b64_tr_b16 a[106:107], v13 offset:1024
v_mfma_f32_16x16x32_bf16 v[224:227], a[4:7], a[80:83], v[224:227]
ds_read_b64_tr_b16 a[108:109], v13 offset:8192
v_mfma_f32_16x16x32_bf16 v[232:235], a[8:11], a[80:83], v[232:235]
ds_read_b64_tr_b16 a[110:111], v13 offset:9216
v_mfma_f32_16x16x32_bf16 v[232:235], a[24:27], a[84:87], v[232:235]
v_mfma_f32_16x16x32_bf16 v[240:243], a[28:31], a[84:87], v[240:243]
s_add_u32 m0, s17, 0x10800
v_mfma_f32_16x16x32_bf16 v[240:243], a[12:15], a[80:83], v[240:243]
buffer_load_dwordx4 v6, s[52:55], 0 offen lds
v_mfma_f32_16x16x32_bf16 v[244:247], a[12:15], a[88:91], v[244:247]
ds_read_b64_tr_b16 a[80:81], v12 offset:256
v_mfma_f32_16x16x32_bf16 v[244:247], a[28:31], a[92:95], v[244:247]
ds_read_b64_tr_b16 a[82:83], v12 offset:1280
v_mfma_f32_16x16x32_bf16 v[236:239], a[24:27], a[92:95], v[236:239]
ds_read_b64_tr_b16 a[84:85], v12 offset:8448
v_mfma_f32_16x16x32_bf16 v[236:239], a[8:11], a[88:91], v[236:239]
ds_read_b64_tr_b16 a[86:87], v12 offset:9472
v_mfma_f32_16x16x32_bf16 v[228:231], a[4:7], a[88:91], v[228:231]
v_mfma_f32_16x16x32_bf16 v[228:231], a[20:23], a[92:95], v[228:231]
s_add_u32 m0, s17, 0x10c00
v_mfma_f32_16x16x32_bf16 v[220:223], a[16:19], a[92:95], v[220:223]
buffer_load_dwordx4 v6, s[52:55], s13 offen lds
v_mfma_f32_16x16x32_bf16 v[220:223], a[0:3], a[88:91], v[220:223]
s_waitcnt lgkmcnt(4)
L_S15:
v_mfma_f32_16x16x32_bf16 v[24:27], a[96:99], a[32:35], v[24:27]
ds_read_b64_tr_b16 a[88:89], v13 offset:256
s_waitcnt vmcnt(24)
v_mfma_f32_16x16x32_bf16 v[24:27], a[100:103], a[48:51], v[24:27]
ds_read_b64_tr_b16 a[90:91], v13 offset:1280
v_mfma_f32_16x16x32_bf16 v[32:35], a[100:103], a[52:55], v[32:35]
ds_read_b64_tr_b16 a[92:93], v13 offset:8448
v_mfma_f32_16x16x32_bf16 v[32:35], a[96:99], a[36:39], v[32:35]
ds_read_b64_tr_b16 a[94:95], v13 offset:9472
v_mfma_f32_16x16x32_bf16 v[40:43], a[96:99], a[40:43], v[40:43]
ds_read_b128 a[0:3], v8 offset:0
s_add_u32 m0, s18, 0x14000
v_mfma_f32_16x16x32_bf16 v[40:43], a[100:103], a[56:59], v[40:43]
buffer_load_dwordx4 v7, s[68:71], 0 offen lds
v_mfma_f32_16x16x32_bf16 v[48:51], a[100:103], a[60:63], v[48:51]
ds_read_b128 a[16:19], v9 offset:0
v_mfma_f32_16x16x32_bf16 v[48:51], a[96:99], a[44:47], v[48:51]
ds_read_b128 a[4:7], v8 offset:2048
v_mfma_f32_16x16x32_bf16 v[52:55], a[104:107], a[44:47], v[52:55]
ds_read_b64_tr_b16 a[96:97], v12 offset:512
v_mfma_f32_16x16x32_bf16 v[52:55], a[108:111], a[60:63], v[52:55]
ds_read_b64_tr_b16 a[98:99], v12 offset:1536
v_mfma_f32_16x16x32_bf16 v[44:47], a[108:111], a[56:59], v[44:47]
ds_read_b64_tr_b16 a[100:101], v12 offset:8704
s_add_u32 s8, s28, 0x4c00
v_mfma_f32_16x16x32_bf16 v[44:47], a[104:107], a[40:43], v[44:47]
buffer_store_dwordx4 a[216:219], v16, s[88:91], s8 offen sc1
v_mfma_f32_16x16x32_bf16 v[36:39], a[104:107], a[36:39], v[36:39]
ds_read_b64_tr_b16 a[102:103], v12 offset:9728
v_mfma_f32_16x16x32_bf16 v[36:39], a[108:111], a[52:55], v[36:39]
ds_read_b128 a[20:23], v9 offset:2048
v_mfma_f32_16x16x32_bf16 v[28:31], a[108:111], a[48:51], v[28:31]
ds_read_b128 a[8:11], v8 offset:4096
v_mfma_f32_16x16x32_bf16 v[28:31], a[104:107], a[32:35], v[28:31]
ds_read_b128 a[24:27], v9 offset:4096
s_waitcnt lgkmcnt(10)
v_mfma_f32_16x16x32_bf16 v[56:59], a[80:83], a[32:35], v[56:59]
ds_read_b64_tr_b16 a[104:105], v13 offset:512
v_mfma_f32_16x16x32_bf16 v[56:59], a[84:87], a[48:51], v[56:59]
ds_read_b64_tr_b16 a[106:107], v13 offset:1536
s_add_u32 m0, s18, 0x15000
v_mfma_f32_16x16x32_bf16 v[64:67], a[84:87], a[52:55], v[64:67]
buffer_load_dwordx4 v7, s[68:71], s25 offen lds
v_mfma_f32_16x16x32_bf16 v[64:67], a[80:83], a[36:39], v[64:67]
ds_read_b64_tr_b16 a[108:109], v13 offset:8704
v_mfma_f32_16x16x32_bf16 v[72:75], a[80:83], a[40:43], v[72:75]
ds_read_b64_tr_b16 a[110:111], v13 offset:9728
v_mfma_f32_16x16x32_bf16 v[72:75], a[84:87], a[56:59], v[72:75]
ds_read_b128 a[12:15], v8 offset:6144
v_mfma_f32_16x16x32_bf16 v[80:83], a[84:87], a[60:63], v[80:83]
ds_read_b128 a[28:31], v9 offset:6144
v_mfma_f32_16x16x32_bf16 v[80:83], a[80:83], a[44:47], v[80:83]
v_mfma_f32_16x16x32_bf16 v[84:87], a[88:91], a[44:47], v[84:87]
ds_read_b64_tr_b16 a[80:81], v12 offset:768
s_add_u32 m0, s18, 0x16000
v_mfma_f32_16x16x32_bf16 v[84:87], a[92:95], a[60:63], v[84:87]
buffer_load_dwordx4 v7, s[68:71], s26 offen lds
v_mfma_f32_16x16x32_bf16 v[76:79], a[92:95], a[56:59], v[76:79]
ds_read_b64_tr_b16 a[82:83], v12 offset:1792
v_lshl_add_u32 v5, s42, 19, v5
v_mfma_f32_16x16x32_bf16 v[76:79], a[88:91], a[40:43], v[76:79]
ds_read_b64_tr_b16 a[84:85], v12 offset:8960
v_lshl_add_u32 v6, s42, 19, v6
v_mfma_f32_16x16x32_bf16 v[68:71], a[88:91], a[36:39], v[68:71]
ds_read_b64_tr_b16 a[86:87], v12 offset:9984
v_lshl_add_u32 v7, s42, 18, v7
v_mfma_f32_16x16x32_bf16 v[68:71], a[92:95], a[52:55], v[68:71]
v_lshl_add_u32 v7, s42, 17, v7
v_mfma_f32_16x16x32_bf16 v[60:63], a[92:95], a[48:51], v[60:63]
v_mfma_f32_16x16x32_bf16 v[60:63], a[88:91], a[32:35], v[60:63]
s_add_u32 m0, s16, 0x0
s_waitcnt lgkmcnt(4)
s_waitcnt lgkmcnt(6)
v_mfma_f32_16x16x32_bf16 v[88:91], a[96:99], a[32:35], v[88:91]
buffer_load_dwordx4 v22, s[44:47], s20 offen lds
v_mfma_f32_16x16x32_bf16 v[88:91], a[100:103], a[48:51], v[88:91]
ds_read_b64_tr_b16 a[88:89], v13 offset:768
v_mfma_f32_16x16x32_bf16 v[96:99], a[100:103], a[52:55], v[96:99]
ds_read_b64_tr_b16 a[90:91], v13 offset:1792
v_mfma_f32_16x16x32_bf16 v[96:99], a[96:99], a[36:39], v[96:99]
ds_read_b64_tr_b16 a[92:93], v13 offset:8960
v_mfma_f32_16x16x32_bf16 v[104:107], a[96:99], a[40:43], v[104:107]
ds_read_b64_tr_b16 a[94:95], v13 offset:9984
s_add_u32 m0, s16, 0x400
v_mfma_f32_16x16x32_bf16 v[104:107], a[100:103], a[56:59], v[104:107]
buffer_load_dwordx4 v23, s[44:47], s20 offen lds
v_mfma_f32_16x16x32_bf16 v[112:115], a[100:103], a[60:63], v[112:115]
v_mfma_f32_16x16x32_bf16 v[112:115], a[96:99], a[44:47], v[112:115]
v_mfma_f32_16x16x32_bf16 v[116:119], a[104:107], a[44:47], v[116:119]
ds_read_b64_tr_b16 a[96:97], v14 offset:0
v_mfma_f32_16x16x32_bf16 v[116:119], a[108:111], a[60:63], v[116:119]
ds_read_b64_tr_b16 a[98:99], v14 offset:256
v_mfma_f32_16x16x32_bf16 v[108:111], a[108:111], a[56:59], v[108:111]
ds_read_b64_tr_b16 a[100:101], v14 offset:2048
s_add_u32 m0, s16, 0x800
v_mfma_f32_16x16x32_bf16 v[108:111], a[104:107], a[40:43], v[108:111]
buffer_load_dwordx4 v22, s[44:47], s21 offen lds
v_mfma_f32_16x16x32_bf16 v[100:103], a[104:107], a[36:39], v[100:103]
ds_read_b64_tr_b16 a[102:103], v14 offset:2304
v_mfma_f32_16x16x32_bf16 v[100:103], a[108:111], a[52:55], v[100:103]
v_mfma_f32_16x16x32_bf16 v[92:95], a[108:111], a[48:51], v[92:95]
v_mfma_f32_16x16x32_bf16 v[92:95], a[104:107], a[32:35], v[92:95]
s_add_u32 s8, s28, 0x8c00
s_waitcnt lgkmcnt(4)
v_mfma_f32_16x16x32_bf16 v[120:123], a[80:83], a[32:35], v[120:123]
buffer_store_dwordx4 a[220:223], v16, s[88:91], s8 offen sc1
v_mfma_f32_16x16x32_bf16 v[120:123], a[84:87], a[48:51], v[120:123]
ds_read_b64_tr_b16 a[104:105], v15 offset:0
v_mfma_f32_16x16x32_bf16 v[128:131], a[84:87], a[52:55], v[128:131]
ds_read_b64_tr_b16 a[106:107], v15 offset:256
v_mfma_f32_16x16x32_bf16 v[128:131], a[80:83], a[36:39], v[128:131]
ds_read_b64_tr_b16 a[108:109], v15 offset:2048
v_mfma_f32_16x16x32_bf16 v[136:139], a[80:83], a[40:43], v[136:139]
ds_read_b64_tr_b16 a[110:111], v15 offset:2304
v_mfma_f32_16x16x32_bf16 v[136:139], a[84:87], a[56:59], v[136:139]
s_add_u32 m0, s16, 0xc00
v_mfma_f32_16x16x32_bf16 v[144:147], a[84:87], a[60:63], v[144:147]
buffer_load_dwordx4 v23, s[44:47], s21 offen lds
v_mfma_f32_16x16x32_bf16 v[144:147], a[80:83], a[44:47], v[144:147]
v_mfma_f32_16x16x32_bf16 v[148:151], a[88:91], a[44:47], v[148:151]
ds_read_b64_tr_b16 a[80:81], v14 offset:4096
v_mfma_f32_16x16x32_bf16 v[148:151], a[92:95], a[60:63], v[148:151]
ds_read_b64_tr_b16 a[82:83], v14 offset:4352
v_mfma_f32_16x16x32_bf16 v[140:143], a[92:95], a[56:59], v[140:143]
ds_read_b64_tr_b16 a[84:85], v14 offset:6144
v_mfma_f32_16x16x32_bf16 v[140:143], a[88:91], a[40:43], v[140:143]
ds_read_b64_tr_b16 a[86:87], v14 offset:6400
s_add_u32 m0, s16, 0x1000
v_mfma_f32_16x16x32_bf16 v[132:135], a[88:91], a[36:39], v[132:135]
buffer_load_dwordx4 v22, s[44:47], s22 offen lds
v_mfma_f32_16x16x32_bf16 v[132:135], a[92:95], a[52:55], v[132:135]
v_mfma_f32_16x16x32_bf16 v[124:127], a[92:95], a[48:51], v[124:127]
v_mfma_f32_16x16x32_bf16 v[124:127], a[88:91], a[32:35], v[124:127]
s_waitcnt lgkmcnt(4)
v_mfma_f32_16x16x32_bf16 v[152:155], a[96:99], a[32:35], v[152:155]
ds_read_b64_tr_b16 a[88:89], v15 offset:4096
s_add_u32 m0, s16, 0x1400
v_mfma_f32_16x16x32_bf16 v[152:155], a[100:103], a[48:51], v[152:155]
buffer_load_dwordx4 v23, s[44:47], s22 offen lds
v_mfma_f32_16x16x32_bf16 v[160:163], a[100:103], a[52:55], v[160:163]
ds_read_b64_tr_b16 a[90:91], v15 offset:4352
v_mfma_f32_16x16x32_bf16 v[160:163], a[96:99], a[36:39], v[160:163]
ds_read_b64_tr_b16 a[92:93], v15 offset:6144
v_mfma_f32_16x16x32_bf16 v[168:171], a[96:99], a[40:43], v[168:171]
ds_read_b64_tr_b16 a[94:95], v15 offset:6400
v_mfma_f32_16x16x32_bf16 v[168:171], a[100:103], a[56:59], v[168:171]
v_mfma_f32_16x16x32_bf16 v[176:179], a[100:103], a[60:63], v[176:179]
s_add_u32 m0, s16, 0x1800
v_mfma_f32_16x16x32_bf16 v[176:179], a[96:99], a[44:47], v[176:179]
buffer_load_dwordx4 v22, s[44:47], s23 offen lds
v_mfma_f32_16x16x32_bf16 v[180:183], a[104:107], a[44:47], v[180:183]
ds_read_b64_tr_b16 a[96:97], v14 offset:8192
v_mfma_f32_16x16x32_bf16 v[180:183], a[108:111], a[60:63], v[180:183]
ds_read_b64_tr_b16 a[98:99], v14 offset:8448
v_mfma_f32_16x16x32_bf16 v[172:175], a[108:111], a[56:59], v[172:175]
ds_read_b64_tr_b16 a[100:101], v14 offset:10240
v_mfma_f32_16x16x32_bf16 v[172:175], a[104:107], a[40:43], v[172:175]
ds_read_b64_tr_b16 a[102:103], v14 offset:10496
s_add_u32 m0, s16, 0x1c00
v_mfma_f32_16x16x32_bf16 v[164:167], a[104:107], a[36:39], v[164:167]
buffer_load_dwordx4 v23, s[44:47], s23 offen lds
v_mfma_f32_16x16x32_bf16 v[164:167], a[108:111], a[52:55], v[164:167]
v_lshl_add_u32 v22, s42, 7, v22
v_lshl_add_u32 v23, s42, 7, v23
v_mfma_f32_16x16x32_bf16 v[156:159], a[108:111], a[48:51], v[156:159]
v_mfma_f32_16x16x32_bf16 v[156:159], a[104:107], a[32:35], v[156:159]
s_waitcnt lgkmcnt(4)
v_mfma_f32_16x16x32_bf16 v[184:187], a[80:83], a[32:35], v[184:187]
ds_read_b64_tr_b16 a[104:105], v15 offset:8192
v_mfma_f32_16x16x32_bf16 v[184:187], a[84:87], a[48:51], v[184:187]
ds_read_b64_tr_b16 a[106:107], v15 offset:8448
s_add_u32 s8, s28, 0x5000
v_mfma_f32_16x16x32_bf16 v[192:195], a[84:87], a[52:55], v[192:195]
buffer_store_dwordx4 a[224:227], v16, s[88:91], s8 offen sc1
v_mfma_f32_16x16x32_bf16 v[192:195], a[80:83], a[36:39], v[192:195]
ds_read_b64_tr_b16 a[108:109], v15 offset:10240
L_padA8:
s_cmp_eq_u32 s95, 1
s_cbranch_scc1 L_padA12
v_mfma_f32_16x16x32_bf16 v[200:203], a[80:83], a[40:43], v[200:203]
ds_read_b64_tr_b16 a[110:111], v15 offset:10496
v_add_u32 v12, 0x8000, v12
v_mfma_f32_16x16x32_bf16 v[200:203], a[84:87], a[56:59], v[200:203]
v_add_u32 v13, 0x8000, v13
v_add_u32 v14, 0x8000, v14
v_mfma_f32_16x16x32_bf16 v[208:211], a[84:87], a[60:63], v[208:211]
v_add_u32 v15, 0x8000, v15
v_mfma_f32_16x16x32_bf16 v[208:211], a[80:83], a[44:47], v[208:211]
v_mfma_f32_16x16x32_bf16 v[212:215], a[88:91], a[44:47], v[212:215]
s_waitcnt vmcnt(29) lgkmcnt(0)
v_mfma_f32_16x16x32_bf16 v[212:215], a[92:95], a[60:63], v[212:215]
s_barrier
s_add_u32 m0, s17, 0x0
v_mfma_f32_16x16x32_bf16 v[204:207], a[92:95], a[56:59], v[204:207]
buffer_load_dwordx4 v5, s[52:55], 0 offen lds
v_mfma_f32_16x16x32_bf16 v[204:207], a[88:91], a[40:43], v[204:207]
ds_read_b64_tr_b16 a[80:81], v12 offset:0
v_mfma_f32_16x16x32_bf16 v[196:199], a[88:91], a[36:39], v[196:199]
ds_read_b64_tr_b16 a[82:83], v12 offset:1024
v_mfma_f32_16x16x32_bf16 v[196:199], a[92:95], a[52:55], v[196:199]
ds_read_b64_tr_b16 a[84:85], v12 offset:8192
v_mfma_f32_16x16x32_bf16 v[188:191], a[92:95], a[48:51], v[188:191]
ds_read_b64_tr_b16 a[86:87], v12 offset:9216
v_mfma_f32_16x16x32_bf16 v[188:191], a[88:91], a[32:35], v[188:191]
s_add_u32 m0, s17, 0x400
s_waitcnt lgkmcnt(4)
v_mfma_f32_16x16x32_bf16 v[216:219], a[32:35], a[96:99], v[216:219]
buffer_load_dwordx4 v5, s[52:55], s13 offen lds
v_mfma_f32_16x16x32_bf16 v[216:219], a[48:51], a[100:103], v[216:219]
ds_read_b64_tr_b16 a[88:89], v13 offset:0
v_mfma_f32_16x16x32_bf16 v[224:227], a[52:55], a[100:103], v[224:227]
ds_read_b64_tr_b16 a[90:91], v13 offset:1024
v_mfma_f32_16x16x32_bf16 v[224:227], a[36:39], a[96:99], v[224:227]
ds_read_b64_tr_b16 a[92:93], v13 offset:8192
v_mfma_f32_16x16x32_bf16 v[232:235], a[40:43], a[96:99], v[232:235]
ds_read_b64_tr_b16 a[94:95], v13 offset:9216
v_mfma_f32_16x16x32_bf16 v[232:235], a[56:59], a[100:103], v[232:235]
v_mfma_f32_16x16x32_bf16 v[240:243], a[60:63], a[100:103], v[240:243]
s_add_u32 m0, s17, 0x800
v_mfma_f32_16x16x32_bf16 v[240:243], a[44:47], a[96:99], v[240:243]
buffer_load_dwordx4 v6, s[52:55], 0 offen lds
v_mfma_f32_16x16x32_bf16 v[244:247], a[44:47], a[104:107], v[244:247]
ds_read_b64_tr_b16 a[96:97], v12 offset:256
v_mfma_f32_16x16x32_bf16 v[244:247], a[60:63], a[108:111], v[244:247]
ds_read_b64_tr_b16 a[98:99], v12 offset:1280
v_mfma_f32_16x16x32_bf16 v[236:239], a[56:59], a[108:111], v[236:239]
ds_read_b64_tr_b16 a[100:101], v12 offset:8448
v_mfma_f32_16x16x32_bf16 v[236:239], a[40:43], a[104:107], v[236:239]
ds_read_b64_tr_b16 a[102:103], v12 offset:9472
v_mfma_f32_16x16x32_bf16 v[228:231], a[36:39], a[104:107], v[228:231]
v_mfma_f32_16x16x32_bf16 v[228:231], a[52:55], a[108:111], v[228:231]
s_add_u32 m0, s17, 0xc00
v_mfma_f32_16x16x32_bf16 v[220:223], a[48:51], a[108:111], v[220:223]
buffer_load_dwordx4 v6, s[52:55], s13 offen lds
v_mfma_f32_16x16x32_bf16 v[220:223], a[32:35], a[104:107], v[220:223]
s_waitcnt lgkmcnt(4)
L_S16:
v_mfma_f32_16x16x32_bf16 v[24:27], a[80:83], a[0:3], v[24:27]
ds_read_b64_tr_b16 a[104:105], v13 offset:256
s_waitcnt vmcnt(23)
v_mfma_f32_16x16x32_bf16 v[24:27], a[84:87], a[16:19], v[24:27]
ds_read_b64_tr_b16 a[106:107], v13 offset:1280
v_mfma_f32_16x16x32_bf16 v[32:35], a[84:87], a[20:23], v[32:35]
ds_read_b64_tr_b16 a[108:109], v13 offset:8448
v_mfma_f32_16x16x32_bf16 v[32:35], a[80:83], a[4:7], v[32:35]
ds_read_b64_tr_b16 a[110:111], v13 offset:9472
v_mfma_f32_16x16x32_bf16 v[40:43], a[80:83], a[8:11], v[40:43]
ds_read_b128 a[32:35], v8 offset:32768
s_add_u32 m0, s18, 0x4000
v_mfma_f32_16x16x32_bf16 v[40:43], a[84:87], a[24:27], v[40:43]
buffer_load_dwordx4 v7, s[68:71], 0 offen lds
v_mfma_f32_16x16x32_bf16 v[48:51], a[84:87], a[28:31], v[48:51]
ds_read_b128 a[48:51], v9 offset:32768
v_mfma_f32_16x16x32_bf16 v[48:51], a[80:83], a[12:15], v[48:51]
ds_read_b128 a[36:39], v8 offset:34816
v_mfma_f32_16x16x32_bf16 v[52:55], a[88:91], a[12:15], v[52:55]
ds_read_b64_tr_b16 a[80:81], v12 offset:512
v_mfma_f32_16x16x32_bf16 v[52:55], a[92:95], a[28:31], v[52:55]
ds_read_b64_tr_b16 a[82:83], v12 offset:1536
v_mfma_f32_16x16x32_bf16 v[44:47], a[92:95], a[24:27], v[44:47]
ds_read_b64_tr_b16 a[84:85], v12 offset:8704
s_add_u32 s8, s28, 0x9000
v_mfma_f32_16x16x32_bf16 v[44:47], a[88:91], a[8:11], v[44:47]
buffer_store_dwordx4 a[228:231], v16, s[88:91], s8 offen sc1
v_mfma_f32_16x16x32_bf16 v[36:39], a[88:91], a[4:7], v[36:39]
ds_read_b64_tr_b16 a[86:87], v12 offset:9728
v_mfma_f32_16x16x32_bf16 v[36:39], a[92:95], a[20:23], v[36:39]
ds_read_b128 a[52:55], v9 offset:34816
v_mfma_f32_16x16x32_bf16 v[28:31], a[92:95], a[16:19], v[28:31]
ds_read_b128 a[40:43], v8 offset:36864
v_mfma_f32_16x16x32_bf16 v[28:31], a[88:91], a[0:3], v[28:31]
ds_read_b128 a[56:59], v9 offset:36864
s_waitcnt lgkmcnt(10)
v_mfma_f32_16x16x32_bf16 v[56:59], a[96:99], a[0:3], v[56:59]
ds_read_b64_tr_b16 a[88:89], v13 offset:512
v_mfma_f32_16x16x32_bf16 v[56:59], a[100:103], a[16:19], v[56:59]
ds_read_b64_tr_b16 a[90:91], v13 offset:1536
s_add_u32 m0, s18, 0x5000
v_mfma_f32_16x16x32_bf16 v[64:67], a[100:103], a[20:23], v[64:67]
buffer_load_dwordx4 v7, s[68:71], s25 offen lds
v_mfma_f32_16x16x32_bf16 v[64:67], a[96:99], a[4:7], v[64:67]
ds_read_b64_tr_b16 a[92:93], v13 offset:8704
v_mfma_f32_16x16x32_bf16 v[72:75], a[96:99], a[8:11], v[72:75]
ds_read_b64_tr_b16 a[94:95], v13 offset:9728
v_mfma_f32_16x16x32_bf16 v[72:75], a[100:103], a[24:27], v[72:75]
ds_read_b128 a[44:47], v8 offset:38912
v_mfma_f32_16x16x32_bf16 v[80:83], a[100:103], a[28:31], v[80:83]
ds_read_b128 a[60:63], v9 offset:38912
v_mfma_f32_16x16x32_bf16 v[80:83], a[96:99], a[12:15], v[80:83]
v_mfma_f32_16x16x32_bf16 v[84:87], a[104:107], a[12:15], v[84:87]
ds_read_b64_tr_b16 a[96:97], v12 offset:768
s_add_u32 m0, s18, 0x6000
v_mfma_f32_16x16x32_bf16 v[84:87], a[108:111], a[28:31], v[84:87]
buffer_load_dwordx4 v7, s[68:71], s26 offen lds
v_mfma_f32_16x16x32_bf16 v[76:79], a[108:111], a[24:27], v[76:79]
ds_read_b64_tr_b16 a[98:99], v12 offset:1792
v_lshl_add_u32 v5, s42, 19, v5
v_mfma_f32_16x16x32_bf16 v[76:79], a[104:107], a[8:11], v[76:79]
ds_read_b64_tr_b16 a[100:101], v12 offset:8960
v_lshl_add_u32 v6, s42, 19, v6
v_mfma_f32_16x16x32_bf16 v[68:71], a[104:107], a[4:7], v[68:71]
ds_read_b64_tr_b16 a[102:103], v12 offset:9984
v_lshl_add_u32 v7, s42, 18, v7
v_mfma_f32_16x16x32_bf16 v[68:71], a[108:111], a[20:23], v[68:71]
v_lshl_add_u32 v7, s42, 17, v7
v_mfma_f32_16x16x32_bf16 v[60:63], a[108:111], a[16:19], v[60:63]
v_mfma_f32_16x16x32_bf16 v[60:63], a[104:107], a[0:3], v[60:63]
s_add_u32 m0, s16, 0x8000
s_waitcnt lgkmcnt(4)
s_waitcnt lgkmcnt(6)
v_mfma_f32_16x16x32_bf16 v[88:91], a[80:83], a[0:3], v[88:91]
buffer_load_dwordx4 v22, s[44:47], s20 offen lds
v_mfma_f32_16x16x32_bf16 v[88:91], a[84:87], a[16:19], v[88:91]
ds_read_b64_tr_b16 a[104:105], v13 offset:768
v_mfma_f32_16x16x32_bf16 v[96:99], a[84:87], a[20:23], v[96:99]
ds_read_b64_tr_b16 a[106:107], v13 offset:1792
v_mfma_f32_16x16x32_bf16 v[96:99], a[80:83], a[4:7], v[96:99]
ds_read_b64_tr_b16 a[108:109], v13 offset:8960
v_mfma_f32_16x16x32_bf16 v[104:107], a[80:83], a[8:11], v[104:107]
ds_read_b64_tr_b16 a[110:111], v13 offset:9984
s_add_u32 m0, s16, 0x8400
v_mfma_f32_16x16x32_bf16 v[104:107], a[84:87], a[24:27], v[104:107]
buffer_load_dwordx4 v23, s[44:47], s20 offen lds
v_mfma_f32_16x16x32_bf16 v[112:115], a[84:87], a[28:31], v[112:115]
v_mfma_f32_16x16x32_bf16 v[112:115], a[80:83], a[12:15], v[112:115]
v_mfma_f32_16x16x32_bf16 v[116:119], a[88:91], a[12:15], v[116:119]
ds_read_b64_tr_b16 a[80:81], v14 offset:0
v_mfma_f32_16x16x32_bf16 v[116:119], a[92:95], a[28:31], v[116:119]
ds_read_b64_tr_b16 a[82:83], v14 offset:256
v_mfma_f32_16x16x32_bf16 v[108:111], a[92:95], a[24:27], v[108:111]
ds_read_b64_tr_b16 a[84:85], v14 offset:2048
s_add_u32 m0, s16, 0x8800
v_mfma_f32_16x16x32_bf16 v[108:111], a[88:91], a[8:11], v[108:111]
buffer_load_dwordx4 v22, s[44:47], s21 offen lds
v_mfma_f32_16x16x32_bf16 v[100:103], a[88:91], a[4:7], v[100:103]
ds_read_b64_tr_b16 a[86:87], v14 offset:2304
v_mfma_f32_16x16x32_bf16 v[100:103], a[92:95], a[20:23], v[100:103]
v_mfma_f32_16x16x32_bf16 v[92:95], a[92:95], a[16:19], v[92:95]
v_mfma_f32_16x16x32_bf16 v[92:95], a[88:91], a[0:3], v[92:95]
s_add_u32 s8, s28, 0x5400
s_waitcnt lgkmcnt(4)
v_mfma_f32_16x16x32_bf16 v[120:123], a[96:99], a[0:3], v[120:123]
buffer_store_dwordx4 a[112:115], v16, s[88:91], s8 offen sc1
v_mfma_f32_16x16x32_bf16 v[120:123], a[100:103], a[16:19], v[120:123]
ds_read_b64_tr_b16 a[88:89], v15 offset:0
v_mfma_f32_16x16x32_bf16 v[128:131], a[100:103], a[20:23], v[128:131]
ds_read_b64_tr_b16 a[90:91], v15 offset:256
v_mfma_f32_16x16x32_bf16 v[128:131], a[96:99], a[4:7], v[128:131]
ds_read_b64_tr_b16 a[92:93], v15 offset:2048
v_mfma_f32_16x16x32_bf16 v[136:139], a[96:99], a[8:11], v[136:139]
ds_read_b64_tr_b16 a[94:95], v15 offset:2304
v_mfma_f32_16x16x32_bf16 v[136:139], a[100:103], a[24:27], v[136:139]
s_add_u32 m0, s16, 0x8c00
v_mfma_f32_16x16x32_bf16 v[144:147], a[100:103], a[28:31], v[144:147]
buffer_load_dwordx4 v23, s[44:47], s21 offen lds
v_mfma_f32_16x16x32_bf16 v[144:147], a[96:99], a[12:15], v[144:147]
v_mfma_f32_16x16x32_bf16 v[148:151], a[104:107], a[12:15], v[148:151]
ds_read_b64_tr_b16 a[96:97], v14 offset:4096
v_mfma_f32_16x16x32_bf16 v[148:151], a[108:111], a[28:31], v[148:151]
ds_read_b64_tr_b16 a[98:99], v14 offset:4352
v_mfma_f32_16x16x32_bf16 v[140:143], a[108:111], a[24:27], v[140:143]
ds_read_b64_tr_b16 a[100:101], v14 offset:6144
v_mfma_f32_16x16x32_bf16 v[140:143], a[104:107], a[8:11], v[140:143]
ds_read_b64_tr_b16 a[102:103], v14 offset:6400
s_add_u32 m0, s16, 0x9000
v_mfma_f32_16x16x32_bf16 v[132:135], a[104:107], a[4:7], v[132:135]
buffer_load_dwordx4 v22, s[44:47], s22 offen lds
v_mfma_f32_16x16x32_bf16 v[132:135], a[108:111], a[20:23], v[132:135]
v_mfma_f32_16x16x32_bf16 v[124:127], a[108:111], a[16:19], v[124:127]
v_mfma_f32_16x16x32_bf16 v[124:127], a[104:107], a[0:3], v[124:127]
s_waitcnt lgkmcnt(4)
v_mfma_f32_16x16x32_bf16 v[152:155], a[80:83], a[0:3], v[152:155]
ds_read_b64_tr_b16 a[104:105], v15 offset:4096
s_add_u32 m0, s16, 0x9400
v_mfma_f32_16x16x32_bf16 v[152:155], a[84:87], a[16:19], v[152:155]
buffer_load_dwordx4 v23, s[44:47], s22 offen lds
v_mfma_f32_16x16x32_bf16 v[160:163], a[84:87], a[20:23], v[160:163]
ds_read_b64_tr_b16 a[106:107], v15 offset:4352
v_mfma_f32_16x16x32_bf16 v[160:163], a[80:83], a[4:7], v[160:163]
ds_read_b64_tr_b16 a[108:109], v15 offset:6144
v_mfma_f32_16x16x32_bf16 v[168:171], a[80:83], a[8:11], v[168:171]
ds_read_b64_tr_b16 a[110:111], v15 offset:6400
v_mfma_f32_16x16x32_bf16 v[168:171], a[84:87], a[24:27], v[168:171]
v_mfma_f32_16x16x32_bf16 v[176:179], a[84:87], a[28:31], v[176:179]
s_add_u32 m0, s16, 0x9800
v_mfma_f32_16x16x32_bf16 v[176:179], a[80:83], a[12:15], v[176:179]
buffer_load_dwordx4 v22, s[44:47], s23 offen lds
v_mfma_f32_16x16x32_bf16 v[180:183], a[88:91], a[12:15], v[180:183]
ds_read_b64_tr_b16 a[80:81], v14 offset:8192
v_mfma_f32_16x16x32_bf16 v[180:183], a[92:95], a[28:31], v[180:183]
ds_read_b64_tr_b16 a[82:83], v14 offset:8448
v_mfma_f32_16x16x32_bf16 v[172:175], a[92:95], a[24:27], v[172:175]
ds_read_b64_tr_b16 a[84:85], v14 offset:10240
v_mfma_f32_16x16x32_bf16 v[172:175], a[88:91], a[8:11], v[172:175]
ds_read_b64_tr_b16 a[86:87], v14 offset:10496
s_add_u32 m0, s16, 0x9c00
v_mfma_f32_16x16x32_bf16 v[164:167], a[88:91], a[4:7], v[164:167]
buffer_load_dwordx4 v23, s[44:47], s23 offen lds
v_mfma_f32_16x16x32_bf16 v[164:167], a[92:95], a[20:23], v[164:167]
v_lshl_add_u32 v22, s42, 7, v22
v_lshl_add_u32 v23, s42, 7, v23
v_mfma_f32_16x16x32_bf16 v[156:159], a[92:95], a[16:19], v[156:159]
v_mfma_f32_16x16x32_bf16 v[156:159], a[88:91], a[0:3], v[156:159]
s_waitcnt lgkmcnt(4)
v_mfma_f32_16x16x32_bf16 v[184:187], a[96:99], a[0:3], v[184:187]
ds_read_b64_tr_b16 a[88:89], v15 offset:8192
v_mfma_f32_16x16x32_bf16 v[184:187], a[100:103], a[16:19], v[184:187]
ds_read_b64_tr_b16 a[90:91], v15 offset:8448
s_add_u32 s8, s28, 0x9400
v_mfma_f32_16x16x32_bf16 v[192:195], a[100:103], a[20:23], v[192:195]
buffer_store_dwordx4 a[116:119], v16, s[88:91], s8 offen sc1
v_mfma_f32_16x16x32_bf16 v[192:195], a[96:99], a[4:7], v[192:195]
ds_read_b64_tr_b16 a[92:93], v15 offset:10240
v_mfma_f32_16x16x32_bf16 v[200:203], a[96:99], a[8:11], v[200:203]
ds_read_b64_tr_b16 a[94:95], v15 offset:10496
v_add_u32 v12, 0x8000, v12
v_mfma_f32_16x16x32_bf16 v[200:203], a[100:103], a[24:27], v[200:203]
v_add_u32 v13, 0x8000, v13
v_add_u32 v14, 0x8000, v14
v_mfma_f32_16x16x32_bf16 v[208:211], a[100:103], a[28:31], v[208:211]
v_add_u32 v15, 0x8000, v15
v_mfma_f32_16x16x32_bf16 v[208:211], a[96:99], a[12:15], v[208:211]
v_mfma_f32_16x16x32_bf16 v[212:215], a[104:107], a[12:15], v[212:215]
s_waitcnt vmcnt(28) lgkmcnt(0)
v_mfma_f32_16x16x32_bf16 v[212:215], a[108:111], a[28:31], v[212:215]
s_barrier
s_add_u32 m0, s17, 0x8000
v_mfma_f32_16x16x32_bf16 v[204:207], a[108:111], a[24:27], v[204:207]
buffer_load_dwordx4 v5, s[52:55], 0 offen lds
v_mfma_f32_16x16x32_bf16 v[204:207], a[104:107], a[8:11], v[204:207]
ds_read_b64_tr_b16 a[96:97], v12 offset:0
v_mfma_f32_16x16x32_bf16 v[196:199], a[104:107], a[4:7], v[196:199]
ds_read_b64_tr_b16 a[98:99], v12 offset:1024
v_mfma_f32_16x16x32_bf16 v[196:199], a[108:111], a[20:23], v[196:199]
ds_read_b64_tr_b16 a[100:101], v12 offset:8192
v_mfma_f32_16x16x32_bf16 v[188:191], a[108:111], a[16:19], v[188:191]
ds_read_b64_tr_b16 a[102:103], v12 offset:9216
v_mfma_f32_16x16x32_bf16 v[188:191], a[104:107], a[0:3], v[188:191]
s_add_u32 m0, s17, 0x8400
s_waitcnt lgkmcnt(4)
v_mfma_f32_16x16x32_bf16 v[216:219], a[0:3], a[80:83], v[216:219]
buffer_load_dwordx4 v5, s[52:55], s13 offen lds
v_mfma_f32_16x16x32_bf16 v[216:219], a[16:19], a[84:87], v[216:219]
ds_read_b64_tr_b16 a[104:105], v13 offset:0
v_mfma_f32_16x16x32_bf16 v[224:227], a[20:23], a[84:87], v[224:227]
ds_read_b64_tr_b16 a[106:107], v13 offset:1024
v_mfma_f32_16x16x32_bf16 v[224:227], a[4:7], a[80:83], v[224:227]
ds_read_b64_tr_b16 a[108:109], v13 offset:8192
v_mfma_f32_16x16x32_bf16 v[232:235], a[8:11], a[80:83], v[232:235]
ds_read_b64_tr_b16 a[110:111], v13 offset:9216
v_mfma_f32_16x16x32_bf16 v[232:235], a[24:27], a[84:87], v[232:235]
s_add_u32 m0, s17, 0x8800
v_mfma_f32_16x16x32_bf16 v[240:243], a[28:31], a[84:87], v[240:243]
buffer_load_dwordx4 v6, s[52:55], 0 offen lds
v_mfma_f32_16x16x32_bf16 v[240:243], a[12:15], a[80:83], v[240:243]
v_mfma_f32_16x16x32_bf16 v[244:247], a[12:15], a[88:91], v[244:247]
ds_read_b64_tr_b16 a[80:81], v12 offset:256
v_mfma_f32_16x16x32_bf16 v[244:247], a[28:31], a[92:95], v[244:247]
ds_read_b64_tr_b16 a[82:83], v12 offset:1280
v_mfma_f32_16x16x32_bf16 v[236:239], a[24:27], a[92:95], v[236:239]
ds_read_b64_tr_b16 a[84:85], v12 offset:8448
v_mfma_f32_16x16x32_bf16 v[236:239], a[8:11], a[88:91], v[236:239]
ds_read_b64_tr_b16 a[86:87], v12 offset:9472
s_add_u32 s8, s28, 0x5800
v_mfma_f32_16x16x32_bf16 v[228:231], a[4:7], a[88:91], v[228:231]
buffer_store_dwordx4 a[124:127], v16, s[88:91], s8 offen sc1
v_mfma_f32_16x16x32_bf16 v[228:231], a[20:23], a[92:95], v[228:231]
v_mfma_f32_16x16x32_bf16 v[220:223], a[16:19], a[92:95], v[220:223]
v_mfma_f32_16x16x32_bf16 v[220:223], a[0:3], a[88:91], v[220:223]
s_waitcnt lgkmcnt(4)
L_S17:
v_mfma_f32_16x16x32_bf16 v[24:27], a[96:99], a[32:35], v[24:27]
ds_read_b64_tr_b16 a[88:89], v13 offset:256
s_waitcnt vmcnt(23)
v_mfma_f32_16x16x32_bf16 v[24:27], a[100:103], a[48:51], v[24:27]
ds_read_b64_tr_b16 a[90:91], v13 offset:1280
s_add_u32 m0, s17, 0x8c00
v_mfma_f32_16x16x32_bf16 v[32:35], a[100:103], a[52:55], v[32:35]
buffer_load_dwordx4 v6, s[52:55], s13 offen lds
v_mfma_f32_16x16x32_bf16 v[32:35], a[96:99], a[36:39], v[32:35]
ds_read_b64_tr_b16 a[92:93], v13 offset:8448
v_mfma_f32_16x16x32_bf16 v[40:43], a[96:99], a[40:43], v[40:43]
ds_read_b64_tr_b16 a[94:95], v13 offset:9472
v_mfma_f32_16x16x32_bf16 v[40:43], a[100:103], a[56:59], v[40:43]
ds_read_b128 a[0:3], v8 offset:0
v_mfma_f32_16x16x32_bf16 v[48:51], a[100:103], a[60:63], v[48:51]
ds_read_b128 a[16:19], v9 offset:0
v_mfma_f32_16x16x32_bf16 v[48:51], a[96:99], a[44:47], v[48:51]
ds_read_b128 a[4:7], v8 offset:2048
s_add_u32 m0, s18, 0xc000
v_mfma_f32_16x16x32_bf16 v[52:55], a[104:107], a[44:47], v[52:55]
buffer_load_dwordx4 v7, s[68:71], 0 offen lds
v_mfma_f32_16x16x32_bf16 v[52:55], a[108:111], a[60:63], v[52:55]
ds_read_b64_tr_b16 a[96:97], v12 offset:512
v_mfma_f32_16x16x32_bf16 v[44:47], a[108:111], a[56:59], v[44:47]
ds_read_b64_tr_b16 a[98:99], v12 offset:1536
v_mfma_f32_16x16x32_bf16 v[44:47], a[104:107], a[40:43], v[44:47]
ds_read_b64_tr_b16 a[100:101], v12 offset:8704
v_mfma_f32_16x16x32_bf16 v[36:39], a[104:107], a[36:39], v[36:39]
ds_read_b64_tr_b16 a[102:103], v12 offset:9728
v_mfma_f32_16x16x32_bf16 v[36:39], a[108:111], a[52:55], v[36:39]
ds_read_b128 a[20:23], v9 offset:2048
s_add_u32 m0, s18, 0xd000
v_mfma_f32_16x16x32_bf16 v[28:31], a[108:111], a[48:51], v[28:31]
buffer_load_dwordx4 v7, s[68:71], s25 offen lds
v_mfma_f32_16x16x32_bf16 v[28:31], a[104:107], a[32:35], v[28:31]
ds_read_b128 a[8:11], v8 offset:4096
s_waitcnt lgkmcnt(9)
v_mfma_f32_16x16x32_bf16 v[56:59], a[80:83], a[32:35], v[56:59]
ds_read_b64_tr_b16 a[104:105], v13 offset:512
v_mfma_f32_16x16x32_bf16 v[56:59], a[84:87], a[48:51], v[56:59]
ds_read_b64_tr_b16 a[106:107], v13 offset:1536
v_mfma_f32_16x16x32_bf16 v[64:67], a[84:87], a[52:55], v[64:67]
ds_read_b64_tr_b16 a[108:109], v13 offset:8704
v_mfma_f32_16x16x32_bf16 v[64:67], a[80:83], a[36:39], v[64:67]
ds_read_b64_tr_b16 a[110:111], v13 offset:9728
s_add_u32 m0, s18, 0xe000
v_mfma_f32_16x16x32_bf16 v[72:75], a[80:83], a[40:43], v[72:75]
buffer_load_dwordx4 v7, s[68:71], s26 offen lds
v_mfma_f32_16x16x32_bf16 v[72:75], a[84:87], a[56:59], v[72:75]
ds_read_b128 a[24:27], v9 offset:4096
v_lshl_add_u32 v5, s42, 19, v5
v_mfma_f32_16x16x32_bf16 v[80:83], a[84:87], a[60:63], v[80:83]
ds_read_b128 a[12:15], v8 offset:6144
v_lshl_add_u32 v6, s42, 19, v6
v_mfma_f32_16x16x32_bf16 v[80:83], a[80:83], a[44:47], v[80:83]
ds_read_b128 a[28:31], v9 offset:6144
v_lshl_add_u32 v7, s42, 18, v7
v_mfma_f32_16x16x32_bf16 v[84:87], a[88:91], a[44:47], v[84:87]
ds_read_b64_tr_b16 a[80:81], v12 offset:768
v_lshl_add_u32 v7, s42, 17, v7
v_mfma_f32_16x16x32_bf16 v[84:87], a[92:95], a[60:63], v[84:87]
ds_read_b64_tr_b16 a[82:83], v12 offset:1792
s_add_u32 s8, s28, 0x9800
v_mfma_f32_16x16x32_bf16 v[76:79], a[92:95], a[56:59], v[76:79]
buffer_store_dwordx4 a[232:235], v16, s[88:91], s8 offen sc1
v_mfma_f32_16x16x32_bf16 v[76:79], a[88:91], a[40:43], v[76:79]
ds_read_b64_tr_b16 a[84:85], v12 offset:8960
v_mfma_f32_16x16x32_bf16 v[68:71], a[88:91], a[36:39], v[68:71]
ds_read_b64_tr_b16 a[86:87], v12 offset:9984
v_mfma_f32_16x16x32_bf16 v[68:71], a[92:95], a[52:55], v[68:71]
v_mfma_f32_16x16x32_bf16 v[60:63], a[92:95], a[48:51], v[60:63]
v_mfma_f32_16x16x32_bf16 v[60:63], a[88:91], a[32:35], v[60:63]
s_add_u32 m0, s16, 0x0
s_waitcnt lgkmcnt(4)
s_waitcnt lgkmcnt(7)
v_mfma_f32_16x16x32_bf16 v[88:91], a[96:99], a[32:35], v[88:91]
buffer_load_dwordx4 v22, s[44:47], s20 offen lds
v_mfma_f32_16x16x32_bf16 v[88:91], a[100:103], a[48:51], v[88:91]
ds_read_b64_tr_b16 a[88:89], v13 offset:768
v_mfma_f32_16x16x32_bf16 v[96:99], a[100:103], a[52:55], v[96:99]
ds_read_b64_tr_b16 a[90:91], v13 offset:1792
v_mfma_f32_16x16x32_bf16 v[96:99], a[96:99], a[36:39], v[96:99]
ds_read_b64_tr_b16 a[92:93], v13 offset:8960
v_mfma_f32_16x16x32_bf16 v[104:107], a[96:99], a[40:43], v[104:107]
ds_read_b64_tr_b16 a[94:95], v13 offset:9984
s_add_u32 m0, s16, 0x400
v_mfma_f32_16x16x32_bf16 v[104:107], a[100:103], a[56:59], v[104:107]
buffer_load_dwordx4 v23, s[44:47], s20 offen lds
v_mfma_f32_16x16x32_bf16 v[112:115], a[100:103], a[60:63], v[112:115]
v_mfma_f32_16x16x32_bf16 v[112:115], a[96:99], a[44:47], v[112:115]
v_mfma_f32_16x16x32_bf16 v[116:119], a[104:107], a[44:47], v[116:119]
ds_read_b64_tr_b16 a[96:97], v14 offset:0
v_mfma_f32_16x16x32_bf16 v[116:119], a[108:111], a[60:63], v[116:119]
ds_read_b64_tr_b16 a[98:99], v14 offset:256
v_mfma_f32_16x16x32_bf16 v[108:111], a[108:111], a[56:59], v[108:111]
ds_read_b64_tr_b16 a[100:101], v14 offset:2048
s_add_u32 m0, s16, 0x800
v_mfma_f32_16x16x32_bf16 v[108:111], a[104:107], a[40:43], v[108:111]
buffer_load_dwordx4 v22, s[44:47], s21 offen lds
v_mfma_f32_16x16x32_bf16 v[100:103], a[104:107], a[36:39], v[100:103]
ds_read_b64_tr_b16 a[102:103], v14 offset:2304
v_mfma_f32_16x16x32_bf16 v[100:103], a[108:111], a[52:55], v[100:103]
v_mfma_f32_16x16x32_bf16 v[92:95], a[108:111], a[48:51], v[92:95]
v_mfma_f32_16x16x32_bf16 v[92:95], a[104:107], a[32:35], v[92:95]
s_add_u32 m0, s16, 0xc00
s_waitcnt lgkmcnt(4)
v_mfma_f32_16x16x32_bf16 v[120:123], a[80:83], a[32:35], v[120:123]
buffer_load_dwordx4 v23, s[44:47], s21 offen lds
v_mfma_f32_16x16x32_bf16 v[120:123], a[84:87], a[48:51], v[120:123]
ds_read_b64_tr_b16 a[104:105], v15 offset:0
v_mfma_f32_16x16x32_bf16 v[128:131], a[84:87], a[52:55], v[128:131]
ds_read_b64_tr_b16 a[106:107], v15 offset:256
v_mfma_f32_16x16x32_bf16 v[128:131], a[80:83], a[36:39], v[128:131]
ds_read_b64_tr_b16 a[108:109], v15 offset:2048
v_mfma_f32_16x16x32_bf16 v[136:139], a[80:83], a[40:43], v[136:139]
ds_read_b64_tr_b16 a[110:111], v15 offset:2304
v_mfma_f32_16x16x32_bf16 v[136:139], a[84:87], a[56:59], v[136:139]
s_add_u32 s8, s28, 0x5c00
v_mfma_f32_16x16x32_bf16 v[144:147], a[84:87], a[60:63], v[144:147]
buffer_store_dwordx4 a[240:243], v16, s[88:91], s8 offen sc1
v_mfma_f32_16x16x32_bf16 v[144:147], a[80:83], a[44:47], v[144:147]
v_mfma_f32_16x16x32_bf16 v[148:151], a[88:91], a[44:47], v[148:151]
ds_read_b64_tr_b16 a[80:81], v14 offset:4096
v_mfma_f32_16x16x32_bf16 v[148:151], a[92:95], a[60:63], v[148:151]
ds_read_b64_tr_b16 a[82:83], v14 offset:4352
v_mfma_f32_16x16x32_bf16 v[140:143], a[92:95], a[56:59], v[140:143]
ds_read_b64_tr_b16 a[84:85], v14 offset:6144
v_mfma_f32_16x16x32_bf16 v[140:143], a[88:91], a[40:43], v[140:143]
ds_read_b64_tr_b16 a[86:87], v14 offset:6400
s_add_u32 m0, s16, 0x1000
v_mfma_f32_16x16x32_bf16 v[132:135], a[88:91], a[36:39], v[132:135]
buffer_load_dwordx4 v22, s[44:47], s22 offen lds
v_mfma_f32_16x16x32_bf16 v[132:135], a[92:95], a[52:55], v[132:135]
v_mfma_f32_16x16x32_bf16 v[124:127], a[92:95], a[48:51], v[124:127]
v_mfma_f32_16x16x32_bf16 v[124:127], a[88:91], a[32:35], v[124:127]
s_waitcnt lgkmcnt(4)
v_mfma_f32_16x16x32_bf16 v[152:155], a[96:99], a[32:35], v[152:155]
ds_read_b64_tr_b16 a[88:89], v15 offset:4096
s_add_u32 m0, s16, 0x1400
v_mfma_f32_16x16x32_bf16 v[152:155], a[100:103], a[48:51], v[152:155]
buffer_load_dwordx4 v23, s[44:47], s22 offen lds
v_mfma_f32_16x16x32_bf16 v[160:163], a[100:103], a[52:55], v[160:163]
ds_read_b64_tr_b16 a[90:91], v15 offset:4352
v_mfma_f32_16x16x32_bf16 v[160:163], a[96:99], a[36:39], v[160:163]
ds_read_b64_tr_b16 a[92:93], v15 offset:6144
v_mfma_f32_16x16x32_bf16 v[168:171], a[96:99], a[40:43], v[168:171]
ds_read_b64_tr_b16 a[94:95], v15 offset:6400
v_mfma_f32_16x16x32_bf16 v[168:171], a[100:103], a[56:59], v[168:171]
v_mfma_f32_16x16x32_bf16 v[176:179], a[100:103], a[60:63], v[176:179]
s_add_u32 m0, s16, 0x1800
v_mfma_f32_16x16x32_bf16 v[176:179], a[96:99], a[44:47], v[176:179]
buffer_load_dwordx4 v22, s[44:47], s23 offen lds
v_mfma_f32_16x16x32_bf16 v[180:183], a[104:107], a[44:47], v[180:183]
ds_read_b64_tr_b16 a[96:97], v14 offset:8192
v_mfma_f32_16x16x32_bf16 v[180:183], a[108:111], a[60:63], v[180:183]
ds_read_b64_tr_b16 a[98:99], v14 offset:8448
v_mfma_f32_16x16x32_bf16 v[172:175], a[108:111], a[56:59], v[172:175]
ds_read_b64_tr_b16 a[100:101], v14 offset:10240
v_mfma_f32_16x16x32_bf16 v[172:175], a[104:107], a[40:43], v[172:175]
ds_read_b64_tr_b16 a[102:103], v14 offset:10496
s_add_u32 m0, s16, 0x1c00
v_mfma_f32_16x16x32_bf16 v[164:167], a[104:107], a[36:39], v[164:167]
buffer_load_dwordx4 v23, s[44:47], s23 offen lds
v_mfma_f32_16x16x32_bf16 v[164:167], a[108:111], a[52:55], v[164:167]
v_lshl_add_u32 v22, s42, 7, v22
v_lshl_add_u32 v23, s42, 7, v23
v_mfma_f32_16x16x32_bf16 v[156:159], a[108:111], a[48:51], v[156:159]
v_mfma_f32_16x16x32_bf16 v[156:159], a[104:107], a[32:35], v[156:159]
s_waitcnt lgkmcnt(4)
v_mfma_f32_16x16x32_bf16 v[184:187], a[80:83], a[32:35], v[184:187]
ds_read_b64_tr_b16 a[104:105], v15 offset:8192
v_mfma_f32_16x16x32_bf16 v[184:187], a[84:87], a[48:51], v[184:187]
ds_read_b64_tr_b16 a[106:107], v15 offset:8448
s_add_u32 s8, s28, 0x9c00
v_mfma_f32_16x16x32_bf16 v[192:195], a[84:87], a[52:55], v[192:195]
buffer_store_dwordx4 a[248:251], v16, s[88:91], s8 offen sc1
v_mfma_f32_16x16x32_bf16 v[192:195], a[80:83], a[36:39], v[192:195]
ds_read_b64_tr_b16 a[108:109], v15 offset:10240
v_mfma_f32_16x16x32_bf16 v[200:203], a[80:83], a[40:43], v[200:203]
ds_read_b64_tr_b16 a[110:111], v15 offset:10496
v_add_u32 v12, 0xffff0000, v12
v_mfma_f32_16x16x32_bf16 v[200:203], a[84:87], a[56:59], v[200:203]
v_add_u32 v13, 0xffff0000, v13
v_add_u32 v14, 0xffff0000, v14
v_mfma_f32_16x16x32_bf16 v[208:211], a[84:87], a[60:63], v[208:211]
v_add_u32 v15, 0xffff0000, v15
v_mfma_f32_16x16x32_bf16 v[208:211], a[80:83], a[44:47], v[208:211]
v_mfma_f32_16x16x32_bf16 v[212:215], a[88:91], a[44:47], v[212:215]
s_waitcnt vmcnt(29) lgkmcnt(0)
v_mfma_f32_16x16x32_bf16 v[212:215], a[92:95], a[60:63], v[212:215]
s_barrier
s_add_u32 m0, s17, 0x10000
v_mfma_f32_16x16x32_bf16 v[204:207], a[92:95], a[56:59], v[204:207]
buffer_load_dwordx4 v5, s[52:55], 0 offen lds
v_mfma_f32_16x16x32_bf16 v[204:207], a[88:91], a[40:43], v[204:207]
ds_read_b64_tr_b16 a[80:81], v12 offset:0
v_mfma_f32_16x16x32_bf16 v[196:199], a[88:91], a[36:39], v[196:199]
ds_read_b64_tr_b16 a[82:83], v12 offset:1024
v_mfma_f32_16x16x32_bf16 v[196:199], a[92:95], a[52:55], v[196:199]
ds_read_b64_tr_b16 a[84:85], v12 offset:8192
v_mfma_f32_16x16x32_bf16 v[188:191], a[92:95], a[48:51], v[188:191]
ds_read_b64_tr_b16 a[86:87], v12 offset:9216
v_mfma_f32_16x16x32_bf16 v[188:191], a[88:91], a[32:35], v[188:191]
s_add_u32 m0, s17, 0x10400
s_waitcnt lgkmcnt(4)
v_mfma_f32_16x16x32_bf16 v[216:219], a[32:35], a[96:99], v[216:219]
buffer_load_dwordx4 v5, s[52:55], s13 offen lds
v_mfma_f32_16x16x32_bf16 v[216:219], a[48:51], a[100:103], v[216:219]
ds_read_b64_tr_b16 a[88:89], v13 offset:0
v_mfma_f32_16x16x32_bf16 v[224:227], a[52:55], a[100:103], v[224:227]
ds_read_b64_tr_b16 a[90:91], v13 offset:1024
v_mfma_f32_16x16x32_bf16 v[224:227], a[36:39], a[96:99], v[224:227]
ds_read_b64_tr_b16 a[92:93], v13 offset:8192
v_mfma_f32_16x16x32_bf16 v[232:235], a[40:43], a[96:99], v[232:235]
ds_read_b64_tr_b16 a[94:95], v13 offset:9216
v_mfma_f32_16x16x32_bf16 v[232:235], a[56:59], a[100:103], v[232:235]
s_add_u32 m0, s17, 0x10800
v_mfma_f32_16x16x32_bf16 v[240:243], a[60:63], a[100:103], v[240:243]
buffer_load_dwordx4 v6, s[52:55], 0 offen lds
v_mfma_f32_16x16x32_bf16 v[240:243], a[44:47], a[96:99], v[240:243]
v_mfma_f32_16x16x32_bf16 v[244:247], a[44:47], a[104:107], v[244:247]
ds_read_b64_tr_b16 a[96:97], v12 offset:256
v_mfma_f32_16x16x32_bf16 v[244:247], a[60:63], a[108:111], v[244:247]
ds_read_b64_tr_b16 a[98:99], v12 offset:1280
v_mfma_f32_16x16x32_bf16 v[236:239], a[56:59], a[108:111], v[236:239]
ds_read_b64_tr_b16 a[100:101], v12 offset:8448
v_mfma_f32_16x16x32_bf16 v[236:239], a[40:43], a[104:107], v[236:239]
ds_read_b64_tr_b16 a[102:103], v12 offset:9472
v_mfma_f32_16x16x32_bf16 v[228:231], a[36:39], a[104:107], v[228:231]
buffer_load_dwordx4 a[128:131], v16, s[44:47], s100 offen offset:0
v_mfma_f32_16x16x32_bf16 v[228:231], a[52:55], a[108:111], v[228:231]
v_mfma_f32_16x16x32_bf16 v[220:223], a[48:51], a[108:111], v[220:223]
L_padA9:
s_cmp_eq_u32 s95, 1
s_cbranch_scc1 L_hopA_ret
v_mfma_f32_16x16x32_bf16 v[220:223], a[32:35], a[104:107], v[220:223]
s_waitcnt lgkmcnt(4)
L_S18:
v_mfma_f32_16x16x32_bf16 v[24:27], a[80:83], a[0:3], v[24:27]
ds_read_b64_tr_b16 a[104:105], v13 offset:256
s_waitcnt vmcnt(24)
v_mfma_f32_16x16x32_bf16 v[24:27], a[84:87], a[16:19], v[24:27]
ds_read_b64_tr_b16 a[106:107], v13 offset:1280
s_add_u32 m0, s17, 0x10c00
v_mfma_f32_16x16x32_bf16 v[32:35], a[84:87], a[20:23], v[32:35]
buffer_load_dwordx4 v6, s[52:55], s13 offen lds
v_mfma_f32_16x16x32_bf16 v[32:35], a[80:83], a[4:7], v[32:35]
ds_read_b64_tr_b16 a[108:109], v13 offset:8448
v_mfma_f32_16x16x32_bf16 v[40:43], a[80:83], a[8:11], v[40:43]
ds_read_b64_tr_b16 a[110:111], v13 offset:9472
v_mfma_f32_16x16x32_bf16 v[40:43], a[84:87], a[24:27], v[40:43]
ds_read_b128 a[32:35], v8 offset:32768
v_mfma_f32_16x16x32_bf16 v[48:51], a[84:87], a[28:31], v[48:51]
ds_read_b128 a[48:51], v9 offset:32768
v_mfma_f32_16x16x32_bf16 v[48:51], a[80:83], a[12:15], v[48:51]
ds_read_b128 a[36:39], v8 offset:34816
s_add_u32 m0, s18, 0x14000
v_mfma_f32_16x16x32_bf16 v[52:55], a[88:91], a[12:15], v[52:55]
buffer_load_dwordx4 v7, s[68:71], 0 offen lds
v_mfma_f32_16x16x32_bf16 v[52:55], a[92:95], a[28:31], v[52:55]
ds_read_b64_tr_b16 a[80:81], v12 offset:512
v_mfma_f32_16x16x32_bf16 v[44:47], a[92:95], a[24:27], v[44:47]
ds_read_b64_tr_b16 a[82:83], v12 offset:1536
v_mfma_f32_16x16x32_bf16 v[44:47], a[88:91], a[8:11], v[44:47]
ds_read_b64_tr_b16 a[84:85], v12 offset:8704
v_mfma_f32_16x16x32_bf16 v[36:39], a[88:91], a[4:7], v[36:39]
ds_read_b64_tr_b16 a[86:87], v12 offset:9728
v_mfma_f32_16x16x32_bf16 v[36:39], a[92:95], a[20:23], v[36:39]
ds_read_b128 a[52:55], v9 offset:34816
s_add_u32 m0, s18, 0x15000
v_mfma_f32_16x16x32_bf16 v[28:31], a[92:95], a[16:19], v[28:31]
buffer_load_dwordx4 v7, s[68:71], s25 offen lds
v_mfma_f32_16x16x32_bf16 v[28:31], a[88:91], a[0:3], v[28:31]
ds_read_b128 a[40:43], v8 offset:36864
s_waitcnt lgkmcnt(9)
v_mfma_f32_16x16x32_bf16 v[56:59], a[96:99], a[0:3], v[56:59]
ds_read_b64_tr_b16 a[88:89], v13 offset:512
v_mfma_f32_16x16x32_bf16 v[56:59], a[100:103], a[16:19], v[56:59]
ds_read_b64_tr_b16 a[90:91], v13 offset:1536
v_mfma_f32_16x16x32_bf16 v[64:67], a[100:103], a[20:23], v[64:67]
ds_read_b64_tr_b16 a[92:93], v13 offset:8704
v_mfma_f32_16x16x32_bf16 v[64:67], a[96:99], a[4:7], v[64:67]
ds_read_b64_tr_b16 a[94:95], v13 offset:9728
s_add_u32 m0, s18, 0x16000
v_mfma_f32_16x16x32_bf16 v[72:75], a[96:99], a[8:11], v[72:75]
buffer_load_dwordx4 v7, s[68:71], s26 offen lds
v_mfma_f32_16x16x32_bf16 v[72:75], a[100:103], a[24:27], v[72:75]
ds_read_b128 a[56:59], v9 offset:36864
v_lshl_add_u32 v5, s42, 19, v5
v_mfma_f32_16x16x32_bf16 v[80:83], a[100:103], a[28:31], v[80:83]
ds_read_b128 a[44:47], v8 offset:38912
v_lshl_add_u32 v6, s42, 19, v6
v_mfma_f32_16x16x32_bf16 v[80:83], a[96:99], a[12:15], v[80:83]
ds_read_b128 a[60:63], v9 offset:38912
v_lshl_add_u32 v7, s42, 18, v7
v_mfma_f32_16x16x32_bf16 v[84:87], a[104:107], a[12:15], v[84:87]
ds_read_b64_tr_b16 a[96:97], v12 offset:768
v_lshl_add_u32 v7, s42, 17, v7
v_mfma_f32_16x16x32_bf16 v[84:87], a[108:111], a[28:31], v[84:87]
ds_read_b64_tr_b16 a[98:99], v12 offset:1792
v_mfma_f32_16x16x32_bf16 v[76:79], a[108:111], a[24:27], v[76:79]
buffer_load_dwordx4 a[132:135], v16, s[44:47], s100 offen offset:1024
v_mfma_f32_16x16x32_bf16 v[76:79], a[104:107], a[8:11], v[76:79]
ds_read_b64_tr_b16 a[100:101], v12 offset:8960
v_mfma_f32_16x16x32_bf16 v[68:71], a[104:107], a[4:7], v[68:71]
ds_read_b64_tr_b16 a[102:103], v12 offset:9984
v_mfma_f32_16x16x32_bf16 v[68:71], a[108:111], a[20:23], v[68:71]
v_mfma_f32_16x16x32_bf16 v[60:63], a[108:111], a[16:19], v[60:63]
v_mfma_f32_16x16x32_bf16 v[60:63], a[104:107], a[0:3], v[60:63]
s_add_u32 m0, s16, 0x8000
s_waitcnt lgkmcnt(4)
s_waitcnt lgkmcnt(7)
v_mfma_f32_16x16x32_bf16 v[88:91], a[80:83], a[0:3], v[88:91]
buffer_load_dwordx4 v22, s[44:47], s20 offen lds
v_mfma_f32_16x16x32_bf16 v[88:91], a[84:87], a[16:19], v[88:91]
ds_read_b64_tr_b16 a[104:105], v13 offset:768
v_mfma_f32_16x16x32_bf16 v[96:99], a[84:87], a[20:23], v[96:99]
ds_read_b64_tr_b16 a[106:107], v13 offset:1792
v_mfma_f32_16x16x32_bf16 v[96:99], a[80:83], a[4:7], v[96:99]
ds_read_b64_tr_b16 a[108:109], v13 offset:8960
v_mfma_f32_16x16x32_bf16 v[104:107], a[80:83], a[8:11], v[104:107]
ds_read_b64_tr_b16 a[110:111], v13 offset:9984
s_add_u32 m0, s16, 0x8400
v_mfma_f32_16x16x32_bf16 v[104:107], a[84:87], a[24:27], v[104:107]
buffer_load_dwordx4 v23, s[44:47], s20 offen lds
v_mfma_f32_16x16x32_bf16 v[112:115], a[84:87], a[28:31], v[112:115]
v_mfma_f32_16x16x32_bf16 v[112:115], a[80:83], a[12:15], v[112:115]
v_mfma_f32_16x16x32_bf16 v[116:119], a[88:91], a[12:15], v[116:119]
ds_read_b64_tr_b16 a[80:81], v14 offset:0
v_mfma_f32_16x16x32_bf16 v[116:119], a[92:95], a[28:31], v[116:119]
ds_read_b64_tr_b16 a[82:83], v14 offset:256
v_mfma_f32_16x16x32_bf16 v[108:111], a[92:95], a[24:27], v[108:111]
ds_read_b64_tr_b16 a[84:85], v14 offset:2048
s_add_u32 m0, s16, 0x8800
v_mfma_f32_16x16x32_bf16 v[108:111], a[88:91], a[8:11], v[108:111]
buffer_load_dwordx4 v22, s[44:47], s21 offen lds
v_mfma_f32_16x16x32_bf16 v[100:103], a[88:91], a[4:7], v[100:103]
ds_read_b64_tr_b16 a[86:87], v14 offset:2304
v_mfma_f32_16x16x32_bf16 v[100:103], a[92:95], a[20:23], v[100:103]
v_mfma_f32_16x16x32_bf16 v[92:95], a[92:95], a[16:19], v[92:95]
v_mfma_f32_16x16x32_bf16 v[92:95], a[88:91], a[0:3], v[92:95]
s_add_u32 m0, s16, 0x8c00
s_waitcnt lgkmcnt(4)
v_mfma_f32_16x16x32_bf16 v[120:123], a[96:99], a[0:3], v[120:123]
buffer_load_dwordx4 v23, s[44:47], s21 offen lds
v_mfma_f32_16x16x32_bf16 v[120:123], a[100:103], a[16:19], v[120:123]
ds_read_b64_tr_b16 a[88:89], v15 offset:0
v_mfma_f32_16x16x32_bf16 v[128:131], a[100:103], a[20:23], v[128:131]
ds_read_b64_tr_b16 a[90:91], v15 offset:256
v_mfma_f32_16x16x32_bf16 v[128:131], a[96:99], a[4:7], v[128:131]
ds_read_b64_tr_b16 a[92:93], v15 offset:2048
v_mfma_f32_16x16x32_bf16 v[136:139], a[96:99], a[8:11], v[136:139]
ds_read_b64_tr_b16 a[94:95], v15 offset:2304
v_mfma_f32_16x16x32_bf16 v[136:139], a[100:103], a[24:27], v[136:139]
v_mfma_f32_16x16x32_bf16 v[144:147], a[100:103], a[28:31], v[144:147]
buffer_load_dwordx4 a[136:139], v16, s[44:47], s100 offen offset:2048
v_mfma_f32_16x16x32_bf16 v[144:147], a[96:99], a[12:15], v[144:147]
v_mfma_f32_16x16x32_bf16 v[148:151], a[104:107], a[12:15], v[148:151]
ds_read_b64_tr_b16 a[96:97], v14 offset:4096
v_mfma_f32_16x16x32_bf16 v[148:151], a[108:111], a[28:31], v[148:151]
ds_read_b64_tr_b16 a[98:99], v14 offset:4352
v_mfma_f32_16x16x32_bf16 v[140:143], a[108:111], a[24:27], v[140:143]
ds_read_b64_tr_b16 a[100:101], v14 offset:6144
v_mfma_f32_16x16x32_bf16 v[140:143], a[104:107], a[8:11], v[140:143]
ds_read_b64_tr_b16 a[102:103], v14 offset:6400
s_add_u32 m0, s16, 0x9000
v_mfma_f32_16x16x32_bf16 v[132:135], a[104:107], a[4:7], v[132:135]
buffer_load_dwordx4 v22, s[44:47], s22 offen lds
v_mfma_f32_16x16x32_bf16 v[132:135], a[108:111], a[20:23], v[132:135]
v_mfma_f32_16x16x32_bf16 v[124:127], a[108:111], a[16:19], v[124:127]
v_mfma_f32_16x16x32_bf16 v[124:127], a[104:107], a[0:3], v[124:127]
s_waitcnt lgkmcnt(4)
v_mfma_f32_16x16x32_bf16 v[152:155], a[80:83], a[0:3], v[152:155]
ds_read_b64_tr_b16 a[104:105], v15 offset:4096
s_add_u32 m0, s16, 0x9400
v_mfma_f32_16x16x32_bf16 v[152:155], a[84:87], a[16:19], v[152:155]
buffer_load_dwordx4 v23, s[44:47], s22 offen lds
v_mfma_f32_16x16x32_bf16 v[160:163], a[84:87], a[20:23], v[160:163]
ds_read_b64_tr_b16 a[106:107], v15 offset:4352
v_mfma_f32_16x16x32_bf16 v[160:163], a[80:83], a[4:7], v[160:163]
ds_read_b64_tr_b16 a[108:109], v15 offset:6144
v_mfma_f32_16x16x32_bf16 v[168:171], a[80:83], a[8:11], v[168:171]
ds_read_b64_tr_b16 a[110:111], v15 offset:6400
v_mfma_f32_16x16x32_bf16 v[168:171], a[84:87], a[24:27], v[168:171]
v_mfma_f32_16x16x32_bf16 v[176:179], a[84:87], a[28:31], v[176:179]
s_add_u32 m0, s16, 0x9800
v_mfma_f32_16x16x32_bf16 v[176:179], a[80:83], a[12:15], v[176:179]
buffer_load_dwordx4 v22, s[44:47], s23 offen lds
v_mfma_f32_16x16x32_bf16 v[180:183], a[88:91], a[12:15], v[180:183]
ds_read_b64_tr_b16 a[80:81], v14 offset:8192
v_mfma_f32_16x16x32_bf16 v[180:183], a[92:95], a[28:31], v[180:183]
ds_read_b64_tr_b16 a[82:83], v14 offset:8448
v_mfma_f32_16x16x32_bf16 v[172:175], a[92:95], a[24:27], v[172:175]
ds_read_b64_tr_b16 a[84:85], v14 offset:10240
v_mfma_f32_16x16x32_bf16 v[172:175], a[88:91], a[8:11], v[172:175]
ds_read_b64_tr_b16 a[86:87], v14 offset:10496
s_add_u32 m0, s16, 0x9c00
v_mfma_f32_16x16x32_bf16 v[164:167], a[88:91], a[4:7], v[164:167]
buffer_load_dwordx4 v23, s[44:47], s23 offen lds
v_mfma_f32_16x16x32_bf16 v[164:167], a[92:95], a[20:23], v[164:167]
v_lshl_add_u32 v22, s42, 7, v22
v_lshl_add_u32 v23, s42, 7, v23
v_mfma_f32_16x16x32_bf16 v[156:159], a[92:95], a[16:19], v[156:159]
v_mfma_f32_16x16x32_bf16 v[156:159], a[88:91], a[0:3], v[156:159]
s_waitcnt lgkmcnt(4)
v_mfma_f32_16x16x32_bf16 v[184:187], a[96:99], a[0:3], v[184:187]
ds_read_b64_tr_b16 a[88:89], v15 offset:8192
v_mov_b32 v21, s1
v_mfma_f32_16x16x32_bf16 v[184:187], a[100:103], a[16:19], v[184:187]
ds_read_b64_tr_b16 a[90:91], v15 offset:8448
v_add_u32 v20, s0, v16
v_mfma_f32_16x16x32_bf16 v[192:195], a[100:103], a[20:23], v[192:195]
global_load_dword a120, v[20:21], off sc1
v_mfma_f32_16x16x32_bf16 v[192:195], a[96:99], a[4:7], v[192:195]
ds_read_b64_tr_b16 a[92:93], v15 offset:10240
v_mfma_f32_16x16x32_bf16 v[200:203], a[96:99], a[8:11], v[200:203]
ds_read_b64_tr_b16 a[94:95], v15 offset:10496
v_add_u32 v12, 0x8000, v12
v_mfma_f32_16x16x32_bf16 v[200:203], a[100:103], a[24:27], v[200:203]
v_add_u32 v13, 0x8000, v13
v_add_u32 v14, 0x8000, v14
v_mfma_f32_16x16x32_bf16 v[208:211], a[100:103], a[28:31], v[208:211]
v_add_u32 v15, 0x8000, v15
v_mfma_f32_16x16x32_bf16 v[208:211], a[96:99], a[12:15], v[208:211]
v_mfma_f32_16x16x32_bf16 v[212:215], a[104:107], a[12:15], v[212:215]
s_waitcnt vmcnt(19) lgkmcnt(0)
v_mfma_f32_16x16x32_bf16 v[212:215], a[108:111], a[28:31], v[212:215]
s_barrier
s_add_u32 m0, s17, 0x0
s_cmp_lg_u32 s4, 0
s_cbranch_scc1 L_sig_kv
v_mov_b32 v20, 1
s_mov_b64 exec, 1
buffer_atomic_add v20, off, s[84:87], s10 sc1
s_mov_b64 exec, -1
L_sig_kv:
v_mfma_f32_16x16x32_bf16 v[204:207], a[108:111], a[24:27], v[204:207]
buffer_load_dwordx4 v5, s[52:55], 0 offen lds
v_mfma_f32_16x16x32_bf16 v[204:207], a[104:107], a[8:11], v[204:207]
ds_read_b64_tr_b16 a[96:97], v12 offset:0
v_mfma_f32_16x16x32_bf16 v[196:199], a[104:107], a[4:7], v[196:199]
ds_read_b64_tr_b16 a[98:99], v12 offset:1024
v_mfma_f32_16x16x32_bf16 v[196:199], a[108:111], a[20:23], v[196:199]
ds_read_b64_tr_b16 a[100:101], v12 offset:8192
v_mfma_f32_16x16x32_bf16 v[188:191], a[108:111], a[16:19], v[188:191]
ds_read_b64_tr_b16 a[102:103], v12 offset:9216
v_mfma_f32_16x16x32_bf16 v[188:191], a[104:107], a[0:3], v[188:191]
s_add_u32 m0, s17, 0x400
s_waitcnt lgkmcnt(4)
v_mfma_f32_16x16x32_bf16 v[216:219], a[0:3], a[80:83], v[216:219]
buffer_load_dwordx4 v5, s[52:55], s13 offen lds
v_mfma_f32_16x16x32_bf16 v[216:219], a[16:19], a[84:87], v[216:219]
ds_read_b64_tr_b16 a[104:105], v13 offset:0
v_mfma_f32_16x16x32_bf16 v[224:227], a[20:23], a[84:87], v[224:227]
ds_read_b64_tr_b16 a[106:107], v13 offset:1024
v_mfma_f32_16x16x32_bf16 v[224:227], a[4:7], a[80:83], v[224:227]
ds_read_b64_tr_b16 a[108:109], v13 offset:8192
v_mfma_f32_16x16x32_bf16 v[232:235], a[8:11], a[80:83], v[232:235]
ds_read_b64_tr_b16 a[110:111], v13 offset:9216
v_mfma_f32_16x16x32_bf16 v[232:235], a[24:27], a[84:87], v[232:235]
v_mfma_f32_16x16x32_bf16 v[240:243], a[28:31], a[84:87], v[240:243]
s_add_u32 m0, s17, 0x800
v_mfma_f32_16x16x32_bf16 v[240:243], a[12:15], a[80:83], v[240:243]
buffer_load_dwordx4 v6, s[52:55], 0 offen lds
v_mfma_f32_16x16x32_bf16 v[244:247], a[12:15], a[88:91], v[244:247]
ds_read_b64_tr_b16 a[80:81], v12 offset:256
v_mfma_f32_16x16x32_bf16 v[244:247], a[28:31], a[92:95], v[244:247]
ds_read_b64_tr_b16 a[82:83], v12 offset:1280
v_mfma_f32_16x16x32_bf16 v[236:239], a[24:27], a[92:95], v[236:239]
ds_read_b64_tr_b16 a[84:85], v12 offset:8448
v_mfma_f32_16x16x32_bf16 v[236:239], a[8:11], a[88:91], v[236:239]
ds_read_b64_tr_b16 a[86:87], v12 offset:9472
v_mfma_f32_16x16x32_bf16 v[228:231], a[4:7], a[88:91], v[228:231]
v_mfma_f32_16x16x32_bf16 v[228:231], a[20:23], a[92:95], v[228:231]
s_add_u32 m0, s17, 0xc00
v_mfma_f32_16x16x32_bf16 v[220:223], a[16:19], a[92:95], v[220:223]
buffer_load_dwordx4 v6, s[52:55], s13 offen lds
v_mfma_f32_16x16x32_bf16 v[220:223], a[0:3], a[88:91], v[220:223]
s_waitcnt lgkmcnt(4)
L_S19:
v_mfma_f32_16x16x32_bf16 v[24:27], a[96:99], a[32:35], v[24:27]
ds_read_b64_tr_b16 a[88:89], v13 offset:256
s_waitcnt vmcnt(24)
v_mfma_f32_16x16x32_bf16 v[24:27], a[100:103], a[48:51], v[24:27]
ds_read_b64_tr_b16 a[90:91], v13 offset:1280
v_mfma_f32_16x16x32_bf16 v[32:35], a[100:103], a[52:55], v[32:35]
ds_read_b64_tr_b16 a[92:93], v13 offset:8448
v_mfma_f32_16x16x32_bf16 v[32:35], a[96:99], a[36:39], v[32:35]
ds_read_b64_tr_b16 a[94:95], v13 offset:9472
v_mfma_f32_16x16x32_bf16 v[40:43], a[96:99], a[40:43], v[40:43]
ds_read_b128 a[0:3], v8 offset:0
s_add_u32 m0, s18, 0x4000
v_mfma_f32_16x16x32_bf16 v[40:43], a[100:103], a[56:59], v[40:43]
buffer_load_dwordx4 v7, s[68:71], 0 offen lds
v_mfma_f32_16x16x32_bf16 v[48:51], a[100:103], a[60:63], v[48:51]
ds_read_b128 a[16:19], v9 offset:0
v_mfma_f32_16x16x32_bf16 v[48:51], a[96:99], a[44:47], v[48:51]
ds_read_b128 a[4:7], v8 offset:2048
v_mfma_f32_16x16x32_bf16 v[52:55], a[104:107], a[44:47], v[52:55]
ds_read_b64_tr_b16 a[96:97], v12 offset:512
v_mfma_f32_16x16x32_bf16 v[52:55], a[108:111], a[60:63], v[52:55]
ds_read_b64_tr_b16 a[98:99], v12 offset:1536
v_mfma_f32_16x16x32_bf16 v[44:47], a[108:111], a[56:59], v[44:47]
ds_read_b64_tr_b16 a[100:101], v12 offset:8704
v_mfma_f32_16x16x32_bf16 v[44:47], a[104:107], a[40:43], v[44:47]
buffer_load_dwordx4 a[140:143], v16, s[44:47], s100 offen offset:3072
v_mfma_f32_16x16x32_bf16 v[36:39], a[104:107], a[36:39], v[36:39]
ds_read_b64_tr_b16 a[102:103], v12 offset:9728
v_mfma_f32_16x16x32_bf16 v[36:39], a[108:111], a[52:55], v[36:39]
ds_read_b128 a[20:23], v9 offset:2048
v_mfma_f32_16x16x32_bf16 v[28:31], a[108:111], a[48:51], v[28:31]
ds_read_b128 a[8:11], v8 offset:4096
v_mfma_f32_16x16x32_bf16 v[28:31], a[104:107], a[32:35], v[28:31]
ds_read_b128 a[24:27], v9 offset:4096
s_waitcnt lgkmcnt(10)
v_mfma_f32_16x16x32_bf16 v[56:59], a[80:83], a[32:35], v[56:59]
ds_read_b64_tr_b16 a[104:105], v13 offset:512
v_mfma_f32_16x16x32_bf16 v[56:59], a[84:87], a[48:51], v[56:59]
ds_read_b64_tr_b16 a[106:107], v13 offset:1536
s_add_u32 m0, s18, 0x5000
v_mfma_f32_16x16x32_bf16 v[64:67], a[84:87], a[52:55], v[64:67]
buffer_load_dwordx4 v7, s[68:71], s25 offen lds
v_mfma_f32_16x16x32_bf16 v[64:67], a[80:83], a[36:39], v[64:67]
ds_read_b64_tr_b16 a[108:109], v13 offset:8704
v_mfma_f32_16x16x32_bf16 v[72:75], a[80:83], a[40:43], v[72:75]
ds_read_b64_tr_b16 a[110:111], v13 offset:9728
v_mfma_f32_16x16x32_bf16 v[72:75], a[84:87], a[56:59], v[72:75]
ds_read_b128 a[12:15], v8 offset:6144
v_mfma_f32_16x16x32_bf16 v[80:83], a[84:87], a[60:63], v[80:83]
ds_read_b128 a[28:31], v9 offset:6144
v_mfma_f32_16x16x32_bf16 v[80:83], a[80:83], a[44:47], v[80:83]
v_mfma_f32_16x16x32_bf16 v[84:87], a[88:91], a[44:47], v[84:87]
ds_read_b64_tr_b16 a[80:81], v12 offset:768
s_add_u32 m0, s18, 0x6000
v_mfma_f32_16x16x32_bf16 v[84:87], a[92:95], a[60:63], v[84:87]
buffer_load_dwordx4 v7, s[68:71], s26 offen lds
v_mfma_f32_16x16x32_bf16 v[76:79], a[92:95], a[56:59], v[76:79]
ds_read_b64_tr_b16 a[82:83], v12 offset:1792
v_lshl_add_u32 v5, s42, 19, v5
v_mfma_f32_16x16x32_bf16 v[76:79], a[88:91], a[40:43], v[76:79]
ds_read_b64_tr_b16 a[84:85], v12 offset:8960
v_lshl_add_u32 v6, s42, 19, v6
v_mfma_f32_16x16x32_bf16 v[68:71], a[88:91], a[36:39], v[68:71]
ds_read_b64_tr_b16 a[86:87], v12 offset:9984
v_lshl_add_u32 v7, s42, 18, v7
v_mfma_f32_16x16x32_bf16 v[68:71], a[92:95], a[52:55], v[68:71]
v_lshl_add_u32 v7, s42, 17, v7
v_mfma_f32_16x16x32_bf16 v[60:63], a[92:95], a[48:51], v[60:63]
v_mfma_f32_16x16x32_bf16 v[60:63], a[88:91], a[32:35], v[60:63]
s_add_u32 m0, s16, 0x0
s_waitcnt lgkmcnt(4)
s_waitcnt lgkmcnt(6)
v_mfma_f32_16x16x32_bf16 v[88:91], a[96:99], a[32:35], v[88:91]
buffer_load_dwordx4 v22, s[44:47], s20 offen lds
v_mfma_f32_16x16x32_bf16 v[88:91], a[100:103], a[48:51], v[88:91]
ds_read_b64_tr_b16 a[88:89], v13 offset:768
v_mfma_f32_16x16x32_bf16 v[96:99], a[100:103], a[52:55], v[96:99]
ds_read_b64_tr_b16 a[90:91], v13 offset:1792
v_mfma_f32_16x16x32_bf16 v[96:99], a[96:99], a[36:39], v[96:99]
ds_read_b64_tr_b16 a[92:93], v13 offset:8960
v_mfma_f32_16x16x32_bf16 v[104:107], a[96:99], a[40:43], v[104:107]
ds_read_b64_tr_b16 a[94:95], v13 offset:9984
s_add_u32 m0, s16, 0x400
v_mfma_f32_16x16x32_bf16 v[104:107], a[100:103], a[56:59], v[104:107]
buffer_load_dwordx4 v23, s[44:47], s20 offen lds
v_mfma_f32_16x16x32_bf16 v[112:115], a[100:103], a[60:63], v[112:115]
v_mfma_f32_16x16x32_bf16 v[112:115], a[96:99], a[44:47], v[112:115]
v_mfma_f32_16x16x32_bf16 v[116:119], a[104:107], a[44:47], v[116:119]
ds_read_b64_tr_b16 a[96:97], v14 offset:0
v_mfma_f32_16x16x32_bf16 v[116:119], a[108:111], a[60:63], v[116:119]
ds_read_b64_tr_b16 a[98:99], v14 offset:256
v_mfma_f32_16x16x32_bf16 v[108:111], a[108:111], a[56:59], v[108:111]
ds_read_b64_tr_b16 a[100:101], v14 offset:2048
s_add_u32 m0, s16, 0x800
v_mfma_f32_16x16x32_bf16 v[108:111], a[104:107], a[40:43], v[108:111]
buffer_load_dwordx4 v22, s[44:47], s21 offen lds
v_mfma_f32_16x16x32_bf16 v[100:103], a[104:107], a[36:39], v[100:103]
ds_read_b64_tr_b16 a[102:103], v14 offset:2304
v_mfma_f32_16x16x32_bf16 v[100:103], a[108:111], a[52:55], v[100:103]
v_mfma_f32_16x16x32_bf16 v[92:95], a[108:111], a[48:51], v[92:95]
v_mfma_f32_16x16x32_bf16 v[92:95], a[104:107], a[32:35], v[92:95]
s_waitcnt lgkmcnt(4)
v_mfma_f32_16x16x32_bf16 v[120:123], a[80:83], a[32:35], v[120:123]
buffer_load_dwordx4 a[144:147], v16, s[76:79], 0 offen offset:0
v_mfma_f32_16x16x32_bf16 v[120:123], a[84:87], a[48:51], v[120:123]
ds_read_b64_tr_b16 a[104:105], v15 offset:0
v_mfma_f32_16x16x32_bf16 v[128:131], a[84:87], a[52:55], v[128:131]
ds_read_b64_tr_b16 a[106:107], v15 offset:256
v_mfma_f32_16x16x32_bf16 v[128:131], a[80:83], a[36:39], v[128:131]
ds_read_b64_tr_b16 a[108:109], v15 offset:2048
v_mfma_f32_16x16x32_bf16 v[136:139], a[80:83], a[40:43], v[136:139]
ds_read_b64_tr_b16 a[110:111], v15 offset:2304
v_mfma_f32_16x16x32_bf16 v[136:139], a[84:87], a[56:59], v[136:139]
s_add_u32 m0, s16, 0xc00
v_mfma_f32_16x16x32_bf16 v[144:147], a[84:87], a[60:63], v[144:147]
buffer_load_dwordx4 v23, s[44:47], s21 offen lds
v_mfma_f32_16x16x32_bf16 v[144:147], a[80:83], a[44:47], v[144:147]
v_mfma_f32_16x16x32_bf16 v[148:151], a[88:91], a[44:47], v[148:151]
ds_read_b64_tr_b16 a[80:81], v14 offset:4096
v_mfma_f32_16x16x32_bf16 v[148:151], a[92:95], a[60:63], v[148:151]
ds_read_b64_tr_b16 a[82:83], v14 offset:4352
v_mfma_f32_16x16x32_bf16 v[140:143], a[92:95], a[56:59], v[140:143]
ds_read_b64_tr_b16 a[84:85], v14 offset:6144
v_mfma_f32_16x16x32_bf16 v[140:143], a[88:91], a[40:43], v[140:143]
ds_read_b64_tr_b16 a[86:87], v14 offset:6400
s_add_u32 m0, s16, 0x1000
v_mfma_f32_16x16x32_bf16 v[132:135], a[88:91], a[36:39], v[132:135]
buffer_load_dwordx4 v22, s[44:47], s22 offen lds
v_mfma_f32_16x16x32_bf16 v[132:135], a[92:95], a[52:55], v[132:135]
v_mfma_f32_16x16x32_bf16 v[124:127], a[92:95], a[48:51], v[124:127]
v_mfma_f32_16x16x32_bf16 v[124:127], a[88:91], a[32:35], v[124:127]
s_waitcnt lgkmcnt(4)
v_mfma_f32_16x16x32_bf16 v[152:155], a[96:99], a[32:35], v[152:155]
ds_read_b64_tr_b16 a[88:89], v15 offset:4096
s_add_u32 m0, s16, 0x1400
v_mfma_f32_16x16x32_bf16 v[152:155], a[100:103], a[48:51], v[152:155]
buffer_load_dwordx4 v23, s[44:47], s22 offen lds
v_mfma_f32_16x16x32_bf16 v[160:163], a[100:103], a[52:55], v[160:163]
ds_read_b64_tr_b16 a[90:91], v15 offset:4352
v_mfma_f32_16x16x32_bf16 v[160:163], a[96:99], a[36:39], v[160:163]
ds_read_b64_tr_b16 a[92:93], v15 offset:6144
v_mfma_f32_16x16x32_bf16 v[168:171], a[96:99], a[40:43], v[168:171]
ds_read_b64_tr_b16 a[94:95], v15 offset:6400
v_mfma_f32_16x16x32_bf16 v[168:171], a[100:103], a[56:59], v[168:171]
v_mfma_f32_16x16x32_bf16 v[176:179], a[100:103], a[60:63], v[176:179]
s_add_u32 m0, s16, 0x1800
v_mfma_f32_16x16x32_bf16 v[176:179], a[96:99], a[44:47], v[176:179]
buffer_load_dwordx4 v22, s[44:47], s23 offen lds
v_mfma_f32_16x16x32_bf16 v[180:183], a[104:107], a[44:47], v[180:183]
ds_read_b64_tr_b16 a[96:97], v14 offset:8192
v_mfma_f32_16x16x32_bf16 v[180:183], a[108:111], a[60:63], v[180:183]
ds_read_b64_tr_b16 a[98:99], v14 offset:8448
v_mfma_f32_16x16x32_bf16 v[172:175], a[108:111], a[56:59], v[172:175]
ds_read_b64_tr_b16 a[100:101], v14 offset:10240
v_mfma_f32_16x16x32_bf16 v[172:175], a[104:107], a[40:43], v[172:175]
ds_read_b64_tr_b16 a[102:103], v14 offset:10496
s_add_u32 m0, s16, 0x1c00
v_mfma_f32_16x16x32_bf16 v[164:167], a[104:107], a[36:39], v[164:167]
buffer_load_dwordx4 v23, s[44:47], s23 offen lds
v_mfma_f32_16x16x32_bf16 v[164:167], a[108:111], a[52:55], v[164:167]
v_lshl_add_u32 v22, s42, 7, v22
v_lshl_add_u32 v23, s42, 7, v23
v_mfma_f32_16x16x32_bf16 v[156:159], a[108:111], a[48:51], v[156:159]
v_mfma_f32_16x16x32_bf16 v[156:159], a[104:107], a[32:35], v[156:159]
s_waitcnt lgkmcnt(4)
v_mfma_f32_16x16x32_bf16 v[184:187], a[80:83], a[32:35], v[184:187]
ds_read_b64_tr_b16 a[104:105], v15 offset:8192
v_mfma_f32_16x16x32_bf16 v[184:187], a[84:87], a[48:51], v[184:187]
ds_read_b64_tr_b16 a[106:107], v15 offset:8448
v_mfma_f32_16x16x32_bf16 v[192:195], a[84:87], a[52:55], v[192:195]
buffer_load_dwordx4 a[148:151], v16, s[76:79], 0 offen offset:1024
v_mfma_f32_16x16x32_bf16 v[192:195], a[80:83], a[36:39], v[192:195]
ds_read_b64_tr_b16 a[108:109], v15 offset:10240
v_mfma_f32_16x16x32_bf16 v[200:203], a[80:83], a[40:43], v[200:203]
ds_read_b64_tr_b16 a[110:111], v15 offset:10496
v_add_u32 v12, 0x8000, v12
v_mfma_f32_16x16x32_bf16 v[200:203], a[84:87], a[56:59], v[200:203]
v_add_u32 v13, 0x8000, v13
v_add_u32 v14, 0x8000, v14
v_mfma_f32_16x16x32_bf16 v[208:211], a[84:87], a[60:63], v[208:211]
v_add_u32 v15, 0x8000, v15
v_mfma_f32_16x16x32_bf16 v[208:211], a[80:83], a[44:47], v[208:211]
v_mfma_f32_16x16x32_bf16 v[212:215], a[88:91], a[44:47], v[212:215]
s_waitcnt vmcnt(29) lgkmcnt(0)
v_mfma_f32_16x16x32_bf16 v[212:215], a[92:95], a[60:63], v[212:215]
s_barrier
s_add_u32 m0, s17, 0x8000
v_mfma_f32_16x16x32_bf16 v[204:207], a[92:95], a[56:59], v[204:207]
buffer_load_dwordx4 v5, s[52:55], 0 offen lds
v_mfma_f32_16x16x32_bf16 v[204:207], a[88:91], a[40:43], v[204:207]
ds_read_b64_tr_b16 a[80:81], v12 offset:0
v_mfma_f32_16x16x32_bf16 v[196:199], a[88:91], a[36:39], v[196:199]
ds_read_b64_tr_b16 a[82:83], v12 offset:1024
v_mfma_f32_16x16x32_bf16 v[196:199], a[92:95], a[52:55], v[196:199]
ds_read_b64_tr_b16 a[84:85], v12 offset:8192
v_mfma_f32_16x16x32_bf16 v[188:191], a[92:95], a[48:51], v[188:191]
ds_read_b64_tr_b16 a[86:87], v12 offset:9216
v_mfma_f32_16x16x32_bf16 v[188:191], a[88:91], a[32:35], v[188:191]
s_waitcnt lgkmcnt(4)
v_mfma_f32_16x16x32_bf16 v[216:219], a[32:35], a[96:99], v[216:219]
ds_read_b64_tr_b16 a[88:89], v13 offset:0
s_add_u32 m0, s17, 0x8400
v_mfma_f32_16x16x32_bf16 v[216:219], a[48:51], a[100:103], v[216:219]
buffer_load_dwordx4 v5, s[52:55], s13 offen lds
v_mfma_f32_16x16x32_bf16 v[224:227], a[52:55], a[100:103], v[224:227]
ds_read_b64_tr_b16 a[90:91], v13 offset:1024
v_mfma_f32_16x16x32_bf16 v[224:227], a[36:39], a[96:99], v[224:227]
ds_read_b64_tr_b16 a[92:93], v13 offset:8192
v_mfma_f32_16x16x32_bf16 v[232:235], a[40:43], a[96:99], v[232:235]
ds_read_b64_tr_b16 a[94:95], v13 offset:9216
v_mfma_f32_16x16x32_bf16 v[232:235], a[56:59], a[100:103], v[232:235]
v_mfma_f32_16x16x32_bf16 v[240:243], a[60:63], a[100:103], v[240:243]
v_mfma_f32_16x16x32_bf16 v[240:243], a[44:47], a[96:99], v[240:243]
v_mfma_f32_16x16x32_bf16 v[244:247], a[44:47], a[104:107], v[244:247]
ds_read_b64_tr_b16 a[96:97], v12 offset:256
s_add_u32 m0, s17, 0x8800
v_mfma_f32_16x16x32_bf16 v[244:247], a[60:63], a[108:111], v[244:247]
buffer_load_dwordx4 v6, s[52:55], 0 offen lds
v_mfma_f32_16x16x32_bf16 v[236:239], a[56:59], a[108:111], v[236:239]
ds_read_b64_tr_b16 a[98:99], v12 offset:1280
v_mfma_f32_16x16x32_bf16 v[236:239], a[40:43], a[104:107], v[236:239]
ds_read_b64_tr_b16 a[100:101], v12 offset:8448
v_mfma_f32_16x16x32_bf16 v[228:231], a[36:39], a[104:107], v[228:231]
ds_read_b64_tr_b16 a[102:103], v12 offset:9472
v_mfma_f32_16x16x32_bf16 v[228:231], a[52:55], a[108:111], v[228:231]
v_mfma_f32_16x16x32_bf16 v[220:223], a[48:51], a[108:111], v[220:223]
v_mfma_f32_16x16x32_bf16 v[220:223], a[32:35], a[104:107], v[220:223]
s_add_u32 m0, s17, 0x8c00
s_waitcnt lgkmcnt(4)
L_S20:
v_mfma_f32_16x16x32_bf16 v[24:27], a[80:83], a[0:3], v[24:27]
ds_read_b64_tr_b16 a[104:105], v13 offset:256
s_waitcnt vmcnt(22)
v_mfma_f32_16x16x32_bf16 v[24:27], a[84:87], a[16:19], v[24:27]
buffer_load_dwordx4 v6, s[52:55], s13 offen lds
v_mfma_f32_16x16x32_bf16 v[32:35], a[84:87], a[20:23], v[32:35]
ds_read_b64_tr_b16 a[106:107], v13 offset:1280
v_mfma_f32_16x16x32_bf16 v[32:35], a[80:83], a[4:7], v[32:35]
ds_read_b64_tr_b16 a[108:109], v13 offset:8448
v_mfma_f32_16x16x32_bf16 v[40:43], a[80:83], a[8:11], v[40:43]
ds_read_b64_tr_b16 a[110:111], v13 offset:9472
v_mfma_f32_16x16x32_bf16 v[40:43], a[84:87], a[24:27], v[40:43]
ds_read_b128 a[32:35], v8 offset:32768
v_mfma_f32_16x16x32_bf16 v[48:51], a[84:87], a[28:31], v[48:51]
ds_read_b128 a[48:51], v9 offset:32768
v_mfma_f32_16x16x32_bf16 v[48:51], a[80:83], a[12:15], v[48:51]
ds_read_b128 a[36:39], v8 offset:34816
s_add_u32 m0, s18, 0xc000
v_mfma_f32_16x16x32_bf16 v[52:55], a[88:91], a[12:15], v[52:55]
buffer_load_dwordx4 v7, s[68:71], 0 offen lds
v_mfma_f32_16x16x32_bf16 v[52:55], a[92:95], a[28:31], v[52:55]
ds_read_b64_tr_b16 a[80:81], v12 offset:512
v_mfma_f32_16x16x32_bf16 v[44:47], a[92:95], a[24:27], v[44:47]
ds_read_b64_tr_b16 a[82:83], v12 offset:1536
v_mfma_f32_16x16x32_bf16 v[44:47], a[88:91], a[8:11], v[44:47]
ds_read_b64_tr_b16 a[84:85], v12 offset:8704
v_mfma_f32_16x16x32_bf16 v[36:39], a[88:91], a[4:7], v[36:39]
ds_read_b64_tr_b16 a[86:87], v12 offset:9728
v_mfma_f32_16x16x32_bf16 v[36:39], a[92:95], a[20:23], v[36:39]
ds_read_b128 a[52:55], v9 offset:34816
v_mfma_f32_16x16x32_bf16 v[28:31], a[92:95], a[16:19], v[28:31]
ds_read_b128 a[40:43], v8 offset:36864
s_waitcnt lgkmcnt(9)
v_mfma_f32_16x16x32_bf16 v[28:31], a[88:91], a[0:3], v[28:31]
ds_read_b128 a[56:59], v9 offset:36864
s_add_u32 m0, s18, 0xd000
v_mfma_f32_16x16x32_bf16 v[56:59], a[96:99], a[0:3], v[56:59]
buffer_load_dwordx4 v7, s[68:71], s25 offen lds
v_mfma_f32_16x16x32_bf16 v[56:59], a[100:103], a[16:19], v[56:59]
ds_read_b64_tr_b16 a[88:89], v13 offset:512
v_mfma_f32_16x16x32_bf16 v[64:67], a[100:103], a[20:23], v[64:67]
ds_read_b64_tr_b16 a[90:91], v13 offset:1536
v_mfma_f32_16x16x32_bf16 v[64:67], a[96:99], a[4:7], v[64:67]
ds_read_b64_tr_b16 a[92:93], v13 offset:8704
v_mfma_f32_16x16x32_bf16 v[72:75], a[96:99], a[8:11], v[72:75]
ds_read_b64_tr_b16 a[94:95], v13 offset:9728
v_mfma_f32_16x16x32_bf16 v[72:75], a[100:103], a[24:27], v[72:75]
ds_read_b128 a[44:47], v8 offset:38912
v_mfma_f32_16x16x32_bf16 v[80:83], a[100:103], a[28:31], v[80:83]
ds_read_b128 a[60:63], v9 offset:38912
v_mfma_f32_16x16x32_bf16 v[80:83], a[96:99], a[12:15], v[80:83]
s_add_u32 m0, s18, 0xe000
v_mfma_f32_16x16x32_bf16 v[84:87], a[104:107], a[12:15], v[84:87]
buffer_load_dwordx4 v7, s[68:71], s26 offen lds
v_mfma_f32_16x16x32_bf16 v[84:87], a[108:111], a[28:31], v[84:87]
ds_read_b64_tr_b16 a[96:97], v12 offset:768
v_lshl_add_u32 v5, s42, 19, v5
v_mfma_f32_16x16x32_bf16 v[76:79], a[108:111], a[24:27], v[76:79]
ds_read_b64_tr_b16 a[98:99], v12 offset:1792
L_padA10:
s_cmp_eq_u32 s95, 1
s_cbranch_scc1 L_hopA_ret
v_lshl_add_u32 v6, s42, 19, v6
v_mfma_f32_16x16x32_bf16 v[76:79], a[104:107], a[8:11], v[76:79]
ds_read_b64_tr_b16 a[100:101], v12 offset:8960
v_lshl_add_u32 v7, s42, 18, v7
v_mfma_f32_16x16x32_bf16 v[68:71], a[104:107], a[4:7], v[68:71]
ds_read_b64_tr_b16 a[102:103], v12 offset:9984
v_lshl_add_u32 v7, s42, 17, v7
v_mfma_f32_16x16x32_bf16 v[68:71], a[108:111], a[20:23], v[68:71]
s_waitcnt vmcnt(13)
v_accvgpr_read_b32 v18, a144
v_lshlrev_b32 v1, 16, v18
v_mfma_f32_16x16x32_bf16 v[60:63], a[108:111], a[16:19], v[60:63]
v_and_b32 v18, 0xffff0000, v18
v_accvgpr_read_b32 v21, a128
v_mfma_f32_16x16x32_bf16 v[60:63], a[104:107], a[0:3], v[60:63]
s_add_u32 m0, s16, 0x8000
s_waitcnt lgkmcnt(4)
s_waitcnt lgkmcnt(6)
v_mfma_f32_16x16x32_bf16 v[88:91], a[80:83], a[0:3], v[88:91]
buffer_load_dwordx4 v22, s[44:47], s20 offen lds
v_mfma_f32_16x16x32_bf16 v[88:91], a[84:87], a[16:19], v[88:91]
ds_read_b64_tr_b16 a[104:105], v13 offset:768
v_lshlrev_b32 v20, 16, v21
v_mfma_f32_16x16x32_bf16 v[96:99], a[84:87], a[20:23], v[96:99]
ds_read_b64_tr_b16 a[106:107], v13 offset:1792
v_and_b32 v21, 0xffff0000, v21
v_mfma_f32_16x16x32_bf16 v[96:99], a[80:83], a[4:7], v[96:99]
ds_read_b64_tr_b16 a[108:109], v13 offset:8960
v_mul_f32 v2, v1, v20
v_mfma_f32_16x16x32_bf16 v[104:107], a[80:83], a[8:11], v[104:107]
ds_read_b64_tr_b16 a[110:111], v13 offset:9984
v_fmac_f32 v2, v18, v21
v_mfma_f32_16x16x32_bf16 v[104:107], a[84:87], a[24:27], v[104:107]
v_accvgpr_read_b32 v21, a136
v_lshlrev_b32 v20, 16, v21
v_mfma_f32_16x16x32_bf16 v[112:115], a[84:87], a[28:31], v[112:115]
s_add_u32 m0, s16, 0x8400
v_and_b32 v21, 0xffff0000, v21
v_mul_f32 v3, v1, v20
v_mfma_f32_16x16x32_bf16 v[112:115], a[80:83], a[12:15], v[112:115]
buffer_load_dwordx4 v23, s[44:47], s20 offen lds
v_mfma_f32_16x16x32_bf16 v[116:119], a[88:91], a[12:15], v[116:119]
ds_read_b64_tr_b16 a[80:81], v14 offset:0
v_fmac_f32 v3, v18, v21
v_mfma_f32_16x16x32_bf16 v[116:119], a[92:95], a[28:31], v[116:119]
ds_read_b64_tr_b16 a[82:83], v14 offset:256
v_accvgpr_read_b32 v18, a145
v_mfma_f32_16x16x32_bf16 v[108:111], a[92:95], a[24:27], v[108:111]
ds_read_b64_tr_b16 a[84:85], v14 offset:2048
v_lshlrev_b32 v1, 16, v18
v_mfma_f32_16x16x32_bf16 v[108:111], a[88:91], a[8:11], v[108:111]
ds_read_b64_tr_b16 a[86:87], v14 offset:2304
v_and_b32 v18, 0xffff0000, v18
v_mfma_f32_16x16x32_bf16 v[100:103], a[88:91], a[4:7], v[100:103]
v_accvgpr_read_b32 v21, a129
v_lshlrev_b32 v20, 16, v21
v_mfma_f32_16x16x32_bf16 v[100:103], a[92:95], a[20:23], v[100:103]
s_add_u32 m0, s16, 0x8800
v_and_b32 v21, 0xffff0000, v21
v_fmac_f32 v2, v1, v20
v_mfma_f32_16x16x32_bf16 v[92:95], a[92:95], a[16:19], v[92:95]
buffer_load_dwordx4 v22, s[44:47], s21 offen lds
v_mfma_f32_16x16x32_bf16 v[92:95], a[88:91], a[0:3], v[92:95]
s_waitcnt lgkmcnt(4)
v_fmac_f32 v2, v18, v21
v_accvgpr_read_b32 v21, a137
v_mfma_f32_16x16x32_bf16 v[120:123], a[96:99], a[0:3], v[120:123]
ds_read_b64_tr_b16 a[88:89], v15 offset:0
v_lshlrev_b32 v20, 16, v21
v_mfma_f32_16x16x32_bf16 v[120:123], a[100:103], a[16:19], v[120:123]
ds_read_b64_tr_b16 a[90:91], v15 offset:256
v_and_b32 v21, 0xffff0000, v21
v_mfma_f32_16x16x32_bf16 v[128:131], a[100:103], a[20:23], v[128:131]
ds_read_b64_tr_b16 a[92:93], v15 offset:2048
v_fmac_f32 v3, v1, v20
v_mfma_f32_16x16x32_bf16 v[128:131], a[96:99], a[4:7], v[128:131]
ds_read_b64_tr_b16 a[94:95], v15 offset:2304
v_fmac_f32 v3, v18, v21
v_mfma_f32_16x16x32_bf16 v[136:139], a[96:99], a[8:11], v[136:139]
s_add_u32 m0, s16, 0x8c00
v_accvgpr_read_b32 v18, a146
v_lshlrev_b32 v1, 16, v18
v_mfma_f32_16x16x32_bf16 v[136:139], a[100:103], a[24:27], v[136:139]
buffer_load_dwordx4 v23, s[44:47], s21 offen lds
v_mfma_f32_16x16x32_bf16 v[144:147], a[100:103], a[28:31], v[144:147]
v_and_b32 v18, 0xffff0000, v18
v_accvgpr_read_b32 v21, a130
v_mfma_f32_16x16x32_bf16 v[144:147], a[96:99], a[12:15], v[144:147]
v_lshlrev_b32 v20, 16, v21
v_and_b32 v21, 0xffff0000, v21
v_mfma_f32_16x16x32_bf16 v[148:151], a[104:107], a[12:15], v[148:151]
ds_read_b64_tr_b16 a[96:97], v14 offset:4096
v_fmac_f32 v2, v1, v20
v_mfma_f32_16x16x32_bf16 v[148:151], a[108:111], a[28:31], v[148:151]
ds_read_b64_tr_b16 a[98:99], v14 offset:4352
v_fmac_f32 v2, v18, v21
v_mfma_f32_16x16x32_bf16 v[140:143], a[108:111], a[24:27], v[140:143]
ds_read_b64_tr_b16 a[100:101], v14 offset:6144
v_accvgpr_read_b32 v21, a138
v_mfma_f32_16x16x32_bf16 v[140:143], a[104:107], a[8:11], v[140:143]
ds_read_b64_tr_b16 a[102:103], v14 offset:6400
s_add_u32 m0, s16, 0x9000
v_mfma_f32_16x16x32_bf16 v[132:135], a[104:107], a[4:7], v[132:135]
buffer_load_dwordx4 v22, s[44:47], s22 offen lds
v_mfma_f32_16x16x32_bf16 v[132:135], a[108:111], a[20:23], v[132:135]
v_lshlrev_b32 v20, 16, v21
v_and_b32 v21, 0xffff0000, v21
v_mfma_f32_16x16x32_bf16 v[124:127], a[108:111], a[16:19], v[124:127]
v_fmac_f32 v3, v1, v20
v_fmac_f32 v3, v18, v21
v_mfma_f32_16x16x32_bf16 v[124:127], a[104:107], a[0:3], v[124:127]
s_waitcnt lgkmcnt(4)
v_accvgpr_read_b32 v18, a147
v_lshlrev_b32 v1, 16, v18
v_mfma_f32_16x16x32_bf16 v[152:155], a[80:83], a[0:3], v[152:155]
ds_read_b64_tr_b16 a[104:105], v15 offset:4096
v_and_b32 v18, 0xffff0000, v18
v_mfma_f32_16x16x32_bf16 v[152:155], a[84:87], a[16:19], v[152:155]
ds_read_b64_tr_b16 a[106:107], v15 offset:4352
v_accvgpr_read_b32 v21, a131
v_mfma_f32_16x16x32_bf16 v[160:163], a[84:87], a[20:23], v[160:163]
ds_read_b64_tr_b16 a[108:109], v15 offset:6144
s_add_u32 m0, s16, 0x9400
v_mfma_f32_16x16x32_bf16 v[160:163], a[80:83], a[4:7], v[160:163]
buffer_load_dwordx4 v23, s[44:47], s22 offen lds
v_mfma_f32_16x16x32_bf16 v[168:171], a[80:83], a[8:11], v[168:171]
ds_read_b64_tr_b16 a[110:111], v15 offset:6400
v_lshlrev_b32 v20, 16, v21
v_mfma_f32_16x16x32_bf16 v[168:171], a[84:87], a[24:27], v[168:171]
v_and_b32 v21, 0xffff0000, v21
v_fmac_f32 v2, v1, v20
v_mfma_f32_16x16x32_bf16 v[176:179], a[84:87], a[28:31], v[176:179]
v_fmac_f32 v2, v18, v21
v_accvgpr_read_b32 v21, a139
v_mfma_f32_16x16x32_bf16 v[176:179], a[80:83], a[12:15], v[176:179]
v_lshlrev_b32 v20, 16, v21
v_and_b32 v21, 0xffff0000, v21
v_mfma_f32_16x16x32_bf16 v[180:183], a[88:91], a[12:15], v[180:183]
ds_read_b64_tr_b16 a[80:81], v14 offset:8192
v_fmac_f32 v3, v1, v20
v_mfma_f32_16x16x32_bf16 v[180:183], a[92:95], a[28:31], v[180:183]
ds_read_b64_tr_b16 a[82:83], v14 offset:8448
s_add_u32 m0, s16, 0x9800
v_mfma_f32_16x16x32_bf16 v[172:175], a[92:95], a[24:27], v[172:175]
buffer_load_dwordx4 v22, s[44:47], s23 offen lds
v_mfma_f32_16x16x32_bf16 v[172:175], a[88:91], a[8:11], v[172:175]
ds_read_b64_tr_b16 a[84:85], v14 offset:10240
v_fmac_f32 v3, v18, v21
v_mfma_f32_16x16x32_bf16 v[164:167], a[88:91], a[4:7], v[164:167]
ds_read_b64_tr_b16 a[86:87], v14 offset:10496
s_waitcnt vmcnt(14)
v_accvgpr_read_b32 v18, a148
v_mfma_f32_16x16x32_bf16 v[164:167], a[92:95], a[20:23], v[164:167]
v_lshlrev_b32 v1, 16, v18
v_and_b32 v18, 0xffff0000, v18
v_mfma_f32_16x16x32_bf16 v[156:159], a[92:95], a[16:19], v[156:159]
v_accvgpr_read_b32 v21, a132
v_lshlrev_b32 v20, 16, v21
v_mfma_f32_16x16x32_bf16 v[156:159], a[88:91], a[0:3], v[156:159]
s_waitcnt lgkmcnt(4)
v_and_b32 v21, 0xffff0000, v21
v_fmac_f32 v2, v1, v20
v_mfma_f32_16x16x32_bf16 v[184:187], a[96:99], a[0:3], v[184:187]
ds_read_b64_tr_b16 a[88:89], v15 offset:8192
s_add_u32 m0, s16, 0x9c00
v_mfma_f32_16x16x32_bf16 v[184:187], a[100:103], a[16:19], v[184:187]
buffer_load_dwordx4 v23, s[44:47], s23 offen lds
v_mfma_f32_16x16x32_bf16 v[192:195], a[100:103], a[20:23], v[192:195]
ds_read_b64_tr_b16 a[90:91], v15 offset:8448
v_fmac_f32 v2, v18, v21
v_mfma_f32_16x16x32_bf16 v[192:195], a[96:99], a[4:7], v[192:195]
ds_read_b64_tr_b16 a[92:93], v15 offset:10240
v_accvgpr_read_b32 v21, a140
v_mfma_f32_16x16x32_bf16 v[200:203], a[96:99], a[8:11], v[200:203]
ds_read_b64_tr_b16 a[94:95], v15 offset:10496
v_add_u32 v12, 0xffff0000, v12
v_mfma_f32_16x16x32_bf16 v[200:203], a[100:103], a[24:27], v[200:203]
v_add_u32 v13, 0xffff0000, v13
v_add_u32 v14, 0xffff0000, v14
v_mfma_f32_16x16x32_bf16 v[208:211], a[100:103], a[28:31], v[208:211]
v_add_u32 v15, 0xffff0000, v15
v_lshlrev_b32 v20, 16, v21
v_mfma_f32_16x16x32_bf16 v[208:211], a[96:99], a[12:15], v[208:211]
v_and_b32 v21, 0xffff0000, v21
v_fmac_f32 v3, v1, v20
v_mfma_f32_16x16x32_bf16 v[212:215], a[104:107], a[12:15], v[212:215]
s_waitcnt vmcnt(25) lgkmcnt(0)
v_fmac_f32 v3, v18, v21
v_accvgpr_read_b32 v18, a149
v_mfma_f32_16x16x32_bf16 v[212:215], a[108:111], a[28:31], v[212:215]
s_barrier
s_add_u32 m0, s17, 0x10000
v_lshlrev_b32 v1, 16, v18
v_mfma_f32_16x16x32_bf16 v[204:207], a[108:111], a[24:27], v[204:207]
buffer_load_dwordx4 v5, s[52:55], 0 offen lds
v_mfma_f32_16x16x32_bf16 v[204:207], a[104:107], a[8:11], v[204:207]
ds_read_b64_tr_b16 a[96:97], v12 offset:0
v_and_b32 v18, 0xffff0000, v18
v_mfma_f32_16x16x32_bf16 v[196:199], a[104:107], a[4:7], v[196:199]
ds_read_b64_tr_b16 a[98:99], v12 offset:1024
v_accvgpr_read_b32 v21, a133
v_mfma_f32_16x16x32_bf16 v[196:199], a[108:111], a[20:23], v[196:199]
ds_read_b64_tr_b16 a[100:101], v12 offset:8192
v_lshlrev_b32 v20, 16, v21
v_mfma_f32_16x16x32_bf16 v[188:191], a[108:111], a[16:19], v[188:191]
ds_read_b64_tr_b16 a[102:103], v12 offset:9216
v_and_b32 v21, 0xffff0000, v21
v_mfma_f32_16x16x32_bf16 v[188:191], a[104:107], a[0:3], v[188:191]
s_waitcnt lgkmcnt(4)
v_fmac_f32 v2, v1, v20
v_fmac_f32 v2, v18, v21
v_mfma_f32_16x16x32_bf16 v[216:219], a[0:3], a[80:83], v[216:219]
ds_read_b64_tr_b16 a[104:105], v13 offset:0
v_accvgpr_read_b32 v21, a141
v_mfma_f32_16x16x32_bf16 v[216:219], a[16:19], a[84:87], v[216:219]
ds_read_b64_tr_b16 a[106:107], v13 offset:1024
s_add_u32 m0, s17, 0x10400
v_mfma_f32_16x16x32_bf16 v[224:227], a[20:23], a[84:87], v[224:227]
buffer_load_dwordx4 v5, s[52:55], s13 offen lds
v_mfma_f32_16x16x32_bf16 v[224:227], a[4:7], a[80:83], v[224:227]
ds_read_b64_tr_b16 a[108:109], v13 offset:8192
v_lshlrev_b32 v20, 16, v21
v_mfma_f32_16x16x32_bf16 v[232:235], a[8:11], a[80:83], v[232:235]
ds_read_b64_tr_b16 a[110:111], v13 offset:9216
v_and_b32 v21, 0xffff0000, v21
v_mfma_f32_16x16x32_bf16 v[232:235], a[24:27], a[84:87], v[232:235]
s_lshl_b32 s15, s2, 2
v_fmac_f32 v3, v1, v20
v_fmac_f32 v3, v18, v21
v_mfma_f32_16x16x32_bf16 v[240:243], a[28:31], a[84:87], v[240:243]
s_add_u32 s15, s15, s4
v_accvgpr_read_b32 v18, a150
v_lshlrev_b32 v1, 16, v18
v_mfma_f32_16x16x32_bf16 v[240:243], a[12:15], a[80:83], v[240:243]
s_lshl_b32 s15, s15, 12
v_and_b32 v18, 0xffff0000, v18
v_accvgpr_read_b32 v21, a134
v_mfma_f32_16x16x32_bf16 v[244:247], a[12:15], a[88:91], v[244:247]
ds_read_b64_tr_b16 a[80:81], v12 offset:256
v_lshlrev_b32 v20, 16, v21
v_mfma_f32_16x16x32_bf16 v[244:247], a[28:31], a[92:95], v[244:247]
ds_read_b64_tr_b16 a[82:83], v12 offset:1280
v_and_b32 v21, 0xffff0000, v21
v_mfma_f32_16x16x32_bf16 v[236:239], a[24:27], a[92:95], v[236:239]
ds_read_b64_tr_b16 a[84:85], v12 offset:8448
s_add_u32 m0, s17, 0x10800
v_mfma_f32_16x16x32_bf16 v[236:239], a[8:11], a[88:91], v[236:239]
buffer_load_dwordx4 v6, s[52:55], 0 offen lds
v_mfma_f32_16x16x32_bf16 v[228:231], a[4:7], a[88:91], v[228:231]
ds_read_b64_tr_b16 a[86:87], v12 offset:9472
v_fmac_f32 v2, v1, v20
v_mfma_f32_16x16x32_bf16 v[228:231], a[20:23], a[92:95], v[228:231]
s_add_u32 s15, s15, 0x3800000
v_fmac_f32 v2, v18, v21
v_accvgpr_read_b32 v21, a142
v_mfma_f32_16x16x32_bf16 v[220:223], a[16:19], a[92:95], v[220:223]
v_lshlrev_b32 v20, 16, v21
v_and_b32 v21, 0xffff0000, v21
v_mfma_f32_16x16x32_bf16 v[220:223], a[0:3], a[88:91], v[220:223]
s_waitcnt lgkmcnt(4)
v_fmac_f32 v3, v1, v20
v_fmac_f32 v3, v18, v21
L_S21:
v_mfma_f32_16x16x32_bf16 v[24:27], a[96:99], a[32:35], v[24:27]
ds_read_b64_tr_b16 a[88:89], v13 offset:256
s_waitcnt vmcnt(19)
v_mfma_f32_16x16x32_bf16 v[24:27], a[100:103], a[48:51], v[24:27]
ds_read_b64_tr_b16 a[90:91], v13 offset:1280
v_accvgpr_read_b32 v18, a151
v_mfma_f32_16x16x32_bf16 v[32:35], a[100:103], a[52:55], v[32:35]
ds_read_b64_tr_b16 a[92:93], v13 offset:8448
s_add_u32 m0, s17, 0x10c00
v_mfma_f32_16x16x32_bf16 v[32:35], a[96:99], a[36:39], v[32:35]
buffer_load_dwordx4 v6, s[52:55], s13 offen lds
v_mfma_f32_16x16x32_bf16 v[40:43], a[96:99], a[40:43], v[40:43]
ds_read_b64_tr_b16 a[94:95], v13 offset:9472
v_lshlrev_b32 v1, 16, v18
v_mfma_f32_16x16x32_bf16 v[40:43], a[100:103], a[56:59], v[40:43]
ds_read_b128 a[0:3], v8 offset:0
v_and_b32 v18, 0xffff0000, v18
v_mfma_f32_16x16x32_bf16 v[48:51], a[100:103], a[60:63], v[48:51]
ds_read_b128 a[16:19], v9 offset:0
v_accvgpr_read_b32 v21, a135
v_mfma_f32_16x16x32_bf16 v[48:51], a[96:99], a[44:47], v[48:51]
ds_read_b128 a[4:7], v8 offset:2048
v_lshlrev_b32 v20, 16, v21
v_mfma_f32_16x16x32_bf16 v[52:55], a[104:107], a[44:47], v[52:55]
ds_read_b64_tr_b16 a[96:97], v12 offset:512
v_and_b32 v21, 0xffff0000, v21
v_mfma_f32_16x16x32_bf16 v[52:55], a[108:111], a[60:63], v[52:55]
ds_read_b64_tr_b16 a[98:99], v12 offset:1536
v_fmac_f32 v2, v1, v20
v_mfma_f32_16x16x32_bf16 v[44:47], a[108:111], a[56:59], v[44:47]
ds_read_b64_tr_b16 a[100:101], v12 offset:8704
v_fmac_f32 v2, v18, v21
v_mfma_f32_16x16x32_bf16 v[44:47], a[104:107], a[40:43], v[44:47]
ds_read_b64_tr_b16 a[102:103], v12 offset:9728
s_add_u32 m0, s18, 0x14000
v_mfma_f32_16x16x32_bf16 v[36:39], a[104:107], a[36:39], v[36:39]
buffer_load_dwordx4 v7, s[68:71], 0 offen lds
v_mfma_f32_16x16x32_bf16 v[36:39], a[108:111], a[52:55], v[36:39]
ds_read_b128 a[20:23], v9 offset:2048
v_accvgpr_read_b32 v21, a143
v_mfma_f32_16x16x32_bf16 v[28:31], a[108:111], a[48:51], v[28:31]
ds_read_b128 a[8:11], v8 offset:4096
v_lshlrev_b32 v20, 16, v21
v_mfma_f32_16x16x32_bf16 v[28:31], a[104:107], a[32:35], v[28:31]
ds_read_b128 a[24:27], v9 offset:4096
s_waitcnt lgkmcnt(10)
v_mfma_f32_16x16x32_bf16 v[56:59], a[80:83], a[32:35], v[56:59]
ds_read_b64_tr_b16 a[104:105], v13 offset:512
v_and_b32 v21, 0xffff0000, v21
v_mfma_f32_16x16x32_bf16 v[56:59], a[84:87], a[48:51], v[56:59]
ds_read_b64_tr_b16 a[106:107], v13 offset:1536
v_fmac_f32 v3, v1, v20
v_mfma_f32_16x16x32_bf16 v[64:67], a[84:87], a[52:55], v[64:67]
ds_read_b64_tr_b16 a[108:109], v13 offset:8704
v_fmac_f32 v3, v18, v21
v_mfma_f32_16x16x32_bf16 v[64:67], a[80:83], a[36:39], v[64:67]
ds_read_b64_tr_b16 a[110:111], v13 offset:9728
s_add_u32 m0, s18, 0x15000
v_mfma_f32_16x16x32_bf16 v[72:75], a[80:83], a[40:43], v[72:75]
buffer_load_dwordx4 v7, s[68:71], s25 offen lds
v_mfma_f32_16x16x32_bf16 v[72:75], a[84:87], a[56:59], v[72:75]
ds_read_b128 a[12:15], v8 offset:6144
v_add_f32_dpp v2, v2, v2 row_ror:8 row_mask:0xf bank_mask:0xf
v_mfma_f32_16x16x32_bf16 v[80:83], a[84:87], a[60:63], v[80:83]
ds_read_b128 a[28:31], v9 offset:6144
v_add_f32_dpp v3, v3, v3 row_ror:8 row_mask:0xf bank_mask:0xf
v_mfma_f32_16x16x32_bf16 v[80:83], a[80:83], a[44:47], v[80:83]
v_add_f32_dpp v2, v2, v2 row_ror:4 row_mask:0xf bank_mask:0xf
v_add_f32_dpp v3, v3, v3 row_ror:4 row_mask:0xf bank_mask:0xf
v_mfma_f32_16x16x32_bf16 v[84:87], a[88:91], a[44:47], v[84:87]
ds_read_b64_tr_b16 a[80:81], v12 offset:768
v_add_f32_dpp v2, v2, v2 row_ror:2 row_mask:0xf bank_mask:0xf
v_mfma_f32_16x16x32_bf16 v[84:87], a[92:95], a[60:63], v[84:87]
ds_read_b64_tr_b16 a[82:83], v12 offset:1792
v_add_f32_dpp v3, v3, v3 row_ror:2 row_mask:0xf bank_mask:0xf
v_mfma_f32_16x16x32_bf16 v[76:79], a[92:95], a[56:59], v[76:79]
ds_read_b64_tr_b16 a[84:85], v12 offset:8960
v_add_f32_dpp v2, v2, v2 row_ror:1 row_mask:0xf bank_mask:0xf
v_mfma_f32_16x16x32_bf16 v[76:79], a[88:91], a[40:43], v[76:79]
ds_read_b64_tr_b16 a[86:87], v12 offset:9984
v_add_f32_dpp v3, v3, v3 row_ror:1 row_mask:0xf bank_mask:0xf
v_mfma_f32_16x16x32_bf16 v[68:71], a[88:91], a[36:39], v[68:71]
s_add_u32 m0, s18, 0x16000
v_mov_b32 v1, v2
v_mov_b32 v18, v3
v_mfma_f32_16x16x32_bf16 v[68:71], a[92:95], a[52:55], v[68:71]
buffer_load_dwordx4 v7, s[68:71], s26 offen lds
v_mfma_f32_16x16x32_bf16 v[60:63], a[92:95], a[48:51], v[60:63]
v_permlane16_swap_b32 v1, v2
v_permlane16_swap_b32 v18, v3
v_mfma_f32_16x16x32_bf16 v[60:63], a[88:91], a[32:35], v[60:63]
s_waitcnt lgkmcnt(6)
v_add_f32 v2, v2, v1
v_add_f32 v3, v3, v18
v_mfma_f32_16x16x32_bf16 v[88:91], a[96:99], a[32:35], v[88:91]
ds_read_b64_tr_b16 a[88:89], v13 offset:768
v_mov_b32 v1, v2
v_mfma_f32_16x16x32_bf16 v[88:91], a[100:103], a[48:51], v[88:91]
ds_read_b64_tr_b16 a[90:91], v13 offset:1792
v_mov_b32 v18, v3
v_mfma_f32_16x16x32_bf16 v[96:99], a[100:103], a[52:55], v[96:99]
ds_read_b64_tr_b16 a[92:93], v13 offset:8960
v_permlane32_swap_b32 v1, v2
v_mfma_f32_16x16x32_bf16 v[96:99], a[96:99], a[36:39], v[96:99]
ds_read_b64_tr_b16 a[94:95], v13 offset:9984
v_permlane32_swap_b32 v18, v3
v_mfma_f32_16x16x32_bf16 v[104:107], a[96:99], a[40:43], v[104:107]
v_add_f32 v2, v2, v1
v_add_f32 v3, v3, v18
v_mfma_f32_16x16x32_bf16 v[104:107], a[100:103], a[56:59], v[104:107]
buffer_load_dword v23, off, s[84:87], s10 sc1
v_mfma_f32_16x16x32_bf16 v[112:115], a[100:103], a[60:63], v[112:115]
v_mul_f32 v2, 0xbfb8aa3b, v2
v_mul_f32 v3, 0xbfb8aa3b, v3
v_mfma_f32_16x16x32_bf16 v[112:115], a[96:99], a[44:47], v[112:115]
v_exp_f32 v2, v2
v_mfma_f32_16x16x32_bf16 v[116:119], a[104:107], a[44:47], v[116:119]
ds_read_b64_tr_b16 a[96:97], v14 offset:0
v_mfma_f32_16x16x32_bf16 v[116:119], a[108:111], a[60:63], v[116:119]
ds_read_b64_tr_b16 a[98:99], v14 offset:256
v_mfma_f32_16x16x32_bf16 v[108:111], a[108:111], a[56:59], v[108:111]
ds_read_b64_tr_b16 a[100:101], v14 offset:2048
v_mfma_f32_16x16x32_bf16 v[108:111], a[104:107], a[40:43], v[108:111]
ds_read_b64_tr_b16 a[102:103], v14 offset:2304
v_mfma_f32_16x16x32_bf16 v[100:103], a[104:107], a[36:39], v[100:103]
v_exp_f32 v3, v3
v_mfma_f32_16x16x32_bf16 v[100:103], a[108:111], a[52:55], v[100:103]
v_add_f32 v2, 1.0, v2
v_add_f32 v3, 1.0, v3
v_mfma_f32_16x16x32_bf16 v[92:95], a[108:111], a[48:51], v[92:95]
v_rcp_f32 v2, v2
v_mfma_f32_16x16x32_bf16 v[92:95], a[104:107], a[32:35], v[92:95]
s_waitcnt lgkmcnt(4)
v_rcp_f32 v3, v3
v_mfma_f32_16x16x32_bf16 v[120:123], a[80:83], a[32:35], v[120:123]
ds_read_b64_tr_b16 a[104:105], v15 offset:0
v_mfma_f32_16x16x32_bf16 v[120:123], a[84:87], a[48:51], v[120:123]
ds_read_b64_tr_b16 a[106:107], v15 offset:256
v_mfma_f32_16x16x32_bf16 v[128:131], a[84:87], a[52:55], v[128:131]
ds_read_b64_tr_b16 a[108:109], v15 offset:2048
v_mfma_f32_16x16x32_bf16 v[128:131], a[80:83], a[36:39], v[128:131]
ds_read_b64_tr_b16 a[110:111], v15 offset:2304
v_mfma_f32_16x16x32_bf16 v[136:139], a[80:83], a[40:43], v[136:139]
buffer_store_dwordx2 v[2:3], off, s[88:91], s101 sc1
v_mfma_f32_16x16x32_bf16 v[136:139], a[84:87], a[56:59], v[136:139]
v_mfma_f32_16x16x32_bf16 v[144:147], a[84:87], a[60:63], v[144:147]
v_mfma_f32_16x16x32_bf16 v[144:147], a[80:83], a[44:47], v[144:147]
v_mfma_f32_16x16x32_bf16 v[148:151], a[88:91], a[44:47], v[148:151]
ds_read_b64_tr_b16 a[80:81], v14 offset:4096
v_mfma_f32_16x16x32_bf16 v[148:151], a[92:95], a[60:63], v[148:151]
ds_read_b64_tr_b16 a[82:83], v14 offset:4352
v_mfma_f32_16x16x32_bf16 v[140:143], a[92:95], a[56:59], v[140:143]
ds_read_b64_tr_b16 a[84:85], v14 offset:6144
v_mfma_f32_16x16x32_bf16 v[140:143], a[88:91], a[40:43], v[140:143]
ds_read_b64_tr_b16 a[86:87], v14 offset:6400
v_mfma_f32_16x16x32_bf16 v[132:135], a[88:91], a[36:39], v[132:135]
v_mfma_f32_16x16x32_bf16 v[132:135], a[92:95], a[52:55], v[132:135]
v_mfma_f32_16x16x32_bf16 v[124:127], a[92:95], a[48:51], v[124:127]
v_mfma_f32_16x16x32_bf16 v[124:127], a[88:91], a[32:35], v[124:127]
s_waitcnt lgkmcnt(4)
v_mfma_f32_16x16x32_bf16 v[152:155], a[96:99], a[32:35], v[152:155]
ds_read_b64_tr_b16 a[88:89], v15 offset:4096
v_mfma_f32_16x16x32_bf16 v[152:155], a[100:103], a[48:51], v[152:155]
ds_read_b64_tr_b16 a[90:91], v15 offset:4352
v_mfma_f32_16x16x32_bf16 v[160:163], a[100:103], a[52:55], v[160:163]
ds_read_b64_tr_b16 a[92:93], v15 offset:6144
v_mfma_f32_16x16x32_bf16 v[160:163], a[96:99], a[36:39], v[160:163]
ds_read_b64_tr_b16 a[94:95], v15 offset:6400
v_mfma_f32_16x16x32_bf16 v[168:171], a[96:99], a[40:43], v[168:171]
v_mfma_f32_16x16x32_bf16 v[168:171], a[100:103], a[56:59], v[168:171]
v_mfma_f32_16x16x32_bf16 v[176:179], a[100:103], a[60:63], v[176:179]
v_mfma_f32_16x16x32_bf16 v[176:179], a[96:99], a[44:47], v[176:179]
v_mfma_f32_16x16x32_bf16 v[180:183], a[104:107], a[44:47], v[180:183]
ds_read_b64_tr_b16 a[96:97], v14 offset:8192
v_mfma_f32_16x16x32_bf16 v[180:183], a[108:111], a[60:63], v[180:183]
ds_read_b64_tr_b16 a[98:99], v14 offset:8448
v_mfma_f32_16x16x32_bf16 v[172:175], a[108:111], a[56:59], v[172:175]
ds_read_b64_tr_b16 a[100:101], v14 offset:10240
v_mfma_f32_16x16x32_bf16 v[172:175], a[104:107], a[40:43], v[172:175]
ds_read_b64_tr_b16 a[102:103], v14 offset:10496
v_mfma_f32_16x16x32_bf16 v[164:167], a[104:107], a[36:39], v[164:167]
v_mfma_f32_16x16x32_bf16 v[164:167], a[108:111], a[52:55], v[164:167]
v_mfma_f32_16x16x32_bf16 v[156:159], a[108:111], a[48:51], v[156:159]
v_mfma_f32_16x16x32_bf16 v[156:159], a[104:107], a[32:35], v[156:159]
s_waitcnt lgkmcnt(4)
v_mfma_f32_16x16x32_bf16 v[184:187], a[80:83], a[32:35], v[184:187]
ds_read_b64_tr_b16 a[104:105], v15 offset:8192
v_mfma_f32_16x16x32_bf16 v[184:187], a[84:87], a[48:51], v[184:187]
ds_read_b64_tr_b16 a[106:107], v15 offset:8448
v_mfma_f32_16x16x32_bf16 v[192:195], a[84:87], a[52:55], v[192:195]
ds_read_b64_tr_b16 a[108:109], v15 offset:10240
v_mfma_f32_16x16x32_bf16 v[192:195], a[80:83], a[36:39], v[192:195]
ds_read_b64_tr_b16 a[110:111], v15 offset:10496
v_add_u32 v12, 0x8000, v12
v_mfma_f32_16x16x32_bf16 v[200:203], a[80:83], a[40:43], v[200:203]
v_add_u32 v13, 0x8000, v13
v_add_u32 v14, 0x8000, v14
v_mfma_f32_16x16x32_bf16 v[200:203], a[84:87], a[56:59], v[200:203]
v_add_u32 v15, 0x8000, v15
v_mfma_f32_16x16x32_bf16 v[208:211], a[84:87], a[60:63], v[208:211]
v_mfma_f32_16x16x32_bf16 v[208:211], a[80:83], a[44:47], v[208:211]
v_mfma_f32_16x16x32_bf16 v[212:215], a[88:91], a[44:47], v[212:215]
s_waitcnt vmcnt(1) lgkmcnt(0)
s_mov_b32 s92, 200000
L_spin_kv:
v_readfirstlane_b32 s93, v23
s_nop 1
s_cmp_ge_u32 s93, 8
s_cbranch_scc1 L_spun_kv
s_sub_u32 s92, s92, 1
s_cbranch_scc1 L_spun_kv
s_sleep 4
buffer_load_dword v23, off, s[84:87], s10 sc1
s_waitcnt vmcnt(0)
s_branch L_spin_kv
L_spun_kv:
v_mfma_f32_16x16x32_bf16 v[212:215], a[92:95], a[60:63], v[212:215]
s_barrier
s_add_u32 m0, s19, 0x0
v_mfma_f32_16x16x32_bf16 v[204:207], a[92:95], a[56:59], v[204:207]
buffer_load_dwordx4 v16, s[48:51], s32 offen offset:0 sc1 lds
v_mfma_f32_16x16x32_bf16 v[204:207], a[88:91], a[40:43], v[204:207]
ds_read_b64_tr_b16 a[80:81], v12 offset:0
v_mov_b32 v3, v16
v_mfma_f32_16x16x32_bf16 v[196:199], a[88:91], a[36:39], v[196:199]
ds_read_b64_tr_b16 a[82:83], v12 offset:1024
v_mov_b32 v22, 0x3f803f80
v_mfma_f32_16x16x32_bf16 v[196:199], a[92:95], a[52:55], v[196:199]
ds_read_b64_tr_b16 a[84:85], v12 offset:8192
s_mov_b32 s33, 0
v_mfma_f32_16x16x32_bf16 v[188:191], a[92:95], a[48:51], v[188:191]
ds_read_b64_tr_b16 a[86:87], v12 offset:9216
v_accvgpr_write_b32 a240, v22
v_mfma_f32_16x16x32_bf16 v[188:191], a[88:91], a[32:35], v[188:191]
s_waitcnt lgkmcnt(4)
v_accvgpr_write_b32 a241, v22
v_accvgpr_write_b32 a242, v22
v_mfma_f32_16x16x32_bf16 v[216:219], a[32:35], a[96:99], v[216:219]
buffer_load_dwordx4 v16, s[48:51], s32 offen offset:1024 sc1 lds
v_accvgpr_write_b32 a243, v22
v_mfma_f32_16x16x32_bf16 v[216:219], a[48:51], a[100:103], v[216:219]
ds_read_b64_tr_b16 a[88:89], v13 offset:0
s_mov_b32 s36, 0x33333333
v_mfma_f32_16x16x32_bf16 v[224:227], a[52:55], a[100:103], v[224:227]
ds_read_b64_tr_b16 a[90:91], v13 offset:1024
s_mov_b32 s37, 0xcccccccc
v_mfma_f32_16x16x32_bf16 v[224:227], a[36:39], a[96:99], v[224:227]
ds_read_b64_tr_b16 a[92:93], v13 offset:8192
v_cndmask_b32 v4, 0, v22, s[36:37]
v_mfma_f32_16x16x32_bf16 v[232:235], a[40:43], a[96:99], v[232:235]
ds_read_b64_tr_b16 a[94:95], v13 offset:9216
v_accvgpr_write_b32 a232, v4
v_mfma_f32_16x16x32_bf16 v[232:235], a[56:59], a[100:103], v[232:235]
v_accvgpr_write_b32 a233, v4
v_accvgpr_write_b32 a234, v4
v_mfma_f32_16x16x32_bf16 v[240:243], a[60:63], a[100:103], v[240:243]
v_accvgpr_write_b32 a235, v4
v_mfma_f32_16x16x32_bf16 v[240:243], a[44:47], a[96:99], v[240:243]
buffer_load_dwordx4 v16, s[48:51], s32 offen offset:2048 sc1 lds
v_mfma_f32_16x16x32_bf16 v[244:247], a[44:47], a[104:107], v[244:247]
ds_read_b64_tr_b16 a[96:97], v12 offset:256
s_mov_b32 s36, 0x44444444
s_mov_b32 s37, 0x44444444
v_mfma_f32_16x16x32_bf16 v[244:247], a[60:63], a[108:111], v[244:247]
ds_read_b64_tr_b16 a[98:99], v12 offset:1280
v_cndmask_b32 v4, 0, v22, s[36:37]
v_mfma_f32_16x16x32_bf16 v[236:239], a[56:59], a[108:111], v[236:239]
ds_read_b64_tr_b16 a[100:101], v12 offset:8448
v_accvgpr_write_b32 a236, v4
v_mfma_f32_16x16x32_bf16 v[236:239], a[40:43], a[104:107], v[236:239]
ds_read_b64_tr_b16 a[102:103], v12 offset:9472
v_accvgpr_write_b32 a237, v4
v_mfma_f32_16x16x32_bf16 v[228:231], a[36:39], a[104:107], v[228:231]
v_accvgpr_write_b32 a238, v4
v_accvgpr_write_b32 a239, v4
v_mfma_f32_16x16x32_bf16 v[228:231], a[52:55], a[108:111], v[228:231]
v_mov_b32 v1, v3
v_add_u32 v2, 98304, v3
v_mfma_f32_16x16x32_bf16 v[220:223], a[48:51], a[108:111], v[220:223]
buffer_load_dwordx4 v16, s[48:51], s32 offen offset:3072 sc1 lds
v_mfma_f32_16x16x32_bf16 v[220:223], a[32:35], a[104:107], v[220:223]
s_waitcnt lgkmcnt(4)
s_mov_b64 s[34:35], 0
v_accvgpr_write_b32 a224, 0
L_S22:
v_mfma_f32_16x16x32_bf16 v[24:27], a[80:83], a[0:3], v[24:27]
ds_read_b64_tr_b16 a[104:105], v13 offset:256
s_waitcnt vmcnt(13)
v_accvgpr_write_b32 a225, 0
v_mfma_f32_16x16x32_bf16 v[24:27], a[84:87], a[16:19], v[24:27]
ds_read_b64_tr_b16 a[106:107], v13 offset:1280
v_accvgpr_write_b32 a226, 0
v_mfma_f32_16x16x32_bf16 v[32:35], a[84:87], a[20:23], v[32:35]
ds_read_b64_tr_b16 a[108:109], v13 offset:8448
v_accvgpr_write_b32 a227, 0
v_mfma_f32_16x16x32_bf16 v[32:35], a[80:83], a[4:7], v[32:35]
ds_read_b64_tr_b16 a[110:111], v13 offset:9472
v_accvgpr_write_b32 a228, 0
v_mfma_f32_16x16x32_bf16 v[40:43], a[80:83], a[8:11], v[40:43]
ds_read_b128 a[32:35], v8 offset:32768
s_add_u32 m0, s19, 0x1000
v_mfma_f32_16x16x32_bf16 v[40:43], a[84:87], a[24:27], v[40:43]
buffer_load_dwordx4 v16, s[48:51], s7 offen offset:0 sc1 lds
v_mfma_f32_16x16x32_bf16 v[48:51], a[84:87], a[28:31], v[48:51]
ds_read_b128 a[48:51], v9 offset:32768
v_accvgpr_write_b32 a229, 0
v_mfma_f32_16x16x32_bf16 v[48:51], a[80:83], a[12:15], v[48:51]
ds_read_b128 a[36:39], v8 offset:34816
L_padA11:
s_cmp_eq_u32 s95, 1
s_cbranch_scc1 L_hopA_ret
v_accvgpr_write_b32 a230, 0
v_mfma_f32_16x16x32_bf16 v[52:55], a[88:91], a[12:15], v[52:55]
ds_read_b64_tr_b16 a[80:81], v12 offset:512
v_accvgpr_write_b32 a231, 0
v_mfma_f32_16x16x32_bf16 v[52:55], a[92:95], a[28:31], v[52:55]
ds_read_b64_tr_b16 a[82:83], v12 offset:1536
s_mul_i32 s8, s6, 0x142400
v_mfma_f32_16x16x32_bf16 v[44:47], a[92:95], a[24:27], v[44:47]
ds_read_b64_tr_b16 a[84:85], v12 offset:8704
s_sub_u32 s9, 0x12e1c00, s8
v_mfma_f32_16x16x32_bf16 v[44:47], a[88:91], a[8:11], v[44:47]
buffer_load_dwordx4 v16, s[48:51], s7 offen offset:1024 sc1 lds
v_mfma_f32_16x16x32_bf16 v[36:39], a[88:91], a[4:7], v[36:39]
ds_read_b64_tr_b16 a[86:87], v12 offset:9728
s_lshl_b32 s11, s5, 13
v_mfma_f32_16x16x32_bf16 v[36:39], a[92:95], a[20:23], v[36:39]
ds_read_b128 a[52:55], v9 offset:34816
s_add_u32 s11, s11, 0x2200000
v_mfma_f32_16x16x32_bf16 v[28:31], a[92:95], a[16:19], v[28:31]
ds_read_b128 a[40:43], v8 offset:36864
s_add_u32 s8, s8, s11
v_mfma_f32_16x16x32_bf16 v[28:31], a[88:91], a[0:3], v[28:31]
ds_read_b128 a[56:59], v9 offset:36864
s_waitcnt lgkmcnt(10)
v_mfma_f32_16x16x32_bf16 v[56:59], a[96:99], a[0:3], v[56:59]
ds_read_b64_tr_b16 a[88:89], v13 offset:512
s_add_u32 s9, s9, s11
s_lshl_b32 s11, s4, 10
v_mfma_f32_16x16x32_bf16 v[56:59], a[100:103], a[16:19], v[56:59]
ds_read_b64_tr_b16 a[90:91], v13 offset:1536
s_add_u32 s44, s8, s11
v_mfma_f32_16x16x32_bf16 v[64:67], a[100:103], a[20:23], v[64:67]
buffer_load_dwordx4 v16, s[48:51], s7 offen offset:2048 sc1 lds
v_mfma_f32_16x16x32_bf16 v[64:67], a[96:99], a[4:7], v[64:67]
ds_read_b64_tr_b16 a[92:93], v13 offset:8704
s_add_u32 s46, s9, s11
v_mfma_f32_16x16x32_bf16 v[72:75], a[96:99], a[8:11], v[72:75]
ds_read_b64_tr_b16 a[94:95], v13 offset:9728
s_sub_u32 s11, 0x1c00, s11
v_mfma_f32_16x16x32_bf16 v[72:75], a[100:103], a[24:27], v[72:75]
ds_read_b128 a[44:47], v8 offset:38912
s_add_u32 s45, s8, s11
v_mfma_f32_16x16x32_bf16 v[80:83], a[100:103], a[28:31], v[80:83]
ds_read_b128 a[60:63], v9 offset:38912
s_add_u32 s47, s9, s11
v_mfma_f32_16x16x32_bf16 v[80:83], a[96:99], a[12:15], v[80:83]
s_mul_i32 s8, s5, 0x6000
s_add_u32 s8, s8, 0x40000
s_add_u32 s28, s44, s8
v_mfma_f32_16x16x32_bf16 v[84:87], a[104:107], a[12:15], v[84:87]
ds_read_b64_tr_b16 a[96:97], v12 offset:768
s_add_u32 s29, s45, s8
s_add_u32 s30, s46, s8
v_mfma_f32_16x16x32_bf16 v[84:87], a[108:111], a[28:31], v[84:87]
buffer_load_dwordx4 v16, s[48:51], s7 offen offset:3072 sc1 lds
v_mfma_f32_16x16x32_bf16 v[76:79], a[108:111], a[24:27], v[76:79]
ds_read_b64_tr_b16 a[98:99], v12 offset:1792
s_add_u32 s32, s32, s94
v_mfma_f32_16x16x32_bf16 v[76:79], a[104:107], a[8:11], v[76:79]
ds_read_b64_tr_b16 a[100:101], v12 offset:8960
s_add_u32 s7, s7, s94
v_mfma_f32_16x16x32_bf16 v[68:71], a[104:107], a[4:7], v[68:71]
ds_read_b64_tr_b16 a[102:103], v12 offset:9984
s_add_u32 s31, s47, s8
v_mfma_f32_16x16x32_bf16 v[68:71], a[108:111], a[20:23], v[68:71]
s_lshl_b32 s8, s4, 11
s_add_u32 s9, s8, 131072
v_add_u32 v4, s9, v16
v_mfma_f32_16x16x32_bf16 v[60:63], a[108:111], a[16:19], v[60:63]
s_sub_u32 s9, 145408, s8
s_cmp_eq_u32 s4, 0
s_cselect_b32 s8, 131072, s9
v_mfma_f32_16x16x32_bf16 v[60:63], a[104:107], a[0:3], v[60:63]
s_add_u32 m0, s19, 0x18000
s_waitcnt lgkmcnt(6)
v_add_u32 v5, s8, v16
v_mfma_f32_16x16x32_bf16 v[88:91], a[80:83], a[0:3], v[88:91]
buffer_load_dwordx4 v16, s[48:51], s32 offen offset:0 sc1 lds
v_add_u32 v6, s9, v16
v_mfma_f32_16x16x32_bf16 v[88:91], a[84:87], a[16:19], v[88:91]
ds_read_b64_tr_b16 a[104:105], v13 offset:768
v_add_u32 v22, 0x800, v10
v_mfma_f32_16x16x32_bf16 v[96:99], a[84:87], a[20:23], v[96:99]
ds_read_b64_tr_b16 a[106:107], v13 offset:1792
s_mov_b32 s8, 0x800
v_mfma_f32_16x16x32_bf16 v[96:99], a[80:83], a[4:7], v[96:99]
ds_read_b64_tr_b16 a[108:109], v13 offset:8960
v_mfma_f32_16x16x32_bf16 v[104:107], a[80:83], a[8:11], v[104:107]
ds_read_b64_tr_b16 a[110:111], v13 offset:9984
v_mfma_f32_16x16x32_bf16 v[104:107], a[84:87], a[24:27], v[104:107]
s_cmp_eq_u32 s6, 0
s_cselect_b32 s8, 0xffff8800, s8
v_add_u32 v7, s8, v11
v_mfma_f32_16x16x32_bf16 v[112:115], a[84:87], a[28:31], v[112:115]
buffer_load_dwordx4 v16, s[48:51], s32 offen offset:1024 sc1 lds
v_mfma_f32_16x16x32_bf16 v[112:115], a[80:83], a[12:15], v[112:115]
s_bfe_u32 s99, s2, 0x20001
s_lshl_b32 s99, s99, 2
s_lshr_b32 s8, s2, 6
v_mfma_f32_16x16x32_bf16 v[116:119], a[88:91], a[12:15], v[116:119]
ds_read_b64_tr_b16 a[80:81], v14 offset:0
s_add_u32 s99, s99, s8
s_bfe_u32 s100, s2, 0x30003
v_mfma_f32_16x16x32_bf16 v[116:119], a[92:95], a[28:31], v[116:119]
ds_read_b64_tr_b16 a[82:83], v14 offset:256
s_and_b32 s14, s2, 1
v_mfma_f32_16x16x32_bf16 v[108:111], a[92:95], a[24:27], v[108:111]
ds_read_b64_tr_b16 a[84:85], v14 offset:2048
s_sub_u32 s24, 15, s99
v_mfma_f32_16x16x32_bf16 v[108:111], a[88:91], a[8:11], v[108:111]
ds_read_b64_tr_b16 a[86:87], v14 offset:2304
s_min_u32 s18, s24, s99
v_mfma_f32_16x16x32_bf16 v[100:103], a[88:91], a[4:7], v[100:103]
buffer_load_dwordx4 v16, s[48:51], s32 offen offset:2048 sc1 lds
v_mfma_f32_16x16x32_bf16 v[100:103], a[92:95], a[20:23], v[100:103]
s_lshl_b32 s24, s18, 1
s_add_u32 s24, s24, s14
s_lshl_b32 s24, s24, 8
v_mfma_f32_16x16x32_bf16 v[92:95], a[92:95], a[16:19], v[92:95]
s_add_u32 s24, s24, 0x3704000
s_mov_b32 s12, 14336
s_and_b32 s16, s6, 1
v_mfma_f32_16x16x32_bf16 v[92:95], a[88:91], a[0:3], v[92:95]
s_waitcnt lgkmcnt(4)
s_lshl_b32 s16, s16, 15
s_add_u32 s16, s16, 98304
v_mfma_f32_16x16x32_bf16 v[120:123], a[96:99], a[0:3], v[120:123]
ds_read_b64_tr_b16 a[88:89], v15 offset:0
s_add_u32 s16, s16, s17
s_lshl_b32 s13, s4, 15
v_mfma_f32_16x16x32_bf16 v[120:123], a[100:103], a[16:19], v[120:123]
ds_read_b64_tr_b16 a[90:91], v15 offset:256
s_lshl_b32 s9, s100, 8
v_mfma_f32_16x16x32_bf16 v[128:131], a[100:103], a[20:23], v[128:131]
buffer_load_dwordx4 v16, s[48:51], s32 offen offset:3072 sc1 lds
v_mfma_f32_16x16x32_bf16 v[128:131], a[96:99], a[4:7], v[128:131]
ds_read_b64_tr_b16 a[92:93], v15 offset:2048
s_add_u32 s13, s13, s9
v_mfma_f32_16x16x32_bf16 v[136:139], a[96:99], a[8:11], v[136:139]
ds_read_b64_tr_b16 a[94:95], v15 offset:2304
s_mul_i32 s9, s14, 1310848
v_mfma_f32_16x16x32_bf16 v[136:139], a[100:103], a[24:27], v[136:139]
s_add_u32 s13, s13, s9
s_mul_i32 s25, s14, 3407872
s_sub_u32 s25, s25, 1179648
v_mfma_f32_16x16x32_bf16 v[144:147], a[100:103], a[28:31], v[144:147]
s_mul_i32 s101, s99, 0x142400
s_lshl_b32 s8, s4, 11
s_add_u32 s101, s101, s8
v_mfma_f32_16x16x32_bf16 v[144:147], a[96:99], a[12:15], v[144:147]
s_add_u32 m0, s19, 0x19000
s_mul_i32 s8, s14, 163840
s_add_u32 s101, s101, s8
v_mfma_f32_16x16x32_bf16 v[148:151], a[104:107], a[12:15], v[148:151]
buffer_load_dwordx4 v16, s[48:51], s7 offen offset:0 sc1 lds
s_add_u32 s101, s101, 0x21fe000
v_mfma_f32_16x16x32_bf16 v[148:151], a[108:111], a[28:31], v[148:151]
ds_read_b64_tr_b16 a[96:97], v14 offset:4096
s_mul_i32 s26, s14, 425984
v_mfma_f32_16x16x32_bf16 v[140:143], a[108:111], a[24:27], v[140:143]
ds_read_b64_tr_b16 a[98:99], v14 offset:4352
s_add_u32 s26, s26, 106496
v_mfma_f32_16x16x32_bf16 v[140:143], a[104:107], a[8:11], v[140:143]
ds_read_b64_tr_b16 a[100:101], v14 offset:6144
s_mov_b32 s52, 0x3e0293ee
v_mfma_f32_16x16x32_bf16 v[132:135], a[104:107], a[4:7], v[132:135]
ds_read_b64_tr_b16 a[102:103], v14 offset:6400
s_mov_b32 s53, 0x3e0293ee
v_mfma_f32_16x16x32_bf16 v[132:135], a[108:111], a[20:23], v[132:135]
s_mov_b32 s54, 0x3e8293ee
s_or_b32 s55, s6, s4
s_cselect_b32 s55, 0, 0xf149f2ca
v_mfma_f32_16x16x32_bf16 v[124:127], a[108:111], a[16:19], v[124:127]
s_waitcnt lgkmcnt(4)
s_mov_b32 s56, 0x50000
s_mov_b32 s57, 0x5550055
v_mfma_f32_16x16x32_bf16 v[124:127], a[104:107], a[0:3], v[124:127]
buffer_load_dwordx4 v16, s[48:51], s7 offen offset:1024 sc1 lds
v_mfma_f32_16x16x32_bf16 v[152:155], a[80:83], a[0:3], v[152:155]
ds_read_b64_tr_b16 a[104:105], v15 offset:4096
s_mov_b32 s58, 0xa0000
s_mov_b32 s59, 0xaaa00aa
v_mfma_f32_16x16x32_bf16 v[152:155], a[84:87], a[16:19], v[152:155]
ds_read_b64_tr_b16 a[106:107], v15 offset:4352
s_mov_b32 s60, 0x150001
v_mfma_f32_16x16x32_bf16 v[160:163], a[84:87], a[20:23], v[160:163]
ds_read_b64_tr_b16 a[108:109], v15 offset:6144
s_mov_b32 s61, 0x15550155
v_mfma_f32_16x16x32_bf16 v[160:163], a[80:83], a[4:7], v[160:163]
ds_read_b64_tr_b16 a[110:111], v15 offset:6400
s_mov_b32 s62, 0x2a0002
v_mfma_f32_16x16x32_bf16 v[168:171], a[80:83], a[8:11], v[168:171]
s_mov_b32 s63, 0x2aaa02aa
s_mov_b32 s68, 0x55505555
s_mov_b32 s69, 0x50005500
v_mfma_f32_16x16x32_bf16 v[168:171], a[84:87], a[24:27], v[168:171]
buffer_load_dwordx4 v16, s[48:51], s7 offen offset:2048 sc1 lds
v_mfma_f32_16x16x32_bf16 v[176:179], a[84:87], a[28:31], v[176:179]
s_mov_b32 s70, 0xaaa0aaaa
s_mov_b32 s71, 0xa000aa00
s_mov_b32 s76, 0x55405554
v_mfma_f32_16x16x32_bf16 v[176:179], a[80:83], a[12:15], v[176:179]
s_mov_b32 s77, 0x40005400
s_mov_b32 s78, 0xaa80aaa8
s_mov_b32 s79, 0x8000a800
v_mfma_f32_16x16x32_bf16 v[180:183], a[88:91], a[12:15], v[180:183]
ds_read_b64_tr_b16 a[80:81], v14 offset:8192
s_mov_b32 s11, 0xf149f2ca
s_mov_b32 s36, 0xfff0ffff
v_mfma_f32_16x16x32_bf16 v[180:183], a[92:95], a[28:31], v[180:183]
ds_read_b64_tr_b16 a[82:83], v14 offset:8448
s_mov_b32 s37, 0xf000ff00
v_mfma_f32_16x16x32_bf16 v[172:175], a[92:95], a[24:27], v[172:175]
ds_read_b64_tr_b16 a[84:85], v14 offset:10240
s_mov_b32 s38, 0xffe0fffe
v_mfma_f32_16x16x32_bf16 v[172:175], a[88:91], a[8:11], v[172:175]
buffer_load_dwordx4 v16, s[48:51], s7 offen offset:3072 sc1 lds
v_mfma_f32_16x16x32_bf16 v[164:167], a[88:91], a[4:7], v[164:167]
ds_read_b64_tr_b16 a[86:87], v14 offset:10496
s_add_u32 s32, s32, 0x8000
v_mfma_f32_16x16x32_bf16 v[164:167], a[92:95], a[20:23], v[164:167]
s_add_u32 s7, s7, 0x8000
s_mov_b32 s39, 0xe000fe00
s_mov_b32 s40, 0xffc0fffc
v_mfma_f32_16x16x32_bf16 v[156:159], a[92:95], a[16:19], v[156:159]
s_mov_b32 s41, 0xc000fc00
s_mov_b32 s42, 0xff80fff8
s_mov_b32 s43, 0x8000f800
v_mfma_f32_16x16x32_bf16 v[156:159], a[88:91], a[0:3], v[156:159]
s_waitcnt lgkmcnt(4)
v_mov_b32 v21, s1
v_mfma_f32_16x16x32_bf16 v[184:187], a[96:99], a[0:3], v[184:187]
ds_read_b64_tr_b16 a[88:89], v15 offset:8192
v_add_u32 v20, s0, v16
v_mfma_f32_16x16x32_bf16 v[184:187], a[100:103], a[16:19], v[184:187]
global_load_dword a120, v[20:21], off sc1
v_mfma_f32_16x16x32_bf16 v[192:195], a[100:103], a[20:23], v[192:195]
ds_read_b64_tr_b16 a[90:91], v15 offset:8448
v_mfma_f32_16x16x32_bf16 v[192:195], a[96:99], a[4:7], v[192:195]
ds_read_b64_tr_b16 a[92:93], v15 offset:10240
v_mfma_f32_16x16x32_bf16 v[200:203], a[96:99], a[8:11], v[200:203]
ds_read_b64_tr_b16 a[94:95], v15 offset:10496
v_add_u32 v12, 0x8000, v12
v_mfma_f32_16x16x32_bf16 v[200:203], a[100:103], a[24:27], v[200:203]
v_add_u32 v13, 0x8000, v13
v_add_u32 v14, 0x8000, v14
v_mfma_f32_16x16x32_bf16 v[208:211], a[100:103], a[28:31], v[208:211]
v_add_u32 v15, 0x8000, v15
v_mfma_f32_16x16x32_bf16 v[208:211], a[96:99], a[12:15], v[208:211]
s_bitcmp1_b32 s4, 0
s_cselect_b32 s8, 0x7f800000, s11
s_cselect_b32 s9, s11, 0x7f800000
v_mfma_f32_16x16x32_bf16 v[212:215], a[104:107], a[12:15], v[212:215]
s_waitcnt vmcnt(19) lgkmcnt(0)
v_mfma_f32_16x16x32_bf16 v[212:215], a[108:111], a[28:31], v[212:215]
s_barrier
s_add_u32 m0, s19, 0x8000
v_mfma_f32_16x16x32_bf16 v[204:207], a[108:111], a[24:27], v[204:207]
buffer_load_dwordx4 v16, s[48:51], s32 offen offset:0 sc1 lds
v_mfma_f32_16x16x32_bf16 v[204:207], a[104:107], a[8:11], v[204:207]
ds_read_b64_tr_b16 a[96:97], v14 offset:4096
v_mfma_f32_16x16x32_bf16 v[196:199], a[104:107], a[4:7], v[196:199]
ds_read_b64_tr_b16 a[98:99], v14 offset:4352
v_mfma_f32_16x16x32_bf16 v[196:199], a[108:111], a[20:23], v[196:199]
ds_read_b64_tr_b16 a[100:101], v14 offset:6144
v_mfma_f32_16x16x32_bf16 v[188:191], a[108:111], a[16:19], v[188:191]
buffer_load_dwordx4 v16, s[48:51], s32 offen offset:1024 sc1 lds
v_mfma_f32_16x16x32_bf16 v[188:191], a[104:107], a[0:3], v[188:191]
ds_read_b64_tr_b16 a[102:103], v14 offset:6400
s_waitcnt lgkmcnt(4)
v_mfma_f32_16x16x32_bf16 v[216:219], a[0:3], a[80:83], v[216:219]
ds_read_b64_tr_b16 a[104:105], v15 offset:4096
v_mfma_f32_16x16x32_bf16 v[216:219], a[16:19], a[84:87], v[216:219]
ds_read_b64_tr_b16 a[106:107], v15 offset:4352
v_mfma_f32_16x16x32_bf16 v[224:227], a[20:23], a[84:87], v[224:227]
ds_read_b64_tr_b16 a[108:109], v15 offset:6144
v_mfma_f32_16x16x32_bf16 v[224:227], a[4:7], a[80:83], v[224:227]
buffer_store_dwordx4 a[64:67], v16, s[88:91], s15 offen offset:0 sc1
v_mfma_f32_16x16x32_bf16 v[232:235], a[8:11], a[80:83], v[232:235]
ds_read_b64_tr_b16 a[110:111], v15 offset:6400
v_mfma_f32_16x16x32_bf16 v[232:235], a[24:27], a[84:87], v[232:235]
v_mfma_f32_16x16x32_bf16 v[240:243], a[28:31], a[84:87], v[240:243]
v_mfma_f32_16x16x32_bf16 v[240:243], a[12:15], a[80:83], v[240:243]
buffer_load_dwordx4 v16, s[48:51], s32 offen offset:2048 sc1 lds
v_mfma_f32_16x16x32_bf16 v[244:247], a[12:15], a[88:91], v[244:247]
ds_read_b64_tr_b16 a[80:81], v14 offset:8192
v_mfma_f32_16x16x32_bf16 v[244:247], a[28:31], a[92:95], v[244:247]
ds_read_b64_tr_b16 a[82:83], v14 offset:8448
v_mfma_f32_16x16x32_bf16 v[236:239], a[24:27], a[92:95], v[236:239]
ds_read_b64_tr_b16 a[84:85], v14 offset:10240
v_mfma_f32_16x16x32_bf16 v[236:239], a[8:11], a[88:91], v[236:239]
ds_read_b64_tr_b16 a[86:87], v14 offset:10496
v_mfma_f32_16x16x32_bf16 v[228:231], a[4:7], a[88:91], v[228:231]
buffer_load_dwordx4 v16, s[48:51], s32 offen offset:3072 sc1 lds
v_mfma_f32_16x16x32_bf16 v[228:231], a[20:23], a[92:95], v[228:231]
v_mfma_f32_16x16x32_bf16 v[220:223], a[16:19], a[92:95], v[220:223]
v_mfma_f32_16x16x32_bf16 v[220:223], a[0:3], a[88:91], v[220:223]
s_waitcnt lgkmcnt(4)
L_S23:
v_mfma_f32_16x16x32_bf16 v[184:187], a[96:99], a[32:35], v[184:187]
buffer_store_dwordx4 a[64:67], v16, s[88:91], s15 offen offset:1024 sc1
v_mov_b32 v8, v19
v_mfma_f32_16x16x32_bf16 v[184:187], a[100:103], a[48:51], v[184:187]
ds_read_b64_tr_b16 a[88:89], v15 offset:8192
v_mov_b32 v9, 0xf149f2ca
v_mfma_f32_16x16x32_bf16 v[192:195], a[100:103], a[52:55], v[192:195]
ds_read_b64_tr_b16 a[90:91], v15 offset:8448
v_mov_b32 v248, 0xffff
v_mfma_f32_16x16x32_bf16 v[192:195], a[96:99], a[36:39], v[192:195]
ds_read_b64_tr_b16 a[92:93], v15 offset:10240
v_mov_b32 v249, 0xffff0000
v_mfma_f32_16x16x32_bf16 v[200:203], a[96:99], a[40:43], v[200:203]
ds_read_b64_tr_b16 a[94:95], v15 offset:10496
s_add_u32 m0, s19, 0x9000
v_cndmask_b32 v252, 0, v248, s[56:57]
v_mfma_f32_16x16x32_bf16 v[200:203], a[100:103], a[56:59], v[200:203]
buffer_load_dwordx4 v16, s[48:51], s7 offen offset:0 sc1 lds
v_mfma_f32_16x16x32_bf16 v[208:211], a[100:103], a[60:63], v[208:211]
v_cndmask_b32 v252, v252, v249, s[58:59]
v_cndmask_b32 v253, 0, v248, s[60:61]
v_mfma_f32_16x16x32_bf16 v[208:211], a[96:99], a[44:47], v[208:211]
v_cndmask_b32 v253, v253, v249, s[62:63]
v_cndmask_b32 v254, 0, v248, s[68:69]
v_mfma_f32_16x16x32_bf16 v[212:215], a[104:107], a[44:47], v[212:215]
ds_read_b64_tr_b16 a[96:97], v14 offset:0
v_cndmask_b32 v254, v254, v249, s[70:71]
v_cndmask_b32 v255, 0, v248, s[76:77]
v_mfma_f32_16x16x32_bf16 v[212:215], a[108:111], a[60:63], v[212:215]
buffer_load_dwordx4 v16, s[48:51], s7 offen offset:1024 sc1 lds
v_mfma_f32_16x16x32_bf16 v[204:207], a[108:111], a[56:59], v[204:207]
ds_read_b64_tr_b16 a[98:99], v14 offset:256
v_cndmask_b32 v255, v255, v249, s[78:79]
v_mfma_f32_16x16x32_bf16 v[204:207], a[104:107], a[40:43], v[204:207]
ds_read_b64_tr_b16 a[100:101], v14 offset:2048
v_cndmask_b32 v248, v9, 0, s[68:69]
v_mfma_f32_16x16x32_bf16 v[196:199], a[104:107], a[36:39], v[196:199]
ds_read_b64_tr_b16 a[102:103], v14 offset:2304
v_cndmask_b32 v249, v9, 0, s[70:71]
v_cndmask_b32 v250, v9, 0, s[76:77]
v_mfma_f32_16x16x32_bf16 v[196:199], a[108:111], a[52:55], v[196:199]
v_cndmask_b32 v251, v9, 0, s[78:79]
v_mfma_f32_16x16x32_bf16 v[188:191], a[108:111], a[48:51], v[188:191]
buffer_store_dwordx4 a[64:67], v16, s[88:91], s15 offen offset:2048 sc1
v_mfma_f32_16x16x32_bf16 v[188:191], a[104:107], a[32:35], v[188:191]
s_waitcnt lgkmcnt(4)
v_mfma_f32_16x16x32_bf16 v[216:219], a[32:35], a[80:83], v[216:219]
ds_read_b64_tr_b16 a[104:105], v15 offset:0
v_mfma_f32_16x16x32_bf16 v[216:219], a[48:51], a[84:87], v[216:219]
ds_read_b64_tr_b16 a[106:107], v15 offset:256
v_mfma_f32_16x16x32_bf16 v[224:227], a[52:55], a[84:87], v[224:227]
buffer_load_dwordx4 v16, s[48:51], s7 offen offset:2048 sc1 lds
v_mfma_f32_16x16x32_bf16 v[224:227], a[36:39], a[80:83], v[224:227]
ds_read_b64_tr_b16 a[108:109], v15 offset:2048
v_cvt_pk_bf16_f32 v192, v192, v193
v_mfma_f32_16x16x32_bf16 v[232:235], a[40:43], a[80:83], v[232:235]
ds_read_b64_tr_b16 a[110:111], v15 offset:2304
v_cvt_pk_bf16_f32 v193, v194, v195
v_cvt_pk_bf16_f32 v194, v196, v197
v_mfma_f32_16x16x32_bf16 v[232:235], a[56:59], a[84:87], v[232:235]
v_cvt_pk_bf16_f32 v195, v198, v199
v_cvt_pk_bf16_f32 v208, v208, v209
v_mfma_f32_16x16x32_bf16 v[240:243], a[60:63], a[84:87], v[240:243]
v_cvt_pk_bf16_f32 v209, v210, v211
v_cvt_pk_bf16_f32 v210, v212, v213
v_mfma_f32_16x16x32_bf16 v[240:243], a[44:47], a[80:83], v[240:243]
buffer_load_dwordx4 v16, s[48:51], s7 offen offset:3072 sc1 lds
v_mfma_f32_16x16x32_bf16 v[244:247], a[44:47], a[88:91], v[244:247]
ds_read_b64_tr_b16 a[80:81], v12 offset:0
s_add_u32 s32, s32, 0x8000
v_cvt_pk_bf16_f32 v211, v214, v215
v_mfma_f32_16x16x32_bf16 v[244:247], a[60:63], a[92:95], v[244:247]
ds_read_b64_tr_b16 a[82:83], v12 offset:1024
s_add_u32 s7, s7, 0x8000
v_mfma_f32_16x16x32_bf16 v[236:239], a[56:59], a[92:95], v[236:239]
ds_read_b64_tr_b16 a[84:85], v12 offset:8192
v_mfma_f32_16x16x32_bf16 v[236:239], a[40:43], a[88:91], v[236:239]
buffer_store_dwordx4 a[64:67], v16, s[88:91], s15 offen offset:3072 sc1
v_mfma_f32_16x16x32_bf16 v[228:231], a[36:39], a[88:91], v[228:231]
ds_read_b64_tr_b16 a[86:87], v12 offset:9216
v_mfma_f32_16x16x32_bf16 v[228:231], a[52:55], a[92:95], v[228:231]
s_cmp_lg_u32 s4, 0
s_cbranch_scc1 L_hx0
buffer_store_dwordx4 v[192:195], v22, s[88:91], 0 offen offset:0 sc1
buffer_store_dwordx4 v[208:211], v7, s[88:91], 0 offen offset:0 sc1
L_hx0:
v_mfma_f32_16x16x32_bf16 v[220:223], a[48:51], a[92:95], v[220:223]
v_cvt_pk_bf16_f32 v184, v184, v185
v_cvt_pk_bf16_f32 v185, v186, v187
v_mfma_f32_16x16x32_bf16 v[220:223], a[32:35], a[88:91], v[220:223]
s_waitcnt lgkmcnt(4)
v_cvt_pk_bf16_f32 v186, v188, v189
v_cvt_pk_bf16_f32 v187, v190, v191
v_mfma_f32_16x16x32_bf16 v[152:155], a[96:99], a[32:35], v[152:155]
ds_read_b64_tr_b16 a[88:89], v13 offset:0
v_cvt_pk_bf16_f32 v200, v200, v201
v_cvt_pk_bf16_f32 v201, v202, v203
v_mfma_f32_16x16x32_bf16 v[152:155], a[100:103], a[48:51], v[152:155]
ds_read_b64_tr_b16 a[90:91], v13 offset:1024
v_cvt_pk_bf16_f32 v202, v204, v205
v_mfma_f32_16x16x32_bf16 v[160:163], a[100:103], a[52:55], v[160:163]
ds_read_b64_tr_b16 a[92:93], v13 offset:8192
v_cvt_pk_bf16_f32 v203, v206, v207
v_mfma_f32_16x16x32_bf16 v[160:163], a[96:99], a[36:39], v[160:163]
ds_read_b64_tr_b16 a[94:95], v13 offset:9216
v_mfma_f32_16x16x32_bf16 v[168:171], a[96:99], a[40:43], v[168:171]
ds_write_b128 v5, v[192:195] offset:2048
v_mfma_f32_16x16x32_bf16 v[168:171], a[100:103], a[56:59], v[168:171]
ds_write_b128 v5, v[208:211] offset:18432
v_mfma_f32_16x16x32_bf16 v[176:179], a[100:103], a[60:63], v[176:179]
ds_write_b128 v4, v[184:187] offset:2048
v_mfma_f32_16x16x32_bf16 v[176:179], a[96:99], a[44:47], v[176:179]
ds_write_b128 v4, v[200:203] offset:18432
v_mfma_f32_16x16x32_bf16 v[180:183], a[104:107], a[44:47], v[180:183]
ds_read_b64_tr_b16 a[96:97], v12 offset:256
v_cvt_pk_bf16_f32 v231, v230, v231
v_cvt_pk_bf16_f32 v230, v228, v229
v_mfma_f32_16x16x32_bf16 v[180:183], a[108:111], a[60:63], v[180:183]
ds_read_b64_tr_b16 a[98:99], v12 offset:1280
v_cvt_pk_bf16_f32 v228, v224, v225
v_mfma_f32_16x16x32_bf16 v[172:175], a[108:111], a[56:59], v[172:175]
ds_read_b64_tr_b16 a[100:101], v12 offset:8448
v_cvt_pk_bf16_f32 v229, v226, v227
v_mfma_f32_16x16x32_bf16 v[172:175], a[104:107], a[40:43], v[172:175]
ds_read_b64_tr_b16 a[102:103], v12 offset:9472
v_cvt_pk_bf16_f32 v227, v226, v227
v_mfma_f32_16x16x32_bf16 v[164:167], a[104:107], a[36:39], v[164:167]
v_cvt_pk_bf16_f32 v226, v224, v225
v_cvt_pk_bf16_f32 v247, v246, v247
v_cvt_pk_bf16_f32 v246, v244, v245
v_mfma_f32_16x16x32_bf16 v[164:167], a[108:111], a[52:55], v[164:167]
v_cvt_pk_bf16_f32 v244, v240, v241
v_cvt_pk_bf16_f32 v245, v242, v243
v_mfma_f32_16x16x32_bf16 v[156:159], a[108:111], a[48:51], v[156:159]
v_cvt_pk_bf16_f32 v243, v242, v243
v_cvt_pk_bf16_f32 v242, v240, v241
v_mfma_f32_16x16x32_bf16 v[156:159], a[104:107], a[32:35], v[156:159]
s_waitcnt lgkmcnt(4)
v_mfma_f32_16x16x32_bf16 v[24:27], a[80:83], a[32:35], v[24:27]
ds_read_b64_tr_b16 a[104:105], v13 offset:256
v_mfma_f32_16x16x32_bf16 v[24:27], a[84:87], a[48:51], v[24:27]
ds_read_b64_tr_b16 a[106:107], v13 offset:1280
v_mfma_f32_16x16x32_bf16 v[32:35], a[84:87], a[52:55], v[32:35]
ds_read_b64_tr_b16 a[108:109], v13 offset:8448
v_mfma_f32_16x16x32_bf16 v[32:35], a[80:83], a[36:39], v[32:35]
ds_read_b64_tr_b16 a[110:111], v13 offset:9472
v_mfma_f32_16x16x32_bf16 v[40:43], a[80:83], a[40:43], v[40:43]
s_cmp_lg_u32 s4, 0
s_cbranch_scc1 L_hx1
buffer_store_dwordx4 v[228:231], v22, s[88:91], 0 offen offset:1024 sc1
buffer_store_dwordx4 v[244:247], v7, s[88:91], 0 offen offset:1024 sc1
L_hx1:
v_mfma_f32_16x16x32_bf16 v[40:43], a[84:87], a[56:59], v[40:43]
v_cvt_pk_bf16_f32 v223, v222, v223
v_cvt_pk_bf16_f32 v222, v220, v221
v_mfma_f32_16x16x32_bf16 v[48:51], a[84:87], a[60:63], v[48:51]
v_cvt_pk_bf16_f32 v220, v216, v217
v_cvt_pk_bf16_f32 v221, v218, v219
v_mfma_f32_16x16x32_bf16 v[48:51], a[80:83], a[44:47], v[48:51]
v_cvt_pk_bf16_f32 v219, v218, v219
v_cvt_pk_bf16_f32 v218, v216, v217
v_mfma_f32_16x16x32_bf16 v[52:55], a[88:91], a[44:47], v[52:55]
ds_read_b64_tr_b16 a[80:81], v12 offset:512
v_cvt_pk_bf16_f32 v239, v238, v239
v_cvt_pk_bf16_f32 v238, v236, v237
v_mfma_f32_16x16x32_bf16 v[52:55], a[92:95], a[60:63], v[52:55]
ds_read_b64_tr_b16 a[82:83], v12 offset:1536
v_cvt_pk_bf16_f32 v236, v232, v233
v_mfma_f32_16x16x32_bf16 v[44:47], a[92:95], a[56:59], v[44:47]
ds_read_b64_tr_b16 a[84:85], v12 offset:8704
v_cvt_pk_bf16_f32 v237, v234, v235
v_mfma_f32_16x16x32_bf16 v[44:47], a[88:91], a[40:43], v[44:47]
ds_read_b64_tr_b16 a[86:87], v12 offset:9728
v_cvt_pk_bf16_f32 v235, v234, v235
v_mfma_f32_16x16x32_bf16 v[36:39], a[88:91], a[36:39], v[36:39]
v_cvt_pk_bf16_f32 v234, v232, v233
v_mfma_f32_16x16x32_bf16 v[36:39], a[92:95], a[52:55], v[36:39]
ds_write_b128 v5, v[228:231] offset:3072
v_mfma_f32_16x16x32_bf16 v[28:31], a[92:95], a[48:51], v[28:31]
ds_write_b128 v5, v[244:247] offset:19456
v_mfma_f32_16x16x32_bf16 v[28:31], a[88:91], a[32:35], v[28:31]
s_waitcnt lgkmcnt(4)
v_mfma_f32_16x16x32_bf16 v[56:59], a[96:99], a[32:35], v[56:59]
ds_read_b64_tr_b16 a[88:89], v13 offset:512
v_mfma_f32_16x16x32_bf16 v[56:59], a[100:103], a[48:51], v[56:59]
ds_read_b64_tr_b16 a[90:91], v13 offset:1536
v_mfma_f32_16x16x32_bf16 v[64:67], a[100:103], a[52:55], v[64:67]
ds_read_b64_tr_b16 a[92:93], v13 offset:8704
v_mfma_f32_16x16x32_bf16 v[64:67], a[96:99], a[36:39], v[64:67]
ds_read_b64_tr_b16 a[94:95], v13 offset:9728
v_mfma_f32_16x16x32_bf16 v[72:75], a[96:99], a[40:43], v[72:75]
ds_write_b128 v4, v[220:223] offset:3072
v_mfma_f32_16x16x32_bf16 v[72:75], a[100:103], a[56:59], v[72:75]
ds_write_b128 v4, v[236:239] offset:19456
v_mfma_f32_16x16x32_bf16 v[80:83], a[100:103], a[60:63], v[80:83]
v_cvt_pk_bf16_f32 v152, v152, v153
v_cvt_pk_bf16_f32 v153, v154, v155
v_mfma_f32_16x16x32_bf16 v[80:83], a[96:99], a[44:47], v[80:83]
v_cvt_pk_bf16_f32 v154, v156, v157
v_cvt_pk_bf16_f32 v155, v158, v159
v_mfma_f32_16x16x32_bf16 v[84:87], a[104:107], a[44:47], v[84:87]
ds_read_b64_tr_b16 a[96:97], v12 offset:768
v_cvt_pk_bf16_f32 v160, v160, v161
v_cvt_pk_bf16_f32 v161, v162, v163
v_mfma_f32_16x16x32_bf16 v[84:87], a[108:111], a[60:63], v[84:87]
ds_read_b64_tr_b16 a[98:99], v12 offset:1792
v_cvt_pk_bf16_f32 v162, v164, v165
v_mfma_f32_16x16x32_bf16 v[76:79], a[108:111], a[56:59], v[76:79]
ds_read_b64_tr_b16 a[100:101], v12 offset:8960
v_cvt_pk_bf16_f32 v163, v166, v167
v_mfma_f32_16x16x32_bf16 v[76:79], a[104:107], a[40:43], v[76:79]
ds_read_b64_tr_b16 a[102:103], v12 offset:9984
v_cvt_pk_bf16_f32 v168, v168, v169
v_mfma_f32_16x16x32_bf16 v[68:71], a[104:107], a[36:39], v[68:71]
v_cvt_pk_bf16_f32 v169, v170, v171
v_cvt_pk_bf16_f32 v170, v172, v173
v_cvt_pk_bf16_f32 v171, v174, v175
v_mfma_f32_16x16x32_bf16 v[68:71], a[108:111], a[52:55], v[68:71]
v_cvt_pk_bf16_f32 v176, v176, v177
v_cvt_pk_bf16_f32 v177, v178, v179
v_mfma_f32_16x16x32_bf16 v[60:63], a[108:111], a[48:51], v[60:63]
v_cvt_pk_bf16_f32 v178, v180, v181
v_cvt_pk_bf16_f32 v179, v182, v183
v_mfma_f32_16x16x32_bf16 v[60:63], a[104:107], a[32:35], v[60:63]
s_waitcnt lgkmcnt(4)
v_mfma_f32_16x16x32_bf16 v[88:91], a[80:83], a[32:35], v[88:91]
ds_read_b64_tr_b16 a[104:105], v13 offset:768
v_mfma_f32_16x16x32_bf16 v[88:91], a[84:87], a[48:51], v[88:91]
ds_read_b64_tr_b16 a[106:107], v13 offset:1792
v_mfma_f32_16x16x32_bf16 v[96:99], a[84:87], a[52:55], v[96:99]
ds_read_b64_tr_b16 a[108:109], v13 offset:8960
v_mfma_f32_16x16x32_bf16 v[96:99], a[80:83], a[36:39], v[96:99]
ds_read_b64_tr_b16 a[110:111], v13 offset:9984
v_mfma_f32_16x16x32_bf16 v[104:107], a[80:83], a[40:43], v[104:107]
v_mfma_f32_16x16x32_bf16 v[104:107], a[84:87], a[56:59], v[104:107]
v_mfma_f32_16x16x32_bf16 v[112:115], a[84:87], a[60:63], v[112:115]
v_mfma_f32_16x16x32_bf16 v[112:115], a[80:83], a[44:47], v[112:115]
v_mfma_f32_16x16x32_bf16 v[116:119], a[88:91], a[44:47], v[116:119]
v_mfma_f32_16x16x32_bf16 v[116:119], a[92:95], a[60:63], v[116:119]
v_mfma_f32_16x16x32_bf16 v[108:111], a[92:95], a[56:59], v[108:111]
v_mfma_f32_16x16x32_bf16 v[108:111], a[88:91], a[40:43], v[108:111]
v_mov_b32 v15, s6
v_xor_b32 v15, 0, v15
v_mfma_f32_16x16x32_bf16 v[100:103], a[88:91], a[36:39], v[100:103]
v_writelane_b32 v15, s18, 0
v_lshlrev_b32 v15, 2, v15
v_bfe_u32 v12, v0, 2, 2
v_mfma_f32_16x16x32_bf16 v[100:103], a[92:95], a[52:55], v[100:103]
L_padA12:
s_cmp_eq_u32 s95, 1
s_cbranch_scc1 L_hopA_ret
v_lshlrev_b32 v12, 11, v12
v_lshrrev_b32 v13, 4, v0
v_mfma_f32_16x16x32_bf16 v[92:95], a[92:95], a[48:51], v[92:95]
v_lshl_add_u32 v12, v13, 6, v12
v_and_b32 v13, 3, v0
v_mfma_f32_16x16x32_bf16 v[92:95], a[88:91], a[32:35], v[92:95]
s_waitcnt lgkmcnt(0)
v_lshl_add_u32 v12, v13, 4, v12
v_xor_b32 v12, s13, v12
v_mfma_f32_16x16x32_bf16 v[120:123], a[96:99], a[32:35], v[120:123]
v_xor_b32 v13, 32, v12
v_add_u32 v13, 7168, v13
v_mul_f32 v24, s52, v24
v_mfma_f32_16x16x32_bf16 v[120:123], a[100:103], a[48:51], v[120:123]
v_mul_f32 v25, s52, v25
v_mul_f32 v26, s52, v26
v_mfma_f32_16x16x32_bf16 v[128:131], a[100:103], a[52:55], v[128:131]
v_mul_f32 v27, s52, v27
v_mul_f32 v28, s52, v28
v_mfma_f32_16x16x32_bf16 v[128:131], a[96:99], a[36:39], v[128:131]
v_mul_f32 v29, s52, v29
v_mul_f32 v30, s52, v30
v_mfma_f32_16x16x32_bf16 v[136:139], a[96:99], a[40:43], v[136:139]
v_mul_f32 v31, s52, v31
v_cvt_pk_bf16_f32 v24, v24, v25
v_cvt_pk_bf16_f32 v25, v26, v27
v_mfma_f32_16x16x32_bf16 v[136:139], a[100:103], a[56:59], v[136:139]
v_cvt_pk_bf16_f32 v26, v28, v29
v_cvt_pk_bf16_f32 v27, v30, v31
v_mfma_f32_16x16x32_bf16 v[144:147], a[100:103], a[60:63], v[144:147]
v_accvgpr_write_b32 a160, v24
v_accvgpr_write_b32 a161, v25
v_mfma_f32_16x16x32_bf16 v[144:147], a[96:99], a[44:47], v[144:147]
v_accvgpr_write_b32 a162, v26
v_accvgpr_write_b32 a163, v27
v_mfma_f32_16x16x32_bf16 v[148:151], a[104:107], a[44:47], v[148:151]
v_mul_f32 v32, s52, v32
v_mul_f32 v33, s52, v33
v_mul_f32 v34, s52, v34
v_mfma_f32_16x16x32_bf16 v[148:151], a[108:111], a[60:63], v[148:151]
v_mul_f32 v35, s52, v35
v_mul_f32 v36, s52, v36
v_mfma_f32_16x16x32_bf16 v[140:143], a[108:111], a[56:59], v[140:143]
v_mul_f32 v37, s52, v37
v_mul_f32 v38, s52, v38
v_mfma_f32_16x16x32_bf16 v[140:143], a[104:107], a[40:43], v[140:143]
v_mul_f32 v39, s52, v39
v_cvt_pk_bf16_f32 v32, v32, v33
v_mfma_f32_16x16x32_bf16 v[132:135], a[104:107], a[36:39], v[132:135]
v_cvt_pk_bf16_f32 v33, v34, v35
v_cvt_pk_bf16_f32 v34, v36, v37
v_cvt_pk_bf16_f32 v35, v38, v39
v_mfma_f32_16x16x32_bf16 v[132:135], a[108:111], a[52:55], v[132:135]
v_accvgpr_write_b32 a176, v32
v_accvgpr_write_b32 a177, v33
v_mfma_f32_16x16x32_bf16 v[124:127], a[108:111], a[48:51], v[124:127]
v_accvgpr_write_b32 a178, v34
v_accvgpr_write_b32 a179, v35
v_mfma_f32_16x16x32_bf16 v[124:127], a[104:107], a[32:35], v[124:127]
L_trans:
s_waitcnt vmcnt(21) lgkmcnt(0)
s_barrier
s_cmp_eq_u32 s4, 0
s_cbranch_scc1 L_hx_ld
ds_read_b128 v[188:191], v4 offset:0
ds_read_b64 v[216:217], v4 offset:1024
ds_read_b64 v[220:221], v4 offset:1032
ds_read_b128 v[204:207], v4 offset:16384
ds_read_b64 v[232:233], v4 offset:17408
ds_read_b64 v[236:237], v4 offset:17416
s_branch L_hx_rd
L_hx_ld:
buffer_load_dwordx4 v[188:191], v10, s[88:91], 0 offen sc1
buffer_load_dwordx2 v[216:217], v10, s[88:91], 0 offen offset:1024 sc1
buffer_load_dwordx2 v[220:221], v10, s[88:91], 0 offen offset:1032 sc1
buffer_load_dwordx4 v[204:207], v11, s[88:91], 0 offen sc1
buffer_load_dwordx2 v[232:233], v11, s[88:91], 0 offen offset:1024 sc1
buffer_load_dwordx2 v[236:237], v11, s[88:91], 0 offen offset:1032 sc1
L_hx_rd:
ds_read_b128 v[196:199], v6 offset:0
ds_read_b64 v[224:225], v6 offset:1024
ds_read_b64 v[228:229], v6 offset:1032
ds_read_b128 v[212:215], v6 offset:16384
ds_read_b64 v[240:241], v6 offset:17408
ds_read_b64 v[244:245], v6 offset:17416
ds_read_b128 a[0:3], v1 offset:8192
ds_read_b128 a[4:7], v1 offset:9216
ds_read_b128 a[8:11], v1 offset:10240
ds_read_b128 a[12:15], v1 offset:11264
ds_read_b128 a[16:19], v1 offset:12288
ds_read_b128 a[20:23], v1 offset:13312
ds_read_b128 a[24:27], v1 offset:14336
ds_read_b128 a[28:31], v1 offset:15360
L_hopB:
s_mov_b32 s95, 0
v_pk_mul_f32 v[40:41], v[40:41], s[52:53]
v_pk_mul_f32 v[42:43], v[42:43], s[52:53]
v_pk_mul_f32 v[44:45], v[44:45], s[52:53]
v_pk_mul_f32 v[46:47], v[46:47], s[52:53]
v_cvt_pk_bf16_f32 v40, v40, v41
v_cvt_pk_bf16_f32 v41, v42, v43
v_cvt_pk_bf16_f32 v42, v44, v45
v_cvt_pk_bf16_f32 v43, v46, v47
v_accvgpr_write_b32 a192, v40
v_accvgpr_write_b32 a193, v41
v_accvgpr_write_b32 a194, v42
v_accvgpr_write_b32 a195, v43
v_pk_mul_f32 v[48:49], v[48:49], s[52:53]
v_pk_mul_f32 v[50:51], v[50:51], s[52:53]
v_pk_mul_f32 v[52:53], v[52:53], s[52:53]
v_pk_mul_f32 v[54:55], v[54:55], s[52:53]
v_cvt_pk_bf16_f32 v48, v48, v49
v_cvt_pk_bf16_f32 v49, v50, v51
v_cvt_pk_bf16_f32 v50, v52, v53
v_cvt_pk_bf16_f32 v51, v54, v55
v_accvgpr_write_b32 a208, v48
v_accvgpr_write_b32 a209, v49
v_accvgpr_write_b32 a210, v50
v_accvgpr_write_b32 a211, v51
v_mov_b32 v47, s55
v_cndmask_b32 v36, v9, 0, s[56:57]
v_min_f32 v32, s55, v36
v_cndmask_b32 v44, v47, 0, s[36:37]
v_cndmask_b32 v37, v9, 0, s[58:59]
v_min_f32 v33, s55, v37
v_cndmask_b32 v45, v47, 0, s[38:39]
v_cndmask_b32 v38, v9, 0, s[60:61]
v_min_f32 v34, s55, v38
v_cndmask_b32 v46, v47, 0, s[40:41]
v_cndmask_b32 v39, v9, 0, s[62:63]
v_min_f32 v35, s55, v39
v_cndmask_b32 v47, v47, 0, s[42:43]
v_pk_mul_f32 v[56:57], v[56:57], s[52:53]
v_pk_mul_f32 v[58:59], v[58:59], s[52:53]
v_pk_mul_f32 v[60:61], v[60:61], s[52:53]
v_pk_mul_f32 v[62:63], v[62:63], s[52:53]
v_cvt_pk_bf16_f32 v56, v56, v57
v_cvt_pk_bf16_f32 v57, v58, v59
v_cvt_pk_bf16_f32 v58, v60, v61
v_cvt_pk_bf16_f32 v59, v62, v63
v_accvgpr_write_b32 a164, v56
v_accvgpr_write_b32 a165, v57
v_accvgpr_write_b32 a166, v58
v_accvgpr_write_b32 a167, v59
v_pk_mul_f32 v[64:65], v[64:65], s[52:53]
v_pk_mul_f32 v[66:67], v[66:67], s[52:53]
v_pk_mul_f32 v[68:69], v[68:69], s[52:53]
v_pk_mul_f32 v[70:71], v[70:71], s[52:53]
v_cvt_pk_bf16_f32 v64, v64, v65
v_cvt_pk_bf16_f32 v65, v66, v67
v_cvt_pk_bf16_f32 v66, v68, v69
v_cvt_pk_bf16_f32 v67, v70, v71
v_accvgpr_write_b32 a180, v64
v_accvgpr_write_b32 a181, v65
v_accvgpr_write_b32 a182, v66
v_accvgpr_write_b32 a183, v67
v_pk_mul_f32 v[72:73], v[72:73], s[52:53]
v_pk_mul_f32 v[74:75], v[74:75], s[52:53]
v_pk_mul_f32 v[76:77], v[76:77], s[52:53]
v_pk_mul_f32 v[78:79], v[78:79], s[52:53]
v_cvt_pk_bf16_f32 v72, v72, v73
v_cvt_pk_bf16_f32 v73, v74, v75
v_cvt_pk_bf16_f32 v74, v76, v77
v_cvt_pk_bf16_f32 v75, v78, v79
v_accvgpr_write_b32 a196, v72
v_accvgpr_write_b32 a197, v73
v_accvgpr_write_b32 a198, v74
v_accvgpr_write_b32 a199, v75
v_pk_mul_f32 v[80:81], v[80:81], s[52:53]
v_pk_mul_f32 v[82:83], v[82:83], s[52:53]
v_pk_mul_f32 v[84:85], v[84:85], s[52:53]
v_pk_mul_f32 v[86:87], v[86:87], s[52:53]
v_cvt_pk_bf16_f32 v80, v80, v81
v_cvt_pk_bf16_f32 v81, v82, v83
v_cvt_pk_bf16_f32 v82, v84, v85
v_cvt_pk_bf16_f32 v83, v86, v87
v_accvgpr_write_b32 a212, v80
v_accvgpr_write_b32 a213, v81
v_accvgpr_write_b32 a214, v82
v_accvgpr_write_b32 a215, v83
v_pk_mul_f32 v[88:89], v[88:89], s[52:53]
v_pk_mul_f32 v[90:91], v[90:91], s[52:53]
v_pk_mul_f32 v[92:93], v[92:93], s[52:53]
v_pk_mul_f32 v[94:95], v[94:95], s[52:53]
v_cvt_pk_bf16_f32 v88, v88, v89
v_cvt_pk_bf16_f32 v89, v90, v91
v_cvt_pk_bf16_f32 v90, v92, v93
v_cvt_pk_bf16_f32 v91, v94, v95
v_accvgpr_write_b32 a168, v88
v_accvgpr_write_b32 a169, v89
v_accvgpr_write_b32 a170, v90
v_accvgpr_write_b32 a171, v91
v_pk_mul_f32 v[96:97], v[96:97], s[52:53]
v_pk_mul_f32 v[98:99], v[98:99], s[52:53]
v_pk_mul_f32 v[100:101], v[100:101], s[52:53]
v_pk_mul_f32 v[102:103], v[102:103], s[52:53]
v_cvt_pk_bf16_f32 v96, v96, v97
v_cvt_pk_bf16_f32 v97, v98, v99
v_cvt_pk_bf16_f32 v98, v100, v101
v_cvt_pk_bf16_f32 v99, v102, v103
v_accvgpr_write_b32 a184, v96
v_accvgpr_write_b32 a185, v97
v_accvgpr_write_b32 a186, v98
v_accvgpr_write_b32 a187, v99
v_pk_mul_f32 v[104:105], v[104:105], s[52:53]
v_pk_mul_f32 v[106:107], v[106:107], s[52:53]
v_pk_mul_f32 v[108:109], v[108:109], s[52:53]
v_pk_mul_f32 v[110:111], v[110:111], s[52:53]
v_cvt_pk_bf16_f32 v104, v104, v105
v_cvt_pk_bf16_f32 v105, v106, v107
v_cvt_pk_bf16_f32 v106, v108, v109
v_cvt_pk_bf16_f32 v107, v110, v111
v_accvgpr_write_b32 a200, v104
v_accvgpr_write_b32 a201, v105
v_accvgpr_write_b32 a202, v106
v_accvgpr_write_b32 a203, v107
v_pk_mul_f32 v[112:113], v[112:113], s[52:53]
v_pk_mul_f32 v[114:115], v[114:115], s[52:53]
v_pk_mul_f32 v[116:117], v[116:117], s[52:53]
v_pk_mul_f32 v[118:119], v[118:119], s[52:53]
v_cvt_pk_bf16_f32 v112, v112, v113
v_cvt_pk_bf16_f32 v113, v114, v115
v_cvt_pk_bf16_f32 v114, v116, v117
v_cvt_pk_bf16_f32 v115, v118, v119
v_accvgpr_write_b32 a216, v112
v_accvgpr_write_b32 a217, v113
v_accvgpr_write_b32 a218, v114
v_accvgpr_write_b32 a219, v115
v_pk_mul_f32 v[120:121], v[120:121], s[52:53]
v_pk_mul_f32 v[122:123], v[122:123], s[52:53]
v_pk_mul_f32 v[124:125], v[124:125], s[52:53]
v_pk_mul_f32 v[126:127], v[126:127], s[52:53]
v_cvt_pk_bf16_f32 v120, v120, v121
v_cvt_pk_bf16_f32 v121, v122, v123
v_cvt_pk_bf16_f32 v122, v124, v125
v_cvt_pk_bf16_f32 v123, v126, v127
v_accvgpr_write_b32 a172, v120
v_accvgpr_write_b32 a173, v121
v_accvgpr_write_b32 a174, v122
v_accvgpr_write_b32 a175, v123
v_pk_mul_f32 v[128:129], v[128:129], s[52:53]
v_pk_mul_f32 v[130:131], v[130:131], s[52:53]
v_pk_mul_f32 v[132:133], v[132:133], s[52:53]
v_pk_mul_f32 v[134:135], v[134:135], s[52:53]
v_cvt_pk_bf16_f32 v128, v128, v129
v_cvt_pk_bf16_f32 v129, v130, v131
v_cvt_pk_bf16_f32 v130, v132, v133
v_cvt_pk_bf16_f32 v131, v134, v135
v_accvgpr_write_b32 a188, v128
v_accvgpr_write_b32 a189, v129
v_accvgpr_write_b32 a190, v130
v_accvgpr_write_b32 a191, v131
v_pk_mul_f32 v[136:137], v[136:137], s[52:53]
v_pk_mul_f32 v[138:139], v[138:139], s[52:53]
v_pk_mul_f32 v[140:141], v[140:141], s[52:53]
v_pk_mul_f32 v[142:143], v[142:143], s[52:53]
v_cvt_pk_bf16_f32 v136, v136, v137
v_cvt_pk_bf16_f32 v137, v138, v139
v_cvt_pk_bf16_f32 v138, v140, v141
v_cvt_pk_bf16_f32 v139, v142, v143
v_accvgpr_write_b32 a204, v136
v_accvgpr_write_b32 a205, v137
v_accvgpr_write_b32 a206, v138
v_accvgpr_write_b32 a207, v139
v_pk_mul_f32 v[144:145], v[144:145], s[52:53]
v_pk_mul_f32 v[146:147], v[146:147], s[52:53]
v_pk_mul_f32 v[148:149], v[148:149], s[52:53]
v_pk_mul_f32 v[150:151], v[150:151], s[52:53]
v_cvt_pk_bf16_f32 v144, v144, v145
v_cvt_pk_bf16_f32 v145, v146, v147
v_cvt_pk_bf16_f32 v146, v148, v149
v_cvt_pk_bf16_f32 v147, v150, v151
v_accvgpr_write_b32 a220, v144
v_accvgpr_write_b32 a221, v145
v_accvgpr_write_b32 a222, v146
v_accvgpr_write_b32 a223, v147
s_cmp_lg_u32 s4, 0
s_cbranch_scc1 L_spun_hx
s_mov_b32 s92, 200000
L_spin_hx:
s_waitcnt vmcnt(0)
v_max3_u32 v128, v188, v189, 0
v_max3_u32 v128, v190, v191, v128
v_max3_u32 v128, v216, v217, v128
v_max3_u32 v128, v220, v221, v128
v_max3_u32 v128, v204, v205, v128
v_max3_u32 v128, v206, v207, v128
v_max3_u32 v128, v232, v233, v128
v_max3_u32 v128, v236, v237, v128
v_cmp_eq_u32 vcc, -1, v128
s_sub_u32 s92, s92, 1
s_cbranch_scc1 L_spun_hx
s_nop 3
s_cbranch_vccz L_spun_hx
s_sleep 2
buffer_load_dwordx4 v[188:191], v10, s[88:91], 0 offen sc1
buffer_load_dwordx2 v[216:217], v10, s[88:91], 0 offen offset:1024 sc1
buffer_load_dwordx2 v[220:221], v10, s[88:91], 0 offen offset:1032 sc1
buffer_load_dwordx4 v[204:207], v11, s[88:91], 0 offen sc1
buffer_load_dwordx2 v[232:233], v11, s[88:91], 0 offen offset:1024 sc1
buffer_load_dwordx2 v[236:237], v11, s[88:91], 0 offen offset:1032 sc1
s_branch L_spin_hx
L_spun_hx:
s_waitcnt lgkmcnt(0)
s_barrier
v_mfma_f32_16x16x32_bf16 v[52:55], v[184:187], v[152:155], v[248:251]
v_mov_b32 v140, 0
v_mov_b32 v141, 0
v_mfma_f32_16x16x32_bf16 v[48:51], v[188:191], v[152:155], v[32:35]
v_mov_b32 v142, 0
v_mov_b32 v143, 0
v_mfma_f32_16x16x32_bf16 v[60:63], v[192:195], v[160:163], v[248:251]
v_mov_b32 v144, 0
v_mov_b32 v145, 0
v_mfma_f32_16x16x32_bf16 v[56:59], v[196:199], v[160:163], v[36:39]
v_mov_b32 v146, 0
v_mov_b32 v147, 0
v_mfma_f32_16x16x32_bf16 v[68:71], v[200:203], v[168:171], v[248:251]
v_mov_b32 v148, 0
v_mov_b32 v149, 0
v_mfma_f32_16x16x32_bf16 v[64:67], v[204:207], v[168:171], v[36:39]
v_max3_f32 v52, v48, v49, v52
v_max3_f32 v54, v50, v51, v54
v_mfma_f32_16x16x32_bf16 v[76:79], v[208:211], v[176:179], v[248:251]
v_max_f32 v52, v52, v53
v_max_f32 v53, v54, v55
v_mfma_f32_16x16x32_bf16 v[72:75], v[212:215], v[176:179], v[36:39]
v_max_f32 v136, v52, v53
v_max3_f32 v60, v56, v57, v60
v_mfma_f32_16x16x32_bf16 v[16:19], a[0:3], a[160:163], v[44:47]
v_max3_f32 v62, v58, v59, v62
v_max_f32 v60, v60, v61
v_mfma_f32_16x16x32_bf16 v[16:19], a[4:7], a[164:167], v[16:19]
v_max_f32 v61, v62, v63
v_max_f32 v137, v60, v61
v_mfma_f32_16x16x32_bf16 v[16:19], a[8:11], a[168:171], v[16:19]
v_max3_f32 v68, v64, v65, v68
v_max3_f32 v70, v66, v67, v70
v_mfma_f32_16x16x32_bf16 v[16:19], a[12:15], a[172:175], v[16:19]
v_max_f32 v68, v68, v69
v_max_f32 v69, v70, v71
v_mfma_f32_16x16x32_bf16 v[20:23], a[0:3], a[176:179], 0
v_max_f32 v138, v68, v69
v_max3_f32 v76, v72, v73, v76
v_mfma_f32_16x16x32_bf16 v[20:23], a[4:7], a[180:183], v[20:23]
v_max3_f32 v78, v74, v75, v78
v_max_f32 v76, v76, v77
v_mfma_f32_16x16x32_bf16 v[20:23], a[8:11], a[184:187], v[20:23]
v_max_f32 v77, v78, v79
v_max_f32 v139, v76, v77
v_mfma_f32_16x16x32_bf16 v[20:23], a[12:15], a[188:191], v[20:23]
v_mov_b32 v150, 0
v_mov_b32 v151, 0
v_mfma_f32_16x16x32_bf16 v[24:27], a[0:3], a[192:195], 0
v_mov_b32 v248, 0
v_mov_b32 v249, 0
v_mfma_f32_16x16x32_bf16 v[24:27], a[4:7], a[196:199], v[24:27]
v_mov_b32 v250, 0
v_mov_b32 v251, 0
v_mfma_f32_16x16x32_bf16 v[24:27], a[8:11], a[200:203], v[24:27]
v_max3_f32 v80, v16, v17, v18
v_max_f32 v80, v80, v19
v_mfma_f32_16x16x32_bf16 v[24:27], a[12:15], a[204:207], v[24:27]
v_max3_f32 v84, v20, v21, v22
v_max_f32 v84, v84, v23
v_mfma_f32_16x16x32_bf16 v[28:31], a[0:3], a[208:211], 0
v_mov_b32 v128, v136
v_mov_b32 v129, v137
v_mfma_f32_16x16x32_bf16 v[28:31], a[4:7], a[212:215], v[28:31]
v_mov_b32 v130, v138
v_mov_b32 v131, v139
v_mfma_f32_16x16x32_bf16 v[28:31], a[8:11], a[216:219], v[28:31]
v_permlane16_swap_b32 v128, v136
v_permlane16_swap_b32 v129, v137
v_mfma_f32_16x16x32_bf16 v[28:31], a[12:15], a[220:223], v[28:31]
v_permlane16_swap_b32 v130, v138
v_permlane16_swap_b32 v131, v139
v_max_f32 v136, v136, v128
v_max_f32 v137, v137, v129
v_max_f32 v138, v138, v130
v_max_f32 v139, v139, v131
v_max3_f32 v88, v24, v25, v26
v_max_f32 v88, v88, v27
v_mov_b32 v128, v136
v_mov_b32 v129, v137
v_mov_b32 v130, v138
v_mov_b32 v131, v139
v_max3_f32 v92, v28, v29, v30
v_max_f32 v92, v92, v31
v_permlane32_swap_b32 v128, v136
v_permlane32_swap_b32 v129, v137
v_permlane32_swap_b32 v130, v138
v_permlane32_swap_b32 v131, v139
v_max_f32 v136, v136, v128
v_max_f32 v137, v137, v129
v_max_f32 v138, v138, v130
v_max_f32 v139, v139, v131
v_mul_f32 v136, s54, v136
v_mul_f32 v137, s54, v137
v_mul_f32 v138, s54, v138
v_mul_f32 v139, s54, v139
v_fma_f32 v52, v52, s54, -v136
v_fma_f32 v53, v53, s54, -v136
v_fma_f32 v60, v60, s54, -v137
v_fma_f32 v61, v61, s54, -v137
v_fma_f32 v68, v68, s54, -v138
v_fma_f32 v69, v69, s54, -v138
v_fma_f32 v76, v76, s54, -v139
v_fma_f32 v77, v77, s54, -v139
v_exp_f32 v52, v52
v_exp_f32 v53, v53
v_exp_f32 v60, v60
v_exp_f32 v61, v61
v_exp_f32 v68, v68
v_exp_f32 v69, v69
v_exp_f32 v76, v76
v_exp_f32 v77, v77
v_cvt_pk_bf16_f32 v52, v52, v52
v_cvt_pk_bf16_f32 v53, v53, v53
v_cvt_pk_bf16_f32 v60, v60, v60
v_cvt_pk_bf16_f32 v61, v61, v61
v_cvt_pk_bf16_f32 v68, v68, v68
v_cvt_pk_bf16_f32 v69, v69, v69
v_cvt_pk_bf16_f32 v76, v76, v76
v_cvt_pk_bf16_f32 v77, v77, v77
v_and_b32 v48, v252, v52
v_and_b32 v49, v253, v53
v_and_b32 v50, v254, v52
v_and_b32 v51, v255, v53
v_and_b32 v56, v252, v60
v_and_b32 v57, v253, v61
v_and_b32 v58, v254, v60
v_and_b32 v59, v255, v61
v_and_b32 v64, v252, v68
v_and_b32 v65, v253, v69
v_and_b32 v66, v254, v68
v_and_b32 v67, v255, v69
v_and_b32 v72, v252, v76
v_and_b32 v73, v253, v77
v_and_b32 v74, v254, v76
v_and_b32 v75, v255, v77
v_mfma_f32_16x16x32_bf16 v[156:159], a[240:243], v[48:51], 0
v_mov_b32 v128, v80
v_mov_b32 v129, v84
v_mfma_f32_16x16x32_bf16 v[164:167], a[240:243], v[56:59], 0
v_mov_b32 v130, v88
v_mov_b32 v131, v92
v_mfma_f32_16x16x32_bf16 v[172:175], a[240:243], v[64:67], 0
v_permlane16_swap_b32 v128, v80
v_permlane16_swap_b32 v129, v84
v_mfma_f32_16x16x32_bf16 v[180:183], a[240:243], v[72:75], 0
v_permlane16_swap_b32 v130, v88
v_permlane16_swap_b32 v131, v92
v_mfma_f32_16x16x32_bf16 v[184:187], v[216:219], v[48:51], 0
v_max_f32 v80, v80, v128
v_max_f32 v84, v84, v129
v_mfma_f32_16x16x32_bf16 v[188:191], v[220:223], v[48:51], 0
v_max_f32 v88, v88, v130
v_max_f32 v92, v92, v131
v_mfma_f32_16x16x32_bf16 v[192:195], v[224:227], v[56:59], 0
v_mov_b32 v128, v80
v_mov_b32 v129, v84
v_mfma_f32_16x16x32_bf16 v[196:199], v[228:231], v[56:59], 0
v_mov_b32 v130, v88
v_mov_b32 v131, v92
v_mfma_f32_16x16x32_bf16 v[200:203], v[232:235], v[64:67], 0
v_permlane32_swap_b32 v128, v80
v_permlane32_swap_b32 v129, v84
v_mfma_f32_16x16x32_bf16 v[204:207], v[236:239], v[64:67], 0
v_permlane32_swap_b32 v130, v88
v_permlane32_swap_b32 v131, v92
v_mfma_f32_16x16x32_bf16 v[208:211], v[240:243], v[72:75], 0
v_max_f32 v80, v80, v128
v_max_f32 v84, v84, v129
v_mfma_f32_16x16x32_bf16 v[212:215], v[244:247], v[72:75], 0
v_max_f32 v88, v88, v130
v_max_f32 v92, v92, v131
v_rcp_f32 v128, v156
v_rcp_f32 v130, v164
v_rcp_f32 v132, v172
v_rcp_f32 v134, v180
v_sub_f32 v83, 0, v80
v_sub_f32 v82, 0, v80
v_sub_f32 v81, 0, v80
v_sub_f32 v80, 0, v80
v_min_f32 v103, s8, v80
v_cndmask_b32 v96, v103, v80, s[36:37]
v_cndmask_b32 v97, v103, v80, s[38:39]
v_cndmask_b32 v98, v103, v80, s[40:41]
v_cndmask_b32 v99, v103, v80, s[42:43]
v_cndmask_b32 v100, v9, v103, s[36:37]
v_cndmask_b32 v101, v9, v103, s[38:39]
v_cndmask_b32 v102, v9, v103, s[40:41]
v_cndmask_b32 v103, v9, v103, s[42:43]
v_pk_mul_f32 v[184:185], v[184:185], v[128:129] op_sel_hi:[1,0]
v_pk_mul_f32 v[186:187], v[186:187], v[128:129] op_sel_hi:[1,0]
v_pk_mul_f32 v[188:189], v[188:189], v[128:129] op_sel_hi:[1,0]
v_pk_mul_f32 v[190:191], v[190:191], v[128:129] op_sel_hi:[1,0]
v_pk_mul_f32 v[192:193], v[192:193], v[130:131] op_sel_hi:[1,0]
v_pk_mul_f32 v[194:195], v[194:195], v[130:131] op_sel_hi:[1,0]
v_pk_mul_f32 v[196:197], v[196:197], v[130:131] op_sel_hi:[1,0]
v_pk_mul_f32 v[198:199], v[198:199], v[130:131] op_sel_hi:[1,0]
v_pk_mul_f32 v[200:201], v[200:201], v[132:133] op_sel_hi:[1,0]
v_pk_mul_f32 v[202:203], v[202:203], v[132:133] op_sel_hi:[1,0]
v_pk_mul_f32 v[204:205], v[204:205], v[132:133] op_sel_hi:[1,0]
v_pk_mul_f32 v[206:207], v[206:207], v[132:133] op_sel_hi:[1,0]
v_pk_mul_f32 v[208:209], v[208:209], v[134:135] op_sel_hi:[1,0]
v_pk_mul_f32 v[210:211], v[210:211], v[134:135] op_sel_hi:[1,0]
v_pk_mul_f32 v[212:213], v[212:213], v[134:135] op_sel_hi:[1,0]
v_pk_mul_f32 v[214:215], v[214:215], v[134:135] op_sel_hi:[1,0]
v_cvt_pk_bf16_f32 v32, v184, v185
v_cvt_pk_bf16_f32 v33, v186, v187
v_cvt_pk_bf16_f32 v34, v188, v189
v_cvt_pk_bf16_f32 v35, v190, v191
v_cvt_pk_bf16_f32 v36, v192, v193
v_cvt_pk_bf16_f32 v37, v194, v195
v_cvt_pk_bf16_f32 v38, v196, v197
v_cvt_pk_bf16_f32 v39, v198, v199
v_cvt_pk_bf16_f32 v40, v200, v201
v_cvt_pk_bf16_f32 v41, v202, v203
v_cvt_pk_bf16_f32 v42, v204, v205
v_cvt_pk_bf16_f32 v43, v206, v207
v_cvt_pk_bf16_f32 v44, v208, v209
v_cvt_pk_bf16_f32 v45, v210, v211
v_cvt_pk_bf16_f32 v46, v212, v213
v_cvt_pk_bf16_f32 v47, v214, v215
buffer_store_dwordx4 v[32:35], v3, s[88:91], s44 offen sc1
v_sub_f32 v87, 0, v84
v_sub_f32 v86, 0, v84
v_sub_f32 v85, 0, v84
v_sub_f32 v84, 0, v84
v_min_f32 v111, s9, v84
v_cndmask_b32 v104, v111, v84, s[36:37]
v_cndmask_b32 v105, v111, v84, s[38:39]
v_cndmask_b32 v106, v111, v84, s[40:41]
v_cndmask_b32 v107, v111, v84, s[42:43]
v_cndmask_b32 v108, v9, v111, s[36:37]
v_cndmask_b32 v109, v9, v111, s[38:39]
v_cndmask_b32 v110, v9, v111, s[40:41]
v_cndmask_b32 v111, v9, v111, s[42:43]
v_sub_f32 v91, 0, v88
v_sub_f32 v90, 0, v88
v_sub_f32 v89, 0, v88
v_sub_f32 v88, 0, v88
v_min_f32 v119, s8, v88
v_cndmask_b32 v112, v119, v88, s[36:37]
v_cndmask_b32 v113, v119, v88, s[38:39]
v_cndmask_b32 v114, v119, v88, s[40:41]
v_cndmask_b32 v115, v119, v88, s[42:43]
v_cndmask_b32 v116, v9, v119, s[36:37]
buffer_store_dwordx4 v[36:39], v3, s[88:91], s45 offen sc1
v_cndmask_b32 v117, v9, v119, s[38:39]
v_cndmask_b32 v118, v9, v119, s[40:41]
v_cndmask_b32 v119, v9, v119, s[42:43]
v_sub_f32 v95, 0, v92
v_sub_f32 v94, 0, v92
v_sub_f32 v93, 0, v92
v_sub_f32 v92, 0, v92
v_min_f32 v127, s9, v92
v_cndmask_b32 v120, v127, v92, s[36:37]
v_cndmask_b32 v121, v127, v92, s[38:39]
v_cndmask_b32 v122, v127, v92, s[40:41]
v_cndmask_b32 v123, v127, v92, s[42:43]
v_cndmask_b32 v124, v9, v127, s[36:37]
v_cndmask_b32 v125, v9, v127, s[38:39]
v_cndmask_b32 v126, v9, v127, s[40:41]
v_cndmask_b32 v127, v9, v127, s[42:43]
v_and_b32 v9, 1, v0
v_mul_u32_u24 v9, 0xaaaa, v9
v_add_u32 v9, 0x4444, v9
v_mov_b64 v[128:129], 0
v_mov_b64 v[130:131], 0
v_mov_b64 v[132:133], 0
v_mov_b64 v[134:135], 0
v_mov_b64 v[136:137], 0
buffer_store_dwordx4 v[40:43], v3, s[88:91], s46 offen sc1
v_mov_b64 v[138:139], 0
v_mov_b64 v[152:153], 0
v_mov_b64 v[154:155], 0
v_mov_b64 v[156:157], 0
v_mov_b64 v[158:159], 0
v_mov_b64 v[160:161], 0
v_mov_b64 v[162:163], 0
v_mov_b64 v[164:165], 0
v_mov_b64 v[166:167], 0
v_mov_b64 v[168:169], 0
v_mov_b64 v[170:171], 0
v_mov_b64 v[172:173], 0
v_mov_b64 v[174:175], 0
v_mov_b64 v[176:177], 0
v_mov_b64 v[178:179], 0
v_mov_b64 v[180:181], 0
v_mov_b64 v[182:183], 0
v_mov_b64 v[184:185], 0
v_mov_b64 v[186:187], 0
v_mov_b64 v[188:189], 0
v_mov_b64 v[190:191], 0
v_mov_b64 v[192:193], 0
v_mov_b64 v[194:195], 0
buffer_store_dwordx4 v[44:47], v3, s[88:91], s47 offen sc1
v_mov_b64 v[196:197], 0
v_mov_b64 v[198:199], 0
v_mov_b64 v[200:201], 0
v_mov_b64 v[202:203], 0
v_mov_b64 v[204:205], 0
v_mov_b64 v[206:207], 0
v_mov_b64 v[208:209], 0
v_mov_b64 v[210:211], 0
v_mov_b64 v[212:213], 0
v_mov_b64 v[214:215], 0
v_mov_b64 v[216:217], 0
v_mov_b64 v[218:219], 0
v_mov_b64 v[220:221], 0
v_mov_b64 v[222:223], 0
v_mov_b64 v[224:225], 0
v_mov_b64 v[226:227], 0
v_mov_b64 v[228:229], 0
v_mov_b64 v[230:231], 0
v_mov_b64 v[232:233], 0
v_mov_b64 v[234:235], 0
v_mov_b64 v[236:237], 0
v_mov_b64 v[238:239], 0
v_mov_b64 v[252:253], 0
v_mov_b64 v[254:255], 0
L_att_start:
s_mov_b32 s15, s6
s_cmp_eq_u32 s6, 0
s_cbranch_scc1 L_att_j0
v_mfma_f32_16x16x32_bf16 v[16:19], a[0:3], a[160:163], v[80:83]
ds_read_b128 a[128:131], v1 offset:24576
v_mov_b32 v240, 0
v_mfma_f32_16x16x32_bf16 v[16:19], a[4:7], a[164:167], v[16:19]
ds_read_b128 a[132:135], v1 offset:25600
v_mov_b32 v241, 0
v_mfma_f32_16x16x32_bf16 v[16:19], a[8:11], a[168:171], v[16:19]
ds_read_b128 a[136:139], v1 offset:26624
s_add_u32 m0, s27, 0x0
v_mfma_f32_16x16x32_bf16 v[16:19], a[12:15], a[172:175], v[16:19]
buffer_load_dwordx4 v3, s[48:51], s32 offen offset:0 sc1 lds
v_mfma_f32_16x16x32_bf16 v[20:23], a[0:3], a[176:179], v[84:87]
ds_read_b128 a[140:143], v1 offset:27648
v_mov_b32 v242, 0
v_mfma_f32_16x16x32_bf16 v[20:23], a[4:7], a[180:183], v[20:23]
ds_read_b128 a[144:147], v1 offset:28672
v_mov_b32 v243, 0
v_mfma_f32_16x16x32_bf16 v[20:23], a[8:11], a[184:187], v[20:23]
ds_read_b128 a[148:151], v1 offset:29696
v_mov_b32 v244, 0
v_mfma_f32_16x16x32_bf16 v[20:23], a[12:15], a[188:191], v[20:23]
ds_read_b128 a[152:155], v1 offset:30720
v_mov_b32 v245, 0
v_mfma_f32_16x16x32_bf16 v[24:27], a[0:3], a[192:195], v[88:91]
ds_read_b128 a[156:159], v1 offset:31744
v_exp_f32 v16, v16
v_mfma_f32_16x16x32_bf16 v[24:27], a[4:7], a[196:199], v[24:27]
v_exp_f32 v17, v17
v_mfma_f32_16x16x32_bf16 v[24:27], a[8:11], a[200:203], v[24:27]
buffer_load_dwordx4 v3, s[48:51], s32 offen offset:1024 sc1 lds
v_mfma_f32_16x16x32_bf16 v[24:27], a[12:15], a[204:207], v[24:27]
v_exp_f32 v18, v18
v_mfma_f32_16x16x32_bf16 v[28:31], a[0:3], a[208:211], v[92:95]
v_exp_f32 v19, v19
v_mfma_f32_16x16x32_bf16 v[28:31], a[4:7], a[212:215], v[28:31]
v_exp_f32 v20, v20
v_mfma_f32_16x16x32_bf16 v[28:31], a[8:11], a[216:219], v[28:31]
v_cvt_pk_bf16_f32 v48, v16, v17
v_cvt_pk_bf16_f32 v49, v18, v19
v_mfma_f32_16x16x32_bf16 v[28:31], a[12:15], a[220:223], v[28:31]
v_exp_f32 v21, v21
v_mfma_f32_16x16x32_bf16 v[32:35], a[16:19], a[160:163], v[80:83]
v_exp_f32 v22, v22
v_mfma_f32_16x16x32_bf16 v[32:35], a[20:23], a[164:167], v[32:35]
v_exp_f32 v23, v23
v_mfma_f32_16x16x32_bf16 v[32:35], a[24:27], a[168:171], v[32:35]
buffer_load_dwordx4 v3, s[48:51], s32 offen offset:2048 sc1 lds
v_mfma_f32_16x16x32_bf16 v[32:35], a[28:31], a[172:175], v[32:35]
v_exp_f32 v24, v24
v_mfma_f32_16x16x32_bf16 v[36:39], a[16:19], a[176:179], v[84:87]
v_exp_f32 v25, v25
v_mfma_f32_16x16x32_bf16 v[36:39], a[20:23], a[180:183], v[36:39]
v_cvt_pk_bf16_f32 v52, v20, v21
v_cvt_pk_bf16_f32 v53, v22, v23
v_mfma_f32_16x16x32_bf16 v[36:39], a[24:27], a[184:187], v[36:39]
v_exp_f32 v26, v26
v_mfma_f32_16x16x32_bf16 v[36:39], a[28:31], a[188:191], v[36:39]
v_exp_f32 v27, v27
v_mfma_f32_16x16x32_bf16 v[40:43], a[16:19], a[192:195], v[88:91]
v_exp_f32 v28, v28
v_mfma_f32_16x16x32_bf16 v[40:43], a[20:23], a[196:199], v[40:43]
buffer_load_dwordx4 v3, s[48:51], s32 offen offset:3072 sc1 lds
v_mfma_f32_16x16x32_bf16 v[40:43], a[24:27], a[200:203], v[40:43]
s_add_u32 s32, s32, 0x8000
v_exp_f32 v29, v29
v_mfma_f32_16x16x32_bf16 v[40:43], a[28:31], a[204:207], v[40:43]
v_exp_f32 v30, v30
v_mfma_f32_16x16x32_bf16 v[44:47], a[16:19], a[208:211], v[92:95]
v_exp_f32 v31, v31
v_mfma_f32_16x16x32_bf16 v[44:47], a[20:23], a[212:215], v[44:47]
v_exp_f32 v32, v32
v_mfma_f32_16x16x32_bf16 v[44:47], a[24:27], a[216:219], v[44:47]
v_exp_f32 v33, v33
v_mfma_f32_16x16x32_bf16 v[44:47], a[28:31], a[220:223], v[44:47]
s_waitcnt lgkmcnt(0)
v_cvt_pk_bf16_f32 v56, v24, v25
v_cvt_pk_bf16_f32 v57, v26, v27
v_mov_b32 v246, 0
v_mov_b32 v247, 0
v_mfma_f32_16x16x32_bf16 v[16:19], a[128:131], a[160:163], v[80:83]
ds_read_b128 a[32:35], v1 offset:16384
v_cvt_pk_bf16_f32 v60, v28, v29
v_mfma_f32_16x16x32_bf16 v[16:19], a[132:135], a[164:167], v[16:19]
v_exp_f32 v34, v34
v_mfma_f32_16x16x32_bf16 v[16:19], a[136:139], a[168:171], v[16:19]
s_add_u32 m0, s27, 0x1000
v_exp_f32 v35, v35
v_mfma_f32_16x16x32_bf16 v[16:19], a[140:143], a[172:175], v[16:19]
buffer_load_dwordx4 v3, s[48:51], s7 offen offset:0 sc1 lds
v_mfma_f32_16x16x32_bf16 v[20:23], a[128:131], a[176:179], v[84:87]
ds_read_b128 a[36:39], v1 offset:17408
v_cvt_pk_bf16_f32 v61, v30, v31
v_mfma_f32_16x16x32_bf16 v[20:23], a[132:135], a[180:183], v[20:23]
v_exp_f32 v36, v36
v_mfma_f32_16x16x32_bf16 v[20:23], a[136:139], a[184:187], v[20:23]
ds_read_b128 a[40:43], v1 offset:18432
v_cvt_pk_bf16_f32 v50, v32, v33
v_mfma_f32_16x16x32_bf16 v[20:23], a[140:143], a[188:191], v[20:23]
v_exp_f32 v37, v37
v_mfma_f32_16x16x32_bf16 v[24:27], a[128:131], a[192:195], v[88:91]
v_exp_f32 v38, v38
v_mfma_f32_16x16x32_bf16 v[24:27], a[132:135], a[196:199], v[24:27]
ds_read_b128 a[44:47], v1 offset:19456
v_cvt_pk_bf16_f32 v51, v34, v35
v_mfma_f32_16x16x32_bf16 v[24:27], a[136:139], a[200:203], v[24:27]
buffer_load_dwordx4 v3, s[48:51], s7 offen offset:1024 sc1 lds
v_mfma_f32_16x16x32_bf16 v[24:27], a[140:143], a[204:207], v[24:27]
v_exp_f32 v39, v39
v_mfma_f32_16x16x32_bf16 v[28:31], a[128:131], a[208:211], v[92:95]
v_exp_f32 v40, v40
v_mfma_f32_16x16x32_bf16 v[28:31], a[132:135], a[212:215], v[28:31]
ds_read_b128 a[48:51], v1 offset:20480
v_cvt_pk_bf16_f32 v54, v36, v37
v_mfma_f32_16x16x32_bf16 v[28:31], a[136:139], a[216:219], v[28:31]
v_exp_f32 v41, v41
v_mfma_f32_16x16x32_bf16 v[28:31], a[140:143], a[220:223], v[28:31]
v_exp_f32 v42, v42
v_mfma_f32_16x16x32_bf16 v[32:35], a[144:147], a[160:163], v[80:83]
buffer_load_dwordx4 v3, s[48:51], s7 offen offset:2048 sc1 lds
v_mfma_f32_16x16x32_bf16 v[32:35], a[148:151], a[164:167], v[32:35]
ds_read_b128 a[52:55], v1 offset:21504
v_cvt_pk_bf16_f32 v55, v38, v39
v_mfma_f32_16x16x32_bf16 v[32:35], a[152:155], a[168:171], v[32:35]
v_exp_f32 v43, v43
v_mfma_f32_16x16x32_bf16 v[32:35], a[156:159], a[172:175], v[32:35]
ds_read_b128 a[56:59], v1 offset:22528
v_cvt_pk_bf16_f32 v58, v40, v41
v_mfma_f32_16x16x32_bf16 v[36:39], a[144:147], a[176:179], v[84:87]
v_exp_f32 v44, v44
v_mfma_f32_16x16x32_bf16 v[36:39], a[148:151], a[180:183], v[36:39]
v_exp_f32 v45, v45
v_mfma_f32_16x16x32_bf16 v[36:39], a[152:155], a[184:187], v[36:39]
ds_read_b128 a[60:63], v1 offset:23552
v_xor_b32 v1, 0x8000, v1
v_mfma_f32_16x16x32_bf16 v[36:39], a[156:159], a[188:191], v[36:39]
buffer_load_dwordx4 v3, s[48:51], s7 offen offset:3072 sc1 lds
v_cvt_pk_bf16_f32 v59, v42, v43
v_mfma_f32_16x16x32_bf16 v[40:43], a[144:147], a[192:195], v[88:91]
s_add_u32 s7, s7, 0x8000
v_exp_f32 v46, v46
v_mfma_f32_16x16x32_bf16 v[40:43], a[148:151], a[196:199], v[40:43]
s_xor_b32 s27, s27, 0x38000
v_exp_f32 v47, v47
v_mfma_f32_16x16x32_bf16 v[40:43], a[152:155], a[200:203], v[40:43]
v_exp_f32 v16, v16
v_mfma_f32_16x16x32_bf16 v[40:43], a[156:159], a[204:207], v[40:43]
v_exp_f32 v17, v17
v_cvt_pk_bf16_f32 v62, v44, v45
v_cvt_pk_bf16_f32 v63, v46, v47
v_mfma_f32_16x16x32_bf16 v[44:47], a[144:147], a[208:211], v[92:95]
v_exp_f32 v18, v18
v_mfma_f32_16x16x32_bf16 v[44:47], a[148:151], a[212:215], v[44:47]
v_exp_f32 v19, v19
v_mfma_f32_16x16x32_bf16 v[44:47], a[152:155], a[216:219], v[44:47]
s_waitcnt vmcnt(8) lgkmcnt(0)
v_exp_f32 v20, v20
v_mfma_f32_16x16x32_bf16 v[44:47], a[156:159], a[220:223], v[44:47]
s_barrier
v_cvt_pk_bf16_f32 v64, v16, v17
v_exp_f32 v21, v21
v_exp_f32 v22, v22
v_exp_f32 v23, v23
v_exp_f32 v24, v24
v_exp_f32 v25, v25
v_exp_f32 v26, v26
v_exp_f32 v27, v27
v_cvt_pk_bf16_f32 v65, v18, v19
v_cvt_pk_bf16_f32 v68, v20, v21
v_cvt_pk_bf16_f32 v69, v22, v23
s_cmp_lg_u32 s33, 0
s_cbranch_scc1 L_sig_bd
s_lshl_b32 s8, s6, 2
s_add_u32 s8, s8, 192
s_cmp_lg_u32 s4, 0
s_cbranch_scc1 L_sig_bd
v_mov_b32 v4, 1
s_mov_b64 exec, 1
buffer_atomic_add v4, off, s[84:87], s8 sc1
s_mov_b64 exec, -1
L_sig_bd:
s_getreg_b32 s8, hwreg(HW_REG_HW_ID, 5, 1)
s_cmp_lg_u32 s8, 0
s_cbranch_scc1 L_att_dodd1
s_branch L_att_dodd0
L_att_deven0:
v_mfma_f32_16x16x32_bf16 v[128:131], a[32:35], v[48:51], v[128:131]
ds_read_b128 a[0:3], v1 offset:8192
v_cvt_pk_bf16_f32 v72, v24, v25
v_mfma_f32_16x16x32_bf16 v[160:163], a[32:35], v[52:55], v[160:163]
v_exp_f32 v28, v28
v_mfma_f32_16x16x32_bf16 v[192:195], a[32:35], v[56:59], v[192:195]
v_cvt_pk_bf16_f32 v73, v26, v27
v_mfma_f32_16x16x32_bf16 v[224:227], a[32:35], v[60:63], v[224:227]
ds_read_b128 a[4:7], v1 offset:9216
v_mfma_f32_16x16x32_bf16 v[228:231], a[36:39], v[60:63], v[228:231]
v_exp_f32 v29, v29
v_mfma_f32_16x16x32_bf16 v[196:199], a[36:39], v[56:59], v[196:199]
v_exp_f32 v30, v30
v_mfma_f32_16x16x32_bf16 v[164:167], a[36:39], v[52:55], v[164:167]
s_add_u32 m0, s27, 0x0
v_cvt_pk_bf16_f32 v76, v28, v29
v_mfma_f32_16x16x32_bf16 v[132:135], a[36:39], v[48:51], v[132:135]
buffer_load_dwordx4 v3, s[48:51], s32 offen offset:0 sc1 lds
v_mfma_f32_16x16x32_bf16 v[136:139], a[40:43], v[48:51], v[136:139]
ds_read_b128 a[8:11], v1 offset:10240
v_mfma_f32_16x16x32_bf16 v[168:171], a[40:43], v[52:55], v[168:171]
v_exp_f32 v31, v31
v_mfma_f32_16x16x32_bf16 v[200:203], a[40:43], v[56:59], v[200:203]
v_exp_f32 v32, v32
v_mfma_f32_16x16x32_bf16 v[232:235], a[40:43], v[60:63], v[232:235]
ds_read_b128 a[12:15], v1 offset:11264
v_cvt_pk_bf16_f32 v77, v30, v31
v_mfma_f32_16x16x32_bf16 v[236:239], a[44:47], v[60:63], v[236:239]
v_mfma_f32_16x16x32_bf16 v[204:207], a[44:47], v[56:59], v[204:207]
v_exp_f32 v33, v33
v_mfma_f32_16x16x32_bf16 v[172:175], a[44:47], v[52:55], v[172:175]
v_exp_f32 v34, v34
v_mfma_f32_16x16x32_bf16 v[140:143], a[44:47], v[48:51], v[140:143]
ds_read_b128 a[16:19], v1 offset:12288
v_cvt_pk_bf16_f32 v66, v32, v33
v_mfma_f32_16x16x32_bf16 v[144:147], a[48:51], v[48:51], v[144:147]
v_mfma_f32_16x16x32_bf16 v[176:179], a[48:51], v[52:55], v[176:179]
v_exp_f32 v35, v35
v_mfma_f32_16x16x32_bf16 v[208:211], a[48:51], v[56:59], v[208:211]
v_exp_f32 v36, v36
v_mfma_f32_16x16x32_bf16 v[240:243], a[48:51], v[60:63], v[240:243]
ds_read_b128 a[20:23], v1 offset:13312
v_cvt_pk_bf16_f32 v67, v34, v35
v_mfma_f32_16x16x32_bf16 v[244:247], a[52:55], v[60:63], v[244:247]
v_exp_f32 v37, v37
v_mfma_f32_16x16x32_bf16 v[212:215], a[52:55], v[56:59], v[212:215]
v_cvt_pk_bf16_f32 v70, v36, v37
v_mfma_f32_16x16x32_bf16 v[180:183], a[52:55], v[52:55], v[180:183]
ds_read_b128 a[24:27], v1 offset:14336
v_mfma_f32_16x16x32_bf16 v[148:151], a[52:55], v[48:51], v[148:151]
buffer_load_dwordx4 v3, s[48:51], s32 offen offset:1024 sc1 lds
v_mfma_f32_16x16x32_bf16 v[152:155], a[56:59], v[48:51], v[152:155]
v_exp_f32 v38, v38
v_mfma_f32_16x16x32_bf16 v[184:187], a[56:59], v[52:55], v[184:187]
v_exp_f32 v39, v39
v_mfma_f32_16x16x32_bf16 v[216:219], a[56:59], v[56:59], v[216:219]
ds_read_b128 a[28:31], v1 offset:15360
v_cvt_pk_bf16_f32 v71, v38, v39
v_mfma_f32_16x16x32_bf16 v[248:251], a[56:59], v[60:63], v[248:251]
v_mfma_f32_16x16x32_bf16 v[252:255], a[60:63], v[60:63], v[252:255]
v_exp_f32 v40, v40
v_mfma_f32_16x16x32_bf16 v[220:223], a[60:63], v[56:59], v[220:223]
v_exp_f32 v41, v41
v_mfma_f32_16x16x32_bf16 v[188:191], a[60:63], v[52:55], v[188:191]
ds_read_b128 a[32:35], v1 offset:0
v_cvt_pk_bf16_f32 v74, v40, v41
v_mfma_f32_16x16x32_bf16 v[156:159], a[60:63], v[48:51], v[156:159]
v_smfmac_f32_16x16x64_bf16 a[224:227], a[232:235], v[48:55], v9
v_exp_f32 v42, v42
v_smfmac_f32_16x16x64_bf16 a[228:231], a[232:235], v[56:63], v9
s_waitcnt lgkmcnt(5)
v_exp_f32 v43, v43
v_mfma_f32_16x16x32_bf16 v[16:19], a[0:3], a[160:163], v[80:83]
ds_read_b128 a[36:39], v1 offset:1024
v_cvt_pk_bf16_f32 v75, v42, v43
v_mfma_f32_16x16x32_bf16 v[16:19], a[4:7], a[164:167], v[16:19]
v_exp_f32 v44, v44
v_mfma_f32_16x16x32_bf16 v[16:19], a[8:11], a[168:171], v[16:19]
v_mfma_f32_16x16x32_bf16 v[16:19], a[12:15], a[172:175], v[16:19]
v_exp_f32 v45, v45
v_mfma_f32_16x16x32_bf16 v[20:23], a[0:3], a[176:179], v[84:87]
ds_read_b128 a[40:43], v1 offset:2048
v_cvt_pk_bf16_f32 v78, v44, v45
v_mfma_f32_16x16x32_bf16 v[20:23], a[4:7], a[180:183], v[20:23]
buffer_load_dwordx4 v3, s[48:51], s32 offen offset:2048 sc1 lds
v_mfma_f32_16x16x32_bf16 v[20:23], a[8:11], a[184:187], v[20:23]
v_exp_f32 v46, v46
v_mfma_f32_16x16x32_bf16 v[20:23], a[12:15], a[188:191], v[20:23]
ds_read_b128 a[44:47], v1 offset:3072
v_mfma_f32_16x16x32_bf16 v[24:27], a[0:3], a[192:195], v[88:91]
v_mfma_f32_16x16x32_bf16 v[24:27], a[4:7], a[196:199], v[24:27]
v_exp_f32 v47, v47
v_mfma_f32_16x16x32_bf16 v[24:27], a[8:11], a[200:203], v[24:27]
v_exp_f32 v16, v16
v_mfma_f32_16x16x32_bf16 v[24:27], a[12:15], a[204:207], v[24:27]
ds_read_b128 a[48:51], v1 offset:4096
v_cvt_pk_bf16_f32 v79, v46, v47
v_mfma_f32_16x16x32_bf16 v[28:31], a[0:3], a[208:211], v[92:95]
v_mfma_f32_16x16x32_bf16 v[28:31], a[4:7], a[212:215], v[28:31]
v_exp_f32 v17, v17
v_mfma_f32_16x16x32_bf16 v[28:31], a[8:11], a[216:219], v[28:31]
s_waitcnt lgkmcnt(5)
v_exp_f32 v18, v18
v_mfma_f32_16x16x32_bf16 v[28:31], a[12:15], a[220:223], v[28:31]
ds_read_b128 a[52:55], v1 offset:5120
v_cvt_pk_bf16_f32 v48, v16, v17
v_mfma_f32_16x16x32_bf16 v[32:35], a[16:19], a[160:163], v[80:83]
v_mfma_f32_16x16x32_bf16 v[32:35], a[20:23], a[164:167], v[32:35]
v_exp_f32 v19, v19
v_mfma_f32_16x16x32_bf16 v[32:35], a[24:27], a[168:171], v[32:35]
v_exp_f32 v20, v20
v_mfma_f32_16x16x32_bf16 v[32:35], a[28:31], a[172:175], v[32:35]
ds_read_b128 a[56:59], v1 offset:6144
v_cvt_pk_bf16_f32 v49, v18, v19
v_mfma_f32_16x16x32_bf16 v[36:39], a[16:19], a[176:179], v[84:87]
v_exp_f32 v21, v21
v_mfma_f32_16x16x32_bf16 v[36:39], a[20:23], a[180:183], v[36:39]
buffer_load_dwordx4 v3, s[48:51], s32 offen offset:3072 sc1 lds
v_mfma_f32_16x16x32_bf16 v[36:39], a[24:27], a[184:187], v[36:39]
s_add_u32 s32, s32, 0x8000
v_cvt_pk_bf16_f32 v52, v20, v21
v_mfma_f32_16x16x32_bf16 v[36:39], a[28:31], a[188:191], v[36:39]
ds_read_b128 a[60:63], v1 offset:7168
v_mfma_f32_16x16x32_bf16 v[40:43], a[16:19], a[192:195], v[88:91]
v_exp_f32 v22, v22
v_mfma_f32_16x16x32_bf16 v[40:43], a[20:23], a[196:199], v[40:43]
v_exp_f32 v23, v23
v_mfma_f32_16x16x32_bf16 v[40:43], a[24:27], a[200:203], v[40:43]
v_cvt_pk_bf16_f32 v53, v22, v23
v_mfma_f32_16x16x32_bf16 v[40:43], a[28:31], a[204:207], v[40:43]
v_exp_f32 v24, v24
v_mfma_f32_16x16x32_bf16 v[44:47], a[16:19], a[208:211], v[92:95]
v_exp_f32 v25, v25
v_mfma_f32_16x16x32_bf16 v[44:47], a[20:23], a[212:215], v[44:47]
v_exp_f32 v26, v26
v_mfma_f32_16x16x32_bf16 v[44:47], a[24:27], a[216:219], v[44:47]
v_exp_f32 v27, v27
v_mfma_f32_16x16x32_bf16 v[44:47], a[28:31], a[220:223], v[44:47]
s_waitcnt lgkmcnt(0)
v_mfma_f32_16x16x32_bf16 v[128:131], a[32:35], v[64:67], v[128:131]
ds_read_b128 a[0:3], v1 offset:24576
v_cvt_pk_bf16_f32 v56, v24, v25
v_mfma_f32_16x16x32_bf16 v[160:163], a[32:35], v[68:71], v[160:163]
v_exp_f32 v28, v28
v_mfma_f32_16x16x32_bf16 v[192:195], a[32:35], v[72:75], v[192:195]
v_cvt_pk_bf16_f32 v57, v26, v27
v_mfma_f32_16x16x32_bf16 v[224:227], a[32:35], v[76:79], v[224:227]
ds_read_b128 a[4:7], v1 offset:25600
v_mfma_f32_16x16x32_bf16 v[228:231], a[36:39], v[76:79], v[228:231]
v_exp_f32 v29, v29
v_mfma_f32_16x16x32_bf16 v[196:199], a[36:39], v[72:75], v[196:199]
v_exp_f32 v30, v30
v_mfma_f32_16x16x32_bf16 v[164:167], a[36:39], v[68:71], v[164:167]
s_add_u32 m0, s27, 0x1000
v_cvt_pk_bf16_f32 v60, v28, v29
v_mfma_f32_16x16x32_bf16 v[132:135], a[36:39], v[64:67], v[132:135]
buffer_load_dwordx4 v3, s[48:51], s7 offen offset:0 sc1 lds
v_mfma_f32_16x16x32_bf16 v[136:139], a[40:43], v[64:67], v[136:139]
ds_read_b128 a[8:11], v1 offset:26624
v_mfma_f32_16x16x32_bf16 v[168:171], a[40:43], v[68:71], v[168:171]
v_exp_f32 v31, v31
v_mfma_f32_16x16x32_bf16 v[200:203], a[40:43], v[72:75], v[200:203]
v_exp_f32 v32, v32
v_mfma_f32_16x16x32_bf16 v[232:235], a[40:43], v[76:79], v[232:235]
ds_read_b128 a[12:15], v1 offset:27648
v_cvt_pk_bf16_f32 v61, v30, v31
v_mfma_f32_16x16x32_bf16 v[236:239], a[44:47], v[76:79], v[236:239]
v_mfma_f32_16x16x32_bf16 v[204:207], a[44:47], v[72:75], v[204:207]
v_exp_f32 v33, v33
v_mfma_f32_16x16x32_bf16 v[172:175], a[44:47], v[68:71], v[172:175]
v_exp_f32 v34, v34
v_mfma_f32_16x16x32_bf16 v[140:143], a[44:47], v[64:67], v[140:143]
ds_read_b128 a[16:19], v1 offset:28672
v_cvt_pk_bf16_f32 v50, v32, v33
v_mfma_f32_16x16x32_bf16 v[144:147], a[48:51], v[64:67], v[144:147]
v_mfma_f32_16x16x32_bf16 v[176:179], a[48:51], v[68:71], v[176:179]
v_exp_f32 v35, v35
v_mfma_f32_16x16x32_bf16 v[208:211], a[48:51], v[72:75], v[208:211]
ds_read_b128 a[20:23], v1 offset:29696
v_cvt_pk_bf16_f32 v51, v34, v35
v_mfma_f32_16x16x32_bf16 v[240:243], a[48:51], v[76:79], v[240:243]
v_exp_f32 v36, v36
v_mfma_f32_16x16x32_bf16 v[244:247], a[52:55], v[76:79], v[244:247]
v_exp_f32 v37, v37
v_mfma_f32_16x16x32_bf16 v[212:215], a[52:55], v[72:75], v[212:215]
v_cvt_pk_bf16_f32 v54, v36, v37
v_mfma_f32_16x16x32_bf16 v[180:183], a[52:55], v[68:71], v[180:183]
buffer_load_dwordx4 v3, s[48:51], s7 offen offset:1024 sc1 lds
v_mfma_f32_16x16x32_bf16 v[148:151], a[52:55], v[64:67], v[148:151]
ds_read_b128 a[24:27], v1 offset:30720
v_mfma_f32_16x16x32_bf16 v[152:155], a[56:59], v[64:67], v[152:155]
v_exp_f32 v38, v38
v_mfma_f32_16x16x32_bf16 v[184:187], a[56:59], v[68:71], v[184:187]
v_exp_f32 v39, v39
v_mfma_f32_16x16x32_bf16 v[216:219], a[56:59], v[72:75], v[216:219]
ds_read_b128 a[28:31], v1 offset:31744
v_cvt_pk_bf16_f32 v55, v38, v39
v_mfma_f32_16x16x32_bf16 v[248:251], a[56:59], v[76:79], v[248:251]
v_mfma_f32_16x16x32_bf16 v[252:255], a[60:63], v[76:79], v[252:255]
v_exp_f32 v40, v40
v_mfma_f32_16x16x32_bf16 v[220:223], a[60:63], v[72:75], v[220:223]
v_exp_f32 v41, v41
v_mfma_f32_16x16x32_bf16 v[188:191], a[60:63], v[68:71], v[188:191]
ds_read_b128 a[32:35], v1 offset:16384
v_cvt_pk_bf16_f32 v58, v40, v41
v_mfma_f32_16x16x32_bf16 v[156:159], a[60:63], v[64:67], v[156:159]
v_smfmac_f32_16x16x64_bf16 a[224:227], a[232:235], v[64:71], v9
s_waitcnt lgkmcnt(5)
v_exp_f32 v42, v42
v_smfmac_f32_16x16x64_bf16 a[228:231], a[232:235], v[72:79], v9
ds_read_b128 a[36:39], v1 offset:17408
v_mfma_f32_16x16x32_bf16 v[16:19], a[0:3], a[160:163], v[80:83]
v_exp_f32 v43, v43
v_mfma_f32_16x16x32_bf16 v[16:19], a[4:7], a[164:167], v[16:19]
v_exp_f32 v44, v44
v_mfma_f32_16x16x32_bf16 v[16:19], a[8:11], a[168:171], v[16:19]
v_cvt_pk_bf16_f32 v59, v42, v43
v_mfma_f32_16x16x32_bf16 v[16:19], a[12:15], a[172:175], v[16:19]
ds_read_b128 a[40:43], v1 offset:18432
v_mfma_f32_16x16x32_bf16 v[20:23], a[0:3], a[176:179], v[84:87]
buffer_load_dwordx4 v3, s[48:51], s7 offen offset:2048 sc1 lds
v_mfma_f32_16x16x32_bf16 v[20:23], a[4:7], a[180:183], v[20:23]
v_exp_f32 v45, v45
v_mfma_f32_16x16x32_bf16 v[20:23], a[8:11], a[184:187], v[20:23]
v_exp_f32 v46, v46
v_mfma_f32_16x16x32_bf16 v[20:23], a[12:15], a[188:191], v[20:23]
ds_read_b128 a[44:47], v1 offset:19456
v_cvt_pk_bf16_f32 v62, v44, v45
v_mfma_f32_16x16x32_bf16 v[24:27], a[0:3], a[192:195], v[88:91]
v_mfma_f32_16x16x32_bf16 v[24:27], a[4:7], a[196:199], v[24:27]
v_exp_f32 v47, v47
v_mfma_f32_16x16x32_bf16 v[24:27], a[8:11], a[200:203], v[24:27]
v_exp_f32 v16, v16
v_mfma_f32_16x16x32_bf16 v[24:27], a[12:15], a[204:207], v[24:27]
ds_read_b128 a[48:51], v1 offset:20480
v_cvt_pk_bf16_f32 v63, v46, v47
v_mfma_f32_16x16x32_bf16 v[28:31], a[0:3], a[208:211], v[92:95]
v_mfma_f32_16x16x32_bf16 v[28:31], a[4:7], a[212:215], v[28:31]
v_exp_f32 v17, v17
v_mfma_f32_16x16x32_bf16 v[28:31], a[8:11], a[216:219], v[28:31]
ds_read_b128 a[52:55], v1 offset:21504
v_cvt_pk_bf16_f32 v64, v16, v17
v_mfma_f32_16x16x32_bf16 v[28:31], a[12:15], a[220:223], v[28:31]
s_waitcnt lgkmcnt(6)
v_exp_f32 v18, v18
v_mfma_f32_16x16x32_bf16 v[32:35], a[16:19], a[160:163], v[80:83]
v_mfma_f32_16x16x32_bf16 v[32:35], a[20:23], a[164:167], v[32:35]
v_exp_f32 v19, v19
v_mfma_f32_16x16x32_bf16 v[32:35], a[24:27], a[168:171], v[32:35]
ds_read_b128 a[56:59], v1 offset:22528
v_cvt_pk_bf16_f32 v65, v18, v19
v_mfma_f32_16x16x32_bf16 v[32:35], a[28:31], a[172:175], v[32:35]
buffer_load_dwordx4 v3, s[48:51], s7 offen offset:3072 sc1 lds
v_mfma_f32_16x16x32_bf16 v[36:39], a[16:19], a[176:179], v[84:87]
s_add_u32 s7, s7, 0x8000
v_exp_f32 v20, v20
v_mfma_f32_16x16x32_bf16 v[36:39], a[20:23], a[180:183], v[36:39]
s_xor_b32 s27, s27, 0x38000
v_exp_f32 v21, v21
v_mfma_f32_16x16x32_bf16 v[36:39], a[24:27], a[184:187], v[36:39]
ds_read_b128 a[60:63], v1 offset:23552
v_xor_b32 v1, 0x8000, v1
v_mfma_f32_16x16x32_bf16 v[36:39], a[28:31], a[188:191], v[36:39]
v_cvt_pk_bf16_f32 v68, v20, v21
v_mfma_f32_16x16x32_bf16 v[40:43], a[16:19], a[192:195], v[88:91]
v_exp_f32 v22, v22
v_mfma_f32_16x16x32_bf16 v[40:43], a[20:23], a[196:199], v[40:43]
v_exp_f32 v23, v23
v_mfma_f32_16x16x32_bf16 v[40:43], a[24:27], a[200:203], v[40:43]
v_cvt_pk_bf16_f32 v69, v22, v23
v_mfma_f32_16x16x32_bf16 v[40:43], a[28:31], a[204:207], v[40:43]
v_exp_f32 v24, v24
v_mfma_f32_16x16x32_bf16 v[44:47], a[16:19], a[208:211], v[92:95]
v_exp_f32 v25, v25
v_mfma_f32_16x16x32_bf16 v[44:47], a[20:23], a[212:215], v[44:47]
v_exp_f32 v26, v26
v_mfma_f32_16x16x32_bf16 v[44:47], a[24:27], a[216:219], v[44:47]
s_waitcnt vmcnt(16) lgkmcnt(0)
v_exp_f32 v27, v27
v_mfma_f32_16x16x32_bf16 v[44:47], a[28:31], a[220:223], v[44:47]
s_barrier
L_att_dodd0:
v_mfma_f32_16x16x32_bf16 v[128:131], a[32:35], v[48:51], v[128:131]
ds_read_b128 a[0:3], v2 offset:8192
v_cvt_pk_bf16_f32 v72, v24, v25
v_mfma_f32_16x16x32_bf16 v[160:163], a[32:35], v[52:55], v[160:163]
v_exp_f32 v28, v28
v_mfma_f32_16x16x32_bf16 v[192:195], a[32:35], v[56:59], v[192:195]
v_cvt_pk_bf16_f32 v73, v26, v27
v_mfma_f32_16x16x32_bf16 v[224:227], a[32:35], v[60:63], v[224:227]
ds_read_b128 a[4:7], v2 offset:9216
v_mfma_f32_16x16x32_bf16 v[228:231], a[36:39], v[60:63], v[228:231]
v_exp_f32 v29, v29
v_mfma_f32_16x16x32_bf16 v[196:199], a[36:39], v[56:59], v[196:199]
v_exp_f32 v30, v30
v_mfma_f32_16x16x32_bf16 v[164:167], a[36:39], v[52:55], v[164:167]
s_add_u32 m0, s19, 0x0
v_cvt_pk_bf16_f32 v76, v28, v29
v_mfma_f32_16x16x32_bf16 v[132:135], a[36:39], v[48:51], v[132:135]
buffer_load_dwordx4 v3, s[48:51], s32 offen offset:0 sc1 lds
v_mfma_f32_16x16x32_bf16 v[136:139], a[40:43], v[48:51], v[136:139]
ds_read_b128 a[8:11], v2 offset:10240
v_mfma_f32_16x16x32_bf16 v[168:171], a[40:43], v[52:55], v[168:171]
v_exp_f32 v31, v31
v_mfma_f32_16x16x32_bf16 v[200:203], a[40:43], v[56:59], v[200:203]
v_exp_f32 v32, v32
v_mfma_f32_16x16x32_bf16 v[232:235], a[40:43], v[60:63], v[232:235]
ds_read_b128 a[12:15], v2 offset:11264
v_cvt_pk_bf16_f32 v77, v30, v31
v_mfma_f32_16x16x32_bf16 v[236:239], a[44:47], v[60:63], v[236:239]
v_mfma_f32_16x16x32_bf16 v[204:207], a[44:47], v[56:59], v[204:207]
v_exp_f32 v33, v33
v_mfma_f32_16x16x32_bf16 v[172:175], a[44:47], v[52:55], v[172:175]
v_exp_f32 v34, v34
v_mfma_f32_16x16x32_bf16 v[140:143], a[44:47], v[48:51], v[140:143]
ds_read_b128 a[16:19], v2 offset:12288
v_cvt_pk_bf16_f32 v66, v32, v33
v_mfma_f32_16x16x32_bf16 v[144:147], a[48:51], v[48:51], v[144:147]
v_mfma_f32_16x16x32_bf16 v[176:179], a[48:51], v[52:55], v[176:179]
v_exp_f32 v35, v35
v_mfma_f32_16x16x32_bf16 v[208:211], a[48:51], v[56:59], v[208:211]
v_exp_f32 v36, v36
v_mfma_f32_16x16x32_bf16 v[240:243], a[48:51], v[60:63], v[240:243]
ds_read_b128 a[20:23], v2 offset:13312
v_cvt_pk_bf16_f32 v67, v34, v35
v_mfma_f32_16x16x32_bf16 v[244:247], a[52:55], v[60:63], v[244:247]
v_exp_f32 v37, v37
v_mfma_f32_16x16x32_bf16 v[212:215], a[52:55], v[56:59], v[212:215]
v_cvt_pk_bf16_f32 v70, v36, v37
v_mfma_f32_16x16x32_bf16 v[180:183], a[52:55], v[52:55], v[180:183]
ds_read_b128 a[24:27], v2 offset:14336
v_mfma_f32_16x16x32_bf16 v[148:151], a[52:55], v[48:51], v[148:151]
buffer_load_dwordx4 v3, s[48:51], s32 offen offset:1024 sc1 lds
v_mfma_f32_16x16x32_bf16 v[152:155], a[56:59], v[48:51], v[152:155]
v_exp_f32 v38, v38
v_mfma_f32_16x16x32_bf16 v[184:187], a[56:59], v[52:55], v[184:187]
v_exp_f32 v39, v39
v_mfma_f32_16x16x32_bf16 v[216:219], a[56:59], v[56:59], v[216:219]
ds_read_b128 a[28:31], v2 offset:15360
v_cvt_pk_bf16_f32 v71, v38, v39
v_mfma_f32_16x16x32_bf16 v[248:251], a[56:59], v[60:63], v[248:251]
v_mfma_f32_16x16x32_bf16 v[252:255], a[60:63], v[60:63], v[252:255]
v_exp_f32 v40, v40
v_mfma_f32_16x16x32_bf16 v[220:223], a[60:63], v[56:59], v[220:223]
v_exp_f32 v41, v41
v_mfma_f32_16x16x32_bf16 v[188:191], a[60:63], v[52:55], v[188:191]
ds_read_b128 a[32:35], v2 offset:0
v_cvt_pk_bf16_f32 v74, v40, v41
v_mfma_f32_16x16x32_bf16 v[156:159], a[60:63], v[48:51], v[156:159]
v_smfmac_f32_16x16x64_bf16 a[224:227], a[232:235], v[48:55], v9
v_exp_f32 v42, v42
v_smfmac_f32_16x16x64_bf16 a[228:231], a[232:235], v[56:63], v9
s_waitcnt lgkmcnt(5)
v_exp_f32 v43, v43
v_mfma_f32_16x16x32_bf16 v[16:19], a[0:3], a[160:163], v[80:83]
ds_read_b128 a[36:39], v2 offset:1024
v_cvt_pk_bf16_f32 v75, v42, v43
v_mfma_f32_16x16x32_bf16 v[16:19], a[4:7], a[164:167], v[16:19]
v_exp_f32 v44, v44
v_mfma_f32_16x16x32_bf16 v[16:19], a[8:11], a[168:171], v[16:19]
v_mfma_f32_16x16x32_bf16 v[16:19], a[12:15], a[172:175], v[16:19]
v_exp_f32 v45, v45
v_mfma_f32_16x16x32_bf16 v[20:23], a[0:3], a[176:179], v[84:87]
ds_read_b128 a[40:43], v2 offset:2048
v_cvt_pk_bf16_f32 v78, v44, v45
v_mfma_f32_16x16x32_bf16 v[20:23], a[4:7], a[180:183], v[20:23]
buffer_load_dwordx4 v3, s[48:51], s32 offen offset:2048 sc1 lds
v_mfma_f32_16x16x32_bf16 v[20:23], a[8:11], a[184:187], v[20:23]
v_exp_f32 v46, v46
v_mfma_f32_16x16x32_bf16 v[20:23], a[12:15], a[188:191], v[20:23]
ds_read_b128 a[44:47], v2 offset:3072
v_mfma_f32_16x16x32_bf16 v[24:27], a[0:3], a[192:195], v[88:91]
v_mfma_f32_16x16x32_bf16 v[24:27], a[4:7], a[196:199], v[24:27]
v_exp_f32 v47, v47
v_mfma_f32_16x16x32_bf16 v[24:27], a[8:11], a[200:203], v[24:27]
v_exp_f32 v16, v16
v_mfma_f32_16x16x32_bf16 v[24:27], a[12:15], a[204:207], v[24:27]
ds_read_b128 a[48:51], v2 offset:4096
v_cvt_pk_bf16_f32 v79, v46, v47
v_mfma_f32_16x16x32_bf16 v[28:31], a[0:3], a[208:211], v[92:95]
v_mfma_f32_16x16x32_bf16 v[28:31], a[4:7], a[212:215], v[28:31]
v_exp_f32 v17, v17
v_mfma_f32_16x16x32_bf16 v[28:31], a[8:11], a[216:219], v[28:31]
s_waitcnt lgkmcnt(5)
v_exp_f32 v18, v18
v_mfma_f32_16x16x32_bf16 v[28:31], a[12:15], a[220:223], v[28:31]
ds_read_b128 a[52:55], v2 offset:5120
v_cvt_pk_bf16_f32 v48, v16, v17
v_mfma_f32_16x16x32_bf16 v[32:35], a[16:19], a[160:163], v[80:83]
v_mfma_f32_16x16x32_bf16 v[32:35], a[20:23], a[164:167], v[32:35]
v_exp_f32 v19, v19
v_mfma_f32_16x16x32_bf16 v[32:35], a[24:27], a[168:171], v[32:35]
v_exp_f32 v20, v20
v_mfma_f32_16x16x32_bf16 v[32:35], a[28:31], a[172:175], v[32:35]
ds_read_b128 a[56:59], v2 offset:6144
v_cvt_pk_bf16_f32 v49, v18, v19
v_mfma_f32_16x16x32_bf16 v[36:39], a[16:19], a[176:179], v[84:87]
v_exp_f32 v21, v21
v_mfma_f32_16x16x32_bf16 v[36:39], a[20:23], a[180:183], v[36:39]
buffer_load_dwordx4 v3, s[48:51], s32 offen offset:3072 sc1 lds
v_mfma_f32_16x16x32_bf16 v[36:39], a[24:27], a[184:187], v[36:39]
s_add_u32 s32, s32, 0x8000
v_cvt_pk_bf16_f32 v52, v20, v21
v_mfma_f32_16x16x32_bf16 v[36:39], a[28:31], a[188:191], v[36:39]
ds_read_b128 a[60:63], v2 offset:7168
v_mfma_f32_16x16x32_bf16 v[40:43], a[16:19], a[192:195], v[88:91]
v_exp_f32 v22, v22
v_mfma_f32_16x16x32_bf16 v[40:43], a[20:23], a[196:199], v[40:43]
v_exp_f32 v23, v23
v_mfma_f32_16x16x32_bf16 v[40:43], a[24:27], a[200:203], v[40:43]
v_cvt_pk_bf16_f32 v53, v22, v23
v_mfma_f32_16x16x32_bf16 v[40:43], a[28:31], a[204:207], v[40:43]
v_exp_f32 v24, v24
v_mfma_f32_16x16x32_bf16 v[44:47], a[16:19], a[208:211], v[92:95]
v_exp_f32 v25, v25
v_mfma_f32_16x16x32_bf16 v[44:47], a[20:23], a[212:215], v[44:47]
v_exp_f32 v26, v26
v_mfma_f32_16x16x32_bf16 v[44:47], a[24:27], a[216:219], v[44:47]
v_exp_f32 v27, v27
v_mfma_f32_16x16x32_bf16 v[44:47], a[28:31], a[220:223], v[44:47]
s_waitcnt lgkmcnt(0)
v_mfma_f32_16x16x32_bf16 v[128:131], a[32:35], v[64:67], v[128:131]
ds_read_b128 a[0:3], v2 offset:24576
v_cvt_pk_bf16_f32 v56, v24, v25
v_mfma_f32_16x16x32_bf16 v[160:163], a[32:35], v[68:71], v[160:163]
v_exp_f32 v28, v28
v_mfma_f32_16x16x32_bf16 v[192:195], a[32:35], v[72:75], v[192:195]
v_cvt_pk_bf16_f32 v57, v26, v27
v_mfma_f32_16x16x32_bf16 v[224:227], a[32:35], v[76:79], v[224:227]
ds_read_b128 a[4:7], v2 offset:25600
v_mfma_f32_16x16x32_bf16 v[228:231], a[36:39], v[76:79], v[228:231]
v_exp_f32 v29, v29
v_mfma_f32_16x16x32_bf16 v[196:199], a[36:39], v[72:75], v[196:199]
v_exp_f32 v30, v30
v_mfma_f32_16x16x32_bf16 v[164:167], a[36:39], v[68:71], v[164:167]
s_add_u32 m0, s19, 0x1000
v_cvt_pk_bf16_f32 v60, v28, v29
v_mfma_f32_16x16x32_bf16 v[132:135], a[36:39], v[64:67], v[132:135]
buffer_load_dwordx4 v3, s[48:51], s7 offen offset:0 sc1 lds
v_mfma_f32_16x16x32_bf16 v[136:139], a[40:43], v[64:67], v[136:139]
ds_read_b128 a[8:11], v2 offset:26624
v_mfma_f32_16x16x32_bf16 v[168:171], a[40:43], v[68:71], v[168:171]
v_exp_f32 v31, v31
v_mfma_f32_16x16x32_bf16 v[200:203], a[40:43], v[72:75], v[200:203]
v_exp_f32 v32, v32
v_mfma_f32_16x16x32_bf16 v[232:235], a[40:43], v[76:79], v[232:235]
ds_read_b128 a[12:15], v2 offset:27648
v_cvt_pk_bf16_f32 v61, v30, v31
v_mfma_f32_16x16x32_bf16 v[236:239], a[44:47], v[76:79], v[236:239]
v_mfma_f32_16x16x32_bf16 v[204:207], a[44:47], v[72:75], v[204:207]
v_exp_f32 v33, v33
v_mfma_f32_16x16x32_bf16 v[172:175], a[44:47], v[68:71], v[172:175]
v_exp_f32 v34, v34
v_mfma_f32_16x16x32_bf16 v[140:143], a[44:47], v[64:67], v[140:143]
ds_read_b128 a[16:19], v2 offset:28672
v_cvt_pk_bf16_f32 v50, v32, v33
v_mfma_f32_16x16x32_bf16 v[144:147], a[48:51], v[64:67], v[144:147]
v_exp_f32 v35, v35
v_mfma_f32_16x16x32_bf16 v[176:179], a[48:51], v[68:71], v[176:179]
v_cvt_pk_bf16_f32 v51, v34, v35
v_mfma_f32_16x16x32_bf16 v[208:211], a[48:51], v[72:75], v[208:211]
ds_read_b128 a[20:23], v2 offset:29696
v_mfma_f32_16x16x32_bf16 v[240:243], a[48:51], v[76:79], v[240:243]
v_exp_f32 v36, v36
v_mfma_f32_16x16x32_bf16 v[244:247], a[52:55], v[76:79], v[244:247]
v_exp_f32 v37, v37
v_mfma_f32_16x16x32_bf16 v[212:215], a[52:55], v[72:75], v[212:215]
v_cvt_pk_bf16_f32 v54, v36, v37
v_mfma_f32_16x16x32_bf16 v[180:183], a[52:55], v[68:71], v[180:183]
buffer_load_dwordx4 v3, s[48:51], s7 offen offset:1024 sc1 lds
v_mfma_f32_16x16x32_bf16 v[148:151], a[52:55], v[64:67], v[148:151]
ds_read_b128 a[24:27], v2 offset:30720
v_mfma_f32_16x16x32_bf16 v[152:155], a[56:59], v[64:67], v[152:155]
v_exp_f32 v38, v38
v_mfma_f32_16x16x32_bf16 v[184:187], a[56:59], v[68:71], v[184:187]
v_exp_f32 v39, v39
v_mfma_f32_16x16x32_bf16 v[216:219], a[56:59], v[72:75], v[216:219]
ds_read_b128 a[28:31], v2 offset:31744
v_cvt_pk_bf16_f32 v55, v38, v39
v_mfma_f32_16x16x32_bf16 v[248:251], a[56:59], v[76:79], v[248:251]
v_exp_f32 v40, v40
v_mfma_f32_16x16x32_bf16 v[252:255], a[60:63], v[76:79], v[252:255]
v_mfma_f32_16x16x32_bf16 v[220:223], a[60:63], v[72:75], v[220:223]
v_exp_f32 v41, v41
v_mfma_f32_16x16x32_bf16 v[188:191], a[60:63], v[68:71], v[188:191]
ds_read_b128 a[32:35], v2 offset:16384
v_cvt_pk_bf16_f32 v58, v40, v41
v_mfma_f32_16x16x32_bf16 v[156:159], a[60:63], v[64:67], v[156:159]
v_exp_f32 v42, v42
v_smfmac_f32_16x16x64_bf16 a[224:227], a[232:235], v[64:71], v9
s_waitcnt lgkmcnt(5)
v_smfmac_f32_16x16x64_bf16 a[228:231], a[232:235], v[72:79], v9
ds_read_b128 a[36:39], v2 offset:17408
v_mfma_f32_16x16x32_bf16 v[16:19], a[0:3], a[160:163], v[80:83]
v_exp_f32 v43, v43
v_mfma_f32_16x16x32_bf16 v[16:19], a[4:7], a[164:167], v[16:19]
v_exp_f32 v44, v44
v_mfma_f32_16x16x32_bf16 v[16:19], a[8:11], a[168:171], v[16:19]
buffer_load_dwordx4 v3, s[48:51], s7 offen offset:2048 sc1 lds
v_mfma_f32_16x16x32_bf16 v[16:19], a[12:15], a[172:175], v[16:19]
ds_read_b128 a[40:43], v2 offset:18432
v_cvt_pk_bf16_f32 v59, v42, v43
v_mfma_f32_16x16x32_bf16 v[20:23], a[0:3], a[176:179], v[84:87]
v_exp_f32 v45, v45
v_mfma_f32_16x16x32_bf16 v[20:23], a[4:7], a[180:183], v[20:23]
v_cvt_pk_bf16_f32 v62, v44, v45
v_mfma_f32_16x16x32_bf16 v[20:23], a[8:11], a[184:187], v[20:23]
v_exp_f32 v46, v46
v_mfma_f32_16x16x32_bf16 v[20:23], a[12:15], a[188:191], v[20:23]
ds_read_b128 a[44:47], v2 offset:19456
v_mfma_f32_16x16x32_bf16 v[24:27], a[0:3], a[192:195], v[88:91]
v_exp_f32 v47, v47
v_mfma_f32_16x16x32_bf16 v[24:27], a[4:7], a[196:199], v[24:27]
v_cvt_pk_bf16_f32 v63, v46, v47
v_mfma_f32_16x16x32_bf16 v[24:27], a[8:11], a[200:203], v[24:27]
v_exp_f32 v16, v16
v_mfma_f32_16x16x32_bf16 v[24:27], a[12:15], a[204:207], v[24:27]
ds_read_b128 a[48:51], v2 offset:20480
v_mfma_f32_16x16x32_bf16 v[28:31], a[0:3], a[208:211], v[92:95]
v_exp_f32 v17, v17
v_mfma_f32_16x16x32_bf16 v[28:31], a[4:7], a[212:215], v[28:31]
v_exp_f32 v18, v18
v_mfma_f32_16x16x32_bf16 v[28:31], a[8:11], a[216:219], v[28:31]
ds_read_b128 a[52:55], v2 offset:21504
v_cvt_pk_bf16_f32 v64, v16, v17
v_mfma_f32_16x16x32_bf16 v[28:31], a[12:15], a[220:223], v[28:31]
s_waitcnt lgkmcnt(6)
v_mfma_f32_16x16x32_bf16 v[32:35], a[16:19], a[160:163], v[80:83]
v_exp_f32 v19, v19
v_mfma_f32_16x16x32_bf16 v[32:35], a[20:23], a[164:167], v[32:35]
buffer_load_dwordx4 v3, s[48:51], s7 offen offset:3072 sc1 lds
v_mfma_f32_16x16x32_bf16 v[32:35], a[24:27], a[168:171], v[32:35]
ds_read_b128 a[56:59], v2 offset:22528
v_cvt_pk_bf16_f32 v65, v18, v19
v_mfma_f32_16x16x32_bf16 v[32:35], a[28:31], a[172:175], v[32:35]
s_add_u32 s7, s7, 0x8000
v_exp_f32 v20, v20
v_mfma_f32_16x16x32_bf16 v[36:39], a[16:19], a[176:179], v[84:87]
s_xor_b32 s19, s19, 0x8000
v_mfma_f32_16x16x32_bf16 v[36:39], a[20:23], a[180:183], v[36:39]
s_sub_u32 s15, s15, 1
v_exp_f32 v21, v21
v_mfma_f32_16x16x32_bf16 v[36:39], a[24:27], a[184:187], v[36:39]
ds_read_b128 a[60:63], v2 offset:23552
v_xor_b32 v2, 0x38000, v2
v_mfma_f32_16x16x32_bf16 v[36:39], a[28:31], a[188:191], v[36:39]
s_cmp_lg_u32 s15, 0
v_exp_f32 v22, v22
v_mfma_f32_16x16x32_bf16 v[40:43], a[16:19], a[192:195], v[88:91]
v_exp_f32 v23, v23
v_mfma_f32_16x16x32_bf16 v[40:43], a[20:23], a[196:199], v[40:43]
v_cvt_pk_bf16_f32 v68, v20, v21
v_cvt_pk_bf16_f32 v69, v22, v23
v_mfma_f32_16x16x32_bf16 v[40:43], a[24:27], a[200:203], v[40:43]
v_exp_f32 v24, v24
v_mfma_f32_16x16x32_bf16 v[40:43], a[28:31], a[204:207], v[40:43]
v_exp_f32 v25, v25
v_mfma_f32_16x16x32_bf16 v[44:47], a[16:19], a[208:211], v[92:95]
v_exp_f32 v26, v26
v_mfma_f32_16x16x32_bf16 v[44:47], a[20:23], a[212:215], v[44:47]
v_exp_f32 v27, v27
v_mfma_f32_16x16x32_bf16 v[44:47], a[24:27], a[216:219], v[44:47]
s_waitcnt vmcnt(16) lgkmcnt(0)
v_mfma_f32_16x16x32_bf16 v[44:47], a[28:31], a[220:223], v[44:47]
s_barrier
s_cbranch_scc1 L_att_deven0
s_branch L_att_ddone
L_att_deven1:
v_mfma_f32_16x16x32_bf16 v[128:131], a[32:35], v[48:51], v[128:131]
ds_read_b128 a[0:3], v1 offset:8192
v_cvt_pk_bf16_f32 v72, v24, v25
v_mfma_f32_16x16x32_bf16 v[160:163], a[32:35], v[52:55], v[160:163]
v_exp_f32 v28, v28
v_mfma_f32_16x16x32_bf16 v[192:195], a[32:35], v[56:59], v[192:195]
v_cvt_pk_bf16_f32 v73, v26, v27
v_mfma_f32_16x16x32_bf16 v[224:227], a[32:35], v[60:63], v[224:227]
ds_read_b128 a[4:7], v1 offset:9216
v_mfma_f32_16x16x32_bf16 v[228:231], a[36:39], v[60:63], v[228:231]
v_exp_f32 v29, v29
v_mfma_f32_16x16x32_bf16 v[196:199], a[36:39], v[56:59], v[196:199]
v_exp_f32 v30, v30
v_mfma_f32_16x16x32_bf16 v[164:167], a[36:39], v[52:55], v[164:167]
s_add_u32 m0, s27, 0x0
v_cvt_pk_bf16_f32 v76, v28, v29
v_mfma_f32_16x16x32_bf16 v[132:135], a[36:39], v[48:51], v[132:135]
buffer_load_dwordx4 v3, s[48:51], s32 offen offset:0 sc1 lds
v_mfma_f32_16x16x32_bf16 v[136:139], a[40:43], v[48:51], v[136:139]
ds_read_b128 a[8:11], v1 offset:10240
v_mfma_f32_16x16x32_bf16 v[168:171], a[40:43], v[52:55], v[168:171]
v_exp_f32 v31, v31
v_mfma_f32_16x16x32_bf16 v[200:203], a[40:43], v[56:59], v[200:203]
v_exp_f32 v32, v32
v_mfma_f32_16x16x32_bf16 v[232:235], a[40:43], v[60:63], v[232:235]
ds_read_b128 a[12:15], v1 offset:11264
v_cvt_pk_bf16_f32 v77, v30, v31
v_mfma_f32_16x16x32_bf16 v[236:239], a[44:47], v[60:63], v[236:239]
v_mfma_f32_16x16x32_bf16 v[204:207], a[44:47], v[56:59], v[204:207]
v_exp_f32 v33, v33
v_mfma_f32_16x16x32_bf16 v[172:175], a[44:47], v[52:55], v[172:175]
v_exp_f32 v34, v34
v_mfma_f32_16x16x32_bf16 v[140:143], a[44:47], v[48:51], v[140:143]
ds_read_b128 a[16:19], v1 offset:12288
v_cvt_pk_bf16_f32 v66, v32, v33
v_mfma_f32_16x16x32_bf16 v[144:147], a[48:51], v[48:51], v[144:147]
v_mfma_f32_16x16x32_bf16 v[176:179], a[48:51], v[52:55], v[176:179]
v_exp_f32 v35, v35
v_mfma_f32_16x16x32_bf16 v[208:211], a[48:51], v[56:59], v[208:211]
v_exp_f32 v36, v36
v_mfma_f32_16x16x32_bf16 v[240:243], a[48:51], v[60:63], v[240:243]
ds_read_b128 a[20:23], v1 offset:13312
v_cvt_pk_bf16_f32 v67, v34, v35
v_mfma_f32_16x16x32_bf16 v[244:247], a[52:55], v[60:63], v[244:247]
v_exp_f32 v37, v37
v_mfma_f32_16x16x32_bf16 v[212:215], a[52:55], v[56:59], v[212:215]
v_cvt_pk_bf16_f32 v70, v36, v37
v_mfma_f32_16x16x32_bf16 v[180:183], a[52:55], v[52:55], v[180:183]
ds_read_b128 a[24:27], v1 offset:14336
v_mfma_f32_16x16x32_bf16 v[148:151], a[52:55], v[48:51], v[148:151]
buffer_load_dwordx4 v3, s[48:51], s32 offen offset:1024 sc1 lds
v_mfma_f32_16x16x32_bf16 v[152:155], a[56:59], v[48:51], v[152:155]
v_exp_f32 v38, v38
v_mfma_f32_16x16x32_bf16 v[184:187], a[56:59], v[52:55], v[184:187]
v_exp_f32 v39, v39
v_mfma_f32_16x16x32_bf16 v[216:219], a[56:59], v[56:59], v[216:219]
ds_read_b128 a[28:31], v1 offset:15360
v_cvt_pk_bf16_f32 v71, v38, v39
v_mfma_f32_16x16x32_bf16 v[248:251], a[56:59], v[60:63], v[248:251]
v_mfma_f32_16x16x32_bf16 v[252:255], a[60:63], v[60:63], v[252:255]
v_exp_f32 v40, v40
v_mfma_f32_16x16x32_bf16 v[220:223], a[60:63], v[56:59], v[220:223]
v_exp_f32 v41, v41
v_mfma_f32_16x16x32_bf16 v[188:191], a[60:63], v[52:55], v[188:191]
ds_read_b128 a[32:35], v1 offset:0
v_cvt_pk_bf16_f32 v74, v40, v41
v_mfma_f32_16x16x32_bf16 v[156:159], a[60:63], v[48:51], v[156:159]
v_smfmac_f32_16x16x64_bf16 a[224:227], a[232:235], v[48:55], v9
v_exp_f32 v42, v42
v_smfmac_f32_16x16x64_bf16 a[228:231], a[232:235], v[56:63], v9
s_waitcnt lgkmcnt(5)
v_exp_f32 v43, v43
v_mfma_f32_16x16x32_bf16 v[16:19], a[0:3], a[160:163], v[80:83]
ds_read_b128 a[36:39], v1 offset:1024
v_cvt_pk_bf16_f32 v75, v42, v43
v_mfma_f32_16x16x32_bf16 v[16:19], a[4:7], a[164:167], v[16:19]
v_exp_f32 v44, v44
v_mfma_f32_16x16x32_bf16 v[16:19], a[8:11], a[168:171], v[16:19]
v_mfma_f32_16x16x32_bf16 v[16:19], a[12:15], a[172:175], v[16:19]
v_exp_f32 v45, v45
v_mfma_f32_16x16x32_bf16 v[20:23], a[0:3], a[176:179], v[84:87]
ds_read_b128 a[40:43], v1 offset:2048
v_cvt_pk_bf16_f32 v78, v44, v45
v_mfma_f32_16x16x32_bf16 v[20:23], a[4:7], a[180:183], v[20:23]
buffer_load_dwordx4 v3, s[48:51], s32 offen offset:2048 sc1 lds
v_mfma_f32_16x16x32_bf16 v[20:23], a[8:11], a[184:187], v[20:23]
v_exp_f32 v46, v46
v_mfma_f32_16x16x32_bf16 v[20:23], a[12:15], a[188:191], v[20:23]
ds_read_b128 a[44:47], v1 offset:3072
v_mfma_f32_16x16x32_bf16 v[24:27], a[0:3], a[192:195], v[88:91]
v_mfma_f32_16x16x32_bf16 v[24:27], a[4:7], a[196:199], v[24:27]
v_exp_f32 v47, v47
v_mfma_f32_16x16x32_bf16 v[24:27], a[8:11], a[200:203], v[24:27]
v_exp_f32 v16, v16
v_mfma_f32_16x16x32_bf16 v[24:27], a[12:15], a[204:207], v[24:27]
ds_read_b128 a[48:51], v1 offset:4096
v_cvt_pk_bf16_f32 v79, v46, v47
v_mfma_f32_16x16x32_bf16 v[28:31], a[0:3], a[208:211], v[92:95]
v_mfma_f32_16x16x32_bf16 v[28:31], a[4:7], a[212:215], v[28:31]
v_exp_f32 v17, v17
v_mfma_f32_16x16x32_bf16 v[28:31], a[8:11], a[216:219], v[28:31]
s_waitcnt lgkmcnt(5)
v_exp_f32 v18, v18
v_mfma_f32_16x16x32_bf16 v[28:31], a[12:15], a[220:223], v[28:31]
ds_read_b128 a[52:55], v1 offset:5120
v_cvt_pk_bf16_f32 v48, v16, v17
v_mfma_f32_16x16x32_bf16 v[32:35], a[16:19], a[160:163], v[80:83]
v_mfma_f32_16x16x32_bf16 v[32:35], a[20:23], a[164:167], v[32:35]
v_exp_f32 v19, v19
v_mfma_f32_16x16x32_bf16 v[32:35], a[24:27], a[168:171], v[32:35]
v_exp_f32 v20, v20
v_mfma_f32_16x16x32_bf16 v[32:35], a[28:31], a[172:175], v[32:35]
ds_read_b128 a[56:59], v1 offset:6144
v_cvt_pk_bf16_f32 v49, v18, v19
v_mfma_f32_16x16x32_bf16 v[36:39], a[16:19], a[176:179], v[84:87]
v_exp_f32 v21, v21
v_mfma_f32_16x16x32_bf16 v[36:39], a[20:23], a[180:183], v[36:39]
buffer_load_dwordx4 v3, s[48:51], s32 offen offset:3072 sc1 lds
v_mfma_f32_16x16x32_bf16 v[36:39], a[24:27], a[184:187], v[36:39]
s_add_u32 s32, s32, 0x8000
v_cvt_pk_bf16_f32 v52, v20, v21
v_mfma_f32_16x16x32_bf16 v[36:39], a[28:31], a[188:191], v[36:39]
ds_read_b128 a[60:63], v1 offset:7168
v_mfma_f32_16x16x32_bf16 v[40:43], a[16:19], a[192:195], v[88:91]
v_exp_f32 v22, v22
v_mfma_f32_16x16x32_bf16 v[40:43], a[20:23], a[196:199], v[40:43]
v_exp_f32 v23, v23
v_mfma_f32_16x16x32_bf16 v[40:43], a[24:27], a[200:203], v[40:43]
v_cvt_pk_bf16_f32 v53, v22, v23
v_mfma_f32_16x16x32_bf16 v[40:43], a[28:31], a[204:207], v[40:43]
v_exp_f32 v24, v24
v_mfma_f32_16x16x32_bf16 v[44:47], a[16:19], a[208:211], v[92:95]
v_exp_f32 v25, v25
v_mfma_f32_16x16x32_bf16 v[44:47], a[20:23], a[212:215], v[44:47]
v_exp_f32 v26, v26
v_mfma_f32_16x16x32_bf16 v[44:47], a[24:27], a[216:219], v[44:47]
v_exp_f32 v27, v27
v_mfma_f32_16x16x32_bf16 v[44:47], a[28:31], a[220:223], v[44:47]
s_waitcnt lgkmcnt(0)
v_mfma_f32_16x16x32_bf16 v[128:131], a[32:35], v[64:67], v[128:131]
ds_read_b128 a[0:3], v1 offset:24576
v_cvt_pk_bf16_f32 v56, v24, v25
v_mfma_f32_16x16x32_bf16 v[160:163], a[32:35], v[68:71], v[160:163]
v_exp_f32 v28, v28
v_mfma_f32_16x16x32_bf16 v[192:195], a[32:35], v[72:75], v[192:195]
v_cvt_pk_bf16_f32 v57, v26, v27
v_mfma_f32_16x16x32_bf16 v[224:227], a[32:35], v[76:79], v[224:227]
ds_read_b128 a[4:7], v1 offset:25600
v_mfma_f32_16x16x32_bf16 v[228:231], a[36:39], v[76:79], v[228:231]
v_exp_f32 v29, v29
v_mfma_f32_16x16x32_bf16 v[196:199], a[36:39], v[72:75], v[196:199]
v_exp_f32 v30, v30
v_mfma_f32_16x16x32_bf16 v[164:167], a[36:39], v[68:71], v[164:167]
s_add_u32 m0, s27, 0x1000
v_cvt_pk_bf16_f32 v60, v28, v29
v_mfma_f32_16x16x32_bf16 v[132:135], a[36:39], v[64:67], v[132:135]
buffer_load_dwordx4 v3, s[48:51], s7 offen offset:0 sc1 lds
v_mfma_f32_16x16x32_bf16 v[136:139], a[40:43], v[64:67], v[136:139]
ds_read_b128 a[8:11], v1 offset:26624
v_mfma_f32_16x16x32_bf16 v[168:171], a[40:43], v[68:71], v[168:171]
v_exp_f32 v31, v31
v_mfma_f32_16x16x32_bf16 v[200:203], a[40:43], v[72:75], v[200:203]
v_exp_f32 v32, v32
v_mfma_f32_16x16x32_bf16 v[232:235], a[40:43], v[76:79], v[232:235]
ds_read_b128 a[12:15], v1 offset:27648
v_cvt_pk_bf16_f32 v61, v30, v31
v_mfma_f32_16x16x32_bf16 v[236:239], a[44:47], v[76:79], v[236:239]
v_mfma_f32_16x16x32_bf16 v[204:207], a[44:47], v[72:75], v[204:207]
v_exp_f32 v33, v33
v_mfma_f32_16x16x32_bf16 v[172:175], a[44:47], v[68:71], v[172:175]
v_exp_f32 v34, v34
v_mfma_f32_16x16x32_bf16 v[140:143], a[44:47], v[64:67], v[140:143]
ds_read_b128 a[16:19], v1 offset:28672
v_cvt_pk_bf16_f32 v50, v32, v33
v_mfma_f32_16x16x32_bf16 v[144:147], a[48:51], v[64:67], v[144:147]
v_mfma_f32_16x16x32_bf16 v[176:179], a[48:51], v[68:71], v[176:179]
v_exp_f32 v35, v35
v_mfma_f32_16x16x32_bf16 v[208:211], a[48:51], v[72:75], v[208:211]
ds_read_b128 a[20:23], v1 offset:29696
v_cvt_pk_bf16_f32 v51, v34, v35
v_mfma_f32_16x16x32_bf16 v[240:243], a[48:51], v[76:79], v[240:243]
v_exp_f32 v36, v36
v_mfma_f32_16x16x32_bf16 v[244:247], a[52:55], v[76:79], v[244:247]
v_exp_f32 v37, v37
v_mfma_f32_16x16x32_bf16 v[212:215], a[52:55], v[72:75], v[212:215]
v_cvt_pk_bf16_f32 v54, v36, v37
v_mfma_f32_16x16x32_bf16 v[180:183], a[52:55], v[68:71], v[180:183]
buffer_load_dwordx4 v3, s[48:51], s7 offen offset:1024 sc1 lds
v_mfma_f32_16x16x32_bf16 v[148:151], a[52:55], v[64:67], v[148:151]
ds_read_b128 a[24:27], v1 offset:30720
v_mfma_f32_16x16x32_bf16 v[152:155], a[56:59], v[64:67], v[152:155]
v_exp_f32 v38, v38
v_mfma_f32_16x16x32_bf16 v[184:187], a[56:59], v[68:71], v[184:187]
v_exp_f32 v39, v39
v_mfma_f32_16x16x32_bf16 v[216:219], a[56:59], v[72:75], v[216:219]
ds_read_b128 a[28:31], v1 offset:31744
v_cvt_pk_bf16_f32 v55, v38, v39
v_mfma_f32_16x16x32_bf16 v[248:251], a[56:59], v[76:79], v[248:251]
v_mfma_f32_16x16x32_bf16 v[252:255], a[60:63], v[76:79], v[252:255]
v_exp_f32 v40, v40
v_mfma_f32_16x16x32_bf16 v[220:223], a[60:63], v[72:75], v[220:223]
v_exp_f32 v41, v41
v_mfma_f32_16x16x32_bf16 v[188:191], a[60:63], v[68:71], v[188:191]
ds_read_b128 a[32:35], v1 offset:16384
v_cvt_pk_bf16_f32 v58, v40, v41
v_mfma_f32_16x16x32_bf16 v[156:159], a[60:63], v[64:67], v[156:159]
v_smfmac_f32_16x16x64_bf16 a[224:227], a[232:235], v[64:71], v9
s_waitcnt lgkmcnt(5)
v_exp_f32 v42, v42
v_smfmac_f32_16x16x64_bf16 a[228:231], a[232:235], v[72:79], v9
ds_read_b128 a[36:39], v1 offset:17408
v_mfma_f32_16x16x32_bf16 v[16:19], a[0:3], a[160:163], v[80:83]
v_exp_f32 v43, v43
v_mfma_f32_16x16x32_bf16 v[16:19], a[4:7], a[164:167], v[16:19]
v_exp_f32 v44, v44
v_mfma_f32_16x16x32_bf16 v[16:19], a[8:11], a[168:171], v[16:19]
v_cvt_pk_bf16_f32 v59, v42, v43
v_mfma_f32_16x16x32_bf16 v[16:19], a[12:15], a[172:175], v[16:19]
ds_read_b128 a[40:43], v1 offset:18432
v_mfma_f32_16x16x32_bf16 v[20:23], a[0:3], a[176:179], v[84:87]
buffer_load_dwordx4 v3, s[48:51], s7 offen offset:2048 sc1 lds
v_mfma_f32_16x16x32_bf16 v[20:23], a[4:7], a[180:183], v[20:23]
v_exp_f32 v45, v45
v_mfma_f32_16x16x32_bf16 v[20:23], a[8:11], a[184:187], v[20:23]
v_exp_f32 v46, v46
v_mfma_f32_16x16x32_bf16 v[20:23], a[12:15], a[188:191], v[20:23]
ds_read_b128 a[44:47], v1 offset:19456
v_cvt_pk_bf16_f32 v62, v44, v45
v_mfma_f32_16x16x32_bf16 v[24:27], a[0:3], a[192:195], v[88:91]
v_mfma_f32_16x16x32_bf16 v[24:27], a[4:7], a[196:199], v[24:27]
v_exp_f32 v47, v47
v_mfma_f32_16x16x32_bf16 v[24:27], a[8:11], a[200:203], v[24:27]
v_exp_f32 v16, v16
v_mfma_f32_16x16x32_bf16 v[24:27], a[12:15], a[204:207], v[24:27]
ds_read_b128 a[48:51], v1 offset:20480
v_cvt_pk_bf16_f32 v63, v46, v47
v_mfma_f32_16x16x32_bf16 v[28:31], a[0:3], a[208:211], v[92:95]
v_mfma_f32_16x16x32_bf16 v[28:31], a[4:7], a[212:215], v[28:31]
v_exp_f32 v17, v17
v_mfma_f32_16x16x32_bf16 v[28:31], a[8:11], a[216:219], v[28:31]
ds_read_b128 a[52:55], v1 offset:21504
v_cvt_pk_bf16_f32 v64, v16, v17
v_mfma_f32_16x16x32_bf16 v[28:31], a[12:15], a[220:223], v[28:31]
s_waitcnt lgkmcnt(6)
v_exp_f32 v18, v18
v_mfma_f32_16x16x32_bf16 v[32:35], a[16:19], a[160:163], v[80:83]
v_mfma_f32_16x16x32_bf16 v[32:35], a[20:23], a[164:167], v[32:35]
v_exp_f32 v19, v19
v_mfma_f32_16x16x32_bf16 v[32:35], a[24:27], a[168:171], v[32:35]
ds_read_b128 a[56:59], v1 offset:22528
v_cvt_pk_bf16_f32 v65, v18, v19
v_mfma_f32_16x16x32_bf16 v[32:35], a[28:31], a[172:175], v[32:35]
buffer_load_dwordx4 v3, s[48:51], s7 offen offset:3072 sc1 lds
v_mfma_f32_16x16x32_bf16 v[36:39], a[16:19], a[176:179], v[84:87]
s_add_u32 s7, s7, 0x8000
v_exp_f32 v20, v20
v_mfma_f32_16x16x32_bf16 v[36:39], a[20:23], a[180:183], v[36:39]
s_xor_b32 s27, s27, 0x38000
v_exp_f32 v21, v21
v_mfma_f32_16x16x32_bf16 v[36:39], a[24:27], a[184:187], v[36:39]
ds_read_b128 a[60:63], v1 offset:23552
v_xor_b32 v1, 0x8000, v1
v_mfma_f32_16x16x32_bf16 v[36:39], a[28:31], a[188:191], v[36:39]
v_cvt_pk_bf16_f32 v68, v20, v21
v_mfma_f32_16x16x32_bf16 v[40:43], a[16:19], a[192:195], v[88:91]
v_exp_f32 v22, v22
v_mfma_f32_16x16x32_bf16 v[40:43], a[20:23], a[196:199], v[40:43]
v_exp_f32 v23, v23
v_mfma_f32_16x16x32_bf16 v[40:43], a[24:27], a[200:203], v[40:43]
v_cvt_pk_bf16_f32 v69, v22, v23
v_mfma_f32_16x16x32_bf16 v[40:43], a[28:31], a[204:207], v[40:43]
v_exp_f32 v24, v24
v_mfma_f32_16x16x32_bf16 v[44:47], a[16:19], a[208:211], v[92:95]
s_waitcnt vmcnt(16) lgkmcnt(0)
v_exp_f32 v25, v25
v_mfma_f32_16x16x32_bf16 v[44:47], a[20:23], a[212:215], v[44:47]
s_barrier
v_exp_f32 v26, v26
v_mfma_f32_16x16x32_bf16 v[44:47], a[24:27], a[216:219], v[44:47]
v_exp_f32 v27, v27
v_mfma_f32_16x16x32_bf16 v[44:47], a[28:31], a[220:223], v[44:47]
L_att_dodd1:
v_mfma_f32_16x16x32_bf16 v[128:131], a[32:35], v[48:51], v[128:131]
ds_read_b128 a[0:3], v2 offset:8192
v_cvt_pk_bf16_f32 v72, v24, v25
v_mfma_f32_16x16x32_bf16 v[160:163], a[32:35], v[52:55], v[160:163]
v_exp_f32 v28, v28
v_mfma_f32_16x16x32_bf16 v[192:195], a[32:35], v[56:59], v[192:195]
v_cvt_pk_bf16_f32 v73, v26, v27
v_mfma_f32_16x16x32_bf16 v[224:227], a[32:35], v[60:63], v[224:227]
ds_read_b128 a[4:7], v2 offset:9216
v_mfma_f32_16x16x32_bf16 v[228:231], a[36:39], v[60:63], v[228:231]
v_exp_f32 v29, v29
v_mfma_f32_16x16x32_bf16 v[196:199], a[36:39], v[56:59], v[196:199]
v_exp_f32 v30, v30
v_mfma_f32_16x16x32_bf16 v[164:167], a[36:39], v[52:55], v[164:167]
s_add_u32 m0, s19, 0x0
v_cvt_pk_bf16_f32 v76, v28, v29
v_mfma_f32_16x16x32_bf16 v[132:135], a[36:39], v[48:51], v[132:135]
buffer_load_dwordx4 v3, s[48:51], s32 offen offset:0 sc1 lds
v_mfma_f32_16x16x32_bf16 v[136:139], a[40:43], v[48:51], v[136:139]
ds_read_b128 a[8:11], v2 offset:10240
v_mfma_f32_16x16x32_bf16 v[168:171], a[40:43], v[52:55], v[168:171]
v_exp_f32 v31, v31
v_mfma_f32_16x16x32_bf16 v[200:203], a[40:43], v[56:59], v[200:203]
v_exp_f32 v32, v32
v_mfma_f32_16x16x32_bf16 v[232:235], a[40:43], v[60:63], v[232:235]
ds_read_b128 a[12:15], v2 offset:11264
v_cvt_pk_bf16_f32 v77, v30, v31
v_mfma_f32_16x16x32_bf16 v[236:239], a[44:47], v[60:63], v[236:239]
v_mfma_f32_16x16x32_bf16 v[204:207], a[44:47], v[56:59], v[204:207]
v_exp_f32 v33, v33
v_mfma_f32_16x16x32_bf16 v[172:175], a[44:47], v[52:55], v[172:175]
v_exp_f32 v34, v34
v_mfma_f32_16x16x32_bf16 v[140:143], a[44:47], v[48:51], v[140:143]
ds_read_b128 a[16:19], v2 offset:12288
v_cvt_pk_bf16_f32 v66, v32, v33
v_mfma_f32_16x16x32_bf16 v[144:147], a[48:51], v[48:51], v[144:147]
v_mfma_f32_16x16x32_bf16 v[176:179], a[48:51], v[52:55], v[176:179]
v_exp_f32 v35, v35
v_mfma_f32_16x16x32_bf16 v[208:211], a[48:51], v[56:59], v[208:211]
v_exp_f32 v36, v36
v_mfma_f32_16x16x32_bf16 v[240:243], a[48:51], v[60:63], v[240:243]
ds_read_b128 a[20:23], v2 offset:13312
v_cvt_pk_bf16_f32 v67, v34, v35
v_mfma_f32_16x16x32_bf16 v[244:247], a[52:55], v[60:63], v[244:247]
v_exp_f32 v37, v37
v_mfma_f32_16x16x32_bf16 v[212:215], a[52:55], v[56:59], v[212:215]
v_cvt_pk_bf16_f32 v70, v36, v37
v_mfma_f32_16x16x32_bf16 v[180:183], a[52:55], v[52:55], v[180:183]
ds_read_b128 a[24:27], v2 offset:14336
v_mfma_f32_16x16x32_bf16 v[148:151], a[52:55], v[48:51], v[148:151]
buffer_load_dwordx4 v3, s[48:51], s32 offen offset:1024 sc1 lds
v_mfma_f32_16x16x32_bf16 v[152:155], a[56:59], v[48:51], v[152:155]
v_exp_f32 v38, v38
v_mfma_f32_16x16x32_bf16 v[184:187], a[56:59], v[52:55], v[184:187]
v_exp_f32 v39, v39
v_mfma_f32_16x16x32_bf16 v[216:219], a[56:59], v[56:59], v[216:219]
ds_read_b128 a[28:31], v2 offset:15360
v_cvt_pk_bf16_f32 v71, v38, v39
v_mfma_f32_16x16x32_bf16 v[248:251], a[56:59], v[60:63], v[248:251]
v_mfma_f32_16x16x32_bf16 v[252:255], a[60:63], v[60:63], v[252:255]
v_exp_f32 v40, v40
v_mfma_f32_16x16x32_bf16 v[220:223], a[60:63], v[56:59], v[220:223]
v_exp_f32 v41, v41
v_mfma_f32_16x16x32_bf16 v[188:191], a[60:63], v[52:55], v[188:191]
ds_read_b128 a[32:35], v2 offset:0
v_cvt_pk_bf16_f32 v74, v40, v41
v_mfma_f32_16x16x32_bf16 v[156:159], a[60:63], v[48:51], v[156:159]
v_smfmac_f32_16x16x64_bf16 a[224:227], a[232:235], v[48:55], v9
v_exp_f32 v42, v42
v_smfmac_f32_16x16x64_bf16 a[228:231], a[232:235], v[56:63], v9
s_waitcnt lgkmcnt(5)
v_exp_f32 v43, v43
v_mfma_f32_16x16x32_bf16 v[16:19], a[0:3], a[160:163], v[80:83]
ds_read_b128 a[36:39], v2 offset:1024
v_cvt_pk_bf16_f32 v75, v42, v43
v_mfma_f32_16x16x32_bf16 v[16:19], a[4:7], a[164:167], v[16:19]
v_exp_f32 v44, v44
v_mfma_f32_16x16x32_bf16 v[16:19], a[8:11], a[168:171], v[16:19]
v_mfma_f32_16x16x32_bf16 v[16:19], a[12:15], a[172:175], v[16:19]
v_exp_f32 v45, v45
v_mfma_f32_16x16x32_bf16 v[20:23], a[0:3], a[176:179], v[84:87]
ds_read_b128 a[40:43], v2 offset:2048
v_cvt_pk_bf16_f32 v78, v44, v45
v_mfma_f32_16x16x32_bf16 v[20:23], a[4:7], a[180:183], v[20:23]
buffer_load_dwordx4 v3, s[48:51], s32 offen offset:2048 sc1 lds
v_mfma_f32_16x16x32_bf16 v[20:23], a[8:11], a[184:187], v[20:23]
v_exp_f32 v46, v46
v_mfma_f32_16x16x32_bf16 v[20:23], a[12:15], a[188:191], v[20:23]
ds_read_b128 a[44:47], v2 offset:3072
v_mfma_f32_16x16x32_bf16 v[24:27], a[0:3], a[192:195], v[88:91]
v_mfma_f32_16x16x32_bf16 v[24:27], a[4:7], a[196:199], v[24:27]
v_exp_f32 v47, v47
v_mfma_f32_16x16x32_bf16 v[24:27], a[8:11], a[200:203], v[24:27]
v_exp_f32 v16, v16
v_mfma_f32_16x16x32_bf16 v[24:27], a[12:15], a[204:207], v[24:27]
ds_read_b128 a[48:51], v2 offset:4096
v_cvt_pk_bf16_f32 v79, v46, v47
v_mfma_f32_16x16x32_bf16 v[28:31], a[0:3], a[208:211], v[92:95]
v_mfma_f32_16x16x32_bf16 v[28:31], a[4:7], a[212:215], v[28:31]
v_exp_f32 v17, v17
v_mfma_f32_16x16x32_bf16 v[28:31], a[8:11], a[216:219], v[28:31]
s_waitcnt lgkmcnt(5)
v_exp_f32 v18, v18
v_mfma_f32_16x16x32_bf16 v[28:31], a[12:15], a[220:223], v[28:31]
ds_read_b128 a[52:55], v2 offset:5120
v_cvt_pk_bf16_f32 v48, v16, v17
v_mfma_f32_16x16x32_bf16 v[32:35], a[16:19], a[160:163], v[80:83]
v_mfma_f32_16x16x32_bf16 v[32:35], a[20:23], a[164:167], v[32:35]
v_exp_f32 v19, v19
v_mfma_f32_16x16x32_bf16 v[32:35], a[24:27], a[168:171], v[32:35]
v_exp_f32 v20, v20
v_mfma_f32_16x16x32_bf16 v[32:35], a[28:31], a[172:175], v[32:35]
ds_read_b128 a[56:59], v2 offset:6144
v_cvt_pk_bf16_f32 v49, v18, v19
v_mfma_f32_16x16x32_bf16 v[36:39], a[16:19], a[176:179], v[84:87]
v_exp_f32 v21, v21
v_mfma_f32_16x16x32_bf16 v[36:39], a[20:23], a[180:183], v[36:39]
buffer_load_dwordx4 v3, s[48:51], s32 offen offset:3072 sc1 lds
v_mfma_f32_16x16x32_bf16 v[36:39], a[24:27], a[184:187], v[36:39]
s_add_u32 s32, s32, 0x8000
v_cvt_pk_bf16_f32 v52, v20, v21
v_mfma_f32_16x16x32_bf16 v[36:39], a[28:31], a[188:191], v[36:39]
ds_read_b128 a[60:63], v2 offset:7168
v_mfma_f32_16x16x32_bf16 v[40:43], a[16:19], a[192:195], v[88:91]
v_exp_f32 v22, v22
v_mfma_f32_16x16x32_bf16 v[40:43], a[20:23], a[196:199], v[40:43]
v_exp_f32 v23, v23
v_mfma_f32_16x16x32_bf16 v[40:43], a[24:27], a[200:203], v[40:43]
v_cvt_pk_bf16_f32 v53, v22, v23
v_mfma_f32_16x16x32_bf16 v[40:43], a[28:31], a[204:207], v[40:43]
v_exp_f32 v24, v24
v_mfma_f32_16x16x32_bf16 v[44:47], a[16:19], a[208:211], v[92:95]
v_exp_f32 v25, v25
v_mfma_f32_16x16x32_bf16 v[44:47], a[20:23], a[212:215], v[44:47]
v_exp_f32 v26, v26
v_mfma_f32_16x16x32_bf16 v[44:47], a[24:27], a[216:219], v[44:47]
v_exp_f32 v27, v27
v_mfma_f32_16x16x32_bf16 v[44:47], a[28:31], a[220:223], v[44:47]
s_waitcnt lgkmcnt(0)
v_mfma_f32_16x16x32_bf16 v[128:131], a[32:35], v[64:67], v[128:131]
ds_read_b128 a[0:3], v2 offset:24576
v_cvt_pk_bf16_f32 v56, v24, v25
v_mfma_f32_16x16x32_bf16 v[160:163], a[32:35], v[68:71], v[160:163]
v_exp_f32 v28, v28
v_mfma_f32_16x16x32_bf16 v[192:195], a[32:35], v[72:75], v[192:195]
v_cvt_pk_bf16_f32 v57, v26, v27
v_mfma_f32_16x16x32_bf16 v[224:227], a[32:35], v[76:79], v[224:227]
ds_read_b128 a[4:7], v2 offset:25600
v_mfma_f32_16x16x32_bf16 v[228:231], a[36:39], v[76:79], v[228:231]
v_exp_f32 v29, v29
v_mfma_f32_16x16x32_bf16 v[196:199], a[36:39], v[72:75], v[196:199]
v_exp_f32 v30, v30
v_mfma_f32_16x16x32_bf16 v[164:167], a[36:39], v[68:71], v[164:167]
s_add_u32 m0, s19, 0x1000
v_cvt_pk_bf16_f32 v60, v28, v29
v_mfma_f32_16x16x32_bf16 v[132:135], a[36:39], v[64:67], v[132:135]
buffer_load_dwordx4 v3, s[48:51], s7 offen offset:0 sc1 lds
v_mfma_f32_16x16x32_bf16 v[136:139], a[40:43], v[64:67], v[136:139]
ds_read_b128 a[8:11], v2 offset:26624
v_mfma_f32_16x16x32_bf16 v[168:171], a[40:43], v[68:71], v[168:171]
v_exp_f32 v31, v31
v_mfma_f32_16x16x32_bf16 v[200:203], a[40:43], v[72:75], v[200:203]
v_exp_f32 v32, v32
v_mfma_f32_16x16x32_bf16 v[232:235], a[40:43], v[76:79], v[232:235]
ds_read_b128 a[12:15], v2 offset:27648
v_cvt_pk_bf16_f32 v61, v30, v31
v_mfma_f32_16x16x32_bf16 v[236:239], a[44:47], v[76:79], v[236:239]
v_mfma_f32_16x16x32_bf16 v[204:207], a[44:47], v[72:75], v[204:207]
v_exp_f32 v33, v33
v_mfma_f32_16x16x32_bf16 v[172:175], a[44:47], v[68:71], v[172:175]
v_exp_f32 v34, v34
v_mfma_f32_16x16x32_bf16 v[140:143], a[44:47], v[64:67], v[140:143]
ds_read_b128 a[16:19], v2 offset:28672
v_cvt_pk_bf16_f32 v50, v32, v33
v_mfma_f32_16x16x32_bf16 v[144:147], a[48:51], v[64:67], v[144:147]
v_exp_f32 v35, v35
v_mfma_f32_16x16x32_bf16 v[176:179], a[48:51], v[68:71], v[176:179]
v_cvt_pk_bf16_f32 v51, v34, v35
v_mfma_f32_16x16x32_bf16 v[208:211], a[48:51], v[72:75], v[208:211]
ds_read_b128 a[20:23], v2 offset:29696
v_mfma_f32_16x16x32_bf16 v[240:243], a[48:51], v[76:79], v[240:243]
v_exp_f32 v36, v36
v_mfma_f32_16x16x32_bf16 v[244:247], a[52:55], v[76:79], v[244:247]
v_exp_f32 v37, v37
v_mfma_f32_16x16x32_bf16 v[212:215], a[52:55], v[72:75], v[212:215]
v_cvt_pk_bf16_f32 v54, v36, v37
v_mfma_f32_16x16x32_bf16 v[180:183], a[52:55], v[68:71], v[180:183]
buffer_load_dwordx4 v3, s[48:51], s7 offen offset:1024 sc1 lds
v_mfma_f32_16x16x32_bf16 v[148:151], a[52:55], v[64:67], v[148:151]
ds_read_b128 a[24:27], v2 offset:30720
v_mfma_f32_16x16x32_bf16 v[152:155], a[56:59], v[64:67], v[152:155]
v_exp_f32 v38, v38
v_mfma_f32_16x16x32_bf16 v[184:187], a[56:59], v[68:71], v[184:187]
v_exp_f32 v39, v39
v_mfma_f32_16x16x32_bf16 v[216:219], a[56:59], v[72:75], v[216:219]
ds_read_b128 a[28:31], v2 offset:31744
v_cvt_pk_bf16_f32 v55, v38, v39
v_mfma_f32_16x16x32_bf16 v[248:251], a[56:59], v[76:79], v[248:251]
v_exp_f32 v40, v40
v_mfma_f32_16x16x32_bf16 v[252:255], a[60:63], v[76:79], v[252:255]
v_mfma_f32_16x16x32_bf16 v[220:223], a[60:63], v[72:75], v[220:223]
v_exp_f32 v41, v41
v_mfma_f32_16x16x32_bf16 v[188:191], a[60:63], v[68:71], v[188:191]
ds_read_b128 a[32:35], v2 offset:16384
v_cvt_pk_bf16_f32 v58, v40, v41
v_mfma_f32_16x16x32_bf16 v[156:159], a[60:63], v[64:67], v[156:159]
v_exp_f32 v42, v42
v_smfmac_f32_16x16x64_bf16 a[224:227], a[232:235], v[64:71], v9
s_waitcnt lgkmcnt(5)
v_smfmac_f32_16x16x64_bf16 a[228:231], a[232:235], v[72:79], v9
ds_read_b128 a[36:39], v2 offset:17408
v_mfma_f32_16x16x32_bf16 v[16:19], a[0:3], a[160:163], v[80:83]
v_exp_f32 v43, v43
v_mfma_f32_16x16x32_bf16 v[16:19], a[4:7], a[164:167], v[16:19]
v_exp_f32 v44, v44
v_mfma_f32_16x16x32_bf16 v[16:19], a[8:11], a[168:171], v[16:19]
buffer_load_dwordx4 v3, s[48:51], s7 offen offset:2048 sc1 lds
v_mfma_f32_16x16x32_bf16 v[16:19], a[12:15], a[172:175], v[16:19]
ds_read_b128 a[40:43], v2 offset:18432
v_cvt_pk_bf16_f32 v59, v42, v43
v_mfma_f32_16x16x32_bf16 v[20:23], a[0:3], a[176:179], v[84:87]
v_exp_f32 v45, v45
v_mfma_f32_16x16x32_bf16 v[20:23], a[4:7], a[180:183], v[20:23]
v_cvt_pk_bf16_f32 v62, v44, v45
v_mfma_f32_16x16x32_bf16 v[20:23], a[8:11], a[184:187], v[20:23]
v_exp_f32 v46, v46
v_mfma_f32_16x16x32_bf16 v[20:23], a[12:15], a[188:191], v[20:23]
ds_read_b128 a[44:47], v2 offset:19456
v_mfma_f32_16x16x32_bf16 v[24:27], a[0:3], a[192:195], v[88:91]
v_exp_f32 v47, v47
v_mfma_f32_16x16x32_bf16 v[24:27], a[4:7], a[196:199], v[24:27]
v_cvt_pk_bf16_f32 v63, v46, v47
v_mfma_f32_16x16x32_bf16 v[24:27], a[8:11], a[200:203], v[24:27]
v_exp_f32 v16, v16
v_mfma_f32_16x16x32_bf16 v[24:27], a[12:15], a[204:207], v[24:27]
ds_read_b128 a[48:51], v2 offset:20480
v_mfma_f32_16x16x32_bf16 v[28:31], a[0:3], a[208:211], v[92:95]
v_exp_f32 v17, v17
v_mfma_f32_16x16x32_bf16 v[28:31], a[4:7], a[212:215], v[28:31]
v_exp_f32 v18, v18
v_mfma_f32_16x16x32_bf16 v[28:31], a[8:11], a[216:219], v[28:31]
ds_read_b128 a[52:55], v2 offset:21504
v_cvt_pk_bf16_f32 v64, v16, v17
v_mfma_f32_16x16x32_bf16 v[28:31], a[12:15], a[220:223], v[28:31]
s_waitcnt lgkmcnt(6)
v_mfma_f32_16x16x32_bf16 v[32:35], a[16:19], a[160:163], v[80:83]
v_exp_f32 v19, v19
v_mfma_f32_16x16x32_bf16 v[32:35], a[20:23], a[164:167], v[32:35]
buffer_load_dwordx4 v3, s[48:51], s7 offen offset:3072 sc1 lds
v_mfma_f32_16x16x32_bf16 v[32:35], a[24:27], a[168:171], v[32:35]
ds_read_b128 a[56:59], v2 offset:22528
v_cvt_pk_bf16_f32 v65, v18, v19
v_mfma_f32_16x16x32_bf16 v[32:35], a[28:31], a[172:175], v[32:35]
s_add_u32 s7, s7, 0x8000
v_exp_f32 v20, v20
v_mfma_f32_16x16x32_bf16 v[36:39], a[16:19], a[176:179], v[84:87]
s_xor_b32 s19, s19, 0x8000
v_mfma_f32_16x16x32_bf16 v[36:39], a[20:23], a[180:183], v[36:39]
s_sub_u32 s15, s15, 1
v_exp_f32 v21, v21
v_mfma_f32_16x16x32_bf16 v[36:39], a[24:27], a[184:187], v[36:39]
ds_read_b128 a[60:63], v2 offset:23552
v_xor_b32 v2, 0x38000, v2
v_mfma_f32_16x16x32_bf16 v[36:39], a[28:31], a[188:191], v[36:39]
s_cmp_lg_u32 s15, 0
v_exp_f32 v22, v22
v_mfma_f32_16x16x32_bf16 v[40:43], a[16:19], a[192:195], v[88:91]
v_exp_f32 v23, v23
v_mfma_f32_16x16x32_bf16 v[40:43], a[20:23], a[196:199], v[40:43]
v_cvt_pk_bf16_f32 v68, v20, v21
v_cvt_pk_bf16_f32 v69, v22, v23
v_mfma_f32_16x16x32_bf16 v[40:43], a[24:27], a[200:203], v[40:43]
v_exp_f32 v24, v24
v_mfma_f32_16x16x32_bf16 v[40:43], a[28:31], a[204:207], v[40:43]
v_exp_f32 v25, v25
v_mfma_f32_16x16x32_bf16 v[44:47], a[16:19], a[208:211], v[92:95]
s_waitcnt vmcnt(16) lgkmcnt(0)
v_exp_f32 v26, v26
v_mfma_f32_16x16x32_bf16 v[44:47], a[20:23], a[212:215], v[44:47]
s_barrier
v_exp_f32 v27, v27
v_mfma_f32_16x16x32_bf16 v[44:47], a[24:27], a[216:219], v[44:47]
v_mfma_f32_16x16x32_bf16 v[44:47], a[28:31], a[220:223], v[44:47]
s_cbranch_scc1 L_att_deven1
L_att_ddone:
s_cmp_ge_u32 s4, 2
s_cbranch_scc1 L_att_dl0_1
L_att_dl0_0:
v_mfma_f32_16x16x32_bf16 v[128:131], a[32:35], v[48:51], v[128:131]
ds_read_b128 a[0:3], v1 offset:8192
v_cvt_pk_bf16_f32 v72, v24, v25
v_mfma_f32_16x16x32_bf16 v[160:163], a[32:35], v[52:55], v[160:163]
v_exp_f32 v28, v28
v_mfma_f32_16x16x32_bf16 v[192:195], a[32:35], v[56:59], v[192:195]
v_cvt_pk_bf16_f32 v73, v26, v27
v_mfma_f32_16x16x32_bf16 v[224:227], a[32:35], v[60:63], v[224:227]
ds_read_b128 a[4:7], v1 offset:9216
v_mfma_f32_16x16x32_bf16 v[228:231], a[36:39], v[60:63], v[228:231]
s_add_u32 m0, s27, 0x0
v_exp_f32 v29, v29
v_mfma_f32_16x16x32_bf16 v[196:199], a[36:39], v[56:59], v[196:199]
buffer_load_dwordx4 v3, s[48:51], s32 offen offset:0 sc1 lds
v_mfma_f32_16x16x32_bf16 v[164:167], a[36:39], v[52:55], v[164:167]
v_exp_f32 v30, v30
v_mfma_f32_16x16x32_bf16 v[132:135], a[36:39], v[48:51], v[132:135]
ds_read_b128 a[8:11], v1 offset:10240
v_cvt_pk_bf16_f32 v76, v28, v29
v_mfma_f32_16x16x32_bf16 v[136:139], a[40:43], v[48:51], v[136:139]
v_mfma_f32_16x16x32_bf16 v[168:171], a[40:43], v[52:55], v[168:171]
v_exp_f32 v31, v31
v_mfma_f32_16x16x32_bf16 v[200:203], a[40:43], v[56:59], v[200:203]
v_exp_f32 v32, v32
v_mfma_f32_16x16x32_bf16 v[232:235], a[40:43], v[60:63], v[232:235]
ds_read_b128 a[12:15], v1 offset:11264
v_cvt_pk_bf16_f32 v77, v30, v31
v_mfma_f32_16x16x32_bf16 v[236:239], a[44:47], v[60:63], v[236:239]
v_exp_f32 v33, v33
v_mfma_f32_16x16x32_bf16 v[204:207], a[44:47], v[56:59], v[204:207]
v_cvt_pk_bf16_f32 v66, v32, v33
v_mfma_f32_16x16x32_bf16 v[172:175], a[44:47], v[52:55], v[172:175]
s_mov_b32 s9, 0x0
v_exp_f32 v34, v34
v_mfma_f32_16x16x32_bf16 v[140:143], a[44:47], v[48:51], v[140:143]
ds_read_b128 a[16:19], v1 offset:12288
v_mfma_f32_16x16x32_bf16 v[144:147], a[48:51], v[48:51], v[144:147]
buffer_load_dword a244, v8, s[72:75], s9 offen
v_mfma_f32_16x16x32_bf16 v[176:179], a[48:51], v[52:55], v[176:179]
v_exp_f32 v35, v35
v_mfma_f32_16x16x32_bf16 v[208:211], a[48:51], v[56:59], v[208:211]
v_exp_f32 v36, v36
v_mfma_f32_16x16x32_bf16 v[240:243], a[48:51], v[60:63], v[240:243]
ds_read_b128 a[20:23], v1 offset:13312
v_cvt_pk_bf16_f32 v67, v34, v35
v_mfma_f32_16x16x32_bf16 v[244:247], a[52:55], v[60:63], v[244:247]
v_mfma_f32_16x16x32_bf16 v[212:215], a[52:55], v[56:59], v[212:215]
v_exp_f32 v37, v37
v_mfma_f32_16x16x32_bf16 v[180:183], a[52:55], v[52:55], v[180:183]
ds_read_b128 a[24:27], v1 offset:14336
v_cvt_pk_bf16_f32 v70, v36, v37
v_mfma_f32_16x16x32_bf16 v[148:151], a[52:55], v[48:51], v[148:151]
v_exp_f32 v38, v38
v_mfma_f32_16x16x32_bf16 v[152:155], a[56:59], v[48:51], v[152:155]
v_mfma_f32_16x16x32_bf16 v[184:187], a[56:59], v[52:55], v[184:187]
v_exp_f32 v39, v39
v_mfma_f32_16x16x32_bf16 v[216:219], a[56:59], v[56:59], v[216:219]
buffer_load_dwordx4 v3, s[48:51], s32 offen offset:1024 sc1 lds
v_mfma_f32_16x16x32_bf16 v[248:251], a[56:59], v[60:63], v[248:251]
ds_read_b128 a[28:31], v1 offset:15360
v_cvt_pk_bf16_f32 v71, v38, v39
v_mfma_f32_16x16x32_bf16 v[252:255], a[60:63], v[60:63], v[252:255]
v_exp_f32 v40, v40
v_mfma_f32_16x16x32_bf16 v[220:223], a[60:63], v[56:59], v[220:223]
v_exp_f32 v41, v41
v_mfma_f32_16x16x32_bf16 v[188:191], a[60:63], v[52:55], v[188:191]
ds_read_b128 a[32:35], v1 offset:0
v_cvt_pk_bf16_f32 v74, v40, v41
v_mfma_f32_16x16x32_bf16 v[156:159], a[60:63], v[48:51], v[156:159]
v_smfmac_f32_16x16x64_bf16 a[224:227], a[232:235], v[48:55], v9
v_exp_f32 v42, v42
v_smfmac_f32_16x16x64_bf16 a[228:231], a[232:235], v[56:63], v9
s_waitcnt lgkmcnt(5)
v_exp_f32 v43, v43
v_mfma_f32_16x16x32_bf16 v[16:19], a[0:3], a[160:163], v[96:99]
ds_read_b128 a[36:39], v1 offset:1024
v_cvt_pk_bf16_f32 v75, v42, v43
v_mfma_f32_16x16x32_bf16 v[16:19], a[4:7], a[164:167], v[16:19]
v_exp_f32 v44, v44
v_mfma_f32_16x16x32_bf16 v[16:19], a[8:11], a[168:171], v[16:19]
v_mfma_f32_16x16x32_bf16 v[16:19], a[12:15], a[172:175], v[16:19]
buffer_load_dwordx4 v3, s[48:51], s32 offen offset:2048 sc1 lds
v_mfma_f32_16x16x32_bf16 v[20:23], a[0:3], a[176:179], v[84:87]
ds_read_b128 a[40:43], v1 offset:2048
v_mfma_f32_16x16x32_bf16 v[20:23], a[4:7], a[180:183], v[20:23]
v_exp_f32 v45, v45
v_mfma_f32_16x16x32_bf16 v[20:23], a[8:11], a[184:187], v[20:23]
v_exp_f32 v46, v46
v_mfma_f32_16x16x32_bf16 v[20:23], a[12:15], a[188:191], v[20:23]
ds_read_b128 a[44:47], v1 offset:3072
v_cvt_pk_bf16_f32 v78, v44, v45
v_mfma_f32_16x16x32_bf16 v[24:27], a[0:3], a[192:195], v[88:91]
v_mfma_f32_16x16x32_bf16 v[24:27], a[4:7], a[196:199], v[24:27]
v_exp_f32 v47, v47
v_mfma_f32_16x16x32_bf16 v[24:27], a[8:11], a[200:203], v[24:27]
v_exp_f32 v16, v16
v_mfma_f32_16x16x32_bf16 v[24:27], a[12:15], a[204:207], v[24:27]
ds_read_b128 a[48:51], v1 offset:4096
v_cvt_pk_bf16_f32 v79, v46, v47
v_mfma_f32_16x16x32_bf16 v[28:31], a[0:3], a[208:211], v[92:95]
v_exp_f32 v17, v17
v_mfma_f32_16x16x32_bf16 v[28:31], a[4:7], a[212:215], v[28:31]
s_waitcnt lgkmcnt(5)
v_cvt_pk_bf16_f32 v48, v16, v17
v_mfma_f32_16x16x32_bf16 v[28:31], a[8:11], a[216:219], v[28:31]
buffer_load_dwordx4 v3, s[48:51], s32 offen offset:3072 sc1 lds
v_mfma_f32_16x16x32_bf16 v[28:31], a[12:15], a[220:223], v[28:31]
ds_read_b128 a[52:55], v1 offset:5120
v_mfma_f32_16x16x32_bf16 v[32:35], a[16:19], a[160:163], v[100:103]
v_exp_f32 v18, v18
v_mfma_f32_16x16x32_bf16 v[32:35], a[20:23], a[164:167], v[32:35]
v_exp_f32 v19, v19
v_mfma_f32_16x16x32_bf16 v[32:35], a[24:27], a[168:171], v[32:35]
v_exp_f32 v20, v20
v_mfma_f32_16x16x32_bf16 v[32:35], a[28:31], a[172:175], v[32:35]
ds_read_b128 a[56:59], v1 offset:6144
v_cvt_pk_bf16_f32 v49, v18, v19
v_mfma_f32_16x16x32_bf16 v[36:39], a[16:19], a[176:179], v[84:87]
v_mfma_f32_16x16x32_bf16 v[36:39], a[20:23], a[180:183], v[36:39]
v_exp_f32 v21, v21
v_mfma_f32_16x16x32_bf16 v[36:39], a[24:27], a[184:187], v[36:39]
s_mov_b32 s9, 0x0
v_exp_f32 v22, v22
v_mfma_f32_16x16x32_bf16 v[36:39], a[28:31], a[188:191], v[36:39]
ds_read_b128 a[60:63], v1 offset:7168
v_cvt_pk_bf16_f32 v52, v20, v21
v_mfma_f32_16x16x32_bf16 v[40:43], a[16:19], a[192:195], v[88:91]
buffer_load_dword a244, v8, s[64:67], s9 offen
v_mfma_f32_16x16x32_bf16 v[40:43], a[20:23], a[196:199], v[40:43]
v_mfma_f32_16x16x32_bf16 v[40:43], a[24:27], a[200:203], v[40:43]
v_exp_f32 v23, v23
v_mfma_f32_16x16x32_bf16 v[40:43], a[28:31], a[204:207], v[40:43]
v_exp_f32 v24, v24
v_mfma_f32_16x16x32_bf16 v[44:47], a[16:19], a[208:211], v[92:95]
v_exp_f32 v25, v25
v_mfma_f32_16x16x32_bf16 v[44:47], a[20:23], a[212:215], v[44:47]
v_exp_f32 v26, v26
v_mfma_f32_16x16x32_bf16 v[44:47], a[24:27], a[216:219], v[44:47]
v_exp_f32 v27, v27
v_mfma_f32_16x16x32_bf16 v[44:47], a[28:31], a[220:223], v[44:47]
s_waitcnt lgkmcnt(0)
v_cvt_pk_bf16_f32 v53, v22, v23
v_mfma_f32_16x16x32_bf16 v[128:131], a[32:35], v[64:67], v[128:131]
ds_read_b128 a[0:3], v1 offset:24576
v_cvt_pk_bf16_f32 v56, v24, v25
v_mfma_f32_16x16x32_bf16 v[160:163], a[32:35], v[68:71], v[160:163]
v_exp_f32 v28, v28
v_mfma_f32_16x16x32_bf16 v[192:195], a[32:35], v[72:75], v[192:195]
v_cvt_pk_bf16_f32 v57, v26, v27
v_mfma_f32_16x16x32_bf16 v[224:227], a[32:35], v[76:79], v[224:227]
ds_read_b128 a[4:7], v1 offset:25600
v_mfma_f32_16x16x32_bf16 v[228:231], a[36:39], v[76:79], v[228:231]
s_add_u32 m0, s27, 0x1000
v_exp_f32 v29, v29
v_mfma_f32_16x16x32_bf16 v[196:199], a[36:39], v[72:75], v[196:199]
buffer_load_dwordx4 v3, s[48:51], s7 offen offset:0 sc1 lds
v_mfma_f32_16x16x32_bf16 v[164:167], a[36:39], v[68:71], v[164:167]
ds_read_b128 a[8:11], v1 offset:26624
v_cvt_pk_bf16_f32 v60, v28, v29
v_mfma_f32_16x16x32_bf16 v[132:135], a[36:39], v[64:67], v[132:135]
v_exp_f32 v30, v30
v_mfma_f32_16x16x32_bf16 v[136:139], a[40:43], v[64:67], v[136:139]
v_exp_f32 v31, v31
v_mfma_f32_16x16x32_bf16 v[168:171], a[40:43], v[68:71], v[168:171]
ds_read_b128 a[12:15], v1 offset:27648
v_cvt_pk_bf16_f32 v61, v30, v31
v_mfma_f32_16x16x32_bf16 v[200:203], a[40:43], v[72:75], v[200:203]
v_mfma_f32_16x16x32_bf16 v[232:235], a[40:43], v[76:79], v[232:235]
v_exp_f32 v32, v32
v_mfma_f32_16x16x32_bf16 v[236:239], a[44:47], v[76:79], v[236:239]
v_exp_f32 v33, v33
v_mfma_f32_16x16x32_bf16 v[204:207], a[44:47], v[72:75], v[204:207]
ds_read_b128 a[16:19], v1 offset:28672
v_cvt_pk_bf16_f32 v50, v32, v33
v_mfma_f32_16x16x32_bf16 v[172:175], a[44:47], v[68:71], v[172:175]
v_exp_f32 v34, v34
v_mfma_f32_16x16x32_bf16 v[140:143], a[44:47], v[64:67], v[140:143]
buffer_load_dwordx4 v3, s[48:51], s7 offen offset:1024 sc1 lds
v_mfma_f32_16x16x32_bf16 v[144:147], a[48:51], v[64:67], v[144:147]
ds_read_b128 a[20:23], v1 offset:29696
v_mfma_f32_16x16x32_bf16 v[176:179], a[48:51], v[68:71], v[176:179]
v_mfma_f32_16x16x32_bf16 v[208:211], a[48:51], v[72:75], v[208:211]
v_exp_f32 v35, v35
v_mfma_f32_16x16x32_bf16 v[240:243], a[48:51], v[76:79], v[240:243]
ds_read_b128 a[24:27], v1 offset:30720
v_cvt_pk_bf16_f32 v51, v34, v35
v_mfma_f32_16x16x32_bf16 v[244:247], a[52:55], v[76:79], v[244:247]
v_exp_f32 v36, v36
v_mfma_f32_16x16x32_bf16 v[212:215], a[52:55], v[72:75], v[212:215]
v_exp_f32 v37, v37
v_mfma_f32_16x16x32_bf16 v[180:183], a[52:55], v[68:71], v[180:183]
ds_read_b128 a[28:31], v1 offset:31744
v_cvt_pk_bf16_f32 v54, v36, v37
v_mfma_f32_16x16x32_bf16 v[148:151], a[52:55], v[64:67], v[148:151]
v_mfma_f32_16x16x32_bf16 v[152:155], a[56:59], v[64:67], v[152:155]
v_exp_f32 v38, v38
v_mfma_f32_16x16x32_bf16 v[184:187], a[56:59], v[68:71], v[184:187]
v_exp_f32 v39, v39
v_mfma_f32_16x16x32_bf16 v[216:219], a[56:59], v[72:75], v[216:219]
buffer_load_dwordx4 v3, s[48:51], s7 offen offset:2048 sc1 lds
v_mfma_f32_16x16x32_bf16 v[248:251], a[56:59], v[76:79], v[248:251]
ds_read_b128 a[32:35], v1 offset:16384
v_cvt_pk_bf16_f32 v55, v38, v39
v_mfma_f32_16x16x32_bf16 v[252:255], a[60:63], v[76:79], v[252:255]
v_exp_f32 v40, v40
v_mfma_f32_16x16x32_bf16 v[220:223], a[60:63], v[72:75], v[220:223]
ds_read_b128 a[36:39], v1 offset:17408
v_mfma_f32_16x16x32_bf16 v[188:191], a[60:63], v[68:71], v[188:191]
v_mfma_f32_16x16x32_bf16 v[156:159], a[60:63], v[64:67], v[156:159]
v_exp_f32 v41, v41
v_smfmac_f32_16x16x64_bf16 a[224:227], a[232:235], v[64:71], v9
ds_read_b128 a[40:43], v1 offset:18432
v_cvt_pk_bf16_f32 v58, v40, v41
v_smfmac_f32_16x16x64_bf16 a[228:231], a[232:235], v[72:79], v9
s_waitcnt lgkmcnt(7)
v_exp_f32 v42, v42
v_mfma_f32_16x16x32_bf16 v[20:23], a[0:3], a[176:179], v[84:87]
s_mov_b32 s9, 0x400000
v_exp_f32 v43, v43
v_mfma_f32_16x16x32_bf16 v[20:23], a[4:7], a[180:183], v[20:23]
ds_read_b128 a[44:47], v1 offset:19456
v_cvt_pk_bf16_f32 v59, v42, v43
v_mfma_f32_16x16x32_bf16 v[20:23], a[8:11], a[184:187], v[20:23]
buffer_load_dword a244, v8, s[64:67], s9 offen
v_mfma_f32_16x16x32_bf16 v[20:23], a[12:15], a[188:191], v[20:23]
v_mfma_f32_16x16x32_bf16 v[24:27], a[0:3], a[192:195], v[88:91]
v_exp_f32 v44, v44
v_mfma_f32_16x16x32_bf16 v[24:27], a[4:7], a[196:199], v[24:27]
ds_read_b128 a[48:51], v1 offset:20480
v_mfma_f32_16x16x32_bf16 v[24:27], a[8:11], a[200:203], v[24:27]
v_exp_f32 v45, v45
v_mfma_f32_16x16x32_bf16 v[24:27], a[12:15], a[204:207], v[24:27]
v_exp_f32 v46, v46
v_mfma_f32_16x16x32_bf16 v[28:31], a[0:3], a[208:211], v[92:95]
ds_read_b128 a[52:55], v1 offset:21504
v_cvt_pk_bf16_f32 v62, v44, v45
v_mfma_f32_16x16x32_bf16 v[28:31], a[4:7], a[212:215], v[28:31]
v_mfma_f32_16x16x32_bf16 v[28:31], a[8:11], a[216:219], v[28:31]
s_waitcnt lgkmcnt(6)
v_exp_f32 v47, v47
v_mfma_f32_16x16x32_bf16 v[28:31], a[12:15], a[220:223], v[28:31]
ds_read_b128 a[56:59], v1 offset:22528
v_cvt_pk_bf16_f32 v63, v46, v47
v_mfma_f32_16x16x32_bf16 v[36:39], a[16:19], a[176:179], v[84:87]
buffer_load_dwordx4 v3, s[48:51], s7 offen offset:3072 sc1 lds
v_mfma_f32_16x16x32_bf16 v[36:39], a[20:23], a[180:183], v[36:39]
s_add_u32 s32, s32, 0x8000
v_exp_f32 v20, v20
v_mfma_f32_16x16x32_bf16 v[36:39], a[24:27], a[184:187], v[36:39]
ds_read_b128 a[60:63], v1 offset:23552
v_xor_b32 v1, 0x8000, v1
v_mfma_f32_16x16x32_bf16 v[36:39], a[28:31], a[188:191], v[36:39]
s_add_u32 s7, s7, 0x8000
v_exp_f32 v21, v21
v_mfma_f32_16x16x32_bf16 v[40:43], a[16:19], a[192:195], v[88:91]
s_xor_b32 s27, s27, 0x38000
v_cvt_pk_bf16_f32 v68, v20, v21
v_mfma_f32_16x16x32_bf16 v[40:43], a[20:23], a[196:199], v[40:43]
v_exp_f32 v22, v22
v_mfma_f32_16x16x32_bf16 v[40:43], a[24:27], a[200:203], v[40:43]
v_exp_f32 v23, v23
v_mfma_f32_16x16x32_bf16 v[40:43], a[28:31], a[204:207], v[40:43]
v_exp_f32 v24, v24
v_mfma_f32_16x16x32_bf16 v[44:47], a[16:19], a[208:211], v[92:95]
v_exp_f32 v25, v25
v_mfma_f32_16x16x32_bf16 v[44:47], a[20:23], a[212:215], v[44:47]
v_exp_f32 v26, v26
v_mfma_f32_16x16x32_bf16 v[44:47], a[24:27], a[216:219], v[44:47]
s_waitcnt vmcnt(19) lgkmcnt(0)
v_exp_f32 v27, v27
v_mfma_f32_16x16x32_bf16 v[44:47], a[28:31], a[220:223], v[44:47]
s_barrier
v_cvt_pk_bf16_f32 v69, v22, v23
L_att_l1_0:
v_mfma_f32_16x16x32_bf16 v[128:131], a[32:35], v[48:51], v[128:131]
ds_read_b128 a[0:3], v2 offset:8192
v_cvt_pk_bf16_f32 v72, v24, v25
v_mfma_f32_16x16x32_bf16 v[160:163], a[32:35], v[52:55], v[160:163]
s_lshr_b32 s44, s2, 6
v_exp_f32 v28, v28
v_mfma_f32_16x16x32_bf16 v[192:195], a[32:35], v[56:59], v[192:195]
s_add_u32 m0, s19, 0x0
s_lshl_b32 s45, s44, 1
v_cvt_pk_bf16_f32 v73, v26, v27
v_mfma_f32_16x16x32_bf16 v[224:227], a[32:35], v[60:63], v[224:227]
ds_read_b128 a[4:7], v2 offset:9216
s_add_u32 s45, s45, s100
v_mfma_f32_16x16x32_bf16 v[228:231], a[36:39], v[60:63], v[228:231]
buffer_load_dwordx4 v3, s[48:51], s32 offen offset:0 sc1 lds
v_mfma_f32_16x16x32_bf16 v[196:199], a[36:39], v[56:59], v[196:199]
s_and_b32 s60, s45, 3
v_exp_f32 v29, v29
v_mfma_f32_16x16x32_bf16 v[164:167], a[36:39], v[52:55], v[164:167]
ds_read_b128 a[8:11], v2 offset:10240
v_cvt_pk_bf16_f32 v76, v28, v29
v_mfma_f32_16x16x32_bf16 v[132:135], a[36:39], v[48:51], v[132:135]
s_sub_u32 s60, s60, s44
v_exp_f32 v30, v30
v_mfma_f32_16x16x32_bf16 v[136:139], a[40:43], v[48:51], v[136:139]
s_add_u32 s60, s60, 4
s_lshl_b32 s60, s60, 14
s_and_b32 s60, s60, 0x7c000
v_mfma_f32_16x16x32_bf16 v[168:171], a[40:43], v[52:55], v[168:171]
ds_read_b128 a[12:15], v2 offset:11264
s_lshl_b32 s61, s60, 3
v_mfma_f32_16x16x32_bf16 v[200:203], a[40:43], v[56:59], v[200:203]
s_add_u32 s62, s61, s12
v_exp_f32 v31, v31
v_mfma_f32_16x16x32_bf16 v[232:235], a[40:43], v[60:63], v[232:235]
s_mul_i32 s44, s44, -8
v_exp_f32 v36, v36
v_mfma_f32_16x16x32_bf16 v[236:239], a[44:47], v[60:63], v[236:239]
s_mov_b32 s9, 0x200000
s_lshl_b32 s44, 4, s44
v_cvt_pk_bf16_f32 v77, v30, v31
v_mfma_f32_16x16x32_bf16 v[204:207], a[44:47], v[56:59], v[204:207]
ds_read_b128 a[16:19], v2 offset:12288
s_mul_i32 s45, s45, -8
v_mfma_f32_16x16x32_bf16 v[172:175], a[44:47], v[52:55], v[172:175]
buffer_load_dword a244, v8, s[64:67], s9 offen
v_mfma_f32_16x16x32_bf16 v[140:143], a[44:47], v[48:51], v[140:143]
s_lshl_b32 s45, 4, s45
v_exp_f32 v37, v37
v_mfma_f32_16x16x32_bf16 v[144:147], a[48:51], v[48:51], v[144:147]
ds_read_b128 a[20:23], v2 offset:13312
v_cvt_pk_bf16_f32 v70, v36, v37
v_mfma_f32_16x16x32_bf16 v[176:179], a[48:51], v[52:55], v[176:179]
s_add_u32 s44, s44, 0x21212121
v_exp_f32 v38, v38
v_mfma_f32_16x16x32_bf16 v[208:211], a[48:51], v[56:59], v[208:211]
s_sub_u32 s44, s44, s45
s_bfe_u32 s56, s44, 0x80000
s_lshl_b32 s56, s56, 14
v_mfma_f32_16x16x32_bf16 v[240:243], a[48:51], v[60:63], v[240:243]
ds_read_b128 a[24:27], v2 offset:14336
s_bfe_u32 s57, s44, 0x80008
v_mfma_f32_16x16x32_bf16 v[244:247], a[52:55], v[60:63], v[244:247]
s_lshl_b32 s57, s57, 14
v_exp_f32 v39, v39
v_mfma_f32_16x16x32_bf16 v[212:215], a[52:55], v[56:59], v[212:215]
s_bfe_u32 s58, s44, 0x80010
v_exp_f32 v40, v40
v_mfma_f32_16x16x32_bf16 v[180:183], a[52:55], v[52:55], v[180:183]
s_lshl_b32 s58, s58, 14
s_bfe_u32 s59, s44, 0x80018
v_cvt_pk_bf16_f32 v71, v38, v39
v_mfma_f32_16x16x32_bf16 v[148:151], a[52:55], v[48:51], v[148:151]
buffer_load_dwordx4 v3, s[48:51], s32 offen offset:1024 sc1 lds
v_mfma_f32_16x16x32_bf16 v[152:155], a[56:59], v[48:51], v[152:155]
ds_read_b128 a[28:31], v2 offset:15360
s_lshl_b32 s59, s59, 14
v_mfma_f32_16x16x32_bf16 v[184:187], a[56:59], v[52:55], v[184:187]
v_exp_f32 v41, v41
v_mfma_f32_16x16x32_bf16 v[216:219], a[56:59], v[56:59], v[216:219]
ds_read_b128 a[32:35], v2 offset:0
v_cvt_pk_bf16_f32 v74, v40, v41
v_mfma_f32_16x16x32_bf16 v[248:251], a[56:59], v[60:63], v[248:251]
v_exp_f32 v42, v42
v_mfma_f32_16x16x32_bf16 v[252:255], a[60:63], v[60:63], v[252:255]
v_mfma_f32_16x16x32_bf16 v[220:223], a[60:63], v[56:59], v[220:223]
ds_read_b128 a[36:39], v2 offset:1024
v_mfma_f32_16x16x32_bf16 v[188:191], a[60:63], v[52:55], v[188:191]
v_exp_f32 v43, v43
v_mfma_f32_16x16x32_bf16 v[156:159], a[60:63], v[48:51], v[156:159]
s_waitcnt lgkmcnt(6)
v_exp_f32 v44, v44
v_smfmac_f32_16x16x64_bf16 a[224:227], a[232:235], v[48:55], v9
buffer_load_dwordx4 v3, s[48:51], s32 offen offset:2048 sc1 lds
v_smfmac_f32_16x16x64_bf16 a[228:231], a[232:235], v[56:63], v9
ds_read_b128 a[40:43], v2 offset:2048
v_cvt_pk_bf16_f32 v75, v42, v43
v_mfma_f32_16x16x32_bf16 v[20:23], a[0:3], a[176:179], v[84:87]
v_mfma_f32_16x16x32_bf16 v[20:23], a[4:7], a[180:183], v[20:23]
v_exp_f32 v45, v45
v_mfma_f32_16x16x32_bf16 v[20:23], a[8:11], a[184:187], v[20:23]
ds_read_b128 a[44:47], v2 offset:3072
v_cvt_pk_bf16_f32 v78, v44, v45
v_mfma_f32_16x16x32_bf16 v[20:23], a[12:15], a[188:191], v[20:23]
v_exp_f32 v46, v46
v_mfma_f32_16x16x32_bf16 v[24:27], a[0:3], a[192:195], v[88:91]
v_mfma_f32_16x16x32_bf16 v[24:27], a[4:7], a[196:199], v[24:27]
ds_read_b128 a[48:51], v2 offset:4096
v_mfma_f32_16x16x32_bf16 v[24:27], a[8:11], a[200:203], v[24:27]
v_exp_f32 v47, v47
v_mfma_f32_16x16x32_bf16 v[24:27], a[12:15], a[204:207], v[24:27]
s_nop 0
v_exp_f32 v20, v20
v_mfma_f32_16x16x32_bf16 v[28:31], a[0:3], a[208:211], v[92:95]
buffer_load_dwordx4 v3, s[48:51], s32 offen offset:3072 sc1 lds
v_mfma_f32_16x16x32_bf16 v[28:31], a[4:7], a[212:215], v[28:31]
ds_read_b128 a[52:55], v2 offset:5120
v_cvt_pk_bf16_f32 v79, v46, v47
v_mfma_f32_16x16x32_bf16 v[28:31], a[8:11], a[216:219], v[28:31]
v_mfma_f32_16x16x32_bf16 v[28:31], a[12:15], a[220:223], v[28:31]
s_waitcnt lgkmcnt(6)
v_exp_f32 v21, v21
v_mfma_f32_16x16x32_bf16 v[36:39], a[16:19], a[176:179], v[84:87]
ds_read_b128 a[56:59], v2 offset:6144
v_cvt_pk_bf16_f32 v52, v20, v21
v_mfma_f32_16x16x32_bf16 v[36:39], a[20:23], a[180:183], v[36:39]
v_exp_f32 v22, v22
v_mfma_f32_16x16x32_bf16 v[36:39], a[24:27], a[184:187], v[36:39]
v_mfma_f32_16x16x32_bf16 v[36:39], a[28:31], a[188:191], v[36:39]
ds_read_b128 a[60:63], v2 offset:7168
v_mfma_f32_16x16x32_bf16 v[40:43], a[16:19], a[192:195], v[88:91]
s_mov_b32 s9, 0x600000
v_exp_f32 v23, v23
v_mfma_f32_16x16x32_bf16 v[40:43], a[20:23], a[196:199], v[40:43]
buffer_load_dword a244, v8, s[64:67], s9 offen
v_mfma_f32_16x16x32_bf16 v[40:43], a[24:27], a[200:203], v[40:43]
v_exp_f32 v24, v24
v_mfma_f32_16x16x32_bf16 v[40:43], a[28:31], a[204:207], v[40:43]
v_cvt_pk_bf16_f32 v53, v22, v23
v_mfma_f32_16x16x32_bf16 v[44:47], a[16:19], a[208:211], v[92:95]
v_exp_f32 v25, v25
v_mfma_f32_16x16x32_bf16 v[44:47], a[20:23], a[212:215], v[44:47]
v_exp_f32 v26, v26
v_mfma_f32_16x16x32_bf16 v[44:47], a[24:27], a[216:219], v[44:47]
v_exp_f32 v27, v27
v_mfma_f32_16x16x32_bf16 v[44:47], a[28:31], a[220:223], v[44:47]
s_waitcnt lgkmcnt(0)
v_mfma_f32_16x16x32_bf16 v[160:163], a[32:35], v[68:71], v[160:163]
ds_read_b128 a[0:3], v2 offset:24576
v_cvt_pk_bf16_f32 v56, v24, v25
v_mfma_f32_16x16x32_bf16 v[192:195], a[32:35], v[72:75], v[192:195]
v_exp_f32 v28, v28
v_mfma_f32_16x16x32_bf16 v[224:227], a[32:35], v[76:79], v[224:227]
ds_read_b128 a[4:7], v2 offset:25600
v_cvt_pk_bf16_f32 v57, v26, v27
v_mfma_f32_16x16x32_bf16 v[228:231], a[36:39], v[76:79], v[228:231]
s_add_u32 m0, s19, 0x1000
v_mfma_f32_16x16x32_bf16 v[196:199], a[36:39], v[72:75], v[196:199]
buffer_load_dwordx4 v3, s[48:51], s7 offen offset:0 sc1 lds
v_mfma_f32_16x16x32_bf16 v[164:167], a[36:39], v[68:71], v[164:167]
ds_read_b128 a[8:11], v2 offset:26624
v_mfma_f32_16x16x32_bf16 v[168:171], a[40:43], v[68:71], v[168:171]
v_exp_f32 v29, v29
v_mfma_f32_16x16x32_bf16 v[200:203], a[40:43], v[72:75], v[200:203]
v_exp_f32 v30, v30
v_mfma_f32_16x16x32_bf16 v[232:235], a[40:43], v[76:79], v[232:235]
ds_read_b128 a[12:15], v2 offset:27648
v_cvt_pk_bf16_f32 v60, v28, v29
v_mfma_f32_16x16x32_bf16 v[236:239], a[44:47], v[76:79], v[236:239]
v_exp_f32 v31, v31
v_mfma_f32_16x16x32_bf16 v[204:207], a[44:47], v[72:75], v[204:207]
v_exp_f32 v36, v36
v_mfma_f32_16x16x32_bf16 v[172:175], a[44:47], v[68:71], v[172:175]
ds_read_b128 a[16:19], v2 offset:28672
v_cvt_pk_bf16_f32 v61, v30, v31
v_mfma_f32_16x16x32_bf16 v[176:179], a[48:51], v[68:71], v[176:179]
buffer_load_dwordx4 v3, s[48:51], s7 offen offset:1024 sc1 lds
v_mfma_f32_16x16x32_bf16 v[208:211], a[48:51], v[72:75], v[208:211]
ds_read_b128 a[20:23], v2 offset:29696
v_mfma_f32_16x16x32_bf16 v[240:243], a[48:51], v[76:79], v[240:243]
v_mfma_f32_16x16x32_bf16 v[244:247], a[52:55], v[76:79], v[244:247]
v_exp_f32 v37, v37
v_mfma_f32_16x16x32_bf16 v[212:215], a[52:55], v[72:75], v[212:215]
ds_read_b128 a[24:27], v2 offset:30720
v_cvt_pk_bf16_f32 v54, v36, v37
v_mfma_f32_16x16x32_bf16 v[180:183], a[52:55], v[68:71], v[180:183]
v_exp_f32 v38, v38
v_mfma_f32_16x16x32_bf16 v[184:187], a[56:59], v[68:71], v[184:187]
v_exp_f32 v39, v39
v_mfma_f32_16x16x32_bf16 v[216:219], a[56:59], v[72:75], v[216:219]
ds_read_b128 a[28:31], v2 offset:31744
v_cvt_pk_bf16_f32 v55, v38, v39
v_mfma_f32_16x16x32_bf16 v[248:251], a[56:59], v[76:79], v[248:251]
v_exp_f32 v40, v40
v_mfma_f32_16x16x32_bf16 v[252:255], a[60:63], v[76:79], v[252:255]
buffer_load_dwordx4 v3, s[48:51], s7 offen offset:2048 sc1 lds
v_mfma_f32_16x16x32_bf16 v[220:223], a[60:63], v[72:75], v[220:223]
ds_read_b128 a[32:35], v2 offset:16384
v_mfma_f32_16x16x32_bf16 v[188:191], a[60:63], v[68:71], v[188:191]
v_exp_f32 v41, v41
v_mfma_f32_16x16x32_bf16 a[224:227], a[236:239], v[68:71], a[224:227]
ds_read_b128 a[36:39], v2 offset:17408
v_cvt_pk_bf16_f32 v58, v40, v41
v_smfmac_f32_16x16x64_bf16 a[228:231], a[232:235], v[72:79], v9
s_waitcnt lgkmcnt(6)
v_exp_f32 v42, v42
v_mfma_f32_16x16x32_bf16 v[20:23], a[0:3], a[176:179], v[104:107]
v_exp_f32 v43, v43
v_mfma_f32_16x16x32_bf16 v[20:23], a[4:7], a[180:183], v[20:23]
ds_read_b128 a[40:43], v2 offset:18432
v_cvt_pk_bf16_f32 v59, v42, v43
v_mfma_f32_16x16x32_bf16 v[20:23], a[8:11], a[184:187], v[20:23]
v_exp_f32 v44, v44
v_mfma_f32_16x16x32_bf16 v[20:23], a[12:15], a[188:191], v[20:23]
buffer_load_dwordx4 v3, s[48:51], s7 offen offset:3072 sc1 lds
v_mfma_f32_16x16x32_bf16 v[24:27], a[0:3], a[192:195], v[88:91]
ds_read_b128 a[44:47], v2 offset:19456
v_mfma_f32_16x16x32_bf16 v[24:27], a[4:7], a[196:199], v[24:27]
v_exp_f32 v45, v45
v_mfma_f32_16x16x32_bf16 v[24:27], a[8:11], a[200:203], v[24:27]
v_exp_f32 v46, v46
v_mfma_f32_16x16x32_bf16 v[24:27], a[12:15], a[204:207], v[24:27]
ds_read_b128 a[48:51], v2 offset:20480
v_add_u32 v4, s0, v3
v_mfma_f32_16x16x32_bf16 v[28:31], a[0:3], a[208:211], v[92:95]
v_cvt_pk_bf16_f32 v62, v44, v45
v_mfma_f32_16x16x32_bf16 v[28:31], a[4:7], a[212:215], v[28:31]
ds_read_b128 a[52:55], v2 offset:21504
v_mov_b32 v5, s1
v_mfma_f32_16x16x32_bf16 v[28:31], a[8:11], a[216:219], v[28:31]
s_waitcnt lgkmcnt(6)
v_exp_f32 v47, v47
v_mfma_f32_16x16x32_bf16 v[28:31], a[12:15], a[220:223], v[28:31]
global_load_dword a244, v[4:5], off sc1
v_mfma_f32_16x16x32_bf16 v[36:39], a[16:19], a[176:179], v[108:111]
ds_read_b128 a[56:59], v2 offset:22528
v_cvt_pk_bf16_f32 v63, v46, v47
v_mfma_f32_16x16x32_bf16 v[36:39], a[20:23], a[180:183], v[36:39]
s_add_u32 s32, s32, 0x8000
v_exp_f32 v20, v20
v_mfma_f32_16x16x32_bf16 v[36:39], a[24:27], a[184:187], v[36:39]
s_add_u32 s7, s7, 0x8000
v_exp_f32 v21, v21
v_mfma_f32_16x16x32_bf16 v[36:39], a[28:31], a[188:191], v[36:39]
ds_read_b128 a[60:63], v2 offset:23552
v_xor_b32 v2, 0x38000, v2
v_mfma_f32_16x16x32_bf16 v[40:43], a[16:19], a[192:195], v[88:91]
s_xor_b32 s19, s19, 0x8000
v_exp_f32 v22, v22
v_mfma_f32_16x16x32_bf16 v[40:43], a[20:23], a[196:199], v[40:43]
s_sub_u32 s15, 7, s6
v_exp_f32 v23, v23
v_mfma_f32_16x16x32_bf16 v[40:43], a[24:27], a[200:203], v[40:43]
s_lshl_b32 s15, s15, 1
v_exp_f32 v24, v24
v_mfma_f32_16x16x32_bf16 v[40:43], a[28:31], a[204:207], v[40:43]
v_exp_f32 v25, v25
v_mfma_f32_16x16x32_bf16 v[44:47], a[16:19], a[208:211], v[92:95]
v_exp_f32 v26, v26
v_mfma_f32_16x16x32_bf16 v[44:47], a[20:23], a[212:215], v[44:47]
v_exp_f32 v27, v27
v_mfma_f32_16x16x32_bf16 v[44:47], a[24:27], a[216:219], v[44:47]
s_waitcnt vmcnt(22) lgkmcnt(0)
v_cvt_pk_bf16_f32 v68, v20, v21
v_cvt_pk_bf16_f32 v69, v22, v23
v_mfma_f32_16x16x32_bf16 v[44:47], a[28:31], a[220:223], v[44:47]
s_barrier
s_cbranch_scc0 L_att_lh0_0
v_mfma_f32_16x16x32_bf16 v[160:163], a[32:35], v[52:55], v[160:163]
ds_read_b128 a[0:3], v1 offset:8192
v_cvt_pk_bf16_f32 v72, v24, v25
v_mfma_f32_16x16x32_bf16 v[192:195], a[32:35], v[56:59], v[192:195]
v_exp_f32 v28, v28
v_mfma_f32_16x16x32_bf16 v[224:227], a[32:35], v[60:63], v[224:227]
ds_read_b128 a[4:7], v1 offset:9216
v_cvt_pk_bf16_f32 v73, v26, v27
v_mfma_f32_16x16x32_bf16 v[228:231], a[36:39], v[60:63], v[228:231]
s_add_u32 m0, s27, 0x0
v_exp_f32 v29, v29
v_mfma_f32_16x16x32_bf16 v[196:199], a[36:39], v[56:59], v[196:199]
buffer_load_dwordx4 v3, s[48:51], s32 offen offset:0 sc1 lds
v_mfma_f32_16x16x32_bf16 v[164:167], a[36:39], v[52:55], v[164:167]
ds_read_b128 a[8:11], v1 offset:10240
v_cvt_pk_bf16_f32 v76, v28, v29
v_mfma_f32_16x16x32_bf16 v[168:171], a[40:43], v[52:55], v[168:171]
ds_read_b128 a[12:15], v1 offset:11264
v_accvgpr_read_b32 v6, a224
v_mfma_f32_16x16x32_bf16 v[200:203], a[40:43], v[56:59], v[200:203]
v_exp_f32 v30, v30
v_mfma_f32_16x16x32_bf16 v[232:235], a[40:43], v[60:63], v[232:235]
v_exp_f32 v31, v31
v_mfma_f32_16x16x32_bf16 v[236:239], a[44:47], v[60:63], v[236:239]
ds_read_b128 a[16:19], v1 offset:12288
v_cvt_pk_bf16_f32 v77, v30, v31
v_mfma_f32_16x16x32_bf16 v[204:207], a[44:47], v[56:59], v[204:207]
v_exp_f32 v36, v36
v_mfma_f32_16x16x32_bf16 v[172:175], a[44:47], v[52:55], v[172:175]
ds_read_b128 a[20:23], v1 offset:13312
v_accvgpr_read_b32 v7, a225
v_mfma_f32_16x16x32_bf16 v[176:179], a[48:51], v[52:55], v[176:179]
v_exp_f32 v37, v37
v_mfma_f32_16x16x32_bf16 v[208:211], a[48:51], v[56:59], v[208:211]
ds_read_b128 a[24:27], v1 offset:14336
v_cvt_pk_bf16_f32 v70, v36, v37
v_mfma_f32_16x16x32_bf16 v[240:243], a[48:51], v[60:63], v[240:243]
buffer_load_dwordx4 v3, s[48:51], s32 offen offset:1024 sc1 lds
v_mfma_f32_16x16x32_bf16 v[244:247], a[52:55], v[60:63], v[244:247]
v_exp_f32 v38, v38
v_mfma_f32_16x16x32_bf16 v[212:215], a[52:55], v[56:59], v[212:215]
ds_read_b128 a[28:31], v1 offset:15360
v_add_f32 v6, v6, v7
v_mfma_f32_16x16x32_bf16 v[180:183], a[52:55], v[52:55], v[180:183]
v_exp_f32 v39, v39
v_mfma_f32_16x16x32_bf16 v[184:187], a[56:59], v[52:55], v[184:187]
ds_read_b128 a[32:35], v1 offset:0
v_cvt_pk_bf16_f32 v71, v38, v39
v_mfma_f32_16x16x32_bf16 v[216:219], a[56:59], v[56:59], v[216:219]
v_exp_f32 v40, v40
v_mfma_f32_16x16x32_bf16 v[248:251], a[56:59], v[60:63], v[248:251]
ds_read_b128 a[36:39], v1 offset:1024
v_cmp_nge_f32 vcc, 0x5f800000, v6
v_mfma_f32_16x16x32_bf16 v[252:255], a[60:63], v[60:63], v[252:255]
v_exp_f32 v41, v41
v_mfma_f32_16x16x32_bf16 v[220:223], a[60:63], v[56:59], v[220:223]
v_exp_f32 v42, v42
v_mfma_f32_16x16x32_bf16 v[188:191], a[60:63], v[52:55], v[188:191]
ds_read_b128 a[40:43], v1 offset:2048
v_cvt_pk_bf16_f32 v74, v40, v41
v_mfma_f32_16x16x32_bf16 a[224:227], a[236:239], v[52:55], a[224:227]
buffer_load_dwordx4 v3, s[48:51], s32 offen offset:2048 sc1 lds
v_smfmac_f32_16x16x64_bf16 a[228:231], a[232:235], v[56:63], v9
ds_read_b128 a[44:47], v1 offset:3072
s_waitcnt lgkmcnt(8)
v_mfma_f32_16x16x32_bf16 v[24:27], a[0:3], a[192:195], v[88:91]
v_exp_f32 v43, v43
v_mfma_f32_16x16x32_bf16 v[24:27], a[4:7], a[196:199], v[24:27]
ds_read_b128 a[48:51], v1 offset:4096
v_cvt_pk_bf16_f32 v75, v42, v43
v_mfma_f32_16x16x32_bf16 v[24:27], a[8:11], a[200:203], v[24:27]
v_exp_f32 v44, v44
v_mfma_f32_16x16x32_bf16 v[24:27], a[12:15], a[204:207], v[24:27]
v_exp_f32 v45, v45
v_mfma_f32_16x16x32_bf16 v[28:31], a[0:3], a[208:211], v[92:95]
ds_read_b128 a[52:55], v1 offset:5120
v_cvt_pk_bf16_f32 v78, v44, v45
v_mfma_f32_16x16x32_bf16 v[28:31], a[4:7], a[212:215], v[28:31]
v_exp_f32 v46, v46
v_mfma_f32_16x16x32_bf16 v[28:31], a[8:11], a[216:219], v[28:31]
ds_read_b128 a[56:59], v1 offset:6144
v_mfma_f32_16x16x32_bf16 v[28:31], a[12:15], a[220:223], v[28:31]
s_waitcnt lgkmcnt(7)
v_exp_f32 v47, v47
v_mfma_f32_16x16x32_bf16 v[40:43], a[16:19], a[192:195], v[88:91]
buffer_load_dwordx4 v3, s[48:51], s32 offen offset:3072 sc1 lds
v_mfma_f32_16x16x32_bf16 v[40:43], a[20:23], a[196:199], v[40:43]
ds_read_b128 a[60:63], v1 offset:7168
v_cvt_pk_bf16_f32 v79, v46, v47
v_mfma_f32_16x16x32_bf16 v[40:43], a[24:27], a[200:203], v[40:43]
s_add_u32 s32, s32, 0x8000
v_exp_f32 v24, v24
v_mfma_f32_16x16x32_bf16 v[40:43], a[28:31], a[204:207], v[40:43]
v_exp_f32 v25, v25
v_mfma_f32_16x16x32_bf16 v[44:47], a[16:19], a[208:211], v[92:95]
v_exp_f32 v26, v26
v_mfma_f32_16x16x32_bf16 v[44:47], a[20:23], a[212:215], v[44:47]
v_exp_f32 v27, v27
v_mfma_f32_16x16x32_bf16 v[44:47], a[24:27], a[216:219], v[44:47]
v_exp_f32 v28, v28
v_mfma_f32_16x16x32_bf16 v[44:47], a[28:31], a[220:223], v[44:47]
s_waitcnt lgkmcnt(0)
v_exp_f32 v29, v29
v_mfma_f32_16x16x32_bf16 v[160:163], a[32:35], v[68:71], v[160:163]
ds_read_b128 a[0:3], v1 offset:24576
v_cvt_pk_bf16_f32 v56, v24, v25
v_mfma_f32_16x16x32_bf16 v[192:195], a[32:35], v[72:75], v[192:195]
v_exp_f32 v30, v30
v_mfma_f32_16x16x32_bf16 v[224:227], a[32:35], v[76:79], v[224:227]
ds_read_b128 a[4:7], v1 offset:25600
v_cvt_pk_bf16_f32 v57, v26, v27
v_mfma_f32_16x16x32_bf16 v[228:231], a[36:39], v[76:79], v[228:231]
s_add_u32 m0, s27, 0x1000
v_cvt_pk_bf16_f32 v60, v28, v29
v_mfma_f32_16x16x32_bf16 v[196:199], a[36:39], v[72:75], v[196:199]
buffer_load_dwordx4 v3, s[48:51], s7 offen offset:0 sc1 lds
v_mfma_f32_16x16x32_bf16 v[164:167], a[36:39], v[68:71], v[164:167]
ds_read_b128 a[8:11], v1 offset:26624
v_mfma_f32_16x16x32_bf16 v[168:171], a[40:43], v[68:71], v[168:171]
ds_read_b128 a[12:15], v1 offset:27648
v_mfma_f32_16x16x32_bf16 v[200:203], a[40:43], v[72:75], v[200:203]
v_exp_f32 v31, v31
v_mfma_f32_16x16x32_bf16 v[232:235], a[40:43], v[76:79], v[232:235]
v_exp_f32 v40, v40
v_mfma_f32_16x16x32_bf16 v[236:239], a[44:47], v[76:79], v[236:239]
ds_read_b128 a[16:19], v1 offset:28672
v_cvt_pk_bf16_f32 v61, v30, v31
v_mfma_f32_16x16x32_bf16 v[204:207], a[44:47], v[72:75], v[204:207]
v_exp_f32 v41, v41
v_mfma_f32_16x16x32_bf16 v[172:175], a[44:47], v[68:71], v[172:175]
ds_read_b128 a[20:23], v1 offset:29696
v_cvt_pk_bf16_f32 v58, v40, v41
v_mfma_f32_16x16x32_bf16 v[176:179], a[48:51], v[68:71], v[176:179]
v_rcp_f32 v6, v6
v_mfma_f32_16x16x32_bf16 v[208:211], a[48:51], v[72:75], v[208:211]
buffer_load_dwordx4 v3, s[48:51], s7 offen offset:1024 sc1 lds
v_mfma_f32_16x16x32_bf16 v[240:243], a[48:51], v[76:79], v[240:243]
ds_read_b128 a[24:27], v1 offset:30720
s_or_b64 s[34:35], s[34:35], vcc
v_mfma_f32_16x16x32_bf16 v[244:247], a[52:55], v[76:79], v[244:247]
ds_read_b128 a[28:31], v1 offset:31744
s_add_u32 s8, s28, 0x0
v_mfma_f32_16x16x32_bf16 v[212:215], a[52:55], v[72:75], v[212:215]
v_exp_f32 v42, v42
v_mfma_f32_16x16x32_bf16 v[180:183], a[52:55], v[68:71], v[180:183]
v_exp_f32 v43, v43
v_mfma_f32_16x16x32_bf16 v[184:187], a[56:59], v[68:71], v[184:187]
ds_read_b128 a[32:35], v1 offset:16384
v_cvt_pk_bf16_f32 v59, v42, v43
v_mfma_f32_16x16x32_bf16 v[216:219], a[56:59], v[72:75], v[216:219]
v_exp_f32 v44, v44
v_mfma_f32_16x16x32_bf16 v[248:251], a[56:59], v[76:79], v[248:251]
ds_read_b128 a[36:39], v1 offset:17408
v_mul_f32 v128, v6, v128
v_mfma_f32_16x16x32_bf16 v[252:255], a[60:63], v[76:79], v[252:255]
v_mul_f32 v129, v6, v129
v_mul_f32 v130, v6, v130
v_mfma_f32_16x16x32_bf16 v[220:223], a[60:63], v[72:75], v[220:223]
ds_read_b128 a[40:43], v1 offset:18432
v_mul_f32 v131, v6, v131
v_mfma_f32_16x16x32_bf16 v[188:191], a[60:63], v[68:71], v[188:191]
buffer_load_dwordx4 v3, s[48:51], s7 offen offset:2048 sc1 lds
v_mfma_f32_16x16x32_bf16 a[224:227], a[236:239], v[68:71], a[224:227]
ds_read_b128 a[44:47], v1 offset:19456
v_mul_f32 v132, v6, v132
v_smfmac_f32_16x16x64_bf16 a[228:231], a[232:235], v[72:79], v9
s_waitcnt lgkmcnt(8)
v_exp_f32 v45, v45
v_mfma_f32_16x16x32_bf16 v[24:27], a[0:3], a[192:195], v[88:91]
v_exp_f32 v46, v46
v_mfma_f32_16x16x32_bf16 v[24:27], a[4:7], a[196:199], v[24:27]
ds_read_b128 a[48:51], v1 offset:20480
v_cvt_pk_bf16_f32 v62, v44, v45
v_mfma_f32_16x16x32_bf16 v[24:27], a[8:11], a[200:203], v[24:27]
v_exp_f32 v47, v47
v_mfma_f32_16x16x32_bf16 v[24:27], a[12:15], a[204:207], v[24:27]
ds_read_b128 a[52:55], v1 offset:21504
v_cvt_pk_bf16_f32 v63, v46, v47
v_mfma_f32_16x16x32_bf16 v[28:31], a[0:3], a[208:211], v[92:95]
v_mul_f32 v133, v6, v133
v_mul_f32 v134, v6, v134
v_mfma_f32_16x16x32_bf16 v[28:31], a[4:7], a[212:215], v[28:31]
ds_read_b128 a[56:59], v1 offset:22528
v_mul_f32 v135, v6, v135
v_mfma_f32_16x16x32_bf16 v[28:31], a[8:11], a[216:219], v[28:31]
buffer_load_dwordx4 v3, s[48:51], s7 offen offset:3072 sc1 lds
v_mfma_f32_16x16x32_bf16 v[28:31], a[12:15], a[220:223], v[28:31]
ds_read_b128 a[60:63], v1 offset:23552
s_waitcnt lgkmcnt(8)
v_mfma_f32_16x16x32_bf16 v[40:43], a[16:19], a[192:195], v[88:91]
s_add_u32 s7, s7, 0x8000
v_xor_b32 v1, 0x8000, v1
v_cvt_pk_bf16_f32 v128, v128, v129
v_mfma_f32_16x16x32_bf16 v[40:43], a[20:23], a[196:199], v[40:43]
s_xor_b32 s27, s27, 0x38000
v_exp_f32 v24, v24
v_mfma_f32_16x16x32_bf16 v[40:43], a[24:27], a[200:203], v[40:43]
v_exp_f32 v25, v25
v_mfma_f32_16x16x32_bf16 v[40:43], a[28:31], a[204:207], v[40:43]
v_exp_f32 v26, v26
v_mfma_f32_16x16x32_bf16 v[44:47], a[16:19], a[208:211], v[92:95]
v_exp_f32 v27, v27
v_mfma_f32_16x16x32_bf16 v[44:47], a[20:23], a[212:215], v[44:47]
v_exp_f32 v28, v28
v_mfma_f32_16x16x32_bf16 v[44:47], a[24:27], a[216:219], v[44:47]
s_waitcnt vmcnt(19) lgkmcnt(0)
v_exp_f32 v29, v29
v_mfma_f32_16x16x32_bf16 v[44:47], a[28:31], a[220:223], v[44:47]
s_barrier
v_cvt_pk_bf16_f32 v129, v130, v131
v_cvt_pk_bf16_f32 v130, v132, v133
v_cvt_pk_bf16_f32 v131, v134, v135
buffer_store_dwordx4 v[128:131], v3, s[88:91], s8 offen sc1
s_add_u32 s8, s28, 0x2000
v_mul_f32 v136, v6, v136
v_mul_f32 v137, v6, v137
v_mul_f32 v138, v6, v138
v_mul_f32 v139, v6, v139
v_mul_f32 v140, v6, v140
v_mul_f32 v141, v6, v141
v_mul_f32 v142, v6, v142
v_mul_f32 v143, v6, v143
v_cvt_pk_bf16_f32 v136, v136, v137
v_cvt_pk_bf16_f32 v137, v138, v139
v_cvt_pk_bf16_f32 v138, v140, v141
v_cvt_pk_bf16_f32 v139, v142, v143
buffer_store_dwordx4 v[136:139], v3, s[88:91], s8 offen sc1
s_add_u32 s8, s28, 0x4000
v_mul_f32 v144, v6, v144
v_mul_f32 v145, v6, v145
v_mul_f32 v146, v6, v146
v_mul_f32 v147, v6, v147
v_mul_f32 v148, v6, v148
v_mul_f32 v149, v6, v149
v_mul_f32 v150, v6, v150
v_mul_f32 v151, v6, v151
v_cvt_pk_bf16_f32 v144, v144, v145
v_cvt_pk_bf16_f32 v145, v146, v147
v_cvt_pk_bf16_f32 v146, v148, v149
v_cvt_pk_bf16_f32 v147, v150, v151
buffer_store_dwordx4 v[144:147], v3, s[88:91], s8 offen sc1
s_add_u32 s8, s28, 0x6000
v_mul_f32 v152, v6, v152
v_mul_f32 v153, v6, v153
v_mul_f32 v154, v6, v154
v_mul_f32 v155, v6, v155
v_mul_f32 v156, v6, v156
v_mul_f32 v157, v6, v157
v_mul_f32 v158, v6, v158
v_mul_f32 v159, v6, v159
v_cvt_pk_bf16_f32 v152, v152, v153
v_cvt_pk_bf16_f32 v153, v154, v155
v_cvt_pk_bf16_f32 v154, v156, v157
v_cvt_pk_bf16_f32 v155, v158, v159
buffer_store_dwordx4 v[152:155], v3, s[88:91], s8 offen sc1
v_accvgpr_read_b32 v6, a226
v_accvgpr_read_b32 v7, a227
v_add_f32 v6, v6, v7
v_cmp_nge_f32 vcc, 0x5f800000, v6
v_rcp_f32 v6, v6
s_or_b64 s[34:35], s[34:35], vcc
s_add_u32 s8, s29, 0x0
v_pk_mul_f32 v[160:161], v[160:161], v[6:7] op_sel_hi:[1,0]
v_pk_mul_f32 v[162:163], v[162:163], v[6:7] op_sel_hi:[1,0]
v_pk_mul_f32 v[164:165], v[164:165], v[6:7] op_sel_hi:[1,0]
v_pk_mul_f32 v[166:167], v[166:167], v[6:7] op_sel_hi:[1,0]
v_cvt_pk_bf16_f32 v160, v160, v161
v_cvt_pk_bf16_f32 v161, v162, v163
v_cvt_pk_bf16_f32 v162, v164, v165
v_cvt_pk_bf16_f32 v163, v166, v167
buffer_store_dwordx4 v[160:163], v3, s[88:91], s8 offen sc1
s_add_u32 s8, s29, 0x2000
v_pk_mul_f32 v[168:169], v[168:169], v[6:7] op_sel_hi:[1,0]
v_pk_mul_f32 v[170:171], v[170:171], v[6:7] op_sel_hi:[1,0]
v_pk_mul_f32 v[172:173], v[172:173], v[6:7] op_sel_hi:[1,0]
v_pk_mul_f32 v[174:175], v[174:175], v[6:7] op_sel_hi:[1,0]
v_cvt_pk_bf16_f32 v168, v168, v169
v_cvt_pk_bf16_f32 v169, v170, v171
v_cvt_pk_bf16_f32 v170, v172, v173
v_cvt_pk_bf16_f32 v171, v174, v175
buffer_store_dwordx4 v[168:171], v3, s[88:91], s8 offen sc1
s_add_u32 s8, s29, 0x4000
v_pk_mul_f32 v[176:177], v[176:177], v[6:7] op_sel_hi:[1,0]
v_pk_mul_f32 v[178:179], v[178:179], v[6:7] op_sel_hi:[1,0]
v_pk_mul_f32 v[180:181], v[180:181], v[6:7] op_sel_hi:[1,0]
v_pk_mul_f32 v[182:183], v[182:183], v[6:7] op_sel_hi:[1,0]
v_cvt_pk_bf16_f32 v176, v176, v177
v_cvt_pk_bf16_f32 v177, v178, v179
v_cvt_pk_bf16_f32 v178, v180, v181
v_cvt_pk_bf16_f32 v179, v182, v183
buffer_store_dwordx4 v[176:179], v3, s[88:91], s8 offen sc1
s_add_u32 s8, s29, 0x6000
v_pk_mul_f32 v[184:185], v[184:185], v[6:7] op_sel_hi:[1,0]
v_pk_mul_f32 v[186:187], v[186:187], v[6:7] op_sel_hi:[1,0]
v_pk_mul_f32 v[188:189], v[188:189], v[6:7] op_sel_hi:[1,0]
v_pk_mul_f32 v[190:191], v[190:191], v[6:7] op_sel_hi:[1,0]
v_cvt_pk_bf16_f32 v184, v184, v185
v_cvt_pk_bf16_f32 v185, v186, v187
v_cvt_pk_bf16_f32 v186, v188, v189
v_cvt_pk_bf16_f32 v187, v190, v191
buffer_store_dwordx4 v[184:187], v3, s[88:91], s8 offen sc1
s_getreg_b32 s8, hwreg(HW_REG_HW_ID, 5, 1)
s_cmp_lg_u32 s8, 0
s_cbranch_scc1 L_att_sodd1
s_branch L_att_sodd0
L_att_lh0_0:
v_mfma_f32_16x16x32_bf16 v[160:163], a[32:35], v[52:55], v[160:163]
v_exp_f32 v28, v28
v_mfma_f32_16x16x32_bf16 v[192:195], a[32:35], v[56:59], v[192:195]
buffer_load_dword v14, v15, s[84:87], 0 offen offset:192 sc1
v_mfma_f32_16x16x32_bf16 v[224:227], a[32:35], v[60:63], v[224:227]
v_exp_f32 v29, v29
v_mfma_f32_16x16x32_bf16 v[228:231], a[36:39], v[60:63], v[228:231]
v_exp_f32 v30, v30
v_mfma_f32_16x16x32_bf16 v[196:199], a[36:39], v[56:59], v[196:199]
s_add_u32 m0, s17, 0x10000
v_exp_f32 v31, v31
v_mfma_f32_16x16x32_bf16 v[164:167], a[36:39], v[52:55], v[164:167]
ds_read_b128 a[0:3], v1 offset:8192
v_cvt_pk_bf16_f32 v72, v24, v25
v_mfma_f32_16x16x32_bf16 v[168:171], a[40:43], v[52:55], v[168:171]
ds_read_b128 a[4:7], v1 offset:9216
v_cvt_pk_bf16_f32 v73, v26, v27
v_mfma_f32_16x16x32_bf16 v[200:203], a[40:43], v[56:59], v[200:203]
buffer_load_dwordx4 v12, s[72:75], 0 offen lds
v_mfma_f32_16x16x32_bf16 v[232:235], a[40:43], v[60:63], v[232:235]
ds_read_b128 a[8:11], v1 offset:10240
v_cvt_pk_bf16_f32 v76, v28, v29
v_mfma_f32_16x16x32_bf16 v[236:239], a[44:47], v[60:63], v[236:239]
v_exp_f32 v36, v36
v_mfma_f32_16x16x32_bf16 v[204:207], a[44:47], v[56:59], v[204:207]
v_exp_f32 v37, v37
v_mfma_f32_16x16x32_bf16 v[172:175], a[44:47], v[52:55], v[172:175]
ds_read_b128 a[12:15], v1 offset:11264
v_cvt_pk_bf16_f32 v77, v30, v31
v_mfma_f32_16x16x32_bf16 v[176:179], a[48:51], v[52:55], v[176:179]
buffer_load_dwordx4 v13, s[72:75], 0 offen offset:1024 lds
v_mfma_f32_16x16x32_bf16 v[208:211], a[48:51], v[56:59], v[208:211]
ds_read_b128 a[16:19], v1 offset:12288
v_cvt_pk_bf16_f32 v70, v36, v37
v_mfma_f32_16x16x32_bf16 v[240:243], a[48:51], v[60:63], v[240:243]
ds_read_b128 a[20:23], v1 offset:13312
v_exp_f32 v38, v38
v_mfma_f32_16x16x32_bf16 v[244:247], a[52:55], v[60:63], v[244:247]
ds_read_b128 a[24:27], v1 offset:14336
v_exp_f32 v39, v39
v_mfma_f32_16x16x32_bf16 v[212:215], a[52:55], v[56:59], v[212:215]
v_exp_f32 v40, v40
v_mfma_f32_16x16x32_bf16 v[180:183], a[52:55], v[52:55], v[180:183]
buffer_load_dwordx4 v12, s[72:75], s12 offen offset:2048 lds
v_mfma_f32_16x16x32_bf16 v[184:187], a[56:59], v[52:55], v[184:187]
ds_read_b128 a[28:31], v1 offset:15360
v_exp_f32 v41, v41
v_mfma_f32_16x16x32_bf16 v[216:219], a[56:59], v[56:59], v[216:219]
buffer_load_dwordx4 v13, s[72:75], s12 offen offset:3072 lds
v_mfma_f32_16x16x32_bf16 v[248:251], a[56:59], v[60:63], v[248:251]
s_add_u32 m0, s17, 0x14000
v_exp_f32 v42, v42
v_mfma_f32_16x16x32_bf16 v[252:255], a[60:63], v[60:63], v[252:255]
ds_read_b128 a[32:35], v1 offset:0
v_cvt_pk_bf16_f32 v71, v38, v39
v_mfma_f32_16x16x32_bf16 v[220:223], a[60:63], v[56:59], v[220:223]
ds_read_b128 a[36:39], v1 offset:1024
v_add_u32 v12, 0x20000, v12
v_mfma_f32_16x16x32_bf16 v[188:191], a[60:63], v[52:55], v[188:191]
buffer_load_dwordx4 v12, s[72:75], 0 offen lds
v_mfma_f32_16x16x32_bf16 a[224:227], a[236:239], v[52:55], a[224:227]
ds_read_b128 a[40:43], v1 offset:2048
v_exp_f32 v43, v43
v_smfmac_f32_16x16x64_bf16 a[228:231], a[232:235], v[56:63], v9
s_waitcnt lgkmcnt(7)
v_exp_f32 v44, v44
v_mfma_f32_16x16x32_bf16 v[24:27], a[0:3], a[192:195], v[112:115]
ds_read_b128 a[44:47], v1 offset:3072
v_exp_f32 v45, v45
v_mfma_f32_16x16x32_bf16 v[24:27], a[4:7], a[196:199], v[24:27]
ds_read_b128 a[48:51], v1 offset:4096
v_add_u32 v13, 0x20000, v13
v_mfma_f32_16x16x32_bf16 v[24:27], a[8:11], a[200:203], v[24:27]
v_exp_f32 v46, v46
v_mfma_f32_16x16x32_bf16 v[24:27], a[12:15], a[204:207], v[24:27]
buffer_load_dwordx4 v13, s[72:75], 0 offen offset:1024 lds
v_mfma_f32_16x16x32_bf16 v[28:31], a[0:3], a[208:211], v[92:95]
v_exp_f32 v47, v47
v_mfma_f32_16x16x32_bf16 v[28:31], a[4:7], a[212:215], v[28:31]
ds_read_b128 a[52:55], v1 offset:5120
v_cvt_pk_bf16_f32 v74, v40, v41
v_mfma_f32_16x16x32_bf16 v[28:31], a[8:11], a[216:219], v[28:31]
ds_read_b128 a[56:59], v1 offset:6144
v_cvt_pk_bf16_f32 v75, v42, v43
v_mfma_f32_16x16x32_bf16 v[28:31], a[12:15], a[220:223], v[28:31]
s_waitcnt lgkmcnt(7)
v_exp_f32 v24, v24
v_mfma_f32_16x16x32_bf16 v[40:43], a[16:19], a[192:195], v[116:119]
buffer_load_dwordx4 v12, s[72:75], s12 offen offset:2048 lds
v_mfma_f32_16x16x32_bf16 v[40:43], a[20:23], a[196:199], v[40:43]
ds_read_b128 a[60:63], v1 offset:7168
v_cvt_pk_bf16_f32 v78, v44, v45
v_mfma_f32_16x16x32_bf16 v[40:43], a[24:27], a[200:203], v[40:43]
v_exp_f32 v25, v25
v_mfma_f32_16x16x32_bf16 v[40:43], a[28:31], a[204:207], v[40:43]
buffer_load_dwordx4 v13, s[72:75], s12 offen offset:3072 lds
v_cvt_pk_bf16_f32 v79, v46, v47
v_mfma_f32_16x16x32_bf16 v[44:47], a[16:19], a[208:211], v[92:95]
v_exp_f32 v26, v26
v_mfma_f32_16x16x32_bf16 v[44:47], a[20:23], a[212:215], v[44:47]
v_exp_f32 v27, v27
v_mfma_f32_16x16x32_bf16 v[44:47], a[24:27], a[216:219], v[44:47]
v_exp_f32 v28, v28
v_mfma_f32_16x16x32_bf16 v[44:47], a[28:31], a[220:223], v[44:47]
s_waitcnt lgkmcnt(0)
v_exp_f32 v29, v29
v_mfma_f32_16x16x32_bf16 v[160:163], a[32:35], v[68:71], v[160:163]
ds_read_b128 a[0:3], v1 offset:24576
v_cvt_pk_bf16_f32 v56, v24, v25
v_mfma_f32_16x16x32_bf16 v[192:195], a[32:35], v[72:75], v[192:195]
ds_read_b128 a[4:7], v1 offset:25600
v_add_u32 v12, 0x20000, v12
v_mfma_f32_16x16x32_bf16 v[224:227], a[32:35], v[76:79], v[224:227]
s_add_u32 m0, s16, 0x0
v_exp_f32 v30, v30
v_mfma_f32_16x16x32_bf16 v[228:231], a[36:39], v[76:79], v[228:231]
buffer_load_dwordx4 v12, s[72:75], 0 offen lds
v_mfma_f32_16x16x32_bf16 v[196:199], a[36:39], v[72:75], v[196:199]
ds_read_b128 a[8:11], v1 offset:26624
v_add_u32 v13, 0x20000, v13
v_mfma_f32_16x16x32_bf16 v[164:167], a[36:39], v[68:71], v[164:167]
buffer_load_dwordx4 v13, s[72:75], 0 offen offset:1024 lds
v_mfma_f32_16x16x32_bf16 v[168:171], a[40:43], v[68:71], v[168:171]
ds_read_b128 a[12:15], v1 offset:27648
v_cvt_pk_bf16_f32 v57, v26, v27
v_mfma_f32_16x16x32_bf16 v[200:203], a[40:43], v[72:75], v[200:203]
v_exp_f32 v31, v31
v_mfma_f32_16x16x32_bf16 v[232:235], a[40:43], v[76:79], v[232:235]
ds_read_b128 a[16:19], v1 offset:28672
v_cvt_pk_bf16_f32 v60, v28, v29
v_mfma_f32_16x16x32_bf16 v[236:239], a[44:47], v[76:79], v[236:239]
buffer_load_dwordx4 v12, s[72:75], s12 offen offset:2048 lds
v_mfma_f32_16x16x32_bf16 v[204:207], a[44:47], v[72:75], v[204:207]
ds_read_b128 a[20:23], v1 offset:29696
v_cvt_pk_bf16_f32 v61, v30, v31
v_mfma_f32_16x16x32_bf16 v[172:175], a[44:47], v[68:71], v[172:175]
buffer_load_dwordx4 v13, s[72:75], s12 offen offset:3072 lds
v_mfma_f32_16x16x32_bf16 v[176:179], a[48:51], v[68:71], v[176:179]
ds_read_b128 a[24:27], v1 offset:30720
v_mfma_f32_16x16x32_bf16 v[208:211], a[48:51], v[72:75], v[208:211]
ds_read_b128 a[28:31], v1 offset:31744
v_mfma_f32_16x16x32_bf16 v[240:243], a[48:51], v[76:79], v[240:243]
v_exp_f32 v40, v40
v_mfma_f32_16x16x32_bf16 v[244:247], a[52:55], v[76:79], v[244:247]
s_add_u32 m0, s16, 0x4000
v_exp_f32 v41, v41
v_mfma_f32_16x16x32_bf16 v[212:215], a[52:55], v[72:75], v[212:215]
ds_read_b128 a[32:35], v1 offset:16384
v_cvt_pk_bf16_f32 v58, v40, v41
v_mfma_f32_16x16x32_bf16 v[180:183], a[52:55], v[68:71], v[180:183]
ds_read_b128 a[36:39], v1 offset:17408
v_add_u32 v12, 0x20000, v12
v_mfma_f32_16x16x32_bf16 v[184:187], a[56:59], v[68:71], v[184:187]
buffer_load_dwordx4 v12, s[72:75], 0 offen lds
v_mfma_f32_16x16x32_bf16 v[216:219], a[56:59], v[72:75], v[216:219]
ds_read_b128 a[40:43], v1 offset:18432
v_mfma_f32_16x16x32_bf16 v[248:251], a[56:59], v[76:79], v[248:251]
v_exp_f32 v42, v42
v_mfma_f32_16x16x32_bf16 v[252:255], a[60:63], v[76:79], v[252:255]
ds_read_b128 a[44:47], v1 offset:19456
v_add_u32 v13, 0x20000, v13
v_mfma_f32_16x16x32_bf16 v[220:223], a[60:63], v[72:75], v[220:223]
buffer_load_dwordx4 v13, s[72:75], 0 offen offset:1024 lds
v_mfma_f32_16x16x32_bf16 v[188:191], a[60:63], v[68:71], v[188:191]
ds_read_b128 a[48:51], v1 offset:20480
v_exp_f32 v43, v43
v_mfma_f32_16x16x32_bf16 a[224:227], a[236:239], v[68:71], a[224:227]
s_waitcnt lgkmcnt(9)
v_exp_f32 v44, v44
v_smfmac_f32_16x16x64_bf16 a[228:231], a[232:235], v[72:79], v9
ds_read_b128 a[52:55], v1 offset:21504
v_exp_f32 v45, v45
v_mfma_f32_16x16x32_bf16 v[28:31], a[0:3], a[208:211], v[92:95]
buffer_load_dwordx4 v12, s[72:75], s12 offen offset:2048 lds
v_mfma_f32_16x16x32_bf16 v[28:31], a[4:7], a[212:215], v[28:31]
ds_read_b128 a[56:59], v1 offset:22528
v_exp_f32 v46, v46
v_mfma_f32_16x16x32_bf16 v[28:31], a[8:11], a[216:219], v[28:31]
ds_read_b128 a[60:63], v1 offset:23552
v_xor_b32 v1, 0x8000, v1
v_mfma_f32_16x16x32_bf16 v[28:31], a[12:15], a[220:223], v[28:31]
s_waitcnt lgkmcnt(8)
v_exp_f32 v47, v47
v_cvt_pk_bf16_f32 v62, v44, v45
v_cvt_pk_bf16_f32 v63, v46, v47
v_mfma_f32_16x16x32_bf16 v[44:47], a[16:19], a[208:211], v[92:95]
buffer_load_dwordx4 v13, s[72:75], s12 offen offset:3072 lds
v_mfma_f32_16x16x32_bf16 v[44:47], a[20:23], a[212:215], v[44:47]
v_cvt_pk_bf16_f32 v59, v42, v43
v_mfma_f32_16x16x32_bf16 v[44:47], a[24:27], a[216:219], v[44:47]
v_mfma_f32_16x16x32_bf16 v[44:47], a[28:31], a[220:223], v[44:47]
v_accvgpr_read_b32 v6, a224
v_accvgpr_read_b32 v7, a225
v_add_f32 v6, v6, v7
v_cmp_nge_f32 vcc, 0x5f800000, v6
v_rcp_f32 v6, v6
s_or_b64 s[34:35], s[34:35], vcc
s_add_u32 s8, s28, 0x0
v_pk_mul_f32 v[128:129], v[128:129], v[6:7] op_sel_hi:[1,0]
v_pk_mul_f32 v[130:131], v[130:131], v[6:7] op_sel_hi:[1,0]
v_pk_mul_f32 v[132:133], v[132:133], v[6:7] op_sel_hi:[1,0]
v_pk_mul_f32 v[134:135], v[134:135], v[6:7] op_sel_hi:[1,0]
v_cvt_pk_bf16_f32 v128, v128, v129
v_cvt_pk_bf16_f32 v129, v130, v131
v_cvt_pk_bf16_f32 v130, v132, v133
v_cvt_pk_bf16_f32 v131, v134, v135
buffer_store_dwordx4 v[128:131], v3, s[88:91], s8 offen sc1
s_add_u32 s8, s28, 0x2000
v_pk_mul_f32 v[136:137], v[136:137], v[6:7] op_sel_hi:[1,0]
v_pk_mul_f32 v[138:139], v[138:139], v[6:7] op_sel_hi:[1,0]
v_pk_mul_f32 v[140:141], v[140:141], v[6:7] op_sel_hi:[1,0]
v_pk_mul_f32 v[142:143], v[142:143], v[6:7] op_sel_hi:[1,0]
v_cvt_pk_bf16_f32 v136, v136, v137
v_cvt_pk_bf16_f32 v137, v138, v139
v_cvt_pk_bf16_f32 v138, v140, v141
v_cvt_pk_bf16_f32 v139, v142, v143
buffer_store_dwordx4 v[136:139], v3, s[88:91], s8 offen sc1
s_add_u32 s8, s28, 0x4000
v_pk_mul_f32 v[144:145], v[144:145], v[6:7] op_sel_hi:[1,0]
v_pk_mul_f32 v[146:147], v[146:147], v[6:7] op_sel_hi:[1,0]
v_pk_mul_f32 v[148:149], v[148:149], v[6:7] op_sel_hi:[1,0]
v_pk_mul_f32 v[150:151], v[150:151], v[6:7] op_sel_hi:[1,0]
v_cvt_pk_bf16_f32 v144, v144, v145
v_cvt_pk_bf16_f32 v145, v146, v147
v_cvt_pk_bf16_f32 v146, v148, v149
v_cvt_pk_bf16_f32 v147, v150, v151
buffer_store_dwordx4 v[144:147], v3, s[88:91], s8 offen sc1
s_add_u32 s8, s28, 0x6000
v_pk_mul_f32 v[152:153], v[152:153], v[6:7] op_sel_hi:[1,0]
v_pk_mul_f32 v[154:155], v[154:155], v[6:7] op_sel_hi:[1,0]
v_pk_mul_f32 v[156:157], v[156:157], v[6:7] op_sel_hi:[1,0]
v_pk_mul_f32 v[158:159], v[158:159], v[6:7] op_sel_hi:[1,0]
v_cvt_pk_bf16_f32 v152, v152, v153
v_cvt_pk_bf16_f32 v153, v154, v155
v_cvt_pk_bf16_f32 v154, v156, v157
v_cvt_pk_bf16_f32 v155, v158, v159
buffer_store_dwordx4 v[152:155], v3, s[88:91], s8 offen sc1
v_accvgpr_read_b32 v6, a226
v_accvgpr_read_b32 v7, a227
v_add_f32 v6, v6, v7
v_cmp_nge_f32 vcc, 0x5f800000, v6
v_rcp_f32 v6, v6
s_or_b64 s[34:35], s[34:35], vcc
s_add_u32 s8, s29, 0x0
v_pk_mul_f32 v[160:161], v[160:161], v[6:7] op_sel_hi:[1,0]
v_pk_mul_f32 v[162:163], v[162:163], v[6:7] op_sel_hi:[1,0]
v_pk_mul_f32 v[164:165], v[164:165], v[6:7] op_sel_hi:[1,0]
v_pk_mul_f32 v[166:167], v[166:167], v[6:7] op_sel_hi:[1,0]
v_cvt_pk_bf16_f32 v160, v160, v161
v_cvt_pk_bf16_f32 v161, v162, v163
v_cvt_pk_bf16_f32 v162, v164, v165
v_cvt_pk_bf16_f32 v163, v166, v167
buffer_store_dwordx4 v[160:163], v3, s[88:91], s8 offen sc1
s_add_u32 s8, s29, 0x2000
v_pk_mul_f32 v[168:169], v[168:169], v[6:7] op_sel_hi:[1,0]
v_pk_mul_f32 v[170:171], v[170:171], v[6:7] op_sel_hi:[1,0]
v_pk_mul_f32 v[172:173], v[172:173], v[6:7] op_sel_hi:[1,0]
v_pk_mul_f32 v[174:175], v[174:175], v[6:7] op_sel_hi:[1,0]
v_cvt_pk_bf16_f32 v168, v168, v169
v_cvt_pk_bf16_f32 v169, v170, v171
v_cvt_pk_bf16_f32 v170, v172, v173
v_cvt_pk_bf16_f32 v171, v174, v175
buffer_store_dwordx4 v[168:171], v3, s[88:91], s8 offen sc1
s_add_u32 s8, s29, 0x4000
v_pk_mul_f32 v[176:177], v[176:177], v[6:7] op_sel_hi:[1,0]
v_pk_mul_f32 v[178:179], v[178:179], v[6:7] op_sel_hi:[1,0]
v_pk_mul_f32 v[180:181], v[180:181], v[6:7] op_sel_hi:[1,0]
v_pk_mul_f32 v[182:183], v[182:183], v[6:7] op_sel_hi:[1,0]
v_cvt_pk_bf16_f32 v176, v176, v177
v_cvt_pk_bf16_f32 v177, v178, v179
v_cvt_pk_bf16_f32 v178, v180, v181
v_cvt_pk_bf16_f32 v179, v182, v183
buffer_store_dwordx4 v[176:179], v3, s[88:91], s8 offen sc1
s_add_u32 s8, s29, 0x6000
v_pk_mul_f32 v[184:185], v[184:185], v[6:7] op_sel_hi:[1,0]
v_pk_mul_f32 v[186:187], v[186:187], v[6:7] op_sel_hi:[1,0]
v_pk_mul_f32 v[188:189], v[188:189], v[6:7] op_sel_hi:[1,0]
v_pk_mul_f32 v[190:191], v[190:191], v[6:7] op_sel_hi:[1,0]
v_cvt_pk_bf16_f32 v184, v184, v185
v_cvt_pk_bf16_f32 v185, v186, v187
v_cvt_pk_bf16_f32 v186, v188, v189
v_cvt_pk_bf16_f32 v187, v190, v191
buffer_store_dwordx4 v[184:187], v3, s[88:91], s8 offen sc1
s_branch L_att_h1_0
L_att_dl0_1:
v_mfma_f32_16x16x32_bf16 v[128:131], a[32:35], v[48:51], v[128:131]
ds_read_b128 a[0:3], v1 offset:8192
v_cvt_pk_bf16_f32 v72, v24, v25
v_mfma_f32_16x16x32_bf16 v[160:163], a[32:35], v[52:55], v[160:163]
v_exp_f32 v28, v28
v_mfma_f32_16x16x32_bf16 v[192:195], a[32:35], v[56:59], v[192:195]
v_cvt_pk_bf16_f32 v73, v26, v27
v_mfma_f32_16x16x32_bf16 v[224:227], a[32:35], v[60:63], v[224:227]
ds_read_b128 a[4:7], v1 offset:9216
v_mfma_f32_16x16x32_bf16 v[228:231], a[36:39], v[60:63], v[228:231]
s_add_u32 m0, s27, 0x0
v_exp_f32 v29, v29
v_mfma_f32_16x16x32_bf16 v[196:199], a[36:39], v[56:59], v[196:199]
buffer_load_dwordx4 v3, s[48:51], s32 offen offset:0 sc1 lds
v_mfma_f32_16x16x32_bf16 v[164:167], a[36:39], v[52:55], v[164:167]
v_exp_f32 v30, v30
v_mfma_f32_16x16x32_bf16 v[132:135], a[36:39], v[48:51], v[132:135]
ds_read_b128 a[8:11], v1 offset:10240
v_cvt_pk_bf16_f32 v76, v28, v29
v_mfma_f32_16x16x32_bf16 v[136:139], a[40:43], v[48:51], v[136:139]
v_mfma_f32_16x16x32_bf16 v[168:171], a[40:43], v[52:55], v[168:171]
v_exp_f32 v31, v31
v_mfma_f32_16x16x32_bf16 v[200:203], a[40:43], v[56:59], v[200:203]
v_exp_f32 v32, v32
v_mfma_f32_16x16x32_bf16 v[232:235], a[40:43], v[60:63], v[232:235]
ds_read_b128 a[12:15], v1 offset:11264
v_cvt_pk_bf16_f32 v77, v30, v31
v_mfma_f32_16x16x32_bf16 v[236:239], a[44:47], v[60:63], v[236:239]
v_exp_f32 v33, v33
v_mfma_f32_16x16x32_bf16 v[204:207], a[44:47], v[56:59], v[204:207]
v_cvt_pk_bf16_f32 v66, v32, v33
v_mfma_f32_16x16x32_bf16 v[172:175], a[44:47], v[52:55], v[172:175]
s_mov_b32 s9, 0x0
v_exp_f32 v34, v34
v_mfma_f32_16x16x32_bf16 v[140:143], a[44:47], v[48:51], v[140:143]
ds_read_b128 a[16:19], v1 offset:12288
v_mfma_f32_16x16x32_bf16 v[144:147], a[48:51], v[48:51], v[144:147]
buffer_load_dword a244, v8, s[72:75], s9 offen
v_mfma_f32_16x16x32_bf16 v[176:179], a[48:51], v[52:55], v[176:179]
v_exp_f32 v35, v35
v_mfma_f32_16x16x32_bf16 v[208:211], a[48:51], v[56:59], v[208:211]
v_exp_f32 v36, v36
v_mfma_f32_16x16x32_bf16 v[240:243], a[48:51], v[60:63], v[240:243]
ds_read_b128 a[20:23], v1 offset:13312
v_cvt_pk_bf16_f32 v67, v34, v35
v_mfma_f32_16x16x32_bf16 v[244:247], a[52:55], v[60:63], v[244:247]
v_mfma_f32_16x16x32_bf16 v[212:215], a[52:55], v[56:59], v[212:215]
v_exp_f32 v37, v37
v_mfma_f32_16x16x32_bf16 v[180:183], a[52:55], v[52:55], v[180:183]
ds_read_b128 a[24:27], v1 offset:14336
v_cvt_pk_bf16_f32 v70, v36, v37
v_mfma_f32_16x16x32_bf16 v[148:151], a[52:55], v[48:51], v[148:151]
v_exp_f32 v38, v38
v_mfma_f32_16x16x32_bf16 v[152:155], a[56:59], v[48:51], v[152:155]
v_mfma_f32_16x16x32_bf16 v[184:187], a[56:59], v[52:55], v[184:187]
v_exp_f32 v39, v39
v_mfma_f32_16x16x32_bf16 v[216:219], a[56:59], v[56:59], v[216:219]
buffer_load_dwordx4 v3, s[48:51], s32 offen offset:1024 sc1 lds
v_mfma_f32_16x16x32_bf16 v[248:251], a[56:59], v[60:63], v[248:251]
ds_read_b128 a[28:31], v1 offset:15360
v_cvt_pk_bf16_f32 v71, v38, v39
v_mfma_f32_16x16x32_bf16 v[252:255], a[60:63], v[60:63], v[252:255]
v_exp_f32 v40, v40
v_mfma_f32_16x16x32_bf16 v[220:223], a[60:63], v[56:59], v[220:223]
v_exp_f32 v41, v41
v_mfma_f32_16x16x32_bf16 v[188:191], a[60:63], v[52:55], v[188:191]
ds_read_b128 a[32:35], v1 offset:0
v_cvt_pk_bf16_f32 v74, v40, v41
v_mfma_f32_16x16x32_bf16 v[156:159], a[60:63], v[48:51], v[156:159]
v_smfmac_f32_16x16x64_bf16 a[224:227], a[232:235], v[48:55], v9
v_exp_f32 v42, v42
v_smfmac_f32_16x16x64_bf16 a[228:231], a[232:235], v[56:63], v9
s_waitcnt lgkmcnt(5)
v_exp_f32 v43, v43
v_mfma_f32_16x16x32_bf16 v[16:19], a[0:3], a[160:163], v[80:83]
ds_read_b128 a[36:39], v1 offset:1024
v_cvt_pk_bf16_f32 v75, v42, v43
v_mfma_f32_16x16x32_bf16 v[16:19], a[4:7], a[164:167], v[16:19]
v_exp_f32 v44, v44
v_mfma_f32_16x16x32_bf16 v[16:19], a[8:11], a[168:171], v[16:19]
v_mfma_f32_16x16x32_bf16 v[16:19], a[12:15], a[172:175], v[16:19]
buffer_load_dwordx4 v3, s[48:51], s32 offen offset:2048 sc1 lds
v_mfma_f32_16x16x32_bf16 v[20:23], a[0:3], a[176:179], v[84:87]
ds_read_b128 a[40:43], v1 offset:2048
v_mfma_f32_16x16x32_bf16 v[20:23], a[4:7], a[180:183], v[20:23]
v_exp_f32 v45, v45
v_mfma_f32_16x16x32_bf16 v[20:23], a[8:11], a[184:187], v[20:23]
v_exp_f32 v46, v46
v_mfma_f32_16x16x32_bf16 v[20:23], a[12:15], a[188:191], v[20:23]
ds_read_b128 a[44:47], v1 offset:3072
v_cvt_pk_bf16_f32 v78, v44, v45
v_mfma_f32_16x16x32_bf16 v[24:27], a[0:3], a[192:195], v[88:91]
v_mfma_f32_16x16x32_bf16 v[24:27], a[4:7], a[196:199], v[24:27]
v_exp_f32 v47, v47
v_mfma_f32_16x16x32_bf16 v[24:27], a[8:11], a[200:203], v[24:27]
v_exp_f32 v16, v16
v_mfma_f32_16x16x32_bf16 v[24:27], a[12:15], a[204:207], v[24:27]
ds_read_b128 a[48:51], v1 offset:4096
v_cvt_pk_bf16_f32 v79, v46, v47
v_mfma_f32_16x16x32_bf16 v[28:31], a[0:3], a[208:211], v[92:95]
v_exp_f32 v17, v17
v_mfma_f32_16x16x32_bf16 v[28:31], a[4:7], a[212:215], v[28:31]
s_waitcnt lgkmcnt(5)
v_cvt_pk_bf16_f32 v48, v16, v17
v_mfma_f32_16x16x32_bf16 v[28:31], a[8:11], a[216:219], v[28:31]
buffer_load_dwordx4 v3, s[48:51], s32 offen offset:3072 sc1 lds
v_mfma_f32_16x16x32_bf16 v[28:31], a[12:15], a[220:223], v[28:31]
ds_read_b128 a[52:55], v1 offset:5120
v_mfma_f32_16x16x32_bf16 v[32:35], a[16:19], a[160:163], v[80:83]
v_exp_f32 v18, v18
v_mfma_f32_16x16x32_bf16 v[32:35], a[20:23], a[164:167], v[32:35]
v_exp_f32 v19, v19
v_mfma_f32_16x16x32_bf16 v[32:35], a[24:27], a[168:171], v[32:35]
v_exp_f32 v20, v20
v_mfma_f32_16x16x32_bf16 v[32:35], a[28:31], a[172:175], v[32:35]
ds_read_b128 a[56:59], v1 offset:6144
v_cvt_pk_bf16_f32 v49, v18, v19
v_mfma_f32_16x16x32_bf16 v[36:39], a[16:19], a[176:179], v[84:87]
v_mfma_f32_16x16x32_bf16 v[36:39], a[20:23], a[180:183], v[36:39]
v_exp_f32 v21, v21
v_mfma_f32_16x16x32_bf16 v[36:39], a[24:27], a[184:187], v[36:39]
s_mov_b32 s9, 0x0
v_exp_f32 v22, v22
v_mfma_f32_16x16x32_bf16 v[36:39], a[28:31], a[188:191], v[36:39]
ds_read_b128 a[60:63], v1 offset:7168
v_cvt_pk_bf16_f32 v52, v20, v21
v_mfma_f32_16x16x32_bf16 v[40:43], a[16:19], a[192:195], v[88:91]
buffer_load_dword a244, v8, s[64:67], s9 offen
v_mfma_f32_16x16x32_bf16 v[40:43], a[20:23], a[196:199], v[40:43]
v_mfma_f32_16x16x32_bf16 v[40:43], a[24:27], a[200:203], v[40:43]
v_exp_f32 v23, v23
v_mfma_f32_16x16x32_bf16 v[40:43], a[28:31], a[204:207], v[40:43]
v_exp_f32 v24, v24
v_mfma_f32_16x16x32_bf16 v[44:47], a[16:19], a[208:211], v[92:95]
v_exp_f32 v25, v25
v_mfma_f32_16x16x32_bf16 v[44:47], a[20:23], a[212:215], v[44:47]
v_exp_f32 v26, v26
v_mfma_f32_16x16x32_bf16 v[44:47], a[24:27], a[216:219], v[44:47]
v_exp_f32 v27, v27
v_mfma_f32_16x16x32_bf16 v[44:47], a[28:31], a[220:223], v[44:47]
s_waitcnt lgkmcnt(0)
v_cvt_pk_bf16_f32 v53, v22, v23
v_mfma_f32_16x16x32_bf16 v[128:131], a[32:35], v[64:67], v[128:131]
ds_read_b128 a[0:3], v1 offset:24576
v_cvt_pk_bf16_f32 v56, v24, v25
v_mfma_f32_16x16x32_bf16 v[160:163], a[32:35], v[68:71], v[160:163]
v_exp_f32 v28, v28
v_mfma_f32_16x16x32_bf16 v[192:195], a[32:35], v[72:75], v[192:195]
v_cvt_pk_bf16_f32 v57, v26, v27
v_mfma_f32_16x16x32_bf16 v[224:227], a[32:35], v[76:79], v[224:227]
ds_read_b128 a[4:7], v1 offset:25600
v_mfma_f32_16x16x32_bf16 v[228:231], a[36:39], v[76:79], v[228:231]
v_exp_f32 v29, v29
v_mfma_f32_16x16x32_bf16 v[196:199], a[36:39], v[72:75], v[196:199]
s_add_u32 m0, s27, 0x1000
v_exp_f32 v30, v30
v_mfma_f32_16x16x32_bf16 v[164:167], a[36:39], v[68:71], v[164:167]
buffer_load_dwordx4 v3, s[48:51], s7 offen offset:0 sc1 lds
v_mfma_f32_16x16x32_bf16 v[132:135], a[36:39], v[64:67], v[132:135]
ds_read_b128 a[8:11], v1 offset:26624
v_cvt_pk_bf16_f32 v60, v28, v29
v_mfma_f32_16x16x32_bf16 v[136:139], a[40:43], v[64:67], v[136:139]
v_mfma_f32_16x16x32_bf16 v[168:171], a[40:43], v[68:71], v[168:171]
v_exp_f32 v31, v31
v_mfma_f32_16x16x32_bf16 v[200:203], a[40:43], v[72:75], v[200:203]
v_exp_f32 v32, v32
v_mfma_f32_16x16x32_bf16 v[232:235], a[40:43], v[76:79], v[232:235]
ds_read_b128 a[12:15], v1 offset:27648
v_cvt_pk_bf16_f32 v61, v30, v31
v_mfma_f32_16x16x32_bf16 v[236:239], a[44:47], v[76:79], v[236:239]
v_mfma_f32_16x16x32_bf16 v[204:207], a[44:47], v[72:75], v[204:207]
v_exp_f32 v33, v33
v_mfma_f32_16x16x32_bf16 v[172:175], a[44:47], v[68:71], v[172:175]
v_exp_f32 v34, v34
v_mfma_f32_16x16x32_bf16 v[140:143], a[44:47], v[64:67], v[140:143]
ds_read_b128 a[16:19], v1 offset:28672
v_cvt_pk_bf16_f32 v50, v32, v33
v_mfma_f32_16x16x32_bf16 v[144:147], a[48:51], v[64:67], v[144:147]
v_exp_f32 v35, v35
v_mfma_f32_16x16x32_bf16 v[176:179], a[48:51], v[68:71], v[176:179]
v_cvt_pk_bf16_f32 v51, v34, v35
v_mfma_f32_16x16x32_bf16 v[208:211], a[48:51], v[72:75], v[208:211]
buffer_load_dwordx4 v3, s[48:51], s7 offen offset:1024 sc1 lds
v_mfma_f32_16x16x32_bf16 v[240:243], a[48:51], v[76:79], v[240:243]
ds_read_b128 a[20:23], v1 offset:29696
v_mfma_f32_16x16x32_bf16 v[244:247], a[52:55], v[76:79], v[244:247]
v_exp_f32 v36, v36
v_mfma_f32_16x16x32_bf16 v[212:215], a[52:55], v[72:75], v[212:215]
v_exp_f32 v37, v37
v_mfma_f32_16x16x32_bf16 v[180:183], a[52:55], v[68:71], v[180:183]
ds_read_b128 a[24:27], v1 offset:30720
v_cvt_pk_bf16_f32 v54, v36, v37
v_mfma_f32_16x16x32_bf16 v[148:151], a[52:55], v[64:67], v[148:151]
v_mfma_f32_16x16x32_bf16 v[152:155], a[56:59], v[64:67], v[152:155]
v_exp_f32 v38, v38
v_mfma_f32_16x16x32_bf16 v[184:187], a[56:59], v[68:71], v[184:187]
v_exp_f32 v39, v39
v_mfma_f32_16x16x32_bf16 v[216:219], a[56:59], v[72:75], v[216:219]
ds_read_b128 a[28:31], v1 offset:31744
v_cvt_pk_bf16_f32 v55, v38, v39
v_mfma_f32_16x16x32_bf16 v[248:251], a[56:59], v[76:79], v[248:251]
v_exp_f32 v40, v40
v_mfma_f32_16x16x32_bf16 v[252:255], a[60:63], v[76:79], v[252:255]
v_mfma_f32_16x16x32_bf16 v[220:223], a[60:63], v[72:75], v[220:223]
v_exp_f32 v41, v41
v_mfma_f32_16x16x32_bf16 v[188:191], a[60:63], v[68:71], v[188:191]
buffer_load_dwordx4 v3, s[48:51], s7 offen offset:2048 sc1 lds
v_mfma_f32_16x16x32_bf16 v[156:159], a[60:63], v[64:67], v[156:159]
ds_read_b128 a[32:35], v1 offset:16384
v_cvt_pk_bf16_f32 v58, v40, v41
v_smfmac_f32_16x16x64_bf16 a[224:227], a[232:235], v[64:71], v9
s_waitcnt lgkmcnt(5)
v_exp_f32 v42, v42
v_smfmac_f32_16x16x64_bf16 a[228:231], a[232:235], v[72:79], v9
ds_read_b128 a[36:39], v1 offset:17408
v_mfma_f32_16x16x32_bf16 v[16:19], a[0:3], a[160:163], v[96:99]
v_mfma_f32_16x16x32_bf16 v[16:19], a[4:7], a[164:167], v[16:19]
v_exp_f32 v43, v43
v_mfma_f32_16x16x32_bf16 v[16:19], a[8:11], a[168:171], v[16:19]
v_exp_f32 v44, v44
v_mfma_f32_16x16x32_bf16 v[16:19], a[12:15], a[172:175], v[16:19]
ds_read_b128 a[40:43], v1 offset:18432
v_cvt_pk_bf16_f32 v59, v42, v43
v_mfma_f32_16x16x32_bf16 v[20:23], a[0:3], a[176:179], v[84:87]
v_exp_f32 v45, v45
v_mfma_f32_16x16x32_bf16 v[20:23], a[4:7], a[180:183], v[20:23]
v_cvt_pk_bf16_f32 v62, v44, v45
v_mfma_f32_16x16x32_bf16 v[20:23], a[8:11], a[184:187], v[20:23]
s_mov_b32 s9, 0x400000
v_exp_f32 v46, v46
v_mfma_f32_16x16x32_bf16 v[20:23], a[12:15], a[188:191], v[20:23]
ds_read_b128 a[44:47], v1 offset:19456
v_mfma_f32_16x16x32_bf16 v[24:27], a[0:3], a[192:195], v[88:91]
buffer_load_dword a244, v8, s[64:67], s9 offen
v_mfma_f32_16x16x32_bf16 v[24:27], a[4:7], a[196:199], v[24:27]
v_exp_f32 v47, v47
v_mfma_f32_16x16x32_bf16 v[24:27], a[8:11], a[200:203], v[24:27]
v_cvt_pk_bf16_f32 v63, v46, v47
v_mfma_f32_16x16x32_bf16 v[24:27], a[12:15], a[204:207], v[24:27]
ds_read_b128 a[48:51], v1 offset:20480
v_mfma_f32_16x16x32_bf16 v[28:31], a[0:3], a[208:211], v[92:95]
v_exp_f32 v16, v16
v_mfma_f32_16x16x32_bf16 v[28:31], a[4:7], a[212:215], v[28:31]
v_exp_f32 v17, v17
v_mfma_f32_16x16x32_bf16 v[28:31], a[8:11], a[216:219], v[28:31]
ds_read_b128 a[52:55], v1 offset:21504
v_cvt_pk_bf16_f32 v64, v16, v17
v_mfma_f32_16x16x32_bf16 v[28:31], a[12:15], a[220:223], v[28:31]
s_waitcnt lgkmcnt(6)
v_exp_f32 v18, v18
v_mfma_f32_16x16x32_bf16 v[32:35], a[16:19], a[160:163], v[100:103]
v_mfma_f32_16x16x32_bf16 v[32:35], a[20:23], a[164:167], v[32:35]
v_exp_f32 v19, v19
v_mfma_f32_16x16x32_bf16 v[32:35], a[24:27], a[168:171], v[32:35]
ds_read_b128 a[56:59], v1 offset:22528
v_cvt_pk_bf16_f32 v65, v18, v19
v_mfma_f32_16x16x32_bf16 v[32:35], a[28:31], a[172:175], v[32:35]
v_exp_f32 v20, v20
v_mfma_f32_16x16x32_bf16 v[36:39], a[16:19], a[176:179], v[84:87]
buffer_load_dwordx4 v3, s[48:51], s7 offen offset:3072 sc1 lds
v_mfma_f32_16x16x32_bf16 v[36:39], a[20:23], a[180:183], v[36:39]
s_add_u32 s32, s32, 0x8000
v_mfma_f32_16x16x32_bf16 v[36:39], a[24:27], a[184:187], v[36:39]
ds_read_b128 a[60:63], v1 offset:23552
v_xor_b32 v1, 0x8000, v1
v_mfma_f32_16x16x32_bf16 v[36:39], a[28:31], a[188:191], v[36:39]
s_add_u32 s7, s7, 0x8000
v_exp_f32 v21, v21
v_mfma_f32_16x16x32_bf16 v[40:43], a[16:19], a[192:195], v[88:91]
s_xor_b32 s27, s27, 0x38000
v_exp_f32 v22, v22
v_mfma_f32_16x16x32_bf16 v[40:43], a[20:23], a[196:199], v[40:43]
v_exp_f32 v23, v23
v_mfma_f32_16x16x32_bf16 v[40:43], a[24:27], a[200:203], v[40:43]
v_cvt_pk_bf16_f32 v68, v20, v21
v_cvt_pk_bf16_f32 v69, v22, v23
v_mfma_f32_16x16x32_bf16 v[40:43], a[28:31], a[204:207], v[40:43]
v_exp_f32 v24, v24
v_mfma_f32_16x16x32_bf16 v[44:47], a[16:19], a[208:211], v[92:95]
v_exp_f32 v25, v25
v_mfma_f32_16x16x32_bf16 v[44:47], a[20:23], a[212:215], v[44:47]
v_exp_f32 v26, v26
v_mfma_f32_16x16x32_bf16 v[44:47], a[24:27], a[216:219], v[44:47]
s_waitcnt vmcnt(19) lgkmcnt(0)
v_exp_f32 v27, v27
v_mfma_f32_16x16x32_bf16 v[44:47], a[28:31], a[220:223], v[44:47]
s_barrier
L_att_l1_1:
v_mfma_f32_16x16x32_bf16 v[128:131], a[32:35], v[48:51], v[128:131]
ds_read_b128 a[0:3], v2 offset:8192
v_cvt_pk_bf16_f32 v72, v24, v25
v_mfma_f32_16x16x32_bf16 v[160:163], a[32:35], v[52:55], v[160:163]
s_lshr_b32 s44, s2, 6
v_exp_f32 v28, v28
v_mfma_f32_16x16x32_bf16 v[192:195], a[32:35], v[56:59], v[192:195]
s_add_u32 m0, s19, 0x0
s_lshl_b32 s45, s44, 1
v_cvt_pk_bf16_f32 v73, v26, v27
v_mfma_f32_16x16x32_bf16 v[224:227], a[32:35], v[60:63], v[224:227]
ds_read_b128 a[4:7], v2 offset:9216
s_add_u32 s45, s45, s100
v_mfma_f32_16x16x32_bf16 v[228:231], a[36:39], v[60:63], v[228:231]
buffer_load_dwordx4 v3, s[48:51], s32 offen offset:0 sc1 lds
v_mfma_f32_16x16x32_bf16 v[196:199], a[36:39], v[56:59], v[196:199]
s_and_b32 s60, s45, 3
v_exp_f32 v29, v29
v_mfma_f32_16x16x32_bf16 v[164:167], a[36:39], v[52:55], v[164:167]
ds_read_b128 a[8:11], v2 offset:10240
v_cvt_pk_bf16_f32 v76, v28, v29
v_mfma_f32_16x16x32_bf16 v[132:135], a[36:39], v[48:51], v[132:135]
s_sub_u32 s60, s60, s44
v_exp_f32 v30, v30
v_mfma_f32_16x16x32_bf16 v[136:139], a[40:43], v[48:51], v[136:139]
s_add_u32 s60, s60, 4
v_exp_f32 v31, v31
v_mfma_f32_16x16x32_bf16 v[168:171], a[40:43], v[52:55], v[168:171]
ds_read_b128 a[12:15], v2 offset:11264
v_cvt_pk_bf16_f32 v77, v30, v31
v_mfma_f32_16x16x32_bf16 v[200:203], a[40:43], v[56:59], v[200:203]
s_lshl_b32 s60, s60, 14
s_and_b32 s60, s60, 0x7c000
s_lshl_b32 s61, s60, 3
v_mfma_f32_16x16x32_bf16 v[232:235], a[40:43], v[60:63], v[232:235]
s_add_u32 s62, s61, s12
v_exp_f32 v32, v32
v_mfma_f32_16x16x32_bf16 v[236:239], a[44:47], v[60:63], v[236:239]
s_mov_b32 s9, 0x200000
v_exp_f32 v33, v33
v_mfma_f32_16x16x32_bf16 v[204:207], a[44:47], v[56:59], v[204:207]
ds_read_b128 a[16:19], v2 offset:12288
v_cvt_pk_bf16_f32 v66, v32, v33
v_mfma_f32_16x16x32_bf16 v[172:175], a[44:47], v[52:55], v[172:175]
buffer_load_dword a244, v8, s[64:67], s9 offen
v_mfma_f32_16x16x32_bf16 v[140:143], a[44:47], v[48:51], v[140:143]
s_mul_i32 s44, s44, -8
v_exp_f32 v34, v34
v_mfma_f32_16x16x32_bf16 v[144:147], a[48:51], v[48:51], v[144:147]
ds_read_b128 a[20:23], v2 offset:13312
s_lshl_b32 s44, 4, s44
v_mfma_f32_16x16x32_bf16 v[176:179], a[48:51], v[52:55], v[176:179]
s_mul_i32 s45, s45, -8
v_exp_f32 v35, v35
v_mfma_f32_16x16x32_bf16 v[208:211], a[48:51], v[56:59], v[208:211]
s_lshl_b32 s45, 4, s45
s_add_u32 s44, s44, 0x21212121
v_cvt_pk_bf16_f32 v67, v34, v35
v_mfma_f32_16x16x32_bf16 v[240:243], a[48:51], v[60:63], v[240:243]
ds_read_b128 a[24:27], v2 offset:14336
s_sub_u32 s44, s44, s45
v_mfma_f32_16x16x32_bf16 v[244:247], a[52:55], v[60:63], v[244:247]
s_bfe_u32 s56, s44, 0x80000
v_exp_f32 v36, v36
v_mfma_f32_16x16x32_bf16 v[212:215], a[52:55], v[56:59], v[212:215]
s_lshl_b32 s56, s56, 14
v_exp_f32 v37, v37
v_mfma_f32_16x16x32_bf16 v[180:183], a[52:55], v[52:55], v[180:183]
s_bfe_u32 s57, s44, 0x80008
v_exp_f32 v38, v38
v_mfma_f32_16x16x32_bf16 v[148:151], a[52:55], v[48:51], v[148:151]
buffer_load_dwordx4 v3, s[48:51], s32 offen offset:1024 sc1 lds
v_mfma_f32_16x16x32_bf16 v[152:155], a[56:59], v[48:51], v[152:155]
ds_read_b128 a[28:31], v2 offset:15360
v_cvt_pk_bf16_f32 v70, v36, v37
v_mfma_f32_16x16x32_bf16 v[184:187], a[56:59], v[52:55], v[184:187]
s_lshl_b32 s57, s57, 14
s_bfe_u32 s58, s44, 0x80010
s_lshl_b32 s58, s58, 14
v_mfma_f32_16x16x32_bf16 v[216:219], a[56:59], v[56:59], v[216:219]
ds_read_b128 a[32:35], v2 offset:0
s_bfe_u32 s59, s44, 0x80018
v_mfma_f32_16x16x32_bf16 v[248:251], a[56:59], v[60:63], v[248:251]
s_lshl_b32 s59, s59, 14
v_exp_f32 v39, v39
v_mfma_f32_16x16x32_bf16 v[252:255], a[60:63], v[60:63], v[252:255]
v_exp_f32 v40, v40
v_mfma_f32_16x16x32_bf16 v[220:223], a[60:63], v[56:59], v[220:223]
ds_read_b128 a[36:39], v2 offset:1024
v_cvt_pk_bf16_f32 v71, v38, v39
v_mfma_f32_16x16x32_bf16 v[188:191], a[60:63], v[52:55], v[188:191]
v_exp_f32 v41, v41
v_mfma_f32_16x16x32_bf16 v[156:159], a[60:63], v[48:51], v[156:159]
s_waitcnt lgkmcnt(6)
v_exp_f32 v42, v42
v_smfmac_f32_16x16x64_bf16 a[224:227], a[232:235], v[48:55], v9
buffer_load_dwordx4 v3, s[48:51], s32 offen offset:2048 sc1 lds
v_smfmac_f32_16x16x64_bf16 a[228:231], a[232:235], v[56:63], v9
ds_read_b128 a[40:43], v2 offset:2048
v_cvt_pk_bf16_f32 v74, v40, v41
v_mfma_f32_16x16x32_bf16 v[20:23], a[0:3], a[176:179], v[104:107]
v_mfma_f32_16x16x32_bf16 v[20:23], a[4:7], a[180:183], v[20:23]
v_exp_f32 v43, v43
v_mfma_f32_16x16x32_bf16 v[20:23], a[8:11], a[184:187], v[20:23]
ds_read_b128 a[44:47], v2 offset:3072
v_cvt_pk_bf16_f32 v75, v42, v43
v_mfma_f32_16x16x32_bf16 v[20:23], a[12:15], a[188:191], v[20:23]
v_exp_f32 v44, v44
v_mfma_f32_16x16x32_bf16 v[24:27], a[0:3], a[192:195], v[88:91]
v_exp_f32 v45, v45
v_mfma_f32_16x16x32_bf16 v[24:27], a[4:7], a[196:199], v[24:27]
ds_read_b128 a[48:51], v2 offset:4096
v_cvt_pk_bf16_f32 v78, v44, v45
v_mfma_f32_16x16x32_bf16 v[24:27], a[8:11], a[200:203], v[24:27]
v_mfma_f32_16x16x32_bf16 v[24:27], a[12:15], a[204:207], v[24:27]
v_exp_f32 v46, v46
v_mfma_f32_16x16x32_bf16 v[28:31], a[0:3], a[208:211], v[92:95]
buffer_load_dwordx4 v3, s[48:51], s32 offen offset:3072 sc1 lds
v_mfma_f32_16x16x32_bf16 v[28:31], a[4:7], a[212:215], v[28:31]
ds_read_b128 a[52:55], v2 offset:5120
v_mfma_f32_16x16x32_bf16 v[28:31], a[8:11], a[216:219], v[28:31]
v_exp_f32 v47, v47
v_mfma_f32_16x16x32_bf16 v[28:31], a[12:15], a[220:223], v[28:31]
s_waitcnt lgkmcnt(6)
v_exp_f32 v20, v20
v_mfma_f32_16x16x32_bf16 v[36:39], a[16:19], a[176:179], v[108:111]
ds_read_b128 a[56:59], v2 offset:6144
v_cvt_pk_bf16_f32 v79, v46, v47
v_mfma_f32_16x16x32_bf16 v[36:39], a[20:23], a[180:183], v[36:39]
v_exp_f32 v21, v21
v_mfma_f32_16x16x32_bf16 v[36:39], a[24:27], a[184:187], v[36:39]
v_cvt_pk_bf16_f32 v52, v20, v21
v_mfma_f32_16x16x32_bf16 v[36:39], a[28:31], a[188:191], v[36:39]
ds_read_b128 a[60:63], v2 offset:7168
v_mfma_f32_16x16x32_bf16 v[40:43], a[16:19], a[192:195], v[88:91]
s_mov_b32 s9, 0x600000
v_exp_f32 v22, v22
v_mfma_f32_16x16x32_bf16 v[40:43], a[20:23], a[196:199], v[40:43]
buffer_load_dword a244, v8, s[64:67], s9 offen
v_mfma_f32_16x16x32_bf16 v[40:43], a[24:27], a[200:203], v[40:43]
v_exp_f32 v23, v23
v_mfma_f32_16x16x32_bf16 v[40:43], a[28:31], a[204:207], v[40:43]
v_exp_f32 v24, v24
v_mfma_f32_16x16x32_bf16 v[44:47], a[16:19], a[208:211], v[92:95]
v_exp_f32 v25, v25
v_mfma_f32_16x16x32_bf16 v[44:47], a[20:23], a[212:215], v[44:47]
v_exp_f32 v26, v26
v_mfma_f32_16x16x32_bf16 v[44:47], a[24:27], a[216:219], v[44:47]
v_exp_f32 v27, v27
v_mfma_f32_16x16x32_bf16 v[44:47], a[28:31], a[220:223], v[44:47]
s_waitcnt lgkmcnt(0)
v_cvt_pk_bf16_f32 v53, v22, v23
v_mfma_f32_16x16x32_bf16 v[128:131], a[32:35], v[64:67], v[128:131]
ds_read_b128 a[0:3], v2 offset:24576
v_cvt_pk_bf16_f32 v56, v24, v25
v_mfma_f32_16x16x32_bf16 v[160:163], a[32:35], v[68:71], v[160:163]
v_exp_f32 v28, v28
v_mfma_f32_16x16x32_bf16 v[192:195], a[32:35], v[72:75], v[192:195]
ds_read_b128 a[4:7], v2 offset:25600
v_cvt_pk_bf16_f32 v57, v26, v27
v_mfma_f32_16x16x32_bf16 v[224:227], a[32:35], v[76:79], v[224:227]
s_add_u32 m0, s19, 0x1000
v_mfma_f32_16x16x32_bf16 v[228:231], a[36:39], v[76:79], v[228:231]
buffer_load_dwordx4 v3, s[48:51], s7 offen offset:0 sc1 lds
v_mfma_f32_16x16x32_bf16 v[196:199], a[36:39], v[72:75], v[196:199]
ds_read_b128 a[8:11], v2 offset:26624
v_mfma_f32_16x16x32_bf16 v[164:167], a[36:39], v[68:71], v[164:167]
v_exp_f32 v29, v29
v_mfma_f32_16x16x32_bf16 v[132:135], a[36:39], v[64:67], v[132:135]
v_exp_f32 v30, v30
v_mfma_f32_16x16x32_bf16 v[136:139], a[40:43], v[64:67], v[136:139]
ds_read_b128 a[12:15], v2 offset:27648
v_cvt_pk_bf16_f32 v60, v28, v29
v_mfma_f32_16x16x32_bf16 v[168:171], a[40:43], v[68:71], v[168:171]
v_exp_f32 v31, v31
v_mfma_f32_16x16x32_bf16 v[200:203], a[40:43], v[72:75], v[200:203]
v_exp_f32 v36, v36
v_mfma_f32_16x16x32_bf16 v[232:235], a[40:43], v[76:79], v[232:235]
ds_read_b128 a[16:19], v2 offset:28672
v_cvt_pk_bf16_f32 v61, v30, v31
v_mfma_f32_16x16x32_bf16 v[236:239], a[44:47], v[76:79], v[236:239]
buffer_load_dwordx4 v3, s[48:51], s7 offen offset:1024 sc1 lds
v_mfma_f32_16x16x32_bf16 v[204:207], a[44:47], v[72:75], v[204:207]
ds_read_b128 a[20:23], v2 offset:29696
v_mfma_f32_16x16x32_bf16 v[172:175], a[44:47], v[68:71], v[172:175]
v_mfma_f32_16x16x32_bf16 v[140:143], a[44:47], v[64:67], v[140:143]
v_exp_f32 v37, v37
v_mfma_f32_16x16x32_bf16 v[144:147], a[48:51], v[64:67], v[144:147]
ds_read_b128 a[24:27], v2 offset:30720
v_cvt_pk_bf16_f32 v54, v36, v37
v_mfma_f32_16x16x32_bf16 v[176:179], a[48:51], v[68:71], v[176:179]
v_exp_f32 v38, v38
v_mfma_f32_16x16x32_bf16 v[208:211], a[48:51], v[72:75], v[208:211]
v_exp_f32 v39, v39
v_mfma_f32_16x16x32_bf16 v[240:243], a[48:51], v[76:79], v[240:243]
ds_read_b128 a[28:31], v2 offset:31744
v_cvt_pk_bf16_f32 v55, v38, v39
v_mfma_f32_16x16x32_bf16 v[244:247], a[52:55], v[76:79], v[244:247]
v_exp_f32 v40, v40
v_mfma_f32_16x16x32_bf16 v[212:215], a[52:55], v[72:75], v[212:215]
buffer_load_dwordx4 v3, s[48:51], s7 offen offset:2048 sc1 lds
v_mfma_f32_16x16x32_bf16 v[180:183], a[52:55], v[68:71], v[180:183]
ds_read_b128 a[32:35], v2 offset:16384
v_mfma_f32_16x16x32_bf16 v[148:151], a[52:55], v[64:67], v[148:151]
v_mfma_f32_16x16x32_bf16 v[152:155], a[56:59], v[64:67], v[152:155]
ds_read_b128 a[36:39], v2 offset:17408
v_mfma_f32_16x16x32_bf16 v[184:187], a[56:59], v[68:71], v[184:187]
v_exp_f32 v41, v41
v_mfma_f32_16x16x32_bf16 v[216:219], a[56:59], v[72:75], v[216:219]
v_exp_f32 v42, v42
v_mfma_f32_16x16x32_bf16 v[248:251], a[56:59], v[76:79], v[248:251]
ds_read_b128 a[40:43], v2 offset:18432
v_cvt_pk_bf16_f32 v58, v40, v41
v_mfma_f32_16x16x32_bf16 v[252:255], a[60:63], v[76:79], v[252:255]
v_exp_f32 v43, v43
v_mfma_f32_16x16x32_bf16 v[220:223], a[60:63], v[72:75], v[220:223]
buffer_load_dwordx4 v3, s[48:51], s7 offen offset:3072 sc1 lds
v_mfma_f32_16x16x32_bf16 v[188:191], a[60:63], v[68:71], v[188:191]
ds_read_b128 a[44:47], v2 offset:19456
v_cvt_pk_bf16_f32 v59, v42, v43
v_mfma_f32_16x16x32_bf16 v[156:159], a[60:63], v[64:67], v[156:159]
v_exp_f32 v44, v44
v_smfmac_f32_16x16x64_bf16 a[224:227], a[232:235], v[64:71], v9
s_waitcnt lgkmcnt(8)
v_exp_f32 v45, v45
v_smfmac_f32_16x16x64_bf16 a[228:231], a[232:235], v[72:79], v9
ds_read_b128 a[48:51], v2 offset:20480
v_add_u32 v4, s0, v3
v_mfma_f32_16x16x32_bf16 v[24:27], a[0:3], a[192:195], v[88:91]
v_cvt_pk_bf16_f32 v62, v44, v45
v_mfma_f32_16x16x32_bf16 v[24:27], a[4:7], a[196:199], v[24:27]
ds_read_b128 a[52:55], v2 offset:21504
v_mov_b32 v5, s1
v_mfma_f32_16x16x32_bf16 v[24:27], a[8:11], a[200:203], v[24:27]
v_exp_f32 v46, v46
v_mfma_f32_16x16x32_bf16 v[24:27], a[12:15], a[204:207], v[24:27]
global_load_dword a244, v[4:5], off sc1
v_mfma_f32_16x16x32_bf16 v[28:31], a[0:3], a[208:211], v[92:95]
ds_read_b128 a[56:59], v2 offset:22528
v_mfma_f32_16x16x32_bf16 v[28:31], a[4:7], a[212:215], v[28:31]
s_add_u32 s32, s32, 0x8000
v_exp_f32 v47, v47
v_mfma_f32_16x16x32_bf16 v[28:31], a[8:11], a[216:219], v[28:31]
s_waitcnt lgkmcnt(7)
v_cvt_pk_bf16_f32 v63, v46, v47
v_mfma_f32_16x16x32_bf16 v[28:31], a[12:15], a[220:223], v[28:31]
ds_read_b128 a[60:63], v2 offset:23552
s_add_u32 s7, s7, 0x8000
v_mfma_f32_16x16x32_bf16 v[40:43], a[16:19], a[192:195], v[88:91]
s_xor_b32 s19, s19, 0x8000
v_xor_b32 v2, 0x38000, v2
v_mfma_f32_16x16x32_bf16 v[40:43], a[20:23], a[196:199], v[40:43]
s_sub_u32 s15, 7, s6
v_exp_f32 v24, v24
v_mfma_f32_16x16x32_bf16 v[40:43], a[24:27], a[200:203], v[40:43]
s_lshl_b32 s15, s15, 1
v_exp_f32 v25, v25
v_mfma_f32_16x16x32_bf16 v[40:43], a[28:31], a[204:207], v[40:43]
v_exp_f32 v26, v26
v_mfma_f32_16x16x32_bf16 v[44:47], a[16:19], a[208:211], v[92:95]
v_exp_f32 v27, v27
v_mfma_f32_16x16x32_bf16 v[44:47], a[20:23], a[212:215], v[44:47]
v_exp_f32 v28, v28
v_mfma_f32_16x16x32_bf16 v[44:47], a[24:27], a[216:219], v[44:47]
s_waitcnt vmcnt(22) lgkmcnt(0)
v_exp_f32 v29, v29
v_mfma_f32_16x16x32_bf16 v[44:47], a[28:31], a[220:223], v[44:47]
s_barrier
s_cbranch_scc0 L_att_lh0_1
v_mfma_f32_16x16x32_bf16 v[160:163], a[32:35], v[52:55], v[160:163]
ds_read_b128 a[0:3], v1 offset:8192
v_cvt_pk_bf16_f32 v72, v24, v25
v_mfma_f32_16x16x32_bf16 v[192:195], a[32:35], v[56:59], v[192:195]
v_exp_f32 v30, v30
v_mfma_f32_16x16x32_bf16 v[224:227], a[32:35], v[60:63], v[224:227]
ds_read_b128 a[4:7], v1 offset:9216
v_cvt_pk_bf16_f32 v73, v26, v27
v_mfma_f32_16x16x32_bf16 v[228:231], a[36:39], v[60:63], v[228:231]
s_add_u32 m0, s27, 0x0
v_cvt_pk_bf16_f32 v76, v28, v29
v_accvgpr_read_b32 v6, a224
v_mfma_f32_16x16x32_bf16 v[196:199], a[36:39], v[56:59], v[196:199]
buffer_load_dwordx4 v3, s[48:51], s32 offen offset:0 sc1 lds
v_mfma_f32_16x16x32_bf16 v[164:167], a[36:39], v[52:55], v[164:167]
ds_read_b128 a[8:11], v1 offset:10240
v_accvgpr_read_b32 v7, a225
v_mfma_f32_16x16x32_bf16 v[168:171], a[40:43], v[52:55], v[168:171]
ds_read_b128 a[12:15], v1 offset:11264
v_add_f32 v6, v6, v7
v_mfma_f32_16x16x32_bf16 v[200:203], a[40:43], v[56:59], v[200:203]
v_exp_f32 v31, v31
v_mfma_f32_16x16x32_bf16 v[232:235], a[40:43], v[60:63], v[232:235]
v_exp_f32 v40, v40
v_mfma_f32_16x16x32_bf16 v[236:239], a[44:47], v[60:63], v[236:239]
ds_read_b128 a[16:19], v1 offset:12288
v_cvt_pk_bf16_f32 v77, v30, v31
v_mfma_f32_16x16x32_bf16 v[204:207], a[44:47], v[56:59], v[204:207]
v_cmp_nge_f32 vcc, 0x5f800000, v6
v_mfma_f32_16x16x32_bf16 v[172:175], a[44:47], v[52:55], v[172:175]
ds_read_b128 a[20:23], v1 offset:13312
v_mfma_f32_16x16x32_bf16 v[176:179], a[48:51], v[52:55], v[176:179]
v_exp_f32 v41, v41
v_mfma_f32_16x16x32_bf16 v[208:211], a[48:51], v[56:59], v[208:211]
ds_read_b128 a[24:27], v1 offset:14336
v_cvt_pk_bf16_f32 v74, v40, v41
v_mfma_f32_16x16x32_bf16 v[240:243], a[48:51], v[60:63], v[240:243]
buffer_load_dwordx4 v3, s[48:51], s32 offen offset:1024 sc1 lds
v_mfma_f32_16x16x32_bf16 v[244:247], a[52:55], v[60:63], v[244:247]
v_exp_f32 v42, v42
v_mfma_f32_16x16x32_bf16 v[212:215], a[52:55], v[56:59], v[212:215]
ds_read_b128 a[28:31], v1 offset:15360
v_mfma_f32_16x16x32_bf16 v[180:183], a[52:55], v[52:55], v[180:183]
v_exp_f32 v43, v43
v_mfma_f32_16x16x32_bf16 v[184:187], a[56:59], v[52:55], v[184:187]
ds_read_b128 a[32:35], v1 offset:0
v_cvt_pk_bf16_f32 v75, v42, v43
v_mfma_f32_16x16x32_bf16 v[216:219], a[56:59], v[56:59], v[216:219]
v_rcp_f32 v6, v6
v_mfma_f32_16x16x32_bf16 v[248:251], a[56:59], v[60:63], v[248:251]
ds_read_b128 a[36:39], v1 offset:1024
s_or_b64 s[34:35], s[34:35], vcc
v_mfma_f32_16x16x32_bf16 v[252:255], a[60:63], v[60:63], v[252:255]
s_add_u32 s8, s28, 0x0
v_exp_f32 v44, v44
v_mfma_f32_16x16x32_bf16 v[220:223], a[60:63], v[56:59], v[220:223]
v_exp_f32 v45, v45
v_mfma_f32_16x16x32_bf16 v[188:191], a[60:63], v[52:55], v[188:191]
ds_read_b128 a[40:43], v1 offset:2048
v_cvt_pk_bf16_f32 v78, v44, v45
v_mfma_f32_16x16x32_bf16 a[224:227], a[236:239], v[52:55], a[224:227]
buffer_load_dwordx4 v3, s[48:51], s32 offen offset:2048 sc1 lds
v_smfmac_f32_16x16x64_bf16 a[228:231], a[232:235], v[56:63], v9
ds_read_b128 a[44:47], v1 offset:3072
s_waitcnt lgkmcnt(8)
v_mfma_f32_16x16x32_bf16 v[24:27], a[0:3], a[192:195], v[88:91]
v_exp_f32 v46, v46
v_mfma_f32_16x16x32_bf16 v[24:27], a[4:7], a[196:199], v[24:27]
ds_read_b128 a[48:51], v1 offset:4096
v_mul_f32 v128, v6, v128
v_mfma_f32_16x16x32_bf16 v[24:27], a[8:11], a[200:203], v[24:27]
v_mul_f32 v129, v6, v129
v_mul_f32 v130, v6, v130
v_mfma_f32_16x16x32_bf16 v[24:27], a[12:15], a[204:207], v[24:27]
v_exp_f32 v47, v47
v_mfma_f32_16x16x32_bf16 v[28:31], a[0:3], a[208:211], v[92:95]
ds_read_b128 a[52:55], v1 offset:5120
v_cvt_pk_bf16_f32 v79, v46, v47
v_mfma_f32_16x16x32_bf16 v[28:31], a[4:7], a[212:215], v[28:31]
v_mul_f32 v131, v6, v131
v_mul_f32 v132, v6, v132
v_mfma_f32_16x16x32_bf16 v[28:31], a[8:11], a[216:219], v[28:31]
ds_read_b128 a[56:59], v1 offset:6144
v_mul_f32 v133, v6, v133
v_mfma_f32_16x16x32_bf16 v[28:31], a[12:15], a[220:223], v[28:31]
s_waitcnt lgkmcnt(7)
v_exp_f32 v24, v24
v_mfma_f32_16x16x32_bf16 v[40:43], a[16:19], a[192:195], v[88:91]
buffer_load_dwordx4 v3, s[48:51], s32 offen offset:3072 sc1 lds
v_mfma_f32_16x16x32_bf16 v[40:43], a[20:23], a[196:199], v[40:43]
ds_read_b128 a[60:63], v1 offset:7168
v_mul_f32 v134, v6, v134
v_mfma_f32_16x16x32_bf16 v[40:43], a[24:27], a[200:203], v[40:43]
s_add_u32 s32, s32, 0x8000
v_exp_f32 v25, v25
v_mfma_f32_16x16x32_bf16 v[40:43], a[28:31], a[204:207], v[40:43]
v_exp_f32 v26, v26
v_mfma_f32_16x16x32_bf16 v[44:47], a[16:19], a[208:211], v[92:95]
v_exp_f32 v27, v27
v_mfma_f32_16x16x32_bf16 v[44:47], a[20:23], a[212:215], v[44:47]
v_exp_f32 v28, v28
v_mfma_f32_16x16x32_bf16 v[44:47], a[24:27], a[216:219], v[44:47]
v_exp_f32 v29, v29
v_mfma_f32_16x16x32_bf16 v[44:47], a[28:31], a[220:223], v[44:47]
s_waitcnt lgkmcnt(0)
v_mul_f32 v135, v6, v135
v_cvt_pk_bf16_f32 v128, v128, v129
v_mfma_f32_16x16x32_bf16 v[192:195], a[32:35], v[72:75], v[192:195]
s_add_u32 m0, s27, 0x1000
v_exp_f32 v30, v30
v_mfma_f32_16x16x32_bf16 v[224:227], a[32:35], v[76:79], v[224:227]
buffer_load_dwordx4 v3, s[48:51], s7 offen offset:0 sc1 lds
v_mfma_f32_16x16x32_bf16 v[228:231], a[36:39], v[76:79], v[228:231]
v_exp_f32 v31, v31
v_mfma_f32_16x16x32_bf16 v[196:199], a[36:39], v[72:75], v[196:199]
ds_read_b128 a[0:3], v1 offset:24576
v_cvt_pk_bf16_f32 v56, v24, v25
v_mfma_f32_16x16x32_bf16 v[200:203], a[40:43], v[72:75], v[200:203]
ds_read_b128 a[4:7], v1 offset:25600
v_cvt_pk_bf16_f32 v57, v26, v27
v_mfma_f32_16x16x32_bf16 v[232:235], a[40:43], v[76:79], v[232:235]
v_exp_f32 v40, v40
v_mfma_f32_16x16x32_bf16 v[236:239], a[44:47], v[76:79], v[236:239]
ds_read_b128 a[8:11], v1 offset:26624
v_cvt_pk_bf16_f32 v60, v28, v29
v_mfma_f32_16x16x32_bf16 v[204:207], a[44:47], v[72:75], v[204:207]
v_exp_f32 v41, v41
v_mfma_f32_16x16x32_bf16 v[208:211], a[48:51], v[72:75], v[208:211]
ds_read_b128 a[12:15], v1 offset:27648
v_cvt_pk_bf16_f32 v61, v30, v31
v_mfma_f32_16x16x32_bf16 v[240:243], a[48:51], v[76:79], v[240:243]
ds_read_b128 a[16:19], v1 offset:28672
v_cvt_pk_bf16_f32 v58, v40, v41
v_mfma_f32_16x16x32_bf16 v[244:247], a[52:55], v[76:79], v[244:247]
v_exp_f32 v42, v42
v_mfma_f32_16x16x32_bf16 v[212:215], a[52:55], v[72:75], v[212:215]
buffer_load_dwordx4 v3, s[48:51], s7 offen offset:1024 sc1 lds
v_mfma_f32_16x16x32_bf16 v[216:219], a[56:59], v[72:75], v[216:219]
ds_read_b128 a[20:23], v1 offset:29696
v_cvt_pk_bf16_f32 v129, v130, v131
v_mfma_f32_16x16x32_bf16 v[248:251], a[56:59], v[76:79], v[248:251]
ds_read_b128 a[24:27], v1 offset:30720
v_cvt_pk_bf16_f32 v130, v132, v133
v_mfma_f32_16x16x32_bf16 v[252:255], a[60:63], v[76:79], v[252:255]
ds_read_b128 a[28:31], v1 offset:31744
v_cvt_pk_bf16_f32 v131, v134, v135
v_mfma_f32_16x16x32_bf16 v[220:223], a[60:63], v[72:75], v[220:223]
s_waitcnt lgkmcnt(4)
v_exp_f32 v43, v43
v_smfmac_f32_16x16x64_bf16 a[228:231], a[232:235], v[72:79], v9
ds_read_b128 a[32:35], v1 offset:16384
v_cvt_pk_bf16_f32 v59, v42, v43
v_mfma_f32_16x16x32_bf16 v[24:27], a[0:3], a[192:195], v[88:91]
ds_read_b128 a[36:39], v1 offset:17408
buffer_store_dwordx4 v[128:131], v3, s[88:91], s8 offen sc1
v_mfma_f32_16x16x32_bf16 v[24:27], a[4:7], a[196:199], v[24:27]
buffer_load_dwordx4 v3, s[48:51], s7 offen offset:2048 sc1 lds
v_mfma_f32_16x16x32_bf16 v[24:27], a[8:11], a[200:203], v[24:27]
ds_read_b128 a[40:43], v1 offset:18432
v_exp_f32 v44, v44
v_mfma_f32_16x16x32_bf16 v[24:27], a[12:15], a[204:207], v[24:27]
ds_read_b128 a[44:47], v1 offset:19456
v_exp_f32 v45, v45
v_mfma_f32_16x16x32_bf16 v[28:31], a[0:3], a[208:211], v[92:95]
ds_read_b128 a[48:51], v1 offset:20480
v_exp_f32 v46, v46
v_mfma_f32_16x16x32_bf16 v[28:31], a[4:7], a[212:215], v[28:31]
s_waitcnt lgkmcnt(5)
v_exp_f32 v47, v47
v_mfma_f32_16x16x32_bf16 v[28:31], a[8:11], a[216:219], v[28:31]
ds_read_b128 a[52:55], v1 offset:21504
v_cvt_pk_bf16_f32 v62, v44, v45
v_mfma_f32_16x16x32_bf16 v[28:31], a[12:15], a[220:223], v[28:31]
ds_read_b128 a[56:59], v1 offset:22528
v_cvt_pk_bf16_f32 v63, v46, v47
v_mfma_f32_16x16x32_bf16 v[40:43], a[16:19], a[192:195], v[88:91]
ds_read_b128 a[60:63], v1 offset:23552
v_xor_b32 v1, 0x8000, v1
v_mfma_f32_16x16x32_bf16 v[40:43], a[20:23], a[196:199], v[40:43]
buffer_load_dwordx4 v3, s[48:51], s7 offen offset:3072 sc1 lds
v_mfma_f32_16x16x32_bf16 v[40:43], a[24:27], a[200:203], v[40:43]
s_add_u32 s7, s7, 0x8000
v_exp_f32 v24, v24
v_mfma_f32_16x16x32_bf16 v[40:43], a[28:31], a[204:207], v[40:43]
s_xor_b32 s27, s27, 0x38000
v_exp_f32 v25, v25
v_mfma_f32_16x16x32_bf16 v[44:47], a[16:19], a[208:211], v[92:95]
s_add_u32 s8, s28, 0x2000
v_exp_f32 v26, v26
v_mfma_f32_16x16x32_bf16 v[44:47], a[20:23], a[212:215], v[44:47]
v_exp_f32 v27, v27
v_mfma_f32_16x16x32_bf16 v[44:47], a[24:27], a[216:219], v[44:47]
s_waitcnt vmcnt(19) lgkmcnt(0)
v_exp_f32 v28, v28
v_mfma_f32_16x16x32_bf16 v[44:47], a[28:31], a[220:223], v[44:47]
s_barrier
v_exp_f32 v29, v29
v_mul_f32 v136, v6, v136
v_mul_f32 v137, v6, v137
v_mul_f32 v138, v6, v138
v_mul_f32 v139, v6, v139
v_mul_f32 v140, v6, v140
v_mul_f32 v141, v6, v141
v_mul_f32 v142, v6, v142
v_mul_f32 v143, v6, v143
v_cvt_pk_bf16_f32 v136, v136, v137
v_cvt_pk_bf16_f32 v137, v138, v139
v_cvt_pk_bf16_f32 v138, v140, v141
v_cvt_pk_bf16_f32 v139, v142, v143
buffer_store_dwordx4 v[136:139], v3, s[88:91], s8 offen sc1
s_add_u32 s8, s28, 0x4000
v_mul_f32 v144, v6, v144
v_mul_f32 v145, v6, v145
v_mul_f32 v146, v6, v146
v_mul_f32 v147, v6, v147
v_mul_f32 v148, v6, v148
v_mul_f32 v149, v6, v149
v_mul_f32 v150, v6, v150
v_mul_f32 v151, v6, v151
v_cvt_pk_bf16_f32 v144, v144, v145
v_cvt_pk_bf16_f32 v145, v146, v147
v_cvt_pk_bf16_f32 v146, v148, v149
v_cvt_pk_bf16_f32 v147, v150, v151
buffer_store_dwordx4 v[144:147], v3, s[88:91], s8 offen sc1
s_add_u32 s8, s28, 0x6000
v_mul_f32 v152, v6, v152
v_mul_f32 v153, v6, v153
v_mul_f32 v154, v6, v154
v_mul_f32 v155, v6, v155
v_mul_f32 v156, v6, v156
v_mul_f32 v157, v6, v157
v_mul_f32 v158, v6, v158
v_mul_f32 v159, v6, v159
v_cvt_pk_bf16_f32 v152, v152, v153
v_cvt_pk_bf16_f32 v153, v154, v155
v_cvt_pk_bf16_f32 v154, v156, v157
v_cvt_pk_bf16_f32 v155, v158, v159
buffer_store_dwordx4 v[152:155], v3, s[88:91], s8 offen sc1
v_accvgpr_read_b32 v6, a226
v_accvgpr_read_b32 v7, a227
v_add_f32 v6, v6, v7
v_cmp_nge_f32 vcc, 0x5f800000, v6
v_rcp_f32 v6, v6
s_or_b64 s[34:35], s[34:35], vcc
s_add_u32 s8, s29, 0x0
v_pk_mul_f32 v[160:161], v[160:161], v[6:7] op_sel_hi:[1,0]
v_pk_mul_f32 v[162:163], v[162:163], v[6:7] op_sel_hi:[1,0]
v_pk_mul_f32 v[164:165], v[164:165], v[6:7] op_sel_hi:[1,0]
v_pk_mul_f32 v[166:167], v[166:167], v[6:7] op_sel_hi:[1,0]
v_cvt_pk_bf16_f32 v160, v160, v161
v_cvt_pk_bf16_f32 v161, v162, v163
v_cvt_pk_bf16_f32 v162, v164, v165
v_cvt_pk_bf16_f32 v163, v166, v167
buffer_store_dwordx4 v[160:163], v3, s[88:91], s8 offen sc1
s_add_u32 s8, s29, 0x2000
v_pk_mul_f32 v[168:169], v[168:169], v[6:7] op_sel_hi:[1,0]
v_pk_mul_f32 v[170:171], v[170:171], v[6:7] op_sel_hi:[1,0]
v_pk_mul_f32 v[172:173], v[172:173], v[6:7] op_sel_hi:[1,0]
v_pk_mul_f32 v[174:175], v[174:175], v[6:7] op_sel_hi:[1,0]
v_cvt_pk_bf16_f32 v168, v168, v169
v_cvt_pk_bf16_f32 v169, v170, v171
v_cvt_pk_bf16_f32 v170, v172, v173
v_cvt_pk_bf16_f32 v171, v174, v175
buffer_store_dwordx4 v[168:171], v3, s[88:91], s8 offen sc1
s_add_u32 s8, s29, 0x4000
v_pk_mul_f32 v[176:177], v[176:177], v[6:7] op_sel_hi:[1,0]
v_pk_mul_f32 v[178:179], v[178:179], v[6:7] op_sel_hi:[1,0]
v_pk_mul_f32 v[180:181], v[180:181], v[6:7] op_sel_hi:[1,0]
v_pk_mul_f32 v[182:183], v[182:183], v[6:7] op_sel_hi:[1,0]
v_cvt_pk_bf16_f32 v176, v176, v177
v_cvt_pk_bf16_f32 v177, v178, v179
v_cvt_pk_bf16_f32 v178, v180, v181
v_cvt_pk_bf16_f32 v179, v182, v183
buffer_store_dwordx4 v[176:179], v3, s[88:91], s8 offen sc1
s_add_u32 s8, s29, 0x6000
v_pk_mul_f32 v[184:185], v[184:185], v[6:7] op_sel_hi:[1,0]
v_pk_mul_f32 v[186:187], v[186:187], v[6:7] op_sel_hi:[1,0]
v_pk_mul_f32 v[188:189], v[188:189], v[6:7] op_sel_hi:[1,0]
v_pk_mul_f32 v[190:191], v[190:191], v[6:7] op_sel_hi:[1,0]
v_cvt_pk_bf16_f32 v184, v184, v185
v_cvt_pk_bf16_f32 v185, v186, v187
v_cvt_pk_bf16_f32 v186, v188, v189
v_cvt_pk_bf16_f32 v187, v190, v191
buffer_store_dwordx4 v[184:187], v3, s[88:91], s8 offen sc1
s_getreg_b32 s8, hwreg(HW_REG_HW_ID, 5, 1)
s_cmp_lg_u32 s8, 0
s_cbranch_scc1 L_att_sodd1
s_branch L_att_sodd0
L_att_lh0_1:
v_mfma_f32_16x16x32_bf16 v[160:163], a[32:35], v[52:55], v[160:163]
ds_read_b128 a[0:3], v1 offset:8192
v_cvt_pk_bf16_f32 v72, v24, v25
v_mfma_f32_16x16x32_bf16 v[192:195], a[32:35], v[56:59], v[192:195]
v_exp_f32 v30, v30
v_mfma_f32_16x16x32_bf16 v[224:227], a[32:35], v[60:63], v[224:227]
buffer_load_dword v14, v15, s[84:87], 0 offen offset:192 sc1
v_mfma_f32_16x16x32_bf16 v[228:231], a[36:39], v[60:63], v[228:231]
ds_read_b128 a[4:7], v1 offset:9216
v_cvt_pk_bf16_f32 v73, v26, v27
v_mfma_f32_16x16x32_bf16 v[196:199], a[36:39], v[56:59], v[196:199]
ds_read_b128 a[8:11], v1 offset:10240
v_cvt_pk_bf16_f32 v76, v28, v29
v_mfma_f32_16x16x32_bf16 v[164:167], a[36:39], v[52:55], v[164:167]
s_add_u32 m0, s17, 0x10000
v_exp_f32 v31, v31
v_mfma_f32_16x16x32_bf16 v[168:171], a[40:43], v[52:55], v[168:171]
buffer_load_dwordx4 v12, s[72:75], 0 offen lds
v_mfma_f32_16x16x32_bf16 v[200:203], a[40:43], v[56:59], v[200:203]
ds_read_b128 a[12:15], v1 offset:11264
v_cvt_pk_bf16_f32 v77, v30, v31
v_mfma_f32_16x16x32_bf16 v[232:235], a[40:43], v[60:63], v[232:235]
v_exp_f32 v40, v40
v_mfma_f32_16x16x32_bf16 v[236:239], a[44:47], v[60:63], v[236:239]
ds_read_b128 a[16:19], v1 offset:12288
v_mfma_f32_16x16x32_bf16 v[204:207], a[44:47], v[56:59], v[204:207]
v_exp_f32 v41, v41
v_mfma_f32_16x16x32_bf16 v[172:175], a[44:47], v[52:55], v[172:175]
buffer_load_dwordx4 v13, s[72:75], 0 offen offset:1024 lds
v_mfma_f32_16x16x32_bf16 v[176:179], a[48:51], v[52:55], v[176:179]
ds_read_b128 a[20:23], v1 offset:13312
v_cvt_pk_bf16_f32 v74, v40, v41
v_mfma_f32_16x16x32_bf16 v[208:211], a[48:51], v[56:59], v[208:211]
ds_read_b128 a[24:27], v1 offset:14336
v_mfma_f32_16x16x32_bf16 v[240:243], a[48:51], v[60:63], v[240:243]
v_exp_f32 v42, v42
v_mfma_f32_16x16x32_bf16 v[244:247], a[52:55], v[60:63], v[244:247]
buffer_load_dwordx4 v12, s[72:75], s12 offen offset:2048 lds
v_mfma_f32_16x16x32_bf16 v[212:215], a[52:55], v[56:59], v[212:215]
ds_read_b128 a[28:31], v1 offset:15360
v_mfma_f32_16x16x32_bf16 v[180:183], a[52:55], v[52:55], v[180:183]
v_exp_f32 v43, v43
v_mfma_f32_16x16x32_bf16 v[184:187], a[56:59], v[52:55], v[184:187]
ds_read_b128 a[32:35], v1 offset:0
v_cvt_pk_bf16_f32 v75, v42, v43
v_mfma_f32_16x16x32_bf16 v[216:219], a[56:59], v[56:59], v[216:219]
v_exp_f32 v44, v44
v_mfma_f32_16x16x32_bf16 v[248:251], a[56:59], v[60:63], v[248:251]
buffer_load_dwordx4 v13, s[72:75], s12 offen offset:3072 lds
v_mfma_f32_16x16x32_bf16 v[252:255], a[60:63], v[60:63], v[252:255]
ds_read_b128 a[36:39], v1 offset:1024
v_mfma_f32_16x16x32_bf16 v[220:223], a[60:63], v[56:59], v[220:223]
s_add_u32 m0, s17, 0x14000
v_exp_f32 v45, v45
v_mfma_f32_16x16x32_bf16 v[188:191], a[60:63], v[52:55], v[188:191]
ds_read_b128 a[40:43], v1 offset:2048
v_add_u32 v12, 0x20000, v12
v_mfma_f32_16x16x32_bf16 a[224:227], a[236:239], v[52:55], a[224:227]
buffer_load_dwordx4 v12, s[72:75], 0 offen lds
v_smfmac_f32_16x16x64_bf16 a[228:231], a[232:235], v[56:63], v9
ds_read_b128 a[44:47], v1 offset:3072
s_waitcnt lgkmcnt(8)
v_mfma_f32_16x16x32_bf16 v[24:27], a[0:3], a[192:195], v[88:91]
v_exp_f32 v46, v46
v_mfma_f32_16x16x32_bf16 v[24:27], a[4:7], a[196:199], v[24:27]
ds_read_b128 a[48:51], v1 offset:4096
v_add_u32 v13, 0x20000, v13
v_mfma_f32_16x16x32_bf16 v[24:27], a[8:11], a[200:203], v[24:27]
buffer_load_dwordx4 v13, s[72:75], 0 offen offset:1024 lds
v_mfma_f32_16x16x32_bf16 v[24:27], a[12:15], a[204:207], v[24:27]
v_exp_f32 v47, v47
v_mfma_f32_16x16x32_bf16 v[28:31], a[0:3], a[208:211], v[92:95]
ds_read_b128 a[52:55], v1 offset:5120
v_cvt_pk_bf16_f32 v78, v44, v45
v_mfma_f32_16x16x32_bf16 v[28:31], a[4:7], a[212:215], v[28:31]
s_waitcnt lgkmcnt(6)
v_cvt_pk_bf16_f32 v79, v46, v47
v_mfma_f32_16x16x32_bf16 v[28:31], a[8:11], a[216:219], v[28:31]
ds_read_b128 a[56:59], v1 offset:6144
v_mfma_f32_16x16x32_bf16 v[28:31], a[12:15], a[220:223], v[28:31]
buffer_load_dwordx4 v12, s[72:75], s12 offen offset:2048 lds
v_mfma_f32_16x16x32_bf16 v[40:43], a[16:19], a[192:195], v[88:91]
ds_read_b128 a[60:63], v1 offset:7168
v_mfma_f32_16x16x32_bf16 v[40:43], a[20:23], a[196:199], v[40:43]
v_exp_f32 v24, v24
v_mfma_f32_16x16x32_bf16 v[40:43], a[24:27], a[200:203], v[40:43]
v_exp_f32 v25, v25
v_mfma_f32_16x16x32_bf16 v[40:43], a[28:31], a[204:207], v[40:43]
buffer_load_dwordx4 v13, s[72:75], s12 offen offset:3072 lds
v_mfma_f32_16x16x32_bf16 v[44:47], a[16:19], a[208:211], v[92:95]
v_exp_f32 v26, v26
v_mfma_f32_16x16x32_bf16 v[44:47], a[20:23], a[212:215], v[44:47]
v_exp_f32 v27, v27
v_mfma_f32_16x16x32_bf16 v[44:47], a[24:27], a[216:219], v[44:47]
v_exp_f32 v28, v28
v_mfma_f32_16x16x32_bf16 v[44:47], a[28:31], a[220:223], v[44:47]
s_waitcnt lgkmcnt(0)
v_exp_f32 v29, v29
v_mfma_f32_16x16x32_bf16 v[192:195], a[32:35], v[72:75], v[192:195]
s_add_u32 m0, s16, 0x0
v_add_u32 v12, 0x20000, v12
v_cvt_pk_bf16_f32 v56, v24, v25
v_mfma_f32_16x16x32_bf16 v[224:227], a[32:35], v[76:79], v[224:227]
buffer_load_dwordx4 v12, s[72:75], 0 offen lds
v_mfma_f32_16x16x32_bf16 v[228:231], a[36:39], v[76:79], v[228:231]
ds_read_b128 a[0:3], v1 offset:24576
v_cvt_pk_bf16_f32 v57, v26, v27
v_mfma_f32_16x16x32_bf16 v[196:199], a[36:39], v[72:75], v[196:199]
v_exp_f32 v30, v30
v_mfma_f32_16x16x32_bf16 v[200:203], a[40:43], v[72:75], v[200:203]
ds_read_b128 a[4:7], v1 offset:25600
v_cvt_pk_bf16_f32 v60, v28, v29
v_mfma_f32_16x16x32_bf16 v[232:235], a[40:43], v[76:79], v[232:235]
ds_read_b128 a[8:11], v1 offset:26624
v_add_u32 v13, 0x20000, v13
v_mfma_f32_16x16x32_bf16 v[236:239], a[44:47], v[76:79], v[236:239]
buffer_load_dwordx4 v13, s[72:75], 0 offen offset:1024 lds
v_mfma_f32_16x16x32_bf16 v[204:207], a[44:47], v[72:75], v[204:207]
ds_read_b128 a[12:15], v1 offset:27648
v_exp_f32 v31, v31
v_mfma_f32_16x16x32_bf16 v[208:211], a[48:51], v[72:75], v[208:211]
buffer_load_dwordx4 v12, s[72:75], s12 offen offset:2048 lds
v_mfma_f32_16x16x32_bf16 v[240:243], a[48:51], v[76:79], v[240:243]
ds_read_b128 a[16:19], v1 offset:28672
v_exp_f32 v40, v40
v_mfma_f32_16x16x32_bf16 v[244:247], a[52:55], v[76:79], v[244:247]
ds_read_b128 a[20:23], v1 offset:29696
v_cvt_pk_bf16_f32 v61, v30, v31
v_mfma_f32_16x16x32_bf16 v[212:215], a[52:55], v[72:75], v[212:215]
buffer_load_dwordx4 v13, s[72:75], s12 offen offset:3072 lds
v_mfma_f32_16x16x32_bf16 v[216:219], a[56:59], v[72:75], v[216:219]
ds_read_b128 a[24:27], v1 offset:30720
v_exp_f32 v41, v41
v_mfma_f32_16x16x32_bf16 v[248:251], a[56:59], v[76:79], v[248:251]
ds_read_b128 a[28:31], v1 offset:31744
v_exp_f32 v42, v42
v_mfma_f32_16x16x32_bf16 v[252:255], a[60:63], v[76:79], v[252:255]
ds_read_b128 a[32:35], v1 offset:16384
v_cvt_pk_bf16_f32 v58, v40, v41
v_mfma_f32_16x16x32_bf16 v[220:223], a[60:63], v[72:75], v[220:223]
s_waitcnt lgkmcnt(5)
v_exp_f32 v43, v43
v_smfmac_f32_16x16x64_bf16 a[228:231], a[232:235], v[72:79], v9
ds_read_b128 a[36:39], v1 offset:17408
v_add_u32 v12, 0x20000, v12
v_mfma_f32_16x16x32_bf16 v[24:27], a[0:3], a[192:195], v[112:115]
s_add_u32 m0, s16, 0x4000
v_exp_f32 v44, v44
v_mfma_f32_16x16x32_bf16 v[24:27], a[4:7], a[196:199], v[24:27]
buffer_load_dwordx4 v12, s[72:75], 0 offen lds
v_mfma_f32_16x16x32_bf16 v[24:27], a[8:11], a[200:203], v[24:27]
ds_read_b128 a[40:43], v1 offset:18432
v_add_u32 v13, 0x20000, v13
v_mfma_f32_16x16x32_bf16 v[24:27], a[12:15], a[204:207], v[24:27]
buffer_load_dwordx4 v13, s[72:75], 0 offen offset:1024 lds
v_mfma_f32_16x16x32_bf16 v[28:31], a[0:3], a[208:211], v[92:95]
ds_read_b128 a[44:47], v1 offset:19456
v_cvt_pk_bf16_f32 v59, v42, v43
v_mfma_f32_16x16x32_bf16 v[28:31], a[4:7], a[212:215], v[28:31]
ds_read_b128 a[48:51], v1 offset:20480
v_exp_f32 v45, v45
v_mfma_f32_16x16x32_bf16 v[28:31], a[8:11], a[216:219], v[28:31]
s_waitcnt lgkmcnt(5)
v_exp_f32 v46, v46
v_mfma_f32_16x16x32_bf16 v[28:31], a[12:15], a[220:223], v[28:31]
buffer_load_dwordx4 v12, s[72:75], s12 offen offset:2048 lds
v_mfma_f32_16x16x32_bf16 v[40:43], a[16:19], a[192:195], v[116:119]
ds_read_b128 a[52:55], v1 offset:21504
v_exp_f32 v47, v47
v_mfma_f32_16x16x32_bf16 v[40:43], a[20:23], a[196:199], v[40:43]
ds_read_b128 a[56:59], v1 offset:22528
v_exp_f32 v24, v24
v_mfma_f32_16x16x32_bf16 v[40:43], a[24:27], a[200:203], v[40:43]
ds_read_b128 a[60:63], v1 offset:23552
v_xor_b32 v1, 0x8000, v1
v_mfma_f32_16x16x32_bf16 v[40:43], a[28:31], a[204:207], v[40:43]
v_exp_f32 v25, v25
v_cvt_pk_bf16_f32 v62, v44, v45
v_cvt_pk_bf16_f32 v63, v46, v47
v_mfma_f32_16x16x32_bf16 v[44:47], a[16:19], a[208:211], v[92:95]
v_exp_f32 v26, v26
v_mfma_f32_16x16x32_bf16 v[44:47], a[20:23], a[212:215], v[44:47]
buffer_load_dwordx4 v13, s[72:75], s12 offen offset:3072 lds
v_mfma_f32_16x16x32_bf16 v[44:47], a[24:27], a[216:219], v[44:47]
v_exp_f32 v27, v27
v_mfma_f32_16x16x32_bf16 v[44:47], a[28:31], a[220:223], v[44:47]
v_exp_f32 v28, v28
v_exp_f32 v29, v29
v_accvgpr_read_b32 v6, a224
v_accvgpr_read_b32 v7, a225
v_add_f32 v6, v6, v7
v_cmp_nge_f32 vcc, 0x5f800000, v6
v_rcp_f32 v6, v6
s_or_b64 s[34:35], s[34:35], vcc
s_add_u32 s8, s28, 0x0
v_pk_mul_f32 v[128:129], v[128:129], v[6:7] op_sel_hi:[1,0]
v_pk_mul_f32 v[130:131], v[130:131], v[6:7] op_sel_hi:[1,0]
v_pk_mul_f32 v[132:133], v[132:133], v[6:7] op_sel_hi:[1,0]
v_pk_mul_f32 v[134:135], v[134:135], v[6:7] op_sel_hi:[1,0]
v_cvt_pk_bf16_f32 v128, v128, v129
v_cvt_pk_bf16_f32 v129, v130, v131
v_cvt_pk_bf16_f32 v130, v132, v133
v_cvt_pk_bf16_f32 v131, v134, v135
buffer_store_dwordx4 v[128:131], v3, s[88:91], s8 offen sc1
s_add_u32 s8, s28, 0x2000
v_pk_mul_f32 v[136:137], v[136:137], v[6:7] op_sel_hi:[1,0]
v_pk_mul_f32 v[138:139], v[138:139], v[6:7] op_sel_hi:[1,0]
v_pk_mul_f32 v[140:141], v[140:141], v[6:7] op_sel_hi:[1,0]
v_pk_mul_f32 v[142:143], v[142:143], v[6:7] op_sel_hi:[1,0]
v_cvt_pk_bf16_f32 v136, v136, v137
v_cvt_pk_bf16_f32 v137, v138, v139
v_cvt_pk_bf16_f32 v138, v140, v141
v_cvt_pk_bf16_f32 v139, v142, v143
buffer_store_dwordx4 v[136:139], v3, s[88:91], s8 offen sc1
s_add_u32 s8, s28, 0x4000
v_pk_mul_f32 v[144:145], v[144:145], v[6:7] op_sel_hi:[1,0]
v_pk_mul_f32 v[146:147], v[146:147], v[6:7] op_sel_hi:[1,0]
v_pk_mul_f32 v[148:149], v[148:149], v[6:7] op_sel_hi:[1,0]
v_pk_mul_f32 v[150:151], v[150:151], v[6:7] op_sel_hi:[1,0]
v_cvt_pk_bf16_f32 v144, v144, v145
v_cvt_pk_bf16_f32 v145, v146, v147
v_cvt_pk_bf16_f32 v146, v148, v149
v_cvt_pk_bf16_f32 v147, v150, v151
buffer_store_dwordx4 v[144:147], v3, s[88:91], s8 offen sc1
s_add_u32 s8, s28, 0x6000
v_pk_mul_f32 v[152:153], v[152:153], v[6:7] op_sel_hi:[1,0]
v_pk_mul_f32 v[154:155], v[154:155], v[6:7] op_sel_hi:[1,0]
v_pk_mul_f32 v[156:157], v[156:157], v[6:7] op_sel_hi:[1,0]
v_pk_mul_f32 v[158:159], v[158:159], v[6:7] op_sel_hi:[1,0]
v_cvt_pk_bf16_f32 v152, v152, v153
v_cvt_pk_bf16_f32 v153, v154, v155
v_cvt_pk_bf16_f32 v154, v156, v157
v_cvt_pk_bf16_f32 v155, v158, v159
buffer_store_dwordx4 v[152:155], v3, s[88:91], s8 offen sc1
v_accvgpr_read_b32 v6, a226
v_accvgpr_read_b32 v7, a227
v_add_f32 v6, v6, v7
v_cmp_nge_f32 vcc, 0x5f800000, v6
v_rcp_f32 v6, v6
s_or_b64 s[34:35], s[34:35], vcc
s_add_u32 s8, s29, 0x0
v_pk_mul_f32 v[160:161], v[160:161], v[6:7] op_sel_hi:[1,0]
v_pk_mul_f32 v[162:163], v[162:163], v[6:7] op_sel_hi:[1,0]
v_pk_mul_f32 v[164:165], v[164:165], v[6:7] op_sel_hi:[1,0]
v_pk_mul_f32 v[166:167], v[166:167], v[6:7] op_sel_hi:[1,0]
v_cvt_pk_bf16_f32 v160, v160, v161
v_cvt_pk_bf16_f32 v161, v162, v163
v_cvt_pk_bf16_f32 v162, v164, v165
v_cvt_pk_bf16_f32 v163, v166, v167
buffer_store_dwordx4 v[160:163], v3, s[88:91], s8 offen sc1
s_add_u32 s8, s29, 0x2000
v_pk_mul_f32 v[168:169], v[168:169], v[6:7] op_sel_hi:[1,0]
v_pk_mul_f32 v[170:171], v[170:171], v[6:7] op_sel_hi:[1,0]
v_pk_mul_f32 v[172:173], v[172:173], v[6:7] op_sel_hi:[1,0]
v_pk_mul_f32 v[174:175], v[174:175], v[6:7] op_sel_hi:[1,0]
v_cvt_pk_bf16_f32 v168, v168, v169
v_cvt_pk_bf16_f32 v169, v170, v171
v_cvt_pk_bf16_f32 v170, v172, v173
v_cvt_pk_bf16_f32 v171, v174, v175
buffer_store_dwordx4 v[168:171], v3, s[88:91], s8 offen sc1
s_add_u32 s8, s29, 0x4000
v_pk_mul_f32 v[176:177], v[176:177], v[6:7] op_sel_hi:[1,0]
v_pk_mul_f32 v[178:179], v[178:179], v[6:7] op_sel_hi:[1,0]
v_pk_mul_f32 v[180:181], v[180:181], v[6:7] op_sel_hi:[1,0]
v_pk_mul_f32 v[182:183], v[182:183], v[6:7] op_sel_hi:[1,0]
v_cvt_pk_bf16_f32 v176, v176, v177
v_cvt_pk_bf16_f32 v177, v178, v179
v_cvt_pk_bf16_f32 v178, v180, v181
v_cvt_pk_bf16_f32 v179, v182, v183
buffer_store_dwordx4 v[176:179], v3, s[88:91], s8 offen sc1
s_add_u32 s8, s29, 0x6000
v_pk_mul_f32 v[184:185], v[184:185], v[6:7] op_sel_hi:[1,0]
v_pk_mul_f32 v[186:187], v[186:187], v[6:7] op_sel_hi:[1,0]
v_pk_mul_f32 v[188:189], v[188:189], v[6:7] op_sel_hi:[1,0]
v_pk_mul_f32 v[190:191], v[190:191], v[6:7] op_sel_hi:[1,0]
v_cvt_pk_bf16_f32 v184, v184, v185
v_cvt_pk_bf16_f32 v185, v186, v187
v_cvt_pk_bf16_f32 v186, v188, v189
v_cvt_pk_bf16_f32 v187, v190, v191
buffer_store_dwordx4 v[184:187], v3, s[88:91], s8 offen sc1
s_branch L_att_h1_1
L_att_j0:
s_cmp_ge_u32 s4, 2
s_cbranch_scc1 L_att_nl0_1
L_att_nl0_0:
v_mfma_f32_16x16x32_bf16 v[16:19], a[0:3], a[160:163], v[96:99]
ds_read_b128 a[128:131], v1 offset:24576
v_mov_b32 v240, 0
v_mfma_f32_16x16x32_bf16 v[16:19], a[4:7], a[164:167], v[16:19]
ds_read_b128 a[132:135], v1 offset:25600
s_add_u32 m0, s27, 0x0
v_mfma_f32_16x16x32_bf16 v[16:19], a[8:11], a[168:171], v[16:19]
buffer_load_dwordx4 v3, s[48:51], s32 offen offset:0 sc1 lds
v_mfma_f32_16x16x32_bf16 v[16:19], a[12:15], a[172:175], v[16:19]
ds_read_b128 a[136:139], v1 offset:26624
v_mov_b32 v241, 0
v_mfma_f32_16x16x32_bf16 v[20:23], a[0:3], a[176:179], v[84:87]
ds_read_b128 a[140:143], v1 offset:27648
v_mov_b32 v242, 0
v_mfma_f32_16x16x32_bf16 v[20:23], a[4:7], a[180:183], v[20:23]
ds_read_b128 a[144:147], v1 offset:28672
v_mov_b32 v243, 0
v_mfma_f32_16x16x32_bf16 v[20:23], a[8:11], a[184:187], v[20:23]
ds_read_b128 a[148:151], v1 offset:29696
s_mov_b32 s9, 0x0
v_mfma_f32_16x16x32_bf16 v[20:23], a[12:15], a[188:191], v[20:23]
buffer_load_dword a244, v8, s[72:75], s9 offen
v_mfma_f32_16x16x32_bf16 v[24:27], a[0:3], a[192:195], v[88:91]
ds_read_b128 a[152:155], v1 offset:30720
v_mov_b32 v244, 0
v_mfma_f32_16x16x32_bf16 v[24:27], a[4:7], a[196:199], v[24:27]
ds_read_b128 a[156:159], v1 offset:31744
v_exp_f32 v16, v16
v_mfma_f32_16x16x32_bf16 v[24:27], a[8:11], a[200:203], v[24:27]
v_exp_f32 v17, v17
v_mfma_f32_16x16x32_bf16 v[24:27], a[12:15], a[204:207], v[24:27]
v_exp_f32 v18, v18
v_mfma_f32_16x16x32_bf16 v[28:31], a[0:3], a[208:211], v[92:95]
buffer_load_dwordx4 v3, s[48:51], s32 offen offset:1024 sc1 lds
v_mfma_f32_16x16x32_bf16 v[28:31], a[4:7], a[212:215], v[28:31]
v_exp_f32 v19, v19
v_mfma_f32_16x16x32_bf16 v[28:31], a[8:11], a[216:219], v[28:31]
v_exp_f32 v20, v20
v_mfma_f32_16x16x32_bf16 v[28:31], a[12:15], a[220:223], v[28:31]
v_exp_f32 v21, v21
v_mfma_f32_16x16x32_bf16 v[32:35], a[16:19], a[160:163], v[100:103]
v_exp_f32 v22, v22
v_mfma_f32_16x16x32_bf16 v[32:35], a[20:23], a[164:167], v[32:35]
buffer_load_dwordx4 v3, s[48:51], s32 offen offset:2048 sc1 lds
v_mfma_f32_16x16x32_bf16 v[32:35], a[24:27], a[168:171], v[32:35]
v_exp_f32 v23, v23
v_mfma_f32_16x16x32_bf16 v[32:35], a[28:31], a[172:175], v[32:35]
v_exp_f32 v24, v24
v_mfma_f32_16x16x32_bf16 v[36:39], a[16:19], a[176:179], v[84:87]
v_exp_f32 v25, v25
v_mfma_f32_16x16x32_bf16 v[36:39], a[20:23], a[180:183], v[36:39]
v_exp_f32 v26, v26
v_mfma_f32_16x16x32_bf16 v[36:39], a[24:27], a[184:187], v[36:39]
buffer_load_dwordx4 v3, s[48:51], s32 offen offset:3072 sc1 lds
v_mfma_f32_16x16x32_bf16 v[36:39], a[28:31], a[188:191], v[36:39]
v_exp_f32 v27, v27
v_mfma_f32_16x16x32_bf16 v[40:43], a[16:19], a[192:195], v[88:91]
v_exp_f32 v28, v28
v_mfma_f32_16x16x32_bf16 v[40:43], a[20:23], a[196:199], v[40:43]
v_exp_f32 v29, v29
v_mfma_f32_16x16x32_bf16 v[40:43], a[24:27], a[200:203], v[40:43]
s_mov_b32 s9, 0x0
v_exp_f32 v30, v30
v_mfma_f32_16x16x32_bf16 v[40:43], a[28:31], a[204:207], v[40:43]
buffer_load_dword a244, v8, s[64:67], s9 offen
v_mfma_f32_16x16x32_bf16 v[44:47], a[16:19], a[208:211], v[92:95]
v_exp_f32 v31, v31
v_mfma_f32_16x16x32_bf16 v[44:47], a[20:23], a[212:215], v[44:47]
v_exp_f32 v32, v32
v_mfma_f32_16x16x32_bf16 v[44:47], a[24:27], a[216:219], v[44:47]
v_exp_f32 v33, v33
v_mfma_f32_16x16x32_bf16 v[44:47], a[28:31], a[220:223], v[44:47]
s_waitcnt lgkmcnt(0)
v_cvt_pk_bf16_f32 v48, v16, v17
v_cvt_pk_bf16_f32 v49, v18, v19
v_cvt_pk_bf16_f32 v52, v20, v21
v_cvt_pk_bf16_f32 v53, v22, v23
v_cvt_pk_bf16_f32 v56, v24, v25
v_cvt_pk_bf16_f32 v57, v26, v27
v_mov_b32 v245, 0
v_mov_b32 v246, 0
v_mov_b32 v247, 0
v_mfma_f32_16x16x32_bf16 v[20:23], a[128:131], a[176:179], v[84:87]
s_add_u32 m0, s27, 0x1000
v_exp_f32 v34, v34
v_mfma_f32_16x16x32_bf16 v[20:23], a[132:135], a[180:183], v[20:23]
buffer_load_dwordx4 v3, s[48:51], s7 offen offset:0 sc1 lds
v_mfma_f32_16x16x32_bf16 v[20:23], a[136:139], a[184:187], v[20:23]
v_exp_f32 v35, v35
v_mfma_f32_16x16x32_bf16 v[20:23], a[140:143], a[188:191], v[20:23]
ds_read_b128 a[32:35], v1 offset:16384
v_cvt_pk_bf16_f32 v60, v28, v29
v_mfma_f32_16x16x32_bf16 v[24:27], a[128:131], a[192:195], v[88:91]
v_exp_f32 v36, v36
v_mfma_f32_16x16x32_bf16 v[24:27], a[132:135], a[196:199], v[24:27]
ds_read_b128 a[36:39], v1 offset:17408
v_cvt_pk_bf16_f32 v61, v30, v31
v_mfma_f32_16x16x32_bf16 v[24:27], a[136:139], a[200:203], v[24:27]
buffer_load_dwordx4 v3, s[48:51], s7 offen offset:1024 sc1 lds
v_mfma_f32_16x16x32_bf16 v[24:27], a[140:143], a[204:207], v[24:27]
ds_read_b128 a[40:43], v1 offset:18432
v_cvt_pk_bf16_f32 v50, v32, v33
v_mfma_f32_16x16x32_bf16 v[28:31], a[128:131], a[208:211], v[92:95]
v_exp_f32 v37, v37
v_mfma_f32_16x16x32_bf16 v[28:31], a[132:135], a[212:215], v[28:31]
ds_read_b128 a[44:47], v1 offset:19456
v_cvt_pk_bf16_f32 v51, v34, v35
v_mfma_f32_16x16x32_bf16 v[28:31], a[136:139], a[216:219], v[28:31]
buffer_load_dwordx4 v3, s[48:51], s7 offen offset:2048 sc1 lds
v_mfma_f32_16x16x32_bf16 v[28:31], a[140:143], a[220:223], v[28:31]
s_mov_b32 s9, 0x400000
v_exp_f32 v38, v38
v_exp_f32 v39, v39
v_cvt_pk_bf16_f32 v54, v36, v37
v_cvt_pk_bf16_f32 v55, v38, v39
v_mfma_f32_16x16x32_bf16 v[36:39], a[144:147], a[176:179], v[84:87]
ds_read_b128 a[48:51], v1 offset:20480
v_exp_f32 v40, v40
v_mfma_f32_16x16x32_bf16 v[36:39], a[148:151], a[180:183], v[36:39]
ds_read_b128 a[52:55], v1 offset:21504
v_exp_f32 v41, v41
v_mfma_f32_16x16x32_bf16 v[36:39], a[152:155], a[184:187], v[36:39]
buffer_load_dword a244, v8, s[64:67], s9 offen
v_mfma_f32_16x16x32_bf16 v[36:39], a[156:159], a[188:191], v[36:39]
ds_read_b128 a[56:59], v1 offset:22528
v_cvt_pk_bf16_f32 v58, v40, v41
v_exp_f32 v42, v42
v_exp_f32 v43, v43
s_nop 0
v_cvt_pk_bf16_f32 v59, v42, v43
v_mfma_f32_16x16x32_bf16 v[40:43], a[144:147], a[192:195], v[88:91]
buffer_load_dwordx4 v3, s[48:51], s7 offen offset:3072 sc1 lds
v_mfma_f32_16x16x32_bf16 v[40:43], a[148:151], a[196:199], v[40:43]
ds_read_b128 a[60:63], v1 offset:23552
v_xor_b32 v1, 0x8000, v1
v_mfma_f32_16x16x32_bf16 v[40:43], a[152:155], a[200:203], v[40:43]
s_add_u32 s32, s32, 0x8000
v_exp_f32 v44, v44
v_mfma_f32_16x16x32_bf16 v[40:43], a[156:159], a[204:207], v[40:43]
s_add_u32 s7, s7, 0x8000
v_exp_f32 v45, v45
v_exp_f32 v46, v46
v_exp_f32 v47, v47
v_cvt_pk_bf16_f32 v62, v44, v45
v_cvt_pk_bf16_f32 v63, v46, v47
v_mfma_f32_16x16x32_bf16 v[44:47], a[144:147], a[208:211], v[92:95]
s_xor_b32 s27, s27, 0x38000
v_exp_f32 v20, v20
v_mfma_f32_16x16x32_bf16 v[44:47], a[148:151], a[212:215], v[44:47]
v_exp_f32 v21, v21
v_mfma_f32_16x16x32_bf16 v[44:47], a[152:155], a[216:219], v[44:47]
s_waitcnt vmcnt(11) lgkmcnt(0)
v_exp_f32 v22, v22
v_mfma_f32_16x16x32_bf16 v[44:47], a[156:159], a[220:223], v[44:47]
s_barrier
v_cvt_pk_bf16_f32 v68, v20, v21
v_exp_f32 v23, v23
v_exp_f32 v24, v24
v_exp_f32 v25, v25
v_exp_f32 v26, v26
v_exp_f32 v27, v27
v_cvt_pk_bf16_f32 v69, v22, v23
s_cmp_lg_u32 s33, 0
s_cbranch_scc1 L_sig_bn0
s_lshl_b32 s8, s6, 2
s_add_u32 s8, s8, 192
s_cmp_lg_u32 s4, 0
s_cbranch_scc1 L_sig_bn0
v_mov_b32 v4, 1
s_mov_b64 exec, 1
buffer_atomic_add v4, off, s[84:87], s8 sc1
s_mov_b64 exec, -1
L_sig_bn0:
s_branch L_att_l1_0
L_att_nl0_1:
v_mfma_f32_16x16x32_bf16 v[16:19], a[0:3], a[160:163], v[80:83]
ds_read_b128 a[128:131], v1 offset:24576
v_mov_b32 v240, 0
v_mfma_f32_16x16x32_bf16 v[16:19], a[4:7], a[164:167], v[16:19]
ds_read_b128 a[132:135], v1 offset:25600
s_add_u32 m0, s27, 0x0
v_mfma_f32_16x16x32_bf16 v[16:19], a[8:11], a[168:171], v[16:19]
buffer_load_dwordx4 v3, s[48:51], s32 offen offset:0 sc1 lds
v_mfma_f32_16x16x32_bf16 v[16:19], a[12:15], a[172:175], v[16:19]
ds_read_b128 a[136:139], v1 offset:26624
v_mov_b32 v241, 0
v_mfma_f32_16x16x32_bf16 v[20:23], a[0:3], a[176:179], v[84:87]
ds_read_b128 a[140:143], v1 offset:27648
v_mov_b32 v242, 0
v_mfma_f32_16x16x32_bf16 v[20:23], a[4:7], a[180:183], v[20:23]
ds_read_b128 a[144:147], v1 offset:28672
v_mov_b32 v243, 0
v_mfma_f32_16x16x32_bf16 v[20:23], a[8:11], a[184:187], v[20:23]
ds_read_b128 a[148:151], v1 offset:29696
s_mov_b32 s9, 0x0
v_mfma_f32_16x16x32_bf16 v[20:23], a[12:15], a[188:191], v[20:23]
buffer_load_dword a244, v8, s[72:75], s9 offen
v_mfma_f32_16x16x32_bf16 v[24:27], a[0:3], a[192:195], v[88:91]
ds_read_b128 a[152:155], v1 offset:30720
v_mov_b32 v244, 0
v_mfma_f32_16x16x32_bf16 v[24:27], a[4:7], a[196:199], v[24:27]
ds_read_b128 a[156:159], v1 offset:31744
v_exp_f32 v16, v16
v_mfma_f32_16x16x32_bf16 v[24:27], a[8:11], a[200:203], v[24:27]
v_exp_f32 v17, v17
v_mfma_f32_16x16x32_bf16 v[24:27], a[12:15], a[204:207], v[24:27]
v_exp_f32 v18, v18
v_mfma_f32_16x16x32_bf16 v[28:31], a[0:3], a[208:211], v[92:95]
buffer_load_dwordx4 v3, s[48:51], s32 offen offset:1024 sc1 lds
v_mfma_f32_16x16x32_bf16 v[28:31], a[4:7], a[212:215], v[28:31]
v_exp_f32 v19, v19
v_mfma_f32_16x16x32_bf16 v[28:31], a[8:11], a[216:219], v[28:31]
v_exp_f32 v20, v20
v_mfma_f32_16x16x32_bf16 v[28:31], a[12:15], a[220:223], v[28:31]
v_exp_f32 v21, v21
v_mfma_f32_16x16x32_bf16 v[32:35], a[16:19], a[160:163], v[80:83]
v_exp_f32 v22, v22
v_mfma_f32_16x16x32_bf16 v[32:35], a[20:23], a[164:167], v[32:35]
buffer_load_dwordx4 v3, s[48:51], s32 offen offset:2048 sc1 lds
v_mfma_f32_16x16x32_bf16 v[32:35], a[24:27], a[168:171], v[32:35]
v_exp_f32 v23, v23
v_mfma_f32_16x16x32_bf16 v[32:35], a[28:31], a[172:175], v[32:35]
v_exp_f32 v24, v24
v_mfma_f32_16x16x32_bf16 v[36:39], a[16:19], a[176:179], v[84:87]
v_exp_f32 v25, v25
v_mfma_f32_16x16x32_bf16 v[36:39], a[20:23], a[180:183], v[36:39]
v_exp_f32 v26, v26
v_mfma_f32_16x16x32_bf16 v[36:39], a[24:27], a[184:187], v[36:39]
buffer_load_dwordx4 v3, s[48:51], s32 offen offset:3072 sc1 lds
v_mfma_f32_16x16x32_bf16 v[36:39], a[28:31], a[188:191], v[36:39]
v_exp_f32 v27, v27
v_mfma_f32_16x16x32_bf16 v[40:43], a[16:19], a[192:195], v[88:91]
v_exp_f32 v28, v28
v_mfma_f32_16x16x32_bf16 v[40:43], a[20:23], a[196:199], v[40:43]
v_exp_f32 v29, v29
v_mfma_f32_16x16x32_bf16 v[40:43], a[24:27], a[200:203], v[40:43]
s_mov_b32 s9, 0x0
v_exp_f32 v30, v30
v_mfma_f32_16x16x32_bf16 v[40:43], a[28:31], a[204:207], v[40:43]
buffer_load_dword a244, v8, s[64:67], s9 offen
v_mfma_f32_16x16x32_bf16 v[44:47], a[16:19], a[208:211], v[92:95]
v_exp_f32 v31, v31
v_mfma_f32_16x16x32_bf16 v[44:47], a[20:23], a[212:215], v[44:47]
v_exp_f32 v32, v32
v_mfma_f32_16x16x32_bf16 v[44:47], a[24:27], a[216:219], v[44:47]
v_exp_f32 v33, v33
v_mfma_f32_16x16x32_bf16 v[44:47], a[28:31], a[220:223], v[44:47]
s_waitcnt lgkmcnt(0)
v_cvt_pk_bf16_f32 v48, v16, v17
v_cvt_pk_bf16_f32 v49, v18, v19
v_cvt_pk_bf16_f32 v52, v20, v21
v_cvt_pk_bf16_f32 v53, v22, v23
v_cvt_pk_bf16_f32 v56, v24, v25
v_cvt_pk_bf16_f32 v57, v26, v27
v_mov_b32 v245, 0
v_mov_b32 v246, 0
v_mov_b32 v247, 0
v_mfma_f32_16x16x32_bf16 v[16:19], a[128:131], a[160:163], v[96:99]
ds_read_b128 a[32:35], v1 offset:16384
v_cvt_pk_bf16_f32 v60, v28, v29
v_mfma_f32_16x16x32_bf16 v[16:19], a[132:135], a[164:167], v[16:19]
s_add_u32 m0, s27, 0x1000
v_exp_f32 v34, v34
v_mfma_f32_16x16x32_bf16 v[16:19], a[136:139], a[168:171], v[16:19]
buffer_load_dwordx4 v3, s[48:51], s7 offen offset:0 sc1 lds
v_mfma_f32_16x16x32_bf16 v[16:19], a[140:143], a[172:175], v[16:19]
ds_read_b128 a[36:39], v1 offset:17408
v_cvt_pk_bf16_f32 v61, v30, v31
v_mfma_f32_16x16x32_bf16 v[20:23], a[128:131], a[176:179], v[84:87]
v_exp_f32 v35, v35
v_mfma_f32_16x16x32_bf16 v[20:23], a[132:135], a[180:183], v[20:23]
v_exp_f32 v36, v36
v_mfma_f32_16x16x32_bf16 v[20:23], a[136:139], a[184:187], v[20:23]
ds_read_b128 a[40:43], v1 offset:18432
v_cvt_pk_bf16_f32 v50, v32, v33
v_mfma_f32_16x16x32_bf16 v[20:23], a[140:143], a[188:191], v[20:23]
buffer_load_dwordx4 v3, s[48:51], s7 offen offset:1024 sc1 lds
v_mfma_f32_16x16x32_bf16 v[24:27], a[128:131], a[192:195], v[88:91]
v_exp_f32 v37, v37
v_mfma_f32_16x16x32_bf16 v[24:27], a[132:135], a[196:199], v[24:27]
ds_read_b128 a[44:47], v1 offset:19456
v_cvt_pk_bf16_f32 v51, v34, v35
v_mfma_f32_16x16x32_bf16 v[24:27], a[136:139], a[200:203], v[24:27]
v_exp_f32 v38, v38
v_mfma_f32_16x16x32_bf16 v[24:27], a[140:143], a[204:207], v[24:27]
v_exp_f32 v39, v39
v_mfma_f32_16x16x32_bf16 v[28:31], a[128:131], a[208:211], v[92:95]
v_exp_f32 v40, v40
v_mfma_f32_16x16x32_bf16 v[28:31], a[132:135], a[212:215], v[28:31]
buffer_load_dwordx4 v3, s[48:51], s7 offen offset:2048 sc1 lds
v_mfma_f32_16x16x32_bf16 v[28:31], a[136:139], a[216:219], v[28:31]
ds_read_b128 a[48:51], v1 offset:20480
v_cvt_pk_bf16_f32 v54, v36, v37
v_mfma_f32_16x16x32_bf16 v[28:31], a[140:143], a[220:223], v[28:31]
v_exp_f32 v41, v41
v_mfma_f32_16x16x32_bf16 v[32:35], a[144:147], a[160:163], v[100:103]
ds_read_b128 a[52:55], v1 offset:21504
v_cvt_pk_bf16_f32 v55, v38, v39
v_mfma_f32_16x16x32_bf16 v[32:35], a[148:151], a[164:167], v[32:35]
s_mov_b32 s9, 0x400000
v_exp_f32 v42, v42
v_mfma_f32_16x16x32_bf16 v[32:35], a[152:155], a[168:171], v[32:35]
buffer_load_dword a244, v8, s[64:67], s9 offen
v_mfma_f32_16x16x32_bf16 v[32:35], a[156:159], a[172:175], v[32:35]
ds_read_b128 a[56:59], v1 offset:22528
v_cvt_pk_bf16_f32 v58, v40, v41
v_mfma_f32_16x16x32_bf16 v[36:39], a[144:147], a[176:179], v[84:87]
v_exp_f32 v43, v43
v_mfma_f32_16x16x32_bf16 v[36:39], a[148:151], a[180:183], v[36:39]
v_exp_f32 v44, v44
v_mfma_f32_16x16x32_bf16 v[36:39], a[152:155], a[184:187], v[36:39]
ds_read_b128 a[60:63], v1 offset:23552
v_xor_b32 v1, 0x8000, v1
v_mfma_f32_16x16x32_bf16 v[36:39], a[156:159], a[188:191], v[36:39]
buffer_load_dwordx4 v3, s[48:51], s7 offen offset:3072 sc1 lds
v_cvt_pk_bf16_f32 v59, v42, v43
v_mfma_f32_16x16x32_bf16 v[40:43], a[144:147], a[192:195], v[88:91]
s_add_u32 s32, s32, 0x8000
v_exp_f32 v45, v45
v_mfma_f32_16x16x32_bf16 v[40:43], a[148:151], a[196:199], v[40:43]
s_add_u32 s7, s7, 0x8000
v_exp_f32 v46, v46
v_mfma_f32_16x16x32_bf16 v[40:43], a[152:155], a[200:203], v[40:43]
s_xor_b32 s27, s27, 0x38000
v_exp_f32 v47, v47
v_mfma_f32_16x16x32_bf16 v[40:43], a[156:159], a[204:207], v[40:43]
v_exp_f32 v16, v16
v_cvt_pk_bf16_f32 v62, v44, v45
v_cvt_pk_bf16_f32 v63, v46, v47
v_mfma_f32_16x16x32_bf16 v[44:47], a[144:147], a[208:211], v[92:95]
v_exp_f32 v17, v17
v_mfma_f32_16x16x32_bf16 v[44:47], a[148:151], a[212:215], v[44:47]
v_exp_f32 v18, v18
v_mfma_f32_16x16x32_bf16 v[44:47], a[152:155], a[216:219], v[44:47]
s_waitcnt vmcnt(11) lgkmcnt(0)
v_exp_f32 v19, v19
v_mfma_f32_16x16x32_bf16 v[44:47], a[156:159], a[220:223], v[44:47]
s_barrier
v_cvt_pk_bf16_f32 v64, v16, v17
v_exp_f32 v20, v20
v_exp_f32 v21, v21
v_exp_f32 v22, v22
v_exp_f32 v23, v23
v_exp_f32 v24, v24
v_exp_f32 v25, v25
v_exp_f32 v26, v26
v_exp_f32 v27, v27
v_cvt_pk_bf16_f32 v65, v18, v19
v_cvt_pk_bf16_f32 v68, v20, v21
v_cvt_pk_bf16_f32 v69, v22, v23
s_cmp_lg_u32 s33, 0
s_cbranch_scc1 L_sig_bn1
s_lshl_b32 s8, s6, 2
s_add_u32 s8, s8, 192
s_cmp_lg_u32 s4, 0
s_cbranch_scc1 L_sig_bn1
v_mov_b32 v4, 1
s_mov_b64 exec, 1
buffer_atomic_add v4, off, s[84:87], s8 sc1
s_mov_b64 exec, -1
L_sig_bn1:
s_branch L_att_l1_1
L_att_seven0:
v_mfma_f32_16x16x32_bf16 v[192:195], a[32:35], v[56:59], v[192:195]
v_exp_f32 v30, v30
v_mfma_f32_16x16x32_bf16 v[224:227], a[32:35], v[60:63], v[224:227]
ds_read_b128 a[0:3], v1 offset:8192
v_cvt_pk_bf16_f32 v72, v24, v25
v_mfma_f32_16x16x32_bf16 v[228:231], a[36:39], v[60:63], v[228:231]
ds_read_b128 a[4:7], v1 offset:9216
v_cvt_pk_bf16_f32 v73, v26, v27
v_mfma_f32_16x16x32_bf16 v[196:199], a[36:39], v[56:59], v[196:199]
s_add_u32 m0, s27, 0x0
v_exp_f32 v31, v31
v_mfma_f32_16x16x32_bf16 v[200:203], a[40:43], v[56:59], v[200:203]
ds_read_b128 a[8:11], v1 offset:10240
v_cvt_pk_bf16_f32 v76, v28, v29
v_mfma_f32_16x16x32_bf16 v[232:235], a[40:43], v[60:63], v[232:235]
buffer_load_dwordx4 v3, s[48:51], s32 offen offset:0 sc1 lds
v_mfma_f32_16x16x32_bf16 v[236:239], a[44:47], v[60:63], v[236:239]
v_exp_f32 v40, v40
v_mfma_f32_16x16x32_bf16 v[204:207], a[44:47], v[56:59], v[204:207]
ds_read_b128 a[12:15], v1 offset:11264
v_cvt_pk_bf16_f32 v77, v30, v31
v_mfma_f32_16x16x32_bf16 v[208:211], a[48:51], v[56:59], v[208:211]
ds_read_b128 a[16:19], v1 offset:12288
v_mfma_f32_16x16x32_bf16 v[240:243], a[48:51], v[60:63], v[240:243]
buffer_load_dwordx4 v3, s[48:51], s32 offen offset:1024 sc1 lds
v_mfma_f32_16x16x32_bf16 v[244:247], a[52:55], v[60:63], v[244:247]
ds_read_b128 a[20:23], v1 offset:13312
v_mfma_f32_16x16x32_bf16 v[212:215], a[52:55], v[56:59], v[212:215]
ds_read_b128 a[24:27], v1 offset:14336
v_mfma_f32_16x16x32_bf16 v[216:219], a[56:59], v[56:59], v[216:219]
ds_read_b128 a[28:31], v1 offset:15360
v_mfma_f32_16x16x32_bf16 v[248:251], a[56:59], v[60:63], v[248:251]
ds_read_b128 a[32:35], v1 offset:0
v_exp_f32 v41, v41
v_mfma_f32_16x16x32_bf16 v[252:255], a[60:63], v[60:63], v[252:255]
v_exp_f32 v42, v42
v_mfma_f32_16x16x32_bf16 v[220:223], a[60:63], v[56:59], v[220:223]
s_waitcnt lgkmcnt(5)
v_exp_f32 v43, v43
v_smfmac_f32_16x16x64_bf16 a[228:231], a[232:235], v[56:63], v9
ds_read_b128 a[36:39], v1 offset:1024
v_cvt_pk_bf16_f32 v74, v40, v41
v_mfma_f32_16x16x32_bf16 v[24:27], a[0:3], a[192:195], v[88:91]
ds_read_b128 a[40:43], v1 offset:2048
v_exp_f32 v44, v44
v_mfma_f32_16x16x32_bf16 v[24:27], a[4:7], a[196:199], v[24:27]
buffer_load_dwordx4 v3, s[48:51], s32 offen offset:2048 sc1 lds
v_mfma_f32_16x16x32_bf16 v[24:27], a[8:11], a[200:203], v[24:27]
v_exp_f32 v45, v45
v_mfma_f32_16x16x32_bf16 v[24:27], a[12:15], a[204:207], v[24:27]
ds_read_b128 a[44:47], v1 offset:3072
v_cvt_pk_bf16_f32 v75, v42, v43
v_mfma_f32_16x16x32_bf16 v[28:31], a[0:3], a[208:211], v[92:95]
ds_read_b128 a[48:51], v1 offset:4096
v_exp_f32 v46, v46
v_mfma_f32_16x16x32_bf16 v[28:31], a[4:7], a[212:215], v[28:31]
s_waitcnt lgkmcnt(5)
v_exp_f32 v47, v47
v_mfma_f32_16x16x32_bf16 v[28:31], a[8:11], a[216:219], v[28:31]
ds_read_b128 a[52:55], v1 offset:5120
v_cvt_pk_bf16_f32 v78, v44, v45
v_mfma_f32_16x16x32_bf16 v[28:31], a[12:15], a[220:223], v[28:31]
buffer_load_dwordx4 v3, s[48:51], s32 offen offset:3072 sc1 lds
v_mfma_f32_16x16x32_bf16 v[40:43], a[16:19], a[192:195], v[88:91]
ds_read_b128 a[56:59], v1 offset:6144
s_add_u32 s32, s32, 0x8000
v_mfma_f32_16x16x32_bf16 v[40:43], a[20:23], a[196:199], v[40:43]
ds_read_b128 a[60:63], v1 offset:7168
v_cvt_pk_bf16_f32 v79, v46, v47
v_mfma_f32_16x16x32_bf16 v[40:43], a[24:27], a[200:203], v[40:43]
v_exp_f32 v24, v24
v_mfma_f32_16x16x32_bf16 v[40:43], a[28:31], a[204:207], v[40:43]
v_exp_f32 v25, v25
v_mfma_f32_16x16x32_bf16 v[44:47], a[16:19], a[208:211], v[92:95]
v_exp_f32 v26, v26
v_mfma_f32_16x16x32_bf16 v[44:47], a[20:23], a[212:215], v[44:47]
v_exp_f32 v27, v27
v_mfma_f32_16x16x32_bf16 v[44:47], a[24:27], a[216:219], v[44:47]
v_exp_f32 v28, v28
v_mfma_f32_16x16x32_bf16 v[44:47], a[28:31], a[220:223], v[44:47]
s_waitcnt lgkmcnt(0)
v_exp_f32 v29, v29
v_mfma_f32_16x16x32_bf16 v[192:195], a[32:35], v[72:75], v[192:195]
s_add_u32 m0, s27, 0x1000
v_exp_f32 v30, v30
v_mfma_f32_16x16x32_bf16 v[224:227], a[32:35], v[76:79], v[224:227]
buffer_load_dwordx4 v3, s[48:51], s7 offen offset:0 sc1 lds
v_mfma_f32_16x16x32_bf16 v[228:231], a[36:39], v[76:79], v[228:231]
v_exp_f32 v31, v31
v_mfma_f32_16x16x32_bf16 v[196:199], a[36:39], v[72:75], v[196:199]
ds_read_b128 a[0:3], v1 offset:24576
v_cvt_pk_bf16_f32 v56, v24, v25
v_mfma_f32_16x16x32_bf16 v[200:203], a[40:43], v[72:75], v[200:203]
ds_read_b128 a[4:7], v1 offset:25600
v_cvt_pk_bf16_f32 v57, v26, v27
v_mfma_f32_16x16x32_bf16 v[232:235], a[40:43], v[76:79], v[232:235]
v_exp_f32 v40, v40
v_mfma_f32_16x16x32_bf16 v[236:239], a[44:47], v[76:79], v[236:239]
ds_read_b128 a[8:11], v1 offset:26624
v_cvt_pk_bf16_f32 v60, v28, v29
v_mfma_f32_16x16x32_bf16 v[204:207], a[44:47], v[72:75], v[204:207]
v_exp_f32 v41, v41
v_mfma_f32_16x16x32_bf16 v[208:211], a[48:51], v[72:75], v[208:211]
ds_read_b128 a[12:15], v1 offset:27648
v_cvt_pk_bf16_f32 v61, v30, v31
v_mfma_f32_16x16x32_bf16 v[240:243], a[48:51], v[76:79], v[240:243]
ds_read_b128 a[16:19], v1 offset:28672
v_cvt_pk_bf16_f32 v58, v40, v41
v_mfma_f32_16x16x32_bf16 v[244:247], a[52:55], v[76:79], v[244:247]
v_exp_f32 v42, v42
v_mfma_f32_16x16x32_bf16 v[212:215], a[52:55], v[72:75], v[212:215]
buffer_load_dwordx4 v3, s[48:51], s7 offen offset:1024 sc1 lds
v_mfma_f32_16x16x32_bf16 v[216:219], a[56:59], v[72:75], v[216:219]
ds_read_b128 a[20:23], v1 offset:29696
v_mfma_f32_16x16x32_bf16 v[248:251], a[56:59], v[76:79], v[248:251]
ds_read_b128 a[24:27], v1 offset:30720
v_mfma_f32_16x16x32_bf16 v[252:255], a[60:63], v[76:79], v[252:255]
ds_read_b128 a[28:31], v1 offset:31744
v_mfma_f32_16x16x32_bf16 v[220:223], a[60:63], v[72:75], v[220:223]
s_waitcnt lgkmcnt(4)
v_exp_f32 v43, v43
v_smfmac_f32_16x16x64_bf16 a[228:231], a[232:235], v[72:79], v9
ds_read_b128 a[32:35], v1 offset:16384
v_cvt_pk_bf16_f32 v59, v42, v43
v_mfma_f32_16x16x32_bf16 v[24:27], a[0:3], a[192:195], v[88:91]
ds_read_b128 a[36:39], v1 offset:17408
v_mfma_f32_16x16x32_bf16 v[24:27], a[4:7], a[196:199], v[24:27]
buffer_load_dwordx4 v3, s[48:51], s7 offen offset:2048 sc1 lds
v_mfma_f32_16x16x32_bf16 v[24:27], a[8:11], a[200:203], v[24:27]
ds_read_b128 a[40:43], v1 offset:18432
v_exp_f32 v44, v44
v_mfma_f32_16x16x32_bf16 v[24:27], a[12:15], a[204:207], v[24:27]
ds_read_b128 a[44:47], v1 offset:19456
v_exp_f32 v45, v45
v_mfma_f32_16x16x32_bf16 v[28:31], a[0:3], a[208:211], v[92:95]
ds_read_b128 a[48:51], v1 offset:20480
v_exp_f32 v46, v46
v_mfma_f32_16x16x32_bf16 v[28:31], a[4:7], a[212:215], v[28:31]
s_waitcnt lgkmcnt(5)
v_exp_f32 v47, v47
v_mfma_f32_16x16x32_bf16 v[28:31], a[8:11], a[216:219], v[28:31]
ds_read_b128 a[52:55], v1 offset:21504
v_cvt_pk_bf16_f32 v62, v44, v45
v_mfma_f32_16x16x32_bf16 v[28:31], a[12:15], a[220:223], v[28:31]
ds_read_b128 a[56:59], v1 offset:22528
v_cvt_pk_bf16_f32 v63, v46, v47
v_mfma_f32_16x16x32_bf16 v[40:43], a[16:19], a[192:195], v[88:91]
ds_read_b128 a[60:63], v1 offset:23552
v_xor_b32 v1, 0x8000, v1
v_mfma_f32_16x16x32_bf16 v[40:43], a[20:23], a[196:199], v[40:43]
buffer_load_dwordx4 v3, s[48:51], s7 offen offset:3072 sc1 lds
v_mfma_f32_16x16x32_bf16 v[40:43], a[24:27], a[200:203], v[40:43]
s_add_u32 s7, s7, 0x8000
v_exp_f32 v24, v24
v_mfma_f32_16x16x32_bf16 v[40:43], a[28:31], a[204:207], v[40:43]
s_xor_b32 s27, s27, 0x38000
v_exp_f32 v25, v25
v_mfma_f32_16x16x32_bf16 v[44:47], a[16:19], a[208:211], v[92:95]
v_exp_f32 v26, v26
v_mfma_f32_16x16x32_bf16 v[44:47], a[20:23], a[212:215], v[44:47]
v_exp_f32 v27, v27
v_mfma_f32_16x16x32_bf16 v[44:47], a[24:27], a[216:219], v[44:47]
s_waitcnt vmcnt(16) lgkmcnt(0)
v_exp_f32 v28, v28
v_mfma_f32_16x16x32_bf16 v[44:47], a[28:31], a[220:223], v[44:47]
s_barrier
v_exp_f32 v29, v29
L_att_sodd0:
v_mfma_f32_16x16x32_bf16 v[192:195], a[32:35], v[56:59], v[192:195]
v_exp_f32 v30, v30
v_mfma_f32_16x16x32_bf16 v[224:227], a[32:35], v[60:63], v[224:227]
ds_read_b128 a[0:3], v2 offset:8192
v_cvt_pk_bf16_f32 v72, v24, v25
v_mfma_f32_16x16x32_bf16 v[228:231], a[36:39], v[60:63], v[228:231]
ds_read_b128 a[4:7], v2 offset:9216
v_cvt_pk_bf16_f32 v73, v26, v27
v_mfma_f32_16x16x32_bf16 v[196:199], a[36:39], v[56:59], v[196:199]
s_add_u32 m0, s19, 0x0
v_exp_f32 v31, v31
v_mfma_f32_16x16x32_bf16 v[200:203], a[40:43], v[56:59], v[200:203]
ds_read_b128 a[8:11], v2 offset:10240
v_cvt_pk_bf16_f32 v76, v28, v29
v_mfma_f32_16x16x32_bf16 v[232:235], a[40:43], v[60:63], v[232:235]
buffer_load_dwordx4 v3, s[48:51], s32 offen offset:0 sc1 lds
v_mfma_f32_16x16x32_bf16 v[236:239], a[44:47], v[60:63], v[236:239]
v_exp_f32 v40, v40
v_mfma_f32_16x16x32_bf16 v[204:207], a[44:47], v[56:59], v[204:207]
ds_read_b128 a[12:15], v2 offset:11264
v_cvt_pk_bf16_f32 v77, v30, v31
v_mfma_f32_16x16x32_bf16 v[208:211], a[48:51], v[56:59], v[208:211]
ds_read_b128 a[16:19], v2 offset:12288
v_mfma_f32_16x16x32_bf16 v[240:243], a[48:51], v[60:63], v[240:243]
buffer_load_dwordx4 v3, s[48:51], s32 offen offset:1024 sc1 lds
v_mfma_f32_16x16x32_bf16 v[244:247], a[52:55], v[60:63], v[244:247]
ds_read_b128 a[20:23], v2 offset:13312
v_mfma_f32_16x16x32_bf16 v[212:215], a[52:55], v[56:59], v[212:215]
ds_read_b128 a[24:27], v2 offset:14336
v_mfma_f32_16x16x32_bf16 v[216:219], a[56:59], v[56:59], v[216:219]
ds_read_b128 a[28:31], v2 offset:15360
v_mfma_f32_16x16x32_bf16 v[248:251], a[56:59], v[60:63], v[248:251]
ds_read_b128 a[32:35], v2 offset:0
v_exp_f32 v41, v41
v_mfma_f32_16x16x32_bf16 v[252:255], a[60:63], v[60:63], v[252:255]
v_exp_f32 v42, v42
v_mfma_f32_16x16x32_bf16 v[220:223], a[60:63], v[56:59], v[220:223]
s_waitcnt lgkmcnt(5)
v_exp_f32 v43, v43
v_smfmac_f32_16x16x64_bf16 a[228:231], a[232:235], v[56:63], v9
ds_read_b128 a[36:39], v2 offset:1024
v_cvt_pk_bf16_f32 v74, v40, v41
v_mfma_f32_16x16x32_bf16 v[24:27], a[0:3], a[192:195], v[88:91]
ds_read_b128 a[40:43], v2 offset:2048
v_exp_f32 v44, v44
v_mfma_f32_16x16x32_bf16 v[24:27], a[4:7], a[196:199], v[24:27]
buffer_load_dwordx4 v3, s[48:51], s32 offen offset:2048 sc1 lds
v_mfma_f32_16x16x32_bf16 v[24:27], a[8:11], a[200:203], v[24:27]
v_exp_f32 v45, v45
v_mfma_f32_16x16x32_bf16 v[24:27], a[12:15], a[204:207], v[24:27]
ds_read_b128 a[44:47], v2 offset:3072
v_cvt_pk_bf16_f32 v75, v42, v43
v_mfma_f32_16x16x32_bf16 v[28:31], a[0:3], a[208:211], v[92:95]
ds_read_b128 a[48:51], v2 offset:4096
v_exp_f32 v46, v46
v_mfma_f32_16x16x32_bf16 v[28:31], a[4:7], a[212:215], v[28:31]
s_waitcnt lgkmcnt(5)
v_exp_f32 v47, v47
v_mfma_f32_16x16x32_bf16 v[28:31], a[8:11], a[216:219], v[28:31]
ds_read_b128 a[52:55], v2 offset:5120
v_cvt_pk_bf16_f32 v78, v44, v45
v_mfma_f32_16x16x32_bf16 v[28:31], a[12:15], a[220:223], v[28:31]
buffer_load_dwordx4 v3, s[48:51], s32 offen offset:3072 sc1 lds
v_mfma_f32_16x16x32_bf16 v[40:43], a[16:19], a[192:195], v[88:91]
ds_read_b128 a[56:59], v2 offset:6144
s_add_u32 s32, s32, 0x8000
v_mfma_f32_16x16x32_bf16 v[40:43], a[20:23], a[196:199], v[40:43]
ds_read_b128 a[60:63], v2 offset:7168
v_cvt_pk_bf16_f32 v79, v46, v47
v_mfma_f32_16x16x32_bf16 v[40:43], a[24:27], a[200:203], v[40:43]
v_exp_f32 v24, v24
v_mfma_f32_16x16x32_bf16 v[40:43], a[28:31], a[204:207], v[40:43]
v_exp_f32 v25, v25
v_mfma_f32_16x16x32_bf16 v[44:47], a[16:19], a[208:211], v[92:95]
v_exp_f32 v26, v26
v_mfma_f32_16x16x32_bf16 v[44:47], a[20:23], a[212:215], v[44:47]
v_exp_f32 v27, v27
v_mfma_f32_16x16x32_bf16 v[44:47], a[24:27], a[216:219], v[44:47]
v_exp_f32 v28, v28
v_mfma_f32_16x16x32_bf16 v[44:47], a[28:31], a[220:223], v[44:47]
s_waitcnt lgkmcnt(0)
v_exp_f32 v29, v29
v_mfma_f32_16x16x32_bf16 v[192:195], a[32:35], v[72:75], v[192:195]
v_exp_f32 v30, v30
v_mfma_f32_16x16x32_bf16 v[224:227], a[32:35], v[76:79], v[224:227]
v_exp_f32 v31, v31
v_mfma_f32_16x16x32_bf16 v[228:231], a[36:39], v[76:79], v[228:231]
v_exp_f32 v40, v40
v_mfma_f32_16x16x32_bf16 v[196:199], a[36:39], v[72:75], v[196:199]
s_add_u32 m0, s19, 0x1000
v_exp_f32 v41, v41
v_mfma_f32_16x16x32_bf16 v[200:203], a[40:43], v[72:75], v[200:203]
ds_read_b128 a[0:3], v2 offset:24576
v_cvt_pk_bf16_f32 v56, v24, v25
v_mfma_f32_16x16x32_bf16 v[232:235], a[40:43], v[76:79], v[232:235]
buffer_load_dwordx4 v3, s[48:51], s7 offen offset:0 sc1 lds
v_mfma_f32_16x16x32_bf16 v[236:239], a[44:47], v[76:79], v[236:239]
ds_read_b128 a[4:7], v2 offset:25600
v_cvt_pk_bf16_f32 v57, v26, v27
v_mfma_f32_16x16x32_bf16 v[204:207], a[44:47], v[72:75], v[204:207]
ds_read_b128 a[8:11], v2 offset:26624
v_cvt_pk_bf16_f32 v60, v28, v29
v_mfma_f32_16x16x32_bf16 v[208:211], a[48:51], v[72:75], v[208:211]
ds_read_b128 a[12:15], v2 offset:27648
v_cvt_pk_bf16_f32 v61, v30, v31
v_mfma_f32_16x16x32_bf16 v[240:243], a[48:51], v[76:79], v[240:243]
ds_read_b128 a[16:19], v2 offset:28672
v_cvt_pk_bf16_f32 v58, v40, v41
v_mfma_f32_16x16x32_bf16 v[244:247], a[52:55], v[76:79], v[244:247]
buffer_load_dwordx4 v3, s[48:51], s7 offen offset:1024 sc1 lds
v_mfma_f32_16x16x32_bf16 v[212:215], a[52:55], v[72:75], v[212:215]
ds_read_b128 a[20:23], v2 offset:29696
v_mfma_f32_16x16x32_bf16 v[216:219], a[56:59], v[72:75], v[216:219]
v_exp_f32 v42, v42
v_mfma_f32_16x16x32_bf16 v[248:251], a[56:59], v[76:79], v[248:251]
ds_read_b128 a[24:27], v2 offset:30720
v_mfma_f32_16x16x32_bf16 v[252:255], a[60:63], v[76:79], v[252:255]
ds_read_b128 a[28:31], v2 offset:31744
v_exp_f32 v43, v43
v_mfma_f32_16x16x32_bf16 v[220:223], a[60:63], v[72:75], v[220:223]
ds_read_b128 a[32:35], v2 offset:16384
v_cvt_pk_bf16_f32 v59, v42, v43
v_smfmac_f32_16x16x64_bf16 a[228:231], a[232:235], v[72:79], v9
ds_read_b128 a[36:39], v2 offset:17408
s_waitcnt lgkmcnt(6)
v_mfma_f32_16x16x32_bf16 v[24:27], a[0:3], a[192:195], v[88:91]
buffer_load_dwordx4 v3, s[48:51], s7 offen offset:2048 sc1 lds
v_mfma_f32_16x16x32_bf16 v[24:27], a[4:7], a[196:199], v[24:27]
ds_read_b128 a[40:43], v2 offset:18432
v_exp_f32 v44, v44
v_mfma_f32_16x16x32_bf16 v[24:27], a[8:11], a[200:203], v[24:27]
ds_read_b128 a[44:47], v2 offset:19456
v_exp_f32 v45, v45
v_mfma_f32_16x16x32_bf16 v[24:27], a[12:15], a[204:207], v[24:27]
ds_read_b128 a[48:51], v2 offset:20480
v_cvt_pk_bf16_f32 v62, v44, v45
v_mfma_f32_16x16x32_bf16 v[28:31], a[0:3], a[208:211], v[92:95]
v_exp_f32 v46, v46
v_mfma_f32_16x16x32_bf16 v[28:31], a[4:7], a[212:215], v[28:31]
s_waitcnt lgkmcnt(5)
v_exp_f32 v47, v47
v_mfma_f32_16x16x32_bf16 v[28:31], a[8:11], a[216:219], v[28:31]
ds_read_b128 a[52:55], v2 offset:21504
v_cvt_pk_bf16_f32 v63, v46, v47
v_mfma_f32_16x16x32_bf16 v[28:31], a[12:15], a[220:223], v[28:31]
buffer_load_dwordx4 v3, s[48:51], s7 offen offset:3072 sc1 lds
v_mfma_f32_16x16x32_bf16 v[40:43], a[16:19], a[192:195], v[88:91]
ds_read_b128 a[56:59], v2 offset:22528
s_add_u32 s7, s7, 0x8000
v_mfma_f32_16x16x32_bf16 v[40:43], a[20:23], a[196:199], v[40:43]
ds_read_b128 a[60:63], v2 offset:23552
v_xor_b32 v2, 0x38000, v2
v_mfma_f32_16x16x32_bf16 v[40:43], a[24:27], a[200:203], v[40:43]
s_xor_b32 s19, s19, 0x8000
v_exp_f32 v24, v24
v_mfma_f32_16x16x32_bf16 v[40:43], a[28:31], a[204:207], v[40:43]
s_sub_u32 s15, s15, 1
v_exp_f32 v25, v25
v_mfma_f32_16x16x32_bf16 v[44:47], a[16:19], a[208:211], v[92:95]
s_cmp_lg_u32 s15, 0
v_exp_f32 v26, v26
v_mfma_f32_16x16x32_bf16 v[44:47], a[20:23], a[212:215], v[44:47]
v_exp_f32 v27, v27
v_mfma_f32_16x16x32_bf16 v[44:47], a[24:27], a[216:219], v[44:47]
s_waitcnt vmcnt(16) lgkmcnt(0)
v_exp_f32 v28, v28
v_mfma_f32_16x16x32_bf16 v[44:47], a[28:31], a[220:223], v[44:47]
s_barrier
v_exp_f32 v29, v29
s_cbranch_scc1 L_att_seven0
s_branch L_att_sdone
L_att_seven1:
v_mfma_f32_16x16x32_bf16 v[192:195], a[32:35], v[56:59], v[192:195]
v_exp_f32 v30, v30
v_mfma_f32_16x16x32_bf16 v[224:227], a[32:35], v[60:63], v[224:227]
ds_read_b128 a[0:3], v1 offset:8192
v_cvt_pk_bf16_f32 v72, v24, v25
v_mfma_f32_16x16x32_bf16 v[228:231], a[36:39], v[60:63], v[228:231]
ds_read_b128 a[4:7], v1 offset:9216
v_cvt_pk_bf16_f32 v73, v26, v27
v_mfma_f32_16x16x32_bf16 v[196:199], a[36:39], v[56:59], v[196:199]
s_add_u32 m0, s27, 0x0
v_exp_f32 v31, v31
v_mfma_f32_16x16x32_bf16 v[200:203], a[40:43], v[56:59], v[200:203]
ds_read_b128 a[8:11], v1 offset:10240
v_cvt_pk_bf16_f32 v76, v28, v29
v_mfma_f32_16x16x32_bf16 v[232:235], a[40:43], v[60:63], v[232:235]
buffer_load_dwordx4 v3, s[48:51], s32 offen offset:0 sc1 lds
v_mfma_f32_16x16x32_bf16 v[236:239], a[44:47], v[60:63], v[236:239]
v_exp_f32 v40, v40
v_mfma_f32_16x16x32_bf16 v[204:207], a[44:47], v[56:59], v[204:207]
ds_read_b128 a[12:15], v1 offset:11264
v_cvt_pk_bf16_f32 v77, v30, v31
v_mfma_f32_16x16x32_bf16 v[208:211], a[48:51], v[56:59], v[208:211]
ds_read_b128 a[16:19], v1 offset:12288
v_mfma_f32_16x16x32_bf16 v[240:243], a[48:51], v[60:63], v[240:243]
buffer_load_dwordx4 v3, s[48:51], s32 offen offset:1024 sc1 lds
v_mfma_f32_16x16x32_bf16 v[244:247], a[52:55], v[60:63], v[244:247]
ds_read_b128 a[20:23], v1 offset:13312
v_mfma_f32_16x16x32_bf16 v[212:215], a[52:55], v[56:59], v[212:215]
ds_read_b128 a[24:27], v1 offset:14336
v_mfma_f32_16x16x32_bf16 v[216:219], a[56:59], v[56:59], v[216:219]
ds_read_b128 a[28:31], v1 offset:15360
v_mfma_f32_16x16x32_bf16 v[248:251], a[56:59], v[60:63], v[248:251]
ds_read_b128 a[32:35], v1 offset:0
v_exp_f32 v41, v41
v_mfma_f32_16x16x32_bf16 v[252:255], a[60:63], v[60:63], v[252:255]
v_exp_f32 v42, v42
v_mfma_f32_16x16x32_bf16 v[220:223], a[60:63], v[56:59], v[220:223]
s_waitcnt lgkmcnt(5)
v_exp_f32 v43, v43
v_smfmac_f32_16x16x64_bf16 a[228:231], a[232:235], v[56:63], v9
ds_read_b128 a[36:39], v1 offset:1024
v_cvt_pk_bf16_f32 v74, v40, v41
v_mfma_f32_16x16x32_bf16 v[24:27], a[0:3], a[192:195], v[88:91]
ds_read_b128 a[40:43], v1 offset:2048
v_exp_f32 v44, v44
v_mfma_f32_16x16x32_bf16 v[24:27], a[4:7], a[196:199], v[24:27]
buffer_load_dwordx4 v3, s[48:51], s32 offen offset:2048 sc1 lds
v_mfma_f32_16x16x32_bf16 v[24:27], a[8:11], a[200:203], v[24:27]
v_exp_f32 v45, v45
v_mfma_f32_16x16x32_bf16 v[24:27], a[12:15], a[204:207], v[24:27]
ds_read_b128 a[44:47], v1 offset:3072
v_cvt_pk_bf16_f32 v75, v42, v43
v_mfma_f32_16x16x32_bf16 v[28:31], a[0:3], a[208:211], v[92:95]
ds_read_b128 a[48:51], v1 offset:4096
v_exp_f32 v46, v46
v_mfma_f32_16x16x32_bf16 v[28:31], a[4:7], a[212:215], v[28:31]
s_waitcnt lgkmcnt(5)
v_exp_f32 v47, v47
v_mfma_f32_16x16x32_bf16 v[28:31], a[8:11], a[216:219], v[28:31]
ds_read_b128 a[52:55], v1 offset:5120
v_cvt_pk_bf16_f32 v78, v44, v45
v_mfma_f32_16x16x32_bf16 v[28:31], a[12:15], a[220:223], v[28:31]
buffer_load_dwordx4 v3, s[48:51], s32 offen offset:3072 sc1 lds
v_mfma_f32_16x16x32_bf16 v[40:43], a[16:19], a[192:195], v[88:91]
ds_read_b128 a[56:59], v1 offset:6144
s_add_u32 s32, s32, 0x8000
v_mfma_f32_16x16x32_bf16 v[40:43], a[20:23], a[196:199], v[40:43]
ds_read_b128 a[60:63], v1 offset:7168
v_cvt_pk_bf16_f32 v79, v46, v47
v_mfma_f32_16x16x32_bf16 v[40:43], a[24:27], a[200:203], v[40:43]
v_exp_f32 v24, v24
v_mfma_f32_16x16x32_bf16 v[40:43], a[28:31], a[204:207], v[40:43]
v_exp_f32 v25, v25
v_mfma_f32_16x16x32_bf16 v[44:47], a[16:19], a[208:211], v[92:95]
v_exp_f32 v26, v26
v_mfma_f32_16x16x32_bf16 v[44:47], a[20:23], a[212:215], v[44:47]
v_exp_f32 v27, v27
v_mfma_f32_16x16x32_bf16 v[44:47], a[24:27], a[216:219], v[44:47]
v_exp_f32 v28, v28
v_mfma_f32_16x16x32_bf16 v[44:47], a[28:31], a[220:223], v[44:47]
s_waitcnt lgkmcnt(0)
v_exp_f32 v29, v29
v_mfma_f32_16x16x32_bf16 v[192:195], a[32:35], v[72:75], v[192:195]
s_add_u32 m0, s27, 0x1000
v_exp_f32 v30, v30
v_mfma_f32_16x16x32_bf16 v[224:227], a[32:35], v[76:79], v[224:227]
buffer_load_dwordx4 v3, s[48:51], s7 offen offset:0 sc1 lds
v_mfma_f32_16x16x32_bf16 v[228:231], a[36:39], v[76:79], v[228:231]
v_exp_f32 v31, v31
v_mfma_f32_16x16x32_bf16 v[196:199], a[36:39], v[72:75], v[196:199]
ds_read_b128 a[0:3], v1 offset:24576
v_cvt_pk_bf16_f32 v56, v24, v25
v_mfma_f32_16x16x32_bf16 v[200:203], a[40:43], v[72:75], v[200:203]
ds_read_b128 a[4:7], v1 offset:25600
v_cvt_pk_bf16_f32 v57, v26, v27
v_mfma_f32_16x16x32_bf16 v[232:235], a[40:43], v[76:79], v[232:235]
v_exp_f32 v40, v40
v_mfma_f32_16x16x32_bf16 v[236:239], a[44:47], v[76:79], v[236:239]
ds_read_b128 a[8:11], v1 offset:26624
v_cvt_pk_bf16_f32 v60, v28, v29
v_mfma_f32_16x16x32_bf16 v[204:207], a[44:47], v[72:75], v[204:207]
v_exp_f32 v41, v41
v_mfma_f32_16x16x32_bf16 v[208:211], a[48:51], v[72:75], v[208:211]
ds_read_b128 a[12:15], v1 offset:27648
v_cvt_pk_bf16_f32 v61, v30, v31
v_mfma_f32_16x16x32_bf16 v[240:243], a[48:51], v[76:79], v[240:243]
ds_read_b128 a[16:19], v1 offset:28672
v_cvt_pk_bf16_f32 v58, v40, v41
v_mfma_f32_16x16x32_bf16 v[244:247], a[52:55], v[76:79], v[244:247]
v_exp_f32 v42, v42
v_mfma_f32_16x16x32_bf16 v[212:215], a[52:55], v[72:75], v[212:215]
buffer_load_dwordx4 v3, s[48:51], s7 offen offset:1024 sc1 lds
v_mfma_f32_16x16x32_bf16 v[216:219], a[56:59], v[72:75], v[216:219]
ds_read_b128 a[20:23], v1 offset:29696
v_mfma_f32_16x16x32_bf16 v[248:251], a[56:59], v[76:79], v[248:251]
ds_read_b128 a[24:27], v1 offset:30720
v_mfma_f32_16x16x32_bf16 v[252:255], a[60:63], v[76:79], v[252:255]
ds_read_b128 a[28:31], v1 offset:31744
v_mfma_f32_16x16x32_bf16 v[220:223], a[60:63], v[72:75], v[220:223]
s_waitcnt lgkmcnt(4)
v_exp_f32 v43, v43
v_smfmac_f32_16x16x64_bf16 a[228:231], a[232:235], v[72:79], v9
ds_read_b128 a[32:35], v1 offset:16384
v_cvt_pk_bf16_f32 v59, v42, v43
v_mfma_f32_16x16x32_bf16 v[24:27], a[0:3], a[192:195], v[88:91]
ds_read_b128 a[36:39], v1 offset:17408
v_mfma_f32_16x16x32_bf16 v[24:27], a[4:7], a[196:199], v[24:27]
buffer_load_dwordx4 v3, s[48:51], s7 offen offset:2048 sc1 lds
v_mfma_f32_16x16x32_bf16 v[24:27], a[8:11], a[200:203], v[24:27]
ds_read_b128 a[40:43], v1 offset:18432
v_exp_f32 v44, v44
v_mfma_f32_16x16x32_bf16 v[24:27], a[12:15], a[204:207], v[24:27]
ds_read_b128 a[44:47], v1 offset:19456
v_exp_f32 v45, v45
v_mfma_f32_16x16x32_bf16 v[28:31], a[0:3], a[208:211], v[92:95]
ds_read_b128 a[48:51], v1 offset:20480
v_exp_f32 v46, v46
v_mfma_f32_16x16x32_bf16 v[28:31], a[4:7], a[212:215], v[28:31]
s_waitcnt lgkmcnt(5)
v_exp_f32 v47, v47
v_mfma_f32_16x16x32_bf16 v[28:31], a[8:11], a[216:219], v[28:31]
ds_read_b128 a[52:55], v1 offset:21504
v_cvt_pk_bf16_f32 v62, v44, v45
v_mfma_f32_16x16x32_bf16 v[28:31], a[12:15], a[220:223], v[28:31]
ds_read_b128 a[56:59], v1 offset:22528
v_cvt_pk_bf16_f32 v63, v46, v47
v_mfma_f32_16x16x32_bf16 v[40:43], a[16:19], a[192:195], v[88:91]
ds_read_b128 a[60:63], v1 offset:23552
v_xor_b32 v1, 0x8000, v1
v_mfma_f32_16x16x32_bf16 v[40:43], a[20:23], a[196:199], v[40:43]
buffer_load_dwordx4 v3, s[48:51], s7 offen offset:3072 sc1 lds
v_mfma_f32_16x16x32_bf16 v[40:43], a[24:27], a[200:203], v[40:43]
s_add_u32 s7, s7, 0x8000
v_exp_f32 v24, v24
v_mfma_f32_16x16x32_bf16 v[40:43], a[28:31], a[204:207], v[40:43]
s_xor_b32 s27, s27, 0x38000
v_exp_f32 v25, v25
v_mfma_f32_16x16x32_bf16 v[44:47], a[16:19], a[208:211], v[92:95]
s_waitcnt vmcnt(16) lgkmcnt(0)
v_exp_f32 v26, v26
v_mfma_f32_16x16x32_bf16 v[44:47], a[20:23], a[212:215], v[44:47]
s_barrier
v_exp_f32 v27, v27
v_mfma_f32_16x16x32_bf16 v[44:47], a[24:27], a[216:219], v[44:47]
v_exp_f32 v28, v28
v_mfma_f32_16x16x32_bf16 v[44:47], a[28:31], a[220:223], v[44:47]
v_exp_f32 v29, v29
L_att_sodd1:
v_mfma_f32_16x16x32_bf16 v[192:195], a[32:35], v[56:59], v[192:195]
v_exp_f32 v30, v30
v_mfma_f32_16x16x32_bf16 v[224:227], a[32:35], v[60:63], v[224:227]
ds_read_b128 a[0:3], v2 offset:8192
v_cvt_pk_bf16_f32 v72, v24, v25
v_mfma_f32_16x16x32_bf16 v[228:231], a[36:39], v[60:63], v[228:231]
ds_read_b128 a[4:7], v2 offset:9216
v_cvt_pk_bf16_f32 v73, v26, v27
v_mfma_f32_16x16x32_bf16 v[196:199], a[36:39], v[56:59], v[196:199]
s_add_u32 m0, s19, 0x0
v_exp_f32 v31, v31
v_mfma_f32_16x16x32_bf16 v[200:203], a[40:43], v[56:59], v[200:203]
ds_read_b128 a[8:11], v2 offset:10240
v_cvt_pk_bf16_f32 v76, v28, v29
v_mfma_f32_16x16x32_bf16 v[232:235], a[40:43], v[60:63], v[232:235]
buffer_load_dwordx4 v3, s[48:51], s32 offen offset:0 sc1 lds
v_mfma_f32_16x16x32_bf16 v[236:239], a[44:47], v[60:63], v[236:239]
v_exp_f32 v40, v40
v_mfma_f32_16x16x32_bf16 v[204:207], a[44:47], v[56:59], v[204:207]
ds_read_b128 a[12:15], v2 offset:11264
v_cvt_pk_bf16_f32 v77, v30, v31
v_mfma_f32_16x16x32_bf16 v[208:211], a[48:51], v[56:59], v[208:211]
ds_read_b128 a[16:19], v2 offset:12288
v_mfma_f32_16x16x32_bf16 v[240:243], a[48:51], v[60:63], v[240:243]
buffer_load_dwordx4 v3, s[48:51], s32 offen offset:1024 sc1 lds
v_mfma_f32_16x16x32_bf16 v[244:247], a[52:55], v[60:63], v[244:247]
ds_read_b128 a[20:23], v2 offset:13312
v_mfma_f32_16x16x32_bf16 v[212:215], a[52:55], v[56:59], v[212:215]
ds_read_b128 a[24:27], v2 offset:14336
v_mfma_f32_16x16x32_bf16 v[216:219], a[56:59], v[56:59], v[216:219]
ds_read_b128 a[28:31], v2 offset:15360
v_mfma_f32_16x16x32_bf16 v[248:251], a[56:59], v[60:63], v[248:251]
ds_read_b128 a[32:35], v2 offset:0
v_exp_f32 v41, v41
v_mfma_f32_16x16x32_bf16 v[252:255], a[60:63], v[60:63], v[252:255]
v_exp_f32 v42, v42
v_mfma_f32_16x16x32_bf16 v[220:223], a[60:63], v[56:59], v[220:223]
s_waitcnt lgkmcnt(5)
v_exp_f32 v43, v43
v_smfmac_f32_16x16x64_bf16 a[228:231], a[232:235], v[56:63], v9
ds_read_b128 a[36:39], v2 offset:1024
v_cvt_pk_bf16_f32 v74, v40, v41
v_mfma_f32_16x16x32_bf16 v[24:27], a[0:3], a[192:195], v[88:91]
ds_read_b128 a[40:43], v2 offset:2048
v_exp_f32 v44, v44
v_mfma_f32_16x16x32_bf16 v[24:27], a[4:7], a[196:199], v[24:27]
buffer_load_dwordx4 v3, s[48:51], s32 offen offset:2048 sc1 lds
v_mfma_f32_16x16x32_bf16 v[24:27], a[8:11], a[200:203], v[24:27]
v_exp_f32 v45, v45
v_mfma_f32_16x16x32_bf16 v[24:27], a[12:15], a[204:207], v[24:27]
ds_read_b128 a[44:47], v2 offset:3072
v_cvt_pk_bf16_f32 v75, v42, v43
v_mfma_f32_16x16x32_bf16 v[28:31], a[0:3], a[208:211], v[92:95]
ds_read_b128 a[48:51], v2 offset:4096
v_exp_f32 v46, v46
v_mfma_f32_16x16x32_bf16 v[28:31], a[4:7], a[212:215], v[28:31]
s_waitcnt lgkmcnt(5)
v_exp_f32 v47, v47
v_mfma_f32_16x16x32_bf16 v[28:31], a[8:11], a[216:219], v[28:31]
ds_read_b128 a[52:55], v2 offset:5120
v_cvt_pk_bf16_f32 v78, v44, v45
v_mfma_f32_16x16x32_bf16 v[28:31], a[12:15], a[220:223], v[28:31]
buffer_load_dwordx4 v3, s[48:51], s32 offen offset:3072 sc1 lds
v_mfma_f32_16x16x32_bf16 v[40:43], a[16:19], a[192:195], v[88:91]
ds_read_b128 a[56:59], v2 offset:6144
s_add_u32 s32, s32, 0x8000
v_mfma_f32_16x16x32_bf16 v[40:43], a[20:23], a[196:199], v[40:43]
ds_read_b128 a[60:63], v2 offset:7168
v_cvt_pk_bf16_f32 v79, v46, v47
v_mfma_f32_16x16x32_bf16 v[40:43], a[24:27], a[200:203], v[40:43]
v_exp_f32 v24, v24
v_mfma_f32_16x16x32_bf16 v[40:43], a[28:31], a[204:207], v[40:43]
v_exp_f32 v25, v25
v_mfma_f32_16x16x32_bf16 v[44:47], a[16:19], a[208:211], v[92:95]
v_exp_f32 v26, v26
v_mfma_f32_16x16x32_bf16 v[44:47], a[20:23], a[212:215], v[44:47]
v_exp_f32 v27, v27
v_mfma_f32_16x16x32_bf16 v[44:47], a[24:27], a[216:219], v[44:47]
v_exp_f32 v28, v28
v_mfma_f32_16x16x32_bf16 v[44:47], a[28:31], a[220:223], v[44:47]
s_waitcnt lgkmcnt(0)
v_exp_f32 v29, v29
v_mfma_f32_16x16x32_bf16 v[192:195], a[32:35], v[72:75], v[192:195]
v_exp_f32 v30, v30
v_mfma_f32_16x16x32_bf16 v[224:227], a[32:35], v[76:79], v[224:227]
v_exp_f32 v31, v31
v_mfma_f32_16x16x32_bf16 v[228:231], a[36:39], v[76:79], v[228:231]
v_exp_f32 v40, v40
v_mfma_f32_16x16x32_bf16 v[196:199], a[36:39], v[72:75], v[196:199]
s_add_u32 m0, s19, 0x1000
v_exp_f32 v41, v41
v_mfma_f32_16x16x32_bf16 v[200:203], a[40:43], v[72:75], v[200:203]
ds_read_b128 a[0:3], v2 offset:24576
v_cvt_pk_bf16_f32 v56, v24, v25
v_mfma_f32_16x16x32_bf16 v[232:235], a[40:43], v[76:79], v[232:235]
buffer_load_dwordx4 v3, s[48:51], s7 offen offset:0 sc1 lds
v_mfma_f32_16x16x32_bf16 v[236:239], a[44:47], v[76:79], v[236:239]
ds_read_b128 a[4:7], v2 offset:25600
v_cvt_pk_bf16_f32 v57, v26, v27
v_mfma_f32_16x16x32_bf16 v[204:207], a[44:47], v[72:75], v[204:207]
ds_read_b128 a[8:11], v2 offset:26624
v_cvt_pk_bf16_f32 v60, v28, v29
v_mfma_f32_16x16x32_bf16 v[208:211], a[48:51], v[72:75], v[208:211]
ds_read_b128 a[12:15], v2 offset:27648
v_cvt_pk_bf16_f32 v61, v30, v31
v_mfma_f32_16x16x32_bf16 v[240:243], a[48:51], v[76:79], v[240:243]
ds_read_b128 a[16:19], v2 offset:28672
v_cvt_pk_bf16_f32 v58, v40, v41
v_mfma_f32_16x16x32_bf16 v[244:247], a[52:55], v[76:79], v[244:247]
buffer_load_dwordx4 v3, s[48:51], s7 offen offset:1024 sc1 lds
v_mfma_f32_16x16x32_bf16 v[212:215], a[52:55], v[72:75], v[212:215]
ds_read_b128 a[20:23], v2 offset:29696
v_mfma_f32_16x16x32_bf16 v[216:219], a[56:59], v[72:75], v[216:219]
v_exp_f32 v42, v42
v_mfma_f32_16x16x32_bf16 v[248:251], a[56:59], v[76:79], v[248:251]
ds_read_b128 a[24:27], v2 offset:30720
v_mfma_f32_16x16x32_bf16 v[252:255], a[60:63], v[76:79], v[252:255]
ds_read_b128 a[28:31], v2 offset:31744
v_exp_f32 v43, v43
v_mfma_f32_16x16x32_bf16 v[220:223], a[60:63], v[72:75], v[220:223]
ds_read_b128 a[32:35], v2 offset:16384
v_cvt_pk_bf16_f32 v59, v42, v43
v_smfmac_f32_16x16x64_bf16 a[228:231], a[232:235], v[72:79], v9
ds_read_b128 a[36:39], v2 offset:17408
s_waitcnt lgkmcnt(6)
v_mfma_f32_16x16x32_bf16 v[24:27], a[0:3], a[192:195], v[88:91]
buffer_load_dwordx4 v3, s[48:51], s7 offen offset:2048 sc1 lds
v_mfma_f32_16x16x32_bf16 v[24:27], a[4:7], a[196:199], v[24:27]
ds_read_b128 a[40:43], v2 offset:18432
v_exp_f32 v44, v44
v_mfma_f32_16x16x32_bf16 v[24:27], a[8:11], a[200:203], v[24:27]
ds_read_b128 a[44:47], v2 offset:19456
v_exp_f32 v45, v45
v_mfma_f32_16x16x32_bf16 v[24:27], a[12:15], a[204:207], v[24:27]
ds_read_b128 a[48:51], v2 offset:20480
v_cvt_pk_bf16_f32 v62, v44, v45
v_mfma_f32_16x16x32_bf16 v[28:31], a[0:3], a[208:211], v[92:95]
v_exp_f32 v46, v46
v_mfma_f32_16x16x32_bf16 v[28:31], a[4:7], a[212:215], v[28:31]
s_waitcnt lgkmcnt(5)
v_exp_f32 v47, v47
v_mfma_f32_16x16x32_bf16 v[28:31], a[8:11], a[216:219], v[28:31]
ds_read_b128 a[52:55], v2 offset:21504
v_cvt_pk_bf16_f32 v63, v46, v47
v_mfma_f32_16x16x32_bf16 v[28:31], a[12:15], a[220:223], v[28:31]
buffer_load_dwordx4 v3, s[48:51], s7 offen offset:3072 sc1 lds
v_mfma_f32_16x16x32_bf16 v[40:43], a[16:19], a[192:195], v[88:91]
ds_read_b128 a[56:59], v2 offset:22528
s_add_u32 s7, s7, 0x8000
v_mfma_f32_16x16x32_bf16 v[40:43], a[20:23], a[196:199], v[40:43]
ds_read_b128 a[60:63], v2 offset:23552
v_xor_b32 v2, 0x38000, v2
v_mfma_f32_16x16x32_bf16 v[40:43], a[24:27], a[200:203], v[40:43]
s_xor_b32 s19, s19, 0x8000
v_exp_f32 v24, v24
v_mfma_f32_16x16x32_bf16 v[40:43], a[28:31], a[204:207], v[40:43]
s_sub_u32 s15, s15, 1
v_exp_f32 v25, v25
v_mfma_f32_16x16x32_bf16 v[44:47], a[16:19], a[208:211], v[92:95]
s_cmp_lg_u32 s15, 0
s_waitcnt vmcnt(16) lgkmcnt(0)
v_exp_f32 v26, v26
v_mfma_f32_16x16x32_bf16 v[44:47], a[20:23], a[212:215], v[44:47]
s_barrier
v_exp_f32 v27, v27
v_mfma_f32_16x16x32_bf16 v[44:47], a[24:27], a[216:219], v[44:47]
v_exp_f32 v28, v28
v_mfma_f32_16x16x32_bf16 v[44:47], a[28:31], a[220:223], v[44:47]
v_exp_f32 v29, v29
s_cbranch_scc1 L_att_seven1
L_att_sdone:
s_cmp_ge_u32 s4, 2
s_cbranch_scc1 L_att_sh0_1
L_att_sh0_0:
v_mfma_f32_16x16x32_bf16 v[192:195], a[32:35], v[56:59], v[192:195]
v_exp_f32 v30, v30
v_mfma_f32_16x16x32_bf16 v[224:227], a[32:35], v[60:63], v[224:227]
buffer_load_dword v14, v15, s[84:87], 0 offen offset:192 sc1
v_mfma_f32_16x16x32_bf16 v[228:231], a[36:39], v[60:63], v[228:231]
v_exp_f32 v31, v31
v_mfma_f32_16x16x32_bf16 v[196:199], a[36:39], v[56:59], v[196:199]
s_add_u32 m0, s17, 0x10000
v_exp_f32 v40, v40
v_mfma_f32_16x16x32_bf16 v[200:203], a[40:43], v[56:59], v[200:203]
ds_read_b128 a[0:3], v1 offset:8192
v_cvt_pk_bf16_f32 v72, v24, v25
v_mfma_f32_16x16x32_bf16 v[232:235], a[40:43], v[60:63], v[232:235]
ds_read_b128 a[4:7], v1 offset:9216
v_cvt_pk_bf16_f32 v73, v26, v27
v_mfma_f32_16x16x32_bf16 v[236:239], a[44:47], v[60:63], v[236:239]
buffer_load_dwordx4 v12, s[72:75], 0 offen lds
v_mfma_f32_16x16x32_bf16 v[204:207], a[44:47], v[56:59], v[204:207]
ds_read_b128 a[8:11], v1 offset:10240
v_cvt_pk_bf16_f32 v76, v28, v29
v_mfma_f32_16x16x32_bf16 v[208:211], a[48:51], v[56:59], v[208:211]
buffer_load_dwordx4 v13, s[72:75], 0 offen offset:1024 lds
v_mfma_f32_16x16x32_bf16 v[240:243], a[48:51], v[60:63], v[240:243]
ds_read_b128 a[12:15], v1 offset:11264
v_cvt_pk_bf16_f32 v77, v30, v31
v_mfma_f32_16x16x32_bf16 v[244:247], a[52:55], v[60:63], v[244:247]
buffer_load_dwordx4 v12, s[72:75], s12 offen offset:2048 lds
v_mfma_f32_16x16x32_bf16 v[212:215], a[52:55], v[56:59], v[212:215]
ds_read_b128 a[16:19], v1 offset:12288
v_exp_f32 v41, v41
v_mfma_f32_16x16x32_bf16 v[216:219], a[56:59], v[56:59], v[216:219]
ds_read_b128 a[20:23], v1 offset:13312
v_exp_f32 v42, v42
v_mfma_f32_16x16x32_bf16 v[248:251], a[56:59], v[60:63], v[248:251]
buffer_load_dwordx4 v13, s[72:75], s12 offen offset:3072 lds
v_mfma_f32_16x16x32_bf16 v[252:255], a[60:63], v[60:63], v[252:255]
ds_read_b128 a[24:27], v1 offset:14336
s_waitcnt lgkmcnt(3)
v_mfma_f32_16x16x32_bf16 v[220:223], a[60:63], v[56:59], v[220:223]
ds_read_b128 a[28:31], v1 offset:15360
v_add_u32 v12, 0x20000, v12
v_smfmac_f32_16x16x64_bf16 a[228:231], a[232:235], v[56:63], v9
s_add_u32 m0, s17, 0x14000
v_exp_f32 v43, v43
v_mfma_f32_16x16x32_bf16 v[24:27], a[0:3], a[192:195], v[112:115]
buffer_load_dwordx4 v12, s[72:75], 0 offen lds
v_mfma_f32_16x16x32_bf16 v[24:27], a[4:7], a[196:199], v[24:27]
ds_read_b128 a[32:35], v1 offset:0
v_cvt_pk_bf16_f32 v74, v40, v41
v_mfma_f32_16x16x32_bf16 v[24:27], a[8:11], a[200:203], v[24:27]
ds_read_b128 a[36:39], v1 offset:1024
v_exp_f32 v44, v44
v_mfma_f32_16x16x32_bf16 v[24:27], a[12:15], a[204:207], v[24:27]
ds_read_b128 a[40:43], v1 offset:2048
v_exp_f32 v45, v45
v_mfma_f32_16x16x32_bf16 v[28:31], a[0:3], a[208:211], v[92:95]
ds_read_b128 a[44:47], v1 offset:3072
v_exp_f32 v46, v46
v_mfma_f32_16x16x32_bf16 v[28:31], a[4:7], a[212:215], v[28:31]
s_waitcnt lgkmcnt(4)
v_exp_f32 v47, v47
v_mfma_f32_16x16x32_bf16 v[28:31], a[8:11], a[216:219], v[28:31]
ds_read_b128 a[48:51], v1 offset:4096
v_add_u32 v13, 0x20000, v13
v_mfma_f32_16x16x32_bf16 v[28:31], a[12:15], a[220:223], v[28:31]
buffer_load_dwordx4 v13, s[72:75], 0 offen offset:1024 lds
v_cvt_pk_bf16_f32 v75, v42, v43
v_mfma_f32_16x16x32_bf16 v[40:43], a[16:19], a[192:195], v[116:119]
ds_read_b128 a[52:55], v1 offset:5120
v_exp_f32 v24, v24
v_mfma_f32_16x16x32_bf16 v[40:43], a[20:23], a[196:199], v[40:43]
buffer_load_dwordx4 v12, s[72:75], s12 offen offset:2048 lds
v_mfma_f32_16x16x32_bf16 v[40:43], a[24:27], a[200:203], v[40:43]
ds_read_b128 a[56:59], v1 offset:6144
v_exp_f32 v25, v25
v_mfma_f32_16x16x32_bf16 v[40:43], a[28:31], a[204:207], v[40:43]
ds_read_b128 a[60:63], v1 offset:7168
v_cvt_pk_bf16_f32 v78, v44, v45
v_cvt_pk_bf16_f32 v79, v46, v47
v_mfma_f32_16x16x32_bf16 v[44:47], a[16:19], a[208:211], v[92:95]
buffer_load_dwordx4 v13, s[72:75], s12 offen offset:3072 lds
v_mfma_f32_16x16x32_bf16 v[44:47], a[20:23], a[212:215], v[44:47]
v_exp_f32 v26, v26
v_mfma_f32_16x16x32_bf16 v[44:47], a[24:27], a[216:219], v[44:47]
v_exp_f32 v27, v27
v_mfma_f32_16x16x32_bf16 v[44:47], a[28:31], a[220:223], v[44:47]
s_waitcnt lgkmcnt(0)
v_exp_f32 v28, v28
v_exp_f32 v29, v29
v_mfma_f32_16x16x32_bf16 v[192:195], a[32:35], v[72:75], v[192:195]
ds_read_b128 a[0:3], v1 offset:24576
v_cvt_pk_bf16_f32 v56, v24, v25
v_mfma_f32_16x16x32_bf16 v[224:227], a[32:35], v[76:79], v[224:227]
ds_read_b128 a[4:7], v1 offset:25600
v_add_u32 v12, 0x20000, v12
v_mfma_f32_16x16x32_bf16 v[228:231], a[36:39], v[76:79], v[228:231]
s_add_u32 m0, s16, 0x0
v_exp_f32 v30, v30
v_mfma_f32_16x16x32_bf16 v[196:199], a[36:39], v[72:75], v[196:199]
buffer_load_dwordx4 v12, s[72:75], 0 offen lds
v_mfma_f32_16x16x32_bf16 v[200:203], a[40:43], v[72:75], v[200:203]
ds_read_b128 a[8:11], v1 offset:26624
v_add_u32 v13, 0x20000, v13
v_mfma_f32_16x16x32_bf16 v[232:235], a[40:43], v[76:79], v[232:235]
buffer_load_dwordx4 v13, s[72:75], 0 offen offset:1024 lds
v_mfma_f32_16x16x32_bf16 v[236:239], a[44:47], v[76:79], v[236:239]
ds_read_b128 a[12:15], v1 offset:27648
v_cvt_pk_bf16_f32 v57, v26, v27
v_mfma_f32_16x16x32_bf16 v[204:207], a[44:47], v[72:75], v[204:207]
buffer_load_dwordx4 v12, s[72:75], s12 offen offset:2048 lds
v_mfma_f32_16x16x32_bf16 v[208:211], a[48:51], v[72:75], v[208:211]
ds_read_b128 a[16:19], v1 offset:28672
v_cvt_pk_bf16_f32 v60, v28, v29
v_mfma_f32_16x16x32_bf16 v[240:243], a[48:51], v[76:79], v[240:243]
buffer_load_dwordx4 v13, s[72:75], s12 offen offset:3072 lds
v_mfma_f32_16x16x32_bf16 v[244:247], a[52:55], v[76:79], v[244:247]
ds_read_b128 a[20:23], v1 offset:29696
v_exp_f32 v31, v31
v_mfma_f32_16x16x32_bf16 v[212:215], a[52:55], v[72:75], v[212:215]
ds_read_b128 a[24:27], v1 offset:30720
s_add_u32 m0, s16, 0x4000
v_mfma_f32_16x16x32_bf16 v[216:219], a[56:59], v[72:75], v[216:219]
ds_read_b128 a[28:31], v1 offset:31744
v_add_u32 v12, 0x20000, v12
v_mfma_f32_16x16x32_bf16 v[248:251], a[56:59], v[76:79], v[248:251]
buffer_load_dwordx4 v12, s[72:75], 0 offen lds
v_mfma_f32_16x16x32_bf16 v[252:255], a[60:63], v[76:79], v[252:255]
ds_read_b128 a[32:35], v1 offset:16384
s_waitcnt lgkmcnt(5)
v_mfma_f32_16x16x32_bf16 v[220:223], a[60:63], v[72:75], v[220:223]
ds_read_b128 a[36:39], v1 offset:17408
v_add_u32 v13, 0x20000, v13
v_smfmac_f32_16x16x64_bf16 a[228:231], a[232:235], v[72:79], v9
buffer_load_dwordx4 v13, s[72:75], 0 offen offset:1024 lds
v_cvt_pk_bf16_f32 v61, v30, v31
v_mfma_f32_16x16x32_bf16 v[28:31], a[0:3], a[208:211], v[92:95]
ds_read_b128 a[40:43], v1 offset:18432
v_exp_f32 v40, v40
v_mfma_f32_16x16x32_bf16 v[28:31], a[4:7], a[212:215], v[28:31]
buffer_load_dwordx4 v12, s[72:75], s12 offen offset:2048 lds
v_mfma_f32_16x16x32_bf16 v[28:31], a[8:11], a[216:219], v[28:31]
ds_read_b128 a[44:47], v1 offset:19456
v_exp_f32 v41, v41
v_mfma_f32_16x16x32_bf16 v[28:31], a[12:15], a[220:223], v[28:31]
ds_read_b128 a[48:51], v1 offset:20480
s_waitcnt lgkmcnt(5)
v_exp_f32 v42, v42
v_exp_f32 v43, v43
v_exp_f32 v44, v44
v_exp_f32 v45, v45
v_exp_f32 v46, v46
v_exp_f32 v47, v47
v_cvt_pk_bf16_f32 v62, v44, v45
v_cvt_pk_bf16_f32 v63, v46, v47
v_mfma_f32_16x16x32_bf16 v[44:47], a[16:19], a[208:211], v[92:95]
buffer_load_dwordx4 v13, s[72:75], s12 offen offset:3072 lds
v_mfma_f32_16x16x32_bf16 v[44:47], a[20:23], a[212:215], v[44:47]
ds_read_b128 a[52:55], v1 offset:21504
v_cvt_pk_bf16_f32 v58, v40, v41
v_mfma_f32_16x16x32_bf16 v[44:47], a[24:27], a[216:219], v[44:47]
ds_read_b128 a[56:59], v1 offset:22528
v_cvt_pk_bf16_f32 v59, v42, v43
v_mfma_f32_16x16x32_bf16 v[44:47], a[28:31], a[220:223], v[44:47]
ds_read_b128 a[60:63], v1 offset:23552
v_xor_b32 v1, 0x8000, v1
L_att_h1_0:
s_waitcnt vmcnt(16) lgkmcnt(0)
s_mov_b32 s92, 200000
L_spin_b0:
v_cmp_gt_u32 vcc, 32, v14
s_nop 4
s_cbranch_vccz L_spun_b0
s_sub_u32 s92, s92, 1
s_cbranch_scc1 L_spun_b0
s_sleep 6
buffer_load_dword v14, v15, s[84:87], 0 offen offset:192 sc1
s_waitcnt vmcnt(0)
s_branch L_spin_b0
L_spun_b0:
s_barrier
v_mfma_f32_16x16x32_bf16 v[192:195], a[32:35], v[56:59], v[192:195]
ds_read_b128 a[0:3], v2 offset:8192
v_exp_f32 v28, v28
v_mfma_f32_16x16x32_bf16 v[224:227], a[32:35], v[60:63], v[224:227]
ds_read_b128 a[4:7], v2 offset:9216
v_exp_f32 v29, v29
v_mfma_f32_16x16x32_bf16 v[228:231], a[36:39], v[60:63], v[228:231]
s_add_u32 s101, s101, 0x2000
v_exp_f32 v30, v30
v_mfma_f32_16x16x32_bf16 v[196:199], a[36:39], v[56:59], v[196:199]
buffer_load_dwordx4 a[64:67], v3, s[88:91], s101 offen sc1
v_mfma_f32_16x16x32_bf16 v[200:203], a[40:43], v[56:59], v[200:203]
ds_read_b128 a[8:11], v2 offset:10240
v_exp_f32 v31, v31
v_mfma_f32_16x16x32_bf16 v[232:235], a[40:43], v[60:63], v[232:235]
buffer_load_dwordx4 a[68:71], v3, s[88:91], s101 offen offset:1024 sc1
v_mfma_f32_16x16x32_bf16 v[236:239], a[44:47], v[60:63], v[236:239]
ds_read_b128 a[12:15], v2 offset:11264
s_add_u32 s101, s101, 0x2000
v_mfma_f32_16x16x32_bf16 v[204:207], a[44:47], v[56:59], v[204:207]
buffer_load_dwordx4 a[72:75], v3, s[88:91], s101 offen sc1
v_mfma_f32_16x16x32_bf16 v[208:211], a[48:51], v[56:59], v[208:211]
ds_read_b128 a[16:19], v2 offset:12288
v_cvt_pk_bf16_f32 v76, v28, v29
v_mfma_f32_16x16x32_bf16 v[240:243], a[48:51], v[60:63], v[240:243]
buffer_load_dwordx4 a[76:79], v3, s[88:91], s101 offen offset:1024 sc1
v_mfma_f32_16x16x32_bf16 v[244:247], a[52:55], v[60:63], v[244:247]
ds_read_b128 a[20:23], v2 offset:13312
v_exp_f32 v44, v44
v_mfma_f32_16x16x32_bf16 v[212:215], a[52:55], v[56:59], v[212:215]
ds_read_b128 a[24:27], v2 offset:14336
v_exp_f32 v45, v45
v_mfma_f32_16x16x32_bf16 v[216:219], a[56:59], v[56:59], v[216:219]
ds_read_b128 a[28:31], v2 offset:15360
s_add_u32 s101, s101, 0x2000
v_mfma_f32_16x16x32_bf16 v[248:251], a[56:59], v[60:63], v[248:251]
buffer_load_dwordx4 a[80:83], v3, s[88:91], s101 offen sc1
v_mfma_f32_16x16x32_bf16 v[252:255], a[60:63], v[60:63], v[252:255]
ds_read_b128 a[32:35], v2 offset:0
v_cvt_pk_bf16_f32 v77, v30, v31
v_mfma_f32_16x16x32_bf16 v[220:223], a[60:63], v[56:59], v[220:223]
ds_read_b128 a[36:39], v2 offset:1024
s_waitcnt lgkmcnt(6)
v_smfmac_f32_16x16x64_bf16 a[228:231], a[232:235], v[56:63], v9
buffer_load_dwordx4 a[84:87], v3, s[88:91], s101 offen offset:1024 sc1
v_mfma_f32_16x16x32_bf16 v[28:31], a[0:3], a[208:211], v[92:95]
ds_read_b128 a[40:43], v2 offset:2048
v_exp_f32 v46, v46
v_mfma_f32_16x16x32_bf16 v[28:31], a[4:7], a[212:215], v[28:31]
ds_read_b128 a[44:47], v2 offset:3072
s_add_u32 s101, s101, 0x2000
v_mfma_f32_16x16x32_bf16 v[28:31], a[8:11], a[216:219], v[28:31]
buffer_load_dwordx4 a[88:91], v3, s[88:91], s101 offen sc1
v_mfma_f32_16x16x32_bf16 v[28:31], a[12:15], a[220:223], v[28:31]
ds_read_b128 a[48:51], v2 offset:4096
s_waitcnt lgkmcnt(5)
v_exp_f32 v47, v47
v_cvt_pk_bf16_f32 v78, v44, v45
v_cvt_pk_bf16_f32 v79, v46, v47
v_mfma_f32_16x16x32_bf16 v[44:47], a[16:19], a[208:211], v[92:95]
ds_read_b128 a[52:55], v2 offset:5120
v_mfma_f32_16x16x32_bf16 v[44:47], a[20:23], a[212:215], v[44:47]
buffer_load_dwordx4 a[92:95], v3, s[88:91], s101 offen offset:1024 sc1
v_mfma_f32_16x16x32_bf16 v[44:47], a[24:27], a[216:219], v[44:47]
ds_read_b128 a[56:59], v2 offset:6144
v_mfma_f32_16x16x32_bf16 v[44:47], a[28:31], a[220:223], v[44:47]
ds_read_b128 a[60:63], v2 offset:7168
s_waitcnt lgkmcnt(0)
v_mfma_f32_16x16x32_bf16 v[224:227], a[32:35], v[76:79], v[224:227]
ds_read_b128 a[0:3], v2 offset:24576
s_add_u32 s101, s101, 0x2000
v_mfma_f32_16x16x32_bf16 v[228:231], a[36:39], v[76:79], v[228:231]
buffer_load_dwordx4 a[96:99], v3, s[88:91], s101 offen sc1
v_mfma_f32_16x16x32_bf16 v[232:235], a[40:43], v[76:79], v[232:235]
ds_read_b128 a[4:7], v2 offset:25600
v_exp_f32 v28, v28
v_mfma_f32_16x16x32_bf16 v[236:239], a[44:47], v[76:79], v[236:239]
buffer_load_dwordx4 a[100:103], v3, s[88:91], s101 offen offset:1024 sc1
v_mfma_f32_16x16x32_bf16 v[240:243], a[48:51], v[76:79], v[240:243]
ds_read_b128 a[8:11], v2 offset:26624
s_add_u32 s101, s101, 0x2000
v_mfma_f32_16x16x32_bf16 v[244:247], a[52:55], v[76:79], v[244:247]
buffer_load_dwordx4 a[104:107], v3, s[88:91], s101 offen sc1
v_mfma_f32_16x16x32_bf16 v[248:251], a[56:59], v[76:79], v[248:251]
ds_read_b128 a[12:15], v2 offset:27648
s_waitcnt lgkmcnt(0)
v_mfma_f32_16x16x32_bf16 v[252:255], a[60:63], v[76:79], v[252:255]
buffer_load_dwordx4 a[108:111], v3, s[88:91], s101 offen offset:1024 sc1
ds_read_b128 a[16:19], v2 offset:28672
v_mfma_f32_16x16x32_bf16 a[228:231], a[236:239], v[76:79], a[228:231]
ds_read_b128 a[20:23], v2 offset:29696
s_add_u32 s101, s101, 0x2000
v_exp_f32 v29, v29
v_exp_f32 v30, v30
v_exp_f32 v31, v31
v_cvt_pk_bf16_f32 v60, v28, v29
v_cvt_pk_bf16_f32 v61, v30, v31
v_mfma_f32_16x16x32_bf16 v[28:31], a[0:3], a[208:211], v[120:123]
buffer_load_dwordx4 a[112:115], v3, s[88:91], s101 offen sc1
ds_read_b128 a[24:27], v2 offset:30720
v_mfma_f32_16x16x32_bf16 v[28:31], a[4:7], a[212:215], v[28:31]
ds_read_b128 a[28:31], v2 offset:31744
s_waitcnt lgkmcnt(0)
v_mfma_f32_16x16x32_bf16 v[28:31], a[8:11], a[216:219], v[28:31]
buffer_load_dwordx4 a[116:119], v3, s[88:91], s101 offen offset:1024 sc1
v_mfma_f32_16x16x32_bf16 v[28:31], a[12:15], a[220:223], v[28:31]
ds_read_b128 a[32:35], v2 offset:16384
s_add_u32 s101, s101, 0x2000
v_exp_f32 v44, v44
v_exp_f32 v45, v45
v_exp_f32 v46, v46
v_exp_f32 v47, v47
v_cvt_pk_bf16_f32 v62, v44, v45
v_cvt_pk_bf16_f32 v63, v46, v47
v_mfma_f32_16x16x32_bf16 v[44:47], a[16:19], a[208:211], v[124:127]
buffer_load_dwordx4 a[120:123], v3, s[88:91], s101 offen sc1
v_mfma_f32_16x16x32_bf16 v[44:47], a[20:23], a[212:215], v[44:47]
buffer_load_dwordx4 a[124:127], v3, s[88:91], s101 offen offset:1024 sc1
v_mfma_f32_16x16x32_bf16 v[44:47], a[24:27], a[216:219], v[44:47]
ds_read_b128 a[36:39], v2 offset:17408
v_mfma_f32_16x16x32_bf16 v[44:47], a[28:31], a[220:223], v[44:47]
ds_read_b128 a[40:43], v2 offset:18432
ds_read_b128 a[44:47], v2 offset:19456
ds_read_b128 a[48:51], v2 offset:20480
ds_read_b128 a[52:55], v2 offset:21504
ds_read_b128 a[56:59], v2 offset:22528
ds_read_b128 a[60:63], v2 offset:23552
v_xor_b32 v2, 0x38000, v2
s_waitcnt lgkmcnt(0)
s_barrier
v_accvgpr_read_b32 v6, a228
v_accvgpr_read_b32 v7, a229
v_add_f32 v6, v6, v7
v_cmp_nge_f32 vcc, 0x5f800000, v6
v_rcp_f32 v6, v6
s_or_b64 s[34:35], s[34:35], vcc
v_mfma_f32_16x16x32_bf16 v[224:227], a[32:35], v[60:63], v[224:227]
ds_read_b128 a[32:35], v1 offset:0
v_exp_f32 v28, v28
v_mfma_f32_16x16x32_bf16 v[228:231], a[36:39], v[60:63], v[228:231]
ds_read_b128 a[36:39], v1 offset:1024
v_exp_f32 v29, v29
v_mfma_f32_16x16x32_bf16 v[232:235], a[40:43], v[60:63], v[232:235]
ds_read_b128 a[40:43], v1 offset:2048
v_exp_f32 v30, v30
v_mfma_f32_16x16x32_bf16 v[236:239], a[44:47], v[60:63], v[236:239]
ds_read_b128 a[44:47], v1 offset:3072
v_exp_f32 v31, v31
v_mfma_f32_16x16x32_bf16 v[240:243], a[48:51], v[60:63], v[240:243]
ds_read_b128 a[48:51], v1 offset:4096
v_exp_f32 v44, v44
v_mfma_f32_16x16x32_bf16 v[244:247], a[52:55], v[60:63], v[244:247]
ds_read_b128 a[52:55], v1 offset:5120
v_exp_f32 v45, v45
v_mfma_f32_16x16x32_bf16 v[248:251], a[56:59], v[60:63], v[248:251]
ds_read_b128 a[56:59], v1 offset:6144
v_exp_f32 v46, v46
v_mfma_f32_16x16x32_bf16 v[252:255], a[60:63], v[60:63], v[252:255]
ds_read_b128 a[60:63], v1 offset:7168
v_exp_f32 v47, v47
v_mfma_f32_16x16x32_bf16 a[228:231], a[236:239], v[60:63], a[228:231]
v_cvt_pk_bf16_f32 v76, v28, v29
v_cvt_pk_bf16_f32 v77, v30, v31
v_cvt_pk_bf16_f32 v78, v44, v45
v_cvt_pk_bf16_f32 v79, v46, v47
s_add_u32 s8, s30, 0x0
v_pk_mul_f32 v[192:193], v[192:193], v[6:7] op_sel_hi:[1,0]
v_pk_mul_f32 v[194:195], v[194:195], v[6:7] op_sel_hi:[1,0]
v_pk_mul_f32 v[196:197], v[196:197], v[6:7] op_sel_hi:[1,0]
v_pk_mul_f32 v[198:199], v[198:199], v[6:7] op_sel_hi:[1,0]
v_cvt_pk_bf16_f32 v192, v192, v193
v_cvt_pk_bf16_f32 v193, v194, v195
v_cvt_pk_bf16_f32 v194, v196, v197
v_cvt_pk_bf16_f32 v195, v198, v199
buffer_store_dwordx4 v[192:195], v3, s[88:91], s8 offen sc1
s_add_u32 s8, s30, 0x2000
v_pk_mul_f32 v[200:201], v[200:201], v[6:7] op_sel_hi:[1,0]
v_pk_mul_f32 v[202:203], v[202:203], v[6:7] op_sel_hi:[1,0]
v_pk_mul_f32 v[204:205], v[204:205], v[6:7] op_sel_hi:[1,0]
v_pk_mul_f32 v[206:207], v[206:207], v[6:7] op_sel_hi:[1,0]
v_cvt_pk_bf16_f32 v200, v200, v201
v_cvt_pk_bf16_f32 v201, v202, v203
v_cvt_pk_bf16_f32 v202, v204, v205
v_cvt_pk_bf16_f32 v203, v206, v207
buffer_store_dwordx4 v[200:203], v3, s[88:91], s8 offen sc1
s_waitcnt lgkmcnt(0)
v_mfma_f32_16x16x32_bf16 v[224:227], a[32:35], v[76:79], v[224:227]
s_add_u32 s8, s30, 0x4000
v_mul_f32 v208, v6, v208
v_mfma_f32_16x16x32_bf16 v[228:231], a[36:39], v[76:79], v[228:231]
v_mul_f32 v209, v6, v209
v_mul_f32 v210, v6, v210
v_mfma_f32_16x16x32_bf16 v[232:235], a[40:43], v[76:79], v[232:235]
v_mul_f32 v211, v6, v211
v_mul_f32 v212, v6, v212
v_mfma_f32_16x16x32_bf16 v[236:239], a[44:47], v[76:79], v[236:239]
v_mul_f32 v213, v6, v213
v_mul_f32 v214, v6, v214
v_mfma_f32_16x16x32_bf16 v[240:243], a[48:51], v[76:79], v[240:243]
v_mul_f32 v215, v6, v215
v_cvt_pk_bf16_f32 v208, v208, v209
v_mfma_f32_16x16x32_bf16 v[244:247], a[52:55], v[76:79], v[244:247]
v_cvt_pk_bf16_f32 v209, v210, v211
v_cvt_pk_bf16_f32 v210, v212, v213
v_mfma_f32_16x16x32_bf16 v[248:251], a[56:59], v[76:79], v[248:251]
v_cvt_pk_bf16_f32 v211, v214, v215
buffer_store_dwordx4 v[208:211], v3, s[88:91], s8 offen sc1
v_mfma_f32_16x16x32_bf16 v[252:255], a[60:63], v[76:79], v[252:255]
s_add_u32 s8, s30, 0x6000
v_mul_f32 v216, v6, v216
v_mfma_f32_16x16x32_bf16 a[228:231], a[236:239], v[76:79], a[228:231]
v_mul_f32 v217, v6, v217
v_mul_f32 v218, v6, v218
v_mul_f32 v219, v6, v219
v_mul_f32 v220, v6, v220
v_mul_f32 v221, v6, v221
v_mul_f32 v222, v6, v222
v_mul_f32 v223, v6, v223
v_cvt_pk_bf16_f32 v216, v216, v217
v_cvt_pk_bf16_f32 v217, v218, v219
v_cvt_pk_bf16_f32 v218, v220, v221
v_cvt_pk_bf16_f32 v219, v222, v223
buffer_store_dwordx4 v[216:219], v3, s[88:91], s8 offen sc1
s_branch L_att_fin
L_att_sh0_1:
v_mfma_f32_16x16x32_bf16 v[192:195], a[32:35], v[56:59], v[192:195]
v_exp_f32 v30, v30
v_mfma_f32_16x16x32_bf16 v[224:227], a[32:35], v[60:63], v[224:227]
buffer_load_dword v14, v15, s[84:87], 0 offen offset:192 sc1
v_mfma_f32_16x16x32_bf16 v[228:231], a[36:39], v[60:63], v[228:231]
v_exp_f32 v31, v31
v_mfma_f32_16x16x32_bf16 v[196:199], a[36:39], v[56:59], v[196:199]
s_add_u32 m0, s17, 0x10000
v_exp_f32 v40, v40
v_mfma_f32_16x16x32_bf16 v[200:203], a[40:43], v[56:59], v[200:203]
ds_read_b128 a[0:3], v1 offset:8192
v_cvt_pk_bf16_f32 v72, v24, v25
v_mfma_f32_16x16x32_bf16 v[232:235], a[40:43], v[60:63], v[232:235]
ds_read_b128 a[4:7], v1 offset:9216
v_cvt_pk_bf16_f32 v73, v26, v27
v_mfma_f32_16x16x32_bf16 v[236:239], a[44:47], v[60:63], v[236:239]
buffer_load_dwordx4 v12, s[72:75], 0 offen lds
v_mfma_f32_16x16x32_bf16 v[204:207], a[44:47], v[56:59], v[204:207]
ds_read_b128 a[8:11], v1 offset:10240
v_cvt_pk_bf16_f32 v76, v28, v29
v_mfma_f32_16x16x32_bf16 v[208:211], a[48:51], v[56:59], v[208:211]
buffer_load_dwordx4 v13, s[72:75], 0 offen offset:1024 lds
v_mfma_f32_16x16x32_bf16 v[240:243], a[48:51], v[60:63], v[240:243]
ds_read_b128 a[12:15], v1 offset:11264
v_cvt_pk_bf16_f32 v77, v30, v31
v_mfma_f32_16x16x32_bf16 v[244:247], a[52:55], v[60:63], v[244:247]
buffer_load_dwordx4 v12, s[72:75], s12 offen offset:2048 lds
v_mfma_f32_16x16x32_bf16 v[212:215], a[52:55], v[56:59], v[212:215]
ds_read_b128 a[16:19], v1 offset:12288
v_exp_f32 v41, v41
v_mfma_f32_16x16x32_bf16 v[216:219], a[56:59], v[56:59], v[216:219]
ds_read_b128 a[20:23], v1 offset:13312
v_exp_f32 v42, v42
v_mfma_f32_16x16x32_bf16 v[248:251], a[56:59], v[60:63], v[248:251]
buffer_load_dwordx4 v13, s[72:75], s12 offen offset:3072 lds
v_mfma_f32_16x16x32_bf16 v[252:255], a[60:63], v[60:63], v[252:255]
ds_read_b128 a[24:27], v1 offset:14336
s_waitcnt lgkmcnt(3)
v_mfma_f32_16x16x32_bf16 v[220:223], a[60:63], v[56:59], v[220:223]
ds_read_b128 a[28:31], v1 offset:15360
v_add_u32 v12, 0x20000, v12
v_smfmac_f32_16x16x64_bf16 a[228:231], a[232:235], v[56:63], v9
s_add_u32 m0, s17, 0x14000
v_exp_f32 v43, v43
v_mfma_f32_16x16x32_bf16 v[24:27], a[0:3], a[192:195], v[88:91]
buffer_load_dwordx4 v12, s[72:75], 0 offen lds
v_mfma_f32_16x16x32_bf16 v[24:27], a[4:7], a[196:199], v[24:27]
ds_read_b128 a[32:35], v1 offset:0
v_cvt_pk_bf16_f32 v74, v40, v41
v_mfma_f32_16x16x32_bf16 v[24:27], a[8:11], a[200:203], v[24:27]
ds_read_b128 a[36:39], v1 offset:1024
v_exp_f32 v44, v44
v_mfma_f32_16x16x32_bf16 v[24:27], a[12:15], a[204:207], v[24:27]
ds_read_b128 a[40:43], v1 offset:2048
v_exp_f32 v45, v45
v_mfma_f32_16x16x32_bf16 v[28:31], a[0:3], a[208:211], v[92:95]
ds_read_b128 a[44:47], v1 offset:3072
v_exp_f32 v46, v46
v_mfma_f32_16x16x32_bf16 v[28:31], a[4:7], a[212:215], v[28:31]
s_waitcnt lgkmcnt(4)
v_exp_f32 v47, v47
v_mfma_f32_16x16x32_bf16 v[28:31], a[8:11], a[216:219], v[28:31]
ds_read_b128 a[48:51], v1 offset:4096
v_add_u32 v13, 0x20000, v13
v_mfma_f32_16x16x32_bf16 v[28:31], a[12:15], a[220:223], v[28:31]
buffer_load_dwordx4 v13, s[72:75], 0 offen offset:1024 lds
v_cvt_pk_bf16_f32 v75, v42, v43
v_mfma_f32_16x16x32_bf16 v[40:43], a[16:19], a[192:195], v[88:91]
ds_read_b128 a[52:55], v1 offset:5120
v_exp_f32 v24, v24
v_mfma_f32_16x16x32_bf16 v[40:43], a[20:23], a[196:199], v[40:43]
buffer_load_dwordx4 v12, s[72:75], s12 offen offset:2048 lds
v_mfma_f32_16x16x32_bf16 v[40:43], a[24:27], a[200:203], v[40:43]
ds_read_b128 a[56:59], v1 offset:6144
v_exp_f32 v25, v25
v_mfma_f32_16x16x32_bf16 v[40:43], a[28:31], a[204:207], v[40:43]
ds_read_b128 a[60:63], v1 offset:7168
v_cvt_pk_bf16_f32 v78, v44, v45
v_cvt_pk_bf16_f32 v79, v46, v47
v_mfma_f32_16x16x32_bf16 v[44:47], a[16:19], a[208:211], v[92:95]
buffer_load_dwordx4 v13, s[72:75], s12 offen offset:3072 lds
v_mfma_f32_16x16x32_bf16 v[44:47], a[20:23], a[212:215], v[44:47]
v_exp_f32 v26, v26
v_mfma_f32_16x16x32_bf16 v[44:47], a[24:27], a[216:219], v[44:47]
v_exp_f32 v27, v27
v_mfma_f32_16x16x32_bf16 v[44:47], a[28:31], a[220:223], v[44:47]
s_waitcnt lgkmcnt(0)
v_exp_f32 v28, v28
v_exp_f32 v29, v29
v_mfma_f32_16x16x32_bf16 v[192:195], a[32:35], v[72:75], v[192:195]
s_add_u32 m0, s16, 0x0
v_add_u32 v12, 0x20000, v12
v_cvt_pk_bf16_f32 v56, v24, v25
v_mfma_f32_16x16x32_bf16 v[224:227], a[32:35], v[76:79], v[224:227]
buffer_load_dwordx4 v12, s[72:75], 0 offen lds
v_mfma_f32_16x16x32_bf16 v[228:231], a[36:39], v[76:79], v[228:231]
ds_read_b128 a[0:3], v1 offset:24576
v_cvt_pk_bf16_f32 v57, v26, v27
v_mfma_f32_16x16x32_bf16 v[196:199], a[36:39], v[72:75], v[196:199]
v_exp_f32 v30, v30
v_mfma_f32_16x16x32_bf16 v[200:203], a[40:43], v[72:75], v[200:203]
ds_read_b128 a[4:7], v1 offset:25600
v_cvt_pk_bf16_f32 v60, v28, v29
v_mfma_f32_16x16x32_bf16 v[232:235], a[40:43], v[76:79], v[232:235]
ds_read_b128 a[8:11], v1 offset:26624
v_add_u32 v13, 0x20000, v13
v_mfma_f32_16x16x32_bf16 v[236:239], a[44:47], v[76:79], v[236:239]
buffer_load_dwordx4 v13, s[72:75], 0 offen offset:1024 lds
v_mfma_f32_16x16x32_bf16 v[204:207], a[44:47], v[72:75], v[204:207]
ds_read_b128 a[12:15], v1 offset:27648
v_exp_f32 v31, v31
v_mfma_f32_16x16x32_bf16 v[208:211], a[48:51], v[72:75], v[208:211]
buffer_load_dwordx4 v12, s[72:75], s12 offen offset:2048 lds
v_mfma_f32_16x16x32_bf16 v[240:243], a[48:51], v[76:79], v[240:243]
ds_read_b128 a[16:19], v1 offset:28672
v_exp_f32 v40, v40
v_mfma_f32_16x16x32_bf16 v[244:247], a[52:55], v[76:79], v[244:247]
ds_read_b128 a[20:23], v1 offset:29696
v_cvt_pk_bf16_f32 v61, v30, v31
v_mfma_f32_16x16x32_bf16 v[212:215], a[52:55], v[72:75], v[212:215]
buffer_load_dwordx4 v13, s[72:75], s12 offen offset:3072 lds
v_mfma_f32_16x16x32_bf16 v[216:219], a[56:59], v[72:75], v[216:219]
ds_read_b128 a[24:27], v1 offset:30720
v_exp_f32 v41, v41
v_mfma_f32_16x16x32_bf16 v[248:251], a[56:59], v[76:79], v[248:251]
ds_read_b128 a[28:31], v1 offset:31744
v_exp_f32 v42, v42
v_mfma_f32_16x16x32_bf16 v[252:255], a[60:63], v[76:79], v[252:255]
ds_read_b128 a[32:35], v1 offset:16384
v_cvt_pk_bf16_f32 v58, v40, v41
v_mfma_f32_16x16x32_bf16 v[220:223], a[60:63], v[72:75], v[220:223]
s_waitcnt lgkmcnt(5)
v_exp_f32 v43, v43
v_smfmac_f32_16x16x64_bf16 a[228:231], a[232:235], v[72:79], v9
ds_read_b128 a[36:39], v1 offset:17408
v_add_u32 v12, 0x20000, v12
v_mfma_f32_16x16x32_bf16 v[24:27], a[0:3], a[192:195], v[112:115]
s_add_u32 m0, s16, 0x4000
v_exp_f32 v44, v44
v_mfma_f32_16x16x32_bf16 v[24:27], a[4:7], a[196:199], v[24:27]
buffer_load_dwordx4 v12, s[72:75], 0 offen lds
v_mfma_f32_16x16x32_bf16 v[24:27], a[8:11], a[200:203], v[24:27]
ds_read_b128 a[40:43], v1 offset:18432
v_add_u32 v13, 0x20000, v13
v_mfma_f32_16x16x32_bf16 v[24:27], a[12:15], a[204:207], v[24:27]
buffer_load_dwordx4 v13, s[72:75], 0 offen offset:1024 lds
v_mfma_f32_16x16x32_bf16 v[28:31], a[0:3], a[208:211], v[92:95]
ds_read_b128 a[44:47], v1 offset:19456
v_cvt_pk_bf16_f32 v59, v42, v43
v_mfma_f32_16x16x32_bf16 v[28:31], a[4:7], a[212:215], v[28:31]
ds_read_b128 a[48:51], v1 offset:20480
v_exp_f32 v45, v45
v_mfma_f32_16x16x32_bf16 v[28:31], a[8:11], a[216:219], v[28:31]
s_waitcnt lgkmcnt(5)
v_exp_f32 v46, v46
v_mfma_f32_16x16x32_bf16 v[28:31], a[12:15], a[220:223], v[28:31]
buffer_load_dwordx4 v12, s[72:75], s12 offen offset:2048 lds
v_mfma_f32_16x16x32_bf16 v[40:43], a[16:19], a[192:195], v[116:119]
ds_read_b128 a[52:55], v1 offset:21504
v_exp_f32 v47, v47
v_mfma_f32_16x16x32_bf16 v[40:43], a[20:23], a[196:199], v[40:43]
ds_read_b128 a[56:59], v1 offset:22528
v_exp_f32 v24, v24
v_mfma_f32_16x16x32_bf16 v[40:43], a[24:27], a[200:203], v[40:43]
ds_read_b128 a[60:63], v1 offset:23552
v_xor_b32 v1, 0x8000, v1
v_mfma_f32_16x16x32_bf16 v[40:43], a[28:31], a[204:207], v[40:43]
v_exp_f32 v25, v25
v_cvt_pk_bf16_f32 v62, v44, v45
v_cvt_pk_bf16_f32 v63, v46, v47
v_mfma_f32_16x16x32_bf16 v[44:47], a[16:19], a[208:211], v[92:95]
v_exp_f32 v26, v26
v_mfma_f32_16x16x32_bf16 v[44:47], a[20:23], a[212:215], v[44:47]
buffer_load_dwordx4 v13, s[72:75], s12 offen offset:3072 lds
v_mfma_f32_16x16x32_bf16 v[44:47], a[24:27], a[216:219], v[44:47]
v_exp_f32 v27, v27
v_mfma_f32_16x16x32_bf16 v[44:47], a[28:31], a[220:223], v[44:47]
v_exp_f32 v28, v28
v_exp_f32 v29, v29
L_att_h1_1:
s_waitcnt vmcnt(16) lgkmcnt(0)
s_mov_b32 s92, 200000
L_spin_b1:
v_cmp_gt_u32 vcc, 32, v14
s_nop 4
s_cbranch_vccz L_spun_b1
s_sub_u32 s92, s92, 1
s_cbranch_scc1 L_spun_b1
s_sleep 6
buffer_load_dword v14, v15, s[84:87], 0 offen offset:192 sc1
s_waitcnt vmcnt(0)
s_branch L_spin_b1
L_spun_b1:
s_barrier
v_mfma_f32_16x16x32_bf16 v[192:195], a[32:35], v[56:59], v[192:195]
ds_read_b128 a[0:3], v2 offset:8192
v_cvt_pk_bf16_f32 v72, v24, v25
v_mfma_f32_16x16x32_bf16 v[224:227], a[32:35], v[60:63], v[224:227]
ds_read_b128 a[4:7], v2 offset:9216
v_cvt_pk_bf16_f32 v73, v26, v27
v_mfma_f32_16x16x32_bf16 v[228:231], a[36:39], v[60:63], v[228:231]
s_add_u32 s101, s101, 0x2000
v_exp_f32 v30, v30
v_mfma_f32_16x16x32_bf16 v[196:199], a[36:39], v[56:59], v[196:199]
buffer_load_dwordx4 a[64:67], v3, s[88:91], s101 offen sc1
v_mfma_f32_16x16x32_bf16 v[200:203], a[40:43], v[56:59], v[200:203]
ds_read_b128 a[8:11], v2 offset:10240
v_cvt_pk_bf16_f32 v76, v28, v29
v_mfma_f32_16x16x32_bf16 v[232:235], a[40:43], v[60:63], v[232:235]
buffer_load_dwordx4 a[68:71], v3, s[88:91], s101 offen offset:1024 sc1
v_mfma_f32_16x16x32_bf16 v[236:239], a[44:47], v[60:63], v[236:239]
ds_read_b128 a[12:15], v2 offset:11264
s_add_u32 s101, s101, 0x2000
v_mfma_f32_16x16x32_bf16 v[204:207], a[44:47], v[56:59], v[204:207]
buffer_load_dwordx4 a[72:75], v3, s[88:91], s101 offen sc1
v_mfma_f32_16x16x32_bf16 v[208:211], a[48:51], v[56:59], v[208:211]
ds_read_b128 a[16:19], v2 offset:12288
v_exp_f32 v31, v31
v_mfma_f32_16x16x32_bf16 v[240:243], a[48:51], v[60:63], v[240:243]
buffer_load_dwordx4 a[76:79], v3, s[88:91], s101 offen offset:1024 sc1
v_mfma_f32_16x16x32_bf16 v[244:247], a[52:55], v[60:63], v[244:247]
ds_read_b128 a[20:23], v2 offset:13312
v_exp_f32 v40, v40
v_mfma_f32_16x16x32_bf16 v[212:215], a[52:55], v[56:59], v[212:215]
ds_read_b128 a[24:27], v2 offset:14336
v_exp_f32 v41, v41
v_mfma_f32_16x16x32_bf16 v[216:219], a[56:59], v[56:59], v[216:219]
ds_read_b128 a[28:31], v2 offset:15360
s_add_u32 s101, s101, 0x2000
v_mfma_f32_16x16x32_bf16 v[248:251], a[56:59], v[60:63], v[248:251]
buffer_load_dwordx4 a[80:83], v3, s[88:91], s101 offen sc1
v_mfma_f32_16x16x32_bf16 v[252:255], a[60:63], v[60:63], v[252:255]
ds_read_b128 a[32:35], v2 offset:0
v_cvt_pk_bf16_f32 v77, v30, v31
v_mfma_f32_16x16x32_bf16 v[220:223], a[60:63], v[56:59], v[220:223]
ds_read_b128 a[36:39], v2 offset:1024
s_waitcnt lgkmcnt(6)
v_smfmac_f32_16x16x64_bf16 a[228:231], a[232:235], v[56:63], v9
buffer_load_dwordx4 a[84:87], v3, s[88:91], s101 offen offset:1024 sc1
v_mfma_f32_16x16x32_bf16 v[28:31], a[0:3], a[208:211], v[120:123]
ds_read_b128 a[40:43], v2 offset:2048
v_exp_f32 v42, v42
v_mfma_f32_16x16x32_bf16 v[28:31], a[4:7], a[212:215], v[28:31]
ds_read_b128 a[44:47], v2 offset:3072
s_add_u32 s101, s101, 0x2000
v_mfma_f32_16x16x32_bf16 v[28:31], a[8:11], a[216:219], v[28:31]
buffer_load_dwordx4 a[88:91], v3, s[88:91], s101 offen sc1
v_mfma_f32_16x16x32_bf16 v[28:31], a[12:15], a[220:223], v[28:31]
ds_read_b128 a[48:51], v2 offset:4096
s_waitcnt lgkmcnt(5)
v_exp_f32 v43, v43
v_exp_f32 v44, v44
v_exp_f32 v45, v45
v_exp_f32 v46, v46
v_exp_f32 v47, v47
v_cvt_pk_bf16_f32 v78, v44, v45
v_cvt_pk_bf16_f32 v79, v46, v47
v_mfma_f32_16x16x32_bf16 v[44:47], a[16:19], a[208:211], v[124:127]
ds_read_b128 a[52:55], v2 offset:5120
v_cvt_pk_bf16_f32 v74, v40, v41
v_mfma_f32_16x16x32_bf16 v[44:47], a[20:23], a[212:215], v[44:47]
buffer_load_dwordx4 a[92:95], v3, s[88:91], s101 offen offset:1024 sc1
v_mfma_f32_16x16x32_bf16 v[44:47], a[24:27], a[216:219], v[44:47]
ds_read_b128 a[56:59], v2 offset:6144
v_cvt_pk_bf16_f32 v75, v42, v43
v_mfma_f32_16x16x32_bf16 v[44:47], a[28:31], a[220:223], v[44:47]
ds_read_b128 a[60:63], v2 offset:7168
s_waitcnt lgkmcnt(0)
v_mfma_f32_16x16x32_bf16 v[192:195], a[32:35], v[72:75], v[192:195]
s_add_u32 s101, s101, 0x2000
v_exp_f32 v28, v28
v_mfma_f32_16x16x32_bf16 v[224:227], a[32:35], v[76:79], v[224:227]
buffer_load_dwordx4 a[96:99], v3, s[88:91], s101 offen sc1
v_mfma_f32_16x16x32_bf16 v[228:231], a[36:39], v[76:79], v[228:231]
ds_read_b128 a[32:35], v2 offset:16384
v_exp_f32 v29, v29
v_mfma_f32_16x16x32_bf16 v[196:199], a[36:39], v[72:75], v[196:199]
buffer_load_dwordx4 a[100:103], v3, s[88:91], s101 offen offset:1024 sc1
v_mfma_f32_16x16x32_bf16 v[200:203], a[40:43], v[72:75], v[200:203]
ds_read_b128 a[36:39], v2 offset:17408
s_add_u32 s101, s101, 0x2000
v_mfma_f32_16x16x32_bf16 v[232:235], a[40:43], v[76:79], v[232:235]
buffer_load_dwordx4 a[104:107], v3, s[88:91], s101 offen sc1
v_mfma_f32_16x16x32_bf16 v[236:239], a[44:47], v[76:79], v[236:239]
ds_read_b128 a[40:43], v2 offset:18432
v_exp_f32 v30, v30
v_mfma_f32_16x16x32_bf16 v[204:207], a[44:47], v[72:75], v[204:207]
buffer_load_dwordx4 a[108:111], v3, s[88:91], s101 offen offset:1024 sc1
v_mfma_f32_16x16x32_bf16 v[208:211], a[48:51], v[72:75], v[208:211]
ds_read_b128 a[44:47], v2 offset:19456
s_add_u32 s101, s101, 0x2000
v_mfma_f32_16x16x32_bf16 v[240:243], a[48:51], v[76:79], v[240:243]
buffer_load_dwordx4 a[112:115], v3, s[88:91], s101 offen sc1
v_mfma_f32_16x16x32_bf16 v[244:247], a[52:55], v[76:79], v[244:247]
ds_read_b128 a[48:51], v2 offset:20480
v_exp_f32 v31, v31
v_mfma_f32_16x16x32_bf16 v[212:215], a[52:55], v[72:75], v[212:215]
buffer_load_dwordx4 a[116:119], v3, s[88:91], s101 offen offset:1024 sc1
v_mfma_f32_16x16x32_bf16 v[216:219], a[56:59], v[72:75], v[216:219]
ds_read_b128 a[52:55], v2 offset:21504
s_add_u32 s101, s101, 0x2000
v_mfma_f32_16x16x32_bf16 v[248:251], a[56:59], v[76:79], v[248:251]
buffer_load_dwordx4 a[120:123], v3, s[88:91], s101 offen sc1
v_mfma_f32_16x16x32_bf16 v[252:255], a[60:63], v[76:79], v[252:255]
buffer_load_dwordx4 a[124:127], v3, s[88:91], s101 offen offset:1024 sc1
v_mfma_f32_16x16x32_bf16 v[220:223], a[60:63], v[72:75], v[220:223]
ds_read_b128 a[56:59], v2 offset:22528
v_cvt_pk_bf16_f32 v60, v28, v29
v_smfmac_f32_16x16x64_bf16 a[228:231], a[232:235], v[72:79], v9
ds_read_b128 a[60:63], v2 offset:23552
v_xor_b32 v2, 0x38000, v2
v_exp_f32 v44, v44
v_exp_f32 v45, v45
v_exp_f32 v46, v46
v_exp_f32 v47, v47
v_cvt_pk_bf16_f32 v61, v30, v31
v_cvt_pk_bf16_f32 v62, v44, v45
v_cvt_pk_bf16_f32 v63, v46, v47
s_waitcnt lgkmcnt(0)
s_barrier
v_accvgpr_read_b32 v6, a228
v_accvgpr_read_b32 v7, a229
v_add_f32 v6, v6, v7
v_cmp_nge_f32 vcc, 0x5f800000, v6
v_rcp_f32 v6, v6
s_or_b64 s[34:35], s[34:35], vcc
v_mfma_f32_16x16x32_bf16 v[224:227], a[32:35], v[60:63], v[224:227]
s_add_u32 s8, s30, 0x0
v_mul_f32 v192, v6, v192
v_mfma_f32_16x16x32_bf16 v[228:231], a[36:39], v[60:63], v[228:231]
v_mul_f32 v193, v6, v193
v_mul_f32 v194, v6, v194
v_mfma_f32_16x16x32_bf16 v[232:235], a[40:43], v[60:63], v[232:235]
v_mul_f32 v195, v6, v195
v_mul_f32 v196, v6, v196
v_mfma_f32_16x16x32_bf16 v[236:239], a[44:47], v[60:63], v[236:239]
v_mul_f32 v197, v6, v197
v_mul_f32 v198, v6, v198
v_mfma_f32_16x16x32_bf16 v[240:243], a[48:51], v[60:63], v[240:243]
v_mul_f32 v199, v6, v199
v_cvt_pk_bf16_f32 v192, v192, v193
v_mfma_f32_16x16x32_bf16 v[244:247], a[52:55], v[60:63], v[244:247]
v_cvt_pk_bf16_f32 v193, v194, v195
v_cvt_pk_bf16_f32 v194, v196, v197
v_mfma_f32_16x16x32_bf16 v[248:251], a[56:59], v[60:63], v[248:251]
v_cvt_pk_bf16_f32 v195, v198, v199
buffer_store_dwordx4 v[192:195], v3, s[88:91], s8 offen sc1
v_mfma_f32_16x16x32_bf16 v[252:255], a[60:63], v[60:63], v[252:255]
v_mfma_f32_16x16x32_bf16 a[228:231], a[236:239], v[60:63], a[228:231]
s_add_u32 s8, s30, 0x2000
v_pk_mul_f32 v[200:201], v[200:201], v[6:7] op_sel_hi:[1,0]
v_pk_mul_f32 v[202:203], v[202:203], v[6:7] op_sel_hi:[1,0]
v_pk_mul_f32 v[204:205], v[204:205], v[6:7] op_sel_hi:[1,0]
v_pk_mul_f32 v[206:207], v[206:207], v[6:7] op_sel_hi:[1,0]
v_cvt_pk_bf16_f32 v200, v200, v201
v_cvt_pk_bf16_f32 v201, v202, v203
v_cvt_pk_bf16_f32 v202, v204, v205
v_cvt_pk_bf16_f32 v203, v206, v207
buffer_store_dwordx4 v[200:203], v3, s[88:91], s8 offen sc1
s_add_u32 s8, s30, 0x4000
v_pk_mul_f32 v[208:209], v[208:209], v[6:7] op_sel_hi:[1,0]
v_pk_mul_f32 v[210:211], v[210:211], v[6:7] op_sel_hi:[1,0]
v_pk_mul_f32 v[212:213], v[212:213], v[6:7] op_sel_hi:[1,0]
v_pk_mul_f32 v[214:215], v[214:215], v[6:7] op_sel_hi:[1,0]
v_cvt_pk_bf16_f32 v208, v208, v209
v_cvt_pk_bf16_f32 v209, v210, v211
v_cvt_pk_bf16_f32 v210, v212, v213
v_cvt_pk_bf16_f32 v211, v214, v215
buffer_store_dwordx4 v[208:211], v3, s[88:91], s8 offen sc1
s_add_u32 s8, s30, 0x6000
v_pk_mul_f32 v[216:217], v[216:217], v[6:7] op_sel_hi:[1,0]
v_pk_mul_f32 v[218:219], v[218:219], v[6:7] op_sel_hi:[1,0]
v_pk_mul_f32 v[220:221], v[220:221], v[6:7] op_sel_hi:[1,0]
v_pk_mul_f32 v[222:223], v[222:223], v[6:7] op_sel_hi:[1,0]
v_cvt_pk_bf16_f32 v216, v216, v217
v_cvt_pk_bf16_f32 v217, v218, v219
v_cvt_pk_bf16_f32 v218, v220, v221
v_cvt_pk_bf16_f32 v219, v222, v223
buffer_store_dwordx4 v[216:219], v3, s[88:91], s8 offen sc1
L_att_fin:
v_accvgpr_read_b32 v6, a230
v_accvgpr_read_b32 v7, a231
v_add_f32 v6, v6, v7
v_cmp_nge_f32 vcc, 0x5f800000, v6
v_rcp_f32 v6, v6
s_or_b64 s[34:35], s[34:35], vcc
s_add_u32 s8, s31, 0x0
v_pk_mul_f32 v[224:225], v[224:225], v[6:7] op_sel_hi:[1,0]
v_pk_mul_f32 v[226:227], v[226:227], v[6:7] op_sel_hi:[1,0]
v_pk_mul_f32 v[228:229], v[228:229], v[6:7] op_sel_hi:[1,0]
v_pk_mul_f32 v[230:231], v[230:231], v[6:7] op_sel_hi:[1,0]
v_cvt_pk_bf16_f32 v224, v224, v225
v_cvt_pk_bf16_f32 v225, v226, v227
v_cvt_pk_bf16_f32 v226, v228, v229
v_cvt_pk_bf16_f32 v227, v230, v231
buffer_store_dwordx4 v[224:227], v3, s[88:91], s8 offen sc1
s_add_u32 s8, s31, 0x2000
v_pk_mul_f32 v[232:233], v[232:233], v[6:7] op_sel_hi:[1,0]
v_pk_mul_f32 v[234:235], v[234:235], v[6:7] op_sel_hi:[1,0]
v_pk_mul_f32 v[236:237], v[236:237], v[6:7] op_sel_hi:[1,0]
v_pk_mul_f32 v[238:239], v[238:239], v[6:7] op_sel_hi:[1,0]
v_cvt_pk_bf16_f32 v232, v232, v233
v_cvt_pk_bf16_f32 v233, v234, v235
v_cvt_pk_bf16_f32 v234, v236, v237
v_cvt_pk_bf16_f32 v235, v238, v239
buffer_store_dwordx4 v[232:235], v3, s[88:91], s8 offen sc1
s_add_u32 s8, s31, 0x4000
v_pk_mul_f32 v[240:241], v[240:241], v[6:7] op_sel_hi:[1,0]
v_pk_mul_f32 v[242:243], v[242:243], v[6:7] op_sel_hi:[1,0]
v_pk_mul_f32 v[244:245], v[244:245], v[6:7] op_sel_hi:[1,0]
v_pk_mul_f32 v[246:247], v[246:247], v[6:7] op_sel_hi:[1,0]
v_cvt_pk_bf16_f32 v240, v240, v241
v_cvt_pk_bf16_f32 v241, v242, v243
v_cvt_pk_bf16_f32 v242, v244, v245
v_cvt_pk_bf16_f32 v243, v246, v247
buffer_store_dwordx4 v[240:243], v3, s[88:91], s8 offen sc1
s_add_u32 s8, s31, 0x6000
v_pk_mul_f32 v[248:249], v[248:249], v[6:7] op_sel_hi:[1,0]
v_pk_mul_f32 v[250:251], v[250:251], v[6:7] op_sel_hi:[1,0]
v_pk_mul_f32 v[252:253], v[252:253], v[6:7] op_sel_hi:[1,0]
v_pk_mul_f32 v[254:255], v[254:255], v[6:7] op_sel_hi:[1,0]
v_cvt_pk_bf16_f32 v248, v248, v249
v_cvt_pk_bf16_f32 v249, v250, v251
v_cvt_pk_bf16_f32 v250, v252, v253
v_cvt_pk_bf16_f32 v251, v254, v255
buffer_store_dwordx4 v[248:251], v3, s[88:91], s8 offen sc1
s_cmp_lg_u64 s[34:35], 0
s_cselect_b32 s8, 1, 0
s_lshl_b32 s9, s4, 2
s_add_u32 s9, s9, 24576
v_mov_b32 v4, s9
v_mov_b32 v5, s8
ds_write_b32 v4, v5
v_lshrrev_b32 v17, 4, v0
v_lshlrev_b32 v18, 10, v17
v_and_b32 v17, 1, v17
v_lshl_add_u32 v18, v17, 5, v18
v_bfe_u32 v17, v0, 2, 2
v_lshl_add_u32 v18, v17, 6, v18
v_and_b32 v17, 3, v0
v_lshl_add_u32 v4, v17, 3, v18
s_sub_u32 s8, s16, s17
v_add_u32 v6, s8, v4
v_xor_b32 v7, 32, v6
v_add_u32 v4, 65536, v4
v_xor_b32 v5, 32, v4
v_and_b32 v20, 15, v0
v_lshlrev_b32 v20, 2, v20
v_and_b32 v16, 28, v20
s_waitcnt vmcnt(20) lgkmcnt(0)
s_barrier
v_and_b32 v17, 3, v0
v_lshlrev_b32 v17, 2, v17
v_add_u32 v17, 24576, v17
ds_read_b32 v18, v17
s_waitcnt lgkmcnt(0)
v_cmp_ne_u32 vcc, 0, v18
s_cmp_lg_u32 s33, 0
s_cbranch_scc1 L_att_done
s_nop 4
s_cbranch_vccnz L_att_fallback
L_att_done:
ds_read_b64_tr_b16 v[152:153], v4 offset:512
ds_read_b64_tr_b16 v[154:155], v4 offset:4608
ds_read_b64_tr_b16 v[156:157], v4 offset:8704
ds_read_b64_tr_b16 v[158:159], v4 offset:12800
ds_read_b64_tr_b16 v[160:161], v5 offset:512
ds_read_b64_tr_b16 v[162:163], v5 offset:4608
ds_read_b64_tr_b16 v[164:165], v5 offset:8704
ds_read_b64_tr_b16 v[166:167], v5 offset:12800
ds_read_b64_tr_b16 v[168:169], v4 offset:768
ds_read_b64_tr_b16 v[170:171], v4 offset:4864
ds_read_b64_tr_b16 v[172:173], v4 offset:8960
ds_read_b64_tr_b16 v[174:175], v4 offset:13056
ds_read_b64_tr_b16 v[176:177], v5 offset:768
ds_read_b64_tr_b16 v[178:179], v5 offset:4864
ds_read_b64_tr_b16 v[180:181], v5 offset:8960
ds_read_b64_tr_b16 v[182:183], v5 offset:13056
s_lshl_b32 s29, s99, 7
s_lshl_b32 s9, s4, 5
s_add_u32 s29, s29, s9
s_lshl_b32 s9, s29, 2
s_add_u32 s9, s9, 0x3700000
buffer_load_dword v8, v20, s[88:91], s9 offen sc1
buffer_load_dword v9, v20, s[88:91], s9 offen offset:64 sc1
s_waitcnt lgkmcnt(8)
v_mfma_f32_16x16x32_bf16 v[56:59], v[152:155], a[64:67], 0
ds_read_b64_tr_b16 v[184:185], v4 offset:0
v_mov_b32 v88, 0
v_mfma_f32_16x16x32_bf16 v[56:59], v[156:159], a[72:75], v[56:59]
ds_read_b64_tr_b16 v[186:187], v4 offset:4096
v_mov_b32 v89, 0
v_mfma_f32_16x16x32_bf16 v[72:75], v[156:159], a[76:79], 0
ds_read_b64_tr_b16 v[188:189], v4 offset:8192
v_mov_b32 v90, 0
v_mfma_f32_16x16x32_bf16 v[72:75], v[152:155], a[68:71], v[72:75]
ds_read_b64_tr_b16 v[190:191], v4 offset:12288
v_mov_b32 v91, 0
v_mfma_f32_16x16x32_bf16 v[76:79], v[160:163], a[68:71], 0
ds_read_b64_tr_b16 v[192:193], v5 offset:0
v_mov_b32 v92, 0
v_mfma_f32_16x16x32_bf16 v[76:79], v[164:167], a[76:79], v[76:79]
ds_read_b64_tr_b16 v[194:195], v5 offset:4096
v_mov_b32 v93, 0
v_mfma_f32_16x16x32_bf16 v[60:63], v[164:167], a[72:75], 0
ds_read_b64_tr_b16 v[196:197], v5 offset:8192
s_waitcnt lgkmcnt(7)
v_mfma_f32_16x16x32_bf16 v[60:63], v[160:163], a[64:67], v[60:63]
ds_read_b64_tr_b16 v[198:199], v5 offset:12288
v_mov_b32 v94, 0
v_mfma_f32_16x16x32_bf16 v[64:67], v[168:171], a[64:67], 0
ds_read_b64_tr_b16 v[200:201], v4 offset:256
v_mov_b32 v95, 0
v_mfma_f32_16x16x32_bf16 v[64:67], v[172:175], a[72:75], v[64:67]
ds_read_b64_tr_b16 v[202:203], v4 offset:4352
v_mov_b32 v96, 0
v_mfma_f32_16x16x32_bf16 v[80:83], v[172:175], a[76:79], 0
ds_read_b64_tr_b16 v[204:205], v4 offset:8448
v_mov_b32 v97, 0
v_mfma_f32_16x16x32_bf16 v[80:83], v[168:171], a[68:71], v[80:83]
ds_read_b64_tr_b16 v[206:207], v4 offset:12544
v_mov_b32 v98, 0
v_mfma_f32_16x16x32_bf16 v[84:87], v[176:179], a[68:71], 0
ds_read_b64_tr_b16 v[208:209], v5 offset:256
v_mov_b32 v99, 0
v_mfma_f32_16x16x32_bf16 v[84:87], v[180:183], a[76:79], v[84:87]
ds_read_b64_tr_b16 v[210:211], v5 offset:4352
s_waitcnt vmcnt(2) lgkmcnt(6)
v_mfma_f32_16x16x32_bf16 v[68:71], v[180:183], a[72:75], 0
ds_read_b64_tr_b16 v[212:213], v5 offset:8448
s_barrier
v_mfma_f32_16x16x32_bf16 v[68:71], v[176:179], a[64:67], v[68:71]
ds_read_b64_tr_b16 v[214:215], v5 offset:12544
v_mov_b32 v100, 0
s_cmp_lg_u32 s4, 0
s_cbranch_scc1 L_flag_set
s_lshl_b32 s8, s6, 5
s_add_u32 s8, s8, s5
s_and_b32 s92, s8, 0xf0
s_mul_i32 s92, s92, 3
s_add_u32 s8, s8, s92
s_lshl_b32 s8, s8, 2
s_add_u32 s8, s8, 0x3704000
v_mov_b32 v21, 1
s_mov_b64 exec, 1
buffer_store_dword v21, off, s[88:91], s8 sc1
s_mov_b64 exec, -1
L_flag_set:
v_mfma_f32_16x16x32_bf16 v[24:27], v[184:187], a[64:67], 0
ds_read_b64_tr_b16 v[152:153], v4 offset:16896
s_lshl_b32 s29, s29, 11
v_mfma_f32_16x16x32_bf16 v[24:27], v[188:191], a[72:75], v[24:27]
ds_read_b64_tr_b16 v[154:155], v4 offset:20992
s_lshl_b32 s9, s100, 8
v_mfma_f32_16x16x32_bf16 v[40:43], v[188:191], a[76:79], 0
ds_read_b64_tr_b16 v[156:157], v4 offset:25088
s_add_u32 s29, s29, s9
v_mfma_f32_16x16x32_bf16 v[40:43], v[184:187], a[68:71], v[40:43]
ds_read_b64_tr_b16 v[158:159], v4 offset:29184
s_lshl_b32 s9, s14, 7
v_mfma_f32_16x16x32_bf16 v[44:47], v[192:195], a[68:71], 0
ds_read_b64_tr_b16 v[160:161], v5 offset:16896
s_add_u32 s29, s29, s9
v_mfma_f32_16x16x32_bf16 v[44:47], v[196:199], a[76:79], v[44:47]
ds_read_b64_tr_b16 v[162:163], v5 offset:20992
s_add_u32 s31, s29, 0x8000
v_mfma_f32_16x16x32_bf16 v[28:31], v[196:199], a[72:75], 0
ds_read_b64_tr_b16 v[164:165], v5 offset:25088
s_waitcnt lgkmcnt(7)
v_mfma_f32_16x16x32_bf16 v[28:31], v[192:195], a[64:67], v[28:31]
ds_read_b64_tr_b16 v[166:167], v5 offset:29184
s_lshl_b32 s28, s2, 2
v_mfma_f32_16x16x32_bf16 v[32:35], v[200:203], a[64:67], 0
ds_read_b64_tr_b16 v[168:169], v4 offset:17152
s_add_u32 s28, s28, s4
v_mfma_f32_16x16x32_bf16 v[32:35], v[204:207], a[72:75], v[32:35]
ds_read_b64_tr_b16 v[170:171], v4 offset:21248
s_lshl_b32 s28, s28, 12
v_mfma_f32_16x16x32_bf16 v[48:51], v[204:207], a[76:79], 0
ds_read_b64_tr_b16 v[172:173], v4 offset:25344
s_add_u32 s28, s28, 0x3800000
v_mfma_f32_16x16x32_bf16 v[48:51], v[200:203], a[68:71], v[48:51]
ds_read_b64_tr_b16 v[174:175], v4 offset:29440
s_xor_b32 s30, s28, 0x4000
v_mfma_f32_16x16x32_bf16 v[52:55], v[208:211], a[68:71], 0
ds_read_b64_tr_b16 v[176:177], v5 offset:17152
v_and_b32 v18, 16, v0
v_mfma_f32_16x16x32_bf16 v[52:55], v[212:215], a[76:79], v[52:55]
ds_read_b64_tr_b16 v[178:179], v5 offset:21248
s_waitcnt lgkmcnt(6)
v_mfma_f32_16x16x32_bf16 v[36:39], v[212:215], a[72:75], 0
ds_read_b64_tr_b16 v[180:181], v5 offset:25344
v_lshrrev_b32 v19, 5, v0
v_mfma_f32_16x16x32_bf16 v[36:39], v[208:211], a[64:67], v[36:39]
ds_read_b64_tr_b16 v[182:183], v5 offset:29440
v_lshlrev_b32 v19, 4, v19
v_mfma_f32_16x16x32_bf16 v[56:59], v[152:155], a[80:83], v[56:59]
ds_read_b64_tr_b16 v[184:185], v4 offset:16384
v_mov_b32 v101, 0
v_mfma_f32_16x16x32_bf16 v[56:59], v[156:159], a[88:91], v[56:59]
ds_read_b64_tr_b16 v[186:187], v4 offset:20480
v_mov_b32 v102, 0
v_mfma_f32_16x16x32_bf16 v[72:75], v[156:159], a[92:95], v[72:75]
ds_read_b64_tr_b16 v[188:189], v4 offset:24576
v_mov_b32 v103, 0
v_mfma_f32_16x16x32_bf16 v[72:75], v[152:155], a[84:87], v[72:75]
ds_read_b64_tr_b16 v[190:191], v4 offset:28672
v_mov_b32 v104, 0
v_mfma_f32_16x16x32_bf16 v[76:79], v[160:163], a[84:87], v[76:79]
ds_read_b64_tr_b16 v[192:193], v5 offset:16384
v_mov_b32 v105, 0
v_mfma_f32_16x16x32_bf16 v[76:79], v[164:167], a[92:95], v[76:79]
ds_read_b64_tr_b16 v[194:195], v5 offset:20480
v_mov_b32 v106, 0
v_mfma_f32_16x16x32_bf16 v[60:63], v[164:167], a[88:91], v[60:63]
ds_read_b64_tr_b16 v[196:197], v5 offset:24576
s_waitcnt lgkmcnt(7)
v_mfma_f32_16x16x32_bf16 v[60:63], v[160:163], a[80:83], v[60:63]
ds_read_b64_tr_b16 v[198:199], v5 offset:28672
v_mov_b32 v107, 0
v_mfma_f32_16x16x32_bf16 v[64:67], v[168:171], a[80:83], v[64:67]
ds_read_b64_tr_b16 v[200:201], v4 offset:16640
v_mov_b32 v108, 0
v_mfma_f32_16x16x32_bf16 v[64:67], v[172:175], a[88:91], v[64:67]
ds_read_b64_tr_b16 v[202:203], v4 offset:20736
v_mov_b32 v109, 0
v_mfma_f32_16x16x32_bf16 v[80:83], v[172:175], a[92:95], v[80:83]
ds_read_b64_tr_b16 v[204:205], v4 offset:24832
v_mov_b32 v110, 0
v_mfma_f32_16x16x32_bf16 v[80:83], v[168:171], a[84:87], v[80:83]
ds_read_b64_tr_b16 v[206:207], v4 offset:28928
v_mov_b32 v111, 0
v_mfma_f32_16x16x32_bf16 v[84:87], v[176:179], a[84:87], v[84:87]
ds_read_b64_tr_b16 v[208:209], v5 offset:16640
v_lshl_add_u32 v18, v18, 1, v19
v_mfma_f32_16x16x32_bf16 v[84:87], v[180:183], a[92:95], v[84:87]
ds_read_b64_tr_b16 v[210:211], v5 offset:20736
s_waitcnt vmcnt(14) lgkmcnt(6)
v_mfma_f32_16x16x32_bf16 v[68:71], v[180:183], a[88:91], v[68:71]
ds_read_b64_tr_b16 v[212:213], v5 offset:24832
s_barrier
v_mfma_f32_16x16x32_bf16 v[68:71], v[176:179], a[80:83], v[68:71]
ds_read_b64_tr_b16 v[214:215], v5 offset:28928
v_lshl_add_u32 v17, v20, 9, v18
s_cmp_eq_u32 s14, 1
s_cbranch_scc1 L_p4_skip
v_mfma_f32_16x16x32_bf16 v[24:27], v[184:187], a[80:83], v[24:27]
ds_read_b64_tr_b16 v[152:153], v6 offset:512
ds_read_b64_tr_b16 v[154:155], v6 offset:4608
v_mfma_f32_16x16x32_bf16 v[24:27], v[188:191], a[88:91], v[24:27]
ds_read_b64_tr_b16 v[156:157], v6 offset:8704
v_add_u32 v12, 0x20000, v12
v_mfma_f32_16x16x32_bf16 v[40:43], v[188:191], a[92:95], v[40:43]
ds_read_b64_tr_b16 v[158:159], v6 offset:12800
s_add_u32 m0, s17, 0x10000
v_mfma_f32_16x16x32_bf16 v[40:43], v[184:187], a[84:87], v[40:43]
buffer_load_dwordx4 v12, s[72:75], 0 offen lds
v_mfma_f32_16x16x32_bf16 v[44:47], v[192:195], a[84:87], v[44:47]
ds_read_b64_tr_b16 v[160:161], v7 offset:512
ds_read_b64_tr_b16 v[162:163], v7 offset:4608
v_mfma_f32_16x16x32_bf16 v[44:47], v[196:199], a[92:95], v[44:47]
ds_read_b64_tr_b16 v[164:165], v7 offset:8704
v_add_u32 v13, 0x20000, v13
v_mfma_f32_16x16x32_bf16 v[28:31], v[196:199], a[88:91], v[28:31]
ds_read_b64_tr_b16 v[166:167], v7 offset:12800
s_waitcnt lgkmcnt(8)
v_mfma_f32_16x16x32_bf16 v[28:31], v[192:195], a[80:83], v[28:31]
buffer_load_dwordx4 v13, s[72:75], 0 offen offset:1024 lds
v_mfma_f32_16x16x32_bf16 v[32:35], v[200:203], a[80:83], v[32:35]
ds_read_b64_tr_b16 v[168:169], v6 offset:768
ds_read_b64_tr_b16 v[170:171], v6 offset:4864
v_mfma_f32_16x16x32_bf16 v[32:35], v[204:207], a[88:91], v[32:35]
ds_read_b64_tr_b16 v[172:173], v6 offset:8960
v_mfma_f32_16x16x32_bf16 v[48:51], v[204:207], a[92:95], v[48:51]
ds_read_b64_tr_b16 v[174:175], v6 offset:13056
v_mfma_f32_16x16x32_bf16 v[48:51], v[200:203], a[84:87], v[48:51]
buffer_load_dwordx4 v12, s[72:75], s12 offen offset:2048 lds
v_mfma_f32_16x16x32_bf16 v[52:55], v[208:211], a[84:87], v[52:55]
ds_read_b64_tr_b16 v[176:177], v7 offset:768
ds_read_b64_tr_b16 v[178:179], v7 offset:4864
v_mfma_f32_16x16x32_bf16 v[52:55], v[212:215], a[92:95], v[52:55]
ds_read_b64_tr_b16 v[180:181], v7 offset:8960
s_waitcnt lgkmcnt(7)
v_mfma_f32_16x16x32_bf16 v[36:39], v[212:215], a[88:91], v[36:39]
ds_read_b64_tr_b16 v[182:183], v7 offset:13056
v_mfma_f32_16x16x32_bf16 v[36:39], v[208:211], a[80:83], v[36:39]
buffer_load_dwordx4 v13, s[72:75], s12 offen offset:3072 lds
v_mfma_f32_16x16x32_bf16 v[56:59], v[152:155], a[96:99], v[56:59]
ds_read_b64_tr_b16 v[184:185], v6 offset:0
ds_read_b64_tr_b16 v[186:187], v6 offset:4096
v_mfma_f32_16x16x32_bf16 v[56:59], v[156:159], a[104:107], v[56:59]
ds_read_b64_tr_b16 v[188:189], v6 offset:8192
v_mfma_f32_16x16x32_bf16 v[72:75], v[156:159], a[108:111], v[72:75]
ds_read_b64_tr_b16 v[190:191], v6 offset:12288
s_add_u32 s101, s101, 0x2000
v_mfma_f32_16x16x32_bf16 v[72:75], v[152:155], a[100:103], v[72:75]
buffer_load_dwordx4 a[64:67], v3, s[88:91], s101 offen sc1
v_mfma_f32_16x16x32_bf16 v[76:79], v[160:163], a[100:103], v[76:79]
ds_read_b64_tr_b16 v[192:193], v7 offset:0
ds_read_b64_tr_b16 v[194:195], v7 offset:4096
v_mfma_f32_16x16x32_bf16 v[76:79], v[164:167], a[108:111], v[76:79]
ds_read_b64_tr_b16 v[196:197], v7 offset:8192
v_mfma_f32_16x16x32_bf16 v[60:63], v[164:167], a[104:107], v[60:63]
ds_read_b64_tr_b16 v[198:199], v7 offset:12288
s_waitcnt lgkmcnt(8)
v_mfma_f32_16x16x32_bf16 v[60:63], v[160:163], a[96:99], v[60:63]
buffer_load_dwordx4 a[68:71], v3, s[88:91], s101 offen offset:1024 sc1
v_mfma_f32_16x16x32_bf16 v[64:67], v[168:171], a[96:99], v[64:67]
ds_read_b64_tr_b16 v[200:201], v6 offset:256
ds_read_b64_tr_b16 v[202:203], v6 offset:4352
v_mfma_f32_16x16x32_bf16 v[64:67], v[172:175], a[104:107], v[64:67]
ds_read_b64_tr_b16 v[204:205], v6 offset:8448
v_mfma_f32_16x16x32_bf16 v[80:83], v[172:175], a[108:111], v[80:83]
ds_read_b64_tr_b16 v[206:207], v6 offset:12544
s_add_u32 s101, s101, 0x2000
v_mfma_f32_16x16x32_bf16 v[80:83], v[168:171], a[100:103], v[80:83]
buffer_load_dwordx4 a[72:75], v3, s[88:91], s101 offen sc1
v_mfma_f32_16x16x32_bf16 v[84:87], v[176:179], a[100:103], v[84:87]
ds_read_b64_tr_b16 v[208:209], v7 offset:256
ds_read_b64_tr_b16 v[210:211], v7 offset:4352
v_mfma_f32_16x16x32_bf16 v[84:87], v[180:183], a[108:111], v[84:87]
ds_read_b64_tr_b16 v[212:213], v7 offset:8448
s_waitcnt vmcnt(17) lgkmcnt(7)
v_mfma_f32_16x16x32_bf16 v[68:71], v[180:183], a[104:107], v[68:71]
ds_read_b64_tr_b16 v[214:215], v7 offset:12544
s_barrier
v_mfma_f32_16x16x32_bf16 v[68:71], v[176:179], a[96:99], v[68:71]
buffer_load_dwordx4 a[76:79], v3, s[88:91], s101 offen offset:1024 sc1
v_mfma_f32_16x16x32_bf16 v[24:27], v[184:187], a[96:99], v[24:27]
ds_read_b64_tr_b16 v[152:153], v6 offset:16896
ds_read_b64_tr_b16 v[154:155], v6 offset:20992
v_mfma_f32_16x16x32_bf16 v[24:27], v[188:191], a[104:107], v[24:27]
ds_read_b64_tr_b16 v[156:157], v6 offset:25088
v_add_u32 v12, 0x20000, v12
v_mfma_f32_16x16x32_bf16 v[40:43], v[188:191], a[108:111], v[40:43]
ds_read_b64_tr_b16 v[158:159], v6 offset:29184
s_add_u32 m0, s17, 0x14000
v_mfma_f32_16x16x32_bf16 v[40:43], v[184:187], a[100:103], v[40:43]
buffer_load_dwordx4 v12, s[72:75], 0 offen lds
v_mfma_f32_16x16x32_bf16 v[44:47], v[192:195], a[100:103], v[44:47]
ds_read_b64_tr_b16 v[160:161], v7 offset:16896
ds_read_b64_tr_b16 v[162:163], v7 offset:20992
v_mfma_f32_16x16x32_bf16 v[44:47], v[196:199], a[108:111], v[44:47]
ds_read_b64_tr_b16 v[164:165], v7 offset:25088
v_add_u32 v13, 0x20000, v13
v_mfma_f32_16x16x32_bf16 v[28:31], v[196:199], a[104:107], v[28:31]
ds_read_b64_tr_b16 v[166:167], v7 offset:29184
s_waitcnt lgkmcnt(8)
v_mfma_f32_16x16x32_bf16 v[28:31], v[192:195], a[96:99], v[28:31]
buffer_load_dwordx4 v13, s[72:75], 0 offen offset:1024 lds
v_mfma_f32_16x16x32_bf16 v[32:35], v[200:203], a[96:99], v[32:35]
ds_read_b64_tr_b16 v[168:169], v6 offset:17152
ds_read_b64_tr_b16 v[170:171], v6 offset:21248
v_mfma_f32_16x16x32_bf16 v[32:35], v[204:207], a[104:107], v[32:35]
ds_read_b64_tr_b16 v[172:173], v6 offset:25344
v_mfma_f32_16x16x32_bf16 v[48:51], v[204:207], a[108:111], v[48:51]
ds_read_b64_tr_b16 v[174:175], v6 offset:29440
v_mfma_f32_16x16x32_bf16 v[48:51], v[200:203], a[100:103], v[48:51]
buffer_load_dwordx4 v12, s[72:75], s12 offen offset:2048 lds
v_mfma_f32_16x16x32_bf16 v[52:55], v[208:211], a[100:103], v[52:55]
ds_read_b64_tr_b16 v[176:177], v7 offset:17152
ds_read_b64_tr_b16 v[178:179], v7 offset:21248
v_mfma_f32_16x16x32_bf16 v[52:55], v[212:215], a[108:111], v[52:55]
ds_read_b64_tr_b16 v[180:181], v7 offset:25344
s_waitcnt lgkmcnt(7)
v_mfma_f32_16x16x32_bf16 v[36:39], v[212:215], a[104:107], v[36:39]
ds_read_b64_tr_b16 v[182:183], v7 offset:29440
v_mfma_f32_16x16x32_bf16 v[36:39], v[208:211], a[96:99], v[36:39]
buffer_load_dwordx4 v13, s[72:75], s12 offen offset:3072 lds
v_mfma_f32_16x16x32_bf16 v[56:59], v[152:155], a[112:115], v[56:59]
ds_read_b64_tr_b16 v[184:185], v6 offset:16384
ds_read_b64_tr_b16 v[186:187], v6 offset:20480
v_mfma_f32_16x16x32_bf16 v[56:59], v[156:159], a[120:123], v[56:59]
ds_read_b64_tr_b16 v[188:189], v6 offset:24576
v_mfma_f32_16x16x32_bf16 v[72:75], v[156:159], a[124:127], v[72:75]
ds_read_b64_tr_b16 v[190:191], v6 offset:28672
s_add_u32 s101, s101, 0x2000
v_mfma_f32_16x16x32_bf16 v[72:75], v[152:155], a[116:119], v[72:75]
buffer_load_dwordx4 a[80:83], v3, s[88:91], s101 offen sc1
v_mfma_f32_16x16x32_bf16 v[76:79], v[160:163], a[116:119], v[76:79]
ds_read_b64_tr_b16 v[192:193], v7 offset:16384
ds_read_b64_tr_b16 v[194:195], v7 offset:20480
v_mfma_f32_16x16x32_bf16 v[76:79], v[164:167], a[124:127], v[76:79]
ds_read_b64_tr_b16 v[196:197], v7 offset:24576
v_mfma_f32_16x16x32_bf16 v[60:63], v[164:167], a[120:123], v[60:63]
ds_read_b64_tr_b16 v[198:199], v7 offset:28672
s_waitcnt lgkmcnt(8)
v_mfma_f32_16x16x32_bf16 v[60:63], v[160:163], a[112:115], v[60:63]
buffer_load_dwordx4 a[84:87], v3, s[88:91], s101 offen offset:1024 sc1
v_mfma_f32_16x16x32_bf16 v[64:67], v[168:171], a[112:115], v[64:67]
ds_read_b64_tr_b16 v[200:201], v6 offset:16640
ds_read_b64_tr_b16 v[202:203], v6 offset:20736
v_mfma_f32_16x16x32_bf16 v[64:67], v[172:175], a[120:123], v[64:67]
ds_read_b64_tr_b16 v[204:205], v6 offset:24832
v_mfma_f32_16x16x32_bf16 v[80:83], v[172:175], a[124:127], v[80:83]
ds_read_b64_tr_b16 v[206:207], v6 offset:28928
s_add_u32 s101, s101, 0x2000
v_mfma_f32_16x16x32_bf16 v[80:83], v[168:171], a[116:119], v[80:83]
buffer_load_dwordx4 a[88:91], v3, s[88:91], s101 offen sc1
v_mfma_f32_16x16x32_bf16 v[84:87], v[176:179], a[116:119], v[84:87]
ds_read_b64_tr_b16 v[208:209], v7 offset:16640
ds_read_b64_tr_b16 v[210:211], v7 offset:20736
v_mfma_f32_16x16x32_bf16 v[84:87], v[180:183], a[124:127], v[84:87]
ds_read_b64_tr_b16 v[212:213], v7 offset:24832
s_waitcnt vmcnt(7) lgkmcnt(7)
v_mfma_f32_16x16x32_bf16 v[68:71], v[180:183], a[120:123], v[68:71]
ds_read_b64_tr_b16 v[214:215], v7 offset:28928
s_barrier
v_mfma_f32_16x16x32_bf16 v[68:71], v[176:179], a[112:115], v[68:71]
buffer_load_dwordx4 a[92:95], v3, s[88:91], s101 offen offset:1024 sc1
v_mfma_f32_16x16x32_bf16 v[24:27], v[184:187], a[112:115], v[24:27]
ds_read_b64_tr_b16 v[152:153], v4 offset:512
ds_read_b64_tr_b16 v[154:155], v4 offset:4608
v_mfma_f32_16x16x32_bf16 v[24:27], v[188:191], a[120:123], v[24:27]
ds_read_b64_tr_b16 v[156:157], v4 offset:8704
v_add_u32 v12, 0x20000, v12
v_mfma_f32_16x16x32_bf16 v[40:43], v[188:191], a[124:127], v[40:43]
ds_read_b64_tr_b16 v[158:159], v4 offset:12800
s_add_u32 m0, s16, 0x0
v_mfma_f32_16x16x32_bf16 v[40:43], v[184:187], a[116:119], v[40:43]
buffer_load_dwordx4 v12, s[72:75], 0 offen lds
v_mfma_f32_16x16x32_bf16 v[44:47], v[192:195], a[116:119], v[44:47]
ds_read_b64_tr_b16 v[160:161], v5 offset:512
ds_read_b64_tr_b16 v[162:163], v5 offset:4608
v_mfma_f32_16x16x32_bf16 v[44:47], v[196:199], a[124:127], v[44:47]
ds_read_b64_tr_b16 v[164:165], v5 offset:8704
v_add_u32 v13, 0x20000, v13
v_mfma_f32_16x16x32_bf16 v[28:31], v[196:199], a[120:123], v[28:31]
ds_read_b64_tr_b16 v[166:167], v5 offset:12800
s_waitcnt lgkmcnt(8)
v_mfma_f32_16x16x32_bf16 v[28:31], v[192:195], a[112:115], v[28:31]
buffer_load_dwordx4 v13, s[72:75], 0 offen offset:1024 lds
v_mfma_f32_16x16x32_bf16 v[32:35], v[200:203], a[112:115], v[32:35]
ds_read_b64_tr_b16 v[168:169], v4 offset:768
ds_read_b64_tr_b16 v[170:171], v4 offset:4864
v_mfma_f32_16x16x32_bf16 v[32:35], v[204:207], a[120:123], v[32:35]
ds_read_b64_tr_b16 v[172:173], v4 offset:8960
v_mfma_f32_16x16x32_bf16 v[48:51], v[204:207], a[124:127], v[48:51]
ds_read_b64_tr_b16 v[174:175], v4 offset:13056
v_mfma_f32_16x16x32_bf16 v[48:51], v[200:203], a[116:119], v[48:51]
buffer_load_dwordx4 v12, s[72:75], s12 offen offset:2048 lds
v_mfma_f32_16x16x32_bf16 v[52:55], v[208:211], a[116:119], v[52:55]
ds_read_b64_tr_b16 v[176:177], v5 offset:768
ds_read_b64_tr_b16 v[178:179], v5 offset:4864
v_mfma_f32_16x16x32_bf16 v[52:55], v[212:215], a[124:127], v[52:55]
ds_read_b64_tr_b16 v[180:181], v5 offset:8960
s_waitcnt lgkmcnt(7)
v_mfma_f32_16x16x32_bf16 v[36:39], v[212:215], a[120:123], v[36:39]
ds_read_b64_tr_b16 v[182:183], v5 offset:13056
v_mfma_f32_16x16x32_bf16 v[36:39], v[208:211], a[112:115], v[36:39]
buffer_load_dwordx4 v13, s[72:75], s12 offen offset:3072 lds
v_mfma_f32_16x16x32_bf16 v[56:59], v[152:155], a[64:67], v[56:59]
ds_read_b64_tr_b16 v[184:185], v4 offset:0
ds_read_b64_tr_b16 v[186:187], v4 offset:4096
v_mfma_f32_16x16x32_bf16 v[56:59], v[156:159], a[72:75], v[56:59]
ds_read_b64_tr_b16 v[188:189], v4 offset:8192
v_mfma_f32_16x16x32_bf16 v[72:75], v[156:159], a[76:79], v[72:75]
ds_read_b64_tr_b16 v[190:191], v4 offset:12288
s_add_u32 s101, s101, 0x2000
v_mfma_f32_16x16x32_bf16 v[72:75], v[152:155], a[68:71], v[72:75]
buffer_load_dwordx4 a[96:99], v3, s[88:91], s101 offen sc1
v_mfma_f32_16x16x32_bf16 v[76:79], v[160:163], a[68:71], v[76:79]
ds_read_b64_tr_b16 v[192:193], v5 offset:0
ds_read_b64_tr_b16 v[194:195], v5 offset:4096
v_mfma_f32_16x16x32_bf16 v[76:79], v[164:167], a[76:79], v[76:79]
ds_read_b64_tr_b16 v[196:197], v5 offset:8192
v_mfma_f32_16x16x32_bf16 v[60:63], v[164:167], a[72:75], v[60:63]
ds_read_b64_tr_b16 v[198:199], v5 offset:12288
s_waitcnt lgkmcnt(8)
v_mfma_f32_16x16x32_bf16 v[60:63], v[160:163], a[64:67], v[60:63]
buffer_load_dwordx4 a[100:103], v3, s[88:91], s101 offen offset:1024 sc1
v_mfma_f32_16x16x32_bf16 v[64:67], v[168:171], a[64:67], v[64:67]
ds_read_b64_tr_b16 v[200:201], v4 offset:256
ds_read_b64_tr_b16 v[202:203], v4 offset:4352
v_mfma_f32_16x16x32_bf16 v[64:67], v[172:175], a[72:75], v[64:67]
ds_read_b64_tr_b16 v[204:205], v4 offset:8448
v_mfma_f32_16x16x32_bf16 v[80:83], v[172:175], a[76:79], v[80:83]
ds_read_b64_tr_b16 v[206:207], v4 offset:12544
s_add_u32 s101, s101, 0x2000
v_mfma_f32_16x16x32_bf16 v[80:83], v[168:171], a[68:71], v[80:83]
buffer_load_dwordx4 a[104:107], v3, s[88:91], s101 offen sc1
v_mfma_f32_16x16x32_bf16 v[84:87], v[176:179], a[68:71], v[84:87]
ds_read_b64_tr_b16 v[208:209], v5 offset:256
ds_read_b64_tr_b16 v[210:211], v5 offset:4352
v_mfma_f32_16x16x32_bf16 v[84:87], v[180:183], a[76:79], v[84:87]
ds_read_b64_tr_b16 v[212:213], v5 offset:8448
s_waitcnt vmcnt(7) lgkmcnt(7)
v_mfma_f32_16x16x32_bf16 v[68:71], v[180:183], a[72:75], v[68:71]
ds_read_b64_tr_b16 v[214:215], v5 offset:12544
s_barrier
v_mfma_f32_16x16x32_bf16 v[68:71], v[176:179], a[64:67], v[68:71]
buffer_load_dwordx4 a[108:111], v3, s[88:91], s101 offen offset:1024 sc1
v_mfma_f32_16x16x32_bf16 v[24:27], v[184:187], a[64:67], v[24:27]
ds_read_b64_tr_b16 v[152:153], v4 offset:16896
ds_read_b64_tr_b16 v[154:155], v4 offset:20992
v_mfma_f32_16x16x32_bf16 v[24:27], v[188:191], a[72:75], v[24:27]
ds_read_b64_tr_b16 v[156:157], v4 offset:25088
v_add_u32 v12, 0x20000, v12
v_mfma_f32_16x16x32_bf16 v[40:43], v[188:191], a[76:79], v[40:43]
ds_read_b64_tr_b16 v[158:159], v4 offset:29184
s_add_u32 m0, s16, 0x4000
v_mfma_f32_16x16x32_bf16 v[40:43], v[184:187], a[68:71], v[40:43]
buffer_load_dwordx4 v12, s[72:75], 0 offen lds
v_mfma_f32_16x16x32_bf16 v[44:47], v[192:195], a[68:71], v[44:47]
ds_read_b64_tr_b16 v[160:161], v5 offset:16896
ds_read_b64_tr_b16 v[162:163], v5 offset:20992
v_mfma_f32_16x16x32_bf16 v[44:47], v[196:199], a[76:79], v[44:47]
ds_read_b64_tr_b16 v[164:165], v5 offset:25088
v_add_u32 v13, 0x20000, v13
v_mfma_f32_16x16x32_bf16 v[28:31], v[196:199], a[72:75], v[28:31]
ds_read_b64_tr_b16 v[166:167], v5 offset:29184
s_waitcnt lgkmcnt(8)
v_mfma_f32_16x16x32_bf16 v[28:31], v[192:195], a[64:67], v[28:31]
buffer_load_dwordx4 v13, s[72:75], 0 offen offset:1024 lds
v_mfma_f32_16x16x32_bf16 v[32:35], v[200:203], a[64:67], v[32:35]
ds_read_b64_tr_b16 v[168:169], v4 offset:17152
ds_read_b64_tr_b16 v[170:171], v4 offset:21248
v_mfma_f32_16x16x32_bf16 v[32:35], v[204:207], a[72:75], v[32:35]
ds_read_b64_tr_b16 v[172:173], v4 offset:25344
v_mfma_f32_16x16x32_bf16 v[48:51], v[204:207], a[76:79], v[48:51]
ds_read_b64_tr_b16 v[174:175], v4 offset:29440
v_mfma_f32_16x16x32_bf16 v[48:51], v[200:203], a[68:71], v[48:51]
buffer_load_dwordx4 v12, s[72:75], s12 offen offset:2048 lds
v_mfma_f32_16x16x32_bf16 v[52:55], v[208:211], a[68:71], v[52:55]
ds_read_b64_tr_b16 v[176:177], v5 offset:17152
ds_read_b64_tr_b16 v[178:179], v5 offset:21248
v_mfma_f32_16x16x32_bf16 v[52:55], v[212:215], a[76:79], v[52:55]
ds_read_b64_tr_b16 v[180:181], v5 offset:25344
s_waitcnt lgkmcnt(7)
v_mfma_f32_16x16x32_bf16 v[36:39], v[212:215], a[72:75], v[36:39]
ds_read_b64_tr_b16 v[182:183], v5 offset:29440
v_mfma_f32_16x16x32_bf16 v[36:39], v[208:211], a[64:67], v[36:39]
buffer_load_dwordx4 v13, s[72:75], s12 offen offset:3072 lds
v_mfma_f32_16x16x32_bf16 v[56:59], v[152:155], a[80:83], v[56:59]
ds_read_b64_tr_b16 v[184:185], v4 offset:16384
ds_read_b64_tr_b16 v[186:187], v4 offset:20480
v_mfma_f32_16x16x32_bf16 v[56:59], v[156:159], a[88:91], v[56:59]
ds_read_b64_tr_b16 v[188:189], v4 offset:24576
v_mfma_f32_16x16x32_bf16 v[72:75], v[156:159], a[92:95], v[72:75]
ds_read_b64_tr_b16 v[190:191], v4 offset:28672
s_add_u32 s101, s101, 0x2000
v_mfma_f32_16x16x32_bf16 v[72:75], v[152:155], a[84:87], v[72:75]
buffer_load_dwordx4 a[112:115], v3, s[88:91], s101 offen sc1
v_mfma_f32_16x16x32_bf16 v[76:79], v[160:163], a[84:87], v[76:79]
ds_read_b64_tr_b16 v[192:193], v5 offset:16384
ds_read_b64_tr_b16 v[194:195], v5 offset:20480
v_mfma_f32_16x16x32_bf16 v[76:79], v[164:167], a[92:95], v[76:79]
ds_read_b64_tr_b16 v[196:197], v5 offset:24576
v_mfma_f32_16x16x32_bf16 v[60:63], v[164:167], a[88:91], v[60:63]
ds_read_b64_tr_b16 v[198:199], v5 offset:28672
s_waitcnt lgkmcnt(8)
v_mfma_f32_16x16x32_bf16 v[60:63], v[160:163], a[80:83], v[60:63]
buffer_load_dwordx4 a[116:119], v3, s[88:91], s101 offen offset:1024 sc1
v_mfma_f32_16x16x32_bf16 v[64:67], v[168:171], a[80:83], v[64:67]
ds_read_b64_tr_b16 v[200:201], v4 offset:16640
ds_read_b64_tr_b16 v[202:203], v4 offset:20736
v_mfma_f32_16x16x32_bf16 v[64:67], v[172:175], a[88:91], v[64:67]
ds_read_b64_tr_b16 v[204:205], v4 offset:24832
v_mfma_f32_16x16x32_bf16 v[80:83], v[172:175], a[92:95], v[80:83]
ds_read_b64_tr_b16 v[206:207], v4 offset:28928
s_add_u32 s101, s101, 0x2000
v_mfma_f32_16x16x32_bf16 v[80:83], v[168:171], a[84:87], v[80:83]
buffer_load_dwordx4 a[120:123], v3, s[88:91], s101 offen sc1
v_mfma_f32_16x16x32_bf16 v[84:87], v[176:179], a[84:87], v[84:87]
ds_read_b64_tr_b16 v[208:209], v5 offset:16640
ds_read_b64_tr_b16 v[210:211], v5 offset:20736
v_mfma_f32_16x16x32_bf16 v[84:87], v[180:183], a[92:95], v[84:87]
ds_read_b64_tr_b16 v[212:213], v5 offset:24832
s_waitcnt vmcnt(7) lgkmcnt(7)
v_mfma_f32_16x16x32_bf16 v[68:71], v[180:183], a[88:91], v[68:71]
ds_read_b64_tr_b16 v[214:215], v5 offset:28928
s_barrier
v_mfma_f32_16x16x32_bf16 v[68:71], v[176:179], a[80:83], v[68:71]
buffer_load_dwordx4 a[124:127], v3, s[88:91], s101 offen offset:1024 sc1
L_p4_skip:
v_mfma_f32_16x16x32_bf16 v[24:27], v[184:187], a[80:83], v[24:27]
ds_read_b64_tr_b16 v[152:153], v6 offset:512
ds_read_b64_tr_b16 v[154:155], v6 offset:4608
v_mfma_f32_16x16x32_bf16 v[24:27], v[188:191], a[88:91], v[24:27]
ds_read_b64_tr_b16 v[156:157], v6 offset:8704
v_add_u32 v12, 0x20000, v12
v_mfma_f32_16x16x32_bf16 v[40:43], v[188:191], a[92:95], v[40:43]
ds_read_b64_tr_b16 v[158:159], v6 offset:12800
s_add_u32 m0, s17, 0x10000
v_mfma_f32_16x16x32_bf16 v[40:43], v[184:187], a[84:87], v[40:43]
buffer_load_dwordx4 v12, s[72:75], 0 offen lds
v_mfma_f32_16x16x32_bf16 v[44:47], v[192:195], a[84:87], v[44:47]
ds_read_b64_tr_b16 v[160:161], v7 offset:512
ds_read_b64_tr_b16 v[162:163], v7 offset:4608
v_mfma_f32_16x16x32_bf16 v[44:47], v[196:199], a[92:95], v[44:47]
ds_read_b64_tr_b16 v[164:165], v7 offset:8704
v_add_u32 v13, 0x20000, v13
v_mfma_f32_16x16x32_bf16 v[28:31], v[196:199], a[88:91], v[28:31]
ds_read_b64_tr_b16 v[166:167], v7 offset:12800
s_waitcnt lgkmcnt(8)
v_mfma_f32_16x16x32_bf16 v[28:31], v[192:195], a[80:83], v[28:31]
buffer_load_dwordx4 v13, s[72:75], 0 offen offset:1024 lds
v_mfma_f32_16x16x32_bf16 v[32:35], v[200:203], a[80:83], v[32:35]
ds_read_b64_tr_b16 v[168:169], v6 offset:768
ds_read_b64_tr_b16 v[170:171], v6 offset:4864
v_mfma_f32_16x16x32_bf16 v[32:35], v[204:207], a[88:91], v[32:35]
ds_read_b64_tr_b16 v[172:173], v6 offset:8960
v_mfma_f32_16x16x32_bf16 v[48:51], v[204:207], a[92:95], v[48:51]
ds_read_b64_tr_b16 v[174:175], v6 offset:13056
v_mfma_f32_16x16x32_bf16 v[48:51], v[200:203], a[84:87], v[48:51]
buffer_load_dwordx4 v12, s[72:75], s12 offen offset:2048 lds
v_mfma_f32_16x16x32_bf16 v[52:55], v[208:211], a[84:87], v[52:55]
ds_read_b64_tr_b16 v[176:177], v7 offset:768
ds_read_b64_tr_b16 v[178:179], v7 offset:4864
v_mfma_f32_16x16x32_bf16 v[52:55], v[212:215], a[92:95], v[52:55]
ds_read_b64_tr_b16 v[180:181], v7 offset:8960
s_waitcnt lgkmcnt(7)
v_mfma_f32_16x16x32_bf16 v[36:39], v[212:215], a[88:91], v[36:39]
ds_read_b64_tr_b16 v[182:183], v7 offset:13056
v_mfma_f32_16x16x32_bf16 v[36:39], v[208:211], a[80:83], v[36:39]
buffer_load_dwordx4 v13, s[72:75], s12 offen offset:3072 lds
v_mfma_f32_16x16x32_bf16 v[56:59], v[152:155], a[96:99], v[56:59]
ds_read_b64_tr_b16 v[184:185], v6 offset:0
ds_read_b64_tr_b16 v[186:187], v6 offset:4096
v_mfma_f32_16x16x32_bf16 v[56:59], v[156:159], a[104:107], v[56:59]
ds_read_b64_tr_b16 v[188:189], v6 offset:8192
v_mov_b32 v112, 0
v_mfma_f32_16x16x32_bf16 v[72:75], v[156:159], a[108:111], v[72:75]
ds_read_b64_tr_b16 v[190:191], v6 offset:12288
s_add_u32 s101, s101, 0x2000
v_mfma_f32_16x16x32_bf16 v[72:75], v[152:155], a[100:103], v[72:75]
buffer_load_dwordx4 a[64:67], v3, s[88:91], s101 offen sc1
v_mfma_f32_16x16x32_bf16 v[76:79], v[160:163], a[100:103], v[76:79]
ds_read_b64_tr_b16 v[192:193], v7 offset:0
ds_read_b64_tr_b16 v[194:195], v7 offset:4096
v_mfma_f32_16x16x32_bf16 v[76:79], v[164:167], a[108:111], v[76:79]
ds_read_b64_tr_b16 v[196:197], v7 offset:8192
v_mov_b32 v113, 0
v_mfma_f32_16x16x32_bf16 v[60:63], v[164:167], a[104:107], v[60:63]
ds_read_b64_tr_b16 v[198:199], v7 offset:12288
s_waitcnt lgkmcnt(8)
v_mfma_f32_16x16x32_bf16 v[60:63], v[160:163], a[96:99], v[60:63]
buffer_load_dwordx4 a[68:71], v3, s[88:91], s101 offen offset:1024 sc1
v_mfma_f32_16x16x32_bf16 v[64:67], v[168:171], a[96:99], v[64:67]
ds_read_b64_tr_b16 v[200:201], v6 offset:256
ds_read_b64_tr_b16 v[202:203], v6 offset:4352
v_mfma_f32_16x16x32_bf16 v[64:67], v[172:175], a[104:107], v[64:67]
ds_read_b64_tr_b16 v[204:205], v6 offset:8448
v_mov_b32 v114, 0
v_mfma_f32_16x16x32_bf16 v[80:83], v[172:175], a[108:111], v[80:83]
ds_read_b64_tr_b16 v[206:207], v6 offset:12544
s_add_u32 s101, s101, 0x2000
v_mfma_f32_16x16x32_bf16 v[80:83], v[168:171], a[100:103], v[80:83]
buffer_load_dwordx4 a[72:75], v3, s[88:91], s101 offen sc1
v_mfma_f32_16x16x32_bf16 v[84:87], v[176:179], a[100:103], v[84:87]
ds_read_b64_tr_b16 v[208:209], v7 offset:256
ds_read_b64_tr_b16 v[210:211], v7 offset:4352
v_mfma_f32_16x16x32_bf16 v[84:87], v[180:183], a[108:111], v[84:87]
ds_read_b64_tr_b16 v[212:213], v7 offset:8448
s_waitcnt vmcnt(7) lgkmcnt(7)
v_mfma_f32_16x16x32_bf16 v[68:71], v[180:183], a[104:107], v[68:71]
ds_read_b64_tr_b16 v[214:215], v7 offset:12544
s_barrier
v_mfma_f32_16x16x32_bf16 v[68:71], v[176:179], a[96:99], v[68:71]
buffer_load_dwordx4 a[76:79], v3, s[88:91], s101 offen offset:1024 sc1
v_mov_b32 v115, 0
buffer_load_dword v14, v16, s[88:91], s24 offen sc1
v_mfma_f32_16x16x32_bf16 v[24:27], v[184:187], a[96:99], v[24:27]
ds_read_b64_tr_b16 v[152:153], v6 offset:16896
ds_read_b64_tr_b16 v[154:155], v6 offset:20992
v_mfma_f32_16x16x32_bf16 v[24:27], v[188:191], a[104:107], v[24:27]
ds_read_b64_tr_b16 v[156:157], v6 offset:25088
v_add_u32 v12, 0x20000, v12
v_mfma_f32_16x16x32_bf16 v[40:43], v[188:191], a[108:111], v[40:43]
ds_read_b64_tr_b16 v[158:159], v6 offset:29184
s_add_u32 m0, s17, 0x14000
v_mfma_f32_16x16x32_bf16 v[40:43], v[184:187], a[100:103], v[40:43]
buffer_load_dwordx4 v12, s[72:75], 0 offen lds
v_mfma_f32_16x16x32_bf16 v[44:47], v[192:195], a[100:103], v[44:47]
ds_read_b64_tr_b16 v[160:161], v7 offset:16896
ds_read_b64_tr_b16 v[162:163], v7 offset:20992
v_mfma_f32_16x16x32_bf16 v[44:47], v[196:199], a[108:111], v[44:47]
ds_read_b64_tr_b16 v[164:165], v7 offset:25088
v_add_u32 v13, 0x20000, v13
v_mfma_f32_16x16x32_bf16 v[28:31], v[196:199], a[104:107], v[28:31]
ds_read_b64_tr_b16 v[166:167], v7 offset:29184
s_waitcnt lgkmcnt(8)
v_mfma_f32_16x16x32_bf16 v[28:31], v[192:195], a[96:99], v[28:31]
buffer_load_dwordx4 v13, s[72:75], 0 offen offset:1024 lds
v_mfma_f32_16x16x32_bf16 v[32:35], v[200:203], a[96:99], v[32:35]
ds_read_b64_tr_b16 v[168:169], v6 offset:17152
ds_read_b64_tr_b16 v[170:171], v6 offset:21248
v_mfma_f32_16x16x32_bf16 v[32:35], v[204:207], a[104:107], v[32:35]
ds_read_b64_tr_b16 v[172:173], v6 offset:25344
v_mfma_f32_16x16x32_bf16 v[48:51], v[204:207], a[108:111], v[48:51]
ds_read_b64_tr_b16 v[174:175], v6 offset:29440
v_mfma_f32_16x16x32_bf16 v[48:51], v[200:203], a[100:103], v[48:51]
buffer_load_dwordx4 v12, s[72:75], s12 offen offset:2048 lds
v_mfma_f32_16x16x32_bf16 v[52:55], v[208:211], a[100:103], v[52:55]
ds_read_b64_tr_b16 v[176:177], v7 offset:17152
ds_read_b64_tr_b16 v[178:179], v7 offset:21248
v_mfma_f32_16x16x32_bf16 v[52:55], v[212:215], a[108:111], v[52:55]
ds_read_b64_tr_b16 v[180:181], v7 offset:25344
s_waitcnt lgkmcnt(7)
v_mfma_f32_16x16x32_bf16 v[36:39], v[212:215], a[104:107], v[36:39]
ds_read_b64_tr_b16 v[182:183], v7 offset:29440
v_mfma_f32_16x16x32_bf16 v[36:39], v[208:211], a[96:99], v[36:39]
buffer_load_dwordx4 v13, s[72:75], s12 offen offset:3072 lds
v_mfma_f32_16x16x32_bf16 v[56:59], v[152:155], a[112:115], v[56:59]
ds_read_b64_tr_b16 v[184:185], v6 offset:16384
ds_read_b64_tr_b16 v[186:187], v6 offset:20480
v_mfma_f32_16x16x32_bf16 v[56:59], v[156:159], a[120:123], v[56:59]
ds_read_b64_tr_b16 v[188:189], v6 offset:24576
v_mov_b32 v116, 0
v_mfma_f32_16x16x32_bf16 v[72:75], v[156:159], a[124:127], v[72:75]
ds_read_b64_tr_b16 v[190:191], v6 offset:28672
s_add_u32 s101, s101, 0x2000
v_mfma_f32_16x16x32_bf16 v[72:75], v[152:155], a[116:119], v[72:75]
buffer_load_dwordx4 a[80:83], v3, s[88:91], s101 offen sc1
v_mfma_f32_16x16x32_bf16 v[76:79], v[160:163], a[116:119], v[76:79]
ds_read_b64_tr_b16 v[192:193], v7 offset:16384
ds_read_b64_tr_b16 v[194:195], v7 offset:20480
v_mfma_f32_16x16x32_bf16 v[76:79], v[164:167], a[124:127], v[76:79]
ds_read_b64_tr_b16 v[196:197], v7 offset:24576
v_mov_b32 v117, 0
v_mfma_f32_16x16x32_bf16 v[60:63], v[164:167], a[120:123], v[60:63]
ds_read_b64_tr_b16 v[198:199], v7 offset:28672
s_waitcnt lgkmcnt(8)
v_mfma_f32_16x16x32_bf16 v[60:63], v[160:163], a[112:115], v[60:63]
buffer_load_dwordx4 a[84:87], v3, s[88:91], s101 offen offset:1024 sc1
v_mfma_f32_16x16x32_bf16 v[64:67], v[168:171], a[112:115], v[64:67]
ds_read_b64_tr_b16 v[200:201], v6 offset:16640
ds_read_b64_tr_b16 v[202:203], v6 offset:20736
v_mfma_f32_16x16x32_bf16 v[64:67], v[172:175], a[120:123], v[64:67]
ds_read_b64_tr_b16 v[204:205], v6 offset:24832
v_mov_b32 v118, 0
v_mfma_f32_16x16x32_bf16 v[80:83], v[172:175], a[124:127], v[80:83]
ds_read_b64_tr_b16 v[206:207], v6 offset:28928
s_add_u32 s101, s101, 0x2000
v_mfma_f32_16x16x32_bf16 v[80:83], v[168:171], a[116:119], v[80:83]
buffer_load_dwordx4 a[88:91], v3, s[88:91], s101 offen sc1
v_mfma_f32_16x16x32_bf16 v[84:87], v[176:179], a[116:119], v[84:87]
ds_read_b64_tr_b16 v[208:209], v7 offset:16640
ds_read_b64_tr_b16 v[210:211], v7 offset:20736
v_mfma_f32_16x16x32_bf16 v[84:87], v[180:183], a[124:127], v[84:87]
ds_read_b64_tr_b16 v[212:213], v7 offset:24832
s_waitcnt vmcnt(7) lgkmcnt(7)
v_mfma_f32_16x16x32_bf16 v[68:71], v[180:183], a[120:123], v[68:71]
ds_read_b64_tr_b16 v[214:215], v7 offset:28928
s_barrier
v_mfma_f32_16x16x32_bf16 v[68:71], v[176:179], a[112:115], v[68:71]
buffer_load_dwordx4 a[92:95], v3, s[88:91], s101 offen offset:1024 sc1
v_mov_b32 v119, 0
s_mov_b32 s92, 200000
L_spin_c:
v_cmp_ne_u32 vcc, 1, v14
s_nop 4
s_cbranch_vccz L_spun_c
s_sub_u32 s92, s92, 1
s_cbranch_scc1 L_spun_c
s_sleep 6
buffer_load_dword v14, v16, s[88:91], s24 offen sc1
s_waitcnt vmcnt(0)
s_branch L_spin_c
L_spun_c:
v_mfma_f32_16x16x32_bf16 v[24:27], v[184:187], a[112:115], v[24:27]
ds_read_b64_tr_b16 v[152:153], v4 offset:512
ds_read_b64_tr_b16 v[154:155], v4 offset:4608
v_mfma_f32_16x16x32_bf16 v[24:27], v[188:191], a[120:123], v[24:27]
ds_read_b64_tr_b16 v[156:157], v4 offset:8704
v_add_u32 v12, s25, v12
v_mfma_f32_16x16x32_bf16 v[40:43], v[188:191], a[124:127], v[40:43]
ds_read_b64_tr_b16 v[158:159], v4 offset:12800
s_add_u32 m0, s16, 0x0
v_mfma_f32_16x16x32_bf16 v[40:43], v[184:187], a[116:119], v[40:43]
buffer_load_dwordx4 v12, s[64:67], s61 offen lds
v_mfma_f32_16x16x32_bf16 v[44:47], v[192:195], a[116:119], v[44:47]
ds_read_b64_tr_b16 v[160:161], v5 offset:512
ds_read_b64_tr_b16 v[162:163], v5 offset:4608
v_mfma_f32_16x16x32_bf16 v[44:47], v[196:199], a[124:127], v[44:47]
ds_read_b64_tr_b16 v[164:165], v5 offset:8704
v_add_u32 v13, s25, v13
v_mfma_f32_16x16x32_bf16 v[28:31], v[196:199], a[120:123], v[28:31]
ds_read_b64_tr_b16 v[166:167], v5 offset:12800
s_waitcnt lgkmcnt(8)
v_mfma_f32_16x16x32_bf16 v[28:31], v[192:195], a[112:115], v[28:31]
buffer_load_dwordx4 v13, s[64:67], s61 offen offset:1024 lds
v_mfma_f32_16x16x32_bf16 v[32:35], v[200:203], a[112:115], v[32:35]
ds_read_b64_tr_b16 v[168:169], v4 offset:768
ds_read_b64_tr_b16 v[170:171], v4 offset:4864
v_mfma_f32_16x16x32_bf16 v[32:35], v[204:207], a[120:123], v[32:35]
ds_read_b64_tr_b16 v[172:173], v4 offset:8960
s_add_u32 s63, s101, s26
v_mfma_f32_16x16x32_bf16 v[48:51], v[204:207], a[124:127], v[48:51]
ds_read_b64_tr_b16 v[174:175], v4 offset:13056
s_add_u32 s101, s63, s60
v_mfma_f32_16x16x32_bf16 v[48:51], v[200:203], a[116:119], v[48:51]
buffer_load_dwordx4 v12, s[64:67], s62 offen offset:2048 lds
v_mfma_f32_16x16x32_bf16 v[52:55], v[208:211], a[116:119], v[52:55]
ds_read_b64_tr_b16 v[176:177], v5 offset:768
ds_read_b64_tr_b16 v[178:179], v5 offset:4864
v_mfma_f32_16x16x32_bf16 v[52:55], v[212:215], a[124:127], v[52:55]
ds_read_b64_tr_b16 v[180:181], v5 offset:8960
s_waitcnt lgkmcnt(7)
v_mfma_f32_16x16x32_bf16 v[36:39], v[212:215], a[120:123], v[36:39]
ds_read_b64_tr_b16 v[182:183], v5 offset:13056
v_mfma_f32_16x16x32_bf16 v[36:39], v[208:211], a[112:115], v[36:39]
buffer_load_dwordx4 v13, s[64:67], s62 offen offset:3072 lds
v_mfma_f32_16x16x32_bf16 v[56:59], v[152:155], a[64:67], v[56:59]
ds_read_b64_tr_b16 v[184:185], v4 offset:0
ds_read_b64_tr_b16 v[186:187], v4 offset:4096
v_mfma_f32_16x16x32_bf16 v[56:59], v[156:159], a[72:75], v[56:59]
ds_read_b64_tr_b16 v[188:189], v4 offset:8192
s_add_u32 s60, s60, s57
v_mfma_f32_16x16x32_bf16 v[72:75], v[156:159], a[76:79], v[72:75]
ds_read_b64_tr_b16 v[190:191], v4 offset:12288
s_and_b32 s60, s60, 0x7c000
v_mfma_f32_16x16x32_bf16 v[72:75], v[152:155], a[68:71], v[72:75]
buffer_load_dwordx4 a[96:99], v3, s[88:91], s101 offen sc1
v_mfma_f32_16x16x32_bf16 v[76:79], v[160:163], a[68:71], v[76:79]
ds_read_b64_tr_b16 v[192:193], v5 offset:0
ds_read_b64_tr_b16 v[194:195], v5 offset:4096
v_mfma_f32_16x16x32_bf16 v[76:79], v[164:167], a[76:79], v[76:79]
ds_read_b64_tr_b16 v[196:197], v5 offset:8192
s_lshl_b32 s61, s60, 3
v_mfma_f32_16x16x32_bf16 v[60:63], v[164:167], a[72:75], v[60:63]
ds_read_b64_tr_b16 v[198:199], v5 offset:12288
s_waitcnt lgkmcnt(8)
v_mfma_f32_16x16x32_bf16 v[60:63], v[160:163], a[64:67], v[60:63]
buffer_load_dwordx4 a[100:103], v3, s[88:91], s101 offen offset:1024 sc1
v_mfma_f32_16x16x32_bf16 v[64:67], v[168:171], a[64:67], v[64:67]
ds_read_b64_tr_b16 v[200:201], v4 offset:256
ds_read_b64_tr_b16 v[202:203], v4 offset:4352
v_mfma_f32_16x16x32_bf16 v[64:67], v[172:175], a[72:75], v[64:67]
ds_read_b64_tr_b16 v[204:205], v4 offset:8448
s_add_u32 s62, s61, s12
v_mfma_f32_16x16x32_bf16 v[80:83], v[172:175], a[76:79], v[80:83]
ds_read_b64_tr_b16 v[206:207], v4 offset:12544
s_add_u32 s101, s101, 0x2000
v_mfma_f32_16x16x32_bf16 v[80:83], v[168:171], a[68:71], v[80:83]
buffer_load_dwordx4 a[104:107], v3, s[88:91], s101 offen sc1
v_mfma_f32_16x16x32_bf16 v[84:87], v[176:179], a[68:71], v[84:87]
ds_read_b64_tr_b16 v[208:209], v5 offset:256
ds_read_b64_tr_b16 v[210:211], v5 offset:4352
v_mfma_f32_16x16x32_bf16 v[84:87], v[180:183], a[76:79], v[84:87]
ds_read_b64_tr_b16 v[212:213], v5 offset:8448
s_waitcnt vmcnt(7) lgkmcnt(7)
v_mfma_f32_16x16x32_bf16 v[68:71], v[180:183], a[72:75], v[68:71]
ds_read_b64_tr_b16 v[214:215], v5 offset:12544
s_barrier
v_mfma_f32_16x16x32_bf16 v[68:71], v[176:179], a[64:67], v[68:71]
buffer_load_dwordx4 a[108:111], v3, s[88:91], s101 offen offset:1024 sc1
v_mfma_f32_16x16x32_bf16 v[24:27], v[184:187], a[64:67], v[24:27]
ds_read_b64_tr_b16 v[152:153], v4 offset:16896
ds_read_b64_tr_b16 v[154:155], v4 offset:20992
v_mfma_f32_16x16x32_bf16 v[24:27], v[188:191], a[72:75], v[24:27]
ds_read_b64_tr_b16 v[156:157], v4 offset:25088
s_add_u32 s101, s63, s60
v_mfma_f32_16x16x32_bf16 v[40:43], v[188:191], a[76:79], v[40:43]
ds_read_b64_tr_b16 v[158:159], v4 offset:29184
s_add_u32 m0, s16, 0x4000
v_mfma_f32_16x16x32_bf16 v[40:43], v[184:187], a[68:71], v[40:43]
buffer_load_dwordx4 v12, s[64:67], s61 offen lds
v_mfma_f32_16x16x32_bf16 v[44:47], v[192:195], a[68:71], v[44:47]
ds_read_b64_tr_b16 v[160:161], v5 offset:16896
ds_read_b64_tr_b16 v[162:163], v5 offset:20992
v_mfma_f32_16x16x32_bf16 v[44:47], v[196:199], a[76:79], v[44:47]
ds_read_b64_tr_b16 v[164:165], v5 offset:25088
v_mfma_f32_16x16x32_bf16 v[28:31], v[196:199], a[72:75], v[28:31]
ds_read_b64_tr_b16 v[166:167], v5 offset:29184
s_waitcnt lgkmcnt(8)
v_mfma_f32_16x16x32_bf16 v[28:31], v[192:195], a[64:67], v[28:31]
buffer_load_dwordx4 v13, s[64:67], s61 offen offset:1024 lds
v_mfma_f32_16x16x32_bf16 v[32:35], v[200:203], a[64:67], v[32:35]
ds_read_b64_tr_b16 v[168:169], v4 offset:17152
ds_read_b64_tr_b16 v[170:171], v4 offset:21248
v_mfma_f32_16x16x32_bf16 v[32:35], v[204:207], a[72:75], v[32:35]
ds_read_b64_tr_b16 v[172:173], v4 offset:25344
v_mfma_f32_16x16x32_bf16 v[48:51], v[204:207], a[76:79], v[48:51]
ds_read_b64_tr_b16 v[174:175], v4 offset:29440
v_mfma_f32_16x16x32_bf16 v[48:51], v[200:203], a[68:71], v[48:51]
buffer_load_dwordx4 v12, s[64:67], s62 offen offset:2048 lds
v_mfma_f32_16x16x32_bf16 v[52:55], v[208:211], a[68:71], v[52:55]
ds_read_b64_tr_b16 v[176:177], v5 offset:17152
ds_read_b64_tr_b16 v[178:179], v5 offset:21248
v_mfma_f32_16x16x32_bf16 v[52:55], v[212:215], a[76:79], v[52:55]
ds_read_b64_tr_b16 v[180:181], v5 offset:25344
s_waitcnt lgkmcnt(7)
v_mfma_f32_16x16x32_bf16 v[36:39], v[212:215], a[72:75], v[36:39]
ds_read_b64_tr_b16 v[182:183], v5 offset:29440
v_mfma_f32_16x16x32_bf16 v[36:39], v[208:211], a[64:67], v[36:39]
buffer_load_dwordx4 v13, s[64:67], s62 offen offset:3072 lds
v_mfma_f32_16x16x32_bf16 v[56:59], v[152:155], a[80:83], v[56:59]
ds_read_b64_tr_b16 v[184:185], v4 offset:16384
ds_read_b64_tr_b16 v[186:187], v4 offset:20480
v_mfma_f32_16x16x32_bf16 v[56:59], v[156:159], a[88:91], v[56:59]
ds_read_b64_tr_b16 v[188:189], v4 offset:24576
s_add_u32 s60, s60, s58
v_mfma_f32_16x16x32_bf16 v[72:75], v[156:159], a[92:95], v[72:75]
ds_read_b64_tr_b16 v[190:191], v4 offset:28672
s_and_b32 s60, s60, 0x7c000
v_mfma_f32_16x16x32_bf16 v[72:75], v[152:155], a[84:87], v[72:75]
buffer_load_dwordx4 a[112:115], v3, s[88:91], s101 offen sc1
v_mfma_f32_16x16x32_bf16 v[76:79], v[160:163], a[84:87], v[76:79]
ds_read_b64_tr_b16 v[192:193], v5 offset:16384
ds_read_b64_tr_b16 v[194:195], v5 offset:20480
v_mfma_f32_16x16x32_bf16 v[76:79], v[164:167], a[92:95], v[76:79]
ds_read_b64_tr_b16 v[196:197], v5 offset:24576
s_lshl_b32 s61, s60, 3
v_mfma_f32_16x16x32_bf16 v[60:63], v[164:167], a[88:91], v[60:63]
ds_read_b64_tr_b16 v[198:199], v5 offset:28672
s_waitcnt lgkmcnt(8)
v_mfma_f32_16x16x32_bf16 v[60:63], v[160:163], a[80:83], v[60:63]
buffer_load_dwordx4 a[116:119], v3, s[88:91], s101 offen offset:1024 sc1
v_mfma_f32_16x16x32_bf16 v[64:67], v[168:171], a[80:83], v[64:67]
ds_read_b64_tr_b16 v[200:201], v4 offset:16640
ds_read_b64_tr_b16 v[202:203], v4 offset:20736
v_mfma_f32_16x16x32_bf16 v[64:67], v[172:175], a[88:91], v[64:67]
ds_read_b64_tr_b16 v[204:205], v4 offset:24832
s_add_u32 s62, s61, s12
v_mfma_f32_16x16x32_bf16 v[80:83], v[172:175], a[92:95], v[80:83]
ds_read_b64_tr_b16 v[206:207], v4 offset:28928
s_add_u32 s101, s101, 0x2000
v_mfma_f32_16x16x32_bf16 v[80:83], v[168:171], a[84:87], v[80:83]
buffer_load_dwordx4 a[120:123], v3, s[88:91], s101 offen sc1
v_mfma_f32_16x16x32_bf16 v[84:87], v[176:179], a[84:87], v[84:87]
ds_read_b64_tr_b16 v[208:209], v5 offset:16640
ds_read_b64_tr_b16 v[210:211], v5 offset:20736
v_mfma_f32_16x16x32_bf16 v[84:87], v[180:183], a[92:95], v[84:87]
ds_read_b64_tr_b16 v[212:213], v5 offset:24832
s_waitcnt vmcnt(7) lgkmcnt(7)
v_mfma_f32_16x16x32_bf16 v[68:71], v[180:183], a[88:91], v[68:71]
ds_read_b64_tr_b16 v[214:215], v5 offset:28928
s_barrier
v_mfma_f32_16x16x32_bf16 v[68:71], v[176:179], a[80:83], v[68:71]
buffer_load_dwordx4 a[124:127], v3, s[88:91], s101 offen offset:1024 sc1
v_mfma_f32_16x16x32_bf16 v[24:27], v[184:187], a[80:83], v[24:27]
ds_read_b64_tr_b16 v[152:153], v6 offset:512
ds_read_b64_tr_b16 v[154:155], v6 offset:4608
v_mfma_f32_16x16x32_bf16 v[24:27], v[188:191], a[88:91], v[24:27]
ds_read_b64_tr_b16 v[156:157], v6 offset:8704
s_add_u32 s101, s63, s60
v_mfma_f32_16x16x32_bf16 v[40:43], v[188:191], a[92:95], v[40:43]
ds_read_b64_tr_b16 v[158:159], v6 offset:12800
s_add_u32 m0, s17, 0x10000
v_mfma_f32_16x16x32_bf16 v[40:43], v[184:187], a[84:87], v[40:43]
buffer_load_dwordx4 v12, s[64:67], s61 offen lds
v_mfma_f32_16x16x32_bf16 v[44:47], v[192:195], a[84:87], v[44:47]
ds_read_b64_tr_b16 v[160:161], v7 offset:512
ds_read_b64_tr_b16 v[162:163], v7 offset:4608
v_mfma_f32_16x16x32_bf16 v[44:47], v[196:199], a[92:95], v[44:47]
ds_read_b64_tr_b16 v[164:165], v7 offset:8704
v_mfma_f32_16x16x32_bf16 v[28:31], v[196:199], a[88:91], v[28:31]
ds_read_b64_tr_b16 v[166:167], v7 offset:12800
s_waitcnt lgkmcnt(8)
v_mfma_f32_16x16x32_bf16 v[28:31], v[192:195], a[80:83], v[28:31]
buffer_load_dwordx4 v13, s[64:67], s61 offen offset:1024 lds
v_mfma_f32_16x16x32_bf16 v[32:35], v[200:203], a[80:83], v[32:35]
ds_read_b64_tr_b16 v[168:169], v6 offset:768
ds_read_b64_tr_b16 v[170:171], v6 offset:4864
v_mfma_f32_16x16x32_bf16 v[32:35], v[204:207], a[88:91], v[32:35]
ds_read_b64_tr_b16 v[172:173], v6 offset:8960
v_mfma_f32_16x16x32_bf16 v[48:51], v[204:207], a[92:95], v[48:51]
ds_read_b64_tr_b16 v[174:175], v6 offset:13056
v_mfma_f32_16x16x32_bf16 v[48:51], v[200:203], a[84:87], v[48:51]
buffer_load_dwordx4 v12, s[64:67], s62 offen offset:2048 lds
v_mfma_f32_16x16x32_bf16 v[52:55], v[208:211], a[84:87], v[52:55]
ds_read_b64_tr_b16 v[176:177], v7 offset:768
ds_read_b64_tr_b16 v[178:179], v7 offset:4864
v_mfma_f32_16x16x32_bf16 v[52:55], v[212:215], a[92:95], v[52:55]
ds_read_b64_tr_b16 v[180:181], v7 offset:8960
s_waitcnt lgkmcnt(7)
v_mfma_f32_16x16x32_bf16 v[36:39], v[212:215], a[88:91], v[36:39]
ds_read_b64_tr_b16 v[182:183], v7 offset:13056
v_mfma_f32_16x16x32_bf16 v[36:39], v[208:211], a[80:83], v[36:39]
buffer_load_dwordx4 v13, s[64:67], s62 offen offset:3072 lds
v_mfma_f32_16x16x32_bf16 v[120:123], v[152:155], a[96:99], 0
ds_read_b64_tr_b16 v[184:185], v6 offset:0
ds_read_b64_tr_b16 v[186:187], v6 offset:4096
v_mfma_f32_16x16x32_bf16 v[120:123], v[156:159], a[104:107], v[120:123]
ds_read_b64_tr_b16 v[188:189], v6 offset:8192
s_add_u32 s60, s60, s59
v_mfma_f32_16x16x32_bf16 v[136:139], v[156:159], a[108:111], 0
ds_read_b64_tr_b16 v[190:191], v6 offset:12288
s_and_b32 s60, s60, 0x7c000
v_mfma_f32_16x16x32_bf16 v[136:139], v[152:155], a[100:103], v[136:139]
buffer_load_dwordx4 a[64:67], v3, s[88:91], s101 offen sc1
v_mfma_f32_16x16x32_bf16 v[140:143], v[160:163], a[100:103], 0
ds_read_b64_tr_b16 v[192:193], v7 offset:0
ds_read_b64_tr_b16 v[194:195], v7 offset:4096
v_mfma_f32_16x16x32_bf16 v[140:143], v[164:167], a[108:111], v[140:143]
ds_read_b64_tr_b16 v[196:197], v7 offset:8192
s_lshl_b32 s61, s60, 3
v_mfma_f32_16x16x32_bf16 v[124:127], v[164:167], a[104:107], 0
ds_read_b64_tr_b16 v[198:199], v7 offset:12288
s_waitcnt lgkmcnt(8)
v_mfma_f32_16x16x32_bf16 v[124:127], v[160:163], a[96:99], v[124:127]
buffer_load_dwordx4 a[68:71], v3, s[88:91], s101 offen offset:1024 sc1
v_mfma_f32_16x16x32_bf16 v[128:131], v[168:171], a[96:99], 0
ds_read_b64_tr_b16 v[200:201], v6 offset:256
ds_read_b64_tr_b16 v[202:203], v6 offset:4352
v_mfma_f32_16x16x32_bf16 v[128:131], v[172:175], a[104:107], v[128:131]
ds_read_b64_tr_b16 v[204:205], v6 offset:8448
s_add_u32 s62, s61, s12
v_mfma_f32_16x16x32_bf16 v[144:147], v[172:175], a[108:111], 0
ds_read_b64_tr_b16 v[206:207], v6 offset:12544
s_add_u32 s101, s101, 0x2000
v_mfma_f32_16x16x32_bf16 v[144:147], v[168:171], a[100:103], v[144:147]
buffer_load_dwordx4 a[72:75], v3, s[88:91], s101 offen sc1
v_mfma_f32_16x16x32_bf16 v[148:151], v[176:179], a[100:103], 0
ds_read_b64_tr_b16 v[208:209], v7 offset:256
ds_read_b64_tr_b16 v[210:211], v7 offset:4352
v_mfma_f32_16x16x32_bf16 v[148:151], v[180:183], a[108:111], v[148:151]
ds_read_b64_tr_b16 v[212:213], v7 offset:8448
s_waitcnt vmcnt(7) lgkmcnt(7)
v_mfma_f32_16x16x32_bf16 v[132:135], v[180:183], a[104:107], 0
ds_read_b64_tr_b16 v[214:215], v7 offset:12544
s_barrier
v_mfma_f32_16x16x32_bf16 v[132:135], v[176:179], a[96:99], v[132:135]
buffer_load_dwordx4 a[76:79], v3, s[88:91], s101 offen offset:1024 sc1
s_mov_b32 s15, 7
L_p4_loop:
v_mfma_f32_16x16x32_bf16 v[88:91], v[184:187], a[96:99], v[88:91]
ds_read_b64_tr_b16 v[152:153], v6 offset:16896
ds_read_b64_tr_b16 v[154:155], v6 offset:20992
v_mfma_f32_16x16x32_bf16 v[88:91], v[188:191], a[104:107], v[88:91]
ds_read_b64_tr_b16 v[156:157], v6 offset:25088
s_add_u32 s101, s63, s60
v_mfma_f32_16x16x32_bf16 v[104:107], v[188:191], a[108:111], v[104:107]
ds_read_b64_tr_b16 v[158:159], v6 offset:29184
s_add_u32 m0, s17, 0x14000
v_mfma_f32_16x16x32_bf16 v[104:107], v[184:187], a[100:103], v[104:107]
buffer_load_dwordx4 v12, s[64:67], s61 offen lds
v_mfma_f32_16x16x32_bf16 v[108:111], v[192:195], a[100:103], v[108:111]
ds_read_b64_tr_b16 v[160:161], v7 offset:16896
ds_read_b64_tr_b16 v[162:163], v7 offset:20992
v_mfma_f32_16x16x32_bf16 v[108:111], v[196:199], a[108:111], v[108:111]
ds_read_b64_tr_b16 v[164:165], v7 offset:25088
v_mfma_f32_16x16x32_bf16 v[92:95], v[196:199], a[104:107], v[92:95]
ds_read_b64_tr_b16 v[166:167], v7 offset:29184
s_waitcnt lgkmcnt(8)
v_mfma_f32_16x16x32_bf16 v[92:95], v[192:195], a[96:99], v[92:95]
buffer_load_dwordx4 v13, s[64:67], s61 offen offset:1024 lds
v_mfma_f32_16x16x32_bf16 v[96:99], v[200:203], a[96:99], v[96:99]
ds_read_b64_tr_b16 v[168:169], v6 offset:17152
ds_read_b64_tr_b16 v[170:171], v6 offset:21248
v_mfma_f32_16x16x32_bf16 v[96:99], v[204:207], a[104:107], v[96:99]
ds_read_b64_tr_b16 v[172:173], v6 offset:25344
v_mfma_f32_16x16x32_bf16 v[112:115], v[204:207], a[108:111], v[112:115]
ds_read_b64_tr_b16 v[174:175], v6 offset:29440
v_mfma_f32_16x16x32_bf16 v[112:115], v[200:203], a[100:103], v[112:115]
buffer_load_dwordx4 v12, s[64:67], s62 offen offset:2048 lds
v_mfma_f32_16x16x32_bf16 v[116:119], v[208:211], a[100:103], v[116:119]
ds_read_b64_tr_b16 v[176:177], v7 offset:17152
ds_read_b64_tr_b16 v[178:179], v7 offset:21248
v_mfma_f32_16x16x32_bf16 v[116:119], v[212:215], a[108:111], v[116:119]
ds_read_b64_tr_b16 v[180:181], v7 offset:25344
s_waitcnt lgkmcnt(7)
v_mfma_f32_16x16x32_bf16 v[100:103], v[212:215], a[104:107], v[100:103]
ds_read_b64_tr_b16 v[182:183], v7 offset:29440
v_mfma_f32_16x16x32_bf16 v[100:103], v[208:211], a[96:99], v[100:103]
buffer_load_dwordx4 v13, s[64:67], s62 offen offset:3072 lds
v_mfma_f32_16x16x32_bf16 v[120:123], v[152:155], a[112:115], v[120:123]
ds_read_b64_tr_b16 v[184:185], v6 offset:16384
ds_read_b64_tr_b16 v[186:187], v6 offset:20480
v_mfma_f32_16x16x32_bf16 v[120:123], v[156:159], a[120:123], v[120:123]
ds_read_b64_tr_b16 v[188:189], v6 offset:24576
s_add_u32 s60, s60, s56
v_mfma_f32_16x16x32_bf16 v[136:139], v[156:159], a[124:127], v[136:139]
ds_read_b64_tr_b16 v[190:191], v6 offset:28672
s_and_b32 s60, s60, 0x7c000
v_mfma_f32_16x16x32_bf16 v[136:139], v[152:155], a[116:119], v[136:139]
buffer_load_dwordx4 a[80:83], v3, s[88:91], s101 offen sc1
v_mfma_f32_16x16x32_bf16 v[140:143], v[160:163], a[116:119], v[140:143]
ds_read_b64_tr_b16 v[192:193], v7 offset:16384
ds_read_b64_tr_b16 v[194:195], v7 offset:20480
v_mfma_f32_16x16x32_bf16 v[140:143], v[164:167], a[124:127], v[140:143]
ds_read_b64_tr_b16 v[196:197], v7 offset:24576
s_lshl_b32 s61, s60, 3
v_mfma_f32_16x16x32_bf16 v[124:127], v[164:167], a[120:123], v[124:127]
ds_read_b64_tr_b16 v[198:199], v7 offset:28672
s_waitcnt lgkmcnt(8)
v_mfma_f32_16x16x32_bf16 v[124:127], v[160:163], a[112:115], v[124:127]
buffer_load_dwordx4 a[84:87], v3, s[88:91], s101 offen offset:1024 sc1
v_mfma_f32_16x16x32_bf16 v[128:131], v[168:171], a[112:115], v[128:131]
ds_read_b64_tr_b16 v[200:201], v6 offset:16640
ds_read_b64_tr_b16 v[202:203], v6 offset:20736
v_mfma_f32_16x16x32_bf16 v[128:131], v[172:175], a[120:123], v[128:131]
ds_read_b64_tr_b16 v[204:205], v6 offset:24832
s_add_u32 s62, s61, s12
v_mfma_f32_16x16x32_bf16 v[144:147], v[172:175], a[124:127], v[144:147]
ds_read_b64_tr_b16 v[206:207], v6 offset:28928
s_add_u32 s101, s101, 0x2000
v_mfma_f32_16x16x32_bf16 v[144:147], v[168:171], a[116:119], v[144:147]
buffer_load_dwordx4 a[88:91], v3, s[88:91], s101 offen sc1
v_mfma_f32_16x16x32_bf16 v[148:151], v[176:179], a[116:119], v[148:151]
ds_read_b64_tr_b16 v[208:209], v7 offset:16640
ds_read_b64_tr_b16 v[210:211], v7 offset:20736
v_mfma_f32_16x16x32_bf16 v[148:151], v[180:183], a[124:127], v[148:151]
ds_read_b64_tr_b16 v[212:213], v7 offset:24832
s_waitcnt vmcnt(7) lgkmcnt(7)
v_mfma_f32_16x16x32_bf16 v[132:135], v[180:183], a[120:123], v[132:135]
ds_read_b64_tr_b16 v[214:215], v7 offset:28928
s_barrier
v_mfma_f32_16x16x32_bf16 v[132:135], v[176:179], a[112:115], v[132:135]
buffer_load_dwordx4 a[92:95], v3, s[88:91], s101 offen offset:1024 sc1
v_mfma_f32_16x16x32_bf16 v[88:91], v[184:187], a[112:115], v[88:91]
ds_read_b64_tr_b16 v[152:153], v4 offset:512
ds_read_b64_tr_b16 v[154:155], v4 offset:4608
v_mfma_f32_16x16x32_bf16 v[88:91], v[188:191], a[120:123], v[88:91]
ds_read_b64_tr_b16 v[156:157], v4 offset:8704
s_add_u32 s101, s63, s60
v_mfma_f32_16x16x32_bf16 v[104:107], v[188:191], a[124:127], v[104:107]
ds_read_b64_tr_b16 v[158:159], v4 offset:12800
s_add_u32 m0, s16, 0x0
v_mfma_f32_16x16x32_bf16 v[104:107], v[184:187], a[116:119], v[104:107]
buffer_load_dwordx4 v12, s[64:67], s61 offen lds
v_mfma_f32_16x16x32_bf16 v[108:111], v[192:195], a[116:119], v[108:111]
ds_read_b64_tr_b16 v[160:161], v5 offset:512
ds_read_b64_tr_b16 v[162:163], v5 offset:4608
v_mfma_f32_16x16x32_bf16 v[108:111], v[196:199], a[124:127], v[108:111]
ds_read_b64_tr_b16 v[164:165], v5 offset:8704
v_mfma_f32_16x16x32_bf16 v[92:95], v[196:199], a[120:123], v[92:95]
ds_read_b64_tr_b16 v[166:167], v5 offset:12800
s_waitcnt lgkmcnt(8)
v_mfma_f32_16x16x32_bf16 v[92:95], v[192:195], a[112:115], v[92:95]
buffer_load_dwordx4 v13, s[64:67], s61 offen offset:1024 lds
v_mfma_f32_16x16x32_bf16 v[96:99], v[200:203], a[112:115], v[96:99]
ds_read_b64_tr_b16 v[168:169], v4 offset:768
ds_read_b64_tr_b16 v[170:171], v4 offset:4864
v_mfma_f32_16x16x32_bf16 v[96:99], v[204:207], a[120:123], v[96:99]
ds_read_b64_tr_b16 v[172:173], v4 offset:8960
v_mfma_f32_16x16x32_bf16 v[112:115], v[204:207], a[124:127], v[112:115]
ds_read_b64_tr_b16 v[174:175], v4 offset:13056
v_mfma_f32_16x16x32_bf16 v[112:115], v[200:203], a[116:119], v[112:115]
buffer_load_dwordx4 v12, s[64:67], s62 offen offset:2048 lds
v_mfma_f32_16x16x32_bf16 v[116:119], v[208:211], a[116:119], v[116:119]
ds_read_b64_tr_b16 v[176:177], v5 offset:768
ds_read_b64_tr_b16 v[178:179], v5 offset:4864
v_mfma_f32_16x16x32_bf16 v[116:119], v[212:215], a[124:127], v[116:119]
ds_read_b64_tr_b16 v[180:181], v5 offset:8960
s_waitcnt lgkmcnt(7)
v_mfma_f32_16x16x32_bf16 v[100:103], v[212:215], a[120:123], v[100:103]
ds_read_b64_tr_b16 v[182:183], v5 offset:13056
v_mfma_f32_16x16x32_bf16 v[100:103], v[208:211], a[112:115], v[100:103]
buffer_load_dwordx4 v13, s[64:67], s62 offen offset:3072 lds
v_mfma_f32_16x16x32_bf16 v[120:123], v[152:155], a[64:67], v[120:123]
ds_read_b64_tr_b16 v[184:185], v4 offset:0
ds_read_b64_tr_b16 v[186:187], v4 offset:4096
v_mfma_f32_16x16x32_bf16 v[120:123], v[156:159], a[72:75], v[120:123]
ds_read_b64_tr_b16 v[188:189], v4 offset:8192
s_add_u32 s60, s60, s57
v_mfma_f32_16x16x32_bf16 v[136:139], v[156:159], a[76:79], v[136:139]
ds_read_b64_tr_b16 v[190:191], v4 offset:12288
s_and_b32 s60, s60, 0x7c000
v_mfma_f32_16x16x32_bf16 v[136:139], v[152:155], a[68:71], v[136:139]
buffer_load_dwordx4 a[96:99], v3, s[88:91], s101 offen sc1
v_mfma_f32_16x16x32_bf16 v[140:143], v[160:163], a[68:71], v[140:143]
ds_read_b64_tr_b16 v[192:193], v5 offset:0
ds_read_b64_tr_b16 v[194:195], v5 offset:4096
v_mfma_f32_16x16x32_bf16 v[140:143], v[164:167], a[76:79], v[140:143]
ds_read_b64_tr_b16 v[196:197], v5 offset:8192
s_lshl_b32 s61, s60, 3
v_mfma_f32_16x16x32_bf16 v[124:127], v[164:167], a[72:75], v[124:127]
ds_read_b64_tr_b16 v[198:199], v5 offset:12288
s_waitcnt lgkmcnt(8)
v_mfma_f32_16x16x32_bf16 v[124:127], v[160:163], a[64:67], v[124:127]
buffer_load_dwordx4 a[100:103], v3, s[88:91], s101 offen offset:1024 sc1
v_mfma_f32_16x16x32_bf16 v[128:131], v[168:171], a[64:67], v[128:131]
ds_read_b64_tr_b16 v[200:201], v4 offset:256
ds_read_b64_tr_b16 v[202:203], v4 offset:4352
v_mfma_f32_16x16x32_bf16 v[128:131], v[172:175], a[72:75], v[128:131]
ds_read_b64_tr_b16 v[204:205], v4 offset:8448
s_add_u32 s62, s61, s12
v_mfma_f32_16x16x32_bf16 v[144:147], v[172:175], a[76:79], v[144:147]
ds_read_b64_tr_b16 v[206:207], v4 offset:12544
s_add_u32 s101, s101, 0x2000
v_mfma_f32_16x16x32_bf16 v[144:147], v[168:171], a[68:71], v[144:147]
buffer_load_dwordx4 a[104:107], v3, s[88:91], s101 offen sc1
v_mfma_f32_16x16x32_bf16 v[148:151], v[176:179], a[68:71], v[148:151]
ds_read_b64_tr_b16 v[208:209], v5 offset:256
ds_read_b64_tr_b16 v[210:211], v5 offset:4352
v_mfma_f32_16x16x32_bf16 v[148:151], v[180:183], a[76:79], v[148:151]
ds_read_b64_tr_b16 v[212:213], v5 offset:8448
s_waitcnt vmcnt(7) lgkmcnt(7)
v_mfma_f32_16x16x32_bf16 v[132:135], v[180:183], a[72:75], v[132:135]
ds_read_b64_tr_b16 v[214:215], v5 offset:12544
s_barrier
v_mfma_f32_16x16x32_bf16 v[132:135], v[176:179], a[64:67], v[132:135]
buffer_load_dwordx4 a[108:111], v3, s[88:91], s101 offen offset:1024 sc1
v_mfma_f32_16x16x32_bf16 v[88:91], v[184:187], a[64:67], v[88:91]
ds_read_b64_tr_b16 v[152:153], v4 offset:16896
ds_read_b64_tr_b16 v[154:155], v4 offset:20992
v_mfma_f32_16x16x32_bf16 v[88:91], v[188:191], a[72:75], v[88:91]
ds_read_b64_tr_b16 v[156:157], v4 offset:25088
s_add_u32 s101, s63, s60
v_mfma_f32_16x16x32_bf16 v[104:107], v[188:191], a[76:79], v[104:107]
ds_read_b64_tr_b16 v[158:159], v4 offset:29184
s_add_u32 m0, s16, 0x4000
v_mfma_f32_16x16x32_bf16 v[104:107], v[184:187], a[68:71], v[104:107]
buffer_load_dwordx4 v12, s[64:67], s61 offen lds
v_mfma_f32_16x16x32_bf16 v[108:111], v[192:195], a[68:71], v[108:111]
ds_read_b64_tr_b16 v[160:161], v5 offset:16896
ds_read_b64_tr_b16 v[162:163], v5 offset:20992
v_mfma_f32_16x16x32_bf16 v[108:111], v[196:199], a[76:79], v[108:111]
ds_read_b64_tr_b16 v[164:165], v5 offset:25088
v_mfma_f32_16x16x32_bf16 v[92:95], v[196:199], a[72:75], v[92:95]
ds_read_b64_tr_b16 v[166:167], v5 offset:29184
s_waitcnt lgkmcnt(8)
v_mfma_f32_16x16x32_bf16 v[92:95], v[192:195], a[64:67], v[92:95]
buffer_load_dwordx4 v13, s[64:67], s61 offen offset:1024 lds
v_mfma_f32_16x16x32_bf16 v[96:99], v[200:203], a[64:67], v[96:99]
ds_read_b64_tr_b16 v[168:169], v4 offset:17152
ds_read_b64_tr_b16 v[170:171], v4 offset:21248
v_mfma_f32_16x16x32_bf16 v[96:99], v[204:207], a[72:75], v[96:99]
ds_read_b64_tr_b16 v[172:173], v4 offset:25344
v_mfma_f32_16x16x32_bf16 v[112:115], v[204:207], a[76:79], v[112:115]
ds_read_b64_tr_b16 v[174:175], v4 offset:29440
v_mfma_f32_16x16x32_bf16 v[112:115], v[200:203], a[68:71], v[112:115]
buffer_load_dwordx4 v12, s[64:67], s62 offen offset:2048 lds
v_mfma_f32_16x16x32_bf16 v[116:119], v[208:211], a[68:71], v[116:119]
ds_read_b64_tr_b16 v[176:177], v5 offset:17152
ds_read_b64_tr_b16 v[178:179], v5 offset:21248
v_mfma_f32_16x16x32_bf16 v[116:119], v[212:215], a[76:79], v[116:119]
ds_read_b64_tr_b16 v[180:181], v5 offset:25344
s_waitcnt lgkmcnt(7)
v_mfma_f32_16x16x32_bf16 v[100:103], v[212:215], a[72:75], v[100:103]
ds_read_b64_tr_b16 v[182:183], v5 offset:29440
v_mfma_f32_16x16x32_bf16 v[100:103], v[208:211], a[64:67], v[100:103]
buffer_load_dwordx4 v13, s[64:67], s62 offen offset:3072 lds
v_mfma_f32_16x16x32_bf16 v[120:123], v[152:155], a[80:83], v[120:123]
ds_read_b64_tr_b16 v[184:185], v4 offset:16384
ds_read_b64_tr_b16 v[186:187], v4 offset:20480
v_mfma_f32_16x16x32_bf16 v[120:123], v[156:159], a[88:91], v[120:123]
ds_read_b64_tr_b16 v[188:189], v4 offset:24576
s_add_u32 s60, s60, s58
v_mfma_f32_16x16x32_bf16 v[136:139], v[156:159], a[92:95], v[136:139]
ds_read_b64_tr_b16 v[190:191], v4 offset:28672
s_and_b32 s60, s60, 0x7c000
v_mfma_f32_16x16x32_bf16 v[136:139], v[152:155], a[84:87], v[136:139]
buffer_load_dwordx4 a[112:115], v3, s[88:91], s101 offen sc1
v_mfma_f32_16x16x32_bf16 v[140:143], v[160:163], a[84:87], v[140:143]
ds_read_b64_tr_b16 v[192:193], v5 offset:16384
ds_read_b64_tr_b16 v[194:195], v5 offset:20480
v_mfma_f32_16x16x32_bf16 v[140:143], v[164:167], a[92:95], v[140:143]
ds_read_b64_tr_b16 v[196:197], v5 offset:24576
s_lshl_b32 s61, s60, 3
v_mfma_f32_16x16x32_bf16 v[124:127], v[164:167], a[88:91], v[124:127]
ds_read_b64_tr_b16 v[198:199], v5 offset:28672
s_waitcnt lgkmcnt(8)
v_mfma_f32_16x16x32_bf16 v[124:127], v[160:163], a[80:83], v[124:127]
buffer_load_dwordx4 a[116:119], v3, s[88:91], s101 offen offset:1024 sc1
v_mfma_f32_16x16x32_bf16 v[128:131], v[168:171], a[80:83], v[128:131]
ds_read_b64_tr_b16 v[200:201], v4 offset:16640
ds_read_b64_tr_b16 v[202:203], v4 offset:20736
v_mfma_f32_16x16x32_bf16 v[128:131], v[172:175], a[88:91], v[128:131]
ds_read_b64_tr_b16 v[204:205], v4 offset:24832
s_add_u32 s62, s61, s12
v_mfma_f32_16x16x32_bf16 v[144:147], v[172:175], a[92:95], v[144:147]
ds_read_b64_tr_b16 v[206:207], v4 offset:28928
s_add_u32 s101, s101, 0x2000
v_mfma_f32_16x16x32_bf16 v[144:147], v[168:171], a[84:87], v[144:147]
buffer_load_dwordx4 a[120:123], v3, s[88:91], s101 offen sc1
v_mfma_f32_16x16x32_bf16 v[148:151], v[176:179], a[84:87], v[148:151]
ds_read_b64_tr_b16 v[208:209], v5 offset:16640
ds_read_b64_tr_b16 v[210:211], v5 offset:20736
v_mfma_f32_16x16x32_bf16 v[148:151], v[180:183], a[92:95], v[148:151]
ds_read_b64_tr_b16 v[212:213], v5 offset:24832
s_waitcnt vmcnt(7) lgkmcnt(7)
v_mfma_f32_16x16x32_bf16 v[132:135], v[180:183], a[88:91], v[132:135]
ds_read_b64_tr_b16 v[214:215], v5 offset:28928
s_barrier
v_mfma_f32_16x16x32_bf16 v[132:135], v[176:179], a[80:83], v[132:135]
buffer_load_dwordx4 a[124:127], v3, s[88:91], s101 offen offset:1024 sc1
buffer_load_dword v14, v20, s[88:91], s24 offen sc1
v_mfma_f32_16x16x32_bf16 v[88:91], v[184:187], a[80:83], v[88:91]
ds_read_b64_tr_b16 v[152:153], v6 offset:512
ds_read_b64_tr_b16 v[154:155], v6 offset:4608
v_mfma_f32_16x16x32_bf16 v[88:91], v[188:191], a[88:91], v[88:91]
ds_read_b64_tr_b16 v[156:157], v6 offset:8704
s_add_u32 s101, s63, s60
v_mfma_f32_16x16x32_bf16 v[104:107], v[188:191], a[92:95], v[104:107]
ds_read_b64_tr_b16 v[158:159], v6 offset:12800
s_add_u32 m0, s17, 0x10000
v_mfma_f32_16x16x32_bf16 v[104:107], v[184:187], a[84:87], v[104:107]
buffer_load_dwordx4 v12, s[64:67], s61 offen lds
v_mfma_f32_16x16x32_bf16 v[108:111], v[192:195], a[84:87], v[108:111]
ds_read_b64_tr_b16 v[160:161], v7 offset:512
ds_read_b64_tr_b16 v[162:163], v7 offset:4608
v_mfma_f32_16x16x32_bf16 v[108:111], v[196:199], a[92:95], v[108:111]
ds_read_b64_tr_b16 v[164:165], v7 offset:8704
s_sub_u32 s15, s15, 1
v_mfma_f32_16x16x32_bf16 v[92:95], v[196:199], a[88:91], v[92:95]
ds_read_b64_tr_b16 v[166:167], v7 offset:12800
s_waitcnt lgkmcnt(8)
v_mfma_f32_16x16x32_bf16 v[92:95], v[192:195], a[80:83], v[92:95]
buffer_load_dwordx4 v13, s[64:67], s61 offen offset:1024 lds
v_mfma_f32_16x16x32_bf16 v[96:99], v[200:203], a[80:83], v[96:99]
ds_read_b64_tr_b16 v[168:169], v6 offset:768
ds_read_b64_tr_b16 v[170:171], v6 offset:4864
v_mfma_f32_16x16x32_bf16 v[96:99], v[204:207], a[88:91], v[96:99]
ds_read_b64_tr_b16 v[172:173], v6 offset:8960
v_mfma_f32_16x16x32_bf16 v[112:115], v[204:207], a[92:95], v[112:115]
ds_read_b64_tr_b16 v[174:175], v6 offset:13056
v_mfma_f32_16x16x32_bf16 v[112:115], v[200:203], a[84:87], v[112:115]
buffer_load_dwordx4 v12, s[64:67], s62 offen offset:2048 lds
v_mfma_f32_16x16x32_bf16 v[116:119], v[208:211], a[84:87], v[116:119]
ds_read_b64_tr_b16 v[176:177], v7 offset:768
ds_read_b64_tr_b16 v[178:179], v7 offset:4864
v_mfma_f32_16x16x32_bf16 v[116:119], v[212:215], a[92:95], v[116:119]
ds_read_b64_tr_b16 v[180:181], v7 offset:8960
s_waitcnt lgkmcnt(7)
v_mfma_f32_16x16x32_bf16 v[100:103], v[212:215], a[88:91], v[100:103]
ds_read_b64_tr_b16 v[182:183], v7 offset:13056
v_mfma_f32_16x16x32_bf16 v[100:103], v[208:211], a[80:83], v[100:103]
buffer_load_dwordx4 v13, s[64:67], s62 offen offset:3072 lds
v_mfma_f32_16x16x32_bf16 v[120:123], v[152:155], a[96:99], v[120:123]
ds_read_b64_tr_b16 v[184:185], v6 offset:0
ds_read_b64_tr_b16 v[186:187], v6 offset:4096
v_mfma_f32_16x16x32_bf16 v[120:123], v[156:159], a[104:107], v[120:123]
ds_read_b64_tr_b16 v[188:189], v6 offset:8192
s_add_u32 s60, s60, s59
v_mfma_f32_16x16x32_bf16 v[136:139], v[156:159], a[108:111], v[136:139]
ds_read_b64_tr_b16 v[190:191], v6 offset:12288
s_and_b32 s60, s60, 0x7c000
v_mfma_f32_16x16x32_bf16 v[136:139], v[152:155], a[100:103], v[136:139]
buffer_load_dwordx4 a[64:67], v3, s[88:91], s101 offen sc1
v_mfma_f32_16x16x32_bf16 v[140:143], v[160:163], a[100:103], v[140:143]
ds_read_b64_tr_b16 v[192:193], v7 offset:0
ds_read_b64_tr_b16 v[194:195], v7 offset:4096
v_mfma_f32_16x16x32_bf16 v[140:143], v[164:167], a[108:111], v[140:143]
ds_read_b64_tr_b16 v[196:197], v7 offset:8192
s_lshl_b32 s61, s60, 3
v_mfma_f32_16x16x32_bf16 v[124:127], v[164:167], a[104:107], v[124:127]
ds_read_b64_tr_b16 v[198:199], v7 offset:12288
s_waitcnt lgkmcnt(8)
v_mfma_f32_16x16x32_bf16 v[124:127], v[160:163], a[96:99], v[124:127]
buffer_load_dwordx4 a[68:71], v3, s[88:91], s101 offen offset:1024 sc1
v_mfma_f32_16x16x32_bf16 v[128:131], v[168:171], a[96:99], v[128:131]
ds_read_b64_tr_b16 v[200:201], v6 offset:256
ds_read_b64_tr_b16 v[202:203], v6 offset:4352
v_mfma_f32_16x16x32_bf16 v[128:131], v[172:175], a[104:107], v[128:131]
ds_read_b64_tr_b16 v[204:205], v6 offset:8448
s_add_u32 s62, s61, s12
v_mfma_f32_16x16x32_bf16 v[144:147], v[172:175], a[108:111], v[144:147]
ds_read_b64_tr_b16 v[206:207], v6 offset:12544
s_add_u32 s101, s101, 0x2000
v_mfma_f32_16x16x32_bf16 v[144:147], v[168:171], a[100:103], v[144:147]
buffer_load_dwordx4 a[72:75], v3, s[88:91], s101 offen sc1
v_mfma_f32_16x16x32_bf16 v[148:151], v[176:179], a[100:103], v[148:151]
ds_read_b64_tr_b16 v[208:209], v7 offset:256
ds_read_b64_tr_b16 v[210:211], v7 offset:4352
v_mfma_f32_16x16x32_bf16 v[148:151], v[180:183], a[108:111], v[148:151]
ds_read_b64_tr_b16 v[212:213], v7 offset:8448
s_waitcnt vmcnt(7) lgkmcnt(7)
v_mfma_f32_16x16x32_bf16 v[132:135], v[180:183], a[104:107], v[132:135]
ds_read_b64_tr_b16 v[214:215], v7 offset:12544
s_barrier
v_mfma_f32_16x16x32_bf16 v[132:135], v[176:179], a[96:99], v[132:135]
buffer_load_dwordx4 a[76:79], v3, s[88:91], s101 offen offset:1024 sc1
v_cmp_ne_u32 vcc, 1, v14
s_cmp_lg_u32 s15, 0
s_cbranch_scc0 L_p4_exit
s_cbranch_vccz L_p4_loop
s_mov_b32 s92, 200000
L_spin_d:
v_cmp_ne_u32 vcc, 1, v14
s_nop 4
s_cbranch_vccz L_spun_d
s_sub_u32 s92, s92, 1
s_cbranch_scc1 L_spun_d
s_sleep 6
buffer_load_dword v14, v20, s[88:91], s24 offen sc1
s_waitcnt vmcnt(0)
s_branch L_spin_d
L_spun_d:
s_branch L_p4_loop
L_p4_exit:
s_add_u32 s101, s63, s60
v_mfma_f32_16x16x32_bf16 v[88:91], v[184:187], a[96:99], v[88:91]
ds_read_b64_tr_b16 v[152:153], v6 offset:16896
ds_read_b64_tr_b16 v[154:155], v6 offset:20992
s_add_u32 m0, s17, 0x14000
v_mfma_f32_16x16x32_bf16 v[88:91], v[188:191], a[104:107], v[88:91]
buffer_load_dwordx4 v12, s[64:67], s61 offen lds
v_mfma_f32_16x16x32_bf16 v[104:107], v[188:191], a[108:111], v[104:107]
ds_read_b64_tr_b16 v[156:157], v6 offset:25088
ds_read_b64_tr_b16 v[158:159], v6 offset:29184
v_mfma_f32_16x16x32_bf16 v[104:107], v[184:187], a[100:103], v[104:107]
buffer_load_dwordx4 v13, s[64:67], s61 offen offset:1024 lds
v_mfma_f32_16x16x32_bf16 v[108:111], v[192:195], a[100:103], v[108:111]
ds_read_b64_tr_b16 v[160:161], v7 offset:16896
ds_read_b64_tr_b16 v[162:163], v7 offset:20992
v_mfma_f32_16x16x32_bf16 v[108:111], v[196:199], a[108:111], v[108:111]
buffer_load_dwordx4 v12, s[64:67], s62 offen offset:2048 lds
v_mfma_f32_16x16x32_bf16 v[92:95], v[196:199], a[104:107], v[92:95]
ds_read_b64_tr_b16 v[164:165], v7 offset:25088
ds_read_b64_tr_b16 v[166:167], v7 offset:29184
s_waitcnt lgkmcnt(8)
v_mfma_f32_16x16x32_bf16 v[92:95], v[192:195], a[96:99], v[92:95]
buffer_load_dwordx4 v13, s[64:67], s62 offen offset:3072 lds
v_mfma_f32_16x16x32_bf16 v[96:99], v[200:203], a[96:99], v[96:99]
ds_read_b64_tr_b16 v[168:169], v6 offset:17152
ds_read_b64_tr_b16 v[170:171], v6 offset:21248
v_mfma_f32_16x16x32_bf16 v[96:99], v[204:207], a[104:107], v[96:99]
buffer_load_dwordx4 a[80:83], v3, s[88:91], s101 offen sc1
v_mfma_f32_16x16x32_bf16 v[112:115], v[204:207], a[108:111], v[112:115]
ds_read_b64_tr_b16 v[172:173], v6 offset:25344
ds_read_b64_tr_b16 v[174:175], v6 offset:29440
v_mfma_f32_16x16x32_bf16 v[112:115], v[200:203], a[100:103], v[112:115]
buffer_load_dwordx4 a[84:87], v3, s[88:91], s101 offen offset:1024 sc1
v_mfma_f32_16x16x32_bf16 v[116:119], v[208:211], a[100:103], v[116:119]
ds_read_b64_tr_b16 v[176:177], v7 offset:17152
ds_read_b64_tr_b16 v[178:179], v7 offset:21248
s_add_u32 s101, s101, 0x2000
v_mfma_f32_16x16x32_bf16 v[116:119], v[212:215], a[108:111], v[116:119]
buffer_load_dwordx4 a[88:91], v3, s[88:91], s101 offen sc1
s_waitcnt vmcnt(7) lgkmcnt(6)
v_mfma_f32_16x16x32_bf16 v[100:103], v[212:215], a[104:107], v[100:103]
ds_read_b64_tr_b16 v[180:181], v7 offset:25344
ds_read_b64_tr_b16 v[182:183], v7 offset:29440
s_barrier
v_mfma_f32_16x16x32_bf16 v[100:103], v[208:211], a[96:99], v[100:103]
buffer_load_dwordx4 a[92:95], v3, s[88:91], s101 offen offset:1024 sc1
v_mfma_f32_16x16x32_bf16 v[120:123], v[152:155], a[112:115], v[120:123]
ds_read_b64_tr_b16 v[184:185], v4 offset:512
v_sub_f32 v10, 1.0, v8
v_mfma_f32_16x16x32_bf16 v[120:123], v[156:159], a[120:123], v[120:123]
ds_read_b64_tr_b16 v[186:187], v4 offset:4608
v_sub_f32 v11, 1.0, v9
v_mfma_f32_16x16x32_bf16 v[136:139], v[156:159], a[124:127], v[136:139]
ds_read_b64_tr_b16 v[188:189], v4 offset:8704
v_mul_f32 v56, v10, v56
v_mfma_f32_16x16x32_bf16 v[136:139], v[152:155], a[116:119], v[136:139]
ds_read_b64_tr_b16 v[190:191], v4 offset:12800
v_mul_f32 v57, v10, v57
v_mfma_f32_16x16x32_bf16 v[140:143], v[160:163], a[116:119], v[140:143]
ds_read_b64_tr_b16 v[192:193], v5 offset:512
v_mul_f32 v58, v10, v58
v_mfma_f32_16x16x32_bf16 v[140:143], v[164:167], a[124:127], v[140:143]
ds_read_b64_tr_b16 v[194:195], v5 offset:4608
v_mul_f32 v59, v10, v59
v_mfma_f32_16x16x32_bf16 v[124:127], v[164:167], a[120:123], v[124:127]
ds_read_b64_tr_b16 v[196:197], v5 offset:8704
s_waitcnt lgkmcnt(7)
v_mfma_f32_16x16x32_bf16 v[124:127], v[160:163], a[112:115], v[124:127]
ds_read_b64_tr_b16 v[198:199], v5 offset:12800
v_mul_f32 v60, v10, v60
v_mfma_f32_16x16x32_bf16 v[128:131], v[168:171], a[112:115], v[128:131]
ds_read_b64_tr_b16 v[200:201], v4 offset:768
v_mul_f32 v61, v10, v61
v_mfma_f32_16x16x32_bf16 v[128:131], v[172:175], a[120:123], v[128:131]
ds_read_b64_tr_b16 v[202:203], v4 offset:4864
v_mul_f32 v62, v10, v62
v_mfma_f32_16x16x32_bf16 v[144:147], v[172:175], a[124:127], v[144:147]
ds_read_b64_tr_b16 v[204:205], v4 offset:8960
v_mul_f32 v63, v10, v63
v_mfma_f32_16x16x32_bf16 v[144:147], v[168:171], a[116:119], v[144:147]
ds_read_b64_tr_b16 v[206:207], v4 offset:13056
v_mul_f32 v64, v10, v64
v_mfma_f32_16x16x32_bf16 v[148:151], v[176:179], a[116:119], v[148:151]
ds_read_b64_tr_b16 v[208:209], v5 offset:768
v_mul_f32 v65, v10, v65
v_mfma_f32_16x16x32_bf16 v[148:151], v[180:183], a[124:127], v[148:151]
ds_read_b64_tr_b16 v[210:211], v5 offset:4864
s_waitcnt vmcnt(0) lgkmcnt(6)
v_mfma_f32_16x16x32_bf16 v[132:135], v[180:183], a[120:123], v[132:135]
ds_read_b64_tr_b16 v[212:213], v5 offset:8960
s_barrier
v_mfma_f32_16x16x32_bf16 v[132:135], v[176:179], a[112:115], v[132:135]
ds_read_b64_tr_b16 v[214:215], v5 offset:13056
v_mul_f32 v66, v10, v66
v_mul_f32 v67, v10, v67
v_mfma_f32_16x16x32_bf16 v[120:123], v[184:187], a[64:67], v[120:123]
ds_read_b64_tr_b16 v[152:153], v4 offset:16896
v_mul_f32 v68, v10, v68
v_mfma_f32_16x16x32_bf16 v[120:123], v[188:191], a[72:75], v[120:123]
ds_read_b64_tr_b16 v[154:155], v4 offset:20992
v_mul_f32 v69, v10, v69
v_mfma_f32_16x16x32_bf16 v[136:139], v[188:191], a[76:79], v[136:139]
ds_read_b64_tr_b16 v[156:157], v4 offset:25088
v_mul_f32 v70, v10, v70
v_mfma_f32_16x16x32_bf16 v[136:139], v[184:187], a[68:71], v[136:139]
ds_read_b64_tr_b16 v[158:159], v4 offset:29184
v_mul_f32 v71, v10, v71
v_mfma_f32_16x16x32_bf16 v[140:143], v[192:195], a[68:71], v[140:143]
ds_read_b64_tr_b16 v[160:161], v5 offset:16896
v_mul_f32 v72, v11, v72
v_mfma_f32_16x16x32_bf16 v[140:143], v[196:199], a[76:79], v[140:143]
ds_read_b64_tr_b16 v[162:163], v5 offset:20992
v_mul_f32 v73, v11, v73
v_mfma_f32_16x16x32_bf16 v[124:127], v[196:199], a[72:75], v[124:127]
ds_read_b64_tr_b16 v[164:165], v5 offset:25088
s_waitcnt lgkmcnt(7)
v_mfma_f32_16x16x32_bf16 v[124:127], v[192:195], a[64:67], v[124:127]
ds_read_b64_tr_b16 v[166:167], v5 offset:29184
v_mul_f32 v74, v11, v74
v_mfma_f32_16x16x32_bf16 v[128:131], v[200:203], a[64:67], v[128:131]
ds_read_b64_tr_b16 v[168:169], v4 offset:17152
v_mul_f32 v75, v11, v75
v_mfma_f32_16x16x32_bf16 v[128:131], v[204:207], a[72:75], v[128:131]
ds_read_b64_tr_b16 v[170:171], v4 offset:21248
v_mul_f32 v76, v11, v76
v_mfma_f32_16x16x32_bf16 v[144:147], v[204:207], a[76:79], v[144:147]
ds_read_b64_tr_b16 v[172:173], v4 offset:25344
v_mul_f32 v77, v11, v77
v_mfma_f32_16x16x32_bf16 v[144:147], v[200:203], a[68:71], v[144:147]
ds_read_b64_tr_b16 v[174:175], v4 offset:29440
v_mul_f32 v78, v11, v78
v_mfma_f32_16x16x32_bf16 v[148:151], v[208:211], a[68:71], v[148:151]
ds_read_b64_tr_b16 v[176:177], v5 offset:17152
v_mul_f32 v79, v11, v79
v_mfma_f32_16x16x32_bf16 v[148:151], v[212:215], a[76:79], v[148:151]
ds_read_b64_tr_b16 v[178:179], v5 offset:21248
s_waitcnt lgkmcnt(6)
v_mfma_f32_16x16x32_bf16 v[132:135], v[212:215], a[72:75], v[132:135]
ds_read_b64_tr_b16 v[180:181], v5 offset:25344
v_mul_f32 v80, v11, v80
v_mfma_f32_16x16x32_bf16 v[132:135], v[208:211], a[64:67], v[132:135]
ds_read_b64_tr_b16 v[182:183], v5 offset:29440
v_mul_f32 v81, v11, v81
v_mfma_f32_16x16x32_bf16 v[120:123], v[152:155], a[80:83], v[120:123]
ds_read_b64_tr_b16 v[184:185], v6 offset:16384
v_mul_f32 v82, v11, v82
v_mfma_f32_16x16x32_bf16 v[120:123], v[156:159], a[88:91], v[120:123]
ds_read_b64_tr_b16 v[186:187], v6 offset:20480
v_mul_f32 v83, v11, v83
v_mfma_f32_16x16x32_bf16 v[136:139], v[156:159], a[92:95], v[136:139]
ds_read_b64_tr_b16 v[188:189], v6 offset:24576
v_mul_f32 v84, v11, v84
v_mfma_f32_16x16x32_bf16 v[136:139], v[152:155], a[84:87], v[136:139]
ds_read_b64_tr_b16 v[190:191], v6 offset:28672
v_mul_f32 v85, v11, v85
v_mfma_f32_16x16x32_bf16 v[140:143], v[160:163], a[84:87], v[140:143]
ds_read_b64_tr_b16 v[192:193], v7 offset:16384
v_mul_f32 v86, v11, v86
v_mfma_f32_16x16x32_bf16 v[140:143], v[164:167], a[92:95], v[140:143]
ds_read_b64_tr_b16 v[194:195], v7 offset:20480
v_mul_f32 v87, v11, v87
v_mfma_f32_16x16x32_bf16 v[124:127], v[164:167], a[88:91], v[124:127]
ds_read_b64_tr_b16 v[196:197], v7 offset:24576
s_waitcnt lgkmcnt(7)
v_mfma_f32_16x16x32_bf16 v[124:127], v[160:163], a[80:83], v[124:127]
ds_read_b64_tr_b16 v[198:199], v7 offset:28672
v_mul_f32 v24, v10, v24
v_mfma_f32_16x16x32_bf16 v[128:131], v[168:171], a[80:83], v[128:131]
ds_read_b64_tr_b16 v[200:201], v6 offset:16640
v_mul_f32 v25, v10, v25
v_mfma_f32_16x16x32_bf16 v[128:131], v[172:175], a[88:91], v[128:131]
ds_read_b64_tr_b16 v[202:203], v6 offset:20736
v_mul_f32 v26, v10, v26
v_mfma_f32_16x16x32_bf16 v[144:147], v[172:175], a[92:95], v[144:147]
ds_read_b64_tr_b16 v[204:205], v6 offset:24832
v_mul_f32 v27, v10, v27
v_mfma_f32_16x16x32_bf16 v[144:147], v[168:171], a[84:87], v[144:147]
ds_read_b64_tr_b16 v[206:207], v6 offset:28928
v_mul_f32 v28, v10, v28
v_mfma_f32_16x16x32_bf16 v[148:151], v[176:179], a[84:87], v[148:151]
ds_read_b64_tr_b16 v[208:209], v7 offset:16640
v_mul_f32 v29, v10, v29
v_mfma_f32_16x16x32_bf16 v[148:151], v[180:183], a[92:95], v[148:151]
ds_read_b64_tr_b16 v[210:211], v7 offset:20736
s_waitcnt lgkmcnt(6)
v_mfma_f32_16x16x32_bf16 v[132:135], v[180:183], a[88:91], v[132:135]
ds_read_b64_tr_b16 v[212:213], v7 offset:24832
v_mul_f32 v30, v10, v30
v_mfma_f32_16x16x32_bf16 v[132:135], v[176:179], a[80:83], v[132:135]
ds_read_b64_tr_b16 v[214:215], v7 offset:28928
v_mul_f32 v31, v10, v31
v_mfma_f32_16x16x32_bf16 v[88:91], v[184:187], a[112:115], v[88:91]
ds_read_b64_tr_b16 v[152:153], v4 offset:0
v_mfma_f32_16x16x32_bf16 v[88:91], v[188:191], a[120:123], v[88:91]
ds_read_b64_tr_b16 v[154:155], v4 offset:4096
v_mfma_f32_16x16x32_bf16 v[104:107], v[188:191], a[124:127], v[104:107]
ds_read_b64_tr_b16 v[156:157], v4 offset:8192
v_mfma_f32_16x16x32_bf16 v[104:107], v[184:187], a[116:119], v[104:107]
ds_read_b64_tr_b16 v[158:159], v4 offset:12288
v_fmac_f32 v56, v8, v120
v_fmac_f32 v57, v8, v121
v_fmac_f32 v58, v8, v122
v_fmac_f32 v59, v8, v123
v_mfma_f32_16x16x32_bf16 v[108:111], v[192:195], a[116:119], v[108:111]
ds_read_b64_tr_b16 v[160:161], v5 offset:0
v_fmac_f32 v60, v8, v124
v_fmac_f32 v61, v8, v125
v_fmac_f32 v62, v8, v126
v_fmac_f32 v63, v8, v127
v_mfma_f32_16x16x32_bf16 v[108:111], v[196:199], a[124:127], v[108:111]
ds_read_b64_tr_b16 v[162:163], v5 offset:4096
v_cvt_pk_bf16_f32 v56, v56, v57
v_cvt_pk_bf16_f32 v57, v58, v59
v_cvt_pk_bf16_f32 v58, v60, v61
v_cvt_pk_bf16_f32 v59, v62, v63
v_mfma_f32_16x16x32_bf16 v[92:95], v[196:199], a[120:123], v[92:95]
ds_read_b64_tr_b16 v[164:165], v5 offset:8192
s_waitcnt lgkmcnt(7)
buffer_store_dwordx4 v[56:59], v3, s[88:91], s30 offen offset:0 sc1
v_fmac_f32 v64, v8, v128
v_fmac_f32 v65, v8, v129
v_fmac_f32 v66, v8, v130
v_mfma_f32_16x16x32_bf16 v[92:95], v[192:195], a[112:115], v[92:95]
ds_read_b64_tr_b16 v[166:167], v5 offset:12288
v_fmac_f32 v67, v8, v131
v_fmac_f32 v68, v8, v132
v_fmac_f32 v69, v8, v133
v_fmac_f32 v70, v8, v134
v_mfma_f32_16x16x32_bf16 v[96:99], v[200:203], a[112:115], v[96:99]
ds_read_b64_tr_b16 v[168:169], v4 offset:256
v_fmac_f32 v71, v8, v135
v_cvt_pk_bf16_f32 v64, v64, v65
v_cvt_pk_bf16_f32 v65, v66, v67
v_cvt_pk_bf16_f32 v66, v68, v69
v_mfma_f32_16x16x32_bf16 v[96:99], v[204:207], a[120:123], v[96:99]
ds_read_b64_tr_b16 v[170:171], v4 offset:4352
v_cvt_pk_bf16_f32 v67, v70, v71
buffer_store_dwordx4 v[64:67], v3, s[88:91], s30 offen offset:1024 sc1
v_fmac_f32 v72, v9, v136
v_fmac_f32 v73, v9, v137
v_mfma_f32_16x16x32_bf16 v[112:115], v[204:207], a[124:127], v[112:115]
ds_read_b64_tr_b16 v[172:173], v4 offset:8448
v_fmac_f32 v74, v9, v138
v_fmac_f32 v75, v9, v139
v_fmac_f32 v76, v9, v140
v_fmac_f32 v77, v9, v141
v_mfma_f32_16x16x32_bf16 v[112:115], v[200:203], a[116:119], v[112:115]
ds_read_b64_tr_b16 v[174:175], v4 offset:12544
v_fmac_f32 v78, v9, v142
v_fmac_f32 v79, v9, v143
v_cvt_pk_bf16_f32 v72, v72, v73
v_cvt_pk_bf16_f32 v73, v74, v75
v_mfma_f32_16x16x32_bf16 v[116:119], v[208:211], a[116:119], v[116:119]
ds_read_b64_tr_b16 v[176:177], v5 offset:256
v_cvt_pk_bf16_f32 v74, v76, v77
v_cvt_pk_bf16_f32 v75, v78, v79
buffer_store_dwordx4 v[72:75], v3, s[88:91], s30 offen offset:2048 sc1
v_fmac_f32 v80, v9, v144
v_mfma_f32_16x16x32_bf16 v[116:119], v[212:215], a[124:127], v[116:119]
ds_read_b64_tr_b16 v[178:179], v5 offset:4352
s_waitcnt lgkmcnt(6)
v_fmac_f32 v81, v9, v145
v_fmac_f32 v82, v9, v146
v_fmac_f32 v83, v9, v147
v_fmac_f32 v84, v9, v148
v_mfma_f32_16x16x32_bf16 v[100:103], v[212:215], a[120:123], v[100:103]
ds_read_b64_tr_b16 v[180:181], v5 offset:8448
v_fmac_f32 v85, v9, v149
v_fmac_f32 v86, v9, v150
v_fmac_f32 v87, v9, v151
v_cvt_pk_bf16_f32 v80, v80, v81
v_mfma_f32_16x16x32_bf16 v[100:103], v[208:211], a[112:115], v[100:103]
ds_read_b64_tr_b16 v[182:183], v5 offset:12544
v_cvt_pk_bf16_f32 v81, v82, v83
v_cvt_pk_bf16_f32 v82, v84, v85
v_cvt_pk_bf16_f32 v83, v86, v87
buffer_store_dwordx4 v[80:83], v3, s[88:91], s30 offen offset:3072 sc1
v_mfma_f32_16x16x32_bf16 v[88:91], v[152:155], a[64:67], v[88:91]
ds_read_b64_tr_b16 v[184:185], v4 offset:16384
v_mul_f32 v32, v10, v32
v_mfma_f32_16x16x32_bf16 v[88:91], v[156:159], a[72:75], v[88:91]
ds_read_b64_tr_b16 v[186:187], v4 offset:20480
v_mul_f32 v33, v10, v33
v_mfma_f32_16x16x32_bf16 v[104:107], v[156:159], a[76:79], v[104:107]
ds_read_b64_tr_b16 v[188:189], v4 offset:24576
v_mul_f32 v34, v10, v34
v_mfma_f32_16x16x32_bf16 v[104:107], v[152:155], a[68:71], v[104:107]
ds_read_b64_tr_b16 v[190:191], v4 offset:28672
v_mul_f32 v35, v10, v35
v_mfma_f32_16x16x32_bf16 v[108:111], v[160:163], a[68:71], v[108:111]
ds_read_b64_tr_b16 v[192:193], v5 offset:16384
v_mul_f32 v36, v10, v36
v_mfma_f32_16x16x32_bf16 v[108:111], v[164:167], a[76:79], v[108:111]
ds_read_b64_tr_b16 v[194:195], v5 offset:20480
v_mul_f32 v37, v10, v37
v_mfma_f32_16x16x32_bf16 v[92:95], v[164:167], a[72:75], v[92:95]
ds_read_b64_tr_b16 v[196:197], v5 offset:24576
s_waitcnt lgkmcnt(7)
v_mfma_f32_16x16x32_bf16 v[92:95], v[160:163], a[64:67], v[92:95]
ds_read_b64_tr_b16 v[198:199], v5 offset:28672
v_mul_f32 v38, v10, v38
v_mfma_f32_16x16x32_bf16 v[96:99], v[168:171], a[64:67], v[96:99]
ds_read_b64_tr_b16 v[200:201], v4 offset:16640
v_mul_f32 v39, v10, v39
v_mfma_f32_16x16x32_bf16 v[96:99], v[172:175], a[72:75], v[96:99]
ds_read_b64_tr_b16 v[202:203], v4 offset:20736
v_mul_f32 v40, v11, v40
v_mfma_f32_16x16x32_bf16 v[112:115], v[172:175], a[76:79], v[112:115]
ds_read_b64_tr_b16 v[204:205], v4 offset:24832
v_mul_f32 v41, v11, v41
v_mfma_f32_16x16x32_bf16 v[112:115], v[168:171], a[68:71], v[112:115]
ds_read_b64_tr_b16 v[206:207], v4 offset:28928
v_mul_f32 v42, v11, v42
v_mfma_f32_16x16x32_bf16 v[116:119], v[176:179], a[68:71], v[116:119]
ds_read_b64_tr_b16 v[208:209], v5 offset:16640
v_mul_f32 v43, v11, v43
v_mfma_f32_16x16x32_bf16 v[116:119], v[180:183], a[76:79], v[116:119]
ds_read_b64_tr_b16 v[210:211], v5 offset:20736
s_waitcnt lgkmcnt(6)
v_mfma_f32_16x16x32_bf16 v[100:103], v[180:183], a[72:75], v[100:103]
ds_read_b64_tr_b16 v[212:213], v5 offset:24832
v_mul_f32 v44, v11, v44
v_mfma_f32_16x16x32_bf16 v[100:103], v[176:179], a[64:67], v[100:103]
ds_read_b64_tr_b16 v[214:215], v5 offset:28928
v_mul_f32 v45, v11, v45
v_mfma_f32_16x16x32_bf16 v[88:91], v[184:187], a[80:83], v[88:91]
v_mul_f32 v46, v11, v46
v_mul_f32 v47, v11, v47
v_mfma_f32_16x16x32_bf16 v[88:91], v[188:191], a[88:91], v[88:91]
v_mul_f32 v48, v11, v48
v_mul_f32 v49, v11, v49
v_mfma_f32_16x16x32_bf16 v[104:107], v[188:191], a[92:95], v[104:107]
v_mul_f32 v50, v11, v50
v_mul_f32 v51, v11, v51
v_mfma_f32_16x16x32_bf16 v[104:107], v[184:187], a[84:87], v[104:107]
v_mul_f32 v52, v11, v52
v_mul_f32 v53, v11, v53
v_mfma_f32_16x16x32_bf16 v[108:111], v[192:195], a[84:87], v[108:111]
v_mul_f32 v54, v11, v54
v_mul_f32 v55, v11, v55
v_mfma_f32_16x16x32_bf16 v[108:111], v[196:199], a[92:95], v[108:111]
v_mfma_f32_16x16x32_bf16 v[92:95], v[196:199], a[88:91], v[92:95]
s_waitcnt lgkmcnt(0)
v_mfma_f32_16x16x32_bf16 v[92:95], v[192:195], a[80:83], v[92:95]
v_mfma_f32_16x16x32_bf16 v[96:99], v[200:203], a[80:83], v[96:99]
v_mfma_f32_16x16x32_bf16 v[96:99], v[204:207], a[88:91], v[96:99]
v_mfma_f32_16x16x32_bf16 v[112:115], v[204:207], a[92:95], v[112:115]
v_mfma_f32_16x16x32_bf16 v[112:115], v[200:203], a[84:87], v[112:115]
v_mfma_f32_16x16x32_bf16 v[116:119], v[208:211], a[84:87], v[116:119]
v_mfma_f32_16x16x32_bf16 v[116:119], v[212:215], a[92:95], v[116:119]
v_mfma_f32_16x16x32_bf16 v[100:103], v[212:215], a[88:91], v[100:103]
v_mfma_f32_16x16x32_bf16 v[100:103], v[208:211], a[80:83], v[100:103]
buffer_load_dwordx4 v[152:155], v3, s[88:91], s28 offen offset:0 sc1
buffer_load_dwordx4 v[156:159], v3, s[88:91], s28 offen offset:1024 sc1
buffer_load_dwordx4 v[160:163], v3, s[88:91], s28 offen offset:2048 sc1
buffer_load_dwordx4 v[164:167], v3, s[88:91], s28 offen offset:3072 sc1
v_fmac_f32 v24, v8, v88
v_fmac_f32 v25, v8, v89
v_fmac_f32 v26, v8, v90
v_fmac_f32 v27, v8, v91
v_fmac_f32 v28, v8, v92
v_fmac_f32 v29, v8, v93
v_fmac_f32 v30, v8, v94
v_fmac_f32 v31, v8, v95
v_fmac_f32 v32, v8, v96
v_fmac_f32 v33, v8, v97
v_fmac_f32 v34, v8, v98
v_fmac_f32 v35, v8, v99
v_fmac_f32 v36, v8, v100
v_fmac_f32 v37, v8, v101
v_fmac_f32 v38, v8, v102
v_fmac_f32 v39, v8, v103
v_fmac_f32 v40, v9, v104
v_fmac_f32 v41, v9, v105
v_fmac_f32 v42, v9, v106
v_fmac_f32 v43, v9, v107
v_fmac_f32 v44, v9, v108
v_fmac_f32 v45, v9, v109
v_fmac_f32 v46, v9, v110
v_fmac_f32 v47, v9, v111
v_fmac_f32 v48, v9, v112
v_fmac_f32 v49, v9, v113
v_fmac_f32 v50, v9, v114
v_fmac_f32 v51, v9, v115
v_fmac_f32 v52, v9, v116
v_fmac_f32 v53, v9, v117
v_fmac_f32 v54, v9, v118
v_fmac_f32 v55, v9, v119
s_mov_b32 s92, 200000
L_spin_x:
s_waitcnt vmcnt(0)
v_max3_u32 v168, v152, v153, 0
v_max3_u32 v168, v154, v155, v168
v_max3_u32 v168, v156, v157, v168
v_max3_u32 v168, v158, v159, v168
v_max3_u32 v168, v160, v161, v168
v_max3_u32 v168, v162, v163, v168
v_max3_u32 v168, v164, v165, v168
v_max3_u32 v168, v166, v167, v168
v_cmp_eq_u32 vcc, -1, v168
s_sub_u32 s92, s92, 1
s_cbranch_scc1 L_spun_x
s_nop 3
s_cbranch_vccz L_spun_x
s_sleep 2
buffer_load_dwordx4 v[152:155], v3, s[88:91], s28 offen offset:0 sc1
buffer_load_dwordx4 v[156:159], v3, s[88:91], s28 offen offset:1024 sc1
buffer_load_dwordx4 v[160:163], v3, s[88:91], s28 offen offset:2048 sc1
buffer_load_dwordx4 v[164:167], v3, s[88:91], s28 offen offset:3072 sc1
s_branch L_spin_x
L_spun_x:
v_lshlrev_b32 v168, 16, v152
v_and_b32 v169, 0xffff0000, v152
v_pk_add_f32 v[24:25], v[24:25], v[168:169]
v_lshlrev_b32 v168, 16, v153
v_and_b32 v169, 0xffff0000, v153
v_pk_add_f32 v[26:27], v[26:27], v[168:169]
v_lshlrev_b32 v168, 16, v154
v_and_b32 v169, 0xffff0000, v154
v_pk_add_f32 v[28:29], v[28:29], v[168:169]
v_lshlrev_b32 v168, 16, v155
v_and_b32 v169, 0xffff0000, v155
v_pk_add_f32 v[30:31], v[30:31], v[168:169]
v_cvt_pk_bf16_f32 v24, v24, v25
v_cvt_pk_bf16_f32 v25, v26, v27
v_cvt_pk_bf16_f32 v26, v28, v29
v_cvt_pk_bf16_f32 v27, v30, v31
s_nop 1
v_permlane16_swap_b32 v24, v26
v_permlane16_swap_b32 v25, v27
buffer_store_dwordx4 v[24:27], v17, s[80:83], s29 offen offset:0
v_lshlrev_b32 v168, 16, v156
v_and_b32 v169, 0xffff0000, v156
v_pk_add_f32 v[32:33], v[32:33], v[168:169]
v_lshlrev_b32 v168, 16, v157
v_and_b32 v169, 0xffff0000, v157
v_pk_add_f32 v[34:35], v[34:35], v[168:169]
v_lshlrev_b32 v168, 16, v158
v_and_b32 v169, 0xffff0000, v158
v_pk_add_f32 v[36:37], v[36:37], v[168:169]
v_lshlrev_b32 v168, 16, v159
v_and_b32 v169, 0xffff0000, v159
v_pk_add_f32 v[38:39], v[38:39], v[168:169]
v_cvt_pk_bf16_f32 v32, v32, v33
v_cvt_pk_bf16_f32 v33, v34, v35
v_cvt_pk_bf16_f32 v34, v36, v37
v_cvt_pk_bf16_f32 v35, v38, v39
s_nop 1
v_permlane16_swap_b32 v32, v34
v_permlane16_swap_b32 v33, v35
buffer_store_dwordx4 v[32:35], v17, s[80:83], s29 offen offset:64
v_lshlrev_b32 v168, 16, v160
v_and_b32 v169, 0xffff0000, v160
v_pk_add_f32 v[40:41], v[40:41], v[168:169]
v_lshlrev_b32 v168, 16, v161
v_and_b32 v169, 0xffff0000, v161
v_pk_add_f32 v[42:43], v[42:43], v[168:169]
v_lshlrev_b32 v168, 16, v162
v_and_b32 v169, 0xffff0000, v162
v_pk_add_f32 v[44:45], v[44:45], v[168:169]
v_lshlrev_b32 v168, 16, v163
v_and_b32 v169, 0xffff0000, v163
v_pk_add_f32 v[46:47], v[46:47], v[168:169]
v_cvt_pk_bf16_f32 v40, v40, v41
v_cvt_pk_bf16_f32 v41, v42, v43
v_cvt_pk_bf16_f32 v42, v44, v45
v_cvt_pk_bf16_f32 v43, v46, v47
s_nop 1
v_permlane16_swap_b32 v40, v42
v_permlane16_swap_b32 v41, v43
buffer_store_dwordx4 v[40:43], v17, s[80:83], s31 offen offset:0
v_lshlrev_b32 v168, 16, v164
v_and_b32 v169, 0xffff0000, v164
v_pk_add_f32 v[48:49], v[48:49], v[168:169]
v_lshlrev_b32 v168, 16, v165
v_and_b32 v169, 0xffff0000, v165
v_pk_add_f32 v[50:51], v[50:51], v[168:169]
v_lshlrev_b32 v168, 16, v166
v_and_b32 v169, 0xffff0000, v166
v_pk_add_f32 v[52:53], v[52:53], v[168:169]
v_lshlrev_b32 v168, 16, v167
v_and_b32 v169, 0xffff0000, v167
v_pk_add_f32 v[54:55], v[54:55], v[168:169]
v_cvt_pk_bf16_f32 v48, v48, v49
v_cvt_pk_bf16_f32 v49, v50, v51
v_cvt_pk_bf16_f32 v50, v52, v53
v_cvt_pk_bf16_f32 v51, v54, v55
s_nop 1
v_permlane16_swap_b32 v48, v50
v_permlane16_swap_b32 v49, v51
buffer_store_dwordx4 v[48:51], v17, s[80:83], s31 offen offset:64
L_end:
s_endpgm
L_att_fallback:
s_waitcnt vmcnt(0)
s_mov_b32 s33, 1
s_mul_i32 s32, s5, 0x10c400
s_lshl_b32 s19, s4, 13
s_add_u32 s32, s32, s19
s_cmp_eq_u32 s4, 0
s_cselect_b32 s94, 0x200000, 0
s_add_u32 s32, s32, s94
s_sub_u32 s94, 0x8000, s94
s_add_u32 s7, s32, 0x1000
s_add_u32 s27, s19, 131072
v_and_b32 v5, 15, v0
v_lshrrev_b32 v6, 4, v0
v_lshlrev_b32 v6, 2, v6
v_sub_u32 v5, v5, v6
v_mov_b32 v9, 0xf149f2ca
s_lshr_b32 s8, s20, 11
v_add_u32 v96, s8, v5
v_mov_b32 v80, v9
s_lshr_b32 s8, s21, 11
v_add_u32 v97, s8, v5
v_mov_b32 v84, v9
s_lshr_b32 s8, s22, 11
v_add_u32 v98, s8, v5
v_mov_b32 v88, v9
s_lshr_b32 s8, s23, 11
v_add_u32 v99, s8, v5
v_mov_b32 v92, v9
s_sub_u32 s15, 16, s6
s_lshl_b32 s15, s15, 1
L_fb_loop:
s_waitcnt lgkmcnt(0)
s_barrier
s_add_u32 m0, s19, 0x0
s_nop 0
buffer_load_dwordx4 v3, s[48:51], s32 offen offset:0 sc1 lds
buffer_load_dwordx4 v3, s[48:51], s32 offen offset:1024 sc1 lds
buffer_load_dwordx4 v3, s[48:51], s32 offen offset:2048 sc1 lds
buffer_load_dwordx4 v3, s[48:51], s32 offen offset:3072 sc1 lds
s_add_u32 m0, s19, 0x1000
s_nop 0
buffer_load_dwordx4 v3, s[48:51], s7 offen offset:0 sc1 lds
buffer_load_dwordx4 v3, s[48:51], s7 offen offset:1024 sc1 lds
buffer_load_dwordx4 v3, s[48:51], s7 offen offset:2048 sc1 lds
buffer_load_dwordx4 v3, s[48:51], s7 offen offset:3072 sc1 lds
s_add_u32 s32, s32, s94
s_add_u32 s7, s7, s94
s_mov_b32 s94, 0x8000
s_waitcnt vmcnt(0)
s_barrier
ds_read_b128 a[0:3], v3 offset:8192
ds_read_b128 a[4:7], v3 offset:9216
ds_read_b128 a[8:11], v3 offset:10240
ds_read_b128 a[12:15], v3 offset:11264
ds_read_b128 a[16:19], v3 offset:12288
ds_read_b128 a[20:23], v3 offset:13312
ds_read_b128 a[24:27], v3 offset:14336
ds_read_b128 a[28:31], v3 offset:15360
s_waitcnt lgkmcnt(0)
v_mfma_f32_16x16x32_bf16 v[16:19], a[0:3], a[160:163], 0
v_mfma_f32_16x16x32_bf16 v[16:19], a[4:7], a[164:167], v[16:19]
v_mfma_f32_16x16x32_bf16 v[16:19], a[8:11], a[168:171], v[16:19]
v_mfma_f32_16x16x32_bf16 v[16:19], a[12:15], a[172:175], v[16:19]
v_mfma_f32_16x16x32_bf16 v[20:23], a[0:3], a[176:179], 0
v_mfma_f32_16x16x32_bf16 v[20:23], a[4:7], a[180:183], v[20:23]
v_mfma_f32_16x16x32_bf16 v[20:23], a[8:11], a[184:187], v[20:23]
v_mfma_f32_16x16x32_bf16 v[20:23], a[12:15], a[188:191], v[20:23]
v_mfma_f32_16x16x32_bf16 v[24:27], a[0:3], a[192:195], 0
v_mfma_f32_16x16x32_bf16 v[24:27], a[4:7], a[196:199], v[24:27]
v_mfma_f32_16x16x32_bf16 v[24:27], a[8:11], a[200:203], v[24:27]
v_mfma_f32_16x16x32_bf16 v[24:27], a[12:15], a[204:207], v[24:27]
v_mfma_f32_16x16x32_bf16 v[28:31], a[0:3], a[208:211], 0
v_mfma_f32_16x16x32_bf16 v[28:31], a[4:7], a[212:215], v[28:31]
v_mfma_f32_16x16x32_bf16 v[28:31], a[8:11], a[216:219], v[28:31]
v_mfma_f32_16x16x32_bf16 v[28:31], a[12:15], a[220:223], v[28:31]
v_mfma_f32_16x16x32_bf16 v[32:35], a[16:19], a[160:163], 0
v_mfma_f32_16x16x32_bf16 v[32:35], a[20:23], a[164:167], v[32:35]
v_mfma_f32_16x16x32_bf16 v[32:35], a[24:27], a[168:171], v[32:35]
v_mfma_f32_16x16x32_bf16 v[32:35], a[28:31], a[172:175], v[32:35]
v_mfma_f32_16x16x32_bf16 v[36:39], a[16:19], a[176:179], 0
v_mfma_f32_16x16x32_bf16 v[36:39], a[20:23], a[180:183], v[36:39]
v_mfma_f32_16x16x32_bf16 v[36:39], a[24:27], a[184:187], v[36:39]
v_mfma_f32_16x16x32_bf16 v[36:39], a[28:31], a[188:191], v[36:39]
v_mfma_f32_16x16x32_bf16 v[40:43], a[16:19], a[192:195], 0
v_mfma_f32_16x16x32_bf16 v[40:43], a[20:23], a[196:199], v[40:43]
v_mfma_f32_16x16x32_bf16 v[40:43], a[24:27], a[200:203], v[40:43]
v_mfma_f32_16x16x32_bf16 v[40:43], a[28:31], a[204:207], v[40:43]
v_mfma_f32_16x16x32_bf16 v[44:47], a[16:19], a[208:211], 0
v_mfma_f32_16x16x32_bf16 v[44:47], a[20:23], a[212:215], v[44:47]
v_mfma_f32_16x16x32_bf16 v[44:47], a[24:27], a[216:219], v[44:47]
v_mfma_f32_16x16x32_bf16 v[44:47], a[28:31], a[220:223], v[44:47]
s_nop 7
v_cmp_le_i32 s[36:37], 0, v96
v_cmp_le_i32 s[38:39], 1, v96
v_cmp_le_i32 s[40:41], 2, v96
v_cmp_le_i32 s[42:43], 3, v96
s_nop 1
v_cndmask_b32 v16, v9, v16, s[36:37]
v_cndmask_b32 v17, v9, v17, s[38:39]
v_cndmask_b32 v18, v9, v18, s[40:41]
v_cndmask_b32 v19, v9, v19, s[42:43]
v_max3_f32 v80, v80, v16, v17
v_max3_f32 v80, v80, v18, v19
v_cmp_le_i32 s[36:37], 0, v97
v_cmp_le_i32 s[38:39], 1, v97
v_cmp_le_i32 s[40:41], 2, v97
v_cmp_le_i32 s[42:43], 3, v97
s_nop 1
v_cndmask_b32 v20, v9, v20, s[36:37]
v_cndmask_b32 v21, v9, v21, s[38:39]
v_cndmask_b32 v22, v9, v22, s[40:41]
v_cndmask_b32 v23, v9, v23, s[42:43]
v_max3_f32 v84, v84, v20, v21
v_max3_f32 v84, v84, v22, v23
v_cmp_le_i32 s[36:37], 0, v98
v_cmp_le_i32 s[38:39], 1, v98
v_cmp_le_i32 s[40:41], 2, v98
v_cmp_le_i32 s[42:43], 3, v98
s_nop 1
v_cndmask_b32 v24, v9, v24, s[36:37]
v_cndmask_b32 v25, v9, v25, s[38:39]
v_cndmask_b32 v26, v9, v26, s[40:41]
v_cndmask_b32 v27, v9, v27, s[42:43]
v_max3_f32 v88, v88, v24, v25
v_max3_f32 v88, v88, v26, v27
v_cmp_le_i32 s[36:37], 0, v99
v_cmp_le_i32 s[38:39], 1, v99
v_cmp_le_i32 s[40:41], 2, v99
v_cmp_le_i32 s[42:43], 3, v99
s_nop 1
v_cndmask_b32 v28, v9, v28, s[36:37]
v_cndmask_b32 v29, v9, v29, s[38:39]
v_cndmask_b32 v30, v9, v30, s[40:41]
v_cndmask_b32 v31, v9, v31, s[42:43]
v_max3_f32 v92, v92, v28, v29
v_max3_f32 v92, v92, v30, v31
v_cmp_le_i32 s[36:37], 16, v96
v_cmp_le_i32 s[38:39], 17, v96
v_cmp_le_i32 s[40:41], 18, v96
v_cmp_le_i32 s[42:43], 19, v96
s_nop 1
v_cndmask_b32 v32, v9, v32, s[36:37]
v_cndmask_b32 v33, v9, v33, s[38:39]
v_cndmask_b32 v34, v9, v34, s[40:41]
v_cndmask_b32 v35, v9, v35, s[42:43]
v_max3_f32 v80, v80, v32, v33
v_max3_f32 v80, v80, v34, v35
v_cmp_le_i32 s[36:37], 16, v97
v_cmp_le_i32 s[38:39], 17, v97
v_cmp_le_i32 s[40:41], 18, v97
v_cmp_le_i32 s[42:43], 19, v97
s_nop 1
v_cndmask_b32 v36, v9, v36, s[36:37]
v_cndmask_b32 v37, v9, v37, s[38:39]
v_cndmask_b32 v38, v9, v38, s[40:41]
v_cndmask_b32 v39, v9, v39, s[42:43]
v_max3_f32 v84, v84, v36, v37
v_max3_f32 v84, v84, v38, v39
v_cmp_le_i32 s[36:37], 16, v98
v_cmp_le_i32 s[38:39], 17, v98
v_cmp_le_i32 s[40:41], 18, v98
v_cmp_le_i32 s[42:43], 19, v98
s_nop 1
v_cndmask_b32 v40, v9, v40, s[36:37]
v_cndmask_b32 v41, v9, v41, s[38:39]
v_cndmask_b32 v42, v9, v42, s[40:41]
v_cndmask_b32 v43, v9, v43, s[42:43]
v_max3_f32 v88, v88, v40, v41
v_max3_f32 v88, v88, v42, v43
v_cmp_le_i32 s[36:37], 16, v99
v_cmp_le_i32 s[38:39], 17, v99
v_cmp_le_i32 s[40:41], 18, v99
v_cmp_le_i32 s[42:43], 19, v99
s_nop 1
v_cndmask_b32 v44, v9, v44, s[36:37]
v_cndmask_b32 v45, v9, v45, s[38:39]
v_cndmask_b32 v46, v9, v46, s[40:41]
v_cndmask_b32 v47, v9, v47, s[42:43]
v_max3_f32 v92, v92, v44, v45
v_max3_f32 v92, v92, v46, v47
ds_read_b128 a[0:3], v3 offset:24576
ds_read_b128 a[4:7], v3 offset:25600
ds_read_b128 a[8:11], v3 offset:26624
ds_read_b128 a[12:15], v3 offset:27648
ds_read_b128 a[16:19], v3 offset:28672
ds_read_b128 a[20:23], v3 offset:29696
ds_read_b128 a[24:27], v3 offset:30720
ds_read_b128 a[28:31], v3 offset:31744
s_waitcnt lgkmcnt(0)
v_mfma_f32_16x16x32_bf16 v[16:19], a[0:3], a[160:163], 0
v_mfma_f32_16x16x32_bf16 v[16:19], a[4:7], a[164:167], v[16:19]
v_mfma_f32_16x16x32_bf16 v[16:19], a[8:11], a[168:171], v[16:19]
v_mfma_f32_16x16x32_bf16 v[16:19], a[12:15], a[172:175], v[16:19]
v_mfma_f32_16x16x32_bf16 v[20:23], a[0:3], a[176:179], 0
v_mfma_f32_16x16x32_bf16 v[20:23], a[4:7], a[180:183], v[20:23]
v_mfma_f32_16x16x32_bf16 v[20:23], a[8:11], a[184:187], v[20:23]
v_mfma_f32_16x16x32_bf16 v[20:23], a[12:15], a[188:191], v[20:23]
v_mfma_f32_16x16x32_bf16 v[24:27], a[0:3], a[192:195], 0
v_mfma_f32_16x16x32_bf16 v[24:27], a[4:7], a[196:199], v[24:27]
v_mfma_f32_16x16x32_bf16 v[24:27], a[8:11], a[200:203], v[24:27]
v_mfma_f32_16x16x32_bf16 v[24:27], a[12:15], a[204:207], v[24:27]
v_mfma_f32_16x16x32_bf16 v[28:31], a[0:3], a[208:211], 0
v_mfma_f32_16x16x32_bf16 v[28:31], a[4:7], a[212:215], v[28:31]
v_mfma_f32_16x16x32_bf16 v[28:31], a[8:11], a[216:219], v[28:31]
v_mfma_f32_16x16x32_bf16 v[28:31], a[12:15], a[220:223], v[28:31]
v_mfma_f32_16x16x32_bf16 v[32:35], a[16:19], a[160:163], 0
v_mfma_f32_16x16x32_bf16 v[32:35], a[20:23], a[164:167], v[32:35]
v_mfma_f32_16x16x32_bf16 v[32:35], a[24:27], a[168:171], v[32:35]
v_mfma_f32_16x16x32_bf16 v[32:35], a[28:31], a[172:175], v[32:35]
v_mfma_f32_16x16x32_bf16 v[36:39], a[16:19], a[176:179], 0
v_mfma_f32_16x16x32_bf16 v[36:39], a[20:23], a[180:183], v[36:39]
v_mfma_f32_16x16x32_bf16 v[36:39], a[24:27], a[184:187], v[36:39]
v_mfma_f32_16x16x32_bf16 v[36:39], a[28:31], a[188:191], v[36:39]
v_mfma_f32_16x16x32_bf16 v[40:43], a[16:19], a[192:195], 0
v_mfma_f32_16x16x32_bf16 v[40:43], a[20:23], a[196:199], v[40:43]
v_mfma_f32_16x16x32_bf16 v[40:43], a[24:27], a[200:203], v[40:43]
v_mfma_f32_16x16x32_bf16 v[40:43], a[28:31], a[204:207], v[40:43]
v_mfma_f32_16x16x32_bf16 v[44:47], a[16:19], a[208:211], 0
v_mfma_f32_16x16x32_bf16 v[44:47], a[20:23], a[212:215], v[44:47]
v_mfma_f32_16x16x32_bf16 v[44:47], a[24:27], a[216:219], v[44:47]
v_mfma_f32_16x16x32_bf16 v[44:47], a[28:31], a[220:223], v[44:47]
s_nop 7
v_cmp_le_i32 s[36:37], 32, v96
v_cmp_le_i32 s[38:39], 33, v96
v_cmp_le_i32 s[40:41], 34, v96
v_cmp_le_i32 s[42:43], 35, v96
s_nop 1
v_cndmask_b32 v16, v9, v16, s[36:37]
v_cndmask_b32 v17, v9, v17, s[38:39]
v_cndmask_b32 v18, v9, v18, s[40:41]
v_cndmask_b32 v19, v9, v19, s[42:43]
v_max3_f32 v80, v80, v16, v17
v_max3_f32 v80, v80, v18, v19
v_cmp_le_i32 s[36:37], 32, v97
v_cmp_le_i32 s[38:39], 33, v97
v_cmp_le_i32 s[40:41], 34, v97
v_cmp_le_i32 s[42:43], 35, v97
s_nop 1
v_cndmask_b32 v20, v9, v20, s[36:37]
v_cndmask_b32 v21, v9, v21, s[38:39]
v_cndmask_b32 v22, v9, v22, s[40:41]
v_cndmask_b32 v23, v9, v23, s[42:43]
v_max3_f32 v84, v84, v20, v21
v_max3_f32 v84, v84, v22, v23
v_cmp_le_i32 s[36:37], 32, v98
v_cmp_le_i32 s[38:39], 33, v98
v_cmp_le_i32 s[40:41], 34, v98
v_cmp_le_i32 s[42:43], 35, v98
s_nop 1
v_cndmask_b32 v24, v9, v24, s[36:37]
v_cndmask_b32 v25, v9, v25, s[38:39]
v_cndmask_b32 v26, v9, v26, s[40:41]
v_cndmask_b32 v27, v9, v27, s[42:43]
v_max3_f32 v88, v88, v24, v25
v_max3_f32 v88, v88, v26, v27
v_cmp_le_i32 s[36:37], 32, v99
v_cmp_le_i32 s[38:39], 33, v99
v_cmp_le_i32 s[40:41], 34, v99
v_cmp_le_i32 s[42:43], 35, v99
s_nop 1
v_cndmask_b32 v28, v9, v28, s[36:37]
v_cndmask_b32 v29, v9, v29, s[38:39]
v_cndmask_b32 v30, v9, v30, s[40:41]
v_cndmask_b32 v31, v9, v31, s[42:43]
v_max3_f32 v92, v92, v28, v29
v_max3_f32 v92, v92, v30, v31
v_cmp_le_i32 s[36:37], 48, v96
v_cmp_le_i32 s[38:39], 49, v96
v_cmp_le_i32 s[40:41], 50, v96
v_cmp_le_i32 s[42:43], 51, v96
s_nop 1
v_cndmask_b32 v32, v9, v32, s[36:37]
v_cndmask_b32 v33, v9, v33, s[38:39]
v_cndmask_b32 v34, v9, v34, s[40:41]
v_cndmask_b32 v35, v9, v35, s[42:43]
v_max3_f32 v80, v80, v32, v33
v_max3_f32 v80, v80, v34, v35
v_cmp_le_i32 s[36:37], 48, v97
v_cmp_le_i32 s[38:39], 49, v97
v_cmp_le_i32 s[40:41], 50, v97
v_cmp_le_i32 s[42:43], 51, v97
s_nop 1
v_cndmask_b32 v36, v9, v36, s[36:37]
v_cndmask_b32 v37, v9, v37, s[38:39]
v_cndmask_b32 v38, v9, v38, s[40:41]
v_cndmask_b32 v39, v9, v39, s[42:43]
v_max3_f32 v84, v84, v36, v37
v_max3_f32 v84, v84, v38, v39
v_cmp_le_i32 s[36:37], 48, v98
v_cmp_le_i32 s[38:39], 49, v98
v_cmp_le_i32 s[40:41], 50, v98
v_cmp_le_i32 s[42:43], 51, v98
s_nop 1
v_cndmask_b32 v40, v9, v40, s[36:37]
v_cndmask_b32 v41, v9, v41, s[38:39]
v_cndmask_b32 v42, v9, v42, s[40:41]
v_cndmask_b32 v43, v9, v43, s[42:43]
v_max3_f32 v88, v88, v40, v41
v_max3_f32 v88, v88, v42, v43
v_cmp_le_i32 s[36:37], 48, v99
v_cmp_le_i32 s[38:39], 49, v99
v_cmp_le_i32 s[40:41], 50, v99
v_cmp_le_i32 s[42:43], 51, v99
s_nop 1
v_cndmask_b32 v44, v9, v44, s[36:37]
v_cndmask_b32 v45, v9, v45, s[38:39]
v_cndmask_b32 v46, v9, v46, s[40:41]
v_cndmask_b32 v47, v9, v47, s[42:43]
v_max3_f32 v92, v92, v44, v45
v_max3_f32 v92, v92, v46, v47
v_subrev_u32 v96, 64, v96
v_subrev_u32 v97, 64, v97
v_subrev_u32 v98, 64, v98
v_subrev_u32 v99, 64, v99
s_sub_u32 s15, s15, 1
s_cmp_lg_u32 s15, 0
s_cbranch_scc1 L_fb_loop
v_mov_b32 v16, v80
v_mov_b32 v20, v84
v_mov_b32 v24, v88
v_mov_b32 v28, v92
v_permlane16_swap_b32 v16, v80
v_permlane16_swap_b32 v20, v84
v_permlane16_swap_b32 v24, v88
v_permlane16_swap_b32 v28, v92
v_max_f32 v80, v80, v16
v_max_f32 v84, v84, v20
v_max_f32 v88, v88, v24
v_max_f32 v92, v92, v28
v_mov_b32 v16, v80
v_mov_b32 v20, v84
v_mov_b32 v24, v88
v_mov_b32 v28, v92
v_permlane32_swap_b32 v16, v80
v_permlane32_swap_b32 v20, v84
v_permlane32_swap_b32 v24, v88
v_permlane32_swap_b32 v28, v92
v_max_f32 v80, v80, v16
v_max_f32 v84, v84, v20
v_max_f32 v88, v88, v24
v_max_f32 v92, v92, v28
s_barrier
s_mul_i32 s32, s5, 0x10c400
s_lshl_b32 s19, s4, 13
s_add_u32 s32, s32, s19
s_cmp_eq_u32 s4, 0
s_cselect_b32 s94, 0x200000, 0
s_add_u32 s32, s32, s94
s_sub_u32 s94, 0x8000, s94
s_add_u32 s7, s32, 0x1000
s_add_u32 s27, s19, 131072
s_add_u32 m0, s19, 0x0
s_nop 0
buffer_load_dwordx4 v3, s[48:51], s32 offen offset:0 sc1 lds
buffer_load_dwordx4 v3, s[48:51], s32 offen offset:1024 sc1 lds
buffer_load_dwordx4 v3, s[48:51], s32 offen offset:2048 sc1 lds
buffer_load_dwordx4 v3, s[48:51], s32 offen offset:3072 sc1 lds
s_add_u32 m0, s19, 0x1000
s_nop 0
buffer_load_dwordx4 v3, s[48:51], s7 offen offset:0 sc1 lds
buffer_load_dwordx4 v3, s[48:51], s7 offen offset:1024 sc1 lds
buffer_load_dwordx4 v3, s[48:51], s7 offen offset:2048 sc1 lds
buffer_load_dwordx4 v3, s[48:51], s7 offen offset:3072 sc1 lds
s_add_u32 s32, s32, s94
s_add_u32 s7, s7, s94
s_add_u32 m0, s19, 0x18000
s_nop 0
buffer_load_dwordx4 v3, s[48:51], s32 offen offset:0 sc1 lds
buffer_load_dwordx4 v3, s[48:51], s32 offen offset:1024 sc1 lds
buffer_load_dwordx4 v3, s[48:51], s32 offen offset:2048 sc1 lds
buffer_load_dwordx4 v3, s[48:51], s32 offen offset:3072 sc1 lds
s_add_u32 m0, s19, 0x19000
s_nop 0
buffer_load_dwordx4 v3, s[48:51], s7 offen offset:0 sc1 lds
buffer_load_dwordx4 v3, s[48:51], s7 offen offset:1024 sc1 lds
buffer_load_dwordx4 v3, s[48:51], s7 offen offset:2048 sc1 lds
buffer_load_dwordx4 v3, s[48:51], s7 offen offset:3072 sc1 lds
s_add_u32 s32, s32, 0x8000
s_add_u32 s7, s7, 0x8000
s_add_u32 m0, s19, 0x8000
s_nop 0
buffer_load_dwordx4 v3, s[48:51], s32 offen offset:0 sc1 lds
buffer_load_dwordx4 v3, s[48:51], s32 offen offset:1024 sc1 lds
buffer_load_dwordx4 v3, s[48:51], s32 offen offset:2048 sc1 lds
buffer_load_dwordx4 v3, s[48:51], s32 offen offset:3072 sc1 lds
s_add_u32 m0, s19, 0x9000
s_nop 0
buffer_load_dwordx4 v3, s[48:51], s7 offen offset:0 sc1 lds
buffer_load_dwordx4 v3, s[48:51], s7 offen offset:1024 sc1 lds
buffer_load_dwordx4 v3, s[48:51], s7 offen offset:2048 sc1 lds
buffer_load_dwordx4 v3, s[48:51], s7 offen offset:3072 sc1 lds
s_add_u32 s32, s32, 0x8000
s_add_u32 s7, s7, 0x8000
s_bfe_u32 s99, s2, 0x20001
s_lshl_b32 s99, s99, 2
s_lshr_b32 s8, s2, 6
s_add_u32 s99, s99, s8
s_bfe_u32 s100, s2, 0x30003
s_and_b32 s14, s2, 1
s_sub_u32 s24, 15, s99
s_min_u32 s18, s24, s99
s_lshl_b32 s24, s18, 1
s_add_u32 s24, s24, s14
s_lshl_b32 s24, s24, 8
s_add_u32 s24, s24, 0x3704000
s_mov_b32 s12, 14336
s_and_b32 s16, s6, 1
s_lshl_b32 s16, s16, 15
s_add_u32 s16, s16, 98304
s_add_u32 s16, s16, s17
s_lshl_b32 s13, s4, 15
s_lshl_b32 s9, s100, 8
s_add_u32 s13, s13, s9
s_mul_i32 s9, s14, 1310848
s_add_u32 s13, s13, s9
s_mul_i32 s25, s14, 3407872
s_sub_u32 s25, s25, 1179648
s_mul_i32 s101, s99, 0x142400
s_lshl_b32 s8, s4, 11
s_add_u32 s101, s101, s8
s_mul_i32 s8, s14, 163840
s_add_u32 s101, s101, s8
s_add_u32 s101, s101, 0x21fe000
s_mul_i32 s26, s14, 425984
s_add_u32 s26, s26, 106496
v_mov_b32 v15, s6
v_xor_b32 v15, 0, v15
v_writelane_b32 v15, s18, 0
v_lshlrev_b32 v15, 2, v15
v_bfe_u32 v12, v0, 2, 2
v_lshlrev_b32 v12, 11, v12
v_lshrrev_b32 v13, 4, v0
v_lshl_add_u32 v12, v13, 6, v12
v_and_b32 v13, 3, v0
v_lshl_add_u32 v12, v13, 4, v12
v_xor_b32 v12, s13, v12
v_xor_b32 v13, 32, v12
v_add_u32 v13, 7168, v13
s_mov_b32 s11, 0xf149f2ca
s_mov_b32 s36, 0xfff0ffff
s_mov_b32 s37, 0xf000ff00
s_mov_b32 s38, 0xffe0fffe
s_mov_b32 s39, 0xe000fe00
s_mov_b32 s40, 0xffc0fffc
s_mov_b32 s41, 0xc000fc00
s_mov_b32 s42, 0xff80fff8
s_mov_b32 s43, 0x8000f800
s_bitcmp1_b32 s4, 0
s_cselect_b32 s8, 0x7f800000, s11
s_cselect_b32 s9, s11, 0x7f800000
v_mov_b32 v1, v3
v_add_u32 v2, 98304, v3
s_mov_b64 s[34:35], 0
v_accvgpr_write_b32 a224, 0
v_accvgpr_write_b32 a225, 0
v_accvgpr_write_b32 a226, 0
v_accvgpr_write_b32 a227, 0
v_accvgpr_write_b32 a228, 0
v_accvgpr_write_b32 a229, 0
v_accvgpr_write_b32 a230, 0
v_accvgpr_write_b32 a231, 0
v_sub_f32 v83, 0, v80
v_sub_f32 v82, 0, v80
v_sub_f32 v81, 0, v80
v_sub_f32 v80, 0, v80
v_min_f32 v103, s8, v80
v_cndmask_b32 v96, v103, v80, s[36:37]
v_cndmask_b32 v97, v103, v80, s[38:39]
v_cndmask_b32 v98, v103, v80, s[40:41]
v_cndmask_b32 v99, v103, v80, s[42:43]
v_cndmask_b32 v100, v9, v103, s[36:37]
v_cndmask_b32 v101, v9, v103, s[38:39]
v_cndmask_b32 v102, v9, v103, s[40:41]
v_cndmask_b32 v103, v9, v103, s[42:43]
v_sub_f32 v87, 0, v84
v_sub_f32 v86, 0, v84
v_sub_f32 v85, 0, v84
v_sub_f32 v84, 0, v84
v_min_f32 v111, s9, v84
v_cndmask_b32 v104, v111, v84, s[36:37]
v_cndmask_b32 v105, v111, v84, s[38:39]
v_cndmask_b32 v106, v111, v84, s[40:41]
v_cndmask_b32 v107, v111, v84, s[42:43]
v_cndmask_b32 v108, v9, v111, s[36:37]
v_cndmask_b32 v109, v9, v111, s[38:39]
v_cndmask_b32 v110, v9, v111, s[40:41]
v_cndmask_b32 v111, v9, v111, s[42:43]
v_sub_f32 v91, 0, v88
v_sub_f32 v90, 0, v88
v_sub_f32 v89, 0, v88
v_sub_f32 v88, 0, v88
v_min_f32 v119, s8, v88
v_cndmask_b32 v112, v119, v88, s[36:37]
v_cndmask_b32 v113, v119, v88, s[38:39]
v_cndmask_b32 v114, v119, v88, s[40:41]
v_cndmask_b32 v115, v119, v88, s[42:43]
v_cndmask_b32 v116, v9, v119, s[36:37]
v_cndmask_b32 v117, v9, v119, s[38:39]
v_cndmask_b32 v118, v9, v119, s[40:41]
v_cndmask_b32 v119, v9, v119, s[42:43]
v_sub_f32 v95, 0, v92
v_sub_f32 v94, 0, v92
v_sub_f32 v93, 0, v92
v_sub_f32 v92, 0, v92
v_min_f32 v127, s9, v92
v_cndmask_b32 v120, v127, v92, s[36:37]
v_cndmask_b32 v121, v127, v92, s[38:39]
v_cndmask_b32 v122, v127, v92, s[40:41]
v_cndmask_b32 v123, v127, v92, s[42:43]
v_cndmask_b32 v124, v9, v127, s[36:37]
v_cndmask_b32 v125, v9, v127, s[38:39]
v_cndmask_b32 v126, v9, v127, s[40:41]
v_cndmask_b32 v127, v9, v127, s[42:43]
v_and_b32 v9, 1, v0
v_mul_u32_u24 v9, 0xaaaa, v9
v_add_u32 v9, 0x4444, v9
v_mov_b32 v128, 0
v_mov_b32 v129, 0
v_mov_b32 v130, 0
v_mov_b32 v131, 0
v_mov_b32 v132, 0
v_mov_b32 v133, 0
v_mov_b32 v134, 0
v_mov_b32 v135, 0
v_mov_b32 v136, 0
v_mov_b32 v137, 0
v_mov_b32 v138, 0
v_mov_b32 v139, 0
v_mov_b32 v140, 0
v_mov_b32 v141, 0
v_mov_b32 v142, 0
v_mov_b32 v143, 0
v_mov_b32 v144, 0
v_mov_b32 v145, 0
v_mov_b32 v146, 0
v_mov_b32 v147, 0
v_mov_b32 v148, 0
v_mov_b32 v149, 0
v_mov_b32 v150, 0
v_mov_b32 v151, 0
v_mov_b32 v152, 0
v_mov_b32 v153, 0
v_mov_b32 v154, 0
v_mov_b32 v155, 0
v_mov_b32 v156, 0
v_mov_b32 v157, 0
v_mov_b32 v158, 0
v_mov_b32 v159, 0
v_mov_b32 v160, 0
v_mov_b32 v161, 0
v_mov_b32 v162, 0
v_mov_b32 v163, 0
v_mov_b32 v164, 0
v_mov_b32 v165, 0
v_mov_b32 v166, 0
v_mov_b32 v167, 0
v_mov_b32 v168, 0
v_mov_b32 v169, 0
v_mov_b32 v170, 0
v_mov_b32 v171, 0
v_mov_b32 v172, 0
v_mov_b32 v173, 0
v_mov_b32 v174, 0
v_mov_b32 v175, 0
v_mov_b32 v176, 0
v_mov_b32 v177, 0
v_mov_b32 v178, 0
v_mov_b32 v179, 0
v_mov_b32 v180, 0
v_mov_b32 v181, 0
v_mov_b32 v182, 0
v_mov_b32 v183, 0
v_mov_b32 v184, 0
v_mov_b32 v185, 0
v_mov_b32 v186, 0
v_mov_b32 v187, 0
v_mov_b32 v188, 0
v_mov_b32 v189, 0
v_mov_b32 v190, 0
v_mov_b32 v191, 0
v_mov_b32 v192, 0
v_mov_b32 v193, 0
v_mov_b32 v194, 0
v_mov_b32 v195, 0
v_mov_b32 v196, 0
v_mov_b32 v197, 0
v_mov_b32 v198, 0
v_mov_b32 v199, 0
v_mov_b32 v200, 0
v_mov_b32 v201, 0
v_mov_b32 v202, 0
v_mov_b32 v203, 0
v_mov_b32 v204, 0
v_mov_b32 v205, 0
v_mov_b32 v206, 0
v_mov_b32 v207, 0
v_mov_b32 v208, 0
v_mov_b32 v209, 0
v_mov_b32 v210, 0
v_mov_b32 v211, 0
v_mov_b32 v212, 0
v_mov_b32 v213, 0
v_mov_b32 v214, 0
v_mov_b32 v215, 0
v_mov_b32 v216, 0
v_mov_b32 v217, 0
v_mov_b32 v218, 0
v_mov_b32 v219, 0
v_mov_b32 v220, 0
v_mov_b32 v221, 0
v_mov_b32 v222, 0
v_mov_b32 v223, 0
v_mov_b32 v224, 0
v_mov_b32 v225, 0
v_mov_b32 v226, 0
v_mov_b32 v227, 0
v_mov_b32 v228, 0
v_mov_b32 v229, 0
v_mov_b32 v230, 0
v_mov_b32 v231, 0
v_mov_b32 v232, 0
v_mov_b32 v233, 0
v_mov_b32 v234, 0
v_mov_b32 v235, 0
v_mov_b32 v236, 0
v_mov_b32 v237, 0
v_mov_b32 v238, 0
v_mov_b32 v239, 0
v_mov_b32 v240, 0
v_mov_b32 v241, 0
v_mov_b32 v242, 0
v_mov_b32 v243, 0
v_mov_b32 v244, 0
v_mov_b32 v245, 0
v_mov_b32 v246, 0
v_mov_b32 v247, 0
v_mov_b32 v248, 0
v_mov_b32 v249, 0
v_mov_b32 v250, 0
v_mov_b32 v251, 0
v_mov_b32 v252, 0
v_mov_b32 v253, 0
v_mov_b32 v254, 0
v_mov_b32 v255, 0
s_waitcnt vmcnt(16)
s_barrier
ds_read_b128 a[0:3], v1 offset:8192
ds_read_b128 a[4:7], v1 offset:9216
ds_read_b128 a[8:11], v1 offset:10240
ds_read_b128 a[12:15], v1 offset:11264
ds_read_b128 a[16:19], v1 offset:12288
ds_read_b128 a[20:23], v1 offset:13312
ds_read_b128 a[24:27], v1 offset:14336
ds_read_b128 a[28:31], v1 offset:15360
s_waitcnt lgkmcnt(0)
s_branch L_att_start
.section .rodata,"a"
.p2align 6
.amdhsa_kernel gated_mix__compressed_kv_cla__sliding_local_dilated__prompt_kernel
  .amdhsa_next_free_vgpr 512
  .amdhsa_next_free_sgpr 102
  .amdhsa_accum_offset 256
  .amdhsa_group_segment_fixed_size 0
  .amdhsa_kernarg_size 104
  .amdhsa_user_sgpr_count 2
  .amdhsa_user_sgpr_kernarg_segment_ptr 1
  .amdhsa_system_sgpr_workgroup_id_x 1
.end_amdhsa_kernel
```

```asm
; @launch grid=(256,1,1) block=(256,1,1) lds=163840
.amdgcn_target "amdgcn-amd-amdhsa--gfx950"
.text
.globl gated_mix__compressed_kv_cla__sliding_local_dilated__prompt_kernel
.p2align 8
.type gated_mix__compressed_kv_cla__sliding_local_dilated__prompt_kernel,@function
gated_mix__compressed_kv_cla__sliding_local_dilated__prompt_kernel:
s_load_dwordx16 s[16:31], s[0:1], 0
s_load_dwordx8 s[32:39], s[0:1], 64
s_load_dwordx2 s[88:89], s[0:1], 96
s_cmp_ge_u32 s2, 256
s_cbranch_scc1 L_end
v_lshrrev_b32 v1, 6, v0
v_and_b32 v0, 63, v0
v_readfirstlane_b32 s4, v1
v_lshlrev_b32 v16, 4, v0
s_lshr_b32 s8, s2, 3
s_lshl_b32 s8, s8, 2
s_add_u32 s8, s8, s4
s_min_u32 s8, s8, 101
s_lshl_b32 s8, s8, 10
s_getpc_b64 s[92:93]
L_here:
s_add_u32 s8, s8, L_page0-L_here
s_add_u32 s92, s92, s8
s_addc_u32 s93, s93, 0
v_add_u32 v60, s92, v16
v_mov_b32 v61, s93
global_load_dword a120, v[60:61], off sc1
s_and_b32 s5, s2, 7
s_lshl_b32 s5, s5, 2
s_lshr_b32 s5, 0x75643120, s5
s_and_b32 s5, s5, 7
s_lshl_b32 s5, s5, 2
s_bfe_u32 s3, s2, 0x20003
s_add_u32 s5, s5, s3
s_lshr_b32 s6, s2, 5
s_mov_b32 s12, 0x4000
s_mov_b32 s13, 0x8000
s_mov_b32 s14, 0xc000
s_mov_b32 s46, 0x400000
s_mov_b32 s47, 0x20000
s_mov_b32 s50, 0x200000
s_mov_b32 s51, 0x20000
s_mov_b32 s54, 0x800000
s_mov_b32 s55, 0x20000
s_mov_b32 s58, 0x400000
s_mov_b32 s59, 0x20000
s_mov_b32 s62, 0x400000
s_mov_b32 s63, 0x20000
s_mov_b32 s66, 0x800000
s_mov_b32 s67, 0x20000
s_mov_b32 s70, 0x600000
s_mov_b32 s71, 0x20000
s_mov_b32 s74, 0x200000
s_mov_b32 s75, 0x20000
s_mov_b32 s78, 0x800
s_mov_b32 s79, 0x20000
s_mov_b32 s82, 0x400000
s_mov_b32 s83, 0x20000
s_mov_b32 s86, 0x100
s_mov_b32 s87, 0x20000
s_mov_b32 s90, 0x10000000
s_mov_b32 s91, 0x20000
v_bfe_u32 v17, v0, 2, 2
s_lshl_b32 s8, s4, 4
v_add_u32 v17, s8, v17
v_lshlrev_b32 v17, 13, v17
v_lshrrev_b32 v18, 4, v0
v_lshl_add_u32 v17, v18, 6, v17
v_and_b32 v18, 3, v0
v_lshl_add_u32 v17, v18, 4, v17
s_lshl_b32 s8, s5, 8
v_add_u32 v5, s8, v17
v_xor_b32 v6, 32, v5
v_add_u32 v6, 0x10000, v6
v_lshrrev_b32 v17, 4, v0
v_xor_b32 v17, v17, v0
v_and_b32 v17, 7, v17
v_lshlrev_b32 v17, 4, v17
v_lshrrev_b32 v18, 3, v0
v_lshl_add_u32 v2, v18, 10, v17
s_lshl_b32 s8, s6, 18
s_lshl_b32 s9, s4, 16
s_add_u32 s8, s8, s9
v_add_u32 v2, s8, v2
v_xor_b32 v3, 64, v2
v_add_u32 v3, 0x2000, v3
s_mov_b32 s41, 0
s_mov_b32 s43, 0
v_lshl_add_u32 v5, s41, 19, v5
v_lshl_add_u32 v6, s41, 19, v6
v_lshl_add_u32 v2, s41, 7, v2
v_lshl_add_u32 v3, s41, 7, v3
s_sub_u32 s10, 15, s6
s_cmp_lt_u32 s5, 16
s_cselect_b32 s10, s6, s10
s_lshl_b32 s10, s10, 4
s_and_b32 s11, s5, 15
s_add_u32 s10, s10, s11
s_lshl_b32 s10, s10, 3
s_lshl_b32 s11, s4, 1
s_add_u32 s10, s10, s11
s_lshl_b32 s100, s10, 11
s_lshl_b32 s101, s10, 2
s_add_u32 s101, s101, 0x3700000
s_lshl_b32 s8, s2, 2
s_add_u32 s8, s8, s4
s_lshl_b32 s8, s8, 11
v_lshrrev_b32 v19, 2, v0
v_lshl_add_u32 v19, v19, 7, s8
s_lshr_b32 s8, s2, 3
s_lshl_b32 s8, s8, 2
s_add_u32 s8, s8, s4
s_lshl_b32 s8, s8, 4
s_lshr_b32 s9, s5, 2
s_add_u32 s8, s8, s9
s_lshl_b32 s8, s8, 10
v_bfe_u32 v63, v0, 2, 3
v_lshl_add_u32 v63, v63, 7, s8
v_lshrrev_b32 v59, 5, v0
v_lshl_add_u32 v63, v59, 13, v63
v_mov_b32 v62, v19
s_waitcnt lgkmcnt(0)
s_mov_b64 s[48:49], s[18:19]
s_mov_b64 s[56:57], s[22:23]
s_mov_b64 s[60:61], s[24:25]
L_args:
s_mov_b64 s[0:1], s[92:93]
s_mov_b64 s[44:45], s[16:17]
s_mov_b64 s[76:77], s[34:35]
s_mov_b64 s[52:53], s[20:21]
s_mov_b64 s[64:65], s[26:27]
s_mov_b64 s[68:69], s[30:31]
s_mov_b64 s[72:73], s[32:33]
s_mov_b64 s[80:81], s[36:37]
s_mov_b64 s[84:85], s[38:39]
s_lshl_b32 s16, s4, 13
s_add_u32 s16, s16, 0x18000
s_lshl_b32 s17, s4, 12
s_lshl_b32 s18, s4, 10
s_mov_b32 s25, 0x800
s_mov_b32 s26, 0x1000
s_mov_b32 s3, 0
s_mov_b32 s9, 0x0
s_nop 0
buffer_load_dword a120, v63, s[56:59], s9 offen
s_mov_b32 s9, 0x0
s_nop 0
buffer_load_dword a120, v63, s[60:63], s9 offen
s_add_u32 m0, s17, 0x0
s_nop 0
buffer_load_dwordx4 v5, s[56:59], 0 offen lds
s_add_u32 m0, s17, 0x4000
s_nop 0
buffer_load_dwordx4 v5, s[60:63], 0 offen lds
s_add_u32 m0, s17, 0x400
s_nop 0
buffer_load_dwordx4 v5, s[56:59], s13 offen lds
s_add_u32 m0, s17, 0x4400
s_nop 0
buffer_load_dwordx4 v5, s[60:63], s13 offen lds
s_add_u32 m0, s17, 0x800
s_nop 0
buffer_load_dwordx4 v6, s[56:59], 0 offen lds
s_add_u32 m0, s17, 0x4800
s_nop 0
buffer_load_dwordx4 v6, s[60:63], 0 offen lds
s_add_u32 m0, s17, 0xc00
s_nop 0
buffer_load_dwordx4 v6, s[56:59], s13 offen lds
s_add_u32 m0, s17, 0x4c00
s_nop 0
buffer_load_dwordx4 v6, s[60:63], s13 offen lds
s_mov_b32 s42, 1
s_mov_b32 s41, 7
v_lshl_add_u32 v5, s42, 19, v5
v_lshl_add_u32 v6, s42, 19, v6
s_add_u32 m0, s16, 0x0
s_nop 0
buffer_load_dwordx4 v2, s[48:51], 0 offen lds
s_add_u32 m0, s16, 0x400
s_nop 0
buffer_load_dwordx4 v3, s[48:51], 0 offen lds
s_add_u32 m0, s16, 0x800
s_nop 0
buffer_load_dwordx4 v2, s[48:51], s12 offen lds
s_add_u32 m0, s16, 0xc00
s_nop 0
buffer_load_dwordx4 v3, s[48:51], s12 offen lds
s_add_u32 m0, s16, 0x1000
s_nop 0
buffer_load_dwordx4 v2, s[48:51], s13 offen lds
s_add_u32 m0, s16, 0x1400
s_nop 0
buffer_load_dwordx4 v3, s[48:51], s13 offen lds
s_add_u32 m0, s16, 0x1800
s_nop 0
buffer_load_dwordx4 v2, s[48:51], s14 offen lds
s_add_u32 m0, s16, 0x1c00
s_nop 0
buffer_load_dwordx4 v3, s[48:51], s14 offen lds
v_lshl_add_u32 v2, s42, 7, v2
v_lshl_add_u32 v3, s42, 7, v3
v_lshrrev_b32 v17, 4, v0
v_xor_b32 v17, v17, v0
v_and_b32 v17, 7, v17
v_lshlrev_b32 v17, 4, v17
v_lshrrev_b32 v18, 3, v0
v_lshl_add_u32 v22, v18, 11, v17
v_xor_b32 v23, 64, v22
v_add_u32 v23, 0x4000, v23
s_lshl_b32 s8, s6, 18
s_sub_u32 s9, 15, s6
s_lshl_b32 s9, s9, 18
s_lshl_b32 s10, s4, 15
s_sub_u32 s11, 0x38000, s10
s_add_u32 s20, s8, s10
s_add_u32 s21, s8, s11
s_add_u32 s22, s9, s10
s_add_u32 s23, s9, s11
s_lshl_b32 s10, s5, 15
s_add_u32 s10, s10, 0x3c00000
s_lshr_b32 s8, s8, 7
s_lshr_b32 s9, s9, 7
s_add_u32 s8, s8, s10
s_add_u32 s9, s9, s10
v_add_u32 v10, s8, v16
v_add_u32 v11, s9, v16
s_cmp_lt_u32 s4, 2
s_cselect_b32 s8, s8, s9
s_and_b32 s9, s4, 1
s_lshl_b32 s9, s9, 10
s_add_u32 s8, s8, s9
v_add_u32 v4, s8, v16
v_lshrrev_b32 v17, 2, v0
s_lshl_b32 s8, s4, 4
v_add_u32 v17, s8, v17
v_mul_u32_u24 v17, 0x1800, v17
v_and_b32 v18, 3, v0
v_lshlrev_b32 v18, 4, v18
v_and_b32 v19, 32, v0
v_xor_b32 v18, v18, v19
s_lshl_b32 s8, s5, 6
v_add3_u32 v7, v17, v18, s8
v_lshl_add_u32 v22, s43, 7, v22
v_lshl_add_u32 v23, s43, 7, v23
v_lshl_add_u32 v7, s43, 18, v7
v_lshl_add_u32 v7, s43, 17, v7
v_and_b32 v17, 15, v0
v_lshrrev_b32 v18, 1, v17
v_lshrrev_b32 v19, 4, v0
v_xor_b32 v18, v18, v19
v_lshlrev_b32 v18, 4, v18
v_lshl_add_u32 v8, v17, 7, v18
v_add_u32 v8, s16, v8
v_xor_b32 v9, 64, v8
v_lshrrev_b32 v17, 4, v0
v_lshlrev_b32 v18, 11, v17
v_and_b32 v17, 1, v17
v_lshl_add_u32 v18, v17, 5, v18
v_bfe_u32 v17, v0, 2, 2
v_lshl_add_u32 v18, v17, 6, v18
v_and_b32 v17, 3, v0
v_lshl_add_u32 v12, v17, 3, v18
v_xor_b32 v13, 32, v12
v_lshrrev_b32 v17, 4, v0
v_lshlrev_b32 v18, 9, v17
v_and_b32 v17, 1, v17
v_lshl_add_u32 v18, v17, 5, v18
v_bfe_u32 v17, v0, 2, 2
v_lshl_add_u32 v18, v17, 6, v18
v_and_b32 v17, 3, v0
v_lshl_add_u32 v14, v17, 3, v18
v_accvgpr_write_b32 a64, -1
v_accvgpr_write_b32 a65, -1
v_accvgpr_write_b32 a66, -1
v_accvgpr_write_b32 a67, -1
v_add_u32 v14, 81920, v14
v_xor_b32 v15, 32, v14
s_mul_i32 s32, s5, 0x10c400
s_lshl_b32 s19, s4, 13
s_add_u32 s32, s32, s19
s_cmp_eq_u32 s4, 0
s_cselect_b32 s94, 0x200000, 0
s_add_u32 s32, s32, s94
s_sub_u32 s94, 0x8000, s94
s_add_u32 s7, s32, 0x1000
s_add_u32 s27, s19, 131072
s_add_u32 m0, s16, 0x8000
s_nop 0
buffer_load_dwordx4 v2, s[48:51], 0 offen lds
s_add_u32 m0, s16, 0x8400
s_nop 0
buffer_load_dwordx4 v3, s[48:51], 0 offen lds
s_add_u32 m0, s16, 0x8800
s_nop 0
buffer_load_dwordx4 v2, s[48:51], s12 offen lds
s_add_u32 m0, s16, 0x8c00
s_nop 0
buffer_load_dwordx4 v3, s[48:51], s12 offen lds
s_add_u32 m0, s16, 0x9000
s_nop 0
buffer_load_dwordx4 v2, s[48:51], s13 offen lds
s_add_u32 m0, s16, 0x9400
s_nop 0
buffer_load_dwordx4 v3, s[48:51], s13 offen lds
s_add_u32 m0, s16, 0x9800
s_nop 0
buffer_load_dwordx4 v2, s[48:51], s14 offen lds
s_add_u32 m0, s16, 0x9c00
s_nop 0
buffer_load_dwordx4 v3, s[48:51], s14 offen lds
v_lshl_add_u32 v2, s42, 7, v2
v_lshl_add_u32 v3, s42, 7, v3
s_mov_b32 s9, 0x0
s_nop 0
buffer_load_dword a120, v62, s[48:51], s9 offen
L_hopA:
s_mov_b32 s95, 1
s_cmp_eq_u32 s4, 0
s_cbranch_scc1 L_padA0
s_cmp_eq_u32 s4, 1
s_cbranch_scc1 L_padA1
s_cmp_eq_u32 s4, 2
s_cbranch_scc1 L_padA2
s_branch L_padA3
L_hopA_ret:
s_mov_b32 s95, 0
v_mov_b32 v19, v62
v_mov_b32 v18, v63
s_cmp_lg_u32 s4, 0
s_cbranch_scc1 L_flag_clr
s_lshl_b32 s8, s6, 5
s_add_u32 s8, s8, s5
s_and_b32 s92, s8, 0xf0
s_mul_i32 s92, s92, 3
s_add_u32 s8, s8, s92
s_lshl_b32 s8, s8, 2
s_add_u32 s8, s8, 0x3704000
v_mov_b32 v17, 0
s_mov_b64 exec, 1
buffer_store_dword v17, off, s[88:91], s8 sc1
s_mov_b64 exec, -1
L_flag_clr:
s_waitcnt vmcnt(9)
s_barrier
s_branch L_main
.p2align 12
L_page0:
L_padA0:
s_branch L_padA4
L_main:
ds_read_b64_tr_b16 a[80:81], v12 offset:0
ds_read_b64_tr_b16 a[82:83], v12 offset:1024
ds_read_b64_tr_b16 a[84:85], v12 offset:8192
ds_read_b64_tr_b16 a[86:87], v12 offset:9216
ds_read_b128 a[0:3], v8 offset:0
ds_read_b128 a[16:19], v9 offset:0
ds_read_b128 a[4:7], v8 offset:2048
ds_read_b128 a[20:23], v9 offset:2048
ds_read_b128 a[8:11], v8 offset:4096
ds_read_b128 a[24:27], v9 offset:4096
ds_read_b128 a[12:15], v8 offset:6144
ds_read_b128 a[28:31], v9 offset:6144
ds_read_b64_tr_b16 a[88:89], v13 offset:0
ds_read_b64_tr_b16 a[90:91], v13 offset:1024
ds_read_b64_tr_b16 a[92:93], v13 offset:8192
ds_read_b64_tr_b16 a[94:95], v13 offset:9216
ds_read_b64_tr_b16 a[96:97], v12 offset:256
ds_read_b64_tr_b16 a[98:99], v12 offset:1280
ds_read_b64_tr_b16 a[100:101], v12 offset:8448
ds_read_b64_tr_b16 a[102:103], v12 offset:9472
s_waitcnt lgkmcnt(0)
L_S0:
v_mfma_f32_16x16x32_bf16 v[24:27], a[80:83], a[0:3], 0
ds_read_b64_tr_b16 a[104:105], v13 offset:256
s_add_u32 m0, s17, 0x8000
v_mfma_f32_16x16x32_bf16 v[24:27], a[84:87], a[16:19], v[24:27]
buffer_load_dwordx4 v5, s[56:59], 0 offen lds
v_mfma_f32_16x16x32_bf16 v[32:35], a[84:87], a[20:23], 0
ds_read_b64_tr_b16 a[106:107], v13 offset:1280
v_mfma_f32_16x16x32_bf16 v[32:35], a[80:83], a[4:7], v[32:35]
ds_read_b64_tr_b16 a[108:109], v13 offset:8448
v_mfma_f32_16x16x32_bf16 v[40:43], a[80:83], a[8:11], 0
ds_read_b64_tr_b16 a[110:111], v13 offset:9472
v_mfma_f32_16x16x32_bf16 v[40:43], a[84:87], a[24:27], v[40:43]
s_add_u32 m0, s17, 0xc000
v_mfma_f32_16x16x32_bf16 v[48:51], a[84:87], a[28:31], 0
buffer_load_dwordx4 v5, s[60:63], 0 offen lds
v_mfma_f32_16x16x32_bf16 v[48:51], a[80:83], a[12:15], v[48:51]
v_mfma_f32_16x16x32_bf16 v[52:55], a[88:91], a[12:15], 0
ds_read_b64_tr_b16 a[80:81], v12 offset:512
v_mfma_f32_16x16x32_bf16 v[52:55], a[92:95], a[28:31], v[52:55]
ds_read_b64_tr_b16 a[82:83], v12 offset:1536
v_mfma_f32_16x16x32_bf16 v[44:47], a[92:95], a[24:27], 0
ds_read_b64_tr_b16 a[84:85], v12 offset:8704
s_add_u32 m0, s17, 0x8400
v_mfma_f32_16x16x32_bf16 v[44:47], a[88:91], a[8:11], v[44:47]
buffer_load_dwordx4 v5, s[56:59], s13 offen lds
v_mfma_f32_16x16x32_bf16 v[36:39], a[88:91], a[4:7], 0
ds_read_b64_tr_b16 a[86:87], v12 offset:9728
v_mfma_f32_16x16x32_bf16 v[36:39], a[92:95], a[20:23], v[36:39]
v_mfma_f32_16x16x32_bf16 v[28:31], a[92:95], a[16:19], 0
v_mfma_f32_16x16x32_bf16 v[28:31], a[88:91], a[0:3], v[28:31]
s_add_u32 m0, s17, 0xc400
v_mfma_f32_16x16x32_bf16 v[56:59], a[96:99], a[0:3], 0
buffer_load_dwordx4 v5, s[60:63], s13 offen lds
v_mfma_f32_16x16x32_bf16 v[56:59], a[100:103], a[16:19], v[56:59]
ds_read_b64_tr_b16 a[88:89], v13 offset:512
v_mfma_f32_16x16x32_bf16 v[64:67], a[100:103], a[20:23], 0
ds_read_b64_tr_b16 a[90:91], v13 offset:1536
v_mfma_f32_16x16x32_bf16 v[64:67], a[96:99], a[4:7], v[64:67]
ds_read_b64_tr_b16 a[92:93], v13 offset:8704
v_mfma_f32_16x16x32_bf16 v[72:75], a[96:99], a[8:11], 0
ds_read_b64_tr_b16 a[94:95], v13 offset:9728
s_add_u32 m0, s17, 0x8800
v_mfma_f32_16x16x32_bf16 v[72:75], a[100:103], a[24:27], v[72:75]
buffer_load_dwordx4 v6, s[56:59], 0 offen lds
v_mfma_f32_16x16x32_bf16 v[80:83], a[100:103], a[28:31], 0
v_mfma_f32_16x16x32_bf16 v[80:83], a[96:99], a[12:15], v[80:83]
s_waitcnt lgkmcnt(10)
v_mfma_f32_16x16x32_bf16 v[84:87], a[104:107], a[12:15], 0
ds_read_b64_tr_b16 a[96:97], v12 offset:768
s_waitcnt lgkmcnt(9)
v_mfma_f32_16x16x32_bf16 v[84:87], a[108:111], a[28:31], v[84:87]
ds_read_b64_tr_b16 a[98:99], v12 offset:1792
s_add_u32 m0, s17, 0xc800
v_mfma_f32_16x16x32_bf16 v[76:79], a[108:111], a[24:27], 0
buffer_load_dwordx4 v6, s[60:63], 0 offen lds
v_mfma_f32_16x16x32_bf16 v[76:79], a[104:107], a[8:11], v[76:79]
ds_read_b64_tr_b16 a[100:101], v12 offset:8960
v_mfma_f32_16x16x32_bf16 v[68:71], a[104:107], a[4:7], 0
ds_read_b64_tr_b16 a[102:103], v12 offset:9984
v_mfma_f32_16x16x32_bf16 v[68:71], a[108:111], a[20:23], v[68:71]
v_mfma_f32_16x16x32_bf16 v[60:63], a[108:111], a[16:19], 0
s_add_u32 m0, s17, 0x8c00
s_waitcnt lgkmcnt(4)
v_mfma_f32_16x16x32_bf16 v[60:63], a[104:107], a[0:3], v[60:63]
buffer_load_dwordx4 v6, s[56:59], s13 offen lds
v_mfma_f32_16x16x32_bf16 v[88:91], a[80:83], a[0:3], 0
ds_read_b64_tr_b16 a[104:105], v13 offset:768
v_mfma_f32_16x16x32_bf16 v[88:91], a[84:87], a[16:19], v[88:91]
ds_read_b64_tr_b16 a[106:107], v13 offset:1792
v_mfma_f32_16x16x32_bf16 v[96:99], a[84:87], a[20:23], 0
ds_read_b64_tr_b16 a[108:109], v13 offset:8960
v_mfma_f32_16x16x32_bf16 v[96:99], a[80:83], a[4:7], v[96:99]
ds_read_b64_tr_b16 a[110:111], v13 offset:9984
s_add_u32 m0, s17, 0xcc00
v_mfma_f32_16x16x32_bf16 v[104:107], a[80:83], a[8:11], 0
buffer_load_dwordx4 v6, s[60:63], s13 offen lds
v_mfma_f32_16x16x32_bf16 v[104:107], a[84:87], a[24:27], v[104:107]
v_lshl_add_u32 v5, s42, 19, v5
v_lshl_add_u32 v6, s42, 19, v6
v_mfma_f32_16x16x32_bf16 v[112:115], a[84:87], a[28:31], 0
v_mfma_f32_16x16x32_bf16 v[112:115], a[80:83], a[12:15], v[112:115]
v_mfma_f32_16x16x32_bf16 v[116:119], a[88:91], a[12:15], 0
ds_read_b64_tr_b16 a[80:81], v12 offset:16384
s_add_u32 m0, s16, 0x0
v_mfma_f32_16x16x32_bf16 v[116:119], a[92:95], a[28:31], v[116:119]
buffer_load_dwordx4 v2, s[48:51], 0 offen lds
v_mfma_f32_16x16x32_bf16 v[108:111], a[92:95], a[24:27], 0
ds_read_b64_tr_b16 a[82:83], v12 offset:17408
v_mfma_f32_16x16x32_bf16 v[108:111], a[88:91], a[8:11], v[108:111]
ds_read_b64_tr_b16 a[84:85], v12 offset:24576
v_mfma_f32_16x16x32_bf16 v[100:103], a[88:91], a[4:7], 0
ds_read_b64_tr_b16 a[86:87], v12 offset:25600
v_mfma_f32_16x16x32_bf16 v[100:103], a[92:95], a[20:23], v[100:103]
s_add_u32 m0, s16, 0x400
v_mfma_f32_16x16x32_bf16 v[92:95], a[92:95], a[16:19], 0
buffer_load_dwordx4 v3, s[48:51], 0 offen lds
v_mfma_f32_16x16x32_bf16 v[92:95], a[88:91], a[0:3], v[92:95]
s_waitcnt lgkmcnt(4)
v_mfma_f32_16x16x32_bf16 v[120:123], a[96:99], a[0:3], 0
ds_read_b64_tr_b16 a[88:89], v13 offset:16384
s_waitcnt vmcnt(11)
v_mfma_f32_16x16x32_bf16 v[120:123], a[100:103], a[16:19], v[120:123]
ds_read_b64_tr_b16 a[90:91], v13 offset:17408
v_mfma_f32_16x16x32_bf16 v[128:131], a[100:103], a[20:23], 0
ds_read_b64_tr_b16 a[92:93], v13 offset:24576
s_add_u32 m0, s16, 0x800
v_mfma_f32_16x16x32_bf16 v[128:131], a[96:99], a[4:7], v[128:131]
buffer_load_dwordx4 v2, s[48:51], s12 offen lds
v_mfma_f32_16x16x32_bf16 v[136:139], a[96:99], a[8:11], 0
ds_read_b64_tr_b16 a[94:95], v13 offset:25600
v_mfma_f32_16x16x32_bf16 v[136:139], a[100:103], a[24:27], v[136:139]
ds_read_b128 a[32:35], v8 offset:32768
v_mfma_f32_16x16x32_bf16 v[144:147], a[100:103], a[28:31], 0
ds_read_b128 a[48:51], v9 offset:32768
v_mfma_f32_16x16x32_bf16 v[144:147], a[96:99], a[12:15], v[144:147]
ds_read_b128 a[36:39], v8 offset:34816
s_add_u32 m0, s16, 0xc00
v_mfma_f32_16x16x32_bf16 v[148:151], a[104:107], a[12:15], 0
buffer_load_dwordx4 v3, s[48:51], s12 offen lds
v_mfma_f32_16x16x32_bf16 v[148:151], a[108:111], a[28:31], v[148:151]
ds_read_b64_tr_b16 a[96:97], v12 offset:16640
v_mfma_f32_16x16x32_bf16 v[140:143], a[108:111], a[24:27], 0
ds_read_b64_tr_b16 a[98:99], v12 offset:17664
v_mfma_f32_16x16x32_bf16 v[140:143], a[104:107], a[8:11], v[140:143]
ds_read_b64_tr_b16 a[100:101], v12 offset:24832
v_mfma_f32_16x16x32_bf16 v[132:135], a[104:107], a[4:7], 0
ds_read_b64_tr_b16 a[102:103], v12 offset:25856
s_add_u32 m0, s16, 0x1000
v_mfma_f32_16x16x32_bf16 v[132:135], a[108:111], a[20:23], v[132:135]
buffer_load_dwordx4 v2, s[48:51], s13 offen lds
v_mfma_f32_16x16x32_bf16 v[124:127], a[108:111], a[16:19], 0
ds_read_b128 a[52:55], v9 offset:34816
v_mfma_f32_16x16x32_bf16 v[124:127], a[104:107], a[0:3], v[124:127]
ds_read_b128 a[40:43], v8 offset:36864
s_waitcnt lgkmcnt(9)
v_mfma_f32_16x16x32_bf16 v[152:155], a[0:3], a[80:83], 0
ds_read_b64_tr_b16 a[104:105], v13 offset:16640
v_mfma_f32_16x16x32_bf16 v[152:155], a[16:19], a[84:87], v[152:155]
ds_read_b64_tr_b16 a[106:107], v13 offset:17664
s_add_u32 m0, s16, 0x1400
v_mfma_f32_16x16x32_bf16 v[156:159], a[20:23], a[84:87], 0
buffer_load_dwordx4 v3, s[48:51], s13 offen lds
v_mfma_f32_16x16x32_bf16 v[156:159], a[4:7], a[80:83], v[156:159]
ds_read_b64_tr_b16 a[108:109], v13 offset:24832
v_mfma_f32_16x16x32_bf16 v[160:163], a[8:11], a[80:83], 0
ds_read_b64_tr_b16 a[110:111], v13 offset:25856
v_mfma_f32_16x16x32_bf16 v[160:163], a[24:27], a[84:87], v[160:163]
ds_read_b128 a[56:59], v9 offset:36864
v_mfma_f32_16x16x32_bf16 v[164:167], a[28:31], a[84:87], 0
ds_read_b128 a[44:47], v8 offset:38912
s_add_u32 m0, s16, 0x1800
v_mfma_f32_16x16x32_bf16 v[164:167], a[12:15], a[80:83], v[164:167]
buffer_load_dwordx4 v2, s[48:51], s14 offen lds
v_mfma_f32_16x16x32_bf16 v[180:183], a[12:15], a[88:91], 0
ds_read_b64_tr_b16 a[80:81], v12 offset:16896
v_mfma_f32_16x16x32_bf16 v[180:183], a[28:31], a[92:95], v[180:183]
ds_read_b64_tr_b16 a[82:83], v12 offset:17920
v_mfma_f32_16x16x32_bf16 v[176:179], a[24:27], a[92:95], 0
ds_read_b64_tr_b16 a[84:85], v12 offset:25088
v_mfma_f32_16x16x32_bf16 v[176:179], a[8:11], a[88:91], v[176:179]
ds_read_b64_tr_b16 a[86:87], v12 offset:26112
s_add_u32 m0, s16, 0x1c00
v_mfma_f32_16x16x32_bf16 v[172:175], a[4:7], a[88:91], 0
buffer_load_dwordx4 v3, s[48:51], s14 offen lds
v_mfma_f32_16x16x32_bf16 v[172:175], a[20:23], a[92:95], v[172:175]
ds_read_b128 a[60:63], v9 offset:38912
v_lshl_add_u32 v2, s42, 7, v2
v_mfma_f32_16x16x32_bf16 v[168:171], a[16:19], a[92:95], 0
v_lshl_add_u32 v3, s42, 7, v3
v_mfma_f32_16x16x32_bf16 v[168:171], a[0:3], a[88:91], v[168:171]
s_waitcnt lgkmcnt(7)
v_mfma_f32_16x16x32_bf16 v[184:187], a[0:3], a[96:99], 0
ds_read_b64_tr_b16 a[88:89], v13 offset:16896
s_add_u32 m0, s17, 0x10000
v_mfma_f32_16x16x32_bf16 v[184:187], a[16:19], a[100:103], v[184:187]
buffer_load_dwordx4 v5, s[56:59], 0 offen lds
v_mfma_f32_16x16x32_bf16 v[188:191], a[20:23], a[100:103], 0
ds_read_b64_tr_b16 a[90:91], v13 offset:17920
v_mfma_f32_16x16x32_bf16 v[188:191], a[4:7], a[96:99], v[188:191]
ds_read_b64_tr_b16 a[92:93], v13 offset:25088
v_mfma_f32_16x16x32_bf16 v[192:195], a[8:11], a[96:99], 0
ds_read_b64_tr_b16 a[94:95], v13 offset:26112
v_mfma_f32_16x16x32_bf16 v[192:195], a[24:27], a[100:103], v[192:195]
s_add_u32 m0, s17, 0x14000
v_mfma_f32_16x16x32_bf16 v[196:199], a[28:31], a[100:103], 0
buffer_load_dwordx4 v5, s[60:63], 0 offen lds
v_mfma_f32_16x16x32_bf16 v[196:199], a[12:15], a[96:99], v[196:199]
v_mfma_f32_16x16x32_bf16 v[212:215], a[12:15], a[104:107], 0
ds_read_b64_tr_b16 a[96:97], v12 offset:17152
v_mfma_f32_16x16x32_bf16 v[212:215], a[28:31], a[108:111], v[212:215]
ds_read_b64_tr_b16 a[98:99], v12 offset:18176
v_mfma_f32_16x16x32_bf16 v[208:211], a[24:27], a[108:111], 0
ds_read_b64_tr_b16 a[100:101], v12 offset:25344
s_add_u32 m0, s17, 0x10400
v_mfma_f32_16x16x32_bf16 v[208:211], a[8:11], a[104:107], v[208:211]
buffer_load_dwordx4 v5, s[56:59], s13 offen lds
v_mfma_f32_16x16x32_bf16 v[204:207], a[4:7], a[104:107], 0
ds_read_b64_tr_b16 a[102:103], v12 offset:26368
v_mfma_f32_16x16x32_bf16 v[204:207], a[20:23], a[108:111], v[204:207]
v_mfma_f32_16x16x32_bf16 v[200:203], a[16:19], a[108:111], 0
v_mfma_f32_16x16x32_bf16 v[200:203], a[0:3], a[104:107], v[200:203]
s_add_u32 m0, s17, 0x14400
s_waitcnt lgkmcnt(4)
v_mfma_f32_16x16x32_bf16 v[216:219], a[0:3], a[80:83], 0
buffer_load_dwordx4 v5, s[60:63], s13 offen lds
v_mfma_f32_16x16x32_bf16 v[216:219], a[16:19], a[84:87], v[216:219]
ds_read_b64_tr_b16 a[104:105], v13 offset:17152
v_mfma_f32_16x16x32_bf16 v[220:223], a[20:23], a[84:87], 0
ds_read_b64_tr_b16 a[106:107], v13 offset:18176
v_mfma_f32_16x16x32_bf16 v[220:223], a[4:7], a[80:83], v[220:223]
ds_read_b64_tr_b16 a[108:109], v13 offset:25344
v_mfma_f32_16x16x32_bf16 v[224:227], a[8:11], a[80:83], 0
ds_read_b64_tr_b16 a[110:111], v13 offset:26368
s_add_u32 m0, s17, 0x10800
v_mfma_f32_16x16x32_bf16 v[224:227], a[24:27], a[84:87], v[224:227]
buffer_load_dwordx4 v6, s[56:59], 0 offen lds
v_mfma_f32_16x16x32_bf16 v[228:231], a[28:31], a[84:87], 0
v_add_u32 v12, 0x8000, v12
v_add_u32 v13, 0x8000, v13
v_mfma_f32_16x16x32_bf16 v[228:231], a[12:15], a[80:83], v[228:231]
v_mfma_f32_16x16x32_bf16 v[244:247], a[12:15], a[88:91], 0
s_waitcnt vmcnt(13) lgkmcnt(0)
v_mfma_f32_16x16x32_bf16 v[244:247], a[28:31], a[92:95], v[244:247]
s_barrier
s_add_u32 m0, s17, 0x14800
v_mfma_f32_16x16x32_bf16 v[240:243], a[24:27], a[92:95], 0
buffer_load_dwordx4 v6, s[60:63], 0 offen lds
v_mfma_f32_16x16x32_bf16 v[240:243], a[8:11], a[88:91], v[240:243]
ds_read_b64_tr_b16 a[80:81], v12 offset:0
v_mfma_f32_16x16x32_bf16 v[236:239], a[4:7], a[88:91], 0
ds_read_b64_tr_b16 a[82:83], v12 offset:1024
v_mfma_f32_16x16x32_bf16 v[236:239], a[20:23], a[92:95], v[236:239]
ds_read_b64_tr_b16 a[84:85], v12 offset:8192
s_waitcnt lgkmcnt(3)
v_mfma_f32_16x16x32_bf16 v[232:235], a[16:19], a[92:95], 0
ds_read_b64_tr_b16 a[86:87], v12 offset:9216
s_add_u32 m0, s17, 0x10c00
v_mfma_f32_16x16x32_bf16 v[232:235], a[0:3], a[88:91], v[232:235]
buffer_load_dwordx4 v6, s[56:59], s13 offen lds
v_mfma_f32_16x16x32_bf16 v[248:251], a[0:3], a[96:99], 0
ds_read_b64_tr_b16 a[88:89], v13 offset:0
v_mfma_f32_16x16x32_bf16 v[248:251], a[16:19], a[100:103], v[248:251]
ds_read_b64_tr_b16 a[90:91], v13 offset:1024
v_mfma_f32_16x16x32_bf16 v[252:255], a[20:23], a[100:103], 0
ds_read_b64_tr_b16 a[92:93], v13 offset:8192
v_mfma_f32_16x16x32_bf16 v[252:255], a[4:7], a[96:99], v[252:255]
ds_read_b64_tr_b16 a[94:95], v13 offset:9216
s_add_u32 m0, s17, 0x14c00
v_mfma_f32_16x16x32_bf16 a[232:235], a[8:11], a[96:99], 0
buffer_load_dwordx4 v6, s[60:63], s13 offen lds
v_mfma_f32_16x16x32_bf16 a[232:235], a[24:27], a[100:103], a[232:235]
v_lshl_add_u32 v5, s42, 19, v5
v_lshl_add_u32 v6, s42, 19, v6
v_mfma_f32_16x16x32_bf16 a[236:239], a[28:31], a[100:103], 0
v_mfma_f32_16x16x32_bf16 a[236:239], a[12:15], a[96:99], a[236:239]
s_waitcnt lgkmcnt(15)
v_mfma_f32_16x16x32_bf16 a[252:255], a[12:15], a[104:107], 0
ds_read_b64_tr_b16 a[96:97], v12 offset:256
s_add_u32 m0, s16, 0x8000
v_mfma_f32_16x16x32_bf16 a[252:255], a[28:31], a[108:111], a[252:255]
buffer_load_dwordx4 v2, s[48:51], 0 offen lds
v_mfma_f32_16x16x32_bf16 a[248:251], a[24:27], a[108:111], 0
ds_read_b64_tr_b16 a[98:99], v12 offset:1280
v_mfma_f32_16x16x32_bf16 a[248:251], a[8:11], a[104:107], a[248:251]
ds_read_b64_tr_b16 a[100:101], v12 offset:8448
v_mfma_f32_16x16x32_bf16 a[244:247], a[4:7], a[104:107], 0
ds_read_b64_tr_b16 a[102:103], v12 offset:9472
v_mfma_f32_16x16x32_bf16 a[244:247], a[20:23], a[108:111], a[244:247]
s_add_u32 m0, s16, 0x8400
v_mfma_f32_16x16x32_bf16 a[240:243], a[16:19], a[108:111], 0
buffer_load_dwordx4 v3, s[48:51], 0 offen lds
v_mfma_f32_16x16x32_bf16 a[240:243], a[0:3], a[104:107], a[240:243]
s_waitcnt lgkmcnt(4)
L_S1:
v_mfma_f32_16x16x32_bf16 v[24:27], a[80:83], a[32:35], v[24:27]
ds_read_b64_tr_b16 a[104:105], v13 offset:256
v_mfma_f32_16x16x32_bf16 v[24:27], a[84:87], a[48:51], v[24:27]
ds_read_b64_tr_b16 a[106:107], v13 offset:1280
v_mfma_f32_16x16x32_bf16 v[32:35], a[84:87], a[52:55], v[32:35]
ds_read_b64_tr_b16 a[108:109], v13 offset:8448
s_add_u32 m0, s16, 0x8800
v_mfma_f32_16x16x32_bf16 v[32:35], a[80:83], a[36:39], v[32:35]
buffer_load_dwordx4 v2, s[48:51], s12 offen lds
v_mfma_f32_16x16x32_bf16 v[40:43], a[80:83], a[40:43], v[40:43]
ds_read_b64_tr_b16 a[110:111], v13 offset:9472
v_mfma_f32_16x16x32_bf16 v[40:43], a[84:87], a[56:59], v[40:43]
v_mfma_f32_16x16x32_bf16 v[48:51], a[84:87], a[60:63], v[48:51]
v_mfma_f32_16x16x32_bf16 v[48:51], a[80:83], a[44:47], v[48:51]
s_add_u32 m0, s16, 0x8c00
v_mfma_f32_16x16x32_bf16 v[52:55], a[88:91], a[44:47], v[52:55]
buffer_load_dwordx4 v3, s[48:51], s12 offen lds
v_mfma_f32_16x16x32_bf16 v[52:55], a[92:95], a[60:63], v[52:55]
ds_read_b64_tr_b16 a[80:81], v12 offset:512
v_mfma_f32_16x16x32_bf16 v[44:47], a[92:95], a[56:59], v[44:47]
ds_read_b64_tr_b16 a[82:83], v12 offset:1536
v_mfma_f32_16x16x32_bf16 v[44:47], a[88:91], a[40:43], v[44:47]
ds_read_b64_tr_b16 a[84:85], v12 offset:8704
v_mfma_f32_16x16x32_bf16 v[36:39], a[88:91], a[36:39], v[36:39]
ds_read_b64_tr_b16 a[86:87], v12 offset:9728
s_add_u32 m0, s16, 0x9000
v_mfma_f32_16x16x32_bf16 v[36:39], a[92:95], a[52:55], v[36:39]
buffer_load_dwordx4 v2, s[48:51], s13 offen lds
v_mfma_f32_16x16x32_bf16 v[28:31], a[92:95], a[48:51], v[28:31]
v_mfma_f32_16x16x32_bf16 v[28:31], a[88:91], a[32:35], v[28:31]
s_waitcnt lgkmcnt(4)
v_mfma_f32_16x16x32_bf16 v[56:59], a[96:99], a[32:35], v[56:59]
ds_read_b64_tr_b16 a[88:89], v13 offset:512
v_mfma_f32_16x16x32_bf16 v[56:59], a[100:103], a[48:51], v[56:59]
ds_read_b64_tr_b16 a[90:91], v13 offset:1536
s_add_u32 m0, s16, 0x9400
v_mfma_f32_16x16x32_bf16 v[64:67], a[100:103], a[52:55], v[64:67]
buffer_load_dwordx4 v3, s[48:51], s13 offen lds
v_mfma_f32_16x16x32_bf16 v[64:67], a[96:99], a[36:39], v[64:67]
ds_read_b64_tr_b16 a[92:93], v13 offset:8704
v_mfma_f32_16x16x32_bf16 v[72:75], a[96:99], a[40:43], v[72:75]
ds_read_b64_tr_b16 a[94:95], v13 offset:9728
v_mfma_f32_16x16x32_bf16 v[72:75], a[100:103], a[56:59], v[72:75]
v_mfma_f32_16x16x32_bf16 v[80:83], a[100:103], a[60:63], v[80:83]
s_add_u32 m0, s16, 0x9800
v_mfma_f32_16x16x32_bf16 v[80:83], a[96:99], a[44:47], v[80:83]
buffer_load_dwordx4 v2, s[48:51], s14 offen lds
v_mfma_f32_16x16x32_bf16 v[84:87], a[104:107], a[44:47], v[84:87]
ds_read_b64_tr_b16 a[96:97], v12 offset:768
v_mfma_f32_16x16x32_bf16 v[84:87], a[108:111], a[60:63], v[84:87]
ds_read_b64_tr_b16 a[98:99], v12 offset:1792
v_mfma_f32_16x16x32_bf16 v[76:79], a[108:111], a[56:59], v[76:79]
ds_read_b64_tr_b16 a[100:101], v12 offset:8960
v_mfma_f32_16x16x32_bf16 v[76:79], a[104:107], a[40:43], v[76:79]
ds_read_b64_tr_b16 a[102:103], v12 offset:9984
s_add_u32 m0, s16, 0x9c00
v_mfma_f32_16x16x32_bf16 v[68:71], a[104:107], a[36:39], v[68:71]
buffer_load_dwordx4 v3, s[48:51], s14 offen lds
v_mfma_f32_16x16x32_bf16 v[68:71], a[108:111], a[52:55], v[68:71]
v_lshl_add_u32 v2, s42, 7, v2
v_lshl_add_u32 v3, s42, 7, v3
v_mfma_f32_16x16x32_bf16 v[60:63], a[108:111], a[48:51], v[60:63]
v_mfma_f32_16x16x32_bf16 v[60:63], a[104:107], a[32:35], v[60:63]
s_add_u32 m0, s17, 0x0
s_waitcnt lgkmcnt(4)
v_mfma_f32_16x16x32_bf16 v[88:91], a[80:83], a[32:35], v[88:91]
ds_read_b64_tr_b16 a[104:105], v13 offset:768
s_waitcnt vmcnt(16)
v_mfma_f32_16x16x32_bf16 v[88:91], a[84:87], a[48:51], v[88:91]
buffer_load_dwordx4 v5, s[56:59], 0 offen lds
v_mfma_f32_16x16x32_bf16 v[96:99], a[84:87], a[52:55], v[96:99]
ds_read_b64_tr_b16 a[106:107], v13 offset:1792
v_mfma_f32_16x16x32_bf16 v[96:99], a[80:83], a[36:39], v[96:99]
ds_read_b64_tr_b16 a[108:109], v13 offset:8960
v_mfma_f32_16x16x32_bf16 v[104:107], a[80:83], a[40:43], v[104:107]
ds_read_b64_tr_b16 a[110:111], v13 offset:9984
v_mfma_f32_16x16x32_bf16 v[104:107], a[84:87], a[56:59], v[104:107]
ds_read_b128 a[0:3], v8 offset:0
s_add_u32 m0, s17, 0x4000
v_mfma_f32_16x16x32_bf16 v[112:115], a[84:87], a[60:63], v[112:115]
buffer_load_dwordx4 v5, s[60:63], 0 offen lds
v_mfma_f32_16x16x32_bf16 v[112:115], a[80:83], a[44:47], v[112:115]
ds_read_b128 a[16:19], v9 offset:0
v_mfma_f32_16x16x32_bf16 v[116:119], a[88:91], a[44:47], v[116:119]
ds_read_b64_tr_b16 a[80:81], v12 offset:16384
v_mfma_f32_16x16x32_bf16 v[116:119], a[92:95], a[60:63], v[116:119]
ds_read_b64_tr_b16 a[82:83], v12 offset:17408
v_mfma_f32_16x16x32_bf16 v[108:111], a[92:95], a[56:59], v[108:111]
ds_read_b64_tr_b16 a[84:85], v12 offset:24576
s_add_u32 m0, s17, 0x400
v_mfma_f32_16x16x32_bf16 v[108:111], a[88:91], a[40:43], v[108:111]
buffer_load_dwordx4 v5, s[56:59], s13 offen lds
v_mfma_f32_16x16x32_bf16 v[100:103], a[88:91], a[36:39], v[100:103]
ds_read_b64_tr_b16 a[86:87], v12 offset:25600
v_mfma_f32_16x16x32_bf16 v[100:103], a[92:95], a[52:55], v[100:103]
ds_read_b128 a[4:7], v8 offset:2048
v_mfma_f32_16x16x32_bf16 v[92:95], a[92:95], a[48:51], v[92:95]
ds_read_b128 a[20:23], v9 offset:2048
s_waitcnt lgkmcnt(8)
v_mfma_f32_16x16x32_bf16 v[92:95], a[88:91], a[32:35], v[92:95]
ds_read_b128 a[8:11], v8 offset:4096
s_add_u32 m0, s17, 0x4400
v_mfma_f32_16x16x32_bf16 v[120:123], a[96:99], a[32:35], v[120:123]
buffer_load_dwordx4 v5, s[60:63], s13 offen lds
v_mfma_f32_16x16x32_bf16 v[120:123], a[100:103], a[48:51], v[120:123]
ds_read_b64_tr_b16 a[88:89], v13 offset:16384
v_mfma_f32_16x16x32_bf16 v[128:131], a[100:103], a[52:55], v[128:131]
ds_read_b64_tr_b16 a[90:91], v13 offset:17408
v_mfma_f32_16x16x32_bf16 v[128:131], a[96:99], a[36:39], v[128:131]
ds_read_b64_tr_b16 a[92:93], v13 offset:24576
v_mfma_f32_16x16x32_bf16 v[136:139], a[96:99], a[40:43], v[136:139]
ds_read_b64_tr_b16 a[94:95], v13 offset:25600
s_add_u32 m0, s17, 0x800
v_mfma_f32_16x16x32_bf16 v[136:139], a[100:103], a[56:59], v[136:139]
buffer_load_dwordx4 v6, s[56:59], 0 offen lds
v_mfma_f32_16x16x32_bf16 v[144:147], a[100:103], a[60:63], v[144:147]
ds_read_b128 a[24:27], v9 offset:4096
v_mfma_f32_16x16x32_bf16 v[144:147], a[96:99], a[44:47], v[144:147]
ds_read_b128 a[12:15], v8 offset:6144
v_mfma_f32_16x16x32_bf16 v[148:151], a[104:107], a[44:47], v[148:151]
ds_read_b64_tr_b16 a[96:97], v12 offset:16640
v_mfma_f32_16x16x32_bf16 v[148:151], a[108:111], a[60:63], v[148:151]
ds_read_b64_tr_b16 a[98:99], v12 offset:17664
s_add_u32 m0, s17, 0x4800
v_mfma_f32_16x16x32_bf16 v[140:143], a[108:111], a[56:59], v[140:143]
buffer_load_dwordx4 v6, s[60:63], 0 offen lds
v_mfma_f32_16x16x32_bf16 v[140:143], a[104:107], a[40:43], v[140:143]
ds_read_b64_tr_b16 a[100:101], v12 offset:24832
v_mfma_f32_16x16x32_bf16 v[132:135], a[104:107], a[36:39], v[132:135]
ds_read_b64_tr_b16 a[102:103], v12 offset:25856
v_mfma_f32_16x16x32_bf16 v[132:135], a[108:111], a[52:55], v[132:135]
ds_read_b128 a[28:31], v9 offset:6144
v_mfma_f32_16x16x32_bf16 v[124:127], a[108:111], a[48:51], v[124:127]
s_add_u32 m0, s17, 0xc00
s_waitcnt lgkmcnt(7)
v_mfma_f32_16x16x32_bf16 v[124:127], a[104:107], a[32:35], v[124:127]
buffer_load_dwordx4 v6, s[56:59], s13 offen lds
v_mfma_f32_16x16x32_bf16 v[152:155], a[32:35], a[80:83], v[152:155]
ds_read_b64_tr_b16 a[104:105], v13 offset:16640
v_mfma_f32_16x16x32_bf16 v[152:155], a[48:51], a[84:87], v[152:155]
ds_read_b64_tr_b16 a[106:107], v13 offset:17664
v_mfma_f32_16x16x32_bf16 v[156:159], a[52:55], a[84:87], v[156:159]
ds_read_b64_tr_b16 a[108:109], v13 offset:24832
v_mfma_f32_16x16x32_bf16 v[156:159], a[36:39], a[80:83], v[156:159]
ds_read_b64_tr_b16 a[110:111], v13 offset:25856
s_add_u32 m0, s17, 0x4c00
v_mfma_f32_16x16x32_bf16 v[160:163], a[40:43], a[80:83], v[160:163]
buffer_load_dwordx4 v6, s[60:63], s13 offen lds
v_mfma_f32_16x16x32_bf16 v[160:163], a[56:59], a[84:87], v[160:163]
v_lshl_add_u32 v5, s42, 19, v5
v_lshl_add_u32 v6, s42, 19, v6
v_mfma_f32_16x16x32_bf16 v[164:167], a[60:63], a[84:87], v[164:167]
v_mfma_f32_16x16x32_bf16 v[164:167], a[44:47], a[80:83], v[164:167]
v_mfma_f32_16x16x32_bf16 v[180:183], a[44:47], a[88:91], v[180:183]
ds_read_b64_tr_b16 a[80:81], v12 offset:16896
s_mov_b32 s9, 0x200000
v_mfma_f32_16x16x32_bf16 v[180:183], a[60:63], a[92:95], v[180:183]
buffer_load_dword a120, v18, s[56:59], s9 offen
v_mfma_f32_16x16x32_bf16 v[176:179], a[56:59], a[92:95], v[176:179]
ds_read_b64_tr_b16 a[82:83], v12 offset:17920
v_mfma_f32_16x16x32_bf16 v[176:179], a[40:43], a[88:91], v[176:179]
ds_read_b64_tr_b16 a[84:85], v12 offset:25088
v_mfma_f32_16x16x32_bf16 v[172:175], a[36:39], a[88:91], v[172:175]
ds_read_b64_tr_b16 a[86:87], v12 offset:26112
v_mfma_f32_16x16x32_bf16 v[172:175], a[52:55], a[92:95], v[172:175]
s_add_u32 m0, s16, 0x0
s_waitcnt lgkmcnt(8)
v_mfma_f32_16x16x32_bf16 v[168:171], a[48:51], a[92:95], v[168:171]
buffer_load_dwordx4 v2, s[48:51], 0 offen lds
v_mfma_f32_16x16x32_bf16 v[168:171], a[32:35], a[88:91], v[168:171]
s_waitcnt lgkmcnt(4)
v_mfma_f32_16x16x32_bf16 v[184:187], a[32:35], a[96:99], v[184:187]
ds_read_b64_tr_b16 a[88:89], v13 offset:16896
v_mfma_f32_16x16x32_bf16 v[184:187], a[48:51], a[100:103], v[184:187]
ds_read_b64_tr_b16 a[90:91], v13 offset:17920
v_mfma_f32_16x16x32_bf16 v[188:191], a[52:55], a[100:103], v[188:191]
ds_read_b64_tr_b16 a[92:93], v13 offset:25088
s_add_u32 m0, s16, 0x400
v_mfma_f32_16x16x32_bf16 v[188:191], a[36:39], a[96:99], v[188:191]
buffer_load_dwordx4 v3, s[48:51], 0 offen lds
v_mfma_f32_16x16x32_bf16 v[192:195], a[40:43], a[96:99], v[192:195]
ds_read_b64_tr_b16 a[94:95], v13 offset:26112
v_mfma_f32_16x16x32_bf16 v[192:195], a[56:59], a[100:103], v[192:195]
v_mfma_f32_16x16x32_bf16 v[196:199], a[60:63], a[100:103], v[196:199]
v_mfma_f32_16x16x32_bf16 v[196:199], a[44:47], a[96:99], v[196:199]
s_add_u32 m0, s16, 0x800
v_mfma_f32_16x16x32_bf16 v[212:215], a[44:47], a[104:107], v[212:215]
buffer_load_dwordx4 v2, s[48:51], s12 offen lds
v_mfma_f32_16x16x32_bf16 v[212:215], a[60:63], a[108:111], v[212:215]
ds_read_b64_tr_b16 a[96:97], v12 offset:17152
v_mfma_f32_16x16x32_bf16 v[208:211], a[56:59], a[108:111], v[208:211]
ds_read_b64_tr_b16 a[98:99], v12 offset:18176
v_mfma_f32_16x16x32_bf16 v[208:211], a[40:43], a[104:107], v[208:211]
ds_read_b64_tr_b16 a[100:101], v12 offset:25344
v_mfma_f32_16x16x32_bf16 v[204:207], a[36:39], a[104:107], v[204:207]
ds_read_b64_tr_b16 a[102:103], v12 offset:26368
s_add_u32 m0, s16, 0xc00
v_mfma_f32_16x16x32_bf16 v[204:207], a[52:55], a[108:111], v[204:207]
buffer_load_dwordx4 v3, s[48:51], s12 offen lds
v_mfma_f32_16x16x32_bf16 v[200:203], a[48:51], a[108:111], v[200:203]
v_mfma_f32_16x16x32_bf16 v[200:203], a[32:35], a[104:107], v[200:203]
s_waitcnt lgkmcnt(4)
v_mfma_f32_16x16x32_bf16 v[216:219], a[32:35], a[80:83], v[216:219]
ds_read_b64_tr_b16 a[104:105], v13 offset:17152
v_mfma_f32_16x16x32_bf16 v[216:219], a[48:51], a[84:87], v[216:219]
ds_read_b64_tr_b16 a[106:107], v13 offset:18176
s_add_u32 m0, s16, 0x1000
v_mfma_f32_16x16x32_bf16 v[220:223], a[52:55], a[84:87], v[220:223]
buffer_load_dwordx4 v2, s[48:51], s13 offen lds
v_mfma_f32_16x16x32_bf16 v[220:223], a[36:39], a[80:83], v[220:223]
ds_read_b64_tr_b16 a[108:109], v13 offset:25344
v_mfma_f32_16x16x32_bf16 v[224:227], a[40:43], a[80:83], v[224:227]
ds_read_b64_tr_b16 a[110:111], v13 offset:26368
v_add_u32 v12, 0x8000, v12
v_mfma_f32_16x16x32_bf16 v[224:227], a[56:59], a[84:87], v[224:227]
v_add_u32 v13, 0x8000, v13
v_mfma_f32_16x16x32_bf16 v[228:231], a[60:63], a[84:87], v[228:231]
s_add_u32 m0, s16, 0x1400
v_mfma_f32_16x16x32_bf16 v[228:231], a[44:47], a[80:83], v[228:231]
buffer_load_dwordx4 v3, s[48:51], s13 offen lds
v_mfma_f32_16x16x32_bf16 v[244:247], a[44:47], a[88:91], v[244:247]
s_waitcnt vmcnt(23) lgkmcnt(0)
v_mfma_f32_16x16x32_bf16 v[244:247], a[60:63], a[92:95], v[244:247]
s_barrier
v_mfma_f32_16x16x32_bf16 v[240:243], a[56:59], a[92:95], v[240:243]
ds_read_b64_tr_b16 a[80:81], v12 offset:0
v_mfma_f32_16x16x32_bf16 v[240:243], a[40:43], a[88:91], v[240:243]
ds_read_b64_tr_b16 a[82:83], v12 offset:1024
s_add_u32 m0, s16, 0x1800
v_mfma_f32_16x16x32_bf16 v[236:239], a[36:39], a[88:91], v[236:239]
buffer_load_dwordx4 v2, s[48:51], s14 offen lds
v_mfma_f32_16x16x32_bf16 v[236:239], a[52:55], a[92:95], v[236:239]
ds_read_b64_tr_b16 a[84:85], v12 offset:8192
v_mfma_f32_16x16x32_bf16 v[232:235], a[48:51], a[92:95], v[232:235]
ds_read_b64_tr_b16 a[86:87], v12 offset:9216
v_mfma_f32_16x16x32_bf16 v[232:235], a[32:35], a[88:91], v[232:235]
L_padA1:
s_cmp_eq_u32 s95, 1
s_cbranch_scc1 L_padA5
s_waitcnt lgkmcnt(4)
v_mfma_f32_16x16x32_bf16 v[248:251], a[32:35], a[96:99], v[248:251]
ds_read_b64_tr_b16 a[88:89], v13 offset:0
s_add_u32 m0, s16, 0x1c00
v_mfma_f32_16x16x32_bf16 v[248:251], a[48:51], a[100:103], v[248:251]
buffer_load_dwordx4 v3, s[48:51], s14 offen lds
v_mfma_f32_16x16x32_bf16 v[252:255], a[52:55], a[100:103], v[252:255]
ds_read_b64_tr_b16 a[90:91], v13 offset:1024
v_lshl_add_u32 v2, s42, 7, v2
v_mfma_f32_16x16x32_bf16 v[252:255], a[36:39], a[96:99], v[252:255]
ds_read_b64_tr_b16 a[92:93], v13 offset:8192
v_lshl_add_u32 v3, s42, 7, v3
v_mfma_f32_16x16x32_bf16 a[232:235], a[40:43], a[96:99], a[232:235]
ds_read_b64_tr_b16 a[94:95], v13 offset:9216
v_mfma_f32_16x16x32_bf16 a[232:235], a[56:59], a[100:103], a[232:235]
s_mov_b32 s9, 0x200000
v_mfma_f32_16x16x32_bf16 a[236:239], a[60:63], a[100:103], a[236:239]
buffer_load_dword a120, v18, s[60:63], s9 offen
v_mfma_f32_16x16x32_bf16 a[236:239], a[44:47], a[96:99], a[236:239]
v_mfma_f32_16x16x32_bf16 a[252:255], a[44:47], a[104:107], a[252:255]
ds_read_b64_tr_b16 a[96:97], v12 offset:256
v_mfma_f32_16x16x32_bf16 a[252:255], a[60:63], a[108:111], a[252:255]
ds_read_b64_tr_b16 a[98:99], v12 offset:1280
v_mfma_f32_16x16x32_bf16 a[248:251], a[56:59], a[108:111], a[248:251]
ds_read_b64_tr_b16 a[100:101], v12 offset:8448
s_add_u32 m0, s17, 0x8000
v_mfma_f32_16x16x32_bf16 a[248:251], a[40:43], a[104:107], a[248:251]
buffer_load_dwordx4 v5, s[56:59], 0 offen lds
v_mfma_f32_16x16x32_bf16 a[244:247], a[36:39], a[104:107], a[244:247]
ds_read_b64_tr_b16 a[102:103], v12 offset:9472
v_mfma_f32_16x16x32_bf16 a[244:247], a[52:55], a[108:111], a[244:247]
v_mfma_f32_16x16x32_bf16 a[240:243], a[48:51], a[108:111], a[240:243]
v_mfma_f32_16x16x32_bf16 a[240:243], a[32:35], a[104:107], a[240:243]
s_add_u32 m0, s17, 0xc000
s_waitcnt lgkmcnt(4)
L_S2:
v_mfma_f32_16x16x32_bf16 v[24:27], a[80:83], a[0:3], v[24:27]
buffer_load_dwordx4 v5, s[60:63], 0 offen lds
v_mfma_f32_16x16x32_bf16 v[24:27], a[84:87], a[16:19], v[24:27]
ds_read_b64_tr_b16 a[104:105], v13 offset:256
s_waitcnt vmcnt(20)
v_mfma_f32_16x16x32_bf16 v[32:35], a[84:87], a[20:23], v[32:35]
ds_read_b64_tr_b16 a[106:107], v13 offset:1280
v_mfma_f32_16x16x32_bf16 v[32:35], a[80:83], a[4:7], v[32:35]
ds_read_b64_tr_b16 a[108:109], v13 offset:8448
v_mfma_f32_16x16x32_bf16 v[40:43], a[80:83], a[8:11], v[40:43]
ds_read_b64_tr_b16 a[110:111], v13 offset:9472
s_add_u32 m0, s17, 0x8400
v_mfma_f32_16x16x32_bf16 v[40:43], a[84:87], a[24:27], v[40:43]
buffer_load_dwordx4 v5, s[56:59], s13 offen lds
v_mfma_f32_16x16x32_bf16 v[48:51], a[84:87], a[28:31], v[48:51]
ds_read_b128 a[32:35], v8 offset:32768
v_mfma_f32_16x16x32_bf16 v[48:51], a[80:83], a[12:15], v[48:51]
ds_read_b128 a[48:51], v9 offset:32768
v_mfma_f32_16x16x32_bf16 v[52:55], a[88:91], a[12:15], v[52:55]
ds_read_b64_tr_b16 a[80:81], v12 offset:512
v_mfma_f32_16x16x32_bf16 v[52:55], a[92:95], a[28:31], v[52:55]
ds_read_b64_tr_b16 a[82:83], v12 offset:1536
s_add_u32 m0, s17, 0xc400
v_mfma_f32_16x16x32_bf16 v[44:47], a[92:95], a[24:27], v[44:47]
buffer_load_dwordx4 v5, s[60:63], s13 offen lds
v_mfma_f32_16x16x32_bf16 v[44:47], a[88:91], a[8:11], v[44:47]
ds_read_b64_tr_b16 a[84:85], v12 offset:8704
v_mfma_f32_16x16x32_bf16 v[36:39], a[88:91], a[4:7], v[36:39]
ds_read_b64_tr_b16 a[86:87], v12 offset:9728
v_mfma_f32_16x16x32_bf16 v[36:39], a[92:95], a[20:23], v[36:39]
ds_read_b128 a[36:39], v8 offset:34816
s_waitcnt lgkmcnt(7)
v_mfma_f32_16x16x32_bf16 v[28:31], a[92:95], a[16:19], v[28:31]
ds_read_b128 a[52:55], v9 offset:34816
s_add_u32 m0, s17, 0x8800
v_mfma_f32_16x16x32_bf16 v[28:31], a[88:91], a[0:3], v[28:31]
buffer_load_dwordx4 v6, s[56:59], 0 offen lds
v_mfma_f32_16x16x32_bf16 v[56:59], a[96:99], a[0:3], v[56:59]
ds_read_b64_tr_b16 a[88:89], v13 offset:512
v_mfma_f32_16x16x32_bf16 v[56:59], a[100:103], a[16:19], v[56:59]
ds_read_b64_tr_b16 a[90:91], v13 offset:1536
v_mfma_f32_16x16x32_bf16 v[64:67], a[100:103], a[20:23], v[64:67]
ds_read_b64_tr_b16 a[92:93], v13 offset:8704
v_mfma_f32_16x16x32_bf16 v[64:67], a[96:99], a[4:7], v[64:67]
ds_read_b64_tr_b16 a[94:95], v13 offset:9728
s_add_u32 m0, s17, 0xc800
v_mfma_f32_16x16x32_bf16 v[72:75], a[96:99], a[8:11], v[72:75]
buffer_load_dwordx4 v6, s[60:63], 0 offen lds
v_mfma_f32_16x16x32_bf16 v[72:75], a[100:103], a[24:27], v[72:75]
ds_read_b128 a[40:43], v8 offset:36864
v_mfma_f32_16x16x32_bf16 v[80:83], a[100:103], a[28:31], v[80:83]
ds_read_b128 a[56:59], v9 offset:36864
v_mfma_f32_16x16x32_bf16 v[80:83], a[96:99], a[12:15], v[80:83]
ds_read_b128 a[44:47], v8 offset:38912
v_mfma_f32_16x16x32_bf16 v[84:87], a[104:107], a[12:15], v[84:87]
ds_read_b64_tr_b16 a[96:97], v12 offset:768
s_add_u32 m0, s17, 0x8c00
v_mfma_f32_16x16x32_bf16 v[84:87], a[108:111], a[28:31], v[84:87]
buffer_load_dwordx4 v6, s[56:59], s13 offen lds
v_mfma_f32_16x16x32_bf16 v[76:79], a[108:111], a[24:27], v[76:79]
ds_read_b64_tr_b16 a[98:99], v12 offset:1792
v_mfma_f32_16x16x32_bf16 v[76:79], a[104:107], a[8:11], v[76:79]
ds_read_b64_tr_b16 a[100:101], v12 offset:8960
v_mfma_f32_16x16x32_bf16 v[68:71], a[104:107], a[4:7], v[68:71]
ds_read_b64_tr_b16 a[102:103], v12 offset:9984
v_mfma_f32_16x16x32_bf16 v[68:71], a[108:111], a[20:23], v[68:71]
ds_read_b128 a[60:63], v9 offset:38912
s_add_u32 m0, s17, 0xcc00
v_mfma_f32_16x16x32_bf16 v[60:63], a[108:111], a[16:19], v[60:63]
buffer_load_dwordx4 v6, s[60:63], s13 offen lds
v_mfma_f32_16x16x32_bf16 v[60:63], a[104:107], a[0:3], v[60:63]
s_waitcnt lgkmcnt(8)
v_lshl_add_u32 v5, s42, 19, v5
v_lshl_add_u32 v6, s42, 19, v6
v_mfma_f32_16x16x32_bf16 v[88:91], a[80:83], a[0:3], v[88:91]
ds_read_b64_tr_b16 a[104:105], v13 offset:768
v_mfma_f32_16x16x32_bf16 v[88:91], a[84:87], a[16:19], v[88:91]
ds_read_b64_tr_b16 a[106:107], v13 offset:1792
v_mfma_f32_16x16x32_bf16 v[96:99], a[84:87], a[20:23], v[96:99]
ds_read_b64_tr_b16 a[108:109], v13 offset:8960
v_mfma_f32_16x16x32_bf16 v[96:99], a[80:83], a[4:7], v[96:99]
ds_read_b64_tr_b16 a[110:111], v13 offset:9984
v_mfma_f32_16x16x32_bf16 v[104:107], a[80:83], a[8:11], v[104:107]
s_add_u32 m0, s16, 0x8000
s_waitcnt lgkmcnt(4)
v_mfma_f32_16x16x32_bf16 v[104:107], a[84:87], a[24:27], v[104:107]
buffer_load_dwordx4 v2, s[48:51], 0 offen lds
v_mfma_f32_16x16x32_bf16 v[112:115], a[84:87], a[28:31], v[112:115]
v_mfma_f32_16x16x32_bf16 v[112:115], a[80:83], a[12:15], v[112:115]
v_mfma_f32_16x16x32_bf16 v[116:119], a[88:91], a[12:15], v[116:119]
ds_read_b64_tr_b16 a[80:81], v12 offset:16384
v_mfma_f32_16x16x32_bf16 v[116:119], a[92:95], a[28:31], v[116:119]
ds_read_b64_tr_b16 a[82:83], v12 offset:17408
v_mfma_f32_16x16x32_bf16 v[108:111], a[92:95], a[24:27], v[108:111]
ds_read_b64_tr_b16 a[84:85], v12 offset:24576
v_mfma_f32_16x16x32_bf16 v[108:111], a[88:91], a[8:11], v[108:111]
ds_read_b64_tr_b16 a[86:87], v12 offset:25600
s_add_u32 m0, s16, 0x8400
v_mfma_f32_16x16x32_bf16 v[100:103], a[88:91], a[4:7], v[100:103]
buffer_load_dwordx4 v3, s[48:51], 0 offen lds
v_mfma_f32_16x16x32_bf16 v[100:103], a[92:95], a[20:23], v[100:103]
v_mfma_f32_16x16x32_bf16 v[92:95], a[92:95], a[16:19], v[92:95]
v_mfma_f32_16x16x32_bf16 v[92:95], a[88:91], a[0:3], v[92:95]
s_waitcnt lgkmcnt(4)
v_mfma_f32_16x16x32_bf16 v[120:123], a[96:99], a[0:3], v[120:123]
ds_read_b64_tr_b16 a[88:89], v13 offset:16384
v_mfma_f32_16x16x32_bf16 v[120:123], a[100:103], a[16:19], v[120:123]
ds_read_b64_tr_b16 a[90:91], v13 offset:17408
v_mfma_f32_16x16x32_bf16 v[128:131], a[100:103], a[20:23], v[128:131]
ds_read_b64_tr_b16 a[92:93], v13 offset:24576
v_mfma_f32_16x16x32_bf16 v[128:131], a[96:99], a[4:7], v[128:131]
ds_read_b64_tr_b16 a[94:95], v13 offset:25600
s_add_u32 m0, s16, 0x8800
v_mfma_f32_16x16x32_bf16 v[136:139], a[96:99], a[8:11], v[136:139]
buffer_load_dwordx4 v2, s[48:51], s12 offen lds
v_mfma_f32_16x16x32_bf16 v[136:139], a[100:103], a[24:27], v[136:139]
v_mfma_f32_16x16x32_bf16 v[144:147], a[100:103], a[28:31], v[144:147]
v_mfma_f32_16x16x32_bf16 v[144:147], a[96:99], a[12:15], v[144:147]
v_mfma_f32_16x16x32_bf16 v[148:151], a[104:107], a[12:15], v[148:151]
ds_read_b64_tr_b16 a[96:97], v12 offset:16640
v_mfma_f32_16x16x32_bf16 v[148:151], a[108:111], a[28:31], v[148:151]
ds_read_b64_tr_b16 a[98:99], v12 offset:17664
v_mfma_f32_16x16x32_bf16 v[140:143], a[108:111], a[24:27], v[140:143]
ds_read_b64_tr_b16 a[100:101], v12 offset:24832
s_add_u32 m0, s16, 0x8c00
v_mfma_f32_16x16x32_bf16 v[140:143], a[104:107], a[8:11], v[140:143]
buffer_load_dwordx4 v3, s[48:51], s12 offen lds
v_mfma_f32_16x16x32_bf16 v[132:135], a[104:107], a[4:7], v[132:135]
ds_read_b64_tr_b16 a[102:103], v12 offset:25856
v_mfma_f32_16x16x32_bf16 v[132:135], a[108:111], a[20:23], v[132:135]
v_mfma_f32_16x16x32_bf16 v[124:127], a[108:111], a[16:19], v[124:127]
v_mfma_f32_16x16x32_bf16 v[124:127], a[104:107], a[0:3], v[124:127]
s_waitcnt lgkmcnt(4)
v_mfma_f32_16x16x32_bf16 v[152:155], a[0:3], a[80:83], v[152:155]
ds_read_b64_tr_b16 a[104:105], v13 offset:16640
v_mfma_f32_16x16x32_bf16 v[152:155], a[16:19], a[84:87], v[152:155]
ds_read_b64_tr_b16 a[106:107], v13 offset:17664
s_add_u32 m0, s16, 0x9000
v_mfma_f32_16x16x32_bf16 v[156:159], a[20:23], a[84:87], v[156:159]
buffer_load_dwordx4 v2, s[48:51], s13 offen lds
v_mfma_f32_16x16x32_bf16 v[156:159], a[4:7], a[80:83], v[156:159]
ds_read_b64_tr_b16 a[108:109], v13 offset:24832
v_mfma_f32_16x16x32_bf16 v[160:163], a[8:11], a[80:83], v[160:163]
ds_read_b64_tr_b16 a[110:111], v13 offset:25856
v_mfma_f32_16x16x32_bf16 v[160:163], a[24:27], a[84:87], v[160:163]
v_mfma_f32_16x16x32_bf16 v[164:167], a[28:31], a[84:87], v[164:167]
v_mfma_f32_16x16x32_bf16 v[164:167], a[12:15], a[80:83], v[164:167]
v_mfma_f32_16x16x32_bf16 v[180:183], a[12:15], a[88:91], v[180:183]
ds_read_b64_tr_b16 a[80:81], v12 offset:16896
v_mfma_f32_16x16x32_bf16 v[180:183], a[28:31], a[92:95], v[180:183]
ds_read_b64_tr_b16 a[82:83], v12 offset:17920
s_add_u32 m0, s16, 0x9400
v_mfma_f32_16x16x32_bf16 v[176:179], a[24:27], a[92:95], v[176:179]
buffer_load_dwordx4 v3, s[48:51], s13 offen lds
v_mfma_f32_16x16x32_bf16 v[176:179], a[8:11], a[88:91], v[176:179]
ds_read_b64_tr_b16 a[84:85], v12 offset:25088
v_mfma_f32_16x16x32_bf16 v[172:175], a[4:7], a[88:91], v[172:175]
ds_read_b64_tr_b16 a[86:87], v12 offset:26112
v_mfma_f32_16x16x32_bf16 v[172:175], a[20:23], a[92:95], v[172:175]
v_mfma_f32_16x16x32_bf16 v[168:171], a[16:19], a[92:95], v[168:171]
v_mfma_f32_16x16x32_bf16 v[168:171], a[0:3], a[88:91], v[168:171]
s_waitcnt lgkmcnt(4)
v_mfma_f32_16x16x32_bf16 v[184:187], a[0:3], a[96:99], v[184:187]
ds_read_b64_tr_b16 a[88:89], v13 offset:16896
s_add_u32 m0, s16, 0x9800
v_mfma_f32_16x16x32_bf16 v[184:187], a[16:19], a[100:103], v[184:187]
buffer_load_dwordx4 v2, s[48:51], s14 offen lds
v_mfma_f32_16x16x32_bf16 v[188:191], a[20:23], a[100:103], v[188:191]
ds_read_b64_tr_b16 a[90:91], v13 offset:17920
v_mfma_f32_16x16x32_bf16 v[188:191], a[4:7], a[96:99], v[188:191]
ds_read_b64_tr_b16 a[92:93], v13 offset:25088
v_mfma_f32_16x16x32_bf16 v[192:195], a[8:11], a[96:99], v[192:195]
ds_read_b64_tr_b16 a[94:95], v13 offset:26112
v_mfma_f32_16x16x32_bf16 v[192:195], a[24:27], a[100:103], v[192:195]
v_mfma_f32_16x16x32_bf16 v[196:199], a[28:31], a[100:103], v[196:199]
v_mfma_f32_16x16x32_bf16 v[196:199], a[12:15], a[96:99], v[196:199]
v_mfma_f32_16x16x32_bf16 v[212:215], a[12:15], a[104:107], v[212:215]
ds_read_b64_tr_b16 a[96:97], v12 offset:17152
s_add_u32 m0, s16, 0x9c00
v_mfma_f32_16x16x32_bf16 v[212:215], a[28:31], a[108:111], v[212:215]
buffer_load_dwordx4 v3, s[48:51], s14 offen lds
v_mfma_f32_16x16x32_bf16 v[208:211], a[24:27], a[108:111], v[208:211]
ds_read_b64_tr_b16 a[98:99], v12 offset:18176
v_lshl_add_u32 v2, s42, 7, v2
v_mfma_f32_16x16x32_bf16 v[208:211], a[8:11], a[104:107], v[208:211]
ds_read_b64_tr_b16 a[100:101], v12 offset:25344
v_lshl_add_u32 v3, s42, 7, v3
v_mfma_f32_16x16x32_bf16 v[204:207], a[4:7], a[104:107], v[204:207]
ds_read_b64_tr_b16 a[102:103], v12 offset:26368
v_mfma_f32_16x16x32_bf16 v[204:207], a[20:23], a[108:111], v[204:207]
v_mfma_f32_16x16x32_bf16 v[200:203], a[16:19], a[108:111], v[200:203]
v_mfma_f32_16x16x32_bf16 v[200:203], a[0:3], a[104:107], v[200:203]
s_mov_b32 s9, 0x0
s_waitcnt lgkmcnt(4)
v_mfma_f32_16x16x32_bf16 v[216:219], a[0:3], a[80:83], v[216:219]
buffer_load_dword a120, v19, s[44:47], s9 offen
v_mfma_f32_16x16x32_bf16 v[216:219], a[16:19], a[84:87], v[216:219]
ds_read_b64_tr_b16 a[104:105], v13 offset:17152
v_mfma_f32_16x16x32_bf16 v[220:223], a[20:23], a[84:87], v[220:223]
ds_read_b64_tr_b16 a[106:107], v13 offset:18176
v_mfma_f32_16x16x32_bf16 v[220:223], a[4:7], a[80:83], v[220:223]
ds_read_b64_tr_b16 a[108:109], v13 offset:25344
v_mfma_f32_16x16x32_bf16 v[224:227], a[8:11], a[80:83], v[224:227]
ds_read_b64_tr_b16 a[110:111], v13 offset:26368
v_add_u32 v12, 0xffff0000, v12
v_mfma_f32_16x16x32_bf16 v[224:227], a[24:27], a[84:87], v[224:227]
v_add_u32 v13, 0xffff0000, v13
v_mfma_f32_16x16x32_bf16 v[228:231], a[28:31], a[84:87], v[228:231]
v_mfma_f32_16x16x32_bf16 v[228:231], a[12:15], a[80:83], v[228:231]
v_mfma_f32_16x16x32_bf16 v[244:247], a[12:15], a[88:91], v[244:247]
s_waitcnt vmcnt(27) lgkmcnt(0)
v_mfma_f32_16x16x32_bf16 v[244:247], a[28:31], a[92:95], v[244:247]
s_barrier
s_add_u32 m0, s17, 0x10000
v_mfma_f32_16x16x32_bf16 v[240:243], a[24:27], a[92:95], v[240:243]
buffer_load_dwordx4 v5, s[56:59], 0 offen lds
v_mfma_f32_16x16x32_bf16 v[240:243], a[8:11], a[88:91], v[240:243]
ds_read_b64_tr_b16 a[80:81], v12 offset:0
v_mfma_f32_16x16x32_bf16 v[236:239], a[4:7], a[88:91], v[236:239]
ds_read_b64_tr_b16 a[82:83], v12 offset:1024
v_mfma_f32_16x16x32_bf16 v[236:239], a[20:23], a[92:95], v[236:239]
ds_read_b64_tr_b16 a[84:85], v12 offset:8192
v_mfma_f32_16x16x32_bf16 v[232:235], a[16:19], a[92:95], v[232:235]
ds_read_b64_tr_b16 a[86:87], v12 offset:9216
v_mfma_f32_16x16x32_bf16 v[232:235], a[0:3], a[88:91], v[232:235]
s_waitcnt lgkmcnt(4)
v_mfma_f32_16x16x32_bf16 v[248:251], a[0:3], a[96:99], v[248:251]
ds_read_b64_tr_b16 a[88:89], v13 offset:0
s_add_u32 m0, s17, 0x14000
v_mfma_f32_16x16x32_bf16 v[248:251], a[16:19], a[100:103], v[248:251]
buffer_load_dwordx4 v5, s[60:63], 0 offen lds
v_mfma_f32_16x16x32_bf16 v[252:255], a[20:23], a[100:103], v[252:255]
ds_read_b64_tr_b16 a[90:91], v13 offset:1024
v_mfma_f32_16x16x32_bf16 v[252:255], a[4:7], a[96:99], v[252:255]
ds_read_b64_tr_b16 a[92:93], v13 offset:8192
v_mfma_f32_16x16x32_bf16 a[232:235], a[8:11], a[96:99], a[232:235]
ds_read_b64_tr_b16 a[94:95], v13 offset:9216
v_mfma_f32_16x16x32_bf16 a[232:235], a[24:27], a[100:103], a[232:235]
v_mfma_f32_16x16x32_bf16 a[236:239], a[28:31], a[100:103], a[236:239]
v_mfma_f32_16x16x32_bf16 a[236:239], a[12:15], a[96:99], a[236:239]
s_add_u32 m0, s17, 0x10400
v_mfma_f32_16x16x32_bf16 a[252:255], a[12:15], a[104:107], a[252:255]
buffer_load_dwordx4 v5, s[56:59], s13 offen lds
v_mfma_f32_16x16x32_bf16 a[252:255], a[28:31], a[108:111], a[252:255]
ds_read_b64_tr_b16 a[96:97], v12 offset:256
v_mfma_f32_16x16x32_bf16 a[248:251], a[24:27], a[108:111], a[248:251]
ds_read_b64_tr_b16 a[98:99], v12 offset:1280
v_mfma_f32_16x16x32_bf16 a[248:251], a[8:11], a[104:107], a[248:251]
ds_read_b64_tr_b16 a[100:101], v12 offset:8448
v_mfma_f32_16x16x32_bf16 a[244:247], a[4:7], a[104:107], a[244:247]
ds_read_b64_tr_b16 a[102:103], v12 offset:9472
v_mfma_f32_16x16x32_bf16 a[244:247], a[20:23], a[108:111], a[244:247]
v_mfma_f32_16x16x32_bf16 a[240:243], a[16:19], a[108:111], a[240:243]
s_add_u32 m0, s17, 0x14400
s_waitcnt lgkmcnt(4)
v_mfma_f32_16x16x32_bf16 a[240:243], a[0:3], a[104:107], a[240:243]
buffer_load_dwordx4 v5, s[60:63], s13 offen lds
L_S3:
v_mfma_f32_16x16x32_bf16 v[24:27], a[80:83], a[32:35], v[24:27]
ds_read_b64_tr_b16 a[104:105], v13 offset:256
s_waitcnt vmcnt(22)
v_mfma_f32_16x16x32_bf16 v[24:27], a[84:87], a[48:51], v[24:27]
ds_read_b64_tr_b16 a[106:107], v13 offset:1280
v_mfma_f32_16x16x32_bf16 v[32:35], a[84:87], a[52:55], v[32:35]
ds_read_b64_tr_b16 a[108:109], v13 offset:8448
v_mfma_f32_16x16x32_bf16 v[32:35], a[80:83], a[36:39], v[32:35]
ds_read_b64_tr_b16 a[110:111], v13 offset:9472
v_mfma_f32_16x16x32_bf16 v[40:43], a[80:83], a[40:43], v[40:43]
ds_read_b128 a[0:3], v8 offset:0
v_mfma_f32_16x16x32_bf16 v[40:43], a[84:87], a[56:59], v[40:43]
ds_read_b128 a[16:19], v9 offset:0
s_add_u32 m0, s17, 0x10800
v_mfma_f32_16x16x32_bf16 v[48:51], a[84:87], a[60:63], v[48:51]
buffer_load_dwordx4 v6, s[56:59], 0 offen lds
v_mfma_f32_16x16x32_bf16 v[48:51], a[80:83], a[44:47], v[48:51]
ds_read_b128 a[4:7], v8 offset:2048
v_mfma_f32_16x16x32_bf16 v[52:55], a[88:91], a[44:47], v[52:55]
ds_read_b64_tr_b16 a[80:81], v12 offset:512
v_mfma_f32_16x16x32_bf16 v[52:55], a[92:95], a[60:63], v[52:55]
ds_read_b64_tr_b16 a[82:83], v12 offset:1536
v_mfma_f32_16x16x32_bf16 v[44:47], a[92:95], a[56:59], v[44:47]
ds_read_b64_tr_b16 a[84:85], v12 offset:8704
v_mfma_f32_16x16x32_bf16 v[44:47], a[88:91], a[40:43], v[44:47]
ds_read_b64_tr_b16 a[86:87], v12 offset:9728
v_mfma_f32_16x16x32_bf16 v[36:39], a[88:91], a[36:39], v[36:39]
ds_read_b128 a[20:23], v9 offset:2048
s_add_u32 m0, s17, 0x14800
v_mfma_f32_16x16x32_bf16 v[36:39], a[92:95], a[52:55], v[36:39]
buffer_load_dwordx4 v6, s[60:63], 0 offen lds
v_mfma_f32_16x16x32_bf16 v[28:31], a[92:95], a[48:51], v[28:31]
ds_read_b128 a[8:11], v8 offset:4096
v_mfma_f32_16x16x32_bf16 v[28:31], a[88:91], a[32:35], v[28:31]
ds_read_b128 a[24:27], v9 offset:4096
s_waitcnt lgkmcnt(10)
v_mfma_f32_16x16x32_bf16 v[56:59], a[96:99], a[32:35], v[56:59]
ds_read_b64_tr_b16 a[88:89], v13 offset:512
v_mfma_f32_16x16x32_bf16 v[56:59], a[100:103], a[48:51], v[56:59]
ds_read_b64_tr_b16 a[90:91], v13 offset:1536
v_mfma_f32_16x16x32_bf16 v[64:67], a[100:103], a[52:55], v[64:67]
ds_read_b64_tr_b16 a[92:93], v13 offset:8704
v_mfma_f32_16x16x32_bf16 v[64:67], a[96:99], a[36:39], v[64:67]
ds_read_b64_tr_b16 a[94:95], v13 offset:9728
s_add_u32 m0, s17, 0x10c00
v_mfma_f32_16x16x32_bf16 v[72:75], a[96:99], a[40:43], v[72:75]
buffer_load_dwordx4 v6, s[56:59], s13 offen lds
v_mfma_f32_16x16x32_bf16 v[72:75], a[100:103], a[56:59], v[72:75]
ds_read_b128 a[12:15], v8 offset:6144
v_mfma_f32_16x16x32_bf16 v[80:83], a[100:103], a[60:63], v[80:83]
ds_read_b128 a[28:31], v9 offset:6144
v_mfma_f32_16x16x32_bf16 v[80:83], a[96:99], a[44:47], v[80:83]
v_mfma_f32_16x16x32_bf16 v[84:87], a[104:107], a[44:47], v[84:87]
ds_read_b64_tr_b16 a[96:97], v12 offset:768
v_mfma_f32_16x16x32_bf16 v[84:87], a[108:111], a[60:63], v[84:87]
ds_read_b64_tr_b16 a[98:99], v12 offset:1792
v_mfma_f32_16x16x32_bf16 v[76:79], a[108:111], a[56:59], v[76:79]
ds_read_b64_tr_b16 a[100:101], v12 offset:8960
s_add_u32 m0, s17, 0x14c00
v_mfma_f32_16x16x32_bf16 v[76:79], a[104:107], a[40:43], v[76:79]
buffer_load_dwordx4 v6, s[60:63], s13 offen lds
v_mfma_f32_16x16x32_bf16 v[68:71], a[104:107], a[36:39], v[68:71]
ds_read_b64_tr_b16 a[102:103], v12 offset:9984
v_lshl_add_u32 v5, s42, 19, v5
v_mfma_f32_16x16x32_bf16 v[68:71], a[108:111], a[52:55], v[68:71]
v_lshl_add_u32 v6, s42, 19, v6
v_mfma_f32_16x16x32_bf16 v[60:63], a[108:111], a[48:51], v[60:63]
v_mfma_f32_16x16x32_bf16 v[60:63], a[104:107], a[32:35], v[60:63]
s_waitcnt lgkmcnt(6)
v_mfma_f32_16x16x32_bf16 v[88:91], a[80:83], a[32:35], v[88:91]
ds_read_b64_tr_b16 a[104:105], v13 offset:768
v_mfma_f32_16x16x32_bf16 v[88:91], a[84:87], a[48:51], v[88:91]
ds_read_b64_tr_b16 a[106:107], v13 offset:1792
s_mov_b32 s9, 0x200000
v_mfma_f32_16x16x32_bf16 v[96:99], a[84:87], a[52:55], v[96:99]
buffer_load_dword a120, v19, s[44:47], s9 offen
v_mfma_f32_16x16x32_bf16 v[96:99], a[80:83], a[36:39], v[96:99]
ds_read_b64_tr_b16 a[108:109], v13 offset:8960
v_mfma_f32_16x16x32_bf16 v[104:107], a[80:83], a[40:43], v[104:107]
ds_read_b64_tr_b16 a[110:111], v13 offset:9984
v_mfma_f32_16x16x32_bf16 v[104:107], a[84:87], a[56:59], v[104:107]
v_mfma_f32_16x16x32_bf16 v[112:115], a[84:87], a[60:63], v[112:115]
v_mfma_f32_16x16x32_bf16 v[112:115], a[80:83], a[44:47], v[112:115]
s_waitcnt lgkmcnt(8)
v_mfma_f32_16x16x32_bf16 v[116:119], a[88:91], a[44:47], v[116:119]
ds_read_b64_tr_b16 a[80:81], v12 offset:16384
s_add_u32 m0, s16, 0x0
v_mfma_f32_16x16x32_bf16 v[116:119], a[92:95], a[60:63], v[116:119]
buffer_load_dwordx4 v2, s[48:51], 0 offen lds
v_mfma_f32_16x16x32_bf16 v[108:111], a[92:95], a[56:59], v[108:111]
ds_read_b64_tr_b16 a[82:83], v12 offset:17408
v_mfma_f32_16x16x32_bf16 v[108:111], a[88:91], a[40:43], v[108:111]
ds_read_b64_tr_b16 a[84:85], v12 offset:24576
v_mfma_f32_16x16x32_bf16 v[100:103], a[88:91], a[36:39], v[100:103]
ds_read_b64_tr_b16 a[86:87], v12 offset:25600
v_mfma_f32_16x16x32_bf16 v[100:103], a[92:95], a[52:55], v[100:103]
v_mfma_f32_16x16x32_bf16 v[92:95], a[92:95], a[48:51], v[92:95]
v_mfma_f32_16x16x32_bf16 v[92:95], a[88:91], a[32:35], v[92:95]
s_add_u32 m0, s16, 0x400
s_waitcnt lgkmcnt(4)
v_mfma_f32_16x16x32_bf16 v[120:123], a[96:99], a[32:35], v[120:123]
buffer_load_dwordx4 v3, s[48:51], 0 offen lds
v_mfma_f32_16x16x32_bf16 v[120:123], a[100:103], a[48:51], v[120:123]
ds_read_b64_tr_b16 a[88:89], v13 offset:16384
v_mfma_f32_16x16x32_bf16 v[128:131], a[100:103], a[52:55], v[128:131]
ds_read_b64_tr_b16 a[90:91], v13 offset:17408
v_mfma_f32_16x16x32_bf16 v[128:131], a[96:99], a[36:39], v[128:131]
ds_read_b64_tr_b16 a[92:93], v13 offset:24576
v_mfma_f32_16x16x32_bf16 v[136:139], a[96:99], a[40:43], v[136:139]
ds_read_b64_tr_b16 a[94:95], v13 offset:25600
v_mfma_f32_16x16x32_bf16 v[136:139], a[100:103], a[56:59], v[136:139]
v_mfma_f32_16x16x32_bf16 v[144:147], a[100:103], a[60:63], v[144:147]
s_add_u32 m0, s16, 0x800
v_mfma_f32_16x16x32_bf16 v[144:147], a[96:99], a[44:47], v[144:147]
buffer_load_dwordx4 v2, s[48:51], s12 offen lds
v_mfma_f32_16x16x32_bf16 v[148:151], a[104:107], a[44:47], v[148:151]
ds_read_b64_tr_b16 a[96:97], v12 offset:16640
v_mfma_f32_16x16x32_bf16 v[148:151], a[108:111], a[60:63], v[148:151]
ds_read_b64_tr_b16 a[98:99], v12 offset:17664
v_mfma_f32_16x16x32_bf16 v[140:143], a[108:111], a[56:59], v[140:143]
ds_read_b64_tr_b16 a[100:101], v12 offset:24832
v_mfma_f32_16x16x32_bf16 v[140:143], a[104:107], a[40:43], v[140:143]
ds_read_b64_tr_b16 a[102:103], v12 offset:25856
v_mfma_f32_16x16x32_bf16 v[132:135], a[104:107], a[36:39], v[132:135]
v_mfma_f32_16x16x32_bf16 v[132:135], a[108:111], a[52:55], v[132:135]
s_add_u32 m0, s16, 0xc00
v_mfma_f32_16x16x32_bf16 v[124:127], a[108:111], a[48:51], v[124:127]
buffer_load_dwordx4 v3, s[48:51], s12 offen lds
v_mfma_f32_16x16x32_bf16 v[124:127], a[104:107], a[32:35], v[124:127]
s_waitcnt lgkmcnt(4)
v_mfma_f32_16x16x32_bf16 v[152:155], a[32:35], a[80:83], v[152:155]
ds_read_b64_tr_b16 a[104:105], v13 offset:16640
v_mfma_f32_16x16x32_bf16 v[152:155], a[48:51], a[84:87], v[152:155]
ds_read_b64_tr_b16 a[106:107], v13 offset:17664
v_mfma_f32_16x16x32_bf16 v[156:159], a[52:55], a[84:87], v[156:159]
ds_read_b64_tr_b16 a[108:109], v13 offset:24832
v_mfma_f32_16x16x32_bf16 v[156:159], a[36:39], a[80:83], v[156:159]
ds_read_b64_tr_b16 a[110:111], v13 offset:25856
v_mfma_f32_16x16x32_bf16 v[160:163], a[40:43], a[80:83], v[160:163]
s_add_u32 m0, s16, 0x1000
v_mfma_f32_16x16x32_bf16 v[160:163], a[56:59], a[84:87], v[160:163]
buffer_load_dwordx4 v2, s[48:51], s13 offen lds
v_mfma_f32_16x16x32_bf16 v[164:167], a[60:63], a[84:87], v[164:167]
v_mfma_f32_16x16x32_bf16 v[164:167], a[44:47], a[80:83], v[164:167]
v_mfma_f32_16x16x32_bf16 v[180:183], a[44:47], a[88:91], v[180:183]
ds_read_b64_tr_b16 a[80:81], v12 offset:16896
v_mfma_f32_16x16x32_bf16 v[180:183], a[60:63], a[92:95], v[180:183]
ds_read_b64_tr_b16 a[82:83], v12 offset:17920
v_mfma_f32_16x16x32_bf16 v[176:179], a[56:59], a[92:95], v[176:179]
ds_read_b64_tr_b16 a[84:85], v12 offset:25088
v_mfma_f32_16x16x32_bf16 v[176:179], a[40:43], a[88:91], v[176:179]
ds_read_b64_tr_b16 a[86:87], v12 offset:26112
s_add_u32 m0, s16, 0x1400
v_mfma_f32_16x16x32_bf16 v[172:175], a[36:39], a[88:91], v[172:175]
buffer_load_dwordx4 v3, s[48:51], s13 offen lds
v_mfma_f32_16x16x32_bf16 v[172:175], a[52:55], a[92:95], v[172:175]
v_mfma_f32_16x16x32_bf16 v[168:171], a[48:51], a[92:95], v[168:171]
v_mfma_f32_16x16x32_bf16 v[168:171], a[32:35], a[88:91], v[168:171]
s_waitcnt lgkmcnt(4)
v_mfma_f32_16x16x32_bf16 v[184:187], a[32:35], a[96:99], v[184:187]
ds_read_b64_tr_b16 a[88:89], v13 offset:16896
v_mfma_f32_16x16x32_bf16 v[184:187], a[48:51], a[100:103], v[184:187]
ds_read_b64_tr_b16 a[90:91], v13 offset:17920
v_mfma_f32_16x16x32_bf16 v[188:191], a[52:55], a[100:103], v[188:191]
ds_read_b64_tr_b16 a[92:93], v13 offset:25088
s_add_u32 m0, s16, 0x1800
v_mfma_f32_16x16x32_bf16 v[188:191], a[36:39], a[96:99], v[188:191]
buffer_load_dwordx4 v2, s[48:51], s14 offen lds
v_mfma_f32_16x16x32_bf16 v[192:195], a[40:43], a[96:99], v[192:195]
ds_read_b64_tr_b16 a[94:95], v13 offset:26112
v_mfma_f32_16x16x32_bf16 v[192:195], a[56:59], a[100:103], v[192:195]
v_mfma_f32_16x16x32_bf16 v[196:199], a[60:63], a[100:103], v[196:199]
v_mfma_f32_16x16x32_bf16 v[196:199], a[44:47], a[96:99], v[196:199]
v_mfma_f32_16x16x32_bf16 v[212:215], a[44:47], a[104:107], v[212:215]
ds_read_b64_tr_b16 a[96:97], v12 offset:17152
v_mfma_f32_16x16x32_bf16 v[212:215], a[60:63], a[108:111], v[212:215]
ds_read_b64_tr_b16 a[98:99], v12 offset:18176
s_add_u32 m0, s16, 0x1c00
v_mfma_f32_16x16x32_bf16 v[208:211], a[56:59], a[108:111], v[208:211]
buffer_load_dwordx4 v3, s[48:51], s14 offen lds
v_mfma_f32_16x16x32_bf16 v[208:211], a[40:43], a[104:107], v[208:211]
ds_read_b64_tr_b16 a[100:101], v12 offset:25344
v_lshl_add_u32 v2, s42, 7, v2
v_mfma_f32_16x16x32_bf16 v[204:207], a[36:39], a[104:107], v[204:207]
ds_read_b64_tr_b16 a[102:103], v12 offset:26368
v_lshl_add_u32 v3, s42, 7, v3
v_mfma_f32_16x16x32_bf16 v[204:207], a[52:55], a[108:111], v[204:207]
v_mfma_f32_16x16x32_bf16 v[200:203], a[48:51], a[108:111], v[200:203]
v_mfma_f32_16x16x32_bf16 v[200:203], a[32:35], a[104:107], v[200:203]
s_waitcnt lgkmcnt(4)
v_mfma_f32_16x16x32_bf16 v[216:219], a[32:35], a[80:83], v[216:219]
ds_read_b64_tr_b16 a[104:105], v13 offset:17152
s_mov_b32 s9, 0x0
v_mfma_f32_16x16x32_bf16 v[216:219], a[48:51], a[84:87], v[216:219]
buffer_load_dword a120, v18, s[52:55], s9 offen
v_mfma_f32_16x16x32_bf16 v[220:223], a[52:55], a[84:87], v[220:223]
ds_read_b64_tr_b16 a[106:107], v13 offset:18176
v_mfma_f32_16x16x32_bf16 v[220:223], a[36:39], a[80:83], v[220:223]
ds_read_b64_tr_b16 a[108:109], v13 offset:25344
v_mfma_f32_16x16x32_bf16 v[224:227], a[40:43], a[80:83], v[224:227]
ds_read_b64_tr_b16 a[110:111], v13 offset:26368
v_add_u32 v12, 0x8000, v12
v_mfma_f32_16x16x32_bf16 v[224:227], a[56:59], a[84:87], v[224:227]
v_add_u32 v13, 0x8000, v13
v_mfma_f32_16x16x32_bf16 v[228:231], a[60:63], a[84:87], v[228:231]
v_mfma_f32_16x16x32_bf16 v[228:231], a[44:47], a[80:83], v[228:231]
v_mfma_f32_16x16x32_bf16 v[244:247], a[44:47], a[88:91], v[244:247]
s_waitcnt vmcnt(27) lgkmcnt(0)
v_mfma_f32_16x16x32_bf16 v[244:247], a[60:63], a[92:95], v[244:247]
s_barrier
s_add_u32 m0, s17, 0x0
v_mfma_f32_16x16x32_bf16 v[240:243], a[56:59], a[92:95], v[240:243]
buffer_load_dwordx4 v5, s[56:59], 0 offen lds
v_mfma_f32_16x16x32_bf16 v[240:243], a[40:43], a[88:91], v[240:243]
ds_read_b64_tr_b16 a[80:81], v12 offset:0
v_mfma_f32_16x16x32_bf16 v[236:239], a[36:39], a[88:91], v[236:239]
ds_read_b64_tr_b16 a[82:83], v12 offset:1024
v_mfma_f32_16x16x32_bf16 v[236:239], a[52:55], a[92:95], v[236:239]
ds_read_b64_tr_b16 a[84:85], v12 offset:8192
v_mfma_f32_16x16x32_bf16 v[232:235], a[48:51], a[92:95], v[232:235]
ds_read_b64_tr_b16 a[86:87], v12 offset:9216
v_mfma_f32_16x16x32_bf16 v[232:235], a[32:35], a[88:91], v[232:235]
s_waitcnt lgkmcnt(4)
v_mfma_f32_16x16x32_bf16 v[248:251], a[32:35], a[96:99], v[248:251]
ds_read_b64_tr_b16 a[88:89], v13 offset:0
s_add_u32 m0, s17, 0x4000
v_mfma_f32_16x16x32_bf16 v[248:251], a[48:51], a[100:103], v[248:251]
buffer_load_dwordx4 v5, s[60:63], 0 offen lds
v_mfma_f32_16x16x32_bf16 v[252:255], a[52:55], a[100:103], v[252:255]
ds_read_b64_tr_b16 a[90:91], v13 offset:1024
v_mfma_f32_16x16x32_bf16 v[252:255], a[36:39], a[96:99], v[252:255]
ds_read_b64_tr_b16 a[92:93], v13 offset:8192
v_mfma_f32_16x16x32_bf16 a[232:235], a[40:43], a[96:99], a[232:235]
ds_read_b64_tr_b16 a[94:95], v13 offset:9216
v_mfma_f32_16x16x32_bf16 a[232:235], a[56:59], a[100:103], a[232:235]
L_padA2:
s_cmp_eq_u32 s95, 1
s_cbranch_scc1 L_padA6
v_mfma_f32_16x16x32_bf16 a[236:239], a[60:63], a[100:103], a[236:239]
v_mfma_f32_16x16x32_bf16 a[236:239], a[44:47], a[96:99], a[236:239]
s_add_u32 m0, s17, 0x400
v_mfma_f32_16x16x32_bf16 a[252:255], a[44:47], a[104:107], a[252:255]
buffer_load_dwordx4 v5, s[56:59], s13 offen lds
v_mfma_f32_16x16x32_bf16 a[252:255], a[60:63], a[108:111], a[252:255]
ds_read_b64_tr_b16 a[96:97], v12 offset:256
v_mfma_f32_16x16x32_bf16 a[248:251], a[56:59], a[108:111], a[248:251]
ds_read_b64_tr_b16 a[98:99], v12 offset:1280
v_mfma_f32_16x16x32_bf16 a[248:251], a[40:43], a[104:107], a[248:251]
ds_read_b64_tr_b16 a[100:101], v12 offset:8448
v_mfma_f32_16x16x32_bf16 a[244:247], a[36:39], a[104:107], a[244:247]
ds_read_b64_tr_b16 a[102:103], v12 offset:9472
v_mfma_f32_16x16x32_bf16 a[244:247], a[52:55], a[108:111], a[244:247]
v_mfma_f32_16x16x32_bf16 a[240:243], a[48:51], a[108:111], a[240:243]
v_mfma_f32_16x16x32_bf16 a[240:243], a[32:35], a[104:107], a[240:243]
s_add_u32 m0, s17, 0x4400
s_waitcnt lgkmcnt(4)
L_S4:
v_mfma_f32_16x16x32_bf16 v[24:27], a[80:83], a[0:3], v[24:27]
buffer_load_dwordx4 v5, s[60:63], s13 offen lds
v_mfma_f32_16x16x32_bf16 v[24:27], a[84:87], a[16:19], v[24:27]
ds_read_b64_tr_b16 a[104:105], v13 offset:256
s_waitcnt vmcnt(23)
v_mfma_f32_16x16x32_bf16 v[32:35], a[84:87], a[20:23], v[32:35]
ds_read_b64_tr_b16 a[106:107], v13 offset:1280
v_mfma_f32_16x16x32_bf16 v[32:35], a[80:83], a[4:7], v[32:35]
ds_read_b64_tr_b16 a[108:109], v13 offset:8448
v_mfma_f32_16x16x32_bf16 v[40:43], a[80:83], a[8:11], v[40:43]
ds_read_b64_tr_b16 a[110:111], v13 offset:9472
v_mfma_f32_16x16x32_bf16 v[40:43], a[84:87], a[24:27], v[40:43]
ds_read_b128 a[32:35], v8 offset:32768
v_mfma_f32_16x16x32_bf16 v[48:51], a[84:87], a[28:31], v[48:51]
ds_read_b128 a[48:51], v9 offset:32768
s_add_u32 m0, s17, 0x800
v_mfma_f32_16x16x32_bf16 v[48:51], a[80:83], a[12:15], v[48:51]
buffer_load_dwordx4 v6, s[56:59], 0 offen lds
v_mfma_f32_16x16x32_bf16 v[52:55], a[88:91], a[12:15], v[52:55]
ds_read_b64_tr_b16 a[80:81], v12 offset:512
v_mfma_f32_16x16x32_bf16 v[52:55], a[92:95], a[28:31], v[52:55]
ds_read_b64_tr_b16 a[82:83], v12 offset:1536
v_mfma_f32_16x16x32_bf16 v[44:47], a[92:95], a[24:27], v[44:47]
ds_read_b64_tr_b16 a[84:85], v12 offset:8704
v_mfma_f32_16x16x32_bf16 v[44:47], a[88:91], a[8:11], v[44:47]
ds_read_b64_tr_b16 a[86:87], v12 offset:9728
v_mfma_f32_16x16x32_bf16 v[36:39], a[88:91], a[4:7], v[36:39]
ds_read_b128 a[36:39], v8 offset:34816
v_mfma_f32_16x16x32_bf16 v[36:39], a[92:95], a[20:23], v[36:39]
ds_read_b128 a[52:55], v9 offset:34816
s_waitcnt lgkmcnt(8)
v_mfma_f32_16x16x32_bf16 v[28:31], a[92:95], a[16:19], v[28:31]
ds_read_b128 a[40:43], v8 offset:36864
s_add_u32 m0, s17, 0x4800
v_mfma_f32_16x16x32_bf16 v[28:31], a[88:91], a[0:3], v[28:31]
buffer_load_dwordx4 v6, s[60:63], 0 offen lds
v_mfma_f32_16x16x32_bf16 v[56:59], a[96:99], a[0:3], v[56:59]
ds_read_b64_tr_b16 a[88:89], v13 offset:512
v_mfma_f32_16x16x32_bf16 v[56:59], a[100:103], a[16:19], v[56:59]
ds_read_b64_tr_b16 a[90:91], v13 offset:1536
v_mfma_f32_16x16x32_bf16 v[64:67], a[100:103], a[20:23], v[64:67]
ds_read_b64_tr_b16 a[92:93], v13 offset:8704
v_mfma_f32_16x16x32_bf16 v[64:67], a[96:99], a[4:7], v[64:67]
ds_read_b64_tr_b16 a[94:95], v13 offset:9728
v_mfma_f32_16x16x32_bf16 v[72:75], a[96:99], a[8:11], v[72:75]
ds_read_b128 a[56:59], v9 offset:36864
v_mfma_f32_16x16x32_bf16 v[72:75], a[100:103], a[24:27], v[72:75]
ds_read_b128 a[44:47], v8 offset:38912
s_add_u32 m0, s17, 0xc00
v_mfma_f32_16x16x32_bf16 v[80:83], a[100:103], a[28:31], v[80:83]
buffer_load_dwordx4 v6, s[56:59], s13 offen lds
v_mfma_f32_16x16x32_bf16 v[80:83], a[96:99], a[12:15], v[80:83]
ds_read_b128 a[60:63], v9 offset:38912
v_mfma_f32_16x16x32_bf16 v[84:87], a[104:107], a[12:15], v[84:87]
ds_read_b64_tr_b16 a[96:97], v12 offset:768
v_mfma_f32_16x16x32_bf16 v[84:87], a[108:111], a[28:31], v[84:87]
ds_read_b64_tr_b16 a[98:99], v12 offset:1792
v_mfma_f32_16x16x32_bf16 v[76:79], a[108:111], a[24:27], v[76:79]
ds_read_b64_tr_b16 a[100:101], v12 offset:8960
v_mfma_f32_16x16x32_bf16 v[76:79], a[104:107], a[8:11], v[76:79]
ds_read_b64_tr_b16 a[102:103], v12 offset:9984
v_mfma_f32_16x16x32_bf16 v[68:71], a[104:107], a[4:7], v[68:71]
s_add_u32 m0, s17, 0x4c00
v_mfma_f32_16x16x32_bf16 v[68:71], a[108:111], a[20:23], v[68:71]
buffer_load_dwordx4 v6, s[60:63], s13 offen lds
v_mfma_f32_16x16x32_bf16 v[60:63], a[108:111], a[16:19], v[60:63]
v_lshl_add_u32 v5, s42, 19, v5
v_lshl_add_u32 v6, s42, 19, v6
v_mfma_f32_16x16x32_bf16 v[60:63], a[104:107], a[0:3], v[60:63]
s_waitcnt lgkmcnt(7)
v_mfma_f32_16x16x32_bf16 v[88:91], a[80:83], a[0:3], v[88:91]
ds_read_b64_tr_b16 a[104:105], v13 offset:768
v_mfma_f32_16x16x32_bf16 v[88:91], a[84:87], a[16:19], v[88:91]
ds_read_b64_tr_b16 a[106:107], v13 offset:1792
v_mfma_f32_16x16x32_bf16 v[96:99], a[84:87], a[20:23], v[96:99]
ds_read_b64_tr_b16 a[108:109], v13 offset:8960
v_mfma_f32_16x16x32_bf16 v[96:99], a[80:83], a[4:7], v[96:99]
ds_read_b64_tr_b16 a[110:111], v13 offset:9984
v_mfma_f32_16x16x32_bf16 v[104:107], a[80:83], a[8:11], v[104:107]
s_add_u32 m0, s16, 0x8000
s_waitcnt lgkmcnt(8)
v_mfma_f32_16x16x32_bf16 v[104:107], a[84:87], a[24:27], v[104:107]
buffer_load_dwordx4 v2, s[48:51], 0 offen lds
v_mfma_f32_16x16x32_bf16 v[112:115], a[84:87], a[28:31], v[112:115]
v_mfma_f32_16x16x32_bf16 v[112:115], a[80:83], a[12:15], v[112:115]
v_mfma_f32_16x16x32_bf16 v[116:119], a[88:91], a[12:15], v[116:119]
ds_read_b64_tr_b16 a[80:81], v12 offset:16384
v_mfma_f32_16x16x32_bf16 v[116:119], a[92:95], a[28:31], v[116:119]
ds_read_b64_tr_b16 a[82:83], v12 offset:17408
v_mfma_f32_16x16x32_bf16 v[108:111], a[92:95], a[24:27], v[108:111]
ds_read_b64_tr_b16 a[84:85], v12 offset:24576
v_mfma_f32_16x16x32_bf16 v[108:111], a[88:91], a[8:11], v[108:111]
ds_read_b64_tr_b16 a[86:87], v12 offset:25600
s_add_u32 m0, s16, 0x8400
v_mfma_f32_16x16x32_bf16 v[100:103], a[88:91], a[4:7], v[100:103]
buffer_load_dwordx4 v3, s[48:51], 0 offen lds
v_mfma_f32_16x16x32_bf16 v[100:103], a[92:95], a[20:23], v[100:103]
v_mfma_f32_16x16x32_bf16 v[92:95], a[92:95], a[16:19], v[92:95]
v_mfma_f32_16x16x32_bf16 v[92:95], a[88:91], a[0:3], v[92:95]
s_waitcnt lgkmcnt(4)
v_mfma_f32_16x16x32_bf16 v[120:123], a[96:99], a[0:3], v[120:123]
ds_read_b64_tr_b16 a[88:89], v13 offset:16384
v_mfma_f32_16x16x32_bf16 v[120:123], a[100:103], a[16:19], v[120:123]
ds_read_b64_tr_b16 a[90:91], v13 offset:17408
v_mfma_f32_16x16x32_bf16 v[128:131], a[100:103], a[20:23], v[128:131]
ds_read_b64_tr_b16 a[92:93], v13 offset:24576
v_mfma_f32_16x16x32_bf16 v[128:131], a[96:99], a[4:7], v[128:131]
ds_read_b64_tr_b16 a[94:95], v13 offset:25600
s_add_u32 m0, s16, 0x8800
v_mfma_f32_16x16x32_bf16 v[136:139], a[96:99], a[8:11], v[136:139]
buffer_load_dwordx4 v2, s[48:51], s12 offen lds
v_mfma_f32_16x16x32_bf16 v[136:139], a[100:103], a[24:27], v[136:139]
v_mfma_f32_16x16x32_bf16 v[144:147], a[100:103], a[28:31], v[144:147]
v_mfma_f32_16x16x32_bf16 v[144:147], a[96:99], a[12:15], v[144:147]
v_mfma_f32_16x16x32_bf16 v[148:151], a[104:107], a[12:15], v[148:151]
ds_read_b64_tr_b16 a[96:97], v12 offset:16640
v_mfma_f32_16x16x32_bf16 v[148:151], a[108:111], a[28:31], v[148:151]
ds_read_b64_tr_b16 a[98:99], v12 offset:17664
v_mfma_f32_16x16x32_bf16 v[140:143], a[108:111], a[24:27], v[140:143]
ds_read_b64_tr_b16 a[100:101], v12 offset:24832
s_add_u32 m0, s16, 0x8c00
v_mfma_f32_16x16x32_bf16 v[140:143], a[104:107], a[8:11], v[140:143]
buffer_load_dwordx4 v3, s[48:51], s12 offen lds
v_mfma_f32_16x16x32_bf16 v[132:135], a[104:107], a[4:7], v[132:135]
ds_read_b64_tr_b16 a[102:103], v12 offset:25856
v_mfma_f32_16x16x32_bf16 v[132:135], a[108:111], a[20:23], v[132:135]
v_mfma_f32_16x16x32_bf16 v[124:127], a[108:111], a[16:19], v[124:127]
v_mfma_f32_16x16x32_bf16 v[124:127], a[104:107], a[0:3], v[124:127]
s_waitcnt lgkmcnt(4)
v_mfma_f32_16x16x32_bf16 v[152:155], a[0:3], a[80:83], v[152:155]
ds_read_b64_tr_b16 a[104:105], v13 offset:16640
v_mfma_f32_16x16x32_bf16 v[152:155], a[16:19], a[84:87], v[152:155]
ds_read_b64_tr_b16 a[106:107], v13 offset:17664
s_add_u32 m0, s16, 0x9000
v_mfma_f32_16x16x32_bf16 v[156:159], a[20:23], a[84:87], v[156:159]
buffer_load_dwordx4 v2, s[48:51], s13 offen lds
v_mfma_f32_16x16x32_bf16 v[156:159], a[4:7], a[80:83], v[156:159]
ds_read_b64_tr_b16 a[108:109], v13 offset:24832
v_mfma_f32_16x16x32_bf16 v[160:163], a[8:11], a[80:83], v[160:163]
ds_read_b64_tr_b16 a[110:111], v13 offset:25856
v_mfma_f32_16x16x32_bf16 v[160:163], a[24:27], a[84:87], v[160:163]
v_mfma_f32_16x16x32_bf16 v[164:167], a[28:31], a[84:87], v[164:167]
v_mfma_f32_16x16x32_bf16 v[164:167], a[12:15], a[80:83], v[164:167]
v_mfma_f32_16x16x32_bf16 v[180:183], a[12:15], a[88:91], v[180:183]
ds_read_b64_tr_b16 a[80:81], v12 offset:16896
v_mfma_f32_16x16x32_bf16 v[180:183], a[28:31], a[92:95], v[180:183]
ds_read_b64_tr_b16 a[82:83], v12 offset:17920
s_add_u32 m0, s16, 0x9400
v_mfma_f32_16x16x32_bf16 v[176:179], a[24:27], a[92:95], v[176:179]
buffer_load_dwordx4 v3, s[48:51], s13 offen lds
v_mfma_f32_16x16x32_bf16 v[176:179], a[8:11], a[88:91], v[176:179]
ds_read_b64_tr_b16 a[84:85], v12 offset:25088
v_mfma_f32_16x16x32_bf16 v[172:175], a[4:7], a[88:91], v[172:175]
ds_read_b64_tr_b16 a[86:87], v12 offset:26112
v_mfma_f32_16x16x32_bf16 v[172:175], a[20:23], a[92:95], v[172:175]
v_mfma_f32_16x16x32_bf16 v[168:171], a[16:19], a[92:95], v[168:171]
v_mfma_f32_16x16x32_bf16 v[168:171], a[0:3], a[88:91], v[168:171]
s_waitcnt lgkmcnt(4)
v_mfma_f32_16x16x32_bf16 v[184:187], a[0:3], a[96:99], v[184:187]
ds_read_b64_tr_b16 a[88:89], v13 offset:16896
s_add_u32 m0, s16, 0x9800
v_mfma_f32_16x16x32_bf16 v[184:187], a[16:19], a[100:103], v[184:187]
buffer_load_dwordx4 v2, s[48:51], s14 offen lds
v_mfma_f32_16x16x32_bf16 v[188:191], a[20:23], a[100:103], v[188:191]
ds_read_b64_tr_b16 a[90:91], v13 offset:17920
v_mfma_f32_16x16x32_bf16 v[188:191], a[4:7], a[96:99], v[188:191]
ds_read_b64_tr_b16 a[92:93], v13 offset:25088
v_mfma_f32_16x16x32_bf16 v[192:195], a[8:11], a[96:99], v[192:195]
ds_read_b64_tr_b16 a[94:95], v13 offset:26112
v_mfma_f32_16x16x32_bf16 v[192:195], a[24:27], a[100:103], v[192:195]
v_mfma_f32_16x16x32_bf16 v[196:199], a[28:31], a[100:103], v[196:199]
v_mfma_f32_16x16x32_bf16 v[196:199], a[12:15], a[96:99], v[196:199]
v_mfma_f32_16x16x32_bf16 v[212:215], a[12:15], a[104:107], v[212:215]
ds_read_b64_tr_b16 a[96:97], v12 offset:17152
s_add_u32 m0, s16, 0x9c00
v_mfma_f32_16x16x32_bf16 v[212:215], a[28:31], a[108:111], v[212:215]
buffer_load_dwordx4 v3, s[48:51], s14 offen lds
v_mfma_f32_16x16x32_bf16 v[208:211], a[24:27], a[108:111], v[208:211]
ds_read_b64_tr_b16 a[98:99], v12 offset:18176
s_sub_u32 s42, s43, s41
v_mfma_f32_16x16x32_bf16 v[208:211], a[8:11], a[104:107], v[208:211]
ds_read_b64_tr_b16 a[100:101], v12 offset:25344
s_mov_b32 s41, s43
v_mfma_f32_16x16x32_bf16 v[204:207], a[4:7], a[104:107], v[204:207]
ds_read_b64_tr_b16 a[102:103], v12 offset:26368
v_mfma_f32_16x16x32_bf16 v[204:207], a[20:23], a[108:111], v[204:207]
v_mfma_f32_16x16x32_bf16 v[200:203], a[16:19], a[108:111], v[200:203]
v_mfma_f32_16x16x32_bf16 v[200:203], a[0:3], a[104:107], v[200:203]
s_mov_b32 s9, 0x0
s_waitcnt lgkmcnt(4)
v_mfma_f32_16x16x32_bf16 v[216:219], a[0:3], a[80:83], v[216:219]
buffer_load_dword a120, v19, s[68:71], s9 offen
v_mfma_f32_16x16x32_bf16 v[216:219], a[16:19], a[84:87], v[216:219]
ds_read_b64_tr_b16 a[104:105], v13 offset:17152
v_mfma_f32_16x16x32_bf16 v[220:223], a[20:23], a[84:87], v[220:223]
ds_read_b64_tr_b16 a[106:107], v13 offset:18176
v_mfma_f32_16x16x32_bf16 v[220:223], a[4:7], a[80:83], v[220:223]
ds_read_b64_tr_b16 a[108:109], v13 offset:25344
v_mfma_f32_16x16x32_bf16 v[224:227], a[8:11], a[80:83], v[224:227]
ds_read_b64_tr_b16 a[110:111], v13 offset:26368
v_add_u32 v12, 0x8000, v12
v_mfma_f32_16x16x32_bf16 v[224:227], a[24:27], a[84:87], v[224:227]
v_add_u32 v13, 0x8000, v13
v_mfma_f32_16x16x32_bf16 v[228:231], a[28:31], a[84:87], v[228:231]
v_mfma_f32_16x16x32_bf16 v[228:231], a[12:15], a[80:83], v[228:231]
v_mfma_f32_16x16x32_bf16 v[244:247], a[12:15], a[88:91], v[244:247]
s_waitcnt vmcnt(27) lgkmcnt(0)
v_mfma_f32_16x16x32_bf16 v[244:247], a[28:31], a[92:95], v[244:247]
s_barrier
s_add_u32 m0, s17, 0x8000
v_mfma_f32_16x16x32_bf16 v[240:243], a[24:27], a[92:95], v[240:243]
buffer_load_dwordx4 v5, s[56:59], 0 offen lds
v_mfma_f32_16x16x32_bf16 v[240:243], a[8:11], a[88:91], v[240:243]
ds_read_b64_tr_b16 a[80:81], v12 offset:0
v_mfma_f32_16x16x32_bf16 v[236:239], a[4:7], a[88:91], v[236:239]
ds_read_b64_tr_b16 a[82:83], v12 offset:1024
v_mfma_f32_16x16x32_bf16 v[236:239], a[20:23], a[92:95], v[236:239]
ds_read_b64_tr_b16 a[84:85], v12 offset:8192
v_mfma_f32_16x16x32_bf16 v[232:235], a[16:19], a[92:95], v[232:235]
ds_read_b64_tr_b16 a[86:87], v12 offset:9216
v_mfma_f32_16x16x32_bf16 v[232:235], a[0:3], a[88:91], v[232:235]
s_add_u32 m0, s17, 0xc000
s_waitcnt lgkmcnt(4)
v_mfma_f32_16x16x32_bf16 v[248:251], a[0:3], a[96:99], v[248:251]
buffer_load_dwordx4 v5, s[60:63], 0 offen lds
v_mfma_f32_16x16x32_bf16 v[248:251], a[16:19], a[100:103], v[248:251]
ds_read_b64_tr_b16 a[88:89], v13 offset:0
v_mfma_f32_16x16x32_bf16 v[252:255], a[20:23], a[100:103], v[252:255]
ds_read_b64_tr_b16 a[90:91], v13 offset:1024
v_mfma_f32_16x16x32_bf16 v[252:255], a[4:7], a[96:99], v[252:255]
ds_read_b64_tr_b16 a[92:93], v13 offset:8192
v_mfma_f32_16x16x32_bf16 a[232:235], a[8:11], a[96:99], a[232:235]
ds_read_b64_tr_b16 a[94:95], v13 offset:9216
v_mfma_f32_16x16x32_bf16 a[232:235], a[24:27], a[100:103], a[232:235]
v_mfma_f32_16x16x32_bf16 a[236:239], a[28:31], a[100:103], a[236:239]
s_add_u32 m0, s17, 0x8400
v_mfma_f32_16x16x32_bf16 a[236:239], a[12:15], a[96:99], a[236:239]
buffer_load_dwordx4 v5, s[56:59], s13 offen lds
v_mfma_f32_16x16x32_bf16 a[252:255], a[12:15], a[104:107], a[252:255]
ds_read_b64_tr_b16 a[96:97], v12 offset:256
v_mfma_f32_16x16x32_bf16 a[252:255], a[28:31], a[108:111], a[252:255]
ds_read_b64_tr_b16 a[98:99], v12 offset:1280
v_mfma_f32_16x16x32_bf16 a[248:251], a[24:27], a[108:111], a[248:251]
ds_read_b64_tr_b16 a[100:101], v12 offset:8448
v_mfma_f32_16x16x32_bf16 a[248:251], a[8:11], a[104:107], a[248:251]
ds_read_b64_tr_b16 a[102:103], v12 offset:9472
v_mfma_f32_16x16x32_bf16 a[244:247], a[4:7], a[104:107], a[244:247]
s_add_u32 m0, s17, 0xc400
v_mfma_f32_16x16x32_bf16 a[244:247], a[20:23], a[108:111], a[244:247]
buffer_load_dwordx4 v5, s[60:63], s13 offen lds
v_mfma_f32_16x16x32_bf16 a[240:243], a[16:19], a[108:111], a[240:243]
v_mfma_f32_16x16x32_bf16 a[240:243], a[0:3], a[104:107], a[240:243]
s_waitcnt lgkmcnt(4)
L_S5:
v_mfma_f32_16x16x32_bf16 v[24:27], a[80:83], a[32:35], v[24:27]
ds_read_b64_tr_b16 a[104:105], v13 offset:256
s_waitcnt vmcnt(22)
v_mfma_f32_16x16x32_bf16 v[24:27], a[84:87], a[48:51], v[24:27]
ds_read_b64_tr_b16 a[106:107], v13 offset:1280
v_mfma_f32_16x16x32_bf16 v[32:35], a[84:87], a[52:55], v[32:35]
ds_read_b64_tr_b16 a[108:109], v13 offset:8448
v_mfma_f32_16x16x32_bf16 v[32:35], a[80:83], a[36:39], v[32:35]
ds_read_b64_tr_b16 a[110:111], v13 offset:9472
s_add_u32 m0, s17, 0x8800
v_mfma_f32_16x16x32_bf16 v[40:43], a[80:83], a[40:43], v[40:43]
buffer_load_dwordx4 v6, s[56:59], 0 offen lds
v_mfma_f32_16x16x32_bf16 v[40:43], a[84:87], a[56:59], v[40:43]
ds_read_b128 a[0:3], v8 offset:0
v_mfma_f32_16x16x32_bf16 v[48:51], a[84:87], a[60:63], v[48:51]
ds_read_b128 a[16:19], v9 offset:0
v_mfma_f32_16x16x32_bf16 v[48:51], a[80:83], a[44:47], v[48:51]
ds_read_b128 a[4:7], v8 offset:2048
v_mfma_f32_16x16x32_bf16 v[52:55], a[88:91], a[44:47], v[52:55]
ds_read_b64_tr_b16 a[80:81], v12 offset:512
v_mfma_f32_16x16x32_bf16 v[52:55], a[92:95], a[60:63], v[52:55]
ds_read_b64_tr_b16 a[82:83], v12 offset:1536
v_mfma_f32_16x16x32_bf16 v[44:47], a[92:95], a[56:59], v[44:47]
ds_read_b64_tr_b16 a[84:85], v12 offset:8704
s_mov_b32 s9, 0x200000
v_mfma_f32_16x16x32_bf16 v[44:47], a[88:91], a[40:43], v[44:47]
buffer_load_dword a120, v18, s[52:55], s9 offen
v_mfma_f32_16x16x32_bf16 v[36:39], a[88:91], a[36:39], v[36:39]
ds_read_b64_tr_b16 a[86:87], v12 offset:9728
v_mfma_f32_16x16x32_bf16 v[36:39], a[92:95], a[52:55], v[36:39]
ds_read_b128 a[20:23], v9 offset:2048
v_mfma_f32_16x16x32_bf16 v[28:31], a[92:95], a[48:51], v[28:31]
ds_read_b128 a[8:11], v8 offset:4096
v_mfma_f32_16x16x32_bf16 v[28:31], a[88:91], a[32:35], v[28:31]
ds_read_b128 a[24:27], v9 offset:4096
s_waitcnt lgkmcnt(10)
v_mfma_f32_16x16x32_bf16 v[56:59], a[96:99], a[32:35], v[56:59]
ds_read_b64_tr_b16 a[88:89], v13 offset:512
s_add_u32 m0, s17, 0xc800
v_mfma_f32_16x16x32_bf16 v[56:59], a[100:103], a[48:51], v[56:59]
buffer_load_dwordx4 v6, s[60:63], 0 offen lds
v_mfma_f32_16x16x32_bf16 v[64:67], a[100:103], a[52:55], v[64:67]
ds_read_b64_tr_b16 a[90:91], v13 offset:1536
v_mfma_f32_16x16x32_bf16 v[64:67], a[96:99], a[36:39], v[64:67]
ds_read_b64_tr_b16 a[92:93], v13 offset:8704
v_mfma_f32_16x16x32_bf16 v[72:75], a[96:99], a[40:43], v[72:75]
ds_read_b64_tr_b16 a[94:95], v13 offset:9728
v_mfma_f32_16x16x32_bf16 v[72:75], a[100:103], a[56:59], v[72:75]
ds_read_b128 a[12:15], v8 offset:6144
v_mfma_f32_16x16x32_bf16 v[80:83], a[100:103], a[60:63], v[80:83]
ds_read_b128 a[28:31], v9 offset:6144
v_mfma_f32_16x16x32_bf16 v[80:83], a[96:99], a[44:47], v[80:83]
s_add_u32 m0, s17, 0x8c00
v_mfma_f32_16x16x32_bf16 v[84:87], a[104:107], a[44:47], v[84:87]
buffer_load_dwordx4 v6, s[56:59], s13 offen lds
v_mfma_f32_16x16x32_bf16 v[84:87], a[108:111], a[60:63], v[84:87]
ds_read_b64_tr_b16 a[96:97], v12 offset:768
v_mfma_f32_16x16x32_bf16 v[76:79], a[108:111], a[56:59], v[76:79]
ds_read_b64_tr_b16 a[98:99], v12 offset:1792
v_mfma_f32_16x16x32_bf16 v[76:79], a[104:107], a[40:43], v[76:79]
ds_read_b64_tr_b16 a[100:101], v12 offset:8960
v_mfma_f32_16x16x32_bf16 v[68:71], a[104:107], a[36:39], v[68:71]
ds_read_b64_tr_b16 a[102:103], v12 offset:9984
v_mfma_f32_16x16x32_bf16 v[68:71], a[108:111], a[52:55], v[68:71]
v_mfma_f32_16x16x32_bf16 v[60:63], a[108:111], a[48:51], v[60:63]
s_add_u32 m0, s17, 0xcc00
s_waitcnt lgkmcnt(6)
v_mfma_f32_16x16x32_bf16 v[60:63], a[104:107], a[32:35], v[60:63]
buffer_load_dwordx4 v6, s[60:63], s13 offen lds
v_mfma_f32_16x16x32_bf16 v[88:91], a[80:83], a[32:35], v[88:91]
ds_read_b64_tr_b16 a[104:105], v13 offset:768
v_lshl_add_u32 v5, s42, 19, v5
v_mfma_f32_16x16x32_bf16 v[88:91], a[84:87], a[48:51], v[88:91]
ds_read_b64_tr_b16 a[106:107], v13 offset:1792
v_lshl_add_u32 v6, s42, 19, v6
v_mfma_f32_16x16x32_bf16 v[96:99], a[84:87], a[52:55], v[96:99]
ds_read_b64_tr_b16 a[108:109], v13 offset:8960
v_mfma_f32_16x16x32_bf16 v[96:99], a[80:83], a[36:39], v[96:99]
ds_read_b64_tr_b16 a[110:111], v13 offset:9984
v_mfma_f32_16x16x32_bf16 v[104:107], a[80:83], a[40:43], v[104:107]
s_add_u32 m0, s16, 0x0
s_waitcnt lgkmcnt(8)
v_mfma_f32_16x16x32_bf16 v[104:107], a[84:87], a[56:59], v[104:107]
buffer_load_dwordx4 v22, s[44:47], s20 offen lds
v_mfma_f32_16x16x32_bf16 v[112:115], a[84:87], a[60:63], v[112:115]
v_mfma_f32_16x16x32_bf16 v[112:115], a[80:83], a[44:47], v[112:115]
v_mfma_f32_16x16x32_bf16 v[116:119], a[88:91], a[44:47], v[116:119]
ds_read_b64_tr_b16 a[80:81], v12 offset:16384
v_mfma_f32_16x16x32_bf16 v[116:119], a[92:95], a[60:63], v[116:119]
ds_read_b64_tr_b16 a[82:83], v12 offset:17408
v_mfma_f32_16x16x32_bf16 v[108:111], a[92:95], a[56:59], v[108:111]
ds_read_b64_tr_b16 a[84:85], v12 offset:24576
v_mfma_f32_16x16x32_bf16 v[108:111], a[88:91], a[40:43], v[108:111]
ds_read_b64_tr_b16 a[86:87], v12 offset:25600
s_add_u32 m0, s16, 0x400
v_mfma_f32_16x16x32_bf16 v[100:103], a[88:91], a[36:39], v[100:103]
buffer_load_dwordx4 v23, s[44:47], s20 offen lds
v_mfma_f32_16x16x32_bf16 v[100:103], a[92:95], a[52:55], v[100:103]
v_mfma_f32_16x16x32_bf16 v[92:95], a[92:95], a[48:51], v[92:95]
v_mfma_f32_16x16x32_bf16 v[92:95], a[88:91], a[32:35], v[92:95]
s_waitcnt lgkmcnt(4)
v_mfma_f32_16x16x32_bf16 v[120:123], a[96:99], a[32:35], v[120:123]
ds_read_b64_tr_b16 a[88:89], v13 offset:16384
v_mfma_f32_16x16x32_bf16 v[120:123], a[100:103], a[48:51], v[120:123]
ds_read_b64_tr_b16 a[90:91], v13 offset:17408
s_mov_b32 s9, 0x200000
v_mfma_f32_16x16x32_bf16 v[128:131], a[100:103], a[52:55], v[128:131]
buffer_load_dword a120, v19, s[68:71], s9 offen
v_mfma_f32_16x16x32_bf16 v[128:131], a[96:99], a[36:39], v[128:131]
ds_read_b64_tr_b16 a[92:93], v13 offset:24576
v_mfma_f32_16x16x32_bf16 v[136:139], a[96:99], a[40:43], v[136:139]
ds_read_b64_tr_b16 a[94:95], v13 offset:25600
v_mfma_f32_16x16x32_bf16 v[136:139], a[100:103], a[56:59], v[136:139]
v_mfma_f32_16x16x32_bf16 v[144:147], a[100:103], a[60:63], v[144:147]
v_mfma_f32_16x16x32_bf16 v[144:147], a[96:99], a[44:47], v[144:147]
v_mfma_f32_16x16x32_bf16 v[148:151], a[104:107], a[44:47], v[148:151]
ds_read_b64_tr_b16 a[96:97], v12 offset:16640
s_add_u32 m0, s16, 0x800
v_mfma_f32_16x16x32_bf16 v[148:151], a[108:111], a[60:63], v[148:151]
buffer_load_dwordx4 v22, s[44:47], s21 offen lds
v_mfma_f32_16x16x32_bf16 v[140:143], a[108:111], a[56:59], v[140:143]
ds_read_b64_tr_b16 a[98:99], v12 offset:17664
v_mfma_f32_16x16x32_bf16 v[140:143], a[104:107], a[40:43], v[140:143]
ds_read_b64_tr_b16 a[100:101], v12 offset:24832
v_mfma_f32_16x16x32_bf16 v[132:135], a[104:107], a[36:39], v[132:135]
ds_read_b64_tr_b16 a[102:103], v12 offset:25856
v_mfma_f32_16x16x32_bf16 v[132:135], a[108:111], a[52:55], v[132:135]
v_mfma_f32_16x16x32_bf16 v[124:127], a[108:111], a[48:51], v[124:127]
v_mfma_f32_16x16x32_bf16 v[124:127], a[104:107], a[32:35], v[124:127]
s_add_u32 m0, s16, 0xc00
s_waitcnt lgkmcnt(4)
v_mfma_f32_16x16x32_bf16 v[152:155], a[32:35], a[80:83], v[152:155]
buffer_load_dwordx4 v23, s[44:47], s21 offen lds
v_mfma_f32_16x16x32_bf16 v[152:155], a[48:51], a[84:87], v[152:155]
ds_read_b64_tr_b16 a[104:105], v13 offset:16640
v_mfma_f32_16x16x32_bf16 v[156:159], a[52:55], a[84:87], v[156:159]
ds_read_b64_tr_b16 a[106:107], v13 offset:17664
v_mfma_f32_16x16x32_bf16 v[156:159], a[36:39], a[80:83], v[156:159]
ds_read_b64_tr_b16 a[108:109], v13 offset:24832
v_mfma_f32_16x16x32_bf16 v[160:163], a[40:43], a[80:83], v[160:163]
ds_read_b64_tr_b16 a[110:111], v13 offset:25856
v_mfma_f32_16x16x32_bf16 v[160:163], a[56:59], a[84:87], v[160:163]
s_add_u32 m0, s16, 0x1000
v_mfma_f32_16x16x32_bf16 v[164:167], a[60:63], a[84:87], v[164:167]
buffer_load_dwordx4 v22, s[44:47], s22 offen lds
v_mfma_f32_16x16x32_bf16 v[164:167], a[44:47], a[80:83], v[164:167]
v_mfma_f32_16x16x32_bf16 v[180:183], a[44:47], a[88:91], v[180:183]
ds_read_b64_tr_b16 a[80:81], v12 offset:16896
v_mfma_f32_16x16x32_bf16 v[180:183], a[60:63], a[92:95], v[180:183]
ds_read_b64_tr_b16 a[82:83], v12 offset:17920
v_mfma_f32_16x16x32_bf16 v[176:179], a[56:59], a[92:95], v[176:179]
ds_read_b64_tr_b16 a[84:85], v12 offset:25088
v_mfma_f32_16x16x32_bf16 v[176:179], a[40:43], a[88:91], v[176:179]
ds_read_b64_tr_b16 a[86:87], v12 offset:26112
v_mfma_f32_16x16x32_bf16 v[172:175], a[36:39], a[88:91], v[172:175]
s_add_u32 m0, s16, 0x1400
v_mfma_f32_16x16x32_bf16 v[172:175], a[52:55], a[92:95], v[172:175]
buffer_load_dwordx4 v23, s[44:47], s22 offen lds
v_mfma_f32_16x16x32_bf16 v[168:171], a[48:51], a[92:95], v[168:171]
v_mfma_f32_16x16x32_bf16 v[168:171], a[32:35], a[88:91], v[168:171]
s_waitcnt lgkmcnt(4)
v_mfma_f32_16x16x32_bf16 v[184:187], a[32:35], a[96:99], v[184:187]
ds_read_b64_tr_b16 a[88:89], v13 offset:16896
v_mfma_f32_16x16x32_bf16 v[184:187], a[48:51], a[100:103], v[184:187]
ds_read_b64_tr_b16 a[90:91], v13 offset:17920
v_mfma_f32_16x16x32_bf16 v[188:191], a[52:55], a[100:103], v[188:191]
ds_read_b64_tr_b16 a[92:93], v13 offset:25088
v_mfma_f32_16x16x32_bf16 v[188:191], a[36:39], a[96:99], v[188:191]
ds_read_b64_tr_b16 a[94:95], v13 offset:26112
s_add_u32 m0, s16, 0x1800
v_mfma_f32_16x16x32_bf16 v[192:195], a[40:43], a[96:99], v[192:195]
buffer_load_dwordx4 v22, s[44:47], s23 offen lds
v_mfma_f32_16x16x32_bf16 v[192:195], a[56:59], a[100:103], v[192:195]
v_mfma_f32_16x16x32_bf16 v[196:199], a[60:63], a[100:103], v[196:199]
v_mfma_f32_16x16x32_bf16 v[196:199], a[44:47], a[96:99], v[196:199]
v_mfma_f32_16x16x32_bf16 v[212:215], a[44:47], a[104:107], v[212:215]
ds_read_b64_tr_b16 a[96:97], v12 offset:17152
v_mfma_f32_16x16x32_bf16 v[212:215], a[60:63], a[108:111], v[212:215]
ds_read_b64_tr_b16 a[98:99], v12 offset:18176
s_add_u32 m0, s16, 0x1c00
v_mfma_f32_16x16x32_bf16 v[208:211], a[56:59], a[108:111], v[208:211]
buffer_load_dwordx4 v23, s[44:47], s23 offen lds
v_mfma_f32_16x16x32_bf16 v[208:211], a[40:43], a[104:107], v[208:211]
ds_read_b64_tr_b16 a[100:101], v12 offset:25344
s_mov_b32 s42, 1
v_mfma_f32_16x16x32_bf16 v[204:207], a[36:39], a[104:107], v[204:207]
ds_read_b64_tr_b16 a[102:103], v12 offset:26368
v_lshl_add_u32 v22, s42, 7, v22
v_mfma_f32_16x16x32_bf16 v[204:207], a[52:55], a[108:111], v[204:207]
v_lshl_add_u32 v23, s42, 7, v23
v_mfma_f32_16x16x32_bf16 v[200:203], a[48:51], a[108:111], v[200:203]
v_mfma_f32_16x16x32_bf16 v[200:203], a[32:35], a[104:107], v[200:203]
s_waitcnt lgkmcnt(4)
v_mov_b32 v21, s1
v_mfma_f32_16x16x32_bf16 v[216:219], a[32:35], a[80:83], v[216:219]
ds_read_b64_tr_b16 a[104:105], v13 offset:17152
v_add_u32 v20, s0, v16
v_mfma_f32_16x16x32_bf16 v[216:219], a[48:51], a[84:87], v[216:219]
global_load_dword a120, v[20:21], off sc1
v_mfma_f32_16x16x32_bf16 v[220:223], a[52:55], a[84:87], v[220:223]
ds_read_b64_tr_b16 a[106:107], v13 offset:18176
v_mfma_f32_16x16x32_bf16 v[220:223], a[36:39], a[80:83], v[220:223]
ds_read_b64_tr_b16 a[108:109], v13 offset:25344
v_mfma_f32_16x16x32_bf16 v[224:227], a[40:43], a[80:83], v[224:227]
ds_read_b64_tr_b16 a[110:111], v13 offset:26368
v_add_u32 v12, 0xffff0000, v12
v_mfma_f32_16x16x32_bf16 v[224:227], a[56:59], a[84:87], v[224:227]
v_add_u32 v13, 0xffff0000, v13
v_mfma_f32_16x16x32_bf16 v[228:231], a[60:63], a[84:87], v[228:231]
v_mfma_f32_16x16x32_bf16 v[228:231], a[44:47], a[80:83], v[228:231]
v_mfma_f32_16x16x32_bf16 v[244:247], a[44:47], a[88:91], v[244:247]
s_waitcnt vmcnt(28) lgkmcnt(0)
v_mfma_f32_16x16x32_bf16 v[244:247], a[60:63], a[92:95], v[244:247]
s_barrier
s_add_u32 m0, s17, 0x10000
v_mfma_f32_16x16x32_bf16 v[240:243], a[56:59], a[92:95], v[240:243]
buffer_load_dwordx4 v5, s[52:55], 0 offen lds
v_mfma_f32_16x16x32_bf16 v[240:243], a[40:43], a[88:91], v[240:243]
ds_read_b64_tr_b16 a[80:81], v12 offset:0
s_mul_i32 s28, s5, 0x10c400
v_mfma_f32_16x16x32_bf16 v[236:239], a[36:39], a[88:91], v[236:239]
ds_read_b64_tr_b16 a[82:83], v12 offset:1024
s_mov_b32 s48, s88
v_mfma_f32_16x16x32_bf16 v[236:239], a[52:55], a[92:95], v[236:239]
ds_read_b64_tr_b16 a[84:85], v12 offset:8192
s_mov_b32 s49, s89
v_mfma_f32_16x16x32_bf16 v[232:235], a[48:51], a[92:95], v[232:235]
ds_read_b64_tr_b16 a[86:87], v12 offset:9216
s_sub_u32 s11, 16, s6
v_mfma_f32_16x16x32_bf16 v[232:235], a[32:35], a[88:91], v[232:235]
s_waitcnt lgkmcnt(4)
s_lshl_b32 s11, s11, 16
s_add_u32 s11, s11, s28
v_mfma_f32_16x16x32_bf16 v[248:251], a[32:35], a[96:99], v[248:251]
ds_read_b64_tr_b16 a[88:89], v13 offset:0
s_add_u32 m0, s17, 0x10400
v_mfma_f32_16x16x32_bf16 v[248:251], a[48:51], a[100:103], v[248:251]
buffer_load_dwordx4 v5, s[52:55], s13 offen lds
v_mfma_f32_16x16x32_bf16 v[252:255], a[52:55], a[100:103], v[252:255]
ds_read_b64_tr_b16 a[90:91], v13 offset:1024
s_add_u32 s50, s11, 0x2000
v_mfma_f32_16x16x32_bf16 v[252:255], a[36:39], a[96:99], v[252:255]
ds_read_b64_tr_b16 a[92:93], v13 offset:8192
s_lshl_b32 s11, s6, 17
v_mfma_f32_16x16x32_bf16 a[232:235], a[40:43], a[96:99], a[232:235]
ds_read_b64_tr_b16 a[94:95], v13 offset:9216
s_add_u32 s28, s28, s11
v_mfma_f32_16x16x32_bf16 a[232:235], a[56:59], a[100:103], a[232:235]
s_lshl_b32 s11, s4, 15
s_add_u32 s28, s28, s11
s_lshl_b32 s10, s5, 2
v_mfma_f32_16x16x32_bf16 a[236:239], a[60:63], a[100:103], a[236:239]
s_add_u32 s10, s10, 64
v_mfma_f32_16x16x32_bf16 a[236:239], a[44:47], a[96:99], a[236:239]
s_add_u32 m0, s17, 0x10800
L_padA3:
s_cmp_eq_u32 s95, 1
s_cbranch_scc1 L_padA7
v_mfma_f32_16x16x32_bf16 a[252:255], a[44:47], a[104:107], a[252:255]
buffer_load_dwordx4 v6, s[52:55], 0 offen lds
v_mfma_f32_16x16x32_bf16 a[252:255], a[60:63], a[108:111], a[252:255]
ds_read_b64_tr_b16 a[96:97], v12 offset:256
v_mfma_f32_16x16x32_bf16 a[248:251], a[56:59], a[108:111], a[248:251]
ds_read_b64_tr_b16 a[98:99], v12 offset:1280
v_mfma_f32_16x16x32_bf16 a[248:251], a[40:43], a[104:107], a[248:251]
ds_read_b64_tr_b16 a[100:101], v12 offset:8448
v_mfma_f32_16x16x32_bf16 a[244:247], a[36:39], a[104:107], a[244:247]
ds_read_b64_tr_b16 a[102:103], v12 offset:9472
v_mfma_f32_16x16x32_bf16 a[244:247], a[52:55], a[108:111], a[244:247]
v_mfma_f32_16x16x32_bf16 a[240:243], a[48:51], a[108:111], a[240:243]
v_mfma_f32_16x16x32_bf16 a[240:243], a[32:35], a[104:107], a[240:243]
s_add_u32 m0, s17, 0x10c00
s_waitcnt lgkmcnt(4)
L_S6:
v_mfma_f32_16x16x32_bf16 v[24:27], a[80:83], a[0:3], v[24:27]
buffer_load_dwordx4 v6, s[52:55], s13 offen lds
v_mfma_f32_16x16x32_bf16 v[24:27], a[84:87], a[16:19], v[24:27]
ds_read_b64_tr_b16 a[104:105], v13 offset:256
s_waitcnt vmcnt(24)
v_mfma_f32_16x16x32_bf16 v[32:35], a[84:87], a[20:23], v[32:35]
ds_read_b64_tr_b16 a[106:107], v13 offset:1280
v_mfma_f32_16x16x32_bf16 v[32:35], a[80:83], a[4:7], v[32:35]
ds_read_b64_tr_b16 a[108:109], v13 offset:8448
v_mfma_f32_16x16x32_bf16 v[40:43], a[80:83], a[8:11], v[40:43]
ds_read_b64_tr_b16 a[110:111], v13 offset:9472
v_mfma_f32_16x16x32_bf16 v[40:43], a[84:87], a[24:27], v[40:43]
ds_read_b128 a[32:35], v8 offset:32768
v_mfma_f32_16x16x32_bf16 v[48:51], a[84:87], a[28:31], v[48:51]
ds_read_b128 a[48:51], v9 offset:32768
s_add_u32 m0, s18, 0x14000
v_mfma_f32_16x16x32_bf16 v[48:51], a[80:83], a[12:15], v[48:51]
buffer_load_dwordx4 v7, s[68:71], 0 offen lds
v_mfma_f32_16x16x32_bf16 v[52:55], a[88:91], a[12:15], v[52:55]
ds_read_b64_tr_b16 a[80:81], v12 offset:512
v_mfma_f32_16x16x32_bf16 v[52:55], a[92:95], a[28:31], v[52:55]
ds_read_b64_tr_b16 a[82:83], v12 offset:1536
v_mfma_f32_16x16x32_bf16 v[44:47], a[92:95], a[24:27], v[44:47]
ds_read_b64_tr_b16 a[84:85], v12 offset:8704
v_mfma_f32_16x16x32_bf16 v[44:47], a[88:91], a[8:11], v[44:47]
ds_read_b64_tr_b16 a[86:87], v12 offset:9728
v_mfma_f32_16x16x32_bf16 v[36:39], a[88:91], a[4:7], v[36:39]
ds_read_b128 a[36:39], v8 offset:34816
v_mfma_f32_16x16x32_bf16 v[36:39], a[92:95], a[20:23], v[36:39]
ds_read_b128 a[52:55], v9 offset:34816
s_waitcnt lgkmcnt(8)
v_mfma_f32_16x16x32_bf16 v[28:31], a[92:95], a[16:19], v[28:31]
ds_read_b128 a[40:43], v8 offset:36864
s_add_u32 m0, s18, 0x15000
v_mfma_f32_16x16x32_bf16 v[28:31], a[88:91], a[0:3], v[28:31]
buffer_load_dwordx4 v7, s[68:71], s25 offen lds
v_mfma_f32_16x16x32_bf16 v[56:59], a[96:99], a[0:3], v[56:59]
ds_read_b64_tr_b16 a[88:89], v13 offset:512
v_mfma_f32_16x16x32_bf16 v[56:59], a[100:103], a[16:19], v[56:59]
ds_read_b64_tr_b16 a[90:91], v13 offset:1536
v_mfma_f32_16x16x32_bf16 v[64:67], a[100:103], a[20:23], v[64:67]
ds_read_b64_tr_b16 a[92:93], v13 offset:8704
v_mfma_f32_16x16x32_bf16 v[64:67], a[96:99], a[4:7], v[64:67]
ds_read_b64_tr_b16 a[94:95], v13 offset:9728
v_mfma_f32_16x16x32_bf16 v[72:75], a[96:99], a[8:11], v[72:75]
ds_read_b128 a[56:59], v9 offset:36864
v_mfma_f32_16x16x32_bf16 v[72:75], a[100:103], a[24:27], v[72:75]
ds_read_b128 a[44:47], v8 offset:38912
s_add_u32 m0, s18, 0x16000
v_mfma_f32_16x16x32_bf16 v[80:83], a[100:103], a[28:31], v[80:83]
buffer_load_dwordx4 v7, s[68:71], s26 offen lds
v_mfma_f32_16x16x32_bf16 v[80:83], a[96:99], a[12:15], v[80:83]
ds_read_b128 a[60:63], v9 offset:38912
v_lshl_add_u32 v5, s42, 19, v5
v_mfma_f32_16x16x32_bf16 v[84:87], a[104:107], a[12:15], v[84:87]
ds_read_b64_tr_b16 a[96:97], v12 offset:768
v_lshl_add_u32 v6, s42, 19, v6
v_mfma_f32_16x16x32_bf16 v[84:87], a[108:111], a[28:31], v[84:87]
ds_read_b64_tr_b16 a[98:99], v12 offset:1792
v_lshl_add_u32 v7, s42, 18, v7
v_mfma_f32_16x16x32_bf16 v[76:79], a[108:111], a[24:27], v[76:79]
ds_read_b64_tr_b16 a[100:101], v12 offset:8960
v_lshl_add_u32 v7, s42, 17, v7
v_mfma_f32_16x16x32_bf16 v[76:79], a[104:107], a[8:11], v[76:79]
ds_read_b64_tr_b16 a[102:103], v12 offset:9984
v_mfma_f32_16x16x32_bf16 v[68:71], a[104:107], a[4:7], v[68:71]
v_mfma_f32_16x16x32_bf16 v[68:71], a[108:111], a[20:23], v[68:71]
buffer_store_dwordx4 a[64:67], v4, s[88:91], 0 offen sc1
v_mfma_f32_16x16x32_bf16 v[60:63], a[108:111], a[16:19], v[60:63]
v_mfma_f32_16x16x32_bf16 v[60:63], a[104:107], a[0:3], v[60:63]
s_waitcnt lgkmcnt(7)
v_mfma_f32_16x16x32_bf16 v[88:91], a[80:83], a[0:3], v[88:91]
ds_read_b64_tr_b16 a[104:105], v13 offset:768
v_mfma_f32_16x16x32_bf16 v[88:91], a[84:87], a[16:19], v[88:91]
ds_read_b64_tr_b16 a[106:107], v13 offset:1792
v_mfma_f32_16x16x32_bf16 v[96:99], a[84:87], a[20:23], v[96:99]
ds_read_b64_tr_b16 a[108:109], v13 offset:8960
v_mfma_f32_16x16x32_bf16 v[96:99], a[80:83], a[4:7], v[96:99]
ds_read_b64_tr_b16 a[110:111], v13 offset:9984
v_mfma_f32_16x16x32_bf16 v[104:107], a[80:83], a[8:11], v[104:107]
s_add_u32 m0, s16, 0x8000
s_waitcnt lgkmcnt(8)
v_mfma_f32_16x16x32_bf16 v[104:107], a[84:87], a[24:27], v[104:107]
buffer_load_dwordx4 v22, s[44:47], s20 offen lds
v_mfma_f32_16x16x32_bf16 v[112:115], a[84:87], a[28:31], v[112:115]
v_mfma_f32_16x16x32_bf16 v[112:115], a[80:83], a[12:15], v[112:115]
v_mfma_f32_16x16x32_bf16 v[116:119], a[88:91], a[12:15], v[116:119]
ds_read_b64_tr_b16 a[80:81], v12 offset:16384
v_mfma_f32_16x16x32_bf16 v[116:119], a[92:95], a[28:31], v[116:119]
ds_read_b64_tr_b16 a[82:83], v12 offset:17408
v_mfma_f32_16x16x32_bf16 v[108:111], a[92:95], a[24:27], v[108:111]
ds_read_b64_tr_b16 a[84:85], v12 offset:24576
v_mfma_f32_16x16x32_bf16 v[108:111], a[88:91], a[8:11], v[108:111]
ds_read_b64_tr_b16 a[86:87], v12 offset:25600
s_add_u32 m0, s16, 0x8400
v_mfma_f32_16x16x32_bf16 v[100:103], a[88:91], a[4:7], v[100:103]
buffer_load_dwordx4 v23, s[44:47], s20 offen lds
v_mfma_f32_16x16x32_bf16 v[100:103], a[92:95], a[20:23], v[100:103]
v_mfma_f32_16x16x32_bf16 v[92:95], a[92:95], a[16:19], v[92:95]
v_mfma_f32_16x16x32_bf16 v[92:95], a[88:91], a[0:3], v[92:95]
s_waitcnt lgkmcnt(4)
v_mfma_f32_16x16x32_bf16 v[120:123], a[96:99], a[0:3], v[120:123]
ds_read_b64_tr_b16 a[88:89], v13 offset:16384
v_mfma_f32_16x16x32_bf16 v[120:123], a[100:103], a[16:19], v[120:123]
ds_read_b64_tr_b16 a[90:91], v13 offset:17408
v_mfma_f32_16x16x32_bf16 v[128:131], a[100:103], a[20:23], v[128:131]
ds_read_b64_tr_b16 a[92:93], v13 offset:24576
v_mfma_f32_16x16x32_bf16 v[128:131], a[96:99], a[4:7], v[128:131]
ds_read_b64_tr_b16 a[94:95], v13 offset:25600
s_add_u32 m0, s16, 0x8800
v_mfma_f32_16x16x32_bf16 v[136:139], a[96:99], a[8:11], v[136:139]
buffer_load_dwordx4 v22, s[44:47], s21 offen lds
v_mfma_f32_16x16x32_bf16 v[136:139], a[100:103], a[24:27], v[136:139]
v_mfma_f32_16x16x32_bf16 v[144:147], a[100:103], a[28:31], v[144:147]
v_mfma_f32_16x16x32_bf16 v[144:147], a[96:99], a[12:15], v[144:147]
v_mfma_f32_16x16x32_bf16 v[148:151], a[104:107], a[12:15], v[148:151]
ds_read_b64_tr_b16 a[96:97], v12 offset:16640
v_mfma_f32_16x16x32_bf16 v[148:151], a[108:111], a[28:31], v[148:151]
ds_read_b64_tr_b16 a[98:99], v12 offset:17664
v_mfma_f32_16x16x32_bf16 v[140:143], a[108:111], a[24:27], v[140:143]
ds_read_b64_tr_b16 a[100:101], v12 offset:24832
s_add_u32 m0, s16, 0x8c00
v_mfma_f32_16x16x32_bf16 v[140:143], a[104:107], a[8:11], v[140:143]
buffer_load_dwordx4 v23, s[44:47], s21 offen lds
v_mfma_f32_16x16x32_bf16 v[132:135], a[104:107], a[4:7], v[132:135]
ds_read_b64_tr_b16 a[102:103], v12 offset:25856
v_mfma_f32_16x16x32_bf16 v[132:135], a[108:111], a[20:23], v[132:135]
v_mfma_f32_16x16x32_bf16 v[124:127], a[108:111], a[16:19], v[124:127]
v_mfma_f32_16x16x32_bf16 v[124:127], a[104:107], a[0:3], v[124:127]
s_waitcnt lgkmcnt(4)
v_mfma_f32_16x16x32_bf16 v[152:155], a[0:3], a[80:83], v[152:155]
ds_read_b64_tr_b16 a[104:105], v13 offset:16640
v_mfma_f32_16x16x32_bf16 v[152:155], a[16:19], a[84:87], v[152:155]
ds_read_b64_tr_b16 a[106:107], v13 offset:17664
s_add_u32 m0, s16, 0x9000
v_mfma_f32_16x16x32_bf16 v[156:159], a[20:23], a[84:87], v[156:159]
buffer_load_dwordx4 v22, s[44:47], s22 offen lds
v_mfma_f32_16x16x32_bf16 v[156:159], a[4:7], a[80:83], v[156:159]
ds_read_b64_tr_b16 a[108:109], v13 offset:24832
v_mfma_f32_16x16x32_bf16 v[160:163], a[8:11], a[80:83], v[160:163]
ds_read_b64_tr_b16 a[110:111], v13 offset:25856
v_mfma_f32_16x16x32_bf16 v[160:163], a[24:27], a[84:87], v[160:163]
v_mfma_f32_16x16x32_bf16 v[164:167], a[28:31], a[84:87], v[164:167]
v_mfma_f32_16x16x32_bf16 v[164:167], a[12:15], a[80:83], v[164:167]
v_mfma_f32_16x16x32_bf16 v[180:183], a[12:15], a[88:91], v[180:183]
ds_read_b64_tr_b16 a[80:81], v12 offset:16896
v_mfma_f32_16x16x32_bf16 v[180:183], a[28:31], a[92:95], v[180:183]
ds_read_b64_tr_b16 a[82:83], v12 offset:17920
s_add_u32 m0, s16, 0x9400
v_mfma_f32_16x16x32_bf16 v[176:179], a[24:27], a[92:95], v[176:179]
buffer_load_dwordx4 v23, s[44:47], s22 offen lds
v_mfma_f32_16x16x32_bf16 v[176:179], a[8:11], a[88:91], v[176:179]
ds_read_b64_tr_b16 a[84:85], v12 offset:25088
v_mfma_f32_16x16x32_bf16 v[172:175], a[4:7], a[88:91], v[172:175]
ds_read_b64_tr_b16 a[86:87], v12 offset:26112
v_mfma_f32_16x16x32_bf16 v[172:175], a[20:23], a[92:95], v[172:175]
v_mfma_f32_16x16x32_bf16 v[168:171], a[16:19], a[92:95], v[168:171]
v_mfma_f32_16x16x32_bf16 v[168:171], a[0:3], a[88:91], v[168:171]
s_waitcnt lgkmcnt(4)
v_mfma_f32_16x16x32_bf16 v[184:187], a[0:3], a[96:99], v[184:187]
ds_read_b64_tr_b16 a[88:89], v13 offset:16896
s_add_u32 m0, s16, 0x9800
v_mfma_f32_16x16x32_bf16 v[184:187], a[16:19], a[100:103], v[184:187]
buffer_load_dwordx4 v22, s[44:47], s23 offen lds
v_mfma_f32_16x16x32_bf16 v[188:191], a[20:23], a[100:103], v[188:191]
ds_read_b64_tr_b16 a[90:91], v13 offset:17920
v_mfma_f32_16x16x32_bf16 v[188:191], a[4:7], a[96:99], v[188:191]
ds_read_b64_tr_b16 a[92:93], v13 offset:25088
v_mfma_f32_16x16x32_bf16 v[192:195], a[8:11], a[96:99], v[192:195]
ds_read_b64_tr_b16 a[94:95], v13 offset:26112
v_mfma_f32_16x16x32_bf16 v[192:195], a[24:27], a[100:103], v[192:195]
v_mfma_f32_16x16x32_bf16 v[196:199], a[28:31], a[100:103], v[196:199]
v_mfma_f32_16x16x32_bf16 v[196:199], a[12:15], a[96:99], v[196:199]
v_mfma_f32_16x16x32_bf16 v[212:215], a[12:15], a[104:107], v[212:215]
ds_read_b64_tr_b16 a[96:97], v12 offset:17152
s_add_u32 m0, s16, 0x9c00
v_mfma_f32_16x16x32_bf16 v[212:215], a[28:31], a[108:111], v[212:215]
buffer_load_dwordx4 v23, s[44:47], s23 offen lds
v_mfma_f32_16x16x32_bf16 v[208:211], a[24:27], a[108:111], v[208:211]
ds_read_b64_tr_b16 a[98:99], v12 offset:18176
v_lshl_add_u32 v22, s42, 7, v22
v_mfma_f32_16x16x32_bf16 v[208:211], a[8:11], a[104:107], v[208:211]
ds_read_b64_tr_b16 a[100:101], v12 offset:25344
v_lshl_add_u32 v23, s42, 7, v23
v_mfma_f32_16x16x32_bf16 v[204:207], a[4:7], a[104:107], v[204:207]
ds_read_b64_tr_b16 a[102:103], v12 offset:26368
v_mfma_f32_16x16x32_bf16 v[204:207], a[20:23], a[108:111], v[204:207]
v_mfma_f32_16x16x32_bf16 v[200:203], a[16:19], a[108:111], v[200:203]
v_mfma_f32_16x16x32_bf16 v[200:203], a[0:3], a[104:107], v[200:203]
s_mov_b32 s9, 0x400000
s_waitcnt lgkmcnt(4)
v_mfma_f32_16x16x32_bf16 v[216:219], a[0:3], a[80:83], v[216:219]
buffer_load_dword a120, v18, s[52:55], s9 offen
v_mfma_f32_16x16x32_bf16 v[216:219], a[16:19], a[84:87], v[216:219]
ds_read_b64_tr_b16 a[104:105], v13 offset:17152
v_mfma_f32_16x16x32_bf16 v[220:223], a[20:23], a[84:87], v[220:223]
ds_read_b64_tr_b16 a[106:107], v13 offset:18176
v_mfma_f32_16x16x32_bf16 v[220:223], a[4:7], a[80:83], v[220:223]
ds_read_b64_tr_b16 a[108:109], v13 offset:25344
v_mfma_f32_16x16x32_bf16 v[224:227], a[8:11], a[80:83], v[224:227]
ds_read_b64_tr_b16 a[110:111], v13 offset:26368
v_add_u32 v12, 0x8000, v12
v_mfma_f32_16x16x32_bf16 v[224:227], a[24:27], a[84:87], v[224:227]
v_add_u32 v13, 0x8000, v13
v_mfma_f32_16x16x32_bf16 v[228:231], a[28:31], a[84:87], v[228:231]
v_mfma_f32_16x16x32_bf16 v[228:231], a[12:15], a[80:83], v[228:231]
v_mfma_f32_16x16x32_bf16 v[244:247], a[12:15], a[88:91], v[244:247]
s_waitcnt vmcnt(27) lgkmcnt(0)
v_mfma_f32_16x16x32_bf16 v[244:247], a[28:31], a[92:95], v[244:247]
s_barrier
s_add_u32 m0, s17, 0x0
v_mfma_f32_16x16x32_bf16 v[240:243], a[24:27], a[92:95], v[240:243]
buffer_load_dwordx4 v5, s[52:55], 0 offen lds
v_mfma_f32_16x16x32_bf16 v[240:243], a[8:11], a[88:91], v[240:243]
ds_read_b64_tr_b16 a[80:81], v12 offset:0
v_mfma_f32_16x16x32_bf16 v[236:239], a[4:7], a[88:91], v[236:239]
ds_read_b64_tr_b16 a[82:83], v12 offset:1024
v_mfma_f32_16x16x32_bf16 v[236:239], a[20:23], a[92:95], v[236:239]
ds_read_b64_tr_b16 a[84:85], v12 offset:8192
v_mfma_f32_16x16x32_bf16 v[232:235], a[16:19], a[92:95], v[232:235]
ds_read_b64_tr_b16 a[86:87], v12 offset:9216
v_mfma_f32_16x16x32_bf16 v[232:235], a[0:3], a[88:91], v[232:235]
s_waitcnt lgkmcnt(4)
v_mfma_f32_16x16x32_bf16 v[248:251], a[0:3], a[96:99], v[248:251]
ds_read_b64_tr_b16 a[88:89], v13 offset:0
s_add_u32 m0, s17, 0x400
v_mfma_f32_16x16x32_bf16 v[248:251], a[16:19], a[100:103], v[248:251]
buffer_load_dwordx4 v5, s[52:55], s13 offen lds
v_mfma_f32_16x16x32_bf16 v[252:255], a[20:23], a[100:103], v[252:255]
ds_read_b64_tr_b16 a[90:91], v13 offset:1024
v_mfma_f32_16x16x32_bf16 v[252:255], a[4:7], a[96:99], v[252:255]
ds_read_b64_tr_b16 a[92:93], v13 offset:8192
v_mfma_f32_16x16x32_bf16 a[232:235], a[8:11], a[96:99], a[232:235]
ds_read_b64_tr_b16 a[94:95], v13 offset:9216
v_mfma_f32_16x16x32_bf16 a[232:235], a[24:27], a[100:103], a[232:235]
v_mfma_f32_16x16x32_bf16 a[236:239], a[28:31], a[100:103], a[236:239]
v_mfma_f32_16x16x32_bf16 a[236:239], a[12:15], a[96:99], a[236:239]
s_add_u32 m0, s17, 0x800
v_mfma_f32_16x16x32_bf16 a[252:255], a[12:15], a[104:107], a[252:255]
buffer_load_dwordx4 v6, s[52:55], 0 offen lds
v_mfma_f32_16x16x32_bf16 a[252:255], a[28:31], a[108:111], a[252:255]
ds_read_b64_tr_b16 a[96:97], v12 offset:256
v_mfma_f32_16x16x32_bf16 a[248:251], a[24:27], a[108:111], a[248:251]
ds_read_b64_tr_b16 a[98:99], v12 offset:1280
v_mfma_f32_16x16x32_bf16 a[248:251], a[8:11], a[104:107], a[248:251]
ds_read_b64_tr_b16 a[100:101], v12 offset:8448
v_mfma_f32_16x16x32_bf16 a[244:247], a[4:7], a[104:107], a[244:247]
ds_read_b64_tr_b16 a[102:103], v12 offset:9472
v_mfma_f32_16x16x32_bf16 a[244:247], a[20:23], a[108:111], a[244:247]
v_mfma_f32_16x16x32_bf16 a[240:243], a[16:19], a[108:111], a[240:243]
v_mfma_f32_16x16x32_bf16 a[240:243], a[0:3], a[104:107], a[240:243]
s_add_u32 m0, s17, 0xc00
s_waitcnt lgkmcnt(4)
L_S7:
v_mfma_f32_16x16x32_bf16 v[24:27], a[80:83], a[32:35], v[24:27]
buffer_load_dwordx4 v6, s[52:55], s13 offen lds
v_mfma_f32_16x16x32_bf16 v[24:27], a[84:87], a[48:51], v[24:27]
ds_read_b64_tr_b16 a[104:105], v13 offset:256
s_waitcnt vmcnt(22)
v_mfma_f32_16x16x32_bf16 v[32:35], a[84:87], a[52:55], v[32:35]
ds_read_b64_tr_b16 a[106:107], v13 offset:1280
v_mfma_f32_16x16x32_bf16 v[32:35], a[80:83], a[36:39], v[32:35]
ds_read_b64_tr_b16 a[108:109], v13 offset:8448
v_mfma_f32_16x16x32_bf16 v[40:43], a[80:83], a[40:43], v[40:43]
ds_read_b64_tr_b16 a[110:111], v13 offset:9472
v_mfma_f32_16x16x32_bf16 v[40:43], a[84:87], a[56:59], v[40:43]
ds_read_b128 a[0:3], v8 offset:0
v_mfma_f32_16x16x32_bf16 v[48:51], a[84:87], a[60:63], v[48:51]
ds_read_b128 a[16:19], v9 offset:0
s_add_u32 m0, s18, 0x4000
v_mfma_f32_16x16x32_bf16 v[48:51], a[80:83], a[44:47], v[48:51]
buffer_load_dwordx4 v7, s[68:71], 0 offen lds
v_mfma_f32_16x16x32_bf16 v[52:55], a[88:91], a[44:47], v[52:55]
ds_read_b64_tr_b16 a[80:81], v12 offset:512
v_mfma_f32_16x16x32_bf16 v[52:55], a[92:95], a[60:63], v[52:55]
ds_read_b64_tr_b16 a[82:83], v12 offset:1536
v_mfma_f32_16x16x32_bf16 v[44:47], a[92:95], a[56:59], v[44:47]
ds_read_b64_tr_b16 a[84:85], v12 offset:8704
v_mfma_f32_16x16x32_bf16 v[44:47], a[88:91], a[40:43], v[44:47]
ds_read_b64_tr_b16 a[86:87], v12 offset:9728
v_mfma_f32_16x16x32_bf16 v[36:39], a[88:91], a[36:39], v[36:39]
ds_read_b128 a[4:7], v8 offset:2048
v_mfma_f32_16x16x32_bf16 v[36:39], a[92:95], a[52:55], v[36:39]
ds_read_b128 a[20:23], v9 offset:2048
s_waitcnt lgkmcnt(8)
v_mfma_f32_16x16x32_bf16 v[28:31], a[92:95], a[48:51], v[28:31]
ds_read_b128 a[8:11], v8 offset:4096
s_add_u32 m0, s18, 0x5000
v_mfma_f32_16x16x32_bf16 v[28:31], a[88:91], a[32:35], v[28:31]
buffer_load_dwordx4 v7, s[68:71], s25 offen lds
v_mfma_f32_16x16x32_bf16 v[56:59], a[96:99], a[32:35], v[56:59]
ds_read_b64_tr_b16 a[88:89], v13 offset:512
v_mfma_f32_16x16x32_bf16 v[56:59], a[100:103], a[48:51], v[56:59]
ds_read_b64_tr_b16 a[90:91], v13 offset:1536
v_mfma_f32_16x16x32_bf16 v[64:67], a[100:103], a[52:55], v[64:67]
ds_read_b64_tr_b16 a[92:93], v13 offset:8704
v_mfma_f32_16x16x32_bf16 v[64:67], a[96:99], a[36:39], v[64:67]
ds_read_b64_tr_b16 a[94:95], v13 offset:9728
v_cvt_pk_bf16_f32 v24, v24, v25
v_cvt_pk_bf16_f32 v25, v26, v27
v_mfma_f32_16x16x32_bf16 v[72:75], a[96:99], a[40:43], v[72:75]
ds_read_b128 a[24:27], v9 offset:4096
v_cvt_pk_bf16_f32 v26, v28, v29
v_mfma_f32_16x16x32_bf16 v[72:75], a[100:103], a[56:59], v[72:75]
ds_read_b128 a[12:15], v8 offset:6144
s_add_u32 m0, s18, 0x6000
v_mfma_f32_16x16x32_bf16 v[80:83], a[100:103], a[60:63], v[80:83]
buffer_load_dwordx4 v7, s[68:71], s26 offen lds
v_cvt_pk_bf16_f32 v27, v30, v31
v_mfma_f32_16x16x32_bf16 v[80:83], a[96:99], a[44:47], v[80:83]
ds_read_b128 a[28:31], v9 offset:6144
v_lshl_add_u32 v5, s42, 19, v5
v_mfma_f32_16x16x32_bf16 v[84:87], a[104:107], a[44:47], v[84:87]
ds_read_b64_tr_b16 a[96:97], v12 offset:768
v_lshl_add_u32 v6, s42, 19, v6
v_mfma_f32_16x16x32_bf16 v[84:87], a[108:111], a[60:63], v[84:87]
ds_read_b64_tr_b16 a[98:99], v12 offset:1792
v_lshl_add_u32 v7, s42, 18, v7
v_accvgpr_write_b32 a128, v24
v_mfma_f32_16x16x32_bf16 v[76:79], a[108:111], a[56:59], v[76:79]
ds_read_b64_tr_b16 a[100:101], v12 offset:8960
v_lshl_add_u32 v7, s42, 17, v7
v_mfma_f32_16x16x32_bf16 v[76:79], a[104:107], a[40:43], v[76:79]
ds_read_b64_tr_b16 a[102:103], v12 offset:9984
v_accvgpr_write_b32 a129, v25
v_mfma_f32_16x16x32_bf16 v[68:71], a[104:107], a[36:39], v[68:71]
s_mov_b32 s9, 0x400000
v_accvgpr_write_b32 a130, v26
v_accvgpr_write_b32 a131, v27
v_cvt_pk_bf16_f32 v32, v32, v33
v_mfma_f32_16x16x32_bf16 v[68:71], a[108:111], a[52:55], v[68:71]
buffer_load_dword a120, v19, s[68:71], s9 offen
v_mfma_f32_16x16x32_bf16 v[60:63], a[108:111], a[48:51], v[60:63]
v_cvt_pk_bf16_f32 v33, v34, v35
v_cvt_pk_bf16_f32 v34, v36, v37
v_mfma_f32_16x16x32_bf16 v[60:63], a[104:107], a[32:35], v[60:63]
s_waitcnt lgkmcnt(7)
v_cvt_pk_bf16_f32 v35, v38, v39
v_accvgpr_write_b32 a132, v32
v_accvgpr_write_b32 a133, v33
v_mfma_f32_16x16x32_bf16 v[88:91], a[80:83], a[32:35], v[88:91]
ds_read_b64_tr_b16 a[104:105], v13 offset:768
v_accvgpr_write_b32 a134, v34
v_mfma_f32_16x16x32_bf16 v[88:91], a[84:87], a[48:51], v[88:91]
ds_read_b64_tr_b16 a[106:107], v13 offset:1792
v_accvgpr_write_b32 a135, v35
v_mfma_f32_16x16x32_bf16 v[96:99], a[84:87], a[52:55], v[96:99]
ds_read_b64_tr_b16 a[108:109], v13 offset:8960
v_cvt_pk_bf16_f32 v40, v40, v41
v_cvt_pk_bf16_f32 v41, v42, v43
v_mfma_f32_16x16x32_bf16 v[96:99], a[80:83], a[36:39], v[96:99]
ds_read_b64_tr_b16 a[110:111], v13 offset:9984
v_cvt_pk_bf16_f32 v42, v44, v45
v_mfma_f32_16x16x32_bf16 v[104:107], a[80:83], a[40:43], v[104:107]
s_add_u32 m0, s16, 0x0
s_waitcnt lgkmcnt(8)
v_cvt_pk_bf16_f32 v43, v46, v47
v_mfma_f32_16x16x32_bf16 v[104:107], a[84:87], a[56:59], v[104:107]
buffer_load_dwordx4 v22, s[44:47], s20 offen lds
v_accvgpr_write_b32 a136, v40
v_mfma_f32_16x16x32_bf16 v[112:115], a[84:87], a[60:63], v[112:115]
v_accvgpr_write_b32 a137, v41
v_accvgpr_write_b32 a138, v42
v_mfma_f32_16x16x32_bf16 v[112:115], a[80:83], a[44:47], v[112:115]
v_accvgpr_write_b32 a139, v43
v_cvt_pk_bf16_f32 v48, v48, v49
v_mfma_f32_16x16x32_bf16 v[116:119], a[88:91], a[44:47], v[116:119]
ds_read_b64_tr_b16 a[80:81], v12 offset:16384
v_cvt_pk_bf16_f32 v49, v50, v51
v_cvt_pk_bf16_f32 v50, v52, v53
v_mfma_f32_16x16x32_bf16 v[116:119], a[92:95], a[60:63], v[116:119]
ds_read_b64_tr_b16 a[82:83], v12 offset:17408
v_cvt_pk_bf16_f32 v51, v54, v55
v_mfma_f32_16x16x32_bf16 v[108:111], a[92:95], a[56:59], v[108:111]
ds_read_b64_tr_b16 a[84:85], v12 offset:24576
v_accvgpr_write_b32 a140, v48
v_mfma_f32_16x16x32_bf16 v[108:111], a[88:91], a[40:43], v[108:111]
ds_read_b64_tr_b16 a[86:87], v12 offset:25600
s_add_u32 m0, s16, 0x400
v_accvgpr_write_b32 a141, v49
v_mfma_f32_16x16x32_bf16 v[100:103], a[88:91], a[36:39], v[100:103]
buffer_load_dwordx4 v23, s[44:47], s20 offen lds
v_mfma_f32_16x16x32_bf16 v[100:103], a[92:95], a[52:55], v[100:103]
v_accvgpr_write_b32 a142, v50
v_accvgpr_write_b32 a143, v51
v_mfma_f32_16x16x32_bf16 v[92:95], a[92:95], a[48:51], v[92:95]
v_cvt_pk_bf16_f32 v56, v56, v57
v_cvt_pk_bf16_f32 v57, v58, v59
v_cvt_pk_bf16_f32 v58, v60, v61
v_mfma_f32_16x16x32_bf16 v[92:95], a[88:91], a[32:35], v[92:95]
s_waitcnt lgkmcnt(4)
v_cvt_pk_bf16_f32 v59, v62, v63
v_accvgpr_write_b32 a144, v56
v_mfma_f32_16x16x32_bf16 v[120:123], a[96:99], a[32:35], v[120:123]
ds_read_b64_tr_b16 a[88:89], v13 offset:16384
v_accvgpr_write_b32 a145, v57
v_mfma_f32_16x16x32_bf16 v[120:123], a[100:103], a[48:51], v[120:123]
ds_read_b64_tr_b16 a[90:91], v13 offset:17408
v_accvgpr_write_b32 a146, v58
v_accvgpr_write_b32 a147, v59
v_mfma_f32_16x16x32_bf16 v[128:131], a[100:103], a[52:55], v[128:131]
ds_read_b64_tr_b16 a[92:93], v13 offset:24576
v_cvt_pk_bf16_f32 v64, v64, v65
v_mfma_f32_16x16x32_bf16 v[128:131], a[96:99], a[36:39], v[128:131]
ds_read_b64_tr_b16 a[94:95], v13 offset:25600
s_add_u32 m0, s16, 0x800
v_mfma_f32_16x16x32_bf16 v[136:139], a[96:99], a[40:43], v[136:139]
buffer_load_dwordx4 v22, s[44:47], s21 offen lds
v_cvt_pk_bf16_f32 v65, v66, v67
v_mfma_f32_16x16x32_bf16 v[136:139], a[100:103], a[56:59], v[136:139]
v_cvt_pk_bf16_f32 v66, v68, v69
v_cvt_pk_bf16_f32 v67, v70, v71
v_mfma_f32_16x16x32_bf16 v[144:147], a[100:103], a[60:63], v[144:147]
v_accvgpr_write_b32 a148, v64
v_accvgpr_write_b32 a149, v65
v_mfma_f32_16x16x32_bf16 v[144:147], a[96:99], a[44:47], v[144:147]
v_accvgpr_write_b32 a150, v66
v_accvgpr_write_b32 a151, v67
v_cvt_pk_bf16_f32 v72, v72, v73
v_mfma_f32_16x16x32_bf16 v[148:151], a[104:107], a[44:47], v[148:151]
ds_read_b64_tr_b16 a[96:97], v12 offset:16640
v_cvt_pk_bf16_f32 v73, v74, v75
v_mfma_f32_16x16x32_bf16 v[148:151], a[108:111], a[60:63], v[148:151]
ds_read_b64_tr_b16 a[98:99], v12 offset:17664
v_cvt_pk_bf16_f32 v74, v76, v77
v_mfma_f32_16x16x32_bf16 v[140:143], a[108:111], a[56:59], v[140:143]
ds_read_b64_tr_b16 a[100:101], v12 offset:24832
s_add_u32 m0, s16, 0xc00
v_cvt_pk_bf16_f32 v75, v78, v79
v_mfma_f32_16x16x32_bf16 v[140:143], a[104:107], a[40:43], v[140:143]
buffer_load_dwordx4 v23, s[44:47], s21 offen lds
v_mfma_f32_16x16x32_bf16 v[132:135], a[104:107], a[36:39], v[132:135]
ds_read_b64_tr_b16 a[102:103], v12 offset:25856
v_accvgpr_write_b32 a152, v72
v_mfma_f32_16x16x32_bf16 v[132:135], a[108:111], a[52:55], v[132:135]
v_accvgpr_write_b32 a153, v73
v_accvgpr_write_b32 a154, v74
v_accvgpr_write_b32 a155, v75
v_mfma_f32_16x16x32_bf16 v[124:127], a[108:111], a[48:51], v[124:127]
v_cvt_pk_bf16_f32 v80, v80, v81
v_cvt_pk_bf16_f32 v81, v82, v83
v_mfma_f32_16x16x32_bf16 v[124:127], a[104:107], a[32:35], v[124:127]
s_waitcnt lgkmcnt(4)
v_cvt_pk_bf16_f32 v82, v84, v85
v_cvt_pk_bf16_f32 v83, v86, v87
v_mfma_f32_16x16x32_bf16 v[152:155], a[32:35], a[80:83], v[152:155]
ds_read_b64_tr_b16 a[104:105], v13 offset:16640
v_accvgpr_write_b32 a156, v80
v_accvgpr_write_b32 a157, v81
v_mfma_f32_16x16x32_bf16 v[152:155], a[48:51], a[84:87], v[152:155]
ds_read_b64_tr_b16 a[106:107], v13 offset:17664
s_add_u32 m0, s16, 0x1000
v_mfma_f32_16x16x32_bf16 v[156:159], a[52:55], a[84:87], v[156:159]
buffer_load_dwordx4 v22, s[44:47], s22 offen lds
v_mfma_f32_16x16x32_bf16 v[156:159], a[36:39], a[80:83], v[156:159]
ds_read_b64_tr_b16 a[108:109], v13 offset:24832
v_accvgpr_write_b32 a158, v82
v_accvgpr_write_b32 a159, v83
v_mfma_f32_16x16x32_bf16 v[160:163], a[40:43], a[80:83], v[160:163]
ds_read_b64_tr_b16 a[110:111], v13 offset:25856
v_cvt_pk_bf16_f32 v88, v88, v89
v_mfma_f32_16x16x32_bf16 v[160:163], a[56:59], a[84:87], v[160:163]
v_cvt_pk_bf16_f32 v89, v90, v91
v_cvt_pk_bf16_f32 v90, v92, v93
v_mfma_f32_16x16x32_bf16 v[164:167], a[60:63], a[84:87], v[164:167]
v_cvt_pk_bf16_f32 v91, v94, v95
v_accvgpr_write_b32 a160, v88
v_accvgpr_write_b32 a161, v89
v_mfma_f32_16x16x32_bf16 v[164:167], a[44:47], a[80:83], v[164:167]
v_accvgpr_write_b32 a162, v90
v_accvgpr_write_b32 a163, v91
v_mfma_f32_16x16x32_bf16 v[180:183], a[44:47], a[88:91], v[180:183]
ds_read_b64_tr_b16 a[80:81], v12 offset:16896
v_cvt_pk_bf16_f32 v96, v96, v97
v_mfma_f32_16x16x32_bf16 v[180:183], a[60:63], a[92:95], v[180:183]
ds_read_b64_tr_b16 a[82:83], v12 offset:17920
s_add_u32 m0, s16, 0x1400
v_cvt_pk_bf16_f32 v97, v98, v99
v_mfma_f32_16x16x32_bf16 v[176:179], a[56:59], a[92:95], v[176:179]
buffer_load_dwordx4 v23, s[44:47], s22 offen lds
v_mfma_f32_16x16x32_bf16 v[176:179], a[40:43], a[88:91], v[176:179]
ds_read_b64_tr_b16 a[84:85], v12 offset:25088
v_cvt_pk_bf16_f32 v98, v100, v101
v_mfma_f32_16x16x32_bf16 v[172:175], a[36:39], a[88:91], v[172:175]
ds_read_b64_tr_b16 a[86:87], v12 offset:26112
v_cvt_pk_bf16_f32 v99, v102, v103
v_accvgpr_write_b32 a164, v96
v_mfma_f32_16x16x32_bf16 v[172:175], a[52:55], a[92:95], v[172:175]
v_accvgpr_write_b32 a165, v97
v_accvgpr_write_b32 a166, v98
v_mfma_f32_16x16x32_bf16 v[168:171], a[48:51], a[92:95], v[168:171]
v_accvgpr_write_b32 a167, v99
v_cvt_pk_bf16_f32 v104, v104, v105
v_mfma_f32_16x16x32_bf16 v[168:171], a[32:35], a[88:91], v[168:171]
s_waitcnt lgkmcnt(4)
v_cvt_pk_bf16_f32 v105, v106, v107
v_cvt_pk_bf16_f32 v106, v108, v109
v_cvt_pk_bf16_f32 v107, v110, v111
v_mfma_f32_16x16x32_bf16 v[184:187], a[32:35], a[96:99], v[184:187]
ds_read_b64_tr_b16 a[88:89], v13 offset:16896
s_add_u32 m0, s16, 0x1800
v_mfma_f32_16x16x32_bf16 v[184:187], a[48:51], a[100:103], v[184:187]
buffer_load_dwordx4 v22, s[44:47], s23 offen lds
v_mfma_f32_16x16x32_bf16 v[188:191], a[52:55], a[100:103], v[188:191]
ds_read_b64_tr_b16 a[90:91], v13 offset:17920
v_accvgpr_write_b32 a168, v104
v_accvgpr_write_b32 a169, v105
v_mfma_f32_16x16x32_bf16 v[188:191], a[36:39], a[96:99], v[188:191]
ds_read_b64_tr_b16 a[92:93], v13 offset:25088
v_accvgpr_write_b32 a170, v106
v_mfma_f32_16x16x32_bf16 v[192:195], a[40:43], a[96:99], v[192:195]
ds_read_b64_tr_b16 a[94:95], v13 offset:26112
v_accvgpr_write_b32 a171, v107
v_mfma_f32_16x16x32_bf16 v[192:195], a[56:59], a[100:103], v[192:195]
L_padA4:
s_cmp_eq_u32 s95, 1
s_cbranch_scc1 L_padA8
v_cvt_pk_bf16_f32 v112, v112, v113
v_cvt_pk_bf16_f32 v113, v114, v115
v_cvt_pk_bf16_f32 v114, v116, v117
v_mfma_f32_16x16x32_bf16 v[196:199], a[60:63], a[100:103], v[196:199]
v_cvt_pk_bf16_f32 v115, v118, v119
v_accvgpr_write_b32 a172, v112
v_mfma_f32_16x16x32_bf16 v[196:199], a[44:47], a[96:99], v[196:199]
v_accvgpr_write_b32 a173, v113
v_accvgpr_write_b32 a174, v114
v_mfma_f32_16x16x32_bf16 v[212:215], a[44:47], a[104:107], v[212:215]
ds_read_b64_tr_b16 a[96:97], v12 offset:17152
s_add_u32 m0, s16, 0x1c00
v_accvgpr_write_b32 a175, v115
v_mfma_f32_16x16x32_bf16 v[212:215], a[60:63], a[108:111], v[212:215]
buffer_load_dwordx4 v23, s[44:47], s23 offen lds
v_mfma_f32_16x16x32_bf16 v[208:211], a[56:59], a[108:111], v[208:211]
ds_read_b64_tr_b16 a[98:99], v12 offset:18176
v_lshl_add_u32 v22, s42, 7, v22
v_mfma_f32_16x16x32_bf16 v[208:211], a[40:43], a[104:107], v[208:211]
ds_read_b64_tr_b16 a[100:101], v12 offset:25344
v_lshl_add_u32 v23, s42, 7, v23
v_cvt_pk_bf16_f32 v120, v120, v121
v_mfma_f32_16x16x32_bf16 v[204:207], a[36:39], a[104:107], v[204:207]
ds_read_b64_tr_b16 a[102:103], v12 offset:26368
v_cvt_pk_bf16_f32 v121, v122, v123
v_mfma_f32_16x16x32_bf16 v[204:207], a[52:55], a[108:111], v[204:207]
v_cvt_pk_bf16_f32 v122, v124, v125
v_cvt_pk_bf16_f32 v123, v126, v127
v_mfma_f32_16x16x32_bf16 v[200:203], a[48:51], a[108:111], v[200:203]
v_accvgpr_write_b32 a176, v120
v_accvgpr_write_b32 a177, v121
v_accvgpr_write_b32 a178, v122
v_mfma_f32_16x16x32_bf16 v[200:203], a[32:35], a[104:107], v[200:203]
s_mov_b32 s9, 0x600000
s_waitcnt lgkmcnt(4)
v_accvgpr_write_b32 a179, v123
v_mfma_f32_16x16x32_bf16 v[216:219], a[32:35], a[80:83], v[216:219]
buffer_load_dword a120, v18, s[52:55], s9 offen
v_mfma_f32_16x16x32_bf16 v[216:219], a[48:51], a[84:87], v[216:219]
ds_read_b64_tr_b16 a[104:105], v13 offset:17152
v_cvt_pk_bf16_f32 v128, v128, v129
v_cvt_pk_bf16_f32 v129, v130, v131
v_mfma_f32_16x16x32_bf16 v[220:223], a[52:55], a[84:87], v[220:223]
ds_read_b64_tr_b16 a[106:107], v13 offset:18176
v_cvt_pk_bf16_f32 v130, v132, v133
v_mfma_f32_16x16x32_bf16 v[220:223], a[36:39], a[80:83], v[220:223]
ds_read_b64_tr_b16 a[108:109], v13 offset:25344
v_cvt_pk_bf16_f32 v131, v134, v135
v_mfma_f32_16x16x32_bf16 v[224:227], a[40:43], a[80:83], v[224:227]
ds_read_b64_tr_b16 a[110:111], v13 offset:26368
v_add_u32 v12, 0x8000, v12
v_accvgpr_write_b32 a180, v128
v_mfma_f32_16x16x32_bf16 v[224:227], a[56:59], a[84:87], v[224:227]
v_add_u32 v13, 0x8000, v13
v_accvgpr_write_b32 a181, v129
v_mfma_f32_16x16x32_bf16 v[228:231], a[60:63], a[84:87], v[228:231]
v_accvgpr_write_b32 a182, v130
v_accvgpr_write_b32 a183, v131
v_mfma_f32_16x16x32_bf16 v[228:231], a[44:47], a[80:83], v[228:231]
v_cvt_pk_bf16_f32 v136, v136, v137
v_cvt_pk_bf16_f32 v137, v138, v139
v_cvt_pk_bf16_f32 v138, v140, v141
v_mfma_f32_16x16x32_bf16 v[244:247], a[44:47], a[88:91], v[244:247]
s_waitcnt vmcnt(27) lgkmcnt(0)
v_cvt_pk_bf16_f32 v139, v142, v143
v_accvgpr_write_b32 a184, v136
v_mfma_f32_16x16x32_bf16 v[244:247], a[60:63], a[92:95], v[244:247]
s_barrier
s_add_u32 m0, s17, 0x8000
v_accvgpr_write_b32 a185, v137
v_mfma_f32_16x16x32_bf16 v[240:243], a[56:59], a[92:95], v[240:243]
buffer_load_dwordx4 v5, s[52:55], 0 offen lds
v_accvgpr_write_b32 a186, v138
v_mfma_f32_16x16x32_bf16 v[240:243], a[40:43], a[88:91], v[240:243]
ds_read_b64_tr_b16 a[80:81], v12 offset:0
v_accvgpr_write_b32 a187, v139
v_mfma_f32_16x16x32_bf16 v[236:239], a[36:39], a[88:91], v[236:239]
ds_read_b64_tr_b16 a[82:83], v12 offset:1024
v_cvt_pk_bf16_f32 v144, v144, v145
v_mfma_f32_16x16x32_bf16 v[236:239], a[52:55], a[92:95], v[236:239]
ds_read_b64_tr_b16 a[84:85], v12 offset:8192
v_cvt_pk_bf16_f32 v145, v146, v147
v_cvt_pk_bf16_f32 v146, v148, v149
v_mfma_f32_16x16x32_bf16 v[232:235], a[48:51], a[92:95], v[232:235]
ds_read_b64_tr_b16 a[86:87], v12 offset:9216
v_cvt_pk_bf16_f32 v147, v150, v151
v_mfma_f32_16x16x32_bf16 v[232:235], a[32:35], a[88:91], v[232:235]
s_add_u32 m0, s17, 0x8400
s_waitcnt lgkmcnt(4)
v_accvgpr_write_b32 a188, v144
v_mfma_f32_16x16x32_bf16 v[248:251], a[32:35], a[96:99], v[248:251]
buffer_load_dwordx4 v5, s[52:55], s13 offen lds
v_accvgpr_write_b32 a189, v145
v_mfma_f32_16x16x32_bf16 v[248:251], a[48:51], a[100:103], v[248:251]
ds_read_b64_tr_b16 a[88:89], v13 offset:0
v_accvgpr_write_b32 a190, v146
v_mfma_f32_16x16x32_bf16 v[252:255], a[52:55], a[100:103], v[252:255]
ds_read_b64_tr_b16 a[90:91], v13 offset:1024
v_accvgpr_write_b32 a191, v147
v_mfma_f32_16x16x32_bf16 v[252:255], a[36:39], a[96:99], v[252:255]
ds_read_b64_tr_b16 a[92:93], v13 offset:8192
v_cvt_pk_bf16_f32 v152, v152, v153
v_cvt_pk_bf16_f32 v153, v154, v155
v_mfma_f32_16x16x32_bf16 a[232:235], a[40:43], a[96:99], a[232:235]
ds_read_b64_tr_b16 a[94:95], v13 offset:9216
v_cvt_pk_bf16_f32 v154, v156, v157
v_mfma_f32_16x16x32_bf16 a[232:235], a[56:59], a[100:103], a[232:235]
v_cvt_pk_bf16_f32 v155, v158, v159
v_accvgpr_write_b32 a192, v152
v_mfma_f32_16x16x32_bf16 a[236:239], a[60:63], a[100:103], a[236:239]
s_add_u32 m0, s17, 0x8800
v_accvgpr_write_b32 a193, v153
v_accvgpr_write_b32 a194, v154
v_accvgpr_write_b32 a195, v155
v_mfma_f32_16x16x32_bf16 a[236:239], a[44:47], a[96:99], a[236:239]
buffer_load_dwordx4 v6, s[52:55], 0 offen lds
v_mfma_f32_16x16x32_bf16 a[252:255], a[44:47], a[104:107], a[252:255]
ds_read_b64_tr_b16 a[96:97], v12 offset:256
v_cvt_pk_bf16_f32 v160, v160, v161
v_mfma_f32_16x16x32_bf16 a[252:255], a[60:63], a[108:111], a[252:255]
ds_read_b64_tr_b16 a[98:99], v12 offset:1280
v_cvt_pk_bf16_f32 v161, v162, v163
v_cvt_pk_bf16_f32 v162, v164, v165
v_mfma_f32_16x16x32_bf16 a[248:251], a[56:59], a[108:111], a[248:251]
ds_read_b64_tr_b16 a[100:101], v12 offset:8448
v_cvt_pk_bf16_f32 v163, v166, v167
v_mfma_f32_16x16x32_bf16 a[248:251], a[40:43], a[104:107], a[248:251]
ds_read_b64_tr_b16 a[102:103], v12 offset:9472
v_accvgpr_write_b32 a196, v160
v_mfma_f32_16x16x32_bf16 a[244:247], a[36:39], a[104:107], a[244:247]
v_accvgpr_write_b32 a197, v161
v_accvgpr_write_b32 a198, v162
v_accvgpr_write_b32 a199, v163
v_mfma_f32_16x16x32_bf16 a[244:247], a[52:55], a[108:111], a[244:247]
s_add_u32 m0, s17, 0x8c00
v_cvt_pk_bf16_f32 v168, v168, v169
v_cvt_pk_bf16_f32 v169, v170, v171
v_mfma_f32_16x16x32_bf16 a[240:243], a[48:51], a[108:111], a[240:243]
buffer_load_dwordx4 v6, s[52:55], s13 offen lds
v_mfma_f32_16x16x32_bf16 a[240:243], a[32:35], a[104:107], a[240:243]
s_waitcnt lgkmcnt(4)
v_cvt_pk_bf16_f32 v170, v172, v173
v_cvt_pk_bf16_f32 v171, v174, v175
v_accvgpr_write_b32 a200, v168
L_S8:
v_mfma_f32_16x16x32_bf16 v[24:27], a[80:83], a[0:3], 0
ds_read_b64_tr_b16 a[104:105], v13 offset:256
s_waitcnt vmcnt(22)
v_mfma_f32_16x16x32_bf16 v[24:27], a[84:87], a[16:19], v[24:27]
ds_read_b64_tr_b16 a[106:107], v13 offset:1280
v_accvgpr_write_b32 a201, v169
v_mfma_f32_16x16x32_bf16 v[32:35], a[84:87], a[20:23], 0
ds_read_b64_tr_b16 a[108:109], v13 offset:8448
v_accvgpr_write_b32 a202, v170
v_accvgpr_write_b32 a203, v171
v_mfma_f32_16x16x32_bf16 v[32:35], a[80:83], a[4:7], v[32:35]
ds_read_b64_tr_b16 a[110:111], v13 offset:9472
v_cvt_pk_bf16_f32 v176, v176, v177
v_mfma_f32_16x16x32_bf16 v[40:43], a[80:83], a[8:11], 0
ds_read_b128 a[32:35], v8 offset:32768
s_add_u32 m0, s18, 0xc000
v_mfma_f32_16x16x32_bf16 v[40:43], a[84:87], a[24:27], v[40:43]
buffer_load_dwordx4 v7, s[68:71], 0 offen lds
v_cvt_pk_bf16_f32 v177, v178, v179
v_mfma_f32_16x16x32_bf16 v[48:51], a[84:87], a[28:31], 0
ds_read_b128 a[48:51], v9 offset:32768
v_cvt_pk_bf16_f32 v178, v180, v181
v_mfma_f32_16x16x32_bf16 v[48:51], a[80:83], a[12:15], v[48:51]
ds_read_b128 a[36:39], v8 offset:34816
v_cvt_pk_bf16_f32 v179, v182, v183
v_mfma_f32_16x16x32_bf16 v[52:55], a[88:91], a[12:15], 0
ds_read_b64_tr_b16 a[80:81], v12 offset:512
v_accvgpr_write_b32 a204, v176
v_accvgpr_write_b32 a205, v177
v_mfma_f32_16x16x32_bf16 v[52:55], a[92:95], a[28:31], v[52:55]
ds_read_b64_tr_b16 a[82:83], v12 offset:1536
v_accvgpr_write_b32 a206, v178
v_mfma_f32_16x16x32_bf16 v[44:47], a[92:95], a[24:27], 0
ds_read_b64_tr_b16 a[84:85], v12 offset:8704
s_add_u32 s8, s28, 0x2000
v_mfma_f32_16x16x32_bf16 v[44:47], a[88:91], a[8:11], v[44:47]
buffer_store_dwordx4 a[128:131], v16, s[88:91], s8 offen sc1
v_accvgpr_write_b32 a207, v179
v_mfma_f32_16x16x32_bf16 v[36:39], a[88:91], a[4:7], 0
ds_read_b64_tr_b16 a[86:87], v12 offset:9728
v_cvt_pk_bf16_f32 v184, v184, v185
v_mfma_f32_16x16x32_bf16 v[36:39], a[92:95], a[20:23], v[36:39]
ds_read_b128 a[52:55], v9 offset:34816
v_cvt_pk_bf16_f32 v185, v186, v187
v_mfma_f32_16x16x32_bf16 v[28:31], a[92:95], a[16:19], 0
ds_read_b128 a[40:43], v8 offset:36864
v_cvt_pk_bf16_f32 v186, v188, v189
v_cvt_pk_bf16_f32 v187, v190, v191
v_mfma_f32_16x16x32_bf16 v[28:31], a[88:91], a[0:3], v[28:31]
ds_read_b128 a[56:59], v9 offset:36864
s_waitcnt lgkmcnt(10)
v_mfma_f32_16x16x32_bf16 v[56:59], a[96:99], a[0:3], 0
ds_read_b64_tr_b16 a[88:89], v13 offset:512
v_accvgpr_write_b32 a208, v184
v_mfma_f32_16x16x32_bf16 v[56:59], a[100:103], a[16:19], v[56:59]
ds_read_b64_tr_b16 a[90:91], v13 offset:1536
s_add_u32 m0, s18, 0xd000
v_accvgpr_write_b32 a209, v185
v_mfma_f32_16x16x32_bf16 v[64:67], a[100:103], a[20:23], 0
buffer_load_dwordx4 v7, s[68:71], s25 offen lds
v_mfma_f32_16x16x32_bf16 v[64:67], a[96:99], a[4:7], v[64:67]
ds_read_b64_tr_b16 a[92:93], v13 offset:8704
v_accvgpr_write_b32 a210, v186
v_mfma_f32_16x16x32_bf16 v[72:75], a[96:99], a[8:11], 0
ds_read_b64_tr_b16 a[94:95], v13 offset:9728
v_accvgpr_write_b32 a211, v187
v_cvt_pk_bf16_f32 v192, v192, v193
v_mfma_f32_16x16x32_bf16 v[72:75], a[100:103], a[24:27], v[72:75]
ds_read_b128 a[44:47], v8 offset:38912
v_cvt_pk_bf16_f32 v193, v194, v195
v_mfma_f32_16x16x32_bf16 v[80:83], a[100:103], a[28:31], 0
ds_read_b128 a[60:63], v9 offset:38912
v_cvt_pk_bf16_f32 v194, v196, v197
v_mfma_f32_16x16x32_bf16 v[80:83], a[96:99], a[12:15], v[80:83]
v_cvt_pk_bf16_f32 v195, v198, v199
v_accvgpr_write_b32 a212, v192
v_accvgpr_write_b32 a213, v193
v_mfma_f32_16x16x32_bf16 v[84:87], a[104:107], a[12:15], 0
ds_read_b64_tr_b16 a[96:97], v12 offset:768
s_add_u32 m0, s18, 0xe000
v_mfma_f32_16x16x32_bf16 v[84:87], a[108:111], a[28:31], v[84:87]
buffer_load_dwordx4 v7, s[68:71], s26 offen lds
v_mfma_f32_16x16x32_bf16 v[76:79], a[108:111], a[24:27], 0
ds_read_b64_tr_b16 a[98:99], v12 offset:1792
v_lshl_add_u32 v5, s42, 19, v5
v_accvgpr_write_b32 a214, v194
v_mfma_f32_16x16x32_bf16 v[76:79], a[104:107], a[8:11], v[76:79]
ds_read_b64_tr_b16 a[100:101], v12 offset:8960
v_lshl_add_u32 v6, s42, 19, v6
v_mfma_f32_16x16x32_bf16 v[68:71], a[104:107], a[4:7], 0
ds_read_b64_tr_b16 a[102:103], v12 offset:9984
v_lshl_add_u32 v7, s42, 18, v7
v_mfma_f32_16x16x32_bf16 v[68:71], a[108:111], a[20:23], v[68:71]
v_lshl_add_u32 v7, s42, 17, v7
v_accvgpr_write_b32 a215, v195
v_cvt_pk_bf16_f32 v200, v200, v201
v_mfma_f32_16x16x32_bf16 v[60:63], a[108:111], a[16:19], 0
v_cvt_pk_bf16_f32 v201, v202, v203
v_cvt_pk_bf16_f32 v202, v204, v205
v_mfma_f32_16x16x32_bf16 v[60:63], a[104:107], a[0:3], v[60:63]
s_add_u32 m0, s16, 0x8000
s_waitcnt lgkmcnt(4)
s_waitcnt lgkmcnt(6)
v_mfma_f32_16x16x32_bf16 v[88:91], a[80:83], a[0:3], 0
buffer_load_dwordx4 v22, s[44:47], s20 offen lds
v_cvt_pk_bf16_f32 v203, v206, v207
v_mfma_f32_16x16x32_bf16 v[88:91], a[84:87], a[16:19], v[88:91]
ds_read_b64_tr_b16 a[104:105], v13 offset:768
v_accvgpr_write_b32 a216, v200
v_mfma_f32_16x16x32_bf16 v[96:99], a[84:87], a[20:23], 0
ds_read_b64_tr_b16 a[106:107], v13 offset:1792
v_accvgpr_write_b32 a217, v201
v_mfma_f32_16x16x32_bf16 v[96:99], a[80:83], a[4:7], v[96:99]
ds_read_b64_tr_b16 a[108:109], v13 offset:8960
v_accvgpr_write_b32 a218, v202
v_accvgpr_write_b32 a219, v203
v_mfma_f32_16x16x32_bf16 v[104:107], a[80:83], a[8:11], 0
ds_read_b64_tr_b16 a[110:111], v13 offset:9984
s_add_u32 m0, s16, 0x8400
v_mfma_f32_16x16x32_bf16 v[104:107], a[84:87], a[24:27], v[104:107]
buffer_load_dwordx4 v23, s[44:47], s20 offen lds
v_mfma_f32_16x16x32_bf16 v[112:115], a[84:87], a[28:31], 0
v_cvt_pk_bf16_f32 v208, v208, v209
v_cvt_pk_bf16_f32 v209, v210, v211
v_cvt_pk_bf16_f32 v210, v212, v213
v_mfma_f32_16x16x32_bf16 v[112:115], a[80:83], a[12:15], v[112:115]
v_cvt_pk_bf16_f32 v211, v214, v215
v_accvgpr_write_b32 a220, v208
v_mfma_f32_16x16x32_bf16 v[116:119], a[88:91], a[12:15], 0
ds_read_b64_tr_b16 a[80:81], v14 offset:0
v_accvgpr_write_b32 a221, v209
v_mfma_f32_16x16x32_bf16 v[116:119], a[92:95], a[28:31], v[116:119]
ds_read_b64_tr_b16 a[82:83], v14 offset:256
v_accvgpr_write_b32 a222, v210
v_accvgpr_write_b32 a223, v211
v_mfma_f32_16x16x32_bf16 v[108:111], a[92:95], a[24:27], 0
ds_read_b64_tr_b16 a[84:85], v14 offset:2048
s_add_u32 m0, s16, 0x8800
v_mfma_f32_16x16x32_bf16 v[108:111], a[88:91], a[8:11], v[108:111]
buffer_load_dwordx4 v22, s[44:47], s21 offen lds
v_mfma_f32_16x16x32_bf16 v[100:103], a[88:91], a[4:7], 0
ds_read_b64_tr_b16 a[86:87], v14 offset:2304
v_cvt_pk_bf16_f32 v216, v216, v217
v_cvt_pk_bf16_f32 v217, v218, v219
v_mfma_f32_16x16x32_bf16 v[100:103], a[92:95], a[20:23], v[100:103]
v_cvt_pk_bf16_f32 v218, v220, v221
v_cvt_pk_bf16_f32 v219, v222, v223
v_mfma_f32_16x16x32_bf16 v[92:95], a[92:95], a[16:19], 0
v_accvgpr_write_b32 a224, v216
v_accvgpr_write_b32 a225, v217
v_mfma_f32_16x16x32_bf16 v[92:95], a[88:91], a[0:3], v[92:95]
s_add_u32 s8, s28, 0x3000
s_waitcnt lgkmcnt(4)
v_accvgpr_write_b32 a226, v218
v_accvgpr_write_b32 a227, v219
v_mfma_f32_16x16x32_bf16 v[120:123], a[96:99], a[0:3], 0
buffer_store_dwordx4 a[132:135], v16, s[88:91], s8 offen sc1
v_mfma_f32_16x16x32_bf16 v[120:123], a[100:103], a[16:19], v[120:123]
ds_read_b64_tr_b16 a[88:89], v15 offset:0
v_cvt_pk_bf16_f32 v224, v224, v225
v_mfma_f32_16x16x32_bf16 v[128:131], a[100:103], a[20:23], 0
ds_read_b64_tr_b16 a[90:91], v15 offset:256
v_cvt_pk_bf16_f32 v225, v226, v227
v_cvt_pk_bf16_f32 v226, v228, v229
v_mfma_f32_16x16x32_bf16 v[128:131], a[96:99], a[4:7], v[128:131]
ds_read_b64_tr_b16 a[92:93], v15 offset:2048
v_cvt_pk_bf16_f32 v227, v230, v231
v_mfma_f32_16x16x32_bf16 v[136:139], a[96:99], a[8:11], 0
ds_read_b64_tr_b16 a[94:95], v15 offset:2304
v_accvgpr_write_b32 a228, v224
v_mfma_f32_16x16x32_bf16 v[136:139], a[100:103], a[24:27], v[136:139]
s_add_u32 m0, s16, 0x8c00
v_accvgpr_write_b32 a229, v225
v_accvgpr_write_b32 a230, v226
v_accvgpr_write_b32 a231, v227
v_mfma_f32_16x16x32_bf16 v[144:147], a[100:103], a[28:31], 0
buffer_load_dwordx4 v23, s[44:47], s21 offen lds
v_mfma_f32_16x16x32_bf16 v[144:147], a[96:99], a[12:15], v[144:147]
v_cvt_pk_bf16_f32 v232, v232, v233
v_cvt_pk_bf16_f32 v233, v234, v235
v_mfma_f32_16x16x32_bf16 v[148:151], a[104:107], a[12:15], 0
ds_read_b64_tr_b16 a[96:97], v14 offset:4096
v_cvt_pk_bf16_f32 v234, v236, v237
v_cvt_pk_bf16_f32 v235, v238, v239
v_mfma_f32_16x16x32_bf16 v[148:151], a[108:111], a[28:31], v[148:151]
ds_read_b64_tr_b16 a[98:99], v14 offset:4352
v_accvgpr_write_b32 a112, v232
v_mfma_f32_16x16x32_bf16 v[140:143], a[108:111], a[24:27], 0
ds_read_b64_tr_b16 a[100:101], v14 offset:6144
v_accvgpr_write_b32 a113, v233
v_mfma_f32_16x16x32_bf16 v[140:143], a[104:107], a[8:11], v[140:143]
ds_read_b64_tr_b16 a[102:103], v14 offset:6400
s_add_u32 m0, s16, 0x9000
v_accvgpr_write_b32 a114, v234
v_mfma_f32_16x16x32_bf16 v[132:135], a[104:107], a[4:7], 0
buffer_load_dwordx4 v22, s[44:47], s22 offen lds
v_mfma_f32_16x16x32_bf16 v[132:135], a[108:111], a[20:23], v[132:135]
v_accvgpr_write_b32 a115, v235
v_cvt_pk_bf16_f32 v240, v240, v241
v_mfma_f32_16x16x32_bf16 v[124:127], a[108:111], a[16:19], 0
v_cvt_pk_bf16_f32 v241, v242, v243
v_cvt_pk_bf16_f32 v242, v244, v245
v_cvt_pk_bf16_f32 v243, v246, v247
v_mfma_f32_16x16x32_bf16 v[124:127], a[104:107], a[0:3], v[124:127]
s_waitcnt lgkmcnt(4)
v_accvgpr_write_b32 a116, v240
v_accvgpr_write_b32 a117, v241
v_mfma_f32_16x16x32_bf16 v[152:155], a[80:83], a[0:3], 0
ds_read_b64_tr_b16 a[104:105], v15 offset:4096
s_add_u32 m0, s16, 0x9400
v_mfma_f32_16x16x32_bf16 v[152:155], a[84:87], a[16:19], v[152:155]
buffer_load_dwordx4 v23, s[44:47], s22 offen lds
v_accvgpr_write_b32 a118, v242
v_mfma_f32_16x16x32_bf16 v[160:163], a[84:87], a[20:23], 0
ds_read_b64_tr_b16 a[106:107], v15 offset:4352
v_accvgpr_write_b32 a119, v243
v_mfma_f32_16x16x32_bf16 v[160:163], a[80:83], a[4:7], v[160:163]
ds_read_b64_tr_b16 a[108:109], v15 offset:6144
v_cvt_pk_bf16_f32 v248, v248, v249
v_mfma_f32_16x16x32_bf16 v[168:171], a[80:83], a[8:11], 0
ds_read_b64_tr_b16 a[110:111], v15 offset:6400
v_cvt_pk_bf16_f32 v249, v250, v251
v_cvt_pk_bf16_f32 v250, v252, v253
v_mfma_f32_16x16x32_bf16 v[168:171], a[84:87], a[24:27], v[168:171]
v_cvt_pk_bf16_f32 v251, v254, v255
v_accvgpr_write_b32 a124, v248
v_mfma_f32_16x16x32_bf16 v[176:179], a[84:87], a[28:31], 0
s_add_u32 m0, s16, 0x9800
v_accvgpr_write_b32 a125, v249
v_accvgpr_write_b32 a126, v250
v_mfma_f32_16x16x32_bf16 v[176:179], a[80:83], a[12:15], v[176:179]
buffer_load_dwordx4 v22, s[44:47], s23 offen lds
v_accvgpr_write_b32 a127, v251
v_mfma_f32_16x16x32_bf16 v[180:183], a[88:91], a[12:15], 0
ds_read_b64_tr_b16 a[80:81], v14 offset:8192
v_accvgpr_read_b32 v2, a232
v_mfma_f32_16x16x32_bf16 v[180:183], a[92:95], a[28:31], v[180:183]
ds_read_b64_tr_b16 a[82:83], v14 offset:8448
v_accvgpr_read_b32 v3, a233
v_mfma_f32_16x16x32_bf16 v[172:175], a[92:95], a[24:27], 0
ds_read_b64_tr_b16 a[84:85], v14 offset:10240
v_cvt_pk_bf16_f32 v2, v2, v3
v_accvgpr_write_b32 a232, v2
v_mfma_f32_16x16x32_bf16 v[172:175], a[88:91], a[8:11], v[172:175]
ds_read_b64_tr_b16 a[86:87], v14 offset:10496
s_add_u32 m0, s16, 0x9c00
v_mfma_f32_16x16x32_bf16 v[164:167], a[88:91], a[4:7], 0
buffer_load_dwordx4 v23, s[44:47], s23 offen lds
v_mfma_f32_16x16x32_bf16 v[164:167], a[92:95], a[20:23], v[164:167]
v_lshl_add_u32 v22, s42, 7, v22
v_lshl_add_u32 v23, s42, 7, v23
v_accvgpr_read_b32 v2, a234
v_mfma_f32_16x16x32_bf16 v[156:159], a[92:95], a[16:19], 0
v_accvgpr_read_b32 v3, a235
v_cvt_pk_bf16_f32 v2, v2, v3
v_mfma_f32_16x16x32_bf16 v[156:159], a[88:91], a[0:3], v[156:159]
s_waitcnt lgkmcnt(4)
v_accvgpr_write_b32 a233, v2
v_accvgpr_read_b32 v2, a236
v_mfma_f32_16x16x32_bf16 v[184:187], a[96:99], a[0:3], 0
ds_read_b64_tr_b16 a[88:89], v15 offset:8192
v_accvgpr_read_b32 v3, a237
v_cvt_pk_bf16_f32 v2, v2, v3
v_mfma_f32_16x16x32_bf16 v[184:187], a[100:103], a[16:19], v[184:187]
ds_read_b64_tr_b16 a[90:91], v15 offset:8448
s_add_u32 s8, s28, 0x6000
v_mfma_f32_16x16x32_bf16 v[192:195], a[100:103], a[20:23], 0
buffer_store_dwordx4 a[136:139], v16, s[88:91], s8 offen sc1
v_mfma_f32_16x16x32_bf16 v[192:195], a[96:99], a[4:7], v[192:195]
ds_read_b64_tr_b16 a[92:93], v15 offset:10240
v_accvgpr_write_b32 a234, v2
v_accvgpr_read_b32 v2, a238
v_mfma_f32_16x16x32_bf16 v[200:203], a[96:99], a[8:11], 0
ds_read_b64_tr_b16 a[94:95], v15 offset:10496
v_add_u32 v12, 0xffff0000, v12
v_mfma_f32_16x16x32_bf16 v[200:203], a[100:103], a[24:27], v[200:203]
v_add_u32 v13, 0xffff0000, v13
v_add_u32 v14, 0xffff0000, v14
v_mfma_f32_16x16x32_bf16 v[208:211], a[100:103], a[28:31], 0
v_add_u32 v15, 0xffff0000, v15
v_accvgpr_read_b32 v3, a239
v_cvt_pk_bf16_f32 v2, v2, v3
v_mfma_f32_16x16x32_bf16 v[208:211], a[96:99], a[12:15], v[208:211]
v_accvgpr_write_b32 a235, v2
v_accvgpr_read_b32 v2, a240
v_mfma_f32_16x16x32_bf16 v[212:215], a[104:107], a[12:15], 0
s_waitcnt vmcnt(28) lgkmcnt(0)
v_accvgpr_read_b32 v3, a241
v_cvt_pk_bf16_f32 v2, v2, v3
v_mfma_f32_16x16x32_bf16 v[212:215], a[108:111], a[28:31], v[212:215]
s_barrier
s_add_u32 m0, s17, 0x10000
v_accvgpr_write_b32 a240, v2
v_accvgpr_read_b32 v2, a242
v_mfma_f32_16x16x32_bf16 v[204:207], a[108:111], a[24:27], 0
buffer_load_dwordx4 v5, s[52:55], 0 offen lds
v_mfma_f32_16x16x32_bf16 v[204:207], a[104:107], a[8:11], v[204:207]
ds_read_b64_tr_b16 a[96:97], v12 offset:0
v_accvgpr_read_b32 v3, a243
v_mfma_f32_16x16x32_bf16 v[196:199], a[104:107], a[4:7], 0
ds_read_b64_tr_b16 a[98:99], v12 offset:1024
v_cvt_pk_bf16_f32 v2, v2, v3
v_accvgpr_write_b32 a241, v2
v_mfma_f32_16x16x32_bf16 v[196:199], a[108:111], a[20:23], v[196:199]
ds_read_b64_tr_b16 a[100:101], v12 offset:8192
v_accvgpr_read_b32 v2, a244
v_mfma_f32_16x16x32_bf16 v[188:191], a[108:111], a[16:19], 0
ds_read_b64_tr_b16 a[102:103], v12 offset:9216
v_accvgpr_read_b32 v3, a245
v_mfma_f32_16x16x32_bf16 v[188:191], a[104:107], a[0:3], v[188:191]
s_add_u32 m0, s17, 0x10400
s_waitcnt lgkmcnt(4)
v_cvt_pk_bf16_f32 v2, v2, v3
v_accvgpr_write_b32 a242, v2
v_mfma_f32_16x16x32_bf16 v[216:219], a[0:3], a[80:83], 0
buffer_load_dwordx4 v5, s[52:55], s13 offen lds
v_mfma_f32_16x16x32_bf16 v[216:219], a[16:19], a[84:87], v[216:219]
ds_read_b64_tr_b16 a[104:105], v13 offset:0
v_accvgpr_read_b32 v2, a246
v_mfma_f32_16x16x32_bf16 v[224:227], a[20:23], a[84:87], 0
ds_read_b64_tr_b16 a[106:107], v13 offset:1024
v_accvgpr_read_b32 v3, a247
v_cvt_pk_bf16_f32 v2, v2, v3
v_mfma_f32_16x16x32_bf16 v[224:227], a[4:7], a[80:83], v[224:227]
ds_read_b64_tr_b16 a[108:109], v13 offset:8192
v_accvgpr_write_b32 a243, v2
v_mfma_f32_16x16x32_bf16 v[232:235], a[8:11], a[80:83], 0
ds_read_b64_tr_b16 a[110:111], v13 offset:9216
v_accvgpr_read_b32 v2, a248
v_mfma_f32_16x16x32_bf16 v[232:235], a[24:27], a[84:87], v[232:235]
v_accvgpr_read_b32 v3, a249
v_cvt_pk_bf16_f32 v2, v2, v3
v_accvgpr_write_b32 a248, v2
v_mfma_f32_16x16x32_bf16 v[240:243], a[28:31], a[84:87], 0
s_add_u32 m0, s17, 0x10800
v_accvgpr_read_b32 v2, a250
v_accvgpr_read_b32 v3, a251
v_mfma_f32_16x16x32_bf16 v[240:243], a[12:15], a[80:83], v[240:243]
buffer_load_dwordx4 v6, s[52:55], 0 offen lds
v_mfma_f32_16x16x32_bf16 v[244:247], a[12:15], a[88:91], 0
ds_read_b64_tr_b16 a[80:81], v12 offset:256
v_cvt_pk_bf16_f32 v2, v2, v3
v_accvgpr_write_b32 a249, v2
v_mfma_f32_16x16x32_bf16 v[244:247], a[28:31], a[92:95], v[244:247]
ds_read_b64_tr_b16 a[82:83], v12 offset:1280
v_accvgpr_read_b32 v2, a252
v_mfma_f32_16x16x32_bf16 v[236:239], a[24:27], a[92:95], 0
ds_read_b64_tr_b16 a[84:85], v12 offset:8448
v_accvgpr_read_b32 v3, a253
v_mfma_f32_16x16x32_bf16 v[236:239], a[8:11], a[88:91], v[236:239]
ds_read_b64_tr_b16 a[86:87], v12 offset:9472
v_cvt_pk_bf16_f32 v2, v2, v3
v_accvgpr_write_b32 a250, v2
v_mfma_f32_16x16x32_bf16 v[228:231], a[4:7], a[88:91], 0
v_accvgpr_read_b32 v2, a254
v_accvgpr_read_b32 v3, a255
v_mfma_f32_16x16x32_bf16 v[228:231], a[20:23], a[92:95], v[228:231]
s_add_u32 m0, s17, 0x10c00
v_cvt_pk_bf16_f32 v2, v2, v3
v_accvgpr_write_b32 a251, v2
v_mfma_f32_16x16x32_bf16 v[220:223], a[16:19], a[92:95], 0
buffer_load_dwordx4 v6, s[52:55], s13 offen lds
v_mfma_f32_16x16x32_bf16 v[220:223], a[0:3], a[88:91], v[220:223]
s_waitcnt lgkmcnt(4)
L_S9:
v_mfma_f32_16x16x32_bf16 v[24:27], a[96:99], a[32:35], v[24:27]
ds_read_b64_tr_b16 a[88:89], v13 offset:256
s_waitcnt vmcnt(23)
v_mfma_f32_16x16x32_bf16 v[24:27], a[100:103], a[48:51], v[24:27]
ds_read_b64_tr_b16 a[90:91], v13 offset:1280
L_padA5:
s_cmp_eq_u32 s95, 1
s_cbranch_scc1 L_padA9
v_mfma_f32_16x16x32_bf16 v[32:35], a[100:103], a[52:55], v[32:35]
ds_read_b64_tr_b16 a[92:93], v13 offset:8448
v_mfma_f32_16x16x32_bf16 v[32:35], a[96:99], a[36:39], v[32:35]
ds_read_b64_tr_b16 a[94:95], v13 offset:9472
v_mfma_f32_16x16x32_bf16 v[40:43], a[96:99], a[40:43], v[40:43]
ds_read_b128 a[0:3], v8 offset:0
s_add_u32 m0, s18, 0x14000
v_mfma_f32_16x16x32_bf16 v[40:43], a[100:103], a[56:59], v[40:43]
buffer_load_dwordx4 v7, s[68:71], 0 offen lds
v_mfma_f32_16x16x32_bf16 v[48:51], a[100:103], a[60:63], v[48:51]
ds_read_b128 a[16:19], v9 offset:0
v_mfma_f32_16x16x32_bf16 v[48:51], a[96:99], a[44:47], v[48:51]
ds_read_b128 a[4:7], v8 offset:2048
v_mfma_f32_16x16x32_bf16 v[52:55], a[104:107], a[44:47], v[52:55]
ds_read_b64_tr_b16 a[96:97], v12 offset:512
v_mfma_f32_16x16x32_bf16 v[52:55], a[108:111], a[60:63], v[52:55]
ds_read_b64_tr_b16 a[98:99], v12 offset:1536
v_mfma_f32_16x16x32_bf16 v[44:47], a[108:111], a[56:59], v[44:47]
ds_read_b64_tr_b16 a[100:101], v12 offset:8704
s_add_u32 s8, s28, 0x7000
v_mfma_f32_16x16x32_bf16 v[44:47], a[104:107], a[40:43], v[44:47]
buffer_store_dwordx4 a[140:143], v16, s[88:91], s8 offen sc1
v_mfma_f32_16x16x32_bf16 v[36:39], a[104:107], a[36:39], v[36:39]
ds_read_b64_tr_b16 a[102:103], v12 offset:9728
v_mfma_f32_16x16x32_bf16 v[36:39], a[108:111], a[52:55], v[36:39]
ds_read_b128 a[20:23], v9 offset:2048
v_mfma_f32_16x16x32_bf16 v[28:31], a[108:111], a[48:51], v[28:31]
ds_read_b128 a[8:11], v8 offset:4096
v_mfma_f32_16x16x32_bf16 v[28:31], a[104:107], a[32:35], v[28:31]
ds_read_b128 a[24:27], v9 offset:4096
s_waitcnt lgkmcnt(10)
v_mfma_f32_16x16x32_bf16 v[56:59], a[80:83], a[32:35], v[56:59]
ds_read_b64_tr_b16 a[104:105], v13 offset:512
v_mfma_f32_16x16x32_bf16 v[56:59], a[84:87], a[48:51], v[56:59]
ds_read_b64_tr_b16 a[106:107], v13 offset:1536
s_add_u32 m0, s18, 0x15000
v_mfma_f32_16x16x32_bf16 v[64:67], a[84:87], a[52:55], v[64:67]
buffer_load_dwordx4 v7, s[68:71], s25 offen lds
v_mfma_f32_16x16x32_bf16 v[64:67], a[80:83], a[36:39], v[64:67]
ds_read_b64_tr_b16 a[108:109], v13 offset:8704
v_mfma_f32_16x16x32_bf16 v[72:75], a[80:83], a[40:43], v[72:75]
ds_read_b64_tr_b16 a[110:111], v13 offset:9728
v_mfma_f32_16x16x32_bf16 v[72:75], a[84:87], a[56:59], v[72:75]
ds_read_b128 a[12:15], v8 offset:6144
v_mfma_f32_16x16x32_bf16 v[80:83], a[84:87], a[60:63], v[80:83]
ds_read_b128 a[28:31], v9 offset:6144
v_mfma_f32_16x16x32_bf16 v[80:83], a[80:83], a[44:47], v[80:83]
v_mfma_f32_16x16x32_bf16 v[84:87], a[88:91], a[44:47], v[84:87]
ds_read_b64_tr_b16 a[80:81], v12 offset:768
s_add_u32 m0, s18, 0x16000
v_mfma_f32_16x16x32_bf16 v[84:87], a[92:95], a[60:63], v[84:87]
buffer_load_dwordx4 v7, s[68:71], s26 offen lds
v_mfma_f32_16x16x32_bf16 v[76:79], a[92:95], a[56:59], v[76:79]
ds_read_b64_tr_b16 a[82:83], v12 offset:1792
v_lshl_add_u32 v5, s42, 19, v5
v_mfma_f32_16x16x32_bf16 v[76:79], a[88:91], a[40:43], v[76:79]
ds_read_b64_tr_b16 a[84:85], v12 offset:8960
v_lshl_add_u32 v6, s42, 19, v6
v_mfma_f32_16x16x32_bf16 v[68:71], a[88:91], a[36:39], v[68:71]
ds_read_b64_tr_b16 a[86:87], v12 offset:9984
v_lshl_add_u32 v7, s42, 18, v7
v_mfma_f32_16x16x32_bf16 v[68:71], a[92:95], a[52:55], v[68:71]
v_lshl_add_u32 v7, s42, 17, v7
v_mfma_f32_16x16x32_bf16 v[60:63], a[92:95], a[48:51], v[60:63]
v_mfma_f32_16x16x32_bf16 v[60:63], a[88:91], a[32:35], v[60:63]
s_add_u32 m0, s16, 0x0
s_waitcnt lgkmcnt(4)
s_waitcnt lgkmcnt(6)
v_mfma_f32_16x16x32_bf16 v[88:91], a[96:99], a[32:35], v[88:91]
buffer_load_dwordx4 v22, s[44:47], s20 offen lds
v_mfma_f32_16x16x32_bf16 v[88:91], a[100:103], a[48:51], v[88:91]
ds_read_b64_tr_b16 a[88:89], v13 offset:768
v_mfma_f32_16x16x32_bf16 v[96:99], a[100:103], a[52:55], v[96:99]
ds_read_b64_tr_b16 a[90:91], v13 offset:1792
v_mfma_f32_16x16x32_bf16 v[96:99], a[96:99], a[36:39], v[96:99]
ds_read_b64_tr_b16 a[92:93], v13 offset:8960
v_mfma_f32_16x16x32_bf16 v[104:107], a[96:99], a[40:43], v[104:107]
ds_read_b64_tr_b16 a[94:95], v13 offset:9984
s_add_u32 m0, s16, 0x400
v_mfma_f32_16x16x32_bf16 v[104:107], a[100:103], a[56:59], v[104:107]
buffer_load_dwordx4 v23, s[44:47], s20 offen lds
v_mfma_f32_16x16x32_bf16 v[112:115], a[100:103], a[60:63], v[112:115]
v_mfma_f32_16x16x32_bf16 v[112:115], a[96:99], a[44:47], v[112:115]
v_mfma_f32_16x16x32_bf16 v[116:119], a[104:107], a[44:47], v[116:119]
ds_read_b64_tr_b16 a[96:97], v14 offset:0
v_mfma_f32_16x16x32_bf16 v[116:119], a[108:111], a[60:63], v[116:119]
ds_read_b64_tr_b16 a[98:99], v14 offset:256
v_mfma_f32_16x16x32_bf16 v[108:111], a[108:111], a[56:59], v[108:111]
ds_read_b64_tr_b16 a[100:101], v14 offset:2048
s_add_u32 m0, s16, 0x800
v_mfma_f32_16x16x32_bf16 v[108:111], a[104:107], a[40:43], v[108:111]
buffer_load_dwordx4 v22, s[44:47], s21 offen lds
v_mfma_f32_16x16x32_bf16 v[100:103], a[104:107], a[36:39], v[100:103]
ds_read_b64_tr_b16 a[102:103], v14 offset:2304
v_mfma_f32_16x16x32_bf16 v[100:103], a[108:111], a[52:55], v[100:103]
v_mfma_f32_16x16x32_bf16 v[92:95], a[108:111], a[48:51], v[92:95]
v_mfma_f32_16x16x32_bf16 v[92:95], a[104:107], a[32:35], v[92:95]
s_add_u32 s8, s28, 0x2400
s_waitcnt lgkmcnt(4)
v_mfma_f32_16x16x32_bf16 v[120:123], a[80:83], a[32:35], v[120:123]
buffer_store_dwordx4 a[144:147], v16, s[88:91], s8 offen sc1
v_mfma_f32_16x16x32_bf16 v[120:123], a[84:87], a[48:51], v[120:123]
ds_read_b64_tr_b16 a[104:105], v15 offset:0
v_mfma_f32_16x16x32_bf16 v[128:131], a[84:87], a[52:55], v[128:131]
ds_read_b64_tr_b16 a[106:107], v15 offset:256
v_mfma_f32_16x16x32_bf16 v[128:131], a[80:83], a[36:39], v[128:131]
ds_read_b64_tr_b16 a[108:109], v15 offset:2048
v_mfma_f32_16x16x32_bf16 v[136:139], a[80:83], a[40:43], v[136:139]
ds_read_b64_tr_b16 a[110:111], v15 offset:2304
v_mfma_f32_16x16x32_bf16 v[136:139], a[84:87], a[56:59], v[136:139]
s_add_u32 m0, s16, 0xc00
v_mfma_f32_16x16x32_bf16 v[144:147], a[84:87], a[60:63], v[144:147]
buffer_load_dwordx4 v23, s[44:47], s21 offen lds
v_mfma_f32_16x16x32_bf16 v[144:147], a[80:83], a[44:47], v[144:147]
v_mfma_f32_16x16x32_bf16 v[148:151], a[88:91], a[44:47], v[148:151]
ds_read_b64_tr_b16 a[80:81], v14 offset:4096
v_mfma_f32_16x16x32_bf16 v[148:151], a[92:95], a[60:63], v[148:151]
ds_read_b64_tr_b16 a[82:83], v14 offset:4352
v_mfma_f32_16x16x32_bf16 v[140:143], a[92:95], a[56:59], v[140:143]
ds_read_b64_tr_b16 a[84:85], v14 offset:6144
v_mfma_f32_16x16x32_bf16 v[140:143], a[88:91], a[40:43], v[140:143]
ds_read_b64_tr_b16 a[86:87], v14 offset:6400
s_add_u32 m0, s16, 0x1000
v_mfma_f32_16x16x32_bf16 v[132:135], a[88:91], a[36:39], v[132:135]
buffer_load_dwordx4 v22, s[44:47], s22 offen lds
v_mfma_f32_16x16x32_bf16 v[132:135], a[92:95], a[52:55], v[132:135]
v_mfma_f32_16x16x32_bf16 v[124:127], a[92:95], a[48:51], v[124:127]
v_mfma_f32_16x16x32_bf16 v[124:127], a[88:91], a[32:35], v[124:127]
s_waitcnt lgkmcnt(4)
v_mfma_f32_16x16x32_bf16 v[152:155], a[96:99], a[32:35], v[152:155]
ds_read_b64_tr_b16 a[88:89], v15 offset:4096
s_add_u32 m0, s16, 0x1400
v_mfma_f32_16x16x32_bf16 v[152:155], a[100:103], a[48:51], v[152:155]
buffer_load_dwordx4 v23, s[44:47], s22 offen lds
v_mfma_f32_16x16x32_bf16 v[160:163], a[100:103], a[52:55], v[160:163]
ds_read_b64_tr_b16 a[90:91], v15 offset:4352
v_mfma_f32_16x16x32_bf16 v[160:163], a[96:99], a[36:39], v[160:163]
ds_read_b64_tr_b16 a[92:93], v15 offset:6144
v_mfma_f32_16x16x32_bf16 v[168:171], a[96:99], a[40:43], v[168:171]
ds_read_b64_tr_b16 a[94:95], v15 offset:6400
v_mfma_f32_16x16x32_bf16 v[168:171], a[100:103], a[56:59], v[168:171]
v_mfma_f32_16x16x32_bf16 v[176:179], a[100:103], a[60:63], v[176:179]
s_add_u32 m0, s16, 0x1800
v_mfma_f32_16x16x32_bf16 v[176:179], a[96:99], a[44:47], v[176:179]
buffer_load_dwordx4 v22, s[44:47], s23 offen lds
v_mfma_f32_16x16x32_bf16 v[180:183], a[104:107], a[44:47], v[180:183]
ds_read_b64_tr_b16 a[96:97], v14 offset:8192
v_mfma_f32_16x16x32_bf16 v[180:183], a[108:111], a[60:63], v[180:183]
ds_read_b64_tr_b16 a[98:99], v14 offset:8448
v_mfma_f32_16x16x32_bf16 v[172:175], a[108:111], a[56:59], v[172:175]
ds_read_b64_tr_b16 a[100:101], v14 offset:10240
v_mfma_f32_16x16x32_bf16 v[172:175], a[104:107], a[40:43], v[172:175]
ds_read_b64_tr_b16 a[102:103], v14 offset:10496
s_add_u32 m0, s16, 0x1c00
v_mfma_f32_16x16x32_bf16 v[164:167], a[104:107], a[36:39], v[164:167]
buffer_load_dwordx4 v23, s[44:47], s23 offen lds
v_mfma_f32_16x16x32_bf16 v[164:167], a[108:111], a[52:55], v[164:167]
v_lshl_add_u32 v22, s42, 7, v22
v_lshl_add_u32 v23, s42, 7, v23
v_mfma_f32_16x16x32_bf16 v[156:159], a[108:111], a[48:51], v[156:159]
v_mfma_f32_16x16x32_bf16 v[156:159], a[104:107], a[32:35], v[156:159]
s_waitcnt lgkmcnt(4)
v_mfma_f32_16x16x32_bf16 v[184:187], a[80:83], a[32:35], v[184:187]
ds_read_b64_tr_b16 a[104:105], v15 offset:8192
v_mfma_f32_16x16x32_bf16 v[184:187], a[84:87], a[48:51], v[184:187]
ds_read_b64_tr_b16 a[106:107], v15 offset:8448
s_add_u32 s8, s28, 0x3400
v_mfma_f32_16x16x32_bf16 v[192:195], a[84:87], a[52:55], v[192:195]
buffer_store_dwordx4 a[148:151], v16, s[88:91], s8 offen sc1
v_mfma_f32_16x16x32_bf16 v[192:195], a[80:83], a[36:39], v[192:195]
ds_read_b64_tr_b16 a[108:109], v15 offset:10240
v_mfma_f32_16x16x32_bf16 v[200:203], a[80:83], a[40:43], v[200:203]
ds_read_b64_tr_b16 a[110:111], v15 offset:10496
v_add_u32 v12, 0x8000, v12
v_mfma_f32_16x16x32_bf16 v[200:203], a[84:87], a[56:59], v[200:203]
v_add_u32 v13, 0x8000, v13
v_add_u32 v14, 0x8000, v14
v_mfma_f32_16x16x32_bf16 v[208:211], a[84:87], a[60:63], v[208:211]
v_add_u32 v15, 0x8000, v15
v_mfma_f32_16x16x32_bf16 v[208:211], a[80:83], a[44:47], v[208:211]
v_mfma_f32_16x16x32_bf16 v[212:215], a[88:91], a[44:47], v[212:215]
s_waitcnt vmcnt(28) lgkmcnt(0)
v_mfma_f32_16x16x32_bf16 v[212:215], a[92:95], a[60:63], v[212:215]
s_barrier
s_add_u32 m0, s17, 0x0
v_mfma_f32_16x16x32_bf16 v[204:207], a[92:95], a[56:59], v[204:207]
buffer_load_dwordx4 v5, s[52:55], 0 offen lds
v_mfma_f32_16x16x32_bf16 v[204:207], a[88:91], a[40:43], v[204:207]
ds_read_b64_tr_b16 a[80:81], v12 offset:0
v_mfma_f32_16x16x32_bf16 v[196:199], a[88:91], a[36:39], v[196:199]
ds_read_b64_tr_b16 a[82:83], v12 offset:1024
v_mfma_f32_16x16x32_bf16 v[196:199], a[92:95], a[52:55], v[196:199]
ds_read_b64_tr_b16 a[84:85], v12 offset:8192
v_mfma_f32_16x16x32_bf16 v[188:191], a[92:95], a[48:51], v[188:191]
ds_read_b64_tr_b16 a[86:87], v12 offset:9216
v_mfma_f32_16x16x32_bf16 v[188:191], a[88:91], a[32:35], v[188:191]
s_add_u32 m0, s17, 0x400
s_waitcnt lgkmcnt(4)
v_mfma_f32_16x16x32_bf16 v[216:219], a[32:35], a[96:99], v[216:219]
buffer_load_dwordx4 v5, s[52:55], s13 offen lds
v_mfma_f32_16x16x32_bf16 v[216:219], a[48:51], a[100:103], v[216:219]
ds_read_b64_tr_b16 a[88:89], v13 offset:0
v_mfma_f32_16x16x32_bf16 v[224:227], a[52:55], a[100:103], v[224:227]
ds_read_b64_tr_b16 a[90:91], v13 offset:1024
v_mfma_f32_16x16x32_bf16 v[224:227], a[36:39], a[96:99], v[224:227]
ds_read_b64_tr_b16 a[92:93], v13 offset:8192
v_mfma_f32_16x16x32_bf16 v[232:235], a[40:43], a[96:99], v[232:235]
ds_read_b64_tr_b16 a[94:95], v13 offset:9216
v_mfma_f32_16x16x32_bf16 v[232:235], a[56:59], a[100:103], v[232:235]
s_add_u32 m0, s17, 0x800
v_mfma_f32_16x16x32_bf16 v[240:243], a[60:63], a[100:103], v[240:243]
buffer_load_dwordx4 v6, s[52:55], 0 offen lds
v_mfma_f32_16x16x32_bf16 v[240:243], a[44:47], a[96:99], v[240:243]
v_mfma_f32_16x16x32_bf16 v[244:247], a[44:47], a[104:107], v[244:247]
ds_read_b64_tr_b16 a[96:97], v12 offset:256
v_mfma_f32_16x16x32_bf16 v[244:247], a[60:63], a[108:111], v[244:247]
ds_read_b64_tr_b16 a[98:99], v12 offset:1280
v_mfma_f32_16x16x32_bf16 v[236:239], a[56:59], a[108:111], v[236:239]
ds_read_b64_tr_b16 a[100:101], v12 offset:8448
v_mov_b32 v21, s1
v_mfma_f32_16x16x32_bf16 v[236:239], a[40:43], a[104:107], v[236:239]
ds_read_b64_tr_b16 a[102:103], v12 offset:9472
v_add_u32 v20, s0, v16
v_mfma_f32_16x16x32_bf16 v[228:231], a[36:39], a[104:107], v[228:231]
global_load_dword a120, v[20:21], off sc1
v_mfma_f32_16x16x32_bf16 v[228:231], a[52:55], a[108:111], v[228:231]
v_mfma_f32_16x16x32_bf16 v[220:223], a[48:51], a[108:111], v[220:223]
v_mfma_f32_16x16x32_bf16 v[220:223], a[32:35], a[104:107], v[220:223]
s_waitcnt lgkmcnt(4)
L_S10:
v_mfma_f32_16x16x32_bf16 v[24:27], a[80:83], a[0:3], v[24:27]
ds_read_b64_tr_b16 a[104:105], v13 offset:256
s_waitcnt vmcnt(23)
v_mfma_f32_16x16x32_bf16 v[24:27], a[84:87], a[16:19], v[24:27]
ds_read_b64_tr_b16 a[106:107], v13 offset:1280
s_add_u32 m0, s17, 0xc00
v_mfma_f32_16x16x32_bf16 v[32:35], a[84:87], a[20:23], v[32:35]
buffer_load_dwordx4 v6, s[52:55], s13 offen lds
v_mfma_f32_16x16x32_bf16 v[32:35], a[80:83], a[4:7], v[32:35]
ds_read_b64_tr_b16 a[108:109], v13 offset:8448
v_mfma_f32_16x16x32_bf16 v[40:43], a[80:83], a[8:11], v[40:43]
ds_read_b64_tr_b16 a[110:111], v13 offset:9472
v_mfma_f32_16x16x32_bf16 v[40:43], a[84:87], a[24:27], v[40:43]
ds_read_b128 a[32:35], v8 offset:32768
v_mfma_f32_16x16x32_bf16 v[48:51], a[84:87], a[28:31], v[48:51]
ds_read_b128 a[48:51], v9 offset:32768
v_mfma_f32_16x16x32_bf16 v[48:51], a[80:83], a[12:15], v[48:51]
ds_read_b128 a[36:39], v8 offset:34816
s_add_u32 m0, s18, 0x4000
v_mfma_f32_16x16x32_bf16 v[52:55], a[88:91], a[12:15], v[52:55]
buffer_load_dwordx4 v7, s[68:71], 0 offen lds
v_mfma_f32_16x16x32_bf16 v[52:55], a[92:95], a[28:31], v[52:55]
ds_read_b64_tr_b16 a[80:81], v12 offset:512
v_mfma_f32_16x16x32_bf16 v[44:47], a[92:95], a[24:27], v[44:47]
ds_read_b64_tr_b16 a[82:83], v12 offset:1536
v_mfma_f32_16x16x32_bf16 v[44:47], a[88:91], a[8:11], v[44:47]
ds_read_b64_tr_b16 a[84:85], v12 offset:8704
v_mfma_f32_16x16x32_bf16 v[36:39], a[88:91], a[4:7], v[36:39]
ds_read_b64_tr_b16 a[86:87], v12 offset:9728
v_mfma_f32_16x16x32_bf16 v[36:39], a[92:95], a[20:23], v[36:39]
ds_read_b128 a[52:55], v9 offset:34816
s_add_u32 m0, s18, 0x5000
v_mfma_f32_16x16x32_bf16 v[28:31], a[92:95], a[16:19], v[28:31]
buffer_load_dwordx4 v7, s[68:71], s25 offen lds
v_mfma_f32_16x16x32_bf16 v[28:31], a[88:91], a[0:3], v[28:31]
ds_read_b128 a[40:43], v8 offset:36864
s_waitcnt lgkmcnt(9)
v_mfma_f32_16x16x32_bf16 v[56:59], a[96:99], a[0:3], v[56:59]
ds_read_b64_tr_b16 a[88:89], v13 offset:512
v_mfma_f32_16x16x32_bf16 v[56:59], a[100:103], a[16:19], v[56:59]
ds_read_b64_tr_b16 a[90:91], v13 offset:1536
v_mfma_f32_16x16x32_bf16 v[64:67], a[100:103], a[20:23], v[64:67]
ds_read_b64_tr_b16 a[92:93], v13 offset:8704
v_mfma_f32_16x16x32_bf16 v[64:67], a[96:99], a[4:7], v[64:67]
ds_read_b64_tr_b16 a[94:95], v13 offset:9728
s_add_u32 m0, s18, 0x6000
v_mfma_f32_16x16x32_bf16 v[72:75], a[96:99], a[8:11], v[72:75]
buffer_load_dwordx4 v7, s[68:71], s26 offen lds
v_mfma_f32_16x16x32_bf16 v[72:75], a[100:103], a[24:27], v[72:75]
ds_read_b128 a[56:59], v9 offset:36864
v_lshl_add_u32 v5, s42, 19, v5
v_mfma_f32_16x16x32_bf16 v[80:83], a[100:103], a[28:31], v[80:83]
ds_read_b128 a[44:47], v8 offset:38912
v_lshl_add_u32 v6, s42, 19, v6
v_mfma_f32_16x16x32_bf16 v[80:83], a[96:99], a[12:15], v[80:83]
ds_read_b128 a[60:63], v9 offset:38912
v_lshl_add_u32 v7, s42, 18, v7
v_mfma_f32_16x16x32_bf16 v[84:87], a[104:107], a[12:15], v[84:87]
ds_read_b64_tr_b16 a[96:97], v12 offset:768
v_lshl_add_u32 v7, s42, 17, v7
v_mfma_f32_16x16x32_bf16 v[84:87], a[108:111], a[28:31], v[84:87]
ds_read_b64_tr_b16 a[98:99], v12 offset:1792
s_add_u32 s8, s28, 0x6400
v_mfma_f32_16x16x32_bf16 v[76:79], a[108:111], a[24:27], v[76:79]
buffer_store_dwordx4 a[152:155], v16, s[88:91], s8 offen sc1
v_mfma_f32_16x16x32_bf16 v[76:79], a[104:107], a[8:11], v[76:79]
ds_read_b64_tr_b16 a[100:101], v12 offset:8960
v_mfma_f32_16x16x32_bf16 v[68:71], a[104:107], a[4:7], v[68:71]
ds_read_b64_tr_b16 a[102:103], v12 offset:9984
v_mfma_f32_16x16x32_bf16 v[68:71], a[108:111], a[20:23], v[68:71]
v_mfma_f32_16x16x32_bf16 v[60:63], a[108:111], a[16:19], v[60:63]
v_mfma_f32_16x16x32_bf16 v[60:63], a[104:107], a[0:3], v[60:63]
s_add_u32 m0, s16, 0x8000
s_waitcnt lgkmcnt(4)
s_waitcnt lgkmcnt(7)
v_mfma_f32_16x16x32_bf16 v[88:91], a[80:83], a[0:3], v[88:91]
buffer_load_dwordx4 v22, s[44:47], s20 offen lds
v_mfma_f32_16x16x32_bf16 v[88:91], a[84:87], a[16:19], v[88:91]
ds_read_b64_tr_b16 a[104:105], v13 offset:768
v_mfma_f32_16x16x32_bf16 v[96:99], a[84:87], a[20:23], v[96:99]
ds_read_b64_tr_b16 a[106:107], v13 offset:1792
v_mfma_f32_16x16x32_bf16 v[96:99], a[80:83], a[4:7], v[96:99]
ds_read_b64_tr_b16 a[108:109], v13 offset:8960
v_mfma_f32_16x16x32_bf16 v[104:107], a[80:83], a[8:11], v[104:107]
ds_read_b64_tr_b16 a[110:111], v13 offset:9984
s_add_u32 m0, s16, 0x8400
v_mfma_f32_16x16x32_bf16 v[104:107], a[84:87], a[24:27], v[104:107]
buffer_load_dwordx4 v23, s[44:47], s20 offen lds
v_mfma_f32_16x16x32_bf16 v[112:115], a[84:87], a[28:31], v[112:115]
v_mfma_f32_16x16x32_bf16 v[112:115], a[80:83], a[12:15], v[112:115]
v_mfma_f32_16x16x32_bf16 v[116:119], a[88:91], a[12:15], v[116:119]
ds_read_b64_tr_b16 a[80:81], v14 offset:0
v_mfma_f32_16x16x32_bf16 v[116:119], a[92:95], a[28:31], v[116:119]
ds_read_b64_tr_b16 a[82:83], v14 offset:256
v_mfma_f32_16x16x32_bf16 v[108:111], a[92:95], a[24:27], v[108:111]
ds_read_b64_tr_b16 a[84:85], v14 offset:2048
s_add_u32 m0, s16, 0x8800
v_mfma_f32_16x16x32_bf16 v[108:111], a[88:91], a[8:11], v[108:111]
buffer_load_dwordx4 v22, s[44:47], s21 offen lds
v_mfma_f32_16x16x32_bf16 v[100:103], a[88:91], a[4:7], v[100:103]
ds_read_b64_tr_b16 a[86:87], v14 offset:2304
v_mfma_f32_16x16x32_bf16 v[100:103], a[92:95], a[20:23], v[100:103]
v_mfma_f32_16x16x32_bf16 v[92:95], a[92:95], a[16:19], v[92:95]
v_mfma_f32_16x16x32_bf16 v[92:95], a[88:91], a[0:3], v[92:95]
s_add_u32 m0, s16, 0x8c00
s_waitcnt lgkmcnt(4)
v_mfma_f32_16x16x32_bf16 v[120:123], a[96:99], a[0:3], v[120:123]
buffer_load_dwordx4 v23, s[44:47], s21 offen lds
v_mfma_f32_16x16x32_bf16 v[120:123], a[100:103], a[16:19], v[120:123]
ds_read_b64_tr_b16 a[88:89], v15 offset:0
v_mfma_f32_16x16x32_bf16 v[128:131], a[100:103], a[20:23], v[128:131]
ds_read_b64_tr_b16 a[90:91], v15 offset:256
v_mfma_f32_16x16x32_bf16 v[128:131], a[96:99], a[4:7], v[128:131]
ds_read_b64_tr_b16 a[92:93], v15 offset:2048
v_mfma_f32_16x16x32_bf16 v[136:139], a[96:99], a[8:11], v[136:139]
ds_read_b64_tr_b16 a[94:95], v15 offset:2304
v_mfma_f32_16x16x32_bf16 v[136:139], a[100:103], a[24:27], v[136:139]
s_add_u32 s8, s28, 0x7400
v_mfma_f32_16x16x32_bf16 v[144:147], a[100:103], a[28:31], v[144:147]
buffer_store_dwordx4 a[156:159], v16, s[88:91], s8 offen sc1
v_mfma_f32_16x16x32_bf16 v[144:147], a[96:99], a[12:15], v[144:147]
v_mfma_f32_16x16x32_bf16 v[148:151], a[104:107], a[12:15], v[148:151]
ds_read_b64_tr_b16 a[96:97], v14 offset:4096
v_mfma_f32_16x16x32_bf16 v[148:151], a[108:111], a[28:31], v[148:151]
ds_read_b64_tr_b16 a[98:99], v14 offset:4352
v_mfma_f32_16x16x32_bf16 v[140:143], a[108:111], a[24:27], v[140:143]
ds_read_b64_tr_b16 a[100:101], v14 offset:6144
v_mfma_f32_16x16x32_bf16 v[140:143], a[104:107], a[8:11], v[140:143]
ds_read_b64_tr_b16 a[102:103], v14 offset:6400
s_add_u32 m0, s16, 0x9000
v_mfma_f32_16x16x32_bf16 v[132:135], a[104:107], a[4:7], v[132:135]
buffer_load_dwordx4 v22, s[44:47], s22 offen lds
v_mfma_f32_16x16x32_bf16 v[132:135], a[108:111], a[20:23], v[132:135]
v_mfma_f32_16x16x32_bf16 v[124:127], a[108:111], a[16:19], v[124:127]
v_mfma_f32_16x16x32_bf16 v[124:127], a[104:107], a[0:3], v[124:127]
s_waitcnt lgkmcnt(4)
v_mfma_f32_16x16x32_bf16 v[152:155], a[80:83], a[0:3], v[152:155]
ds_read_b64_tr_b16 a[104:105], v15 offset:4096
s_add_u32 m0, s16, 0x9400
v_mfma_f32_16x16x32_bf16 v[152:155], a[84:87], a[16:19], v[152:155]
buffer_load_dwordx4 v23, s[44:47], s22 offen lds
v_mfma_f32_16x16x32_bf16 v[160:163], a[84:87], a[20:23], v[160:163]
ds_read_b64_tr_b16 a[106:107], v15 offset:4352
v_mfma_f32_16x16x32_bf16 v[160:163], a[80:83], a[4:7], v[160:163]
ds_read_b64_tr_b16 a[108:109], v15 offset:6144
v_mfma_f32_16x16x32_bf16 v[168:171], a[80:83], a[8:11], v[168:171]
ds_read_b64_tr_b16 a[110:111], v15 offset:6400
v_mfma_f32_16x16x32_bf16 v[168:171], a[84:87], a[24:27], v[168:171]
v_mfma_f32_16x16x32_bf16 v[176:179], a[84:87], a[28:31], v[176:179]
s_add_u32 m0, s16, 0x9800
v_mfma_f32_16x16x32_bf16 v[176:179], a[80:83], a[12:15], v[176:179]
buffer_load_dwordx4 v22, s[44:47], s23 offen lds
v_mfma_f32_16x16x32_bf16 v[180:183], a[88:91], a[12:15], v[180:183]
ds_read_b64_tr_b16 a[80:81], v14 offset:8192
v_mfma_f32_16x16x32_bf16 v[180:183], a[92:95], a[28:31], v[180:183]
ds_read_b64_tr_b16 a[82:83], v14 offset:8448
v_mfma_f32_16x16x32_bf16 v[172:175], a[92:95], a[24:27], v[172:175]
ds_read_b64_tr_b16 a[84:85], v14 offset:10240
v_mfma_f32_16x16x32_bf16 v[172:175], a[88:91], a[8:11], v[172:175]
ds_read_b64_tr_b16 a[86:87], v14 offset:10496
s_add_u32 m0, s16, 0x9c00
v_mfma_f32_16x16x32_bf16 v[164:167], a[88:91], a[4:7], v[164:167]
buffer_load_dwordx4 v23, s[44:47], s23 offen lds
v_mfma_f32_16x16x32_bf16 v[164:167], a[92:95], a[20:23], v[164:167]
v_lshl_add_u32 v22, s42, 7, v22
v_lshl_add_u32 v23, s42, 7, v23
v_mfma_f32_16x16x32_bf16 v[156:159], a[92:95], a[16:19], v[156:159]
v_mfma_f32_16x16x32_bf16 v[156:159], a[88:91], a[0:3], v[156:159]
s_waitcnt lgkmcnt(4)
v_mfma_f32_16x16x32_bf16 v[184:187], a[96:99], a[0:3], v[184:187]
ds_read_b64_tr_b16 a[88:89], v15 offset:8192
v_mfma_f32_16x16x32_bf16 v[184:187], a[100:103], a[16:19], v[184:187]
ds_read_b64_tr_b16 a[90:91], v15 offset:8448
s_add_u32 s8, s28, 0x2800
v_mfma_f32_16x16x32_bf16 v[192:195], a[100:103], a[20:23], v[192:195]
buffer_store_dwordx4 a[160:163], v16, s[88:91], s8 offen sc1
v_mfma_f32_16x16x32_bf16 v[192:195], a[96:99], a[4:7], v[192:195]
ds_read_b64_tr_b16 a[92:93], v15 offset:10240
v_mfma_f32_16x16x32_bf16 v[200:203], a[96:99], a[8:11], v[200:203]
ds_read_b64_tr_b16 a[94:95], v15 offset:10496
v_add_u32 v12, 0x8000, v12
v_mfma_f32_16x16x32_bf16 v[200:203], a[100:103], a[24:27], v[200:203]
v_add_u32 v13, 0x8000, v13
v_add_u32 v14, 0x8000, v14
v_mfma_f32_16x16x32_bf16 v[208:211], a[100:103], a[28:31], v[208:211]
v_add_u32 v15, 0x8000, v15
v_mfma_f32_16x16x32_bf16 v[208:211], a[96:99], a[12:15], v[208:211]
v_mfma_f32_16x16x32_bf16 v[212:215], a[104:107], a[12:15], v[212:215]
s_waitcnt vmcnt(29) lgkmcnt(0)
v_mfma_f32_16x16x32_bf16 v[212:215], a[108:111], a[28:31], v[212:215]
s_barrier
s_add_u32 m0, s17, 0x8000
v_mfma_f32_16x16x32_bf16 v[204:207], a[108:111], a[24:27], v[204:207]
buffer_load_dwordx4 v5, s[52:55], 0 offen lds
v_mfma_f32_16x16x32_bf16 v[204:207], a[104:107], a[8:11], v[204:207]
ds_read_b64_tr_b16 a[96:97], v12 offset:0
v_mfma_f32_16x16x32_bf16 v[196:199], a[104:107], a[4:7], v[196:199]
ds_read_b64_tr_b16 a[98:99], v12 offset:1024
v_mfma_f32_16x16x32_bf16 v[196:199], a[108:111], a[20:23], v[196:199]
ds_read_b64_tr_b16 a[100:101], v12 offset:8192
v_mfma_f32_16x16x32_bf16 v[188:191], a[108:111], a[16:19], v[188:191]
ds_read_b64_tr_b16 a[102:103], v12 offset:9216
v_mfma_f32_16x16x32_bf16 v[188:191], a[104:107], a[0:3], v[188:191]
s_add_u32 m0, s17, 0x8400
s_waitcnt lgkmcnt(4)
v_mfma_f32_16x16x32_bf16 v[216:219], a[0:3], a[80:83], v[216:219]
buffer_load_dwordx4 v5, s[52:55], s13 offen lds
v_mfma_f32_16x16x32_bf16 v[216:219], a[16:19], a[84:87], v[216:219]
ds_read_b64_tr_b16 a[104:105], v13 offset:0
v_mfma_f32_16x16x32_bf16 v[224:227], a[20:23], a[84:87], v[224:227]
ds_read_b64_tr_b16 a[106:107], v13 offset:1024
v_mfma_f32_16x16x32_bf16 v[224:227], a[4:7], a[80:83], v[224:227]
ds_read_b64_tr_b16 a[108:109], v13 offset:8192
v_mfma_f32_16x16x32_bf16 v[232:235], a[8:11], a[80:83], v[232:235]
ds_read_b64_tr_b16 a[110:111], v13 offset:9216
v_mfma_f32_16x16x32_bf16 v[232:235], a[24:27], a[84:87], v[232:235]
v_mfma_f32_16x16x32_bf16 v[240:243], a[28:31], a[84:87], v[240:243]
s_add_u32 m0, s17, 0x8800
v_mfma_f32_16x16x32_bf16 v[240:243], a[12:15], a[80:83], v[240:243]
buffer_load_dwordx4 v6, s[52:55], 0 offen lds
v_mfma_f32_16x16x32_bf16 v[244:247], a[12:15], a[88:91], v[244:247]
ds_read_b64_tr_b16 a[80:81], v12 offset:256
v_mfma_f32_16x16x32_bf16 v[244:247], a[28:31], a[92:95], v[244:247]
ds_read_b64_tr_b16 a[82:83], v12 offset:1280
v_mfma_f32_16x16x32_bf16 v[236:239], a[24:27], a[92:95], v[236:239]
ds_read_b64_tr_b16 a[84:85], v12 offset:8448
v_mfma_f32_16x16x32_bf16 v[236:239], a[8:11], a[88:91], v[236:239]
ds_read_b64_tr_b16 a[86:87], v12 offset:9472
v_mfma_f32_16x16x32_bf16 v[228:231], a[4:7], a[88:91], v[228:231]
v_mfma_f32_16x16x32_bf16 v[228:231], a[20:23], a[92:95], v[228:231]
s_add_u32 m0, s17, 0x8c00
v_mfma_f32_16x16x32_bf16 v[220:223], a[16:19], a[92:95], v[220:223]
buffer_load_dwordx4 v6, s[52:55], s13 offen lds
v_mfma_f32_16x16x32_bf16 v[220:223], a[0:3], a[88:91], v[220:223]
s_waitcnt lgkmcnt(4)
L_S11:
v_mfma_f32_16x16x32_bf16 v[24:27], a[96:99], a[32:35], v[24:27]
ds_read_b64_tr_b16 a[88:89], v13 offset:256
s_waitcnt vmcnt(24)
v_mfma_f32_16x16x32_bf16 v[24:27], a[100:103], a[48:51], v[24:27]
ds_read_b64_tr_b16 a[90:91], v13 offset:1280
v_mfma_f32_16x16x32_bf16 v[32:35], a[100:103], a[52:55], v[32:35]
ds_read_b64_tr_b16 a[92:93], v13 offset:8448
v_mfma_f32_16x16x32_bf16 v[32:35], a[96:99], a[36:39], v[32:35]
ds_read_b64_tr_b16 a[94:95], v13 offset:9472
v_mfma_f32_16x16x32_bf16 v[40:43], a[96:99], a[40:43], v[40:43]
ds_read_b128 a[0:3], v8 offset:0
s_add_u32 m0, s18, 0xc000
v_mfma_f32_16x16x32_bf16 v[40:43], a[100:103], a[56:59], v[40:43]
buffer_load_dwordx4 v7, s[68:71], 0 offen lds
v_mfma_f32_16x16x32_bf16 v[48:51], a[100:103], a[60:63], v[48:51]
ds_read_b128 a[16:19], v9 offset:0
v_mfma_f32_16x16x32_bf16 v[48:51], a[96:99], a[44:47], v[48:51]
ds_read_b128 a[4:7], v8 offset:2048
v_mfma_f32_16x16x32_bf16 v[52:55], a[104:107], a[44:47], v[52:55]
ds_read_b64_tr_b16 a[96:97], v12 offset:512
v_mfma_f32_16x16x32_bf16 v[52:55], a[108:111], a[60:63], v[52:55]
ds_read_b64_tr_b16 a[98:99], v12 offset:1536
v_mfma_f32_16x16x32_bf16 v[44:47], a[108:111], a[56:59], v[44:47]
ds_read_b64_tr_b16 a[100:101], v12 offset:8704
s_add_u32 s8, s28, 0x3800
v_mfma_f32_16x16x32_bf16 v[44:47], a[104:107], a[40:43], v[44:47]
buffer_store_dwordx4 a[164:167], v16, s[88:91], s8 offen sc1
v_mfma_f32_16x16x32_bf16 v[36:39], a[104:107], a[36:39], v[36:39]
ds_read_b64_tr_b16 a[102:103], v12 offset:9728
v_mfma_f32_16x16x32_bf16 v[36:39], a[108:111], a[52:55], v[36:39]
ds_read_b128 a[20:23], v9 offset:2048
v_mfma_f32_16x16x32_bf16 v[28:31], a[108:111], a[48:51], v[28:31]
ds_read_b128 a[8:11], v8 offset:4096
v_mfma_f32_16x16x32_bf16 v[28:31], a[104:107], a[32:35], v[28:31]
ds_read_b128 a[24:27], v9 offset:4096
s_waitcnt lgkmcnt(10)
v_mfma_f32_16x16x32_bf16 v[56:59], a[80:83], a[32:35], v[56:59]
ds_read_b64_tr_b16 a[104:105], v13 offset:512
v_mfma_f32_16x16x32_bf16 v[56:59], a[84:87], a[48:51], v[56:59]
ds_read_b64_tr_b16 a[106:107], v13 offset:1536
s_add_u32 m0, s18, 0xd000
v_mfma_f32_16x16x32_bf16 v[64:67], a[84:87], a[52:55], v[64:67]
buffer_load_dwordx4 v7, s[68:71], s25 offen lds
v_mfma_f32_16x16x32_bf16 v[64:67], a[80:83], a[36:39], v[64:67]
ds_read_b64_tr_b16 a[108:109], v13 offset:8704
v_mfma_f32_16x16x32_bf16 v[72:75], a[80:83], a[40:43], v[72:75]
ds_read_b64_tr_b16 a[110:111], v13 offset:9728
v_mfma_f32_16x16x32_bf16 v[72:75], a[84:87], a[56:59], v[72:75]
ds_read_b128 a[12:15], v8 offset:6144
v_mfma_f32_16x16x32_bf16 v[80:83], a[84:87], a[60:63], v[80:83]
ds_read_b128 a[28:31], v9 offset:6144
v_mfma_f32_16x16x32_bf16 v[80:83], a[80:83], a[44:47], v[80:83]
v_mfma_f32_16x16x32_bf16 v[84:87], a[88:91], a[44:47], v[84:87]
ds_read_b64_tr_b16 a[80:81], v12 offset:768
s_add_u32 m0, s18, 0xe000
v_mfma_f32_16x16x32_bf16 v[84:87], a[92:95], a[60:63], v[84:87]
buffer_load_dwordx4 v7, s[68:71], s26 offen lds
v_mfma_f32_16x16x32_bf16 v[76:79], a[92:95], a[56:59], v[76:79]
ds_read_b64_tr_b16 a[82:83], v12 offset:1792
v_lshl_add_u32 v5, s42, 19, v5
v_mfma_f32_16x16x32_bf16 v[76:79], a[88:91], a[40:43], v[76:79]
ds_read_b64_tr_b16 a[84:85], v12 offset:8960
v_lshl_add_u32 v6, s42, 19, v6
v_mfma_f32_16x16x32_bf16 v[68:71], a[88:91], a[36:39], v[68:71]
ds_read_b64_tr_b16 a[86:87], v12 offset:9984
v_lshl_add_u32 v7, s42, 18, v7
v_mfma_f32_16x16x32_bf16 v[68:71], a[92:95], a[52:55], v[68:71]
L_padA6:
s_cmp_eq_u32 s95, 1
s_cbranch_scc1 L_padA10
v_lshl_add_u32 v7, s42, 17, v7
v_mfma_f32_16x16x32_bf16 v[60:63], a[92:95], a[48:51], v[60:63]
v_mfma_f32_16x16x32_bf16 v[60:63], a[88:91], a[32:35], v[60:63]
s_add_u32 m0, s16, 0x0
s_waitcnt lgkmcnt(4)
s_waitcnt lgkmcnt(6)
v_mfma_f32_16x16x32_bf16 v[88:91], a[96:99], a[32:35], v[88:91]
buffer_load_dwordx4 v22, s[44:47], s20 offen lds
v_mfma_f32_16x16x32_bf16 v[88:91], a[100:103], a[48:51], v[88:91]
ds_read_b64_tr_b16 a[88:89], v13 offset:768
v_mfma_f32_16x16x32_bf16 v[96:99], a[100:103], a[52:55], v[96:99]
ds_read_b64_tr_b16 a[90:91], v13 offset:1792
v_mfma_f32_16x16x32_bf16 v[96:99], a[96:99], a[36:39], v[96:99]
ds_read_b64_tr_b16 a[92:93], v13 offset:8960
v_mfma_f32_16x16x32_bf16 v[104:107], a[96:99], a[40:43], v[104:107]
ds_read_b64_tr_b16 a[94:95], v13 offset:9984
s_add_u32 m0, s16, 0x400
v_mfma_f32_16x16x32_bf16 v[104:107], a[100:103], a[56:59], v[104:107]
buffer_load_dwordx4 v23, s[44:47], s20 offen lds
v_mfma_f32_16x16x32_bf16 v[112:115], a[100:103], a[60:63], v[112:115]
v_mfma_f32_16x16x32_bf16 v[112:115], a[96:99], a[44:47], v[112:115]
v_mfma_f32_16x16x32_bf16 v[116:119], a[104:107], a[44:47], v[116:119]
ds_read_b64_tr_b16 a[96:97], v14 offset:0
v_mfma_f32_16x16x32_bf16 v[116:119], a[108:111], a[60:63], v[116:119]
ds_read_b64_tr_b16 a[98:99], v14 offset:256
v_mfma_f32_16x16x32_bf16 v[108:111], a[108:111], a[56:59], v[108:111]
ds_read_b64_tr_b16 a[100:101], v14 offset:2048
s_add_u32 m0, s16, 0x800
v_mfma_f32_16x16x32_bf16 v[108:111], a[104:107], a[40:43], v[108:111]
buffer_load_dwordx4 v22, s[44:47], s21 offen lds
v_mfma_f32_16x16x32_bf16 v[100:103], a[104:107], a[36:39], v[100:103]
ds_read_b64_tr_b16 a[102:103], v14 offset:2304
v_mfma_f32_16x16x32_bf16 v[100:103], a[108:111], a[52:55], v[100:103]
v_mfma_f32_16x16x32_bf16 v[92:95], a[108:111], a[48:51], v[92:95]
v_mfma_f32_16x16x32_bf16 v[92:95], a[104:107], a[32:35], v[92:95]
s_add_u32 s8, s28, 0x6800
s_waitcnt lgkmcnt(4)
v_mfma_f32_16x16x32_bf16 v[120:123], a[80:83], a[32:35], v[120:123]
buffer_store_dwordx4 a[168:171], v16, s[88:91], s8 offen sc1
v_mfma_f32_16x16x32_bf16 v[120:123], a[84:87], a[48:51], v[120:123]
ds_read_b64_tr_b16 a[104:105], v15 offset:0
v_mfma_f32_16x16x32_bf16 v[128:131], a[84:87], a[52:55], v[128:131]
ds_read_b64_tr_b16 a[106:107], v15 offset:256
v_mfma_f32_16x16x32_bf16 v[128:131], a[80:83], a[36:39], v[128:131]
ds_read_b64_tr_b16 a[108:109], v15 offset:2048
v_mfma_f32_16x16x32_bf16 v[136:139], a[80:83], a[40:43], v[136:139]
ds_read_b64_tr_b16 a[110:111], v15 offset:2304
v_mfma_f32_16x16x32_bf16 v[136:139], a[84:87], a[56:59], v[136:139]
s_add_u32 m0, s16, 0xc00
v_mfma_f32_16x16x32_bf16 v[144:147], a[84:87], a[60:63], v[144:147]
buffer_load_dwordx4 v23, s[44:47], s21 offen lds
v_mfma_f32_16x16x32_bf16 v[144:147], a[80:83], a[44:47], v[144:147]
v_mfma_f32_16x16x32_bf16 v[148:151], a[88:91], a[44:47], v[148:151]
ds_read_b64_tr_b16 a[80:81], v14 offset:4096
v_mfma_f32_16x16x32_bf16 v[148:151], a[92:95], a[60:63], v[148:151]
ds_read_b64_tr_b16 a[82:83], v14 offset:4352
v_mfma_f32_16x16x32_bf16 v[140:143], a[92:95], a[56:59], v[140:143]
ds_read_b64_tr_b16 a[84:85], v14 offset:6144
v_mfma_f32_16x16x32_bf16 v[140:143], a[88:91], a[40:43], v[140:143]
ds_read_b64_tr_b16 a[86:87], v14 offset:6400
s_add_u32 m0, s16, 0x1000
v_mfma_f32_16x16x32_bf16 v[132:135], a[88:91], a[36:39], v[132:135]
buffer_load_dwordx4 v22, s[44:47], s22 offen lds
v_mfma_f32_16x16x32_bf16 v[132:135], a[92:95], a[52:55], v[132:135]
v_mfma_f32_16x16x32_bf16 v[124:127], a[92:95], a[48:51], v[124:127]
v_mfma_f32_16x16x32_bf16 v[124:127], a[88:91], a[32:35], v[124:127]
s_waitcnt lgkmcnt(4)
v_mfma_f32_16x16x32_bf16 v[152:155], a[96:99], a[32:35], v[152:155]
ds_read_b64_tr_b16 a[88:89], v15 offset:4096
s_add_u32 m0, s16, 0x1400
v_mfma_f32_16x16x32_bf16 v[152:155], a[100:103], a[48:51], v[152:155]
buffer_load_dwordx4 v23, s[44:47], s22 offen lds
v_mfma_f32_16x16x32_bf16 v[160:163], a[100:103], a[52:55], v[160:163]
ds_read_b64_tr_b16 a[90:91], v15 offset:4352
v_mfma_f32_16x16x32_bf16 v[160:163], a[96:99], a[36:39], v[160:163]
ds_read_b64_tr_b16 a[92:93], v15 offset:6144
v_mfma_f32_16x16x32_bf16 v[168:171], a[96:99], a[40:43], v[168:171]
ds_read_b64_tr_b16 a[94:95], v15 offset:6400
v_mfma_f32_16x16x32_bf16 v[168:171], a[100:103], a[56:59], v[168:171]
v_mfma_f32_16x16x32_bf16 v[176:179], a[100:103], a[60:63], v[176:179]
s_add_u32 m0, s16, 0x1800
v_mfma_f32_16x16x32_bf16 v[176:179], a[96:99], a[44:47], v[176:179]
buffer_load_dwordx4 v22, s[44:47], s23 offen lds
v_mfma_f32_16x16x32_bf16 v[180:183], a[104:107], a[44:47], v[180:183]
ds_read_b64_tr_b16 a[96:97], v14 offset:8192
v_mfma_f32_16x16x32_bf16 v[180:183], a[108:111], a[60:63], v[180:183]
ds_read_b64_tr_b16 a[98:99], v14 offset:8448
v_mfma_f32_16x16x32_bf16 v[172:175], a[108:111], a[56:59], v[172:175]
ds_read_b64_tr_b16 a[100:101], v14 offset:10240
v_mfma_f32_16x16x32_bf16 v[172:175], a[104:107], a[40:43], v[172:175]
ds_read_b64_tr_b16 a[102:103], v14 offset:10496
s_add_u32 m0, s16, 0x1c00
v_mfma_f32_16x16x32_bf16 v[164:167], a[104:107], a[36:39], v[164:167]
buffer_load_dwordx4 v23, s[44:47], s23 offen lds
v_mfma_f32_16x16x32_bf16 v[164:167], a[108:111], a[52:55], v[164:167]
v_lshl_add_u32 v22, s42, 7, v22
v_lshl_add_u32 v23, s42, 7, v23
v_mfma_f32_16x16x32_bf16 v[156:159], a[108:111], a[48:51], v[156:159]
v_mfma_f32_16x16x32_bf16 v[156:159], a[104:107], a[32:35], v[156:159]
s_waitcnt lgkmcnt(4)
v_mfma_f32_16x16x32_bf16 v[184:187], a[80:83], a[32:35], v[184:187]
ds_read_b64_tr_b16 a[104:105], v15 offset:8192
v_mfma_f32_16x16x32_bf16 v[184:187], a[84:87], a[48:51], v[184:187]
ds_read_b64_tr_b16 a[106:107], v15 offset:8448
s_add_u32 s8, s28, 0x7800
v_mfma_f32_16x16x32_bf16 v[192:195], a[84:87], a[52:55], v[192:195]
buffer_store_dwordx4 a[172:175], v16, s[88:91], s8 offen sc1
v_mfma_f32_16x16x32_bf16 v[192:195], a[80:83], a[36:39], v[192:195]
ds_read_b64_tr_b16 a[108:109], v15 offset:10240
v_mfma_f32_16x16x32_bf16 v[200:203], a[80:83], a[40:43], v[200:203]
ds_read_b64_tr_b16 a[110:111], v15 offset:10496
v_add_u32 v12, 0xffff0000, v12
v_mfma_f32_16x16x32_bf16 v[200:203], a[84:87], a[56:59], v[200:203]
v_add_u32 v13, 0xffff0000, v13
v_add_u32 v14, 0xffff0000, v14
v_mfma_f32_16x16x32_bf16 v[208:211], a[84:87], a[60:63], v[208:211]
v_add_u32 v15, 0xffff0000, v15
v_mfma_f32_16x16x32_bf16 v[208:211], a[80:83], a[44:47], v[208:211]
v_mfma_f32_16x16x32_bf16 v[212:215], a[88:91], a[44:47], v[212:215]
s_waitcnt vmcnt(29) lgkmcnt(0)
v_mfma_f32_16x16x32_bf16 v[212:215], a[92:95], a[60:63], v[212:215]
s_barrier
s_add_u32 m0, s17, 0x10000
v_mfma_f32_16x16x32_bf16 v[204:207], a[92:95], a[56:59], v[204:207]
buffer_load_dwordx4 v5, s[52:55], 0 offen lds
v_mfma_f32_16x16x32_bf16 v[204:207], a[88:91], a[40:43], v[204:207]
ds_read_b64_tr_b16 a[80:81], v12 offset:0
v_mfma_f32_16x16x32_bf16 v[196:199], a[88:91], a[36:39], v[196:199]
ds_read_b64_tr_b16 a[82:83], v12 offset:1024
v_mfma_f32_16x16x32_bf16 v[196:199], a[92:95], a[52:55], v[196:199]
ds_read_b64_tr_b16 a[84:85], v12 offset:8192
v_mfma_f32_16x16x32_bf16 v[188:191], a[92:95], a[48:51], v[188:191]
ds_read_b64_tr_b16 a[86:87], v12 offset:9216
v_mfma_f32_16x16x32_bf16 v[188:191], a[88:91], a[32:35], v[188:191]
s_add_u32 m0, s17, 0x10400
s_waitcnt lgkmcnt(4)
v_mfma_f32_16x16x32_bf16 v[216:219], a[32:35], a[96:99], v[216:219]
buffer_load_dwordx4 v5, s[52:55], s13 offen lds
v_mfma_f32_16x16x32_bf16 v[216:219], a[48:51], a[100:103], v[216:219]
ds_read_b64_tr_b16 a[88:89], v13 offset:0
v_mfma_f32_16x16x32_bf16 v[224:227], a[52:55], a[100:103], v[224:227]
ds_read_b64_tr_b16 a[90:91], v13 offset:1024
v_mfma_f32_16x16x32_bf16 v[224:227], a[36:39], a[96:99], v[224:227]
ds_read_b64_tr_b16 a[92:93], v13 offset:8192
v_mfma_f32_16x16x32_bf16 v[232:235], a[40:43], a[96:99], v[232:235]
ds_read_b64_tr_b16 a[94:95], v13 offset:9216
v_mfma_f32_16x16x32_bf16 v[232:235], a[56:59], a[100:103], v[232:235]
s_add_u32 m0, s17, 0x10800
v_mfma_f32_16x16x32_bf16 v[240:243], a[60:63], a[100:103], v[240:243]
buffer_load_dwordx4 v6, s[52:55], 0 offen lds
v_mfma_f32_16x16x32_bf16 v[240:243], a[44:47], a[96:99], v[240:243]
v_mfma_f32_16x16x32_bf16 v[244:247], a[44:47], a[104:107], v[244:247]
ds_read_b64_tr_b16 a[96:97], v12 offset:256
v_mfma_f32_16x16x32_bf16 v[244:247], a[60:63], a[108:111], v[244:247]
ds_read_b64_tr_b16 a[98:99], v12 offset:1280
v_mfma_f32_16x16x32_bf16 v[236:239], a[56:59], a[108:111], v[236:239]
ds_read_b64_tr_b16 a[100:101], v12 offset:8448
v_mfma_f32_16x16x32_bf16 v[236:239], a[40:43], a[104:107], v[236:239]
ds_read_b64_tr_b16 a[102:103], v12 offset:9472
s_add_u32 s8, s28, 0x2c00
v_mfma_f32_16x16x32_bf16 v[228:231], a[36:39], a[104:107], v[228:231]
buffer_store_dwordx4 a[176:179], v16, s[88:91], s8 offen sc1
v_mfma_f32_16x16x32_bf16 v[228:231], a[52:55], a[108:111], v[228:231]
v_mfma_f32_16x16x32_bf16 v[220:223], a[48:51], a[108:111], v[220:223]
v_mfma_f32_16x16x32_bf16 v[220:223], a[32:35], a[104:107], v[220:223]
s_waitcnt lgkmcnt(4)
L_S12:
v_mfma_f32_16x16x32_bf16 v[24:27], a[80:83], a[0:3], v[24:27]
ds_read_b64_tr_b16 a[104:105], v13 offset:256
s_waitcnt vmcnt(23)
v_mfma_f32_16x16x32_bf16 v[24:27], a[84:87], a[16:19], v[24:27]
ds_read_b64_tr_b16 a[106:107], v13 offset:1280
s_add_u32 m0, s17, 0x10c00
v_mfma_f32_16x16x32_bf16 v[32:35], a[84:87], a[20:23], v[32:35]
buffer_load_dwordx4 v6, s[52:55], s13 offen lds
v_mfma_f32_16x16x32_bf16 v[32:35], a[80:83], a[4:7], v[32:35]
ds_read_b64_tr_b16 a[108:109], v13 offset:8448
v_mfma_f32_16x16x32_bf16 v[40:43], a[80:83], a[8:11], v[40:43]
ds_read_b64_tr_b16 a[110:111], v13 offset:9472
v_mfma_f32_16x16x32_bf16 v[40:43], a[84:87], a[24:27], v[40:43]
ds_read_b128 a[32:35], v8 offset:32768
v_mfma_f32_16x16x32_bf16 v[48:51], a[84:87], a[28:31], v[48:51]
ds_read_b128 a[48:51], v9 offset:32768
v_mfma_f32_16x16x32_bf16 v[48:51], a[80:83], a[12:15], v[48:51]
ds_read_b128 a[36:39], v8 offset:34816
s_add_u32 m0, s18, 0x14000
v_mfma_f32_16x16x32_bf16 v[52:55], a[88:91], a[12:15], v[52:55]
buffer_load_dwordx4 v7, s[68:71], 0 offen lds
v_mfma_f32_16x16x32_bf16 v[52:55], a[92:95], a[28:31], v[52:55]
ds_read_b64_tr_b16 a[80:81], v12 offset:512
v_mfma_f32_16x16x32_bf16 v[44:47], a[92:95], a[24:27], v[44:47]
ds_read_b64_tr_b16 a[82:83], v12 offset:1536
v_mfma_f32_16x16x32_bf16 v[44:47], a[88:91], a[8:11], v[44:47]
ds_read_b64_tr_b16 a[84:85], v12 offset:8704
v_mfma_f32_16x16x32_bf16 v[36:39], a[88:91], a[4:7], v[36:39]
ds_read_b64_tr_b16 a[86:87], v12 offset:9728
v_mfma_f32_16x16x32_bf16 v[36:39], a[92:95], a[20:23], v[36:39]
ds_read_b128 a[52:55], v9 offset:34816
s_add_u32 m0, s18, 0x15000
v_mfma_f32_16x16x32_bf16 v[28:31], a[92:95], a[16:19], v[28:31]
buffer_load_dwordx4 v7, s[68:71], s25 offen lds
v_mfma_f32_16x16x32_bf16 v[28:31], a[88:91], a[0:3], v[28:31]
ds_read_b128 a[40:43], v8 offset:36864
s_waitcnt lgkmcnt(9)
v_mfma_f32_16x16x32_bf16 v[56:59], a[96:99], a[0:3], v[56:59]
ds_read_b64_tr_b16 a[88:89], v13 offset:512
v_mfma_f32_16x16x32_bf16 v[56:59], a[100:103], a[16:19], v[56:59]
ds_read_b64_tr_b16 a[90:91], v13 offset:1536
v_mfma_f32_16x16x32_bf16 v[64:67], a[100:103], a[20:23], v[64:67]
ds_read_b64_tr_b16 a[92:93], v13 offset:8704
v_mfma_f32_16x16x32_bf16 v[64:67], a[96:99], a[4:7], v[64:67]
ds_read_b64_tr_b16 a[94:95], v13 offset:9728
s_add_u32 m0, s18, 0x16000
v_mfma_f32_16x16x32_bf16 v[72:75], a[96:99], a[8:11], v[72:75]
buffer_load_dwordx4 v7, s[68:71], s26 offen lds
v_mfma_f32_16x16x32_bf16 v[72:75], a[100:103], a[24:27], v[72:75]
ds_read_b128 a[56:59], v9 offset:36864
v_lshl_add_u32 v5, s42, 19, v5
v_mfma_f32_16x16x32_bf16 v[80:83], a[100:103], a[28:31], v[80:83]
ds_read_b128 a[44:47], v8 offset:38912
v_lshl_add_u32 v6, s42, 19, v6
v_mfma_f32_16x16x32_bf16 v[80:83], a[96:99], a[12:15], v[80:83]
ds_read_b128 a[60:63], v9 offset:38912
v_lshl_add_u32 v7, s42, 18, v7
v_mfma_f32_16x16x32_bf16 v[84:87], a[104:107], a[12:15], v[84:87]
ds_read_b64_tr_b16 a[96:97], v12 offset:768
v_lshl_add_u32 v7, s42, 17, v7
v_mfma_f32_16x16x32_bf16 v[84:87], a[108:111], a[28:31], v[84:87]
ds_read_b64_tr_b16 a[98:99], v12 offset:1792
s_add_u32 s8, s28, 0x3c00
v_mfma_f32_16x16x32_bf16 v[76:79], a[108:111], a[24:27], v[76:79]
buffer_store_dwordx4 a[180:183], v16, s[88:91], s8 offen sc1
v_mfma_f32_16x16x32_bf16 v[76:79], a[104:107], a[8:11], v[76:79]
ds_read_b64_tr_b16 a[100:101], v12 offset:8960
v_mfma_f32_16x16x32_bf16 v[68:71], a[104:107], a[4:7], v[68:71]
ds_read_b64_tr_b16 a[102:103], v12 offset:9984
v_mfma_f32_16x16x32_bf16 v[68:71], a[108:111], a[20:23], v[68:71]
v_mfma_f32_16x16x32_bf16 v[60:63], a[108:111], a[16:19], v[60:63]
v_mfma_f32_16x16x32_bf16 v[60:63], a[104:107], a[0:3], v[60:63]
s_add_u32 m0, s16, 0x8000
s_waitcnt lgkmcnt(4)
s_waitcnt lgkmcnt(7)
v_mfma_f32_16x16x32_bf16 v[88:91], a[80:83], a[0:3], v[88:91]
buffer_load_dwordx4 v22, s[44:47], s20 offen lds
v_mfma_f32_16x16x32_bf16 v[88:91], a[84:87], a[16:19], v[88:91]
ds_read_b64_tr_b16 a[104:105], v13 offset:768
v_mfma_f32_16x16x32_bf16 v[96:99], a[84:87], a[20:23], v[96:99]
ds_read_b64_tr_b16 a[106:107], v13 offset:1792
v_mfma_f32_16x16x32_bf16 v[96:99], a[80:83], a[4:7], v[96:99]
ds_read_b64_tr_b16 a[108:109], v13 offset:8960
v_mfma_f32_16x16x32_bf16 v[104:107], a[80:83], a[8:11], v[104:107]
ds_read_b64_tr_b16 a[110:111], v13 offset:9984
s_add_u32 m0, s16, 0x8400
v_mfma_f32_16x16x32_bf16 v[104:107], a[84:87], a[24:27], v[104:107]
buffer_load_dwordx4 v23, s[44:47], s20 offen lds
v_mfma_f32_16x16x32_bf16 v[112:115], a[84:87], a[28:31], v[112:115]
v_mfma_f32_16x16x32_bf16 v[112:115], a[80:83], a[12:15], v[112:115]
v_mfma_f32_16x16x32_bf16 v[116:119], a[88:91], a[12:15], v[116:119]
ds_read_b64_tr_b16 a[80:81], v14 offset:0
v_mfma_f32_16x16x32_bf16 v[116:119], a[92:95], a[28:31], v[116:119]
ds_read_b64_tr_b16 a[82:83], v14 offset:256
v_mfma_f32_16x16x32_bf16 v[108:111], a[92:95], a[24:27], v[108:111]
ds_read_b64_tr_b16 a[84:85], v14 offset:2048
s_add_u32 m0, s16, 0x8800
v_mfma_f32_16x16x32_bf16 v[108:111], a[88:91], a[8:11], v[108:111]
buffer_load_dwordx4 v22, s[44:47], s21 offen lds
v_mfma_f32_16x16x32_bf16 v[100:103], a[88:91], a[4:7], v[100:103]
ds_read_b64_tr_b16 a[86:87], v14 offset:2304
v_mfma_f32_16x16x32_bf16 v[100:103], a[92:95], a[20:23], v[100:103]
v_mfma_f32_16x16x32_bf16 v[92:95], a[92:95], a[16:19], v[92:95]
v_mfma_f32_16x16x32_bf16 v[92:95], a[88:91], a[0:3], v[92:95]
s_add_u32 m0, s16, 0x8c00
s_waitcnt lgkmcnt(4)
v_mfma_f32_16x16x32_bf16 v[120:123], a[96:99], a[0:3], v[120:123]
buffer_load_dwordx4 v23, s[44:47], s21 offen lds
v_mfma_f32_16x16x32_bf16 v[120:123], a[100:103], a[16:19], v[120:123]
ds_read_b64_tr_b16 a[88:89], v15 offset:0
v_mfma_f32_16x16x32_bf16 v[128:131], a[100:103], a[20:23], v[128:131]
ds_read_b64_tr_b16 a[90:91], v15 offset:256
v_mfma_f32_16x16x32_bf16 v[128:131], a[96:99], a[4:7], v[128:131]
ds_read_b64_tr_b16 a[92:93], v15 offset:2048
v_mfma_f32_16x16x32_bf16 v[136:139], a[96:99], a[8:11], v[136:139]
ds_read_b64_tr_b16 a[94:95], v15 offset:2304
v_mfma_f32_16x16x32_bf16 v[136:139], a[100:103], a[24:27], v[136:139]
s_add_u32 s8, s28, 0x6c00
v_mfma_f32_16x16x32_bf16 v[144:147], a[100:103], a[28:31], v[144:147]
buffer_store_dwordx4 a[184:187], v16, s[88:91], s8 offen sc1
v_mfma_f32_16x16x32_bf16 v[144:147], a[96:99], a[12:15], v[144:147]
v_mfma_f32_16x16x32_bf16 v[148:151], a[104:107], a[12:15], v[148:151]
ds_read_b64_tr_b16 a[96:97], v14 offset:4096
v_mfma_f32_16x16x32_bf16 v[148:151], a[108:111], a[28:31], v[148:151]
ds_read_b64_tr_b16 a[98:99], v14 offset:4352
v_mfma_f32_16x16x32_bf16 v[140:143], a[108:111], a[24:27], v[140:143]
ds_read_b64_tr_b16 a[100:101], v14 offset:6144
v_mfma_f32_16x16x32_bf16 v[140:143], a[104:107], a[8:11], v[140:143]
ds_read_b64_tr_b16 a[102:103], v14 offset:6400
s_add_u32 m0, s16, 0x9000
v_mfma_f32_16x16x32_bf16 v[132:135], a[104:107], a[4:7], v[132:135]
buffer_load_dwordx4 v22, s[44:47], s22 offen lds
v_mfma_f32_16x16x32_bf16 v[132:135], a[108:111], a[20:23], v[132:135]
v_mfma_f32_16x16x32_bf16 v[124:127], a[108:111], a[16:19], v[124:127]
v_mfma_f32_16x16x32_bf16 v[124:127], a[104:107], a[0:3], v[124:127]
s_waitcnt lgkmcnt(4)
v_mfma_f32_16x16x32_bf16 v[152:155], a[80:83], a[0:3], v[152:155]
ds_read_b64_tr_b16 a[104:105], v15 offset:4096
s_add_u32 m0, s16, 0x9400
v_mfma_f32_16x16x32_bf16 v[152:155], a[84:87], a[16:19], v[152:155]
buffer_load_dwordx4 v23, s[44:47], s22 offen lds
v_mfma_f32_16x16x32_bf16 v[160:163], a[84:87], a[20:23], v[160:163]
ds_read_b64_tr_b16 a[106:107], v15 offset:4352
v_mfma_f32_16x16x32_bf16 v[160:163], a[80:83], a[4:7], v[160:163]
ds_read_b64_tr_b16 a[108:109], v15 offset:6144
v_mfma_f32_16x16x32_bf16 v[168:171], a[80:83], a[8:11], v[168:171]
ds_read_b64_tr_b16 a[110:111], v15 offset:6400
v_mfma_f32_16x16x32_bf16 v[168:171], a[84:87], a[24:27], v[168:171]
v_mfma_f32_16x16x32_bf16 v[176:179], a[84:87], a[28:31], v[176:179]
s_add_u32 m0, s16, 0x9800
v_mfma_f32_16x16x32_bf16 v[176:179], a[80:83], a[12:15], v[176:179]
buffer_load_dwordx4 v22, s[44:47], s23 offen lds
v_mfma_f32_16x16x32_bf16 v[180:183], a[88:91], a[12:15], v[180:183]
ds_read_b64_tr_b16 a[80:81], v14 offset:8192
v_mfma_f32_16x16x32_bf16 v[180:183], a[92:95], a[28:31], v[180:183]
ds_read_b64_tr_b16 a[82:83], v14 offset:8448
v_mfma_f32_16x16x32_bf16 v[172:175], a[92:95], a[24:27], v[172:175]
ds_read_b64_tr_b16 a[84:85], v14 offset:10240
v_mfma_f32_16x16x32_bf16 v[172:175], a[88:91], a[8:11], v[172:175]
ds_read_b64_tr_b16 a[86:87], v14 offset:10496
s_add_u32 m0, s16, 0x9c00
v_mfma_f32_16x16x32_bf16 v[164:167], a[88:91], a[4:7], v[164:167]
buffer_load_dwordx4 v23, s[44:47], s23 offen lds
v_mfma_f32_16x16x32_bf16 v[164:167], a[92:95], a[20:23], v[164:167]
v_lshl_add_u32 v22, s42, 7, v22
v_lshl_add_u32 v23, s42, 7, v23
v_mfma_f32_16x16x32_bf16 v[156:159], a[92:95], a[16:19], v[156:159]
v_mfma_f32_16x16x32_bf16 v[156:159], a[88:91], a[0:3], v[156:159]
s_waitcnt lgkmcnt(4)
v_mfma_f32_16x16x32_bf16 v[184:187], a[96:99], a[0:3], v[184:187]
ds_read_b64_tr_b16 a[88:89], v15 offset:8192
v_mfma_f32_16x16x32_bf16 v[184:187], a[100:103], a[16:19], v[184:187]
ds_read_b64_tr_b16 a[90:91], v15 offset:8448
s_add_u32 s8, s28, 0x7c00
v_mfma_f32_16x16x32_bf16 v[192:195], a[100:103], a[20:23], v[192:195]
buffer_store_dwordx4 a[188:191], v16, s[88:91], s8 offen sc1
v_mfma_f32_16x16x32_bf16 v[192:195], a[96:99], a[4:7], v[192:195]
ds_read_b64_tr_b16 a[92:93], v15 offset:10240
v_mfma_f32_16x16x32_bf16 v[200:203], a[96:99], a[8:11], v[200:203]
ds_read_b64_tr_b16 a[94:95], v15 offset:10496
v_add_u32 v12, 0x8000, v12
v_mfma_f32_16x16x32_bf16 v[200:203], a[100:103], a[24:27], v[200:203]
v_add_u32 v13, 0x8000, v13
v_add_u32 v14, 0x8000, v14
v_mfma_f32_16x16x32_bf16 v[208:211], a[100:103], a[28:31], v[208:211]
v_add_u32 v15, 0x8000, v15
v_mfma_f32_16x16x32_bf16 v[208:211], a[96:99], a[12:15], v[208:211]
v_mfma_f32_16x16x32_bf16 v[212:215], a[104:107], a[12:15], v[212:215]
s_waitcnt vmcnt(29) lgkmcnt(0)
v_mfma_f32_16x16x32_bf16 v[212:215], a[108:111], a[28:31], v[212:215]
s_barrier
s_add_u32 m0, s17, 0x0
v_mfma_f32_16x16x32_bf16 v[204:207], a[108:111], a[24:27], v[204:207]
buffer_load_dwordx4 v5, s[52:55], 0 offen lds
v_mfma_f32_16x16x32_bf16 v[204:207], a[104:107], a[8:11], v[204:207]
ds_read_b64_tr_b16 a[96:97], v12 offset:0
v_mfma_f32_16x16x32_bf16 v[196:199], a[104:107], a[4:7], v[196:199]
ds_read_b64_tr_b16 a[98:99], v12 offset:1024
v_mfma_f32_16x16x32_bf16 v[196:199], a[108:111], a[20:23], v[196:199]
ds_read_b64_tr_b16 a[100:101], v12 offset:8192
v_mfma_f32_16x16x32_bf16 v[188:191], a[108:111], a[16:19], v[188:191]
ds_read_b64_tr_b16 a[102:103], v12 offset:9216
v_mfma_f32_16x16x32_bf16 v[188:191], a[104:107], a[0:3], v[188:191]
s_add_u32 m0, s17, 0x400
s_waitcnt lgkmcnt(4)
v_mfma_f32_16x16x32_bf16 v[216:219], a[0:3], a[80:83], v[216:219]
buffer_load_dwordx4 v5, s[52:55], s13 offen lds
v_mfma_f32_16x16x32_bf16 v[216:219], a[16:19], a[84:87], v[216:219]
ds_read_b64_tr_b16 a[104:105], v13 offset:0
v_mfma_f32_16x16x32_bf16 v[224:227], a[20:23], a[84:87], v[224:227]
ds_read_b64_tr_b16 a[106:107], v13 offset:1024
v_mfma_f32_16x16x32_bf16 v[224:227], a[4:7], a[80:83], v[224:227]
ds_read_b64_tr_b16 a[108:109], v13 offset:8192
v_mfma_f32_16x16x32_bf16 v[232:235], a[8:11], a[80:83], v[232:235]
ds_read_b64_tr_b16 a[110:111], v13 offset:9216
v_mfma_f32_16x16x32_bf16 v[232:235], a[24:27], a[84:87], v[232:235]
v_mfma_f32_16x16x32_bf16 v[240:243], a[28:31], a[84:87], v[240:243]
s_add_u32 m0, s17, 0x800
v_mfma_f32_16x16x32_bf16 v[240:243], a[12:15], a[80:83], v[240:243]
buffer_load_dwordx4 v6, s[52:55], 0 offen lds
v_mfma_f32_16x16x32_bf16 v[244:247], a[12:15], a[88:91], v[244:247]
ds_read_b64_tr_b16 a[80:81], v12 offset:256
v_mfma_f32_16x16x32_bf16 v[244:247], a[28:31], a[92:95], v[244:247]
ds_read_b64_tr_b16 a[82:83], v12 offset:1280
v_mfma_f32_16x16x32_bf16 v[236:239], a[24:27], a[92:95], v[236:239]
ds_read_b64_tr_b16 a[84:85], v12 offset:8448
v_mfma_f32_16x16x32_bf16 v[236:239], a[8:11], a[88:91], v[236:239]
ds_read_b64_tr_b16 a[86:87], v12 offset:9472
v_mfma_f32_16x16x32_bf16 v[228:231], a[4:7], a[88:91], v[228:231]
v_mfma_f32_16x16x32_bf16 v[228:231], a[20:23], a[92:95], v[228:231]
s_add_u32 m0, s17, 0xc00
v_mfma_f32_16x16x32_bf16 v[220:223], a[16:19], a[92:95], v[220:223]
buffer_load_dwordx4 v6, s[52:55], s13 offen lds
v_mfma_f32_16x16x32_bf16 v[220:223], a[0:3], a[88:91], v[220:223]
s_waitcnt lgkmcnt(4)
L_S13:
v_mfma_f32_16x16x32_bf16 v[24:27], a[96:99], a[32:35], v[24:27]
ds_read_b64_tr_b16 a[88:89], v13 offset:256
s_waitcnt vmcnt(24)
v_mfma_f32_16x16x32_bf16 v[24:27], a[100:103], a[48:51], v[24:27]
ds_read_b64_tr_b16 a[90:91], v13 offset:1280
v_mfma_f32_16x16x32_bf16 v[32:35], a[100:103], a[52:55], v[32:35]
ds_read_b64_tr_b16 a[92:93], v13 offset:8448
v_mfma_f32_16x16x32_bf16 v[32:35], a[96:99], a[36:39], v[32:35]
ds_read_b64_tr_b16 a[94:95], v13 offset:9472
v_mfma_f32_16x16x32_bf16 v[40:43], a[96:99], a[40:43], v[40:43]
ds_read_b128 a[0:3], v8 offset:0
s_add_u32 m0, s18, 0x4000
v_mfma_f32_16x16x32_bf16 v[40:43], a[100:103], a[56:59], v[40:43]
buffer_load_dwordx4 v7, s[68:71], 0 offen lds
v_mfma_f32_16x16x32_bf16 v[48:51], a[100:103], a[60:63], v[48:51]
ds_read_b128 a[16:19], v9 offset:0
v_mfma_f32_16x16x32_bf16 v[48:51], a[96:99], a[44:47], v[48:51]
ds_read_b128 a[4:7], v8 offset:2048
v_mfma_f32_16x16x32_bf16 v[52:55], a[104:107], a[44:47], v[52:55]
ds_read_b64_tr_b16 a[96:97], v12 offset:512
v_mfma_f32_16x16x32_bf16 v[52:55], a[108:111], a[60:63], v[52:55]
ds_read_b64_tr_b16 a[98:99], v12 offset:1536
v_mfma_f32_16x16x32_bf16 v[44:47], a[108:111], a[56:59], v[44:47]
ds_read_b64_tr_b16 a[100:101], v12 offset:8704
s_add_u32 s8, s28, 0x4000
v_mfma_f32_16x16x32_bf16 v[44:47], a[104:107], a[40:43], v[44:47]
buffer_store_dwordx4 a[192:195], v16, s[88:91], s8 offen sc1
v_mfma_f32_16x16x32_bf16 v[36:39], a[104:107], a[36:39], v[36:39]
ds_read_b64_tr_b16 a[102:103], v12 offset:9728
v_mfma_f32_16x16x32_bf16 v[36:39], a[108:111], a[52:55], v[36:39]
ds_read_b128 a[20:23], v9 offset:2048
v_mfma_f32_16x16x32_bf16 v[28:31], a[108:111], a[48:51], v[28:31]
ds_read_b128 a[8:11], v8 offset:4096
v_mfma_f32_16x16x32_bf16 v[28:31], a[104:107], a[32:35], v[28:31]
ds_read_b128 a[24:27], v9 offset:4096
s_waitcnt lgkmcnt(10)
v_mfma_f32_16x16x32_bf16 v[56:59], a[80:83], a[32:35], v[56:59]
ds_read_b64_tr_b16 a[104:105], v13 offset:512
v_mfma_f32_16x16x32_bf16 v[56:59], a[84:87], a[48:51], v[56:59]
ds_read_b64_tr_b16 a[106:107], v13 offset:1536
s_add_u32 m0, s18, 0x5000
v_mfma_f32_16x16x32_bf16 v[64:67], a[84:87], a[52:55], v[64:67]
buffer_load_dwordx4 v7, s[68:71], s25 offen lds
v_mfma_f32_16x16x32_bf16 v[64:67], a[80:83], a[36:39], v[64:67]
ds_read_b64_tr_b16 a[108:109], v13 offset:8704
v_mfma_f32_16x16x32_bf16 v[72:75], a[80:83], a[40:43], v[72:75]
ds_read_b64_tr_b16 a[110:111], v13 offset:9728
v_mfma_f32_16x16x32_bf16 v[72:75], a[84:87], a[56:59], v[72:75]
ds_read_b128 a[12:15], v8 offset:6144
v_mfma_f32_16x16x32_bf16 v[80:83], a[84:87], a[60:63], v[80:83]
ds_read_b128 a[28:31], v9 offset:6144
v_mfma_f32_16x16x32_bf16 v[80:83], a[80:83], a[44:47], v[80:83]
v_mfma_f32_16x16x32_bf16 v[84:87], a[88:91], a[44:47], v[84:87]
ds_read_b64_tr_b16 a[80:81], v12 offset:768
s_add_u32 m0, s18, 0x6000
v_mfma_f32_16x16x32_bf16 v[84:87], a[92:95], a[60:63], v[84:87]
buffer_load_dwordx4 v7, s[68:71], s26 offen lds
v_mfma_f32_16x16x32_bf16 v[76:79], a[92:95], a[56:59], v[76:79]
ds_read_b64_tr_b16 a[82:83], v12 offset:1792
v_lshl_add_u32 v5, s42, 19, v5
v_mfma_f32_16x16x32_bf16 v[76:79], a[88:91], a[40:43], v[76:79]
ds_read_b64_tr_b16 a[84:85], v12 offset:8960
v_lshl_add_u32 v6, s42, 19, v6
v_mfma_f32_16x16x32_bf16 v[68:71], a[88:91], a[36:39], v[68:71]
ds_read_b64_tr_b16 a[86:87], v12 offset:9984
v_lshl_add_u32 v7, s42, 18, v7
v_mfma_f32_16x16x32_bf16 v[68:71], a[92:95], a[52:55], v[68:71]
v_lshl_add_u32 v7, s42, 17, v7
v_mfma_f32_16x16x32_bf16 v[60:63], a[92:95], a[48:51], v[60:63]
v_mfma_f32_16x16x32_bf16 v[60:63], a[88:91], a[32:35], v[60:63]
s_add_u32 m0, s16, 0x0
s_waitcnt lgkmcnt(4)
s_waitcnt lgkmcnt(6)
v_mfma_f32_16x16x32_bf16 v[88:91], a[96:99], a[32:35], v[88:91]
buffer_load_dwordx4 v22, s[44:47], s20 offen lds
v_mfma_f32_16x16x32_bf16 v[88:91], a[100:103], a[48:51], v[88:91]
ds_read_b64_tr_b16 a[88:89], v13 offset:768
v_mfma_f32_16x16x32_bf16 v[96:99], a[100:103], a[52:55], v[96:99]
ds_read_b64_tr_b16 a[90:91], v13 offset:1792
v_mfma_f32_16x16x32_bf16 v[96:99], a[96:99], a[36:39], v[96:99]
ds_read_b64_tr_b16 a[92:93], v13 offset:8960
v_mfma_f32_16x16x32_bf16 v[104:107], a[96:99], a[40:43], v[104:107]
ds_read_b64_tr_b16 a[94:95], v13 offset:9984
s_add_u32 m0, s16, 0x400
v_mfma_f32_16x16x32_bf16 v[104:107], a[100:103], a[56:59], v[104:107]
buffer_load_dwordx4 v23, s[44:47], s20 offen lds
v_mfma_f32_16x16x32_bf16 v[112:115], a[100:103], a[60:63], v[112:115]
v_mfma_f32_16x16x32_bf16 v[112:115], a[96:99], a[44:47], v[112:115]
v_mfma_f32_16x16x32_bf16 v[116:119], a[104:107], a[44:47], v[116:119]
ds_read_b64_tr_b16 a[96:97], v14 offset:0
v_mfma_f32_16x16x32_bf16 v[116:119], a[108:111], a[60:63], v[116:119]
ds_read_b64_tr_b16 a[98:99], v14 offset:256
v_mfma_f32_16x16x32_bf16 v[108:111], a[108:111], a[56:59], v[108:111]
ds_read_b64_tr_b16 a[100:101], v14 offset:2048
s_add_u32 m0, s16, 0x800
v_mfma_f32_16x16x32_bf16 v[108:111], a[104:107], a[40:43], v[108:111]
buffer_load_dwordx4 v22, s[44:47], s21 offen lds
v_mfma_f32_16x16x32_bf16 v[100:103], a[104:107], a[36:39], v[100:103]
ds_read_b64_tr_b16 a[102:103], v14 offset:2304
v_mfma_f32_16x16x32_bf16 v[100:103], a[108:111], a[52:55], v[100:103]
v_mfma_f32_16x16x32_bf16 v[92:95], a[108:111], a[48:51], v[92:95]
v_mfma_f32_16x16x32_bf16 v[92:95], a[104:107], a[32:35], v[92:95]
s_add_u32 s8, s28, 0x8000
s_waitcnt lgkmcnt(4)
v_mfma_f32_16x16x32_bf16 v[120:123], a[80:83], a[32:35], v[120:123]
buffer_store_dwordx4 a[196:199], v16, s[88:91], s8 offen sc1
v_mfma_f32_16x16x32_bf16 v[120:123], a[84:87], a[48:51], v[120:123]
ds_read_b64_tr_b16 a[104:105], v15 offset:0
v_mfma_f32_16x16x32_bf16 v[128:131], a[84:87], a[52:55], v[128:131]
ds_read_b64_tr_b16 a[106:107], v15 offset:256
v_mfma_f32_16x16x32_bf16 v[128:131], a[80:83], a[36:39], v[128:131]
ds_read_b64_tr_b16 a[108:109], v15 offset:2048
v_mfma_f32_16x16x32_bf16 v[136:139], a[80:83], a[40:43], v[136:139]
ds_read_b64_tr_b16 a[110:111], v15 offset:2304
v_mfma_f32_16x16x32_bf16 v[136:139], a[84:87], a[56:59], v[136:139]
s_add_u32 m0, s16, 0xc00
v_mfma_f32_16x16x32_bf16 v[144:147], a[84:87], a[60:63], v[144:147]
buffer_load_dwordx4 v23, s[44:47], s21 offen lds
v_mfma_f32_16x16x32_bf16 v[144:147], a[80:83], a[44:47], v[144:147]
L_padA7:
s_cmp_eq_u32 s95, 1
s_cbranch_scc1 L_padA11
v_mfma_f32_16x16x32_bf16 v[148:151], a[88:91], a[44:47], v[148:151]
ds_read_b64_tr_b16 a[80:81], v14 offset:4096
v_mfma_f32_16x16x32_bf16 v[148:151], a[92:95], a[60:63], v[148:151]
ds_read_b64_tr_b16 a[82:83], v14 offset:4352
v_mfma_f32_16x16x32_bf16 v[140:143], a[92:95], a[56:59], v[140:143]
ds_read_b64_tr_b16 a[84:85], v14 offset:6144
v_mfma_f32_16x16x32_bf16 v[140:143], a[88:91], a[40:43], v[140:143]
ds_read_b64_tr_b16 a[86:87], v14 offset:6400
s_add_u32 m0, s16, 0x1000
v_mfma_f32_16x16x32_bf16 v[132:135], a[88:91], a[36:39], v[132:135]
buffer_load_dwordx4 v22, s[44:47], s22 offen lds
v_mfma_f32_16x16x32_bf16 v[132:135], a[92:95], a[52:55], v[132:135]
v_mfma_f32_16x16x32_bf16 v[124:127], a[92:95], a[48:51], v[124:127]
v_mfma_f32_16x16x32_bf16 v[124:127], a[88:91], a[32:35], v[124:127]
s_waitcnt lgkmcnt(4)
v_mfma_f32_16x16x32_bf16 v[152:155], a[96:99], a[32:35], v[152:155]
ds_read_b64_tr_b16 a[88:89], v15 offset:4096
s_add_u32 m0, s16, 0x1400
v_mfma_f32_16x16x32_bf16 v[152:155], a[100:103], a[48:51], v[152:155]
buffer_load_dwordx4 v23, s[44:47], s22 offen lds
v_mfma_f32_16x16x32_bf16 v[160:163], a[100:103], a[52:55], v[160:163]
ds_read_b64_tr_b16 a[90:91], v15 offset:4352
v_mfma_f32_16x16x32_bf16 v[160:163], a[96:99], a[36:39], v[160:163]
ds_read_b64_tr_b16 a[92:93], v15 offset:6144
v_mfma_f32_16x16x32_bf16 v[168:171], a[96:99], a[40:43], v[168:171]
ds_read_b64_tr_b16 a[94:95], v15 offset:6400
v_mfma_f32_16x16x32_bf16 v[168:171], a[100:103], a[56:59], v[168:171]
v_mfma_f32_16x16x32_bf16 v[176:179], a[100:103], a[60:63], v[176:179]
s_add_u32 m0, s16, 0x1800
v_mfma_f32_16x16x32_bf16 v[176:179], a[96:99], a[44:47], v[176:179]
buffer_load_dwordx4 v22, s[44:47], s23 offen lds
v_mfma_f32_16x16x32_bf16 v[180:183], a[104:107], a[44:47], v[180:183]
ds_read_b64_tr_b16 a[96:97], v14 offset:8192
v_mfma_f32_16x16x32_bf16 v[180:183], a[108:111], a[60:63], v[180:183]
ds_read_b64_tr_b16 a[98:99], v14 offset:8448
v_mfma_f32_16x16x32_bf16 v[172:175], a[108:111], a[56:59], v[172:175]
ds_read_b64_tr_b16 a[100:101], v14 offset:10240
v_mfma_f32_16x16x32_bf16 v[172:175], a[104:107], a[40:43], v[172:175]
ds_read_b64_tr_b16 a[102:103], v14 offset:10496
s_add_u32 m0, s16, 0x1c00
v_mfma_f32_16x16x32_bf16 v[164:167], a[104:107], a[36:39], v[164:167]
buffer_load_dwordx4 v23, s[44:47], s23 offen lds
v_mfma_f32_16x16x32_bf16 v[164:167], a[108:111], a[52:55], v[164:167]
v_lshl_add_u32 v22, s42, 7, v22
v_lshl_add_u32 v23, s42, 7, v23
v_mfma_f32_16x16x32_bf16 v[156:159], a[108:111], a[48:51], v[156:159]
v_mfma_f32_16x16x32_bf16 v[156:159], a[104:107], a[32:35], v[156:159]
s_waitcnt lgkmcnt(4)
v_mfma_f32_16x16x32_bf16 v[184:187], a[80:83], a[32:35], v[184:187]
ds_read_b64_tr_b16 a[104:105], v15 offset:8192
v_mfma_f32_16x16x32_bf16 v[184:187], a[84:87], a[48:51], v[184:187]
ds_read_b64_tr_b16 a[106:107], v15 offset:8448
s_add_u32 s8, s28, 0x4400
v_mfma_f32_16x16x32_bf16 v[192:195], a[84:87], a[52:55], v[192:195]
buffer_store_dwordx4 a[200:203], v16, s[88:91], s8 offen sc1
v_mfma_f32_16x16x32_bf16 v[192:195], a[80:83], a[36:39], v[192:195]
ds_read_b64_tr_b16 a[108:109], v15 offset:10240
v_mfma_f32_16x16x32_bf16 v[200:203], a[80:83], a[40:43], v[200:203]
ds_read_b64_tr_b16 a[110:111], v15 offset:10496
v_add_u32 v12, 0x8000, v12
v_mfma_f32_16x16x32_bf16 v[200:203], a[84:87], a[56:59], v[200:203]
v_add_u32 v13, 0x8000, v13
v_add_u32 v14, 0x8000, v14
v_mfma_f32_16x16x32_bf16 v[208:211], a[84:87], a[60:63], v[208:211]
v_add_u32 v15, 0x8000, v15
v_mfma_f32_16x16x32_bf16 v[208:211], a[80:83], a[44:47], v[208:211]
v_mfma_f32_16x16x32_bf16 v[212:215], a[88:91], a[44:47], v[212:215]
s_waitcnt vmcnt(29) lgkmcnt(0)
v_mfma_f32_16x16x32_bf16 v[212:215], a[92:95], a[60:63], v[212:215]
s_barrier
s_add_u32 m0, s17, 0x8000
v_mfma_f32_16x16x32_bf16 v[204:207], a[92:95], a[56:59], v[204:207]
buffer_load_dwordx4 v5, s[52:55], 0 offen lds
v_mfma_f32_16x16x32_bf16 v[204:207], a[88:91], a[40:43], v[204:207]
ds_read_b64_tr_b16 a[80:81], v12 offset:0
v_mfma_f32_16x16x32_bf16 v[196:199], a[88:91], a[36:39], v[196:199]
ds_read_b64_tr_b16 a[82:83], v12 offset:1024
v_mfma_f32_16x16x32_bf16 v[196:199], a[92:95], a[52:55], v[196:199]
ds_read_b64_tr_b16 a[84:85], v12 offset:8192
v_mfma_f32_16x16x32_bf16 v[188:191], a[92:95], a[48:51], v[188:191]
ds_read_b64_tr_b16 a[86:87], v12 offset:9216
v_mfma_f32_16x16x32_bf16 v[188:191], a[88:91], a[32:35], v[188:191]
s_add_u32 m0, s17, 0x8400
s_waitcnt lgkmcnt(4)
v_mfma_f32_16x16x32_bf16 v[216:219], a[32:35], a[96:99], v[216:219]
buffer_load_dwordx4 v5, s[52:55], s13 offen lds
v_mfma_f32_16x16x32_bf16 v[216:219], a[48:51], a[100:103], v[216:219]
ds_read_b64_tr_b16 a[88:89], v13 offset:0
v_mfma_f32_16x16x32_bf16 v[224:227], a[52:55], a[100:103], v[224:227]
ds_read_b64_tr_b16 a[90:91], v13 offset:1024
v_mfma_f32_16x16x32_bf16 v[224:227], a[36:39], a[96:99], v[224:227]
ds_read_b64_tr_b16 a[92:93], v13 offset:8192
v_mfma_f32_16x16x32_bf16 v[232:235], a[40:43], a[96:99], v[232:235]
ds_read_b64_tr_b16 a[94:95], v13 offset:9216
v_mfma_f32_16x16x32_bf16 v[232:235], a[56:59], a[100:103], v[232:235]
s_add_u32 m0, s17, 0x8800
v_mfma_f32_16x16x32_bf16 v[240:243], a[60:63], a[100:103], v[240:243]
buffer_load_dwordx4 v6, s[52:55], 0 offen lds
v_mfma_f32_16x16x32_bf16 v[240:243], a[44:47], a[96:99], v[240:243]
v_mfma_f32_16x16x32_bf16 v[244:247], a[44:47], a[104:107], v[244:247]
ds_read_b64_tr_b16 a[96:97], v12 offset:256
v_mfma_f32_16x16x32_bf16 v[244:247], a[60:63], a[108:111], v[244:247]
ds_read_b64_tr_b16 a[98:99], v12 offset:1280
v_mfma_f32_16x16x32_bf16 v[236:239], a[56:59], a[108:111], v[236:239]
ds_read_b64_tr_b16 a[100:101], v12 offset:8448
v_mov_b32 v21, s1
v_mfma_f32_16x16x32_bf16 v[236:239], a[40:43], a[104:107], v[236:239]
ds_read_b64_tr_b16 a[102:103], v12 offset:9472
v_add_u32 v20, s0, v16
v_mfma_f32_16x16x32_bf16 v[228:231], a[36:39], a[104:107], v[228:231]
global_load_dword a120, v[20:21], off sc1
v_mfma_f32_16x16x32_bf16 v[228:231], a[52:55], a[108:111], v[228:231]
v_mfma_f32_16x16x32_bf16 v[220:223], a[48:51], a[108:111], v[220:223]
v_mfma_f32_16x16x32_bf16 v[220:223], a[32:35], a[104:107], v[220:223]
s_waitcnt lgkmcnt(4)
L_S14:
v_mfma_f32_16x16x32_bf16 v[24:27], a[80:83], a[0:3], v[24:27]
ds_read_b64_tr_b16 a[104:105], v13 offset:256
s_waitcnt vmcnt(23)
v_mfma_f32_16x16x32_bf16 v[24:27], a[84:87], a[16:19], v[24:27]
ds_read_b64_tr_b16 a[106:107], v13 offset:1280
s_add_u32 m0, s17, 0x8c00
v_mfma_f32_16x16x32_bf16 v[32:35], a[84:87], a[20:23], v[32:35]
buffer_load_dwordx4 v6, s[52:55], s13 offen lds
v_mfma_f32_16x16x32_bf16 v[32:35], a[80:83], a[4:7], v[32:35]
ds_read_b64_tr_b16 a[108:109], v13 offset:8448
v_mfma_f32_16x16x32_bf16 v[40:43], a[80:83], a[8:11], v[40:43]
ds_read_b64_tr_b16 a[110:111], v13 offset:9472
v_mfma_f32_16x16x32_bf16 v[40:43], a[84:87], a[24:27], v[40:43]
ds_read_b128 a[32:35], v8 offset:32768
v_mfma_f32_16x16x32_bf16 v[48:51], a[84:87], a[28:31], v[48:51]
ds_read_b128 a[48:51], v9 offset:32768
v_mfma_f32_16x16x32_bf16 v[48:51], a[80:83], a[12:15], v[48:51]
ds_read_b128 a[36:39], v8 offset:34816
s_add_u32 m0, s18, 0xc000
v_mfma_f32_16x16x32_bf16 v[52:55], a[88:91], a[12:15], v[52:55]
buffer_load_dwordx4 v7, s[68:71], 0 offen lds
v_mfma_f32_16x16x32_bf16 v[52:55], a[92:95], a[28:31], v[52:55]
ds_read_b64_tr_b16 a[80:81], v12 offset:512
v_mfma_f32_16x16x32_bf16 v[44:47], a[92:95], a[24:27], v[44:47]
ds_read_b64_tr_b16 a[82:83], v12 offset:1536
v_mfma_f32_16x16x32_bf16 v[44:47], a[88:91], a[8:11], v[44:47]
ds_read_b64_tr_b16 a[84:85], v12 offset:8704
v_mfma_f32_16x16x32_bf16 v[36:39], a[88:91], a[4:7], v[36:39]
ds_read_b64_tr_b16 a[86:87], v12 offset:9728
v_mfma_f32_16x16x32_bf16 v[36:39], a[92:95], a[20:23], v[36:39]
ds_read_b128 a[52:55], v9 offset:34816
s_add_u32 m0, s18, 0xd000
v_mfma_f32_16x16x32_bf16 v[28:31], a[92:95], a[16:19], v[28:31]
buffer_load_dwordx4 v7, s[68:71], s25 offen lds
v_mfma_f32_16x16x32_bf16 v[28:31], a[88:91], a[0:3], v[28:31]
ds_read_b128 a[40:43], v8 offset:36864
s_waitcnt lgkmcnt(9)
v_mfma_f32_16x16x32_bf16 v[56:59], a[96:99], a[0:3], v[56:59]
ds_read_b64_tr_b16 a[88:89], v13 offset:512
v_mfma_f32_16x16x32_bf16 v[56:59], a[100:103], a[16:19], v[56:59]
ds_read_b64_tr_b16 a[90:91], v13 offset:1536
v_mfma_f32_16x16x32_bf16 v[64:67], a[100:103], a[20:23], v[64:67]
ds_read_b64_tr_b16 a[92:93], v13 offset:8704
v_mfma_f32_16x16x32_bf16 v[64:67], a[96:99], a[4:7], v[64:67]
ds_read_b64_tr_b16 a[94:95], v13 offset:9728
s_add_u32 m0, s18, 0xe000
v_mfma_f32_16x16x32_bf16 v[72:75], a[96:99], a[8:11], v[72:75]
buffer_load_dwordx4 v7, s[68:71], s26 offen lds
v_mfma_f32_16x16x32_bf16 v[72:75], a[100:103], a[24:27], v[72:75]
ds_read_b128 a[56:59], v9 offset:36864
v_lshl_add_u32 v5, s42, 19, v5
v_mfma_f32_16x16x32_bf16 v[80:83], a[100:103], a[28:31], v[80:83]
ds_read_b128 a[44:47], v8 offset:38912
v_lshl_add_u32 v6, s42, 19, v6
v_mfma_f32_16x16x32_bf16 v[80:83], a[96:99], a[12:15], v[80:83]
ds_read_b128 a[60:63], v9 offset:38912
v_lshl_add_u32 v7, s42, 18, v7
v_mfma_f32_16x16x32_bf16 v[84:87], a[104:107], a[12:15], v[84:87]
ds_read_b64_tr_b16 a[96:97], v12 offset:768
v_lshl_add_u32 v7, s42, 17, v7
v_mfma_f32_16x16x32_bf16 v[84:87], a[108:111], a[28:31], v[84:87]
ds_read_b64_tr_b16 a[98:99], v12 offset:1792
s_add_u32 s8, s28, 0x8400
v_mfma_f32_16x16x32_bf16 v[76:79], a[108:111], a[24:27], v[76:79]
buffer_store_dwordx4 a[204:207], v16, s[88:91], s8 offen sc1
v_mfma_f32_16x16x32_bf16 v[76:79], a[104:107], a[8:11], v[76:79]
ds_read_b64_tr_b16 a[100:101], v12 offset:8960
v_mfma_f32_16x16x32_bf16 v[68:71], a[104:107], a[4:7], v[68:71]
ds_read_b64_tr_b16 a[102:103], v12 offset:9984
v_mfma_f32_16x16x32_bf16 v[68:71], a[108:111], a[20:23], v[68:71]
v_mfma_f32_16x16x32_bf16 v[60:63], a[108:111], a[16:19], v[60:63]
v_mfma_f32_16x16x32_bf16 v[60:63], a[104:107], a[0:3], v[60:63]
s_add_u32 m0, s16, 0x8000
s_waitcnt lgkmcnt(4)
s_waitcnt lgkmcnt(7)
v_mfma_f32_16x16x32_bf16 v[88:91], a[80:83], a[0:3], v[88:91]
buffer_load_dwordx4 v22, s[44:47], s20 offen lds
v_mfma_f32_16x16x32_bf16 v[88:91], a[84:87], a[16:19], v[88:91]
ds_read_b64_tr_b16 a[104:105], v13 offset:768
v_mfma_f32_16x16x32_bf16 v[96:99], a[84:87], a[20:23], v[96:99]
ds_read_b64_tr_b16 a[106:107], v13 offset:1792
v_mfma_f32_16x16x32_bf16 v[96:99], a[80:83], a[4:7], v[96:99]
ds_read_b64_tr_b16 a[108:109], v13 offset:8960
v_mfma_f32_16x16x32_bf16 v[104:107], a[80:83], a[8:11], v[104:107]
ds_read_b64_tr_b16 a[110:111], v13 offset:9984
s_add_u32 m0, s16, 0x8400
v_mfma_f32_16x16x32_bf16 v[104:107], a[84:87], a[24:27], v[104:107]
buffer_load_dwordx4 v23, s[44:47], s20 offen lds
v_mfma_f32_16x16x32_bf16 v[112:115], a[84:87], a[28:31], v[112:115]
v_mfma_f32_16x16x32_bf16 v[112:115], a[80:83], a[12:15], v[112:115]
v_mfma_f32_16x16x32_bf16 v[116:119], a[88:91], a[12:15], v[116:119]
ds_read_b64_tr_b16 a[80:81], v14 offset:0
v_mfma_f32_16x16x32_bf16 v[116:119], a[92:95], a[28:31], v[116:119]
ds_read_b64_tr_b16 a[82:83], v14 offset:256
v_mfma_f32_16x16x32_bf16 v[108:111], a[92:95], a[24:27], v[108:111]
ds_read_b64_tr_b16 a[84:85], v14 offset:2048
s_add_u32 m0, s16, 0x8800
v_mfma_f32_16x16x32_bf16 v[108:111], a[88:91], a[8:11], v[108:111]
buffer_load_dwordx4 v22, s[44:47], s21 offen lds
v_mfma_f32_16x16x32_bf16 v[100:103], a[88:91], a[4:7], v[100:103]
ds_read_b64_tr_b16 a[86:87], v14 offset:2304
v_mfma_f32_16x16x32_bf16 v[100:103], a[92:95], a[20:23], v[100:103]
v_mfma_f32_16x16x32_bf16 v[92:95], a[92:95], a[16:19], v[92:95]
v_mfma_f32_16x16x32_bf16 v[92:95], a[88:91], a[0:3], v[92:95]
s_add_u32 m0, s16, 0x8c00
s_waitcnt lgkmcnt(4)
v_mfma_f32_16x16x32_bf16 v[120:123], a[96:99], a[0:3], v[120:123]
buffer_load_dwordx4 v23, s[44:47], s21 offen lds
v_mfma_f32_16x16x32_bf16 v[120:123], a[100:103], a[16:19], v[120:123]
ds_read_b64_tr_b16 a[88:89], v15 offset:0
v_mfma_f32_16x16x32_bf16 v[128:131], a[100:103], a[20:23], v[128:131]
ds_read_b64_tr_b16 a[90:91], v15 offset:256
v_mfma_f32_16x16x32_bf16 v[128:131], a[96:99], a[4:7], v[128:131]
ds_read_b64_tr_b16 a[92:93], v15 offset:2048
v_mfma_f32_16x16x32_bf16 v[136:139], a[96:99], a[8:11], v[136:139]
ds_read_b64_tr_b16 a[94:95], v15 offset:2304
v_mfma_f32_16x16x32_bf16 v[136:139], a[100:103], a[24:27], v[136:139]
s_add_u32 s8, s28, 0x4800
v_mfma_f32_16x16x32_bf16 v[144:147], a[100:103], a[28:31], v[144:147]
buffer_store_dwordx4 a[208:211], v16, s[88:91], s8 offen sc1
v_mfma_f32_16x16x32_bf16 v[144:147], a[96:99], a[12:15], v[144:147]
v_mfma_f32_16x16x32_bf16 v[148:151], a[104:107], a[12:15], v[148:151]
ds_read_b64_tr_b16 a[96:97], v14 offset:4096
v_mfma_f32_16x16x32_bf16 v[148:151], a[108:111], a[28:31], v[148:151]
ds_read_b64_tr_b16 a[98:99], v14 offset:4352
v_mfma_f32_16x16x32_bf16 v[140:143], a[108:111], a[24:27], v[140:143]
ds_read_b64_tr_b16 a[100:101], v14 offset:6144
v_mfma_f32_16x16x32_bf16 v[140:143], a[104:107], a[8:11], v[140:143]
ds_read_b64_tr_b16 a[102:103], v14 offset:6400
s_add_u32 m0, s16, 0x9000
v_mfma_f32_16x16x32_bf16 v[132:135], a[104:107], a[4:7], v[132:135]
buffer_load_dwordx4 v22, s[44:47], s22 offen lds
v_mfma_f32_16x16x32_bf16 v[132:135], a[108:111], a[20:23], v[132:135]
v_mfma_f32_16x16x32_bf16 v[124:127], a[108:111], a[16:19], v[124:127]
v_mfma_f32_16x16x32_bf16 v[124:127], a[104:107], a[0:3], v[124:127]
s_waitcnt lgkmcnt(4)
v_mfma_f32_16x16x32_bf16 v[152:155], a[80:83], a[0:3], v[152:155]
ds_read_b64_tr_b16 a[104:105], v15 offset:4096
s_add_u32 m0, s16, 0x9400
v_mfma_f32_16x16x32_bf16 v[152:155], a[84:87], a[16:19], v[152:155]
buffer_load_dwordx4 v23, s[44:47], s22 offen lds
v_mfma_f32_16x16x32_bf16 v[160:163], a[84:87], a[20:23], v[160:163]
ds_read_b64_tr_b16 a[106:107], v15 offset:4352
v_mfma_f32_16x16x32_bf16 v[160:163], a[80:83], a[4:7], v[160:163]
ds_read_b64_tr_b16 a[108:109], v15 offset:6144
v_mfma_f32_16x16x32_bf16 v[168:171], a[80:83], a[8:11], v[168:171]
ds_read_b64_tr_b16 a[110:111], v15 offset:6400
v_mfma_f32_16x16x32_bf16 v[168:171], a[84:87], a[24:27], v[168:171]
v_mfma_f32_16x16x32_bf16 v[176:179], a[84:87], a[28:31], v[176:179]
s_add_u32 m0, s16, 0x9800
v_mfma_f32_16x16x32_bf16 v[176:179], a[80:83], a[12:15], v[176:179]
buffer_load_dwordx4 v22, s[44:47], s23 offen lds
v_mfma_f32_16x16x32_bf16 v[180:183], a[88:91], a[12:15], v[180:183]
ds_read_b64_tr_b16 a[80:81], v14 offset:8192
v_mfma_f32_16x16x32_bf16 v[180:183], a[92:95], a[28:31], v[180:183]
ds_read_b64_tr_b16 a[82:83], v14 offset:8448
v_mfma_f32_16x16x32_bf16 v[172:175], a[92:95], a[24:27], v[172:175]
ds_read_b64_tr_b16 a[84:85], v14 offset:10240
v_mfma_f32_16x16x32_bf16 v[172:175], a[88:91], a[8:11], v[172:175]
ds_read_b64_tr_b16 a[86:87], v14 offset:10496
s_add_u32 m0, s16, 0x9c00
v_mfma_f32_16x16x32_bf16 v[164:167], a[88:91], a[4:7], v[164:167]
buffer_load_dwordx4 v23, s[44:47], s23 offen lds
v_mfma_f32_16x16x32_bf16 v[164:167], a[92:95], a[20:23], v[164:167]
v_lshl_add_u32 v22, s42, 7, v22
v_lshl_add_u32 v23, s42, 7, v23
v_mfma_f32_16x16x32_bf16 v[156:159], a[92:95], a[16:19], v[156:159]
v_mfma_f32_16x16x32_bf16 v[156:159], a[88:91], a[0:3], v[156:159]
s_waitcnt lgkmcnt(4)
v_mfma_f32_16x16x32_bf16 v[184:187], a[96:99], a[0:3], v[184:187]
ds_read_b64_tr_b16 a[88:89], v15 offset:8192
v_mfma_f32_16x16x32_bf16 v[184:187], a[100:103], a[16:19], v[184:187]
ds_read_b64_tr_b16 a[90:91], v15 offset:8448
s_add_u32 s8, s28, 0x8800
v_mfma_f32_16x16x32_bf16 v[192:195], a[100:103], a[20:23], v[192:195]
buffer_store_dwordx4 a[212:215], v16, s[88:91], s8 offen sc1
v_mfma_f32_16x16x32_bf16 v[192:195], a[96:99], a[4:7], v[192:195]
ds_read_b64_tr_b16 a[92:93], v15 offset:10240
v_mfma_f32_16x16x32_bf16 v[200:203], a[96:99], a[8:11], v[200:203]
ds_read_b64_tr_b16 a[94:95], v15 offset:10496
v_add_u32 v12, 0xffff0000, v12
v_mfma_f32_16x16x32_bf16 v[200:203], a[100:103], a[24:27], v[200:203]
v_add_u32 v13, 0xffff0000, v13
v_add_u32 v14, 0xffff0000, v14
v_mfma_f32_16x16x32_bf16 v[208:211], a[100:103], a[28:31], v[208:211]
v_add_u32 v15, 0xffff0000, v15
v_mfma_f32_16x16x32_bf16 v[208:211], a[96:99], a[12:15], v[208:211]
v_mfma_f32_16x16x32_bf16 v[212:215], a[104:107], a[12:15], v[212:215]
s_waitcnt vmcnt(29) lgkmcnt(0)
v_mfma_f32_16x16x32_bf16 v[212:215], a[108:111], a[28:31], v[212:215]
s_barrier
s_add_u32 m0, s17, 0x10000
v_mfma_f32_16x16x32_bf16 v[204:207], a[108:111], a[24:27], v[204:207]
buffer_load_dwordx4 v5, s[52:55], 0 offen lds
v_mfma_f32_16x16x32_bf16 v[204:207], a[104:107], a[8:11], v[204:207]
ds_read_b64_tr_b16 a[96:97], v12 offset:0
v_mfma_f32_16x16x32_bf16 v[196:199], a[104:107], a[4:7], v[196:199]
ds_read_b64_tr_b16 a[98:99], v12 offset:1024
v_mfma_f32_16x16x32_bf16 v[196:199], a[108:111], a[20:23], v[196:199]
ds_read_b64_tr_b16 a[100:101], v12 offset:8192
v_mfma_f32_16x16x32_bf16 v[188:191], a[108:111], a[16:19], v[188:191]
ds_read_b64_tr_b16 a[102:103], v12 offset:9216
v_mfma_f32_16x16x32_bf16 v[188:191], a[104:107], a[0:3], v[188:191]
s_add_u32 m0, s17, 0x10400
s_waitcnt lgkmcnt(4)
v_mfma_f32_16x16x32_bf16 v[216:219], a[0:3], a[80:83], v[216:219]
buffer_load_dwordx4 v5, s[52:55], s13 offen lds
v_mfma_f32_16x16x32_bf16 v[216:219], a[16:19], a[84:87], v[216:219]
ds_read_b64_tr_b16 a[104:105], v13 offset:0
v_mfma_f32_16x16x32_bf16 v[224:227], a[20:23], a[84:87], v[224:227]
ds_read_b64_tr_b16 a[106:107], v13 offset:1024
v_mfma_f32_16x16x32_bf16 v[224:227], a[4:7], a[80:83], v[224:227]
ds_read_b64_tr_b16 a[108:109], v13 offset:8192
v_mfma_f32_16x16x32_bf16 v[232:235], a[8:11], a[80:83], v[232:235]
ds_read_b64_tr_b16 a[110:111], v13 offset:9216
v_mfma_f32_16x16x32_bf16 v[232:235], a[24:27], a[84:87], v[232:235]
v_mfma_f32_16x16x32_bf16 v[240:243], a[28:31], a[84:87], v[240:243]
s_add_u32 m0, s17, 0x10800
v_mfma_f32_16x16x32_bf16 v[240:243], a[12:15], a[80:83], v[240:243]
buffer_load_dwordx4 v6, s[52:55], 0 offen lds
v_mfma_f32_16x16x32_bf16 v[244:247], a[12:15], a[88:91], v[244:247]
ds_read_b64_tr_b16 a[80:81], v12 offset:256
v_mfma_f32_16x16x32_bf16 v[244:247], a[28:31], a[92:95], v[244:247]
ds_read_b64_tr_b16 a[82:83], v12 offset:1280
v_mfma_f32_16x16x32_bf16 v[236:239], a[24:27], a[92:95], v[236:239]
ds_read_b64_tr_b16 a[84:85], v12 offset:8448
v_mfma_f32_16x16x32_bf16 v[236:239], a[8:11], a[88:91], v[236:239]
ds_read_b64_tr_b16 a[86:87], v12 offset:9472
v_mfma_f32_16x16x32_bf16 v[228:231], a[4:7], a[88:91], v[228:231]
v_mfma_f32_16x16x32_bf16 v[228:231], a[20:23], a[92:95], v[228:231]
s_add_u32 m0, s17, 0x10c00
v_mfma_f32_16x16x32_bf16 v[220:223], a[16:19], a[92:95], v[220:223]
buffer_load_dwordx4 v6, s[52:55], s13 offen lds
v_mfma_f32_16x16x32_bf16 v[220:223], a[0:3], a[88:91], v[220:223]
s_waitcnt lgkmcnt(4)
L_S15:
v_mfma_f32_16x16x32_bf16 v[24:27], a[96:99], a[32:35], v[24:27]
ds_read_b64_tr_b16 a[88:89], v13 offset:256
s_waitcnt vmcnt(24)
v_mfma_f32_16x16x32_bf16 v[24:27], a[100:103], a[48:51], v[24:27]
ds_read_b64_tr_b16 a[90:91], v13 offset:1280
v_mfma_f32_16x16x32_bf16 v[32:35], a[100:103], a[52:55], v[32:35]
ds_read_b64_tr_b16 a[92:93], v13 offset:8448
v_mfma_f32_16x16x32_bf16 v[32:35], a[96:99], a[36:39], v[32:35]
ds_read_b64_tr_b16 a[94:95], v13 offset:9472
v_mfma_f32_16x16x32_bf16 v[40:43], a[96:99], a[40:43], v[40:43]
ds_read_b128 a[0:3], v8 offset:0
s_add_u32 m0, s18, 0x14000
v_mfma_f32_16x16x32_bf16 v[40:43], a[100:103], a[56:59], v[40:43]
buffer_load_dwordx4 v7, s[68:71], 0 offen lds
v_mfma_f32_16x16x32_bf16 v[48:51], a[100:103], a[60:63], v[48:51]
ds_read_b128 a[16:19], v9 offset:0
v_mfma_f32_16x16x32_bf16 v[48:51], a[96:99], a[44:47], v[48:51]
ds_read_b128 a[4:7], v8 offset:2048
v_mfma_f32_16x16x32_bf16 v[52:55], a[104:107], a[44:47], v[52:55]
ds_read_b64_tr_b16 a[96:97], v12 offset:512
v_mfma_f32_16x16x32_bf16 v[52:55], a[108:111], a[60:63], v[52:55]
ds_read_b64_tr_b16 a[98:99], v12 offset:1536
v_mfma_f32_16x16x32_bf16 v[44:47], a[108:111], a[56:59], v[44:47]
ds_read_b64_tr_b16 a[100:101], v12 offset:8704
s_add_u32 s8, s28, 0x4c00
v_mfma_f32_16x16x32_bf16 v[44:47], a[104:107], a[40:43], v[44:47]
buffer_store_dwordx4 a[216:219], v16, s[88:91], s8 offen sc1
v_mfma_f32_16x16x32_bf16 v[36:39], a[104:107], a[36:39], v[36:39]
ds_read_b64_tr_b16 a[102:103], v12 offset:9728
v_mfma_f32_16x16x32_bf16 v[36:39], a[108:111], a[52:55], v[36:39]
ds_read_b128 a[20:23], v9 offset:2048
v_mfma_f32_16x16x32_bf16 v[28:31], a[108:111], a[48:51], v[28:31]
ds_read_b128 a[8:11], v8 offset:4096
v_mfma_f32_16x16x32_bf16 v[28:31], a[104:107], a[32:35], v[28:31]
ds_read_b128 a[24:27], v9 offset:4096
s_waitcnt lgkmcnt(10)
v_mfma_f32_16x16x32_bf16 v[56:59], a[80:83], a[32:35], v[56:59]
ds_read_b64_tr_b16 a[104:105], v13 offset:512
v_mfma_f32_16x16x32_bf16 v[56:59], a[84:87], a[48:51], v[56:59]
ds_read_b64_tr_b16 a[106:107], v13 offset:1536
s_add_u32 m0, s18, 0x15000
v_mfma_f32_16x16x32_bf16 v[64:67], a[84:87], a[52:55], v[64:67]
buffer_load_dwordx4 v7, s[68:71], s25 offen lds
v_mfma_f32_16x16x32_bf16 v[64:67], a[80:83], a[36:39], v[64:67]
ds_read_b64_tr_b16 a[108:109], v13 offset:8704
v_mfma_f32_16x16x32_bf16 v[72:75], a[80:83], a[40:43], v[72:75]
ds_read_b64_tr_b16 a[110:111], v13 offset:9728
v_mfma_f32_16x16x32_bf16 v[72:75], a[84:87], a[56:59], v[72:75]
ds_read_b128 a[12:15], v8 offset:6144
v_mfma_f32_16x16x32_bf16 v[80:83], a[84:87], a[60:63], v[80:83]
ds_read_b128 a[28:31], v9 offset:6144
v_mfma_f32_16x16x32_bf16 v[80:83], a[80:83], a[44:47], v[80:83]
v_mfma_f32_16x16x32_bf16 v[84:87], a[88:91], a[44:47], v[84:87]
ds_read_b64_tr_b16 a[80:81], v12 offset:768
s_add_u32 m0, s18, 0x16000
v_mfma_f32_16x16x32_bf16 v[84:87], a[92:95], a[60:63], v[84:87]
buffer_load_dwordx4 v7, s[68:71], s26 offen lds
v_mfma_f32_16x16x32_bf16 v[76:79], a[92:95], a[56:59], v[76:79]
ds_read_b64_tr_b16 a[82:83], v12 offset:1792
v_lshl_add_u32 v5, s42, 19, v5
v_mfma_f32_16x16x32_bf16 v[76:79], a[88:91], a[40:43], v[76:79]
ds_read_b64_tr_b16 a[84:85], v12 offset:8960
v_lshl_add_u32 v6, s42, 19, v6
v_mfma_f32_16x16x32_bf16 v[68:71], a[88:91], a[36:39], v[68:71]
ds_read_b64_tr_b16 a[86:87], v12 offset:9984
v_lshl_add_u32 v7, s42, 18, v7
v_mfma_f32_16x16x32_bf16 v[68:71], a[92:95], a[52:55], v[68:71]
v_lshl_add_u32 v7, s42, 17, v7
v_mfma_f32_16x16x32_bf16 v[60:63], a[92:95], a[48:51], v[60:63]
v_mfma_f32_16x16x32_bf16 v[60:63], a[88:91], a[32:35], v[60:63]
s_add_u32 m0, s16, 0x0
s_waitcnt lgkmcnt(4)
s_waitcnt lgkmcnt(6)
v_mfma_f32_16x16x32_bf16 v[88:91], a[96:99], a[32:35], v[88:91]
buffer_load_dwordx4 v22, s[44:47], s20 offen lds
v_mfma_f32_16x16x32_bf16 v[88:91], a[100:103], a[48:51], v[88:91]
ds_read_b64_tr_b16 a[88:89], v13 offset:768
v_mfma_f32_16x16x32_bf16 v[96:99], a[100:103], a[52:55], v[96:99]
ds_read_b64_tr_b16 a[90:91], v13 offset:1792
v_mfma_f32_16x16x32_bf16 v[96:99], a[96:99], a[36:39], v[96:99]
ds_read_b64_tr_b16 a[92:93], v13 offset:8960
v_mfma_f32_16x16x32_bf16 v[104:107], a[96:99], a[40:43], v[104:107]
ds_read_b64_tr_b16 a[94:95], v13 offset:9984
s_add_u32 m0, s16, 0x400
v_mfma_f32_16x16x32_bf16 v[104:107], a[100:103], a[56:59], v[104:107]
buffer_load_dwordx4 v23, s[44:47], s20 offen lds
v_mfma_f32_16x16x32_bf16 v[112:115], a[100:103], a[60:63], v[112:115]
v_mfma_f32_16x16x32_bf16 v[112:115], a[96:99], a[44:47], v[112:115]
v_mfma_f32_16x16x32_bf16 v[116:119], a[104:107], a[44:47], v[116:119]
ds_read_b64_tr_b16 a[96:97], v14 offset:0
v_mfma_f32_16x16x32_bf16 v[116:119], a[108:111], a[60:63], v[116:119]
ds_read_b64_tr_b16 a[98:99], v14 offset:256
v_mfma_f32_16x16x32_bf16 v[108:111], a[108:111], a[56:59], v[108:111]
ds_read_b64_tr_b16 a[100:101], v14 offset:2048
s_add_u32 m0, s16, 0x800
v_mfma_f32_16x16x32_bf16 v[108:111], a[104:107], a[40:43], v[108:111]
buffer_load_dwordx4 v22, s[44:47], s21 offen lds
v_mfma_f32_16x16x32_bf16 v[100:103], a[104:107], a[36:39], v[100:103]
ds_read_b64_tr_b16 a[102:103], v14 offset:2304
v_mfma_f32_16x16x32_bf16 v[100:103], a[108:111], a[52:55], v[100:103]
v_mfma_f32_16x16x32_bf16 v[92:95], a[108:111], a[48:51], v[92:95]
v_mfma_f32_16x16x32_bf16 v[92:95], a[104:107], a[32:35], v[92:95]
s_add_u32 s8, s28, 0x8c00
s_waitcnt lgkmcnt(4)
v_mfma_f32_16x16x32_bf16 v[120:123], a[80:83], a[32:35], v[120:123]
buffer_store_dwordx4 a[220:223], v16, s[88:91], s8 offen sc1
v_mfma_f32_16x16x32_bf16 v[120:123], a[84:87], a[48:51], v[120:123]
ds_read_b64_tr_b16 a[104:105], v15 offset:0
v_mfma_f32_16x16x32_bf16 v[128:131], a[84:87], a[52:55], v[128:131]
ds_read_b64_tr_b16 a[106:107], v15 offset:256
v_mfma_f32_16x16x32_bf16 v[128:131], a[80:83], a[36:39], v[128:131]
ds_read_b64_tr_b16 a[108:109], v15 offset:2048
v_mfma_f32_16x16x32_bf16 v[136:139], a[80:83], a[40:43], v[136:139]
ds_read_b64_tr_b16 a[110:111], v15 offset:2304
v_mfma_f32_16x16x32_bf16 v[136:139], a[84:87], a[56:59], v[136:139]
s_add_u32 m0, s16, 0xc00
v_mfma_f32_16x16x32_bf16 v[144:147], a[84:87], a[60:63], v[144:147]
buffer_load_dwordx4 v23, s[44:47], s21 offen lds
v_mfma_f32_16x16x32_bf16 v[144:147], a[80:83], a[44:47], v[144:147]
v_mfma_f32_16x16x32_bf16 v[148:151], a[88:91], a[44:47], v[148:151]
ds_read_b64_tr_b16 a[80:81], v14 offset:4096
v_mfma_f32_16x16x32_bf16 v[148:151], a[92:95], a[60:63], v[148:151]
ds_read_b64_tr_b16 a[82:83], v14 offset:4352
v_mfma_f32_16x16x32_bf16 v[140:143], a[92:95], a[56:59], v[140:143]
ds_read_b64_tr_b16 a[84:85], v14 offset:6144
v_mfma_f32_16x16x32_bf16 v[140:143], a[88:91], a[40:43], v[140:143]
ds_read_b64_tr_b16 a[86:87], v14 offset:6400
s_add_u32 m0, s16, 0x1000
v_mfma_f32_16x16x32_bf16 v[132:135], a[88:91], a[36:39], v[132:135]
buffer_load_dwordx4 v22, s[44:47], s22 offen lds
v_mfma_f32_16x16x32_bf16 v[132:135], a[92:95], a[52:55], v[132:135]
v_mfma_f32_16x16x32_bf16 v[124:127], a[92:95], a[48:51], v[124:127]
v_mfma_f32_16x16x32_bf16 v[124:127], a[88:91], a[32:35], v[124:127]
s_waitcnt lgkmcnt(4)
v_mfma_f32_16x16x32_bf16 v[152:155], a[96:99], a[32:35], v[152:155]
ds_read_b64_tr_b16 a[88:89], v15 offset:4096
s_add_u32 m0, s16, 0x1400
v_mfma_f32_16x16x32_bf16 v[152:155], a[100:103], a[48:51], v[152:155]
buffer_load_dwordx4 v23, s[44:47], s22 offen lds
v_mfma_f32_16x16x32_bf16 v[160:163], a[100:103], a[52:55], v[160:163]
ds_read_b64_tr_b16 a[90:91], v15 offset:4352
v_mfma_f32_16x16x32_bf16 v[160:163], a[96:99], a[36:39], v[160:163]
ds_read_b64_tr_b16 a[92:93], v15 offset:6144
v_mfma_f32_16x16x32_bf16 v[168:171], a[96:99], a[40:43], v[168:171]
ds_read_b64_tr_b16 a[94:95], v15 offset:6400
v_mfma_f32_16x16x32_bf16 v[168:171], a[100:103], a[56:59], v[168:171]
v_mfma_f32_16x16x32_bf16 v[176:179], a[100:103], a[60:63], v[176:179]
s_add_u32 m0, s16, 0x1800
v_mfma_f32_16x16x32_bf16 v[176:179], a[96:99], a[44:47], v[176:179]
buffer_load_dwordx4 v22, s[44:47], s23 offen lds
v_mfma_f32_16x16x32_bf16 v[180:183], a[104:107], a[44:47], v[180:183]
ds_read_b64_tr_b16 a[96:97], v14 offset:8192
v_mfma_f32_16x16x32_bf16 v[180:183], a[108:111], a[60:63], v[180:183]
ds_read_b64_tr_b16 a[98:99], v14 offset:8448
v_mfma_f32_16x16x32_bf16 v[172:175], a[108:111], a[56:59], v[172:175]
ds_read_b64_tr_b16 a[100:101], v14 offset:10240
v_mfma_f32_16x16x32_bf16 v[172:175], a[104:107], a[40:43], v[172:175]
ds_read_b64_tr_b16 a[102:103], v14 offset:10496
s_add_u32 m0, s16, 0x1c00
v_mfma_f32_16x16x32_bf16 v[164:167], a[104:107], a[36:39], v[164:167]
buffer_load_dwordx4 v23, s[44:47], s23 offen lds
v_mfma_f32_16x16x32_bf16 v[164:167], a[108:111], a[52:55], v[164:167]
v_lshl_add_u32 v22, s42, 7, v22
v_lshl_add_u32 v23, s42, 7, v23
v_mfma_f32_16x16x32_bf16 v[156:159], a[108:111], a[48:51], v[156:159]
v_mfma_f32_16x16x32_bf16 v[156:159], a[104:107], a[32:35], v[156:159]
s_waitcnt lgkmcnt(4)
v_mfma_f32_16x16x32_bf16 v[184:187], a[80:83], a[32:35], v[184:187]
ds_read_b64_tr_b16 a[104:105], v15 offset:8192
v_mfma_f32_16x16x32_bf16 v[184:187], a[84:87], a[48:51], v[184:187]
ds_read_b64_tr_b16 a[106:107], v15 offset:8448
s_add_u32 s8, s28, 0x5000
v_mfma_f32_16x16x32_bf16 v[192:195], a[84:87], a[52:55], v[192:195]
buffer_store_dwordx4 a[224:227], v16, s[88:91], s8 offen sc1
v_mfma_f32_16x16x32_bf16 v[192:195], a[80:83], a[36:39], v[192:195]
ds_read_b64_tr_b16 a[108:109], v15 offset:10240
L_padA8:
s_cmp_eq_u32 s95, 1
s_cbranch_scc1 L_padA12
v_mfma_f32_16x16x32_bf16 v[200:203], a[80:83], a[40:43], v[200:203]
ds_read_b64_tr_b16 a[110:111], v15 offset:10496
v_add_u32 v12, 0x8000, v12
v_mfma_f32_16x16x32_bf16 v[200:203], a[84:87], a[56:59], v[200:203]
v_add_u32 v13, 0x8000, v13
v_add_u32 v14, 0x8000, v14
v_mfma_f32_16x16x32_bf16 v[208:211], a[84:87], a[60:63], v[208:211]
v_add_u32 v15, 0x8000, v15
v_mfma_f32_16x16x32_bf16 v[208:211], a[80:83], a[44:47], v[208:211]
v_mfma_f32_16x16x32_bf16 v[212:215], a[88:91], a[44:47], v[212:215]
s_waitcnt vmcnt(29) lgkmcnt(0)
v_mfma_f32_16x16x32_bf16 v[212:215], a[92:95], a[60:63], v[212:215]
s_barrier
s_add_u32 m0, s17, 0x0
v_mfma_f32_16x16x32_bf16 v[204:207], a[92:95], a[56:59], v[204:207]
buffer_load_dwordx4 v5, s[52:55], 0 offen lds
v_mfma_f32_16x16x32_bf16 v[204:207], a[88:91], a[40:43], v[204:207]
ds_read_b64_tr_b16 a[80:81], v12 offset:0
v_mfma_f32_16x16x32_bf16 v[196:199], a[88:91], a[36:39], v[196:199]
ds_read_b64_tr_b16 a[82:83], v12 offset:1024
v_mfma_f32_16x16x32_bf16 v[196:199], a[92:95], a[52:55], v[196:199]
ds_read_b64_tr_b16 a[84:85], v12 offset:8192
v_mfma_f32_16x16x32_bf16 v[188:191], a[92:95], a[48:51], v[188:191]
ds_read_b64_tr_b16 a[86:87], v12 offset:9216
v_mfma_f32_16x16x32_bf16 v[188:191], a[88:91], a[32:35], v[188:191]
s_add_u32 m0, s17, 0x400
s_waitcnt lgkmcnt(4)
v_mfma_f32_16x16x32_bf16 v[216:219], a[32:35], a[96:99], v[216:219]
buffer_load_dwordx4 v5, s[52:55], s13 offen lds
v_mfma_f32_16x16x32_bf16 v[216:219], a[48:51], a[100:103], v[216:219]
ds_read_b64_tr_b16 a[88:89], v13 offset:0
v_mfma_f32_16x16x32_bf16 v[224:227], a[52:55], a[100:103], v[224:227]
ds_read_b64_tr_b16 a[90:91], v13 offset:1024
v_mfma_f32_16x16x32_bf16 v[224:227], a[36:39], a[96:99], v[224:227]
ds_read_b64_tr_b16 a[92:93], v13 offset:8192
v_mfma_f32_16x16x32_bf16 v[232:235], a[40:43], a[96:99], v[232:235]
ds_read_b64_tr_b16 a[94:95], v13 offset:9216
v_mfma_f32_16x16x32_bf16 v[232:235], a[56:59], a[100:103], v[232:235]
v_mfma_f32_16x16x32_bf16 v[240:243], a[60:63], a[100:103], v[240:243]
s_add_u32 m0, s17, 0x800
v_mfma_f32_16x16x32_bf16 v[240:243], a[44:47], a[96:99], v[240:243]
buffer_load_dwordx4 v6, s[52:55], 0 offen lds
v_mfma_f32_16x16x32_bf16 v[244:247], a[44:47], a[104:107], v[244:247]
ds_read_b64_tr_b16 a[96:97], v12 offset:256
v_mfma_f32_16x16x32_bf16 v[244:247], a[60:63], a[108:111], v[244:247]
ds_read_b64_tr_b16 a[98:99], v12 offset:1280
v_mfma_f32_16x16x32_bf16 v[236:239], a[56:59], a[108:111], v[236:239]
ds_read_b64_tr_b16 a[100:101], v12 offset:8448
v_mfma_f32_16x16x32_bf16 v[236:239], a[40:43], a[104:107], v[236:239]
ds_read_b64_tr_b16 a[102:103], v12 offset:9472
v_mfma_f32_16x16x32_bf16 v[228:231], a[36:39], a[104:107], v[228:231]
v_mfma_f32_16x16x32_bf16 v[228:231], a[52:55], a[108:111], v[228:231]
s_add_u32 m0, s17, 0xc00
v_mfma_f32_16x16x32_bf16 v[220:223], a[48:51], a[108:111], v[220:223]
buffer_load_dwordx4 v6, s[52:55], s13 offen lds
v_mfma_f32_16x16x32_bf16 v[220:223], a[32:35], a[104:107], v[220:223]
s_waitcnt lgkmcnt(4)
L_S16:
v_mfma_f32_16x16x32_bf16 v[24:27], a[80:83], a[0:3], v[24:27]
ds_read_b64_tr_b16 a[104:105], v13 offset:256
s_waitcnt vmcnt(23)
v_mfma_f32_16x16x32_bf16 v[24:27], a[84:87], a[16:19], v[24:27]
ds_read_b64_tr_b16 a[106:107], v13 offset:1280
v_mfma_f32_16x16x32_bf16 v[32:35], a[84:87], a[20:23], v[32:35]
ds_read_b64_tr_b16 a[108:109], v13 offset:8448
v_mfma_f32_16x16x32_bf16 v[32:35], a[80:83], a[4:7], v[32:35]
ds_read_b64_tr_b16 a[110:111], v13 offset:9472
v_mfma_f32_16x16x32_bf16 v[40:43], a[80:83], a[8:11], v[40:43]
ds_read_b128 a[32:35], v8 offset:32768
s_add_u32 m0, s18, 0x4000
v_mfma_f32_16x16x32_bf16 v[40:43], a[84:87], a[24:27], v[40:43]
buffer_load_dwordx4 v7, s[68:71], 0 offen lds
v_mfma_f32_16x16x32_bf16 v[48:51], a[84:87], a[28:31], v[48:51]
ds_read_b128 a[48:51], v9 offset:32768
v_mfma_f32_16x16x32_bf16 v[48:51], a[80:83], a[12:15], v[48:51]
ds_read_b128 a[36:39], v8 offset:34816
v_mfma_f32_16x16x32_bf16 v[52:55], a[88:91], a[12:15], v[52:55]
ds_read_b64_tr_b16 a[80:81], v12 offset:512
v_mfma_f32_16x16x32_bf16 v[52:55], a[92:95], a[28:31], v[52:55]
ds_read_b64_tr_b16 a[82:83], v12 offset:1536
v_mfma_f32_16x16x32_bf16 v[44:47], a[92:95], a[24:27], v[44:47]
ds_read_b64_tr_b16 a[84:85], v12 offset:8704
s_add_u32 s8, s28, 0x9000
v_mfma_f32_16x16x32_bf16 v[44:47], a[88:91], a[8:11], v[44:47]
buffer_store_dwordx4 a[228:231], v16, s[88:91], s8 offen sc1
v_mfma_f32_16x16x32_bf16 v[36:39], a[88:91], a[4:7], v[36:39]
ds_read_b64_tr_b16 a[86:87], v12 offset:9728
v_mfma_f32_16x16x32_bf16 v[36:39], a[92:95], a[20:23], v[36:39]
ds_read_b128 a[52:55], v9 offset:34816
v_mfma_f32_16x16x32_bf16 v[28:31], a[92:95], a[16:19], v[28:31]
ds_read_b128 a[40:43], v8 offset:36864
v_mfma_f32_16x16x32_bf16 v[28:31], a[88:91], a[0:3], v[28:31]
ds_read_b128 a[56:59], v9 offset:36864
s_waitcnt lgkmcnt(10)
v_mfma_f32_16x16x32_bf16 v[56:59], a[96:99], a[0:3], v[56:59]
ds_read_b64_tr_b16 a[88:89], v13 offset:512
v_mfma_f32_16x16x32_bf16 v[56:59], a[100:103], a[16:19], v[56:59]
ds_read_b64_tr_b16 a[90:91], v13 offset:1536
s_add_u32 m0, s18, 0x5000
v_mfma_f32_16x16x32_bf16 v[64:67], a[100:103], a[20:23], v[64:67]
buffer_load_dwordx4 v7, s[68:71], s25 offen lds
v_mfma_f32_16x16x32_bf16 v[64:67], a[96:99], a[4:7], v[64:67]
ds_read_b64_tr_b16 a[92:93], v13 offset:8704
v_mfma_f32_16x16x32_bf16 v[72:75], a[96:99], a[8:11], v[72:75]
ds_read_b64_tr_b16 a[94:95], v13 offset:9728
v_mfma_f32_16x16x32_bf16 v[72:75], a[100:103], a[24:27], v[72:75]
ds_read_b128 a[44:47], v8 offset:38912
v_mfma_f32_16x16x32_bf16 v[80:83], a[100:103], a[28:31], v[80:83]
ds_read_b128 a[60:63], v9 offset:38912
v_mfma_f32_16x16x32_bf16 v[80:83], a[96:99], a[12:15], v[80:83]
v_mfma_f32_16x16x32_bf16 v[84:87], a[104:107], a[12:15], v[84:87]
ds_read_b64_tr_b16 a[96:97], v12 offset:768
s_add_u32 m0, s18, 0x6000
v_mfma_f32_16x16x32_bf16 v[84:87], a[108:111], a[28:31], v[84:87]
buffer_load_dwordx4 v7, s[68:71], s26 offen lds
v_mfma_f32_16x16x32_bf16 v[76:79], a[108:111], a[24:27], v[76:79]
ds_read_b64_tr_b16 a[98:99], v12 offset:1792
v_lshl_add_u32 v5, s42, 19, v5
v_mfma_f32_16x16x32_bf16 v[76:79], a[104:107], a[8:11], v[76:79]
ds_read_b64_tr_b16 a[100:101], v12 offset:8960
v_lshl_add_u32 v6, s42, 19, v6
v_mfma_f32_16x16x32_bf16 v[68:71], a[104:107], a[4:7], v[68:71]
ds_read_b64_tr_b16 a[102:103], v12 offset:9984
v_lshl_add_u32 v7, s42, 18, v7
v_mfma_f32_16x16x32_bf16 v[68:71], a[108:111], a[20:23], v[68:71]
v_lshl_add_u32 v7, s42, 17, v7
v_mfma_f32_16x16x32_bf16 v[60:63], a[108:111], a[16:19], v[60:63]
v_mfma_f32_16x16x32_bf16 v[60:63], a[104:107], a[0:3], v[60:63]
s_add_u32 m0, s16, 0x8000
s_waitcnt lgkmcnt(4)
s_waitcnt lgkmcnt(6)
v_mfma_f32_16x16x32_bf16 v[88:91], a[80:83], a[0:3], v[88:91]
buffer_load_dwordx4 v22, s[44:47], s20 offen lds
v_mfma_f32_16x16x32_bf16 v[88:91], a[84:87], a[16:19], v[88:91]
ds_read_b64_tr_b16 a[104:105], v13 offset:768
v_mfma_f32_16x16x32_bf16 v[96:99], a[84:87], a[20:23], v[96:99]
ds_read_b64_tr_b16 a[106:107], v13 offset:1792
v_mfma_f32_16x16x32_bf16 v[96:99], a[80:83], a[4:7], v[96:99]
ds_read_b64_tr_b16 a[108:109], v13 offset:8960
v_mfma_f32_16x16x32_bf16 v[104:107], a[80:83], a[8:11], v[104:107]
ds_read_b64_tr_b16 a[110:111], v13 offset:9984
s_add_u32 m0, s16, 0x8400
v_mfma_f32_16x16x32_bf16 v[104:107], a[84:87], a[24:27], v[104:107]
buffer_load_dwordx4 v23, s[44:47], s20 offen lds
v_mfma_f32_16x16x32_bf16 v[112:115], a[84:87], a[28:31], v[112:115]
v_mfma_f32_16x16x32_bf16 v[112:115], a[80:83], a[12:15], v[112:115]
v_mfma_f32_16x16x32_bf16 v[116:119], a[88:91], a[12:15], v[116:119]
ds_read_b64_tr_b16 a[80:81], v14 offset:0
v_mfma_f32_16x16x32_bf16 v[116:119], a[92:95], a[28:31], v[116:119]
ds_read_b64_tr_b16 a[82:83], v14 offset:256
v_mfma_f32_16x16x32_bf16 v[108:111], a[92:95], a[24:27], v[108:111]
ds_read_b64_tr_b16 a[84:85], v14 offset:2048
s_add_u32 m0, s16, 0x8800
v_mfma_f32_16x16x32_bf16 v[108:111], a[88:91], a[8:11], v[108:111]
buffer_load_dwordx4 v22, s[44:47], s21 offen lds
v_mfma_f32_16x16x32_bf16 v[100:103], a[88:91], a[4:7], v[100:103]
ds_read_b64_tr_b16 a[86:87], v14 offset:2304
v_mfma_f32_16x16x32_bf16 v[100:103], a[92:95], a[20:23], v[100:103]
v_mfma_f32_16x16x32_bf16 v[92:95], a[92:95], a[16:19], v[92:95]
v_mfma_f32_16x16x32_bf16 v[92:95], a[88:91], a[0:3], v[92:95]
s_add_u32 s8, s28, 0x5400
s_waitcnt lgkmcnt(4)
v_mfma_f32_16x16x32_bf16 v[120:123], a[96:99], a[0:3], v[120:123]
buffer_store_dwordx4 a[112:115], v16, s[88:91], s8 offen sc1
v_mfma_f32_16x16x32_bf16 v[120:123], a[100:103], a[16:19], v[120:123]
ds_read_b64_tr_b16 a[88:89], v15 offset:0
v_mfma_f32_16x16x32_bf16 v[128:131], a[100:103], a[20:23], v[128:131]
ds_read_b64_tr_b16 a[90:91], v15 offset:256
v_mfma_f32_16x16x32_bf16 v[128:131], a[96:99], a[4:7], v[128:131]
ds_read_b64_tr_b16 a[92:93], v15 offset:2048
v_mfma_f32_16x16x32_bf16 v[136:139], a[96:99], a[8:11], v[136:139]
ds_read_b64_tr_b16 a[94:95], v15 offset:2304
v_mfma_f32_16x16x32_bf16 v[136:139], a[100:103], a[24:27], v[136:139]
s_add_u32 m0, s16, 0x8c00
v_mfma_f32_16x16x32_bf16 v[144:147], a[100:103], a[28:31], v[144:147]
buffer_load_dwordx4 v23, s[44:47], s21 offen lds
v_mfma_f32_16x16x32_bf16 v[144:147], a[96:99], a[12:15], v[144:147]
v_mfma_f32_16x16x32_bf16 v[148:151], a[104:107], a[12:15], v[148:151]
ds_read_b64_tr_b16 a[96:97], v14 offset:4096
v_mfma_f32_16x16x32_bf16 v[148:151], a[108:111], a[28:31], v[148:151]
ds_read_b64_tr_b16 a[98:99], v14 offset:4352
v_mfma_f32_16x16x32_bf16 v[140:143], a[108:111], a[24:27], v[140:143]
ds_read_b64_tr_b16 a[100:101], v14 offset:6144
v_mfma_f32_16x16x32_bf16 v[140:143], a[104:107], a[8:11], v[140:143]
ds_read_b64_tr_b16 a[102:103], v14 offset:6400
s_add_u32 m0, s16, 0x9000
v_mfma_f32_16x16x32_bf16 v[132:135], a[104:107], a[4:7], v[132:135]
buffer_load_dwordx4 v22, s[44:47], s22 offen lds
v_mfma_f32_16x16x32_bf16 v[132:135], a[108:111], a[20:23], v[132:135]
v_mfma_f32_16x16x32_bf16 v[124:127], a[108:111], a[16:19], v[124:127]
v_mfma_f32_16x16x32_bf16 v[124:127], a[104:107], a[0:3], v[124:127]
s_waitcnt lgkmcnt(4)
v_mfma_f32_16x16x32_bf16 v[152:155], a[80:83], a[0:3], v[152:155]
ds_read_b64_tr_b16 a[104:105], v15 offset:4096
s_add_u32 m0, s16, 0x9400
v_mfma_f32_16x16x32_bf16 v[152:155], a[84:87], a[16:19], v[152:155]
buffer_load_dwordx4 v23, s[44:47], s22 offen lds
v_mfma_f32_16x16x32_bf16 v[160:163], a[84:87], a[20:23], v[160:163]
ds_read_b64_tr_b16 a[106:107], v15 offset:4352
v_mfma_f32_16x16x32_bf16 v[160:163], a[80:83], a[4:7], v[160:163]
ds_read_b64_tr_b16 a[108:109], v15 offset:6144
v_mfma_f32_16x16x32_bf16 v[168:171], a[80:83], a[8:11], v[168:171]
ds_read_b64_tr_b16 a[110:111], v15 offset:6400
v_mfma_f32_16x16x32_bf16 v[168:171], a[84:87], a[24:27], v[168:171]
v_mfma_f32_16x16x32_bf16 v[176:179], a[84:87], a[28:31], v[176:179]
s_add_u32 m0, s16, 0x9800
v_mfma_f32_16x16x32_bf16 v[176:179], a[80:83], a[12:15], v[176:179]
buffer_load_dwordx4 v22, s[44:47], s23 offen lds
v_mfma_f32_16x16x32_bf16 v[180:183], a[88:91], a[12:15], v[180:183]
ds_read_b64_tr_b16 a[80:81], v14 offset:8192
v_mfma_f32_16x16x32_bf16 v[180:183], a[92:95], a[28:31], v[180:183]
ds_read_b64_tr_b16 a[82:83], v14 offset:8448
v_mfma_f32_16x16x32_bf16 v[172:175], a[92:95], a[24:27], v[172:175]
ds_read_b64_tr_b16 a[84:85], v14 offset:10240
v_mfma_f32_16x16x32_bf16 v[172:175], a[88:91], a[8:11], v[172:175]
ds_read_b64_tr_b16 a[86:87], v14 offset:10496
s_add_u32 m0, s16, 0x9c00
v_mfma_f32_16x16x32_bf16 v[164:167], a[88:91], a[4:7], v[164:167]
buffer_load_dwordx4 v23, s[44:47], s23 offen lds
v_mfma_f32_16x16x32_bf16 v[164:167], a[92:95], a[20:23], v[164:167]
v_lshl_add_u32 v22, s42, 7, v22
v_lshl_add_u32 v23, s42, 7, v23
v_mfma_f32_16x16x32_bf16 v[156:159], a[92:95], a[16:19], v[156:159]
v_mfma_f32_16x16x32_bf16 v[156:159], a[88:91], a[0:3], v[156:159]
s_waitcnt lgkmcnt(4)
v_mfma_f32_16x16x32_bf16 v[184:187], a[96:99], a[0:3], v[184:187]
ds_read_b64_tr_b16 a[88:89], v15 offset:8192
v_mfma_f32_16x16x32_bf16 v[184:187], a[100:103], a[16:19], v[184:187]
ds_read_b64_tr_b16 a[90:91], v15 offset:8448
s_add_u32 s8, s28, 0x9400
v_mfma_f32_16x16x32_bf16 v[192:195], a[100:103], a[20:23], v[192:195]
buffer_store_dwordx4 a[116:119], v16, s[88:91], s8 offen sc1
v_mfma_f32_16x16x32_bf16 v[192:195], a[96:99], a[4:7], v[192:195]
ds_read_b64_tr_b16 a[92:93], v15 offset:10240
v_mfma_f32_16x16x32_bf16 v[200:203], a[96:99], a[8:11], v[200:203]
ds_read_b64_tr_b16 a[94:95], v15 offset:10496
v_add_u32 v12, 0x8000, v12
v_mfma_f32_16x16x32_bf16 v[200:203], a[100:103], a[24:27], v[200:203]
v_add_u32 v13, 0x8000, v13
v_add_u32 v14, 0x8000, v14
v_mfma_f32_16x16x32_bf16 v[208:211], a[100:103], a[28:31], v[208:211]
v_add_u32 v15, 0x8000, v15
v_mfma_f32_16x16x32_bf16 v[208:211], a[96:99], a[12:15], v[208:211]
v_mfma_f32_16x16x32_bf16 v[212:215], a[104:107], a[12:15], v[212:215]
s_waitcnt vmcnt(28) lgkmcnt(0)
v_mfma_f32_16x16x32_bf16 v[212:215], a[108:111], a[28:31], v[212:215]
s_barrier
s_add_u32 m0, s17, 0x8000
v_mfma_f32_16x16x32_bf16 v[204:207], a[108:111], a[24:27], v[204:207]
buffer_load_dwordx4 v5, s[52:55], 0 offen lds
v_mfma_f32_16x16x32_bf16 v[204:207], a[104:107], a[8:11], v[204:207]
ds_read_b64_tr_b16 a[96:97], v12 offset:0
v_mfma_f32_16x16x32_bf16 v[196:199], a[104:107], a[4:7], v[196:199]
ds_read_b64_tr_b16 a[98:99], v12 offset:1024
v_mfma_f32_16x16x32_bf16 v[196:199], a[108:111], a[20:23], v[196:199]
ds_read_b64_tr_b16 a[100:101], v12 offset:8192
v_mfma_f32_16x16x32_bf16 v[188:191], a[108:111], a[16:19], v[188:191]
ds_read_b64_tr_b16 a[102:103], v12 offset:9216
v_mfma_f32_16x16x32_bf16 v[188:191], a[104:107], a[0:3], v[188:191]
s_add_u32 m0, s17, 0x8400
s_waitcnt lgkmcnt(4)
v_mfma_f32_16x16x32_bf16 v[216:219], a[0:3], a[80:83], v[216:219]
buffer_load_dwordx4 v5, s[52:55], s13 offen lds
v_mfma_f32_16x16x32_bf16 v[216:219], a[16:19], a[84:87], v[216:219]
ds_read_b64_tr_b16 a[104:105], v13 offset:0
v_mfma_f32_16x16x32_bf16 v[224:227], a[20:23], a[84:87], v[224:227]
ds_read_b64_tr_b16 a[106:107], v13 offset:1024
v_mfma_f32_16x16x32_bf16 v[224:227], a[4:7], a[80:83], v[224:227]
ds_read_b64_tr_b16 a[108:109], v13 offset:8192
v_mfma_f32_16x16x32_bf16 v[232:235], a[8:11], a[80:83], v[232:235]
ds_read_b64_tr_b16 a[110:111], v13 offset:9216
v_mfma_f32_16x16x32_bf16 v[232:235], a[24:27], a[84:87], v[232:235]
s_add_u32 m0, s17, 0x8800
v_mfma_f32_16x16x32_bf16 v[240:243], a[28:31], a[84:87], v[240:243]
buffer_load_dwordx4 v6, s[52:55], 0 offen lds
v_mfma_f32_16x16x32_bf16 v[240:243], a[12:15], a[80:83], v[240:243]
v_mfma_f32_16x16x32_bf16 v[244:247], a[12:15], a[88:91], v[244:247]
ds_read_b64_tr_b16 a[80:81], v12 offset:256
v_mfma_f32_16x16x32_bf16 v[244:247], a[28:31], a[92:95], v[244:247]
ds_read_b64_tr_b16 a[82:83], v12 offset:1280
v_mfma_f32_16x16x32_bf16 v[236:239], a[24:27], a[92:95], v[236:239]
ds_read_b64_tr_b16 a[84:85], v12 offset:8448
v_mfma_f32_16x16x32_bf16 v[236:239], a[8:11], a[88:91], v[236:239]
ds_read_b64_tr_b16 a[86:87], v12 offset:9472
s_add_u32 s8, s28, 0x5800
v_mfma_f32_16x16x32_bf16 v[228:231], a[4:7], a[88:91], v[228:231]
buffer_store_dwordx4 a[124:127], v16, s[88:91], s8 offen sc1
v_mfma_f32_16x16x32_bf16 v[228:231], a[20:23], a[92:95], v[228:231]
v_mfma_f32_16x16x32_bf16 v[220:223], a[16:19], a[92:95], v[220:223]
v_mfma_f32_16x16x32_bf16 v[220:223], a[0:3], a[88:91], v[220:223]
s_waitcnt lgkmcnt(4)
L_S17:
v_mfma_f32_16x16x32_bf16 v[24:27], a[96:99], a[32:35], v[24:27]
ds_read_b64_tr_b16 a[88:89], v13 offset:256
s_waitcnt vmcnt(23)
v_mfma_f32_16x16x32_bf16 v[24:27], a[100:103], a[48:51], v[24:27]
ds_read_b64_tr_b16 a[90:91], v13 offset:1280
s_add_u32 m0, s17, 0x8c00
v_mfma_f32_16x16x32_bf16 v[32:35], a[100:103], a[52:55], v[32:35]
buffer_load_dwordx4 v6, s[52:55], s13 offen lds
v_mfma_f32_16x16x32_bf16 v[32:35], a[96:99], a[36:39], v[32:35]
ds_read_b64_tr_b16 a[92:93], v13 offset:8448
v_mfma_f32_16x16x32_bf16 v[40:43], a[96:99], a[40:43], v[40:43]
ds_read_b64_tr_b16 a[94:95], v13 offset:9472
v_mfma_f32_16x16x32_bf16 v[40:43], a[100:103], a[56:59], v[40:43]
ds_read_b128 a[0:3], v8 offset:0
v_mfma_f32_16x16x32_bf16 v[48:51], a[100:103], a[60:63], v[48:51]
ds_read_b128 a[16:19], v9 offset:0
v_mfma_f32_16x16x32_bf16 v[48:51], a[96:99], a[44:47], v[48:51]
ds_read_b128 a[4:7], v8 offset:2048
s_add_u32 m0, s18, 0xc000
v_mfma_f32_16x16x32_bf16 v[52:55], a[104:107], a[44:47], v[52:55]
buffer_load_dwordx4 v7, s[68:71], 0 offen lds
v_mfma_f32_16x16x32_bf16 v[52:55], a[108:111], a[60:63], v[52:55]
ds_read_b64_tr_b16 a[96:97], v12 offset:512
v_mfma_f32_16x16x32_bf16 v[44:47], a[108:111], a[56:59], v[44:47]
ds_read_b64_tr_b16 a[98:99], v12 offset:1536
v_mfma_f32_16x16x32_bf16 v[44:47], a[104:107], a[40:43], v[44:47]
ds_read_b64_tr_b16 a[100:101], v12 offset:8704
v_mfma_f32_16x16x32_bf16 v[36:39], a[104:107], a[36:39], v[36:39]
ds_read_b64_tr_b16 a[102:103], v12 offset:9728
v_mfma_f32_16x16x32_bf16 v[36:39], a[108:111], a[52:55], v[36:39]
ds_read_b128 a[20:23], v9 offset:2048
s_add_u32 m0, s18, 0xd000
v_mfma_f32_16x16x32_bf16 v[28:31], a[108:111], a[48:51], v[28:31]
buffer_load_dwordx4 v7, s[68:71], s25 offen lds
v_mfma_f32_16x16x32_bf16 v[28:31], a[104:107], a[32:35], v[28:31]
ds_read_b128 a[8:11], v8 offset:4096
s_waitcnt lgkmcnt(9)
v_mfma_f32_16x16x32_bf16 v[56:59], a[80:83], a[32:35], v[56:59]
ds_read_b64_tr_b16 a[104:105], v13 offset:512
v_mfma_f32_16x16x32_bf16 v[56:59], a[84:87], a[48:51], v[56:59]
ds_read_b64_tr_b16 a[106:107], v13 offset:1536
v_mfma_f32_16x16x32_bf16 v[64:67], a[84:87], a[52:55], v[64:67]
ds_read_b64_tr_b16 a[108:109], v13 offset:8704
v_mfma_f32_16x16x32_bf16 v[64:67], a[80:83], a[36:39], v[64:67]
ds_read_b64_tr_b16 a[110:111], v13 offset:9728
s_add_u32 m0, s18, 0xe000
v_mfma_f32_16x16x32_bf16 v[72:75], a[80:83], a[40:43], v[72:75]
buffer_load_dwordx4 v7, s[68:71], s26 offen lds
v_mfma_f32_16x16x32_bf16 v[72:75], a[84:87], a[56:59], v[72:75]
ds_read_b128 a[24:27], v9 offset:4096
v_lshl_add_u32 v5, s42, 19, v5
v_mfma_f32_16x16x32_bf16 v[80:83], a[84:87], a[60:63], v[80:83]
ds_read_b128 a[12:15], v8 offset:6144
v_lshl_add_u32 v6, s42, 19, v6
v_mfma_f32_16x16x32_bf16 v[80:83], a[80:83], a[44:47], v[80:83]
ds_read_b128 a[28:31], v9 offset:6144
v_lshl_add_u32 v7, s42, 18, v7
v_mfma_f32_16x16x32_bf16 v[84:87], a[88:91], a[44:47], v[84:87]
ds_read_b64_tr_b16 a[80:81], v12 offset:768
v_lshl_add_u32 v7, s42, 17, v7
v_mfma_f32_16x16x32_bf16 v[84:87], a[92:95], a[60:63], v[84:87]
ds_read_b64_tr_b16 a[82:83], v12 offset:1792
s_add_u32 s8, s28, 0x9800
v_mfma_f32_16x16x32_bf16 v[76:79], a[92:95], a[56:59], v[76:79]
buffer_store_dwordx4 a[232:235], v16, s[88:91], s8 offen sc1
v_mfma_f32_16x16x32_bf16 v[76:79], a[88:91], a[40:43], v[76:79]
ds_read_b64_tr_b16 a[84:85], v12 offset:8960
v_mfma_f32_16x16x32_bf16 v[68:71], a[88:91], a[36:39], v[68:71]
ds_read_b64_tr_b16 a[86:87], v12 offset:9984
v_mfma_f32_16x16x32_bf16 v[68:71], a[92:95], a[52:55], v[68:71]
v_mfma_f32_16x16x32_bf16 v[60:63], a[92:95], a[48:51], v[60:63]
v_mfma_f32_16x16x32_bf16 v[60:63], a[88:91], a[32:35], v[60:63]
s_add_u32 m0, s16, 0x0
s_waitcnt lgkmcnt(4)
s_waitcnt lgkmcnt(7)
v_mfma_f32_16x16x32_bf16 v[88:91], a[96:99], a[32:35], v[88:91]
buffer_load_dwordx4 v22, s[44:47], s20 offen lds
v_mfma_f32_16x16x32_bf16 v[88:91], a[100:103], a[48:51], v[88:91]
ds_read_b64_tr_b16 a[88:89], v13 offset:768
v_mfma_f32_16x16x32_bf16 v[96:99], a[100:103], a[52:55], v[96:99]
ds_read_b64_tr_b16 a[90:91], v13 offset:1792
v_mfma_f32_16x16x32_bf16 v[96:99], a[96:99], a[36:39], v[96:99]
ds_read_b64_tr_b16 a[92:93], v13 offset:8960
v_mfma_f32_16x16x32_bf16 v[104:107], a[96:99], a[40:43], v[104:107]
ds_read_b64_tr_b16 a[94:95], v13 offset:9984
s_add_u32 m0, s16, 0x400
v_mfma_f32_16x16x32_bf16 v[104:107], a[100:103], a[56:59], v[104:107]
buffer_load_dwordx4 v23, s[44:47], s20 offen lds
v_mfma_f32_16x16x32_bf16 v[112:115], a[100:103], a[60:63], v[112:115]
v_mfma_f32_16x16x32_bf16 v[112:115], a[96:99], a[44:47], v[112:115]
v_mfma_f32_16x16x32_bf16 v[116:119], a[104:107], a[44:47], v[116:119]
ds_read_b64_tr_b16 a[96:97], v14 offset:0
v_mfma_f32_16x16x32_bf16 v[116:119], a[108:111], a[60:63], v[116:119]
ds_read_b64_tr_b16 a[98:99], v14 offset:256
v_mfma_f32_16x16x32_bf16 v[108:111], a[108:111], a[56:59], v[108:111]
ds_read_b64_tr_b16 a[100:101], v14 offset:2048
s_add_u32 m0, s16, 0x800
v_mfma_f32_16x16x32_bf16 v[108:111], a[104:107], a[40:43], v[108:111]
buffer_load_dwordx4 v22, s[44:47], s21 offen lds
v_mfma_f32_16x16x32_bf16 v[100:103], a[104:107], a[36:39], v[100:103]
ds_read_b64_tr_b16 a[102:103], v14 offset:2304
v_mfma_f32_16x16x32_bf16 v[100:103], a[108:111], a[52:55], v[100:103]
v_mfma_f32_16x16x32_bf16 v[92:95], a[108:111], a[48:51], v[92:95]
v_mfma_f32_16x16x32_bf16 v[92:95], a[104:107], a[32:35], v[92:95]
s_add_u32 m0, s16, 0xc00
s_waitcnt lgkmcnt(4)
v_mfma_f32_16x16x32_bf16 v[120:123], a[80:83], a[32:35], v[120:123]
buffer_load_dwordx4 v23, s[44:47], s21 offen lds
v_mfma_f32_16x16x32_bf16 v[120:123], a[84:87], a[48:51], v[120:123]
ds_read_b64_tr_b16 a[104:105], v15 offset:0
v_mfma_f32_16x16x32_bf16 v[128:131], a[84:87], a[52:55], v[128:131]
ds_read_b64_tr_b16 a[106:107], v15 offset:256
v_mfma_f32_16x16x32_bf16 v[128:131], a[80:83], a[36:39], v[128:131]
ds_read_b64_tr_b16 a[108:109], v15 offset:2048
v_mfma_f32_16x16x32_bf16 v[136:139], a[80:83], a[40:43], v[136:139]
ds_read_b64_tr_b16 a[110:111], v15 offset:2304
v_mfma_f32_16x16x32_bf16 v[136:139], a[84:87], a[56:59], v[136:139]
s_add_u32 s8, s28, 0x5c00
v_mfma_f32_16x16x32_bf16 v[144:147], a[84:87], a[60:63], v[144:147]
buffer_store_dwordx4 a[240:243], v16, s[88:91], s8 offen sc1
v_mfma_f32_16x16x32_bf16 v[144:147], a[80:83], a[44:47], v[144:147]
v_mfma_f32_16x16x32_bf16 v[148:151], a[88:91], a[44:47], v[148:151]
ds_read_b64_tr_b16 a[80:81], v14 offset:4096
v_mfma_f32_16x16x32_bf16 v[148:151], a[92:95], a[60:63], v[148:151]
ds_read_b64_tr_b16 a[82:83], v14 offset:4352
v_mfma_f32_16x16x32_bf16 v[140:143], a[92:95], a[56:59], v[140:143]
ds_read_b64_tr_b16 a[84:85], v14 offset:6144
v_mfma_f32_16x16x32_bf16 v[140:143], a[88:91], a[40:43], v[140:143]
ds_read_b64_tr_b16 a[86:87], v14 offset:6400
s_add_u32 m0, s16, 0x1000
v_mfma_f32_16x16x32_bf16 v[132:135], a[88:91], a[36:39], v[132:135]
buffer_load_dwordx4 v22, s[44:47], s22 offen lds
v_mfma_f32_16x16x32_bf16 v[132:135], a[92:95], a[52:55], v[132:135]
v_mfma_f32_16x16x32_bf16 v[124:127], a[92:95], a[48:51], v[124:127]
v_mfma_f32_16x16x32_bf16 v[124:127], a[88:91], a[32:35], v[124:127]
s_waitcnt lgkmcnt(4)
v_mfma_f32_16x16x32_bf16 v[152:155], a[96:99], a[32:35], v[152:155]
ds_read_b64_tr_b16 a[88:89], v15 offset:4096
s_add_u32 m0, s16, 0x1400
v_mfma_f32_16x16x32_bf16 v[152:155], a[100:103], a[48:51], v[152:155]
buffer_load_dwordx4 v23, s[44:47], s22 offen lds
v_mfma_f32_16x16x32_bf16 v[160:163], a[100:103], a[52:55], v[160:163]
ds_read_b64_tr_b16 a[90:91], v15 offset:4352
v_mfma_f32_16x16x32_bf16 v[160:163], a[96:99], a[36:39], v[160:163]
ds_read_b64_tr_b16 a[92:93], v15 offset:6144
v_mfma_f32_16x16x32_bf16 v[168:171], a[96:99], a[40:43], v[168:171]
ds_read_b64_tr_b16 a[94:95], v15 offset:6400
v_mfma_f32_16x16x32_bf16 v[168:171], a[100:103], a[56:59], v[168:171]
v_mfma_f32_16x16x32_bf16 v[176:179], a[100:103], a[60:63], v[176:179]
s_add_u32 m0, s16, 0x1800
v_mfma_f32_16x16x32_bf16 v[176:179], a[96:99], a[44:47], v[176:179]
buffer_load_dwordx4 v22, s[44:47], s23 offen lds
v_mfma_f32_16x16x32_bf16 v[180:183], a[104:107], a[44:47], v[180:183]
ds_read_b64_tr_b16 a[96:97], v14 offset:8192
v_mfma_f32_16x16x32_bf16 v[180:183], a[108:111], a[60:63], v[180:183]
ds_read_b64_tr_b16 a[98:99], v14 offset:8448
v_mfma_f32_16x16x32_bf16 v[172:175], a[108:111], a[56:59], v[172:175]
ds_read_b64_tr_b16 a[100:101], v14 offset:10240
v_mfma_f32_16x16x32_bf16 v[172:175], a[104:107], a[40:43], v[172:175]
ds_read_b64_tr_b16 a[102:103], v14 offset:10496
s_add_u32 m0, s16, 0x1c00
v_mfma_f32_16x16x32_bf16 v[164:167], a[104:107], a[36:39], v[164:167]
buffer_load_dwordx4 v23, s[44:47], s23 offen lds
v_mfma_f32_16x16x32_bf16 v[164:167], a[108:111], a[52:55], v[164:167]
v_lshl_add_u32 v22, s42, 7, v22
v_lshl_add_u32 v23, s42, 7, v23
v_mfma_f32_16x16x32_bf16 v[156:159], a[108:111], a[48:51], v[156:159]
v_mfma_f32_16x16x32_bf16 v[156:159], a[104:107], a[32:35], v[156:159]
s_waitcnt lgkmcnt(4)
v_mfma_f32_16x16x32_bf16 v[184:187], a[80:83], a[32:35], v[184:187]
ds_read_b64_tr_b16 a[104:105], v15 offset:8192
v_mfma_f32_16x16x32_bf16 v[184:187], a[84:87], a[48:51], v[184:187]
ds_read_b64_tr_b16 a[106:107], v15 offset:8448
s_add_u32 s8, s28, 0x9c00
v_mfma_f32_16x16x32_bf16 v[192:195], a[84:87], a[52:55], v[192:195]
buffer_store_dwordx4 a[248:251], v16, s[88:91], s8 offen sc1
v_mfma_f32_16x16x32_bf16 v[192:195], a[80:83], a[36:39], v[192:195]
ds_read_b64_tr_b16 a[108:109], v15 offset:10240
v_mfma_f32_16x16x32_bf16 v[200:203], a[80:83], a[40:43], v[200:203]
ds_read_b64_tr_b16 a[110:111], v15 offset:10496
v_add_u32 v12, 0xffff0000, v12
v_mfma_f32_16x16x32_bf16 v[200:203], a[84:87], a[56:59], v[200:203]
v_add_u32 v13, 0xffff0000, v13
v_add_u32 v14, 0xffff0000, v14
v_mfma_f32_16x16x32_bf16 v[208:211], a[84:87], a[60:63], v[208:211]
v_add_u32 v15, 0xffff0000, v15
v_mfma_f32_16x16x32_bf16 v[208:211], a[80:83], a[44:47], v[208:211]
v_mfma_f32_16x16x32_bf16 v[212:215], a[88:91], a[44:47], v[212:215]
s_waitcnt vmcnt(29) lgkmcnt(0)
v_mfma_f32_16x16x32_bf16 v[212:215], a[92:95], a[60:63], v[212:215]
s_barrier
s_add_u32 m0, s17, 0x10000
v_mfma_f32_16x16x32_bf16 v[204:207], a[92:95], a[56:59], v[204:207]
buffer_load_dwordx4 v5, s[52:55], 0 offen lds
v_mfma_f32_16x16x32_bf16 v[204:207], a[88:91], a[40:43], v[204:207]
ds_read_b64_tr_b16 a[80:81], v12 offset:0
v_mfma_f32_16x16x32_bf16 v[196:199], a[88:91], a[36:39], v[196:199]
ds_read_b64_tr_b16 a[82:83], v12 offset:1024
v_mfma_f32_16x16x32_bf16 v[196:199], a[92:95], a[52:55], v[196:199]
ds_read_b64_tr_b16 a[84:85], v12 offset:8192
v_mfma_f32_16x16x32_bf16 v[188:191], a[92:95], a[48:51], v[188:191]
ds_read_b64_tr_b16 a[86:87], v12 offset:9216
v_mfma_f32_16x16x32_bf16 v[188:191], a[88:91], a[32:35], v[188:191]
s_add_u32 m0, s17, 0x10400
s_waitcnt lgkmcnt(4)
v_mfma_f32_16x16x32_bf16 v[216:219], a[32:35], a[96:99], v[216:219]
buffer_load_dwordx4 v5, s[52:55], s13 offen lds
v_mfma_f32_16x16x32_bf16 v[216:219], a[48:51], a[100:103], v[216:219]
ds_read_b64_tr_b16 a[88:89], v13 offset:0
v_mfma_f32_16x16x32_bf16 v[224:227], a[52:55], a[100:103], v[224:227]
ds_read_b64_tr_b16 a[90:91], v13 offset:1024
v_mfma_f32_16x16x32_bf16 v[224:227], a[36:39], a[96:99], v[224:227]
ds_read_b64_tr_b16 a[92:93], v13 offset:8192
v_mfma_f32_16x16x32_bf16 v[232:235], a[40:43], a[96:99], v[232:235]
ds_read_b64_tr_b16 a[94:95], v13 offset:9216
v_mfma_f32_16x16x32_bf16 v[232:235], a[56:59], a[100:103], v[232:235]
s_add_u32 m0, s17, 0x10800
v_mfma_f32_16x16x32_bf16 v[240:243], a[60:63], a[100:103], v[240:243]
buffer_load_dwordx4 v6, s[52:55], 0 offen lds
v_mfma_f32_16x16x32_bf16 v[240:243], a[44:47], a[96:99], v[240:243]
v_mfma_f32_16x16x32_bf16 v[244:247], a[44:47], a[104:107], v[244:247]
ds_read_b64_tr_b16 a[96:97], v12 offset:256
v_mfma_f32_16x16x32_bf16 v[244:247], a[60:63], a[108:111], v[244:247]
ds_read_b64_tr_b16 a[98:99], v12 offset:1280
v_mfma_f32_16x16x32_bf16 v[236:239], a[56:59], a[108:111], v[236:239]
ds_read_b64_tr_b16 a[100:101], v12 offset:8448
v_mfma_f32_16x16x32_bf16 v[236:239], a[40:43], a[104:107], v[236:239]
ds_read_b64_tr_b16 a[102:103], v12 offset:9472
v_mfma_f32_16x16x32_bf16 v[228:231], a[36:39], a[104:107], v[228:231]
buffer_load_dwordx4 a[128:131], v16, s[44:47], s100 offen offset:0
v_mfma_f32_16x16x32_bf16 v[228:231], a[52:55], a[108:111], v[228:231]
v_mfma_f32_16x16x32_bf16 v[220:223], a[48:51], a[108:111], v[220:223]
L_padA9:
s_cmp_eq_u32 s95, 1
s_cbranch_scc1 L_hopA_ret
v_mfma_f32_16x16x32_bf16 v[220:223], a[32:35], a[104:107], v[220:223]
s_waitcnt lgkmcnt(4)
L_S18:
v_mfma_f32_16x16x32_bf16 v[24:27], a[80:83], a[0:3], v[24:27]
ds_read_b64_tr_b16 a[104:105], v13 offset:256
s_waitcnt vmcnt(24)
v_mfma_f32_16x16x32_bf16 v[24:27], a[84:87], a[16:19], v[24:27]
ds_read_b64_tr_b16 a[106:107], v13 offset:1280
s_add_u32 m0, s17, 0x10c00
v_mfma_f32_16x16x32_bf16 v[32:35], a[84:87], a[20:23], v[32:35]
buffer_load_dwordx4 v6, s[52:55], s13 offen lds
v_mfma_f32_16x16x32_bf16 v[32:35], a[80:83], a[4:7], v[32:35]
ds_read_b64_tr_b16 a[108:109], v13 offset:8448
v_mfma_f32_16x16x32_bf16 v[40:43], a[80:83], a[8:11], v[40:43]
ds_read_b64_tr_b16 a[110:111], v13 offset:9472
v_mfma_f32_16x16x32_bf16 v[40:43], a[84:87], a[24:27], v[40:43]
ds_read_b128 a[32:35], v8 offset:32768
v_mfma_f32_16x16x32_bf16 v[48:51], a[84:87], a[28:31], v[48:51]
ds_read_b128 a[48:51], v9 offset:32768
v_mfma_f32_16x16x32_bf16 v[48:51], a[80:83], a[12:15], v[48:51]
ds_read_b128 a[36:39], v8 offset:34816
s_add_u32 m0, s18, 0x14000
v_mfma_f32_16x16x32_bf16 v[52:55], a[88:91], a[12:15], v[52:55]
buffer_load_dwordx4 v7, s[68:71], 0 offen lds
v_mfma_f32_16x16x32_bf16 v[52:55], a[92:95], a[28:31], v[52:55]
ds_read_b64_tr_b16 a[80:81], v12 offset:512
v_mfma_f32_16x16x32_bf16 v[44:47], a[92:95], a[24:27], v[44:47]
ds_read_b64_tr_b16 a[82:83], v12 offset:1536
v_mfma_f32_16x16x32_bf16 v[44:47], a[88:91], a[8:11], v[44:47]
ds_read_b64_tr_b16 a[84:85], v12 offset:8704
v_mfma_f32_16x16x32_bf16 v[36:39], a[88:91], a[4:7], v[36:39]
ds_read_b64_tr_b16 a[86:87], v12 offset:9728
v_mfma_f32_16x16x32_bf16 v[36:39], a[92:95], a[20:23], v[36:39]
ds_read_b128 a[52:55], v9 offset:34816
s_add_u32 m0, s18, 0x15000
v_mfma_f32_16x16x32_bf16 v[28:31], a[92:95], a[16:19], v[28:31]
buffer_load_dwordx4 v7, s[68:71], s25 offen lds
v_mfma_f32_16x16x32_bf16 v[28:31], a[88:91], a[0:3], v[28:31]
ds_read_b128 a[40:43], v8 offset:36864
s_waitcnt lgkmcnt(9)
v_mfma_f32_16x16x32_bf16 v[56:59], a[96:99], a[0:3], v[56:59]
ds_read_b64_tr_b16 a[88:89], v13 offset:512
v_mfma_f32_16x16x32_bf16 v[56:59], a[100:103], a[16:19], v[56:59]
ds_read_b64_tr_b16 a[90:91], v13 offset:1536
v_mfma_f32_16x16x32_bf16 v[64:67], a[100:103], a[20:23], v[64:67]
ds_read_b64_tr_b16 a[92:93], v13 offset:8704
v_mfma_f32_16x16x32_bf16 v[64:67], a[96:99], a[4:7], v[64:67]
ds_read_b64_tr_b16 a[94:95], v13 offset:9728
s_add_u32 m0, s18, 0x16000
v_mfma_f32_16x16x32_bf16 v[72:75], a[96:99], a[8:11], v[72:75]
buffer_load_dwordx4 v7, s[68:71], s26 offen lds
v_mfma_f32_16x16x32_bf16 v[72:75], a[100:103], a[24:27], v[72:75]
ds_read_b128 a[56:59], v9 offset:36864
v_lshl_add_u32 v5, s42, 19, v5
v_mfma_f32_16x16x32_bf16 v[80:83], a[100:103], a[28:31], v[80:83]
ds_read_b128 a[44:47], v8 offset:38912
v_lshl_add_u32 v6, s42, 19, v6
v_mfma_f32_16x16x32_bf16 v[80:83], a[96:99], a[12:15], v[80:83]
ds_read_b128 a[60:63], v9 offset:38912
v_lshl_add_u32 v7, s42, 18, v7
v_mfma_f32_16x16x32_bf16 v[84:87], a[104:107], a[12:15], v[84:87]
ds_read_b64_tr_b16 a[96:97], v12 offset:768
v_lshl_add_u32 v7, s42, 17, v7
v_mfma_f32_16x16x32_bf16 v[84:87], a[108:111], a[28:31], v[84:87]
ds_read_b64_tr_b16 a[98:99], v12 offset:1792
v_mfma_f32_16x16x32_bf16 v[76:79], a[108:111], a[24:27], v[76:79]
buffer_load_dwordx4 a[132:135], v16, s[44:47], s100 offen offset:1024
v_mfma_f32_16x16x32_bf16 v[76:79], a[104:107], a[8:11], v[76:79]
ds_read_b64_tr_b16 a[100:101], v12 offset:8960
v_mfma_f32_16x16x32_bf16 v[68:71], a[104:107], a[4:7], v[68:71]
ds_read_b64_tr_b16 a[102:103], v12 offset:9984
v_mfma_f32_16x16x32_bf16 v[68:71], a[108:111], a[20:23], v[68:71]
v_mfma_f32_16x16x32_bf16 v[60:63], a[108:111], a[16:19], v[60:63]
v_mfma_f32_16x16x32_bf16 v[60:63], a[104:107], a[0:3], v[60:63]
s_add_u32 m0, s16, 0x8000
s_waitcnt lgkmcnt(4)
s_waitcnt lgkmcnt(7)
v_mfma_f32_16x16x32_bf16 v[88:91], a[80:83], a[0:3], v[88:91]
buffer_load_dwordx4 v22, s[44:47], s20 offen lds
v_mfma_f32_16x16x32_bf16 v[88:91], a[84:87], a[16:19], v[88:91]
ds_read_b64_tr_b16 a[104:105], v13 offset:768
v_mfma_f32_16x16x32_bf16 v[96:99], a[84:87], a[20:23], v[96:99]
ds_read_b64_tr_b16 a[106:107], v13 offset:1792
v_mfma_f32_16x16x32_bf16 v[96:99], a[80:83], a[4:7], v[96:99]
ds_read_b64_tr_b16 a[108:109], v13 offset:8960
v_mfma_f32_16x16x32_bf16 v[104:107], a[80:83], a[8:11], v[104:107]
ds_read_b64_tr_b16 a[110:111], v13 offset:9984
s_add_u32 m0, s16, 0x8400
v_mfma_f32_16x16x32_bf16 v[104:107], a[84:87], a[24:27], v[104:107]
buffer_load_dwordx4 v23, s[44:47], s20 offen lds
v_mfma_f32_16x16x32_bf16 v[112:115], a[84:87], a[28:31], v[112:115]
v_mfma_f32_16x16x32_bf16 v[112:115], a[80:83], a[12:15], v[112:115]
v_mfma_f32_16x16x32_bf16 v[116:119], a[88:91], a[12:15], v[116:119]
ds_read_b64_tr_b16 a[80:81], v14 offset:0
v_mfma_f32_16x16x32_bf16 v[116:119], a[92:95], a[28:31], v[116:119]
ds_read_b64_tr_b16 a[82:83], v14 offset:256
v_mfma_f32_16x16x32_bf16 v[108:111], a[92:95], a[24:27], v[108:111]
ds_read_b64_tr_b16 a[84:85], v14 offset:2048
s_add_u32 m0, s16, 0x8800
v_mfma_f32_16x16x32_bf16 v[108:111], a[88:91], a[8:11], v[108:111]
buffer_load_dwordx4 v22, s[44:47], s21 offen lds
v_mfma_f32_16x16x32_bf16 v[100:103], a[88:91], a[4:7], v[100:103]
ds_read_b64_tr_b16 a[86:87], v14 offset:2304
v_mfma_f32_16x16x32_bf16 v[100:103], a[92:95], a[20:23], v[100:103]
v_mfma_f32_16x16x32_bf16 v[92:95], a[92:95], a[16:19], v[92:95]
v_mfma_f32_16x16x32_bf16 v[92:95], a[88:91], a[0:3], v[92:95]
s_add_u32 m0, s16, 0x8c00
s_waitcnt lgkmcnt(4)
v_mfma_f32_16x16x32_bf16 v[120:123], a[96:99], a[0:3], v[120:123]
buffer_load_dwordx4 v23, s[44:47], s21 offen lds
v_mfma_f32_16x16x32_bf16 v[120:123], a[100:103], a[16:19], v[120:123]
ds_read_b64_tr_b16 a[88:89], v15 offset:0
v_mfma_f32_16x16x32_bf16 v[128:131], a[100:103], a[20:23], v[128:131]
ds_read_b64_tr_b16 a[90:91], v15 offset:256
v_mfma_f32_16x16x32_bf16 v[128:131], a[96:99], a[4:7], v[128:131]
ds_read_b64_tr_b16 a[92:93], v15 offset:2048
v_mfma_f32_16x16x32_bf16 v[136:139], a[96:99], a[8:11], v[136:139]
ds_read_b64_tr_b16 a[94:95], v15 offset:2304
v_mfma_f32_16x16x32_bf16 v[136:139], a[100:103], a[24:27], v[136:139]
v_mfma_f32_16x16x32_bf16 v[144:147], a[100:103], a[28:31], v[144:147]
buffer_load_dwordx4 a[136:139], v16, s[44:47], s100 offen offset:2048
v_mfma_f32_16x16x32_bf16 v[144:147], a[96:99], a[12:15], v[144:147]
v_mfma_f32_16x16x32_bf16 v[148:151], a[104:107], a[12:15], v[148:151]
ds_read_b64_tr_b16 a[96:97], v14 offset:4096
v_mfma_f32_16x16x32_bf16 v[148:151], a[108:111], a[28:31], v[148:151]
ds_read_b64_tr_b16 a[98:99], v14 offset:4352
v_mfma_f32_16x16x32_bf16 v[140:143], a[108:111], a[24:27], v[140:143]
ds_read_b64_tr_b16 a[100:101], v14 offset:6144
v_mfma_f32_16x16x32_bf16 v[140:143], a[104:107], a[8:11], v[140:143]
ds_read_b64_tr_b16 a[102:103], v14 offset:6400
s_add_u32 m0, s16, 0x9000
v_mfma_f32_16x16x32_bf16 v[132:135], a[104:107], a[4:7], v[132:135]
buffer_load_dwordx4 v22, s[44:47], s22 offen lds
v_mfma_f32_16x16x32_bf16 v[132:135], a[108:111], a[20:23], v[132:135]
v_mfma_f32_16x16x32_bf16 v[124:127], a[108:111], a[16:19], v[124:127]
v_mfma_f32_16x16x32_bf16 v[124:127], a[104:107], a[0:3], v[124:127]
s_waitcnt lgkmcnt(4)
v_mfma_f32_16x16x32_bf16 v[152:155], a[80:83], a[0:3], v[152:155]
ds_read_b64_tr_b16 a[104:105], v15 offset:4096
s_add_u32 m0, s16, 0x9400
v_mfma_f32_16x16x32_bf16 v[152:155], a[84:87], a[16:19], v[152:155]
buffer_load_dwordx4 v23, s[44:47], s22 offen lds
v_mfma_f32_16x16x32_bf16 v[160:163], a[84:87], a[20:23], v[160:163]
ds_read_b64_tr_b16 a[106:107], v15 offset:4352
v_mfma_f32_16x16x32_bf16 v[160:163], a[80:83], a[4:7], v[160:163]
ds_read_b64_tr_b16 a[108:109], v15 offset:6144
v_mfma_f32_16x16x32_bf16 v[168:171], a[80:83], a[8:11], v[168:171]
ds_read_b64_tr_b16 a[110:111], v15 offset:6400
v_mfma_f32_16x16x32_bf16 v[168:171], a[84:87], a[24:27], v[168:171]
v_mfma_f32_16x16x32_bf16 v[176:179], a[84:87], a[28:31], v[176:179]
s_add_u32 m0, s16, 0x9800
v_mfma_f32_16x16x32_bf16 v[176:179], a[80:83], a[12:15], v[176:179]
buffer_load_dwordx4 v22, s[44:47], s23 offen lds
v_mfma_f32_16x16x32_bf16 v[180:183], a[88:91], a[12:15], v[180:183]
ds_read_b64_tr_b16 a[80:81], v14 offset:8192
v_mfma_f32_16x16x32_bf16 v[180:183], a[92:95], a[28:31], v[180:183]
ds_read_b64_tr_b16 a[82:83], v14 offset:8448
v_mfma_f32_16x16x32_bf16 v[172:175], a[92:95], a[24:27], v[172:175]
ds_read_b64_tr_b16 a[84:85], v14 offset:10240
v_mfma_f32_16x16x32_bf16 v[172:175], a[88:91], a[8:11], v[172:175]
ds_read_b64_tr_b16 a[86:87], v14 offset:10496
s_add_u32 m0, s16, 0x9c00
v_mfma_f32_16x16x32_bf16 v[164:167], a[88:91], a[4:7], v[164:167]
buffer_load_dwordx4 v23, s[44:47], s23 offen lds
v_mfma_f32_16x16x32_bf16 v[164:167], a[92:95], a[20:23], v[164:167]
v_lshl_add_u32 v22, s42, 7, v22
v_lshl_add_u32 v23, s42, 7, v23
v_mfma_f32_16x16x32_bf16 v[156:159], a[92:95], a[16:19], v[156:159]
v_mfma_f32_16x16x32_bf16 v[156:159], a[88:91], a[0:3], v[156:159]
s_waitcnt lgkmcnt(4)
v_mfma_f32_16x16x32_bf16 v[184:187], a[96:99], a[0:3], v[184:187]
ds_read_b64_tr_b16 a[88:89], v15 offset:8192
v_mov_b32 v21, s1
v_mfma_f32_16x16x32_bf16 v[184:187], a[100:103], a[16:19], v[184:187]
ds_read_b64_tr_b16 a[90:91], v15 offset:8448
v_add_u32 v20, s0, v16
v_mfma_f32_16x16x32_bf16 v[192:195], a[100:103], a[20:23], v[192:195]
global_load_dword a120, v[20:21], off sc1
v_mfma_f32_16x16x32_bf16 v[192:195], a[96:99], a[4:7], v[192:195]
ds_read_b64_tr_b16 a[92:93], v15 offset:10240
v_mfma_f32_16x16x32_bf16 v[200:203], a[96:99], a[8:11], v[200:203]
ds_read_b64_tr_b16 a[94:95], v15 offset:10496
v_add_u32 v12, 0x8000, v12
v_mfma_f32_16x16x32_bf16 v[200:203], a[100:103], a[24:27], v[200:203]
v_add_u32 v13, 0x8000, v13
v_add_u32 v14, 0x8000, v14
v_mfma_f32_16x16x32_bf16 v[208:211], a[100:103], a[28:31], v[208:211]
v_add_u32 v15, 0x8000, v15
v_mfma_f32_16x16x32_bf16 v[208:211], a[96:99], a[12:15], v[208:211]
v_mfma_f32_16x16x32_bf16 v[212:215], a[104:107], a[12:15], v[212:215]
s_waitcnt vmcnt(19) lgkmcnt(0)
v_mfma_f32_16x16x32_bf16 v[212:215], a[108:111], a[28:31], v[212:215]
s_barrier
s_add_u32 m0, s17, 0x0
s_cmp_lg_u32 s4, 0
s_cbranch_scc1 L_sig_kv
v_mov_b32 v20, 1
s_mov_b64 exec, 1
buffer_atomic_add v20, off, s[84:87], s10 sc1
s_mov_b64 exec, -1
L_sig_kv:
v_mfma_f32_16x16x32_bf16 v[204:207], a[108:111], a[24:27], v[204:207]
buffer_load_dwordx4 v5, s[52:55], 0 offen lds
v_mfma_f32_16x16x32_bf16 v[204:207], a[104:107], a[8:11], v[204:207]
ds_read_b64_tr_b16 a[96:97], v12 offset:0
v_mfma_f32_16x16x32_bf16 v[196:199], a[104:107], a[4:7], v[196:199]
ds_read_b64_tr_b16 a[98:99], v12 offset:1024
v_mfma_f32_16x16x32_bf16 v[196:199], a[108:111], a[20:23], v[196:199]
ds_read_b64_tr_b16 a[100:101], v12 offset:8192
v_mfma_f32_16x16x32_bf16 v[188:191], a[108:111], a[16:19], v[188:191]
ds_read_b64_tr_b16 a[102:103], v12 offset:9216
v_mfma_f32_16x16x32_bf16 v[188:191], a[104:107], a[0:3], v[188:191]
s_add_u32 m0, s17, 0x400
s_waitcnt lgkmcnt(4)
v_mfma_f32_16x16x32_bf16 v[216:219], a[0:3], a[80:83], v[216:219]
buffer_load_dwordx4 v5, s[52:55], s13 offen lds
v_mfma_f32_16x16x32_bf16 v[216:219], a[16:19], a[84:87], v[216:219]
ds_read_b64_tr_b16 a[104:105], v13 offset:0
v_mfma_f32_16x16x32_bf16 v[224:227], a[20:23], a[84:87], v[224:227]
ds_read_b64_tr_b16 a[106:107], v13 offset:1024
v_mfma_f32_16x16x32_bf16 v[224:227], a[4:7], a[80:83], v[224:227]
ds_read_b64_tr_b16 a[108:109], v13 offset:8192
v_mfma_f32_16x16x32_bf16 v[232:235], a[8:11], a[80:83], v[232:235]
ds_read_b64_tr_b16 a[110:111], v13 offset:9216
v_mfma_f32_16x16x32_bf16 v[232:235], a[24:27], a[84:87], v[232:235]
v_mfma_f32_16x16x32_bf16 v[240:243], a[28:31], a[84:87], v[240:243]
s_add_u32 m0, s17, 0x800
v_mfma_f32_16x16x32_bf16 v[240:243], a[12:15], a[80:83], v[240:243]
buffer_load_dwordx4 v6, s[52:55], 0 offen lds
v_mfma_f32_16x16x32_bf16 v[244:247], a[12:15], a[88:91], v[244:247]
ds_read_b64_tr_b16 a[80:81], v12 offset:256
v_mfma_f32_16x16x32_bf16 v[244:247], a[28:31], a[92:95], v[244:247]
ds_read_b64_tr_b16 a[82:83], v12 offset:1280
v_mfma_f32_16x16x32_bf16 v[236:239], a[24:27], a[92:95], v[236:239]
ds_read_b64_tr_b16 a[84:85], v12 offset:8448
v_mfma_f32_16x16x32_bf16 v[236:239], a[8:11], a[88:91], v[236:239]
ds_read_b64_tr_b16 a[86:87], v12 offset:9472
v_mfma_f32_16x16x32_bf16 v[228:231], a[4:7], a[88:91], v[228:231]
v_mfma_f32_16x16x32_bf16 v[228:231], a[20:23], a[92:95], v[228:231]
s_add_u32 m0, s17, 0xc00
v_mfma_f32_16x16x32_bf16 v[220:223], a[16:19], a[92:95], v[220:223]
buffer_load_dwordx4 v6, s[52:55], s13 offen lds
v_mfma_f32_16x16x32_bf16 v[220:223], a[0:3], a[88:91], v[220:223]
s_waitcnt lgkmcnt(4)
L_S19:
v_mfma_f32_16x16x32_bf16 v[24:27], a[96:99], a[32:35], v[24:27]
ds_read_b64_tr_b16 a[88:89], v13 offset:256
s_waitcnt vmcnt(24)
v_mfma_f32_16x16x32_bf16 v[24:27], a[100:103], a[48:51], v[24:27]
ds_read_b64_tr_b16 a[90:91], v13 offset:1280
v_mfma_f32_16x16x32_bf16 v[32:35], a[100:103], a[52:55], v[32:35]
ds_read_b64_tr_b16 a[92:93], v13 offset:8448
v_mfma_f32_16x16x32_bf16 v[32:35], a[96:99], a[36:39], v[32:35]
ds_read_b64_tr_b16 a[94:95], v13 offset:9472
v_mfma_f32_16x16x32_bf16 v[40:43], a[96:99], a[40:43], v[40:43]
ds_read_b128 a[0:3], v8 offset:0
s_add_u32 m0, s18, 0x4000
v_mfma_f32_16x16x32_bf16 v[40:43], a[100:103], a[56:59], v[40:43]
buffer_load_dwordx4 v7, s[68:71], 0 offen lds
v_mfma_f32_16x16x32_bf16 v[48:51], a[100:103], a[60:63], v[48:51]
ds_read_b128 a[16:19], v9 offset:0
v_mfma_f32_16x16x32_bf16 v[48:51], a[96:99], a[44:47], v[48:51]
ds_read_b128 a[4:7], v8 offset:2048
v_mfma_f32_16x16x32_bf16 v[52:55], a[104:107], a[44:47], v[52:55]
ds_read_b64_tr_b16 a[96:97], v12 offset:512
v_mfma_f32_16x16x32_bf16 v[52:55], a[108:111], a[60:63], v[52:55]
ds_read_b64_tr_b16 a[98:99], v12 offset:1536
v_mfma_f32_16x16x32_bf16 v[44:47], a[108:111], a[56:59], v[44:47]
ds_read_b64_tr_b16 a[100:101], v12 offset:8704
v_mfma_f32_16x16x32_bf16 v[44:47], a[104:107], a[40:43], v[44:47]
buffer_load_dwordx4 a[140:143], v16, s[44:47], s100 offen offset:3072
v_mfma_f32_16x16x32_bf16 v[36:39], a[104:107], a[36:39], v[36:39]
ds_read_b64_tr_b16 a[102:103], v12 offset:9728
v_mfma_f32_16x16x32_bf16 v[36:39], a[108:111], a[52:55], v[36:39]
ds_read_b128 a[20:23], v9 offset:2048
v_mfma_f32_16x16x32_bf16 v[28:31], a[108:111], a[48:51], v[28:31]
ds_read_b128 a[8:11], v8 offset:4096
v_mfma_f32_16x16x32_bf16 v[28:31], a[104:107], a[32:35], v[28:31]
ds_read_b128 a[24:27], v9 offset:4096
s_waitcnt lgkmcnt(10)
v_mfma_f32_16x16x32_bf16 v[56:59], a[80:83], a[32:35], v[56:59]
ds_read_b64_tr_b16 a[104:105], v13 offset:512
v_mfma_f32_16x16x32_bf16 v[56:59], a[84:87], a[48:51], v[56:59]
ds_read_b64_tr_b16 a[106:107], v13 offset:1536
s_add_u32 m0, s18, 0x5000
v_mfma_f32_16x16x32_bf16 v[64:67], a[84:87], a[52:55], v[64:67]
buffer_load_dwordx4 v7, s[68:71], s25 offen lds
v_mfma_f32_16x16x32_bf16 v[64:67], a[80:83], a[36:39], v[64:67]
ds_read_b64_tr_b16 a[108:109], v13 offset:8704
v_mfma_f32_16x16x32_bf16 v[72:75], a[80:83], a[40:43], v[72:75]
ds_read_b64_tr_b16 a[110:111], v13 offset:9728
v_mfma_f32_16x16x32_bf16 v[72:75], a[84:87], a[56:59], v[72:75]
ds_read_b128 a[12:15], v8 offset:6144
v_mfma_f32_16x16x32_bf16 v[80:83], a[84:87], a[60:63], v[80:83]
ds_read_b128 a[28:31], v9 offset:6144
v_mfma_f32_16x16x32_bf16 v[80:83], a[80:83], a[44:47], v[80:83]
v_mfma_f32_16x16x32_bf16 v[84:87], a[88:91], a[44:47], v[84:87]
ds_read_b64_tr_b16 a[80:81], v12 offset:768
s_add_u32 m0, s18, 0x6000
v_mfma_f32_16x16x32_bf16 v[84:87], a[92:95], a[60:63], v[84:87]
buffer_load_dwordx4 v7, s[68:71], s26 offen lds
v_mfma_f32_16x16x32_bf16 v[76:79], a[92:95], a[56:59], v[76:79]
ds_read_b64_tr_b16 a[82:83], v12 offset:1792
v_lshl_add_u32 v5, s42, 19, v5
v_mfma_f32_16x16x32_bf16 v[76:79], a[88:91], a[40:43], v[76:79]
ds_read_b64_tr_b16 a[84:85], v12 offset:8960
v_lshl_add_u32 v6, s42, 19, v6
v_mfma_f32_16x16x32_bf16 v[68:71], a[88:91], a[36:39], v[68:71]
ds_read_b64_tr_b16 a[86:87], v12 offset:9984
v_lshl_add_u32 v7, s42, 18, v7
v_mfma_f32_16x16x32_bf16 v[68:71], a[92:95], a[52:55], v[68:71]
v_lshl_add_u32 v7, s42, 17, v7
v_mfma_f32_16x16x32_bf16 v[60:63], a[92:95], a[48:51], v[60:63]
v_mfma_f32_16x16x32_bf16 v[60:63], a[88:91], a[32:35], v[60:63]
s_add_u32 m0, s16, 0x0
s_waitcnt lgkmcnt(4)
s_waitcnt lgkmcnt(6)
v_mfma_f32_16x16x32_bf16 v[88:91], a[96:99], a[32:35], v[88:91]
buffer_load_dwordx4 v22, s[44:47], s20 offen lds
v_mfma_f32_16x16x32_bf16 v[88:91], a[100:103], a[48:51], v[88:91]
ds_read_b64_tr_b16 a[88:89], v13 offset:768
v_mfma_f32_16x16x32_bf16 v[96:99], a[100:103], a[52:55], v[96:99]
ds_read_b64_tr_b16 a[90:91], v13 offset:1792
v_mfma_f32_16x16x32_bf16 v[96:99], a[96:99], a[36:39], v[96:99]
ds_read_b64_tr_b16 a[92:93], v13 offset:8960
v_mfma_f32_16x16x32_bf16 v[104:107], a[96:99], a[40:43], v[104:107]
ds_read_b64_tr_b16 a[94:95], v13 offset:9984
s_add_u32 m0, s16, 0x400
v_mfma_f32_16x16x32_bf16 v[104:107], a[100:103], a[56:59], v[104:107]
buffer_load_dwordx4 v23, s[44:47], s20 offen lds
v_mfma_f32_16x16x32_bf16 v[112:115], a[100:103], a[60:63], v[112:115]
v_mfma_f32_16x16x32_bf16 v[112:115], a[96:99], a[44:47], v[112:115]
v_mfma_f32_16x16x32_bf16 v[116:119], a[104:107], a[44:47], v[116:119]
ds_read_b64_tr_b16 a[96:97], v14 offset:0
v_mfma_f32_16x16x32_bf16 v[116:119], a[108:111], a[60:63], v[116:119]
ds_read_b64_tr_b16 a[98:99], v14 offset:256
v_mfma_f32_16x16x32_bf16 v[108:111], a[108:111], a[56:59], v[108:111]
ds_read_b64_tr_b16 a[100:101], v14 offset:2048
s_add_u32 m0, s16, 0x800
v_mfma_f32_16x16x32_bf16 v[108:111], a[104:107], a[40:43], v[108:111]
buffer_load_dwordx4 v22, s[44:47], s21 offen lds
v_mfma_f32_16x16x32_bf16 v[100:103], a[104:107], a[36:39], v[100:103]
ds_read_b64_tr_b16 a[102:103], v14 offset:2304
v_mfma_f32_16x16x32_bf16 v[100:103], a[108:111], a[52:55], v[100:103]
v_mfma_f32_16x16x32_bf16 v[92:95], a[108:111], a[48:51], v[92:95]
v_mfma_f32_16x16x32_bf16 v[92:95], a[104:107], a[32:35], v[92:95]
s_waitcnt lgkmcnt(4)
v_mfma_f32_16x16x32_bf16 v[120:123], a[80:83], a[32:35], v[120:123]
buffer_load_dwordx4 a[144:147], v16, s[76:79], 0 offen offset:0
v_mfma_f32_16x16x32_bf16 v[120:123], a[84:87], a[48:51], v[120:123]
ds_read_b64_tr_b16 a[104:105], v15 offset:0
v_mfma_f32_16x16x32_bf16 v[128:131], a[84:87], a[52:55], v[128:131]
ds_read_b64_tr_b16 a[106:107], v15 offset:256
v_mfma_f32_16x16x32_bf16 v[128:131], a[80:83], a[36:39], v[128:131]
ds_read_b64_tr_b16 a[108:109], v15 offset:2048
v_mfma_f32_16x16x32_bf16 v[136:139], a[80:83], a[40:43], v[136:139]
ds_read_b64_tr_b16 a[110:111], v15 offset:2304
v_mfma_f32_16x16x32_bf16 v[136:139], a[84:87], a[56:59], v[136:139]
s_add_u32 m0, s16, 0xc00
v_mfma_f32_16x16x32_bf16 v[144:147], a[84:87], a[60:63], v[144:147]
buffer_load_dwordx4 v23, s[44:47], s21 offen lds
v_mfma_f32_16x16x32_bf16 v[144:147], a[80:83], a[44:47], v[144:147]
v_mfma_f32_16x16x32_bf16 v[148:151], a[88:91], a[44:47], v[148:151]
ds_read_b64_tr_b16 a[80:81], v14 offset:4096
v_mfma_f32_16x16x32_bf16 v[148:151], a[92:95], a[60:63], v[148:151]
ds_read_b64_tr_b16 a[82:83], v14 offset:4352
v_mfma_f32_16x16x32_bf16 v[140:143], a[92:95], a[56:59], v[140:143]
ds_read_b64_tr_b16 a[84:85], v14 offset:6144
v_mfma_f32_16x16x32_bf16 v[140:143], a[88:91], a[40:43], v[140:143]
ds_read_b64_tr_b16 a[86:87], v14 offset:6400
s_add_u32 m0, s16, 0x1000
v_mfma_f32_16x16x32_bf16 v[132:135], a[88:91], a[36:39], v[132:135]
buffer_load_dwordx4 v22, s[44:47], s22 offen lds
v_mfma_f32_16x16x32_bf16 v[132:135], a[92:95], a[52:55], v[132:135]
v_mfma_f32_16x16x32_bf16 v[124:127], a[92:95], a[48:51], v[124:127]
v_mfma_f32_16x16x32_bf16 v[124:127], a[88:91], a[32:35], v[124:127]
s_waitcnt lgkmcnt(4)
v_mfma_f32_16x16x32_bf16 v[152:155], a[96:99], a[32:35], v[152:155]
ds_read_b64_tr_b16 a[88:89], v15 offset:4096
s_add_u32 m0, s16, 0x1400
v_mfma_f32_16x16x32_bf16 v[152:155], a[100:103], a[48:51], v[152:155]
buffer_load_dwordx4 v23, s[44:47], s22 offen lds
v_mfma_f32_16x16x32_bf16 v[160:163], a[100:103], a[52:55], v[160:163]
ds_read_b64_tr_b16 a[90:91], v15 offset:4352
v_mfma_f32_16x16x32_bf16 v[160:163], a[96:99], a[36:39], v[160:163]
ds_read_b64_tr_b16 a[92:93], v15 offset:6144
v_mfma_f32_16x16x32_bf16 v[168:171], a[96:99], a[40:43], v[168:171]
ds_read_b64_tr_b16 a[94:95], v15 offset:6400
v_mfma_f32_16x16x32_bf16 v[168:171], a[100:103], a[56:59], v[168:171]
v_mfma_f32_16x16x32_bf16 v[176:179], a[100:103], a[60:63], v[176:179]
s_add_u32 m0, s16, 0x1800
v_mfma_f32_16x16x32_bf16 v[176:179], a[96:99], a[44:47], v[176:179]
buffer_load_dwordx4 v22, s[44:47], s23 offen lds
v_mfma_f32_16x16x32_bf16 v[180:183], a[104:107], a[44:47], v[180:183]
ds_read_b64_tr_b16 a[96:97], v14 offset:8192
v_mfma_f32_16x16x32_bf16 v[180:183], a[108:111], a[60:63], v[180:183]
ds_read_b64_tr_b16 a[98:99], v14 offset:8448
v_mfma_f32_16x16x32_bf16 v[172:175], a[108:111], a[56:59], v[172:175]
ds_read_b64_tr_b16 a[100:101], v14 offset:10240
v_mfma_f32_16x16x32_bf16 v[172:175], a[104:107], a[40:43], v[172:175]
ds_read_b64_tr_b16 a[102:103], v14 offset:10496
s_add_u32 m0, s16, 0x1c00
v_mfma_f32_16x16x32_bf16 v[164:167], a[104:107], a[36:39], v[164:167]
buffer_load_dwordx4 v23, s[44:47], s23 offen lds
v_mfma_f32_16x16x32_bf16 v[164:167], a[108:111], a[52:55], v[164:167]
v_lshl_add_u32 v22, s42, 7, v22
v_lshl_add_u32 v23, s42, 7, v23
v_mfma_f32_16x16x32_bf16 v[156:159], a[108:111], a[48:51], v[156:159]
v_mfma_f32_16x16x32_bf16 v[156:159], a[104:107], a[32:35], v[156:159]
s_waitcnt lgkmcnt(4)
v_mfma_f32_16x16x32_bf16 v[184:187], a[80:83], a[32:35], v[184:187]
ds_read_b64_tr_b16 a[104:105], v15 offset:8192
v_mfma_f32_16x16x32_bf16 v[184:187], a[84:87], a[48:51], v[184:187]
ds_read_b64_tr_b16 a[106:107], v15 offset:8448
v_mfma_f32_16x16x32_bf16 v[192:195], a[84:87], a[52:55], v[192:195]
buffer_load_dwordx4 a[148:151], v16, s[76:79], 0 offen offset:1024
v_mfma_f32_16x16x32_bf16 v[192:195], a[80:83], a[36:39], v[192:195]
ds_read_b64_tr_b16 a[108:109], v15 offset:10240
v_mfma_f32_16x16x32_bf16 v[200:203], a[80:83], a[40:43], v[200:203]
ds_read_b64_tr_b16 a[110:111], v15 offset:10496
v_add_u32 v12, 0x8000, v12
v_mfma_f32_16x16x32_bf16 v[200:203], a[84:87], a[56:59], v[200:203]
v_add_u32 v13, 0x8000, v13
v_add_u32 v14, 0x8000, v14
v_mfma_f32_16x16x32_bf16 v[208:211], a[84:87], a[60:63], v[208:211]
v_add_u32 v15, 0x8000, v15
v_mfma_f32_16x16x32_bf16 v[208:211], a[80:83], a[44:47], v[208:211]
v_mfma_f32_16x16x32_bf16 v[212:215], a[88:91], a[44:47], v[212:215]
s_waitcnt vmcnt(29) lgkmcnt(0)
v_mfma_f32_16x16x32_bf16 v[212:215], a[92:95], a[60:63], v[212:215]
s_barrier
s_add_u32 m0, s17, 0x8000
v_mfma_f32_16x16x32_bf16 v[204:207], a[92:95], a[56:59], v[204:207]
buffer_load_dwordx4 v5, s[52:55], 0 offen lds
v_mfma_f32_16x16x32_bf16 v[204:207], a[88:91], a[40:43], v[204:207]
ds_read_b64_tr_b16 a[80:81], v12 offset:0
v_mfma_f32_16x16x32_bf16 v[196:199], a[88:91], a[36:39], v[196:199]
ds_read_b64_tr_b16 a[82:83], v12 offset:1024
v_mfma_f32_16x16x32_bf16 v[196:199], a[92:95], a[52:55], v[196:199]
ds_read_b64_tr_b16 a[84:85], v12 offset:8192
v_mfma_f32_16x16x32_bf16 v[188:191], a[92:95], a[48:51], v[188:191]
ds_read_b64_tr_b16 a[86:87], v12 offset:9216
v_mfma_f32_16x16x32_bf16 v[188:191], a[88:91], a[32:35], v[188:191]
s_waitcnt lgkmcnt(4)
v_mfma_f32_16x16x32_bf16 v[216:219], a[32:35], a[96:99], v[216:219]
ds_read_b64_tr_b16 a[88:89], v13 offset:0
s_add_u32 m0, s17, 0x8400
v_mfma_f32_16x16x32_bf16 v[216:219], a[48:51], a[100:103], v[216:219]
buffer_load_dwordx4 v5, s[52:55], s13 offen lds
v_mfma_f32_16x16x32_bf16 v[224:227], a[52:55], a[100:103], v[224:227]
ds_read_b64_tr_b16 a[90:91], v13 offset:1024
v_mfma_f32_16x16x32_bf16 v[224:227], a[36:39], a[96:99], v[224:227]
ds_read_b64_tr_b16 a[92:93], v13 offset:8192
v_mfma_f32_16x16x32_bf16 v[232:235], a[40:43], a[96:99], v[232:235]
ds_read_b64_tr_b16 a[94:95], v13 offset:9216
v_mfma_f32_16x16x32_bf16 v[232:235], a[56:59], a[100:103], v[232:235]
v_mfma_f32_16x16x32_bf16 v[240:243], a[60:63], a[100:103], v[240:243]
v_mfma_f32_16x16x32_bf16 v[240:243], a[44:47], a[96:99], v[240:243]
v_mfma_f32_16x16x32_bf16 v[244:247], a[44:47], a[104:107], v[244:247]
ds_read_b64_tr_b16 a[96:97], v12 offset:256
s_add_u32 m0, s17, 0x8800
v_mfma_f32_16x16x32_bf16 v[244:247], a[60:63], a[108:111], v[244:247]
buffer_load_dwordx4 v6, s[52:55], 0 offen lds
v_mfma_f32_16x16x32_bf16 v[236:239], a[56:59], a[108:111], v[236:239]
ds_read_b64_tr_b16 a[98:99], v12 offset:1280
v_mfma_f32_16x16x32_bf16 v[236:239], a[40:43], a[104:107], v[236:239]
ds_read_b64_tr_b16 a[100:101], v12 offset:8448
v_mfma_f32_16x16x32_bf16 v[228:231], a[36:39], a[104:107], v[228:231]
ds_read_b64_tr_b16 a[102:103], v12 offset:9472
v_mfma_f32_16x16x32_bf16 v[228:231], a[52:55], a[108:111], v[228:231]
v_mfma_f32_16x16x32_bf16 v[220:223], a[48:51], a[108:111], v[220:223]
v_mfma_f32_16x16x32_bf16 v[220:223], a[32:35], a[104:107], v[220:223]
s_add_u32 m0, s17, 0x8c00
s_waitcnt lgkmcnt(4)
L_S20:
v_mfma_f32_16x16x32_bf16 v[24:27], a[80:83], a[0:3], v[24:27]
ds_read_b64_tr_b16 a[104:105], v13 offset:256
s_waitcnt vmcnt(22)
v_mfma_f32_16x16x32_bf16 v[24:27], a[84:87], a[16:19], v[24:27]
buffer_load_dwordx4 v6, s[52:55], s13 offen lds
v_mfma_f32_16x16x32_bf16 v[32:35], a[84:87], a[20:23], v[32:35]
ds_read_b64_tr_b16 a[106:107], v13 offset:1280
v_mfma_f32_16x16x32_bf16 v[32:35], a[80:83], a[4:7], v[32:35]
ds_read_b64_tr_b16 a[108:109], v13 offset:8448
v_mfma_f32_16x16x32_bf16 v[40:43], a[80:83], a[8:11], v[40:43]
ds_read_b64_tr_b16 a[110:111], v13 offset:9472
v_mfma_f32_16x16x32_bf16 v[40:43], a[84:87], a[24:27], v[40:43]
ds_read_b128 a[32:35], v8 offset:32768
v_mfma_f32_16x16x32_bf16 v[48:51], a[84:87], a[28:31], v[48:51]
ds_read_b128 a[48:51], v9 offset:32768
v_mfma_f32_16x16x32_bf16 v[48:51], a[80:83], a[12:15], v[48:51]
ds_read_b128 a[36:39], v8 offset:34816
s_add_u32 m0, s18, 0xc000
v_mfma_f32_16x16x32_bf16 v[52:55], a[88:91], a[12:15], v[52:55]
buffer_load_dwordx4 v7, s[68:71], 0 offen lds
v_mfma_f32_16x16x32_bf16 v[52:55], a[92:95], a[28:31], v[52:55]
ds_read_b64_tr_b16 a[80:81], v12 offset:512
v_mfma_f32_16x16x32_bf16 v[44:47], a[92:95], a[24:27], v[44:47]
ds_read_b64_tr_b16 a[82:83], v12 offset:1536
v_mfma_f32_16x16x32_bf16 v[44:47], a[88:91], a[8:11], v[44:47]
ds_read_b64_tr_b16 a[84:85], v12 offset:8704
v_mfma_f32_16x16x32_bf16 v[36:39], a[88:91], a[4:7], v[36:39]
ds_read_b64_tr_b16 a[86:87], v12 offset:9728
v_mfma_f32_16x16x32_bf16 v[36:39], a[92:95], a[20:23], v[36:39]
ds_read_b128 a[52:55], v9 offset:34816
v_mfma_f32_16x16x32_bf16 v[28:31], a[92:95], a[16:19], v[28:31]
ds_read_b128 a[40:43], v8 offset:36864
s_waitcnt lgkmcnt(9)
v_mfma_f32_16x16x32_bf16 v[28:31], a[88:91], a[0:3], v[28:31]
ds_read_b128 a[56:59], v9 offset:36864
s_add_u32 m0, s18, 0xd000
v_mfma_f32_16x16x32_bf16 v[56:59], a[96:99], a[0:3], v[56:59]
buffer_load_dwordx4 v7, s[68:71], s25 offen lds
v_mfma_f32_16x16x32_bf16 v[56:59], a[100:103], a[16:19], v[56:59]
ds_read_b64_tr_b16 a[88:89], v13 offset:512
v_mfma_f32_16x16x32_bf16 v[64:67], a[100:103], a[20:23], v[64:67]
ds_read_b64_tr_b16 a[90:91], v13 offset:1536
v_mfma_f32_16x16x32_bf16 v[64:67], a[96:99], a[4:7], v[64:67]
ds_read_b64_tr_b16 a[92:93], v13 offset:8704
v_mfma_f32_16x16x32_bf16 v[72:75], a[96:99], a[8:11], v[72:75]
ds_read_b64_tr_b16 a[94:95], v13 offset:9728
v_mfma_f32_16x16x32_bf16 v[72:75], a[100:103], a[24:27], v[72:75]
ds_read_b128 a[44:47], v8 offset:38912
v_mfma_f32_16x16x32_bf16 v[80:83], a[100:103], a[28:31], v[80:83]
ds_read_b128 a[60:63], v9 offset:38912
v_mfma_f32_16x16x32_bf16 v[80:83], a[96:99], a[12:15], v[80:83]
s_add_u32 m0, s18, 0xe000
v_mfma_f32_16x16x32_bf16 v[84:87], a[104:107], a[12:15], v[84:87]
buffer_load_dwordx4 v7, s[68:71], s26 offen lds
v_mfma_f32_16x16x32_bf16 v[84:87], a[108:111], a[28:31], v[84:87]
ds_read_b64_tr_b16 a[96:97], v12 offset:768
v_lshl_add_u32 v5, s42, 19, v5
v_mfma_f32_16x16x32_bf16 v[76:79], a[108:111], a[24:27], v[76:79]
ds_read_b64_tr_b16 a[98:99], v12 offset:1792
L_padA10:
s_cmp_eq_u32 s95, 1
s_cbranch_scc1 L_hopA_ret
v_lshl_add_u32 v6, s42, 19, v6
v_mfma_f32_16x16x32_bf16 v[76:79], a[104:107], a[8:11], v[76:79]
ds_read_b64_tr_b16 a[100:101], v12 offset:8960
v_lshl_add_u32 v7, s42, 18, v7
v_mfma_f32_16x16x32_bf16 v[68:71], a[104:107], a[4:7], v[68:71]
ds_read_b64_tr_b16 a[102:103], v12 offset:9984
v_lshl_add_u32 v7, s42, 17, v7
v_mfma_f32_16x16x32_bf16 v[68:71], a[108:111], a[20:23], v[68:71]
s_waitcnt vmcnt(13)
v_accvgpr_read_b32 v18, a144
v_lshlrev_b32 v1, 16, v18
v_mfma_f32_16x16x32_bf16 v[60:63], a[108:111], a[16:19], v[60:63]
v_and_b32 v18, 0xffff0000, v18
v_accvgpr_read_b32 v21, a128
v_mfma_f32_16x16x32_bf16 v[60:63], a[104:107], a[0:3], v[60:63]
s_add_u32 m0, s16, 0x8000
s_waitcnt lgkmcnt(4)
s_waitcnt lgkmcnt(6)
v_mfma_f32_16x16x32_bf16 v[88:91], a[80:83], a[0:3], v[88:91]
buffer_load_dwordx4 v22, s[44:47], s20 offen lds
v_mfma_f32_16x16x32_bf16 v[88:91], a[84:87], a[16:19], v[88:91]
ds_read_b64_tr_b16 a[104:105], v13 offset:768
v_lshlrev_b32 v20, 16, v21
v_mfma_f32_16x16x32_bf16 v[96:99], a[84:87], a[20:23], v[96:99]
ds_read_b64_tr_b16 a[106:107], v13 offset:1792
v_and_b32 v21, 0xffff0000, v21
v_mfma_f32_16x16x32_bf16 v[96:99], a[80:83], a[4:7], v[96:99]
ds_read_b64_tr_b16 a[108:109], v13 offset:8960
v_mul_f32 v2, v1, v20
v_mfma_f32_16x16x32_bf16 v[104:107], a[80:83], a[8:11], v[104:107]
ds_read_b64_tr_b16 a[110:111], v13 offset:9984
v_fmac_f32 v2, v18, v21
v_mfma_f32_16x16x32_bf16 v[104:107], a[84:87], a[24:27], v[104:107]
v_accvgpr_read_b32 v21, a136
v_lshlrev_b32 v20, 16, v21
v_mfma_f32_16x16x32_bf16 v[112:115], a[84:87], a[28:31], v[112:115]
s_add_u32 m0, s16, 0x8400
v_and_b32 v21, 0xffff0000, v21
v_mul_f32 v3, v1, v20
v_mfma_f32_16x16x32_bf16 v[112:115], a[80:83], a[12:15], v[112:115]
buffer_load_dwordx4 v23, s[44:47], s20 offen lds
v_mfma_f32_16x16x32_bf16 v[116:119], a[88:91], a[12:15], v[116:119]
ds_read_b64_tr_b16 a[80:81], v14 offset:0
v_fmac_f32 v3, v18, v21
v_mfma_f32_16x16x32_bf16 v[116:119], a[92:95], a[28:31], v[116:119]
ds_read_b64_tr_b16 a[82:83], v14 offset:256
v_accvgpr_read_b32 v18, a145
v_mfma_f32_16x16x32_bf16 v[108:111], a[92:95], a[24:27], v[108:111]
ds_read_b64_tr_b16 a[84:85], v14 offset:2048
v_lshlrev_b32 v1, 16, v18
v_mfma_f32_16x16x32_bf16 v[108:111], a[88:91], a[8:11], v[108:111]
ds_read_b64_tr_b16 a[86:87], v14 offset:2304
v_and_b32 v18, 0xffff0000, v18
v_mfma_f32_16x16x32_bf16 v[100:103], a[88:91], a[4:7], v[100:103]
v_accvgpr_read_b32 v21, a129
v_lshlrev_b32 v20, 16, v21
v_mfma_f32_16x16x32_bf16 v[100:103], a[92:95], a[20:23], v[100:103]
s_add_u32 m0, s16, 0x8800
v_and_b32 v21, 0xffff0000, v21
v_fmac_f32 v2, v1, v20
v_mfma_f32_16x16x32_bf16 v[92:95], a[92:95], a[16:19], v[92:95]
buffer_load_dwordx4 v22, s[44:47], s21 offen lds
v_mfma_f32_16x16x32_bf16 v[92:95], a[88:91], a[0:3], v[92:95]
s_waitcnt lgkmcnt(4)
v_fmac_f32 v2, v18, v21
v_accvgpr_read_b32 v21, a137
v_mfma_f32_16x16x32_bf16 v[120:123], a[96:99], a[0:3], v[120:123]
ds_read_b64_tr_b16 a[88:89], v15 offset:0
v_lshlrev_b32 v20, 16, v21
v_mfma_f32_16x16x32_bf16 v[120:123], a[100:103], a[16:19], v[120:123]
ds_read_b64_tr_b16 a[90:91], v15 offset:256
v_and_b32 v21, 0xffff0000, v21
v_mfma_f32_16x16x32_bf16 v[128:131], a[100:103], a[20:23], v[128:131]
ds_read_b64_tr_b16 a[92:93], v15 offset:2048
v_fmac_f32 v3, v1, v20
v_mfma_f32_16x16x32_bf16 v[128:131], a[96:99], a[4:7], v[128:131]
ds_read_b64_tr_b16 a[94:95], v15 offset:2304
v_fmac_f32 v3, v18, v21
v_mfma_f32_16x16x32_bf16 v[136:139], a[96:99], a[8:11], v[136:139]
s_add_u32 m0, s16, 0x8c00
v_accvgpr_read_b32 v18, a146
v_lshlrev_b32 v1, 16, v18
v_mfma_f32_16x16x32_bf16 v[136:139], a[100:103], a[24:27], v[136:139]
buffer_load_dwordx4 v23, s[44:47], s21 offen lds
v_mfma_f32_16x16x32_bf16 v[144:147], a[100:103], a[28:31], v[144:147]
v_and_b32 v18, 0xffff0000, v18
v_accvgpr_read_b32 v21, a130
v_mfma_f32_16x16x32_bf16 v[144:147], a[96:99], a[12:15], v[144:147]
v_lshlrev_b32 v20, 16, v21
v_and_b32 v21, 0xffff0000, v21
v_mfma_f32_16x16x32_bf16 v[148:151], a[104:107], a[12:15], v[148:151]
ds_read_b64_tr_b16 a[96:97], v14 offset:4096
v_fmac_f32 v2, v1, v20
v_mfma_f32_16x16x32_bf16 v[148:151], a[108:111], a[28:31], v[148:151]
ds_read_b64_tr_b16 a[98:99], v14 offset:4352
v_fmac_f32 v2, v18, v21
v_mfma_f32_16x16x32_bf16 v[140:143], a[108:111], a[24:27], v[140:143]
ds_read_b64_tr_b16 a[100:101], v14 offset:6144
v_accvgpr_read_b32 v21, a138
v_mfma_f32_16x16x32_bf16 v[140:143], a[104:107], a[8:11], v[140:143]
ds_read_b64_tr_b16 a[102:103], v14 offset:6400
s_add_u32 m0, s16, 0x9000
v_mfma_f32_16x16x32_bf16 v[132:135], a[104:107], a[4:7], v[132:135]
buffer_load_dwordx4 v22, s[44:47], s22 offen lds
v_mfma_f32_16x16x32_bf16 v[132:135], a[108:111], a[20:23], v[132:135]
v_lshlrev_b32 v20, 16, v21
v_and_b32 v21, 0xffff0000, v21
v_mfma_f32_16x16x32_bf16 v[124:127], a[108:111], a[16:19], v[124:127]
v_fmac_f32 v3, v1, v20
v_fmac_f32 v3, v18, v21
v_mfma_f32_16x16x32_bf16 v[124:127], a[104:107], a[0:3], v[124:127]
s_waitcnt lgkmcnt(4)
v_accvgpr_read_b32 v18, a147
v_lshlrev_b32 v1, 16, v18
v_mfma_f32_16x16x32_bf16 v[152:155], a[80:83], a[0:3], v[152:155]
ds_read_b64_tr_b16 a[104:105], v15 offset:4096
v_and_b32 v18, 0xffff0000, v18
v_mfma_f32_16x16x32_bf16 v[152:155], a[84:87], a[16:19], v[152:155]
ds_read_b64_tr_b16 a[106:107], v15 offset:4352
v_accvgpr_read_b32 v21, a131
v_mfma_f32_16x16x32_bf16 v[160:163], a[84:87], a[20:23], v[160:163]
ds_read_b64_tr_b16 a[108:109], v15 offset:6144
s_add_u32 m0, s16, 0x9400
v_mfma_f32_16x16x32_bf16 v[160:163], a[80:83], a[4:7], v[160:163]
buffer_load_dwordx4 v23, s[44:47], s22 offen lds
v_mfma_f32_16x16x32_bf16 v[168:171], a[80:83], a[8:11], v[168:171]
ds_read_b64_tr_b16 a[110:111], v15 offset:6400
v_lshlrev_b32 v20, 16, v21
v_mfma_f32_16x16x32_bf16 v[168:171], a[84:87], a[24:27], v[168:171]
v_and_b32 v21, 0xffff0000, v21
v_fmac_f32 v2, v1, v20
v_mfma_f32_16x16x32_bf16 v[176:179], a[84:87], a[28:31], v[176:179]
v_fmac_f32 v2, v18, v21
v_accvgpr_read_b32 v21, a139
v_mfma_f32_16x16x32_bf16 v[176:179], a[80:83], a[12:15], v[176:179]
v_lshlrev_b32 v20, 16, v21
v_and_b32 v21, 0xffff0000, v21
v_mfma_f32_16x16x32_bf16 v[180:183], a[88:91], a[12:15], v[180:183]
ds_read_b64_tr_b16 a[80:81], v14 offset:8192
v_fmac_f32 v3, v1, v20
v_mfma_f32_16x16x32_bf16 v[180:183], a[92:95], a[28:31], v[180:183]
ds_read_b64_tr_b16 a[82:83], v14 offset:8448
s_add_u32 m0, s16, 0x9800
v_mfma_f32_16x16x32_bf16 v[172:175], a[92:95], a[24:27], v[172:175]
buffer_load_dwordx4 v22, s[44:47], s23 offen lds
v_mfma_f32_16x16x32_bf16 v[172:175], a[88:91], a[8:11], v[172:175]
ds_read_b64_tr_b16 a[84:85], v14 offset:10240
v_fmac_f32 v3, v18, v21
v_mfma_f32_16x16x32_bf16 v[164:167], a[88:91], a[4:7], v[164:167]
ds_read_b64_tr_b16 a[86:87], v14 offset:10496
s_waitcnt vmcnt(14)
v_accvgpr_read_b32 v18, a148
v_mfma_f32_16x16x32_bf16 v[164:167], a[92:95], a[20:23], v[164:167]
v_lshlrev_b32 v1, 16, v18
v_and_b32 v18, 0xffff0000, v18
v_mfma_f32_16x16x32_bf16 v[156:159], a[92:95], a[16:19], v[156:159]
v_accvgpr_read_b32 v21, a132
v_lshlrev_b32 v20, 16, v21
v_mfma_f32_16x16x32_bf16 v[156:159], a[88:91], a[0:3], v[156:159]
s_waitcnt lgkmcnt(4)
v_and_b32 v21, 0xffff0000, v21
v_fmac_f32 v2, v1, v20
v_mfma_f32_16x16x32_bf16 v[184:187], a[96:99], a[0:3], v[184:187]
ds_read_b64_tr_b16 a[88:89], v15 offset:8192
s_add_u32 m0, s16, 0x9c00
v_mfma_f32_16x16x32_bf16 v[184:187], a[100:103], a[16:19], v[184:187]
buffer_load_dwordx4 v23, s[44:47], s23 offen lds
v_mfma_f32_16x16x32_bf16 v[192:195], a[100:103], a[20:23], v[192:195]
ds_read_b64_tr_b16 a[90:91], v15 offset:8448
v_fmac_f32 v2, v18, v21
v_mfma_f32_16x16x32_bf16 v[192:195], a[96:99], a[4:7], v[192:195]
ds_read_b64_tr_b16 a[92:93], v15 offset:10240
v_accvgpr_read_b32 v21, a140
v_mfma_f32_16x16x32_bf16 v[200:203], a[96:99], a[8:11], v[200:203]
ds_read_b64_tr_b16 a[94:95], v15 offset:10496
v_add_u32 v12, 0xffff0000, v12
v_mfma_f32_16x16x32_bf16 v[200:203], a[100:103], a[24:27], v[200:203]
v_add_u32 v13, 0xffff0000, v13
v_add_u32 v14, 0xffff0000, v14
v_mfma_f32_16x16x32_bf16 v[208:211], a[100:103], a[28:31], v[208:211]
v_add_u32 v15, 0xffff0000, v15
v_lshlrev_b32 v20, 16, v21
v_mfma_f32_16x16x32_bf16 v[208:211], a[96:99], a[12:15], v[208:211]
v_and_b32 v21, 0xffff0000, v21
v_fmac_f32 v3, v1, v20
v_mfma_f32_16x16x32_bf16 v[212:215], a[104:107], a[12:15], v[212:215]
s_waitcnt vmcnt(25) lgkmcnt(0)
v_fmac_f32 v3, v18, v21
v_accvgpr_read_b32 v18, a149
v_mfma_f32_16x16x32_bf16 v[212:215], a[108:111], a[28:31], v[212:215]
s_barrier
s_add_u32 m0, s17, 0x10000
v_lshlrev_b32 v1, 16, v18
v_mfma_f32_16x16x32_bf16 v[204:207], a[108:111], a[24:27], v[204:207]
buffer_load_dwordx4 v5, s[52:55], 0 offen lds
v_mfma_f32_16x16x32_bf16 v[204:207], a[104:107], a[8:11], v[204:207]
ds_read_b64_tr_b16 a[96:97], v12 offset:0
v_and_b32 v18, 0xffff0000, v18
v_mfma_f32_16x16x32_bf16 v[196:199], a[104:107], a[4:7], v[196:199]
ds_read_b64_tr_b16 a[98:99], v12 offset:1024
v_accvgpr_read_b32 v21, a133
v_mfma_f32_16x16x32_bf16 v[196:199], a[108:111], a[20:23], v[196:199]
ds_read_b64_tr_b16 a[100:101], v12 offset:8192
v_lshlrev_b32 v20, 16, v21
v_mfma_f32_16x16x32_bf16 v[188:191], a[108:111], a[16:19], v[188:191]
ds_read_b64_tr_b16 a[102:103], v12 offset:9216
v_and_b32 v21, 0xffff0000, v21
v_mfma_f32_16x16x32_bf16 v[188:191], a[104:107], a[0:3], v[188:191]
s_waitcnt lgkmcnt(4)
v_fmac_f32 v2, v1, v20
v_fmac_f32 v2, v18, v21
v_mfma_f32_16x16x32_bf16 v[216:219], a[0:3], a[80:83], v[216:219]
ds_read_b64_tr_b16 a[104:105], v13 offset:0
v_accvgpr_read_b32 v21, a141
v_mfma_f32_16x16x32_bf16 v[216:219], a[16:19], a[84:87], v[216:219]
ds_read_b64_tr_b16 a[106:107], v13 offset:1024
s_add_u32 m0, s17, 0x10400
v_mfma_f32_16x16x32_bf16 v[224:227], a[20:23], a[84:87], v[224:227]
buffer_load_dwordx4 v5, s[52:55], s13 offen lds
v_mfma_f32_16x16x32_bf16 v[224:227], a[4:7], a[80:83], v[224:227]
ds_read_b64_tr_b16 a[108:109], v13 offset:8192
v_lshlrev_b32 v20, 16, v21
v_mfma_f32_16x16x32_bf16 v[232:235], a[8:11], a[80:83], v[232:235]
ds_read_b64_tr_b16 a[110:111], v13 offset:9216
v_and_b32 v21, 0xffff0000, v21
v_mfma_f32_16x16x32_bf16 v[232:235], a[24:27], a[84:87], v[232:235]
s_lshl_b32 s15, s2, 2
v_fmac_f32 v3, v1, v20
v_fmac_f32 v3, v18, v21
v_mfma_f32_16x16x32_bf16 v[240:243], a[28:31], a[84:87], v[240:243]
s_add_u32 s15, s15, s4
v_accvgpr_read_b32 v18, a150
v_lshlrev_b32 v1, 16, v18
v_mfma_f32_16x16x32_bf16 v[240:243], a[12:15], a[80:83], v[240:243]
s_lshl_b32 s15, s15, 12
v_and_b32 v18, 0xffff0000, v18
v_accvgpr_read_b32 v21, a134
v_mfma_f32_16x16x32_bf16 v[244:247], a[12:15], a[88:91], v[244:247]
ds_read_b64_tr_b16 a[80:81], v12 offset:256
v_lshlrev_b32 v20, 16, v21
v_mfma_f32_16x16x32_bf16 v[244:247], a[28:31], a[92:95], v[244:247]
ds_read_b64_tr_b16 a[82:83], v12 offset:1280
v_and_b32 v21, 0xffff0000, v21
v_mfma_f32_16x16x32_bf16 v[236:239], a[24:27], a[92:95], v[236:239]
ds_read_b64_tr_b16 a[84:85], v12 offset:8448
s_add_u32 m0, s17, 0x10800
v_mfma_f32_16x16x32_bf16 v[236:239], a[8:11], a[88:91], v[236:239]
buffer_load_dwordx4 v6, s[52:55], 0 offen lds
v_mfma_f32_16x16x32_bf16 v[228:231], a[4:7], a[88:91], v[228:231]
ds_read_b64_tr_b16 a[86:87], v12 offset:9472
v_fmac_f32 v2, v1, v20
v_mfma_f32_16x16x32_bf16 v[228:231], a[20:23], a[92:95], v[228:231]
s_add_u32 s15, s15, 0x3800000
v_fmac_f32 v2, v18, v21
v_accvgpr_read_b32 v21, a142
v_mfma_f32_16x16x32_bf16 v[220:223], a[16:19], a[92:95], v[220:223]
v_lshlrev_b32 v20, 16, v21
v_and_b32 v21, 0xffff0000, v21
v_mfma_f32_16x16x32_bf16 v[220:223], a[0:3], a[88:91], v[220:223]
s_waitcnt lgkmcnt(4)
v_fmac_f32 v3, v1, v20
v_fmac_f32 v3, v18, v21
L_S21:
v_mfma_f32_16x16x32_bf16 v[24:27], a[96:99], a[32:35], v[24:27]
ds_read_b64_tr_b16 a[88:89], v13 offset:256
s_waitcnt vmcnt(19)
v_mfma_f32_16x16x32_bf16 v[24:27], a[100:103], a[48:51], v[24:27]
ds_read_b64_tr_b16 a[90:91], v13 offset:1280
v_accvgpr_read_b32 v18, a151
v_mfma_f32_16x16x32_bf16 v[32:35], a[100:103], a[52:55], v[32:35]
ds_read_b64_tr_b16 a[92:93], v13 offset:8448
s_add_u32 m0, s17, 0x10c00
v_mfma_f32_16x16x32_bf16 v[32:35], a[96:99], a[36:39], v[32:35]
buffer_load_dwordx4 v6, s[52:55], s13 offen lds
v_mfma_f32_16x16x32_bf16 v[40:43], a[96:99], a[40:43], v[40:43]
ds_read_b64_tr_b16 a[94:95], v13 offset:9472
v_lshlrev_b32 v1, 16, v18
v_mfma_f32_16x16x32_bf16 v[40:43], a[100:103], a[56:59], v[40:43]
ds_read_b128 a[0:3], v8 offset:0
v_and_b32 v18, 0xffff0000, v18
v_mfma_f32_16x16x32_bf16 v[48:51], a[100:103], a[60:63], v[48:51]
ds_read_b128 a[16:19], v9 offset:0
v_accvgpr_read_b32 v21, a135
v_mfma_f32_16x16x32_bf16 v[48:51], a[96:99], a[44:47], v[48:51]
ds_read_b128 a[4:7], v8 offset:2048
v_lshlrev_b32 v20, 16, v21
v_mfma_f32_16x16x32_bf16 v[52:55], a[104:107], a[44:47], v[52:55]
ds_read_b64_tr_b16 a[96:97], v12 offset:512
v_and_b32 v21, 0xffff0000, v21
v_mfma_f32_16x16x32_bf16 v[52:55], a[108:111], a[60:63], v[52:55]
ds_read_b64_tr_b16 a[98:99], v12 offset:1536
v_fmac_f32 v2, v1, v20
v_mfma_f32_16x16x32_bf16 v[44:47], a[108:111], a[56:59], v[44:47]
ds_read_b64_tr_b16 a[100:101], v12 offset:8704
v_fmac_f32 v2, v18, v21
v_mfma_f32_16x16x32_bf16 v[44:47], a[104:107], a[40:43], v[44:47]
ds_read_b64_tr_b16 a[102:103], v12 offset:9728
s_add_u32 m0, s18, 0x14000
v_mfma_f32_16x16x32_bf16 v[36:39], a[104:107], a[36:39], v[36:39]
buffer_load_dwordx4 v7, s[68:71], 0 offen lds
v_mfma_f32_16x16x32_bf16 v[36:39], a[108:111], a[52:55], v[36:39]
ds_read_b128 a[20:23], v9 offset:2048
v_accvgpr_read_b32 v21, a143
v_mfma_f32_16x16x32_bf16 v[28:31], a[108:111], a[48:51], v[28:31]
ds_read_b128 a[8:11], v8 offset:4096
v_lshlrev_b32 v20, 16, v21
v_mfma_f32_16x16x32_bf16 v[28:31], a[104:107], a[32:35], v[28:31]
ds_read_b128 a[24:27], v9 offset:4096
s_waitcnt lgkmcnt(10)
v_mfma_f32_16x16x32_bf16 v[56:59], a[80:83], a[32:35], v[56:59]
ds_read_b64_tr_b16 a[104:105], v13 offset:512
v_and_b32 v21, 0xffff0000, v21
v_mfma_f32_16x16x32_bf16 v[56:59], a[84:87], a[48:51], v[56:59]
ds_read_b64_tr_b16 a[106:107], v13 offset:1536
v_fmac_f32 v3, v1, v20
v_mfma_f32_16x16x32_bf16 v[64:67], a[84:87], a[52:55], v[64:67]
ds_read_b64_tr_b16 a[108:109], v13 offset:8704
v_fmac_f32 v3, v18, v21
v_mfma_f32_16x16x32_bf16 v[64:67], a[80:83], a[36:39], v[64:67]
ds_read_b64_tr_b16 a[110:111], v13 offset:9728
s_add_u32 m0, s18, 0x15000
v_mfma_f32_16x16x32_bf16 v[72:75], a[80:83], a[40:43], v[72:75]
buffer_load_dwordx4 v7, s[68:71], s25 offen lds
v_mfma_f32_16x16x32_bf16 v[72:75], a[84:87], a[56:59], v[72:75]
ds_read_b128 a[12:15], v8 offset:6144
v_add_f32_dpp v2, v2, v2 row_ror:8 row_mask:0xf bank_mask:0xf
v_mfma_f32_16x16x32_bf16 v[80:83], a[84:87], a[60:63], v[80:83]
ds_read_b128 a[28:31], v9 offset:6144
v_add_f32_dpp v3, v3, v3 row_ror:8 row_mask:0xf bank_mask:0xf
v_mfma_f32_16x16x32_bf16 v[80:83], a[80:83], a[44:47], v[80:83]
v_add_f32_dpp v2, v2, v2 row_ror:4 row_mask:0xf bank_mask:0xf
v_add_f32_dpp v3, v3, v3 row_ror:4 row_mask:0xf bank_mask:0xf
v_mfma_f32_16x16x32_bf16 v[84:87], a[88:91], a[44:47], v[84:87]
ds_read_b64_tr_b16 a[80:81], v12 offset:768
v_add_f32_dpp v2, v2, v2 row_ror:2 row_mask:0xf bank_mask:0xf
v_mfma_f32_16x16x32_bf16 v[84:87], a[92:95], a[60:63], v[84:87]
ds_read_b64_tr_b16 a[82:83], v12 offset:1792
v_add_f32_dpp v3, v3, v3 row_ror:2 row_mask:0xf bank_mask:0xf
v_mfma_f32_16x16x32_bf16 v[76:79], a[92:95], a[56:59], v[76:79]
ds_read_b64_tr_b16 a[84:85], v12 offset:8960
v_add_f32_dpp v2, v2, v2 row_ror:1 row_mask:0xf bank_mask:0xf
v_mfma_f32_16x16x32_bf16 v[76:79], a[88:91], a[40:43], v[76:79]
ds_read_b64_tr_b16 a[86:87], v12 offset:9984
v_add_f32_dpp v3, v3, v3 row_ror:1 row_mask:0xf bank_mask:0xf
v_mfma_f32_16x16x32_bf16 v[68:71], a[88:91], a[36:39], v[68:71]
s_add_u32 m0, s18, 0x16000
v_mov_b32 v1, v2
v_mov_b32 v18, v3
v_mfma_f32_16x16x32_bf16 v[68:71], a[92:95], a[52:55], v[68:71]
buffer_load_dwordx4 v7, s[68:71], s26 offen lds
v_mfma_f32_16x16x32_bf16 v[60:63], a[92:95], a[48:51], v[60:63]
v_permlane16_swap_b32 v1, v2
v_permlane16_swap_b32 v18, v3
v_mfma_f32_16x16x32_bf16 v[60:63], a[88:91], a[32:35], v[60:63]
s_waitcnt lgkmcnt(6)
v_add_f32 v2, v2, v1
v_add_f32 v3, v3, v18
v_mfma_f32_16x16x32_bf16 v[88:91], a[96:99], a[32:35], v[88:91]
ds_read_b64_tr_b16 a[88:89], v13 offset:768
v_mov_b32 v1, v2
v_mfma_f32_16x16x32_bf16 v[88:91], a[100:103], a[48:51], v[88:91]
ds_read_b64_tr_b16 a[90:91], v13 offset:1792
v_mov_b32 v18, v3
v_mfma_f32_16x16x32_bf16 v[96:99], a[100:103], a[52:55], v[96:99]
ds_read_b64_tr_b16 a[92:93], v13 offset:8960
v_permlane32_swap_b32 v1, v2
v_mfma_f32_16x16x32_bf16 v[96:99], a[96:99], a[36:39], v[96:99]
ds_read_b64_tr_b16 a[94:95], v13 offset:9984
v_permlane32_swap_b32 v18, v3
v_mfma_f32_16x16x32_bf16 v[104:107], a[96:99], a[40:43], v[104:107]
v_add_f32 v2, v2, v1
v_add_f32 v3, v3, v18
v_mfma_f32_16x16x32_bf16 v[104:107], a[100:103], a[56:59], v[104:107]
buffer_load_dword v23, off, s[84:87], s10 sc1
v_mfma_f32_16x16x32_bf16 v[112:115], a[100:103], a[60:63], v[112:115]
v_mul_f32 v2, 0xbfb8aa3b, v2
v_mul_f32 v3, 0xbfb8aa3b, v3
v_mfma_f32_16x16x32_bf16 v[112:115], a[96:99], a[44:47], v[112:115]
v_exp_f32 v2, v2
v_mfma_f32_16x16x32_bf16 v[116:119], a[104:107], a[44:47], v[116:119]
ds_read_b64_tr_b16 a[96:97], v14 offset:0
v_mfma_f32_16x16x32_bf16 v[116:119], a[108:111], a[60:63], v[116:119]
ds_read_b64_tr_b16 a[98:99], v14 offset:256
v_mfma_f32_16x16x32_bf16 v[108:111], a[108:111], a[56:59], v[108:111]
ds_read_b64_tr_b16 a[100:101], v14 offset:2048
v_mfma_f32_16x16x32_bf16 v[108:111], a[104:107], a[40:43], v[108:111]
ds_read_b64_tr_b16 a[102:103], v14 offset:2304
v_mfma_f32_16x16x32_bf16 v[100:103], a[104:107], a[36:39], v[100:103]
v_exp_f32 v3, v3
v_mfma_f32_16x16x32_bf16 v[100:103], a[108:111], a[52:55], v[100:103]
v_add_f32 v2, 1.0, v2
v_add_f32 v3, 1.0, v3
v_mfma_f32_16x16x32_bf16 v[92:95], a[108:111], a[48:51], v[92:95]
v_rcp_f32 v2, v2
v_mfma_f32_16x16x32_bf16 v[92:95], a[104:107], a[32:35], v[92:95]
s_waitcnt lgkmcnt(4)
v_rcp_f32 v3, v3
v_mfma_f32_16x16x32_bf16 v[120:123], a[80:83], a[32:35], v[120:123]
ds_read_b64_tr_b16 a[104:105], v15 offset:0
v_mfma_f32_16x16x32_bf16 v[120:123], a[84:87], a[48:51], v[120:123]
ds_read_b64_tr_b16 a[106:107], v15 offset:256
v_mfma_f32_16x16x32_bf16 v[128:131], a[84:87], a[52:55], v[128:131]
ds_read_b64_tr_b16 a[108:109], v15 offset:2048
v_mfma_f32_16x16x32_bf16 v[128:131], a[80:83], a[36:39], v[128:131]
ds_read_b64_tr_b16 a[110:111], v15 offset:2304
v_mfma_f32_16x16x32_bf16 v[136:139], a[80:83], a[40:43], v[136:139]
buffer_store_dwordx2 v[2:3], off, s[88:91], s101 sc1
v_mfma_f32_16x16x32_bf16 v[136:139], a[84:87], a[56:59], v[136:139]
v_mfma_f32_16x16x32_bf16 v[144:147], a[84:87], a[60:63], v[144:147]
v_mfma_f32_16x16x32_bf16 v[144:147], a[80:83], a[44:47], v[144:147]
v_mfma_f32_16x16x32_bf16 v[148:151], a[88:91], a[44:47], v[148:151]
ds_read_b64_tr_b16 a[80:81], v14 offset:4096
v_mfma_f32_16x16x32_bf16 v[148:151], a[92:95], a[60:63], v[148:151]
ds_read_b64_tr_b16 a[82:83], v14 offset:4352
v_mfma_f32_16x16x32_bf16 v[140:143], a[92:95], a[56:59], v[140:143]
ds_read_b64_tr_b16 a[84:85], v14 offset:6144
v_mfma_f32_16x16x32_bf16 v[140:143], a[88:91], a[40:43], v[140:143]
ds_read_b64_tr_b16 a[86:87], v14 offset:6400
v_mfma_f32_16x16x32_bf16 v[132:135], a[88:91], a[36:39], v[132:135]
v_mfma_f32_16x16x32_bf16 v[132:135], a[92:95], a[52:55], v[132:135]
v_mfma_f32_16x16x32_bf16 v[124:127], a[92:95], a[48:51], v[124:127]
v_mfma_f32_16x16x32_bf16 v[124:127], a[88:91], a[32:35], v[124:127]
s_waitcnt lgkmcnt(4)
v_mfma_f32_16x16x32_bf16 v[152:155], a[96:99], a[32:35], v[152:155]
ds_read_b64_tr_b16 a[88:89], v15 offset:4096
v_mfma_f32_16x16x32_bf16 v[152:155], a[100:103], a[48:51], v[152:155]
ds_read_b64_tr_b16 a[90:91], v15 offset:4352
v_mfma_f32_16x16x32_bf16 v[160:163], a[100:103], a[52:55], v[160:163]
ds_read_b64_tr_b16 a[92:93], v15 offset:6144
v_mfma_f32_16x16x32_bf16 v[160:163], a[96:99], a[36:39], v[160:163]
ds_read_b64_tr_b16 a[94:95], v15 offset:6400
v_mfma_f32_16x16x32_bf16 v[168:171], a[96:99], a[40:43], v[168:171]
v_mfma_f32_16x16x32_bf16 v[168:171], a[100:103], a[56:59], v[168:171]
v_mfma_f32_16x16x32_bf16 v[176:179], a[100:103], a[60:63], v[176:179]
v_mfma_f32_16x16x32_bf16 v[176:179], a[96:99], a[44:47], v[176:179]
v_mfma_f32_16x16x32_bf16 v[180:183], a[104:107], a[44:47], v[180:183]
ds_read_b64_tr_b16 a[96:97], v14 offset:8192
v_mfma_f32_16x16x32_bf16 v[180:183], a[108:111], a[60:63], v[180:183]
ds_read_b64_tr_b16 a[98:99], v14 offset:8448
v_mfma_f32_16x16x32_bf16 v[172:175], a[108:111], a[56:59], v[172:175]
ds_read_b64_tr_b16 a[100:101], v14 offset:10240
v_mfma_f32_16x16x32_bf16 v[172:175], a[104:107], a[40:43], v[172:175]
ds_read_b64_tr_b16 a[102:103], v14 offset:10496
v_mfma_f32_16x16x32_bf16 v[164:167], a[104:107], a[36:39], v[164:167]
v_mfma_f32_16x16x32_bf16 v[164:167], a[108:111], a[52:55], v[164:167]
v_mfma_f32_16x16x32_bf16 v[156:159], a[108:111], a[48:51], v[156:159]
v_mfma_f32_16x16x32_bf16 v[156:159], a[104:107], a[32:35], v[156:159]
s_waitcnt lgkmcnt(4)
v_mfma_f32_16x16x32_bf16 v[184:187], a[80:83], a[32:35], v[184:187]
ds_read_b64_tr_b16 a[104:105], v15 offset:8192
v_mfma_f32_16x16x32_bf16 v[184:187], a[84:87], a[48:51], v[184:187]
ds_read_b64_tr_b16 a[106:107], v15 offset:8448
v_mfma_f32_16x16x32_bf16 v[192:195], a[84:87], a[52:55], v[192:195]
ds_read_b64_tr_b16 a[108:109], v15 offset:10240
v_mfma_f32_16x16x32_bf16 v[192:195], a[80:83], a[36:39], v[192:195]
ds_read_b64_tr_b16 a[110:111], v15 offset:10496
v_add_u32 v12, 0x8000, v12
v_mfma_f32_16x16x32_bf16 v[200:203], a[80:83], a[40:43], v[200:203]
v_add_u32 v13, 0x8000, v13
v_add_u32 v14, 0x8000, v14
v_mfma_f32_16x16x32_bf16 v[200:203], a[84:87], a[56:59], v[200:203]
v_add_u32 v15, 0x8000, v15
v_mfma_f32_16x16x32_bf16 v[208:211], a[84:87], a[60:63], v[208:211]
v_mfma_f32_16x16x32_bf16 v[208:211], a[80:83], a[44:47], v[208:211]
v_mfma_f32_16x16x32_bf16 v[212:215], a[88:91], a[44:47], v[212:215]
s_waitcnt vmcnt(1) lgkmcnt(0)
s_mov_b32 s92, 200000
L_spin_kv:
v_readfirstlane_b32 s93, v23
s_nop 1
s_cmp_ge_u32 s93, 8
s_cbranch_scc1 L_spun_kv
s_sub_u32 s92, s92, 1
s_cbranch_scc1 L_spun_kv
s_sleep 4
buffer_load_dword v23, off, s[84:87], s10 sc1
s_waitcnt vmcnt(0)
s_branch L_spin_kv
L_spun_kv:
v_mfma_f32_16x16x32_bf16 v[212:215], a[92:95], a[60:63], v[212:215]
s_barrier
s_add_u32 m0, s19, 0x0
v_mfma_f32_16x16x32_bf16 v[204:207], a[92:95], a[56:59], v[204:207]
buffer_load_dwordx4 v16, s[48:51], s32 offen offset:0 sc1 lds
v_mfma_f32_16x16x32_bf16 v[204:207], a[88:91], a[40:43], v[204:207]
ds_read_b64_tr_b16 a[80:81], v12 offset:0
v_mov_b32 v3, v16
v_mfma_f32_16x16x32_bf16 v[196:199], a[88:91], a[36:39], v[196:199]
ds_read_b64_tr_b16 a[82:83], v12 offset:1024
v_mov_b32 v22, 0x3f803f80
v_mfma_f32_16x16x32_bf16 v[196:199], a[92:95], a[52:55], v[196:199]
ds_read_b64_tr_b16 a[84:85], v12 offset:8192
s_mov_b32 s33, 0
v_mfma_f32_16x16x32_bf16 v[188:191], a[92:95], a[48:51], v[188:191]
ds_read_b64_tr_b16 a[86:87], v12 offset:9216
v_accvgpr_write_b32 a240, v22
v_mfma_f32_16x16x32_bf16 v[188:191], a[88:91], a[32:35], v[188:191]
s_waitcnt lgkmcnt(4)
v_accvgpr_write_b32 a241, v22
v_accvgpr_write_b32 a242, v22
v_mfma_f32_16x16x32_bf16 v[216:219], a[32:35], a[96:99], v[216:219]
buffer_load_dwordx4 v16, s[48:51], s32 offen offset:1024 sc1 lds
v_accvgpr_write_b32 a243, v22
v_mfma_f32_16x16x32_bf16 v[216:219], a[48:51], a[100:103], v[216:219]
ds_read_b64_tr_b16 a[88:89], v13 offset:0
s_mov_b32 s36, 0x33333333
v_mfma_f32_16x16x32_bf16 v[224:227], a[52:55], a[100:103], v[224:227]
ds_read_b64_tr_b16 a[90:91], v13 offset:1024
s_mov_b32 s37, 0xcccccccc
v_mfma_f32_16x16x32_bf16 v[224:227], a[36:39], a[96:99], v[224:227]
ds_read_b64_tr_b16 a[92:93], v13 offset:8192
v_cndmask_b32 v4, 0, v22, s[36:37]
v_mfma_f32_16x16x32_bf16 v[232:235], a[40:43], a[96:99], v[232:235]
ds_read_b64_tr_b16 a[94:95], v13 offset:9216
v_accvgpr_write_b32 a232, v4
v_mfma_f32_16x16x32_bf16 v[232:235], a[56:59], a[100:103], v[232:235]
v_accvgpr_write_b32 a233, v4
v_accvgpr_write_b32 a234, v4
v_mfma_f32_16x16x32_bf16 v[240:243], a[60:63], a[100:103], v[240:243]
v_accvgpr_write_b32 a235, v4
v_mfma_f32_16x16x32_bf16 v[240:243], a[44:47], a[96:99], v[240:243]
buffer_load_dwordx4 v16, s[48:51], s32 offen offset:2048 sc1 lds
v_mfma_f32_16x16x32_bf16 v[244:247], a[44:47], a[104:107], v[244:247]
ds_read_b64_tr_b16 a[96:97], v12 offset:256
s_mov_b32 s36, 0x44444444
s_mov_b32 s37, 0x44444444
v_mfma_f32_16x16x32_bf16 v[244:247], a[60:63], a[108:111], v[244:247]
ds_read_b64_tr_b16 a[98:99], v12 offset:1280
v_cndmask_b32 v4, 0, v22, s[36:37]
v_mfma_f32_16x16x32_bf16 v[236:239], a[56:59], a[108:111], v[236:239]
ds_read_b64_tr_b16 a[100:101], v12 offset:8448
v_accvgpr_write_b32 a236, v4
v_mfma_f32_16x16x32_bf16 v[236:239], a[40:43], a[104:107], v[236:239]
ds_read_b64_tr_b16 a[102:103], v12 offset:9472
v_accvgpr_write_b32 a237, v4
v_mfma_f32_16x16x32_bf16 v[228:231], a[36:39], a[104:107], v[228:231]
v_accvgpr_write_b32 a238, v4
v_accvgpr_write_b32 a239, v4
v_mfma_f32_16x16x32_bf16 v[228:231], a[52:55], a[108:111], v[228:231]
v_mov_b32 v1, v3
v_add_u32 v2, 98304, v3
v_mfma_f32_16x16x32_bf16 v[220:223], a[48:51], a[108:111], v[220:223]
buffer_load_dwordx4 v16, s[48:51], s32 offen offset:3072 sc1 lds
v_mfma_f32_16x16x32_bf16 v[220:223], a[32:35], a[104:107], v[220:223]
s_waitcnt lgkmcnt(4)
s_mov_b64 s[34:35], 0
v_accvgpr_write_b32 a224, 0
L_S22:
v_mfma_f32_16x16x32_bf16 v[24:27], a[80:83], a[0:3], v[24:27]
ds_read_b64_tr_b16 a[104:105], v13 offset:256
s_waitcnt vmcnt(13)
v_accvgpr_write_b32 a225, 0
v_mfma_f32_16x16x32_bf16 v[24:27], a[84:87], a[16:19], v[24:27]
ds_read_b64_tr_b16 a[106:107], v13 offset:1280
v_accvgpr_write_b32 a226, 0
v_mfma_f32_16x16x32_bf16 v[32:35], a[84:87], a[20:23], v[32:35]
ds_read_b64_tr_b16 a[108:109], v13 offset:8448
v_accvgpr_write_b32 a227, 0
v_mfma_f32_16x16x32_bf16 v[32:35], a[80:83], a[4:7], v[32:35]
ds_read_b64_tr_b16 a[110:111], v13 offset:9472
v_accvgpr_write_b32 a228, 0
v_mfma_f32_16x16x32_bf16 v[40:43], a[80:83], a[8:11], v[40:43]
ds_read_b128 a[32:35], v8 offset:32768
s_add_u32 m0, s19, 0x1000
v_mfma_f32_16x16x32_bf16 v[40:43], a[84:87], a[24:27], v[40:43]
buffer_load_dwordx4 v16, s[48:51], s7 offen offset:0 sc1 lds
v_mfma_f32_16x16x32_bf16 v[48:51], a[84:87], a[28:31], v[48:51]
ds_read_b128 a[48:51], v9 offset:32768
v_accvgpr_write_b32 a229, 0
v_mfma_f32_16x16x32_bf16 v[48:51], a[80:83], a[12:15], v[48:51]
ds_read_b128 a[36:39], v8 offset:34816
L_padA11:
s_cmp_eq_u32 s95, 1
s_cbranch_scc1 L_hopA_ret
v_accvgpr_write_b32 a230, 0
v_mfma_f32_16x16x32_bf16 v[52:55], a[88:91], a[12:15], v[52:55]
ds_read_b64_tr_b16 a[80:81], v12 offset:512
v_accvgpr_write_b32 a231, 0
v_mfma_f32_16x16x32_bf16 v[52:55], a[92:95], a[28:31], v[52:55]
ds_read_b64_tr_b16 a[82:83], v12 offset:1536
s_mul_i32 s8, s6, 0x142400
v_mfma_f32_16x16x32_bf16 v[44:47], a[92:95], a[24:27], v[44:47]
ds_read_b64_tr_b16 a[84:85], v12 offset:8704
s_sub_u32 s9, 0x12e1c00, s8
v_mfma_f32_16x16x32_bf16 v[44:47], a[88:91], a[8:11], v[44:47]
buffer_load_dwordx4 v16, s[48:51], s7 offen offset:1024 sc1 lds
v_mfma_f32_16x16x32_bf16 v[36:39], a[88:91], a[4:7], v[36:39]
ds_read_b64_tr_b16 a[86:87], v12 offset:9728
s_lshl_b32 s11, s5, 13
v_mfma_f32_16x16x32_bf16 v[36:39], a[92:95], a[20:23], v[36:39]
ds_read_b128 a[52:55], v9 offset:34816
s_add_u32 s11, s11, 0x2200000
v_mfma_f32_16x16x32_bf16 v[28:31], a[92:95], a[16:19], v[28:31]
ds_read_b128 a[40:43], v8 offset:36864
s_add_u32 s8, s8, s11
v_mfma_f32_16x16x32_bf16 v[28:31], a[88:91], a[0:3], v[28:31]
ds_read_b128 a[56:59], v9 offset:36864
s_waitcnt lgkmcnt(10)
v_mfma_f32_16x16x32_bf16 v[56:59], a[96:99], a[0:3], v[56:59]
ds_read_b64_tr_b16 a[88:89], v13 offset:512
s_add_u32 s9, s9, s11
s_lshl_b32 s11, s4, 10
v_mfma_f32_16x16x32_bf16 v[56:59], a[100:103], a[16:19], v[56:59]
ds_read_b64_tr_b16 a[90:91], v13 offset:1536
s_add_u32 s44, s8, s11
v_mfma_f32_16x16x32_bf16 v[64:67], a[100:103], a[20:23], v[64:67]
buffer_load_dwordx4 v16, s[48:51], s7 offen offset:2048 sc1 lds
v_mfma_f32_16x16x32_bf16 v[64:67], a[96:99], a[4:7], v[64:67]
ds_read_b64_tr_b16 a[92:93], v13 offset:8704
s_add_u32 s46, s9, s11
v_mfma_f32_16x16x32_bf16 v[72:75], a[96:99], a[8:11], v[72:75]
ds_read_b64_tr_b16 a[94:95], v13 offset:9728
s_sub_u32 s11, 0x1c00, s11
v_mfma_f32_16x16x32_bf16 v[72:75], a[100:103], a[24:27], v[72:75]
ds_read_b128 a[44:47], v8 offset:38912
s_add_u32 s45, s8, s11
v_mfma_f32_16x16x32_bf16 v[80:83], a[100:103], a[28:31], v[80:83]
ds_read_b128 a[60:63], v9 offset:38912
s_add_u32 s47, s9, s11
v_mfma_f32_16x16x32_bf16 v[80:83], a[96:99], a[12:15], v[80:83]
s_mul_i32 s8, s5, 0x6000
s_add_u32 s8, s8, 0x40000
s_add_u32 s28, s44, s8
v_mfma_f32_16x16x32_bf16 v[84:87], a[104:107], a[12:15], v[84:87]
ds_read_b64_tr_b16 a[96:97], v12 offset:768
s_add_u32 s29, s45, s8
s_add_u32 s30, s46, s8
v_mfma_f32_16x16x32_bf16 v[84:87], a[108:111], a[28:31], v[84:87]
buffer_load_dwordx4 v16, s[48:51], s7 offen offset:3072 sc1 lds
v_mfma_f32_16x16x32_bf16 v[76:79], a[108:111], a[24:27], v[76:79]
ds_read_b64_tr_b16 a[98:99], v12 offset:1792
s_add_u32 s32, s32, s94
v_mfma_f32_16x16x32_bf16 v[76:79], a[104:107], a[8:11], v[76:79]
ds_read_b64_tr_b16 a[100:101], v12 offset:8960
s_add_u32 s7, s7, s94
v_mfma_f32_16x16x32_bf16 v[68:71], a[104:107], a[4:7], v[68:71]
ds_read_b64_tr_b16 a[102:103], v12 offset:9984
s_add_u32 s31, s47, s8
v_mfma_f32_16x16x32_bf16 v[68:71], a[108:111], a[20:23], v[68:71]
s_lshl_b32 s8, s4, 11
s_add_u32 s9, s8, 131072
v_add_u32 v4, s9, v16
v_mfma_f32_16x16x32_bf16 v[60:63], a[108:111], a[16:19], v[60:63]
s_sub_u32 s9, 145408, s8
s_cmp_eq_u32 s4, 0
s_cselect_b32 s8, 131072, s9
v_mfma_f32_16x16x32_bf16 v[60:63], a[104:107], a[0:3], v[60:63]
s_add_u32 m0, s19, 0x18000
s_waitcnt lgkmcnt(6)
v_add_u32 v5, s8, v16
v_mfma_f32_16x16x32_bf16 v[88:91], a[80:83], a[0:3], v[88:91]
buffer_load_dwordx4 v16, s[48:51], s32 offen offset:0 sc1 lds
v_add_u32 v6, s9, v16
v_mfma_f32_16x16x32_bf16 v[88:91], a[84:87], a[16:19], v[88:91]
ds_read_b64_tr_b16 a[104:105], v13 offset:768
v_add_u32 v22, 0x800, v10
v_mfma_f32_16x16x32_bf16 v[96:99], a[84:87], a[20:23], v[96:99]
ds_read_b64_tr_b16 a[106:107], v13 offset:1792
s_mov_b32 s8, 0x800
v_mfma_f32_16x16x32_bf16 v[96:99], a[80:83], a[4:7], v[96:99]
ds_read_b64_tr_b16 a[108:109], v13 offset:8960
v_mfma_f32_16x16x32_bf16 v[104:107], a[80:83], a[8:11], v[104:107]
ds_read_b64_tr_b16 a[110:111], v13 offset:9984
v_mfma_f32_16x16x32_bf16 v[104:107], a[84:87], a[24:27], v[104:107]
s_cmp_eq_u32 s6, 0
s_cselect_b32 s8, 0xffff8800, s8
v_add_u32 v7, s8, v11
v_mfma_f32_16x16x32_bf16 v[112:115], a[84:87], a[28:31], v[112:115]
buffer_load_dwordx4 v16, s[48:51], s32 offen offset:1024 sc1 lds
v_mfma_f32_16x16x32_bf16 v[112:115], a[80:83], a[12:15], v[112:115]
s_bfe_u32 s99, s2, 0x20001
s_lshl_b32 s99, s99, 2
s_lshr_b32 s8, s2, 6
v_mfma_f32_16x16x32_bf16 v[116:119], a[88:91], a[12:15], v[116:119]
ds_read_b64_tr_b16 a[80:81], v14 offset:0
s_add_u32 s99, s99, s8
s_bfe_u32 s100, s2, 0x30003
v_mfma_f32_16x16x32_bf16 v[116:119], a[92:95], a[28:31], v[116:119]
ds_read_b64_tr_b16 a[82:83], v14 offset:256
s_and_b32 s14, s2, 1
v_mfma_f32_16x16x32_bf16 v[108:111], a[92:95], a[24:27], v[108:111]
ds_read_b64_tr_b16 a[84:85], v14 offset:2048
s_sub_u32 s24, 15, s99
v_mfma_f32_16x16x32_bf16 v[108:111], a[88:91], a[8:11], v[108:111]
ds_read_b64_tr_b16 a[86:87], v14 offset:2304
s_min_u32 s18, s24, s99
v_mfma_f32_16x16x32_bf16 v[100:103], a[88:91], a[4:7], v[100:103]
buffer_load_dwordx4 v16, s[48:51], s32 offen offset:2048 sc1 lds
v_mfma_f32_16x16x32_bf16 v[100:103], a[92:95], a[20:23], v[100:103]
s_lshl_b32 s24, s18, 1
s_add_u32 s24, s24, s14
s_lshl_b32 s24, s24, 8
v_mfma_f32_16x16x32_bf16 v[92:95], a[92:95], a[16:19], v[92:95]
s_add_u32 s24, s24, 0x3704000
s_mov_b32 s12, 14336
s_and_b32 s16, s6, 1
v_mfma_f32_16x16x32_bf16 v[92:95], a[88:91], a[0:3], v[92:95]
s_waitcnt lgkmcnt(4)
s_lshl_b32 s16, s16, 15
s_add_u32 s16, s16, 98304
v_mfma_f32_16x16x32_bf16 v[120:123], a[96:99], a[0:3], v[120:123]
ds_read_b64_tr_b16 a[88:89], v15 offset:0
s_add_u32 s16, s16, s17
s_lshl_b32 s13, s4, 15
v_mfma_f32_16x16x32_bf16 v[120:123], a[100:103], a[16:19], v[120:123]
ds_read_b64_tr_b16 a[90:91], v15 offset:256
s_lshl_b32 s9, s100, 8
v_mfma_f32_16x16x32_bf16 v[128:131], a[100:103], a[20:23], v[128:131]
buffer_load_dwordx4 v16, s[48:51], s32 offen offset:3072 sc1 lds
v_mfma_f32_16x16x32_bf16 v[128:131], a[96:99], a[4:7], v[128:131]
ds_read_b64_tr_b16 a[92:93], v15 offset:2048
s_add_u32 s13, s13, s9
v_mfma_f32_16x16x32_bf16 v[136:139], a[96:99], a[8:11], v[136:139]
ds_read_b64_tr_b16 a[94:95], v15 offset:2304
s_mul_i32 s9, s14, 1310848
v_mfma_f32_16x16x32_bf16 v[136:139], a[100:103], a[24:27], v[136:139]
s_add_u32 s13, s13, s9
s_mul_i32 s25, s14, 3407872
s_sub_u32 s25, s25, 1179648
v_mfma_f32_16x16x32_bf16 v[144:147], a[100:103], a[28:31], v[144:147]
s_mul_i32 s101, s99, 0x142400
s_lshl_b32 s8, s4, 11
s_add_u32 s101, s101, s8
v_mfma_f32_16x16x32_bf16 v[144:147], a[96:99], a[12:15], v[144:147]
s_add_u32 m0, s19, 0x19000
s_mul_i32 s8, s14, 163840
s_add_u32 s101, s101, s8
v_mfma_f32_16x16x32_bf16 v[148:151], a[104:107], a[12:15], v[148:151]
buffer_load_dwordx4 v16, s[48:51], s7 offen offset:0 sc1 lds
s_add_u32 s101, s101, 0x21fe000
v_mfma_f32_16x16x32_bf16 v[148:151], a[108:111], a[28:31], v[148:151]
ds_read_b64_tr_b16 a[96:97], v14 offset:4096
s_mul_i32 s26, s14, 425984
v_mfma_f32_16x16x32_bf16 v[140:143], a[108:111], a[24:27], v[140:143]
ds_read_b64_tr_b16 a[98:99], v14 offset:4352
s_add_u32 s26, s26, 106496
v_mfma_f32_16x16x32_bf16 v[140:143], a[104:107], a[8:11], v[140:143]
ds_read_b64_tr_b16 a[100:101], v14 offset:6144
s_mov_b32 s52, 0x3e0293ee
v_mfma_f32_16x16x32_bf16 v[132:135], a[104:107], a[4:7], v[132:135]
ds_read_b64_tr_b16 a[102:103], v14 offset:6400
s_mov_b32 s53, 0x3e0293ee
v_mfma_f32_16x16x32_bf16 v[132:135], a[108:111], a[20:23], v[132:135]
s_mov_b32 s54, 0x3e8293ee
s_or_b32 s55, s6, s4
s_cselect_b32 s55, 0, 0xf149f2ca
v_mfma_f32_16x16x32_bf16 v[124:127], a[108:111], a[16:19], v[124:127]
s_waitcnt lgkmcnt(4)
s_mov_b32 s56, 0x50000
s_mov_b32 s57, 0x5550055
v_mfma_f32_16x16x32_bf16 v[124:127], a[104:107], a[0:3], v[124:127]
buffer_load_dwordx4 v16, s[48:51], s7 offen offset:1024 sc1 lds
v_mfma_f32_16x16x32_bf16 v[152:155], a[80:83], a[0:3], v[152:155]
ds_read_b64_tr_b16 a[104:105], v15 offset:4096
s_mov_b32 s58, 0xa0000
s_mov_b32 s59, 0xaaa00aa
v_mfma_f32_16x16x32_bf16 v[152:155], a[84:87], a[16:19], v[152:155]
ds_read_b64_tr_b16 a[106:107], v15 offset:4352
s_mov_b32 s60, 0x150001
v_mfma_f32_16x16x32_bf16 v[160:163], a[84:87], a[20:23], v[160:163]
ds_read_b64_tr_b16 a[108:109], v15 offset:6144
s_mov_b32 s61, 0x15550155
v_mfma_f32_16x16x32_bf16 v[160:163], a[80:83], a[4:7], v[160:163]
ds_read_b64_tr_b16 a[110:111], v15 offset:6400
s_mov_b32 s62, 0x2a0002
v_mfma_f32_16x16x32_bf16 v[168:171], a[80:83], a[8:11], v[168:171]
s_mov_b32 s63, 0x2aaa02aa
s_mov_b32 s68, 0x55505555
s_mov_b32 s69, 0x50005500
v_mfma_f32_16x16x32_bf16 v[168:171], a[84:87], a[24:27], v[168:171]
buffer_load_dwordx4 v16, s[48:51], s7 offen offset:2048 sc1 lds
v_mfma_f32_16x16x32_bf16 v[176:179], a[84:87], a[28:31], v[176:179]
s_mov_b32 s70, 0xaaa0aaaa
s_mov_b32 s71, 0xa000aa00
s_mov_b32 s76, 0x55405554
v_mfma_f32_16x16x32_bf16 v[176:179], a[80:83], a[12:15], v[176:179]
s_mov_b32 s77, 0x40005400
s_mov_b32 s78, 0xaa80aaa8
s_mov_b32 s79, 0x8000a800
v_mfma_f32_16x16x32_bf16 v[180:183], a[88:91], a[12:15], v[180:183]
ds_read_b64_tr_b16 a[80:81], v14 offset:8192
s_mov_b32 s11, 0xf149f2ca
s_mov_b32 s36, 0xfff0ffff
v_mfma_f32_16x16x32_bf16 v[180:183], a[92:95], a[28:31], v[180:183]
ds_read_b64_tr_b16 a[82:83], v14 offset:8448
s_mov_b32 s37, 0xf000ff00
v_mfma_f32_16x16x32_bf16 v[172:175], a[92:95], a[24:27], v[172:175]
ds_read_b64_tr_b16 a[84:85], v14 offset:10240
s_mov_b32 s38, 0xffe0fffe
v_mfma_f32_16x16x32_bf16 v[172:175], a[88:91], a[8:11], v[172:175]
buffer_load_dwordx4 v16, s[48:51], s7 offen offset:3072 sc1 lds
v_mfma_f32_16x16x32_bf16 v[164:167], a[88:91], a[4:7], v[164:167]
ds_read_b64_tr_b16 a[86:87], v14 offset:10496
s_add_u32 s32, s32, 0x8000
v_mfma_f32_16x16x32_bf16 v[164:167], a[92:95], a[20:23], v[164:167]
s_add_u32 s7, s7, 0x8000
s_mov_b32 s39, 0xe000fe00
s_mov_b32 s40, 0xffc0fffc
v_mfma_f32_16x16x32_bf16 v[156:159], a[92:95], a[16:19], v[156:159]
s_mov_b32 s41, 0xc000fc00
s_mov_b32 s42, 0xff80fff8
s_mov_b32 s43, 0x8000f800
v_mfma_f32_16x16x32_bf16 v[156:159], a[88:91], a[0:3], v[156:159]
s_waitcnt lgkmcnt(4)
v_mov_b32 v21, s1
v_mfma_f32_16x16x32_bf16 v[184:187], a[96:99], a[0:3], v[184:187]
ds_read_b64_tr_b16 a[88:89], v15 offset:8192
v_add_u32 v20, s0, v16
v_mfma_f32_16x16x32_bf16 v[184:187], a[100:103], a[16:19], v[184:187]
global_load_dword a120, v[20:21], off sc1
v_mfma_f32_16x16x32_bf16 v[192:195], a[100:103], a[20:23], v[192:195]
ds_read_b64_tr_b16 a[90:91], v15 offset:8448
v_mfma_f32_16x16x32_bf16 v[192:195], a[96:99], a[4:7], v[192:195]
ds_read_b64_tr_b16 a[92:93], v15 offset:10240
v_mfma_f32_16x16x32_bf16 v[200:203], a[96:99], a[8:11], v[200:203]
ds_read_b64_tr_b16 a[94:95], v15 offset:10496
v_add_u32 v12, 0x8000, v12
v_mfma_f32_16x16x32_bf16 v[200:203], a[100:103], a[24:27], v[200:203]
v_add_u32 v13, 0x8000, v13
v_add_u32 v14, 0x8000, v14
v_mfma_f32_16x16x32_bf16 v[208:211], a[100:103], a[28:31], v[208:211]
v_add_u32 v15, 0x8000, v15
v_mfma_f32_16x16x32_bf16 v[208:211], a[96:99], a[12:15], v[208:211]
s_bitcmp1_b32 s4, 0
s_cselect_b32 s8, 0x7f800000, s11
s_cselect_b32 s9, s11, 0x7f800000
v_mfma_f32_16x16x32_bf16 v[212:215], a[104:107], a[12:15], v[212:215]
s_waitcnt vmcnt(19) lgkmcnt(0)
v_mfma_f32_16x16x32_bf16 v[212:215], a[108:111], a[28:31], v[212:215]
s_barrier
s_add_u32 m0, s19, 0x8000
v_mfma_f32_16x16x32_bf16 v[204:207], a[108:111], a[24:27], v[204:207]
buffer_load_dwordx4 v16, s[48:51], s32 offen offset:0 sc1 lds
v_mfma_f32_16x16x32_bf16 v[204:207], a[104:107], a[8:11], v[204:207]
ds_read_b64_tr_b16 a[96:97], v14 offset:4096
v_mfma_f32_16x16x32_bf16 v[196:199], a[104:107], a[4:7], v[196:199]
ds_read_b64_tr_b16 a[98:99], v14 offset:4352
v_mfma_f32_16x16x32_bf16 v[196:199], a[108:111], a[20:23], v[196:199]
ds_read_b64_tr_b16 a[100:101], v14 offset:6144
v_mfma_f32_16x16x32_bf16 v[188:191], a[108:111], a[16:19], v[188:191]
buffer_load_dwordx4 v16, s[48:51], s32 offen offset:1024 sc1 lds
v_mfma_f32_16x16x32_bf16 v[188:191], a[104:107], a[0:3], v[188:191]
ds_read_b64_tr_b16 a[102:103], v14 offset:6400
s_waitcnt lgkmcnt(4)
v_mfma_f32_16x16x32_bf16 v[216:219], a[0:3], a[80:83], v[216:219]
ds_read_b64_tr_b16 a[104:105], v15 offset:4096
v_mfma_f32_16x16x32_bf16 v[216:219], a[16:19], a[84:87], v[216:219]
ds_read_b64_tr_b16 a[106:107], v15 offset:4352
v_mfma_f32_16x16x32_bf16 v[224:227], a[20:23], a[84:87], v[224:227]
ds_read_b64_tr_b16 a[108:109], v15 offset:6144
v_mfma_f32_16x16x32_bf16 v[224:227], a[4:7], a[80:83], v[224:227]
buffer_store_dwordx4 a[64:67], v16, s[88:91], s15 offen offset:0 sc1
v_mfma_f32_16x16x32_bf16 v[232:235], a[8:11], a[80:83], v[232:235]
ds_read_b64_tr_b16 a[110:111], v15 offset:6400
v_mfma_f32_16x16x32_bf16 v[232:235], a[24:27], a[84:87], v[232:235]
v_mfma_f32_16x16x32_bf16 v[240:243], a[28:31], a[84:87], v[240:243]
v_mfma_f32_16x16x32_bf16 v[240:243], a[12:15], a[80:83], v[240:243]
buffer_load_dwordx4 v16, s[48:51], s32 offen offset:2048 sc1 lds
v_mfma_f32_16x16x32_bf16 v[244:247], a[12:15], a[88:91], v[244:247]
ds_read_b64_tr_b16 a[80:81], v14 offset:8192
v_mfma_f32_16x16x32_bf16 v[244:247], a[28:31], a[92:95], v[244:247]
ds_read_b64_tr_b16 a[82:83], v14 offset:8448
v_mfma_f32_16x16x32_bf16 v[236:239], a[24:27], a[92:95], v[236:239]
ds_read_b64_tr_b16 a[84:85], v14 offset:10240
v_mfma_f32_16x16x32_bf16 v[236:239], a[8:11], a[88:91], v[236:239]
ds_read_b64_tr_b16 a[86:87], v14 offset:10496
v_mfma_f32_16x16x32_bf16 v[228:231], a[4:7], a[88:91], v[228:231]
buffer_load_dwordx4 v16, s[48:51], s32 offen offset:3072 sc1 lds
v_mfma_f32_16x16x32_bf16 v[228:231], a[20:23], a[92:95], v[228:231]
v_mfma_f32_16x16x32_bf16 v[220:223], a[16:19], a[92:95], v[220:223]
v_mfma_f32_16x16x32_bf16 v[220:223], a[0:3], a[88:91], v[220:223]
s_waitcnt lgkmcnt(4)
L_S23:
v_mfma_f32_16x16x32_bf16 v[184:187], a[96:99], a[32:35], v[184:187]
buffer_store_dwordx4 a[64:67], v16, s[88:91], s15 offen offset:1024 sc1
v_mov_b32 v8, v19
v_mfma_f32_16x16x32_bf16 v[184:187], a[100:103], a[48:51], v[184:187]
ds_read_b64_tr_b16 a[88:89], v15 offset:8192
v_mov_b32 v9, 0xf149f2ca
v_mfma_f32_16x16x32_bf16 v[192:195], a[100:103], a[52:55], v[192:195]
ds_read_b64_tr_b16 a[90:91], v15 offset:8448
v_mov_b32 v248, 0xffff
v_mfma_f32_16x16x32_bf16 v[192:195], a[96:99], a[36:39], v[192:195]
ds_read_b64_tr_b16 a[92:93], v15 offset:10240
v_mov_b32 v249, 0xffff0000
v_mfma_f32_16x16x32_bf16 v[200:203], a[96:99], a[40:43], v[200:203]
ds_read_b64_tr_b16 a[94:95], v15 offset:10496
s_add_u32 m0, s19, 0x9000
v_cndmask_b32 v252, 0, v248, s[56:57]
v_mfma_f32_16x16x32_bf16 v[200:203], a[100:103], a[56:59], v[200:203]
buffer_load_dwordx4 v16, s[48:51], s7 offen offset:0 sc1 lds
v_mfma_f32_16x16x32_bf16 v[208:211], a[100:103], a[60:63], v[208:211]
v_cndmask_b32 v252, v252, v249, s[58:59]
v_cndmask_b32 v253, 0, v248, s[60:61]
v_mfma_f32_16x16x32_bf16 v[208:211], a[96:99], a[44:47], v[208:211]
v_cndmask_b32 v253, v253, v249, s[62:63]
v_cndmask_b32 v254, 0, v248, s[68:69]
v_mfma_f32_16x16x32_bf16 v[212:215], a[104:107], a[44:47], v[212:215]
ds_read_b64_tr_b16 a[96:97], v14 offset:0
v_cndmask_b32 v254, v254, v249, s[70:71]
v_cndmask_b32 v255, 0, v248, s[76:77]
v_mfma_f32_16x16x32_bf16 v[212:215], a[108:111], a[60:63], v[212:215]
buffer_load_dwordx4 v16, s[48:51], s7 offen offset:1024 sc1 lds
v_mfma_f32_16x16x32_bf16 v[204:207], a[108:111], a[56:59], v[204:207]
ds_read_b64_tr_b16 a[98:99], v14 offset:256
v_cndmask_b32 v255, v255, v249, s[78:79]
v_mfma_f32_16x16x32_bf16 v[204:207], a[104:107], a[40:43], v[204:207]
ds_read_b64_tr_b16 a[100:101], v14 offset:2048
v_cndmask_b32 v248, v9, 0, s[68:69]
v_mfma_f32_16x16x32_bf16 v[196:199], a[104:107], a[36:39], v[196:199]
ds_read_b64_tr_b16 a[102:103], v14 offset:2304
v_cndmask_b32 v249, v9, 0, s[70:71]
v_cndmask_b32 v250, v9, 0, s[76:77]
v_mfma_f32_16x16x32_bf16 v[196:199], a[108:111], a[52:55], v[196:199]
v_cndmask_b32 v251, v9, 0, s[78:79]
v_mfma_f32_16x16x32_bf16 v[188:191], a[108:111], a[48:51], v[188:191]
buffer_store_dwordx4 a[64:67], v16, s[88:91], s15 offen offset:2048 sc1
v_mfma_f32_16x16x32_bf16 v[188:191], a[104:107], a[32:35], v[188:191]
s_waitcnt lgkmcnt(4)
v_mfma_f32_16x16x32_bf16 v[216:219], a[32:35], a[80:83], v[216:219]
ds_read_b64_tr_b16 a[104:105], v15 offset:0
v_mfma_f32_16x16x32_bf16 v[216:219], a[48:51], a[84:87], v[216:219]
ds_read_b64_tr_b16 a[106:107], v15 offset:256
v_mfma_f32_16x16x32_bf16 v[224:227], a[52:55], a[84:87], v[224:227]
buffer_load_dwordx4 v16, s[48:51], s7 offen offset:2048 sc1 lds
v_mfma_f32_16x16x32_bf16 v[224:227], a[36:39], a[80:83], v[224:227]
ds_read_b64_tr_b16 a[108:109], v15 offset:2048
v_cvt_pk_bf16_f32 v192, v192, v193
v_mfma_f32_16x16x32_bf16 v[232:235], a[40:43], a[80:83], v[232:235]
ds_read_b64_tr_b16 a[110:111], v15 offset:2304
v_cvt_pk_bf16_f32 v193, v194, v195
v_cvt_pk_bf16_f32 v194, v196, v197
v_mfma_f32_16x16x32_bf16 v[232:235], a[56:59], a[84:87], v[232:235]
v_cvt_pk_bf16_f32 v195, v198, v199
v_cvt_pk_bf16_f32 v208, v208, v209
v_mfma_f32_16x16x32_bf16 v[240:243], a[60:63], a[84:87], v[240:243]
v_cvt_pk_bf16_f32 v209, v210, v211
v_cvt_pk_bf16_f32 v210, v212, v213
v_mfma_f32_16x16x32_bf16 v[240:243], a[44:47], a[80:83], v[240:243]
buffer_load_dwordx4 v16, s[48:51], s7 offen offset:3072 sc1 lds
v_mfma_f32_16x16x32_bf16 v[244:247], a[44:47], a[88:91], v[244:247]
ds_read_b64_tr_b16 a[80:81], v12 offset:0
s_add_u32 s32, s32, 0x8000
v_cvt_pk_bf16_f32 v211, v214, v215
v_mfma_f32_16x16x32_bf16 v[244:247], a[60:63], a[92:95], v[244:247]
ds_read_b64_tr_b16 a[82:83], v12 offset:1024
s_add_u32 s7, s7, 0x8000
v_mfma_f32_16x16x32_bf16 v[236:239], a[56:59], a[92:95], v[236:239]
ds_read_b64_tr_b16 a[84:85], v12 offset:8192
v_mfma_f32_16x16x32_bf16 v[236:239], a[40:43], a[88:91], v[236:239]
buffer_store_dwordx4 a[64:67], v16, s[88:91], s15 offen offset:3072 sc1
v_mfma_f32_16x16x32_bf16 v[228:231], a[36:39], a[88:91], v[228:231]
ds_read_b64_tr_b16 a[86:87], v12 offset:9216
v_mfma_f32_16x16x32_bf16 v[228:231], a[52:55], a[92:95], v[228:231]
s_cmp_lg_u32 s4, 0
s_cbranch_scc1 L_hx0
buffer_store_dwordx4 v[192:195], v22, s[88:91], 0 offen offset:0 sc1
buffer_store_dwordx4 v[208:211], v7, s[88:91], 0 offen offset:0 sc1
L_hx0:
v_mfma_f32_16x16x32_bf16 v[220:223], a[48:51], a[92:95], v[220:223]
v_cvt_pk_bf16_f32 v184, v184, v185
v_cvt_pk_bf16_f32 v185, v186, v187
v_mfma_f32_16x16x32_bf16 v[220:223], a[32:35], a[88:91], v[220:223]
s_waitcnt lgkmcnt(4)
v_cvt_pk_bf16_f32 v186, v188, v189
v_cvt_pk_bf16_f32 v187, v190, v191
v_mfma_f32_16x16x32_bf16 v[152:155], a[96:99], a[32:35], v[152:155]
ds_read_b64_tr_b16 a[88:89], v13 offset:0
v_cvt_pk_bf16_f32 v200, v200, v201
v_cvt_pk_bf16_f32 v201, v202, v203
v_mfma_f32_16x16x32_bf16 v[152:155], a[100:103], a[48:51], v[152:155]
ds_read_b64_tr_b16 a[90:91], v13 offset:1024
v_cvt_pk_bf16_f32 v202, v204, v205
v_mfma_f32_16x16x32_bf16 v[160:163], a[100:103], a[52:55], v[160:163]
ds_read_b64_tr_b16 a[92:93], v13 offset:8192
v_cvt_pk_bf16_f32 v203, v206, v207
v_mfma_f32_16x16x32_bf16 v[160:163], a[96:99], a[36:39], v[160:163]
ds_read_b64_tr_b16 a[94:95], v13 offset:9216
v_mfma_f32_16x16x32_bf16 v[168:171], a[96:99], a[40:43], v[168:171]
ds_write_b128 v5, v[192:195] offset:2048
v_mfma_f32_16x16x32_bf16 v[168:171], a[100:103], a[56:59], v[168:171]
ds_write_b128 v5, v[208:211] offset:18432
v_mfma_f32_16x16x32_bf16 v[176:179], a[100:103], a[60:63], v[176:179]
ds_write_b128 v4, v[184:187] offset:2048
v_mfma_f32_16x16x32_bf16 v[176:179], a[96:99], a[44:47], v[176:179]
ds_write_b128 v4, v[200:203] offset:18432
v_mfma_f32_16x16x32_bf16 v[180:183], a[104:107], a[44:47], v[180:183]
ds_read_b64_tr_b16 a[96:97], v12 offset:256
v_cvt_pk_bf16_f32 v231, v230, v231
v_cvt_pk_bf16_f32 v230, v228, v229
v_mfma_f32_16x16x32_bf16 v[180:183], a[108:111], a[60:63], v[180:183]
ds_read_b64_tr_b16 a[98:99], v12 offset:1280
v_cvt_pk_bf16_f32 v228, v224, v225
v_mfma_f32_16x16x32_bf16 v[172:175], a[108:111], a[56:59], v[172:175]
ds_read_b64_tr_b16 a[100:101], v12 offset:8448
v_cvt_pk_bf16_f32 v229, v226, v227
v_mfma_f32_16x16x32_bf16 v[172:175], a[104:107], a[40:43], v[172:175]
ds_read_b64_tr_b16 a[102:103], v12 offset:9472
v_cvt_pk_bf16_f32 v227, v226, v227
v_mfma_f32_16x16x32_bf16 v[164:167], a[104:107], a[36:39], v[164:167]
v_cvt_pk_bf16_f32 v226, v224, v225
v_cvt_pk_bf16_f32 v247, v246, v247
v_cvt_pk_bf16_f32 v246, v244, v245
v_mfma_f32_16x16x32_bf16 v[164:167], a[108:111], a[52:55], v[164:167]
v_cvt_pk_bf16_f32 v244, v240, v241
v_cvt_pk_bf16_f32 v245, v242, v243
v_mfma_f32_16x16x32_bf16 v[156:159], a[108:111], a[48:51], v[156:159]
v_cvt_pk_bf16_f32 v243, v242, v243
v_cvt_pk_bf16_f32 v242, v240, v241
v_mfma_f32_16x16x32_bf16 v[156:159], a[104:107], a[32:35], v[156:159]
s_waitcnt lgkmcnt(4)
v_mfma_f32_16x16x32_bf16 v[24:27], a[80:83], a[32:35], v[24:27]
ds_read_b64_tr_b16 a[104:105], v13 offset:256
v_mfma_f32_16x16x32_bf16 v[24:27], a[84:87], a[48:51], v[24:27]
ds_read_b64_tr_b16 a[106:107], v13 offset:1280
v_mfma_f32_16x16x32_bf16 v[32:35], a[84:87], a[52:55], v[32:35]
ds_read_b64_tr_b16 a[108:109], v13 offset:8448
v_mfma_f32_16x16x32_bf16 v[32:35], a[80:83], a[36:39], v[32:35]
ds_read_b64_tr_b16 a[110:111], v13 offset:9472
v_mfma_f32_16x16x32_bf16 v[40:43], a[80:83], a[40:43], v[40:43]
s_cmp_lg_u32 s4, 0
s_cbranch_scc1 L_hx1
buffer_store_dwordx4 v[228:231], v22, s[88:91], 0 offen offset:1024 sc1
buffer_store_dwordx4 v[244:247], v7, s[88:91], 0 offen offset:1024 sc1
L_hx1:
v_mfma_f32_16x16x32_bf16 v[40:43], a[84:87], a[56:59], v[40:43]
v_cvt_pk_bf16_f32 v223, v222, v223
v_cvt_pk_bf16_f32 v222, v220, v221
v_mfma_f32_16x16x32_bf16 v[48:51], a[84:87], a[60:63], v[48:51]
v_cvt_pk_bf16_f32 v220, v216, v217
v_cvt_pk_bf16_f32 v221, v218, v219
v_mfma_f32_16x16x32_bf16 v[48:51], a[80:83], a[44:47], v[48:51]
v_cvt_pk_bf16_f32 v219, v218, v219
v_cvt_pk_bf16_f32 v218, v216, v217
v_mfma_f32_16x16x32_bf16 v[52:55], a[88:91], a[44:47], v[52:55]
ds_read_b64_tr_b16 a[80:81], v12 offset:512
v_cvt_pk_bf16_f32 v239, v238, v239
v_cvt_pk_bf16_f32 v238, v236, v237
v_mfma_f32_16x16x32_bf16 v[52:55], a[92:95], a[60:63], v[52:55]
ds_read_b64_tr_b16 a[82:83], v12 offset:1536
v_cvt_pk_bf16_f32 v236, v232, v233
v_mfma_f32_16x16x32_bf16 v[44:47], a[92:95], a[56:59], v[44:47]
ds_read_b64_tr_b16 a[84:85], v12 offset:8704
v_cvt_pk_bf16_f32 v237, v234, v235
v_mfma_f32_16x16x32_bf16 v[44:47], a[88:91], a[40:43], v[44:47]
ds_read_b64_tr_b16 a[86:87], v12 offset:9728
v_cvt_pk_bf16_f32 v235, v234, v235
v_mfma_f32_16x16x32_bf16 v[36:39], a[88:91], a[36:39], v[36:39]
v_cvt_pk_bf16_f32 v234, v232, v233
v_mfma_f32_16x16x32_bf16 v[36:39], a[92:95], a[52:55], v[36:39]
ds_write_b128 v5, v[228:231] offset:3072
v_mfma_f32_16x16x32_bf16 v[28:31], a[92:95], a[48:51], v[28:31]
ds_write_b128 v5, v[244:247] offset:19456
v_mfma_f32_16x16x32_bf16 v[28:31], a[88:91], a[32:35], v[28:31]
s_waitcnt lgkmcnt(4)
v_mfma_f32_16x16x32_bf16 v[56:59], a[96:99], a[32:35], v[56:59]
ds_read_b64_tr_b16 a[88:89], v13 offset:512
v_mfma_f32_16x16x32_bf16 v[56:59], a[100:103], a[48:51], v[56:59]
ds_read_b64_tr_b16 a[90:91], v13 offset:1536
v_mfma_f32_16x16x32_bf16 v[64:67], a[100:103], a[52:55], v[64:67]
ds_read_b64_tr_b16 a[92:93], v13 offset:8704
v_mfma_f32_16x16x32_bf16 v[64:67], a[96:99], a[36:39], v[64:67]
ds_read_b64_tr_b16 a[94:95], v13 offset:9728
v_mfma_f32_16x16x32_bf16 v[72:75], a[96:99], a[40:43], v[72:75]
ds_write_b128 v4, v[220:223] offset:3072
v_mfma_f32_16x16x32_bf16 v[72:75], a[100:103], a[56:59], v[72:75]
ds_write_b128 v4, v[236:239] offset:19456
v_mfma_f32_16x16x32_bf16 v[80:83], a[100:103], a[60:63], v[80:83]
v_cvt_pk_bf16_f32 v152, v152, v153
v_cvt_pk_bf16_f32 v153, v154, v155
v_mfma_f32_16x16x32_bf16 v[80:83], a[96:99], a[44:47], v[80:83]
v_cvt_pk_bf16_f32 v154, v156, v157
v_cvt_pk_bf16_f32 v155, v158, v159
v_mfma_f32_16x16x32_bf16 v[84:87], a[104:107], a[44:47], v[84:87]
ds_read_b64_tr_b16 a[96:97], v12 offset:768
v_cvt_pk_bf16_f32 v160, v160, v161
v_cvt_pk_bf16_f32 v161, v162, v163
v_mfma_f32_16x16x32_bf16 v[84:87], a[108:111], a[60:63], v[84:87]
ds_read_b64_tr_b16 a[98:99], v12 offset:1792
v_cvt_pk_bf16_f32 v162, v164, v165
v_mfma_f32_16x16x32_bf16 v[76:79], a[108:111], a[56:59], v[76:79]
ds_read_b64_tr_b16 a[100:101], v12 offset:8960
v_cvt_pk_bf16_f32 v163, v166, v167
v_mfma_f32_16x16x32_bf16 v[76:79], a[104:107], a[40:43], v[76:79]
ds_read_b64_tr_b16 a[102:103], v12 offset:9984
v_cvt_pk_bf16_f32 v168, v168, v169
v_mfma_f32_16x16x32_bf16 v[68:71], a[104:107], a[36:39], v[68:71]
v_cvt_pk_bf16_f32 v169, v170, v171
v_cvt_pk_bf16_f32 v170, v172, v173
v_cvt_pk_bf16_f32 v171, v174, v175
v_mfma_f32_16x16x32_bf16 v[68:71], a[108:111], a[52:55], v[68:71]
v_cvt_pk_bf16_f32 v176, v176, v177
v_cvt_pk_bf16_f32 v177, v178, v179
v_mfma_f32_16x16x32_bf16 v[60:63], a[108:111], a[48:51], v[60:63]
v_cvt_pk_bf16_f32 v178, v180, v181
v_cvt_pk_bf16_f32 v179, v182, v183
v_mfma_f32_16x16x32_bf16 v[60:63], a[104:107], a[32:35], v[60:63]
s_waitcnt lgkmcnt(4)
v_mfma_f32_16x16x32_bf16 v[88:91], a[80:83], a[32:35], v[88:91]
ds_read_b64_tr_b16 a[104:105], v13 offset:768
v_mfma_f32_16x16x32_bf16 v[88:91], a[84:87], a[48:51], v[88:91]
ds_read_b64_tr_b16 a[106:107], v13 offset:1792
v_mfma_f32_16x16x32_bf16 v[96:99], a[84:87], a[52:55], v[96:99]
ds_read_b64_tr_b16 a[108:109], v13 offset:8960
v_mfma_f32_16x16x32_bf16 v[96:99], a[80:83], a[36:39], v[96:99]
ds_read_b64_tr_b16 a[110:111], v13 offset:9984
v_mfma_f32_16x16x32_bf16 v[104:107], a[80:83], a[40:43], v[104:107]
v_mfma_f32_16x16x32_bf16 v[104:107], a[84:87], a[56:59], v[104:107]
v_mfma_f32_16x16x32_bf16 v[112:115], a[84:87], a[60:63], v[112:115]
v_mfma_f32_16x16x32_bf16 v[112:115], a[80:83], a[44:47], v[112:115]
v_mfma_f32_16x16x32_bf16 v[116:119], a[88:91], a[44:47], v[116:119]
v_mfma_f32_16x16x32_bf16 v[116:119], a[92:95], a[60:63], v[116:119]
v_mfma_f32_16x16x32_bf16 v[108:111], a[92:95], a[56:59], v[108:111]
v_mfma_f32_16x16x32_bf16 v[108:111], a[88:91], a[40:43], v[108:111]
v_mov_b32 v15, s6
v_xor_b32 v15, 0, v15
v_mfma_f32_16x16x32_bf16 v[100:103], a[88:91], a[36:39], v[100:103]
v_writelane_b32 v15, s18, 0
v_lshlrev_b32 v15, 2, v15
v_bfe_u32 v12, v0, 2, 2
v_mfma_f32_16x16x32_bf16 v[100:103], a[92:95], a[52:55], v[100:103]
L_padA12:
s_cmp_eq_u32 s95, 1
s_cbranch_scc1 L_hopA_ret
v_lshlrev_b32 v12, 11, v12
v_lshrrev_b32 v13, 4, v0
v_mfma_f32_16x16x32_bf16 v[92:95], a[92:95], a[48:51], v[92:95]
v_lshl_add_u32 v12, v13, 6, v12
v_and_b32 v13, 3, v0
v_mfma_f32_16x16x32_bf16 v[92:95], a[88:91], a[32:35], v[92:95]
s_waitcnt lgkmcnt(0)
v_lshl_add_u32 v12, v13, 4, v12
v_xor_b32 v12, s13, v12
v_mfma_f32_16x16x32_bf16 v[120:123], a[96:99], a[32:35], v[120:123]
v_xor_b32 v13, 32, v12
v_add_u32 v13, 7168, v13
v_mul_f32 v24, s52, v24
v_mfma_f32_16x16x32_bf16 v[120:123], a[100:103], a[48:51], v[120:123]
v_mul_f32 v25, s52, v25
v_mul_f32 v26, s52, v26
v_mfma_f32_16x16x32_bf16 v[128:131], a[100:103], a[52:55], v[128:131]
v_mul_f32 v27, s52, v27
v_mul_f32 v28, s52, v28
v_mfma_f32_16x16x32_bf16 v[128:131], a[96:99], a[36:39], v[128:131]
v_mul_f32 v29, s52, v29
v_mul_f32 v30, s52, v30
v_mfma_f32_16x16x32_bf16 v[136:139], a[96:99], a[40:43], v[136:139]
v_mul_f32 v31, s52, v31
v_cvt_pk_bf16_f32 v24, v24, v25
v_cvt_pk_bf16_f32 v25, v26, v27
v_mfma_f32_16x16x32_bf16 v[136:139], a[100:103], a[56:59], v[136:139]
v_cvt_pk_bf16_f32 v26, v28, v29
v_cvt_pk_bf16_f32 v27, v30, v31
v_mfma_f32_16x16x32_bf16 v[144:147], a[100:103], a[60:63], v[144:147]
v_accvgpr_write_b32 a160, v24
v_accvgpr_write_b32 a161, v25
v_mfma_f32_16x16x32_bf16 v[144:147], a[96:99], a[44:47], v[144:147]
v_accvgpr_write_b32 a162, v26
v_accvgpr_write_b32 a163, v27
v_mfma_f32_16x16x32_bf16 v[148:151], a[104:107], a[44:47], v[148:151]
v_mul_f32 v32, s52, v32
v_mul_f32 v33, s52, v33
v_mul_f32 v34, s52, v34
v_mfma_f32_16x16x32_bf16 v[148:151], a[108:111], a[60:63], v[148:151]
v_mul_f32 v35, s52, v35
v_mul_f32 v36, s52, v36
v_mfma_f32_16x16x32_bf16 v[140:143], a[108:111], a[56:59], v[140:143]
v_mul_f32 v37, s52, v37
v_mul_f32 v38, s52, v38
v_mfma_f32_16x16x32_bf16 v[140:143], a[104:107], a[40:43], v[140:143]
v_mul_f32 v39, s52, v39
v_cvt_pk_bf16_f32 v32, v32, v33
v_mfma_f32_16x16x32_bf16 v[132:135], a[104:107], a[36:39], v[132:135]
v_cvt_pk_bf16_f32 v33, v34, v35
v_cvt_pk_bf16_f32 v34, v36, v37
v_cvt_pk_bf16_f32 v35, v38, v39
v_mfma_f32_16x16x32_bf16 v[132:135], a[108:111], a[52:55], v[132:135]
v_accvgpr_write_b32 a176, v32
v_accvgpr_write_b32 a177, v33
v_mfma_f32_16x16x32_bf16 v[124:127], a[108:111], a[48:51], v[124:127]
v_accvgpr_write_b32 a178, v34
v_accvgpr_write_b32 a179, v35
v_mfma_f32_16x16x32_bf16 v[124:127], a[104:107], a[32:35], v[124:127]
L_trans:
s_waitcnt vmcnt(21) lgkmcnt(0)
s_barrier
s_cmp_eq_u32 s4, 0
s_cbranch_scc1 L_hx_ld
ds_read_b128 v[188:191], v4 offset:0
ds_read_b64 v[216:217], v4 offset:1024
ds_read_b64 v[220:221], v4 offset:1032
ds_read_b128 v[204:207], v4 offset:16384
ds_read_b64 v[232:233], v4 offset:17408
ds_read_b64 v[236:237], v4 offset:17416
s_branch L_hx_rd
L_hx_ld:
buffer_load_dwordx4 v[188:191], v10, s[88:91], 0 offen sc1
buffer_load_dwordx2 v[216:217], v10, s[88:91], 0 offen offset:1024 sc1
buffer_load_dwordx2 v[220:221], v10, s[88:91], 0 offen offset:1032 sc1
buffer_load_dwordx4 v[204:207], v11, s[88:91], 0 offen sc1
buffer_load_dwordx2 v[232:233], v11, s[88:91], 0 offen offset:1024 sc1
buffer_load_dwordx2 v[236:237], v11, s[88:91], 0 offen offset:1032 sc1
L_hx_rd:
ds_read_b128 v[196:199], v6 offset:0
ds_read_b64 v[224:225], v6 offset:1024
ds_read_b64 v[228:229], v6 offset:1032
ds_read_b128 v[212:215], v6 offset:16384
ds_read_b64 v[240:241], v6 offset:17408
ds_read_b64 v[244:245], v6 offset:17416
ds_read_b128 a[0:3], v1 offset:8192
ds_read_b128 a[4:7], v1 offset:9216
ds_read_b128 a[8:11], v1 offset:10240
ds_read_b128 a[12:15], v1 offset:11264
ds_read_b128 a[16:19], v1 offset:12288
ds_read_b128 a[20:23], v1 offset:13312
ds_read_b128 a[24:27], v1 offset:14336
ds_read_b128 a[28:31], v1 offset:15360
L_hopB:
s_mov_b32 s95, 0
v_pk_mul_f32 v[40:41], v[40:41], s[52:53]
v_pk_mul_f32 v[42:43], v[42:43], s[52:53]
v_pk_mul_f32 v[44:45], v[44:45], s[52:53]
v_pk_mul_f32 v[46:47], v[46:47], s[52:53]
v_cvt_pk_bf16_f32 v40, v40, v41
v_cvt_pk_bf16_f32 v41, v42, v43
v_cvt_pk_bf16_f32 v42, v44, v45
v_cvt_pk_bf16_f32 v43, v46, v47
v_accvgpr_write_b32 a192, v40
v_accvgpr_write_b32 a193, v41
v_accvgpr_write_b32 a194, v42
v_accvgpr_write_b32 a195, v43
v_pk_mul_f32 v[48:49], v[48:49], s[52:53]
v_pk_mul_f32 v[50:51], v[50:51], s[52:53]
v_pk_mul_f32 v[52:53], v[52:53], s[52:53]
v_pk_mul_f32 v[54:55], v[54:55], s[52:53]
v_cvt_pk_bf16_f32 v48, v48, v49
v_cvt_pk_bf16_f32 v49, v50, v51
v_cvt_pk_bf16_f32 v50, v52, v53
v_cvt_pk_bf16_f32 v51, v54, v55
v_accvgpr_write_b32 a208, v48
v_accvgpr_write_b32 a209, v49
v_accvgpr_write_b32 a210, v50
v_accvgpr_write_b32 a211, v51
v_mov_b32 v47, s55
v_cndmask_b32 v36, v9, 0, s[56:57]
v_min_f32 v32, s55, v36
v_cndmask_b32 v44, v47, 0, s[36:37]
v_cndmask_b32 v37, v9, 0, s[58:59]
v_min_f32 v33, s55, v37
v_cndmask_b32 v45, v47, 0, s[38:39]
v_cndmask_b32 v38, v9, 0, s[60:61]
v_min_f32 v34, s55, v38
v_cndmask_b32 v46, v47, 0, s[40:41]
v_cndmask_b32 v39, v9, 0, s[62:63]
v_min_f32 v35, s55, v39
v_cndmask_b32 v47, v47, 0, s[42:43]
v_pk_mul_f32 v[56:57], v[56:57], s[52:53]
v_pk_mul_f32 v[58:59], v[58:59], s[52:53]
v_pk_mul_f32 v[60:61], v[60:61], s[52:53]
v_pk_mul_f32 v[62:63], v[62:63], s[52:53]
v_cvt_pk_bf16_f32 v56, v56, v57
v_cvt_pk_bf16_f32 v57, v58, v59
v_cvt_pk_bf16_f32 v58, v60, v61
v_cvt_pk_bf16_f32 v59, v62, v63
v_accvgpr_write_b32 a164, v56
v_accvgpr_write_b32 a165, v57
v_accvgpr_write_b32 a166, v58
v_accvgpr_write_b32 a167, v59
v_pk_mul_f32 v[64:65], v[64:65], s[52:53]
v_pk_mul_f32 v[66:67], v[66:67], s[52:53]
v_pk_mul_f32 v[68:69], v[68:69], s[52:53]
v_pk_mul_f32 v[70:71], v[70:71], s[52:53]
v_cvt_pk_bf16_f32 v64, v64, v65
v_cvt_pk_bf16_f32 v65, v66, v67
v_cvt_pk_bf16_f32 v66, v68, v69
v_cvt_pk_bf16_f32 v67, v70, v71
v_accvgpr_write_b32 a180, v64
v_accvgpr_write_b32 a181, v65
v_accvgpr_write_b32 a182, v66
v_accvgpr_write_b32 a183, v67
v_pk_mul_f32 v[72:73], v[72:73], s[52:53]
v_pk_mul_f32 v[74:75], v[74:75], s[52:53]
v_pk_mul_f32 v[76:77], v[76:77], s[52:53]
v_pk_mul_f32 v[78:79], v[78:79], s[52:53]
v_cvt_pk_bf16_f32 v72, v72, v73
v_cvt_pk_bf16_f32 v73, v74, v75
v_cvt_pk_bf16_f32 v74, v76, v77
v_cvt_pk_bf16_f32 v75, v78, v79
v_accvgpr_write_b32 a196, v72
v_accvgpr_write_b32 a197, v73
v_accvgpr_write_b32 a198, v74
v_accvgpr_write_b32 a199, v75
v_pk_mul_f32 v[80:81], v[80:81], s[52:53]
v_pk_mul_f32 v[82:83], v[82:83], s[52:53]
v_pk_mul_f32 v[84:85], v[84:85], s[52:53]
v_pk_mul_f32 v[86:87], v[86:87], s[52:53]
v_cvt_pk_bf16_f32 v80, v80, v81
v_cvt_pk_bf16_f32 v81, v82, v83
v_cvt_pk_bf16_f32 v82, v84, v85
v_cvt_pk_bf16_f32 v83, v86, v87
v_accvgpr_write_b32 a212, v80
v_accvgpr_write_b32 a213, v81
v_accvgpr_write_b32 a214, v82
v_accvgpr_write_b32 a215, v83
v_pk_mul_f32 v[88:89], v[88:89], s[52:53]
v_pk_mul_f32 v[90:91], v[90:91], s[52:53]
v_pk_mul_f32 v[92:93], v[92:93], s[52:53]
v_pk_mul_f32 v[94:95], v[94:95], s[52:53]
v_cvt_pk_bf16_f32 v88, v88, v89
v_cvt_pk_bf16_f32 v89, v90, v91
v_cvt_pk_bf16_f32 v90, v92, v93
v_cvt_pk_bf16_f32 v91, v94, v95
v_accvgpr_write_b32 a168, v88
v_accvgpr_write_b32 a169, v89
v_accvgpr_write_b32 a170, v90
v_accvgpr_write_b32 a171, v91
v_pk_mul_f32 v[96:97], v[96:97], s[52:53]
v_pk_mul_f32 v[98:99], v[98:99], s[52:53]
v_pk_mul_f32 v[100:101], v[100:101], s[52:53]
v_pk_mul_f32 v[102:103], v[102:103], s[52:53]
v_cvt_pk_bf16_f32 v96, v96, v97
v_cvt_pk_bf16_f32 v97, v98, v99
v_cvt_pk_bf16_f32 v98, v100, v101
v_cvt_pk_bf16_f32 v99, v102, v103
v_accvgpr_write_b32 a184, v96
v_accvgpr_write_b32 a185, v97
v_accvgpr_write_b32 a186, v98
v_accvgpr_write_b32 a187, v99
v_pk_mul_f32 v[104:105], v[104:105], s[52:53]
v_pk_mul_f32 v[106:107], v[106:107], s[52:53]
v_pk_mul_f32 v[108:109], v[108:109], s[52:53]
v_pk_mul_f32 v[110:111], v[110:111], s[52:53]
v_cvt_pk_bf16_f32 v104, v104, v105
v_cvt_pk_bf16_f32 v105, v106, v107
v_cvt_pk_bf16_f32 v106, v108, v109
v_cvt_pk_bf16_f32 v107, v110, v111
v_accvgpr_write_b32 a200, v104
v_accvgpr_write_b32 a201, v105
v_accvgpr_write_b32 a202, v106
v_accvgpr_write_b32 a203, v107
v_pk_mul_f32 v[112:113], v[112:113], s[52:53]
v_pk_mul_f32 v[114:115], v[114:115], s[52:53]
v_pk_mul_f32 v[116:117], v[116:117], s[52:53]
v_pk_mul_f32 v[118:119], v[118:119], s[52:53]
v_cvt_pk_bf16_f32 v112, v112, v113
v_cvt_pk_bf16_f32 v113, v114, v115
v_cvt_pk_bf16_f32 v114, v116, v117
v_cvt_pk_bf16_f32 v115, v118, v119
v_accvgpr_write_b32 a216, v112
v_accvgpr_write_b32 a217, v113
v_accvgpr_write_b32 a218, v114
v_accvgpr_write_b32 a219, v115
v_pk_mul_f32 v[120:121], v[120:121], s[52:53]
v_pk_mul_f32 v[122:123], v[122:123], s[52:53]
v_pk_mul_f32 v[124:125], v[124:125], s[52:53]
v_pk_mul_f32 v[126:127], v[126:127], s[52:53]
v_cvt_pk_bf16_f32 v120, v120, v121
v_cvt_pk_bf16_f32 v121, v122, v123
v_cvt_pk_bf16_f32 v122, v124, v125
v_cvt_pk_bf16_f32 v123, v126, v127
v_accvgpr_write_b32 a172, v120
v_accvgpr_write_b32 a173, v121
v_accvgpr_write_b32 a174, v122
v_accvgpr_write_b32 a175, v123
v_pk_mul_f32 v[128:129], v[128:129], s[52:53]
v_pk_mul_f32 v[130:131], v[130:131], s[52:53]
v_pk_mul_f32 v[132:133], v[132:133], s[52:53]
v_pk_mul_f32 v[134:135], v[134:135], s[52:53]
v_cvt_pk_bf16_f32 v128, v128, v129
v_cvt_pk_bf16_f32 v129, v130, v131
v_cvt_pk_bf16_f32 v130, v132, v133
v_cvt_pk_bf16_f32 v131, v134, v135
v_accvgpr_write_b32 a188, v128
v_accvgpr_write_b32 a189, v129
v_accvgpr_write_b32 a190, v130
v_accvgpr_write_b32 a191, v131
v_pk_mul_f32 v[136:137], v[136:137], s[52:53]
v_pk_mul_f32 v[138:139], v[138:139], s[52:53]
v_pk_mul_f32 v[140:141], v[140:141], s[52:53]
v_pk_mul_f32 v[142:143], v[142:143], s[52:53]
v_cvt_pk_bf16_f32 v136, v136, v137
v_cvt_pk_bf16_f32 v137, v138, v139
v_cvt_pk_bf16_f32 v138, v140, v141
v_cvt_pk_bf16_f32 v139, v142, v143
v_accvgpr_write_b32 a204, v136
v_accvgpr_write_b32 a205, v137
v_accvgpr_write_b32 a206, v138
v_accvgpr_write_b32 a207, v139
v_pk_mul_f32 v[144:145], v[144:145], s[52:53]
v_pk_mul_f32 v[146:147], v[146:147], s[52:53]
v_pk_mul_f32 v[148:149], v[148:149], s[52:53]
v_pk_mul_f32 v[150:151], v[150:151], s[52:53]
v_cvt_pk_bf16_f32 v144, v144, v145
v_cvt_pk_bf16_f32 v145, v146, v147
v_cvt_pk_bf16_f32 v146, v148, v149
v_cvt_pk_bf16_f32 v147, v150, v151
v_accvgpr_write_b32 a220, v144
v_accvgpr_write_b32 a221, v145
v_accvgpr_write_b32 a222, v146
v_accvgpr_write_b32 a223, v147
s_cmp_lg_u32 s4, 0
s_cbranch_scc1 L_spun_hx
s_mov_b32 s92, 200000
L_spin_hx:
s_waitcnt vmcnt(0)
v_max3_u32 v128, v188, v189, 0
v_max3_u32 v128, v190, v191, v128
v_max3_u32 v128, v216, v217, v128
v_max3_u32 v128, v220, v221, v128
v_max3_u32 v128, v204, v205, v128
v_max3_u32 v128, v206, v207, v128
v_max3_u32 v128, v232, v233, v128
v_max3_u32 v128, v236, v237, v128
v_cmp_eq_u32 vcc, -1, v128
s_sub_u32 s92, s92, 1
s_cbranch_scc1 L_spun_hx
s_nop 3
s_cbranch_vccz L_spun_hx
s_sleep 2
buffer_load_dwordx4 v[188:191], v10, s[88:91], 0 offen sc1
buffer_load_dwordx2 v[216:217], v10, s[88:91], 0 offen offset:1024 sc1
buffer_load_dwordx2 v[220:221], v10, s[88:91], 0 offen offset:1032 sc1
buffer_load_dwordx4 v[204:207], v11, s[88:91], 0 offen sc1
buffer_load_dwordx2 v[232:233], v11, s[88:91], 0 offen offset:1024 sc1
buffer_load_dwordx2 v[236:237], v11, s[88:91], 0 offen offset:1032 sc1
s_branch L_spin_hx
L_spun_hx:
s_waitcnt lgkmcnt(0)
s_barrier
v_mfma_f32_16x16x32_bf16 v[52:55], v[184:187], v[152:155], v[248:251]
v_mov_b32 v140, 0
v_mov_b32 v141, 0
v_mfma_f32_16x16x32_bf16 v[48:51], v[188:191], v[152:155], v[32:35]
v_mov_b32 v142, 0
v_mov_b32 v143, 0
v_mfma_f32_16x16x32_bf16 v[60:63], v[192:195], v[160:163], v[248:251]
v_mov_b32 v144, 0
v_mov_b32 v145, 0
v_mfma_f32_16x16x32_bf16 v[56:59], v[196:199], v[160:163], v[36:39]
v_mov_b32 v146, 0
v_mov_b32 v147, 0
v_mfma_f32_16x16x32_bf16 v[68:71], v[200:203], v[168:171], v[248:251]
v_mov_b32 v148, 0
v_mov_b32 v149, 0
v_mfma_f32_16x16x32_bf16 v[64:67], v[204:207], v[168:171], v[36:39]
v_max3_f32 v52, v48, v49, v52
v_max3_f32 v54, v50, v51, v54
v_mfma_f32_16x16x32_bf16 v[76:79], v[208:211], v[176:179], v[248:251]
v_max_f32 v52, v52, v53
v_max_f32 v53, v54, v55
v_mfma_f32_16x16x32_bf16 v[72:75], v[212:215], v[176:179], v[36:39]
v_max_f32 v136, v52, v53
v_max3_f32 v60, v56, v57, v60
v_mfma_f32_16x16x32_bf16 v[16:19], a[0:3], a[160:163], v[44:47]
v_max3_f32 v62, v58, v59, v62
v_max_f32 v60, v60, v61
v_mfma_f32_16x16x32_bf16 v[16:19], a[4:7], a[164:167], v[16:19]
v_max_f32 v61, v62, v63
v_max_f32 v137, v60, v61
v_mfma_f32_16x16x32_bf16 v[16:19], a[8:11], a[168:171], v[16:19]
v_max3_f32 v68, v64, v65, v68
v_max3_f32 v70, v66, v67, v70
v_mfma_f32_16x16x32_bf16 v[16:19], a[12:15], a[172:175], v[16:19]
v_max_f32 v68, v68, v69
v_max_f32 v69, v70, v71
v_mfma_f32_16x16x32_bf16 v[20:23], a[0:3], a[176:179], 0
v_max_f32 v138, v68, v69
v_max3_f32 v76, v72, v73, v76
v_mfma_f32_16x16x32_bf16 v[20:23], a[4:7], a[180:183], v[20:23]
v_max3_f32 v78, v74, v75, v78
v_max_f32 v76, v76, v77
v_mfma_f32_16x16x32_bf16 v[20:23], a[8:11], a[184:187], v[20:23]
v_max_f32 v77, v78, v79
v_max_f32 v139, v76, v77
v_mfma_f32_16x16x32_bf16 v[20:23], a[12:15], a[188:191], v[20:23]
v_mov_b32 v150, 0
v_mov_b32 v151, 0
v_mfma_f32_16x16x32_bf16 v[24:27], a[0:3], a[192:195], 0
v_mov_b32 v248, 0
v_mov_b32 v249, 0
v_mfma_f32_16x16x32_bf16 v[24:27], a[4:7], a[196:199], v[24:27]
v_mov_b32 v250, 0
v_mov_b32 v251, 0
v_mfma_f32_16x16x32_bf16 v[24:27], a[8:11], a[200:203], v[24:27]
v_max3_f32 v80, v16, v17, v18
v_max_f32 v80, v80, v19
v_mfma_f32_16x16x32_bf16 v[24:27], a[12:15], a[204:207], v[24:27]
v_max3_f32 v84, v20, v21, v22
v_max_f32 v84, v84, v23
v_mfma_f32_16x16x32_bf16 v[28:31], a[0:3], a[208:211], 0
v_mov_b32 v128, v136
v_mov_b32 v129, v137
v_mfma_f32_16x16x32_bf16 v[28:31], a[4:7], a[212:215], v[28:31]
v_mov_b32 v130, v138
v_mov_b32 v131, v139
v_mfma_f32_16x16x32_bf16 v[28:31], a[8:11], a[216:219], v[28:31]
v_permlane16_swap_b32 v128, v136
v_permlane16_swap_b32 v129, v137
v_mfma_f32_16x16x32_bf16 v[28:31], a[12:15], a[220:223], v[28:31]
v_permlane16_swap_b32 v130, v138
v_permlane16_swap_b32 v131, v139
v_max_f32 v136, v136, v128
v_max_f32 v137, v137, v129
v_max_f32 v138, v138, v130
v_max_f32 v139, v139, v131
v_max3_f32 v88, v24, v25, v26
v_max_f32 v88, v88, v27
v_mov_b32 v128, v136
v_mov_b32 v129, v137
v_mov_b32 v130, v138
v_mov_b32 v131, v139
v_max3_f32 v92, v28, v29, v30
v_max_f32 v92, v92, v31
v_permlane32_swap_b32 v128, v136
v_permlane32_swap_b32 v129, v137
v_permlane32_swap_b32 v130, v138
v_permlane32_swap_b32 v131, v139
v_max_f32 v136, v136, v128
v_max_f32 v137, v137, v129
v_max_f32 v138, v138, v130
v_max_f32 v139, v139, v131
v_mul_f32 v136, s54, v136
v_mul_f32 v137, s54, v137
v_mul_f32 v138, s54, v138
v_mul_f32 v139, s54, v139
v_fma_f32 v52, v52, s54, -v136
v_fma_f32 v53, v53, s54, -v136
v_fma_f32 v60, v60, s54, -v137
v_fma_f32 v61, v61, s54, -v137
v_fma_f32 v68, v68, s54, -v138
v_fma_f32 v69, v69, s54, -v138
v_fma_f32 v76, v76, s54, -v139
v_fma_f32 v77, v77, s54, -v139
v_exp_f32 v52, v52
v_exp_f32 v53, v53
v_exp_f32 v60, v60
v_exp_f32 v61, v61
v_exp_f32 v68, v68
v_exp_f32 v69, v69
v_exp_f32 v76, v76
v_exp_f32 v77, v77
v_cvt_pk_bf16_f32 v52, v52, v52
v_cvt_pk_bf16_f32 v53, v53, v53
v_cvt_pk_bf16_f32 v60, v60, v60
v_cvt_pk_bf16_f32 v61, v61, v61
v_cvt_pk_bf16_f32 v68, v68, v68
v_cvt_pk_bf16_f32 v69, v69, v69
v_cvt_pk_bf16_f32 v76, v76, v76
v_cvt_pk_bf16_f32 v77, v77, v77
v_and_b32 v48, v252, v52
v_and_b32 v49, v253, v53
v_and_b32 v50, v254, v52
v_and_b32 v51, v255, v53
v_and_b32 v56, v252, v60
v_and_b32 v57, v253, v61
v_and_b32 v58, v254, v60
v_and_b32 v59, v255, v61
v_and_b32 v64, v252, v68
v_and_b32 v65, v253, v69
v_and_b32 v66, v254, v68
v_and_b32 v67, v255, v69
v_and_b32 v72, v252, v76
v_and_b32 v73, v253, v77
v_and_b32 v74, v254, v76
v_and_b32 v75, v255, v77
v_mfma_f32_16x16x32_bf16 v[156:159], a[240:243], v[48:51], 0
v_mov_b32 v128, v80
v_mov_b32 v129, v84
v_mfma_f32_16x16x32_bf16 v[164:167], a[240:243], v[56:59], 0
v_mov_b32 v130, v88
v_mov_b32 v131, v92
v_mfma_f32_16x16x32_bf16 v[172:175], a[240:243], v[64:67], 0
v_permlane16_swap_b32 v128, v80
v_permlane16_swap_b32 v129, v84
v_mfma_f32_16x16x32_bf16 v[180:183], a[240:243], v[72:75], 0
v_permlane16_swap_b32 v130, v88
v_permlane16_swap_b32 v131, v92
v_mfma_f32_16x16x32_bf16 v[184:187], v[216:219], v[48:51], 0
v_max_f32 v80, v80, v128
v_max_f32 v84, v84, v129
v_mfma_f32_16x16x32_bf16 v[188:191], v[220:223], v[48:51], 0
v_max_f32 v88, v88, v130
v_max_f32 v92, v92, v131
v_mfma_f32_16x16x32_bf16 v[192:195], v[224:227], v[56:59], 0
v_mov_b32 v128, v80
v_mov_b32 v129, v84
v_mfma_f32_16x16x32_bf16 v[196:199], v[228:231], v[56:59], 0
v_mov_b32 v130, v88
v_mov_b32 v131, v92
v_mfma_f32_16x16x32_bf16 v[200:203], v[232:235], v[64:67], 0
v_permlane32_swap_b32 v128, v80
v_permlane32_swap_b32 v129, v84
v_mfma_f32_16x16x32_bf16 v[204:207], v[236:239], v[64:67], 0
v_permlane32_swap_b32 v130, v88
v_permlane32_swap_b32 v131, v92
v_mfma_f32_16x16x32_bf16 v[208:211], v[240:243], v[72:75], 0
v_max_f32 v80, v80, v128
v_max_f32 v84, v84, v129
v_mfma_f32_16x16x32_bf16 v[212:215], v[244:247], v[72:75], 0
v_max_f32 v88, v88, v130
v_max_f32 v92, v92, v131
v_rcp_f32 v128, v156
v_rcp_f32 v130, v164
v_rcp_f32 v132, v172
v_rcp_f32 v134, v180
v_sub_f32 v83, 0, v80
v_sub_f32 v82, 0, v80
v_sub_f32 v81, 0, v80
v_sub_f32 v80, 0, v80
v_min_f32 v103, s8, v80
v_cndmask_b32 v96, v103, v80, s[36:37]
v_cndmask_b32 v97, v103, v80, s[38:39]
v_cndmask_b32 v98, v103, v80, s[40:41]
v_cndmask_b32 v99, v103, v80, s[42:43]
v_cndmask_b32 v100, v9, v103, s[36:37]
v_cndmask_b32 v101, v9, v103, s[38:39]
v_cndmask_b32 v102, v9, v103, s[40:41]
v_cndmask_b32 v103, v9, v103, s[42:43]
v_pk_mul_f32 v[184:185], v[184:185], v[128:129] op_sel_hi:[1,0]
v_pk_mul_f32 v[186:187], v[186:187], v[128:129] op_sel_hi:[1,0]
v_pk_mul_f32 v[188:189], v[188:189], v[128:129] op_sel_hi:[1,0]
v_pk_mul_f32 v[190:191], v[190:191], v[128:129] op_sel_hi:[1,0]
v_pk_mul_f32 v[192:193], v[192:193], v[130:131] op_sel_hi:[1,0]
v_pk_mul_f32 v[194:195], v[194:195], v[130:131] op_sel_hi:[1,0]
v_pk_mul_f32 v[196:197], v[196:197], v[130:131] op_sel_hi:[1,0]
v_pk_mul_f32 v[198:199], v[198:199], v[130:131] op_sel_hi:[1,0]
v_pk_mul_f32 v[200:201], v[200:201], v[132:133] op_sel_hi:[1,0]
v_pk_mul_f32 v[202:203], v[202:203], v[132:133] op_sel_hi:[1,0]
v_pk_mul_f32 v[204:205], v[204:205], v[132:133] op_sel_hi:[1,0]
v_pk_mul_f32 v[206:207], v[206:207], v[132:133] op_sel_hi:[1,0]
v_pk_mul_f32 v[208:209], v[208:209], v[134:135] op_sel_hi:[1,0]
v_pk_mul_f32 v[210:211], v[210:211], v[134:135] op_sel_hi:[1,0]
v_pk_mul_f32 v[212:213], v[212:213], v[134:135] op_sel_hi:[1,0]
v_pk_mul_f32 v[214:215], v[214:215], v[134:135] op_sel_hi:[1,0]
v_cvt_pk_bf16_f32 v32, v184, v185
v_cvt_pk_bf16_f32 v33, v186, v187
v_cvt_pk_bf16_f32 v34, v188, v189
v_cvt_pk_bf16_f32 v35, v190, v191
v_cvt_pk_bf16_f32 v36, v192, v193
v_cvt_pk_bf16_f32 v37, v194, v195
v_cvt_pk_bf16_f32 v38, v196, v197
v_cvt_pk_bf16_f32 v39, v198, v199
v_cvt_pk_bf16_f32 v40, v200, v201
v_cvt_pk_bf16_f32 v41, v202, v203
v_cvt_pk_bf16_f32 v42, v204, v205
v_cvt_pk_bf16_f32 v43, v206, v207
v_cvt_pk_bf16_f32 v44, v208, v209
v_cvt_pk_bf16_f32 v45, v210, v211
v_cvt_pk_bf16_f32 v46, v212, v213
v_cvt_pk_bf16_f32 v47, v214, v215
buffer_store_dwordx4 v[32:35], v3, s[88:91], s44 offen sc1
v_sub_f32 v87, 0, v84
v_sub_f32 v86, 0, v84
v_sub_f32 v85, 0, v84
v_sub_f32 v84, 0, v84
v_min_f32 v111, s9, v84
v_cndmask_b32 v104, v111, v84, s[36:37]
v_cndmask_b32 v105, v111, v84, s[38:39]
v_cndmask_b32 v106, v111, v84, s[40:41]
v_cndmask_b32 v107, v111, v84, s[42:43]
v_cndmask_b32 v108, v9, v111, s[36:37]
v_cndmask_b32 v109, v9, v111, s[38:39]
v_cndmask_b32 v110, v9, v111, s[40:41]
v_cndmask_b32 v111, v9, v111, s[42:43]
v_sub_f32 v91, 0, v88
v_sub_f32 v90, 0, v88
v_sub_f32 v89, 0, v88
v_sub_f32 v88, 0, v88
v_min_f32 v119, s8, v88
v_cndmask_b32 v112, v119, v88, s[36:37]
v_cndmask_b32 v113, v119, v88, s[38:39]
v_cndmask_b32 v114, v119, v88, s[40:41]
v_cndmask_b32 v115, v119, v88, s[42:43]
v_cndmask_b32 v116, v9, v119, s[36:37]
buffer_store_dwordx4 v[36:39], v3, s[88:91], s45 offen sc1
v_cndmask_b32 v117, v9, v119, s[38:39]
v_cndmask_b32 v118, v9, v119, s[40:41]
v_cndmask_b32 v119, v9, v119, s[42:43]
v_sub_f32 v95, 0, v92
v_sub_f32 v94, 0, v92
v_sub_f32 v93, 0, v92
v_sub_f32 v92, 0, v92
v_min_f32 v127, s9, v92
v_cndmask_b32 v120, v127, v92, s[36:37]
v_cndmask_b32 v121, v127, v92, s[38:39]
v_cndmask_b32 v122, v127, v92, s[40:41]
v_cndmask_b32 v123, v127, v92, s[42:43]
v_cndmask_b32 v124, v9, v127, s[36:37]
v_cndmask_b32 v125, v9, v127, s[38:39]
v_cndmask_b32 v126, v9, v127, s[40:41]
v_cndmask_b32 v127, v9, v127, s[42:43]
v_and_b32 v9, 1, v0
v_mul_u32_u24 v9, 0xaaaa, v9
v_add_u32 v9, 0x4444, v9
v_mov_b64 v[128:129], 0
v_mov_b64 v[130:131], 0
v_mov_b64 v[132:133], 0
v_mov_b64 v[134:135], 0
v_mov_b64 v[136:137], 0
buffer_store_dwordx4 v[40:43], v3, s[88:91], s46 offen sc1
v_mov_b64 v[138:139], 0
v_mov_b64 v[152:153], 0
v_mov_b64 v[154:155], 0
v_mov_b64 v[156:157], 0
v_mov_b64 v[158:159], 0
v_mov_b64 v[160:161], 0
v_mov_b64 v[162:163], 0
v_mov_b64 v[164:165], 0
v_mov_b64 v[166:167], 0
v_mov_b64 v[168:169], 0
v_mov_b64 v[170:171], 0
v_mov_b64 v[172:173], 0
v_mov_b64 v[174:175], 0
v_mov_b64 v[176:177], 0
v_mov_b64 v[178:179], 0
v_mov_b64 v[180:181], 0
v_mov_b64 v[182:183], 0
v_mov_b64 v[184:185], 0
v_mov_b64 v[186:187], 0
v_mov_b64 v[188:189], 0
v_mov_b64 v[190:191], 0
v_mov_b64 v[192:193], 0
v_mov_b64 v[194:195], 0
buffer_store_dwordx4 v[44:47], v3, s[88:91], s47 offen sc1
v_mov_b64 v[196:197], 0
v_mov_b64 v[198:199], 0
v_mov_b64 v[200:201], 0
v_mov_b64 v[202:203], 0
v_mov_b64 v[204:205], 0
v_mov_b64 v[206:207], 0
v_mov_b64 v[208:209], 0
v_mov_b64 v[210:211], 0
v_mov_b64 v[212:213], 0
v_mov_b64 v[214:215], 0
v_mov_b64 v[216:217], 0
v_mov_b64 v[218:219], 0
v_mov_b64 v[220:221], 0
v_mov_b64 v[222:223], 0
v_mov_b64 v[224:225], 0
v_mov_b64 v[226:227], 0
v_mov_b64 v[228:229], 0
v_mov_b64 v[230:231], 0
v_mov_b64 v[232:233], 0
v_mov_b64 v[234:235], 0
v_mov_b64 v[236:237], 0
v_mov_b64 v[238:239], 0
v_mov_b64 v[252:253], 0
v_mov_b64 v[254:255], 0
L_att_start:
s_mov_b32 s15, s6
s_cmp_eq_u32 s6, 0
s_cbranch_scc1 L_att_j0
v_mfma_f32_16x16x32_bf16 v[16:19], a[0:3], a[160:163], v[80:83]
ds_read_b128 a[128:131], v1 offset:24576
v_mov_b32 v240, 0
v_mfma_f32_16x16x32_bf16 v[16:19], a[4:7], a[164:167], v[16:19]
ds_read_b128 a[132:135], v1 offset:25600
v_mov_b32 v241, 0
v_mfma_f32_16x16x32_bf16 v[16:19], a[8:11], a[168:171], v[16:19]
ds_read_b128 a[136:139], v1 offset:26624
s_add_u32 m0, s27, 0x0
v_mfma_f32_16x16x32_bf16 v[16:19], a[12:15], a[172:175], v[16:19]
buffer_load_dwordx4 v3, s[48:51], s32 offen offset:0 sc1 lds
v_mfma_f32_16x16x32_bf16 v[20:23], a[0:3], a[176:179], v[84:87]
ds_read_b128 a[140:143], v1 offset:27648
v_mov_b32 v242, 0
v_mfma_f32_16x16x32_bf16 v[20:23], a[4:7], a[180:183], v[20:23]
ds_read_b128 a[144:147], v1 offset:28672
v_mov_b32 v243, 0
v_mfma_f32_16x16x32_bf16 v[20:23], a[8:11], a[184:187], v[20:23]
ds_read_b128 a[148:151], v1 offset:29696
v_mov_b32 v244, 0
v_mfma_f32_16x16x32_bf16 v[20:23], a[12:15], a[188:191], v[20:23]
ds_read_b128 a[152:155], v1 offset:30720
v_mov_b32 v245, 0
v_mfma_f32_16x16x32_bf16 v[24:27], a[0:3], a[192:195], v[88:91]
ds_read_b128 a[156:159], v1 offset:31744
v_exp_f32 v16, v16
v_mfma_f32_16x16x32_bf16 v[24:27], a[4:7], a[196:199], v[24:27]
v_exp_f32 v17, v17
v_mfma_f32_16x16x32_bf16 v[24:27], a[8:11], a[200:203], v[24:27]
buffer_load_dwordx4 v3, s[48:51], s32 offen offset:1024 sc1 lds
v_mfma_f32_16x16x32_bf16 v[24:27], a[12:15], a[204:207], v[24:27]
v_exp_f32 v18, v18
v_mfma_f32_16x16x32_bf16 v[28:31], a[0:3], a[208:211], v[92:95]
v_exp_f32 v19, v19
v_mfma_f32_16x16x32_bf16 v[28:31], a[4:7], a[212:215], v[28:31]
v_exp_f32 v20, v20
v_mfma_f32_16x16x32_bf16 v[28:31], a[8:11], a[216:219], v[28:31]
v_cvt_pk_bf16_f32 v48, v16, v17
v_cvt_pk_bf16_f32 v49, v18, v19
v_mfma_f32_16x16x32_bf16 v[28:31], a[12:15], a[220:223], v[28:31]
v_exp_f32 v21, v21
v_mfma_f32_16x16x32_bf16 v[32:35], a[16:19], a[160:163], v[80:83]
v_exp_f32 v22, v22
v_mfma_f32_16x16x32_bf16 v[32:35], a[20:23], a[164:167], v[32:35]
v_exp_f32 v23, v23
v_mfma_f32_16x16x32_bf16 v[32:35], a[24:27], a[168:171], v[32:35]
buffer_load_dwordx4 v3, s[48:51], s32 offen offset:2048 sc1 lds
v_mfma_f32_16x16x32_bf16 v[32:35], a[28:31], a[172:175], v[32:35]
v_exp_f32 v24, v24
v_mfma_f32_16x16x32_bf16 v[36:39], a[16:19], a[176:179], v[84:87]
v_exp_f32 v25, v25
v_mfma_f32_16x16x32_bf16 v[36:39], a[20:23], a[180:183], v[36:39]
v_cvt_pk_bf16_f32 v52, v20, v21
v_cvt_pk_bf16_f32 v53, v22, v23
v_mfma_f32_16x16x32_bf16 v[36:39], a[24:27], a[184:187], v[36:39]
v_exp_f32 v26, v26
v_mfma_f32_16x16x32_bf16 v[36:39], a[28:31], a[188:191], v[36:39]
v_exp_f32 v27, v27
v_mfma_f32_16x16x32_bf16 v[40:43], a[16:19], a[192:195], v[88:91]
v_exp_f32 v28, v28
v_mfma_f32_16x16x32_bf16 v[40:43], a[20:23], a[196:199], v[40:43]
buffer_load_dwordx4 v3, s[48:51], s32 offen offset:3072 sc1 lds
v_mfma_f32_16x16x32_bf16 v[40:43], a[24:27], a[200:203], v[40:43]
s_add_u32 s32, s32, 0x8000
v_exp_f32 v29, v29
v_mfma_f32_16x16x32_bf16 v[40:43], a[28:31], a[204:207], v[40:43]
v_exp_f32 v30, v30
v_mfma_f32_16x16x32_bf16 v[44:47], a[16:19], a[208:211], v[92:95]
v_exp_f32 v31, v31
v_mfma_f32_16x16x32_bf16 v[44:47], a[20:23], a[212:215], v[44:47]
v_exp_f32 v32, v32
v_mfma_f32_16x16x32_bf16 v[44:47], a[24:27], a[216:219], v[44:47]
v_exp_f32 v33, v33
v_mfma_f32_16x16x32_bf16 v[44:47], a[28:31], a[220:223], v[44:47]
s_waitcnt lgkmcnt(0)
v_cvt_pk_bf16_f32 v56, v24, v25
v_cvt_pk_bf16_f32 v57, v26, v27
v_mov_b32 v246, 0
v_mov_b32 v247, 0
v_mfma_f32_16x16x32_bf16 v[16:19], a[128:131], a[160:163], v[80:83]
ds_read_b128 a[32:35], v1 offset:16384
v_cvt_pk_bf16_f32 v60, v28, v29
v_mfma_f32_16x16x32_bf16 v[16:19], a[132:135], a[164:167], v[16:19]
v_exp_f32 v34, v34
v_mfma_f32_16x16x32_bf16 v[16:19], a[136:139], a[168:171], v[16:19]
s_add_u32 m0, s27, 0x1000
v_exp_f32 v35, v35
v_mfma_f32_16x16x32_bf16 v[16:19], a[140:143], a[172:175], v[16:19]
buffer_load_dwordx4 v3, s[48:51], s7 offen offset:0 sc1 lds
v_mfma_f32_16x16x32_bf16 v[20:23], a[128:131], a[176:179], v[84:87]
ds_read_b128 a[36:39], v1 offset:17408
v_cvt_pk_bf16_f32 v61, v30, v31
v_mfma_f32_16x16x32_bf16 v[20:23], a[132:135], a[180:183], v[20:23]
v_exp_f32 v36, v36
v_mfma_f32_16x16x32_bf16 v[20:23], a[136:139], a[184:187], v[20:23]
ds_read_b128 a[40:43], v1 offset:18432
v_cvt_pk_bf16_f32 v50, v32, v33
v_mfma_f32_16x16x32_bf16 v[20:23], a[140:143], a[188:191], v[20:23]
v_exp_f32 v37, v37
v_mfma_f32_16x16x32_bf16 v[24:27], a[128:131], a[192:195], v[88:91]
v_exp_f32 v38, v38
v_mfma_f32_16x16x32_bf16 v[24:27], a[132:135], a[196:199], v[24:27]
ds_read_b128 a[44:47], v1 offset:19456
v_cvt_pk_bf16_f32 v51, v34, v35
v_mfma_f32_16x16x32_bf16 v[24:27], a[136:139], a[200:203], v[24:27]
buffer_load_dwordx4 v3, s[48:51], s7 offen offset:1024 sc1 lds
v_mfma_f32_16x16x32_bf16 v[24:27], a[140:143], a[204:207], v[24:27]
v_exp_f32 v39, v39
v_mfma_f32_16x16x32_bf16 v[28:31], a[128:131], a[208:211], v[92:95]
v_exp_f32 v40, v40
v_mfma_f32_16x16x32_bf16 v[28:31], a[132:135], a[212:215], v[28:31]
ds_read_b128 a[48:51], v1 offset:20480
v_cvt_pk_bf16_f32 v54, v36, v37
v_mfma_f32_16x16x32_bf16 v[28:31], a[136:139], a[216:219], v[28:31]
v_exp_f32 v41, v41
v_mfma_f32_16x16x32_bf16 v[28:31], a[140:143], a[220:223], v[28:31]
v_exp_f32 v42, v42
v_mfma_f32_16x16x32_bf16 v[32:35], a[144:147], a[160:163], v[80:83]
buffer_load_dwordx4 v3, s[48:51], s7 offen offset:2048 sc1 lds
v_mfma_f32_16x16x32_bf16 v[32:35], a[148:151], a[164:167], v[32:35]
ds_read_b128 a[52:55], v1 offset:21504
v_cvt_pk_bf16_f32 v55, v38, v39
v_mfma_f32_16x16x32_bf16 v[32:35], a[152:155], a[168:171], v[32:35]
v_exp_f32 v43, v43
v_mfma_f32_16x16x32_bf16 v[32:35], a[156:159], a[172:175], v[32:35]
ds_read_b128 a[56:59], v1 offset:22528
v_cvt_pk_bf16_f32 v58, v40, v41
v_mfma_f32_16x16x32_bf16 v[36:39], a[144:147], a[176:179], v[84:87]
v_exp_f32 v44, v44
v_mfma_f32_16x16x32_bf16 v[36:39], a[148:151], a[180:183], v[36:39]
v_exp_f32 v45, v45
v_mfma_f32_16x16x32_bf16 v[36:39], a[152:155], a[184:187], v[36:39]
ds_read_b128 a[60:63], v1 offset:23552
v_xor_b32 v1, 0x8000, v1
v_mfma_f32_16x16x32_bf16 v[36:39], a[156:159], a[188:191], v[36:39]
buffer_load_dwordx4 v3, s[48:51], s7 offen offset:3072 sc1 lds
v_cvt_pk_bf16_f32 v59, v42, v43
v_mfma_f32_16x16x32_bf16 v[40:43], a[144:147], a[192:195], v[88:91]
s_add_u32 s7, s7, 0x8000
v_exp_f32 v46, v46
v_mfma_f32_16x16x32_bf16 v[40:43], a[148:151], a[196:199], v[40:43]
s_xor_b32 s27, s27, 0x38000
v_exp_f32 v47, v47
v_mfma_f32_16x16x32_bf16 v[40:43], a[152:155], a[200:203], v[40:43]
v_exp_f32 v16, v16
v_mfma_f32_16x16x32_bf16 v[40:43], a[156:159], a[204:207], v[40:43]
v_exp_f32 v17, v17
v_cvt_pk_bf16_f32 v62, v44, v45
v_cvt_pk_bf16_f32 v63, v46, v47
v_mfma_f32_16x16x32_bf16 v[44:47], a[144:147], a[208:211], v[92:95]
v_exp_f32 v18, v18
v_mfma_f32_16x16x32_bf16 v[44:47], a[148:151], a[212:215], v[44:47]
v_exp_f32 v19, v19
v_mfma_f32_16x16x32_bf16 v[44:47], a[152:155], a[216:219], v[44:47]
s_waitcnt vmcnt(8) lgkmcnt(0)
v_exp_f32 v20, v20
v_mfma_f32_16x16x32_bf16 v[44:47], a[156:159], a[220:223], v[44:47]
s_barrier
v_cvt_pk_bf16_f32 v64, v16, v17
v_exp_f32 v21, v21
v_exp_f32 v22, v22
v_exp_f32 v23, v23
v_exp_f32 v24, v24
v_exp_f32 v25, v25
v_exp_f32 v26, v26
v_exp_f32 v27, v27
v_cvt_pk_bf16_f32 v65, v18, v19
v_cvt_pk_bf16_f32 v68, v20, v21
v_cvt_pk_bf16_f32 v69, v22, v23
s_cmp_lg_u32 s33, 0
s_cbranch_scc1 L_sig_bd
s_lshl_b32 s8, s6, 2
s_add_u32 s8, s8, 192
s_cmp_lg_u32 s4, 0
s_cbranch_scc1 L_sig_bd
v_mov_b32 v4, 1
s_mov_b64 exec, 1
buffer_atomic_add v4, off, s[84:87], s8 sc1
s_mov_b64 exec, -1
L_sig_bd:
s_getreg_b32 s8, hwreg(HW_REG_HW_ID, 5, 1)
s_cmp_lg_u32 s8, 0
s_cbranch_scc1 L_att_dodd1
s_branch L_att_dodd0
L_att_deven0:
v_mfma_f32_16x16x32_bf16 v[128:131], a[32:35], v[48:51], v[128:131]
ds_read_b128 a[0:3], v1 offset:8192
v_cvt_pk_bf16_f32 v72, v24, v25
v_mfma_f32_16x16x32_bf16 v[160:163], a[32:35], v[52:55], v[160:163]
v_exp_f32 v28, v28
v_mfma_f32_16x16x32_bf16 v[192:195], a[32:35], v[56:59], v[192:195]
v_cvt_pk_bf16_f32 v73, v26, v27
v_mfma_f32_16x16x32_bf16 v[224:227], a[32:35], v[60:63], v[224:227]
ds_read_b128 a[4:7], v1 offset:9216
v_mfma_f32_16x16x32_bf16 v[228:231], a[36:39], v[60:63], v[228:231]
v_exp_f32 v29, v29
v_mfma_f32_16x16x32_bf16 v[196:199], a[36:39], v[56:59], v[196:199]
v_exp_f32 v30, v30
v_mfma_f32_16x16x32_bf16 v[164:167], a[36:39], v[52:55], v[164:167]
s_add_u32 m0, s27, 0x0
v_cvt_pk_bf16_f32 v76, v28, v29
v_mfma_f32_16x16x32_bf16 v[132:135], a[36:39], v[48:51], v[132:135]
buffer_load_dwordx4 v3, s[48:51], s32 offen offset:0 sc1 lds
v_mfma_f32_16x16x32_bf16 v[136:139], a[40:43], v[48:51], v[136:139]
ds_read_b128 a[8:11], v1 offset:10240
v_mfma_f32_16x16x32_bf16 v[168:171], a[40:43], v[52:55], v[168:171]
v_exp_f32 v31, v31
v_mfma_f32_16x16x32_bf16 v[200:203], a[40:43], v[56:59], v[200:203]
v_exp_f32 v32, v32
v_mfma_f32_16x16x32_bf16 v[232:235], a[40:43], v[60:63], v[232:235]
ds_read_b128 a[12:15], v1 offset:11264
v_cvt_pk_bf16_f32 v77, v30, v31
v_mfma_f32_16x16x32_bf16 v[236:239], a[44:47], v[60:63], v[236:239]
v_mfma_f32_16x16x32_bf16 v[204:207], a[44:47], v[56:59], v[204:207]
v_exp_f32 v33, v33
v_mfma_f32_16x16x32_bf16 v[172:175], a[44:47], v[52:55], v[172:175]
v_exp_f32 v34, v34
v_mfma_f32_16x16x32_bf16 v[140:143], a[44:47], v[48:51], v[140:143]
ds_read_b128 a[16:19], v1 offset:12288
v_cvt_pk_bf16_f32 v66, v32, v33
v_mfma_f32_16x16x32_bf16 v[144:147], a[48:51], v[48:51], v[144:147]
v_mfma_f32_16x16x32_bf16 v[176:179], a[48:51], v[52:55], v[176:179]
v_exp_f32 v35, v35
v_mfma_f32_16x16x32_bf16 v[208:211], a[48:51], v[56:59], v[208:211]
v_exp_f32 v36, v36
v_mfma_f32_16x16x32_bf16 v[240:243], a[48:51], v[60:63], v[240:243]
ds_read_b128 a[20:23], v1 offset:13312
v_cvt_pk_bf16_f32 v67, v34, v35
v_mfma_f32_16x16x32_bf16 v[244:247], a[52:55], v[60:63], v[244:247]
v_exp_f32 v37, v37
v_mfma_f32_16x16x32_bf16 v[212:215], a[52:55], v[56:59], v[212:215]
v_cvt_pk_bf16_f32 v70, v36, v37
v_mfma_f32_16x16x32_bf16 v[180:183], a[52:55], v[52:55], v[180:183]
ds_read_b128 a[24:27], v1 offset:14336
v_mfma_f32_16x16x32_bf16 v[148:151], a[52:55], v[48:51], v[148:151]
buffer_load_dwordx4 v3, s[48:51], s32 offen offset:1024 sc1 lds
v_mfma_f32_16x16x32_bf16 v[152:155], a[56:59], v[48:51], v[152:155]
v_exp_f32 v38, v38
v_mfma_f32_16x16x32_bf16 v[184:187], a[56:59], v[52:55], v[184:187]
v_exp_f32 v39, v39
v_mfma_f32_16x16x32_bf16 v[216:219], a[56:59], v[56:59], v[216:219]
ds_read_b128 a[28:31], v1 offset:15360
v_cvt_pk_bf16_f32 v71, v38, v39
v_mfma_f32_16x16x32_bf16 v[248:251], a[56:59], v[60:63], v[248:251]
v_mfma_f32_16x16x32_bf16 v[252:255], a[60:63], v[60:63], v[252:255]
v_exp_f32 v40, v40
v_mfma_f32_16x16x32_bf16 v[220:223], a[60:63], v[56:59], v[220:223]
v_exp_f32 v41, v41
v_mfma_f32_16x16x32_bf16 v[188:191], a[60:63], v[52:55], v[188:191]
ds_read_b128 a[32:35], v1 offset:0
v_cvt_pk_bf16_f32 v74, v40, v41
v_mfma_f32_16x16x32_bf16 v[156:159], a[60:63], v[48:51], v[156:159]
v_smfmac_f32_16x16x64_bf16 a[224:227], a[232:235], v[48:55], v9
v_exp_f32 v42, v42
v_smfmac_f32_16x16x64_bf16 a[228:231], a[232:235], v[56:63], v9
s_waitcnt lgkmcnt(5)
v_exp_f32 v43, v43
v_mfma_f32_16x16x32_bf16 v[16:19], a[0:3], a[160:163], v[80:83]
ds_read_b128 a[36:39], v1 offset:1024
v_cvt_pk_bf16_f32 v75, v42, v43
v_mfma_f32_16x16x32_bf16 v[16:19], a[4:7], a[164:167], v[16:19]
v_exp_f32 v44, v44
v_mfma_f32_16x16x32_bf16 v[16:19], a[8:11], a[168:171], v[16:19]
v_mfma_f32_16x16x32_bf16 v[16:19], a[12:15], a[172:175], v[16:19]
v_exp_f32 v45, v45
v_mfma_f32_16x16x32_bf16 v[20:23], a[0:3], a[176:179], v[84:87]
ds_read_b128 a[40:43], v1 offset:2048
v_cvt_pk_bf16_f32 v78, v44, v45
v_mfma_f32_16x16x32_bf16 v[20:23], a[4:7], a[180:183], v[20:23]
buffer_load_dwordx4 v3, s[48:51], s32 offen offset:2048 sc1 lds
v_mfma_f32_16x16x32_bf16 v[20:23], a[8:11], a[184:187], v[20:23]
v_exp_f32 v46, v46
v_mfma_f32_16x16x32_bf16 v[20:23], a[12:15], a[188:191], v[20:23]
ds_read_b128 a[44:47], v1 offset:3072
v_mfma_f32_16x16x32_bf16 v[24:27], a[0:3], a[192:195], v[88:91]
v_mfma_f32_16x16x32_bf16 v[24:27], a[4:7], a[196:199], v[24:27]
v_exp_f32 v47, v47
v_mfma_f32_16x16x32_bf16 v[24:27], a[8:11], a[200:203], v[24:27]
v_exp_f32 v16, v16
v_mfma_f32_16x16x32_bf16 v[24:27], a[12:15], a[204:207], v[24:27]
ds_read_b128 a[48:51], v1 offset:4096
v_cvt_pk_bf16_f32 v79, v46, v47
v_mfma_f32_16x16x32_bf16 v[28:31], a[0:3], a[208:211], v[92:95]
v_mfma_f32_16x16x32_bf16 v[28:31], a[4:7], a[212:215], v[28:31]
v_exp_f32 v17, v17
v_mfma_f32_16x16x32_bf16 v[28:31], a[8:11], a[216:219], v[28:31]
s_waitcnt lgkmcnt(5)
v_exp_f32 v18, v18
v_mfma_f32_16x16x32_bf16 v[28:31], a[12:15], a[220:223], v[28:31]
ds_read_b128 a[52:55], v1 offset:5120
v_cvt_pk_bf16_f32 v48, v16, v17
v_mfma_f32_16x16x32_bf16 v[32:35], a[16:19], a[160:163], v[80:83]
v_mfma_f32_16x16x32_bf16 v[32:35], a[20:23], a[164:167], v[32:35]
v_exp_f32 v19, v19
v_mfma_f32_16x16x32_bf16 v[32:35], a[24:27], a[168:171], v[32:35]
v_exp_f32 v20, v20
v_mfma_f32_16x16x32_bf16 v[32:35], a[28:31], a[172:175], v[32:35]
ds_read_b128 a[56:59], v1 offset:6144
v_cvt_pk_bf16_f32 v49, v18, v19
v_mfma_f32_16x16x32_bf16 v[36:39], a[16:19], a[176:179], v[84:87]
v_exp_f32 v21, v21
v_mfma_f32_16x16x32_bf16 v[36:39], a[20:23], a[180:183], v[36:39]
buffer_load_dwordx4 v3, s[48:51], s32 offen offset:3072 sc1 lds
v_mfma_f32_16x16x32_bf16 v[36:39], a[24:27], a[184:187], v[36:39]
s_add_u32 s32, s32, 0x8000
v_cvt_pk_bf16_f32 v52, v20, v21
v_mfma_f32_16x16x32_bf16 v[36:39], a[28:31], a[188:191], v[36:39]
ds_read_b128 a[60:63], v1 offset:7168
v_mfma_f32_16x16x32_bf16 v[40:43], a[16:19], a[192:195], v[88:91]
v_exp_f32 v22, v22
v_mfma_f32_16x16x32_bf16 v[40:43], a[20:23], a[196:199], v[40:43]
v_exp_f32 v23, v23
v_mfma_f32_16x16x32_bf16 v[40:43], a[24:27], a[200:203], v[40:43]
v_cvt_pk_bf16_f32 v53, v22, v23
v_mfma_f32_16x16x32_bf16 v[40:43], a[28:31], a[204:207], v[40:43]
v_exp_f32 v24, v24
v_mfma_f32_16x16x32_bf16 v[44:47], a[16:19], a[208:211], v[92:95]
v_exp_f32 v25, v25
v_mfma_f32_16x16x32_bf16 v[44:47], a[20:23], a[212:215], v[44:47]
v_exp_f32 v26, v26
v_mfma_f32_16x16x32_bf16 v[44:47], a[24:27], a[216:219], v[44:47]
v_exp_f32 v27, v27
v_mfma_f32_16x16x32_bf16 v[44:47], a[28:31], a[220:223], v[44:47]
s_waitcnt lgkmcnt(0)
v_mfma_f32_16x16x32_bf16 v[128:131], a[32:35], v[64:67], v[128:131]
ds_read_b128 a[0:3], v1 offset:24576
v_cvt_pk_bf16_f32 v56, v24, v25
v_mfma_f32_16x16x32_bf16 v[160:163], a[32:35], v[68:71], v[160:163]
v_exp_f32 v28, v28
v_mfma_f32_16x16x32_bf16 v[192:195], a[32:35], v[72:75], v[192:195]
v_cvt_pk_bf16_f32 v57, v26, v27
v_mfma_f32_16x16x32_bf16 v[224:227], a[32:35], v[76:79], v[224:227]
ds_read_b128 a[4:7], v1 offset:25600
v_mfma_f32_16x16x32_bf16 v[228:231], a[36:39], v[76:79], v[228:231]
v_exp_f32 v29, v29
v_mfma_f32_16x16x32_bf16 v[196:199], a[36:39], v[72:75], v[196:199]
v_exp_f32 v30, v30
v_mfma_f32_16x16x32_bf16 v[164:167], a[36:39], v[68:71], v[164:167]
s_add_u32 m0, s27, 0x1000
v_cvt_pk_bf16_f32 v60, v28, v29
v_mfma_f32_16x16x32_bf16 v[132:135], a[36:39], v[64:67], v[132:135]
buffer_load_dwordx4 v3, s[48:51], s7 offen offset:0 sc1 lds
v_mfma_f32_16x16x32_bf16 v[136:139], a[40:43], v[64:67], v[136:139]
ds_read_b128 a[8:11], v1 offset:26624
v_mfma_f32_16x16x32_bf16 v[168:171], a[40:43], v[68:71], v[168:171]
v_exp_f32 v31, v31
v_mfma_f32_16x16x32_bf16 v[200:203], a[40:43], v[72:75], v[200:203]
v_exp_f32 v32, v32
v_mfma_f32_16x16x32_bf16 v[232:235], a[40:43], v[76:79], v[232:235]
ds_read_b128 a[12:15], v1 offset:27648
v_cvt_pk_bf16_f32 v61, v30, v31
v_mfma_f32_16x16x32_bf16 v[236:239], a[44:47], v[76:79], v[236:239]
v_mfma_f32_16x16x32_bf16 v[204:207], a[44:47], v[72:75], v[204:207]
v_exp_f32 v33, v33
v_mfma_f32_16x16x32_bf16 v[172:175], a[44:47], v[68:71], v[172:175]
v_exp_f32 v34, v34
v_mfma_f32_16x16x32_bf16 v[140:143], a[44:47], v[64:67], v[140:143]
ds_read_b128 a[16:19], v1 offset:28672
v_cvt_pk_bf16_f32 v50, v32, v33
v_mfma_f32_16x16x32_bf16 v[144:147], a[48:51], v[64:67], v[144:147]
v_mfma_f32_16x16x32_bf16 v[176:179], a[48:51], v[68:71], v[176:179]
v_exp_f32 v35, v35
v_mfma_f32_16x16x32_bf16 v[208:211], a[48:51], v[72:75], v[208:211]
ds_read_b128 a[20:23], v1 offset:29696
v_cvt_pk_bf16_f32 v51, v34, v35
v_mfma_f32_16x16x32_bf16 v[240:243], a[48:51], v[76:79], v[240:243]
v_exp_f32 v36, v36
v_mfma_f32_16x16x32_bf16 v[244:247], a[52:55], v[76:79], v[244:247]
v_exp_f32 v37, v37
v_mfma_f32_16x16x32_bf16 v[212:215], a[52:55], v[72:75], v[212:215]
v_cvt_pk_bf16_f32 v54, v36, v37
v_mfma_f32_16x16x32_bf16 v[180:183], a[52:55], v[68:71], v[180:183]
buffer_load_dwordx4 v3, s[48:51], s7 offen offset:1024 sc1 lds
v_mfma_f32_16x16x32_bf16 v[148:151], a[52:55], v[64:67], v[148:151]
ds_read_b128 a[24:27], v1 offset:30720
v_mfma_f32_16x16x32_bf16 v[152:155], a[56:59], v[64:67], v[152:155]
v_exp_f32 v38, v38
v_mfma_f32_16x16x32_bf16 v[184:187], a[56:59], v[68:71], v[184:187]
v_exp_f32 v39, v39
v_mfma_f32_16x16x32_bf16 v[216:219], a[56:59], v[72:75], v[216:219]
ds_read_b128 a[28:31], v1 offset:31744
v_cvt_pk_bf16_f32 v55, v38, v39
v_mfma_f32_16x16x32_bf16 v[248:251], a[56:59], v[76:79], v[248:251]
v_mfma_f32_16x16x32_bf16 v[252:255], a[60:63], v[76:79], v[252:255]
v_exp_f32 v40, v40
v_mfma_f32_16x16x32_bf16 v[220:223], a[60:63], v[72:75], v[220:223]
v_exp_f32 v41, v41
v_mfma_f32_16x16x32_bf16 v[188:191], a[60:63], v[68:71], v[188:191]
ds_read_b128 a[32:35], v1 offset:16384
v_cvt_pk_bf16_f32 v58, v40, v41
v_mfma_f32_16x16x32_bf16 v[156:159], a[60:63], v[64:67], v[156:159]
v_smfmac_f32_16x16x64_bf16 a[224:227], a[232:235], v[64:71], v9
s_waitcnt lgkmcnt(5)
v_exp_f32 v42, v42
v_smfmac_f32_16x16x64_bf16 a[228:231], a[232:235], v[72:79], v9
ds_read_b128 a[36:39], v1 offset:17408
v_mfma_f32_16x16x32_bf16 v[16:19], a[0:3], a[160:163], v[80:83]
v_exp_f32 v43, v43
v_mfma_f32_16x16x32_bf16 v[16:19], a[4:7], a[164:167], v[16:19]
v_exp_f32 v44, v44
v_mfma_f32_16x16x32_bf16 v[16:19], a[8:11], a[168:171], v[16:19]
v_cvt_pk_bf16_f32 v59, v42, v43
v_mfma_f32_16x16x32_bf16 v[16:19], a[12:15], a[172:175], v[16:19]
ds_read_b128 a[40:43], v1 offset:18432
v_mfma_f32_16x16x32_bf16 v[20:23], a[0:3], a[176:179], v[84:87]
buffer_load_dwordx4 v3, s[48:51], s7 offen offset:2048 sc1 lds
v_mfma_f32_16x16x32_bf16 v[20:23], a[4:7], a[180:183], v[20:23]
v_exp_f32 v45, v45
v_mfma_f32_16x16x32_bf16 v[20:23], a[8:11], a[184:187], v[20:23]
v_exp_f32 v46, v46
v_mfma_f32_16x16x32_bf16 v[20:23], a[12:15], a[188:191], v[20:23]
ds_read_b128 a[44:47], v1 offset:19456
v_cvt_pk_bf16_f32 v62, v44, v45
v_mfma_f32_16x16x32_bf16 v[24:27], a[0:3], a[192:195], v[88:91]
v_mfma_f32_16x16x32_bf16 v[24:27], a[4:7], a[196:199], v[24:27]
v_exp_f32 v47, v47
v_mfma_f32_16x16x32_bf16 v[24:27], a[8:11], a[200:203], v[24:27]
v_exp_f32 v16, v16
v_mfma_f32_16x16x32_bf16 v[24:27], a[12:15], a[204:207], v[24:27]
ds_read_b128 a[48:51], v1 offset:20480
v_cvt_pk_bf16_f32 v63, v46, v47
v_mfma_f32_16x16x32_bf16 v[28:31], a[0:3], a[208:211], v[92:95]
v_mfma_f32_16x16x32_bf16 v[28:31], a[4:7], a[212:215], v[28:31]
v_exp_f32 v17, v17
v_mfma_f32_16x16x32_bf16 v[28:31], a[8:11], a[216:219], v[28:31]
ds_read_b128 a[52:55], v1 offset:21504
v_cvt_pk_bf16_f32 v64, v16, v17
v_mfma_f32_16x16x32_bf16 v[28:31], a[12:15], a[220:223], v[28:31]
s_waitcnt lgkmcnt(6)
v_exp_f32 v18, v18
v_mfma_f32_16x16x32_bf16 v[32:35], a[16:19], a[160:163], v[80:83]
v_mfma_f32_16x16x32_bf16 v[32:35], a[20:23], a[164:167], v[32:35]
v_exp_f32 v19, v19
v_mfma_f32_16x16x32_bf16 v[32:35], a[24:27], a[168:171], v[32:35]
ds_read_b128 a[56:59], v1 offset:22528
v_cvt_pk_bf16_f32 v65, v18, v19
v_mfma_f32_16x16x32_bf16 v[32:35], a[28:31], a[172:175], v[32:35]
buffer_load_dwordx4 v3, s[48:51], s7 offen offset:3072 sc1 lds
v_mfma_f32_16x16x32_bf16 v[36:39], a[16:19], a[176:179], v[84:87]
s_add_u32 s7, s7, 0x8000
v_exp_f32 v20, v20
v_mfma_f32_16x16x32_bf16 v[36:39], a[20:23], a[180:183], v[36:39]
s_xor_b32 s27, s27, 0x38000
v_exp_f32 v21, v21
v_mfma_f32_16x16x32_bf16 v[36:39], a[24:27], a[184:187], v[36:39]
ds_read_b128 a[60:63], v1 offset:23552
v_xor_b32 v1, 0x8000, v1
v_mfma_f32_16x16x32_bf16 v[36:39], a[28:31], a[188:191], v[36:39]
v_cvt_pk_bf16_f32 v68, v20, v21
v_mfma_f32_16x16x32_bf16 v[40:43], a[16:19], a[192:195], v[88:91]
v_exp_f32 v22, v22
v_mfma_f32_16x16x32_bf16 v[40:43], a[20:23], a[196:199], v[40:43]
v_exp_f32 v23, v23
v_mfma_f32_16x16x32_bf16 v[40:43], a[24:27], a[200:203], v[40:43]
v_cvt_pk_bf16_f32 v69, v22, v23
v_mfma_f32_16x16x32_bf16 v[40:43], a[28:31], a[204:207], v[40:43]
v_exp_f32 v24, v24
v_mfma_f32_16x16x32_bf16 v[44:47], a[16:19], a[208:211], v[92:95]
v_exp_f32 v25, v25
v_mfma_f32_16x16x32_bf16 v[44:47], a[20:23], a[212:215], v[44:47]
v_exp_f32 v26, v26
v_mfma_f32_16x16x32_bf16 v[44:47], a[24:27], a[216:219], v[44:47]
s_waitcnt vmcnt(16) lgkmcnt(0)
v_exp_f32 v27, v27
v_mfma_f32_16x16x32_bf16 v[44:47], a[28:31], a[220:223], v[44:47]
s_barrier
L_att_dodd0:
v_mfma_f32_16x16x32_bf16 v[128:131], a[32:35], v[48:51], v[128:131]
ds_read_b128 a[0:3], v2 offset:8192
v_cvt_pk_bf16_f32 v72, v24, v25
v_mfma_f32_16x16x32_bf16 v[160:163], a[32:35], v[52:55], v[160:163]
v_exp_f32 v28, v28
v_mfma_f32_16x16x32_bf16 v[192:195], a[32:35], v[56:59], v[192:195]
v_cvt_pk_bf16_f32 v73, v26, v27
v_mfma_f32_16x16x32_bf16 v[224:227], a[32:35], v[60:63], v[224:227]
ds_read_b128 a[4:7], v2 offset:9216
v_mfma_f32_16x16x32_bf16 v[228:231], a[36:39], v[60:63], v[228:231]
v_exp_f32 v29, v29
v_mfma_f32_16x16x32_bf16 v[196:199], a[36:39], v[56:59], v[196:199]
v_exp_f32 v30, v30
v_mfma_f32_16x16x32_bf16 v[164:167], a[36:39], v[52:55], v[164:167]
s_add_u32 m0, s19, 0x0
v_cvt_pk_bf16_f32 v76, v28, v29
v_mfma_f32_16x16x32_bf16 v[132:135], a[36:39], v[48:51], v[132:135]
buffer_load_dwordx4 v3, s[48:51], s32 offen offset:0 sc1 lds
v_mfma_f32_16x16x32_bf16 v[136:139], a[40:43], v[48:51], v[136:139]
ds_read_b128 a[8:11], v2 offset:10240
v_mfma_f32_16x16x32_bf16 v[168:171], a[40:43], v[52:55], v[168:171]
v_exp_f32 v31, v31
v_mfma_f32_16x16x32_bf16 v[200:203], a[40:43], v[56:59], v[200:203]
v_exp_f32 v32, v32
v_mfma_f32_16x16x32_bf16 v[232:235], a[40:43], v[60:63], v[232:235]
ds_read_b128 a[12:15], v2 offset:11264
v_cvt_pk_bf16_f32 v77, v30, v31
v_mfma_f32_16x16x32_bf16 v[236:239], a[44:47], v[60:63], v[236:239]
v_mfma_f32_16x16x32_bf16 v[204:207], a[44:47], v[56:59], v[204:207]
v_exp_f32 v33, v33
v_mfma_f32_16x16x32_bf16 v[172:175], a[44:47], v[52:55], v[172:175]
v_exp_f32 v34, v34
v_mfma_f32_16x16x32_bf16 v[140:143], a[44:47], v[48:51], v[140:143]
ds_read_b128 a[16:19], v2 offset:12288
v_cvt_pk_bf16_f32 v66, v32, v33
v_mfma_f32_16x16x32_bf16 v[144:147], a[48:51], v[48:51], v[144:147]
v_mfma_f32_16x16x32_bf16 v[176:179], a[48:51], v[52:55], v[176:179]
v_exp_f32 v35, v35
v_mfma_f32_16x16x32_bf16 v[208:211], a[48:51], v[56:59], v[208:211]
v_exp_f32 v36, v36
v_mfma_f32_16x16x32_bf16 v[240:243], a[48:51], v[60:63], v[240:243]
ds_read_b128 a[20:23], v2 offset:13312
v_cvt_pk_bf16_f32 v67, v34, v35
v_mfma_f32_16x16x32_bf16 v[244:247], a[52:55], v[60:63], v[244:247]
v_exp_f32 v37, v37
v_mfma_f32_16x16x32_bf16 v[212:215], a[52:55], v[56:59], v[212:215]
v_cvt_pk_bf16_f32 v70, v36, v37
v_mfma_f32_16x16x32_bf16 v[180:183], a[52:55], v[52:55], v[180:183]
ds_read_b128 a[24:27], v2 offset:14336
v_mfma_f32_16x16x32_bf16 v[148:151], a[52:55], v[48:51], v[148:151]
buffer_load_dwordx4 v3, s[48:51], s32 offen offset:1024 sc1 lds
v_mfma_f32_16x16x32_bf16 v[152:155], a[56:59], v[48:51], v[152:155]
v_exp_f32 v38, v38
v_mfma_f32_16x16x32_bf16 v[184:187], a[56:59], v[52:55], v[184:187]
v_exp_f32 v39, v39
v_mfma_f32_16x16x32_bf16 v[216:219], a[56:59], v[56:59], v[216:219]
ds_read_b128 a[28:31], v2 offset:15360
v_cvt_pk_bf16_f32 v71, v38, v39
v_mfma_f32_16x16x32_bf16 v[248:251], a[56:59], v[60:63], v[248:251]
v_mfma_f32_16x16x32_bf16 v[252:255], a[60:63], v[60:63], v[252:255]
v_exp_f32 v40, v40
v_mfma_f32_16x16x32_bf16 v[220:223], a[60:63], v[56:59], v[220:223]
v_exp_f32 v41, v41
v_mfma_f32_16x16x32_bf16 v[188:191], a[60:63], v[52:55], v[188:191]
ds_read_b128 a[32:35], v2 offset:0
v_cvt_pk_bf16_f32 v74, v40, v41
v_mfma_f32_16x16x32_bf16 v[156:159], a[60:63], v[48:51], v[156:159]
v_smfmac_f32_16x16x64_bf16 a[224:227], a[232:235], v[48:55], v9
v_exp_f32 v42, v42
v_smfmac_f32_16x16x64_bf16 a[228:231], a[232:235], v[56:63], v9
s_waitcnt lgkmcnt(5)
v_exp_f32 v43, v43
v_mfma_f32_16x16x32_bf16 v[16:19], a[0:3], a[160:163], v[80:83]
ds_read_b128 a[36:39], v2 offset:1024
v_cvt_pk_bf16_f32 v75, v42, v43
v_mfma_f32_16x16x32_bf16 v[16:19], a[4:7], a[164:167], v[16:19]
v_exp_f32 v44, v44
v_mfma_f32_16x16x32_bf16 v[16:19], a[8:11], a[168:171], v[16:19]
v_mfma_f32_16x16x32_bf16 v[16:19], a[12:15], a[172:175], v[16:19]
v_exp_f32 v45, v45
v_mfma_f32_16x16x32_bf16 v[20:23], a[0:3], a[176:179], v[84:87]
ds_read_b128 a[40:43], v2 offset:2048
v_cvt_pk_bf16_f32 v78, v44, v45
v_mfma_f32_16x16x32_bf16 v[20:23], a[4:7], a[180:183], v[20:23]
buffer_load_dwordx4 v3, s[48:51], s32 offen offset:2048 sc1 lds
v_mfma_f32_16x16x32_bf16 v[20:23], a[8:11], a[184:187], v[20:23]
v_exp_f32 v46, v46
v_mfma_f32_16x16x32_bf16 v[20:23], a[12:15], a[188:191], v[20:23]
ds_read_b128 a[44:47], v2 offset:3072
v_mfma_f32_16x16x32_bf16 v[24:27], a[0:3], a[192:195], v[88:91]
v_mfma_f32_16x16x32_bf16 v[24:27], a[4:7], a[196:199], v[24:27]
v_exp_f32 v47, v47
v_mfma_f32_16x16x32_bf16 v[24:27], a[8:11], a[200:203], v[24:27]
v_exp_f32 v16, v16
v_mfma_f32_16x16x32_bf16 v[24:27], a[12:15], a[204:207], v[24:27]
ds_read_b128 a[48:51], v2 offset:4096
v_cvt_pk_bf16_f32 v79, v46, v47
v_mfma_f32_16x16x32_bf16 v[28:31], a[0:3], a[208:211], v[92:95]
v_mfma_f32_16x16x32_bf16 v[28:31], a[4:7], a[212:215], v[28:31]
v_exp_f32 v17, v17
v_mfma_f32_16x16x32_bf16 v[28:31], a[8:11], a[216:219], v[28:31]
s_waitcnt lgkmcnt(5)
v_exp_f32 v18, v18
v_mfma_f32_16x16x32_bf16 v[28:31], a[12:15], a[220:223], v[28:31]
ds_read_b128 a[52:55], v2 offset:5120
v_cvt_pk_bf16_f32 v48, v16, v17
v_mfma_f32_16x16x32_bf16 v[32:35], a[16:19], a[160:163], v[80:83]
v_mfma_f32_16x16x32_bf16 v[32:35], a[20:23], a[164:167], v[32:35]
v_exp_f32 v19, v19
v_mfma_f32_16x16x32_bf16 v[32:35], a[24:27], a[168:171], v[32:35]
v_exp_f32 v20, v20
v_mfma_f32_16x16x32_bf16 v[32:35], a[28:31], a[172:175], v[32:35]
ds_read_b128 a[56:59], v2 offset:6144
v_cvt_pk_bf16_f32 v49, v18, v19
v_mfma_f32_16x16x32_bf16 v[36:39], a[16:19], a[176:179], v[84:87]
v_exp_f32 v21, v21
v_mfma_f32_16x16x32_bf16 v[36:39], a[20:23], a[180:183], v[36:39]
buffer_load_dwordx4 v3, s[48:51], s32 offen offset:3072 sc1 lds
v_mfma_f32_16x16x32_bf16 v[36:39], a[24:27], a[184:187], v[36:39]
s_add_u32 s32, s32, 0x8000
v_cvt_pk_bf16_f32 v52, v20, v21
v_mfma_f32_16x16x32_bf16 v[36:39], a[28:31], a[188:191], v[36:39]
ds_read_b128 a[60:63], v2 offset:7168
v_mfma_f32_16x16x32_bf16 v[40:43], a[16:19], a[192:195], v[88:91]
v_exp_f32 v22, v22
v_mfma_f32_16x16x32_bf16 v[40:43], a[20:23], a[196:199], v[40:43]
v_exp_f32 v23, v23
v_mfma_f32_16x16x32_bf16 v[40:43], a[24:27], a[200:203], v[40:43]
v_cvt_pk_bf16_f32 v53, v22, v23
v_mfma_f32_16x16x32_bf16 v[40:43], a[28:31], a[204:207], v[40:43]
v_exp_f32 v24, v24
v_mfma_f32_16x16x32_bf16 v[44:47], a[16:19], a[208:211], v[92:95]
v_exp_f32 v25, v25
v_mfma_f32_16x16x32_bf16 v[44:47], a[20:23], a[212:215], v[44:47]
v_exp_f32 v26, v26
v_mfma_f32_16x16x32_bf16 v[44:47], a[24:27], a[216:219], v[44:47]
v_exp_f32 v27, v27
v_mfma_f32_16x16x32_bf16 v[44:47], a[28:31], a[220:223], v[44:47]
s_waitcnt lgkmcnt(0)
v_mfma_f32_16x16x32_bf16 v[128:131], a[32:35], v[64:67], v[128:131]
ds_read_b128 a[0:3], v2 offset:24576
v_cvt_pk_bf16_f32 v56, v24, v25
v_mfma_f32_16x16x32_bf16 v[160:163], a[32:35], v[68:71], v[160:163]
v_exp_f32 v28, v28
v_mfma_f32_16x16x32_bf16 v[192:195], a[32:35], v[72:75], v[192:195]
v_cvt_pk_bf16_f32 v57, v26, v27
v_mfma_f32_16x16x32_bf16 v[224:227], a[32:35], v[76:79], v[224:227]
ds_read_b128 a[4:7], v2 offset:25600
v_mfma_f32_16x16x32_bf16 v[228:231], a[36:39], v[76:79], v[228:231]
v_exp_f32 v29, v29
v_mfma_f32_16x16x32_bf16 v[196:199], a[36:39], v[72:75], v[196:199]
v_exp_f32 v30, v30
v_mfma_f32_16x16x32_bf16 v[164:167], a[36:39], v[68:71], v[164:167]
s_add_u32 m0, s19, 0x1000
v_cvt_pk_bf16_f32 v60, v28, v29
v_mfma_f32_16x16x32_bf16 v[132:135], a[36:39], v[64:67], v[132:135]
buffer_load_dwordx4 v3, s[48:51], s7 offen offset:0 sc1 lds
v_mfma_f32_16x16x32_bf16 v[136:139], a[40:43], v[64:67], v[136:139]
ds_read_b128 a[8:11], v2 offset:26624
v_mfma_f32_16x16x32_bf16 v[168:171], a[40:43], v[68:71], v[168:171]
v_exp_f32 v31, v31
v_mfma_f32_16x16x32_bf16 v[200:203], a[40:43], v[72:75], v[200:203]
v_exp_f32 v32, v32
v_mfma_f32_16x16x32_bf16 v[232:235], a[40:43], v[76:79], v[232:235]
ds_read_b128 a[12:15], v2 offset:27648
v_cvt_pk_bf16_f32 v61, v30, v31
v_mfma_f32_16x16x32_bf16 v[236:239], a[44:47], v[76:79], v[236:239]
v_mfma_f32_16x16x32_bf16 v[204:207], a[44:47], v[72:75], v[204:207]
v_exp_f32 v33, v33
v_mfma_f32_16x16x32_bf16 v[172:175], a[44:47], v[68:71], v[172:175]
v_exp_f32 v34, v34
v_mfma_f32_16x16x32_bf16 v[140:143], a[44:47], v[64:67], v[140:143]
ds_read_b128 a[16:19], v2 offset:28672
v_cvt_pk_bf16_f32 v50, v32, v33
v_mfma_f32_16x16x32_bf16 v[144:147], a[48:51], v[64:67], v[144:147]
v_exp_f32 v35, v35
v_mfma_f32_16x16x32_bf16 v[176:179], a[48:51], v[68:71], v[176:179]
v_cvt_pk_bf16_f32 v51, v34, v35
v_mfma_f32_16x16x32_bf16 v[208:211], a[48:51], v[72:75], v[208:211]
ds_read_b128 a[20:23], v2 offset:29696
v_mfma_f32_16x16x32_bf16 v[240:243], a[48:51], v[76:79], v[240:243]
v_exp_f32 v36, v36
v_mfma_f32_16x16x32_bf16 v[244:247], a[52:55], v[76:79], v[244:247]
v_exp_f32 v37, v37
v_mfma_f32_16x16x32_bf16 v[212:215], a[52:55], v[72:75], v[212:215]
v_cvt_pk_bf16_f32 v54, v36, v37
v_mfma_f32_16x16x32_bf16 v[180:183], a[52:55], v[68:71], v[180:183]
buffer_load_dwordx4 v3, s[48:51], s7 offen offset:1024 sc1 lds
v_mfma_f32_16x16x32_bf16 v[148:151], a[52:55], v[64:67], v[148:151]
ds_read_b128 a[24:27], v2 offset:30720
v_mfma_f32_16x16x32_bf16 v[152:155], a[56:59], v[64:67], v[152:155]
v_exp_f32 v38, v38
v_mfma_f32_16x16x32_bf16 v[184:187], a[56:59], v[68:71], v[184:187]
v_exp_f32 v39, v39
v_mfma_f32_16x16x32_bf16 v[216:219], a[56:59], v[72:75], v[216:219]
ds_read_b128 a[28:31], v2 offset:31744
v_cvt_pk_bf16_f32 v55, v38, v39
v_mfma_f32_16x16x32_bf16 v[248:251], a[56:59], v[76:79], v[248:251]
v_exp_f32 v40, v40
v_mfma_f32_16x16x32_bf16 v[252:255], a[60:63], v[76:79], v[252:255]
v_mfma_f32_16x16x32_bf16 v[220:223], a[60:63], v[72:75], v[220:223]
v_exp_f32 v41, v41
v_mfma_f32_16x16x32_bf16 v[188:191], a[60:63], v[68:71], v[188:191]
ds_read_b128 a[32:35], v2 offset:16384
v_cvt_pk_bf16_f32 v58, v40, v41
v_mfma_f32_16x16x32_bf16 v[156:159], a[60:63], v[64:67], v[156:159]
v_exp_f32 v42, v42
v_smfmac_f32_16x16x64_bf16 a[224:227], a[232:235], v[64:71], v9
s_waitcnt lgkmcnt(5)
v_smfmac_f32_16x16x64_bf16 a[228:231], a[232:235], v[72:79], v9
ds_read_b128 a[36:39], v2 offset:17408
v_mfma_f32_16x16x32_bf16 v[16:19], a[0:3], a[160:163], v[80:83]
v_exp_f32 v43, v43
v_mfma_f32_16x16x32_bf16 v[16:19], a[4:7], a[164:167], v[16:19]
v_exp_f32 v44, v44
v_mfma_f32_16x16x32_bf16 v[16:19], a[8:11], a[168:171], v[16:19]
buffer_load_dwordx4 v3, s[48:51], s7 offen offset:2048 sc1 lds
v_mfma_f32_16x16x32_bf16 v[16:19], a[12:15], a[172:175], v[16:19]
ds_read_b128 a[40:43], v2 offset:18432
v_cvt_pk_bf16_f32 v59, v42, v43
v_mfma_f32_16x16x32_bf16 v[20:23], a[0:3], a[176:179], v[84:87]
v_exp_f32 v45, v45
v_mfma_f32_16x16x32_bf16 v[20:23], a[4:7], a[180:183], v[20:23]
v_cvt_pk_bf16_f32 v62, v44, v45
v_mfma_f32_16x16x32_bf16 v[20:23], a[8:11], a[184:187], v[20:23]
v_exp_f32 v46, v46
v_mfma_f32_16x16x32_bf16 v[20:23], a[12:15], a[188:191], v[20:23]
ds_read_b128 a[44:47], v2 offset:19456
v_mfma_f32_16x16x32_bf16 v[24:27], a[0:3], a[192:195], v[88:91]
v_exp_f32 v47, v47
v_mfma_f32_16x16x32_bf16 v[24:27], a[4:7], a[196:199], v[24:27]
v_cvt_pk_bf16_f32 v63, v46, v47
v_mfma_f32_16x16x32_bf16 v[24:27], a[8:11], a[200:203], v[24:27]
v_exp_f32 v16, v16
v_mfma_f32_16x16x32_bf16 v[24:27], a[12:15], a[204:207], v[24:27]
ds_read_b128 a[48:51], v2 offset:20480
v_mfma_f32_16x16x32_bf16 v[28:31], a[0:3], a[208:211], v[92:95]
v_exp_f32 v17, v17
v_mfma_f32_16x16x32_bf16 v[28:31], a[4:7], a[212:215], v[28:31]
v_exp_f32 v18, v18
v_mfma_f32_16x16x32_bf16 v[28:31], a[8:11], a[216:219], v[28:31]
ds_read_b128 a[52:55], v2 offset:21504
v_cvt_pk_bf16_f32 v64, v16, v17
v_mfma_f32_16x16x32_bf16 v[28:31], a[12:15], a[220:223], v[28:31]
s_waitcnt lgkmcnt(6)
v_mfma_f32_16x16x32_bf16 v[32:35], a[16:19], a[160:163], v[80:83]
v_exp_f32 v19, v19
v_mfma_f32_16x16x32_bf16 v[32:35], a[20:23], a[164:167], v[32:35]
buffer_load_dwordx4 v3, s[48:51], s7 offen offset:3072 sc1 lds
v_mfma_f32_16x16x32_bf16 v[32:35], a[24:27], a[168:171], v[32:35]
ds_read_b128 a[56:59], v2 offset:22528
v_cvt_pk_bf16_f32 v65, v18, v19
v_mfma_f32_16x16x32_bf16 v[32:35], a[28:31], a[172:175], v[32:35]
s_add_u32 s7, s7, 0x8000
v_exp_f32 v20, v20
v_mfma_f32_16x16x32_bf16 v[36:39], a[16:19], a[176:179], v[84:87]
s_xor_b32 s19, s19, 0x8000
v_mfma_f32_16x16x32_bf16 v[36:39], a[20:23], a[180:183], v[36:39]
s_sub_u32 s15, s15, 1
v_exp_f32 v21, v21
v_mfma_f32_16x16x32_bf16 v[36:39], a[24:27], a[184:187], v[36:39]
ds_read_b128 a[60:63], v2 offset:23552
v_xor_b32 v2, 0x38000, v2
v_mfma_f32_16x16x32_bf16 v[36:39], a[28:31], a[188:191], v[36:39]
s_cmp_lg_u32 s15, 0
v_exp_f32 v22, v22
v_mfma_f32_16x16x32_bf16 v[40:43], a[16:19], a[192:195], v[88:91]
v_exp_f32 v23, v23
v_mfma_f32_16x16x32_bf16 v[40:43], a[20:23], a[196:199], v[40:43]
v_cvt_pk_bf16_f32 v68, v20, v21
v_cvt_pk_bf16_f32 v69, v22, v23
v_mfma_f32_16x16x32_bf16 v[40:43], a[24:27], a[200:203], v[40:43]
v_exp_f32 v24, v24
v_mfma_f32_16x16x32_bf16 v[40:43], a[28:31], a[204:207], v[40:43]
v_exp_f32 v25, v25
v_mfma_f32_16x16x32_bf16 v[44:47], a[16:19], a[208:211], v[92:95]
v_exp_f32 v26, v26
v_mfma_f32_16x16x32_bf16 v[44:47], a[20:23], a[212:215], v[44:47]
v_exp_f32 v27, v27
v_mfma_f32_16x16x32_bf16 v[44:47], a[24:27], a[216:219], v[44:47]
s_waitcnt vmcnt(16) lgkmcnt(0)
v_mfma_f32_16x16x32_bf16 v[44:47], a[28:31], a[220:223], v[44:47]
s_barrier
s_cbranch_scc1 L_att_deven0
s_branch L_att_ddone
L_att_deven1:
v_mfma_f32_16x16x32_bf16 v[128:131], a[32:35], v[48:51], v[128:131]
ds_read_b128 a[0:3], v1 offset:8192
v_cvt_pk_bf16_f32 v72, v24, v25
v_mfma_f32_16x16x32_bf16 v[160:163], a[32:35], v[52:55], v[160:163]
v_exp_f32 v28, v28
v_mfma_f32_16x16x32_bf16 v[192:195], a[32:35], v[56:59], v[192:195]
v_cvt_pk_bf16_f32 v73, v26, v27
v_mfma_f32_16x16x32_bf16 v[224:227], a[32:35], v[60:63], v[224:227]
ds_read_b128 a[4:7], v1 offset:9216
v_mfma_f32_16x16x32_bf16 v[228:231], a[36:39], v[60:63], v[228:231]
v_exp_f32 v29, v29
v_mfma_f32_16x16x32_bf16 v[196:199], a[36:39], v[56:59], v[196:199]
v_exp_f32 v30, v30
v_mfma_f32_16x16x32_bf16 v[164:167], a[36:39], v[52:55], v[164:167]
s_add_u32 m0, s27, 0x0
v_cvt_pk_bf16_f32 v76, v28, v29
v_mfma_f32_16x16x32_bf16 v[132:135], a[36:39], v[48:51], v[132:135]
buffer_load_dwordx4 v3, s[48:51], s32 offen offset:0 sc1 lds
v_mfma_f32_16x16x32_bf16 v[136:139], a[40:43], v[48:51], v[136:139]
ds_read_b128 a[8:11], v1 offset:10240
v_mfma_f32_16x16x32_bf16 v[168:171], a[40:43], v[52:55], v[168:171]
v_exp_f32 v31, v31
v_mfma_f32_16x16x32_bf16 v[200:203], a[40:43], v[56:59], v[200:203]
v_exp_f32 v32, v32
v_mfma_f32_16x16x32_bf16 v[232:235], a[40:43], v[60:63], v[232:235]
ds_read_b128 a[12:15], v1 offset:11264
v_cvt_pk_bf16_f32 v77, v30, v31
v_mfma_f32_16x16x32_bf16 v[236:239], a[44:47], v[60:63], v[236:239]
v_mfma_f32_16x16x32_bf16 v[204:207], a[44:47], v[56:59], v[204:207]
v_exp_f32 v33, v33
v_mfma_f32_16x16x32_bf16 v[172:175], a[44:47], v[52:55], v[172:175]
v_exp_f32 v34, v34
v_mfma_f32_16x16x32_bf16 v[140:143], a[44:47], v[48:51], v[140:143]
ds_read_b128 a[16:19], v1 offset:12288
v_cvt_pk_bf16_f32 v66, v32, v33
v_mfma_f32_16x16x32_bf16 v[144:147], a[48:51], v[48:51], v[144:147]
v_mfma_f32_16x16x32_bf16 v[176:179], a[48:51], v[52:55], v[176:179]
v_exp_f32 v35, v35
v_mfma_f32_16x16x32_bf16 v[208:211], a[48:51], v[56:59], v[208:211]
v_exp_f32 v36, v36
v_mfma_f32_16x16x32_bf16 v[240:243], a[48:51], v[60:63], v[240:243]
ds_read_b128 a[20:23], v1 offset:13312
v_cvt_pk_bf16_f32 v67, v34, v35
v_mfma_f32_16x16x32_bf16 v[244:247], a[52:55], v[60:63], v[244:247]
v_exp_f32 v37, v37
v_mfma_f32_16x16x32_bf16 v[212:215], a[52:55], v[56:59], v[212:215]
v_cvt_pk_bf16_f32 v70, v36, v37
v_mfma_f32_16x16x32_bf16 v[180:183], a[52:55], v[52:55], v[180:183]
ds_read_b128 a[24:27], v1 offset:14336
v_mfma_f32_16x16x32_bf16 v[148:151], a[52:55], v[48:51], v[148:151]
buffer_load_dwordx4 v3, s[48:51], s32 offen offset:1024 sc1 lds
v_mfma_f32_16x16x32_bf16 v[152:155], a[56:59], v[48:51], v[152:155]
v_exp_f32 v38, v38
v_mfma_f32_16x16x32_bf16 v[184:187], a[56:59], v[52:55], v[184:187]
v_exp_f32 v39, v39
v_mfma_f32_16x16x32_bf16 v[216:219], a[56:59], v[56:59], v[216:219]
ds_read_b128 a[28:31], v1 offset:15360
v_cvt_pk_bf16_f32 v71, v38, v39
v_mfma_f32_16x16x32_bf16 v[248:251], a[56:59], v[60:63], v[248:251]
v_mfma_f32_16x16x32_bf16 v[252:255], a[60:63], v[60:63], v[252:255]
v_exp_f32 v40, v40
v_mfma_f32_16x16x32_bf16 v[220:223], a[60:63], v[56:59], v[220:223]
v_exp_f32 v41, v41
v_mfma_f32_16x16x32_bf16 v[188:191], a[60:63], v[52:55], v[188:191]
ds_read_b128 a[32:35], v1 offset:0
v_cvt_pk_bf16_f32 v74, v40, v41
v_mfma_f32_16x16x32_bf16 v[156:159], a[60:63], v[48:51], v[156:159]
v_smfmac_f32_16x16x64_bf16 a[224:227], a[232:235], v[48:55], v9
v_exp_f32 v42, v42
v_smfmac_f32_16x16x64_bf16 a[228:231], a[232:235], v[56:63], v9
s_waitcnt lgkmcnt(5)
v_exp_f32 v43, v43
v_mfma_f32_16x16x32_bf16 v[16:19], a[0:3], a[160:163], v[80:83]
ds_read_b128 a[36:39], v1 offset:1024
v_cvt_pk_bf16_f32 v75, v42, v43
v_mfma_f32_16x16x32_bf16 v[16:19], a[4:7], a[164:167], v[16:19]
v_exp_f32 v44, v44
v_mfma_f32_16x16x32_bf16 v[16:19], a[8:11], a[168:171], v[16:19]
v_mfma_f32_16x16x32_bf16 v[16:19], a[12:15], a[172:175], v[16:19]
v_exp_f32 v45, v45
v_mfma_f32_16x16x32_bf16 v[20:23], a[0:3], a[176:179], v[84:87]
ds_read_b128 a[40:43], v1 offset:2048
v_cvt_pk_bf16_f32 v78, v44, v45
v_mfma_f32_16x16x32_bf16 v[20:23], a[4:7], a[180:183], v[20:23]
buffer_load_dwordx4 v3, s[48:51], s32 offen offset:2048 sc1 lds
v_mfma_f32_16x16x32_bf16 v[20:23], a[8:11], a[184:187], v[20:23]
v_exp_f32 v46, v46
v_mfma_f32_16x16x32_bf16 v[20:23], a[12:15], a[188:191], v[20:23]
ds_read_b128 a[44:47], v1 offset:3072
v_mfma_f32_16x16x32_bf16 v[24:27], a[0:3], a[192:195], v[88:91]
v_mfma_f32_16x16x32_bf16 v[24:27], a[4:7], a[196:199], v[24:27]
v_exp_f32 v47, v47
v_mfma_f32_16x16x32_bf16 v[24:27], a[8:11], a[200:203], v[24:27]
v_exp_f32 v16, v16
v_mfma_f32_16x16x32_bf16 v[24:27], a[12:15], a[204:207], v[24:27]
ds_read_b128 a[48:51], v1 offset:4096
v_cvt_pk_bf16_f32 v79, v46, v47
v_mfma_f32_16x16x32_bf16 v[28:31], a[0:3], a[208:211], v[92:95]
v_mfma_f32_16x16x32_bf16 v[28:31], a[4:7], a[212:215], v[28:31]
v_exp_f32 v17, v17
v_mfma_f32_16x16x32_bf16 v[28:31], a[8:11], a[216:219], v[28:31]
s_waitcnt lgkmcnt(5)
v_exp_f32 v18, v18
v_mfma_f32_16x16x32_bf16 v[28:31], a[12:15], a[220:223], v[28:31]
ds_read_b128 a[52:55], v1 offset:5120
v_cvt_pk_bf16_f32 v48, v16, v17
v_mfma_f32_16x16x32_bf16 v[32:35], a[16:19], a[160:163], v[80:83]
v_mfma_f32_16x16x32_bf16 v[32:35], a[20:23], a[164:167], v[32:35]
v_exp_f32 v19, v19
v_mfma_f32_16x16x32_bf16 v[32:35], a[24:27], a[168:171], v[32:35]
v_exp_f32 v20, v20
v_mfma_f32_16x16x32_bf16 v[32:35], a[28:31], a[172:175], v[32:35]
ds_read_b128 a[56:59], v1 offset:6144
v_cvt_pk_bf16_f32 v49, v18, v19
v_mfma_f32_16x16x32_bf16 v[36:39], a[16:19], a[176:179], v[84:87]
v_exp_f32 v21, v21
v_mfma_f32_16x16x32_bf16 v[36:39], a[20:23], a[180:183], v[36:39]
buffer_load_dwordx4 v3, s[48:51], s32 offen offset:3072 sc1 lds
v_mfma_f32_16x16x32_bf16 v[36:39], a[24:27], a[184:187], v[36:39]
s_add_u32 s32, s32, 0x8000
v_cvt_pk_bf16_f32 v52, v20, v21
v_mfma_f32_16x16x32_bf16 v[36:39], a[28:31], a[188:191], v[36:39]
ds_read_b128 a[60:63], v1 offset:7168
v_mfma_f32_16x16x32_bf16 v[40:43], a[16:19], a[192:195], v[88:91]
v_exp_f32 v22, v22
v_mfma_f32_16x16x32_bf16 v[40:43], a[20:23], a[196:199], v[40:43]
v_exp_f32 v23, v23
v_mfma_f32_16x16x32_bf16 v[40:43], a[24:27], a[200:203], v[40:43]
v_cvt_pk_bf16_f32 v53, v22, v23
v_mfma_f32_16x16x32_bf16 v[40:43], a[28:31], a[204:207], v[40:43]
v_exp_f32 v24, v24
v_mfma_f32_16x16x32_bf16 v[44:47], a[16:19], a[208:211], v[92:95]
v_exp_f32 v25, v25
v_mfma_f32_16x16x32_bf16 v[44:47], a[20:23], a[212:215], v[44:47]
v_exp_f32 v26, v26
v_mfma_f32_16x16x32_bf16 v[44:47], a[24:27], a[216:219], v[44:47]
v_exp_f32 v27, v27
v_mfma_f32_16x16x32_bf16 v[44:47], a[28:31], a[220:223], v[44:47]
s_waitcnt lgkmcnt(0)
v_mfma_f32_16x16x32_bf16 v[128:131], a[32:35], v[64:67], v[128:131]
ds_read_b128 a[0:3], v1 offset:24576
v_cvt_pk_bf16_f32 v56, v24, v25
v_mfma_f32_16x16x32_bf16 v[160:163], a[32:35], v[68:71], v[160:163]
v_exp_f32 v28, v28
v_mfma_f32_16x16x32_bf16 v[192:195], a[32:35], v[72:75], v[192:195]
v_cvt_pk_bf16_f32 v57, v26, v27
v_mfma_f32_16x16x32_bf16 v[224:227], a[32:35], v[76:79], v[224:227]
ds_read_b128 a[4:7], v1 offset:25600
v_mfma_f32_16x16x32_bf16 v[228:231], a[36:39], v[76:79], v[228:231]
v_exp_f32 v29, v29
v_mfma_f32_16x16x32_bf16 v[196:199], a[36:39], v[72:75], v[196:199]
v_exp_f32 v30, v30
v_mfma_f32_16x16x32_bf16 v[164:167], a[36:39], v[68:71], v[164:167]
s_add_u32 m0, s27, 0x1000
v_cvt_pk_bf16_f32 v60, v28, v29
v_mfma_f32_16x16x32_bf16 v[132:135], a[36:39], v[64:67], v[132:135]
buffer_load_dwordx4 v3, s[48:51], s7 offen offset:0 sc1 lds
v_mfma_f32_16x16x32_bf16 v[136:139], a[40:43], v[64:67], v[136:139]
ds_read_b128 a[8:11], v1 offset:26624
v_mfma_f32_16x16x32_bf16 v[168:171], a[40:43], v[68:71], v[168:171]
v_exp_f32 v31, v31
v_mfma_f32_16x16x32_bf16 v[200:203], a[40:43], v[72:75], v[200:203]
v_exp_f32 v32, v32
v_mfma_f32_16x16x32_bf16 v[232:235], a[40:43], v[76:79], v[232:235]
ds_read_b128 a[12:15], v1 offset:27648
v_cvt_pk_bf16_f32 v61, v30, v31
v_mfma_f32_16x16x32_bf16 v[236:239], a[44:47], v[76:79], v[236:239]
v_mfma_f32_16x16x32_bf16 v[204:207], a[44:47], v[72:75], v[204:207]
v_exp_f32 v33, v33
v_mfma_f32_16x16x32_bf16 v[172:175], a[44:47], v[68:71], v[172:175]
v_exp_f32 v34, v34
v_mfma_f32_16x16x32_bf16 v[140:143], a[44:47], v[64:67], v[140:143]
ds_read_b128 a[16:19], v1 offset:28672
v_cvt_pk_bf16_f32 v50, v32, v33
v_mfma_f32_16x16x32_bf16 v[144:147], a[48:51], v[64:67], v[144:147]
v_mfma_f32_16x16x32_bf16 v[176:179], a[48:51], v[68:71], v[176:179]
v_exp_f32 v35, v35
v_mfma_f32_16x16x32_bf16 v[208:211], a[48:51], v[72:75], v[208:211]
ds_read_b128 a[20:23], v1 offset:29696
v_cvt_pk_bf16_f32 v51, v34, v35
v_mfma_f32_16x16x32_bf16 v[240:243], a[48:51], v[76:79], v[240:243]
v_exp_f32 v36, v36
v_mfma_f32_16x16x32_bf16 v[244:247], a[52:55], v[76:79], v[244:247]
v_exp_f32 v37, v37
v_mfma_f32_16x16x32_bf16 v[212:215], a[52:55], v[72:75], v[212:215]
v_cvt_pk_bf16_f32 v54, v36, v37
v_mfma_f32_16x16x32_bf16 v[180:183], a[52:55], v[68:71], v[180:183]
buffer_load_dwordx4 v3, s[48:51], s7 offen offset:1024 sc1 lds
v_mfma_f32_16x16x32_bf16 v[148:151], a[52:55], v[64:67], v[148:151]
ds_read_b128 a[24:27], v1 offset:30720
v_mfma_f32_16x16x32_bf16 v[152:155], a[56:59], v[64:67], v[152:155]
v_exp_f32 v38, v38
v_mfma_f32_16x16x32_bf16 v[184:187], a[56:59], v[68:71], v[184:187]
v_exp_f32 v39, v39
v_mfma_f32_16x16x32_bf16 v[216:219], a[56:59], v[72:75], v[216:219]
ds_read_b128 a[28:31], v1 offset:31744
v_cvt_pk_bf16_f32 v55, v38, v39
v_mfma_f32_16x16x32_bf16 v[248:251], a[56:59], v[76:79], v[248:251]
v_mfma_f32_16x16x32_bf16 v[252:255], a[60:63], v[76:79], v[252:255]
v_exp_f32 v40, v40
v_mfma_f32_16x16x32_bf16 v[220:223], a[60:63], v[72:75], v[220:223]
v_exp_f32 v41, v41
v_mfma_f32_16x16x32_bf16 v[188:191], a[60:63], v[68:71], v[188:191]
ds_read_b128 a[32:35], v1 offset:16384
v_cvt_pk_bf16_f32 v58, v40, v41
v_mfma_f32_16x16x32_bf16 v[156:159], a[60:63], v[64:67], v[156:159]
v_smfmac_f32_16x16x64_bf16 a[224:227], a[232:235], v[64:71], v9
s_waitcnt lgkmcnt(5)
v_exp_f32 v42, v42
v_smfmac_f32_16x16x64_bf16 a[228:231], a[232:235], v[72:79], v9
ds_read_b128 a[36:39], v1 offset:17408
v_mfma_f32_16x16x32_bf16 v[16:19], a[0:3], a[160:163], v[80:83]
v_exp_f32 v43, v43
v_mfma_f32_16x16x32_bf16 v[16:19], a[4:7], a[164:167], v[16:19]
v_exp_f32 v44, v44
v_mfma_f32_16x16x32_bf16 v[16:19], a[8:11], a[168:171], v[16:19]
v_cvt_pk_bf16_f32 v59, v42, v43
v_mfma_f32_16x16x32_bf16 v[16:19], a[12:15], a[172:175], v[16:19]
ds_read_b128 a[40:43], v1 offset:18432
v_mfma_f32_16x16x32_bf16 v[20:23], a[0:3], a[176:179], v[84:87]
buffer_load_dwordx4 v3, s[48:51], s7 offen offset:2048 sc1 lds
v_mfma_f32_16x16x32_bf16 v[20:23], a[4:7], a[180:183], v[20:23]
v_exp_f32 v45, v45
v_mfma_f32_16x16x32_bf16 v[20:23], a[8:11], a[184:187], v[20:23]
v_exp_f32 v46, v46
v_mfma_f32_16x16x32_bf16 v[20:23], a[12:15], a[188:191], v[20:23]
ds_read_b128 a[44:47], v1 offset:19456
v_cvt_pk_bf16_f32 v62, v44, v45
v_mfma_f32_16x16x32_bf16 v[24:27], a[0:3], a[192:195], v[88:91]
v_mfma_f32_16x16x32_bf16 v[24:27], a[4:7], a[196:199], v[24:27]
v_exp_f32 v47, v47
v_mfma_f32_16x16x32_bf16 v[24:27], a[8:11], a[200:203], v[24:27]
v_exp_f32 v16, v16
v_mfma_f32_16x16x32_bf16 v[24:27], a[12:15], a[204:207], v[24:27]
ds_read_b128 a[48:51], v1 offset:20480
v_cvt_pk_bf16_f32 v63, v46, v47
v_mfma_f32_16x16x32_bf16 v[28:31], a[0:3], a[208:211], v[92:95]
v_mfma_f32_16x16x32_bf16 v[28:31], a[4:7], a[212:215], v[28:31]
v_exp_f32 v17, v17
v_mfma_f32_16x16x32_bf16 v[28:31], a[8:11], a[216:219], v[28:31]
ds_read_b128 a[52:55], v1 offset:21504
v_cvt_pk_bf16_f32 v64, v16, v17
v_mfma_f32_16x16x32_bf16 v[28:31], a[12:15], a[220:223], v[28:31]
s_waitcnt lgkmcnt(6)
v_exp_f32 v18, v18
v_mfma_f32_16x16x32_bf16 v[32:35], a[16:19], a[160:163], v[80:83]
v_mfma_f32_16x16x32_bf16 v[32:35], a[20:23], a[164:167], v[32:35]
v_exp_f32 v19, v19
v_mfma_f32_16x16x32_bf16 v[32:35], a[24:27], a[168:171], v[32:35]
ds_read_b128 a[56:59], v1 offset:22528
v_cvt_pk_bf16_f32 v65, v18, v19
v_mfma_f32_16x16x32_bf16 v[32:35], a[28:31], a[172:175], v[32:35]
buffer_load_dwordx4 v3, s[48:51], s7 offen offset:3072 sc1 lds
v_mfma_f32_16x16x32_bf16 v[36:39], a[16:19], a[176:179], v[84:87]
s_add_u32 s7, s7, 0x8000
v_exp_f32 v20, v20
v_mfma_f32_16x16x32_bf16 v[36:39], a[20:23], a[180:183], v[36:39]
s_xor_b32 s27, s27, 0x38000
v_exp_f32 v21, v21
v_mfma_f32_16x16x32_bf16 v[36:39], a[24:27], a[184:187], v[36:39]
ds_read_b128 a[60:63], v1 offset:23552
v_xor_b32 v1, 0x8000, v1
v_mfma_f32_16x16x32_bf16 v[36:39], a[28:31], a[188:191], v[36:39]
v_cvt_pk_bf16_f32 v68, v20, v21
v_mfma_f32_16x16x32_bf16 v[40:43], a[16:19], a[192:195], v[88:91]
v_exp_f32 v22, v22
v_mfma_f32_16x16x32_bf16 v[40:43], a[20:23], a[196:199], v[40:43]
v_exp_f32 v23, v23
v_mfma_f32_16x16x32_bf16 v[40:43], a[24:27], a[200:203], v[40:43]
v_cvt_pk_bf16_f32 v69, v22, v23
v_mfma_f32_16x16x32_bf16 v[40:43], a[28:31], a[204:207], v[40:43]
v_exp_f32 v24, v24
v_mfma_f32_16x16x32_bf16 v[44:47], a[16:19], a[208:211], v[92:95]
s_waitcnt vmcnt(16) lgkmcnt(0)
v_exp_f32 v25, v25
v_mfma_f32_16x16x32_bf16 v[44:47], a[20:23], a[212:215], v[44:47]
s_barrier
v_exp_f32 v26, v26
v_mfma_f32_16x16x32_bf16 v[44:47], a[24:27], a[216:219], v[44:47]
v_exp_f32 v27, v27
v_mfma_f32_16x16x32_bf16 v[44:47], a[28:31], a[220:223], v[44:47]
L_att_dodd1:
v_mfma_f32_16x16x32_bf16 v[128:131], a[32:35], v[48:51], v[128:131]
ds_read_b128 a[0:3], v2 offset:8192
v_cvt_pk_bf16_f32 v72, v24, v25
v_mfma_f32_16x16x32_bf16 v[160:163], a[32:35], v[52:55], v[160:163]
v_exp_f32 v28, v28
v_mfma_f32_16x16x32_bf16 v[192:195], a[32:35], v[56:59], v[192:195]
v_cvt_pk_bf16_f32 v73, v26, v27
v_mfma_f32_16x16x32_bf16 v[224:227], a[32:35], v[60:63], v[224:227]
ds_read_b128 a[4:7], v2 offset:9216
v_mfma_f32_16x16x32_bf16 v[228:231], a[36:39], v[60:63], v[228:231]
v_exp_f32 v29, v29
v_mfma_f32_16x16x32_bf16 v[196:199], a[36:39], v[56:59], v[196:199]
v_exp_f32 v30, v30
v_mfma_f32_16x16x32_bf16 v[164:167], a[36:39], v[52:55], v[164:167]
s_add_u32 m0, s19, 0x0
v_cvt_pk_bf16_f32 v76, v28, v29
v_mfma_f32_16x16x32_bf16 v[132:135], a[36:39], v[48:51], v[132:135]
buffer_load_dwordx4 v3, s[48:51], s32 offen offset:0 sc1 lds
v_mfma_f32_16x16x32_bf16 v[136:139], a[40:43], v[48:51], v[136:139]
ds_read_b128 a[8:11], v2 offset:10240
v_mfma_f32_16x16x32_bf16 v[168:171], a[40:43], v[52:55], v[168:171]
v_exp_f32 v31, v31
v_mfma_f32_16x16x32_bf16 v[200:203], a[40:43], v[56:59], v[200:203]
v_exp_f32 v32, v32
v_mfma_f32_16x16x32_bf16 v[232:235], a[40:43], v[60:63], v[232:235]
ds_read_b128 a[12:15], v2 offset:11264
v_cvt_pk_bf16_f32 v77, v30, v31
v_mfma_f32_16x16x32_bf16 v[236:239], a[44:47], v[60:63], v[236:239]
v_mfma_f32_16x16x32_bf16 v[204:207], a[44:47], v[56:59], v[204:207]
v_exp_f32 v33, v33
v_mfma_f32_16x16x32_bf16 v[172:175], a[44:47], v[52:55], v[172:175]
v_exp_f32 v34, v34
v_mfma_f32_16x16x32_bf16 v[140:143], a[44:47], v[48:51], v[140:143]
ds_read_b128 a[16:19], v2 offset:12288
v_cvt_pk_bf16_f32 v66, v32, v33
v_mfma_f32_16x16x32_bf16 v[144:147], a[48:51], v[48:51], v[144:147]
v_mfma_f32_16x16x32_bf16 v[176:179], a[48:51], v[52:55], v[176:179]
v_exp_f32 v35, v35
v_mfma_f32_16x16x32_bf16 v[208:211], a[48:51], v[56:59], v[208:211]
v_exp_f32 v36, v36
v_mfma_f32_16x16x32_bf16 v[240:243], a[48:51], v[60:63], v[240:243]
ds_read_b128 a[20:23], v2 offset:13312
v_cvt_pk_bf16_f32 v67, v34, v35
v_mfma_f32_16x16x32_bf16 v[244:247], a[52:55], v[60:63], v[244:247]
v_exp_f32 v37, v37
v_mfma_f32_16x16x32_bf16 v[212:215], a[52:55], v[56:59], v[212:215]
v_cvt_pk_bf16_f32 v70, v36, v37
v_mfma_f32_16x16x32_bf16 v[180:183], a[52:55], v[52:55], v[180:183]
ds_read_b128 a[24:27], v2 offset:14336
v_mfma_f32_16x16x32_bf16 v[148:151], a[52:55], v[48:51], v[148:151]
buffer_load_dwordx4 v3, s[48:51], s32 offen offset:1024 sc1 lds
v_mfma_f32_16x16x32_bf16 v[152:155], a[56:59], v[48:51], v[152:155]
v_exp_f32 v38, v38
v_mfma_f32_16x16x32_bf16 v[184:187], a[56:59], v[52:55], v[184:187]
v_exp_f32 v39, v39
v_mfma_f32_16x16x32_bf16 v[216:219], a[56:59], v[56:59], v[216:219]
ds_read_b128 a[28:31], v2 offset:15360
v_cvt_pk_bf16_f32 v71, v38, v39
v_mfma_f32_16x16x32_bf16 v[248:251], a[56:59], v[60:63], v[248:251]
v_mfma_f32_16x16x32_bf16 v[252:255], a[60:63], v[60:63], v[252:255]
v_exp_f32 v40, v40
v_mfma_f32_16x16x32_bf16 v[220:223], a[60:63], v[56:59], v[220:223]
v_exp_f32 v41, v41
v_mfma_f32_16x16x32_bf16 v[188:191], a[60:63], v[52:55], v[188:191]
ds_read_b128 a[32:35], v2 offset:0
v_cvt_pk_bf16_f32 v74, v40, v41
v_mfma_f32_16x16x32_bf16 v[156:159], a[60:63], v[48:51], v[156:159]
v_smfmac_f32_16x16x64_bf16 a[224:227], a[232:235], v[48:55], v9
v_exp_f32 v42, v42
v_smfmac_f32_16x16x64_bf16 a[228:231], a[232:235], v[56:63], v9
s_waitcnt lgkmcnt(5)
v_exp_f32 v43, v43
v_mfma_f32_16x16x32_bf16 v[16:19], a[0:3], a[160:163], v[80:83]
ds_read_b128 a[36:39], v2 offset:1024
v_cvt_pk_bf16_f32 v75, v42, v43
v_mfma_f32_16x16x32_bf16 v[16:19], a[4:7], a[164:167], v[16:19]
v_exp_f32 v44, v44
v_mfma_f32_16x16x32_bf16 v[16:19], a[8:11], a[168:171], v[16:19]
v_mfma_f32_16x16x32_bf16 v[16:19], a[12:15], a[172:175], v[16:19]
v_exp_f32 v45, v45
v_mfma_f32_16x16x32_bf16 v[20:23], a[0:3], a[176:179], v[84:87]
ds_read_b128 a[40:43], v2 offset:2048
v_cvt_pk_bf16_f32 v78, v44, v45
v_mfma_f32_16x16x32_bf16 v[20:23], a[4:7], a[180:183], v[20:23]
buffer_load_dwordx4 v3, s[48:51], s32 offen offset:2048 sc1 lds
v_mfma_f32_16x16x32_bf16 v[20:23], a[8:11], a[184:187], v[20:23]
v_exp_f32 v46, v46
v_mfma_f32_16x16x32_bf16 v[20:23], a[12:15], a[188:191], v[20:23]
ds_read_b128 a[44:47], v2 offset:3072
v_mfma_f32_16x16x32_bf16 v[24:27], a[0:3], a[192:195], v[88:91]
v_mfma_f32_16x16x32_bf16 v[24:27], a[4:7], a[196:199], v[24:27]
v_exp_f32 v47, v47
v_mfma_f32_16x16x32_bf16 v[24:27], a[8:11], a[200:203], v[24:27]
v_exp_f32 v16, v16
v_mfma_f32_16x16x32_bf16 v[24:27], a[12:15], a[204:207], v[24:27]
ds_read_b128 a[48:51], v2 offset:4096
v_cvt_pk_bf16_f32 v79, v46, v47
v_mfma_f32_16x16x32_bf16 v[28:31], a[0:3], a[208:211], v[92:95]
v_mfma_f32_16x16x32_bf16 v[28:31], a[4:7], a[212:215], v[28:31]
v_exp_f32 v17, v17
v_mfma_f32_16x16x32_bf16 v[28:31], a[8:11], a[216:219], v[28:31]
s_waitcnt lgkmcnt(5)
v_exp_f32 v18, v18
v_mfma_f32_16x16x32_bf16 v[28:31], a[12:15], a[220:223], v[28:31]
ds_read_b128 a[52:55], v2 offset:5120
v_cvt_pk_bf16_f32 v48, v16, v17
v_mfma_f32_16x16x32_bf16 v[32:35], a[16:19], a[160:163], v[80:83]
v_mfma_f32_16x16x32_bf16 v[32:35], a[20:23], a[164:167], v[32:35]
v_exp_f32 v19, v19
v_mfma_f32_16x16x32_bf16 v[32:35], a[24:27], a[168:171], v[32:35]
v_exp_f32 v20, v20
v_mfma_f32_16x16x32_bf16 v[32:35], a[28:31], a[172:175], v[32:35]
ds_read_b128 a[56:59], v2 offset:6144
v_cvt_pk_bf16_f32 v49, v18, v19
v_mfma_f32_16x16x32_bf16 v[36:39], a[16:19], a[176:179], v[84:87]
v_exp_f32 v21, v21
v_mfma_f32_16x16x32_bf16 v[36:39], a[20:23], a[180:183], v[36:39]
buffer_load_dwordx4 v3, s[48:51], s32 offen offset:3072 sc1 lds
v_mfma_f32_16x16x32_bf16 v[36:39], a[24:27], a[184:187], v[36:39]
s_add_u32 s32, s32, 0x8000
v_cvt_pk_bf16_f32 v52, v20, v21
v_mfma_f32_16x16x32_bf16 v[36:39], a[28:31], a[188:191], v[36:39]
ds_read_b128 a[60:63], v2 offset:7168
v_mfma_f32_16x16x32_bf16 v[40:43], a[16:19], a[192:195], v[88:91]
v_exp_f32 v22, v22
v_mfma_f32_16x16x32_bf16 v[40:43], a[20:23], a[196:199], v[40:43]
v_exp_f32 v23, v23
v_mfma_f32_16x16x32_bf16 v[40:43], a[24:27], a[200:203], v[40:43]
v_cvt_pk_bf16_f32 v53, v22, v23
v_mfma_f32_16x16x32_bf16 v[40:43], a[28:31], a[204:207], v[40:43]
v_exp_f32 v24, v24
v_mfma_f32_16x16x32_bf16 v[44:47], a[16:19], a[208:211], v[92:95]
v_exp_f32 v25, v25
v_mfma_f32_16x16x32_bf16 v[44:47], a[20:23], a[212:215], v[44:47]
v_exp_f32 v26, v26
v_mfma_f32_16x16x32_bf16 v[44:47], a[24:27], a[216:219], v[44:47]
v_exp_f32 v27, v27
v_mfma_f32_16x16x32_bf16 v[44:47], a[28:31], a[220:223], v[44:47]
s_waitcnt lgkmcnt(0)
v_mfma_f32_16x16x32_bf16 v[128:131], a[32:35], v[64:67], v[128:131]
ds_read_b128 a[0:3], v2 offset:24576
v_cvt_pk_bf16_f32 v56, v24, v25
v_mfma_f32_16x16x32_bf16 v[160:163], a[32:35], v[68:71], v[160:163]
v_exp_f32 v28, v28
v_mfma_f32_16x16x32_bf16 v[192:195], a[32:35], v[72:75], v[192:195]
v_cvt_pk_bf16_f32 v57, v26, v27
v_mfma_f32_16x16x32_bf16 v[224:227], a[32:35], v[76:79], v[224:227]
ds_read_b128 a[4:7], v2 offset:25600
v_mfma_f32_16x16x32_bf16 v[228:231], a[36:39], v[76:79], v[228:231]
v_exp_f32 v29, v29
v_mfma_f32_16x16x32_bf16 v[196:199], a[36:39], v[72:75], v[196:199]
v_exp_f32 v30, v30
v_mfma_f32_16x16x32_bf16 v[164:167], a[36:39], v[68:71], v[164:167]
s_add_u32 m0, s19, 0x1000
v_cvt_pk_bf16_f32 v60, v28, v29
v_mfma_f32_16x16x32_bf16 v[132:135], a[36:39], v[64:67], v[132:135]
buffer_load_dwordx4 v3, s[48:51], s7 offen offset:0 sc1 lds
v_mfma_f32_16x16x32_bf16 v[136:139], a[40:43], v[64:67], v[136:139]
ds_read_b128 a[8:11], v2 offset:26624
v_mfma_f32_16x16x32_bf16 v[168:171], a[40:43], v[68:71], v[168:171]
v_exp_f32 v31, v31
v_mfma_f32_16x16x32_bf16 v[200:203], a[40:43], v[72:75], v[200:203]
v_exp_f32 v32, v32
v_mfma_f32_16x16x32_bf16 v[232:235], a[40:43], v[76:79], v[232:235]
ds_read_b128 a[12:15], v2 offset:27648
v_cvt_pk_bf16_f32 v61, v30, v31
v_mfma_f32_16x16x32_bf16 v[236:239], a[44:47], v[76:79], v[236:239]
v_mfma_f32_16x16x32_bf16 v[204:207], a[44:47], v[72:75], v[204:207]
v_exp_f32 v33, v33
v_mfma_f32_16x16x32_bf16 v[172:175], a[44:47], v[68:71], v[172:175]
v_exp_f32 v34, v34
v_mfma_f32_16x16x32_bf16 v[140:143], a[44:47], v[64:67], v[140:143]
ds_read_b128 a[16:19], v2 offset:28672
v_cvt_pk_bf16_f32 v50, v32, v33
v_mfma_f32_16x16x32_bf16 v[144:147], a[48:51], v[64:67], v[144:147]
v_exp_f32 v35, v35
v_mfma_f32_16x16x32_bf16 v[176:179], a[48:51], v[68:71], v[176:179]
v_cvt_pk_bf16_f32 v51, v34, v35
v_mfma_f32_16x16x32_bf16 v[208:211], a[48:51], v[72:75], v[208:211]
ds_read_b128 a[20:23], v2 offset:29696
v_mfma_f32_16x16x32_bf16 v[240:243], a[48:51], v[76:79], v[240:243]
v_exp_f32 v36, v36
v_mfma_f32_16x16x32_bf16 v[244:247], a[52:55], v[76:79], v[244:247]
v_exp_f32 v37, v37
v_mfma_f32_16x16x32_bf16 v[212:215], a[52:55], v[72:75], v[212:215]
v_cvt_pk_bf16_f32 v54, v36, v37
v_mfma_f32_16x16x32_bf16 v[180:183], a[52:55], v[68:71], v[180:183]
buffer_load_dwordx4 v3, s[48:51], s7 offen offset:1024 sc1 lds
v_mfma_f32_16x16x32_bf16 v[148:151], a[52:55], v[64:67], v[148:151]
ds_read_b128 a[24:27], v2 offset:30720
v_mfma_f32_16x16x32_bf16 v[152:155], a[56:59], v[64:67], v[152:155]
v_exp_f32 v38, v38
v_mfma_f32_16x16x32_bf16 v[184:187], a[56:59], v[68:71], v[184:187]
v_exp_f32 v39, v39
v_mfma_f32_16x16x32_bf16 v[216:219], a[56:59], v[72:75], v[216:219]
ds_read_b128 a[28:31], v2 offset:31744
v_cvt_pk_bf16_f32 v55, v38, v39
v_mfma_f32_16x16x32_bf16 v[248:251], a[56:59], v[76:79], v[248:251]
v_exp_f32 v40, v40
v_mfma_f32_16x16x32_bf16 v[252:255], a[60:63], v[76:79], v[252:255]
v_mfma_f32_16x16x32_bf16 v[220:223], a[60:63], v[72:75], v[220:223]
v_exp_f32 v41, v41
v_mfma_f32_16x16x32_bf16 v[188:191], a[60:63], v[68:71], v[188:191]
ds_read_b128 a[32:35], v2 offset:16384
v_cvt_pk_bf16_f32 v58, v40, v41
v_mfma_f32_16x16x32_bf16 v[156:159], a[60:63], v[64:67], v[156:159]
v_exp_f32 v42, v42
v_smfmac_f32_16x16x64_bf16 a[224:227], a[232:235], v[64:71], v9
s_waitcnt lgkmcnt(5)
v_smfmac_f32_16x16x64_bf16 a[228:231], a[232:235], v[72:79], v9
ds_read_b128 a[36:39], v2 offset:17408
v_mfma_f32_16x16x32_bf16 v[16:19], a[0:3], a[160:163], v[80:83]
v_exp_f32 v43, v43
v_mfma_f32_16x16x32_bf16 v[16:19], a[4:7], a[164:167], v[16:19]
v_exp_f32 v44, v44
v_mfma_f32_16x16x32_bf16 v[16:19], a[8:11], a[168:171], v[16:19]
buffer_load_dwordx4 v3, s[48:51], s7 offen offset:2048 sc1 lds
v_mfma_f32_16x16x32_bf16 v[16:19], a[12:15], a[172:175], v[16:19]
ds_read_b128 a[40:43], v2 offset:18432
v_cvt_pk_bf16_f32 v59, v42, v43
v_mfma_f32_16x16x32_bf16 v[20:23], a[0:3], a[176:179], v[84:87]
v_exp_f32 v45, v45
v_mfma_f32_16x16x32_bf16 v[20:23], a[4:7], a[180:183], v[20:23]
v_cvt_pk_bf16_f32 v62, v44, v45
v_mfma_f32_16x16x32_bf16 v[20:23], a[8:11], a[184:187], v[20:23]
v_exp_f32 v46, v46
v_mfma_f32_16x16x32_bf16 v[20:23], a[12:15], a[188:191], v[20:23]
ds_read_b128 a[44:47], v2 offset:19456
v_mfma_f32_16x16x32_bf16 v[24:27], a[0:3], a[192:195], v[88:91]
v_exp_f32 v47, v47
v_mfma_f32_16x16x32_bf16 v[24:27], a[4:7], a[196:199], v[24:27]
v_cvt_pk_bf16_f32 v63, v46, v47
v_mfma_f32_16x16x32_bf16 v[24:27], a[8:11], a[200:203], v[24:27]
v_exp_f32 v16, v16
v_mfma_f32_16x16x32_bf16 v[24:27], a[12:15], a[204:207], v[24:27]
ds_read_b128 a[48:51], v2 offset:20480
v_mfma_f32_16x16x32_bf16 v[28:31], a[0:3], a[208:211], v[92:95]
v_exp_f32 v17, v17
v_mfma_f32_16x16x32_bf16 v[28:31], a[4:7], a[212:215], v[28:31]
v_exp_f32 v18, v18
v_mfma_f32_16x16x32_bf16 v[28:31], a[8:11], a[216:219], v[28:31]
ds_read_b128 a[52:55], v2 offset:21504
v_cvt_pk_bf16_f32 v64, v16, v17
v_mfma_f32_16x16x32_bf16 v[28:31], a[12:15], a[220:223], v[28:31]
s_waitcnt lgkmcnt(6)
v_mfma_f32_16x16x32_bf16 v[32:35], a[16:19], a[160:163], v[80:83]
v_exp_f32 v19, v19
v_mfma_f32_16x16x32_bf16 v[32:35], a[20:23], a[164:167], v[32:35]
buffer_load_dwordx4 v3, s[48:51], s7 offen offset:3072 sc1 lds
v_mfma_f32_16x16x32_bf16 v[32:35], a[24:27], a[168:171], v[32:35]
ds_read_b128 a[56:59], v2 offset:22528
v_cvt_pk_bf16_f32 v65, v18, v19
v_mfma_f32_16x16x32_bf16 v[32:35], a[28:31], a[172:175], v[32:35]
s_add_u32 s7, s7, 0x8000
v_exp_f32 v20, v20
v_mfma_f32_16x16x32_bf16 v[36:39], a[16:19], a[176:179], v[84:87]
s_xor_b32 s19, s19, 0x8000
v_mfma_f32_16x16x32_bf16 v[36:39], a[20:23], a[180:183], v[36:39]
s_sub_u32 s15, s15, 1
v_exp_f32 v21, v21
v_mfma_f32_16x16x32_bf16 v[36:39], a[24:27], a[184:187], v[36:39]
ds_read_b128 a[60:63], v2 offset:23552
v_xor_b32 v2, 0x38000, v2
v_mfma_f32_16x16x32_bf16 v[36:39], a[28:31], a[188:191], v[36:39]
s_cmp_lg_u32 s15, 0
v_exp_f32 v22, v22
v_mfma_f32_16x16x32_bf16 v[40:43], a[16:19], a[192:195], v[88:91]
v_exp_f32 v23, v23
v_mfma_f32_16x16x32_bf16 v[40:43], a[20:23], a[196:199], v[40:43]
v_cvt_pk_bf16_f32 v68, v20, v21
v_cvt_pk_bf16_f32 v69, v22, v23
v_mfma_f32_16x16x32_bf16 v[40:43], a[24:27], a[200:203], v[40:43]
v_exp_f32 v24, v24
v_mfma_f32_16x16x32_bf16 v[40:43], a[28:31], a[204:207], v[40:43]
v_exp_f32 v25, v25
v_mfma_f32_16x16x32_bf16 v[44:47], a[16:19], a[208:211], v[92:95]
s_waitcnt vmcnt(16) lgkmcnt(0)
v_exp_f32 v26, v26
v_mfma_f32_16x16x32_bf16 v[44:47], a[20:23], a[212:215], v[44:47]
s_barrier
v_exp_f32 v27, v27
v_mfma_f32_16x16x32_bf16 v[44:47], a[24:27], a[216:219], v[44:47]
v_mfma_f32_16x16x32_bf16 v[44:47], a[28:31], a[220:223], v[44:47]
s_cbranch_scc1 L_att_deven1
L_att_ddone:
s_cmp_ge_u32 s4, 2
s_cbranch_scc1 L_att_dl0_1
L_att_dl0_0:
v_mfma_f32_16x16x32_bf16 v[128:131], a[32:35], v[48:51], v[128:131]
ds_read_b128 a[0:3], v1 offset:8192
v_cvt_pk_bf16_f32 v72, v24, v25
v_mfma_f32_16x16x32_bf16 v[160:163], a[32:35], v[52:55], v[160:163]
v_exp_f32 v28, v28
v_mfma_f32_16x16x32_bf16 v[192:195], a[32:35], v[56:59], v[192:195]
v_cvt_pk_bf16_f32 v73, v26, v27
v_mfma_f32_16x16x32_bf16 v[224:227], a[32:35], v[60:63], v[224:227]
ds_read_b128 a[4:7], v1 offset:9216
v_mfma_f32_16x16x32_bf16 v[228:231], a[36:39], v[60:63], v[228:231]
s_add_u32 m0, s27, 0x0
v_exp_f32 v29, v29
v_mfma_f32_16x16x32_bf16 v[196:199], a[36:39], v[56:59], v[196:199]
buffer_load_dwordx4 v3, s[48:51], s32 offen offset:0 sc1 lds
v_mfma_f32_16x16x32_bf16 v[164:167], a[36:39], v[52:55], v[164:167]
v_exp_f32 v30, v30
v_mfma_f32_16x16x32_bf16 v[132:135], a[36:39], v[48:51], v[132:135]
ds_read_b128 a[8:11], v1 offset:10240
v_cvt_pk_bf16_f32 v76, v28, v29
v_mfma_f32_16x16x32_bf16 v[136:139], a[40:43], v[48:51], v[136:139]
v_mfma_f32_16x16x32_bf16 v[168:171], a[40:43], v[52:55], v[168:171]
v_exp_f32 v31, v31
v_mfma_f32_16x16x32_bf16 v[200:203], a[40:43], v[56:59], v[200:203]
v_exp_f32 v32, v32
v_mfma_f32_16x16x32_bf16 v[232:235], a[40:43], v[60:63], v[232:235]
ds_read_b128 a[12:15], v1 offset:11264
v_cvt_pk_bf16_f32 v77, v30, v31
v_mfma_f32_16x16x32_bf16 v[236:239], a[44:47], v[60:63], v[236:239]
v_exp_f32 v33, v33
v_mfma_f32_16x16x32_bf16 v[204:207], a[44:47], v[56:59], v[204:207]
v_cvt_pk_bf16_f32 v66, v32, v33
v_mfma_f32_16x16x32_bf16 v[172:175], a[44:47], v[52:55], v[172:175]
s_mov_b32 s9, 0x0
v_exp_f32 v34, v34
v_mfma_f32_16x16x32_bf16 v[140:143], a[44:47], v[48:51], v[140:143]
ds_read_b128 a[16:19], v1 offset:12288
v_mfma_f32_16x16x32_bf16 v[144:147], a[48:51], v[48:51], v[144:147]
buffer_load_dword a244, v8, s[72:75], s9 offen
v_mfma_f32_16x16x32_bf16 v[176:179], a[48:51], v[52:55], v[176:179]
v_exp_f32 v35, v35
v_mfma_f32_16x16x32_bf16 v[208:211], a[48:51], v[56:59], v[208:211]
v_exp_f32 v36, v36
v_mfma_f32_16x16x32_bf16 v[240:243], a[48:51], v[60:63], v[240:243]
ds_read_b128 a[20:23], v1 offset:13312
v_cvt_pk_bf16_f32 v67, v34, v35
v_mfma_f32_16x16x32_bf16 v[244:247], a[52:55], v[60:63], v[244:247]
v_mfma_f32_16x16x32_bf16 v[212:215], a[52:55], v[56:59], v[212:215]
v_exp_f32 v37, v37
v_mfma_f32_16x16x32_bf16 v[180:183], a[52:55], v[52:55], v[180:183]
ds_read_b128 a[24:27], v1 offset:14336
v_cvt_pk_bf16_f32 v70, v36, v37
v_mfma_f32_16x16x32_bf16 v[148:151], a[52:55], v[48:51], v[148:151]
v_exp_f32 v38, v38
v_mfma_f32_16x16x32_bf16 v[152:155], a[56:59], v[48:51], v[152:155]
v_mfma_f32_16x16x32_bf16 v[184:187], a[56:59], v[52:55], v[184:187]
v_exp_f32 v39, v39
v_mfma_f32_16x16x32_bf16 v[216:219], a[56:59], v[56:59], v[216:219]
buffer_load_dwordx4 v3, s[48:51], s32 offen offset:1024 sc1 lds
v_mfma_f32_16x16x32_bf16 v[248:251], a[56:59], v[60:63], v[248:251]
ds_read_b128 a[28:31], v1 offset:15360
v_cvt_pk_bf16_f32 v71, v38, v39
v_mfma_f32_16x16x32_bf16 v[252:255], a[60:63], v[60:63], v[252:255]
v_exp_f32 v40, v40
v_mfma_f32_16x16x32_bf16 v[220:223], a[60:63], v[56:59], v[220:223]
v_exp_f32 v41, v41
v_mfma_f32_16x16x32_bf16 v[188:191], a[60:63], v[52:55], v[188:191]
ds_read_b128 a[32:35], v1 offset:0
v_cvt_pk_bf16_f32 v74, v40, v41
v_mfma_f32_16x16x32_bf16 v[156:159], a[60:63], v[48:51], v[156:159]
v_smfmac_f32_16x16x64_bf16 a[224:227], a[232:235], v[48:55], v9
v_exp_f32 v42, v42
v_smfmac_f32_16x16x64_bf16 a[228:231], a[232:235], v[56:63], v9
s_waitcnt lgkmcnt(5)
v_exp_f32 v43, v43
v_mfma_f32_16x16x32_bf16 v[16:19], a[0:3], a[160:163], v[96:99]
ds_read_b128 a[36:39], v1 offset:1024
v_cvt_pk_bf16_f32 v75, v42, v43
v_mfma_f32_16x16x32_bf16 v[16:19], a[4:7], a[164:167], v[16:19]
v_exp_f32 v44, v44
v_mfma_f32_16x16x32_bf16 v[16:19], a[8:11], a[168:171], v[16:19]
v_mfma_f32_16x16x32_bf16 v[16:19], a[12:15], a[172:175], v[16:19]
buffer_load_dwordx4 v3, s[48:51], s32 offen offset:2048 sc1 lds
v_mfma_f32_16x16x32_bf16 v[20:23], a[0:3], a[176:179], v[84:87]
ds_read_b128 a[40:43], v1 offset:2048
v_mfma_f32_16x16x32_bf16 v[20:23], a[4:7], a[180:183], v[20:23]
v_exp_f32 v45, v45
v_mfma_f32_16x16x32_bf16 v[20:23], a[8:11], a[184:187], v[20:23]
v_exp_f32 v46, v46
v_mfma_f32_16x16x32_bf16 v[20:23], a[12:15], a[188:191], v[20:23]
ds_read_b128 a[44:47], v1 offset:3072
v_cvt_pk_bf16_f32 v78, v44, v45
v_mfma_f32_16x16x32_bf16 v[24:27], a[0:3], a[192:195], v[88:91]
v_mfma_f32_16x16x32_bf16 v[24:27], a[4:7], a[196:199], v[24:27]
v_exp_f32 v47, v47
v_mfma_f32_16x16x32_bf16 v[24:27], a[8:11], a[200:203], v[24:27]
v_exp_f32 v16, v16
v_mfma_f32_16x16x32_bf16 v[24:27], a[12:15], a[204:207], v[24:27]
ds_read_b128 a[48:51], v1 offset:4096
v_cvt_pk_bf16_f32 v79, v46, v47
v_mfma_f32_16x16x32_bf16 v[28:31], a[0:3], a[208:211], v[92:95]
v_exp_f32 v17, v17
v_mfma_f32_16x16x32_bf16 v[28:31], a[4:7], a[212:215], v[28:31]
s_waitcnt lgkmcnt(5)
v_cvt_pk_bf16_f32 v48, v16, v17
v_mfma_f32_16x16x32_bf16 v[28:31], a[8:11], a[216:219], v[28:31]
buffer_load_dwordx4 v3, s[48:51], s32 offen offset:3072 sc1 lds
v_mfma_f32_16x16x32_bf16 v[28:31], a[12:15], a[220:223], v[28:31]
ds_read_b128 a[52:55], v1 offset:5120
v_mfma_f32_16x16x32_bf16 v[32:35], a[16:19], a[160:163], v[100:103]
v_exp_f32 v18, v18
v_mfma_f32_16x16x32_bf16 v[32:35], a[20:23], a[164:167], v[32:35]
v_exp_f32 v19, v19
v_mfma_f32_16x16x32_bf16 v[32:35], a[24:27], a[168:171], v[32:35]
v_exp_f32 v20, v20
v_mfma_f32_16x16x32_bf16 v[32:35], a[28:31], a[172:175], v[32:35]
ds_read_b128 a[56:59], v1 offset:6144
v_cvt_pk_bf16_f32 v49, v18, v19
v_mfma_f32_16x16x32_bf16 v[36:39], a[16:19], a[176:179], v[84:87]
v_mfma_f32_16x16x32_bf16 v[36:39], a[20:23], a[180:183], v[36:39]
v_exp_f32 v21, v21
v_mfma_f32_16x16x32_bf16 v[36:39], a[24:27], a[184:187], v[36:39]
s_mov_b32 s9, 0x0
v_exp_f32 v22, v22
v_mfma_f32_16x16x32_bf16 v[36:39], a[28:31], a[188:191], v[36:39]
ds_read_b128 a[60:63], v1 offset:7168
v_cvt_pk_bf16_f32 v52, v20, v21
v_mfma_f32_16x16x32_bf16 v[40:43], a[16:19], a[192:195], v[88:91]
buffer_load_dword a244, v8, s[64:67], s9 offen
v_mfma_f32_16x16x32_bf16 v[40:43], a[20:23], a[196:199], v[40:43]
v_mfma_f32_16x16x32_bf16 v[40:43], a[24:27], a[200:203], v[40:43]
v_exp_f32 v23, v23
v_mfma_f32_16x16x32_bf16 v[40:43], a[28:31], a[204:207], v[40:43]
v_exp_f32 v24, v24
v_mfma_f32_16x16x32_bf16 v[44:47], a[16:19], a[208:211], v[92:95]
v_exp_f32 v25, v25
v_mfma_f32_16x16x32_bf16 v[44:47], a[20:23], a[212:215], v[44:47]
v_exp_f32 v26, v26
v_mfma_f32_16x16x32_bf16 v[44:47], a[24:27], a[216:219], v[44:47]
v_exp_f32 v27, v27
v_mfma_f32_16x16x32_bf16 v[44:47], a[28:31], a[220:223], v[44:47]
s_waitcnt lgkmcnt(0)
v_cvt_pk_bf16_f32 v53, v22, v23
v_mfma_f32_16x16x32_bf16 v[128:131], a[32:35], v[64:67], v[128:131]
ds_read_b128 a[0:3], v1 offset:24576
v_cvt_pk_bf16_f32 v56, v24, v25
v_mfma_f32_16x16x32_bf16 v[160:163], a[32:35], v[68:71], v[160:163]
v_exp_f32 v28, v28
v_mfma_f32_16x16x32_bf16 v[192:195], a[32:35], v[72:75], v[192:195]
v_cvt_pk_bf16_f32 v57, v26, v27
v_mfma_f32_16x16x32_bf16 v[224:227], a[32:35], v[76:79], v[224:227]
ds_read_b128 a[4:7], v1 offset:25600
v_mfma_f32_16x16x32_bf16 v[228:231], a[36:39], v[76:79], v[228:231]
s_add_u32 m0, s27, 0x1000
v_exp_f32 v29, v29
v_mfma_f32_16x16x32_bf16 v[196:199], a[36:39], v[72:75], v[196:199]
buffer_load_dwordx4 v3, s[48:51], s7 offen offset:0 sc1 lds
v_mfma_f32_16x16x32_bf16 v[164:167], a[36:39], v[68:71], v[164:167]
ds_read_b128 a[8:11], v1 offset:26624
v_cvt_pk_bf16_f32 v60, v28, v29
v_mfma_f32_16x16x32_bf16 v[132:135], a[36:39], v[64:67], v[132:135]
v_exp_f32 v30, v30
v_mfma_f32_16x16x32_bf16 v[136:139], a[40:43], v[64:67], v[136:139]
v_exp_f32 v31, v31
v_mfma_f32_16x16x32_bf16 v[168:171], a[40:43], v[68:71], v[168:171]
ds_read_b128 a[12:15], v1 offset:27648
v_cvt_pk_bf16_f32 v61, v30, v31
v_mfma_f32_16x16x32_bf16 v[200:203], a[40:43], v[72:75], v[200:203]
v_mfma_f32_16x16x32_bf16 v[232:235], a[40:43], v[76:79], v[232:235]
v_exp_f32 v32, v32
v_mfma_f32_16x16x32_bf16 v[236:239], a[44:47], v[76:79], v[236:239]
v_exp_f32 v33, v33
v_mfma_f32_16x16x32_bf16 v[204:207], a[44:47], v[72:75], v[204:207]
ds_read_b128 a[16:19], v1 offset:28672
v_cvt_pk_bf16_f32 v50, v32, v33
v_mfma_f32_16x16x32_bf16 v[172:175], a[44:47], v[68:71], v[172:175]
v_exp_f32 v34, v34
v_mfma_f32_16x16x32_bf16 v[140:143], a[44:47], v[64:67], v[140:143]
buffer_load_dwordx4 v3, s[48:51], s7 offen offset:1024 sc1 lds
v_mfma_f32_16x16x32_bf16 v[144:147], a[48:51], v[64:67], v[144:147]
ds_read_b128 a[20:23], v1 offset:29696
v_mfma_f32_16x16x32_bf16 v[176:179], a[48:51], v[68:71], v[176:179]
v_mfma_f32_16x16x32_bf16 v[208:211], a[48:51], v[72:75], v[208:211]
v_exp_f32 v35, v35
v_mfma_f32_16x16x32_bf16 v[240:243], a[48:51], v[76:79], v[240:243]
ds_read_b128 a[24:27], v1 offset:30720
v_cvt_pk_bf16_f32 v51, v34, v35
v_mfma_f32_16x16x32_bf16 v[244:247], a[52:55], v[76:79], v[244:247]
v_exp_f32 v36, v36
v_mfma_f32_16x16x32_bf16 v[212:215], a[52:55], v[72:75], v[212:215]
v_exp_f32 v37, v37
v_mfma_f32_16x16x32_bf16 v[180:183], a[52:55], v[68:71], v[180:183]
ds_read_b128 a[28:31], v1 offset:31744
v_cvt_pk_bf16_f32 v54, v36, v37
v_mfma_f32_16x16x32_bf16 v[148:151], a[52:55], v[64:67], v[148:151]
v_mfma_f32_16x16x32_bf16 v[152:155], a[56:59], v[64:67], v[152:155]
v_exp_f32 v38, v38
v_mfma_f32_16x16x32_bf16 v[184:187], a[56:59], v[68:71], v[184:187]
v_exp_f32 v39, v39
v_mfma_f32_16x16x32_bf16 v[216:219], a[56:59], v[72:75], v[216:219]
buffer_load_dwordx4 v3, s[48:51], s7 offen offset:2048 sc1 lds
v_mfma_f32_16x16x32_bf16 v[248:251], a[56:59], v[76:79], v[248:251]
ds_read_b128 a[32:35], v1 offset:16384
v_cvt_pk_bf16_f32 v55, v38, v39
v_mfma_f32_16x16x32_bf16 v[252:255], a[60:63], v[76:79], v[252:255]
v_exp_f32 v40, v40
v_mfma_f32_16x16x32_bf16 v[220:223], a[60:63], v[72:75], v[220:223]
ds_read_b128 a[36:39], v1 offset:17408
v_mfma_f32_16x16x32_bf16 v[188:191], a[60:63], v[68:71], v[188:191]
v_mfma_f32_16x16x32_bf16 v[156:159], a[60:63], v[64:67], v[156:159]
v_exp_f32 v41, v41
v_smfmac_f32_16x16x64_bf16 a[224:227], a[232:235], v[64:71], v9
ds_read_b128 a[40:43], v1 offset:18432
v_cvt_pk_bf16_f32 v58, v40, v41
v_smfmac_f32_16x16x64_bf16 a[228:231], a[232:235], v[72:79], v9
s_waitcnt lgkmcnt(7)
v_exp_f32 v42, v42
v_mfma_f32_16x16x32_bf16 v[20:23], a[0:3], a[176:179], v[84:87]
s_mov_b32 s9, 0x400000
v_exp_f32 v43, v43
v_mfma_f32_16x16x32_bf16 v[20:23], a[4:7], a[180:183], v[20:23]
ds_read_b128 a[44:47], v1 offset:19456
v_cvt_pk_bf16_f32 v59, v42, v43
v_mfma_f32_16x16x32_bf16 v[20:23], a[8:11], a[184:187], v[20:23]
buffer_load_dword a244, v8, s[64:67], s9 offen
v_mfma_f32_16x16x32_bf16 v[20:23], a[12:15], a[188:191], v[20:23]
v_mfma_f32_16x16x32_bf16 v[24:27], a[0:3], a[192:195], v[88:91]
v_exp_f32 v44, v44
v_mfma_f32_16x16x32_bf16 v[24:27], a[4:7], a[196:199], v[24:27]
ds_read_b128 a[48:51], v1 offset:20480
v_mfma_f32_16x16x32_bf16 v[24:27], a[8:11], a[200:203], v[24:27]
v_exp_f32 v45, v45
v_mfma_f32_16x16x32_bf16 v[24:27], a[12:15], a[204:207], v[24:27]
v_exp_f32 v46, v46
v_mfma_f32_16x16x32_bf16 v[28:31], a[0:3], a[208:211], v[92:95]
ds_read_b128 a[52:55], v1 offset:21504
v_cvt_pk_bf16_f32 v62, v44, v45
v_mfma_f32_16x16x32_bf16 v[28:31], a[4:7], a[212:215], v[28:31]
v_mfma_f32_16x16x32_bf16 v[28:31], a[8:11], a[216:219], v[28:31]
s_waitcnt lgkmcnt(6)
v_exp_f32 v47, v47
v_mfma_f32_16x16x32_bf16 v[28:31], a[12:15], a[220:223], v[28:31]
ds_read_b128 a[56:59], v1 offset:22528
v_cvt_pk_bf16_f32 v63, v46, v47
v_mfma_f32_16x16x32_bf16 v[36:39], a[16:19], a[176:179], v[84:87]
buffer_load_dwordx4 v3, s[48:51], s7 offen offset:3072 sc1 lds
v_mfma_f32_16x16x32_bf16 v[36:39], a[20:23], a[180:183], v[36:39]
s_add_u32 s32, s32, 0x8000
v_exp_f32 v20, v20
v_mfma_f32_16x16x32_bf16 v[36:39], a[24:27], a[184:187], v[36:39]
ds_read_b128 a[60:63], v1 offset:23552
v_xor_b32 v1, 0x8000, v1
v_mfma_f32_16x16x32_bf16 v[36:39], a[28:31], a[188:191], v[36:39]
s_add_u32 s7, s7, 0x8000
v_exp_f32 v21, v21
v_mfma_f32_16x16x32_bf16 v[40:43], a[16:19], a[192:195], v[88:91]
s_xor_b32 s27, s27, 0x38000
v_cvt_pk_bf16_f32 v68, v20, v21
v_mfma_f32_16x16x32_bf16 v[40:43], a[20:23], a[196:199], v[40:43]
v_exp_f32 v22, v22
v_mfma_f32_16x16x32_bf16 v[40:43], a[24:27], a[200:203], v[40:43]
v_exp_f32 v23, v23
v_mfma_f32_16x16x32_bf16 v[40:43], a[28:31], a[204:207], v[40:43]
v_exp_f32 v24, v24
v_mfma_f32_16x16x32_bf16 v[44:47], a[16:19], a[208:211], v[92:95]
v_exp_f32 v25, v25
v_mfma_f32_16x16x32_bf16 v[44:47], a[20:23], a[212:215], v[44:47]
v_exp_f32 v26, v26
v_mfma_f32_16x16x32_bf16 v[44:47], a[24:27], a[216:219], v[44:47]
s_waitcnt vmcnt(19) lgkmcnt(0)
v_exp_f32 v27, v27
v_mfma_f32_16x16x32_bf16 v[44:47], a[28:31], a[220:223], v[44:47]
s_barrier
v_cvt_pk_bf16_f32 v69, v22, v23
L_att_l1_0:
v_mfma_f32_16x16x32_bf16 v[128:131], a[32:35], v[48:51], v[128:131]
ds_read_b128 a[0:3], v2 offset:8192
v_cvt_pk_bf16_f32 v72, v24, v25
v_mfma_f32_16x16x32_bf16 v[160:163], a[32:35], v[52:55], v[160:163]
s_lshr_b32 s44, s2, 6
v_exp_f32 v28, v28
v_mfma_f32_16x16x32_bf16 v[192:195], a[32:35], v[56:59], v[192:195]
s_add_u32 m0, s19, 0x0
s_lshl_b32 s45, s44, 1
v_cvt_pk_bf16_f32 v73, v26, v27
v_mfma_f32_16x16x32_bf16 v[224:227], a[32:35], v[60:63], v[224:227]
ds_read_b128 a[4:7], v2 offset:9216
s_add_u32 s45, s45, s100
v_mfma_f32_16x16x32_bf16 v[228:231], a[36:39], v[60:63], v[228:231]
buffer_load_dwordx4 v3, s[48:51], s32 offen offset:0 sc1 lds
v_mfma_f32_16x16x32_bf16 v[196:199], a[36:39], v[56:59], v[196:199]
s_and_b32 s60, s45, 3
v_exp_f32 v29, v29
v_mfma_f32_16x16x32_bf16 v[164:167], a[36:39], v[52:55], v[164:167]
ds_read_b128 a[8:11], v2 offset:10240
v_cvt_pk_bf16_f32 v76, v28, v29
v_mfma_f32_16x16x32_bf16 v[132:135], a[36:39], v[48:51], v[132:135]
s_sub_u32 s60, s60, s44
v_exp_f32 v30, v30
v_mfma_f32_16x16x32_bf16 v[136:139], a[40:43], v[48:51], v[136:139]
s_add_u32 s60, s60, 4
s_lshl_b32 s60, s60, 14
s_and_b32 s60, s60, 0x7c000
v_mfma_f32_16x16x32_bf16 v[168:171], a[40:43], v[52:55], v[168:171]
ds_read_b128 a[12:15], v2 offset:11264
s_lshl_b32 s61, s60, 3
v_mfma_f32_16x16x32_bf16 v[200:203], a[40:43], v[56:59], v[200:203]
s_add_u32 s62, s61, s12
v_exp_f32 v31, v31
v_mfma_f32_16x16x32_bf16 v[232:235], a[40:43], v[60:63], v[232:235]
s_mul_i32 s44, s44, -8
v_exp_f32 v36, v36
v_mfma_f32_16x16x32_bf16 v[236:239], a[44:47], v[60:63], v[236:239]
s_mov_b32 s9, 0x200000
s_lshl_b32 s44, 4, s44
v_cvt_pk_bf16_f32 v77, v30, v31
v_mfma_f32_16x16x32_bf16 v[204:207], a[44:47], v[56:59], v[204:207]
ds_read_b128 a[16:19], v2 offset:12288
s_mul_i32 s45, s45, -8
v_mfma_f32_16x16x32_bf16 v[172:175], a[44:47], v[52:55], v[172:175]
buffer_load_dword a244, v8, s[64:67], s9 offen
v_mfma_f32_16x16x32_bf16 v[140:143], a[44:47], v[48:51], v[140:143]
s_lshl_b32 s45, 4, s45
v_exp_f32 v37, v37
v_mfma_f32_16x16x32_bf16 v[144:147], a[48:51], v[48:51], v[144:147]
ds_read_b128 a[20:23], v2 offset:13312
v_cvt_pk_bf16_f32 v70, v36, v37
v_mfma_f32_16x16x32_bf16 v[176:179], a[48:51], v[52:55], v[176:179]
s_add_u32 s44, s44, 0x21212121
v_exp_f32 v38, v38
v_mfma_f32_16x16x32_bf16 v[208:211], a[48:51], v[56:59], v[208:211]
s_sub_u32 s44, s44, s45
s_bfe_u32 s56, s44, 0x80000
s_lshl_b32 s56, s56, 14
v_mfma_f32_16x16x32_bf16 v[240:243], a[48:51], v[60:63], v[240:243]
ds_read_b128 a[24:27], v2 offset:14336
s_bfe_u32 s57, s44, 0x80008
v_mfma_f32_16x16x32_bf16 v[244:247], a[52:55], v[60:63], v[244:247]
s_lshl_b32 s57, s57, 14
v_exp_f32 v39, v39
v_mfma_f32_16x16x32_bf16 v[212:215], a[52:55], v[56:59], v[212:215]
s_bfe_u32 s58, s44, 0x80010
v_exp_f32 v40, v40
v_mfma_f32_16x16x32_bf16 v[180:183], a[52:55], v[52:55], v[180:183]
s_lshl_b32 s58, s58, 14
s_bfe_u32 s59, s44, 0x80018
v_cvt_pk_bf16_f32 v71, v38, v39
v_mfma_f32_16x16x32_bf16 v[148:151], a[52:55], v[48:51], v[148:151]
buffer_load_dwordx4 v3, s[48:51], s32 offen offset:1024 sc1 lds
v_mfma_f32_16x16x32_bf16 v[152:155], a[56:59], v[48:51], v[152:155]
ds_read_b128 a[28:31], v2 offset:15360
s_lshl_b32 s59, s59, 14
v_mfma_f32_16x16x32_bf16 v[184:187], a[56:59], v[52:55], v[184:187]
v_exp_f32 v41, v41
v_mfma_f32_16x16x32_bf16 v[216:219], a[56:59], v[56:59], v[216:219]
ds_read_b128 a[32:35], v2 offset:0
v_cvt_pk_bf16_f32 v74, v40, v41
v_mfma_f32_16x16x32_bf16 v[248:251], a[56:59], v[60:63], v[248:251]
v_exp_f32 v42, v42
v_mfma_f32_16x16x32_bf16 v[252:255], a[60:63], v[60:63], v[252:255]
v_mfma_f32_16x16x32_bf16 v[220:223], a[60:63], v[56:59], v[220:223]
ds_read_b128 a[36:39], v2 offset:1024
v_mfma_f32_16x16x32_bf16 v[188:191], a[60:63], v[52:55], v[188:191]
v_exp_f32 v43, v43
v_mfma_f32_16x16x32_bf16 v[156:159], a[60:63], v[48:51], v[156:159]
s_waitcnt lgkmcnt(6)
v_exp_f32 v44, v44
v_smfmac_f32_16x16x64_bf16 a[224:227], a[232:235], v[48:55], v9
buffer_load_dwordx4 v3, s[48:51], s32 offen offset:2048 sc1 lds
v_smfmac_f32_16x16x64_bf16 a[228:231], a[232:235], v[56:63], v9
ds_read_b128 a[40:43], v2 offset:2048
v_cvt_pk_bf16_f32 v75, v42, v43
v_mfma_f32_16x16x32_bf16 v[20:23], a[0:3], a[176:179], v[84:87]
v_mfma_f32_16x16x32_bf16 v[20:23], a[4:7], a[180:183], v[20:23]
v_exp_f32 v45, v45
v_mfma_f32_16x16x32_bf16 v[20:23], a[8:11], a[184:187], v[20:23]
ds_read_b128 a[44:47], v2 offset:3072
v_cvt_pk_bf16_f32 v78, v44, v45
v_mfma_f32_16x16x32_bf16 v[20:23], a[12:15], a[188:191], v[20:23]
v_exp_f32 v46, v46
v_mfma_f32_16x16x32_bf16 v[24:27], a[0:3], a[192:195], v[88:91]
v_mfma_f32_16x16x32_bf16 v[24:27], a[4:7], a[196:199], v[24:27]
ds_read_b128 a[48:51], v2 offset:4096
v_mfma_f32_16x16x32_bf16 v[24:27], a[8:11], a[200:203], v[24:27]
v_exp_f32 v47, v47
v_mfma_f32_16x16x32_bf16 v[24:27], a[12:15], a[204:207], v[24:27]
s_nop 0
v_exp_f32 v20, v20
v_mfma_f32_16x16x32_bf16 v[28:31], a[0:3], a[208:211], v[92:95]
buffer_load_dwordx4 v3, s[48:51], s32 offen offset:3072 sc1 lds
v_mfma_f32_16x16x32_bf16 v[28:31], a[4:7], a[212:215], v[28:31]
ds_read_b128 a[52:55], v2 offset:5120
v_cvt_pk_bf16_f32 v79, v46, v47
v_mfma_f32_16x16x32_bf16 v[28:31], a[8:11], a[216:219], v[28:31]
v_mfma_f32_16x16x32_bf16 v[28:31], a[12:15], a[220:223], v[28:31]
s_waitcnt lgkmcnt(6)
v_exp_f32 v21, v21
v_mfma_f32_16x16x32_bf16 v[36:39], a[16:19], a[176:179], v[84:87]
ds_read_b128 a[56:59], v2 offset:6144
v_cvt_pk_bf16_f32 v52, v20, v21
v_mfma_f32_16x16x32_bf16 v[36:39], a[20:23], a[180:183], v[36:39]
v_exp_f32 v22, v22
v_mfma_f32_16x16x32_bf16 v[36:39], a[24:27], a[184:187], v[36:39]
v_mfma_f32_16x16x32_bf16 v[36:39], a[28:31], a[188:191], v[36:39]
ds_read_b128 a[60:63], v2 offset:7168
v_mfma_f32_16x16x32_bf16 v[40:43], a[16:19], a[192:195], v[88:91]
s_mov_b32 s9, 0x600000
v_exp_f32 v23, v23
v_mfma_f32_16x16x32_bf16 v[40:43], a[20:23], a[196:199], v[40:43]
buffer_load_dword a244, v8, s[64:67], s9 offen
v_mfma_f32_16x16x32_bf16 v[40:43], a[24:27], a[200:203], v[40:43]
v_exp_f32 v24, v24
v_mfma_f32_16x16x32_bf16 v[40:43], a[28:31], a[204:207], v[40:43]
v_cvt_pk_bf16_f32 v53, v22, v23
v_mfma_f32_16x16x32_bf16 v[44:47], a[16:19], a[208:211], v[92:95]
v_exp_f32 v25, v25
v_mfma_f32_16x16x32_bf16 v[44:47], a[20:23], a[212:215], v[44:47]
v_exp_f32 v26, v26
v_mfma_f32_16x16x32_bf16 v[44:47], a[24:27], a[216:219], v[44:47]
v_exp_f32 v27, v27
v_mfma_f32_16x16x32_bf16 v[44:47], a[28:31], a[220:223], v[44:47]
s_waitcnt lgkmcnt(0)
v_mfma_f32_16x16x32_bf16 v[160:163], a[32:35], v[68:71], v[160:163]
ds_read_b128 a[0:3], v2 offset:24576
v_cvt_pk_bf16_f32 v56, v24, v25
v_mfma_f32_16x16x32_bf16 v[192:195], a[32:35], v[72:75], v[192:195]
v_exp_f32 v28, v28
v_mfma_f32_16x16x32_bf16 v[224:227], a[32:35], v[76:79], v[224:227]
ds_read_b128 a[4:7], v2 offset:25600
v_cvt_pk_bf16_f32 v57, v26, v27
v_mfma_f32_16x16x32_bf16 v[228:231], a[36:39], v[76:79], v[228:231]
s_add_u32 m0, s19, 0x1000
v_mfma_f32_16x16x32_bf16 v[196:199], a[36:39], v[72:75], v[196:199]
buffer_load_dwordx4 v3, s[48:51], s7 offen offset:0 sc1 lds
v_mfma_f32_16x16x32_bf16 v[164:167], a[36:39], v[68:71], v[164:167]
ds_read_b128 a[8:11], v2 offset:26624
v_mfma_f32_16x16x32_bf16 v[168:171], a[40:43], v[68:71], v[168:171]
v_exp_f32 v29, v29
v_mfma_f32_16x16x32_bf16 v[200:203], a[40:43], v[72:75], v[200:203]
v_exp_f32 v30, v30
v_mfma_f32_16x16x32_bf16 v[232:235], a[40:43], v[76:79], v[232:235]
ds_read_b128 a[12:15], v2 offset:27648
v_cvt_pk_bf16_f32 v60, v28, v29
v_mfma_f32_16x16x32_bf16 v[236:239], a[44:47], v[76:79], v[236:239]
v_exp_f32 v31, v31
v_mfma_f32_16x16x32_bf16 v[204:207], a[44:47], v[72:75], v[204:207]
v_exp_f32 v36, v36
v_mfma_f32_16x16x32_bf16 v[172:175], a[44:47], v[68:71], v[172:175]
ds_read_b128 a[16:19], v2 offset:28672
v_cvt_pk_bf16_f32 v61, v30, v31
v_mfma_f32_16x16x32_bf16 v[176:179], a[48:51], v[68:71], v[176:179]
buffer_load_dwordx4 v3, s[48:51], s7 offen offset:1024 sc1 lds
v_mfma_f32_16x16x32_bf16 v[208:211], a[48:51], v[72:75], v[208:211]
ds_read_b128 a[20:23], v2 offset:29696
v_mfma_f32_16x16x32_bf16 v[240:243], a[48:51], v[76:79], v[240:243]
v_mfma_f32_16x16x32_bf16 v[244:247], a[52:55], v[76:79], v[244:247]
v_exp_f32 v37, v37
v_mfma_f32_16x16x32_bf16 v[212:215], a[52:55], v[72:75], v[212:215]
ds_read_b128 a[24:27], v2 offset:30720
v_cvt_pk_bf16_f32 v54, v36, v37
v_mfma_f32_16x16x32_bf16 v[180:183], a[52:55], v[68:71], v[180:183]
v_exp_f32 v38, v38
v_mfma_f32_16x16x32_bf16 v[184:187], a[56:59], v[68:71], v[184:187]
v_exp_f32 v39, v39
v_mfma_f32_16x16x32_bf16 v[216:219], a[56:59], v[72:75], v[216:219]
ds_read_b128 a[28:31], v2 offset:31744
v_cvt_pk_bf16_f32 v55, v38, v39
v_mfma_f32_16x16x32_bf16 v[248:251], a[56:59], v[76:79], v[248:251]
v_exp_f32 v40, v40
v_mfma_f32_16x16x32_bf16 v[252:255], a[60:63], v[76:79], v[252:255]
buffer_load_dwordx4 v3, s[48:51], s7 offen offset:2048 sc1 lds
v_mfma_f32_16x16x32_bf16 v[220:223], a[60:63], v[72:75], v[220:223]
ds_read_b128 a[32:35], v2 offset:16384
v_mfma_f32_16x16x32_bf16 v[188:191], a[60:63], v[68:71], v[188:191]
v_exp_f32 v41, v41
v_mfma_f32_16x16x32_bf16 a[224:227], a[236:239], v[68:71], a[224:227]
ds_read_b128 a[36:39], v2 offset:17408
v_cvt_pk_bf16_f32 v58, v40, v41
v_smfmac_f32_16x16x64_bf16 a[228:231], a[232:235], v[72:79], v9
s_waitcnt lgkmcnt(6)
v_exp_f32 v42, v42
v_mfma_f32_16x16x32_bf16 v[20:23], a[0:3], a[176:179], v[104:107]
v_exp_f32 v43, v43
v_mfma_f32_16x16x32_bf16 v[20:23], a[4:7], a[180:183], v[20:23]
ds_read_b128 a[40:43], v2 offset:18432
v_cvt_pk_bf16_f32 v59, v42, v43
v_mfma_f32_16x16x32_bf16 v[20:23], a[8:11], a[184:187], v[20:23]
v_exp_f32 v44, v44
v_mfma_f32_16x16x32_bf16 v[20:23], a[12:15], a[188:191], v[20:23]
buffer_load_dwordx4 v3, s[48:51], s7 offen offset:3072 sc1 lds
v_mfma_f32_16x16x32_bf16 v[24:27], a[0:3], a[192:195], v[88:91]
ds_read_b128 a[44:47], v2 offset:19456
v_mfma_f32_16x16x32_bf16 v[24:27], a[4:7], a[196:199], v[24:27]
v_exp_f32 v45, v45
v_mfma_f32_16x16x32_bf16 v[24:27], a[8:11], a[200:203], v[24:27]
v_exp_f32 v46, v46
v_mfma_f32_16x16x32_bf16 v[24:27], a[12:15], a[204:207], v[24:27]
ds_read_b128 a[48:51], v2 offset:20480
v_add_u32 v4, s0, v3
v_mfma_f32_16x16x32_bf16 v[28:31], a[0:3], a[208:211], v[92:95]
v_cvt_pk_bf16_f32 v62, v44, v45
v_mfma_f32_16x16x32_bf16 v[28:31], a[4:7], a[212:215], v[28:31]
ds_read_b128 a[52:55], v2 offset:21504
v_mov_b32 v5, s1
v_mfma_f32_16x16x32_bf16 v[28:31], a[8:11], a[216:219], v[28:31]
s_waitcnt lgkmcnt(6)
v_exp_f32 v47, v47
v_mfma_f32_16x16x32_bf16 v[28:31], a[12:15], a[220:223], v[28:31]
global_load_dword a244, v[4:5], off sc1
v_mfma_f32_16x16x32_bf16 v[36:39], a[16:19], a[176:179], v[108:111]
ds_read_b128 a[56:59], v2 offset:22528
v_cvt_pk_bf16_f32 v63, v46, v47
v_mfma_f32_16x16x32_bf16 v[36:39], a[20:23], a[180:183], v[36:39]
s_add_u32 s32, s32, 0x8000
v_exp_f32 v20, v20
v_mfma_f32_16x16x32_bf16 v[36:39], a[24:27], a[184:187], v[36:39]
s_add_u32 s7, s7, 0x8000
v_exp_f32 v21, v21
v_mfma_f32_16x16x32_bf16 v[36:39], a[28:31], a[188:191], v[36:39]
ds_read_b128 a[60:63], v2 offset:23552
v_xor_b32 v2, 0x38000, v2
v_mfma_f32_16x16x32_bf16 v[40:43], a[16:19], a[192:195], v[88:91]
s_xor_b32 s19, s19, 0x8000
v_exp_f32 v22, v22
v_mfma_f32_16x16x32_bf16 v[40:43], a[20:23], a[196:199], v[40:43]
s_sub_u32 s15, 7, s6
v_exp_f32 v23, v23
v_mfma_f32_16x16x32_bf16 v[40:43], a[24:27], a[200:203], v[40:43]
s_lshl_b32 s15, s15, 1
v_exp_f32 v24, v24
v_mfma_f32_16x16x32_bf16 v[40:43], a[28:31], a[204:207], v[40:43]
v_exp_f32 v25, v25
v_mfma_f32_16x16x32_bf16 v[44:47], a[16:19], a[208:211], v[92:95]
v_exp_f32 v26, v26
v_mfma_f32_16x16x32_bf16 v[44:47], a[20:23], a[212:215], v[44:47]
v_exp_f32 v27, v27
v_mfma_f32_16x16x32_bf16 v[44:47], a[24:27], a[216:219], v[44:47]
s_waitcnt vmcnt(22) lgkmcnt(0)
v_cvt_pk_bf16_f32 v68, v20, v21
v_cvt_pk_bf16_f32 v69, v22, v23
v_mfma_f32_16x16x32_bf16 v[44:47], a[28:31], a[220:223], v[44:47]
s_barrier
s_cbranch_scc0 L_att_lh0_0
v_mfma_f32_16x16x32_bf16 v[160:163], a[32:35], v[52:55], v[160:163]
ds_read_b128 a[0:3], v1 offset:8192
v_cvt_pk_bf16_f32 v72, v24, v25
v_mfma_f32_16x16x32_bf16 v[192:195], a[32:35], v[56:59], v[192:195]
v_exp_f32 v28, v28
v_mfma_f32_16x16x32_bf16 v[224:227], a[32:35], v[60:63], v[224:227]
ds_read_b128 a[4:7], v1 offset:9216
v_cvt_pk_bf16_f32 v73, v26, v27
v_mfma_f32_16x16x32_bf16 v[228:231], a[36:39], v[60:63], v[228:231]
s_add_u32 m0, s27, 0x0
v_exp_f32 v29, v29
v_mfma_f32_16x16x32_bf16 v[196:199], a[36:39], v[56:59], v[196:199]
buffer_load_dwordx4 v3, s[48:51], s32 offen offset:0 sc1 lds
v_mfma_f32_16x16x32_bf16 v[164:167], a[36:39], v[52:55], v[164:167]
ds_read_b128 a[8:11], v1 offset:10240
v_cvt_pk_bf16_f32 v76, v28, v29
v_mfma_f32_16x16x32_bf16 v[168:171], a[40:43], v[52:55], v[168:171]
ds_read_b128 a[12:15], v1 offset:11264
v_accvgpr_read_b32 v6, a224
v_mfma_f32_16x16x32_bf16 v[200:203], a[40:43], v[56:59], v[200:203]
v_exp_f32 v30, v30
v_mfma_f32_16x16x32_bf16 v[232:235], a[40:43], v[60:63], v[232:235]
v_exp_f32 v31, v31
v_mfma_f32_16x16x32_bf16 v[236:239], a[44:47], v[60:63], v[236:239]
ds_read_b128 a[16:19], v1 offset:12288
v_cvt_pk_bf16_f32 v77, v30, v31
v_mfma_f32_16x16x32_bf16 v[204:207], a[44:47], v[56:59], v[204:207]
v_exp_f32 v36, v36
v_mfma_f32_16x16x32_bf16 v[172:175], a[44:47], v[52:55], v[172:175]
ds_read_b128 a[20:23], v1 offset:13312
v_accvgpr_read_b32 v7, a225
v_mfma_f32_16x16x32_bf16 v[176:179], a[48:51], v[52:55], v[176:179]
v_exp_f32 v37, v37
v_mfma_f32_16x16x32_bf16 v[208:211], a[48:51], v[56:59], v[208:211]
ds_read_b128 a[24:27], v1 offset:14336
v_cvt_pk_bf16_f32 v70, v36, v37
v_mfma_f32_16x16x32_bf16 v[240:243], a[48:51], v[60:63], v[240:243]
buffer_load_dwordx4 v3, s[48:51], s32 offen offset:1024 sc1 lds
v_mfma_f32_16x16x32_bf16 v[244:247], a[52:55], v[60:63], v[244:247]
v_exp_f32 v38, v38
v_mfma_f32_16x16x32_bf16 v[212:215], a[52:55], v[56:59], v[212:215]
ds_read_b128 a[28:31], v1 offset:15360
v_add_f32 v6, v6, v7
v_mfma_f32_16x16x32_bf16 v[180:183], a[52:55], v[52:55], v[180:183]
v_exp_f32 v39, v39
v_mfma_f32_16x16x32_bf16 v[184:187], a[56:59], v[52:55], v[184:187]
ds_read_b128 a[32:35], v1 offset:0
v_cvt_pk_bf16_f32 v71, v38, v39
v_mfma_f32_16x16x32_bf16 v[216:219], a[56:59], v[56:59], v[216:219]
v_exp_f32 v40, v40
v_mfma_f32_16x16x32_bf16 v[248:251], a[56:59], v[60:63], v[248:251]
ds_read_b128 a[36:39], v1 offset:1024
v_cmp_nge_f32 vcc, 0x5f800000, v6
v_mfma_f32_16x16x32_bf16 v[252:255], a[60:63], v[60:63], v[252:255]
v_exp_f32 v41, v41
v_mfma_f32_16x16x32_bf16 v[220:223], a[60:63], v[56:59], v[220:223]
v_exp_f32 v42, v42
v_mfma_f32_16x16x32_bf16 v[188:191], a[60:63], v[52:55], v[188:191]
ds_read_b128 a[40:43], v1 offset:2048
v_cvt_pk_bf16_f32 v74, v40, v41
v_mfma_f32_16x16x32_bf16 a[224:227], a[236:239], v[52:55], a[224:227]
buffer_load_dwordx4 v3, s[48:51], s32 offen offset:2048 sc1 lds
v_smfmac_f32_16x16x64_bf16 a[228:231], a[232:235], v[56:63], v9
ds_read_b128 a[44:47], v1 offset:3072
s_waitcnt lgkmcnt(8)
v_mfma_f32_16x16x32_bf16 v[24:27], a[0:3], a[192:195], v[88:91]
v_exp_f32 v43, v43
v_mfma_f32_16x16x32_bf16 v[24:27], a[4:7], a[196:199], v[24:27]
ds_read_b128 a[48:51], v1 offset:4096
v_cvt_pk_bf16_f32 v75, v42, v43
v_mfma_f32_16x16x32_bf16 v[24:27], a[8:11], a[200:203], v[24:27]
v_exp_f32 v44, v44
v_mfma_f32_16x16x32_bf16 v[24:27], a[12:15], a[204:207], v[24:27]
v_exp_f32 v45, v45
v_mfma_f32_16x16x32_bf16 v[28:31], a[0:3], a[208:211], v[92:95]
ds_read_b128 a[52:55], v1 offset:5120
v_cvt_pk_bf16_f32 v78, v44, v45
v_mfma_f32_16x16x32_bf16 v[28:31], a[4:7], a[212:215], v[28:31]
v_exp_f32 v46, v46
v_mfma_f32_16x16x32_bf16 v[28:31], a[8:11], a[216:219], v[28:31]
ds_read_b128 a[56:59], v1 offset:6144
v_mfma_f32_16x16x32_bf16 v[28:31], a[12:15], a[220:223], v[28:31]
s_waitcnt lgkmcnt(7)
v_exp_f32 v47, v47
v_mfma_f32_16x16x32_bf16 v[40:43], a[16:19], a[192:195], v[88:91]
buffer_load_dwordx4 v3, s[48:51], s32 offen offset:3072 sc1 lds
v_mfma_f32_16x16x32_bf16 v[40:43], a[20:23], a[196:199], v[40:43]
ds_read_b128 a[60:63], v1 offset:7168
v_cvt_pk_bf16_f32 v79, v46, v47
v_mfma_f32_16x16x32_bf16 v[40:43], a[24:27], a[200:203], v[40:43]
s_add_u32 s32, s32, 0x8000
v_exp_f32 v24, v24
v_mfma_f32_16x16x32_bf16 v[40:43], a[28:31], a[204:207], v[40:43]
v_exp_f32 v25, v25
v_mfma_f32_16x16x32_bf16 v[44:47], a[16:19], a[208:211], v[92:95]
v_exp_f32 v26, v26
v_mfma_f32_16x16x32_bf16 v[44:47], a[20:23], a[212:215], v[44:47]
v_exp_f32 v27, v27
v_mfma_f32_16x16x32_bf16 v[44:47], a[24:27], a[216:219], v[44:47]
v_exp_f32 v28, v28
v_mfma_f32_16x16x32_bf16 v[44:47], a[28:31], a[220:223], v[44:47]
s_waitcnt lgkmcnt(0)
v_exp_f32 v29, v29
v_mfma_f32_16x16x32_bf16 v[160:163], a[32:35], v[68:71], v[160:163]
ds_read_b128 a[0:3], v1 offset:24576
v_cvt_pk_bf16_f32 v56, v24, v25
v_mfma_f32_16x16x32_bf16 v[192:195], a[32:35], v[72:75], v[192:195]
v_exp_f32 v30, v30
v_mfma_f32_16x16x32_bf16 v[224:227], a[32:35], v[76:79], v[224:227]
ds_read_b128 a[4:7], v1 offset:25600
v_cvt_pk_bf16_f32 v57, v26, v27
v_mfma_f32_16x16x32_bf16 v[228:231], a[36:39], v[76:79], v[228:231]
s_add_u32 m0, s27, 0x1000
v_cvt_pk_bf16_f32 v60, v28, v29
v_mfma_f32_16x16x32_bf16 v[196:199], a[36:39], v[72:75], v[196:199]
buffer_load_dwordx4 v3, s[48:51], s7 offen offset:0 sc1 lds
v_mfma_f32_16x16x32_bf16 v[164:167], a[36:39], v[68:71], v[164:167]
ds_read_b128 a[8:11], v1 offset:26624
v_mfma_f32_16x16x32_bf16 v[168:171], a[40:43], v[68:71], v[168:171]
ds_read_b128 a[12:15], v1 offset:27648
v_mfma_f32_16x16x32_bf16 v[200:203], a[40:43], v[72:75], v[200:203]
v_exp_f32 v31, v31
v_mfma_f32_16x16x32_bf16 v[232:235], a[40:43], v[76:79], v[232:235]
v_exp_f32 v40, v40
v_mfma_f32_16x16x32_bf16 v[236:239], a[44:47], v[76:79], v[236:239]
ds_read_b128 a[16:19], v1 offset:28672
v_cvt_pk_bf16_f32 v61, v30, v31
v_mfma_f32_16x16x32_bf16 v[204:207], a[44:47], v[72:75], v[204:207]
v_exp_f32 v41, v41
v_mfma_f32_16x16x32_bf16 v[172:175], a[44:47], v[68:71], v[172:175]
ds_read_b128 a[20:23], v1 offset:29696
v_cvt_pk_bf16_f32 v58, v40, v41
v_mfma_f32_16x16x32_bf16 v[176:179], a[48:51], v[68:71], v[176:179]
v_rcp_f32 v6, v6
v_mfma_f32_16x16x32_bf16 v[208:211], a[48:51], v[72:75], v[208:211]
buffer_load_dwordx4 v3, s[48:51], s7 offen offset:1024 sc1 lds
v_mfma_f32_16x16x32_bf16 v[240:243], a[48:51], v[76:79], v[240:243]
ds_read_b128 a[24:27], v1 offset:30720
s_or_b64 s[34:35], s[34:35], vcc
v_mfma_f32_16x16x32_bf16 v[244:247], a[52:55], v[76:79], v[244:247]
ds_read_b128 a[28:31], v1 offset:31744
s_add_u32 s8, s28, 0x0
v_mfma_f32_16x16x32_bf16 v[212:215], a[52:55], v[72:75], v[212:215]
v_exp_f32 v42, v42
v_mfma_f32_16x16x32_bf16 v[180:183], a[52:55], v[68:71], v[180:183]
v_exp_f32 v43, v43
v_mfma_f32_16x16x32_bf16 v[184:187], a[56:59], v[68:71], v[184:187]
ds_read_b128 a[32:35], v1 offset:16384
v_cvt_pk_bf16_f32 v59, v42, v43
v_mfma_f32_16x16x32_bf16 v[216:219], a[56:59], v[72:75], v[216:219]
v_exp_f32 v44, v44
v_mfma_f32_16x16x32_bf16 v[248:251], a[56:59], v[76:79], v[248:251]
ds_read_b128 a[36:39], v1 offset:17408
v_mul_f32 v128, v6, v128
v_mfma_f32_16x16x32_bf16 v[252:255], a[60:63], v[76:79], v[252:255]
v_mul_f32 v129, v6, v129
v_mul_f32 v130, v6, v130
v_mfma_f32_16x16x32_bf16 v[220:223], a[60:63], v[72:75], v[220:223]
ds_read_b128 a[40:43], v1 offset:18432
v_mul_f32 v131, v6, v131
v_mfma_f32_16x16x32_bf16 v[188:191], a[60:63], v[68:71], v[188:191]
buffer_load_dwordx4 v3, s[48:51], s7 offen offset:2048 sc1 lds
v_mfma_f32_16x16x32_bf16 a[224:227], a[236:239], v[68:71], a[224:227]
ds_read_b128 a[44:47], v1 offset:19456
v_mul_f32 v132, v6, v132
v_smfmac_f32_16x16x64_bf16 a[228:231], a[232:235], v[72:79], v9
s_waitcnt lgkmcnt(8)
v_exp_f32 v45, v45
v_mfma_f32_16x16x32_bf16 v[24:27], a[0:3], a[192:195], v[88:91]
v_exp_f32 v46, v46
v_mfma_f32_16x16x32_bf16 v[24:27], a[4:7], a[196:199], v[24:27]
ds_read_b128 a[48:51], v1 offset:20480
v_cvt_pk_bf16_f32 v62, v44, v45
v_mfma_f32_16x16x32_bf16 v[24:27], a[8:11], a[200:203], v[24:27]
v_exp_f32 v47, v47
v_mfma_f32_16x16x32_bf16 v[24:27], a[12:15], a[204:207], v[24:27]
ds_read_b128 a[52:55], v1 offset:21504
v_cvt_pk_bf16_f32 v63, v46, v47
v_mfma_f32_16x16x32_bf16 v[28:31], a[0:3], a[208:211], v[92:95]
v_mul_f32 v133, v6, v133
v_mul_f32 v134, v6, v134
v_mfma_f32_16x16x32_bf16 v[28:31], a[4:7], a[212:215], v[28:31]
ds_read_b128 a[56:59], v1 offset:22528
v_mul_f32 v135, v6, v135
v_mfma_f32_16x16x32_bf16 v[28:31], a[8:11], a[216:219], v[28:31]
buffer_load_dwordx4 v3, s[48:51], s7 offen offset:3072 sc1 lds
v_mfma_f32_16x16x32_bf16 v[28:31], a[12:15], a[220:223], v[28:31]
ds_read_b128 a[60:63], v1 offset:23552
s_waitcnt lgkmcnt(8)
v_mfma_f32_16x16x32_bf16 v[40:43], a[16:19], a[192:195], v[88:91]
s_add_u32 s7, s7, 0x8000
v_xor_b32 v1, 0x8000, v1
v_cvt_pk_bf16_f32 v128, v128, v129
v_mfma_f32_16x16x32_bf16 v[40:43], a[20:23], a[196:199], v[40:43]
s_xor_b32 s27, s27, 0x38000
v_exp_f32 v24, v24
v_mfma_f32_16x16x32_bf16 v[40:43], a[24:27], a[200:203], v[40:43]
v_exp_f32 v25, v25
v_mfma_f32_16x16x32_bf16 v[40:43], a[28:31], a[204:207], v[40:43]
v_exp_f32 v26, v26
v_mfma_f32_16x16x32_bf16 v[44:47], a[16:19], a[208:211], v[92:95]
v_exp_f32 v27, v27
v_mfma_f32_16x16x32_bf16 v[44:47], a[20:23], a[212:215], v[44:47]
v_exp_f32 v28, v28
v_mfma_f32_16x16x32_bf16 v[44:47], a[24:27], a[216:219], v[44:47]
s_waitcnt vmcnt(19) lgkmcnt(0)
v_exp_f32 v29, v29
v_mfma_f32_16x16x32_bf16 v[44:47], a[28:31], a[220:223], v[44:47]
s_barrier
v_cvt_pk_bf16_f32 v129, v130, v131
v_cvt_pk_bf16_f32 v130, v132, v133
v_cvt_pk_bf16_f32 v131, v134, v135
buffer_store_dwordx4 v[128:131], v3, s[88:91], s8 offen sc1
s_add_u32 s8, s28, 0x2000
v_mul_f32 v136, v6, v136
v_mul_f32 v137, v6, v137
v_mul_f32 v138, v6, v138
v_mul_f32 v139, v6, v139
v_mul_f32 v140, v6, v140
v_mul_f32 v141, v6, v141
v_mul_f32 v142, v6, v142
v_mul_f32 v143, v6, v143
v_cvt_pk_bf16_f32 v136, v136, v137
v_cvt_pk_bf16_f32 v137, v138, v139
v_cvt_pk_bf16_f32 v138, v140, v141
v_cvt_pk_bf16_f32 v139, v142, v143
buffer_store_dwordx4 v[136:139], v3, s[88:91], s8 offen sc1
s_add_u32 s8, s28, 0x4000
v_mul_f32 v144, v6, v144
v_mul_f32 v145, v6, v145
v_mul_f32 v146, v6, v146
v_mul_f32 v147, v6, v147
v_mul_f32 v148, v6, v148
v_mul_f32 v149, v6, v149
v_mul_f32 v150, v6, v150
v_mul_f32 v151, v6, v151
v_cvt_pk_bf16_f32 v144, v144, v145
v_cvt_pk_bf16_f32 v145, v146, v147
v_cvt_pk_bf16_f32 v146, v148, v149
v_cvt_pk_bf16_f32 v147, v150, v151
buffer_store_dwordx4 v[144:147], v3, s[88:91], s8 offen sc1
s_add_u32 s8, s28, 0x6000
v_mul_f32 v152, v6, v152
v_mul_f32 v153, v6, v153
v_mul_f32 v154, v6, v154
v_mul_f32 v155, v6, v155
v_mul_f32 v156, v6, v156
v_mul_f32 v157, v6, v157
v_mul_f32 v158, v6, v158
v_mul_f32 v159, v6, v159
v_cvt_pk_bf16_f32 v152, v152, v153
v_cvt_pk_bf16_f32 v153, v154, v155
v_cvt_pk_bf16_f32 v154, v156, v157
v_cvt_pk_bf16_f32 v155, v158, v159
buffer_store_dwordx4 v[152:155], v3, s[88:91], s8 offen sc1
v_accvgpr_read_b32 v6, a226
v_accvgpr_read_b32 v7, a227
v_add_f32 v6, v6, v7
v_cmp_nge_f32 vcc, 0x5f800000, v6
v_rcp_f32 v6, v6
s_or_b64 s[34:35], s[34:35], vcc
s_add_u32 s8, s29, 0x0
v_pk_mul_f32 v[160:161], v[160:161], v[6:7] op_sel_hi:[1,0]
v_pk_mul_f32 v[162:163], v[162:163], v[6:7] op_sel_hi:[1,0]
v_pk_mul_f32 v[164:165], v[164:165], v[6:7] op_sel_hi:[1,0]
v_pk_mul_f32 v[166:167], v[166:167], v[6:7] op_sel_hi:[1,0]
v_cvt_pk_bf16_f32 v160, v160, v161
v_cvt_pk_bf16_f32 v161, v162, v163
v_cvt_pk_bf16_f32 v162, v164, v165
v_cvt_pk_bf16_f32 v163, v166, v167
buffer_store_dwordx4 v[160:163], v3, s[88:91], s8 offen sc1
s_add_u32 s8, s29, 0x2000
v_pk_mul_f32 v[168:169], v[168:169], v[6:7] op_sel_hi:[1,0]
v_pk_mul_f32 v[170:171], v[170:171], v[6:7] op_sel_hi:[1,0]
v_pk_mul_f32 v[172:173], v[172:173], v[6:7] op_sel_hi:[1,0]
v_pk_mul_f32 v[174:175], v[174:175], v[6:7] op_sel_hi:[1,0]
v_cvt_pk_bf16_f32 v168, v168, v169
v_cvt_pk_bf16_f32 v169, v170, v171
v_cvt_pk_bf16_f32 v170, v172, v173
v_cvt_pk_bf16_f32 v171, v174, v175
buffer_store_dwordx4 v[168:171], v3, s[88:91], s8 offen sc1
s_add_u32 s8, s29, 0x4000
v_pk_mul_f32 v[176:177], v[176:177], v[6:7] op_sel_hi:[1,0]
v_pk_mul_f32 v[178:179], v[178:179], v[6:7] op_sel_hi:[1,0]
v_pk_mul_f32 v[180:181], v[180:181], v[6:7] op_sel_hi:[1,0]
v_pk_mul_f32 v[182:183], v[182:183], v[6:7] op_sel_hi:[1,0]
v_cvt_pk_bf16_f32 v176, v176, v177
v_cvt_pk_bf16_f32 v177, v178, v179
v_cvt_pk_bf16_f32 v178, v180, v181
v_cvt_pk_bf16_f32 v179, v182, v183
buffer_store_dwordx4 v[176:179], v3, s[88:91], s8 offen sc1
s_add_u32 s8, s29, 0x6000
v_pk_mul_f32 v[184:185], v[184:185], v[6:7] op_sel_hi:[1,0]
v_pk_mul_f32 v[186:187], v[186:187], v[6:7] op_sel_hi:[1,0]
v_pk_mul_f32 v[188:189], v[188:189], v[6:7] op_sel_hi:[1,0]
v_pk_mul_f32 v[190:191], v[190:191], v[6:7] op_sel_hi:[1,0]
v_cvt_pk_bf16_f32 v184, v184, v185
v_cvt_pk_bf16_f32 v185, v186, v187
v_cvt_pk_bf16_f32 v186, v188, v189
v_cvt_pk_bf16_f32 v187, v190, v191
buffer_store_dwordx4 v[184:187], v3, s[88:91], s8 offen sc1
s_getreg_b32 s8, hwreg(HW_REG_HW_ID, 5, 1)
s_cmp_lg_u32 s8, 0
s_cbranch_scc1 L_att_sodd1
s_branch L_att_sodd0
L_att_lh0_0:
v_mfma_f32_16x16x32_bf16 v[160:163], a[32:35], v[52:55], v[160:163]
v_exp_f32 v28, v28
v_mfma_f32_16x16x32_bf16 v[192:195], a[32:35], v[56:59], v[192:195]
buffer_load_dword v14, v15, s[84:87], 0 offen offset:192 sc1
v_mfma_f32_16x16x32_bf16 v[224:227], a[32:35], v[60:63], v[224:227]
v_exp_f32 v29, v29
v_mfma_f32_16x16x32_bf16 v[228:231], a[36:39], v[60:63], v[228:231]
v_exp_f32 v30, v30
v_mfma_f32_16x16x32_bf16 v[196:199], a[36:39], v[56:59], v[196:199]
s_add_u32 m0, s17, 0x10000
v_exp_f32 v31, v31
v_mfma_f32_16x16x32_bf16 v[164:167], a[36:39], v[52:55], v[164:167]
ds_read_b128 a[0:3], v1 offset:8192
v_cvt_pk_bf16_f32 v72, v24, v25
v_mfma_f32_16x16x32_bf16 v[168:171], a[40:43], v[52:55], v[168:171]
ds_read_b128 a[4:7], v1 offset:9216
v_cvt_pk_bf16_f32 v73, v26, v27
v_mfma_f32_16x16x32_bf16 v[200:203], a[40:43], v[56:59], v[200:203]
buffer_load_dwordx4 v12, s[72:75], 0 offen lds
v_mfma_f32_16x16x32_bf16 v[232:235], a[40:43], v[60:63], v[232:235]
ds_read_b128 a[8:11], v1 offset:10240
v_cvt_pk_bf16_f32 v76, v28, v29
v_mfma_f32_16x16x32_bf16 v[236:239], a[44:47], v[60:63], v[236:239]
v_exp_f32 v36, v36
v_mfma_f32_16x16x32_bf16 v[204:207], a[44:47], v[56:59], v[204:207]
v_exp_f32 v37, v37
v_mfma_f32_16x16x32_bf16 v[172:175], a[44:47], v[52:55], v[172:175]
ds_read_b128 a[12:15], v1 offset:11264
v_cvt_pk_bf16_f32 v77, v30, v31
v_mfma_f32_16x16x32_bf16 v[176:179], a[48:51], v[52:55], v[176:179]
buffer_load_dwordx4 v13, s[72:75], 0 offen offset:1024 lds
v_mfma_f32_16x16x32_bf16 v[208:211], a[48:51], v[56:59], v[208:211]
ds_read_b128 a[16:19], v1 offset:12288
v_cvt_pk_bf16_f32 v70, v36, v37
v_mfma_f32_16x16x32_bf16 v[240:243], a[48:51], v[60:63], v[240:243]
ds_read_b128 a[20:23], v1 offset:13312
v_exp_f32 v38, v38
v_mfma_f32_16x16x32_bf16 v[244:247], a[52:55], v[60:63], v[244:247]
ds_read_b128 a[24:27], v1 offset:14336
v_exp_f32 v39, v39
v_mfma_f32_16x16x32_bf16 v[212:215], a[52:55], v[56:59], v[212:215]
v_exp_f32 v40, v40
v_mfma_f32_16x16x32_bf16 v[180:183], a[52:55], v[52:55], v[180:183]
buffer_load_dwordx4 v12, s[72:75], s12 offen offset:2048 lds
v_mfma_f32_16x16x32_bf16 v[184:187], a[56:59], v[52:55], v[184:187]
ds_read_b128 a[28:31], v1 offset:15360
v_exp_f32 v41, v41
v_mfma_f32_16x16x32_bf16 v[216:219], a[56:59], v[56:59], v[216:219]
buffer_load_dwordx4 v13, s[72:75], s12 offen offset:3072 lds
v_mfma_f32_16x16x32_bf16 v[248:251], a[56:59], v[60:63], v[248:251]
s_add_u32 m0, s17, 0x14000
v_exp_f32 v42, v42
v_mfma_f32_16x16x32_bf16 v[252:255], a[60:63], v[60:63], v[252:255]
ds_read_b128 a[32:35], v1 offset:0
v_cvt_pk_bf16_f32 v71, v38, v39
v_mfma_f32_16x16x32_bf16 v[220:223], a[60:63], v[56:59], v[220:223]
ds_read_b128 a[36:39], v1 offset:1024
v_add_u32 v12, 0x20000, v12
v_mfma_f32_16x16x32_bf16 v[188:191], a[60:63], v[52:55], v[188:191]
buffer_load_dwordx4 v12, s[72:75], 0 offen lds
v_mfma_f32_16x16x32_bf16 a[224:227], a[236:239], v[52:55], a[224:227]
ds_read_b128 a[40:43], v1 offset:2048
v_exp_f32 v43, v43
v_smfmac_f32_16x16x64_bf16 a[228:231], a[232:235], v[56:63], v9
s_waitcnt lgkmcnt(7)
v_exp_f32 v44, v44
v_mfma_f32_16x16x32_bf16 v[24:27], a[0:3], a[192:195], v[112:115]
ds_read_b128 a[44:47], v1 offset:3072
v_exp_f32 v45, v45
v_mfma_f32_16x16x32_bf16 v[24:27], a[4:7], a[196:199], v[24:27]
ds_read_b128 a[48:51], v1 offset:4096
v_add_u32 v13, 0x20000, v13
v_mfma_f32_16x16x32_bf16 v[24:27], a[8:11], a[200:203], v[24:27]
v_exp_f32 v46, v46
v_mfma_f32_16x16x32_bf16 v[24:27], a[12:15], a[204:207], v[24:27]
buffer_load_dwordx4 v13, s[72:75], 0 offen offset:1024 lds
v_mfma_f32_16x16x32_bf16 v[28:31], a[0:3], a[208:211], v[92:95]
v_exp_f32 v47, v47
v_mfma_f32_16x16x32_bf16 v[28:31], a[4:7], a[212:215], v[28:31]
ds_read_b128 a[52:55], v1 offset:5120
v_cvt_pk_bf16_f32 v74, v40, v41
v_mfma_f32_16x16x32_bf16 v[28:31], a[8:11], a[216:219], v[28:31]
ds_read_b128 a[56:59], v1 offset:6144
v_cvt_pk_bf16_f32 v75, v42, v43
v_mfma_f32_16x16x32_bf16 v[28:31], a[12:15], a[220:223], v[28:31]
s_waitcnt lgkmcnt(7)
v_exp_f32 v24, v24
v_mfma_f32_16x16x32_bf16 v[40:43], a[16:19], a[192:195], v[116:119]
buffer_load_dwordx4 v12, s[72:75], s12 offen offset:2048 lds
v_mfma_f32_16x16x32_bf16 v[40:43], a[20:23], a[196:199], v[40:43]
ds_read_b128 a[60:63], v1 offset:7168
v_cvt_pk_bf16_f32 v78, v44, v45
v_mfma_f32_16x16x32_bf16 v[40:43], a[24:27], a[200:203], v[40:43]
v_exp_f32 v25, v25
v_mfma_f32_16x16x32_bf16 v[40:43], a[28:31], a[204:207], v[40:43]
buffer_load_dwordx4 v13, s[72:75], s12 offen offset:3072 lds
v_cvt_pk_bf16_f32 v79, v46, v47
v_mfma_f32_16x16x32_bf16 v[44:47], a[16:19], a[208:211], v[92:95]
v_exp_f32 v26, v26
v_mfma_f32_16x16x32_bf16 v[44:47], a[20:23], a[212:215], v[44:47]
v_exp_f32 v27, v27
v_mfma_f32_16x16x32_bf16 v[44:47], a[24:27], a[216:219], v[44:47]
v_exp_f32 v28, v28
v_mfma_f32_16x16x32_bf16 v[44:47], a[28:31], a[220:223], v[44:47]
s_waitcnt lgkmcnt(0)
v_exp_f32 v29, v29
v_mfma_f32_16x16x32_bf16 v[160:163], a[32:35], v[68:71], v[160:163]
ds_read_b128 a[0:3], v1 offset:24576
v_cvt_pk_bf16_f32 v56, v24, v25
v_mfma_f32_16x16x32_bf16 v[192:195], a[32:35], v[72:75], v[192:195]
ds_read_b128 a[4:7], v1 offset:25600
v_add_u32 v12, 0x20000, v12
v_mfma_f32_16x16x32_bf16 v[224:227], a[32:35], v[76:79], v[224:227]
s_add_u32 m0, s16, 0x0
v_exp_f32 v30, v30
v_mfma_f32_16x16x32_bf16 v[228:231], a[36:39], v[76:79], v[228:231]
buffer_load_dwordx4 v12, s[72:75], 0 offen lds
v_mfma_f32_16x16x32_bf16 v[196:199], a[36:39], v[72:75], v[196:199]
ds_read_b128 a[8:11], v1 offset:26624
v_add_u32 v13, 0x20000, v13
v_mfma_f32_16x16x32_bf16 v[164:167], a[36:39], v[68:71], v[164:167]
buffer_load_dwordx4 v13, s[72:75], 0 offen offset:1024 lds
v_mfma_f32_16x16x32_bf16 v[168:171], a[40:43], v[68:71], v[168:171]
ds_read_b128 a[12:15], v1 offset:27648
v_cvt_pk_bf16_f32 v57, v26, v27
v_mfma_f32_16x16x32_bf16 v[200:203], a[40:43], v[72:75], v[200:203]
v_exp_f32 v31, v31
v_mfma_f32_16x16x32_bf16 v[232:235], a[40:43], v[76:79], v[232:235]
ds_read_b128 a[16:19], v1 offset:28672
v_cvt_pk_bf16_f32 v60, v28, v29
v_mfma_f32_16x16x32_bf16 v[236:239], a[44:47], v[76:79], v[236:239]
buffer_load_dwordx4 v12, s[72:75], s12 offen offset:2048 lds
v_mfma_f32_16x16x32_bf16 v[204:207], a[44:47], v[72:75], v[204:207]
ds_read_b128 a[20:23], v1 offset:29696
v_cvt_pk_bf16_f32 v61, v30, v31
v_mfma_f32_16x16x32_bf16 v[172:175], a[44:47], v[68:71], v[172:175]
buffer_load_dwordx4 v13, s[72:75], s12 offen offset:3072 lds
v_mfma_f32_16x16x32_bf16 v[176:179], a[48:51], v[68:71], v[176:179]
ds_read_b128 a[24:27], v1 offset:30720
v_mfma_f32_16x16x32_bf16 v[208:211], a[48:51], v[72:75], v[208:211]
ds_read_b128 a[28:31], v1 offset:31744
v_mfma_f32_16x16x32_bf16 v[240:243], a[48:51], v[76:79], v[240:243]
v_exp_f32 v40, v40
v_mfma_f32_16x16x32_bf16 v[244:247], a[52:55], v[76:79], v[244:247]
s_add_u32 m0, s16, 0x4000
v_exp_f32 v41, v41
v_mfma_f32_16x16x32_bf16 v[212:215], a[52:55], v[72:75], v[212:215]
ds_read_b128 a[32:35], v1 offset:16384
v_cvt_pk_bf16_f32 v58, v40, v41
v_mfma_f32_16x16x32_bf16 v[180:183], a[52:55], v[68:71], v[180:183]
ds_read_b128 a[36:39], v1 offset:17408
v_add_u32 v12, 0x20000, v12
v_mfma_f32_16x16x32_bf16 v[184:187], a[56:59], v[68:71], v[184:187]
buffer_load_dwordx4 v12, s[72:75], 0 offen lds
v_mfma_f32_16x16x32_bf16 v[216:219], a[56:59], v[72:75], v[216:219]
ds_read_b128 a[40:43], v1 offset:18432
v_mfma_f32_16x16x32_bf16 v[248:251], a[56:59], v[76:79], v[248:251]
v_exp_f32 v42, v42
v_mfma_f32_16x16x32_bf16 v[252:255], a[60:63], v[76:79], v[252:255]
ds_read_b128 a[44:47], v1 offset:19456
v_add_u32 v13, 0x20000, v13
v_mfma_f32_16x16x32_bf16 v[220:223], a[60:63], v[72:75], v[220:223]
buffer_load_dwordx4 v13, s[72:75], 0 offen offset:1024 lds
v_mfma_f32_16x16x32_bf16 v[188:191], a[60:63], v[68:71], v[188:191]
ds_read_b128 a[48:51], v1 offset:20480
v_exp_f32 v43, v43
v_mfma_f32_16x16x32_bf16 a[224:227], a[236:239], v[68:71], a[224:227]
s_waitcnt lgkmcnt(9)
v_exp_f32 v44, v44
v_smfmac_f32_16x16x64_bf16 a[228:231], a[232:235], v[72:79], v9
ds_read_b128 a[52:55], v1 offset:21504
v_exp_f32 v45, v45
v_mfma_f32_16x16x32_bf16 v[28:31], a[0:3], a[208:211], v[92:95]
buffer_load_dwordx4 v12, s[72:75], s12 offen offset:2048 lds
v_mfma_f32_16x16x32_bf16 v[28:31], a[4:7], a[212:215], v[28:31]
ds_read_b128 a[56:59], v1 offset:22528
v_exp_f32 v46, v46
v_mfma_f32_16x16x32_bf16 v[28:31], a[8:11], a[216:219], v[28:31]
ds_read_b128 a[60:63], v1 offset:23552
v_xor_b32 v1, 0x8000, v1
v_mfma_f32_16x16x32_bf16 v[28:31], a[12:15], a[220:223], v[28:31]
s_waitcnt lgkmcnt(8)
v_exp_f32 v47, v47
v_cvt_pk_bf16_f32 v62, v44, v45
v_cvt_pk_bf16_f32 v63, v46, v47
v_mfma_f32_16x16x32_bf16 v[44:47], a[16:19], a[208:211], v[92:95]
buffer_load_dwordx4 v13, s[72:75], s12 offen offset:3072 lds
v_mfma_f32_16x16x32_bf16 v[44:47], a[20:23], a[212:215], v[44:47]
v_cvt_pk_bf16_f32 v59, v42, v43
v_mfma_f32_16x16x32_bf16 v[44:47], a[24:27], a[216:219], v[44:47]
v_mfma_f32_16x16x32_bf16 v[44:47], a[28:31], a[220:223], v[44:47]
v_accvgpr_read_b32 v6, a224
v_accvgpr_read_b32 v7, a225
v_add_f32 v6, v6, v7
v_cmp_nge_f32 vcc, 0x5f800000, v6
v_rcp_f32 v6, v6
s_or_b64 s[34:35], s[34:35], vcc
s_add_u32 s8, s28, 0x0
v_pk_mul_f32 v[128:129], v[128:129], v[6:7] op_sel_hi:[1,0]
v_pk_mul_f32 v[130:131], v[130:131], v[6:7] op_sel_hi:[1,0]
v_pk_mul_f32 v[132:133], v[132:133], v[6:7] op_sel_hi:[1,0]
v_pk_mul_f32 v[134:135], v[134:135], v[6:7] op_sel_hi:[1,0]
v_cvt_pk_bf16_f32 v128, v128, v129
v_cvt_pk_bf16_f32 v129, v130, v131
v_cvt_pk_bf16_f32 v130, v132, v133
v_cvt_pk_bf16_f32 v131, v134, v135
buffer_store_dwordx4 v[128:131], v3, s[88:91], s8 offen sc1
s_add_u32 s8, s28, 0x2000
v_pk_mul_f32 v[136:137], v[136:137], v[6:7] op_sel_hi:[1,0]
v_pk_mul_f32 v[138:139], v[138:139], v[6:7] op_sel_hi:[1,0]
v_pk_mul_f32 v[140:141], v[140:141], v[6:7] op_sel_hi:[1,0]
v_pk_mul_f32 v[142:143], v[142:143], v[6:7] op_sel_hi:[1,0]
v_cvt_pk_bf16_f32 v136, v136, v137
v_cvt_pk_bf16_f32 v137, v138, v139
v_cvt_pk_bf16_f32 v138, v140, v141
v_cvt_pk_bf16_f32 v139, v142, v143
buffer_store_dwordx4 v[136:139], v3, s[88:91], s8 offen sc1
s_add_u32 s8, s28, 0x4000
v_pk_mul_f32 v[144:145], v[144:145], v[6:7] op_sel_hi:[1,0]
v_pk_mul_f32 v[146:147], v[146:147], v[6:7] op_sel_hi:[1,0]
v_pk_mul_f32 v[148:149], v[148:149], v[6:7] op_sel_hi:[1,0]
v_pk_mul_f32 v[150:151], v[150:151], v[6:7] op_sel_hi:[1,0]
v_cvt_pk_bf16_f32 v144, v144, v145
v_cvt_pk_bf16_f32 v145, v146, v147
v_cvt_pk_bf16_f32 v146, v148, v149
v_cvt_pk_bf16_f32 v147, v150, v151
buffer_store_dwordx4 v[144:147], v3, s[88:91], s8 offen sc1
s_add_u32 s8, s28, 0x6000
v_pk_mul_f32 v[152:153], v[152:153], v[6:7] op_sel_hi:[1,0]
v_pk_mul_f32 v[154:155], v[154:155], v[6:7] op_sel_hi:[1,0]
v_pk_mul_f32 v[156:157], v[156:157], v[6:7] op_sel_hi:[1,0]
v_pk_mul_f32 v[158:159], v[158:159], v[6:7] op_sel_hi:[1,0]
v_cvt_pk_bf16_f32 v152, v152, v153
v_cvt_pk_bf16_f32 v153, v154, v155
v_cvt_pk_bf16_f32 v154, v156, v157
v_cvt_pk_bf16_f32 v155, v158, v159
buffer_store_dwordx4 v[152:155], v3, s[88:91], s8 offen sc1
v_accvgpr_read_b32 v6, a226
v_accvgpr_read_b32 v7, a227
v_add_f32 v6, v6, v7
v_cmp_nge_f32 vcc, 0x5f800000, v6
v_rcp_f32 v6, v6
s_or_b64 s[34:35], s[34:35], vcc
s_add_u32 s8, s29, 0x0
v_pk_mul_f32 v[160:161], v[160:161], v[6:7] op_sel_hi:[1,0]
v_pk_mul_f32 v[162:163], v[162:163], v[6:7] op_sel_hi:[1,0]
v_pk_mul_f32 v[164:165], v[164:165], v[6:7] op_sel_hi:[1,0]
v_pk_mul_f32 v[166:167], v[166:167], v[6:7] op_sel_hi:[1,0]
v_cvt_pk_bf16_f32 v160, v160, v161
v_cvt_pk_bf16_f32 v161, v162, v163
v_cvt_pk_bf16_f32 v162, v164, v165
v_cvt_pk_bf16_f32 v163, v166, v167
buffer_store_dwordx4 v[160:163], v3, s[88:91], s8 offen sc1
s_add_u32 s8, s29, 0x2000
v_pk_mul_f32 v[168:169], v[168:169], v[6:7] op_sel_hi:[1,0]
v_pk_mul_f32 v[170:171], v[170:171], v[6:7] op_sel_hi:[1,0]
v_pk_mul_f32 v[172:173], v[172:173], v[6:7] op_sel_hi:[1,0]
v_pk_mul_f32 v[174:175], v[174:175], v[6:7] op_sel_hi:[1,0]
v_cvt_pk_bf16_f32 v168, v168, v169
v_cvt_pk_bf16_f32 v169, v170, v171
v_cvt_pk_bf16_f32 v170, v172, v173
v_cvt_pk_bf16_f32 v171, v174, v175
buffer_store_dwordx4 v[168:171], v3, s[88:91], s8 offen sc1
s_add_u32 s8, s29, 0x4000
v_pk_mul_f32 v[176:177], v[176:177], v[6:7] op_sel_hi:[1,0]
v_pk_mul_f32 v[178:179], v[178:179], v[6:7] op_sel_hi:[1,0]
v_pk_mul_f32 v[180:181], v[180:181], v[6:7] op_sel_hi:[1,0]
v_pk_mul_f32 v[182:183], v[182:183], v[6:7] op_sel_hi:[1,0]
v_cvt_pk_bf16_f32 v176, v176, v177
v_cvt_pk_bf16_f32 v177, v178, v179
v_cvt_pk_bf16_f32 v178, v180, v181
v_cvt_pk_bf16_f32 v179, v182, v183
buffer_store_dwordx4 v[176:179], v3, s[88:91], s8 offen sc1
s_add_u32 s8, s29, 0x6000
v_pk_mul_f32 v[184:185], v[184:185], v[6:7] op_sel_hi:[1,0]
v_pk_mul_f32 v[186:187], v[186:187], v[6:7] op_sel_hi:[1,0]
v_pk_mul_f32 v[188:189], v[188:189], v[6:7] op_sel_hi:[1,0]
v_pk_mul_f32 v[190:191], v[190:191], v[6:7] op_sel_hi:[1,0]
v_cvt_pk_bf16_f32 v184, v184, v185
v_cvt_pk_bf16_f32 v185, v186, v187
v_cvt_pk_bf16_f32 v186, v188, v189
v_cvt_pk_bf16_f32 v187, v190, v191
buffer_store_dwordx4 v[184:187], v3, s[88:91], s8 offen sc1
s_branch L_att_h1_0
L_att_dl0_1:
v_mfma_f32_16x16x32_bf16 v[128:131], a[32:35], v[48:51], v[128:131]
ds_read_b128 a[0:3], v1 offset:8192
v_cvt_pk_bf16_f32 v72, v24, v25
v_mfma_f32_16x16x32_bf16 v[160:163], a[32:35], v[52:55], v[160:163]
v_exp_f32 v28, v28
v_mfma_f32_16x16x32_bf16 v[192:195], a[32:35], v[56:59], v[192:195]
v_cvt_pk_bf16_f32 v73, v26, v27
v_mfma_f32_16x16x32_bf16 v[224:227], a[32:35], v[60:63], v[224:227]
ds_read_b128 a[4:7], v1 offset:9216
v_mfma_f32_16x16x32_bf16 v[228:231], a[36:39], v[60:63], v[228:231]
s_add_u32 m0, s27, 0x0
v_exp_f32 v29, v29
v_mfma_f32_16x16x32_bf16 v[196:199], a[36:39], v[56:59], v[196:199]
buffer_load_dwordx4 v3, s[48:51], s32 offen offset:0 sc1 lds
v_mfma_f32_16x16x32_bf16 v[164:167], a[36:39], v[52:55], v[164:167]
v_exp_f32 v30, v30
v_mfma_f32_16x16x32_bf16 v[132:135], a[36:39], v[48:51], v[132:135]
ds_read_b128 a[8:11], v1 offset:10240
v_cvt_pk_bf16_f32 v76, v28, v29
v_mfma_f32_16x16x32_bf16 v[136:139], a[40:43], v[48:51], v[136:139]
v_mfma_f32_16x16x32_bf16 v[168:171], a[40:43], v[52:55], v[168:171]
v_exp_f32 v31, v31
v_mfma_f32_16x16x32_bf16 v[200:203], a[40:43], v[56:59], v[200:203]
v_exp_f32 v32, v32
v_mfma_f32_16x16x32_bf16 v[232:235], a[40:43], v[60:63], v[232:235]
ds_read_b128 a[12:15], v1 offset:11264
v_cvt_pk_bf16_f32 v77, v30, v31
v_mfma_f32_16x16x32_bf16 v[236:239], a[44:47], v[60:63], v[236:239]
v_exp_f32 v33, v33
v_mfma_f32_16x16x32_bf16 v[204:207], a[44:47], v[56:59], v[204:207]
v_cvt_pk_bf16_f32 v66, v32, v33
v_mfma_f32_16x16x32_bf16 v[172:175], a[44:47], v[52:55], v[172:175]
s_mov_b32 s9, 0x0
v_exp_f32 v34, v34
v_mfma_f32_16x16x32_bf16 v[140:143], a[44:47], v[48:51], v[140:143]
ds_read_b128 a[16:19], v1 offset:12288
v_mfma_f32_16x16x32_bf16 v[144:147], a[48:51], v[48:51], v[144:147]
buffer_load_dword a244, v8, s[72:75], s9 offen
v_mfma_f32_16x16x32_bf16 v[176:179], a[48:51], v[52:55], v[176:179]
v_exp_f32 v35, v35
v_mfma_f32_16x16x32_bf16 v[208:211], a[48:51], v[56:59], v[208:211]
v_exp_f32 v36, v36
v_mfma_f32_16x16x32_bf16 v[240:243], a[48:51], v[60:63], v[240:243]
ds_read_b128 a[20:23], v1 offset:13312
v_cvt_pk_bf16_f32 v67, v34, v35
v_mfma_f32_16x16x32_bf16 v[244:247], a[52:55], v[60:63], v[244:247]
v_mfma_f32_16x16x32_bf16 v[212:215], a[52:55], v[56:59], v[212:215]
v_exp_f32 v37, v37
v_mfma_f32_16x16x32_bf16 v[180:183], a[52:55], v[52:55], v[180:183]
ds_read_b128 a[24:27], v1 offset:14336
v_cvt_pk_bf16_f32 v70, v36, v37
v_mfma_f32_16x16x32_bf16 v[148:151], a[52:55], v[48:51], v[148:151]
v_exp_f32 v38, v38
v_mfma_f32_16x16x32_bf16 v[152:155], a[56:59], v[48:51], v[152:155]
v_mfma_f32_16x16x32_bf16 v[184:187], a[56:59], v[52:55], v[184:187]
v_exp_f32 v39, v39
v_mfma_f32_16x16x32_bf16 v[216:219], a[56:59], v[56:59], v[216:219]
buffer_load_dwordx4 v3, s[48:51], s32 offen offset:1024 sc1 lds
v_mfma_f32_16x16x32_bf16 v[248:251], a[56:59], v[60:63], v[248:251]
ds_read_b128 a[28:31], v1 offset:15360
v_cvt_pk_bf16_f32 v71, v38, v39
v_mfma_f32_16x16x32_bf16 v[252:255], a[60:63], v[60:63], v[252:255]
v_exp_f32 v40, v40
v_mfma_f32_16x16x32_bf16 v[220:223], a[60:63], v[56:59], v[220:223]
v_exp_f32 v41, v41
v_mfma_f32_16x16x32_bf16 v[188:191], a[60:63], v[52:55], v[188:191]
ds_read_b128 a[32:35], v1 offset:0
v_cvt_pk_bf16_f32 v74, v40, v41
v_mfma_f32_16x16x32_bf16 v[156:159], a[60:63], v[48:51], v[156:159]
v_smfmac_f32_16x16x64_bf16 a[224:227], a[232:235], v[48:55], v9
v_exp_f32 v42, v42
v_smfmac_f32_16x16x64_bf16 a[228:231], a[232:235], v[56:63], v9
s_waitcnt lgkmcnt(5)
v_exp_f32 v43, v43
v_mfma_f32_16x16x32_bf16 v[16:19], a[0:3], a[160:163], v[80:83]
ds_read_b128 a[36:39], v1 offset:1024
v_cvt_pk_bf16_f32 v75, v42, v43
v_mfma_f32_16x16x32_bf16 v[16:19], a[4:7], a[164:167], v[16:19]
v_exp_f32 v44, v44
v_mfma_f32_16x16x32_bf16 v[16:19], a[8:11], a[168:171], v[16:19]
v_mfma_f32_16x16x32_bf16 v[16:19], a[12:15], a[172:175], v[16:19]
buffer_load_dwordx4 v3, s[48:51], s32 offen offset:2048 sc1 lds
v_mfma_f32_16x16x32_bf16 v[20:23], a[0:3], a[176:179], v[84:87]
ds_read_b128 a[40:43], v1 offset:2048
v_mfma_f32_16x16x32_bf16 v[20:23], a[4:7], a[180:183], v[20:23]
v_exp_f32 v45, v45
v_mfma_f32_16x16x32_bf16 v[20:23], a[8:11], a[184:187], v[20:23]
v_exp_f32 v46, v46
v_mfma_f32_16x16x32_bf16 v[20:23], a[12:15], a[188:191], v[20:23]
ds_read_b128 a[44:47], v1 offset:3072
v_cvt_pk_bf16_f32 v78, v44, v45
v_mfma_f32_16x16x32_bf16 v[24:27], a[0:3], a[192:195], v[88:91]
v_mfma_f32_16x16x32_bf16 v[24:27], a[4:7], a[196:199], v[24:27]
v_exp_f32 v47, v47
v_mfma_f32_16x16x32_bf16 v[24:27], a[8:11], a[200:203], v[24:27]
v_exp_f32 v16, v16
v_mfma_f32_16x16x32_bf16 v[24:27], a[12:15], a[204:207], v[24:27]
ds_read_b128 a[48:51], v1 offset:4096
v_cvt_pk_bf16_f32 v79, v46, v47
v_mfma_f32_16x16x32_bf16 v[28:31], a[0:3], a[208:211], v[92:95]
v_exp_f32 v17, v17
v_mfma_f32_16x16x32_bf16 v[28:31], a[4:7], a[212:215], v[28:31]
s_waitcnt lgkmcnt(5)
v_cvt_pk_bf16_f32 v48, v16, v17
v_mfma_f32_16x16x32_bf16 v[28:31], a[8:11], a[216:219], v[28:31]
buffer_load_dwordx4 v3, s[48:51], s32 offen offset:3072 sc1 lds
v_mfma_f32_16x16x32_bf16 v[28:31], a[12:15], a[220:223], v[28:31]
ds_read_b128 a[52:55], v1 offset:5120
v_mfma_f32_16x16x32_bf16 v[32:35], a[16:19], a[160:163], v[80:83]
v_exp_f32 v18, v18
v_mfma_f32_16x16x32_bf16 v[32:35], a[20:23], a[164:167], v[32:35]
v_exp_f32 v19, v19
v_mfma_f32_16x16x32_bf16 v[32:35], a[24:27], a[168:171], v[32:35]
v_exp_f32 v20, v20
v_mfma_f32_16x16x32_bf16 v[32:35], a[28:31], a[172:175], v[32:35]
ds_read_b128 a[56:59], v1 offset:6144
v_cvt_pk_bf16_f32 v49, v18, v19
v_mfma_f32_16x16x32_bf16 v[36:39], a[16:19], a[176:179], v[84:87]
v_mfma_f32_16x16x32_bf16 v[36:39], a[20:23], a[180:183], v[36:39]
v_exp_f32 v21, v21
v_mfma_f32_16x16x32_bf16 v[36:39], a[24:27], a[184:187], v[36:39]
s_mov_b32 s9, 0x0
v_exp_f32 v22, v22
v_mfma_f32_16x16x32_bf16 v[36:39], a[28:31], a[188:191], v[36:39]
ds_read_b128 a[60:63], v1 offset:7168
v_cvt_pk_bf16_f32 v52, v20, v21
v_mfma_f32_16x16x32_bf16 v[40:43], a[16:19], a[192:195], v[88:91]
buffer_load_dword a244, v8, s[64:67], s9 offen
v_mfma_f32_16x16x32_bf16 v[40:43], a[20:23], a[196:199], v[40:43]
v_mfma_f32_16x16x32_bf16 v[40:43], a[24:27], a[200:203], v[40:43]
v_exp_f32 v23, v23
v_mfma_f32_16x16x32_bf16 v[40:43], a[28:31], a[204:207], v[40:43]
v_exp_f32 v24, v24
v_mfma_f32_16x16x32_bf16 v[44:47], a[16:19], a[208:211], v[92:95]
v_exp_f32 v25, v25
v_mfma_f32_16x16x32_bf16 v[44:47], a[20:23], a[212:215], v[44:47]
v_exp_f32 v26, v26
v_mfma_f32_16x16x32_bf16 v[44:47], a[24:27], a[216:219], v[44:47]
v_exp_f32 v27, v27
v_mfma_f32_16x16x32_bf16 v[44:47], a[28:31], a[220:223], v[44:47]
s_waitcnt lgkmcnt(0)
v_cvt_pk_bf16_f32 v53, v22, v23
v_mfma_f32_16x16x32_bf16 v[128:131], a[32:35], v[64:67], v[128:131]
ds_read_b128 a[0:3], v1 offset:24576
v_cvt_pk_bf16_f32 v56, v24, v25
v_mfma_f32_16x16x32_bf16 v[160:163], a[32:35], v[68:71], v[160:163]
v_exp_f32 v28, v28
v_mfma_f32_16x16x32_bf16 v[192:195], a[32:35], v[72:75], v[192:195]
v_cvt_pk_bf16_f32 v57, v26, v27
v_mfma_f32_16x16x32_bf16 v[224:227], a[32:35], v[76:79], v[224:227]
ds_read_b128 a[4:7], v1 offset:25600
v_mfma_f32_16x16x32_bf16 v[228:231], a[36:39], v[76:79], v[228:231]
v_exp_f32 v29, v29
v_mfma_f32_16x16x32_bf16 v[196:199], a[36:39], v[72:75], v[196:199]
s_add_u32 m0, s27, 0x1000
v_exp_f32 v30, v30
v_mfma_f32_16x16x32_bf16 v[164:167], a[36:39], v[68:71], v[164:167]
buffer_load_dwordx4 v3, s[48:51], s7 offen offset:0 sc1 lds
v_mfma_f32_16x16x32_bf16 v[132:135], a[36:39], v[64:67], v[132:135]
ds_read_b128 a[8:11], v1 offset:26624
v_cvt_pk_bf16_f32 v60, v28, v29
v_mfma_f32_16x16x32_bf16 v[136:139], a[40:43], v[64:67], v[136:139]
v_mfma_f32_16x16x32_bf16 v[168:171], a[40:43], v[68:71], v[168:171]
v_exp_f32 v31, v31
v_mfma_f32_16x16x32_bf16 v[200:203], a[40:43], v[72:75], v[200:203]
v_exp_f32 v32, v32
v_mfma_f32_16x16x32_bf16 v[232:235], a[40:43], v[76:79], v[232:235]
ds_read_b128 a[12:15], v1 offset:27648
v_cvt_pk_bf16_f32 v61, v30, v31
v_mfma_f32_16x16x32_bf16 v[236:239], a[44:47], v[76:79], v[236:239]
v_mfma_f32_16x16x32_bf16 v[204:207], a[44:47], v[72:75], v[204:207]
v_exp_f32 v33, v33
v_mfma_f32_16x16x32_bf16 v[172:175], a[44:47], v[68:71], v[172:175]
v_exp_f32 v34, v34
v_mfma_f32_16x16x32_bf16 v[140:143], a[44:47], v[64:67], v[140:143]
ds_read_b128 a[16:19], v1 offset:28672
v_cvt_pk_bf16_f32 v50, v32, v33
v_mfma_f32_16x16x32_bf16 v[144:147], a[48:51], v[64:67], v[144:147]
v_exp_f32 v35, v35
v_mfma_f32_16x16x32_bf16 v[176:179], a[48:51], v[68:71], v[176:179]
v_cvt_pk_bf16_f32 v51, v34, v35
v_mfma_f32_16x16x32_bf16 v[208:211], a[48:51], v[72:75], v[208:211]
buffer_load_dwordx4 v3, s[48:51], s7 offen offset:1024 sc1 lds
v_mfma_f32_16x16x32_bf16 v[240:243], a[48:51], v[76:79], v[240:243]
ds_read_b128 a[20:23], v1 offset:29696
v_mfma_f32_16x16x32_bf16 v[244:247], a[52:55], v[76:79], v[244:247]
v_exp_f32 v36, v36
v_mfma_f32_16x16x32_bf16 v[212:215], a[52:55], v[72:75], v[212:215]
v_exp_f32 v37, v37
v_mfma_f32_16x16x32_bf16 v[180:183], a[52:55], v[68:71], v[180:183]
ds_read_b128 a[24:27], v1 offset:30720
v_cvt_pk_bf16_f32 v54, v36, v37
v_mfma_f32_16x16x32_bf16 v[148:151], a[52:55], v[64:67], v[148:151]
v_mfma_f32_16x16x32_bf16 v[152:155], a[56:59], v[64:67], v[152:155]
v_exp_f32 v38, v38
v_mfma_f32_16x16x32_bf16 v[184:187], a[56:59], v[68:71], v[184:187]
v_exp_f32 v39, v39
v_mfma_f32_16x16x32_bf16 v[216:219], a[56:59], v[72:75], v[216:219]
ds_read_b128 a[28:31], v1 offset:31744
v_cvt_pk_bf16_f32 v55, v38, v39
v_mfma_f32_16x16x32_bf16 v[248:251], a[56:59], v[76:79], v[248:251]
v_exp_f32 v40, v40
v_mfma_f32_16x16x32_bf16 v[252:255], a[60:63], v[76:79], v[252:255]
v_mfma_f32_16x16x32_bf16 v[220:223], a[60:63], v[72:75], v[220:223]
v_exp_f32 v41, v41
v_mfma_f32_16x16x32_bf16 v[188:191], a[60:63], v[68:71], v[188:191]
buffer_load_dwordx4 v3, s[48:51], s7 offen offset:2048 sc1 lds
v_mfma_f32_16x16x32_bf16 v[156:159], a[60:63], v[64:67], v[156:159]
ds_read_b128 a[32:35], v1 offset:16384
v_cvt_pk_bf16_f32 v58, v40, v41
v_smfmac_f32_16x16x64_bf16 a[224:227], a[232:235], v[64:71], v9
s_waitcnt lgkmcnt(5)
v_exp_f32 v42, v42
v_smfmac_f32_16x16x64_bf16 a[228:231], a[232:235], v[72:79], v9
ds_read_b128 a[36:39], v1 offset:17408
v_mfma_f32_16x16x32_bf16 v[16:19], a[0:3], a[160:163], v[96:99]
v_mfma_f32_16x16x32_bf16 v[16:19], a[4:7], a[164:167], v[16:19]
v_exp_f32 v43, v43
v_mfma_f32_16x16x32_bf16 v[16:19], a[8:11], a[168:171], v[16:19]
v_exp_f32 v44, v44
v_mfma_f32_16x16x32_bf16 v[16:19], a[12:15], a[172:175], v[16:19]
ds_read_b128 a[40:43], v1 offset:18432
v_cvt_pk_bf16_f32 v59, v42, v43
v_mfma_f32_16x16x32_bf16 v[20:23], a[0:3], a[176:179], v[84:87]
v_exp_f32 v45, v45
v_mfma_f32_16x16x32_bf16 v[20:23], a[4:7], a[180:183], v[20:23]
v_cvt_pk_bf16_f32 v62, v44, v45
v_mfma_f32_16x16x32_bf16 v[20:23], a[8:11], a[184:187], v[20:23]
s_mov_b32 s9, 0x400000
v_exp_f32 v46, v46
v_mfma_f32_16x16x32_bf16 v[20:23], a[12:15], a[188:191], v[20:23]
ds_read_b128 a[44:47], v1 offset:19456
v_mfma_f32_16x16x32_bf16 v[24:27], a[0:3], a[192:195], v[88:91]
buffer_load_dword a244, v8, s[64:67], s9 offen
v_mfma_f32_16x16x32_bf16 v[24:27], a[4:7], a[196:199], v[24:27]
v_exp_f32 v47, v47
v_mfma_f32_16x16x32_bf16 v[24:27], a[8:11], a[200:203], v[24:27]
v_cvt_pk_bf16_f32 v63, v46, v47
v_mfma_f32_16x16x32_bf16 v[24:27], a[12:15], a[204:207], v[24:27]
ds_read_b128 a[48:51], v1 offset:20480
v_mfma_f32_16x16x32_bf16 v[28:31], a[0:3], a[208:211], v[92:95]
v_exp_f32 v16, v16
v_mfma_f32_16x16x32_bf16 v[28:31], a[4:7], a[212:215], v[28:31]
v_exp_f32 v17, v17
v_mfma_f32_16x16x32_bf16 v[28:31], a[8:11], a[216:219], v[28:31]
ds_read_b128 a[52:55], v1 offset:21504
v_cvt_pk_bf16_f32 v64, v16, v17
v_mfma_f32_16x16x32_bf16 v[28:31], a[12:15], a[220:223], v[28:31]
s_waitcnt lgkmcnt(6)
v_exp_f32 v18, v18
v_mfma_f32_16x16x32_bf16 v[32:35], a[16:19], a[160:163], v[100:103]
v_mfma_f32_16x16x32_bf16 v[32:35], a[20:23], a[164:167], v[32:35]
v_exp_f32 v19, v19
v_mfma_f32_16x16x32_bf16 v[32:35], a[24:27], a[168:171], v[32:35]
ds_read_b128 a[56:59], v1 offset:22528
v_cvt_pk_bf16_f32 v65, v18, v19
v_mfma_f32_16x16x32_bf16 v[32:35], a[28:31], a[172:175], v[32:35]
v_exp_f32 v20, v20
v_mfma_f32_16x16x32_bf16 v[36:39], a[16:19], a[176:179], v[84:87]
buffer_load_dwordx4 v3, s[48:51], s7 offen offset:3072 sc1 lds
v_mfma_f32_16x16x32_bf16 v[36:39], a[20:23], a[180:183], v[36:39]
s_add_u32 s32, s32, 0x8000
v_mfma_f32_16x16x32_bf16 v[36:39], a[24:27], a[184:187], v[36:39]
ds_read_b128 a[60:63], v1 offset:23552
v_xor_b32 v1, 0x8000, v1
v_mfma_f32_16x16x32_bf16 v[36:39], a[28:31], a[188:191], v[36:39]
s_add_u32 s7, s7, 0x8000
v_exp_f32 v21, v21
v_mfma_f32_16x16x32_bf16 v[40:43], a[16:19], a[192:195], v[88:91]
s_xor_b32 s27, s27, 0x38000
v_exp_f32 v22, v22
v_mfma_f32_16x16x32_bf16 v[40:43], a[20:23], a[196:199], v[40:43]
v_exp_f32 v23, v23
v_mfma_f32_16x16x32_bf16 v[40:43], a[24:27], a[200:203], v[40:43]
v_cvt_pk_bf16_f32 v68, v20, v21
v_cvt_pk_bf16_f32 v69, v22, v23
v_mfma_f32_16x16x32_bf16 v[40:43], a[28:31], a[204:207], v[40:43]
v_exp_f32 v24, v24
v_mfma_f32_16x16x32_bf16 v[44:47], a[16:19], a[208:211], v[92:95]
v_exp_f32 v25, v25
v_mfma_f32_16x16x32_bf16 v[44:47], a[20:23], a[212:215], v[44:47]
v_exp_f32 v26, v26
v_mfma_f32_16x16x32_bf16 v[44:47], a[24:27], a[216:219], v[44:47]
s_waitcnt vmcnt(19) lgkmcnt(0)
v_exp_f32 v27, v27
v_mfma_f32_16x16x32_bf16 v[44:47], a[28:31], a[220:223], v[44:47]
s_barrier
L_att_l1_1:
v_mfma_f32_16x16x32_bf16 v[128:131], a[32:35], v[48:51], v[128:131]
ds_read_b128 a[0:3], v2 offset:8192
v_cvt_pk_bf16_f32 v72, v24, v25
v_mfma_f32_16x16x32_bf16 v[160:163], a[32:35], v[52:55], v[160:163]
s_lshr_b32 s44, s2, 6
v_exp_f32 v28, v28
v_mfma_f32_16x16x32_bf16 v[192:195], a[32:35], v[56:59], v[192:195]
s_add_u32 m0, s19, 0x0
s_lshl_b32 s45, s44, 1
v_cvt_pk_bf16_f32 v73, v26, v27
v_mfma_f32_16x16x32_bf16 v[224:227], a[32:35], v[60:63], v[224:227]
ds_read_b128 a[4:7], v2 offset:9216
s_add_u32 s45, s45, s100
v_mfma_f32_16x16x32_bf16 v[228:231], a[36:39], v[60:63], v[228:231]
buffer_load_dwordx4 v3, s[48:51], s32 offen offset:0 sc1 lds
v_mfma_f32_16x16x32_bf16 v[196:199], a[36:39], v[56:59], v[196:199]
s_and_b32 s60, s45, 3
v_exp_f32 v29, v29
v_mfma_f32_16x16x32_bf16 v[164:167], a[36:39], v[52:55], v[164:167]
ds_read_b128 a[8:11], v2 offset:10240
v_cvt_pk_bf16_f32 v76, v28, v29
v_mfma_f32_16x16x32_bf16 v[132:135], a[36:39], v[48:51], v[132:135]
s_sub_u32 s60, s60, s44
v_exp_f32 v30, v30
v_mfma_f32_16x16x32_bf16 v[136:139], a[40:43], v[48:51], v[136:139]
s_add_u32 s60, s60, 4
v_exp_f32 v31, v31
v_mfma_f32_16x16x32_bf16 v[168:171], a[40:43], v[52:55], v[168:171]
ds_read_b128 a[12:15], v2 offset:11264
v_cvt_pk_bf16_f32 v77, v30, v31
v_mfma_f32_16x16x32_bf16 v[200:203], a[40:43], v[56:59], v[200:203]
s_lshl_b32 s60, s60, 14
s_and_b32 s60, s60, 0x7c000
s_lshl_b32 s61, s60, 3
v_mfma_f32_16x16x32_bf16 v[232:235], a[40:43], v[60:63], v[232:235]
s_add_u32 s62, s61, s12
v_exp_f32 v32, v32
v_mfma_f32_16x16x32_bf16 v[236:239], a[44:47], v[60:63], v[236:239]
s_mov_b32 s9, 0x200000
v_exp_f32 v33, v33
v_mfma_f32_16x16x32_bf16 v[204:207], a[44:47], v[56:59], v[204:207]
ds_read_b128 a[16:19], v2 offset:12288
v_cvt_pk_bf16_f32 v66, v32, v33
v_mfma_f32_16x16x32_bf16 v[172:175], a[44:47], v[52:55], v[172:175]
buffer_load_dword a244, v8, s[64:67], s9 offen
v_mfma_f32_16x16x32_bf16 v[140:143], a[44:47], v[48:51], v[140:143]
s_mul_i32 s44, s44, -8
v_exp_f32 v34, v34
v_mfma_f32_16x16x32_bf16 v[144:147], a[48:51], v[48:51], v[144:147]
ds_read_b128 a[20:23], v2 offset:13312
s_lshl_b32 s44, 4, s44
v_mfma_f32_16x16x32_bf16 v[176:179], a[48:51], v[52:55], v[176:179]
s_mul_i32 s45, s45, -8
v_exp_f32 v35, v35
v_mfma_f32_16x16x32_bf16 v[208:211], a[48:51], v[56:59], v[208:211]
s_lshl_b32 s45, 4, s45
s_add_u32 s44, s44, 0x21212121
v_cvt_pk_bf16_f32 v67, v34, v35
v_mfma_f32_16x16x32_bf16 v[240:243], a[48:51], v[60:63], v[240:243]
ds_read_b128 a[24:27], v2 offset:14336
s_sub_u32 s44, s44, s45
v_mfma_f32_16x16x32_bf16 v[244:247], a[52:55], v[60:63], v[244:247]
s_bfe_u32 s56, s44, 0x80000
v_exp_f32 v36, v36
v_mfma_f32_16x16x32_bf16 v[212:215], a[52:55], v[56:59], v[212:215]
s_lshl_b32 s56, s56, 14
v_exp_f32 v37, v37
v_mfma_f32_16x16x32_bf16 v[180:183], a[52:55], v[52:55], v[180:183]
s_bfe_u32 s57, s44, 0x80008
v_exp_f32 v38, v38
v_mfma_f32_16x16x32_bf16 v[148:151], a[52:55], v[48:51], v[148:151]
buffer_load_dwordx4 v3, s[48:51], s32 offen offset:1024 sc1 lds
v_mfma_f32_16x16x32_bf16 v[152:155], a[56:59], v[48:51], v[152:155]
ds_read_b128 a[28:31], v2 offset:15360
v_cvt_pk_bf16_f32 v70, v36, v37
v_mfma_f32_16x16x32_bf16 v[184:187], a[56:59], v[52:55], v[184:187]
s_lshl_b32 s57, s57, 14
s_bfe_u32 s58, s44, 0x80010
s_lshl_b32 s58, s58, 14
v_mfma_f32_16x16x32_bf16 v[216:219], a[56:59], v[56:59], v[216:219]
ds_read_b128 a[32:35], v2 offset:0
s_bfe_u32 s59, s44, 0x80018
v_mfma_f32_16x16x32_bf16 v[248:251], a[56:59], v[60:63], v[248:251]
s_lshl_b32 s59, s59, 14
v_exp_f32 v39, v39
v_mfma_f32_16x16x32_bf16 v[252:255], a[60:63], v[60:63], v[252:255]
v_exp_f32 v40, v40
v_mfma_f32_16x16x32_bf16 v[220:223], a[60:63], v[56:59], v[220:223]
ds_read_b128 a[36:39], v2 offset:1024
v_cvt_pk_bf16_f32 v71, v38, v39
v_mfma_f32_16x16x32_bf16 v[188:191], a[60:63], v[52:55], v[188:191]
v_exp_f32 v41, v41
v_mfma_f32_16x16x32_bf16 v[156:159], a[60:63], v[48:51], v[156:159]
s_waitcnt lgkmcnt(6)
v_exp_f32 v42, v42
v_smfmac_f32_16x16x64_bf16 a[224:227], a[232:235], v[48:55], v9
buffer_load_dwordx4 v3, s[48:51], s32 offen offset:2048 sc1 lds
v_smfmac_f32_16x16x64_bf16 a[228:231], a[232:235], v[56:63], v9
ds_read_b128 a[40:43], v2 offset:2048
v_cvt_pk_bf16_f32 v74, v40, v41
v_mfma_f32_16x16x32_bf16 v[20:23], a[0:3], a[176:179], v[104:107]
v_mfma_f32_16x16x32_bf16 v[20:23], a[4:7], a[180:183], v[20:23]
v_exp_f32 v43, v43
v_mfma_f32_16x16x32_bf16 v[20:23], a[8:11], a[184:187], v[20:23]
ds_read_b128 a[44:47], v2 offset:3072
v_cvt_pk_bf16_f32 v75, v42, v43
v_mfma_f32_16x16x32_bf16 v[20:23], a[12:15], a[188:191], v[20:23]
v_exp_f32 v44, v44
v_mfma_f32_16x16x32_bf16 v[24:27], a[0:3], a[192:195], v[88:91]
v_exp_f32 v45, v45
v_mfma_f32_16x16x32_bf16 v[24:27], a[4:7], a[196:199], v[24:27]
ds_read_b128 a[48:51], v2 offset:4096
v_cvt_pk_bf16_f32 v78, v44, v45
v_mfma_f32_16x16x32_bf16 v[24:27], a[8:11], a[200:203], v[24:27]
v_mfma_f32_16x16x32_bf16 v[24:27], a[12:15], a[204:207], v[24:27]
v_exp_f32 v46, v46
v_mfma_f32_16x16x32_bf16 v[28:31], a[0:3], a[208:211], v[92:95]
buffer_load_dwordx4 v3, s[48:51], s32 offen offset:3072 sc1 lds
v_mfma_f32_16x16x32_bf16 v[28:31], a[4:7], a[212:215], v[28:31]
ds_read_b128 a[52:55], v2 offset:5120
v_mfma_f32_16x16x32_bf16 v[28:31], a[8:11], a[216:219], v[28:31]
v_exp_f32 v47, v47
v_mfma_f32_16x16x32_bf16 v[28:31], a[12:15], a[220:223], v[28:31]
s_waitcnt lgkmcnt(6)
v_exp_f32 v20, v20
v_mfma_f32_16x16x32_bf16 v[36:39], a[16:19], a[176:179], v[108:111]
ds_read_b128 a[56:59], v2 offset:6144
v_cvt_pk_bf16_f32 v79, v46, v47
v_mfma_f32_16x16x32_bf16 v[36:39], a[20:23], a[180:183], v[36:39]
v_exp_f32 v21, v21
v_mfma_f32_16x16x32_bf16 v[36:39], a[24:27], a[184:187], v[36:39]
v_cvt_pk_bf16_f32 v52, v20, v21
v_mfma_f32_16x16x32_bf16 v[36:39], a[28:31], a[188:191], v[36:39]
ds_read_b128 a[60:63], v2 offset:7168
v_mfma_f32_16x16x32_bf16 v[40:43], a[16:19], a[192:195], v[88:91]
s_mov_b32 s9, 0x600000
v_exp_f32 v22, v22
v_mfma_f32_16x16x32_bf16 v[40:43], a[20:23], a[196:199], v[40:43]
buffer_load_dword a244, v8, s[64:67], s9 offen
v_mfma_f32_16x16x32_bf16 v[40:43], a[24:27], a[200:203], v[40:43]
v_exp_f32 v23, v23
v_mfma_f32_16x16x32_bf16 v[40:43], a[28:31], a[204:207], v[40:43]
v_exp_f32 v24, v24
v_mfma_f32_16x16x32_bf16 v[44:47], a[16:19], a[208:211], v[92:95]
v_exp_f32 v25, v25
v_mfma_f32_16x16x32_bf16 v[44:47], a[20:23], a[212:215], v[44:47]
v_exp_f32 v26, v26
v_mfma_f32_16x16x32_bf16 v[44:47], a[24:27], a[216:219], v[44:47]
v_exp_f32 v27, v27
v_mfma_f32_16x16x32_bf16 v[44:47], a[28:31], a[220:223], v[44:47]
s_waitcnt lgkmcnt(0)
v_cvt_pk_bf16_f32 v53, v22, v23
v_mfma_f32_16x16x32_bf16 v[128:131], a[32:35], v[64:67], v[128:131]
ds_read_b128 a[0:3], v2 offset:24576
v_cvt_pk_bf16_f32 v56, v24, v25
v_mfma_f32_16x16x32_bf16 v[160:163], a[32:35], v[68:71], v[160:163]
v_exp_f32 v28, v28
v_mfma_f32_16x16x32_bf16 v[192:195], a[32:35], v[72:75], v[192:195]
ds_read_b128 a[4:7], v2 offset:25600
v_cvt_pk_bf16_f32 v57, v26, v27
v_mfma_f32_16x16x32_bf16 v[224:227], a[32:35], v[76:79], v[224:227]
s_add_u32 m0, s19, 0x1000
v_mfma_f32_16x16x32_bf16 v[228:231], a[36:39], v[76:79], v[228:231]
buffer_load_dwordx4 v3, s[48:51], s7 offen offset:0 sc1 lds
v_mfma_f32_16x16x32_bf16 v[196:199], a[36:39], v[72:75], v[196:199]
ds_read_b128 a[8:11], v2 offset:26624
v_mfma_f32_16x16x32_bf16 v[164:167], a[36:39], v[68:71], v[164:167]
v_exp_f32 v29, v29
v_mfma_f32_16x16x32_bf16 v[132:135], a[36:39], v[64:67], v[132:135]
v_exp_f32 v30, v30
v_mfma_f32_16x16x32_bf16 v[136:139], a[40:43], v[64:67], v[136:139]
ds_read_b128 a[12:15], v2 offset:27648
v_cvt_pk_bf16_f32 v60, v28, v29
v_mfma_f32_16x16x32_bf16 v[168:171], a[40:43], v[68:71], v[168:171]
v_exp_f32 v31, v31
v_mfma_f32_16x16x32_bf16 v[200:203], a[40:43], v[72:75], v[200:203]
v_exp_f32 v36, v36
v_mfma_f32_16x16x32_bf16 v[232:235], a[40:43], v[76:79], v[232:235]
ds_read_b128 a[16:19], v2 offset:28672
v_cvt_pk_bf16_f32 v61, v30, v31
v_mfma_f32_16x16x32_bf16 v[236:239], a[44:47], v[76:79], v[236:239]
buffer_load_dwordx4 v3, s[48:51], s7 offen offset:1024 sc1 lds
v_mfma_f32_16x16x32_bf16 v[204:207], a[44:47], v[72:75], v[204:207]
ds_read_b128 a[20:23], v2 offset:29696
v_mfma_f32_16x16x32_bf16 v[172:175], a[44:47], v[68:71], v[172:175]
v_mfma_f32_16x16x32_bf16 v[140:143], a[44:47], v[64:67], v[140:143]
v_exp_f32 v37, v37
v_mfma_f32_16x16x32_bf16 v[144:147], a[48:51], v[64:67], v[144:147]
ds_read_b128 a[24:27], v2 offset:30720
v_cvt_pk_bf16_f32 v54, v36, v37
v_mfma_f32_16x16x32_bf16 v[176:179], a[48:51], v[68:71], v[176:179]
v_exp_f32 v38, v38
v_mfma_f32_16x16x32_bf16 v[208:211], a[48:51], v[72:75], v[208:211]
v_exp_f32 v39, v39
v_mfma_f32_16x16x32_bf16 v[240:243], a[48:51], v[76:79], v[240:243]
ds_read_b128 a[28:31], v2 offset:31744
v_cvt_pk_bf16_f32 v55, v38, v39
v_mfma_f32_16x16x32_bf16 v[244:247], a[52:55], v[76:79], v[244:247]
v_exp_f32 v40, v40
v_mfma_f32_16x16x32_bf16 v[212:215], a[52:55], v[72:75], v[212:215]
buffer_load_dwordx4 v3, s[48:51], s7 offen offset:2048 sc1 lds
v_mfma_f32_16x16x32_bf16 v[180:183], a[52:55], v[68:71], v[180:183]
ds_read_b128 a[32:35], v2 offset:16384
v_mfma_f32_16x16x32_bf16 v[148:151], a[52:55], v[64:67], v[148:151]
v_mfma_f32_16x16x32_bf16 v[152:155], a[56:59], v[64:67], v[152:155]
ds_read_b128 a[36:39], v2 offset:17408
v_mfma_f32_16x16x32_bf16 v[184:187], a[56:59], v[68:71], v[184:187]
v_exp_f32 v41, v41
v_mfma_f32_16x16x32_bf16 v[216:219], a[56:59], v[72:75], v[216:219]
v_exp_f32 v42, v42
v_mfma_f32_16x16x32_bf16 v[248:251], a[56:59], v[76:79], v[248:251]
ds_read_b128 a[40:43], v2 offset:18432
v_cvt_pk_bf16_f32 v58, v40, v41
v_mfma_f32_16x16x32_bf16 v[252:255], a[60:63], v[76:79], v[252:255]
v_exp_f32 v43, v43
v_mfma_f32_16x16x32_bf16 v[220:223], a[60:63], v[72:75], v[220:223]
buffer_load_dwordx4 v3, s[48:51], s7 offen offset:3072 sc1 lds
v_mfma_f32_16x16x32_bf16 v[188:191], a[60:63], v[68:71], v[188:191]
ds_read_b128 a[44:47], v2 offset:19456
v_cvt_pk_bf16_f32 v59, v42, v43
v_mfma_f32_16x16x32_bf16 v[156:159], a[60:63], v[64:67], v[156:159]
v_exp_f32 v44, v44
v_smfmac_f32_16x16x64_bf16 a[224:227], a[232:235], v[64:71], v9
s_waitcnt lgkmcnt(8)
v_exp_f32 v45, v45
v_smfmac_f32_16x16x64_bf16 a[228:231], a[232:235], v[72:79], v9
ds_read_b128 a[48:51], v2 offset:20480
v_add_u32 v4, s0, v3
v_mfma_f32_16x16x32_bf16 v[24:27], a[0:3], a[192:195], v[88:91]
v_cvt_pk_bf16_f32 v62, v44, v45
v_mfma_f32_16x16x32_bf16 v[24:27], a[4:7], a[196:199], v[24:27]
ds_read_b128 a[52:55], v2 offset:21504
v_mov_b32 v5, s1
v_mfma_f32_16x16x32_bf16 v[24:27], a[8:11], a[200:203], v[24:27]
v_exp_f32 v46, v46
v_mfma_f32_16x16x32_bf16 v[24:27], a[12:15], a[204:207], v[24:27]
global_load_dword a244, v[4:5], off sc1
v_mfma_f32_16x16x32_bf16 v[28:31], a[0:3], a[208:211], v[92:95]
ds_read_b128 a[56:59], v2 offset:22528
v_mfma_f32_16x16x32_bf16 v[28:31], a[4:7], a[212:215], v[28:31]
s_add_u32 s32, s32, 0x8000
v_exp_f32 v47, v47
v_mfma_f32_16x16x32_bf16 v[28:31], a[8:11], a[216:219], v[28:31]
s_waitcnt lgkmcnt(7)
v_cvt_pk_bf16_f32 v63, v46, v47
v_mfma_f32_16x16x32_bf16 v[28:31], a[12:15], a[220:223], v[28:31]
ds_read_b128 a[60:63], v2 offset:23552
s_add_u32 s7, s7, 0x8000
v_mfma_f32_16x16x32_bf16 v[40:43], a[16:19], a[192:195], v[88:91]
s_xor_b32 s19, s19, 0x8000
v_xor_b32 v2, 0x38000, v2
v_mfma_f32_16x16x32_bf16 v[40:43], a[20:23], a[196:199], v[40:43]
s_sub_u32 s15, 7, s6
v_exp_f32 v24, v24
v_mfma_f32_16x16x32_bf16 v[40:43], a[24:27], a[200:203], v[40:43]
s_lshl_b32 s15, s15, 1
v_exp_f32 v25, v25
v_mfma_f32_16x16x32_bf16 v[40:43], a[28:31], a[204:207], v[40:43]
v_exp_f32 v26, v26
v_mfma_f32_16x16x32_bf16 v[44:47], a[16:19], a[208:211], v[92:95]
v_exp_f32 v27, v27
v_mfma_f32_16x16x32_bf16 v[44:47], a[20:23], a[212:215], v[44:47]
v_exp_f32 v28, v28
v_mfma_f32_16x16x32_bf16 v[44:47], a[24:27], a[216:219], v[44:47]
s_waitcnt vmcnt(22) lgkmcnt(0)
v_exp_f32 v29, v29
v_mfma_f32_16x16x32_bf16 v[44:47], a[28:31], a[220:223], v[44:47]
s_barrier
s_cbranch_scc0 L_att_lh0_1
v_mfma_f32_16x16x32_bf16 v[160:163], a[32:35], v[52:55], v[160:163]
ds_read_b128 a[0:3], v1 offset:8192
v_cvt_pk_bf16_f32 v72, v24, v25
v_mfma_f32_16x16x32_bf16 v[192:195], a[32:35], v[56:59], v[192:195]
v_exp_f32 v30, v30
v_mfma_f32_16x16x32_bf16 v[224:227], a[32:35], v[60:63], v[224:227]
ds_read_b128 a[4:7], v1 offset:9216
v_cvt_pk_bf16_f32 v73, v26, v27
v_mfma_f32_16x16x32_bf16 v[228:231], a[36:39], v[60:63], v[228:231]
s_add_u32 m0, s27, 0x0
v_cvt_pk_bf16_f32 v76, v28, v29
v_accvgpr_read_b32 v6, a224
v_mfma_f32_16x16x32_bf16 v[196:199], a[36:39], v[56:59], v[196:199]
buffer_load_dwordx4 v3, s[48:51], s32 offen offset:0 sc1 lds
v_mfma_f32_16x16x32_bf16 v[164:167], a[36:39], v[52:55], v[164:167]
ds_read_b128 a[8:11], v1 offset:10240
v_accvgpr_read_b32 v7, a225
v_mfma_f32_16x16x32_bf16 v[168:171], a[40:43], v[52:55], v[168:171]
ds_read_b128 a[12:15], v1 offset:11264
v_add_f32 v6, v6, v7
v_mfma_f32_16x16x32_bf16 v[200:203], a[40:43], v[56:59], v[200:203]
v_exp_f32 v31, v31
v_mfma_f32_16x16x32_bf16 v[232:235], a[40:43], v[60:63], v[232:235]
v_exp_f32 v40, v40
v_mfma_f32_16x16x32_bf16 v[236:239], a[44:47], v[60:63], v[236:239]
ds_read_b128 a[16:19], v1 offset:12288
v_cvt_pk_bf16_f32 v77, v30, v31
v_mfma_f32_16x16x32_bf16 v[204:207], a[44:47], v[56:59], v[204:207]
v_cmp_nge_f32 vcc, 0x5f800000, v6
v_mfma_f32_16x16x32_bf16 v[172:175], a[44:47], v[52:55], v[172:175]
ds_read_b128 a[20:23], v1 offset:13312
v_mfma_f32_16x16x32_bf16 v[176:179], a[48:51], v[52:55], v[176:179]
v_exp_f32 v41, v41
v_mfma_f32_16x16x32_bf16 v[208:211], a[48:51], v[56:59], v[208:211]
ds_read_b128 a[24:27], v1 offset:14336
v_cvt_pk_bf16_f32 v74, v40, v41
v_mfma_f32_16x16x32_bf16 v[240:243], a[48:51], v[60:63], v[240:243]
buffer_load_dwordx4 v3, s[48:51], s32 offen offset:1024 sc1 lds
v_mfma_f32_16x16x32_bf16 v[244:247], a[52:55], v[60:63], v[244:247]
v_exp_f32 v42, v42
v_mfma_f32_16x16x32_bf16 v[212:215], a[52:55], v[56:59], v[212:215]
ds_read_b128 a[28:31], v1 offset:15360
v_mfma_f32_16x16x32_bf16 v[180:183], a[52:55], v[52:55], v[180:183]
v_exp_f32 v43, v43
v_mfma_f32_16x16x32_bf16 v[184:187], a[56:59], v[52:55], v[184:187]
ds_read_b128 a[32:35], v1 offset:0
v_cvt_pk_bf16_f32 v75, v42, v43
v_mfma_f32_16x16x32_bf16 v[216:219], a[56:59], v[56:59], v[216:219]
v_rcp_f32 v6, v6
v_mfma_f32_16x16x32_bf16 v[248:251], a[56:59], v[60:63], v[248:251]
ds_read_b128 a[36:39], v1 offset:1024
s_or_b64 s[34:35], s[34:35], vcc
v_mfma_f32_16x16x32_bf16 v[252:255], a[60:63], v[60:63], v[252:255]
s_add_u32 s8, s28, 0x0
v_exp_f32 v44, v44
v_mfma_f32_16x16x32_bf16 v[220:223], a[60:63], v[56:59], v[220:223]
v_exp_f32 v45, v45
v_mfma_f32_16x16x32_bf16 v[188:191], a[60:63], v[52:55], v[188:191]
ds_read_b128 a[40:43], v1 offset:2048
v_cvt_pk_bf16_f32 v78, v44, v45
v_mfma_f32_16x16x32_bf16 a[224:227], a[236:239], v[52:55], a[224:227]
buffer_load_dwordx4 v3, s[48:51], s32 offen offset:2048 sc1 lds
v_smfmac_f32_16x16x64_bf16 a[228:231], a[232:235], v[56:63], v9
ds_read_b128 a[44:47], v1 offset:3072
s_waitcnt lgkmcnt(8)
v_mfma_f32_16x16x32_bf16 v[24:27], a[0:3], a[192:195], v[88:91]
v_exp_f32 v46, v46
v_mfma_f32_16x16x32_bf16 v[24:27], a[4:7], a[196:199], v[24:27]
ds_read_b128 a[48:51], v1 offset:4096
v_mul_f32 v128, v6, v128
v_mfma_f32_16x16x32_bf16 v[24:27], a[8:11], a[200:203], v[24:27]
v_mul_f32 v129, v6, v129
v_mul_f32 v130, v6, v130
v_mfma_f32_16x16x32_bf16 v[24:27], a[12:15], a[204:207], v[24:27]
v_exp_f32 v47, v47
v_mfma_f32_16x16x32_bf16 v[28:31], a[0:3], a[208:211], v[92:95]
ds_read_b128 a[52:55], v1 offset:5120
v_cvt_pk_bf16_f32 v79, v46, v47
v_mfma_f32_16x16x32_bf16 v[28:31], a[4:7], a[212:215], v[28:31]
v_mul_f32 v131, v6, v131
v_mul_f32 v132, v6, v132
v_mfma_f32_16x16x32_bf16 v[28:31], a[8:11], a[216:219], v[28:31]
ds_read_b128 a[56:59], v1 offset:6144
v_mul_f32 v133, v6, v133
v_mfma_f32_16x16x32_bf16 v[28:31], a[12:15], a[220:223], v[28:31]
s_waitcnt lgkmcnt(7)
v_exp_f32 v24, v24
v_mfma_f32_16x16x32_bf16 v[40:43], a[16:19], a[192:195], v[88:91]
buffer_load_dwordx4 v3, s[48:51], s32 offen offset:3072 sc1 lds
v_mfma_f32_16x16x32_bf16 v[40:43], a[20:23], a[196:199], v[40:43]
ds_read_b128 a[60:63], v1 offset:7168
v_mul_f32 v134, v6, v134
v_mfma_f32_16x16x32_bf16 v[40:43], a[24:27], a[200:203], v[40:43]
s_add_u32 s32, s32, 0x8000
v_exp_f32 v25, v25
v_mfma_f32_16x16x32_bf16 v[40:43], a[28:31], a[204:207], v[40:43]
v_exp_f32 v26, v26
v_mfma_f32_16x16x32_bf16 v[44:47], a[16:19], a[208:211], v[92:95]
v_exp_f32 v27, v27
v_mfma_f32_16x16x32_bf16 v[44:47], a[20:23], a[212:215], v[44:47]
v_exp_f32 v28, v28
v_mfma_f32_16x16x32_bf16 v[44:47], a[24:27], a[216:219], v[44:47]
v_exp_f32 v29, v29
v_mfma_f32_16x16x32_bf16 v[44:47], a[28:31], a[220:223], v[44:47]
s_waitcnt lgkmcnt(0)
v_mul_f32 v135, v6, v135
v_cvt_pk_bf16_f32 v128, v128, v129
v_mfma_f32_16x16x32_bf16 v[192:195], a[32:35], v[72:75], v[192:195]
s_add_u32 m0, s27, 0x1000
v_exp_f32 v30, v30
v_mfma_f32_16x16x32_bf16 v[224:227], a[32:35], v[76:79], v[224:227]
buffer_load_dwordx4 v3, s[48:51], s7 offen offset:0 sc1 lds
v_mfma_f32_16x16x32_bf16 v[228:231], a[36:39], v[76:79], v[228:231]
v_exp_f32 v31, v31
v_mfma_f32_16x16x32_bf16 v[196:199], a[36:39], v[72:75], v[196:199]
ds_read_b128 a[0:3], v1 offset:24576
v_cvt_pk_bf16_f32 v56, v24, v25
v_mfma_f32_16x16x32_bf16 v[200:203], a[40:43], v[72:75], v[200:203]
ds_read_b128 a[4:7], v1 offset:25600
v_cvt_pk_bf16_f32 v57, v26, v27
v_mfma_f32_16x16x32_bf16 v[232:235], a[40:43], v[76:79], v[232:235]
v_exp_f32 v40, v40
v_mfma_f32_16x16x32_bf16 v[236:239], a[44:47], v[76:79], v[236:239]
ds_read_b128 a[8:11], v1 offset:26624
v_cvt_pk_bf16_f32 v60, v28, v29
v_mfma_f32_16x16x32_bf16 v[204:207], a[44:47], v[72:75], v[204:207]
v_exp_f32 v41, v41
v_mfma_f32_16x16x32_bf16 v[208:211], a[48:51], v[72:75], v[208:211]
ds_read_b128 a[12:15], v1 offset:27648
v_cvt_pk_bf16_f32 v61, v30, v31
v_mfma_f32_16x16x32_bf16 v[240:243], a[48:51], v[76:79], v[240:243]
ds_read_b128 a[16:19], v1 offset:28672
v_cvt_pk_bf16_f32 v58, v40, v41
v_mfma_f32_16x16x32_bf16 v[244:247], a[52:55], v[76:79], v[244:247]
v_exp_f32 v42, v42
v_mfma_f32_16x16x32_bf16 v[212:215], a[52:55], v[72:75], v[212:215]
buffer_load_dwordx4 v3, s[48:51], s7 offen offset:1024 sc1 lds
v_mfma_f32_16x16x32_bf16 v[216:219], a[56:59], v[72:75], v[216:219]
ds_read_b128 a[20:23], v1 offset:29696
v_cvt_pk_bf16_f32 v129, v130, v131
v_mfma_f32_16x16x32_bf16 v[248:251], a[56:59], v[76:79], v[248:251]
ds_read_b128 a[24:27], v1 offset:30720
v_cvt_pk_bf16_f32 v130, v132, v133
v_mfma_f32_16x16x32_bf16 v[252:255], a[60:63], v[76:79], v[252:255]
ds_read_b128 a[28:31], v1 offset:31744
v_cvt_pk_bf16_f32 v131, v134, v135
v_mfma_f32_16x16x32_bf16 v[220:223], a[60:63], v[72:75], v[220:223]
s_waitcnt lgkmcnt(4)
v_exp_f32 v43, v43
v_smfmac_f32_16x16x64_bf16 a[228:231], a[232:235], v[72:79], v9
ds_read_b128 a[32:35], v1 offset:16384
v_cvt_pk_bf16_f32 v59, v42, v43
v_mfma_f32_16x16x32_bf16 v[24:27], a[0:3], a[192:195], v[88:91]
ds_read_b128 a[36:39], v1 offset:17408
buffer_store_dwordx4 v[128:131], v3, s[88:91], s8 offen sc1
v_mfma_f32_16x16x32_bf16 v[24:27], a[4:7], a[196:199], v[24:27]
buffer_load_dwordx4 v3, s[48:51], s7 offen offset:2048 sc1 lds
v_mfma_f32_16x16x32_bf16 v[24:27], a[8:11], a[200:203], v[24:27]
ds_read_b128 a[40:43], v1 offset:18432
v_exp_f32 v44, v44
v_mfma_f32_16x16x32_bf16 v[24:27], a[12:15], a[204:207], v[24:27]
ds_read_b128 a[44:47], v1 offset:19456
v_exp_f32 v45, v45
v_mfma_f32_16x16x32_bf16 v[28:31], a[0:3], a[208:211], v[92:95]
ds_read_b128 a[48:51], v1 offset:20480
v_exp_f32 v46, v46
v_mfma_f32_16x16x32_bf16 v[28:31], a[4:7], a[212:215], v[28:31]
s_waitcnt lgkmcnt(5)
v_exp_f32 v47, v47
v_mfma_f32_16x16x32_bf16 v[28:31], a[8:11], a[216:219], v[28:31]
ds_read_b128 a[52:55], v1 offset:21504
v_cvt_pk_bf16_f32 v62, v44, v45
v_mfma_f32_16x16x32_bf16 v[28:31], a[12:15], a[220:223], v[28:31]
ds_read_b128 a[56:59], v1 offset:22528
v_cvt_pk_bf16_f32 v63, v46, v47
v_mfma_f32_16x16x32_bf16 v[40:43], a[16:19], a[192:195], v[88:91]
ds_read_b128 a[60:63], v1 offset:23552
v_xor_b32 v1, 0x8000, v1
v_mfma_f32_16x16x32_bf16 v[40:43], a[20:23], a[196:199], v[40:43]
buffer_load_dwordx4 v3, s[48:51], s7 offen offset:3072 sc1 lds
v_mfma_f32_16x16x32_bf16 v[40:43], a[24:27], a[200:203], v[40:43]
s_add_u32 s7, s7, 0x8000
v_exp_f32 v24, v24
v_mfma_f32_16x16x32_bf16 v[40:43], a[28:31], a[204:207], v[40:43]
s_xor_b32 s27, s27, 0x38000
v_exp_f32 v25, v25
v_mfma_f32_16x16x32_bf16 v[44:47], a[16:19], a[208:211], v[92:95]
s_add_u32 s8, s28, 0x2000
v_exp_f32 v26, v26
v_mfma_f32_16x16x32_bf16 v[44:47], a[20:23], a[212:215], v[44:47]
v_exp_f32 v27, v27
v_mfma_f32_16x16x32_bf16 v[44:47], a[24:27], a[216:219], v[44:47]
s_waitcnt vmcnt(19) lgkmcnt(0)
v_exp_f32 v28, v28
v_mfma_f32_16x16x32_bf16 v[44:47], a[28:31], a[220:223], v[44:47]
s_barrier
v_exp_f32 v29, v29
v_mul_f32 v136, v6, v136
v_mul_f32 v137, v6, v137
v_mul_f32 v138, v6, v138
v_mul_f32 v139, v6, v139
v_mul_f32 v140, v6, v140
v_mul_f32 v141, v6, v141
v_mul_f32 v142, v6, v142
v_mul_f32 v143, v6, v143
v_cvt_pk_bf16_f32 v136, v136, v137
v_cvt_pk_bf16_f32 v137, v138, v139
v_cvt_pk_bf16_f32 v138, v140, v141
v_cvt_pk_bf16_f32 v139, v142, v143
buffer_store_dwordx4 v[136:139], v3, s[88:91], s8 offen sc1
s_add_u32 s8, s28, 0x4000
v_mul_f32 v144, v6, v144
v_mul_f32 v145, v6, v145
v_mul_f32 v146, v6, v146
v_mul_f32 v147, v6, v147
v_mul_f32 v148, v6, v148
v_mul_f32 v149, v6, v149
v_mul_f32 v150, v6, v150
v_mul_f32 v151, v6, v151
v_cvt_pk_bf16_f32 v144, v144, v145
v_cvt_pk_bf16_f32 v145, v146, v147
v_cvt_pk_bf16_f32 v146, v148, v149
v_cvt_pk_bf16_f32 v147, v150, v151
buffer_store_dwordx4 v[144:147], v3, s[88:91], s8 offen sc1
s_add_u32 s8, s28, 0x6000
v_mul_f32 v152, v6, v152
v_mul_f32 v153, v6, v153
v_mul_f32 v154, v6, v154
v_mul_f32 v155, v6, v155
v_mul_f32 v156, v6, v156
v_mul_f32 v157, v6, v157
v_mul_f32 v158, v6, v158
v_mul_f32 v159, v6, v159
v_cvt_pk_bf16_f32 v152, v152, v153
v_cvt_pk_bf16_f32 v153, v154, v155
v_cvt_pk_bf16_f32 v154, v156, v157
v_cvt_pk_bf16_f32 v155, v158, v159
buffer_store_dwordx4 v[152:155], v3, s[88:91], s8 offen sc1
v_accvgpr_read_b32 v6, a226
v_accvgpr_read_b32 v7, a227
v_add_f32 v6, v6, v7
v_cmp_nge_f32 vcc, 0x5f800000, v6
v_rcp_f32 v6, v6
s_or_b64 s[34:35], s[34:35], vcc
s_add_u32 s8, s29, 0x0
v_pk_mul_f32 v[160:161], v[160:161], v[6:7] op_sel_hi:[1,0]
v_pk_mul_f32 v[162:163], v[162:163], v[6:7] op_sel_hi:[1,0]
v_pk_mul_f32 v[164:165], v[164:165], v[6:7] op_sel_hi:[1,0]
v_pk_mul_f32 v[166:167], v[166:167], v[6:7] op_sel_hi:[1,0]
v_cvt_pk_bf16_f32 v160, v160, v161
v_cvt_pk_bf16_f32 v161, v162, v163
v_cvt_pk_bf16_f32 v162, v164, v165
v_cvt_pk_bf16_f32 v163, v166, v167
buffer_store_dwordx4 v[160:163], v3, s[88:91], s8 offen sc1
s_add_u32 s8, s29, 0x2000
v_pk_mul_f32 v[168:169], v[168:169], v[6:7] op_sel_hi:[1,0]
v_pk_mul_f32 v[170:171], v[170:171], v[6:7] op_sel_hi:[1,0]
v_pk_mul_f32 v[172:173], v[172:173], v[6:7] op_sel_hi:[1,0]
v_pk_mul_f32 v[174:175], v[174:175], v[6:7] op_sel_hi:[1,0]
v_cvt_pk_bf16_f32 v168, v168, v169
v_cvt_pk_bf16_f32 v169, v170, v171
v_cvt_pk_bf16_f32 v170, v172, v173
v_cvt_pk_bf16_f32 v171, v174, v175
buffer_store_dwordx4 v[168:171], v3, s[88:91], s8 offen sc1
s_add_u32 s8, s29, 0x4000
v_pk_mul_f32 v[176:177], v[176:177], v[6:7] op_sel_hi:[1,0]
v_pk_mul_f32 v[178:179], v[178:179], v[6:7] op_sel_hi:[1,0]
v_pk_mul_f32 v[180:181], v[180:181], v[6:7] op_sel_hi:[1,0]
v_pk_mul_f32 v[182:183], v[182:183], v[6:7] op_sel_hi:[1,0]
v_cvt_pk_bf16_f32 v176, v176, v177
v_cvt_pk_bf16_f32 v177, v178, v179
v_cvt_pk_bf16_f32 v178, v180, v181
v_cvt_pk_bf16_f32 v179, v182, v183
buffer_store_dwordx4 v[176:179], v3, s[88:91], s8 offen sc1
s_add_u32 s8, s29, 0x6000
v_pk_mul_f32 v[184:185], v[184:185], v[6:7] op_sel_hi:[1,0]
v_pk_mul_f32 v[186:187], v[186:187], v[6:7] op_sel_hi:[1,0]
v_pk_mul_f32 v[188:189], v[188:189], v[6:7] op_sel_hi:[1,0]
v_pk_mul_f32 v[190:191], v[190:191], v[6:7] op_sel_hi:[1,0]
v_cvt_pk_bf16_f32 v184, v184, v185
v_cvt_pk_bf16_f32 v185, v186, v187
v_cvt_pk_bf16_f32 v186, v188, v189
v_cvt_pk_bf16_f32 v187, v190, v191
buffer_store_dwordx4 v[184:187], v3, s[88:91], s8 offen sc1
s_getreg_b32 s8, hwreg(HW_REG_HW_ID, 5, 1)
s_cmp_lg_u32 s8, 0
s_cbranch_scc1 L_att_sodd1
s_branch L_att_sodd0
L_att_lh0_1:
v_mfma_f32_16x16x32_bf16 v[160:163], a[32:35], v[52:55], v[160:163]
ds_read_b128 a[0:3], v1 offset:8192
v_cvt_pk_bf16_f32 v72, v24, v25
v_mfma_f32_16x16x32_bf16 v[192:195], a[32:35], v[56:59], v[192:195]
v_exp_f32 v30, v30
v_mfma_f32_16x16x32_bf16 v[224:227], a[32:35], v[60:63], v[224:227]
buffer_load_dword v14, v15, s[84:87], 0 offen offset:192 sc1
v_mfma_f32_16x16x32_bf16 v[228:231], a[36:39], v[60:63], v[228:231]
ds_read_b128 a[4:7], v1 offset:9216
v_cvt_pk_bf16_f32 v73, v26, v27
v_mfma_f32_16x16x32_bf16 v[196:199], a[36:39], v[56:59], v[196:199]
ds_read_b128 a[8:11], v1 offset:10240
v_cvt_pk_bf16_f32 v76, v28, v29
v_mfma_f32_16x16x32_bf16 v[164:167], a[36:39], v[52:55], v[164:167]
s_add_u32 m0, s17, 0x10000
v_exp_f32 v31, v31
v_mfma_f32_16x16x32_bf16 v[168:171], a[40:43], v[52:55], v[168:171]
buffer_load_dwordx4 v12, s[72:75], 0 offen lds
v_mfma_f32_16x16x32_bf16 v[200:203], a[40:43], v[56:59], v[200:203]
ds_read_b128 a[12:15], v1 offset:11264
v_cvt_pk_bf16_f32 v77, v30, v31
v_mfma_f32_16x16x32_bf16 v[232:235], a[40:43], v[60:63], v[232:235]
v_exp_f32 v40, v40
v_mfma_f32_16x16x32_bf16 v[236:239], a[44:47], v[60:63], v[236:239]
ds_read_b128 a[16:19], v1 offset:12288
v_mfma_f32_16x16x32_bf16 v[204:207], a[44:47], v[56:59], v[204:207]
v_exp_f32 v41, v41
v_mfma_f32_16x16x32_bf16 v[172:175], a[44:47], v[52:55], v[172:175]
buffer_load_dwordx4 v13, s[72:75], 0 offen offset:1024 lds
v_mfma_f32_16x16x32_bf16 v[176:179], a[48:51], v[52:55], v[176:179]
ds_read_b128 a[20:23], v1 offset:13312
v_cvt_pk_bf16_f32 v74, v40, v41
v_mfma_f32_16x16x32_bf16 v[208:211], a[48:51], v[56:59], v[208:211]
ds_read_b128 a[24:27], v1 offset:14336
v_mfma_f32_16x16x32_bf16 v[240:243], a[48:51], v[60:63], v[240:243]
v_exp_f32 v42, v42
v_mfma_f32_16x16x32_bf16 v[244:247], a[52:55], v[60:63], v[244:247]
buffer_load_dwordx4 v12, s[72:75], s12 offen offset:2048 lds
v_mfma_f32_16x16x32_bf16 v[212:215], a[52:55], v[56:59], v[212:215]
ds_read_b128 a[28:31], v1 offset:15360
v_mfma_f32_16x16x32_bf16 v[180:183], a[52:55], v[52:55], v[180:183]
v_exp_f32 v43, v43
v_mfma_f32_16x16x32_bf16 v[184:187], a[56:59], v[52:55], v[184:187]
ds_read_b128 a[32:35], v1 offset:0
v_cvt_pk_bf16_f32 v75, v42, v43
v_mfma_f32_16x16x32_bf16 v[216:219], a[56:59], v[56:59], v[216:219]
v_exp_f32 v44, v44
v_mfma_f32_16x16x32_bf16 v[248:251], a[56:59], v[60:63], v[248:251]
buffer_load_dwordx4 v13, s[72:75], s12 offen offset:3072 lds
v_mfma_f32_16x16x32_bf16 v[252:255], a[60:63], v[60:63], v[252:255]
ds_read_b128 a[36:39], v1 offset:1024
v_mfma_f32_16x16x32_bf16 v[220:223], a[60:63], v[56:59], v[220:223]
s_add_u32 m0, s17, 0x14000
v_exp_f32 v45, v45
v_mfma_f32_16x16x32_bf16 v[188:191], a[60:63], v[52:55], v[188:191]
ds_read_b128 a[40:43], v1 offset:2048
v_add_u32 v12, 0x20000, v12
v_mfma_f32_16x16x32_bf16 a[224:227], a[236:239], v[52:55], a[224:227]
buffer_load_dwordx4 v12, s[72:75], 0 offen lds
v_smfmac_f32_16x16x64_bf16 a[228:231], a[232:235], v[56:63], v9
ds_read_b128 a[44:47], v1 offset:3072
s_waitcnt lgkmcnt(8)
v_mfma_f32_16x16x32_bf16 v[24:27], a[0:3], a[192:195], v[88:91]
v_exp_f32 v46, v46
v_mfma_f32_16x16x32_bf16 v[24:27], a[4:7], a[196:199], v[24:27]
ds_read_b128 a[48:51], v1 offset:4096
v_add_u32 v13, 0x20000, v13
v_mfma_f32_16x16x32_bf16 v[24:27], a[8:11], a[200:203], v[24:27]
buffer_load_dwordx4 v13, s[72:75], 0 offen offset:1024 lds
v_mfma_f32_16x16x32_bf16 v[24:27], a[12:15], a[204:207], v[24:27]
v_exp_f32 v47, v47
v_mfma_f32_16x16x32_bf16 v[28:31], a[0:3], a[208:211], v[92:95]
ds_read_b128 a[52:55], v1 offset:5120
v_cvt_pk_bf16_f32 v78, v44, v45
v_mfma_f32_16x16x32_bf16 v[28:31], a[4:7], a[212:215], v[28:31]
s_waitcnt lgkmcnt(6)
v_cvt_pk_bf16_f32 v79, v46, v47
v_mfma_f32_16x16x32_bf16 v[28:31], a[8:11], a[216:219], v[28:31]
ds_read_b128 a[56:59], v1 offset:6144
v_mfma_f32_16x16x32_bf16 v[28:31], a[12:15], a[220:223], v[28:31]
buffer_load_dwordx4 v12, s[72:75], s12 offen offset:2048 lds
v_mfma_f32_16x16x32_bf16 v[40:43], a[16:19], a[192:195], v[88:91]
ds_read_b128 a[60:63], v1 offset:7168
v_mfma_f32_16x16x32_bf16 v[40:43], a[20:23], a[196:199], v[40:43]
v_exp_f32 v24, v24
v_mfma_f32_16x16x32_bf16 v[40:43], a[24:27], a[200:203], v[40:43]
v_exp_f32 v25, v25
v_mfma_f32_16x16x32_bf16 v[40:43], a[28:31], a[204:207], v[40:43]
buffer_load_dwordx4 v13, s[72:75], s12 offen offset:3072 lds
v_mfma_f32_16x16x32_bf16 v[44:47], a[16:19], a[208:211], v[92:95]
v_exp_f32 v26, v26
v_mfma_f32_16x16x32_bf16 v[44:47], a[20:23], a[212:215], v[44:47]
v_exp_f32 v27, v27
v_mfma_f32_16x16x32_bf16 v[44:47], a[24:27], a[216:219], v[44:47]
v_exp_f32 v28, v28
v_mfma_f32_16x16x32_bf16 v[44:47], a[28:31], a[220:223], v[44:47]
s_waitcnt lgkmcnt(0)
v_exp_f32 v29, v29
v_mfma_f32_16x16x32_bf16 v[192:195], a[32:35], v[72:75], v[192:195]
s_add_u32 m0, s16, 0x0
v_add_u32 v12, 0x20000, v12
v_cvt_pk_bf16_f32 v56, v24, v25
v_mfma_f32_16x16x32_bf16 v[224:227], a[32:35], v[76:79], v[224:227]
buffer_load_dwordx4 v12, s[72:75], 0 offen lds
v_mfma_f32_16x16x32_bf16 v[228:231], a[36:39], v[76:79], v[228:231]
ds_read_b128 a[0:3], v1 offset:24576
v_cvt_pk_bf16_f32 v57, v26, v27
v_mfma_f32_16x16x32_bf16 v[196:199], a[36:39], v[72:75], v[196:199]
v_exp_f32 v30, v30
v_mfma_f32_16x16x32_bf16 v[200:203], a[40:43], v[72:75], v[200:203]
ds_read_b128 a[4:7], v1 offset:25600
v_cvt_pk_bf16_f32 v60, v28, v29
v_mfma_f32_16x16x32_bf16 v[232:235], a[40:43], v[76:79], v[232:235]
ds_read_b128 a[8:11], v1 offset:26624
v_add_u32 v13, 0x20000, v13
v_mfma_f32_16x16x32_bf16 v[236:239], a[44:47], v[76:79], v[236:239]
buffer_load_dwordx4 v13, s[72:75], 0 offen offset:1024 lds
v_mfma_f32_16x16x32_bf16 v[204:207], a[44:47], v[72:75], v[204:207]
ds_read_b128 a[12:15], v1 offset:27648
v_exp_f32 v31, v31
v_mfma_f32_16x16x32_bf16 v[208:211], a[48:51], v[72:75], v[208:211]
buffer_load_dwordx4 v12, s[72:75], s12 offen offset:2048 lds
v_mfma_f32_16x16x32_bf16 v[240:243], a[48:51], v[76:79], v[240:243]
ds_read_b128 a[16:19], v1 offset:28672
v_exp_f32 v40, v40
v_mfma_f32_16x16x32_bf16 v[244:247], a[52:55], v[76:79], v[244:247]
ds_read_b128 a[20:23], v1 offset:29696
v_cvt_pk_bf16_f32 v61, v30, v31
v_mfma_f32_16x16x32_bf16 v[212:215], a[52:55], v[72:75], v[212:215]
buffer_load_dwordx4 v13, s[72:75], s12 offen offset:3072 lds
v_mfma_f32_16x16x32_bf16 v[216:219], a[56:59], v[72:75], v[216:219]
ds_read_b128 a[24:27], v1 offset:30720
v_exp_f32 v41, v41
v_mfma_f32_16x16x32_bf16 v[248:251], a[56:59], v[76:79], v[248:251]
ds_read_b128 a[28:31], v1 offset:31744
v_exp_f32 v42, v42
v_mfma_f32_16x16x32_bf16 v[252:255], a[60:63], v[76:79], v[252:255]
ds_read_b128 a[32:35], v1 offset:16384
v_cvt_pk_bf16_f32 v58, v40, v41
v_mfma_f32_16x16x32_bf16 v[220:223], a[60:63], v[72:75], v[220:223]
s_waitcnt lgkmcnt(5)
v_exp_f32 v43, v43
v_smfmac_f32_16x16x64_bf16 a[228:231], a[232:235], v[72:79], v9
ds_read_b128 a[36:39], v1 offset:17408
v_add_u32 v12, 0x20000, v12
v_mfma_f32_16x16x32_bf16 v[24:27], a[0:3], a[192:195], v[112:115]
s_add_u32 m0, s16, 0x4000
v_exp_f32 v44, v44
v_mfma_f32_16x16x32_bf16 v[24:27], a[4:7], a[196:199], v[24:27]
buffer_load_dwordx4 v12, s[72:75], 0 offen lds
v_mfma_f32_16x16x32_bf16 v[24:27], a[8:11], a[200:203], v[24:27]
ds_read_b128 a[40:43], v1 offset:18432
v_add_u32 v13, 0x20000, v13
v_mfma_f32_16x16x32_bf16 v[24:27], a[12:15], a[204:207], v[24:27]
buffer_load_dwordx4 v13, s[72:75], 0 offen offset:1024 lds
v_mfma_f32_16x16x32_bf16 v[28:31], a[0:3], a[208:211], v[92:95]
ds_read_b128 a[44:47], v1 offset:19456
v_cvt_pk_bf16_f32 v59, v42, v43
v_mfma_f32_16x16x32_bf16 v[28:31], a[4:7], a[212:215], v[28:31]
ds_read_b128 a[48:51], v1 offset:20480
v_exp_f32 v45, v45
v_mfma_f32_16x16x32_bf16 v[28:31], a[8:11], a[216:219], v[28:31]
s_waitcnt lgkmcnt(5)
v_exp_f32 v46, v46
v_mfma_f32_16x16x32_bf16 v[28:31], a[12:15], a[220:223], v[28:31]
buffer_load_dwordx4 v12, s[72:75], s12 offen offset:2048 lds
v_mfma_f32_16x16x32_bf16 v[40:43], a[16:19], a[192:195], v[116:119]
ds_read_b128 a[52:55], v1 offset:21504
v_exp_f32 v47, v47
v_mfma_f32_16x16x32_bf16 v[40:43], a[20:23], a[196:199], v[40:43]
ds_read_b128 a[56:59], v1 offset:22528
v_exp_f32 v24, v24
v_mfma_f32_16x16x32_bf16 v[40:43], a[24:27], a[200:203], v[40:43]
ds_read_b128 a[60:63], v1 offset:23552
v_xor_b32 v1, 0x8000, v1
v_mfma_f32_16x16x32_bf16 v[40:43], a[28:31], a[204:207], v[40:43]
v_exp_f32 v25, v25
v_cvt_pk_bf16_f32 v62, v44, v45
v_cvt_pk_bf16_f32 v63, v46, v47
v_mfma_f32_16x16x32_bf16 v[44:47], a[16:19], a[208:211], v[92:95]
v_exp_f32 v26, v26
v_mfma_f32_16x16x32_bf16 v[44:47], a[20:23], a[212:215], v[44:47]
buffer_load_dwordx4 v13, s[72:75], s12 offen offset:3072 lds
v_mfma_f32_16x16x32_bf16 v[44:47], a[24:27], a[216:219], v[44:47]
v_exp_f32 v27, v27
v_mfma_f32_16x16x32_bf16 v[44:47], a[28:31], a[220:223], v[44:47]
v_exp_f32 v28, v28
v_exp_f32 v29, v29
v_accvgpr_read_b32 v6, a224
v_accvgpr_read_b32 v7, a225
v_add_f32 v6, v6, v7
v_cmp_nge_f32 vcc, 0x5f800000, v6
v_rcp_f32 v6, v6
s_or_b64 s[34:35], s[34:35], vcc
s_add_u32 s8, s28, 0x0
v_pk_mul_f32 v[128:129], v[128:129], v[6:7] op_sel_hi:[1,0]
v_pk_mul_f32 v[130:131], v[130:131], v[6:7] op_sel_hi:[1,0]
v_pk_mul_f32 v[132:133], v[132:133], v[6:7] op_sel_hi:[1,0]
v_pk_mul_f32 v[134:135], v[134:135], v[6:7] op_sel_hi:[1,0]
v_cvt_pk_bf16_f32 v128, v128, v129
v_cvt_pk_bf16_f32 v129, v130, v131
v_cvt_pk_bf16_f32 v130, v132, v133
v_cvt_pk_bf16_f32 v131, v134, v135
buffer_store_dwordx4 v[128:131], v3, s[88:91], s8 offen sc1
s_add_u32 s8, s28, 0x2000
v_pk_mul_f32 v[136:137], v[136:137], v[6:7] op_sel_hi:[1,0]
v_pk_mul_f32 v[138:139], v[138:139], v[6:7] op_sel_hi:[1,0]
v_pk_mul_f32 v[140:141], v[140:141], v[6:7] op_sel_hi:[1,0]
v_pk_mul_f32 v[142:143], v[142:143], v[6:7] op_sel_hi:[1,0]
v_cvt_pk_bf16_f32 v136, v136, v137
v_cvt_pk_bf16_f32 v137, v138, v139
v_cvt_pk_bf16_f32 v138, v140, v141
v_cvt_pk_bf16_f32 v139, v142, v143
buffer_store_dwordx4 v[136:139], v3, s[88:91], s8 offen sc1
s_add_u32 s8, s28, 0x4000
v_pk_mul_f32 v[144:145], v[144:145], v[6:7] op_sel_hi:[1,0]
v_pk_mul_f32 v[146:147], v[146:147], v[6:7] op_sel_hi:[1,0]
v_pk_mul_f32 v[148:149], v[148:149], v[6:7] op_sel_hi:[1,0]
v_pk_mul_f32 v[150:151], v[150:151], v[6:7] op_sel_hi:[1,0]
v_cvt_pk_bf16_f32 v144, v144, v145
v_cvt_pk_bf16_f32 v145, v146, v147
v_cvt_pk_bf16_f32 v146, v148, v149
v_cvt_pk_bf16_f32 v147, v150, v151
buffer_store_dwordx4 v[144:147], v3, s[88:91], s8 offen sc1
s_add_u32 s8, s28, 0x6000
v_pk_mul_f32 v[152:153], v[152:153], v[6:7] op_sel_hi:[1,0]
v_pk_mul_f32 v[154:155], v[154:155], v[6:7] op_sel_hi:[1,0]
v_pk_mul_f32 v[156:157], v[156:157], v[6:7] op_sel_hi:[1,0]
v_pk_mul_f32 v[158:159], v[158:159], v[6:7] op_sel_hi:[1,0]
v_cvt_pk_bf16_f32 v152, v152, v153
v_cvt_pk_bf16_f32 v153, v154, v155
v_cvt_pk_bf16_f32 v154, v156, v157
v_cvt_pk_bf16_f32 v155, v158, v159
buffer_store_dwordx4 v[152:155], v3, s[88:91], s8 offen sc1
v_accvgpr_read_b32 v6, a226
v_accvgpr_read_b32 v7, a227
v_add_f32 v6, v6, v7
v_cmp_nge_f32 vcc, 0x5f800000, v6
v_rcp_f32 v6, v6
s_or_b64 s[34:35], s[34:35], vcc
s_add_u32 s8, s29, 0x0
v_pk_mul_f32 v[160:161], v[160:161], v[6:7] op_sel_hi:[1,0]
v_pk_mul_f32 v[162:163], v[162:163], v[6:7] op_sel_hi:[1,0]
v_pk_mul_f32 v[164:165], v[164:165], v[6:7] op_sel_hi:[1,0]
v_pk_mul_f32 v[166:167], v[166:167], v[6:7] op_sel_hi:[1,0]
v_cvt_pk_bf16_f32 v160, v160, v161
v_cvt_pk_bf16_f32 v161, v162, v163
v_cvt_pk_bf16_f32 v162, v164, v165
v_cvt_pk_bf16_f32 v163, v166, v167
buffer_store_dwordx4 v[160:163], v3, s[88:91], s8 offen sc1
s_add_u32 s8, s29, 0x2000
v_pk_mul_f32 v[168:169], v[168:169], v[6:7] op_sel_hi:[1,0]
v_pk_mul_f32 v[170:171], v[170:171], v[6:7] op_sel_hi:[1,0]
v_pk_mul_f32 v[172:173], v[172:173], v[6:7] op_sel_hi:[1,0]
v_pk_mul_f32 v[174:175], v[174:175], v[6:7] op_sel_hi:[1,0]
v_cvt_pk_bf16_f32 v168, v168, v169
v_cvt_pk_bf16_f32 v169, v170, v171
v_cvt_pk_bf16_f32 v170, v172, v173
v_cvt_pk_bf16_f32 v171, v174, v175
buffer_store_dwordx4 v[168:171], v3, s[88:91], s8 offen sc1
s_add_u32 s8, s29, 0x4000
v_pk_mul_f32 v[176:177], v[176:177], v[6:7] op_sel_hi:[1,0]
v_pk_mul_f32 v[178:179], v[178:179], v[6:7] op_sel_hi:[1,0]
v_pk_mul_f32 v[180:181], v[180:181], v[6:7] op_sel_hi:[1,0]
v_pk_mul_f32 v[182:183], v[182:183], v[6:7] op_sel_hi:[1,0]
v_cvt_pk_bf16_f32 v176, v176, v177
v_cvt_pk_bf16_f32 v177, v178, v179
v_cvt_pk_bf16_f32 v178, v180, v181
v_cvt_pk_bf16_f32 v179, v182, v183
buffer_store_dwordx4 v[176:179], v3, s[88:91], s8 offen sc1
s_add_u32 s8, s29, 0x6000
v_pk_mul_f32 v[184:185], v[184:185], v[6:7] op_sel_hi:[1,0]
v_pk_mul_f32 v[186:187], v[186:187], v[6:7] op_sel_hi:[1,0]
v_pk_mul_f32 v[188:189], v[188:189], v[6:7] op_sel_hi:[1,0]
v_pk_mul_f32 v[190:191], v[190:191], v[6:7] op_sel_hi:[1,0]
v_cvt_pk_bf16_f32 v184, v184, v185
v_cvt_pk_bf16_f32 v185, v186, v187
v_cvt_pk_bf16_f32 v186, v188, v189
v_cvt_pk_bf16_f32 v187, v190, v191
buffer_store_dwordx4 v[184:187], v3, s[88:91], s8 offen sc1
s_branch L_att_h1_1
L_att_j0:
s_cmp_ge_u32 s4, 2
s_cbranch_scc1 L_att_nl0_1
L_att_nl0_0:
v_mfma_f32_16x16x32_bf16 v[16:19], a[0:3], a[160:163], v[96:99]
ds_read_b128 a[128:131], v1 offset:24576
v_mov_b32 v240, 0
v_mfma_f32_16x16x32_bf16 v[16:19], a[4:7], a[164:167], v[16:19]
ds_read_b128 a[132:135], v1 offset:25600
s_add_u32 m0, s27, 0x0
v_mfma_f32_16x16x32_bf16 v[16:19], a[8:11], a[168:171], v[16:19]
buffer_load_dwordx4 v3, s[48:51], s32 offen offset:0 sc1 lds
v_mfma_f32_16x16x32_bf16 v[16:19], a[12:15], a[172:175], v[16:19]
ds_read_b128 a[136:139], v1 offset:26624
v_mov_b32 v241, 0
v_mfma_f32_16x16x32_bf16 v[20:23], a[0:3], a[176:179], v[84:87]
ds_read_b128 a[140:143], v1 offset:27648
v_mov_b32 v242, 0
v_mfma_f32_16x16x32_bf16 v[20:23], a[4:7], a[180:183], v[20:23]
ds_read_b128 a[144:147], v1 offset:28672
v_mov_b32 v243, 0
v_mfma_f32_16x16x32_bf16 v[20:23], a[8:11], a[184:187], v[20:23]
ds_read_b128 a[148:151], v1 offset:29696
s_mov_b32 s9, 0x0
v_mfma_f32_16x16x32_bf16 v[20:23], a[12:15], a[188:191], v[20:23]
buffer_load_dword a244, v8, s[72:75], s9 offen
v_mfma_f32_16x16x32_bf16 v[24:27], a[0:3], a[192:195], v[88:91]
ds_read_b128 a[152:155], v1 offset:30720
v_mov_b32 v244, 0
v_mfma_f32_16x16x32_bf16 v[24:27], a[4:7], a[196:199], v[24:27]
ds_read_b128 a[156:159], v1 offset:31744
v_exp_f32 v16, v16
v_mfma_f32_16x16x32_bf16 v[24:27], a[8:11], a[200:203], v[24:27]
v_exp_f32 v17, v17
v_mfma_f32_16x16x32_bf16 v[24:27], a[12:15], a[204:207], v[24:27]
v_exp_f32 v18, v18
v_mfma_f32_16x16x32_bf16 v[28:31], a[0:3], a[208:211], v[92:95]
buffer_load_dwordx4 v3, s[48:51], s32 offen offset:1024 sc1 lds
v_mfma_f32_16x16x32_bf16 v[28:31], a[4:7], a[212:215], v[28:31]
v_exp_f32 v19, v19
v_mfma_f32_16x16x32_bf16 v[28:31], a[8:11], a[216:219], v[28:31]
v_exp_f32 v20, v20
v_mfma_f32_16x16x32_bf16 v[28:31], a[12:15], a[220:223], v[28:31]
v_exp_f32 v21, v21
v_mfma_f32_16x16x32_bf16 v[32:35], a[16:19], a[160:163], v[100:103]
v_exp_f32 v22, v22
v_mfma_f32_16x16x32_bf16 v[32:35], a[20:23], a[164:167], v[32:35]
buffer_load_dwordx4 v3, s[48:51], s32 offen offset:2048 sc1 lds
v_mfma_f32_16x16x32_bf16 v[32:35], a[24:27], a[168:171], v[32:35]
v_exp_f32 v23, v23
v_mfma_f32_16x16x32_bf16 v[32:35], a[28:31], a[172:175], v[32:35]
v_exp_f32 v24, v24
v_mfma_f32_16x16x32_bf16 v[36:39], a[16:19], a[176:179], v[84:87]
v_exp_f32 v25, v25
v_mfma_f32_16x16x32_bf16 v[36:39], a[20:23], a[180:183], v[36:39]
v_exp_f32 v26, v26
v_mfma_f32_16x16x32_bf16 v[36:39], a[24:27], a[184:187], v[36:39]
buffer_load_dwordx4 v3, s[48:51], s32 offen offset:3072 sc1 lds
v_mfma_f32_16x16x32_bf16 v[36:39], a[28:31], a[188:191], v[36:39]
v_exp_f32 v27, v27
v_mfma_f32_16x16x32_bf16 v[40:43], a[16:19], a[192:195], v[88:91]
v_exp_f32 v28, v28
v_mfma_f32_16x16x32_bf16 v[40:43], a[20:23], a[196:199], v[40:43]
v_exp_f32 v29, v29
v_mfma_f32_16x16x32_bf16 v[40:43], a[24:27], a[200:203], v[40:43]
s_mov_b32 s9, 0x0
v_exp_f32 v30, v30
v_mfma_f32_16x16x32_bf16 v[40:43], a[28:31], a[204:207], v[40:43]
buffer_load_dword a244, v8, s[64:67], s9 offen
v_mfma_f32_16x16x32_bf16 v[44:47], a[16:19], a[208:211], v[92:95]
v_exp_f32 v31, v31
v_mfma_f32_16x16x32_bf16 v[44:47], a[20:23], a[212:215], v[44:47]
v_exp_f32 v32, v32
v_mfma_f32_16x16x32_bf16 v[44:47], a[24:27], a[216:219], v[44:47]
v_exp_f32 v33, v33
v_mfma_f32_16x16x32_bf16 v[44:47], a[28:31], a[220:223], v[44:47]
s_waitcnt lgkmcnt(0)
v_cvt_pk_bf16_f32 v48, v16, v17
v_cvt_pk_bf16_f32 v49, v18, v19
v_cvt_pk_bf16_f32 v52, v20, v21
v_cvt_pk_bf16_f32 v53, v22, v23
v_cvt_pk_bf16_f32 v56, v24, v25
v_cvt_pk_bf16_f32 v57, v26, v27
v_mov_b32 v245, 0
v_mov_b32 v246, 0
v_mov_b32 v247, 0
v_mfma_f32_16x16x32_bf16 v[20:23], a[128:131], a[176:179], v[84:87]
s_add_u32 m0, s27, 0x1000
v_exp_f32 v34, v34
v_mfma_f32_16x16x32_bf16 v[20:23], a[132:135], a[180:183], v[20:23]
buffer_load_dwordx4 v3, s[48:51], s7 offen offset:0 sc1 lds
v_mfma_f32_16x16x32_bf16 v[20:23], a[136:139], a[184:187], v[20:23]
v_exp_f32 v35, v35
v_mfma_f32_16x16x32_bf16 v[20:23], a[140:143], a[188:191], v[20:23]
ds_read_b128 a[32:35], v1 offset:16384
v_cvt_pk_bf16_f32 v60, v28, v29
v_mfma_f32_16x16x32_bf16 v[24:27], a[128:131], a[192:195], v[88:91]
v_exp_f32 v36, v36
v_mfma_f32_16x16x32_bf16 v[24:27], a[132:135], a[196:199], v[24:27]
ds_read_b128 a[36:39], v1 offset:17408
v_cvt_pk_bf16_f32 v61, v30, v31
v_mfma_f32_16x16x32_bf16 v[24:27], a[136:139], a[200:203], v[24:27]
buffer_load_dwordx4 v3, s[48:51], s7 offen offset:1024 sc1 lds
v_mfma_f32_16x16x32_bf16 v[24:27], a[140:143], a[204:207], v[24:27]
ds_read_b128 a[40:43], v1 offset:18432
v_cvt_pk_bf16_f32 v50, v32, v33
v_mfma_f32_16x16x32_bf16 v[28:31], a[128:131], a[208:211], v[92:95]
v_exp_f32 v37, v37
v_mfma_f32_16x16x32_bf16 v[28:31], a[132:135], a[212:215], v[28:31]
ds_read_b128 a[44:47], v1 offset:19456
v_cvt_pk_bf16_f32 v51, v34, v35
v_mfma_f32_16x16x32_bf16 v[28:31], a[136:139], a[216:219], v[28:31]
buffer_load_dwordx4 v3, s[48:51], s7 offen offset:2048 sc1 lds
v_mfma_f32_16x16x32_bf16 v[28:31], a[140:143], a[220:223], v[28:31]
s_mov_b32 s9, 0x400000
v_exp_f32 v38, v38
v_exp_f32 v39, v39
v_cvt_pk_bf16_f32 v54, v36, v37
v_cvt_pk_bf16_f32 v55, v38, v39
v_mfma_f32_16x16x32_bf16 v[36:39], a[144:147], a[176:179], v[84:87]
ds_read_b128 a[48:51], v1 offset:20480
v_exp_f32 v40, v40
v_mfma_f32_16x16x32_bf16 v[36:39], a[148:151], a[180:183], v[36:39]
ds_read_b128 a[52:55], v1 offset:21504
v_exp_f32 v41, v41
v_mfma_f32_16x16x32_bf16 v[36:39], a[152:155], a[184:187], v[36:39]
buffer_load_dword a244, v8, s[64:67], s9 offen
v_mfma_f32_16x16x32_bf16 v[36:39], a[156:159], a[188:191], v[36:39]
ds_read_b128 a[56:59], v1 offset:22528
v_cvt_pk_bf16_f32 v58, v40, v41
v_exp_f32 v42, v42
v_exp_f32 v43, v43
s_nop 0
v_cvt_pk_bf16_f32 v59, v42, v43
v_mfma_f32_16x16x32_bf16 v[40:43], a[144:147], a[192:195], v[88:91]
buffer_load_dwordx4 v3, s[48:51], s7 offen offset:3072 sc1 lds
v_mfma_f32_16x16x32_bf16 v[40:43], a[148:151], a[196:199], v[40:43]
ds_read_b128 a[60:63], v1 offset:23552
v_xor_b32 v1, 0x8000, v1
v_mfma_f32_16x16x32_bf16 v[40:43], a[152:155], a[200:203], v[40:43]
s_add_u32 s32, s32, 0x8000
v_exp_f32 v44, v44
v_mfma_f32_16x16x32_bf16 v[40:43], a[156:159], a[204:207], v[40:43]
s_add_u32 s7, s7, 0x8000
v_exp_f32 v45, v45
v_exp_f32 v46, v46
v_exp_f32 v47, v47
v_cvt_pk_bf16_f32 v62, v44, v45
v_cvt_pk_bf16_f32 v63, v46, v47
v_mfma_f32_16x16x32_bf16 v[44:47], a[144:147], a[208:211], v[92:95]
s_xor_b32 s27, s27, 0x38000
v_exp_f32 v20, v20
v_mfma_f32_16x16x32_bf16 v[44:47], a[148:151], a[212:215], v[44:47]
v_exp_f32 v21, v21
v_mfma_f32_16x16x32_bf16 v[44:47], a[152:155], a[216:219], v[44:47]
s_waitcnt vmcnt(11) lgkmcnt(0)
v_exp_f32 v22, v22
v_mfma_f32_16x16x32_bf16 v[44:47], a[156:159], a[220:223], v[44:47]
s_barrier
v_cvt_pk_bf16_f32 v68, v20, v21
v_exp_f32 v23, v23
v_exp_f32 v24, v24
v_exp_f32 v25, v25
v_exp_f32 v26, v26
v_exp_f32 v27, v27
v_cvt_pk_bf16_f32 v69, v22, v23
s_cmp_lg_u32 s33, 0
s_cbranch_scc1 L_sig_bn0
s_lshl_b32 s8, s6, 2
s_add_u32 s8, s8, 192
s_cmp_lg_u32 s4, 0
s_cbranch_scc1 L_sig_bn0
v_mov_b32 v4, 1
s_mov_b64 exec, 1
buffer_atomic_add v4, off, s[84:87], s8 sc1
s_mov_b64 exec, -1
L_sig_bn0:
s_branch L_att_l1_0
L_att_nl0_1:
v_mfma_f32_16x16x32_bf16 v[16:19], a[0:3], a[160:163], v[80:83]
ds_read_b128 a[128:131], v1 offset:24576
v_mov_b32 v240, 0
v_mfma_f32_16x16x32_bf16 v[16:19], a[4:7], a[164:167], v[16:19]
ds_read_b128 a[132:135], v1 offset:25600
s_add_u32 m0, s27, 0x0
v_mfma_f32_16x16x32_bf16 v[16:19], a[8:11], a[168:171], v[16:19]
buffer_load_dwordx4 v3, s[48:51], s32 offen offset:0 sc1 lds
v_mfma_f32_16x16x32_bf16 v[16:19], a[12:15], a[172:175], v[16:19]
ds_read_b128 a[136:139], v1 offset:26624
v_mov_b32 v241, 0
v_mfma_f32_16x16x32_bf16 v[20:23], a[0:3], a[176:179], v[84:87]
ds_read_b128 a[140:143], v1 offset:27648
v_mov_b32 v242, 0
v_mfma_f32_16x16x32_bf16 v[20:23], a[4:7], a[180:183], v[20:23]
ds_read_b128 a[144:147], v1 offset:28672
v_mov_b32 v243, 0
v_mfma_f32_16x16x32_bf16 v[20:23], a[8:11], a[184:187], v[20:23]
ds_read_b128 a[148:151], v1 offset:29696
s_mov_b32 s9, 0x0
v_mfma_f32_16x16x32_bf16 v[20:23], a[12:15], a[188:191], v[20:23]
buffer_load_dword a244, v8, s[72:75], s9 offen
v_mfma_f32_16x16x32_bf16 v[24:27], a[0:3], a[192:195], v[88:91]
ds_read_b128 a[152:155], v1 offset:30720
v_mov_b32 v244, 0
v_mfma_f32_16x16x32_bf16 v[24:27], a[4:7], a[196:199], v[24:27]
ds_read_b128 a[156:159], v1 offset:31744
v_exp_f32 v16, v16
v_mfma_f32_16x16x32_bf16 v[24:27], a[8:11], a[200:203], v[24:27]
v_exp_f32 v17, v17
v_mfma_f32_16x16x32_bf16 v[24:27], a[12:15], a[204:207], v[24:27]
v_exp_f32 v18, v18
v_mfma_f32_16x16x32_bf16 v[28:31], a[0:3], a[208:211], v[92:95]
buffer_load_dwordx4 v3, s[48:51], s32 offen offset:1024 sc1 lds
v_mfma_f32_16x16x32_bf16 v[28:31], a[4:7], a[212:215], v[28:31]
v_exp_f32 v19, v19
v_mfma_f32_16x16x32_bf16 v[28:31], a[8:11], a[216:219], v[28:31]
v_exp_f32 v20, v20
v_mfma_f32_16x16x32_bf16 v[28:31], a[12:15], a[220:223], v[28:31]
v_exp_f32 v21, v21
v_mfma_f32_16x16x32_bf16 v[32:35], a[16:19], a[160:163], v[80:83]
v_exp_f32 v22, v22
v_mfma_f32_16x16x32_bf16 v[32:35], a[20:23], a[164:167], v[32:35]
buffer_load_dwordx4 v3, s[48:51], s32 offen offset:2048 sc1 lds
v_mfma_f32_16x16x32_bf16 v[32:35], a[24:27], a[168:171], v[32:35]
v_exp_f32 v23, v23
v_mfma_f32_16x16x32_bf16 v[32:35], a[28:31], a[172:175], v[32:35]
v_exp_f32 v24, v24
v_mfma_f32_16x16x32_bf16 v[36:39], a[16:19], a[176:179], v[84:87]
v_exp_f32 v25, v25
v_mfma_f32_16x16x32_bf16 v[36:39], a[20:23], a[180:183], v[36:39]
v_exp_f32 v26, v26
v_mfma_f32_16x16x32_bf16 v[36:39], a[24:27], a[184:187], v[36:39]
buffer_load_dwordx4 v3, s[48:51], s32 offen offset:3072 sc1 lds
v_mfma_f32_16x16x32_bf16 v[36:39], a[28:31], a[188:191], v[36:39]
v_exp_f32 v27, v27
v_mfma_f32_16x16x32_bf16 v[40:43], a[16:19], a[192:195], v[88:91]
v_exp_f32 v28, v28
v_mfma_f32_16x16x32_bf16 v[40:43], a[20:23], a[196:199], v[40:43]
v_exp_f32 v29, v29
v_mfma_f32_16x16x32_bf16 v[40:43], a[24:27], a[200:203], v[40:43]
s_mov_b32 s9, 0x0
v_exp_f32 v30, v30
v_mfma_f32_16x16x32_bf16 v[40:43], a[28:31], a[204:207], v[40:43]
buffer_load_dword a244, v8, s[64:67], s9 offen
v_mfma_f32_16x16x32_bf16 v[44:47], a[16:19], a[208:211], v[92:95]
v_exp_f32 v31, v31
v_mfma_f32_16x16x32_bf16 v[44:47], a[20:23], a[212:215], v[44:47]
v_exp_f32 v32, v32
v_mfma_f32_16x16x32_bf16 v[44:47], a[24:27], a[216:219], v[44:47]
v_exp_f32 v33, v33
v_mfma_f32_16x16x32_bf16 v[44:47], a[28:31], a[220:223], v[44:47]
s_waitcnt lgkmcnt(0)
v_cvt_pk_bf16_f32 v48, v16, v17
v_cvt_pk_bf16_f32 v49, v18, v19
v_cvt_pk_bf16_f32 v52, v20, v21
v_cvt_pk_bf16_f32 v53, v22, v23
v_cvt_pk_bf16_f32 v56, v24, v25
v_cvt_pk_bf16_f32 v57, v26, v27
v_mov_b32 v245, 0
v_mov_b32 v246, 0
v_mov_b32 v247, 0
v_mfma_f32_16x16x32_bf16 v[16:19], a[128:131], a[160:163], v[96:99]
ds_read_b128 a[32:35], v1 offset:16384
v_cvt_pk_bf16_f32 v60, v28, v29
v_mfma_f32_16x16x32_bf16 v[16:19], a[132:135], a[164:167], v[16:19]
s_add_u32 m0, s27, 0x1000
v_exp_f32 v34, v34
v_mfma_f32_16x16x32_bf16 v[16:19], a[136:139], a[168:171], v[16:19]
buffer_load_dwordx4 v3, s[48:51], s7 offen offset:0 sc1 lds
v_mfma_f32_16x16x32_bf16 v[16:19], a[140:143], a[172:175], v[16:19]
ds_read_b128 a[36:39], v1 offset:17408
v_cvt_pk_bf16_f32 v61, v30, v31
v_mfma_f32_16x16x32_bf16 v[20:23], a[128:131], a[176:179], v[84:87]
v_exp_f32 v35, v35
v_mfma_f32_16x16x32_bf16 v[20:23], a[132:135], a[180:183], v[20:23]
v_exp_f32 v36, v36
v_mfma_f32_16x16x32_bf16 v[20:23], a[136:139], a[184:187], v[20:23]
ds_read_b128 a[40:43], v1 offset:18432
v_cvt_pk_bf16_f32 v50, v32, v33
v_mfma_f32_16x16x32_bf16 v[20:23], a[140:143], a[188:191], v[20:23]
buffer_load_dwordx4 v3, s[48:51], s7 offen offset:1024 sc1 lds
v_mfma_f32_16x16x32_bf16 v[24:27], a[128:131], a[192:195], v[88:91]
v_exp_f32 v37, v37
v_mfma_f32_16x16x32_bf16 v[24:27], a[132:135], a[196:199], v[24:27]
ds_read_b128 a[44:47], v1 offset:19456
v_cvt_pk_bf16_f32 v51, v34, v35
v_mfma_f32_16x16x32_bf16 v[24:27], a[136:139], a[200:203], v[24:27]
v_exp_f32 v38, v38
v_mfma_f32_16x16x32_bf16 v[24:27], a[140:143], a[204:207], v[24:27]
v_exp_f32 v39, v39
v_mfma_f32_16x16x32_bf16 v[28:31], a[128:131], a[208:211], v[92:95]
v_exp_f32 v40, v40
v_mfma_f32_16x16x32_bf16 v[28:31], a[132:135], a[212:215], v[28:31]
buffer_load_dwordx4 v3, s[48:51], s7 offen offset:2048 sc1 lds
v_mfma_f32_16x16x32_bf16 v[28:31], a[136:139], a[216:219], v[28:31]
ds_read_b128 a[48:51], v1 offset:20480
v_cvt_pk_bf16_f32 v54, v36, v37
v_mfma_f32_16x16x32_bf16 v[28:31], a[140:143], a[220:223], v[28:31]
v_exp_f32 v41, v41
v_mfma_f32_16x16x32_bf16 v[32:35], a[144:147], a[160:163], v[100:103]
ds_read_b128 a[52:55], v1 offset:21504
v_cvt_pk_bf16_f32 v55, v38, v39
v_mfma_f32_16x16x32_bf16 v[32:35], a[148:151], a[164:167], v[32:35]
s_mov_b32 s9, 0x400000
v_exp_f32 v42, v42
v_mfma_f32_16x16x32_bf16 v[32:35], a[152:155], a[168:171], v[32:35]
buffer_load_dword a244, v8, s[64:67], s9 offen
v_mfma_f32_16x16x32_bf16 v[32:35], a[156:159], a[172:175], v[32:35]
ds_read_b128 a[56:59], v1 offset:22528
v_cvt_pk_bf16_f32 v58, v40, v41
v_mfma_f32_16x16x32_bf16 v[36:39], a[144:147], a[176:179], v[84:87]
v_exp_f32 v43, v43
v_mfma_f32_16x16x32_bf16 v[36:39], a[148:151], a[180:183], v[36:39]
v_exp_f32 v44, v44
v_mfma_f32_16x16x32_bf16 v[36:39], a[152:155], a[184:187], v[36:39]
ds_read_b128 a[60:63], v1 offset:23552
v_xor_b32 v1, 0x8000, v1
v_mfma_f32_16x16x32_bf16 v[36:39], a[156:159], a[188:191], v[36:39]
buffer_load_dwordx4 v3, s[48:51], s7 offen offset:3072 sc1 lds
v_cvt_pk_bf16_f32 v59, v42, v43
v_mfma_f32_16x16x32_bf16 v[40:43], a[144:147], a[192:195], v[88:91]
s_add_u32 s32, s32, 0x8000
v_exp_f32 v45, v45
v_mfma_f32_16x16x32_bf16 v[40:43], a[148:151], a[196:199], v[40:43]
s_add_u32 s7, s7, 0x8000
v_exp_f32 v46, v46
v_mfma_f32_16x16x32_bf16 v[40:43], a[152:155], a[200:203], v[40:43]
s_xor_b32 s27, s27, 0x38000
v_exp_f32 v47, v47
v_mfma_f32_16x16x32_bf16 v[40:43], a[156:159], a[204:207], v[40:43]
v_exp_f32 v16, v16
v_cvt_pk_bf16_f32 v62, v44, v45
v_cvt_pk_bf16_f32 v63, v46, v47
v_mfma_f32_16x16x32_bf16 v[44:47], a[144:147], a[208:211], v[92:95]
v_exp_f32 v17, v17
v_mfma_f32_16x16x32_bf16 v[44:47], a[148:151], a[212:215], v[44:47]
v_exp_f32 v18, v18
v_mfma_f32_16x16x32_bf16 v[44:47], a[152:155], a[216:219], v[44:47]
s_waitcnt vmcnt(11) lgkmcnt(0)
v_exp_f32 v19, v19
v_mfma_f32_16x16x32_bf16 v[44:47], a[156:159], a[220:223], v[44:47]
s_barrier
v_cvt_pk_bf16_f32 v64, v16, v17
v_exp_f32 v20, v20
v_exp_f32 v21, v21
v_exp_f32 v22, v22
v_exp_f32 v23, v23
v_exp_f32 v24, v24
v_exp_f32 v25, v25
v_exp_f32 v26, v26
v_exp_f32 v27, v27
v_cvt_pk_bf16_f32 v65, v18, v19
v_cvt_pk_bf16_f32 v68, v20, v21
v_cvt_pk_bf16_f32 v69, v22, v23
s_cmp_lg_u32 s33, 0
s_cbranch_scc1 L_sig_bn1
s_lshl_b32 s8, s6, 2
s_add_u32 s8, s8, 192
s_cmp_lg_u32 s4, 0
s_cbranch_scc1 L_sig_bn1
v_mov_b32 v4, 1
s_mov_b64 exec, 1
buffer_atomic_add v4, off, s[84:87], s8 sc1
s_mov_b64 exec, -1
L_sig_bn1:
s_branch L_att_l1_1
L_att_seven0:
v_mfma_f32_16x16x32_bf16 v[192:195], a[32:35], v[56:59], v[192:195]
v_exp_f32 v30, v30
v_mfma_f32_16x16x32_bf16 v[224:227], a[32:35], v[60:63], v[224:227]
ds_read_b128 a[0:3], v1 offset:8192
v_cvt_pk_bf16_f32 v72, v24, v25
v_mfma_f32_16x16x32_bf16 v[228:231], a[36:39], v[60:63], v[228:231]
ds_read_b128 a[4:7], v1 offset:9216
v_cvt_pk_bf16_f32 v73, v26, v27
v_mfma_f32_16x16x32_bf16 v[196:199], a[36:39], v[56:59], v[196:199]
s_add_u32 m0, s27, 0x0
v_exp_f32 v31, v31
v_mfma_f32_16x16x32_bf16 v[200:203], a[40:43], v[56:59], v[200:203]
ds_read_b128 a[8:11], v1 offset:10240
v_cvt_pk_bf16_f32 v76, v28, v29
v_mfma_f32_16x16x32_bf16 v[232:235], a[40:43], v[60:63], v[232:235]
buffer_load_dwordx4 v3, s[48:51], s32 offen offset:0 sc1 lds
v_mfma_f32_16x16x32_bf16 v[236:239], a[44:47], v[60:63], v[236:239]
v_exp_f32 v40, v40
v_mfma_f32_16x16x32_bf16 v[204:207], a[44:47], v[56:59], v[204:207]
ds_read_b128 a[12:15], v1 offset:11264
v_cvt_pk_bf16_f32 v77, v30, v31
v_mfma_f32_16x16x32_bf16 v[208:211], a[48:51], v[56:59], v[208:211]
ds_read_b128 a[16:19], v1 offset:12288
v_mfma_f32_16x16x32_bf16 v[240:243], a[48:51], v[60:63], v[240:243]
buffer_load_dwordx4 v3, s[48:51], s32 offen offset:1024 sc1 lds
v_mfma_f32_16x16x32_bf16 v[244:247], a[52:55], v[60:63], v[244:247]
ds_read_b128 a[20:23], v1 offset:13312
v_mfma_f32_16x16x32_bf16 v[212:215], a[52:55], v[56:59], v[212:215]
ds_read_b128 a[24:27], v1 offset:14336
v_mfma_f32_16x16x32_bf16 v[216:219], a[56:59], v[56:59], v[216:219]
ds_read_b128 a[28:31], v1 offset:15360
v_mfma_f32_16x16x32_bf16 v[248:251], a[56:59], v[60:63], v[248:251]
ds_read_b128 a[32:35], v1 offset:0
v_exp_f32 v41, v41
v_mfma_f32_16x16x32_bf16 v[252:255], a[60:63], v[60:63], v[252:255]
v_exp_f32 v42, v42
v_mfma_f32_16x16x32_bf16 v[220:223], a[60:63], v[56:59], v[220:223]
s_waitcnt lgkmcnt(5)
v_exp_f32 v43, v43
v_smfmac_f32_16x16x64_bf16 a[228:231], a[232:235], v[56:63], v9
ds_read_b128 a[36:39], v1 offset:1024
v_cvt_pk_bf16_f32 v74, v40, v41
v_mfma_f32_16x16x32_bf16 v[24:27], a[0:3], a[192:195], v[88:91]
ds_read_b128 a[40:43], v1 offset:2048
v_exp_f32 v44, v44
v_mfma_f32_16x16x32_bf16 v[24:27], a[4:7], a[196:199], v[24:27]
buffer_load_dwordx4 v3, s[48:51], s32 offen offset:2048 sc1 lds
v_mfma_f32_16x16x32_bf16 v[24:27], a[8:11], a[200:203], v[24:27]
v_exp_f32 v45, v45
v_mfma_f32_16x16x32_bf16 v[24:27], a[12:15], a[204:207], v[24:27]
ds_read_b128 a[44:47], v1 offset:3072
v_cvt_pk_bf16_f32 v75, v42, v43
v_mfma_f32_16x16x32_bf16 v[28:31], a[0:3], a[208:211], v[92:95]
ds_read_b128 a[48:51], v1 offset:4096
v_exp_f32 v46, v46
v_mfma_f32_16x16x32_bf16 v[28:31], a[4:7], a[212:215], v[28:31]
s_waitcnt lgkmcnt(5)
v_exp_f32 v47, v47
v_mfma_f32_16x16x32_bf16 v[28:31], a[8:11], a[216:219], v[28:31]
ds_read_b128 a[52:55], v1 offset:5120
v_cvt_pk_bf16_f32 v78, v44, v45
v_mfma_f32_16x16x32_bf16 v[28:31], a[12:15], a[220:223], v[28:31]
buffer_load_dwordx4 v3, s[48:51], s32 offen offset:3072 sc1 lds
v_mfma_f32_16x16x32_bf16 v[40:43], a[16:19], a[192:195], v[88:91]
ds_read_b128 a[56:59], v1 offset:6144
s_add_u32 s32, s32, 0x8000
v_mfma_f32_16x16x32_bf16 v[40:43], a[20:23], a[196:199], v[40:43]
ds_read_b128 a[60:63], v1 offset:7168
v_cvt_pk_bf16_f32 v79, v46, v47
v_mfma_f32_16x16x32_bf16 v[40:43], a[24:27], a[200:203], v[40:43]
v_exp_f32 v24, v24
v_mfma_f32_16x16x32_bf16 v[40:43], a[28:31], a[204:207], v[40:43]
v_exp_f32 v25, v25
v_mfma_f32_16x16x32_bf16 v[44:47], a[16:19], a[208:211], v[92:95]
v_exp_f32 v26, v26
v_mfma_f32_16x16x32_bf16 v[44:47], a[20:23], a[212:215], v[44:47]
v_exp_f32 v27, v27
v_mfma_f32_16x16x32_bf16 v[44:47], a[24:27], a[216:219], v[44:47]
v_exp_f32 v28, v28
v_mfma_f32_16x16x32_bf16 v[44:47], a[28:31], a[220:223], v[44:47]
s_waitcnt lgkmcnt(0)
v_exp_f32 v29, v29
v_mfma_f32_16x16x32_bf16 v[192:195], a[32:35], v[72:75], v[192:195]
s_add_u32 m0, s27, 0x1000
v_exp_f32 v30, v30
v_mfma_f32_16x16x32_bf16 v[224:227], a[32:35], v[76:79], v[224:227]
buffer_load_dwordx4 v3, s[48:51], s7 offen offset:0 sc1 lds
v_mfma_f32_16x16x32_bf16 v[228:231], a[36:39], v[76:79], v[228:231]
v_exp_f32 v31, v31
v_mfma_f32_16x16x32_bf16 v[196:199], a[36:39], v[72:75], v[196:199]
ds_read_b128 a[0:3], v1 offset:24576
v_cvt_pk_bf16_f32 v56, v24, v25
v_mfma_f32_16x16x32_bf16 v[200:203], a[40:43], v[72:75], v[200:203]
ds_read_b128 a[4:7], v1 offset:25600
v_cvt_pk_bf16_f32 v57, v26, v27
v_mfma_f32_16x16x32_bf16 v[232:235], a[40:43], v[76:79], v[232:235]
v_exp_f32 v40, v40
v_mfma_f32_16x16x32_bf16 v[236:239], a[44:47], v[76:79], v[236:239]
ds_read_b128 a[8:11], v1 offset:26624
v_cvt_pk_bf16_f32 v60, v28, v29
v_mfma_f32_16x16x32_bf16 v[204:207], a[44:47], v[72:75], v[204:207]
v_exp_f32 v41, v41
v_mfma_f32_16x16x32_bf16 v[208:211], a[48:51], v[72:75], v[208:211]
ds_read_b128 a[12:15], v1 offset:27648
v_cvt_pk_bf16_f32 v61, v30, v31
v_mfma_f32_16x16x32_bf16 v[240:243], a[48:51], v[76:79], v[240:243]
ds_read_b128 a[16:19], v1 offset:28672
v_cvt_pk_bf16_f32 v58, v40, v41
v_mfma_f32_16x16x32_bf16 v[244:247], a[52:55], v[76:79], v[244:247]
v_exp_f32 v42, v42
v_mfma_f32_16x16x32_bf16 v[212:215], a[52:55], v[72:75], v[212:215]
buffer_load_dwordx4 v3, s[48:51], s7 offen offset:1024 sc1 lds
v_mfma_f32_16x16x32_bf16 v[216:219], a[56:59], v[72:75], v[216:219]
ds_read_b128 a[20:23], v1 offset:29696
v_mfma_f32_16x16x32_bf16 v[248:251], a[56:59], v[76:79], v[248:251]
ds_read_b128 a[24:27], v1 offset:30720
v_mfma_f32_16x16x32_bf16 v[252:255], a[60:63], v[76:79], v[252:255]
ds_read_b128 a[28:31], v1 offset:31744
v_mfma_f32_16x16x32_bf16 v[220:223], a[60:63], v[72:75], v[220:223]
s_waitcnt lgkmcnt(4)
v_exp_f32 v43, v43
v_smfmac_f32_16x16x64_bf16 a[228:231], a[232:235], v[72:79], v9
ds_read_b128 a[32:35], v1 offset:16384
v_cvt_pk_bf16_f32 v59, v42, v43
v_mfma_f32_16x16x32_bf16 v[24:27], a[0:3], a[192:195], v[88:91]
ds_read_b128 a[36:39], v1 offset:17408
v_mfma_f32_16x16x32_bf16 v[24:27], a[4:7], a[196:199], v[24:27]
buffer_load_dwordx4 v3, s[48:51], s7 offen offset:2048 sc1 lds
v_mfma_f32_16x16x32_bf16 v[24:27], a[8:11], a[200:203], v[24:27]
ds_read_b128 a[40:43], v1 offset:18432
v_exp_f32 v44, v44
v_mfma_f32_16x16x32_bf16 v[24:27], a[12:15], a[204:207], v[24:27]
ds_read_b128 a[44:47], v1 offset:19456
v_exp_f32 v45, v45
v_mfma_f32_16x16x32_bf16 v[28:31], a[0:3], a[208:211], v[92:95]
ds_read_b128 a[48:51], v1 offset:20480
v_exp_f32 v46, v46
v_mfma_f32_16x16x32_bf16 v[28:31], a[4:7], a[212:215], v[28:31]
s_waitcnt lgkmcnt(5)
v_exp_f32 v47, v47
v_mfma_f32_16x16x32_bf16 v[28:31], a[8:11], a[216:219], v[28:31]
ds_read_b128 a[52:55], v1 offset:21504
v_cvt_pk_bf16_f32 v62, v44, v45
v_mfma_f32_16x16x32_bf16 v[28:31], a[12:15], a[220:223], v[28:31]
ds_read_b128 a[56:59], v1 offset:22528
v_cvt_pk_bf16_f32 v63, v46, v47
v_mfma_f32_16x16x32_bf16 v[40:43], a[16:19], a[192:195], v[88:91]
ds_read_b128 a[60:63], v1 offset:23552
v_xor_b32 v1, 0x8000, v1
v_mfma_f32_16x16x32_bf16 v[40:43], a[20:23], a[196:199], v[40:43]
buffer_load_dwordx4 v3, s[48:51], s7 offen offset:3072 sc1 lds
v_mfma_f32_16x16x32_bf16 v[40:43], a[24:27], a[200:203], v[40:43]
s_add_u32 s7, s7, 0x8000
v_exp_f32 v24, v24
v_mfma_f32_16x16x32_bf16 v[40:43], a[28:31], a[204:207], v[40:43]
s_xor_b32 s27, s27, 0x38000
v_exp_f32 v25, v25
v_mfma_f32_16x16x32_bf16 v[44:47], a[16:19], a[208:211], v[92:95]
v_exp_f32 v26, v26
v_mfma_f32_16x16x32_bf16 v[44:47], a[20:23], a[212:215], v[44:47]
v_exp_f32 v27, v27
v_mfma_f32_16x16x32_bf16 v[44:47], a[24:27], a[216:219], v[44:47]
s_waitcnt vmcnt(16) lgkmcnt(0)
v_exp_f32 v28, v28
v_mfma_f32_16x16x32_bf16 v[44:47], a[28:31], a[220:223], v[44:47]
s_barrier
v_exp_f32 v29, v29
L_att_sodd0:
v_mfma_f32_16x16x32_bf16 v[192:195], a[32:35], v[56:59], v[192:195]
v_exp_f32 v30, v30
v_mfma_f32_16x16x32_bf16 v[224:227], a[32:35], v[60:63], v[224:227]
ds_read_b128 a[0:3], v2 offset:8192
v_cvt_pk_bf16_f32 v72, v24, v25
v_mfma_f32_16x16x32_bf16 v[228:231], a[36:39], v[60:63], v[228:231]
ds_read_b128 a[4:7], v2 offset:9216
v_cvt_pk_bf16_f32 v73, v26, v27
v_mfma_f32_16x16x32_bf16 v[196:199], a[36:39], v[56:59], v[196:199]
s_add_u32 m0, s19, 0x0
v_exp_f32 v31, v31
v_mfma_f32_16x16x32_bf16 v[200:203], a[40:43], v[56:59], v[200:203]
ds_read_b128 a[8:11], v2 offset:10240
v_cvt_pk_bf16_f32 v76, v28, v29
v_mfma_f32_16x16x32_bf16 v[232:235], a[40:43], v[60:63], v[232:235]
buffer_load_dwordx4 v3, s[48:51], s32 offen offset:0 sc1 lds
v_mfma_f32_16x16x32_bf16 v[236:239], a[44:47], v[60:63], v[236:239]
v_exp_f32 v40, v40
v_mfma_f32_16x16x32_bf16 v[204:207], a[44:47], v[56:59], v[204:207]
ds_read_b128 a[12:15], v2 offset:11264
v_cvt_pk_bf16_f32 v77, v30, v31
v_mfma_f32_16x16x32_bf16 v[208:211], a[48:51], v[56:59], v[208:211]
ds_read_b128 a[16:19], v2 offset:12288
v_mfma_f32_16x16x32_bf16 v[240:243], a[48:51], v[60:63], v[240:243]
buffer_load_dwordx4 v3, s[48:51], s32 offen offset:1024 sc1 lds
v_mfma_f32_16x16x32_bf16 v[244:247], a[52:55], v[60:63], v[244:247]
ds_read_b128 a[20:23], v2 offset:13312
v_mfma_f32_16x16x32_bf16 v[212:215], a[52:55], v[56:59], v[212:215]
ds_read_b128 a[24:27], v2 offset:14336
v_mfma_f32_16x16x32_bf16 v[216:219], a[56:59], v[56:59], v[216:219]
ds_read_b128 a[28:31], v2 offset:15360
v_mfma_f32_16x16x32_bf16 v[248:251], a[56:59], v[60:63], v[248:251]
ds_read_b128 a[32:35], v2 offset:0
v_exp_f32 v41, v41
v_mfma_f32_16x16x32_bf16 v[252:255], a[60:63], v[60:63], v[252:255]
v_exp_f32 v42, v42
v_mfma_f32_16x16x32_bf16 v[220:223], a[60:63], v[56:59], v[220:223]
s_waitcnt lgkmcnt(5)
v_exp_f32 v43, v43
v_smfmac_f32_16x16x64_bf16 a[228:231], a[232:235], v[56:63], v9
ds_read_b128 a[36:39], v2 offset:1024
v_cvt_pk_bf16_f32 v74, v40, v41
v_mfma_f32_16x16x32_bf16 v[24:27], a[0:3], a[192:195], v[88:91]
ds_read_b128 a[40:43], v2 offset:2048
v_exp_f32 v44, v44
v_mfma_f32_16x16x32_bf16 v[24:27], a[4:7], a[196:199], v[24:27]
buffer_load_dwordx4 v3, s[48:51], s32 offen offset:2048 sc1 lds
v_mfma_f32_16x16x32_bf16 v[24:27], a[8:11], a[200:203], v[24:27]
v_exp_f32 v45, v45
v_mfma_f32_16x16x32_bf16 v[24:27], a[12:15], a[204:207], v[24:27]
ds_read_b128 a[44:47], v2 offset:3072
v_cvt_pk_bf16_f32 v75, v42, v43
v_mfma_f32_16x16x32_bf16 v[28:31], a[0:3], a[208:211], v[92:95]
ds_read_b128 a[48:51], v2 offset:4096
v_exp_f32 v46, v46
v_mfma_f32_16x16x32_bf16 v[28:31], a[4:7], a[212:215], v[28:31]
s_waitcnt lgkmcnt(5)
v_exp_f32 v47, v47
v_mfma_f32_16x16x32_bf16 v[28:31], a[8:11], a[216:219], v[28:31]
ds_read_b128 a[52:55], v2 offset:5120
v_cvt_pk_bf16_f32 v78, v44, v45
v_mfma_f32_16x16x32_bf16 v[28:31], a[12:15], a[220:223], v[28:31]
buffer_load_dwordx4 v3, s[48:51], s32 offen offset:3072 sc1 lds
v_mfma_f32_16x16x32_bf16 v[40:43], a[16:19], a[192:195], v[88:91]
ds_read_b128 a[56:59], v2 offset:6144
s_add_u32 s32, s32, 0x8000
v_mfma_f32_16x16x32_bf16 v[40:43], a[20:23], a[196:199], v[40:43]
ds_read_b128 a[60:63], v2 offset:7168
v_cvt_pk_bf16_f32 v79, v46, v47
v_mfma_f32_16x16x32_bf16 v[40:43], a[24:27], a[200:203], v[40:43]
v_exp_f32 v24, v24
v_mfma_f32_16x16x32_bf16 v[40:43], a[28:31], a[204:207], v[40:43]
v_exp_f32 v25, v25
v_mfma_f32_16x16x32_bf16 v[44:47], a[16:19], a[208:211], v[92:95]
v_exp_f32 v26, v26
v_mfma_f32_16x16x32_bf16 v[44:47], a[20:23], a[212:215], v[44:47]
v_exp_f32 v27, v27
v_mfma_f32_16x16x32_bf16 v[44:47], a[24:27], a[216:219], v[44:47]
v_exp_f32 v28, v28
v_mfma_f32_16x16x32_bf16 v[44:47], a[28:31], a[220:223], v[44:47]
s_waitcnt lgkmcnt(0)
v_exp_f32 v29, v29
v_mfma_f32_16x16x32_bf16 v[192:195], a[32:35], v[72:75], v[192:195]
v_exp_f32 v30, v30
v_mfma_f32_16x16x32_bf16 v[224:227], a[32:35], v[76:79], v[224:227]
v_exp_f32 v31, v31
v_mfma_f32_16x16x32_bf16 v[228:231], a[36:39], v[76:79], v[228:231]
v_exp_f32 v40, v40
v_mfma_f32_16x16x32_bf16 v[196:199], a[36:39], v[72:75], v[196:199]
s_add_u32 m0, s19, 0x1000
v_exp_f32 v41, v41
v_mfma_f32_16x16x32_bf16 v[200:203], a[40:43], v[72:75], v[200:203]
ds_read_b128 a[0:3], v2 offset:24576
v_cvt_pk_bf16_f32 v56, v24, v25
v_mfma_f32_16x16x32_bf16 v[232:235], a[40:43], v[76:79], v[232:235]
buffer_load_dwordx4 v3, s[48:51], s7 offen offset:0 sc1 lds
v_mfma_f32_16x16x32_bf16 v[236:239], a[44:47], v[76:79], v[236:239]
ds_read_b128 a[4:7], v2 offset:25600
v_cvt_pk_bf16_f32 v57, v26, v27
v_mfma_f32_16x16x32_bf16 v[204:207], a[44:47], v[72:75], v[204:207]
ds_read_b128 a[8:11], v2 offset:26624
v_cvt_pk_bf16_f32 v60, v28, v29
v_mfma_f32_16x16x32_bf16 v[208:211], a[48:51], v[72:75], v[208:211]
ds_read_b128 a[12:15], v2 offset:27648
v_cvt_pk_bf16_f32 v61, v30, v31
v_mfma_f32_16x16x32_bf16 v[240:243], a[48:51], v[76:79], v[240:243]
ds_read_b128 a[16:19], v2 offset:28672
v_cvt_pk_bf16_f32 v58, v40, v41
v_mfma_f32_16x16x32_bf16 v[244:247], a[52:55], v[76:79], v[244:247]
buffer_load_dwordx4 v3, s[48:51], s7 offen offset:1024 sc1 lds
v_mfma_f32_16x16x32_bf16 v[212:215], a[52:55], v[72:75], v[212:215]
ds_read_b128 a[20:23], v2 offset:29696
v_mfma_f32_16x16x32_bf16 v[216:219], a[56:59], v[72:75], v[216:219]
v_exp_f32 v42, v42
v_mfma_f32_16x16x32_bf16 v[248:251], a[56:59], v[76:79], v[248:251]
ds_read_b128 a[24:27], v2 offset:30720
v_mfma_f32_16x16x32_bf16 v[252:255], a[60:63], v[76:79], v[252:255]
ds_read_b128 a[28:31], v2 offset:31744
v_exp_f32 v43, v43
v_mfma_f32_16x16x32_bf16 v[220:223], a[60:63], v[72:75], v[220:223]
ds_read_b128 a[32:35], v2 offset:16384
v_cvt_pk_bf16_f32 v59, v42, v43
v_smfmac_f32_16x16x64_bf16 a[228:231], a[232:235], v[72:79], v9
ds_read_b128 a[36:39], v2 offset:17408
s_waitcnt lgkmcnt(6)
v_mfma_f32_16x16x32_bf16 v[24:27], a[0:3], a[192:195], v[88:91]
buffer_load_dwordx4 v3, s[48:51], s7 offen offset:2048 sc1 lds
v_mfma_f32_16x16x32_bf16 v[24:27], a[4:7], a[196:199], v[24:27]
ds_read_b128 a[40:43], v2 offset:18432
v_exp_f32 v44, v44
v_mfma_f32_16x16x32_bf16 v[24:27], a[8:11], a[200:203], v[24:27]
ds_read_b128 a[44:47], v2 offset:19456
v_exp_f32 v45, v45
v_mfma_f32_16x16x32_bf16 v[24:27], a[12:15], a[204:207], v[24:27]
ds_read_b128 a[48:51], v2 offset:20480
v_cvt_pk_bf16_f32 v62, v44, v45
v_mfma_f32_16x16x32_bf16 v[28:31], a[0:3], a[208:211], v[92:95]
v_exp_f32 v46, v46
v_mfma_f32_16x16x32_bf16 v[28:31], a[4:7], a[212:215], v[28:31]
s_waitcnt lgkmcnt(5)
v_exp_f32 v47, v47
v_mfma_f32_16x16x32_bf16 v[28:31], a[8:11], a[216:219], v[28:31]
ds_read_b128 a[52:55], v2 offset:21504
v_cvt_pk_bf16_f32 v63, v46, v47
v_mfma_f32_16x16x32_bf16 v[28:31], a[12:15], a[220:223], v[28:31]
buffer_load_dwordx4 v3, s[48:51], s7 offen offset:3072 sc1 lds
v_mfma_f32_16x16x32_bf16 v[40:43], a[16:19], a[192:195], v[88:91]
ds_read_b128 a[56:59], v2 offset:22528
s_add_u32 s7, s7, 0x8000
v_mfma_f32_16x16x32_bf16 v[40:43], a[20:23], a[196:199], v[40:43]
ds_read_b128 a[60:63], v2 offset:23552
v_xor_b32 v2, 0x38000, v2
v_mfma_f32_16x16x32_bf16 v[40:43], a[24:27], a[200:203], v[40:43]
s_xor_b32 s19, s19, 0x8000
v_exp_f32 v24, v24
v_mfma_f32_16x16x32_bf16 v[40:43], a[28:31], a[204:207], v[40:43]
s_sub_u32 s15, s15, 1
v_exp_f32 v25, v25
v_mfma_f32_16x16x32_bf16 v[44:47], a[16:19], a[208:211], v[92:95]
s_cmp_lg_u32 s15, 0
v_exp_f32 v26, v26
v_mfma_f32_16x16x32_bf16 v[44:47], a[20:23], a[212:215], v[44:47]
v_exp_f32 v27, v27
v_mfma_f32_16x16x32_bf16 v[44:47], a[24:27], a[216:219], v[44:47]
s_waitcnt vmcnt(16) lgkmcnt(0)
v_exp_f32 v28, v28
v_mfma_f32_16x16x32_bf16 v[44:47], a[28:31], a[220:223], v[44:47]
s_barrier
v_exp_f32 v29, v29
s_cbranch_scc1 L_att_seven0
s_branch L_att_sdone
L_att_seven1:
v_mfma_f32_16x16x32_bf16 v[192:195], a[32:35], v[56:59], v[192:195]
v_exp_f32 v30, v30
v_mfma_f32_16x16x32_bf16 v[224:227], a[32:35], v[60:63], v[224:227]
ds_read_b128 a[0:3], v1 offset:8192
v_cvt_pk_bf16_f32 v72, v24, v25
v_mfma_f32_16x16x32_bf16 v[228:231], a[36:39], v[60:63], v[228:231]
ds_read_b128 a[4:7], v1 offset:9216
v_cvt_pk_bf16_f32 v73, v26, v27
v_mfma_f32_16x16x32_bf16 v[196:199], a[36:39], v[56:59], v[196:199]
s_add_u32 m0, s27, 0x0
v_exp_f32 v31, v31
v_mfma_f32_16x16x32_bf16 v[200:203], a[40:43], v[56:59], v[200:203]
ds_read_b128 a[8:11], v1 offset:10240
v_cvt_pk_bf16_f32 v76, v28, v29
v_mfma_f32_16x16x32_bf16 v[232:235], a[40:43], v[60:63], v[232:235]
buffer_load_dwordx4 v3, s[48:51], s32 offen offset:0 sc1 lds
v_mfma_f32_16x16x32_bf16 v[236:239], a[44:47], v[60:63], v[236:239]
v_exp_f32 v40, v40
v_mfma_f32_16x16x32_bf16 v[204:207], a[44:47], v[56:59], v[204:207]
ds_read_b128 a[12:15], v1 offset:11264
v_cvt_pk_bf16_f32 v77, v30, v31
v_mfma_f32_16x16x32_bf16 v[208:211], a[48:51], v[56:59], v[208:211]
ds_read_b128 a[16:19], v1 offset:12288
v_mfma_f32_16x16x32_bf16 v[240:243], a[48:51], v[60:63], v[240:243]
buffer_load_dwordx4 v3, s[48:51], s32 offen offset:1024 sc1 lds
v_mfma_f32_16x16x32_bf16 v[244:247], a[52:55], v[60:63], v[244:247]
ds_read_b128 a[20:23], v1 offset:13312
v_mfma_f32_16x16x32_bf16 v[212:215], a[52:55], v[56:59], v[212:215]
ds_read_b128 a[24:27], v1 offset:14336
v_mfma_f32_16x16x32_bf16 v[216:219], a[56:59], v[56:59], v[216:219]
ds_read_b128 a[28:31], v1 offset:15360
v_mfma_f32_16x16x32_bf16 v[248:251], a[56:59], v[60:63], v[248:251]
ds_read_b128 a[32:35], v1 offset:0
v_exp_f32 v41, v41
v_mfma_f32_16x16x32_bf16 v[252:255], a[60:63], v[60:63], v[252:255]
v_exp_f32 v42, v42
v_mfma_f32_16x16x32_bf16 v[220:223], a[60:63], v[56:59], v[220:223]
s_waitcnt lgkmcnt(5)
v_exp_f32 v43, v43
v_smfmac_f32_16x16x64_bf16 a[228:231], a[232:235], v[56:63], v9
ds_read_b128 a[36:39], v1 offset:1024
v_cvt_pk_bf16_f32 v74, v40, v41
v_mfma_f32_16x16x32_bf16 v[24:27], a[0:3], a[192:195], v[88:91]
ds_read_b128 a[40:43], v1 offset:2048
v_exp_f32 v44, v44
v_mfma_f32_16x16x32_bf16 v[24:27], a[4:7], a[196:199], v[24:27]
buffer_load_dwordx4 v3, s[48:51], s32 offen offset:2048 sc1 lds
v_mfma_f32_16x16x32_bf16 v[24:27], a[8:11], a[200:203], v[24:27]
v_exp_f32 v45, v45
v_mfma_f32_16x16x32_bf16 v[24:27], a[12:15], a[204:207], v[24:27]
ds_read_b128 a[44:47], v1 offset:3072
v_cvt_pk_bf16_f32 v75, v42, v43
v_mfma_f32_16x16x32_bf16 v[28:31], a[0:3], a[208:211], v[92:95]
ds_read_b128 a[48:51], v1 offset:4096
v_exp_f32 v46, v46
v_mfma_f32_16x16x32_bf16 v[28:31], a[4:7], a[212:215], v[28:31]
s_waitcnt lgkmcnt(5)
v_exp_f32 v47, v47
v_mfma_f32_16x16x32_bf16 v[28:31], a[8:11], a[216:219], v[28:31]
ds_read_b128 a[52:55], v1 offset:5120
v_cvt_pk_bf16_f32 v78, v44, v45
v_mfma_f32_16x16x32_bf16 v[28:31], a[12:15], a[220:223], v[28:31]
buffer_load_dwordx4 v3, s[48:51], s32 offen offset:3072 sc1 lds
v_mfma_f32_16x16x32_bf16 v[40:43], a[16:19], a[192:195], v[88:91]
ds_read_b128 a[56:59], v1 offset:6144
s_add_u32 s32, s32, 0x8000
v_mfma_f32_16x16x32_bf16 v[40:43], a[20:23], a[196:199], v[40:43]
ds_read_b128 a[60:63], v1 offset:7168
v_cvt_pk_bf16_f32 v79, v46, v47
v_mfma_f32_16x16x32_bf16 v[40:43], a[24:27], a[200:203], v[40:43]
v_exp_f32 v24, v24
v_mfma_f32_16x16x32_bf16 v[40:43], a[28:31], a[204:207], v[40:43]
v_exp_f32 v25, v25
v_mfma_f32_16x16x32_bf16 v[44:47], a[16:19], a[208:211], v[92:95]
v_exp_f32 v26, v26
v_mfma_f32_16x16x32_bf16 v[44:47], a[20:23], a[212:215], v[44:47]
v_exp_f32 v27, v27
v_mfma_f32_16x16x32_bf16 v[44:47], a[24:27], a[216:219], v[44:47]
v_exp_f32 v28, v28
v_mfma_f32_16x16x32_bf16 v[44:47], a[28:31], a[220:223], v[44:47]
s_waitcnt lgkmcnt(0)
v_exp_f32 v29, v29
v_mfma_f32_16x16x32_bf16 v[192:195], a[32:35], v[72:75], v[192:195]
s_add_u32 m0, s27, 0x1000
v_exp_f32 v30, v30
v_mfma_f32_16x16x32_bf16 v[224:227], a[32:35], v[76:79], v[224:227]
buffer_load_dwordx4 v3, s[48:51], s7 offen offset:0 sc1 lds
v_mfma_f32_16x16x32_bf16 v[228:231], a[36:39], v[76:79], v[228:231]
v_exp_f32 v31, v31
v_mfma_f32_16x16x32_bf16 v[196:199], a[36:39], v[72:75], v[196:199]
ds_read_b128 a[0:3], v1 offset:24576
v_cvt_pk_bf16_f32 v56, v24, v25
v_mfma_f32_16x16x32_bf16 v[200:203], a[40:43], v[72:75], v[200:203]
ds_read_b128 a[4:7], v1 offset:25600
v_cvt_pk_bf16_f32 v57, v26, v27
v_mfma_f32_16x16x32_bf16 v[232:235], a[40:43], v[76:79], v[232:235]
v_exp_f32 v40, v40
v_mfma_f32_16x16x32_bf16 v[236:239], a[44:47], v[76:79], v[236:239]
ds_read_b128 a[8:11], v1 offset:26624
v_cvt_pk_bf16_f32 v60, v28, v29
v_mfma_f32_16x16x32_bf16 v[204:207], a[44:47], v[72:75], v[204:207]
v_exp_f32 v41, v41
v_mfma_f32_16x16x32_bf16 v[208:211], a[48:51], v[72:75], v[208:211]
ds_read_b128 a[12:15], v1 offset:27648
v_cvt_pk_bf16_f32 v61, v30, v31
v_mfma_f32_16x16x32_bf16 v[240:243], a[48:51], v[76:79], v[240:243]
ds_read_b128 a[16:19], v1 offset:28672
v_cvt_pk_bf16_f32 v58, v40, v41
v_mfma_f32_16x16x32_bf16 v[244:247], a[52:55], v[76:79], v[244:247]
v_exp_f32 v42, v42
v_mfma_f32_16x16x32_bf16 v[212:215], a[52:55], v[72:75], v[212:215]
buffer_load_dwordx4 v3, s[48:51], s7 offen offset:1024 sc1 lds
v_mfma_f32_16x16x32_bf16 v[216:219], a[56:59], v[72:75], v[216:219]
ds_read_b128 a[20:23], v1 offset:29696
v_mfma_f32_16x16x32_bf16 v[248:251], a[56:59], v[76:79], v[248:251]
ds_read_b128 a[24:27], v1 offset:30720
v_mfma_f32_16x16x32_bf16 v[252:255], a[60:63], v[76:79], v[252:255]
ds_read_b128 a[28:31], v1 offset:31744
v_mfma_f32_16x16x32_bf16 v[220:223], a[60:63], v[72:75], v[220:223]
s_waitcnt lgkmcnt(4)
v_exp_f32 v43, v43
v_smfmac_f32_16x16x64_bf16 a[228:231], a[232:235], v[72:79], v9
ds_read_b128 a[32:35], v1 offset:16384
v_cvt_pk_bf16_f32 v59, v42, v43
v_mfma_f32_16x16x32_bf16 v[24:27], a[0:3], a[192:195], v[88:91]
ds_read_b128 a[36:39], v1 offset:17408
v_mfma_f32_16x16x32_bf16 v[24:27], a[4:7], a[196:199], v[24:27]
buffer_load_dwordx4 v3, s[48:51], s7 offen offset:2048 sc1 lds
v_mfma_f32_16x16x32_bf16 v[24:27], a[8:11], a[200:203], v[24:27]
ds_read_b128 a[40:43], v1 offset:18432
v_exp_f32 v44, v44
v_mfma_f32_16x16x32_bf16 v[24:27], a[12:15], a[204:207], v[24:27]
ds_read_b128 a[44:47], v1 offset:19456
v_exp_f32 v45, v45
v_mfma_f32_16x16x32_bf16 v[28:31], a[0:3], a[208:211], v[92:95]
ds_read_b128 a[48:51], v1 offset:20480
v_exp_f32 v46, v46
v_mfma_f32_16x16x32_bf16 v[28:31], a[4:7], a[212:215], v[28:31]
s_waitcnt lgkmcnt(5)
v_exp_f32 v47, v47
v_mfma_f32_16x16x32_bf16 v[28:31], a[8:11], a[216:219], v[28:31]
ds_read_b128 a[52:55], v1 offset:21504
v_cvt_pk_bf16_f32 v62, v44, v45
v_mfma_f32_16x16x32_bf16 v[28:31], a[12:15], a[220:223], v[28:31]
ds_read_b128 a[56:59], v1 offset:22528
v_cvt_pk_bf16_f32 v63, v46, v47
v_mfma_f32_16x16x32_bf16 v[40:43], a[16:19], a[192:195], v[88:91]
ds_read_b128 a[60:63], v1 offset:23552
v_xor_b32 v1, 0x8000, v1
v_mfma_f32_16x16x32_bf16 v[40:43], a[20:23], a[196:199], v[40:43]
buffer_load_dwordx4 v3, s[48:51], s7 offen offset:3072 sc1 lds
v_mfma_f32_16x16x32_bf16 v[40:43], a[24:27], a[200:203], v[40:43]
s_add_u32 s7, s7, 0x8000
v_exp_f32 v24, v24
v_mfma_f32_16x16x32_bf16 v[40:43], a[28:31], a[204:207], v[40:43]
s_xor_b32 s27, s27, 0x38000
v_exp_f32 v25, v25
v_mfma_f32_16x16x32_bf16 v[44:47], a[16:19], a[208:211], v[92:95]
s_waitcnt vmcnt(16) lgkmcnt(0)
v_exp_f32 v26, v26
v_mfma_f32_16x16x32_bf16 v[44:47], a[20:23], a[212:215], v[44:47]
s_barrier
v_exp_f32 v27, v27
v_mfma_f32_16x16x32_bf16 v[44:47], a[24:27], a[216:219], v[44:47]
v_exp_f32 v28, v28
v_mfma_f32_16x16x32_bf16 v[44:47], a[28:31], a[220:223], v[44:47]
v_exp_f32 v29, v29
L_att_sodd1:
v_mfma_f32_16x16x32_bf16 v[192:195], a[32:35], v[56:59], v[192:195]
v_exp_f32 v30, v30
v_mfma_f32_16x16x32_bf16 v[224:227], a[32:35], v[60:63], v[224:227]
ds_read_b128 a[0:3], v2 offset:8192
v_cvt_pk_bf16_f32 v72, v24, v25
v_mfma_f32_16x16x32_bf16 v[228:231], a[36:39], v[60:63], v[228:231]
ds_read_b128 a[4:7], v2 offset:9216
v_cvt_pk_bf16_f32 v73, v26, v27
v_mfma_f32_16x16x32_bf16 v[196:199], a[36:39], v[56:59], v[196:199]
s_add_u32 m0, s19, 0x0
v_exp_f32 v31, v31
v_mfma_f32_16x16x32_bf16 v[200:203], a[40:43], v[56:59], v[200:203]
ds_read_b128 a[8:11], v2 offset:10240
v_cvt_pk_bf16_f32 v76, v28, v29
v_mfma_f32_16x16x32_bf16 v[232:235], a[40:43], v[60:63], v[232:235]
buffer_load_dwordx4 v3, s[48:51], s32 offen offset:0 sc1 lds
v_mfma_f32_16x16x32_bf16 v[236:239], a[44:47], v[60:63], v[236:239]
v_exp_f32 v40, v40
v_mfma_f32_16x16x32_bf16 v[204:207], a[44:47], v[56:59], v[204:207]
ds_read_b128 a[12:15], v2 offset:11264
v_cvt_pk_bf16_f32 v77, v30, v31
v_mfma_f32_16x16x32_bf16 v[208:211], a[48:51], v[56:59], v[208:211]
ds_read_b128 a[16:19], v2 offset:12288
v_mfma_f32_16x16x32_bf16 v[240:243], a[48:51], v[60:63], v[240:243]
buffer_load_dwordx4 v3, s[48:51], s32 offen offset:1024 sc1 lds
v_mfma_f32_16x16x32_bf16 v[244:247], a[52:55], v[60:63], v[244:247]
ds_read_b128 a[20:23], v2 offset:13312
v_mfma_f32_16x16x32_bf16 v[212:215], a[52:55], v[56:59], v[212:215]
ds_read_b128 a[24:27], v2 offset:14336
v_mfma_f32_16x16x32_bf16 v[216:219], a[56:59], v[56:59], v[216:219]
ds_read_b128 a[28:31], v2 offset:15360
v_mfma_f32_16x16x32_bf16 v[248:251], a[56:59], v[60:63], v[248:251]
ds_read_b128 a[32:35], v2 offset:0
v_exp_f32 v41, v41
v_mfma_f32_16x16x32_bf16 v[252:255], a[60:63], v[60:63], v[252:255]
v_exp_f32 v42, v42
v_mfma_f32_16x16x32_bf16 v[220:223], a[60:63], v[56:59], v[220:223]
s_waitcnt lgkmcnt(5)
v_exp_f32 v43, v43
v_smfmac_f32_16x16x64_bf16 a[228:231], a[232:235], v[56:63], v9
ds_read_b128 a[36:39], v2 offset:1024
v_cvt_pk_bf16_f32 v74, v40, v41
v_mfma_f32_16x16x32_bf16 v[24:27], a[0:3], a[192:195], v[88:91]
ds_read_b128 a[40:43], v2 offset:2048
v_exp_f32 v44, v44
v_mfma_f32_16x16x32_bf16 v[24:27], a[4:7], a[196:199], v[24:27]
buffer_load_dwordx4 v3, s[48:51], s32 offen offset:2048 sc1 lds
v_mfma_f32_16x16x32_bf16 v[24:27], a[8:11], a[200:203], v[24:27]
v_exp_f32 v45, v45
v_mfma_f32_16x16x32_bf16 v[24:27], a[12:15], a[204:207], v[24:27]
ds_read_b128 a[44:47], v2 offset:3072
v_cvt_pk_bf16_f32 v75, v42, v43
v_mfma_f32_16x16x32_bf16 v[28:31], a[0:3], a[208:211], v[92:95]
ds_read_b128 a[48:51], v2 offset:4096
v_exp_f32 v46, v46
v_mfma_f32_16x16x32_bf16 v[28:31], a[4:7], a[212:215], v[28:31]
s_waitcnt lgkmcnt(5)
v_exp_f32 v47, v47
v_mfma_f32_16x16x32_bf16 v[28:31], a[8:11], a[216:219], v[28:31]
ds_read_b128 a[52:55], v2 offset:5120
v_cvt_pk_bf16_f32 v78, v44, v45
v_mfma_f32_16x16x32_bf16 v[28:31], a[12:15], a[220:223], v[28:31]
buffer_load_dwordx4 v3, s[48:51], s32 offen offset:3072 sc1 lds
v_mfma_f32_16x16x32_bf16 v[40:43], a[16:19], a[192:195], v[88:91]
ds_read_b128 a[56:59], v2 offset:6144
s_add_u32 s32, s32, 0x8000
v_mfma_f32_16x16x32_bf16 v[40:43], a[20:23], a[196:199], v[40:43]
ds_read_b128 a[60:63], v2 offset:7168
v_cvt_pk_bf16_f32 v79, v46, v47
v_mfma_f32_16x16x32_bf16 v[40:43], a[24:27], a[200:203], v[40:43]
v_exp_f32 v24, v24
v_mfma_f32_16x16x32_bf16 v[40:43], a[28:31], a[204:207], v[40:43]
v_exp_f32 v25, v25
v_mfma_f32_16x16x32_bf16 v[44:47], a[16:19], a[208:211], v[92:95]
v_exp_f32 v26, v26
v_mfma_f32_16x16x32_bf16 v[44:47], a[20:23], a[212:215], v[44:47]
v_exp_f32 v27, v27
v_mfma_f32_16x16x32_bf16 v[44:47], a[24:27], a[216:219], v[44:47]
v_exp_f32 v28, v28
v_mfma_f32_16x16x32_bf16 v[44:47], a[28:31], a[220:223], v[44:47]
s_waitcnt lgkmcnt(0)
v_exp_f32 v29, v29
v_mfma_f32_16x16x32_bf16 v[192:195], a[32:35], v[72:75], v[192:195]
v_exp_f32 v30, v30
v_mfma_f32_16x16x32_bf16 v[224:227], a[32:35], v[76:79], v[224:227]
v_exp_f32 v31, v31
v_mfma_f32_16x16x32_bf16 v[228:231], a[36:39], v[76:79], v[228:231]
v_exp_f32 v40, v40
v_mfma_f32_16x16x32_bf16 v[196:199], a[36:39], v[72:75], v[196:199]
s_add_u32 m0, s19, 0x1000
v_exp_f32 v41, v41
v_mfma_f32_16x16x32_bf16 v[200:203], a[40:43], v[72:75], v[200:203]
ds_read_b128 a[0:3], v2 offset:24576
v_cvt_pk_bf16_f32 v56, v24, v25
v_mfma_f32_16x16x32_bf16 v[232:235], a[40:43], v[76:79], v[232:235]
buffer_load_dwordx4 v3, s[48:51], s7 offen offset:0 sc1 lds
v_mfma_f32_16x16x32_bf16 v[236:239], a[44:47], v[76:79], v[236:239]
ds_read_b128 a[4:7], v2 offset:25600
v_cvt_pk_bf16_f32 v57, v26, v27
v_mfma_f32_16x16x32_bf16 v[204:207], a[44:47], v[72:75], v[204:207]
ds_read_b128 a[8:11], v2 offset:26624
v_cvt_pk_bf16_f32 v60, v28, v29
v_mfma_f32_16x16x32_bf16 v[208:211], a[48:51], v[72:75], v[208:211]
ds_read_b128 a[12:15], v2 offset:27648
v_cvt_pk_bf16_f32 v61, v30, v31
v_mfma_f32_16x16x32_bf16 v[240:243], a[48:51], v[76:79], v[240:243]
ds_read_b128 a[16:19], v2 offset:28672
v_cvt_pk_bf16_f32 v58, v40, v41
v_mfma_f32_16x16x32_bf16 v[244:247], a[52:55], v[76:79], v[244:247]
buffer_load_dwordx4 v3, s[48:51], s7 offen offset:1024 sc1 lds
v_mfma_f32_16x16x32_bf16 v[212:215], a[52:55], v[72:75], v[212:215]
ds_read_b128 a[20:23], v2 offset:29696
v_mfma_f32_16x16x32_bf16 v[216:219], a[56:59], v[72:75], v[216:219]
v_exp_f32 v42, v42
v_mfma_f32_16x16x32_bf16 v[248:251], a[56:59], v[76:79], v[248:251]
ds_read_b128 a[24:27], v2 offset:30720
v_mfma_f32_16x16x32_bf16 v[252:255], a[60:63], v[76:79], v[252:255]
ds_read_b128 a[28:31], v2 offset:31744
v_exp_f32 v43, v43
v_mfma_f32_16x16x32_bf16 v[220:223], a[60:63], v[72:75], v[220:223]
ds_read_b128 a[32:35], v2 offset:16384
v_cvt_pk_bf16_f32 v59, v42, v43
v_smfmac_f32_16x16x64_bf16 a[228:231], a[232:235], v[72:79], v9
ds_read_b128 a[36:39], v2 offset:17408
s_waitcnt lgkmcnt(6)
v_mfma_f32_16x16x32_bf16 v[24:27], a[0:3], a[192:195], v[88:91]
buffer_load_dwordx4 v3, s[48:51], s7 offen offset:2048 sc1 lds
v_mfma_f32_16x16x32_bf16 v[24:27], a[4:7], a[196:199], v[24:27]
ds_read_b128 a[40:43], v2 offset:18432
v_exp_f32 v44, v44
v_mfma_f32_16x16x32_bf16 v[24:27], a[8:11], a[200:203], v[24:27]
ds_read_b128 a[44:47], v2 offset:19456
v_exp_f32 v45, v45
v_mfma_f32_16x16x32_bf16 v[24:27], a[12:15], a[204:207], v[24:27]
ds_read_b128 a[48:51], v2 offset:20480
v_cvt_pk_bf16_f32 v62, v44, v45
v_mfma_f32_16x16x32_bf16 v[28:31], a[0:3], a[208:211], v[92:95]
v_exp_f32 v46, v46
v_mfma_f32_16x16x32_bf16 v[28:31], a[4:7], a[212:215], v[28:31]
s_waitcnt lgkmcnt(5)
v_exp_f32 v47, v47
v_mfma_f32_16x16x32_bf16 v[28:31], a[8:11], a[216:219], v[28:31]
ds_read_b128 a[52:55], v2 offset:21504
v_cvt_pk_bf16_f32 v63, v46, v47
v_mfma_f32_16x16x32_bf16 v[28:31], a[12:15], a[220:223], v[28:31]
buffer_load_dwordx4 v3, s[48:51], s7 offen offset:3072 sc1 lds
v_mfma_f32_16x16x32_bf16 v[40:43], a[16:19], a[192:195], v[88:91]
ds_read_b128 a[56:59], v2 offset:22528
s_add_u32 s7, s7, 0x8000
v_mfma_f32_16x16x32_bf16 v[40:43], a[20:23], a[196:199], v[40:43]
ds_read_b128 a[60:63], v2 offset:23552
v_xor_b32 v2, 0x38000, v2
v_mfma_f32_16x16x32_bf16 v[40:43], a[24:27], a[200:203], v[40:43]
s_xor_b32 s19, s19, 0x8000
v_exp_f32 v24, v24
v_mfma_f32_16x16x32_bf16 v[40:43], a[28:31], a[204:207], v[40:43]
s_sub_u32 s15, s15, 1
v_exp_f32 v25, v25
v_mfma_f32_16x16x32_bf16 v[44:47], a[16:19], a[208:211], v[92:95]
s_cmp_lg_u32 s15, 0
s_waitcnt vmcnt(16) lgkmcnt(0)
v_exp_f32 v26, v26
v_mfma_f32_16x16x32_bf16 v[44:47], a[20:23], a[212:215], v[44:47]
s_barrier
v_exp_f32 v27, v27
v_mfma_f32_16x16x32_bf16 v[44:47], a[24:27], a[216:219], v[44:47]
v_exp_f32 v28, v28
v_mfma_f32_16x16x32_bf16 v[44:47], a[28:31], a[220:223], v[44:47]
v_exp_f32 v29, v29
s_cbranch_scc1 L_att_seven1
L_att_sdone:
s_cmp_ge_u32 s4, 2
s_cbranch_scc1 L_att_sh0_1
L_att_sh0_0:
v_mfma_f32_16x16x32_bf16 v[192:195], a[32:35], v[56:59], v[192:195]
v_exp_f32 v30, v30
v_mfma_f32_16x16x32_bf16 v[224:227], a[32:35], v[60:63], v[224:227]
buffer_load_dword v14, v15, s[84:87], 0 offen offset:192 sc1
v_mfma_f32_16x16x32_bf16 v[228:231], a[36:39], v[60:63], v[228:231]
v_exp_f32 v31, v31
v_mfma_f32_16x16x32_bf16 v[196:199], a[36:39], v[56:59], v[196:199]
s_add_u32 m0, s17, 0x10000
v_exp_f32 v40, v40
v_mfma_f32_16x16x32_bf16 v[200:203], a[40:43], v[56:59], v[200:203]
ds_read_b128 a[0:3], v1 offset:8192
v_cvt_pk_bf16_f32 v72, v24, v25
v_mfma_f32_16x16x32_bf16 v[232:235], a[40:43], v[60:63], v[232:235]
ds_read_b128 a[4:7], v1 offset:9216
v_cvt_pk_bf16_f32 v73, v26, v27
v_mfma_f32_16x16x32_bf16 v[236:239], a[44:47], v[60:63], v[236:239]
buffer_load_dwordx4 v12, s[72:75], 0 offen lds
v_mfma_f32_16x16x32_bf16 v[204:207], a[44:47], v[56:59], v[204:207]
ds_read_b128 a[8:11], v1 offset:10240
v_cvt_pk_bf16_f32 v76, v28, v29
v_mfma_f32_16x16x32_bf16 v[208:211], a[48:51], v[56:59], v[208:211]
buffer_load_dwordx4 v13, s[72:75], 0 offen offset:1024 lds
v_mfma_f32_16x16x32_bf16 v[240:243], a[48:51], v[60:63], v[240:243]
ds_read_b128 a[12:15], v1 offset:11264
v_cvt_pk_bf16_f32 v77, v30, v31
v_mfma_f32_16x16x32_bf16 v[244:247], a[52:55], v[60:63], v[244:247]
buffer_load_dwordx4 v12, s[72:75], s12 offen offset:2048 lds
v_mfma_f32_16x16x32_bf16 v[212:215], a[52:55], v[56:59], v[212:215]
ds_read_b128 a[16:19], v1 offset:12288
v_exp_f32 v41, v41
v_mfma_f32_16x16x32_bf16 v[216:219], a[56:59], v[56:59], v[216:219]
ds_read_b128 a[20:23], v1 offset:13312
v_exp_f32 v42, v42
v_mfma_f32_16x16x32_bf16 v[248:251], a[56:59], v[60:63], v[248:251]
buffer_load_dwordx4 v13, s[72:75], s12 offen offset:3072 lds
v_mfma_f32_16x16x32_bf16 v[252:255], a[60:63], v[60:63], v[252:255]
ds_read_b128 a[24:27], v1 offset:14336
s_waitcnt lgkmcnt(3)
v_mfma_f32_16x16x32_bf16 v[220:223], a[60:63], v[56:59], v[220:223]
ds_read_b128 a[28:31], v1 offset:15360
v_add_u32 v12, 0x20000, v12
v_smfmac_f32_16x16x64_bf16 a[228:231], a[232:235], v[56:63], v9
s_add_u32 m0, s17, 0x14000
v_exp_f32 v43, v43
v_mfma_f32_16x16x32_bf16 v[24:27], a[0:3], a[192:195], v[112:115]
buffer_load_dwordx4 v12, s[72:75], 0 offen lds
v_mfma_f32_16x16x32_bf16 v[24:27], a[4:7], a[196:199], v[24:27]
ds_read_b128 a[32:35], v1 offset:0
v_cvt_pk_bf16_f32 v74, v40, v41
v_mfma_f32_16x16x32_bf16 v[24:27], a[8:11], a[200:203], v[24:27]
ds_read_b128 a[36:39], v1 offset:1024
v_exp_f32 v44, v44
v_mfma_f32_16x16x32_bf16 v[24:27], a[12:15], a[204:207], v[24:27]
ds_read_b128 a[40:43], v1 offset:2048
v_exp_f32 v45, v45
v_mfma_f32_16x16x32_bf16 v[28:31], a[0:3], a[208:211], v[92:95]
ds_read_b128 a[44:47], v1 offset:3072
v_exp_f32 v46, v46
v_mfma_f32_16x16x32_bf16 v[28:31], a[4:7], a[212:215], v[28:31]
s_waitcnt lgkmcnt(4)
v_exp_f32 v47, v47
v_mfma_f32_16x16x32_bf16 v[28:31], a[8:11], a[216:219], v[28:31]
ds_read_b128 a[48:51], v1 offset:4096
v_add_u32 v13, 0x20000, v13
v_mfma_f32_16x16x32_bf16 v[28:31], a[12:15], a[220:223], v[28:31]
buffer_load_dwordx4 v13, s[72:75], 0 offen offset:1024 lds
v_cvt_pk_bf16_f32 v75, v42, v43
v_mfma_f32_16x16x32_bf16 v[40:43], a[16:19], a[192:195], v[116:119]
ds_read_b128 a[52:55], v1 offset:5120
v_exp_f32 v24, v24
v_mfma_f32_16x16x32_bf16 v[40:43], a[20:23], a[196:199], v[40:43]
buffer_load_dwordx4 v12, s[72:75], s12 offen offset:2048 lds
v_mfma_f32_16x16x32_bf16 v[40:43], a[24:27], a[200:203], v[40:43]
ds_read_b128 a[56:59], v1 offset:6144
v_exp_f32 v25, v25
v_mfma_f32_16x16x32_bf16 v[40:43], a[28:31], a[204:207], v[40:43]
ds_read_b128 a[60:63], v1 offset:7168
v_cvt_pk_bf16_f32 v78, v44, v45
v_cvt_pk_bf16_f32 v79, v46, v47
v_mfma_f32_16x16x32_bf16 v[44:47], a[16:19], a[208:211], v[92:95]
buffer_load_dwordx4 v13, s[72:75], s12 offen offset:3072 lds
v_mfma_f32_16x16x32_bf16 v[44:47], a[20:23], a[212:215], v[44:47]
v_exp_f32 v26, v26
v_mfma_f32_16x16x32_bf16 v[44:47], a[24:27], a[216:219], v[44:47]
v_exp_f32 v27, v27
v_mfma_f32_16x16x32_bf16 v[44:47], a[28:31], a[220:223], v[44:47]
s_waitcnt lgkmcnt(0)
v_exp_f32 v28, v28
v_exp_f32 v29, v29
v_mfma_f32_16x16x32_bf16 v[192:195], a[32:35], v[72:75], v[192:195]
ds_read_b128 a[0:3], v1 offset:24576
v_cvt_pk_bf16_f32 v56, v24, v25
v_mfma_f32_16x16x32_bf16 v[224:227], a[32:35], v[76:79], v[224:227]
ds_read_b128 a[4:7], v1 offset:25600
v_add_u32 v12, 0x20000, v12
v_mfma_f32_16x16x32_bf16 v[228:231], a[36:39], v[76:79], v[228:231]
s_add_u32 m0, s16, 0x0
v_exp_f32 v30, v30
v_mfma_f32_16x16x32_bf16 v[196:199], a[36:39], v[72:75], v[196:199]
buffer_load_dwordx4 v12, s[72:75], 0 offen lds
v_mfma_f32_16x16x32_bf16 v[200:203], a[40:43], v[72:75], v[200:203]
ds_read_b128 a[8:11], v1 offset:26624
v_add_u32 v13, 0x20000, v13
v_mfma_f32_16x16x32_bf16 v[232:235], a[40:43], v[76:79], v[232:235]
buffer_load_dwordx4 v13, s[72:75], 0 offen offset:1024 lds
v_mfma_f32_16x16x32_bf16 v[236:239], a[44:47], v[76:79], v[236:239]
ds_read_b128 a[12:15], v1 offset:27648
v_cvt_pk_bf16_f32 v57, v26, v27
v_mfma_f32_16x16x32_bf16 v[204:207], a[44:47], v[72:75], v[204:207]
buffer_load_dwordx4 v12, s[72:75], s12 offen offset:2048 lds
v_mfma_f32_16x16x32_bf16 v[208:211], a[48:51], v[72:75], v[208:211]
ds_read_b128 a[16:19], v1 offset:28672
v_cvt_pk_bf16_f32 v60, v28, v29
v_mfma_f32_16x16x32_bf16 v[240:243], a[48:51], v[76:79], v[240:243]
buffer_load_dwordx4 v13, s[72:75], s12 offen offset:3072 lds
v_mfma_f32_16x16x32_bf16 v[244:247], a[52:55], v[76:79], v[244:247]
ds_read_b128 a[20:23], v1 offset:29696
v_exp_f32 v31, v31
v_mfma_f32_16x16x32_bf16 v[212:215], a[52:55], v[72:75], v[212:215]
ds_read_b128 a[24:27], v1 offset:30720
s_add_u32 m0, s16, 0x4000
v_mfma_f32_16x16x32_bf16 v[216:219], a[56:59], v[72:75], v[216:219]
ds_read_b128 a[28:31], v1 offset:31744
v_add_u32 v12, 0x20000, v12
v_mfma_f32_16x16x32_bf16 v[248:251], a[56:59], v[76:79], v[248:251]
buffer_load_dwordx4 v12, s[72:75], 0 offen lds
v_mfma_f32_16x16x32_bf16 v[252:255], a[60:63], v[76:79], v[252:255]
ds_read_b128 a[32:35], v1 offset:16384
s_waitcnt lgkmcnt(5)
v_mfma_f32_16x16x32_bf16 v[220:223], a[60:63], v[72:75], v[220:223]
ds_read_b128 a[36:39], v1 offset:17408
v_add_u32 v13, 0x20000, v13
v_smfmac_f32_16x16x64_bf16 a[228:231], a[232:235], v[72:79], v9
buffer_load_dwordx4 v13, s[72:75], 0 offen offset:1024 lds
v_cvt_pk_bf16_f32 v61, v30, v31
v_mfma_f32_16x16x32_bf16 v[28:31], a[0:3], a[208:211], v[92:95]
ds_read_b128 a[40:43], v1 offset:18432
v_exp_f32 v40, v40
v_mfma_f32_16x16x32_bf16 v[28:31], a[4:7], a[212:215], v[28:31]
buffer_load_dwordx4 v12, s[72:75], s12 offen offset:2048 lds
v_mfma_f32_16x16x32_bf16 v[28:31], a[8:11], a[216:219], v[28:31]
ds_read_b128 a[44:47], v1 offset:19456
v_exp_f32 v41, v41
v_mfma_f32_16x16x32_bf16 v[28:31], a[12:15], a[220:223], v[28:31]
ds_read_b128 a[48:51], v1 offset:20480
s_waitcnt lgkmcnt(5)
v_exp_f32 v42, v42
v_exp_f32 v43, v43
v_exp_f32 v44, v44
v_exp_f32 v45, v45
v_exp_f32 v46, v46
v_exp_f32 v47, v47
v_cvt_pk_bf16_f32 v62, v44, v45
v_cvt_pk_bf16_f32 v63, v46, v47
v_mfma_f32_16x16x32_bf16 v[44:47], a[16:19], a[208:211], v[92:95]
buffer_load_dwordx4 v13, s[72:75], s12 offen offset:3072 lds
v_mfma_f32_16x16x32_bf16 v[44:47], a[20:23], a[212:215], v[44:47]
ds_read_b128 a[52:55], v1 offset:21504
v_cvt_pk_bf16_f32 v58, v40, v41
v_mfma_f32_16x16x32_bf16 v[44:47], a[24:27], a[216:219], v[44:47]
ds_read_b128 a[56:59], v1 offset:22528
v_cvt_pk_bf16_f32 v59, v42, v43
v_mfma_f32_16x16x32_bf16 v[44:47], a[28:31], a[220:223], v[44:47]
ds_read_b128 a[60:63], v1 offset:23552
v_xor_b32 v1, 0x8000, v1
L_att_h1_0:
s_waitcnt vmcnt(16) lgkmcnt(0)
s_mov_b32 s92, 200000
L_spin_b0:
v_cmp_gt_u32 vcc, 32, v14
s_nop 4
s_cbranch_vccz L_spun_b0
s_sub_u32 s92, s92, 1
s_cbranch_scc1 L_spun_b0
s_sleep 6
buffer_load_dword v14, v15, s[84:87], 0 offen offset:192 sc1
s_waitcnt vmcnt(0)
s_branch L_spin_b0
L_spun_b0:
s_barrier
v_mfma_f32_16x16x32_bf16 v[192:195], a[32:35], v[56:59], v[192:195]
ds_read_b128 a[0:3], v2 offset:8192
v_exp_f32 v28, v28
v_mfma_f32_16x16x32_bf16 v[224:227], a[32:35], v[60:63], v[224:227]
ds_read_b128 a[4:7], v2 offset:9216
v_exp_f32 v29, v29
v_mfma_f32_16x16x32_bf16 v[228:231], a[36:39], v[60:63], v[228:231]
s_add_u32 s101, s101, 0x2000
v_exp_f32 v30, v30
v_mfma_f32_16x16x32_bf16 v[196:199], a[36:39], v[56:59], v[196:199]
buffer_load_dwordx4 a[64:67], v3, s[88:91], s101 offen sc1
v_mfma_f32_16x16x32_bf16 v[200:203], a[40:43], v[56:59], v[200:203]
ds_read_b128 a[8:11], v2 offset:10240
v_exp_f32 v31, v31
v_mfma_f32_16x16x32_bf16 v[232:235], a[40:43], v[60:63], v[232:235]
buffer_load_dwordx4 a[68:71], v3, s[88:91], s101 offen offset:1024 sc1
v_mfma_f32_16x16x32_bf16 v[236:239], a[44:47], v[60:63], v[236:239]
ds_read_b128 a[12:15], v2 offset:11264
s_add_u32 s101, s101, 0x2000
v_mfma_f32_16x16x32_bf16 v[204:207], a[44:47], v[56:59], v[204:207]
buffer_load_dwordx4 a[72:75], v3, s[88:91], s101 offen sc1
v_mfma_f32_16x16x32_bf16 v[208:211], a[48:51], v[56:59], v[208:211]
ds_read_b128 a[16:19], v2 offset:12288
v_cvt_pk_bf16_f32 v76, v28, v29
v_mfma_f32_16x16x32_bf16 v[240:243], a[48:51], v[60:63], v[240:243]
buffer_load_dwordx4 a[76:79], v3, s[88:91], s101 offen offset:1024 sc1
v_mfma_f32_16x16x32_bf16 v[244:247], a[52:55], v[60:63], v[244:247]
ds_read_b128 a[20:23], v2 offset:13312
v_exp_f32 v44, v44
v_mfma_f32_16x16x32_bf16 v[212:215], a[52:55], v[56:59], v[212:215]
ds_read_b128 a[24:27], v2 offset:14336
v_exp_f32 v45, v45
v_mfma_f32_16x16x32_bf16 v[216:219], a[56:59], v[56:59], v[216:219]
ds_read_b128 a[28:31], v2 offset:15360
s_add_u32 s101, s101, 0x2000
v_mfma_f32_16x16x32_bf16 v[248:251], a[56:59], v[60:63], v[248:251]
buffer_load_dwordx4 a[80:83], v3, s[88:91], s101 offen sc1
v_mfma_f32_16x16x32_bf16 v[252:255], a[60:63], v[60:63], v[252:255]
ds_read_b128 a[32:35], v2 offset:0
v_cvt_pk_bf16_f32 v77, v30, v31
v_mfma_f32_16x16x32_bf16 v[220:223], a[60:63], v[56:59], v[220:223]
ds_read_b128 a[36:39], v2 offset:1024
s_waitcnt lgkmcnt(6)
v_smfmac_f32_16x16x64_bf16 a[228:231], a[232:235], v[56:63], v9
buffer_load_dwordx4 a[84:87], v3, s[88:91], s101 offen offset:1024 sc1
v_mfma_f32_16x16x32_bf16 v[28:31], a[0:3], a[208:211], v[92:95]
ds_read_b128 a[40:43], v2 offset:2048
v_exp_f32 v46, v46
v_mfma_f32_16x16x32_bf16 v[28:31], a[4:7], a[212:215], v[28:31]
ds_read_b128 a[44:47], v2 offset:3072
s_add_u32 s101, s101, 0x2000
v_mfma_f32_16x16x32_bf16 v[28:31], a[8:11], a[216:219], v[28:31]
buffer_load_dwordx4 a[88:91], v3, s[88:91], s101 offen sc1
v_mfma_f32_16x16x32_bf16 v[28:31], a[12:15], a[220:223], v[28:31]
ds_read_b128 a[48:51], v2 offset:4096
s_waitcnt lgkmcnt(5)
v_exp_f32 v47, v47
v_cvt_pk_bf16_f32 v78, v44, v45
v_cvt_pk_bf16_f32 v79, v46, v47
v_mfma_f32_16x16x32_bf16 v[44:47], a[16:19], a[208:211], v[92:95]
ds_read_b128 a[52:55], v2 offset:5120
v_mfma_f32_16x16x32_bf16 v[44:47], a[20:23], a[212:215], v[44:47]
buffer_load_dwordx4 a[92:95], v3, s[88:91], s101 offen offset:1024 sc1
v_mfma_f32_16x16x32_bf16 v[44:47], a[24:27], a[216:219], v[44:47]
ds_read_b128 a[56:59], v2 offset:6144
v_mfma_f32_16x16x32_bf16 v[44:47], a[28:31], a[220:223], v[44:47]
ds_read_b128 a[60:63], v2 offset:7168
s_waitcnt lgkmcnt(0)
v_mfma_f32_16x16x32_bf16 v[224:227], a[32:35], v[76:79], v[224:227]
ds_read_b128 a[0:3], v2 offset:24576
s_add_u32 s101, s101, 0x2000
v_mfma_f32_16x16x32_bf16 v[228:231], a[36:39], v[76:79], v[228:231]
buffer_load_dwordx4 a[96:99], v3, s[88:91], s101 offen sc1
v_mfma_f32_16x16x32_bf16 v[232:235], a[40:43], v[76:79], v[232:235]
ds_read_b128 a[4:7], v2 offset:25600
v_exp_f32 v28, v28
v_mfma_f32_16x16x32_bf16 v[236:239], a[44:47], v[76:79], v[236:239]
buffer_load_dwordx4 a[100:103], v3, s[88:91], s101 offen offset:1024 sc1
v_mfma_f32_16x16x32_bf16 v[240:243], a[48:51], v[76:79], v[240:243]
ds_read_b128 a[8:11], v2 offset:26624
s_add_u32 s101, s101, 0x2000
v_mfma_f32_16x16x32_bf16 v[244:247], a[52:55], v[76:79], v[244:247]
buffer_load_dwordx4 a[104:107], v3, s[88:91], s101 offen sc1
v_mfma_f32_16x16x32_bf16 v[248:251], a[56:59], v[76:79], v[248:251]
ds_read_b128 a[12:15], v2 offset:27648
s_waitcnt lgkmcnt(0)
v_mfma_f32_16x16x32_bf16 v[252:255], a[60:63], v[76:79], v[252:255]
buffer_load_dwordx4 a[108:111], v3, s[88:91], s101 offen offset:1024 sc1
ds_read_b128 a[16:19], v2 offset:28672
v_mfma_f32_16x16x32_bf16 a[228:231], a[236:239], v[76:79], a[228:231]
ds_read_b128 a[20:23], v2 offset:29696
s_add_u32 s101, s101, 0x2000
v_exp_f32 v29, v29
v_exp_f32 v30, v30
v_exp_f32 v31, v31
v_cvt_pk_bf16_f32 v60, v28, v29
v_cvt_pk_bf16_f32 v61, v30, v31
v_mfma_f32_16x16x32_bf16 v[28:31], a[0:3], a[208:211], v[120:123]
buffer_load_dwordx4 a[112:115], v3, s[88:91], s101 offen sc1
ds_read_b128 a[24:27], v2 offset:30720
v_mfma_f32_16x16x32_bf16 v[28:31], a[4:7], a[212:215], v[28:31]
ds_read_b128 a[28:31], v2 offset:31744
s_waitcnt lgkmcnt(0)
v_mfma_f32_16x16x32_bf16 v[28:31], a[8:11], a[216:219], v[28:31]
buffer_load_dwordx4 a[116:119], v3, s[88:91], s101 offen offset:1024 sc1
v_mfma_f32_16x16x32_bf16 v[28:31], a[12:15], a[220:223], v[28:31]
ds_read_b128 a[32:35], v2 offset:16384
s_add_u32 s101, s101, 0x2000
v_exp_f32 v44, v44
v_exp_f32 v45, v45
v_exp_f32 v46, v46
v_exp_f32 v47, v47
v_cvt_pk_bf16_f32 v62, v44, v45
v_cvt_pk_bf16_f32 v63, v46, v47
v_mfma_f32_16x16x32_bf16 v[44:47], a[16:19], a[208:211], v[124:127]
buffer_load_dwordx4 a[120:123], v3, s[88:91], s101 offen sc1
v_mfma_f32_16x16x32_bf16 v[44:47], a[20:23], a[212:215], v[44:47]
buffer_load_dwordx4 a[124:127], v3, s[88:91], s101 offen offset:1024 sc1
v_mfma_f32_16x16x32_bf16 v[44:47], a[24:27], a[216:219], v[44:47]
ds_read_b128 a[36:39], v2 offset:17408
v_mfma_f32_16x16x32_bf16 v[44:47], a[28:31], a[220:223], v[44:47]
ds_read_b128 a[40:43], v2 offset:18432
ds_read_b128 a[44:47], v2 offset:19456
ds_read_b128 a[48:51], v2 offset:20480
ds_read_b128 a[52:55], v2 offset:21504
ds_read_b128 a[56:59], v2 offset:22528
ds_read_b128 a[60:63], v2 offset:23552
v_xor_b32 v2, 0x38000, v2
s_waitcnt lgkmcnt(0)
s_barrier
v_accvgpr_read_b32 v6, a228
v_accvgpr_read_b32 v7, a229
v_add_f32 v6, v6, v7
v_cmp_nge_f32 vcc, 0x5f800000, v6
v_rcp_f32 v6, v6
s_or_b64 s[34:35], s[34:35], vcc
v_mfma_f32_16x16x32_bf16 v[224:227], a[32:35], v[60:63], v[224:227]
ds_read_b128 a[32:35], v1 offset:0
v_exp_f32 v28, v28
v_mfma_f32_16x16x32_bf16 v[228:231], a[36:39], v[60:63], v[228:231]
ds_read_b128 a[36:39], v1 offset:1024
v_exp_f32 v29, v29
v_mfma_f32_16x16x32_bf16 v[232:235], a[40:43], v[60:63], v[232:235]
ds_read_b128 a[40:43], v1 offset:2048
v_exp_f32 v30, v30
v_mfma_f32_16x16x32_bf16 v[236:239], a[44:47], v[60:63], v[236:239]
ds_read_b128 a[44:47], v1 offset:3072
v_exp_f32 v31, v31
v_mfma_f32_16x16x32_bf16 v[240:243], a[48:51], v[60:63], v[240:243]
ds_read_b128 a[48:51], v1 offset:4096
v_exp_f32 v44, v44
v_mfma_f32_16x16x32_bf16 v[244:247], a[52:55], v[60:63], v[244:247]
ds_read_b128 a[52:55], v1 offset:5120
v_exp_f32 v45, v45
v_mfma_f32_16x16x32_bf16 v[248:251], a[56:59], v[60:63], v[248:251]
ds_read_b128 a[56:59], v1 offset:6144
v_exp_f32 v46, v46
v_mfma_f32_16x16x32_bf16 v[252:255], a[60:63], v[60:63], v[252:255]
ds_read_b128 a[60:63], v1 offset:7168
v_exp_f32 v47, v47
v_mfma_f32_16x16x32_bf16 a[228:231], a[236:239], v[60:63], a[228:231]
v_cvt_pk_bf16_f32 v76, v28, v29
v_cvt_pk_bf16_f32 v77, v30, v31
v_cvt_pk_bf16_f32 v78, v44, v45
v_cvt_pk_bf16_f32 v79, v46, v47
s_add_u32 s8, s30, 0x0
v_pk_mul_f32 v[192:193], v[192:193], v[6:7] op_sel_hi:[1,0]
v_pk_mul_f32 v[194:195], v[194:195], v[6:7] op_sel_hi:[1,0]
v_pk_mul_f32 v[196:197], v[196:197], v[6:7] op_sel_hi:[1,0]
v_pk_mul_f32 v[198:199], v[198:199], v[6:7] op_sel_hi:[1,0]
v_cvt_pk_bf16_f32 v192, v192, v193
v_cvt_pk_bf16_f32 v193, v194, v195
v_cvt_pk_bf16_f32 v194, v196, v197
v_cvt_pk_bf16_f32 v195, v198, v199
buffer_store_dwordx4 v[192:195], v3, s[88:91], s8 offen sc1
s_add_u32 s8, s30, 0x2000
v_pk_mul_f32 v[200:201], v[200:201], v[6:7] op_sel_hi:[1,0]
v_pk_mul_f32 v[202:203], v[202:203], v[6:7] op_sel_hi:[1,0]
v_pk_mul_f32 v[204:205], v[204:205], v[6:7] op_sel_hi:[1,0]
v_pk_mul_f32 v[206:207], v[206:207], v[6:7] op_sel_hi:[1,0]
v_cvt_pk_bf16_f32 v200, v200, v201
v_cvt_pk_bf16_f32 v201, v202, v203
v_cvt_pk_bf16_f32 v202, v204, v205
v_cvt_pk_bf16_f32 v203, v206, v207
buffer_store_dwordx4 v[200:203], v3, s[88:91], s8 offen sc1
s_waitcnt lgkmcnt(0)
v_mfma_f32_16x16x32_bf16 v[224:227], a[32:35], v[76:79], v[224:227]
s_add_u32 s8, s30, 0x4000
v_mul_f32 v208, v6, v208
v_mfma_f32_16x16x32_bf16 v[228:231], a[36:39], v[76:79], v[228:231]
v_mul_f32 v209, v6, v209
v_mul_f32 v210, v6, v210
v_mfma_f32_16x16x32_bf16 v[232:235], a[40:43], v[76:79], v[232:235]
v_mul_f32 v211, v6, v211
v_mul_f32 v212, v6, v212
v_mfma_f32_16x16x32_bf16 v[236:239], a[44:47], v[76:79], v[236:239]
v_mul_f32 v213, v6, v213
v_mul_f32 v214, v6, v214
v_mfma_f32_16x16x32_bf16 v[240:243], a[48:51], v[76:79], v[240:243]
v_mul_f32 v215, v6, v215
v_cvt_pk_bf16_f32 v208, v208, v209
v_mfma_f32_16x16x32_bf16 v[244:247], a[52:55], v[76:79], v[244:247]
v_cvt_pk_bf16_f32 v209, v210, v211
v_cvt_pk_bf16_f32 v210, v212, v213
v_mfma_f32_16x16x32_bf16 v[248:251], a[56:59], v[76:79], v[248:251]
v_cvt_pk_bf16_f32 v211, v214, v215
buffer_store_dwordx4 v[208:211], v3, s[88:91], s8 offen sc1
v_mfma_f32_16x16x32_bf16 v[252:255], a[60:63], v[76:79], v[252:255]
s_add_u32 s8, s30, 0x6000
v_mul_f32 v216, v6, v216
v_mfma_f32_16x16x32_bf16 a[228:231], a[236:239], v[76:79], a[228:231]
v_mul_f32 v217, v6, v217
v_mul_f32 v218, v6, v218
v_mul_f32 v219, v6, v219
v_mul_f32 v220, v6, v220
v_mul_f32 v221, v6, v221
v_mul_f32 v222, v6, v222
v_mul_f32 v223, v6, v223
v_cvt_pk_bf16_f32 v216, v216, v217
v_cvt_pk_bf16_f32 v217, v218, v219
v_cvt_pk_bf16_f32 v218, v220, v221
v_cvt_pk_bf16_f32 v219, v222, v223
buffer_store_dwordx4 v[216:219], v3, s[88:91], s8 offen sc1
s_branch L_att_fin
L_att_sh0_1:
v_mfma_f32_16x16x32_bf16 v[192:195], a[32:35], v[56:59], v[192:195]
v_exp_f32 v30, v30
v_mfma_f32_16x16x32_bf16 v[224:227], a[32:35], v[60:63], v[224:227]
buffer_load_dword v14, v15, s[84:87], 0 offen offset:192 sc1
v_mfma_f32_16x16x32_bf16 v[228:231], a[36:39], v[60:63], v[228:231]
v_exp_f32 v31, v31
v_mfma_f32_16x16x32_bf16 v[196:199], a[36:39], v[56:59], v[196:199]
s_add_u32 m0, s17, 0x10000
v_exp_f32 v40, v40
v_mfma_f32_16x16x32_bf16 v[200:203], a[40:43], v[56:59], v[200:203]
ds_read_b128 a[0:3], v1 offset:8192
v_cvt_pk_bf16_f32 v72, v24, v25
v_mfma_f32_16x16x32_bf16 v[232:235], a[40:43], v[60:63], v[232:235]
ds_read_b128 a[4:7], v1 offset:9216
v_cvt_pk_bf16_f32 v73, v26, v27
v_mfma_f32_16x16x32_bf16 v[236:239], a[44:47], v[60:63], v[236:239]
buffer_load_dwordx4 v12, s[72:75], 0 offen lds
v_mfma_f32_16x16x32_bf16 v[204:207], a[44:47], v[56:59], v[204:207]
ds_read_b128 a[8:11], v1 offset:10240
v_cvt_pk_bf16_f32 v76, v28, v29
v_mfma_f32_16x16x32_bf16 v[208:211], a[48:51], v[56:59], v[208:211]
buffer_load_dwordx4 v13, s[72:75], 0 offen offset:1024 lds
v_mfma_f32_16x16x32_bf16 v[240:243], a[48:51], v[60:63], v[240:243]
ds_read_b128 a[12:15], v1 offset:11264
v_cvt_pk_bf16_f32 v77, v30, v31
v_mfma_f32_16x16x32_bf16 v[244:247], a[52:55], v[60:63], v[244:247]
buffer_load_dwordx4 v12, s[72:75], s12 offen offset:2048 lds
v_mfma_f32_16x16x32_bf16 v[212:215], a[52:55], v[56:59], v[212:215]
ds_read_b128 a[16:19], v1 offset:12288
v_exp_f32 v41, v41
v_mfma_f32_16x16x32_bf16 v[216:219], a[56:59], v[56:59], v[216:219]
ds_read_b128 a[20:23], v1 offset:13312
v_exp_f32 v42, v42
v_mfma_f32_16x16x32_bf16 v[248:251], a[56:59], v[60:63], v[248:251]
buffer_load_dwordx4 v13, s[72:75], s12 offen offset:3072 lds
v_mfma_f32_16x16x32_bf16 v[252:255], a[60:63], v[60:63], v[252:255]
ds_read_b128 a[24:27], v1 offset:14336
s_waitcnt lgkmcnt(3)
v_mfma_f32_16x16x32_bf16 v[220:223], a[60:63], v[56:59], v[220:223]
ds_read_b128 a[28:31], v1 offset:15360
v_add_u32 v12, 0x20000, v12
v_smfmac_f32_16x16x64_bf16 a[228:231], a[232:235], v[56:63], v9
s_add_u32 m0, s17, 0x14000
v_exp_f32 v43, v43
v_mfma_f32_16x16x32_bf16 v[24:27], a[0:3], a[192:195], v[88:91]
buffer_load_dwordx4 v12, s[72:75], 0 offen lds
v_mfma_f32_16x16x32_bf16 v[24:27], a[4:7], a[196:199], v[24:27]
ds_read_b128 a[32:35], v1 offset:0
v_cvt_pk_bf16_f32 v74, v40, v41
v_mfma_f32_16x16x32_bf16 v[24:27], a[8:11], a[200:203], v[24:27]
ds_read_b128 a[36:39], v1 offset:1024
v_exp_f32 v44, v44
v_mfma_f32_16x16x32_bf16 v[24:27], a[12:15], a[204:207], v[24:27]
ds_read_b128 a[40:43], v1 offset:2048
v_exp_f32 v45, v45
v_mfma_f32_16x16x32_bf16 v[28:31], a[0:3], a[208:211], v[92:95]
ds_read_b128 a[44:47], v1 offset:3072
v_exp_f32 v46, v46
v_mfma_f32_16x16x32_bf16 v[28:31], a[4:7], a[212:215], v[28:31]
s_waitcnt lgkmcnt(4)
v_exp_f32 v47, v47
v_mfma_f32_16x16x32_bf16 v[28:31], a[8:11], a[216:219], v[28:31]
ds_read_b128 a[48:51], v1 offset:4096
v_add_u32 v13, 0x20000, v13
v_mfma_f32_16x16x32_bf16 v[28:31], a[12:15], a[220:223], v[28:31]
buffer_load_dwordx4 v13, s[72:75], 0 offen offset:1024 lds
v_cvt_pk_bf16_f32 v75, v42, v43
v_mfma_f32_16x16x32_bf16 v[40:43], a[16:19], a[192:195], v[88:91]
ds_read_b128 a[52:55], v1 offset:5120
v_exp_f32 v24, v24
v_mfma_f32_16x16x32_bf16 v[40:43], a[20:23], a[196:199], v[40:43]
buffer_load_dwordx4 v12, s[72:75], s12 offen offset:2048 lds
v_mfma_f32_16x16x32_bf16 v[40:43], a[24:27], a[200:203], v[40:43]
ds_read_b128 a[56:59], v1 offset:6144
v_exp_f32 v25, v25
v_mfma_f32_16x16x32_bf16 v[40:43], a[28:31], a[204:207], v[40:43]
ds_read_b128 a[60:63], v1 offset:7168
v_cvt_pk_bf16_f32 v78, v44, v45
v_cvt_pk_bf16_f32 v79, v46, v47
v_mfma_f32_16x16x32_bf16 v[44:47], a[16:19], a[208:211], v[92:95]
buffer_load_dwordx4 v13, s[72:75], s12 offen offset:3072 lds
v_mfma_f32_16x16x32_bf16 v[44:47], a[20:23], a[212:215], v[44:47]
v_exp_f32 v26, v26
v_mfma_f32_16x16x32_bf16 v[44:47], a[24:27], a[216:219], v[44:47]
v_exp_f32 v27, v27
v_mfma_f32_16x16x32_bf16 v[44:47], a[28:31], a[220:223], v[44:47]
s_waitcnt lgkmcnt(0)
v_exp_f32 v28, v28
v_exp_f32 v29, v29
v_mfma_f32_16x16x32_bf16 v[192:195], a[32:35], v[72:75], v[192:195]
s_add_u32 m0, s16, 0x0
v_add_u32 v12, 0x20000, v12
v_cvt_pk_bf16_f32 v56, v24, v25
v_mfma_f32_16x16x32_bf16 v[224:227], a[32:35], v[76:79], v[224:227]
buffer_load_dwordx4 v12, s[72:75], 0 offen lds
v_mfma_f32_16x16x32_bf16 v[228:231], a[36:39], v[76:79], v[228:231]
ds_read_b128 a[0:3], v1 offset:24576
v_cvt_pk_bf16_f32 v57, v26, v27
v_mfma_f32_16x16x32_bf16 v[196:199], a[36:39], v[72:75], v[196:199]
v_exp_f32 v30, v30
v_mfma_f32_16x16x32_bf16 v[200:203], a[40:43], v[72:75], v[200:203]
ds_read_b128 a[4:7], v1 offset:25600
v_cvt_pk_bf16_f32 v60, v28, v29
v_mfma_f32_16x16x32_bf16 v[232:235], a[40:43], v[76:79], v[232:235]
ds_read_b128 a[8:11], v1 offset:26624
v_add_u32 v13, 0x20000, v13
v_mfma_f32_16x16x32_bf16 v[236:239], a[44:47], v[76:79], v[236:239]
buffer_load_dwordx4 v13, s[72:75], 0 offen offset:1024 lds
v_mfma_f32_16x16x32_bf16 v[204:207], a[44:47], v[72:75], v[204:207]
ds_read_b128 a[12:15], v1 offset:27648
v_exp_f32 v31, v31
v_mfma_f32_16x16x32_bf16 v[208:211], a[48:51], v[72:75], v[208:211]
buffer_load_dwordx4 v12, s[72:75], s12 offen offset:2048 lds
v_mfma_f32_16x16x32_bf16 v[240:243], a[48:51], v[76:79], v[240:243]
ds_read_b128 a[16:19], v1 offset:28672
v_exp_f32 v40, v40
v_mfma_f32_16x16x32_bf16 v[244:247], a[52:55], v[76:79], v[244:247]
ds_read_b128 a[20:23], v1 offset:29696
v_cvt_pk_bf16_f32 v61, v30, v31
v_mfma_f32_16x16x32_bf16 v[212:215], a[52:55], v[72:75], v[212:215]
buffer_load_dwordx4 v13, s[72:75], s12 offen offset:3072 lds
v_mfma_f32_16x16x32_bf16 v[216:219], a[56:59], v[72:75], v[216:219]
ds_read_b128 a[24:27], v1 offset:30720
v_exp_f32 v41, v41
v_mfma_f32_16x16x32_bf16 v[248:251], a[56:59], v[76:79], v[248:251]
ds_read_b128 a[28:31], v1 offset:31744
v_exp_f32 v42, v42
v_mfma_f32_16x16x32_bf16 v[252:255], a[60:63], v[76:79], v[252:255]
ds_read_b128 a[32:35], v1 offset:16384
v_cvt_pk_bf16_f32 v58, v40, v41
v_mfma_f32_16x16x32_bf16 v[220:223], a[60:63], v[72:75], v[220:223]
s_waitcnt lgkmcnt(5)
v_exp_f32 v43, v43
v_smfmac_f32_16x16x64_bf16 a[228:231], a[232:235], v[72:79], v9
ds_read_b128 a[36:39], v1 offset:17408
v_add_u32 v12, 0x20000, v12
v_mfma_f32_16x16x32_bf16 v[24:27], a[0:3], a[192:195], v[112:115]
s_add_u32 m0, s16, 0x4000
v_exp_f32 v44, v44
v_mfma_f32_16x16x32_bf16 v[24:27], a[4:7], a[196:199], v[24:27]
buffer_load_dwordx4 v12, s[72:75], 0 offen lds
v_mfma_f32_16x16x32_bf16 v[24:27], a[8:11], a[200:203], v[24:27]
ds_read_b128 a[40:43], v1 offset:18432
v_add_u32 v13, 0x20000, v13
v_mfma_f32_16x16x32_bf16 v[24:27], a[12:15], a[204:207], v[24:27]
buffer_load_dwordx4 v13, s[72:75], 0 offen offset:1024 lds
v_mfma_f32_16x16x32_bf16 v[28:31], a[0:3], a[208:211], v[92:95]
ds_read_b128 a[44:47], v1 offset:19456
v_cvt_pk_bf16_f32 v59, v42, v43
v_mfma_f32_16x16x32_bf16 v[28:31], a[4:7], a[212:215], v[28:31]
ds_read_b128 a[48:51], v1 offset:20480
v_exp_f32 v45, v45
v_mfma_f32_16x16x32_bf16 v[28:31], a[8:11], a[216:219], v[28:31]
s_waitcnt lgkmcnt(5)
v_exp_f32 v46, v46
v_mfma_f32_16x16x32_bf16 v[28:31], a[12:15], a[220:223], v[28:31]
buffer_load_dwordx4 v12, s[72:75], s12 offen offset:2048 lds
v_mfma_f32_16x16x32_bf16 v[40:43], a[16:19], a[192:195], v[116:119]
ds_read_b128 a[52:55], v1 offset:21504
v_exp_f32 v47, v47
v_mfma_f32_16x16x32_bf16 v[40:43], a[20:23], a[196:199], v[40:43]
ds_read_b128 a[56:59], v1 offset:22528
v_exp_f32 v24, v24
v_mfma_f32_16x16x32_bf16 v[40:43], a[24:27], a[200:203], v[40:43]
ds_read_b128 a[60:63], v1 offset:23552
v_xor_b32 v1, 0x8000, v1
v_mfma_f32_16x16x32_bf16 v[40:43], a[28:31], a[204:207], v[40:43]
v_exp_f32 v25, v25
v_cvt_pk_bf16_f32 v62, v44, v45
v_cvt_pk_bf16_f32 v63, v46, v47
v_mfma_f32_16x16x32_bf16 v[44:47], a[16:19], a[208:211], v[92:95]
v_exp_f32 v26, v26
v_mfma_f32_16x16x32_bf16 v[44:47], a[20:23], a[212:215], v[44:47]
buffer_load_dwordx4 v13, s[72:75], s12 offen offset:3072 lds
v_mfma_f32_16x16x32_bf16 v[44:47], a[24:27], a[216:219], v[44:47]
v_exp_f32 v27, v27
v_mfma_f32_16x16x32_bf16 v[44:47], a[28:31], a[220:223], v[44:47]
v_exp_f32 v28, v28
v_exp_f32 v29, v29
L_att_h1_1:
s_waitcnt vmcnt(16) lgkmcnt(0)
s_mov_b32 s92, 200000
L_spin_b1:
v_cmp_gt_u32 vcc, 32, v14
s_nop 4
s_cbranch_vccz L_spun_b1
s_sub_u32 s92, s92, 1
s_cbranch_scc1 L_spun_b1
s_sleep 6
buffer_load_dword v14, v15, s[84:87], 0 offen offset:192 sc1
s_waitcnt vmcnt(0)
s_branch L_spin_b1
L_spun_b1:
s_barrier
v_mfma_f32_16x16x32_bf16 v[192:195], a[32:35], v[56:59], v[192:195]
ds_read_b128 a[0:3], v2 offset:8192
v_cvt_pk_bf16_f32 v72, v24, v25
v_mfma_f32_16x16x32_bf16 v[224:227], a[32:35], v[60:63], v[224:227]
ds_read_b128 a[4:7], v2 offset:9216
v_cvt_pk_bf16_f32 v73, v26, v27
v_mfma_f32_16x16x32_bf16 v[228:231], a[36:39], v[60:63], v[228:231]
s_add_u32 s101, s101, 0x2000
v_exp_f32 v30, v30
v_mfma_f32_16x16x32_bf16 v[196:199], a[36:39], v[56:59], v[196:199]
buffer_load_dwordx4 a[64:67], v3, s[88:91], s101 offen sc1
v_mfma_f32_16x16x32_bf16 v[200:203], a[40:43], v[56:59], v[200:203]
ds_read_b128 a[8:11], v2 offset:10240
v_cvt_pk_bf16_f32 v76, v28, v29
v_mfma_f32_16x16x32_bf16 v[232:235], a[40:43], v[60:63], v[232:235]
buffer_load_dwordx4 a[68:71], v3, s[88:91], s101 offen offset:1024 sc1
v_mfma_f32_16x16x32_bf16 v[236:239], a[44:47], v[60:63], v[236:239]
ds_read_b128 a[12:15], v2 offset:11264
s_add_u32 s101, s101, 0x2000
v_mfma_f32_16x16x32_bf16 v[204:207], a[44:47], v[56:59], v[204:207]
buffer_load_dwordx4 a[72:75], v3, s[88:91], s101 offen sc1
v_mfma_f32_16x16x32_bf16 v[208:211], a[48:51], v[56:59], v[208:211]
ds_read_b128 a[16:19], v2 offset:12288
v_exp_f32 v31, v31
v_mfma_f32_16x16x32_bf16 v[240:243], a[48:51], v[60:63], v[240:243]
buffer_load_dwordx4 a[76:79], v3, s[88:91], s101 offen offset:1024 sc1
v_mfma_f32_16x16x32_bf16 v[244:247], a[52:55], v[60:63], v[244:247]
ds_read_b128 a[20:23], v2 offset:13312
v_exp_f32 v40, v40
v_mfma_f32_16x16x32_bf16 v[212:215], a[52:55], v[56:59], v[212:215]
ds_read_b128 a[24:27], v2 offset:14336
v_exp_f32 v41, v41
v_mfma_f32_16x16x32_bf16 v[216:219], a[56:59], v[56:59], v[216:219]
ds_read_b128 a[28:31], v2 offset:15360
s_add_u32 s101, s101, 0x2000
v_mfma_f32_16x16x32_bf16 v[248:251], a[56:59], v[60:63], v[248:251]
buffer_load_dwordx4 a[80:83], v3, s[88:91], s101 offen sc1
v_mfma_f32_16x16x32_bf16 v[252:255], a[60:63], v[60:63], v[252:255]
ds_read_b128 a[32:35], v2 offset:0
v_cvt_pk_bf16_f32 v77, v30, v31
v_mfma_f32_16x16x32_bf16 v[220:223], a[60:63], v[56:59], v[220:223]
ds_read_b128 a[36:39], v2 offset:1024
s_waitcnt lgkmcnt(6)
v_smfmac_f32_16x16x64_bf16 a[228:231], a[232:235], v[56:63], v9
buffer_load_dwordx4 a[84:87], v3, s[88:91], s101 offen offset:1024 sc1
v_mfma_f32_16x16x32_bf16 v[28:31], a[0:3], a[208:211], v[120:123]
ds_read_b128 a[40:43], v2 offset:2048
v_exp_f32 v42, v42
v_mfma_f32_16x16x32_bf16 v[28:31], a[4:7], a[212:215], v[28:31]
ds_read_b128 a[44:47], v2 offset:3072
s_add_u32 s101, s101, 0x2000
v_mfma_f32_16x16x32_bf16 v[28:31], a[8:11], a[216:219], v[28:31]
buffer_load_dwordx4 a[88:91], v3, s[88:91], s101 offen sc1
v_mfma_f32_16x16x32_bf16 v[28:31], a[12:15], a[220:223], v[28:31]
ds_read_b128 a[48:51], v2 offset:4096
s_waitcnt lgkmcnt(5)
v_exp_f32 v43, v43
v_exp_f32 v44, v44
v_exp_f32 v45, v45
v_exp_f32 v46, v46
v_exp_f32 v47, v47
v_cvt_pk_bf16_f32 v78, v44, v45
v_cvt_pk_bf16_f32 v79, v46, v47
v_mfma_f32_16x16x32_bf16 v[44:47], a[16:19], a[208:211], v[124:127]
ds_read_b128 a[52:55], v2 offset:5120
v_cvt_pk_bf16_f32 v74, v40, v41
v_mfma_f32_16x16x32_bf16 v[44:47], a[20:23], a[212:215], v[44:47]
buffer_load_dwordx4 a[92:95], v3, s[88:91], s101 offen offset:1024 sc1
v_mfma_f32_16x16x32_bf16 v[44:47], a[24:27], a[216:219], v[44:47]
ds_read_b128 a[56:59], v2 offset:6144
v_cvt_pk_bf16_f32 v75, v42, v43
v_mfma_f32_16x16x32_bf16 v[44:47], a[28:31], a[220:223], v[44:47]
ds_read_b128 a[60:63], v2 offset:7168
s_waitcnt lgkmcnt(0)
v_mfma_f32_16x16x32_bf16 v[192:195], a[32:35], v[72:75], v[192:195]
s_add_u32 s101, s101, 0x2000
v_exp_f32 v28, v28
v_mfma_f32_16x16x32_bf16 v[224:227], a[32:35], v[76:79], v[224:227]
buffer_load_dwordx4 a[96:99], v3, s[88:91], s101 offen sc1
v_mfma_f32_16x16x32_bf16 v[228:231], a[36:39], v[76:79], v[228:231]
ds_read_b128 a[32:35], v2 offset:16384
v_exp_f32 v29, v29
v_mfma_f32_16x16x32_bf16 v[196:199], a[36:39], v[72:75], v[196:199]
buffer_load_dwordx4 a[100:103], v3, s[88:91], s101 offen offset:1024 sc1
v_mfma_f32_16x16x32_bf16 v[200:203], a[40:43], v[72:75], v[200:203]
ds_read_b128 a[36:39], v2 offset:17408
s_add_u32 s101, s101, 0x2000
v_mfma_f32_16x16x32_bf16 v[232:235], a[40:43], v[76:79], v[232:235]
buffer_load_dwordx4 a[104:107], v3, s[88:91], s101 offen sc1
v_mfma_f32_16x16x32_bf16 v[236:239], a[44:47], v[76:79], v[236:239]
ds_read_b128 a[40:43], v2 offset:18432
v_exp_f32 v30, v30
v_mfma_f32_16x16x32_bf16 v[204:207], a[44:47], v[72:75], v[204:207]
buffer_load_dwordx4 a[108:111], v3, s[88:91], s101 offen offset:1024 sc1
v_mfma_f32_16x16x32_bf16 v[208:211], a[48:51], v[72:75], v[208:211]
ds_read_b128 a[44:47], v2 offset:19456
s_add_u32 s101, s101, 0x2000
v_mfma_f32_16x16x32_bf16 v[240:243], a[48:51], v[76:79], v[240:243]
buffer_load_dwordx4 a[112:115], v3, s[88:91], s101 offen sc1
v_mfma_f32_16x16x32_bf16 v[244:247], a[52:55], v[76:79], v[244:247]
ds_read_b128 a[48:51], v2 offset:20480
v_exp_f32 v31, v31
v_mfma_f32_16x16x32_bf16 v[212:215], a[52:55], v[72:75], v[212:215]
buffer_load_dwordx4 a[116:119], v3, s[88:91], s101 offen offset:1024 sc1
v_mfma_f32_16x16x32_bf16 v[216:219], a[56:59], v[72:75], v[216:219]
ds_read_b128 a[52:55], v2 offset:21504
s_add_u32 s101, s101, 0x2000
v_mfma_f32_16x16x32_bf16 v[248:251], a[56:59], v[76:79], v[248:251]
buffer_load_dwordx4 a[120:123], v3, s[88:91], s101 offen sc1
v_mfma_f32_16x16x32_bf16 v[252:255], a[60:63], v[76:79], v[252:255]
buffer_load_dwordx4 a[124:127], v3, s[88:91], s101 offen offset:1024 sc1
v_mfma_f32_16x16x32_bf16 v[220:223], a[60:63], v[72:75], v[220:223]
ds_read_b128 a[56:59], v2 offset:22528
v_cvt_pk_bf16_f32 v60, v28, v29
v_smfmac_f32_16x16x64_bf16 a[228:231], a[232:235], v[72:79], v9
ds_read_b128 a[60:63], v2 offset:23552
v_xor_b32 v2, 0x38000, v2
v_exp_f32 v44, v44
v_exp_f32 v45, v45
v_exp_f32 v46, v46
v_exp_f32 v47, v47
v_cvt_pk_bf16_f32 v61, v30, v31
v_cvt_pk_bf16_f32 v62, v44, v45
v_cvt_pk_bf16_f32 v63, v46, v47
s_waitcnt lgkmcnt(0)
s_barrier
v_accvgpr_read_b32 v6, a228
v_accvgpr_read_b32 v7, a229
v_add_f32 v6, v6, v7
v_cmp_nge_f32 vcc, 0x5f800000, v6
v_rcp_f32 v6, v6
s_or_b64 s[34:35], s[34:35], vcc
v_mfma_f32_16x16x32_bf16 v[224:227], a[32:35], v[60:63], v[224:227]
s_add_u32 s8, s30, 0x0
v_mul_f32 v192, v6, v192
v_mfma_f32_16x16x32_bf16 v[228:231], a[36:39], v[60:63], v[228:231]
v_mul_f32 v193, v6, v193
v_mul_f32 v194, v6, v194
v_mfma_f32_16x16x32_bf16 v[232:235], a[40:43], v[60:63], v[232:235]
v_mul_f32 v195, v6, v195
v_mul_f32 v196, v6, v196
v_mfma_f32_16x16x32_bf16 v[236:239], a[44:47], v[60:63], v[236:239]
v_mul_f32 v197, v6, v197
v_mul_f32 v198, v6, v198
v_mfma_f32_16x16x32_bf16 v[240:243], a[48:51], v[60:63], v[240:243]
v_mul_f32 v199, v6, v199
v_cvt_pk_bf16_f32 v192, v192, v193
v_mfma_f32_16x16x32_bf16 v[244:247], a[52:55], v[60:63], v[244:247]
v_cvt_pk_bf16_f32 v193, v194, v195
v_cvt_pk_bf16_f32 v194, v196, v197
v_mfma_f32_16x16x32_bf16 v[248:251], a[56:59], v[60:63], v[248:251]
v_cvt_pk_bf16_f32 v195, v198, v199
buffer_store_dwordx4 v[192:195], v3, s[88:91], s8 offen sc1
v_mfma_f32_16x16x32_bf16 v[252:255], a[60:63], v[60:63], v[252:255]
v_mfma_f32_16x16x32_bf16 a[228:231], a[236:239], v[60:63], a[228:231]
s_add_u32 s8, s30, 0x2000
v_pk_mul_f32 v[200:201], v[200:201], v[6:7] op_sel_hi:[1,0]
v_pk_mul_f32 v[202:203], v[202:203], v[6:7] op_sel_hi:[1,0]
v_pk_mul_f32 v[204:205], v[204:205], v[6:7] op_sel_hi:[1,0]
v_pk_mul_f32 v[206:207], v[206:207], v[6:7] op_sel_hi:[1,0]
v_cvt_pk_bf16_f32 v200, v200, v201
v_cvt_pk_bf16_f32 v201, v202, v203
v_cvt_pk_bf16_f32 v202, v204, v205
v_cvt_pk_bf16_f32 v203, v206, v207
buffer_store_dwordx4 v[200:203], v3, s[88:91], s8 offen sc1
s_add_u32 s8, s30, 0x4000
v_pk_mul_f32 v[208:209], v[208:209], v[6:7] op_sel_hi:[1,0]
v_pk_mul_f32 v[210:211], v[210:211], v[6:7] op_sel_hi:[1,0]
v_pk_mul_f32 v[212:213], v[212:213], v[6:7] op_sel_hi:[1,0]
v_pk_mul_f32 v[214:215], v[214:215], v[6:7] op_sel_hi:[1,0]
v_cvt_pk_bf16_f32 v208, v208, v209
v_cvt_pk_bf16_f32 v209, v210, v211
v_cvt_pk_bf16_f32 v210, v212, v213
v_cvt_pk_bf16_f32 v211, v214, v215
buffer_store_dwordx4 v[208:211], v3, s[88:91], s8 offen sc1
s_add_u32 s8, s30, 0x6000
v_pk_mul_f32 v[216:217], v[216:217], v[6:7] op_sel_hi:[1,0]
v_pk_mul_f32 v[218:219], v[218:219], v[6:7] op_sel_hi:[1,0]
v_pk_mul_f32 v[220:221], v[220:221], v[6:7] op_sel_hi:[1,0]
v_pk_mul_f32 v[222:223], v[222:223], v[6:7] op_sel_hi:[1,0]
v_cvt_pk_bf16_f32 v216, v216, v217
v_cvt_pk_bf16_f32 v217, v218, v219
v_cvt_pk_bf16_f32 v218, v220, v221
v_cvt_pk_bf16_f32 v219, v222, v223
buffer_store_dwordx4 v[216:219], v3, s[88:91], s8 offen sc1
L_att_fin:
v_accvgpr_read_b32 v6, a230
v_accvgpr_read_b32 v7, a231
v_add_f32 v6, v6, v7
v_cmp_nge_f32 vcc, 0x5f800000, v6
v_rcp_f32 v6, v6
s_or_b64 s[34:35], s[34:35], vcc
s_add_u32 s8, s31, 0x0
v_pk_mul_f32 v[224:225], v[224:225], v[6:7] op_sel_hi:[1,0]
v_pk_mul_f32 v[226:227], v[226:227], v[6:7] op_sel_hi:[1,0]
v_pk_mul_f32 v[228:229], v[228:229], v[6:7] op_sel_hi:[1,0]
v_pk_mul_f32 v[230:231], v[230:231], v[6:7] op_sel_hi:[1,0]
v_cvt_pk_bf16_f32 v224, v224, v225
v_cvt_pk_bf16_f32 v225, v226, v227
v_cvt_pk_bf16_f32 v226, v228, v229
v_cvt_pk_bf16_f32 v227, v230, v231
buffer_store_dwordx4 v[224:227], v3, s[88:91], s8 offen sc1
s_add_u32 s8, s31, 0x2000
v_pk_mul_f32 v[232:233], v[232:233], v[6:7] op_sel_hi:[1,0]
v_pk_mul_f32 v[234:235], v[234:235], v[6:7] op_sel_hi:[1,0]
v_pk_mul_f32 v[236:237], v[236:237], v[6:7] op_sel_hi:[1,0]
v_pk_mul_f32 v[238:239], v[238:239], v[6:7] op_sel_hi:[1,0]
v_cvt_pk_bf16_f32 v232, v232, v233
v_cvt_pk_bf16_f32 v233, v234, v235
v_cvt_pk_bf16_f32 v234, v236, v237
v_cvt_pk_bf16_f32 v235, v238, v239
buffer_store_dwordx4 v[232:235], v3, s[88:91], s8 offen sc1
s_add_u32 s8, s31, 0x4000
v_pk_mul_f32 v[240:241], v[240:241], v[6:7] op_sel_hi:[1,0]
v_pk_mul_f32 v[242:243], v[242:243], v[6:7] op_sel_hi:[1,0]
v_pk_mul_f32 v[244:245], v[244:245], v[6:7] op_sel_hi:[1,0]
v_pk_mul_f32 v[246:247], v[246:247], v[6:7] op_sel_hi:[1,0]
v_cvt_pk_bf16_f32 v240, v240, v241
v_cvt_pk_bf16_f32 v241, v242, v243
v_cvt_pk_bf16_f32 v242, v244, v245
v_cvt_pk_bf16_f32 v243, v246, v247
buffer_store_dwordx4 v[240:243], v3, s[88:91], s8 offen sc1
s_add_u32 s8, s31, 0x6000
v_pk_mul_f32 v[248:249], v[248:249], v[6:7] op_sel_hi:[1,0]
v_pk_mul_f32 v[250:251], v[250:251], v[6:7] op_sel_hi:[1,0]
v_pk_mul_f32 v[252:253], v[252:253], v[6:7] op_sel_hi:[1,0]
v_pk_mul_f32 v[254:255], v[254:255], v[6:7] op_sel_hi:[1,0]
v_cvt_pk_bf16_f32 v248, v248, v249
v_cvt_pk_bf16_f32 v249, v250, v251
v_cvt_pk_bf16_f32 v250, v252, v253
v_cvt_pk_bf16_f32 v251, v254, v255
buffer_store_dwordx4 v[248:251], v3, s[88:91], s8 offen sc1
s_cmp_lg_u64 s[34:35], 0
s_cselect_b32 s8, 1, 0
s_lshl_b32 s9, s4, 2
s_add_u32 s9, s9, 24576
v_mov_b32 v4, s9
v_mov_b32 v5, s8
ds_write_b32 v4, v5
v_lshrrev_b32 v17, 4, v0
v_lshlrev_b32 v18, 10, v17
v_and_b32 v17, 1, v17
v_lshl_add_u32 v18, v17, 5, v18
v_bfe_u32 v17, v0, 2, 2
v_lshl_add_u32 v18, v17, 6, v18
v_and_b32 v17, 3, v0
v_lshl_add_u32 v4, v17, 3, v18
s_sub_u32 s8, s16, s17
v_add_u32 v6, s8, v4
v_xor_b32 v7, 32, v6
v_add_u32 v4, 65536, v4
v_xor_b32 v5, 32, v4
v_and_b32 v20, 15, v0
v_lshlrev_b32 v20, 2, v20
v_and_b32 v16, 28, v20
s_waitcnt vmcnt(20) lgkmcnt(0)
s_barrier
v_and_b32 v17, 3, v0
v_lshlrev_b32 v17, 2, v17
v_add_u32 v17, 24576, v17
ds_read_b32 v18, v17
s_waitcnt lgkmcnt(0)
v_cmp_ne_u32 vcc, 0, v18
s_cmp_lg_u32 s33, 0
s_cbranch_scc1 L_att_done
s_nop 4
s_cbranch_vccnz L_att_fallback
L_att_done:
ds_read_b64_tr_b16 v[152:153], v4 offset:512
ds_read_b64_tr_b16 v[154:155], v4 offset:4608
ds_read_b64_tr_b16 v[156:157], v4 offset:8704
ds_read_b64_tr_b16 v[158:159], v4 offset:12800
ds_read_b64_tr_b16 v[160:161], v5 offset:512
ds_read_b64_tr_b16 v[162:163], v5 offset:4608
ds_read_b64_tr_b16 v[164:165], v5 offset:8704
ds_read_b64_tr_b16 v[166:167], v5 offset:12800
ds_read_b64_tr_b16 v[168:169], v4 offset:768
ds_read_b64_tr_b16 v[170:171], v4 offset:4864
ds_read_b64_tr_b16 v[172:173], v4 offset:8960
ds_read_b64_tr_b16 v[174:175], v4 offset:13056
ds_read_b64_tr_b16 v[176:177], v5 offset:768
ds_read_b64_tr_b16 v[178:179], v5 offset:4864
ds_read_b64_tr_b16 v[180:181], v5 offset:8960
ds_read_b64_tr_b16 v[182:183], v5 offset:13056
s_lshl_b32 s29, s99, 7
s_lshl_b32 s9, s4, 5
s_add_u32 s29, s29, s9
s_lshl_b32 s9, s29, 2
s_add_u32 s9, s9, 0x3700000
buffer_load_dword v8, v20, s[88:91], s9 offen sc1
buffer_load_dword v9, v20, s[88:91], s9 offen offset:64 sc1
s_waitcnt lgkmcnt(8)
v_mfma_f32_16x16x32_bf16 v[56:59], v[152:155], a[64:67], 0
ds_read_b64_tr_b16 v[184:185], v4 offset:0
v_mov_b32 v88, 0
v_mfma_f32_16x16x32_bf16 v[56:59], v[156:159], a[72:75], v[56:59]
ds_read_b64_tr_b16 v[186:187], v4 offset:4096
v_mov_b32 v89, 0
v_mfma_f32_16x16x32_bf16 v[72:75], v[156:159], a[76:79], 0
ds_read_b64_tr_b16 v[188:189], v4 offset:8192
v_mov_b32 v90, 0
v_mfma_f32_16x16x32_bf16 v[72:75], v[152:155], a[68:71], v[72:75]
ds_read_b64_tr_b16 v[190:191], v4 offset:12288
v_mov_b32 v91, 0
v_mfma_f32_16x16x32_bf16 v[76:79], v[160:163], a[68:71], 0
ds_read_b64_tr_b16 v[192:193], v5 offset:0
v_mov_b32 v92, 0
v_mfma_f32_16x16x32_bf16 v[76:79], v[164:167], a[76:79], v[76:79]
ds_read_b64_tr_b16 v[194:195], v5 offset:4096
v_mov_b32 v93, 0
v_mfma_f32_16x16x32_bf16 v[60:63], v[164:167], a[72:75], 0
ds_read_b64_tr_b16 v[196:197], v5 offset:8192
s_waitcnt lgkmcnt(7)
v_mfma_f32_16x16x32_bf16 v[60:63], v[160:163], a[64:67], v[60:63]
ds_read_b64_tr_b16 v[198:199], v5 offset:12288
v_mov_b32 v94, 0
v_mfma_f32_16x16x32_bf16 v[64:67], v[168:171], a[64:67], 0
ds_read_b64_tr_b16 v[200:201], v4 offset:256
v_mov_b32 v95, 0
v_mfma_f32_16x16x32_bf16 v[64:67], v[172:175], a[72:75], v[64:67]
ds_read_b64_tr_b16 v[202:203], v4 offset:4352
v_mov_b32 v96, 0
v_mfma_f32_16x16x32_bf16 v[80:83], v[172:175], a[76:79], 0
ds_read_b64_tr_b16 v[204:205], v4 offset:8448
v_mov_b32 v97, 0
v_mfma_f32_16x16x32_bf16 v[80:83], v[168:171], a[68:71], v[80:83]
ds_read_b64_tr_b16 v[206:207], v4 offset:12544
v_mov_b32 v98, 0
v_mfma_f32_16x16x32_bf16 v[84:87], v[176:179], a[68:71], 0
ds_read_b64_tr_b16 v[208:209], v5 offset:256
v_mov_b32 v99, 0
v_mfma_f32_16x16x32_bf16 v[84:87], v[180:183], a[76:79], v[84:87]
ds_read_b64_tr_b16 v[210:211], v5 offset:4352
s_waitcnt vmcnt(2) lgkmcnt(6)
v_mfma_f32_16x16x32_bf16 v[68:71], v[180:183], a[72:75], 0
ds_read_b64_tr_b16 v[212:213], v5 offset:8448
s_barrier
v_mfma_f32_16x16x32_bf16 v[68:71], v[176:179], a[64:67], v[68:71]
ds_read_b64_tr_b16 v[214:215], v5 offset:12544
v_mov_b32 v100, 0
s_cmp_lg_u32 s4, 0
s_cbranch_scc1 L_flag_set
s_lshl_b32 s8, s6, 5
s_add_u32 s8, s8, s5
s_and_b32 s92, s8, 0xf0
s_mul_i32 s92, s92, 3
s_add_u32 s8, s8, s92
s_lshl_b32 s8, s8, 2
s_add_u32 s8, s8, 0x3704000
v_mov_b32 v21, 1
s_mov_b64 exec, 1
buffer_store_dword v21, off, s[88:91], s8 sc1
s_mov_b64 exec, -1
L_flag_set:
v_mfma_f32_16x16x32_bf16 v[24:27], v[184:187], a[64:67], 0
ds_read_b64_tr_b16 v[152:153], v4 offset:16896
s_lshl_b32 s29, s29, 11
v_mfma_f32_16x16x32_bf16 v[24:27], v[188:191], a[72:75], v[24:27]
ds_read_b64_tr_b16 v[154:155], v4 offset:20992
s_lshl_b32 s9, s100, 8
v_mfma_f32_16x16x32_bf16 v[40:43], v[188:191], a[76:79], 0
ds_read_b64_tr_b16 v[156:157], v4 offset:25088
s_add_u32 s29, s29, s9
v_mfma_f32_16x16x32_bf16 v[40:43], v[184:187], a[68:71], v[40:43]
ds_read_b64_tr_b16 v[158:159], v4 offset:29184
s_lshl_b32 s9, s14, 7
v_mfma_f32_16x16x32_bf16 v[44:47], v[192:195], a[68:71], 0
ds_read_b64_tr_b16 v[160:161], v5 offset:16896
s_add_u32 s29, s29, s9
v_mfma_f32_16x16x32_bf16 v[44:47], v[196:199], a[76:79], v[44:47]
ds_read_b64_tr_b16 v[162:163], v5 offset:20992
s_add_u32 s31, s29, 0x8000
v_mfma_f32_16x16x32_bf16 v[28:31], v[196:199], a[72:75], 0
ds_read_b64_tr_b16 v[164:165], v5 offset:25088
s_waitcnt lgkmcnt(7)
v_mfma_f32_16x16x32_bf16 v[28:31], v[192:195], a[64:67], v[28:31]
ds_read_b64_tr_b16 v[166:167], v5 offset:29184
s_lshl_b32 s28, s2, 2
v_mfma_f32_16x16x32_bf16 v[32:35], v[200:203], a[64:67], 0
ds_read_b64_tr_b16 v[168:169], v4 offset:17152
s_add_u32 s28, s28, s4
v_mfma_f32_16x16x32_bf16 v[32:35], v[204:207], a[72:75], v[32:35]
ds_read_b64_tr_b16 v[170:171], v4 offset:21248
s_lshl_b32 s28, s28, 12
v_mfma_f32_16x16x32_bf16 v[48:51], v[204:207], a[76:79], 0
ds_read_b64_tr_b16 v[172:173], v4 offset:25344
s_add_u32 s28, s28, 0x3800000
v_mfma_f32_16x16x32_bf16 v[48:51], v[200:203], a[68:71], v[48:51]
ds_read_b64_tr_b16 v[174:175], v4 offset:29440
s_xor_b32 s30, s28, 0x4000
v_mfma_f32_16x16x32_bf16 v[52:55], v[208:211], a[68:71], 0
ds_read_b64_tr_b16 v[176:177], v5 offset:17152
v_and_b32 v18, 16, v0
v_mfma_f32_16x16x32_bf16 v[52:55], v[212:215], a[76:79], v[52:55]
ds_read_b64_tr_b16 v[178:179], v5 offset:21248
s_waitcnt lgkmcnt(6)
v_mfma_f32_16x16x32_bf16 v[36:39], v[212:215], a[72:75], 0
ds_read_b64_tr_b16 v[180:181], v5 offset:25344
v_lshrrev_b32 v19, 5, v0
v_mfma_f32_16x16x32_bf16 v[36:39], v[208:211], a[64:67], v[36:39]
ds_read_b64_tr_b16 v[182:183], v5 offset:29440
v_lshlrev_b32 v19, 4, v19
v_mfma_f32_16x16x32_bf16 v[56:59], v[152:155], a[80:83], v[56:59]
ds_read_b64_tr_b16 v[184:185], v4 offset:16384
v_mov_b32 v101, 0
v_mfma_f32_16x16x32_bf16 v[56:59], v[156:159], a[88:91], v[56:59]
ds_read_b64_tr_b16 v[186:187], v4 offset:20480
v_mov_b32 v102, 0
v_mfma_f32_16x16x32_bf16 v[72:75], v[156:159], a[92:95], v[72:75]
ds_read_b64_tr_b16 v[188:189], v4 offset:24576
v_mov_b32 v103, 0
v_mfma_f32_16x16x32_bf16 v[72:75], v[152:155], a[84:87], v[72:75]
ds_read_b64_tr_b16 v[190:191], v4 offset:28672
v_mov_b32 v104, 0
v_mfma_f32_16x16x32_bf16 v[76:79], v[160:163], a[84:87], v[76:79]
ds_read_b64_tr_b16 v[192:193], v5 offset:16384
v_mov_b32 v105, 0
v_mfma_f32_16x16x32_bf16 v[76:79], v[164:167], a[92:95], v[76:79]
ds_read_b64_tr_b16 v[194:195], v5 offset:20480
v_mov_b32 v106, 0
v_mfma_f32_16x16x32_bf16 v[60:63], v[164:167], a[88:91], v[60:63]
ds_read_b64_tr_b16 v[196:197], v5 offset:24576
s_waitcnt lgkmcnt(7)
v_mfma_f32_16x16x32_bf16 v[60:63], v[160:163], a[80:83], v[60:63]
ds_read_b64_tr_b16 v[198:199], v5 offset:28672
v_mov_b32 v107, 0
v_mfma_f32_16x16x32_bf16 v[64:67], v[168:171], a[80:83], v[64:67]
ds_read_b64_tr_b16 v[200:201], v4 offset:16640
v_mov_b32 v108, 0
v_mfma_f32_16x16x32_bf16 v[64:67], v[172:175], a[88:91], v[64:67]
ds_read_b64_tr_b16 v[202:203], v4 offset:20736
v_mov_b32 v109, 0
v_mfma_f32_16x16x32_bf16 v[80:83], v[172:175], a[92:95], v[80:83]
ds_read_b64_tr_b16 v[204:205], v4 offset:24832
v_mov_b32 v110, 0
v_mfma_f32_16x16x32_bf16 v[80:83], v[168:171], a[84:87], v[80:83]
ds_read_b64_tr_b16 v[206:207], v4 offset:28928
v_mov_b32 v111, 0
v_mfma_f32_16x16x32_bf16 v[84:87], v[176:179], a[84:87], v[84:87]
ds_read_b64_tr_b16 v[208:209], v5 offset:16640
v_lshl_add_u32 v18, v18, 1, v19
v_mfma_f32_16x16x32_bf16 v[84:87], v[180:183], a[92:95], v[84:87]
ds_read_b64_tr_b16 v[210:211], v5 offset:20736
s_waitcnt vmcnt(14) lgkmcnt(6)
v_mfma_f32_16x16x32_bf16 v[68:71], v[180:183], a[88:91], v[68:71]
ds_read_b64_tr_b16 v[212:213], v5 offset:24832
s_barrier
v_mfma_f32_16x16x32_bf16 v[68:71], v[176:179], a[80:83], v[68:71]
ds_read_b64_tr_b16 v[214:215], v5 offset:28928
v_lshl_add_u32 v17, v20, 9, v18
s_cmp_eq_u32 s14, 1
s_cbranch_scc1 L_p4_skip
v_mfma_f32_16x16x32_bf16 v[24:27], v[184:187], a[80:83], v[24:27]
ds_read_b64_tr_b16 v[152:153], v6 offset:512
ds_read_b64_tr_b16 v[154:155], v6 offset:4608
v_mfma_f32_16x16x32_bf16 v[24:27], v[188:191], a[88:91], v[24:27]
ds_read_b64_tr_b16 v[156:157], v6 offset:8704
v_add_u32 v12, 0x20000, v12
v_mfma_f32_16x16x32_bf16 v[40:43], v[188:191], a[92:95], v[40:43]
ds_read_b64_tr_b16 v[158:159], v6 offset:12800
s_add_u32 m0, s17, 0x10000
v_mfma_f32_16x16x32_bf16 v[40:43], v[184:187], a[84:87], v[40:43]
buffer_load_dwordx4 v12, s[72:75], 0 offen lds
v_mfma_f32_16x16x32_bf16 v[44:47], v[192:195], a[84:87], v[44:47]
ds_read_b64_tr_b16 v[160:161], v7 offset:512
ds_read_b64_tr_b16 v[162:163], v7 offset:4608
v_mfma_f32_16x16x32_bf16 v[44:47], v[196:199], a[92:95], v[44:47]
ds_read_b64_tr_b16 v[164:165], v7 offset:8704
v_add_u32 v13, 0x20000, v13
v_mfma_f32_16x16x32_bf16 v[28:31], v[196:199], a[88:91], v[28:31]
ds_read_b64_tr_b16 v[166:167], v7 offset:12800
s_waitcnt lgkmcnt(8)
v_mfma_f32_16x16x32_bf16 v[28:31], v[192:195], a[80:83], v[28:31]
buffer_load_dwordx4 v13, s[72:75], 0 offen offset:1024 lds
v_mfma_f32_16x16x32_bf16 v[32:35], v[200:203], a[80:83], v[32:35]
ds_read_b64_tr_b16 v[168:169], v6 offset:768
ds_read_b64_tr_b16 v[170:171], v6 offset:4864
v_mfma_f32_16x16x32_bf16 v[32:35], v[204:207], a[88:91], v[32:35]
ds_read_b64_tr_b16 v[172:173], v6 offset:8960
v_mfma_f32_16x16x32_bf16 v[48:51], v[204:207], a[92:95], v[48:51]
ds_read_b64_tr_b16 v[174:175], v6 offset:13056
v_mfma_f32_16x16x32_bf16 v[48:51], v[200:203], a[84:87], v[48:51]
buffer_load_dwordx4 v12, s[72:75], s12 offen offset:2048 lds
v_mfma_f32_16x16x32_bf16 v[52:55], v[208:211], a[84:87], v[52:55]
ds_read_b64_tr_b16 v[176:177], v7 offset:768
ds_read_b64_tr_b16 v[178:179], v7 offset:4864
v_mfma_f32_16x16x32_bf16 v[52:55], v[212:215], a[92:95], v[52:55]
ds_read_b64_tr_b16 v[180:181], v7 offset:8960
s_waitcnt lgkmcnt(7)
v_mfma_f32_16x16x32_bf16 v[36:39], v[212:215], a[88:91], v[36:39]
ds_read_b64_tr_b16 v[182:183], v7 offset:13056
v_mfma_f32_16x16x32_bf16 v[36:39], v[208:211], a[80:83], v[36:39]
buffer_load_dwordx4 v13, s[72:75], s12 offen offset:3072 lds
v_mfma_f32_16x16x32_bf16 v[56:59], v[152:155], a[96:99], v[56:59]
ds_read_b64_tr_b16 v[184:185], v6 offset:0
ds_read_b64_tr_b16 v[186:187], v6 offset:4096
v_mfma_f32_16x16x32_bf16 v[56:59], v[156:159], a[104:107], v[56:59]
ds_read_b64_tr_b16 v[188:189], v6 offset:8192
v_mfma_f32_16x16x32_bf16 v[72:75], v[156:159], a[108:111], v[72:75]
ds_read_b64_tr_b16 v[190:191], v6 offset:12288
s_add_u32 s101, s101, 0x2000
v_mfma_f32_16x16x32_bf16 v[72:75], v[152:155], a[100:103], v[72:75]
buffer_load_dwordx4 a[64:67], v3, s[88:91], s101 offen sc1
v_mfma_f32_16x16x32_bf16 v[76:79], v[160:163], a[100:103], v[76:79]
ds_read_b64_tr_b16 v[192:193], v7 offset:0
ds_read_b64_tr_b16 v[194:195], v7 offset:4096
v_mfma_f32_16x16x32_bf16 v[76:79], v[164:167], a[108:111], v[76:79]
ds_read_b64_tr_b16 v[196:197], v7 offset:8192
v_mfma_f32_16x16x32_bf16 v[60:63], v[164:167], a[104:107], v[60:63]
ds_read_b64_tr_b16 v[198:199], v7 offset:12288
s_waitcnt lgkmcnt(8)
v_mfma_f32_16x16x32_bf16 v[60:63], v[160:163], a[96:99], v[60:63]
buffer_load_dwordx4 a[68:71], v3, s[88:91], s101 offen offset:1024 sc1
v_mfma_f32_16x16x32_bf16 v[64:67], v[168:171], a[96:99], v[64:67]
ds_read_b64_tr_b16 v[200:201], v6 offset:256
ds_read_b64_tr_b16 v[202:203], v6 offset:4352
v_mfma_f32_16x16x32_bf16 v[64:67], v[172:175], a[104:107], v[64:67]
ds_read_b64_tr_b16 v[204:205], v6 offset:8448
v_mfma_f32_16x16x32_bf16 v[80:83], v[172:175], a[108:111], v[80:83]
ds_read_b64_tr_b16 v[206:207], v6 offset:12544
s_add_u32 s101, s101, 0x2000
v_mfma_f32_16x16x32_bf16 v[80:83], v[168:171], a[100:103], v[80:83]
buffer_load_dwordx4 a[72:75], v3, s[88:91], s101 offen sc1
v_mfma_f32_16x16x32_bf16 v[84:87], v[176:179], a[100:103], v[84:87]
ds_read_b64_tr_b16 v[208:209], v7 offset:256
ds_read_b64_tr_b16 v[210:211], v7 offset:4352
v_mfma_f32_16x16x32_bf16 v[84:87], v[180:183], a[108:111], v[84:87]
ds_read_b64_tr_b16 v[212:213], v7 offset:8448
s_waitcnt vmcnt(17) lgkmcnt(7)
v_mfma_f32_16x16x32_bf16 v[68:71], v[180:183], a[104:107], v[68:71]
ds_read_b64_tr_b16 v[214:215], v7 offset:12544
s_barrier
v_mfma_f32_16x16x32_bf16 v[68:71], v[176:179], a[96:99], v[68:71]
buffer_load_dwordx4 a[76:79], v3, s[88:91], s101 offen offset:1024 sc1
v_mfma_f32_16x16x32_bf16 v[24:27], v[184:187], a[96:99], v[24:27]
ds_read_b64_tr_b16 v[152:153], v6 offset:16896
ds_read_b64_tr_b16 v[154:155], v6 offset:20992
v_mfma_f32_16x16x32_bf16 v[24:27], v[188:191], a[104:107], v[24:27]
ds_read_b64_tr_b16 v[156:157], v6 offset:25088
v_add_u32 v12, 0x20000, v12
v_mfma_f32_16x16x32_bf16 v[40:43], v[188:191], a[108:111], v[40:43]
ds_read_b64_tr_b16 v[158:159], v6 offset:29184
s_add_u32 m0, s17, 0x14000
v_mfma_f32_16x16x32_bf16 v[40:43], v[184:187], a[100:103], v[40:43]
buffer_load_dwordx4 v12, s[72:75], 0 offen lds
v_mfma_f32_16x16x32_bf16 v[44:47], v[192:195], a[100:103], v[44:47]
ds_read_b64_tr_b16 v[160:161], v7 offset:16896
ds_read_b64_tr_b16 v[162:163], v7 offset:20992
v_mfma_f32_16x16x32_bf16 v[44:47], v[196:199], a[108:111], v[44:47]
ds_read_b64_tr_b16 v[164:165], v7 offset:25088
v_add_u32 v13, 0x20000, v13
v_mfma_f32_16x16x32_bf16 v[28:31], v[196:199], a[104:107], v[28:31]
ds_read_b64_tr_b16 v[166:167], v7 offset:29184
s_waitcnt lgkmcnt(8)
v_mfma_f32_16x16x32_bf16 v[28:31], v[192:195], a[96:99], v[28:31]
buffer_load_dwordx4 v13, s[72:75], 0 offen offset:1024 lds
v_mfma_f32_16x16x32_bf16 v[32:35], v[200:203], a[96:99], v[32:35]
ds_read_b64_tr_b16 v[168:169], v6 offset:17152
ds_read_b64_tr_b16 v[170:171], v6 offset:21248
v_mfma_f32_16x16x32_bf16 v[32:35], v[204:207], a[104:107], v[32:35]
ds_read_b64_tr_b16 v[172:173], v6 offset:25344
v_mfma_f32_16x16x32_bf16 v[48:51], v[204:207], a[108:111], v[48:51]
ds_read_b64_tr_b16 v[174:175], v6 offset:29440
v_mfma_f32_16x16x32_bf16 v[48:51], v[200:203], a[100:103], v[48:51]
buffer_load_dwordx4 v12, s[72:75], s12 offen offset:2048 lds
v_mfma_f32_16x16x32_bf16 v[52:55], v[208:211], a[100:103], v[52:55]
ds_read_b64_tr_b16 v[176:177], v7 offset:17152
ds_read_b64_tr_b16 v[178:179], v7 offset:21248
v_mfma_f32_16x16x32_bf16 v[52:55], v[212:215], a[108:111], v[52:55]
ds_read_b64_tr_b16 v[180:181], v7 offset:25344
s_waitcnt lgkmcnt(7)
v_mfma_f32_16x16x32_bf16 v[36:39], v[212:215], a[104:107], v[36:39]
ds_read_b64_tr_b16 v[182:183], v7 offset:29440
v_mfma_f32_16x16x32_bf16 v[36:39], v[208:211], a[96:99], v[36:39]
buffer_load_dwordx4 v13, s[72:75], s12 offen offset:3072 lds
v_mfma_f32_16x16x32_bf16 v[56:59], v[152:155], a[112:115], v[56:59]
ds_read_b64_tr_b16 v[184:185], v6 offset:16384
ds_read_b64_tr_b16 v[186:187], v6 offset:20480
v_mfma_f32_16x16x32_bf16 v[56:59], v[156:159], a[120:123], v[56:59]
ds_read_b64_tr_b16 v[188:189], v6 offset:24576
v_mfma_f32_16x16x32_bf16 v[72:75], v[156:159], a[124:127], v[72:75]
ds_read_b64_tr_b16 v[190:191], v6 offset:28672
s_add_u32 s101, s101, 0x2000
v_mfma_f32_16x16x32_bf16 v[72:75], v[152:155], a[116:119], v[72:75]
buffer_load_dwordx4 a[80:83], v3, s[88:91], s101 offen sc1
v_mfma_f32_16x16x32_bf16 v[76:79], v[160:163], a[116:119], v[76:79]
ds_read_b64_tr_b16 v[192:193], v7 offset:16384
ds_read_b64_tr_b16 v[194:195], v7 offset:20480
v_mfma_f32_16x16x32_bf16 v[76:79], v[164:167], a[124:127], v[76:79]
ds_read_b64_tr_b16 v[196:197], v7 offset:24576
v_mfma_f32_16x16x32_bf16 v[60:63], v[164:167], a[120:123], v[60:63]
ds_read_b64_tr_b16 v[198:199], v7 offset:28672
s_waitcnt lgkmcnt(8)
v_mfma_f32_16x16x32_bf16 v[60:63], v[160:163], a[112:115], v[60:63]
buffer_load_dwordx4 a[84:87], v3, s[88:91], s101 offen offset:1024 sc1
v_mfma_f32_16x16x32_bf16 v[64:67], v[168:171], a[112:115], v[64:67]
ds_read_b64_tr_b16 v[200:201], v6 offset:16640
ds_read_b64_tr_b16 v[202:203], v6 offset:20736
v_mfma_f32_16x16x32_bf16 v[64:67], v[172:175], a[120:123], v[64:67]
ds_read_b64_tr_b16 v[204:205], v6 offset:24832
v_mfma_f32_16x16x32_bf16 v[80:83], v[172:175], a[124:127], v[80:83]
ds_read_b64_tr_b16 v[206:207], v6 offset:28928
s_add_u32 s101, s101, 0x2000
v_mfma_f32_16x16x32_bf16 v[80:83], v[168:171], a[116:119], v[80:83]
buffer_load_dwordx4 a[88:91], v3, s[88:91], s101 offen sc1
v_mfma_f32_16x16x32_bf16 v[84:87], v[176:179], a[116:119], v[84:87]
ds_read_b64_tr_b16 v[208:209], v7 offset:16640
ds_read_b64_tr_b16 v[210:211], v7 offset:20736
v_mfma_f32_16x16x32_bf16 v[84:87], v[180:183], a[124:127], v[84:87]
ds_read_b64_tr_b16 v[212:213], v7 offset:24832
s_waitcnt vmcnt(7) lgkmcnt(7)
v_mfma_f32_16x16x32_bf16 v[68:71], v[180:183], a[120:123], v[68:71]
ds_read_b64_tr_b16 v[214:215], v7 offset:28928
s_barrier
v_mfma_f32_16x16x32_bf16 v[68:71], v[176:179], a[112:115], v[68:71]
buffer_load_dwordx4 a[92:95], v3, s[88:91], s101 offen offset:1024 sc1
v_mfma_f32_16x16x32_bf16 v[24:27], v[184:187], a[112:115], v[24:27]
ds_read_b64_tr_b16 v[152:153], v4 offset:512
ds_read_b64_tr_b16 v[154:155], v4 offset:4608
v_mfma_f32_16x16x32_bf16 v[24:27], v[188:191], a[120:123], v[24:27]
ds_read_b64_tr_b16 v[156:157], v4 offset:8704
v_add_u32 v12, 0x20000, v12
v_mfma_f32_16x16x32_bf16 v[40:43], v[188:191], a[124:127], v[40:43]
ds_read_b64_tr_b16 v[158:159], v4 offset:12800
s_add_u32 m0, s16, 0x0
v_mfma_f32_16x16x32_bf16 v[40:43], v[184:187], a[116:119], v[40:43]
buffer_load_dwordx4 v12, s[72:75], 0 offen lds
v_mfma_f32_16x16x32_bf16 v[44:47], v[192:195], a[116:119], v[44:47]
ds_read_b64_tr_b16 v[160:161], v5 offset:512
ds_read_b64_tr_b16 v[162:163], v5 offset:4608
v_mfma_f32_16x16x32_bf16 v[44:47], v[196:199], a[124:127], v[44:47]
ds_read_b64_tr_b16 v[164:165], v5 offset:8704
v_add_u32 v13, 0x20000, v13
v_mfma_f32_16x16x32_bf16 v[28:31], v[196:199], a[120:123], v[28:31]
ds_read_b64_tr_b16 v[166:167], v5 offset:12800
s_waitcnt lgkmcnt(8)
v_mfma_f32_16x16x32_bf16 v[28:31], v[192:195], a[112:115], v[28:31]
buffer_load_dwordx4 v13, s[72:75], 0 offen offset:1024 lds
v_mfma_f32_16x16x32_bf16 v[32:35], v[200:203], a[112:115], v[32:35]
ds_read_b64_tr_b16 v[168:169], v4 offset:768
ds_read_b64_tr_b16 v[170:171], v4 offset:4864
v_mfma_f32_16x16x32_bf16 v[32:35], v[204:207], a[120:123], v[32:35]
ds_read_b64_tr_b16 v[172:173], v4 offset:8960
v_mfma_f32_16x16x32_bf16 v[48:51], v[204:207], a[124:127], v[48:51]
ds_read_b64_tr_b16 v[174:175], v4 offset:13056
v_mfma_f32_16x16x32_bf16 v[48:51], v[200:203], a[116:119], v[48:51]
buffer_load_dwordx4 v12, s[72:75], s12 offen offset:2048 lds
v_mfma_f32_16x16x32_bf16 v[52:55], v[208:211], a[116:119], v[52:55]
ds_read_b64_tr_b16 v[176:177], v5 offset:768
ds_read_b64_tr_b16 v[178:179], v5 offset:4864
v_mfma_f32_16x16x32_bf16 v[52:55], v[212:215], a[124:127], v[52:55]
ds_read_b64_tr_b16 v[180:181], v5 offset:8960
s_waitcnt lgkmcnt(7)
v_mfma_f32_16x16x32_bf16 v[36:39], v[212:215], a[120:123], v[36:39]
ds_read_b64_tr_b16 v[182:183], v5 offset:13056
v_mfma_f32_16x16x32_bf16 v[36:39], v[208:211], a[112:115], v[36:39]
buffer_load_dwordx4 v13, s[72:75], s12 offen offset:3072 lds
v_mfma_f32_16x16x32_bf16 v[56:59], v[152:155], a[64:67], v[56:59]
ds_read_b64_tr_b16 v[184:185], v4 offset:0
ds_read_b64_tr_b16 v[186:187], v4 offset:4096
v_mfma_f32_16x16x32_bf16 v[56:59], v[156:159], a[72:75], v[56:59]
ds_read_b64_tr_b16 v[188:189], v4 offset:8192
v_mfma_f32_16x16x32_bf16 v[72:75], v[156:159], a[76:79], v[72:75]
ds_read_b64_tr_b16 v[190:191], v4 offset:12288
s_add_u32 s101, s101, 0x2000
v_mfma_f32_16x16x32_bf16 v[72:75], v[152:155], a[68:71], v[72:75]
buffer_load_dwordx4 a[96:99], v3, s[88:91], s101 offen sc1
v_mfma_f32_16x16x32_bf16 v[76:79], v[160:163], a[68:71], v[76:79]
ds_read_b64_tr_b16 v[192:193], v5 offset:0
ds_read_b64_tr_b16 v[194:195], v5 offset:4096
v_mfma_f32_16x16x32_bf16 v[76:79], v[164:167], a[76:79], v[76:79]
ds_read_b64_tr_b16 v[196:197], v5 offset:8192
v_mfma_f32_16x16x32_bf16 v[60:63], v[164:167], a[72:75], v[60:63]
ds_read_b64_tr_b16 v[198:199], v5 offset:12288
s_waitcnt lgkmcnt(8)
v_mfma_f32_16x16x32_bf16 v[60:63], v[160:163], a[64:67], v[60:63]
buffer_load_dwordx4 a[100:103], v3, s[88:91], s101 offen offset:1024 sc1
v_mfma_f32_16x16x32_bf16 v[64:67], v[168:171], a[64:67], v[64:67]
ds_read_b64_tr_b16 v[200:201], v4 offset:256
ds_read_b64_tr_b16 v[202:203], v4 offset:4352
v_mfma_f32_16x16x32_bf16 v[64:67], v[172:175], a[72:75], v[64:67]
ds_read_b64_tr_b16 v[204:205], v4 offset:8448
v_mfma_f32_16x16x32_bf16 v[80:83], v[172:175], a[76:79], v[80:83]
ds_read_b64_tr_b16 v[206:207], v4 offset:12544
s_add_u32 s101, s101, 0x2000
v_mfma_f32_16x16x32_bf16 v[80:83], v[168:171], a[68:71], v[80:83]
buffer_load_dwordx4 a[104:107], v3, s[88:91], s101 offen sc1
v_mfma_f32_16x16x32_bf16 v[84:87], v[176:179], a[68:71], v[84:87]
ds_read_b64_tr_b16 v[208:209], v5 offset:256
ds_read_b64_tr_b16 v[210:211], v5 offset:4352
v_mfma_f32_16x16x32_bf16 v[84:87], v[180:183], a[76:79], v[84:87]
ds_read_b64_tr_b16 v[212:213], v5 offset:8448
s_waitcnt vmcnt(7) lgkmcnt(7)
v_mfma_f32_16x16x32_bf16 v[68:71], v[180:183], a[72:75], v[68:71]
ds_read_b64_tr_b16 v[214:215], v5 offset:12544
s_barrier
v_mfma_f32_16x16x32_bf16 v[68:71], v[176:179], a[64:67], v[68:71]
buffer_load_dwordx4 a[108:111], v3, s[88:91], s101 offen offset:1024 sc1
v_mfma_f32_16x16x32_bf16 v[24:27], v[184:187], a[64:67], v[24:27]
ds_read_b64_tr_b16 v[152:153], v4 offset:16896
ds_read_b64_tr_b16 v[154:155], v4 offset:20992
v_mfma_f32_16x16x32_bf16 v[24:27], v[188:191], a[72:75], v[24:27]
ds_read_b64_tr_b16 v[156:157], v4 offset:25088
v_add_u32 v12, 0x20000, v12
v_mfma_f32_16x16x32_bf16 v[40:43], v[188:191], a[76:79], v[40:43]
ds_read_b64_tr_b16 v[158:159], v4 offset:29184
s_add_u32 m0, s16, 0x4000
v_mfma_f32_16x16x32_bf16 v[40:43], v[184:187], a[68:71], v[40:43]
buffer_load_dwordx4 v12, s[72:75], 0 offen lds
v_mfma_f32_16x16x32_bf16 v[44:47], v[192:195], a[68:71], v[44:47]
ds_read_b64_tr_b16 v[160:161], v5 offset:16896
ds_read_b64_tr_b16 v[162:163], v5 offset:20992
v_mfma_f32_16x16x32_bf16 v[44:47], v[196:199], a[76:79], v[44:47]
ds_read_b64_tr_b16 v[164:165], v5 offset:25088
v_add_u32 v13, 0x20000, v13
v_mfma_f32_16x16x32_bf16 v[28:31], v[196:199], a[72:75], v[28:31]
ds_read_b64_tr_b16 v[166:167], v5 offset:29184
s_waitcnt lgkmcnt(8)
v_mfma_f32_16x16x32_bf16 v[28:31], v[192:195], a[64:67], v[28:31]
buffer_load_dwordx4 v13, s[72:75], 0 offen offset:1024 lds
v_mfma_f32_16x16x32_bf16 v[32:35], v[200:203], a[64:67], v[32:35]
ds_read_b64_tr_b16 v[168:169], v4 offset:17152
ds_read_b64_tr_b16 v[170:171], v4 offset:21248
v_mfma_f32_16x16x32_bf16 v[32:35], v[204:207], a[72:75], v[32:35]
ds_read_b64_tr_b16 v[172:173], v4 offset:25344
v_mfma_f32_16x16x32_bf16 v[48:51], v[204:207], a[76:79], v[48:51]
ds_read_b64_tr_b16 v[174:175], v4 offset:29440
v_mfma_f32_16x16x32_bf16 v[48:51], v[200:203], a[68:71], v[48:51]
buffer_load_dwordx4 v12, s[72:75], s12 offen offset:2048 lds
v_mfma_f32_16x16x32_bf16 v[52:55], v[208:211], a[68:71], v[52:55]
ds_read_b64_tr_b16 v[176:177], v5 offset:17152
ds_read_b64_tr_b16 v[178:179], v5 offset:21248
v_mfma_f32_16x16x32_bf16 v[52:55], v[212:215], a[76:79], v[52:55]
ds_read_b64_tr_b16 v[180:181], v5 offset:25344
s_waitcnt lgkmcnt(7)
v_mfma_f32_16x16x32_bf16 v[36:39], v[212:215], a[72:75], v[36:39]
ds_read_b64_tr_b16 v[182:183], v5 offset:29440
v_mfma_f32_16x16x32_bf16 v[36:39], v[208:211], a[64:67], v[36:39]
buffer_load_dwordx4 v13, s[72:75], s12 offen offset:3072 lds
v_mfma_f32_16x16x32_bf16 v[56:59], v[152:155], a[80:83], v[56:59]
ds_read_b64_tr_b16 v[184:185], v4 offset:16384
ds_read_b64_tr_b16 v[186:187], v4 offset:20480
v_mfma_f32_16x16x32_bf16 v[56:59], v[156:159], a[88:91], v[56:59]
ds_read_b64_tr_b16 v[188:189], v4 offset:24576
v_mfma_f32_16x16x32_bf16 v[72:75], v[156:159], a[92:95], v[72:75]
ds_read_b64_tr_b16 v[190:191], v4 offset:28672
s_add_u32 s101, s101, 0x2000
v_mfma_f32_16x16x32_bf16 v[72:75], v[152:155], a[84:87], v[72:75]
buffer_load_dwordx4 a[112:115], v3, s[88:91], s101 offen sc1
v_mfma_f32_16x16x32_bf16 v[76:79], v[160:163], a[84:87], v[76:79]
ds_read_b64_tr_b16 v[192:193], v5 offset:16384
ds_read_b64_tr_b16 v[194:195], v5 offset:20480
v_mfma_f32_16x16x32_bf16 v[76:79], v[164:167], a[92:95], v[76:79]
ds_read_b64_tr_b16 v[196:197], v5 offset:24576
v_mfma_f32_16x16x32_bf16 v[60:63], v[164:167], a[88:91], v[60:63]
ds_read_b64_tr_b16 v[198:199], v5 offset:28672
s_waitcnt lgkmcnt(8)
v_mfma_f32_16x16x32_bf16 v[60:63], v[160:163], a[80:83], v[60:63]
buffer_load_dwordx4 a[116:119], v3, s[88:91], s101 offen offset:1024 sc1
v_mfma_f32_16x16x32_bf16 v[64:67], v[168:171], a[80:83], v[64:67]
ds_read_b64_tr_b16 v[200:201], v4 offset:16640
ds_read_b64_tr_b16 v[202:203], v4 offset:20736
v_mfma_f32_16x16x32_bf16 v[64:67], v[172:175], a[88:91], v[64:67]
ds_read_b64_tr_b16 v[204:205], v4 offset:24832
v_mfma_f32_16x16x32_bf16 v[80:83], v[172:175], a[92:95], v[80:83]
ds_read_b64_tr_b16 v[206:207], v4 offset:28928
s_add_u32 s101, s101, 0x2000
v_mfma_f32_16x16x32_bf16 v[80:83], v[168:171], a[84:87], v[80:83]
buffer_load_dwordx4 a[120:123], v3, s[88:91], s101 offen sc1
v_mfma_f32_16x16x32_bf16 v[84:87], v[176:179], a[84:87], v[84:87]
ds_read_b64_tr_b16 v[208:209], v5 offset:16640
ds_read_b64_tr_b16 v[210:211], v5 offset:20736
v_mfma_f32_16x16x32_bf16 v[84:87], v[180:183], a[92:95], v[84:87]
ds_read_b64_tr_b16 v[212:213], v5 offset:24832
s_waitcnt vmcnt(7) lgkmcnt(7)
v_mfma_f32_16x16x32_bf16 v[68:71], v[180:183], a[88:91], v[68:71]
ds_read_b64_tr_b16 v[214:215], v5 offset:28928
s_barrier
v_mfma_f32_16x16x32_bf16 v[68:71], v[176:179], a[80:83], v[68:71]
buffer_load_dwordx4 a[124:127], v3, s[88:91], s101 offen offset:1024 sc1
L_p4_skip:
v_mfma_f32_16x16x32_bf16 v[24:27], v[184:187], a[80:83], v[24:27]
ds_read_b64_tr_b16 v[152:153], v6 offset:512
ds_read_b64_tr_b16 v[154:155], v6 offset:4608
v_mfma_f32_16x16x32_bf16 v[24:27], v[188:191], a[88:91], v[24:27]
ds_read_b64_tr_b16 v[156:157], v6 offset:8704
v_add_u32 v12, 0x20000, v12
v_mfma_f32_16x16x32_bf16 v[40:43], v[188:191], a[92:95], v[40:43]
ds_read_b64_tr_b16 v[158:159], v6 offset:12800
s_add_u32 m0, s17, 0x10000
v_mfma_f32_16x16x32_bf16 v[40:43], v[184:187], a[84:87], v[40:43]
buffer_load_dwordx4 v12, s[72:75], 0 offen lds
v_mfma_f32_16x16x32_bf16 v[44:47], v[192:195], a[84:87], v[44:47]
ds_read_b64_tr_b16 v[160:161], v7 offset:512
ds_read_b64_tr_b16 v[162:163], v7 offset:4608
v_mfma_f32_16x16x32_bf16 v[44:47], v[196:199], a[92:95], v[44:47]
ds_read_b64_tr_b16 v[164:165], v7 offset:8704
v_add_u32 v13, 0x20000, v13
v_mfma_f32_16x16x32_bf16 v[28:31], v[196:199], a[88:91], v[28:31]
ds_read_b64_tr_b16 v[166:167], v7 offset:12800
s_waitcnt lgkmcnt(8)
v_mfma_f32_16x16x32_bf16 v[28:31], v[192:195], a[80:83], v[28:31]
buffer_load_dwordx4 v13, s[72:75], 0 offen offset:1024 lds
v_mfma_f32_16x16x32_bf16 v[32:35], v[200:203], a[80:83], v[32:35]
ds_read_b64_tr_b16 v[168:169], v6 offset:768
ds_read_b64_tr_b16 v[170:171], v6 offset:4864
v_mfma_f32_16x16x32_bf16 v[32:35], v[204:207], a[88:91], v[32:35]
ds_read_b64_tr_b16 v[172:173], v6 offset:8960
v_mfma_f32_16x16x32_bf16 v[48:51], v[204:207], a[92:95], v[48:51]
ds_read_b64_tr_b16 v[174:175], v6 offset:13056
v_mfma_f32_16x16x32_bf16 v[48:51], v[200:203], a[84:87], v[48:51]
buffer_load_dwordx4 v12, s[72:75], s12 offen offset:2048 lds
v_mfma_f32_16x16x32_bf16 v[52:55], v[208:211], a[84:87], v[52:55]
ds_read_b64_tr_b16 v[176:177], v7 offset:768
ds_read_b64_tr_b16 v[178:179], v7 offset:4864
v_mfma_f32_16x16x32_bf16 v[52:55], v[212:215], a[92:95], v[52:55]
ds_read_b64_tr_b16 v[180:181], v7 offset:8960
s_waitcnt lgkmcnt(7)
v_mfma_f32_16x16x32_bf16 v[36:39], v[212:215], a[88:91], v[36:39]
ds_read_b64_tr_b16 v[182:183], v7 offset:13056
v_mfma_f32_16x16x32_bf16 v[36:39], v[208:211], a[80:83], v[36:39]
buffer_load_dwordx4 v13, s[72:75], s12 offen offset:3072 lds
v_mfma_f32_16x16x32_bf16 v[56:59], v[152:155], a[96:99], v[56:59]
ds_read_b64_tr_b16 v[184:185], v6 offset:0
ds_read_b64_tr_b16 v[186:187], v6 offset:4096
v_mfma_f32_16x16x32_bf16 v[56:59], v[156:159], a[104:107], v[56:59]
ds_read_b64_tr_b16 v[188:189], v6 offset:8192
v_mov_b32 v112, 0
v_mfma_f32_16x16x32_bf16 v[72:75], v[156:159], a[108:111], v[72:75]
ds_read_b64_tr_b16 v[190:191], v6 offset:12288
s_add_u32 s101, s101, 0x2000
v_mfma_f32_16x16x32_bf16 v[72:75], v[152:155], a[100:103], v[72:75]
buffer_load_dwordx4 a[64:67], v3, s[88:91], s101 offen sc1
v_mfma_f32_16x16x32_bf16 v[76:79], v[160:163], a[100:103], v[76:79]
ds_read_b64_tr_b16 v[192:193], v7 offset:0
ds_read_b64_tr_b16 v[194:195], v7 offset:4096
v_mfma_f32_16x16x32_bf16 v[76:79], v[164:167], a[108:111], v[76:79]
ds_read_b64_tr_b16 v[196:197], v7 offset:8192
v_mov_b32 v113, 0
v_mfma_f32_16x16x32_bf16 v[60:63], v[164:167], a[104:107], v[60:63]
ds_read_b64_tr_b16 v[198:199], v7 offset:12288
s_waitcnt lgkmcnt(8)
v_mfma_f32_16x16x32_bf16 v[60:63], v[160:163], a[96:99], v[60:63]
buffer_load_dwordx4 a[68:71], v3, s[88:91], s101 offen offset:1024 sc1
v_mfma_f32_16x16x32_bf16 v[64:67], v[168:171], a[96:99], v[64:67]
ds_read_b64_tr_b16 v[200:201], v6 offset:256
ds_read_b64_tr_b16 v[202:203], v6 offset:4352
v_mfma_f32_16x16x32_bf16 v[64:67], v[172:175], a[104:107], v[64:67]
ds_read_b64_tr_b16 v[204:205], v6 offset:8448
v_mov_b32 v114, 0
v_mfma_f32_16x16x32_bf16 v[80:83], v[172:175], a[108:111], v[80:83]
ds_read_b64_tr_b16 v[206:207], v6 offset:12544
s_add_u32 s101, s101, 0x2000
v_mfma_f32_16x16x32_bf16 v[80:83], v[168:171], a[100:103], v[80:83]
buffer_load_dwordx4 a[72:75], v3, s[88:91], s101 offen sc1
v_mfma_f32_16x16x32_bf16 v[84:87], v[176:179], a[100:103], v[84:87]
ds_read_b64_tr_b16 v[208:209], v7 offset:256
ds_read_b64_tr_b16 v[210:211], v7 offset:4352
v_mfma_f32_16x16x32_bf16 v[84:87], v[180:183], a[108:111], v[84:87]
ds_read_b64_tr_b16 v[212:213], v7 offset:8448
s_waitcnt vmcnt(7) lgkmcnt(7)
v_mfma_f32_16x16x32_bf16 v[68:71], v[180:183], a[104:107], v[68:71]
ds_read_b64_tr_b16 v[214:215], v7 offset:12544
s_barrier
v_mfma_f32_16x16x32_bf16 v[68:71], v[176:179], a[96:99], v[68:71]
buffer_load_dwordx4 a[76:79], v3, s[88:91], s101 offen offset:1024 sc1
v_mov_b32 v115, 0
buffer_load_dword v14, v16, s[88:91], s24 offen sc1
v_mfma_f32_16x16x32_bf16 v[24:27], v[184:187], a[96:99], v[24:27]
ds_read_b64_tr_b16 v[152:153], v6 offset:16896
ds_read_b64_tr_b16 v[154:155], v6 offset:20992
v_mfma_f32_16x16x32_bf16 v[24:27], v[188:191], a[104:107], v[24:27]
ds_read_b64_tr_b16 v[156:157], v6 offset:25088
v_add_u32 v12, 0x20000, v12
v_mfma_f32_16x16x32_bf16 v[40:43], v[188:191], a[108:111], v[40:43]
ds_read_b64_tr_b16 v[158:159], v6 offset:29184
s_add_u32 m0, s17, 0x14000
v_mfma_f32_16x16x32_bf16 v[40:43], v[184:187], a[100:103], v[40:43]
buffer_load_dwordx4 v12, s[72:75], 0 offen lds
v_mfma_f32_16x16x32_bf16 v[44:47], v[192:195], a[100:103], v[44:47]
ds_read_b64_tr_b16 v[160:161], v7 offset:16896
ds_read_b64_tr_b16 v[162:163], v7 offset:20992
v_mfma_f32_16x16x32_bf16 v[44:47], v[196:199], a[108:111], v[44:47]
ds_read_b64_tr_b16 v[164:165], v7 offset:25088
v_add_u32 v13, 0x20000, v13
v_mfma_f32_16x16x32_bf16 v[28:31], v[196:199], a[104:107], v[28:31]
ds_read_b64_tr_b16 v[166:167], v7 offset:29184
s_waitcnt lgkmcnt(8)
v_mfma_f32_16x16x32_bf16 v[28:31], v[192:195], a[96:99], v[28:31]
buffer_load_dwordx4 v13, s[72:75], 0 offen offset:1024 lds
v_mfma_f32_16x16x32_bf16 v[32:35], v[200:203], a[96:99], v[32:35]
ds_read_b64_tr_b16 v[168:169], v6 offset:17152
ds_read_b64_tr_b16 v[170:171], v6 offset:21248
v_mfma_f32_16x16x32_bf16 v[32:35], v[204:207], a[104:107], v[32:35]
ds_read_b64_tr_b16 v[172:173], v6 offset:25344
v_mfma_f32_16x16x32_bf16 v[48:51], v[204:207], a[108:111], v[48:51]
ds_read_b64_tr_b16 v[174:175], v6 offset:29440
v_mfma_f32_16x16x32_bf16 v[48:51], v[200:203], a[100:103], v[48:51]
buffer_load_dwordx4 v12, s[72:75], s12 offen offset:2048 lds
v_mfma_f32_16x16x32_bf16 v[52:55], v[208:211], a[100:103], v[52:55]
ds_read_b64_tr_b16 v[176:177], v7 offset:17152
ds_read_b64_tr_b16 v[178:179], v7 offset:21248
v_mfma_f32_16x16x32_bf16 v[52:55], v[212:215], a[108:111], v[52:55]
ds_read_b64_tr_b16 v[180:181], v7 offset:25344
s_waitcnt lgkmcnt(7)
v_mfma_f32_16x16x32_bf16 v[36:39], v[212:215], a[104:107], v[36:39]
ds_read_b64_tr_b16 v[182:183], v7 offset:29440
v_mfma_f32_16x16x32_bf16 v[36:39], v[208:211], a[96:99], v[36:39]
buffer_load_dwordx4 v13, s[72:75], s12 offen offset:3072 lds
v_mfma_f32_16x16x32_bf16 v[56:59], v[152:155], a[112:115], v[56:59]
ds_read_b64_tr_b16 v[184:185], v6 offset:16384
ds_read_b64_tr_b16 v[186:187], v6 offset:20480
v_mfma_f32_16x16x32_bf16 v[56:59], v[156:159], a[120:123], v[56:59]
ds_read_b64_tr_b16 v[188:189], v6 offset:24576
v_mov_b32 v116, 0
v_mfma_f32_16x16x32_bf16 v[72:75], v[156:159], a[124:127], v[72:75]
ds_read_b64_tr_b16 v[190:191], v6 offset:28672
s_add_u32 s101, s101, 0x2000
v_mfma_f32_16x16x32_bf16 v[72:75], v[152:155], a[116:119], v[72:75]
buffer_load_dwordx4 a[80:83], v3, s[88:91], s101 offen sc1
v_mfma_f32_16x16x32_bf16 v[76:79], v[160:163], a[116:119], v[76:79]
ds_read_b64_tr_b16 v[192:193], v7 offset:16384
ds_read_b64_tr_b16 v[194:195], v7 offset:20480
v_mfma_f32_16x16x32_bf16 v[76:79], v[164:167], a[124:127], v[76:79]
ds_read_b64_tr_b16 v[196:197], v7 offset:24576
v_mov_b32 v117, 0
v_mfma_f32_16x16x32_bf16 v[60:63], v[164:167], a[120:123], v[60:63]
ds_read_b64_tr_b16 v[198:199], v7 offset:28672
s_waitcnt lgkmcnt(8)
v_mfma_f32_16x16x32_bf16 v[60:63], v[160:163], a[112:115], v[60:63]
buffer_load_dwordx4 a[84:87], v3, s[88:91], s101 offen offset:1024 sc1
v_mfma_f32_16x16x32_bf16 v[64:67], v[168:171], a[112:115], v[64:67]
ds_read_b64_tr_b16 v[200:201], v6 offset:16640
ds_read_b64_tr_b16 v[202:203], v6 offset:20736
v_mfma_f32_16x16x32_bf16 v[64:67], v[172:175], a[120:123], v[64:67]
ds_read_b64_tr_b16 v[204:205], v6 offset:24832
v_mov_b32 v118, 0
v_mfma_f32_16x16x32_bf16 v[80:83], v[172:175], a[124:127], v[80:83]
ds_read_b64_tr_b16 v[206:207], v6 offset:28928
s_add_u32 s101, s101, 0x2000
v_mfma_f32_16x16x32_bf16 v[80:83], v[168:171], a[116:119], v[80:83]
buffer_load_dwordx4 a[88:91], v3, s[88:91], s101 offen sc1
v_mfma_f32_16x16x32_bf16 v[84:87], v[176:179], a[116:119], v[84:87]
ds_read_b64_tr_b16 v[208:209], v7 offset:16640
ds_read_b64_tr_b16 v[210:211], v7 offset:20736
v_mfma_f32_16x16x32_bf16 v[84:87], v[180:183], a[124:127], v[84:87]
ds_read_b64_tr_b16 v[212:213], v7 offset:24832
s_waitcnt vmcnt(7) lgkmcnt(7)
v_mfma_f32_16x16x32_bf16 v[68:71], v[180:183], a[120:123], v[68:71]
ds_read_b64_tr_b16 v[214:215], v7 offset:28928
s_barrier
v_mfma_f32_16x16x32_bf16 v[68:71], v[176:179], a[112:115], v[68:71]
buffer_load_dwordx4 a[92:95], v3, s[88:91], s101 offen offset:1024 sc1
v_mov_b32 v119, 0
s_mov_b32 s92, 200000
L_spin_c:
v_cmp_ne_u32 vcc, 1, v14
s_nop 4
s_cbranch_vccz L_spun_c
s_sub_u32 s92, s92, 1
s_cbranch_scc1 L_spun_c
s_sleep 6
buffer_load_dword v14, v16, s[88:91], s24 offen sc1
s_waitcnt vmcnt(0)
s_branch L_spin_c
L_spun_c:
v_mfma_f32_16x16x32_bf16 v[24:27], v[184:187], a[112:115], v[24:27]
ds_read_b64_tr_b16 v[152:153], v4 offset:512
ds_read_b64_tr_b16 v[154:155], v4 offset:4608
v_mfma_f32_16x16x32_bf16 v[24:27], v[188:191], a[120:123], v[24:27]
ds_read_b64_tr_b16 v[156:157], v4 offset:8704
v_add_u32 v12, s25, v12
v_mfma_f32_16x16x32_bf16 v[40:43], v[188:191], a[124:127], v[40:43]
ds_read_b64_tr_b16 v[158:159], v4 offset:12800
s_add_u32 m0, s16, 0x0
v_mfma_f32_16x16x32_bf16 v[40:43], v[184:187], a[116:119], v[40:43]
buffer_load_dwordx4 v12, s[64:67], s61 offen lds
v_mfma_f32_16x16x32_bf16 v[44:47], v[192:195], a[116:119], v[44:47]
ds_read_b64_tr_b16 v[160:161], v5 offset:512
ds_read_b64_tr_b16 v[162:163], v5 offset:4608
v_mfma_f32_16x16x32_bf16 v[44:47], v[196:199], a[124:127], v[44:47]
ds_read_b64_tr_b16 v[164:165], v5 offset:8704
v_add_u32 v13, s25, v13
v_mfma_f32_16x16x32_bf16 v[28:31], v[196:199], a[120:123], v[28:31]
ds_read_b64_tr_b16 v[166:167], v5 offset:12800
s_waitcnt lgkmcnt(8)
v_mfma_f32_16x16x32_bf16 v[28:31], v[192:195], a[112:115], v[28:31]
buffer_load_dwordx4 v13, s[64:67], s61 offen offset:1024 lds
v_mfma_f32_16x16x32_bf16 v[32:35], v[200:203], a[112:115], v[32:35]
ds_read_b64_tr_b16 v[168:169], v4 offset:768
ds_read_b64_tr_b16 v[170:171], v4 offset:4864
v_mfma_f32_16x16x32_bf16 v[32:35], v[204:207], a[120:123], v[32:35]
ds_read_b64_tr_b16 v[172:173], v4 offset:8960
s_add_u32 s63, s101, s26
v_mfma_f32_16x16x32_bf16 v[48:51], v[204:207], a[124:127], v[48:51]
ds_read_b64_tr_b16 v[174:175], v4 offset:13056
s_add_u32 s101, s63, s60
v_mfma_f32_16x16x32_bf16 v[48:51], v[200:203], a[116:119], v[48:51]
buffer_load_dwordx4 v12, s[64:67], s62 offen offset:2048 lds
v_mfma_f32_16x16x32_bf16 v[52:55], v[208:211], a[116:119], v[52:55]
ds_read_b64_tr_b16 v[176:177], v5 offset:768
ds_read_b64_tr_b16 v[178:179], v5 offset:4864
v_mfma_f32_16x16x32_bf16 v[52:55], v[212:215], a[124:127], v[52:55]
ds_read_b64_tr_b16 v[180:181], v5 offset:8960
s_waitcnt lgkmcnt(7)
v_mfma_f32_16x16x32_bf16 v[36:39], v[212:215], a[120:123], v[36:39]
ds_read_b64_tr_b16 v[182:183], v5 offset:13056
v_mfma_f32_16x16x32_bf16 v[36:39], v[208:211], a[112:115], v[36:39]
buffer_load_dwordx4 v13, s[64:67], s62 offen offset:3072 lds
v_mfma_f32_16x16x32_bf16 v[56:59], v[152:155], a[64:67], v[56:59]
ds_read_b64_tr_b16 v[184:185], v4 offset:0
ds_read_b64_tr_b16 v[186:187], v4 offset:4096
v_mfma_f32_16x16x32_bf16 v[56:59], v[156:159], a[72:75], v[56:59]
ds_read_b64_tr_b16 v[188:189], v4 offset:8192
s_add_u32 s60, s60, s57
v_mfma_f32_16x16x32_bf16 v[72:75], v[156:159], a[76:79], v[72:75]
ds_read_b64_tr_b16 v[190:191], v4 offset:12288
s_and_b32 s60, s60, 0x7c000
v_mfma_f32_16x16x32_bf16 v[72:75], v[152:155], a[68:71], v[72:75]
buffer_load_dwordx4 a[96:99], v3, s[88:91], s101 offen sc1
v_mfma_f32_16x16x32_bf16 v[76:79], v[160:163], a[68:71], v[76:79]
ds_read_b64_tr_b16 v[192:193], v5 offset:0
ds_read_b64_tr_b16 v[194:195], v5 offset:4096
v_mfma_f32_16x16x32_bf16 v[76:79], v[164:167], a[76:79], v[76:79]
ds_read_b64_tr_b16 v[196:197], v5 offset:8192
s_lshl_b32 s61, s60, 3
v_mfma_f32_16x16x32_bf16 v[60:63], v[164:167], a[72:75], v[60:63]
ds_read_b64_tr_b16 v[198:199], v5 offset:12288
s_waitcnt lgkmcnt(8)
v_mfma_f32_16x16x32_bf16 v[60:63], v[160:163], a[64:67], v[60:63]
buffer_load_dwordx4 a[100:103], v3, s[88:91], s101 offen offset:1024 sc1
v_mfma_f32_16x16x32_bf16 v[64:67], v[168:171], a[64:67], v[64:67]
ds_read_b64_tr_b16 v[200:201], v4 offset:256
ds_read_b64_tr_b16 v[202:203], v4 offset:4352
v_mfma_f32_16x16x32_bf16 v[64:67], v[172:175], a[72:75], v[64:67]
ds_read_b64_tr_b16 v[204:205], v4 offset:8448
s_add_u32 s62, s61, s12
v_mfma_f32_16x16x32_bf16 v[80:83], v[172:175], a[76:79], v[80:83]
ds_read_b64_tr_b16 v[206:207], v4 offset:12544
s_add_u32 s101, s101, 0x2000
v_mfma_f32_16x16x32_bf16 v[80:83], v[168:171], a[68:71], v[80:83]
buffer_load_dwordx4 a[104:107], v3, s[88:91], s101 offen sc1
v_mfma_f32_16x16x32_bf16 v[84:87], v[176:179], a[68:71], v[84:87]
ds_read_b64_tr_b16 v[208:209], v5 offset:256
ds_read_b64_tr_b16 v[210:211], v5 offset:4352
v_mfma_f32_16x16x32_bf16 v[84:87], v[180:183], a[76:79], v[84:87]
ds_read_b64_tr_b16 v[212:213], v5 offset:8448
s_waitcnt vmcnt(7) lgkmcnt(7)
v_mfma_f32_16x16x32_bf16 v[68:71], v[180:183], a[72:75], v[68:71]
ds_read_b64_tr_b16 v[214:215], v5 offset:12544
s_barrier
v_mfma_f32_16x16x32_bf16 v[68:71], v[176:179], a[64:67], v[68:71]
buffer_load_dwordx4 a[108:111], v3, s[88:91], s101 offen offset:1024 sc1
v_mfma_f32_16x16x32_bf16 v[24:27], v[184:187], a[64:67], v[24:27]
ds_read_b64_tr_b16 v[152:153], v4 offset:16896
ds_read_b64_tr_b16 v[154:155], v4 offset:20992
v_mfma_f32_16x16x32_bf16 v[24:27], v[188:191], a[72:75], v[24:27]
ds_read_b64_tr_b16 v[156:157], v4 offset:25088
s_add_u32 s101, s63, s60
v_mfma_f32_16x16x32_bf16 v[40:43], v[188:191], a[76:79], v[40:43]
ds_read_b64_tr_b16 v[158:159], v4 offset:29184
s_add_u32 m0, s16, 0x4000
v_mfma_f32_16x16x32_bf16 v[40:43], v[184:187], a[68:71], v[40:43]
buffer_load_dwordx4 v12, s[64:67], s61 offen lds
v_mfma_f32_16x16x32_bf16 v[44:47], v[192:195], a[68:71], v[44:47]
ds_read_b64_tr_b16 v[160:161], v5 offset:16896
ds_read_b64_tr_b16 v[162:163], v5 offset:20992
v_mfma_f32_16x16x32_bf16 v[44:47], v[196:199], a[76:79], v[44:47]
ds_read_b64_tr_b16 v[164:165], v5 offset:25088
v_mfma_f32_16x16x32_bf16 v[28:31], v[196:199], a[72:75], v[28:31]
ds_read_b64_tr_b16 v[166:167], v5 offset:29184
s_waitcnt lgkmcnt(8)
v_mfma_f32_16x16x32_bf16 v[28:31], v[192:195], a[64:67], v[28:31]
buffer_load_dwordx4 v13, s[64:67], s61 offen offset:1024 lds
v_mfma_f32_16x16x32_bf16 v[32:35], v[200:203], a[64:67], v[32:35]
ds_read_b64_tr_b16 v[168:169], v4 offset:17152
ds_read_b64_tr_b16 v[170:171], v4 offset:21248
v_mfma_f32_16x16x32_bf16 v[32:35], v[204:207], a[72:75], v[32:35]
ds_read_b64_tr_b16 v[172:173], v4 offset:25344
v_mfma_f32_16x16x32_bf16 v[48:51], v[204:207], a[76:79], v[48:51]
ds_read_b64_tr_b16 v[174:175], v4 offset:29440
v_mfma_f32_16x16x32_bf16 v[48:51], v[200:203], a[68:71], v[48:51]
buffer_load_dwordx4 v12, s[64:67], s62 offen offset:2048 lds
v_mfma_f32_16x16x32_bf16 v[52:55], v[208:211], a[68:71], v[52:55]
ds_read_b64_tr_b16 v[176:177], v5 offset:17152
ds_read_b64_tr_b16 v[178:179], v5 offset:21248
v_mfma_f32_16x16x32_bf16 v[52:55], v[212:215], a[76:79], v[52:55]
ds_read_b64_tr_b16 v[180:181], v5 offset:25344
s_waitcnt lgkmcnt(7)
v_mfma_f32_16x16x32_bf16 v[36:39], v[212:215], a[72:75], v[36:39]
ds_read_b64_tr_b16 v[182:183], v5 offset:29440
v_mfma_f32_16x16x32_bf16 v[36:39], v[208:211], a[64:67], v[36:39]
buffer_load_dwordx4 v13, s[64:67], s62 offen offset:3072 lds
v_mfma_f32_16x16x32_bf16 v[56:59], v[152:155], a[80:83], v[56:59]
ds_read_b64_tr_b16 v[184:185], v4 offset:16384
ds_read_b64_tr_b16 v[186:187], v4 offset:20480
v_mfma_f32_16x16x32_bf16 v[56:59], v[156:159], a[88:91], v[56:59]
ds_read_b64_tr_b16 v[188:189], v4 offset:24576
s_add_u32 s60, s60, s58
v_mfma_f32_16x16x32_bf16 v[72:75], v[156:159], a[92:95], v[72:75]
ds_read_b64_tr_b16 v[190:191], v4 offset:28672
s_and_b32 s60, s60, 0x7c000
v_mfma_f32_16x16x32_bf16 v[72:75], v[152:155], a[84:87], v[72:75]
buffer_load_dwordx4 a[112:115], v3, s[88:91], s101 offen sc1
v_mfma_f32_16x16x32_bf16 v[76:79], v[160:163], a[84:87], v[76:79]
ds_read_b64_tr_b16 v[192:193], v5 offset:16384
ds_read_b64_tr_b16 v[194:195], v5 offset:20480
v_mfma_f32_16x16x32_bf16 v[76:79], v[164:167], a[92:95], v[76:79]
ds_read_b64_tr_b16 v[196:197], v5 offset:24576
s_lshl_b32 s61, s60, 3
v_mfma_f32_16x16x32_bf16 v[60:63], v[164:167], a[88:91], v[60:63]
ds_read_b64_tr_b16 v[198:199], v5 offset:28672
s_waitcnt lgkmcnt(8)
v_mfma_f32_16x16x32_bf16 v[60:63], v[160:163], a[80:83], v[60:63]
buffer_load_dwordx4 a[116:119], v3, s[88:91], s101 offen offset:1024 sc1
v_mfma_f32_16x16x32_bf16 v[64:67], v[168:171], a[80:83], v[64:67]
ds_read_b64_tr_b16 v[200:201], v4 offset:16640
ds_read_b64_tr_b16 v[202:203], v4 offset:20736
v_mfma_f32_16x16x32_bf16 v[64:67], v[172:175], a[88:91], v[64:67]
ds_read_b64_tr_b16 v[204:205], v4 offset:24832
s_add_u32 s62, s61, s12
v_mfma_f32_16x16x32_bf16 v[80:83], v[172:175], a[92:95], v[80:83]
ds_read_b64_tr_b16 v[206:207], v4 offset:28928
s_add_u32 s101, s101, 0x2000
v_mfma_f32_16x16x32_bf16 v[80:83], v[168:171], a[84:87], v[80:83]
buffer_load_dwordx4 a[120:123], v3, s[88:91], s101 offen sc1
v_mfma_f32_16x16x32_bf16 v[84:87], v[176:179], a[84:87], v[84:87]
ds_read_b64_tr_b16 v[208:209], v5 offset:16640
ds_read_b64_tr_b16 v[210:211], v5 offset:20736
v_mfma_f32_16x16x32_bf16 v[84:87], v[180:183], a[92:95], v[84:87]
ds_read_b64_tr_b16 v[212:213], v5 offset:24832
s_waitcnt vmcnt(7) lgkmcnt(7)
v_mfma_f32_16x16x32_bf16 v[68:71], v[180:183], a[88:91], v[68:71]
ds_read_b64_tr_b16 v[214:215], v5 offset:28928
s_barrier
v_mfma_f32_16x16x32_bf16 v[68:71], v[176:179], a[80:83], v[68:71]
buffer_load_dwordx4 a[124:127], v3, s[88:91], s101 offen offset:1024 sc1
v_mfma_f32_16x16x32_bf16 v[24:27], v[184:187], a[80:83], v[24:27]
ds_read_b64_tr_b16 v[152:153], v6 offset:512
ds_read_b64_tr_b16 v[154:155], v6 offset:4608
v_mfma_f32_16x16x32_bf16 v[24:27], v[188:191], a[88:91], v[24:27]
ds_read_b64_tr_b16 v[156:157], v6 offset:8704
s_add_u32 s101, s63, s60
v_mfma_f32_16x16x32_bf16 v[40:43], v[188:191], a[92:95], v[40:43]
ds_read_b64_tr_b16 v[158:159], v6 offset:12800
s_add_u32 m0, s17, 0x10000
v_mfma_f32_16x16x32_bf16 v[40:43], v[184:187], a[84:87], v[40:43]
buffer_load_dwordx4 v12, s[64:67], s61 offen lds
v_mfma_f32_16x16x32_bf16 v[44:47], v[192:195], a[84:87], v[44:47]
ds_read_b64_tr_b16 v[160:161], v7 offset:512
ds_read_b64_tr_b16 v[162:163], v7 offset:4608
v_mfma_f32_16x16x32_bf16 v[44:47], v[196:199], a[92:95], v[44:47]
ds_read_b64_tr_b16 v[164:165], v7 offset:8704
v_mfma_f32_16x16x32_bf16 v[28:31], v[196:199], a[88:91], v[28:31]
ds_read_b64_tr_b16 v[166:167], v7 offset:12800
s_waitcnt lgkmcnt(8)
v_mfma_f32_16x16x32_bf16 v[28:31], v[192:195], a[80:83], v[28:31]
buffer_load_dwordx4 v13, s[64:67], s61 offen offset:1024 lds
v_mfma_f32_16x16x32_bf16 v[32:35], v[200:203], a[80:83], v[32:35]
ds_read_b64_tr_b16 v[168:169], v6 offset:768
ds_read_b64_tr_b16 v[170:171], v6 offset:4864
v_mfma_f32_16x16x32_bf16 v[32:35], v[204:207], a[88:91], v[32:35]
ds_read_b64_tr_b16 v[172:173], v6 offset:8960
v_mfma_f32_16x16x32_bf16 v[48:51], v[204:207], a[92:95], v[48:51]
ds_read_b64_tr_b16 v[174:175], v6 offset:13056
v_mfma_f32_16x16x32_bf16 v[48:51], v[200:203], a[84:87], v[48:51]
buffer_load_dwordx4 v12, s[64:67], s62 offen offset:2048 lds
v_mfma_f32_16x16x32_bf16 v[52:55], v[208:211], a[84:87], v[52:55]
ds_read_b64_tr_b16 v[176:177], v7 offset:768
ds_read_b64_tr_b16 v[178:179], v7 offset:4864
v_mfma_f32_16x16x32_bf16 v[52:55], v[212:215], a[92:95], v[52:55]
ds_read_b64_tr_b16 v[180:181], v7 offset:8960
s_waitcnt lgkmcnt(7)
v_mfma_f32_16x16x32_bf16 v[36:39], v[212:215], a[88:91], v[36:39]
ds_read_b64_tr_b16 v[182:183], v7 offset:13056
v_mfma_f32_16x16x32_bf16 v[36:39], v[208:211], a[80:83], v[36:39]
buffer_load_dwordx4 v13, s[64:67], s62 offen offset:3072 lds
v_mfma_f32_16x16x32_bf16 v[120:123], v[152:155], a[96:99], 0
ds_read_b64_tr_b16 v[184:185], v6 offset:0
ds_read_b64_tr_b16 v[186:187], v6 offset:4096
v_mfma_f32_16x16x32_bf16 v[120:123], v[156:159], a[104:107], v[120:123]
ds_read_b64_tr_b16 v[188:189], v6 offset:8192
s_add_u32 s60, s60, s59
v_mfma_f32_16x16x32_bf16 v[136:139], v[156:159], a[108:111], 0
ds_read_b64_tr_b16 v[190:191], v6 offset:12288
s_and_b32 s60, s60, 0x7c000
v_mfma_f32_16x16x32_bf16 v[136:139], v[152:155], a[100:103], v[136:139]
buffer_load_dwordx4 a[64:67], v3, s[88:91], s101 offen sc1
v_mfma_f32_16x16x32_bf16 v[140:143], v[160:163], a[100:103], 0
ds_read_b64_tr_b16 v[192:193], v7 offset:0
ds_read_b64_tr_b16 v[194:195], v7 offset:4096
v_mfma_f32_16x16x32_bf16 v[140:143], v[164:167], a[108:111], v[140:143]
ds_read_b64_tr_b16 v[196:197], v7 offset:8192
s_lshl_b32 s61, s60, 3
v_mfma_f32_16x16x32_bf16 v[124:127], v[164:167], a[104:107], 0
ds_read_b64_tr_b16 v[198:199], v7 offset:12288
s_waitcnt lgkmcnt(8)
v_mfma_f32_16x16x32_bf16 v[124:127], v[160:163], a[96:99], v[124:127]
buffer_load_dwordx4 a[68:71], v3, s[88:91], s101 offen offset:1024 sc1
v_mfma_f32_16x16x32_bf16 v[128:131], v[168:171], a[96:99], 0
ds_read_b64_tr_b16 v[200:201], v6 offset:256
ds_read_b64_tr_b16 v[202:203], v6 offset:4352
v_mfma_f32_16x16x32_bf16 v[128:131], v[172:175], a[104:107], v[128:131]
ds_read_b64_tr_b16 v[204:205], v6 offset:8448
s_add_u32 s62, s61, s12
v_mfma_f32_16x16x32_bf16 v[144:147], v[172:175], a[108:111], 0
ds_read_b64_tr_b16 v[206:207], v6 offset:12544
s_add_u32 s101, s101, 0x2000
v_mfma_f32_16x16x32_bf16 v[144:147], v[168:171], a[100:103], v[144:147]
buffer_load_dwordx4 a[72:75], v3, s[88:91], s101 offen sc1
v_mfma_f32_16x16x32_bf16 v[148:151], v[176:179], a[100:103], 0
ds_read_b64_tr_b16 v[208:209], v7 offset:256
ds_read_b64_tr_b16 v[210:211], v7 offset:4352
v_mfma_f32_16x16x32_bf16 v[148:151], v[180:183], a[108:111], v[148:151]
ds_read_b64_tr_b16 v[212:213], v7 offset:8448
s_waitcnt vmcnt(7) lgkmcnt(7)
v_mfma_f32_16x16x32_bf16 v[132:135], v[180:183], a[104:107], 0
ds_read_b64_tr_b16 v[214:215], v7 offset:12544
s_barrier
v_mfma_f32_16x16x32_bf16 v[132:135], v[176:179], a[96:99], v[132:135]
buffer_load_dwordx4 a[76:79], v3, s[88:91], s101 offen offset:1024 sc1
s_mov_b32 s15, 7
L_p4_loop:
v_mfma_f32_16x16x32_bf16 v[88:91], v[184:187], a[96:99], v[88:91]
ds_read_b64_tr_b16 v[152:153], v6 offset:16896
ds_read_b64_tr_b16 v[154:155], v6 offset:20992
v_mfma_f32_16x16x32_bf16 v[88:91], v[188:191], a[104:107], v[88:91]
ds_read_b64_tr_b16 v[156:157], v6 offset:25088
s_add_u32 s101, s63, s60
v_mfma_f32_16x16x32_bf16 v[104:107], v[188:191], a[108:111], v[104:107]
ds_read_b64_tr_b16 v[158:159], v6 offset:29184
s_add_u32 m0, s17, 0x14000
v_mfma_f32_16x16x32_bf16 v[104:107], v[184:187], a[100:103], v[104:107]
buffer_load_dwordx4 v12, s[64:67], s61 offen lds
v_mfma_f32_16x16x32_bf16 v[108:111], v[192:195], a[100:103], v[108:111]
ds_read_b64_tr_b16 v[160:161], v7 offset:16896
ds_read_b64_tr_b16 v[162:163], v7 offset:20992
v_mfma_f32_16x16x32_bf16 v[108:111], v[196:199], a[108:111], v[108:111]
ds_read_b64_tr_b16 v[164:165], v7 offset:25088
v_mfma_f32_16x16x32_bf16 v[92:95], v[196:199], a[104:107], v[92:95]
ds_read_b64_tr_b16 v[166:167], v7 offset:29184
s_waitcnt lgkmcnt(8)
v_mfma_f32_16x16x32_bf16 v[92:95], v[192:195], a[96:99], v[92:95]
buffer_load_dwordx4 v13, s[64:67], s61 offen offset:1024 lds
v_mfma_f32_16x16x32_bf16 v[96:99], v[200:203], a[96:99], v[96:99]
ds_read_b64_tr_b16 v[168:169], v6 offset:17152
ds_read_b64_tr_b16 v[170:171], v6 offset:21248
v_mfma_f32_16x16x32_bf16 v[96:99], v[204:207], a[104:107], v[96:99]
ds_read_b64_tr_b16 v[172:173], v6 offset:25344
v_mfma_f32_16x16x32_bf16 v[112:115], v[204:207], a[108:111], v[112:115]
ds_read_b64_tr_b16 v[174:175], v6 offset:29440
v_mfma_f32_16x16x32_bf16 v[112:115], v[200:203], a[100:103], v[112:115]
buffer_load_dwordx4 v12, s[64:67], s62 offen offset:2048 lds
v_mfma_f32_16x16x32_bf16 v[116:119], v[208:211], a[100:103], v[116:119]
ds_read_b64_tr_b16 v[176:177], v7 offset:17152
ds_read_b64_tr_b16 v[178:179], v7 offset:21248
v_mfma_f32_16x16x32_bf16 v[116:119], v[212:215], a[108:111], v[116:119]
ds_read_b64_tr_b16 v[180:181], v7 offset:25344
s_waitcnt lgkmcnt(7)
v_mfma_f32_16x16x32_bf16 v[100:103], v[212:215], a[104:107], v[100:103]
ds_read_b64_tr_b16 v[182:183], v7 offset:29440
v_mfma_f32_16x16x32_bf16 v[100:103], v[208:211], a[96:99], v[100:103]
buffer_load_dwordx4 v13, s[64:67], s62 offen offset:3072 lds
v_mfma_f32_16x16x32_bf16 v[120:123], v[152:155], a[112:115], v[120:123]
ds_read_b64_tr_b16 v[184:185], v6 offset:16384
ds_read_b64_tr_b16 v[186:187], v6 offset:20480
v_mfma_f32_16x16x32_bf16 v[120:123], v[156:159], a[120:123], v[120:123]
ds_read_b64_tr_b16 v[188:189], v6 offset:24576
s_add_u32 s60, s60, s56
v_mfma_f32_16x16x32_bf16 v[136:139], v[156:159], a[124:127], v[136:139]
ds_read_b64_tr_b16 v[190:191], v6 offset:28672
s_and_b32 s60, s60, 0x7c000
v_mfma_f32_16x16x32_bf16 v[136:139], v[152:155], a[116:119], v[136:139]
buffer_load_dwordx4 a[80:83], v3, s[88:91], s101 offen sc1
v_mfma_f32_16x16x32_bf16 v[140:143], v[160:163], a[116:119], v[140:143]
ds_read_b64_tr_b16 v[192:193], v7 offset:16384
ds_read_b64_tr_b16 v[194:195], v7 offset:20480
v_mfma_f32_16x16x32_bf16 v[140:143], v[164:167], a[124:127], v[140:143]
ds_read_b64_tr_b16 v[196:197], v7 offset:24576
s_lshl_b32 s61, s60, 3
v_mfma_f32_16x16x32_bf16 v[124:127], v[164:167], a[120:123], v[124:127]
ds_read_b64_tr_b16 v[198:199], v7 offset:28672
s_waitcnt lgkmcnt(8)
v_mfma_f32_16x16x32_bf16 v[124:127], v[160:163], a[112:115], v[124:127]
buffer_load_dwordx4 a[84:87], v3, s[88:91], s101 offen offset:1024 sc1
v_mfma_f32_16x16x32_bf16 v[128:131], v[168:171], a[112:115], v[128:131]
ds_read_b64_tr_b16 v[200:201], v6 offset:16640
ds_read_b64_tr_b16 v[202:203], v6 offset:20736
v_mfma_f32_16x16x32_bf16 v[128:131], v[172:175], a[120:123], v[128:131]
ds_read_b64_tr_b16 v[204:205], v6 offset:24832
s_add_u32 s62, s61, s12
v_mfma_f32_16x16x32_bf16 v[144:147], v[172:175], a[124:127], v[144:147]
ds_read_b64_tr_b16 v[206:207], v6 offset:28928
s_add_u32 s101, s101, 0x2000
v_mfma_f32_16x16x32_bf16 v[144:147], v[168:171], a[116:119], v[144:147]
buffer_load_dwordx4 a[88:91], v3, s[88:91], s101 offen sc1
v_mfma_f32_16x16x32_bf16 v[148:151], v[176:179], a[116:119], v[148:151]
ds_read_b64_tr_b16 v[208:209], v7 offset:16640
ds_read_b64_tr_b16 v[210:211], v7 offset:20736
v_mfma_f32_16x16x32_bf16 v[148:151], v[180:183], a[124:127], v[148:151]
ds_read_b64_tr_b16 v[212:213], v7 offset:24832
s_waitcnt vmcnt(7) lgkmcnt(7)
v_mfma_f32_16x16x32_bf16 v[132:135], v[180:183], a[120:123], v[132:135]
ds_read_b64_tr_b16 v[214:215], v7 offset:28928
s_barrier
v_mfma_f32_16x16x32_bf16 v[132:135], v[176:179], a[112:115], v[132:135]
buffer_load_dwordx4 a[92:95], v3, s[88:91], s101 offen offset:1024 sc1
v_mfma_f32_16x16x32_bf16 v[88:91], v[184:187], a[112:115], v[88:91]
ds_read_b64_tr_b16 v[152:153], v4 offset:512
ds_read_b64_tr_b16 v[154:155], v4 offset:4608
v_mfma_f32_16x16x32_bf16 v[88:91], v[188:191], a[120:123], v[88:91]
ds_read_b64_tr_b16 v[156:157], v4 offset:8704
s_add_u32 s101, s63, s60
v_mfma_f32_16x16x32_bf16 v[104:107], v[188:191], a[124:127], v[104:107]
ds_read_b64_tr_b16 v[158:159], v4 offset:12800
s_add_u32 m0, s16, 0x0
v_mfma_f32_16x16x32_bf16 v[104:107], v[184:187], a[116:119], v[104:107]
buffer_load_dwordx4 v12, s[64:67], s61 offen lds
v_mfma_f32_16x16x32_bf16 v[108:111], v[192:195], a[116:119], v[108:111]
ds_read_b64_tr_b16 v[160:161], v5 offset:512
ds_read_b64_tr_b16 v[162:163], v5 offset:4608
v_mfma_f32_16x16x32_bf16 v[108:111], v[196:199], a[124:127], v[108:111]
ds_read_b64_tr_b16 v[164:165], v5 offset:8704
v_mfma_f32_16x16x32_bf16 v[92:95], v[196:199], a[120:123], v[92:95]
ds_read_b64_tr_b16 v[166:167], v5 offset:12800
s_waitcnt lgkmcnt(8)
v_mfma_f32_16x16x32_bf16 v[92:95], v[192:195], a[112:115], v[92:95]
buffer_load_dwordx4 v13, s[64:67], s61 offen offset:1024 lds
v_mfma_f32_16x16x32_bf16 v[96:99], v[200:203], a[112:115], v[96:99]
ds_read_b64_tr_b16 v[168:169], v4 offset:768
ds_read_b64_tr_b16 v[170:171], v4 offset:4864
v_mfma_f32_16x16x32_bf16 v[96:99], v[204:207], a[120:123], v[96:99]
ds_read_b64_tr_b16 v[172:173], v4 offset:8960
v_mfma_f32_16x16x32_bf16 v[112:115], v[204:207], a[124:127], v[112:115]
ds_read_b64_tr_b16 v[174:175], v4 offset:13056
v_mfma_f32_16x16x32_bf16 v[112:115], v[200:203], a[116:119], v[112:115]
buffer_load_dwordx4 v12, s[64:67], s62 offen offset:2048 lds
v_mfma_f32_16x16x32_bf16 v[116:119], v[208:211], a[116:119], v[116:119]
ds_read_b64_tr_b16 v[176:177], v5 offset:768
ds_read_b64_tr_b16 v[178:179], v5 offset:4864
v_mfma_f32_16x16x32_bf16 v[116:119], v[212:215], a[124:127], v[116:119]
ds_read_b64_tr_b16 v[180:181], v5 offset:8960
s_waitcnt lgkmcnt(7)
v_mfma_f32_16x16x32_bf16 v[100:103], v[212:215], a[120:123], v[100:103]
ds_read_b64_tr_b16 v[182:183], v5 offset:13056
v_mfma_f32_16x16x32_bf16 v[100:103], v[208:211], a[112:115], v[100:103]
buffer_load_dwordx4 v13, s[64:67], s62 offen offset:3072 lds
v_mfma_f32_16x16x32_bf16 v[120:123], v[152:155], a[64:67], v[120:123]
ds_read_b64_tr_b16 v[184:185], v4 offset:0
ds_read_b64_tr_b16 v[186:187], v4 offset:4096
v_mfma_f32_16x16x32_bf16 v[120:123], v[156:159], a[72:75], v[120:123]
ds_read_b64_tr_b16 v[188:189], v4 offset:8192
s_add_u32 s60, s60, s57
v_mfma_f32_16x16x32_bf16 v[136:139], v[156:159], a[76:79], v[136:139]
ds_read_b64_tr_b16 v[190:191], v4 offset:12288
s_and_b32 s60, s60, 0x7c000
v_mfma_f32_16x16x32_bf16 v[136:139], v[152:155], a[68:71], v[136:139]
buffer_load_dwordx4 a[96:99], v3, s[88:91], s101 offen sc1
v_mfma_f32_16x16x32_bf16 v[140:143], v[160:163], a[68:71], v[140:143]
ds_read_b64_tr_b16 v[192:193], v5 offset:0
ds_read_b64_tr_b16 v[194:195], v5 offset:4096
v_mfma_f32_16x16x32_bf16 v[140:143], v[164:167], a[76:79], v[140:143]
ds_read_b64_tr_b16 v[196:197], v5 offset:8192
s_lshl_b32 s61, s60, 3
v_mfma_f32_16x16x32_bf16 v[124:127], v[164:167], a[72:75], v[124:127]
ds_read_b64_tr_b16 v[198:199], v5 offset:12288
s_waitcnt lgkmcnt(8)
v_mfma_f32_16x16x32_bf16 v[124:127], v[160:163], a[64:67], v[124:127]
buffer_load_dwordx4 a[100:103], v3, s[88:91], s101 offen offset:1024 sc1
v_mfma_f32_16x16x32_bf16 v[128:131], v[168:171], a[64:67], v[128:131]
ds_read_b64_tr_b16 v[200:201], v4 offset:256
ds_read_b64_tr_b16 v[202:203], v4 offset:4352
v_mfma_f32_16x16x32_bf16 v[128:131], v[172:175], a[72:75], v[128:131]
ds_read_b64_tr_b16 v[204:205], v4 offset:8448
s_add_u32 s62, s61, s12
v_mfma_f32_16x16x32_bf16 v[144:147], v[172:175], a[76:79], v[144:147]
ds_read_b64_tr_b16 v[206:207], v4 offset:12544
s_add_u32 s101, s101, 0x2000
v_mfma_f32_16x16x32_bf16 v[144:147], v[168:171], a[68:71], v[144:147]
buffer_load_dwordx4 a[104:107], v3, s[88:91], s101 offen sc1
v_mfma_f32_16x16x32_bf16 v[148:151], v[176:179], a[68:71], v[148:151]
ds_read_b64_tr_b16 v[208:209], v5 offset:256
ds_read_b64_tr_b16 v[210:211], v5 offset:4352
v_mfma_f32_16x16x32_bf16 v[148:151], v[180:183], a[76:79], v[148:151]
ds_read_b64_tr_b16 v[212:213], v5 offset:8448
s_waitcnt vmcnt(7) lgkmcnt(7)
v_mfma_f32_16x16x32_bf16 v[132:135], v[180:183], a[72:75], v[132:135]
ds_read_b64_tr_b16 v[214:215], v5 offset:12544
s_barrier
v_mfma_f32_16x16x32_bf16 v[132:135], v[176:179], a[64:67], v[132:135]
buffer_load_dwordx4 a[108:111], v3, s[88:91], s101 offen offset:1024 sc1
v_mfma_f32_16x16x32_bf16 v[88:91], v[184:187], a[64:67], v[88:91]
ds_read_b64_tr_b16 v[152:153], v4 offset:16896
ds_read_b64_tr_b16 v[154:155], v4 offset:20992
v_mfma_f32_16x16x32_bf16 v[88:91], v[188:191], a[72:75], v[88:91]
ds_read_b64_tr_b16 v[156:157], v4 offset:25088
s_add_u32 s101, s63, s60
v_mfma_f32_16x16x32_bf16 v[104:107], v[188:191], a[76:79], v[104:107]
ds_read_b64_tr_b16 v[158:159], v4 offset:29184
s_add_u32 m0, s16, 0x4000
v_mfma_f32_16x16x32_bf16 v[104:107], v[184:187], a[68:71], v[104:107]
buffer_load_dwordx4 v12, s[64:67], s61 offen lds
v_mfma_f32_16x16x32_bf16 v[108:111], v[192:195], a[68:71], v[108:111]
ds_read_b64_tr_b16 v[160:161], v5 offset:16896
ds_read_b64_tr_b16 v[162:163], v5 offset:20992
v_mfma_f32_16x16x32_bf16 v[108:111], v[196:199], a[76:79], v[108:111]
ds_read_b64_tr_b16 v[164:165], v5 offset:25088
v_mfma_f32_16x16x32_bf16 v[92:95], v[196:199], a[72:75], v[92:95]
ds_read_b64_tr_b16 v[166:167], v5 offset:29184
s_waitcnt lgkmcnt(8)
v_mfma_f32_16x16x32_bf16 v[92:95], v[192:195], a[64:67], v[92:95]
buffer_load_dwordx4 v13, s[64:67], s61 offen offset:1024 lds
v_mfma_f32_16x16x32_bf16 v[96:99], v[200:203], a[64:67], v[96:99]
ds_read_b64_tr_b16 v[168:169], v4 offset:17152
ds_read_b64_tr_b16 v[170:171], v4 offset:21248
v_mfma_f32_16x16x32_bf16 v[96:99], v[204:207], a[72:75], v[96:99]
ds_read_b64_tr_b16 v[172:173], v4 offset:25344
v_mfma_f32_16x16x32_bf16 v[112:115], v[204:207], a[76:79], v[112:115]
ds_read_b64_tr_b16 v[174:175], v4 offset:29440
v_mfma_f32_16x16x32_bf16 v[112:115], v[200:203], a[68:71], v[112:115]
buffer_load_dwordx4 v12, s[64:67], s62 offen offset:2048 lds
v_mfma_f32_16x16x32_bf16 v[116:119], v[208:211], a[68:71], v[116:119]
ds_read_b64_tr_b16 v[176:177], v5 offset:17152
ds_read_b64_tr_b16 v[178:179], v5 offset:21248
v_mfma_f32_16x16x32_bf16 v[116:119], v[212:215], a[76:79], v[116:119]
ds_read_b64_tr_b16 v[180:181], v5 offset:25344
s_waitcnt lgkmcnt(7)
v_mfma_f32_16x16x32_bf16 v[100:103], v[212:215], a[72:75], v[100:103]
ds_read_b64_tr_b16 v[182:183], v5 offset:29440
v_mfma_f32_16x16x32_bf16 v[100:103], v[208:211], a[64:67], v[100:103]
buffer_load_dwordx4 v13, s[64:67], s62 offen offset:3072 lds
v_mfma_f32_16x16x32_bf16 v[120:123], v[152:155], a[80:83], v[120:123]
ds_read_b64_tr_b16 v[184:185], v4 offset:16384
ds_read_b64_tr_b16 v[186:187], v4 offset:20480
v_mfma_f32_16x16x32_bf16 v[120:123], v[156:159], a[88:91], v[120:123]
ds_read_b64_tr_b16 v[188:189], v4 offset:24576
s_add_u32 s60, s60, s58
v_mfma_f32_16x16x32_bf16 v[136:139], v[156:159], a[92:95], v[136:139]
ds_read_b64_tr_b16 v[190:191], v4 offset:28672
s_and_b32 s60, s60, 0x7c000
v_mfma_f32_16x16x32_bf16 v[136:139], v[152:155], a[84:87], v[136:139]
buffer_load_dwordx4 a[112:115], v3, s[88:91], s101 offen sc1
v_mfma_f32_16x16x32_bf16 v[140:143], v[160:163], a[84:87], v[140:143]
ds_read_b64_tr_b16 v[192:193], v5 offset:16384
ds_read_b64_tr_b16 v[194:195], v5 offset:20480
v_mfma_f32_16x16x32_bf16 v[140:143], v[164:167], a[92:95], v[140:143]
ds_read_b64_tr_b16 v[196:197], v5 offset:24576
s_lshl_b32 s61, s60, 3
v_mfma_f32_16x16x32_bf16 v[124:127], v[164:167], a[88:91], v[124:127]
ds_read_b64_tr_b16 v[198:199], v5 offset:28672
s_waitcnt lgkmcnt(8)
v_mfma_f32_16x16x32_bf16 v[124:127], v[160:163], a[80:83], v[124:127]
buffer_load_dwordx4 a[116:119], v3, s[88:91], s101 offen offset:1024 sc1
v_mfma_f32_16x16x32_bf16 v[128:131], v[168:171], a[80:83], v[128:131]
ds_read_b64_tr_b16 v[200:201], v4 offset:16640
ds_read_b64_tr_b16 v[202:203], v4 offset:20736
v_mfma_f32_16x16x32_bf16 v[128:131], v[172:175], a[88:91], v[128:131]
ds_read_b64_tr_b16 v[204:205], v4 offset:24832
s_add_u32 s62, s61, s12
v_mfma_f32_16x16x32_bf16 v[144:147], v[172:175], a[92:95], v[144:147]
ds_read_b64_tr_b16 v[206:207], v4 offset:28928
s_add_u32 s101, s101, 0x2000
v_mfma_f32_16x16x32_bf16 v[144:147], v[168:171], a[84:87], v[144:147]
buffer_load_dwordx4 a[120:123], v3, s[88:91], s101 offen sc1
v_mfma_f32_16x16x32_bf16 v[148:151], v[176:179], a[84:87], v[148:151]
ds_read_b64_tr_b16 v[208:209], v5 offset:16640
ds_read_b64_tr_b16 v[210:211], v5 offset:20736
v_mfma_f32_16x16x32_bf16 v[148:151], v[180:183], a[92:95], v[148:151]
ds_read_b64_tr_b16 v[212:213], v5 offset:24832
s_waitcnt vmcnt(7) lgkmcnt(7)
v_mfma_f32_16x16x32_bf16 v[132:135], v[180:183], a[88:91], v[132:135]
ds_read_b64_tr_b16 v[214:215], v5 offset:28928
s_barrier
v_mfma_f32_16x16x32_bf16 v[132:135], v[176:179], a[80:83], v[132:135]
buffer_load_dwordx4 a[124:127], v3, s[88:91], s101 offen offset:1024 sc1
buffer_load_dword v14, v20, s[88:91], s24 offen sc1
v_mfma_f32_16x16x32_bf16 v[88:91], v[184:187], a[80:83], v[88:91]
ds_read_b64_tr_b16 v[152:153], v6 offset:512
ds_read_b64_tr_b16 v[154:155], v6 offset:4608
v_mfma_f32_16x16x32_bf16 v[88:91], v[188:191], a[88:91], v[88:91]
ds_read_b64_tr_b16 v[156:157], v6 offset:8704
s_add_u32 s101, s63, s60
v_mfma_f32_16x16x32_bf16 v[104:107], v[188:191], a[92:95], v[104:107]
ds_read_b64_tr_b16 v[158:159], v6 offset:12800
s_add_u32 m0, s17, 0x10000
v_mfma_f32_16x16x32_bf16 v[104:107], v[184:187], a[84:87], v[104:107]
buffer_load_dwordx4 v12, s[64:67], s61 offen lds
v_mfma_f32_16x16x32_bf16 v[108:111], v[192:195], a[84:87], v[108:111]
ds_read_b64_tr_b16 v[160:161], v7 offset:512
ds_read_b64_tr_b16 v[162:163], v7 offset:4608
v_mfma_f32_16x16x32_bf16 v[108:111], v[196:199], a[92:95], v[108:111]
ds_read_b64_tr_b16 v[164:165], v7 offset:8704
s_sub_u32 s15, s15, 1
v_mfma_f32_16x16x32_bf16 v[92:95], v[196:199], a[88:91], v[92:95]
ds_read_b64_tr_b16 v[166:167], v7 offset:12800
s_waitcnt lgkmcnt(8)
v_mfma_f32_16x16x32_bf16 v[92:95], v[192:195], a[80:83], v[92:95]
buffer_load_dwordx4 v13, s[64:67], s61 offen offset:1024 lds
v_mfma_f32_16x16x32_bf16 v[96:99], v[200:203], a[80:83], v[96:99]
ds_read_b64_tr_b16 v[168:169], v6 offset:768
ds_read_b64_tr_b16 v[170:171], v6 offset:4864
v_mfma_f32_16x16x32_bf16 v[96:99], v[204:207], a[88:91], v[96:99]
ds_read_b64_tr_b16 v[172:173], v6 offset:8960
v_mfma_f32_16x16x32_bf16 v[112:115], v[204:207], a[92:95], v[112:115]
ds_read_b64_tr_b16 v[174:175], v6 offset:13056
v_mfma_f32_16x16x32_bf16 v[112:115], v[200:203], a[84:87], v[112:115]
buffer_load_dwordx4 v12, s[64:67], s62 offen offset:2048 lds
v_mfma_f32_16x16x32_bf16 v[116:119], v[208:211], a[84:87], v[116:119]
ds_read_b64_tr_b16 v[176:177], v7 offset:768
ds_read_b64_tr_b16 v[178:179], v7 offset:4864
v_mfma_f32_16x16x32_bf16 v[116:119], v[212:215], a[92:95], v[116:119]
ds_read_b64_tr_b16 v[180:181], v7 offset:8960
s_waitcnt lgkmcnt(7)
v_mfma_f32_16x16x32_bf16 v[100:103], v[212:215], a[88:91], v[100:103]
ds_read_b64_tr_b16 v[182:183], v7 offset:13056
v_mfma_f32_16x16x32_bf16 v[100:103], v[208:211], a[80:83], v[100:103]
buffer_load_dwordx4 v13, s[64:67], s62 offen offset:3072 lds
v_mfma_f32_16x16x32_bf16 v[120:123], v[152:155], a[96:99], v[120:123]
ds_read_b64_tr_b16 v[184:185], v6 offset:0
ds_read_b64_tr_b16 v[186:187], v6 offset:4096
v_mfma_f32_16x16x32_bf16 v[120:123], v[156:159], a[104:107], v[120:123]
ds_read_b64_tr_b16 v[188:189], v6 offset:8192
s_add_u32 s60, s60, s59
v_mfma_f32_16x16x32_bf16 v[136:139], v[156:159], a[108:111], v[136:139]
ds_read_b64_tr_b16 v[190:191], v6 offset:12288
s_and_b32 s60, s60, 0x7c000
v_mfma_f32_16x16x32_bf16 v[136:139], v[152:155], a[100:103], v[136:139]
buffer_load_dwordx4 a[64:67], v3, s[88:91], s101 offen sc1
v_mfma_f32_16x16x32_bf16 v[140:143], v[160:163], a[100:103], v[140:143]
ds_read_b64_tr_b16 v[192:193], v7 offset:0
ds_read_b64_tr_b16 v[194:195], v7 offset:4096
v_mfma_f32_16x16x32_bf16 v[140:143], v[164:167], a[108:111], v[140:143]
ds_read_b64_tr_b16 v[196:197], v7 offset:8192
s_lshl_b32 s61, s60, 3
v_mfma_f32_16x16x32_bf16 v[124:127], v[164:167], a[104:107], v[124:127]
ds_read_b64_tr_b16 v[198:199], v7 offset:12288
s_waitcnt lgkmcnt(8)
v_mfma_f32_16x16x32_bf16 v[124:127], v[160:163], a[96:99], v[124:127]
buffer_load_dwordx4 a[68:71], v3, s[88:91], s101 offen offset:1024 sc1
v_mfma_f32_16x16x32_bf16 v[128:131], v[168:171], a[96:99], v[128:131]
ds_read_b64_tr_b16 v[200:201], v6 offset:256
ds_read_b64_tr_b16 v[202:203], v6 offset:4352
v_mfma_f32_16x16x32_bf16 v[128:131], v[172:175], a[104:107], v[128:131]
ds_read_b64_tr_b16 v[204:205], v6 offset:8448
s_add_u32 s62, s61, s12
v_mfma_f32_16x16x32_bf16 v[144:147], v[172:175], a[108:111], v[144:147]
ds_read_b64_tr_b16 v[206:207], v6 offset:12544
s_add_u32 s101, s101, 0x2000
v_mfma_f32_16x16x32_bf16 v[144:147], v[168:171], a[100:103], v[144:147]
buffer_load_dwordx4 a[72:75], v3, s[88:91], s101 offen sc1
v_mfma_f32_16x16x32_bf16 v[148:151], v[176:179], a[100:103], v[148:151]
ds_read_b64_tr_b16 v[208:209], v7 offset:256
ds_read_b64_tr_b16 v[210:211], v7 offset:4352
v_mfma_f32_16x16x32_bf16 v[148:151], v[180:183], a[108:111], v[148:151]
ds_read_b64_tr_b16 v[212:213], v7 offset:8448
s_waitcnt vmcnt(7) lgkmcnt(7)
v_mfma_f32_16x16x32_bf16 v[132:135], v[180:183], a[104:107], v[132:135]
ds_read_b64_tr_b16 v[214:215], v7 offset:12544
s_barrier
v_mfma_f32_16x16x32_bf16 v[132:135], v[176:179], a[96:99], v[132:135]
buffer_load_dwordx4 a[76:79], v3, s[88:91], s101 offen offset:1024 sc1
v_cmp_ne_u32 vcc, 1, v14
s_cmp_lg_u32 s15, 0
s_cbranch_scc0 L_p4_exit
s_cbranch_vccz L_p4_loop
s_mov_b32 s92, 200000
L_spin_d:
v_cmp_ne_u32 vcc, 1, v14
s_nop 4
s_cbranch_vccz L_spun_d
s_sub_u32 s92, s92, 1
s_cbranch_scc1 L_spun_d
s_sleep 6
buffer_load_dword v14, v20, s[88:91], s24 offen sc1
s_waitcnt vmcnt(0)
s_branch L_spin_d
L_spun_d:
s_branch L_p4_loop
L_p4_exit:
s_add_u32 s101, s63, s60
v_mfma_f32_16x16x32_bf16 v[88:91], v[184:187], a[96:99], v[88:91]
ds_read_b64_tr_b16 v[152:153], v6 offset:16896
ds_read_b64_tr_b16 v[154:155], v6 offset:20992
s_add_u32 m0, s17, 0x14000
v_mfma_f32_16x16x32_bf16 v[88:91], v[188:191], a[104:107], v[88:91]
buffer_load_dwordx4 v12, s[64:67], s61 offen lds
v_mfma_f32_16x16x32_bf16 v[104:107], v[188:191], a[108:111], v[104:107]
ds_read_b64_tr_b16 v[156:157], v6 offset:25088
ds_read_b64_tr_b16 v[158:159], v6 offset:29184
v_mfma_f32_16x16x32_bf16 v[104:107], v[184:187], a[100:103], v[104:107]
buffer_load_dwordx4 v13, s[64:67], s61 offen offset:1024 lds
v_mfma_f32_16x16x32_bf16 v[108:111], v[192:195], a[100:103], v[108:111]
ds_read_b64_tr_b16 v[160:161], v7 offset:16896
ds_read_b64_tr_b16 v[162:163], v7 offset:20992
v_mfma_f32_16x16x32_bf16 v[108:111], v[196:199], a[108:111], v[108:111]
buffer_load_dwordx4 v12, s[64:67], s62 offen offset:2048 lds
v_mfma_f32_16x16x32_bf16 v[92:95], v[196:199], a[104:107], v[92:95]
ds_read_b64_tr_b16 v[164:165], v7 offset:25088
ds_read_b64_tr_b16 v[166:167], v7 offset:29184
s_waitcnt lgkmcnt(8)
v_mfma_f32_16x16x32_bf16 v[92:95], v[192:195], a[96:99], v[92:95]
buffer_load_dwordx4 v13, s[64:67], s62 offen offset:3072 lds
v_mfma_f32_16x16x32_bf16 v[96:99], v[200:203], a[96:99], v[96:99]
ds_read_b64_tr_b16 v[168:169], v6 offset:17152
ds_read_b64_tr_b16 v[170:171], v6 offset:21248
v_mfma_f32_16x16x32_bf16 v[96:99], v[204:207], a[104:107], v[96:99]
buffer_load_dwordx4 a[80:83], v3, s[88:91], s101 offen sc1
v_mfma_f32_16x16x32_bf16 v[112:115], v[204:207], a[108:111], v[112:115]
ds_read_b64_tr_b16 v[172:173], v6 offset:25344
ds_read_b64_tr_b16 v[174:175], v6 offset:29440
v_mfma_f32_16x16x32_bf16 v[112:115], v[200:203], a[100:103], v[112:115]
buffer_load_dwordx4 a[84:87], v3, s[88:91], s101 offen offset:1024 sc1
v_mfma_f32_16x16x32_bf16 v[116:119], v[208:211], a[100:103], v[116:119]
ds_read_b64_tr_b16 v[176:177], v7 offset:17152
ds_read_b64_tr_b16 v[178:179], v7 offset:21248
s_add_u32 s101, s101, 0x2000
v_mfma_f32_16x16x32_bf16 v[116:119], v[212:215], a[108:111], v[116:119]
buffer_load_dwordx4 a[88:91], v3, s[88:91], s101 offen sc1
s_waitcnt vmcnt(7) lgkmcnt(6)
v_mfma_f32_16x16x32_bf16 v[100:103], v[212:215], a[104:107], v[100:103]
ds_read_b64_tr_b16 v[180:181], v7 offset:25344
ds_read_b64_tr_b16 v[182:183], v7 offset:29440
s_barrier
v_mfma_f32_16x16x32_bf16 v[100:103], v[208:211], a[96:99], v[100:103]
buffer_load_dwordx4 a[92:95], v3, s[88:91], s101 offen offset:1024 sc1
v_mfma_f32_16x16x32_bf16 v[120:123], v[152:155], a[112:115], v[120:123]
ds_read_b64_tr_b16 v[184:185], v4 offset:512
v_sub_f32 v10, 1.0, v8
v_mfma_f32_16x16x32_bf16 v[120:123], v[156:159], a[120:123], v[120:123]
ds_read_b64_tr_b16 v[186:187], v4 offset:4608
v_sub_f32 v11, 1.0, v9
v_mfma_f32_16x16x32_bf16 v[136:139], v[156:159], a[124:127], v[136:139]
ds_read_b64_tr_b16 v[188:189], v4 offset:8704
v_mul_f32 v56, v10, v56
v_mfma_f32_16x16x32_bf16 v[136:139], v[152:155], a[116:119], v[136:139]
ds_read_b64_tr_b16 v[190:191], v4 offset:12800
v_mul_f32 v57, v10, v57
v_mfma_f32_16x16x32_bf16 v[140:143], v[160:163], a[116:119], v[140:143]
ds_read_b64_tr_b16 v[192:193], v5 offset:512
v_mul_f32 v58, v10, v58
v_mfma_f32_16x16x32_bf16 v[140:143], v[164:167], a[124:127], v[140:143]
ds_read_b64_tr_b16 v[194:195], v5 offset:4608
v_mul_f32 v59, v10, v59
v_mfma_f32_16x16x32_bf16 v[124:127], v[164:167], a[120:123], v[124:127]
ds_read_b64_tr_b16 v[196:197], v5 offset:8704
s_waitcnt lgkmcnt(7)
v_mfma_f32_16x16x32_bf16 v[124:127], v[160:163], a[112:115], v[124:127]
ds_read_b64_tr_b16 v[198:199], v5 offset:12800
v_mul_f32 v60, v10, v60
v_mfma_f32_16x16x32_bf16 v[128:131], v[168:171], a[112:115], v[128:131]
ds_read_b64_tr_b16 v[200:201], v4 offset:768
v_mul_f32 v61, v10, v61
v_mfma_f32_16x16x32_bf16 v[128:131], v[172:175], a[120:123], v[128:131]
ds_read_b64_tr_b16 v[202:203], v4 offset:4864
v_mul_f32 v62, v10, v62
v_mfma_f32_16x16x32_bf16 v[144:147], v[172:175], a[124:127], v[144:147]
ds_read_b64_tr_b16 v[204:205], v4 offset:8960
v_mul_f32 v63, v10, v63
v_mfma_f32_16x16x32_bf16 v[144:147], v[168:171], a[116:119], v[144:147]
ds_read_b64_tr_b16 v[206:207], v4 offset:13056
v_mul_f32 v64, v10, v64
v_mfma_f32_16x16x32_bf16 v[148:151], v[176:179], a[116:119], v[148:151]
ds_read_b64_tr_b16 v[208:209], v5 offset:768
v_mul_f32 v65, v10, v65
v_mfma_f32_16x16x32_bf16 v[148:151], v[180:183], a[124:127], v[148:151]
ds_read_b64_tr_b16 v[210:211], v5 offset:4864
s_waitcnt vmcnt(0) lgkmcnt(6)
v_mfma_f32_16x16x32_bf16 v[132:135], v[180:183], a[120:123], v[132:135]
ds_read_b64_tr_b16 v[212:213], v5 offset:8960
s_barrier
v_mfma_f32_16x16x32_bf16 v[132:135], v[176:179], a[112:115], v[132:135]
ds_read_b64_tr_b16 v[214:215], v5 offset:13056
v_mul_f32 v66, v10, v66
v_mul_f32 v67, v10, v67
v_mfma_f32_16x16x32_bf16 v[120:123], v[184:187], a[64:67], v[120:123]
ds_read_b64_tr_b16 v[152:153], v4 offset:16896
v_mul_f32 v68, v10, v68
v_mfma_f32_16x16x32_bf16 v[120:123], v[188:191], a[72:75], v[120:123]
ds_read_b64_tr_b16 v[154:155], v4 offset:20992
v_mul_f32 v69, v10, v69
v_mfma_f32_16x16x32_bf16 v[136:139], v[188:191], a[76:79], v[136:139]
ds_read_b64_tr_b16 v[156:157], v4 offset:25088
v_mul_f32 v70, v10, v70
v_mfma_f32_16x16x32_bf16 v[136:139], v[184:187], a[68:71], v[136:139]
ds_read_b64_tr_b16 v[158:159], v4 offset:29184
v_mul_f32 v71, v10, v71
v_mfma_f32_16x16x32_bf16 v[140:143], v[192:195], a[68:71], v[140:143]
ds_read_b64_tr_b16 v[160:161], v5 offset:16896
v_mul_f32 v72, v11, v72
v_mfma_f32_16x16x32_bf16 v[140:143], v[196:199], a[76:79], v[140:143]
ds_read_b64_tr_b16 v[162:163], v5 offset:20992
v_mul_f32 v73, v11, v73
v_mfma_f32_16x16x32_bf16 v[124:127], v[196:199], a[72:75], v[124:127]
ds_read_b64_tr_b16 v[164:165], v5 offset:25088
s_waitcnt lgkmcnt(7)
v_mfma_f32_16x16x32_bf16 v[124:127], v[192:195], a[64:67], v[124:127]
ds_read_b64_tr_b16 v[166:167], v5 offset:29184
v_mul_f32 v74, v11, v74
v_mfma_f32_16x16x32_bf16 v[128:131], v[200:203], a[64:67], v[128:131]
ds_read_b64_tr_b16 v[168:169], v4 offset:17152
v_mul_f32 v75, v11, v75
v_mfma_f32_16x16x32_bf16 v[128:131], v[204:207], a[72:75], v[128:131]
ds_read_b64_tr_b16 v[170:171], v4 offset:21248
v_mul_f32 v76, v11, v76
v_mfma_f32_16x16x32_bf16 v[144:147], v[204:207], a[76:79], v[144:147]
ds_read_b64_tr_b16 v[172:173], v4 offset:25344
v_mul_f32 v77, v11, v77
v_mfma_f32_16x16x32_bf16 v[144:147], v[200:203], a[68:71], v[144:147]
ds_read_b64_tr_b16 v[174:175], v4 offset:29440
v_mul_f32 v78, v11, v78
v_mfma_f32_16x16x32_bf16 v[148:151], v[208:211], a[68:71], v[148:151]
ds_read_b64_tr_b16 v[176:177], v5 offset:17152
v_mul_f32 v79, v11, v79
v_mfma_f32_16x16x32_bf16 v[148:151], v[212:215], a[76:79], v[148:151]
ds_read_b64_tr_b16 v[178:179], v5 offset:21248
s_waitcnt lgkmcnt(6)
v_mfma_f32_16x16x32_bf16 v[132:135], v[212:215], a[72:75], v[132:135]
ds_read_b64_tr_b16 v[180:181], v5 offset:25344
v_mul_f32 v80, v11, v80
v_mfma_f32_16x16x32_bf16 v[132:135], v[208:211], a[64:67], v[132:135]
ds_read_b64_tr_b16 v[182:183], v5 offset:29440
v_mul_f32 v81, v11, v81
v_mfma_f32_16x16x32_bf16 v[120:123], v[152:155], a[80:83], v[120:123]
ds_read_b64_tr_b16 v[184:185], v6 offset:16384
v_mul_f32 v82, v11, v82
v_mfma_f32_16x16x32_bf16 v[120:123], v[156:159], a[88:91], v[120:123]
ds_read_b64_tr_b16 v[186:187], v6 offset:20480
v_mul_f32 v83, v11, v83
v_mfma_f32_16x16x32_bf16 v[136:139], v[156:159], a[92:95], v[136:139]
ds_read_b64_tr_b16 v[188:189], v6 offset:24576
v_mul_f32 v84, v11, v84
v_mfma_f32_16x16x32_bf16 v[136:139], v[152:155], a[84:87], v[136:139]
ds_read_b64_tr_b16 v[190:191], v6 offset:28672
v_mul_f32 v85, v11, v85
v_mfma_f32_16x16x32_bf16 v[140:143], v[160:163], a[84:87], v[140:143]
ds_read_b64_tr_b16 v[192:193], v7 offset:16384
v_mul_f32 v86, v11, v86
v_mfma_f32_16x16x32_bf16 v[140:143], v[164:167], a[92:95], v[140:143]
ds_read_b64_tr_b16 v[194:195], v7 offset:20480
v_mul_f32 v87, v11, v87
v_mfma_f32_16x16x32_bf16 v[124:127], v[164:167], a[88:91], v[124:127]
ds_read_b64_tr_b16 v[196:197], v7 offset:24576
s_waitcnt lgkmcnt(7)
v_mfma_f32_16x16x32_bf16 v[124:127], v[160:163], a[80:83], v[124:127]
ds_read_b64_tr_b16 v[198:199], v7 offset:28672
v_mul_f32 v24, v10, v24
v_mfma_f32_16x16x32_bf16 v[128:131], v[168:171], a[80:83], v[128:131]
ds_read_b64_tr_b16 v[200:201], v6 offset:16640
v_mul_f32 v25, v10, v25
v_mfma_f32_16x16x32_bf16 v[128:131], v[172:175], a[88:91], v[128:131]
ds_read_b64_tr_b16 v[202:203], v6 offset:20736
v_mul_f32 v26, v10, v26
v_mfma_f32_16x16x32_bf16 v[144:147], v[172:175], a[92:95], v[144:147]
ds_read_b64_tr_b16 v[204:205], v6 offset:24832
v_mul_f32 v27, v10, v27
v_mfma_f32_16x16x32_bf16 v[144:147], v[168:171], a[84:87], v[144:147]
ds_read_b64_tr_b16 v[206:207], v6 offset:28928
v_mul_f32 v28, v10, v28
v_mfma_f32_16x16x32_bf16 v[148:151], v[176:179], a[84:87], v[148:151]
ds_read_b64_tr_b16 v[208:209], v7 offset:16640
v_mul_f32 v29, v10, v29
v_mfma_f32_16x16x32_bf16 v[148:151], v[180:183], a[92:95], v[148:151]
ds_read_b64_tr_b16 v[210:211], v7 offset:20736
s_waitcnt lgkmcnt(6)
v_mfma_f32_16x16x32_bf16 v[132:135], v[180:183], a[88:91], v[132:135]
ds_read_b64_tr_b16 v[212:213], v7 offset:24832
v_mul_f32 v30, v10, v30
v_mfma_f32_16x16x32_bf16 v[132:135], v[176:179], a[80:83], v[132:135]
ds_read_b64_tr_b16 v[214:215], v7 offset:28928
v_mul_f32 v31, v10, v31
v_mfma_f32_16x16x32_bf16 v[88:91], v[184:187], a[112:115], v[88:91]
ds_read_b64_tr_b16 v[152:153], v4 offset:0
v_mfma_f32_16x16x32_bf16 v[88:91], v[188:191], a[120:123], v[88:91]
ds_read_b64_tr_b16 v[154:155], v4 offset:4096
v_mfma_f32_16x16x32_bf16 v[104:107], v[188:191], a[124:127], v[104:107]
ds_read_b64_tr_b16 v[156:157], v4 offset:8192
v_mfma_f32_16x16x32_bf16 v[104:107], v[184:187], a[116:119], v[104:107]
ds_read_b64_tr_b16 v[158:159], v4 offset:12288
v_fmac_f32 v56, v8, v120
v_fmac_f32 v57, v8, v121
v_fmac_f32 v58, v8, v122
v_fmac_f32 v59, v8, v123
v_mfma_f32_16x16x32_bf16 v[108:111], v[192:195], a[116:119], v[108:111]
ds_read_b64_tr_b16 v[160:161], v5 offset:0
v_fmac_f32 v60, v8, v124
v_fmac_f32 v61, v8, v125
v_fmac_f32 v62, v8, v126
v_fmac_f32 v63, v8, v127
v_mfma_f32_16x16x32_bf16 v[108:111], v[196:199], a[124:127], v[108:111]
ds_read_b64_tr_b16 v[162:163], v5 offset:4096
v_cvt_pk_bf16_f32 v56, v56, v57
v_cvt_pk_bf16_f32 v57, v58, v59
v_cvt_pk_bf16_f32 v58, v60, v61
v_cvt_pk_bf16_f32 v59, v62, v63
v_mfma_f32_16x16x32_bf16 v[92:95], v[196:199], a[120:123], v[92:95]
ds_read_b64_tr_b16 v[164:165], v5 offset:8192
s_waitcnt lgkmcnt(7)
buffer_store_dwordx4 v[56:59], v3, s[88:91], s30 offen offset:0 sc1
v_fmac_f32 v64, v8, v128
v_fmac_f32 v65, v8, v129
v_fmac_f32 v66, v8, v130
v_mfma_f32_16x16x32_bf16 v[92:95], v[192:195], a[112:115], v[92:95]
ds_read_b64_tr_b16 v[166:167], v5 offset:12288
v_fmac_f32 v67, v8, v131
v_fmac_f32 v68, v8, v132
v_fmac_f32 v69, v8, v133
v_fmac_f32 v70, v8, v134
v_mfma_f32_16x16x32_bf16 v[96:99], v[200:203], a[112:115], v[96:99]
ds_read_b64_tr_b16 v[168:169], v4 offset:256
v_fmac_f32 v71, v8, v135
v_cvt_pk_bf16_f32 v64, v64, v65
v_cvt_pk_bf16_f32 v65, v66, v67
v_cvt_pk_bf16_f32 v66, v68, v69
v_mfma_f32_16x16x32_bf16 v[96:99], v[204:207], a[120:123], v[96:99]
ds_read_b64_tr_b16 v[170:171], v4 offset:4352
v_cvt_pk_bf16_f32 v67, v70, v71
buffer_store_dwordx4 v[64:67], v3, s[88:91], s30 offen offset:1024 sc1
v_fmac_f32 v72, v9, v136
v_fmac_f32 v73, v9, v137
v_mfma_f32_16x16x32_bf16 v[112:115], v[204:207], a[124:127], v[112:115]
ds_read_b64_tr_b16 v[172:173], v4 offset:8448
v_fmac_f32 v74, v9, v138
v_fmac_f32 v75, v9, v139
v_fmac_f32 v76, v9, v140
v_fmac_f32 v77, v9, v141
v_mfma_f32_16x16x32_bf16 v[112:115], v[200:203], a[116:119], v[112:115]
ds_read_b64_tr_b16 v[174:175], v4 offset:12544
v_fmac_f32 v78, v9, v142
v_fmac_f32 v79, v9, v143
v_cvt_pk_bf16_f32 v72, v72, v73
v_cvt_pk_bf16_f32 v73, v74, v75
v_mfma_f32_16x16x32_bf16 v[116:119], v[208:211], a[116:119], v[116:119]
ds_read_b64_tr_b16 v[176:177], v5 offset:256
v_cvt_pk_bf16_f32 v74, v76, v77
v_cvt_pk_bf16_f32 v75, v78, v79
buffer_store_dwordx4 v[72:75], v3, s[88:91], s30 offen offset:2048 sc1
v_fmac_f32 v80, v9, v144
v_mfma_f32_16x16x32_bf16 v[116:119], v[212:215], a[124:127], v[116:119]
ds_read_b64_tr_b16 v[178:179], v5 offset:4352
s_waitcnt lgkmcnt(6)
v_fmac_f32 v81, v9, v145
v_fmac_f32 v82, v9, v146
v_fmac_f32 v83, v9, v147
v_fmac_f32 v84, v9, v148
v_mfma_f32_16x16x32_bf16 v[100:103], v[212:215], a[120:123], v[100:103]
ds_read_b64_tr_b16 v[180:181], v5 offset:8448
v_fmac_f32 v85, v9, v149
v_fmac_f32 v86, v9, v150
v_fmac_f32 v87, v9, v151
v_cvt_pk_bf16_f32 v80, v80, v81
v_mfma_f32_16x16x32_bf16 v[100:103], v[208:211], a[112:115], v[100:103]
ds_read_b64_tr_b16 v[182:183], v5 offset:12544
v_cvt_pk_bf16_f32 v81, v82, v83
v_cvt_pk_bf16_f32 v82, v84, v85
v_cvt_pk_bf16_f32 v83, v86, v87
buffer_store_dwordx4 v[80:83], v3, s[88:91], s30 offen offset:3072 sc1
v_mfma_f32_16x16x32_bf16 v[88:91], v[152:155], a[64:67], v[88:91]
ds_read_b64_tr_b16 v[184:185], v4 offset:16384
v_mul_f32 v32, v10, v32
v_mfma_f32_16x16x32_bf16 v[88:91], v[156:159], a[72:75], v[88:91]
ds_read_b64_tr_b16 v[186:187], v4 offset:20480
v_mul_f32 v33, v10, v33
v_mfma_f32_16x16x32_bf16 v[104:107], v[156:159], a[76:79], v[104:107]
ds_read_b64_tr_b16 v[188:189], v4 offset:24576
v_mul_f32 v34, v10, v34
v_mfma_f32_16x16x32_bf16 v[104:107], v[152:155], a[68:71], v[104:107]
ds_read_b64_tr_b16 v[190:191], v4 offset:28672
v_mul_f32 v35, v10, v35
v_mfma_f32_16x16x32_bf16 v[108:111], v[160:163], a[68:71], v[108:111]
ds_read_b64_tr_b16 v[192:193], v5 offset:16384
v_mul_f32 v36, v10, v36
v_mfma_f32_16x16x32_bf16 v[108:111], v[164:167], a[76:79], v[108:111]
ds_read_b64_tr_b16 v[194:195], v5 offset:20480
v_mul_f32 v37, v10, v37
v_mfma_f32_16x16x32_bf16 v[92:95], v[164:167], a[72:75], v[92:95]
ds_read_b64_tr_b16 v[196:197], v5 offset:24576
s_waitcnt lgkmcnt(7)
v_mfma_f32_16x16x32_bf16 v[92:95], v[160:163], a[64:67], v[92:95]
ds_read_b64_tr_b16 v[198:199], v5 offset:28672
v_mul_f32 v38, v10, v38
v_mfma_f32_16x16x32_bf16 v[96:99], v[168:171], a[64:67], v[96:99]
ds_read_b64_tr_b16 v[200:201], v4 offset:16640
v_mul_f32 v39, v10, v39
v_mfma_f32_16x16x32_bf16 v[96:99], v[172:175], a[72:75], v[96:99]
ds_read_b64_tr_b16 v[202:203], v4 offset:20736
v_mul_f32 v40, v11, v40
v_mfma_f32_16x16x32_bf16 v[112:115], v[172:175], a[76:79], v[112:115]
ds_read_b64_tr_b16 v[204:205], v4 offset:24832
v_mul_f32 v41, v11, v41
v_mfma_f32_16x16x32_bf16 v[112:115], v[168:171], a[68:71], v[112:115]
ds_read_b64_tr_b16 v[206:207], v4 offset:28928
v_mul_f32 v42, v11, v42
v_mfma_f32_16x16x32_bf16 v[116:119], v[176:179], a[68:71], v[116:119]
ds_read_b64_tr_b16 v[208:209], v5 offset:16640
v_mul_f32 v43, v11, v43
v_mfma_f32_16x16x32_bf16 v[116:119], v[180:183], a[76:79], v[116:119]
ds_read_b64_tr_b16 v[210:211], v5 offset:20736
s_waitcnt lgkmcnt(6)
v_mfma_f32_16x16x32_bf16 v[100:103], v[180:183], a[72:75], v[100:103]
ds_read_b64_tr_b16 v[212:213], v5 offset:24832
v_mul_f32 v44, v11, v44
v_mfma_f32_16x16x32_bf16 v[100:103], v[176:179], a[64:67], v[100:103]
ds_read_b64_tr_b16 v[214:215], v5 offset:28928
v_mul_f32 v45, v11, v45
v_mfma_f32_16x16x32_bf16 v[88:91], v[184:187], a[80:83], v[88:91]
v_mul_f32 v46, v11, v46
v_mul_f32 v47, v11, v47
v_mfma_f32_16x16x32_bf16 v[88:91], v[188:191], a[88:91], v[88:91]
v_mul_f32 v48, v11, v48
v_mul_f32 v49, v11, v49
v_mfma_f32_16x16x32_bf16 v[104:107], v[188:191], a[92:95], v[104:107]
v_mul_f32 v50, v11, v50
v_mul_f32 v51, v11, v51
v_mfma_f32_16x16x32_bf16 v[104:107], v[184:187], a[84:87], v[104:107]
v_mul_f32 v52, v11, v52
v_mul_f32 v53, v11, v53
v_mfma_f32_16x16x32_bf16 v[108:111], v[192:195], a[84:87], v[108:111]
v_mul_f32 v54, v11, v54
v_mul_f32 v55, v11, v55
v_mfma_f32_16x16x32_bf16 v[108:111], v[196:199], a[92:95], v[108:111]
v_mfma_f32_16x16x32_bf16 v[92:95], v[196:199], a[88:91], v[92:95]
s_waitcnt lgkmcnt(0)
v_mfma_f32_16x16x32_bf16 v[92:95], v[192:195], a[80:83], v[92:95]
v_mfma_f32_16x16x32_bf16 v[96:99], v[200:203], a[80:83], v[96:99]
v_mfma_f32_16x16x32_bf16 v[96:99], v[204:207], a[88:91], v[96:99]
v_mfma_f32_16x16x32_bf16 v[112:115], v[204:207], a[92:95], v[112:115]
v_mfma_f32_16x16x32_bf16 v[112:115], v[200:203], a[84:87], v[112:115]
v_mfma_f32_16x16x32_bf16 v[116:119], v[208:211], a[84:87], v[116:119]
v_mfma_f32_16x16x32_bf16 v[116:119], v[212:215], a[92:95], v[116:119]
v_mfma_f32_16x16x32_bf16 v[100:103], v[212:215], a[88:91], v[100:103]
v_mfma_f32_16x16x32_bf16 v[100:103], v[208:211], a[80:83], v[100:103]
buffer_load_dwordx4 v[152:155], v3, s[88:91], s28 offen offset:0 sc1
buffer_load_dwordx4 v[156:159], v3, s[88:91], s28 offen offset:1024 sc1
buffer_load_dwordx4 v[160:163], v3, s[88:91], s28 offen offset:2048 sc1
buffer_load_dwordx4 v[164:167], v3, s[88:91], s28 offen offset:3072 sc1
v_fmac_f32 v24, v8, v88
v_fmac_f32 v25, v8, v89
v_fmac_f32 v26, v8, v90
v_fmac_f32 v27, v8, v91
v_fmac_f32 v28, v8, v92
v_fmac_f32 v29, v8, v93
v_fmac_f32 v30, v8, v94
v_fmac_f32 v31, v8, v95
v_fmac_f32 v32, v8, v96
v_fmac_f32 v33, v8, v97
v_fmac_f32 v34, v8, v98
v_fmac_f32 v35, v8, v99
v_fmac_f32 v36, v8, v100
v_fmac_f32 v37, v8, v101
v_fmac_f32 v38, v8, v102
v_fmac_f32 v39, v8, v103
v_fmac_f32 v40, v9, v104
v_fmac_f32 v41, v9, v105
v_fmac_f32 v42, v9, v106
v_fmac_f32 v43, v9, v107
v_fmac_f32 v44, v9, v108
v_fmac_f32 v45, v9, v109
v_fmac_f32 v46, v9, v110
v_fmac_f32 v47, v9, v111
v_fmac_f32 v48, v9, v112
v_fmac_f32 v49, v9, v113
v_fmac_f32 v50, v9, v114
v_fmac_f32 v51, v9, v115
v_fmac_f32 v52, v9, v116
v_fmac_f32 v53, v9, v117
v_fmac_f32 v54, v9, v118
v_fmac_f32 v55, v9, v119
s_mov_b32 s92, 200000
L_spin_x:
s_waitcnt vmcnt(0)
v_max3_u32 v168, v152, v153, 0
v_max3_u32 v168, v154, v155, v168
v_max3_u32 v168, v156, v157, v168
v_max3_u32 v168, v158, v159, v168
v_max3_u32 v168, v160, v161, v168
v_max3_u32 v168, v162, v163, v168
v_max3_u32 v168, v164, v165, v168
v_max3_u32 v168, v166, v167, v168
v_cmp_eq_u32 vcc, -1, v168
s_sub_u32 s92, s92, 1
s_cbranch_scc1 L_spun_x
s_nop 3
s_cbranch_vccz L_spun_x
s_sleep 2
buffer_load_dwordx4 v[152:155], v3, s[88:91], s28 offen offset:0 sc1
buffer_load_dwordx4 v[156:159], v3, s[88:91], s28 offen offset:1024 sc1
buffer_load_dwordx4 v[160:163], v3, s[88:91], s28 offen offset:2048 sc1
buffer_load_dwordx4 v[164:167], v3, s[88:91], s28 offen offset:3072 sc1
s_branch L_spin_x
L_spun_x:
v_lshlrev_b32 v168, 16, v152
v_and_b32 v169, 0xffff0000, v152
v_pk_add_f32 v[24:25], v[24:25], v[168:169]
v_lshlrev_b32 v168, 16, v153
v_and_b32 v169, 0xffff0000, v153
v_pk_add_f32 v[26:27], v[26:27], v[168:169]
v_lshlrev_b32 v168, 16, v154
v_and_b32 v169, 0xffff0000, v154
v_pk_add_f32 v[28:29], v[28:29], v[168:169]
v_lshlrev_b32 v168, 16, v155
v_and_b32 v169, 0xffff0000, v155
v_pk_add_f32 v[30:31], v[30:31], v[168:169]
v_cvt_pk_bf16_f32 v24, v24, v25
v_cvt_pk_bf16_f32 v25, v26, v27
v_cvt_pk_bf16_f32 v26, v28, v29
v_cvt_pk_bf16_f32 v27, v30, v31
s_nop 1
v_permlane16_swap_b32 v24, v26
v_permlane16_swap_b32 v25, v27
buffer_store_dwordx4 v[24:27], v17, s[80:83], s29 offen offset:0 sc1
v_lshlrev_b32 v168, 16, v156
v_and_b32 v169, 0xffff0000, v156
v_pk_add_f32 v[32:33], v[32:33], v[168:169]
v_lshlrev_b32 v168, 16, v157
v_and_b32 v169, 0xffff0000, v157
v_pk_add_f32 v[34:35], v[34:35], v[168:169]
v_lshlrev_b32 v168, 16, v158
v_and_b32 v169, 0xffff0000, v158
v_pk_add_f32 v[36:37], v[36:37], v[168:169]
v_lshlrev_b32 v168, 16, v159
v_and_b32 v169, 0xffff0000, v159
v_pk_add_f32 v[38:39], v[38:39], v[168:169]
v_cvt_pk_bf16_f32 v32, v32, v33
v_cvt_pk_bf16_f32 v33, v34, v35
v_cvt_pk_bf16_f32 v34, v36, v37
v_cvt_pk_bf16_f32 v35, v38, v39
s_nop 1
v_permlane16_swap_b32 v32, v34
v_permlane16_swap_b32 v33, v35
buffer_store_dwordx4 v[32:35], v17, s[80:83], s29 offen offset:64 sc1
v_lshlrev_b32 v168, 16, v160
v_and_b32 v169, 0xffff0000, v160
v_pk_add_f32 v[40:41], v[40:41], v[168:169]
v_lshlrev_b32 v168, 16, v161
v_and_b32 v169, 0xffff0000, v161
v_pk_add_f32 v[42:43], v[42:43], v[168:169]
v_lshlrev_b32 v168, 16, v162
v_and_b32 v169, 0xffff0000, v162
v_pk_add_f32 v[44:45], v[44:45], v[168:169]
v_lshlrev_b32 v168, 16, v163
v_and_b32 v169, 0xffff0000, v163
v_pk_add_f32 v[46:47], v[46:47], v[168:169]
v_cvt_pk_bf16_f32 v40, v40, v41
v_cvt_pk_bf16_f32 v41, v42, v43
v_cvt_pk_bf16_f32 v42, v44, v45
v_cvt_pk_bf16_f32 v43, v46, v47
s_nop 1
v_permlane16_swap_b32 v40, v42
v_permlane16_swap_b32 v41, v43
buffer_store_dwordx4 v[40:43], v17, s[80:83], s31 offen offset:0 sc1
v_lshlrev_b32 v168, 16, v164
v_and_b32 v169, 0xffff0000, v164
v_pk_add_f32 v[48:49], v[48:49], v[168:169]
v_lshlrev_b32 v168, 16, v165
v_and_b32 v169, 0xffff0000, v165
v_pk_add_f32 v[50:51], v[50:51], v[168:169]
v_lshlrev_b32 v168, 16, v166
v_and_b32 v169, 0xffff0000, v166
v_pk_add_f32 v[52:53], v[52:53], v[168:169]
v_lshlrev_b32 v168, 16, v167
v_and_b32 v169, 0xffff0000, v167
v_pk_add_f32 v[54:55], v[54:55], v[168:169]
v_cvt_pk_bf16_f32 v48, v48, v49
v_cvt_pk_bf16_f32 v49, v50, v51
v_cvt_pk_bf16_f32 v50, v52, v53
v_cvt_pk_bf16_f32 v51, v54, v55
s_nop 1
v_permlane16_swap_b32 v48, v50
v_permlane16_swap_b32 v49, v51
buffer_store_dwordx4 v[48:51], v17, s[80:83], s31 offen offset:64 sc1
L_end:
s_endpgm
L_att_fallback:
s_waitcnt vmcnt(0)
s_mov_b32 s33, 1
s_mul_i32 s32, s5, 0x10c400
s_lshl_b32 s19, s4, 13
s_add_u32 s32, s32, s19
s_cmp_eq_u32 s4, 0
s_cselect_b32 s94, 0x200000, 0
s_add_u32 s32, s32, s94
s_sub_u32 s94, 0x8000, s94
s_add_u32 s7, s32, 0x1000
s_add_u32 s27, s19, 131072
v_and_b32 v5, 15, v0
v_lshrrev_b32 v6, 4, v0
v_lshlrev_b32 v6, 2, v6
v_sub_u32 v5, v5, v6
v_mov_b32 v9, 0xf149f2ca
s_lshr_b32 s8, s20, 11
v_add_u32 v96, s8, v5
v_mov_b32 v80, v9
s_lshr_b32 s8, s21, 11
v_add_u32 v97, s8, v5
v_mov_b32 v84, v9
s_lshr_b32 s8, s22, 11
v_add_u32 v98, s8, v5
v_mov_b32 v88, v9
s_lshr_b32 s8, s23, 11
v_add_u32 v99, s8, v5
v_mov_b32 v92, v9
s_sub_u32 s15, 16, s6
s_lshl_b32 s15, s15, 1
L_fb_loop:
s_waitcnt lgkmcnt(0)
s_barrier
s_add_u32 m0, s19, 0x0
s_nop 0
buffer_load_dwordx4 v3, s[48:51], s32 offen offset:0 sc1 lds
buffer_load_dwordx4 v3, s[48:51], s32 offen offset:1024 sc1 lds
buffer_load_dwordx4 v3, s[48:51], s32 offen offset:2048 sc1 lds
buffer_load_dwordx4 v3, s[48:51], s32 offen offset:3072 sc1 lds
s_add_u32 m0, s19, 0x1000
s_nop 0
buffer_load_dwordx4 v3, s[48:51], s7 offen offset:0 sc1 lds
buffer_load_dwordx4 v3, s[48:51], s7 offen offset:1024 sc1 lds
buffer_load_dwordx4 v3, s[48:51], s7 offen offset:2048 sc1 lds
buffer_load_dwordx4 v3, s[48:51], s7 offen offset:3072 sc1 lds
s_add_u32 s32, s32, s94
s_add_u32 s7, s7, s94
s_mov_b32 s94, 0x8000
s_waitcnt vmcnt(0)
s_barrier
ds_read_b128 a[0:3], v3 offset:8192
ds_read_b128 a[4:7], v3 offset:9216
ds_read_b128 a[8:11], v3 offset:10240
ds_read_b128 a[12:15], v3 offset:11264
ds_read_b128 a[16:19], v3 offset:12288
ds_read_b128 a[20:23], v3 offset:13312
ds_read_b128 a[24:27], v3 offset:14336
ds_read_b128 a[28:31], v3 offset:15360
s_waitcnt lgkmcnt(0)
v_mfma_f32_16x16x32_bf16 v[16:19], a[0:3], a[160:163], 0
v_mfma_f32_16x16x32_bf16 v[16:19], a[4:7], a[164:167], v[16:19]
v_mfma_f32_16x16x32_bf16 v[16:19], a[8:11], a[168:171], v[16:19]
v_mfma_f32_16x16x32_bf16 v[16:19], a[12:15], a[172:175], v[16:19]
v_mfma_f32_16x16x32_bf16 v[20:23], a[0:3], a[176:179], 0
v_mfma_f32_16x16x32_bf16 v[20:23], a[4:7], a[180:183], v[20:23]
v_mfma_f32_16x16x32_bf16 v[20:23], a[8:11], a[184:187], v[20:23]
v_mfma_f32_16x16x32_bf16 v[20:23], a[12:15], a[188:191], v[20:23]
v_mfma_f32_16x16x32_bf16 v[24:27], a[0:3], a[192:195], 0
v_mfma_f32_16x16x32_bf16 v[24:27], a[4:7], a[196:199], v[24:27]
v_mfma_f32_16x16x32_bf16 v[24:27], a[8:11], a[200:203], v[24:27]
v_mfma_f32_16x16x32_bf16 v[24:27], a[12:15], a[204:207], v[24:27]
v_mfma_f32_16x16x32_bf16 v[28:31], a[0:3], a[208:211], 0
v_mfma_f32_16x16x32_bf16 v[28:31], a[4:7], a[212:215], v[28:31]
v_mfma_f32_16x16x32_bf16 v[28:31], a[8:11], a[216:219], v[28:31]
v_mfma_f32_16x16x32_bf16 v[28:31], a[12:15], a[220:223], v[28:31]
v_mfma_f32_16x16x32_bf16 v[32:35], a[16:19], a[160:163], 0
v_mfma_f32_16x16x32_bf16 v[32:35], a[20:23], a[164:167], v[32:35]
v_mfma_f32_16x16x32_bf16 v[32:35], a[24:27], a[168:171], v[32:35]
v_mfma_f32_16x16x32_bf16 v[32:35], a[28:31], a[172:175], v[32:35]
v_mfma_f32_16x16x32_bf16 v[36:39], a[16:19], a[176:179], 0
v_mfma_f32_16x16x32_bf16 v[36:39], a[20:23], a[180:183], v[36:39]
v_mfma_f32_16x16x32_bf16 v[36:39], a[24:27], a[184:187], v[36:39]
v_mfma_f32_16x16x32_bf16 v[36:39], a[28:31], a[188:191], v[36:39]
v_mfma_f32_16x16x32_bf16 v[40:43], a[16:19], a[192:195], 0
v_mfma_f32_16x16x32_bf16 v[40:43], a[20:23], a[196:199], v[40:43]
v_mfma_f32_16x16x32_bf16 v[40:43], a[24:27], a[200:203], v[40:43]
v_mfma_f32_16x16x32_bf16 v[40:43], a[28:31], a[204:207], v[40:43]
v_mfma_f32_16x16x32_bf16 v[44:47], a[16:19], a[208:211], 0
v_mfma_f32_16x16x32_bf16 v[44:47], a[20:23], a[212:215], v[44:47]
v_mfma_f32_16x16x32_bf16 v[44:47], a[24:27], a[216:219], v[44:47]
v_mfma_f32_16x16x32_bf16 v[44:47], a[28:31], a[220:223], v[44:47]
s_nop 7
v_cmp_le_i32 s[36:37], 0, v96
v_cmp_le_i32 s[38:39], 1, v96
v_cmp_le_i32 s[40:41], 2, v96
v_cmp_le_i32 s[42:43], 3, v96
s_nop 1
v_cndmask_b32 v16, v9, v16, s[36:37]
v_cndmask_b32 v17, v9, v17, s[38:39]
v_cndmask_b32 v18, v9, v18, s[40:41]
v_cndmask_b32 v19, v9, v19, s[42:43]
v_max3_f32 v80, v80, v16, v17
v_max3_f32 v80, v80, v18, v19
v_cmp_le_i32 s[36:37], 0, v97
v_cmp_le_i32 s[38:39], 1, v97
v_cmp_le_i32 s[40:41], 2, v97
v_cmp_le_i32 s[42:43], 3, v97
s_nop 1
v_cndmask_b32 v20, v9, v20, s[36:37]
v_cndmask_b32 v21, v9, v21, s[38:39]
v_cndmask_b32 v22, v9, v22, s[40:41]
v_cndmask_b32 v23, v9, v23, s[42:43]
v_max3_f32 v84, v84, v20, v21
v_max3_f32 v84, v84, v22, v23
v_cmp_le_i32 s[36:37], 0, v98
v_cmp_le_i32 s[38:39], 1, v98
v_cmp_le_i32 s[40:41], 2, v98
v_cmp_le_i32 s[42:43], 3, v98
s_nop 1
v_cndmask_b32 v24, v9, v24, s[36:37]
v_cndmask_b32 v25, v9, v25, s[38:39]
v_cndmask_b32 v26, v9, v26, s[40:41]
v_cndmask_b32 v27, v9, v27, s[42:43]
v_max3_f32 v88, v88, v24, v25
v_max3_f32 v88, v88, v26, v27
v_cmp_le_i32 s[36:37], 0, v99
v_cmp_le_i32 s[38:39], 1, v99
v_cmp_le_i32 s[40:41], 2, v99
v_cmp_le_i32 s[42:43], 3, v99
s_nop 1
v_cndmask_b32 v28, v9, v28, s[36:37]
v_cndmask_b32 v29, v9, v29, s[38:39]
v_cndmask_b32 v30, v9, v30, s[40:41]
v_cndmask_b32 v31, v9, v31, s[42:43]
v_max3_f32 v92, v92, v28, v29
v_max3_f32 v92, v92, v30, v31
v_cmp_le_i32 s[36:37], 16, v96
v_cmp_le_i32 s[38:39], 17, v96
v_cmp_le_i32 s[40:41], 18, v96
v_cmp_le_i32 s[42:43], 19, v96
s_nop 1
v_cndmask_b32 v32, v9, v32, s[36:37]
v_cndmask_b32 v33, v9, v33, s[38:39]
v_cndmask_b32 v34, v9, v34, s[40:41]
v_cndmask_b32 v35, v9, v35, s[42:43]
v_max3_f32 v80, v80, v32, v33
v_max3_f32 v80, v80, v34, v35
v_cmp_le_i32 s[36:37], 16, v97
v_cmp_le_i32 s[38:39], 17, v97
v_cmp_le_i32 s[40:41], 18, v97
v_cmp_le_i32 s[42:43], 19, v97
s_nop 1
v_cndmask_b32 v36, v9, v36, s[36:37]
v_cndmask_b32 v37, v9, v37, s[38:39]
v_cndmask_b32 v38, v9, v38, s[40:41]
v_cndmask_b32 v39, v9, v39, s[42:43]
v_max3_f32 v84, v84, v36, v37
v_max3_f32 v84, v84, v38, v39
v_cmp_le_i32 s[36:37], 16, v98
v_cmp_le_i32 s[38:39], 17, v98
v_cmp_le_i32 s[40:41], 18, v98
v_cmp_le_i32 s[42:43], 19, v98
s_nop 1
v_cndmask_b32 v40, v9, v40, s[36:37]
v_cndmask_b32 v41, v9, v41, s[38:39]
v_cndmask_b32 v42, v9, v42, s[40:41]
v_cndmask_b32 v43, v9, v43, s[42:43]
v_max3_f32 v88, v88, v40, v41
v_max3_f32 v88, v88, v42, v43
v_cmp_le_i32 s[36:37], 16, v99
v_cmp_le_i32 s[38:39], 17, v99
v_cmp_le_i32 s[40:41], 18, v99
v_cmp_le_i32 s[42:43], 19, v99
s_nop 1
v_cndmask_b32 v44, v9, v44, s[36:37]
v_cndmask_b32 v45, v9, v45, s[38:39]
v_cndmask_b32 v46, v9, v46, s[40:41]
v_cndmask_b32 v47, v9, v47, s[42:43]
v_max3_f32 v92, v92, v44, v45
v_max3_f32 v92, v92, v46, v47
ds_read_b128 a[0:3], v3 offset:24576
ds_read_b128 a[4:7], v3 offset:25600
ds_read_b128 a[8:11], v3 offset:26624
ds_read_b128 a[12:15], v3 offset:27648
ds_read_b128 a[16:19], v3 offset:28672
ds_read_b128 a[20:23], v3 offset:29696
ds_read_b128 a[24:27], v3 offset:30720
ds_read_b128 a[28:31], v3 offset:31744
s_waitcnt lgkmcnt(0)
v_mfma_f32_16x16x32_bf16 v[16:19], a[0:3], a[160:163], 0
v_mfma_f32_16x16x32_bf16 v[16:19], a[4:7], a[164:167], v[16:19]
v_mfma_f32_16x16x32_bf16 v[16:19], a[8:11], a[168:171], v[16:19]
v_mfma_f32_16x16x32_bf16 v[16:19], a[12:15], a[172:175], v[16:19]
v_mfma_f32_16x16x32_bf16 v[20:23], a[0:3], a[176:179], 0
v_mfma_f32_16x16x32_bf16 v[20:23], a[4:7], a[180:183], v[20:23]
v_mfma_f32_16x16x32_bf16 v[20:23], a[8:11], a[184:187], v[20:23]
v_mfma_f32_16x16x32_bf16 v[20:23], a[12:15], a[188:191], v[20:23]
v_mfma_f32_16x16x32_bf16 v[24:27], a[0:3], a[192:195], 0
v_mfma_f32_16x16x32_bf16 v[24:27], a[4:7], a[196:199], v[24:27]
v_mfma_f32_16x16x32_bf16 v[24:27], a[8:11], a[200:203], v[24:27]
v_mfma_f32_16x16x32_bf16 v[24:27], a[12:15], a[204:207], v[24:27]
v_mfma_f32_16x16x32_bf16 v[28:31], a[0:3], a[208:211], 0
v_mfma_f32_16x16x32_bf16 v[28:31], a[4:7], a[212:215], v[28:31]
v_mfma_f32_16x16x32_bf16 v[28:31], a[8:11], a[216:219], v[28:31]
v_mfma_f32_16x16x32_bf16 v[28:31], a[12:15], a[220:223], v[28:31]
v_mfma_f32_16x16x32_bf16 v[32:35], a[16:19], a[160:163], 0
v_mfma_f32_16x16x32_bf16 v[32:35], a[20:23], a[164:167], v[32:35]
v_mfma_f32_16x16x32_bf16 v[32:35], a[24:27], a[168:171], v[32:35]
v_mfma_f32_16x16x32_bf16 v[32:35], a[28:31], a[172:175], v[32:35]
v_mfma_f32_16x16x32_bf16 v[36:39], a[16:19], a[176:179], 0
v_mfma_f32_16x16x32_bf16 v[36:39], a[20:23], a[180:183], v[36:39]
v_mfma_f32_16x16x32_bf16 v[36:39], a[24:27], a[184:187], v[36:39]
v_mfma_f32_16x16x32_bf16 v[36:39], a[28:31], a[188:191], v[36:39]
v_mfma_f32_16x16x32_bf16 v[40:43], a[16:19], a[192:195], 0
v_mfma_f32_16x16x32_bf16 v[40:43], a[20:23], a[196:199], v[40:43]
v_mfma_f32_16x16x32_bf16 v[40:43], a[24:27], a[200:203], v[40:43]
v_mfma_f32_16x16x32_bf16 v[40:43], a[28:31], a[204:207], v[40:43]
v_mfma_f32_16x16x32_bf16 v[44:47], a[16:19], a[208:211], 0
v_mfma_f32_16x16x32_bf16 v[44:47], a[20:23], a[212:215], v[44:47]
v_mfma_f32_16x16x32_bf16 v[44:47], a[24:27], a[216:219], v[44:47]
v_mfma_f32_16x16x32_bf16 v[44:47], a[28:31], a[220:223], v[44:47]
s_nop 7
v_cmp_le_i32 s[36:37], 32, v96
v_cmp_le_i32 s[38:39], 33, v96
v_cmp_le_i32 s[40:41], 34, v96
v_cmp_le_i32 s[42:43], 35, v96
s_nop 1
v_cndmask_b32 v16, v9, v16, s[36:37]
v_cndmask_b32 v17, v9, v17, s[38:39]
v_cndmask_b32 v18, v9, v18, s[40:41]
v_cndmask_b32 v19, v9, v19, s[42:43]
v_max3_f32 v80, v80, v16, v17
v_max3_f32 v80, v80, v18, v19
v_cmp_le_i32 s[36:37], 32, v97
v_cmp_le_i32 s[38:39], 33, v97
v_cmp_le_i32 s[40:41], 34, v97
v_cmp_le_i32 s[42:43], 35, v97
s_nop 1
v_cndmask_b32 v20, v9, v20, s[36:37]
v_cndmask_b32 v21, v9, v21, s[38:39]
v_cndmask_b32 v22, v9, v22, s[40:41]
v_cndmask_b32 v23, v9, v23, s[42:43]
v_max3_f32 v84, v84, v20, v21
v_max3_f32 v84, v84, v22, v23
v_cmp_le_i32 s[36:37], 32, v98
v_cmp_le_i32 s[38:39], 33, v98
v_cmp_le_i32 s[40:41], 34, v98
v_cmp_le_i32 s[42:43], 35, v98
s_nop 1
v_cndmask_b32 v24, v9, v24, s[36:37]
v_cndmask_b32 v25, v9, v25, s[38:39]
v_cndmask_b32 v26, v9, v26, s[40:41]
v_cndmask_b32 v27, v9, v27, s[42:43]
v_max3_f32 v88, v88, v24, v25
v_max3_f32 v88, v88, v26, v27
v_cmp_le_i32 s[36:37], 32, v99
v_cmp_le_i32 s[38:39], 33, v99
v_cmp_le_i32 s[40:41], 34, v99
v_cmp_le_i32 s[42:43], 35, v99
s_nop 1
v_cndmask_b32 v28, v9, v28, s[36:37]
v_cndmask_b32 v29, v9, v29, s[38:39]
v_cndmask_b32 v30, v9, v30, s[40:41]
v_cndmask_b32 v31, v9, v31, s[42:43]
v_max3_f32 v92, v92, v28, v29
v_max3_f32 v92, v92, v30, v31
v_cmp_le_i32 s[36:37], 48, v96
v_cmp_le_i32 s[38:39], 49, v96
v_cmp_le_i32 s[40:41], 50, v96
v_cmp_le_i32 s[42:43], 51, v96
s_nop 1
v_cndmask_b32 v32, v9, v32, s[36:37]
v_cndmask_b32 v33, v9, v33, s[38:39]
v_cndmask_b32 v34, v9, v34, s[40:41]
v_cndmask_b32 v35, v9, v35, s[42:43]
v_max3_f32 v80, v80, v32, v33
v_max3_f32 v80, v80, v34, v35
v_cmp_le_i32 s[36:37], 48, v97
v_cmp_le_i32 s[38:39], 49, v97
v_cmp_le_i32 s[40:41], 50, v97
v_cmp_le_i32 s[42:43], 51, v97
s_nop 1
v_cndmask_b32 v36, v9, v36, s[36:37]
v_cndmask_b32 v37, v9, v37, s[38:39]
v_cndmask_b32 v38, v9, v38, s[40:41]
v_cndmask_b32 v39, v9, v39, s[42:43]
v_max3_f32 v84, v84, v36, v37
v_max3_f32 v84, v84, v38, v39
v_cmp_le_i32 s[36:37], 48, v98
v_cmp_le_i32 s[38:39], 49, v98
v_cmp_le_i32 s[40:41], 50, v98
v_cmp_le_i32 s[42:43], 51, v98
s_nop 1
v_cndmask_b32 v40, v9, v40, s[36:37]
v_cndmask_b32 v41, v9, v41, s[38:39]
v_cndmask_b32 v42, v9, v42, s[40:41]
v_cndmask_b32 v43, v9, v43, s[42:43]
v_max3_f32 v88, v88, v40, v41
v_max3_f32 v88, v88, v42, v43
v_cmp_le_i32 s[36:37], 48, v99
v_cmp_le_i32 s[38:39], 49, v99
v_cmp_le_i32 s[40:41], 50, v99
v_cmp_le_i32 s[42:43], 51, v99
s_nop 1
v_cndmask_b32 v44, v9, v44, s[36:37]
v_cndmask_b32 v45, v9, v45, s[38:39]
v_cndmask_b32 v46, v9, v46, s[40:41]
v_cndmask_b32 v47, v9, v47, s[42:43]
v_max3_f32 v92, v92, v44, v45
v_max3_f32 v92, v92, v46, v47
v_subrev_u32 v96, 64, v96
v_subrev_u32 v97, 64, v97
v_subrev_u32 v98, 64, v98
v_subrev_u32 v99, 64, v99
s_sub_u32 s15, s15, 1
s_cmp_lg_u32 s15, 0
s_cbranch_scc1 L_fb_loop
v_mov_b32 v16, v80
v_mov_b32 v20, v84
v_mov_b32 v24, v88
v_mov_b32 v28, v92
v_permlane16_swap_b32 v16, v80
v_permlane16_swap_b32 v20, v84
v_permlane16_swap_b32 v24, v88
v_permlane16_swap_b32 v28, v92
v_max_f32 v80, v80, v16
v_max_f32 v84, v84, v20
v_max_f32 v88, v88, v24
v_max_f32 v92, v92, v28
v_mov_b32 v16, v80
v_mov_b32 v20, v84
v_mov_b32 v24, v88
v_mov_b32 v28, v92
v_permlane32_swap_b32 v16, v80
v_permlane32_swap_b32 v20, v84
v_permlane32_swap_b32 v24, v88
v_permlane32_swap_b32 v28, v92
v_max_f32 v80, v80, v16
v_max_f32 v84, v84, v20
v_max_f32 v88, v88, v24
v_max_f32 v92, v92, v28
s_barrier
s_mul_i32 s32, s5, 0x10c400
s_lshl_b32 s19, s4, 13
s_add_u32 s32, s32, s19
s_cmp_eq_u32 s4, 0
s_cselect_b32 s94, 0x200000, 0
s_add_u32 s32, s32, s94
s_sub_u32 s94, 0x8000, s94
s_add_u32 s7, s32, 0x1000
s_add_u32 s27, s19, 131072
s_add_u32 m0, s19, 0x0
s_nop 0
buffer_load_dwordx4 v3, s[48:51], s32 offen offset:0 sc1 lds
buffer_load_dwordx4 v3, s[48:51], s32 offen offset:1024 sc1 lds
buffer_load_dwordx4 v3, s[48:51], s32 offen offset:2048 sc1 lds
buffer_load_dwordx4 v3, s[48:51], s32 offen offset:3072 sc1 lds
s_add_u32 m0, s19, 0x1000
s_nop 0
buffer_load_dwordx4 v3, s[48:51], s7 offen offset:0 sc1 lds
buffer_load_dwordx4 v3, s[48:51], s7 offen offset:1024 sc1 lds
buffer_load_dwordx4 v3, s[48:51], s7 offen offset:2048 sc1 lds
buffer_load_dwordx4 v3, s[48:51], s7 offen offset:3072 sc1 lds
s_add_u32 s32, s32, s94
s_add_u32 s7, s7, s94
s_add_u32 m0, s19, 0x18000
s_nop 0
buffer_load_dwordx4 v3, s[48:51], s32 offen offset:0 sc1 lds
buffer_load_dwordx4 v3, s[48:51], s32 offen offset:1024 sc1 lds
buffer_load_dwordx4 v3, s[48:51], s32 offen offset:2048 sc1 lds
buffer_load_dwordx4 v3, s[48:51], s32 offen offset:3072 sc1 lds
s_add_u32 m0, s19, 0x19000
s_nop 0
buffer_load_dwordx4 v3, s[48:51], s7 offen offset:0 sc1 lds
buffer_load_dwordx4 v3, s[48:51], s7 offen offset:1024 sc1 lds
buffer_load_dwordx4 v3, s[48:51], s7 offen offset:2048 sc1 lds
buffer_load_dwordx4 v3, s[48:51], s7 offen offset:3072 sc1 lds
s_add_u32 s32, s32, 0x8000
s_add_u32 s7, s7, 0x8000
s_add_u32 m0, s19, 0x8000
s_nop 0
buffer_load_dwordx4 v3, s[48:51], s32 offen offset:0 sc1 lds
buffer_load_dwordx4 v3, s[48:51], s32 offen offset:1024 sc1 lds
buffer_load_dwordx4 v3, s[48:51], s32 offen offset:2048 sc1 lds
buffer_load_dwordx4 v3, s[48:51], s32 offen offset:3072 sc1 lds
s_add_u32 m0, s19, 0x9000
s_nop 0
buffer_load_dwordx4 v3, s[48:51], s7 offen offset:0 sc1 lds
buffer_load_dwordx4 v3, s[48:51], s7 offen offset:1024 sc1 lds
buffer_load_dwordx4 v3, s[48:51], s7 offen offset:2048 sc1 lds
buffer_load_dwordx4 v3, s[48:51], s7 offen offset:3072 sc1 lds
s_add_u32 s32, s32, 0x8000
s_add_u32 s7, s7, 0x8000
s_bfe_u32 s99, s2, 0x20001
s_lshl_b32 s99, s99, 2
s_lshr_b32 s8, s2, 6
s_add_u32 s99, s99, s8
s_bfe_u32 s100, s2, 0x30003
s_and_b32 s14, s2, 1
s_sub_u32 s24, 15, s99
s_min_u32 s18, s24, s99
s_lshl_b32 s24, s18, 1
s_add_u32 s24, s24, s14
s_lshl_b32 s24, s24, 8
s_add_u32 s24, s24, 0x3704000
s_mov_b32 s12, 14336
s_and_b32 s16, s6, 1
s_lshl_b32 s16, s16, 15
s_add_u32 s16, s16, 98304
s_add_u32 s16, s16, s17
s_lshl_b32 s13, s4, 15
s_lshl_b32 s9, s100, 8
s_add_u32 s13, s13, s9
s_mul_i32 s9, s14, 1310848
s_add_u32 s13, s13, s9
s_mul_i32 s25, s14, 3407872
s_sub_u32 s25, s25, 1179648
s_mul_i32 s101, s99, 0x142400
s_lshl_b32 s8, s4, 11
s_add_u32 s101, s101, s8
s_mul_i32 s8, s14, 163840
s_add_u32 s101, s101, s8
s_add_u32 s101, s101, 0x21fe000
s_mul_i32 s26, s14, 425984
s_add_u32 s26, s26, 106496
v_mov_b32 v15, s6
v_xor_b32 v15, 0, v15
v_writelane_b32 v15, s18, 0
v_lshlrev_b32 v15, 2, v15
v_bfe_u32 v12, v0, 2, 2
v_lshlrev_b32 v12, 11, v12
v_lshrrev_b32 v13, 4, v0
v_lshl_add_u32 v12, v13, 6, v12
v_and_b32 v13, 3, v0
v_lshl_add_u32 v12, v13, 4, v12
v_xor_b32 v12, s13, v12
v_xor_b32 v13, 32, v12
v_add_u32 v13, 7168, v13
s_mov_b32 s11, 0xf149f2ca
s_mov_b32 s36, 0xfff0ffff
s_mov_b32 s37, 0xf000ff00
s_mov_b32 s38, 0xffe0fffe
s_mov_b32 s39, 0xe000fe00
s_mov_b32 s40, 0xffc0fffc
s_mov_b32 s41, 0xc000fc00
s_mov_b32 s42, 0xff80fff8
s_mov_b32 s43, 0x8000f800
s_bitcmp1_b32 s4, 0
s_cselect_b32 s8, 0x7f800000, s11
s_cselect_b32 s9, s11, 0x7f800000
v_mov_b32 v1, v3
v_add_u32 v2, 98304, v3
s_mov_b64 s[34:35], 0
v_accvgpr_write_b32 a224, 0
v_accvgpr_write_b32 a225, 0
v_accvgpr_write_b32 a226, 0
v_accvgpr_write_b32 a227, 0
v_accvgpr_write_b32 a228, 0
v_accvgpr_write_b32 a229, 0
v_accvgpr_write_b32 a230, 0
v_accvgpr_write_b32 a231, 0
v_sub_f32 v83, 0, v80
v_sub_f32 v82, 0, v80
v_sub_f32 v81, 0, v80
v_sub_f32 v80, 0, v80
v_min_f32 v103, s8, v80
v_cndmask_b32 v96, v103, v80, s[36:37]
v_cndmask_b32 v97, v103, v80, s[38:39]
v_cndmask_b32 v98, v103, v80, s[40:41]
v_cndmask_b32 v99, v103, v80, s[42:43]
v_cndmask_b32 v100, v9, v103, s[36:37]
v_cndmask_b32 v101, v9, v103, s[38:39]
v_cndmask_b32 v102, v9, v103, s[40:41]
v_cndmask_b32 v103, v9, v103, s[42:43]
v_sub_f32 v87, 0, v84
v_sub_f32 v86, 0, v84
v_sub_f32 v85, 0, v84
v_sub_f32 v84, 0, v84
v_min_f32 v111, s9, v84
v_cndmask_b32 v104, v111, v84, s[36:37]
v_cndmask_b32 v105, v111, v84, s[38:39]
v_cndmask_b32 v106, v111, v84, s[40:41]
v_cndmask_b32 v107, v111, v84, s[42:43]
v_cndmask_b32 v108, v9, v111, s[36:37]
v_cndmask_b32 v109, v9, v111, s[38:39]
v_cndmask_b32 v110, v9, v111, s[40:41]
v_cndmask_b32 v111, v9, v111, s[42:43]
v_sub_f32 v91, 0, v88
v_sub_f32 v90, 0, v88
v_sub_f32 v89, 0, v88
v_sub_f32 v88, 0, v88
v_min_f32 v119, s8, v88
v_cndmask_b32 v112, v119, v88, s[36:37]
v_cndmask_b32 v113, v119, v88, s[38:39]
v_cndmask_b32 v114, v119, v88, s[40:41]
v_cndmask_b32 v115, v119, v88, s[42:43]
v_cndmask_b32 v116, v9, v119, s[36:37]
v_cndmask_b32 v117, v9, v119, s[38:39]
v_cndmask_b32 v118, v9, v119, s[40:41]
v_cndmask_b32 v119, v9, v119, s[42:43]
v_sub_f32 v95, 0, v92
v_sub_f32 v94, 0, v92
v_sub_f32 v93, 0, v92
v_sub_f32 v92, 0, v92
v_min_f32 v127, s9, v92
v_cndmask_b32 v120, v127, v92, s[36:37]
v_cndmask_b32 v121, v127, v92, s[38:39]
v_cndmask_b32 v122, v127, v92, s[40:41]
v_cndmask_b32 v123, v127, v92, s[42:43]
v_cndmask_b32 v124, v9, v127, s[36:37]
v_cndmask_b32 v125, v9, v127, s[38:39]
v_cndmask_b32 v126, v9, v127, s[40:41]
v_cndmask_b32 v127, v9, v127, s[42:43]
v_and_b32 v9, 1, v0
v_mul_u32_u24 v9, 0xaaaa, v9
v_add_u32 v9, 0x4444, v9
v_mov_b32 v128, 0
v_mov_b32 v129, 0
v_mov_b32 v130, 0
v_mov_b32 v131, 0
v_mov_b32 v132, 0
v_mov_b32 v133, 0
v_mov_b32 v134, 0
v_mov_b32 v135, 0
v_mov_b32 v136, 0
v_mov_b32 v137, 0
v_mov_b32 v138, 0
v_mov_b32 v139, 0
v_mov_b32 v140, 0
v_mov_b32 v141, 0
v_mov_b32 v142, 0
v_mov_b32 v143, 0
v_mov_b32 v144, 0
v_mov_b32 v145, 0
v_mov_b32 v146, 0
v_mov_b32 v147, 0
v_mov_b32 v148, 0
v_mov_b32 v149, 0
v_mov_b32 v150, 0
v_mov_b32 v151, 0
v_mov_b32 v152, 0
v_mov_b32 v153, 0
v_mov_b32 v154, 0
v_mov_b32 v155, 0
v_mov_b32 v156, 0
v_mov_b32 v157, 0
v_mov_b32 v158, 0
v_mov_b32 v159, 0
v_mov_b32 v160, 0
v_mov_b32 v161, 0
v_mov_b32 v162, 0
v_mov_b32 v163, 0
v_mov_b32 v164, 0
v_mov_b32 v165, 0
v_mov_b32 v166, 0
v_mov_b32 v167, 0
v_mov_b32 v168, 0
v_mov_b32 v169, 0
v_mov_b32 v170, 0
v_mov_b32 v171, 0
v_mov_b32 v172, 0
v_mov_b32 v173, 0
v_mov_b32 v174, 0
v_mov_b32 v175, 0
v_mov_b32 v176, 0
v_mov_b32 v177, 0
v_mov_b32 v178, 0
v_mov_b32 v179, 0
v_mov_b32 v180, 0
v_mov_b32 v181, 0
v_mov_b32 v182, 0
v_mov_b32 v183, 0
v_mov_b32 v184, 0
v_mov_b32 v185, 0
v_mov_b32 v186, 0
v_mov_b32 v187, 0
v_mov_b32 v188, 0
v_mov_b32 v189, 0
v_mov_b32 v190, 0
v_mov_b32 v191, 0
v_mov_b32 v192, 0
v_mov_b32 v193, 0
v_mov_b32 v194, 0
v_mov_b32 v195, 0
v_mov_b32 v196, 0
v_mov_b32 v197, 0
v_mov_b32 v198, 0
v_mov_b32 v199, 0
v_mov_b32 v200, 0
v_mov_b32 v201, 0
v_mov_b32 v202, 0
v_mov_b32 v203, 0
v_mov_b32 v204, 0
v_mov_b32 v205, 0
v_mov_b32 v206, 0
v_mov_b32 v207, 0
v_mov_b32 v208, 0
v_mov_b32 v209, 0
v_mov_b32 v210, 0
v_mov_b32 v211, 0
v_mov_b32 v212, 0
v_mov_b32 v213, 0
v_mov_b32 v214, 0
v_mov_b32 v215, 0
v_mov_b32 v216, 0
v_mov_b32 v217, 0
v_mov_b32 v218, 0
v_mov_b32 v219, 0
v_mov_b32 v220, 0
v_mov_b32 v221, 0
v_mov_b32 v222, 0
v_mov_b32 v223, 0
v_mov_b32 v224, 0
v_mov_b32 v225, 0
v_mov_b32 v226, 0
v_mov_b32 v227, 0
v_mov_b32 v228, 0
v_mov_b32 v229, 0
v_mov_b32 v230, 0
v_mov_b32 v231, 0
v_mov_b32 v232, 0
v_mov_b32 v233, 0
v_mov_b32 v234, 0
v_mov_b32 v235, 0
v_mov_b32 v236, 0
v_mov_b32 v237, 0
v_mov_b32 v238, 0
v_mov_b32 v239, 0
v_mov_b32 v240, 0
v_mov_b32 v241, 0
v_mov_b32 v242, 0
v_mov_b32 v243, 0
v_mov_b32 v244, 0
v_mov_b32 v245, 0
v_mov_b32 v246, 0
v_mov_b32 v247, 0
v_mov_b32 v248, 0
v_mov_b32 v249, 0
v_mov_b32 v250, 0
v_mov_b32 v251, 0
v_mov_b32 v252, 0
v_mov_b32 v253, 0
v_mov_b32 v254, 0
v_mov_b32 v255, 0
s_waitcnt vmcnt(16)
s_barrier
ds_read_b128 a[0:3], v1 offset:8192
ds_read_b128 a[4:7], v1 offset:9216
ds_read_b128 a[8:11], v1 offset:10240
ds_read_b128 a[12:15], v1 offset:11264
ds_read_b128 a[16:19], v1 offset:12288
ds_read_b128 a[20:23], v1 offset:13312
ds_read_b128 a[24:27], v1 offset:14336
ds_read_b128 a[28:31], v1 offset:15360
s_waitcnt lgkmcnt(0)
s_branch L_att_start
.section .rodata,"a"
.p2align 6
.amdhsa_kernel gated_mix__compressed_kv_cla__sliding_local_dilated__prompt_kernel
  .amdhsa_next_free_vgpr 512
  .amdhsa_next_free_sgpr 102
  .amdhsa_accum_offset 256
  .amdhsa_group_segment_fixed_size 0
  .amdhsa_kernarg_size 104
  .amdhsa_user_sgpr_count 2
  .amdhsa_user_sgpr_kernarg_segment_ptr 1
  .amdhsa_system_sgpr_workgroup_id_x 1
.end_amdhsa_kernel
```

```asm
; @launch grid=(256,1,1) block=(256,1,1) lds=163840
.amdgcn_target "amdgcn-amd-amdhsa--gfx950"
.text
.globl gated_mix__compressed_kv_cla__sliding_local_dilated__prompt_kernel
.p2align 8
.type gated_mix__compressed_kv_cla__sliding_local_dilated__prompt_kernel,@function
gated_mix__compressed_kv_cla__sliding_local_dilated__prompt_kernel:
s_load_dwordx16 s[16:31], s[0:1], 0
s_load_dwordx8 s[32:39], s[0:1], 64
s_load_dwordx2 s[88:89], s[0:1], 96
s_cmp_ge_u32 s2, 256
s_cbranch_scc1 L_end
v_lshrrev_b32 v1, 6, v0
v_and_b32 v0, 63, v0
v_readfirstlane_b32 s4, v1
v_lshlrev_b32 v16, 4, v0
s_lshr_b32 s8, s2, 3
s_lshl_b32 s8, s8, 2
s_add_u32 s8, s8, s4
s_min_u32 s8, s8, 101
s_lshl_b32 s8, s8, 10
s_getpc_b64 s[92:93]
L_here:
s_add_u32 s8, s8, L_page0-L_here
s_add_u32 s92, s92, s8
s_addc_u32 s93, s93, 0
v_add_u32 v60, s92, v16
v_mov_b32 v61, s93
global_load_dword a120, v[60:61], off sc1
s_and_b32 s5, s2, 7
s_lshl_b32 s5, s5, 2
s_lshr_b32 s5, 0x75643120, s5
s_and_b32 s5, s5, 7
s_lshl_b32 s5, s5, 2
s_bfe_u32 s3, s2, 0x20003
s_add_u32 s5, s5, s3
s_lshr_b32 s6, s2, 5
s_mov_b32 s12, 0x4000
s_mov_b32 s13, 0x8000
s_mov_b32 s14, 0xc000
s_mov_b32 s46, 0x400000
s_mov_b32 s47, 0x20000
s_mov_b32 s50, 0x200000
s_mov_b32 s51, 0x20000
s_mov_b32 s54, 0x800000
s_mov_b32 s55, 0x20000
s_mov_b32 s58, 0x400000
s_mov_b32 s59, 0x20000
s_mov_b32 s62, 0x400000
s_mov_b32 s63, 0x20000
s_mov_b32 s66, 0x800000
s_mov_b32 s67, 0x20000
s_mov_b32 s70, 0x600000
s_mov_b32 s71, 0x20000
s_mov_b32 s74, 0x200000
s_mov_b32 s75, 0x20000
s_mov_b32 s78, 0x800
s_mov_b32 s79, 0x20000
s_mov_b32 s82, 0x400000
s_mov_b32 s83, 0x20000
s_mov_b32 s86, 0x100
s_mov_b32 s87, 0x20000
s_mov_b32 s90, 0x10000000
s_mov_b32 s91, 0x20000
v_bfe_u32 v17, v0, 2, 2
s_lshl_b32 s8, s4, 4
v_add_u32 v17, s8, v17
v_lshlrev_b32 v17, 13, v17
v_lshrrev_b32 v18, 4, v0
v_lshl_add_u32 v17, v18, 6, v17
v_and_b32 v18, 3, v0
v_lshl_add_u32 v17, v18, 4, v17
s_lshl_b32 s8, s5, 8
v_add_u32 v5, s8, v17
v_xor_b32 v6, 32, v5
v_add_u32 v6, 0x10000, v6
v_lshrrev_b32 v17, 4, v0
v_xor_b32 v17, v17, v0
v_and_b32 v17, 7, v17
v_lshlrev_b32 v17, 4, v17
v_lshrrev_b32 v18, 3, v0
v_lshl_add_u32 v2, v18, 10, v17
s_lshl_b32 s8, s6, 18
s_lshl_b32 s9, s4, 16
s_add_u32 s8, s8, s9
v_add_u32 v2, s8, v2
v_xor_b32 v3, 64, v2
v_add_u32 v3, 0x2000, v3
s_mov_b32 s41, 0
s_mov_b32 s43, 0
v_lshl_add_u32 v5, s41, 19, v5
v_lshl_add_u32 v6, s41, 19, v6
v_lshl_add_u32 v2, s41, 7, v2
v_lshl_add_u32 v3, s41, 7, v3
s_sub_u32 s10, 15, s6
s_cmp_lt_u32 s5, 16
s_cselect_b32 s10, s6, s10
s_lshl_b32 s10, s10, 4
s_and_b32 s11, s5, 15
s_add_u32 s10, s10, s11
s_lshl_b32 s10, s10, 3
s_lshl_b32 s11, s4, 1
s_add_u32 s10, s10, s11
s_lshl_b32 s100, s10, 11
s_lshl_b32 s101, s10, 2
s_add_u32 s101, s101, 0x3700000
s_lshl_b32 s8, s2, 2
s_add_u32 s8, s8, s4
s_lshl_b32 s8, s8, 11
v_lshrrev_b32 v19, 2, v0
v_lshl_add_u32 v19, v19, 7, s8
s_lshr_b32 s8, s2, 3
s_lshl_b32 s8, s8, 2
s_add_u32 s8, s8, s4
s_lshl_b32 s8, s8, 4
s_lshr_b32 s9, s5, 2
s_add_u32 s8, s8, s9
s_lshl_b32 s8, s8, 10
v_bfe_u32 v63, v0, 2, 3
v_lshl_add_u32 v63, v63, 7, s8
v_lshrrev_b32 v59, 5, v0
v_lshl_add_u32 v63, v59, 13, v63
v_mov_b32 v62, v19
s_waitcnt lgkmcnt(0)
s_mov_b64 s[48:49], s[18:19]
s_mov_b64 s[56:57], s[22:23]
s_mov_b64 s[60:61], s[24:25]
L_args:
s_mov_b64 s[0:1], s[92:93]
s_mov_b64 s[44:45], s[16:17]
s_mov_b64 s[76:77], s[34:35]
s_mov_b64 s[52:53], s[20:21]
s_mov_b64 s[64:65], s[26:27]
s_mov_b64 s[68:69], s[30:31]
s_mov_b64 s[72:73], s[32:33]
s_mov_b64 s[80:81], s[36:37]
s_mov_b64 s[84:85], s[38:39]
s_lshl_b32 s16, s4, 13
s_add_u32 s16, s16, 0x18000
s_lshl_b32 s17, s4, 12
s_lshl_b32 s18, s4, 10
s_mov_b32 s25, 0x800
s_mov_b32 s26, 0x1000
s_mov_b32 s3, 0
s_mov_b32 s9, 0x0
s_nop 0
buffer_load_dword a120, v63, s[56:59], s9 offen
s_mov_b32 s9, 0x0
s_nop 0
buffer_load_dword a120, v63, s[60:63], s9 offen
s_add_u32 m0, s17, 0x0
s_nop 0
buffer_load_dwordx4 v5, s[56:59], 0 offen lds
s_add_u32 m0, s17, 0x4000
s_nop 0
buffer_load_dwordx4 v5, s[60:63], 0 offen lds
s_add_u32 m0, s17, 0x400
s_nop 0
buffer_load_dwordx4 v5, s[56:59], s13 offen lds
s_add_u32 m0, s17, 0x4400
s_nop 0
buffer_load_dwordx4 v5, s[60:63], s13 offen lds
s_add_u32 m0, s17, 0x800
s_nop 0
buffer_load_dwordx4 v6, s[56:59], 0 offen lds
s_add_u32 m0, s17, 0x4800
s_nop 0
buffer_load_dwordx4 v6, s[60:63], 0 offen lds
s_add_u32 m0, s17, 0xc00
s_nop 0
buffer_load_dwordx4 v6, s[56:59], s13 offen lds
s_add_u32 m0, s17, 0x4c00
s_nop 0
buffer_load_dwordx4 v6, s[60:63], s13 offen lds
s_mov_b32 s42, 1
s_mov_b32 s41, 7
v_lshl_add_u32 v5, s42, 19, v5
v_lshl_add_u32 v6, s42, 19, v6
s_add_u32 m0, s16, 0x0
s_nop 0
buffer_load_dwordx4 v2, s[48:51], 0 offen lds
s_add_u32 m0, s16, 0x400
s_nop 0
buffer_load_dwordx4 v3, s[48:51], 0 offen lds
s_add_u32 m0, s16, 0x800
s_nop 0
buffer_load_dwordx4 v2, s[48:51], s12 offen lds
s_add_u32 m0, s16, 0xc00
s_nop 0
buffer_load_dwordx4 v3, s[48:51], s12 offen lds
s_add_u32 m0, s16, 0x1000
s_nop 0
buffer_load_dwordx4 v2, s[48:51], s13 offen lds
s_add_u32 m0, s16, 0x1400
s_nop 0
buffer_load_dwordx4 v3, s[48:51], s13 offen lds
s_add_u32 m0, s16, 0x1800
s_nop 0
buffer_load_dwordx4 v2, s[48:51], s14 offen lds
s_add_u32 m0, s16, 0x1c00
s_nop 0
buffer_load_dwordx4 v3, s[48:51], s14 offen lds
v_lshl_add_u32 v2, s42, 7, v2
v_lshl_add_u32 v3, s42, 7, v3
v_lshrrev_b32 v17, 4, v0
v_xor_b32 v17, v17, v0
v_and_b32 v17, 7, v17
v_lshlrev_b32 v17, 4, v17
v_lshrrev_b32 v18, 3, v0
v_lshl_add_u32 v22, v18, 11, v17
v_xor_b32 v23, 64, v22
v_add_u32 v23, 0x4000, v23
s_lshl_b32 s8, s6, 18
s_sub_u32 s9, 15, s6
s_lshl_b32 s9, s9, 18
s_lshl_b32 s10, s4, 15
s_sub_u32 s11, 0x38000, s10
s_add_u32 s20, s8, s10
s_add_u32 s21, s8, s11
s_add_u32 s22, s9, s10
s_add_u32 s23, s9, s11
s_lshl_b32 s10, s5, 15
s_add_u32 s10, s10, 0x3c00000
s_lshr_b32 s8, s8, 7
s_lshr_b32 s9, s9, 7
s_add_u32 s8, s8, s10
s_add_u32 s9, s9, s10
v_add_u32 v10, s8, v16
v_add_u32 v11, s9, v16
s_cmp_lt_u32 s4, 2
s_cselect_b32 s8, s8, s9
s_and_b32 s9, s4, 1
s_lshl_b32 s9, s9, 10
s_add_u32 s8, s8, s9
v_add_u32 v4, s8, v16
v_lshrrev_b32 v17, 2, v0
s_lshl_b32 s8, s4, 4
v_add_u32 v17, s8, v17
v_mul_u32_u24 v17, 0x1800, v17
v_and_b32 v18, 3, v0
v_lshlrev_b32 v18, 4, v18
v_and_b32 v19, 32, v0
v_xor_b32 v18, v18, v19
s_lshl_b32 s8, s5, 6
v_add3_u32 v7, v17, v18, s8
v_lshl_add_u32 v22, s43, 7, v22
v_lshl_add_u32 v23, s43, 7, v23
v_lshl_add_u32 v7, s43, 18, v7
v_lshl_add_u32 v7, s43, 17, v7
v_and_b32 v17, 15, v0
v_lshrrev_b32 v18, 1, v17
v_lshrrev_b32 v19, 4, v0
v_xor_b32 v18, v18, v19
v_lshlrev_b32 v18, 4, v18
v_lshl_add_u32 v8, v17, 7, v18
v_add_u32 v8, s16, v8
v_xor_b32 v9, 64, v8
v_lshrrev_b32 v17, 4, v0
v_lshlrev_b32 v18, 11, v17
v_and_b32 v17, 1, v17
v_lshl_add_u32 v18, v17, 5, v18
v_bfe_u32 v17, v0, 2, 2
v_lshl_add_u32 v18, v17, 6, v18
v_and_b32 v17, 3, v0
v_lshl_add_u32 v12, v17, 3, v18
v_xor_b32 v13, 32, v12
v_lshrrev_b32 v17, 4, v0
v_lshlrev_b32 v18, 9, v17
v_and_b32 v17, 1, v17
v_lshl_add_u32 v18, v17, 5, v18
v_bfe_u32 v17, v0, 2, 2
v_lshl_add_u32 v18, v17, 6, v18
v_and_b32 v17, 3, v0
v_lshl_add_u32 v14, v17, 3, v18
v_accvgpr_write_b32 a64, -1
v_accvgpr_write_b32 a65, -1
v_accvgpr_write_b32 a66, -1
v_accvgpr_write_b32 a67, -1
v_add_u32 v14, 81920, v14
v_xor_b32 v15, 32, v14
s_mul_i32 s32, s5, 0x10c400
s_lshl_b32 s19, s4, 13
s_add_u32 s32, s32, s19
s_cmp_eq_u32 s4, 0
s_cselect_b32 s94, 0x200000, 0
s_add_u32 s32, s32, s94
s_sub_u32 s94, 0x8000, s94
s_add_u32 s7, s32, 0x1000
s_add_u32 s27, s19, 131072
s_add_u32 m0, s16, 0x8000
s_nop 0
buffer_load_dwordx4 v2, s[48:51], 0 offen lds
s_add_u32 m0, s16, 0x8400
s_nop 0
buffer_load_dwordx4 v3, s[48:51], 0 offen lds
s_add_u32 m0, s16, 0x8800
s_nop 0
buffer_load_dwordx4 v2, s[48:51], s12 offen lds
s_add_u32 m0, s16, 0x8c00
s_nop 0
buffer_load_dwordx4 v3, s[48:51], s12 offen lds
s_add_u32 m0, s16, 0x9000
s_nop 0
buffer_load_dwordx4 v2, s[48:51], s13 offen lds
s_add_u32 m0, s16, 0x9400
s_nop 0
buffer_load_dwordx4 v3, s[48:51], s13 offen lds
s_add_u32 m0, s16, 0x9800
s_nop 0
buffer_load_dwordx4 v2, s[48:51], s14 offen lds
s_add_u32 m0, s16, 0x9c00
s_nop 0
buffer_load_dwordx4 v3, s[48:51], s14 offen lds
v_lshl_add_u32 v2, s42, 7, v2
v_lshl_add_u32 v3, s42, 7, v3
s_mov_b32 s9, 0x0
s_nop 0
buffer_load_dword a120, v62, s[48:51], s9 offen
L_hopA:
s_mov_b32 s95, 1
s_cmp_eq_u32 s4, 0
s_cbranch_scc1 L_padA0
s_cmp_eq_u32 s4, 1
s_cbranch_scc1 L_padA1
s_cmp_eq_u32 s4, 2
s_cbranch_scc1 L_padA2
s_branch L_padA3
L_hopA_ret:
s_mov_b32 s95, 0
v_mov_b32 v19, v62
v_mov_b32 v18, v63
s_cmp_lg_u32 s4, 0
s_cbranch_scc1 L_flag_clr
s_lshl_b32 s8, s6, 5
s_add_u32 s8, s8, s5
s_and_b32 s92, s8, 0xf0
s_mul_i32 s92, s92, 3
s_add_u32 s8, s8, s92
s_lshl_b32 s8, s8, 2
s_add_u32 s8, s8, 0x3704000
v_mov_b32 v17, 0
s_mov_b64 exec, 1
buffer_store_dword v17, off, s[88:91], s8 sc1
s_mov_b64 exec, -1
L_flag_clr:
s_waitcnt vmcnt(9)
s_barrier
s_branch L_main
.p2align 12
L_page0:
L_padA0:
s_branch L_padA4
L_main:
ds_read_b64_tr_b16 a[80:81], v12 offset:0
ds_read_b64_tr_b16 a[82:83], v12 offset:1024
ds_read_b64_tr_b16 a[84:85], v12 offset:8192
ds_read_b64_tr_b16 a[86:87], v12 offset:9216
ds_read_b128 a[0:3], v8 offset:0
ds_read_b128 a[16:19], v9 offset:0
ds_read_b128 a[4:7], v8 offset:2048
ds_read_b128 a[20:23], v9 offset:2048
ds_read_b128 a[8:11], v8 offset:4096
ds_read_b128 a[24:27], v9 offset:4096
ds_read_b128 a[12:15], v8 offset:6144
ds_read_b128 a[28:31], v9 offset:6144
ds_read_b64_tr_b16 a[88:89], v13 offset:0
ds_read_b64_tr_b16 a[90:91], v13 offset:1024
ds_read_b64_tr_b16 a[92:93], v13 offset:8192
ds_read_b64_tr_b16 a[94:95], v13 offset:9216
ds_read_b64_tr_b16 a[96:97], v12 offset:256
ds_read_b64_tr_b16 a[98:99], v12 offset:1280
ds_read_b64_tr_b16 a[100:101], v12 offset:8448
ds_read_b64_tr_b16 a[102:103], v12 offset:9472
s_waitcnt lgkmcnt(0)
L_S0:
v_mfma_f32_16x16x32_bf16 v[24:27], a[80:83], a[0:3], 0
ds_read_b64_tr_b16 a[104:105], v13 offset:256
s_add_u32 m0, s17, 0x8000
v_mfma_f32_16x16x32_bf16 v[24:27], a[84:87], a[16:19], v[24:27]
buffer_load_dwordx4 v5, s[56:59], 0 offen lds
v_mfma_f32_16x16x32_bf16 v[32:35], a[84:87], a[20:23], 0
ds_read_b64_tr_b16 a[106:107], v13 offset:1280
v_mfma_f32_16x16x32_bf16 v[32:35], a[80:83], a[4:7], v[32:35]
ds_read_b64_tr_b16 a[108:109], v13 offset:8448
v_mfma_f32_16x16x32_bf16 v[40:43], a[80:83], a[8:11], 0
ds_read_b64_tr_b16 a[110:111], v13 offset:9472
v_mfma_f32_16x16x32_bf16 v[40:43], a[84:87], a[24:27], v[40:43]
s_add_u32 m0, s17, 0xc000
v_mfma_f32_16x16x32_bf16 v[48:51], a[84:87], a[28:31], 0
buffer_load_dwordx4 v5, s[60:63], 0 offen lds
v_mfma_f32_16x16x32_bf16 v[48:51], a[80:83], a[12:15], v[48:51]
v_mfma_f32_16x16x32_bf16 v[52:55], a[88:91], a[12:15], 0
ds_read_b64_tr_b16 a[80:81], v12 offset:512
v_mfma_f32_16x16x32_bf16 v[52:55], a[92:95], a[28:31], v[52:55]
ds_read_b64_tr_b16 a[82:83], v12 offset:1536
v_mfma_f32_16x16x32_bf16 v[44:47], a[92:95], a[24:27], 0
ds_read_b64_tr_b16 a[84:85], v12 offset:8704
s_add_u32 m0, s17, 0x8400
v_mfma_f32_16x16x32_bf16 v[44:47], a[88:91], a[8:11], v[44:47]
buffer_load_dwordx4 v5, s[56:59], s13 offen lds
v_mfma_f32_16x16x32_bf16 v[36:39], a[88:91], a[4:7], 0
ds_read_b64_tr_b16 a[86:87], v12 offset:9728
v_mfma_f32_16x16x32_bf16 v[36:39], a[92:95], a[20:23], v[36:39]
v_mfma_f32_16x16x32_bf16 v[28:31], a[92:95], a[16:19], 0
v_mfma_f32_16x16x32_bf16 v[28:31], a[88:91], a[0:3], v[28:31]
s_add_u32 m0, s17, 0xc400
v_mfma_f32_16x16x32_bf16 v[56:59], a[96:99], a[0:3], 0
buffer_load_dwordx4 v5, s[60:63], s13 offen lds
v_mfma_f32_16x16x32_bf16 v[56:59], a[100:103], a[16:19], v[56:59]
ds_read_b64_tr_b16 a[88:89], v13 offset:512
v_mfma_f32_16x16x32_bf16 v[64:67], a[100:103], a[20:23], 0
ds_read_b64_tr_b16 a[90:91], v13 offset:1536
v_mfma_f32_16x16x32_bf16 v[64:67], a[96:99], a[4:7], v[64:67]
ds_read_b64_tr_b16 a[92:93], v13 offset:8704
v_mfma_f32_16x16x32_bf16 v[72:75], a[96:99], a[8:11], 0
ds_read_b64_tr_b16 a[94:95], v13 offset:9728
s_add_u32 m0, s17, 0x8800
v_mfma_f32_16x16x32_bf16 v[72:75], a[100:103], a[24:27], v[72:75]
buffer_load_dwordx4 v6, s[56:59], 0 offen lds
v_mfma_f32_16x16x32_bf16 v[80:83], a[100:103], a[28:31], 0
v_mfma_f32_16x16x32_bf16 v[80:83], a[96:99], a[12:15], v[80:83]
s_waitcnt lgkmcnt(10)
v_mfma_f32_16x16x32_bf16 v[84:87], a[104:107], a[12:15], 0
ds_read_b64_tr_b16 a[96:97], v12 offset:768
s_waitcnt lgkmcnt(9)
v_mfma_f32_16x16x32_bf16 v[84:87], a[108:111], a[28:31], v[84:87]
ds_read_b64_tr_b16 a[98:99], v12 offset:1792
s_add_u32 m0, s17, 0xc800
v_mfma_f32_16x16x32_bf16 v[76:79], a[108:111], a[24:27], 0
buffer_load_dwordx4 v6, s[60:63], 0 offen lds
v_mfma_f32_16x16x32_bf16 v[76:79], a[104:107], a[8:11], v[76:79]
ds_read_b64_tr_b16 a[100:101], v12 offset:8960
v_mfma_f32_16x16x32_bf16 v[68:71], a[104:107], a[4:7], 0
ds_read_b64_tr_b16 a[102:103], v12 offset:9984
v_mfma_f32_16x16x32_bf16 v[68:71], a[108:111], a[20:23], v[68:71]
v_mfma_f32_16x16x32_bf16 v[60:63], a[108:111], a[16:19], 0
s_add_u32 m0, s17, 0x8c00
s_waitcnt lgkmcnt(4)
v_mfma_f32_16x16x32_bf16 v[60:63], a[104:107], a[0:3], v[60:63]
buffer_load_dwordx4 v6, s[56:59], s13 offen lds
v_mfma_f32_16x16x32_bf16 v[88:91], a[80:83], a[0:3], 0
ds_read_b64_tr_b16 a[104:105], v13 offset:768
v_mfma_f32_16x16x32_bf16 v[88:91], a[84:87], a[16:19], v[88:91]
ds_read_b64_tr_b16 a[106:107], v13 offset:1792
v_mfma_f32_16x16x32_bf16 v[96:99], a[84:87], a[20:23], 0
ds_read_b64_tr_b16 a[108:109], v13 offset:8960
v_mfma_f32_16x16x32_bf16 v[96:99], a[80:83], a[4:7], v[96:99]
ds_read_b64_tr_b16 a[110:111], v13 offset:9984
s_add_u32 m0, s17, 0xcc00
v_mfma_f32_16x16x32_bf16 v[104:107], a[80:83], a[8:11], 0
buffer_load_dwordx4 v6, s[60:63], s13 offen lds
v_mfma_f32_16x16x32_bf16 v[104:107], a[84:87], a[24:27], v[104:107]
v_lshl_add_u32 v5, s42, 19, v5
v_lshl_add_u32 v6, s42, 19, v6
v_mfma_f32_16x16x32_bf16 v[112:115], a[84:87], a[28:31], 0
v_mfma_f32_16x16x32_bf16 v[112:115], a[80:83], a[12:15], v[112:115]
v_mfma_f32_16x16x32_bf16 v[116:119], a[88:91], a[12:15], 0
ds_read_b64_tr_b16 a[80:81], v12 offset:16384
s_add_u32 m0, s16, 0x0
v_mfma_f32_16x16x32_bf16 v[116:119], a[92:95], a[28:31], v[116:119]
buffer_load_dwordx4 v2, s[48:51], 0 offen lds
v_mfma_f32_16x16x32_bf16 v[108:111], a[92:95], a[24:27], 0
ds_read_b64_tr_b16 a[82:83], v12 offset:17408
v_mfma_f32_16x16x32_bf16 v[108:111], a[88:91], a[8:11], v[108:111]
ds_read_b64_tr_b16 a[84:85], v12 offset:24576
v_mfma_f32_16x16x32_bf16 v[100:103], a[88:91], a[4:7], 0
ds_read_b64_tr_b16 a[86:87], v12 offset:25600
v_mfma_f32_16x16x32_bf16 v[100:103], a[92:95], a[20:23], v[100:103]
s_add_u32 m0, s16, 0x400
v_mfma_f32_16x16x32_bf16 v[92:95], a[92:95], a[16:19], 0
buffer_load_dwordx4 v3, s[48:51], 0 offen lds
v_mfma_f32_16x16x32_bf16 v[92:95], a[88:91], a[0:3], v[92:95]
s_waitcnt lgkmcnt(4)
v_mfma_f32_16x16x32_bf16 v[120:123], a[96:99], a[0:3], 0
ds_read_b64_tr_b16 a[88:89], v13 offset:16384
s_waitcnt vmcnt(11)
v_mfma_f32_16x16x32_bf16 v[120:123], a[100:103], a[16:19], v[120:123]
ds_read_b64_tr_b16 a[90:91], v13 offset:17408
v_mfma_f32_16x16x32_bf16 v[128:131], a[100:103], a[20:23], 0
ds_read_b64_tr_b16 a[92:93], v13 offset:24576
s_add_u32 m0, s16, 0x800
v_mfma_f32_16x16x32_bf16 v[128:131], a[96:99], a[4:7], v[128:131]
buffer_load_dwordx4 v2, s[48:51], s12 offen lds
v_mfma_f32_16x16x32_bf16 v[136:139], a[96:99], a[8:11], 0
ds_read_b64_tr_b16 a[94:95], v13 offset:25600
v_mfma_f32_16x16x32_bf16 v[136:139], a[100:103], a[24:27], v[136:139]
ds_read_b128 a[32:35], v8 offset:32768
v_mfma_f32_16x16x32_bf16 v[144:147], a[100:103], a[28:31], 0
ds_read_b128 a[48:51], v9 offset:32768
v_mfma_f32_16x16x32_bf16 v[144:147], a[96:99], a[12:15], v[144:147]
ds_read_b128 a[36:39], v8 offset:34816
s_add_u32 m0, s16, 0xc00
v_mfma_f32_16x16x32_bf16 v[148:151], a[104:107], a[12:15], 0
buffer_load_dwordx4 v3, s[48:51], s12 offen lds
v_mfma_f32_16x16x32_bf16 v[148:151], a[108:111], a[28:31], v[148:151]
ds_read_b64_tr_b16 a[96:97], v12 offset:16640
v_mfma_f32_16x16x32_bf16 v[140:143], a[108:111], a[24:27], 0
ds_read_b64_tr_b16 a[98:99], v12 offset:17664
v_mfma_f32_16x16x32_bf16 v[140:143], a[104:107], a[8:11], v[140:143]
ds_read_b64_tr_b16 a[100:101], v12 offset:24832
v_mfma_f32_16x16x32_bf16 v[132:135], a[104:107], a[4:7], 0
ds_read_b64_tr_b16 a[102:103], v12 offset:25856
s_add_u32 m0, s16, 0x1000
v_mfma_f32_16x16x32_bf16 v[132:135], a[108:111], a[20:23], v[132:135]
buffer_load_dwordx4 v2, s[48:51], s13 offen lds
v_mfma_f32_16x16x32_bf16 v[124:127], a[108:111], a[16:19], 0
ds_read_b128 a[52:55], v9 offset:34816
v_mfma_f32_16x16x32_bf16 v[124:127], a[104:107], a[0:3], v[124:127]
ds_read_b128 a[40:43], v8 offset:36864
s_waitcnt lgkmcnt(9)
v_mfma_f32_16x16x32_bf16 v[152:155], a[0:3], a[80:83], 0
ds_read_b64_tr_b16 a[104:105], v13 offset:16640
v_mfma_f32_16x16x32_bf16 v[152:155], a[16:19], a[84:87], v[152:155]
ds_read_b64_tr_b16 a[106:107], v13 offset:17664
s_add_u32 m0, s16, 0x1400
v_mfma_f32_16x16x32_bf16 v[156:159], a[20:23], a[84:87], 0
buffer_load_dwordx4 v3, s[48:51], s13 offen lds
v_mfma_f32_16x16x32_bf16 v[156:159], a[4:7], a[80:83], v[156:159]
ds_read_b64_tr_b16 a[108:109], v13 offset:24832
v_mfma_f32_16x16x32_bf16 v[160:163], a[8:11], a[80:83], 0
ds_read_b64_tr_b16 a[110:111], v13 offset:25856
v_mfma_f32_16x16x32_bf16 v[160:163], a[24:27], a[84:87], v[160:163]
ds_read_b128 a[56:59], v9 offset:36864
v_mfma_f32_16x16x32_bf16 v[164:167], a[28:31], a[84:87], 0
ds_read_b128 a[44:47], v8 offset:38912
s_add_u32 m0, s16, 0x1800
v_mfma_f32_16x16x32_bf16 v[164:167], a[12:15], a[80:83], v[164:167]
buffer_load_dwordx4 v2, s[48:51], s14 offen lds
v_mfma_f32_16x16x32_bf16 v[180:183], a[12:15], a[88:91], 0
ds_read_b64_tr_b16 a[80:81], v12 offset:16896
v_mfma_f32_16x16x32_bf16 v[180:183], a[28:31], a[92:95], v[180:183]
ds_read_b64_tr_b16 a[82:83], v12 offset:17920
v_mfma_f32_16x16x32_bf16 v[176:179], a[24:27], a[92:95], 0
ds_read_b64_tr_b16 a[84:85], v12 offset:25088
v_mfma_f32_16x16x32_bf16 v[176:179], a[8:11], a[88:91], v[176:179]
ds_read_b64_tr_b16 a[86:87], v12 offset:26112
s_add_u32 m0, s16, 0x1c00
v_mfma_f32_16x16x32_bf16 v[172:175], a[4:7], a[88:91], 0
buffer_load_dwordx4 v3, s[48:51], s14 offen lds
v_mfma_f32_16x16x32_bf16 v[172:175], a[20:23], a[92:95], v[172:175]
ds_read_b128 a[60:63], v9 offset:38912
v_lshl_add_u32 v2, s42, 7, v2
v_mfma_f32_16x16x32_bf16 v[168:171], a[16:19], a[92:95], 0
v_lshl_add_u32 v3, s42, 7, v3
v_mfma_f32_16x16x32_bf16 v[168:171], a[0:3], a[88:91], v[168:171]
s_waitcnt lgkmcnt(7)
v_mfma_f32_16x16x32_bf16 v[184:187], a[0:3], a[96:99], 0
ds_read_b64_tr_b16 a[88:89], v13 offset:16896
s_add_u32 m0, s17, 0x10000
v_mfma_f32_16x16x32_bf16 v[184:187], a[16:19], a[100:103], v[184:187]
buffer_load_dwordx4 v5, s[56:59], 0 offen lds
v_mfma_f32_16x16x32_bf16 v[188:191], a[20:23], a[100:103], 0
ds_read_b64_tr_b16 a[90:91], v13 offset:17920
v_mfma_f32_16x16x32_bf16 v[188:191], a[4:7], a[96:99], v[188:191]
ds_read_b64_tr_b16 a[92:93], v13 offset:25088
v_mfma_f32_16x16x32_bf16 v[192:195], a[8:11], a[96:99], 0
ds_read_b64_tr_b16 a[94:95], v13 offset:26112
v_mfma_f32_16x16x32_bf16 v[192:195], a[24:27], a[100:103], v[192:195]
s_add_u32 m0, s17, 0x14000
v_mfma_f32_16x16x32_bf16 v[196:199], a[28:31], a[100:103], 0
buffer_load_dwordx4 v5, s[60:63], 0 offen lds
v_mfma_f32_16x16x32_bf16 v[196:199], a[12:15], a[96:99], v[196:199]
v_mfma_f32_16x16x32_bf16 v[212:215], a[12:15], a[104:107], 0
ds_read_b64_tr_b16 a[96:97], v12 offset:17152
v_mfma_f32_16x16x32_bf16 v[212:215], a[28:31], a[108:111], v[212:215]
ds_read_b64_tr_b16 a[98:99], v12 offset:18176
v_mfma_f32_16x16x32_bf16 v[208:211], a[24:27], a[108:111], 0
ds_read_b64_tr_b16 a[100:101], v12 offset:25344
s_add_u32 m0, s17, 0x10400
v_mfma_f32_16x16x32_bf16 v[208:211], a[8:11], a[104:107], v[208:211]
buffer_load_dwordx4 v5, s[56:59], s13 offen lds
v_mfma_f32_16x16x32_bf16 v[204:207], a[4:7], a[104:107], 0
ds_read_b64_tr_b16 a[102:103], v12 offset:26368
v_mfma_f32_16x16x32_bf16 v[204:207], a[20:23], a[108:111], v[204:207]
v_mfma_f32_16x16x32_bf16 v[200:203], a[16:19], a[108:111], 0
v_mfma_f32_16x16x32_bf16 v[200:203], a[0:3], a[104:107], v[200:203]
s_add_u32 m0, s17, 0x14400
s_waitcnt lgkmcnt(4)
v_mfma_f32_16x16x32_bf16 v[216:219], a[0:3], a[80:83], 0
buffer_load_dwordx4 v5, s[60:63], s13 offen lds
v_mfma_f32_16x16x32_bf16 v[216:219], a[16:19], a[84:87], v[216:219]
ds_read_b64_tr_b16 a[104:105], v13 offset:17152
v_mfma_f32_16x16x32_bf16 v[220:223], a[20:23], a[84:87], 0
ds_read_b64_tr_b16 a[106:107], v13 offset:18176
v_mfma_f32_16x16x32_bf16 v[220:223], a[4:7], a[80:83], v[220:223]
ds_read_b64_tr_b16 a[108:109], v13 offset:25344
v_mfma_f32_16x16x32_bf16 v[224:227], a[8:11], a[80:83], 0
ds_read_b64_tr_b16 a[110:111], v13 offset:26368
s_add_u32 m0, s17, 0x10800
v_mfma_f32_16x16x32_bf16 v[224:227], a[24:27], a[84:87], v[224:227]
buffer_load_dwordx4 v6, s[56:59], 0 offen lds
v_mfma_f32_16x16x32_bf16 v[228:231], a[28:31], a[84:87], 0
v_add_u32 v12, 0x8000, v12
v_add_u32 v13, 0x8000, v13
v_mfma_f32_16x16x32_bf16 v[228:231], a[12:15], a[80:83], v[228:231]
v_mfma_f32_16x16x32_bf16 v[244:247], a[12:15], a[88:91], 0
s_waitcnt vmcnt(13) lgkmcnt(0)
v_mfma_f32_16x16x32_bf16 v[244:247], a[28:31], a[92:95], v[244:247]
s_barrier
s_add_u32 m0, s17, 0x14800
v_mfma_f32_16x16x32_bf16 v[240:243], a[24:27], a[92:95], 0
buffer_load_dwordx4 v6, s[60:63], 0 offen lds
v_mfma_f32_16x16x32_bf16 v[240:243], a[8:11], a[88:91], v[240:243]
ds_read_b64_tr_b16 a[80:81], v12 offset:0
v_mfma_f32_16x16x32_bf16 v[236:239], a[4:7], a[88:91], 0
ds_read_b64_tr_b16 a[82:83], v12 offset:1024
v_mfma_f32_16x16x32_bf16 v[236:239], a[20:23], a[92:95], v[236:239]
ds_read_b64_tr_b16 a[84:85], v12 offset:8192
s_waitcnt lgkmcnt(3)
v_mfma_f32_16x16x32_bf16 v[232:235], a[16:19], a[92:95], 0
ds_read_b64_tr_b16 a[86:87], v12 offset:9216
s_add_u32 m0, s17, 0x10c00
v_mfma_f32_16x16x32_bf16 v[232:235], a[0:3], a[88:91], v[232:235]
buffer_load_dwordx4 v6, s[56:59], s13 offen lds
v_mfma_f32_16x16x32_bf16 v[248:251], a[0:3], a[96:99], 0
ds_read_b64_tr_b16 a[88:89], v13 offset:0
v_mfma_f32_16x16x32_bf16 v[248:251], a[16:19], a[100:103], v[248:251]
ds_read_b64_tr_b16 a[90:91], v13 offset:1024
v_mfma_f32_16x16x32_bf16 v[252:255], a[20:23], a[100:103], 0
ds_read_b64_tr_b16 a[92:93], v13 offset:8192
v_mfma_f32_16x16x32_bf16 v[252:255], a[4:7], a[96:99], v[252:255]
ds_read_b64_tr_b16 a[94:95], v13 offset:9216
s_add_u32 m0, s17, 0x14c00
v_mfma_f32_16x16x32_bf16 a[232:235], a[8:11], a[96:99], 0
buffer_load_dwordx4 v6, s[60:63], s13 offen lds
v_mfma_f32_16x16x32_bf16 a[232:235], a[24:27], a[100:103], a[232:235]
v_lshl_add_u32 v5, s42, 19, v5
v_lshl_add_u32 v6, s42, 19, v6
v_mfma_f32_16x16x32_bf16 a[236:239], a[28:31], a[100:103], 0
v_mfma_f32_16x16x32_bf16 a[236:239], a[12:15], a[96:99], a[236:239]
s_waitcnt lgkmcnt(15)
v_mfma_f32_16x16x32_bf16 a[252:255], a[12:15], a[104:107], 0
ds_read_b64_tr_b16 a[96:97], v12 offset:256
s_add_u32 m0, s16, 0x8000
v_mfma_f32_16x16x32_bf16 a[252:255], a[28:31], a[108:111], a[252:255]
buffer_load_dwordx4 v2, s[48:51], 0 offen lds
v_mfma_f32_16x16x32_bf16 a[248:251], a[24:27], a[108:111], 0
ds_read_b64_tr_b16 a[98:99], v12 offset:1280
v_mfma_f32_16x16x32_bf16 a[248:251], a[8:11], a[104:107], a[248:251]
ds_read_b64_tr_b16 a[100:101], v12 offset:8448
v_mfma_f32_16x16x32_bf16 a[244:247], a[4:7], a[104:107], 0
ds_read_b64_tr_b16 a[102:103], v12 offset:9472
v_mfma_f32_16x16x32_bf16 a[244:247], a[20:23], a[108:111], a[244:247]
s_add_u32 m0, s16, 0x8400
v_mfma_f32_16x16x32_bf16 a[240:243], a[16:19], a[108:111], 0
buffer_load_dwordx4 v3, s[48:51], 0 offen lds
v_mfma_f32_16x16x32_bf16 a[240:243], a[0:3], a[104:107], a[240:243]
s_waitcnt lgkmcnt(4)
L_S1:
v_mfma_f32_16x16x32_bf16 v[24:27], a[80:83], a[32:35], v[24:27]
ds_read_b64_tr_b16 a[104:105], v13 offset:256
v_mfma_f32_16x16x32_bf16 v[24:27], a[84:87], a[48:51], v[24:27]
ds_read_b64_tr_b16 a[106:107], v13 offset:1280
v_mfma_f32_16x16x32_bf16 v[32:35], a[84:87], a[52:55], v[32:35]
ds_read_b64_tr_b16 a[108:109], v13 offset:8448
s_add_u32 m0, s16, 0x8800
v_mfma_f32_16x16x32_bf16 v[32:35], a[80:83], a[36:39], v[32:35]
buffer_load_dwordx4 v2, s[48:51], s12 offen lds
v_mfma_f32_16x16x32_bf16 v[40:43], a[80:83], a[40:43], v[40:43]
ds_read_b64_tr_b16 a[110:111], v13 offset:9472
v_mfma_f32_16x16x32_bf16 v[40:43], a[84:87], a[56:59], v[40:43]
v_mfma_f32_16x16x32_bf16 v[48:51], a[84:87], a[60:63], v[48:51]
v_mfma_f32_16x16x32_bf16 v[48:51], a[80:83], a[44:47], v[48:51]
s_add_u32 m0, s16, 0x8c00
v_mfma_f32_16x16x32_bf16 v[52:55], a[88:91], a[44:47], v[52:55]
buffer_load_dwordx4 v3, s[48:51], s12 offen lds
v_mfma_f32_16x16x32_bf16 v[52:55], a[92:95], a[60:63], v[52:55]
ds_read_b64_tr_b16 a[80:81], v12 offset:512
v_mfma_f32_16x16x32_bf16 v[44:47], a[92:95], a[56:59], v[44:47]
ds_read_b64_tr_b16 a[82:83], v12 offset:1536
v_mfma_f32_16x16x32_bf16 v[44:47], a[88:91], a[40:43], v[44:47]
ds_read_b64_tr_b16 a[84:85], v12 offset:8704
v_mfma_f32_16x16x32_bf16 v[36:39], a[88:91], a[36:39], v[36:39]
ds_read_b64_tr_b16 a[86:87], v12 offset:9728
s_add_u32 m0, s16, 0x9000
v_mfma_f32_16x16x32_bf16 v[36:39], a[92:95], a[52:55], v[36:39]
buffer_load_dwordx4 v2, s[48:51], s13 offen lds
v_mfma_f32_16x16x32_bf16 v[28:31], a[92:95], a[48:51], v[28:31]
v_mfma_f32_16x16x32_bf16 v[28:31], a[88:91], a[32:35], v[28:31]
s_waitcnt lgkmcnt(4)
v_mfma_f32_16x16x32_bf16 v[56:59], a[96:99], a[32:35], v[56:59]
ds_read_b64_tr_b16 a[88:89], v13 offset:512
v_mfma_f32_16x16x32_bf16 v[56:59], a[100:103], a[48:51], v[56:59]
ds_read_b64_tr_b16 a[90:91], v13 offset:1536
s_add_u32 m0, s16, 0x9400
v_mfma_f32_16x16x32_bf16 v[64:67], a[100:103], a[52:55], v[64:67]
buffer_load_dwordx4 v3, s[48:51], s13 offen lds
v_mfma_f32_16x16x32_bf16 v[64:67], a[96:99], a[36:39], v[64:67]
ds_read_b64_tr_b16 a[92:93], v13 offset:8704
v_mfma_f32_16x16x32_bf16 v[72:75], a[96:99], a[40:43], v[72:75]
ds_read_b64_tr_b16 a[94:95], v13 offset:9728
v_mfma_f32_16x16x32_bf16 v[72:75], a[100:103], a[56:59], v[72:75]
v_mfma_f32_16x16x32_bf16 v[80:83], a[100:103], a[60:63], v[80:83]
s_add_u32 m0, s16, 0x9800
v_mfma_f32_16x16x32_bf16 v[80:83], a[96:99], a[44:47], v[80:83]
buffer_load_dwordx4 v2, s[48:51], s14 offen lds
v_mfma_f32_16x16x32_bf16 v[84:87], a[104:107], a[44:47], v[84:87]
ds_read_b64_tr_b16 a[96:97], v12 offset:768
v_mfma_f32_16x16x32_bf16 v[84:87], a[108:111], a[60:63], v[84:87]
ds_read_b64_tr_b16 a[98:99], v12 offset:1792
v_mfma_f32_16x16x32_bf16 v[76:79], a[108:111], a[56:59], v[76:79]
ds_read_b64_tr_b16 a[100:101], v12 offset:8960
v_mfma_f32_16x16x32_bf16 v[76:79], a[104:107], a[40:43], v[76:79]
ds_read_b64_tr_b16 a[102:103], v12 offset:9984
s_add_u32 m0, s16, 0x9c00
v_mfma_f32_16x16x32_bf16 v[68:71], a[104:107], a[36:39], v[68:71]
buffer_load_dwordx4 v3, s[48:51], s14 offen lds
v_mfma_f32_16x16x32_bf16 v[68:71], a[108:111], a[52:55], v[68:71]
v_lshl_add_u32 v2, s42, 7, v2
v_lshl_add_u32 v3, s42, 7, v3
v_mfma_f32_16x16x32_bf16 v[60:63], a[108:111], a[48:51], v[60:63]
v_mfma_f32_16x16x32_bf16 v[60:63], a[104:107], a[32:35], v[60:63]
s_add_u32 m0, s17, 0x0
s_waitcnt lgkmcnt(4)
v_mfma_f32_16x16x32_bf16 v[88:91], a[80:83], a[32:35], v[88:91]
ds_read_b64_tr_b16 a[104:105], v13 offset:768
s_waitcnt vmcnt(16)
v_mfma_f32_16x16x32_bf16 v[88:91], a[84:87], a[48:51], v[88:91]
buffer_load_dwordx4 v5, s[56:59], 0 offen lds
v_mfma_f32_16x16x32_bf16 v[96:99], a[84:87], a[52:55], v[96:99]
ds_read_b64_tr_b16 a[106:107], v13 offset:1792
v_mfma_f32_16x16x32_bf16 v[96:99], a[80:83], a[36:39], v[96:99]
ds_read_b64_tr_b16 a[108:109], v13 offset:8960
v_mfma_f32_16x16x32_bf16 v[104:107], a[80:83], a[40:43], v[104:107]
ds_read_b64_tr_b16 a[110:111], v13 offset:9984
v_mfma_f32_16x16x32_bf16 v[104:107], a[84:87], a[56:59], v[104:107]
ds_read_b128 a[0:3], v8 offset:0
s_add_u32 m0, s17, 0x4000
v_mfma_f32_16x16x32_bf16 v[112:115], a[84:87], a[60:63], v[112:115]
buffer_load_dwordx4 v5, s[60:63], 0 offen lds
v_mfma_f32_16x16x32_bf16 v[112:115], a[80:83], a[44:47], v[112:115]
ds_read_b128 a[16:19], v9 offset:0
v_mfma_f32_16x16x32_bf16 v[116:119], a[88:91], a[44:47], v[116:119]
ds_read_b64_tr_b16 a[80:81], v12 offset:16384
v_mfma_f32_16x16x32_bf16 v[116:119], a[92:95], a[60:63], v[116:119]
ds_read_b64_tr_b16 a[82:83], v12 offset:17408
v_mfma_f32_16x16x32_bf16 v[108:111], a[92:95], a[56:59], v[108:111]
ds_read_b64_tr_b16 a[84:85], v12 offset:24576
s_add_u32 m0, s17, 0x400
v_mfma_f32_16x16x32_bf16 v[108:111], a[88:91], a[40:43], v[108:111]
buffer_load_dwordx4 v5, s[56:59], s13 offen lds
v_mfma_f32_16x16x32_bf16 v[100:103], a[88:91], a[36:39], v[100:103]
ds_read_b64_tr_b16 a[86:87], v12 offset:25600
v_mfma_f32_16x16x32_bf16 v[100:103], a[92:95], a[52:55], v[100:103]
ds_read_b128 a[4:7], v8 offset:2048
v_mfma_f32_16x16x32_bf16 v[92:95], a[92:95], a[48:51], v[92:95]
ds_read_b128 a[20:23], v9 offset:2048
s_waitcnt lgkmcnt(8)
v_mfma_f32_16x16x32_bf16 v[92:95], a[88:91], a[32:35], v[92:95]
ds_read_b128 a[8:11], v8 offset:4096
s_add_u32 m0, s17, 0x4400
v_mfma_f32_16x16x32_bf16 v[120:123], a[96:99], a[32:35], v[120:123]
buffer_load_dwordx4 v5, s[60:63], s13 offen lds
v_mfma_f32_16x16x32_bf16 v[120:123], a[100:103], a[48:51], v[120:123]
ds_read_b64_tr_b16 a[88:89], v13 offset:16384
v_mfma_f32_16x16x32_bf16 v[128:131], a[100:103], a[52:55], v[128:131]
ds_read_b64_tr_b16 a[90:91], v13 offset:17408
v_mfma_f32_16x16x32_bf16 v[128:131], a[96:99], a[36:39], v[128:131]
ds_read_b64_tr_b16 a[92:93], v13 offset:24576
v_mfma_f32_16x16x32_bf16 v[136:139], a[96:99], a[40:43], v[136:139]
ds_read_b64_tr_b16 a[94:95], v13 offset:25600
s_add_u32 m0, s17, 0x800
v_mfma_f32_16x16x32_bf16 v[136:139], a[100:103], a[56:59], v[136:139]
buffer_load_dwordx4 v6, s[56:59], 0 offen lds
v_mfma_f32_16x16x32_bf16 v[144:147], a[100:103], a[60:63], v[144:147]
ds_read_b128 a[24:27], v9 offset:4096
v_mfma_f32_16x16x32_bf16 v[144:147], a[96:99], a[44:47], v[144:147]
ds_read_b128 a[12:15], v8 offset:6144
v_mfma_f32_16x16x32_bf16 v[148:151], a[104:107], a[44:47], v[148:151]
ds_read_b64_tr_b16 a[96:97], v12 offset:16640
v_mfma_f32_16x16x32_bf16 v[148:151], a[108:111], a[60:63], v[148:151]
ds_read_b64_tr_b16 a[98:99], v12 offset:17664
s_add_u32 m0, s17, 0x4800
v_mfma_f32_16x16x32_bf16 v[140:143], a[108:111], a[56:59], v[140:143]
buffer_load_dwordx4 v6, s[60:63], 0 offen lds
v_mfma_f32_16x16x32_bf16 v[140:143], a[104:107], a[40:43], v[140:143]
ds_read_b64_tr_b16 a[100:101], v12 offset:24832
v_mfma_f32_16x16x32_bf16 v[132:135], a[104:107], a[36:39], v[132:135]
ds_read_b64_tr_b16 a[102:103], v12 offset:25856
v_mfma_f32_16x16x32_bf16 v[132:135], a[108:111], a[52:55], v[132:135]
ds_read_b128 a[28:31], v9 offset:6144
v_mfma_f32_16x16x32_bf16 v[124:127], a[108:111], a[48:51], v[124:127]
s_add_u32 m0, s17, 0xc00
s_waitcnt lgkmcnt(7)
v_mfma_f32_16x16x32_bf16 v[124:127], a[104:107], a[32:35], v[124:127]
buffer_load_dwordx4 v6, s[56:59], s13 offen lds
v_mfma_f32_16x16x32_bf16 v[152:155], a[32:35], a[80:83], v[152:155]
ds_read_b64_tr_b16 a[104:105], v13 offset:16640
v_mfma_f32_16x16x32_bf16 v[152:155], a[48:51], a[84:87], v[152:155]
ds_read_b64_tr_b16 a[106:107], v13 offset:17664
v_mfma_f32_16x16x32_bf16 v[156:159], a[52:55], a[84:87], v[156:159]
ds_read_b64_tr_b16 a[108:109], v13 offset:24832
v_mfma_f32_16x16x32_bf16 v[156:159], a[36:39], a[80:83], v[156:159]
ds_read_b64_tr_b16 a[110:111], v13 offset:25856
s_add_u32 m0, s17, 0x4c00
v_mfma_f32_16x16x32_bf16 v[160:163], a[40:43], a[80:83], v[160:163]
buffer_load_dwordx4 v6, s[60:63], s13 offen lds
v_mfma_f32_16x16x32_bf16 v[160:163], a[56:59], a[84:87], v[160:163]
v_lshl_add_u32 v5, s42, 19, v5
v_lshl_add_u32 v6, s42, 19, v6
v_mfma_f32_16x16x32_bf16 v[164:167], a[60:63], a[84:87], v[164:167]
v_mfma_f32_16x16x32_bf16 v[164:167], a[44:47], a[80:83], v[164:167]
v_mfma_f32_16x16x32_bf16 v[180:183], a[44:47], a[88:91], v[180:183]
ds_read_b64_tr_b16 a[80:81], v12 offset:16896
s_mov_b32 s9, 0x200000
v_mfma_f32_16x16x32_bf16 v[180:183], a[60:63], a[92:95], v[180:183]
buffer_load_dword a120, v18, s[56:59], s9 offen
v_mfma_f32_16x16x32_bf16 v[176:179], a[56:59], a[92:95], v[176:179]
ds_read_b64_tr_b16 a[82:83], v12 offset:17920
v_mfma_f32_16x16x32_bf16 v[176:179], a[40:43], a[88:91], v[176:179]
ds_read_b64_tr_b16 a[84:85], v12 offset:25088
v_mfma_f32_16x16x32_bf16 v[172:175], a[36:39], a[88:91], v[172:175]
ds_read_b64_tr_b16 a[86:87], v12 offset:26112
v_mfma_f32_16x16x32_bf16 v[172:175], a[52:55], a[92:95], v[172:175]
s_add_u32 m0, s16, 0x0
s_waitcnt lgkmcnt(8)
v_mfma_f32_16x16x32_bf16 v[168:171], a[48:51], a[92:95], v[168:171]
buffer_load_dwordx4 v2, s[48:51], 0 offen lds
v_mfma_f32_16x16x32_bf16 v[168:171], a[32:35], a[88:91], v[168:171]
s_waitcnt lgkmcnt(4)
v_mfma_f32_16x16x32_bf16 v[184:187], a[32:35], a[96:99], v[184:187]
ds_read_b64_tr_b16 a[88:89], v13 offset:16896
v_mfma_f32_16x16x32_bf16 v[184:187], a[48:51], a[100:103], v[184:187]
ds_read_b64_tr_b16 a[90:91], v13 offset:17920
v_mfma_f32_16x16x32_bf16 v[188:191], a[52:55], a[100:103], v[188:191]
ds_read_b64_tr_b16 a[92:93], v13 offset:25088
s_add_u32 m0, s16, 0x400
v_mfma_f32_16x16x32_bf16 v[188:191], a[36:39], a[96:99], v[188:191]
buffer_load_dwordx4 v3, s[48:51], 0 offen lds
v_mfma_f32_16x16x32_bf16 v[192:195], a[40:43], a[96:99], v[192:195]
ds_read_b64_tr_b16 a[94:95], v13 offset:26112
v_mfma_f32_16x16x32_bf16 v[192:195], a[56:59], a[100:103], v[192:195]
v_mfma_f32_16x16x32_bf16 v[196:199], a[60:63], a[100:103], v[196:199]
v_mfma_f32_16x16x32_bf16 v[196:199], a[44:47], a[96:99], v[196:199]
s_add_u32 m0, s16, 0x800
v_mfma_f32_16x16x32_bf16 v[212:215], a[44:47], a[104:107], v[212:215]
buffer_load_dwordx4 v2, s[48:51], s12 offen lds
v_mfma_f32_16x16x32_bf16 v[212:215], a[60:63], a[108:111], v[212:215]
ds_read_b64_tr_b16 a[96:97], v12 offset:17152
v_mfma_f32_16x16x32_bf16 v[208:211], a[56:59], a[108:111], v[208:211]
ds_read_b64_tr_b16 a[98:99], v12 offset:18176
v_mfma_f32_16x16x32_bf16 v[208:211], a[40:43], a[104:107], v[208:211]
ds_read_b64_tr_b16 a[100:101], v12 offset:25344
v_mfma_f32_16x16x32_bf16 v[204:207], a[36:39], a[104:107], v[204:207]
ds_read_b64_tr_b16 a[102:103], v12 offset:26368
s_add_u32 m0, s16, 0xc00
v_mfma_f32_16x16x32_bf16 v[204:207], a[52:55], a[108:111], v[204:207]
buffer_load_dwordx4 v3, s[48:51], s12 offen lds
v_mfma_f32_16x16x32_bf16 v[200:203], a[48:51], a[108:111], v[200:203]
v_mfma_f32_16x16x32_bf16 v[200:203], a[32:35], a[104:107], v[200:203]
s_waitcnt lgkmcnt(4)
v_mfma_f32_16x16x32_bf16 v[216:219], a[32:35], a[80:83], v[216:219]
ds_read_b64_tr_b16 a[104:105], v13 offset:17152
v_mfma_f32_16x16x32_bf16 v[216:219], a[48:51], a[84:87], v[216:219]
ds_read_b64_tr_b16 a[106:107], v13 offset:18176
s_add_u32 m0, s16, 0x1000
v_mfma_f32_16x16x32_bf16 v[220:223], a[52:55], a[84:87], v[220:223]
buffer_load_dwordx4 v2, s[48:51], s13 offen lds
v_mfma_f32_16x16x32_bf16 v[220:223], a[36:39], a[80:83], v[220:223]
ds_read_b64_tr_b16 a[108:109], v13 offset:25344
v_mfma_f32_16x16x32_bf16 v[224:227], a[40:43], a[80:83], v[224:227]
ds_read_b64_tr_b16 a[110:111], v13 offset:26368
v_add_u32 v12, 0x8000, v12
v_mfma_f32_16x16x32_bf16 v[224:227], a[56:59], a[84:87], v[224:227]
v_add_u32 v13, 0x8000, v13
v_mfma_f32_16x16x32_bf16 v[228:231], a[60:63], a[84:87], v[228:231]
s_add_u32 m0, s16, 0x1400
v_mfma_f32_16x16x32_bf16 v[228:231], a[44:47], a[80:83], v[228:231]
buffer_load_dwordx4 v3, s[48:51], s13 offen lds
v_mfma_f32_16x16x32_bf16 v[244:247], a[44:47], a[88:91], v[244:247]
s_waitcnt vmcnt(23) lgkmcnt(0)
v_mfma_f32_16x16x32_bf16 v[244:247], a[60:63], a[92:95], v[244:247]
s_barrier
v_mfma_f32_16x16x32_bf16 v[240:243], a[56:59], a[92:95], v[240:243]
ds_read_b64_tr_b16 a[80:81], v12 offset:0
v_mfma_f32_16x16x32_bf16 v[240:243], a[40:43], a[88:91], v[240:243]
ds_read_b64_tr_b16 a[82:83], v12 offset:1024
s_add_u32 m0, s16, 0x1800
v_mfma_f32_16x16x32_bf16 v[236:239], a[36:39], a[88:91], v[236:239]
buffer_load_dwordx4 v2, s[48:51], s14 offen lds
v_mfma_f32_16x16x32_bf16 v[236:239], a[52:55], a[92:95], v[236:239]
ds_read_b64_tr_b16 a[84:85], v12 offset:8192
v_mfma_f32_16x16x32_bf16 v[232:235], a[48:51], a[92:95], v[232:235]
ds_read_b64_tr_b16 a[86:87], v12 offset:9216
v_mfma_f32_16x16x32_bf16 v[232:235], a[32:35], a[88:91], v[232:235]
L_padA1:
s_cmp_eq_u32 s95, 1
s_cbranch_scc1 L_padA5
s_waitcnt lgkmcnt(4)
v_mfma_f32_16x16x32_bf16 v[248:251], a[32:35], a[96:99], v[248:251]
ds_read_b64_tr_b16 a[88:89], v13 offset:0
s_add_u32 m0, s16, 0x1c00
v_mfma_f32_16x16x32_bf16 v[248:251], a[48:51], a[100:103], v[248:251]
buffer_load_dwordx4 v3, s[48:51], s14 offen lds
v_mfma_f32_16x16x32_bf16 v[252:255], a[52:55], a[100:103], v[252:255]
ds_read_b64_tr_b16 a[90:91], v13 offset:1024
v_lshl_add_u32 v2, s42, 7, v2
v_mfma_f32_16x16x32_bf16 v[252:255], a[36:39], a[96:99], v[252:255]
ds_read_b64_tr_b16 a[92:93], v13 offset:8192
v_lshl_add_u32 v3, s42, 7, v3
v_mfma_f32_16x16x32_bf16 a[232:235], a[40:43], a[96:99], a[232:235]
ds_read_b64_tr_b16 a[94:95], v13 offset:9216
v_mfma_f32_16x16x32_bf16 a[232:235], a[56:59], a[100:103], a[232:235]
s_mov_b32 s9, 0x200000
v_mfma_f32_16x16x32_bf16 a[236:239], a[60:63], a[100:103], a[236:239]
buffer_load_dword a120, v18, s[60:63], s9 offen
v_mfma_f32_16x16x32_bf16 a[236:239], a[44:47], a[96:99], a[236:239]
v_mfma_f32_16x16x32_bf16 a[252:255], a[44:47], a[104:107], a[252:255]
ds_read_b64_tr_b16 a[96:97], v12 offset:256
v_mfma_f32_16x16x32_bf16 a[252:255], a[60:63], a[108:111], a[252:255]
ds_read_b64_tr_b16 a[98:99], v12 offset:1280
v_mfma_f32_16x16x32_bf16 a[248:251], a[56:59], a[108:111], a[248:251]
ds_read_b64_tr_b16 a[100:101], v12 offset:8448
s_add_u32 m0, s17, 0x8000
v_mfma_f32_16x16x32_bf16 a[248:251], a[40:43], a[104:107], a[248:251]
buffer_load_dwordx4 v5, s[56:59], 0 offen lds
v_mfma_f32_16x16x32_bf16 a[244:247], a[36:39], a[104:107], a[244:247]
ds_read_b64_tr_b16 a[102:103], v12 offset:9472
v_mfma_f32_16x16x32_bf16 a[244:247], a[52:55], a[108:111], a[244:247]
v_mfma_f32_16x16x32_bf16 a[240:243], a[48:51], a[108:111], a[240:243]
v_mfma_f32_16x16x32_bf16 a[240:243], a[32:35], a[104:107], a[240:243]
s_add_u32 m0, s17, 0xc000
s_waitcnt lgkmcnt(4)
L_S2:
v_mfma_f32_16x16x32_bf16 v[24:27], a[80:83], a[0:3], v[24:27]
buffer_load_dwordx4 v5, s[60:63], 0 offen lds
v_mfma_f32_16x16x32_bf16 v[24:27], a[84:87], a[16:19], v[24:27]
ds_read_b64_tr_b16 a[104:105], v13 offset:256
s_waitcnt vmcnt(20)
v_mfma_f32_16x16x32_bf16 v[32:35], a[84:87], a[20:23], v[32:35]
ds_read_b64_tr_b16 a[106:107], v13 offset:1280
v_mfma_f32_16x16x32_bf16 v[32:35], a[80:83], a[4:7], v[32:35]
ds_read_b64_tr_b16 a[108:109], v13 offset:8448
v_mfma_f32_16x16x32_bf16 v[40:43], a[80:83], a[8:11], v[40:43]
ds_read_b64_tr_b16 a[110:111], v13 offset:9472
s_add_u32 m0, s17, 0x8400
v_mfma_f32_16x16x32_bf16 v[40:43], a[84:87], a[24:27], v[40:43]
buffer_load_dwordx4 v5, s[56:59], s13 offen lds
v_mfma_f32_16x16x32_bf16 v[48:51], a[84:87], a[28:31], v[48:51]
ds_read_b128 a[32:35], v8 offset:32768
v_mfma_f32_16x16x32_bf16 v[48:51], a[80:83], a[12:15], v[48:51]
ds_read_b128 a[48:51], v9 offset:32768
v_mfma_f32_16x16x32_bf16 v[52:55], a[88:91], a[12:15], v[52:55]
ds_read_b64_tr_b16 a[80:81], v12 offset:512
v_mfma_f32_16x16x32_bf16 v[52:55], a[92:95], a[28:31], v[52:55]
ds_read_b64_tr_b16 a[82:83], v12 offset:1536
s_add_u32 m0, s17, 0xc400
v_mfma_f32_16x16x32_bf16 v[44:47], a[92:95], a[24:27], v[44:47]
buffer_load_dwordx4 v5, s[60:63], s13 offen lds
v_mfma_f32_16x16x32_bf16 v[44:47], a[88:91], a[8:11], v[44:47]
ds_read_b64_tr_b16 a[84:85], v12 offset:8704
v_mfma_f32_16x16x32_bf16 v[36:39], a[88:91], a[4:7], v[36:39]
ds_read_b64_tr_b16 a[86:87], v12 offset:9728
v_mfma_f32_16x16x32_bf16 v[36:39], a[92:95], a[20:23], v[36:39]
ds_read_b128 a[36:39], v8 offset:34816
s_waitcnt lgkmcnt(7)
v_mfma_f32_16x16x32_bf16 v[28:31], a[92:95], a[16:19], v[28:31]
ds_read_b128 a[52:55], v9 offset:34816
s_add_u32 m0, s17, 0x8800
v_mfma_f32_16x16x32_bf16 v[28:31], a[88:91], a[0:3], v[28:31]
buffer_load_dwordx4 v6, s[56:59], 0 offen lds
v_mfma_f32_16x16x32_bf16 v[56:59], a[96:99], a[0:3], v[56:59]
ds_read_b64_tr_b16 a[88:89], v13 offset:512
v_mfma_f32_16x16x32_bf16 v[56:59], a[100:103], a[16:19], v[56:59]
ds_read_b64_tr_b16 a[90:91], v13 offset:1536
v_mfma_f32_16x16x32_bf16 v[64:67], a[100:103], a[20:23], v[64:67]
ds_read_b64_tr_b16 a[92:93], v13 offset:8704
v_mfma_f32_16x16x32_bf16 v[64:67], a[96:99], a[4:7], v[64:67]
ds_read_b64_tr_b16 a[94:95], v13 offset:9728
s_add_u32 m0, s17, 0xc800
v_mfma_f32_16x16x32_bf16 v[72:75], a[96:99], a[8:11], v[72:75]
buffer_load_dwordx4 v6, s[60:63], 0 offen lds
v_mfma_f32_16x16x32_bf16 v[72:75], a[100:103], a[24:27], v[72:75]
ds_read_b128 a[40:43], v8 offset:36864
v_mfma_f32_16x16x32_bf16 v[80:83], a[100:103], a[28:31], v[80:83]
ds_read_b128 a[56:59], v9 offset:36864
v_mfma_f32_16x16x32_bf16 v[80:83], a[96:99], a[12:15], v[80:83]
ds_read_b128 a[44:47], v8 offset:38912
v_mfma_f32_16x16x32_bf16 v[84:87], a[104:107], a[12:15], v[84:87]
ds_read_b64_tr_b16 a[96:97], v12 offset:768
s_add_u32 m0, s17, 0x8c00
v_mfma_f32_16x16x32_bf16 v[84:87], a[108:111], a[28:31], v[84:87]
buffer_load_dwordx4 v6, s[56:59], s13 offen lds
v_mfma_f32_16x16x32_bf16 v[76:79], a[108:111], a[24:27], v[76:79]
ds_read_b64_tr_b16 a[98:99], v12 offset:1792
v_mfma_f32_16x16x32_bf16 v[76:79], a[104:107], a[8:11], v[76:79]
ds_read_b64_tr_b16 a[100:101], v12 offset:8960
v_mfma_f32_16x16x32_bf16 v[68:71], a[104:107], a[4:7], v[68:71]
ds_read_b64_tr_b16 a[102:103], v12 offset:9984
v_mfma_f32_16x16x32_bf16 v[68:71], a[108:111], a[20:23], v[68:71]
ds_read_b128 a[60:63], v9 offset:38912
s_add_u32 m0, s17, 0xcc00
v_mfma_f32_16x16x32_bf16 v[60:63], a[108:111], a[16:19], v[60:63]
buffer_load_dwordx4 v6, s[60:63], s13 offen lds
v_mfma_f32_16x16x32_bf16 v[60:63], a[104:107], a[0:3], v[60:63]
s_waitcnt lgkmcnt(8)
v_lshl_add_u32 v5, s42, 19, v5
v_lshl_add_u32 v6, s42, 19, v6
v_mfma_f32_16x16x32_bf16 v[88:91], a[80:83], a[0:3], v[88:91]
ds_read_b64_tr_b16 a[104:105], v13 offset:768
v_mfma_f32_16x16x32_bf16 v[88:91], a[84:87], a[16:19], v[88:91]
ds_read_b64_tr_b16 a[106:107], v13 offset:1792
v_mfma_f32_16x16x32_bf16 v[96:99], a[84:87], a[20:23], v[96:99]
ds_read_b64_tr_b16 a[108:109], v13 offset:8960
v_mfma_f32_16x16x32_bf16 v[96:99], a[80:83], a[4:7], v[96:99]
ds_read_b64_tr_b16 a[110:111], v13 offset:9984
v_mfma_f32_16x16x32_bf16 v[104:107], a[80:83], a[8:11], v[104:107]
s_add_u32 m0, s16, 0x8000
s_waitcnt lgkmcnt(4)
v_mfma_f32_16x16x32_bf16 v[104:107], a[84:87], a[24:27], v[104:107]
buffer_load_dwordx4 v2, s[48:51], 0 offen lds
v_mfma_f32_16x16x32_bf16 v[112:115], a[84:87], a[28:31], v[112:115]
v_mfma_f32_16x16x32_bf16 v[112:115], a[80:83], a[12:15], v[112:115]
v_mfma_f32_16x16x32_bf16 v[116:119], a[88:91], a[12:15], v[116:119]
ds_read_b64_tr_b16 a[80:81], v12 offset:16384
v_mfma_f32_16x16x32_bf16 v[116:119], a[92:95], a[28:31], v[116:119]
ds_read_b64_tr_b16 a[82:83], v12 offset:17408
v_mfma_f32_16x16x32_bf16 v[108:111], a[92:95], a[24:27], v[108:111]
ds_read_b64_tr_b16 a[84:85], v12 offset:24576
v_mfma_f32_16x16x32_bf16 v[108:111], a[88:91], a[8:11], v[108:111]
ds_read_b64_tr_b16 a[86:87], v12 offset:25600
s_add_u32 m0, s16, 0x8400
v_mfma_f32_16x16x32_bf16 v[100:103], a[88:91], a[4:7], v[100:103]
buffer_load_dwordx4 v3, s[48:51], 0 offen lds
v_mfma_f32_16x16x32_bf16 v[100:103], a[92:95], a[20:23], v[100:103]
v_mfma_f32_16x16x32_bf16 v[92:95], a[92:95], a[16:19], v[92:95]
v_mfma_f32_16x16x32_bf16 v[92:95], a[88:91], a[0:3], v[92:95]
s_waitcnt lgkmcnt(4)
v_mfma_f32_16x16x32_bf16 v[120:123], a[96:99], a[0:3], v[120:123]
ds_read_b64_tr_b16 a[88:89], v13 offset:16384
v_mfma_f32_16x16x32_bf16 v[120:123], a[100:103], a[16:19], v[120:123]
ds_read_b64_tr_b16 a[90:91], v13 offset:17408
v_mfma_f32_16x16x32_bf16 v[128:131], a[100:103], a[20:23], v[128:131]
ds_read_b64_tr_b16 a[92:93], v13 offset:24576
v_mfma_f32_16x16x32_bf16 v[128:131], a[96:99], a[4:7], v[128:131]
ds_read_b64_tr_b16 a[94:95], v13 offset:25600
s_add_u32 m0, s16, 0x8800
v_mfma_f32_16x16x32_bf16 v[136:139], a[96:99], a[8:11], v[136:139]
buffer_load_dwordx4 v2, s[48:51], s12 offen lds
v_mfma_f32_16x16x32_bf16 v[136:139], a[100:103], a[24:27], v[136:139]
v_mfma_f32_16x16x32_bf16 v[144:147], a[100:103], a[28:31], v[144:147]
v_mfma_f32_16x16x32_bf16 v[144:147], a[96:99], a[12:15], v[144:147]
v_mfma_f32_16x16x32_bf16 v[148:151], a[104:107], a[12:15], v[148:151]
ds_read_b64_tr_b16 a[96:97], v12 offset:16640
v_mfma_f32_16x16x32_bf16 v[148:151], a[108:111], a[28:31], v[148:151]
ds_read_b64_tr_b16 a[98:99], v12 offset:17664
v_mfma_f32_16x16x32_bf16 v[140:143], a[108:111], a[24:27], v[140:143]
ds_read_b64_tr_b16 a[100:101], v12 offset:24832
s_add_u32 m0, s16, 0x8c00
v_mfma_f32_16x16x32_bf16 v[140:143], a[104:107], a[8:11], v[140:143]
buffer_load_dwordx4 v3, s[48:51], s12 offen lds
v_mfma_f32_16x16x32_bf16 v[132:135], a[104:107], a[4:7], v[132:135]
ds_read_b64_tr_b16 a[102:103], v12 offset:25856
v_mfma_f32_16x16x32_bf16 v[132:135], a[108:111], a[20:23], v[132:135]
v_mfma_f32_16x16x32_bf16 v[124:127], a[108:111], a[16:19], v[124:127]
v_mfma_f32_16x16x32_bf16 v[124:127], a[104:107], a[0:3], v[124:127]
s_waitcnt lgkmcnt(4)
v_mfma_f32_16x16x32_bf16 v[152:155], a[0:3], a[80:83], v[152:155]
ds_read_b64_tr_b16 a[104:105], v13 offset:16640
v_mfma_f32_16x16x32_bf16 v[152:155], a[16:19], a[84:87], v[152:155]
ds_read_b64_tr_b16 a[106:107], v13 offset:17664
s_add_u32 m0, s16, 0x9000
v_mfma_f32_16x16x32_bf16 v[156:159], a[20:23], a[84:87], v[156:159]
buffer_load_dwordx4 v2, s[48:51], s13 offen lds
v_mfma_f32_16x16x32_bf16 v[156:159], a[4:7], a[80:83], v[156:159]
ds_read_b64_tr_b16 a[108:109], v13 offset:24832
v_mfma_f32_16x16x32_bf16 v[160:163], a[8:11], a[80:83], v[160:163]
ds_read_b64_tr_b16 a[110:111], v13 offset:25856
v_mfma_f32_16x16x32_bf16 v[160:163], a[24:27], a[84:87], v[160:163]
v_mfma_f32_16x16x32_bf16 v[164:167], a[28:31], a[84:87], v[164:167]
v_mfma_f32_16x16x32_bf16 v[164:167], a[12:15], a[80:83], v[164:167]
v_mfma_f32_16x16x32_bf16 v[180:183], a[12:15], a[88:91], v[180:183]
ds_read_b64_tr_b16 a[80:81], v12 offset:16896
v_mfma_f32_16x16x32_bf16 v[180:183], a[28:31], a[92:95], v[180:183]
ds_read_b64_tr_b16 a[82:83], v12 offset:17920
s_add_u32 m0, s16, 0x9400
v_mfma_f32_16x16x32_bf16 v[176:179], a[24:27], a[92:95], v[176:179]
buffer_load_dwordx4 v3, s[48:51], s13 offen lds
v_mfma_f32_16x16x32_bf16 v[176:179], a[8:11], a[88:91], v[176:179]
ds_read_b64_tr_b16 a[84:85], v12 offset:25088
v_mfma_f32_16x16x32_bf16 v[172:175], a[4:7], a[88:91], v[172:175]
ds_read_b64_tr_b16 a[86:87], v12 offset:26112
v_mfma_f32_16x16x32_bf16 v[172:175], a[20:23], a[92:95], v[172:175]
v_mfma_f32_16x16x32_bf16 v[168:171], a[16:19], a[92:95], v[168:171]
v_mfma_f32_16x16x32_bf16 v[168:171], a[0:3], a[88:91], v[168:171]
s_waitcnt lgkmcnt(4)
v_mfma_f32_16x16x32_bf16 v[184:187], a[0:3], a[96:99], v[184:187]
ds_read_b64_tr_b16 a[88:89], v13 offset:16896
s_add_u32 m0, s16, 0x9800
v_mfma_f32_16x16x32_bf16 v[184:187], a[16:19], a[100:103], v[184:187]
buffer_load_dwordx4 v2, s[48:51], s14 offen lds
v_mfma_f32_16x16x32_bf16 v[188:191], a[20:23], a[100:103], v[188:191]
ds_read_b64_tr_b16 a[90:91], v13 offset:17920
v_mfma_f32_16x16x32_bf16 v[188:191], a[4:7], a[96:99], v[188:191]
ds_read_b64_tr_b16 a[92:93], v13 offset:25088
v_mfma_f32_16x16x32_bf16 v[192:195], a[8:11], a[96:99], v[192:195]
ds_read_b64_tr_b16 a[94:95], v13 offset:26112
v_mfma_f32_16x16x32_bf16 v[192:195], a[24:27], a[100:103], v[192:195]
v_mfma_f32_16x16x32_bf16 v[196:199], a[28:31], a[100:103], v[196:199]
v_mfma_f32_16x16x32_bf16 v[196:199], a[12:15], a[96:99], v[196:199]
v_mfma_f32_16x16x32_bf16 v[212:215], a[12:15], a[104:107], v[212:215]
ds_read_b64_tr_b16 a[96:97], v12 offset:17152
s_add_u32 m0, s16, 0x9c00
v_mfma_f32_16x16x32_bf16 v[212:215], a[28:31], a[108:111], v[212:215]
buffer_load_dwordx4 v3, s[48:51], s14 offen lds
v_mfma_f32_16x16x32_bf16 v[208:211], a[24:27], a[108:111], v[208:211]
ds_read_b64_tr_b16 a[98:99], v12 offset:18176
v_lshl_add_u32 v2, s42, 7, v2
v_mfma_f32_16x16x32_bf16 v[208:211], a[8:11], a[104:107], v[208:211]
ds_read_b64_tr_b16 a[100:101], v12 offset:25344
v_lshl_add_u32 v3, s42, 7, v3
v_mfma_f32_16x16x32_bf16 v[204:207], a[4:7], a[104:107], v[204:207]
ds_read_b64_tr_b16 a[102:103], v12 offset:26368
v_mfma_f32_16x16x32_bf16 v[204:207], a[20:23], a[108:111], v[204:207]
v_mfma_f32_16x16x32_bf16 v[200:203], a[16:19], a[108:111], v[200:203]
v_mfma_f32_16x16x32_bf16 v[200:203], a[0:3], a[104:107], v[200:203]
s_mov_b32 s9, 0x0
s_waitcnt lgkmcnt(4)
v_mfma_f32_16x16x32_bf16 v[216:219], a[0:3], a[80:83], v[216:219]
buffer_load_dword a120, v19, s[44:47], s9 offen
v_mfma_f32_16x16x32_bf16 v[216:219], a[16:19], a[84:87], v[216:219]
ds_read_b64_tr_b16 a[104:105], v13 offset:17152
v_mfma_f32_16x16x32_bf16 v[220:223], a[20:23], a[84:87], v[220:223]
ds_read_b64_tr_b16 a[106:107], v13 offset:18176
v_mfma_f32_16x16x32_bf16 v[220:223], a[4:7], a[80:83], v[220:223]
ds_read_b64_tr_b16 a[108:109], v13 offset:25344
v_mfma_f32_16x16x32_bf16 v[224:227], a[8:11], a[80:83], v[224:227]
ds_read_b64_tr_b16 a[110:111], v13 offset:26368
v_add_u32 v12, 0xffff0000, v12
v_mfma_f32_16x16x32_bf16 v[224:227], a[24:27], a[84:87], v[224:227]
v_add_u32 v13, 0xffff0000, v13
v_mfma_f32_16x16x32_bf16 v[228:231], a[28:31], a[84:87], v[228:231]
v_mfma_f32_16x16x32_bf16 v[228:231], a[12:15], a[80:83], v[228:231]
v_mfma_f32_16x16x32_bf16 v[244:247], a[12:15], a[88:91], v[244:247]
s_waitcnt vmcnt(27) lgkmcnt(0)
v_mfma_f32_16x16x32_bf16 v[244:247], a[28:31], a[92:95], v[244:247]
s_barrier
s_add_u32 m0, s17, 0x10000
v_mfma_f32_16x16x32_bf16 v[240:243], a[24:27], a[92:95], v[240:243]
buffer_load_dwordx4 v5, s[56:59], 0 offen lds
v_mfma_f32_16x16x32_bf16 v[240:243], a[8:11], a[88:91], v[240:243]
ds_read_b64_tr_b16 a[80:81], v12 offset:0
v_mfma_f32_16x16x32_bf16 v[236:239], a[4:7], a[88:91], v[236:239]
ds_read_b64_tr_b16 a[82:83], v12 offset:1024
v_mfma_f32_16x16x32_bf16 v[236:239], a[20:23], a[92:95], v[236:239]
ds_read_b64_tr_b16 a[84:85], v12 offset:8192
v_mfma_f32_16x16x32_bf16 v[232:235], a[16:19], a[92:95], v[232:235]
ds_read_b64_tr_b16 a[86:87], v12 offset:9216
v_mfma_f32_16x16x32_bf16 v[232:235], a[0:3], a[88:91], v[232:235]
s_waitcnt lgkmcnt(4)
v_mfma_f32_16x16x32_bf16 v[248:251], a[0:3], a[96:99], v[248:251]
ds_read_b64_tr_b16 a[88:89], v13 offset:0
s_add_u32 m0, s17, 0x14000
v_mfma_f32_16x16x32_bf16 v[248:251], a[16:19], a[100:103], v[248:251]
buffer_load_dwordx4 v5, s[60:63], 0 offen lds
v_mfma_f32_16x16x32_bf16 v[252:255], a[20:23], a[100:103], v[252:255]
ds_read_b64_tr_b16 a[90:91], v13 offset:1024
v_mfma_f32_16x16x32_bf16 v[252:255], a[4:7], a[96:99], v[252:255]
ds_read_b64_tr_b16 a[92:93], v13 offset:8192
v_mfma_f32_16x16x32_bf16 a[232:235], a[8:11], a[96:99], a[232:235]
ds_read_b64_tr_b16 a[94:95], v13 offset:9216
v_mfma_f32_16x16x32_bf16 a[232:235], a[24:27], a[100:103], a[232:235]
v_mfma_f32_16x16x32_bf16 a[236:239], a[28:31], a[100:103], a[236:239]
v_mfma_f32_16x16x32_bf16 a[236:239], a[12:15], a[96:99], a[236:239]
s_add_u32 m0, s17, 0x10400
v_mfma_f32_16x16x32_bf16 a[252:255], a[12:15], a[104:107], a[252:255]
buffer_load_dwordx4 v5, s[56:59], s13 offen lds
v_mfma_f32_16x16x32_bf16 a[252:255], a[28:31], a[108:111], a[252:255]
ds_read_b64_tr_b16 a[96:97], v12 offset:256
v_mfma_f32_16x16x32_bf16 a[248:251], a[24:27], a[108:111], a[248:251]
ds_read_b64_tr_b16 a[98:99], v12 offset:1280
v_mfma_f32_16x16x32_bf16 a[248:251], a[8:11], a[104:107], a[248:251]
ds_read_b64_tr_b16 a[100:101], v12 offset:8448
v_mfma_f32_16x16x32_bf16 a[244:247], a[4:7], a[104:107], a[244:247]
ds_read_b64_tr_b16 a[102:103], v12 offset:9472
v_mfma_f32_16x16x32_bf16 a[244:247], a[20:23], a[108:111], a[244:247]
v_mfma_f32_16x16x32_bf16 a[240:243], a[16:19], a[108:111], a[240:243]
s_add_u32 m0, s17, 0x14400
s_waitcnt lgkmcnt(4)
v_mfma_f32_16x16x32_bf16 a[240:243], a[0:3], a[104:107], a[240:243]
buffer_load_dwordx4 v5, s[60:63], s13 offen lds
L_S3:
v_mfma_f32_16x16x32_bf16 v[24:27], a[80:83], a[32:35], v[24:27]
ds_read_b64_tr_b16 a[104:105], v13 offset:256
s_waitcnt vmcnt(22)
v_mfma_f32_16x16x32_bf16 v[24:27], a[84:87], a[48:51], v[24:27]
ds_read_b64_tr_b16 a[106:107], v13 offset:1280
v_mfma_f32_16x16x32_bf16 v[32:35], a[84:87], a[52:55], v[32:35]
ds_read_b64_tr_b16 a[108:109], v13 offset:8448
v_mfma_f32_16x16x32_bf16 v[32:35], a[80:83], a[36:39], v[32:35]
ds_read_b64_tr_b16 a[110:111], v13 offset:9472
v_mfma_f32_16x16x32_bf16 v[40:43], a[80:83], a[40:43], v[40:43]
ds_read_b128 a[0:3], v8 offset:0
v_mfma_f32_16x16x32_bf16 v[40:43], a[84:87], a[56:59], v[40:43]
ds_read_b128 a[16:19], v9 offset:0
s_add_u32 m0, s17, 0x10800
v_mfma_f32_16x16x32_bf16 v[48:51], a[84:87], a[60:63], v[48:51]
buffer_load_dwordx4 v6, s[56:59], 0 offen lds
v_mfma_f32_16x16x32_bf16 v[48:51], a[80:83], a[44:47], v[48:51]
ds_read_b128 a[4:7], v8 offset:2048
v_mfma_f32_16x16x32_bf16 v[52:55], a[88:91], a[44:47], v[52:55]
ds_read_b64_tr_b16 a[80:81], v12 offset:512
v_mfma_f32_16x16x32_bf16 v[52:55], a[92:95], a[60:63], v[52:55]
ds_read_b64_tr_b16 a[82:83], v12 offset:1536
v_mfma_f32_16x16x32_bf16 v[44:47], a[92:95], a[56:59], v[44:47]
ds_read_b64_tr_b16 a[84:85], v12 offset:8704
v_mfma_f32_16x16x32_bf16 v[44:47], a[88:91], a[40:43], v[44:47]
ds_read_b64_tr_b16 a[86:87], v12 offset:9728
v_mfma_f32_16x16x32_bf16 v[36:39], a[88:91], a[36:39], v[36:39]
ds_read_b128 a[20:23], v9 offset:2048
s_add_u32 m0, s17, 0x14800
v_mfma_f32_16x16x32_bf16 v[36:39], a[92:95], a[52:55], v[36:39]
buffer_load_dwordx4 v6, s[60:63], 0 offen lds
v_mfma_f32_16x16x32_bf16 v[28:31], a[92:95], a[48:51], v[28:31]
ds_read_b128 a[8:11], v8 offset:4096
v_mfma_f32_16x16x32_bf16 v[28:31], a[88:91], a[32:35], v[28:31]
ds_read_b128 a[24:27], v9 offset:4096
s_waitcnt lgkmcnt(10)
v_mfma_f32_16x16x32_bf16 v[56:59], a[96:99], a[32:35], v[56:59]
ds_read_b64_tr_b16 a[88:89], v13 offset:512
v_mfma_f32_16x16x32_bf16 v[56:59], a[100:103], a[48:51], v[56:59]
ds_read_b64_tr_b16 a[90:91], v13 offset:1536
v_mfma_f32_16x16x32_bf16 v[64:67], a[100:103], a[52:55], v[64:67]
ds_read_b64_tr_b16 a[92:93], v13 offset:8704
v_mfma_f32_16x16x32_bf16 v[64:67], a[96:99], a[36:39], v[64:67]
ds_read_b64_tr_b16 a[94:95], v13 offset:9728
s_add_u32 m0, s17, 0x10c00
v_mfma_f32_16x16x32_bf16 v[72:75], a[96:99], a[40:43], v[72:75]
buffer_load_dwordx4 v6, s[56:59], s13 offen lds
v_mfma_f32_16x16x32_bf16 v[72:75], a[100:103], a[56:59], v[72:75]
ds_read_b128 a[12:15], v8 offset:6144
v_mfma_f32_16x16x32_bf16 v[80:83], a[100:103], a[60:63], v[80:83]
ds_read_b128 a[28:31], v9 offset:6144
v_mfma_f32_16x16x32_bf16 v[80:83], a[96:99], a[44:47], v[80:83]
v_mfma_f32_16x16x32_bf16 v[84:87], a[104:107], a[44:47], v[84:87]
ds_read_b64_tr_b16 a[96:97], v12 offset:768
v_mfma_f32_16x16x32_bf16 v[84:87], a[108:111], a[60:63], v[84:87]
ds_read_b64_tr_b16 a[98:99], v12 offset:1792
v_mfma_f32_16x16x32_bf16 v[76:79], a[108:111], a[56:59], v[76:79]
ds_read_b64_tr_b16 a[100:101], v12 offset:8960
s_add_u32 m0, s17, 0x14c00
v_mfma_f32_16x16x32_bf16 v[76:79], a[104:107], a[40:43], v[76:79]
buffer_load_dwordx4 v6, s[60:63], s13 offen lds
v_mfma_f32_16x16x32_bf16 v[68:71], a[104:107], a[36:39], v[68:71]
ds_read_b64_tr_b16 a[102:103], v12 offset:9984
v_lshl_add_u32 v5, s42, 19, v5
v_mfma_f32_16x16x32_bf16 v[68:71], a[108:111], a[52:55], v[68:71]
v_lshl_add_u32 v6, s42, 19, v6
v_mfma_f32_16x16x32_bf16 v[60:63], a[108:111], a[48:51], v[60:63]
v_mfma_f32_16x16x32_bf16 v[60:63], a[104:107], a[32:35], v[60:63]
s_waitcnt lgkmcnt(6)
v_mfma_f32_16x16x32_bf16 v[88:91], a[80:83], a[32:35], v[88:91]
ds_read_b64_tr_b16 a[104:105], v13 offset:768
v_mfma_f32_16x16x32_bf16 v[88:91], a[84:87], a[48:51], v[88:91]
ds_read_b64_tr_b16 a[106:107], v13 offset:1792
s_mov_b32 s9, 0x200000
v_mfma_f32_16x16x32_bf16 v[96:99], a[84:87], a[52:55], v[96:99]
buffer_load_dword a120, v19, s[44:47], s9 offen
v_mfma_f32_16x16x32_bf16 v[96:99], a[80:83], a[36:39], v[96:99]
ds_read_b64_tr_b16 a[108:109], v13 offset:8960
v_mfma_f32_16x16x32_bf16 v[104:107], a[80:83], a[40:43], v[104:107]
ds_read_b64_tr_b16 a[110:111], v13 offset:9984
v_mfma_f32_16x16x32_bf16 v[104:107], a[84:87], a[56:59], v[104:107]
v_mfma_f32_16x16x32_bf16 v[112:115], a[84:87], a[60:63], v[112:115]
v_mfma_f32_16x16x32_bf16 v[112:115], a[80:83], a[44:47], v[112:115]
s_waitcnt lgkmcnt(8)
v_mfma_f32_16x16x32_bf16 v[116:119], a[88:91], a[44:47], v[116:119]
ds_read_b64_tr_b16 a[80:81], v12 offset:16384
s_add_u32 m0, s16, 0x0
v_mfma_f32_16x16x32_bf16 v[116:119], a[92:95], a[60:63], v[116:119]
buffer_load_dwordx4 v2, s[48:51], 0 offen lds
v_mfma_f32_16x16x32_bf16 v[108:111], a[92:95], a[56:59], v[108:111]
ds_read_b64_tr_b16 a[82:83], v12 offset:17408
v_mfma_f32_16x16x32_bf16 v[108:111], a[88:91], a[40:43], v[108:111]
ds_read_b64_tr_b16 a[84:85], v12 offset:24576
v_mfma_f32_16x16x32_bf16 v[100:103], a[88:91], a[36:39], v[100:103]
ds_read_b64_tr_b16 a[86:87], v12 offset:25600
v_mfma_f32_16x16x32_bf16 v[100:103], a[92:95], a[52:55], v[100:103]
v_mfma_f32_16x16x32_bf16 v[92:95], a[92:95], a[48:51], v[92:95]
v_mfma_f32_16x16x32_bf16 v[92:95], a[88:91], a[32:35], v[92:95]
s_add_u32 m0, s16, 0x400
s_waitcnt lgkmcnt(4)
v_mfma_f32_16x16x32_bf16 v[120:123], a[96:99], a[32:35], v[120:123]
buffer_load_dwordx4 v3, s[48:51], 0 offen lds
v_mfma_f32_16x16x32_bf16 v[120:123], a[100:103], a[48:51], v[120:123]
ds_read_b64_tr_b16 a[88:89], v13 offset:16384
v_mfma_f32_16x16x32_bf16 v[128:131], a[100:103], a[52:55], v[128:131]
ds_read_b64_tr_b16 a[90:91], v13 offset:17408
v_mfma_f32_16x16x32_bf16 v[128:131], a[96:99], a[36:39], v[128:131]
ds_read_b64_tr_b16 a[92:93], v13 offset:24576
v_mfma_f32_16x16x32_bf16 v[136:139], a[96:99], a[40:43], v[136:139]
ds_read_b64_tr_b16 a[94:95], v13 offset:25600
v_mfma_f32_16x16x32_bf16 v[136:139], a[100:103], a[56:59], v[136:139]
v_mfma_f32_16x16x32_bf16 v[144:147], a[100:103], a[60:63], v[144:147]
s_add_u32 m0, s16, 0x800
v_mfma_f32_16x16x32_bf16 v[144:147], a[96:99], a[44:47], v[144:147]
buffer_load_dwordx4 v2, s[48:51], s12 offen lds
v_mfma_f32_16x16x32_bf16 v[148:151], a[104:107], a[44:47], v[148:151]
ds_read_b64_tr_b16 a[96:97], v12 offset:16640
v_mfma_f32_16x16x32_bf16 v[148:151], a[108:111], a[60:63], v[148:151]
ds_read_b64_tr_b16 a[98:99], v12 offset:17664
v_mfma_f32_16x16x32_bf16 v[140:143], a[108:111], a[56:59], v[140:143]
ds_read_b64_tr_b16 a[100:101], v12 offset:24832
v_mfma_f32_16x16x32_bf16 v[140:143], a[104:107], a[40:43], v[140:143]
ds_read_b64_tr_b16 a[102:103], v12 offset:25856
v_mfma_f32_16x16x32_bf16 v[132:135], a[104:107], a[36:39], v[132:135]
v_mfma_f32_16x16x32_bf16 v[132:135], a[108:111], a[52:55], v[132:135]
s_add_u32 m0, s16, 0xc00
v_mfma_f32_16x16x32_bf16 v[124:127], a[108:111], a[48:51], v[124:127]
buffer_load_dwordx4 v3, s[48:51], s12 offen lds
v_mfma_f32_16x16x32_bf16 v[124:127], a[104:107], a[32:35], v[124:127]
s_waitcnt lgkmcnt(4)
v_mfma_f32_16x16x32_bf16 v[152:155], a[32:35], a[80:83], v[152:155]
ds_read_b64_tr_b16 a[104:105], v13 offset:16640
v_mfma_f32_16x16x32_bf16 v[152:155], a[48:51], a[84:87], v[152:155]
ds_read_b64_tr_b16 a[106:107], v13 offset:17664
v_mfma_f32_16x16x32_bf16 v[156:159], a[52:55], a[84:87], v[156:159]
ds_read_b64_tr_b16 a[108:109], v13 offset:24832
v_mfma_f32_16x16x32_bf16 v[156:159], a[36:39], a[80:83], v[156:159]
ds_read_b64_tr_b16 a[110:111], v13 offset:25856
v_mfma_f32_16x16x32_bf16 v[160:163], a[40:43], a[80:83], v[160:163]
s_add_u32 m0, s16, 0x1000
v_mfma_f32_16x16x32_bf16 v[160:163], a[56:59], a[84:87], v[160:163]
buffer_load_dwordx4 v2, s[48:51], s13 offen lds
v_mfma_f32_16x16x32_bf16 v[164:167], a[60:63], a[84:87], v[164:167]
v_mfma_f32_16x16x32_bf16 v[164:167], a[44:47], a[80:83], v[164:167]
v_mfma_f32_16x16x32_bf16 v[180:183], a[44:47], a[88:91], v[180:183]
ds_read_b64_tr_b16 a[80:81], v12 offset:16896
v_mfma_f32_16x16x32_bf16 v[180:183], a[60:63], a[92:95], v[180:183]
ds_read_b64_tr_b16 a[82:83], v12 offset:17920
v_mfma_f32_16x16x32_bf16 v[176:179], a[56:59], a[92:95], v[176:179]
ds_read_b64_tr_b16 a[84:85], v12 offset:25088
v_mfma_f32_16x16x32_bf16 v[176:179], a[40:43], a[88:91], v[176:179]
ds_read_b64_tr_b16 a[86:87], v12 offset:26112
s_add_u32 m0, s16, 0x1400
v_mfma_f32_16x16x32_bf16 v[172:175], a[36:39], a[88:91], v[172:175]
buffer_load_dwordx4 v3, s[48:51], s13 offen lds
v_mfma_f32_16x16x32_bf16 v[172:175], a[52:55], a[92:95], v[172:175]
v_mfma_f32_16x16x32_bf16 v[168:171], a[48:51], a[92:95], v[168:171]
v_mfma_f32_16x16x32_bf16 v[168:171], a[32:35], a[88:91], v[168:171]
s_waitcnt lgkmcnt(4)
v_mfma_f32_16x16x32_bf16 v[184:187], a[32:35], a[96:99], v[184:187]
ds_read_b64_tr_b16 a[88:89], v13 offset:16896
v_mfma_f32_16x16x32_bf16 v[184:187], a[48:51], a[100:103], v[184:187]
ds_read_b64_tr_b16 a[90:91], v13 offset:17920
v_mfma_f32_16x16x32_bf16 v[188:191], a[52:55], a[100:103], v[188:191]
ds_read_b64_tr_b16 a[92:93], v13 offset:25088
s_add_u32 m0, s16, 0x1800
v_mfma_f32_16x16x32_bf16 v[188:191], a[36:39], a[96:99], v[188:191]
buffer_load_dwordx4 v2, s[48:51], s14 offen lds
v_mfma_f32_16x16x32_bf16 v[192:195], a[40:43], a[96:99], v[192:195]
ds_read_b64_tr_b16 a[94:95], v13 offset:26112
v_mfma_f32_16x16x32_bf16 v[192:195], a[56:59], a[100:103], v[192:195]
v_mfma_f32_16x16x32_bf16 v[196:199], a[60:63], a[100:103], v[196:199]
v_mfma_f32_16x16x32_bf16 v[196:199], a[44:47], a[96:99], v[196:199]
v_mfma_f32_16x16x32_bf16 v[212:215], a[44:47], a[104:107], v[212:215]
ds_read_b64_tr_b16 a[96:97], v12 offset:17152
v_mfma_f32_16x16x32_bf16 v[212:215], a[60:63], a[108:111], v[212:215]
ds_read_b64_tr_b16 a[98:99], v12 offset:18176
s_add_u32 m0, s16, 0x1c00
v_mfma_f32_16x16x32_bf16 v[208:211], a[56:59], a[108:111], v[208:211]
buffer_load_dwordx4 v3, s[48:51], s14 offen lds
v_mfma_f32_16x16x32_bf16 v[208:211], a[40:43], a[104:107], v[208:211]
ds_read_b64_tr_b16 a[100:101], v12 offset:25344
v_lshl_add_u32 v2, s42, 7, v2
v_mfma_f32_16x16x32_bf16 v[204:207], a[36:39], a[104:107], v[204:207]
ds_read_b64_tr_b16 a[102:103], v12 offset:26368
v_lshl_add_u32 v3, s42, 7, v3
v_mfma_f32_16x16x32_bf16 v[204:207], a[52:55], a[108:111], v[204:207]
v_mfma_f32_16x16x32_bf16 v[200:203], a[48:51], a[108:111], v[200:203]
v_mfma_f32_16x16x32_bf16 v[200:203], a[32:35], a[104:107], v[200:203]
s_waitcnt lgkmcnt(4)
v_mfma_f32_16x16x32_bf16 v[216:219], a[32:35], a[80:83], v[216:219]
ds_read_b64_tr_b16 a[104:105], v13 offset:17152
s_mov_b32 s9, 0x0
v_mfma_f32_16x16x32_bf16 v[216:219], a[48:51], a[84:87], v[216:219]
buffer_load_dword a120, v18, s[52:55], s9 offen
v_mfma_f32_16x16x32_bf16 v[220:223], a[52:55], a[84:87], v[220:223]
ds_read_b64_tr_b16 a[106:107], v13 offset:18176
v_mfma_f32_16x16x32_bf16 v[220:223], a[36:39], a[80:83], v[220:223]
ds_read_b64_tr_b16 a[108:109], v13 offset:25344
v_mfma_f32_16x16x32_bf16 v[224:227], a[40:43], a[80:83], v[224:227]
ds_read_b64_tr_b16 a[110:111], v13 offset:26368
v_add_u32 v12, 0x8000, v12
v_mfma_f32_16x16x32_bf16 v[224:227], a[56:59], a[84:87], v[224:227]
v_add_u32 v13, 0x8000, v13
v_mfma_f32_16x16x32_bf16 v[228:231], a[60:63], a[84:87], v[228:231]
v_mfma_f32_16x16x32_bf16 v[228:231], a[44:47], a[80:83], v[228:231]
v_mfma_f32_16x16x32_bf16 v[244:247], a[44:47], a[88:91], v[244:247]
s_waitcnt vmcnt(27) lgkmcnt(0)
v_mfma_f32_16x16x32_bf16 v[244:247], a[60:63], a[92:95], v[244:247]
s_barrier
s_add_u32 m0, s17, 0x0
v_mfma_f32_16x16x32_bf16 v[240:243], a[56:59], a[92:95], v[240:243]
buffer_load_dwordx4 v5, s[56:59], 0 offen lds
v_mfma_f32_16x16x32_bf16 v[240:243], a[40:43], a[88:91], v[240:243]
ds_read_b64_tr_b16 a[80:81], v12 offset:0
v_mfma_f32_16x16x32_bf16 v[236:239], a[36:39], a[88:91], v[236:239]
ds_read_b64_tr_b16 a[82:83], v12 offset:1024
v_mfma_f32_16x16x32_bf16 v[236:239], a[52:55], a[92:95], v[236:239]
ds_read_b64_tr_b16 a[84:85], v12 offset:8192
v_mfma_f32_16x16x32_bf16 v[232:235], a[48:51], a[92:95], v[232:235]
ds_read_b64_tr_b16 a[86:87], v12 offset:9216
v_mfma_f32_16x16x32_bf16 v[232:235], a[32:35], a[88:91], v[232:235]
s_waitcnt lgkmcnt(4)
v_mfma_f32_16x16x32_bf16 v[248:251], a[32:35], a[96:99], v[248:251]
ds_read_b64_tr_b16 a[88:89], v13 offset:0
s_add_u32 m0, s17, 0x4000
v_mfma_f32_16x16x32_bf16 v[248:251], a[48:51], a[100:103], v[248:251]
buffer_load_dwordx4 v5, s[60:63], 0 offen lds
v_mfma_f32_16x16x32_bf16 v[252:255], a[52:55], a[100:103], v[252:255]
ds_read_b64_tr_b16 a[90:91], v13 offset:1024
v_mfma_f32_16x16x32_bf16 v[252:255], a[36:39], a[96:99], v[252:255]
ds_read_b64_tr_b16 a[92:93], v13 offset:8192
v_mfma_f32_16x16x32_bf16 a[232:235], a[40:43], a[96:99], a[232:235]
ds_read_b64_tr_b16 a[94:95], v13 offset:9216
v_mfma_f32_16x16x32_bf16 a[232:235], a[56:59], a[100:103], a[232:235]
L_padA2:
s_cmp_eq_u32 s95, 1
s_cbranch_scc1 L_padA6
v_mfma_f32_16x16x32_bf16 a[236:239], a[60:63], a[100:103], a[236:239]
v_mfma_f32_16x16x32_bf16 a[236:239], a[44:47], a[96:99], a[236:239]
s_add_u32 m0, s17, 0x400
v_mfma_f32_16x16x32_bf16 a[252:255], a[44:47], a[104:107], a[252:255]
buffer_load_dwordx4 v5, s[56:59], s13 offen lds
v_mfma_f32_16x16x32_bf16 a[252:255], a[60:63], a[108:111], a[252:255]
ds_read_b64_tr_b16 a[96:97], v12 offset:256
v_mfma_f32_16x16x32_bf16 a[248:251], a[56:59], a[108:111], a[248:251]
ds_read_b64_tr_b16 a[98:99], v12 offset:1280
v_mfma_f32_16x16x32_bf16 a[248:251], a[40:43], a[104:107], a[248:251]
ds_read_b64_tr_b16 a[100:101], v12 offset:8448
v_mfma_f32_16x16x32_bf16 a[244:247], a[36:39], a[104:107], a[244:247]
ds_read_b64_tr_b16 a[102:103], v12 offset:9472
v_mfma_f32_16x16x32_bf16 a[244:247], a[52:55], a[108:111], a[244:247]
v_mfma_f32_16x16x32_bf16 a[240:243], a[48:51], a[108:111], a[240:243]
v_mfma_f32_16x16x32_bf16 a[240:243], a[32:35], a[104:107], a[240:243]
s_add_u32 m0, s17, 0x4400
s_waitcnt lgkmcnt(4)
L_S4:
v_mfma_f32_16x16x32_bf16 v[24:27], a[80:83], a[0:3], v[24:27]
buffer_load_dwordx4 v5, s[60:63], s13 offen lds
v_mfma_f32_16x16x32_bf16 v[24:27], a[84:87], a[16:19], v[24:27]
ds_read_b64_tr_b16 a[104:105], v13 offset:256
s_waitcnt vmcnt(23)
v_mfma_f32_16x16x32_bf16 v[32:35], a[84:87], a[20:23], v[32:35]
ds_read_b64_tr_b16 a[106:107], v13 offset:1280
v_mfma_f32_16x16x32_bf16 v[32:35], a[80:83], a[4:7], v[32:35]
ds_read_b64_tr_b16 a[108:109], v13 offset:8448
v_mfma_f32_16x16x32_bf16 v[40:43], a[80:83], a[8:11], v[40:43]
ds_read_b64_tr_b16 a[110:111], v13 offset:9472
v_mfma_f32_16x16x32_bf16 v[40:43], a[84:87], a[24:27], v[40:43]
ds_read_b128 a[32:35], v8 offset:32768
v_mfma_f32_16x16x32_bf16 v[48:51], a[84:87], a[28:31], v[48:51]
ds_read_b128 a[48:51], v9 offset:32768
s_add_u32 m0, s17, 0x800
v_mfma_f32_16x16x32_bf16 v[48:51], a[80:83], a[12:15], v[48:51]
buffer_load_dwordx4 v6, s[56:59], 0 offen lds
v_mfma_f32_16x16x32_bf16 v[52:55], a[88:91], a[12:15], v[52:55]
ds_read_b64_tr_b16 a[80:81], v12 offset:512
v_mfma_f32_16x16x32_bf16 v[52:55], a[92:95], a[28:31], v[52:55]
ds_read_b64_tr_b16 a[82:83], v12 offset:1536
v_mfma_f32_16x16x32_bf16 v[44:47], a[92:95], a[24:27], v[44:47]
ds_read_b64_tr_b16 a[84:85], v12 offset:8704
v_mfma_f32_16x16x32_bf16 v[44:47], a[88:91], a[8:11], v[44:47]
ds_read_b64_tr_b16 a[86:87], v12 offset:9728
v_mfma_f32_16x16x32_bf16 v[36:39], a[88:91], a[4:7], v[36:39]
ds_read_b128 a[36:39], v8 offset:34816
v_mfma_f32_16x16x32_bf16 v[36:39], a[92:95], a[20:23], v[36:39]
ds_read_b128 a[52:55], v9 offset:34816
s_waitcnt lgkmcnt(8)
v_mfma_f32_16x16x32_bf16 v[28:31], a[92:95], a[16:19], v[28:31]
ds_read_b128 a[40:43], v8 offset:36864
s_add_u32 m0, s17, 0x4800
v_mfma_f32_16x16x32_bf16 v[28:31], a[88:91], a[0:3], v[28:31]
buffer_load_dwordx4 v6, s[60:63], 0 offen lds
v_mfma_f32_16x16x32_bf16 v[56:59], a[96:99], a[0:3], v[56:59]
ds_read_b64_tr_b16 a[88:89], v13 offset:512
v_mfma_f32_16x16x32_bf16 v[56:59], a[100:103], a[16:19], v[56:59]
ds_read_b64_tr_b16 a[90:91], v13 offset:1536
v_mfma_f32_16x16x32_bf16 v[64:67], a[100:103], a[20:23], v[64:67]
ds_read_b64_tr_b16 a[92:93], v13 offset:8704
v_mfma_f32_16x16x32_bf16 v[64:67], a[96:99], a[4:7], v[64:67]
ds_read_b64_tr_b16 a[94:95], v13 offset:9728
v_mfma_f32_16x16x32_bf16 v[72:75], a[96:99], a[8:11], v[72:75]
ds_read_b128 a[56:59], v9 offset:36864
v_mfma_f32_16x16x32_bf16 v[72:75], a[100:103], a[24:27], v[72:75]
ds_read_b128 a[44:47], v8 offset:38912
s_add_u32 m0, s17, 0xc00
v_mfma_f32_16x16x32_bf16 v[80:83], a[100:103], a[28:31], v[80:83]
buffer_load_dwordx4 v6, s[56:59], s13 offen lds
v_mfma_f32_16x16x32_bf16 v[80:83], a[96:99], a[12:15], v[80:83]
ds_read_b128 a[60:63], v9 offset:38912
v_mfma_f32_16x16x32_bf16 v[84:87], a[104:107], a[12:15], v[84:87]
ds_read_b64_tr_b16 a[96:97], v12 offset:768
v_mfma_f32_16x16x32_bf16 v[84:87], a[108:111], a[28:31], v[84:87]
ds_read_b64_tr_b16 a[98:99], v12 offset:1792
v_mfma_f32_16x16x32_bf16 v[76:79], a[108:111], a[24:27], v[76:79]
ds_read_b64_tr_b16 a[100:101], v12 offset:8960
v_mfma_f32_16x16x32_bf16 v[76:79], a[104:107], a[8:11], v[76:79]
ds_read_b64_tr_b16 a[102:103], v12 offset:9984
v_mfma_f32_16x16x32_bf16 v[68:71], a[104:107], a[4:7], v[68:71]
s_add_u32 m0, s17, 0x4c00
v_mfma_f32_16x16x32_bf16 v[68:71], a[108:111], a[20:23], v[68:71]
buffer_load_dwordx4 v6, s[60:63], s13 offen lds
v_mfma_f32_16x16x32_bf16 v[60:63], a[108:111], a[16:19], v[60:63]
v_lshl_add_u32 v5, s42, 19, v5
v_lshl_add_u32 v6, s42, 19, v6
v_mfma_f32_16x16x32_bf16 v[60:63], a[104:107], a[0:3], v[60:63]
s_waitcnt lgkmcnt(7)
v_mfma_f32_16x16x32_bf16 v[88:91], a[80:83], a[0:3], v[88:91]
ds_read_b64_tr_b16 a[104:105], v13 offset:768
v_mfma_f32_16x16x32_bf16 v[88:91], a[84:87], a[16:19], v[88:91]
ds_read_b64_tr_b16 a[106:107], v13 offset:1792
v_mfma_f32_16x16x32_bf16 v[96:99], a[84:87], a[20:23], v[96:99]
ds_read_b64_tr_b16 a[108:109], v13 offset:8960
v_mfma_f32_16x16x32_bf16 v[96:99], a[80:83], a[4:7], v[96:99]
ds_read_b64_tr_b16 a[110:111], v13 offset:9984
v_mfma_f32_16x16x32_bf16 v[104:107], a[80:83], a[8:11], v[104:107]
s_add_u32 m0, s16, 0x8000
s_waitcnt lgkmcnt(8)
v_mfma_f32_16x16x32_bf16 v[104:107], a[84:87], a[24:27], v[104:107]
buffer_load_dwordx4 v2, s[48:51], 0 offen lds
v_mfma_f32_16x16x32_bf16 v[112:115], a[84:87], a[28:31], v[112:115]
v_mfma_f32_16x16x32_bf16 v[112:115], a[80:83], a[12:15], v[112:115]
v_mfma_f32_16x16x32_bf16 v[116:119], a[88:91], a[12:15], v[116:119]
ds_read_b64_tr_b16 a[80:81], v12 offset:16384
v_mfma_f32_16x16x32_bf16 v[116:119], a[92:95], a[28:31], v[116:119]
ds_read_b64_tr_b16 a[82:83], v12 offset:17408
v_mfma_f32_16x16x32_bf16 v[108:111], a[92:95], a[24:27], v[108:111]
ds_read_b64_tr_b16 a[84:85], v12 offset:24576
v_mfma_f32_16x16x32_bf16 v[108:111], a[88:91], a[8:11], v[108:111]
ds_read_b64_tr_b16 a[86:87], v12 offset:25600
s_add_u32 m0, s16, 0x8400
v_mfma_f32_16x16x32_bf16 v[100:103], a[88:91], a[4:7], v[100:103]
buffer_load_dwordx4 v3, s[48:51], 0 offen lds
v_mfma_f32_16x16x32_bf16 v[100:103], a[92:95], a[20:23], v[100:103]
v_mfma_f32_16x16x32_bf16 v[92:95], a[92:95], a[16:19], v[92:95]
v_mfma_f32_16x16x32_bf16 v[92:95], a[88:91], a[0:3], v[92:95]
s_waitcnt lgkmcnt(4)
v_mfma_f32_16x16x32_bf16 v[120:123], a[96:99], a[0:3], v[120:123]
ds_read_b64_tr_b16 a[88:89], v13 offset:16384
v_mfma_f32_16x16x32_bf16 v[120:123], a[100:103], a[16:19], v[120:123]
ds_read_b64_tr_b16 a[90:91], v13 offset:17408
v_mfma_f32_16x16x32_bf16 v[128:131], a[100:103], a[20:23], v[128:131]
ds_read_b64_tr_b16 a[92:93], v13 offset:24576
v_mfma_f32_16x16x32_bf16 v[128:131], a[96:99], a[4:7], v[128:131]
ds_read_b64_tr_b16 a[94:95], v13 offset:25600
s_add_u32 m0, s16, 0x8800
v_mfma_f32_16x16x32_bf16 v[136:139], a[96:99], a[8:11], v[136:139]
buffer_load_dwordx4 v2, s[48:51], s12 offen lds
v_mfma_f32_16x16x32_bf16 v[136:139], a[100:103], a[24:27], v[136:139]
v_mfma_f32_16x16x32_bf16 v[144:147], a[100:103], a[28:31], v[144:147]
v_mfma_f32_16x16x32_bf16 v[144:147], a[96:99], a[12:15], v[144:147]
v_mfma_f32_16x16x32_bf16 v[148:151], a[104:107], a[12:15], v[148:151]
ds_read_b64_tr_b16 a[96:97], v12 offset:16640
v_mfma_f32_16x16x32_bf16 v[148:151], a[108:111], a[28:31], v[148:151]
ds_read_b64_tr_b16 a[98:99], v12 offset:17664
v_mfma_f32_16x16x32_bf16 v[140:143], a[108:111], a[24:27], v[140:143]
ds_read_b64_tr_b16 a[100:101], v12 offset:24832
s_add_u32 m0, s16, 0x8c00
v_mfma_f32_16x16x32_bf16 v[140:143], a[104:107], a[8:11], v[140:143]
buffer_load_dwordx4 v3, s[48:51], s12 offen lds
v_mfma_f32_16x16x32_bf16 v[132:135], a[104:107], a[4:7], v[132:135]
ds_read_b64_tr_b16 a[102:103], v12 offset:25856
v_mfma_f32_16x16x32_bf16 v[132:135], a[108:111], a[20:23], v[132:135]
v_mfma_f32_16x16x32_bf16 v[124:127], a[108:111], a[16:19], v[124:127]
v_mfma_f32_16x16x32_bf16 v[124:127], a[104:107], a[0:3], v[124:127]
s_waitcnt lgkmcnt(4)
v_mfma_f32_16x16x32_bf16 v[152:155], a[0:3], a[80:83], v[152:155]
ds_read_b64_tr_b16 a[104:105], v13 offset:16640
v_mfma_f32_16x16x32_bf16 v[152:155], a[16:19], a[84:87], v[152:155]
ds_read_b64_tr_b16 a[106:107], v13 offset:17664
s_add_u32 m0, s16, 0x9000
v_mfma_f32_16x16x32_bf16 v[156:159], a[20:23], a[84:87], v[156:159]
buffer_load_dwordx4 v2, s[48:51], s13 offen lds
v_mfma_f32_16x16x32_bf16 v[156:159], a[4:7], a[80:83], v[156:159]
ds_read_b64_tr_b16 a[108:109], v13 offset:24832
v_mfma_f32_16x16x32_bf16 v[160:163], a[8:11], a[80:83], v[160:163]
ds_read_b64_tr_b16 a[110:111], v13 offset:25856
v_mfma_f32_16x16x32_bf16 v[160:163], a[24:27], a[84:87], v[160:163]
v_mfma_f32_16x16x32_bf16 v[164:167], a[28:31], a[84:87], v[164:167]
v_mfma_f32_16x16x32_bf16 v[164:167], a[12:15], a[80:83], v[164:167]
v_mfma_f32_16x16x32_bf16 v[180:183], a[12:15], a[88:91], v[180:183]
ds_read_b64_tr_b16 a[80:81], v12 offset:16896
v_mfma_f32_16x16x32_bf16 v[180:183], a[28:31], a[92:95], v[180:183]
ds_read_b64_tr_b16 a[82:83], v12 offset:17920
s_add_u32 m0, s16, 0x9400
v_mfma_f32_16x16x32_bf16 v[176:179], a[24:27], a[92:95], v[176:179]
buffer_load_dwordx4 v3, s[48:51], s13 offen lds
v_mfma_f32_16x16x32_bf16 v[176:179], a[8:11], a[88:91], v[176:179]
ds_read_b64_tr_b16 a[84:85], v12 offset:25088
v_mfma_f32_16x16x32_bf16 v[172:175], a[4:7], a[88:91], v[172:175]
ds_read_b64_tr_b16 a[86:87], v12 offset:26112
v_mfma_f32_16x16x32_bf16 v[172:175], a[20:23], a[92:95], v[172:175]
v_mfma_f32_16x16x32_bf16 v[168:171], a[16:19], a[92:95], v[168:171]
v_mfma_f32_16x16x32_bf16 v[168:171], a[0:3], a[88:91], v[168:171]
s_waitcnt lgkmcnt(4)
v_mfma_f32_16x16x32_bf16 v[184:187], a[0:3], a[96:99], v[184:187]
ds_read_b64_tr_b16 a[88:89], v13 offset:16896
s_add_u32 m0, s16, 0x9800
v_mfma_f32_16x16x32_bf16 v[184:187], a[16:19], a[100:103], v[184:187]
buffer_load_dwordx4 v2, s[48:51], s14 offen lds
v_mfma_f32_16x16x32_bf16 v[188:191], a[20:23], a[100:103], v[188:191]
ds_read_b64_tr_b16 a[90:91], v13 offset:17920
v_mfma_f32_16x16x32_bf16 v[188:191], a[4:7], a[96:99], v[188:191]
ds_read_b64_tr_b16 a[92:93], v13 offset:25088
v_mfma_f32_16x16x32_bf16 v[192:195], a[8:11], a[96:99], v[192:195]
ds_read_b64_tr_b16 a[94:95], v13 offset:26112
v_mfma_f32_16x16x32_bf16 v[192:195], a[24:27], a[100:103], v[192:195]
v_mfma_f32_16x16x32_bf16 v[196:199], a[28:31], a[100:103], v[196:199]
v_mfma_f32_16x16x32_bf16 v[196:199], a[12:15], a[96:99], v[196:199]
v_mfma_f32_16x16x32_bf16 v[212:215], a[12:15], a[104:107], v[212:215]
ds_read_b64_tr_b16 a[96:97], v12 offset:17152
s_add_u32 m0, s16, 0x9c00
v_mfma_f32_16x16x32_bf16 v[212:215], a[28:31], a[108:111], v[212:215]
buffer_load_dwordx4 v3, s[48:51], s14 offen lds
v_mfma_f32_16x16x32_bf16 v[208:211], a[24:27], a[108:111], v[208:211]
ds_read_b64_tr_b16 a[98:99], v12 offset:18176
s_sub_u32 s42, s43, s41
v_mfma_f32_16x16x32_bf16 v[208:211], a[8:11], a[104:107], v[208:211]
ds_read_b64_tr_b16 a[100:101], v12 offset:25344
s_mov_b32 s41, s43
v_mfma_f32_16x16x32_bf16 v[204:207], a[4:7], a[104:107], v[204:207]
ds_read_b64_tr_b16 a[102:103], v12 offset:26368
v_mfma_f32_16x16x32_bf16 v[204:207], a[20:23], a[108:111], v[204:207]
v_mfma_f32_16x16x32_bf16 v[200:203], a[16:19], a[108:111], v[200:203]
v_mfma_f32_16x16x32_bf16 v[200:203], a[0:3], a[104:107], v[200:203]
s_mov_b32 s9, 0x0
s_waitcnt lgkmcnt(4)
v_mfma_f32_16x16x32_bf16 v[216:219], a[0:3], a[80:83], v[216:219]
buffer_load_dword a120, v19, s[68:71], s9 offen
v_mfma_f32_16x16x32_bf16 v[216:219], a[16:19], a[84:87], v[216:219]
ds_read_b64_tr_b16 a[104:105], v13 offset:17152
v_mfma_f32_16x16x32_bf16 v[220:223], a[20:23], a[84:87], v[220:223]
ds_read_b64_tr_b16 a[106:107], v13 offset:18176
v_mfma_f32_16x16x32_bf16 v[220:223], a[4:7], a[80:83], v[220:223]
ds_read_b64_tr_b16 a[108:109], v13 offset:25344
v_mfma_f32_16x16x32_bf16 v[224:227], a[8:11], a[80:83], v[224:227]
ds_read_b64_tr_b16 a[110:111], v13 offset:26368
v_add_u32 v12, 0x8000, v12
v_mfma_f32_16x16x32_bf16 v[224:227], a[24:27], a[84:87], v[224:227]
v_add_u32 v13, 0x8000, v13
v_mfma_f32_16x16x32_bf16 v[228:231], a[28:31], a[84:87], v[228:231]
v_mfma_f32_16x16x32_bf16 v[228:231], a[12:15], a[80:83], v[228:231]
v_mfma_f32_16x16x32_bf16 v[244:247], a[12:15], a[88:91], v[244:247]
s_waitcnt vmcnt(27) lgkmcnt(0)
v_mfma_f32_16x16x32_bf16 v[244:247], a[28:31], a[92:95], v[244:247]
s_barrier
s_add_u32 m0, s17, 0x8000
v_mfma_f32_16x16x32_bf16 v[240:243], a[24:27], a[92:95], v[240:243]
buffer_load_dwordx4 v5, s[56:59], 0 offen lds
v_mfma_f32_16x16x32_bf16 v[240:243], a[8:11], a[88:91], v[240:243]
ds_read_b64_tr_b16 a[80:81], v12 offset:0
v_mfma_f32_16x16x32_bf16 v[236:239], a[4:7], a[88:91], v[236:239]
ds_read_b64_tr_b16 a[82:83], v12 offset:1024
v_mfma_f32_16x16x32_bf16 v[236:239], a[20:23], a[92:95], v[236:239]
ds_read_b64_tr_b16 a[84:85], v12 offset:8192
v_mfma_f32_16x16x32_bf16 v[232:235], a[16:19], a[92:95], v[232:235]
ds_read_b64_tr_b16 a[86:87], v12 offset:9216
v_mfma_f32_16x16x32_bf16 v[232:235], a[0:3], a[88:91], v[232:235]
s_waitcnt lgkmcnt(4)
v_mfma_f32_16x16x32_bf16 v[248:251], a[0:3], a[96:99], v[248:251]
ds_read_b64_tr_b16 a[88:89], v13 offset:0
s_add_u32 m0, s17, 0xc000
v_mfma_f32_16x16x32_bf16 v[248:251], a[16:19], a[100:103], v[248:251]
buffer_load_dwordx4 v5, s[60:63], 0 offen lds
v_mfma_f32_16x16x32_bf16 v[252:255], a[20:23], a[100:103], v[252:255]
ds_read_b64_tr_b16 a[90:91], v13 offset:1024
v_mfma_f32_16x16x32_bf16 v[252:255], a[4:7], a[96:99], v[252:255]
ds_read_b64_tr_b16 a[92:93], v13 offset:8192
v_mfma_f32_16x16x32_bf16 a[232:235], a[8:11], a[96:99], a[232:235]
ds_read_b64_tr_b16 a[94:95], v13 offset:9216
v_mfma_f32_16x16x32_bf16 a[232:235], a[24:27], a[100:103], a[232:235]
v_mfma_f32_16x16x32_bf16 a[236:239], a[28:31], a[100:103], a[236:239]
v_mfma_f32_16x16x32_bf16 a[236:239], a[12:15], a[96:99], a[236:239]
s_add_u32 m0, s17, 0x8400
v_mfma_f32_16x16x32_bf16 a[252:255], a[12:15], a[104:107], a[252:255]
buffer_load_dwordx4 v5, s[56:59], s13 offen lds
v_mfma_f32_16x16x32_bf16 a[252:255], a[28:31], a[108:111], a[252:255]
ds_read_b64_tr_b16 a[96:97], v12 offset:256
v_mfma_f32_16x16x32_bf16 a[248:251], a[24:27], a[108:111], a[248:251]
ds_read_b64_tr_b16 a[98:99], v12 offset:1280
v_mfma_f32_16x16x32_bf16 a[248:251], a[8:11], a[104:107], a[248:251]
ds_read_b64_tr_b16 a[100:101], v12 offset:8448
v_mfma_f32_16x16x32_bf16 a[244:247], a[4:7], a[104:107], a[244:247]
ds_read_b64_tr_b16 a[102:103], v12 offset:9472
v_mfma_f32_16x16x32_bf16 a[244:247], a[20:23], a[108:111], a[244:247]
v_mfma_f32_16x16x32_bf16 a[240:243], a[16:19], a[108:111], a[240:243]
s_add_u32 m0, s17, 0xc400
s_waitcnt lgkmcnt(4)
v_mfma_f32_16x16x32_bf16 a[240:243], a[0:3], a[104:107], a[240:243]
buffer_load_dwordx4 v5, s[60:63], s13 offen lds
L_S5:
v_mfma_f32_16x16x32_bf16 v[24:27], a[80:83], a[32:35], v[24:27]
ds_read_b64_tr_b16 a[104:105], v13 offset:256
s_waitcnt vmcnt(22)
v_mfma_f32_16x16x32_bf16 v[24:27], a[84:87], a[48:51], v[24:27]
ds_read_b64_tr_b16 a[106:107], v13 offset:1280
v_mfma_f32_16x16x32_bf16 v[32:35], a[84:87], a[52:55], v[32:35]
ds_read_b64_tr_b16 a[108:109], v13 offset:8448
v_mfma_f32_16x16x32_bf16 v[32:35], a[80:83], a[36:39], v[32:35]
ds_read_b64_tr_b16 a[110:111], v13 offset:9472
v_mfma_f32_16x16x32_bf16 v[40:43], a[80:83], a[40:43], v[40:43]
ds_read_b128 a[0:3], v8 offset:0
v_mfma_f32_16x16x32_bf16 v[40:43], a[84:87], a[56:59], v[40:43]
ds_read_b128 a[16:19], v9 offset:0
s_add_u32 m0, s17, 0x8800
v_mfma_f32_16x16x32_bf16 v[48:51], a[84:87], a[60:63], v[48:51]
buffer_load_dwordx4 v6, s[56:59], 0 offen lds
v_mfma_f32_16x16x32_bf16 v[48:51], a[80:83], a[44:47], v[48:51]
ds_read_b128 a[4:7], v8 offset:2048
v_mfma_f32_16x16x32_bf16 v[52:55], a[88:91], a[44:47], v[52:55]
ds_read_b64_tr_b16 a[80:81], v12 offset:512
v_mfma_f32_16x16x32_bf16 v[52:55], a[92:95], a[60:63], v[52:55]
ds_read_b64_tr_b16 a[82:83], v12 offset:1536
v_mfma_f32_16x16x32_bf16 v[44:47], a[92:95], a[56:59], v[44:47]
ds_read_b64_tr_b16 a[84:85], v12 offset:8704
v_mfma_f32_16x16x32_bf16 v[44:47], a[88:91], a[40:43], v[44:47]
ds_read_b64_tr_b16 a[86:87], v12 offset:9728
v_mfma_f32_16x16x32_bf16 v[36:39], a[88:91], a[36:39], v[36:39]
ds_read_b128 a[20:23], v9 offset:2048
s_add_u32 m0, s17, 0xc800
v_mfma_f32_16x16x32_bf16 v[36:39], a[92:95], a[52:55], v[36:39]
buffer_load_dwordx4 v6, s[60:63], 0 offen lds
v_mfma_f32_16x16x32_bf16 v[28:31], a[92:95], a[48:51], v[28:31]
ds_read_b128 a[8:11], v8 offset:4096
v_mfma_f32_16x16x32_bf16 v[28:31], a[88:91], a[32:35], v[28:31]
ds_read_b128 a[24:27], v9 offset:4096
s_waitcnt lgkmcnt(10)
v_mfma_f32_16x16x32_bf16 v[56:59], a[96:99], a[32:35], v[56:59]
ds_read_b64_tr_b16 a[88:89], v13 offset:512
v_mfma_f32_16x16x32_bf16 v[56:59], a[100:103], a[48:51], v[56:59]
ds_read_b64_tr_b16 a[90:91], v13 offset:1536
v_mfma_f32_16x16x32_bf16 v[64:67], a[100:103], a[52:55], v[64:67]
ds_read_b64_tr_b16 a[92:93], v13 offset:8704
v_mfma_f32_16x16x32_bf16 v[64:67], a[96:99], a[36:39], v[64:67]
ds_read_b64_tr_b16 a[94:95], v13 offset:9728
s_add_u32 m0, s17, 0x8c00
v_mfma_f32_16x16x32_bf16 v[72:75], a[96:99], a[40:43], v[72:75]
buffer_load_dwordx4 v6, s[56:59], s13 offen lds
v_mfma_f32_16x16x32_bf16 v[72:75], a[100:103], a[56:59], v[72:75]
ds_read_b128 a[12:15], v8 offset:6144
v_mfma_f32_16x16x32_bf16 v[80:83], a[100:103], a[60:63], v[80:83]
ds_read_b128 a[28:31], v9 offset:6144
v_mfma_f32_16x16x32_bf16 v[80:83], a[96:99], a[44:47], v[80:83]
v_mfma_f32_16x16x32_bf16 v[84:87], a[104:107], a[44:47], v[84:87]
ds_read_b64_tr_b16 a[96:97], v12 offset:768
v_mfma_f32_16x16x32_bf16 v[84:87], a[108:111], a[60:63], v[84:87]
ds_read_b64_tr_b16 a[98:99], v12 offset:1792
v_mfma_f32_16x16x32_bf16 v[76:79], a[108:111], a[56:59], v[76:79]
ds_read_b64_tr_b16 a[100:101], v12 offset:8960
s_add_u32 m0, s17, 0xcc00
v_mfma_f32_16x16x32_bf16 v[76:79], a[104:107], a[40:43], v[76:79]
buffer_load_dwordx4 v6, s[60:63], s13 offen lds
v_mfma_f32_16x16x32_bf16 v[68:71], a[104:107], a[36:39], v[68:71]
ds_read_b64_tr_b16 a[102:103], v12 offset:9984
v_lshl_add_u32 v5, s42, 19, v5
v_mfma_f32_16x16x32_bf16 v[68:71], a[108:111], a[52:55], v[68:71]
v_lshl_add_u32 v6, s42, 19, v6
v_mfma_f32_16x16x32_bf16 v[60:63], a[108:111], a[48:51], v[60:63]
v_mfma_f32_16x16x32_bf16 v[60:63], a[104:107], a[32:35], v[60:63]
s_waitcnt lgkmcnt(6)
v_mfma_f32_16x16x32_bf16 v[88:91], a[80:83], a[32:35], v[88:91]
ds_read_b64_tr_b16 a[104:105], v13 offset:768
v_mfma_f32_16x16x32_bf16 v[88:91], a[84:87], a[48:51], v[88:91]
ds_read_b64_tr_b16 a[106:107], v13 offset:1792
s_mov_b32 s9, 0x200000
v_mfma_f32_16x16x32_bf16 v[96:99], a[84:87], a[52:55], v[96:99]
buffer_load_dword a120, v18, s[52:55], s9 offen
v_mfma_f32_16x16x32_bf16 v[96:99], a[80:83], a[36:39], v[96:99]
ds_read_b64_tr_b16 a[108:109], v13 offset:8960
v_mfma_f32_16x16x32_bf16 v[104:107], a[80:83], a[40:43], v[104:107]
ds_read_b64_tr_b16 a[110:111], v13 offset:9984
v_mfma_f32_16x16x32_bf16 v[104:107], a[84:87], a[56:59], v[104:107]
v_mfma_f32_16x16x32_bf16 v[112:115], a[84:87], a[60:63], v[112:115]
v_mfma_f32_16x16x32_bf16 v[112:115], a[80:83], a[44:47], v[112:115]
s_waitcnt lgkmcnt(8)
v_mfma_f32_16x16x32_bf16 v[116:119], a[88:91], a[44:47], v[116:119]
ds_read_b64_tr_b16 a[80:81], v12 offset:16384
s_add_u32 m0, s16, 0x0
v_mfma_f32_16x16x32_bf16 v[116:119], a[92:95], a[60:63], v[116:119]
buffer_load_dwordx4 v22, s[44:47], s20 offen lds
v_mfma_f32_16x16x32_bf16 v[108:111], a[92:95], a[56:59], v[108:111]
ds_read_b64_tr_b16 a[82:83], v12 offset:17408
v_mfma_f32_16x16x32_bf16 v[108:111], a[88:91], a[40:43], v[108:111]
ds_read_b64_tr_b16 a[84:85], v12 offset:24576
v_mfma_f32_16x16x32_bf16 v[100:103], a[88:91], a[36:39], v[100:103]
ds_read_b64_tr_b16 a[86:87], v12 offset:25600
v_mfma_f32_16x16x32_bf16 v[100:103], a[92:95], a[52:55], v[100:103]
v_mfma_f32_16x16x32_bf16 v[92:95], a[92:95], a[48:51], v[92:95]
v_mfma_f32_16x16x32_bf16 v[92:95], a[88:91], a[32:35], v[92:95]
s_add_u32 m0, s16, 0x400
s_waitcnt lgkmcnt(4)
v_mfma_f32_16x16x32_bf16 v[120:123], a[96:99], a[32:35], v[120:123]
buffer_load_dwordx4 v23, s[44:47], s20 offen lds
v_mfma_f32_16x16x32_bf16 v[120:123], a[100:103], a[48:51], v[120:123]
ds_read_b64_tr_b16 a[88:89], v13 offset:16384
v_mfma_f32_16x16x32_bf16 v[128:131], a[100:103], a[52:55], v[128:131]
ds_read_b64_tr_b16 a[90:91], v13 offset:17408
v_mfma_f32_16x16x32_bf16 v[128:131], a[96:99], a[36:39], v[128:131]
ds_read_b64_tr_b16 a[92:93], v13 offset:24576
v_mfma_f32_16x16x32_bf16 v[136:139], a[96:99], a[40:43], v[136:139]
ds_read_b64_tr_b16 a[94:95], v13 offset:25600
v_mfma_f32_16x16x32_bf16 v[136:139], a[100:103], a[56:59], v[136:139]
v_mfma_f32_16x16x32_bf16 v[144:147], a[100:103], a[60:63], v[144:147]
s_add_u32 m0, s16, 0x800
v_mfma_f32_16x16x32_bf16 v[144:147], a[96:99], a[44:47], v[144:147]
buffer_load_dwordx4 v22, s[44:47], s21 offen lds
v_mfma_f32_16x16x32_bf16 v[148:151], a[104:107], a[44:47], v[148:151]
ds_read_b64_tr_b16 a[96:97], v12 offset:16640
v_mfma_f32_16x16x32_bf16 v[148:151], a[108:111], a[60:63], v[148:151]
ds_read_b64_tr_b16 a[98:99], v12 offset:17664
v_mfma_f32_16x16x32_bf16 v[140:143], a[108:111], a[56:59], v[140:143]
ds_read_b64_tr_b16 a[100:101], v12 offset:24832
v_mfma_f32_16x16x32_bf16 v[140:143], a[104:107], a[40:43], v[140:143]
ds_read_b64_tr_b16 a[102:103], v12 offset:25856
v_mfma_f32_16x16x32_bf16 v[132:135], a[104:107], a[36:39], v[132:135]
v_mfma_f32_16x16x32_bf16 v[132:135], a[108:111], a[52:55], v[132:135]
s_add_u32 m0, s16, 0xc00
v_mfma_f32_16x16x32_bf16 v[124:127], a[108:111], a[48:51], v[124:127]
buffer_load_dwordx4 v23, s[44:47], s21 offen lds
v_mfma_f32_16x16x32_bf16 v[124:127], a[104:107], a[32:35], v[124:127]
s_waitcnt lgkmcnt(4)
v_mfma_f32_16x16x32_bf16 v[152:155], a[32:35], a[80:83], v[152:155]
ds_read_b64_tr_b16 a[104:105], v13 offset:16640
v_mfma_f32_16x16x32_bf16 v[152:155], a[48:51], a[84:87], v[152:155]
ds_read_b64_tr_b16 a[106:107], v13 offset:17664
v_mfma_f32_16x16x32_bf16 v[156:159], a[52:55], a[84:87], v[156:159]
ds_read_b64_tr_b16 a[108:109], v13 offset:24832
v_mfma_f32_16x16x32_bf16 v[156:159], a[36:39], a[80:83], v[156:159]
ds_read_b64_tr_b16 a[110:111], v13 offset:25856
v_mfma_f32_16x16x32_bf16 v[160:163], a[40:43], a[80:83], v[160:163]
s_add_u32 m0, s16, 0x1000
v_mfma_f32_16x16x32_bf16 v[160:163], a[56:59], a[84:87], v[160:163]
buffer_load_dwordx4 v22, s[44:47], s22 offen lds
v_mfma_f32_16x16x32_bf16 v[164:167], a[60:63], a[84:87], v[164:167]
v_mfma_f32_16x16x32_bf16 v[164:167], a[44:47], a[80:83], v[164:167]
v_mfma_f32_16x16x32_bf16 v[180:183], a[44:47], a[88:91], v[180:183]
ds_read_b64_tr_b16 a[80:81], v12 offset:16896
v_mfma_f32_16x16x32_bf16 v[180:183], a[60:63], a[92:95], v[180:183]
ds_read_b64_tr_b16 a[82:83], v12 offset:17920
v_mfma_f32_16x16x32_bf16 v[176:179], a[56:59], a[92:95], v[176:179]
ds_read_b64_tr_b16 a[84:85], v12 offset:25088
v_mfma_f32_16x16x32_bf16 v[176:179], a[40:43], a[88:91], v[176:179]
ds_read_b64_tr_b16 a[86:87], v12 offset:26112
s_add_u32 m0, s16, 0x1400
v_mfma_f32_16x16x32_bf16 v[172:175], a[36:39], a[88:91], v[172:175]
buffer_load_dwordx4 v23, s[44:47], s22 offen lds
v_mfma_f32_16x16x32_bf16 v[172:175], a[52:55], a[92:95], v[172:175]
v_mfma_f32_16x16x32_bf16 v[168:171], a[48:51], a[92:95], v[168:171]
v_mfma_f32_16x16x32_bf16 v[168:171], a[32:35], a[88:91], v[168:171]
s_waitcnt lgkmcnt(4)
v_mfma_f32_16x16x32_bf16 v[184:187], a[32:35], a[96:99], v[184:187]
ds_read_b64_tr_b16 a[88:89], v13 offset:16896
v_mfma_f32_16x16x32_bf16 v[184:187], a[48:51], a[100:103], v[184:187]
ds_read_b64_tr_b16 a[90:91], v13 offset:17920
v_mfma_f32_16x16x32_bf16 v[188:191], a[52:55], a[100:103], v[188:191]
ds_read_b64_tr_b16 a[92:93], v13 offset:25088
s_add_u32 m0, s16, 0x1800
v_mfma_f32_16x16x32_bf16 v[188:191], a[36:39], a[96:99], v[188:191]
buffer_load_dwordx4 v22, s[44:47], s23 offen lds
v_mfma_f32_16x16x32_bf16 v[192:195], a[40:43], a[96:99], v[192:195]
ds_read_b64_tr_b16 a[94:95], v13 offset:26112
v_mfma_f32_16x16x32_bf16 v[192:195], a[56:59], a[100:103], v[192:195]
v_mfma_f32_16x16x32_bf16 v[196:199], a[60:63], a[100:103], v[196:199]
v_mfma_f32_16x16x32_bf16 v[196:199], a[44:47], a[96:99], v[196:199]
v_mfma_f32_16x16x32_bf16 v[212:215], a[44:47], a[104:107], v[212:215]
ds_read_b64_tr_b16 a[96:97], v12 offset:17152
v_mfma_f32_16x16x32_bf16 v[212:215], a[60:63], a[108:111], v[212:215]
ds_read_b64_tr_b16 a[98:99], v12 offset:18176
s_add_u32 m0, s16, 0x1c00
v_mfma_f32_16x16x32_bf16 v[208:211], a[56:59], a[108:111], v[208:211]
buffer_load_dwordx4 v23, s[44:47], s23 offen lds
v_mfma_f32_16x16x32_bf16 v[208:211], a[40:43], a[104:107], v[208:211]
ds_read_b64_tr_b16 a[100:101], v12 offset:25344
s_mov_b32 s42, 1
v_mfma_f32_16x16x32_bf16 v[204:207], a[36:39], a[104:107], v[204:207]
ds_read_b64_tr_b16 a[102:103], v12 offset:26368
v_lshl_add_u32 v22, s42, 7, v22
v_mfma_f32_16x16x32_bf16 v[204:207], a[52:55], a[108:111], v[204:207]
v_lshl_add_u32 v23, s42, 7, v23
v_mfma_f32_16x16x32_bf16 v[200:203], a[48:51], a[108:111], v[200:203]
v_mfma_f32_16x16x32_bf16 v[200:203], a[32:35], a[104:107], v[200:203]
s_waitcnt lgkmcnt(4)
v_mfma_f32_16x16x32_bf16 v[216:219], a[32:35], a[80:83], v[216:219]
ds_read_b64_tr_b16 a[104:105], v13 offset:17152
s_mov_b32 s9, 0x200000
v_mfma_f32_16x16x32_bf16 v[216:219], a[48:51], a[84:87], v[216:219]
buffer_load_dword a120, v19, s[68:71], s9 offen
v_mfma_f32_16x16x32_bf16 v[220:223], a[52:55], a[84:87], v[220:223]
ds_read_b64_tr_b16 a[106:107], v13 offset:18176
v_mfma_f32_16x16x32_bf16 v[220:223], a[36:39], a[80:83], v[220:223]
ds_read_b64_tr_b16 a[108:109], v13 offset:25344
v_mfma_f32_16x16x32_bf16 v[224:227], a[40:43], a[80:83], v[224:227]
ds_read_b64_tr_b16 a[110:111], v13 offset:26368
v_add_u32 v12, 0xffff0000, v12
v_mfma_f32_16x16x32_bf16 v[224:227], a[56:59], a[84:87], v[224:227]
v_add_u32 v13, 0xffff0000, v13
v_mfma_f32_16x16x32_bf16 v[228:231], a[60:63], a[84:87], v[228:231]
v_mfma_f32_16x16x32_bf16 v[228:231], a[44:47], a[80:83], v[228:231]
v_mfma_f32_16x16x32_bf16 v[244:247], a[44:47], a[88:91], v[244:247]
s_waitcnt vmcnt(27) lgkmcnt(0)
v_mfma_f32_16x16x32_bf16 v[244:247], a[60:63], a[92:95], v[244:247]
s_barrier
s_add_u32 m0, s17, 0x10000
v_mfma_f32_16x16x32_bf16 v[240:243], a[56:59], a[92:95], v[240:243]
buffer_load_dwordx4 v5, s[52:55], 0 offen lds
v_mfma_f32_16x16x32_bf16 v[240:243], a[40:43], a[88:91], v[240:243]
ds_read_b64_tr_b16 a[80:81], v12 offset:0
s_mul_i32 s28, s5, 0x10c400
v_mfma_f32_16x16x32_bf16 v[236:239], a[36:39], a[88:91], v[236:239]
ds_read_b64_tr_b16 a[82:83], v12 offset:1024
s_mov_b32 s48, s88
v_mfma_f32_16x16x32_bf16 v[236:239], a[52:55], a[92:95], v[236:239]
ds_read_b64_tr_b16 a[84:85], v12 offset:8192
s_mov_b32 s49, s89
v_mfma_f32_16x16x32_bf16 v[232:235], a[48:51], a[92:95], v[232:235]
ds_read_b64_tr_b16 a[86:87], v12 offset:9216
s_sub_u32 s11, 16, s6
v_mfma_f32_16x16x32_bf16 v[232:235], a[32:35], a[88:91], v[232:235]
s_waitcnt lgkmcnt(4)
s_lshl_b32 s11, s11, 16
s_add_u32 s11, s11, s28
v_mfma_f32_16x16x32_bf16 v[248:251], a[32:35], a[96:99], v[248:251]
ds_read_b64_tr_b16 a[88:89], v13 offset:0
s_add_u32 m0, s17, 0x10400
v_mfma_f32_16x16x32_bf16 v[248:251], a[48:51], a[100:103], v[248:251]
buffer_load_dwordx4 v5, s[52:55], s13 offen lds
v_mfma_f32_16x16x32_bf16 v[252:255], a[52:55], a[100:103], v[252:255]
ds_read_b64_tr_b16 a[90:91], v13 offset:1024
s_add_u32 s50, s11, 0x2000
v_mfma_f32_16x16x32_bf16 v[252:255], a[36:39], a[96:99], v[252:255]
ds_read_b64_tr_b16 a[92:93], v13 offset:8192
s_lshl_b32 s11, s6, 17
v_mfma_f32_16x16x32_bf16 a[232:235], a[40:43], a[96:99], a[232:235]
ds_read_b64_tr_b16 a[94:95], v13 offset:9216
s_add_u32 s28, s28, s11
v_mfma_f32_16x16x32_bf16 a[232:235], a[56:59], a[100:103], a[232:235]
s_lshl_b32 s11, s4, 15
s_add_u32 s28, s28, s11
s_lshl_b32 s10, s5, 2
v_mfma_f32_16x16x32_bf16 a[236:239], a[60:63], a[100:103], a[236:239]
s_add_u32 s10, s10, 64
v_mfma_f32_16x16x32_bf16 a[236:239], a[44:47], a[96:99], a[236:239]
s_add_u32 m0, s17, 0x10800
v_mfma_f32_16x16x32_bf16 a[252:255], a[44:47], a[104:107], a[252:255]
buffer_load_dwordx4 v6, s[52:55], 0 offen lds
v_mfma_f32_16x16x32_bf16 a[252:255], a[60:63], a[108:111], a[252:255]
ds_read_b64_tr_b16 a[96:97], v12 offset:256
L_padA3:
s_cmp_eq_u32 s95, 1
s_cbranch_scc1 L_padA7
v_mfma_f32_16x16x32_bf16 a[248:251], a[56:59], a[108:111], a[248:251]
ds_read_b64_tr_b16 a[98:99], v12 offset:1280
v_mfma_f32_16x16x32_bf16 a[248:251], a[40:43], a[104:107], a[248:251]
ds_read_b64_tr_b16 a[100:101], v12 offset:8448
v_mfma_f32_16x16x32_bf16 a[244:247], a[36:39], a[104:107], a[244:247]
ds_read_b64_tr_b16 a[102:103], v12 offset:9472
v_mfma_f32_16x16x32_bf16 a[244:247], a[52:55], a[108:111], a[244:247]
v_mfma_f32_16x16x32_bf16 a[240:243], a[48:51], a[108:111], a[240:243]
v_mfma_f32_16x16x32_bf16 a[240:243], a[32:35], a[104:107], a[240:243]
s_add_u32 m0, s17, 0x10c00
s_waitcnt lgkmcnt(4)
L_S6:
v_mfma_f32_16x16x32_bf16 v[24:27], a[80:83], a[0:3], v[24:27]
buffer_load_dwordx4 v6, s[52:55], s13 offen lds
v_mfma_f32_16x16x32_bf16 v[24:27], a[84:87], a[16:19], v[24:27]
ds_read_b64_tr_b16 a[104:105], v13 offset:256
s_waitcnt vmcnt(23)
v_mfma_f32_16x16x32_bf16 v[32:35], a[84:87], a[20:23], v[32:35]
ds_read_b64_tr_b16 a[106:107], v13 offset:1280
v_mfma_f32_16x16x32_bf16 v[32:35], a[80:83], a[4:7], v[32:35]
ds_read_b64_tr_b16 a[108:109], v13 offset:8448
v_mfma_f32_16x16x32_bf16 v[40:43], a[80:83], a[8:11], v[40:43]
ds_read_b64_tr_b16 a[110:111], v13 offset:9472
v_mfma_f32_16x16x32_bf16 v[40:43], a[84:87], a[24:27], v[40:43]
ds_read_b128 a[32:35], v8 offset:32768
v_mfma_f32_16x16x32_bf16 v[48:51], a[84:87], a[28:31], v[48:51]
ds_read_b128 a[48:51], v9 offset:32768
s_add_u32 m0, s18, 0x14000
v_mfma_f32_16x16x32_bf16 v[48:51], a[80:83], a[12:15], v[48:51]
buffer_load_dwordx4 v7, s[68:71], 0 offen lds
v_mfma_f32_16x16x32_bf16 v[52:55], a[88:91], a[12:15], v[52:55]
ds_read_b64_tr_b16 a[80:81], v12 offset:512
v_mfma_f32_16x16x32_bf16 v[52:55], a[92:95], a[28:31], v[52:55]
ds_read_b64_tr_b16 a[82:83], v12 offset:1536
v_mfma_f32_16x16x32_bf16 v[44:47], a[92:95], a[24:27], v[44:47]
ds_read_b64_tr_b16 a[84:85], v12 offset:8704
v_mfma_f32_16x16x32_bf16 v[44:47], a[88:91], a[8:11], v[44:47]
ds_read_b64_tr_b16 a[86:87], v12 offset:9728
v_mfma_f32_16x16x32_bf16 v[36:39], a[88:91], a[4:7], v[36:39]
ds_read_b128 a[36:39], v8 offset:34816
v_mfma_f32_16x16x32_bf16 v[36:39], a[92:95], a[20:23], v[36:39]
ds_read_b128 a[52:55], v9 offset:34816
s_waitcnt lgkmcnt(8)
v_mfma_f32_16x16x32_bf16 v[28:31], a[92:95], a[16:19], v[28:31]
ds_read_b128 a[40:43], v8 offset:36864
s_add_u32 m0, s18, 0x15000
v_mfma_f32_16x16x32_bf16 v[28:31], a[88:91], a[0:3], v[28:31]
buffer_load_dwordx4 v7, s[68:71], s25 offen lds
v_mfma_f32_16x16x32_bf16 v[56:59], a[96:99], a[0:3], v[56:59]
ds_read_b64_tr_b16 a[88:89], v13 offset:512
v_mfma_f32_16x16x32_bf16 v[56:59], a[100:103], a[16:19], v[56:59]
ds_read_b64_tr_b16 a[90:91], v13 offset:1536
v_mfma_f32_16x16x32_bf16 v[64:67], a[100:103], a[20:23], v[64:67]
ds_read_b64_tr_b16 a[92:93], v13 offset:8704
v_mfma_f32_16x16x32_bf16 v[64:67], a[96:99], a[4:7], v[64:67]
ds_read_b64_tr_b16 a[94:95], v13 offset:9728
v_mfma_f32_16x16x32_bf16 v[72:75], a[96:99], a[8:11], v[72:75]
ds_read_b128 a[56:59], v9 offset:36864
v_mfma_f32_16x16x32_bf16 v[72:75], a[100:103], a[24:27], v[72:75]
ds_read_b128 a[44:47], v8 offset:38912
s_add_u32 m0, s18, 0x16000
v_mfma_f32_16x16x32_bf16 v[80:83], a[100:103], a[28:31], v[80:83]
buffer_load_dwordx4 v7, s[68:71], s26 offen lds
v_mfma_f32_16x16x32_bf16 v[80:83], a[96:99], a[12:15], v[80:83]
ds_read_b128 a[60:63], v9 offset:38912
v_lshl_add_u32 v5, s42, 19, v5
v_mfma_f32_16x16x32_bf16 v[84:87], a[104:107], a[12:15], v[84:87]
ds_read_b64_tr_b16 a[96:97], v12 offset:768
v_lshl_add_u32 v6, s42, 19, v6
v_mfma_f32_16x16x32_bf16 v[84:87], a[108:111], a[28:31], v[84:87]
ds_read_b64_tr_b16 a[98:99], v12 offset:1792
v_lshl_add_u32 v7, s42, 18, v7
v_mfma_f32_16x16x32_bf16 v[76:79], a[108:111], a[24:27], v[76:79]
ds_read_b64_tr_b16 a[100:101], v12 offset:8960
v_lshl_add_u32 v7, s42, 17, v7
v_mfma_f32_16x16x32_bf16 v[76:79], a[104:107], a[8:11], v[76:79]
ds_read_b64_tr_b16 a[102:103], v12 offset:9984
v_mfma_f32_16x16x32_bf16 v[68:71], a[104:107], a[4:7], v[68:71]
v_mfma_f32_16x16x32_bf16 v[68:71], a[108:111], a[20:23], v[68:71]
buffer_store_dwordx4 a[64:67], v4, s[88:91], 0 offen sc1
v_mfma_f32_16x16x32_bf16 v[60:63], a[108:111], a[16:19], v[60:63]
v_mfma_f32_16x16x32_bf16 v[60:63], a[104:107], a[0:3], v[60:63]
s_waitcnt lgkmcnt(7)
v_mfma_f32_16x16x32_bf16 v[88:91], a[80:83], a[0:3], v[88:91]
ds_read_b64_tr_b16 a[104:105], v13 offset:768
v_mfma_f32_16x16x32_bf16 v[88:91], a[84:87], a[16:19], v[88:91]
ds_read_b64_tr_b16 a[106:107], v13 offset:1792
v_mfma_f32_16x16x32_bf16 v[96:99], a[84:87], a[20:23], v[96:99]
ds_read_b64_tr_b16 a[108:109], v13 offset:8960
v_mfma_f32_16x16x32_bf16 v[96:99], a[80:83], a[4:7], v[96:99]
ds_read_b64_tr_b16 a[110:111], v13 offset:9984
v_mfma_f32_16x16x32_bf16 v[104:107], a[80:83], a[8:11], v[104:107]
s_add_u32 m0, s16, 0x8000
s_waitcnt lgkmcnt(8)
v_mfma_f32_16x16x32_bf16 v[104:107], a[84:87], a[24:27], v[104:107]
buffer_load_dwordx4 v22, s[44:47], s20 offen lds
v_mfma_f32_16x16x32_bf16 v[112:115], a[84:87], a[28:31], v[112:115]
v_mfma_f32_16x16x32_bf16 v[112:115], a[80:83], a[12:15], v[112:115]
v_mfma_f32_16x16x32_bf16 v[116:119], a[88:91], a[12:15], v[116:119]
ds_read_b64_tr_b16 a[80:81], v12 offset:16384
v_mfma_f32_16x16x32_bf16 v[116:119], a[92:95], a[28:31], v[116:119]
ds_read_b64_tr_b16 a[82:83], v12 offset:17408
v_mfma_f32_16x16x32_bf16 v[108:111], a[92:95], a[24:27], v[108:111]
ds_read_b64_tr_b16 a[84:85], v12 offset:24576
v_mfma_f32_16x16x32_bf16 v[108:111], a[88:91], a[8:11], v[108:111]
ds_read_b64_tr_b16 a[86:87], v12 offset:25600
s_add_u32 m0, s16, 0x8400
v_mfma_f32_16x16x32_bf16 v[100:103], a[88:91], a[4:7], v[100:103]
buffer_load_dwordx4 v23, s[44:47], s20 offen lds
v_mfma_f32_16x16x32_bf16 v[100:103], a[92:95], a[20:23], v[100:103]
v_mfma_f32_16x16x32_bf16 v[92:95], a[92:95], a[16:19], v[92:95]
v_mfma_f32_16x16x32_bf16 v[92:95], a[88:91], a[0:3], v[92:95]
s_waitcnt lgkmcnt(4)
v_mfma_f32_16x16x32_bf16 v[120:123], a[96:99], a[0:3], v[120:123]
ds_read_b64_tr_b16 a[88:89], v13 offset:16384
v_mfma_f32_16x16x32_bf16 v[120:123], a[100:103], a[16:19], v[120:123]
ds_read_b64_tr_b16 a[90:91], v13 offset:17408
v_mfma_f32_16x16x32_bf16 v[128:131], a[100:103], a[20:23], v[128:131]
ds_read_b64_tr_b16 a[92:93], v13 offset:24576
v_mfma_f32_16x16x32_bf16 v[128:131], a[96:99], a[4:7], v[128:131]
ds_read_b64_tr_b16 a[94:95], v13 offset:25600
s_add_u32 m0, s16, 0x8800
v_mfma_f32_16x16x32_bf16 v[136:139], a[96:99], a[8:11], v[136:139]
buffer_load_dwordx4 v22, s[44:47], s21 offen lds
v_mfma_f32_16x16x32_bf16 v[136:139], a[100:103], a[24:27], v[136:139]
v_mfma_f32_16x16x32_bf16 v[144:147], a[100:103], a[28:31], v[144:147]
v_mfma_f32_16x16x32_bf16 v[144:147], a[96:99], a[12:15], v[144:147]
v_mfma_f32_16x16x32_bf16 v[148:151], a[104:107], a[12:15], v[148:151]
ds_read_b64_tr_b16 a[96:97], v12 offset:16640
v_mfma_f32_16x16x32_bf16 v[148:151], a[108:111], a[28:31], v[148:151]
ds_read_b64_tr_b16 a[98:99], v12 offset:17664
v_mfma_f32_16x16x32_bf16 v[140:143], a[108:111], a[24:27], v[140:143]
ds_read_b64_tr_b16 a[100:101], v12 offset:24832
s_add_u32 m0, s16, 0x8c00
v_mfma_f32_16x16x32_bf16 v[140:143], a[104:107], a[8:11], v[140:143]
buffer_load_dwordx4 v23, s[44:47], s21 offen lds
v_mfma_f32_16x16x32_bf16 v[132:135], a[104:107], a[4:7], v[132:135]
ds_read_b64_tr_b16 a[102:103], v12 offset:25856
v_mfma_f32_16x16x32_bf16 v[132:135], a[108:111], a[20:23], v[132:135]
v_mfma_f32_16x16x32_bf16 v[124:127], a[108:111], a[16:19], v[124:127]
v_mfma_f32_16x16x32_bf16 v[124:127], a[104:107], a[0:3], v[124:127]
s_waitcnt lgkmcnt(4)
v_mfma_f32_16x16x32_bf16 v[152:155], a[0:3], a[80:83], v[152:155]
ds_read_b64_tr_b16 a[104:105], v13 offset:16640
v_mfma_f32_16x16x32_bf16 v[152:155], a[16:19], a[84:87], v[152:155]
ds_read_b64_tr_b16 a[106:107], v13 offset:17664
s_add_u32 m0, s16, 0x9000
v_mfma_f32_16x16x32_bf16 v[156:159], a[20:23], a[84:87], v[156:159]
buffer_load_dwordx4 v22, s[44:47], s22 offen lds
v_mfma_f32_16x16x32_bf16 v[156:159], a[4:7], a[80:83], v[156:159]
ds_read_b64_tr_b16 a[108:109], v13 offset:24832
v_mfma_f32_16x16x32_bf16 v[160:163], a[8:11], a[80:83], v[160:163]
ds_read_b64_tr_b16 a[110:111], v13 offset:25856
v_mfma_f32_16x16x32_bf16 v[160:163], a[24:27], a[84:87], v[160:163]
v_mfma_f32_16x16x32_bf16 v[164:167], a[28:31], a[84:87], v[164:167]
v_mfma_f32_16x16x32_bf16 v[164:167], a[12:15], a[80:83], v[164:167]
v_mfma_f32_16x16x32_bf16 v[180:183], a[12:15], a[88:91], v[180:183]
ds_read_b64_tr_b16 a[80:81], v12 offset:16896
v_mfma_f32_16x16x32_bf16 v[180:183], a[28:31], a[92:95], v[180:183]
ds_read_b64_tr_b16 a[82:83], v12 offset:17920
s_add_u32 m0, s16, 0x9400
v_mfma_f32_16x16x32_bf16 v[176:179], a[24:27], a[92:95], v[176:179]
buffer_load_dwordx4 v23, s[44:47], s22 offen lds
v_mfma_f32_16x16x32_bf16 v[176:179], a[8:11], a[88:91], v[176:179]
ds_read_b64_tr_b16 a[84:85], v12 offset:25088
v_mfma_f32_16x16x32_bf16 v[172:175], a[4:7], a[88:91], v[172:175]
ds_read_b64_tr_b16 a[86:87], v12 offset:26112
v_mfma_f32_16x16x32_bf16 v[172:175], a[20:23], a[92:95], v[172:175]
v_mfma_f32_16x16x32_bf16 v[168:171], a[16:19], a[92:95], v[168:171]
v_mfma_f32_16x16x32_bf16 v[168:171], a[0:3], a[88:91], v[168:171]
s_waitcnt lgkmcnt(4)
v_mfma_f32_16x16x32_bf16 v[184:187], a[0:3], a[96:99], v[184:187]
ds_read_b64_tr_b16 a[88:89], v13 offset:16896
s_add_u32 m0, s16, 0x9800
v_mfma_f32_16x16x32_bf16 v[184:187], a[16:19], a[100:103], v[184:187]
buffer_load_dwordx4 v22, s[44:47], s23 offen lds
v_mfma_f32_16x16x32_bf16 v[188:191], a[20:23], a[100:103], v[188:191]
ds_read_b64_tr_b16 a[90:91], v13 offset:17920
v_mfma_f32_16x16x32_bf16 v[188:191], a[4:7], a[96:99], v[188:191]
ds_read_b64_tr_b16 a[92:93], v13 offset:25088
v_mfma_f32_16x16x32_bf16 v[192:195], a[8:11], a[96:99], v[192:195]
ds_read_b64_tr_b16 a[94:95], v13 offset:26112
v_mfma_f32_16x16x32_bf16 v[192:195], a[24:27], a[100:103], v[192:195]
v_mfma_f32_16x16x32_bf16 v[196:199], a[28:31], a[100:103], v[196:199]
v_mfma_f32_16x16x32_bf16 v[196:199], a[12:15], a[96:99], v[196:199]
v_mfma_f32_16x16x32_bf16 v[212:215], a[12:15], a[104:107], v[212:215]
ds_read_b64_tr_b16 a[96:97], v12 offset:17152
s_add_u32 m0, s16, 0x9c00
v_mfma_f32_16x16x32_bf16 v[212:215], a[28:31], a[108:111], v[212:215]
buffer_load_dwordx4 v23, s[44:47], s23 offen lds
v_mfma_f32_16x16x32_bf16 v[208:211], a[24:27], a[108:111], v[208:211]
ds_read_b64_tr_b16 a[98:99], v12 offset:18176
v_lshl_add_u32 v22, s42, 7, v22
v_mfma_f32_16x16x32_bf16 v[208:211], a[8:11], a[104:107], v[208:211]
ds_read_b64_tr_b16 a[100:101], v12 offset:25344
v_lshl_add_u32 v23, s42, 7, v23
v_mfma_f32_16x16x32_bf16 v[204:207], a[4:7], a[104:107], v[204:207]
ds_read_b64_tr_b16 a[102:103], v12 offset:26368
v_mfma_f32_16x16x32_bf16 v[204:207], a[20:23], a[108:111], v[204:207]
v_mfma_f32_16x16x32_bf16 v[200:203], a[16:19], a[108:111], v[200:203]
v_mfma_f32_16x16x32_bf16 v[200:203], a[0:3], a[104:107], v[200:203]
s_mov_b32 s9, 0x400000
s_waitcnt lgkmcnt(4)
v_mfma_f32_16x16x32_bf16 v[216:219], a[0:3], a[80:83], v[216:219]
buffer_load_dword a120, v18, s[52:55], s9 offen
v_mfma_f32_16x16x32_bf16 v[216:219], a[16:19], a[84:87], v[216:219]
ds_read_b64_tr_b16 a[104:105], v13 offset:17152
v_mfma_f32_16x16x32_bf16 v[220:223], a[20:23], a[84:87], v[220:223]
ds_read_b64_tr_b16 a[106:107], v13 offset:18176
v_mfma_f32_16x16x32_bf16 v[220:223], a[4:7], a[80:83], v[220:223]
ds_read_b64_tr_b16 a[108:109], v13 offset:25344
v_mfma_f32_16x16x32_bf16 v[224:227], a[8:11], a[80:83], v[224:227]
ds_read_b64_tr_b16 a[110:111], v13 offset:26368
v_add_u32 v12, 0x8000, v12
v_mfma_f32_16x16x32_bf16 v[224:227], a[24:27], a[84:87], v[224:227]
v_add_u32 v13, 0x8000, v13
v_mfma_f32_16x16x32_bf16 v[228:231], a[28:31], a[84:87], v[228:231]
v_mfma_f32_16x16x32_bf16 v[228:231], a[12:15], a[80:83], v[228:231]
v_mfma_f32_16x16x32_bf16 v[244:247], a[12:15], a[88:91], v[244:247]
s_waitcnt vmcnt(27) lgkmcnt(0)
v_mfma_f32_16x16x32_bf16 v[244:247], a[28:31], a[92:95], v[244:247]
s_barrier
s_add_u32 m0, s17, 0x0
v_mfma_f32_16x16x32_bf16 v[240:243], a[24:27], a[92:95], v[240:243]
buffer_load_dwordx4 v5, s[52:55], 0 offen lds
v_mfma_f32_16x16x32_bf16 v[240:243], a[8:11], a[88:91], v[240:243]
ds_read_b64_tr_b16 a[80:81], v12 offset:0
v_mfma_f32_16x16x32_bf16 v[236:239], a[4:7], a[88:91], v[236:239]
ds_read_b64_tr_b16 a[82:83], v12 offset:1024
v_mfma_f32_16x16x32_bf16 v[236:239], a[20:23], a[92:95], v[236:239]
ds_read_b64_tr_b16 a[84:85], v12 offset:8192
v_mfma_f32_16x16x32_bf16 v[232:235], a[16:19], a[92:95], v[232:235]
ds_read_b64_tr_b16 a[86:87], v12 offset:9216
v_mfma_f32_16x16x32_bf16 v[232:235], a[0:3], a[88:91], v[232:235]
s_waitcnt lgkmcnt(4)
v_mfma_f32_16x16x32_bf16 v[248:251], a[0:3], a[96:99], v[248:251]
ds_read_b64_tr_b16 a[88:89], v13 offset:0
s_add_u32 m0, s17, 0x400
v_mfma_f32_16x16x32_bf16 v[248:251], a[16:19], a[100:103], v[248:251]
buffer_load_dwordx4 v5, s[52:55], s13 offen lds
v_mfma_f32_16x16x32_bf16 v[252:255], a[20:23], a[100:103], v[252:255]
ds_read_b64_tr_b16 a[90:91], v13 offset:1024
v_mfma_f32_16x16x32_bf16 v[252:255], a[4:7], a[96:99], v[252:255]
ds_read_b64_tr_b16 a[92:93], v13 offset:8192
v_mfma_f32_16x16x32_bf16 a[232:235], a[8:11], a[96:99], a[232:235]
ds_read_b64_tr_b16 a[94:95], v13 offset:9216
v_mfma_f32_16x16x32_bf16 a[232:235], a[24:27], a[100:103], a[232:235]
v_mfma_f32_16x16x32_bf16 a[236:239], a[28:31], a[100:103], a[236:239]
v_mfma_f32_16x16x32_bf16 a[236:239], a[12:15], a[96:99], a[236:239]
s_add_u32 m0, s17, 0x800
v_mfma_f32_16x16x32_bf16 a[252:255], a[12:15], a[104:107], a[252:255]
buffer_load_dwordx4 v6, s[52:55], 0 offen lds
v_mfma_f32_16x16x32_bf16 a[252:255], a[28:31], a[108:111], a[252:255]
ds_read_b64_tr_b16 a[96:97], v12 offset:256
v_mfma_f32_16x16x32_bf16 a[248:251], a[24:27], a[108:111], a[248:251]
ds_read_b64_tr_b16 a[98:99], v12 offset:1280
v_mfma_f32_16x16x32_bf16 a[248:251], a[8:11], a[104:107], a[248:251]
ds_read_b64_tr_b16 a[100:101], v12 offset:8448
v_mfma_f32_16x16x32_bf16 a[244:247], a[4:7], a[104:107], a[244:247]
ds_read_b64_tr_b16 a[102:103], v12 offset:9472
v_mfma_f32_16x16x32_bf16 a[244:247], a[20:23], a[108:111], a[244:247]
v_mfma_f32_16x16x32_bf16 a[240:243], a[16:19], a[108:111], a[240:243]
v_mfma_f32_16x16x32_bf16 a[240:243], a[0:3], a[104:107], a[240:243]
s_add_u32 m0, s17, 0xc00
s_waitcnt lgkmcnt(4)
L_S7:
v_mfma_f32_16x16x32_bf16 v[24:27], a[80:83], a[32:35], v[24:27]
buffer_load_dwordx4 v6, s[52:55], s13 offen lds
v_mfma_f32_16x16x32_bf16 v[24:27], a[84:87], a[48:51], v[24:27]
ds_read_b64_tr_b16 a[104:105], v13 offset:256
s_waitcnt vmcnt(22)
v_mfma_f32_16x16x32_bf16 v[32:35], a[84:87], a[52:55], v[32:35]
ds_read_b64_tr_b16 a[106:107], v13 offset:1280
v_mfma_f32_16x16x32_bf16 v[32:35], a[80:83], a[36:39], v[32:35]
ds_read_b64_tr_b16 a[108:109], v13 offset:8448
v_mfma_f32_16x16x32_bf16 v[40:43], a[80:83], a[40:43], v[40:43]
ds_read_b64_tr_b16 a[110:111], v13 offset:9472
v_mfma_f32_16x16x32_bf16 v[40:43], a[84:87], a[56:59], v[40:43]
ds_read_b128 a[0:3], v8 offset:0
v_mfma_f32_16x16x32_bf16 v[48:51], a[84:87], a[60:63], v[48:51]
ds_read_b128 a[16:19], v9 offset:0
s_add_u32 m0, s18, 0x4000
v_mfma_f32_16x16x32_bf16 v[48:51], a[80:83], a[44:47], v[48:51]
buffer_load_dwordx4 v7, s[68:71], 0 offen lds
v_mfma_f32_16x16x32_bf16 v[52:55], a[88:91], a[44:47], v[52:55]
ds_read_b64_tr_b16 a[80:81], v12 offset:512
v_mfma_f32_16x16x32_bf16 v[52:55], a[92:95], a[60:63], v[52:55]
ds_read_b64_tr_b16 a[82:83], v12 offset:1536
v_mfma_f32_16x16x32_bf16 v[44:47], a[92:95], a[56:59], v[44:47]
ds_read_b64_tr_b16 a[84:85], v12 offset:8704
v_mfma_f32_16x16x32_bf16 v[44:47], a[88:91], a[40:43], v[44:47]
ds_read_b64_tr_b16 a[86:87], v12 offset:9728
v_mfma_f32_16x16x32_bf16 v[36:39], a[88:91], a[36:39], v[36:39]
ds_read_b128 a[4:7], v8 offset:2048
v_mfma_f32_16x16x32_bf16 v[36:39], a[92:95], a[52:55], v[36:39]
ds_read_b128 a[20:23], v9 offset:2048
s_waitcnt lgkmcnt(8)
v_mfma_f32_16x16x32_bf16 v[28:31], a[92:95], a[48:51], v[28:31]
ds_read_b128 a[8:11], v8 offset:4096
s_add_u32 m0, s18, 0x5000
v_mfma_f32_16x16x32_bf16 v[28:31], a[88:91], a[32:35], v[28:31]
buffer_load_dwordx4 v7, s[68:71], s25 offen lds
v_mfma_f32_16x16x32_bf16 v[56:59], a[96:99], a[32:35], v[56:59]
ds_read_b64_tr_b16 a[88:89], v13 offset:512
v_mfma_f32_16x16x32_bf16 v[56:59], a[100:103], a[48:51], v[56:59]
ds_read_b64_tr_b16 a[90:91], v13 offset:1536
v_mfma_f32_16x16x32_bf16 v[64:67], a[100:103], a[52:55], v[64:67]
ds_read_b64_tr_b16 a[92:93], v13 offset:8704
v_mfma_f32_16x16x32_bf16 v[64:67], a[96:99], a[36:39], v[64:67]
ds_read_b64_tr_b16 a[94:95], v13 offset:9728
v_cvt_pk_bf16_f32 v24, v24, v25
v_cvt_pk_bf16_f32 v25, v26, v27
v_mfma_f32_16x16x32_bf16 v[72:75], a[96:99], a[40:43], v[72:75]
ds_read_b128 a[24:27], v9 offset:4096
v_cvt_pk_bf16_f32 v26, v28, v29
v_mfma_f32_16x16x32_bf16 v[72:75], a[100:103], a[56:59], v[72:75]
ds_read_b128 a[12:15], v8 offset:6144
s_add_u32 m0, s18, 0x6000
v_mfma_f32_16x16x32_bf16 v[80:83], a[100:103], a[60:63], v[80:83]
buffer_load_dwordx4 v7, s[68:71], s26 offen lds
v_cvt_pk_bf16_f32 v27, v30, v31
v_mfma_f32_16x16x32_bf16 v[80:83], a[96:99], a[44:47], v[80:83]
ds_read_b128 a[28:31], v9 offset:6144
v_lshl_add_u32 v5, s42, 19, v5
v_mfma_f32_16x16x32_bf16 v[84:87], a[104:107], a[44:47], v[84:87]
ds_read_b64_tr_b16 a[96:97], v12 offset:768
v_lshl_add_u32 v6, s42, 19, v6
v_mfma_f32_16x16x32_bf16 v[84:87], a[108:111], a[60:63], v[84:87]
ds_read_b64_tr_b16 a[98:99], v12 offset:1792
v_lshl_add_u32 v7, s42, 18, v7
v_accvgpr_write_b32 a128, v24
v_mfma_f32_16x16x32_bf16 v[76:79], a[108:111], a[56:59], v[76:79]
ds_read_b64_tr_b16 a[100:101], v12 offset:8960
v_lshl_add_u32 v7, s42, 17, v7
v_mfma_f32_16x16x32_bf16 v[76:79], a[104:107], a[40:43], v[76:79]
ds_read_b64_tr_b16 a[102:103], v12 offset:9984
v_accvgpr_write_b32 a129, v25
v_mfma_f32_16x16x32_bf16 v[68:71], a[104:107], a[36:39], v[68:71]
s_mov_b32 s9, 0x400000
v_accvgpr_write_b32 a130, v26
v_accvgpr_write_b32 a131, v27
v_cvt_pk_bf16_f32 v32, v32, v33
v_mfma_f32_16x16x32_bf16 v[68:71], a[108:111], a[52:55], v[68:71]
buffer_load_dword a120, v19, s[68:71], s9 offen
v_mfma_f32_16x16x32_bf16 v[60:63], a[108:111], a[48:51], v[60:63]
v_cvt_pk_bf16_f32 v33, v34, v35
v_cvt_pk_bf16_f32 v34, v36, v37
v_mfma_f32_16x16x32_bf16 v[60:63], a[104:107], a[32:35], v[60:63]
s_waitcnt lgkmcnt(7)
v_cvt_pk_bf16_f32 v35, v38, v39
v_accvgpr_write_b32 a132, v32
v_accvgpr_write_b32 a133, v33
v_mfma_f32_16x16x32_bf16 v[88:91], a[80:83], a[32:35], v[88:91]
ds_read_b64_tr_b16 a[104:105], v13 offset:768
v_accvgpr_write_b32 a134, v34
v_mfma_f32_16x16x32_bf16 v[88:91], a[84:87], a[48:51], v[88:91]
ds_read_b64_tr_b16 a[106:107], v13 offset:1792
v_accvgpr_write_b32 a135, v35
v_mfma_f32_16x16x32_bf16 v[96:99], a[84:87], a[52:55], v[96:99]
ds_read_b64_tr_b16 a[108:109], v13 offset:8960
v_cvt_pk_bf16_f32 v40, v40, v41
v_cvt_pk_bf16_f32 v41, v42, v43
v_mfma_f32_16x16x32_bf16 v[96:99], a[80:83], a[36:39], v[96:99]
ds_read_b64_tr_b16 a[110:111], v13 offset:9984
v_cvt_pk_bf16_f32 v42, v44, v45
v_mfma_f32_16x16x32_bf16 v[104:107], a[80:83], a[40:43], v[104:107]
s_add_u32 m0, s16, 0x0
s_waitcnt lgkmcnt(8)
v_cvt_pk_bf16_f32 v43, v46, v47
v_mfma_f32_16x16x32_bf16 v[104:107], a[84:87], a[56:59], v[104:107]
buffer_load_dwordx4 v22, s[44:47], s20 offen lds
v_accvgpr_write_b32 a136, v40
v_mfma_f32_16x16x32_bf16 v[112:115], a[84:87], a[60:63], v[112:115]
v_accvgpr_write_b32 a137, v41
v_accvgpr_write_b32 a138, v42
v_mfma_f32_16x16x32_bf16 v[112:115], a[80:83], a[44:47], v[112:115]
v_accvgpr_write_b32 a139, v43
v_cvt_pk_bf16_f32 v48, v48, v49
v_mfma_f32_16x16x32_bf16 v[116:119], a[88:91], a[44:47], v[116:119]
ds_read_b64_tr_b16 a[80:81], v12 offset:16384
v_cvt_pk_bf16_f32 v49, v50, v51
v_cvt_pk_bf16_f32 v50, v52, v53
v_mfma_f32_16x16x32_bf16 v[116:119], a[92:95], a[60:63], v[116:119]
ds_read_b64_tr_b16 a[82:83], v12 offset:17408
v_cvt_pk_bf16_f32 v51, v54, v55
v_mfma_f32_16x16x32_bf16 v[108:111], a[92:95], a[56:59], v[108:111]
ds_read_b64_tr_b16 a[84:85], v12 offset:24576
v_accvgpr_write_b32 a140, v48
v_mfma_f32_16x16x32_bf16 v[108:111], a[88:91], a[40:43], v[108:111]
ds_read_b64_tr_b16 a[86:87], v12 offset:25600
s_add_u32 m0, s16, 0x400
v_accvgpr_write_b32 a141, v49
v_mfma_f32_16x16x32_bf16 v[100:103], a[88:91], a[36:39], v[100:103]
buffer_load_dwordx4 v23, s[44:47], s20 offen lds
v_mfma_f32_16x16x32_bf16 v[100:103], a[92:95], a[52:55], v[100:103]
v_accvgpr_write_b32 a142, v50
v_accvgpr_write_b32 a143, v51
v_mfma_f32_16x16x32_bf16 v[92:95], a[92:95], a[48:51], v[92:95]
v_cvt_pk_bf16_f32 v56, v56, v57
v_cvt_pk_bf16_f32 v57, v58, v59
v_cvt_pk_bf16_f32 v58, v60, v61
v_mfma_f32_16x16x32_bf16 v[92:95], a[88:91], a[32:35], v[92:95]
s_waitcnt lgkmcnt(4)
v_cvt_pk_bf16_f32 v59, v62, v63
v_accvgpr_write_b32 a144, v56
v_mfma_f32_16x16x32_bf16 v[120:123], a[96:99], a[32:35], v[120:123]
ds_read_b64_tr_b16 a[88:89], v13 offset:16384
v_accvgpr_write_b32 a145, v57
v_mfma_f32_16x16x32_bf16 v[120:123], a[100:103], a[48:51], v[120:123]
ds_read_b64_tr_b16 a[90:91], v13 offset:17408
v_accvgpr_write_b32 a146, v58
v_accvgpr_write_b32 a147, v59
v_mfma_f32_16x16x32_bf16 v[128:131], a[100:103], a[52:55], v[128:131]
ds_read_b64_tr_b16 a[92:93], v13 offset:24576
v_cvt_pk_bf16_f32 v64, v64, v65
v_mfma_f32_16x16x32_bf16 v[128:131], a[96:99], a[36:39], v[128:131]
ds_read_b64_tr_b16 a[94:95], v13 offset:25600
s_add_u32 m0, s16, 0x800
v_mfma_f32_16x16x32_bf16 v[136:139], a[96:99], a[40:43], v[136:139]
buffer_load_dwordx4 v22, s[44:47], s21 offen lds
v_cvt_pk_bf16_f32 v65, v66, v67
v_mfma_f32_16x16x32_bf16 v[136:139], a[100:103], a[56:59], v[136:139]
v_cvt_pk_bf16_f32 v66, v68, v69
v_cvt_pk_bf16_f32 v67, v70, v71
v_mfma_f32_16x16x32_bf16 v[144:147], a[100:103], a[60:63], v[144:147]
v_accvgpr_write_b32 a148, v64
v_accvgpr_write_b32 a149, v65
v_mfma_f32_16x16x32_bf16 v[144:147], a[96:99], a[44:47], v[144:147]
v_accvgpr_write_b32 a150, v66
v_accvgpr_write_b32 a151, v67
v_cvt_pk_bf16_f32 v72, v72, v73
v_mfma_f32_16x16x32_bf16 v[148:151], a[104:107], a[44:47], v[148:151]
ds_read_b64_tr_b16 a[96:97], v12 offset:16640
v_cvt_pk_bf16_f32 v73, v74, v75
v_mfma_f32_16x16x32_bf16 v[148:151], a[108:111], a[60:63], v[148:151]
ds_read_b64_tr_b16 a[98:99], v12 offset:17664
v_cvt_pk_bf16_f32 v74, v76, v77
v_mfma_f32_16x16x32_bf16 v[140:143], a[108:111], a[56:59], v[140:143]
ds_read_b64_tr_b16 a[100:101], v12 offset:24832
s_add_u32 m0, s16, 0xc00
v_cvt_pk_bf16_f32 v75, v78, v79
v_mfma_f32_16x16x32_bf16 v[140:143], a[104:107], a[40:43], v[140:143]
buffer_load_dwordx4 v23, s[44:47], s21 offen lds
v_mfma_f32_16x16x32_bf16 v[132:135], a[104:107], a[36:39], v[132:135]
ds_read_b64_tr_b16 a[102:103], v12 offset:25856
v_accvgpr_write_b32 a152, v72
v_mfma_f32_16x16x32_bf16 v[132:135], a[108:111], a[52:55], v[132:135]
v_accvgpr_write_b32 a153, v73
v_accvgpr_write_b32 a154, v74
v_accvgpr_write_b32 a155, v75
v_mfma_f32_16x16x32_bf16 v[124:127], a[108:111], a[48:51], v[124:127]
v_cvt_pk_bf16_f32 v80, v80, v81
v_cvt_pk_bf16_f32 v81, v82, v83
v_mfma_f32_16x16x32_bf16 v[124:127], a[104:107], a[32:35], v[124:127]
s_waitcnt lgkmcnt(4)
v_cvt_pk_bf16_f32 v82, v84, v85
v_cvt_pk_bf16_f32 v83, v86, v87
v_mfma_f32_16x16x32_bf16 v[152:155], a[32:35], a[80:83], v[152:155]
ds_read_b64_tr_b16 a[104:105], v13 offset:16640
v_accvgpr_write_b32 a156, v80
v_accvgpr_write_b32 a157, v81
v_mfma_f32_16x16x32_bf16 v[152:155], a[48:51], a[84:87], v[152:155]
ds_read_b64_tr_b16 a[106:107], v13 offset:17664
s_add_u32 m0, s16, 0x1000
v_mfma_f32_16x16x32_bf16 v[156:159], a[52:55], a[84:87], v[156:159]
buffer_load_dwordx4 v22, s[44:47], s22 offen lds
v_mfma_f32_16x16x32_bf16 v[156:159], a[36:39], a[80:83], v[156:159]
ds_read_b64_tr_b16 a[108:109], v13 offset:24832
v_accvgpr_write_b32 a158, v82
v_accvgpr_write_b32 a159, v83
v_mfma_f32_16x16x32_bf16 v[160:163], a[40:43], a[80:83], v[160:163]
ds_read_b64_tr_b16 a[110:111], v13 offset:25856
v_cvt_pk_bf16_f32 v88, v88, v89
v_mfma_f32_16x16x32_bf16 v[160:163], a[56:59], a[84:87], v[160:163]
v_cvt_pk_bf16_f32 v89, v90, v91
v_cvt_pk_bf16_f32 v90, v92, v93
v_mfma_f32_16x16x32_bf16 v[164:167], a[60:63], a[84:87], v[164:167]
v_cvt_pk_bf16_f32 v91, v94, v95
v_accvgpr_write_b32 a160, v88
v_accvgpr_write_b32 a161, v89
v_mfma_f32_16x16x32_bf16 v[164:167], a[44:47], a[80:83], v[164:167]
v_accvgpr_write_b32 a162, v90
v_accvgpr_write_b32 a163, v91
v_mfma_f32_16x16x32_bf16 v[180:183], a[44:47], a[88:91], v[180:183]
ds_read_b64_tr_b16 a[80:81], v12 offset:16896
v_cvt_pk_bf16_f32 v96, v96, v97
v_mfma_f32_16x16x32_bf16 v[180:183], a[60:63], a[92:95], v[180:183]
ds_read_b64_tr_b16 a[82:83], v12 offset:17920
s_add_u32 m0, s16, 0x1400
v_cvt_pk_bf16_f32 v97, v98, v99
v_mfma_f32_16x16x32_bf16 v[176:179], a[56:59], a[92:95], v[176:179]
buffer_load_dwordx4 v23, s[44:47], s22 offen lds
v_mfma_f32_16x16x32_bf16 v[176:179], a[40:43], a[88:91], v[176:179]
ds_read_b64_tr_b16 a[84:85], v12 offset:25088
v_cvt_pk_bf16_f32 v98, v100, v101
v_mfma_f32_16x16x32_bf16 v[172:175], a[36:39], a[88:91], v[172:175]
ds_read_b64_tr_b16 a[86:87], v12 offset:26112
v_cvt_pk_bf16_f32 v99, v102, v103
v_accvgpr_write_b32 a164, v96
v_mfma_f32_16x16x32_bf16 v[172:175], a[52:55], a[92:95], v[172:175]
v_accvgpr_write_b32 a165, v97
v_accvgpr_write_b32 a166, v98
v_mfma_f32_16x16x32_bf16 v[168:171], a[48:51], a[92:95], v[168:171]
v_accvgpr_write_b32 a167, v99
v_cvt_pk_bf16_f32 v104, v104, v105
v_mfma_f32_16x16x32_bf16 v[168:171], a[32:35], a[88:91], v[168:171]
s_waitcnt lgkmcnt(4)
v_cvt_pk_bf16_f32 v105, v106, v107
v_cvt_pk_bf16_f32 v106, v108, v109
v_cvt_pk_bf16_f32 v107, v110, v111
v_mfma_f32_16x16x32_bf16 v[184:187], a[32:35], a[96:99], v[184:187]
ds_read_b64_tr_b16 a[88:89], v13 offset:16896
s_add_u32 m0, s16, 0x1800
v_mfma_f32_16x16x32_bf16 v[184:187], a[48:51], a[100:103], v[184:187]
buffer_load_dwordx4 v22, s[44:47], s23 offen lds
v_mfma_f32_16x16x32_bf16 v[188:191], a[52:55], a[100:103], v[188:191]
ds_read_b64_tr_b16 a[90:91], v13 offset:17920
v_accvgpr_write_b32 a168, v104
v_accvgpr_write_b32 a169, v105
v_mfma_f32_16x16x32_bf16 v[188:191], a[36:39], a[96:99], v[188:191]
ds_read_b64_tr_b16 a[92:93], v13 offset:25088
v_accvgpr_write_b32 a170, v106
v_mfma_f32_16x16x32_bf16 v[192:195], a[40:43], a[96:99], v[192:195]
ds_read_b64_tr_b16 a[94:95], v13 offset:26112
v_accvgpr_write_b32 a171, v107
v_mfma_f32_16x16x32_bf16 v[192:195], a[56:59], a[100:103], v[192:195]
L_padA4:
s_cmp_eq_u32 s95, 1
s_cbranch_scc1 L_padA8
v_cvt_pk_bf16_f32 v112, v112, v113
v_cvt_pk_bf16_f32 v113, v114, v115
v_cvt_pk_bf16_f32 v114, v116, v117
v_mfma_f32_16x16x32_bf16 v[196:199], a[60:63], a[100:103], v[196:199]
v_cvt_pk_bf16_f32 v115, v118, v119
v_accvgpr_write_b32 a172, v112
v_mfma_f32_16x16x32_bf16 v[196:199], a[44:47], a[96:99], v[196:199]
v_accvgpr_write_b32 a173, v113
v_accvgpr_write_b32 a174, v114
v_mfma_f32_16x16x32_bf16 v[212:215], a[44:47], a[104:107], v[212:215]
ds_read_b64_tr_b16 a[96:97], v12 offset:17152
s_add_u32 m0, s16, 0x1c00
v_accvgpr_write_b32 a175, v115
v_mfma_f32_16x16x32_bf16 v[212:215], a[60:63], a[108:111], v[212:215]
buffer_load_dwordx4 v23, s[44:47], s23 offen lds
v_mfma_f32_16x16x32_bf16 v[208:211], a[56:59], a[108:111], v[208:211]
ds_read_b64_tr_b16 a[98:99], v12 offset:18176
v_lshl_add_u32 v22, s42, 7, v22
v_mfma_f32_16x16x32_bf16 v[208:211], a[40:43], a[104:107], v[208:211]
ds_read_b64_tr_b16 a[100:101], v12 offset:25344
v_lshl_add_u32 v23, s42, 7, v23
v_cvt_pk_bf16_f32 v120, v120, v121
v_mfma_f32_16x16x32_bf16 v[204:207], a[36:39], a[104:107], v[204:207]
ds_read_b64_tr_b16 a[102:103], v12 offset:26368
v_cvt_pk_bf16_f32 v121, v122, v123
v_mfma_f32_16x16x32_bf16 v[204:207], a[52:55], a[108:111], v[204:207]
v_cvt_pk_bf16_f32 v122, v124, v125
v_cvt_pk_bf16_f32 v123, v126, v127
v_mfma_f32_16x16x32_bf16 v[200:203], a[48:51], a[108:111], v[200:203]
v_accvgpr_write_b32 a176, v120
v_accvgpr_write_b32 a177, v121
v_accvgpr_write_b32 a178, v122
v_mfma_f32_16x16x32_bf16 v[200:203], a[32:35], a[104:107], v[200:203]
s_mov_b32 s9, 0x600000
s_waitcnt lgkmcnt(4)
v_accvgpr_write_b32 a179, v123
v_mfma_f32_16x16x32_bf16 v[216:219], a[32:35], a[80:83], v[216:219]
buffer_load_dword a120, v18, s[52:55], s9 offen
v_mfma_f32_16x16x32_bf16 v[216:219], a[48:51], a[84:87], v[216:219]
ds_read_b64_tr_b16 a[104:105], v13 offset:17152
v_cvt_pk_bf16_f32 v128, v128, v129
v_cvt_pk_bf16_f32 v129, v130, v131
v_mfma_f32_16x16x32_bf16 v[220:223], a[52:55], a[84:87], v[220:223]
ds_read_b64_tr_b16 a[106:107], v13 offset:18176
v_cvt_pk_bf16_f32 v130, v132, v133
v_mfma_f32_16x16x32_bf16 v[220:223], a[36:39], a[80:83], v[220:223]
ds_read_b64_tr_b16 a[108:109], v13 offset:25344
v_cvt_pk_bf16_f32 v131, v134, v135
v_mfma_f32_16x16x32_bf16 v[224:227], a[40:43], a[80:83], v[224:227]
ds_read_b64_tr_b16 a[110:111], v13 offset:26368
v_add_u32 v12, 0x8000, v12
v_accvgpr_write_b32 a180, v128
v_mfma_f32_16x16x32_bf16 v[224:227], a[56:59], a[84:87], v[224:227]
v_add_u32 v13, 0x8000, v13
v_accvgpr_write_b32 a181, v129
v_mfma_f32_16x16x32_bf16 v[228:231], a[60:63], a[84:87], v[228:231]
v_accvgpr_write_b32 a182, v130
v_accvgpr_write_b32 a183, v131
v_mfma_f32_16x16x32_bf16 v[228:231], a[44:47], a[80:83], v[228:231]
v_cvt_pk_bf16_f32 v136, v136, v137
v_cvt_pk_bf16_f32 v137, v138, v139
v_cvt_pk_bf16_f32 v138, v140, v141
v_mfma_f32_16x16x32_bf16 v[244:247], a[44:47], a[88:91], v[244:247]
s_waitcnt vmcnt(27) lgkmcnt(0)
v_cvt_pk_bf16_f32 v139, v142, v143
v_accvgpr_write_b32 a184, v136
v_mfma_f32_16x16x32_bf16 v[244:247], a[60:63], a[92:95], v[244:247]
s_barrier
s_add_u32 m0, s17, 0x8000
v_accvgpr_write_b32 a185, v137
v_mfma_f32_16x16x32_bf16 v[240:243], a[56:59], a[92:95], v[240:243]
buffer_load_dwordx4 v5, s[52:55], 0 offen lds
v_accvgpr_write_b32 a186, v138
v_mfma_f32_16x16x32_bf16 v[240:243], a[40:43], a[88:91], v[240:243]
ds_read_b64_tr_b16 a[80:81], v12 offset:0
v_accvgpr_write_b32 a187, v139
v_mfma_f32_16x16x32_bf16 v[236:239], a[36:39], a[88:91], v[236:239]
ds_read_b64_tr_b16 a[82:83], v12 offset:1024
v_cvt_pk_bf16_f32 v144, v144, v145
v_mfma_f32_16x16x32_bf16 v[236:239], a[52:55], a[92:95], v[236:239]
ds_read_b64_tr_b16 a[84:85], v12 offset:8192
v_cvt_pk_bf16_f32 v145, v146, v147
v_cvt_pk_bf16_f32 v146, v148, v149
v_mfma_f32_16x16x32_bf16 v[232:235], a[48:51], a[92:95], v[232:235]
ds_read_b64_tr_b16 a[86:87], v12 offset:9216
v_cvt_pk_bf16_f32 v147, v150, v151
v_mfma_f32_16x16x32_bf16 v[232:235], a[32:35], a[88:91], v[232:235]
s_add_u32 m0, s17, 0x8400
s_waitcnt lgkmcnt(4)
v_accvgpr_write_b32 a188, v144
v_mfma_f32_16x16x32_bf16 v[248:251], a[32:35], a[96:99], v[248:251]
buffer_load_dwordx4 v5, s[52:55], s13 offen lds
v_accvgpr_write_b32 a189, v145
v_mfma_f32_16x16x32_bf16 v[248:251], a[48:51], a[100:103], v[248:251]
ds_read_b64_tr_b16 a[88:89], v13 offset:0
v_accvgpr_write_b32 a190, v146
v_mfma_f32_16x16x32_bf16 v[252:255], a[52:55], a[100:103], v[252:255]
ds_read_b64_tr_b16 a[90:91], v13 offset:1024
v_accvgpr_write_b32 a191, v147
v_mfma_f32_16x16x32_bf16 v[252:255], a[36:39], a[96:99], v[252:255]
ds_read_b64_tr_b16 a[92:93], v13 offset:8192
v_cvt_pk_bf16_f32 v152, v152, v153
v_cvt_pk_bf16_f32 v153, v154, v155
v_mfma_f32_16x16x32_bf16 a[232:235], a[40:43], a[96:99], a[232:235]
ds_read_b64_tr_b16 a[94:95], v13 offset:9216
v_cvt_pk_bf16_f32 v154, v156, v157
v_mfma_f32_16x16x32_bf16 a[232:235], a[56:59], a[100:103], a[232:235]
v_cvt_pk_bf16_f32 v155, v158, v159
v_accvgpr_write_b32 a192, v152
v_mfma_f32_16x16x32_bf16 a[236:239], a[60:63], a[100:103], a[236:239]
s_add_u32 m0, s17, 0x8800
v_accvgpr_write_b32 a193, v153
v_accvgpr_write_b32 a194, v154
v_accvgpr_write_b32 a195, v155
v_mfma_f32_16x16x32_bf16 a[236:239], a[44:47], a[96:99], a[236:239]
buffer_load_dwordx4 v6, s[52:55], 0 offen lds
v_mfma_f32_16x16x32_bf16 a[252:255], a[44:47], a[104:107], a[252:255]
ds_read_b64_tr_b16 a[96:97], v12 offset:256
v_cvt_pk_bf16_f32 v160, v160, v161
v_mfma_f32_16x16x32_bf16 a[252:255], a[60:63], a[108:111], a[252:255]
ds_read_b64_tr_b16 a[98:99], v12 offset:1280
v_cvt_pk_bf16_f32 v161, v162, v163
v_cvt_pk_bf16_f32 v162, v164, v165
v_mfma_f32_16x16x32_bf16 a[248:251], a[56:59], a[108:111], a[248:251]
ds_read_b64_tr_b16 a[100:101], v12 offset:8448
v_cvt_pk_bf16_f32 v163, v166, v167
v_mfma_f32_16x16x32_bf16 a[248:251], a[40:43], a[104:107], a[248:251]
ds_read_b64_tr_b16 a[102:103], v12 offset:9472
v_accvgpr_write_b32 a196, v160
v_mfma_f32_16x16x32_bf16 a[244:247], a[36:39], a[104:107], a[244:247]
v_accvgpr_write_b32 a197, v161
v_accvgpr_write_b32 a198, v162
v_accvgpr_write_b32 a199, v163
v_mfma_f32_16x16x32_bf16 a[244:247], a[52:55], a[108:111], a[244:247]
s_add_u32 m0, s17, 0x8c00
v_cvt_pk_bf16_f32 v168, v168, v169
v_cvt_pk_bf16_f32 v169, v170, v171
v_mfma_f32_16x16x32_bf16 a[240:243], a[48:51], a[108:111], a[240:243]
buffer_load_dwordx4 v6, s[52:55], s13 offen lds
v_mfma_f32_16x16x32_bf16 a[240:243], a[32:35], a[104:107], a[240:243]
s_waitcnt lgkmcnt(4)
v_cvt_pk_bf16_f32 v170, v172, v173
v_cvt_pk_bf16_f32 v171, v174, v175
v_accvgpr_write_b32 a200, v168
L_S8:
v_mfma_f32_16x16x32_bf16 v[24:27], a[80:83], a[0:3], 0
ds_read_b64_tr_b16 a[104:105], v13 offset:256
s_waitcnt vmcnt(22)
v_mfma_f32_16x16x32_bf16 v[24:27], a[84:87], a[16:19], v[24:27]
ds_read_b64_tr_b16 a[106:107], v13 offset:1280
v_accvgpr_write_b32 a201, v169
v_mfma_f32_16x16x32_bf16 v[32:35], a[84:87], a[20:23], 0
ds_read_b64_tr_b16 a[108:109], v13 offset:8448
v_accvgpr_write_b32 a202, v170
v_accvgpr_write_b32 a203, v171
v_mfma_f32_16x16x32_bf16 v[32:35], a[80:83], a[4:7], v[32:35]
ds_read_b64_tr_b16 a[110:111], v13 offset:9472
v_cvt_pk_bf16_f32 v176, v176, v177
v_mfma_f32_16x16x32_bf16 v[40:43], a[80:83], a[8:11], 0
ds_read_b128 a[32:35], v8 offset:32768
s_add_u32 m0, s18, 0xc000
v_mfma_f32_16x16x32_bf16 v[40:43], a[84:87], a[24:27], v[40:43]
buffer_load_dwordx4 v7, s[68:71], 0 offen lds
v_cvt_pk_bf16_f32 v177, v178, v179
v_mfma_f32_16x16x32_bf16 v[48:51], a[84:87], a[28:31], 0
ds_read_b128 a[48:51], v9 offset:32768
v_cvt_pk_bf16_f32 v178, v180, v181
v_mfma_f32_16x16x32_bf16 v[48:51], a[80:83], a[12:15], v[48:51]
ds_read_b128 a[36:39], v8 offset:34816
v_cvt_pk_bf16_f32 v179, v182, v183
v_mfma_f32_16x16x32_bf16 v[52:55], a[88:91], a[12:15], 0
ds_read_b64_tr_b16 a[80:81], v12 offset:512
v_accvgpr_write_b32 a204, v176
v_accvgpr_write_b32 a205, v177
v_mfma_f32_16x16x32_bf16 v[52:55], a[92:95], a[28:31], v[52:55]
ds_read_b64_tr_b16 a[82:83], v12 offset:1536
v_accvgpr_write_b32 a206, v178
v_mfma_f32_16x16x32_bf16 v[44:47], a[92:95], a[24:27], 0
ds_read_b64_tr_b16 a[84:85], v12 offset:8704
s_add_u32 s8, s28, 0x2000
v_mfma_f32_16x16x32_bf16 v[44:47], a[88:91], a[8:11], v[44:47]
buffer_store_dwordx4 a[128:131], v16, s[88:91], s8 offen sc1
v_accvgpr_write_b32 a207, v179
v_mfma_f32_16x16x32_bf16 v[36:39], a[88:91], a[4:7], 0
ds_read_b64_tr_b16 a[86:87], v12 offset:9728
v_cvt_pk_bf16_f32 v184, v184, v185
v_mfma_f32_16x16x32_bf16 v[36:39], a[92:95], a[20:23], v[36:39]
ds_read_b128 a[52:55], v9 offset:34816
v_cvt_pk_bf16_f32 v185, v186, v187
v_mfma_f32_16x16x32_bf16 v[28:31], a[92:95], a[16:19], 0
ds_read_b128 a[40:43], v8 offset:36864
v_cvt_pk_bf16_f32 v186, v188, v189
v_cvt_pk_bf16_f32 v187, v190, v191
v_mfma_f32_16x16x32_bf16 v[28:31], a[88:91], a[0:3], v[28:31]
ds_read_b128 a[56:59], v9 offset:36864
s_waitcnt lgkmcnt(10)
v_mfma_f32_16x16x32_bf16 v[56:59], a[96:99], a[0:3], 0
ds_read_b64_tr_b16 a[88:89], v13 offset:512
v_accvgpr_write_b32 a208, v184
v_mfma_f32_16x16x32_bf16 v[56:59], a[100:103], a[16:19], v[56:59]
ds_read_b64_tr_b16 a[90:91], v13 offset:1536
s_add_u32 m0, s18, 0xd000
v_accvgpr_write_b32 a209, v185
v_mfma_f32_16x16x32_bf16 v[64:67], a[100:103], a[20:23], 0
buffer_load_dwordx4 v7, s[68:71], s25 offen lds
v_mfma_f32_16x16x32_bf16 v[64:67], a[96:99], a[4:7], v[64:67]
ds_read_b64_tr_b16 a[92:93], v13 offset:8704
v_accvgpr_write_b32 a210, v186
v_mfma_f32_16x16x32_bf16 v[72:75], a[96:99], a[8:11], 0
ds_read_b64_tr_b16 a[94:95], v13 offset:9728
v_accvgpr_write_b32 a211, v187
v_cvt_pk_bf16_f32 v192, v192, v193
v_mfma_f32_16x16x32_bf16 v[72:75], a[100:103], a[24:27], v[72:75]
ds_read_b128 a[44:47], v8 offset:38912
v_cvt_pk_bf16_f32 v193, v194, v195
v_mfma_f32_16x16x32_bf16 v[80:83], a[100:103], a[28:31], 0
ds_read_b128 a[60:63], v9 offset:38912
v_cvt_pk_bf16_f32 v194, v196, v197
v_mfma_f32_16x16x32_bf16 v[80:83], a[96:99], a[12:15], v[80:83]
v_cvt_pk_bf16_f32 v195, v198, v199
v_accvgpr_write_b32 a212, v192
v_accvgpr_write_b32 a213, v193
v_mfma_f32_16x16x32_bf16 v[84:87], a[104:107], a[12:15], 0
ds_read_b64_tr_b16 a[96:97], v12 offset:768
s_add_u32 m0, s18, 0xe000
v_mfma_f32_16x16x32_bf16 v[84:87], a[108:111], a[28:31], v[84:87]
buffer_load_dwordx4 v7, s[68:71], s26 offen lds
v_mfma_f32_16x16x32_bf16 v[76:79], a[108:111], a[24:27], 0
ds_read_b64_tr_b16 a[98:99], v12 offset:1792
v_lshl_add_u32 v5, s42, 19, v5
v_accvgpr_write_b32 a214, v194
v_mfma_f32_16x16x32_bf16 v[76:79], a[104:107], a[8:11], v[76:79]
ds_read_b64_tr_b16 a[100:101], v12 offset:8960
v_lshl_add_u32 v6, s42, 19, v6
v_mfma_f32_16x16x32_bf16 v[68:71], a[104:107], a[4:7], 0
ds_read_b64_tr_b16 a[102:103], v12 offset:9984
v_lshl_add_u32 v7, s42, 18, v7
v_mfma_f32_16x16x32_bf16 v[68:71], a[108:111], a[20:23], v[68:71]
v_lshl_add_u32 v7, s42, 17, v7
v_accvgpr_write_b32 a215, v195
v_cvt_pk_bf16_f32 v200, v200, v201
v_mfma_f32_16x16x32_bf16 v[60:63], a[108:111], a[16:19], 0
v_cvt_pk_bf16_f32 v201, v202, v203
v_cvt_pk_bf16_f32 v202, v204, v205
v_mfma_f32_16x16x32_bf16 v[60:63], a[104:107], a[0:3], v[60:63]
s_add_u32 m0, s16, 0x8000
s_waitcnt lgkmcnt(4)
s_waitcnt lgkmcnt(6)
v_mfma_f32_16x16x32_bf16 v[88:91], a[80:83], a[0:3], 0
buffer_load_dwordx4 v22, s[44:47], s20 offen lds
v_cvt_pk_bf16_f32 v203, v206, v207
v_mfma_f32_16x16x32_bf16 v[88:91], a[84:87], a[16:19], v[88:91]
ds_read_b64_tr_b16 a[104:105], v13 offset:768
v_accvgpr_write_b32 a216, v200
v_mfma_f32_16x16x32_bf16 v[96:99], a[84:87], a[20:23], 0
ds_read_b64_tr_b16 a[106:107], v13 offset:1792
v_accvgpr_write_b32 a217, v201
v_mfma_f32_16x16x32_bf16 v[96:99], a[80:83], a[4:7], v[96:99]
ds_read_b64_tr_b16 a[108:109], v13 offset:8960
v_accvgpr_write_b32 a218, v202
v_accvgpr_write_b32 a219, v203
v_mfma_f32_16x16x32_bf16 v[104:107], a[80:83], a[8:11], 0
ds_read_b64_tr_b16 a[110:111], v13 offset:9984
s_add_u32 m0, s16, 0x8400
v_mfma_f32_16x16x32_bf16 v[104:107], a[84:87], a[24:27], v[104:107]
buffer_load_dwordx4 v23, s[44:47], s20 offen lds
v_mfma_f32_16x16x32_bf16 v[112:115], a[84:87], a[28:31], 0
v_cvt_pk_bf16_f32 v208, v208, v209
v_cvt_pk_bf16_f32 v209, v210, v211
v_cvt_pk_bf16_f32 v210, v212, v213
v_mfma_f32_16x16x32_bf16 v[112:115], a[80:83], a[12:15], v[112:115]
v_cvt_pk_bf16_f32 v211, v214, v215
v_accvgpr_write_b32 a220, v208
v_mfma_f32_16x16x32_bf16 v[116:119], a[88:91], a[12:15], 0
ds_read_b64_tr_b16 a[80:81], v14 offset:0
v_accvgpr_write_b32 a221, v209
v_mfma_f32_16x16x32_bf16 v[116:119], a[92:95], a[28:31], v[116:119]
ds_read_b64_tr_b16 a[82:83], v14 offset:256
v_accvgpr_write_b32 a222, v210
v_accvgpr_write_b32 a223, v211
v_mfma_f32_16x16x32_bf16 v[108:111], a[92:95], a[24:27], 0
ds_read_b64_tr_b16 a[84:85], v14 offset:2048
s_add_u32 m0, s16, 0x8800
v_mfma_f32_16x16x32_bf16 v[108:111], a[88:91], a[8:11], v[108:111]
buffer_load_dwordx4 v22, s[44:47], s21 offen lds
v_mfma_f32_16x16x32_bf16 v[100:103], a[88:91], a[4:7], 0
ds_read_b64_tr_b16 a[86:87], v14 offset:2304
v_cvt_pk_bf16_f32 v216, v216, v217
v_cvt_pk_bf16_f32 v217, v218, v219
v_mfma_f32_16x16x32_bf16 v[100:103], a[92:95], a[20:23], v[100:103]
v_cvt_pk_bf16_f32 v218, v220, v221
v_cvt_pk_bf16_f32 v219, v222, v223
v_mfma_f32_16x16x32_bf16 v[92:95], a[92:95], a[16:19], 0
v_accvgpr_write_b32 a224, v216
v_accvgpr_write_b32 a225, v217
v_mfma_f32_16x16x32_bf16 v[92:95], a[88:91], a[0:3], v[92:95]
s_add_u32 s8, s28, 0x3000
s_waitcnt lgkmcnt(4)
v_accvgpr_write_b32 a226, v218
v_accvgpr_write_b32 a227, v219
v_mfma_f32_16x16x32_bf16 v[120:123], a[96:99], a[0:3], 0
buffer_store_dwordx4 a[132:135], v16, s[88:91], s8 offen sc1
v_mfma_f32_16x16x32_bf16 v[120:123], a[100:103], a[16:19], v[120:123]
ds_read_b64_tr_b16 a[88:89], v15 offset:0
v_cvt_pk_bf16_f32 v224, v224, v225
v_mfma_f32_16x16x32_bf16 v[128:131], a[100:103], a[20:23], 0
ds_read_b64_tr_b16 a[90:91], v15 offset:256
v_cvt_pk_bf16_f32 v225, v226, v227
v_cvt_pk_bf16_f32 v226, v228, v229
v_mfma_f32_16x16x32_bf16 v[128:131], a[96:99], a[4:7], v[128:131]
ds_read_b64_tr_b16 a[92:93], v15 offset:2048
v_cvt_pk_bf16_f32 v227, v230, v231
v_mfma_f32_16x16x32_bf16 v[136:139], a[96:99], a[8:11], 0
ds_read_b64_tr_b16 a[94:95], v15 offset:2304
v_accvgpr_write_b32 a228, v224
v_mfma_f32_16x16x32_bf16 v[136:139], a[100:103], a[24:27], v[136:139]
s_add_u32 m0, s16, 0x8c00
v_accvgpr_write_b32 a229, v225
v_accvgpr_write_b32 a230, v226
v_accvgpr_write_b32 a231, v227
v_mfma_f32_16x16x32_bf16 v[144:147], a[100:103], a[28:31], 0
buffer_load_dwordx4 v23, s[44:47], s21 offen lds
v_mfma_f32_16x16x32_bf16 v[144:147], a[96:99], a[12:15], v[144:147]
v_cvt_pk_bf16_f32 v232, v232, v233
v_cvt_pk_bf16_f32 v233, v234, v235
v_mfma_f32_16x16x32_bf16 v[148:151], a[104:107], a[12:15], 0
ds_read_b64_tr_b16 a[96:97], v14 offset:4096
v_cvt_pk_bf16_f32 v234, v236, v237
v_cvt_pk_bf16_f32 v235, v238, v239
v_mfma_f32_16x16x32_bf16 v[148:151], a[108:111], a[28:31], v[148:151]
ds_read_b64_tr_b16 a[98:99], v14 offset:4352
v_accvgpr_write_b32 a112, v232
v_mfma_f32_16x16x32_bf16 v[140:143], a[108:111], a[24:27], 0
ds_read_b64_tr_b16 a[100:101], v14 offset:6144
v_accvgpr_write_b32 a113, v233
v_mfma_f32_16x16x32_bf16 v[140:143], a[104:107], a[8:11], v[140:143]
ds_read_b64_tr_b16 a[102:103], v14 offset:6400
s_add_u32 m0, s16, 0x9000
v_accvgpr_write_b32 a114, v234
v_mfma_f32_16x16x32_bf16 v[132:135], a[104:107], a[4:7], 0
buffer_load_dwordx4 v22, s[44:47], s22 offen lds
v_mfma_f32_16x16x32_bf16 v[132:135], a[108:111], a[20:23], v[132:135]
v_accvgpr_write_b32 a115, v235
v_cvt_pk_bf16_f32 v240, v240, v241
v_mfma_f32_16x16x32_bf16 v[124:127], a[108:111], a[16:19], 0
v_cvt_pk_bf16_f32 v241, v242, v243
v_cvt_pk_bf16_f32 v242, v244, v245
v_cvt_pk_bf16_f32 v243, v246, v247
v_mfma_f32_16x16x32_bf16 v[124:127], a[104:107], a[0:3], v[124:127]
s_waitcnt lgkmcnt(4)
v_accvgpr_write_b32 a116, v240
v_accvgpr_write_b32 a117, v241
v_mfma_f32_16x16x32_bf16 v[152:155], a[80:83], a[0:3], 0
ds_read_b64_tr_b16 a[104:105], v15 offset:4096
s_add_u32 m0, s16, 0x9400
v_mfma_f32_16x16x32_bf16 v[152:155], a[84:87], a[16:19], v[152:155]
buffer_load_dwordx4 v23, s[44:47], s22 offen lds
v_accvgpr_write_b32 a118, v242
v_mfma_f32_16x16x32_bf16 v[160:163], a[84:87], a[20:23], 0
ds_read_b64_tr_b16 a[106:107], v15 offset:4352
v_accvgpr_write_b32 a119, v243
v_mfma_f32_16x16x32_bf16 v[160:163], a[80:83], a[4:7], v[160:163]
ds_read_b64_tr_b16 a[108:109], v15 offset:6144
v_cvt_pk_bf16_f32 v248, v248, v249
v_mfma_f32_16x16x32_bf16 v[168:171], a[80:83], a[8:11], 0
ds_read_b64_tr_b16 a[110:111], v15 offset:6400
v_cvt_pk_bf16_f32 v249, v250, v251
v_cvt_pk_bf16_f32 v250, v252, v253
v_mfma_f32_16x16x32_bf16 v[168:171], a[84:87], a[24:27], v[168:171]
v_cvt_pk_bf16_f32 v251, v254, v255
v_accvgpr_write_b32 a124, v248
v_mfma_f32_16x16x32_bf16 v[176:179], a[84:87], a[28:31], 0
s_add_u32 m0, s16, 0x9800
v_accvgpr_write_b32 a125, v249
v_accvgpr_write_b32 a126, v250
v_mfma_f32_16x16x32_bf16 v[176:179], a[80:83], a[12:15], v[176:179]
buffer_load_dwordx4 v22, s[44:47], s23 offen lds
v_accvgpr_write_b32 a127, v251
v_mfma_f32_16x16x32_bf16 v[180:183], a[88:91], a[12:15], 0
ds_read_b64_tr_b16 a[80:81], v14 offset:8192
v_accvgpr_read_b32 v2, a232
v_mfma_f32_16x16x32_bf16 v[180:183], a[92:95], a[28:31], v[180:183]
ds_read_b64_tr_b16 a[82:83], v14 offset:8448
v_accvgpr_read_b32 v3, a233
v_mfma_f32_16x16x32_bf16 v[172:175], a[92:95], a[24:27], 0
ds_read_b64_tr_b16 a[84:85], v14 offset:10240
v_cvt_pk_bf16_f32 v2, v2, v3
v_accvgpr_write_b32 a232, v2
v_mfma_f32_16x16x32_bf16 v[172:175], a[88:91], a[8:11], v[172:175]
ds_read_b64_tr_b16 a[86:87], v14 offset:10496
s_add_u32 m0, s16, 0x9c00
v_mfma_f32_16x16x32_bf16 v[164:167], a[88:91], a[4:7], 0
buffer_load_dwordx4 v23, s[44:47], s23 offen lds
v_mfma_f32_16x16x32_bf16 v[164:167], a[92:95], a[20:23], v[164:167]
v_lshl_add_u32 v22, s42, 7, v22
v_lshl_add_u32 v23, s42, 7, v23
v_accvgpr_read_b32 v2, a234
v_mfma_f32_16x16x32_bf16 v[156:159], a[92:95], a[16:19], 0
v_accvgpr_read_b32 v3, a235
v_cvt_pk_bf16_f32 v2, v2, v3
v_mfma_f32_16x16x32_bf16 v[156:159], a[88:91], a[0:3], v[156:159]
s_waitcnt lgkmcnt(4)
v_accvgpr_write_b32 a233, v2
v_accvgpr_read_b32 v2, a236
v_mfma_f32_16x16x32_bf16 v[184:187], a[96:99], a[0:3], 0
ds_read_b64_tr_b16 a[88:89], v15 offset:8192
v_accvgpr_read_b32 v3, a237
v_cvt_pk_bf16_f32 v2, v2, v3
v_mfma_f32_16x16x32_bf16 v[184:187], a[100:103], a[16:19], v[184:187]
ds_read_b64_tr_b16 a[90:91], v15 offset:8448
s_add_u32 s8, s28, 0x6000
v_mfma_f32_16x16x32_bf16 v[192:195], a[100:103], a[20:23], 0
buffer_store_dwordx4 a[136:139], v16, s[88:91], s8 offen sc1
v_mfma_f32_16x16x32_bf16 v[192:195], a[96:99], a[4:7], v[192:195]
ds_read_b64_tr_b16 a[92:93], v15 offset:10240
v_accvgpr_write_b32 a234, v2
v_accvgpr_read_b32 v2, a238
v_mfma_f32_16x16x32_bf16 v[200:203], a[96:99], a[8:11], 0
ds_read_b64_tr_b16 a[94:95], v15 offset:10496
v_add_u32 v12, 0xffff0000, v12
v_mfma_f32_16x16x32_bf16 v[200:203], a[100:103], a[24:27], v[200:203]
v_add_u32 v13, 0xffff0000, v13
v_add_u32 v14, 0xffff0000, v14
v_mfma_f32_16x16x32_bf16 v[208:211], a[100:103], a[28:31], 0
v_add_u32 v15, 0xffff0000, v15
v_accvgpr_read_b32 v3, a239
v_cvt_pk_bf16_f32 v2, v2, v3
v_mfma_f32_16x16x32_bf16 v[208:211], a[96:99], a[12:15], v[208:211]
v_accvgpr_write_b32 a235, v2
v_accvgpr_read_b32 v2, a240
v_mfma_f32_16x16x32_bf16 v[212:215], a[104:107], a[12:15], 0
s_waitcnt vmcnt(28) lgkmcnt(0)
v_accvgpr_read_b32 v3, a241
v_cvt_pk_bf16_f32 v2, v2, v3
v_mfma_f32_16x16x32_bf16 v[212:215], a[108:111], a[28:31], v[212:215]
s_barrier
s_add_u32 m0, s17, 0x10000
v_accvgpr_write_b32 a240, v2
v_accvgpr_read_b32 v2, a242
v_mfma_f32_16x16x32_bf16 v[204:207], a[108:111], a[24:27], 0
buffer_load_dwordx4 v5, s[52:55], 0 offen lds
v_mfma_f32_16x16x32_bf16 v[204:207], a[104:107], a[8:11], v[204:207]
ds_read_b64_tr_b16 a[96:97], v12 offset:0
v_accvgpr_read_b32 v3, a243
v_mfma_f32_16x16x32_bf16 v[196:199], a[104:107], a[4:7], 0
ds_read_b64_tr_b16 a[98:99], v12 offset:1024
v_cvt_pk_bf16_f32 v2, v2, v3
v_accvgpr_write_b32 a241, v2
v_mfma_f32_16x16x32_bf16 v[196:199], a[108:111], a[20:23], v[196:199]
ds_read_b64_tr_b16 a[100:101], v12 offset:8192
v_accvgpr_read_b32 v2, a244
v_mfma_f32_16x16x32_bf16 v[188:191], a[108:111], a[16:19], 0
ds_read_b64_tr_b16 a[102:103], v12 offset:9216
v_accvgpr_read_b32 v3, a245
v_mfma_f32_16x16x32_bf16 v[188:191], a[104:107], a[0:3], v[188:191]
s_add_u32 m0, s17, 0x10400
s_waitcnt lgkmcnt(4)
v_cvt_pk_bf16_f32 v2, v2, v3
v_accvgpr_write_b32 a242, v2
v_mfma_f32_16x16x32_bf16 v[216:219], a[0:3], a[80:83], 0
buffer_load_dwordx4 v5, s[52:55], s13 offen lds
v_mfma_f32_16x16x32_bf16 v[216:219], a[16:19], a[84:87], v[216:219]
ds_read_b64_tr_b16 a[104:105], v13 offset:0
v_accvgpr_read_b32 v2, a246
v_mfma_f32_16x16x32_bf16 v[224:227], a[20:23], a[84:87], 0
ds_read_b64_tr_b16 a[106:107], v13 offset:1024
v_accvgpr_read_b32 v3, a247
v_cvt_pk_bf16_f32 v2, v2, v3
v_mfma_f32_16x16x32_bf16 v[224:227], a[4:7], a[80:83], v[224:227]
ds_read_b64_tr_b16 a[108:109], v13 offset:8192
v_accvgpr_write_b32 a243, v2
v_mfma_f32_16x16x32_bf16 v[232:235], a[8:11], a[80:83], 0
ds_read_b64_tr_b16 a[110:111], v13 offset:9216
v_accvgpr_read_b32 v2, a248
v_mfma_f32_16x16x32_bf16 v[232:235], a[24:27], a[84:87], v[232:235]
v_accvgpr_read_b32 v3, a249
v_cvt_pk_bf16_f32 v2, v2, v3
v_accvgpr_write_b32 a248, v2
v_mfma_f32_16x16x32_bf16 v[240:243], a[28:31], a[84:87], 0
s_add_u32 m0, s17, 0x10800
v_accvgpr_read_b32 v2, a250
v_accvgpr_read_b32 v3, a251
v_mfma_f32_16x16x32_bf16 v[240:243], a[12:15], a[80:83], v[240:243]
buffer_load_dwordx4 v6, s[52:55], 0 offen lds
v_mfma_f32_16x16x32_bf16 v[244:247], a[12:15], a[88:91], 0
ds_read_b64_tr_b16 a[80:81], v12 offset:256
v_cvt_pk_bf16_f32 v2, v2, v3
v_accvgpr_write_b32 a249, v2
v_mfma_f32_16x16x32_bf16 v[244:247], a[28:31], a[92:95], v[244:247]
ds_read_b64_tr_b16 a[82:83], v12 offset:1280
v_accvgpr_read_b32 v2, a252
v_mfma_f32_16x16x32_bf16 v[236:239], a[24:27], a[92:95], 0
ds_read_b64_tr_b16 a[84:85], v12 offset:8448
v_accvgpr_read_b32 v3, a253
v_mfma_f32_16x16x32_bf16 v[236:239], a[8:11], a[88:91], v[236:239]
ds_read_b64_tr_b16 a[86:87], v12 offset:9472
v_cvt_pk_bf16_f32 v2, v2, v3
v_accvgpr_write_b32 a250, v2
v_mfma_f32_16x16x32_bf16 v[228:231], a[4:7], a[88:91], 0
v_accvgpr_read_b32 v2, a254
v_accvgpr_read_b32 v3, a255
v_mfma_f32_16x16x32_bf16 v[228:231], a[20:23], a[92:95], v[228:231]
s_add_u32 m0, s17, 0x10c00
v_cvt_pk_bf16_f32 v2, v2, v3
v_accvgpr_write_b32 a251, v2
v_mfma_f32_16x16x32_bf16 v[220:223], a[16:19], a[92:95], 0
buffer_load_dwordx4 v6, s[52:55], s13 offen lds
v_mfma_f32_16x16x32_bf16 v[220:223], a[0:3], a[88:91], v[220:223]
s_waitcnt lgkmcnt(4)
L_S9:
v_mfma_f32_16x16x32_bf16 v[24:27], a[96:99], a[32:35], v[24:27]
ds_read_b64_tr_b16 a[88:89], v13 offset:256
s_waitcnt vmcnt(23)
v_mfma_f32_16x16x32_bf16 v[24:27], a[100:103], a[48:51], v[24:27]
ds_read_b64_tr_b16 a[90:91], v13 offset:1280
v_mfma_f32_16x16x32_bf16 v[32:35], a[100:103], a[52:55], v[32:35]
ds_read_b64_tr_b16 a[92:93], v13 offset:8448
L_padA5:
s_cmp_eq_u32 s95, 1
s_cbranch_scc1 L_padA9
v_mfma_f32_16x16x32_bf16 v[32:35], a[96:99], a[36:39], v[32:35]
ds_read_b64_tr_b16 a[94:95], v13 offset:9472
v_mfma_f32_16x16x32_bf16 v[40:43], a[96:99], a[40:43], v[40:43]
ds_read_b128 a[0:3], v8 offset:0
s_add_u32 m0, s18, 0x14000
v_mfma_f32_16x16x32_bf16 v[40:43], a[100:103], a[56:59], v[40:43]
buffer_load_dwordx4 v7, s[68:71], 0 offen lds
v_mfma_f32_16x16x32_bf16 v[48:51], a[100:103], a[60:63], v[48:51]
ds_read_b128 a[16:19], v9 offset:0
v_mfma_f32_16x16x32_bf16 v[48:51], a[96:99], a[44:47], v[48:51]
ds_read_b128 a[4:7], v8 offset:2048
v_mfma_f32_16x16x32_bf16 v[52:55], a[104:107], a[44:47], v[52:55]
ds_read_b64_tr_b16 a[96:97], v12 offset:512
v_mfma_f32_16x16x32_bf16 v[52:55], a[108:111], a[60:63], v[52:55]
ds_read_b64_tr_b16 a[98:99], v12 offset:1536
v_mfma_f32_16x16x32_bf16 v[44:47], a[108:111], a[56:59], v[44:47]
ds_read_b64_tr_b16 a[100:101], v12 offset:8704
s_add_u32 s8, s28, 0x7000
v_mfma_f32_16x16x32_bf16 v[44:47], a[104:107], a[40:43], v[44:47]
buffer_store_dwordx4 a[140:143], v16, s[88:91], s8 offen sc1
v_mfma_f32_16x16x32_bf16 v[36:39], a[104:107], a[36:39], v[36:39]
ds_read_b64_tr_b16 a[102:103], v12 offset:9728
v_mfma_f32_16x16x32_bf16 v[36:39], a[108:111], a[52:55], v[36:39]
ds_read_b128 a[20:23], v9 offset:2048
v_mfma_f32_16x16x32_bf16 v[28:31], a[108:111], a[48:51], v[28:31]
ds_read_b128 a[8:11], v8 offset:4096
v_mfma_f32_16x16x32_bf16 v[28:31], a[104:107], a[32:35], v[28:31]
ds_read_b128 a[24:27], v9 offset:4096
s_waitcnt lgkmcnt(10)
v_mfma_f32_16x16x32_bf16 v[56:59], a[80:83], a[32:35], v[56:59]
ds_read_b64_tr_b16 a[104:105], v13 offset:512
v_mfma_f32_16x16x32_bf16 v[56:59], a[84:87], a[48:51], v[56:59]
ds_read_b64_tr_b16 a[106:107], v13 offset:1536
s_add_u32 m0, s18, 0x15000
v_mfma_f32_16x16x32_bf16 v[64:67], a[84:87], a[52:55], v[64:67]
buffer_load_dwordx4 v7, s[68:71], s25 offen lds
v_mfma_f32_16x16x32_bf16 v[64:67], a[80:83], a[36:39], v[64:67]
ds_read_b64_tr_b16 a[108:109], v13 offset:8704
v_mfma_f32_16x16x32_bf16 v[72:75], a[80:83], a[40:43], v[72:75]
ds_read_b64_tr_b16 a[110:111], v13 offset:9728
v_mfma_f32_16x16x32_bf16 v[72:75], a[84:87], a[56:59], v[72:75]
ds_read_b128 a[12:15], v8 offset:6144
v_mfma_f32_16x16x32_bf16 v[80:83], a[84:87], a[60:63], v[80:83]
ds_read_b128 a[28:31], v9 offset:6144
v_mfma_f32_16x16x32_bf16 v[80:83], a[80:83], a[44:47], v[80:83]
v_mfma_f32_16x16x32_bf16 v[84:87], a[88:91], a[44:47], v[84:87]
ds_read_b64_tr_b16 a[80:81], v12 offset:768
s_add_u32 m0, s18, 0x16000
v_mfma_f32_16x16x32_bf16 v[84:87], a[92:95], a[60:63], v[84:87]
buffer_load_dwordx4 v7, s[68:71], s26 offen lds
v_mfma_f32_16x16x32_bf16 v[76:79], a[92:95], a[56:59], v[76:79]
ds_read_b64_tr_b16 a[82:83], v12 offset:1792
v_lshl_add_u32 v5, s42, 19, v5
v_mfma_f32_16x16x32_bf16 v[76:79], a[88:91], a[40:43], v[76:79]
ds_read_b64_tr_b16 a[84:85], v12 offset:8960
v_lshl_add_u32 v6, s42, 19, v6
v_mfma_f32_16x16x32_bf16 v[68:71], a[88:91], a[36:39], v[68:71]
ds_read_b64_tr_b16 a[86:87], v12 offset:9984
v_lshl_add_u32 v7, s42, 18, v7
v_mfma_f32_16x16x32_bf16 v[68:71], a[92:95], a[52:55], v[68:71]
v_lshl_add_u32 v7, s42, 17, v7
v_mfma_f32_16x16x32_bf16 v[60:63], a[92:95], a[48:51], v[60:63]
v_mfma_f32_16x16x32_bf16 v[60:63], a[88:91], a[32:35], v[60:63]
s_add_u32 m0, s16, 0x0
s_waitcnt lgkmcnt(4)
s_waitcnt lgkmcnt(6)
v_mfma_f32_16x16x32_bf16 v[88:91], a[96:99], a[32:35], v[88:91]
buffer_load_dwordx4 v22, s[44:47], s20 offen lds
v_mfma_f32_16x16x32_bf16 v[88:91], a[100:103], a[48:51], v[88:91]
ds_read_b64_tr_b16 a[88:89], v13 offset:768
v_mfma_f32_16x16x32_bf16 v[96:99], a[100:103], a[52:55], v[96:99]
ds_read_b64_tr_b16 a[90:91], v13 offset:1792
v_mfma_f32_16x16x32_bf16 v[96:99], a[96:99], a[36:39], v[96:99]
ds_read_b64_tr_b16 a[92:93], v13 offset:8960
v_mfma_f32_16x16x32_bf16 v[104:107], a[96:99], a[40:43], v[104:107]
ds_read_b64_tr_b16 a[94:95], v13 offset:9984
s_add_u32 m0, s16, 0x400
v_mfma_f32_16x16x32_bf16 v[104:107], a[100:103], a[56:59], v[104:107]
buffer_load_dwordx4 v23, s[44:47], s20 offen lds
v_mfma_f32_16x16x32_bf16 v[112:115], a[100:103], a[60:63], v[112:115]
v_mfma_f32_16x16x32_bf16 v[112:115], a[96:99], a[44:47], v[112:115]
v_mfma_f32_16x16x32_bf16 v[116:119], a[104:107], a[44:47], v[116:119]
ds_read_b64_tr_b16 a[96:97], v14 offset:0
v_mfma_f32_16x16x32_bf16 v[116:119], a[108:111], a[60:63], v[116:119]
ds_read_b64_tr_b16 a[98:99], v14 offset:256
v_mfma_f32_16x16x32_bf16 v[108:111], a[108:111], a[56:59], v[108:111]
ds_read_b64_tr_b16 a[100:101], v14 offset:2048
s_add_u32 m0, s16, 0x800
v_mfma_f32_16x16x32_bf16 v[108:111], a[104:107], a[40:43], v[108:111]
buffer_load_dwordx4 v22, s[44:47], s21 offen lds
v_mfma_f32_16x16x32_bf16 v[100:103], a[104:107], a[36:39], v[100:103]
ds_read_b64_tr_b16 a[102:103], v14 offset:2304
v_mfma_f32_16x16x32_bf16 v[100:103], a[108:111], a[52:55], v[100:103]
v_mfma_f32_16x16x32_bf16 v[92:95], a[108:111], a[48:51], v[92:95]
v_mfma_f32_16x16x32_bf16 v[92:95], a[104:107], a[32:35], v[92:95]
s_add_u32 s8, s28, 0x2400
s_waitcnt lgkmcnt(4)
v_mfma_f32_16x16x32_bf16 v[120:123], a[80:83], a[32:35], v[120:123]
buffer_store_dwordx4 a[144:147], v16, s[88:91], s8 offen sc1
v_mfma_f32_16x16x32_bf16 v[120:123], a[84:87], a[48:51], v[120:123]
ds_read_b64_tr_b16 a[104:105], v15 offset:0
v_mfma_f32_16x16x32_bf16 v[128:131], a[84:87], a[52:55], v[128:131]
ds_read_b64_tr_b16 a[106:107], v15 offset:256
v_mfma_f32_16x16x32_bf16 v[128:131], a[80:83], a[36:39], v[128:131]
ds_read_b64_tr_b16 a[108:109], v15 offset:2048
v_mfma_f32_16x16x32_bf16 v[136:139], a[80:83], a[40:43], v[136:139]
ds_read_b64_tr_b16 a[110:111], v15 offset:2304
v_mfma_f32_16x16x32_bf16 v[136:139], a[84:87], a[56:59], v[136:139]
s_add_u32 m0, s16, 0xc00
v_mfma_f32_16x16x32_bf16 v[144:147], a[84:87], a[60:63], v[144:147]
buffer_load_dwordx4 v23, s[44:47], s21 offen lds
v_mfma_f32_16x16x32_bf16 v[144:147], a[80:83], a[44:47], v[144:147]
v_mfma_f32_16x16x32_bf16 v[148:151], a[88:91], a[44:47], v[148:151]
ds_read_b64_tr_b16 a[80:81], v14 offset:4096
v_mfma_f32_16x16x32_bf16 v[148:151], a[92:95], a[60:63], v[148:151]
ds_read_b64_tr_b16 a[82:83], v14 offset:4352
v_mfma_f32_16x16x32_bf16 v[140:143], a[92:95], a[56:59], v[140:143]
ds_read_b64_tr_b16 a[84:85], v14 offset:6144
v_mfma_f32_16x16x32_bf16 v[140:143], a[88:91], a[40:43], v[140:143]
ds_read_b64_tr_b16 a[86:87], v14 offset:6400
s_add_u32 m0, s16, 0x1000
v_mfma_f32_16x16x32_bf16 v[132:135], a[88:91], a[36:39], v[132:135]
buffer_load_dwordx4 v22, s[44:47], s22 offen lds
v_mfma_f32_16x16x32_bf16 v[132:135], a[92:95], a[52:55], v[132:135]
v_mfma_f32_16x16x32_bf16 v[124:127], a[92:95], a[48:51], v[124:127]
v_mfma_f32_16x16x32_bf16 v[124:127], a[88:91], a[32:35], v[124:127]
s_waitcnt lgkmcnt(4)
v_mfma_f32_16x16x32_bf16 v[152:155], a[96:99], a[32:35], v[152:155]
ds_read_b64_tr_b16 a[88:89], v15 offset:4096
s_add_u32 m0, s16, 0x1400
v_mfma_f32_16x16x32_bf16 v[152:155], a[100:103], a[48:51], v[152:155]
buffer_load_dwordx4 v23, s[44:47], s22 offen lds
v_mfma_f32_16x16x32_bf16 v[160:163], a[100:103], a[52:55], v[160:163]
ds_read_b64_tr_b16 a[90:91], v15 offset:4352
v_mfma_f32_16x16x32_bf16 v[160:163], a[96:99], a[36:39], v[160:163]
ds_read_b64_tr_b16 a[92:93], v15 offset:6144
v_mfma_f32_16x16x32_bf16 v[168:171], a[96:99], a[40:43], v[168:171]
ds_read_b64_tr_b16 a[94:95], v15 offset:6400
v_mfma_f32_16x16x32_bf16 v[168:171], a[100:103], a[56:59], v[168:171]
v_mfma_f32_16x16x32_bf16 v[176:179], a[100:103], a[60:63], v[176:179]
s_add_u32 m0, s16, 0x1800
v_mfma_f32_16x16x32_bf16 v[176:179], a[96:99], a[44:47], v[176:179]
buffer_load_dwordx4 v22, s[44:47], s23 offen lds
v_mfma_f32_16x16x32_bf16 v[180:183], a[104:107], a[44:47], v[180:183]
ds_read_b64_tr_b16 a[96:97], v14 offset:8192
v_mfma_f32_16x16x32_bf16 v[180:183], a[108:111], a[60:63], v[180:183]
ds_read_b64_tr_b16 a[98:99], v14 offset:8448
v_mfma_f32_16x16x32_bf16 v[172:175], a[108:111], a[56:59], v[172:175]
ds_read_b64_tr_b16 a[100:101], v14 offset:10240
v_mfma_f32_16x16x32_bf16 v[172:175], a[104:107], a[40:43], v[172:175]
ds_read_b64_tr_b16 a[102:103], v14 offset:10496
s_add_u32 m0, s16, 0x1c00
v_mfma_f32_16x16x32_bf16 v[164:167], a[104:107], a[36:39], v[164:167]
buffer_load_dwordx4 v23, s[44:47], s23 offen lds
v_mfma_f32_16x16x32_bf16 v[164:167], a[108:111], a[52:55], v[164:167]
v_lshl_add_u32 v22, s42, 7, v22
v_lshl_add_u32 v23, s42, 7, v23
v_mfma_f32_16x16x32_bf16 v[156:159], a[108:111], a[48:51], v[156:159]
v_mfma_f32_16x16x32_bf16 v[156:159], a[104:107], a[32:35], v[156:159]
s_waitcnt lgkmcnt(4)
v_mfma_f32_16x16x32_bf16 v[184:187], a[80:83], a[32:35], v[184:187]
ds_read_b64_tr_b16 a[104:105], v15 offset:8192
v_mfma_f32_16x16x32_bf16 v[184:187], a[84:87], a[48:51], v[184:187]
ds_read_b64_tr_b16 a[106:107], v15 offset:8448
s_add_u32 s8, s28, 0x3400
v_mfma_f32_16x16x32_bf16 v[192:195], a[84:87], a[52:55], v[192:195]
buffer_store_dwordx4 a[148:151], v16, s[88:91], s8 offen sc1
v_mfma_f32_16x16x32_bf16 v[192:195], a[80:83], a[36:39], v[192:195]
ds_read_b64_tr_b16 a[108:109], v15 offset:10240
v_mfma_f32_16x16x32_bf16 v[200:203], a[80:83], a[40:43], v[200:203]
ds_read_b64_tr_b16 a[110:111], v15 offset:10496
v_add_u32 v12, 0x8000, v12
v_mfma_f32_16x16x32_bf16 v[200:203], a[84:87], a[56:59], v[200:203]
v_add_u32 v13, 0x8000, v13
v_add_u32 v14, 0x8000, v14
v_mfma_f32_16x16x32_bf16 v[208:211], a[84:87], a[60:63], v[208:211]
v_add_u32 v15, 0x8000, v15
v_mfma_f32_16x16x32_bf16 v[208:211], a[80:83], a[44:47], v[208:211]
v_mfma_f32_16x16x32_bf16 v[212:215], a[88:91], a[44:47], v[212:215]
s_waitcnt vmcnt(28) lgkmcnt(0)
v_mfma_f32_16x16x32_bf16 v[212:215], a[92:95], a[60:63], v[212:215]
s_barrier
s_add_u32 m0, s17, 0x0
v_mfma_f32_16x16x32_bf16 v[204:207], a[92:95], a[56:59], v[204:207]
buffer_load_dwordx4 v5, s[52:55], 0 offen lds
v_mfma_f32_16x16x32_bf16 v[204:207], a[88:91], a[40:43], v[204:207]
ds_read_b64_tr_b16 a[80:81], v12 offset:0
v_mfma_f32_16x16x32_bf16 v[196:199], a[88:91], a[36:39], v[196:199]
ds_read_b64_tr_b16 a[82:83], v12 offset:1024
v_mfma_f32_16x16x32_bf16 v[196:199], a[92:95], a[52:55], v[196:199]
ds_read_b64_tr_b16 a[84:85], v12 offset:8192
v_mfma_f32_16x16x32_bf16 v[188:191], a[92:95], a[48:51], v[188:191]
ds_read_b64_tr_b16 a[86:87], v12 offset:9216
v_mfma_f32_16x16x32_bf16 v[188:191], a[88:91], a[32:35], v[188:191]
s_add_u32 m0, s17, 0x400
s_waitcnt lgkmcnt(4)
v_mfma_f32_16x16x32_bf16 v[216:219], a[32:35], a[96:99], v[216:219]
buffer_load_dwordx4 v5, s[52:55], s13 offen lds
v_mfma_f32_16x16x32_bf16 v[216:219], a[48:51], a[100:103], v[216:219]
ds_read_b64_tr_b16 a[88:89], v13 offset:0
v_mfma_f32_16x16x32_bf16 v[224:227], a[52:55], a[100:103], v[224:227]
ds_read_b64_tr_b16 a[90:91], v13 offset:1024
v_mfma_f32_16x16x32_bf16 v[224:227], a[36:39], a[96:99], v[224:227]
ds_read_b64_tr_b16 a[92:93], v13 offset:8192
v_mfma_f32_16x16x32_bf16 v[232:235], a[40:43], a[96:99], v[232:235]
ds_read_b64_tr_b16 a[94:95], v13 offset:9216
v_mfma_f32_16x16x32_bf16 v[232:235], a[56:59], a[100:103], v[232:235]
v_mfma_f32_16x16x32_bf16 v[240:243], a[60:63], a[100:103], v[240:243]
s_add_u32 m0, s17, 0x800
v_mfma_f32_16x16x32_bf16 v[240:243], a[44:47], a[96:99], v[240:243]
buffer_load_dwordx4 v6, s[52:55], 0 offen lds
v_mfma_f32_16x16x32_bf16 v[244:247], a[44:47], a[104:107], v[244:247]
ds_read_b64_tr_b16 a[96:97], v12 offset:256
v_mfma_f32_16x16x32_bf16 v[244:247], a[60:63], a[108:111], v[244:247]
ds_read_b64_tr_b16 a[98:99], v12 offset:1280
v_mfma_f32_16x16x32_bf16 v[236:239], a[56:59], a[108:111], v[236:239]
ds_read_b64_tr_b16 a[100:101], v12 offset:8448
v_mfma_f32_16x16x32_bf16 v[236:239], a[40:43], a[104:107], v[236:239]
ds_read_b64_tr_b16 a[102:103], v12 offset:9472
v_mfma_f32_16x16x32_bf16 v[228:231], a[36:39], a[104:107], v[228:231]
v_mfma_f32_16x16x32_bf16 v[228:231], a[52:55], a[108:111], v[228:231]
s_add_u32 m0, s17, 0xc00
v_mfma_f32_16x16x32_bf16 v[220:223], a[48:51], a[108:111], v[220:223]
buffer_load_dwordx4 v6, s[52:55], s13 offen lds
v_mfma_f32_16x16x32_bf16 v[220:223], a[32:35], a[104:107], v[220:223]
s_waitcnt lgkmcnt(4)
L_S10:
v_mfma_f32_16x16x32_bf16 v[24:27], a[80:83], a[0:3], v[24:27]
ds_read_b64_tr_b16 a[104:105], v13 offset:256
s_waitcnt vmcnt(23)
v_mfma_f32_16x16x32_bf16 v[24:27], a[84:87], a[16:19], v[24:27]
ds_read_b64_tr_b16 a[106:107], v13 offset:1280
v_mfma_f32_16x16x32_bf16 v[32:35], a[84:87], a[20:23], v[32:35]
ds_read_b64_tr_b16 a[108:109], v13 offset:8448
v_mfma_f32_16x16x32_bf16 v[32:35], a[80:83], a[4:7], v[32:35]
ds_read_b64_tr_b16 a[110:111], v13 offset:9472
v_mfma_f32_16x16x32_bf16 v[40:43], a[80:83], a[8:11], v[40:43]
ds_read_b128 a[32:35], v8 offset:32768
s_add_u32 m0, s18, 0x4000
v_mfma_f32_16x16x32_bf16 v[40:43], a[84:87], a[24:27], v[40:43]
buffer_load_dwordx4 v7, s[68:71], 0 offen lds
v_mfma_f32_16x16x32_bf16 v[48:51], a[84:87], a[28:31], v[48:51]
ds_read_b128 a[48:51], v9 offset:32768
v_mfma_f32_16x16x32_bf16 v[48:51], a[80:83], a[12:15], v[48:51]
ds_read_b128 a[36:39], v8 offset:34816
v_mfma_f32_16x16x32_bf16 v[52:55], a[88:91], a[12:15], v[52:55]
ds_read_b64_tr_b16 a[80:81], v12 offset:512
v_mfma_f32_16x16x32_bf16 v[52:55], a[92:95], a[28:31], v[52:55]
ds_read_b64_tr_b16 a[82:83], v12 offset:1536
v_mfma_f32_16x16x32_bf16 v[44:47], a[92:95], a[24:27], v[44:47]
ds_read_b64_tr_b16 a[84:85], v12 offset:8704
s_add_u32 s8, s28, 0x6400
v_mfma_f32_16x16x32_bf16 v[44:47], a[88:91], a[8:11], v[44:47]
buffer_store_dwordx4 a[152:155], v16, s[88:91], s8 offen sc1
v_mfma_f32_16x16x32_bf16 v[36:39], a[88:91], a[4:7], v[36:39]
ds_read_b64_tr_b16 a[86:87], v12 offset:9728
v_mfma_f32_16x16x32_bf16 v[36:39], a[92:95], a[20:23], v[36:39]
ds_read_b128 a[52:55], v9 offset:34816
v_mfma_f32_16x16x32_bf16 v[28:31], a[92:95], a[16:19], v[28:31]
ds_read_b128 a[40:43], v8 offset:36864
v_mfma_f32_16x16x32_bf16 v[28:31], a[88:91], a[0:3], v[28:31]
ds_read_b128 a[56:59], v9 offset:36864
s_waitcnt lgkmcnt(10)
v_mfma_f32_16x16x32_bf16 v[56:59], a[96:99], a[0:3], v[56:59]
ds_read_b64_tr_b16 a[88:89], v13 offset:512
v_mfma_f32_16x16x32_bf16 v[56:59], a[100:103], a[16:19], v[56:59]
ds_read_b64_tr_b16 a[90:91], v13 offset:1536
s_add_u32 m0, s18, 0x5000
v_mfma_f32_16x16x32_bf16 v[64:67], a[100:103], a[20:23], v[64:67]
buffer_load_dwordx4 v7, s[68:71], s25 offen lds
v_mfma_f32_16x16x32_bf16 v[64:67], a[96:99], a[4:7], v[64:67]
ds_read_b64_tr_b16 a[92:93], v13 offset:8704
v_mfma_f32_16x16x32_bf16 v[72:75], a[96:99], a[8:11], v[72:75]
ds_read_b64_tr_b16 a[94:95], v13 offset:9728
v_mfma_f32_16x16x32_bf16 v[72:75], a[100:103], a[24:27], v[72:75]
ds_read_b128 a[44:47], v8 offset:38912
v_mfma_f32_16x16x32_bf16 v[80:83], a[100:103], a[28:31], v[80:83]
ds_read_b128 a[60:63], v9 offset:38912
v_mfma_f32_16x16x32_bf16 v[80:83], a[96:99], a[12:15], v[80:83]
v_mfma_f32_16x16x32_bf16 v[84:87], a[104:107], a[12:15], v[84:87]
ds_read_b64_tr_b16 a[96:97], v12 offset:768
s_add_u32 m0, s18, 0x6000
v_mfma_f32_16x16x32_bf16 v[84:87], a[108:111], a[28:31], v[84:87]
buffer_load_dwordx4 v7, s[68:71], s26 offen lds
v_mfma_f32_16x16x32_bf16 v[76:79], a[108:111], a[24:27], v[76:79]
ds_read_b64_tr_b16 a[98:99], v12 offset:1792
v_lshl_add_u32 v5, s42, 19, v5
v_mfma_f32_16x16x32_bf16 v[76:79], a[104:107], a[8:11], v[76:79]
ds_read_b64_tr_b16 a[100:101], v12 offset:8960
v_lshl_add_u32 v6, s42, 19, v6
v_mfma_f32_16x16x32_bf16 v[68:71], a[104:107], a[4:7], v[68:71]
ds_read_b64_tr_b16 a[102:103], v12 offset:9984
v_lshl_add_u32 v7, s42, 18, v7
v_mfma_f32_16x16x32_bf16 v[68:71], a[108:111], a[20:23], v[68:71]
v_lshl_add_u32 v7, s42, 17, v7
v_mfma_f32_16x16x32_bf16 v[60:63], a[108:111], a[16:19], v[60:63]
v_mfma_f32_16x16x32_bf16 v[60:63], a[104:107], a[0:3], v[60:63]
s_add_u32 m0, s16, 0x8000
s_waitcnt lgkmcnt(4)
s_waitcnt lgkmcnt(6)
v_mfma_f32_16x16x32_bf16 v[88:91], a[80:83], a[0:3], v[88:91]
buffer_load_dwordx4 v22, s[44:47], s20 offen lds
v_mfma_f32_16x16x32_bf16 v[88:91], a[84:87], a[16:19], v[88:91]
ds_read_b64_tr_b16 a[104:105], v13 offset:768
v_mfma_f32_16x16x32_bf16 v[96:99], a[84:87], a[20:23], v[96:99]
ds_read_b64_tr_b16 a[106:107], v13 offset:1792
v_mfma_f32_16x16x32_bf16 v[96:99], a[80:83], a[4:7], v[96:99]
ds_read_b64_tr_b16 a[108:109], v13 offset:8960
v_mfma_f32_16x16x32_bf16 v[104:107], a[80:83], a[8:11], v[104:107]
ds_read_b64_tr_b16 a[110:111], v13 offset:9984
s_add_u32 m0, s16, 0x8400
v_mfma_f32_16x16x32_bf16 v[104:107], a[84:87], a[24:27], v[104:107]
buffer_load_dwordx4 v23, s[44:47], s20 offen lds
v_mfma_f32_16x16x32_bf16 v[112:115], a[84:87], a[28:31], v[112:115]
v_mfma_f32_16x16x32_bf16 v[112:115], a[80:83], a[12:15], v[112:115]
v_mfma_f32_16x16x32_bf16 v[116:119], a[88:91], a[12:15], v[116:119]
ds_read_b64_tr_b16 a[80:81], v14 offset:0
v_mfma_f32_16x16x32_bf16 v[116:119], a[92:95], a[28:31], v[116:119]
ds_read_b64_tr_b16 a[82:83], v14 offset:256
v_mfma_f32_16x16x32_bf16 v[108:111], a[92:95], a[24:27], v[108:111]
ds_read_b64_tr_b16 a[84:85], v14 offset:2048
s_add_u32 m0, s16, 0x8800
v_mfma_f32_16x16x32_bf16 v[108:111], a[88:91], a[8:11], v[108:111]
buffer_load_dwordx4 v22, s[44:47], s21 offen lds
v_mfma_f32_16x16x32_bf16 v[100:103], a[88:91], a[4:7], v[100:103]
ds_read_b64_tr_b16 a[86:87], v14 offset:2304
v_mfma_f32_16x16x32_bf16 v[100:103], a[92:95], a[20:23], v[100:103]
v_mfma_f32_16x16x32_bf16 v[92:95], a[92:95], a[16:19], v[92:95]
v_mfma_f32_16x16x32_bf16 v[92:95], a[88:91], a[0:3], v[92:95]
s_add_u32 s8, s28, 0x7400
s_waitcnt lgkmcnt(4)
v_mfma_f32_16x16x32_bf16 v[120:123], a[96:99], a[0:3], v[120:123]
buffer_store_dwordx4 a[156:159], v16, s[88:91], s8 offen sc1
v_mfma_f32_16x16x32_bf16 v[120:123], a[100:103], a[16:19], v[120:123]
ds_read_b64_tr_b16 a[88:89], v15 offset:0
v_mfma_f32_16x16x32_bf16 v[128:131], a[100:103], a[20:23], v[128:131]
ds_read_b64_tr_b16 a[90:91], v15 offset:256
v_mfma_f32_16x16x32_bf16 v[128:131], a[96:99], a[4:7], v[128:131]
ds_read_b64_tr_b16 a[92:93], v15 offset:2048
v_mfma_f32_16x16x32_bf16 v[136:139], a[96:99], a[8:11], v[136:139]
ds_read_b64_tr_b16 a[94:95], v15 offset:2304
v_mfma_f32_16x16x32_bf16 v[136:139], a[100:103], a[24:27], v[136:139]
s_add_u32 m0, s16, 0x8c00
v_mfma_f32_16x16x32_bf16 v[144:147], a[100:103], a[28:31], v[144:147]
buffer_load_dwordx4 v23, s[44:47], s21 offen lds
v_mfma_f32_16x16x32_bf16 v[144:147], a[96:99], a[12:15], v[144:147]
v_mfma_f32_16x16x32_bf16 v[148:151], a[104:107], a[12:15], v[148:151]
ds_read_b64_tr_b16 a[96:97], v14 offset:4096
v_mfma_f32_16x16x32_bf16 v[148:151], a[108:111], a[28:31], v[148:151]
ds_read_b64_tr_b16 a[98:99], v14 offset:4352
v_mfma_f32_16x16x32_bf16 v[140:143], a[108:111], a[24:27], v[140:143]
ds_read_b64_tr_b16 a[100:101], v14 offset:6144
v_mfma_f32_16x16x32_bf16 v[140:143], a[104:107], a[8:11], v[140:143]
ds_read_b64_tr_b16 a[102:103], v14 offset:6400
s_add_u32 m0, s16, 0x9000
v_mfma_f32_16x16x32_bf16 v[132:135], a[104:107], a[4:7], v[132:135]
buffer_load_dwordx4 v22, s[44:47], s22 offen lds
v_mfma_f32_16x16x32_bf16 v[132:135], a[108:111], a[20:23], v[132:135]
v_mfma_f32_16x16x32_bf16 v[124:127], a[108:111], a[16:19], v[124:127]
v_mfma_f32_16x16x32_bf16 v[124:127], a[104:107], a[0:3], v[124:127]
s_waitcnt lgkmcnt(4)
v_mfma_f32_16x16x32_bf16 v[152:155], a[80:83], a[0:3], v[152:155]
ds_read_b64_tr_b16 a[104:105], v15 offset:4096
s_add_u32 m0, s16, 0x9400
v_mfma_f32_16x16x32_bf16 v[152:155], a[84:87], a[16:19], v[152:155]
buffer_load_dwordx4 v23, s[44:47], s22 offen lds
v_mfma_f32_16x16x32_bf16 v[160:163], a[84:87], a[20:23], v[160:163]
ds_read_b64_tr_b16 a[106:107], v15 offset:4352
v_mfma_f32_16x16x32_bf16 v[160:163], a[80:83], a[4:7], v[160:163]
ds_read_b64_tr_b16 a[108:109], v15 offset:6144
v_mfma_f32_16x16x32_bf16 v[168:171], a[80:83], a[8:11], v[168:171]
ds_read_b64_tr_b16 a[110:111], v15 offset:6400
v_mfma_f32_16x16x32_bf16 v[168:171], a[84:87], a[24:27], v[168:171]
v_mfma_f32_16x16x32_bf16 v[176:179], a[84:87], a[28:31], v[176:179]
s_add_u32 m0, s16, 0x9800
v_mfma_f32_16x16x32_bf16 v[176:179], a[80:83], a[12:15], v[176:179]
buffer_load_dwordx4 v22, s[44:47], s23 offen lds
v_mfma_f32_16x16x32_bf16 v[180:183], a[88:91], a[12:15], v[180:183]
ds_read_b64_tr_b16 a[80:81], v14 offset:8192
v_mfma_f32_16x16x32_bf16 v[180:183], a[92:95], a[28:31], v[180:183]
ds_read_b64_tr_b16 a[82:83], v14 offset:8448
v_mfma_f32_16x16x32_bf16 v[172:175], a[92:95], a[24:27], v[172:175]
ds_read_b64_tr_b16 a[84:85], v14 offset:10240
v_mfma_f32_16x16x32_bf16 v[172:175], a[88:91], a[8:11], v[172:175]
ds_read_b64_tr_b16 a[86:87], v14 offset:10496
s_add_u32 m0, s16, 0x9c00
v_mfma_f32_16x16x32_bf16 v[164:167], a[88:91], a[4:7], v[164:167]
buffer_load_dwordx4 v23, s[44:47], s23 offen lds
v_mfma_f32_16x16x32_bf16 v[164:167], a[92:95], a[20:23], v[164:167]
v_lshl_add_u32 v22, s42, 7, v22
v_lshl_add_u32 v23, s42, 7, v23
v_mfma_f32_16x16x32_bf16 v[156:159], a[92:95], a[16:19], v[156:159]
v_mfma_f32_16x16x32_bf16 v[156:159], a[88:91], a[0:3], v[156:159]
s_waitcnt lgkmcnt(4)
v_mfma_f32_16x16x32_bf16 v[184:187], a[96:99], a[0:3], v[184:187]
ds_read_b64_tr_b16 a[88:89], v15 offset:8192
v_mfma_f32_16x16x32_bf16 v[184:187], a[100:103], a[16:19], v[184:187]
ds_read_b64_tr_b16 a[90:91], v15 offset:8448
s_add_u32 s8, s28, 0x2800
v_mfma_f32_16x16x32_bf16 v[192:195], a[100:103], a[20:23], v[192:195]
buffer_store_dwordx4 a[160:163], v16, s[88:91], s8 offen sc1
v_mfma_f32_16x16x32_bf16 v[192:195], a[96:99], a[4:7], v[192:195]
ds_read_b64_tr_b16 a[92:93], v15 offset:10240
v_mfma_f32_16x16x32_bf16 v[200:203], a[96:99], a[8:11], v[200:203]
ds_read_b64_tr_b16 a[94:95], v15 offset:10496
v_add_u32 v12, 0x8000, v12
v_mfma_f32_16x16x32_bf16 v[200:203], a[100:103], a[24:27], v[200:203]
v_add_u32 v13, 0x8000, v13
v_add_u32 v14, 0x8000, v14
v_mfma_f32_16x16x32_bf16 v[208:211], a[100:103], a[28:31], v[208:211]
v_add_u32 v15, 0x8000, v15
v_mfma_f32_16x16x32_bf16 v[208:211], a[96:99], a[12:15], v[208:211]
v_mfma_f32_16x16x32_bf16 v[212:215], a[104:107], a[12:15], v[212:215]
s_waitcnt vmcnt(28) lgkmcnt(0)
v_mfma_f32_16x16x32_bf16 v[212:215], a[108:111], a[28:31], v[212:215]
s_barrier
s_add_u32 m0, s17, 0x8000
v_mfma_f32_16x16x32_bf16 v[204:207], a[108:111], a[24:27], v[204:207]
buffer_load_dwordx4 v5, s[52:55], 0 offen lds
v_mfma_f32_16x16x32_bf16 v[204:207], a[104:107], a[8:11], v[204:207]
ds_read_b64_tr_b16 a[96:97], v12 offset:0
v_mfma_f32_16x16x32_bf16 v[196:199], a[104:107], a[4:7], v[196:199]
ds_read_b64_tr_b16 a[98:99], v12 offset:1024
v_mfma_f32_16x16x32_bf16 v[196:199], a[108:111], a[20:23], v[196:199]
ds_read_b64_tr_b16 a[100:101], v12 offset:8192
v_mfma_f32_16x16x32_bf16 v[188:191], a[108:111], a[16:19], v[188:191]
ds_read_b64_tr_b16 a[102:103], v12 offset:9216
v_mfma_f32_16x16x32_bf16 v[188:191], a[104:107], a[0:3], v[188:191]
s_add_u32 m0, s17, 0x8400
s_waitcnt lgkmcnt(4)
v_mfma_f32_16x16x32_bf16 v[216:219], a[0:3], a[80:83], v[216:219]
buffer_load_dwordx4 v5, s[52:55], s13 offen lds
v_mfma_f32_16x16x32_bf16 v[216:219], a[16:19], a[84:87], v[216:219]
ds_read_b64_tr_b16 a[104:105], v13 offset:0
v_mfma_f32_16x16x32_bf16 v[224:227], a[20:23], a[84:87], v[224:227]
ds_read_b64_tr_b16 a[106:107], v13 offset:1024
v_mfma_f32_16x16x32_bf16 v[224:227], a[4:7], a[80:83], v[224:227]
ds_read_b64_tr_b16 a[108:109], v13 offset:8192
v_mfma_f32_16x16x32_bf16 v[232:235], a[8:11], a[80:83], v[232:235]
ds_read_b64_tr_b16 a[110:111], v13 offset:9216
v_mfma_f32_16x16x32_bf16 v[232:235], a[24:27], a[84:87], v[232:235]
v_mfma_f32_16x16x32_bf16 v[240:243], a[28:31], a[84:87], v[240:243]
s_add_u32 m0, s17, 0x8800
v_mfma_f32_16x16x32_bf16 v[240:243], a[12:15], a[80:83], v[240:243]
buffer_load_dwordx4 v6, s[52:55], 0 offen lds
v_mfma_f32_16x16x32_bf16 v[244:247], a[12:15], a[88:91], v[244:247]
ds_read_b64_tr_b16 a[80:81], v12 offset:256
v_mfma_f32_16x16x32_bf16 v[244:247], a[28:31], a[92:95], v[244:247]
ds_read_b64_tr_b16 a[82:83], v12 offset:1280
v_mfma_f32_16x16x32_bf16 v[236:239], a[24:27], a[92:95], v[236:239]
ds_read_b64_tr_b16 a[84:85], v12 offset:8448
v_mfma_f32_16x16x32_bf16 v[236:239], a[8:11], a[88:91], v[236:239]
ds_read_b64_tr_b16 a[86:87], v12 offset:9472
v_mfma_f32_16x16x32_bf16 v[228:231], a[4:7], a[88:91], v[228:231]
v_mfma_f32_16x16x32_bf16 v[228:231], a[20:23], a[92:95], v[228:231]
s_add_u32 m0, s17, 0x8c00
v_mfma_f32_16x16x32_bf16 v[220:223], a[16:19], a[92:95], v[220:223]
buffer_load_dwordx4 v6, s[52:55], s13 offen lds
v_mfma_f32_16x16x32_bf16 v[220:223], a[0:3], a[88:91], v[220:223]
s_waitcnt lgkmcnt(4)
L_S11:
v_mfma_f32_16x16x32_bf16 v[24:27], a[96:99], a[32:35], v[24:27]
ds_read_b64_tr_b16 a[88:89], v13 offset:256
s_waitcnt vmcnt(23)
v_mfma_f32_16x16x32_bf16 v[24:27], a[100:103], a[48:51], v[24:27]
ds_read_b64_tr_b16 a[90:91], v13 offset:1280
v_mfma_f32_16x16x32_bf16 v[32:35], a[100:103], a[52:55], v[32:35]
ds_read_b64_tr_b16 a[92:93], v13 offset:8448
v_mfma_f32_16x16x32_bf16 v[32:35], a[96:99], a[36:39], v[32:35]
ds_read_b64_tr_b16 a[94:95], v13 offset:9472
v_mfma_f32_16x16x32_bf16 v[40:43], a[96:99], a[40:43], v[40:43]
ds_read_b128 a[0:3], v8 offset:0
s_add_u32 m0, s18, 0xc000
v_mfma_f32_16x16x32_bf16 v[40:43], a[100:103], a[56:59], v[40:43]
buffer_load_dwordx4 v7, s[68:71], 0 offen lds
v_mfma_f32_16x16x32_bf16 v[48:51], a[100:103], a[60:63], v[48:51]
ds_read_b128 a[16:19], v9 offset:0
v_mfma_f32_16x16x32_bf16 v[48:51], a[96:99], a[44:47], v[48:51]
ds_read_b128 a[4:7], v8 offset:2048
v_mfma_f32_16x16x32_bf16 v[52:55], a[104:107], a[44:47], v[52:55]
ds_read_b64_tr_b16 a[96:97], v12 offset:512
v_mfma_f32_16x16x32_bf16 v[52:55], a[108:111], a[60:63], v[52:55]
ds_read_b64_tr_b16 a[98:99], v12 offset:1536
v_mfma_f32_16x16x32_bf16 v[44:47], a[108:111], a[56:59], v[44:47]
ds_read_b64_tr_b16 a[100:101], v12 offset:8704
s_add_u32 s8, s28, 0x3800
v_mfma_f32_16x16x32_bf16 v[44:47], a[104:107], a[40:43], v[44:47]
buffer_store_dwordx4 a[164:167], v16, s[88:91], s8 offen sc1
v_mfma_f32_16x16x32_bf16 v[36:39], a[104:107], a[36:39], v[36:39]
ds_read_b64_tr_b16 a[102:103], v12 offset:9728
v_mfma_f32_16x16x32_bf16 v[36:39], a[108:111], a[52:55], v[36:39]
ds_read_b128 a[20:23], v9 offset:2048
v_mfma_f32_16x16x32_bf16 v[28:31], a[108:111], a[48:51], v[28:31]
ds_read_b128 a[8:11], v8 offset:4096
v_mfma_f32_16x16x32_bf16 v[28:31], a[104:107], a[32:35], v[28:31]
ds_read_b128 a[24:27], v9 offset:4096
s_waitcnt lgkmcnt(10)
v_mfma_f32_16x16x32_bf16 v[56:59], a[80:83], a[32:35], v[56:59]
ds_read_b64_tr_b16 a[104:105], v13 offset:512
v_mfma_f32_16x16x32_bf16 v[56:59], a[84:87], a[48:51], v[56:59]
ds_read_b64_tr_b16 a[106:107], v13 offset:1536
s_add_u32 m0, s18, 0xd000
v_mfma_f32_16x16x32_bf16 v[64:67], a[84:87], a[52:55], v[64:67]
buffer_load_dwordx4 v7, s[68:71], s25 offen lds
v_mfma_f32_16x16x32_bf16 v[64:67], a[80:83], a[36:39], v[64:67]
ds_read_b64_tr_b16 a[108:109], v13 offset:8704
v_mfma_f32_16x16x32_bf16 v[72:75], a[80:83], a[40:43], v[72:75]
ds_read_b64_tr_b16 a[110:111], v13 offset:9728
v_mfma_f32_16x16x32_bf16 v[72:75], a[84:87], a[56:59], v[72:75]
ds_read_b128 a[12:15], v8 offset:6144
v_mfma_f32_16x16x32_bf16 v[80:83], a[84:87], a[60:63], v[80:83]
ds_read_b128 a[28:31], v9 offset:6144
v_mfma_f32_16x16x32_bf16 v[80:83], a[80:83], a[44:47], v[80:83]
v_mfma_f32_16x16x32_bf16 v[84:87], a[88:91], a[44:47], v[84:87]
ds_read_b64_tr_b16 a[80:81], v12 offset:768
s_add_u32 m0, s18, 0xe000
v_mfma_f32_16x16x32_bf16 v[84:87], a[92:95], a[60:63], v[84:87]
buffer_load_dwordx4 v7, s[68:71], s26 offen lds
v_mfma_f32_16x16x32_bf16 v[76:79], a[92:95], a[56:59], v[76:79]
ds_read_b64_tr_b16 a[82:83], v12 offset:1792
v_lshl_add_u32 v5, s42, 19, v5
v_mfma_f32_16x16x32_bf16 v[76:79], a[88:91], a[40:43], v[76:79]
ds_read_b64_tr_b16 a[84:85], v12 offset:8960
v_lshl_add_u32 v6, s42, 19, v6
v_mfma_f32_16x16x32_bf16 v[68:71], a[88:91], a[36:39], v[68:71]
ds_read_b64_tr_b16 a[86:87], v12 offset:9984
v_lshl_add_u32 v7, s42, 18, v7
v_mfma_f32_16x16x32_bf16 v[68:71], a[92:95], a[52:55], v[68:71]
L_padA6:
s_cmp_eq_u32 s95, 1
s_cbranch_scc1 L_padA10
v_lshl_add_u32 v7, s42, 17, v7
v_mfma_f32_16x16x32_bf16 v[60:63], a[92:95], a[48:51], v[60:63]
v_mfma_f32_16x16x32_bf16 v[60:63], a[88:91], a[32:35], v[60:63]
s_add_u32 m0, s16, 0x0
s_waitcnt lgkmcnt(4)
s_waitcnt lgkmcnt(6)
v_mfma_f32_16x16x32_bf16 v[88:91], a[96:99], a[32:35], v[88:91]
buffer_load_dwordx4 v22, s[44:47], s20 offen lds
v_mfma_f32_16x16x32_bf16 v[88:91], a[100:103], a[48:51], v[88:91]
ds_read_b64_tr_b16 a[88:89], v13 offset:768
v_mfma_f32_16x16x32_bf16 v[96:99], a[100:103], a[52:55], v[96:99]
ds_read_b64_tr_b16 a[90:91], v13 offset:1792
v_mfma_f32_16x16x32_bf16 v[96:99], a[96:99], a[36:39], v[96:99]
ds_read_b64_tr_b16 a[92:93], v13 offset:8960
v_mfma_f32_16x16x32_bf16 v[104:107], a[96:99], a[40:43], v[104:107]
ds_read_b64_tr_b16 a[94:95], v13 offset:9984
s_add_u32 m0, s16, 0x400
v_mfma_f32_16x16x32_bf16 v[104:107], a[100:103], a[56:59], v[104:107]
buffer_load_dwordx4 v23, s[44:47], s20 offen lds
v_mfma_f32_16x16x32_bf16 v[112:115], a[100:103], a[60:63], v[112:115]
v_mfma_f32_16x16x32_bf16 v[112:115], a[96:99], a[44:47], v[112:115]
v_mfma_f32_16x16x32_bf16 v[116:119], a[104:107], a[44:47], v[116:119]
ds_read_b64_tr_b16 a[96:97], v14 offset:0
v_mfma_f32_16x16x32_bf16 v[116:119], a[108:111], a[60:63], v[116:119]
ds_read_b64_tr_b16 a[98:99], v14 offset:256
v_mfma_f32_16x16x32_bf16 v[108:111], a[108:111], a[56:59], v[108:111]
ds_read_b64_tr_b16 a[100:101], v14 offset:2048
s_add_u32 m0, s16, 0x800
v_mfma_f32_16x16x32_bf16 v[108:111], a[104:107], a[40:43], v[108:111]
buffer_load_dwordx4 v22, s[44:47], s21 offen lds
v_mfma_f32_16x16x32_bf16 v[100:103], a[104:107], a[36:39], v[100:103]
ds_read_b64_tr_b16 a[102:103], v14 offset:2304
v_mfma_f32_16x16x32_bf16 v[100:103], a[108:111], a[52:55], v[100:103]
v_mfma_f32_16x16x32_bf16 v[92:95], a[108:111], a[48:51], v[92:95]
v_mfma_f32_16x16x32_bf16 v[92:95], a[104:107], a[32:35], v[92:95]
s_add_u32 s8, s28, 0x6800
s_waitcnt lgkmcnt(4)
v_mfma_f32_16x16x32_bf16 v[120:123], a[80:83], a[32:35], v[120:123]
buffer_store_dwordx4 a[168:171], v16, s[88:91], s8 offen sc1
v_mfma_f32_16x16x32_bf16 v[120:123], a[84:87], a[48:51], v[120:123]
ds_read_b64_tr_b16 a[104:105], v15 offset:0
v_mfma_f32_16x16x32_bf16 v[128:131], a[84:87], a[52:55], v[128:131]
ds_read_b64_tr_b16 a[106:107], v15 offset:256
v_mfma_f32_16x16x32_bf16 v[128:131], a[80:83], a[36:39], v[128:131]
ds_read_b64_tr_b16 a[108:109], v15 offset:2048
v_mfma_f32_16x16x32_bf16 v[136:139], a[80:83], a[40:43], v[136:139]
ds_read_b64_tr_b16 a[110:111], v15 offset:2304
v_mfma_f32_16x16x32_bf16 v[136:139], a[84:87], a[56:59], v[136:139]
s_add_u32 m0, s16, 0xc00
v_mfma_f32_16x16x32_bf16 v[144:147], a[84:87], a[60:63], v[144:147]
buffer_load_dwordx4 v23, s[44:47], s21 offen lds
v_mfma_f32_16x16x32_bf16 v[144:147], a[80:83], a[44:47], v[144:147]
v_mfma_f32_16x16x32_bf16 v[148:151], a[88:91], a[44:47], v[148:151]
ds_read_b64_tr_b16 a[80:81], v14 offset:4096
v_mfma_f32_16x16x32_bf16 v[148:151], a[92:95], a[60:63], v[148:151]
ds_read_b64_tr_b16 a[82:83], v14 offset:4352
v_mfma_f32_16x16x32_bf16 v[140:143], a[92:95], a[56:59], v[140:143]
ds_read_b64_tr_b16 a[84:85], v14 offset:6144
v_mfma_f32_16x16x32_bf16 v[140:143], a[88:91], a[40:43], v[140:143]
ds_read_b64_tr_b16 a[86:87], v14 offset:6400
s_add_u32 m0, s16, 0x1000
v_mfma_f32_16x16x32_bf16 v[132:135], a[88:91], a[36:39], v[132:135]
buffer_load_dwordx4 v22, s[44:47], s22 offen lds
v_mfma_f32_16x16x32_bf16 v[132:135], a[92:95], a[52:55], v[132:135]
v_mfma_f32_16x16x32_bf16 v[124:127], a[92:95], a[48:51], v[124:127]
v_mfma_f32_16x16x32_bf16 v[124:127], a[88:91], a[32:35], v[124:127]
s_waitcnt lgkmcnt(4)
v_mfma_f32_16x16x32_bf16 v[152:155], a[96:99], a[32:35], v[152:155]
ds_read_b64_tr_b16 a[88:89], v15 offset:4096
s_add_u32 m0, s16, 0x1400
v_mfma_f32_16x16x32_bf16 v[152:155], a[100:103], a[48:51], v[152:155]
buffer_load_dwordx4 v23, s[44:47], s22 offen lds
v_mfma_f32_16x16x32_bf16 v[160:163], a[100:103], a[52:55], v[160:163]
ds_read_b64_tr_b16 a[90:91], v15 offset:4352
v_mfma_f32_16x16x32_bf16 v[160:163], a[96:99], a[36:39], v[160:163]
ds_read_b64_tr_b16 a[92:93], v15 offset:6144
v_mfma_f32_16x16x32_bf16 v[168:171], a[96:99], a[40:43], v[168:171]
ds_read_b64_tr_b16 a[94:95], v15 offset:6400
v_mfma_f32_16x16x32_bf16 v[168:171], a[100:103], a[56:59], v[168:171]
v_mfma_f32_16x16x32_bf16 v[176:179], a[100:103], a[60:63], v[176:179]
s_add_u32 m0, s16, 0x1800
v_mfma_f32_16x16x32_bf16 v[176:179], a[96:99], a[44:47], v[176:179]
buffer_load_dwordx4 v22, s[44:47], s23 offen lds
v_mfma_f32_16x16x32_bf16 v[180:183], a[104:107], a[44:47], v[180:183]
ds_read_b64_tr_b16 a[96:97], v14 offset:8192
v_mfma_f32_16x16x32_bf16 v[180:183], a[108:111], a[60:63], v[180:183]
ds_read_b64_tr_b16 a[98:99], v14 offset:8448
v_mfma_f32_16x16x32_bf16 v[172:175], a[108:111], a[56:59], v[172:175]
ds_read_b64_tr_b16 a[100:101], v14 offset:10240
v_mfma_f32_16x16x32_bf16 v[172:175], a[104:107], a[40:43], v[172:175]
ds_read_b64_tr_b16 a[102:103], v14 offset:10496
s_add_u32 m0, s16, 0x1c00
v_mfma_f32_16x16x32_bf16 v[164:167], a[104:107], a[36:39], v[164:167]
buffer_load_dwordx4 v23, s[44:47], s23 offen lds
v_mfma_f32_16x16x32_bf16 v[164:167], a[108:111], a[52:55], v[164:167]
v_lshl_add_u32 v22, s42, 7, v22
v_lshl_add_u32 v23, s42, 7, v23
v_mfma_f32_16x16x32_bf16 v[156:159], a[108:111], a[48:51], v[156:159]
v_mfma_f32_16x16x32_bf16 v[156:159], a[104:107], a[32:35], v[156:159]
s_waitcnt lgkmcnt(4)
v_mfma_f32_16x16x32_bf16 v[184:187], a[80:83], a[32:35], v[184:187]
ds_read_b64_tr_b16 a[104:105], v15 offset:8192
v_mfma_f32_16x16x32_bf16 v[184:187], a[84:87], a[48:51], v[184:187]
ds_read_b64_tr_b16 a[106:107], v15 offset:8448
s_add_u32 s8, s28, 0x7800
v_mfma_f32_16x16x32_bf16 v[192:195], a[84:87], a[52:55], v[192:195]
buffer_store_dwordx4 a[172:175], v16, s[88:91], s8 offen sc1
v_mfma_f32_16x16x32_bf16 v[192:195], a[80:83], a[36:39], v[192:195]
ds_read_b64_tr_b16 a[108:109], v15 offset:10240
v_mfma_f32_16x16x32_bf16 v[200:203], a[80:83], a[40:43], v[200:203]
ds_read_b64_tr_b16 a[110:111], v15 offset:10496
v_add_u32 v12, 0xffff0000, v12
v_mfma_f32_16x16x32_bf16 v[200:203], a[84:87], a[56:59], v[200:203]
v_add_u32 v13, 0xffff0000, v13
v_add_u32 v14, 0xffff0000, v14
v_mfma_f32_16x16x32_bf16 v[208:211], a[84:87], a[60:63], v[208:211]
v_add_u32 v15, 0xffff0000, v15
v_mfma_f32_16x16x32_bf16 v[208:211], a[80:83], a[44:47], v[208:211]
v_mfma_f32_16x16x32_bf16 v[212:215], a[88:91], a[44:47], v[212:215]
s_waitcnt vmcnt(28) lgkmcnt(0)
v_mfma_f32_16x16x32_bf16 v[212:215], a[92:95], a[60:63], v[212:215]
s_barrier
s_add_u32 m0, s17, 0x10000
v_mfma_f32_16x16x32_bf16 v[204:207], a[92:95], a[56:59], v[204:207]
buffer_load_dwordx4 v5, s[52:55], 0 offen lds
v_mfma_f32_16x16x32_bf16 v[204:207], a[88:91], a[40:43], v[204:207]
ds_read_b64_tr_b16 a[80:81], v12 offset:0
v_mfma_f32_16x16x32_bf16 v[196:199], a[88:91], a[36:39], v[196:199]
ds_read_b64_tr_b16 a[82:83], v12 offset:1024
v_mfma_f32_16x16x32_bf16 v[196:199], a[92:95], a[52:55], v[196:199]
ds_read_b64_tr_b16 a[84:85], v12 offset:8192
v_mfma_f32_16x16x32_bf16 v[188:191], a[92:95], a[48:51], v[188:191]
ds_read_b64_tr_b16 a[86:87], v12 offset:9216
v_mfma_f32_16x16x32_bf16 v[188:191], a[88:91], a[32:35], v[188:191]
s_add_u32 m0, s17, 0x10400
s_waitcnt lgkmcnt(4)
v_mfma_f32_16x16x32_bf16 v[216:219], a[32:35], a[96:99], v[216:219]
buffer_load_dwordx4 v5, s[52:55], s13 offen lds
v_mfma_f32_16x16x32_bf16 v[216:219], a[48:51], a[100:103], v[216:219]
ds_read_b64_tr_b16 a[88:89], v13 offset:0
v_mfma_f32_16x16x32_bf16 v[224:227], a[52:55], a[100:103], v[224:227]
ds_read_b64_tr_b16 a[90:91], v13 offset:1024
v_mfma_f32_16x16x32_bf16 v[224:227], a[36:39], a[96:99], v[224:227]
ds_read_b64_tr_b16 a[92:93], v13 offset:8192
v_mfma_f32_16x16x32_bf16 v[232:235], a[40:43], a[96:99], v[232:235]
ds_read_b64_tr_b16 a[94:95], v13 offset:9216
v_mfma_f32_16x16x32_bf16 v[232:235], a[56:59], a[100:103], v[232:235]
s_add_u32 m0, s17, 0x10800
v_mfma_f32_16x16x32_bf16 v[240:243], a[60:63], a[100:103], v[240:243]
buffer_load_dwordx4 v6, s[52:55], 0 offen lds
v_mfma_f32_16x16x32_bf16 v[240:243], a[44:47], a[96:99], v[240:243]
v_mfma_f32_16x16x32_bf16 v[244:247], a[44:47], a[104:107], v[244:247]
ds_read_b64_tr_b16 a[96:97], v12 offset:256
v_mfma_f32_16x16x32_bf16 v[244:247], a[60:63], a[108:111], v[244:247]
ds_read_b64_tr_b16 a[98:99], v12 offset:1280
v_mfma_f32_16x16x32_bf16 v[236:239], a[56:59], a[108:111], v[236:239]
ds_read_b64_tr_b16 a[100:101], v12 offset:8448
v_mfma_f32_16x16x32_bf16 v[236:239], a[40:43], a[104:107], v[236:239]
ds_read_b64_tr_b16 a[102:103], v12 offset:9472
s_add_u32 s8, s28, 0x2c00
v_mfma_f32_16x16x32_bf16 v[228:231], a[36:39], a[104:107], v[228:231]
buffer_store_dwordx4 a[176:179], v16, s[88:91], s8 offen sc1
v_mfma_f32_16x16x32_bf16 v[228:231], a[52:55], a[108:111], v[228:231]
v_mfma_f32_16x16x32_bf16 v[220:223], a[48:51], a[108:111], v[220:223]
v_mfma_f32_16x16x32_bf16 v[220:223], a[32:35], a[104:107], v[220:223]
s_waitcnt lgkmcnt(4)
L_S12:
v_mfma_f32_16x16x32_bf16 v[24:27], a[80:83], a[0:3], v[24:27]
ds_read_b64_tr_b16 a[104:105], v13 offset:256
s_waitcnt vmcnt(23)
v_mfma_f32_16x16x32_bf16 v[24:27], a[84:87], a[16:19], v[24:27]
ds_read_b64_tr_b16 a[106:107], v13 offset:1280
s_add_u32 m0, s17, 0x10c00
v_mfma_f32_16x16x32_bf16 v[32:35], a[84:87], a[20:23], v[32:35]
buffer_load_dwordx4 v6, s[52:55], s13 offen lds
v_mfma_f32_16x16x32_bf16 v[32:35], a[80:83], a[4:7], v[32:35]
ds_read_b64_tr_b16 a[108:109], v13 offset:8448
v_mfma_f32_16x16x32_bf16 v[40:43], a[80:83], a[8:11], v[40:43]
ds_read_b64_tr_b16 a[110:111], v13 offset:9472
v_mfma_f32_16x16x32_bf16 v[40:43], a[84:87], a[24:27], v[40:43]
ds_read_b128 a[32:35], v8 offset:32768
v_mfma_f32_16x16x32_bf16 v[48:51], a[84:87], a[28:31], v[48:51]
ds_read_b128 a[48:51], v9 offset:32768
v_mfma_f32_16x16x32_bf16 v[48:51], a[80:83], a[12:15], v[48:51]
ds_read_b128 a[36:39], v8 offset:34816
s_add_u32 m0, s18, 0x14000
v_mfma_f32_16x16x32_bf16 v[52:55], a[88:91], a[12:15], v[52:55]
buffer_load_dwordx4 v7, s[68:71], 0 offen lds
v_mfma_f32_16x16x32_bf16 v[52:55], a[92:95], a[28:31], v[52:55]
ds_read_b64_tr_b16 a[80:81], v12 offset:512
v_mfma_f32_16x16x32_bf16 v[44:47], a[92:95], a[24:27], v[44:47]
ds_read_b64_tr_b16 a[82:83], v12 offset:1536
v_mfma_f32_16x16x32_bf16 v[44:47], a[88:91], a[8:11], v[44:47]
ds_read_b64_tr_b16 a[84:85], v12 offset:8704
v_mfma_f32_16x16x32_bf16 v[36:39], a[88:91], a[4:7], v[36:39]
ds_read_b64_tr_b16 a[86:87], v12 offset:9728
v_mfma_f32_16x16x32_bf16 v[36:39], a[92:95], a[20:23], v[36:39]
ds_read_b128 a[52:55], v9 offset:34816
s_add_u32 m0, s18, 0x15000
v_mfma_f32_16x16x32_bf16 v[28:31], a[92:95], a[16:19], v[28:31]
buffer_load_dwordx4 v7, s[68:71], s25 offen lds
v_mfma_f32_16x16x32_bf16 v[28:31], a[88:91], a[0:3], v[28:31]
ds_read_b128 a[40:43], v8 offset:36864
s_waitcnt lgkmcnt(9)
v_mfma_f32_16x16x32_bf16 v[56:59], a[96:99], a[0:3], v[56:59]
ds_read_b64_tr_b16 a[88:89], v13 offset:512
v_mfma_f32_16x16x32_bf16 v[56:59], a[100:103], a[16:19], v[56:59]
ds_read_b64_tr_b16 a[90:91], v13 offset:1536
v_mfma_f32_16x16x32_bf16 v[64:67], a[100:103], a[20:23], v[64:67]
ds_read_b64_tr_b16 a[92:93], v13 offset:8704
v_mfma_f32_16x16x32_bf16 v[64:67], a[96:99], a[4:7], v[64:67]
ds_read_b64_tr_b16 a[94:95], v13 offset:9728
s_add_u32 m0, s18, 0x16000
v_mfma_f32_16x16x32_bf16 v[72:75], a[96:99], a[8:11], v[72:75]
buffer_load_dwordx4 v7, s[68:71], s26 offen lds
v_mfma_f32_16x16x32_bf16 v[72:75], a[100:103], a[24:27], v[72:75]
ds_read_b128 a[56:59], v9 offset:36864
v_lshl_add_u32 v5, s42, 19, v5
v_mfma_f32_16x16x32_bf16 v[80:83], a[100:103], a[28:31], v[80:83]
ds_read_b128 a[44:47], v8 offset:38912
v_lshl_add_u32 v6, s42, 19, v6
v_mfma_f32_16x16x32_bf16 v[80:83], a[96:99], a[12:15], v[80:83]
ds_read_b128 a[60:63], v9 offset:38912
v_lshl_add_u32 v7, s42, 18, v7
v_mfma_f32_16x16x32_bf16 v[84:87], a[104:107], a[12:15], v[84:87]
ds_read_b64_tr_b16 a[96:97], v12 offset:768
v_lshl_add_u32 v7, s42, 17, v7
v_mfma_f32_16x16x32_bf16 v[84:87], a[108:111], a[28:31], v[84:87]
ds_read_b64_tr_b16 a[98:99], v12 offset:1792
s_add_u32 s8, s28, 0x3c00
v_mfma_f32_16x16x32_bf16 v[76:79], a[108:111], a[24:27], v[76:79]
buffer_store_dwordx4 a[180:183], v16, s[88:91], s8 offen sc1
v_mfma_f32_16x16x32_bf16 v[76:79], a[104:107], a[8:11], v[76:79]
ds_read_b64_tr_b16 a[100:101], v12 offset:8960
v_mfma_f32_16x16x32_bf16 v[68:71], a[104:107], a[4:7], v[68:71]
ds_read_b64_tr_b16 a[102:103], v12 offset:9984
v_mfma_f32_16x16x32_bf16 v[68:71], a[108:111], a[20:23], v[68:71]
v_mfma_f32_16x16x32_bf16 v[60:63], a[108:111], a[16:19], v[60:63]
v_mfma_f32_16x16x32_bf16 v[60:63], a[104:107], a[0:3], v[60:63]
s_add_u32 m0, s16, 0x8000
s_waitcnt lgkmcnt(4)
s_waitcnt lgkmcnt(7)
v_mfma_f32_16x16x32_bf16 v[88:91], a[80:83], a[0:3], v[88:91]
buffer_load_dwordx4 v22, s[44:47], s20 offen lds
v_mfma_f32_16x16x32_bf16 v[88:91], a[84:87], a[16:19], v[88:91]
ds_read_b64_tr_b16 a[104:105], v13 offset:768
v_mfma_f32_16x16x32_bf16 v[96:99], a[84:87], a[20:23], v[96:99]
ds_read_b64_tr_b16 a[106:107], v13 offset:1792
v_mfma_f32_16x16x32_bf16 v[96:99], a[80:83], a[4:7], v[96:99]
ds_read_b64_tr_b16 a[108:109], v13 offset:8960
v_mfma_f32_16x16x32_bf16 v[104:107], a[80:83], a[8:11], v[104:107]
ds_read_b64_tr_b16 a[110:111], v13 offset:9984
s_add_u32 m0, s16, 0x8400
v_mfma_f32_16x16x32_bf16 v[104:107], a[84:87], a[24:27], v[104:107]
buffer_load_dwordx4 v23, s[44:47], s20 offen lds
v_mfma_f32_16x16x32_bf16 v[112:115], a[84:87], a[28:31], v[112:115]
v_mfma_f32_16x16x32_bf16 v[112:115], a[80:83], a[12:15], v[112:115]
v_mfma_f32_16x16x32_bf16 v[116:119], a[88:91], a[12:15], v[116:119]
ds_read_b64_tr_b16 a[80:81], v14 offset:0
v_mfma_f32_16x16x32_bf16 v[116:119], a[92:95], a[28:31], v[116:119]
ds_read_b64_tr_b16 a[82:83], v14 offset:256
v_mfma_f32_16x16x32_bf16 v[108:111], a[92:95], a[24:27], v[108:111]
ds_read_b64_tr_b16 a[84:85], v14 offset:2048
s_add_u32 m0, s16, 0x8800
v_mfma_f32_16x16x32_bf16 v[108:111], a[88:91], a[8:11], v[108:111]
buffer_load_dwordx4 v22, s[44:47], s21 offen lds
v_mfma_f32_16x16x32_bf16 v[100:103], a[88:91], a[4:7], v[100:103]
ds_read_b64_tr_b16 a[86:87], v14 offset:2304
v_mfma_f32_16x16x32_bf16 v[100:103], a[92:95], a[20:23], v[100:103]
v_mfma_f32_16x16x32_bf16 v[92:95], a[92:95], a[16:19], v[92:95]
v_mfma_f32_16x16x32_bf16 v[92:95], a[88:91], a[0:3], v[92:95]
s_add_u32 m0, s16, 0x8c00
s_waitcnt lgkmcnt(4)
v_mfma_f32_16x16x32_bf16 v[120:123], a[96:99], a[0:3], v[120:123]
buffer_load_dwordx4 v23, s[44:47], s21 offen lds
v_mfma_f32_16x16x32_bf16 v[120:123], a[100:103], a[16:19], v[120:123]
ds_read_b64_tr_b16 a[88:89], v15 offset:0
v_mfma_f32_16x16x32_bf16 v[128:131], a[100:103], a[20:23], v[128:131]
ds_read_b64_tr_b16 a[90:91], v15 offset:256
v_mfma_f32_16x16x32_bf16 v[128:131], a[96:99], a[4:7], v[128:131]
ds_read_b64_tr_b16 a[92:93], v15 offset:2048
v_mfma_f32_16x16x32_bf16 v[136:139], a[96:99], a[8:11], v[136:139]
ds_read_b64_tr_b16 a[94:95], v15 offset:2304
v_mfma_f32_16x16x32_bf16 v[136:139], a[100:103], a[24:27], v[136:139]
s_add_u32 s8, s28, 0x6c00
v_mfma_f32_16x16x32_bf16 v[144:147], a[100:103], a[28:31], v[144:147]
buffer_store_dwordx4 a[184:187], v16, s[88:91], s8 offen sc1
v_mfma_f32_16x16x32_bf16 v[144:147], a[96:99], a[12:15], v[144:147]
v_mfma_f32_16x16x32_bf16 v[148:151], a[104:107], a[12:15], v[148:151]
ds_read_b64_tr_b16 a[96:97], v14 offset:4096
v_mfma_f32_16x16x32_bf16 v[148:151], a[108:111], a[28:31], v[148:151]
ds_read_b64_tr_b16 a[98:99], v14 offset:4352
v_mfma_f32_16x16x32_bf16 v[140:143], a[108:111], a[24:27], v[140:143]
ds_read_b64_tr_b16 a[100:101], v14 offset:6144
v_mfma_f32_16x16x32_bf16 v[140:143], a[104:107], a[8:11], v[140:143]
ds_read_b64_tr_b16 a[102:103], v14 offset:6400
s_add_u32 m0, s16, 0x9000
v_mfma_f32_16x16x32_bf16 v[132:135], a[104:107], a[4:7], v[132:135]
buffer_load_dwordx4 v22, s[44:47], s22 offen lds
v_mfma_f32_16x16x32_bf16 v[132:135], a[108:111], a[20:23], v[132:135]
v_mfma_f32_16x16x32_bf16 v[124:127], a[108:111], a[16:19], v[124:127]
v_mfma_f32_16x16x32_bf16 v[124:127], a[104:107], a[0:3], v[124:127]
s_waitcnt lgkmcnt(4)
v_mfma_f32_16x16x32_bf16 v[152:155], a[80:83], a[0:3], v[152:155]
ds_read_b64_tr_b16 a[104:105], v15 offset:4096
s_add_u32 m0, s16, 0x9400
v_mfma_f32_16x16x32_bf16 v[152:155], a[84:87], a[16:19], v[152:155]
buffer_load_dwordx4 v23, s[44:47], s22 offen lds
v_mfma_f32_16x16x32_bf16 v[160:163], a[84:87], a[20:23], v[160:163]
ds_read_b64_tr_b16 a[106:107], v15 offset:4352
v_mfma_f32_16x16x32_bf16 v[160:163], a[80:83], a[4:7], v[160:163]
ds_read_b64_tr_b16 a[108:109], v15 offset:6144
v_mfma_f32_16x16x32_bf16 v[168:171], a[80:83], a[8:11], v[168:171]
ds_read_b64_tr_b16 a[110:111], v15 offset:6400
v_mfma_f32_16x16x32_bf16 v[168:171], a[84:87], a[24:27], v[168:171]
v_mfma_f32_16x16x32_bf16 v[176:179], a[84:87], a[28:31], v[176:179]
s_add_u32 m0, s16, 0x9800
v_mfma_f32_16x16x32_bf16 v[176:179], a[80:83], a[12:15], v[176:179]
buffer_load_dwordx4 v22, s[44:47], s23 offen lds
v_mfma_f32_16x16x32_bf16 v[180:183], a[88:91], a[12:15], v[180:183]
ds_read_b64_tr_b16 a[80:81], v14 offset:8192
v_mfma_f32_16x16x32_bf16 v[180:183], a[92:95], a[28:31], v[180:183]
ds_read_b64_tr_b16 a[82:83], v14 offset:8448
v_mfma_f32_16x16x32_bf16 v[172:175], a[92:95], a[24:27], v[172:175]
ds_read_b64_tr_b16 a[84:85], v14 offset:10240
v_mfma_f32_16x16x32_bf16 v[172:175], a[88:91], a[8:11], v[172:175]
ds_read_b64_tr_b16 a[86:87], v14 offset:10496
s_add_u32 m0, s16, 0x9c00
v_mfma_f32_16x16x32_bf16 v[164:167], a[88:91], a[4:7], v[164:167]
buffer_load_dwordx4 v23, s[44:47], s23 offen lds
v_mfma_f32_16x16x32_bf16 v[164:167], a[92:95], a[20:23], v[164:167]
v_lshl_add_u32 v22, s42, 7, v22
v_lshl_add_u32 v23, s42, 7, v23
v_mfma_f32_16x16x32_bf16 v[156:159], a[92:95], a[16:19], v[156:159]
v_mfma_f32_16x16x32_bf16 v[156:159], a[88:91], a[0:3], v[156:159]
s_waitcnt lgkmcnt(4)
v_mfma_f32_16x16x32_bf16 v[184:187], a[96:99], a[0:3], v[184:187]
ds_read_b64_tr_b16 a[88:89], v15 offset:8192
v_mfma_f32_16x16x32_bf16 v[184:187], a[100:103], a[16:19], v[184:187]
ds_read_b64_tr_b16 a[90:91], v15 offset:8448
s_add_u32 s8, s28, 0x7c00
v_mfma_f32_16x16x32_bf16 v[192:195], a[100:103], a[20:23], v[192:195]
buffer_store_dwordx4 a[188:191], v16, s[88:91], s8 offen sc1
v_mfma_f32_16x16x32_bf16 v[192:195], a[96:99], a[4:7], v[192:195]
ds_read_b64_tr_b16 a[92:93], v15 offset:10240
v_mfma_f32_16x16x32_bf16 v[200:203], a[96:99], a[8:11], v[200:203]
ds_read_b64_tr_b16 a[94:95], v15 offset:10496
v_add_u32 v12, 0x8000, v12
v_mfma_f32_16x16x32_bf16 v[200:203], a[100:103], a[24:27], v[200:203]
v_add_u32 v13, 0x8000, v13
v_add_u32 v14, 0x8000, v14
v_mfma_f32_16x16x32_bf16 v[208:211], a[100:103], a[28:31], v[208:211]
v_add_u32 v15, 0x8000, v15
v_mfma_f32_16x16x32_bf16 v[208:211], a[96:99], a[12:15], v[208:211]
v_mfma_f32_16x16x32_bf16 v[212:215], a[104:107], a[12:15], v[212:215]
s_waitcnt vmcnt(29) lgkmcnt(0)
v_mfma_f32_16x16x32_bf16 v[212:215], a[108:111], a[28:31], v[212:215]
s_barrier
s_add_u32 m0, s17, 0x0
v_mfma_f32_16x16x32_bf16 v[204:207], a[108:111], a[24:27], v[204:207]
buffer_load_dwordx4 v5, s[52:55], 0 offen lds
v_mfma_f32_16x16x32_bf16 v[204:207], a[104:107], a[8:11], v[204:207]
ds_read_b64_tr_b16 a[96:97], v12 offset:0
v_mfma_f32_16x16x32_bf16 v[196:199], a[104:107], a[4:7], v[196:199]
ds_read_b64_tr_b16 a[98:99], v12 offset:1024
v_mfma_f32_16x16x32_bf16 v[196:199], a[108:111], a[20:23], v[196:199]
ds_read_b64_tr_b16 a[100:101], v12 offset:8192
v_mfma_f32_16x16x32_bf16 v[188:191], a[108:111], a[16:19], v[188:191]
ds_read_b64_tr_b16 a[102:103], v12 offset:9216
v_mfma_f32_16x16x32_bf16 v[188:191], a[104:107], a[0:3], v[188:191]
s_add_u32 m0, s17, 0x400
s_waitcnt lgkmcnt(4)
v_mfma_f32_16x16x32_bf16 v[216:219], a[0:3], a[80:83], v[216:219]
buffer_load_dwordx4 v5, s[52:55], s13 offen lds
v_mfma_f32_16x16x32_bf16 v[216:219], a[16:19], a[84:87], v[216:219]
ds_read_b64_tr_b16 a[104:105], v13 offset:0
v_mfma_f32_16x16x32_bf16 v[224:227], a[20:23], a[84:87], v[224:227]
ds_read_b64_tr_b16 a[106:107], v13 offset:1024
v_mfma_f32_16x16x32_bf16 v[224:227], a[4:7], a[80:83], v[224:227]
ds_read_b64_tr_b16 a[108:109], v13 offset:8192
v_mfma_f32_16x16x32_bf16 v[232:235], a[8:11], a[80:83], v[232:235]
ds_read_b64_tr_b16 a[110:111], v13 offset:9216
v_mfma_f32_16x16x32_bf16 v[232:235], a[24:27], a[84:87], v[232:235]
v_mfma_f32_16x16x32_bf16 v[240:243], a[28:31], a[84:87], v[240:243]
s_add_u32 m0, s17, 0x800
v_mfma_f32_16x16x32_bf16 v[240:243], a[12:15], a[80:83], v[240:243]
buffer_load_dwordx4 v6, s[52:55], 0 offen lds
v_mfma_f32_16x16x32_bf16 v[244:247], a[12:15], a[88:91], v[244:247]
ds_read_b64_tr_b16 a[80:81], v12 offset:256
v_mfma_f32_16x16x32_bf16 v[244:247], a[28:31], a[92:95], v[244:247]
ds_read_b64_tr_b16 a[82:83], v12 offset:1280
v_mfma_f32_16x16x32_bf16 v[236:239], a[24:27], a[92:95], v[236:239]
ds_read_b64_tr_b16 a[84:85], v12 offset:8448
v_mfma_f32_16x16x32_bf16 v[236:239], a[8:11], a[88:91], v[236:239]
ds_read_b64_tr_b16 a[86:87], v12 offset:9472
v_mfma_f32_16x16x32_bf16 v[228:231], a[4:7], a[88:91], v[228:231]
v_mfma_f32_16x16x32_bf16 v[228:231], a[20:23], a[92:95], v[228:231]
s_add_u32 m0, s17, 0xc00
v_mfma_f32_16x16x32_bf16 v[220:223], a[16:19], a[92:95], v[220:223]
buffer_load_dwordx4 v6, s[52:55], s13 offen lds
v_mfma_f32_16x16x32_bf16 v[220:223], a[0:3], a[88:91], v[220:223]
s_waitcnt lgkmcnt(4)
L_S13:
v_mfma_f32_16x16x32_bf16 v[24:27], a[96:99], a[32:35], v[24:27]
ds_read_b64_tr_b16 a[88:89], v13 offset:256
s_waitcnt vmcnt(24)
v_mfma_f32_16x16x32_bf16 v[24:27], a[100:103], a[48:51], v[24:27]
ds_read_b64_tr_b16 a[90:91], v13 offset:1280
v_mfma_f32_16x16x32_bf16 v[32:35], a[100:103], a[52:55], v[32:35]
ds_read_b64_tr_b16 a[92:93], v13 offset:8448
v_mfma_f32_16x16x32_bf16 v[32:35], a[96:99], a[36:39], v[32:35]
ds_read_b64_tr_b16 a[94:95], v13 offset:9472
v_mfma_f32_16x16x32_bf16 v[40:43], a[96:99], a[40:43], v[40:43]
ds_read_b128 a[0:3], v8 offset:0
s_add_u32 m0, s18, 0x4000
v_mfma_f32_16x16x32_bf16 v[40:43], a[100:103], a[56:59], v[40:43]
buffer_load_dwordx4 v7, s[68:71], 0 offen lds
v_mfma_f32_16x16x32_bf16 v[48:51], a[100:103], a[60:63], v[48:51]
ds_read_b128 a[16:19], v9 offset:0
v_mfma_f32_16x16x32_bf16 v[48:51], a[96:99], a[44:47], v[48:51]
ds_read_b128 a[4:7], v8 offset:2048
v_mfma_f32_16x16x32_bf16 v[52:55], a[104:107], a[44:47], v[52:55]
ds_read_b64_tr_b16 a[96:97], v12 offset:512
v_mfma_f32_16x16x32_bf16 v[52:55], a[108:111], a[60:63], v[52:55]
ds_read_b64_tr_b16 a[98:99], v12 offset:1536
v_mfma_f32_16x16x32_bf16 v[44:47], a[108:111], a[56:59], v[44:47]
ds_read_b64_tr_b16 a[100:101], v12 offset:8704
s_add_u32 s8, s28, 0x4000
v_mfma_f32_16x16x32_bf16 v[44:47], a[104:107], a[40:43], v[44:47]
buffer_store_dwordx4 a[192:195], v16, s[88:91], s8 offen sc1
v_mfma_f32_16x16x32_bf16 v[36:39], a[104:107], a[36:39], v[36:39]
ds_read_b64_tr_b16 a[102:103], v12 offset:9728
v_mfma_f32_16x16x32_bf16 v[36:39], a[108:111], a[52:55], v[36:39]
ds_read_b128 a[20:23], v9 offset:2048
v_mfma_f32_16x16x32_bf16 v[28:31], a[108:111], a[48:51], v[28:31]
ds_read_b128 a[8:11], v8 offset:4096
v_mfma_f32_16x16x32_bf16 v[28:31], a[104:107], a[32:35], v[28:31]
ds_read_b128 a[24:27], v9 offset:4096
s_waitcnt lgkmcnt(10)
v_mfma_f32_16x16x32_bf16 v[56:59], a[80:83], a[32:35], v[56:59]
ds_read_b64_tr_b16 a[104:105], v13 offset:512
v_mfma_f32_16x16x32_bf16 v[56:59], a[84:87], a[48:51], v[56:59]
ds_read_b64_tr_b16 a[106:107], v13 offset:1536
s_add_u32 m0, s18, 0x5000
v_mfma_f32_16x16x32_bf16 v[64:67], a[84:87], a[52:55], v[64:67]
buffer_load_dwordx4 v7, s[68:71], s25 offen lds
v_mfma_f32_16x16x32_bf16 v[64:67], a[80:83], a[36:39], v[64:67]
ds_read_b64_tr_b16 a[108:109], v13 offset:8704
v_mfma_f32_16x16x32_bf16 v[72:75], a[80:83], a[40:43], v[72:75]
ds_read_b64_tr_b16 a[110:111], v13 offset:9728
v_mfma_f32_16x16x32_bf16 v[72:75], a[84:87], a[56:59], v[72:75]
ds_read_b128 a[12:15], v8 offset:6144
v_mfma_f32_16x16x32_bf16 v[80:83], a[84:87], a[60:63], v[80:83]
ds_read_b128 a[28:31], v9 offset:6144
v_mfma_f32_16x16x32_bf16 v[80:83], a[80:83], a[44:47], v[80:83]
v_mfma_f32_16x16x32_bf16 v[84:87], a[88:91], a[44:47], v[84:87]
ds_read_b64_tr_b16 a[80:81], v12 offset:768
s_add_u32 m0, s18, 0x6000
v_mfma_f32_16x16x32_bf16 v[84:87], a[92:95], a[60:63], v[84:87]
buffer_load_dwordx4 v7, s[68:71], s26 offen lds
v_mfma_f32_16x16x32_bf16 v[76:79], a[92:95], a[56:59], v[76:79]
ds_read_b64_tr_b16 a[82:83], v12 offset:1792
v_lshl_add_u32 v5, s42, 19, v5
v_mfma_f32_16x16x32_bf16 v[76:79], a[88:91], a[40:43], v[76:79]
ds_read_b64_tr_b16 a[84:85], v12 offset:8960
v_lshl_add_u32 v6, s42, 19, v6
v_mfma_f32_16x16x32_bf16 v[68:71], a[88:91], a[36:39], v[68:71]
ds_read_b64_tr_b16 a[86:87], v12 offset:9984
v_lshl_add_u32 v7, s42, 18, v7
v_mfma_f32_16x16x32_bf16 v[68:71], a[92:95], a[52:55], v[68:71]
v_lshl_add_u32 v7, s42, 17, v7
v_mfma_f32_16x16x32_bf16 v[60:63], a[92:95], a[48:51], v[60:63]
v_mfma_f32_16x16x32_bf16 v[60:63], a[88:91], a[32:35], v[60:63]
s_add_u32 m0, s16, 0x0
s_waitcnt lgkmcnt(4)
s_waitcnt lgkmcnt(6)
v_mfma_f32_16x16x32_bf16 v[88:91], a[96:99], a[32:35], v[88:91]
buffer_load_dwordx4 v22, s[44:47], s20 offen lds
v_mfma_f32_16x16x32_bf16 v[88:91], a[100:103], a[48:51], v[88:91]
ds_read_b64_tr_b16 a[88:89], v13 offset:768
v_mfma_f32_16x16x32_bf16 v[96:99], a[100:103], a[52:55], v[96:99]
ds_read_b64_tr_b16 a[90:91], v13 offset:1792
v_mfma_f32_16x16x32_bf16 v[96:99], a[96:99], a[36:39], v[96:99]
ds_read_b64_tr_b16 a[92:93], v13 offset:8960
v_mfma_f32_16x16x32_bf16 v[104:107], a[96:99], a[40:43], v[104:107]
ds_read_b64_tr_b16 a[94:95], v13 offset:9984
s_add_u32 m0, s16, 0x400
v_mfma_f32_16x16x32_bf16 v[104:107], a[100:103], a[56:59], v[104:107]
buffer_load_dwordx4 v23, s[44:47], s20 offen lds
v_mfma_f32_16x16x32_bf16 v[112:115], a[100:103], a[60:63], v[112:115]
v_mfma_f32_16x16x32_bf16 v[112:115], a[96:99], a[44:47], v[112:115]
v_mfma_f32_16x16x32_bf16 v[116:119], a[104:107], a[44:47], v[116:119]
ds_read_b64_tr_b16 a[96:97], v14 offset:0
v_mfma_f32_16x16x32_bf16 v[116:119], a[108:111], a[60:63], v[116:119]
ds_read_b64_tr_b16 a[98:99], v14 offset:256
v_mfma_f32_16x16x32_bf16 v[108:111], a[108:111], a[56:59], v[108:111]
ds_read_b64_tr_b16 a[100:101], v14 offset:2048
s_add_u32 m0, s16, 0x800
v_mfma_f32_16x16x32_bf16 v[108:111], a[104:107], a[40:43], v[108:111]
buffer_load_dwordx4 v22, s[44:47], s21 offen lds
v_mfma_f32_16x16x32_bf16 v[100:103], a[104:107], a[36:39], v[100:103]
ds_read_b64_tr_b16 a[102:103], v14 offset:2304
v_mfma_f32_16x16x32_bf16 v[100:103], a[108:111], a[52:55], v[100:103]
v_mfma_f32_16x16x32_bf16 v[92:95], a[108:111], a[48:51], v[92:95]
v_mfma_f32_16x16x32_bf16 v[92:95], a[104:107], a[32:35], v[92:95]
s_add_u32 s8, s28, 0x8000
s_waitcnt lgkmcnt(4)
v_mfma_f32_16x16x32_bf16 v[120:123], a[80:83], a[32:35], v[120:123]
buffer_store_dwordx4 a[196:199], v16, s[88:91], s8 offen sc1
v_mfma_f32_16x16x32_bf16 v[120:123], a[84:87], a[48:51], v[120:123]
ds_read_b64_tr_b16 a[104:105], v15 offset:0
v_mfma_f32_16x16x32_bf16 v[128:131], a[84:87], a[52:55], v[128:131]
ds_read_b64_tr_b16 a[106:107], v15 offset:256
v_mfma_f32_16x16x32_bf16 v[128:131], a[80:83], a[36:39], v[128:131]
ds_read_b64_tr_b16 a[108:109], v15 offset:2048
v_mfma_f32_16x16x32_bf16 v[136:139], a[80:83], a[40:43], v[136:139]
ds_read_b64_tr_b16 a[110:111], v15 offset:2304
v_mfma_f32_16x16x32_bf16 v[136:139], a[84:87], a[56:59], v[136:139]
s_add_u32 m0, s16, 0xc00
v_mfma_f32_16x16x32_bf16 v[144:147], a[84:87], a[60:63], v[144:147]
buffer_load_dwordx4 v23, s[44:47], s21 offen lds
v_mfma_f32_16x16x32_bf16 v[144:147], a[80:83], a[44:47], v[144:147]
v_mfma_f32_16x16x32_bf16 v[148:151], a[88:91], a[44:47], v[148:151]
ds_read_b64_tr_b16 a[80:81], v14 offset:4096
v_mfma_f32_16x16x32_bf16 v[148:151], a[92:95], a[60:63], v[148:151]
ds_read_b64_tr_b16 a[82:83], v14 offset:4352
L_padA7:
s_cmp_eq_u32 s95, 1
s_cbranch_scc1 L_padA11
v_mfma_f32_16x16x32_bf16 v[140:143], a[92:95], a[56:59], v[140:143]
ds_read_b64_tr_b16 a[84:85], v14 offset:6144
v_mfma_f32_16x16x32_bf16 v[140:143], a[88:91], a[40:43], v[140:143]
ds_read_b64_tr_b16 a[86:87], v14 offset:6400
s_add_u32 m0, s16, 0x1000
v_mfma_f32_16x16x32_bf16 v[132:135], a[88:91], a[36:39], v[132:135]
buffer_load_dwordx4 v22, s[44:47], s22 offen lds
v_mfma_f32_16x16x32_bf16 v[132:135], a[92:95], a[52:55], v[132:135]
v_mfma_f32_16x16x32_bf16 v[124:127], a[92:95], a[48:51], v[124:127]
v_mfma_f32_16x16x32_bf16 v[124:127], a[88:91], a[32:35], v[124:127]
s_waitcnt lgkmcnt(4)
v_mfma_f32_16x16x32_bf16 v[152:155], a[96:99], a[32:35], v[152:155]
ds_read_b64_tr_b16 a[88:89], v15 offset:4096
s_add_u32 m0, s16, 0x1400
v_mfma_f32_16x16x32_bf16 v[152:155], a[100:103], a[48:51], v[152:155]
buffer_load_dwordx4 v23, s[44:47], s22 offen lds
v_mfma_f32_16x16x32_bf16 v[160:163], a[100:103], a[52:55], v[160:163]
ds_read_b64_tr_b16 a[90:91], v15 offset:4352
v_mfma_f32_16x16x32_bf16 v[160:163], a[96:99], a[36:39], v[160:163]
ds_read_b64_tr_b16 a[92:93], v15 offset:6144
v_mfma_f32_16x16x32_bf16 v[168:171], a[96:99], a[40:43], v[168:171]
ds_read_b64_tr_b16 a[94:95], v15 offset:6400
v_mfma_f32_16x16x32_bf16 v[168:171], a[100:103], a[56:59], v[168:171]
v_mfma_f32_16x16x32_bf16 v[176:179], a[100:103], a[60:63], v[176:179]
s_add_u32 m0, s16, 0x1800
v_mfma_f32_16x16x32_bf16 v[176:179], a[96:99], a[44:47], v[176:179]
buffer_load_dwordx4 v22, s[44:47], s23 offen lds
v_mfma_f32_16x16x32_bf16 v[180:183], a[104:107], a[44:47], v[180:183]
ds_read_b64_tr_b16 a[96:97], v14 offset:8192
v_mfma_f32_16x16x32_bf16 v[180:183], a[108:111], a[60:63], v[180:183]
ds_read_b64_tr_b16 a[98:99], v14 offset:8448
v_mfma_f32_16x16x32_bf16 v[172:175], a[108:111], a[56:59], v[172:175]
ds_read_b64_tr_b16 a[100:101], v14 offset:10240
v_mfma_f32_16x16x32_bf16 v[172:175], a[104:107], a[40:43], v[172:175]
ds_read_b64_tr_b16 a[102:103], v14 offset:10496
s_add_u32 m0, s16, 0x1c00
v_mfma_f32_16x16x32_bf16 v[164:167], a[104:107], a[36:39], v[164:167]
buffer_load_dwordx4 v23, s[44:47], s23 offen lds
v_mfma_f32_16x16x32_bf16 v[164:167], a[108:111], a[52:55], v[164:167]
v_lshl_add_u32 v22, s42, 7, v22
v_lshl_add_u32 v23, s42, 7, v23
v_mfma_f32_16x16x32_bf16 v[156:159], a[108:111], a[48:51], v[156:159]
v_mfma_f32_16x16x32_bf16 v[156:159], a[104:107], a[32:35], v[156:159]
s_waitcnt lgkmcnt(4)
v_mfma_f32_16x16x32_bf16 v[184:187], a[80:83], a[32:35], v[184:187]
ds_read_b64_tr_b16 a[104:105], v15 offset:8192
v_mfma_f32_16x16x32_bf16 v[184:187], a[84:87], a[48:51], v[184:187]
ds_read_b64_tr_b16 a[106:107], v15 offset:8448
s_add_u32 s8, s28, 0x4400
v_mfma_f32_16x16x32_bf16 v[192:195], a[84:87], a[52:55], v[192:195]
buffer_store_dwordx4 a[200:203], v16, s[88:91], s8 offen sc1
v_mfma_f32_16x16x32_bf16 v[192:195], a[80:83], a[36:39], v[192:195]
ds_read_b64_tr_b16 a[108:109], v15 offset:10240
v_mfma_f32_16x16x32_bf16 v[200:203], a[80:83], a[40:43], v[200:203]
ds_read_b64_tr_b16 a[110:111], v15 offset:10496
v_add_u32 v12, 0x8000, v12
v_mfma_f32_16x16x32_bf16 v[200:203], a[84:87], a[56:59], v[200:203]
v_add_u32 v13, 0x8000, v13
v_add_u32 v14, 0x8000, v14
v_mfma_f32_16x16x32_bf16 v[208:211], a[84:87], a[60:63], v[208:211]
v_add_u32 v15, 0x8000, v15
v_mfma_f32_16x16x32_bf16 v[208:211], a[80:83], a[44:47], v[208:211]
v_mfma_f32_16x16x32_bf16 v[212:215], a[88:91], a[44:47], v[212:215]
s_waitcnt vmcnt(29) lgkmcnt(0)
v_mfma_f32_16x16x32_bf16 v[212:215], a[92:95], a[60:63], v[212:215]
s_barrier
s_add_u32 m0, s17, 0x8000
v_mfma_f32_16x16x32_bf16 v[204:207], a[92:95], a[56:59], v[204:207]
buffer_load_dwordx4 v5, s[52:55], 0 offen lds
v_mfma_f32_16x16x32_bf16 v[204:207], a[88:91], a[40:43], v[204:207]
ds_read_b64_tr_b16 a[80:81], v12 offset:0
v_mfma_f32_16x16x32_bf16 v[196:199], a[88:91], a[36:39], v[196:199]
ds_read_b64_tr_b16 a[82:83], v12 offset:1024
v_mfma_f32_16x16x32_bf16 v[196:199], a[92:95], a[52:55], v[196:199]
ds_read_b64_tr_b16 a[84:85], v12 offset:8192
v_mfma_f32_16x16x32_bf16 v[188:191], a[92:95], a[48:51], v[188:191]
ds_read_b64_tr_b16 a[86:87], v12 offset:9216
v_mfma_f32_16x16x32_bf16 v[188:191], a[88:91], a[32:35], v[188:191]
s_add_u32 m0, s17, 0x8400
s_waitcnt lgkmcnt(4)
v_mfma_f32_16x16x32_bf16 v[216:219], a[32:35], a[96:99], v[216:219]
buffer_load_dwordx4 v5, s[52:55], s13 offen lds
v_mfma_f32_16x16x32_bf16 v[216:219], a[48:51], a[100:103], v[216:219]
ds_read_b64_tr_b16 a[88:89], v13 offset:0
v_mfma_f32_16x16x32_bf16 v[224:227], a[52:55], a[100:103], v[224:227]
ds_read_b64_tr_b16 a[90:91], v13 offset:1024
v_mfma_f32_16x16x32_bf16 v[224:227], a[36:39], a[96:99], v[224:227]
ds_read_b64_tr_b16 a[92:93], v13 offset:8192
v_mfma_f32_16x16x32_bf16 v[232:235], a[40:43], a[96:99], v[232:235]
ds_read_b64_tr_b16 a[94:95], v13 offset:9216
v_mfma_f32_16x16x32_bf16 v[232:235], a[56:59], a[100:103], v[232:235]
v_mfma_f32_16x16x32_bf16 v[240:243], a[60:63], a[100:103], v[240:243]
s_add_u32 m0, s17, 0x8800
v_mfma_f32_16x16x32_bf16 v[240:243], a[44:47], a[96:99], v[240:243]
buffer_load_dwordx4 v6, s[52:55], 0 offen lds
v_mfma_f32_16x16x32_bf16 v[244:247], a[44:47], a[104:107], v[244:247]
ds_read_b64_tr_b16 a[96:97], v12 offset:256
v_mfma_f32_16x16x32_bf16 v[244:247], a[60:63], a[108:111], v[244:247]
ds_read_b64_tr_b16 a[98:99], v12 offset:1280
v_mfma_f32_16x16x32_bf16 v[236:239], a[56:59], a[108:111], v[236:239]
ds_read_b64_tr_b16 a[100:101], v12 offset:8448
v_mfma_f32_16x16x32_bf16 v[236:239], a[40:43], a[104:107], v[236:239]
ds_read_b64_tr_b16 a[102:103], v12 offset:9472
v_mfma_f32_16x16x32_bf16 v[228:231], a[36:39], a[104:107], v[228:231]
v_mfma_f32_16x16x32_bf16 v[228:231], a[52:55], a[108:111], v[228:231]
s_add_u32 m0, s17, 0x8c00
v_mfma_f32_16x16x32_bf16 v[220:223], a[48:51], a[108:111], v[220:223]
buffer_load_dwordx4 v6, s[52:55], s13 offen lds
v_mfma_f32_16x16x32_bf16 v[220:223], a[32:35], a[104:107], v[220:223]
s_waitcnt lgkmcnt(4)
L_S14:
v_mfma_f32_16x16x32_bf16 v[24:27], a[80:83], a[0:3], v[24:27]
ds_read_b64_tr_b16 a[104:105], v13 offset:256
s_waitcnt vmcnt(23)
v_mfma_f32_16x16x32_bf16 v[24:27], a[84:87], a[16:19], v[24:27]
ds_read_b64_tr_b16 a[106:107], v13 offset:1280
v_mfma_f32_16x16x32_bf16 v[32:35], a[84:87], a[20:23], v[32:35]
ds_read_b64_tr_b16 a[108:109], v13 offset:8448
v_mfma_f32_16x16x32_bf16 v[32:35], a[80:83], a[4:7], v[32:35]
ds_read_b64_tr_b16 a[110:111], v13 offset:9472
v_mfma_f32_16x16x32_bf16 v[40:43], a[80:83], a[8:11], v[40:43]
ds_read_b128 a[32:35], v8 offset:32768
s_add_u32 m0, s18, 0xc000
v_mfma_f32_16x16x32_bf16 v[40:43], a[84:87], a[24:27], v[40:43]
buffer_load_dwordx4 v7, s[68:71], 0 offen lds
v_mfma_f32_16x16x32_bf16 v[48:51], a[84:87], a[28:31], v[48:51]
ds_read_b128 a[48:51], v9 offset:32768
v_mfma_f32_16x16x32_bf16 v[48:51], a[80:83], a[12:15], v[48:51]
ds_read_b128 a[36:39], v8 offset:34816
v_mfma_f32_16x16x32_bf16 v[52:55], a[88:91], a[12:15], v[52:55]
ds_read_b64_tr_b16 a[80:81], v12 offset:512
v_mfma_f32_16x16x32_bf16 v[52:55], a[92:95], a[28:31], v[52:55]
ds_read_b64_tr_b16 a[82:83], v12 offset:1536
v_mfma_f32_16x16x32_bf16 v[44:47], a[92:95], a[24:27], v[44:47]
ds_read_b64_tr_b16 a[84:85], v12 offset:8704
s_add_u32 s8, s28, 0x8400
v_mfma_f32_16x16x32_bf16 v[44:47], a[88:91], a[8:11], v[44:47]
buffer_store_dwordx4 a[204:207], v16, s[88:91], s8 offen sc1
v_mfma_f32_16x16x32_bf16 v[36:39], a[88:91], a[4:7], v[36:39]
ds_read_b64_tr_b16 a[86:87], v12 offset:9728
v_mfma_f32_16x16x32_bf16 v[36:39], a[92:95], a[20:23], v[36:39]
ds_read_b128 a[52:55], v9 offset:34816
v_mfma_f32_16x16x32_bf16 v[28:31], a[92:95], a[16:19], v[28:31]
ds_read_b128 a[40:43], v8 offset:36864
v_mfma_f32_16x16x32_bf16 v[28:31], a[88:91], a[0:3], v[28:31]
ds_read_b128 a[56:59], v9 offset:36864
s_waitcnt lgkmcnt(10)
v_mfma_f32_16x16x32_bf16 v[56:59], a[96:99], a[0:3], v[56:59]
ds_read_b64_tr_b16 a[88:89], v13 offset:512
v_mfma_f32_16x16x32_bf16 v[56:59], a[100:103], a[16:19], v[56:59]
ds_read_b64_tr_b16 a[90:91], v13 offset:1536
s_add_u32 m0, s18, 0xd000
v_mfma_f32_16x16x32_bf16 v[64:67], a[100:103], a[20:23], v[64:67]
buffer_load_dwordx4 v7, s[68:71], s25 offen lds
v_mfma_f32_16x16x32_bf16 v[64:67], a[96:99], a[4:7], v[64:67]
ds_read_b64_tr_b16 a[92:93], v13 offset:8704
v_mfma_f32_16x16x32_bf16 v[72:75], a[96:99], a[8:11], v[72:75]
ds_read_b64_tr_b16 a[94:95], v13 offset:9728
v_mfma_f32_16x16x32_bf16 v[72:75], a[100:103], a[24:27], v[72:75]
ds_read_b128 a[44:47], v8 offset:38912
v_mfma_f32_16x16x32_bf16 v[80:83], a[100:103], a[28:31], v[80:83]
ds_read_b128 a[60:63], v9 offset:38912
v_mfma_f32_16x16x32_bf16 v[80:83], a[96:99], a[12:15], v[80:83]
v_mfma_f32_16x16x32_bf16 v[84:87], a[104:107], a[12:15], v[84:87]
ds_read_b64_tr_b16 a[96:97], v12 offset:768
s_add_u32 m0, s18, 0xe000
v_mfma_f32_16x16x32_bf16 v[84:87], a[108:111], a[28:31], v[84:87]
buffer_load_dwordx4 v7, s[68:71], s26 offen lds
v_mfma_f32_16x16x32_bf16 v[76:79], a[108:111], a[24:27], v[76:79]
ds_read_b64_tr_b16 a[98:99], v12 offset:1792
v_lshl_add_u32 v5, s42, 19, v5
v_mfma_f32_16x16x32_bf16 v[76:79], a[104:107], a[8:11], v[76:79]
ds_read_b64_tr_b16 a[100:101], v12 offset:8960
v_lshl_add_u32 v6, s42, 19, v6
v_mfma_f32_16x16x32_bf16 v[68:71], a[104:107], a[4:7], v[68:71]
ds_read_b64_tr_b16 a[102:103], v12 offset:9984
v_lshl_add_u32 v7, s42, 18, v7
v_mfma_f32_16x16x32_bf16 v[68:71], a[108:111], a[20:23], v[68:71]
v_lshl_add_u32 v7, s42, 17, v7
v_mfma_f32_16x16x32_bf16 v[60:63], a[108:111], a[16:19], v[60:63]
v_mfma_f32_16x16x32_bf16 v[60:63], a[104:107], a[0:3], v[60:63]
s_add_u32 m0, s16, 0x8000
s_waitcnt lgkmcnt(4)
s_waitcnt lgkmcnt(6)
v_mfma_f32_16x16x32_bf16 v[88:91], a[80:83], a[0:3], v[88:91]
buffer_load_dwordx4 v22, s[44:47], s20 offen lds
v_mfma_f32_16x16x32_bf16 v[88:91], a[84:87], a[16:19], v[88:91]
ds_read_b64_tr_b16 a[104:105], v13 offset:768
v_mfma_f32_16x16x32_bf16 v[96:99], a[84:87], a[20:23], v[96:99]
ds_read_b64_tr_b16 a[106:107], v13 offset:1792
v_mfma_f32_16x16x32_bf16 v[96:99], a[80:83], a[4:7], v[96:99]
ds_read_b64_tr_b16 a[108:109], v13 offset:8960
v_mfma_f32_16x16x32_bf16 v[104:107], a[80:83], a[8:11], v[104:107]
ds_read_b64_tr_b16 a[110:111], v13 offset:9984
s_add_u32 m0, s16, 0x8400
v_mfma_f32_16x16x32_bf16 v[104:107], a[84:87], a[24:27], v[104:107]
buffer_load_dwordx4 v23, s[44:47], s20 offen lds
v_mfma_f32_16x16x32_bf16 v[112:115], a[84:87], a[28:31], v[112:115]
v_mfma_f32_16x16x32_bf16 v[112:115], a[80:83], a[12:15], v[112:115]
v_mfma_f32_16x16x32_bf16 v[116:119], a[88:91], a[12:15], v[116:119]
ds_read_b64_tr_b16 a[80:81], v14 offset:0
v_mfma_f32_16x16x32_bf16 v[116:119], a[92:95], a[28:31], v[116:119]
ds_read_b64_tr_b16 a[82:83], v14 offset:256
v_mfma_f32_16x16x32_bf16 v[108:111], a[92:95], a[24:27], v[108:111]
ds_read_b64_tr_b16 a[84:85], v14 offset:2048
s_add_u32 m0, s16, 0x8800
v_mfma_f32_16x16x32_bf16 v[108:111], a[88:91], a[8:11], v[108:111]
buffer_load_dwordx4 v22, s[44:47], s21 offen lds
v_mfma_f32_16x16x32_bf16 v[100:103], a[88:91], a[4:7], v[100:103]
ds_read_b64_tr_b16 a[86:87], v14 offset:2304
v_mfma_f32_16x16x32_bf16 v[100:103], a[92:95], a[20:23], v[100:103]
v_mfma_f32_16x16x32_bf16 v[92:95], a[92:95], a[16:19], v[92:95]
v_mfma_f32_16x16x32_bf16 v[92:95], a[88:91], a[0:3], v[92:95]
s_add_u32 s8, s28, 0x4800
s_waitcnt lgkmcnt(4)
v_mfma_f32_16x16x32_bf16 v[120:123], a[96:99], a[0:3], v[120:123]
buffer_store_dwordx4 a[208:211], v16, s[88:91], s8 offen sc1
v_mfma_f32_16x16x32_bf16 v[120:123], a[100:103], a[16:19], v[120:123]
ds_read_b64_tr_b16 a[88:89], v15 offset:0
v_mfma_f32_16x16x32_bf16 v[128:131], a[100:103], a[20:23], v[128:131]
ds_read_b64_tr_b16 a[90:91], v15 offset:256
v_mfma_f32_16x16x32_bf16 v[128:131], a[96:99], a[4:7], v[128:131]
ds_read_b64_tr_b16 a[92:93], v15 offset:2048
v_mfma_f32_16x16x32_bf16 v[136:139], a[96:99], a[8:11], v[136:139]
ds_read_b64_tr_b16 a[94:95], v15 offset:2304
v_mfma_f32_16x16x32_bf16 v[136:139], a[100:103], a[24:27], v[136:139]
s_add_u32 m0, s16, 0x8c00
v_mfma_f32_16x16x32_bf16 v[144:147], a[100:103], a[28:31], v[144:147]
buffer_load_dwordx4 v23, s[44:47], s21 offen lds
v_mfma_f32_16x16x32_bf16 v[144:147], a[96:99], a[12:15], v[144:147]
v_mfma_f32_16x16x32_bf16 v[148:151], a[104:107], a[12:15], v[148:151]
ds_read_b64_tr_b16 a[96:97], v14 offset:4096
v_mfma_f32_16x16x32_bf16 v[148:151], a[108:111], a[28:31], v[148:151]
ds_read_b64_tr_b16 a[98:99], v14 offset:4352
v_mfma_f32_16x16x32_bf16 v[140:143], a[108:111], a[24:27], v[140:143]
ds_read_b64_tr_b16 a[100:101], v14 offset:6144
v_mfma_f32_16x16x32_bf16 v[140:143], a[104:107], a[8:11], v[140:143]
ds_read_b64_tr_b16 a[102:103], v14 offset:6400
s_add_u32 m0, s16, 0x9000
v_mfma_f32_16x16x32_bf16 v[132:135], a[104:107], a[4:7], v[132:135]
buffer_load_dwordx4 v22, s[44:47], s22 offen lds
v_mfma_f32_16x16x32_bf16 v[132:135], a[108:111], a[20:23], v[132:135]
v_mfma_f32_16x16x32_bf16 v[124:127], a[108:111], a[16:19], v[124:127]
v_mfma_f32_16x16x32_bf16 v[124:127], a[104:107], a[0:3], v[124:127]
s_waitcnt lgkmcnt(4)
v_mfma_f32_16x16x32_bf16 v[152:155], a[80:83], a[0:3], v[152:155]
ds_read_b64_tr_b16 a[104:105], v15 offset:4096
s_add_u32 m0, s16, 0x9400
v_mfma_f32_16x16x32_bf16 v[152:155], a[84:87], a[16:19], v[152:155]
buffer_load_dwordx4 v23, s[44:47], s22 offen lds
v_mfma_f32_16x16x32_bf16 v[160:163], a[84:87], a[20:23], v[160:163]
ds_read_b64_tr_b16 a[106:107], v15 offset:4352
v_mfma_f32_16x16x32_bf16 v[160:163], a[80:83], a[4:7], v[160:163]
ds_read_b64_tr_b16 a[108:109], v15 offset:6144
v_mfma_f32_16x16x32_bf16 v[168:171], a[80:83], a[8:11], v[168:171]
ds_read_b64_tr_b16 a[110:111], v15 offset:6400
v_mfma_f32_16x16x32_bf16 v[168:171], a[84:87], a[24:27], v[168:171]
v_mfma_f32_16x16x32_bf16 v[176:179], a[84:87], a[28:31], v[176:179]
s_add_u32 m0, s16, 0x9800
v_mfma_f32_16x16x32_bf16 v[176:179], a[80:83], a[12:15], v[176:179]
buffer_load_dwordx4 v22, s[44:47], s23 offen lds
v_mfma_f32_16x16x32_bf16 v[180:183], a[88:91], a[12:15], v[180:183]
ds_read_b64_tr_b16 a[80:81], v14 offset:8192
v_mfma_f32_16x16x32_bf16 v[180:183], a[92:95], a[28:31], v[180:183]
ds_read_b64_tr_b16 a[82:83], v14 offset:8448
v_mfma_f32_16x16x32_bf16 v[172:175], a[92:95], a[24:27], v[172:175]
ds_read_b64_tr_b16 a[84:85], v14 offset:10240
v_mfma_f32_16x16x32_bf16 v[172:175], a[88:91], a[8:11], v[172:175]
ds_read_b64_tr_b16 a[86:87], v14 offset:10496
s_add_u32 m0, s16, 0x9c00
v_mfma_f32_16x16x32_bf16 v[164:167], a[88:91], a[4:7], v[164:167]
buffer_load_dwordx4 v23, s[44:47], s23 offen lds
v_mfma_f32_16x16x32_bf16 v[164:167], a[92:95], a[20:23], v[164:167]
v_lshl_add_u32 v22, s42, 7, v22
v_lshl_add_u32 v23, s42, 7, v23
v_mfma_f32_16x16x32_bf16 v[156:159], a[92:95], a[16:19], v[156:159]
v_mfma_f32_16x16x32_bf16 v[156:159], a[88:91], a[0:3], v[156:159]
s_waitcnt lgkmcnt(4)
v_mfma_f32_16x16x32_bf16 v[184:187], a[96:99], a[0:3], v[184:187]
ds_read_b64_tr_b16 a[88:89], v15 offset:8192
v_mfma_f32_16x16x32_bf16 v[184:187], a[100:103], a[16:19], v[184:187]
ds_read_b64_tr_b16 a[90:91], v15 offset:8448
s_add_u32 s8, s28, 0x8800
v_mfma_f32_16x16x32_bf16 v[192:195], a[100:103], a[20:23], v[192:195]
buffer_store_dwordx4 a[212:215], v16, s[88:91], s8 offen sc1
v_mfma_f32_16x16x32_bf16 v[192:195], a[96:99], a[4:7], v[192:195]
ds_read_b64_tr_b16 a[92:93], v15 offset:10240
v_mfma_f32_16x16x32_bf16 v[200:203], a[96:99], a[8:11], v[200:203]
ds_read_b64_tr_b16 a[94:95], v15 offset:10496
v_add_u32 v12, 0xffff0000, v12
v_mfma_f32_16x16x32_bf16 v[200:203], a[100:103], a[24:27], v[200:203]
v_add_u32 v13, 0xffff0000, v13
v_add_u32 v14, 0xffff0000, v14
v_mfma_f32_16x16x32_bf16 v[208:211], a[100:103], a[28:31], v[208:211]
v_add_u32 v15, 0xffff0000, v15
v_mfma_f32_16x16x32_bf16 v[208:211], a[96:99], a[12:15], v[208:211]
v_mfma_f32_16x16x32_bf16 v[212:215], a[104:107], a[12:15], v[212:215]
s_waitcnt vmcnt(28) lgkmcnt(0)
v_mfma_f32_16x16x32_bf16 v[212:215], a[108:111], a[28:31], v[212:215]
s_barrier
s_add_u32 m0, s17, 0x10000
v_mfma_f32_16x16x32_bf16 v[204:207], a[108:111], a[24:27], v[204:207]
buffer_load_dwordx4 v5, s[52:55], 0 offen lds
v_mfma_f32_16x16x32_bf16 v[204:207], a[104:107], a[8:11], v[204:207]
ds_read_b64_tr_b16 a[96:97], v12 offset:0
v_mfma_f32_16x16x32_bf16 v[196:199], a[104:107], a[4:7], v[196:199]
ds_read_b64_tr_b16 a[98:99], v12 offset:1024
v_mfma_f32_16x16x32_bf16 v[196:199], a[108:111], a[20:23], v[196:199]
ds_read_b64_tr_b16 a[100:101], v12 offset:8192
v_mfma_f32_16x16x32_bf16 v[188:191], a[108:111], a[16:19], v[188:191]
ds_read_b64_tr_b16 a[102:103], v12 offset:9216
v_mfma_f32_16x16x32_bf16 v[188:191], a[104:107], a[0:3], v[188:191]
s_add_u32 m0, s17, 0x10400
s_waitcnt lgkmcnt(4)
v_mfma_f32_16x16x32_bf16 v[216:219], a[0:3], a[80:83], v[216:219]
buffer_load_dwordx4 v5, s[52:55], s13 offen lds
v_mfma_f32_16x16x32_bf16 v[216:219], a[16:19], a[84:87], v[216:219]
ds_read_b64_tr_b16 a[104:105], v13 offset:0
v_mfma_f32_16x16x32_bf16 v[224:227], a[20:23], a[84:87], v[224:227]
ds_read_b64_tr_b16 a[106:107], v13 offset:1024
v_mfma_f32_16x16x32_bf16 v[224:227], a[4:7], a[80:83], v[224:227]
ds_read_b64_tr_b16 a[108:109], v13 offset:8192
v_mfma_f32_16x16x32_bf16 v[232:235], a[8:11], a[80:83], v[232:235]
ds_read_b64_tr_b16 a[110:111], v13 offset:9216
v_mfma_f32_16x16x32_bf16 v[232:235], a[24:27], a[84:87], v[232:235]
v_mfma_f32_16x16x32_bf16 v[240:243], a[28:31], a[84:87], v[240:243]
s_add_u32 m0, s17, 0x10800
v_mfma_f32_16x16x32_bf16 v[240:243], a[12:15], a[80:83], v[240:243]
buffer_load_dwordx4 v6, s[52:55], 0 offen lds
v_mfma_f32_16x16x32_bf16 v[244:247], a[12:15], a[88:91], v[244:247]
ds_read_b64_tr_b16 a[80:81], v12 offset:256
v_mfma_f32_16x16x32_bf16 v[244:247], a[28:31], a[92:95], v[244:247]
ds_read_b64_tr_b16 a[82:83], v12 offset:1280
v_mfma_f32_16x16x32_bf16 v[236:239], a[24:27], a[92:95], v[236:239]
ds_read_b64_tr_b16 a[84:85], v12 offset:8448
v_mfma_f32_16x16x32_bf16 v[236:239], a[8:11], a[88:91], v[236:239]
ds_read_b64_tr_b16 a[86:87], v12 offset:9472
v_mfma_f32_16x16x32_bf16 v[228:231], a[4:7], a[88:91], v[228:231]
v_mfma_f32_16x16x32_bf16 v[228:231], a[20:23], a[92:95], v[228:231]
s_add_u32 m0, s17, 0x10c00
v_mfma_f32_16x16x32_bf16 v[220:223], a[16:19], a[92:95], v[220:223]
buffer_load_dwordx4 v6, s[52:55], s13 offen lds
v_mfma_f32_16x16x32_bf16 v[220:223], a[0:3], a[88:91], v[220:223]
s_waitcnt lgkmcnt(4)
L_S15:
v_mfma_f32_16x16x32_bf16 v[24:27], a[96:99], a[32:35], v[24:27]
ds_read_b64_tr_b16 a[88:89], v13 offset:256
s_waitcnt vmcnt(23)
v_mfma_f32_16x16x32_bf16 v[24:27], a[100:103], a[48:51], v[24:27]
ds_read_b64_tr_b16 a[90:91], v13 offset:1280
v_mfma_f32_16x16x32_bf16 v[32:35], a[100:103], a[52:55], v[32:35]
ds_read_b64_tr_b16 a[92:93], v13 offset:8448
v_mfma_f32_16x16x32_bf16 v[32:35], a[96:99], a[36:39], v[32:35]
ds_read_b64_tr_b16 a[94:95], v13 offset:9472
v_mfma_f32_16x16x32_bf16 v[40:43], a[96:99], a[40:43], v[40:43]
ds_read_b128 a[0:3], v8 offset:0
s_add_u32 m0, s18, 0x14000
v_mfma_f32_16x16x32_bf16 v[40:43], a[100:103], a[56:59], v[40:43]
buffer_load_dwordx4 v7, s[68:71], 0 offen lds
v_mfma_f32_16x16x32_bf16 v[48:51], a[100:103], a[60:63], v[48:51]
ds_read_b128 a[16:19], v9 offset:0
v_mfma_f32_16x16x32_bf16 v[48:51], a[96:99], a[44:47], v[48:51]
ds_read_b128 a[4:7], v8 offset:2048
v_mfma_f32_16x16x32_bf16 v[52:55], a[104:107], a[44:47], v[52:55]
ds_read_b64_tr_b16 a[96:97], v12 offset:512
v_mfma_f32_16x16x32_bf16 v[52:55], a[108:111], a[60:63], v[52:55]
ds_read_b64_tr_b16 a[98:99], v12 offset:1536
v_mfma_f32_16x16x32_bf16 v[44:47], a[108:111], a[56:59], v[44:47]
ds_read_b64_tr_b16 a[100:101], v12 offset:8704
s_add_u32 s8, s28, 0x4c00
v_mfma_f32_16x16x32_bf16 v[44:47], a[104:107], a[40:43], v[44:47]
buffer_store_dwordx4 a[216:219], v16, s[88:91], s8 offen sc1
v_mfma_f32_16x16x32_bf16 v[36:39], a[104:107], a[36:39], v[36:39]
ds_read_b64_tr_b16 a[102:103], v12 offset:9728
v_mfma_f32_16x16x32_bf16 v[36:39], a[108:111], a[52:55], v[36:39]
ds_read_b128 a[20:23], v9 offset:2048
v_mfma_f32_16x16x32_bf16 v[28:31], a[108:111], a[48:51], v[28:31]
ds_read_b128 a[8:11], v8 offset:4096
v_mfma_f32_16x16x32_bf16 v[28:31], a[104:107], a[32:35], v[28:31]
ds_read_b128 a[24:27], v9 offset:4096
s_waitcnt lgkmcnt(10)
v_mfma_f32_16x16x32_bf16 v[56:59], a[80:83], a[32:35], v[56:59]
ds_read_b64_tr_b16 a[104:105], v13 offset:512
v_mfma_f32_16x16x32_bf16 v[56:59], a[84:87], a[48:51], v[56:59]
ds_read_b64_tr_b16 a[106:107], v13 offset:1536
s_add_u32 m0, s18, 0x15000
v_mfma_f32_16x16x32_bf16 v[64:67], a[84:87], a[52:55], v[64:67]
buffer_load_dwordx4 v7, s[68:71], s25 offen lds
v_mfma_f32_16x16x32_bf16 v[64:67], a[80:83], a[36:39], v[64:67]
ds_read_b64_tr_b16 a[108:109], v13 offset:8704
v_mfma_f32_16x16x32_bf16 v[72:75], a[80:83], a[40:43], v[72:75]
ds_read_b64_tr_b16 a[110:111], v13 offset:9728
v_mfma_f32_16x16x32_bf16 v[72:75], a[84:87], a[56:59], v[72:75]
ds_read_b128 a[12:15], v8 offset:6144
v_mfma_f32_16x16x32_bf16 v[80:83], a[84:87], a[60:63], v[80:83]
ds_read_b128 a[28:31], v9 offset:6144
v_mfma_f32_16x16x32_bf16 v[80:83], a[80:83], a[44:47], v[80:83]
v_mfma_f32_16x16x32_bf16 v[84:87], a[88:91], a[44:47], v[84:87]
ds_read_b64_tr_b16 a[80:81], v12 offset:768
s_add_u32 m0, s18, 0x16000
v_mfma_f32_16x16x32_bf16 v[84:87], a[92:95], a[60:63], v[84:87]
buffer_load_dwordx4 v7, s[68:71], s26 offen lds
v_mfma_f32_16x16x32_bf16 v[76:79], a[92:95], a[56:59], v[76:79]
ds_read_b64_tr_b16 a[82:83], v12 offset:1792
v_lshl_add_u32 v5, s42, 19, v5
v_mfma_f32_16x16x32_bf16 v[76:79], a[88:91], a[40:43], v[76:79]
ds_read_b64_tr_b16 a[84:85], v12 offset:8960
v_lshl_add_u32 v6, s42, 19, v6
v_mfma_f32_16x16x32_bf16 v[68:71], a[88:91], a[36:39], v[68:71]
ds_read_b64_tr_b16 a[86:87], v12 offset:9984
v_lshl_add_u32 v7, s42, 18, v7
v_mfma_f32_16x16x32_bf16 v[68:71], a[92:95], a[52:55], v[68:71]
v_lshl_add_u32 v7, s42, 17, v7
v_mfma_f32_16x16x32_bf16 v[60:63], a[92:95], a[48:51], v[60:63]
v_mfma_f32_16x16x32_bf16 v[60:63], a[88:91], a[32:35], v[60:63]
s_add_u32 m0, s16, 0x0
s_waitcnt lgkmcnt(4)
s_waitcnt lgkmcnt(6)
v_mfma_f32_16x16x32_bf16 v[88:91], a[96:99], a[32:35], v[88:91]
buffer_load_dwordx4 v22, s[44:47], s20 offen lds
v_mfma_f32_16x16x32_bf16 v[88:91], a[100:103], a[48:51], v[88:91]
ds_read_b64_tr_b16 a[88:89], v13 offset:768
v_mfma_f32_16x16x32_bf16 v[96:99], a[100:103], a[52:55], v[96:99]
ds_read_b64_tr_b16 a[90:91], v13 offset:1792
v_mfma_f32_16x16x32_bf16 v[96:99], a[96:99], a[36:39], v[96:99]
ds_read_b64_tr_b16 a[92:93], v13 offset:8960
v_mfma_f32_16x16x32_bf16 v[104:107], a[96:99], a[40:43], v[104:107]
ds_read_b64_tr_b16 a[94:95], v13 offset:9984
s_add_u32 m0, s16, 0x400
v_mfma_f32_16x16x32_bf16 v[104:107], a[100:103], a[56:59], v[104:107]
buffer_load_dwordx4 v23, s[44:47], s20 offen lds
v_mfma_f32_16x16x32_bf16 v[112:115], a[100:103], a[60:63], v[112:115]
v_mfma_f32_16x16x32_bf16 v[112:115], a[96:99], a[44:47], v[112:115]
v_mfma_f32_16x16x32_bf16 v[116:119], a[104:107], a[44:47], v[116:119]
ds_read_b64_tr_b16 a[96:97], v14 offset:0
v_mfma_f32_16x16x32_bf16 v[116:119], a[108:111], a[60:63], v[116:119]
ds_read_b64_tr_b16 a[98:99], v14 offset:256
v_mfma_f32_16x16x32_bf16 v[108:111], a[108:111], a[56:59], v[108:111]
ds_read_b64_tr_b16 a[100:101], v14 offset:2048
s_add_u32 m0, s16, 0x800
v_mfma_f32_16x16x32_bf16 v[108:111], a[104:107], a[40:43], v[108:111]
buffer_load_dwordx4 v22, s[44:47], s21 offen lds
v_mfma_f32_16x16x32_bf16 v[100:103], a[104:107], a[36:39], v[100:103]
ds_read_b64_tr_b16 a[102:103], v14 offset:2304
v_mfma_f32_16x16x32_bf16 v[100:103], a[108:111], a[52:55], v[100:103]
v_mfma_f32_16x16x32_bf16 v[92:95], a[108:111], a[48:51], v[92:95]
v_mfma_f32_16x16x32_bf16 v[92:95], a[104:107], a[32:35], v[92:95]
s_add_u32 s8, s28, 0x8c00
s_waitcnt lgkmcnt(4)
v_mfma_f32_16x16x32_bf16 v[120:123], a[80:83], a[32:35], v[120:123]
buffer_store_dwordx4 a[220:223], v16, s[88:91], s8 offen sc1
v_mfma_f32_16x16x32_bf16 v[120:123], a[84:87], a[48:51], v[120:123]
ds_read_b64_tr_b16 a[104:105], v15 offset:0
v_mfma_f32_16x16x32_bf16 v[128:131], a[84:87], a[52:55], v[128:131]
ds_read_b64_tr_b16 a[106:107], v15 offset:256
v_mfma_f32_16x16x32_bf16 v[128:131], a[80:83], a[36:39], v[128:131]
ds_read_b64_tr_b16 a[108:109], v15 offset:2048
v_mfma_f32_16x16x32_bf16 v[136:139], a[80:83], a[40:43], v[136:139]
ds_read_b64_tr_b16 a[110:111], v15 offset:2304
v_mfma_f32_16x16x32_bf16 v[136:139], a[84:87], a[56:59], v[136:139]
s_add_u32 m0, s16, 0xc00
v_mfma_f32_16x16x32_bf16 v[144:147], a[84:87], a[60:63], v[144:147]
buffer_load_dwordx4 v23, s[44:47], s21 offen lds
v_mfma_f32_16x16x32_bf16 v[144:147], a[80:83], a[44:47], v[144:147]
v_mfma_f32_16x16x32_bf16 v[148:151], a[88:91], a[44:47], v[148:151]
ds_read_b64_tr_b16 a[80:81], v14 offset:4096
v_mfma_f32_16x16x32_bf16 v[148:151], a[92:95], a[60:63], v[148:151]
ds_read_b64_tr_b16 a[82:83], v14 offset:4352
v_mfma_f32_16x16x32_bf16 v[140:143], a[92:95], a[56:59], v[140:143]
ds_read_b64_tr_b16 a[84:85], v14 offset:6144
v_mfma_f32_16x16x32_bf16 v[140:143], a[88:91], a[40:43], v[140:143]
ds_read_b64_tr_b16 a[86:87], v14 offset:6400
s_add_u32 m0, s16, 0x1000
v_mfma_f32_16x16x32_bf16 v[132:135], a[88:91], a[36:39], v[132:135]
buffer_load_dwordx4 v22, s[44:47], s22 offen lds
v_mfma_f32_16x16x32_bf16 v[132:135], a[92:95], a[52:55], v[132:135]
v_mfma_f32_16x16x32_bf16 v[124:127], a[92:95], a[48:51], v[124:127]
v_mfma_f32_16x16x32_bf16 v[124:127], a[88:91], a[32:35], v[124:127]
s_waitcnt lgkmcnt(4)
v_mfma_f32_16x16x32_bf16 v[152:155], a[96:99], a[32:35], v[152:155]
ds_read_b64_tr_b16 a[88:89], v15 offset:4096
s_add_u32 m0, s16, 0x1400
v_mfma_f32_16x16x32_bf16 v[152:155], a[100:103], a[48:51], v[152:155]
buffer_load_dwordx4 v23, s[44:47], s22 offen lds
v_mfma_f32_16x16x32_bf16 v[160:163], a[100:103], a[52:55], v[160:163]
ds_read_b64_tr_b16 a[90:91], v15 offset:4352
v_mfma_f32_16x16x32_bf16 v[160:163], a[96:99], a[36:39], v[160:163]
ds_read_b64_tr_b16 a[92:93], v15 offset:6144
v_mfma_f32_16x16x32_bf16 v[168:171], a[96:99], a[40:43], v[168:171]
ds_read_b64_tr_b16 a[94:95], v15 offset:6400
v_mfma_f32_16x16x32_bf16 v[168:171], a[100:103], a[56:59], v[168:171]
v_mfma_f32_16x16x32_bf16 v[176:179], a[100:103], a[60:63], v[176:179]
s_add_u32 m0, s16, 0x1800
v_mfma_f32_16x16x32_bf16 v[176:179], a[96:99], a[44:47], v[176:179]
buffer_load_dwordx4 v22, s[44:47], s23 offen lds
v_mfma_f32_16x16x32_bf16 v[180:183], a[104:107], a[44:47], v[180:183]
ds_read_b64_tr_b16 a[96:97], v14 offset:8192
v_mfma_f32_16x16x32_bf16 v[180:183], a[108:111], a[60:63], v[180:183]
ds_read_b64_tr_b16 a[98:99], v14 offset:8448
v_mfma_f32_16x16x32_bf16 v[172:175], a[108:111], a[56:59], v[172:175]
ds_read_b64_tr_b16 a[100:101], v14 offset:10240
v_mfma_f32_16x16x32_bf16 v[172:175], a[104:107], a[40:43], v[172:175]
ds_read_b64_tr_b16 a[102:103], v14 offset:10496
s_add_u32 m0, s16, 0x1c00
v_mfma_f32_16x16x32_bf16 v[164:167], a[104:107], a[36:39], v[164:167]
buffer_load_dwordx4 v23, s[44:47], s23 offen lds
v_mfma_f32_16x16x32_bf16 v[164:167], a[108:111], a[52:55], v[164:167]
v_lshl_add_u32 v22, s42, 7, v22
v_lshl_add_u32 v23, s42, 7, v23
v_mfma_f32_16x16x32_bf16 v[156:159], a[108:111], a[48:51], v[156:159]
v_mfma_f32_16x16x32_bf16 v[156:159], a[104:107], a[32:35], v[156:159]
s_waitcnt lgkmcnt(4)
v_mfma_f32_16x16x32_bf16 v[184:187], a[80:83], a[32:35], v[184:187]
ds_read_b64_tr_b16 a[104:105], v15 offset:8192
v_mfma_f32_16x16x32_bf16 v[184:187], a[84:87], a[48:51], v[184:187]
ds_read_b64_tr_b16 a[106:107], v15 offset:8448
s_add_u32 s8, s28, 0x5000
v_mfma_f32_16x16x32_bf16 v[192:195], a[84:87], a[52:55], v[192:195]
buffer_store_dwordx4 a[224:227], v16, s[88:91], s8 offen sc1
v_mfma_f32_16x16x32_bf16 v[192:195], a[80:83], a[36:39], v[192:195]
ds_read_b64_tr_b16 a[108:109], v15 offset:10240
v_mfma_f32_16x16x32_bf16 v[200:203], a[80:83], a[40:43], v[200:203]
ds_read_b64_tr_b16 a[110:111], v15 offset:10496
v_add_u32 v12, 0x8000, v12
v_mfma_f32_16x16x32_bf16 v[200:203], a[84:87], a[56:59], v[200:203]
v_add_u32 v13, 0x8000, v13
v_add_u32 v14, 0x8000, v14
v_mfma_f32_16x16x32_bf16 v[208:211], a[84:87], a[60:63], v[208:211]
L_padA8:
s_cmp_eq_u32 s95, 1
s_cbranch_scc1 L_padA12
v_add_u32 v15, 0x8000, v15
v_mfma_f32_16x16x32_bf16 v[208:211], a[80:83], a[44:47], v[208:211]
v_mfma_f32_16x16x32_bf16 v[212:215], a[88:91], a[44:47], v[212:215]
s_waitcnt vmcnt(28) lgkmcnt(0)
v_mfma_f32_16x16x32_bf16 v[212:215], a[92:95], a[60:63], v[212:215]
s_barrier
s_add_u32 m0, s17, 0x0
v_mfma_f32_16x16x32_bf16 v[204:207], a[92:95], a[56:59], v[204:207]
buffer_load_dwordx4 v5, s[52:55], 0 offen lds
v_mfma_f32_16x16x32_bf16 v[204:207], a[88:91], a[40:43], v[204:207]
ds_read_b64_tr_b16 a[80:81], v12 offset:0
v_mfma_f32_16x16x32_bf16 v[196:199], a[88:91], a[36:39], v[196:199]
ds_read_b64_tr_b16 a[82:83], v12 offset:1024
v_mfma_f32_16x16x32_bf16 v[196:199], a[92:95], a[52:55], v[196:199]
ds_read_b64_tr_b16 a[84:85], v12 offset:8192
v_mfma_f32_16x16x32_bf16 v[188:191], a[92:95], a[48:51], v[188:191]
ds_read_b64_tr_b16 a[86:87], v12 offset:9216
v_mfma_f32_16x16x32_bf16 v[188:191], a[88:91], a[32:35], v[188:191]
s_add_u32 m0, s17, 0x400
s_waitcnt lgkmcnt(4)
v_mfma_f32_16x16x32_bf16 v[216:219], a[32:35], a[96:99], v[216:219]
buffer_load_dwordx4 v5, s[52:55], s13 offen lds
v_mfma_f32_16x16x32_bf16 v[216:219], a[48:51], a[100:103], v[216:219]
ds_read_b64_tr_b16 a[88:89], v13 offset:0
v_mfma_f32_16x16x32_bf16 v[224:227], a[52:55], a[100:103], v[224:227]
ds_read_b64_tr_b16 a[90:91], v13 offset:1024
v_mfma_f32_16x16x32_bf16 v[224:227], a[36:39], a[96:99], v[224:227]
ds_read_b64_tr_b16 a[92:93], v13 offset:8192
v_mfma_f32_16x16x32_bf16 v[232:235], a[40:43], a[96:99], v[232:235]
ds_read_b64_tr_b16 a[94:95], v13 offset:9216
v_mfma_f32_16x16x32_bf16 v[232:235], a[56:59], a[100:103], v[232:235]
v_mfma_f32_16x16x32_bf16 v[240:243], a[60:63], a[100:103], v[240:243]
s_add_u32 m0, s17, 0x800
v_mfma_f32_16x16x32_bf16 v[240:243], a[44:47], a[96:99], v[240:243]
buffer_load_dwordx4 v6, s[52:55], 0 offen lds
v_mfma_f32_16x16x32_bf16 v[244:247], a[44:47], a[104:107], v[244:247]
ds_read_b64_tr_b16 a[96:97], v12 offset:256
v_mfma_f32_16x16x32_bf16 v[244:247], a[60:63], a[108:111], v[244:247]
ds_read_b64_tr_b16 a[98:99], v12 offset:1280
v_mfma_f32_16x16x32_bf16 v[236:239], a[56:59], a[108:111], v[236:239]
ds_read_b64_tr_b16 a[100:101], v12 offset:8448
v_mfma_f32_16x16x32_bf16 v[236:239], a[40:43], a[104:107], v[236:239]
ds_read_b64_tr_b16 a[102:103], v12 offset:9472
v_mfma_f32_16x16x32_bf16 v[228:231], a[36:39], a[104:107], v[228:231]
v_mfma_f32_16x16x32_bf16 v[228:231], a[52:55], a[108:111], v[228:231]
s_add_u32 m0, s17, 0xc00
v_mfma_f32_16x16x32_bf16 v[220:223], a[48:51], a[108:111], v[220:223]
buffer_load_dwordx4 v6, s[52:55], s13 offen lds
v_mfma_f32_16x16x32_bf16 v[220:223], a[32:35], a[104:107], v[220:223]
s_waitcnt lgkmcnt(4)
L_S16:
v_mfma_f32_16x16x32_bf16 v[24:27], a[80:83], a[0:3], v[24:27]
ds_read_b64_tr_b16 a[104:105], v13 offset:256
s_waitcnt vmcnt(23)
v_mfma_f32_16x16x32_bf16 v[24:27], a[84:87], a[16:19], v[24:27]
ds_read_b64_tr_b16 a[106:107], v13 offset:1280
v_mfma_f32_16x16x32_bf16 v[32:35], a[84:87], a[20:23], v[32:35]
ds_read_b64_tr_b16 a[108:109], v13 offset:8448
v_mfma_f32_16x16x32_bf16 v[32:35], a[80:83], a[4:7], v[32:35]
ds_read_b64_tr_b16 a[110:111], v13 offset:9472
v_mfma_f32_16x16x32_bf16 v[40:43], a[80:83], a[8:11], v[40:43]
ds_read_b128 a[32:35], v8 offset:32768
s_add_u32 m0, s18, 0x4000
v_mfma_f32_16x16x32_bf16 v[40:43], a[84:87], a[24:27], v[40:43]
buffer_load_dwordx4 v7, s[68:71], 0 offen lds
v_mfma_f32_16x16x32_bf16 v[48:51], a[84:87], a[28:31], v[48:51]
ds_read_b128 a[48:51], v9 offset:32768
v_mfma_f32_16x16x32_bf16 v[48:51], a[80:83], a[12:15], v[48:51]
ds_read_b128 a[36:39], v8 offset:34816
v_mfma_f32_16x16x32_bf16 v[52:55], a[88:91], a[12:15], v[52:55]
ds_read_b64_tr_b16 a[80:81], v12 offset:512
v_mfma_f32_16x16x32_bf16 v[52:55], a[92:95], a[28:31], v[52:55]
ds_read_b64_tr_b16 a[82:83], v12 offset:1536
v_mfma_f32_16x16x32_bf16 v[44:47], a[92:95], a[24:27], v[44:47]
ds_read_b64_tr_b16 a[84:85], v12 offset:8704
s_add_u32 s8, s28, 0x9000
v_mfma_f32_16x16x32_bf16 v[44:47], a[88:91], a[8:11], v[44:47]
buffer_store_dwordx4 a[228:231], v16, s[88:91], s8 offen sc1
v_mfma_f32_16x16x32_bf16 v[36:39], a[88:91], a[4:7], v[36:39]
ds_read_b64_tr_b16 a[86:87], v12 offset:9728
v_mfma_f32_16x16x32_bf16 v[36:39], a[92:95], a[20:23], v[36:39]
ds_read_b128 a[52:55], v9 offset:34816
v_mfma_f32_16x16x32_bf16 v[28:31], a[92:95], a[16:19], v[28:31]
ds_read_b128 a[40:43], v8 offset:36864
v_mfma_f32_16x16x32_bf16 v[28:31], a[88:91], a[0:3], v[28:31]
ds_read_b128 a[56:59], v9 offset:36864
s_waitcnt lgkmcnt(10)
v_mfma_f32_16x16x32_bf16 v[56:59], a[96:99], a[0:3], v[56:59]
ds_read_b64_tr_b16 a[88:89], v13 offset:512
v_mfma_f32_16x16x32_bf16 v[56:59], a[100:103], a[16:19], v[56:59]
ds_read_b64_tr_b16 a[90:91], v13 offset:1536
s_add_u32 m0, s18, 0x5000
v_mfma_f32_16x16x32_bf16 v[64:67], a[100:103], a[20:23], v[64:67]
buffer_load_dwordx4 v7, s[68:71], s25 offen lds
v_mfma_f32_16x16x32_bf16 v[64:67], a[96:99], a[4:7], v[64:67]
ds_read_b64_tr_b16 a[92:93], v13 offset:8704
v_mfma_f32_16x16x32_bf16 v[72:75], a[96:99], a[8:11], v[72:75]
ds_read_b64_tr_b16 a[94:95], v13 offset:9728
v_mfma_f32_16x16x32_bf16 v[72:75], a[100:103], a[24:27], v[72:75]
ds_read_b128 a[44:47], v8 offset:38912
v_mfma_f32_16x16x32_bf16 v[80:83], a[100:103], a[28:31], v[80:83]
ds_read_b128 a[60:63], v9 offset:38912
v_mfma_f32_16x16x32_bf16 v[80:83], a[96:99], a[12:15], v[80:83]
v_mfma_f32_16x16x32_bf16 v[84:87], a[104:107], a[12:15], v[84:87]
ds_read_b64_tr_b16 a[96:97], v12 offset:768
s_add_u32 m0, s18, 0x6000
v_mfma_f32_16x16x32_bf16 v[84:87], a[108:111], a[28:31], v[84:87]
buffer_load_dwordx4 v7, s[68:71], s26 offen lds
v_mfma_f32_16x16x32_bf16 v[76:79], a[108:111], a[24:27], v[76:79]
ds_read_b64_tr_b16 a[98:99], v12 offset:1792
v_lshl_add_u32 v5, s42, 19, v5
v_mfma_f32_16x16x32_bf16 v[76:79], a[104:107], a[8:11], v[76:79]
ds_read_b64_tr_b16 a[100:101], v12 offset:8960
v_lshl_add_u32 v6, s42, 19, v6
v_mfma_f32_16x16x32_bf16 v[68:71], a[104:107], a[4:7], v[68:71]
ds_read_b64_tr_b16 a[102:103], v12 offset:9984
v_lshl_add_u32 v7, s42, 18, v7
v_mfma_f32_16x16x32_bf16 v[68:71], a[108:111], a[20:23], v[68:71]
v_lshl_add_u32 v7, s42, 17, v7
v_mfma_f32_16x16x32_bf16 v[60:63], a[108:111], a[16:19], v[60:63]
v_mfma_f32_16x16x32_bf16 v[60:63], a[104:107], a[0:3], v[60:63]
s_add_u32 m0, s16, 0x8000
s_waitcnt lgkmcnt(4)
s_waitcnt lgkmcnt(6)
v_mfma_f32_16x16x32_bf16 v[88:91], a[80:83], a[0:3], v[88:91]
buffer_load_dwordx4 v22, s[44:47], s20 offen lds
v_mfma_f32_16x16x32_bf16 v[88:91], a[84:87], a[16:19], v[88:91]
ds_read_b64_tr_b16 a[104:105], v13 offset:768
v_mfma_f32_16x16x32_bf16 v[96:99], a[84:87], a[20:23], v[96:99]
ds_read_b64_tr_b16 a[106:107], v13 offset:1792
v_mfma_f32_16x16x32_bf16 v[96:99], a[80:83], a[4:7], v[96:99]
ds_read_b64_tr_b16 a[108:109], v13 offset:8960
v_mfma_f32_16x16x32_bf16 v[104:107], a[80:83], a[8:11], v[104:107]
ds_read_b64_tr_b16 a[110:111], v13 offset:9984
s_add_u32 m0, s16, 0x8400
v_mfma_f32_16x16x32_bf16 v[104:107], a[84:87], a[24:27], v[104:107]
buffer_load_dwordx4 v23, s[44:47], s20 offen lds
v_mfma_f32_16x16x32_bf16 v[112:115], a[84:87], a[28:31], v[112:115]
v_mfma_f32_16x16x32_bf16 v[112:115], a[80:83], a[12:15], v[112:115]
v_mfma_f32_16x16x32_bf16 v[116:119], a[88:91], a[12:15], v[116:119]
ds_read_b64_tr_b16 a[80:81], v14 offset:0
v_mfma_f32_16x16x32_bf16 v[116:119], a[92:95], a[28:31], v[116:119]
ds_read_b64_tr_b16 a[82:83], v14 offset:256
v_mfma_f32_16x16x32_bf16 v[108:111], a[92:95], a[24:27], v[108:111]
ds_read_b64_tr_b16 a[84:85], v14 offset:2048
s_add_u32 m0, s16, 0x8800
v_mfma_f32_16x16x32_bf16 v[108:111], a[88:91], a[8:11], v[108:111]
buffer_load_dwordx4 v22, s[44:47], s21 offen lds
v_mfma_f32_16x16x32_bf16 v[100:103], a[88:91], a[4:7], v[100:103]
ds_read_b64_tr_b16 a[86:87], v14 offset:2304
v_mfma_f32_16x16x32_bf16 v[100:103], a[92:95], a[20:23], v[100:103]
v_mfma_f32_16x16x32_bf16 v[92:95], a[92:95], a[16:19], v[92:95]
v_mfma_f32_16x16x32_bf16 v[92:95], a[88:91], a[0:3], v[92:95]
s_add_u32 s8, s28, 0x5400
s_waitcnt lgkmcnt(4)
v_mfma_f32_16x16x32_bf16 v[120:123], a[96:99], a[0:3], v[120:123]
buffer_store_dwordx4 a[112:115], v16, s[88:91], s8 offen sc1
v_mfma_f32_16x16x32_bf16 v[120:123], a[100:103], a[16:19], v[120:123]
ds_read_b64_tr_b16 a[88:89], v15 offset:0
v_mfma_f32_16x16x32_bf16 v[128:131], a[100:103], a[20:23], v[128:131]
ds_read_b64_tr_b16 a[90:91], v15 offset:256
v_mfma_f32_16x16x32_bf16 v[128:131], a[96:99], a[4:7], v[128:131]
ds_read_b64_tr_b16 a[92:93], v15 offset:2048
v_mfma_f32_16x16x32_bf16 v[136:139], a[96:99], a[8:11], v[136:139]
ds_read_b64_tr_b16 a[94:95], v15 offset:2304
v_mfma_f32_16x16x32_bf16 v[136:139], a[100:103], a[24:27], v[136:139]
s_add_u32 m0, s16, 0x8c00
v_mfma_f32_16x16x32_bf16 v[144:147], a[100:103], a[28:31], v[144:147]
buffer_load_dwordx4 v23, s[44:47], s21 offen lds
v_mfma_f32_16x16x32_bf16 v[144:147], a[96:99], a[12:15], v[144:147]
v_mfma_f32_16x16x32_bf16 v[148:151], a[104:107], a[12:15], v[148:151]
ds_read_b64_tr_b16 a[96:97], v14 offset:4096
v_mfma_f32_16x16x32_bf16 v[148:151], a[108:111], a[28:31], v[148:151]
ds_read_b64_tr_b16 a[98:99], v14 offset:4352
v_mfma_f32_16x16x32_bf16 v[140:143], a[108:111], a[24:27], v[140:143]
ds_read_b64_tr_b16 a[100:101], v14 offset:6144
v_mfma_f32_16x16x32_bf16 v[140:143], a[104:107], a[8:11], v[140:143]
ds_read_b64_tr_b16 a[102:103], v14 offset:6400
s_add_u32 m0, s16, 0x9000
v_mfma_f32_16x16x32_bf16 v[132:135], a[104:107], a[4:7], v[132:135]
buffer_load_dwordx4 v22, s[44:47], s22 offen lds
v_mfma_f32_16x16x32_bf16 v[132:135], a[108:111], a[20:23], v[132:135]
v_mfma_f32_16x16x32_bf16 v[124:127], a[108:111], a[16:19], v[124:127]
v_mfma_f32_16x16x32_bf16 v[124:127], a[104:107], a[0:3], v[124:127]
s_waitcnt lgkmcnt(4)
v_mfma_f32_16x16x32_bf16 v[152:155], a[80:83], a[0:3], v[152:155]
ds_read_b64_tr_b16 a[104:105], v15 offset:4096
s_add_u32 m0, s16, 0x9400
v_mfma_f32_16x16x32_bf16 v[152:155], a[84:87], a[16:19], v[152:155]
buffer_load_dwordx4 v23, s[44:47], s22 offen lds
v_mfma_f32_16x16x32_bf16 v[160:163], a[84:87], a[20:23], v[160:163]
ds_read_b64_tr_b16 a[106:107], v15 offset:4352
v_mfma_f32_16x16x32_bf16 v[160:163], a[80:83], a[4:7], v[160:163]
ds_read_b64_tr_b16 a[108:109], v15 offset:6144
v_mfma_f32_16x16x32_bf16 v[168:171], a[80:83], a[8:11], v[168:171]
ds_read_b64_tr_b16 a[110:111], v15 offset:6400
v_mfma_f32_16x16x32_bf16 v[168:171], a[84:87], a[24:27], v[168:171]
v_mfma_f32_16x16x32_bf16 v[176:179], a[84:87], a[28:31], v[176:179]
s_add_u32 m0, s16, 0x9800
v_mfma_f32_16x16x32_bf16 v[176:179], a[80:83], a[12:15], v[176:179]
buffer_load_dwordx4 v22, s[44:47], s23 offen lds
v_mfma_f32_16x16x32_bf16 v[180:183], a[88:91], a[12:15], v[180:183]
ds_read_b64_tr_b16 a[80:81], v14 offset:8192
v_mfma_f32_16x16x32_bf16 v[180:183], a[92:95], a[28:31], v[180:183]
ds_read_b64_tr_b16 a[82:83], v14 offset:8448
v_mfma_f32_16x16x32_bf16 v[172:175], a[92:95], a[24:27], v[172:175]
ds_read_b64_tr_b16 a[84:85], v14 offset:10240
v_mfma_f32_16x16x32_bf16 v[172:175], a[88:91], a[8:11], v[172:175]
ds_read_b64_tr_b16 a[86:87], v14 offset:10496
s_add_u32 m0, s16, 0x9c00
v_mfma_f32_16x16x32_bf16 v[164:167], a[88:91], a[4:7], v[164:167]
buffer_load_dwordx4 v23, s[44:47], s23 offen lds
v_mfma_f32_16x16x32_bf16 v[164:167], a[92:95], a[20:23], v[164:167]
v_lshl_add_u32 v22, s42, 7, v22
v_lshl_add_u32 v23, s42, 7, v23
v_mfma_f32_16x16x32_bf16 v[156:159], a[92:95], a[16:19], v[156:159]
v_mfma_f32_16x16x32_bf16 v[156:159], a[88:91], a[0:3], v[156:159]
s_waitcnt lgkmcnt(4)
v_mfma_f32_16x16x32_bf16 v[184:187], a[96:99], a[0:3], v[184:187]
ds_read_b64_tr_b16 a[88:89], v15 offset:8192
v_mfma_f32_16x16x32_bf16 v[184:187], a[100:103], a[16:19], v[184:187]
ds_read_b64_tr_b16 a[90:91], v15 offset:8448
s_add_u32 s8, s28, 0x9400
v_mfma_f32_16x16x32_bf16 v[192:195], a[100:103], a[20:23], v[192:195]
buffer_store_dwordx4 a[116:119], v16, s[88:91], s8 offen sc1
v_mfma_f32_16x16x32_bf16 v[192:195], a[96:99], a[4:7], v[192:195]
ds_read_b64_tr_b16 a[92:93], v15 offset:10240
v_mfma_f32_16x16x32_bf16 v[200:203], a[96:99], a[8:11], v[200:203]
ds_read_b64_tr_b16 a[94:95], v15 offset:10496
v_add_u32 v12, 0x8000, v12
v_mfma_f32_16x16x32_bf16 v[200:203], a[100:103], a[24:27], v[200:203]
v_add_u32 v13, 0x8000, v13
v_add_u32 v14, 0x8000, v14
v_mfma_f32_16x16x32_bf16 v[208:211], a[100:103], a[28:31], v[208:211]
v_add_u32 v15, 0x8000, v15
v_mfma_f32_16x16x32_bf16 v[208:211], a[96:99], a[12:15], v[208:211]
v_mfma_f32_16x16x32_bf16 v[212:215], a[104:107], a[12:15], v[212:215]
s_waitcnt vmcnt(28) lgkmcnt(0)
v_mfma_f32_16x16x32_bf16 v[212:215], a[108:111], a[28:31], v[212:215]
s_barrier
s_add_u32 m0, s17, 0x8000
v_mfma_f32_16x16x32_bf16 v[204:207], a[108:111], a[24:27], v[204:207]
buffer_load_dwordx4 v5, s[52:55], 0 offen lds
v_mfma_f32_16x16x32_bf16 v[204:207], a[104:107], a[8:11], v[204:207]
ds_read_b64_tr_b16 a[96:97], v12 offset:0
v_mfma_f32_16x16x32_bf16 v[196:199], a[104:107], a[4:7], v[196:199]
ds_read_b64_tr_b16 a[98:99], v12 offset:1024
v_mfma_f32_16x16x32_bf16 v[196:199], a[108:111], a[20:23], v[196:199]
ds_read_b64_tr_b16 a[100:101], v12 offset:8192
v_mfma_f32_16x16x32_bf16 v[188:191], a[108:111], a[16:19], v[188:191]
ds_read_b64_tr_b16 a[102:103], v12 offset:9216
v_mfma_f32_16x16x32_bf16 v[188:191], a[104:107], a[0:3], v[188:191]
s_add_u32 m0, s17, 0x8400
s_waitcnt lgkmcnt(4)
v_mfma_f32_16x16x32_bf16 v[216:219], a[0:3], a[80:83], v[216:219]
buffer_load_dwordx4 v5, s[52:55], s13 offen lds
v_mfma_f32_16x16x32_bf16 v[216:219], a[16:19], a[84:87], v[216:219]
ds_read_b64_tr_b16 a[104:105], v13 offset:0
v_mfma_f32_16x16x32_bf16 v[224:227], a[20:23], a[84:87], v[224:227]
ds_read_b64_tr_b16 a[106:107], v13 offset:1024
v_mfma_f32_16x16x32_bf16 v[224:227], a[4:7], a[80:83], v[224:227]
ds_read_b64_tr_b16 a[108:109], v13 offset:8192
v_mfma_f32_16x16x32_bf16 v[232:235], a[8:11], a[80:83], v[232:235]
ds_read_b64_tr_b16 a[110:111], v13 offset:9216
v_mfma_f32_16x16x32_bf16 v[232:235], a[24:27], a[84:87], v[232:235]
s_add_u32 m0, s17, 0x8800
v_mfma_f32_16x16x32_bf16 v[240:243], a[28:31], a[84:87], v[240:243]
buffer_load_dwordx4 v6, s[52:55], 0 offen lds
v_mfma_f32_16x16x32_bf16 v[240:243], a[12:15], a[80:83], v[240:243]
v_mfma_f32_16x16x32_bf16 v[244:247], a[12:15], a[88:91], v[244:247]
ds_read_b64_tr_b16 a[80:81], v12 offset:256
v_mfma_f32_16x16x32_bf16 v[244:247], a[28:31], a[92:95], v[244:247]
ds_read_b64_tr_b16 a[82:83], v12 offset:1280
v_mfma_f32_16x16x32_bf16 v[236:239], a[24:27], a[92:95], v[236:239]
ds_read_b64_tr_b16 a[84:85], v12 offset:8448
v_mfma_f32_16x16x32_bf16 v[236:239], a[8:11], a[88:91], v[236:239]
ds_read_b64_tr_b16 a[86:87], v12 offset:9472
s_add_u32 s8, s28, 0x5800
v_mfma_f32_16x16x32_bf16 v[228:231], a[4:7], a[88:91], v[228:231]
buffer_store_dwordx4 a[124:127], v16, s[88:91], s8 offen sc1
v_mfma_f32_16x16x32_bf16 v[228:231], a[20:23], a[92:95], v[228:231]
v_mfma_f32_16x16x32_bf16 v[220:223], a[16:19], a[92:95], v[220:223]
v_mfma_f32_16x16x32_bf16 v[220:223], a[0:3], a[88:91], v[220:223]
s_waitcnt lgkmcnt(4)
L_S17:
v_mfma_f32_16x16x32_bf16 v[24:27], a[96:99], a[32:35], v[24:27]
ds_read_b64_tr_b16 a[88:89], v13 offset:256
s_waitcnt vmcnt(23)
v_mfma_f32_16x16x32_bf16 v[24:27], a[100:103], a[48:51], v[24:27]
ds_read_b64_tr_b16 a[90:91], v13 offset:1280
s_add_u32 m0, s17, 0x8c00
v_mfma_f32_16x16x32_bf16 v[32:35], a[100:103], a[52:55], v[32:35]
buffer_load_dwordx4 v6, s[52:55], s13 offen lds
v_mfma_f32_16x16x32_bf16 v[32:35], a[96:99], a[36:39], v[32:35]
ds_read_b64_tr_b16 a[92:93], v13 offset:8448
v_mfma_f32_16x16x32_bf16 v[40:43], a[96:99], a[40:43], v[40:43]
ds_read_b64_tr_b16 a[94:95], v13 offset:9472
v_mfma_f32_16x16x32_bf16 v[40:43], a[100:103], a[56:59], v[40:43]
ds_read_b128 a[0:3], v8 offset:0
v_mfma_f32_16x16x32_bf16 v[48:51], a[100:103], a[60:63], v[48:51]
ds_read_b128 a[16:19], v9 offset:0
v_mfma_f32_16x16x32_bf16 v[48:51], a[96:99], a[44:47], v[48:51]
ds_read_b128 a[4:7], v8 offset:2048
s_add_u32 m0, s18, 0xc000
v_mfma_f32_16x16x32_bf16 v[52:55], a[104:107], a[44:47], v[52:55]
buffer_load_dwordx4 v7, s[68:71], 0 offen lds
v_mfma_f32_16x16x32_bf16 v[52:55], a[108:111], a[60:63], v[52:55]
ds_read_b64_tr_b16 a[96:97], v12 offset:512
v_mfma_f32_16x16x32_bf16 v[44:47], a[108:111], a[56:59], v[44:47]
ds_read_b64_tr_b16 a[98:99], v12 offset:1536
v_mfma_f32_16x16x32_bf16 v[44:47], a[104:107], a[40:43], v[44:47]
ds_read_b64_tr_b16 a[100:101], v12 offset:8704
v_mfma_f32_16x16x32_bf16 v[36:39], a[104:107], a[36:39], v[36:39]
ds_read_b64_tr_b16 a[102:103], v12 offset:9728
v_mfma_f32_16x16x32_bf16 v[36:39], a[108:111], a[52:55], v[36:39]
ds_read_b128 a[20:23], v9 offset:2048
s_add_u32 m0, s18, 0xd000
v_mfma_f32_16x16x32_bf16 v[28:31], a[108:111], a[48:51], v[28:31]
buffer_load_dwordx4 v7, s[68:71], s25 offen lds
v_mfma_f32_16x16x32_bf16 v[28:31], a[104:107], a[32:35], v[28:31]
ds_read_b128 a[8:11], v8 offset:4096
s_waitcnt lgkmcnt(9)
v_mfma_f32_16x16x32_bf16 v[56:59], a[80:83], a[32:35], v[56:59]
ds_read_b64_tr_b16 a[104:105], v13 offset:512
v_mfma_f32_16x16x32_bf16 v[56:59], a[84:87], a[48:51], v[56:59]
ds_read_b64_tr_b16 a[106:107], v13 offset:1536
v_mfma_f32_16x16x32_bf16 v[64:67], a[84:87], a[52:55], v[64:67]
ds_read_b64_tr_b16 a[108:109], v13 offset:8704
v_mfma_f32_16x16x32_bf16 v[64:67], a[80:83], a[36:39], v[64:67]
ds_read_b64_tr_b16 a[110:111], v13 offset:9728
s_add_u32 m0, s18, 0xe000
v_mfma_f32_16x16x32_bf16 v[72:75], a[80:83], a[40:43], v[72:75]
buffer_load_dwordx4 v7, s[68:71], s26 offen lds
v_mfma_f32_16x16x32_bf16 v[72:75], a[84:87], a[56:59], v[72:75]
ds_read_b128 a[24:27], v9 offset:4096
v_lshl_add_u32 v5, s42, 19, v5
v_mfma_f32_16x16x32_bf16 v[80:83], a[84:87], a[60:63], v[80:83]
ds_read_b128 a[12:15], v8 offset:6144
v_lshl_add_u32 v6, s42, 19, v6
v_mfma_f32_16x16x32_bf16 v[80:83], a[80:83], a[44:47], v[80:83]
ds_read_b128 a[28:31], v9 offset:6144
v_lshl_add_u32 v7, s42, 18, v7
v_mfma_f32_16x16x32_bf16 v[84:87], a[88:91], a[44:47], v[84:87]
ds_read_b64_tr_b16 a[80:81], v12 offset:768
v_lshl_add_u32 v7, s42, 17, v7
v_mfma_f32_16x16x32_bf16 v[84:87], a[92:95], a[60:63], v[84:87]
ds_read_b64_tr_b16 a[82:83], v12 offset:1792
s_add_u32 s8, s28, 0x9800
v_mfma_f32_16x16x32_bf16 v[76:79], a[92:95], a[56:59], v[76:79]
buffer_store_dwordx4 a[232:235], v16, s[88:91], s8 offen sc1
v_mfma_f32_16x16x32_bf16 v[76:79], a[88:91], a[40:43], v[76:79]
ds_read_b64_tr_b16 a[84:85], v12 offset:8960
v_mfma_f32_16x16x32_bf16 v[68:71], a[88:91], a[36:39], v[68:71]
ds_read_b64_tr_b16 a[86:87], v12 offset:9984
v_mfma_f32_16x16x32_bf16 v[68:71], a[92:95], a[52:55], v[68:71]
v_mfma_f32_16x16x32_bf16 v[60:63], a[92:95], a[48:51], v[60:63]
v_mfma_f32_16x16x32_bf16 v[60:63], a[88:91], a[32:35], v[60:63]
s_add_u32 m0, s16, 0x0
s_waitcnt lgkmcnt(4)
s_waitcnt lgkmcnt(7)
v_mfma_f32_16x16x32_bf16 v[88:91], a[96:99], a[32:35], v[88:91]
buffer_load_dwordx4 v22, s[44:47], s20 offen lds
v_mfma_f32_16x16x32_bf16 v[88:91], a[100:103], a[48:51], v[88:91]
ds_read_b64_tr_b16 a[88:89], v13 offset:768
v_mfma_f32_16x16x32_bf16 v[96:99], a[100:103], a[52:55], v[96:99]
ds_read_b64_tr_b16 a[90:91], v13 offset:1792
v_mfma_f32_16x16x32_bf16 v[96:99], a[96:99], a[36:39], v[96:99]
ds_read_b64_tr_b16 a[92:93], v13 offset:8960
v_mfma_f32_16x16x32_bf16 v[104:107], a[96:99], a[40:43], v[104:107]
ds_read_b64_tr_b16 a[94:95], v13 offset:9984
s_add_u32 m0, s16, 0x400
v_mfma_f32_16x16x32_bf16 v[104:107], a[100:103], a[56:59], v[104:107]
buffer_load_dwordx4 v23, s[44:47], s20 offen lds
v_mfma_f32_16x16x32_bf16 v[112:115], a[100:103], a[60:63], v[112:115]
v_mfma_f32_16x16x32_bf16 v[112:115], a[96:99], a[44:47], v[112:115]
v_mfma_f32_16x16x32_bf16 v[116:119], a[104:107], a[44:47], v[116:119]
ds_read_b64_tr_b16 a[96:97], v14 offset:0
v_mfma_f32_16x16x32_bf16 v[116:119], a[108:111], a[60:63], v[116:119]
ds_read_b64_tr_b16 a[98:99], v14 offset:256
v_mfma_f32_16x16x32_bf16 v[108:111], a[108:111], a[56:59], v[108:111]
ds_read_b64_tr_b16 a[100:101], v14 offset:2048
s_add_u32 m0, s16, 0x800
v_mfma_f32_16x16x32_bf16 v[108:111], a[104:107], a[40:43], v[108:111]
buffer_load_dwordx4 v22, s[44:47], s21 offen lds
v_mfma_f32_16x16x32_bf16 v[100:103], a[104:107], a[36:39], v[100:103]
ds_read_b64_tr_b16 a[102:103], v14 offset:2304
v_mfma_f32_16x16x32_bf16 v[100:103], a[108:111], a[52:55], v[100:103]
v_mfma_f32_16x16x32_bf16 v[92:95], a[108:111], a[48:51], v[92:95]
v_mfma_f32_16x16x32_bf16 v[92:95], a[104:107], a[32:35], v[92:95]
s_add_u32 m0, s16, 0xc00
s_waitcnt lgkmcnt(4)
v_mfma_f32_16x16x32_bf16 v[120:123], a[80:83], a[32:35], v[120:123]
buffer_load_dwordx4 v23, s[44:47], s21 offen lds
v_mfma_f32_16x16x32_bf16 v[120:123], a[84:87], a[48:51], v[120:123]
ds_read_b64_tr_b16 a[104:105], v15 offset:0
v_mfma_f32_16x16x32_bf16 v[128:131], a[84:87], a[52:55], v[128:131]
ds_read_b64_tr_b16 a[106:107], v15 offset:256
v_mfma_f32_16x16x32_bf16 v[128:131], a[80:83], a[36:39], v[128:131]
ds_read_b64_tr_b16 a[108:109], v15 offset:2048
v_mfma_f32_16x16x32_bf16 v[136:139], a[80:83], a[40:43], v[136:139]
ds_read_b64_tr_b16 a[110:111], v15 offset:2304
v_mfma_f32_16x16x32_bf16 v[136:139], a[84:87], a[56:59], v[136:139]
s_add_u32 s8, s28, 0x5c00
v_mfma_f32_16x16x32_bf16 v[144:147], a[84:87], a[60:63], v[144:147]
buffer_store_dwordx4 a[240:243], v16, s[88:91], s8 offen sc1
v_mfma_f32_16x16x32_bf16 v[144:147], a[80:83], a[44:47], v[144:147]
v_mfma_f32_16x16x32_bf16 v[148:151], a[88:91], a[44:47], v[148:151]
ds_read_b64_tr_b16 a[80:81], v14 offset:4096
v_mfma_f32_16x16x32_bf16 v[148:151], a[92:95], a[60:63], v[148:151]
ds_read_b64_tr_b16 a[82:83], v14 offset:4352
v_mfma_f32_16x16x32_bf16 v[140:143], a[92:95], a[56:59], v[140:143]
ds_read_b64_tr_b16 a[84:85], v14 offset:6144
v_mfma_f32_16x16x32_bf16 v[140:143], a[88:91], a[40:43], v[140:143]
ds_read_b64_tr_b16 a[86:87], v14 offset:6400
s_add_u32 m0, s16, 0x1000
v_mfma_f32_16x16x32_bf16 v[132:135], a[88:91], a[36:39], v[132:135]
buffer_load_dwordx4 v22, s[44:47], s22 offen lds
v_mfma_f32_16x16x32_bf16 v[132:135], a[92:95], a[52:55], v[132:135]
v_mfma_f32_16x16x32_bf16 v[124:127], a[92:95], a[48:51], v[124:127]
v_mfma_f32_16x16x32_bf16 v[124:127], a[88:91], a[32:35], v[124:127]
s_waitcnt lgkmcnt(4)
v_mfma_f32_16x16x32_bf16 v[152:155], a[96:99], a[32:35], v[152:155]
ds_read_b64_tr_b16 a[88:89], v15 offset:4096
s_add_u32 m0, s16, 0x1400
v_mfma_f32_16x16x32_bf16 v[152:155], a[100:103], a[48:51], v[152:155]
buffer_load_dwordx4 v23, s[44:47], s22 offen lds
v_mfma_f32_16x16x32_bf16 v[160:163], a[100:103], a[52:55], v[160:163]
ds_read_b64_tr_b16 a[90:91], v15 offset:4352
v_mfma_f32_16x16x32_bf16 v[160:163], a[96:99], a[36:39], v[160:163]
ds_read_b64_tr_b16 a[92:93], v15 offset:6144
v_mfma_f32_16x16x32_bf16 v[168:171], a[96:99], a[40:43], v[168:171]
ds_read_b64_tr_b16 a[94:95], v15 offset:6400
v_mfma_f32_16x16x32_bf16 v[168:171], a[100:103], a[56:59], v[168:171]
v_mfma_f32_16x16x32_bf16 v[176:179], a[100:103], a[60:63], v[176:179]
s_add_u32 m0, s16, 0x1800
v_mfma_f32_16x16x32_bf16 v[176:179], a[96:99], a[44:47], v[176:179]
buffer_load_dwordx4 v22, s[44:47], s23 offen lds
v_mfma_f32_16x16x32_bf16 v[180:183], a[104:107], a[44:47], v[180:183]
ds_read_b64_tr_b16 a[96:97], v14 offset:8192
v_mfma_f32_16x16x32_bf16 v[180:183], a[108:111], a[60:63], v[180:183]
ds_read_b64_tr_b16 a[98:99], v14 offset:8448
v_mfma_f32_16x16x32_bf16 v[172:175], a[108:111], a[56:59], v[172:175]
ds_read_b64_tr_b16 a[100:101], v14 offset:10240
v_mfma_f32_16x16x32_bf16 v[172:175], a[104:107], a[40:43], v[172:175]
ds_read_b64_tr_b16 a[102:103], v14 offset:10496
s_add_u32 m0, s16, 0x1c00
v_mfma_f32_16x16x32_bf16 v[164:167], a[104:107], a[36:39], v[164:167]
buffer_load_dwordx4 v23, s[44:47], s23 offen lds
v_mfma_f32_16x16x32_bf16 v[164:167], a[108:111], a[52:55], v[164:167]
v_lshl_add_u32 v22, s42, 7, v22
v_lshl_add_u32 v23, s42, 7, v23
v_mfma_f32_16x16x32_bf16 v[156:159], a[108:111], a[48:51], v[156:159]
v_mfma_f32_16x16x32_bf16 v[156:159], a[104:107], a[32:35], v[156:159]
s_waitcnt lgkmcnt(4)
v_mfma_f32_16x16x32_bf16 v[184:187], a[80:83], a[32:35], v[184:187]
ds_read_b64_tr_b16 a[104:105], v15 offset:8192
v_mfma_f32_16x16x32_bf16 v[184:187], a[84:87], a[48:51], v[184:187]
ds_read_b64_tr_b16 a[106:107], v15 offset:8448
s_add_u32 s8, s28, 0x9c00
v_mfma_f32_16x16x32_bf16 v[192:195], a[84:87], a[52:55], v[192:195]
buffer_store_dwordx4 a[248:251], v16, s[88:91], s8 offen sc1
v_mfma_f32_16x16x32_bf16 v[192:195], a[80:83], a[36:39], v[192:195]
ds_read_b64_tr_b16 a[108:109], v15 offset:10240
v_mfma_f32_16x16x32_bf16 v[200:203], a[80:83], a[40:43], v[200:203]
ds_read_b64_tr_b16 a[110:111], v15 offset:10496
v_add_u32 v12, 0xffff0000, v12
v_mfma_f32_16x16x32_bf16 v[200:203], a[84:87], a[56:59], v[200:203]
v_add_u32 v13, 0xffff0000, v13
v_add_u32 v14, 0xffff0000, v14
v_mfma_f32_16x16x32_bf16 v[208:211], a[84:87], a[60:63], v[208:211]
v_add_u32 v15, 0xffff0000, v15
v_mfma_f32_16x16x32_bf16 v[208:211], a[80:83], a[44:47], v[208:211]
v_mfma_f32_16x16x32_bf16 v[212:215], a[88:91], a[44:47], v[212:215]
s_waitcnt vmcnt(29) lgkmcnt(0)
v_mfma_f32_16x16x32_bf16 v[212:215], a[92:95], a[60:63], v[212:215]
s_barrier
s_add_u32 m0, s17, 0x10000
v_mfma_f32_16x16x32_bf16 v[204:207], a[92:95], a[56:59], v[204:207]
buffer_load_dwordx4 v5, s[52:55], 0 offen lds
v_mfma_f32_16x16x32_bf16 v[204:207], a[88:91], a[40:43], v[204:207]
ds_read_b64_tr_b16 a[80:81], v12 offset:0
v_mfma_f32_16x16x32_bf16 v[196:199], a[88:91], a[36:39], v[196:199]
ds_read_b64_tr_b16 a[82:83], v12 offset:1024
v_mfma_f32_16x16x32_bf16 v[196:199], a[92:95], a[52:55], v[196:199]
ds_read_b64_tr_b16 a[84:85], v12 offset:8192
v_mfma_f32_16x16x32_bf16 v[188:191], a[92:95], a[48:51], v[188:191]
ds_read_b64_tr_b16 a[86:87], v12 offset:9216
v_mfma_f32_16x16x32_bf16 v[188:191], a[88:91], a[32:35], v[188:191]
s_add_u32 m0, s17, 0x10400
s_waitcnt lgkmcnt(4)
v_mfma_f32_16x16x32_bf16 v[216:219], a[32:35], a[96:99], v[216:219]
buffer_load_dwordx4 v5, s[52:55], s13 offen lds
v_mfma_f32_16x16x32_bf16 v[216:219], a[48:51], a[100:103], v[216:219]
ds_read_b64_tr_b16 a[88:89], v13 offset:0
v_mfma_f32_16x16x32_bf16 v[224:227], a[52:55], a[100:103], v[224:227]
ds_read_b64_tr_b16 a[90:91], v13 offset:1024
v_mfma_f32_16x16x32_bf16 v[224:227], a[36:39], a[96:99], v[224:227]
ds_read_b64_tr_b16 a[92:93], v13 offset:8192
v_mfma_f32_16x16x32_bf16 v[232:235], a[40:43], a[96:99], v[232:235]
ds_read_b64_tr_b16 a[94:95], v13 offset:9216
v_mfma_f32_16x16x32_bf16 v[232:235], a[56:59], a[100:103], v[232:235]
v_mfma_f32_16x16x32_bf16 v[240:243], a[60:63], a[100:103], v[240:243]
s_add_u32 m0, s17, 0x10800
v_mfma_f32_16x16x32_bf16 v[240:243], a[44:47], a[96:99], v[240:243]
buffer_load_dwordx4 v6, s[52:55], 0 offen lds
v_mfma_f32_16x16x32_bf16 v[244:247], a[44:47], a[104:107], v[244:247]
ds_read_b64_tr_b16 a[96:97], v12 offset:256
v_mfma_f32_16x16x32_bf16 v[244:247], a[60:63], a[108:111], v[244:247]
ds_read_b64_tr_b16 a[98:99], v12 offset:1280
v_mfma_f32_16x16x32_bf16 v[236:239], a[56:59], a[108:111], v[236:239]
ds_read_b64_tr_b16 a[100:101], v12 offset:8448
v_mfma_f32_16x16x32_bf16 v[236:239], a[40:43], a[104:107], v[236:239]
ds_read_b64_tr_b16 a[102:103], v12 offset:9472
v_mfma_f32_16x16x32_bf16 v[228:231], a[36:39], a[104:107], v[228:231]
v_mfma_f32_16x16x32_bf16 v[228:231], a[52:55], a[108:111], v[228:231]
s_add_u32 m0, s17, 0x10c00
v_mfma_f32_16x16x32_bf16 v[220:223], a[48:51], a[108:111], v[220:223]
buffer_load_dwordx4 v6, s[52:55], s13 offen lds
v_mfma_f32_16x16x32_bf16 v[220:223], a[32:35], a[104:107], v[220:223]
s_waitcnt lgkmcnt(4)
L_S18:
v_mfma_f32_16x16x32_bf16 v[24:27], a[80:83], a[0:3], v[24:27]
ds_read_b64_tr_b16 a[104:105], v13 offset:256
s_waitcnt vmcnt(24)
v_mfma_f32_16x16x32_bf16 v[24:27], a[84:87], a[16:19], v[24:27]
ds_read_b64_tr_b16 a[106:107], v13 offset:1280
L_padA9:
s_cmp_eq_u32 s95, 1
s_cbranch_scc1 L_hopA_ret
v_mfma_f32_16x16x32_bf16 v[32:35], a[84:87], a[20:23], v[32:35]
ds_read_b64_tr_b16 a[108:109], v13 offset:8448
v_mfma_f32_16x16x32_bf16 v[32:35], a[80:83], a[4:7], v[32:35]
ds_read_b64_tr_b16 a[110:111], v13 offset:9472
v_mfma_f32_16x16x32_bf16 v[40:43], a[80:83], a[8:11], v[40:43]
ds_read_b128 a[32:35], v8 offset:32768
s_add_u32 m0, s18, 0x14000
v_mfma_f32_16x16x32_bf16 v[40:43], a[84:87], a[24:27], v[40:43]
buffer_load_dwordx4 v7, s[68:71], 0 offen lds
v_mfma_f32_16x16x32_bf16 v[48:51], a[84:87], a[28:31], v[48:51]
ds_read_b128 a[48:51], v9 offset:32768
v_mfma_f32_16x16x32_bf16 v[48:51], a[80:83], a[12:15], v[48:51]
ds_read_b128 a[36:39], v8 offset:34816
v_mfma_f32_16x16x32_bf16 v[52:55], a[88:91], a[12:15], v[52:55]
ds_read_b64_tr_b16 a[80:81], v12 offset:512
v_mfma_f32_16x16x32_bf16 v[52:55], a[92:95], a[28:31], v[52:55]
ds_read_b64_tr_b16 a[82:83], v12 offset:1536
v_mfma_f32_16x16x32_bf16 v[44:47], a[92:95], a[24:27], v[44:47]
ds_read_b64_tr_b16 a[84:85], v12 offset:8704
v_mfma_f32_16x16x32_bf16 v[44:47], a[88:91], a[8:11], v[44:47]
buffer_load_dwordx4 a[128:131], v16, s[44:47], s100 offen offset:0
v_mfma_f32_16x16x32_bf16 v[36:39], a[88:91], a[4:7], v[36:39]
ds_read_b64_tr_b16 a[86:87], v12 offset:9728
v_mfma_f32_16x16x32_bf16 v[36:39], a[92:95], a[20:23], v[36:39]
ds_read_b128 a[52:55], v9 offset:34816
v_mfma_f32_16x16x32_bf16 v[28:31], a[92:95], a[16:19], v[28:31]
ds_read_b128 a[40:43], v8 offset:36864
v_mfma_f32_16x16x32_bf16 v[28:31], a[88:91], a[0:3], v[28:31]
ds_read_b128 a[56:59], v9 offset:36864
s_waitcnt lgkmcnt(10)
v_mfma_f32_16x16x32_bf16 v[56:59], a[96:99], a[0:3], v[56:59]
ds_read_b64_tr_b16 a[88:89], v13 offset:512
v_mfma_f32_16x16x32_bf16 v[56:59], a[100:103], a[16:19], v[56:59]
ds_read_b64_tr_b16 a[90:91], v13 offset:1536
s_add_u32 m0, s18, 0x15000
v_mfma_f32_16x16x32_bf16 v[64:67], a[100:103], a[20:23], v[64:67]
buffer_load_dwordx4 v7, s[68:71], s25 offen lds
v_mfma_f32_16x16x32_bf16 v[64:67], a[96:99], a[4:7], v[64:67]
ds_read_b64_tr_b16 a[92:93], v13 offset:8704
v_mfma_f32_16x16x32_bf16 v[72:75], a[96:99], a[8:11], v[72:75]
ds_read_b64_tr_b16 a[94:95], v13 offset:9728
v_mfma_f32_16x16x32_bf16 v[72:75], a[100:103], a[24:27], v[72:75]
ds_read_b128 a[44:47], v8 offset:38912
v_mfma_f32_16x16x32_bf16 v[80:83], a[100:103], a[28:31], v[80:83]
ds_read_b128 a[60:63], v9 offset:38912
v_mfma_f32_16x16x32_bf16 v[80:83], a[96:99], a[12:15], v[80:83]
v_mfma_f32_16x16x32_bf16 v[84:87], a[104:107], a[12:15], v[84:87]
ds_read_b64_tr_b16 a[96:97], v12 offset:768
s_add_u32 m0, s18, 0x16000
v_mfma_f32_16x16x32_bf16 v[84:87], a[108:111], a[28:31], v[84:87]
buffer_load_dwordx4 v7, s[68:71], s26 offen lds
v_mfma_f32_16x16x32_bf16 v[76:79], a[108:111], a[24:27], v[76:79]
ds_read_b64_tr_b16 a[98:99], v12 offset:1792
v_lshl_add_u32 v5, s42, 19, v5
v_mfma_f32_16x16x32_bf16 v[76:79], a[104:107], a[8:11], v[76:79]
ds_read_b64_tr_b16 a[100:101], v12 offset:8960
v_lshl_add_u32 v6, s42, 19, v6
v_mfma_f32_16x16x32_bf16 v[68:71], a[104:107], a[4:7], v[68:71]
ds_read_b64_tr_b16 a[102:103], v12 offset:9984
v_lshl_add_u32 v7, s42, 18, v7
v_mfma_f32_16x16x32_bf16 v[68:71], a[108:111], a[20:23], v[68:71]
v_lshl_add_u32 v7, s42, 17, v7
v_mfma_f32_16x16x32_bf16 v[60:63], a[108:111], a[16:19], v[60:63]
v_mfma_f32_16x16x32_bf16 v[60:63], a[104:107], a[0:3], v[60:63]
s_add_u32 m0, s16, 0x8000
s_waitcnt lgkmcnt(4)
s_waitcnt lgkmcnt(6)
v_mfma_f32_16x16x32_bf16 v[88:91], a[80:83], a[0:3], v[88:91]
buffer_load_dwordx4 v22, s[44:47], s20 offen lds
v_mfma_f32_16x16x32_bf16 v[88:91], a[84:87], a[16:19], v[88:91]
ds_read_b64_tr_b16 a[104:105], v13 offset:768
v_mfma_f32_16x16x32_bf16 v[96:99], a[84:87], a[20:23], v[96:99]
ds_read_b64_tr_b16 a[106:107], v13 offset:1792
v_mfma_f32_16x16x32_bf16 v[96:99], a[80:83], a[4:7], v[96:99]
ds_read_b64_tr_b16 a[108:109], v13 offset:8960
v_mfma_f32_16x16x32_bf16 v[104:107], a[80:83], a[8:11], v[104:107]
ds_read_b64_tr_b16 a[110:111], v13 offset:9984
s_add_u32 m0, s16, 0x8400
v_mfma_f32_16x16x32_bf16 v[104:107], a[84:87], a[24:27], v[104:107]
buffer_load_dwordx4 v23, s[44:47], s20 offen lds
v_mfma_f32_16x16x32_bf16 v[112:115], a[84:87], a[28:31], v[112:115]
v_mfma_f32_16x16x32_bf16 v[112:115], a[80:83], a[12:15], v[112:115]
v_mfma_f32_16x16x32_bf16 v[116:119], a[88:91], a[12:15], v[116:119]
ds_read_b64_tr_b16 a[80:81], v14 offset:0
v_mfma_f32_16x16x32_bf16 v[116:119], a[92:95], a[28:31], v[116:119]
ds_read_b64_tr_b16 a[82:83], v14 offset:256
v_mfma_f32_16x16x32_bf16 v[108:111], a[92:95], a[24:27], v[108:111]
ds_read_b64_tr_b16 a[84:85], v14 offset:2048
s_add_u32 m0, s16, 0x8800
v_mfma_f32_16x16x32_bf16 v[108:111], a[88:91], a[8:11], v[108:111]
buffer_load_dwordx4 v22, s[44:47], s21 offen lds
v_mfma_f32_16x16x32_bf16 v[100:103], a[88:91], a[4:7], v[100:103]
ds_read_b64_tr_b16 a[86:87], v14 offset:2304
v_mfma_f32_16x16x32_bf16 v[100:103], a[92:95], a[20:23], v[100:103]
v_mfma_f32_16x16x32_bf16 v[92:95], a[92:95], a[16:19], v[92:95]
v_mfma_f32_16x16x32_bf16 v[92:95], a[88:91], a[0:3], v[92:95]
s_waitcnt lgkmcnt(4)
v_mfma_f32_16x16x32_bf16 v[120:123], a[96:99], a[0:3], v[120:123]
buffer_load_dwordx4 a[132:135], v16, s[44:47], s100 offen offset:1024
v_mfma_f32_16x16x32_bf16 v[120:123], a[100:103], a[16:19], v[120:123]
ds_read_b64_tr_b16 a[88:89], v15 offset:0
v_mfma_f32_16x16x32_bf16 v[128:131], a[100:103], a[20:23], v[128:131]
ds_read_b64_tr_b16 a[90:91], v15 offset:256
v_mfma_f32_16x16x32_bf16 v[128:131], a[96:99], a[4:7], v[128:131]
ds_read_b64_tr_b16 a[92:93], v15 offset:2048
v_mfma_f32_16x16x32_bf16 v[136:139], a[96:99], a[8:11], v[136:139]
ds_read_b64_tr_b16 a[94:95], v15 offset:2304
v_mfma_f32_16x16x32_bf16 v[136:139], a[100:103], a[24:27], v[136:139]
s_add_u32 m0, s16, 0x8c00
v_mfma_f32_16x16x32_bf16 v[144:147], a[100:103], a[28:31], v[144:147]
buffer_load_dwordx4 v23, s[44:47], s21 offen lds
v_mfma_f32_16x16x32_bf16 v[144:147], a[96:99], a[12:15], v[144:147]
v_mfma_f32_16x16x32_bf16 v[148:151], a[104:107], a[12:15], v[148:151]
ds_read_b64_tr_b16 a[96:97], v14 offset:4096
v_mfma_f32_16x16x32_bf16 v[148:151], a[108:111], a[28:31], v[148:151]
ds_read_b64_tr_b16 a[98:99], v14 offset:4352
v_mfma_f32_16x16x32_bf16 v[140:143], a[108:111], a[24:27], v[140:143]
ds_read_b64_tr_b16 a[100:101], v14 offset:6144
v_mfma_f32_16x16x32_bf16 v[140:143], a[104:107], a[8:11], v[140:143]
ds_read_b64_tr_b16 a[102:103], v14 offset:6400
s_add_u32 m0, s16, 0x9000
v_mfma_f32_16x16x32_bf16 v[132:135], a[104:107], a[4:7], v[132:135]
buffer_load_dwordx4 v22, s[44:47], s22 offen lds
v_mfma_f32_16x16x32_bf16 v[132:135], a[108:111], a[20:23], v[132:135]
v_mfma_f32_16x16x32_bf16 v[124:127], a[108:111], a[16:19], v[124:127]
v_mfma_f32_16x16x32_bf16 v[124:127], a[104:107], a[0:3], v[124:127]
s_waitcnt lgkmcnt(4)
v_mfma_f32_16x16x32_bf16 v[152:155], a[80:83], a[0:3], v[152:155]
ds_read_b64_tr_b16 a[104:105], v15 offset:4096
s_add_u32 m0, s16, 0x9400
v_mfma_f32_16x16x32_bf16 v[152:155], a[84:87], a[16:19], v[152:155]
buffer_load_dwordx4 v23, s[44:47], s22 offen lds
v_mfma_f32_16x16x32_bf16 v[160:163], a[84:87], a[20:23], v[160:163]
ds_read_b64_tr_b16 a[106:107], v15 offset:4352
v_mfma_f32_16x16x32_bf16 v[160:163], a[80:83], a[4:7], v[160:163]
ds_read_b64_tr_b16 a[108:109], v15 offset:6144
v_mfma_f32_16x16x32_bf16 v[168:171], a[80:83], a[8:11], v[168:171]
ds_read_b64_tr_b16 a[110:111], v15 offset:6400
v_mfma_f32_16x16x32_bf16 v[168:171], a[84:87], a[24:27], v[168:171]
v_mfma_f32_16x16x32_bf16 v[176:179], a[84:87], a[28:31], v[176:179]
s_add_u32 m0, s16, 0x9800
v_mfma_f32_16x16x32_bf16 v[176:179], a[80:83], a[12:15], v[176:179]
buffer_load_dwordx4 v22, s[44:47], s23 offen lds
v_mfma_f32_16x16x32_bf16 v[180:183], a[88:91], a[12:15], v[180:183]
ds_read_b64_tr_b16 a[80:81], v14 offset:8192
v_mfma_f32_16x16x32_bf16 v[180:183], a[92:95], a[28:31], v[180:183]
ds_read_b64_tr_b16 a[82:83], v14 offset:8448
v_mfma_f32_16x16x32_bf16 v[172:175], a[92:95], a[24:27], v[172:175]
ds_read_b64_tr_b16 a[84:85], v14 offset:10240
v_mfma_f32_16x16x32_bf16 v[172:175], a[88:91], a[8:11], v[172:175]
ds_read_b64_tr_b16 a[86:87], v14 offset:10496
s_add_u32 m0, s16, 0x9c00
v_mfma_f32_16x16x32_bf16 v[164:167], a[88:91], a[4:7], v[164:167]
buffer_load_dwordx4 v23, s[44:47], s23 offen lds
v_mfma_f32_16x16x32_bf16 v[164:167], a[92:95], a[20:23], v[164:167]
v_lshl_add_u32 v22, s42, 7, v22
v_lshl_add_u32 v23, s42, 7, v23
v_mfma_f32_16x16x32_bf16 v[156:159], a[92:95], a[16:19], v[156:159]
v_mfma_f32_16x16x32_bf16 v[156:159], a[88:91], a[0:3], v[156:159]
s_waitcnt lgkmcnt(4)
v_mfma_f32_16x16x32_bf16 v[184:187], a[96:99], a[0:3], v[184:187]
ds_read_b64_tr_b16 a[88:89], v15 offset:8192
v_mfma_f32_16x16x32_bf16 v[184:187], a[100:103], a[16:19], v[184:187]
ds_read_b64_tr_b16 a[90:91], v15 offset:8448
v_mfma_f32_16x16x32_bf16 v[192:195], a[100:103], a[20:23], v[192:195]
buffer_load_dwordx4 a[136:139], v16, s[44:47], s100 offen offset:2048
v_mfma_f32_16x16x32_bf16 v[192:195], a[96:99], a[4:7], v[192:195]
ds_read_b64_tr_b16 a[92:93], v15 offset:10240
v_mfma_f32_16x16x32_bf16 v[200:203], a[96:99], a[8:11], v[200:203]
ds_read_b64_tr_b16 a[94:95], v15 offset:10496
v_add_u32 v12, 0x8000, v12
v_mfma_f32_16x16x32_bf16 v[200:203], a[100:103], a[24:27], v[200:203]
v_add_u32 v13, 0x8000, v13
v_add_u32 v14, 0x8000, v14
v_mfma_f32_16x16x32_bf16 v[208:211], a[100:103], a[28:31], v[208:211]
v_add_u32 v15, 0x8000, v15
v_mfma_f32_16x16x32_bf16 v[208:211], a[96:99], a[12:15], v[208:211]
v_mfma_f32_16x16x32_bf16 v[212:215], a[104:107], a[12:15], v[212:215]
s_waitcnt vmcnt(18) lgkmcnt(0)
v_mfma_f32_16x16x32_bf16 v[212:215], a[108:111], a[28:31], v[212:215]
s_barrier
s_add_u32 m0, s17, 0x0
s_cmp_lg_u32 s4, 0
s_cbranch_scc1 L_sig_kv
v_mov_b32 v20, 1
s_mov_b64 exec, 1
buffer_atomic_add v20, off, s[84:87], s10 sc1
s_mov_b64 exec, -1
L_sig_kv:
v_mfma_f32_16x16x32_bf16 v[204:207], a[108:111], a[24:27], v[204:207]
buffer_load_dwordx4 v5, s[52:55], 0 offen lds
v_mfma_f32_16x16x32_bf16 v[204:207], a[104:107], a[8:11], v[204:207]
ds_read_b64_tr_b16 a[96:97], v12 offset:0
v_mfma_f32_16x16x32_bf16 v[196:199], a[104:107], a[4:7], v[196:199]
ds_read_b64_tr_b16 a[98:99], v12 offset:1024
v_mfma_f32_16x16x32_bf16 v[196:199], a[108:111], a[20:23], v[196:199]
ds_read_b64_tr_b16 a[100:101], v12 offset:8192
v_mfma_f32_16x16x32_bf16 v[188:191], a[108:111], a[16:19], v[188:191]
ds_read_b64_tr_b16 a[102:103], v12 offset:9216
v_mfma_f32_16x16x32_bf16 v[188:191], a[104:107], a[0:3], v[188:191]
s_add_u32 m0, s17, 0x400
s_waitcnt lgkmcnt(4)
v_mfma_f32_16x16x32_bf16 v[216:219], a[0:3], a[80:83], v[216:219]
buffer_load_dwordx4 v5, s[52:55], s13 offen lds
v_mfma_f32_16x16x32_bf16 v[216:219], a[16:19], a[84:87], v[216:219]
ds_read_b64_tr_b16 a[104:105], v13 offset:0
v_mfma_f32_16x16x32_bf16 v[224:227], a[20:23], a[84:87], v[224:227]
ds_read_b64_tr_b16 a[106:107], v13 offset:1024
v_mfma_f32_16x16x32_bf16 v[224:227], a[4:7], a[80:83], v[224:227]
ds_read_b64_tr_b16 a[108:109], v13 offset:8192
v_mfma_f32_16x16x32_bf16 v[232:235], a[8:11], a[80:83], v[232:235]
ds_read_b64_tr_b16 a[110:111], v13 offset:9216
v_mfma_f32_16x16x32_bf16 v[232:235], a[24:27], a[84:87], v[232:235]
v_mfma_f32_16x16x32_bf16 v[240:243], a[28:31], a[84:87], v[240:243]
s_add_u32 m0, s17, 0x800
v_mfma_f32_16x16x32_bf16 v[240:243], a[12:15], a[80:83], v[240:243]
buffer_load_dwordx4 v6, s[52:55], 0 offen lds
v_mfma_f32_16x16x32_bf16 v[244:247], a[12:15], a[88:91], v[244:247]
ds_read_b64_tr_b16 a[80:81], v12 offset:256
v_mfma_f32_16x16x32_bf16 v[244:247], a[28:31], a[92:95], v[244:247]
ds_read_b64_tr_b16 a[82:83], v12 offset:1280
v_mfma_f32_16x16x32_bf16 v[236:239], a[24:27], a[92:95], v[236:239]
ds_read_b64_tr_b16 a[84:85], v12 offset:8448
v_mfma_f32_16x16x32_bf16 v[236:239], a[8:11], a[88:91], v[236:239]
ds_read_b64_tr_b16 a[86:87], v12 offset:9472
v_mfma_f32_16x16x32_bf16 v[228:231], a[4:7], a[88:91], v[228:231]
v_mfma_f32_16x16x32_bf16 v[228:231], a[20:23], a[92:95], v[228:231]
s_add_u32 m0, s17, 0xc00
v_mfma_f32_16x16x32_bf16 v[220:223], a[16:19], a[92:95], v[220:223]
buffer_load_dwordx4 v6, s[52:55], s13 offen lds
v_mfma_f32_16x16x32_bf16 v[220:223], a[0:3], a[88:91], v[220:223]
s_waitcnt lgkmcnt(4)
L_S19:
v_mfma_f32_16x16x32_bf16 v[24:27], a[96:99], a[32:35], v[24:27]
ds_read_b64_tr_b16 a[88:89], v13 offset:256
s_waitcnt vmcnt(23)
v_mfma_f32_16x16x32_bf16 v[24:27], a[100:103], a[48:51], v[24:27]
ds_read_b64_tr_b16 a[90:91], v13 offset:1280
v_mfma_f32_16x16x32_bf16 v[32:35], a[100:103], a[52:55], v[32:35]
ds_read_b64_tr_b16 a[92:93], v13 offset:8448
v_mfma_f32_16x16x32_bf16 v[32:35], a[96:99], a[36:39], v[32:35]
ds_read_b64_tr_b16 a[94:95], v13 offset:9472
v_mfma_f32_16x16x32_bf16 v[40:43], a[96:99], a[40:43], v[40:43]
ds_read_b128 a[0:3], v8 offset:0
s_add_u32 m0, s18, 0x4000
v_mfma_f32_16x16x32_bf16 v[40:43], a[100:103], a[56:59], v[40:43]
buffer_load_dwordx4 v7, s[68:71], 0 offen lds
v_mfma_f32_16x16x32_bf16 v[48:51], a[100:103], a[60:63], v[48:51]
ds_read_b128 a[16:19], v9 offset:0
v_mfma_f32_16x16x32_bf16 v[48:51], a[96:99], a[44:47], v[48:51]
ds_read_b128 a[4:7], v8 offset:2048
v_mfma_f32_16x16x32_bf16 v[52:55], a[104:107], a[44:47], v[52:55]
ds_read_b64_tr_b16 a[96:97], v12 offset:512
v_mfma_f32_16x16x32_bf16 v[52:55], a[108:111], a[60:63], v[52:55]
ds_read_b64_tr_b16 a[98:99], v12 offset:1536
v_mfma_f32_16x16x32_bf16 v[44:47], a[108:111], a[56:59], v[44:47]
ds_read_b64_tr_b16 a[100:101], v12 offset:8704
v_mfma_f32_16x16x32_bf16 v[44:47], a[104:107], a[40:43], v[44:47]
buffer_load_dwordx4 a[140:143], v16, s[44:47], s100 offen offset:3072
v_mfma_f32_16x16x32_bf16 v[36:39], a[104:107], a[36:39], v[36:39]
ds_read_b64_tr_b16 a[102:103], v12 offset:9728
v_mfma_f32_16x16x32_bf16 v[36:39], a[108:111], a[52:55], v[36:39]
ds_read_b128 a[20:23], v9 offset:2048
v_mfma_f32_16x16x32_bf16 v[28:31], a[108:111], a[48:51], v[28:31]
ds_read_b128 a[8:11], v8 offset:4096
v_mfma_f32_16x16x32_bf16 v[28:31], a[104:107], a[32:35], v[28:31]
ds_read_b128 a[24:27], v9 offset:4096
s_waitcnt lgkmcnt(10)
v_mfma_f32_16x16x32_bf16 v[56:59], a[80:83], a[32:35], v[56:59]
ds_read_b64_tr_b16 a[104:105], v13 offset:512
v_mfma_f32_16x16x32_bf16 v[56:59], a[84:87], a[48:51], v[56:59]
ds_read_b64_tr_b16 a[106:107], v13 offset:1536
s_add_u32 m0, s18, 0x5000
v_mfma_f32_16x16x32_bf16 v[64:67], a[84:87], a[52:55], v[64:67]
buffer_load_dwordx4 v7, s[68:71], s25 offen lds
v_mfma_f32_16x16x32_bf16 v[64:67], a[80:83], a[36:39], v[64:67]
ds_read_b64_tr_b16 a[108:109], v13 offset:8704
v_mfma_f32_16x16x32_bf16 v[72:75], a[80:83], a[40:43], v[72:75]
ds_read_b64_tr_b16 a[110:111], v13 offset:9728
v_mfma_f32_16x16x32_bf16 v[72:75], a[84:87], a[56:59], v[72:75]
ds_read_b128 a[12:15], v8 offset:6144
v_mfma_f32_16x16x32_bf16 v[80:83], a[84:87], a[60:63], v[80:83]
ds_read_b128 a[28:31], v9 offset:6144
v_mfma_f32_16x16x32_bf16 v[80:83], a[80:83], a[44:47], v[80:83]
v_mfma_f32_16x16x32_bf16 v[84:87], a[88:91], a[44:47], v[84:87]
ds_read_b64_tr_b16 a[80:81], v12 offset:768
s_add_u32 m0, s18, 0x6000
v_mfma_f32_16x16x32_bf16 v[84:87], a[92:95], a[60:63], v[84:87]
buffer_load_dwordx4 v7, s[68:71], s26 offen lds
v_mfma_f32_16x16x32_bf16 v[76:79], a[92:95], a[56:59], v[76:79]
ds_read_b64_tr_b16 a[82:83], v12 offset:1792
v_lshl_add_u32 v5, s42, 19, v5
v_mfma_f32_16x16x32_bf16 v[76:79], a[88:91], a[40:43], v[76:79]
ds_read_b64_tr_b16 a[84:85], v12 offset:8960
v_lshl_add_u32 v6, s42, 19, v6
v_mfma_f32_16x16x32_bf16 v[68:71], a[88:91], a[36:39], v[68:71]
ds_read_b64_tr_b16 a[86:87], v12 offset:9984
v_lshl_add_u32 v7, s42, 18, v7
v_mfma_f32_16x16x32_bf16 v[68:71], a[92:95], a[52:55], v[68:71]
v_lshl_add_u32 v7, s42, 17, v7
v_mfma_f32_16x16x32_bf16 v[60:63], a[92:95], a[48:51], v[60:63]
v_mfma_f32_16x16x32_bf16 v[60:63], a[88:91], a[32:35], v[60:63]
s_add_u32 m0, s16, 0x0
s_waitcnt lgkmcnt(4)
s_waitcnt lgkmcnt(6)
v_mfma_f32_16x16x32_bf16 v[88:91], a[96:99], a[32:35], v[88:91]
buffer_load_dwordx4 v22, s[44:47], s20 offen lds
v_mfma_f32_16x16x32_bf16 v[88:91], a[100:103], a[48:51], v[88:91]
ds_read_b64_tr_b16 a[88:89], v13 offset:768
v_mfma_f32_16x16x32_bf16 v[96:99], a[100:103], a[52:55], v[96:99]
ds_read_b64_tr_b16 a[90:91], v13 offset:1792
v_mfma_f32_16x16x32_bf16 v[96:99], a[96:99], a[36:39], v[96:99]
ds_read_b64_tr_b16 a[92:93], v13 offset:8960
v_mfma_f32_16x16x32_bf16 v[104:107], a[96:99], a[40:43], v[104:107]
ds_read_b64_tr_b16 a[94:95], v13 offset:9984
s_add_u32 m0, s16, 0x400
v_mfma_f32_16x16x32_bf16 v[104:107], a[100:103], a[56:59], v[104:107]
buffer_load_dwordx4 v23, s[44:47], s20 offen lds
v_mfma_f32_16x16x32_bf16 v[112:115], a[100:103], a[60:63], v[112:115]
v_mfma_f32_16x16x32_bf16 v[112:115], a[96:99], a[44:47], v[112:115]
v_mfma_f32_16x16x32_bf16 v[116:119], a[104:107], a[44:47], v[116:119]
ds_read_b64_tr_b16 a[96:97], v14 offset:0
v_mfma_f32_16x16x32_bf16 v[116:119], a[108:111], a[60:63], v[116:119]
ds_read_b64_tr_b16 a[98:99], v14 offset:256
v_mfma_f32_16x16x32_bf16 v[108:111], a[108:111], a[56:59], v[108:111]
ds_read_b64_tr_b16 a[100:101], v14 offset:2048
s_add_u32 m0, s16, 0x800
v_mfma_f32_16x16x32_bf16 v[108:111], a[104:107], a[40:43], v[108:111]
buffer_load_dwordx4 v22, s[44:47], s21 offen lds
v_mfma_f32_16x16x32_bf16 v[100:103], a[104:107], a[36:39], v[100:103]
ds_read_b64_tr_b16 a[102:103], v14 offset:2304
v_mfma_f32_16x16x32_bf16 v[100:103], a[108:111], a[52:55], v[100:103]
v_mfma_f32_16x16x32_bf16 v[92:95], a[108:111], a[48:51], v[92:95]
v_mfma_f32_16x16x32_bf16 v[92:95], a[104:107], a[32:35], v[92:95]
s_waitcnt lgkmcnt(4)
v_mfma_f32_16x16x32_bf16 v[120:123], a[80:83], a[32:35], v[120:123]
buffer_load_dwordx4 a[144:147], v16, s[76:79], 0 offen offset:0
v_mfma_f32_16x16x32_bf16 v[120:123], a[84:87], a[48:51], v[120:123]
ds_read_b64_tr_b16 a[104:105], v15 offset:0
v_mfma_f32_16x16x32_bf16 v[128:131], a[84:87], a[52:55], v[128:131]
ds_read_b64_tr_b16 a[106:107], v15 offset:256
v_mfma_f32_16x16x32_bf16 v[128:131], a[80:83], a[36:39], v[128:131]
ds_read_b64_tr_b16 a[108:109], v15 offset:2048
v_mfma_f32_16x16x32_bf16 v[136:139], a[80:83], a[40:43], v[136:139]
ds_read_b64_tr_b16 a[110:111], v15 offset:2304
v_mfma_f32_16x16x32_bf16 v[136:139], a[84:87], a[56:59], v[136:139]
s_add_u32 m0, s16, 0xc00
v_mfma_f32_16x16x32_bf16 v[144:147], a[84:87], a[60:63], v[144:147]
buffer_load_dwordx4 v23, s[44:47], s21 offen lds
v_mfma_f32_16x16x32_bf16 v[144:147], a[80:83], a[44:47], v[144:147]
v_mfma_f32_16x16x32_bf16 v[148:151], a[88:91], a[44:47], v[148:151]
ds_read_b64_tr_b16 a[80:81], v14 offset:4096
v_mfma_f32_16x16x32_bf16 v[148:151], a[92:95], a[60:63], v[148:151]
ds_read_b64_tr_b16 a[82:83], v14 offset:4352
v_mfma_f32_16x16x32_bf16 v[140:143], a[92:95], a[56:59], v[140:143]
ds_read_b64_tr_b16 a[84:85], v14 offset:6144
v_mfma_f32_16x16x32_bf16 v[140:143], a[88:91], a[40:43], v[140:143]
ds_read_b64_tr_b16 a[86:87], v14 offset:6400
s_add_u32 m0, s16, 0x1000
v_mfma_f32_16x16x32_bf16 v[132:135], a[88:91], a[36:39], v[132:135]
buffer_load_dwordx4 v22, s[44:47], s22 offen lds
v_mfma_f32_16x16x32_bf16 v[132:135], a[92:95], a[52:55], v[132:135]
v_mfma_f32_16x16x32_bf16 v[124:127], a[92:95], a[48:51], v[124:127]
v_mfma_f32_16x16x32_bf16 v[124:127], a[88:91], a[32:35], v[124:127]
s_waitcnt lgkmcnt(4)
v_mfma_f32_16x16x32_bf16 v[152:155], a[96:99], a[32:35], v[152:155]
ds_read_b64_tr_b16 a[88:89], v15 offset:4096
s_add_u32 m0, s16, 0x1400
v_mfma_f32_16x16x32_bf16 v[152:155], a[100:103], a[48:51], v[152:155]
buffer_load_dwordx4 v23, s[44:47], s22 offen lds
v_mfma_f32_16x16x32_bf16 v[160:163], a[100:103], a[52:55], v[160:163]
ds_read_b64_tr_b16 a[90:91], v15 offset:4352
v_mfma_f32_16x16x32_bf16 v[160:163], a[96:99], a[36:39], v[160:163]
ds_read_b64_tr_b16 a[92:93], v15 offset:6144
v_mfma_f32_16x16x32_bf16 v[168:171], a[96:99], a[40:43], v[168:171]
ds_read_b64_tr_b16 a[94:95], v15 offset:6400
v_mfma_f32_16x16x32_bf16 v[168:171], a[100:103], a[56:59], v[168:171]
v_mfma_f32_16x16x32_bf16 v[176:179], a[100:103], a[60:63], v[176:179]
s_add_u32 m0, s16, 0x1800
v_mfma_f32_16x16x32_bf16 v[176:179], a[96:99], a[44:47], v[176:179]
buffer_load_dwordx4 v22, s[44:47], s23 offen lds
v_mfma_f32_16x16x32_bf16 v[180:183], a[104:107], a[44:47], v[180:183]
ds_read_b64_tr_b16 a[96:97], v14 offset:8192
v_mfma_f32_16x16x32_bf16 v[180:183], a[108:111], a[60:63], v[180:183]
ds_read_b64_tr_b16 a[98:99], v14 offset:8448
v_mfma_f32_16x16x32_bf16 v[172:175], a[108:111], a[56:59], v[172:175]
ds_read_b64_tr_b16 a[100:101], v14 offset:10240
v_mfma_f32_16x16x32_bf16 v[172:175], a[104:107], a[40:43], v[172:175]
ds_read_b64_tr_b16 a[102:103], v14 offset:10496
s_add_u32 m0, s16, 0x1c00
v_mfma_f32_16x16x32_bf16 v[164:167], a[104:107], a[36:39], v[164:167]
buffer_load_dwordx4 v23, s[44:47], s23 offen lds
v_mfma_f32_16x16x32_bf16 v[164:167], a[108:111], a[52:55], v[164:167]
v_lshl_add_u32 v22, s42, 7, v22
v_lshl_add_u32 v23, s42, 7, v23
v_mfma_f32_16x16x32_bf16 v[156:159], a[108:111], a[48:51], v[156:159]
v_mfma_f32_16x16x32_bf16 v[156:159], a[104:107], a[32:35], v[156:159]
s_waitcnt lgkmcnt(4)
v_mfma_f32_16x16x32_bf16 v[184:187], a[80:83], a[32:35], v[184:187]
ds_read_b64_tr_b16 a[104:105], v15 offset:8192
v_mfma_f32_16x16x32_bf16 v[184:187], a[84:87], a[48:51], v[184:187]
ds_read_b64_tr_b16 a[106:107], v15 offset:8448
v_mfma_f32_16x16x32_bf16 v[192:195], a[84:87], a[52:55], v[192:195]
buffer_load_dwordx4 a[148:151], v16, s[76:79], 0 offen offset:1024
v_mfma_f32_16x16x32_bf16 v[192:195], a[80:83], a[36:39], v[192:195]
ds_read_b64_tr_b16 a[108:109], v15 offset:10240
v_mfma_f32_16x16x32_bf16 v[200:203], a[80:83], a[40:43], v[200:203]
ds_read_b64_tr_b16 a[110:111], v15 offset:10496
v_add_u32 v12, 0x8000, v12
v_mfma_f32_16x16x32_bf16 v[200:203], a[84:87], a[56:59], v[200:203]
v_add_u32 v13, 0x8000, v13
v_add_u32 v14, 0x8000, v14
v_mfma_f32_16x16x32_bf16 v[208:211], a[84:87], a[60:63], v[208:211]
v_add_u32 v15, 0x8000, v15
v_mfma_f32_16x16x32_bf16 v[208:211], a[80:83], a[44:47], v[208:211]
v_mfma_f32_16x16x32_bf16 v[212:215], a[88:91], a[44:47], v[212:215]
s_waitcnt vmcnt(28) lgkmcnt(0)
v_mfma_f32_16x16x32_bf16 v[212:215], a[92:95], a[60:63], v[212:215]
s_barrier
s_add_u32 m0, s17, 0x8000
v_mfma_f32_16x16x32_bf16 v[204:207], a[92:95], a[56:59], v[204:207]
buffer_load_dwordx4 v5, s[52:55], 0 offen lds
v_mfma_f32_16x16x32_bf16 v[204:207], a[88:91], a[40:43], v[204:207]
ds_read_b64_tr_b16 a[80:81], v12 offset:0
v_mfma_f32_16x16x32_bf16 v[196:199], a[88:91], a[36:39], v[196:199]
ds_read_b64_tr_b16 a[82:83], v12 offset:1024
v_mfma_f32_16x16x32_bf16 v[196:199], a[92:95], a[52:55], v[196:199]
ds_read_b64_tr_b16 a[84:85], v12 offset:8192
v_mfma_f32_16x16x32_bf16 v[188:191], a[92:95], a[48:51], v[188:191]
ds_read_b64_tr_b16 a[86:87], v12 offset:9216
v_mfma_f32_16x16x32_bf16 v[188:191], a[88:91], a[32:35], v[188:191]
s_waitcnt lgkmcnt(4)
v_mfma_f32_16x16x32_bf16 v[216:219], a[32:35], a[96:99], v[216:219]
ds_read_b64_tr_b16 a[88:89], v13 offset:0
s_add_u32 m0, s17, 0x8400
v_mfma_f32_16x16x32_bf16 v[216:219], a[48:51], a[100:103], v[216:219]
buffer_load_dwordx4 v5, s[52:55], s13 offen lds
v_mfma_f32_16x16x32_bf16 v[224:227], a[52:55], a[100:103], v[224:227]
ds_read_b64_tr_b16 a[90:91], v13 offset:1024
v_mfma_f32_16x16x32_bf16 v[224:227], a[36:39], a[96:99], v[224:227]
ds_read_b64_tr_b16 a[92:93], v13 offset:8192
v_mfma_f32_16x16x32_bf16 v[232:235], a[40:43], a[96:99], v[232:235]
ds_read_b64_tr_b16 a[94:95], v13 offset:9216
v_mfma_f32_16x16x32_bf16 v[232:235], a[56:59], a[100:103], v[232:235]
v_mfma_f32_16x16x32_bf16 v[240:243], a[60:63], a[100:103], v[240:243]
v_mfma_f32_16x16x32_bf16 v[240:243], a[44:47], a[96:99], v[240:243]
v_mfma_f32_16x16x32_bf16 v[244:247], a[44:47], a[104:107], v[244:247]
ds_read_b64_tr_b16 a[96:97], v12 offset:256
s_add_u32 m0, s17, 0x8800
v_mfma_f32_16x16x32_bf16 v[244:247], a[60:63], a[108:111], v[244:247]
buffer_load_dwordx4 v6, s[52:55], 0 offen lds
v_mfma_f32_16x16x32_bf16 v[236:239], a[56:59], a[108:111], v[236:239]
ds_read_b64_tr_b16 a[98:99], v12 offset:1280
v_mfma_f32_16x16x32_bf16 v[236:239], a[40:43], a[104:107], v[236:239]
ds_read_b64_tr_b16 a[100:101], v12 offset:8448
v_mfma_f32_16x16x32_bf16 v[228:231], a[36:39], a[104:107], v[228:231]
ds_read_b64_tr_b16 a[102:103], v12 offset:9472
v_mfma_f32_16x16x32_bf16 v[228:231], a[52:55], a[108:111], v[228:231]
v_mfma_f32_16x16x32_bf16 v[220:223], a[48:51], a[108:111], v[220:223]
v_mfma_f32_16x16x32_bf16 v[220:223], a[32:35], a[104:107], v[220:223]
s_add_u32 m0, s17, 0x8c00
s_waitcnt lgkmcnt(4)
L_S20:
v_mfma_f32_16x16x32_bf16 v[24:27], a[80:83], a[0:3], v[24:27]
ds_read_b64_tr_b16 a[104:105], v13 offset:256
s_waitcnt vmcnt(22)
v_mfma_f32_16x16x32_bf16 v[24:27], a[84:87], a[16:19], v[24:27]
buffer_load_dwordx4 v6, s[52:55], s13 offen lds
v_mfma_f32_16x16x32_bf16 v[32:35], a[84:87], a[20:23], v[32:35]
ds_read_b64_tr_b16 a[106:107], v13 offset:1280
v_mfma_f32_16x16x32_bf16 v[32:35], a[80:83], a[4:7], v[32:35]
ds_read_b64_tr_b16 a[108:109], v13 offset:8448
v_mfma_f32_16x16x32_bf16 v[40:43], a[80:83], a[8:11], v[40:43]
ds_read_b64_tr_b16 a[110:111], v13 offset:9472
v_mfma_f32_16x16x32_bf16 v[40:43], a[84:87], a[24:27], v[40:43]
ds_read_b128 a[32:35], v8 offset:32768
v_mfma_f32_16x16x32_bf16 v[48:51], a[84:87], a[28:31], v[48:51]
ds_read_b128 a[48:51], v9 offset:32768
v_mfma_f32_16x16x32_bf16 v[48:51], a[80:83], a[12:15], v[48:51]
ds_read_b128 a[36:39], v8 offset:34816
s_add_u32 m0, s18, 0xc000
v_mfma_f32_16x16x32_bf16 v[52:55], a[88:91], a[12:15], v[52:55]
buffer_load_dwordx4 v7, s[68:71], 0 offen lds
v_mfma_f32_16x16x32_bf16 v[52:55], a[92:95], a[28:31], v[52:55]
ds_read_b64_tr_b16 a[80:81], v12 offset:512
v_mfma_f32_16x16x32_bf16 v[44:47], a[92:95], a[24:27], v[44:47]
ds_read_b64_tr_b16 a[82:83], v12 offset:1536
v_mfma_f32_16x16x32_bf16 v[44:47], a[88:91], a[8:11], v[44:47]
ds_read_b64_tr_b16 a[84:85], v12 offset:8704
v_mfma_f32_16x16x32_bf16 v[36:39], a[88:91], a[4:7], v[36:39]
ds_read_b64_tr_b16 a[86:87], v12 offset:9728
v_mfma_f32_16x16x32_bf16 v[36:39], a[92:95], a[20:23], v[36:39]
ds_read_b128 a[52:55], v9 offset:34816
v_mfma_f32_16x16x32_bf16 v[28:31], a[92:95], a[16:19], v[28:31]
ds_read_b128 a[40:43], v8 offset:36864
s_waitcnt lgkmcnt(9)
v_mfma_f32_16x16x32_bf16 v[28:31], a[88:91], a[0:3], v[28:31]
ds_read_b128 a[56:59], v9 offset:36864
s_add_u32 m0, s18, 0xd000
v_mfma_f32_16x16x32_bf16 v[56:59], a[96:99], a[0:3], v[56:59]
buffer_load_dwordx4 v7, s[68:71], s25 offen lds
v_mfma_f32_16x16x32_bf16 v[56:59], a[100:103], a[16:19], v[56:59]
ds_read_b64_tr_b16 a[88:89], v13 offset:512
v_mfma_f32_16x16x32_bf16 v[64:67], a[100:103], a[20:23], v[64:67]
ds_read_b64_tr_b16 a[90:91], v13 offset:1536
v_mfma_f32_16x16x32_bf16 v[64:67], a[96:99], a[4:7], v[64:67]
ds_read_b64_tr_b16 a[92:93], v13 offset:8704
v_mfma_f32_16x16x32_bf16 v[72:75], a[96:99], a[8:11], v[72:75]
ds_read_b64_tr_b16 a[94:95], v13 offset:9728
v_mfma_f32_16x16x32_bf16 v[72:75], a[100:103], a[24:27], v[72:75]
ds_read_b128 a[44:47], v8 offset:38912
v_mfma_f32_16x16x32_bf16 v[80:83], a[100:103], a[28:31], v[80:83]
ds_read_b128 a[60:63], v9 offset:38912
v_mfma_f32_16x16x32_bf16 v[80:83], a[96:99], a[12:15], v[80:83]
s_add_u32 m0, s18, 0xe000
v_mfma_f32_16x16x32_bf16 v[84:87], a[104:107], a[12:15], v[84:87]
buffer_load_dwordx4 v7, s[68:71], s26 offen lds
v_mfma_f32_16x16x32_bf16 v[84:87], a[108:111], a[28:31], v[84:87]
ds_read_b64_tr_b16 a[96:97], v12 offset:768
v_lshl_add_u32 v5, s42, 19, v5
v_mfma_f32_16x16x32_bf16 v[76:79], a[108:111], a[24:27], v[76:79]
ds_read_b64_tr_b16 a[98:99], v12 offset:1792
v_lshl_add_u32 v6, s42, 19, v6
v_mfma_f32_16x16x32_bf16 v[76:79], a[104:107], a[8:11], v[76:79]
ds_read_b64_tr_b16 a[100:101], v12 offset:8960
v_lshl_add_u32 v7, s42, 18, v7
v_mfma_f32_16x16x32_bf16 v[68:71], a[104:107], a[4:7], v[68:71]
ds_read_b64_tr_b16 a[102:103], v12 offset:9984
v_lshl_add_u32 v7, s42, 17, v7
v_mfma_f32_16x16x32_bf16 v[68:71], a[108:111], a[20:23], v[68:71]
s_waitcnt vmcnt(13)
v_accvgpr_read_b32 v18, a144
v_lshlrev_b32 v1, 16, v18
v_mfma_f32_16x16x32_bf16 v[60:63], a[108:111], a[16:19], v[60:63]
L_padA10:
s_cmp_eq_u32 s95, 1
s_cbranch_scc1 L_hopA_ret
v_and_b32 v18, 0xffff0000, v18
v_accvgpr_read_b32 v21, a128
v_mfma_f32_16x16x32_bf16 v[60:63], a[104:107], a[0:3], v[60:63]
s_add_u32 m0, s16, 0x8000
s_waitcnt lgkmcnt(4)
s_waitcnt lgkmcnt(6)
v_mfma_f32_16x16x32_bf16 v[88:91], a[80:83], a[0:3], v[88:91]
buffer_load_dwordx4 v22, s[44:47], s20 offen lds
v_mfma_f32_16x16x32_bf16 v[88:91], a[84:87], a[16:19], v[88:91]
ds_read_b64_tr_b16 a[104:105], v13 offset:768
v_lshlrev_b32 v20, 16, v21
v_mfma_f32_16x16x32_bf16 v[96:99], a[84:87], a[20:23], v[96:99]
ds_read_b64_tr_b16 a[106:107], v13 offset:1792
v_and_b32 v21, 0xffff0000, v21
v_mfma_f32_16x16x32_bf16 v[96:99], a[80:83], a[4:7], v[96:99]
ds_read_b64_tr_b16 a[108:109], v13 offset:8960
v_mul_f32 v2, v1, v20
v_mfma_f32_16x16x32_bf16 v[104:107], a[80:83], a[8:11], v[104:107]
ds_read_b64_tr_b16 a[110:111], v13 offset:9984
v_fmac_f32 v2, v18, v21
v_mfma_f32_16x16x32_bf16 v[104:107], a[84:87], a[24:27], v[104:107]
v_accvgpr_read_b32 v21, a136
v_lshlrev_b32 v20, 16, v21
v_mfma_f32_16x16x32_bf16 v[112:115], a[84:87], a[28:31], v[112:115]
s_add_u32 m0, s16, 0x8400
v_and_b32 v21, 0xffff0000, v21
v_mul_f32 v3, v1, v20
v_mfma_f32_16x16x32_bf16 v[112:115], a[80:83], a[12:15], v[112:115]
buffer_load_dwordx4 v23, s[44:47], s20 offen lds
v_mfma_f32_16x16x32_bf16 v[116:119], a[88:91], a[12:15], v[116:119]
ds_read_b64_tr_b16 a[80:81], v14 offset:0
v_fmac_f32 v3, v18, v21
v_mfma_f32_16x16x32_bf16 v[116:119], a[92:95], a[28:31], v[116:119]
ds_read_b64_tr_b16 a[82:83], v14 offset:256
v_accvgpr_read_b32 v18, a145
v_mfma_f32_16x16x32_bf16 v[108:111], a[92:95], a[24:27], v[108:111]
ds_read_b64_tr_b16 a[84:85], v14 offset:2048
v_lshlrev_b32 v1, 16, v18
v_mfma_f32_16x16x32_bf16 v[108:111], a[88:91], a[8:11], v[108:111]
ds_read_b64_tr_b16 a[86:87], v14 offset:2304
v_and_b32 v18, 0xffff0000, v18
v_mfma_f32_16x16x32_bf16 v[100:103], a[88:91], a[4:7], v[100:103]
v_accvgpr_read_b32 v21, a129
v_lshlrev_b32 v20, 16, v21
v_mfma_f32_16x16x32_bf16 v[100:103], a[92:95], a[20:23], v[100:103]
s_add_u32 m0, s16, 0x8800
v_and_b32 v21, 0xffff0000, v21
v_fmac_f32 v2, v1, v20
v_mfma_f32_16x16x32_bf16 v[92:95], a[92:95], a[16:19], v[92:95]
buffer_load_dwordx4 v22, s[44:47], s21 offen lds
v_mfma_f32_16x16x32_bf16 v[92:95], a[88:91], a[0:3], v[92:95]
s_waitcnt lgkmcnt(4)
v_fmac_f32 v2, v18, v21
v_accvgpr_read_b32 v21, a137
v_mfma_f32_16x16x32_bf16 v[120:123], a[96:99], a[0:3], v[120:123]
ds_read_b64_tr_b16 a[88:89], v15 offset:0
v_lshlrev_b32 v20, 16, v21
v_mfma_f32_16x16x32_bf16 v[120:123], a[100:103], a[16:19], v[120:123]
ds_read_b64_tr_b16 a[90:91], v15 offset:256
v_and_b32 v21, 0xffff0000, v21
v_mfma_f32_16x16x32_bf16 v[128:131], a[100:103], a[20:23], v[128:131]
ds_read_b64_tr_b16 a[92:93], v15 offset:2048
v_fmac_f32 v3, v1, v20
v_mfma_f32_16x16x32_bf16 v[128:131], a[96:99], a[4:7], v[128:131]
ds_read_b64_tr_b16 a[94:95], v15 offset:2304
v_fmac_f32 v3, v18, v21
v_mfma_f32_16x16x32_bf16 v[136:139], a[96:99], a[8:11], v[136:139]
s_add_u32 m0, s16, 0x8c00
v_accvgpr_read_b32 v18, a146
v_lshlrev_b32 v1, 16, v18
v_mfma_f32_16x16x32_bf16 v[136:139], a[100:103], a[24:27], v[136:139]
buffer_load_dwordx4 v23, s[44:47], s21 offen lds
v_mfma_f32_16x16x32_bf16 v[144:147], a[100:103], a[28:31], v[144:147]
v_and_b32 v18, 0xffff0000, v18
v_accvgpr_read_b32 v21, a130
v_mfma_f32_16x16x32_bf16 v[144:147], a[96:99], a[12:15], v[144:147]
v_lshlrev_b32 v20, 16, v21
v_and_b32 v21, 0xffff0000, v21
v_mfma_f32_16x16x32_bf16 v[148:151], a[104:107], a[12:15], v[148:151]
ds_read_b64_tr_b16 a[96:97], v14 offset:4096
v_fmac_f32 v2, v1, v20
v_mfma_f32_16x16x32_bf16 v[148:151], a[108:111], a[28:31], v[148:151]
ds_read_b64_tr_b16 a[98:99], v14 offset:4352
v_fmac_f32 v2, v18, v21
v_mfma_f32_16x16x32_bf16 v[140:143], a[108:111], a[24:27], v[140:143]
ds_read_b64_tr_b16 a[100:101], v14 offset:6144
v_accvgpr_read_b32 v21, a138
v_mfma_f32_16x16x32_bf16 v[140:143], a[104:107], a[8:11], v[140:143]
ds_read_b64_tr_b16 a[102:103], v14 offset:6400
s_add_u32 m0, s16, 0x9000
v_mfma_f32_16x16x32_bf16 v[132:135], a[104:107], a[4:7], v[132:135]
buffer_load_dwordx4 v22, s[44:47], s22 offen lds
v_mfma_f32_16x16x32_bf16 v[132:135], a[108:111], a[20:23], v[132:135]
v_lshlrev_b32 v20, 16, v21
v_and_b32 v21, 0xffff0000, v21
v_mfma_f32_16x16x32_bf16 v[124:127], a[108:111], a[16:19], v[124:127]
v_fmac_f32 v3, v1, v20
v_fmac_f32 v3, v18, v21
v_mfma_f32_16x16x32_bf16 v[124:127], a[104:107], a[0:3], v[124:127]
s_waitcnt lgkmcnt(4)
v_accvgpr_read_b32 v18, a147
v_lshlrev_b32 v1, 16, v18
v_mfma_f32_16x16x32_bf16 v[152:155], a[80:83], a[0:3], v[152:155]
ds_read_b64_tr_b16 a[104:105], v15 offset:4096
v_and_b32 v18, 0xffff0000, v18
v_mfma_f32_16x16x32_bf16 v[152:155], a[84:87], a[16:19], v[152:155]
ds_read_b64_tr_b16 a[106:107], v15 offset:4352
v_accvgpr_read_b32 v21, a131
v_mfma_f32_16x16x32_bf16 v[160:163], a[84:87], a[20:23], v[160:163]
ds_read_b64_tr_b16 a[108:109], v15 offset:6144
s_add_u32 m0, s16, 0x9400
v_mfma_f32_16x16x32_bf16 v[160:163], a[80:83], a[4:7], v[160:163]
buffer_load_dwordx4 v23, s[44:47], s22 offen lds
v_mfma_f32_16x16x32_bf16 v[168:171], a[80:83], a[8:11], v[168:171]
ds_read_b64_tr_b16 a[110:111], v15 offset:6400
v_lshlrev_b32 v20, 16, v21
v_mfma_f32_16x16x32_bf16 v[168:171], a[84:87], a[24:27], v[168:171]
v_and_b32 v21, 0xffff0000, v21
v_fmac_f32 v2, v1, v20
v_mfma_f32_16x16x32_bf16 v[176:179], a[84:87], a[28:31], v[176:179]
v_fmac_f32 v2, v18, v21
v_accvgpr_read_b32 v21, a139
v_mfma_f32_16x16x32_bf16 v[176:179], a[80:83], a[12:15], v[176:179]
v_lshlrev_b32 v20, 16, v21
v_and_b32 v21, 0xffff0000, v21
v_mfma_f32_16x16x32_bf16 v[180:183], a[88:91], a[12:15], v[180:183]
ds_read_b64_tr_b16 a[80:81], v14 offset:8192
v_fmac_f32 v3, v1, v20
v_mfma_f32_16x16x32_bf16 v[180:183], a[92:95], a[28:31], v[180:183]
ds_read_b64_tr_b16 a[82:83], v14 offset:8448
s_add_u32 m0, s16, 0x9800
v_mfma_f32_16x16x32_bf16 v[172:175], a[92:95], a[24:27], v[172:175]
buffer_load_dwordx4 v22, s[44:47], s23 offen lds
v_mfma_f32_16x16x32_bf16 v[172:175], a[88:91], a[8:11], v[172:175]
ds_read_b64_tr_b16 a[84:85], v14 offset:10240
v_fmac_f32 v3, v18, v21
v_mfma_f32_16x16x32_bf16 v[164:167], a[88:91], a[4:7], v[164:167]
ds_read_b64_tr_b16 a[86:87], v14 offset:10496
s_waitcnt vmcnt(14)
v_accvgpr_read_b32 v18, a148
v_mfma_f32_16x16x32_bf16 v[164:167], a[92:95], a[20:23], v[164:167]
v_lshlrev_b32 v1, 16, v18
v_and_b32 v18, 0xffff0000, v18
v_mfma_f32_16x16x32_bf16 v[156:159], a[92:95], a[16:19], v[156:159]
v_accvgpr_read_b32 v21, a132
v_lshlrev_b32 v20, 16, v21
v_mfma_f32_16x16x32_bf16 v[156:159], a[88:91], a[0:3], v[156:159]
s_waitcnt lgkmcnt(4)
v_and_b32 v21, 0xffff0000, v21
v_fmac_f32 v2, v1, v20
v_mfma_f32_16x16x32_bf16 v[184:187], a[96:99], a[0:3], v[184:187]
ds_read_b64_tr_b16 a[88:89], v15 offset:8192
s_add_u32 m0, s16, 0x9c00
v_mfma_f32_16x16x32_bf16 v[184:187], a[100:103], a[16:19], v[184:187]
buffer_load_dwordx4 v23, s[44:47], s23 offen lds
v_mfma_f32_16x16x32_bf16 v[192:195], a[100:103], a[20:23], v[192:195]
ds_read_b64_tr_b16 a[90:91], v15 offset:8448
v_fmac_f32 v2, v18, v21
v_mfma_f32_16x16x32_bf16 v[192:195], a[96:99], a[4:7], v[192:195]
ds_read_b64_tr_b16 a[92:93], v15 offset:10240
v_accvgpr_read_b32 v21, a140
v_mfma_f32_16x16x32_bf16 v[200:203], a[96:99], a[8:11], v[200:203]
ds_read_b64_tr_b16 a[94:95], v15 offset:10496
v_add_u32 v12, 0xffff0000, v12
v_mfma_f32_16x16x32_bf16 v[200:203], a[100:103], a[24:27], v[200:203]
v_add_u32 v13, 0xffff0000, v13
v_add_u32 v14, 0xffff0000, v14
v_mfma_f32_16x16x32_bf16 v[208:211], a[100:103], a[28:31], v[208:211]
v_add_u32 v15, 0xffff0000, v15
v_lshlrev_b32 v20, 16, v21
v_mfma_f32_16x16x32_bf16 v[208:211], a[96:99], a[12:15], v[208:211]
v_and_b32 v21, 0xffff0000, v21
v_fmac_f32 v3, v1, v20
v_mfma_f32_16x16x32_bf16 v[212:215], a[104:107], a[12:15], v[212:215]
s_waitcnt vmcnt(25) lgkmcnt(0)
v_fmac_f32 v3, v18, v21
v_accvgpr_read_b32 v18, a149
v_mfma_f32_16x16x32_bf16 v[212:215], a[108:111], a[28:31], v[212:215]
s_barrier
s_add_u32 m0, s17, 0x10000
v_lshlrev_b32 v1, 16, v18
v_mfma_f32_16x16x32_bf16 v[204:207], a[108:111], a[24:27], v[204:207]
buffer_load_dwordx4 v5, s[52:55], 0 offen lds
v_mfma_f32_16x16x32_bf16 v[204:207], a[104:107], a[8:11], v[204:207]
ds_read_b64_tr_b16 a[96:97], v12 offset:0
v_and_b32 v18, 0xffff0000, v18
v_mfma_f32_16x16x32_bf16 v[196:199], a[104:107], a[4:7], v[196:199]
ds_read_b64_tr_b16 a[98:99], v12 offset:1024
v_accvgpr_read_b32 v21, a133
v_mfma_f32_16x16x32_bf16 v[196:199], a[108:111], a[20:23], v[196:199]
ds_read_b64_tr_b16 a[100:101], v12 offset:8192
v_lshlrev_b32 v20, 16, v21
v_mfma_f32_16x16x32_bf16 v[188:191], a[108:111], a[16:19], v[188:191]
ds_read_b64_tr_b16 a[102:103], v12 offset:9216
v_and_b32 v21, 0xffff0000, v21
v_mfma_f32_16x16x32_bf16 v[188:191], a[104:107], a[0:3], v[188:191]
s_waitcnt lgkmcnt(4)
v_fmac_f32 v2, v1, v20
v_fmac_f32 v2, v18, v21
v_mfma_f32_16x16x32_bf16 v[216:219], a[0:3], a[80:83], v[216:219]
ds_read_b64_tr_b16 a[104:105], v13 offset:0
v_accvgpr_read_b32 v21, a141
v_mfma_f32_16x16x32_bf16 v[216:219], a[16:19], a[84:87], v[216:219]
ds_read_b64_tr_b16 a[106:107], v13 offset:1024
s_add_u32 m0, s17, 0x10400
v_mfma_f32_16x16x32_bf16 v[224:227], a[20:23], a[84:87], v[224:227]
buffer_load_dwordx4 v5, s[52:55], s13 offen lds
v_mfma_f32_16x16x32_bf16 v[224:227], a[4:7], a[80:83], v[224:227]
ds_read_b64_tr_b16 a[108:109], v13 offset:8192
v_lshlrev_b32 v20, 16, v21
v_mfma_f32_16x16x32_bf16 v[232:235], a[8:11], a[80:83], v[232:235]
ds_read_b64_tr_b16 a[110:111], v13 offset:9216
v_and_b32 v21, 0xffff0000, v21
v_mfma_f32_16x16x32_bf16 v[232:235], a[24:27], a[84:87], v[232:235]
s_lshl_b32 s15, s2, 2
v_fmac_f32 v3, v1, v20
v_fmac_f32 v3, v18, v21
v_mfma_f32_16x16x32_bf16 v[240:243], a[28:31], a[84:87], v[240:243]
s_add_u32 s15, s15, s4
v_accvgpr_read_b32 v18, a150
v_lshlrev_b32 v1, 16, v18
v_mfma_f32_16x16x32_bf16 v[240:243], a[12:15], a[80:83], v[240:243]
s_lshl_b32 s15, s15, 12
v_and_b32 v18, 0xffff0000, v18
v_accvgpr_read_b32 v21, a134
v_mfma_f32_16x16x32_bf16 v[244:247], a[12:15], a[88:91], v[244:247]
ds_read_b64_tr_b16 a[80:81], v12 offset:256
v_lshlrev_b32 v20, 16, v21
v_mfma_f32_16x16x32_bf16 v[244:247], a[28:31], a[92:95], v[244:247]
ds_read_b64_tr_b16 a[82:83], v12 offset:1280
v_and_b32 v21, 0xffff0000, v21
v_mfma_f32_16x16x32_bf16 v[236:239], a[24:27], a[92:95], v[236:239]
ds_read_b64_tr_b16 a[84:85], v12 offset:8448
s_add_u32 m0, s17, 0x10800
v_mfma_f32_16x16x32_bf16 v[236:239], a[8:11], a[88:91], v[236:239]
buffer_load_dwordx4 v6, s[52:55], 0 offen lds
v_mfma_f32_16x16x32_bf16 v[228:231], a[4:7], a[88:91], v[228:231]
ds_read_b64_tr_b16 a[86:87], v12 offset:9472
v_fmac_f32 v2, v1, v20
v_mfma_f32_16x16x32_bf16 v[228:231], a[20:23], a[92:95], v[228:231]
s_add_u32 s15, s15, 0x3800000
v_fmac_f32 v2, v18, v21
v_accvgpr_read_b32 v21, a142
v_mfma_f32_16x16x32_bf16 v[220:223], a[16:19], a[92:95], v[220:223]
v_lshlrev_b32 v20, 16, v21
v_and_b32 v21, 0xffff0000, v21
v_mfma_f32_16x16x32_bf16 v[220:223], a[0:3], a[88:91], v[220:223]
s_waitcnt lgkmcnt(4)
v_fmac_f32 v3, v1, v20
v_fmac_f32 v3, v18, v21
L_S21:
v_mfma_f32_16x16x32_bf16 v[24:27], a[96:99], a[32:35], v[24:27]
ds_read_b64_tr_b16 a[88:89], v13 offset:256
s_waitcnt vmcnt(19)
v_mfma_f32_16x16x32_bf16 v[24:27], a[100:103], a[48:51], v[24:27]
ds_read_b64_tr_b16 a[90:91], v13 offset:1280
v_accvgpr_read_b32 v18, a151
v_mfma_f32_16x16x32_bf16 v[32:35], a[100:103], a[52:55], v[32:35]
ds_read_b64_tr_b16 a[92:93], v13 offset:8448
s_add_u32 m0, s17, 0x10c00
v_mfma_f32_16x16x32_bf16 v[32:35], a[96:99], a[36:39], v[32:35]
buffer_load_dwordx4 v6, s[52:55], s13 offen lds
v_mfma_f32_16x16x32_bf16 v[40:43], a[96:99], a[40:43], v[40:43]
ds_read_b64_tr_b16 a[94:95], v13 offset:9472
v_lshlrev_b32 v1, 16, v18
v_mfma_f32_16x16x32_bf16 v[40:43], a[100:103], a[56:59], v[40:43]
ds_read_b128 a[0:3], v8 offset:0
v_and_b32 v18, 0xffff0000, v18
v_mfma_f32_16x16x32_bf16 v[48:51], a[100:103], a[60:63], v[48:51]
ds_read_b128 a[16:19], v9 offset:0
v_accvgpr_read_b32 v21, a135
v_mfma_f32_16x16x32_bf16 v[48:51], a[96:99], a[44:47], v[48:51]
ds_read_b128 a[4:7], v8 offset:2048
v_lshlrev_b32 v20, 16, v21
v_mfma_f32_16x16x32_bf16 v[52:55], a[104:107], a[44:47], v[52:55]
ds_read_b64_tr_b16 a[96:97], v12 offset:512
v_and_b32 v21, 0xffff0000, v21
v_mfma_f32_16x16x32_bf16 v[52:55], a[108:111], a[60:63], v[52:55]
ds_read_b64_tr_b16 a[98:99], v12 offset:1536
v_fmac_f32 v2, v1, v20
v_mfma_f32_16x16x32_bf16 v[44:47], a[108:111], a[56:59], v[44:47]
ds_read_b64_tr_b16 a[100:101], v12 offset:8704
v_fmac_f32 v2, v18, v21
v_mfma_f32_16x16x32_bf16 v[44:47], a[104:107], a[40:43], v[44:47]
ds_read_b64_tr_b16 a[102:103], v12 offset:9728
s_add_u32 m0, s18, 0x14000
v_mfma_f32_16x16x32_bf16 v[36:39], a[104:107], a[36:39], v[36:39]
buffer_load_dwordx4 v7, s[68:71], 0 offen lds
v_mfma_f32_16x16x32_bf16 v[36:39], a[108:111], a[52:55], v[36:39]
ds_read_b128 a[20:23], v9 offset:2048
v_accvgpr_read_b32 v21, a143
v_mfma_f32_16x16x32_bf16 v[28:31], a[108:111], a[48:51], v[28:31]
ds_read_b128 a[8:11], v8 offset:4096
v_lshlrev_b32 v20, 16, v21
v_mfma_f32_16x16x32_bf16 v[28:31], a[104:107], a[32:35], v[28:31]
ds_read_b128 a[24:27], v9 offset:4096
s_waitcnt lgkmcnt(10)
v_mfma_f32_16x16x32_bf16 v[56:59], a[80:83], a[32:35], v[56:59]
ds_read_b64_tr_b16 a[104:105], v13 offset:512
v_and_b32 v21, 0xffff0000, v21
v_mfma_f32_16x16x32_bf16 v[56:59], a[84:87], a[48:51], v[56:59]
ds_read_b64_tr_b16 a[106:107], v13 offset:1536
v_fmac_f32 v3, v1, v20
v_mfma_f32_16x16x32_bf16 v[64:67], a[84:87], a[52:55], v[64:67]
ds_read_b64_tr_b16 a[108:109], v13 offset:8704
v_fmac_f32 v3, v18, v21
v_mfma_f32_16x16x32_bf16 v[64:67], a[80:83], a[36:39], v[64:67]
ds_read_b64_tr_b16 a[110:111], v13 offset:9728
s_add_u32 m0, s18, 0x15000
v_mfma_f32_16x16x32_bf16 v[72:75], a[80:83], a[40:43], v[72:75]
buffer_load_dwordx4 v7, s[68:71], s25 offen lds
v_mfma_f32_16x16x32_bf16 v[72:75], a[84:87], a[56:59], v[72:75]
ds_read_b128 a[12:15], v8 offset:6144
v_add_f32_dpp v2, v2, v2 row_ror:8 row_mask:0xf bank_mask:0xf
v_mfma_f32_16x16x32_bf16 v[80:83], a[84:87], a[60:63], v[80:83]
ds_read_b128 a[28:31], v9 offset:6144
v_add_f32_dpp v3, v3, v3 row_ror:8 row_mask:0xf bank_mask:0xf
v_mfma_f32_16x16x32_bf16 v[80:83], a[80:83], a[44:47], v[80:83]
v_add_f32_dpp v2, v2, v2 row_ror:4 row_mask:0xf bank_mask:0xf
v_add_f32_dpp v3, v3, v3 row_ror:4 row_mask:0xf bank_mask:0xf
v_mfma_f32_16x16x32_bf16 v[84:87], a[88:91], a[44:47], v[84:87]
ds_read_b64_tr_b16 a[80:81], v12 offset:768
v_add_f32_dpp v2, v2, v2 row_ror:2 row_mask:0xf bank_mask:0xf
v_mfma_f32_16x16x32_bf16 v[84:87], a[92:95], a[60:63], v[84:87]
ds_read_b64_tr_b16 a[82:83], v12 offset:1792
v_add_f32_dpp v3, v3, v3 row_ror:2 row_mask:0xf bank_mask:0xf
v_mfma_f32_16x16x32_bf16 v[76:79], a[92:95], a[56:59], v[76:79]
ds_read_b64_tr_b16 a[84:85], v12 offset:8960
v_add_f32_dpp v2, v2, v2 row_ror:1 row_mask:0xf bank_mask:0xf
v_mfma_f32_16x16x32_bf16 v[76:79], a[88:91], a[40:43], v[76:79]
ds_read_b64_tr_b16 a[86:87], v12 offset:9984
v_add_f32_dpp v3, v3, v3 row_ror:1 row_mask:0xf bank_mask:0xf
v_mfma_f32_16x16x32_bf16 v[68:71], a[88:91], a[36:39], v[68:71]
s_add_u32 m0, s18, 0x16000
v_mov_b32 v1, v2
v_mov_b32 v18, v3
v_mfma_f32_16x16x32_bf16 v[68:71], a[92:95], a[52:55], v[68:71]
buffer_load_dwordx4 v7, s[68:71], s26 offen lds
v_mfma_f32_16x16x32_bf16 v[60:63], a[92:95], a[48:51], v[60:63]
v_permlane16_swap_b32 v1, v2
v_permlane16_swap_b32 v18, v3
v_mfma_f32_16x16x32_bf16 v[60:63], a[88:91], a[32:35], v[60:63]
s_waitcnt lgkmcnt(6)
v_add_f32 v2, v2, v1
v_add_f32 v3, v3, v18
v_mfma_f32_16x16x32_bf16 v[88:91], a[96:99], a[32:35], v[88:91]
ds_read_b64_tr_b16 a[88:89], v13 offset:768
v_mov_b32 v1, v2
v_mfma_f32_16x16x32_bf16 v[88:91], a[100:103], a[48:51], v[88:91]
ds_read_b64_tr_b16 a[90:91], v13 offset:1792
v_mov_b32 v18, v3
v_mfma_f32_16x16x32_bf16 v[96:99], a[100:103], a[52:55], v[96:99]
ds_read_b64_tr_b16 a[92:93], v13 offset:8960
v_permlane32_swap_b32 v1, v2
v_mfma_f32_16x16x32_bf16 v[96:99], a[96:99], a[36:39], v[96:99]
ds_read_b64_tr_b16 a[94:95], v13 offset:9984
v_permlane32_swap_b32 v18, v3
v_mfma_f32_16x16x32_bf16 v[104:107], a[96:99], a[40:43], v[104:107]
v_add_f32 v2, v2, v1
v_add_f32 v3, v3, v18
v_mfma_f32_16x16x32_bf16 v[104:107], a[100:103], a[56:59], v[104:107]
buffer_load_dword v23, off, s[84:87], s10 sc1
v_mfma_f32_16x16x32_bf16 v[112:115], a[100:103], a[60:63], v[112:115]
v_mul_f32 v2, 0xbfb8aa3b, v2
v_mul_f32 v3, 0xbfb8aa3b, v3
v_mfma_f32_16x16x32_bf16 v[112:115], a[96:99], a[44:47], v[112:115]
v_exp_f32 v2, v2
v_mfma_f32_16x16x32_bf16 v[116:119], a[104:107], a[44:47], v[116:119]
ds_read_b64_tr_b16 a[96:97], v14 offset:0
v_mfma_f32_16x16x32_bf16 v[116:119], a[108:111], a[60:63], v[116:119]
ds_read_b64_tr_b16 a[98:99], v14 offset:256
v_mfma_f32_16x16x32_bf16 v[108:111], a[108:111], a[56:59], v[108:111]
ds_read_b64_tr_b16 a[100:101], v14 offset:2048
v_mfma_f32_16x16x32_bf16 v[108:111], a[104:107], a[40:43], v[108:111]
ds_read_b64_tr_b16 a[102:103], v14 offset:2304
v_mfma_f32_16x16x32_bf16 v[100:103], a[104:107], a[36:39], v[100:103]
v_exp_f32 v3, v3
v_mfma_f32_16x16x32_bf16 v[100:103], a[108:111], a[52:55], v[100:103]
v_add_f32 v2, 1.0, v2
v_add_f32 v3, 1.0, v3
v_mfma_f32_16x16x32_bf16 v[92:95], a[108:111], a[48:51], v[92:95]
v_rcp_f32 v2, v2
v_mfma_f32_16x16x32_bf16 v[92:95], a[104:107], a[32:35], v[92:95]
s_waitcnt lgkmcnt(4)
v_rcp_f32 v3, v3
v_mfma_f32_16x16x32_bf16 v[120:123], a[80:83], a[32:35], v[120:123]
ds_read_b64_tr_b16 a[104:105], v15 offset:0
v_mfma_f32_16x16x32_bf16 v[120:123], a[84:87], a[48:51], v[120:123]
ds_read_b64_tr_b16 a[106:107], v15 offset:256
v_mfma_f32_16x16x32_bf16 v[128:131], a[84:87], a[52:55], v[128:131]
ds_read_b64_tr_b16 a[108:109], v15 offset:2048
v_mfma_f32_16x16x32_bf16 v[128:131], a[80:83], a[36:39], v[128:131]
ds_read_b64_tr_b16 a[110:111], v15 offset:2304
v_mfma_f32_16x16x32_bf16 v[136:139], a[80:83], a[40:43], v[136:139]
buffer_store_dwordx2 v[2:3], off, s[88:91], s101 sc1
v_mfma_f32_16x16x32_bf16 v[136:139], a[84:87], a[56:59], v[136:139]
v_mfma_f32_16x16x32_bf16 v[144:147], a[84:87], a[60:63], v[144:147]
v_mfma_f32_16x16x32_bf16 v[144:147], a[80:83], a[44:47], v[144:147]
v_mfma_f32_16x16x32_bf16 v[148:151], a[88:91], a[44:47], v[148:151]
ds_read_b64_tr_b16 a[80:81], v14 offset:4096
v_mfma_f32_16x16x32_bf16 v[148:151], a[92:95], a[60:63], v[148:151]
ds_read_b64_tr_b16 a[82:83], v14 offset:4352
v_mfma_f32_16x16x32_bf16 v[140:143], a[92:95], a[56:59], v[140:143]
ds_read_b64_tr_b16 a[84:85], v14 offset:6144
v_mfma_f32_16x16x32_bf16 v[140:143], a[88:91], a[40:43], v[140:143]
ds_read_b64_tr_b16 a[86:87], v14 offset:6400
v_mfma_f32_16x16x32_bf16 v[132:135], a[88:91], a[36:39], v[132:135]
v_mfma_f32_16x16x32_bf16 v[132:135], a[92:95], a[52:55], v[132:135]
v_mfma_f32_16x16x32_bf16 v[124:127], a[92:95], a[48:51], v[124:127]
v_mfma_f32_16x16x32_bf16 v[124:127], a[88:91], a[32:35], v[124:127]
s_waitcnt lgkmcnt(4)
v_mfma_f32_16x16x32_bf16 v[152:155], a[96:99], a[32:35], v[152:155]
ds_read_b64_tr_b16 a[88:89], v15 offset:4096
v_mfma_f32_16x16x32_bf16 v[152:155], a[100:103], a[48:51], v[152:155]
ds_read_b64_tr_b16 a[90:91], v15 offset:4352
v_mfma_f32_16x16x32_bf16 v[160:163], a[100:103], a[52:55], v[160:163]
ds_read_b64_tr_b16 a[92:93], v15 offset:6144
v_mfma_f32_16x16x32_bf16 v[160:163], a[96:99], a[36:39], v[160:163]
ds_read_b64_tr_b16 a[94:95], v15 offset:6400
v_mfma_f32_16x16x32_bf16 v[168:171], a[96:99], a[40:43], v[168:171]
v_mfma_f32_16x16x32_bf16 v[168:171], a[100:103], a[56:59], v[168:171]
v_mfma_f32_16x16x32_bf16 v[176:179], a[100:103], a[60:63], v[176:179]
v_mfma_f32_16x16x32_bf16 v[176:179], a[96:99], a[44:47], v[176:179]
v_mfma_f32_16x16x32_bf16 v[180:183], a[104:107], a[44:47], v[180:183]
ds_read_b64_tr_b16 a[96:97], v14 offset:8192
v_mfma_f32_16x16x32_bf16 v[180:183], a[108:111], a[60:63], v[180:183]
ds_read_b64_tr_b16 a[98:99], v14 offset:8448
v_mfma_f32_16x16x32_bf16 v[172:175], a[108:111], a[56:59], v[172:175]
ds_read_b64_tr_b16 a[100:101], v14 offset:10240
v_mfma_f32_16x16x32_bf16 v[172:175], a[104:107], a[40:43], v[172:175]
ds_read_b64_tr_b16 a[102:103], v14 offset:10496
v_mfma_f32_16x16x32_bf16 v[164:167], a[104:107], a[36:39], v[164:167]
v_mfma_f32_16x16x32_bf16 v[164:167], a[108:111], a[52:55], v[164:167]
v_mfma_f32_16x16x32_bf16 v[156:159], a[108:111], a[48:51], v[156:159]
v_mfma_f32_16x16x32_bf16 v[156:159], a[104:107], a[32:35], v[156:159]
s_waitcnt lgkmcnt(4)
v_mfma_f32_16x16x32_bf16 v[184:187], a[80:83], a[32:35], v[184:187]
ds_read_b64_tr_b16 a[104:105], v15 offset:8192
v_mfma_f32_16x16x32_bf16 v[184:187], a[84:87], a[48:51], v[184:187]
ds_read_b64_tr_b16 a[106:107], v15 offset:8448
v_mfma_f32_16x16x32_bf16 v[192:195], a[84:87], a[52:55], v[192:195]
ds_read_b64_tr_b16 a[108:109], v15 offset:10240
v_mfma_f32_16x16x32_bf16 v[192:195], a[80:83], a[36:39], v[192:195]
ds_read_b64_tr_b16 a[110:111], v15 offset:10496
v_add_u32 v12, 0x8000, v12
v_mfma_f32_16x16x32_bf16 v[200:203], a[80:83], a[40:43], v[200:203]
v_add_u32 v13, 0x8000, v13
v_add_u32 v14, 0x8000, v14
v_mfma_f32_16x16x32_bf16 v[200:203], a[84:87], a[56:59], v[200:203]
v_add_u32 v15, 0x8000, v15
v_mfma_f32_16x16x32_bf16 v[208:211], a[84:87], a[60:63], v[208:211]
v_mfma_f32_16x16x32_bf16 v[208:211], a[80:83], a[44:47], v[208:211]
v_mfma_f32_16x16x32_bf16 v[212:215], a[88:91], a[44:47], v[212:215]
s_waitcnt vmcnt(1) lgkmcnt(0)
s_mov_b32 s92, 200000
L_spin_kv:
v_readfirstlane_b32 s93, v23
s_nop 1
s_cmp_ge_u32 s93, 8
s_cbranch_scc1 L_spun_kv
s_sub_u32 s92, s92, 1
s_cbranch_scc1 L_spun_kv
s_sleep 4
buffer_load_dword v23, off, s[84:87], s10 sc1
s_waitcnt vmcnt(0)
s_branch L_spin_kv
L_spun_kv:
v_mfma_f32_16x16x32_bf16 v[212:215], a[92:95], a[60:63], v[212:215]
s_barrier
s_add_u32 m0, s19, 0x0
v_mfma_f32_16x16x32_bf16 v[204:207], a[92:95], a[56:59], v[204:207]
buffer_load_dwordx4 v16, s[48:51], s32 offen offset:0 sc1 lds
v_mfma_f32_16x16x32_bf16 v[204:207], a[88:91], a[40:43], v[204:207]
ds_read_b64_tr_b16 a[80:81], v12 offset:0
v_mov_b32 v3, v16
v_mfma_f32_16x16x32_bf16 v[196:199], a[88:91], a[36:39], v[196:199]
ds_read_b64_tr_b16 a[82:83], v12 offset:1024
v_mov_b32 v22, 0x3f803f80
v_mfma_f32_16x16x32_bf16 v[196:199], a[92:95], a[52:55], v[196:199]
ds_read_b64_tr_b16 a[84:85], v12 offset:8192
s_mov_b32 s33, 0
v_mfma_f32_16x16x32_bf16 v[188:191], a[92:95], a[48:51], v[188:191]
ds_read_b64_tr_b16 a[86:87], v12 offset:9216
v_accvgpr_write_b32 a240, v22
v_mfma_f32_16x16x32_bf16 v[188:191], a[88:91], a[32:35], v[188:191]
s_waitcnt lgkmcnt(4)
v_accvgpr_write_b32 a241, v22
v_accvgpr_write_b32 a242, v22
v_mfma_f32_16x16x32_bf16 v[216:219], a[32:35], a[96:99], v[216:219]
buffer_load_dwordx4 v16, s[48:51], s32 offen offset:1024 sc1 lds
v_accvgpr_write_b32 a243, v22
v_mfma_f32_16x16x32_bf16 v[216:219], a[48:51], a[100:103], v[216:219]
ds_read_b64_tr_b16 a[88:89], v13 offset:0
s_mov_b32 s36, 0x33333333
v_mfma_f32_16x16x32_bf16 v[224:227], a[52:55], a[100:103], v[224:227]
ds_read_b64_tr_b16 a[90:91], v13 offset:1024
s_mov_b32 s37, 0xcccccccc
v_mfma_f32_16x16x32_bf16 v[224:227], a[36:39], a[96:99], v[224:227]
ds_read_b64_tr_b16 a[92:93], v13 offset:8192
v_cndmask_b32 v4, 0, v22, s[36:37]
v_mfma_f32_16x16x32_bf16 v[232:235], a[40:43], a[96:99], v[232:235]
ds_read_b64_tr_b16 a[94:95], v13 offset:9216
v_accvgpr_write_b32 a232, v4
v_mfma_f32_16x16x32_bf16 v[232:235], a[56:59], a[100:103], v[232:235]
v_accvgpr_write_b32 a233, v4
v_accvgpr_write_b32 a234, v4
v_mfma_f32_16x16x32_bf16 v[240:243], a[60:63], a[100:103], v[240:243]
v_accvgpr_write_b32 a235, v4
v_mfma_f32_16x16x32_bf16 v[240:243], a[44:47], a[96:99], v[240:243]
buffer_load_dwordx4 v16, s[48:51], s32 offen offset:2048 sc1 lds
v_mfma_f32_16x16x32_bf16 v[244:247], a[44:47], a[104:107], v[244:247]
ds_read_b64_tr_b16 a[96:97], v12 offset:256
s_mov_b32 s36, 0x44444444
s_mov_b32 s37, 0x44444444
v_mfma_f32_16x16x32_bf16 v[244:247], a[60:63], a[108:111], v[244:247]
ds_read_b64_tr_b16 a[98:99], v12 offset:1280
v_cndmask_b32 v4, 0, v22, s[36:37]
v_mfma_f32_16x16x32_bf16 v[236:239], a[56:59], a[108:111], v[236:239]
ds_read_b64_tr_b16 a[100:101], v12 offset:8448
v_accvgpr_write_b32 a236, v4
v_mfma_f32_16x16x32_bf16 v[236:239], a[40:43], a[104:107], v[236:239]
ds_read_b64_tr_b16 a[102:103], v12 offset:9472
v_accvgpr_write_b32 a237, v4
v_mfma_f32_16x16x32_bf16 v[228:231], a[36:39], a[104:107], v[228:231]
v_accvgpr_write_b32 a238, v4
v_accvgpr_write_b32 a239, v4
v_mfma_f32_16x16x32_bf16 v[228:231], a[52:55], a[108:111], v[228:231]
v_mov_b32 v1, v3
v_add_u32 v2, 98304, v3
v_mfma_f32_16x16x32_bf16 v[220:223], a[48:51], a[108:111], v[220:223]
buffer_load_dwordx4 v16, s[48:51], s32 offen offset:3072 sc1 lds
v_mfma_f32_16x16x32_bf16 v[220:223], a[32:35], a[104:107], v[220:223]
s_waitcnt lgkmcnt(4)
s_mov_b64 s[34:35], 0
v_accvgpr_write_b32 a224, 0
L_S22:
v_mfma_f32_16x16x32_bf16 v[24:27], a[80:83], a[0:3], v[24:27]
ds_read_b64_tr_b16 a[104:105], v13 offset:256
s_waitcnt vmcnt(13)
v_accvgpr_write_b32 a225, 0
v_mfma_f32_16x16x32_bf16 v[24:27], a[84:87], a[16:19], v[24:27]
ds_read_b64_tr_b16 a[106:107], v13 offset:1280
v_accvgpr_write_b32 a226, 0
v_mfma_f32_16x16x32_bf16 v[32:35], a[84:87], a[20:23], v[32:35]
ds_read_b64_tr_b16 a[108:109], v13 offset:8448
v_accvgpr_write_b32 a227, 0
v_mfma_f32_16x16x32_bf16 v[32:35], a[80:83], a[4:7], v[32:35]
ds_read_b64_tr_b16 a[110:111], v13 offset:9472
v_accvgpr_write_b32 a228, 0
v_mfma_f32_16x16x32_bf16 v[40:43], a[80:83], a[8:11], v[40:43]
ds_read_b128 a[32:35], v8 offset:32768
s_add_u32 m0, s19, 0x1000
v_mfma_f32_16x16x32_bf16 v[40:43], a[84:87], a[24:27], v[40:43]
buffer_load_dwordx4 v16, s[48:51], s7 offen offset:0 sc1 lds
v_mfma_f32_16x16x32_bf16 v[48:51], a[84:87], a[28:31], v[48:51]
ds_read_b128 a[48:51], v9 offset:32768
v_accvgpr_write_b32 a229, 0
v_mfma_f32_16x16x32_bf16 v[48:51], a[80:83], a[12:15], v[48:51]
ds_read_b128 a[36:39], v8 offset:34816
v_accvgpr_write_b32 a230, 0
v_mfma_f32_16x16x32_bf16 v[52:55], a[88:91], a[12:15], v[52:55]
ds_read_b64_tr_b16 a[80:81], v12 offset:512
v_accvgpr_write_b32 a231, 0
v_mfma_f32_16x16x32_bf16 v[52:55], a[92:95], a[28:31], v[52:55]
ds_read_b64_tr_b16 a[82:83], v12 offset:1536
L_padA11:
s_cmp_eq_u32 s95, 1
s_cbranch_scc1 L_hopA_ret
s_mul_i32 s8, s6, 0x142400
v_mfma_f32_16x16x32_bf16 v[44:47], a[92:95], a[24:27], v[44:47]
ds_read_b64_tr_b16 a[84:85], v12 offset:8704
s_sub_u32 s9, 0x12e1c00, s8
v_mfma_f32_16x16x32_bf16 v[44:47], a[88:91], a[8:11], v[44:47]
buffer_load_dwordx4 v16, s[48:51], s7 offen offset:1024 sc1 lds
v_mfma_f32_16x16x32_bf16 v[36:39], a[88:91], a[4:7], v[36:39]
ds_read_b64_tr_b16 a[86:87], v12 offset:9728
s_lshl_b32 s11, s5, 13
v_mfma_f32_16x16x32_bf16 v[36:39], a[92:95], a[20:23], v[36:39]
ds_read_b128 a[52:55], v9 offset:34816
s_add_u32 s11, s11, 0x2200000
v_mfma_f32_16x16x32_bf16 v[28:31], a[92:95], a[16:19], v[28:31]
ds_read_b128 a[40:43], v8 offset:36864
s_add_u32 s8, s8, s11
v_mfma_f32_16x16x32_bf16 v[28:31], a[88:91], a[0:3], v[28:31]
ds_read_b128 a[56:59], v9 offset:36864
s_waitcnt lgkmcnt(10)
v_mfma_f32_16x16x32_bf16 v[56:59], a[96:99], a[0:3], v[56:59]
ds_read_b64_tr_b16 a[88:89], v13 offset:512
s_add_u32 s9, s9, s11
s_lshl_b32 s11, s4, 10
v_mfma_f32_16x16x32_bf16 v[56:59], a[100:103], a[16:19], v[56:59]
ds_read_b64_tr_b16 a[90:91], v13 offset:1536
s_add_u32 s44, s8, s11
v_mfma_f32_16x16x32_bf16 v[64:67], a[100:103], a[20:23], v[64:67]
buffer_load_dwordx4 v16, s[48:51], s7 offen offset:2048 sc1 lds
v_mfma_f32_16x16x32_bf16 v[64:67], a[96:99], a[4:7], v[64:67]
ds_read_b64_tr_b16 a[92:93], v13 offset:8704
s_add_u32 s46, s9, s11
v_mfma_f32_16x16x32_bf16 v[72:75], a[96:99], a[8:11], v[72:75]
ds_read_b64_tr_b16 a[94:95], v13 offset:9728
s_sub_u32 s11, 0x1c00, s11
v_mfma_f32_16x16x32_bf16 v[72:75], a[100:103], a[24:27], v[72:75]
ds_read_b128 a[44:47], v8 offset:38912
s_add_u32 s45, s8, s11
v_mfma_f32_16x16x32_bf16 v[80:83], a[100:103], a[28:31], v[80:83]
ds_read_b128 a[60:63], v9 offset:38912
s_add_u32 s47, s9, s11
v_mfma_f32_16x16x32_bf16 v[80:83], a[96:99], a[12:15], v[80:83]
s_mul_i32 s8, s5, 0x6000
s_add_u32 s8, s8, 0x40000
s_add_u32 s28, s44, s8
v_mfma_f32_16x16x32_bf16 v[84:87], a[104:107], a[12:15], v[84:87]
ds_read_b64_tr_b16 a[96:97], v12 offset:768
s_add_u32 s29, s45, s8
s_add_u32 s30, s46, s8
v_mfma_f32_16x16x32_bf16 v[84:87], a[108:111], a[28:31], v[84:87]
buffer_load_dwordx4 v16, s[48:51], s7 offen offset:3072 sc1 lds
v_mfma_f32_16x16x32_bf16 v[76:79], a[108:111], a[24:27], v[76:79]
ds_read_b64_tr_b16 a[98:99], v12 offset:1792
s_add_u32 s32, s32, s94
v_mfma_f32_16x16x32_bf16 v[76:79], a[104:107], a[8:11], v[76:79]
ds_read_b64_tr_b16 a[100:101], v12 offset:8960
s_add_u32 s7, s7, s94
v_mfma_f32_16x16x32_bf16 v[68:71], a[104:107], a[4:7], v[68:71]
ds_read_b64_tr_b16 a[102:103], v12 offset:9984
s_add_u32 s31, s47, s8
v_mfma_f32_16x16x32_bf16 v[68:71], a[108:111], a[20:23], v[68:71]
s_lshl_b32 s8, s4, 11
s_add_u32 s9, s8, 131072
v_add_u32 v4, s9, v16
v_mfma_f32_16x16x32_bf16 v[60:63], a[108:111], a[16:19], v[60:63]
s_sub_u32 s9, 145408, s8
s_cmp_eq_u32 s4, 0
s_cselect_b32 s8, 131072, s9
v_mfma_f32_16x16x32_bf16 v[60:63], a[104:107], a[0:3], v[60:63]
s_add_u32 m0, s19, 0x18000
s_waitcnt lgkmcnt(6)
v_add_u32 v5, s8, v16
v_mfma_f32_16x16x32_bf16 v[88:91], a[80:83], a[0:3], v[88:91]
buffer_load_dwordx4 v16, s[48:51], s32 offen offset:0 sc1 lds
v_add_u32 v6, s9, v16
v_mfma_f32_16x16x32_bf16 v[88:91], a[84:87], a[16:19], v[88:91]
ds_read_b64_tr_b16 a[104:105], v13 offset:768
v_add_u32 v22, 0x800, v10
v_mfma_f32_16x16x32_bf16 v[96:99], a[84:87], a[20:23], v[96:99]
ds_read_b64_tr_b16 a[106:107], v13 offset:1792
s_mov_b32 s8, 0x800
v_mfma_f32_16x16x32_bf16 v[96:99], a[80:83], a[4:7], v[96:99]
ds_read_b64_tr_b16 a[108:109], v13 offset:8960
v_mfma_f32_16x16x32_bf16 v[104:107], a[80:83], a[8:11], v[104:107]
ds_read_b64_tr_b16 a[110:111], v13 offset:9984
v_mfma_f32_16x16x32_bf16 v[104:107], a[84:87], a[24:27], v[104:107]
s_cmp_eq_u32 s6, 0
s_cselect_b32 s8, 0xffff8800, s8
v_add_u32 v7, s8, v11
v_mfma_f32_16x16x32_bf16 v[112:115], a[84:87], a[28:31], v[112:115]
buffer_load_dwordx4 v16, s[48:51], s32 offen offset:1024 sc1 lds
v_mfma_f32_16x16x32_bf16 v[112:115], a[80:83], a[12:15], v[112:115]
s_bfe_u32 s99, s2, 0x20001
s_lshl_b32 s99, s99, 2
s_lshr_b32 s8, s2, 6
v_mfma_f32_16x16x32_bf16 v[116:119], a[88:91], a[12:15], v[116:119]
ds_read_b64_tr_b16 a[80:81], v14 offset:0
s_add_u32 s99, s99, s8
s_bfe_u32 s100, s2, 0x30003
v_mfma_f32_16x16x32_bf16 v[116:119], a[92:95], a[28:31], v[116:119]
ds_read_b64_tr_b16 a[82:83], v14 offset:256
s_and_b32 s14, s2, 1
v_mfma_f32_16x16x32_bf16 v[108:111], a[92:95], a[24:27], v[108:111]
ds_read_b64_tr_b16 a[84:85], v14 offset:2048
s_sub_u32 s24, 15, s99
v_mfma_f32_16x16x32_bf16 v[108:111], a[88:91], a[8:11], v[108:111]
ds_read_b64_tr_b16 a[86:87], v14 offset:2304
s_min_u32 s18, s24, s99
v_mfma_f32_16x16x32_bf16 v[100:103], a[88:91], a[4:7], v[100:103]
buffer_load_dwordx4 v16, s[48:51], s32 offen offset:2048 sc1 lds
v_mfma_f32_16x16x32_bf16 v[100:103], a[92:95], a[20:23], v[100:103]
s_lshl_b32 s24, s18, 1
s_add_u32 s24, s24, s14
s_lshl_b32 s24, s24, 8
v_mfma_f32_16x16x32_bf16 v[92:95], a[92:95], a[16:19], v[92:95]
s_add_u32 s24, s24, 0x3704000
s_mov_b32 s12, 14336
s_and_b32 s16, s6, 1
v_mfma_f32_16x16x32_bf16 v[92:95], a[88:91], a[0:3], v[92:95]
s_waitcnt lgkmcnt(4)
s_lshl_b32 s16, s16, 15
s_add_u32 s16, s16, 98304
v_mfma_f32_16x16x32_bf16 v[120:123], a[96:99], a[0:3], v[120:123]
ds_read_b64_tr_b16 a[88:89], v15 offset:0
s_add_u32 s16, s16, s17
s_lshl_b32 s13, s4, 15
v_mfma_f32_16x16x32_bf16 v[120:123], a[100:103], a[16:19], v[120:123]
ds_read_b64_tr_b16 a[90:91], v15 offset:256
s_lshl_b32 s9, s100, 8
v_mfma_f32_16x16x32_bf16 v[128:131], a[100:103], a[20:23], v[128:131]
buffer_load_dwordx4 v16, s[48:51], s32 offen offset:3072 sc1 lds
v_mfma_f32_16x16x32_bf16 v[128:131], a[96:99], a[4:7], v[128:131]
ds_read_b64_tr_b16 a[92:93], v15 offset:2048
s_add_u32 s13, s13, s9
v_mfma_f32_16x16x32_bf16 v[136:139], a[96:99], a[8:11], v[136:139]
ds_read_b64_tr_b16 a[94:95], v15 offset:2304
s_mul_i32 s9, s14, 1310848
v_mfma_f32_16x16x32_bf16 v[136:139], a[100:103], a[24:27], v[136:139]
s_add_u32 s13, s13, s9
s_mul_i32 s25, s14, 3407872
s_sub_u32 s25, s25, 1179648
v_mfma_f32_16x16x32_bf16 v[144:147], a[100:103], a[28:31], v[144:147]
s_mul_i32 s101, s99, 0x142400
s_lshl_b32 s8, s4, 11
s_add_u32 s101, s101, s8
v_mfma_f32_16x16x32_bf16 v[144:147], a[96:99], a[12:15], v[144:147]
s_add_u32 m0, s19, 0x19000
s_mul_i32 s8, s14, 163840
s_add_u32 s101, s101, s8
v_mfma_f32_16x16x32_bf16 v[148:151], a[104:107], a[12:15], v[148:151]
buffer_load_dwordx4 v16, s[48:51], s7 offen offset:0 sc1 lds
s_add_u32 s101, s101, 0x21fe000
v_mfma_f32_16x16x32_bf16 v[148:151], a[108:111], a[28:31], v[148:151]
ds_read_b64_tr_b16 a[96:97], v14 offset:4096
s_mul_i32 s26, s14, 425984
v_mfma_f32_16x16x32_bf16 v[140:143], a[108:111], a[24:27], v[140:143]
ds_read_b64_tr_b16 a[98:99], v14 offset:4352
s_add_u32 s26, s26, 106496
v_mfma_f32_16x16x32_bf16 v[140:143], a[104:107], a[8:11], v[140:143]
ds_read_b64_tr_b16 a[100:101], v14 offset:6144
s_mov_b32 s52, 0x3e0293ee
v_mfma_f32_16x16x32_bf16 v[132:135], a[104:107], a[4:7], v[132:135]
ds_read_b64_tr_b16 a[102:103], v14 offset:6400
s_mov_b32 s53, 0x3e0293ee
v_mfma_f32_16x16x32_bf16 v[132:135], a[108:111], a[20:23], v[132:135]
s_mov_b32 s54, 0x3e8293ee
s_or_b32 s55, s6, s4
s_cselect_b32 s55, 0, 0xf149f2ca
v_mfma_f32_16x16x32_bf16 v[124:127], a[108:111], a[16:19], v[124:127]
s_waitcnt lgkmcnt(4)
s_mov_b32 s56, 0x50000
s_mov_b32 s57, 0x5550055
v_mfma_f32_16x16x32_bf16 v[124:127], a[104:107], a[0:3], v[124:127]
buffer_load_dwordx4 v16, s[48:51], s7 offen offset:1024 sc1 lds
v_mfma_f32_16x16x32_bf16 v[152:155], a[80:83], a[0:3], v[152:155]
ds_read_b64_tr_b16 a[104:105], v15 offset:4096
s_mov_b32 s58, 0xa0000
s_mov_b32 s59, 0xaaa00aa
v_mfma_f32_16x16x32_bf16 v[152:155], a[84:87], a[16:19], v[152:155]
ds_read_b64_tr_b16 a[106:107], v15 offset:4352
s_mov_b32 s60, 0x150001
v_mfma_f32_16x16x32_bf16 v[160:163], a[84:87], a[20:23], v[160:163]
ds_read_b64_tr_b16 a[108:109], v15 offset:6144
s_mov_b32 s61, 0x15550155
v_mfma_f32_16x16x32_bf16 v[160:163], a[80:83], a[4:7], v[160:163]
ds_read_b64_tr_b16 a[110:111], v15 offset:6400
s_mov_b32 s62, 0x2a0002
v_mfma_f32_16x16x32_bf16 v[168:171], a[80:83], a[8:11], v[168:171]
s_mov_b32 s63, 0x2aaa02aa
s_mov_b32 s68, 0x55505555
s_mov_b32 s69, 0x50005500
v_mfma_f32_16x16x32_bf16 v[168:171], a[84:87], a[24:27], v[168:171]
buffer_load_dwordx4 v16, s[48:51], s7 offen offset:2048 sc1 lds
v_mfma_f32_16x16x32_bf16 v[176:179], a[84:87], a[28:31], v[176:179]
s_mov_b32 s70, 0xaaa0aaaa
s_mov_b32 s71, 0xa000aa00
s_mov_b32 s76, 0x55405554
v_mfma_f32_16x16x32_bf16 v[176:179], a[80:83], a[12:15], v[176:179]
s_mov_b32 s77, 0x40005400
s_mov_b32 s78, 0xaa80aaa8
s_mov_b32 s79, 0x8000a800
v_mfma_f32_16x16x32_bf16 v[180:183], a[88:91], a[12:15], v[180:183]
ds_read_b64_tr_b16 a[80:81], v14 offset:8192
s_mov_b32 s11, 0xf149f2ca
s_mov_b32 s36, 0xfff0ffff
v_mfma_f32_16x16x32_bf16 v[180:183], a[92:95], a[28:31], v[180:183]
ds_read_b64_tr_b16 a[82:83], v14 offset:8448
s_mov_b32 s37, 0xf000ff00
v_mfma_f32_16x16x32_bf16 v[172:175], a[92:95], a[24:27], v[172:175]
ds_read_b64_tr_b16 a[84:85], v14 offset:10240
s_mov_b32 s38, 0xffe0fffe
v_mfma_f32_16x16x32_bf16 v[172:175], a[88:91], a[8:11], v[172:175]
buffer_load_dwordx4 v16, s[48:51], s7 offen offset:3072 sc1 lds
v_mfma_f32_16x16x32_bf16 v[164:167], a[88:91], a[4:7], v[164:167]
ds_read_b64_tr_b16 a[86:87], v14 offset:10496
s_add_u32 s32, s32, 0x8000
v_mfma_f32_16x16x32_bf16 v[164:167], a[92:95], a[20:23], v[164:167]
s_add_u32 s7, s7, 0x8000
s_mov_b32 s39, 0xe000fe00
s_mov_b32 s40, 0xffc0fffc
v_mfma_f32_16x16x32_bf16 v[156:159], a[92:95], a[16:19], v[156:159]
s_mov_b32 s41, 0xc000fc00
s_mov_b32 s42, 0xff80fff8
s_mov_b32 s43, 0x8000f800
v_mfma_f32_16x16x32_bf16 v[156:159], a[88:91], a[0:3], v[156:159]
s_waitcnt lgkmcnt(4)
v_mov_b32 v21, s1
v_mfma_f32_16x16x32_bf16 v[184:187], a[96:99], a[0:3], v[184:187]
ds_read_b64_tr_b16 a[88:89], v15 offset:8192
v_add_u32 v20, s0, v16
v_mfma_f32_16x16x32_bf16 v[184:187], a[100:103], a[16:19], v[184:187]
global_load_dword a120, v[20:21], off sc1
v_mfma_f32_16x16x32_bf16 v[192:195], a[100:103], a[20:23], v[192:195]
ds_read_b64_tr_b16 a[90:91], v15 offset:8448
v_mfma_f32_16x16x32_bf16 v[192:195], a[96:99], a[4:7], v[192:195]
ds_read_b64_tr_b16 a[92:93], v15 offset:10240
v_mfma_f32_16x16x32_bf16 v[200:203], a[96:99], a[8:11], v[200:203]
ds_read_b64_tr_b16 a[94:95], v15 offset:10496
v_add_u32 v12, 0x8000, v12
v_mfma_f32_16x16x32_bf16 v[200:203], a[100:103], a[24:27], v[200:203]
v_add_u32 v13, 0x8000, v13
v_add_u32 v14, 0x8000, v14
v_mfma_f32_16x16x32_bf16 v[208:211], a[100:103], a[28:31], v[208:211]
v_add_u32 v15, 0x8000, v15
v_mfma_f32_16x16x32_bf16 v[208:211], a[96:99], a[12:15], v[208:211]
s_bitcmp1_b32 s4, 0
s_cselect_b32 s8, 0x7f800000, s11
s_cselect_b32 s9, s11, 0x7f800000
v_mfma_f32_16x16x32_bf16 v[212:215], a[104:107], a[12:15], v[212:215]
s_waitcnt vmcnt(19) lgkmcnt(0)
v_mfma_f32_16x16x32_bf16 v[212:215], a[108:111], a[28:31], v[212:215]
s_barrier
s_add_u32 m0, s19, 0x8000
v_mfma_f32_16x16x32_bf16 v[204:207], a[108:111], a[24:27], v[204:207]
buffer_load_dwordx4 v16, s[48:51], s32 offen offset:0 sc1 lds
v_mfma_f32_16x16x32_bf16 v[204:207], a[104:107], a[8:11], v[204:207]
ds_read_b64_tr_b16 a[96:97], v14 offset:4096
v_mfma_f32_16x16x32_bf16 v[196:199], a[104:107], a[4:7], v[196:199]
ds_read_b64_tr_b16 a[98:99], v14 offset:4352
v_mfma_f32_16x16x32_bf16 v[196:199], a[108:111], a[20:23], v[196:199]
ds_read_b64_tr_b16 a[100:101], v14 offset:6144
v_mfma_f32_16x16x32_bf16 v[188:191], a[108:111], a[16:19], v[188:191]
buffer_load_dwordx4 v16, s[48:51], s32 offen offset:1024 sc1 lds
v_mfma_f32_16x16x32_bf16 v[188:191], a[104:107], a[0:3], v[188:191]
ds_read_b64_tr_b16 a[102:103], v14 offset:6400
s_waitcnt lgkmcnt(4)
v_mfma_f32_16x16x32_bf16 v[216:219], a[0:3], a[80:83], v[216:219]
ds_read_b64_tr_b16 a[104:105], v15 offset:4096
v_mfma_f32_16x16x32_bf16 v[216:219], a[16:19], a[84:87], v[216:219]
ds_read_b64_tr_b16 a[106:107], v15 offset:4352
v_mfma_f32_16x16x32_bf16 v[224:227], a[20:23], a[84:87], v[224:227]
ds_read_b64_tr_b16 a[108:109], v15 offset:6144
v_mfma_f32_16x16x32_bf16 v[224:227], a[4:7], a[80:83], v[224:227]
buffer_store_dwordx4 a[64:67], v16, s[88:91], s15 offen offset:0 sc1
v_mfma_f32_16x16x32_bf16 v[232:235], a[8:11], a[80:83], v[232:235]
ds_read_b64_tr_b16 a[110:111], v15 offset:6400
v_mfma_f32_16x16x32_bf16 v[232:235], a[24:27], a[84:87], v[232:235]
v_mfma_f32_16x16x32_bf16 v[240:243], a[28:31], a[84:87], v[240:243]
v_mfma_f32_16x16x32_bf16 v[240:243], a[12:15], a[80:83], v[240:243]
buffer_load_dwordx4 v16, s[48:51], s32 offen offset:2048 sc1 lds
v_mfma_f32_16x16x32_bf16 v[244:247], a[12:15], a[88:91], v[244:247]
ds_read_b64_tr_b16 a[80:81], v14 offset:8192
v_mfma_f32_16x16x32_bf16 v[244:247], a[28:31], a[92:95], v[244:247]
ds_read_b64_tr_b16 a[82:83], v14 offset:8448
v_mfma_f32_16x16x32_bf16 v[236:239], a[24:27], a[92:95], v[236:239]
ds_read_b64_tr_b16 a[84:85], v14 offset:10240
v_mfma_f32_16x16x32_bf16 v[236:239], a[8:11], a[88:91], v[236:239]
ds_read_b64_tr_b16 a[86:87], v14 offset:10496
v_mfma_f32_16x16x32_bf16 v[228:231], a[4:7], a[88:91], v[228:231]
buffer_load_dwordx4 v16, s[48:51], s32 offen offset:3072 sc1 lds
v_mfma_f32_16x16x32_bf16 v[228:231], a[20:23], a[92:95], v[228:231]
v_mfma_f32_16x16x32_bf16 v[220:223], a[16:19], a[92:95], v[220:223]
v_mfma_f32_16x16x32_bf16 v[220:223], a[0:3], a[88:91], v[220:223]
s_waitcnt lgkmcnt(4)
L_S23:
v_mfma_f32_16x16x32_bf16 v[184:187], a[96:99], a[32:35], v[184:187]
buffer_store_dwordx4 a[64:67], v16, s[88:91], s15 offen offset:1024 sc1
v_mov_b32 v8, v19
v_mfma_f32_16x16x32_bf16 v[184:187], a[100:103], a[48:51], v[184:187]
ds_read_b64_tr_b16 a[88:89], v15 offset:8192
v_mov_b32 v9, 0xf149f2ca
v_mfma_f32_16x16x32_bf16 v[192:195], a[100:103], a[52:55], v[192:195]
ds_read_b64_tr_b16 a[90:91], v15 offset:8448
v_mov_b32 v248, 0xffff
v_mfma_f32_16x16x32_bf16 v[192:195], a[96:99], a[36:39], v[192:195]
ds_read_b64_tr_b16 a[92:93], v15 offset:10240
v_mov_b32 v249, 0xffff0000
v_mfma_f32_16x16x32_bf16 v[200:203], a[96:99], a[40:43], v[200:203]
ds_read_b64_tr_b16 a[94:95], v15 offset:10496
s_add_u32 m0, s19, 0x9000
v_cndmask_b32 v252, 0, v248, s[56:57]
v_mfma_f32_16x16x32_bf16 v[200:203], a[100:103], a[56:59], v[200:203]
buffer_load_dwordx4 v16, s[48:51], s7 offen offset:0 sc1 lds
v_mfma_f32_16x16x32_bf16 v[208:211], a[100:103], a[60:63], v[208:211]
v_cndmask_b32 v252, v252, v249, s[58:59]
v_cndmask_b32 v253, 0, v248, s[60:61]
v_mfma_f32_16x16x32_bf16 v[208:211], a[96:99], a[44:47], v[208:211]
v_cndmask_b32 v253, v253, v249, s[62:63]
v_cndmask_b32 v254, 0, v248, s[68:69]
v_mfma_f32_16x16x32_bf16 v[212:215], a[104:107], a[44:47], v[212:215]
ds_read_b64_tr_b16 a[96:97], v14 offset:0
v_cndmask_b32 v254, v254, v249, s[70:71]
v_cndmask_b32 v255, 0, v248, s[76:77]
v_mfma_f32_16x16x32_bf16 v[212:215], a[108:111], a[60:63], v[212:215]
buffer_load_dwordx4 v16, s[48:51], s7 offen offset:1024 sc1 lds
v_mfma_f32_16x16x32_bf16 v[204:207], a[108:111], a[56:59], v[204:207]
ds_read_b64_tr_b16 a[98:99], v14 offset:256
v_cndmask_b32 v255, v255, v249, s[78:79]
v_mfma_f32_16x16x32_bf16 v[204:207], a[104:107], a[40:43], v[204:207]
ds_read_b64_tr_b16 a[100:101], v14 offset:2048
v_cndmask_b32 v248, v9, 0, s[68:69]
v_mfma_f32_16x16x32_bf16 v[196:199], a[104:107], a[36:39], v[196:199]
ds_read_b64_tr_b16 a[102:103], v14 offset:2304
v_cndmask_b32 v249, v9, 0, s[70:71]
v_cndmask_b32 v250, v9, 0, s[76:77]
v_mfma_f32_16x16x32_bf16 v[196:199], a[108:111], a[52:55], v[196:199]
v_cndmask_b32 v251, v9, 0, s[78:79]
v_mfma_f32_16x16x32_bf16 v[188:191], a[108:111], a[48:51], v[188:191]
buffer_store_dwordx4 a[64:67], v16, s[88:91], s15 offen offset:2048 sc1
v_mfma_f32_16x16x32_bf16 v[188:191], a[104:107], a[32:35], v[188:191]
s_waitcnt lgkmcnt(4)
v_mfma_f32_16x16x32_bf16 v[216:219], a[32:35], a[80:83], v[216:219]
ds_read_b64_tr_b16 a[104:105], v15 offset:0
v_mfma_f32_16x16x32_bf16 v[216:219], a[48:51], a[84:87], v[216:219]
ds_read_b64_tr_b16 a[106:107], v15 offset:256
v_mfma_f32_16x16x32_bf16 v[224:227], a[52:55], a[84:87], v[224:227]
buffer_load_dwordx4 v16, s[48:51], s7 offen offset:2048 sc1 lds
v_mfma_f32_16x16x32_bf16 v[224:227], a[36:39], a[80:83], v[224:227]
ds_read_b64_tr_b16 a[108:109], v15 offset:2048
v_cvt_pk_bf16_f32 v192, v192, v193
v_mfma_f32_16x16x32_bf16 v[232:235], a[40:43], a[80:83], v[232:235]
ds_read_b64_tr_b16 a[110:111], v15 offset:2304
v_cvt_pk_bf16_f32 v193, v194, v195
v_cvt_pk_bf16_f32 v194, v196, v197
v_mfma_f32_16x16x32_bf16 v[232:235], a[56:59], a[84:87], v[232:235]
v_cvt_pk_bf16_f32 v195, v198, v199
v_cvt_pk_bf16_f32 v208, v208, v209
v_mfma_f32_16x16x32_bf16 v[240:243], a[60:63], a[84:87], v[240:243]
v_cvt_pk_bf16_f32 v209, v210, v211
v_cvt_pk_bf16_f32 v210, v212, v213
v_mfma_f32_16x16x32_bf16 v[240:243], a[44:47], a[80:83], v[240:243]
buffer_load_dwordx4 v16, s[48:51], s7 offen offset:3072 sc1 lds
v_mfma_f32_16x16x32_bf16 v[244:247], a[44:47], a[88:91], v[244:247]
ds_read_b64_tr_b16 a[80:81], v12 offset:0
s_add_u32 s32, s32, 0x8000
v_cvt_pk_bf16_f32 v211, v214, v215
v_mfma_f32_16x16x32_bf16 v[244:247], a[60:63], a[92:95], v[244:247]
ds_read_b64_tr_b16 a[82:83], v12 offset:1024
s_add_u32 s7, s7, 0x8000
v_mfma_f32_16x16x32_bf16 v[236:239], a[56:59], a[92:95], v[236:239]
ds_read_b64_tr_b16 a[84:85], v12 offset:8192
v_mfma_f32_16x16x32_bf16 v[236:239], a[40:43], a[88:91], v[236:239]
buffer_store_dwordx4 a[64:67], v16, s[88:91], s15 offen offset:3072 sc1
v_mfma_f32_16x16x32_bf16 v[228:231], a[36:39], a[88:91], v[228:231]
ds_read_b64_tr_b16 a[86:87], v12 offset:9216
v_mfma_f32_16x16x32_bf16 v[228:231], a[52:55], a[92:95], v[228:231]
s_cmp_lg_u32 s4, 0
s_cbranch_scc1 L_hx0
buffer_store_dwordx4 v[192:195], v22, s[88:91], 0 offen offset:0 sc1
buffer_store_dwordx4 v[208:211], v7, s[88:91], 0 offen offset:0 sc1
L_hx0:
v_mfma_f32_16x16x32_bf16 v[220:223], a[48:51], a[92:95], v[220:223]
v_cvt_pk_bf16_f32 v184, v184, v185
v_cvt_pk_bf16_f32 v185, v186, v187
v_mfma_f32_16x16x32_bf16 v[220:223], a[32:35], a[88:91], v[220:223]
s_waitcnt lgkmcnt(4)
v_cvt_pk_bf16_f32 v186, v188, v189
v_cvt_pk_bf16_f32 v187, v190, v191
v_mfma_f32_16x16x32_bf16 v[152:155], a[96:99], a[32:35], v[152:155]
ds_read_b64_tr_b16 a[88:89], v13 offset:0
v_cvt_pk_bf16_f32 v200, v200, v201
v_cvt_pk_bf16_f32 v201, v202, v203
v_mfma_f32_16x16x32_bf16 v[152:155], a[100:103], a[48:51], v[152:155]
ds_read_b64_tr_b16 a[90:91], v13 offset:1024
v_cvt_pk_bf16_f32 v202, v204, v205
v_mfma_f32_16x16x32_bf16 v[160:163], a[100:103], a[52:55], v[160:163]
ds_read_b64_tr_b16 a[92:93], v13 offset:8192
v_cvt_pk_bf16_f32 v203, v206, v207
v_mfma_f32_16x16x32_bf16 v[160:163], a[96:99], a[36:39], v[160:163]
ds_read_b64_tr_b16 a[94:95], v13 offset:9216
v_mfma_f32_16x16x32_bf16 v[168:171], a[96:99], a[40:43], v[168:171]
ds_write_b128 v5, v[192:195] offset:2048
v_mfma_f32_16x16x32_bf16 v[168:171], a[100:103], a[56:59], v[168:171]
ds_write_b128 v5, v[208:211] offset:18432
v_mfma_f32_16x16x32_bf16 v[176:179], a[100:103], a[60:63], v[176:179]
ds_write_b128 v4, v[184:187] offset:2048
v_mfma_f32_16x16x32_bf16 v[176:179], a[96:99], a[44:47], v[176:179]
ds_write_b128 v4, v[200:203] offset:18432
v_mfma_f32_16x16x32_bf16 v[180:183], a[104:107], a[44:47], v[180:183]
ds_read_b64_tr_b16 a[96:97], v12 offset:256
v_cvt_pk_bf16_f32 v231, v230, v231
v_cvt_pk_bf16_f32 v230, v228, v229
v_mfma_f32_16x16x32_bf16 v[180:183], a[108:111], a[60:63], v[180:183]
ds_read_b64_tr_b16 a[98:99], v12 offset:1280
v_cvt_pk_bf16_f32 v228, v224, v225
v_mfma_f32_16x16x32_bf16 v[172:175], a[108:111], a[56:59], v[172:175]
ds_read_b64_tr_b16 a[100:101], v12 offset:8448
v_cvt_pk_bf16_f32 v229, v226, v227
v_mfma_f32_16x16x32_bf16 v[172:175], a[104:107], a[40:43], v[172:175]
ds_read_b64_tr_b16 a[102:103], v12 offset:9472
v_cvt_pk_bf16_f32 v227, v226, v227
v_mfma_f32_16x16x32_bf16 v[164:167], a[104:107], a[36:39], v[164:167]
v_cvt_pk_bf16_f32 v226, v224, v225
v_cvt_pk_bf16_f32 v247, v246, v247
v_cvt_pk_bf16_f32 v246, v244, v245
v_mfma_f32_16x16x32_bf16 v[164:167], a[108:111], a[52:55], v[164:167]
v_cvt_pk_bf16_f32 v244, v240, v241
v_cvt_pk_bf16_f32 v245, v242, v243
v_mfma_f32_16x16x32_bf16 v[156:159], a[108:111], a[48:51], v[156:159]
v_cvt_pk_bf16_f32 v243, v242, v243
v_cvt_pk_bf16_f32 v242, v240, v241
v_mfma_f32_16x16x32_bf16 v[156:159], a[104:107], a[32:35], v[156:159]
s_waitcnt lgkmcnt(4)
v_mfma_f32_16x16x32_bf16 v[24:27], a[80:83], a[32:35], v[24:27]
ds_read_b64_tr_b16 a[104:105], v13 offset:256
v_mfma_f32_16x16x32_bf16 v[24:27], a[84:87], a[48:51], v[24:27]
ds_read_b64_tr_b16 a[106:107], v13 offset:1280
v_mfma_f32_16x16x32_bf16 v[32:35], a[84:87], a[52:55], v[32:35]
ds_read_b64_tr_b16 a[108:109], v13 offset:8448
v_mfma_f32_16x16x32_bf16 v[32:35], a[80:83], a[36:39], v[32:35]
ds_read_b64_tr_b16 a[110:111], v13 offset:9472
v_mfma_f32_16x16x32_bf16 v[40:43], a[80:83], a[40:43], v[40:43]
s_cmp_lg_u32 s4, 0
s_cbranch_scc1 L_hx1
buffer_store_dwordx4 v[228:231], v22, s[88:91], 0 offen offset:1024 sc1
buffer_store_dwordx4 v[244:247], v7, s[88:91], 0 offen offset:1024 sc1
L_hx1:
v_mfma_f32_16x16x32_bf16 v[40:43], a[84:87], a[56:59], v[40:43]
v_cvt_pk_bf16_f32 v223, v222, v223
v_cvt_pk_bf16_f32 v222, v220, v221
v_mfma_f32_16x16x32_bf16 v[48:51], a[84:87], a[60:63], v[48:51]
v_cvt_pk_bf16_f32 v220, v216, v217
v_cvt_pk_bf16_f32 v221, v218, v219
v_mfma_f32_16x16x32_bf16 v[48:51], a[80:83], a[44:47], v[48:51]
v_cvt_pk_bf16_f32 v219, v218, v219
v_cvt_pk_bf16_f32 v218, v216, v217
v_mfma_f32_16x16x32_bf16 v[52:55], a[88:91], a[44:47], v[52:55]
ds_read_b64_tr_b16 a[80:81], v12 offset:512
v_cvt_pk_bf16_f32 v239, v238, v239
v_cvt_pk_bf16_f32 v238, v236, v237
v_mfma_f32_16x16x32_bf16 v[52:55], a[92:95], a[60:63], v[52:55]
ds_read_b64_tr_b16 a[82:83], v12 offset:1536
v_cvt_pk_bf16_f32 v236, v232, v233
v_mfma_f32_16x16x32_bf16 v[44:47], a[92:95], a[56:59], v[44:47]
ds_read_b64_tr_b16 a[84:85], v12 offset:8704
v_cvt_pk_bf16_f32 v237, v234, v235
v_mfma_f32_16x16x32_bf16 v[44:47], a[88:91], a[40:43], v[44:47]
ds_read_b64_tr_b16 a[86:87], v12 offset:9728
v_cvt_pk_bf16_f32 v235, v234, v235
v_mfma_f32_16x16x32_bf16 v[36:39], a[88:91], a[36:39], v[36:39]
v_cvt_pk_bf16_f32 v234, v232, v233
v_mfma_f32_16x16x32_bf16 v[36:39], a[92:95], a[52:55], v[36:39]
ds_write_b128 v5, v[228:231] offset:3072
v_mfma_f32_16x16x32_bf16 v[28:31], a[92:95], a[48:51], v[28:31]
ds_write_b128 v5, v[244:247] offset:19456
v_mfma_f32_16x16x32_bf16 v[28:31], a[88:91], a[32:35], v[28:31]
s_waitcnt lgkmcnt(4)
v_mfma_f32_16x16x32_bf16 v[56:59], a[96:99], a[32:35], v[56:59]
ds_read_b64_tr_b16 a[88:89], v13 offset:512
v_mfma_f32_16x16x32_bf16 v[56:59], a[100:103], a[48:51], v[56:59]
ds_read_b64_tr_b16 a[90:91], v13 offset:1536
v_mfma_f32_16x16x32_bf16 v[64:67], a[100:103], a[52:55], v[64:67]
ds_read_b64_tr_b16 a[92:93], v13 offset:8704
v_mfma_f32_16x16x32_bf16 v[64:67], a[96:99], a[36:39], v[64:67]
ds_read_b64_tr_b16 a[94:95], v13 offset:9728
v_mfma_f32_16x16x32_bf16 v[72:75], a[96:99], a[40:43], v[72:75]
ds_write_b128 v4, v[220:223] offset:3072
v_mfma_f32_16x16x32_bf16 v[72:75], a[100:103], a[56:59], v[72:75]
ds_write_b128 v4, v[236:239] offset:19456
v_mfma_f32_16x16x32_bf16 v[80:83], a[100:103], a[60:63], v[80:83]
v_cvt_pk_bf16_f32 v152, v152, v153
v_cvt_pk_bf16_f32 v153, v154, v155
v_mfma_f32_16x16x32_bf16 v[80:83], a[96:99], a[44:47], v[80:83]
v_cvt_pk_bf16_f32 v154, v156, v157
v_cvt_pk_bf16_f32 v155, v158, v159
v_mfma_f32_16x16x32_bf16 v[84:87], a[104:107], a[44:47], v[84:87]
ds_read_b64_tr_b16 a[96:97], v12 offset:768
v_cvt_pk_bf16_f32 v160, v160, v161
v_cvt_pk_bf16_f32 v161, v162, v163
v_mfma_f32_16x16x32_bf16 v[84:87], a[108:111], a[60:63], v[84:87]
ds_read_b64_tr_b16 a[98:99], v12 offset:1792
v_cvt_pk_bf16_f32 v162, v164, v165
v_mfma_f32_16x16x32_bf16 v[76:79], a[108:111], a[56:59], v[76:79]
ds_read_b64_tr_b16 a[100:101], v12 offset:8960
v_cvt_pk_bf16_f32 v163, v166, v167
v_mfma_f32_16x16x32_bf16 v[76:79], a[104:107], a[40:43], v[76:79]
ds_read_b64_tr_b16 a[102:103], v12 offset:9984
v_cvt_pk_bf16_f32 v168, v168, v169
v_mfma_f32_16x16x32_bf16 v[68:71], a[104:107], a[36:39], v[68:71]
v_cvt_pk_bf16_f32 v169, v170, v171
v_cvt_pk_bf16_f32 v170, v172, v173
v_cvt_pk_bf16_f32 v171, v174, v175
v_mfma_f32_16x16x32_bf16 v[68:71], a[108:111], a[52:55], v[68:71]
v_cvt_pk_bf16_f32 v176, v176, v177
v_cvt_pk_bf16_f32 v177, v178, v179
v_mfma_f32_16x16x32_bf16 v[60:63], a[108:111], a[48:51], v[60:63]
v_cvt_pk_bf16_f32 v178, v180, v181
v_cvt_pk_bf16_f32 v179, v182, v183
v_mfma_f32_16x16x32_bf16 v[60:63], a[104:107], a[32:35], v[60:63]
s_waitcnt lgkmcnt(4)
v_mfma_f32_16x16x32_bf16 v[88:91], a[80:83], a[32:35], v[88:91]
ds_read_b64_tr_b16 a[104:105], v13 offset:768
v_mfma_f32_16x16x32_bf16 v[88:91], a[84:87], a[48:51], v[88:91]
ds_read_b64_tr_b16 a[106:107], v13 offset:1792
v_mfma_f32_16x16x32_bf16 v[96:99], a[84:87], a[52:55], v[96:99]
ds_read_b64_tr_b16 a[108:109], v13 offset:8960
v_mfma_f32_16x16x32_bf16 v[96:99], a[80:83], a[36:39], v[96:99]
ds_read_b64_tr_b16 a[110:111], v13 offset:9984
v_mfma_f32_16x16x32_bf16 v[104:107], a[80:83], a[40:43], v[104:107]
v_mfma_f32_16x16x32_bf16 v[104:107], a[84:87], a[56:59], v[104:107]
v_mfma_f32_16x16x32_bf16 v[112:115], a[84:87], a[60:63], v[112:115]
v_mfma_f32_16x16x32_bf16 v[112:115], a[80:83], a[44:47], v[112:115]
v_mfma_f32_16x16x32_bf16 v[116:119], a[88:91], a[44:47], v[116:119]
v_mfma_f32_16x16x32_bf16 v[116:119], a[92:95], a[60:63], v[116:119]
v_mfma_f32_16x16x32_bf16 v[108:111], a[92:95], a[56:59], v[108:111]
v_mfma_f32_16x16x32_bf16 v[108:111], a[88:91], a[40:43], v[108:111]
v_mov_b32 v15, s6
v_xor_b32 v15, 0, v15
v_mfma_f32_16x16x32_bf16 v[100:103], a[88:91], a[36:39], v[100:103]
v_writelane_b32 v15, s18, 0
v_lshlrev_b32 v15, 2, v15
v_bfe_u32 v12, v0, 2, 2
v_mfma_f32_16x16x32_bf16 v[100:103], a[92:95], a[52:55], v[100:103]
v_lshlrev_b32 v12, 11, v12
v_lshrrev_b32 v13, 4, v0
v_mfma_f32_16x16x32_bf16 v[92:95], a[92:95], a[48:51], v[92:95]
v_lshl_add_u32 v12, v13, 6, v12
v_and_b32 v13, 3, v0
v_mfma_f32_16x16x32_bf16 v[92:95], a[88:91], a[32:35], v[92:95]
s_waitcnt lgkmcnt(0)
v_lshl_add_u32 v12, v13, 4, v12
v_xor_b32 v12, s13, v12
v_mfma_f32_16x16x32_bf16 v[120:123], a[96:99], a[32:35], v[120:123]
L_padA12:
s_cmp_eq_u32 s95, 1
s_cbranch_scc1 L_hopA_ret
v_xor_b32 v13, 32, v12
v_add_u32 v13, 7168, v13
v_mul_f32 v24, s52, v24
v_mfma_f32_16x16x32_bf16 v[120:123], a[100:103], a[48:51], v[120:123]
v_mul_f32 v25, s52, v25
v_mul_f32 v26, s52, v26
v_mfma_f32_16x16x32_bf16 v[128:131], a[100:103], a[52:55], v[128:131]
v_mul_f32 v27, s52, v27
v_mul_f32 v28, s52, v28
v_mfma_f32_16x16x32_bf16 v[128:131], a[96:99], a[36:39], v[128:131]
v_mul_f32 v29, s52, v29
v_mul_f32 v30, s52, v30
v_mfma_f32_16x16x32_bf16 v[136:139], a[96:99], a[40:43], v[136:139]
v_mul_f32 v31, s52, v31
v_cvt_pk_bf16_f32 v24, v24, v25
v_cvt_pk_bf16_f32 v25, v26, v27
v_mfma_f32_16x16x32_bf16 v[136:139], a[100:103], a[56:59], v[136:139]
v_cvt_pk_bf16_f32 v26, v28, v29
v_cvt_pk_bf16_f32 v27, v30, v31
v_mfma_f32_16x16x32_bf16 v[144:147], a[100:103], a[60:63], v[144:147]
v_accvgpr_write_b32 a160, v24
v_accvgpr_write_b32 a161, v25
v_mfma_f32_16x16x32_bf16 v[144:147], a[96:99], a[44:47], v[144:147]
v_accvgpr_write_b32 a162, v26
v_accvgpr_write_b32 a163, v27
v_mfma_f32_16x16x32_bf16 v[148:151], a[104:107], a[44:47], v[148:151]
v_mul_f32 v32, s52, v32
v_mul_f32 v33, s52, v33
v_mul_f32 v34, s52, v34
v_mfma_f32_16x16x32_bf16 v[148:151], a[108:111], a[60:63], v[148:151]
v_mul_f32 v35, s52, v35
v_mul_f32 v36, s52, v36
v_mfma_f32_16x16x32_bf16 v[140:143], a[108:111], a[56:59], v[140:143]
v_mul_f32 v37, s52, v37
v_mul_f32 v38, s52, v38
v_mfma_f32_16x16x32_bf16 v[140:143], a[104:107], a[40:43], v[140:143]
v_mul_f32 v39, s52, v39
v_cvt_pk_bf16_f32 v32, v32, v33
v_mfma_f32_16x16x32_bf16 v[132:135], a[104:107], a[36:39], v[132:135]
v_cvt_pk_bf16_f32 v33, v34, v35
v_cvt_pk_bf16_f32 v34, v36, v37
v_cvt_pk_bf16_f32 v35, v38, v39
v_mfma_f32_16x16x32_bf16 v[132:135], a[108:111], a[52:55], v[132:135]
v_accvgpr_write_b32 a176, v32
v_accvgpr_write_b32 a177, v33
v_mfma_f32_16x16x32_bf16 v[124:127], a[108:111], a[48:51], v[124:127]
v_accvgpr_write_b32 a178, v34
v_accvgpr_write_b32 a179, v35
v_mfma_f32_16x16x32_bf16 v[124:127], a[104:107], a[32:35], v[124:127]
L_trans:
s_waitcnt vmcnt(21) lgkmcnt(0)
s_barrier
s_cmp_eq_u32 s4, 0
s_cbranch_scc1 L_hx_ld
ds_read_b128 v[188:191], v4 offset:0
ds_read_b64 v[216:217], v4 offset:1024
ds_read_b64 v[220:221], v4 offset:1032
ds_read_b128 v[204:207], v4 offset:16384
ds_read_b64 v[232:233], v4 offset:17408
ds_read_b64 v[236:237], v4 offset:17416
s_branch L_hx_rd
L_hx_ld:
buffer_load_dwordx4 v[188:191], v10, s[88:91], 0 offen sc1
buffer_load_dwordx2 v[216:217], v10, s[88:91], 0 offen offset:1024 sc1
buffer_load_dwordx2 v[220:221], v10, s[88:91], 0 offen offset:1032 sc1
buffer_load_dwordx4 v[204:207], v11, s[88:91], 0 offen sc1
buffer_load_dwordx2 v[232:233], v11, s[88:91], 0 offen offset:1024 sc1
buffer_load_dwordx2 v[236:237], v11, s[88:91], 0 offen offset:1032 sc1
L_hx_rd:
ds_read_b128 v[196:199], v6 offset:0
ds_read_b64 v[224:225], v6 offset:1024
ds_read_b64 v[228:229], v6 offset:1032
ds_read_b128 v[212:215], v6 offset:16384
ds_read_b64 v[240:241], v6 offset:17408
ds_read_b64 v[244:245], v6 offset:17416
ds_read_b128 a[0:3], v1 offset:8192
ds_read_b128 a[4:7], v1 offset:9216
ds_read_b128 a[8:11], v1 offset:10240
ds_read_b128 a[12:15], v1 offset:11264
ds_read_b128 a[16:19], v1 offset:12288
ds_read_b128 a[20:23], v1 offset:13312
ds_read_b128 a[24:27], v1 offset:14336
ds_read_b128 a[28:31], v1 offset:15360
L_hopB:
s_mov_b32 s95, 0
v_pk_mul_f32 v[40:41], v[40:41], s[52:53]
v_pk_mul_f32 v[42:43], v[42:43], s[52:53]
v_pk_mul_f32 v[44:45], v[44:45], s[52:53]
v_pk_mul_f32 v[46:47], v[46:47], s[52:53]
v_cvt_pk_bf16_f32 v40, v40, v41
v_cvt_pk_bf16_f32 v41, v42, v43
v_cvt_pk_bf16_f32 v42, v44, v45
v_cvt_pk_bf16_f32 v43, v46, v47
v_accvgpr_write_b32 a192, v40
v_accvgpr_write_b32 a193, v41
v_accvgpr_write_b32 a194, v42
v_accvgpr_write_b32 a195, v43
v_pk_mul_f32 v[48:49], v[48:49], s[52:53]
v_pk_mul_f32 v[50:51], v[50:51], s[52:53]
v_pk_mul_f32 v[52:53], v[52:53], s[52:53]
v_pk_mul_f32 v[54:55], v[54:55], s[52:53]
v_cvt_pk_bf16_f32 v48, v48, v49
v_cvt_pk_bf16_f32 v49, v50, v51
v_cvt_pk_bf16_f32 v50, v52, v53
v_cvt_pk_bf16_f32 v51, v54, v55
v_accvgpr_write_b32 a208, v48
v_accvgpr_write_b32 a209, v49
v_accvgpr_write_b32 a210, v50
v_accvgpr_write_b32 a211, v51
v_mov_b32 v47, s55
v_cndmask_b32 v36, v9, 0, s[56:57]
v_min_f32 v32, s55, v36
v_cndmask_b32 v44, v47, 0, s[36:37]
v_cndmask_b32 v37, v9, 0, s[58:59]
v_min_f32 v33, s55, v37
v_cndmask_b32 v45, v47, 0, s[38:39]
v_cndmask_b32 v38, v9, 0, s[60:61]
v_min_f32 v34, s55, v38
v_cndmask_b32 v46, v47, 0, s[40:41]
v_cndmask_b32 v39, v9, 0, s[62:63]
v_min_f32 v35, s55, v39
v_cndmask_b32 v47, v47, 0, s[42:43]
v_pk_mul_f32 v[56:57], v[56:57], s[52:53]
v_pk_mul_f32 v[58:59], v[58:59], s[52:53]
v_pk_mul_f32 v[60:61], v[60:61], s[52:53]
v_pk_mul_f32 v[62:63], v[62:63], s[52:53]
v_cvt_pk_bf16_f32 v56, v56, v57
v_cvt_pk_bf16_f32 v57, v58, v59
v_cvt_pk_bf16_f32 v58, v60, v61
v_cvt_pk_bf16_f32 v59, v62, v63
v_accvgpr_write_b32 a164, v56
v_accvgpr_write_b32 a165, v57
v_accvgpr_write_b32 a166, v58
v_accvgpr_write_b32 a167, v59
v_pk_mul_f32 v[64:65], v[64:65], s[52:53]
v_pk_mul_f32 v[66:67], v[66:67], s[52:53]
v_pk_mul_f32 v[68:69], v[68:69], s[52:53]
v_pk_mul_f32 v[70:71], v[70:71], s[52:53]
v_cvt_pk_bf16_f32 v64, v64, v65
v_cvt_pk_bf16_f32 v65, v66, v67
v_cvt_pk_bf16_f32 v66, v68, v69
v_cvt_pk_bf16_f32 v67, v70, v71
v_accvgpr_write_b32 a180, v64
v_accvgpr_write_b32 a181, v65
v_accvgpr_write_b32 a182, v66
v_accvgpr_write_b32 a183, v67
v_pk_mul_f32 v[72:73], v[72:73], s[52:53]
v_pk_mul_f32 v[74:75], v[74:75], s[52:53]
v_pk_mul_f32 v[76:77], v[76:77], s[52:53]
v_pk_mul_f32 v[78:79], v[78:79], s[52:53]
v_cvt_pk_bf16_f32 v72, v72, v73
v_cvt_pk_bf16_f32 v73, v74, v75
v_cvt_pk_bf16_f32 v74, v76, v77
v_cvt_pk_bf16_f32 v75, v78, v79
v_accvgpr_write_b32 a196, v72
v_accvgpr_write_b32 a197, v73
v_accvgpr_write_b32 a198, v74
v_accvgpr_write_b32 a199, v75
v_pk_mul_f32 v[80:81], v[80:81], s[52:53]
v_pk_mul_f32 v[82:83], v[82:83], s[52:53]
v_pk_mul_f32 v[84:85], v[84:85], s[52:53]
v_pk_mul_f32 v[86:87], v[86:87], s[52:53]
v_cvt_pk_bf16_f32 v80, v80, v81
v_cvt_pk_bf16_f32 v81, v82, v83
v_cvt_pk_bf16_f32 v82, v84, v85
v_cvt_pk_bf16_f32 v83, v86, v87
v_accvgpr_write_b32 a212, v80
v_accvgpr_write_b32 a213, v81
v_accvgpr_write_b32 a214, v82
v_accvgpr_write_b32 a215, v83
v_pk_mul_f32 v[88:89], v[88:89], s[52:53]
v_pk_mul_f32 v[90:91], v[90:91], s[52:53]
v_pk_mul_f32 v[92:93], v[92:93], s[52:53]
v_pk_mul_f32 v[94:95], v[94:95], s[52:53]
v_cvt_pk_bf16_f32 v88, v88, v89
v_cvt_pk_bf16_f32 v89, v90, v91
v_cvt_pk_bf16_f32 v90, v92, v93
v_cvt_pk_bf16_f32 v91, v94, v95
v_accvgpr_write_b32 a168, v88
v_accvgpr_write_b32 a169, v89
v_accvgpr_write_b32 a170, v90
v_accvgpr_write_b32 a171, v91
v_pk_mul_f32 v[96:97], v[96:97], s[52:53]
v_pk_mul_f32 v[98:99], v[98:99], s[52:53]
v_pk_mul_f32 v[100:101], v[100:101], s[52:53]
v_pk_mul_f32 v[102:103], v[102:103], s[52:53]
v_cvt_pk_bf16_f32 v96, v96, v97
v_cvt_pk_bf16_f32 v97, v98, v99
v_cvt_pk_bf16_f32 v98, v100, v101
v_cvt_pk_bf16_f32 v99, v102, v103
v_accvgpr_write_b32 a184, v96
v_accvgpr_write_b32 a185, v97
v_accvgpr_write_b32 a186, v98
v_accvgpr_write_b32 a187, v99
v_pk_mul_f32 v[104:105], v[104:105], s[52:53]
v_pk_mul_f32 v[106:107], v[106:107], s[52:53]
v_pk_mul_f32 v[108:109], v[108:109], s[52:53]
v_pk_mul_f32 v[110:111], v[110:111], s[52:53]
v_cvt_pk_bf16_f32 v104, v104, v105
v_cvt_pk_bf16_f32 v105, v106, v107
v_cvt_pk_bf16_f32 v106, v108, v109
v_cvt_pk_bf16_f32 v107, v110, v111
v_accvgpr_write_b32 a200, v104
v_accvgpr_write_b32 a201, v105
v_accvgpr_write_b32 a202, v106
v_accvgpr_write_b32 a203, v107
v_pk_mul_f32 v[112:113], v[112:113], s[52:53]
v_pk_mul_f32 v[114:115], v[114:115], s[52:53]
v_pk_mul_f32 v[116:117], v[116:117], s[52:53]
v_pk_mul_f32 v[118:119], v[118:119], s[52:53]
v_cvt_pk_bf16_f32 v112, v112, v113
v_cvt_pk_bf16_f32 v113, v114, v115
v_cvt_pk_bf16_f32 v114, v116, v117
v_cvt_pk_bf16_f32 v115, v118, v119
v_accvgpr_write_b32 a216, v112
v_accvgpr_write_b32 a217, v113
v_accvgpr_write_b32 a218, v114
v_accvgpr_write_b32 a219, v115
v_pk_mul_f32 v[120:121], v[120:121], s[52:53]
v_pk_mul_f32 v[122:123], v[122:123], s[52:53]
v_pk_mul_f32 v[124:125], v[124:125], s[52:53]
v_pk_mul_f32 v[126:127], v[126:127], s[52:53]
v_cvt_pk_bf16_f32 v120, v120, v121
v_cvt_pk_bf16_f32 v121, v122, v123
v_cvt_pk_bf16_f32 v122, v124, v125
v_cvt_pk_bf16_f32 v123, v126, v127
v_accvgpr_write_b32 a172, v120
v_accvgpr_write_b32 a173, v121
v_accvgpr_write_b32 a174, v122
v_accvgpr_write_b32 a175, v123
v_pk_mul_f32 v[128:129], v[128:129], s[52:53]
v_pk_mul_f32 v[130:131], v[130:131], s[52:53]
v_pk_mul_f32 v[132:133], v[132:133], s[52:53]
v_pk_mul_f32 v[134:135], v[134:135], s[52:53]
v_cvt_pk_bf16_f32 v128, v128, v129
v_cvt_pk_bf16_f32 v129, v130, v131
v_cvt_pk_bf16_f32 v130, v132, v133
v_cvt_pk_bf16_f32 v131, v134, v135
v_accvgpr_write_b32 a188, v128
v_accvgpr_write_b32 a189, v129
v_accvgpr_write_b32 a190, v130
v_accvgpr_write_b32 a191, v131
v_pk_mul_f32 v[136:137], v[136:137], s[52:53]
v_pk_mul_f32 v[138:139], v[138:139], s[52:53]
v_pk_mul_f32 v[140:141], v[140:141], s[52:53]
v_pk_mul_f32 v[142:143], v[142:143], s[52:53]
v_cvt_pk_bf16_f32 v136, v136, v137
v_cvt_pk_bf16_f32 v137, v138, v139
v_cvt_pk_bf16_f32 v138, v140, v141
v_cvt_pk_bf16_f32 v139, v142, v143
v_accvgpr_write_b32 a204, v136
v_accvgpr_write_b32 a205, v137
v_accvgpr_write_b32 a206, v138
v_accvgpr_write_b32 a207, v139
v_pk_mul_f32 v[144:145], v[144:145], s[52:53]
v_pk_mul_f32 v[146:147], v[146:147], s[52:53]
v_pk_mul_f32 v[148:149], v[148:149], s[52:53]
v_pk_mul_f32 v[150:151], v[150:151], s[52:53]
v_cvt_pk_bf16_f32 v144, v144, v145
v_cvt_pk_bf16_f32 v145, v146, v147
v_cvt_pk_bf16_f32 v146, v148, v149
v_cvt_pk_bf16_f32 v147, v150, v151
v_accvgpr_write_b32 a220, v144
v_accvgpr_write_b32 a221, v145
v_accvgpr_write_b32 a222, v146
v_accvgpr_write_b32 a223, v147
s_cmp_lg_u32 s4, 0
s_cbranch_scc1 L_spun_hx
s_mov_b32 s92, 200000
L_spin_hx:
s_waitcnt vmcnt(0)
v_max3_u32 v128, v188, v189, 0
v_max3_u32 v128, v190, v191, v128
v_max3_u32 v128, v216, v217, v128
v_max3_u32 v128, v220, v221, v128
v_max3_u32 v128, v204, v205, v128
v_max3_u32 v128, v206, v207, v128
v_max3_u32 v128, v232, v233, v128
v_max3_u32 v128, v236, v237, v128
v_cmp_eq_u32 vcc, -1, v128
s_sub_u32 s92, s92, 1
s_cbranch_scc1 L_spun_hx
s_nop 3
s_cbranch_vccz L_spun_hx
s_sleep 2
buffer_load_dwordx4 v[188:191], v10, s[88:91], 0 offen sc1
buffer_load_dwordx2 v[216:217], v10, s[88:91], 0 offen offset:1024 sc1
buffer_load_dwordx2 v[220:221], v10, s[88:91], 0 offen offset:1032 sc1
buffer_load_dwordx4 v[204:207], v11, s[88:91], 0 offen sc1
buffer_load_dwordx2 v[232:233], v11, s[88:91], 0 offen offset:1024 sc1
buffer_load_dwordx2 v[236:237], v11, s[88:91], 0 offen offset:1032 sc1
s_branch L_spin_hx
L_spun_hx:
s_waitcnt lgkmcnt(0)
s_barrier
v_mfma_f32_16x16x32_bf16 v[52:55], v[184:187], v[152:155], v[248:251]
v_mov_b32 v140, 0
v_mov_b32 v141, 0
v_mfma_f32_16x16x32_bf16 v[48:51], v[188:191], v[152:155], v[32:35]
v_mov_b32 v142, 0
v_mov_b32 v143, 0
v_mfma_f32_16x16x32_bf16 v[60:63], v[192:195], v[160:163], v[248:251]
v_mov_b32 v144, 0
v_mov_b32 v145, 0
v_mfma_f32_16x16x32_bf16 v[56:59], v[196:199], v[160:163], v[36:39]
v_mov_b32 v146, 0
v_mov_b32 v147, 0
v_mfma_f32_16x16x32_bf16 v[68:71], v[200:203], v[168:171], v[248:251]
v_mov_b32 v148, 0
v_mov_b32 v149, 0
v_mfma_f32_16x16x32_bf16 v[64:67], v[204:207], v[168:171], v[36:39]
v_max3_f32 v52, v48, v49, v52
v_max3_f32 v54, v50, v51, v54
v_mfma_f32_16x16x32_bf16 v[76:79], v[208:211], v[176:179], v[248:251]
v_max_f32 v52, v52, v53
v_max_f32 v53, v54, v55
v_mfma_f32_16x16x32_bf16 v[72:75], v[212:215], v[176:179], v[36:39]
v_max_f32 v136, v52, v53
v_max3_f32 v60, v56, v57, v60
v_mfma_f32_16x16x32_bf16 v[16:19], a[0:3], a[160:163], v[44:47]
v_max3_f32 v62, v58, v59, v62
v_max_f32 v60, v60, v61
v_mfma_f32_16x16x32_bf16 v[16:19], a[4:7], a[164:167], v[16:19]
v_max_f32 v61, v62, v63
v_max_f32 v137, v60, v61
v_mfma_f32_16x16x32_bf16 v[16:19], a[8:11], a[168:171], v[16:19]
v_max3_f32 v68, v64, v65, v68
v_max3_f32 v70, v66, v67, v70
v_mfma_f32_16x16x32_bf16 v[16:19], a[12:15], a[172:175], v[16:19]
v_max_f32 v68, v68, v69
v_max_f32 v69, v70, v71
v_mfma_f32_16x16x32_bf16 v[20:23], a[0:3], a[176:179], 0
v_max_f32 v138, v68, v69
v_max3_f32 v76, v72, v73, v76
v_mfma_f32_16x16x32_bf16 v[20:23], a[4:7], a[180:183], v[20:23]
v_max3_f32 v78, v74, v75, v78
v_max_f32 v76, v76, v77
v_mfma_f32_16x16x32_bf16 v[20:23], a[8:11], a[184:187], v[20:23]
v_max_f32 v77, v78, v79
v_max_f32 v139, v76, v77
v_mfma_f32_16x16x32_bf16 v[20:23], a[12:15], a[188:191], v[20:23]
v_mov_b32 v150, 0
v_mov_b32 v151, 0
v_mfma_f32_16x16x32_bf16 v[24:27], a[0:3], a[192:195], 0
v_mov_b32 v248, 0
v_mov_b32 v249, 0
v_mfma_f32_16x16x32_bf16 v[24:27], a[4:7], a[196:199], v[24:27]
v_mov_b32 v250, 0
v_mov_b32 v251, 0
v_mfma_f32_16x16x32_bf16 v[24:27], a[8:11], a[200:203], v[24:27]
v_max3_f32 v80, v16, v17, v18
v_max_f32 v80, v80, v19
v_mfma_f32_16x16x32_bf16 v[24:27], a[12:15], a[204:207], v[24:27]
v_max3_f32 v84, v20, v21, v22
v_max_f32 v84, v84, v23
v_mfma_f32_16x16x32_bf16 v[28:31], a[0:3], a[208:211], 0
v_mov_b32 v128, v136
v_mov_b32 v129, v137
v_mfma_f32_16x16x32_bf16 v[28:31], a[4:7], a[212:215], v[28:31]
v_mov_b32 v130, v138
v_mov_b32 v131, v139
v_mfma_f32_16x16x32_bf16 v[28:31], a[8:11], a[216:219], v[28:31]
v_permlane16_swap_b32 v128, v136
v_permlane16_swap_b32 v129, v137
v_mfma_f32_16x16x32_bf16 v[28:31], a[12:15], a[220:223], v[28:31]
v_permlane16_swap_b32 v130, v138
v_permlane16_swap_b32 v131, v139
v_max_f32 v136, v136, v128
v_max_f32 v137, v137, v129
v_max_f32 v138, v138, v130
v_max_f32 v139, v139, v131
v_max3_f32 v88, v24, v25, v26
v_max_f32 v88, v88, v27
v_mov_b32 v128, v136
v_mov_b32 v129, v137
v_mov_b32 v130, v138
v_mov_b32 v131, v139
v_max3_f32 v92, v28, v29, v30
v_max_f32 v92, v92, v31
v_permlane32_swap_b32 v128, v136
v_permlane32_swap_b32 v129, v137
v_permlane32_swap_b32 v130, v138
v_permlane32_swap_b32 v131, v139
v_max_f32 v136, v136, v128
v_max_f32 v137, v137, v129
v_max_f32 v138, v138, v130
v_max_f32 v139, v139, v131
v_mul_f32 v136, s54, v136
v_mul_f32 v137, s54, v137
v_mul_f32 v138, s54, v138
v_mul_f32 v139, s54, v139
v_fma_f32 v52, v52, s54, -v136
v_fma_f32 v53, v53, s54, -v136
v_fma_f32 v60, v60, s54, -v137
v_fma_f32 v61, v61, s54, -v137
v_fma_f32 v68, v68, s54, -v138
v_fma_f32 v69, v69, s54, -v138
v_fma_f32 v76, v76, s54, -v139
v_fma_f32 v77, v77, s54, -v139
v_exp_f32 v52, v52
v_exp_f32 v53, v53
v_exp_f32 v60, v60
v_exp_f32 v61, v61
v_exp_f32 v68, v68
v_exp_f32 v69, v69
v_exp_f32 v76, v76
v_exp_f32 v77, v77
v_cvt_pk_bf16_f32 v52, v52, v52
v_cvt_pk_bf16_f32 v53, v53, v53
v_cvt_pk_bf16_f32 v60, v60, v60
v_cvt_pk_bf16_f32 v61, v61, v61
v_cvt_pk_bf16_f32 v68, v68, v68
v_cvt_pk_bf16_f32 v69, v69, v69
v_cvt_pk_bf16_f32 v76, v76, v76
v_cvt_pk_bf16_f32 v77, v77, v77
v_and_b32 v48, v252, v52
v_and_b32 v49, v253, v53
v_and_b32 v50, v254, v52
v_and_b32 v51, v255, v53
v_and_b32 v56, v252, v60
v_and_b32 v57, v253, v61
v_and_b32 v58, v254, v60
v_and_b32 v59, v255, v61
v_and_b32 v64, v252, v68
v_and_b32 v65, v253, v69
v_and_b32 v66, v254, v68
v_and_b32 v67, v255, v69
v_and_b32 v72, v252, v76
v_and_b32 v73, v253, v77
v_and_b32 v74, v254, v76
v_and_b32 v75, v255, v77
v_mfma_f32_16x16x32_bf16 v[156:159], a[240:243], v[48:51], 0
v_mov_b32 v128, v80
v_mov_b32 v129, v84
v_mfma_f32_16x16x32_bf16 v[164:167], a[240:243], v[56:59], 0
v_mov_b32 v130, v88
v_mov_b32 v131, v92
v_mfma_f32_16x16x32_bf16 v[172:175], a[240:243], v[64:67], 0
v_permlane16_swap_b32 v128, v80
v_permlane16_swap_b32 v129, v84
v_mfma_f32_16x16x32_bf16 v[180:183], a[240:243], v[72:75], 0
v_permlane16_swap_b32 v130, v88
v_permlane16_swap_b32 v131, v92
v_mfma_f32_16x16x32_bf16 v[184:187], v[216:219], v[48:51], 0
v_max_f32 v80, v80, v128
v_max_f32 v84, v84, v129
v_mfma_f32_16x16x32_bf16 v[188:191], v[220:223], v[48:51], 0
v_max_f32 v88, v88, v130
v_max_f32 v92, v92, v131
v_mfma_f32_16x16x32_bf16 v[192:195], v[224:227], v[56:59], 0
v_mov_b32 v128, v80
v_mov_b32 v129, v84
v_mfma_f32_16x16x32_bf16 v[196:199], v[228:231], v[56:59], 0
v_mov_b32 v130, v88
v_mov_b32 v131, v92
v_mfma_f32_16x16x32_bf16 v[200:203], v[232:235], v[64:67], 0
v_permlane32_swap_b32 v128, v80
v_permlane32_swap_b32 v129, v84
v_mfma_f32_16x16x32_bf16 v[204:207], v[236:239], v[64:67], 0
v_permlane32_swap_b32 v130, v88
v_permlane32_swap_b32 v131, v92
v_mfma_f32_16x16x32_bf16 v[208:211], v[240:243], v[72:75], 0
v_max_f32 v80, v80, v128
v_max_f32 v84, v84, v129
v_mfma_f32_16x16x32_bf16 v[212:215], v[244:247], v[72:75], 0
v_max_f32 v88, v88, v130
v_max_f32 v92, v92, v131
v_rcp_f32 v128, v156
v_rcp_f32 v130, v164
v_rcp_f32 v132, v172
v_rcp_f32 v134, v180
v_sub_f32 v83, 0, v80
v_sub_f32 v82, 0, v80
v_sub_f32 v81, 0, v80
v_sub_f32 v80, 0, v80
v_min_f32 v103, s8, v80
v_cndmask_b32 v96, v103, v80, s[36:37]
v_cndmask_b32 v97, v103, v80, s[38:39]
v_cndmask_b32 v98, v103, v80, s[40:41]
v_cndmask_b32 v99, v103, v80, s[42:43]
v_cndmask_b32 v100, v9, v103, s[36:37]
v_cndmask_b32 v101, v9, v103, s[38:39]
v_cndmask_b32 v102, v9, v103, s[40:41]
v_cndmask_b32 v103, v9, v103, s[42:43]
v_pk_mul_f32 v[184:185], v[184:185], v[128:129] op_sel_hi:[1,0]
v_pk_mul_f32 v[186:187], v[186:187], v[128:129] op_sel_hi:[1,0]
v_pk_mul_f32 v[188:189], v[188:189], v[128:129] op_sel_hi:[1,0]
v_pk_mul_f32 v[190:191], v[190:191], v[128:129] op_sel_hi:[1,0]
v_pk_mul_f32 v[192:193], v[192:193], v[130:131] op_sel_hi:[1,0]
v_pk_mul_f32 v[194:195], v[194:195], v[130:131] op_sel_hi:[1,0]
v_pk_mul_f32 v[196:197], v[196:197], v[130:131] op_sel_hi:[1,0]
v_pk_mul_f32 v[198:199], v[198:199], v[130:131] op_sel_hi:[1,0]
v_pk_mul_f32 v[200:201], v[200:201], v[132:133] op_sel_hi:[1,0]
v_pk_mul_f32 v[202:203], v[202:203], v[132:133] op_sel_hi:[1,0]
v_pk_mul_f32 v[204:205], v[204:205], v[132:133] op_sel_hi:[1,0]
v_pk_mul_f32 v[206:207], v[206:207], v[132:133] op_sel_hi:[1,0]
v_pk_mul_f32 v[208:209], v[208:209], v[134:135] op_sel_hi:[1,0]
v_pk_mul_f32 v[210:211], v[210:211], v[134:135] op_sel_hi:[1,0]
v_pk_mul_f32 v[212:213], v[212:213], v[134:135] op_sel_hi:[1,0]
v_pk_mul_f32 v[214:215], v[214:215], v[134:135] op_sel_hi:[1,0]
v_cvt_pk_bf16_f32 v32, v184, v185
v_cvt_pk_bf16_f32 v33, v186, v187
v_cvt_pk_bf16_f32 v34, v188, v189
v_cvt_pk_bf16_f32 v35, v190, v191
v_cvt_pk_bf16_f32 v36, v192, v193
v_cvt_pk_bf16_f32 v37, v194, v195
v_cvt_pk_bf16_f32 v38, v196, v197
v_cvt_pk_bf16_f32 v39, v198, v199
v_cvt_pk_bf16_f32 v40, v200, v201
v_cvt_pk_bf16_f32 v41, v202, v203
v_cvt_pk_bf16_f32 v42, v204, v205
v_cvt_pk_bf16_f32 v43, v206, v207
v_cvt_pk_bf16_f32 v44, v208, v209
v_cvt_pk_bf16_f32 v45, v210, v211
v_cvt_pk_bf16_f32 v46, v212, v213
v_cvt_pk_bf16_f32 v47, v214, v215
buffer_store_dwordx4 v[32:35], v3, s[88:91], s44 offen sc1
v_sub_f32 v87, 0, v84
v_sub_f32 v86, 0, v84
v_sub_f32 v85, 0, v84
v_sub_f32 v84, 0, v84
v_min_f32 v111, s9, v84
v_cndmask_b32 v104, v111, v84, s[36:37]
v_cndmask_b32 v105, v111, v84, s[38:39]
v_cndmask_b32 v106, v111, v84, s[40:41]
v_cndmask_b32 v107, v111, v84, s[42:43]
v_cndmask_b32 v108, v9, v111, s[36:37]
v_cndmask_b32 v109, v9, v111, s[38:39]
v_cndmask_b32 v110, v9, v111, s[40:41]
v_cndmask_b32 v111, v9, v111, s[42:43]
v_sub_f32 v91, 0, v88
v_sub_f32 v90, 0, v88
v_sub_f32 v89, 0, v88
v_sub_f32 v88, 0, v88
v_min_f32 v119, s8, v88
v_cndmask_b32 v112, v119, v88, s[36:37]
v_cndmask_b32 v113, v119, v88, s[38:39]
v_cndmask_b32 v114, v119, v88, s[40:41]
v_cndmask_b32 v115, v119, v88, s[42:43]
v_cndmask_b32 v116, v9, v119, s[36:37]
buffer_store_dwordx4 v[36:39], v3, s[88:91], s45 offen sc1
v_cndmask_b32 v117, v9, v119, s[38:39]
v_cndmask_b32 v118, v9, v119, s[40:41]
v_cndmask_b32 v119, v9, v119, s[42:43]
v_sub_f32 v95, 0, v92
v_sub_f32 v94, 0, v92
v_sub_f32 v93, 0, v92
v_sub_f32 v92, 0, v92
v_min_f32 v127, s9, v92
v_cndmask_b32 v120, v127, v92, s[36:37]
v_cndmask_b32 v121, v127, v92, s[38:39]
v_cndmask_b32 v122, v127, v92, s[40:41]
v_cndmask_b32 v123, v127, v92, s[42:43]
v_cndmask_b32 v124, v9, v127, s[36:37]
v_cndmask_b32 v125, v9, v127, s[38:39]
v_cndmask_b32 v126, v9, v127, s[40:41]
v_cndmask_b32 v127, v9, v127, s[42:43]
v_and_b32 v9, 1, v0
v_mul_u32_u24 v9, 0xaaaa, v9
v_add_u32 v9, 0x4444, v9
v_mov_b64 v[128:129], 0
v_mov_b64 v[130:131], 0
v_mov_b64 v[132:133], 0
v_mov_b64 v[134:135], 0
v_mov_b64 v[136:137], 0
buffer_store_dwordx4 v[40:43], v3, s[88:91], s46 offen sc1
v_mov_b64 v[138:139], 0
v_mov_b64 v[152:153], 0
v_mov_b64 v[154:155], 0
v_mov_b64 v[156:157], 0
v_mov_b64 v[158:159], 0
v_mov_b64 v[160:161], 0
v_mov_b64 v[162:163], 0
v_mov_b64 v[164:165], 0
v_mov_b64 v[166:167], 0
v_mov_b64 v[168:169], 0
v_mov_b64 v[170:171], 0
v_mov_b64 v[172:173], 0
v_mov_b64 v[174:175], 0
v_mov_b64 v[176:177], 0
v_mov_b64 v[178:179], 0
v_mov_b64 v[180:181], 0
v_mov_b64 v[182:183], 0
v_mov_b64 v[184:185], 0
v_mov_b64 v[186:187], 0
v_mov_b64 v[188:189], 0
v_mov_b64 v[190:191], 0
v_mov_b64 v[192:193], 0
v_mov_b64 v[194:195], 0
buffer_store_dwordx4 v[44:47], v3, s[88:91], s47 offen sc1
v_mov_b64 v[196:197], 0
v_mov_b64 v[198:199], 0
v_mov_b64 v[200:201], 0
v_mov_b64 v[202:203], 0
v_mov_b64 v[204:205], 0
v_mov_b64 v[206:207], 0
v_mov_b64 v[208:209], 0
v_mov_b64 v[210:211], 0
v_mov_b64 v[212:213], 0
v_mov_b64 v[214:215], 0
v_mov_b64 v[216:217], 0
v_mov_b64 v[218:219], 0
v_mov_b64 v[220:221], 0
v_mov_b64 v[222:223], 0
v_mov_b64 v[224:225], 0
v_mov_b64 v[226:227], 0
v_mov_b64 v[228:229], 0
v_mov_b64 v[230:231], 0
v_mov_b64 v[232:233], 0
v_mov_b64 v[234:235], 0
v_mov_b64 v[236:237], 0
v_mov_b64 v[238:239], 0
v_mov_b64 v[252:253], 0
v_mov_b64 v[254:255], 0
L_att_start:
s_mov_b32 s15, s6
s_cmp_eq_u32 s6, 0
s_cbranch_scc1 L_att_j0
v_mfma_f32_16x16x32_bf16 v[16:19], a[0:3], a[160:163], v[80:83]
ds_read_b128 a[128:131], v1 offset:24576
v_mov_b32 v240, 0
v_mfma_f32_16x16x32_bf16 v[16:19], a[4:7], a[164:167], v[16:19]
ds_read_b128 a[132:135], v1 offset:25600
v_mov_b32 v241, 0
v_mfma_f32_16x16x32_bf16 v[16:19], a[8:11], a[168:171], v[16:19]
ds_read_b128 a[136:139], v1 offset:26624
s_add_u32 m0, s27, 0x0
v_mfma_f32_16x16x32_bf16 v[16:19], a[12:15], a[172:175], v[16:19]
buffer_load_dwordx4 v3, s[48:51], s32 offen offset:0 sc1 lds
v_mfma_f32_16x16x32_bf16 v[20:23], a[0:3], a[176:179], v[84:87]
ds_read_b128 a[140:143], v1 offset:27648
v_mov_b32 v242, 0
v_mfma_f32_16x16x32_bf16 v[20:23], a[4:7], a[180:183], v[20:23]
ds_read_b128 a[144:147], v1 offset:28672
v_mov_b32 v243, 0
v_mfma_f32_16x16x32_bf16 v[20:23], a[8:11], a[184:187], v[20:23]
ds_read_b128 a[148:151], v1 offset:29696
v_mov_b32 v244, 0
v_mfma_f32_16x16x32_bf16 v[20:23], a[12:15], a[188:191], v[20:23]
ds_read_b128 a[152:155], v1 offset:30720
v_mov_b32 v245, 0
v_mfma_f32_16x16x32_bf16 v[24:27], a[0:3], a[192:195], v[88:91]
ds_read_b128 a[156:159], v1 offset:31744
v_exp_f32 v16, v16
v_mfma_f32_16x16x32_bf16 v[24:27], a[4:7], a[196:199], v[24:27]
v_exp_f32 v17, v17
v_mfma_f32_16x16x32_bf16 v[24:27], a[8:11], a[200:203], v[24:27]
buffer_load_dwordx4 v3, s[48:51], s32 offen offset:1024 sc1 lds
v_mfma_f32_16x16x32_bf16 v[24:27], a[12:15], a[204:207], v[24:27]
v_exp_f32 v18, v18
v_mfma_f32_16x16x32_bf16 v[28:31], a[0:3], a[208:211], v[92:95]
v_exp_f32 v19, v19
v_mfma_f32_16x16x32_bf16 v[28:31], a[4:7], a[212:215], v[28:31]
v_exp_f32 v20, v20
v_mfma_f32_16x16x32_bf16 v[28:31], a[8:11], a[216:219], v[28:31]
v_cvt_pk_bf16_f32 v48, v16, v17
v_cvt_pk_bf16_f32 v49, v18, v19
v_mfma_f32_16x16x32_bf16 v[28:31], a[12:15], a[220:223], v[28:31]
v_exp_f32 v21, v21
v_mfma_f32_16x16x32_bf16 v[32:35], a[16:19], a[160:163], v[80:83]
v_exp_f32 v22, v22
v_mfma_f32_16x16x32_bf16 v[32:35], a[20:23], a[164:167], v[32:35]
v_exp_f32 v23, v23
v_mfma_f32_16x16x32_bf16 v[32:35], a[24:27], a[168:171], v[32:35]
buffer_load_dwordx4 v3, s[48:51], s32 offen offset:2048 sc1 lds
v_mfma_f32_16x16x32_bf16 v[32:35], a[28:31], a[172:175], v[32:35]
v_exp_f32 v24, v24
v_mfma_f32_16x16x32_bf16 v[36:39], a[16:19], a[176:179], v[84:87]
v_exp_f32 v25, v25
v_mfma_f32_16x16x32_bf16 v[36:39], a[20:23], a[180:183], v[36:39]
v_cvt_pk_bf16_f32 v52, v20, v21
v_cvt_pk_bf16_f32 v53, v22, v23
v_mfma_f32_16x16x32_bf16 v[36:39], a[24:27], a[184:187], v[36:39]
v_exp_f32 v26, v26
v_mfma_f32_16x16x32_bf16 v[36:39], a[28:31], a[188:191], v[36:39]
v_exp_f32 v27, v27
v_mfma_f32_16x16x32_bf16 v[40:43], a[16:19], a[192:195], v[88:91]
v_exp_f32 v28, v28
v_mfma_f32_16x16x32_bf16 v[40:43], a[20:23], a[196:199], v[40:43]
buffer_load_dwordx4 v3, s[48:51], s32 offen offset:3072 sc1 lds
v_mfma_f32_16x16x32_bf16 v[40:43], a[24:27], a[200:203], v[40:43]
s_add_u32 s32, s32, 0x8000
v_exp_f32 v29, v29
v_mfma_f32_16x16x32_bf16 v[40:43], a[28:31], a[204:207], v[40:43]
v_exp_f32 v30, v30
v_mfma_f32_16x16x32_bf16 v[44:47], a[16:19], a[208:211], v[92:95]
v_exp_f32 v31, v31
v_mfma_f32_16x16x32_bf16 v[44:47], a[20:23], a[212:215], v[44:47]
v_exp_f32 v32, v32
v_mfma_f32_16x16x32_bf16 v[44:47], a[24:27], a[216:219], v[44:47]
v_exp_f32 v33, v33
v_mfma_f32_16x16x32_bf16 v[44:47], a[28:31], a[220:223], v[44:47]
s_waitcnt lgkmcnt(0)
v_cvt_pk_bf16_f32 v56, v24, v25
v_cvt_pk_bf16_f32 v57, v26, v27
v_mov_b32 v246, 0
v_mov_b32 v247, 0
v_mfma_f32_16x16x32_bf16 v[16:19], a[128:131], a[160:163], v[80:83]
ds_read_b128 a[32:35], v1 offset:16384
v_cvt_pk_bf16_f32 v60, v28, v29
v_mfma_f32_16x16x32_bf16 v[16:19], a[132:135], a[164:167], v[16:19]
v_exp_f32 v34, v34
v_mfma_f32_16x16x32_bf16 v[16:19], a[136:139], a[168:171], v[16:19]
s_add_u32 m0, s27, 0x1000
v_exp_f32 v35, v35
v_mfma_f32_16x16x32_bf16 v[16:19], a[140:143], a[172:175], v[16:19]
buffer_load_dwordx4 v3, s[48:51], s7 offen offset:0 sc1 lds
v_mfma_f32_16x16x32_bf16 v[20:23], a[128:131], a[176:179], v[84:87]
ds_read_b128 a[36:39], v1 offset:17408
v_cvt_pk_bf16_f32 v61, v30, v31
v_mfma_f32_16x16x32_bf16 v[20:23], a[132:135], a[180:183], v[20:23]
v_exp_f32 v36, v36
v_mfma_f32_16x16x32_bf16 v[20:23], a[136:139], a[184:187], v[20:23]
ds_read_b128 a[40:43], v1 offset:18432
v_cvt_pk_bf16_f32 v50, v32, v33
v_mfma_f32_16x16x32_bf16 v[20:23], a[140:143], a[188:191], v[20:23]
v_exp_f32 v37, v37
v_mfma_f32_16x16x32_bf16 v[24:27], a[128:131], a[192:195], v[88:91]
v_exp_f32 v38, v38
v_mfma_f32_16x16x32_bf16 v[24:27], a[132:135], a[196:199], v[24:27]
ds_read_b128 a[44:47], v1 offset:19456
v_cvt_pk_bf16_f32 v51, v34, v35
v_mfma_f32_16x16x32_bf16 v[24:27], a[136:139], a[200:203], v[24:27]
buffer_load_dwordx4 v3, s[48:51], s7 offen offset:1024 sc1 lds
v_mfma_f32_16x16x32_bf16 v[24:27], a[140:143], a[204:207], v[24:27]
v_exp_f32 v39, v39
v_mfma_f32_16x16x32_bf16 v[28:31], a[128:131], a[208:211], v[92:95]
v_exp_f32 v40, v40
v_mfma_f32_16x16x32_bf16 v[28:31], a[132:135], a[212:215], v[28:31]
ds_read_b128 a[48:51], v1 offset:20480
v_cvt_pk_bf16_f32 v54, v36, v37
v_mfma_f32_16x16x32_bf16 v[28:31], a[136:139], a[216:219], v[28:31]
v_exp_f32 v41, v41
v_mfma_f32_16x16x32_bf16 v[28:31], a[140:143], a[220:223], v[28:31]
v_exp_f32 v42, v42
v_mfma_f32_16x16x32_bf16 v[32:35], a[144:147], a[160:163], v[80:83]
buffer_load_dwordx4 v3, s[48:51], s7 offen offset:2048 sc1 lds
v_mfma_f32_16x16x32_bf16 v[32:35], a[148:151], a[164:167], v[32:35]
ds_read_b128 a[52:55], v1 offset:21504
v_cvt_pk_bf16_f32 v55, v38, v39
v_mfma_f32_16x16x32_bf16 v[32:35], a[152:155], a[168:171], v[32:35]
v_exp_f32 v43, v43
v_mfma_f32_16x16x32_bf16 v[32:35], a[156:159], a[172:175], v[32:35]
ds_read_b128 a[56:59], v1 offset:22528
v_cvt_pk_bf16_f32 v58, v40, v41
v_mfma_f32_16x16x32_bf16 v[36:39], a[144:147], a[176:179], v[84:87]
v_exp_f32 v44, v44
v_mfma_f32_16x16x32_bf16 v[36:39], a[148:151], a[180:183], v[36:39]
v_exp_f32 v45, v45
v_mfma_f32_16x16x32_bf16 v[36:39], a[152:155], a[184:187], v[36:39]
ds_read_b128 a[60:63], v1 offset:23552
v_xor_b32 v1, 0x8000, v1
v_mfma_f32_16x16x32_bf16 v[36:39], a[156:159], a[188:191], v[36:39]
buffer_load_dwordx4 v3, s[48:51], s7 offen offset:3072 sc1 lds
v_cvt_pk_bf16_f32 v59, v42, v43
v_mfma_f32_16x16x32_bf16 v[40:43], a[144:147], a[192:195], v[88:91]
s_add_u32 s7, s7, 0x8000
v_exp_f32 v46, v46
v_mfma_f32_16x16x32_bf16 v[40:43], a[148:151], a[196:199], v[40:43]
s_xor_b32 s27, s27, 0x38000
v_exp_f32 v47, v47
v_mfma_f32_16x16x32_bf16 v[40:43], a[152:155], a[200:203], v[40:43]
v_exp_f32 v16, v16
v_mfma_f32_16x16x32_bf16 v[40:43], a[156:159], a[204:207], v[40:43]
v_exp_f32 v17, v17
v_cvt_pk_bf16_f32 v62, v44, v45
v_cvt_pk_bf16_f32 v63, v46, v47
v_mfma_f32_16x16x32_bf16 v[44:47], a[144:147], a[208:211], v[92:95]
v_exp_f32 v18, v18
v_mfma_f32_16x16x32_bf16 v[44:47], a[148:151], a[212:215], v[44:47]
v_exp_f32 v19, v19
v_mfma_f32_16x16x32_bf16 v[44:47], a[152:155], a[216:219], v[44:47]
s_waitcnt vmcnt(8) lgkmcnt(0)
v_exp_f32 v20, v20
v_mfma_f32_16x16x32_bf16 v[44:47], a[156:159], a[220:223], v[44:47]
s_barrier
v_cvt_pk_bf16_f32 v64, v16, v17
v_exp_f32 v21, v21
v_exp_f32 v22, v22
v_exp_f32 v23, v23
v_exp_f32 v24, v24
v_exp_f32 v25, v25
v_exp_f32 v26, v26
v_exp_f32 v27, v27
v_cvt_pk_bf16_f32 v65, v18, v19
v_cvt_pk_bf16_f32 v68, v20, v21
v_cvt_pk_bf16_f32 v69, v22, v23
s_cmp_lg_u32 s33, 0
s_cbranch_scc1 L_sig_bd
s_lshl_b32 s8, s6, 2
s_add_u32 s8, s8, 192
s_cmp_lg_u32 s4, 0
s_cbranch_scc1 L_sig_bd
v_mov_b32 v4, 1
s_mov_b64 exec, 1
buffer_atomic_add v4, off, s[84:87], s8 sc1
s_mov_b64 exec, -1
L_sig_bd:
s_getreg_b32 s8, hwreg(HW_REG_HW_ID, 5, 1)
s_cmp_lg_u32 s8, 0
s_cbranch_scc1 L_att_dodd1
s_branch L_att_dodd0
L_att_deven0:
v_mfma_f32_16x16x32_bf16 v[128:131], a[32:35], v[48:51], v[128:131]
ds_read_b128 a[0:3], v1 offset:8192
v_cvt_pk_bf16_f32 v72, v24, v25
v_mfma_f32_16x16x32_bf16 v[160:163], a[32:35], v[52:55], v[160:163]
v_exp_f32 v28, v28
v_mfma_f32_16x16x32_bf16 v[192:195], a[32:35], v[56:59], v[192:195]
v_cvt_pk_bf16_f32 v73, v26, v27
v_mfma_f32_16x16x32_bf16 v[224:227], a[32:35], v[60:63], v[224:227]
ds_read_b128 a[4:7], v1 offset:9216
v_mfma_f32_16x16x32_bf16 v[228:231], a[36:39], v[60:63], v[228:231]
v_exp_f32 v29, v29
v_mfma_f32_16x16x32_bf16 v[196:199], a[36:39], v[56:59], v[196:199]
v_exp_f32 v30, v30
v_mfma_f32_16x16x32_bf16 v[164:167], a[36:39], v[52:55], v[164:167]
s_add_u32 m0, s27, 0x0
v_cvt_pk_bf16_f32 v76, v28, v29
v_mfma_f32_16x16x32_bf16 v[132:135], a[36:39], v[48:51], v[132:135]
buffer_load_dwordx4 v3, s[48:51], s32 offen offset:0 sc1 lds
v_mfma_f32_16x16x32_bf16 v[136:139], a[40:43], v[48:51], v[136:139]
ds_read_b128 a[8:11], v1 offset:10240
v_mfma_f32_16x16x32_bf16 v[168:171], a[40:43], v[52:55], v[168:171]
v_exp_f32 v31, v31
v_mfma_f32_16x16x32_bf16 v[200:203], a[40:43], v[56:59], v[200:203]
v_exp_f32 v32, v32
v_mfma_f32_16x16x32_bf16 v[232:235], a[40:43], v[60:63], v[232:235]
ds_read_b128 a[12:15], v1 offset:11264
v_cvt_pk_bf16_f32 v77, v30, v31
v_mfma_f32_16x16x32_bf16 v[236:239], a[44:47], v[60:63], v[236:239]
v_mfma_f32_16x16x32_bf16 v[204:207], a[44:47], v[56:59], v[204:207]
v_exp_f32 v33, v33
v_mfma_f32_16x16x32_bf16 v[172:175], a[44:47], v[52:55], v[172:175]
v_exp_f32 v34, v34
v_mfma_f32_16x16x32_bf16 v[140:143], a[44:47], v[48:51], v[140:143]
ds_read_b128 a[16:19], v1 offset:12288
v_cvt_pk_bf16_f32 v66, v32, v33
v_mfma_f32_16x16x32_bf16 v[144:147], a[48:51], v[48:51], v[144:147]
v_mfma_f32_16x16x32_bf16 v[176:179], a[48:51], v[52:55], v[176:179]
v_exp_f32 v35, v35
v_mfma_f32_16x16x32_bf16 v[208:211], a[48:51], v[56:59], v[208:211]
v_exp_f32 v36, v36
v_mfma_f32_16x16x32_bf16 v[240:243], a[48:51], v[60:63], v[240:243]
ds_read_b128 a[20:23], v1 offset:13312
v_cvt_pk_bf16_f32 v67, v34, v35
v_mfma_f32_16x16x32_bf16 v[244:247], a[52:55], v[60:63], v[244:247]
v_exp_f32 v37, v37
v_mfma_f32_16x16x32_bf16 v[212:215], a[52:55], v[56:59], v[212:215]
v_cvt_pk_bf16_f32 v70, v36, v37
v_mfma_f32_16x16x32_bf16 v[180:183], a[52:55], v[52:55], v[180:183]
ds_read_b128 a[24:27], v1 offset:14336
v_mfma_f32_16x16x32_bf16 v[148:151], a[52:55], v[48:51], v[148:151]
buffer_load_dwordx4 v3, s[48:51], s32 offen offset:1024 sc1 lds
v_mfma_f32_16x16x32_bf16 v[152:155], a[56:59], v[48:51], v[152:155]
v_exp_f32 v38, v38
v_mfma_f32_16x16x32_bf16 v[184:187], a[56:59], v[52:55], v[184:187]
v_exp_f32 v39, v39
v_mfma_f32_16x16x32_bf16 v[216:219], a[56:59], v[56:59], v[216:219]
ds_read_b128 a[28:31], v1 offset:15360
v_cvt_pk_bf16_f32 v71, v38, v39
v_mfma_f32_16x16x32_bf16 v[248:251], a[56:59], v[60:63], v[248:251]
v_mfma_f32_16x16x32_bf16 v[252:255], a[60:63], v[60:63], v[252:255]
v_exp_f32 v40, v40
v_mfma_f32_16x16x32_bf16 v[220:223], a[60:63], v[56:59], v[220:223]
v_exp_f32 v41, v41
v_mfma_f32_16x16x32_bf16 v[188:191], a[60:63], v[52:55], v[188:191]
ds_read_b128 a[32:35], v1 offset:0
v_cvt_pk_bf16_f32 v74, v40, v41
v_mfma_f32_16x16x32_bf16 v[156:159], a[60:63], v[48:51], v[156:159]
v_smfmac_f32_16x16x64_bf16 a[224:227], a[232:235], v[48:55], v9
v_exp_f32 v42, v42
v_smfmac_f32_16x16x64_bf16 a[228:231], a[232:235], v[56:63], v9
s_waitcnt lgkmcnt(5)
v_exp_f32 v43, v43
v_mfma_f32_16x16x32_bf16 v[16:19], a[0:3], a[160:163], v[80:83]
ds_read_b128 a[36:39], v1 offset:1024
v_cvt_pk_bf16_f32 v75, v42, v43
v_mfma_f32_16x16x32_bf16 v[16:19], a[4:7], a[164:167], v[16:19]
v_exp_f32 v44, v44
v_mfma_f32_16x16x32_bf16 v[16:19], a[8:11], a[168:171], v[16:19]
v_mfma_f32_16x16x32_bf16 v[16:19], a[12:15], a[172:175], v[16:19]
v_exp_f32 v45, v45
v_mfma_f32_16x16x32_bf16 v[20:23], a[0:3], a[176:179], v[84:87]
ds_read_b128 a[40:43], v1 offset:2048
v_cvt_pk_bf16_f32 v78, v44, v45
v_mfma_f32_16x16x32_bf16 v[20:23], a[4:7], a[180:183], v[20:23]
buffer_load_dwordx4 v3, s[48:51], s32 offen offset:2048 sc1 lds
v_mfma_f32_16x16x32_bf16 v[20:23], a[8:11], a[184:187], v[20:23]
v_exp_f32 v46, v46
v_mfma_f32_16x16x32_bf16 v[20:23], a[12:15], a[188:191], v[20:23]
ds_read_b128 a[44:47], v1 offset:3072
v_mfma_f32_16x16x32_bf16 v[24:27], a[0:3], a[192:195], v[88:91]
v_mfma_f32_16x16x32_bf16 v[24:27], a[4:7], a[196:199], v[24:27]
v_exp_f32 v47, v47
v_mfma_f32_16x16x32_bf16 v[24:27], a[8:11], a[200:203], v[24:27]
v_exp_f32 v16, v16
v_mfma_f32_16x16x32_bf16 v[24:27], a[12:15], a[204:207], v[24:27]
ds_read_b128 a[48:51], v1 offset:4096
v_cvt_pk_bf16_f32 v79, v46, v47
v_mfma_f32_16x16x32_bf16 v[28:31], a[0:3], a[208:211], v[92:95]
v_mfma_f32_16x16x32_bf16 v[28:31], a[4:7], a[212:215], v[28:31]
v_exp_f32 v17, v17
v_mfma_f32_16x16x32_bf16 v[28:31], a[8:11], a[216:219], v[28:31]
s_waitcnt lgkmcnt(5)
v_exp_f32 v18, v18
v_mfma_f32_16x16x32_bf16 v[28:31], a[12:15], a[220:223], v[28:31]
ds_read_b128 a[52:55], v1 offset:5120
v_cvt_pk_bf16_f32 v48, v16, v17
v_mfma_f32_16x16x32_bf16 v[32:35], a[16:19], a[160:163], v[80:83]
v_mfma_f32_16x16x32_bf16 v[32:35], a[20:23], a[164:167], v[32:35]
v_exp_f32 v19, v19
v_mfma_f32_16x16x32_bf16 v[32:35], a[24:27], a[168:171], v[32:35]
v_exp_f32 v20, v20
v_mfma_f32_16x16x32_bf16 v[32:35], a[28:31], a[172:175], v[32:35]
ds_read_b128 a[56:59], v1 offset:6144
v_cvt_pk_bf16_f32 v49, v18, v19
v_mfma_f32_16x16x32_bf16 v[36:39], a[16:19], a[176:179], v[84:87]
v_exp_f32 v21, v21
v_mfma_f32_16x16x32_bf16 v[36:39], a[20:23], a[180:183], v[36:39]
buffer_load_dwordx4 v3, s[48:51], s32 offen offset:3072 sc1 lds
v_mfma_f32_16x16x32_bf16 v[36:39], a[24:27], a[184:187], v[36:39]
s_add_u32 s32, s32, 0x8000
v_cvt_pk_bf16_f32 v52, v20, v21
v_mfma_f32_16x16x32_bf16 v[36:39], a[28:31], a[188:191], v[36:39]
ds_read_b128 a[60:63], v1 offset:7168
v_mfma_f32_16x16x32_bf16 v[40:43], a[16:19], a[192:195], v[88:91]
v_exp_f32 v22, v22
v_mfma_f32_16x16x32_bf16 v[40:43], a[20:23], a[196:199], v[40:43]
v_exp_f32 v23, v23
v_mfma_f32_16x16x32_bf16 v[40:43], a[24:27], a[200:203], v[40:43]
v_cvt_pk_bf16_f32 v53, v22, v23
v_mfma_f32_16x16x32_bf16 v[40:43], a[28:31], a[204:207], v[40:43]
v_exp_f32 v24, v24
v_mfma_f32_16x16x32_bf16 v[44:47], a[16:19], a[208:211], v[92:95]
v_exp_f32 v25, v25
v_mfma_f32_16x16x32_bf16 v[44:47], a[20:23], a[212:215], v[44:47]
v_exp_f32 v26, v26
v_mfma_f32_16x16x32_bf16 v[44:47], a[24:27], a[216:219], v[44:47]
v_exp_f32 v27, v27
v_mfma_f32_16x16x32_bf16 v[44:47], a[28:31], a[220:223], v[44:47]
s_waitcnt lgkmcnt(0)
v_mfma_f32_16x16x32_bf16 v[128:131], a[32:35], v[64:67], v[128:131]
ds_read_b128 a[0:3], v1 offset:24576
v_cvt_pk_bf16_f32 v56, v24, v25
v_mfma_f32_16x16x32_bf16 v[160:163], a[32:35], v[68:71], v[160:163]
v_exp_f32 v28, v28
v_mfma_f32_16x16x32_bf16 v[192:195], a[32:35], v[72:75], v[192:195]
v_cvt_pk_bf16_f32 v57, v26, v27
v_mfma_f32_16x16x32_bf16 v[224:227], a[32:35], v[76:79], v[224:227]
ds_read_b128 a[4:7], v1 offset:25600
v_mfma_f32_16x16x32_bf16 v[228:231], a[36:39], v[76:79], v[228:231]
v_exp_f32 v29, v29
v_mfma_f32_16x16x32_bf16 v[196:199], a[36:39], v[72:75], v[196:199]
v_exp_f32 v30, v30
v_mfma_f32_16x16x32_bf16 v[164:167], a[36:39], v[68:71], v[164:167]
s_add_u32 m0, s27, 0x1000
v_cvt_pk_bf16_f32 v60, v28, v29
v_mfma_f32_16x16x32_bf16 v[132:135], a[36:39], v[64:67], v[132:135]
buffer_load_dwordx4 v3, s[48:51], s7 offen offset:0 sc1 lds
v_mfma_f32_16x16x32_bf16 v[136:139], a[40:43], v[64:67], v[136:139]
ds_read_b128 a[8:11], v1 offset:26624
v_mfma_f32_16x16x32_bf16 v[168:171], a[40:43], v[68:71], v[168:171]
v_exp_f32 v31, v31
v_mfma_f32_16x16x32_bf16 v[200:203], a[40:43], v[72:75], v[200:203]
v_exp_f32 v32, v32
v_mfma_f32_16x16x32_bf16 v[232:235], a[40:43], v[76:79], v[232:235]
ds_read_b128 a[12:15], v1 offset:27648
v_cvt_pk_bf16_f32 v61, v30, v31
v_mfma_f32_16x16x32_bf16 v[236:239], a[44:47], v[76:79], v[236:239]
v_mfma_f32_16x16x32_bf16 v[204:207], a[44:47], v[72:75], v[204:207]
v_exp_f32 v33, v33
v_mfma_f32_16x16x32_bf16 v[172:175], a[44:47], v[68:71], v[172:175]
v_exp_f32 v34, v34
v_mfma_f32_16x16x32_bf16 v[140:143], a[44:47], v[64:67], v[140:143]
ds_read_b128 a[16:19], v1 offset:28672
v_cvt_pk_bf16_f32 v50, v32, v33
v_mfma_f32_16x16x32_bf16 v[144:147], a[48:51], v[64:67], v[144:147]
v_mfma_f32_16x16x32_bf16 v[176:179], a[48:51], v[68:71], v[176:179]
v_exp_f32 v35, v35
v_mfma_f32_16x16x32_bf16 v[208:211], a[48:51], v[72:75], v[208:211]
ds_read_b128 a[20:23], v1 offset:29696
v_cvt_pk_bf16_f32 v51, v34, v35
v_mfma_f32_16x16x32_bf16 v[240:243], a[48:51], v[76:79], v[240:243]
v_exp_f32 v36, v36
v_mfma_f32_16x16x32_bf16 v[244:247], a[52:55], v[76:79], v[244:247]
v_exp_f32 v37, v37
v_mfma_f32_16x16x32_bf16 v[212:215], a[52:55], v[72:75], v[212:215]
v_cvt_pk_bf16_f32 v54, v36, v37
v_mfma_f32_16x16x32_bf16 v[180:183], a[52:55], v[68:71], v[180:183]
buffer_load_dwordx4 v3, s[48:51], s7 offen offset:1024 sc1 lds
v_mfma_f32_16x16x32_bf16 v[148:151], a[52:55], v[64:67], v[148:151]
ds_read_b128 a[24:27], v1 offset:30720
v_mfma_f32_16x16x32_bf16 v[152:155], a[56:59], v[64:67], v[152:155]
v_exp_f32 v38, v38
v_mfma_f32_16x16x32_bf16 v[184:187], a[56:59], v[68:71], v[184:187]
v_exp_f32 v39, v39
v_mfma_f32_16x16x32_bf16 v[216:219], a[56:59], v[72:75], v[216:219]
ds_read_b128 a[28:31], v1 offset:31744
v_cvt_pk_bf16_f32 v55, v38, v39
v_mfma_f32_16x16x32_bf16 v[248:251], a[56:59], v[76:79], v[248:251]
v_mfma_f32_16x16x32_bf16 v[252:255], a[60:63], v[76:79], v[252:255]
v_exp_f32 v40, v40
v_mfma_f32_16x16x32_bf16 v[220:223], a[60:63], v[72:75], v[220:223]
v_exp_f32 v41, v41
v_mfma_f32_16x16x32_bf16 v[188:191], a[60:63], v[68:71], v[188:191]
ds_read_b128 a[32:35], v1 offset:16384
v_cvt_pk_bf16_f32 v58, v40, v41
v_mfma_f32_16x16x32_bf16 v[156:159], a[60:63], v[64:67], v[156:159]
v_smfmac_f32_16x16x64_bf16 a[224:227], a[232:235], v[64:71], v9
s_waitcnt lgkmcnt(5)
v_exp_f32 v42, v42
v_smfmac_f32_16x16x64_bf16 a[228:231], a[232:235], v[72:79], v9
ds_read_b128 a[36:39], v1 offset:17408
v_mfma_f32_16x16x32_bf16 v[16:19], a[0:3], a[160:163], v[80:83]
v_exp_f32 v43, v43
v_mfma_f32_16x16x32_bf16 v[16:19], a[4:7], a[164:167], v[16:19]
v_exp_f32 v44, v44
v_mfma_f32_16x16x32_bf16 v[16:19], a[8:11], a[168:171], v[16:19]
v_cvt_pk_bf16_f32 v59, v42, v43
v_mfma_f32_16x16x32_bf16 v[16:19], a[12:15], a[172:175], v[16:19]
ds_read_b128 a[40:43], v1 offset:18432
v_mfma_f32_16x16x32_bf16 v[20:23], a[0:3], a[176:179], v[84:87]
buffer_load_dwordx4 v3, s[48:51], s7 offen offset:2048 sc1 lds
v_mfma_f32_16x16x32_bf16 v[20:23], a[4:7], a[180:183], v[20:23]
v_exp_f32 v45, v45
v_mfma_f32_16x16x32_bf16 v[20:23], a[8:11], a[184:187], v[20:23]
v_exp_f32 v46, v46
v_mfma_f32_16x16x32_bf16 v[20:23], a[12:15], a[188:191], v[20:23]
ds_read_b128 a[44:47], v1 offset:19456
v_cvt_pk_bf16_f32 v62, v44, v45
v_mfma_f32_16x16x32_bf16 v[24:27], a[0:3], a[192:195], v[88:91]
v_mfma_f32_16x16x32_bf16 v[24:27], a[4:7], a[196:199], v[24:27]
v_exp_f32 v47, v47
v_mfma_f32_16x16x32_bf16 v[24:27], a[8:11], a[200:203], v[24:27]
v_exp_f32 v16, v16
v_mfma_f32_16x16x32_bf16 v[24:27], a[12:15], a[204:207], v[24:27]
ds_read_b128 a[48:51], v1 offset:20480
v_cvt_pk_bf16_f32 v63, v46, v47
v_mfma_f32_16x16x32_bf16 v[28:31], a[0:3], a[208:211], v[92:95]
v_mfma_f32_16x16x32_bf16 v[28:31], a[4:7], a[212:215], v[28:31]
v_exp_f32 v17, v17
v_mfma_f32_16x16x32_bf16 v[28:31], a[8:11], a[216:219], v[28:31]
ds_read_b128 a[52:55], v1 offset:21504
v_cvt_pk_bf16_f32 v64, v16, v17
v_mfma_f32_16x16x32_bf16 v[28:31], a[12:15], a[220:223], v[28:31]
s_waitcnt lgkmcnt(6)
v_exp_f32 v18, v18
v_mfma_f32_16x16x32_bf16 v[32:35], a[16:19], a[160:163], v[80:83]
v_mfma_f32_16x16x32_bf16 v[32:35], a[20:23], a[164:167], v[32:35]
v_exp_f32 v19, v19
v_mfma_f32_16x16x32_bf16 v[32:35], a[24:27], a[168:171], v[32:35]
ds_read_b128 a[56:59], v1 offset:22528
v_cvt_pk_bf16_f32 v65, v18, v19
v_mfma_f32_16x16x32_bf16 v[32:35], a[28:31], a[172:175], v[32:35]
buffer_load_dwordx4 v3, s[48:51], s7 offen offset:3072 sc1 lds
v_mfma_f32_16x16x32_bf16 v[36:39], a[16:19], a[176:179], v[84:87]
s_add_u32 s7, s7, 0x8000
v_exp_f32 v20, v20
v_mfma_f32_16x16x32_bf16 v[36:39], a[20:23], a[180:183], v[36:39]
s_xor_b32 s27, s27, 0x38000
v_exp_f32 v21, v21
v_mfma_f32_16x16x32_bf16 v[36:39], a[24:27], a[184:187], v[36:39]
ds_read_b128 a[60:63], v1 offset:23552
v_xor_b32 v1, 0x8000, v1
v_mfma_f32_16x16x32_bf16 v[36:39], a[28:31], a[188:191], v[36:39]
v_cvt_pk_bf16_f32 v68, v20, v21
v_mfma_f32_16x16x32_bf16 v[40:43], a[16:19], a[192:195], v[88:91]
v_exp_f32 v22, v22
v_mfma_f32_16x16x32_bf16 v[40:43], a[20:23], a[196:199], v[40:43]
v_exp_f32 v23, v23
v_mfma_f32_16x16x32_bf16 v[40:43], a[24:27], a[200:203], v[40:43]
v_cvt_pk_bf16_f32 v69, v22, v23
v_mfma_f32_16x16x32_bf16 v[40:43], a[28:31], a[204:207], v[40:43]
v_exp_f32 v24, v24
v_mfma_f32_16x16x32_bf16 v[44:47], a[16:19], a[208:211], v[92:95]
v_exp_f32 v25, v25
v_mfma_f32_16x16x32_bf16 v[44:47], a[20:23], a[212:215], v[44:47]
v_exp_f32 v26, v26
v_mfma_f32_16x16x32_bf16 v[44:47], a[24:27], a[216:219], v[44:47]
s_waitcnt vmcnt(16) lgkmcnt(0)
v_exp_f32 v27, v27
v_mfma_f32_16x16x32_bf16 v[44:47], a[28:31], a[220:223], v[44:47]
s_barrier
L_att_dodd0:
v_mfma_f32_16x16x32_bf16 v[128:131], a[32:35], v[48:51], v[128:131]
ds_read_b128 a[0:3], v2 offset:8192
v_cvt_pk_bf16_f32 v72, v24, v25
v_mfma_f32_16x16x32_bf16 v[160:163], a[32:35], v[52:55], v[160:163]
v_exp_f32 v28, v28
v_mfma_f32_16x16x32_bf16 v[192:195], a[32:35], v[56:59], v[192:195]
v_cvt_pk_bf16_f32 v73, v26, v27
v_mfma_f32_16x16x32_bf16 v[224:227], a[32:35], v[60:63], v[224:227]
ds_read_b128 a[4:7], v2 offset:9216
v_mfma_f32_16x16x32_bf16 v[228:231], a[36:39], v[60:63], v[228:231]
v_exp_f32 v29, v29
v_mfma_f32_16x16x32_bf16 v[196:199], a[36:39], v[56:59], v[196:199]
v_exp_f32 v30, v30
v_mfma_f32_16x16x32_bf16 v[164:167], a[36:39], v[52:55], v[164:167]
s_add_u32 m0, s19, 0x0
v_cvt_pk_bf16_f32 v76, v28, v29
v_mfma_f32_16x16x32_bf16 v[132:135], a[36:39], v[48:51], v[132:135]
buffer_load_dwordx4 v3, s[48:51], s32 offen offset:0 sc1 lds
v_mfma_f32_16x16x32_bf16 v[136:139], a[40:43], v[48:51], v[136:139]
ds_read_b128 a[8:11], v2 offset:10240
v_mfma_f32_16x16x32_bf16 v[168:171], a[40:43], v[52:55], v[168:171]
v_exp_f32 v31, v31
v_mfma_f32_16x16x32_bf16 v[200:203], a[40:43], v[56:59], v[200:203]
v_exp_f32 v32, v32
v_mfma_f32_16x16x32_bf16 v[232:235], a[40:43], v[60:63], v[232:235]
ds_read_b128 a[12:15], v2 offset:11264
v_cvt_pk_bf16_f32 v77, v30, v31
v_mfma_f32_16x16x32_bf16 v[236:239], a[44:47], v[60:63], v[236:239]
v_mfma_f32_16x16x32_bf16 v[204:207], a[44:47], v[56:59], v[204:207]
v_exp_f32 v33, v33
v_mfma_f32_16x16x32_bf16 v[172:175], a[44:47], v[52:55], v[172:175]
v_exp_f32 v34, v34
v_mfma_f32_16x16x32_bf16 v[140:143], a[44:47], v[48:51], v[140:143]
ds_read_b128 a[16:19], v2 offset:12288
v_cvt_pk_bf16_f32 v66, v32, v33
v_mfma_f32_16x16x32_bf16 v[144:147], a[48:51], v[48:51], v[144:147]
v_mfma_f32_16x16x32_bf16 v[176:179], a[48:51], v[52:55], v[176:179]
v_exp_f32 v35, v35
v_mfma_f32_16x16x32_bf16 v[208:211], a[48:51], v[56:59], v[208:211]
v_exp_f32 v36, v36
v_mfma_f32_16x16x32_bf16 v[240:243], a[48:51], v[60:63], v[240:243]
ds_read_b128 a[20:23], v2 offset:13312
v_cvt_pk_bf16_f32 v67, v34, v35
v_mfma_f32_16x16x32_bf16 v[244:247], a[52:55], v[60:63], v[244:247]
v_exp_f32 v37, v37
v_mfma_f32_16x16x32_bf16 v[212:215], a[52:55], v[56:59], v[212:215]
v_cvt_pk_bf16_f32 v70, v36, v37
v_mfma_f32_16x16x32_bf16 v[180:183], a[52:55], v[52:55], v[180:183]
ds_read_b128 a[24:27], v2 offset:14336
v_mfma_f32_16x16x32_bf16 v[148:151], a[52:55], v[48:51], v[148:151]
buffer_load_dwordx4 v3, s[48:51], s32 offen offset:1024 sc1 lds
v_mfma_f32_16x16x32_bf16 v[152:155], a[56:59], v[48:51], v[152:155]
v_exp_f32 v38, v38
v_mfma_f32_16x16x32_bf16 v[184:187], a[56:59], v[52:55], v[184:187]
v_exp_f32 v39, v39
v_mfma_f32_16x16x32_bf16 v[216:219], a[56:59], v[56:59], v[216:219]
ds_read_b128 a[28:31], v2 offset:15360
v_cvt_pk_bf16_f32 v71, v38, v39
v_mfma_f32_16x16x32_bf16 v[248:251], a[56:59], v[60:63], v[248:251]
v_mfma_f32_16x16x32_bf16 v[252:255], a[60:63], v[60:63], v[252:255]
v_exp_f32 v40, v40
v_mfma_f32_16x16x32_bf16 v[220:223], a[60:63], v[56:59], v[220:223]
v_exp_f32 v41, v41
v_mfma_f32_16x16x32_bf16 v[188:191], a[60:63], v[52:55], v[188:191]
ds_read_b128 a[32:35], v2 offset:0
v_cvt_pk_bf16_f32 v74, v40, v41
v_mfma_f32_16x16x32_bf16 v[156:159], a[60:63], v[48:51], v[156:159]
v_smfmac_f32_16x16x64_bf16 a[224:227], a[232:235], v[48:55], v9
v_exp_f32 v42, v42
v_smfmac_f32_16x16x64_bf16 a[228:231], a[232:235], v[56:63], v9
s_waitcnt lgkmcnt(5)
v_exp_f32 v43, v43
v_mfma_f32_16x16x32_bf16 v[16:19], a[0:3], a[160:163], v[80:83]
ds_read_b128 a[36:39], v2 offset:1024
v_cvt_pk_bf16_f32 v75, v42, v43
v_mfma_f32_16x16x32_bf16 v[16:19], a[4:7], a[164:167], v[16:19]
v_exp_f32 v44, v44
v_mfma_f32_16x16x32_bf16 v[16:19], a[8:11], a[168:171], v[16:19]
v_mfma_f32_16x16x32_bf16 v[16:19], a[12:15], a[172:175], v[16:19]
v_exp_f32 v45, v45
v_mfma_f32_16x16x32_bf16 v[20:23], a[0:3], a[176:179], v[84:87]
ds_read_b128 a[40:43], v2 offset:2048
v_cvt_pk_bf16_f32 v78, v44, v45
v_mfma_f32_16x16x32_bf16 v[20:23], a[4:7], a[180:183], v[20:23]
buffer_load_dwordx4 v3, s[48:51], s32 offen offset:2048 sc1 lds
v_mfma_f32_16x16x32_bf16 v[20:23], a[8:11], a[184:187], v[20:23]
v_exp_f32 v46, v46
v_mfma_f32_16x16x32_bf16 v[20:23], a[12:15], a[188:191], v[20:23]
ds_read_b128 a[44:47], v2 offset:3072
v_mfma_f32_16x16x32_bf16 v[24:27], a[0:3], a[192:195], v[88:91]
v_mfma_f32_16x16x32_bf16 v[24:27], a[4:7], a[196:199], v[24:27]
v_exp_f32 v47, v47
v_mfma_f32_16x16x32_bf16 v[24:27], a[8:11], a[200:203], v[24:27]
v_exp_f32 v16, v16
v_mfma_f32_16x16x32_bf16 v[24:27], a[12:15], a[204:207], v[24:27]
ds_read_b128 a[48:51], v2 offset:4096
v_cvt_pk_bf16_f32 v79, v46, v47
v_mfma_f32_16x16x32_bf16 v[28:31], a[0:3], a[208:211], v[92:95]
v_mfma_f32_16x16x32_bf16 v[28:31], a[4:7], a[212:215], v[28:31]
v_exp_f32 v17, v17
v_mfma_f32_16x16x32_bf16 v[28:31], a[8:11], a[216:219], v[28:31]
s_waitcnt lgkmcnt(5)
v_exp_f32 v18, v18
v_mfma_f32_16x16x32_bf16 v[28:31], a[12:15], a[220:223], v[28:31]
ds_read_b128 a[52:55], v2 offset:5120
v_cvt_pk_bf16_f32 v48, v16, v17
v_mfma_f32_16x16x32_bf16 v[32:35], a[16:19], a[160:163], v[80:83]
v_mfma_f32_16x16x32_bf16 v[32:35], a[20:23], a[164:167], v[32:35]
v_exp_f32 v19, v19
v_mfma_f32_16x16x32_bf16 v[32:35], a[24:27], a[168:171], v[32:35]
v_exp_f32 v20, v20
v_mfma_f32_16x16x32_bf16 v[32:35], a[28:31], a[172:175], v[32:35]
ds_read_b128 a[56:59], v2 offset:6144
v_cvt_pk_bf16_f32 v49, v18, v19
v_mfma_f32_16x16x32_bf16 v[36:39], a[16:19], a[176:179], v[84:87]
v_exp_f32 v21, v21
v_mfma_f32_16x16x32_bf16 v[36:39], a[20:23], a[180:183], v[36:39]
buffer_load_dwordx4 v3, s[48:51], s32 offen offset:3072 sc1 lds
v_mfma_f32_16x16x32_bf16 v[36:39], a[24:27], a[184:187], v[36:39]
s_add_u32 s32, s32, 0x8000
v_cvt_pk_bf16_f32 v52, v20, v21
v_mfma_f32_16x16x32_bf16 v[36:39], a[28:31], a[188:191], v[36:39]
ds_read_b128 a[60:63], v2 offset:7168
v_mfma_f32_16x16x32_bf16 v[40:43], a[16:19], a[192:195], v[88:91]
v_exp_f32 v22, v22
v_mfma_f32_16x16x32_bf16 v[40:43], a[20:23], a[196:199], v[40:43]
v_exp_f32 v23, v23
v_mfma_f32_16x16x32_bf16 v[40:43], a[24:27], a[200:203], v[40:43]
v_cvt_pk_bf16_f32 v53, v22, v23
v_mfma_f32_16x16x32_bf16 v[40:43], a[28:31], a[204:207], v[40:43]
v_exp_f32 v24, v24
v_mfma_f32_16x16x32_bf16 v[44:47], a[16:19], a[208:211], v[92:95]
v_exp_f32 v25, v25
v_mfma_f32_16x16x32_bf16 v[44:47], a[20:23], a[212:215], v[44:47]
v_exp_f32 v26, v26
v_mfma_f32_16x16x32_bf16 v[44:47], a[24:27], a[216:219], v[44:47]
v_exp_f32 v27, v27
v_mfma_f32_16x16x32_bf16 v[44:47], a[28:31], a[220:223], v[44:47]
s_waitcnt lgkmcnt(0)
v_mfma_f32_16x16x32_bf16 v[128:131], a[32:35], v[64:67], v[128:131]
ds_read_b128 a[0:3], v2 offset:24576
v_cvt_pk_bf16_f32 v56, v24, v25
v_mfma_f32_16x16x32_bf16 v[160:163], a[32:35], v[68:71], v[160:163]
v_exp_f32 v28, v28
v_mfma_f32_16x16x32_bf16 v[192:195], a[32:35], v[72:75], v[192:195]
v_cvt_pk_bf16_f32 v57, v26, v27
v_mfma_f32_16x16x32_bf16 v[224:227], a[32:35], v[76:79], v[224:227]
ds_read_b128 a[4:7], v2 offset:25600
v_mfma_f32_16x16x32_bf16 v[228:231], a[36:39], v[76:79], v[228:231]
v_exp_f32 v29, v29
v_mfma_f32_16x16x32_bf16 v[196:199], a[36:39], v[72:75], v[196:199]
v_exp_f32 v30, v30
v_mfma_f32_16x16x32_bf16 v[164:167], a[36:39], v[68:71], v[164:167]
s_add_u32 m0, s19, 0x1000
v_cvt_pk_bf16_f32 v60, v28, v29
v_mfma_f32_16x16x32_bf16 v[132:135], a[36:39], v[64:67], v[132:135]
buffer_load_dwordx4 v3, s[48:51], s7 offen offset:0 sc1 lds
v_mfma_f32_16x16x32_bf16 v[136:139], a[40:43], v[64:67], v[136:139]
ds_read_b128 a[8:11], v2 offset:26624
v_mfma_f32_16x16x32_bf16 v[168:171], a[40:43], v[68:71], v[168:171]
v_exp_f32 v31, v31
v_mfma_f32_16x16x32_bf16 v[200:203], a[40:43], v[72:75], v[200:203]
v_exp_f32 v32, v32
v_mfma_f32_16x16x32_bf16 v[232:235], a[40:43], v[76:79], v[232:235]
ds_read_b128 a[12:15], v2 offset:27648
v_cvt_pk_bf16_f32 v61, v30, v31
v_mfma_f32_16x16x32_bf16 v[236:239], a[44:47], v[76:79], v[236:239]
v_mfma_f32_16x16x32_bf16 v[204:207], a[44:47], v[72:75], v[204:207]
v_exp_f32 v33, v33
v_mfma_f32_16x16x32_bf16 v[172:175], a[44:47], v[68:71], v[172:175]
v_exp_f32 v34, v34
v_mfma_f32_16x16x32_bf16 v[140:143], a[44:47], v[64:67], v[140:143]
ds_read_b128 a[16:19], v2 offset:28672
v_cvt_pk_bf16_f32 v50, v32, v33
v_mfma_f32_16x16x32_bf16 v[144:147], a[48:51], v[64:67], v[144:147]
v_exp_f32 v35, v35
v_mfma_f32_16x16x32_bf16 v[176:179], a[48:51], v[68:71], v[176:179]
v_cvt_pk_bf16_f32 v51, v34, v35
v_mfma_f32_16x16x32_bf16 v[208:211], a[48:51], v[72:75], v[208:211]
ds_read_b128 a[20:23], v2 offset:29696
v_mfma_f32_16x16x32_bf16 v[240:243], a[48:51], v[76:79], v[240:243]
v_exp_f32 v36, v36
v_mfma_f32_16x16x32_bf16 v[244:247], a[52:55], v[76:79], v[244:247]
v_exp_f32 v37, v37
v_mfma_f32_16x16x32_bf16 v[212:215], a[52:55], v[72:75], v[212:215]
v_cvt_pk_bf16_f32 v54, v36, v37
v_mfma_f32_16x16x32_bf16 v[180:183], a[52:55], v[68:71], v[180:183]
buffer_load_dwordx4 v3, s[48:51], s7 offen offset:1024 sc1 lds
v_mfma_f32_16x16x32_bf16 v[148:151], a[52:55], v[64:67], v[148:151]
ds_read_b128 a[24:27], v2 offset:30720
v_mfma_f32_16x16x32_bf16 v[152:155], a[56:59], v[64:67], v[152:155]
v_exp_f32 v38, v38
v_mfma_f32_16x16x32_bf16 v[184:187], a[56:59], v[68:71], v[184:187]
v_exp_f32 v39, v39
v_mfma_f32_16x16x32_bf16 v[216:219], a[56:59], v[72:75], v[216:219]
ds_read_b128 a[28:31], v2 offset:31744
v_cvt_pk_bf16_f32 v55, v38, v39
v_mfma_f32_16x16x32_bf16 v[248:251], a[56:59], v[76:79], v[248:251]
v_exp_f32 v40, v40
v_mfma_f32_16x16x32_bf16 v[252:255], a[60:63], v[76:79], v[252:255]
v_mfma_f32_16x16x32_bf16 v[220:223], a[60:63], v[72:75], v[220:223]
v_exp_f32 v41, v41
v_mfma_f32_16x16x32_bf16 v[188:191], a[60:63], v[68:71], v[188:191]
ds_read_b128 a[32:35], v2 offset:16384
v_cvt_pk_bf16_f32 v58, v40, v41
v_mfma_f32_16x16x32_bf16 v[156:159], a[60:63], v[64:67], v[156:159]
v_exp_f32 v42, v42
v_smfmac_f32_16x16x64_bf16 a[224:227], a[232:235], v[64:71], v9
s_waitcnt lgkmcnt(5)
v_smfmac_f32_16x16x64_bf16 a[228:231], a[232:235], v[72:79], v9
ds_read_b128 a[36:39], v2 offset:17408
v_mfma_f32_16x16x32_bf16 v[16:19], a[0:3], a[160:163], v[80:83]
v_exp_f32 v43, v43
v_mfma_f32_16x16x32_bf16 v[16:19], a[4:7], a[164:167], v[16:19]
v_exp_f32 v44, v44
v_mfma_f32_16x16x32_bf16 v[16:19], a[8:11], a[168:171], v[16:19]
buffer_load_dwordx4 v3, s[48:51], s7 offen offset:2048 sc1 lds
v_mfma_f32_16x16x32_bf16 v[16:19], a[12:15], a[172:175], v[16:19]
ds_read_b128 a[40:43], v2 offset:18432
v_cvt_pk_bf16_f32 v59, v42, v43
v_mfma_f32_16x16x32_bf16 v[20:23], a[0:3], a[176:179], v[84:87]
v_exp_f32 v45, v45
v_mfma_f32_16x16x32_bf16 v[20:23], a[4:7], a[180:183], v[20:23]
v_cvt_pk_bf16_f32 v62, v44, v45
v_mfma_f32_16x16x32_bf16 v[20:23], a[8:11], a[184:187], v[20:23]
v_exp_f32 v46, v46
v_mfma_f32_16x16x32_bf16 v[20:23], a[12:15], a[188:191], v[20:23]
ds_read_b128 a[44:47], v2 offset:19456
v_mfma_f32_16x16x32_bf16 v[24:27], a[0:3], a[192:195], v[88:91]
v_exp_f32 v47, v47
v_mfma_f32_16x16x32_bf16 v[24:27], a[4:7], a[196:199], v[24:27]
v_cvt_pk_bf16_f32 v63, v46, v47
v_mfma_f32_16x16x32_bf16 v[24:27], a[8:11], a[200:203], v[24:27]
v_exp_f32 v16, v16
v_mfma_f32_16x16x32_bf16 v[24:27], a[12:15], a[204:207], v[24:27]
ds_read_b128 a[48:51], v2 offset:20480
v_mfma_f32_16x16x32_bf16 v[28:31], a[0:3], a[208:211], v[92:95]
v_exp_f32 v17, v17
v_mfma_f32_16x16x32_bf16 v[28:31], a[4:7], a[212:215], v[28:31]
v_exp_f32 v18, v18
v_mfma_f32_16x16x32_bf16 v[28:31], a[8:11], a[216:219], v[28:31]
ds_read_b128 a[52:55], v2 offset:21504
v_cvt_pk_bf16_f32 v64, v16, v17
v_mfma_f32_16x16x32_bf16 v[28:31], a[12:15], a[220:223], v[28:31]
s_waitcnt lgkmcnt(6)
v_mfma_f32_16x16x32_bf16 v[32:35], a[16:19], a[160:163], v[80:83]
v_exp_f32 v19, v19
v_mfma_f32_16x16x32_bf16 v[32:35], a[20:23], a[164:167], v[32:35]
buffer_load_dwordx4 v3, s[48:51], s7 offen offset:3072 sc1 lds
v_mfma_f32_16x16x32_bf16 v[32:35], a[24:27], a[168:171], v[32:35]
ds_read_b128 a[56:59], v2 offset:22528
v_cvt_pk_bf16_f32 v65, v18, v19
v_mfma_f32_16x16x32_bf16 v[32:35], a[28:31], a[172:175], v[32:35]
s_add_u32 s7, s7, 0x8000
v_exp_f32 v20, v20
v_mfma_f32_16x16x32_bf16 v[36:39], a[16:19], a[176:179], v[84:87]
s_xor_b32 s19, s19, 0x8000
v_mfma_f32_16x16x32_bf16 v[36:39], a[20:23], a[180:183], v[36:39]
s_sub_u32 s15, s15, 1
v_exp_f32 v21, v21
v_mfma_f32_16x16x32_bf16 v[36:39], a[24:27], a[184:187], v[36:39]
ds_read_b128 a[60:63], v2 offset:23552
v_xor_b32 v2, 0x38000, v2
v_mfma_f32_16x16x32_bf16 v[36:39], a[28:31], a[188:191], v[36:39]
s_cmp_lg_u32 s15, 0
v_exp_f32 v22, v22
v_mfma_f32_16x16x32_bf16 v[40:43], a[16:19], a[192:195], v[88:91]
v_exp_f32 v23, v23
v_mfma_f32_16x16x32_bf16 v[40:43], a[20:23], a[196:199], v[40:43]
v_cvt_pk_bf16_f32 v68, v20, v21
v_cvt_pk_bf16_f32 v69, v22, v23
v_mfma_f32_16x16x32_bf16 v[40:43], a[24:27], a[200:203], v[40:43]
v_exp_f32 v24, v24
v_mfma_f32_16x16x32_bf16 v[40:43], a[28:31], a[204:207], v[40:43]
v_exp_f32 v25, v25
v_mfma_f32_16x16x32_bf16 v[44:47], a[16:19], a[208:211], v[92:95]
v_exp_f32 v26, v26
v_mfma_f32_16x16x32_bf16 v[44:47], a[20:23], a[212:215], v[44:47]
v_exp_f32 v27, v27
v_mfma_f32_16x16x32_bf16 v[44:47], a[24:27], a[216:219], v[44:47]
s_waitcnt vmcnt(16) lgkmcnt(0)
v_mfma_f32_16x16x32_bf16 v[44:47], a[28:31], a[220:223], v[44:47]
s_barrier
s_cbranch_scc1 L_att_deven0
s_branch L_att_ddone
L_att_deven1:
v_mfma_f32_16x16x32_bf16 v[128:131], a[32:35], v[48:51], v[128:131]
ds_read_b128 a[0:3], v1 offset:8192
v_cvt_pk_bf16_f32 v72, v24, v25
v_mfma_f32_16x16x32_bf16 v[160:163], a[32:35], v[52:55], v[160:163]
v_exp_f32 v28, v28
v_mfma_f32_16x16x32_bf16 v[192:195], a[32:35], v[56:59], v[192:195]
v_cvt_pk_bf16_f32 v73, v26, v27
v_mfma_f32_16x16x32_bf16 v[224:227], a[32:35], v[60:63], v[224:227]
ds_read_b128 a[4:7], v1 offset:9216
v_mfma_f32_16x16x32_bf16 v[228:231], a[36:39], v[60:63], v[228:231]
v_exp_f32 v29, v29
v_mfma_f32_16x16x32_bf16 v[196:199], a[36:39], v[56:59], v[196:199]
v_exp_f32 v30, v30
v_mfma_f32_16x16x32_bf16 v[164:167], a[36:39], v[52:55], v[164:167]
s_add_u32 m0, s27, 0x0
v_cvt_pk_bf16_f32 v76, v28, v29
v_mfma_f32_16x16x32_bf16 v[132:135], a[36:39], v[48:51], v[132:135]
buffer_load_dwordx4 v3, s[48:51], s32 offen offset:0 sc1 lds
v_mfma_f32_16x16x32_bf16 v[136:139], a[40:43], v[48:51], v[136:139]
ds_read_b128 a[8:11], v1 offset:10240
v_mfma_f32_16x16x32_bf16 v[168:171], a[40:43], v[52:55], v[168:171]
v_exp_f32 v31, v31
v_mfma_f32_16x16x32_bf16 v[200:203], a[40:43], v[56:59], v[200:203]
v_exp_f32 v32, v32
v_mfma_f32_16x16x32_bf16 v[232:235], a[40:43], v[60:63], v[232:235]
ds_read_b128 a[12:15], v1 offset:11264
v_cvt_pk_bf16_f32 v77, v30, v31
v_mfma_f32_16x16x32_bf16 v[236:239], a[44:47], v[60:63], v[236:239]
v_mfma_f32_16x16x32_bf16 v[204:207], a[44:47], v[56:59], v[204:207]
v_exp_f32 v33, v33
v_mfma_f32_16x16x32_bf16 v[172:175], a[44:47], v[52:55], v[172:175]
v_exp_f32 v34, v34
v_mfma_f32_16x16x32_bf16 v[140:143], a[44:47], v[48:51], v[140:143]
ds_read_b128 a[16:19], v1 offset:12288
v_cvt_pk_bf16_f32 v66, v32, v33
v_mfma_f32_16x16x32_bf16 v[144:147], a[48:51], v[48:51], v[144:147]
v_mfma_f32_16x16x32_bf16 v[176:179], a[48:51], v[52:55], v[176:179]
v_exp_f32 v35, v35
v_mfma_f32_16x16x32_bf16 v[208:211], a[48:51], v[56:59], v[208:211]
v_exp_f32 v36, v36
v_mfma_f32_16x16x32_bf16 v[240:243], a[48:51], v[60:63], v[240:243]
ds_read_b128 a[20:23], v1 offset:13312
v_cvt_pk_bf16_f32 v67, v34, v35
v_mfma_f32_16x16x32_bf16 v[244:247], a[52:55], v[60:63], v[244:247]
v_exp_f32 v37, v37
v_mfma_f32_16x16x32_bf16 v[212:215], a[52:55], v[56:59], v[212:215]
v_cvt_pk_bf16_f32 v70, v36, v37
v_mfma_f32_16x16x32_bf16 v[180:183], a[52:55], v[52:55], v[180:183]
ds_read_b128 a[24:27], v1 offset:14336
v_mfma_f32_16x16x32_bf16 v[148:151], a[52:55], v[48:51], v[148:151]
buffer_load_dwordx4 v3, s[48:51], s32 offen offset:1024 sc1 lds
v_mfma_f32_16x16x32_bf16 v[152:155], a[56:59], v[48:51], v[152:155]
v_exp_f32 v38, v38
v_mfma_f32_16x16x32_bf16 v[184:187], a[56:59], v[52:55], v[184:187]
v_exp_f32 v39, v39
v_mfma_f32_16x16x32_bf16 v[216:219], a[56:59], v[56:59], v[216:219]
ds_read_b128 a[28:31], v1 offset:15360
v_cvt_pk_bf16_f32 v71, v38, v39
v_mfma_f32_16x16x32_bf16 v[248:251], a[56:59], v[60:63], v[248:251]
v_mfma_f32_16x16x32_bf16 v[252:255], a[60:63], v[60:63], v[252:255]
v_exp_f32 v40, v40
v_mfma_f32_16x16x32_bf16 v[220:223], a[60:63], v[56:59], v[220:223]
v_exp_f32 v41, v41
v_mfma_f32_16x16x32_bf16 v[188:191], a[60:63], v[52:55], v[188:191]
ds_read_b128 a[32:35], v1 offset:0
v_cvt_pk_bf16_f32 v74, v40, v41
v_mfma_f32_16x16x32_bf16 v[156:159], a[60:63], v[48:51], v[156:159]
v_smfmac_f32_16x16x64_bf16 a[224:227], a[232:235], v[48:55], v9
v_exp_f32 v42, v42
v_smfmac_f32_16x16x64_bf16 a[228:231], a[232:235], v[56:63], v9
s_waitcnt lgkmcnt(5)
v_exp_f32 v43, v43
v_mfma_f32_16x16x32_bf16 v[16:19], a[0:3], a[160:163], v[80:83]
ds_read_b128 a[36:39], v1 offset:1024
v_cvt_pk_bf16_f32 v75, v42, v43
v_mfma_f32_16x16x32_bf16 v[16:19], a[4:7], a[164:167], v[16:19]
v_exp_f32 v44, v44
v_mfma_f32_16x16x32_bf16 v[16:19], a[8:11], a[168:171], v[16:19]
v_mfma_f32_16x16x32_bf16 v[16:19], a[12:15], a[172:175], v[16:19]
v_exp_f32 v45, v45
v_mfma_f32_16x16x32_bf16 v[20:23], a[0:3], a[176:179], v[84:87]
ds_read_b128 a[40:43], v1 offset:2048
v_cvt_pk_bf16_f32 v78, v44, v45
v_mfma_f32_16x16x32_bf16 v[20:23], a[4:7], a[180:183], v[20:23]
buffer_load_dwordx4 v3, s[48:51], s32 offen offset:2048 sc1 lds
v_mfma_f32_16x16x32_bf16 v[20:23], a[8:11], a[184:187], v[20:23]
v_exp_f32 v46, v46
v_mfma_f32_16x16x32_bf16 v[20:23], a[12:15], a[188:191], v[20:23]
ds_read_b128 a[44:47], v1 offset:3072
v_mfma_f32_16x16x32_bf16 v[24:27], a[0:3], a[192:195], v[88:91]
v_mfma_f32_16x16x32_bf16 v[24:27], a[4:7], a[196:199], v[24:27]
v_exp_f32 v47, v47
v_mfma_f32_16x16x32_bf16 v[24:27], a[8:11], a[200:203], v[24:27]
v_exp_f32 v16, v16
v_mfma_f32_16x16x32_bf16 v[24:27], a[12:15], a[204:207], v[24:27]
ds_read_b128 a[48:51], v1 offset:4096
v_cvt_pk_bf16_f32 v79, v46, v47
v_mfma_f32_16x16x32_bf16 v[28:31], a[0:3], a[208:211], v[92:95]
v_mfma_f32_16x16x32_bf16 v[28:31], a[4:7], a[212:215], v[28:31]
v_exp_f32 v17, v17
v_mfma_f32_16x16x32_bf16 v[28:31], a[8:11], a[216:219], v[28:31]
s_waitcnt lgkmcnt(5)
v_exp_f32 v18, v18
v_mfma_f32_16x16x32_bf16 v[28:31], a[12:15], a[220:223], v[28:31]
ds_read_b128 a[52:55], v1 offset:5120
v_cvt_pk_bf16_f32 v48, v16, v17
v_mfma_f32_16x16x32_bf16 v[32:35], a[16:19], a[160:163], v[80:83]
v_mfma_f32_16x16x32_bf16 v[32:35], a[20:23], a[164:167], v[32:35]
v_exp_f32 v19, v19
v_mfma_f32_16x16x32_bf16 v[32:35], a[24:27], a[168:171], v[32:35]
v_exp_f32 v20, v20
v_mfma_f32_16x16x32_bf16 v[32:35], a[28:31], a[172:175], v[32:35]
ds_read_b128 a[56:59], v1 offset:6144
v_cvt_pk_bf16_f32 v49, v18, v19
v_mfma_f32_16x16x32_bf16 v[36:39], a[16:19], a[176:179], v[84:87]
v_exp_f32 v21, v21
v_mfma_f32_16x16x32_bf16 v[36:39], a[20:23], a[180:183], v[36:39]
buffer_load_dwordx4 v3, s[48:51], s32 offen offset:3072 sc1 lds
v_mfma_f32_16x16x32_bf16 v[36:39], a[24:27], a[184:187], v[36:39]
s_add_u32 s32, s32, 0x8000
v_cvt_pk_bf16_f32 v52, v20, v21
v_mfma_f32_16x16x32_bf16 v[36:39], a[28:31], a[188:191], v[36:39]
ds_read_b128 a[60:63], v1 offset:7168
v_mfma_f32_16x16x32_bf16 v[40:43], a[16:19], a[192:195], v[88:91]
v_exp_f32 v22, v22
v_mfma_f32_16x16x32_bf16 v[40:43], a[20:23], a[196:199], v[40:43]
v_exp_f32 v23, v23
v_mfma_f32_16x16x32_bf16 v[40:43], a[24:27], a[200:203], v[40:43]
v_cvt_pk_bf16_f32 v53, v22, v23
v_mfma_f32_16x16x32_bf16 v[40:43], a[28:31], a[204:207], v[40:43]
v_exp_f32 v24, v24
v_mfma_f32_16x16x32_bf16 v[44:47], a[16:19], a[208:211], v[92:95]
v_exp_f32 v25, v25
v_mfma_f32_16x16x32_bf16 v[44:47], a[20:23], a[212:215], v[44:47]
v_exp_f32 v26, v26
v_mfma_f32_16x16x32_bf16 v[44:47], a[24:27], a[216:219], v[44:47]
v_exp_f32 v27, v27
v_mfma_f32_16x16x32_bf16 v[44:47], a[28:31], a[220:223], v[44:47]
s_waitcnt lgkmcnt(0)
v_mfma_f32_16x16x32_bf16 v[128:131], a[32:35], v[64:67], v[128:131]
ds_read_b128 a[0:3], v1 offset:24576
v_cvt_pk_bf16_f32 v56, v24, v25
v_mfma_f32_16x16x32_bf16 v[160:163], a[32:35], v[68:71], v[160:163]
v_exp_f32 v28, v28
v_mfma_f32_16x16x32_bf16 v[192:195], a[32:35], v[72:75], v[192:195]
v_cvt_pk_bf16_f32 v57, v26, v27
v_mfma_f32_16x16x32_bf16 v[224:227], a[32:35], v[76:79], v[224:227]
ds_read_b128 a[4:7], v1 offset:25600
v_mfma_f32_16x16x32_bf16 v[228:231], a[36:39], v[76:79], v[228:231]
v_exp_f32 v29, v29
v_mfma_f32_16x16x32_bf16 v[196:199], a[36:39], v[72:75], v[196:199]
v_exp_f32 v30, v30
v_mfma_f32_16x16x32_bf16 v[164:167], a[36:39], v[68:71], v[164:167]
s_add_u32 m0, s27, 0x1000
v_cvt_pk_bf16_f32 v60, v28, v29
v_mfma_f32_16x16x32_bf16 v[132:135], a[36:39], v[64:67], v[132:135]
buffer_load_dwordx4 v3, s[48:51], s7 offen offset:0 sc1 lds
v_mfma_f32_16x16x32_bf16 v[136:139], a[40:43], v[64:67], v[136:139]
ds_read_b128 a[8:11], v1 offset:26624
v_mfma_f32_16x16x32_bf16 v[168:171], a[40:43], v[68:71], v[168:171]
v_exp_f32 v31, v31
v_mfma_f32_16x16x32_bf16 v[200:203], a[40:43], v[72:75], v[200:203]
v_exp_f32 v32, v32
v_mfma_f32_16x16x32_bf16 v[232:235], a[40:43], v[76:79], v[232:235]
ds_read_b128 a[12:15], v1 offset:27648
v_cvt_pk_bf16_f32 v61, v30, v31
v_mfma_f32_16x16x32_bf16 v[236:239], a[44:47], v[76:79], v[236:239]
v_mfma_f32_16x16x32_bf16 v[204:207], a[44:47], v[72:75], v[204:207]
v_exp_f32 v33, v33
v_mfma_f32_16x16x32_bf16 v[172:175], a[44:47], v[68:71], v[172:175]
v_exp_f32 v34, v34
v_mfma_f32_16x16x32_bf16 v[140:143], a[44:47], v[64:67], v[140:143]
ds_read_b128 a[16:19], v1 offset:28672
v_cvt_pk_bf16_f32 v50, v32, v33
v_mfma_f32_16x16x32_bf16 v[144:147], a[48:51], v[64:67], v[144:147]
v_mfma_f32_16x16x32_bf16 v[176:179], a[48:51], v[68:71], v[176:179]
v_exp_f32 v35, v35
v_mfma_f32_16x16x32_bf16 v[208:211], a[48:51], v[72:75], v[208:211]
ds_read_b128 a[20:23], v1 offset:29696
v_cvt_pk_bf16_f32 v51, v34, v35
v_mfma_f32_16x16x32_bf16 v[240:243], a[48:51], v[76:79], v[240:243]
v_exp_f32 v36, v36
v_mfma_f32_16x16x32_bf16 v[244:247], a[52:55], v[76:79], v[244:247]
v_exp_f32 v37, v37
v_mfma_f32_16x16x32_bf16 v[212:215], a[52:55], v[72:75], v[212:215]
v_cvt_pk_bf16_f32 v54, v36, v37
v_mfma_f32_16x16x32_bf16 v[180:183], a[52:55], v[68:71], v[180:183]
buffer_load_dwordx4 v3, s[48:51], s7 offen offset:1024 sc1 lds
v_mfma_f32_16x16x32_bf16 v[148:151], a[52:55], v[64:67], v[148:151]
ds_read_b128 a[24:27], v1 offset:30720
v_mfma_f32_16x16x32_bf16 v[152:155], a[56:59], v[64:67], v[152:155]
v_exp_f32 v38, v38
v_mfma_f32_16x16x32_bf16 v[184:187], a[56:59], v[68:71], v[184:187]
v_exp_f32 v39, v39
v_mfma_f32_16x16x32_bf16 v[216:219], a[56:59], v[72:75], v[216:219]
ds_read_b128 a[28:31], v1 offset:31744
v_cvt_pk_bf16_f32 v55, v38, v39
v_mfma_f32_16x16x32_bf16 v[248:251], a[56:59], v[76:79], v[248:251]
v_mfma_f32_16x16x32_bf16 v[252:255], a[60:63], v[76:79], v[252:255]
v_exp_f32 v40, v40
v_mfma_f32_16x16x32_bf16 v[220:223], a[60:63], v[72:75], v[220:223]
v_exp_f32 v41, v41
v_mfma_f32_16x16x32_bf16 v[188:191], a[60:63], v[68:71], v[188:191]
ds_read_b128 a[32:35], v1 offset:16384
v_cvt_pk_bf16_f32 v58, v40, v41
v_mfma_f32_16x16x32_bf16 v[156:159], a[60:63], v[64:67], v[156:159]
v_smfmac_f32_16x16x64_bf16 a[224:227], a[232:235], v[64:71], v9
s_waitcnt lgkmcnt(5)
v_exp_f32 v42, v42
v_smfmac_f32_16x16x64_bf16 a[228:231], a[232:235], v[72:79], v9
ds_read_b128 a[36:39], v1 offset:17408
v_mfma_f32_16x16x32_bf16 v[16:19], a[0:3], a[160:163], v[80:83]
v_exp_f32 v43, v43
v_mfma_f32_16x16x32_bf16 v[16:19], a[4:7], a[164:167], v[16:19]
v_exp_f32 v44, v44
v_mfma_f32_16x16x32_bf16 v[16:19], a[8:11], a[168:171], v[16:19]
v_cvt_pk_bf16_f32 v59, v42, v43
v_mfma_f32_16x16x32_bf16 v[16:19], a[12:15], a[172:175], v[16:19]
ds_read_b128 a[40:43], v1 offset:18432
v_mfma_f32_16x16x32_bf16 v[20:23], a[0:3], a[176:179], v[84:87]
buffer_load_dwordx4 v3, s[48:51], s7 offen offset:2048 sc1 lds
v_mfma_f32_16x16x32_bf16 v[20:23], a[4:7], a[180:183], v[20:23]
v_exp_f32 v45, v45
v_mfma_f32_16x16x32_bf16 v[20:23], a[8:11], a[184:187], v[20:23]
v_exp_f32 v46, v46
v_mfma_f32_16x16x32_bf16 v[20:23], a[12:15], a[188:191], v[20:23]
ds_read_b128 a[44:47], v1 offset:19456
v_cvt_pk_bf16_f32 v62, v44, v45
v_mfma_f32_16x16x32_bf16 v[24:27], a[0:3], a[192:195], v[88:91]
v_mfma_f32_16x16x32_bf16 v[24:27], a[4:7], a[196:199], v[24:27]
v_exp_f32 v47, v47
v_mfma_f32_16x16x32_bf16 v[24:27], a[8:11], a[200:203], v[24:27]
v_exp_f32 v16, v16
v_mfma_f32_16x16x32_bf16 v[24:27], a[12:15], a[204:207], v[24:27]
ds_read_b128 a[48:51], v1 offset:20480
v_cvt_pk_bf16_f32 v63, v46, v47
v_mfma_f32_16x16x32_bf16 v[28:31], a[0:3], a[208:211], v[92:95]
v_mfma_f32_16x16x32_bf16 v[28:31], a[4:7], a[212:215], v[28:31]
v_exp_f32 v17, v17
v_mfma_f32_16x16x32_bf16 v[28:31], a[8:11], a[216:219], v[28:31]
ds_read_b128 a[52:55], v1 offset:21504
v_cvt_pk_bf16_f32 v64, v16, v17
v_mfma_f32_16x16x32_bf16 v[28:31], a[12:15], a[220:223], v[28:31]
s_waitcnt lgkmcnt(6)
v_exp_f32 v18, v18
v_mfma_f32_16x16x32_bf16 v[32:35], a[16:19], a[160:163], v[80:83]
v_mfma_f32_16x16x32_bf16 v[32:35], a[20:23], a[164:167], v[32:35]
v_exp_f32 v19, v19
v_mfma_f32_16x16x32_bf16 v[32:35], a[24:27], a[168:171], v[32:35]
ds_read_b128 a[56:59], v1 offset:22528
v_cvt_pk_bf16_f32 v65, v18, v19
v_mfma_f32_16x16x32_bf16 v[32:35], a[28:31], a[172:175], v[32:35]
buffer_load_dwordx4 v3, s[48:51], s7 offen offset:3072 sc1 lds
v_mfma_f32_16x16x32_bf16 v[36:39], a[16:19], a[176:179], v[84:87]
s_add_u32 s7, s7, 0x8000
v_exp_f32 v20, v20
v_mfma_f32_16x16x32_bf16 v[36:39], a[20:23], a[180:183], v[36:39]
s_xor_b32 s27, s27, 0x38000
v_exp_f32 v21, v21
v_mfma_f32_16x16x32_bf16 v[36:39], a[24:27], a[184:187], v[36:39]
ds_read_b128 a[60:63], v1 offset:23552
v_xor_b32 v1, 0x8000, v1
v_mfma_f32_16x16x32_bf16 v[36:39], a[28:31], a[188:191], v[36:39]
v_cvt_pk_bf16_f32 v68, v20, v21
v_mfma_f32_16x16x32_bf16 v[40:43], a[16:19], a[192:195], v[88:91]
v_exp_f32 v22, v22
v_mfma_f32_16x16x32_bf16 v[40:43], a[20:23], a[196:199], v[40:43]
v_exp_f32 v23, v23
v_mfma_f32_16x16x32_bf16 v[40:43], a[24:27], a[200:203], v[40:43]
v_cvt_pk_bf16_f32 v69, v22, v23
v_mfma_f32_16x16x32_bf16 v[40:43], a[28:31], a[204:207], v[40:43]
v_exp_f32 v24, v24
v_mfma_f32_16x16x32_bf16 v[44:47], a[16:19], a[208:211], v[92:95]
s_waitcnt vmcnt(16) lgkmcnt(0)
v_exp_f32 v25, v25
v_mfma_f32_16x16x32_bf16 v[44:47], a[20:23], a[212:215], v[44:47]
s_barrier
v_exp_f32 v26, v26
v_mfma_f32_16x16x32_bf16 v[44:47], a[24:27], a[216:219], v[44:47]
v_exp_f32 v27, v27
v_mfma_f32_16x16x32_bf16 v[44:47], a[28:31], a[220:223], v[44:47]
L_att_dodd1:
v_mfma_f32_16x16x32_bf16 v[128:131], a[32:35], v[48:51], v[128:131]
ds_read_b128 a[0:3], v2 offset:8192
v_cvt_pk_bf16_f32 v72, v24, v25
v_mfma_f32_16x16x32_bf16 v[160:163], a[32:35], v[52:55], v[160:163]
v_exp_f32 v28, v28
v_mfma_f32_16x16x32_bf16 v[192:195], a[32:35], v[56:59], v[192:195]
v_cvt_pk_bf16_f32 v73, v26, v27
v_mfma_f32_16x16x32_bf16 v[224:227], a[32:35], v[60:63], v[224:227]
ds_read_b128 a[4:7], v2 offset:9216
v_mfma_f32_16x16x32_bf16 v[228:231], a[36:39], v[60:63], v[228:231]
v_exp_f32 v29, v29
v_mfma_f32_16x16x32_bf16 v[196:199], a[36:39], v[56:59], v[196:199]
v_exp_f32 v30, v30
v_mfma_f32_16x16x32_bf16 v[164:167], a[36:39], v[52:55], v[164:167]
s_add_u32 m0, s19, 0x0
v_cvt_pk_bf16_f32 v76, v28, v29
v_mfma_f32_16x16x32_bf16 v[132:135], a[36:39], v[48:51], v[132:135]
buffer_load_dwordx4 v3, s[48:51], s32 offen offset:0 sc1 lds
v_mfma_f32_16x16x32_bf16 v[136:139], a[40:43], v[48:51], v[136:139]
ds_read_b128 a[8:11], v2 offset:10240
v_mfma_f32_16x16x32_bf16 v[168:171], a[40:43], v[52:55], v[168:171]
v_exp_f32 v31, v31
v_mfma_f32_16x16x32_bf16 v[200:203], a[40:43], v[56:59], v[200:203]
v_exp_f32 v32, v32
v_mfma_f32_16x16x32_bf16 v[232:235], a[40:43], v[60:63], v[232:235]
ds_read_b128 a[12:15], v2 offset:11264
v_cvt_pk_bf16_f32 v77, v30, v31
v_mfma_f32_16x16x32_bf16 v[236:239], a[44:47], v[60:63], v[236:239]
v_mfma_f32_16x16x32_bf16 v[204:207], a[44:47], v[56:59], v[204:207]
v_exp_f32 v33, v33
v_mfma_f32_16x16x32_bf16 v[172:175], a[44:47], v[52:55], v[172:175]
v_exp_f32 v34, v34
v_mfma_f32_16x16x32_bf16 v[140:143], a[44:47], v[48:51], v[140:143]
ds_read_b128 a[16:19], v2 offset:12288
v_cvt_pk_bf16_f32 v66, v32, v33
v_mfma_f32_16x16x32_bf16 v[144:147], a[48:51], v[48:51], v[144:147]
v_mfma_f32_16x16x32_bf16 v[176:179], a[48:51], v[52:55], v[176:179]
v_exp_f32 v35, v35
v_mfma_f32_16x16x32_bf16 v[208:211], a[48:51], v[56:59], v[208:211]
v_exp_f32 v36, v36
v_mfma_f32_16x16x32_bf16 v[240:243], a[48:51], v[60:63], v[240:243]
ds_read_b128 a[20:23], v2 offset:13312
v_cvt_pk_bf16_f32 v67, v34, v35
v_mfma_f32_16x16x32_bf16 v[244:247], a[52:55], v[60:63], v[244:247]
v_exp_f32 v37, v37
v_mfma_f32_16x16x32_bf16 v[212:215], a[52:55], v[56:59], v[212:215]
v_cvt_pk_bf16_f32 v70, v36, v37
v_mfma_f32_16x16x32_bf16 v[180:183], a[52:55], v[52:55], v[180:183]
ds_read_b128 a[24:27], v2 offset:14336
v_mfma_f32_16x16x32_bf16 v[148:151], a[52:55], v[48:51], v[148:151]
buffer_load_dwordx4 v3, s[48:51], s32 offen offset:1024 sc1 lds
v_mfma_f32_16x16x32_bf16 v[152:155], a[56:59], v[48:51], v[152:155]
v_exp_f32 v38, v38
v_mfma_f32_16x16x32_bf16 v[184:187], a[56:59], v[52:55], v[184:187]
v_exp_f32 v39, v39
v_mfma_f32_16x16x32_bf16 v[216:219], a[56:59], v[56:59], v[216:219]
ds_read_b128 a[28:31], v2 offset:15360
v_cvt_pk_bf16_f32 v71, v38, v39
v_mfma_f32_16x16x32_bf16 v[248:251], a[56:59], v[60:63], v[248:251]
v_mfma_f32_16x16x32_bf16 v[252:255], a[60:63], v[60:63], v[252:255]
v_exp_f32 v40, v40
v_mfma_f32_16x16x32_bf16 v[220:223], a[60:63], v[56:59], v[220:223]
v_exp_f32 v41, v41
v_mfma_f32_16x16x32_bf16 v[188:191], a[60:63], v[52:55], v[188:191]
ds_read_b128 a[32:35], v2 offset:0
v_cvt_pk_bf16_f32 v74, v40, v41
v_mfma_f32_16x16x32_bf16 v[156:159], a[60:63], v[48:51], v[156:159]
v_smfmac_f32_16x16x64_bf16 a[224:227], a[232:235], v[48:55], v9
v_exp_f32 v42, v42
v_smfmac_f32_16x16x64_bf16 a[228:231], a[232:235], v[56:63], v9
s_waitcnt lgkmcnt(5)
v_exp_f32 v43, v43
v_mfma_f32_16x16x32_bf16 v[16:19], a[0:3], a[160:163], v[80:83]
ds_read_b128 a[36:39], v2 offset:1024
v_cvt_pk_bf16_f32 v75, v42, v43
v_mfma_f32_16x16x32_bf16 v[16:19], a[4:7], a[164:167], v[16:19]
v_exp_f32 v44, v44
v_mfma_f32_16x16x32_bf16 v[16:19], a[8:11], a[168:171], v[16:19]
v_mfma_f32_16x16x32_bf16 v[16:19], a[12:15], a[172:175], v[16:19]
v_exp_f32 v45, v45
v_mfma_f32_16x16x32_bf16 v[20:23], a[0:3], a[176:179], v[84:87]
ds_read_b128 a[40:43], v2 offset:2048
v_cvt_pk_bf16_f32 v78, v44, v45
v_mfma_f32_16x16x32_bf16 v[20:23], a[4:7], a[180:183], v[20:23]
buffer_load_dwordx4 v3, s[48:51], s32 offen offset:2048 sc1 lds
v_mfma_f32_16x16x32_bf16 v[20:23], a[8:11], a[184:187], v[20:23]
v_exp_f32 v46, v46
v_mfma_f32_16x16x32_bf16 v[20:23], a[12:15], a[188:191], v[20:23]
ds_read_b128 a[44:47], v2 offset:3072
v_mfma_f32_16x16x32_bf16 v[24:27], a[0:3], a[192:195], v[88:91]
v_mfma_f32_16x16x32_bf16 v[24:27], a[4:7], a[196:199], v[24:27]
v_exp_f32 v47, v47
v_mfma_f32_16x16x32_bf16 v[24:27], a[8:11], a[200:203], v[24:27]
v_exp_f32 v16, v16
v_mfma_f32_16x16x32_bf16 v[24:27], a[12:15], a[204:207], v[24:27]
ds_read_b128 a[48:51], v2 offset:4096
v_cvt_pk_bf16_f32 v79, v46, v47
v_mfma_f32_16x16x32_bf16 v[28:31], a[0:3], a[208:211], v[92:95]
v_mfma_f32_16x16x32_bf16 v[28:31], a[4:7], a[212:215], v[28:31]
v_exp_f32 v17, v17
v_mfma_f32_16x16x32_bf16 v[28:31], a[8:11], a[216:219], v[28:31]
s_waitcnt lgkmcnt(5)
v_exp_f32 v18, v18
v_mfma_f32_16x16x32_bf16 v[28:31], a[12:15], a[220:223], v[28:31]
ds_read_b128 a[52:55], v2 offset:5120
v_cvt_pk_bf16_f32 v48, v16, v17
v_mfma_f32_16x16x32_bf16 v[32:35], a[16:19], a[160:163], v[80:83]
v_mfma_f32_16x16x32_bf16 v[32:35], a[20:23], a[164:167], v[32:35]
v_exp_f32 v19, v19
v_mfma_f32_16x16x32_bf16 v[32:35], a[24:27], a[168:171], v[32:35]
v_exp_f32 v20, v20
v_mfma_f32_16x16x32_bf16 v[32:35], a[28:31], a[172:175], v[32:35]
ds_read_b128 a[56:59], v2 offset:6144
v_cvt_pk_bf16_f32 v49, v18, v19
v_mfma_f32_16x16x32_bf16 v[36:39], a[16:19], a[176:179], v[84:87]
v_exp_f32 v21, v21
v_mfma_f32_16x16x32_bf16 v[36:39], a[20:23], a[180:183], v[36:39]
buffer_load_dwordx4 v3, s[48:51], s32 offen offset:3072 sc1 lds
v_mfma_f32_16x16x32_bf16 v[36:39], a[24:27], a[184:187], v[36:39]
s_add_u32 s32, s32, 0x8000
v_cvt_pk_bf16_f32 v52, v20, v21
v_mfma_f32_16x16x32_bf16 v[36:39], a[28:31], a[188:191], v[36:39]
ds_read_b128 a[60:63], v2 offset:7168
v_mfma_f32_16x16x32_bf16 v[40:43], a[16:19], a[192:195], v[88:91]
v_exp_f32 v22, v22
v_mfma_f32_16x16x32_bf16 v[40:43], a[20:23], a[196:199], v[40:43]
v_exp_f32 v23, v23
v_mfma_f32_16x16x32_bf16 v[40:43], a[24:27], a[200:203], v[40:43]
v_cvt_pk_bf16_f32 v53, v22, v23
v_mfma_f32_16x16x32_bf16 v[40:43], a[28:31], a[204:207], v[40:43]
v_exp_f32 v24, v24
v_mfma_f32_16x16x32_bf16 v[44:47], a[16:19], a[208:211], v[92:95]
v_exp_f32 v25, v25
v_mfma_f32_16x16x32_bf16 v[44:47], a[20:23], a[212:215], v[44:47]
v_exp_f32 v26, v26
v_mfma_f32_16x16x32_bf16 v[44:47], a[24:27], a[216:219], v[44:47]
v_exp_f32 v27, v27
v_mfma_f32_16x16x32_bf16 v[44:47], a[28:31], a[220:223], v[44:47]
s_waitcnt lgkmcnt(0)
v_mfma_f32_16x16x32_bf16 v[128:131], a[32:35], v[64:67], v[128:131]
ds_read_b128 a[0:3], v2 offset:24576
v_cvt_pk_bf16_f32 v56, v24, v25
v_mfma_f32_16x16x32_bf16 v[160:163], a[32:35], v[68:71], v[160:163]
v_exp_f32 v28, v28
v_mfma_f32_16x16x32_bf16 v[192:195], a[32:35], v[72:75], v[192:195]
v_cvt_pk_bf16_f32 v57, v26, v27
v_mfma_f32_16x16x32_bf16 v[224:227], a[32:35], v[76:79], v[224:227]
ds_read_b128 a[4:7], v2 offset:25600
v_mfma_f32_16x16x32_bf16 v[228:231], a[36:39], v[76:79], v[228:231]
v_exp_f32 v29, v29
v_mfma_f32_16x16x32_bf16 v[196:199], a[36:39], v[72:75], v[196:199]
v_exp_f32 v30, v30
v_mfma_f32_16x16x32_bf16 v[164:167], a[36:39], v[68:71], v[164:167]
s_add_u32 m0, s19, 0x1000
v_cvt_pk_bf16_f32 v60, v28, v29
v_mfma_f32_16x16x32_bf16 v[132:135], a[36:39], v[64:67], v[132:135]
buffer_load_dwordx4 v3, s[48:51], s7 offen offset:0 sc1 lds
v_mfma_f32_16x16x32_bf16 v[136:139], a[40:43], v[64:67], v[136:139]
ds_read_b128 a[8:11], v2 offset:26624
v_mfma_f32_16x16x32_bf16 v[168:171], a[40:43], v[68:71], v[168:171]
v_exp_f32 v31, v31
v_mfma_f32_16x16x32_bf16 v[200:203], a[40:43], v[72:75], v[200:203]
v_exp_f32 v32, v32
v_mfma_f32_16x16x32_bf16 v[232:235], a[40:43], v[76:79], v[232:235]
ds_read_b128 a[12:15], v2 offset:27648
v_cvt_pk_bf16_f32 v61, v30, v31
v_mfma_f32_16x16x32_bf16 v[236:239], a[44:47], v[76:79], v[236:239]
v_mfma_f32_16x16x32_bf16 v[204:207], a[44:47], v[72:75], v[204:207]
v_exp_f32 v33, v33
v_mfma_f32_16x16x32_bf16 v[172:175], a[44:47], v[68:71], v[172:175]
v_exp_f32 v34, v34
v_mfma_f32_16x16x32_bf16 v[140:143], a[44:47], v[64:67], v[140:143]
ds_read_b128 a[16:19], v2 offset:28672
v_cvt_pk_bf16_f32 v50, v32, v33
v_mfma_f32_16x16x32_bf16 v[144:147], a[48:51], v[64:67], v[144:147]
v_exp_f32 v35, v35
v_mfma_f32_16x16x32_bf16 v[176:179], a[48:51], v[68:71], v[176:179]
v_cvt_pk_bf16_f32 v51, v34, v35
v_mfma_f32_16x16x32_bf16 v[208:211], a[48:51], v[72:75], v[208:211]
ds_read_b128 a[20:23], v2 offset:29696
v_mfma_f32_16x16x32_bf16 v[240:243], a[48:51], v[76:79], v[240:243]
v_exp_f32 v36, v36
v_mfma_f32_16x16x32_bf16 v[244:247], a[52:55], v[76:79], v[244:247]
v_exp_f32 v37, v37
v_mfma_f32_16x16x32_bf16 v[212:215], a[52:55], v[72:75], v[212:215]
v_cvt_pk_bf16_f32 v54, v36, v37
v_mfma_f32_16x16x32_bf16 v[180:183], a[52:55], v[68:71], v[180:183]
buffer_load_dwordx4 v3, s[48:51], s7 offen offset:1024 sc1 lds
v_mfma_f32_16x16x32_bf16 v[148:151], a[52:55], v[64:67], v[148:151]
ds_read_b128 a[24:27], v2 offset:30720
v_mfma_f32_16x16x32_bf16 v[152:155], a[56:59], v[64:67], v[152:155]
v_exp_f32 v38, v38
v_mfma_f32_16x16x32_bf16 v[184:187], a[56:59], v[68:71], v[184:187]
v_exp_f32 v39, v39
v_mfma_f32_16x16x32_bf16 v[216:219], a[56:59], v[72:75], v[216:219]
ds_read_b128 a[28:31], v2 offset:31744
v_cvt_pk_bf16_f32 v55, v38, v39
v_mfma_f32_16x16x32_bf16 v[248:251], a[56:59], v[76:79], v[248:251]
v_exp_f32 v40, v40
v_mfma_f32_16x16x32_bf16 v[252:255], a[60:63], v[76:79], v[252:255]
v_mfma_f32_16x16x32_bf16 v[220:223], a[60:63], v[72:75], v[220:223]
v_exp_f32 v41, v41
v_mfma_f32_16x16x32_bf16 v[188:191], a[60:63], v[68:71], v[188:191]
ds_read_b128 a[32:35], v2 offset:16384
v_cvt_pk_bf16_f32 v58, v40, v41
v_mfma_f32_16x16x32_bf16 v[156:159], a[60:63], v[64:67], v[156:159]
v_exp_f32 v42, v42
v_smfmac_f32_16x16x64_bf16 a[224:227], a[232:235], v[64:71], v9
s_waitcnt lgkmcnt(5)
v_smfmac_f32_16x16x64_bf16 a[228:231], a[232:235], v[72:79], v9
ds_read_b128 a[36:39], v2 offset:17408
v_mfma_f32_16x16x32_bf16 v[16:19], a[0:3], a[160:163], v[80:83]
v_exp_f32 v43, v43
v_mfma_f32_16x16x32_bf16 v[16:19], a[4:7], a[164:167], v[16:19]
v_exp_f32 v44, v44
v_mfma_f32_16x16x32_bf16 v[16:19], a[8:11], a[168:171], v[16:19]
buffer_load_dwordx4 v3, s[48:51], s7 offen offset:2048 sc1 lds
v_mfma_f32_16x16x32_bf16 v[16:19], a[12:15], a[172:175], v[16:19]
ds_read_b128 a[40:43], v2 offset:18432
v_cvt_pk_bf16_f32 v59, v42, v43
v_mfma_f32_16x16x32_bf16 v[20:23], a[0:3], a[176:179], v[84:87]
v_exp_f32 v45, v45
v_mfma_f32_16x16x32_bf16 v[20:23], a[4:7], a[180:183], v[20:23]
v_cvt_pk_bf16_f32 v62, v44, v45
v_mfma_f32_16x16x32_bf16 v[20:23], a[8:11], a[184:187], v[20:23]
v_exp_f32 v46, v46
v_mfma_f32_16x16x32_bf16 v[20:23], a[12:15], a[188:191], v[20:23]
ds_read_b128 a[44:47], v2 offset:19456
v_mfma_f32_16x16x32_bf16 v[24:27], a[0:3], a[192:195], v[88:91]
v_exp_f32 v47, v47
v_mfma_f32_16x16x32_bf16 v[24:27], a[4:7], a[196:199], v[24:27]
v_cvt_pk_bf16_f32 v63, v46, v47
v_mfma_f32_16x16x32_bf16 v[24:27], a[8:11], a[200:203], v[24:27]
v_exp_f32 v16, v16
v_mfma_f32_16x16x32_bf16 v[24:27], a[12:15], a[204:207], v[24:27]
ds_read_b128 a[48:51], v2 offset:20480
v_mfma_f32_16x16x32_bf16 v[28:31], a[0:3], a[208:211], v[92:95]
v_exp_f32 v17, v17
v_mfma_f32_16x16x32_bf16 v[28:31], a[4:7], a[212:215], v[28:31]
v_exp_f32 v18, v18
v_mfma_f32_16x16x32_bf16 v[28:31], a[8:11], a[216:219], v[28:31]
ds_read_b128 a[52:55], v2 offset:21504
v_cvt_pk_bf16_f32 v64, v16, v17
v_mfma_f32_16x16x32_bf16 v[28:31], a[12:15], a[220:223], v[28:31]
s_waitcnt lgkmcnt(6)
v_mfma_f32_16x16x32_bf16 v[32:35], a[16:19], a[160:163], v[80:83]
v_exp_f32 v19, v19
v_mfma_f32_16x16x32_bf16 v[32:35], a[20:23], a[164:167], v[32:35]
buffer_load_dwordx4 v3, s[48:51], s7 offen offset:3072 sc1 lds
v_mfma_f32_16x16x32_bf16 v[32:35], a[24:27], a[168:171], v[32:35]
ds_read_b128 a[56:59], v2 offset:22528
v_cvt_pk_bf16_f32 v65, v18, v19
v_mfma_f32_16x16x32_bf16 v[32:35], a[28:31], a[172:175], v[32:35]
s_add_u32 s7, s7, 0x8000
v_exp_f32 v20, v20
v_mfma_f32_16x16x32_bf16 v[36:39], a[16:19], a[176:179], v[84:87]
s_xor_b32 s19, s19, 0x8000
v_mfma_f32_16x16x32_bf16 v[36:39], a[20:23], a[180:183], v[36:39]
s_sub_u32 s15, s15, 1
v_exp_f32 v21, v21
v_mfma_f32_16x16x32_bf16 v[36:39], a[24:27], a[184:187], v[36:39]
ds_read_b128 a[60:63], v2 offset:23552
v_xor_b32 v2, 0x38000, v2
v_mfma_f32_16x16x32_bf16 v[36:39], a[28:31], a[188:191], v[36:39]
s_cmp_lg_u32 s15, 0
v_exp_f32 v22, v22
v_mfma_f32_16x16x32_bf16 v[40:43], a[16:19], a[192:195], v[88:91]
v_exp_f32 v23, v23
v_mfma_f32_16x16x32_bf16 v[40:43], a[20:23], a[196:199], v[40:43]
v_cvt_pk_bf16_f32 v68, v20, v21
v_cvt_pk_bf16_f32 v69, v22, v23
v_mfma_f32_16x16x32_bf16 v[40:43], a[24:27], a[200:203], v[40:43]
v_exp_f32 v24, v24
v_mfma_f32_16x16x32_bf16 v[40:43], a[28:31], a[204:207], v[40:43]
v_exp_f32 v25, v25
v_mfma_f32_16x16x32_bf16 v[44:47], a[16:19], a[208:211], v[92:95]
s_waitcnt vmcnt(16) lgkmcnt(0)
v_exp_f32 v26, v26
v_mfma_f32_16x16x32_bf16 v[44:47], a[20:23], a[212:215], v[44:47]
s_barrier
v_exp_f32 v27, v27
v_mfma_f32_16x16x32_bf16 v[44:47], a[24:27], a[216:219], v[44:47]
v_mfma_f32_16x16x32_bf16 v[44:47], a[28:31], a[220:223], v[44:47]
s_cbranch_scc1 L_att_deven1
L_att_ddone:
s_cmp_ge_u32 s4, 2
s_cbranch_scc1 L_att_dl0_1
L_att_dl0_0:
v_mfma_f32_16x16x32_bf16 v[128:131], a[32:35], v[48:51], v[128:131]
ds_read_b128 a[0:3], v1 offset:8192
v_cvt_pk_bf16_f32 v72, v24, v25
v_mfma_f32_16x16x32_bf16 v[160:163], a[32:35], v[52:55], v[160:163]
v_exp_f32 v28, v28
v_mfma_f32_16x16x32_bf16 v[192:195], a[32:35], v[56:59], v[192:195]
v_cvt_pk_bf16_f32 v73, v26, v27
v_mfma_f32_16x16x32_bf16 v[224:227], a[32:35], v[60:63], v[224:227]
ds_read_b128 a[4:7], v1 offset:9216
v_mfma_f32_16x16x32_bf16 v[228:231], a[36:39], v[60:63], v[228:231]
s_add_u32 m0, s27, 0x0
v_exp_f32 v29, v29
v_mfma_f32_16x16x32_bf16 v[196:199], a[36:39], v[56:59], v[196:199]
buffer_load_dwordx4 v3, s[48:51], s32 offen offset:0 sc1 lds
v_mfma_f32_16x16x32_bf16 v[164:167], a[36:39], v[52:55], v[164:167]
v_exp_f32 v30, v30
v_mfma_f32_16x16x32_bf16 v[132:135], a[36:39], v[48:51], v[132:135]
ds_read_b128 a[8:11], v1 offset:10240
v_cvt_pk_bf16_f32 v76, v28, v29
v_mfma_f32_16x16x32_bf16 v[136:139], a[40:43], v[48:51], v[136:139]
v_mfma_f32_16x16x32_bf16 v[168:171], a[40:43], v[52:55], v[168:171]
v_exp_f32 v31, v31
v_mfma_f32_16x16x32_bf16 v[200:203], a[40:43], v[56:59], v[200:203]
v_exp_f32 v32, v32
v_mfma_f32_16x16x32_bf16 v[232:235], a[40:43], v[60:63], v[232:235]
ds_read_b128 a[12:15], v1 offset:11264
v_cvt_pk_bf16_f32 v77, v30, v31
v_mfma_f32_16x16x32_bf16 v[236:239], a[44:47], v[60:63], v[236:239]
v_exp_f32 v33, v33
v_mfma_f32_16x16x32_bf16 v[204:207], a[44:47], v[56:59], v[204:207]
v_cvt_pk_bf16_f32 v66, v32, v33
v_mfma_f32_16x16x32_bf16 v[172:175], a[44:47], v[52:55], v[172:175]
s_mov_b32 s9, 0x0
v_exp_f32 v34, v34
v_mfma_f32_16x16x32_bf16 v[140:143], a[44:47], v[48:51], v[140:143]
ds_read_b128 a[16:19], v1 offset:12288
v_mfma_f32_16x16x32_bf16 v[144:147], a[48:51], v[48:51], v[144:147]
buffer_load_dword a244, v8, s[72:75], s9 offen
v_mfma_f32_16x16x32_bf16 v[176:179], a[48:51], v[52:55], v[176:179]
v_exp_f32 v35, v35
v_mfma_f32_16x16x32_bf16 v[208:211], a[48:51], v[56:59], v[208:211]
v_exp_f32 v36, v36
v_mfma_f32_16x16x32_bf16 v[240:243], a[48:51], v[60:63], v[240:243]
ds_read_b128 a[20:23], v1 offset:13312
v_cvt_pk_bf16_f32 v67, v34, v35
v_mfma_f32_16x16x32_bf16 v[244:247], a[52:55], v[60:63], v[244:247]
v_mfma_f32_16x16x32_bf16 v[212:215], a[52:55], v[56:59], v[212:215]
v_exp_f32 v37, v37
v_mfma_f32_16x16x32_bf16 v[180:183], a[52:55], v[52:55], v[180:183]
ds_read_b128 a[24:27], v1 offset:14336
v_cvt_pk_bf16_f32 v70, v36, v37
v_mfma_f32_16x16x32_bf16 v[148:151], a[52:55], v[48:51], v[148:151]
v_exp_f32 v38, v38
v_mfma_f32_16x16x32_bf16 v[152:155], a[56:59], v[48:51], v[152:155]
v_mfma_f32_16x16x32_bf16 v[184:187], a[56:59], v[52:55], v[184:187]
v_exp_f32 v39, v39
v_mfma_f32_16x16x32_bf16 v[216:219], a[56:59], v[56:59], v[216:219]
buffer_load_dwordx4 v3, s[48:51], s32 offen offset:1024 sc1 lds
v_mfma_f32_16x16x32_bf16 v[248:251], a[56:59], v[60:63], v[248:251]
ds_read_b128 a[28:31], v1 offset:15360
v_cvt_pk_bf16_f32 v71, v38, v39
v_mfma_f32_16x16x32_bf16 v[252:255], a[60:63], v[60:63], v[252:255]
v_exp_f32 v40, v40
v_mfma_f32_16x16x32_bf16 v[220:223], a[60:63], v[56:59], v[220:223]
v_exp_f32 v41, v41
v_mfma_f32_16x16x32_bf16 v[188:191], a[60:63], v[52:55], v[188:191]
ds_read_b128 a[32:35], v1 offset:0
v_cvt_pk_bf16_f32 v74, v40, v41
v_mfma_f32_16x16x32_bf16 v[156:159], a[60:63], v[48:51], v[156:159]
v_smfmac_f32_16x16x64_bf16 a[224:227], a[232:235], v[48:55], v9
v_exp_f32 v42, v42
v_smfmac_f32_16x16x64_bf16 a[228:231], a[232:235], v[56:63], v9
s_waitcnt lgkmcnt(5)
v_exp_f32 v43, v43
v_mfma_f32_16x16x32_bf16 v[16:19], a[0:3], a[160:163], v[96:99]
ds_read_b128 a[36:39], v1 offset:1024
v_cvt_pk_bf16_f32 v75, v42, v43
v_mfma_f32_16x16x32_bf16 v[16:19], a[4:7], a[164:167], v[16:19]
v_exp_f32 v44, v44
v_mfma_f32_16x16x32_bf16 v[16:19], a[8:11], a[168:171], v[16:19]
v_mfma_f32_16x16x32_bf16 v[16:19], a[12:15], a[172:175], v[16:19]
buffer_load_dwordx4 v3, s[48:51], s32 offen offset:2048 sc1 lds
v_mfma_f32_16x16x32_bf16 v[20:23], a[0:3], a[176:179], v[84:87]
ds_read_b128 a[40:43], v1 offset:2048
v_mfma_f32_16x16x32_bf16 v[20:23], a[4:7], a[180:183], v[20:23]
v_exp_f32 v45, v45
v_mfma_f32_16x16x32_bf16 v[20:23], a[8:11], a[184:187], v[20:23]
v_exp_f32 v46, v46
v_mfma_f32_16x16x32_bf16 v[20:23], a[12:15], a[188:191], v[20:23]
ds_read_b128 a[44:47], v1 offset:3072
v_cvt_pk_bf16_f32 v78, v44, v45
v_mfma_f32_16x16x32_bf16 v[24:27], a[0:3], a[192:195], v[88:91]
v_mfma_f32_16x16x32_bf16 v[24:27], a[4:7], a[196:199], v[24:27]
v_exp_f32 v47, v47
v_mfma_f32_16x16x32_bf16 v[24:27], a[8:11], a[200:203], v[24:27]
v_exp_f32 v16, v16
v_mfma_f32_16x16x32_bf16 v[24:27], a[12:15], a[204:207], v[24:27]
ds_read_b128 a[48:51], v1 offset:4096
v_cvt_pk_bf16_f32 v79, v46, v47
v_mfma_f32_16x16x32_bf16 v[28:31], a[0:3], a[208:211], v[92:95]
v_exp_f32 v17, v17
v_mfma_f32_16x16x32_bf16 v[28:31], a[4:7], a[212:215], v[28:31]
s_waitcnt lgkmcnt(5)
v_cvt_pk_bf16_f32 v48, v16, v17
v_mfma_f32_16x16x32_bf16 v[28:31], a[8:11], a[216:219], v[28:31]
buffer_load_dwordx4 v3, s[48:51], s32 offen offset:3072 sc1 lds
v_mfma_f32_16x16x32_bf16 v[28:31], a[12:15], a[220:223], v[28:31]
ds_read_b128 a[52:55], v1 offset:5120
v_mfma_f32_16x16x32_bf16 v[32:35], a[16:19], a[160:163], v[100:103]
v_exp_f32 v18, v18
v_mfma_f32_16x16x32_bf16 v[32:35], a[20:23], a[164:167], v[32:35]
v_exp_f32 v19, v19
v_mfma_f32_16x16x32_bf16 v[32:35], a[24:27], a[168:171], v[32:35]
v_exp_f32 v20, v20
v_mfma_f32_16x16x32_bf16 v[32:35], a[28:31], a[172:175], v[32:35]
ds_read_b128 a[56:59], v1 offset:6144
v_cvt_pk_bf16_f32 v49, v18, v19
v_mfma_f32_16x16x32_bf16 v[36:39], a[16:19], a[176:179], v[84:87]
v_mfma_f32_16x16x32_bf16 v[36:39], a[20:23], a[180:183], v[36:39]
v_exp_f32 v21, v21
v_mfma_f32_16x16x32_bf16 v[36:39], a[24:27], a[184:187], v[36:39]
s_mov_b32 s9, 0x0
v_exp_f32 v22, v22
v_mfma_f32_16x16x32_bf16 v[36:39], a[28:31], a[188:191], v[36:39]
ds_read_b128 a[60:63], v1 offset:7168
v_cvt_pk_bf16_f32 v52, v20, v21
v_mfma_f32_16x16x32_bf16 v[40:43], a[16:19], a[192:195], v[88:91]
buffer_load_dword a244, v8, s[64:67], s9 offen
v_mfma_f32_16x16x32_bf16 v[40:43], a[20:23], a[196:199], v[40:43]
v_mfma_f32_16x16x32_bf16 v[40:43], a[24:27], a[200:203], v[40:43]
v_exp_f32 v23, v23
v_mfma_f32_16x16x32_bf16 v[40:43], a[28:31], a[204:207], v[40:43]
v_exp_f32 v24, v24
v_mfma_f32_16x16x32_bf16 v[44:47], a[16:19], a[208:211], v[92:95]
v_exp_f32 v25, v25
v_mfma_f32_16x16x32_bf16 v[44:47], a[20:23], a[212:215], v[44:47]
v_exp_f32 v26, v26
v_mfma_f32_16x16x32_bf16 v[44:47], a[24:27], a[216:219], v[44:47]
v_exp_f32 v27, v27
v_mfma_f32_16x16x32_bf16 v[44:47], a[28:31], a[220:223], v[44:47]
s_waitcnt lgkmcnt(0)
v_cvt_pk_bf16_f32 v53, v22, v23
v_mfma_f32_16x16x32_bf16 v[128:131], a[32:35], v[64:67], v[128:131]
ds_read_b128 a[0:3], v1 offset:24576
v_cvt_pk_bf16_f32 v56, v24, v25
v_mfma_f32_16x16x32_bf16 v[160:163], a[32:35], v[68:71], v[160:163]
v_exp_f32 v28, v28
v_mfma_f32_16x16x32_bf16 v[192:195], a[32:35], v[72:75], v[192:195]
v_cvt_pk_bf16_f32 v57, v26, v27
v_mfma_f32_16x16x32_bf16 v[224:227], a[32:35], v[76:79], v[224:227]
ds_read_b128 a[4:7], v1 offset:25600
v_mfma_f32_16x16x32_bf16 v[228:231], a[36:39], v[76:79], v[228:231]
s_add_u32 m0, s27, 0x1000
v_exp_f32 v29, v29
v_mfma_f32_16x16x32_bf16 v[196:199], a[36:39], v[72:75], v[196:199]
buffer_load_dwordx4 v3, s[48:51], s7 offen offset:0 sc1 lds
v_mfma_f32_16x16x32_bf16 v[164:167], a[36:39], v[68:71], v[164:167]
ds_read_b128 a[8:11], v1 offset:26624
v_cvt_pk_bf16_f32 v60, v28, v29
v_mfma_f32_16x16x32_bf16 v[132:135], a[36:39], v[64:67], v[132:135]
v_exp_f32 v30, v30
v_mfma_f32_16x16x32_bf16 v[136:139], a[40:43], v[64:67], v[136:139]
v_exp_f32 v31, v31
v_mfma_f32_16x16x32_bf16 v[168:171], a[40:43], v[68:71], v[168:171]
ds_read_b128 a[12:15], v1 offset:27648
v_cvt_pk_bf16_f32 v61, v30, v31
v_mfma_f32_16x16x32_bf16 v[200:203], a[40:43], v[72:75], v[200:203]
v_mfma_f32_16x16x32_bf16 v[232:235], a[40:43], v[76:79], v[232:235]
v_exp_f32 v32, v32
v_mfma_f32_16x16x32_bf16 v[236:239], a[44:47], v[76:79], v[236:239]
v_exp_f32 v33, v33
v_mfma_f32_16x16x32_bf16 v[204:207], a[44:47], v[72:75], v[204:207]
ds_read_b128 a[16:19], v1 offset:28672
v_cvt_pk_bf16_f32 v50, v32, v33
v_mfma_f32_16x16x32_bf16 v[172:175], a[44:47], v[68:71], v[172:175]
v_exp_f32 v34, v34
v_mfma_f32_16x16x32_bf16 v[140:143], a[44:47], v[64:67], v[140:143]
buffer_load_dwordx4 v3, s[48:51], s7 offen offset:1024 sc1 lds
v_mfma_f32_16x16x32_bf16 v[144:147], a[48:51], v[64:67], v[144:147]
ds_read_b128 a[20:23], v1 offset:29696
v_mfma_f32_16x16x32_bf16 v[176:179], a[48:51], v[68:71], v[176:179]
v_mfma_f32_16x16x32_bf16 v[208:211], a[48:51], v[72:75], v[208:211]
v_exp_f32 v35, v35
v_mfma_f32_16x16x32_bf16 v[240:243], a[48:51], v[76:79], v[240:243]
ds_read_b128 a[24:27], v1 offset:30720
v_cvt_pk_bf16_f32 v51, v34, v35
v_mfma_f32_16x16x32_bf16 v[244:247], a[52:55], v[76:79], v[244:247]
v_exp_f32 v36, v36
v_mfma_f32_16x16x32_bf16 v[212:215], a[52:55], v[72:75], v[212:215]
v_exp_f32 v37, v37
v_mfma_f32_16x16x32_bf16 v[180:183], a[52:55], v[68:71], v[180:183]
ds_read_b128 a[28:31], v1 offset:31744
v_cvt_pk_bf16_f32 v54, v36, v37
v_mfma_f32_16x16x32_bf16 v[148:151], a[52:55], v[64:67], v[148:151]
v_mfma_f32_16x16x32_bf16 v[152:155], a[56:59], v[64:67], v[152:155]
v_exp_f32 v38, v38
v_mfma_f32_16x16x32_bf16 v[184:187], a[56:59], v[68:71], v[184:187]
v_exp_f32 v39, v39
v_mfma_f32_16x16x32_bf16 v[216:219], a[56:59], v[72:75], v[216:219]
buffer_load_dwordx4 v3, s[48:51], s7 offen offset:2048 sc1 lds
v_mfma_f32_16x16x32_bf16 v[248:251], a[56:59], v[76:79], v[248:251]
ds_read_b128 a[32:35], v1 offset:16384
v_cvt_pk_bf16_f32 v55, v38, v39
v_mfma_f32_16x16x32_bf16 v[252:255], a[60:63], v[76:79], v[252:255]
v_exp_f32 v40, v40
v_mfma_f32_16x16x32_bf16 v[220:223], a[60:63], v[72:75], v[220:223]
ds_read_b128 a[36:39], v1 offset:17408
v_mfma_f32_16x16x32_bf16 v[188:191], a[60:63], v[68:71], v[188:191]
v_mfma_f32_16x16x32_bf16 v[156:159], a[60:63], v[64:67], v[156:159]
v_exp_f32 v41, v41
v_smfmac_f32_16x16x64_bf16 a[224:227], a[232:235], v[64:71], v9
ds_read_b128 a[40:43], v1 offset:18432
v_cvt_pk_bf16_f32 v58, v40, v41
v_smfmac_f32_16x16x64_bf16 a[228:231], a[232:235], v[72:79], v9
s_waitcnt lgkmcnt(7)
v_exp_f32 v42, v42
v_mfma_f32_16x16x32_bf16 v[20:23], a[0:3], a[176:179], v[84:87]
s_mov_b32 s9, 0x400000
v_exp_f32 v43, v43
v_mfma_f32_16x16x32_bf16 v[20:23], a[4:7], a[180:183], v[20:23]
ds_read_b128 a[44:47], v1 offset:19456
v_cvt_pk_bf16_f32 v59, v42, v43
v_mfma_f32_16x16x32_bf16 v[20:23], a[8:11], a[184:187], v[20:23]
buffer_load_dword a244, v8, s[64:67], s9 offen
v_mfma_f32_16x16x32_bf16 v[20:23], a[12:15], a[188:191], v[20:23]
v_mfma_f32_16x16x32_bf16 v[24:27], a[0:3], a[192:195], v[88:91]
v_exp_f32 v44, v44
v_mfma_f32_16x16x32_bf16 v[24:27], a[4:7], a[196:199], v[24:27]
ds_read_b128 a[48:51], v1 offset:20480
v_mfma_f32_16x16x32_bf16 v[24:27], a[8:11], a[200:203], v[24:27]
v_exp_f32 v45, v45
v_mfma_f32_16x16x32_bf16 v[24:27], a[12:15], a[204:207], v[24:27]
v_exp_f32 v46, v46
v_mfma_f32_16x16x32_bf16 v[28:31], a[0:3], a[208:211], v[92:95]
ds_read_b128 a[52:55], v1 offset:21504
v_cvt_pk_bf16_f32 v62, v44, v45
v_mfma_f32_16x16x32_bf16 v[28:31], a[4:7], a[212:215], v[28:31]
v_mfma_f32_16x16x32_bf16 v[28:31], a[8:11], a[216:219], v[28:31]
s_waitcnt lgkmcnt(6)
v_exp_f32 v47, v47
v_mfma_f32_16x16x32_bf16 v[28:31], a[12:15], a[220:223], v[28:31]
ds_read_b128 a[56:59], v1 offset:22528
v_cvt_pk_bf16_f32 v63, v46, v47
v_mfma_f32_16x16x32_bf16 v[36:39], a[16:19], a[176:179], v[84:87]
buffer_load_dwordx4 v3, s[48:51], s7 offen offset:3072 sc1 lds
v_mfma_f32_16x16x32_bf16 v[36:39], a[20:23], a[180:183], v[36:39]
s_add_u32 s32, s32, 0x8000
v_exp_f32 v20, v20
v_mfma_f32_16x16x32_bf16 v[36:39], a[24:27], a[184:187], v[36:39]
ds_read_b128 a[60:63], v1 offset:23552
v_xor_b32 v1, 0x8000, v1
v_mfma_f32_16x16x32_bf16 v[36:39], a[28:31], a[188:191], v[36:39]
s_add_u32 s7, s7, 0x8000
v_exp_f32 v21, v21
v_mfma_f32_16x16x32_bf16 v[40:43], a[16:19], a[192:195], v[88:91]
s_xor_b32 s27, s27, 0x38000
v_cvt_pk_bf16_f32 v68, v20, v21
v_mfma_f32_16x16x32_bf16 v[40:43], a[20:23], a[196:199], v[40:43]
v_exp_f32 v22, v22
v_mfma_f32_16x16x32_bf16 v[40:43], a[24:27], a[200:203], v[40:43]
v_exp_f32 v23, v23
v_mfma_f32_16x16x32_bf16 v[40:43], a[28:31], a[204:207], v[40:43]
v_exp_f32 v24, v24
v_mfma_f32_16x16x32_bf16 v[44:47], a[16:19], a[208:211], v[92:95]
v_exp_f32 v25, v25
v_mfma_f32_16x16x32_bf16 v[44:47], a[20:23], a[212:215], v[44:47]
v_exp_f32 v26, v26
v_mfma_f32_16x16x32_bf16 v[44:47], a[24:27], a[216:219], v[44:47]
s_waitcnt vmcnt(19) lgkmcnt(0)
v_exp_f32 v27, v27
v_mfma_f32_16x16x32_bf16 v[44:47], a[28:31], a[220:223], v[44:47]
s_barrier
v_cvt_pk_bf16_f32 v69, v22, v23
L_att_l1_0:
v_mfma_f32_16x16x32_bf16 v[128:131], a[32:35], v[48:51], v[128:131]
ds_read_b128 a[0:3], v2 offset:8192
v_cvt_pk_bf16_f32 v72, v24, v25
v_mfma_f32_16x16x32_bf16 v[160:163], a[32:35], v[52:55], v[160:163]
s_lshr_b32 s44, s2, 6
v_exp_f32 v28, v28
v_mfma_f32_16x16x32_bf16 v[192:195], a[32:35], v[56:59], v[192:195]
s_add_u32 m0, s19, 0x0
s_lshl_b32 s45, s44, 1
v_cvt_pk_bf16_f32 v73, v26, v27
v_mfma_f32_16x16x32_bf16 v[224:227], a[32:35], v[60:63], v[224:227]
ds_read_b128 a[4:7], v2 offset:9216
s_add_u32 s45, s45, s100
v_mfma_f32_16x16x32_bf16 v[228:231], a[36:39], v[60:63], v[228:231]
buffer_load_dwordx4 v3, s[48:51], s32 offen offset:0 sc1 lds
v_mfma_f32_16x16x32_bf16 v[196:199], a[36:39], v[56:59], v[196:199]
s_and_b32 s60, s45, 3
v_exp_f32 v29, v29
v_mfma_f32_16x16x32_bf16 v[164:167], a[36:39], v[52:55], v[164:167]
ds_read_b128 a[8:11], v2 offset:10240
v_cvt_pk_bf16_f32 v76, v28, v29
v_mfma_f32_16x16x32_bf16 v[132:135], a[36:39], v[48:51], v[132:135]
s_sub_u32 s60, s60, s44
v_exp_f32 v30, v30
v_mfma_f32_16x16x32_bf16 v[136:139], a[40:43], v[48:51], v[136:139]
s_add_u32 s60, s60, 4
s_lshl_b32 s60, s60, 14
s_and_b32 s60, s60, 0x7c000
v_mfma_f32_16x16x32_bf16 v[168:171], a[40:43], v[52:55], v[168:171]
ds_read_b128 a[12:15], v2 offset:11264
s_lshl_b32 s61, s60, 3
v_mfma_f32_16x16x32_bf16 v[200:203], a[40:43], v[56:59], v[200:203]
s_add_u32 s62, s61, s12
v_exp_f32 v31, v31
v_mfma_f32_16x16x32_bf16 v[232:235], a[40:43], v[60:63], v[232:235]
s_mul_i32 s44, s44, -8
v_exp_f32 v36, v36
v_mfma_f32_16x16x32_bf16 v[236:239], a[44:47], v[60:63], v[236:239]
s_mov_b32 s9, 0x200000
s_lshl_b32 s44, 4, s44
v_cvt_pk_bf16_f32 v77, v30, v31
v_mfma_f32_16x16x32_bf16 v[204:207], a[44:47], v[56:59], v[204:207]
ds_read_b128 a[16:19], v2 offset:12288
s_mul_i32 s45, s45, -8
v_mfma_f32_16x16x32_bf16 v[172:175], a[44:47], v[52:55], v[172:175]
buffer_load_dword a244, v8, s[64:67], s9 offen
v_mfma_f32_16x16x32_bf16 v[140:143], a[44:47], v[48:51], v[140:143]
s_lshl_b32 s45, 4, s45
v_exp_f32 v37, v37
v_mfma_f32_16x16x32_bf16 v[144:147], a[48:51], v[48:51], v[144:147]
ds_read_b128 a[20:23], v2 offset:13312
v_cvt_pk_bf16_f32 v70, v36, v37
v_mfma_f32_16x16x32_bf16 v[176:179], a[48:51], v[52:55], v[176:179]
s_add_u32 s44, s44, 0x21212121
v_exp_f32 v38, v38
v_mfma_f32_16x16x32_bf16 v[208:211], a[48:51], v[56:59], v[208:211]
s_sub_u32 s44, s44, s45
s_bfe_u32 s56, s44, 0x80000
s_lshl_b32 s56, s56, 14
v_mfma_f32_16x16x32_bf16 v[240:243], a[48:51], v[60:63], v[240:243]
ds_read_b128 a[24:27], v2 offset:14336
s_bfe_u32 s57, s44, 0x80008
v_mfma_f32_16x16x32_bf16 v[244:247], a[52:55], v[60:63], v[244:247]
s_lshl_b32 s57, s57, 14
v_exp_f32 v39, v39
v_mfma_f32_16x16x32_bf16 v[212:215], a[52:55], v[56:59], v[212:215]
s_bfe_u32 s58, s44, 0x80010
v_exp_f32 v40, v40
v_mfma_f32_16x16x32_bf16 v[180:183], a[52:55], v[52:55], v[180:183]
s_lshl_b32 s58, s58, 14
s_bfe_u32 s59, s44, 0x80018
v_cvt_pk_bf16_f32 v71, v38, v39
v_mfma_f32_16x16x32_bf16 v[148:151], a[52:55], v[48:51], v[148:151]
buffer_load_dwordx4 v3, s[48:51], s32 offen offset:1024 sc1 lds
v_mfma_f32_16x16x32_bf16 v[152:155], a[56:59], v[48:51], v[152:155]
ds_read_b128 a[28:31], v2 offset:15360
s_lshl_b32 s59, s59, 14
v_mfma_f32_16x16x32_bf16 v[184:187], a[56:59], v[52:55], v[184:187]
v_exp_f32 v41, v41
v_mfma_f32_16x16x32_bf16 v[216:219], a[56:59], v[56:59], v[216:219]
ds_read_b128 a[32:35], v2 offset:0
v_cvt_pk_bf16_f32 v74, v40, v41
v_mfma_f32_16x16x32_bf16 v[248:251], a[56:59], v[60:63], v[248:251]
v_exp_f32 v42, v42
v_mfma_f32_16x16x32_bf16 v[252:255], a[60:63], v[60:63], v[252:255]
v_mfma_f32_16x16x32_bf16 v[220:223], a[60:63], v[56:59], v[220:223]
ds_read_b128 a[36:39], v2 offset:1024
v_mfma_f32_16x16x32_bf16 v[188:191], a[60:63], v[52:55], v[188:191]
v_exp_f32 v43, v43
v_mfma_f32_16x16x32_bf16 v[156:159], a[60:63], v[48:51], v[156:159]
s_waitcnt lgkmcnt(6)
v_exp_f32 v44, v44
v_smfmac_f32_16x16x64_bf16 a[224:227], a[232:235], v[48:55], v9
buffer_load_dwordx4 v3, s[48:51], s32 offen offset:2048 sc1 lds
v_smfmac_f32_16x16x64_bf16 a[228:231], a[232:235], v[56:63], v9
ds_read_b128 a[40:43], v2 offset:2048
v_cvt_pk_bf16_f32 v75, v42, v43
v_mfma_f32_16x16x32_bf16 v[20:23], a[0:3], a[176:179], v[84:87]
v_mfma_f32_16x16x32_bf16 v[20:23], a[4:7], a[180:183], v[20:23]
v_exp_f32 v45, v45
v_mfma_f32_16x16x32_bf16 v[20:23], a[8:11], a[184:187], v[20:23]
ds_read_b128 a[44:47], v2 offset:3072
v_cvt_pk_bf16_f32 v78, v44, v45
v_mfma_f32_16x16x32_bf16 v[20:23], a[12:15], a[188:191], v[20:23]
v_exp_f32 v46, v46
v_mfma_f32_16x16x32_bf16 v[24:27], a[0:3], a[192:195], v[88:91]
v_mfma_f32_16x16x32_bf16 v[24:27], a[4:7], a[196:199], v[24:27]
ds_read_b128 a[48:51], v2 offset:4096
v_mfma_f32_16x16x32_bf16 v[24:27], a[8:11], a[200:203], v[24:27]
v_exp_f32 v47, v47
v_mfma_f32_16x16x32_bf16 v[24:27], a[12:15], a[204:207], v[24:27]
s_nop 0
v_exp_f32 v20, v20
v_mfma_f32_16x16x32_bf16 v[28:31], a[0:3], a[208:211], v[92:95]
buffer_load_dwordx4 v3, s[48:51], s32 offen offset:3072 sc1 lds
v_mfma_f32_16x16x32_bf16 v[28:31], a[4:7], a[212:215], v[28:31]
ds_read_b128 a[52:55], v2 offset:5120
v_cvt_pk_bf16_f32 v79, v46, v47
v_mfma_f32_16x16x32_bf16 v[28:31], a[8:11], a[216:219], v[28:31]
v_mfma_f32_16x16x32_bf16 v[28:31], a[12:15], a[220:223], v[28:31]
s_waitcnt lgkmcnt(6)
v_exp_f32 v21, v21
v_mfma_f32_16x16x32_bf16 v[36:39], a[16:19], a[176:179], v[84:87]
ds_read_b128 a[56:59], v2 offset:6144
v_cvt_pk_bf16_f32 v52, v20, v21
v_mfma_f32_16x16x32_bf16 v[36:39], a[20:23], a[180:183], v[36:39]
v_exp_f32 v22, v22
v_mfma_f32_16x16x32_bf16 v[36:39], a[24:27], a[184:187], v[36:39]
v_mfma_f32_16x16x32_bf16 v[36:39], a[28:31], a[188:191], v[36:39]
ds_read_b128 a[60:63], v2 offset:7168
v_mfma_f32_16x16x32_bf16 v[40:43], a[16:19], a[192:195], v[88:91]
s_mov_b32 s9, 0x600000
v_exp_f32 v23, v23
v_mfma_f32_16x16x32_bf16 v[40:43], a[20:23], a[196:199], v[40:43]
buffer_load_dword a244, v8, s[64:67], s9 offen
v_mfma_f32_16x16x32_bf16 v[40:43], a[24:27], a[200:203], v[40:43]
v_exp_f32 v24, v24
v_mfma_f32_16x16x32_bf16 v[40:43], a[28:31], a[204:207], v[40:43]
v_cvt_pk_bf16_f32 v53, v22, v23
v_mfma_f32_16x16x32_bf16 v[44:47], a[16:19], a[208:211], v[92:95]
v_exp_f32 v25, v25
v_mfma_f32_16x16x32_bf16 v[44:47], a[20:23], a[212:215], v[44:47]
v_exp_f32 v26, v26
v_mfma_f32_16x16x32_bf16 v[44:47], a[24:27], a[216:219], v[44:47]
v_exp_f32 v27, v27
v_mfma_f32_16x16x32_bf16 v[44:47], a[28:31], a[220:223], v[44:47]
s_waitcnt lgkmcnt(0)
v_mfma_f32_16x16x32_bf16 v[160:163], a[32:35], v[68:71], v[160:163]
ds_read_b128 a[0:3], v2 offset:24576
v_cvt_pk_bf16_f32 v56, v24, v25
v_mfma_f32_16x16x32_bf16 v[192:195], a[32:35], v[72:75], v[192:195]
v_exp_f32 v28, v28
v_mfma_f32_16x16x32_bf16 v[224:227], a[32:35], v[76:79], v[224:227]
ds_read_b128 a[4:7], v2 offset:25600
v_cvt_pk_bf16_f32 v57, v26, v27
v_mfma_f32_16x16x32_bf16 v[228:231], a[36:39], v[76:79], v[228:231]
s_add_u32 m0, s19, 0x1000
v_mfma_f32_16x16x32_bf16 v[196:199], a[36:39], v[72:75], v[196:199]
buffer_load_dwordx4 v3, s[48:51], s7 offen offset:0 sc1 lds
v_mfma_f32_16x16x32_bf16 v[164:167], a[36:39], v[68:71], v[164:167]
ds_read_b128 a[8:11], v2 offset:26624
v_mfma_f32_16x16x32_bf16 v[168:171], a[40:43], v[68:71], v[168:171]
v_exp_f32 v29, v29
v_mfma_f32_16x16x32_bf16 v[200:203], a[40:43], v[72:75], v[200:203]
v_exp_f32 v30, v30
v_mfma_f32_16x16x32_bf16 v[232:235], a[40:43], v[76:79], v[232:235]
ds_read_b128 a[12:15], v2 offset:27648
v_cvt_pk_bf16_f32 v60, v28, v29
v_mfma_f32_16x16x32_bf16 v[236:239], a[44:47], v[76:79], v[236:239]
v_exp_f32 v31, v31
v_mfma_f32_16x16x32_bf16 v[204:207], a[44:47], v[72:75], v[204:207]
v_exp_f32 v36, v36
v_mfma_f32_16x16x32_bf16 v[172:175], a[44:47], v[68:71], v[172:175]
ds_read_b128 a[16:19], v2 offset:28672
v_cvt_pk_bf16_f32 v61, v30, v31
v_mfma_f32_16x16x32_bf16 v[176:179], a[48:51], v[68:71], v[176:179]
buffer_load_dwordx4 v3, s[48:51], s7 offen offset:1024 sc1 lds
v_mfma_f32_16x16x32_bf16 v[208:211], a[48:51], v[72:75], v[208:211]
ds_read_b128 a[20:23], v2 offset:29696
v_mfma_f32_16x16x32_bf16 v[240:243], a[48:51], v[76:79], v[240:243]
v_mfma_f32_16x16x32_bf16 v[244:247], a[52:55], v[76:79], v[244:247]
v_exp_f32 v37, v37
v_mfma_f32_16x16x32_bf16 v[212:215], a[52:55], v[72:75], v[212:215]
ds_read_b128 a[24:27], v2 offset:30720
v_cvt_pk_bf16_f32 v54, v36, v37
v_mfma_f32_16x16x32_bf16 v[180:183], a[52:55], v[68:71], v[180:183]
v_exp_f32 v38, v38
v_mfma_f32_16x16x32_bf16 v[184:187], a[56:59], v[68:71], v[184:187]
v_exp_f32 v39, v39
v_mfma_f32_16x16x32_bf16 v[216:219], a[56:59], v[72:75], v[216:219]
ds_read_b128 a[28:31], v2 offset:31744
v_cvt_pk_bf16_f32 v55, v38, v39
v_mfma_f32_16x16x32_bf16 v[248:251], a[56:59], v[76:79], v[248:251]
v_exp_f32 v40, v40
v_mfma_f32_16x16x32_bf16 v[252:255], a[60:63], v[76:79], v[252:255]
buffer_load_dwordx4 v3, s[48:51], s7 offen offset:2048 sc1 lds
v_mfma_f32_16x16x32_bf16 v[220:223], a[60:63], v[72:75], v[220:223]
ds_read_b128 a[32:35], v2 offset:16384
v_mfma_f32_16x16x32_bf16 v[188:191], a[60:63], v[68:71], v[188:191]
v_exp_f32 v41, v41
v_mfma_f32_16x16x32_bf16 a[224:227], a[236:239], v[68:71], a[224:227]
ds_read_b128 a[36:39], v2 offset:17408
v_cvt_pk_bf16_f32 v58, v40, v41
v_smfmac_f32_16x16x64_bf16 a[228:231], a[232:235], v[72:79], v9
s_waitcnt lgkmcnt(6)
v_exp_f32 v42, v42
v_mfma_f32_16x16x32_bf16 v[20:23], a[0:3], a[176:179], v[104:107]
v_exp_f32 v43, v43
v_mfma_f32_16x16x32_bf16 v[20:23], a[4:7], a[180:183], v[20:23]
ds_read_b128 a[40:43], v2 offset:18432
v_cvt_pk_bf16_f32 v59, v42, v43
v_mfma_f32_16x16x32_bf16 v[20:23], a[8:11], a[184:187], v[20:23]
v_exp_f32 v44, v44
v_mfma_f32_16x16x32_bf16 v[20:23], a[12:15], a[188:191], v[20:23]
buffer_load_dwordx4 v3, s[48:51], s7 offen offset:3072 sc1 lds
v_mfma_f32_16x16x32_bf16 v[24:27], a[0:3], a[192:195], v[88:91]
ds_read_b128 a[44:47], v2 offset:19456
v_mfma_f32_16x16x32_bf16 v[24:27], a[4:7], a[196:199], v[24:27]
v_exp_f32 v45, v45
v_mfma_f32_16x16x32_bf16 v[24:27], a[8:11], a[200:203], v[24:27]
v_exp_f32 v46, v46
v_mfma_f32_16x16x32_bf16 v[24:27], a[12:15], a[204:207], v[24:27]
ds_read_b128 a[48:51], v2 offset:20480
v_add_u32 v4, s0, v3
v_mfma_f32_16x16x32_bf16 v[28:31], a[0:3], a[208:211], v[92:95]
v_cvt_pk_bf16_f32 v62, v44, v45
v_mfma_f32_16x16x32_bf16 v[28:31], a[4:7], a[212:215], v[28:31]
ds_read_b128 a[52:55], v2 offset:21504
v_mov_b32 v5, s1
v_mfma_f32_16x16x32_bf16 v[28:31], a[8:11], a[216:219], v[28:31]
s_waitcnt lgkmcnt(6)
v_exp_f32 v47, v47
v_mfma_f32_16x16x32_bf16 v[28:31], a[12:15], a[220:223], v[28:31]
global_load_dword a244, v[4:5], off sc1
v_mfma_f32_16x16x32_bf16 v[36:39], a[16:19], a[176:179], v[108:111]
ds_read_b128 a[56:59], v2 offset:22528
v_cvt_pk_bf16_f32 v63, v46, v47
v_mfma_f32_16x16x32_bf16 v[36:39], a[20:23], a[180:183], v[36:39]
s_add_u32 s32, s32, 0x8000
v_exp_f32 v20, v20
v_mfma_f32_16x16x32_bf16 v[36:39], a[24:27], a[184:187], v[36:39]
s_add_u32 s7, s7, 0x8000
v_exp_f32 v21, v21
v_mfma_f32_16x16x32_bf16 v[36:39], a[28:31], a[188:191], v[36:39]
ds_read_b128 a[60:63], v2 offset:23552
v_xor_b32 v2, 0x38000, v2
v_mfma_f32_16x16x32_bf16 v[40:43], a[16:19], a[192:195], v[88:91]
s_xor_b32 s19, s19, 0x8000
v_exp_f32 v22, v22
v_mfma_f32_16x16x32_bf16 v[40:43], a[20:23], a[196:199], v[40:43]
s_sub_u32 s15, 7, s6
v_exp_f32 v23, v23
v_mfma_f32_16x16x32_bf16 v[40:43], a[24:27], a[200:203], v[40:43]
s_lshl_b32 s15, s15, 1
v_exp_f32 v24, v24
v_mfma_f32_16x16x32_bf16 v[40:43], a[28:31], a[204:207], v[40:43]
v_exp_f32 v25, v25
v_mfma_f32_16x16x32_bf16 v[44:47], a[16:19], a[208:211], v[92:95]
v_exp_f32 v26, v26
v_mfma_f32_16x16x32_bf16 v[44:47], a[20:23], a[212:215], v[44:47]
v_exp_f32 v27, v27
v_mfma_f32_16x16x32_bf16 v[44:47], a[24:27], a[216:219], v[44:47]
s_waitcnt vmcnt(22) lgkmcnt(0)
v_cvt_pk_bf16_f32 v68, v20, v21
v_cvt_pk_bf16_f32 v69, v22, v23
v_mfma_f32_16x16x32_bf16 v[44:47], a[28:31], a[220:223], v[44:47]
s_barrier
s_cbranch_scc0 L_att_lh0_0
v_mfma_f32_16x16x32_bf16 v[160:163], a[32:35], v[52:55], v[160:163]
ds_read_b128 a[0:3], v1 offset:8192
v_cvt_pk_bf16_f32 v72, v24, v25
v_mfma_f32_16x16x32_bf16 v[192:195], a[32:35], v[56:59], v[192:195]
v_exp_f32 v28, v28
v_mfma_f32_16x16x32_bf16 v[224:227], a[32:35], v[60:63], v[224:227]
ds_read_b128 a[4:7], v1 offset:9216
v_cvt_pk_bf16_f32 v73, v26, v27
v_mfma_f32_16x16x32_bf16 v[228:231], a[36:39], v[60:63], v[228:231]
s_add_u32 m0, s27, 0x0
v_exp_f32 v29, v29
v_mfma_f32_16x16x32_bf16 v[196:199], a[36:39], v[56:59], v[196:199]
buffer_load_dwordx4 v3, s[48:51], s32 offen offset:0 sc1 lds
v_mfma_f32_16x16x32_bf16 v[164:167], a[36:39], v[52:55], v[164:167]
ds_read_b128 a[8:11], v1 offset:10240
v_cvt_pk_bf16_f32 v76, v28, v29
v_mfma_f32_16x16x32_bf16 v[168:171], a[40:43], v[52:55], v[168:171]
ds_read_b128 a[12:15], v1 offset:11264
v_accvgpr_read_b32 v6, a224
v_mfma_f32_16x16x32_bf16 v[200:203], a[40:43], v[56:59], v[200:203]
v_exp_f32 v30, v30
v_mfma_f32_16x16x32_bf16 v[232:235], a[40:43], v[60:63], v[232:235]
v_exp_f32 v31, v31
v_mfma_f32_16x16x32_bf16 v[236:239], a[44:47], v[60:63], v[236:239]
ds_read_b128 a[16:19], v1 offset:12288
v_cvt_pk_bf16_f32 v77, v30, v31
v_mfma_f32_16x16x32_bf16 v[204:207], a[44:47], v[56:59], v[204:207]
v_exp_f32 v36, v36
v_mfma_f32_16x16x32_bf16 v[172:175], a[44:47], v[52:55], v[172:175]
ds_read_b128 a[20:23], v1 offset:13312
v_accvgpr_read_b32 v7, a225
v_mfma_f32_16x16x32_bf16 v[176:179], a[48:51], v[52:55], v[176:179]
v_exp_f32 v37, v37
v_mfma_f32_16x16x32_bf16 v[208:211], a[48:51], v[56:59], v[208:211]
ds_read_b128 a[24:27], v1 offset:14336
v_cvt_pk_bf16_f32 v70, v36, v37
v_mfma_f32_16x16x32_bf16 v[240:243], a[48:51], v[60:63], v[240:243]
buffer_load_dwordx4 v3, s[48:51], s32 offen offset:1024 sc1 lds
v_mfma_f32_16x16x32_bf16 v[244:247], a[52:55], v[60:63], v[244:247]
v_exp_f32 v38, v38
v_mfma_f32_16x16x32_bf16 v[212:215], a[52:55], v[56:59], v[212:215]
ds_read_b128 a[28:31], v1 offset:15360
v_add_f32 v6, v6, v7
v_mfma_f32_16x16x32_bf16 v[180:183], a[52:55], v[52:55], v[180:183]
v_exp_f32 v39, v39
v_mfma_f32_16x16x32_bf16 v[184:187], a[56:59], v[52:55], v[184:187]
ds_read_b128 a[32:35], v1 offset:0
v_cvt_pk_bf16_f32 v71, v38, v39
v_mfma_f32_16x16x32_bf16 v[216:219], a[56:59], v[56:59], v[216:219]
v_exp_f32 v40, v40
v_mfma_f32_16x16x32_bf16 v[248:251], a[56:59], v[60:63], v[248:251]
ds_read_b128 a[36:39], v1 offset:1024
v_cmp_nge_f32 vcc, 0x6f800000, v6
v_mfma_f32_16x16x32_bf16 v[252:255], a[60:63], v[60:63], v[252:255]
v_exp_f32 v41, v41
v_mfma_f32_16x16x32_bf16 v[220:223], a[60:63], v[56:59], v[220:223]
v_exp_f32 v42, v42
v_mfma_f32_16x16x32_bf16 v[188:191], a[60:63], v[52:55], v[188:191]
ds_read_b128 a[40:43], v1 offset:2048
v_cvt_pk_bf16_f32 v74, v40, v41
v_mfma_f32_16x16x32_bf16 a[224:227], a[236:239], v[52:55], a[224:227]
buffer_load_dwordx4 v3, s[48:51], s32 offen offset:2048 sc1 lds
v_smfmac_f32_16x16x64_bf16 a[228:231], a[232:235], v[56:63], v9
ds_read_b128 a[44:47], v1 offset:3072
s_waitcnt lgkmcnt(8)
v_mfma_f32_16x16x32_bf16 v[24:27], a[0:3], a[192:195], v[88:91]
v_exp_f32 v43, v43
v_mfma_f32_16x16x32_bf16 v[24:27], a[4:7], a[196:199], v[24:27]
ds_read_b128 a[48:51], v1 offset:4096
v_cvt_pk_bf16_f32 v75, v42, v43
v_mfma_f32_16x16x32_bf16 v[24:27], a[8:11], a[200:203], v[24:27]
v_exp_f32 v44, v44
v_mfma_f32_16x16x32_bf16 v[24:27], a[12:15], a[204:207], v[24:27]
v_exp_f32 v45, v45
v_mfma_f32_16x16x32_bf16 v[28:31], a[0:3], a[208:211], v[92:95]
ds_read_b128 a[52:55], v1 offset:5120
v_cvt_pk_bf16_f32 v78, v44, v45
v_mfma_f32_16x16x32_bf16 v[28:31], a[4:7], a[212:215], v[28:31]
v_exp_f32 v46, v46
v_mfma_f32_16x16x32_bf16 v[28:31], a[8:11], a[216:219], v[28:31]
ds_read_b128 a[56:59], v1 offset:6144
v_mfma_f32_16x16x32_bf16 v[28:31], a[12:15], a[220:223], v[28:31]
s_waitcnt lgkmcnt(7)
v_exp_f32 v47, v47
v_mfma_f32_16x16x32_bf16 v[40:43], a[16:19], a[192:195], v[88:91]
buffer_load_dwordx4 v3, s[48:51], s32 offen offset:3072 sc1 lds
v_mfma_f32_16x16x32_bf16 v[40:43], a[20:23], a[196:199], v[40:43]
ds_read_b128 a[60:63], v1 offset:7168
v_cvt_pk_bf16_f32 v79, v46, v47
v_mfma_f32_16x16x32_bf16 v[40:43], a[24:27], a[200:203], v[40:43]
s_add_u32 s32, s32, 0x8000
v_exp_f32 v24, v24
v_mfma_f32_16x16x32_bf16 v[40:43], a[28:31], a[204:207], v[40:43]
v_exp_f32 v25, v25
v_mfma_f32_16x16x32_bf16 v[44:47], a[16:19], a[208:211], v[92:95]
v_exp_f32 v26, v26
v_mfma_f32_16x16x32_bf16 v[44:47], a[20:23], a[212:215], v[44:47]
v_exp_f32 v27, v27
v_mfma_f32_16x16x32_bf16 v[44:47], a[24:27], a[216:219], v[44:47]
v_exp_f32 v28, v28
v_mfma_f32_16x16x32_bf16 v[44:47], a[28:31], a[220:223], v[44:47]
s_waitcnt lgkmcnt(0)
v_exp_f32 v29, v29
v_mfma_f32_16x16x32_bf16 v[160:163], a[32:35], v[68:71], v[160:163]
ds_read_b128 a[0:3], v1 offset:24576
v_cvt_pk_bf16_f32 v56, v24, v25
v_mfma_f32_16x16x32_bf16 v[192:195], a[32:35], v[72:75], v[192:195]
v_exp_f32 v30, v30
v_mfma_f32_16x16x32_bf16 v[224:227], a[32:35], v[76:79], v[224:227]
ds_read_b128 a[4:7], v1 offset:25600
v_cvt_pk_bf16_f32 v57, v26, v27
v_mfma_f32_16x16x32_bf16 v[228:231], a[36:39], v[76:79], v[228:231]
s_add_u32 m0, s27, 0x1000
v_cvt_pk_bf16_f32 v60, v28, v29
v_mfma_f32_16x16x32_bf16 v[196:199], a[36:39], v[72:75], v[196:199]
buffer_load_dwordx4 v3, s[48:51], s7 offen offset:0 sc1 lds
v_mfma_f32_16x16x32_bf16 v[164:167], a[36:39], v[68:71], v[164:167]
ds_read_b128 a[8:11], v1 offset:26624
v_mfma_f32_16x16x32_bf16 v[168:171], a[40:43], v[68:71], v[168:171]
ds_read_b128 a[12:15], v1 offset:27648
v_mfma_f32_16x16x32_bf16 v[200:203], a[40:43], v[72:75], v[200:203]
v_exp_f32 v31, v31
v_mfma_f32_16x16x32_bf16 v[232:235], a[40:43], v[76:79], v[232:235]
v_exp_f32 v40, v40
v_mfma_f32_16x16x32_bf16 v[236:239], a[44:47], v[76:79], v[236:239]
ds_read_b128 a[16:19], v1 offset:28672
v_cvt_pk_bf16_f32 v61, v30, v31
v_mfma_f32_16x16x32_bf16 v[204:207], a[44:47], v[72:75], v[204:207]
v_exp_f32 v41, v41
v_mfma_f32_16x16x32_bf16 v[172:175], a[44:47], v[68:71], v[172:175]
ds_read_b128 a[20:23], v1 offset:29696
v_cvt_pk_bf16_f32 v58, v40, v41
v_mfma_f32_16x16x32_bf16 v[176:179], a[48:51], v[68:71], v[176:179]
v_rcp_f32 v6, v6
v_mfma_f32_16x16x32_bf16 v[208:211], a[48:51], v[72:75], v[208:211]
buffer_load_dwordx4 v3, s[48:51], s7 offen offset:1024 sc1 lds
v_mfma_f32_16x16x32_bf16 v[240:243], a[48:51], v[76:79], v[240:243]
ds_read_b128 a[24:27], v1 offset:30720
s_or_b64 s[34:35], s[34:35], vcc
v_mfma_f32_16x16x32_bf16 v[244:247], a[52:55], v[76:79], v[244:247]
ds_read_b128 a[28:31], v1 offset:31744
s_add_u32 s8, s28, 0x0
v_mfma_f32_16x16x32_bf16 v[212:215], a[52:55], v[72:75], v[212:215]
v_exp_f32 v42, v42
v_mfma_f32_16x16x32_bf16 v[180:183], a[52:55], v[68:71], v[180:183]
v_exp_f32 v43, v43
v_mfma_f32_16x16x32_bf16 v[184:187], a[56:59], v[68:71], v[184:187]
ds_read_b128 a[32:35], v1 offset:16384
v_cvt_pk_bf16_f32 v59, v42, v43
v_mfma_f32_16x16x32_bf16 v[216:219], a[56:59], v[72:75], v[216:219]
v_exp_f32 v44, v44
v_mfma_f32_16x16x32_bf16 v[248:251], a[56:59], v[76:79], v[248:251]
ds_read_b128 a[36:39], v1 offset:17408
v_mul_f32 v128, v6, v128
v_mfma_f32_16x16x32_bf16 v[252:255], a[60:63], v[76:79], v[252:255]
v_mul_f32 v129, v6, v129
v_mul_f32 v130, v6, v130
v_mfma_f32_16x16x32_bf16 v[220:223], a[60:63], v[72:75], v[220:223]
ds_read_b128 a[40:43], v1 offset:18432
v_mul_f32 v131, v6, v131
v_mfma_f32_16x16x32_bf16 v[188:191], a[60:63], v[68:71], v[188:191]
buffer_load_dwordx4 v3, s[48:51], s7 offen offset:2048 sc1 lds
v_mfma_f32_16x16x32_bf16 a[224:227], a[236:239], v[68:71], a[224:227]
ds_read_b128 a[44:47], v1 offset:19456
v_mul_f32 v132, v6, v132
v_smfmac_f32_16x16x64_bf16 a[228:231], a[232:235], v[72:79], v9
s_waitcnt lgkmcnt(8)
v_exp_f32 v45, v45
v_mfma_f32_16x16x32_bf16 v[24:27], a[0:3], a[192:195], v[88:91]
v_exp_f32 v46, v46
v_mfma_f32_16x16x32_bf16 v[24:27], a[4:7], a[196:199], v[24:27]
ds_read_b128 a[48:51], v1 offset:20480
v_cvt_pk_bf16_f32 v62, v44, v45
v_mfma_f32_16x16x32_bf16 v[24:27], a[8:11], a[200:203], v[24:27]
v_exp_f32 v47, v47
v_mfma_f32_16x16x32_bf16 v[24:27], a[12:15], a[204:207], v[24:27]
ds_read_b128 a[52:55], v1 offset:21504
v_cvt_pk_bf16_f32 v63, v46, v47
v_mfma_f32_16x16x32_bf16 v[28:31], a[0:3], a[208:211], v[92:95]
v_mul_f32 v133, v6, v133
v_mul_f32 v134, v6, v134
v_mfma_f32_16x16x32_bf16 v[28:31], a[4:7], a[212:215], v[28:31]
ds_read_b128 a[56:59], v1 offset:22528
v_mul_f32 v135, v6, v135
v_mfma_f32_16x16x32_bf16 v[28:31], a[8:11], a[216:219], v[28:31]
buffer_load_dwordx4 v3, s[48:51], s7 offen offset:3072 sc1 lds
v_mfma_f32_16x16x32_bf16 v[28:31], a[12:15], a[220:223], v[28:31]
ds_read_b128 a[60:63], v1 offset:23552
s_waitcnt lgkmcnt(8)
v_mfma_f32_16x16x32_bf16 v[40:43], a[16:19], a[192:195], v[88:91]
s_add_u32 s7, s7, 0x8000
v_xor_b32 v1, 0x8000, v1
v_cvt_pk_bf16_f32 v128, v128, v129
v_mfma_f32_16x16x32_bf16 v[40:43], a[20:23], a[196:199], v[40:43]
s_xor_b32 s27, s27, 0x38000
v_exp_f32 v24, v24
v_mfma_f32_16x16x32_bf16 v[40:43], a[24:27], a[200:203], v[40:43]
v_exp_f32 v25, v25
v_mfma_f32_16x16x32_bf16 v[40:43], a[28:31], a[204:207], v[40:43]
v_exp_f32 v26, v26
v_mfma_f32_16x16x32_bf16 v[44:47], a[16:19], a[208:211], v[92:95]
v_exp_f32 v27, v27
v_mfma_f32_16x16x32_bf16 v[44:47], a[20:23], a[212:215], v[44:47]
v_exp_f32 v28, v28
v_mfma_f32_16x16x32_bf16 v[44:47], a[24:27], a[216:219], v[44:47]
s_waitcnt vmcnt(19) lgkmcnt(0)
v_exp_f32 v29, v29
v_mfma_f32_16x16x32_bf16 v[44:47], a[28:31], a[220:223], v[44:47]
s_barrier
v_cvt_pk_bf16_f32 v129, v130, v131
v_cvt_pk_bf16_f32 v130, v132, v133
v_cvt_pk_bf16_f32 v131, v134, v135
buffer_store_dwordx4 v[128:131], v3, s[88:91], s8 offen sc1
s_add_u32 s8, s28, 0x2000
v_mul_f32 v136, v6, v136
v_mul_f32 v137, v6, v137
v_mul_f32 v138, v6, v138
v_mul_f32 v139, v6, v139
v_mul_f32 v140, v6, v140
v_mul_f32 v141, v6, v141
v_mul_f32 v142, v6, v142
v_mul_f32 v143, v6, v143
v_cvt_pk_bf16_f32 v136, v136, v137
v_cvt_pk_bf16_f32 v137, v138, v139
v_cvt_pk_bf16_f32 v138, v140, v141
v_cvt_pk_bf16_f32 v139, v142, v143
buffer_store_dwordx4 v[136:139], v3, s[88:91], s8 offen sc1
s_add_u32 s8, s28, 0x4000
v_mul_f32 v144, v6, v144
v_mul_f32 v145, v6, v145
v_mul_f32 v146, v6, v146
v_mul_f32 v147, v6, v147
v_mul_f32 v148, v6, v148
v_mul_f32 v149, v6, v149
v_mul_f32 v150, v6, v150
v_mul_f32 v151, v6, v151
v_cvt_pk_bf16_f32 v144, v144, v145
v_cvt_pk_bf16_f32 v145, v146, v147
v_cvt_pk_bf16_f32 v146, v148, v149
v_cvt_pk_bf16_f32 v147, v150, v151
buffer_store_dwordx4 v[144:147], v3, s[88:91], s8 offen sc1
s_add_u32 s8, s28, 0x6000
v_mul_f32 v152, v6, v152
v_mul_f32 v153, v6, v153
v_mul_f32 v154, v6, v154
v_mul_f32 v155, v6, v155
v_mul_f32 v156, v6, v156
v_mul_f32 v157, v6, v157
v_mul_f32 v158, v6, v158
v_mul_f32 v159, v6, v159
v_cvt_pk_bf16_f32 v152, v152, v153
v_cvt_pk_bf16_f32 v153, v154, v155
v_cvt_pk_bf16_f32 v154, v156, v157
v_cvt_pk_bf16_f32 v155, v158, v159
buffer_store_dwordx4 v[152:155], v3, s[88:91], s8 offen sc1
v_accvgpr_read_b32 v6, a226
v_accvgpr_read_b32 v7, a227
v_add_f32 v6, v6, v7
v_cmp_nge_f32 vcc, 0x6f800000, v6
v_rcp_f32 v6, v6
s_or_b64 s[34:35], s[34:35], vcc
s_add_u32 s8, s29, 0x0
v_pk_mul_f32 v[160:161], v[160:161], v[6:7] op_sel_hi:[1,0]
v_pk_mul_f32 v[162:163], v[162:163], v[6:7] op_sel_hi:[1,0]
v_pk_mul_f32 v[164:165], v[164:165], v[6:7] op_sel_hi:[1,0]
v_pk_mul_f32 v[166:167], v[166:167], v[6:7] op_sel_hi:[1,0]
v_cvt_pk_bf16_f32 v160, v160, v161
v_cvt_pk_bf16_f32 v161, v162, v163
v_cvt_pk_bf16_f32 v162, v164, v165
v_cvt_pk_bf16_f32 v163, v166, v167
buffer_store_dwordx4 v[160:163], v3, s[88:91], s8 offen sc1
s_add_u32 s8, s29, 0x2000
v_pk_mul_f32 v[168:169], v[168:169], v[6:7] op_sel_hi:[1,0]
v_pk_mul_f32 v[170:171], v[170:171], v[6:7] op_sel_hi:[1,0]
v_pk_mul_f32 v[172:173], v[172:173], v[6:7] op_sel_hi:[1,0]
v_pk_mul_f32 v[174:175], v[174:175], v[6:7] op_sel_hi:[1,0]
v_cvt_pk_bf16_f32 v168, v168, v169
v_cvt_pk_bf16_f32 v169, v170, v171
v_cvt_pk_bf16_f32 v170, v172, v173
v_cvt_pk_bf16_f32 v171, v174, v175
buffer_store_dwordx4 v[168:171], v3, s[88:91], s8 offen sc1
s_add_u32 s8, s29, 0x4000
v_pk_mul_f32 v[176:177], v[176:177], v[6:7] op_sel_hi:[1,0]
v_pk_mul_f32 v[178:179], v[178:179], v[6:7] op_sel_hi:[1,0]
v_pk_mul_f32 v[180:181], v[180:181], v[6:7] op_sel_hi:[1,0]
v_pk_mul_f32 v[182:183], v[182:183], v[6:7] op_sel_hi:[1,0]
v_cvt_pk_bf16_f32 v176, v176, v177
v_cvt_pk_bf16_f32 v177, v178, v179
v_cvt_pk_bf16_f32 v178, v180, v181
v_cvt_pk_bf16_f32 v179, v182, v183
buffer_store_dwordx4 v[176:179], v3, s[88:91], s8 offen sc1
s_add_u32 s8, s29, 0x6000
v_pk_mul_f32 v[184:185], v[184:185], v[6:7] op_sel_hi:[1,0]
v_pk_mul_f32 v[186:187], v[186:187], v[6:7] op_sel_hi:[1,0]
v_pk_mul_f32 v[188:189], v[188:189], v[6:7] op_sel_hi:[1,0]
v_pk_mul_f32 v[190:191], v[190:191], v[6:7] op_sel_hi:[1,0]
v_cvt_pk_bf16_f32 v184, v184, v185
v_cvt_pk_bf16_f32 v185, v186, v187
v_cvt_pk_bf16_f32 v186, v188, v189
v_cvt_pk_bf16_f32 v187, v190, v191
buffer_store_dwordx4 v[184:187], v3, s[88:91], s8 offen sc1
s_getreg_b32 s8, hwreg(HW_REG_HW_ID, 5, 1)
s_cmp_lg_u32 s8, 0
s_cbranch_scc1 L_att_sodd1
s_branch L_att_sodd0
L_att_lh0_0:
v_mfma_f32_16x16x32_bf16 v[160:163], a[32:35], v[52:55], v[160:163]
v_exp_f32 v28, v28
v_mfma_f32_16x16x32_bf16 v[192:195], a[32:35], v[56:59], v[192:195]
buffer_load_dword v14, v15, s[84:87], 0 offen offset:192 sc1
v_mfma_f32_16x16x32_bf16 v[224:227], a[32:35], v[60:63], v[224:227]
v_exp_f32 v29, v29
v_mfma_f32_16x16x32_bf16 v[228:231], a[36:39], v[60:63], v[228:231]
v_exp_f32 v30, v30
v_mfma_f32_16x16x32_bf16 v[196:199], a[36:39], v[56:59], v[196:199]
s_add_u32 m0, s17, 0x10000
v_exp_f32 v31, v31
v_mfma_f32_16x16x32_bf16 v[164:167], a[36:39], v[52:55], v[164:167]
ds_read_b128 a[0:3], v1 offset:8192
v_cvt_pk_bf16_f32 v72, v24, v25
v_mfma_f32_16x16x32_bf16 v[168:171], a[40:43], v[52:55], v[168:171]
ds_read_b128 a[4:7], v1 offset:9216
v_cvt_pk_bf16_f32 v73, v26, v27
v_mfma_f32_16x16x32_bf16 v[200:203], a[40:43], v[56:59], v[200:203]
buffer_load_dwordx4 v12, s[72:75], 0 offen lds
v_mfma_f32_16x16x32_bf16 v[232:235], a[40:43], v[60:63], v[232:235]
ds_read_b128 a[8:11], v1 offset:10240
v_cvt_pk_bf16_f32 v76, v28, v29
v_mfma_f32_16x16x32_bf16 v[236:239], a[44:47], v[60:63], v[236:239]
v_exp_f32 v36, v36
v_mfma_f32_16x16x32_bf16 v[204:207], a[44:47], v[56:59], v[204:207]
v_exp_f32 v37, v37
v_mfma_f32_16x16x32_bf16 v[172:175], a[44:47], v[52:55], v[172:175]
ds_read_b128 a[12:15], v1 offset:11264
v_cvt_pk_bf16_f32 v77, v30, v31
v_mfma_f32_16x16x32_bf16 v[176:179], a[48:51], v[52:55], v[176:179]
buffer_load_dwordx4 v13, s[72:75], 0 offen offset:1024 lds
v_mfma_f32_16x16x32_bf16 v[208:211], a[48:51], v[56:59], v[208:211]
ds_read_b128 a[16:19], v1 offset:12288
v_cvt_pk_bf16_f32 v70, v36, v37
v_mfma_f32_16x16x32_bf16 v[240:243], a[48:51], v[60:63], v[240:243]
ds_read_b128 a[20:23], v1 offset:13312
v_exp_f32 v38, v38
v_mfma_f32_16x16x32_bf16 v[244:247], a[52:55], v[60:63], v[244:247]
ds_read_b128 a[24:27], v1 offset:14336
v_exp_f32 v39, v39
v_mfma_f32_16x16x32_bf16 v[212:215], a[52:55], v[56:59], v[212:215]
v_exp_f32 v40, v40
v_mfma_f32_16x16x32_bf16 v[180:183], a[52:55], v[52:55], v[180:183]
buffer_load_dwordx4 v12, s[72:75], s12 offen offset:2048 lds
v_mfma_f32_16x16x32_bf16 v[184:187], a[56:59], v[52:55], v[184:187]
ds_read_b128 a[28:31], v1 offset:15360
v_exp_f32 v41, v41
v_mfma_f32_16x16x32_bf16 v[216:219], a[56:59], v[56:59], v[216:219]
buffer_load_dwordx4 v13, s[72:75], s12 offen offset:3072 lds
v_mfma_f32_16x16x32_bf16 v[248:251], a[56:59], v[60:63], v[248:251]
s_add_u32 m0, s17, 0x14000
v_exp_f32 v42, v42
v_mfma_f32_16x16x32_bf16 v[252:255], a[60:63], v[60:63], v[252:255]
ds_read_b128 a[32:35], v1 offset:0
v_cvt_pk_bf16_f32 v71, v38, v39
v_mfma_f32_16x16x32_bf16 v[220:223], a[60:63], v[56:59], v[220:223]
ds_read_b128 a[36:39], v1 offset:1024
v_add_u32 v12, 0x20000, v12
v_mfma_f32_16x16x32_bf16 v[188:191], a[60:63], v[52:55], v[188:191]
buffer_load_dwordx4 v12, s[72:75], 0 offen lds
v_mfma_f32_16x16x32_bf16 a[224:227], a[236:239], v[52:55], a[224:227]
ds_read_b128 a[40:43], v1 offset:2048
v_exp_f32 v43, v43
v_smfmac_f32_16x16x64_bf16 a[228:231], a[232:235], v[56:63], v9
s_waitcnt lgkmcnt(7)
v_exp_f32 v44, v44
v_mfma_f32_16x16x32_bf16 v[24:27], a[0:3], a[192:195], v[112:115]
ds_read_b128 a[44:47], v1 offset:3072
v_exp_f32 v45, v45
v_mfma_f32_16x16x32_bf16 v[24:27], a[4:7], a[196:199], v[24:27]
ds_read_b128 a[48:51], v1 offset:4096
v_add_u32 v13, 0x20000, v13
v_mfma_f32_16x16x32_bf16 v[24:27], a[8:11], a[200:203], v[24:27]
v_exp_f32 v46, v46
v_mfma_f32_16x16x32_bf16 v[24:27], a[12:15], a[204:207], v[24:27]
buffer_load_dwordx4 v13, s[72:75], 0 offen offset:1024 lds
v_mfma_f32_16x16x32_bf16 v[28:31], a[0:3], a[208:211], v[92:95]
v_exp_f32 v47, v47
v_mfma_f32_16x16x32_bf16 v[28:31], a[4:7], a[212:215], v[28:31]
ds_read_b128 a[52:55], v1 offset:5120
v_cvt_pk_bf16_f32 v74, v40, v41
v_mfma_f32_16x16x32_bf16 v[28:31], a[8:11], a[216:219], v[28:31]
ds_read_b128 a[56:59], v1 offset:6144
v_cvt_pk_bf16_f32 v75, v42, v43
v_mfma_f32_16x16x32_bf16 v[28:31], a[12:15], a[220:223], v[28:31]
s_waitcnt lgkmcnt(7)
v_exp_f32 v24, v24
v_mfma_f32_16x16x32_bf16 v[40:43], a[16:19], a[192:195], v[116:119]
buffer_load_dwordx4 v12, s[72:75], s12 offen offset:2048 lds
v_mfma_f32_16x16x32_bf16 v[40:43], a[20:23], a[196:199], v[40:43]
ds_read_b128 a[60:63], v1 offset:7168
v_cvt_pk_bf16_f32 v78, v44, v45
v_mfma_f32_16x16x32_bf16 v[40:43], a[24:27], a[200:203], v[40:43]
v_exp_f32 v25, v25
v_mfma_f32_16x16x32_bf16 v[40:43], a[28:31], a[204:207], v[40:43]
buffer_load_dwordx4 v13, s[72:75], s12 offen offset:3072 lds
v_cvt_pk_bf16_f32 v79, v46, v47
v_mfma_f32_16x16x32_bf16 v[44:47], a[16:19], a[208:211], v[92:95]
v_exp_f32 v26, v26
v_mfma_f32_16x16x32_bf16 v[44:47], a[20:23], a[212:215], v[44:47]
v_exp_f32 v27, v27
v_mfma_f32_16x16x32_bf16 v[44:47], a[24:27], a[216:219], v[44:47]
v_exp_f32 v28, v28
v_mfma_f32_16x16x32_bf16 v[44:47], a[28:31], a[220:223], v[44:47]
s_waitcnt lgkmcnt(0)
v_exp_f32 v29, v29
v_mfma_f32_16x16x32_bf16 v[160:163], a[32:35], v[68:71], v[160:163]
ds_read_b128 a[0:3], v1 offset:24576
v_cvt_pk_bf16_f32 v56, v24, v25
v_mfma_f32_16x16x32_bf16 v[192:195], a[32:35], v[72:75], v[192:195]
ds_read_b128 a[4:7], v1 offset:25600
v_add_u32 v12, 0x20000, v12
v_mfma_f32_16x16x32_bf16 v[224:227], a[32:35], v[76:79], v[224:227]
s_add_u32 m0, s16, 0x0
v_exp_f32 v30, v30
v_mfma_f32_16x16x32_bf16 v[228:231], a[36:39], v[76:79], v[228:231]
buffer_load_dwordx4 v12, s[72:75], 0 offen lds
v_mfma_f32_16x16x32_bf16 v[196:199], a[36:39], v[72:75], v[196:199]
ds_read_b128 a[8:11], v1 offset:26624
v_add_u32 v13, 0x20000, v13
v_mfma_f32_16x16x32_bf16 v[164:167], a[36:39], v[68:71], v[164:167]
buffer_load_dwordx4 v13, s[72:75], 0 offen offset:1024 lds
v_mfma_f32_16x16x32_bf16 v[168:171], a[40:43], v[68:71], v[168:171]
ds_read_b128 a[12:15], v1 offset:27648
v_cvt_pk_bf16_f32 v57, v26, v27
v_mfma_f32_16x16x32_bf16 v[200:203], a[40:43], v[72:75], v[200:203]
v_exp_f32 v31, v31
v_mfma_f32_16x16x32_bf16 v[232:235], a[40:43], v[76:79], v[232:235]
ds_read_b128 a[16:19], v1 offset:28672
v_cvt_pk_bf16_f32 v60, v28, v29
v_mfma_f32_16x16x32_bf16 v[236:239], a[44:47], v[76:79], v[236:239]
buffer_load_dwordx4 v12, s[72:75], s12 offen offset:2048 lds
v_mfma_f32_16x16x32_bf16 v[204:207], a[44:47], v[72:75], v[204:207]
ds_read_b128 a[20:23], v1 offset:29696
v_cvt_pk_bf16_f32 v61, v30, v31
v_mfma_f32_16x16x32_bf16 v[172:175], a[44:47], v[68:71], v[172:175]
buffer_load_dwordx4 v13, s[72:75], s12 offen offset:3072 lds
v_mfma_f32_16x16x32_bf16 v[176:179], a[48:51], v[68:71], v[176:179]
ds_read_b128 a[24:27], v1 offset:30720
v_mfma_f32_16x16x32_bf16 v[208:211], a[48:51], v[72:75], v[208:211]
ds_read_b128 a[28:31], v1 offset:31744
v_mfma_f32_16x16x32_bf16 v[240:243], a[48:51], v[76:79], v[240:243]
v_exp_f32 v40, v40
v_mfma_f32_16x16x32_bf16 v[244:247], a[52:55], v[76:79], v[244:247]
s_add_u32 m0, s16, 0x4000
v_exp_f32 v41, v41
v_mfma_f32_16x16x32_bf16 v[212:215], a[52:55], v[72:75], v[212:215]
ds_read_b128 a[32:35], v1 offset:16384
v_cvt_pk_bf16_f32 v58, v40, v41
v_mfma_f32_16x16x32_bf16 v[180:183], a[52:55], v[68:71], v[180:183]
ds_read_b128 a[36:39], v1 offset:17408
v_add_u32 v12, 0x20000, v12
v_mfma_f32_16x16x32_bf16 v[184:187], a[56:59], v[68:71], v[184:187]
buffer_load_dwordx4 v12, s[72:75], 0 offen lds
v_mfma_f32_16x16x32_bf16 v[216:219], a[56:59], v[72:75], v[216:219]
ds_read_b128 a[40:43], v1 offset:18432
v_mfma_f32_16x16x32_bf16 v[248:251], a[56:59], v[76:79], v[248:251]
v_exp_f32 v42, v42
v_mfma_f32_16x16x32_bf16 v[252:255], a[60:63], v[76:79], v[252:255]
ds_read_b128 a[44:47], v1 offset:19456
v_add_u32 v13, 0x20000, v13
v_mfma_f32_16x16x32_bf16 v[220:223], a[60:63], v[72:75], v[220:223]
buffer_load_dwordx4 v13, s[72:75], 0 offen offset:1024 lds
v_mfma_f32_16x16x32_bf16 v[188:191], a[60:63], v[68:71], v[188:191]
ds_read_b128 a[48:51], v1 offset:20480
v_exp_f32 v43, v43
v_mfma_f32_16x16x32_bf16 a[224:227], a[236:239], v[68:71], a[224:227]
s_waitcnt lgkmcnt(9)
v_exp_f32 v44, v44
v_smfmac_f32_16x16x64_bf16 a[228:231], a[232:235], v[72:79], v9
ds_read_b128 a[52:55], v1 offset:21504
v_exp_f32 v45, v45
v_mfma_f32_16x16x32_bf16 v[28:31], a[0:3], a[208:211], v[92:95]
buffer_load_dwordx4 v12, s[72:75], s12 offen offset:2048 lds
v_mfma_f32_16x16x32_bf16 v[28:31], a[4:7], a[212:215], v[28:31]
ds_read_b128 a[56:59], v1 offset:22528
v_exp_f32 v46, v46
v_mfma_f32_16x16x32_bf16 v[28:31], a[8:11], a[216:219], v[28:31]
ds_read_b128 a[60:63], v1 offset:23552
v_xor_b32 v1, 0x8000, v1
v_mfma_f32_16x16x32_bf16 v[28:31], a[12:15], a[220:223], v[28:31]
s_waitcnt lgkmcnt(8)
v_exp_f32 v47, v47
v_cvt_pk_bf16_f32 v62, v44, v45
v_cvt_pk_bf16_f32 v63, v46, v47
v_mfma_f32_16x16x32_bf16 v[44:47], a[16:19], a[208:211], v[92:95]
buffer_load_dwordx4 v13, s[72:75], s12 offen offset:3072 lds
v_mfma_f32_16x16x32_bf16 v[44:47], a[20:23], a[212:215], v[44:47]
v_cvt_pk_bf16_f32 v59, v42, v43
v_mfma_f32_16x16x32_bf16 v[44:47], a[24:27], a[216:219], v[44:47]
v_mfma_f32_16x16x32_bf16 v[44:47], a[28:31], a[220:223], v[44:47]
v_accvgpr_read_b32 v6, a224
v_accvgpr_read_b32 v7, a225
v_add_f32 v6, v6, v7
v_cmp_nge_f32 vcc, 0x6f800000, v6
v_rcp_f32 v6, v6
s_or_b64 s[34:35], s[34:35], vcc
s_add_u32 s8, s28, 0x0
v_pk_mul_f32 v[128:129], v[128:129], v[6:7] op_sel_hi:[1,0]
v_pk_mul_f32 v[130:131], v[130:131], v[6:7] op_sel_hi:[1,0]
v_pk_mul_f32 v[132:133], v[132:133], v[6:7] op_sel_hi:[1,0]
v_pk_mul_f32 v[134:135], v[134:135], v[6:7] op_sel_hi:[1,0]
v_cvt_pk_bf16_f32 v128, v128, v129
v_cvt_pk_bf16_f32 v129, v130, v131
v_cvt_pk_bf16_f32 v130, v132, v133
v_cvt_pk_bf16_f32 v131, v134, v135
buffer_store_dwordx4 v[128:131], v3, s[88:91], s8 offen sc1
s_add_u32 s8, s28, 0x2000
v_pk_mul_f32 v[136:137], v[136:137], v[6:7] op_sel_hi:[1,0]
v_pk_mul_f32 v[138:139], v[138:139], v[6:7] op_sel_hi:[1,0]
v_pk_mul_f32 v[140:141], v[140:141], v[6:7] op_sel_hi:[1,0]
v_pk_mul_f32 v[142:143], v[142:143], v[6:7] op_sel_hi:[1,0]
v_cvt_pk_bf16_f32 v136, v136, v137
v_cvt_pk_bf16_f32 v137, v138, v139
v_cvt_pk_bf16_f32 v138, v140, v141
v_cvt_pk_bf16_f32 v139, v142, v143
buffer_store_dwordx4 v[136:139], v3, s[88:91], s8 offen sc1
s_add_u32 s8, s28, 0x4000
v_pk_mul_f32 v[144:145], v[144:145], v[6:7] op_sel_hi:[1,0]
v_pk_mul_f32 v[146:147], v[146:147], v[6:7] op_sel_hi:[1,0]
v_pk_mul_f32 v[148:149], v[148:149], v[6:7] op_sel_hi:[1,0]
v_pk_mul_f32 v[150:151], v[150:151], v[6:7] op_sel_hi:[1,0]
v_cvt_pk_bf16_f32 v144, v144, v145
v_cvt_pk_bf16_f32 v145, v146, v147
v_cvt_pk_bf16_f32 v146, v148, v149
v_cvt_pk_bf16_f32 v147, v150, v151
buffer_store_dwordx4 v[144:147], v3, s[88:91], s8 offen sc1
s_add_u32 s8, s28, 0x6000
v_pk_mul_f32 v[152:153], v[152:153], v[6:7] op_sel_hi:[1,0]
v_pk_mul_f32 v[154:155], v[154:155], v[6:7] op_sel_hi:[1,0]
v_pk_mul_f32 v[156:157], v[156:157], v[6:7] op_sel_hi:[1,0]
v_pk_mul_f32 v[158:159], v[158:159], v[6:7] op_sel_hi:[1,0]
v_cvt_pk_bf16_f32 v152, v152, v153
v_cvt_pk_bf16_f32 v153, v154, v155
v_cvt_pk_bf16_f32 v154, v156, v157
v_cvt_pk_bf16_f32 v155, v158, v159
buffer_store_dwordx4 v[152:155], v3, s[88:91], s8 offen sc1
v_accvgpr_read_b32 v6, a226
v_accvgpr_read_b32 v7, a227
v_add_f32 v6, v6, v7
v_cmp_nge_f32 vcc, 0x6f800000, v6
v_rcp_f32 v6, v6
s_or_b64 s[34:35], s[34:35], vcc
s_add_u32 s8, s29, 0x0
v_pk_mul_f32 v[160:161], v[160:161], v[6:7] op_sel_hi:[1,0]
v_pk_mul_f32 v[162:163], v[162:163], v[6:7] op_sel_hi:[1,0]
v_pk_mul_f32 v[164:165], v[164:165], v[6:7] op_sel_hi:[1,0]
v_pk_mul_f32 v[166:167], v[166:167], v[6:7] op_sel_hi:[1,0]
v_cvt_pk_bf16_f32 v160, v160, v161
v_cvt_pk_bf16_f32 v161, v162, v163
v_cvt_pk_bf16_f32 v162, v164, v165
v_cvt_pk_bf16_f32 v163, v166, v167
buffer_store_dwordx4 v[160:163], v3, s[88:91], s8 offen sc1
s_add_u32 s8, s29, 0x2000
v_pk_mul_f32 v[168:169], v[168:169], v[6:7] op_sel_hi:[1,0]
v_pk_mul_f32 v[170:171], v[170:171], v[6:7] op_sel_hi:[1,0]
v_pk_mul_f32 v[172:173], v[172:173], v[6:7] op_sel_hi:[1,0]
v_pk_mul_f32 v[174:175], v[174:175], v[6:7] op_sel_hi:[1,0]
v_cvt_pk_bf16_f32 v168, v168, v169
v_cvt_pk_bf16_f32 v169, v170, v171
v_cvt_pk_bf16_f32 v170, v172, v173
v_cvt_pk_bf16_f32 v171, v174, v175
buffer_store_dwordx4 v[168:171], v3, s[88:91], s8 offen sc1
s_add_u32 s8, s29, 0x4000
v_pk_mul_f32 v[176:177], v[176:177], v[6:7] op_sel_hi:[1,0]
v_pk_mul_f32 v[178:179], v[178:179], v[6:7] op_sel_hi:[1,0]
v_pk_mul_f32 v[180:181], v[180:181], v[6:7] op_sel_hi:[1,0]
v_pk_mul_f32 v[182:183], v[182:183], v[6:7] op_sel_hi:[1,0]
v_cvt_pk_bf16_f32 v176, v176, v177
v_cvt_pk_bf16_f32 v177, v178, v179
v_cvt_pk_bf16_f32 v178, v180, v181
v_cvt_pk_bf16_f32 v179, v182, v183
buffer_store_dwordx4 v[176:179], v3, s[88:91], s8 offen sc1
s_add_u32 s8, s29, 0x6000
v_pk_mul_f32 v[184:185], v[184:185], v[6:7] op_sel_hi:[1,0]
v_pk_mul_f32 v[186:187], v[186:187], v[6:7] op_sel_hi:[1,0]
v_pk_mul_f32 v[188:189], v[188:189], v[6:7] op_sel_hi:[1,0]
v_pk_mul_f32 v[190:191], v[190:191], v[6:7] op_sel_hi:[1,0]
v_cvt_pk_bf16_f32 v184, v184, v185
v_cvt_pk_bf16_f32 v185, v186, v187
v_cvt_pk_bf16_f32 v186, v188, v189
v_cvt_pk_bf16_f32 v187, v190, v191
buffer_store_dwordx4 v[184:187], v3, s[88:91], s8 offen sc1
s_branch L_att_h1_0
L_att_dl0_1:
v_mfma_f32_16x16x32_bf16 v[128:131], a[32:35], v[48:51], v[128:131]
ds_read_b128 a[0:3], v1 offset:8192
v_cvt_pk_bf16_f32 v72, v24, v25
v_mfma_f32_16x16x32_bf16 v[160:163], a[32:35], v[52:55], v[160:163]
v_exp_f32 v28, v28
v_mfma_f32_16x16x32_bf16 v[192:195], a[32:35], v[56:59], v[192:195]
v_cvt_pk_bf16_f32 v73, v26, v27
v_mfma_f32_16x16x32_bf16 v[224:227], a[32:35], v[60:63], v[224:227]
ds_read_b128 a[4:7], v1 offset:9216
v_mfma_f32_16x16x32_bf16 v[228:231], a[36:39], v[60:63], v[228:231]
s_add_u32 m0, s27, 0x0
v_exp_f32 v29, v29
v_mfma_f32_16x16x32_bf16 v[196:199], a[36:39], v[56:59], v[196:199]
buffer_load_dwordx4 v3, s[48:51], s32 offen offset:0 sc1 lds
v_mfma_f32_16x16x32_bf16 v[164:167], a[36:39], v[52:55], v[164:167]
v_exp_f32 v30, v30
v_mfma_f32_16x16x32_bf16 v[132:135], a[36:39], v[48:51], v[132:135]
ds_read_b128 a[8:11], v1 offset:10240
v_cvt_pk_bf16_f32 v76, v28, v29
v_mfma_f32_16x16x32_bf16 v[136:139], a[40:43], v[48:51], v[136:139]
v_mfma_f32_16x16x32_bf16 v[168:171], a[40:43], v[52:55], v[168:171]
v_exp_f32 v31, v31
v_mfma_f32_16x16x32_bf16 v[200:203], a[40:43], v[56:59], v[200:203]
v_exp_f32 v32, v32
v_mfma_f32_16x16x32_bf16 v[232:235], a[40:43], v[60:63], v[232:235]
ds_read_b128 a[12:15], v1 offset:11264
v_cvt_pk_bf16_f32 v77, v30, v31
v_mfma_f32_16x16x32_bf16 v[236:239], a[44:47], v[60:63], v[236:239]
v_exp_f32 v33, v33
v_mfma_f32_16x16x32_bf16 v[204:207], a[44:47], v[56:59], v[204:207]
v_cvt_pk_bf16_f32 v66, v32, v33
v_mfma_f32_16x16x32_bf16 v[172:175], a[44:47], v[52:55], v[172:175]
s_mov_b32 s9, 0x0
v_exp_f32 v34, v34
v_mfma_f32_16x16x32_bf16 v[140:143], a[44:47], v[48:51], v[140:143]
ds_read_b128 a[16:19], v1 offset:12288
v_mfma_f32_16x16x32_bf16 v[144:147], a[48:51], v[48:51], v[144:147]
buffer_load_dword a244, v8, s[72:75], s9 offen
v_mfma_f32_16x16x32_bf16 v[176:179], a[48:51], v[52:55], v[176:179]
v_exp_f32 v35, v35
v_mfma_f32_16x16x32_bf16 v[208:211], a[48:51], v[56:59], v[208:211]
v_exp_f32 v36, v36
v_mfma_f32_16x16x32_bf16 v[240:243], a[48:51], v[60:63], v[240:243]
ds_read_b128 a[20:23], v1 offset:13312
v_cvt_pk_bf16_f32 v67, v34, v35
v_mfma_f32_16x16x32_bf16 v[244:247], a[52:55], v[60:63], v[244:247]
v_mfma_f32_16x16x32_bf16 v[212:215], a[52:55], v[56:59], v[212:215]
v_exp_f32 v37, v37
v_mfma_f32_16x16x32_bf16 v[180:183], a[52:55], v[52:55], v[180:183]
ds_read_b128 a[24:27], v1 offset:14336
v_cvt_pk_bf16_f32 v70, v36, v37
v_mfma_f32_16x16x32_bf16 v[148:151], a[52:55], v[48:51], v[148:151]
v_exp_f32 v38, v38
v_mfma_f32_16x16x32_bf16 v[152:155], a[56:59], v[48:51], v[152:155]
v_mfma_f32_16x16x32_bf16 v[184:187], a[56:59], v[52:55], v[184:187]
v_exp_f32 v39, v39
v_mfma_f32_16x16x32_bf16 v[216:219], a[56:59], v[56:59], v[216:219]
buffer_load_dwordx4 v3, s[48:51], s32 offen offset:1024 sc1 lds
v_mfma_f32_16x16x32_bf16 v[248:251], a[56:59], v[60:63], v[248:251]
ds_read_b128 a[28:31], v1 offset:15360
v_cvt_pk_bf16_f32 v71, v38, v39
v_mfma_f32_16x16x32_bf16 v[252:255], a[60:63], v[60:63], v[252:255]
v_exp_f32 v40, v40
v_mfma_f32_16x16x32_bf16 v[220:223], a[60:63], v[56:59], v[220:223]
v_exp_f32 v41, v41
v_mfma_f32_16x16x32_bf16 v[188:191], a[60:63], v[52:55], v[188:191]
ds_read_b128 a[32:35], v1 offset:0
v_cvt_pk_bf16_f32 v74, v40, v41
v_mfma_f32_16x16x32_bf16 v[156:159], a[60:63], v[48:51], v[156:159]
v_smfmac_f32_16x16x64_bf16 a[224:227], a[232:235], v[48:55], v9
v_exp_f32 v42, v42
v_smfmac_f32_16x16x64_bf16 a[228:231], a[232:235], v[56:63], v9
s_waitcnt lgkmcnt(5)
v_exp_f32 v43, v43
v_mfma_f32_16x16x32_bf16 v[16:19], a[0:3], a[160:163], v[80:83]
ds_read_b128 a[36:39], v1 offset:1024
v_cvt_pk_bf16_f32 v75, v42, v43
v_mfma_f32_16x16x32_bf16 v[16:19], a[4:7], a[164:167], v[16:19]
v_exp_f32 v44, v44
v_mfma_f32_16x16x32_bf16 v[16:19], a[8:11], a[168:171], v[16:19]
v_mfma_f32_16x16x32_bf16 v[16:19], a[12:15], a[172:175], v[16:19]
buffer_load_dwordx4 v3, s[48:51], s32 offen offset:2048 sc1 lds
v_mfma_f32_16x16x32_bf16 v[20:23], a[0:3], a[176:179], v[84:87]
ds_read_b128 a[40:43], v1 offset:2048
v_mfma_f32_16x16x32_bf16 v[20:23], a[4:7], a[180:183], v[20:23]
v_exp_f32 v45, v45
v_mfma_f32_16x16x32_bf16 v[20:23], a[8:11], a[184:187], v[20:23]
v_exp_f32 v46, v46
v_mfma_f32_16x16x32_bf16 v[20:23], a[12:15], a[188:191], v[20:23]
ds_read_b128 a[44:47], v1 offset:3072
v_cvt_pk_bf16_f32 v78, v44, v45
v_mfma_f32_16x16x32_bf16 v[24:27], a[0:3], a[192:195], v[88:91]
v_mfma_f32_16x16x32_bf16 v[24:27], a[4:7], a[196:199], v[24:27]
v_exp_f32 v47, v47
v_mfma_f32_16x16x32_bf16 v[24:27], a[8:11], a[200:203], v[24:27]
v_exp_f32 v16, v16
v_mfma_f32_16x16x32_bf16 v[24:27], a[12:15], a[204:207], v[24:27]
ds_read_b128 a[48:51], v1 offset:4096
v_cvt_pk_bf16_f32 v79, v46, v47
v_mfma_f32_16x16x32_bf16 v[28:31], a[0:3], a[208:211], v[92:95]
v_exp_f32 v17, v17
v_mfma_f32_16x16x32_bf16 v[28:31], a[4:7], a[212:215], v[28:31]
s_waitcnt lgkmcnt(5)
v_cvt_pk_bf16_f32 v48, v16, v17
v_mfma_f32_16x16x32_bf16 v[28:31], a[8:11], a[216:219], v[28:31]
buffer_load_dwordx4 v3, s[48:51], s32 offen offset:3072 sc1 lds
v_mfma_f32_16x16x32_bf16 v[28:31], a[12:15], a[220:223], v[28:31]
ds_read_b128 a[52:55], v1 offset:5120
v_mfma_f32_16x16x32_bf16 v[32:35], a[16:19], a[160:163], v[80:83]
v_exp_f32 v18, v18
v_mfma_f32_16x16x32_bf16 v[32:35], a[20:23], a[164:167], v[32:35]
v_exp_f32 v19, v19
v_mfma_f32_16x16x32_bf16 v[32:35], a[24:27], a[168:171], v[32:35]
v_exp_f32 v20, v20
v_mfma_f32_16x16x32_bf16 v[32:35], a[28:31], a[172:175], v[32:35]
ds_read_b128 a[56:59], v1 offset:6144
v_cvt_pk_bf16_f32 v49, v18, v19
v_mfma_f32_16x16x32_bf16 v[36:39], a[16:19], a[176:179], v[84:87]
v_mfma_f32_16x16x32_bf16 v[36:39], a[20:23], a[180:183], v[36:39]
v_exp_f32 v21, v21
v_mfma_f32_16x16x32_bf16 v[36:39], a[24:27], a[184:187], v[36:39]
s_mov_b32 s9, 0x0
v_exp_f32 v22, v22
v_mfma_f32_16x16x32_bf16 v[36:39], a[28:31], a[188:191], v[36:39]
ds_read_b128 a[60:63], v1 offset:7168
v_cvt_pk_bf16_f32 v52, v20, v21
v_mfma_f32_16x16x32_bf16 v[40:43], a[16:19], a[192:195], v[88:91]
buffer_load_dword a244, v8, s[64:67], s9 offen
v_mfma_f32_16x16x32_bf16 v[40:43], a[20:23], a[196:199], v[40:43]
v_mfma_f32_16x16x32_bf16 v[40:43], a[24:27], a[200:203], v[40:43]
v_exp_f32 v23, v23
v_mfma_f32_16x16x32_bf16 v[40:43], a[28:31], a[204:207], v[40:43]
v_exp_f32 v24, v24
v_mfma_f32_16x16x32_bf16 v[44:47], a[16:19], a[208:211], v[92:95]
v_exp_f32 v25, v25
v_mfma_f32_16x16x32_bf16 v[44:47], a[20:23], a[212:215], v[44:47]
v_exp_f32 v26, v26
v_mfma_f32_16x16x32_bf16 v[44:47], a[24:27], a[216:219], v[44:47]
v_exp_f32 v27, v27
v_mfma_f32_16x16x32_bf16 v[44:47], a[28:31], a[220:223], v[44:47]
s_waitcnt lgkmcnt(0)
v_cvt_pk_bf16_f32 v53, v22, v23
v_mfma_f32_16x16x32_bf16 v[128:131], a[32:35], v[64:67], v[128:131]
ds_read_b128 a[0:3], v1 offset:24576
v_cvt_pk_bf16_f32 v56, v24, v25
v_mfma_f32_16x16x32_bf16 v[160:163], a[32:35], v[68:71], v[160:163]
v_exp_f32 v28, v28
v_mfma_f32_16x16x32_bf16 v[192:195], a[32:35], v[72:75], v[192:195]
v_cvt_pk_bf16_f32 v57, v26, v27
v_mfma_f32_16x16x32_bf16 v[224:227], a[32:35], v[76:79], v[224:227]
ds_read_b128 a[4:7], v1 offset:25600
v_mfma_f32_16x16x32_bf16 v[228:231], a[36:39], v[76:79], v[228:231]
v_exp_f32 v29, v29
v_mfma_f32_16x16x32_bf16 v[196:199], a[36:39], v[72:75], v[196:199]
s_add_u32 m0, s27, 0x1000
v_exp_f32 v30, v30
v_mfma_f32_16x16x32_bf16 v[164:167], a[36:39], v[68:71], v[164:167]
buffer_load_dwordx4 v3, s[48:51], s7 offen offset:0 sc1 lds
v_mfma_f32_16x16x32_bf16 v[132:135], a[36:39], v[64:67], v[132:135]
ds_read_b128 a[8:11], v1 offset:26624
v_cvt_pk_bf16_f32 v60, v28, v29
v_mfma_f32_16x16x32_bf16 v[136:139], a[40:43], v[64:67], v[136:139]
v_mfma_f32_16x16x32_bf16 v[168:171], a[40:43], v[68:71], v[168:171]
v_exp_f32 v31, v31
v_mfma_f32_16x16x32_bf16 v[200:203], a[40:43], v[72:75], v[200:203]
v_exp_f32 v32, v32
v_mfma_f32_16x16x32_bf16 v[232:235], a[40:43], v[76:79], v[232:235]
ds_read_b128 a[12:15], v1 offset:27648
v_cvt_pk_bf16_f32 v61, v30, v31
v_mfma_f32_16x16x32_bf16 v[236:239], a[44:47], v[76:79], v[236:239]
v_mfma_f32_16x16x32_bf16 v[204:207], a[44:47], v[72:75], v[204:207]
v_exp_f32 v33, v33
v_mfma_f32_16x16x32_bf16 v[172:175], a[44:47], v[68:71], v[172:175]
v_exp_f32 v34, v34
v_mfma_f32_16x16x32_bf16 v[140:143], a[44:47], v[64:67], v[140:143]
ds_read_b128 a[16:19], v1 offset:28672
v_cvt_pk_bf16_f32 v50, v32, v33
v_mfma_f32_16x16x32_bf16 v[144:147], a[48:51], v[64:67], v[144:147]
v_exp_f32 v35, v35
v_mfma_f32_16x16x32_bf16 v[176:179], a[48:51], v[68:71], v[176:179]
v_cvt_pk_bf16_f32 v51, v34, v35
v_mfma_f32_16x16x32_bf16 v[208:211], a[48:51], v[72:75], v[208:211]
buffer_load_dwordx4 v3, s[48:51], s7 offen offset:1024 sc1 lds
v_mfma_f32_16x16x32_bf16 v[240:243], a[48:51], v[76:79], v[240:243]
ds_read_b128 a[20:23], v1 offset:29696
v_mfma_f32_16x16x32_bf16 v[244:247], a[52:55], v[76:79], v[244:247]
v_exp_f32 v36, v36
v_mfma_f32_16x16x32_bf16 v[212:215], a[52:55], v[72:75], v[212:215]
v_exp_f32 v37, v37
v_mfma_f32_16x16x32_bf16 v[180:183], a[52:55], v[68:71], v[180:183]
ds_read_b128 a[24:27], v1 offset:30720
v_cvt_pk_bf16_f32 v54, v36, v37
v_mfma_f32_16x16x32_bf16 v[148:151], a[52:55], v[64:67], v[148:151]
v_mfma_f32_16x16x32_bf16 v[152:155], a[56:59], v[64:67], v[152:155]
v_exp_f32 v38, v38
v_mfma_f32_16x16x32_bf16 v[184:187], a[56:59], v[68:71], v[184:187]
v_exp_f32 v39, v39
v_mfma_f32_16x16x32_bf16 v[216:219], a[56:59], v[72:75], v[216:219]
ds_read_b128 a[28:31], v1 offset:31744
v_cvt_pk_bf16_f32 v55, v38, v39
v_mfma_f32_16x16x32_bf16 v[248:251], a[56:59], v[76:79], v[248:251]
v_exp_f32 v40, v40
v_mfma_f32_16x16x32_bf16 v[252:255], a[60:63], v[76:79], v[252:255]
v_mfma_f32_16x16x32_bf16 v[220:223], a[60:63], v[72:75], v[220:223]
v_exp_f32 v41, v41
v_mfma_f32_16x16x32_bf16 v[188:191], a[60:63], v[68:71], v[188:191]
buffer_load_dwordx4 v3, s[48:51], s7 offen offset:2048 sc1 lds
v_mfma_f32_16x16x32_bf16 v[156:159], a[60:63], v[64:67], v[156:159]
ds_read_b128 a[32:35], v1 offset:16384
v_cvt_pk_bf16_f32 v58, v40, v41
v_smfmac_f32_16x16x64_bf16 a[224:227], a[232:235], v[64:71], v9
s_waitcnt lgkmcnt(5)
v_exp_f32 v42, v42
v_smfmac_f32_16x16x64_bf16 a[228:231], a[232:235], v[72:79], v9
ds_read_b128 a[36:39], v1 offset:17408
v_mfma_f32_16x16x32_bf16 v[16:19], a[0:3], a[160:163], v[96:99]
v_mfma_f32_16x16x32_bf16 v[16:19], a[4:7], a[164:167], v[16:19]
v_exp_f32 v43, v43
v_mfma_f32_16x16x32_bf16 v[16:19], a[8:11], a[168:171], v[16:19]
v_exp_f32 v44, v44
v_mfma_f32_16x16x32_bf16 v[16:19], a[12:15], a[172:175], v[16:19]
ds_read_b128 a[40:43], v1 offset:18432
v_cvt_pk_bf16_f32 v59, v42, v43
v_mfma_f32_16x16x32_bf16 v[20:23], a[0:3], a[176:179], v[84:87]
v_exp_f32 v45, v45
v_mfma_f32_16x16x32_bf16 v[20:23], a[4:7], a[180:183], v[20:23]
v_cvt_pk_bf16_f32 v62, v44, v45
v_mfma_f32_16x16x32_bf16 v[20:23], a[8:11], a[184:187], v[20:23]
s_mov_b32 s9, 0x400000
v_exp_f32 v46, v46
v_mfma_f32_16x16x32_bf16 v[20:23], a[12:15], a[188:191], v[20:23]
ds_read_b128 a[44:47], v1 offset:19456
v_mfma_f32_16x16x32_bf16 v[24:27], a[0:3], a[192:195], v[88:91]
buffer_load_dword a244, v8, s[64:67], s9 offen
v_mfma_f32_16x16x32_bf16 v[24:27], a[4:7], a[196:199], v[24:27]
v_exp_f32 v47, v47
v_mfma_f32_16x16x32_bf16 v[24:27], a[8:11], a[200:203], v[24:27]
v_cvt_pk_bf16_f32 v63, v46, v47
v_mfma_f32_16x16x32_bf16 v[24:27], a[12:15], a[204:207], v[24:27]
ds_read_b128 a[48:51], v1 offset:20480
v_mfma_f32_16x16x32_bf16 v[28:31], a[0:3], a[208:211], v[92:95]
v_exp_f32 v16, v16
v_mfma_f32_16x16x32_bf16 v[28:31], a[4:7], a[212:215], v[28:31]
v_exp_f32 v17, v17
v_mfma_f32_16x16x32_bf16 v[28:31], a[8:11], a[216:219], v[28:31]
ds_read_b128 a[52:55], v1 offset:21504
v_cvt_pk_bf16_f32 v64, v16, v17
v_mfma_f32_16x16x32_bf16 v[28:31], a[12:15], a[220:223], v[28:31]
s_waitcnt lgkmcnt(6)
v_exp_f32 v18, v18
v_mfma_f32_16x16x32_bf16 v[32:35], a[16:19], a[160:163], v[100:103]
v_mfma_f32_16x16x32_bf16 v[32:35], a[20:23], a[164:167], v[32:35]
v_exp_f32 v19, v19
v_mfma_f32_16x16x32_bf16 v[32:35], a[24:27], a[168:171], v[32:35]
ds_read_b128 a[56:59], v1 offset:22528
v_cvt_pk_bf16_f32 v65, v18, v19
v_mfma_f32_16x16x32_bf16 v[32:35], a[28:31], a[172:175], v[32:35]
v_exp_f32 v20, v20
v_mfma_f32_16x16x32_bf16 v[36:39], a[16:19], a[176:179], v[84:87]
buffer_load_dwordx4 v3, s[48:51], s7 offen offset:3072 sc1 lds
v_mfma_f32_16x16x32_bf16 v[36:39], a[20:23], a[180:183], v[36:39]
s_add_u32 s32, s32, 0x8000
v_mfma_f32_16x16x32_bf16 v[36:39], a[24:27], a[184:187], v[36:39]
ds_read_b128 a[60:63], v1 offset:23552
v_xor_b32 v1, 0x8000, v1
v_mfma_f32_16x16x32_bf16 v[36:39], a[28:31], a[188:191], v[36:39]
s_add_u32 s7, s7, 0x8000
v_exp_f32 v21, v21
v_mfma_f32_16x16x32_bf16 v[40:43], a[16:19], a[192:195], v[88:91]
s_xor_b32 s27, s27, 0x38000
v_exp_f32 v22, v22
v_mfma_f32_16x16x32_bf16 v[40:43], a[20:23], a[196:199], v[40:43]
v_exp_f32 v23, v23
v_mfma_f32_16x16x32_bf16 v[40:43], a[24:27], a[200:203], v[40:43]
v_cvt_pk_bf16_f32 v68, v20, v21
v_cvt_pk_bf16_f32 v69, v22, v23
v_mfma_f32_16x16x32_bf16 v[40:43], a[28:31], a[204:207], v[40:43]
v_exp_f32 v24, v24
v_mfma_f32_16x16x32_bf16 v[44:47], a[16:19], a[208:211], v[92:95]
v_exp_f32 v25, v25
v_mfma_f32_16x16x32_bf16 v[44:47], a[20:23], a[212:215], v[44:47]
v_exp_f32 v26, v26
v_mfma_f32_16x16x32_bf16 v[44:47], a[24:27], a[216:219], v[44:47]
s_waitcnt vmcnt(19) lgkmcnt(0)
v_exp_f32 v27, v27
v_mfma_f32_16x16x32_bf16 v[44:47], a[28:31], a[220:223], v[44:47]
s_barrier
L_att_l1_1:
v_mfma_f32_16x16x32_bf16 v[128:131], a[32:35], v[48:51], v[128:131]
ds_read_b128 a[0:3], v2 offset:8192
v_cvt_pk_bf16_f32 v72, v24, v25
v_mfma_f32_16x16x32_bf16 v[160:163], a[32:35], v[52:55], v[160:163]
s_lshr_b32 s44, s2, 6
v_exp_f32 v28, v28
v_mfma_f32_16x16x32_bf16 v[192:195], a[32:35], v[56:59], v[192:195]
s_add_u32 m0, s19, 0x0
s_lshl_b32 s45, s44, 1
v_cvt_pk_bf16_f32 v73, v26, v27
v_mfma_f32_16x16x32_bf16 v[224:227], a[32:35], v[60:63], v[224:227]
ds_read_b128 a[4:7], v2 offset:9216
s_add_u32 s45, s45, s100
v_mfma_f32_16x16x32_bf16 v[228:231], a[36:39], v[60:63], v[228:231]
buffer_load_dwordx4 v3, s[48:51], s32 offen offset:0 sc1 lds
v_mfma_f32_16x16x32_bf16 v[196:199], a[36:39], v[56:59], v[196:199]
s_and_b32 s60, s45, 3
v_exp_f32 v29, v29
v_mfma_f32_16x16x32_bf16 v[164:167], a[36:39], v[52:55], v[164:167]
ds_read_b128 a[8:11], v2 offset:10240
v_cvt_pk_bf16_f32 v76, v28, v29
v_mfma_f32_16x16x32_bf16 v[132:135], a[36:39], v[48:51], v[132:135]
s_sub_u32 s60, s60, s44
v_exp_f32 v30, v30
v_mfma_f32_16x16x32_bf16 v[136:139], a[40:43], v[48:51], v[136:139]
s_add_u32 s60, s60, 4
v_exp_f32 v31, v31
v_mfma_f32_16x16x32_bf16 v[168:171], a[40:43], v[52:55], v[168:171]
ds_read_b128 a[12:15], v2 offset:11264
v_cvt_pk_bf16_f32 v77, v30, v31
v_mfma_f32_16x16x32_bf16 v[200:203], a[40:43], v[56:59], v[200:203]
s_lshl_b32 s60, s60, 14
s_and_b32 s60, s60, 0x7c000
s_lshl_b32 s61, s60, 3
v_mfma_f32_16x16x32_bf16 v[232:235], a[40:43], v[60:63], v[232:235]
s_add_u32 s62, s61, s12
v_exp_f32 v32, v32
v_mfma_f32_16x16x32_bf16 v[236:239], a[44:47], v[60:63], v[236:239]
s_mov_b32 s9, 0x200000
v_exp_f32 v33, v33
v_mfma_f32_16x16x32_bf16 v[204:207], a[44:47], v[56:59], v[204:207]
ds_read_b128 a[16:19], v2 offset:12288
v_cvt_pk_bf16_f32 v66, v32, v33
v_mfma_f32_16x16x32_bf16 v[172:175], a[44:47], v[52:55], v[172:175]
buffer_load_dword a244, v8, s[64:67], s9 offen
v_mfma_f32_16x16x32_bf16 v[140:143], a[44:47], v[48:51], v[140:143]
s_mul_i32 s44, s44, -8
v_exp_f32 v34, v34
v_mfma_f32_16x16x32_bf16 v[144:147], a[48:51], v[48:51], v[144:147]
ds_read_b128 a[20:23], v2 offset:13312
s_lshl_b32 s44, 4, s44
v_mfma_f32_16x16x32_bf16 v[176:179], a[48:51], v[52:55], v[176:179]
s_mul_i32 s45, s45, -8
v_exp_f32 v35, v35
v_mfma_f32_16x16x32_bf16 v[208:211], a[48:51], v[56:59], v[208:211]
s_lshl_b32 s45, 4, s45
s_add_u32 s44, s44, 0x21212121
v_cvt_pk_bf16_f32 v67, v34, v35
v_mfma_f32_16x16x32_bf16 v[240:243], a[48:51], v[60:63], v[240:243]
ds_read_b128 a[24:27], v2 offset:14336
s_sub_u32 s44, s44, s45
v_mfma_f32_16x16x32_bf16 v[244:247], a[52:55], v[60:63], v[244:247]
s_bfe_u32 s56, s44, 0x80000
v_exp_f32 v36, v36
v_mfma_f32_16x16x32_bf16 v[212:215], a[52:55], v[56:59], v[212:215]
s_lshl_b32 s56, s56, 14
v_exp_f32 v37, v37
v_mfma_f32_16x16x32_bf16 v[180:183], a[52:55], v[52:55], v[180:183]
s_bfe_u32 s57, s44, 0x80008
v_exp_f32 v38, v38
v_mfma_f32_16x16x32_bf16 v[148:151], a[52:55], v[48:51], v[148:151]
buffer_load_dwordx4 v3, s[48:51], s32 offen offset:1024 sc1 lds
v_mfma_f32_16x16x32_bf16 v[152:155], a[56:59], v[48:51], v[152:155]
ds_read_b128 a[28:31], v2 offset:15360
v_cvt_pk_bf16_f32 v70, v36, v37
v_mfma_f32_16x16x32_bf16 v[184:187], a[56:59], v[52:55], v[184:187]
s_lshl_b32 s57, s57, 14
s_bfe_u32 s58, s44, 0x80010
s_lshl_b32 s58, s58, 14
v_mfma_f32_16x16x32_bf16 v[216:219], a[56:59], v[56:59], v[216:219]
ds_read_b128 a[32:35], v2 offset:0
s_bfe_u32 s59, s44, 0x80018
v_mfma_f32_16x16x32_bf16 v[248:251], a[56:59], v[60:63], v[248:251]
s_lshl_b32 s59, s59, 14
v_exp_f32 v39, v39
v_mfma_f32_16x16x32_bf16 v[252:255], a[60:63], v[60:63], v[252:255]
v_exp_f32 v40, v40
v_mfma_f32_16x16x32_bf16 v[220:223], a[60:63], v[56:59], v[220:223]
ds_read_b128 a[36:39], v2 offset:1024
v_cvt_pk_bf16_f32 v71, v38, v39
v_mfma_f32_16x16x32_bf16 v[188:191], a[60:63], v[52:55], v[188:191]
v_exp_f32 v41, v41
v_mfma_f32_16x16x32_bf16 v[156:159], a[60:63], v[48:51], v[156:159]
s_waitcnt lgkmcnt(6)
v_exp_f32 v42, v42
v_smfmac_f32_16x16x64_bf16 a[224:227], a[232:235], v[48:55], v9
buffer_load_dwordx4 v3, s[48:51], s32 offen offset:2048 sc1 lds
v_smfmac_f32_16x16x64_bf16 a[228:231], a[232:235], v[56:63], v9
ds_read_b128 a[40:43], v2 offset:2048
v_cvt_pk_bf16_f32 v74, v40, v41
v_mfma_f32_16x16x32_bf16 v[20:23], a[0:3], a[176:179], v[104:107]
v_mfma_f32_16x16x32_bf16 v[20:23], a[4:7], a[180:183], v[20:23]
v_exp_f32 v43, v43
v_mfma_f32_16x16x32_bf16 v[20:23], a[8:11], a[184:187], v[20:23]
ds_read_b128 a[44:47], v2 offset:3072
v_cvt_pk_bf16_f32 v75, v42, v43
v_mfma_f32_16x16x32_bf16 v[20:23], a[12:15], a[188:191], v[20:23]
v_exp_f32 v44, v44
v_mfma_f32_16x16x32_bf16 v[24:27], a[0:3], a[192:195], v[88:91]
v_exp_f32 v45, v45
v_mfma_f32_16x16x32_bf16 v[24:27], a[4:7], a[196:199], v[24:27]
ds_read_b128 a[48:51], v2 offset:4096
v_cvt_pk_bf16_f32 v78, v44, v45
v_mfma_f32_16x16x32_bf16 v[24:27], a[8:11], a[200:203], v[24:27]
v_mfma_f32_16x16x32_bf16 v[24:27], a[12:15], a[204:207], v[24:27]
v_exp_f32 v46, v46
v_mfma_f32_16x16x32_bf16 v[28:31], a[0:3], a[208:211], v[92:95]
buffer_load_dwordx4 v3, s[48:51], s32 offen offset:3072 sc1 lds
v_mfma_f32_16x16x32_bf16 v[28:31], a[4:7], a[212:215], v[28:31]
ds_read_b128 a[52:55], v2 offset:5120
v_mfma_f32_16x16x32_bf16 v[28:31], a[8:11], a[216:219], v[28:31]
v_exp_f32 v47, v47
v_mfma_f32_16x16x32_bf16 v[28:31], a[12:15], a[220:223], v[28:31]
s_waitcnt lgkmcnt(6)
v_exp_f32 v20, v20
v_mfma_f32_16x16x32_bf16 v[36:39], a[16:19], a[176:179], v[108:111]
ds_read_b128 a[56:59], v2 offset:6144
v_cvt_pk_bf16_f32 v79, v46, v47
v_mfma_f32_16x16x32_bf16 v[36:39], a[20:23], a[180:183], v[36:39]
v_exp_f32 v21, v21
v_mfma_f32_16x16x32_bf16 v[36:39], a[24:27], a[184:187], v[36:39]
v_cvt_pk_bf16_f32 v52, v20, v21
v_mfma_f32_16x16x32_bf16 v[36:39], a[28:31], a[188:191], v[36:39]
ds_read_b128 a[60:63], v2 offset:7168
v_mfma_f32_16x16x32_bf16 v[40:43], a[16:19], a[192:195], v[88:91]
s_mov_b32 s9, 0x600000
v_exp_f32 v22, v22
v_mfma_f32_16x16x32_bf16 v[40:43], a[20:23], a[196:199], v[40:43]
buffer_load_dword a244, v8, s[64:67], s9 offen
v_mfma_f32_16x16x32_bf16 v[40:43], a[24:27], a[200:203], v[40:43]
v_exp_f32 v23, v23
v_mfma_f32_16x16x32_bf16 v[40:43], a[28:31], a[204:207], v[40:43]
v_exp_f32 v24, v24
v_mfma_f32_16x16x32_bf16 v[44:47], a[16:19], a[208:211], v[92:95]
v_exp_f32 v25, v25
v_mfma_f32_16x16x32_bf16 v[44:47], a[20:23], a[212:215], v[44:47]
v_exp_f32 v26, v26
v_mfma_f32_16x16x32_bf16 v[44:47], a[24:27], a[216:219], v[44:47]
v_exp_f32 v27, v27
v_mfma_f32_16x16x32_bf16 v[44:47], a[28:31], a[220:223], v[44:47]
s_waitcnt lgkmcnt(0)
v_cvt_pk_bf16_f32 v53, v22, v23
v_mfma_f32_16x16x32_bf16 v[128:131], a[32:35], v[64:67], v[128:131]
ds_read_b128 a[0:3], v2 offset:24576
v_cvt_pk_bf16_f32 v56, v24, v25
v_mfma_f32_16x16x32_bf16 v[160:163], a[32:35], v[68:71], v[160:163]
v_exp_f32 v28, v28
v_mfma_f32_16x16x32_bf16 v[192:195], a[32:35], v[72:75], v[192:195]
ds_read_b128 a[4:7], v2 offset:25600
v_cvt_pk_bf16_f32 v57, v26, v27
v_mfma_f32_16x16x32_bf16 v[224:227], a[32:35], v[76:79], v[224:227]
s_add_u32 m0, s19, 0x1000
v_mfma_f32_16x16x32_bf16 v[228:231], a[36:39], v[76:79], v[228:231]
buffer_load_dwordx4 v3, s[48:51], s7 offen offset:0 sc1 lds
v_mfma_f32_16x16x32_bf16 v[196:199], a[36:39], v[72:75], v[196:199]
ds_read_b128 a[8:11], v2 offset:26624
v_mfma_f32_16x16x32_bf16 v[164:167], a[36:39], v[68:71], v[164:167]
v_exp_f32 v29, v29
v_mfma_f32_16x16x32_bf16 v[132:135], a[36:39], v[64:67], v[132:135]
v_exp_f32 v30, v30
v_mfma_f32_16x16x32_bf16 v[136:139], a[40:43], v[64:67], v[136:139]
ds_read_b128 a[12:15], v2 offset:27648
v_cvt_pk_bf16_f32 v60, v28, v29
v_mfma_f32_16x16x32_bf16 v[168:171], a[40:43], v[68:71], v[168:171]
v_exp_f32 v31, v31
v_mfma_f32_16x16x32_bf16 v[200:203], a[40:43], v[72:75], v[200:203]
v_exp_f32 v36, v36
v_mfma_f32_16x16x32_bf16 v[232:235], a[40:43], v[76:79], v[232:235]
ds_read_b128 a[16:19], v2 offset:28672
v_cvt_pk_bf16_f32 v61, v30, v31
v_mfma_f32_16x16x32_bf16 v[236:239], a[44:47], v[76:79], v[236:239]
buffer_load_dwordx4 v3, s[48:51], s7 offen offset:1024 sc1 lds
v_mfma_f32_16x16x32_bf16 v[204:207], a[44:47], v[72:75], v[204:207]
ds_read_b128 a[20:23], v2 offset:29696
v_mfma_f32_16x16x32_bf16 v[172:175], a[44:47], v[68:71], v[172:175]
v_mfma_f32_16x16x32_bf16 v[140:143], a[44:47], v[64:67], v[140:143]
v_exp_f32 v37, v37
v_mfma_f32_16x16x32_bf16 v[144:147], a[48:51], v[64:67], v[144:147]
ds_read_b128 a[24:27], v2 offset:30720
v_cvt_pk_bf16_f32 v54, v36, v37
v_mfma_f32_16x16x32_bf16 v[176:179], a[48:51], v[68:71], v[176:179]
v_exp_f32 v38, v38
v_mfma_f32_16x16x32_bf16 v[208:211], a[48:51], v[72:75], v[208:211]
v_exp_f32 v39, v39
v_mfma_f32_16x16x32_bf16 v[240:243], a[48:51], v[76:79], v[240:243]
ds_read_b128 a[28:31], v2 offset:31744
v_cvt_pk_bf16_f32 v55, v38, v39
v_mfma_f32_16x16x32_bf16 v[244:247], a[52:55], v[76:79], v[244:247]
v_exp_f32 v40, v40
v_mfma_f32_16x16x32_bf16 v[212:215], a[52:55], v[72:75], v[212:215]
buffer_load_dwordx4 v3, s[48:51], s7 offen offset:2048 sc1 lds
v_mfma_f32_16x16x32_bf16 v[180:183], a[52:55], v[68:71], v[180:183]
ds_read_b128 a[32:35], v2 offset:16384
v_mfma_f32_16x16x32_bf16 v[148:151], a[52:55], v[64:67], v[148:151]
v_mfma_f32_16x16x32_bf16 v[152:155], a[56:59], v[64:67], v[152:155]
ds_read_b128 a[36:39], v2 offset:17408
v_mfma_f32_16x16x32_bf16 v[184:187], a[56:59], v[68:71], v[184:187]
v_exp_f32 v41, v41
v_mfma_f32_16x16x32_bf16 v[216:219], a[56:59], v[72:75], v[216:219]
v_exp_f32 v42, v42
v_mfma_f32_16x16x32_bf16 v[248:251], a[56:59], v[76:79], v[248:251]
ds_read_b128 a[40:43], v2 offset:18432
v_cvt_pk_bf16_f32 v58, v40, v41
v_mfma_f32_16x16x32_bf16 v[252:255], a[60:63], v[76:79], v[252:255]
v_exp_f32 v43, v43
v_mfma_f32_16x16x32_bf16 v[220:223], a[60:63], v[72:75], v[220:223]
buffer_load_dwordx4 v3, s[48:51], s7 offen offset:3072 sc1 lds
v_mfma_f32_16x16x32_bf16 v[188:191], a[60:63], v[68:71], v[188:191]
ds_read_b128 a[44:47], v2 offset:19456
v_cvt_pk_bf16_f32 v59, v42, v43
v_mfma_f32_16x16x32_bf16 v[156:159], a[60:63], v[64:67], v[156:159]
v_exp_f32 v44, v44
v_smfmac_f32_16x16x64_bf16 a[224:227], a[232:235], v[64:71], v9
s_waitcnt lgkmcnt(8)
v_exp_f32 v45, v45
v_smfmac_f32_16x16x64_bf16 a[228:231], a[232:235], v[72:79], v9
ds_read_b128 a[48:51], v2 offset:20480
v_add_u32 v4, s0, v3
v_mfma_f32_16x16x32_bf16 v[24:27], a[0:3], a[192:195], v[88:91]
v_cvt_pk_bf16_f32 v62, v44, v45
v_mfma_f32_16x16x32_bf16 v[24:27], a[4:7], a[196:199], v[24:27]
ds_read_b128 a[52:55], v2 offset:21504
v_mov_b32 v5, s1
v_mfma_f32_16x16x32_bf16 v[24:27], a[8:11], a[200:203], v[24:27]
v_exp_f32 v46, v46
v_mfma_f32_16x16x32_bf16 v[24:27], a[12:15], a[204:207], v[24:27]
global_load_dword a244, v[4:5], off sc1
v_mfma_f32_16x16x32_bf16 v[28:31], a[0:3], a[208:211], v[92:95]
ds_read_b128 a[56:59], v2 offset:22528
v_mfma_f32_16x16x32_bf16 v[28:31], a[4:7], a[212:215], v[28:31]
s_add_u32 s32, s32, 0x8000
v_exp_f32 v47, v47
v_mfma_f32_16x16x32_bf16 v[28:31], a[8:11], a[216:219], v[28:31]
s_waitcnt lgkmcnt(7)
v_cvt_pk_bf16_f32 v63, v46, v47
v_mfma_f32_16x16x32_bf16 v[28:31], a[12:15], a[220:223], v[28:31]
ds_read_b128 a[60:63], v2 offset:23552
s_add_u32 s7, s7, 0x8000
v_mfma_f32_16x16x32_bf16 v[40:43], a[16:19], a[192:195], v[88:91]
s_xor_b32 s19, s19, 0x8000
v_xor_b32 v2, 0x38000, v2
v_mfma_f32_16x16x32_bf16 v[40:43], a[20:23], a[196:199], v[40:43]
s_sub_u32 s15, 7, s6
v_exp_f32 v24, v24
v_mfma_f32_16x16x32_bf16 v[40:43], a[24:27], a[200:203], v[40:43]
s_lshl_b32 s15, s15, 1
v_exp_f32 v25, v25
v_mfma_f32_16x16x32_bf16 v[40:43], a[28:31], a[204:207], v[40:43]
v_exp_f32 v26, v26
v_mfma_f32_16x16x32_bf16 v[44:47], a[16:19], a[208:211], v[92:95]
v_exp_f32 v27, v27
v_mfma_f32_16x16x32_bf16 v[44:47], a[20:23], a[212:215], v[44:47]
v_exp_f32 v28, v28
v_mfma_f32_16x16x32_bf16 v[44:47], a[24:27], a[216:219], v[44:47]
s_waitcnt vmcnt(22) lgkmcnt(0)
v_exp_f32 v29, v29
v_mfma_f32_16x16x32_bf16 v[44:47], a[28:31], a[220:223], v[44:47]
s_barrier
s_cbranch_scc0 L_att_lh0_1
v_mfma_f32_16x16x32_bf16 v[160:163], a[32:35], v[52:55], v[160:163]
ds_read_b128 a[0:3], v1 offset:8192
v_cvt_pk_bf16_f32 v72, v24, v25
v_mfma_f32_16x16x32_bf16 v[192:195], a[32:35], v[56:59], v[192:195]
v_exp_f32 v30, v30
v_mfma_f32_16x16x32_bf16 v[224:227], a[32:35], v[60:63], v[224:227]
ds_read_b128 a[4:7], v1 offset:9216
v_cvt_pk_bf16_f32 v73, v26, v27
v_mfma_f32_16x16x32_bf16 v[228:231], a[36:39], v[60:63], v[228:231]
s_add_u32 m0, s27, 0x0
v_cvt_pk_bf16_f32 v76, v28, v29
v_accvgpr_read_b32 v6, a224
v_mfma_f32_16x16x32_bf16 v[196:199], a[36:39], v[56:59], v[196:199]
buffer_load_dwordx4 v3, s[48:51], s32 offen offset:0 sc1 lds
v_mfma_f32_16x16x32_bf16 v[164:167], a[36:39], v[52:55], v[164:167]
ds_read_b128 a[8:11], v1 offset:10240
v_accvgpr_read_b32 v7, a225
v_mfma_f32_16x16x32_bf16 v[168:171], a[40:43], v[52:55], v[168:171]
ds_read_b128 a[12:15], v1 offset:11264
v_add_f32 v6, v6, v7
v_mfma_f32_16x16x32_bf16 v[200:203], a[40:43], v[56:59], v[200:203]
v_exp_f32 v31, v31
v_mfma_f32_16x16x32_bf16 v[232:235], a[40:43], v[60:63], v[232:235]
v_exp_f32 v40, v40
v_mfma_f32_16x16x32_bf16 v[236:239], a[44:47], v[60:63], v[236:239]
ds_read_b128 a[16:19], v1 offset:12288
v_cvt_pk_bf16_f32 v77, v30, v31
v_mfma_f32_16x16x32_bf16 v[204:207], a[44:47], v[56:59], v[204:207]
v_cmp_nge_f32 vcc, 0x6f800000, v6
v_mfma_f32_16x16x32_bf16 v[172:175], a[44:47], v[52:55], v[172:175]
ds_read_b128 a[20:23], v1 offset:13312
v_mfma_f32_16x16x32_bf16 v[176:179], a[48:51], v[52:55], v[176:179]
v_exp_f32 v41, v41
v_mfma_f32_16x16x32_bf16 v[208:211], a[48:51], v[56:59], v[208:211]
ds_read_b128 a[24:27], v1 offset:14336
v_cvt_pk_bf16_f32 v74, v40, v41
v_mfma_f32_16x16x32_bf16 v[240:243], a[48:51], v[60:63], v[240:243]
buffer_load_dwordx4 v3, s[48:51], s32 offen offset:1024 sc1 lds
v_mfma_f32_16x16x32_bf16 v[244:247], a[52:55], v[60:63], v[244:247]
v_exp_f32 v42, v42
v_mfma_f32_16x16x32_bf16 v[212:215], a[52:55], v[56:59], v[212:215]
ds_read_b128 a[28:31], v1 offset:15360
v_mfma_f32_16x16x32_bf16 v[180:183], a[52:55], v[52:55], v[180:183]
v_exp_f32 v43, v43
v_mfma_f32_16x16x32_bf16 v[184:187], a[56:59], v[52:55], v[184:187]
ds_read_b128 a[32:35], v1 offset:0
v_cvt_pk_bf16_f32 v75, v42, v43
v_mfma_f32_16x16x32_bf16 v[216:219], a[56:59], v[56:59], v[216:219]
v_rcp_f32 v6, v6
v_mfma_f32_16x16x32_bf16 v[248:251], a[56:59], v[60:63], v[248:251]
ds_read_b128 a[36:39], v1 offset:1024
s_or_b64 s[34:35], s[34:35], vcc
v_mfma_f32_16x16x32_bf16 v[252:255], a[60:63], v[60:63], v[252:255]
s_add_u32 s8, s28, 0x0
v_exp_f32 v44, v44
v_mfma_f32_16x16x32_bf16 v[220:223], a[60:63], v[56:59], v[220:223]
v_exp_f32 v45, v45
v_mfma_f32_16x16x32_bf16 v[188:191], a[60:63], v[52:55], v[188:191]
ds_read_b128 a[40:43], v1 offset:2048
v_cvt_pk_bf16_f32 v78, v44, v45
v_mfma_f32_16x16x32_bf16 a[224:227], a[236:239], v[52:55], a[224:227]
buffer_load_dwordx4 v3, s[48:51], s32 offen offset:2048 sc1 lds
v_smfmac_f32_16x16x64_bf16 a[228:231], a[232:235], v[56:63], v9
ds_read_b128 a[44:47], v1 offset:3072
s_waitcnt lgkmcnt(8)
v_mfma_f32_16x16x32_bf16 v[24:27], a[0:3], a[192:195], v[88:91]
v_exp_f32 v46, v46
v_mfma_f32_16x16x32_bf16 v[24:27], a[4:7], a[196:199], v[24:27]
ds_read_b128 a[48:51], v1 offset:4096
v_mul_f32 v128, v6, v128
v_mfma_f32_16x16x32_bf16 v[24:27], a[8:11], a[200:203], v[24:27]
v_mul_f32 v129, v6, v129
v_mul_f32 v130, v6, v130
v_mfma_f32_16x16x32_bf16 v[24:27], a[12:15], a[204:207], v[24:27]
v_exp_f32 v47, v47
v_mfma_f32_16x16x32_bf16 v[28:31], a[0:3], a[208:211], v[92:95]
ds_read_b128 a[52:55], v1 offset:5120
v_cvt_pk_bf16_f32 v79, v46, v47
v_mfma_f32_16x16x32_bf16 v[28:31], a[4:7], a[212:215], v[28:31]
v_mul_f32 v131, v6, v131
v_mul_f32 v132, v6, v132
v_mfma_f32_16x16x32_bf16 v[28:31], a[8:11], a[216:219], v[28:31]
ds_read_b128 a[56:59], v1 offset:6144
v_mul_f32 v133, v6, v133
v_mfma_f32_16x16x32_bf16 v[28:31], a[12:15], a[220:223], v[28:31]
s_waitcnt lgkmcnt(7)
v_exp_f32 v24, v24
v_mfma_f32_16x16x32_bf16 v[40:43], a[16:19], a[192:195], v[88:91]
buffer_load_dwordx4 v3, s[48:51], s32 offen offset:3072 sc1 lds
v_mfma_f32_16x16x32_bf16 v[40:43], a[20:23], a[196:199], v[40:43]
ds_read_b128 a[60:63], v1 offset:7168
v_mul_f32 v134, v6, v134
v_mfma_f32_16x16x32_bf16 v[40:43], a[24:27], a[200:203], v[40:43]
s_add_u32 s32, s32, 0x8000
v_exp_f32 v25, v25
v_mfma_f32_16x16x32_bf16 v[40:43], a[28:31], a[204:207], v[40:43]
v_exp_f32 v26, v26
v_mfma_f32_16x16x32_bf16 v[44:47], a[16:19], a[208:211], v[92:95]
v_exp_f32 v27, v27
v_mfma_f32_16x16x32_bf16 v[44:47], a[20:23], a[212:215], v[44:47]
v_exp_f32 v28, v28
v_mfma_f32_16x16x32_bf16 v[44:47], a[24:27], a[216:219], v[44:47]
v_exp_f32 v29, v29
v_mfma_f32_16x16x32_bf16 v[44:47], a[28:31], a[220:223], v[44:47]
s_waitcnt lgkmcnt(0)
v_mul_f32 v135, v6, v135
v_cvt_pk_bf16_f32 v128, v128, v129
v_mfma_f32_16x16x32_bf16 v[192:195], a[32:35], v[72:75], v[192:195]
s_add_u32 m0, s27, 0x1000
v_exp_f32 v30, v30
v_mfma_f32_16x16x32_bf16 v[224:227], a[32:35], v[76:79], v[224:227]
buffer_load_dwordx4 v3, s[48:51], s7 offen offset:0 sc1 lds
v_mfma_f32_16x16x32_bf16 v[228:231], a[36:39], v[76:79], v[228:231]
v_exp_f32 v31, v31
v_mfma_f32_16x16x32_bf16 v[196:199], a[36:39], v[72:75], v[196:199]
ds_read_b128 a[0:3], v1 offset:24576
v_cvt_pk_bf16_f32 v56, v24, v25
v_mfma_f32_16x16x32_bf16 v[200:203], a[40:43], v[72:75], v[200:203]
ds_read_b128 a[4:7], v1 offset:25600
v_cvt_pk_bf16_f32 v57, v26, v27
v_mfma_f32_16x16x32_bf16 v[232:235], a[40:43], v[76:79], v[232:235]
v_exp_f32 v40, v40
v_mfma_f32_16x16x32_bf16 v[236:239], a[44:47], v[76:79], v[236:239]
ds_read_b128 a[8:11], v1 offset:26624
v_cvt_pk_bf16_f32 v60, v28, v29
v_mfma_f32_16x16x32_bf16 v[204:207], a[44:47], v[72:75], v[204:207]
v_exp_f32 v41, v41
v_mfma_f32_16x16x32_bf16 v[208:211], a[48:51], v[72:75], v[208:211]
ds_read_b128 a[12:15], v1 offset:27648
v_cvt_pk_bf16_f32 v61, v30, v31
v_mfma_f32_16x16x32_bf16 v[240:243], a[48:51], v[76:79], v[240:243]
ds_read_b128 a[16:19], v1 offset:28672
v_cvt_pk_bf16_f32 v58, v40, v41
v_mfma_f32_16x16x32_bf16 v[244:247], a[52:55], v[76:79], v[244:247]
v_exp_f32 v42, v42
v_mfma_f32_16x16x32_bf16 v[212:215], a[52:55], v[72:75], v[212:215]
buffer_load_dwordx4 v3, s[48:51], s7 offen offset:1024 sc1 lds
v_mfma_f32_16x16x32_bf16 v[216:219], a[56:59], v[72:75], v[216:219]
ds_read_b128 a[20:23], v1 offset:29696
v_cvt_pk_bf16_f32 v129, v130, v131
v_mfma_f32_16x16x32_bf16 v[248:251], a[56:59], v[76:79], v[248:251]
ds_read_b128 a[24:27], v1 offset:30720
v_cvt_pk_bf16_f32 v130, v132, v133
v_mfma_f32_16x16x32_bf16 v[252:255], a[60:63], v[76:79], v[252:255]
ds_read_b128 a[28:31], v1 offset:31744
v_cvt_pk_bf16_f32 v131, v134, v135
v_mfma_f32_16x16x32_bf16 v[220:223], a[60:63], v[72:75], v[220:223]
s_waitcnt lgkmcnt(4)
v_exp_f32 v43, v43
v_smfmac_f32_16x16x64_bf16 a[228:231], a[232:235], v[72:79], v9
ds_read_b128 a[32:35], v1 offset:16384
v_cvt_pk_bf16_f32 v59, v42, v43
v_mfma_f32_16x16x32_bf16 v[24:27], a[0:3], a[192:195], v[88:91]
ds_read_b128 a[36:39], v1 offset:17408
buffer_store_dwordx4 v[128:131], v3, s[88:91], s8 offen sc1
v_mfma_f32_16x16x32_bf16 v[24:27], a[4:7], a[196:199], v[24:27]
buffer_load_dwordx4 v3, s[48:51], s7 offen offset:2048 sc1 lds
v_mfma_f32_16x16x32_bf16 v[24:27], a[8:11], a[200:203], v[24:27]
ds_read_b128 a[40:43], v1 offset:18432
v_exp_f32 v44, v44
v_mfma_f32_16x16x32_bf16 v[24:27], a[12:15], a[204:207], v[24:27]
ds_read_b128 a[44:47], v1 offset:19456
v_exp_f32 v45, v45
v_mfma_f32_16x16x32_bf16 v[28:31], a[0:3], a[208:211], v[92:95]
ds_read_b128 a[48:51], v1 offset:20480
v_exp_f32 v46, v46
v_mfma_f32_16x16x32_bf16 v[28:31], a[4:7], a[212:215], v[28:31]
s_waitcnt lgkmcnt(5)
v_exp_f32 v47, v47
v_mfma_f32_16x16x32_bf16 v[28:31], a[8:11], a[216:219], v[28:31]
ds_read_b128 a[52:55], v1 offset:21504
v_cvt_pk_bf16_f32 v62, v44, v45
v_mfma_f32_16x16x32_bf16 v[28:31], a[12:15], a[220:223], v[28:31]
ds_read_b128 a[56:59], v1 offset:22528
v_cvt_pk_bf16_f32 v63, v46, v47
v_mfma_f32_16x16x32_bf16 v[40:43], a[16:19], a[192:195], v[88:91]
ds_read_b128 a[60:63], v1 offset:23552
v_xor_b32 v1, 0x8000, v1
v_mfma_f32_16x16x32_bf16 v[40:43], a[20:23], a[196:199], v[40:43]
buffer_load_dwordx4 v3, s[48:51], s7 offen offset:3072 sc1 lds
v_mfma_f32_16x16x32_bf16 v[40:43], a[24:27], a[200:203], v[40:43]
s_add_u32 s7, s7, 0x8000
v_exp_f32 v24, v24
v_mfma_f32_16x16x32_bf16 v[40:43], a[28:31], a[204:207], v[40:43]
s_xor_b32 s27, s27, 0x38000
v_exp_f32 v25, v25
v_mfma_f32_16x16x32_bf16 v[44:47], a[16:19], a[208:211], v[92:95]
s_add_u32 s8, s28, 0x2000
v_exp_f32 v26, v26
v_mfma_f32_16x16x32_bf16 v[44:47], a[20:23], a[212:215], v[44:47]
v_exp_f32 v27, v27
v_mfma_f32_16x16x32_bf16 v[44:47], a[24:27], a[216:219], v[44:47]
s_waitcnt vmcnt(19) lgkmcnt(0)
v_exp_f32 v28, v28
v_mfma_f32_16x16x32_bf16 v[44:47], a[28:31], a[220:223], v[44:47]
s_barrier
v_exp_f32 v29, v29
v_mul_f32 v136, v6, v136
v_mul_f32 v137, v6, v137
v_mul_f32 v138, v6, v138
v_mul_f32 v139, v6, v139
v_mul_f32 v140, v6, v140
v_mul_f32 v141, v6, v141
v_mul_f32 v142, v6, v142
v_mul_f32 v143, v6, v143
v_cvt_pk_bf16_f32 v136, v136, v137
v_cvt_pk_bf16_f32 v137, v138, v139
v_cvt_pk_bf16_f32 v138, v140, v141
v_cvt_pk_bf16_f32 v139, v142, v143
buffer_store_dwordx4 v[136:139], v3, s[88:91], s8 offen sc1
s_add_u32 s8, s28, 0x4000
v_mul_f32 v144, v6, v144
v_mul_f32 v145, v6, v145
v_mul_f32 v146, v6, v146
v_mul_f32 v147, v6, v147
v_mul_f32 v148, v6, v148
v_mul_f32 v149, v6, v149
v_mul_f32 v150, v6, v150
v_mul_f32 v151, v6, v151
v_cvt_pk_bf16_f32 v144, v144, v145
v_cvt_pk_bf16_f32 v145, v146, v147
v_cvt_pk_bf16_f32 v146, v148, v149
v_cvt_pk_bf16_f32 v147, v150, v151
buffer_store_dwordx4 v[144:147], v3, s[88:91], s8 offen sc1
s_add_u32 s8, s28, 0x6000
v_mul_f32 v152, v6, v152
v_mul_f32 v153, v6, v153
v_mul_f32 v154, v6, v154
v_mul_f32 v155, v6, v155
v_mul_f32 v156, v6, v156
v_mul_f32 v157, v6, v157
v_mul_f32 v158, v6, v158
v_mul_f32 v159, v6, v159
v_cvt_pk_bf16_f32 v152, v152, v153
v_cvt_pk_bf16_f32 v153, v154, v155
v_cvt_pk_bf16_f32 v154, v156, v157
v_cvt_pk_bf16_f32 v155, v158, v159
buffer_store_dwordx4 v[152:155], v3, s[88:91], s8 offen sc1
v_accvgpr_read_b32 v6, a226
v_accvgpr_read_b32 v7, a227
v_add_f32 v6, v6, v7
v_cmp_nge_f32 vcc, 0x6f800000, v6
v_rcp_f32 v6, v6
s_or_b64 s[34:35], s[34:35], vcc
s_add_u32 s8, s29, 0x0
v_pk_mul_f32 v[160:161], v[160:161], v[6:7] op_sel_hi:[1,0]
v_pk_mul_f32 v[162:163], v[162:163], v[6:7] op_sel_hi:[1,0]
v_pk_mul_f32 v[164:165], v[164:165], v[6:7] op_sel_hi:[1,0]
v_pk_mul_f32 v[166:167], v[166:167], v[6:7] op_sel_hi:[1,0]
v_cvt_pk_bf16_f32 v160, v160, v161
v_cvt_pk_bf16_f32 v161, v162, v163
v_cvt_pk_bf16_f32 v162, v164, v165
v_cvt_pk_bf16_f32 v163, v166, v167
buffer_store_dwordx4 v[160:163], v3, s[88:91], s8 offen sc1
s_add_u32 s8, s29, 0x2000
v_pk_mul_f32 v[168:169], v[168:169], v[6:7] op_sel_hi:[1,0]
v_pk_mul_f32 v[170:171], v[170:171], v[6:7] op_sel_hi:[1,0]
v_pk_mul_f32 v[172:173], v[172:173], v[6:7] op_sel_hi:[1,0]
v_pk_mul_f32 v[174:175], v[174:175], v[6:7] op_sel_hi:[1,0]
v_cvt_pk_bf16_f32 v168, v168, v169
v_cvt_pk_bf16_f32 v169, v170, v171
v_cvt_pk_bf16_f32 v170, v172, v173
v_cvt_pk_bf16_f32 v171, v174, v175
buffer_store_dwordx4 v[168:171], v3, s[88:91], s8 offen sc1
s_add_u32 s8, s29, 0x4000
v_pk_mul_f32 v[176:177], v[176:177], v[6:7] op_sel_hi:[1,0]
v_pk_mul_f32 v[178:179], v[178:179], v[6:7] op_sel_hi:[1,0]
v_pk_mul_f32 v[180:181], v[180:181], v[6:7] op_sel_hi:[1,0]
v_pk_mul_f32 v[182:183], v[182:183], v[6:7] op_sel_hi:[1,0]
v_cvt_pk_bf16_f32 v176, v176, v177
v_cvt_pk_bf16_f32 v177, v178, v179
v_cvt_pk_bf16_f32 v178, v180, v181
v_cvt_pk_bf16_f32 v179, v182, v183
buffer_store_dwordx4 v[176:179], v3, s[88:91], s8 offen sc1
s_add_u32 s8, s29, 0x6000
v_pk_mul_f32 v[184:185], v[184:185], v[6:7] op_sel_hi:[1,0]
v_pk_mul_f32 v[186:187], v[186:187], v[6:7] op_sel_hi:[1,0]
v_pk_mul_f32 v[188:189], v[188:189], v[6:7] op_sel_hi:[1,0]
v_pk_mul_f32 v[190:191], v[190:191], v[6:7] op_sel_hi:[1,0]
v_cvt_pk_bf16_f32 v184, v184, v185
v_cvt_pk_bf16_f32 v185, v186, v187
v_cvt_pk_bf16_f32 v186, v188, v189
v_cvt_pk_bf16_f32 v187, v190, v191
buffer_store_dwordx4 v[184:187], v3, s[88:91], s8 offen sc1
s_getreg_b32 s8, hwreg(HW_REG_HW_ID, 5, 1)
s_cmp_lg_u32 s8, 0
s_cbranch_scc1 L_att_sodd1
s_branch L_att_sodd0
L_att_lh0_1:
v_mfma_f32_16x16x32_bf16 v[160:163], a[32:35], v[52:55], v[160:163]
ds_read_b128 a[0:3], v1 offset:8192
v_cvt_pk_bf16_f32 v72, v24, v25
v_mfma_f32_16x16x32_bf16 v[192:195], a[32:35], v[56:59], v[192:195]
v_exp_f32 v30, v30
v_mfma_f32_16x16x32_bf16 v[224:227], a[32:35], v[60:63], v[224:227]
buffer_load_dword v14, v15, s[84:87], 0 offen offset:192 sc1
v_mfma_f32_16x16x32_bf16 v[228:231], a[36:39], v[60:63], v[228:231]
ds_read_b128 a[4:7], v1 offset:9216
v_cvt_pk_bf16_f32 v73, v26, v27
v_mfma_f32_16x16x32_bf16 v[196:199], a[36:39], v[56:59], v[196:199]
ds_read_b128 a[8:11], v1 offset:10240
v_cvt_pk_bf16_f32 v76, v28, v29
v_mfma_f32_16x16x32_bf16 v[164:167], a[36:39], v[52:55], v[164:167]
s_add_u32 m0, s17, 0x10000
v_exp_f32 v31, v31
v_mfma_f32_16x16x32_bf16 v[168:171], a[40:43], v[52:55], v[168:171]
buffer_load_dwordx4 v12, s[72:75], 0 offen lds
v_mfma_f32_16x16x32_bf16 v[200:203], a[40:43], v[56:59], v[200:203]
ds_read_b128 a[12:15], v1 offset:11264
v_cvt_pk_bf16_f32 v77, v30, v31
v_mfma_f32_16x16x32_bf16 v[232:235], a[40:43], v[60:63], v[232:235]
v_exp_f32 v40, v40
v_mfma_f32_16x16x32_bf16 v[236:239], a[44:47], v[60:63], v[236:239]
ds_read_b128 a[16:19], v1 offset:12288
v_mfma_f32_16x16x32_bf16 v[204:207], a[44:47], v[56:59], v[204:207]
v_exp_f32 v41, v41
v_mfma_f32_16x16x32_bf16 v[172:175], a[44:47], v[52:55], v[172:175]
buffer_load_dwordx4 v13, s[72:75], 0 offen offset:1024 lds
v_mfma_f32_16x16x32_bf16 v[176:179], a[48:51], v[52:55], v[176:179]
ds_read_b128 a[20:23], v1 offset:13312
v_cvt_pk_bf16_f32 v74, v40, v41
v_mfma_f32_16x16x32_bf16 v[208:211], a[48:51], v[56:59], v[208:211]
ds_read_b128 a[24:27], v1 offset:14336
v_mfma_f32_16x16x32_bf16 v[240:243], a[48:51], v[60:63], v[240:243]
v_exp_f32 v42, v42
v_mfma_f32_16x16x32_bf16 v[244:247], a[52:55], v[60:63], v[244:247]
buffer_load_dwordx4 v12, s[72:75], s12 offen offset:2048 lds
v_mfma_f32_16x16x32_bf16 v[212:215], a[52:55], v[56:59], v[212:215]
ds_read_b128 a[28:31], v1 offset:15360
v_mfma_f32_16x16x32_bf16 v[180:183], a[52:55], v[52:55], v[180:183]
v_exp_f32 v43, v43
v_mfma_f32_16x16x32_bf16 v[184:187], a[56:59], v[52:55], v[184:187]
ds_read_b128 a[32:35], v1 offset:0
v_cvt_pk_bf16_f32 v75, v42, v43
v_mfma_f32_16x16x32_bf16 v[216:219], a[56:59], v[56:59], v[216:219]
v_exp_f32 v44, v44
v_mfma_f32_16x16x32_bf16 v[248:251], a[56:59], v[60:63], v[248:251]
buffer_load_dwordx4 v13, s[72:75], s12 offen offset:3072 lds
v_mfma_f32_16x16x32_bf16 v[252:255], a[60:63], v[60:63], v[252:255]
ds_read_b128 a[36:39], v1 offset:1024
v_mfma_f32_16x16x32_bf16 v[220:223], a[60:63], v[56:59], v[220:223]
s_add_u32 m0, s17, 0x14000
v_exp_f32 v45, v45
v_mfma_f32_16x16x32_bf16 v[188:191], a[60:63], v[52:55], v[188:191]
ds_read_b128 a[40:43], v1 offset:2048
v_add_u32 v12, 0x20000, v12
v_mfma_f32_16x16x32_bf16 a[224:227], a[236:239], v[52:55], a[224:227]
buffer_load_dwordx4 v12, s[72:75], 0 offen lds
v_smfmac_f32_16x16x64_bf16 a[228:231], a[232:235], v[56:63], v9
ds_read_b128 a[44:47], v1 offset:3072
s_waitcnt lgkmcnt(8)
v_mfma_f32_16x16x32_bf16 v[24:27], a[0:3], a[192:195], v[88:91]
v_exp_f32 v46, v46
v_mfma_f32_16x16x32_bf16 v[24:27], a[4:7], a[196:199], v[24:27]
ds_read_b128 a[48:51], v1 offset:4096
v_add_u32 v13, 0x20000, v13
v_mfma_f32_16x16x32_bf16 v[24:27], a[8:11], a[200:203], v[24:27]
buffer_load_dwordx4 v13, s[72:75], 0 offen offset:1024 lds
v_mfma_f32_16x16x32_bf16 v[24:27], a[12:15], a[204:207], v[24:27]
v_exp_f32 v47, v47
v_mfma_f32_16x16x32_bf16 v[28:31], a[0:3], a[208:211], v[92:95]
ds_read_b128 a[52:55], v1 offset:5120
v_cvt_pk_bf16_f32 v78, v44, v45
v_mfma_f32_16x16x32_bf16 v[28:31], a[4:7], a[212:215], v[28:31]
s_waitcnt lgkmcnt(6)
v_cvt_pk_bf16_f32 v79, v46, v47
v_mfma_f32_16x16x32_bf16 v[28:31], a[8:11], a[216:219], v[28:31]
ds_read_b128 a[56:59], v1 offset:6144
v_mfma_f32_16x16x32_bf16 v[28:31], a[12:15], a[220:223], v[28:31]
buffer_load_dwordx4 v12, s[72:75], s12 offen offset:2048 lds
v_mfma_f32_16x16x32_bf16 v[40:43], a[16:19], a[192:195], v[88:91]
ds_read_b128 a[60:63], v1 offset:7168
v_mfma_f32_16x16x32_bf16 v[40:43], a[20:23], a[196:199], v[40:43]
v_exp_f32 v24, v24
v_mfma_f32_16x16x32_bf16 v[40:43], a[24:27], a[200:203], v[40:43]
v_exp_f32 v25, v25
v_mfma_f32_16x16x32_bf16 v[40:43], a[28:31], a[204:207], v[40:43]
buffer_load_dwordx4 v13, s[72:75], s12 offen offset:3072 lds
v_mfma_f32_16x16x32_bf16 v[44:47], a[16:19], a[208:211], v[92:95]
v_exp_f32 v26, v26
v_mfma_f32_16x16x32_bf16 v[44:47], a[20:23], a[212:215], v[44:47]
v_exp_f32 v27, v27
v_mfma_f32_16x16x32_bf16 v[44:47], a[24:27], a[216:219], v[44:47]
v_exp_f32 v28, v28
v_mfma_f32_16x16x32_bf16 v[44:47], a[28:31], a[220:223], v[44:47]
s_waitcnt lgkmcnt(0)
v_exp_f32 v29, v29
v_mfma_f32_16x16x32_bf16 v[192:195], a[32:35], v[72:75], v[192:195]
s_add_u32 m0, s16, 0x0
v_add_u32 v12, 0x20000, v12
v_cvt_pk_bf16_f32 v56, v24, v25
v_mfma_f32_16x16x32_bf16 v[224:227], a[32:35], v[76:79], v[224:227]
buffer_load_dwordx4 v12, s[72:75], 0 offen lds
v_mfma_f32_16x16x32_bf16 v[228:231], a[36:39], v[76:79], v[228:231]
ds_read_b128 a[0:3], v1 offset:24576
v_cvt_pk_bf16_f32 v57, v26, v27
v_mfma_f32_16x16x32_bf16 v[196:199], a[36:39], v[72:75], v[196:199]
v_exp_f32 v30, v30
v_mfma_f32_16x16x32_bf16 v[200:203], a[40:43], v[72:75], v[200:203]
ds_read_b128 a[4:7], v1 offset:25600
v_cvt_pk_bf16_f32 v60, v28, v29
v_mfma_f32_16x16x32_bf16 v[232:235], a[40:43], v[76:79], v[232:235]
ds_read_b128 a[8:11], v1 offset:26624
v_add_u32 v13, 0x20000, v13
v_mfma_f32_16x16x32_bf16 v[236:239], a[44:47], v[76:79], v[236:239]
buffer_load_dwordx4 v13, s[72:75], 0 offen offset:1024 lds
v_mfma_f32_16x16x32_bf16 v[204:207], a[44:47], v[72:75], v[204:207]
ds_read_b128 a[12:15], v1 offset:27648
v_exp_f32 v31, v31
v_mfma_f32_16x16x32_bf16 v[208:211], a[48:51], v[72:75], v[208:211]
buffer_load_dwordx4 v12, s[72:75], s12 offen offset:2048 lds
v_mfma_f32_16x16x32_bf16 v[240:243], a[48:51], v[76:79], v[240:243]
ds_read_b128 a[16:19], v1 offset:28672
v_exp_f32 v40, v40
v_mfma_f32_16x16x32_bf16 v[244:247], a[52:55], v[76:79], v[244:247]
ds_read_b128 a[20:23], v1 offset:29696
v_cvt_pk_bf16_f32 v61, v30, v31
v_mfma_f32_16x16x32_bf16 v[212:215], a[52:55], v[72:75], v[212:215]
buffer_load_dwordx4 v13, s[72:75], s12 offen offset:3072 lds
v_mfma_f32_16x16x32_bf16 v[216:219], a[56:59], v[72:75], v[216:219]
ds_read_b128 a[24:27], v1 offset:30720
v_exp_f32 v41, v41
v_mfma_f32_16x16x32_bf16 v[248:251], a[56:59], v[76:79], v[248:251]
ds_read_b128 a[28:31], v1 offset:31744
v_exp_f32 v42, v42
v_mfma_f32_16x16x32_bf16 v[252:255], a[60:63], v[76:79], v[252:255]
ds_read_b128 a[32:35], v1 offset:16384
v_cvt_pk_bf16_f32 v58, v40, v41
v_mfma_f32_16x16x32_bf16 v[220:223], a[60:63], v[72:75], v[220:223]
s_waitcnt lgkmcnt(5)
v_exp_f32 v43, v43
v_smfmac_f32_16x16x64_bf16 a[228:231], a[232:235], v[72:79], v9
ds_read_b128 a[36:39], v1 offset:17408
v_add_u32 v12, 0x20000, v12
v_mfma_f32_16x16x32_bf16 v[24:27], a[0:3], a[192:195], v[112:115]
s_add_u32 m0, s16, 0x4000
v_exp_f32 v44, v44
v_mfma_f32_16x16x32_bf16 v[24:27], a[4:7], a[196:199], v[24:27]
buffer_load_dwordx4 v12, s[72:75], 0 offen lds
v_mfma_f32_16x16x32_bf16 v[24:27], a[8:11], a[200:203], v[24:27]
ds_read_b128 a[40:43], v1 offset:18432
v_add_u32 v13, 0x20000, v13
v_mfma_f32_16x16x32_bf16 v[24:27], a[12:15], a[204:207], v[24:27]
buffer_load_dwordx4 v13, s[72:75], 0 offen offset:1024 lds
v_mfma_f32_16x16x32_bf16 v[28:31], a[0:3], a[208:211], v[92:95]
ds_read_b128 a[44:47], v1 offset:19456
v_cvt_pk_bf16_f32 v59, v42, v43
v_mfma_f32_16x16x32_bf16 v[28:31], a[4:7], a[212:215], v[28:31]
ds_read_b128 a[48:51], v1 offset:20480
v_exp_f32 v45, v45
v_mfma_f32_16x16x32_bf16 v[28:31], a[8:11], a[216:219], v[28:31]
s_waitcnt lgkmcnt(5)
v_exp_f32 v46, v46
v_mfma_f32_16x16x32_bf16 v[28:31], a[12:15], a[220:223], v[28:31]
buffer_load_dwordx4 v12, s[72:75], s12 offen offset:2048 lds
v_mfma_f32_16x16x32_bf16 v[40:43], a[16:19], a[192:195], v[116:119]
ds_read_b128 a[52:55], v1 offset:21504
v_exp_f32 v47, v47
v_mfma_f32_16x16x32_bf16 v[40:43], a[20:23], a[196:199], v[40:43]
ds_read_b128 a[56:59], v1 offset:22528
v_exp_f32 v24, v24
v_mfma_f32_16x16x32_bf16 v[40:43], a[24:27], a[200:203], v[40:43]
ds_read_b128 a[60:63], v1 offset:23552
v_xor_b32 v1, 0x8000, v1
v_mfma_f32_16x16x32_bf16 v[40:43], a[28:31], a[204:207], v[40:43]
v_exp_f32 v25, v25
v_cvt_pk_bf16_f32 v62, v44, v45
v_cvt_pk_bf16_f32 v63, v46, v47
v_mfma_f32_16x16x32_bf16 v[44:47], a[16:19], a[208:211], v[92:95]
v_exp_f32 v26, v26
v_mfma_f32_16x16x32_bf16 v[44:47], a[20:23], a[212:215], v[44:47]
buffer_load_dwordx4 v13, s[72:75], s12 offen offset:3072 lds
v_mfma_f32_16x16x32_bf16 v[44:47], a[24:27], a[216:219], v[44:47]
v_exp_f32 v27, v27
v_mfma_f32_16x16x32_bf16 v[44:47], a[28:31], a[220:223], v[44:47]
v_exp_f32 v28, v28
v_exp_f32 v29, v29
v_accvgpr_read_b32 v6, a224
v_accvgpr_read_b32 v7, a225
v_add_f32 v6, v6, v7
v_cmp_nge_f32 vcc, 0x6f800000, v6
v_rcp_f32 v6, v6
s_or_b64 s[34:35], s[34:35], vcc
s_add_u32 s8, s28, 0x0
v_pk_mul_f32 v[128:129], v[128:129], v[6:7] op_sel_hi:[1,0]
v_pk_mul_f32 v[130:131], v[130:131], v[6:7] op_sel_hi:[1,0]
v_pk_mul_f32 v[132:133], v[132:133], v[6:7] op_sel_hi:[1,0]
v_pk_mul_f32 v[134:135], v[134:135], v[6:7] op_sel_hi:[1,0]
v_cvt_pk_bf16_f32 v128, v128, v129
v_cvt_pk_bf16_f32 v129, v130, v131
v_cvt_pk_bf16_f32 v130, v132, v133
v_cvt_pk_bf16_f32 v131, v134, v135
buffer_store_dwordx4 v[128:131], v3, s[88:91], s8 offen sc1
s_add_u32 s8, s28, 0x2000
v_pk_mul_f32 v[136:137], v[136:137], v[6:7] op_sel_hi:[1,0]
v_pk_mul_f32 v[138:139], v[138:139], v[6:7] op_sel_hi:[1,0]
v_pk_mul_f32 v[140:141], v[140:141], v[6:7] op_sel_hi:[1,0]
v_pk_mul_f32 v[142:143], v[142:143], v[6:7] op_sel_hi:[1,0]
v_cvt_pk_bf16_f32 v136, v136, v137
v_cvt_pk_bf16_f32 v137, v138, v139
v_cvt_pk_bf16_f32 v138, v140, v141
v_cvt_pk_bf16_f32 v139, v142, v143
buffer_store_dwordx4 v[136:139], v3, s[88:91], s8 offen sc1
s_add_u32 s8, s28, 0x4000
v_pk_mul_f32 v[144:145], v[144:145], v[6:7] op_sel_hi:[1,0]
v_pk_mul_f32 v[146:147], v[146:147], v[6:7] op_sel_hi:[1,0]
v_pk_mul_f32 v[148:149], v[148:149], v[6:7] op_sel_hi:[1,0]
v_pk_mul_f32 v[150:151], v[150:151], v[6:7] op_sel_hi:[1,0]
v_cvt_pk_bf16_f32 v144, v144, v145
v_cvt_pk_bf16_f32 v145, v146, v147
v_cvt_pk_bf16_f32 v146, v148, v149
v_cvt_pk_bf16_f32 v147, v150, v151
buffer_store_dwordx4 v[144:147], v3, s[88:91], s8 offen sc1
s_add_u32 s8, s28, 0x6000
v_pk_mul_f32 v[152:153], v[152:153], v[6:7] op_sel_hi:[1,0]
v_pk_mul_f32 v[154:155], v[154:155], v[6:7] op_sel_hi:[1,0]
v_pk_mul_f32 v[156:157], v[156:157], v[6:7] op_sel_hi:[1,0]
v_pk_mul_f32 v[158:159], v[158:159], v[6:7] op_sel_hi:[1,0]
v_cvt_pk_bf16_f32 v152, v152, v153
v_cvt_pk_bf16_f32 v153, v154, v155
v_cvt_pk_bf16_f32 v154, v156, v157
v_cvt_pk_bf16_f32 v155, v158, v159
buffer_store_dwordx4 v[152:155], v3, s[88:91], s8 offen sc1
v_accvgpr_read_b32 v6, a226
v_accvgpr_read_b32 v7, a227
v_add_f32 v6, v6, v7
v_cmp_nge_f32 vcc, 0x6f800000, v6
v_rcp_f32 v6, v6
s_or_b64 s[34:35], s[34:35], vcc
s_add_u32 s8, s29, 0x0
v_pk_mul_f32 v[160:161], v[160:161], v[6:7] op_sel_hi:[1,0]
v_pk_mul_f32 v[162:163], v[162:163], v[6:7] op_sel_hi:[1,0]
v_pk_mul_f32 v[164:165], v[164:165], v[6:7] op_sel_hi:[1,0]
v_pk_mul_f32 v[166:167], v[166:167], v[6:7] op_sel_hi:[1,0]
v_cvt_pk_bf16_f32 v160, v160, v161
v_cvt_pk_bf16_f32 v161, v162, v163
v_cvt_pk_bf16_f32 v162, v164, v165
v_cvt_pk_bf16_f32 v163, v166, v167
buffer_store_dwordx4 v[160:163], v3, s[88:91], s8 offen sc1
s_add_u32 s8, s29, 0x2000
v_pk_mul_f32 v[168:169], v[168:169], v[6:7] op_sel_hi:[1,0]
v_pk_mul_f32 v[170:171], v[170:171], v[6:7] op_sel_hi:[1,0]
v_pk_mul_f32 v[172:173], v[172:173], v[6:7] op_sel_hi:[1,0]
v_pk_mul_f32 v[174:175], v[174:175], v[6:7] op_sel_hi:[1,0]
v_cvt_pk_bf16_f32 v168, v168, v169
v_cvt_pk_bf16_f32 v169, v170, v171
v_cvt_pk_bf16_f32 v170, v172, v173
v_cvt_pk_bf16_f32 v171, v174, v175
buffer_store_dwordx4 v[168:171], v3, s[88:91], s8 offen sc1
s_add_u32 s8, s29, 0x4000
v_pk_mul_f32 v[176:177], v[176:177], v[6:7] op_sel_hi:[1,0]
v_pk_mul_f32 v[178:179], v[178:179], v[6:7] op_sel_hi:[1,0]
v_pk_mul_f32 v[180:181], v[180:181], v[6:7] op_sel_hi:[1,0]
v_pk_mul_f32 v[182:183], v[182:183], v[6:7] op_sel_hi:[1,0]
v_cvt_pk_bf16_f32 v176, v176, v177
v_cvt_pk_bf16_f32 v177, v178, v179
v_cvt_pk_bf16_f32 v178, v180, v181
v_cvt_pk_bf16_f32 v179, v182, v183
buffer_store_dwordx4 v[176:179], v3, s[88:91], s8 offen sc1
s_add_u32 s8, s29, 0x6000
v_pk_mul_f32 v[184:185], v[184:185], v[6:7] op_sel_hi:[1,0]
v_pk_mul_f32 v[186:187], v[186:187], v[6:7] op_sel_hi:[1,0]
v_pk_mul_f32 v[188:189], v[188:189], v[6:7] op_sel_hi:[1,0]
v_pk_mul_f32 v[190:191], v[190:191], v[6:7] op_sel_hi:[1,0]
v_cvt_pk_bf16_f32 v184, v184, v185
v_cvt_pk_bf16_f32 v185, v186, v187
v_cvt_pk_bf16_f32 v186, v188, v189
v_cvt_pk_bf16_f32 v187, v190, v191
buffer_store_dwordx4 v[184:187], v3, s[88:91], s8 offen sc1
s_branch L_att_h1_1
L_att_j0:
s_cmp_ge_u32 s4, 2
s_cbranch_scc1 L_att_nl0_1
L_att_nl0_0:
v_mfma_f32_16x16x32_bf16 v[16:19], a[0:3], a[160:163], v[96:99]
ds_read_b128 a[128:131], v1 offset:24576
v_mov_b32 v240, 0
v_mfma_f32_16x16x32_bf16 v[16:19], a[4:7], a[164:167], v[16:19]
ds_read_b128 a[132:135], v1 offset:25600
s_add_u32 m0, s27, 0x0
v_mfma_f32_16x16x32_bf16 v[16:19], a[8:11], a[168:171], v[16:19]
buffer_load_dwordx4 v3, s[48:51], s32 offen offset:0 sc1 lds
v_mfma_f32_16x16x32_bf16 v[16:19], a[12:15], a[172:175], v[16:19]
ds_read_b128 a[136:139], v1 offset:26624
v_mov_b32 v241, 0
v_mfma_f32_16x16x32_bf16 v[20:23], a[0:3], a[176:179], v[84:87]
ds_read_b128 a[140:143], v1 offset:27648
v_mov_b32 v242, 0
v_mfma_f32_16x16x32_bf16 v[20:23], a[4:7], a[180:183], v[20:23]
ds_read_b128 a[144:147], v1 offset:28672
v_mov_b32 v243, 0
v_mfma_f32_16x16x32_bf16 v[20:23], a[8:11], a[184:187], v[20:23]
ds_read_b128 a[148:151], v1 offset:29696
s_mov_b32 s9, 0x0
v_mfma_f32_16x16x32_bf16 v[20:23], a[12:15], a[188:191], v[20:23]
buffer_load_dword a244, v8, s[72:75], s9 offen
v_mfma_f32_16x16x32_bf16 v[24:27], a[0:3], a[192:195], v[88:91]
ds_read_b128 a[152:155], v1 offset:30720
v_mov_b32 v244, 0
v_mfma_f32_16x16x32_bf16 v[24:27], a[4:7], a[196:199], v[24:27]
ds_read_b128 a[156:159], v1 offset:31744
v_exp_f32 v16, v16
v_mfma_f32_16x16x32_bf16 v[24:27], a[8:11], a[200:203], v[24:27]
v_exp_f32 v17, v17
v_mfma_f32_16x16x32_bf16 v[24:27], a[12:15], a[204:207], v[24:27]
v_exp_f32 v18, v18
v_mfma_f32_16x16x32_bf16 v[28:31], a[0:3], a[208:211], v[92:95]
buffer_load_dwordx4 v3, s[48:51], s32 offen offset:1024 sc1 lds
v_mfma_f32_16x16x32_bf16 v[28:31], a[4:7], a[212:215], v[28:31]
v_exp_f32 v19, v19
v_mfma_f32_16x16x32_bf16 v[28:31], a[8:11], a[216:219], v[28:31]
v_exp_f32 v20, v20
v_mfma_f32_16x16x32_bf16 v[28:31], a[12:15], a[220:223], v[28:31]
v_exp_f32 v21, v21
v_mfma_f32_16x16x32_bf16 v[32:35], a[16:19], a[160:163], v[100:103]
v_exp_f32 v22, v22
v_mfma_f32_16x16x32_bf16 v[32:35], a[20:23], a[164:167], v[32:35]
buffer_load_dwordx4 v3, s[48:51], s32 offen offset:2048 sc1 lds
v_mfma_f32_16x16x32_bf16 v[32:35], a[24:27], a[168:171], v[32:35]
v_exp_f32 v23, v23
v_mfma_f32_16x16x32_bf16 v[32:35], a[28:31], a[172:175], v[32:35]
v_exp_f32 v24, v24
v_mfma_f32_16x16x32_bf16 v[36:39], a[16:19], a[176:179], v[84:87]
v_exp_f32 v25, v25
v_mfma_f32_16x16x32_bf16 v[36:39], a[20:23], a[180:183], v[36:39]
v_exp_f32 v26, v26
v_mfma_f32_16x16x32_bf16 v[36:39], a[24:27], a[184:187], v[36:39]
buffer_load_dwordx4 v3, s[48:51], s32 offen offset:3072 sc1 lds
v_mfma_f32_16x16x32_bf16 v[36:39], a[28:31], a[188:191], v[36:39]
v_exp_f32 v27, v27
v_mfma_f32_16x16x32_bf16 v[40:43], a[16:19], a[192:195], v[88:91]
v_exp_f32 v28, v28
v_mfma_f32_16x16x32_bf16 v[40:43], a[20:23], a[196:199], v[40:43]
v_exp_f32 v29, v29
v_mfma_f32_16x16x32_bf16 v[40:43], a[24:27], a[200:203], v[40:43]
s_mov_b32 s9, 0x0
v_exp_f32 v30, v30
v_mfma_f32_16x16x32_bf16 v[40:43], a[28:31], a[204:207], v[40:43]
buffer_load_dword a244, v8, s[64:67], s9 offen
v_mfma_f32_16x16x32_bf16 v[44:47], a[16:19], a[208:211], v[92:95]
v_exp_f32 v31, v31
v_mfma_f32_16x16x32_bf16 v[44:47], a[20:23], a[212:215], v[44:47]
v_exp_f32 v32, v32
v_mfma_f32_16x16x32_bf16 v[44:47], a[24:27], a[216:219], v[44:47]
v_exp_f32 v33, v33
v_mfma_f32_16x16x32_bf16 v[44:47], a[28:31], a[220:223], v[44:47]
s_waitcnt lgkmcnt(0)
v_cvt_pk_bf16_f32 v48, v16, v17
v_cvt_pk_bf16_f32 v49, v18, v19
v_cvt_pk_bf16_f32 v52, v20, v21
v_cvt_pk_bf16_f32 v53, v22, v23
v_cvt_pk_bf16_f32 v56, v24, v25
v_cvt_pk_bf16_f32 v57, v26, v27
v_mov_b32 v245, 0
v_mov_b32 v246, 0
v_mov_b32 v247, 0
v_mfma_f32_16x16x32_bf16 v[20:23], a[128:131], a[176:179], v[84:87]
s_add_u32 m0, s27, 0x1000
v_exp_f32 v34, v34
v_mfma_f32_16x16x32_bf16 v[20:23], a[132:135], a[180:183], v[20:23]
buffer_load_dwordx4 v3, s[48:51], s7 offen offset:0 sc1 lds
v_mfma_f32_16x16x32_bf16 v[20:23], a[136:139], a[184:187], v[20:23]
v_exp_f32 v35, v35
v_mfma_f32_16x16x32_bf16 v[20:23], a[140:143], a[188:191], v[20:23]
ds_read_b128 a[32:35], v1 offset:16384
v_cvt_pk_bf16_f32 v60, v28, v29
v_mfma_f32_16x16x32_bf16 v[24:27], a[128:131], a[192:195], v[88:91]
v_exp_f32 v36, v36
v_mfma_f32_16x16x32_bf16 v[24:27], a[132:135], a[196:199], v[24:27]
ds_read_b128 a[36:39], v1 offset:17408
v_cvt_pk_bf16_f32 v61, v30, v31
v_mfma_f32_16x16x32_bf16 v[24:27], a[136:139], a[200:203], v[24:27]
buffer_load_dwordx4 v3, s[48:51], s7 offen offset:1024 sc1 lds
v_mfma_f32_16x16x32_bf16 v[24:27], a[140:143], a[204:207], v[24:27]
ds_read_b128 a[40:43], v1 offset:18432
v_cvt_pk_bf16_f32 v50, v32, v33
v_mfma_f32_16x16x32_bf16 v[28:31], a[128:131], a[208:211], v[92:95]
v_exp_f32 v37, v37
v_mfma_f32_16x16x32_bf16 v[28:31], a[132:135], a[212:215], v[28:31]
ds_read_b128 a[44:47], v1 offset:19456
v_cvt_pk_bf16_f32 v51, v34, v35
v_mfma_f32_16x16x32_bf16 v[28:31], a[136:139], a[216:219], v[28:31]
buffer_load_dwordx4 v3, s[48:51], s7 offen offset:2048 sc1 lds
v_mfma_f32_16x16x32_bf16 v[28:31], a[140:143], a[220:223], v[28:31]
s_mov_b32 s9, 0x400000
v_exp_f32 v38, v38
v_exp_f32 v39, v39
v_cvt_pk_bf16_f32 v54, v36, v37
v_cvt_pk_bf16_f32 v55, v38, v39
v_mfma_f32_16x16x32_bf16 v[36:39], a[144:147], a[176:179], v[84:87]
ds_read_b128 a[48:51], v1 offset:20480
v_exp_f32 v40, v40
v_mfma_f32_16x16x32_bf16 v[36:39], a[148:151], a[180:183], v[36:39]
ds_read_b128 a[52:55], v1 offset:21504
v_exp_f32 v41, v41
v_mfma_f32_16x16x32_bf16 v[36:39], a[152:155], a[184:187], v[36:39]
buffer_load_dword a244, v8, s[64:67], s9 offen
v_mfma_f32_16x16x32_bf16 v[36:39], a[156:159], a[188:191], v[36:39]
ds_read_b128 a[56:59], v1 offset:22528
v_cvt_pk_bf16_f32 v58, v40, v41
v_exp_f32 v42, v42
v_exp_f32 v43, v43
s_nop 0
v_cvt_pk_bf16_f32 v59, v42, v43
v_mfma_f32_16x16x32_bf16 v[40:43], a[144:147], a[192:195], v[88:91]
buffer_load_dwordx4 v3, s[48:51], s7 offen offset:3072 sc1 lds
v_mfma_f32_16x16x32_bf16 v[40:43], a[148:151], a[196:199], v[40:43]
ds_read_b128 a[60:63], v1 offset:23552
v_xor_b32 v1, 0x8000, v1
v_mfma_f32_16x16x32_bf16 v[40:43], a[152:155], a[200:203], v[40:43]
s_add_u32 s32, s32, 0x8000
v_exp_f32 v44, v44
v_mfma_f32_16x16x32_bf16 v[40:43], a[156:159], a[204:207], v[40:43]
s_add_u32 s7, s7, 0x8000
v_exp_f32 v45, v45
v_exp_f32 v46, v46
v_exp_f32 v47, v47
v_cvt_pk_bf16_f32 v62, v44, v45
v_cvt_pk_bf16_f32 v63, v46, v47
v_mfma_f32_16x16x32_bf16 v[44:47], a[144:147], a[208:211], v[92:95]
s_xor_b32 s27, s27, 0x38000
v_exp_f32 v20, v20
v_mfma_f32_16x16x32_bf16 v[44:47], a[148:151], a[212:215], v[44:47]
v_exp_f32 v21, v21
v_mfma_f32_16x16x32_bf16 v[44:47], a[152:155], a[216:219], v[44:47]
s_waitcnt vmcnt(11) lgkmcnt(0)
v_exp_f32 v22, v22
v_mfma_f32_16x16x32_bf16 v[44:47], a[156:159], a[220:223], v[44:47]
s_barrier
v_cvt_pk_bf16_f32 v68, v20, v21
v_exp_f32 v23, v23
v_exp_f32 v24, v24
v_exp_f32 v25, v25
v_exp_f32 v26, v26
v_exp_f32 v27, v27
v_cvt_pk_bf16_f32 v69, v22, v23
s_cmp_lg_u32 s33, 0
s_cbranch_scc1 L_sig_bn0
s_lshl_b32 s8, s6, 2
s_add_u32 s8, s8, 192
s_cmp_lg_u32 s4, 0
s_cbranch_scc1 L_sig_bn0
v_mov_b32 v4, 1
s_mov_b64 exec, 1
buffer_atomic_add v4, off, s[84:87], s8 sc1
s_mov_b64 exec, -1
L_sig_bn0:
s_branch L_att_l1_0
L_att_nl0_1:
v_mfma_f32_16x16x32_bf16 v[16:19], a[0:3], a[160:163], v[80:83]
ds_read_b128 a[128:131], v1 offset:24576
v_mov_b32 v240, 0
v_mfma_f32_16x16x32_bf16 v[16:19], a[4:7], a[164:167], v[16:19]
ds_read_b128 a[132:135], v1 offset:25600
s_add_u32 m0, s27, 0x0
v_mfma_f32_16x16x32_bf16 v[16:19], a[8:11], a[168:171], v[16:19]
buffer_load_dwordx4 v3, s[48:51], s32 offen offset:0 sc1 lds
v_mfma_f32_16x16x32_bf16 v[16:19], a[12:15], a[172:175], v[16:19]
ds_read_b128 a[136:139], v1 offset:26624
v_mov_b32 v241, 0
v_mfma_f32_16x16x32_bf16 v[20:23], a[0:3], a[176:179], v[84:87]
ds_read_b128 a[140:143], v1 offset:27648
v_mov_b32 v242, 0
v_mfma_f32_16x16x32_bf16 v[20:23], a[4:7], a[180:183], v[20:23]
ds_read_b128 a[144:147], v1 offset:28672
v_mov_b32 v243, 0
v_mfma_f32_16x16x32_bf16 v[20:23], a[8:11], a[184:187], v[20:23]
ds_read_b128 a[148:151], v1 offset:29696
s_mov_b32 s9, 0x0
v_mfma_f32_16x16x32_bf16 v[20:23], a[12:15], a[188:191], v[20:23]
buffer_load_dword a244, v8, s[72:75], s9 offen
v_mfma_f32_16x16x32_bf16 v[24:27], a[0:3], a[192:195], v[88:91]
ds_read_b128 a[152:155], v1 offset:30720
v_mov_b32 v244, 0
v_mfma_f32_16x16x32_bf16 v[24:27], a[4:7], a[196:199], v[24:27]
ds_read_b128 a[156:159], v1 offset:31744
v_exp_f32 v16, v16
v_mfma_f32_16x16x32_bf16 v[24:27], a[8:11], a[200:203], v[24:27]
v_exp_f32 v17, v17
v_mfma_f32_16x16x32_bf16 v[24:27], a[12:15], a[204:207], v[24:27]
v_exp_f32 v18, v18
v_mfma_f32_16x16x32_bf16 v[28:31], a[0:3], a[208:211], v[92:95]
buffer_load_dwordx4 v3, s[48:51], s32 offen offset:1024 sc1 lds
v_mfma_f32_16x16x32_bf16 v[28:31], a[4:7], a[212:215], v[28:31]
v_exp_f32 v19, v19
v_mfma_f32_16x16x32_bf16 v[28:31], a[8:11], a[216:219], v[28:31]
v_exp_f32 v20, v20
v_mfma_f32_16x16x32_bf16 v[28:31], a[12:15], a[220:223], v[28:31]
v_exp_f32 v21, v21
v_mfma_f32_16x16x32_bf16 v[32:35], a[16:19], a[160:163], v[80:83]
v_exp_f32 v22, v22
v_mfma_f32_16x16x32_bf16 v[32:35], a[20:23], a[164:167], v[32:35]
buffer_load_dwordx4 v3, s[48:51], s32 offen offset:2048 sc1 lds
v_mfma_f32_16x16x32_bf16 v[32:35], a[24:27], a[168:171], v[32:35]
v_exp_f32 v23, v23
v_mfma_f32_16x16x32_bf16 v[32:35], a[28:31], a[172:175], v[32:35]
v_exp_f32 v24, v24
v_mfma_f32_16x16x32_bf16 v[36:39], a[16:19], a[176:179], v[84:87]
v_exp_f32 v25, v25
v_mfma_f32_16x16x32_bf16 v[36:39], a[20:23], a[180:183], v[36:39]
v_exp_f32 v26, v26
v_mfma_f32_16x16x32_bf16 v[36:39], a[24:27], a[184:187], v[36:39]
buffer_load_dwordx4 v3, s[48:51], s32 offen offset:3072 sc1 lds
v_mfma_f32_16x16x32_bf16 v[36:39], a[28:31], a[188:191], v[36:39]
v_exp_f32 v27, v27
v_mfma_f32_16x16x32_bf16 v[40:43], a[16:19], a[192:195], v[88:91]
v_exp_f32 v28, v28
v_mfma_f32_16x16x32_bf16 v[40:43], a[20:23], a[196:199], v[40:43]
v_exp_f32 v29, v29
v_mfma_f32_16x16x32_bf16 v[40:43], a[24:27], a[200:203], v[40:43]
s_mov_b32 s9, 0x0
v_exp_f32 v30, v30
v_mfma_f32_16x16x32_bf16 v[40:43], a[28:31], a[204:207], v[40:43]
buffer_load_dword a244, v8, s[64:67], s9 offen
v_mfma_f32_16x16x32_bf16 v[44:47], a[16:19], a[208:211], v[92:95]
v_exp_f32 v31, v31
v_mfma_f32_16x16x32_bf16 v[44:47], a[20:23], a[212:215], v[44:47]
v_exp_f32 v32, v32
v_mfma_f32_16x16x32_bf16 v[44:47], a[24:27], a[216:219], v[44:47]
v_exp_f32 v33, v33
v_mfma_f32_16x16x32_bf16 v[44:47], a[28:31], a[220:223], v[44:47]
s_waitcnt lgkmcnt(0)
v_cvt_pk_bf16_f32 v48, v16, v17
v_cvt_pk_bf16_f32 v49, v18, v19
v_cvt_pk_bf16_f32 v52, v20, v21
v_cvt_pk_bf16_f32 v53, v22, v23
v_cvt_pk_bf16_f32 v56, v24, v25
v_cvt_pk_bf16_f32 v57, v26, v27
v_mov_b32 v245, 0
v_mov_b32 v246, 0
v_mov_b32 v247, 0
v_mfma_f32_16x16x32_bf16 v[16:19], a[128:131], a[160:163], v[96:99]
ds_read_b128 a[32:35], v1 offset:16384
v_cvt_pk_bf16_f32 v60, v28, v29
v_mfma_f32_16x16x32_bf16 v[16:19], a[132:135], a[164:167], v[16:19]
s_add_u32 m0, s27, 0x1000
v_exp_f32 v34, v34
v_mfma_f32_16x16x32_bf16 v[16:19], a[136:139], a[168:171], v[16:19]
buffer_load_dwordx4 v3, s[48:51], s7 offen offset:0 sc1 lds
v_mfma_f32_16x16x32_bf16 v[16:19], a[140:143], a[172:175], v[16:19]
ds_read_b128 a[36:39], v1 offset:17408
v_cvt_pk_bf16_f32 v61, v30, v31
v_mfma_f32_16x16x32_bf16 v[20:23], a[128:131], a[176:179], v[84:87]
v_exp_f32 v35, v35
v_mfma_f32_16x16x32_bf16 v[20:23], a[132:135], a[180:183], v[20:23]
v_exp_f32 v36, v36
v_mfma_f32_16x16x32_bf16 v[20:23], a[136:139], a[184:187], v[20:23]
ds_read_b128 a[40:43], v1 offset:18432
v_cvt_pk_bf16_f32 v50, v32, v33
v_mfma_f32_16x16x32_bf16 v[20:23], a[140:143], a[188:191], v[20:23]
buffer_load_dwordx4 v3, s[48:51], s7 offen offset:1024 sc1 lds
v_mfma_f32_16x16x32_bf16 v[24:27], a[128:131], a[192:195], v[88:91]
v_exp_f32 v37, v37
v_mfma_f32_16x16x32_bf16 v[24:27], a[132:135], a[196:199], v[24:27]
ds_read_b128 a[44:47], v1 offset:19456
v_cvt_pk_bf16_f32 v51, v34, v35
v_mfma_f32_16x16x32_bf16 v[24:27], a[136:139], a[200:203], v[24:27]
v_exp_f32 v38, v38
v_mfma_f32_16x16x32_bf16 v[24:27], a[140:143], a[204:207], v[24:27]
v_exp_f32 v39, v39
v_mfma_f32_16x16x32_bf16 v[28:31], a[128:131], a[208:211], v[92:95]
v_exp_f32 v40, v40
v_mfma_f32_16x16x32_bf16 v[28:31], a[132:135], a[212:215], v[28:31]
buffer_load_dwordx4 v3, s[48:51], s7 offen offset:2048 sc1 lds
v_mfma_f32_16x16x32_bf16 v[28:31], a[136:139], a[216:219], v[28:31]
ds_read_b128 a[48:51], v1 offset:20480
v_cvt_pk_bf16_f32 v54, v36, v37
v_mfma_f32_16x16x32_bf16 v[28:31], a[140:143], a[220:223], v[28:31]
v_exp_f32 v41, v41
v_mfma_f32_16x16x32_bf16 v[32:35], a[144:147], a[160:163], v[100:103]
ds_read_b128 a[52:55], v1 offset:21504
v_cvt_pk_bf16_f32 v55, v38, v39
v_mfma_f32_16x16x32_bf16 v[32:35], a[148:151], a[164:167], v[32:35]
s_mov_b32 s9, 0x400000
v_exp_f32 v42, v42
v_mfma_f32_16x16x32_bf16 v[32:35], a[152:155], a[168:171], v[32:35]
buffer_load_dword a244, v8, s[64:67], s9 offen
v_mfma_f32_16x16x32_bf16 v[32:35], a[156:159], a[172:175], v[32:35]
ds_read_b128 a[56:59], v1 offset:22528
v_cvt_pk_bf16_f32 v58, v40, v41
v_mfma_f32_16x16x32_bf16 v[36:39], a[144:147], a[176:179], v[84:87]
v_exp_f32 v43, v43
v_mfma_f32_16x16x32_bf16 v[36:39], a[148:151], a[180:183], v[36:39]
v_exp_f32 v44, v44
v_mfma_f32_16x16x32_bf16 v[36:39], a[152:155], a[184:187], v[36:39]
ds_read_b128 a[60:63], v1 offset:23552
v_xor_b32 v1, 0x8000, v1
v_mfma_f32_16x16x32_bf16 v[36:39], a[156:159], a[188:191], v[36:39]
buffer_load_dwordx4 v3, s[48:51], s7 offen offset:3072 sc1 lds
v_cvt_pk_bf16_f32 v59, v42, v43
v_mfma_f32_16x16x32_bf16 v[40:43], a[144:147], a[192:195], v[88:91]
s_add_u32 s32, s32, 0x8000
v_exp_f32 v45, v45
v_mfma_f32_16x16x32_bf16 v[40:43], a[148:151], a[196:199], v[40:43]
s_add_u32 s7, s7, 0x8000
v_exp_f32 v46, v46
v_mfma_f32_16x16x32_bf16 v[40:43], a[152:155], a[200:203], v[40:43]
s_xor_b32 s27, s27, 0x38000
v_exp_f32 v47, v47
v_mfma_f32_16x16x32_bf16 v[40:43], a[156:159], a[204:207], v[40:43]
v_exp_f32 v16, v16
v_cvt_pk_bf16_f32 v62, v44, v45
v_cvt_pk_bf16_f32 v63, v46, v47
v_mfma_f32_16x16x32_bf16 v[44:47], a[144:147], a[208:211], v[92:95]
v_exp_f32 v17, v17
v_mfma_f32_16x16x32_bf16 v[44:47], a[148:151], a[212:215], v[44:47]
v_exp_f32 v18, v18
v_mfma_f32_16x16x32_bf16 v[44:47], a[152:155], a[216:219], v[44:47]
s_waitcnt vmcnt(11) lgkmcnt(0)
v_exp_f32 v19, v19
v_mfma_f32_16x16x32_bf16 v[44:47], a[156:159], a[220:223], v[44:47]
s_barrier
v_cvt_pk_bf16_f32 v64, v16, v17
v_exp_f32 v20, v20
v_exp_f32 v21, v21
v_exp_f32 v22, v22
v_exp_f32 v23, v23
v_exp_f32 v24, v24
v_exp_f32 v25, v25
v_exp_f32 v26, v26
v_exp_f32 v27, v27
v_cvt_pk_bf16_f32 v65, v18, v19
v_cvt_pk_bf16_f32 v68, v20, v21
v_cvt_pk_bf16_f32 v69, v22, v23
s_cmp_lg_u32 s33, 0
s_cbranch_scc1 L_sig_bn1
s_lshl_b32 s8, s6, 2
s_add_u32 s8, s8, 192
s_cmp_lg_u32 s4, 0
s_cbranch_scc1 L_sig_bn1
v_mov_b32 v4, 1
s_mov_b64 exec, 1
buffer_atomic_add v4, off, s[84:87], s8 sc1
s_mov_b64 exec, -1
L_sig_bn1:
s_branch L_att_l1_1
L_att_seven0:
v_mfma_f32_16x16x32_bf16 v[192:195], a[32:35], v[56:59], v[192:195]
v_exp_f32 v30, v30
v_mfma_f32_16x16x32_bf16 v[224:227], a[32:35], v[60:63], v[224:227]
ds_read_b128 a[0:3], v1 offset:8192
v_cvt_pk_bf16_f32 v72, v24, v25
v_mfma_f32_16x16x32_bf16 v[228:231], a[36:39], v[60:63], v[228:231]
ds_read_b128 a[4:7], v1 offset:9216
v_cvt_pk_bf16_f32 v73, v26, v27
v_mfma_f32_16x16x32_bf16 v[196:199], a[36:39], v[56:59], v[196:199]
s_add_u32 m0, s27, 0x0
v_exp_f32 v31, v31
v_mfma_f32_16x16x32_bf16 v[200:203], a[40:43], v[56:59], v[200:203]
ds_read_b128 a[8:11], v1 offset:10240
v_cvt_pk_bf16_f32 v76, v28, v29
v_mfma_f32_16x16x32_bf16 v[232:235], a[40:43], v[60:63], v[232:235]
buffer_load_dwordx4 v3, s[48:51], s32 offen offset:0 sc1 lds
v_mfma_f32_16x16x32_bf16 v[236:239], a[44:47], v[60:63], v[236:239]
v_exp_f32 v40, v40
v_mfma_f32_16x16x32_bf16 v[204:207], a[44:47], v[56:59], v[204:207]
ds_read_b128 a[12:15], v1 offset:11264
v_cvt_pk_bf16_f32 v77, v30, v31
v_mfma_f32_16x16x32_bf16 v[208:211], a[48:51], v[56:59], v[208:211]
ds_read_b128 a[16:19], v1 offset:12288
v_mfma_f32_16x16x32_bf16 v[240:243], a[48:51], v[60:63], v[240:243]
buffer_load_dwordx4 v3, s[48:51], s32 offen offset:1024 sc1 lds
v_mfma_f32_16x16x32_bf16 v[244:247], a[52:55], v[60:63], v[244:247]
ds_read_b128 a[20:23], v1 offset:13312
v_mfma_f32_16x16x32_bf16 v[212:215], a[52:55], v[56:59], v[212:215]
ds_read_b128 a[24:27], v1 offset:14336
v_mfma_f32_16x16x32_bf16 v[216:219], a[56:59], v[56:59], v[216:219]
ds_read_b128 a[28:31], v1 offset:15360
v_mfma_f32_16x16x32_bf16 v[248:251], a[56:59], v[60:63], v[248:251]
ds_read_b128 a[32:35], v1 offset:0
v_exp_f32 v41, v41
v_mfma_f32_16x16x32_bf16 v[252:255], a[60:63], v[60:63], v[252:255]
v_exp_f32 v42, v42
v_mfma_f32_16x16x32_bf16 v[220:223], a[60:63], v[56:59], v[220:223]
s_waitcnt lgkmcnt(5)
v_exp_f32 v43, v43
v_smfmac_f32_16x16x64_bf16 a[228:231], a[232:235], v[56:63], v9
ds_read_b128 a[36:39], v1 offset:1024
v_cvt_pk_bf16_f32 v74, v40, v41
v_mfma_f32_16x16x32_bf16 v[24:27], a[0:3], a[192:195], v[88:91]
ds_read_b128 a[40:43], v1 offset:2048
v_exp_f32 v44, v44
v_mfma_f32_16x16x32_bf16 v[24:27], a[4:7], a[196:199], v[24:27]
buffer_load_dwordx4 v3, s[48:51], s32 offen offset:2048 sc1 lds
v_mfma_f32_16x16x32_bf16 v[24:27], a[8:11], a[200:203], v[24:27]
v_exp_f32 v45, v45
v_mfma_f32_16x16x32_bf16 v[24:27], a[12:15], a[204:207], v[24:27]
ds_read_b128 a[44:47], v1 offset:3072
v_cvt_pk_bf16_f32 v75, v42, v43
v_mfma_f32_16x16x32_bf16 v[28:31], a[0:3], a[208:211], v[92:95]
ds_read_b128 a[48:51], v1 offset:4096
v_exp_f32 v46, v46
v_mfma_f32_16x16x32_bf16 v[28:31], a[4:7], a[212:215], v[28:31]
s_waitcnt lgkmcnt(5)
v_exp_f32 v47, v47
v_mfma_f32_16x16x32_bf16 v[28:31], a[8:11], a[216:219], v[28:31]
ds_read_b128 a[52:55], v1 offset:5120
v_cvt_pk_bf16_f32 v78, v44, v45
v_mfma_f32_16x16x32_bf16 v[28:31], a[12:15], a[220:223], v[28:31]
buffer_load_dwordx4 v3, s[48:51], s32 offen offset:3072 sc1 lds
v_mfma_f32_16x16x32_bf16 v[40:43], a[16:19], a[192:195], v[88:91]
ds_read_b128 a[56:59], v1 offset:6144
s_add_u32 s32, s32, 0x8000
v_mfma_f32_16x16x32_bf16 v[40:43], a[20:23], a[196:199], v[40:43]
ds_read_b128 a[60:63], v1 offset:7168
v_cvt_pk_bf16_f32 v79, v46, v47
v_mfma_f32_16x16x32_bf16 v[40:43], a[24:27], a[200:203], v[40:43]
v_exp_f32 v24, v24
v_mfma_f32_16x16x32_bf16 v[40:43], a[28:31], a[204:207], v[40:43]
v_exp_f32 v25, v25
v_mfma_f32_16x16x32_bf16 v[44:47], a[16:19], a[208:211], v[92:95]
v_exp_f32 v26, v26
v_mfma_f32_16x16x32_bf16 v[44:47], a[20:23], a[212:215], v[44:47]
v_exp_f32 v27, v27
v_mfma_f32_16x16x32_bf16 v[44:47], a[24:27], a[216:219], v[44:47]
v_exp_f32 v28, v28
v_mfma_f32_16x16x32_bf16 v[44:47], a[28:31], a[220:223], v[44:47]
s_waitcnt lgkmcnt(0)
v_exp_f32 v29, v29
v_mfma_f32_16x16x32_bf16 v[192:195], a[32:35], v[72:75], v[192:195]
s_add_u32 m0, s27, 0x1000
v_exp_f32 v30, v30
v_mfma_f32_16x16x32_bf16 v[224:227], a[32:35], v[76:79], v[224:227]
buffer_load_dwordx4 v3, s[48:51], s7 offen offset:0 sc1 lds
v_mfma_f32_16x16x32_bf16 v[228:231], a[36:39], v[76:79], v[228:231]
v_exp_f32 v31, v31
v_mfma_f32_16x16x32_bf16 v[196:199], a[36:39], v[72:75], v[196:199]
ds_read_b128 a[0:3], v1 offset:24576
v_cvt_pk_bf16_f32 v56, v24, v25
v_mfma_f32_16x16x32_bf16 v[200:203], a[40:43], v[72:75], v[200:203]
ds_read_b128 a[4:7], v1 offset:25600
v_cvt_pk_bf16_f32 v57, v26, v27
v_mfma_f32_16x16x32_bf16 v[232:235], a[40:43], v[76:79], v[232:235]
v_exp_f32 v40, v40
v_mfma_f32_16x16x32_bf16 v[236:239], a[44:47], v[76:79], v[236:239]
ds_read_b128 a[8:11], v1 offset:26624
v_cvt_pk_bf16_f32 v60, v28, v29
v_mfma_f32_16x16x32_bf16 v[204:207], a[44:47], v[72:75], v[204:207]
v_exp_f32 v41, v41
v_mfma_f32_16x16x32_bf16 v[208:211], a[48:51], v[72:75], v[208:211]
ds_read_b128 a[12:15], v1 offset:27648
v_cvt_pk_bf16_f32 v61, v30, v31
v_mfma_f32_16x16x32_bf16 v[240:243], a[48:51], v[76:79], v[240:243]
ds_read_b128 a[16:19], v1 offset:28672
v_cvt_pk_bf16_f32 v58, v40, v41
v_mfma_f32_16x16x32_bf16 v[244:247], a[52:55], v[76:79], v[244:247]
v_exp_f32 v42, v42
v_mfma_f32_16x16x32_bf16 v[212:215], a[52:55], v[72:75], v[212:215]
buffer_load_dwordx4 v3, s[48:51], s7 offen offset:1024 sc1 lds
v_mfma_f32_16x16x32_bf16 v[216:219], a[56:59], v[72:75], v[216:219]
ds_read_b128 a[20:23], v1 offset:29696
v_mfma_f32_16x16x32_bf16 v[248:251], a[56:59], v[76:79], v[248:251]
ds_read_b128 a[24:27], v1 offset:30720
v_mfma_f32_16x16x32_bf16 v[252:255], a[60:63], v[76:79], v[252:255]
ds_read_b128 a[28:31], v1 offset:31744
v_mfma_f32_16x16x32_bf16 v[220:223], a[60:63], v[72:75], v[220:223]
s_waitcnt lgkmcnt(4)
v_exp_f32 v43, v43
v_smfmac_f32_16x16x64_bf16 a[228:231], a[232:235], v[72:79], v9
ds_read_b128 a[32:35], v1 offset:16384
v_cvt_pk_bf16_f32 v59, v42, v43
v_mfma_f32_16x16x32_bf16 v[24:27], a[0:3], a[192:195], v[88:91]
ds_read_b128 a[36:39], v1 offset:17408
v_mfma_f32_16x16x32_bf16 v[24:27], a[4:7], a[196:199], v[24:27]
buffer_load_dwordx4 v3, s[48:51], s7 offen offset:2048 sc1 lds
v_mfma_f32_16x16x32_bf16 v[24:27], a[8:11], a[200:203], v[24:27]
ds_read_b128 a[40:43], v1 offset:18432
v_exp_f32 v44, v44
v_mfma_f32_16x16x32_bf16 v[24:27], a[12:15], a[204:207], v[24:27]
ds_read_b128 a[44:47], v1 offset:19456
v_exp_f32 v45, v45
v_mfma_f32_16x16x32_bf16 v[28:31], a[0:3], a[208:211], v[92:95]
ds_read_b128 a[48:51], v1 offset:20480
v_exp_f32 v46, v46
v_mfma_f32_16x16x32_bf16 v[28:31], a[4:7], a[212:215], v[28:31]
s_waitcnt lgkmcnt(5)
v_exp_f32 v47, v47
v_mfma_f32_16x16x32_bf16 v[28:31], a[8:11], a[216:219], v[28:31]
ds_read_b128 a[52:55], v1 offset:21504
v_cvt_pk_bf16_f32 v62, v44, v45
v_mfma_f32_16x16x32_bf16 v[28:31], a[12:15], a[220:223], v[28:31]
ds_read_b128 a[56:59], v1 offset:22528
v_cvt_pk_bf16_f32 v63, v46, v47
v_mfma_f32_16x16x32_bf16 v[40:43], a[16:19], a[192:195], v[88:91]
ds_read_b128 a[60:63], v1 offset:23552
v_xor_b32 v1, 0x8000, v1
v_mfma_f32_16x16x32_bf16 v[40:43], a[20:23], a[196:199], v[40:43]
buffer_load_dwordx4 v3, s[48:51], s7 offen offset:3072 sc1 lds
v_mfma_f32_16x16x32_bf16 v[40:43], a[24:27], a[200:203], v[40:43]
s_add_u32 s7, s7, 0x8000
v_exp_f32 v24, v24
v_mfma_f32_16x16x32_bf16 v[40:43], a[28:31], a[204:207], v[40:43]
s_xor_b32 s27, s27, 0x38000
v_exp_f32 v25, v25
v_mfma_f32_16x16x32_bf16 v[44:47], a[16:19], a[208:211], v[92:95]
v_exp_f32 v26, v26
v_mfma_f32_16x16x32_bf16 v[44:47], a[20:23], a[212:215], v[44:47]
v_exp_f32 v27, v27
v_mfma_f32_16x16x32_bf16 v[44:47], a[24:27], a[216:219], v[44:47]
s_waitcnt vmcnt(16) lgkmcnt(0)
v_exp_f32 v28, v28
v_mfma_f32_16x16x32_bf16 v[44:47], a[28:31], a[220:223], v[44:47]
s_barrier
v_exp_f32 v29, v29
L_att_sodd0:
v_mfma_f32_16x16x32_bf16 v[192:195], a[32:35], v[56:59], v[192:195]
v_exp_f32 v30, v30
v_mfma_f32_16x16x32_bf16 v[224:227], a[32:35], v[60:63], v[224:227]
ds_read_b128 a[0:3], v2 offset:8192
v_cvt_pk_bf16_f32 v72, v24, v25
v_mfma_f32_16x16x32_bf16 v[228:231], a[36:39], v[60:63], v[228:231]
ds_read_b128 a[4:7], v2 offset:9216
v_cvt_pk_bf16_f32 v73, v26, v27
v_mfma_f32_16x16x32_bf16 v[196:199], a[36:39], v[56:59], v[196:199]
s_add_u32 m0, s19, 0x0
v_exp_f32 v31, v31
v_mfma_f32_16x16x32_bf16 v[200:203], a[40:43], v[56:59], v[200:203]
ds_read_b128 a[8:11], v2 offset:10240
v_cvt_pk_bf16_f32 v76, v28, v29
v_mfma_f32_16x16x32_bf16 v[232:235], a[40:43], v[60:63], v[232:235]
buffer_load_dwordx4 v3, s[48:51], s32 offen offset:0 sc1 lds
v_mfma_f32_16x16x32_bf16 v[236:239], a[44:47], v[60:63], v[236:239]
v_exp_f32 v40, v40
v_mfma_f32_16x16x32_bf16 v[204:207], a[44:47], v[56:59], v[204:207]
ds_read_b128 a[12:15], v2 offset:11264
v_cvt_pk_bf16_f32 v77, v30, v31
v_mfma_f32_16x16x32_bf16 v[208:211], a[48:51], v[56:59], v[208:211]
ds_read_b128 a[16:19], v2 offset:12288
v_mfma_f32_16x16x32_bf16 v[240:243], a[48:51], v[60:63], v[240:243]
buffer_load_dwordx4 v3, s[48:51], s32 offen offset:1024 sc1 lds
v_mfma_f32_16x16x32_bf16 v[244:247], a[52:55], v[60:63], v[244:247]
ds_read_b128 a[20:23], v2 offset:13312
v_mfma_f32_16x16x32_bf16 v[212:215], a[52:55], v[56:59], v[212:215]
ds_read_b128 a[24:27], v2 offset:14336
v_mfma_f32_16x16x32_bf16 v[216:219], a[56:59], v[56:59], v[216:219]
ds_read_b128 a[28:31], v2 offset:15360
v_mfma_f32_16x16x32_bf16 v[248:251], a[56:59], v[60:63], v[248:251]
ds_read_b128 a[32:35], v2 offset:0
v_exp_f32 v41, v41
v_mfma_f32_16x16x32_bf16 v[252:255], a[60:63], v[60:63], v[252:255]
v_exp_f32 v42, v42
v_mfma_f32_16x16x32_bf16 v[220:223], a[60:63], v[56:59], v[220:223]
s_waitcnt lgkmcnt(5)
v_exp_f32 v43, v43
v_smfmac_f32_16x16x64_bf16 a[228:231], a[232:235], v[56:63], v9
ds_read_b128 a[36:39], v2 offset:1024
v_cvt_pk_bf16_f32 v74, v40, v41
v_mfma_f32_16x16x32_bf16 v[24:27], a[0:3], a[192:195], v[88:91]
ds_read_b128 a[40:43], v2 offset:2048
v_exp_f32 v44, v44
v_mfma_f32_16x16x32_bf16 v[24:27], a[4:7], a[196:199], v[24:27]
buffer_load_dwordx4 v3, s[48:51], s32 offen offset:2048 sc1 lds
v_mfma_f32_16x16x32_bf16 v[24:27], a[8:11], a[200:203], v[24:27]
v_exp_f32 v45, v45
v_mfma_f32_16x16x32_bf16 v[24:27], a[12:15], a[204:207], v[24:27]
ds_read_b128 a[44:47], v2 offset:3072
v_cvt_pk_bf16_f32 v75, v42, v43
v_mfma_f32_16x16x32_bf16 v[28:31], a[0:3], a[208:211], v[92:95]
ds_read_b128 a[48:51], v2 offset:4096
v_exp_f32 v46, v46
v_mfma_f32_16x16x32_bf16 v[28:31], a[4:7], a[212:215], v[28:31]
s_waitcnt lgkmcnt(5)
v_exp_f32 v47, v47
v_mfma_f32_16x16x32_bf16 v[28:31], a[8:11], a[216:219], v[28:31]
ds_read_b128 a[52:55], v2 offset:5120
v_cvt_pk_bf16_f32 v78, v44, v45
v_mfma_f32_16x16x32_bf16 v[28:31], a[12:15], a[220:223], v[28:31]
buffer_load_dwordx4 v3, s[48:51], s32 offen offset:3072 sc1 lds
v_mfma_f32_16x16x32_bf16 v[40:43], a[16:19], a[192:195], v[88:91]
ds_read_b128 a[56:59], v2 offset:6144
s_add_u32 s32, s32, 0x8000
v_mfma_f32_16x16x32_bf16 v[40:43], a[20:23], a[196:199], v[40:43]
ds_read_b128 a[60:63], v2 offset:7168
v_cvt_pk_bf16_f32 v79, v46, v47
v_mfma_f32_16x16x32_bf16 v[40:43], a[24:27], a[200:203], v[40:43]
v_exp_f32 v24, v24
v_mfma_f32_16x16x32_bf16 v[40:43], a[28:31], a[204:207], v[40:43]
v_exp_f32 v25, v25
v_mfma_f32_16x16x32_bf16 v[44:47], a[16:19], a[208:211], v[92:95]
v_exp_f32 v26, v26
v_mfma_f32_16x16x32_bf16 v[44:47], a[20:23], a[212:215], v[44:47]
v_exp_f32 v27, v27
v_mfma_f32_16x16x32_bf16 v[44:47], a[24:27], a[216:219], v[44:47]
v_exp_f32 v28, v28
v_mfma_f32_16x16x32_bf16 v[44:47], a[28:31], a[220:223], v[44:47]
s_waitcnt lgkmcnt(0)
v_exp_f32 v29, v29
v_mfma_f32_16x16x32_bf16 v[192:195], a[32:35], v[72:75], v[192:195]
v_exp_f32 v30, v30
v_mfma_f32_16x16x32_bf16 v[224:227], a[32:35], v[76:79], v[224:227]
v_exp_f32 v31, v31
v_mfma_f32_16x16x32_bf16 v[228:231], a[36:39], v[76:79], v[228:231]
v_exp_f32 v40, v40
v_mfma_f32_16x16x32_bf16 v[196:199], a[36:39], v[72:75], v[196:199]
s_add_u32 m0, s19, 0x1000
v_exp_f32 v41, v41
v_mfma_f32_16x16x32_bf16 v[200:203], a[40:43], v[72:75], v[200:203]
ds_read_b128 a[0:3], v2 offset:24576
v_cvt_pk_bf16_f32 v56, v24, v25
v_mfma_f32_16x16x32_bf16 v[232:235], a[40:43], v[76:79], v[232:235]
buffer_load_dwordx4 v3, s[48:51], s7 offen offset:0 sc1 lds
v_mfma_f32_16x16x32_bf16 v[236:239], a[44:47], v[76:79], v[236:239]
ds_read_b128 a[4:7], v2 offset:25600
v_cvt_pk_bf16_f32 v57, v26, v27
v_mfma_f32_16x16x32_bf16 v[204:207], a[44:47], v[72:75], v[204:207]
ds_read_b128 a[8:11], v2 offset:26624
v_cvt_pk_bf16_f32 v60, v28, v29
v_mfma_f32_16x16x32_bf16 v[208:211], a[48:51], v[72:75], v[208:211]
ds_read_b128 a[12:15], v2 offset:27648
v_cvt_pk_bf16_f32 v61, v30, v31
v_mfma_f32_16x16x32_bf16 v[240:243], a[48:51], v[76:79], v[240:243]
ds_read_b128 a[16:19], v2 offset:28672
v_cvt_pk_bf16_f32 v58, v40, v41
v_mfma_f32_16x16x32_bf16 v[244:247], a[52:55], v[76:79], v[244:247]
buffer_load_dwordx4 v3, s[48:51], s7 offen offset:1024 sc1 lds
v_mfma_f32_16x16x32_bf16 v[212:215], a[52:55], v[72:75], v[212:215]
ds_read_b128 a[20:23], v2 offset:29696
v_mfma_f32_16x16x32_bf16 v[216:219], a[56:59], v[72:75], v[216:219]
v_exp_f32 v42, v42
v_mfma_f32_16x16x32_bf16 v[248:251], a[56:59], v[76:79], v[248:251]
ds_read_b128 a[24:27], v2 offset:30720
v_mfma_f32_16x16x32_bf16 v[252:255], a[60:63], v[76:79], v[252:255]
ds_read_b128 a[28:31], v2 offset:31744
v_exp_f32 v43, v43
v_mfma_f32_16x16x32_bf16 v[220:223], a[60:63], v[72:75], v[220:223]
ds_read_b128 a[32:35], v2 offset:16384
v_cvt_pk_bf16_f32 v59, v42, v43
v_smfmac_f32_16x16x64_bf16 a[228:231], a[232:235], v[72:79], v9
ds_read_b128 a[36:39], v2 offset:17408
s_waitcnt lgkmcnt(6)
v_mfma_f32_16x16x32_bf16 v[24:27], a[0:3], a[192:195], v[88:91]
buffer_load_dwordx4 v3, s[48:51], s7 offen offset:2048 sc1 lds
v_mfma_f32_16x16x32_bf16 v[24:27], a[4:7], a[196:199], v[24:27]
ds_read_b128 a[40:43], v2 offset:18432
v_exp_f32 v44, v44
v_mfma_f32_16x16x32_bf16 v[24:27], a[8:11], a[200:203], v[24:27]
ds_read_b128 a[44:47], v2 offset:19456
v_exp_f32 v45, v45
v_mfma_f32_16x16x32_bf16 v[24:27], a[12:15], a[204:207], v[24:27]
ds_read_b128 a[48:51], v2 offset:20480
v_cvt_pk_bf16_f32 v62, v44, v45
v_mfma_f32_16x16x32_bf16 v[28:31], a[0:3], a[208:211], v[92:95]
v_exp_f32 v46, v46
v_mfma_f32_16x16x32_bf16 v[28:31], a[4:7], a[212:215], v[28:31]
s_waitcnt lgkmcnt(5)
v_exp_f32 v47, v47
v_mfma_f32_16x16x32_bf16 v[28:31], a[8:11], a[216:219], v[28:31]
ds_read_b128 a[52:55], v2 offset:21504
v_cvt_pk_bf16_f32 v63, v46, v47
v_mfma_f32_16x16x32_bf16 v[28:31], a[12:15], a[220:223], v[28:31]
buffer_load_dwordx4 v3, s[48:51], s7 offen offset:3072 sc1 lds
v_mfma_f32_16x16x32_bf16 v[40:43], a[16:19], a[192:195], v[88:91]
ds_read_b128 a[56:59], v2 offset:22528
s_add_u32 s7, s7, 0x8000
v_mfma_f32_16x16x32_bf16 v[40:43], a[20:23], a[196:199], v[40:43]
ds_read_b128 a[60:63], v2 offset:23552
v_xor_b32 v2, 0x38000, v2
v_mfma_f32_16x16x32_bf16 v[40:43], a[24:27], a[200:203], v[40:43]
s_xor_b32 s19, s19, 0x8000
v_exp_f32 v24, v24
v_mfma_f32_16x16x32_bf16 v[40:43], a[28:31], a[204:207], v[40:43]
s_sub_u32 s15, s15, 1
v_exp_f32 v25, v25
v_mfma_f32_16x16x32_bf16 v[44:47], a[16:19], a[208:211], v[92:95]
s_cmp_lg_u32 s15, 0
v_exp_f32 v26, v26
v_mfma_f32_16x16x32_bf16 v[44:47], a[20:23], a[212:215], v[44:47]
v_exp_f32 v27, v27
v_mfma_f32_16x16x32_bf16 v[44:47], a[24:27], a[216:219], v[44:47]
s_waitcnt vmcnt(16) lgkmcnt(0)
v_exp_f32 v28, v28
v_mfma_f32_16x16x32_bf16 v[44:47], a[28:31], a[220:223], v[44:47]
s_barrier
v_exp_f32 v29, v29
s_cbranch_scc1 L_att_seven0
s_branch L_att_sdone
L_att_seven1:
v_mfma_f32_16x16x32_bf16 v[192:195], a[32:35], v[56:59], v[192:195]
v_exp_f32 v30, v30
v_mfma_f32_16x16x32_bf16 v[224:227], a[32:35], v[60:63], v[224:227]
ds_read_b128 a[0:3], v1 offset:8192
v_cvt_pk_bf16_f32 v72, v24, v25
v_mfma_f32_16x16x32_bf16 v[228:231], a[36:39], v[60:63], v[228:231]
ds_read_b128 a[4:7], v1 offset:9216
v_cvt_pk_bf16_f32 v73, v26, v27
v_mfma_f32_16x16x32_bf16 v[196:199], a[36:39], v[56:59], v[196:199]
s_add_u32 m0, s27, 0x0
v_exp_f32 v31, v31
v_mfma_f32_16x16x32_bf16 v[200:203], a[40:43], v[56:59], v[200:203]
ds_read_b128 a[8:11], v1 offset:10240
v_cvt_pk_bf16_f32 v76, v28, v29
v_mfma_f32_16x16x32_bf16 v[232:235], a[40:43], v[60:63], v[232:235]
buffer_load_dwordx4 v3, s[48:51], s32 offen offset:0 sc1 lds
v_mfma_f32_16x16x32_bf16 v[236:239], a[44:47], v[60:63], v[236:239]
v_exp_f32 v40, v40
v_mfma_f32_16x16x32_bf16 v[204:207], a[44:47], v[56:59], v[204:207]
ds_read_b128 a[12:15], v1 offset:11264
v_cvt_pk_bf16_f32 v77, v30, v31
v_mfma_f32_16x16x32_bf16 v[208:211], a[48:51], v[56:59], v[208:211]
ds_read_b128 a[16:19], v1 offset:12288
v_mfma_f32_16x16x32_bf16 v[240:243], a[48:51], v[60:63], v[240:243]
buffer_load_dwordx4 v3, s[48:51], s32 offen offset:1024 sc1 lds
v_mfma_f32_16x16x32_bf16 v[244:247], a[52:55], v[60:63], v[244:247]
ds_read_b128 a[20:23], v1 offset:13312
v_mfma_f32_16x16x32_bf16 v[212:215], a[52:55], v[56:59], v[212:215]
ds_read_b128 a[24:27], v1 offset:14336
v_mfma_f32_16x16x32_bf16 v[216:219], a[56:59], v[56:59], v[216:219]
ds_read_b128 a[28:31], v1 offset:15360
v_mfma_f32_16x16x32_bf16 v[248:251], a[56:59], v[60:63], v[248:251]
ds_read_b128 a[32:35], v1 offset:0
v_exp_f32 v41, v41
v_mfma_f32_16x16x32_bf16 v[252:255], a[60:63], v[60:63], v[252:255]
v_exp_f32 v42, v42
v_mfma_f32_16x16x32_bf16 v[220:223], a[60:63], v[56:59], v[220:223]
s_waitcnt lgkmcnt(5)
v_exp_f32 v43, v43
v_smfmac_f32_16x16x64_bf16 a[228:231], a[232:235], v[56:63], v9
ds_read_b128 a[36:39], v1 offset:1024
v_cvt_pk_bf16_f32 v74, v40, v41
v_mfma_f32_16x16x32_bf16 v[24:27], a[0:3], a[192:195], v[88:91]
ds_read_b128 a[40:43], v1 offset:2048
v_exp_f32 v44, v44
v_mfma_f32_16x16x32_bf16 v[24:27], a[4:7], a[196:199], v[24:27]
buffer_load_dwordx4 v3, s[48:51], s32 offen offset:2048 sc1 lds
v_mfma_f32_16x16x32_bf16 v[24:27], a[8:11], a[200:203], v[24:27]
v_exp_f32 v45, v45
v_mfma_f32_16x16x32_bf16 v[24:27], a[12:15], a[204:207], v[24:27]
ds_read_b128 a[44:47], v1 offset:3072
v_cvt_pk_bf16_f32 v75, v42, v43
v_mfma_f32_16x16x32_bf16 v[28:31], a[0:3], a[208:211], v[92:95]
ds_read_b128 a[48:51], v1 offset:4096
v_exp_f32 v46, v46
v_mfma_f32_16x16x32_bf16 v[28:31], a[4:7], a[212:215], v[28:31]
s_waitcnt lgkmcnt(5)
v_exp_f32 v47, v47
v_mfma_f32_16x16x32_bf16 v[28:31], a[8:11], a[216:219], v[28:31]
ds_read_b128 a[52:55], v1 offset:5120
v_cvt_pk_bf16_f32 v78, v44, v45
v_mfma_f32_16x16x32_bf16 v[28:31], a[12:15], a[220:223], v[28:31]
buffer_load_dwordx4 v3, s[48:51], s32 offen offset:3072 sc1 lds
v_mfma_f32_16x16x32_bf16 v[40:43], a[16:19], a[192:195], v[88:91]
ds_read_b128 a[56:59], v1 offset:6144
s_add_u32 s32, s32, 0x8000
v_mfma_f32_16x16x32_bf16 v[40:43], a[20:23], a[196:199], v[40:43]
ds_read_b128 a[60:63], v1 offset:7168
v_cvt_pk_bf16_f32 v79, v46, v47
v_mfma_f32_16x16x32_bf16 v[40:43], a[24:27], a[200:203], v[40:43]
v_exp_f32 v24, v24
v_mfma_f32_16x16x32_bf16 v[40:43], a[28:31], a[204:207], v[40:43]
v_exp_f32 v25, v25
v_mfma_f32_16x16x32_bf16 v[44:47], a[16:19], a[208:211], v[92:95]
v_exp_f32 v26, v26
v_mfma_f32_16x16x32_bf16 v[44:47], a[20:23], a[212:215], v[44:47]
v_exp_f32 v27, v27
v_mfma_f32_16x16x32_bf16 v[44:47], a[24:27], a[216:219], v[44:47]
v_exp_f32 v28, v28
v_mfma_f32_16x16x32_bf16 v[44:47], a[28:31], a[220:223], v[44:47]
s_waitcnt lgkmcnt(0)
v_exp_f32 v29, v29
v_mfma_f32_16x16x32_bf16 v[192:195], a[32:35], v[72:75], v[192:195]
s_add_u32 m0, s27, 0x1000
v_exp_f32 v30, v30
v_mfma_f32_16x16x32_bf16 v[224:227], a[32:35], v[76:79], v[224:227]
buffer_load_dwordx4 v3, s[48:51], s7 offen offset:0 sc1 lds
v_mfma_f32_16x16x32_bf16 v[228:231], a[36:39], v[76:79], v[228:231]
v_exp_f32 v31, v31
v_mfma_f32_16x16x32_bf16 v[196:199], a[36:39], v[72:75], v[196:199]
ds_read_b128 a[0:3], v1 offset:24576
v_cvt_pk_bf16_f32 v56, v24, v25
v_mfma_f32_16x16x32_bf16 v[200:203], a[40:43], v[72:75], v[200:203]
ds_read_b128 a[4:7], v1 offset:25600
v_cvt_pk_bf16_f32 v57, v26, v27
v_mfma_f32_16x16x32_bf16 v[232:235], a[40:43], v[76:79], v[232:235]
v_exp_f32 v40, v40
v_mfma_f32_16x16x32_bf16 v[236:239], a[44:47], v[76:79], v[236:239]
ds_read_b128 a[8:11], v1 offset:26624
v_cvt_pk_bf16_f32 v60, v28, v29
v_mfma_f32_16x16x32_bf16 v[204:207], a[44:47], v[72:75], v[204:207]
v_exp_f32 v41, v41
v_mfma_f32_16x16x32_bf16 v[208:211], a[48:51], v[72:75], v[208:211]
ds_read_b128 a[12:15], v1 offset:27648
v_cvt_pk_bf16_f32 v61, v30, v31
v_mfma_f32_16x16x32_bf16 v[240:243], a[48:51], v[76:79], v[240:243]
ds_read_b128 a[16:19], v1 offset:28672
v_cvt_pk_bf16_f32 v58, v40, v41
v_mfma_f32_16x16x32_bf16 v[244:247], a[52:55], v[76:79], v[244:247]
v_exp_f32 v42, v42
v_mfma_f32_16x16x32_bf16 v[212:215], a[52:55], v[72:75], v[212:215]
buffer_load_dwordx4 v3, s[48:51], s7 offen offset:1024 sc1 lds
v_mfma_f32_16x16x32_bf16 v[216:219], a[56:59], v[72:75], v[216:219]
ds_read_b128 a[20:23], v1 offset:29696
v_mfma_f32_16x16x32_bf16 v[248:251], a[56:59], v[76:79], v[248:251]
ds_read_b128 a[24:27], v1 offset:30720
v_mfma_f32_16x16x32_bf16 v[252:255], a[60:63], v[76:79], v[252:255]
ds_read_b128 a[28:31], v1 offset:31744
v_mfma_f32_16x16x32_bf16 v[220:223], a[60:63], v[72:75], v[220:223]
s_waitcnt lgkmcnt(4)
v_exp_f32 v43, v43
v_smfmac_f32_16x16x64_bf16 a[228:231], a[232:235], v[72:79], v9
ds_read_b128 a[32:35], v1 offset:16384
v_cvt_pk_bf16_f32 v59, v42, v43
v_mfma_f32_16x16x32_bf16 v[24:27], a[0:3], a[192:195], v[88:91]
ds_read_b128 a[36:39], v1 offset:17408
v_mfma_f32_16x16x32_bf16 v[24:27], a[4:7], a[196:199], v[24:27]
buffer_load_dwordx4 v3, s[48:51], s7 offen offset:2048 sc1 lds
v_mfma_f32_16x16x32_bf16 v[24:27], a[8:11], a[200:203], v[24:27]
ds_read_b128 a[40:43], v1 offset:18432
v_exp_f32 v44, v44
v_mfma_f32_16x16x32_bf16 v[24:27], a[12:15], a[204:207], v[24:27]
ds_read_b128 a[44:47], v1 offset:19456
v_exp_f32 v45, v45
v_mfma_f32_16x16x32_bf16 v[28:31], a[0:3], a[208:211], v[92:95]
ds_read_b128 a[48:51], v1 offset:20480
v_exp_f32 v46, v46
v_mfma_f32_16x16x32_bf16 v[28:31], a[4:7], a[212:215], v[28:31]
s_waitcnt lgkmcnt(5)
v_exp_f32 v47, v47
v_mfma_f32_16x16x32_bf16 v[28:31], a[8:11], a[216:219], v[28:31]
ds_read_b128 a[52:55], v1 offset:21504
v_cvt_pk_bf16_f32 v62, v44, v45
v_mfma_f32_16x16x32_bf16 v[28:31], a[12:15], a[220:223], v[28:31]
ds_read_b128 a[56:59], v1 offset:22528
v_cvt_pk_bf16_f32 v63, v46, v47
v_mfma_f32_16x16x32_bf16 v[40:43], a[16:19], a[192:195], v[88:91]
ds_read_b128 a[60:63], v1 offset:23552
v_xor_b32 v1, 0x8000, v1
v_mfma_f32_16x16x32_bf16 v[40:43], a[20:23], a[196:199], v[40:43]
buffer_load_dwordx4 v3, s[48:51], s7 offen offset:3072 sc1 lds
v_mfma_f32_16x16x32_bf16 v[40:43], a[24:27], a[200:203], v[40:43]
s_add_u32 s7, s7, 0x8000
v_exp_f32 v24, v24
v_mfma_f32_16x16x32_bf16 v[40:43], a[28:31], a[204:207], v[40:43]
s_xor_b32 s27, s27, 0x38000
v_exp_f32 v25, v25
v_mfma_f32_16x16x32_bf16 v[44:47], a[16:19], a[208:211], v[92:95]
s_waitcnt vmcnt(16) lgkmcnt(0)
v_exp_f32 v26, v26
v_mfma_f32_16x16x32_bf16 v[44:47], a[20:23], a[212:215], v[44:47]
s_barrier
v_exp_f32 v27, v27
v_mfma_f32_16x16x32_bf16 v[44:47], a[24:27], a[216:219], v[44:47]
v_exp_f32 v28, v28
v_mfma_f32_16x16x32_bf16 v[44:47], a[28:31], a[220:223], v[44:47]
v_exp_f32 v29, v29
L_att_sodd1:
v_mfma_f32_16x16x32_bf16 v[192:195], a[32:35], v[56:59], v[192:195]
v_exp_f32 v30, v30
v_mfma_f32_16x16x32_bf16 v[224:227], a[32:35], v[60:63], v[224:227]
ds_read_b128 a[0:3], v2 offset:8192
v_cvt_pk_bf16_f32 v72, v24, v25
v_mfma_f32_16x16x32_bf16 v[228:231], a[36:39], v[60:63], v[228:231]
ds_read_b128 a[4:7], v2 offset:9216
v_cvt_pk_bf16_f32 v73, v26, v27
v_mfma_f32_16x16x32_bf16 v[196:199], a[36:39], v[56:59], v[196:199]
s_add_u32 m0, s19, 0x0
v_exp_f32 v31, v31
v_mfma_f32_16x16x32_bf16 v[200:203], a[40:43], v[56:59], v[200:203]
ds_read_b128 a[8:11], v2 offset:10240
v_cvt_pk_bf16_f32 v76, v28, v29
v_mfma_f32_16x16x32_bf16 v[232:235], a[40:43], v[60:63], v[232:235]
buffer_load_dwordx4 v3, s[48:51], s32 offen offset:0 sc1 lds
v_mfma_f32_16x16x32_bf16 v[236:239], a[44:47], v[60:63], v[236:239]
v_exp_f32 v40, v40
v_mfma_f32_16x16x32_bf16 v[204:207], a[44:47], v[56:59], v[204:207]
ds_read_b128 a[12:15], v2 offset:11264
v_cvt_pk_bf16_f32 v77, v30, v31
v_mfma_f32_16x16x32_bf16 v[208:211], a[48:51], v[56:59], v[208:211]
ds_read_b128 a[16:19], v2 offset:12288
v_mfma_f32_16x16x32_bf16 v[240:243], a[48:51], v[60:63], v[240:243]
buffer_load_dwordx4 v3, s[48:51], s32 offen offset:1024 sc1 lds
v_mfma_f32_16x16x32_bf16 v[244:247], a[52:55], v[60:63], v[244:247]
ds_read_b128 a[20:23], v2 offset:13312
v_mfma_f32_16x16x32_bf16 v[212:215], a[52:55], v[56:59], v[212:215]
ds_read_b128 a[24:27], v2 offset:14336
v_mfma_f32_16x16x32_bf16 v[216:219], a[56:59], v[56:59], v[216:219]
ds_read_b128 a[28:31], v2 offset:15360
v_mfma_f32_16x16x32_bf16 v[248:251], a[56:59], v[60:63], v[248:251]
ds_read_b128 a[32:35], v2 offset:0
v_exp_f32 v41, v41
v_mfma_f32_16x16x32_bf16 v[252:255], a[60:63], v[60:63], v[252:255]
v_exp_f32 v42, v42
v_mfma_f32_16x16x32_bf16 v[220:223], a[60:63], v[56:59], v[220:223]
s_waitcnt lgkmcnt(5)
v_exp_f32 v43, v43
v_smfmac_f32_16x16x64_bf16 a[228:231], a[232:235], v[56:63], v9
ds_read_b128 a[36:39], v2 offset:1024
v_cvt_pk_bf16_f32 v74, v40, v41
v_mfma_f32_16x16x32_bf16 v[24:27], a[0:3], a[192:195], v[88:91]
ds_read_b128 a[40:43], v2 offset:2048
v_exp_f32 v44, v44
v_mfma_f32_16x16x32_bf16 v[24:27], a[4:7], a[196:199], v[24:27]
buffer_load_dwordx4 v3, s[48:51], s32 offen offset:2048 sc1 lds
v_mfma_f32_16x16x32_bf16 v[24:27], a[8:11], a[200:203], v[24:27]
v_exp_f32 v45, v45
v_mfma_f32_16x16x32_bf16 v[24:27], a[12:15], a[204:207], v[24:27]
ds_read_b128 a[44:47], v2 offset:3072
v_cvt_pk_bf16_f32 v75, v42, v43
v_mfma_f32_16x16x32_bf16 v[28:31], a[0:3], a[208:211], v[92:95]
ds_read_b128 a[48:51], v2 offset:4096
v_exp_f32 v46, v46
v_mfma_f32_16x16x32_bf16 v[28:31], a[4:7], a[212:215], v[28:31]
s_waitcnt lgkmcnt(5)
v_exp_f32 v47, v47
v_mfma_f32_16x16x32_bf16 v[28:31], a[8:11], a[216:219], v[28:31]
ds_read_b128 a[52:55], v2 offset:5120
v_cvt_pk_bf16_f32 v78, v44, v45
v_mfma_f32_16x16x32_bf16 v[28:31], a[12:15], a[220:223], v[28:31]
buffer_load_dwordx4 v3, s[48:51], s32 offen offset:3072 sc1 lds
v_mfma_f32_16x16x32_bf16 v[40:43], a[16:19], a[192:195], v[88:91]
ds_read_b128 a[56:59], v2 offset:6144
s_add_u32 s32, s32, 0x8000
v_mfma_f32_16x16x32_bf16 v[40:43], a[20:23], a[196:199], v[40:43]
ds_read_b128 a[60:63], v2 offset:7168
v_cvt_pk_bf16_f32 v79, v46, v47
v_mfma_f32_16x16x32_bf16 v[40:43], a[24:27], a[200:203], v[40:43]
v_exp_f32 v24, v24
v_mfma_f32_16x16x32_bf16 v[40:43], a[28:31], a[204:207], v[40:43]
v_exp_f32 v25, v25
v_mfma_f32_16x16x32_bf16 v[44:47], a[16:19], a[208:211], v[92:95]
v_exp_f32 v26, v26
v_mfma_f32_16x16x32_bf16 v[44:47], a[20:23], a[212:215], v[44:47]
v_exp_f32 v27, v27
v_mfma_f32_16x16x32_bf16 v[44:47], a[24:27], a[216:219], v[44:47]
v_exp_f32 v28, v28
v_mfma_f32_16x16x32_bf16 v[44:47], a[28:31], a[220:223], v[44:47]
s_waitcnt lgkmcnt(0)
v_exp_f32 v29, v29
v_mfma_f32_16x16x32_bf16 v[192:195], a[32:35], v[72:75], v[192:195]
v_exp_f32 v30, v30
v_mfma_f32_16x16x32_bf16 v[224:227], a[32:35], v[76:79], v[224:227]
v_exp_f32 v31, v31
v_mfma_f32_16x16x32_bf16 v[228:231], a[36:39], v[76:79], v[228:231]
v_exp_f32 v40, v40
v_mfma_f32_16x16x32_bf16 v[196:199], a[36:39], v[72:75], v[196:199]
s_add_u32 m0, s19, 0x1000
v_exp_f32 v41, v41
v_mfma_f32_16x16x32_bf16 v[200:203], a[40:43], v[72:75], v[200:203]
ds_read_b128 a[0:3], v2 offset:24576
v_cvt_pk_bf16_f32 v56, v24, v25
v_mfma_f32_16x16x32_bf16 v[232:235], a[40:43], v[76:79], v[232:235]
buffer_load_dwordx4 v3, s[48:51], s7 offen offset:0 sc1 lds
v_mfma_f32_16x16x32_bf16 v[236:239], a[44:47], v[76:79], v[236:239]
ds_read_b128 a[4:7], v2 offset:25600
v_cvt_pk_bf16_f32 v57, v26, v27
v_mfma_f32_16x16x32_bf16 v[204:207], a[44:47], v[72:75], v[204:207]
ds_read_b128 a[8:11], v2 offset:26624
v_cvt_pk_bf16_f32 v60, v28, v29
v_mfma_f32_16x16x32_bf16 v[208:211], a[48:51], v[72:75], v[208:211]
ds_read_b128 a[12:15], v2 offset:27648
v_cvt_pk_bf16_f32 v61, v30, v31
v_mfma_f32_16x16x32_bf16 v[240:243], a[48:51], v[76:79], v[240:243]
ds_read_b128 a[16:19], v2 offset:28672
v_cvt_pk_bf16_f32 v58, v40, v41
v_mfma_f32_16x16x32_bf16 v[244:247], a[52:55], v[76:79], v[244:247]
buffer_load_dwordx4 v3, s[48:51], s7 offen offset:1024 sc1 lds
v_mfma_f32_16x16x32_bf16 v[212:215], a[52:55], v[72:75], v[212:215]
ds_read_b128 a[20:23], v2 offset:29696
v_mfma_f32_16x16x32_bf16 v[216:219], a[56:59], v[72:75], v[216:219]
v_exp_f32 v42, v42
v_mfma_f32_16x16x32_bf16 v[248:251], a[56:59], v[76:79], v[248:251]
ds_read_b128 a[24:27], v2 offset:30720
v_mfma_f32_16x16x32_bf16 v[252:255], a[60:63], v[76:79], v[252:255]
ds_read_b128 a[28:31], v2 offset:31744
v_exp_f32 v43, v43
v_mfma_f32_16x16x32_bf16 v[220:223], a[60:63], v[72:75], v[220:223]
ds_read_b128 a[32:35], v2 offset:16384
v_cvt_pk_bf16_f32 v59, v42, v43
v_smfmac_f32_16x16x64_bf16 a[228:231], a[232:235], v[72:79], v9
ds_read_b128 a[36:39], v2 offset:17408
s_waitcnt lgkmcnt(6)
v_mfma_f32_16x16x32_bf16 v[24:27], a[0:3], a[192:195], v[88:91]
buffer_load_dwordx4 v3, s[48:51], s7 offen offset:2048 sc1 lds
v_mfma_f32_16x16x32_bf16 v[24:27], a[4:7], a[196:199], v[24:27]
ds_read_b128 a[40:43], v2 offset:18432
v_exp_f32 v44, v44
v_mfma_f32_16x16x32_bf16 v[24:27], a[8:11], a[200:203], v[24:27]
ds_read_b128 a[44:47], v2 offset:19456
v_exp_f32 v45, v45
v_mfma_f32_16x16x32_bf16 v[24:27], a[12:15], a[204:207], v[24:27]
ds_read_b128 a[48:51], v2 offset:20480
v_cvt_pk_bf16_f32 v62, v44, v45
v_mfma_f32_16x16x32_bf16 v[28:31], a[0:3], a[208:211], v[92:95]
v_exp_f32 v46, v46
v_mfma_f32_16x16x32_bf16 v[28:31], a[4:7], a[212:215], v[28:31]
s_waitcnt lgkmcnt(5)
v_exp_f32 v47, v47
v_mfma_f32_16x16x32_bf16 v[28:31], a[8:11], a[216:219], v[28:31]
ds_read_b128 a[52:55], v2 offset:21504
v_cvt_pk_bf16_f32 v63, v46, v47
v_mfma_f32_16x16x32_bf16 v[28:31], a[12:15], a[220:223], v[28:31]
buffer_load_dwordx4 v3, s[48:51], s7 offen offset:3072 sc1 lds
v_mfma_f32_16x16x32_bf16 v[40:43], a[16:19], a[192:195], v[88:91]
ds_read_b128 a[56:59], v2 offset:22528
s_add_u32 s7, s7, 0x8000
v_mfma_f32_16x16x32_bf16 v[40:43], a[20:23], a[196:199], v[40:43]
ds_read_b128 a[60:63], v2 offset:23552
v_xor_b32 v2, 0x38000, v2
v_mfma_f32_16x16x32_bf16 v[40:43], a[24:27], a[200:203], v[40:43]
s_xor_b32 s19, s19, 0x8000
v_exp_f32 v24, v24
v_mfma_f32_16x16x32_bf16 v[40:43], a[28:31], a[204:207], v[40:43]
s_sub_u32 s15, s15, 1
v_exp_f32 v25, v25
v_mfma_f32_16x16x32_bf16 v[44:47], a[16:19], a[208:211], v[92:95]
s_cmp_lg_u32 s15, 0
s_waitcnt vmcnt(16) lgkmcnt(0)
v_exp_f32 v26, v26
v_mfma_f32_16x16x32_bf16 v[44:47], a[20:23], a[212:215], v[44:47]
s_barrier
v_exp_f32 v27, v27
v_mfma_f32_16x16x32_bf16 v[44:47], a[24:27], a[216:219], v[44:47]
v_exp_f32 v28, v28
v_mfma_f32_16x16x32_bf16 v[44:47], a[28:31], a[220:223], v[44:47]
v_exp_f32 v29, v29
s_cbranch_scc1 L_att_seven1
L_att_sdone:
s_cmp_ge_u32 s4, 2
s_cbranch_scc1 L_att_sh0_1
L_att_sh0_0:
v_mfma_f32_16x16x32_bf16 v[192:195], a[32:35], v[56:59], v[192:195]
v_exp_f32 v30, v30
v_mfma_f32_16x16x32_bf16 v[224:227], a[32:35], v[60:63], v[224:227]
buffer_load_dword v14, v15, s[84:87], 0 offen offset:192 sc1
v_mfma_f32_16x16x32_bf16 v[228:231], a[36:39], v[60:63], v[228:231]
v_exp_f32 v31, v31
v_mfma_f32_16x16x32_bf16 v[196:199], a[36:39], v[56:59], v[196:199]
s_add_u32 m0, s17, 0x10000
v_exp_f32 v40, v40
v_mfma_f32_16x16x32_bf16 v[200:203], a[40:43], v[56:59], v[200:203]
ds_read_b128 a[0:3], v1 offset:8192
v_cvt_pk_bf16_f32 v72, v24, v25
v_mfma_f32_16x16x32_bf16 v[232:235], a[40:43], v[60:63], v[232:235]
ds_read_b128 a[4:7], v1 offset:9216
v_cvt_pk_bf16_f32 v73, v26, v27
v_mfma_f32_16x16x32_bf16 v[236:239], a[44:47], v[60:63], v[236:239]
buffer_load_dwordx4 v12, s[72:75], 0 offen lds
v_mfma_f32_16x16x32_bf16 v[204:207], a[44:47], v[56:59], v[204:207]
ds_read_b128 a[8:11], v1 offset:10240
v_cvt_pk_bf16_f32 v76, v28, v29
v_mfma_f32_16x16x32_bf16 v[208:211], a[48:51], v[56:59], v[208:211]
buffer_load_dwordx4 v13, s[72:75], 0 offen offset:1024 lds
v_mfma_f32_16x16x32_bf16 v[240:243], a[48:51], v[60:63], v[240:243]
ds_read_b128 a[12:15], v1 offset:11264
v_cvt_pk_bf16_f32 v77, v30, v31
v_mfma_f32_16x16x32_bf16 v[244:247], a[52:55], v[60:63], v[244:247]
buffer_load_dwordx4 v12, s[72:75], s12 offen offset:2048 lds
v_mfma_f32_16x16x32_bf16 v[212:215], a[52:55], v[56:59], v[212:215]
ds_read_b128 a[16:19], v1 offset:12288
v_exp_f32 v41, v41
v_mfma_f32_16x16x32_bf16 v[216:219], a[56:59], v[56:59], v[216:219]
ds_read_b128 a[20:23], v1 offset:13312
v_exp_f32 v42, v42
v_mfma_f32_16x16x32_bf16 v[248:251], a[56:59], v[60:63], v[248:251]
buffer_load_dwordx4 v13, s[72:75], s12 offen offset:3072 lds
v_mfma_f32_16x16x32_bf16 v[252:255], a[60:63], v[60:63], v[252:255]
ds_read_b128 a[24:27], v1 offset:14336
s_waitcnt lgkmcnt(3)
v_mfma_f32_16x16x32_bf16 v[220:223], a[60:63], v[56:59], v[220:223]
ds_read_b128 a[28:31], v1 offset:15360
v_add_u32 v12, 0x20000, v12
v_smfmac_f32_16x16x64_bf16 a[228:231], a[232:235], v[56:63], v9
s_add_u32 m0, s17, 0x14000
v_exp_f32 v43, v43
v_mfma_f32_16x16x32_bf16 v[24:27], a[0:3], a[192:195], v[112:115]
buffer_load_dwordx4 v12, s[72:75], 0 offen lds
v_mfma_f32_16x16x32_bf16 v[24:27], a[4:7], a[196:199], v[24:27]
ds_read_b128 a[32:35], v1 offset:0
v_cvt_pk_bf16_f32 v74, v40, v41
v_mfma_f32_16x16x32_bf16 v[24:27], a[8:11], a[200:203], v[24:27]
ds_read_b128 a[36:39], v1 offset:1024
v_exp_f32 v44, v44
v_mfma_f32_16x16x32_bf16 v[24:27], a[12:15], a[204:207], v[24:27]
ds_read_b128 a[40:43], v1 offset:2048
v_exp_f32 v45, v45
v_mfma_f32_16x16x32_bf16 v[28:31], a[0:3], a[208:211], v[92:95]
ds_read_b128 a[44:47], v1 offset:3072
v_exp_f32 v46, v46
v_mfma_f32_16x16x32_bf16 v[28:31], a[4:7], a[212:215], v[28:31]
s_waitcnt lgkmcnt(4)
v_exp_f32 v47, v47
v_mfma_f32_16x16x32_bf16 v[28:31], a[8:11], a[216:219], v[28:31]
ds_read_b128 a[48:51], v1 offset:4096
v_add_u32 v13, 0x20000, v13
v_mfma_f32_16x16x32_bf16 v[28:31], a[12:15], a[220:223], v[28:31]
buffer_load_dwordx4 v13, s[72:75], 0 offen offset:1024 lds
v_cvt_pk_bf16_f32 v75, v42, v43
v_mfma_f32_16x16x32_bf16 v[40:43], a[16:19], a[192:195], v[116:119]
ds_read_b128 a[52:55], v1 offset:5120
v_exp_f32 v24, v24
v_mfma_f32_16x16x32_bf16 v[40:43], a[20:23], a[196:199], v[40:43]
buffer_load_dwordx4 v12, s[72:75], s12 offen offset:2048 lds
v_mfma_f32_16x16x32_bf16 v[40:43], a[24:27], a[200:203], v[40:43]
ds_read_b128 a[56:59], v1 offset:6144
v_exp_f32 v25, v25
v_mfma_f32_16x16x32_bf16 v[40:43], a[28:31], a[204:207], v[40:43]
ds_read_b128 a[60:63], v1 offset:7168
v_cvt_pk_bf16_f32 v78, v44, v45
v_cvt_pk_bf16_f32 v79, v46, v47
v_mfma_f32_16x16x32_bf16 v[44:47], a[16:19], a[208:211], v[92:95]
buffer_load_dwordx4 v13, s[72:75], s12 offen offset:3072 lds
v_mfma_f32_16x16x32_bf16 v[44:47], a[20:23], a[212:215], v[44:47]
v_exp_f32 v26, v26
v_mfma_f32_16x16x32_bf16 v[44:47], a[24:27], a[216:219], v[44:47]
v_exp_f32 v27, v27
v_mfma_f32_16x16x32_bf16 v[44:47], a[28:31], a[220:223], v[44:47]
s_waitcnt lgkmcnt(0)
v_exp_f32 v28, v28
v_exp_f32 v29, v29
v_mfma_f32_16x16x32_bf16 v[192:195], a[32:35], v[72:75], v[192:195]
ds_read_b128 a[0:3], v1 offset:24576
v_cvt_pk_bf16_f32 v56, v24, v25
v_mfma_f32_16x16x32_bf16 v[224:227], a[32:35], v[76:79], v[224:227]
ds_read_b128 a[4:7], v1 offset:25600
v_add_u32 v12, 0x20000, v12
v_mfma_f32_16x16x32_bf16 v[228:231], a[36:39], v[76:79], v[228:231]
s_add_u32 m0, s16, 0x0
v_exp_f32 v30, v30
v_mfma_f32_16x16x32_bf16 v[196:199], a[36:39], v[72:75], v[196:199]
buffer_load_dwordx4 v12, s[72:75], 0 offen lds
v_mfma_f32_16x16x32_bf16 v[200:203], a[40:43], v[72:75], v[200:203]
ds_read_b128 a[8:11], v1 offset:26624
v_add_u32 v13, 0x20000, v13
v_mfma_f32_16x16x32_bf16 v[232:235], a[40:43], v[76:79], v[232:235]
buffer_load_dwordx4 v13, s[72:75], 0 offen offset:1024 lds
v_mfma_f32_16x16x32_bf16 v[236:239], a[44:47], v[76:79], v[236:239]
ds_read_b128 a[12:15], v1 offset:27648
v_cvt_pk_bf16_f32 v57, v26, v27
v_mfma_f32_16x16x32_bf16 v[204:207], a[44:47], v[72:75], v[204:207]
buffer_load_dwordx4 v12, s[72:75], s12 offen offset:2048 lds
v_mfma_f32_16x16x32_bf16 v[208:211], a[48:51], v[72:75], v[208:211]
ds_read_b128 a[16:19], v1 offset:28672
v_cvt_pk_bf16_f32 v60, v28, v29
v_mfma_f32_16x16x32_bf16 v[240:243], a[48:51], v[76:79], v[240:243]
buffer_load_dwordx4 v13, s[72:75], s12 offen offset:3072 lds
v_mfma_f32_16x16x32_bf16 v[244:247], a[52:55], v[76:79], v[244:247]
ds_read_b128 a[20:23], v1 offset:29696
v_exp_f32 v31, v31
v_mfma_f32_16x16x32_bf16 v[212:215], a[52:55], v[72:75], v[212:215]
ds_read_b128 a[24:27], v1 offset:30720
s_add_u32 m0, s16, 0x4000
v_mfma_f32_16x16x32_bf16 v[216:219], a[56:59], v[72:75], v[216:219]
ds_read_b128 a[28:31], v1 offset:31744
v_add_u32 v12, 0x20000, v12
v_mfma_f32_16x16x32_bf16 v[248:251], a[56:59], v[76:79], v[248:251]
buffer_load_dwordx4 v12, s[72:75], 0 offen lds
v_mfma_f32_16x16x32_bf16 v[252:255], a[60:63], v[76:79], v[252:255]
ds_read_b128 a[32:35], v1 offset:16384
s_waitcnt lgkmcnt(5)
v_mfma_f32_16x16x32_bf16 v[220:223], a[60:63], v[72:75], v[220:223]
ds_read_b128 a[36:39], v1 offset:17408
v_add_u32 v13, 0x20000, v13
v_smfmac_f32_16x16x64_bf16 a[228:231], a[232:235], v[72:79], v9
buffer_load_dwordx4 v13, s[72:75], 0 offen offset:1024 lds
v_cvt_pk_bf16_f32 v61, v30, v31
v_mfma_f32_16x16x32_bf16 v[28:31], a[0:3], a[208:211], v[92:95]
ds_read_b128 a[40:43], v1 offset:18432
v_exp_f32 v40, v40
v_mfma_f32_16x16x32_bf16 v[28:31], a[4:7], a[212:215], v[28:31]
buffer_load_dwordx4 v12, s[72:75], s12 offen offset:2048 lds
v_mfma_f32_16x16x32_bf16 v[28:31], a[8:11], a[216:219], v[28:31]
ds_read_b128 a[44:47], v1 offset:19456
v_exp_f32 v41, v41
v_mfma_f32_16x16x32_bf16 v[28:31], a[12:15], a[220:223], v[28:31]
ds_read_b128 a[48:51], v1 offset:20480
s_waitcnt lgkmcnt(5)
v_exp_f32 v42, v42
v_exp_f32 v43, v43
v_exp_f32 v44, v44
v_exp_f32 v45, v45
v_exp_f32 v46, v46
v_exp_f32 v47, v47
v_cvt_pk_bf16_f32 v62, v44, v45
v_cvt_pk_bf16_f32 v63, v46, v47
v_mfma_f32_16x16x32_bf16 v[44:47], a[16:19], a[208:211], v[92:95]
buffer_load_dwordx4 v13, s[72:75], s12 offen offset:3072 lds
v_mfma_f32_16x16x32_bf16 v[44:47], a[20:23], a[212:215], v[44:47]
ds_read_b128 a[52:55], v1 offset:21504
v_cvt_pk_bf16_f32 v58, v40, v41
v_mfma_f32_16x16x32_bf16 v[44:47], a[24:27], a[216:219], v[44:47]
ds_read_b128 a[56:59], v1 offset:22528
v_cvt_pk_bf16_f32 v59, v42, v43
v_mfma_f32_16x16x32_bf16 v[44:47], a[28:31], a[220:223], v[44:47]
ds_read_b128 a[60:63], v1 offset:23552
v_xor_b32 v1, 0x8000, v1
L_att_h1_0:
s_waitcnt vmcnt(16) lgkmcnt(0)
s_mov_b32 s92, 200000
L_spin_b0:
v_cmp_gt_u32 vcc, 32, v14
s_nop 4
s_cbranch_vccz L_spun_b0
s_sub_u32 s92, s92, 1
s_cbranch_scc1 L_spun_b0
s_sleep 6
buffer_load_dword v14, v15, s[84:87], 0 offen offset:192 sc1
s_waitcnt vmcnt(0)
s_branch L_spin_b0
L_spun_b0:
s_barrier
v_mfma_f32_16x16x32_bf16 v[192:195], a[32:35], v[56:59], v[192:195]
ds_read_b128 a[0:3], v2 offset:8192
v_exp_f32 v28, v28
v_mfma_f32_16x16x32_bf16 v[224:227], a[32:35], v[60:63], v[224:227]
ds_read_b128 a[4:7], v2 offset:9216
v_exp_f32 v29, v29
v_mfma_f32_16x16x32_bf16 v[228:231], a[36:39], v[60:63], v[228:231]
s_add_u32 s101, s101, 0x2000
v_exp_f32 v30, v30
v_mfma_f32_16x16x32_bf16 v[196:199], a[36:39], v[56:59], v[196:199]
buffer_load_dwordx4 a[64:67], v3, s[88:91], s101 offen sc1
v_mfma_f32_16x16x32_bf16 v[200:203], a[40:43], v[56:59], v[200:203]
ds_read_b128 a[8:11], v2 offset:10240
v_exp_f32 v31, v31
v_mfma_f32_16x16x32_bf16 v[232:235], a[40:43], v[60:63], v[232:235]
buffer_load_dwordx4 a[68:71], v3, s[88:91], s101 offen offset:1024 sc1
v_mfma_f32_16x16x32_bf16 v[236:239], a[44:47], v[60:63], v[236:239]
ds_read_b128 a[12:15], v2 offset:11264
s_add_u32 s101, s101, 0x2000
v_mfma_f32_16x16x32_bf16 v[204:207], a[44:47], v[56:59], v[204:207]
buffer_load_dwordx4 a[72:75], v3, s[88:91], s101 offen sc1
v_mfma_f32_16x16x32_bf16 v[208:211], a[48:51], v[56:59], v[208:211]
ds_read_b128 a[16:19], v2 offset:12288
v_cvt_pk_bf16_f32 v76, v28, v29
v_mfma_f32_16x16x32_bf16 v[240:243], a[48:51], v[60:63], v[240:243]
buffer_load_dwordx4 a[76:79], v3, s[88:91], s101 offen offset:1024 sc1
v_mfma_f32_16x16x32_bf16 v[244:247], a[52:55], v[60:63], v[244:247]
ds_read_b128 a[20:23], v2 offset:13312
v_exp_f32 v44, v44
v_mfma_f32_16x16x32_bf16 v[212:215], a[52:55], v[56:59], v[212:215]
ds_read_b128 a[24:27], v2 offset:14336
v_exp_f32 v45, v45
v_mfma_f32_16x16x32_bf16 v[216:219], a[56:59], v[56:59], v[216:219]
ds_read_b128 a[28:31], v2 offset:15360
s_add_u32 s101, s101, 0x2000
v_mfma_f32_16x16x32_bf16 v[248:251], a[56:59], v[60:63], v[248:251]
buffer_load_dwordx4 a[80:83], v3, s[88:91], s101 offen sc1
v_mfma_f32_16x16x32_bf16 v[252:255], a[60:63], v[60:63], v[252:255]
ds_read_b128 a[32:35], v2 offset:0
v_cvt_pk_bf16_f32 v77, v30, v31
v_mfma_f32_16x16x32_bf16 v[220:223], a[60:63], v[56:59], v[220:223]
ds_read_b128 a[36:39], v2 offset:1024
s_waitcnt lgkmcnt(6)
v_smfmac_f32_16x16x64_bf16 a[228:231], a[232:235], v[56:63], v9
buffer_load_dwordx4 a[84:87], v3, s[88:91], s101 offen offset:1024 sc1
v_mfma_f32_16x16x32_bf16 v[28:31], a[0:3], a[208:211], v[92:95]
ds_read_b128 a[40:43], v2 offset:2048
v_exp_f32 v46, v46
v_mfma_f32_16x16x32_bf16 v[28:31], a[4:7], a[212:215], v[28:31]
ds_read_b128 a[44:47], v2 offset:3072
s_add_u32 s101, s101, 0x2000
v_mfma_f32_16x16x32_bf16 v[28:31], a[8:11], a[216:219], v[28:31]
buffer_load_dwordx4 a[88:91], v3, s[88:91], s101 offen sc1
v_mfma_f32_16x16x32_bf16 v[28:31], a[12:15], a[220:223], v[28:31]
ds_read_b128 a[48:51], v2 offset:4096
s_waitcnt lgkmcnt(5)
v_exp_f32 v47, v47
v_cvt_pk_bf16_f32 v78, v44, v45
v_cvt_pk_bf16_f32 v79, v46, v47
v_mfma_f32_16x16x32_bf16 v[44:47], a[16:19], a[208:211], v[92:95]
ds_read_b128 a[52:55], v2 offset:5120
v_mfma_f32_16x16x32_bf16 v[44:47], a[20:23], a[212:215], v[44:47]
buffer_load_dwordx4 a[92:95], v3, s[88:91], s101 offen offset:1024 sc1
v_mfma_f32_16x16x32_bf16 v[44:47], a[24:27], a[216:219], v[44:47]
ds_read_b128 a[56:59], v2 offset:6144
v_mfma_f32_16x16x32_bf16 v[44:47], a[28:31], a[220:223], v[44:47]
ds_read_b128 a[60:63], v2 offset:7168
s_waitcnt lgkmcnt(0)
v_mfma_f32_16x16x32_bf16 v[224:227], a[32:35], v[76:79], v[224:227]
ds_read_b128 a[0:3], v2 offset:24576
s_add_u32 s101, s101, 0x2000
v_mfma_f32_16x16x32_bf16 v[228:231], a[36:39], v[76:79], v[228:231]
buffer_load_dwordx4 a[96:99], v3, s[88:91], s101 offen sc1
v_mfma_f32_16x16x32_bf16 v[232:235], a[40:43], v[76:79], v[232:235]
ds_read_b128 a[4:7], v2 offset:25600
v_exp_f32 v28, v28
v_mfma_f32_16x16x32_bf16 v[236:239], a[44:47], v[76:79], v[236:239]
buffer_load_dwordx4 a[100:103], v3, s[88:91], s101 offen offset:1024 sc1
v_mfma_f32_16x16x32_bf16 v[240:243], a[48:51], v[76:79], v[240:243]
ds_read_b128 a[8:11], v2 offset:26624
s_add_u32 s101, s101, 0x2000
v_mfma_f32_16x16x32_bf16 v[244:247], a[52:55], v[76:79], v[244:247]
buffer_load_dwordx4 a[104:107], v3, s[88:91], s101 offen sc1
v_mfma_f32_16x16x32_bf16 v[248:251], a[56:59], v[76:79], v[248:251]
ds_read_b128 a[12:15], v2 offset:27648
s_waitcnt lgkmcnt(0)
v_mfma_f32_16x16x32_bf16 v[252:255], a[60:63], v[76:79], v[252:255]
buffer_load_dwordx4 a[108:111], v3, s[88:91], s101 offen offset:1024 sc1
ds_read_b128 a[16:19], v2 offset:28672
v_mfma_f32_16x16x32_bf16 a[228:231], a[236:239], v[76:79], a[228:231]
ds_read_b128 a[20:23], v2 offset:29696
s_add_u32 s101, s101, 0x2000
v_exp_f32 v29, v29
v_exp_f32 v30, v30
v_exp_f32 v31, v31
v_cvt_pk_bf16_f32 v60, v28, v29
v_cvt_pk_bf16_f32 v61, v30, v31
v_mfma_f32_16x16x32_bf16 v[28:31], a[0:3], a[208:211], v[120:123]
buffer_load_dwordx4 a[112:115], v3, s[88:91], s101 offen sc1
ds_read_b128 a[24:27], v2 offset:30720
v_mfma_f32_16x16x32_bf16 v[28:31], a[4:7], a[212:215], v[28:31]
ds_read_b128 a[28:31], v2 offset:31744
s_waitcnt lgkmcnt(0)
v_mfma_f32_16x16x32_bf16 v[28:31], a[8:11], a[216:219], v[28:31]
buffer_load_dwordx4 a[116:119], v3, s[88:91], s101 offen offset:1024 sc1
v_mfma_f32_16x16x32_bf16 v[28:31], a[12:15], a[220:223], v[28:31]
ds_read_b128 a[32:35], v2 offset:16384
s_add_u32 s101, s101, 0x2000
v_exp_f32 v44, v44
v_exp_f32 v45, v45
v_exp_f32 v46, v46
v_exp_f32 v47, v47
v_cvt_pk_bf16_f32 v62, v44, v45
v_cvt_pk_bf16_f32 v63, v46, v47
v_mfma_f32_16x16x32_bf16 v[44:47], a[16:19], a[208:211], v[124:127]
buffer_load_dwordx4 a[120:123], v3, s[88:91], s101 offen sc1
v_mfma_f32_16x16x32_bf16 v[44:47], a[20:23], a[212:215], v[44:47]
buffer_load_dwordx4 a[124:127], v3, s[88:91], s101 offen offset:1024 sc1
v_mfma_f32_16x16x32_bf16 v[44:47], a[24:27], a[216:219], v[44:47]
ds_read_b128 a[36:39], v2 offset:17408
v_mfma_f32_16x16x32_bf16 v[44:47], a[28:31], a[220:223], v[44:47]
ds_read_b128 a[40:43], v2 offset:18432
ds_read_b128 a[44:47], v2 offset:19456
ds_read_b128 a[48:51], v2 offset:20480
ds_read_b128 a[52:55], v2 offset:21504
ds_read_b128 a[56:59], v2 offset:22528
ds_read_b128 a[60:63], v2 offset:23552
v_xor_b32 v2, 0x38000, v2
s_waitcnt lgkmcnt(0)
s_barrier
v_accvgpr_read_b32 v6, a228
v_accvgpr_read_b32 v7, a229
v_add_f32 v6, v6, v7
v_cmp_nge_f32 vcc, 0x6f800000, v6
v_rcp_f32 v6, v6
s_or_b64 s[34:35], s[34:35], vcc
v_mfma_f32_16x16x32_bf16 v[224:227], a[32:35], v[60:63], v[224:227]
ds_read_b128 a[32:35], v1 offset:0
v_exp_f32 v28, v28
v_mfma_f32_16x16x32_bf16 v[228:231], a[36:39], v[60:63], v[228:231]
ds_read_b128 a[36:39], v1 offset:1024
v_exp_f32 v29, v29
v_mfma_f32_16x16x32_bf16 v[232:235], a[40:43], v[60:63], v[232:235]
ds_read_b128 a[40:43], v1 offset:2048
v_exp_f32 v30, v30
v_mfma_f32_16x16x32_bf16 v[236:239], a[44:47], v[60:63], v[236:239]
ds_read_b128 a[44:47], v1 offset:3072
v_exp_f32 v31, v31
v_mfma_f32_16x16x32_bf16 v[240:243], a[48:51], v[60:63], v[240:243]
ds_read_b128 a[48:51], v1 offset:4096
v_exp_f32 v44, v44
v_mfma_f32_16x16x32_bf16 v[244:247], a[52:55], v[60:63], v[244:247]
ds_read_b128 a[52:55], v1 offset:5120
v_exp_f32 v45, v45
v_mfma_f32_16x16x32_bf16 v[248:251], a[56:59], v[60:63], v[248:251]
ds_read_b128 a[56:59], v1 offset:6144
v_exp_f32 v46, v46
v_mfma_f32_16x16x32_bf16 v[252:255], a[60:63], v[60:63], v[252:255]
ds_read_b128 a[60:63], v1 offset:7168
v_exp_f32 v47, v47
v_mfma_f32_16x16x32_bf16 a[228:231], a[236:239], v[60:63], a[228:231]
v_cvt_pk_bf16_f32 v76, v28, v29
v_cvt_pk_bf16_f32 v77, v30, v31
v_cvt_pk_bf16_f32 v78, v44, v45
v_cvt_pk_bf16_f32 v79, v46, v47
s_add_u32 s8, s30, 0x0
v_pk_mul_f32 v[192:193], v[192:193], v[6:7] op_sel_hi:[1,0]
v_pk_mul_f32 v[194:195], v[194:195], v[6:7] op_sel_hi:[1,0]
v_pk_mul_f32 v[196:197], v[196:197], v[6:7] op_sel_hi:[1,0]
v_pk_mul_f32 v[198:199], v[198:199], v[6:7] op_sel_hi:[1,0]
v_cvt_pk_bf16_f32 v192, v192, v193
v_cvt_pk_bf16_f32 v193, v194, v195
v_cvt_pk_bf16_f32 v194, v196, v197
v_cvt_pk_bf16_f32 v195, v198, v199
buffer_store_dwordx4 v[192:195], v3, s[88:91], s8 offen sc1
s_add_u32 s8, s30, 0x2000
v_pk_mul_f32 v[200:201], v[200:201], v[6:7] op_sel_hi:[1,0]
v_pk_mul_f32 v[202:203], v[202:203], v[6:7] op_sel_hi:[1,0]
v_pk_mul_f32 v[204:205], v[204:205], v[6:7] op_sel_hi:[1,0]
v_pk_mul_f32 v[206:207], v[206:207], v[6:7] op_sel_hi:[1,0]
v_cvt_pk_bf16_f32 v200, v200, v201
v_cvt_pk_bf16_f32 v201, v202, v203
v_cvt_pk_bf16_f32 v202, v204, v205
v_cvt_pk_bf16_f32 v203, v206, v207
buffer_store_dwordx4 v[200:203], v3, s[88:91], s8 offen sc1
s_waitcnt lgkmcnt(0)
v_mfma_f32_16x16x32_bf16 v[224:227], a[32:35], v[76:79], v[224:227]
s_add_u32 s8, s30, 0x4000
v_mul_f32 v208, v6, v208
v_mfma_f32_16x16x32_bf16 v[228:231], a[36:39], v[76:79], v[228:231]
v_mul_f32 v209, v6, v209
v_mul_f32 v210, v6, v210
v_mfma_f32_16x16x32_bf16 v[232:235], a[40:43], v[76:79], v[232:235]
v_mul_f32 v211, v6, v211
v_mul_f32 v212, v6, v212
v_mfma_f32_16x16x32_bf16 v[236:239], a[44:47], v[76:79], v[236:239]
v_mul_f32 v213, v6, v213
v_mul_f32 v214, v6, v214
v_mfma_f32_16x16x32_bf16 v[240:243], a[48:51], v[76:79], v[240:243]
v_mul_f32 v215, v6, v215
v_cvt_pk_bf16_f32 v208, v208, v209
v_mfma_f32_16x16x32_bf16 v[244:247], a[52:55], v[76:79], v[244:247]
v_cvt_pk_bf16_f32 v209, v210, v211
v_cvt_pk_bf16_f32 v210, v212, v213
v_mfma_f32_16x16x32_bf16 v[248:251], a[56:59], v[76:79], v[248:251]
v_cvt_pk_bf16_f32 v211, v214, v215
buffer_store_dwordx4 v[208:211], v3, s[88:91], s8 offen sc1
v_mfma_f32_16x16x32_bf16 v[252:255], a[60:63], v[76:79], v[252:255]
s_add_u32 s8, s30, 0x6000
v_mul_f32 v216, v6, v216
v_mfma_f32_16x16x32_bf16 a[228:231], a[236:239], v[76:79], a[228:231]
v_mul_f32 v217, v6, v217
v_mul_f32 v218, v6, v218
v_mul_f32 v219, v6, v219
v_mul_f32 v220, v6, v220
v_mul_f32 v221, v6, v221
v_mul_f32 v222, v6, v222
v_mul_f32 v223, v6, v223
v_cvt_pk_bf16_f32 v216, v216, v217
v_cvt_pk_bf16_f32 v217, v218, v219
v_cvt_pk_bf16_f32 v218, v220, v221
v_cvt_pk_bf16_f32 v219, v222, v223
buffer_store_dwordx4 v[216:219], v3, s[88:91], s8 offen sc1
s_branch L_att_fin
L_att_sh0_1:
v_mfma_f32_16x16x32_bf16 v[192:195], a[32:35], v[56:59], v[192:195]
v_exp_f32 v30, v30
v_mfma_f32_16x16x32_bf16 v[224:227], a[32:35], v[60:63], v[224:227]
buffer_load_dword v14, v15, s[84:87], 0 offen offset:192 sc1
v_mfma_f32_16x16x32_bf16 v[228:231], a[36:39], v[60:63], v[228:231]
v_exp_f32 v31, v31
v_mfma_f32_16x16x32_bf16 v[196:199], a[36:39], v[56:59], v[196:199]
s_add_u32 m0, s17, 0x10000
v_exp_f32 v40, v40
v_mfma_f32_16x16x32_bf16 v[200:203], a[40:43], v[56:59], v[200:203]
ds_read_b128 a[0:3], v1 offset:8192
v_cvt_pk_bf16_f32 v72, v24, v25
v_mfma_f32_16x16x32_bf16 v[232:235], a[40:43], v[60:63], v[232:235]
ds_read_b128 a[4:7], v1 offset:9216
v_cvt_pk_bf16_f32 v73, v26, v27
v_mfma_f32_16x16x32_bf16 v[236:239], a[44:47], v[60:63], v[236:239]
buffer_load_dwordx4 v12, s[72:75], 0 offen lds
v_mfma_f32_16x16x32_bf16 v[204:207], a[44:47], v[56:59], v[204:207]
ds_read_b128 a[8:11], v1 offset:10240
v_cvt_pk_bf16_f32 v76, v28, v29
v_mfma_f32_16x16x32_bf16 v[208:211], a[48:51], v[56:59], v[208:211]
buffer_load_dwordx4 v13, s[72:75], 0 offen offset:1024 lds
v_mfma_f32_16x16x32_bf16 v[240:243], a[48:51], v[60:63], v[240:243]
ds_read_b128 a[12:15], v1 offset:11264
v_cvt_pk_bf16_f32 v77, v30, v31
v_mfma_f32_16x16x32_bf16 v[244:247], a[52:55], v[60:63], v[244:247]
buffer_load_dwordx4 v12, s[72:75], s12 offen offset:2048 lds
v_mfma_f32_16x16x32_bf16 v[212:215], a[52:55], v[56:59], v[212:215]
ds_read_b128 a[16:19], v1 offset:12288
v_exp_f32 v41, v41
v_mfma_f32_16x16x32_bf16 v[216:219], a[56:59], v[56:59], v[216:219]
ds_read_b128 a[20:23], v1 offset:13312
v_exp_f32 v42, v42
v_mfma_f32_16x16x32_bf16 v[248:251], a[56:59], v[60:63], v[248:251]
buffer_load_dwordx4 v13, s[72:75], s12 offen offset:3072 lds
v_mfma_f32_16x16x32_bf16 v[252:255], a[60:63], v[60:63], v[252:255]
ds_read_b128 a[24:27], v1 offset:14336
s_waitcnt lgkmcnt(3)
v_mfma_f32_16x16x32_bf16 v[220:223], a[60:63], v[56:59], v[220:223]
ds_read_b128 a[28:31], v1 offset:15360
v_add_u32 v12, 0x20000, v12
v_smfmac_f32_16x16x64_bf16 a[228:231], a[232:235], v[56:63], v9
s_add_u32 m0, s17, 0x14000
v_exp_f32 v43, v43
v_mfma_f32_16x16x32_bf16 v[24:27], a[0:3], a[192:195], v[88:91]
buffer_load_dwordx4 v12, s[72:75], 0 offen lds
v_mfma_f32_16x16x32_bf16 v[24:27], a[4:7], a[196:199], v[24:27]
ds_read_b128 a[32:35], v1 offset:0
v_cvt_pk_bf16_f32 v74, v40, v41
v_mfma_f32_16x16x32_bf16 v[24:27], a[8:11], a[200:203], v[24:27]
ds_read_b128 a[36:39], v1 offset:1024
v_exp_f32 v44, v44
v_mfma_f32_16x16x32_bf16 v[24:27], a[12:15], a[204:207], v[24:27]
ds_read_b128 a[40:43], v1 offset:2048
v_exp_f32 v45, v45
v_mfma_f32_16x16x32_bf16 v[28:31], a[0:3], a[208:211], v[92:95]
ds_read_b128 a[44:47], v1 offset:3072
v_exp_f32 v46, v46
v_mfma_f32_16x16x32_bf16 v[28:31], a[4:7], a[212:215], v[28:31]
s_waitcnt lgkmcnt(4)
v_exp_f32 v47, v47
v_mfma_f32_16x16x32_bf16 v[28:31], a[8:11], a[216:219], v[28:31]
ds_read_b128 a[48:51], v1 offset:4096
v_add_u32 v13, 0x20000, v13
v_mfma_f32_16x16x32_bf16 v[28:31], a[12:15], a[220:223], v[28:31]
buffer_load_dwordx4 v13, s[72:75], 0 offen offset:1024 lds
v_cvt_pk_bf16_f32 v75, v42, v43
v_mfma_f32_16x16x32_bf16 v[40:43], a[16:19], a[192:195], v[88:91]
ds_read_b128 a[52:55], v1 offset:5120
v_exp_f32 v24, v24
v_mfma_f32_16x16x32_bf16 v[40:43], a[20:23], a[196:199], v[40:43]
buffer_load_dwordx4 v12, s[72:75], s12 offen offset:2048 lds
v_mfma_f32_16x16x32_bf16 v[40:43], a[24:27], a[200:203], v[40:43]
ds_read_b128 a[56:59], v1 offset:6144
v_exp_f32 v25, v25
v_mfma_f32_16x16x32_bf16 v[40:43], a[28:31], a[204:207], v[40:43]
ds_read_b128 a[60:63], v1 offset:7168
v_cvt_pk_bf16_f32 v78, v44, v45
v_cvt_pk_bf16_f32 v79, v46, v47
v_mfma_f32_16x16x32_bf16 v[44:47], a[16:19], a[208:211], v[92:95]
buffer_load_dwordx4 v13, s[72:75], s12 offen offset:3072 lds
v_mfma_f32_16x16x32_bf16 v[44:47], a[20:23], a[212:215], v[44:47]
v_exp_f32 v26, v26
v_mfma_f32_16x16x32_bf16 v[44:47], a[24:27], a[216:219], v[44:47]
v_exp_f32 v27, v27
v_mfma_f32_16x16x32_bf16 v[44:47], a[28:31], a[220:223], v[44:47]
s_waitcnt lgkmcnt(0)
v_exp_f32 v28, v28
v_exp_f32 v29, v29
v_mfma_f32_16x16x32_bf16 v[192:195], a[32:35], v[72:75], v[192:195]
s_add_u32 m0, s16, 0x0
v_add_u32 v12, 0x20000, v12
v_cvt_pk_bf16_f32 v56, v24, v25
v_mfma_f32_16x16x32_bf16 v[224:227], a[32:35], v[76:79], v[224:227]
buffer_load_dwordx4 v12, s[72:75], 0 offen lds
v_mfma_f32_16x16x32_bf16 v[228:231], a[36:39], v[76:79], v[228:231]
ds_read_b128 a[0:3], v1 offset:24576
v_cvt_pk_bf16_f32 v57, v26, v27
v_mfma_f32_16x16x32_bf16 v[196:199], a[36:39], v[72:75], v[196:199]
v_exp_f32 v30, v30
v_mfma_f32_16x16x32_bf16 v[200:203], a[40:43], v[72:75], v[200:203]
ds_read_b128 a[4:7], v1 offset:25600
v_cvt_pk_bf16_f32 v60, v28, v29
v_mfma_f32_16x16x32_bf16 v[232:235], a[40:43], v[76:79], v[232:235]
ds_read_b128 a[8:11], v1 offset:26624
v_add_u32 v13, 0x20000, v13
v_mfma_f32_16x16x32_bf16 v[236:239], a[44:47], v[76:79], v[236:239]
buffer_load_dwordx4 v13, s[72:75], 0 offen offset:1024 lds
v_mfma_f32_16x16x32_bf16 v[204:207], a[44:47], v[72:75], v[204:207]
ds_read_b128 a[12:15], v1 offset:27648
v_exp_f32 v31, v31
v_mfma_f32_16x16x32_bf16 v[208:211], a[48:51], v[72:75], v[208:211]
buffer_load_dwordx4 v12, s[72:75], s12 offen offset:2048 lds
v_mfma_f32_16x16x32_bf16 v[240:243], a[48:51], v[76:79], v[240:243]
ds_read_b128 a[16:19], v1 offset:28672
v_exp_f32 v40, v40
v_mfma_f32_16x16x32_bf16 v[244:247], a[52:55], v[76:79], v[244:247]
ds_read_b128 a[20:23], v1 offset:29696
v_cvt_pk_bf16_f32 v61, v30, v31
v_mfma_f32_16x16x32_bf16 v[212:215], a[52:55], v[72:75], v[212:215]
buffer_load_dwordx4 v13, s[72:75], s12 offen offset:3072 lds
v_mfma_f32_16x16x32_bf16 v[216:219], a[56:59], v[72:75], v[216:219]
ds_read_b128 a[24:27], v1 offset:30720
v_exp_f32 v41, v41
v_mfma_f32_16x16x32_bf16 v[248:251], a[56:59], v[76:79], v[248:251]
ds_read_b128 a[28:31], v1 offset:31744
v_exp_f32 v42, v42
v_mfma_f32_16x16x32_bf16 v[252:255], a[60:63], v[76:79], v[252:255]
ds_read_b128 a[32:35], v1 offset:16384
v_cvt_pk_bf16_f32 v58, v40, v41
v_mfma_f32_16x16x32_bf16 v[220:223], a[60:63], v[72:75], v[220:223]
s_waitcnt lgkmcnt(5)
v_exp_f32 v43, v43
v_smfmac_f32_16x16x64_bf16 a[228:231], a[232:235], v[72:79], v9
ds_read_b128 a[36:39], v1 offset:17408
v_add_u32 v12, 0x20000, v12
v_mfma_f32_16x16x32_bf16 v[24:27], a[0:3], a[192:195], v[112:115]
s_add_u32 m0, s16, 0x4000
v_exp_f32 v44, v44
v_mfma_f32_16x16x32_bf16 v[24:27], a[4:7], a[196:199], v[24:27]
buffer_load_dwordx4 v12, s[72:75], 0 offen lds
v_mfma_f32_16x16x32_bf16 v[24:27], a[8:11], a[200:203], v[24:27]
ds_read_b128 a[40:43], v1 offset:18432
v_add_u32 v13, 0x20000, v13
v_mfma_f32_16x16x32_bf16 v[24:27], a[12:15], a[204:207], v[24:27]
buffer_load_dwordx4 v13, s[72:75], 0 offen offset:1024 lds
v_mfma_f32_16x16x32_bf16 v[28:31], a[0:3], a[208:211], v[92:95]
ds_read_b128 a[44:47], v1 offset:19456
v_cvt_pk_bf16_f32 v59, v42, v43
v_mfma_f32_16x16x32_bf16 v[28:31], a[4:7], a[212:215], v[28:31]
ds_read_b128 a[48:51], v1 offset:20480
v_exp_f32 v45, v45
v_mfma_f32_16x16x32_bf16 v[28:31], a[8:11], a[216:219], v[28:31]
s_waitcnt lgkmcnt(5)
v_exp_f32 v46, v46
v_mfma_f32_16x16x32_bf16 v[28:31], a[12:15], a[220:223], v[28:31]
buffer_load_dwordx4 v12, s[72:75], s12 offen offset:2048 lds
v_mfma_f32_16x16x32_bf16 v[40:43], a[16:19], a[192:195], v[116:119]
ds_read_b128 a[52:55], v1 offset:21504
v_exp_f32 v47, v47
v_mfma_f32_16x16x32_bf16 v[40:43], a[20:23], a[196:199], v[40:43]
ds_read_b128 a[56:59], v1 offset:22528
v_exp_f32 v24, v24
v_mfma_f32_16x16x32_bf16 v[40:43], a[24:27], a[200:203], v[40:43]
ds_read_b128 a[60:63], v1 offset:23552
v_xor_b32 v1, 0x8000, v1
v_mfma_f32_16x16x32_bf16 v[40:43], a[28:31], a[204:207], v[40:43]
v_exp_f32 v25, v25
v_cvt_pk_bf16_f32 v62, v44, v45
v_cvt_pk_bf16_f32 v63, v46, v47
v_mfma_f32_16x16x32_bf16 v[44:47], a[16:19], a[208:211], v[92:95]
v_exp_f32 v26, v26
v_mfma_f32_16x16x32_bf16 v[44:47], a[20:23], a[212:215], v[44:47]
buffer_load_dwordx4 v13, s[72:75], s12 offen offset:3072 lds
v_mfma_f32_16x16x32_bf16 v[44:47], a[24:27], a[216:219], v[44:47]
v_exp_f32 v27, v27
v_mfma_f32_16x16x32_bf16 v[44:47], a[28:31], a[220:223], v[44:47]
v_exp_f32 v28, v28
v_exp_f32 v29, v29
L_att_h1_1:
s_waitcnt vmcnt(16) lgkmcnt(0)
s_mov_b32 s92, 200000
L_spin_b1:
v_cmp_gt_u32 vcc, 32, v14
s_nop 4
s_cbranch_vccz L_spun_b1
s_sub_u32 s92, s92, 1
s_cbranch_scc1 L_spun_b1
s_sleep 6
buffer_load_dword v14, v15, s[84:87], 0 offen offset:192 sc1
s_waitcnt vmcnt(0)
s_branch L_spin_b1
L_spun_b1:
s_barrier
v_mfma_f32_16x16x32_bf16 v[192:195], a[32:35], v[56:59], v[192:195]
ds_read_b128 a[0:3], v2 offset:8192
v_cvt_pk_bf16_f32 v72, v24, v25
v_mfma_f32_16x16x32_bf16 v[224:227], a[32:35], v[60:63], v[224:227]
ds_read_b128 a[4:7], v2 offset:9216
v_cvt_pk_bf16_f32 v73, v26, v27
v_mfma_f32_16x16x32_bf16 v[228:231], a[36:39], v[60:63], v[228:231]
s_add_u32 s101, s101, 0x2000
v_exp_f32 v30, v30
v_mfma_f32_16x16x32_bf16 v[196:199], a[36:39], v[56:59], v[196:199]
buffer_load_dwordx4 a[64:67], v3, s[88:91], s101 offen sc1
v_mfma_f32_16x16x32_bf16 v[200:203], a[40:43], v[56:59], v[200:203]
ds_read_b128 a[8:11], v2 offset:10240
v_cvt_pk_bf16_f32 v76, v28, v29
v_mfma_f32_16x16x32_bf16 v[232:235], a[40:43], v[60:63], v[232:235]
buffer_load_dwordx4 a[68:71], v3, s[88:91], s101 offen offset:1024 sc1
v_mfma_f32_16x16x32_bf16 v[236:239], a[44:47], v[60:63], v[236:239]
ds_read_b128 a[12:15], v2 offset:11264
s_add_u32 s101, s101, 0x2000
v_mfma_f32_16x16x32_bf16 v[204:207], a[44:47], v[56:59], v[204:207]
buffer_load_dwordx4 a[72:75], v3, s[88:91], s101 offen sc1
v_mfma_f32_16x16x32_bf16 v[208:211], a[48:51], v[56:59], v[208:211]
ds_read_b128 a[16:19], v2 offset:12288
v_exp_f32 v31, v31
v_mfma_f32_16x16x32_bf16 v[240:243], a[48:51], v[60:63], v[240:243]
buffer_load_dwordx4 a[76:79], v3, s[88:91], s101 offen offset:1024 sc1
v_mfma_f32_16x16x32_bf16 v[244:247], a[52:55], v[60:63], v[244:247]
ds_read_b128 a[20:23], v2 offset:13312
v_exp_f32 v40, v40
v_mfma_f32_16x16x32_bf16 v[212:215], a[52:55], v[56:59], v[212:215]
ds_read_b128 a[24:27], v2 offset:14336
v_exp_f32 v41, v41
v_mfma_f32_16x16x32_bf16 v[216:219], a[56:59], v[56:59], v[216:219]
ds_read_b128 a[28:31], v2 offset:15360
s_add_u32 s101, s101, 0x2000
v_mfma_f32_16x16x32_bf16 v[248:251], a[56:59], v[60:63], v[248:251]
buffer_load_dwordx4 a[80:83], v3, s[88:91], s101 offen sc1
v_mfma_f32_16x16x32_bf16 v[252:255], a[60:63], v[60:63], v[252:255]
ds_read_b128 a[32:35], v2 offset:0
v_cvt_pk_bf16_f32 v77, v30, v31
v_mfma_f32_16x16x32_bf16 v[220:223], a[60:63], v[56:59], v[220:223]
ds_read_b128 a[36:39], v2 offset:1024
s_waitcnt lgkmcnt(6)
v_smfmac_f32_16x16x64_bf16 a[228:231], a[232:235], v[56:63], v9
buffer_load_dwordx4 a[84:87], v3, s[88:91], s101 offen offset:1024 sc1
v_mfma_f32_16x16x32_bf16 v[28:31], a[0:3], a[208:211], v[120:123]
ds_read_b128 a[40:43], v2 offset:2048
v_exp_f32 v42, v42
v_mfma_f32_16x16x32_bf16 v[28:31], a[4:7], a[212:215], v[28:31]
ds_read_b128 a[44:47], v2 offset:3072
s_add_u32 s101, s101, 0x2000
v_mfma_f32_16x16x32_bf16 v[28:31], a[8:11], a[216:219], v[28:31]
buffer_load_dwordx4 a[88:91], v3, s[88:91], s101 offen sc1
v_mfma_f32_16x16x32_bf16 v[28:31], a[12:15], a[220:223], v[28:31]
ds_read_b128 a[48:51], v2 offset:4096
s_waitcnt lgkmcnt(5)
v_exp_f32 v43, v43
v_exp_f32 v44, v44
v_exp_f32 v45, v45
v_exp_f32 v46, v46
v_exp_f32 v47, v47
v_cvt_pk_bf16_f32 v78, v44, v45
v_cvt_pk_bf16_f32 v79, v46, v47
v_mfma_f32_16x16x32_bf16 v[44:47], a[16:19], a[208:211], v[124:127]
ds_read_b128 a[52:55], v2 offset:5120
v_cvt_pk_bf16_f32 v74, v40, v41
v_mfma_f32_16x16x32_bf16 v[44:47], a[20:23], a[212:215], v[44:47]
buffer_load_dwordx4 a[92:95], v3, s[88:91], s101 offen offset:1024 sc1
v_mfma_f32_16x16x32_bf16 v[44:47], a[24:27], a[216:219], v[44:47]
ds_read_b128 a[56:59], v2 offset:6144
v_cvt_pk_bf16_f32 v75, v42, v43
v_mfma_f32_16x16x32_bf16 v[44:47], a[28:31], a[220:223], v[44:47]
ds_read_b128 a[60:63], v2 offset:7168
s_waitcnt lgkmcnt(0)
v_mfma_f32_16x16x32_bf16 v[192:195], a[32:35], v[72:75], v[192:195]
s_add_u32 s101, s101, 0x2000
v_exp_f32 v28, v28
v_mfma_f32_16x16x32_bf16 v[224:227], a[32:35], v[76:79], v[224:227]
buffer_load_dwordx4 a[96:99], v3, s[88:91], s101 offen sc1
v_mfma_f32_16x16x32_bf16 v[228:231], a[36:39], v[76:79], v[228:231]
ds_read_b128 a[32:35], v2 offset:16384
v_exp_f32 v29, v29
v_mfma_f32_16x16x32_bf16 v[196:199], a[36:39], v[72:75], v[196:199]
buffer_load_dwordx4 a[100:103], v3, s[88:91], s101 offen offset:1024 sc1
v_mfma_f32_16x16x32_bf16 v[200:203], a[40:43], v[72:75], v[200:203]
ds_read_b128 a[36:39], v2 offset:17408
s_add_u32 s101, s101, 0x2000
v_mfma_f32_16x16x32_bf16 v[232:235], a[40:43], v[76:79], v[232:235]
buffer_load_dwordx4 a[104:107], v3, s[88:91], s101 offen sc1
v_mfma_f32_16x16x32_bf16 v[236:239], a[44:47], v[76:79], v[236:239]
ds_read_b128 a[40:43], v2 offset:18432
v_exp_f32 v30, v30
v_mfma_f32_16x16x32_bf16 v[204:207], a[44:47], v[72:75], v[204:207]
buffer_load_dwordx4 a[108:111], v3, s[88:91], s101 offen offset:1024 sc1
v_mfma_f32_16x16x32_bf16 v[208:211], a[48:51], v[72:75], v[208:211]
ds_read_b128 a[44:47], v2 offset:19456
s_add_u32 s101, s101, 0x2000
v_mfma_f32_16x16x32_bf16 v[240:243], a[48:51], v[76:79], v[240:243]
buffer_load_dwordx4 a[112:115], v3, s[88:91], s101 offen sc1
v_mfma_f32_16x16x32_bf16 v[244:247], a[52:55], v[76:79], v[244:247]
ds_read_b128 a[48:51], v2 offset:20480
v_exp_f32 v31, v31
v_mfma_f32_16x16x32_bf16 v[212:215], a[52:55], v[72:75], v[212:215]
buffer_load_dwordx4 a[116:119], v3, s[88:91], s101 offen offset:1024 sc1
v_mfma_f32_16x16x32_bf16 v[216:219], a[56:59], v[72:75], v[216:219]
ds_read_b128 a[52:55], v2 offset:21504
s_add_u32 s101, s101, 0x2000
v_mfma_f32_16x16x32_bf16 v[248:251], a[56:59], v[76:79], v[248:251]
buffer_load_dwordx4 a[120:123], v3, s[88:91], s101 offen sc1
v_mfma_f32_16x16x32_bf16 v[252:255], a[60:63], v[76:79], v[252:255]
buffer_load_dwordx4 a[124:127], v3, s[88:91], s101 offen offset:1024 sc1
v_mfma_f32_16x16x32_bf16 v[220:223], a[60:63], v[72:75], v[220:223]
ds_read_b128 a[56:59], v2 offset:22528
v_cvt_pk_bf16_f32 v60, v28, v29
v_smfmac_f32_16x16x64_bf16 a[228:231], a[232:235], v[72:79], v9
ds_read_b128 a[60:63], v2 offset:23552
v_xor_b32 v2, 0x38000, v2
v_exp_f32 v44, v44
v_exp_f32 v45, v45
v_exp_f32 v46, v46
v_exp_f32 v47, v47
v_cvt_pk_bf16_f32 v61, v30, v31
v_cvt_pk_bf16_f32 v62, v44, v45
v_cvt_pk_bf16_f32 v63, v46, v47
s_waitcnt lgkmcnt(0)
s_barrier
v_accvgpr_read_b32 v6, a228
v_accvgpr_read_b32 v7, a229
v_add_f32 v6, v6, v7
v_cmp_nge_f32 vcc, 0x6f800000, v6
v_rcp_f32 v6, v6
s_or_b64 s[34:35], s[34:35], vcc
v_mfma_f32_16x16x32_bf16 v[224:227], a[32:35], v[60:63], v[224:227]
s_add_u32 s8, s30, 0x0
v_mul_f32 v192, v6, v192
v_mfma_f32_16x16x32_bf16 v[228:231], a[36:39], v[60:63], v[228:231]
v_mul_f32 v193, v6, v193
v_mul_f32 v194, v6, v194
v_mfma_f32_16x16x32_bf16 v[232:235], a[40:43], v[60:63], v[232:235]
v_mul_f32 v195, v6, v195
v_mul_f32 v196, v6, v196
v_mfma_f32_16x16x32_bf16 v[236:239], a[44:47], v[60:63], v[236:239]
v_mul_f32 v197, v6, v197
v_mul_f32 v198, v6, v198
v_mfma_f32_16x16x32_bf16 v[240:243], a[48:51], v[60:63], v[240:243]
v_mul_f32 v199, v6, v199
v_cvt_pk_bf16_f32 v192, v192, v193
v_mfma_f32_16x16x32_bf16 v[244:247], a[52:55], v[60:63], v[244:247]
v_cvt_pk_bf16_f32 v193, v194, v195
v_cvt_pk_bf16_f32 v194, v196, v197
v_mfma_f32_16x16x32_bf16 v[248:251], a[56:59], v[60:63], v[248:251]
v_cvt_pk_bf16_f32 v195, v198, v199
buffer_store_dwordx4 v[192:195], v3, s[88:91], s8 offen sc1
v_mfma_f32_16x16x32_bf16 v[252:255], a[60:63], v[60:63], v[252:255]
v_mfma_f32_16x16x32_bf16 a[228:231], a[236:239], v[60:63], a[228:231]
s_add_u32 s8, s30, 0x2000
v_pk_mul_f32 v[200:201], v[200:201], v[6:7] op_sel_hi:[1,0]
v_pk_mul_f32 v[202:203], v[202:203], v[6:7] op_sel_hi:[1,0]
v_pk_mul_f32 v[204:205], v[204:205], v[6:7] op_sel_hi:[1,0]
v_pk_mul_f32 v[206:207], v[206:207], v[6:7] op_sel_hi:[1,0]
v_cvt_pk_bf16_f32 v200, v200, v201
v_cvt_pk_bf16_f32 v201, v202, v203
v_cvt_pk_bf16_f32 v202, v204, v205
v_cvt_pk_bf16_f32 v203, v206, v207
buffer_store_dwordx4 v[200:203], v3, s[88:91], s8 offen sc1
s_add_u32 s8, s30, 0x4000
v_pk_mul_f32 v[208:209], v[208:209], v[6:7] op_sel_hi:[1,0]
v_pk_mul_f32 v[210:211], v[210:211], v[6:7] op_sel_hi:[1,0]
v_pk_mul_f32 v[212:213], v[212:213], v[6:7] op_sel_hi:[1,0]
v_pk_mul_f32 v[214:215], v[214:215], v[6:7] op_sel_hi:[1,0]
v_cvt_pk_bf16_f32 v208, v208, v209
v_cvt_pk_bf16_f32 v209, v210, v211
v_cvt_pk_bf16_f32 v210, v212, v213
v_cvt_pk_bf16_f32 v211, v214, v215
buffer_store_dwordx4 v[208:211], v3, s[88:91], s8 offen sc1
s_add_u32 s8, s30, 0x6000
v_pk_mul_f32 v[216:217], v[216:217], v[6:7] op_sel_hi:[1,0]
v_pk_mul_f32 v[218:219], v[218:219], v[6:7] op_sel_hi:[1,0]
v_pk_mul_f32 v[220:221], v[220:221], v[6:7] op_sel_hi:[1,0]
v_pk_mul_f32 v[222:223], v[222:223], v[6:7] op_sel_hi:[1,0]
v_cvt_pk_bf16_f32 v216, v216, v217
v_cvt_pk_bf16_f32 v217, v218, v219
v_cvt_pk_bf16_f32 v218, v220, v221
v_cvt_pk_bf16_f32 v219, v222, v223
buffer_store_dwordx4 v[216:219], v3, s[88:91], s8 offen sc1
L_att_fin:
v_accvgpr_read_b32 v6, a230
v_accvgpr_read_b32 v7, a231
v_add_f32 v6, v6, v7
v_cmp_nge_f32 vcc, 0x6f800000, v6
v_rcp_f32 v6, v6
s_or_b64 s[34:35], s[34:35], vcc
s_add_u32 s8, s31, 0x0
v_pk_mul_f32 v[224:225], v[224:225], v[6:7] op_sel_hi:[1,0]
v_pk_mul_f32 v[226:227], v[226:227], v[6:7] op_sel_hi:[1,0]
v_pk_mul_f32 v[228:229], v[228:229], v[6:7] op_sel_hi:[1,0]
v_pk_mul_f32 v[230:231], v[230:231], v[6:7] op_sel_hi:[1,0]
v_cvt_pk_bf16_f32 v224, v224, v225
v_cvt_pk_bf16_f32 v225, v226, v227
v_cvt_pk_bf16_f32 v226, v228, v229
v_cvt_pk_bf16_f32 v227, v230, v231
buffer_store_dwordx4 v[224:227], v3, s[88:91], s8 offen sc1
s_add_u32 s8, s31, 0x2000
v_pk_mul_f32 v[232:233], v[232:233], v[6:7] op_sel_hi:[1,0]
v_pk_mul_f32 v[234:235], v[234:235], v[6:7] op_sel_hi:[1,0]
v_pk_mul_f32 v[236:237], v[236:237], v[6:7] op_sel_hi:[1,0]
v_pk_mul_f32 v[238:239], v[238:239], v[6:7] op_sel_hi:[1,0]
v_cvt_pk_bf16_f32 v232, v232, v233
v_cvt_pk_bf16_f32 v233, v234, v235
v_cvt_pk_bf16_f32 v234, v236, v237
v_cvt_pk_bf16_f32 v235, v238, v239
buffer_store_dwordx4 v[232:235], v3, s[88:91], s8 offen sc1
s_add_u32 s8, s31, 0x4000
v_pk_mul_f32 v[240:241], v[240:241], v[6:7] op_sel_hi:[1,0]
v_pk_mul_f32 v[242:243], v[242:243], v[6:7] op_sel_hi:[1,0]
v_pk_mul_f32 v[244:245], v[244:245], v[6:7] op_sel_hi:[1,0]
v_pk_mul_f32 v[246:247], v[246:247], v[6:7] op_sel_hi:[1,0]
v_cvt_pk_bf16_f32 v240, v240, v241
v_cvt_pk_bf16_f32 v241, v242, v243
v_cvt_pk_bf16_f32 v242, v244, v245
v_cvt_pk_bf16_f32 v243, v246, v247
buffer_store_dwordx4 v[240:243], v3, s[88:91], s8 offen sc1
s_add_u32 s8, s31, 0x6000
v_pk_mul_f32 v[248:249], v[248:249], v[6:7] op_sel_hi:[1,0]
v_pk_mul_f32 v[250:251], v[250:251], v[6:7] op_sel_hi:[1,0]
v_pk_mul_f32 v[252:253], v[252:253], v[6:7] op_sel_hi:[1,0]
v_pk_mul_f32 v[254:255], v[254:255], v[6:7] op_sel_hi:[1,0]
v_cvt_pk_bf16_f32 v248, v248, v249
v_cvt_pk_bf16_f32 v249, v250, v251
v_cvt_pk_bf16_f32 v250, v252, v253
v_cvt_pk_bf16_f32 v251, v254, v255
buffer_store_dwordx4 v[248:251], v3, s[88:91], s8 offen sc1
s_cmp_lg_u64 s[34:35], 0
s_cselect_b32 s8, 1, 0
s_lshl_b32 s9, s4, 2
s_add_u32 s9, s9, 24576
v_mov_b32 v4, s9
v_mov_b32 v5, s8
ds_write_b32 v4, v5
v_lshrrev_b32 v17, 4, v0
v_lshlrev_b32 v18, 10, v17
v_and_b32 v17, 1, v17
v_lshl_add_u32 v18, v17, 5, v18
v_bfe_u32 v17, v0, 2, 2
v_lshl_add_u32 v18, v17, 6, v18
v_and_b32 v17, 3, v0
v_lshl_add_u32 v4, v17, 3, v18
s_sub_u32 s8, s16, s17
v_add_u32 v6, s8, v4
v_xor_b32 v7, 32, v6
v_add_u32 v4, 65536, v4
v_xor_b32 v5, 32, v4
v_and_b32 v20, 15, v0
v_lshlrev_b32 v20, 2, v20
v_and_b32 v16, 28, v20
s_waitcnt vmcnt(20) lgkmcnt(0)
s_barrier
v_and_b32 v17, 3, v0
v_lshlrev_b32 v17, 2, v17
v_add_u32 v17, 24576, v17
ds_read_b32 v18, v17
s_waitcnt lgkmcnt(0)
v_cmp_ne_u32 vcc, 0, v18
s_cmp_lg_u32 s33, 0
s_cbranch_scc1 L_att_done
s_nop 4
s_cbranch_vccnz L_att_fallback
L_att_done:
ds_read_b64_tr_b16 v[152:153], v4 offset:512
ds_read_b64_tr_b16 v[154:155], v4 offset:4608
ds_read_b64_tr_b16 v[156:157], v4 offset:8704
ds_read_b64_tr_b16 v[158:159], v4 offset:12800
ds_read_b64_tr_b16 v[160:161], v5 offset:512
ds_read_b64_tr_b16 v[162:163], v5 offset:4608
ds_read_b64_tr_b16 v[164:165], v5 offset:8704
ds_read_b64_tr_b16 v[166:167], v5 offset:12800
ds_read_b64_tr_b16 v[168:169], v4 offset:768
ds_read_b64_tr_b16 v[170:171], v4 offset:4864
ds_read_b64_tr_b16 v[172:173], v4 offset:8960
ds_read_b64_tr_b16 v[174:175], v4 offset:13056
ds_read_b64_tr_b16 v[176:177], v5 offset:768
ds_read_b64_tr_b16 v[178:179], v5 offset:4864
ds_read_b64_tr_b16 v[180:181], v5 offset:8960
ds_read_b64_tr_b16 v[182:183], v5 offset:13056
s_lshl_b32 s29, s99, 7
s_lshl_b32 s9, s4, 5
s_add_u32 s29, s29, s9
s_lshl_b32 s9, s29, 2
s_add_u32 s9, s9, 0x3700000
buffer_load_dword v8, v20, s[88:91], s9 offen sc1
buffer_load_dword v9, v20, s[88:91], s9 offen offset:64 sc1
s_waitcnt lgkmcnt(8)
v_mfma_f32_16x16x32_bf16 v[56:59], v[152:155], a[64:67], 0
ds_read_b64_tr_b16 v[184:185], v4 offset:0
v_mov_b32 v88, 0
v_mfma_f32_16x16x32_bf16 v[56:59], v[156:159], a[72:75], v[56:59]
ds_read_b64_tr_b16 v[186:187], v4 offset:4096
v_mov_b32 v89, 0
v_mfma_f32_16x16x32_bf16 v[72:75], v[156:159], a[76:79], 0
ds_read_b64_tr_b16 v[188:189], v4 offset:8192
v_mov_b32 v90, 0
v_mfma_f32_16x16x32_bf16 v[72:75], v[152:155], a[68:71], v[72:75]
ds_read_b64_tr_b16 v[190:191], v4 offset:12288
v_mov_b32 v91, 0
v_mfma_f32_16x16x32_bf16 v[76:79], v[160:163], a[68:71], 0
ds_read_b64_tr_b16 v[192:193], v5 offset:0
v_mov_b32 v92, 0
v_mfma_f32_16x16x32_bf16 v[76:79], v[164:167], a[76:79], v[76:79]
ds_read_b64_tr_b16 v[194:195], v5 offset:4096
v_mov_b32 v93, 0
v_mfma_f32_16x16x32_bf16 v[60:63], v[164:167], a[72:75], 0
ds_read_b64_tr_b16 v[196:197], v5 offset:8192
s_waitcnt lgkmcnt(7)
v_mfma_f32_16x16x32_bf16 v[60:63], v[160:163], a[64:67], v[60:63]
ds_read_b64_tr_b16 v[198:199], v5 offset:12288
v_mov_b32 v94, 0
v_mfma_f32_16x16x32_bf16 v[64:67], v[168:171], a[64:67], 0
ds_read_b64_tr_b16 v[200:201], v4 offset:256
v_mov_b32 v95, 0
v_mfma_f32_16x16x32_bf16 v[64:67], v[172:175], a[72:75], v[64:67]
ds_read_b64_tr_b16 v[202:203], v4 offset:4352
v_mov_b32 v96, 0
v_mfma_f32_16x16x32_bf16 v[80:83], v[172:175], a[76:79], 0
ds_read_b64_tr_b16 v[204:205], v4 offset:8448
v_mov_b32 v97, 0
v_mfma_f32_16x16x32_bf16 v[80:83], v[168:171], a[68:71], v[80:83]
ds_read_b64_tr_b16 v[206:207], v4 offset:12544
v_mov_b32 v98, 0
v_mfma_f32_16x16x32_bf16 v[84:87], v[176:179], a[68:71], 0
ds_read_b64_tr_b16 v[208:209], v5 offset:256
v_mov_b32 v99, 0
v_mfma_f32_16x16x32_bf16 v[84:87], v[180:183], a[76:79], v[84:87]
ds_read_b64_tr_b16 v[210:211], v5 offset:4352
s_waitcnt vmcnt(2) lgkmcnt(6)
v_mfma_f32_16x16x32_bf16 v[68:71], v[180:183], a[72:75], 0
ds_read_b64_tr_b16 v[212:213], v5 offset:8448
s_barrier
v_mfma_f32_16x16x32_bf16 v[68:71], v[176:179], a[64:67], v[68:71]
ds_read_b64_tr_b16 v[214:215], v5 offset:12544
v_mov_b32 v100, 0
s_cmp_lg_u32 s4, 0
s_cbranch_scc1 L_flag_set
s_lshl_b32 s8, s6, 5
s_add_u32 s8, s8, s5
s_and_b32 s92, s8, 0xf0
s_mul_i32 s92, s92, 3
s_add_u32 s8, s8, s92
s_lshl_b32 s8, s8, 2
s_add_u32 s8, s8, 0x3704000
v_mov_b32 v21, 1
s_mov_b64 exec, 1
buffer_store_dword v21, off, s[88:91], s8 sc1
s_mov_b64 exec, -1
L_flag_set:
v_mfma_f32_16x16x32_bf16 v[24:27], v[184:187], a[64:67], 0
ds_read_b64_tr_b16 v[152:153], v4 offset:16896
s_lshl_b32 s29, s29, 11
v_mfma_f32_16x16x32_bf16 v[24:27], v[188:191], a[72:75], v[24:27]
ds_read_b64_tr_b16 v[154:155], v4 offset:20992
s_lshl_b32 s9, s100, 8
v_mfma_f32_16x16x32_bf16 v[40:43], v[188:191], a[76:79], 0
ds_read_b64_tr_b16 v[156:157], v4 offset:25088
s_add_u32 s29, s29, s9
v_mfma_f32_16x16x32_bf16 v[40:43], v[184:187], a[68:71], v[40:43]
ds_read_b64_tr_b16 v[158:159], v4 offset:29184
s_lshl_b32 s9, s14, 7
v_mfma_f32_16x16x32_bf16 v[44:47], v[192:195], a[68:71], 0
ds_read_b64_tr_b16 v[160:161], v5 offset:16896
s_add_u32 s29, s29, s9
v_mfma_f32_16x16x32_bf16 v[44:47], v[196:199], a[76:79], v[44:47]
ds_read_b64_tr_b16 v[162:163], v5 offset:20992
s_add_u32 s31, s29, 0x8000
v_mfma_f32_16x16x32_bf16 v[28:31], v[196:199], a[72:75], 0
ds_read_b64_tr_b16 v[164:165], v5 offset:25088
s_waitcnt lgkmcnt(7)
v_mfma_f32_16x16x32_bf16 v[28:31], v[192:195], a[64:67], v[28:31]
ds_read_b64_tr_b16 v[166:167], v5 offset:29184
s_lshl_b32 s28, s2, 2
v_mfma_f32_16x16x32_bf16 v[32:35], v[200:203], a[64:67], 0
ds_read_b64_tr_b16 v[168:169], v4 offset:17152
s_add_u32 s28, s28, s4
v_mfma_f32_16x16x32_bf16 v[32:35], v[204:207], a[72:75], v[32:35]
ds_read_b64_tr_b16 v[170:171], v4 offset:21248
s_lshl_b32 s28, s28, 12
v_mfma_f32_16x16x32_bf16 v[48:51], v[204:207], a[76:79], 0
ds_read_b64_tr_b16 v[172:173], v4 offset:25344
s_add_u32 s28, s28, 0x3800000
v_mfma_f32_16x16x32_bf16 v[48:51], v[200:203], a[68:71], v[48:51]
ds_read_b64_tr_b16 v[174:175], v4 offset:29440
s_xor_b32 s30, s28, 0x4000
v_mfma_f32_16x16x32_bf16 v[52:55], v[208:211], a[68:71], 0
ds_read_b64_tr_b16 v[176:177], v5 offset:17152
v_and_b32 v18, 16, v0
v_mfma_f32_16x16x32_bf16 v[52:55], v[212:215], a[76:79], v[52:55]
ds_read_b64_tr_b16 v[178:179], v5 offset:21248
s_waitcnt lgkmcnt(6)
v_mfma_f32_16x16x32_bf16 v[36:39], v[212:215], a[72:75], 0
ds_read_b64_tr_b16 v[180:181], v5 offset:25344
v_lshrrev_b32 v19, 5, v0
v_mfma_f32_16x16x32_bf16 v[36:39], v[208:211], a[64:67], v[36:39]
ds_read_b64_tr_b16 v[182:183], v5 offset:29440
v_lshlrev_b32 v19, 4, v19
v_mfma_f32_16x16x32_bf16 v[56:59], v[152:155], a[80:83], v[56:59]
ds_read_b64_tr_b16 v[184:185], v4 offset:16384
v_mov_b32 v101, 0
v_mfma_f32_16x16x32_bf16 v[56:59], v[156:159], a[88:91], v[56:59]
ds_read_b64_tr_b16 v[186:187], v4 offset:20480
v_mov_b32 v102, 0
v_mfma_f32_16x16x32_bf16 v[72:75], v[156:159], a[92:95], v[72:75]
ds_read_b64_tr_b16 v[188:189], v4 offset:24576
v_mov_b32 v103, 0
v_mfma_f32_16x16x32_bf16 v[72:75], v[152:155], a[84:87], v[72:75]
ds_read_b64_tr_b16 v[190:191], v4 offset:28672
v_mov_b32 v104, 0
v_mfma_f32_16x16x32_bf16 v[76:79], v[160:163], a[84:87], v[76:79]
ds_read_b64_tr_b16 v[192:193], v5 offset:16384
v_mov_b32 v105, 0
v_mfma_f32_16x16x32_bf16 v[76:79], v[164:167], a[92:95], v[76:79]
ds_read_b64_tr_b16 v[194:195], v5 offset:20480
v_mov_b32 v106, 0
v_mfma_f32_16x16x32_bf16 v[60:63], v[164:167], a[88:91], v[60:63]
ds_read_b64_tr_b16 v[196:197], v5 offset:24576
s_waitcnt lgkmcnt(7)
v_mfma_f32_16x16x32_bf16 v[60:63], v[160:163], a[80:83], v[60:63]
ds_read_b64_tr_b16 v[198:199], v5 offset:28672
v_mov_b32 v107, 0
v_mfma_f32_16x16x32_bf16 v[64:67], v[168:171], a[80:83], v[64:67]
ds_read_b64_tr_b16 v[200:201], v4 offset:16640
v_mov_b32 v108, 0
v_mfma_f32_16x16x32_bf16 v[64:67], v[172:175], a[88:91], v[64:67]
ds_read_b64_tr_b16 v[202:203], v4 offset:20736
v_mov_b32 v109, 0
v_mfma_f32_16x16x32_bf16 v[80:83], v[172:175], a[92:95], v[80:83]
ds_read_b64_tr_b16 v[204:205], v4 offset:24832
v_mov_b32 v110, 0
v_mfma_f32_16x16x32_bf16 v[80:83], v[168:171], a[84:87], v[80:83]
ds_read_b64_tr_b16 v[206:207], v4 offset:28928
v_mov_b32 v111, 0
v_mfma_f32_16x16x32_bf16 v[84:87], v[176:179], a[84:87], v[84:87]
ds_read_b64_tr_b16 v[208:209], v5 offset:16640
v_lshl_add_u32 v18, v18, 1, v19
v_mfma_f32_16x16x32_bf16 v[84:87], v[180:183], a[92:95], v[84:87]
ds_read_b64_tr_b16 v[210:211], v5 offset:20736
s_waitcnt vmcnt(14) lgkmcnt(6)
v_mfma_f32_16x16x32_bf16 v[68:71], v[180:183], a[88:91], v[68:71]
ds_read_b64_tr_b16 v[212:213], v5 offset:24832
s_barrier
v_mfma_f32_16x16x32_bf16 v[68:71], v[176:179], a[80:83], v[68:71]
ds_read_b64_tr_b16 v[214:215], v5 offset:28928
v_lshl_add_u32 v17, v20, 9, v18
s_cmp_eq_u32 s14, 1
s_cbranch_scc1 L_p4_skip
v_mfma_f32_16x16x32_bf16 v[24:27], v[184:187], a[80:83], v[24:27]
ds_read_b64_tr_b16 v[152:153], v6 offset:512
ds_read_b64_tr_b16 v[154:155], v6 offset:4608
v_mfma_f32_16x16x32_bf16 v[24:27], v[188:191], a[88:91], v[24:27]
ds_read_b64_tr_b16 v[156:157], v6 offset:8704
v_add_u32 v12, 0x20000, v12
v_mfma_f32_16x16x32_bf16 v[40:43], v[188:191], a[92:95], v[40:43]
ds_read_b64_tr_b16 v[158:159], v6 offset:12800
s_add_u32 m0, s17, 0x10000
v_mfma_f32_16x16x32_bf16 v[40:43], v[184:187], a[84:87], v[40:43]
buffer_load_dwordx4 v12, s[72:75], 0 offen lds
v_mfma_f32_16x16x32_bf16 v[44:47], v[192:195], a[84:87], v[44:47]
ds_read_b64_tr_b16 v[160:161], v7 offset:512
ds_read_b64_tr_b16 v[162:163], v7 offset:4608
v_mfma_f32_16x16x32_bf16 v[44:47], v[196:199], a[92:95], v[44:47]
ds_read_b64_tr_b16 v[164:165], v7 offset:8704
v_add_u32 v13, 0x20000, v13
v_mfma_f32_16x16x32_bf16 v[28:31], v[196:199], a[88:91], v[28:31]
ds_read_b64_tr_b16 v[166:167], v7 offset:12800
s_waitcnt lgkmcnt(8)
v_mfma_f32_16x16x32_bf16 v[28:31], v[192:195], a[80:83], v[28:31]
buffer_load_dwordx4 v13, s[72:75], 0 offen offset:1024 lds
v_mfma_f32_16x16x32_bf16 v[32:35], v[200:203], a[80:83], v[32:35]
ds_read_b64_tr_b16 v[168:169], v6 offset:768
ds_read_b64_tr_b16 v[170:171], v6 offset:4864
v_mfma_f32_16x16x32_bf16 v[32:35], v[204:207], a[88:91], v[32:35]
ds_read_b64_tr_b16 v[172:173], v6 offset:8960
v_mfma_f32_16x16x32_bf16 v[48:51], v[204:207], a[92:95], v[48:51]
ds_read_b64_tr_b16 v[174:175], v6 offset:13056
v_mfma_f32_16x16x32_bf16 v[48:51], v[200:203], a[84:87], v[48:51]
buffer_load_dwordx4 v12, s[72:75], s12 offen offset:2048 lds
v_mfma_f32_16x16x32_bf16 v[52:55], v[208:211], a[84:87], v[52:55]
ds_read_b64_tr_b16 v[176:177], v7 offset:768
ds_read_b64_tr_b16 v[178:179], v7 offset:4864
v_mfma_f32_16x16x32_bf16 v[52:55], v[212:215], a[92:95], v[52:55]
ds_read_b64_tr_b16 v[180:181], v7 offset:8960
s_waitcnt lgkmcnt(7)
v_mfma_f32_16x16x32_bf16 v[36:39], v[212:215], a[88:91], v[36:39]
ds_read_b64_tr_b16 v[182:183], v7 offset:13056
v_mfma_f32_16x16x32_bf16 v[36:39], v[208:211], a[80:83], v[36:39]
buffer_load_dwordx4 v13, s[72:75], s12 offen offset:3072 lds
v_mfma_f32_16x16x32_bf16 v[56:59], v[152:155], a[96:99], v[56:59]
ds_read_b64_tr_b16 v[184:185], v6 offset:0
ds_read_b64_tr_b16 v[186:187], v6 offset:4096
v_mfma_f32_16x16x32_bf16 v[56:59], v[156:159], a[104:107], v[56:59]
ds_read_b64_tr_b16 v[188:189], v6 offset:8192
v_mfma_f32_16x16x32_bf16 v[72:75], v[156:159], a[108:111], v[72:75]
ds_read_b64_tr_b16 v[190:191], v6 offset:12288
s_add_u32 s101, s101, 0x2000
v_mfma_f32_16x16x32_bf16 v[72:75], v[152:155], a[100:103], v[72:75]
buffer_load_dwordx4 a[64:67], v3, s[88:91], s101 offen sc1
v_mfma_f32_16x16x32_bf16 v[76:79], v[160:163], a[100:103], v[76:79]
ds_read_b64_tr_b16 v[192:193], v7 offset:0
ds_read_b64_tr_b16 v[194:195], v7 offset:4096
v_mfma_f32_16x16x32_bf16 v[76:79], v[164:167], a[108:111], v[76:79]
ds_read_b64_tr_b16 v[196:197], v7 offset:8192
v_mfma_f32_16x16x32_bf16 v[60:63], v[164:167], a[104:107], v[60:63]
ds_read_b64_tr_b16 v[198:199], v7 offset:12288
s_waitcnt lgkmcnt(8)
v_mfma_f32_16x16x32_bf16 v[60:63], v[160:163], a[96:99], v[60:63]
buffer_load_dwordx4 a[68:71], v3, s[88:91], s101 offen offset:1024 sc1
v_mfma_f32_16x16x32_bf16 v[64:67], v[168:171], a[96:99], v[64:67]
ds_read_b64_tr_b16 v[200:201], v6 offset:256
ds_read_b64_tr_b16 v[202:203], v6 offset:4352
v_mfma_f32_16x16x32_bf16 v[64:67], v[172:175], a[104:107], v[64:67]
ds_read_b64_tr_b16 v[204:205], v6 offset:8448
v_mfma_f32_16x16x32_bf16 v[80:83], v[172:175], a[108:111], v[80:83]
ds_read_b64_tr_b16 v[206:207], v6 offset:12544
s_add_u32 s101, s101, 0x2000
v_mfma_f32_16x16x32_bf16 v[80:83], v[168:171], a[100:103], v[80:83]
buffer_load_dwordx4 a[72:75], v3, s[88:91], s101 offen sc1
v_mfma_f32_16x16x32_bf16 v[84:87], v[176:179], a[100:103], v[84:87]
ds_read_b64_tr_b16 v[208:209], v7 offset:256
ds_read_b64_tr_b16 v[210:211], v7 offset:4352
v_mfma_f32_16x16x32_bf16 v[84:87], v[180:183], a[108:111], v[84:87]
ds_read_b64_tr_b16 v[212:213], v7 offset:8448
s_waitcnt vmcnt(17) lgkmcnt(7)
v_mfma_f32_16x16x32_bf16 v[68:71], v[180:183], a[104:107], v[68:71]
ds_read_b64_tr_b16 v[214:215], v7 offset:12544
s_barrier
v_mfma_f32_16x16x32_bf16 v[68:71], v[176:179], a[96:99], v[68:71]
buffer_load_dwordx4 a[76:79], v3, s[88:91], s101 offen offset:1024 sc1
v_mfma_f32_16x16x32_bf16 v[24:27], v[184:187], a[96:99], v[24:27]
ds_read_b64_tr_b16 v[152:153], v6 offset:16896
ds_read_b64_tr_b16 v[154:155], v6 offset:20992
v_mfma_f32_16x16x32_bf16 v[24:27], v[188:191], a[104:107], v[24:27]
ds_read_b64_tr_b16 v[156:157], v6 offset:25088
v_add_u32 v12, 0x20000, v12
v_mfma_f32_16x16x32_bf16 v[40:43], v[188:191], a[108:111], v[40:43]
ds_read_b64_tr_b16 v[158:159], v6 offset:29184
s_add_u32 m0, s17, 0x14000
v_mfma_f32_16x16x32_bf16 v[40:43], v[184:187], a[100:103], v[40:43]
buffer_load_dwordx4 v12, s[72:75], 0 offen lds
v_mfma_f32_16x16x32_bf16 v[44:47], v[192:195], a[100:103], v[44:47]
ds_read_b64_tr_b16 v[160:161], v7 offset:16896
ds_read_b64_tr_b16 v[162:163], v7 offset:20992
v_mfma_f32_16x16x32_bf16 v[44:47], v[196:199], a[108:111], v[44:47]
ds_read_b64_tr_b16 v[164:165], v7 offset:25088
v_add_u32 v13, 0x20000, v13
v_mfma_f32_16x16x32_bf16 v[28:31], v[196:199], a[104:107], v[28:31]
ds_read_b64_tr_b16 v[166:167], v7 offset:29184
s_waitcnt lgkmcnt(8)
v_mfma_f32_16x16x32_bf16 v[28:31], v[192:195], a[96:99], v[28:31]
buffer_load_dwordx4 v13, s[72:75], 0 offen offset:1024 lds
v_mfma_f32_16x16x32_bf16 v[32:35], v[200:203], a[96:99], v[32:35]
ds_read_b64_tr_b16 v[168:169], v6 offset:17152
ds_read_b64_tr_b16 v[170:171], v6 offset:21248
v_mfma_f32_16x16x32_bf16 v[32:35], v[204:207], a[104:107], v[32:35]
ds_read_b64_tr_b16 v[172:173], v6 offset:25344
v_mfma_f32_16x16x32_bf16 v[48:51], v[204:207], a[108:111], v[48:51]
ds_read_b64_tr_b16 v[174:175], v6 offset:29440
v_mfma_f32_16x16x32_bf16 v[48:51], v[200:203], a[100:103], v[48:51]
buffer_load_dwordx4 v12, s[72:75], s12 offen offset:2048 lds
v_mfma_f32_16x16x32_bf16 v[52:55], v[208:211], a[100:103], v[52:55]
ds_read_b64_tr_b16 v[176:177], v7 offset:17152
ds_read_b64_tr_b16 v[178:179], v7 offset:21248
v_mfma_f32_16x16x32_bf16 v[52:55], v[212:215], a[108:111], v[52:55]
ds_read_b64_tr_b16 v[180:181], v7 offset:25344
s_waitcnt lgkmcnt(7)
v_mfma_f32_16x16x32_bf16 v[36:39], v[212:215], a[104:107], v[36:39]
ds_read_b64_tr_b16 v[182:183], v7 offset:29440
v_mfma_f32_16x16x32_bf16 v[36:39], v[208:211], a[96:99], v[36:39]
buffer_load_dwordx4 v13, s[72:75], s12 offen offset:3072 lds
v_mfma_f32_16x16x32_bf16 v[56:59], v[152:155], a[112:115], v[56:59]
ds_read_b64_tr_b16 v[184:185], v6 offset:16384
ds_read_b64_tr_b16 v[186:187], v6 offset:20480
v_mfma_f32_16x16x32_bf16 v[56:59], v[156:159], a[120:123], v[56:59]
ds_read_b64_tr_b16 v[188:189], v6 offset:24576
v_mfma_f32_16x16x32_bf16 v[72:75], v[156:159], a[124:127], v[72:75]
ds_read_b64_tr_b16 v[190:191], v6 offset:28672
s_add_u32 s101, s101, 0x2000
v_mfma_f32_16x16x32_bf16 v[72:75], v[152:155], a[116:119], v[72:75]
buffer_load_dwordx4 a[80:83], v3, s[88:91], s101 offen sc1
v_mfma_f32_16x16x32_bf16 v[76:79], v[160:163], a[116:119], v[76:79]
ds_read_b64_tr_b16 v[192:193], v7 offset:16384
ds_read_b64_tr_b16 v[194:195], v7 offset:20480
v_mfma_f32_16x16x32_bf16 v[76:79], v[164:167], a[124:127], v[76:79]
ds_read_b64_tr_b16 v[196:197], v7 offset:24576
v_mfma_f32_16x16x32_bf16 v[60:63], v[164:167], a[120:123], v[60:63]
ds_read_b64_tr_b16 v[198:199], v7 offset:28672
s_waitcnt lgkmcnt(8)
v_mfma_f32_16x16x32_bf16 v[60:63], v[160:163], a[112:115], v[60:63]
buffer_load_dwordx4 a[84:87], v3, s[88:91], s101 offen offset:1024 sc1
v_mfma_f32_16x16x32_bf16 v[64:67], v[168:171], a[112:115], v[64:67]
ds_read_b64_tr_b16 v[200:201], v6 offset:16640
ds_read_b64_tr_b16 v[202:203], v6 offset:20736
v_mfma_f32_16x16x32_bf16 v[64:67], v[172:175], a[120:123], v[64:67]
ds_read_b64_tr_b16 v[204:205], v6 offset:24832
v_mfma_f32_16x16x32_bf16 v[80:83], v[172:175], a[124:127], v[80:83]
ds_read_b64_tr_b16 v[206:207], v6 offset:28928
s_add_u32 s101, s101, 0x2000
v_mfma_f32_16x16x32_bf16 v[80:83], v[168:171], a[116:119], v[80:83]
buffer_load_dwordx4 a[88:91], v3, s[88:91], s101 offen sc1
v_mfma_f32_16x16x32_bf16 v[84:87], v[176:179], a[116:119], v[84:87]
ds_read_b64_tr_b16 v[208:209], v7 offset:16640
ds_read_b64_tr_b16 v[210:211], v7 offset:20736
v_mfma_f32_16x16x32_bf16 v[84:87], v[180:183], a[124:127], v[84:87]
ds_read_b64_tr_b16 v[212:213], v7 offset:24832
s_waitcnt vmcnt(7) lgkmcnt(7)
v_mfma_f32_16x16x32_bf16 v[68:71], v[180:183], a[120:123], v[68:71]
ds_read_b64_tr_b16 v[214:215], v7 offset:28928
s_barrier
v_mfma_f32_16x16x32_bf16 v[68:71], v[176:179], a[112:115], v[68:71]
buffer_load_dwordx4 a[92:95], v3, s[88:91], s101 offen offset:1024 sc1
v_mfma_f32_16x16x32_bf16 v[24:27], v[184:187], a[112:115], v[24:27]
ds_read_b64_tr_b16 v[152:153], v4 offset:512
ds_read_b64_tr_b16 v[154:155], v4 offset:4608
v_mfma_f32_16x16x32_bf16 v[24:27], v[188:191], a[120:123], v[24:27]
ds_read_b64_tr_b16 v[156:157], v4 offset:8704
v_add_u32 v12, 0x20000, v12
v_mfma_f32_16x16x32_bf16 v[40:43], v[188:191], a[124:127], v[40:43]
ds_read_b64_tr_b16 v[158:159], v4 offset:12800
s_add_u32 m0, s16, 0x0
v_mfma_f32_16x16x32_bf16 v[40:43], v[184:187], a[116:119], v[40:43]
buffer_load_dwordx4 v12, s[72:75], 0 offen lds
v_mfma_f32_16x16x32_bf16 v[44:47], v[192:195], a[116:119], v[44:47]
ds_read_b64_tr_b16 v[160:161], v5 offset:512
ds_read_b64_tr_b16 v[162:163], v5 offset:4608
v_mfma_f32_16x16x32_bf16 v[44:47], v[196:199], a[124:127], v[44:47]
ds_read_b64_tr_b16 v[164:165], v5 offset:8704
v_add_u32 v13, 0x20000, v13
v_mfma_f32_16x16x32_bf16 v[28:31], v[196:199], a[120:123], v[28:31]
ds_read_b64_tr_b16 v[166:167], v5 offset:12800
s_waitcnt lgkmcnt(8)
v_mfma_f32_16x16x32_bf16 v[28:31], v[192:195], a[112:115], v[28:31]
buffer_load_dwordx4 v13, s[72:75], 0 offen offset:1024 lds
v_mfma_f32_16x16x32_bf16 v[32:35], v[200:203], a[112:115], v[32:35]
ds_read_b64_tr_b16 v[168:169], v4 offset:768
ds_read_b64_tr_b16 v[170:171], v4 offset:4864
v_mfma_f32_16x16x32_bf16 v[32:35], v[204:207], a[120:123], v[32:35]
ds_read_b64_tr_b16 v[172:173], v4 offset:8960
v_mfma_f32_16x16x32_bf16 v[48:51], v[204:207], a[124:127], v[48:51]
ds_read_b64_tr_b16 v[174:175], v4 offset:13056
v_mfma_f32_16x16x32_bf16 v[48:51], v[200:203], a[116:119], v[48:51]
buffer_load_dwordx4 v12, s[72:75], s12 offen offset:2048 lds
v_mfma_f32_16x16x32_bf16 v[52:55], v[208:211], a[116:119], v[52:55]
ds_read_b64_tr_b16 v[176:177], v5 offset:768
ds_read_b64_tr_b16 v[178:179], v5 offset:4864
v_mfma_f32_16x16x32_bf16 v[52:55], v[212:215], a[124:127], v[52:55]
ds_read_b64_tr_b16 v[180:181], v5 offset:8960
s_waitcnt lgkmcnt(7)
v_mfma_f32_16x16x32_bf16 v[36:39], v[212:215], a[120:123], v[36:39]
ds_read_b64_tr_b16 v[182:183], v5 offset:13056
v_mfma_f32_16x16x32_bf16 v[36:39], v[208:211], a[112:115], v[36:39]
buffer_load_dwordx4 v13, s[72:75], s12 offen offset:3072 lds
v_mfma_f32_16x16x32_bf16 v[56:59], v[152:155], a[64:67], v[56:59]
ds_read_b64_tr_b16 v[184:185], v4 offset:0
ds_read_b64_tr_b16 v[186:187], v4 offset:4096
v_mfma_f32_16x16x32_bf16 v[56:59], v[156:159], a[72:75], v[56:59]
ds_read_b64_tr_b16 v[188:189], v4 offset:8192
v_mfma_f32_16x16x32_bf16 v[72:75], v[156:159], a[76:79], v[72:75]
ds_read_b64_tr_b16 v[190:191], v4 offset:12288
s_add_u32 s101, s101, 0x2000
v_mfma_f32_16x16x32_bf16 v[72:75], v[152:155], a[68:71], v[72:75]
buffer_load_dwordx4 a[96:99], v3, s[88:91], s101 offen sc1
v_mfma_f32_16x16x32_bf16 v[76:79], v[160:163], a[68:71], v[76:79]
ds_read_b64_tr_b16 v[192:193], v5 offset:0
ds_read_b64_tr_b16 v[194:195], v5 offset:4096
v_mfma_f32_16x16x32_bf16 v[76:79], v[164:167], a[76:79], v[76:79]
ds_read_b64_tr_b16 v[196:197], v5 offset:8192
v_mfma_f32_16x16x32_bf16 v[60:63], v[164:167], a[72:75], v[60:63]
ds_read_b64_tr_b16 v[198:199], v5 offset:12288
s_waitcnt lgkmcnt(8)
v_mfma_f32_16x16x32_bf16 v[60:63], v[160:163], a[64:67], v[60:63]
buffer_load_dwordx4 a[100:103], v3, s[88:91], s101 offen offset:1024 sc1
v_mfma_f32_16x16x32_bf16 v[64:67], v[168:171], a[64:67], v[64:67]
ds_read_b64_tr_b16 v[200:201], v4 offset:256
ds_read_b64_tr_b16 v[202:203], v4 offset:4352
v_mfma_f32_16x16x32_bf16 v[64:67], v[172:175], a[72:75], v[64:67]
ds_read_b64_tr_b16 v[204:205], v4 offset:8448
v_mfma_f32_16x16x32_bf16 v[80:83], v[172:175], a[76:79], v[80:83]
ds_read_b64_tr_b16 v[206:207], v4 offset:12544
s_add_u32 s101, s101, 0x2000
v_mfma_f32_16x16x32_bf16 v[80:83], v[168:171], a[68:71], v[80:83]
buffer_load_dwordx4 a[104:107], v3, s[88:91], s101 offen sc1
v_mfma_f32_16x16x32_bf16 v[84:87], v[176:179], a[68:71], v[84:87]
ds_read_b64_tr_b16 v[208:209], v5 offset:256
ds_read_b64_tr_b16 v[210:211], v5 offset:4352
v_mfma_f32_16x16x32_bf16 v[84:87], v[180:183], a[76:79], v[84:87]
ds_read_b64_tr_b16 v[212:213], v5 offset:8448
s_waitcnt vmcnt(7) lgkmcnt(7)
v_mfma_f32_16x16x32_bf16 v[68:71], v[180:183], a[72:75], v[68:71]
ds_read_b64_tr_b16 v[214:215], v5 offset:12544
s_barrier
v_mfma_f32_16x16x32_bf16 v[68:71], v[176:179], a[64:67], v[68:71]
buffer_load_dwordx4 a[108:111], v3, s[88:91], s101 offen offset:1024 sc1
v_mfma_f32_16x16x32_bf16 v[24:27], v[184:187], a[64:67], v[24:27]
ds_read_b64_tr_b16 v[152:153], v4 offset:16896
ds_read_b64_tr_b16 v[154:155], v4 offset:20992
v_mfma_f32_16x16x32_bf16 v[24:27], v[188:191], a[72:75], v[24:27]
ds_read_b64_tr_b16 v[156:157], v4 offset:25088
v_add_u32 v12, 0x20000, v12
v_mfma_f32_16x16x32_bf16 v[40:43], v[188:191], a[76:79], v[40:43]
ds_read_b64_tr_b16 v[158:159], v4 offset:29184
s_add_u32 m0, s16, 0x4000
v_mfma_f32_16x16x32_bf16 v[40:43], v[184:187], a[68:71], v[40:43]
buffer_load_dwordx4 v12, s[72:75], 0 offen lds
v_mfma_f32_16x16x32_bf16 v[44:47], v[192:195], a[68:71], v[44:47]
ds_read_b64_tr_b16 v[160:161], v5 offset:16896
ds_read_b64_tr_b16 v[162:163], v5 offset:20992
v_mfma_f32_16x16x32_bf16 v[44:47], v[196:199], a[76:79], v[44:47]
ds_read_b64_tr_b16 v[164:165], v5 offset:25088
v_add_u32 v13, 0x20000, v13
v_mfma_f32_16x16x32_bf16 v[28:31], v[196:199], a[72:75], v[28:31]
ds_read_b64_tr_b16 v[166:167], v5 offset:29184
s_waitcnt lgkmcnt(8)
v_mfma_f32_16x16x32_bf16 v[28:31], v[192:195], a[64:67], v[28:31]
buffer_load_dwordx4 v13, s[72:75], 0 offen offset:1024 lds
v_mfma_f32_16x16x32_bf16 v[32:35], v[200:203], a[64:67], v[32:35]
ds_read_b64_tr_b16 v[168:169], v4 offset:17152
ds_read_b64_tr_b16 v[170:171], v4 offset:21248
v_mfma_f32_16x16x32_bf16 v[32:35], v[204:207], a[72:75], v[32:35]
ds_read_b64_tr_b16 v[172:173], v4 offset:25344
v_mfma_f32_16x16x32_bf16 v[48:51], v[204:207], a[76:79], v[48:51]
ds_read_b64_tr_b16 v[174:175], v4 offset:29440
v_mfma_f32_16x16x32_bf16 v[48:51], v[200:203], a[68:71], v[48:51]
buffer_load_dwordx4 v12, s[72:75], s12 offen offset:2048 lds
v_mfma_f32_16x16x32_bf16 v[52:55], v[208:211], a[68:71], v[52:55]
ds_read_b64_tr_b16 v[176:177], v5 offset:17152
ds_read_b64_tr_b16 v[178:179], v5 offset:21248
v_mfma_f32_16x16x32_bf16 v[52:55], v[212:215], a[76:79], v[52:55]
ds_read_b64_tr_b16 v[180:181], v5 offset:25344
s_waitcnt lgkmcnt(7)
v_mfma_f32_16x16x32_bf16 v[36:39], v[212:215], a[72:75], v[36:39]
ds_read_b64_tr_b16 v[182:183], v5 offset:29440
v_mfma_f32_16x16x32_bf16 v[36:39], v[208:211], a[64:67], v[36:39]
buffer_load_dwordx4 v13, s[72:75], s12 offen offset:3072 lds
v_mfma_f32_16x16x32_bf16 v[56:59], v[152:155], a[80:83], v[56:59]
ds_read_b64_tr_b16 v[184:185], v4 offset:16384
ds_read_b64_tr_b16 v[186:187], v4 offset:20480
v_mfma_f32_16x16x32_bf16 v[56:59], v[156:159], a[88:91], v[56:59]
ds_read_b64_tr_b16 v[188:189], v4 offset:24576
v_mfma_f32_16x16x32_bf16 v[72:75], v[156:159], a[92:95], v[72:75]
ds_read_b64_tr_b16 v[190:191], v4 offset:28672
s_add_u32 s101, s101, 0x2000
v_mfma_f32_16x16x32_bf16 v[72:75], v[152:155], a[84:87], v[72:75]
buffer_load_dwordx4 a[112:115], v3, s[88:91], s101 offen sc1
v_mfma_f32_16x16x32_bf16 v[76:79], v[160:163], a[84:87], v[76:79]
ds_read_b64_tr_b16 v[192:193], v5 offset:16384
ds_read_b64_tr_b16 v[194:195], v5 offset:20480
v_mfma_f32_16x16x32_bf16 v[76:79], v[164:167], a[92:95], v[76:79]
ds_read_b64_tr_b16 v[196:197], v5 offset:24576
v_mfma_f32_16x16x32_bf16 v[60:63], v[164:167], a[88:91], v[60:63]
ds_read_b64_tr_b16 v[198:199], v5 offset:28672
s_waitcnt lgkmcnt(8)
v_mfma_f32_16x16x32_bf16 v[60:63], v[160:163], a[80:83], v[60:63]
buffer_load_dwordx4 a[116:119], v3, s[88:91], s101 offen offset:1024 sc1
v_mfma_f32_16x16x32_bf16 v[64:67], v[168:171], a[80:83], v[64:67]
ds_read_b64_tr_b16 v[200:201], v4 offset:16640
ds_read_b64_tr_b16 v[202:203], v4 offset:20736
v_mfma_f32_16x16x32_bf16 v[64:67], v[172:175], a[88:91], v[64:67]
ds_read_b64_tr_b16 v[204:205], v4 offset:24832
v_mfma_f32_16x16x32_bf16 v[80:83], v[172:175], a[92:95], v[80:83]
ds_read_b64_tr_b16 v[206:207], v4 offset:28928
s_add_u32 s101, s101, 0x2000
v_mfma_f32_16x16x32_bf16 v[80:83], v[168:171], a[84:87], v[80:83]
buffer_load_dwordx4 a[120:123], v3, s[88:91], s101 offen sc1
v_mfma_f32_16x16x32_bf16 v[84:87], v[176:179], a[84:87], v[84:87]
ds_read_b64_tr_b16 v[208:209], v5 offset:16640
ds_read_b64_tr_b16 v[210:211], v5 offset:20736
v_mfma_f32_16x16x32_bf16 v[84:87], v[180:183], a[92:95], v[84:87]
ds_read_b64_tr_b16 v[212:213], v5 offset:24832
s_waitcnt vmcnt(7) lgkmcnt(7)
v_mfma_f32_16x16x32_bf16 v[68:71], v[180:183], a[88:91], v[68:71]
ds_read_b64_tr_b16 v[214:215], v5 offset:28928
s_barrier
v_mfma_f32_16x16x32_bf16 v[68:71], v[176:179], a[80:83], v[68:71]
buffer_load_dwordx4 a[124:127], v3, s[88:91], s101 offen offset:1024 sc1
L_p4_skip:
v_mfma_f32_16x16x32_bf16 v[24:27], v[184:187], a[80:83], v[24:27]
ds_read_b64_tr_b16 v[152:153], v6 offset:512
ds_read_b64_tr_b16 v[154:155], v6 offset:4608
v_mfma_f32_16x16x32_bf16 v[24:27], v[188:191], a[88:91], v[24:27]
ds_read_b64_tr_b16 v[156:157], v6 offset:8704
v_add_u32 v12, 0x20000, v12
v_mfma_f32_16x16x32_bf16 v[40:43], v[188:191], a[92:95], v[40:43]
ds_read_b64_tr_b16 v[158:159], v6 offset:12800
s_add_u32 m0, s17, 0x10000
v_mfma_f32_16x16x32_bf16 v[40:43], v[184:187], a[84:87], v[40:43]
buffer_load_dwordx4 v12, s[72:75], 0 offen lds
v_mfma_f32_16x16x32_bf16 v[44:47], v[192:195], a[84:87], v[44:47]
ds_read_b64_tr_b16 v[160:161], v7 offset:512
ds_read_b64_tr_b16 v[162:163], v7 offset:4608
v_mfma_f32_16x16x32_bf16 v[44:47], v[196:199], a[92:95], v[44:47]
ds_read_b64_tr_b16 v[164:165], v7 offset:8704
v_add_u32 v13, 0x20000, v13
v_mfma_f32_16x16x32_bf16 v[28:31], v[196:199], a[88:91], v[28:31]
ds_read_b64_tr_b16 v[166:167], v7 offset:12800
s_waitcnt lgkmcnt(8)
v_mfma_f32_16x16x32_bf16 v[28:31], v[192:195], a[80:83], v[28:31]
buffer_load_dwordx4 v13, s[72:75], 0 offen offset:1024 lds
v_mfma_f32_16x16x32_bf16 v[32:35], v[200:203], a[80:83], v[32:35]
ds_read_b64_tr_b16 v[168:169], v6 offset:768
ds_read_b64_tr_b16 v[170:171], v6 offset:4864
v_mfma_f32_16x16x32_bf16 v[32:35], v[204:207], a[88:91], v[32:35]
ds_read_b64_tr_b16 v[172:173], v6 offset:8960
v_mfma_f32_16x16x32_bf16 v[48:51], v[204:207], a[92:95], v[48:51]
ds_read_b64_tr_b16 v[174:175], v6 offset:13056
v_mfma_f32_16x16x32_bf16 v[48:51], v[200:203], a[84:87], v[48:51]
buffer_load_dwordx4 v12, s[72:75], s12 offen offset:2048 lds
v_mfma_f32_16x16x32_bf16 v[52:55], v[208:211], a[84:87], v[52:55]
ds_read_b64_tr_b16 v[176:177], v7 offset:768
ds_read_b64_tr_b16 v[178:179], v7 offset:4864
v_mfma_f32_16x16x32_bf16 v[52:55], v[212:215], a[92:95], v[52:55]
ds_read_b64_tr_b16 v[180:181], v7 offset:8960
s_waitcnt lgkmcnt(7)
v_mfma_f32_16x16x32_bf16 v[36:39], v[212:215], a[88:91], v[36:39]
ds_read_b64_tr_b16 v[182:183], v7 offset:13056
v_mfma_f32_16x16x32_bf16 v[36:39], v[208:211], a[80:83], v[36:39]
buffer_load_dwordx4 v13, s[72:75], s12 offen offset:3072 lds
v_mfma_f32_16x16x32_bf16 v[56:59], v[152:155], a[96:99], v[56:59]
ds_read_b64_tr_b16 v[184:185], v6 offset:0
ds_read_b64_tr_b16 v[186:187], v6 offset:4096
v_mfma_f32_16x16x32_bf16 v[56:59], v[156:159], a[104:107], v[56:59]
ds_read_b64_tr_b16 v[188:189], v6 offset:8192
v_mov_b32 v112, 0
v_mfma_f32_16x16x32_bf16 v[72:75], v[156:159], a[108:111], v[72:75]
ds_read_b64_tr_b16 v[190:191], v6 offset:12288
s_add_u32 s101, s101, 0x2000
v_mfma_f32_16x16x32_bf16 v[72:75], v[152:155], a[100:103], v[72:75]
buffer_load_dwordx4 a[64:67], v3, s[88:91], s101 offen sc1
v_mfma_f32_16x16x32_bf16 v[76:79], v[160:163], a[100:103], v[76:79]
ds_read_b64_tr_b16 v[192:193], v7 offset:0
ds_read_b64_tr_b16 v[194:195], v7 offset:4096
v_mfma_f32_16x16x32_bf16 v[76:79], v[164:167], a[108:111], v[76:79]
ds_read_b64_tr_b16 v[196:197], v7 offset:8192
v_mov_b32 v113, 0
v_mfma_f32_16x16x32_bf16 v[60:63], v[164:167], a[104:107], v[60:63]
ds_read_b64_tr_b16 v[198:199], v7 offset:12288
s_waitcnt lgkmcnt(8)
v_mfma_f32_16x16x32_bf16 v[60:63], v[160:163], a[96:99], v[60:63]
buffer_load_dwordx4 a[68:71], v3, s[88:91], s101 offen offset:1024 sc1
v_mfma_f32_16x16x32_bf16 v[64:67], v[168:171], a[96:99], v[64:67]
ds_read_b64_tr_b16 v[200:201], v6 offset:256
ds_read_b64_tr_b16 v[202:203], v6 offset:4352
v_mfma_f32_16x16x32_bf16 v[64:67], v[172:175], a[104:107], v[64:67]
ds_read_b64_tr_b16 v[204:205], v6 offset:8448
v_mov_b32 v114, 0
v_mfma_f32_16x16x32_bf16 v[80:83], v[172:175], a[108:111], v[80:83]
ds_read_b64_tr_b16 v[206:207], v6 offset:12544
s_add_u32 s101, s101, 0x2000
v_mfma_f32_16x16x32_bf16 v[80:83], v[168:171], a[100:103], v[80:83]
buffer_load_dwordx4 a[72:75], v3, s[88:91], s101 offen sc1
v_mfma_f32_16x16x32_bf16 v[84:87], v[176:179], a[100:103], v[84:87]
ds_read_b64_tr_b16 v[208:209], v7 offset:256
ds_read_b64_tr_b16 v[210:211], v7 offset:4352
v_mfma_f32_16x16x32_bf16 v[84:87], v[180:183], a[108:111], v[84:87]
ds_read_b64_tr_b16 v[212:213], v7 offset:8448
s_waitcnt vmcnt(7) lgkmcnt(7)
v_mfma_f32_16x16x32_bf16 v[68:71], v[180:183], a[104:107], v[68:71]
ds_read_b64_tr_b16 v[214:215], v7 offset:12544
s_barrier
v_mfma_f32_16x16x32_bf16 v[68:71], v[176:179], a[96:99], v[68:71]
buffer_load_dwordx4 a[76:79], v3, s[88:91], s101 offen offset:1024 sc1
v_mov_b32 v115, 0
buffer_load_dword v14, v16, s[88:91], s24 offen sc1
v_mfma_f32_16x16x32_bf16 v[24:27], v[184:187], a[96:99], v[24:27]
ds_read_b64_tr_b16 v[152:153], v6 offset:16896
ds_read_b64_tr_b16 v[154:155], v6 offset:20992
v_mfma_f32_16x16x32_bf16 v[24:27], v[188:191], a[104:107], v[24:27]
ds_read_b64_tr_b16 v[156:157], v6 offset:25088
v_add_u32 v12, 0x20000, v12
v_mfma_f32_16x16x32_bf16 v[40:43], v[188:191], a[108:111], v[40:43]
ds_read_b64_tr_b16 v[158:159], v6 offset:29184
s_add_u32 m0, s17, 0x14000
v_mfma_f32_16x16x32_bf16 v[40:43], v[184:187], a[100:103], v[40:43]
buffer_load_dwordx4 v12, s[72:75], 0 offen lds
v_mfma_f32_16x16x32_bf16 v[44:47], v[192:195], a[100:103], v[44:47]
ds_read_b64_tr_b16 v[160:161], v7 offset:16896
ds_read_b64_tr_b16 v[162:163], v7 offset:20992
v_mfma_f32_16x16x32_bf16 v[44:47], v[196:199], a[108:111], v[44:47]
ds_read_b64_tr_b16 v[164:165], v7 offset:25088
v_add_u32 v13, 0x20000, v13
v_mfma_f32_16x16x32_bf16 v[28:31], v[196:199], a[104:107], v[28:31]
ds_read_b64_tr_b16 v[166:167], v7 offset:29184
s_waitcnt lgkmcnt(8)
v_mfma_f32_16x16x32_bf16 v[28:31], v[192:195], a[96:99], v[28:31]
buffer_load_dwordx4 v13, s[72:75], 0 offen offset:1024 lds
v_mfma_f32_16x16x32_bf16 v[32:35], v[200:203], a[96:99], v[32:35]
ds_read_b64_tr_b16 v[168:169], v6 offset:17152
ds_read_b64_tr_b16 v[170:171], v6 offset:21248
v_mfma_f32_16x16x32_bf16 v[32:35], v[204:207], a[104:107], v[32:35]
ds_read_b64_tr_b16 v[172:173], v6 offset:25344
v_mfma_f32_16x16x32_bf16 v[48:51], v[204:207], a[108:111], v[48:51]
ds_read_b64_tr_b16 v[174:175], v6 offset:29440
v_mfma_f32_16x16x32_bf16 v[48:51], v[200:203], a[100:103], v[48:51]
buffer_load_dwordx4 v12, s[72:75], s12 offen offset:2048 lds
v_mfma_f32_16x16x32_bf16 v[52:55], v[208:211], a[100:103], v[52:55]
ds_read_b64_tr_b16 v[176:177], v7 offset:17152
ds_read_b64_tr_b16 v[178:179], v7 offset:21248
v_mfma_f32_16x16x32_bf16 v[52:55], v[212:215], a[108:111], v[52:55]
ds_read_b64_tr_b16 v[180:181], v7 offset:25344
s_waitcnt lgkmcnt(7)
v_mfma_f32_16x16x32_bf16 v[36:39], v[212:215], a[104:107], v[36:39]
ds_read_b64_tr_b16 v[182:183], v7 offset:29440
v_mfma_f32_16x16x32_bf16 v[36:39], v[208:211], a[96:99], v[36:39]
buffer_load_dwordx4 v13, s[72:75], s12 offen offset:3072 lds
v_mfma_f32_16x16x32_bf16 v[56:59], v[152:155], a[112:115], v[56:59]
ds_read_b64_tr_b16 v[184:185], v6 offset:16384
ds_read_b64_tr_b16 v[186:187], v6 offset:20480
v_mfma_f32_16x16x32_bf16 v[56:59], v[156:159], a[120:123], v[56:59]
ds_read_b64_tr_b16 v[188:189], v6 offset:24576
v_mov_b32 v116, 0
v_mfma_f32_16x16x32_bf16 v[72:75], v[156:159], a[124:127], v[72:75]
ds_read_b64_tr_b16 v[190:191], v6 offset:28672
s_add_u32 s101, s101, 0x2000
v_mfma_f32_16x16x32_bf16 v[72:75], v[152:155], a[116:119], v[72:75]
buffer_load_dwordx4 a[80:83], v3, s[88:91], s101 offen sc1
v_mfma_f32_16x16x32_bf16 v[76:79], v[160:163], a[116:119], v[76:79]
ds_read_b64_tr_b16 v[192:193], v7 offset:16384
ds_read_b64_tr_b16 v[194:195], v7 offset:20480
v_mfma_f32_16x16x32_bf16 v[76:79], v[164:167], a[124:127], v[76:79]
ds_read_b64_tr_b16 v[196:197], v7 offset:24576
v_mov_b32 v117, 0
v_mfma_f32_16x16x32_bf16 v[60:63], v[164:167], a[120:123], v[60:63]
ds_read_b64_tr_b16 v[198:199], v7 offset:28672
s_waitcnt lgkmcnt(8)
v_mfma_f32_16x16x32_bf16 v[60:63], v[160:163], a[112:115], v[60:63]
buffer_load_dwordx4 a[84:87], v3, s[88:91], s101 offen offset:1024 sc1
v_mfma_f32_16x16x32_bf16 v[64:67], v[168:171], a[112:115], v[64:67]
ds_read_b64_tr_b16 v[200:201], v6 offset:16640
ds_read_b64_tr_b16 v[202:203], v6 offset:20736
v_mfma_f32_16x16x32_bf16 v[64:67], v[172:175], a[120:123], v[64:67]
ds_read_b64_tr_b16 v[204:205], v6 offset:24832
v_mov_b32 v118, 0
v_mfma_f32_16x16x32_bf16 v[80:83], v[172:175], a[124:127], v[80:83]
ds_read_b64_tr_b16 v[206:207], v6 offset:28928
s_add_u32 s101, s101, 0x2000
v_mfma_f32_16x16x32_bf16 v[80:83], v[168:171], a[116:119], v[80:83]
buffer_load_dwordx4 a[88:91], v3, s[88:91], s101 offen sc1
v_mfma_f32_16x16x32_bf16 v[84:87], v[176:179], a[116:119], v[84:87]
ds_read_b64_tr_b16 v[208:209], v7 offset:16640
ds_read_b64_tr_b16 v[210:211], v7 offset:20736
v_mfma_f32_16x16x32_bf16 v[84:87], v[180:183], a[124:127], v[84:87]
ds_read_b64_tr_b16 v[212:213], v7 offset:24832
s_waitcnt vmcnt(7) lgkmcnt(7)
v_mfma_f32_16x16x32_bf16 v[68:71], v[180:183], a[120:123], v[68:71]
ds_read_b64_tr_b16 v[214:215], v7 offset:28928
s_barrier
v_mfma_f32_16x16x32_bf16 v[68:71], v[176:179], a[112:115], v[68:71]
buffer_load_dwordx4 a[92:95], v3, s[88:91], s101 offen offset:1024 sc1
v_mov_b32 v119, 0
s_mov_b32 s92, 200000
L_spin_c:
v_cmp_ne_u32 vcc, 1, v14
s_nop 4
s_cbranch_vccz L_spun_c
s_sub_u32 s92, s92, 1
s_cbranch_scc1 L_spun_c
s_sleep 6
buffer_load_dword v14, v16, s[88:91], s24 offen sc1
s_waitcnt vmcnt(0)
s_branch L_spin_c
L_spun_c:
v_mfma_f32_16x16x32_bf16 v[24:27], v[184:187], a[112:115], v[24:27]
ds_read_b64_tr_b16 v[152:153], v4 offset:512
ds_read_b64_tr_b16 v[154:155], v4 offset:4608
v_mfma_f32_16x16x32_bf16 v[24:27], v[188:191], a[120:123], v[24:27]
ds_read_b64_tr_b16 v[156:157], v4 offset:8704
v_add_u32 v12, s25, v12
v_mfma_f32_16x16x32_bf16 v[40:43], v[188:191], a[124:127], v[40:43]
ds_read_b64_tr_b16 v[158:159], v4 offset:12800
s_add_u32 m0, s16, 0x0
v_mfma_f32_16x16x32_bf16 v[40:43], v[184:187], a[116:119], v[40:43]
buffer_load_dwordx4 v12, s[64:67], s61 offen lds
v_mfma_f32_16x16x32_bf16 v[44:47], v[192:195], a[116:119], v[44:47]
ds_read_b64_tr_b16 v[160:161], v5 offset:512
ds_read_b64_tr_b16 v[162:163], v5 offset:4608
v_mfma_f32_16x16x32_bf16 v[44:47], v[196:199], a[124:127], v[44:47]
ds_read_b64_tr_b16 v[164:165], v5 offset:8704
v_add_u32 v13, s25, v13
v_mfma_f32_16x16x32_bf16 v[28:31], v[196:199], a[120:123], v[28:31]
ds_read_b64_tr_b16 v[166:167], v5 offset:12800
s_waitcnt lgkmcnt(8)
v_mfma_f32_16x16x32_bf16 v[28:31], v[192:195], a[112:115], v[28:31]
buffer_load_dwordx4 v13, s[64:67], s61 offen offset:1024 lds
v_mfma_f32_16x16x32_bf16 v[32:35], v[200:203], a[112:115], v[32:35]
ds_read_b64_tr_b16 v[168:169], v4 offset:768
ds_read_b64_tr_b16 v[170:171], v4 offset:4864
v_mfma_f32_16x16x32_bf16 v[32:35], v[204:207], a[120:123], v[32:35]
ds_read_b64_tr_b16 v[172:173], v4 offset:8960
s_add_u32 s63, s101, s26
v_mfma_f32_16x16x32_bf16 v[48:51], v[204:207], a[124:127], v[48:51]
ds_read_b64_tr_b16 v[174:175], v4 offset:13056
s_add_u32 s101, s63, s60
v_mfma_f32_16x16x32_bf16 v[48:51], v[200:203], a[116:119], v[48:51]
buffer_load_dwordx4 v12, s[64:67], s62 offen offset:2048 lds
v_mfma_f32_16x16x32_bf16 v[52:55], v[208:211], a[116:119], v[52:55]
ds_read_b64_tr_b16 v[176:177], v5 offset:768
ds_read_b64_tr_b16 v[178:179], v5 offset:4864
v_mfma_f32_16x16x32_bf16 v[52:55], v[212:215], a[124:127], v[52:55]
ds_read_b64_tr_b16 v[180:181], v5 offset:8960
s_waitcnt lgkmcnt(7)
v_mfma_f32_16x16x32_bf16 v[36:39], v[212:215], a[120:123], v[36:39]
ds_read_b64_tr_b16 v[182:183], v5 offset:13056
v_mfma_f32_16x16x32_bf16 v[36:39], v[208:211], a[112:115], v[36:39]
buffer_load_dwordx4 v13, s[64:67], s62 offen offset:3072 lds
v_mfma_f32_16x16x32_bf16 v[56:59], v[152:155], a[64:67], v[56:59]
ds_read_b64_tr_b16 v[184:185], v4 offset:0
ds_read_b64_tr_b16 v[186:187], v4 offset:4096
v_mfma_f32_16x16x32_bf16 v[56:59], v[156:159], a[72:75], v[56:59]
ds_read_b64_tr_b16 v[188:189], v4 offset:8192
s_add_u32 s60, s60, s57
v_mfma_f32_16x16x32_bf16 v[72:75], v[156:159], a[76:79], v[72:75]
ds_read_b64_tr_b16 v[190:191], v4 offset:12288
s_and_b32 s60, s60, 0x7c000
v_mfma_f32_16x16x32_bf16 v[72:75], v[152:155], a[68:71], v[72:75]
buffer_load_dwordx4 a[96:99], v3, s[88:91], s101 offen sc1
v_mfma_f32_16x16x32_bf16 v[76:79], v[160:163], a[68:71], v[76:79]
ds_read_b64_tr_b16 v[192:193], v5 offset:0
ds_read_b64_tr_b16 v[194:195], v5 offset:4096
v_mfma_f32_16x16x32_bf16 v[76:79], v[164:167], a[76:79], v[76:79]
ds_read_b64_tr_b16 v[196:197], v5 offset:8192
s_lshl_b32 s61, s60, 3
v_mfma_f32_16x16x32_bf16 v[60:63], v[164:167], a[72:75], v[60:63]
ds_read_b64_tr_b16 v[198:199], v5 offset:12288
s_waitcnt lgkmcnt(8)
v_mfma_f32_16x16x32_bf16 v[60:63], v[160:163], a[64:67], v[60:63]
buffer_load_dwordx4 a[100:103], v3, s[88:91], s101 offen offset:1024 sc1
v_mfma_f32_16x16x32_bf16 v[64:67], v[168:171], a[64:67], v[64:67]
ds_read_b64_tr_b16 v[200:201], v4 offset:256
ds_read_b64_tr_b16 v[202:203], v4 offset:4352
v_mfma_f32_16x16x32_bf16 v[64:67], v[172:175], a[72:75], v[64:67]
ds_read_b64_tr_b16 v[204:205], v4 offset:8448
s_add_u32 s62, s61, s12
v_mfma_f32_16x16x32_bf16 v[80:83], v[172:175], a[76:79], v[80:83]
ds_read_b64_tr_b16 v[206:207], v4 offset:12544
s_add_u32 s101, s101, 0x2000
v_mfma_f32_16x16x32_bf16 v[80:83], v[168:171], a[68:71], v[80:83]
buffer_load_dwordx4 a[104:107], v3, s[88:91], s101 offen sc1
v_mfma_f32_16x16x32_bf16 v[84:87], v[176:179], a[68:71], v[84:87]
ds_read_b64_tr_b16 v[208:209], v5 offset:256
ds_read_b64_tr_b16 v[210:211], v5 offset:4352
v_mfma_f32_16x16x32_bf16 v[84:87], v[180:183], a[76:79], v[84:87]
ds_read_b64_tr_b16 v[212:213], v5 offset:8448
s_waitcnt vmcnt(7) lgkmcnt(7)
v_mfma_f32_16x16x32_bf16 v[68:71], v[180:183], a[72:75], v[68:71]
ds_read_b64_tr_b16 v[214:215], v5 offset:12544
s_barrier
v_mfma_f32_16x16x32_bf16 v[68:71], v[176:179], a[64:67], v[68:71]
buffer_load_dwordx4 a[108:111], v3, s[88:91], s101 offen offset:1024 sc1
v_mfma_f32_16x16x32_bf16 v[24:27], v[184:187], a[64:67], v[24:27]
ds_read_b64_tr_b16 v[152:153], v4 offset:16896
ds_read_b64_tr_b16 v[154:155], v4 offset:20992
v_mfma_f32_16x16x32_bf16 v[24:27], v[188:191], a[72:75], v[24:27]
ds_read_b64_tr_b16 v[156:157], v4 offset:25088
s_add_u32 s101, s63, s60
v_mfma_f32_16x16x32_bf16 v[40:43], v[188:191], a[76:79], v[40:43]
ds_read_b64_tr_b16 v[158:159], v4 offset:29184
s_add_u32 m0, s16, 0x4000
v_mfma_f32_16x16x32_bf16 v[40:43], v[184:187], a[68:71], v[40:43]
buffer_load_dwordx4 v12, s[64:67], s61 offen lds
v_mfma_f32_16x16x32_bf16 v[44:47], v[192:195], a[68:71], v[44:47]
ds_read_b64_tr_b16 v[160:161], v5 offset:16896
ds_read_b64_tr_b16 v[162:163], v5 offset:20992
v_mfma_f32_16x16x32_bf16 v[44:47], v[196:199], a[76:79], v[44:47]
ds_read_b64_tr_b16 v[164:165], v5 offset:25088
v_mfma_f32_16x16x32_bf16 v[28:31], v[196:199], a[72:75], v[28:31]
ds_read_b64_tr_b16 v[166:167], v5 offset:29184
s_waitcnt lgkmcnt(8)
v_mfma_f32_16x16x32_bf16 v[28:31], v[192:195], a[64:67], v[28:31]
buffer_load_dwordx4 v13, s[64:67], s61 offen offset:1024 lds
v_mfma_f32_16x16x32_bf16 v[32:35], v[200:203], a[64:67], v[32:35]
ds_read_b64_tr_b16 v[168:169], v4 offset:17152
ds_read_b64_tr_b16 v[170:171], v4 offset:21248
v_mfma_f32_16x16x32_bf16 v[32:35], v[204:207], a[72:75], v[32:35]
ds_read_b64_tr_b16 v[172:173], v4 offset:25344
v_mfma_f32_16x16x32_bf16 v[48:51], v[204:207], a[76:79], v[48:51]
ds_read_b64_tr_b16 v[174:175], v4 offset:29440
v_mfma_f32_16x16x32_bf16 v[48:51], v[200:203], a[68:71], v[48:51]
buffer_load_dwordx4 v12, s[64:67], s62 offen offset:2048 lds
v_mfma_f32_16x16x32_bf16 v[52:55], v[208:211], a[68:71], v[52:55]
ds_read_b64_tr_b16 v[176:177], v5 offset:17152
ds_read_b64_tr_b16 v[178:179], v5 offset:21248
v_mfma_f32_16x16x32_bf16 v[52:55], v[212:215], a[76:79], v[52:55]
ds_read_b64_tr_b16 v[180:181], v5 offset:25344
s_waitcnt lgkmcnt(7)
v_mfma_f32_16x16x32_bf16 v[36:39], v[212:215], a[72:75], v[36:39]
ds_read_b64_tr_b16 v[182:183], v5 offset:29440
v_mfma_f32_16x16x32_bf16 v[36:39], v[208:211], a[64:67], v[36:39]
buffer_load_dwordx4 v13, s[64:67], s62 offen offset:3072 lds
v_mfma_f32_16x16x32_bf16 v[56:59], v[152:155], a[80:83], v[56:59]
ds_read_b64_tr_b16 v[184:185], v4 offset:16384
ds_read_b64_tr_b16 v[186:187], v4 offset:20480
v_mfma_f32_16x16x32_bf16 v[56:59], v[156:159], a[88:91], v[56:59]
ds_read_b64_tr_b16 v[188:189], v4 offset:24576
s_add_u32 s60, s60, s58
v_mfma_f32_16x16x32_bf16 v[72:75], v[156:159], a[92:95], v[72:75]
ds_read_b64_tr_b16 v[190:191], v4 offset:28672
s_and_b32 s60, s60, 0x7c000
v_mfma_f32_16x16x32_bf16 v[72:75], v[152:155], a[84:87], v[72:75]
buffer_load_dwordx4 a[112:115], v3, s[88:91], s101 offen sc1
v_mfma_f32_16x16x32_bf16 v[76:79], v[160:163], a[84:87], v[76:79]
ds_read_b64_tr_b16 v[192:193], v5 offset:16384
ds_read_b64_tr_b16 v[194:195], v5 offset:20480
v_mfma_f32_16x16x32_bf16 v[76:79], v[164:167], a[92:95], v[76:79]
ds_read_b64_tr_b16 v[196:197], v5 offset:24576
s_lshl_b32 s61, s60, 3
v_mfma_f32_16x16x32_bf16 v[60:63], v[164:167], a[88:91], v[60:63]
ds_read_b64_tr_b16 v[198:199], v5 offset:28672
s_waitcnt lgkmcnt(8)
v_mfma_f32_16x16x32_bf16 v[60:63], v[160:163], a[80:83], v[60:63]
buffer_load_dwordx4 a[116:119], v3, s[88:91], s101 offen offset:1024 sc1
v_mfma_f32_16x16x32_bf16 v[64:67], v[168:171], a[80:83], v[64:67]
ds_read_b64_tr_b16 v[200:201], v4 offset:16640
ds_read_b64_tr_b16 v[202:203], v4 offset:20736
v_mfma_f32_16x16x32_bf16 v[64:67], v[172:175], a[88:91], v[64:67]
ds_read_b64_tr_b16 v[204:205], v4 offset:24832
s_add_u32 s62, s61, s12
v_mfma_f32_16x16x32_bf16 v[80:83], v[172:175], a[92:95], v[80:83]
ds_read_b64_tr_b16 v[206:207], v4 offset:28928
s_add_u32 s101, s101, 0x2000
v_mfma_f32_16x16x32_bf16 v[80:83], v[168:171], a[84:87], v[80:83]
buffer_load_dwordx4 a[120:123], v3, s[88:91], s101 offen sc1
v_mfma_f32_16x16x32_bf16 v[84:87], v[176:179], a[84:87], v[84:87]
ds_read_b64_tr_b16 v[208:209], v5 offset:16640
ds_read_b64_tr_b16 v[210:211], v5 offset:20736
v_mfma_f32_16x16x32_bf16 v[84:87], v[180:183], a[92:95], v[84:87]
ds_read_b64_tr_b16 v[212:213], v5 offset:24832
s_waitcnt vmcnt(7) lgkmcnt(7)
v_mfma_f32_16x16x32_bf16 v[68:71], v[180:183], a[88:91], v[68:71]
ds_read_b64_tr_b16 v[214:215], v5 offset:28928
s_barrier
v_mfma_f32_16x16x32_bf16 v[68:71], v[176:179], a[80:83], v[68:71]
buffer_load_dwordx4 a[124:127], v3, s[88:91], s101 offen offset:1024 sc1
v_mfma_f32_16x16x32_bf16 v[24:27], v[184:187], a[80:83], v[24:27]
ds_read_b64_tr_b16 v[152:153], v6 offset:512
ds_read_b64_tr_b16 v[154:155], v6 offset:4608
v_mfma_f32_16x16x32_bf16 v[24:27], v[188:191], a[88:91], v[24:27]
ds_read_b64_tr_b16 v[156:157], v6 offset:8704
s_add_u32 s101, s63, s60
v_mfma_f32_16x16x32_bf16 v[40:43], v[188:191], a[92:95], v[40:43]
ds_read_b64_tr_b16 v[158:159], v6 offset:12800
s_add_u32 m0, s17, 0x10000
v_mfma_f32_16x16x32_bf16 v[40:43], v[184:187], a[84:87], v[40:43]
buffer_load_dwordx4 v12, s[64:67], s61 offen lds
v_mfma_f32_16x16x32_bf16 v[44:47], v[192:195], a[84:87], v[44:47]
ds_read_b64_tr_b16 v[160:161], v7 offset:512
ds_read_b64_tr_b16 v[162:163], v7 offset:4608
v_mfma_f32_16x16x32_bf16 v[44:47], v[196:199], a[92:95], v[44:47]
ds_read_b64_tr_b16 v[164:165], v7 offset:8704
v_mfma_f32_16x16x32_bf16 v[28:31], v[196:199], a[88:91], v[28:31]
ds_read_b64_tr_b16 v[166:167], v7 offset:12800
s_waitcnt lgkmcnt(8)
v_mfma_f32_16x16x32_bf16 v[28:31], v[192:195], a[80:83], v[28:31]
buffer_load_dwordx4 v13, s[64:67], s61 offen offset:1024 lds
v_mfma_f32_16x16x32_bf16 v[32:35], v[200:203], a[80:83], v[32:35]
ds_read_b64_tr_b16 v[168:169], v6 offset:768
ds_read_b64_tr_b16 v[170:171], v6 offset:4864
v_mfma_f32_16x16x32_bf16 v[32:35], v[204:207], a[88:91], v[32:35]
ds_read_b64_tr_b16 v[172:173], v6 offset:8960
v_mfma_f32_16x16x32_bf16 v[48:51], v[204:207], a[92:95], v[48:51]
ds_read_b64_tr_b16 v[174:175], v6 offset:13056
v_mfma_f32_16x16x32_bf16 v[48:51], v[200:203], a[84:87], v[48:51]
buffer_load_dwordx4 v12, s[64:67], s62 offen offset:2048 lds
v_mfma_f32_16x16x32_bf16 v[52:55], v[208:211], a[84:87], v[52:55]
ds_read_b64_tr_b16 v[176:177], v7 offset:768
ds_read_b64_tr_b16 v[178:179], v7 offset:4864
v_mfma_f32_16x16x32_bf16 v[52:55], v[212:215], a[92:95], v[52:55]
ds_read_b64_tr_b16 v[180:181], v7 offset:8960
s_waitcnt lgkmcnt(7)
v_mfma_f32_16x16x32_bf16 v[36:39], v[212:215], a[88:91], v[36:39]
ds_read_b64_tr_b16 v[182:183], v7 offset:13056
v_mfma_f32_16x16x32_bf16 v[36:39], v[208:211], a[80:83], v[36:39]
buffer_load_dwordx4 v13, s[64:67], s62 offen offset:3072 lds
v_mfma_f32_16x16x32_bf16 v[120:123], v[152:155], a[96:99], 0
ds_read_b64_tr_b16 v[184:185], v6 offset:0
ds_read_b64_tr_b16 v[186:187], v6 offset:4096
v_mfma_f32_16x16x32_bf16 v[120:123], v[156:159], a[104:107], v[120:123]
ds_read_b64_tr_b16 v[188:189], v6 offset:8192
s_add_u32 s60, s60, s59
v_mfma_f32_16x16x32_bf16 v[136:139], v[156:159], a[108:111], 0
ds_read_b64_tr_b16 v[190:191], v6 offset:12288
s_and_b32 s60, s60, 0x7c000
v_mfma_f32_16x16x32_bf16 v[136:139], v[152:155], a[100:103], v[136:139]
buffer_load_dwordx4 a[64:67], v3, s[88:91], s101 offen sc1
v_mfma_f32_16x16x32_bf16 v[140:143], v[160:163], a[100:103], 0
ds_read_b64_tr_b16 v[192:193], v7 offset:0
ds_read_b64_tr_b16 v[194:195], v7 offset:4096
v_mfma_f32_16x16x32_bf16 v[140:143], v[164:167], a[108:111], v[140:143]
ds_read_b64_tr_b16 v[196:197], v7 offset:8192
s_lshl_b32 s61, s60, 3
v_mfma_f32_16x16x32_bf16 v[124:127], v[164:167], a[104:107], 0
ds_read_b64_tr_b16 v[198:199], v7 offset:12288
s_waitcnt lgkmcnt(8)
v_mfma_f32_16x16x32_bf16 v[124:127], v[160:163], a[96:99], v[124:127]
buffer_load_dwordx4 a[68:71], v3, s[88:91], s101 offen offset:1024 sc1
v_mfma_f32_16x16x32_bf16 v[128:131], v[168:171], a[96:99], 0
ds_read_b64_tr_b16 v[200:201], v6 offset:256
ds_read_b64_tr_b16 v[202:203], v6 offset:4352
v_mfma_f32_16x16x32_bf16 v[128:131], v[172:175], a[104:107], v[128:131]
ds_read_b64_tr_b16 v[204:205], v6 offset:8448
s_add_u32 s62, s61, s12
v_mfma_f32_16x16x32_bf16 v[144:147], v[172:175], a[108:111], 0
ds_read_b64_tr_b16 v[206:207], v6 offset:12544
s_add_u32 s101, s101, 0x2000
v_mfma_f32_16x16x32_bf16 v[144:147], v[168:171], a[100:103], v[144:147]
buffer_load_dwordx4 a[72:75], v3, s[88:91], s101 offen sc1
v_mfma_f32_16x16x32_bf16 v[148:151], v[176:179], a[100:103], 0
ds_read_b64_tr_b16 v[208:209], v7 offset:256
ds_read_b64_tr_b16 v[210:211], v7 offset:4352
v_mfma_f32_16x16x32_bf16 v[148:151], v[180:183], a[108:111], v[148:151]
ds_read_b64_tr_b16 v[212:213], v7 offset:8448
s_waitcnt vmcnt(7) lgkmcnt(7)
v_mfma_f32_16x16x32_bf16 v[132:135], v[180:183], a[104:107], 0
ds_read_b64_tr_b16 v[214:215], v7 offset:12544
s_barrier
v_mfma_f32_16x16x32_bf16 v[132:135], v[176:179], a[96:99], v[132:135]
buffer_load_dwordx4 a[76:79], v3, s[88:91], s101 offen offset:1024 sc1
s_mov_b32 s15, 7
L_p4_loop:
v_mfma_f32_16x16x32_bf16 v[88:91], v[184:187], a[96:99], v[88:91]
ds_read_b64_tr_b16 v[152:153], v6 offset:16896
ds_read_b64_tr_b16 v[154:155], v6 offset:20992
v_mfma_f32_16x16x32_bf16 v[88:91], v[188:191], a[104:107], v[88:91]
ds_read_b64_tr_b16 v[156:157], v6 offset:25088
s_add_u32 s101, s63, s60
v_mfma_f32_16x16x32_bf16 v[104:107], v[188:191], a[108:111], v[104:107]
ds_read_b64_tr_b16 v[158:159], v6 offset:29184
s_add_u32 m0, s17, 0x14000
v_mfma_f32_16x16x32_bf16 v[104:107], v[184:187], a[100:103], v[104:107]
buffer_load_dwordx4 v12, s[64:67], s61 offen lds
v_mfma_f32_16x16x32_bf16 v[108:111], v[192:195], a[100:103], v[108:111]
ds_read_b64_tr_b16 v[160:161], v7 offset:16896
ds_read_b64_tr_b16 v[162:163], v7 offset:20992
v_mfma_f32_16x16x32_bf16 v[108:111], v[196:199], a[108:111], v[108:111]
ds_read_b64_tr_b16 v[164:165], v7 offset:25088
v_mfma_f32_16x16x32_bf16 v[92:95], v[196:199], a[104:107], v[92:95]
ds_read_b64_tr_b16 v[166:167], v7 offset:29184
s_waitcnt lgkmcnt(8)
v_mfma_f32_16x16x32_bf16 v[92:95], v[192:195], a[96:99], v[92:95]
buffer_load_dwordx4 v13, s[64:67], s61 offen offset:1024 lds
v_mfma_f32_16x16x32_bf16 v[96:99], v[200:203], a[96:99], v[96:99]
ds_read_b64_tr_b16 v[168:169], v6 offset:17152
ds_read_b64_tr_b16 v[170:171], v6 offset:21248
v_mfma_f32_16x16x32_bf16 v[96:99], v[204:207], a[104:107], v[96:99]
ds_read_b64_tr_b16 v[172:173], v6 offset:25344
v_mfma_f32_16x16x32_bf16 v[112:115], v[204:207], a[108:111], v[112:115]
ds_read_b64_tr_b16 v[174:175], v6 offset:29440
v_mfma_f32_16x16x32_bf16 v[112:115], v[200:203], a[100:103], v[112:115]
buffer_load_dwordx4 v12, s[64:67], s62 offen offset:2048 lds
v_mfma_f32_16x16x32_bf16 v[116:119], v[208:211], a[100:103], v[116:119]
ds_read_b64_tr_b16 v[176:177], v7 offset:17152
ds_read_b64_tr_b16 v[178:179], v7 offset:21248
v_mfma_f32_16x16x32_bf16 v[116:119], v[212:215], a[108:111], v[116:119]
ds_read_b64_tr_b16 v[180:181], v7 offset:25344
s_waitcnt lgkmcnt(7)
v_mfma_f32_16x16x32_bf16 v[100:103], v[212:215], a[104:107], v[100:103]
ds_read_b64_tr_b16 v[182:183], v7 offset:29440
v_mfma_f32_16x16x32_bf16 v[100:103], v[208:211], a[96:99], v[100:103]
buffer_load_dwordx4 v13, s[64:67], s62 offen offset:3072 lds
v_mfma_f32_16x16x32_bf16 v[120:123], v[152:155], a[112:115], v[120:123]
ds_read_b64_tr_b16 v[184:185], v6 offset:16384
ds_read_b64_tr_b16 v[186:187], v6 offset:20480
v_mfma_f32_16x16x32_bf16 v[120:123], v[156:159], a[120:123], v[120:123]
ds_read_b64_tr_b16 v[188:189], v6 offset:24576
s_add_u32 s60, s60, s56
v_mfma_f32_16x16x32_bf16 v[136:139], v[156:159], a[124:127], v[136:139]
ds_read_b64_tr_b16 v[190:191], v6 offset:28672
s_and_b32 s60, s60, 0x7c000
v_mfma_f32_16x16x32_bf16 v[136:139], v[152:155], a[116:119], v[136:139]
buffer_load_dwordx4 a[80:83], v3, s[88:91], s101 offen sc1
v_mfma_f32_16x16x32_bf16 v[140:143], v[160:163], a[116:119], v[140:143]
ds_read_b64_tr_b16 v[192:193], v7 offset:16384
ds_read_b64_tr_b16 v[194:195], v7 offset:20480
v_mfma_f32_16x16x32_bf16 v[140:143], v[164:167], a[124:127], v[140:143]
ds_read_b64_tr_b16 v[196:197], v7 offset:24576
s_lshl_b32 s61, s60, 3
v_mfma_f32_16x16x32_bf16 v[124:127], v[164:167], a[120:123], v[124:127]
ds_read_b64_tr_b16 v[198:199], v7 offset:28672
s_waitcnt lgkmcnt(8)
v_mfma_f32_16x16x32_bf16 v[124:127], v[160:163], a[112:115], v[124:127]
buffer_load_dwordx4 a[84:87], v3, s[88:91], s101 offen offset:1024 sc1
v_mfma_f32_16x16x32_bf16 v[128:131], v[168:171], a[112:115], v[128:131]
ds_read_b64_tr_b16 v[200:201], v6 offset:16640
ds_read_b64_tr_b16 v[202:203], v6 offset:20736
v_mfma_f32_16x16x32_bf16 v[128:131], v[172:175], a[120:123], v[128:131]
ds_read_b64_tr_b16 v[204:205], v6 offset:24832
s_add_u32 s62, s61, s12
v_mfma_f32_16x16x32_bf16 v[144:147], v[172:175], a[124:127], v[144:147]
ds_read_b64_tr_b16 v[206:207], v6 offset:28928
s_add_u32 s101, s101, 0x2000
v_mfma_f32_16x16x32_bf16 v[144:147], v[168:171], a[116:119], v[144:147]
buffer_load_dwordx4 a[88:91], v3, s[88:91], s101 offen sc1
v_mfma_f32_16x16x32_bf16 v[148:151], v[176:179], a[116:119], v[148:151]
ds_read_b64_tr_b16 v[208:209], v7 offset:16640
ds_read_b64_tr_b16 v[210:211], v7 offset:20736
v_mfma_f32_16x16x32_bf16 v[148:151], v[180:183], a[124:127], v[148:151]
ds_read_b64_tr_b16 v[212:213], v7 offset:24832
s_waitcnt vmcnt(7) lgkmcnt(7)
v_mfma_f32_16x16x32_bf16 v[132:135], v[180:183], a[120:123], v[132:135]
ds_read_b64_tr_b16 v[214:215], v7 offset:28928
s_barrier
v_mfma_f32_16x16x32_bf16 v[132:135], v[176:179], a[112:115], v[132:135]
buffer_load_dwordx4 a[92:95], v3, s[88:91], s101 offen offset:1024 sc1
v_mfma_f32_16x16x32_bf16 v[88:91], v[184:187], a[112:115], v[88:91]
ds_read_b64_tr_b16 v[152:153], v4 offset:512
ds_read_b64_tr_b16 v[154:155], v4 offset:4608
v_mfma_f32_16x16x32_bf16 v[88:91], v[188:191], a[120:123], v[88:91]
ds_read_b64_tr_b16 v[156:157], v4 offset:8704
s_add_u32 s101, s63, s60
v_mfma_f32_16x16x32_bf16 v[104:107], v[188:191], a[124:127], v[104:107]
ds_read_b64_tr_b16 v[158:159], v4 offset:12800
s_add_u32 m0, s16, 0x0
v_mfma_f32_16x16x32_bf16 v[104:107], v[184:187], a[116:119], v[104:107]
buffer_load_dwordx4 v12, s[64:67], s61 offen lds
v_mfma_f32_16x16x32_bf16 v[108:111], v[192:195], a[116:119], v[108:111]
ds_read_b64_tr_b16 v[160:161], v5 offset:512
ds_read_b64_tr_b16 v[162:163], v5 offset:4608
v_mfma_f32_16x16x32_bf16 v[108:111], v[196:199], a[124:127], v[108:111]
ds_read_b64_tr_b16 v[164:165], v5 offset:8704
v_mfma_f32_16x16x32_bf16 v[92:95], v[196:199], a[120:123], v[92:95]
ds_read_b64_tr_b16 v[166:167], v5 offset:12800
s_waitcnt lgkmcnt(8)
v_mfma_f32_16x16x32_bf16 v[92:95], v[192:195], a[112:115], v[92:95]
buffer_load_dwordx4 v13, s[64:67], s61 offen offset:1024 lds
v_mfma_f32_16x16x32_bf16 v[96:99], v[200:203], a[112:115], v[96:99]
ds_read_b64_tr_b16 v[168:169], v4 offset:768
ds_read_b64_tr_b16 v[170:171], v4 offset:4864
v_mfma_f32_16x16x32_bf16 v[96:99], v[204:207], a[120:123], v[96:99]
ds_read_b64_tr_b16 v[172:173], v4 offset:8960
v_mfma_f32_16x16x32_bf16 v[112:115], v[204:207], a[124:127], v[112:115]
ds_read_b64_tr_b16 v[174:175], v4 offset:13056
v_mfma_f32_16x16x32_bf16 v[112:115], v[200:203], a[116:119], v[112:115]
buffer_load_dwordx4 v12, s[64:67], s62 offen offset:2048 lds
v_mfma_f32_16x16x32_bf16 v[116:119], v[208:211], a[116:119], v[116:119]
ds_read_b64_tr_b16 v[176:177], v5 offset:768
ds_read_b64_tr_b16 v[178:179], v5 offset:4864
v_mfma_f32_16x16x32_bf16 v[116:119], v[212:215], a[124:127], v[116:119]
ds_read_b64_tr_b16 v[180:181], v5 offset:8960
s_waitcnt lgkmcnt(7)
v_mfma_f32_16x16x32_bf16 v[100:103], v[212:215], a[120:123], v[100:103]
ds_read_b64_tr_b16 v[182:183], v5 offset:13056
v_mfma_f32_16x16x32_bf16 v[100:103], v[208:211], a[112:115], v[100:103]
buffer_load_dwordx4 v13, s[64:67], s62 offen offset:3072 lds
v_mfma_f32_16x16x32_bf16 v[120:123], v[152:155], a[64:67], v[120:123]
ds_read_b64_tr_b16 v[184:185], v4 offset:0
ds_read_b64_tr_b16 v[186:187], v4 offset:4096
v_mfma_f32_16x16x32_bf16 v[120:123], v[156:159], a[72:75], v[120:123]
ds_read_b64_tr_b16 v[188:189], v4 offset:8192
s_add_u32 s60, s60, s57
v_mfma_f32_16x16x32_bf16 v[136:139], v[156:159], a[76:79], v[136:139]
ds_read_b64_tr_b16 v[190:191], v4 offset:12288
s_and_b32 s60, s60, 0x7c000
v_mfma_f32_16x16x32_bf16 v[136:139], v[152:155], a[68:71], v[136:139]
buffer_load_dwordx4 a[96:99], v3, s[88:91], s101 offen sc1
v_mfma_f32_16x16x32_bf16 v[140:143], v[160:163], a[68:71], v[140:143]
ds_read_b64_tr_b16 v[192:193], v5 offset:0
ds_read_b64_tr_b16 v[194:195], v5 offset:4096
v_mfma_f32_16x16x32_bf16 v[140:143], v[164:167], a[76:79], v[140:143]
ds_read_b64_tr_b16 v[196:197], v5 offset:8192
s_lshl_b32 s61, s60, 3
v_mfma_f32_16x16x32_bf16 v[124:127], v[164:167], a[72:75], v[124:127]
ds_read_b64_tr_b16 v[198:199], v5 offset:12288
s_waitcnt lgkmcnt(8)
v_mfma_f32_16x16x32_bf16 v[124:127], v[160:163], a[64:67], v[124:127]
buffer_load_dwordx4 a[100:103], v3, s[88:91], s101 offen offset:1024 sc1
v_mfma_f32_16x16x32_bf16 v[128:131], v[168:171], a[64:67], v[128:131]
ds_read_b64_tr_b16 v[200:201], v4 offset:256
ds_read_b64_tr_b16 v[202:203], v4 offset:4352
v_mfma_f32_16x16x32_bf16 v[128:131], v[172:175], a[72:75], v[128:131]
ds_read_b64_tr_b16 v[204:205], v4 offset:8448
s_add_u32 s62, s61, s12
v_mfma_f32_16x16x32_bf16 v[144:147], v[172:175], a[76:79], v[144:147]
ds_read_b64_tr_b16 v[206:207], v4 offset:12544
s_add_u32 s101, s101, 0x2000
v_mfma_f32_16x16x32_bf16 v[144:147], v[168:171], a[68:71], v[144:147]
buffer_load_dwordx4 a[104:107], v3, s[88:91], s101 offen sc1
v_mfma_f32_16x16x32_bf16 v[148:151], v[176:179], a[68:71], v[148:151]
ds_read_b64_tr_b16 v[208:209], v5 offset:256
ds_read_b64_tr_b16 v[210:211], v5 offset:4352
v_mfma_f32_16x16x32_bf16 v[148:151], v[180:183], a[76:79], v[148:151]
ds_read_b64_tr_b16 v[212:213], v5 offset:8448
s_waitcnt vmcnt(7) lgkmcnt(7)
v_mfma_f32_16x16x32_bf16 v[132:135], v[180:183], a[72:75], v[132:135]
ds_read_b64_tr_b16 v[214:215], v5 offset:12544
s_barrier
v_mfma_f32_16x16x32_bf16 v[132:135], v[176:179], a[64:67], v[132:135]
buffer_load_dwordx4 a[108:111], v3, s[88:91], s101 offen offset:1024 sc1
v_mfma_f32_16x16x32_bf16 v[88:91], v[184:187], a[64:67], v[88:91]
ds_read_b64_tr_b16 v[152:153], v4 offset:16896
ds_read_b64_tr_b16 v[154:155], v4 offset:20992
v_mfma_f32_16x16x32_bf16 v[88:91], v[188:191], a[72:75], v[88:91]
ds_read_b64_tr_b16 v[156:157], v4 offset:25088
s_add_u32 s101, s63, s60
v_mfma_f32_16x16x32_bf16 v[104:107], v[188:191], a[76:79], v[104:107]
ds_read_b64_tr_b16 v[158:159], v4 offset:29184
s_add_u32 m0, s16, 0x4000
v_mfma_f32_16x16x32_bf16 v[104:107], v[184:187], a[68:71], v[104:107]
buffer_load_dwordx4 v12, s[64:67], s61 offen lds
v_mfma_f32_16x16x32_bf16 v[108:111], v[192:195], a[68:71], v[108:111]
ds_read_b64_tr_b16 v[160:161], v5 offset:16896
ds_read_b64_tr_b16 v[162:163], v5 offset:20992
v_mfma_f32_16x16x32_bf16 v[108:111], v[196:199], a[76:79], v[108:111]
ds_read_b64_tr_b16 v[164:165], v5 offset:25088
v_mfma_f32_16x16x32_bf16 v[92:95], v[196:199], a[72:75], v[92:95]
ds_read_b64_tr_b16 v[166:167], v5 offset:29184
s_waitcnt lgkmcnt(8)
v_mfma_f32_16x16x32_bf16 v[92:95], v[192:195], a[64:67], v[92:95]
buffer_load_dwordx4 v13, s[64:67], s61 offen offset:1024 lds
v_mfma_f32_16x16x32_bf16 v[96:99], v[200:203], a[64:67], v[96:99]
ds_read_b64_tr_b16 v[168:169], v4 offset:17152
ds_read_b64_tr_b16 v[170:171], v4 offset:21248
v_mfma_f32_16x16x32_bf16 v[96:99], v[204:207], a[72:75], v[96:99]
ds_read_b64_tr_b16 v[172:173], v4 offset:25344
v_mfma_f32_16x16x32_bf16 v[112:115], v[204:207], a[76:79], v[112:115]
ds_read_b64_tr_b16 v[174:175], v4 offset:29440
v_mfma_f32_16x16x32_bf16 v[112:115], v[200:203], a[68:71], v[112:115]
buffer_load_dwordx4 v12, s[64:67], s62 offen offset:2048 lds
v_mfma_f32_16x16x32_bf16 v[116:119], v[208:211], a[68:71], v[116:119]
ds_read_b64_tr_b16 v[176:177], v5 offset:17152
ds_read_b64_tr_b16 v[178:179], v5 offset:21248
v_mfma_f32_16x16x32_bf16 v[116:119], v[212:215], a[76:79], v[116:119]
ds_read_b64_tr_b16 v[180:181], v5 offset:25344
s_waitcnt lgkmcnt(7)
v_mfma_f32_16x16x32_bf16 v[100:103], v[212:215], a[72:75], v[100:103]
ds_read_b64_tr_b16 v[182:183], v5 offset:29440
v_mfma_f32_16x16x32_bf16 v[100:103], v[208:211], a[64:67], v[100:103]
buffer_load_dwordx4 v13, s[64:67], s62 offen offset:3072 lds
v_mfma_f32_16x16x32_bf16 v[120:123], v[152:155], a[80:83], v[120:123]
ds_read_b64_tr_b16 v[184:185], v4 offset:16384
ds_read_b64_tr_b16 v[186:187], v4 offset:20480
v_mfma_f32_16x16x32_bf16 v[120:123], v[156:159], a[88:91], v[120:123]
ds_read_b64_tr_b16 v[188:189], v4 offset:24576
s_add_u32 s60, s60, s58
v_mfma_f32_16x16x32_bf16 v[136:139], v[156:159], a[92:95], v[136:139]
ds_read_b64_tr_b16 v[190:191], v4 offset:28672
s_and_b32 s60, s60, 0x7c000
v_mfma_f32_16x16x32_bf16 v[136:139], v[152:155], a[84:87], v[136:139]
buffer_load_dwordx4 a[112:115], v3, s[88:91], s101 offen sc1
v_mfma_f32_16x16x32_bf16 v[140:143], v[160:163], a[84:87], v[140:143]
ds_read_b64_tr_b16 v[192:193], v5 offset:16384
ds_read_b64_tr_b16 v[194:195], v5 offset:20480
v_mfma_f32_16x16x32_bf16 v[140:143], v[164:167], a[92:95], v[140:143]
ds_read_b64_tr_b16 v[196:197], v5 offset:24576
s_lshl_b32 s61, s60, 3
v_mfma_f32_16x16x32_bf16 v[124:127], v[164:167], a[88:91], v[124:127]
ds_read_b64_tr_b16 v[198:199], v5 offset:28672
s_waitcnt lgkmcnt(8)
v_mfma_f32_16x16x32_bf16 v[124:127], v[160:163], a[80:83], v[124:127]
buffer_load_dwordx4 a[116:119], v3, s[88:91], s101 offen offset:1024 sc1
v_mfma_f32_16x16x32_bf16 v[128:131], v[168:171], a[80:83], v[128:131]
ds_read_b64_tr_b16 v[200:201], v4 offset:16640
ds_read_b64_tr_b16 v[202:203], v4 offset:20736
v_mfma_f32_16x16x32_bf16 v[128:131], v[172:175], a[88:91], v[128:131]
ds_read_b64_tr_b16 v[204:205], v4 offset:24832
s_add_u32 s62, s61, s12
v_mfma_f32_16x16x32_bf16 v[144:147], v[172:175], a[92:95], v[144:147]
ds_read_b64_tr_b16 v[206:207], v4 offset:28928
s_add_u32 s101, s101, 0x2000
v_mfma_f32_16x16x32_bf16 v[144:147], v[168:171], a[84:87], v[144:147]
buffer_load_dwordx4 a[120:123], v3, s[88:91], s101 offen sc1
v_mfma_f32_16x16x32_bf16 v[148:151], v[176:179], a[84:87], v[148:151]
ds_read_b64_tr_b16 v[208:209], v5 offset:16640
ds_read_b64_tr_b16 v[210:211], v5 offset:20736
v_mfma_f32_16x16x32_bf16 v[148:151], v[180:183], a[92:95], v[148:151]
ds_read_b64_tr_b16 v[212:213], v5 offset:24832
s_waitcnt vmcnt(7) lgkmcnt(7)
v_mfma_f32_16x16x32_bf16 v[132:135], v[180:183], a[88:91], v[132:135]
ds_read_b64_tr_b16 v[214:215], v5 offset:28928
s_barrier
v_mfma_f32_16x16x32_bf16 v[132:135], v[176:179], a[80:83], v[132:135]
buffer_load_dwordx4 a[124:127], v3, s[88:91], s101 offen offset:1024 sc1
buffer_load_dword v14, v20, s[88:91], s24 offen sc1
v_mfma_f32_16x16x32_bf16 v[88:91], v[184:187], a[80:83], v[88:91]
ds_read_b64_tr_b16 v[152:153], v6 offset:512
ds_read_b64_tr_b16 v[154:155], v6 offset:4608
v_mfma_f32_16x16x32_bf16 v[88:91], v[188:191], a[88:91], v[88:91]
ds_read_b64_tr_b16 v[156:157], v6 offset:8704
s_add_u32 s101, s63, s60
v_mfma_f32_16x16x32_bf16 v[104:107], v[188:191], a[92:95], v[104:107]
ds_read_b64_tr_b16 v[158:159], v6 offset:12800
s_add_u32 m0, s17, 0x10000
v_mfma_f32_16x16x32_bf16 v[104:107], v[184:187], a[84:87], v[104:107]
buffer_load_dwordx4 v12, s[64:67], s61 offen lds
v_mfma_f32_16x16x32_bf16 v[108:111], v[192:195], a[84:87], v[108:111]
ds_read_b64_tr_b16 v[160:161], v7 offset:512
ds_read_b64_tr_b16 v[162:163], v7 offset:4608
v_mfma_f32_16x16x32_bf16 v[108:111], v[196:199], a[92:95], v[108:111]
ds_read_b64_tr_b16 v[164:165], v7 offset:8704
s_sub_u32 s15, s15, 1
v_mfma_f32_16x16x32_bf16 v[92:95], v[196:199], a[88:91], v[92:95]
ds_read_b64_tr_b16 v[166:167], v7 offset:12800
s_waitcnt lgkmcnt(8)
v_mfma_f32_16x16x32_bf16 v[92:95], v[192:195], a[80:83], v[92:95]
buffer_load_dwordx4 v13, s[64:67], s61 offen offset:1024 lds
v_mfma_f32_16x16x32_bf16 v[96:99], v[200:203], a[80:83], v[96:99]
ds_read_b64_tr_b16 v[168:169], v6 offset:768
ds_read_b64_tr_b16 v[170:171], v6 offset:4864
v_mfma_f32_16x16x32_bf16 v[96:99], v[204:207], a[88:91], v[96:99]
ds_read_b64_tr_b16 v[172:173], v6 offset:8960
v_mfma_f32_16x16x32_bf16 v[112:115], v[204:207], a[92:95], v[112:115]
ds_read_b64_tr_b16 v[174:175], v6 offset:13056
v_mfma_f32_16x16x32_bf16 v[112:115], v[200:203], a[84:87], v[112:115]
buffer_load_dwordx4 v12, s[64:67], s62 offen offset:2048 lds
v_mfma_f32_16x16x32_bf16 v[116:119], v[208:211], a[84:87], v[116:119]
ds_read_b64_tr_b16 v[176:177], v7 offset:768
ds_read_b64_tr_b16 v[178:179], v7 offset:4864
v_mfma_f32_16x16x32_bf16 v[116:119], v[212:215], a[92:95], v[116:119]
ds_read_b64_tr_b16 v[180:181], v7 offset:8960
s_waitcnt lgkmcnt(7)
v_mfma_f32_16x16x32_bf16 v[100:103], v[212:215], a[88:91], v[100:103]
ds_read_b64_tr_b16 v[182:183], v7 offset:13056
v_mfma_f32_16x16x32_bf16 v[100:103], v[208:211], a[80:83], v[100:103]
buffer_load_dwordx4 v13, s[64:67], s62 offen offset:3072 lds
v_mfma_f32_16x16x32_bf16 v[120:123], v[152:155], a[96:99], v[120:123]
ds_read_b64_tr_b16 v[184:185], v6 offset:0
ds_read_b64_tr_b16 v[186:187], v6 offset:4096
v_mfma_f32_16x16x32_bf16 v[120:123], v[156:159], a[104:107], v[120:123]
ds_read_b64_tr_b16 v[188:189], v6 offset:8192
s_add_u32 s60, s60, s59
v_mfma_f32_16x16x32_bf16 v[136:139], v[156:159], a[108:111], v[136:139]
ds_read_b64_tr_b16 v[190:191], v6 offset:12288
s_and_b32 s60, s60, 0x7c000
v_mfma_f32_16x16x32_bf16 v[136:139], v[152:155], a[100:103], v[136:139]
buffer_load_dwordx4 a[64:67], v3, s[88:91], s101 offen sc1
v_mfma_f32_16x16x32_bf16 v[140:143], v[160:163], a[100:103], v[140:143]
ds_read_b64_tr_b16 v[192:193], v7 offset:0
ds_read_b64_tr_b16 v[194:195], v7 offset:4096
v_mfma_f32_16x16x32_bf16 v[140:143], v[164:167], a[108:111], v[140:143]
ds_read_b64_tr_b16 v[196:197], v7 offset:8192
s_lshl_b32 s61, s60, 3
v_mfma_f32_16x16x32_bf16 v[124:127], v[164:167], a[104:107], v[124:127]
ds_read_b64_tr_b16 v[198:199], v7 offset:12288
s_waitcnt lgkmcnt(8)
v_mfma_f32_16x16x32_bf16 v[124:127], v[160:163], a[96:99], v[124:127]
buffer_load_dwordx4 a[68:71], v3, s[88:91], s101 offen offset:1024 sc1
v_mfma_f32_16x16x32_bf16 v[128:131], v[168:171], a[96:99], v[128:131]
ds_read_b64_tr_b16 v[200:201], v6 offset:256
ds_read_b64_tr_b16 v[202:203], v6 offset:4352
v_mfma_f32_16x16x32_bf16 v[128:131], v[172:175], a[104:107], v[128:131]
ds_read_b64_tr_b16 v[204:205], v6 offset:8448
s_add_u32 s62, s61, s12
v_mfma_f32_16x16x32_bf16 v[144:147], v[172:175], a[108:111], v[144:147]
ds_read_b64_tr_b16 v[206:207], v6 offset:12544
s_add_u32 s101, s101, 0x2000
v_mfma_f32_16x16x32_bf16 v[144:147], v[168:171], a[100:103], v[144:147]
buffer_load_dwordx4 a[72:75], v3, s[88:91], s101 offen sc1
v_mfma_f32_16x16x32_bf16 v[148:151], v[176:179], a[100:103], v[148:151]
ds_read_b64_tr_b16 v[208:209], v7 offset:256
ds_read_b64_tr_b16 v[210:211], v7 offset:4352
v_mfma_f32_16x16x32_bf16 v[148:151], v[180:183], a[108:111], v[148:151]
ds_read_b64_tr_b16 v[212:213], v7 offset:8448
s_waitcnt vmcnt(7) lgkmcnt(7)
v_mfma_f32_16x16x32_bf16 v[132:135], v[180:183], a[104:107], v[132:135]
ds_read_b64_tr_b16 v[214:215], v7 offset:12544
s_barrier
v_mfma_f32_16x16x32_bf16 v[132:135], v[176:179], a[96:99], v[132:135]
buffer_load_dwordx4 a[76:79], v3, s[88:91], s101 offen offset:1024 sc1
v_cmp_ne_u32 vcc, 1, v14
s_cmp_lg_u32 s15, 0
s_cbranch_scc0 L_p4_exit
s_cbranch_vccz L_p4_loop
s_mov_b32 s92, 200000
L_spin_d:
v_cmp_ne_u32 vcc, 1, v14
s_nop 4
s_cbranch_vccz L_spun_d
s_sub_u32 s92, s92, 1
s_cbranch_scc1 L_spun_d
s_sleep 6
buffer_load_dword v14, v20, s[88:91], s24 offen sc1
s_waitcnt vmcnt(0)
s_branch L_spin_d
L_spun_d:
s_branch L_p4_loop
L_p4_exit:
s_add_u32 s101, s63, s60
v_mfma_f32_16x16x32_bf16 v[88:91], v[184:187], a[96:99], v[88:91]
ds_read_b64_tr_b16 v[152:153], v6 offset:16896
ds_read_b64_tr_b16 v[154:155], v6 offset:20992
s_add_u32 m0, s17, 0x14000
v_mfma_f32_16x16x32_bf16 v[88:91], v[188:191], a[104:107], v[88:91]
buffer_load_dwordx4 v12, s[64:67], s61 offen lds
v_mfma_f32_16x16x32_bf16 v[104:107], v[188:191], a[108:111], v[104:107]
ds_read_b64_tr_b16 v[156:157], v6 offset:25088
ds_read_b64_tr_b16 v[158:159], v6 offset:29184
v_mfma_f32_16x16x32_bf16 v[104:107], v[184:187], a[100:103], v[104:107]
buffer_load_dwordx4 v13, s[64:67], s61 offen offset:1024 lds
v_mfma_f32_16x16x32_bf16 v[108:111], v[192:195], a[100:103], v[108:111]
ds_read_b64_tr_b16 v[160:161], v7 offset:16896
ds_read_b64_tr_b16 v[162:163], v7 offset:20992
v_mfma_f32_16x16x32_bf16 v[108:111], v[196:199], a[108:111], v[108:111]
buffer_load_dwordx4 v12, s[64:67], s62 offen offset:2048 lds
v_mfma_f32_16x16x32_bf16 v[92:95], v[196:199], a[104:107], v[92:95]
ds_read_b64_tr_b16 v[164:165], v7 offset:25088
ds_read_b64_tr_b16 v[166:167], v7 offset:29184
s_waitcnt lgkmcnt(8)
v_mfma_f32_16x16x32_bf16 v[92:95], v[192:195], a[96:99], v[92:95]
buffer_load_dwordx4 v13, s[64:67], s62 offen offset:3072 lds
v_mfma_f32_16x16x32_bf16 v[96:99], v[200:203], a[96:99], v[96:99]
ds_read_b64_tr_b16 v[168:169], v6 offset:17152
ds_read_b64_tr_b16 v[170:171], v6 offset:21248
v_mfma_f32_16x16x32_bf16 v[96:99], v[204:207], a[104:107], v[96:99]
buffer_load_dwordx4 a[80:83], v3, s[88:91], s101 offen sc1
v_mfma_f32_16x16x32_bf16 v[112:115], v[204:207], a[108:111], v[112:115]
ds_read_b64_tr_b16 v[172:173], v6 offset:25344
ds_read_b64_tr_b16 v[174:175], v6 offset:29440
v_mfma_f32_16x16x32_bf16 v[112:115], v[200:203], a[100:103], v[112:115]
buffer_load_dwordx4 a[84:87], v3, s[88:91], s101 offen offset:1024 sc1
v_mfma_f32_16x16x32_bf16 v[116:119], v[208:211], a[100:103], v[116:119]
ds_read_b64_tr_b16 v[176:177], v7 offset:17152
ds_read_b64_tr_b16 v[178:179], v7 offset:21248
s_add_u32 s101, s101, 0x2000
v_mfma_f32_16x16x32_bf16 v[116:119], v[212:215], a[108:111], v[116:119]
buffer_load_dwordx4 a[88:91], v3, s[88:91], s101 offen sc1
s_waitcnt vmcnt(7) lgkmcnt(6)
v_mfma_f32_16x16x32_bf16 v[100:103], v[212:215], a[104:107], v[100:103]
ds_read_b64_tr_b16 v[180:181], v7 offset:25344
ds_read_b64_tr_b16 v[182:183], v7 offset:29440
s_barrier
v_mfma_f32_16x16x32_bf16 v[100:103], v[208:211], a[96:99], v[100:103]
buffer_load_dwordx4 a[92:95], v3, s[88:91], s101 offen offset:1024 sc1
v_mfma_f32_16x16x32_bf16 v[120:123], v[152:155], a[112:115], v[120:123]
ds_read_b64_tr_b16 v[184:185], v4 offset:512
v_sub_f32 v10, 1.0, v8
v_mfma_f32_16x16x32_bf16 v[120:123], v[156:159], a[120:123], v[120:123]
ds_read_b64_tr_b16 v[186:187], v4 offset:4608
v_sub_f32 v11, 1.0, v9
v_mfma_f32_16x16x32_bf16 v[136:139], v[156:159], a[124:127], v[136:139]
ds_read_b64_tr_b16 v[188:189], v4 offset:8704
v_mul_f32 v56, v10, v56
v_mfma_f32_16x16x32_bf16 v[136:139], v[152:155], a[116:119], v[136:139]
ds_read_b64_tr_b16 v[190:191], v4 offset:12800
v_mul_f32 v57, v10, v57
v_mfma_f32_16x16x32_bf16 v[140:143], v[160:163], a[116:119], v[140:143]
ds_read_b64_tr_b16 v[192:193], v5 offset:512
v_mul_f32 v58, v10, v58
v_mfma_f32_16x16x32_bf16 v[140:143], v[164:167], a[124:127], v[140:143]
ds_read_b64_tr_b16 v[194:195], v5 offset:4608
v_mul_f32 v59, v10, v59
v_mfma_f32_16x16x32_bf16 v[124:127], v[164:167], a[120:123], v[124:127]
ds_read_b64_tr_b16 v[196:197], v5 offset:8704
s_waitcnt lgkmcnt(7)
v_mfma_f32_16x16x32_bf16 v[124:127], v[160:163], a[112:115], v[124:127]
ds_read_b64_tr_b16 v[198:199], v5 offset:12800
v_mul_f32 v60, v10, v60
v_mfma_f32_16x16x32_bf16 v[128:131], v[168:171], a[112:115], v[128:131]
ds_read_b64_tr_b16 v[200:201], v4 offset:768
v_mul_f32 v61, v10, v61
v_mfma_f32_16x16x32_bf16 v[128:131], v[172:175], a[120:123], v[128:131]
ds_read_b64_tr_b16 v[202:203], v4 offset:4864
v_mul_f32 v62, v10, v62
v_mfma_f32_16x16x32_bf16 v[144:147], v[172:175], a[124:127], v[144:147]
ds_read_b64_tr_b16 v[204:205], v4 offset:8960
v_mul_f32 v63, v10, v63
v_mfma_f32_16x16x32_bf16 v[144:147], v[168:171], a[116:119], v[144:147]
ds_read_b64_tr_b16 v[206:207], v4 offset:13056
v_mul_f32 v64, v10, v64
v_mfma_f32_16x16x32_bf16 v[148:151], v[176:179], a[116:119], v[148:151]
ds_read_b64_tr_b16 v[208:209], v5 offset:768
v_mul_f32 v65, v10, v65
v_mfma_f32_16x16x32_bf16 v[148:151], v[180:183], a[124:127], v[148:151]
ds_read_b64_tr_b16 v[210:211], v5 offset:4864
s_waitcnt vmcnt(0) lgkmcnt(6)
v_mfma_f32_16x16x32_bf16 v[132:135], v[180:183], a[120:123], v[132:135]
ds_read_b64_tr_b16 v[212:213], v5 offset:8960
s_barrier
v_mfma_f32_16x16x32_bf16 v[132:135], v[176:179], a[112:115], v[132:135]
ds_read_b64_tr_b16 v[214:215], v5 offset:13056
v_mul_f32 v66, v10, v66
v_mul_f32 v67, v10, v67
v_mfma_f32_16x16x32_bf16 v[120:123], v[184:187], a[64:67], v[120:123]
ds_read_b64_tr_b16 v[152:153], v4 offset:16896
v_mul_f32 v68, v10, v68
v_mfma_f32_16x16x32_bf16 v[120:123], v[188:191], a[72:75], v[120:123]
ds_read_b64_tr_b16 v[154:155], v4 offset:20992
v_mul_f32 v69, v10, v69
v_mfma_f32_16x16x32_bf16 v[136:139], v[188:191], a[76:79], v[136:139]
ds_read_b64_tr_b16 v[156:157], v4 offset:25088
v_mul_f32 v70, v10, v70
v_mfma_f32_16x16x32_bf16 v[136:139], v[184:187], a[68:71], v[136:139]
ds_read_b64_tr_b16 v[158:159], v4 offset:29184
v_mul_f32 v71, v10, v71
v_mfma_f32_16x16x32_bf16 v[140:143], v[192:195], a[68:71], v[140:143]
ds_read_b64_tr_b16 v[160:161], v5 offset:16896
v_mul_f32 v72, v11, v72
v_mfma_f32_16x16x32_bf16 v[140:143], v[196:199], a[76:79], v[140:143]
ds_read_b64_tr_b16 v[162:163], v5 offset:20992
v_mul_f32 v73, v11, v73
v_mfma_f32_16x16x32_bf16 v[124:127], v[196:199], a[72:75], v[124:127]
ds_read_b64_tr_b16 v[164:165], v5 offset:25088
s_waitcnt lgkmcnt(7)
v_mfma_f32_16x16x32_bf16 v[124:127], v[192:195], a[64:67], v[124:127]
ds_read_b64_tr_b16 v[166:167], v5 offset:29184
v_mul_f32 v74, v11, v74
v_mfma_f32_16x16x32_bf16 v[128:131], v[200:203], a[64:67], v[128:131]
ds_read_b64_tr_b16 v[168:169], v4 offset:17152
v_mul_f32 v75, v11, v75
v_mfma_f32_16x16x32_bf16 v[128:131], v[204:207], a[72:75], v[128:131]
ds_read_b64_tr_b16 v[170:171], v4 offset:21248
v_mul_f32 v76, v11, v76
v_mfma_f32_16x16x32_bf16 v[144:147], v[204:207], a[76:79], v[144:147]
ds_read_b64_tr_b16 v[172:173], v4 offset:25344
v_mul_f32 v77, v11, v77
v_mfma_f32_16x16x32_bf16 v[144:147], v[200:203], a[68:71], v[144:147]
ds_read_b64_tr_b16 v[174:175], v4 offset:29440
v_mul_f32 v78, v11, v78
v_mfma_f32_16x16x32_bf16 v[148:151], v[208:211], a[68:71], v[148:151]
ds_read_b64_tr_b16 v[176:177], v5 offset:17152
v_mul_f32 v79, v11, v79
v_mfma_f32_16x16x32_bf16 v[148:151], v[212:215], a[76:79], v[148:151]
ds_read_b64_tr_b16 v[178:179], v5 offset:21248
s_waitcnt lgkmcnt(6)
v_mfma_f32_16x16x32_bf16 v[132:135], v[212:215], a[72:75], v[132:135]
ds_read_b64_tr_b16 v[180:181], v5 offset:25344
v_mul_f32 v80, v11, v80
v_mfma_f32_16x16x32_bf16 v[132:135], v[208:211], a[64:67], v[132:135]
ds_read_b64_tr_b16 v[182:183], v5 offset:29440
v_mul_f32 v81, v11, v81
v_mfma_f32_16x16x32_bf16 v[120:123], v[152:155], a[80:83], v[120:123]
ds_read_b64_tr_b16 v[184:185], v6 offset:16384
v_mul_f32 v82, v11, v82
v_mfma_f32_16x16x32_bf16 v[120:123], v[156:159], a[88:91], v[120:123]
ds_read_b64_tr_b16 v[186:187], v6 offset:20480
v_mul_f32 v83, v11, v83
v_mfma_f32_16x16x32_bf16 v[136:139], v[156:159], a[92:95], v[136:139]
ds_read_b64_tr_b16 v[188:189], v6 offset:24576
v_mul_f32 v84, v11, v84
v_mfma_f32_16x16x32_bf16 v[136:139], v[152:155], a[84:87], v[136:139]
ds_read_b64_tr_b16 v[190:191], v6 offset:28672
v_mul_f32 v85, v11, v85
v_mfma_f32_16x16x32_bf16 v[140:143], v[160:163], a[84:87], v[140:143]
ds_read_b64_tr_b16 v[192:193], v7 offset:16384
v_mul_f32 v86, v11, v86
v_mfma_f32_16x16x32_bf16 v[140:143], v[164:167], a[92:95], v[140:143]
ds_read_b64_tr_b16 v[194:195], v7 offset:20480
v_mul_f32 v87, v11, v87
v_mfma_f32_16x16x32_bf16 v[124:127], v[164:167], a[88:91], v[124:127]
ds_read_b64_tr_b16 v[196:197], v7 offset:24576
s_waitcnt lgkmcnt(7)
v_mfma_f32_16x16x32_bf16 v[124:127], v[160:163], a[80:83], v[124:127]
ds_read_b64_tr_b16 v[198:199], v7 offset:28672
v_mul_f32 v24, v10, v24
v_mfma_f32_16x16x32_bf16 v[128:131], v[168:171], a[80:83], v[128:131]
ds_read_b64_tr_b16 v[200:201], v6 offset:16640
v_mul_f32 v25, v10, v25
v_mfma_f32_16x16x32_bf16 v[128:131], v[172:175], a[88:91], v[128:131]
ds_read_b64_tr_b16 v[202:203], v6 offset:20736
v_mul_f32 v26, v10, v26
v_mfma_f32_16x16x32_bf16 v[144:147], v[172:175], a[92:95], v[144:147]
ds_read_b64_tr_b16 v[204:205], v6 offset:24832
v_mul_f32 v27, v10, v27
v_mfma_f32_16x16x32_bf16 v[144:147], v[168:171], a[84:87], v[144:147]
ds_read_b64_tr_b16 v[206:207], v6 offset:28928
v_mul_f32 v28, v10, v28
v_mfma_f32_16x16x32_bf16 v[148:151], v[176:179], a[84:87], v[148:151]
ds_read_b64_tr_b16 v[208:209], v7 offset:16640
v_mul_f32 v29, v10, v29
v_mfma_f32_16x16x32_bf16 v[148:151], v[180:183], a[92:95], v[148:151]
ds_read_b64_tr_b16 v[210:211], v7 offset:20736
s_waitcnt lgkmcnt(6)
v_mfma_f32_16x16x32_bf16 v[132:135], v[180:183], a[88:91], v[132:135]
ds_read_b64_tr_b16 v[212:213], v7 offset:24832
v_mul_f32 v30, v10, v30
v_mfma_f32_16x16x32_bf16 v[132:135], v[176:179], a[80:83], v[132:135]
ds_read_b64_tr_b16 v[214:215], v7 offset:28928
v_mul_f32 v31, v10, v31
v_pk_fma_f32 v[56:57], v[120:121], v[8:9], v[56:57] op_sel_hi:[1,0,1]
v_pk_fma_f32 v[58:59], v[122:123], v[8:9], v[58:59] op_sel_hi:[1,0,1]
v_pk_fma_f32 v[60:61], v[124:125], v[8:9], v[60:61] op_sel_hi:[1,0,1]
v_pk_fma_f32 v[62:63], v[126:127], v[8:9], v[62:63] op_sel_hi:[1,0,1]
v_cvt_pk_bf16_f32 v56, v56, v57
v_cvt_pk_bf16_f32 v57, v58, v59
v_cvt_pk_bf16_f32 v58, v60, v61
v_cvt_pk_bf16_f32 v59, v62, v63
buffer_store_dwordx4 v[56:59], v3, s[88:91], s30 offen offset:0 sc1
v_pk_fma_f32 v[72:73], v[136:137], v[8:9], v[72:73] op_sel:[0,1,0] op_sel_hi:[1,1,1]
v_pk_fma_f32 v[74:75], v[138:139], v[8:9], v[74:75] op_sel:[0,1,0] op_sel_hi:[1,1,1]
v_pk_fma_f32 v[76:77], v[140:141], v[8:9], v[76:77] op_sel:[0,1,0] op_sel_hi:[1,1,1]
v_pk_fma_f32 v[78:79], v[142:143], v[8:9], v[78:79] op_sel:[0,1,0] op_sel_hi:[1,1,1]
v_cvt_pk_bf16_f32 v72, v72, v73
v_cvt_pk_bf16_f32 v73, v74, v75
v_cvt_pk_bf16_f32 v74, v76, v77
v_cvt_pk_bf16_f32 v75, v78, v79
buffer_store_dwordx4 v[72:75], v3, s[88:91], s30 offen offset:2048 sc1
v_pk_fma_f32 v[64:65], v[128:129], v[8:9], v[64:65] op_sel_hi:[1,0,1]
v_pk_fma_f32 v[66:67], v[130:131], v[8:9], v[66:67] op_sel_hi:[1,0,1]
v_pk_fma_f32 v[68:69], v[132:133], v[8:9], v[68:69] op_sel_hi:[1,0,1]
v_pk_fma_f32 v[70:71], v[134:135], v[8:9], v[70:71] op_sel_hi:[1,0,1]
v_cvt_pk_bf16_f32 v64, v64, v65
v_cvt_pk_bf16_f32 v65, v66, v67
v_cvt_pk_bf16_f32 v66, v68, v69
v_cvt_pk_bf16_f32 v67, v70, v71
buffer_store_dwordx4 v[64:67], v3, s[88:91], s30 offen offset:1024 sc1
v_pk_fma_f32 v[80:81], v[144:145], v[8:9], v[80:81] op_sel:[0,1,0] op_sel_hi:[1,1,1]
v_pk_fma_f32 v[82:83], v[146:147], v[8:9], v[82:83] op_sel:[0,1,0] op_sel_hi:[1,1,1]
v_pk_fma_f32 v[84:85], v[148:149], v[8:9], v[84:85] op_sel:[0,1,0] op_sel_hi:[1,1,1]
v_pk_fma_f32 v[86:87], v[150:151], v[8:9], v[86:87] op_sel:[0,1,0] op_sel_hi:[1,1,1]
v_cvt_pk_bf16_f32 v80, v80, v81
v_cvt_pk_bf16_f32 v81, v82, v83
v_cvt_pk_bf16_f32 v82, v84, v85
v_cvt_pk_bf16_f32 v83, v86, v87
buffer_store_dwordx4 v[80:83], v3, s[88:91], s30 offen offset:3072 sc1
v_mfma_f32_16x16x32_bf16 v[88:91], v[184:187], a[112:115], v[88:91]
ds_read_b64_tr_b16 v[152:153], v4 offset:0
v_mfma_f32_16x16x32_bf16 v[88:91], v[188:191], a[120:123], v[88:91]
ds_read_b64_tr_b16 v[154:155], v4 offset:4096
v_mfma_f32_16x16x32_bf16 v[104:107], v[188:191], a[124:127], v[104:107]
ds_read_b64_tr_b16 v[156:157], v4 offset:8192
v_mfma_f32_16x16x32_bf16 v[104:107], v[184:187], a[116:119], v[104:107]
ds_read_b64_tr_b16 v[158:159], v4 offset:12288
v_mfma_f32_16x16x32_bf16 v[108:111], v[192:195], a[116:119], v[108:111]
ds_read_b64_tr_b16 v[160:161], v5 offset:0
v_mfma_f32_16x16x32_bf16 v[108:111], v[196:199], a[124:127], v[108:111]
ds_read_b64_tr_b16 v[162:163], v5 offset:4096
v_mfma_f32_16x16x32_bf16 v[92:95], v[196:199], a[120:123], v[92:95]
ds_read_b64_tr_b16 v[164:165], v5 offset:8192
s_waitcnt lgkmcnt(7)
v_mfma_f32_16x16x32_bf16 v[92:95], v[192:195], a[112:115], v[92:95]
ds_read_b64_tr_b16 v[166:167], v5 offset:12288
v_mfma_f32_16x16x32_bf16 v[96:99], v[200:203], a[112:115], v[96:99]
ds_read_b64_tr_b16 v[168:169], v4 offset:256
v_mfma_f32_16x16x32_bf16 v[96:99], v[204:207], a[120:123], v[96:99]
ds_read_b64_tr_b16 v[170:171], v4 offset:4352
v_mfma_f32_16x16x32_bf16 v[112:115], v[204:207], a[124:127], v[112:115]
ds_read_b64_tr_b16 v[172:173], v4 offset:8448
v_mfma_f32_16x16x32_bf16 v[112:115], v[200:203], a[116:119], v[112:115]
ds_read_b64_tr_b16 v[174:175], v4 offset:12544
v_mfma_f32_16x16x32_bf16 v[116:119], v[208:211], a[116:119], v[116:119]
ds_read_b64_tr_b16 v[176:177], v5 offset:256
v_mfma_f32_16x16x32_bf16 v[116:119], v[212:215], a[124:127], v[116:119]
ds_read_b64_tr_b16 v[178:179], v5 offset:4352
s_waitcnt lgkmcnt(6)
v_mfma_f32_16x16x32_bf16 v[100:103], v[212:215], a[120:123], v[100:103]
ds_read_b64_tr_b16 v[180:181], v5 offset:8448
v_mfma_f32_16x16x32_bf16 v[100:103], v[208:211], a[112:115], v[100:103]
ds_read_b64_tr_b16 v[182:183], v5 offset:12544
v_mfma_f32_16x16x32_bf16 v[88:91], v[152:155], a[64:67], v[88:91]
ds_read_b64_tr_b16 v[184:185], v4 offset:16384
v_mul_f32 v32, v10, v32
v_mfma_f32_16x16x32_bf16 v[88:91], v[156:159], a[72:75], v[88:91]
ds_read_b64_tr_b16 v[186:187], v4 offset:20480
v_mul_f32 v33, v10, v33
v_mfma_f32_16x16x32_bf16 v[104:107], v[156:159], a[76:79], v[104:107]
ds_read_b64_tr_b16 v[188:189], v4 offset:24576
v_mul_f32 v34, v10, v34
v_mfma_f32_16x16x32_bf16 v[104:107], v[152:155], a[68:71], v[104:107]
ds_read_b64_tr_b16 v[190:191], v4 offset:28672
v_mul_f32 v35, v10, v35
v_mfma_f32_16x16x32_bf16 v[108:111], v[160:163], a[68:71], v[108:111]
ds_read_b64_tr_b16 v[192:193], v5 offset:16384
v_mul_f32 v36, v10, v36
v_mfma_f32_16x16x32_bf16 v[108:111], v[164:167], a[76:79], v[108:111]
ds_read_b64_tr_b16 v[194:195], v5 offset:20480
v_mul_f32 v37, v10, v37
v_mfma_f32_16x16x32_bf16 v[92:95], v[164:167], a[72:75], v[92:95]
ds_read_b64_tr_b16 v[196:197], v5 offset:24576
s_waitcnt lgkmcnt(7)
v_mfma_f32_16x16x32_bf16 v[92:95], v[160:163], a[64:67], v[92:95]
ds_read_b64_tr_b16 v[198:199], v5 offset:28672
v_mul_f32 v38, v10, v38
v_mfma_f32_16x16x32_bf16 v[96:99], v[168:171], a[64:67], v[96:99]
ds_read_b64_tr_b16 v[200:201], v4 offset:16640
v_mul_f32 v39, v10, v39
v_mfma_f32_16x16x32_bf16 v[96:99], v[172:175], a[72:75], v[96:99]
ds_read_b64_tr_b16 v[202:203], v4 offset:20736
v_mul_f32 v40, v11, v40
v_mfma_f32_16x16x32_bf16 v[112:115], v[172:175], a[76:79], v[112:115]
ds_read_b64_tr_b16 v[204:205], v4 offset:24832
v_mul_f32 v41, v11, v41
v_mfma_f32_16x16x32_bf16 v[112:115], v[168:171], a[68:71], v[112:115]
ds_read_b64_tr_b16 v[206:207], v4 offset:28928
v_mul_f32 v42, v11, v42
v_mfma_f32_16x16x32_bf16 v[116:119], v[176:179], a[68:71], v[116:119]
ds_read_b64_tr_b16 v[208:209], v5 offset:16640
v_mul_f32 v43, v11, v43
v_mfma_f32_16x16x32_bf16 v[116:119], v[180:183], a[76:79], v[116:119]
ds_read_b64_tr_b16 v[210:211], v5 offset:20736
s_waitcnt lgkmcnt(6)
v_mfma_f32_16x16x32_bf16 v[100:103], v[180:183], a[72:75], v[100:103]
ds_read_b64_tr_b16 v[212:213], v5 offset:24832
v_mul_f32 v44, v11, v44
v_mfma_f32_16x16x32_bf16 v[100:103], v[176:179], a[64:67], v[100:103]
ds_read_b64_tr_b16 v[214:215], v5 offset:28928
v_mul_f32 v45, v11, v45
v_mfma_f32_16x16x32_bf16 v[88:91], v[184:187], a[80:83], v[88:91]
v_mul_f32 v46, v11, v46
v_mul_f32 v47, v11, v47
v_mfma_f32_16x16x32_bf16 v[88:91], v[188:191], a[88:91], v[88:91]
v_mul_f32 v48, v11, v48
v_mul_f32 v49, v11, v49
v_mfma_f32_16x16x32_bf16 v[104:107], v[188:191], a[92:95], v[104:107]
v_mul_f32 v50, v11, v50
v_mul_f32 v51, v11, v51
v_mfma_f32_16x16x32_bf16 v[104:107], v[184:187], a[84:87], v[104:107]
v_mul_f32 v52, v11, v52
v_mul_f32 v53, v11, v53
v_mfma_f32_16x16x32_bf16 v[108:111], v[192:195], a[84:87], v[108:111]
v_mul_f32 v54, v11, v54
v_mul_f32 v55, v11, v55
v_mfma_f32_16x16x32_bf16 v[108:111], v[196:199], a[92:95], v[108:111]
v_mfma_f32_16x16x32_bf16 v[92:95], v[196:199], a[88:91], v[92:95]
s_waitcnt lgkmcnt(0)
v_mfma_f32_16x16x32_bf16 v[92:95], v[192:195], a[80:83], v[92:95]
v_mfma_f32_16x16x32_bf16 v[96:99], v[200:203], a[80:83], v[96:99]
v_mfma_f32_16x16x32_bf16 v[96:99], v[204:207], a[88:91], v[96:99]
v_mfma_f32_16x16x32_bf16 v[112:115], v[204:207], a[92:95], v[112:115]
v_mfma_f32_16x16x32_bf16 v[112:115], v[200:203], a[84:87], v[112:115]
v_mfma_f32_16x16x32_bf16 v[116:119], v[208:211], a[84:87], v[116:119]
v_mfma_f32_16x16x32_bf16 v[116:119], v[212:215], a[92:95], v[116:119]
v_mfma_f32_16x16x32_bf16 v[100:103], v[212:215], a[88:91], v[100:103]
v_mfma_f32_16x16x32_bf16 v[100:103], v[208:211], a[80:83], v[100:103]
buffer_load_dwordx4 v[152:155], v3, s[88:91], s28 offen offset:0 sc1
buffer_load_dwordx4 v[156:159], v3, s[88:91], s28 offen offset:1024 sc1
buffer_load_dwordx4 v[160:163], v3, s[88:91], s28 offen offset:2048 sc1
buffer_load_dwordx4 v[164:167], v3, s[88:91], s28 offen offset:3072 sc1
v_fmac_f32 v24, v8, v88
v_fmac_f32 v25, v8, v89
v_fmac_f32 v26, v8, v90
v_fmac_f32 v27, v8, v91
v_fmac_f32 v28, v8, v92
v_fmac_f32 v29, v8, v93
v_fmac_f32 v30, v8, v94
v_fmac_f32 v31, v8, v95
v_fmac_f32 v32, v8, v96
v_fmac_f32 v33, v8, v97
v_fmac_f32 v34, v8, v98
v_fmac_f32 v35, v8, v99
v_fmac_f32 v36, v8, v100
v_fmac_f32 v37, v8, v101
v_fmac_f32 v38, v8, v102
v_fmac_f32 v39, v8, v103
v_fmac_f32 v40, v9, v104
v_fmac_f32 v41, v9, v105
v_fmac_f32 v42, v9, v106
v_fmac_f32 v43, v9, v107
v_fmac_f32 v44, v9, v108
v_fmac_f32 v45, v9, v109
v_fmac_f32 v46, v9, v110
v_fmac_f32 v47, v9, v111
v_fmac_f32 v48, v9, v112
v_fmac_f32 v49, v9, v113
v_fmac_f32 v50, v9, v114
v_fmac_f32 v51, v9, v115
v_fmac_f32 v52, v9, v116
v_fmac_f32 v53, v9, v117
v_fmac_f32 v54, v9, v118
v_fmac_f32 v55, v9, v119
s_mov_b32 s92, 200000
L_spin_x:
s_waitcnt vmcnt(0)
v_max3_u32 v168, v152, v153, 0
v_max3_u32 v168, v154, v155, v168
v_max3_u32 v168, v156, v157, v168
v_max3_u32 v168, v158, v159, v168
v_max3_u32 v168, v160, v161, v168
v_max3_u32 v168, v162, v163, v168
v_max3_u32 v168, v164, v165, v168
v_max3_u32 v168, v166, v167, v168
v_cmp_eq_u32 vcc, -1, v168
s_sub_u32 s92, s92, 1
s_cbranch_scc1 L_spun_x
s_nop 3
s_cbranch_vccz L_spun_x
s_sleep 2
buffer_load_dwordx4 v[152:155], v3, s[88:91], s28 offen offset:0 sc1
buffer_load_dwordx4 v[156:159], v3, s[88:91], s28 offen offset:1024 sc1
buffer_load_dwordx4 v[160:163], v3, s[88:91], s28 offen offset:2048 sc1
buffer_load_dwordx4 v[164:167], v3, s[88:91], s28 offen offset:3072 sc1
s_branch L_spin_x
L_spun_x:
v_lshlrev_b32 v168, 16, v152
v_and_b32 v169, 0xffff0000, v152
v_pk_add_f32 v[24:25], v[24:25], v[168:169]
v_lshlrev_b32 v168, 16, v153
v_and_b32 v169, 0xffff0000, v153
v_pk_add_f32 v[26:27], v[26:27], v[168:169]
v_lshlrev_b32 v168, 16, v154
v_and_b32 v169, 0xffff0000, v154
v_pk_add_f32 v[28:29], v[28:29], v[168:169]
v_lshlrev_b32 v168, 16, v155
v_and_b32 v169, 0xffff0000, v155
v_pk_add_f32 v[30:31], v[30:31], v[168:169]
v_cvt_pk_bf16_f32 v24, v24, v25
v_cvt_pk_bf16_f32 v25, v26, v27
v_cvt_pk_bf16_f32 v26, v28, v29
v_cvt_pk_bf16_f32 v27, v30, v31
s_nop 1
v_permlane16_swap_b32 v24, v26
v_permlane16_swap_b32 v25, v27
buffer_store_dwordx4 v[24:27], v17, s[80:83], s29 offen offset:0 sc1
v_lshlrev_b32 v168, 16, v156
v_and_b32 v169, 0xffff0000, v156
v_pk_add_f32 v[32:33], v[32:33], v[168:169]
v_lshlrev_b32 v168, 16, v157
v_and_b32 v169, 0xffff0000, v157
v_pk_add_f32 v[34:35], v[34:35], v[168:169]
v_lshlrev_b32 v168, 16, v158
v_and_b32 v169, 0xffff0000, v158
v_pk_add_f32 v[36:37], v[36:37], v[168:169]
v_lshlrev_b32 v168, 16, v159
v_and_b32 v169, 0xffff0000, v159
v_pk_add_f32 v[38:39], v[38:39], v[168:169]
v_cvt_pk_bf16_f32 v32, v32, v33
v_cvt_pk_bf16_f32 v33, v34, v35
v_cvt_pk_bf16_f32 v34, v36, v37
v_cvt_pk_bf16_f32 v35, v38, v39
s_nop 1
v_permlane16_swap_b32 v32, v34
v_permlane16_swap_b32 v33, v35
buffer_store_dwordx4 v[32:35], v17, s[80:83], s29 offen offset:64 sc1
v_lshlrev_b32 v168, 16, v160
v_and_b32 v169, 0xffff0000, v160
v_pk_add_f32 v[40:41], v[40:41], v[168:169]
v_lshlrev_b32 v168, 16, v161
v_and_b32 v169, 0xffff0000, v161
v_pk_add_f32 v[42:43], v[42:43], v[168:169]
v_lshlrev_b32 v168, 16, v162
v_and_b32 v169, 0xffff0000, v162
v_pk_add_f32 v[44:45], v[44:45], v[168:169]
v_lshlrev_b32 v168, 16, v163
v_and_b32 v169, 0xffff0000, v163
v_pk_add_f32 v[46:47], v[46:47], v[168:169]
v_cvt_pk_bf16_f32 v40, v40, v41
v_cvt_pk_bf16_f32 v41, v42, v43
v_cvt_pk_bf16_f32 v42, v44, v45
v_cvt_pk_bf16_f32 v43, v46, v47
s_nop 1
v_permlane16_swap_b32 v40, v42
v_permlane16_swap_b32 v41, v43
buffer_store_dwordx4 v[40:43], v17, s[80:83], s31 offen offset:0 sc1
v_lshlrev_b32 v168, 16, v164
v_and_b32 v169, 0xffff0000, v164
v_pk_add_f32 v[48:49], v[48:49], v[168:169]
v_lshlrev_b32 v168, 16, v165
v_and_b32 v169, 0xffff0000, v165
v_pk_add_f32 v[50:51], v[50:51], v[168:169]
v_lshlrev_b32 v168, 16, v166
v_and_b32 v169, 0xffff0000, v166
v_pk_add_f32 v[52:53], v[52:53], v[168:169]
v_lshlrev_b32 v168, 16, v167
v_and_b32 v169, 0xffff0000, v167
v_pk_add_f32 v[54:55], v[54:55], v[168:169]
v_cvt_pk_bf16_f32 v48, v48, v49
v_cvt_pk_bf16_f32 v49, v50, v51
v_cvt_pk_bf16_f32 v50, v52, v53
v_cvt_pk_bf16_f32 v51, v54, v55
s_nop 1
v_permlane16_swap_b32 v48, v50
v_permlane16_swap_b32 v49, v51
buffer_store_dwordx4 v[48:51], v17, s[80:83], s31 offen offset:64 sc1
L_end:
s_endpgm
L_att_fallback:
s_waitcnt vmcnt(0)
s_mov_b32 s33, 1
s_mul_i32 s32, s5, 0x10c400
s_lshl_b32 s19, s4, 13
s_add_u32 s32, s32, s19
s_cmp_eq_u32 s4, 0
s_cselect_b32 s94, 0x200000, 0
s_add_u32 s32, s32, s94
s_sub_u32 s94, 0x8000, s94
s_add_u32 s7, s32, 0x1000
s_add_u32 s27, s19, 131072
v_and_b32 v5, 15, v0
v_lshrrev_b32 v6, 4, v0
v_lshlrev_b32 v6, 2, v6
v_sub_u32 v5, v5, v6
v_mov_b32 v9, 0xf149f2ca
s_lshr_b32 s8, s20, 11
v_add_u32 v96, s8, v5
v_mov_b32 v80, v9
s_lshr_b32 s8, s21, 11
v_add_u32 v97, s8, v5
v_mov_b32 v84, v9
s_lshr_b32 s8, s22, 11
v_add_u32 v98, s8, v5
v_mov_b32 v88, v9
s_lshr_b32 s8, s23, 11
v_add_u32 v99, s8, v5
v_mov_b32 v92, v9
s_sub_u32 s15, 16, s6
s_lshl_b32 s15, s15, 1
L_fb_loop:
s_waitcnt lgkmcnt(0)
s_barrier
s_add_u32 m0, s19, 0x0
s_nop 0
buffer_load_dwordx4 v3, s[48:51], s32 offen offset:0 sc1 lds
buffer_load_dwordx4 v3, s[48:51], s32 offen offset:1024 sc1 lds
buffer_load_dwordx4 v3, s[48:51], s32 offen offset:2048 sc1 lds
buffer_load_dwordx4 v3, s[48:51], s32 offen offset:3072 sc1 lds
s_add_u32 m0, s19, 0x1000
s_nop 0
buffer_load_dwordx4 v3, s[48:51], s7 offen offset:0 sc1 lds
buffer_load_dwordx4 v3, s[48:51], s7 offen offset:1024 sc1 lds
buffer_load_dwordx4 v3, s[48:51], s7 offen offset:2048 sc1 lds
buffer_load_dwordx4 v3, s[48:51], s7 offen offset:3072 sc1 lds
s_add_u32 s32, s32, s94
s_add_u32 s7, s7, s94
s_mov_b32 s94, 0x8000
s_waitcnt vmcnt(0)
s_barrier
ds_read_b128 a[0:3], v3 offset:8192
ds_read_b128 a[4:7], v3 offset:9216
ds_read_b128 a[8:11], v3 offset:10240
ds_read_b128 a[12:15], v3 offset:11264
ds_read_b128 a[16:19], v3 offset:12288
ds_read_b128 a[20:23], v3 offset:13312
ds_read_b128 a[24:27], v3 offset:14336
ds_read_b128 a[28:31], v3 offset:15360
s_waitcnt lgkmcnt(0)
v_mfma_f32_16x16x32_bf16 v[16:19], a[0:3], a[160:163], 0
v_mfma_f32_16x16x32_bf16 v[16:19], a[4:7], a[164:167], v[16:19]
v_mfma_f32_16x16x32_bf16 v[16:19], a[8:11], a[168:171], v[16:19]
v_mfma_f32_16x16x32_bf16 v[16:19], a[12:15], a[172:175], v[16:19]
v_mfma_f32_16x16x32_bf16 v[20:23], a[0:3], a[176:179], 0
v_mfma_f32_16x16x32_bf16 v[20:23], a[4:7], a[180:183], v[20:23]
v_mfma_f32_16x16x32_bf16 v[20:23], a[8:11], a[184:187], v[20:23]
v_mfma_f32_16x16x32_bf16 v[20:23], a[12:15], a[188:191], v[20:23]
v_mfma_f32_16x16x32_bf16 v[24:27], a[0:3], a[192:195], 0
v_mfma_f32_16x16x32_bf16 v[24:27], a[4:7], a[196:199], v[24:27]
v_mfma_f32_16x16x32_bf16 v[24:27], a[8:11], a[200:203], v[24:27]
v_mfma_f32_16x16x32_bf16 v[24:27], a[12:15], a[204:207], v[24:27]
v_mfma_f32_16x16x32_bf16 v[28:31], a[0:3], a[208:211], 0
v_mfma_f32_16x16x32_bf16 v[28:31], a[4:7], a[212:215], v[28:31]
v_mfma_f32_16x16x32_bf16 v[28:31], a[8:11], a[216:219], v[28:31]
v_mfma_f32_16x16x32_bf16 v[28:31], a[12:15], a[220:223], v[28:31]
v_mfma_f32_16x16x32_bf16 v[32:35], a[16:19], a[160:163], 0
v_mfma_f32_16x16x32_bf16 v[32:35], a[20:23], a[164:167], v[32:35]
v_mfma_f32_16x16x32_bf16 v[32:35], a[24:27], a[168:171], v[32:35]
v_mfma_f32_16x16x32_bf16 v[32:35], a[28:31], a[172:175], v[32:35]
v_mfma_f32_16x16x32_bf16 v[36:39], a[16:19], a[176:179], 0
v_mfma_f32_16x16x32_bf16 v[36:39], a[20:23], a[180:183], v[36:39]
v_mfma_f32_16x16x32_bf16 v[36:39], a[24:27], a[184:187], v[36:39]
v_mfma_f32_16x16x32_bf16 v[36:39], a[28:31], a[188:191], v[36:39]
v_mfma_f32_16x16x32_bf16 v[40:43], a[16:19], a[192:195], 0
v_mfma_f32_16x16x32_bf16 v[40:43], a[20:23], a[196:199], v[40:43]
v_mfma_f32_16x16x32_bf16 v[40:43], a[24:27], a[200:203], v[40:43]
v_mfma_f32_16x16x32_bf16 v[40:43], a[28:31], a[204:207], v[40:43]
v_mfma_f32_16x16x32_bf16 v[44:47], a[16:19], a[208:211], 0
v_mfma_f32_16x16x32_bf16 v[44:47], a[20:23], a[212:215], v[44:47]
v_mfma_f32_16x16x32_bf16 v[44:47], a[24:27], a[216:219], v[44:47]
v_mfma_f32_16x16x32_bf16 v[44:47], a[28:31], a[220:223], v[44:47]
s_nop 7
v_cmp_le_i32 s[36:37], 0, v96
v_cmp_le_i32 s[38:39], 1, v96
v_cmp_le_i32 s[40:41], 2, v96
v_cmp_le_i32 s[42:43], 3, v96
s_nop 1
v_cndmask_b32 v16, v9, v16, s[36:37]
v_cndmask_b32 v17, v9, v17, s[38:39]
v_cndmask_b32 v18, v9, v18, s[40:41]
v_cndmask_b32 v19, v9, v19, s[42:43]
v_max3_f32 v80, v80, v16, v17
v_max3_f32 v80, v80, v18, v19
v_cmp_le_i32 s[36:37], 0, v97
v_cmp_le_i32 s[38:39], 1, v97
v_cmp_le_i32 s[40:41], 2, v97
v_cmp_le_i32 s[42:43], 3, v97
s_nop 1
v_cndmask_b32 v20, v9, v20, s[36:37]
v_cndmask_b32 v21, v9, v21, s[38:39]
v_cndmask_b32 v22, v9, v22, s[40:41]
v_cndmask_b32 v23, v9, v23, s[42:43]
v_max3_f32 v84, v84, v20, v21
v_max3_f32 v84, v84, v22, v23
v_cmp_le_i32 s[36:37], 0, v98
v_cmp_le_i32 s[38:39], 1, v98
v_cmp_le_i32 s[40:41], 2, v98
v_cmp_le_i32 s[42:43], 3, v98
s_nop 1
v_cndmask_b32 v24, v9, v24, s[36:37]
v_cndmask_b32 v25, v9, v25, s[38:39]
v_cndmask_b32 v26, v9, v26, s[40:41]
v_cndmask_b32 v27, v9, v27, s[42:43]
v_max3_f32 v88, v88, v24, v25
v_max3_f32 v88, v88, v26, v27
v_cmp_le_i32 s[36:37], 0, v99
v_cmp_le_i32 s[38:39], 1, v99
v_cmp_le_i32 s[40:41], 2, v99
v_cmp_le_i32 s[42:43], 3, v99
s_nop 1
v_cndmask_b32 v28, v9, v28, s[36:37]
v_cndmask_b32 v29, v9, v29, s[38:39]
v_cndmask_b32 v30, v9, v30, s[40:41]
v_cndmask_b32 v31, v9, v31, s[42:43]
v_max3_f32 v92, v92, v28, v29
v_max3_f32 v92, v92, v30, v31
v_cmp_le_i32 s[36:37], 16, v96
v_cmp_le_i32 s[38:39], 17, v96
v_cmp_le_i32 s[40:41], 18, v96
v_cmp_le_i32 s[42:43], 19, v96
s_nop 1
v_cndmask_b32 v32, v9, v32, s[36:37]
v_cndmask_b32 v33, v9, v33, s[38:39]
v_cndmask_b32 v34, v9, v34, s[40:41]
v_cndmask_b32 v35, v9, v35, s[42:43]
v_max3_f32 v80, v80, v32, v33
v_max3_f32 v80, v80, v34, v35
v_cmp_le_i32 s[36:37], 16, v97
v_cmp_le_i32 s[38:39], 17, v97
v_cmp_le_i32 s[40:41], 18, v97
v_cmp_le_i32 s[42:43], 19, v97
s_nop 1
v_cndmask_b32 v36, v9, v36, s[36:37]
v_cndmask_b32 v37, v9, v37, s[38:39]
v_cndmask_b32 v38, v9, v38, s[40:41]
v_cndmask_b32 v39, v9, v39, s[42:43]
v_max3_f32 v84, v84, v36, v37
v_max3_f32 v84, v84, v38, v39
v_cmp_le_i32 s[36:37], 16, v98
v_cmp_le_i32 s[38:39], 17, v98
v_cmp_le_i32 s[40:41], 18, v98
v_cmp_le_i32 s[42:43], 19, v98
s_nop 1
v_cndmask_b32 v40, v9, v40, s[36:37]
v_cndmask_b32 v41, v9, v41, s[38:39]
v_cndmask_b32 v42, v9, v42, s[40:41]
v_cndmask_b32 v43, v9, v43, s[42:43]
v_max3_f32 v88, v88, v40, v41
v_max3_f32 v88, v88, v42, v43
v_cmp_le_i32 s[36:37], 16, v99
v_cmp_le_i32 s[38:39], 17, v99
v_cmp_le_i32 s[40:41], 18, v99
v_cmp_le_i32 s[42:43], 19, v99
s_nop 1
v_cndmask_b32 v44, v9, v44, s[36:37]
v_cndmask_b32 v45, v9, v45, s[38:39]
v_cndmask_b32 v46, v9, v46, s[40:41]
v_cndmask_b32 v47, v9, v47, s[42:43]
v_max3_f32 v92, v92, v44, v45
v_max3_f32 v92, v92, v46, v47
ds_read_b128 a[0:3], v3 offset:24576
ds_read_b128 a[4:7], v3 offset:25600
ds_read_b128 a[8:11], v3 offset:26624
ds_read_b128 a[12:15], v3 offset:27648
ds_read_b128 a[16:19], v3 offset:28672
ds_read_b128 a[20:23], v3 offset:29696
ds_read_b128 a[24:27], v3 offset:30720
ds_read_b128 a[28:31], v3 offset:31744
s_waitcnt lgkmcnt(0)
v_mfma_f32_16x16x32_bf16 v[16:19], a[0:3], a[160:163], 0
v_mfma_f32_16x16x32_bf16 v[16:19], a[4:7], a[164:167], v[16:19]
v_mfma_f32_16x16x32_bf16 v[16:19], a[8:11], a[168:171], v[16:19]
v_mfma_f32_16x16x32_bf16 v[16:19], a[12:15], a[172:175], v[16:19]
v_mfma_f32_16x16x32_bf16 v[20:23], a[0:3], a[176:179], 0
v_mfma_f32_16x16x32_bf16 v[20:23], a[4:7], a[180:183], v[20:23]
v_mfma_f32_16x16x32_bf16 v[20:23], a[8:11], a[184:187], v[20:23]
v_mfma_f32_16x16x32_bf16 v[20:23], a[12:15], a[188:191], v[20:23]
v_mfma_f32_16x16x32_bf16 v[24:27], a[0:3], a[192:195], 0
v_mfma_f32_16x16x32_bf16 v[24:27], a[4:7], a[196:199], v[24:27]
v_mfma_f32_16x16x32_bf16 v[24:27], a[8:11], a[200:203], v[24:27]
v_mfma_f32_16x16x32_bf16 v[24:27], a[12:15], a[204:207], v[24:27]
v_mfma_f32_16x16x32_bf16 v[28:31], a[0:3], a[208:211], 0
v_mfma_f32_16x16x32_bf16 v[28:31], a[4:7], a[212:215], v[28:31]
v_mfma_f32_16x16x32_bf16 v[28:31], a[8:11], a[216:219], v[28:31]
v_mfma_f32_16x16x32_bf16 v[28:31], a[12:15], a[220:223], v[28:31]
v_mfma_f32_16x16x32_bf16 v[32:35], a[16:19], a[160:163], 0
v_mfma_f32_16x16x32_bf16 v[32:35], a[20:23], a[164:167], v[32:35]
v_mfma_f32_16x16x32_bf16 v[32:35], a[24:27], a[168:171], v[32:35]
v_mfma_f32_16x16x32_bf16 v[32:35], a[28:31], a[172:175], v[32:35]
v_mfma_f32_16x16x32_bf16 v[36:39], a[16:19], a[176:179], 0
v_mfma_f32_16x16x32_bf16 v[36:39], a[20:23], a[180:183], v[36:39]
v_mfma_f32_16x16x32_bf16 v[36:39], a[24:27], a[184:187], v[36:39]
v_mfma_f32_16x16x32_bf16 v[36:39], a[28:31], a[188:191], v[36:39]
v_mfma_f32_16x16x32_bf16 v[40:43], a[16:19], a[192:195], 0
v_mfma_f32_16x16x32_bf16 v[40:43], a[20:23], a[196:199], v[40:43]
v_mfma_f32_16x16x32_bf16 v[40:43], a[24:27], a[200:203], v[40:43]
v_mfma_f32_16x16x32_bf16 v[40:43], a[28:31], a[204:207], v[40:43]
v_mfma_f32_16x16x32_bf16 v[44:47], a[16:19], a[208:211], 0
v_mfma_f32_16x16x32_bf16 v[44:47], a[20:23], a[212:215], v[44:47]
v_mfma_f32_16x16x32_bf16 v[44:47], a[24:27], a[216:219], v[44:47]
v_mfma_f32_16x16x32_bf16 v[44:47], a[28:31], a[220:223], v[44:47]
s_nop 7
v_cmp_le_i32 s[36:37], 32, v96
v_cmp_le_i32 s[38:39], 33, v96
v_cmp_le_i32 s[40:41], 34, v96
v_cmp_le_i32 s[42:43], 35, v96
s_nop 1
v_cndmask_b32 v16, v9, v16, s[36:37]
v_cndmask_b32 v17, v9, v17, s[38:39]
v_cndmask_b32 v18, v9, v18, s[40:41]
v_cndmask_b32 v19, v9, v19, s[42:43]
v_max3_f32 v80, v80, v16, v17
v_max3_f32 v80, v80, v18, v19
v_cmp_le_i32 s[36:37], 32, v97
v_cmp_le_i32 s[38:39], 33, v97
v_cmp_le_i32 s[40:41], 34, v97
v_cmp_le_i32 s[42:43], 35, v97
s_nop 1
v_cndmask_b32 v20, v9, v20, s[36:37]
v_cndmask_b32 v21, v9, v21, s[38:39]
v_cndmask_b32 v22, v9, v22, s[40:41]
v_cndmask_b32 v23, v9, v23, s[42:43]
v_max3_f32 v84, v84, v20, v21
v_max3_f32 v84, v84, v22, v23
v_cmp_le_i32 s[36:37], 32, v98
v_cmp_le_i32 s[38:39], 33, v98
v_cmp_le_i32 s[40:41], 34, v98
v_cmp_le_i32 s[42:43], 35, v98
s_nop 1
v_cndmask_b32 v24, v9, v24, s[36:37]
v_cndmask_b32 v25, v9, v25, s[38:39]
v_cndmask_b32 v26, v9, v26, s[40:41]
v_cndmask_b32 v27, v9, v27, s[42:43]
v_max3_f32 v88, v88, v24, v25
v_max3_f32 v88, v88, v26, v27
v_cmp_le_i32 s[36:37], 32, v99
v_cmp_le_i32 s[38:39], 33, v99
v_cmp_le_i32 s[40:41], 34, v99
v_cmp_le_i32 s[42:43], 35, v99
s_nop 1
v_cndmask_b32 v28, v9, v28, s[36:37]
v_cndmask_b32 v29, v9, v29, s[38:39]
v_cndmask_b32 v30, v9, v30, s[40:41]
v_cndmask_b32 v31, v9, v31, s[42:43]
v_max3_f32 v92, v92, v28, v29
v_max3_f32 v92, v92, v30, v31
v_cmp_le_i32 s[36:37], 48, v96
v_cmp_le_i32 s[38:39], 49, v96
v_cmp_le_i32 s[40:41], 50, v96
v_cmp_le_i32 s[42:43], 51, v96
s_nop 1
v_cndmask_b32 v32, v9, v32, s[36:37]
v_cndmask_b32 v33, v9, v33, s[38:39]
v_cndmask_b32 v34, v9, v34, s[40:41]
v_cndmask_b32 v35, v9, v35, s[42:43]
v_max3_f32 v80, v80, v32, v33
v_max3_f32 v80, v80, v34, v35
v_cmp_le_i32 s[36:37], 48, v97
v_cmp_le_i32 s[38:39], 49, v97
v_cmp_le_i32 s[40:41], 50, v97
v_cmp_le_i32 s[42:43], 51, v97
s_nop 1
v_cndmask_b32 v36, v9, v36, s[36:37]
v_cndmask_b32 v37, v9, v37, s[38:39]
v_cndmask_b32 v38, v9, v38, s[40:41]
v_cndmask_b32 v39, v9, v39, s[42:43]
v_max3_f32 v84, v84, v36, v37
v_max3_f32 v84, v84, v38, v39
v_cmp_le_i32 s[36:37], 48, v98
v_cmp_le_i32 s[38:39], 49, v98
v_cmp_le_i32 s[40:41], 50, v98
v_cmp_le_i32 s[42:43], 51, v98
s_nop 1
v_cndmask_b32 v40, v9, v40, s[36:37]
v_cndmask_b32 v41, v9, v41, s[38:39]
v_cndmask_b32 v42, v9, v42, s[40:41]
v_cndmask_b32 v43, v9, v43, s[42:43]
v_max3_f32 v88, v88, v40, v41
v_max3_f32 v88, v88, v42, v43
v_cmp_le_i32 s[36:37], 48, v99
v_cmp_le_i32 s[38:39], 49, v99
v_cmp_le_i32 s[40:41], 50, v99
v_cmp_le_i32 s[42:43], 51, v99
s_nop 1
v_cndmask_b32 v44, v9, v44, s[36:37]
v_cndmask_b32 v45, v9, v45, s[38:39]
v_cndmask_b32 v46, v9, v46, s[40:41]
v_cndmask_b32 v47, v9, v47, s[42:43]
v_max3_f32 v92, v92, v44, v45
v_max3_f32 v92, v92, v46, v47
v_subrev_u32 v96, 64, v96
v_subrev_u32 v97, 64, v97
v_subrev_u32 v98, 64, v98
v_subrev_u32 v99, 64, v99
s_sub_u32 s15, s15, 1
s_cmp_lg_u32 s15, 0
s_cbranch_scc1 L_fb_loop
v_mov_b32 v16, v80
v_mov_b32 v20, v84
v_mov_b32 v24, v88
v_mov_b32 v28, v92
v_permlane16_swap_b32 v16, v80
v_permlane16_swap_b32 v20, v84
v_permlane16_swap_b32 v24, v88
v_permlane16_swap_b32 v28, v92
v_max_f32 v80, v80, v16
v_max_f32 v84, v84, v20
v_max_f32 v88, v88, v24
v_max_f32 v92, v92, v28
v_mov_b32 v16, v80
v_mov_b32 v20, v84
v_mov_b32 v24, v88
v_mov_b32 v28, v92
v_permlane32_swap_b32 v16, v80
v_permlane32_swap_b32 v20, v84
v_permlane32_swap_b32 v24, v88
v_permlane32_swap_b32 v28, v92
v_max_f32 v80, v80, v16
v_max_f32 v84, v84, v20
v_max_f32 v88, v88, v24
v_max_f32 v92, v92, v28
s_barrier
s_mul_i32 s32, s5, 0x10c400
s_lshl_b32 s19, s4, 13
s_add_u32 s32, s32, s19
s_cmp_eq_u32 s4, 0
s_cselect_b32 s94, 0x200000, 0
s_add_u32 s32, s32, s94
s_sub_u32 s94, 0x8000, s94
s_add_u32 s7, s32, 0x1000
s_add_u32 s27, s19, 131072
s_add_u32 m0, s19, 0x0
s_nop 0
buffer_load_dwordx4 v3, s[48:51], s32 offen offset:0 sc1 lds
buffer_load_dwordx4 v3, s[48:51], s32 offen offset:1024 sc1 lds
buffer_load_dwordx4 v3, s[48:51], s32 offen offset:2048 sc1 lds
buffer_load_dwordx4 v3, s[48:51], s32 offen offset:3072 sc1 lds
s_add_u32 m0, s19, 0x1000
s_nop 0
buffer_load_dwordx4 v3, s[48:51], s7 offen offset:0 sc1 lds
buffer_load_dwordx4 v3, s[48:51], s7 offen offset:1024 sc1 lds
buffer_load_dwordx4 v3, s[48:51], s7 offen offset:2048 sc1 lds
buffer_load_dwordx4 v3, s[48:51], s7 offen offset:3072 sc1 lds
s_add_u32 s32, s32, s94
s_add_u32 s7, s7, s94
s_add_u32 m0, s19, 0x18000
s_nop 0
buffer_load_dwordx4 v3, s[48:51], s32 offen offset:0 sc1 lds
buffer_load_dwordx4 v3, s[48:51], s32 offen offset:1024 sc1 lds
buffer_load_dwordx4 v3, s[48:51], s32 offen offset:2048 sc1 lds
buffer_load_dwordx4 v3, s[48:51], s32 offen offset:3072 sc1 lds
s_add_u32 m0, s19, 0x19000
s_nop 0
buffer_load_dwordx4 v3, s[48:51], s7 offen offset:0 sc1 lds
buffer_load_dwordx4 v3, s[48:51], s7 offen offset:1024 sc1 lds
buffer_load_dwordx4 v3, s[48:51], s7 offen offset:2048 sc1 lds
buffer_load_dwordx4 v3, s[48:51], s7 offen offset:3072 sc1 lds
s_add_u32 s32, s32, 0x8000
s_add_u32 s7, s7, 0x8000
s_add_u32 m0, s19, 0x8000
s_nop 0
buffer_load_dwordx4 v3, s[48:51], s32 offen offset:0 sc1 lds
buffer_load_dwordx4 v3, s[48:51], s32 offen offset:1024 sc1 lds
buffer_load_dwordx4 v3, s[48:51], s32 offen offset:2048 sc1 lds
buffer_load_dwordx4 v3, s[48:51], s32 offen offset:3072 sc1 lds
s_add_u32 m0, s19, 0x9000
s_nop 0
buffer_load_dwordx4 v3, s[48:51], s7 offen offset:0 sc1 lds
buffer_load_dwordx4 v3, s[48:51], s7 offen offset:1024 sc1 lds
buffer_load_dwordx4 v3, s[48:51], s7 offen offset:2048 sc1 lds
buffer_load_dwordx4 v3, s[48:51], s7 offen offset:3072 sc1 lds
s_add_u32 s32, s32, 0x8000
s_add_u32 s7, s7, 0x8000
s_bfe_u32 s99, s2, 0x20001
s_lshl_b32 s99, s99, 2
s_lshr_b32 s8, s2, 6
s_add_u32 s99, s99, s8
s_bfe_u32 s100, s2, 0x30003
s_and_b32 s14, s2, 1
s_sub_u32 s24, 15, s99
s_min_u32 s18, s24, s99
s_lshl_b32 s24, s18, 1
s_add_u32 s24, s24, s14
s_lshl_b32 s24, s24, 8
s_add_u32 s24, s24, 0x3704000
s_mov_b32 s12, 14336
s_and_b32 s16, s6, 1
s_lshl_b32 s16, s16, 15
s_add_u32 s16, s16, 98304
s_add_u32 s16, s16, s17
s_lshl_b32 s13, s4, 15
s_lshl_b32 s9, s100, 8
s_add_u32 s13, s13, s9
s_mul_i32 s9, s14, 1310848
s_add_u32 s13, s13, s9
s_mul_i32 s25, s14, 3407872
s_sub_u32 s25, s25, 1179648
s_mul_i32 s101, s99, 0x142400
s_lshl_b32 s8, s4, 11
s_add_u32 s101, s101, s8
s_mul_i32 s8, s14, 163840
s_add_u32 s101, s101, s8
s_add_u32 s101, s101, 0x21fe000
s_mul_i32 s26, s14, 425984
s_add_u32 s26, s26, 106496
v_mov_b32 v15, s6
v_xor_b32 v15, 0, v15
v_writelane_b32 v15, s18, 0
v_lshlrev_b32 v15, 2, v15
v_bfe_u32 v12, v0, 2, 2
v_lshlrev_b32 v12, 11, v12
v_lshrrev_b32 v13, 4, v0
v_lshl_add_u32 v12, v13, 6, v12
v_and_b32 v13, 3, v0
v_lshl_add_u32 v12, v13, 4, v12
v_xor_b32 v12, s13, v12
v_xor_b32 v13, 32, v12
v_add_u32 v13, 7168, v13
s_mov_b32 s11, 0xf149f2ca
s_mov_b32 s36, 0xfff0ffff
s_mov_b32 s37, 0xf000ff00
s_mov_b32 s38, 0xffe0fffe
s_mov_b32 s39, 0xe000fe00
s_mov_b32 s40, 0xffc0fffc
s_mov_b32 s41, 0xc000fc00
s_mov_b32 s42, 0xff80fff8
s_mov_b32 s43, 0x8000f800
s_bitcmp1_b32 s4, 0
s_cselect_b32 s8, 0x7f800000, s11
s_cselect_b32 s9, s11, 0x7f800000
v_mov_b32 v1, v3
v_add_u32 v2, 98304, v3
s_mov_b64 s[34:35], 0
v_accvgpr_write_b32 a224, 0
v_accvgpr_write_b32 a225, 0
v_accvgpr_write_b32 a226, 0
v_accvgpr_write_b32 a227, 0
v_accvgpr_write_b32 a228, 0
v_accvgpr_write_b32 a229, 0
v_accvgpr_write_b32 a230, 0
v_accvgpr_write_b32 a231, 0
v_sub_f32 v83, 0, v80
v_sub_f32 v82, 0, v80
v_sub_f32 v81, 0, v80
v_sub_f32 v80, 0, v80
v_min_f32 v103, s8, v80
v_cndmask_b32 v96, v103, v80, s[36:37]
v_cndmask_b32 v97, v103, v80, s[38:39]
v_cndmask_b32 v98, v103, v80, s[40:41]
v_cndmask_b32 v99, v103, v80, s[42:43]
v_cndmask_b32 v100, v9, v103, s[36:37]
v_cndmask_b32 v101, v9, v103, s[38:39]
v_cndmask_b32 v102, v9, v103, s[40:41]
v_cndmask_b32 v103, v9, v103, s[42:43]
v_sub_f32 v87, 0, v84
v_sub_f32 v86, 0, v84
v_sub_f32 v85, 0, v84
v_sub_f32 v84, 0, v84
v_min_f32 v111, s9, v84
v_cndmask_b32 v104, v111, v84, s[36:37]
v_cndmask_b32 v105, v111, v84, s[38:39]
v_cndmask_b32 v106, v111, v84, s[40:41]
v_cndmask_b32 v107, v111, v84, s[42:43]
v_cndmask_b32 v108, v9, v111, s[36:37]
v_cndmask_b32 v109, v9, v111, s[38:39]
v_cndmask_b32 v110, v9, v111, s[40:41]
v_cndmask_b32 v111, v9, v111, s[42:43]
v_sub_f32 v91, 0, v88
v_sub_f32 v90, 0, v88
v_sub_f32 v89, 0, v88
v_sub_f32 v88, 0, v88
v_min_f32 v119, s8, v88
v_cndmask_b32 v112, v119, v88, s[36:37]
v_cndmask_b32 v113, v119, v88, s[38:39]
v_cndmask_b32 v114, v119, v88, s[40:41]
v_cndmask_b32 v115, v119, v88, s[42:43]
v_cndmask_b32 v116, v9, v119, s[36:37]
v_cndmask_b32 v117, v9, v119, s[38:39]
v_cndmask_b32 v118, v9, v119, s[40:41]
v_cndmask_b32 v119, v9, v119, s[42:43]
v_sub_f32 v95, 0, v92
v_sub_f32 v94, 0, v92
v_sub_f32 v93, 0, v92
v_sub_f32 v92, 0, v92
v_min_f32 v127, s9, v92
v_cndmask_b32 v120, v127, v92, s[36:37]
v_cndmask_b32 v121, v127, v92, s[38:39]
v_cndmask_b32 v122, v127, v92, s[40:41]
v_cndmask_b32 v123, v127, v92, s[42:43]
v_cndmask_b32 v124, v9, v127, s[36:37]
v_cndmask_b32 v125, v9, v127, s[38:39]
v_cndmask_b32 v126, v9, v127, s[40:41]
v_cndmask_b32 v127, v9, v127, s[42:43]
v_and_b32 v9, 1, v0
v_mul_u32_u24 v9, 0xaaaa, v9
v_add_u32 v9, 0x4444, v9
v_mov_b32 v128, 0
v_mov_b32 v129, 0
v_mov_b32 v130, 0
v_mov_b32 v131, 0
v_mov_b32 v132, 0
v_mov_b32 v133, 0
v_mov_b32 v134, 0
v_mov_b32 v135, 0
v_mov_b32 v136, 0
v_mov_b32 v137, 0
v_mov_b32 v138, 0
v_mov_b32 v139, 0
v_mov_b32 v140, 0
v_mov_b32 v141, 0
v_mov_b32 v142, 0
v_mov_b32 v143, 0
v_mov_b32 v144, 0
v_mov_b32 v145, 0
v_mov_b32 v146, 0
v_mov_b32 v147, 0
v_mov_b32 v148, 0
v_mov_b32 v149, 0
v_mov_b32 v150, 0
v_mov_b32 v151, 0
v_mov_b32 v152, 0
v_mov_b32 v153, 0
v_mov_b32 v154, 0
v_mov_b32 v155, 0
v_mov_b32 v156, 0
v_mov_b32 v157, 0
v_mov_b32 v158, 0
v_mov_b32 v159, 0
v_mov_b32 v160, 0
v_mov_b32 v161, 0
v_mov_b32 v162, 0
v_mov_b32 v163, 0
v_mov_b32 v164, 0
v_mov_b32 v165, 0
v_mov_b32 v166, 0
v_mov_b32 v167, 0
v_mov_b32 v168, 0
v_mov_b32 v169, 0
v_mov_b32 v170, 0
v_mov_b32 v171, 0
v_mov_b32 v172, 0
v_mov_b32 v173, 0
v_mov_b32 v174, 0
v_mov_b32 v175, 0
v_mov_b32 v176, 0
v_mov_b32 v177, 0
v_mov_b32 v178, 0
v_mov_b32 v179, 0
v_mov_b32 v180, 0
v_mov_b32 v181, 0
v_mov_b32 v182, 0
v_mov_b32 v183, 0
v_mov_b32 v184, 0
v_mov_b32 v185, 0
v_mov_b32 v186, 0
v_mov_b32 v187, 0
v_mov_b32 v188, 0
v_mov_b32 v189, 0
v_mov_b32 v190, 0
v_mov_b32 v191, 0
v_mov_b32 v192, 0
v_mov_b32 v193, 0
v_mov_b32 v194, 0
v_mov_b32 v195, 0
v_mov_b32 v196, 0
v_mov_b32 v197, 0
v_mov_b32 v198, 0
v_mov_b32 v199, 0
v_mov_b32 v200, 0
v_mov_b32 v201, 0
v_mov_b32 v202, 0
v_mov_b32 v203, 0
v_mov_b32 v204, 0
v_mov_b32 v205, 0
v_mov_b32 v206, 0
v_mov_b32 v207, 0
v_mov_b32 v208, 0
v_mov_b32 v209, 0
v_mov_b32 v210, 0
v_mov_b32 v211, 0
v_mov_b32 v212, 0
v_mov_b32 v213, 0
v_mov_b32 v214, 0
v_mov_b32 v215, 0
v_mov_b32 v216, 0
v_mov_b32 v217, 0
v_mov_b32 v218, 0
v_mov_b32 v219, 0
v_mov_b32 v220, 0
v_mov_b32 v221, 0
v_mov_b32 v222, 0
v_mov_b32 v223, 0
v_mov_b32 v224, 0
v_mov_b32 v225, 0
v_mov_b32 v226, 0
v_mov_b32 v227, 0
v_mov_b32 v228, 0
v_mov_b32 v229, 0
v_mov_b32 v230, 0
v_mov_b32 v231, 0
v_mov_b32 v232, 0
v_mov_b32 v233, 0
v_mov_b32 v234, 0
v_mov_b32 v235, 0
v_mov_b32 v236, 0
v_mov_b32 v237, 0
v_mov_b32 v238, 0
v_mov_b32 v239, 0
v_mov_b32 v240, 0
v_mov_b32 v241, 0
v_mov_b32 v242, 0
v_mov_b32 v243, 0
v_mov_b32 v244, 0
v_mov_b32 v245, 0
v_mov_b32 v246, 0
v_mov_b32 v247, 0
v_mov_b32 v248, 0
v_mov_b32 v249, 0
v_mov_b32 v250, 0
v_mov_b32 v251, 0
v_mov_b32 v252, 0
v_mov_b32 v253, 0
v_mov_b32 v254, 0
v_mov_b32 v255, 0
s_waitcnt vmcnt(16)
s_barrier
ds_read_b128 a[0:3], v1 offset:8192
ds_read_b128 a[4:7], v1 offset:9216
ds_read_b128 a[8:11], v1 offset:10240
ds_read_b128 a[12:15], v1 offset:11264
ds_read_b128 a[16:19], v1 offset:12288
ds_read_b128 a[20:23], v1 offset:13312
ds_read_b128 a[24:27], v1 offset:14336
ds_read_b128 a[28:31], v1 offset:15360
s_waitcnt lgkmcnt(0)
s_branch L_att_start
.section .rodata,"a"
.p2align 6
.amdhsa_kernel gated_mix__compressed_kv_cla__sliding_local_dilated__prompt_kernel
  .amdhsa_next_free_vgpr 512
  .amdhsa_next_free_sgpr 102
  .amdhsa_accum_offset 256
  .amdhsa_group_segment_fixed_size 0
  .amdhsa_kernarg_size 104
  .amdhsa_user_sgpr_count 2
  .amdhsa_user_sgpr_kernarg_segment_ptr 1
  .amdhsa_system_sgpr_workgroup_id_x 1
.end_amdhsa_kernel
```

```asm
; @launch grid=(256,1,1) block=(256,1,1) lds=163840
.amdgcn_target "amdgcn-amd-amdhsa--gfx950"
.text
.globl gated_mix__compressed_kv_cla__sliding_local_dilated__prompt_kernel
.p2align 8
.type gated_mix__compressed_kv_cla__sliding_local_dilated__prompt_kernel,@function
gated_mix__compressed_kv_cla__sliding_local_dilated__prompt_kernel:
s_load_dwordx16 s[16:31], s[0:1], 0
s_load_dwordx8 s[32:39], s[0:1], 64
s_load_dwordx2 s[88:89], s[0:1], 96
s_cmp_ge_u32 s2, 256
s_cbranch_scc1 L_end
v_lshrrev_b32 v1, 6, v0
v_and_b32 v0, 63, v0
v_readfirstlane_b32 s4, v1
v_lshlrev_b32 v16, 4, v0
s_lshr_b32 s8, s2, 3
s_lshl_b32 s8, s8, 2
s_add_u32 s8, s8, s4
s_min_u32 s8, s8, 101
s_lshl_b32 s8, s8, 10
s_getpc_b64 s[92:93]
L_here:
s_add_u32 s8, s8, L_page0-L_here
s_add_u32 s92, s92, s8
s_addc_u32 s93, s93, 0
v_add_u32 v60, s92, v16
v_mov_b32 v61, s93
global_load_dword a120, v[60:61], off sc1
s_and_b32 s5, s2, 7
s_lshl_b32 s5, s5, 2
s_lshr_b32 s5, 0x75643120, s5
s_and_b32 s5, s5, 7
s_lshl_b32 s5, s5, 2
s_bfe_u32 s3, s2, 0x20003
s_add_u32 s5, s5, s3
s_lshr_b32 s6, s2, 5
s_mov_b32 s12, 0x4000
s_mov_b32 s13, 0x8000
s_mov_b32 s14, 0xc000
s_mov_b32 s46, 0x400000
s_mov_b32 s47, 0x20000
s_mov_b32 s50, 0x200000
s_mov_b32 s51, 0x20000
s_mov_b32 s54, 0x800000
s_mov_b32 s55, 0x20000
s_mov_b32 s58, 0x400000
s_mov_b32 s59, 0x20000
s_mov_b32 s62, 0x400000
s_mov_b32 s63, 0x20000
s_mov_b32 s66, 0x800000
s_mov_b32 s67, 0x20000
s_mov_b32 s70, 0x600000
s_mov_b32 s71, 0x20000
s_mov_b32 s74, 0x200000
s_mov_b32 s75, 0x20000
s_mov_b32 s78, 0x800
s_mov_b32 s79, 0x20000
s_mov_b32 s82, 0x400000
s_mov_b32 s83, 0x20000
s_mov_b32 s86, 0x100
s_mov_b32 s87, 0x20000
s_mov_b32 s90, 0x10000000
s_mov_b32 s91, 0x20000
v_bfe_u32 v17, v0, 2, 2
s_lshl_b32 s8, s4, 4
v_add_u32 v17, s8, v17
v_lshlrev_b32 v17, 13, v17
v_lshrrev_b32 v18, 4, v0
v_lshl_add_u32 v17, v18, 6, v17
v_and_b32 v18, 3, v0
v_lshl_add_u32 v17, v18, 4, v17
s_lshl_b32 s8, s5, 8
v_add_u32 v5, s8, v17
v_xor_b32 v6, 32, v5
v_add_u32 v6, 0x10000, v6
v_lshrrev_b32 v17, 4, v0
v_xor_b32 v17, v17, v0
v_and_b32 v17, 7, v17
v_lshlrev_b32 v17, 4, v17
v_lshrrev_b32 v18, 3, v0
v_lshl_add_u32 v2, v18, 10, v17
s_lshl_b32 s8, s6, 18
s_lshl_b32 s9, s4, 16
s_add_u32 s8, s8, s9
v_add_u32 v2, s8, v2
v_xor_b32 v3, 64, v2
v_add_u32 v3, 0x2000, v3
s_mov_b32 s41, 0
s_mov_b32 s43, 0
v_lshl_add_u32 v5, s41, 19, v5
v_lshl_add_u32 v6, s41, 19, v6
v_lshl_add_u32 v2, s41, 7, v2
v_lshl_add_u32 v3, s41, 7, v3
s_sub_u32 s10, 15, s6
s_cmp_lt_u32 s5, 16
s_cselect_b32 s10, s6, s10
s_lshl_b32 s10, s10, 4
s_and_b32 s11, s5, 15
s_add_u32 s10, s10, s11
s_lshl_b32 s10, s10, 3
s_lshl_b32 s11, s4, 1
s_add_u32 s10, s10, s11
s_lshl_b32 s100, s10, 11
s_lshl_b32 s101, s10, 2
s_add_u32 s101, s101, 0x3700000
s_lshl_b32 s8, s2, 2
s_add_u32 s8, s8, s4
s_lshl_b32 s8, s8, 11
v_lshrrev_b32 v19, 2, v0
v_lshl_add_u32 v19, v19, 7, s8
s_lshr_b32 s8, s2, 3
s_lshl_b32 s8, s8, 2
s_add_u32 s8, s8, s4
s_lshl_b32 s8, s8, 4
s_lshr_b32 s9, s5, 2
s_add_u32 s8, s8, s9
s_lshl_b32 s8, s8, 10
v_bfe_u32 v63, v0, 2, 3
v_lshl_add_u32 v63, v63, 7, s8
v_lshrrev_b32 v59, 5, v0
v_lshl_add_u32 v63, v59, 13, v63
s_lshr_b32 s8, s8, 14
s_mul_i32 s8, s8, 49152
s_lshl_b32 s9, s9, 8
s_add_u32 s8, s8, s9
v_lshrrev_b32 v59, 3, v0
v_mul_u32_u24 v59, 0x1800, v59
v_and_b32 v1, 4, v0
v_lshl_add_u32 v1, v1, 5, v59
v_add_u32 v1, s8, v1
v_mov_b32 v62, v19
s_waitcnt lgkmcnt(0)
s_mov_b64 s[48:49], s[18:19]
s_mov_b64 s[56:57], s[22:23]
s_mov_b64 s[60:61], s[24:25]
L_args:
s_mov_b64 s[0:1], s[92:93]
s_mov_b64 s[44:45], s[16:17]
s_mov_b64 s[76:77], s[34:35]
s_mov_b64 s[52:53], s[20:21]
s_mov_b64 s[64:65], s[26:27]
s_mov_b64 s[68:69], s[30:31]
s_mov_b64 s[72:73], s[32:33]
s_mov_b64 s[80:81], s[36:37]
s_mov_b64 s[84:85], s[38:39]
s_lshl_b32 s16, s4, 13
s_add_u32 s16, s16, 0x18000
s_lshl_b32 s17, s4, 12
s_lshl_b32 s18, s4, 10
s_mov_b32 s25, 0x800
s_mov_b32 s26, 0x1000
s_mov_b32 s3, 0
s_mov_b32 s9, 0x0
s_nop 0
buffer_load_dword a120, v63, s[56:59], s9 offen
s_mov_b32 s9, 0x0
s_nop 0
buffer_load_dword a120, v63, s[60:63], s9 offen
s_add_u32 m0, s17, 0x0
s_nop 0
buffer_load_dwordx4 v5, s[56:59], 0 offen lds
s_add_u32 m0, s17, 0x4000
s_nop 0
buffer_load_dwordx4 v5, s[60:63], 0 offen lds
s_add_u32 m0, s17, 0x400
s_nop 0
buffer_load_dwordx4 v5, s[56:59], s13 offen lds
s_add_u32 m0, s17, 0x4400
s_nop 0
buffer_load_dwordx4 v5, s[60:63], s13 offen lds
s_add_u32 m0, s17, 0x800
s_nop 0
buffer_load_dwordx4 v6, s[56:59], 0 offen lds
s_add_u32 m0, s17, 0x4800
s_nop 0
buffer_load_dwordx4 v6, s[60:63], 0 offen lds
s_add_u32 m0, s17, 0xc00
s_nop 0
buffer_load_dwordx4 v6, s[56:59], s13 offen lds
s_add_u32 m0, s17, 0x4c00
s_nop 0
buffer_load_dwordx4 v6, s[60:63], s13 offen lds
s_mov_b32 s42, 1
s_mov_b32 s41, 7
v_lshl_add_u32 v5, s42, 19, v5
v_lshl_add_u32 v6, s42, 19, v6
s_add_u32 m0, s16, 0x0
s_nop 0
buffer_load_dwordx4 v2, s[48:51], 0 offen lds
s_add_u32 m0, s16, 0x400
s_nop 0
buffer_load_dwordx4 v3, s[48:51], 0 offen lds
s_add_u32 m0, s16, 0x800
s_nop 0
buffer_load_dwordx4 v2, s[48:51], s12 offen lds
s_add_u32 m0, s16, 0xc00
s_nop 0
buffer_load_dwordx4 v3, s[48:51], s12 offen lds
s_add_u32 m0, s16, 0x1000
s_nop 0
buffer_load_dwordx4 v2, s[48:51], s13 offen lds
s_add_u32 m0, s16, 0x1400
s_nop 0
buffer_load_dwordx4 v3, s[48:51], s13 offen lds
s_add_u32 m0, s16, 0x1800
s_nop 0
buffer_load_dwordx4 v2, s[48:51], s14 offen lds
s_add_u32 m0, s16, 0x1c00
s_nop 0
buffer_load_dwordx4 v3, s[48:51], s14 offen lds
v_lshl_add_u32 v2, s42, 7, v2
v_lshl_add_u32 v3, s42, 7, v3
v_lshrrev_b32 v17, 4, v0
v_xor_b32 v17, v17, v0
v_and_b32 v17, 7, v17
v_lshlrev_b32 v17, 4, v17
v_lshrrev_b32 v18, 3, v0
v_lshl_add_u32 v22, v18, 11, v17
v_xor_b32 v23, 64, v22
v_add_u32 v23, 0x4000, v23
s_lshl_b32 s8, s6, 18
s_sub_u32 s9, 15, s6
s_lshl_b32 s9, s9, 18
s_lshl_b32 s10, s4, 15
s_sub_u32 s11, 0x38000, s10
s_add_u32 s20, s8, s10
s_add_u32 s21, s8, s11
s_add_u32 s22, s9, s10
s_add_u32 s23, s9, s11
s_lshl_b32 s10, s5, 15
s_add_u32 s10, s10, 0x3c00000
s_lshr_b32 s8, s8, 7
s_lshr_b32 s9, s9, 7
s_add_u32 s8, s8, s10
s_add_u32 s9, s9, s10
v_add_u32 v10, s8, v16
v_add_u32 v11, s9, v16
s_cmp_lt_u32 s4, 2
s_cselect_b32 s8, s8, s9
s_and_b32 s9, s4, 1
s_lshl_b32 s9, s9, 10
s_add_u32 s8, s8, s9
v_add_u32 v4, s8, v16
v_lshrrev_b32 v17, 2, v0
s_lshl_b32 s8, s4, 4
v_add_u32 v17, s8, v17
v_mul_u32_u24 v17, 0x1800, v17
v_and_b32 v18, 3, v0
v_lshlrev_b32 v18, 4, v18
v_and_b32 v19, 32, v0
v_xor_b32 v18, v18, v19
s_lshl_b32 s8, s5, 6
v_add3_u32 v7, v17, v18, s8
v_lshl_add_u32 v22, s43, 7, v22
v_lshl_add_u32 v23, s43, 7, v23
v_lshl_add_u32 v7, s43, 18, v7
v_lshl_add_u32 v7, s43, 17, v7
v_and_b32 v17, 15, v0
v_lshrrev_b32 v18, 1, v17
v_lshrrev_b32 v19, 4, v0
v_xor_b32 v18, v18, v19
v_lshlrev_b32 v18, 4, v18
v_lshl_add_u32 v8, v17, 7, v18
v_add_u32 v8, s16, v8
v_xor_b32 v9, 64, v8
v_lshrrev_b32 v17, 4, v0
v_lshlrev_b32 v18, 11, v17
v_and_b32 v17, 1, v17
v_lshl_add_u32 v18, v17, 5, v18
v_bfe_u32 v17, v0, 2, 2
v_lshl_add_u32 v18, v17, 6, v18
v_and_b32 v17, 3, v0
v_lshl_add_u32 v12, v17, 3, v18
v_xor_b32 v13, 32, v12
v_lshrrev_b32 v17, 4, v0
v_lshlrev_b32 v18, 9, v17
v_and_b32 v17, 1, v17
v_lshl_add_u32 v18, v17, 5, v18
v_bfe_u32 v17, v0, 2, 2
v_lshl_add_u32 v18, v17, 6, v18
v_and_b32 v17, 3, v0
v_lshl_add_u32 v14, v17, 3, v18
v_accvgpr_write_b32 a64, -1
v_accvgpr_write_b32 a65, -1
v_accvgpr_write_b32 a66, -1
v_accvgpr_write_b32 a67, -1
v_add_u32 v14, 81920, v14
v_xor_b32 v15, 32, v14
s_mul_i32 s32, s5, 0x10c400
s_lshl_b32 s19, s4, 13
s_add_u32 s32, s32, s19
s_cmp_eq_u32 s4, 0
s_cselect_b32 s94, 0x200000, 0
s_add_u32 s32, s32, s94
s_sub_u32 s94, 0x8000, s94
s_add_u32 s7, s32, 0x1000
s_add_u32 s27, s19, 131072
s_add_u32 m0, s16, 0x8000
s_nop 0
buffer_load_dwordx4 v2, s[48:51], 0 offen lds
s_add_u32 m0, s16, 0x8400
s_nop 0
buffer_load_dwordx4 v3, s[48:51], 0 offen lds
s_add_u32 m0, s16, 0x8800
s_nop 0
buffer_load_dwordx4 v2, s[48:51], s12 offen lds
s_add_u32 m0, s16, 0x8c00
s_nop 0
buffer_load_dwordx4 v3, s[48:51], s12 offen lds
s_add_u32 m0, s16, 0x9000
s_nop 0
buffer_load_dwordx4 v2, s[48:51], s13 offen lds
s_add_u32 m0, s16, 0x9400
s_nop 0
buffer_load_dwordx4 v3, s[48:51], s13 offen lds
s_add_u32 m0, s16, 0x9800
s_nop 0
buffer_load_dwordx4 v2, s[48:51], s14 offen lds
s_add_u32 m0, s16, 0x9c00
s_nop 0
buffer_load_dwordx4 v3, s[48:51], s14 offen lds
v_lshl_add_u32 v2, s42, 7, v2
v_lshl_add_u32 v3, s42, 7, v3
s_mov_b32 s9, 0x0
s_nop 0
buffer_load_dword a120, v62, s[48:51], s9 offen
L_hopA:
s_mov_b32 s95, 1
s_cmp_eq_u32 s4, 0
s_cbranch_scc1 L_padA0
s_cmp_eq_u32 s4, 1
s_cbranch_scc1 L_padA1
s_cmp_eq_u32 s4, 2
s_cbranch_scc1 L_padA2
s_branch L_padA3
L_hopA_ret:
s_mov_b32 s95, 0
v_mov_b32 v19, v62
v_mov_b32 v18, v63
s_cmp_lg_u32 s4, 0
s_cbranch_scc1 L_flag_clr
s_lshl_b32 s8, s6, 5
s_add_u32 s8, s8, s5
s_and_b32 s92, s8, 0xf0
s_mul_i32 s92, s92, 3
s_add_u32 s8, s8, s92
s_lshl_b32 s8, s8, 2
s_add_u32 s8, s8, 0x3704000
v_mov_b32 v17, 0
s_mov_b64 exec, 1
buffer_store_dword v17, off, s[88:91], s8 sc1
s_mov_b64 exec, -1
L_flag_clr:
s_waitcnt vmcnt(9)
s_barrier
s_branch L_main
.p2align 12
L_page0:
L_padA0:
s_branch L_padA4
L_main:
ds_read_b64_tr_b16 a[80:81], v12 offset:0
ds_read_b64_tr_b16 a[82:83], v12 offset:1024
ds_read_b64_tr_b16 a[84:85], v12 offset:8192
ds_read_b64_tr_b16 a[86:87], v12 offset:9216
ds_read_b128 a[0:3], v8 offset:0
ds_read_b128 a[16:19], v9 offset:0
ds_read_b128 a[4:7], v8 offset:2048
ds_read_b128 a[20:23], v9 offset:2048
ds_read_b128 a[8:11], v8 offset:4096
ds_read_b128 a[24:27], v9 offset:4096
ds_read_b128 a[12:15], v8 offset:6144
ds_read_b128 a[28:31], v9 offset:6144
ds_read_b64_tr_b16 a[88:89], v13 offset:0
ds_read_b64_tr_b16 a[90:91], v13 offset:1024
ds_read_b64_tr_b16 a[92:93], v13 offset:8192
ds_read_b64_tr_b16 a[94:95], v13 offset:9216
ds_read_b64_tr_b16 a[96:97], v12 offset:256
ds_read_b64_tr_b16 a[98:99], v12 offset:1280
ds_read_b64_tr_b16 a[100:101], v12 offset:8448
ds_read_b64_tr_b16 a[102:103], v12 offset:9472
s_waitcnt lgkmcnt(0)
L_S0:
v_mfma_f32_16x16x32_bf16 v[24:27], a[80:83], a[0:3], 0
ds_read_b64_tr_b16 a[104:105], v13 offset:256
s_add_u32 m0, s17, 0x8000
v_mfma_f32_16x16x32_bf16 v[24:27], a[84:87], a[16:19], v[24:27]
buffer_load_dwordx4 v5, s[56:59], 0 offen lds
v_mfma_f32_16x16x32_bf16 v[32:35], a[84:87], a[20:23], 0
ds_read_b64_tr_b16 a[106:107], v13 offset:1280
v_mfma_f32_16x16x32_bf16 v[32:35], a[80:83], a[4:7], v[32:35]
ds_read_b64_tr_b16 a[108:109], v13 offset:8448
v_mfma_f32_16x16x32_bf16 v[40:43], a[80:83], a[8:11], 0
ds_read_b64_tr_b16 a[110:111], v13 offset:9472
v_mfma_f32_16x16x32_bf16 v[40:43], a[84:87], a[24:27], v[40:43]
s_add_u32 m0, s17, 0xc000
v_mfma_f32_16x16x32_bf16 v[48:51], a[84:87], a[28:31], 0
buffer_load_dwordx4 v5, s[60:63], 0 offen lds
v_mfma_f32_16x16x32_bf16 v[48:51], a[80:83], a[12:15], v[48:51]
v_mfma_f32_16x16x32_bf16 v[52:55], a[88:91], a[12:15], 0
ds_read_b64_tr_b16 a[80:81], v12 offset:512
v_mfma_f32_16x16x32_bf16 v[52:55], a[92:95], a[28:31], v[52:55]
ds_read_b64_tr_b16 a[82:83], v12 offset:1536
v_mfma_f32_16x16x32_bf16 v[44:47], a[92:95], a[24:27], 0
ds_read_b64_tr_b16 a[84:85], v12 offset:8704
s_add_u32 m0, s17, 0x8400
v_mfma_f32_16x16x32_bf16 v[44:47], a[88:91], a[8:11], v[44:47]
buffer_load_dwordx4 v5, s[56:59], s13 offen lds
v_mfma_f32_16x16x32_bf16 v[36:39], a[88:91], a[4:7], 0
ds_read_b64_tr_b16 a[86:87], v12 offset:9728
v_mfma_f32_16x16x32_bf16 v[36:39], a[92:95], a[20:23], v[36:39]
v_mfma_f32_16x16x32_bf16 v[28:31], a[92:95], a[16:19], 0
v_mfma_f32_16x16x32_bf16 v[28:31], a[88:91], a[0:3], v[28:31]
s_add_u32 m0, s17, 0xc400
v_mfma_f32_16x16x32_bf16 v[56:59], a[96:99], a[0:3], 0
buffer_load_dwordx4 v5, s[60:63], s13 offen lds
v_mfma_f32_16x16x32_bf16 v[56:59], a[100:103], a[16:19], v[56:59]
ds_read_b64_tr_b16 a[88:89], v13 offset:512
v_mfma_f32_16x16x32_bf16 v[64:67], a[100:103], a[20:23], 0
ds_read_b64_tr_b16 a[90:91], v13 offset:1536
v_mfma_f32_16x16x32_bf16 v[64:67], a[96:99], a[4:7], v[64:67]
ds_read_b64_tr_b16 a[92:93], v13 offset:8704
v_mfma_f32_16x16x32_bf16 v[72:75], a[96:99], a[8:11], 0
ds_read_b64_tr_b16 a[94:95], v13 offset:9728
s_add_u32 m0, s17, 0x8800
v_mfma_f32_16x16x32_bf16 v[72:75], a[100:103], a[24:27], v[72:75]
buffer_load_dwordx4 v6, s[56:59], 0 offen lds
v_mfma_f32_16x16x32_bf16 v[80:83], a[100:103], a[28:31], 0
v_mfma_f32_16x16x32_bf16 v[80:83], a[96:99], a[12:15], v[80:83]
s_waitcnt lgkmcnt(10)
v_mfma_f32_16x16x32_bf16 v[84:87], a[104:107], a[12:15], 0
ds_read_b64_tr_b16 a[96:97], v12 offset:768
s_waitcnt lgkmcnt(9)
v_mfma_f32_16x16x32_bf16 v[84:87], a[108:111], a[28:31], v[84:87]
ds_read_b64_tr_b16 a[98:99], v12 offset:1792
s_add_u32 m0, s17, 0xc800
v_mfma_f32_16x16x32_bf16 v[76:79], a[108:111], a[24:27], 0
buffer_load_dwordx4 v6, s[60:63], 0 offen lds
v_mfma_f32_16x16x32_bf16 v[76:79], a[104:107], a[8:11], v[76:79]
ds_read_b64_tr_b16 a[100:101], v12 offset:8960
v_mfma_f32_16x16x32_bf16 v[68:71], a[104:107], a[4:7], 0
ds_read_b64_tr_b16 a[102:103], v12 offset:9984
v_mfma_f32_16x16x32_bf16 v[68:71], a[108:111], a[20:23], v[68:71]
v_mfma_f32_16x16x32_bf16 v[60:63], a[108:111], a[16:19], 0
s_add_u32 m0, s17, 0x8c00
s_waitcnt lgkmcnt(4)
v_mfma_f32_16x16x32_bf16 v[60:63], a[104:107], a[0:3], v[60:63]
buffer_load_dwordx4 v6, s[56:59], s13 offen lds
v_mfma_f32_16x16x32_bf16 v[88:91], a[80:83], a[0:3], 0
ds_read_b64_tr_b16 a[104:105], v13 offset:768
v_mfma_f32_16x16x32_bf16 v[88:91], a[84:87], a[16:19], v[88:91]
ds_read_b64_tr_b16 a[106:107], v13 offset:1792
v_mfma_f32_16x16x32_bf16 v[96:99], a[84:87], a[20:23], 0
ds_read_b64_tr_b16 a[108:109], v13 offset:8960
v_mfma_f32_16x16x32_bf16 v[96:99], a[80:83], a[4:7], v[96:99]
ds_read_b64_tr_b16 a[110:111], v13 offset:9984
s_add_u32 m0, s17, 0xcc00
v_mfma_f32_16x16x32_bf16 v[104:107], a[80:83], a[8:11], 0
buffer_load_dwordx4 v6, s[60:63], s13 offen lds
v_mfma_f32_16x16x32_bf16 v[104:107], a[84:87], a[24:27], v[104:107]
v_lshl_add_u32 v5, s42, 19, v5
v_lshl_add_u32 v6, s42, 19, v6
v_mfma_f32_16x16x32_bf16 v[112:115], a[84:87], a[28:31], 0
v_mfma_f32_16x16x32_bf16 v[112:115], a[80:83], a[12:15], v[112:115]
v_mfma_f32_16x16x32_bf16 v[116:119], a[88:91], a[12:15], 0
ds_read_b64_tr_b16 a[80:81], v12 offset:16384
s_add_u32 m0, s16, 0x0
v_mfma_f32_16x16x32_bf16 v[116:119], a[92:95], a[28:31], v[116:119]
buffer_load_dwordx4 v2, s[48:51], 0 offen lds
v_mfma_f32_16x16x32_bf16 v[108:111], a[92:95], a[24:27], 0
ds_read_b64_tr_b16 a[82:83], v12 offset:17408
v_mfma_f32_16x16x32_bf16 v[108:111], a[88:91], a[8:11], v[108:111]
ds_read_b64_tr_b16 a[84:85], v12 offset:24576
v_mfma_f32_16x16x32_bf16 v[100:103], a[88:91], a[4:7], 0
ds_read_b64_tr_b16 a[86:87], v12 offset:25600
v_mfma_f32_16x16x32_bf16 v[100:103], a[92:95], a[20:23], v[100:103]
s_add_u32 m0, s16, 0x400
v_mfma_f32_16x16x32_bf16 v[92:95], a[92:95], a[16:19], 0
buffer_load_dwordx4 v3, s[48:51], 0 offen lds
v_mfma_f32_16x16x32_bf16 v[92:95], a[88:91], a[0:3], v[92:95]
s_waitcnt lgkmcnt(4)
v_mfma_f32_16x16x32_bf16 v[120:123], a[96:99], a[0:3], 0
ds_read_b64_tr_b16 a[88:89], v13 offset:16384
s_waitcnt vmcnt(11)
v_mfma_f32_16x16x32_bf16 v[120:123], a[100:103], a[16:19], v[120:123]
ds_read_b64_tr_b16 a[90:91], v13 offset:17408
v_mfma_f32_16x16x32_bf16 v[128:131], a[100:103], a[20:23], 0
ds_read_b64_tr_b16 a[92:93], v13 offset:24576
s_add_u32 m0, s16, 0x800
v_mfma_f32_16x16x32_bf16 v[128:131], a[96:99], a[4:7], v[128:131]
buffer_load_dwordx4 v2, s[48:51], s12 offen lds
v_mfma_f32_16x16x32_bf16 v[136:139], a[96:99], a[8:11], 0
ds_read_b64_tr_b16 a[94:95], v13 offset:25600
v_mfma_f32_16x16x32_bf16 v[136:139], a[100:103], a[24:27], v[136:139]
ds_read_b128 a[32:35], v8 offset:32768
v_mfma_f32_16x16x32_bf16 v[144:147], a[100:103], a[28:31], 0
ds_read_b128 a[48:51], v9 offset:32768
v_mfma_f32_16x16x32_bf16 v[144:147], a[96:99], a[12:15], v[144:147]
ds_read_b128 a[36:39], v8 offset:34816
s_add_u32 m0, s16, 0xc00
v_mfma_f32_16x16x32_bf16 v[148:151], a[104:107], a[12:15], 0
buffer_load_dwordx4 v3, s[48:51], s12 offen lds
v_mfma_f32_16x16x32_bf16 v[148:151], a[108:111], a[28:31], v[148:151]
ds_read_b64_tr_b16 a[96:97], v12 offset:16640
v_mfma_f32_16x16x32_bf16 v[140:143], a[108:111], a[24:27], 0
ds_read_b64_tr_b16 a[98:99], v12 offset:17664
v_mfma_f32_16x16x32_bf16 v[140:143], a[104:107], a[8:11], v[140:143]
ds_read_b64_tr_b16 a[100:101], v12 offset:24832
v_mfma_f32_16x16x32_bf16 v[132:135], a[104:107], a[4:7], 0
ds_read_b64_tr_b16 a[102:103], v12 offset:25856
s_add_u32 m0, s16, 0x1000
v_mfma_f32_16x16x32_bf16 v[132:135], a[108:111], a[20:23], v[132:135]
buffer_load_dwordx4 v2, s[48:51], s13 offen lds
v_mfma_f32_16x16x32_bf16 v[124:127], a[108:111], a[16:19], 0
ds_read_b128 a[52:55], v9 offset:34816
v_mfma_f32_16x16x32_bf16 v[124:127], a[104:107], a[0:3], v[124:127]
ds_read_b128 a[40:43], v8 offset:36864
s_waitcnt lgkmcnt(9)
v_mfma_f32_16x16x32_bf16 v[152:155], a[0:3], a[80:83], 0
ds_read_b64_tr_b16 a[104:105], v13 offset:16640
v_mfma_f32_16x16x32_bf16 v[152:155], a[16:19], a[84:87], v[152:155]
ds_read_b64_tr_b16 a[106:107], v13 offset:17664
s_add_u32 m0, s16, 0x1400
v_mfma_f32_16x16x32_bf16 v[156:159], a[20:23], a[84:87], 0
buffer_load_dwordx4 v3, s[48:51], s13 offen lds
v_mfma_f32_16x16x32_bf16 v[156:159], a[4:7], a[80:83], v[156:159]
ds_read_b64_tr_b16 a[108:109], v13 offset:24832
v_mfma_f32_16x16x32_bf16 v[160:163], a[8:11], a[80:83], 0
ds_read_b64_tr_b16 a[110:111], v13 offset:25856
v_mfma_f32_16x16x32_bf16 v[160:163], a[24:27], a[84:87], v[160:163]
ds_read_b128 a[56:59], v9 offset:36864
v_mfma_f32_16x16x32_bf16 v[164:167], a[28:31], a[84:87], 0
ds_read_b128 a[44:47], v8 offset:38912
s_add_u32 m0, s16, 0x1800
v_mfma_f32_16x16x32_bf16 v[164:167], a[12:15], a[80:83], v[164:167]
buffer_load_dwordx4 v2, s[48:51], s14 offen lds
v_mfma_f32_16x16x32_bf16 v[180:183], a[12:15], a[88:91], 0
ds_read_b64_tr_b16 a[80:81], v12 offset:16896
v_mfma_f32_16x16x32_bf16 v[180:183], a[28:31], a[92:95], v[180:183]
ds_read_b64_tr_b16 a[82:83], v12 offset:17920
v_mfma_f32_16x16x32_bf16 v[176:179], a[24:27], a[92:95], 0
ds_read_b64_tr_b16 a[84:85], v12 offset:25088
v_mfma_f32_16x16x32_bf16 v[176:179], a[8:11], a[88:91], v[176:179]
ds_read_b64_tr_b16 a[86:87], v12 offset:26112
s_add_u32 m0, s16, 0x1c00
v_mfma_f32_16x16x32_bf16 v[172:175], a[4:7], a[88:91], 0
buffer_load_dwordx4 v3, s[48:51], s14 offen lds
v_mfma_f32_16x16x32_bf16 v[172:175], a[20:23], a[92:95], v[172:175]
ds_read_b128 a[60:63], v9 offset:38912
v_lshl_add_u32 v2, s42, 7, v2
v_mfma_f32_16x16x32_bf16 v[168:171], a[16:19], a[92:95], 0
v_lshl_add_u32 v3, s42, 7, v3
v_mfma_f32_16x16x32_bf16 v[168:171], a[0:3], a[88:91], v[168:171]
s_waitcnt lgkmcnt(7)
v_mfma_f32_16x16x32_bf16 v[184:187], a[0:3], a[96:99], 0
ds_read_b64_tr_b16 a[88:89], v13 offset:16896
s_add_u32 m0, s17, 0x10000
v_mfma_f32_16x16x32_bf16 v[184:187], a[16:19], a[100:103], v[184:187]
buffer_load_dwordx4 v5, s[56:59], 0 offen lds
v_mfma_f32_16x16x32_bf16 v[188:191], a[20:23], a[100:103], 0
ds_read_b64_tr_b16 a[90:91], v13 offset:17920
v_mfma_f32_16x16x32_bf16 v[188:191], a[4:7], a[96:99], v[188:191]
ds_read_b64_tr_b16 a[92:93], v13 offset:25088
v_mfma_f32_16x16x32_bf16 v[192:195], a[8:11], a[96:99], 0
ds_read_b64_tr_b16 a[94:95], v13 offset:26112
v_mfma_f32_16x16x32_bf16 v[192:195], a[24:27], a[100:103], v[192:195]
s_add_u32 m0, s17, 0x14000
v_mfma_f32_16x16x32_bf16 v[196:199], a[28:31], a[100:103], 0
buffer_load_dwordx4 v5, s[60:63], 0 offen lds
v_mfma_f32_16x16x32_bf16 v[196:199], a[12:15], a[96:99], v[196:199]
v_mfma_f32_16x16x32_bf16 v[212:215], a[12:15], a[104:107], 0
ds_read_b64_tr_b16 a[96:97], v12 offset:17152
v_mfma_f32_16x16x32_bf16 v[212:215], a[28:31], a[108:111], v[212:215]
ds_read_b64_tr_b16 a[98:99], v12 offset:18176
v_mfma_f32_16x16x32_bf16 v[208:211], a[24:27], a[108:111], 0
ds_read_b64_tr_b16 a[100:101], v12 offset:25344
s_add_u32 m0, s17, 0x10400
v_mfma_f32_16x16x32_bf16 v[208:211], a[8:11], a[104:107], v[208:211]
buffer_load_dwordx4 v5, s[56:59], s13 offen lds
v_mfma_f32_16x16x32_bf16 v[204:207], a[4:7], a[104:107], 0
ds_read_b64_tr_b16 a[102:103], v12 offset:26368
v_mfma_f32_16x16x32_bf16 v[204:207], a[20:23], a[108:111], v[204:207]
v_mfma_f32_16x16x32_bf16 v[200:203], a[16:19], a[108:111], 0
v_mfma_f32_16x16x32_bf16 v[200:203], a[0:3], a[104:107], v[200:203]
s_add_u32 m0, s17, 0x14400
s_waitcnt lgkmcnt(4)
v_mfma_f32_16x16x32_bf16 v[216:219], a[0:3], a[80:83], 0
buffer_load_dwordx4 v5, s[60:63], s13 offen lds
v_mfma_f32_16x16x32_bf16 v[216:219], a[16:19], a[84:87], v[216:219]
ds_read_b64_tr_b16 a[104:105], v13 offset:17152
v_mfma_f32_16x16x32_bf16 v[220:223], a[20:23], a[84:87], 0
ds_read_b64_tr_b16 a[106:107], v13 offset:18176
v_mfma_f32_16x16x32_bf16 v[220:223], a[4:7], a[80:83], v[220:223]
ds_read_b64_tr_b16 a[108:109], v13 offset:25344
v_mfma_f32_16x16x32_bf16 v[224:227], a[8:11], a[80:83], 0
ds_read_b64_tr_b16 a[110:111], v13 offset:26368
s_add_u32 m0, s17, 0x10800
v_mfma_f32_16x16x32_bf16 v[224:227], a[24:27], a[84:87], v[224:227]
buffer_load_dwordx4 v6, s[56:59], 0 offen lds
v_mfma_f32_16x16x32_bf16 v[228:231], a[28:31], a[84:87], 0
v_add_u32 v12, 0x8000, v12
v_add_u32 v13, 0x8000, v13
v_mfma_f32_16x16x32_bf16 v[228:231], a[12:15], a[80:83], v[228:231]
v_mfma_f32_16x16x32_bf16 v[244:247], a[12:15], a[88:91], 0
s_waitcnt vmcnt(13) lgkmcnt(0)
v_mfma_f32_16x16x32_bf16 v[244:247], a[28:31], a[92:95], v[244:247]
s_barrier
s_add_u32 m0, s17, 0x14800
v_mfma_f32_16x16x32_bf16 v[240:243], a[24:27], a[92:95], 0
buffer_load_dwordx4 v6, s[60:63], 0 offen lds
v_mfma_f32_16x16x32_bf16 v[240:243], a[8:11], a[88:91], v[240:243]
ds_read_b64_tr_b16 a[80:81], v12 offset:0
v_mfma_f32_16x16x32_bf16 v[236:239], a[4:7], a[88:91], 0
ds_read_b64_tr_b16 a[82:83], v12 offset:1024
v_mfma_f32_16x16x32_bf16 v[236:239], a[20:23], a[92:95], v[236:239]
ds_read_b64_tr_b16 a[84:85], v12 offset:8192
s_waitcnt lgkmcnt(3)
v_mfma_f32_16x16x32_bf16 v[232:235], a[16:19], a[92:95], 0
ds_read_b64_tr_b16 a[86:87], v12 offset:9216
s_add_u32 m0, s17, 0x10c00
v_mfma_f32_16x16x32_bf16 v[232:235], a[0:3], a[88:91], v[232:235]
buffer_load_dwordx4 v6, s[56:59], s13 offen lds
v_mfma_f32_16x16x32_bf16 v[248:251], a[0:3], a[96:99], 0
ds_read_b64_tr_b16 a[88:89], v13 offset:0
v_mfma_f32_16x16x32_bf16 v[248:251], a[16:19], a[100:103], v[248:251]
ds_read_b64_tr_b16 a[90:91], v13 offset:1024
v_mfma_f32_16x16x32_bf16 v[252:255], a[20:23], a[100:103], 0
ds_read_b64_tr_b16 a[92:93], v13 offset:8192
v_mfma_f32_16x16x32_bf16 v[252:255], a[4:7], a[96:99], v[252:255]
ds_read_b64_tr_b16 a[94:95], v13 offset:9216
s_add_u32 m0, s17, 0x14c00
v_mfma_f32_16x16x32_bf16 a[232:235], a[8:11], a[96:99], 0
buffer_load_dwordx4 v6, s[60:63], s13 offen lds
v_mfma_f32_16x16x32_bf16 a[232:235], a[24:27], a[100:103], a[232:235]
v_lshl_add_u32 v5, s42, 19, v5
v_lshl_add_u32 v6, s42, 19, v6
v_mfma_f32_16x16x32_bf16 a[236:239], a[28:31], a[100:103], 0
v_mfma_f32_16x16x32_bf16 a[236:239], a[12:15], a[96:99], a[236:239]
s_waitcnt lgkmcnt(15)
v_mfma_f32_16x16x32_bf16 a[252:255], a[12:15], a[104:107], 0
ds_read_b64_tr_b16 a[96:97], v12 offset:256
s_add_u32 m0, s16, 0x8000
v_mfma_f32_16x16x32_bf16 a[252:255], a[28:31], a[108:111], a[252:255]
buffer_load_dwordx4 v2, s[48:51], 0 offen lds
v_mfma_f32_16x16x32_bf16 a[248:251], a[24:27], a[108:111], 0
ds_read_b64_tr_b16 a[98:99], v12 offset:1280
v_mfma_f32_16x16x32_bf16 a[248:251], a[8:11], a[104:107], a[248:251]
ds_read_b64_tr_b16 a[100:101], v12 offset:8448
v_mfma_f32_16x16x32_bf16 a[244:247], a[4:7], a[104:107], 0
ds_read_b64_tr_b16 a[102:103], v12 offset:9472
v_mfma_f32_16x16x32_bf16 a[244:247], a[20:23], a[108:111], a[244:247]
s_add_u32 m0, s16, 0x8400
v_mfma_f32_16x16x32_bf16 a[240:243], a[16:19], a[108:111], 0
buffer_load_dwordx4 v3, s[48:51], 0 offen lds
v_mfma_f32_16x16x32_bf16 a[240:243], a[0:3], a[104:107], a[240:243]
s_waitcnt lgkmcnt(4)
L_S1:
v_mfma_f32_16x16x32_bf16 v[24:27], a[80:83], a[32:35], v[24:27]
ds_read_b64_tr_b16 a[104:105], v13 offset:256
v_mfma_f32_16x16x32_bf16 v[24:27], a[84:87], a[48:51], v[24:27]
ds_read_b64_tr_b16 a[106:107], v13 offset:1280
v_mfma_f32_16x16x32_bf16 v[32:35], a[84:87], a[52:55], v[32:35]
ds_read_b64_tr_b16 a[108:109], v13 offset:8448
s_add_u32 m0, s16, 0x8800
v_mfma_f32_16x16x32_bf16 v[32:35], a[80:83], a[36:39], v[32:35]
buffer_load_dwordx4 v2, s[48:51], s12 offen lds
v_mfma_f32_16x16x32_bf16 v[40:43], a[80:83], a[40:43], v[40:43]
ds_read_b64_tr_b16 a[110:111], v13 offset:9472
v_mfma_f32_16x16x32_bf16 v[40:43], a[84:87], a[56:59], v[40:43]
v_mfma_f32_16x16x32_bf16 v[48:51], a[84:87], a[60:63], v[48:51]
v_mfma_f32_16x16x32_bf16 v[48:51], a[80:83], a[44:47], v[48:51]
s_add_u32 m0, s16, 0x8c00
v_mfma_f32_16x16x32_bf16 v[52:55], a[88:91], a[44:47], v[52:55]
buffer_load_dwordx4 v3, s[48:51], s12 offen lds
v_mfma_f32_16x16x32_bf16 v[52:55], a[92:95], a[60:63], v[52:55]
ds_read_b64_tr_b16 a[80:81], v12 offset:512
v_mfma_f32_16x16x32_bf16 v[44:47], a[92:95], a[56:59], v[44:47]
ds_read_b64_tr_b16 a[82:83], v12 offset:1536
v_mfma_f32_16x16x32_bf16 v[44:47], a[88:91], a[40:43], v[44:47]
ds_read_b64_tr_b16 a[84:85], v12 offset:8704
v_mfma_f32_16x16x32_bf16 v[36:39], a[88:91], a[36:39], v[36:39]
ds_read_b64_tr_b16 a[86:87], v12 offset:9728
s_add_u32 m0, s16, 0x9000
v_mfma_f32_16x16x32_bf16 v[36:39], a[92:95], a[52:55], v[36:39]
buffer_load_dwordx4 v2, s[48:51], s13 offen lds
v_mfma_f32_16x16x32_bf16 v[28:31], a[92:95], a[48:51], v[28:31]
v_mfma_f32_16x16x32_bf16 v[28:31], a[88:91], a[32:35], v[28:31]
s_waitcnt lgkmcnt(4)
v_mfma_f32_16x16x32_bf16 v[56:59], a[96:99], a[32:35], v[56:59]
ds_read_b64_tr_b16 a[88:89], v13 offset:512
v_mfma_f32_16x16x32_bf16 v[56:59], a[100:103], a[48:51], v[56:59]
ds_read_b64_tr_b16 a[90:91], v13 offset:1536
s_add_u32 m0, s16, 0x9400
v_mfma_f32_16x16x32_bf16 v[64:67], a[100:103], a[52:55], v[64:67]
buffer_load_dwordx4 v3, s[48:51], s13 offen lds
v_mfma_f32_16x16x32_bf16 v[64:67], a[96:99], a[36:39], v[64:67]
ds_read_b64_tr_b16 a[92:93], v13 offset:8704
v_mfma_f32_16x16x32_bf16 v[72:75], a[96:99], a[40:43], v[72:75]
ds_read_b64_tr_b16 a[94:95], v13 offset:9728
v_mfma_f32_16x16x32_bf16 v[72:75], a[100:103], a[56:59], v[72:75]
v_mfma_f32_16x16x32_bf16 v[80:83], a[100:103], a[60:63], v[80:83]
s_add_u32 m0, s16, 0x9800
v_mfma_f32_16x16x32_bf16 v[80:83], a[96:99], a[44:47], v[80:83]
buffer_load_dwordx4 v2, s[48:51], s14 offen lds
v_mfma_f32_16x16x32_bf16 v[84:87], a[104:107], a[44:47], v[84:87]
ds_read_b64_tr_b16 a[96:97], v12 offset:768
v_mfma_f32_16x16x32_bf16 v[84:87], a[108:111], a[60:63], v[84:87]
ds_read_b64_tr_b16 a[98:99], v12 offset:1792
v_mfma_f32_16x16x32_bf16 v[76:79], a[108:111], a[56:59], v[76:79]
ds_read_b64_tr_b16 a[100:101], v12 offset:8960
v_mfma_f32_16x16x32_bf16 v[76:79], a[104:107], a[40:43], v[76:79]
ds_read_b64_tr_b16 a[102:103], v12 offset:9984
s_add_u32 m0, s16, 0x9c00
v_mfma_f32_16x16x32_bf16 v[68:71], a[104:107], a[36:39], v[68:71]
buffer_load_dwordx4 v3, s[48:51], s14 offen lds
v_mfma_f32_16x16x32_bf16 v[68:71], a[108:111], a[52:55], v[68:71]
v_lshl_add_u32 v2, s42, 7, v2
v_lshl_add_u32 v3, s42, 7, v3
v_mfma_f32_16x16x32_bf16 v[60:63], a[108:111], a[48:51], v[60:63]
v_mfma_f32_16x16x32_bf16 v[60:63], a[104:107], a[32:35], v[60:63]
s_add_u32 m0, s17, 0x0
s_waitcnt lgkmcnt(4)
v_mfma_f32_16x16x32_bf16 v[88:91], a[80:83], a[32:35], v[88:91]
ds_read_b64_tr_b16 a[104:105], v13 offset:768
s_waitcnt vmcnt(16)
v_mfma_f32_16x16x32_bf16 v[88:91], a[84:87], a[48:51], v[88:91]
buffer_load_dwordx4 v5, s[56:59], 0 offen lds
v_mfma_f32_16x16x32_bf16 v[96:99], a[84:87], a[52:55], v[96:99]
ds_read_b64_tr_b16 a[106:107], v13 offset:1792
v_mfma_f32_16x16x32_bf16 v[96:99], a[80:83], a[36:39], v[96:99]
ds_read_b64_tr_b16 a[108:109], v13 offset:8960
v_mfma_f32_16x16x32_bf16 v[104:107], a[80:83], a[40:43], v[104:107]
ds_read_b64_tr_b16 a[110:111], v13 offset:9984
v_mfma_f32_16x16x32_bf16 v[104:107], a[84:87], a[56:59], v[104:107]
ds_read_b128 a[0:3], v8 offset:0
s_add_u32 m0, s17, 0x4000
v_mfma_f32_16x16x32_bf16 v[112:115], a[84:87], a[60:63], v[112:115]
buffer_load_dwordx4 v5, s[60:63], 0 offen lds
v_mfma_f32_16x16x32_bf16 v[112:115], a[80:83], a[44:47], v[112:115]
ds_read_b128 a[16:19], v9 offset:0
v_mfma_f32_16x16x32_bf16 v[116:119], a[88:91], a[44:47], v[116:119]
ds_read_b64_tr_b16 a[80:81], v12 offset:16384
v_mfma_f32_16x16x32_bf16 v[116:119], a[92:95], a[60:63], v[116:119]
ds_read_b64_tr_b16 a[82:83], v12 offset:17408
v_mfma_f32_16x16x32_bf16 v[108:111], a[92:95], a[56:59], v[108:111]
ds_read_b64_tr_b16 a[84:85], v12 offset:24576
s_add_u32 m0, s17, 0x400
v_mfma_f32_16x16x32_bf16 v[108:111], a[88:91], a[40:43], v[108:111]
buffer_load_dwordx4 v5, s[56:59], s13 offen lds
v_mfma_f32_16x16x32_bf16 v[100:103], a[88:91], a[36:39], v[100:103]
ds_read_b64_tr_b16 a[86:87], v12 offset:25600
v_mfma_f32_16x16x32_bf16 v[100:103], a[92:95], a[52:55], v[100:103]
ds_read_b128 a[4:7], v8 offset:2048
v_mfma_f32_16x16x32_bf16 v[92:95], a[92:95], a[48:51], v[92:95]
ds_read_b128 a[20:23], v9 offset:2048
s_waitcnt lgkmcnt(8)
v_mfma_f32_16x16x32_bf16 v[92:95], a[88:91], a[32:35], v[92:95]
ds_read_b128 a[8:11], v8 offset:4096
s_add_u32 m0, s17, 0x4400
v_mfma_f32_16x16x32_bf16 v[120:123], a[96:99], a[32:35], v[120:123]
buffer_load_dwordx4 v5, s[60:63], s13 offen lds
v_mfma_f32_16x16x32_bf16 v[120:123], a[100:103], a[48:51], v[120:123]
ds_read_b64_tr_b16 a[88:89], v13 offset:16384
v_mfma_f32_16x16x32_bf16 v[128:131], a[100:103], a[52:55], v[128:131]
ds_read_b64_tr_b16 a[90:91], v13 offset:17408
v_mfma_f32_16x16x32_bf16 v[128:131], a[96:99], a[36:39], v[128:131]
ds_read_b64_tr_b16 a[92:93], v13 offset:24576
v_mfma_f32_16x16x32_bf16 v[136:139], a[96:99], a[40:43], v[136:139]
ds_read_b64_tr_b16 a[94:95], v13 offset:25600
s_add_u32 m0, s17, 0x800
v_mfma_f32_16x16x32_bf16 v[136:139], a[100:103], a[56:59], v[136:139]
buffer_load_dwordx4 v6, s[56:59], 0 offen lds
v_mfma_f32_16x16x32_bf16 v[144:147], a[100:103], a[60:63], v[144:147]
ds_read_b128 a[24:27], v9 offset:4096
v_mfma_f32_16x16x32_bf16 v[144:147], a[96:99], a[44:47], v[144:147]
ds_read_b128 a[12:15], v8 offset:6144
v_mfma_f32_16x16x32_bf16 v[148:151], a[104:107], a[44:47], v[148:151]
ds_read_b64_tr_b16 a[96:97], v12 offset:16640
v_mfma_f32_16x16x32_bf16 v[148:151], a[108:111], a[60:63], v[148:151]
ds_read_b64_tr_b16 a[98:99], v12 offset:17664
s_add_u32 m0, s17, 0x4800
v_mfma_f32_16x16x32_bf16 v[140:143], a[108:111], a[56:59], v[140:143]
buffer_load_dwordx4 v6, s[60:63], 0 offen lds
v_mfma_f32_16x16x32_bf16 v[140:143], a[104:107], a[40:43], v[140:143]
ds_read_b64_tr_b16 a[100:101], v12 offset:24832
v_mfma_f32_16x16x32_bf16 v[132:135], a[104:107], a[36:39], v[132:135]
ds_read_b64_tr_b16 a[102:103], v12 offset:25856
v_mfma_f32_16x16x32_bf16 v[132:135], a[108:111], a[52:55], v[132:135]
ds_read_b128 a[28:31], v9 offset:6144
v_mfma_f32_16x16x32_bf16 v[124:127], a[108:111], a[48:51], v[124:127]
s_add_u32 m0, s17, 0xc00
s_waitcnt lgkmcnt(7)
v_mfma_f32_16x16x32_bf16 v[124:127], a[104:107], a[32:35], v[124:127]
buffer_load_dwordx4 v6, s[56:59], s13 offen lds
v_mfma_f32_16x16x32_bf16 v[152:155], a[32:35], a[80:83], v[152:155]
ds_read_b64_tr_b16 a[104:105], v13 offset:16640
v_mfma_f32_16x16x32_bf16 v[152:155], a[48:51], a[84:87], v[152:155]
ds_read_b64_tr_b16 a[106:107], v13 offset:17664
v_mfma_f32_16x16x32_bf16 v[156:159], a[52:55], a[84:87], v[156:159]
ds_read_b64_tr_b16 a[108:109], v13 offset:24832
v_mfma_f32_16x16x32_bf16 v[156:159], a[36:39], a[80:83], v[156:159]
ds_read_b64_tr_b16 a[110:111], v13 offset:25856
s_add_u32 m0, s17, 0x4c00
v_mfma_f32_16x16x32_bf16 v[160:163], a[40:43], a[80:83], v[160:163]
buffer_load_dwordx4 v6, s[60:63], s13 offen lds
v_mfma_f32_16x16x32_bf16 v[160:163], a[56:59], a[84:87], v[160:163]
v_lshl_add_u32 v5, s42, 19, v5
v_lshl_add_u32 v6, s42, 19, v6
v_mfma_f32_16x16x32_bf16 v[164:167], a[60:63], a[84:87], v[164:167]
v_mfma_f32_16x16x32_bf16 v[164:167], a[44:47], a[80:83], v[164:167]
v_mfma_f32_16x16x32_bf16 v[180:183], a[44:47], a[88:91], v[180:183]
ds_read_b64_tr_b16 a[80:81], v12 offset:16896
s_mov_b32 s9, 0x200000
v_mfma_f32_16x16x32_bf16 v[180:183], a[60:63], a[92:95], v[180:183]
buffer_load_dword a120, v18, s[56:59], s9 offen
v_mfma_f32_16x16x32_bf16 v[176:179], a[56:59], a[92:95], v[176:179]
ds_read_b64_tr_b16 a[82:83], v12 offset:17920
v_mfma_f32_16x16x32_bf16 v[176:179], a[40:43], a[88:91], v[176:179]
ds_read_b64_tr_b16 a[84:85], v12 offset:25088
v_mfma_f32_16x16x32_bf16 v[172:175], a[36:39], a[88:91], v[172:175]
ds_read_b64_tr_b16 a[86:87], v12 offset:26112
v_mfma_f32_16x16x32_bf16 v[172:175], a[52:55], a[92:95], v[172:175]
s_add_u32 m0, s16, 0x0
s_waitcnt lgkmcnt(8)
v_mfma_f32_16x16x32_bf16 v[168:171], a[48:51], a[92:95], v[168:171]
buffer_load_dwordx4 v2, s[48:51], 0 offen lds
v_mfma_f32_16x16x32_bf16 v[168:171], a[32:35], a[88:91], v[168:171]
s_waitcnt lgkmcnt(4)
v_mfma_f32_16x16x32_bf16 v[184:187], a[32:35], a[96:99], v[184:187]
ds_read_b64_tr_b16 a[88:89], v13 offset:16896
v_mfma_f32_16x16x32_bf16 v[184:187], a[48:51], a[100:103], v[184:187]
ds_read_b64_tr_b16 a[90:91], v13 offset:17920
v_mfma_f32_16x16x32_bf16 v[188:191], a[52:55], a[100:103], v[188:191]
ds_read_b64_tr_b16 a[92:93], v13 offset:25088
s_add_u32 m0, s16, 0x400
v_mfma_f32_16x16x32_bf16 v[188:191], a[36:39], a[96:99], v[188:191]
buffer_load_dwordx4 v3, s[48:51], 0 offen lds
v_mfma_f32_16x16x32_bf16 v[192:195], a[40:43], a[96:99], v[192:195]
ds_read_b64_tr_b16 a[94:95], v13 offset:26112
v_mfma_f32_16x16x32_bf16 v[192:195], a[56:59], a[100:103], v[192:195]
v_mfma_f32_16x16x32_bf16 v[196:199], a[60:63], a[100:103], v[196:199]
v_mfma_f32_16x16x32_bf16 v[196:199], a[44:47], a[96:99], v[196:199]
s_add_u32 m0, s16, 0x800
v_mfma_f32_16x16x32_bf16 v[212:215], a[44:47], a[104:107], v[212:215]
buffer_load_dwordx4 v2, s[48:51], s12 offen lds
v_mfma_f32_16x16x32_bf16 v[212:215], a[60:63], a[108:111], v[212:215]
ds_read_b64_tr_b16 a[96:97], v12 offset:17152
v_mfma_f32_16x16x32_bf16 v[208:211], a[56:59], a[108:111], v[208:211]
ds_read_b64_tr_b16 a[98:99], v12 offset:18176
v_mfma_f32_16x16x32_bf16 v[208:211], a[40:43], a[104:107], v[208:211]
ds_read_b64_tr_b16 a[100:101], v12 offset:25344
v_mfma_f32_16x16x32_bf16 v[204:207], a[36:39], a[104:107], v[204:207]
ds_read_b64_tr_b16 a[102:103], v12 offset:26368
s_add_u32 m0, s16, 0xc00
v_mfma_f32_16x16x32_bf16 v[204:207], a[52:55], a[108:111], v[204:207]
buffer_load_dwordx4 v3, s[48:51], s12 offen lds
v_mfma_f32_16x16x32_bf16 v[200:203], a[48:51], a[108:111], v[200:203]
v_mfma_f32_16x16x32_bf16 v[200:203], a[32:35], a[104:107], v[200:203]
s_waitcnt lgkmcnt(4)
v_mfma_f32_16x16x32_bf16 v[216:219], a[32:35], a[80:83], v[216:219]
ds_read_b64_tr_b16 a[104:105], v13 offset:17152
v_mfma_f32_16x16x32_bf16 v[216:219], a[48:51], a[84:87], v[216:219]
ds_read_b64_tr_b16 a[106:107], v13 offset:18176
s_add_u32 m0, s16, 0x1000
v_mfma_f32_16x16x32_bf16 v[220:223], a[52:55], a[84:87], v[220:223]
buffer_load_dwordx4 v2, s[48:51], s13 offen lds
v_mfma_f32_16x16x32_bf16 v[220:223], a[36:39], a[80:83], v[220:223]
ds_read_b64_tr_b16 a[108:109], v13 offset:25344
v_mfma_f32_16x16x32_bf16 v[224:227], a[40:43], a[80:83], v[224:227]
ds_read_b64_tr_b16 a[110:111], v13 offset:26368
v_add_u32 v12, 0x8000, v12
v_mfma_f32_16x16x32_bf16 v[224:227], a[56:59], a[84:87], v[224:227]
v_add_u32 v13, 0x8000, v13
v_mfma_f32_16x16x32_bf16 v[228:231], a[60:63], a[84:87], v[228:231]
s_add_u32 m0, s16, 0x1400
v_mfma_f32_16x16x32_bf16 v[228:231], a[44:47], a[80:83], v[228:231]
buffer_load_dwordx4 v3, s[48:51], s13 offen lds
v_mfma_f32_16x16x32_bf16 v[244:247], a[44:47], a[88:91], v[244:247]
s_waitcnt vmcnt(23) lgkmcnt(0)
v_mfma_f32_16x16x32_bf16 v[244:247], a[60:63], a[92:95], v[244:247]
s_barrier
v_mfma_f32_16x16x32_bf16 v[240:243], a[56:59], a[92:95], v[240:243]
ds_read_b64_tr_b16 a[80:81], v12 offset:0
v_mfma_f32_16x16x32_bf16 v[240:243], a[40:43], a[88:91], v[240:243]
ds_read_b64_tr_b16 a[82:83], v12 offset:1024
s_add_u32 m0, s16, 0x1800
v_mfma_f32_16x16x32_bf16 v[236:239], a[36:39], a[88:91], v[236:239]
buffer_load_dwordx4 v2, s[48:51], s14 offen lds
v_mfma_f32_16x16x32_bf16 v[236:239], a[52:55], a[92:95], v[236:239]
ds_read_b64_tr_b16 a[84:85], v12 offset:8192
v_mfma_f32_16x16x32_bf16 v[232:235], a[48:51], a[92:95], v[232:235]
ds_read_b64_tr_b16 a[86:87], v12 offset:9216
v_mfma_f32_16x16x32_bf16 v[232:235], a[32:35], a[88:91], v[232:235]
L_padA1:
s_cmp_eq_u32 s95, 1
s_cbranch_scc1 L_padA5
s_waitcnt lgkmcnt(4)
v_mfma_f32_16x16x32_bf16 v[248:251], a[32:35], a[96:99], v[248:251]
ds_read_b64_tr_b16 a[88:89], v13 offset:0
s_add_u32 m0, s16, 0x1c00
v_mfma_f32_16x16x32_bf16 v[248:251], a[48:51], a[100:103], v[248:251]
buffer_load_dwordx4 v3, s[48:51], s14 offen lds
v_mfma_f32_16x16x32_bf16 v[252:255], a[52:55], a[100:103], v[252:255]
ds_read_b64_tr_b16 a[90:91], v13 offset:1024
v_lshl_add_u32 v2, s42, 7, v2
v_mfma_f32_16x16x32_bf16 v[252:255], a[36:39], a[96:99], v[252:255]
ds_read_b64_tr_b16 a[92:93], v13 offset:8192
v_lshl_add_u32 v3, s42, 7, v3
v_mfma_f32_16x16x32_bf16 a[232:235], a[40:43], a[96:99], a[232:235]
ds_read_b64_tr_b16 a[94:95], v13 offset:9216
v_mfma_f32_16x16x32_bf16 a[232:235], a[56:59], a[100:103], a[232:235]
s_mov_b32 s9, 0x200000
v_mfma_f32_16x16x32_bf16 a[236:239], a[60:63], a[100:103], a[236:239]
buffer_load_dword a120, v18, s[60:63], s9 offen
v_mfma_f32_16x16x32_bf16 a[236:239], a[44:47], a[96:99], a[236:239]
v_mfma_f32_16x16x32_bf16 a[252:255], a[44:47], a[104:107], a[252:255]
ds_read_b64_tr_b16 a[96:97], v12 offset:256
v_mfma_f32_16x16x32_bf16 a[252:255], a[60:63], a[108:111], a[252:255]
ds_read_b64_tr_b16 a[98:99], v12 offset:1280
v_mfma_f32_16x16x32_bf16 a[248:251], a[56:59], a[108:111], a[248:251]
ds_read_b64_tr_b16 a[100:101], v12 offset:8448
s_add_u32 m0, s17, 0x8000
v_mfma_f32_16x16x32_bf16 a[248:251], a[40:43], a[104:107], a[248:251]
buffer_load_dwordx4 v5, s[56:59], 0 offen lds
v_mfma_f32_16x16x32_bf16 a[244:247], a[36:39], a[104:107], a[244:247]
ds_read_b64_tr_b16 a[102:103], v12 offset:9472
v_mfma_f32_16x16x32_bf16 a[244:247], a[52:55], a[108:111], a[244:247]
v_mfma_f32_16x16x32_bf16 a[240:243], a[48:51], a[108:111], a[240:243]
v_mfma_f32_16x16x32_bf16 a[240:243], a[32:35], a[104:107], a[240:243]
s_add_u32 m0, s17, 0xc000
s_waitcnt lgkmcnt(4)
L_S2:
v_mfma_f32_16x16x32_bf16 v[24:27], a[80:83], a[0:3], v[24:27]
buffer_load_dwordx4 v5, s[60:63], 0 offen lds
v_mfma_f32_16x16x32_bf16 v[24:27], a[84:87], a[16:19], v[24:27]
ds_read_b64_tr_b16 a[104:105], v13 offset:256
s_waitcnt vmcnt(20)
v_mfma_f32_16x16x32_bf16 v[32:35], a[84:87], a[20:23], v[32:35]
ds_read_b64_tr_b16 a[106:107], v13 offset:1280
v_mfma_f32_16x16x32_bf16 v[32:35], a[80:83], a[4:7], v[32:35]
ds_read_b64_tr_b16 a[108:109], v13 offset:8448
v_mfma_f32_16x16x32_bf16 v[40:43], a[80:83], a[8:11], v[40:43]
ds_read_b64_tr_b16 a[110:111], v13 offset:9472
s_add_u32 m0, s17, 0x8400
v_mfma_f32_16x16x32_bf16 v[40:43], a[84:87], a[24:27], v[40:43]
buffer_load_dwordx4 v5, s[56:59], s13 offen lds
v_mfma_f32_16x16x32_bf16 v[48:51], a[84:87], a[28:31], v[48:51]
ds_read_b128 a[32:35], v8 offset:32768
v_mfma_f32_16x16x32_bf16 v[48:51], a[80:83], a[12:15], v[48:51]
ds_read_b128 a[48:51], v9 offset:32768
v_mfma_f32_16x16x32_bf16 v[52:55], a[88:91], a[12:15], v[52:55]
ds_read_b64_tr_b16 a[80:81], v12 offset:512
v_mfma_f32_16x16x32_bf16 v[52:55], a[92:95], a[28:31], v[52:55]
ds_read_b64_tr_b16 a[82:83], v12 offset:1536
s_add_u32 m0, s17, 0xc400
v_mfma_f32_16x16x32_bf16 v[44:47], a[92:95], a[24:27], v[44:47]
buffer_load_dwordx4 v5, s[60:63], s13 offen lds
v_mfma_f32_16x16x32_bf16 v[44:47], a[88:91], a[8:11], v[44:47]
ds_read_b64_tr_b16 a[84:85], v12 offset:8704
v_mfma_f32_16x16x32_bf16 v[36:39], a[88:91], a[4:7], v[36:39]
ds_read_b64_tr_b16 a[86:87], v12 offset:9728
v_mfma_f32_16x16x32_bf16 v[36:39], a[92:95], a[20:23], v[36:39]
ds_read_b128 a[36:39], v8 offset:34816
s_waitcnt lgkmcnt(7)
v_mfma_f32_16x16x32_bf16 v[28:31], a[92:95], a[16:19], v[28:31]
ds_read_b128 a[52:55], v9 offset:34816
s_add_u32 m0, s17, 0x8800
v_mfma_f32_16x16x32_bf16 v[28:31], a[88:91], a[0:3], v[28:31]
buffer_load_dwordx4 v6, s[56:59], 0 offen lds
v_mfma_f32_16x16x32_bf16 v[56:59], a[96:99], a[0:3], v[56:59]
ds_read_b64_tr_b16 a[88:89], v13 offset:512
v_mfma_f32_16x16x32_bf16 v[56:59], a[100:103], a[16:19], v[56:59]
ds_read_b64_tr_b16 a[90:91], v13 offset:1536
v_mfma_f32_16x16x32_bf16 v[64:67], a[100:103], a[20:23], v[64:67]
ds_read_b64_tr_b16 a[92:93], v13 offset:8704
v_mfma_f32_16x16x32_bf16 v[64:67], a[96:99], a[4:7], v[64:67]
ds_read_b64_tr_b16 a[94:95], v13 offset:9728
s_add_u32 m0, s17, 0xc800
v_mfma_f32_16x16x32_bf16 v[72:75], a[96:99], a[8:11], v[72:75]
buffer_load_dwordx4 v6, s[60:63], 0 offen lds
v_mfma_f32_16x16x32_bf16 v[72:75], a[100:103], a[24:27], v[72:75]
ds_read_b128 a[40:43], v8 offset:36864
v_mfma_f32_16x16x32_bf16 v[80:83], a[100:103], a[28:31], v[80:83]
ds_read_b128 a[56:59], v9 offset:36864
v_mfma_f32_16x16x32_bf16 v[80:83], a[96:99], a[12:15], v[80:83]
ds_read_b128 a[44:47], v8 offset:38912
v_mfma_f32_16x16x32_bf16 v[84:87], a[104:107], a[12:15], v[84:87]
ds_read_b64_tr_b16 a[96:97], v12 offset:768
s_add_u32 m0, s17, 0x8c00
v_mfma_f32_16x16x32_bf16 v[84:87], a[108:111], a[28:31], v[84:87]
buffer_load_dwordx4 v6, s[56:59], s13 offen lds
v_mfma_f32_16x16x32_bf16 v[76:79], a[108:111], a[24:27], v[76:79]
ds_read_b64_tr_b16 a[98:99], v12 offset:1792
v_mfma_f32_16x16x32_bf16 v[76:79], a[104:107], a[8:11], v[76:79]
ds_read_b64_tr_b16 a[100:101], v12 offset:8960
v_mfma_f32_16x16x32_bf16 v[68:71], a[104:107], a[4:7], v[68:71]
ds_read_b64_tr_b16 a[102:103], v12 offset:9984
v_mfma_f32_16x16x32_bf16 v[68:71], a[108:111], a[20:23], v[68:71]
ds_read_b128 a[60:63], v9 offset:38912
s_add_u32 m0, s17, 0xcc00
v_mfma_f32_16x16x32_bf16 v[60:63], a[108:111], a[16:19], v[60:63]
buffer_load_dwordx4 v6, s[60:63], s13 offen lds
v_mfma_f32_16x16x32_bf16 v[60:63], a[104:107], a[0:3], v[60:63]
s_waitcnt lgkmcnt(8)
v_lshl_add_u32 v5, s42, 19, v5
v_lshl_add_u32 v6, s42, 19, v6
v_mfma_f32_16x16x32_bf16 v[88:91], a[80:83], a[0:3], v[88:91]
ds_read_b64_tr_b16 a[104:105], v13 offset:768
v_mfma_f32_16x16x32_bf16 v[88:91], a[84:87], a[16:19], v[88:91]
ds_read_b64_tr_b16 a[106:107], v13 offset:1792
v_mfma_f32_16x16x32_bf16 v[96:99], a[84:87], a[20:23], v[96:99]
ds_read_b64_tr_b16 a[108:109], v13 offset:8960
v_mfma_f32_16x16x32_bf16 v[96:99], a[80:83], a[4:7], v[96:99]
ds_read_b64_tr_b16 a[110:111], v13 offset:9984
v_mfma_f32_16x16x32_bf16 v[104:107], a[80:83], a[8:11], v[104:107]
s_add_u32 m0, s16, 0x8000
s_waitcnt lgkmcnt(4)
v_mfma_f32_16x16x32_bf16 v[104:107], a[84:87], a[24:27], v[104:107]
buffer_load_dwordx4 v2, s[48:51], 0 offen lds
v_mfma_f32_16x16x32_bf16 v[112:115], a[84:87], a[28:31], v[112:115]
v_mfma_f32_16x16x32_bf16 v[112:115], a[80:83], a[12:15], v[112:115]
v_mfma_f32_16x16x32_bf16 v[116:119], a[88:91], a[12:15], v[116:119]
ds_read_b64_tr_b16 a[80:81], v12 offset:16384
v_mfma_f32_16x16x32_bf16 v[116:119], a[92:95], a[28:31], v[116:119]
ds_read_b64_tr_b16 a[82:83], v12 offset:17408
v_mfma_f32_16x16x32_bf16 v[108:111], a[92:95], a[24:27], v[108:111]
ds_read_b64_tr_b16 a[84:85], v12 offset:24576
v_mfma_f32_16x16x32_bf16 v[108:111], a[88:91], a[8:11], v[108:111]
ds_read_b64_tr_b16 a[86:87], v12 offset:25600
s_add_u32 m0, s16, 0x8400
v_mfma_f32_16x16x32_bf16 v[100:103], a[88:91], a[4:7], v[100:103]
buffer_load_dwordx4 v3, s[48:51], 0 offen lds
v_mfma_f32_16x16x32_bf16 v[100:103], a[92:95], a[20:23], v[100:103]
v_mfma_f32_16x16x32_bf16 v[92:95], a[92:95], a[16:19], v[92:95]
v_mfma_f32_16x16x32_bf16 v[92:95], a[88:91], a[0:3], v[92:95]
s_waitcnt lgkmcnt(4)
v_mfma_f32_16x16x32_bf16 v[120:123], a[96:99], a[0:3], v[120:123]
ds_read_b64_tr_b16 a[88:89], v13 offset:16384
v_mfma_f32_16x16x32_bf16 v[120:123], a[100:103], a[16:19], v[120:123]
ds_read_b64_tr_b16 a[90:91], v13 offset:17408
v_mfma_f32_16x16x32_bf16 v[128:131], a[100:103], a[20:23], v[128:131]
ds_read_b64_tr_b16 a[92:93], v13 offset:24576
v_mfma_f32_16x16x32_bf16 v[128:131], a[96:99], a[4:7], v[128:131]
ds_read_b64_tr_b16 a[94:95], v13 offset:25600
s_add_u32 m0, s16, 0x8800
v_mfma_f32_16x16x32_bf16 v[136:139], a[96:99], a[8:11], v[136:139]
buffer_load_dwordx4 v2, s[48:51], s12 offen lds
v_mfma_f32_16x16x32_bf16 v[136:139], a[100:103], a[24:27], v[136:139]
v_mfma_f32_16x16x32_bf16 v[144:147], a[100:103], a[28:31], v[144:147]
v_mfma_f32_16x16x32_bf16 v[144:147], a[96:99], a[12:15], v[144:147]
v_mfma_f32_16x16x32_bf16 v[148:151], a[104:107], a[12:15], v[148:151]
ds_read_b64_tr_b16 a[96:97], v12 offset:16640
v_mfma_f32_16x16x32_bf16 v[148:151], a[108:111], a[28:31], v[148:151]
ds_read_b64_tr_b16 a[98:99], v12 offset:17664
v_mfma_f32_16x16x32_bf16 v[140:143], a[108:111], a[24:27], v[140:143]
ds_read_b64_tr_b16 a[100:101], v12 offset:24832
s_add_u32 m0, s16, 0x8c00
v_mfma_f32_16x16x32_bf16 v[140:143], a[104:107], a[8:11], v[140:143]
buffer_load_dwordx4 v3, s[48:51], s12 offen lds
v_mfma_f32_16x16x32_bf16 v[132:135], a[104:107], a[4:7], v[132:135]
ds_read_b64_tr_b16 a[102:103], v12 offset:25856
v_mfma_f32_16x16x32_bf16 v[132:135], a[108:111], a[20:23], v[132:135]
v_mfma_f32_16x16x32_bf16 v[124:127], a[108:111], a[16:19], v[124:127]
v_mfma_f32_16x16x32_bf16 v[124:127], a[104:107], a[0:3], v[124:127]
s_waitcnt lgkmcnt(4)
v_mfma_f32_16x16x32_bf16 v[152:155], a[0:3], a[80:83], v[152:155]
ds_read_b64_tr_b16 a[104:105], v13 offset:16640
v_mfma_f32_16x16x32_bf16 v[152:155], a[16:19], a[84:87], v[152:155]
ds_read_b64_tr_b16 a[106:107], v13 offset:17664
s_add_u32 m0, s16, 0x9000
v_mfma_f32_16x16x32_bf16 v[156:159], a[20:23], a[84:87], v[156:159]
buffer_load_dwordx4 v2, s[48:51], s13 offen lds
v_mfma_f32_16x16x32_bf16 v[156:159], a[4:7], a[80:83], v[156:159]
ds_read_b64_tr_b16 a[108:109], v13 offset:24832
v_mfma_f32_16x16x32_bf16 v[160:163], a[8:11], a[80:83], v[160:163]
ds_read_b64_tr_b16 a[110:111], v13 offset:25856
v_mfma_f32_16x16x32_bf16 v[160:163], a[24:27], a[84:87], v[160:163]
v_mfma_f32_16x16x32_bf16 v[164:167], a[28:31], a[84:87], v[164:167]
v_mfma_f32_16x16x32_bf16 v[164:167], a[12:15], a[80:83], v[164:167]
v_mfma_f32_16x16x32_bf16 v[180:183], a[12:15], a[88:91], v[180:183]
ds_read_b64_tr_b16 a[80:81], v12 offset:16896
v_mfma_f32_16x16x32_bf16 v[180:183], a[28:31], a[92:95], v[180:183]
ds_read_b64_tr_b16 a[82:83], v12 offset:17920
s_add_u32 m0, s16, 0x9400
v_mfma_f32_16x16x32_bf16 v[176:179], a[24:27], a[92:95], v[176:179]
buffer_load_dwordx4 v3, s[48:51], s13 offen lds
v_mfma_f32_16x16x32_bf16 v[176:179], a[8:11], a[88:91], v[176:179]
ds_read_b64_tr_b16 a[84:85], v12 offset:25088
v_mfma_f32_16x16x32_bf16 v[172:175], a[4:7], a[88:91], v[172:175]
ds_read_b64_tr_b16 a[86:87], v12 offset:26112
v_mfma_f32_16x16x32_bf16 v[172:175], a[20:23], a[92:95], v[172:175]
v_mfma_f32_16x16x32_bf16 v[168:171], a[16:19], a[92:95], v[168:171]
v_mfma_f32_16x16x32_bf16 v[168:171], a[0:3], a[88:91], v[168:171]
s_waitcnt lgkmcnt(4)
v_mfma_f32_16x16x32_bf16 v[184:187], a[0:3], a[96:99], v[184:187]
ds_read_b64_tr_b16 a[88:89], v13 offset:16896
s_add_u32 m0, s16, 0x9800
v_mfma_f32_16x16x32_bf16 v[184:187], a[16:19], a[100:103], v[184:187]
buffer_load_dwordx4 v2, s[48:51], s14 offen lds
v_mfma_f32_16x16x32_bf16 v[188:191], a[20:23], a[100:103], v[188:191]
ds_read_b64_tr_b16 a[90:91], v13 offset:17920
v_mfma_f32_16x16x32_bf16 v[188:191], a[4:7], a[96:99], v[188:191]
ds_read_b64_tr_b16 a[92:93], v13 offset:25088
v_mfma_f32_16x16x32_bf16 v[192:195], a[8:11], a[96:99], v[192:195]
ds_read_b64_tr_b16 a[94:95], v13 offset:26112
v_mfma_f32_16x16x32_bf16 v[192:195], a[24:27], a[100:103], v[192:195]
v_mfma_f32_16x16x32_bf16 v[196:199], a[28:31], a[100:103], v[196:199]
v_mfma_f32_16x16x32_bf16 v[196:199], a[12:15], a[96:99], v[196:199]
v_mfma_f32_16x16x32_bf16 v[212:215], a[12:15], a[104:107], v[212:215]
ds_read_b64_tr_b16 a[96:97], v12 offset:17152
s_add_u32 m0, s16, 0x9c00
v_mfma_f32_16x16x32_bf16 v[212:215], a[28:31], a[108:111], v[212:215]
buffer_load_dwordx4 v3, s[48:51], s14 offen lds
v_mfma_f32_16x16x32_bf16 v[208:211], a[24:27], a[108:111], v[208:211]
ds_read_b64_tr_b16 a[98:99], v12 offset:18176
v_lshl_add_u32 v2, s42, 7, v2
v_mfma_f32_16x16x32_bf16 v[208:211], a[8:11], a[104:107], v[208:211]
ds_read_b64_tr_b16 a[100:101], v12 offset:25344
v_lshl_add_u32 v3, s42, 7, v3
v_mfma_f32_16x16x32_bf16 v[204:207], a[4:7], a[104:107], v[204:207]
ds_read_b64_tr_b16 a[102:103], v12 offset:26368
v_mfma_f32_16x16x32_bf16 v[204:207], a[20:23], a[108:111], v[204:207]
v_mfma_f32_16x16x32_bf16 v[200:203], a[16:19], a[108:111], v[200:203]
v_mfma_f32_16x16x32_bf16 v[200:203], a[0:3], a[104:107], v[200:203]
s_mov_b32 s9, 0x0
s_waitcnt lgkmcnt(4)
v_mfma_f32_16x16x32_bf16 v[216:219], a[0:3], a[80:83], v[216:219]
buffer_load_dword a120, v19, s[44:47], s9 offen
v_mfma_f32_16x16x32_bf16 v[216:219], a[16:19], a[84:87], v[216:219]
ds_read_b64_tr_b16 a[104:105], v13 offset:17152
v_mfma_f32_16x16x32_bf16 v[220:223], a[20:23], a[84:87], v[220:223]
ds_read_b64_tr_b16 a[106:107], v13 offset:18176
v_mfma_f32_16x16x32_bf16 v[220:223], a[4:7], a[80:83], v[220:223]
ds_read_b64_tr_b16 a[108:109], v13 offset:25344
v_mfma_f32_16x16x32_bf16 v[224:227], a[8:11], a[80:83], v[224:227]
ds_read_b64_tr_b16 a[110:111], v13 offset:26368
v_add_u32 v12, 0xffff0000, v12
v_mfma_f32_16x16x32_bf16 v[224:227], a[24:27], a[84:87], v[224:227]
v_add_u32 v13, 0xffff0000, v13
v_mfma_f32_16x16x32_bf16 v[228:231], a[28:31], a[84:87], v[228:231]
v_mfma_f32_16x16x32_bf16 v[228:231], a[12:15], a[80:83], v[228:231]
v_mfma_f32_16x16x32_bf16 v[244:247], a[12:15], a[88:91], v[244:247]
s_waitcnt vmcnt(27) lgkmcnt(0)
v_mfma_f32_16x16x32_bf16 v[244:247], a[28:31], a[92:95], v[244:247]
s_barrier
s_add_u32 m0, s17, 0x10000
v_mfma_f32_16x16x32_bf16 v[240:243], a[24:27], a[92:95], v[240:243]
buffer_load_dwordx4 v5, s[56:59], 0 offen lds
v_mfma_f32_16x16x32_bf16 v[240:243], a[8:11], a[88:91], v[240:243]
ds_read_b64_tr_b16 a[80:81], v12 offset:0
v_mfma_f32_16x16x32_bf16 v[236:239], a[4:7], a[88:91], v[236:239]
ds_read_b64_tr_b16 a[82:83], v12 offset:1024
v_mfma_f32_16x16x32_bf16 v[236:239], a[20:23], a[92:95], v[236:239]
ds_read_b64_tr_b16 a[84:85], v12 offset:8192
v_mfma_f32_16x16x32_bf16 v[232:235], a[16:19], a[92:95], v[232:235]
ds_read_b64_tr_b16 a[86:87], v12 offset:9216
v_mfma_f32_16x16x32_bf16 v[232:235], a[0:3], a[88:91], v[232:235]
s_waitcnt lgkmcnt(4)
v_mfma_f32_16x16x32_bf16 v[248:251], a[0:3], a[96:99], v[248:251]
ds_read_b64_tr_b16 a[88:89], v13 offset:0
s_add_u32 m0, s17, 0x14000
v_mfma_f32_16x16x32_bf16 v[248:251], a[16:19], a[100:103], v[248:251]
buffer_load_dwordx4 v5, s[60:63], 0 offen lds
v_mfma_f32_16x16x32_bf16 v[252:255], a[20:23], a[100:103], v[252:255]
ds_read_b64_tr_b16 a[90:91], v13 offset:1024
v_mfma_f32_16x16x32_bf16 v[252:255], a[4:7], a[96:99], v[252:255]
ds_read_b64_tr_b16 a[92:93], v13 offset:8192
v_mfma_f32_16x16x32_bf16 a[232:235], a[8:11], a[96:99], a[232:235]
ds_read_b64_tr_b16 a[94:95], v13 offset:9216
v_mfma_f32_16x16x32_bf16 a[232:235], a[24:27], a[100:103], a[232:235]
v_mfma_f32_16x16x32_bf16 a[236:239], a[28:31], a[100:103], a[236:239]
v_mfma_f32_16x16x32_bf16 a[236:239], a[12:15], a[96:99], a[236:239]
s_add_u32 m0, s17, 0x10400
v_mfma_f32_16x16x32_bf16 a[252:255], a[12:15], a[104:107], a[252:255]
buffer_load_dwordx4 v5, s[56:59], s13 offen lds
v_mfma_f32_16x16x32_bf16 a[252:255], a[28:31], a[108:111], a[252:255]
ds_read_b64_tr_b16 a[96:97], v12 offset:256
v_mfma_f32_16x16x32_bf16 a[248:251], a[24:27], a[108:111], a[248:251]
ds_read_b64_tr_b16 a[98:99], v12 offset:1280
v_mfma_f32_16x16x32_bf16 a[248:251], a[8:11], a[104:107], a[248:251]
ds_read_b64_tr_b16 a[100:101], v12 offset:8448
v_mfma_f32_16x16x32_bf16 a[244:247], a[4:7], a[104:107], a[244:247]
ds_read_b64_tr_b16 a[102:103], v12 offset:9472
v_mfma_f32_16x16x32_bf16 a[244:247], a[20:23], a[108:111], a[244:247]
v_mfma_f32_16x16x32_bf16 a[240:243], a[16:19], a[108:111], a[240:243]
s_add_u32 m0, s17, 0x14400
s_waitcnt lgkmcnt(4)
v_mfma_f32_16x16x32_bf16 a[240:243], a[0:3], a[104:107], a[240:243]
buffer_load_dwordx4 v5, s[60:63], s13 offen lds
L_S3:
v_mfma_f32_16x16x32_bf16 v[24:27], a[80:83], a[32:35], v[24:27]
ds_read_b64_tr_b16 a[104:105], v13 offset:256
s_waitcnt vmcnt(22)
v_mfma_f32_16x16x32_bf16 v[24:27], a[84:87], a[48:51], v[24:27]
ds_read_b64_tr_b16 a[106:107], v13 offset:1280
v_mfma_f32_16x16x32_bf16 v[32:35], a[84:87], a[52:55], v[32:35]
ds_read_b64_tr_b16 a[108:109], v13 offset:8448
v_mfma_f32_16x16x32_bf16 v[32:35], a[80:83], a[36:39], v[32:35]
ds_read_b64_tr_b16 a[110:111], v13 offset:9472
v_mfma_f32_16x16x32_bf16 v[40:43], a[80:83], a[40:43], v[40:43]
ds_read_b128 a[0:3], v8 offset:0
v_mfma_f32_16x16x32_bf16 v[40:43], a[84:87], a[56:59], v[40:43]
ds_read_b128 a[16:19], v9 offset:0
s_add_u32 m0, s17, 0x10800
v_mfma_f32_16x16x32_bf16 v[48:51], a[84:87], a[60:63], v[48:51]
buffer_load_dwordx4 v6, s[56:59], 0 offen lds
v_mfma_f32_16x16x32_bf16 v[48:51], a[80:83], a[44:47], v[48:51]
ds_read_b128 a[4:7], v8 offset:2048
v_mfma_f32_16x16x32_bf16 v[52:55], a[88:91], a[44:47], v[52:55]
ds_read_b64_tr_b16 a[80:81], v12 offset:512
v_mfma_f32_16x16x32_bf16 v[52:55], a[92:95], a[60:63], v[52:55]
ds_read_b64_tr_b16 a[82:83], v12 offset:1536
v_mfma_f32_16x16x32_bf16 v[44:47], a[92:95], a[56:59], v[44:47]
ds_read_b64_tr_b16 a[84:85], v12 offset:8704
v_mfma_f32_16x16x32_bf16 v[44:47], a[88:91], a[40:43], v[44:47]
ds_read_b64_tr_b16 a[86:87], v12 offset:9728
v_mfma_f32_16x16x32_bf16 v[36:39], a[88:91], a[36:39], v[36:39]
ds_read_b128 a[20:23], v9 offset:2048
s_add_u32 m0, s17, 0x14800
v_mfma_f32_16x16x32_bf16 v[36:39], a[92:95], a[52:55], v[36:39]
buffer_load_dwordx4 v6, s[60:63], 0 offen lds
v_mfma_f32_16x16x32_bf16 v[28:31], a[92:95], a[48:51], v[28:31]
ds_read_b128 a[8:11], v8 offset:4096
v_mfma_f32_16x16x32_bf16 v[28:31], a[88:91], a[32:35], v[28:31]
ds_read_b128 a[24:27], v9 offset:4096
s_waitcnt lgkmcnt(10)
v_mfma_f32_16x16x32_bf16 v[56:59], a[96:99], a[32:35], v[56:59]
ds_read_b64_tr_b16 a[88:89], v13 offset:512
v_mfma_f32_16x16x32_bf16 v[56:59], a[100:103], a[48:51], v[56:59]
ds_read_b64_tr_b16 a[90:91], v13 offset:1536
v_mfma_f32_16x16x32_bf16 v[64:67], a[100:103], a[52:55], v[64:67]
ds_read_b64_tr_b16 a[92:93], v13 offset:8704
v_mfma_f32_16x16x32_bf16 v[64:67], a[96:99], a[36:39], v[64:67]
ds_read_b64_tr_b16 a[94:95], v13 offset:9728
s_add_u32 m0, s17, 0x10c00
v_mfma_f32_16x16x32_bf16 v[72:75], a[96:99], a[40:43], v[72:75]
buffer_load_dwordx4 v6, s[56:59], s13 offen lds
v_mfma_f32_16x16x32_bf16 v[72:75], a[100:103], a[56:59], v[72:75]
ds_read_b128 a[12:15], v8 offset:6144
v_mfma_f32_16x16x32_bf16 v[80:83], a[100:103], a[60:63], v[80:83]
ds_read_b128 a[28:31], v9 offset:6144
v_mfma_f32_16x16x32_bf16 v[80:83], a[96:99], a[44:47], v[80:83]
v_mfma_f32_16x16x32_bf16 v[84:87], a[104:107], a[44:47], v[84:87]
ds_read_b64_tr_b16 a[96:97], v12 offset:768
v_mfma_f32_16x16x32_bf16 v[84:87], a[108:111], a[60:63], v[84:87]
ds_read_b64_tr_b16 a[98:99], v12 offset:1792
v_mfma_f32_16x16x32_bf16 v[76:79], a[108:111], a[56:59], v[76:79]
ds_read_b64_tr_b16 a[100:101], v12 offset:8960
s_add_u32 m0, s17, 0x14c00
v_mfma_f32_16x16x32_bf16 v[76:79], a[104:107], a[40:43], v[76:79]
buffer_load_dwordx4 v6, s[60:63], s13 offen lds
v_mfma_f32_16x16x32_bf16 v[68:71], a[104:107], a[36:39], v[68:71]
ds_read_b64_tr_b16 a[102:103], v12 offset:9984
v_lshl_add_u32 v5, s42, 19, v5
v_mfma_f32_16x16x32_bf16 v[68:71], a[108:111], a[52:55], v[68:71]
v_lshl_add_u32 v6, s42, 19, v6
v_mfma_f32_16x16x32_bf16 v[60:63], a[108:111], a[48:51], v[60:63]
v_mfma_f32_16x16x32_bf16 v[60:63], a[104:107], a[32:35], v[60:63]
s_waitcnt lgkmcnt(6)
v_mfma_f32_16x16x32_bf16 v[88:91], a[80:83], a[32:35], v[88:91]
ds_read_b64_tr_b16 a[104:105], v13 offset:768
v_mfma_f32_16x16x32_bf16 v[88:91], a[84:87], a[48:51], v[88:91]
ds_read_b64_tr_b16 a[106:107], v13 offset:1792
s_mov_b32 s9, 0x200000
v_mfma_f32_16x16x32_bf16 v[96:99], a[84:87], a[52:55], v[96:99]
buffer_load_dword a120, v19, s[44:47], s9 offen
v_mfma_f32_16x16x32_bf16 v[96:99], a[80:83], a[36:39], v[96:99]
ds_read_b64_tr_b16 a[108:109], v13 offset:8960
v_mfma_f32_16x16x32_bf16 v[104:107], a[80:83], a[40:43], v[104:107]
ds_read_b64_tr_b16 a[110:111], v13 offset:9984
v_mfma_f32_16x16x32_bf16 v[104:107], a[84:87], a[56:59], v[104:107]
v_mfma_f32_16x16x32_bf16 v[112:115], a[84:87], a[60:63], v[112:115]
v_mfma_f32_16x16x32_bf16 v[112:115], a[80:83], a[44:47], v[112:115]
s_waitcnt lgkmcnt(8)
v_mfma_f32_16x16x32_bf16 v[116:119], a[88:91], a[44:47], v[116:119]
ds_read_b64_tr_b16 a[80:81], v12 offset:16384
s_add_u32 m0, s16, 0x0
v_mfma_f32_16x16x32_bf16 v[116:119], a[92:95], a[60:63], v[116:119]
buffer_load_dwordx4 v2, s[48:51], 0 offen lds
v_mfma_f32_16x16x32_bf16 v[108:111], a[92:95], a[56:59], v[108:111]
ds_read_b64_tr_b16 a[82:83], v12 offset:17408
v_mfma_f32_16x16x32_bf16 v[108:111], a[88:91], a[40:43], v[108:111]
ds_read_b64_tr_b16 a[84:85], v12 offset:24576
v_mfma_f32_16x16x32_bf16 v[100:103], a[88:91], a[36:39], v[100:103]
ds_read_b64_tr_b16 a[86:87], v12 offset:25600
v_mfma_f32_16x16x32_bf16 v[100:103], a[92:95], a[52:55], v[100:103]
v_mfma_f32_16x16x32_bf16 v[92:95], a[92:95], a[48:51], v[92:95]
v_mfma_f32_16x16x32_bf16 v[92:95], a[88:91], a[32:35], v[92:95]
s_add_u32 m0, s16, 0x400
s_waitcnt lgkmcnt(4)
v_mfma_f32_16x16x32_bf16 v[120:123], a[96:99], a[32:35], v[120:123]
buffer_load_dwordx4 v3, s[48:51], 0 offen lds
v_mfma_f32_16x16x32_bf16 v[120:123], a[100:103], a[48:51], v[120:123]
ds_read_b64_tr_b16 a[88:89], v13 offset:16384
v_mfma_f32_16x16x32_bf16 v[128:131], a[100:103], a[52:55], v[128:131]
ds_read_b64_tr_b16 a[90:91], v13 offset:17408
v_mfma_f32_16x16x32_bf16 v[128:131], a[96:99], a[36:39], v[128:131]
ds_read_b64_tr_b16 a[92:93], v13 offset:24576
v_mfma_f32_16x16x32_bf16 v[136:139], a[96:99], a[40:43], v[136:139]
ds_read_b64_tr_b16 a[94:95], v13 offset:25600
v_mfma_f32_16x16x32_bf16 v[136:139], a[100:103], a[56:59], v[136:139]
v_mfma_f32_16x16x32_bf16 v[144:147], a[100:103], a[60:63], v[144:147]
s_add_u32 m0, s16, 0x800
v_mfma_f32_16x16x32_bf16 v[144:147], a[96:99], a[44:47], v[144:147]
buffer_load_dwordx4 v2, s[48:51], s12 offen lds
v_mfma_f32_16x16x32_bf16 v[148:151], a[104:107], a[44:47], v[148:151]
ds_read_b64_tr_b16 a[96:97], v12 offset:16640
v_mfma_f32_16x16x32_bf16 v[148:151], a[108:111], a[60:63], v[148:151]
ds_read_b64_tr_b16 a[98:99], v12 offset:17664
v_mfma_f32_16x16x32_bf16 v[140:143], a[108:111], a[56:59], v[140:143]
ds_read_b64_tr_b16 a[100:101], v12 offset:24832
v_mfma_f32_16x16x32_bf16 v[140:143], a[104:107], a[40:43], v[140:143]
ds_read_b64_tr_b16 a[102:103], v12 offset:25856
v_mfma_f32_16x16x32_bf16 v[132:135], a[104:107], a[36:39], v[132:135]
v_mfma_f32_16x16x32_bf16 v[132:135], a[108:111], a[52:55], v[132:135]
s_add_u32 m0, s16, 0xc00
v_mfma_f32_16x16x32_bf16 v[124:127], a[108:111], a[48:51], v[124:127]
buffer_load_dwordx4 v3, s[48:51], s12 offen lds
v_mfma_f32_16x16x32_bf16 v[124:127], a[104:107], a[32:35], v[124:127]
s_waitcnt lgkmcnt(4)
v_mfma_f32_16x16x32_bf16 v[152:155], a[32:35], a[80:83], v[152:155]
ds_read_b64_tr_b16 a[104:105], v13 offset:16640
v_mfma_f32_16x16x32_bf16 v[152:155], a[48:51], a[84:87], v[152:155]
ds_read_b64_tr_b16 a[106:107], v13 offset:17664
v_mfma_f32_16x16x32_bf16 v[156:159], a[52:55], a[84:87], v[156:159]
ds_read_b64_tr_b16 a[108:109], v13 offset:24832
v_mfma_f32_16x16x32_bf16 v[156:159], a[36:39], a[80:83], v[156:159]
ds_read_b64_tr_b16 a[110:111], v13 offset:25856
v_mfma_f32_16x16x32_bf16 v[160:163], a[40:43], a[80:83], v[160:163]
s_add_u32 m0, s16, 0x1000
v_mfma_f32_16x16x32_bf16 v[160:163], a[56:59], a[84:87], v[160:163]
buffer_load_dwordx4 v2, s[48:51], s13 offen lds
v_mfma_f32_16x16x32_bf16 v[164:167], a[60:63], a[84:87], v[164:167]
v_mfma_f32_16x16x32_bf16 v[164:167], a[44:47], a[80:83], v[164:167]
v_mfma_f32_16x16x32_bf16 v[180:183], a[44:47], a[88:91], v[180:183]
ds_read_b64_tr_b16 a[80:81], v12 offset:16896
v_mfma_f32_16x16x32_bf16 v[180:183], a[60:63], a[92:95], v[180:183]
ds_read_b64_tr_b16 a[82:83], v12 offset:17920
v_mfma_f32_16x16x32_bf16 v[176:179], a[56:59], a[92:95], v[176:179]
ds_read_b64_tr_b16 a[84:85], v12 offset:25088
v_mfma_f32_16x16x32_bf16 v[176:179], a[40:43], a[88:91], v[176:179]
ds_read_b64_tr_b16 a[86:87], v12 offset:26112
s_add_u32 m0, s16, 0x1400
v_mfma_f32_16x16x32_bf16 v[172:175], a[36:39], a[88:91], v[172:175]
buffer_load_dwordx4 v3, s[48:51], s13 offen lds
v_mfma_f32_16x16x32_bf16 v[172:175], a[52:55], a[92:95], v[172:175]
v_mfma_f32_16x16x32_bf16 v[168:171], a[48:51], a[92:95], v[168:171]
v_mfma_f32_16x16x32_bf16 v[168:171], a[32:35], a[88:91], v[168:171]
s_waitcnt lgkmcnt(4)
v_mfma_f32_16x16x32_bf16 v[184:187], a[32:35], a[96:99], v[184:187]
ds_read_b64_tr_b16 a[88:89], v13 offset:16896
v_mfma_f32_16x16x32_bf16 v[184:187], a[48:51], a[100:103], v[184:187]
ds_read_b64_tr_b16 a[90:91], v13 offset:17920
v_mfma_f32_16x16x32_bf16 v[188:191], a[52:55], a[100:103], v[188:191]
ds_read_b64_tr_b16 a[92:93], v13 offset:25088
s_add_u32 m0, s16, 0x1800
v_mfma_f32_16x16x32_bf16 v[188:191], a[36:39], a[96:99], v[188:191]
buffer_load_dwordx4 v2, s[48:51], s14 offen lds
v_mfma_f32_16x16x32_bf16 v[192:195], a[40:43], a[96:99], v[192:195]
ds_read_b64_tr_b16 a[94:95], v13 offset:26112
v_mfma_f32_16x16x32_bf16 v[192:195], a[56:59], a[100:103], v[192:195]
v_mfma_f32_16x16x32_bf16 v[196:199], a[60:63], a[100:103], v[196:199]
v_mfma_f32_16x16x32_bf16 v[196:199], a[44:47], a[96:99], v[196:199]
v_mfma_f32_16x16x32_bf16 v[212:215], a[44:47], a[104:107], v[212:215]
ds_read_b64_tr_b16 a[96:97], v12 offset:17152
v_mfma_f32_16x16x32_bf16 v[212:215], a[60:63], a[108:111], v[212:215]
ds_read_b64_tr_b16 a[98:99], v12 offset:18176
s_add_u32 m0, s16, 0x1c00
v_mfma_f32_16x16x32_bf16 v[208:211], a[56:59], a[108:111], v[208:211]
buffer_load_dwordx4 v3, s[48:51], s14 offen lds
v_mfma_f32_16x16x32_bf16 v[208:211], a[40:43], a[104:107], v[208:211]
ds_read_b64_tr_b16 a[100:101], v12 offset:25344
v_lshl_add_u32 v2, s42, 7, v2
v_mfma_f32_16x16x32_bf16 v[204:207], a[36:39], a[104:107], v[204:207]
ds_read_b64_tr_b16 a[102:103], v12 offset:26368
v_lshl_add_u32 v3, s42, 7, v3
v_mfma_f32_16x16x32_bf16 v[204:207], a[52:55], a[108:111], v[204:207]
v_mfma_f32_16x16x32_bf16 v[200:203], a[48:51], a[108:111], v[200:203]
v_mfma_f32_16x16x32_bf16 v[200:203], a[32:35], a[104:107], v[200:203]
s_waitcnt lgkmcnt(4)
v_mfma_f32_16x16x32_bf16 v[216:219], a[32:35], a[80:83], v[216:219]
ds_read_b64_tr_b16 a[104:105], v13 offset:17152
s_mov_b32 s9, 0x0
v_mfma_f32_16x16x32_bf16 v[216:219], a[48:51], a[84:87], v[216:219]
buffer_load_dword a120, v18, s[52:55], s9 offen
v_mfma_f32_16x16x32_bf16 v[220:223], a[52:55], a[84:87], v[220:223]
ds_read_b64_tr_b16 a[106:107], v13 offset:18176
v_mfma_f32_16x16x32_bf16 v[220:223], a[36:39], a[80:83], v[220:223]
ds_read_b64_tr_b16 a[108:109], v13 offset:25344
v_mfma_f32_16x16x32_bf16 v[224:227], a[40:43], a[80:83], v[224:227]
ds_read_b64_tr_b16 a[110:111], v13 offset:26368
v_add_u32 v12, 0x8000, v12
v_mfma_f32_16x16x32_bf16 v[224:227], a[56:59], a[84:87], v[224:227]
v_add_u32 v13, 0x8000, v13
v_mfma_f32_16x16x32_bf16 v[228:231], a[60:63], a[84:87], v[228:231]
v_mfma_f32_16x16x32_bf16 v[228:231], a[44:47], a[80:83], v[228:231]
v_mfma_f32_16x16x32_bf16 v[244:247], a[44:47], a[88:91], v[244:247]
s_waitcnt vmcnt(27) lgkmcnt(0)
v_mfma_f32_16x16x32_bf16 v[244:247], a[60:63], a[92:95], v[244:247]
s_barrier
s_add_u32 m0, s17, 0x0
v_mfma_f32_16x16x32_bf16 v[240:243], a[56:59], a[92:95], v[240:243]
buffer_load_dwordx4 v5, s[56:59], 0 offen lds
v_mfma_f32_16x16x32_bf16 v[240:243], a[40:43], a[88:91], v[240:243]
ds_read_b64_tr_b16 a[80:81], v12 offset:0
v_mfma_f32_16x16x32_bf16 v[236:239], a[36:39], a[88:91], v[236:239]
ds_read_b64_tr_b16 a[82:83], v12 offset:1024
v_mfma_f32_16x16x32_bf16 v[236:239], a[52:55], a[92:95], v[236:239]
ds_read_b64_tr_b16 a[84:85], v12 offset:8192
v_mfma_f32_16x16x32_bf16 v[232:235], a[48:51], a[92:95], v[232:235]
ds_read_b64_tr_b16 a[86:87], v12 offset:9216
v_mfma_f32_16x16x32_bf16 v[232:235], a[32:35], a[88:91], v[232:235]
s_waitcnt lgkmcnt(4)
v_mfma_f32_16x16x32_bf16 v[248:251], a[32:35], a[96:99], v[248:251]
ds_read_b64_tr_b16 a[88:89], v13 offset:0
s_add_u32 m0, s17, 0x4000
v_mfma_f32_16x16x32_bf16 v[248:251], a[48:51], a[100:103], v[248:251]
buffer_load_dwordx4 v5, s[60:63], 0 offen lds
v_mfma_f32_16x16x32_bf16 v[252:255], a[52:55], a[100:103], v[252:255]
ds_read_b64_tr_b16 a[90:91], v13 offset:1024
v_mfma_f32_16x16x32_bf16 v[252:255], a[36:39], a[96:99], v[252:255]
ds_read_b64_tr_b16 a[92:93], v13 offset:8192
v_mfma_f32_16x16x32_bf16 a[232:235], a[40:43], a[96:99], a[232:235]
ds_read_b64_tr_b16 a[94:95], v13 offset:9216
v_mfma_f32_16x16x32_bf16 a[232:235], a[56:59], a[100:103], a[232:235]
L_padA2:
s_cmp_eq_u32 s95, 1
s_cbranch_scc1 L_padA6
v_mfma_f32_16x16x32_bf16 a[236:239], a[60:63], a[100:103], a[236:239]
v_mfma_f32_16x16x32_bf16 a[236:239], a[44:47], a[96:99], a[236:239]
s_add_u32 m0, s17, 0x400
v_mfma_f32_16x16x32_bf16 a[252:255], a[44:47], a[104:107], a[252:255]
buffer_load_dwordx4 v5, s[56:59], s13 offen lds
v_mfma_f32_16x16x32_bf16 a[252:255], a[60:63], a[108:111], a[252:255]
ds_read_b64_tr_b16 a[96:97], v12 offset:256
v_mfma_f32_16x16x32_bf16 a[248:251], a[56:59], a[108:111], a[248:251]
ds_read_b64_tr_b16 a[98:99], v12 offset:1280
v_mfma_f32_16x16x32_bf16 a[248:251], a[40:43], a[104:107], a[248:251]
ds_read_b64_tr_b16 a[100:101], v12 offset:8448
v_mfma_f32_16x16x32_bf16 a[244:247], a[36:39], a[104:107], a[244:247]
ds_read_b64_tr_b16 a[102:103], v12 offset:9472
v_mfma_f32_16x16x32_bf16 a[244:247], a[52:55], a[108:111], a[244:247]
v_mfma_f32_16x16x32_bf16 a[240:243], a[48:51], a[108:111], a[240:243]
s_add_u32 m0, s17, 0x4400
s_waitcnt lgkmcnt(4)
v_mfma_f32_16x16x32_bf16 a[240:243], a[32:35], a[104:107], a[240:243]
buffer_load_dwordx4 v5, s[60:63], s13 offen lds
L_S4:
v_mfma_f32_16x16x32_bf16 v[24:27], a[80:83], a[0:3], v[24:27]
ds_read_b64_tr_b16 a[104:105], v13 offset:256
s_waitcnt vmcnt(23)
v_mfma_f32_16x16x32_bf16 v[24:27], a[84:87], a[16:19], v[24:27]
ds_read_b64_tr_b16 a[106:107], v13 offset:1280
v_mfma_f32_16x16x32_bf16 v[32:35], a[84:87], a[20:23], v[32:35]
ds_read_b64_tr_b16 a[108:109], v13 offset:8448
v_mfma_f32_16x16x32_bf16 v[32:35], a[80:83], a[4:7], v[32:35]
ds_read_b64_tr_b16 a[110:111], v13 offset:9472
v_mfma_f32_16x16x32_bf16 v[40:43], a[80:83], a[8:11], v[40:43]
ds_read_b128 a[32:35], v8 offset:32768
v_mfma_f32_16x16x32_bf16 v[40:43], a[84:87], a[24:27], v[40:43]
ds_read_b128 a[48:51], v9 offset:32768
s_add_u32 m0, s17, 0x800
v_mfma_f32_16x16x32_bf16 v[48:51], a[84:87], a[28:31], v[48:51]
buffer_load_dwordx4 v6, s[56:59], 0 offen lds
v_mfma_f32_16x16x32_bf16 v[48:51], a[80:83], a[12:15], v[48:51]
ds_read_b128 a[36:39], v8 offset:34816
v_mfma_f32_16x16x32_bf16 v[52:55], a[88:91], a[12:15], v[52:55]
ds_read_b64_tr_b16 a[80:81], v12 offset:512
v_mfma_f32_16x16x32_bf16 v[52:55], a[92:95], a[28:31], v[52:55]
ds_read_b64_tr_b16 a[82:83], v12 offset:1536
v_mfma_f32_16x16x32_bf16 v[44:47], a[92:95], a[24:27], v[44:47]
ds_read_b64_tr_b16 a[84:85], v12 offset:8704
v_mfma_f32_16x16x32_bf16 v[44:47], a[88:91], a[8:11], v[44:47]
ds_read_b64_tr_b16 a[86:87], v12 offset:9728
v_mfma_f32_16x16x32_bf16 v[36:39], a[88:91], a[4:7], v[36:39]
ds_read_b128 a[52:55], v9 offset:34816
s_add_u32 m0, s17, 0x4800
v_mfma_f32_16x16x32_bf16 v[36:39], a[92:95], a[20:23], v[36:39]
buffer_load_dwordx4 v6, s[60:63], 0 offen lds
v_mfma_f32_16x16x32_bf16 v[28:31], a[92:95], a[16:19], v[28:31]
ds_read_b128 a[40:43], v8 offset:36864
v_mfma_f32_16x16x32_bf16 v[28:31], a[88:91], a[0:3], v[28:31]
ds_read_b128 a[56:59], v9 offset:36864
s_waitcnt lgkmcnt(10)
v_mfma_f32_16x16x32_bf16 v[56:59], a[96:99], a[0:3], v[56:59]
ds_read_b64_tr_b16 a[88:89], v13 offset:512
v_mfma_f32_16x16x32_bf16 v[56:59], a[100:103], a[16:19], v[56:59]
ds_read_b64_tr_b16 a[90:91], v13 offset:1536
v_mfma_f32_16x16x32_bf16 v[64:67], a[100:103], a[20:23], v[64:67]
ds_read_b64_tr_b16 a[92:93], v13 offset:8704
v_mfma_f32_16x16x32_bf16 v[64:67], a[96:99], a[4:7], v[64:67]
ds_read_b64_tr_b16 a[94:95], v13 offset:9728
s_add_u32 m0, s17, 0xc00
v_mfma_f32_16x16x32_bf16 v[72:75], a[96:99], a[8:11], v[72:75]
buffer_load_dwordx4 v6, s[56:59], s13 offen lds
v_mfma_f32_16x16x32_bf16 v[72:75], a[100:103], a[24:27], v[72:75]
ds_read_b128 a[44:47], v8 offset:38912
v_mfma_f32_16x16x32_bf16 v[80:83], a[100:103], a[28:31], v[80:83]
ds_read_b128 a[60:63], v9 offset:38912
v_mfma_f32_16x16x32_bf16 v[80:83], a[96:99], a[12:15], v[80:83]
v_mfma_f32_16x16x32_bf16 v[84:87], a[104:107], a[12:15], v[84:87]
ds_read_b64_tr_b16 a[96:97], v12 offset:768
v_mfma_f32_16x16x32_bf16 v[84:87], a[108:111], a[28:31], v[84:87]
ds_read_b64_tr_b16 a[98:99], v12 offset:1792
v_mfma_f32_16x16x32_bf16 v[76:79], a[108:111], a[24:27], v[76:79]
ds_read_b64_tr_b16 a[100:101], v12 offset:8960
s_add_u32 m0, s17, 0x4c00
v_mfma_f32_16x16x32_bf16 v[76:79], a[104:107], a[8:11], v[76:79]
buffer_load_dwordx4 v6, s[60:63], s13 offen lds
v_mfma_f32_16x16x32_bf16 v[68:71], a[104:107], a[4:7], v[68:71]
ds_read_b64_tr_b16 a[102:103], v12 offset:9984
v_lshl_add_u32 v5, s42, 19, v5
v_mfma_f32_16x16x32_bf16 v[68:71], a[108:111], a[20:23], v[68:71]
v_lshl_add_u32 v6, s42, 19, v6
v_mfma_f32_16x16x32_bf16 v[60:63], a[108:111], a[16:19], v[60:63]
v_mfma_f32_16x16x32_bf16 v[60:63], a[104:107], a[0:3], v[60:63]
s_waitcnt lgkmcnt(6)
v_mfma_f32_16x16x32_bf16 v[88:91], a[80:83], a[0:3], v[88:91]
ds_read_b64_tr_b16 a[104:105], v13 offset:768
v_mfma_f32_16x16x32_bf16 v[88:91], a[84:87], a[16:19], v[88:91]
ds_read_b64_tr_b16 a[106:107], v13 offset:1792
s_mov_b32 s9, 0x0
v_mfma_f32_16x16x32_bf16 v[96:99], a[84:87], a[20:23], v[96:99]
buffer_load_dword a120, v1, s[68:71], s9 offen
v_mfma_f32_16x16x32_bf16 v[96:99], a[80:83], a[4:7], v[96:99]
ds_read_b64_tr_b16 a[108:109], v13 offset:8960
v_mfma_f32_16x16x32_bf16 v[104:107], a[80:83], a[8:11], v[104:107]
ds_read_b64_tr_b16 a[110:111], v13 offset:9984
v_mfma_f32_16x16x32_bf16 v[104:107], a[84:87], a[24:27], v[104:107]
v_mfma_f32_16x16x32_bf16 v[112:115], a[84:87], a[28:31], v[112:115]
v_mfma_f32_16x16x32_bf16 v[112:115], a[80:83], a[12:15], v[112:115]
s_waitcnt lgkmcnt(8)
v_mfma_f32_16x16x32_bf16 v[116:119], a[88:91], a[12:15], v[116:119]
ds_read_b64_tr_b16 a[80:81], v12 offset:16384
s_add_u32 m0, s16, 0x8000
v_mfma_f32_16x16x32_bf16 v[116:119], a[92:95], a[28:31], v[116:119]
buffer_load_dwordx4 v2, s[48:51], 0 offen lds
v_mfma_f32_16x16x32_bf16 v[108:111], a[92:95], a[24:27], v[108:111]
ds_read_b64_tr_b16 a[82:83], v12 offset:17408
v_mfma_f32_16x16x32_bf16 v[108:111], a[88:91], a[8:11], v[108:111]
ds_read_b64_tr_b16 a[84:85], v12 offset:24576
v_mfma_f32_16x16x32_bf16 v[100:103], a[88:91], a[4:7], v[100:103]
ds_read_b64_tr_b16 a[86:87], v12 offset:25600
v_mfma_f32_16x16x32_bf16 v[100:103], a[92:95], a[20:23], v[100:103]
v_mfma_f32_16x16x32_bf16 v[92:95], a[92:95], a[16:19], v[92:95]
v_mfma_f32_16x16x32_bf16 v[92:95], a[88:91], a[0:3], v[92:95]
s_add_u32 m0, s16, 0x8400
s_waitcnt lgkmcnt(4)
v_mfma_f32_16x16x32_bf16 v[120:123], a[96:99], a[0:3], v[120:123]
buffer_load_dwordx4 v3, s[48:51], 0 offen lds
v_mfma_f32_16x16x32_bf16 v[120:123], a[100:103], a[16:19], v[120:123]
ds_read_b64_tr_b16 a[88:89], v13 offset:16384
v_mfma_f32_16x16x32_bf16 v[128:131], a[100:103], a[20:23], v[128:131]
ds_read_b64_tr_b16 a[90:91], v13 offset:17408
v_mfma_f32_16x16x32_bf16 v[128:131], a[96:99], a[4:7], v[128:131]
ds_read_b64_tr_b16 a[92:93], v13 offset:24576
v_mfma_f32_16x16x32_bf16 v[136:139], a[96:99], a[8:11], v[136:139]
ds_read_b64_tr_b16 a[94:95], v13 offset:25600
v_mfma_f32_16x16x32_bf16 v[136:139], a[100:103], a[24:27], v[136:139]
v_mfma_f32_16x16x32_bf16 v[144:147], a[100:103], a[28:31], v[144:147]
s_add_u32 m0, s16, 0x8800
v_mfma_f32_16x16x32_bf16 v[144:147], a[96:99], a[12:15], v[144:147]
buffer_load_dwordx4 v2, s[48:51], s12 offen lds
v_mfma_f32_16x16x32_bf16 v[148:151], a[104:107], a[12:15], v[148:151]
ds_read_b64_tr_b16 a[96:97], v12 offset:16640
v_mfma_f32_16x16x32_bf16 v[148:151], a[108:111], a[28:31], v[148:151]
ds_read_b64_tr_b16 a[98:99], v12 offset:17664
v_mfma_f32_16x16x32_bf16 v[140:143], a[108:111], a[24:27], v[140:143]
ds_read_b64_tr_b16 a[100:101], v12 offset:24832
v_mfma_f32_16x16x32_bf16 v[140:143], a[104:107], a[8:11], v[140:143]
ds_read_b64_tr_b16 a[102:103], v12 offset:25856
v_mfma_f32_16x16x32_bf16 v[132:135], a[104:107], a[4:7], v[132:135]
v_mfma_f32_16x16x32_bf16 v[132:135], a[108:111], a[20:23], v[132:135]
s_add_u32 m0, s16, 0x8c00
v_mfma_f32_16x16x32_bf16 v[124:127], a[108:111], a[16:19], v[124:127]
buffer_load_dwordx4 v3, s[48:51], s12 offen lds
v_mfma_f32_16x16x32_bf16 v[124:127], a[104:107], a[0:3], v[124:127]
s_waitcnt lgkmcnt(4)
v_mfma_f32_16x16x32_bf16 v[152:155], a[0:3], a[80:83], v[152:155]
ds_read_b64_tr_b16 a[104:105], v13 offset:16640
v_mfma_f32_16x16x32_bf16 v[152:155], a[16:19], a[84:87], v[152:155]
ds_read_b64_tr_b16 a[106:107], v13 offset:17664
v_mfma_f32_16x16x32_bf16 v[156:159], a[20:23], a[84:87], v[156:159]
ds_read_b64_tr_b16 a[108:109], v13 offset:24832
v_mfma_f32_16x16x32_bf16 v[156:159], a[4:7], a[80:83], v[156:159]
ds_read_b64_tr_b16 a[110:111], v13 offset:25856
v_mfma_f32_16x16x32_bf16 v[160:163], a[8:11], a[80:83], v[160:163]
s_add_u32 m0, s16, 0x9000
v_mfma_f32_16x16x32_bf16 v[160:163], a[24:27], a[84:87], v[160:163]
buffer_load_dwordx4 v2, s[48:51], s13 offen lds
v_mfma_f32_16x16x32_bf16 v[164:167], a[28:31], a[84:87], v[164:167]
v_mfma_f32_16x16x32_bf16 v[164:167], a[12:15], a[80:83], v[164:167]
v_mfma_f32_16x16x32_bf16 v[180:183], a[12:15], a[88:91], v[180:183]
ds_read_b64_tr_b16 a[80:81], v12 offset:16896
v_mfma_f32_16x16x32_bf16 v[180:183], a[28:31], a[92:95], v[180:183]
ds_read_b64_tr_b16 a[82:83], v12 offset:17920
v_mfma_f32_16x16x32_bf16 v[176:179], a[24:27], a[92:95], v[176:179]
ds_read_b64_tr_b16 a[84:85], v12 offset:25088
v_mfma_f32_16x16x32_bf16 v[176:179], a[8:11], a[88:91], v[176:179]
ds_read_b64_tr_b16 a[86:87], v12 offset:26112
s_add_u32 m0, s16, 0x9400
v_mfma_f32_16x16x32_bf16 v[172:175], a[4:7], a[88:91], v[172:175]
buffer_load_dwordx4 v3, s[48:51], s13 offen lds
v_mfma_f32_16x16x32_bf16 v[172:175], a[20:23], a[92:95], v[172:175]
v_mfma_f32_16x16x32_bf16 v[168:171], a[16:19], a[92:95], v[168:171]
v_mfma_f32_16x16x32_bf16 v[168:171], a[0:3], a[88:91], v[168:171]
s_waitcnt lgkmcnt(4)
v_mfma_f32_16x16x32_bf16 v[184:187], a[0:3], a[96:99], v[184:187]
ds_read_b64_tr_b16 a[88:89], v13 offset:16896
v_mfma_f32_16x16x32_bf16 v[184:187], a[16:19], a[100:103], v[184:187]
ds_read_b64_tr_b16 a[90:91], v13 offset:17920
v_mfma_f32_16x16x32_bf16 v[188:191], a[20:23], a[100:103], v[188:191]
ds_read_b64_tr_b16 a[92:93], v13 offset:25088
s_add_u32 m0, s16, 0x9800
v_mfma_f32_16x16x32_bf16 v[188:191], a[4:7], a[96:99], v[188:191]
buffer_load_dwordx4 v2, s[48:51], s14 offen lds
v_mfma_f32_16x16x32_bf16 v[192:195], a[8:11], a[96:99], v[192:195]
ds_read_b64_tr_b16 a[94:95], v13 offset:26112
v_mfma_f32_16x16x32_bf16 v[192:195], a[24:27], a[100:103], v[192:195]
v_mfma_f32_16x16x32_bf16 v[196:199], a[28:31], a[100:103], v[196:199]
v_mfma_f32_16x16x32_bf16 v[196:199], a[12:15], a[96:99], v[196:199]
v_mfma_f32_16x16x32_bf16 v[212:215], a[12:15], a[104:107], v[212:215]
ds_read_b64_tr_b16 a[96:97], v12 offset:17152
v_mfma_f32_16x16x32_bf16 v[212:215], a[28:31], a[108:111], v[212:215]
ds_read_b64_tr_b16 a[98:99], v12 offset:18176
s_add_u32 m0, s16, 0x9c00
v_mfma_f32_16x16x32_bf16 v[208:211], a[24:27], a[108:111], v[208:211]
buffer_load_dwordx4 v3, s[48:51], s14 offen lds
v_mfma_f32_16x16x32_bf16 v[208:211], a[8:11], a[104:107], v[208:211]
ds_read_b64_tr_b16 a[100:101], v12 offset:25344
s_sub_u32 s42, s43, s41
v_mfma_f32_16x16x32_bf16 v[204:207], a[4:7], a[104:107], v[204:207]
ds_read_b64_tr_b16 a[102:103], v12 offset:26368
s_mov_b32 s41, s43
v_mfma_f32_16x16x32_bf16 v[204:207], a[20:23], a[108:111], v[204:207]
v_mfma_f32_16x16x32_bf16 v[200:203], a[16:19], a[108:111], v[200:203]
v_mfma_f32_16x16x32_bf16 v[200:203], a[0:3], a[104:107], v[200:203]
s_waitcnt lgkmcnt(4)
v_mfma_f32_16x16x32_bf16 v[216:219], a[0:3], a[80:83], v[216:219]
ds_read_b64_tr_b16 a[104:105], v13 offset:17152
s_mov_b32 s9, 0x800
v_mfma_f32_16x16x32_bf16 v[216:219], a[16:19], a[84:87], v[216:219]
buffer_load_dword a120, v1, s[68:71], s9 offen
v_mfma_f32_16x16x32_bf16 v[220:223], a[20:23], a[84:87], v[220:223]
ds_read_b64_tr_b16 a[106:107], v13 offset:18176
v_mfma_f32_16x16x32_bf16 v[220:223], a[4:7], a[80:83], v[220:223]
ds_read_b64_tr_b16 a[108:109], v13 offset:25344
v_mfma_f32_16x16x32_bf16 v[224:227], a[8:11], a[80:83], v[224:227]
ds_read_b64_tr_b16 a[110:111], v13 offset:26368
v_add_u32 v12, 0x8000, v12
v_mfma_f32_16x16x32_bf16 v[224:227], a[24:27], a[84:87], v[224:227]
v_add_u32 v13, 0x8000, v13
v_mfma_f32_16x16x32_bf16 v[228:231], a[28:31], a[84:87], v[228:231]
v_mfma_f32_16x16x32_bf16 v[228:231], a[12:15], a[80:83], v[228:231]
v_mfma_f32_16x16x32_bf16 v[244:247], a[12:15], a[88:91], v[244:247]
s_waitcnt vmcnt(28) lgkmcnt(0)
v_mfma_f32_16x16x32_bf16 v[244:247], a[28:31], a[92:95], v[244:247]
s_barrier
s_add_u32 m0, s17, 0x8000
v_mfma_f32_16x16x32_bf16 v[240:243], a[24:27], a[92:95], v[240:243]
buffer_load_dwordx4 v5, s[56:59], 0 offen lds
v_mfma_f32_16x16x32_bf16 v[240:243], a[8:11], a[88:91], v[240:243]
ds_read_b64_tr_b16 a[80:81], v12 offset:0
v_mfma_f32_16x16x32_bf16 v[236:239], a[4:7], a[88:91], v[236:239]
ds_read_b64_tr_b16 a[82:83], v12 offset:1024
v_mfma_f32_16x16x32_bf16 v[236:239], a[20:23], a[92:95], v[236:239]
ds_read_b64_tr_b16 a[84:85], v12 offset:8192
v_mfma_f32_16x16x32_bf16 v[232:235], a[16:19], a[92:95], v[232:235]
ds_read_b64_tr_b16 a[86:87], v12 offset:9216
v_mfma_f32_16x16x32_bf16 v[232:235], a[0:3], a[88:91], v[232:235]
s_waitcnt lgkmcnt(4)
v_mfma_f32_16x16x32_bf16 v[248:251], a[0:3], a[96:99], v[248:251]
ds_read_b64_tr_b16 a[88:89], v13 offset:0
s_add_u32 m0, s17, 0xc000
v_mfma_f32_16x16x32_bf16 v[248:251], a[16:19], a[100:103], v[248:251]
buffer_load_dwordx4 v5, s[60:63], 0 offen lds
v_mfma_f32_16x16x32_bf16 v[252:255], a[20:23], a[100:103], v[252:255]
ds_read_b64_tr_b16 a[90:91], v13 offset:1024
v_mfma_f32_16x16x32_bf16 v[252:255], a[4:7], a[96:99], v[252:255]
ds_read_b64_tr_b16 a[92:93], v13 offset:8192
v_mfma_f32_16x16x32_bf16 a[232:235], a[8:11], a[96:99], a[232:235]
ds_read_b64_tr_b16 a[94:95], v13 offset:9216
v_mfma_f32_16x16x32_bf16 a[232:235], a[24:27], a[100:103], a[232:235]
v_mfma_f32_16x16x32_bf16 a[236:239], a[28:31], a[100:103], a[236:239]
v_mfma_f32_16x16x32_bf16 a[236:239], a[12:15], a[96:99], a[236:239]
s_add_u32 m0, s17, 0x8400
v_mfma_f32_16x16x32_bf16 a[252:255], a[12:15], a[104:107], a[252:255]
buffer_load_dwordx4 v5, s[56:59], s13 offen lds
v_mfma_f32_16x16x32_bf16 a[252:255], a[28:31], a[108:111], a[252:255]
ds_read_b64_tr_b16 a[96:97], v12 offset:256
v_mfma_f32_16x16x32_bf16 a[248:251], a[24:27], a[108:111], a[248:251]
ds_read_b64_tr_b16 a[98:99], v12 offset:1280
v_mfma_f32_16x16x32_bf16 a[248:251], a[8:11], a[104:107], a[248:251]
ds_read_b64_tr_b16 a[100:101], v12 offset:8448
v_mfma_f32_16x16x32_bf16 a[244:247], a[4:7], a[104:107], a[244:247]
ds_read_b64_tr_b16 a[102:103], v12 offset:9472
v_mfma_f32_16x16x32_bf16 a[244:247], a[20:23], a[108:111], a[244:247]
v_mfma_f32_16x16x32_bf16 a[240:243], a[16:19], a[108:111], a[240:243]
v_mfma_f32_16x16x32_bf16 a[240:243], a[0:3], a[104:107], a[240:243]
s_add_u32 m0, s17, 0xc400
s_waitcnt lgkmcnt(4)
L_S5:
v_mfma_f32_16x16x32_bf16 v[24:27], a[80:83], a[32:35], v[24:27]
buffer_load_dwordx4 v5, s[60:63], s13 offen lds
v_mfma_f32_16x16x32_bf16 v[24:27], a[84:87], a[48:51], v[24:27]
ds_read_b64_tr_b16 a[104:105], v13 offset:256
s_waitcnt vmcnt(23)
v_mfma_f32_16x16x32_bf16 v[32:35], a[84:87], a[52:55], v[32:35]
ds_read_b64_tr_b16 a[106:107], v13 offset:1280
v_mfma_f32_16x16x32_bf16 v[32:35], a[80:83], a[36:39], v[32:35]
ds_read_b64_tr_b16 a[108:109], v13 offset:8448
v_mfma_f32_16x16x32_bf16 v[40:43], a[80:83], a[40:43], v[40:43]
ds_read_b64_tr_b16 a[110:111], v13 offset:9472
v_mfma_f32_16x16x32_bf16 v[40:43], a[84:87], a[56:59], v[40:43]
ds_read_b128 a[0:3], v8 offset:0
v_mfma_f32_16x16x32_bf16 v[48:51], a[84:87], a[60:63], v[48:51]
ds_read_b128 a[16:19], v9 offset:0
s_add_u32 m0, s17, 0x8800
v_mfma_f32_16x16x32_bf16 v[48:51], a[80:83], a[44:47], v[48:51]
buffer_load_dwordx4 v6, s[56:59], 0 offen lds
v_mfma_f32_16x16x32_bf16 v[52:55], a[88:91], a[44:47], v[52:55]
ds_read_b64_tr_b16 a[80:81], v12 offset:512
v_mfma_f32_16x16x32_bf16 v[52:55], a[92:95], a[60:63], v[52:55]
ds_read_b64_tr_b16 a[82:83], v12 offset:1536
v_mfma_f32_16x16x32_bf16 v[44:47], a[92:95], a[56:59], v[44:47]
ds_read_b64_tr_b16 a[84:85], v12 offset:8704
v_mfma_f32_16x16x32_bf16 v[44:47], a[88:91], a[40:43], v[44:47]
ds_read_b64_tr_b16 a[86:87], v12 offset:9728
v_mfma_f32_16x16x32_bf16 v[36:39], a[88:91], a[36:39], v[36:39]
ds_read_b128 a[4:7], v8 offset:2048
v_mfma_f32_16x16x32_bf16 v[36:39], a[92:95], a[52:55], v[36:39]
ds_read_b128 a[20:23], v9 offset:2048
s_waitcnt lgkmcnt(8)
v_mfma_f32_16x16x32_bf16 v[28:31], a[92:95], a[48:51], v[28:31]
ds_read_b128 a[8:11], v8 offset:4096
s_add_u32 m0, s17, 0xc800
v_mfma_f32_16x16x32_bf16 v[28:31], a[88:91], a[32:35], v[28:31]
buffer_load_dwordx4 v6, s[60:63], 0 offen lds
v_mfma_f32_16x16x32_bf16 v[56:59], a[96:99], a[32:35], v[56:59]
ds_read_b64_tr_b16 a[88:89], v13 offset:512
v_mfma_f32_16x16x32_bf16 v[56:59], a[100:103], a[48:51], v[56:59]
ds_read_b64_tr_b16 a[90:91], v13 offset:1536
v_mfma_f32_16x16x32_bf16 v[64:67], a[100:103], a[52:55], v[64:67]
ds_read_b64_tr_b16 a[92:93], v13 offset:8704
v_mfma_f32_16x16x32_bf16 v[64:67], a[96:99], a[36:39], v[64:67]
ds_read_b64_tr_b16 a[94:95], v13 offset:9728
v_mfma_f32_16x16x32_bf16 v[72:75], a[96:99], a[40:43], v[72:75]
ds_read_b128 a[24:27], v9 offset:4096
v_mfma_f32_16x16x32_bf16 v[72:75], a[100:103], a[56:59], v[72:75]
ds_read_b128 a[12:15], v8 offset:6144
s_add_u32 m0, s17, 0x8c00
v_mfma_f32_16x16x32_bf16 v[80:83], a[100:103], a[60:63], v[80:83]
buffer_load_dwordx4 v6, s[56:59], s13 offen lds
v_mfma_f32_16x16x32_bf16 v[80:83], a[96:99], a[44:47], v[80:83]
ds_read_b128 a[28:31], v9 offset:6144
v_mfma_f32_16x16x32_bf16 v[84:87], a[104:107], a[44:47], v[84:87]
ds_read_b64_tr_b16 a[96:97], v12 offset:768
v_mfma_f32_16x16x32_bf16 v[84:87], a[108:111], a[60:63], v[84:87]
ds_read_b64_tr_b16 a[98:99], v12 offset:1792
v_mfma_f32_16x16x32_bf16 v[76:79], a[108:111], a[56:59], v[76:79]
ds_read_b64_tr_b16 a[100:101], v12 offset:8960
v_mfma_f32_16x16x32_bf16 v[76:79], a[104:107], a[40:43], v[76:79]
ds_read_b64_tr_b16 a[102:103], v12 offset:9984
v_mfma_f32_16x16x32_bf16 v[68:71], a[104:107], a[36:39], v[68:71]
s_add_u32 m0, s17, 0xcc00
v_mfma_f32_16x16x32_bf16 v[68:71], a[108:111], a[52:55], v[68:71]
buffer_load_dwordx4 v6, s[60:63], s13 offen lds
v_mfma_f32_16x16x32_bf16 v[60:63], a[108:111], a[48:51], v[60:63]
v_lshl_add_u32 v5, s42, 19, v5
v_lshl_add_u32 v6, s42, 19, v6
v_mfma_f32_16x16x32_bf16 v[60:63], a[104:107], a[32:35], v[60:63]
s_waitcnt lgkmcnt(7)
v_mfma_f32_16x16x32_bf16 v[88:91], a[80:83], a[32:35], v[88:91]
ds_read_b64_tr_b16 a[104:105], v13 offset:768
v_mfma_f32_16x16x32_bf16 v[88:91], a[84:87], a[48:51], v[88:91]
ds_read_b64_tr_b16 a[106:107], v13 offset:1792
v_mfma_f32_16x16x32_bf16 v[96:99], a[84:87], a[52:55], v[96:99]
ds_read_b64_tr_b16 a[108:109], v13 offset:8960
v_mfma_f32_16x16x32_bf16 v[96:99], a[80:83], a[36:39], v[96:99]
ds_read_b64_tr_b16 a[110:111], v13 offset:9984
v_mfma_f32_16x16x32_bf16 v[104:107], a[80:83], a[40:43], v[104:107]
s_add_u32 m0, s16, 0x0
s_waitcnt lgkmcnt(8)
v_mfma_f32_16x16x32_bf16 v[104:107], a[84:87], a[56:59], v[104:107]
buffer_load_dwordx4 v22, s[44:47], s20 offen lds
v_mfma_f32_16x16x32_bf16 v[112:115], a[84:87], a[60:63], v[112:115]
v_mfma_f32_16x16x32_bf16 v[112:115], a[80:83], a[44:47], v[112:115]
v_mfma_f32_16x16x32_bf16 v[116:119], a[88:91], a[44:47], v[116:119]
ds_read_b64_tr_b16 a[80:81], v12 offset:16384
v_mfma_f32_16x16x32_bf16 v[116:119], a[92:95], a[60:63], v[116:119]
ds_read_b64_tr_b16 a[82:83], v12 offset:17408
v_mfma_f32_16x16x32_bf16 v[108:111], a[92:95], a[56:59], v[108:111]
ds_read_b64_tr_b16 a[84:85], v12 offset:24576
v_mfma_f32_16x16x32_bf16 v[108:111], a[88:91], a[40:43], v[108:111]
ds_read_b64_tr_b16 a[86:87], v12 offset:25600
s_add_u32 m0, s16, 0x400
v_mfma_f32_16x16x32_bf16 v[100:103], a[88:91], a[36:39], v[100:103]
buffer_load_dwordx4 v23, s[44:47], s20 offen lds
v_mfma_f32_16x16x32_bf16 v[100:103], a[92:95], a[52:55], v[100:103]
v_mfma_f32_16x16x32_bf16 v[92:95], a[92:95], a[48:51], v[92:95]
v_mfma_f32_16x16x32_bf16 v[92:95], a[88:91], a[32:35], v[92:95]
s_waitcnt lgkmcnt(4)
v_mfma_f32_16x16x32_bf16 v[120:123], a[96:99], a[32:35], v[120:123]
ds_read_b64_tr_b16 a[88:89], v13 offset:16384
v_mfma_f32_16x16x32_bf16 v[120:123], a[100:103], a[48:51], v[120:123]
ds_read_b64_tr_b16 a[90:91], v13 offset:17408
v_mfma_f32_16x16x32_bf16 v[128:131], a[100:103], a[52:55], v[128:131]
ds_read_b64_tr_b16 a[92:93], v13 offset:24576
v_mfma_f32_16x16x32_bf16 v[128:131], a[96:99], a[36:39], v[128:131]
ds_read_b64_tr_b16 a[94:95], v13 offset:25600
s_add_u32 m0, s16, 0x800
v_mfma_f32_16x16x32_bf16 v[136:139], a[96:99], a[40:43], v[136:139]
buffer_load_dwordx4 v22, s[44:47], s21 offen lds
v_mfma_f32_16x16x32_bf16 v[136:139], a[100:103], a[56:59], v[136:139]
v_mfma_f32_16x16x32_bf16 v[144:147], a[100:103], a[60:63], v[144:147]
v_mfma_f32_16x16x32_bf16 v[144:147], a[96:99], a[44:47], v[144:147]
v_mfma_f32_16x16x32_bf16 v[148:151], a[104:107], a[44:47], v[148:151]
ds_read_b64_tr_b16 a[96:97], v12 offset:16640
v_mfma_f32_16x16x32_bf16 v[148:151], a[108:111], a[60:63], v[148:151]
ds_read_b64_tr_b16 a[98:99], v12 offset:17664
v_mfma_f32_16x16x32_bf16 v[140:143], a[108:111], a[56:59], v[140:143]
ds_read_b64_tr_b16 a[100:101], v12 offset:24832
s_add_u32 m0, s16, 0xc00
v_mfma_f32_16x16x32_bf16 v[140:143], a[104:107], a[40:43], v[140:143]
buffer_load_dwordx4 v23, s[44:47], s21 offen lds
v_mfma_f32_16x16x32_bf16 v[132:135], a[104:107], a[36:39], v[132:135]
ds_read_b64_tr_b16 a[102:103], v12 offset:25856
v_mfma_f32_16x16x32_bf16 v[132:135], a[108:111], a[52:55], v[132:135]
v_mfma_f32_16x16x32_bf16 v[124:127], a[108:111], a[48:51], v[124:127]
v_mfma_f32_16x16x32_bf16 v[124:127], a[104:107], a[32:35], v[124:127]
s_waitcnt lgkmcnt(4)
v_mfma_f32_16x16x32_bf16 v[152:155], a[32:35], a[80:83], v[152:155]
ds_read_b64_tr_b16 a[104:105], v13 offset:16640
v_mfma_f32_16x16x32_bf16 v[152:155], a[48:51], a[84:87], v[152:155]
ds_read_b64_tr_b16 a[106:107], v13 offset:17664
s_add_u32 m0, s16, 0x1000
v_mfma_f32_16x16x32_bf16 v[156:159], a[52:55], a[84:87], v[156:159]
buffer_load_dwordx4 v22, s[44:47], s22 offen lds
v_mfma_f32_16x16x32_bf16 v[156:159], a[36:39], a[80:83], v[156:159]
ds_read_b64_tr_b16 a[108:109], v13 offset:24832
v_mfma_f32_16x16x32_bf16 v[160:163], a[40:43], a[80:83], v[160:163]
ds_read_b64_tr_b16 a[110:111], v13 offset:25856
v_mfma_f32_16x16x32_bf16 v[160:163], a[56:59], a[84:87], v[160:163]
v_mfma_f32_16x16x32_bf16 v[164:167], a[60:63], a[84:87], v[164:167]
v_mfma_f32_16x16x32_bf16 v[164:167], a[44:47], a[80:83], v[164:167]
v_mfma_f32_16x16x32_bf16 v[180:183], a[44:47], a[88:91], v[180:183]
ds_read_b64_tr_b16 a[80:81], v12 offset:16896
v_mfma_f32_16x16x32_bf16 v[180:183], a[60:63], a[92:95], v[180:183]
ds_read_b64_tr_b16 a[82:83], v12 offset:17920
s_add_u32 m0, s16, 0x1400
v_mfma_f32_16x16x32_bf16 v[176:179], a[56:59], a[92:95], v[176:179]
buffer_load_dwordx4 v23, s[44:47], s22 offen lds
v_mfma_f32_16x16x32_bf16 v[176:179], a[40:43], a[88:91], v[176:179]
ds_read_b64_tr_b16 a[84:85], v12 offset:25088
v_mfma_f32_16x16x32_bf16 v[172:175], a[36:39], a[88:91], v[172:175]
ds_read_b64_tr_b16 a[86:87], v12 offset:26112
v_mfma_f32_16x16x32_bf16 v[172:175], a[52:55], a[92:95], v[172:175]
v_mfma_f32_16x16x32_bf16 v[168:171], a[48:51], a[92:95], v[168:171]
v_mfma_f32_16x16x32_bf16 v[168:171], a[32:35], a[88:91], v[168:171]
s_waitcnt lgkmcnt(4)
v_mfma_f32_16x16x32_bf16 v[184:187], a[32:35], a[96:99], v[184:187]
ds_read_b64_tr_b16 a[88:89], v13 offset:16896
s_add_u32 m0, s16, 0x1800
v_mfma_f32_16x16x32_bf16 v[184:187], a[48:51], a[100:103], v[184:187]
buffer_load_dwordx4 v22, s[44:47], s23 offen lds
v_mfma_f32_16x16x32_bf16 v[188:191], a[52:55], a[100:103], v[188:191]
ds_read_b64_tr_b16 a[90:91], v13 offset:17920
v_mfma_f32_16x16x32_bf16 v[188:191], a[36:39], a[96:99], v[188:191]
ds_read_b64_tr_b16 a[92:93], v13 offset:25088
v_mfma_f32_16x16x32_bf16 v[192:195], a[40:43], a[96:99], v[192:195]
ds_read_b64_tr_b16 a[94:95], v13 offset:26112
v_mfma_f32_16x16x32_bf16 v[192:195], a[56:59], a[100:103], v[192:195]
v_mfma_f32_16x16x32_bf16 v[196:199], a[60:63], a[100:103], v[196:199]
v_mfma_f32_16x16x32_bf16 v[196:199], a[44:47], a[96:99], v[196:199]
v_mfma_f32_16x16x32_bf16 v[212:215], a[44:47], a[104:107], v[212:215]
ds_read_b64_tr_b16 a[96:97], v12 offset:17152
s_add_u32 m0, s16, 0x1c00
v_mfma_f32_16x16x32_bf16 v[212:215], a[60:63], a[108:111], v[212:215]
buffer_load_dwordx4 v23, s[44:47], s23 offen lds
v_mfma_f32_16x16x32_bf16 v[208:211], a[56:59], a[108:111], v[208:211]
ds_read_b64_tr_b16 a[98:99], v12 offset:18176
s_mov_b32 s42, 1
v_mfma_f32_16x16x32_bf16 v[208:211], a[40:43], a[104:107], v[208:211]
ds_read_b64_tr_b16 a[100:101], v12 offset:25344
v_lshl_add_u32 v22, s42, 7, v22
v_mfma_f32_16x16x32_bf16 v[204:207], a[36:39], a[104:107], v[204:207]
ds_read_b64_tr_b16 a[102:103], v12 offset:26368
v_lshl_add_u32 v23, s42, 7, v23
v_mfma_f32_16x16x32_bf16 v[204:207], a[52:55], a[108:111], v[204:207]
v_mfma_f32_16x16x32_bf16 v[200:203], a[48:51], a[108:111], v[200:203]
v_mfma_f32_16x16x32_bf16 v[200:203], a[32:35], a[104:107], v[200:203]
s_mov_b32 s9, 0x1000
s_waitcnt lgkmcnt(4)
v_mfma_f32_16x16x32_bf16 v[216:219], a[32:35], a[80:83], v[216:219]
buffer_load_dword a120, v1, s[68:71], s9 offen
v_mfma_f32_16x16x32_bf16 v[216:219], a[48:51], a[84:87], v[216:219]
ds_read_b64_tr_b16 a[104:105], v13 offset:17152
v_mfma_f32_16x16x32_bf16 v[220:223], a[52:55], a[84:87], v[220:223]
ds_read_b64_tr_b16 a[106:107], v13 offset:18176
v_mfma_f32_16x16x32_bf16 v[220:223], a[36:39], a[80:83], v[220:223]
ds_read_b64_tr_b16 a[108:109], v13 offset:25344
v_mfma_f32_16x16x32_bf16 v[224:227], a[40:43], a[80:83], v[224:227]
ds_read_b64_tr_b16 a[110:111], v13 offset:26368
v_add_u32 v12, 0xffff0000, v12
v_mfma_f32_16x16x32_bf16 v[224:227], a[56:59], a[84:87], v[224:227]
v_add_u32 v13, 0xffff0000, v13
v_mfma_f32_16x16x32_bf16 v[228:231], a[60:63], a[84:87], v[228:231]
v_mfma_f32_16x16x32_bf16 v[228:231], a[44:47], a[80:83], v[228:231]
v_mfma_f32_16x16x32_bf16 v[244:247], a[44:47], a[88:91], v[244:247]
s_waitcnt vmcnt(27) lgkmcnt(0)
v_mfma_f32_16x16x32_bf16 v[244:247], a[60:63], a[92:95], v[244:247]
s_barrier
s_add_u32 m0, s17, 0x10000
v_mfma_f32_16x16x32_bf16 v[240:243], a[56:59], a[92:95], v[240:243]
buffer_load_dwordx4 v5, s[52:55], 0 offen lds
v_mfma_f32_16x16x32_bf16 v[240:243], a[40:43], a[88:91], v[240:243]
ds_read_b64_tr_b16 a[80:81], v12 offset:0
s_mul_i32 s28, s5, 0x10c400
v_mfma_f32_16x16x32_bf16 v[236:239], a[36:39], a[88:91], v[236:239]
ds_read_b64_tr_b16 a[82:83], v12 offset:1024
s_mov_b32 s48, s88
v_mfma_f32_16x16x32_bf16 v[236:239], a[52:55], a[92:95], v[236:239]
ds_read_b64_tr_b16 a[84:85], v12 offset:8192
s_mov_b32 s49, s89
v_mfma_f32_16x16x32_bf16 v[232:235], a[48:51], a[92:95], v[232:235]
ds_read_b64_tr_b16 a[86:87], v12 offset:9216
s_sub_u32 s11, 16, s6
v_mfma_f32_16x16x32_bf16 v[232:235], a[32:35], a[88:91], v[232:235]
s_waitcnt lgkmcnt(4)
s_lshl_b32 s11, s11, 16
s_add_u32 s11, s11, s28
v_mfma_f32_16x16x32_bf16 v[248:251], a[32:35], a[96:99], v[248:251]
ds_read_b64_tr_b16 a[88:89], v13 offset:0
s_add_u32 m0, s17, 0x10400
v_mfma_f32_16x16x32_bf16 v[248:251], a[48:51], a[100:103], v[248:251]
buffer_load_dwordx4 v5, s[52:55], s13 offen lds
v_mfma_f32_16x16x32_bf16 v[252:255], a[52:55], a[100:103], v[252:255]
ds_read_b64_tr_b16 a[90:91], v13 offset:1024
s_add_u32 s50, s11, 0x2000
v_mfma_f32_16x16x32_bf16 v[252:255], a[36:39], a[96:99], v[252:255]
ds_read_b64_tr_b16 a[92:93], v13 offset:8192
s_lshl_b32 s11, s6, 17
v_mfma_f32_16x16x32_bf16 a[232:235], a[40:43], a[96:99], a[232:235]
ds_read_b64_tr_b16 a[94:95], v13 offset:9216
s_add_u32 s28, s28, s11
v_mfma_f32_16x16x32_bf16 a[232:235], a[56:59], a[100:103], a[232:235]
s_lshl_b32 s11, s4, 15
s_add_u32 s28, s28, s11
s_lshl_b32 s10, s5, 2
v_mfma_f32_16x16x32_bf16 a[236:239], a[60:63], a[100:103], a[236:239]
s_add_u32 s10, s10, 64
v_mfma_f32_16x16x32_bf16 a[236:239], a[44:47], a[96:99], a[236:239]
s_add_u32 m0, s17, 0x10800
v_mfma_f32_16x16x32_bf16 a[252:255], a[44:47], a[104:107], a[252:255]
buffer_load_dwordx4 v6, s[52:55], 0 offen lds
v_mfma_f32_16x16x32_bf16 a[252:255], a[60:63], a[108:111], a[252:255]
ds_read_b64_tr_b16 a[96:97], v12 offset:256
L_padA3:
s_cmp_eq_u32 s95, 1
s_cbranch_scc1 L_padA7
v_mfma_f32_16x16x32_bf16 a[248:251], a[56:59], a[108:111], a[248:251]
ds_read_b64_tr_b16 a[98:99], v12 offset:1280
v_mfma_f32_16x16x32_bf16 a[248:251], a[40:43], a[104:107], a[248:251]
ds_read_b64_tr_b16 a[100:101], v12 offset:8448
v_mfma_f32_16x16x32_bf16 a[244:247], a[36:39], a[104:107], a[244:247]
ds_read_b64_tr_b16 a[102:103], v12 offset:9472
v_mfma_f32_16x16x32_bf16 a[244:247], a[52:55], a[108:111], a[244:247]
v_mfma_f32_16x16x32_bf16 a[240:243], a[48:51], a[108:111], a[240:243]
v_mfma_f32_16x16x32_bf16 a[240:243], a[32:35], a[104:107], a[240:243]
s_add_u32 m0, s17, 0x10c00
s_waitcnt lgkmcnt(4)
L_S6:
v_mfma_f32_16x16x32_bf16 v[24:27], a[80:83], a[0:3], v[24:27]
buffer_load_dwordx4 v6, s[52:55], s13 offen lds
v_mfma_f32_16x16x32_bf16 v[24:27], a[84:87], a[16:19], v[24:27]
ds_read_b64_tr_b16 a[104:105], v13 offset:256
s_waitcnt vmcnt(22)
v_mfma_f32_16x16x32_bf16 v[32:35], a[84:87], a[20:23], v[32:35]
ds_read_b64_tr_b16 a[106:107], v13 offset:1280
v_mfma_f32_16x16x32_bf16 v[32:35], a[80:83], a[4:7], v[32:35]
ds_read_b64_tr_b16 a[108:109], v13 offset:8448
v_mfma_f32_16x16x32_bf16 v[40:43], a[80:83], a[8:11], v[40:43]
ds_read_b64_tr_b16 a[110:111], v13 offset:9472
v_mfma_f32_16x16x32_bf16 v[40:43], a[84:87], a[24:27], v[40:43]
ds_read_b128 a[32:35], v8 offset:32768
v_mfma_f32_16x16x32_bf16 v[48:51], a[84:87], a[28:31], v[48:51]
ds_read_b128 a[48:51], v9 offset:32768
s_add_u32 m0, s18, 0x14000
v_mfma_f32_16x16x32_bf16 v[48:51], a[80:83], a[12:15], v[48:51]
buffer_load_dwordx4 v7, s[68:71], 0 offen lds
v_mfma_f32_16x16x32_bf16 v[52:55], a[88:91], a[12:15], v[52:55]
ds_read_b64_tr_b16 a[80:81], v12 offset:512
v_mfma_f32_16x16x32_bf16 v[52:55], a[92:95], a[28:31], v[52:55]
ds_read_b64_tr_b16 a[82:83], v12 offset:1536
v_mfma_f32_16x16x32_bf16 v[44:47], a[92:95], a[24:27], v[44:47]
ds_read_b64_tr_b16 a[84:85], v12 offset:8704
v_mfma_f32_16x16x32_bf16 v[44:47], a[88:91], a[8:11], v[44:47]
ds_read_b64_tr_b16 a[86:87], v12 offset:9728
v_mfma_f32_16x16x32_bf16 v[36:39], a[88:91], a[4:7], v[36:39]
ds_read_b128 a[36:39], v8 offset:34816
v_mfma_f32_16x16x32_bf16 v[36:39], a[92:95], a[20:23], v[36:39]
ds_read_b128 a[52:55], v9 offset:34816
s_waitcnt lgkmcnt(8)
v_mfma_f32_16x16x32_bf16 v[28:31], a[92:95], a[16:19], v[28:31]
ds_read_b128 a[40:43], v8 offset:36864
s_add_u32 m0, s18, 0x15000
v_mfma_f32_16x16x32_bf16 v[28:31], a[88:91], a[0:3], v[28:31]
buffer_load_dwordx4 v7, s[68:71], s25 offen lds
v_mfma_f32_16x16x32_bf16 v[56:59], a[96:99], a[0:3], v[56:59]
ds_read_b64_tr_b16 a[88:89], v13 offset:512
v_mfma_f32_16x16x32_bf16 v[56:59], a[100:103], a[16:19], v[56:59]
ds_read_b64_tr_b16 a[90:91], v13 offset:1536
v_mfma_f32_16x16x32_bf16 v[64:67], a[100:103], a[20:23], v[64:67]
ds_read_b64_tr_b16 a[92:93], v13 offset:8704
v_mfma_f32_16x16x32_bf16 v[64:67], a[96:99], a[4:7], v[64:67]
ds_read_b64_tr_b16 a[94:95], v13 offset:9728
v_mfma_f32_16x16x32_bf16 v[72:75], a[96:99], a[8:11], v[72:75]
ds_read_b128 a[56:59], v9 offset:36864
v_mfma_f32_16x16x32_bf16 v[72:75], a[100:103], a[24:27], v[72:75]
ds_read_b128 a[44:47], v8 offset:38912
s_add_u32 m0, s18, 0x16000
v_mfma_f32_16x16x32_bf16 v[80:83], a[100:103], a[28:31], v[80:83]
buffer_load_dwordx4 v7, s[68:71], s26 offen lds
v_mfma_f32_16x16x32_bf16 v[80:83], a[96:99], a[12:15], v[80:83]
ds_read_b128 a[60:63], v9 offset:38912
v_lshl_add_u32 v5, s42, 19, v5
v_mfma_f32_16x16x32_bf16 v[84:87], a[104:107], a[12:15], v[84:87]
ds_read_b64_tr_b16 a[96:97], v12 offset:768
v_lshl_add_u32 v6, s42, 19, v6
v_mfma_f32_16x16x32_bf16 v[84:87], a[108:111], a[28:31], v[84:87]
ds_read_b64_tr_b16 a[98:99], v12 offset:1792
v_lshl_add_u32 v7, s42, 18, v7
v_mfma_f32_16x16x32_bf16 v[76:79], a[108:111], a[24:27], v[76:79]
ds_read_b64_tr_b16 a[100:101], v12 offset:8960
v_lshl_add_u32 v7, s42, 17, v7
v_mfma_f32_16x16x32_bf16 v[76:79], a[104:107], a[8:11], v[76:79]
ds_read_b64_tr_b16 a[102:103], v12 offset:9984
v_mfma_f32_16x16x32_bf16 v[68:71], a[104:107], a[4:7], v[68:71]
v_mfma_f32_16x16x32_bf16 v[68:71], a[108:111], a[20:23], v[68:71]
buffer_store_dwordx4 a[64:67], v4, s[88:91], 0 offen sc1
v_mfma_f32_16x16x32_bf16 v[60:63], a[108:111], a[16:19], v[60:63]
v_mfma_f32_16x16x32_bf16 v[60:63], a[104:107], a[0:3], v[60:63]
s_waitcnt lgkmcnt(7)
v_mfma_f32_16x16x32_bf16 v[88:91], a[80:83], a[0:3], v[88:91]
ds_read_b64_tr_b16 a[104:105], v13 offset:768
v_mfma_f32_16x16x32_bf16 v[88:91], a[84:87], a[16:19], v[88:91]
ds_read_b64_tr_b16 a[106:107], v13 offset:1792
v_mfma_f32_16x16x32_bf16 v[96:99], a[84:87], a[20:23], v[96:99]
ds_read_b64_tr_b16 a[108:109], v13 offset:8960
v_mfma_f32_16x16x32_bf16 v[96:99], a[80:83], a[4:7], v[96:99]
ds_read_b64_tr_b16 a[110:111], v13 offset:9984
v_mfma_f32_16x16x32_bf16 v[104:107], a[80:83], a[8:11], v[104:107]
s_add_u32 m0, s16, 0x8000
s_waitcnt lgkmcnt(8)
v_mfma_f32_16x16x32_bf16 v[104:107], a[84:87], a[24:27], v[104:107]
buffer_load_dwordx4 v22, s[44:47], s20 offen lds
v_mfma_f32_16x16x32_bf16 v[112:115], a[84:87], a[28:31], v[112:115]
v_mfma_f32_16x16x32_bf16 v[112:115], a[80:83], a[12:15], v[112:115]
v_mfma_f32_16x16x32_bf16 v[116:119], a[88:91], a[12:15], v[116:119]
ds_read_b64_tr_b16 a[80:81], v12 offset:16384
v_mfma_f32_16x16x32_bf16 v[116:119], a[92:95], a[28:31], v[116:119]
ds_read_b64_tr_b16 a[82:83], v12 offset:17408
v_mfma_f32_16x16x32_bf16 v[108:111], a[92:95], a[24:27], v[108:111]
ds_read_b64_tr_b16 a[84:85], v12 offset:24576
v_mfma_f32_16x16x32_bf16 v[108:111], a[88:91], a[8:11], v[108:111]
ds_read_b64_tr_b16 a[86:87], v12 offset:25600
s_add_u32 m0, s16, 0x8400
v_mfma_f32_16x16x32_bf16 v[100:103], a[88:91], a[4:7], v[100:103]
buffer_load_dwordx4 v23, s[44:47], s20 offen lds
v_mfma_f32_16x16x32_bf16 v[100:103], a[92:95], a[20:23], v[100:103]
v_mfma_f32_16x16x32_bf16 v[92:95], a[92:95], a[16:19], v[92:95]
v_mfma_f32_16x16x32_bf16 v[92:95], a[88:91], a[0:3], v[92:95]
s_waitcnt lgkmcnt(4)
v_mfma_f32_16x16x32_bf16 v[120:123], a[96:99], a[0:3], v[120:123]
ds_read_b64_tr_b16 a[88:89], v13 offset:16384
v_mfma_f32_16x16x32_bf16 v[120:123], a[100:103], a[16:19], v[120:123]
ds_read_b64_tr_b16 a[90:91], v13 offset:17408
v_mfma_f32_16x16x32_bf16 v[128:131], a[100:103], a[20:23], v[128:131]
ds_read_b64_tr_b16 a[92:93], v13 offset:24576
v_mfma_f32_16x16x32_bf16 v[128:131], a[96:99], a[4:7], v[128:131]
ds_read_b64_tr_b16 a[94:95], v13 offset:25600
s_add_u32 m0, s16, 0x8800
v_mfma_f32_16x16x32_bf16 v[136:139], a[96:99], a[8:11], v[136:139]
buffer_load_dwordx4 v22, s[44:47], s21 offen lds
v_mfma_f32_16x16x32_bf16 v[136:139], a[100:103], a[24:27], v[136:139]
v_mfma_f32_16x16x32_bf16 v[144:147], a[100:103], a[28:31], v[144:147]
v_mfma_f32_16x16x32_bf16 v[144:147], a[96:99], a[12:15], v[144:147]
v_mfma_f32_16x16x32_bf16 v[148:151], a[104:107], a[12:15], v[148:151]
ds_read_b64_tr_b16 a[96:97], v12 offset:16640
v_mfma_f32_16x16x32_bf16 v[148:151], a[108:111], a[28:31], v[148:151]
ds_read_b64_tr_b16 a[98:99], v12 offset:17664
v_mfma_f32_16x16x32_bf16 v[140:143], a[108:111], a[24:27], v[140:143]
ds_read_b64_tr_b16 a[100:101], v12 offset:24832
s_add_u32 m0, s16, 0x8c00
v_mfma_f32_16x16x32_bf16 v[140:143], a[104:107], a[8:11], v[140:143]
buffer_load_dwordx4 v23, s[44:47], s21 offen lds
v_mfma_f32_16x16x32_bf16 v[132:135], a[104:107], a[4:7], v[132:135]
ds_read_b64_tr_b16 a[102:103], v12 offset:25856
v_mfma_f32_16x16x32_bf16 v[132:135], a[108:111], a[20:23], v[132:135]
v_mfma_f32_16x16x32_bf16 v[124:127], a[108:111], a[16:19], v[124:127]
v_mfma_f32_16x16x32_bf16 v[124:127], a[104:107], a[0:3], v[124:127]
s_waitcnt lgkmcnt(4)
v_mfma_f32_16x16x32_bf16 v[152:155], a[0:3], a[80:83], v[152:155]
ds_read_b64_tr_b16 a[104:105], v13 offset:16640
v_mfma_f32_16x16x32_bf16 v[152:155], a[16:19], a[84:87], v[152:155]
ds_read_b64_tr_b16 a[106:107], v13 offset:17664
s_add_u32 m0, s16, 0x9000
v_mfma_f32_16x16x32_bf16 v[156:159], a[20:23], a[84:87], v[156:159]
buffer_load_dwordx4 v22, s[44:47], s22 offen lds
v_mfma_f32_16x16x32_bf16 v[156:159], a[4:7], a[80:83], v[156:159]
ds_read_b64_tr_b16 a[108:109], v13 offset:24832
v_mfma_f32_16x16x32_bf16 v[160:163], a[8:11], a[80:83], v[160:163]
ds_read_b64_tr_b16 a[110:111], v13 offset:25856
v_mfma_f32_16x16x32_bf16 v[160:163], a[24:27], a[84:87], v[160:163]
v_mfma_f32_16x16x32_bf16 v[164:167], a[28:31], a[84:87], v[164:167]
v_mfma_f32_16x16x32_bf16 v[164:167], a[12:15], a[80:83], v[164:167]
v_mfma_f32_16x16x32_bf16 v[180:183], a[12:15], a[88:91], v[180:183]
ds_read_b64_tr_b16 a[80:81], v12 offset:16896
v_mfma_f32_16x16x32_bf16 v[180:183], a[28:31], a[92:95], v[180:183]
ds_read_b64_tr_b16 a[82:83], v12 offset:17920
s_add_u32 m0, s16, 0x9400
v_mfma_f32_16x16x32_bf16 v[176:179], a[24:27], a[92:95], v[176:179]
buffer_load_dwordx4 v23, s[44:47], s22 offen lds
v_mfma_f32_16x16x32_bf16 v[176:179], a[8:11], a[88:91], v[176:179]
ds_read_b64_tr_b16 a[84:85], v12 offset:25088
v_mfma_f32_16x16x32_bf16 v[172:175], a[4:7], a[88:91], v[172:175]
ds_read_b64_tr_b16 a[86:87], v12 offset:26112
v_mfma_f32_16x16x32_bf16 v[172:175], a[20:23], a[92:95], v[172:175]
v_mfma_f32_16x16x32_bf16 v[168:171], a[16:19], a[92:95], v[168:171]
v_mfma_f32_16x16x32_bf16 v[168:171], a[0:3], a[88:91], v[168:171]
s_waitcnt lgkmcnt(4)
v_mfma_f32_16x16x32_bf16 v[184:187], a[0:3], a[96:99], v[184:187]
ds_read_b64_tr_b16 a[88:89], v13 offset:16896
s_add_u32 m0, s16, 0x9800
v_mfma_f32_16x16x32_bf16 v[184:187], a[16:19], a[100:103], v[184:187]
buffer_load_dwordx4 v22, s[44:47], s23 offen lds
v_mfma_f32_16x16x32_bf16 v[188:191], a[20:23], a[100:103], v[188:191]
ds_read_b64_tr_b16 a[90:91], v13 offset:17920
v_mfma_f32_16x16x32_bf16 v[188:191], a[4:7], a[96:99], v[188:191]
ds_read_b64_tr_b16 a[92:93], v13 offset:25088
v_mfma_f32_16x16x32_bf16 v[192:195], a[8:11], a[96:99], v[192:195]
ds_read_b64_tr_b16 a[94:95], v13 offset:26112
v_mfma_f32_16x16x32_bf16 v[192:195], a[24:27], a[100:103], v[192:195]
v_mfma_f32_16x16x32_bf16 v[196:199], a[28:31], a[100:103], v[196:199]
v_mfma_f32_16x16x32_bf16 v[196:199], a[12:15], a[96:99], v[196:199]
v_mfma_f32_16x16x32_bf16 v[212:215], a[12:15], a[104:107], v[212:215]
ds_read_b64_tr_b16 a[96:97], v12 offset:17152
s_add_u32 m0, s16, 0x9c00
v_mfma_f32_16x16x32_bf16 v[212:215], a[28:31], a[108:111], v[212:215]
buffer_load_dwordx4 v23, s[44:47], s23 offen lds
v_mfma_f32_16x16x32_bf16 v[208:211], a[24:27], a[108:111], v[208:211]
ds_read_b64_tr_b16 a[98:99], v12 offset:18176
v_lshl_add_u32 v22, s42, 7, v22
v_mfma_f32_16x16x32_bf16 v[208:211], a[8:11], a[104:107], v[208:211]
ds_read_b64_tr_b16 a[100:101], v12 offset:25344
v_lshl_add_u32 v23, s42, 7, v23
v_mfma_f32_16x16x32_bf16 v[204:207], a[4:7], a[104:107], v[204:207]
ds_read_b64_tr_b16 a[102:103], v12 offset:26368
v_mfma_f32_16x16x32_bf16 v[204:207], a[20:23], a[108:111], v[204:207]
v_mfma_f32_16x16x32_bf16 v[200:203], a[16:19], a[108:111], v[200:203]
v_mfma_f32_16x16x32_bf16 v[200:203], a[0:3], a[104:107], v[200:203]
s_mov_b32 s9, 0x200000
s_waitcnt lgkmcnt(4)
v_mfma_f32_16x16x32_bf16 v[216:219], a[0:3], a[80:83], v[216:219]
buffer_load_dword a120, v18, s[52:55], s9 offen
v_mfma_f32_16x16x32_bf16 v[216:219], a[16:19], a[84:87], v[216:219]
ds_read_b64_tr_b16 a[104:105], v13 offset:17152
v_mfma_f32_16x16x32_bf16 v[220:223], a[20:23], a[84:87], v[220:223]
ds_read_b64_tr_b16 a[106:107], v13 offset:18176
v_mfma_f32_16x16x32_bf16 v[220:223], a[4:7], a[80:83], v[220:223]
ds_read_b64_tr_b16 a[108:109], v13 offset:25344
v_mfma_f32_16x16x32_bf16 v[224:227], a[8:11], a[80:83], v[224:227]
ds_read_b64_tr_b16 a[110:111], v13 offset:26368
v_add_u32 v12, 0x8000, v12
v_mfma_f32_16x16x32_bf16 v[224:227], a[24:27], a[84:87], v[224:227]
v_add_u32 v13, 0x8000, v13
v_mfma_f32_16x16x32_bf16 v[228:231], a[28:31], a[84:87], v[228:231]
v_mfma_f32_16x16x32_bf16 v[228:231], a[12:15], a[80:83], v[228:231]
v_mfma_f32_16x16x32_bf16 v[244:247], a[12:15], a[88:91], v[244:247]
s_waitcnt vmcnt(26) lgkmcnt(0)
v_mfma_f32_16x16x32_bf16 v[244:247], a[28:31], a[92:95], v[244:247]
s_barrier
s_add_u32 m0, s17, 0x0
v_mfma_f32_16x16x32_bf16 v[240:243], a[24:27], a[92:95], v[240:243]
buffer_load_dwordx4 v5, s[52:55], 0 offen lds
v_mfma_f32_16x16x32_bf16 v[240:243], a[8:11], a[88:91], v[240:243]
ds_read_b64_tr_b16 a[80:81], v12 offset:0
v_mfma_f32_16x16x32_bf16 v[236:239], a[4:7], a[88:91], v[236:239]
ds_read_b64_tr_b16 a[82:83], v12 offset:1024
v_mfma_f32_16x16x32_bf16 v[236:239], a[20:23], a[92:95], v[236:239]
ds_read_b64_tr_b16 a[84:85], v12 offset:8192
v_mfma_f32_16x16x32_bf16 v[232:235], a[16:19], a[92:95], v[232:235]
ds_read_b64_tr_b16 a[86:87], v12 offset:9216
v_mfma_f32_16x16x32_bf16 v[232:235], a[0:3], a[88:91], v[232:235]
s_waitcnt lgkmcnt(4)
v_mfma_f32_16x16x32_bf16 v[248:251], a[0:3], a[96:99], v[248:251]
ds_read_b64_tr_b16 a[88:89], v13 offset:0
s_add_u32 m0, s17, 0x400
v_mfma_f32_16x16x32_bf16 v[248:251], a[16:19], a[100:103], v[248:251]
buffer_load_dwordx4 v5, s[52:55], s13 offen lds
v_mfma_f32_16x16x32_bf16 v[252:255], a[20:23], a[100:103], v[252:255]
ds_read_b64_tr_b16 a[90:91], v13 offset:1024
v_mfma_f32_16x16x32_bf16 v[252:255], a[4:7], a[96:99], v[252:255]
ds_read_b64_tr_b16 a[92:93], v13 offset:8192
v_mfma_f32_16x16x32_bf16 a[232:235], a[8:11], a[96:99], a[232:235]
ds_read_b64_tr_b16 a[94:95], v13 offset:9216
v_mfma_f32_16x16x32_bf16 a[232:235], a[24:27], a[100:103], a[232:235]
v_mfma_f32_16x16x32_bf16 a[236:239], a[28:31], a[100:103], a[236:239]
v_mfma_f32_16x16x32_bf16 a[236:239], a[12:15], a[96:99], a[236:239]
s_add_u32 m0, s17, 0x800
v_mfma_f32_16x16x32_bf16 a[252:255], a[12:15], a[104:107], a[252:255]
buffer_load_dwordx4 v6, s[52:55], 0 offen lds
v_mfma_f32_16x16x32_bf16 a[252:255], a[28:31], a[108:111], a[252:255]
ds_read_b64_tr_b16 a[96:97], v12 offset:256
v_mfma_f32_16x16x32_bf16 a[248:251], a[24:27], a[108:111], a[248:251]
ds_read_b64_tr_b16 a[98:99], v12 offset:1280
v_mfma_f32_16x16x32_bf16 a[248:251], a[8:11], a[104:107], a[248:251]
ds_read_b64_tr_b16 a[100:101], v12 offset:8448
v_mfma_f32_16x16x32_bf16 a[244:247], a[4:7], a[104:107], a[244:247]
ds_read_b64_tr_b16 a[102:103], v12 offset:9472
v_mfma_f32_16x16x32_bf16 a[244:247], a[20:23], a[108:111], a[244:247]
v_mfma_f32_16x16x32_bf16 a[240:243], a[16:19], a[108:111], a[240:243]
v_mfma_f32_16x16x32_bf16 a[240:243], a[0:3], a[104:107], a[240:243]
s_add_u32 m0, s17, 0xc00
s_waitcnt lgkmcnt(4)
L_S7:
v_mfma_f32_16x16x32_bf16 v[24:27], a[80:83], a[32:35], v[24:27]
buffer_load_dwordx4 v6, s[52:55], s13 offen lds
v_mfma_f32_16x16x32_bf16 v[24:27], a[84:87], a[48:51], v[24:27]
ds_read_b64_tr_b16 a[104:105], v13 offset:256
s_waitcnt vmcnt(22)
v_mfma_f32_16x16x32_bf16 v[32:35], a[84:87], a[52:55], v[32:35]
ds_read_b64_tr_b16 a[106:107], v13 offset:1280
v_mfma_f32_16x16x32_bf16 v[32:35], a[80:83], a[36:39], v[32:35]
ds_read_b64_tr_b16 a[108:109], v13 offset:8448
v_mfma_f32_16x16x32_bf16 v[40:43], a[80:83], a[40:43], v[40:43]
ds_read_b64_tr_b16 a[110:111], v13 offset:9472
v_mfma_f32_16x16x32_bf16 v[40:43], a[84:87], a[56:59], v[40:43]
ds_read_b128 a[0:3], v8 offset:0
v_mfma_f32_16x16x32_bf16 v[48:51], a[84:87], a[60:63], v[48:51]
ds_read_b128 a[16:19], v9 offset:0
s_add_u32 m0, s18, 0x4000
v_mfma_f32_16x16x32_bf16 v[48:51], a[80:83], a[44:47], v[48:51]
buffer_load_dwordx4 v7, s[68:71], 0 offen lds
v_mfma_f32_16x16x32_bf16 v[52:55], a[88:91], a[44:47], v[52:55]
ds_read_b64_tr_b16 a[80:81], v12 offset:512
v_mfma_f32_16x16x32_bf16 v[52:55], a[92:95], a[60:63], v[52:55]
ds_read_b64_tr_b16 a[82:83], v12 offset:1536
v_mfma_f32_16x16x32_bf16 v[44:47], a[92:95], a[56:59], v[44:47]
ds_read_b64_tr_b16 a[84:85], v12 offset:8704
v_mfma_f32_16x16x32_bf16 v[44:47], a[88:91], a[40:43], v[44:47]
ds_read_b64_tr_b16 a[86:87], v12 offset:9728
v_mfma_f32_16x16x32_bf16 v[36:39], a[88:91], a[36:39], v[36:39]
ds_read_b128 a[4:7], v8 offset:2048
v_mfma_f32_16x16x32_bf16 v[36:39], a[92:95], a[52:55], v[36:39]
ds_read_b128 a[20:23], v9 offset:2048
s_waitcnt lgkmcnt(8)
v_mfma_f32_16x16x32_bf16 v[28:31], a[92:95], a[48:51], v[28:31]
ds_read_b128 a[8:11], v8 offset:4096
s_add_u32 m0, s18, 0x5000
v_mfma_f32_16x16x32_bf16 v[28:31], a[88:91], a[32:35], v[28:31]
buffer_load_dwordx4 v7, s[68:71], s25 offen lds
v_mfma_f32_16x16x32_bf16 v[56:59], a[96:99], a[32:35], v[56:59]
ds_read_b64_tr_b16 a[88:89], v13 offset:512
v_mfma_f32_16x16x32_bf16 v[56:59], a[100:103], a[48:51], v[56:59]
ds_read_b64_tr_b16 a[90:91], v13 offset:1536
v_mfma_f32_16x16x32_bf16 v[64:67], a[100:103], a[52:55], v[64:67]
ds_read_b64_tr_b16 a[92:93], v13 offset:8704
v_mfma_f32_16x16x32_bf16 v[64:67], a[96:99], a[36:39], v[64:67]
ds_read_b64_tr_b16 a[94:95], v13 offset:9728
v_cvt_pk_bf16_f32 v24, v24, v25
v_cvt_pk_bf16_f32 v25, v26, v27
v_mfma_f32_16x16x32_bf16 v[72:75], a[96:99], a[40:43], v[72:75]
ds_read_b128 a[24:27], v9 offset:4096
v_cvt_pk_bf16_f32 v26, v28, v29
v_mfma_f32_16x16x32_bf16 v[72:75], a[100:103], a[56:59], v[72:75]
ds_read_b128 a[12:15], v8 offset:6144
s_add_u32 m0, s18, 0x6000
v_mfma_f32_16x16x32_bf16 v[80:83], a[100:103], a[60:63], v[80:83]
buffer_load_dwordx4 v7, s[68:71], s26 offen lds
v_cvt_pk_bf16_f32 v27, v30, v31
v_mfma_f32_16x16x32_bf16 v[80:83], a[96:99], a[44:47], v[80:83]
ds_read_b128 a[28:31], v9 offset:6144
v_lshl_add_u32 v5, s42, 19, v5
v_mfma_f32_16x16x32_bf16 v[84:87], a[104:107], a[44:47], v[84:87]
ds_read_b64_tr_b16 a[96:97], v12 offset:768
v_lshl_add_u32 v6, s42, 19, v6
v_mfma_f32_16x16x32_bf16 v[84:87], a[108:111], a[60:63], v[84:87]
ds_read_b64_tr_b16 a[98:99], v12 offset:1792
v_lshl_add_u32 v7, s42, 18, v7
v_accvgpr_write_b32 a128, v24
v_mfma_f32_16x16x32_bf16 v[76:79], a[108:111], a[56:59], v[76:79]
ds_read_b64_tr_b16 a[100:101], v12 offset:8960
v_lshl_add_u32 v7, s42, 17, v7
v_mfma_f32_16x16x32_bf16 v[76:79], a[104:107], a[40:43], v[76:79]
ds_read_b64_tr_b16 a[102:103], v12 offset:9984
v_accvgpr_write_b32 a129, v25
v_mfma_f32_16x16x32_bf16 v[68:71], a[104:107], a[36:39], v[68:71]
s_mov_b32 s9, 0x400000
v_accvgpr_write_b32 a130, v26
v_accvgpr_write_b32 a131, v27
v_cvt_pk_bf16_f32 v32, v32, v33
v_mfma_f32_16x16x32_bf16 v[68:71], a[108:111], a[52:55], v[68:71]
buffer_load_dword a120, v18, s[52:55], s9 offen
v_mfma_f32_16x16x32_bf16 v[60:63], a[108:111], a[48:51], v[60:63]
v_cvt_pk_bf16_f32 v33, v34, v35
v_cvt_pk_bf16_f32 v34, v36, v37
v_mfma_f32_16x16x32_bf16 v[60:63], a[104:107], a[32:35], v[60:63]
s_waitcnt lgkmcnt(7)
v_cvt_pk_bf16_f32 v35, v38, v39
v_accvgpr_write_b32 a132, v32
v_accvgpr_write_b32 a133, v33
v_mfma_f32_16x16x32_bf16 v[88:91], a[80:83], a[32:35], v[88:91]
ds_read_b64_tr_b16 a[104:105], v13 offset:768
v_accvgpr_write_b32 a134, v34
v_mfma_f32_16x16x32_bf16 v[88:91], a[84:87], a[48:51], v[88:91]
ds_read_b64_tr_b16 a[106:107], v13 offset:1792
v_accvgpr_write_b32 a135, v35
v_mfma_f32_16x16x32_bf16 v[96:99], a[84:87], a[52:55], v[96:99]
ds_read_b64_tr_b16 a[108:109], v13 offset:8960
v_cvt_pk_bf16_f32 v40, v40, v41
v_cvt_pk_bf16_f32 v41, v42, v43
v_mfma_f32_16x16x32_bf16 v[96:99], a[80:83], a[36:39], v[96:99]
ds_read_b64_tr_b16 a[110:111], v13 offset:9984
v_cvt_pk_bf16_f32 v42, v44, v45
v_mfma_f32_16x16x32_bf16 v[104:107], a[80:83], a[40:43], v[104:107]
s_add_u32 m0, s16, 0x0
s_waitcnt lgkmcnt(8)
v_cvt_pk_bf16_f32 v43, v46, v47
v_mfma_f32_16x16x32_bf16 v[104:107], a[84:87], a[56:59], v[104:107]
buffer_load_dwordx4 v22, s[44:47], s20 offen lds
v_accvgpr_write_b32 a136, v40
v_mfma_f32_16x16x32_bf16 v[112:115], a[84:87], a[60:63], v[112:115]
v_accvgpr_write_b32 a137, v41
v_accvgpr_write_b32 a138, v42
v_mfma_f32_16x16x32_bf16 v[112:115], a[80:83], a[44:47], v[112:115]
v_accvgpr_write_b32 a139, v43
v_cvt_pk_bf16_f32 v48, v48, v49
v_mfma_f32_16x16x32_bf16 v[116:119], a[88:91], a[44:47], v[116:119]
ds_read_b64_tr_b16 a[80:81], v12 offset:16384
v_cvt_pk_bf16_f32 v49, v50, v51
v_cvt_pk_bf16_f32 v50, v52, v53
v_mfma_f32_16x16x32_bf16 v[116:119], a[92:95], a[60:63], v[116:119]
ds_read_b64_tr_b16 a[82:83], v12 offset:17408
v_cvt_pk_bf16_f32 v51, v54, v55
v_mfma_f32_16x16x32_bf16 v[108:111], a[92:95], a[56:59], v[108:111]
ds_read_b64_tr_b16 a[84:85], v12 offset:24576
v_accvgpr_write_b32 a140, v48
v_mfma_f32_16x16x32_bf16 v[108:111], a[88:91], a[40:43], v[108:111]
ds_read_b64_tr_b16 a[86:87], v12 offset:25600
s_add_u32 m0, s16, 0x400
v_accvgpr_write_b32 a141, v49
v_mfma_f32_16x16x32_bf16 v[100:103], a[88:91], a[36:39], v[100:103]
buffer_load_dwordx4 v23, s[44:47], s20 offen lds
v_mfma_f32_16x16x32_bf16 v[100:103], a[92:95], a[52:55], v[100:103]
v_accvgpr_write_b32 a142, v50
v_accvgpr_write_b32 a143, v51
v_mfma_f32_16x16x32_bf16 v[92:95], a[92:95], a[48:51], v[92:95]
v_cvt_pk_bf16_f32 v56, v56, v57
v_cvt_pk_bf16_f32 v57, v58, v59
v_cvt_pk_bf16_f32 v58, v60, v61
v_mfma_f32_16x16x32_bf16 v[92:95], a[88:91], a[32:35], v[92:95]
s_waitcnt lgkmcnt(4)
v_cvt_pk_bf16_f32 v59, v62, v63
v_accvgpr_write_b32 a144, v56
v_mfma_f32_16x16x32_bf16 v[120:123], a[96:99], a[32:35], v[120:123]
ds_read_b64_tr_b16 a[88:89], v13 offset:16384
v_accvgpr_write_b32 a145, v57
v_mfma_f32_16x16x32_bf16 v[120:123], a[100:103], a[48:51], v[120:123]
ds_read_b64_tr_b16 a[90:91], v13 offset:17408
v_accvgpr_write_b32 a146, v58
v_accvgpr_write_b32 a147, v59
v_mfma_f32_16x16x32_bf16 v[128:131], a[100:103], a[52:55], v[128:131]
ds_read_b64_tr_b16 a[92:93], v13 offset:24576
v_cvt_pk_bf16_f32 v64, v64, v65
v_mfma_f32_16x16x32_bf16 v[128:131], a[96:99], a[36:39], v[128:131]
ds_read_b64_tr_b16 a[94:95], v13 offset:25600
s_add_u32 m0, s16, 0x800
v_mfma_f32_16x16x32_bf16 v[136:139], a[96:99], a[40:43], v[136:139]
buffer_load_dwordx4 v22, s[44:47], s21 offen lds
v_cvt_pk_bf16_f32 v65, v66, v67
v_mfma_f32_16x16x32_bf16 v[136:139], a[100:103], a[56:59], v[136:139]
v_cvt_pk_bf16_f32 v66, v68, v69
v_cvt_pk_bf16_f32 v67, v70, v71
v_mfma_f32_16x16x32_bf16 v[144:147], a[100:103], a[60:63], v[144:147]
v_accvgpr_write_b32 a148, v64
v_accvgpr_write_b32 a149, v65
v_mfma_f32_16x16x32_bf16 v[144:147], a[96:99], a[44:47], v[144:147]
v_accvgpr_write_b32 a150, v66
v_accvgpr_write_b32 a151, v67
v_cvt_pk_bf16_f32 v72, v72, v73
v_mfma_f32_16x16x32_bf16 v[148:151], a[104:107], a[44:47], v[148:151]
ds_read_b64_tr_b16 a[96:97], v12 offset:16640
v_cvt_pk_bf16_f32 v73, v74, v75
v_mfma_f32_16x16x32_bf16 v[148:151], a[108:111], a[60:63], v[148:151]
ds_read_b64_tr_b16 a[98:99], v12 offset:17664
v_cvt_pk_bf16_f32 v74, v76, v77
v_mfma_f32_16x16x32_bf16 v[140:143], a[108:111], a[56:59], v[140:143]
ds_read_b64_tr_b16 a[100:101], v12 offset:24832
s_add_u32 m0, s16, 0xc00
v_cvt_pk_bf16_f32 v75, v78, v79
v_mfma_f32_16x16x32_bf16 v[140:143], a[104:107], a[40:43], v[140:143]
buffer_load_dwordx4 v23, s[44:47], s21 offen lds
v_mfma_f32_16x16x32_bf16 v[132:135], a[104:107], a[36:39], v[132:135]
ds_read_b64_tr_b16 a[102:103], v12 offset:25856
v_accvgpr_write_b32 a152, v72
v_mfma_f32_16x16x32_bf16 v[132:135], a[108:111], a[52:55], v[132:135]
v_accvgpr_write_b32 a153, v73
v_accvgpr_write_b32 a154, v74
v_accvgpr_write_b32 a155, v75
v_mfma_f32_16x16x32_bf16 v[124:127], a[108:111], a[48:51], v[124:127]
v_cvt_pk_bf16_f32 v80, v80, v81
v_cvt_pk_bf16_f32 v81, v82, v83
v_mfma_f32_16x16x32_bf16 v[124:127], a[104:107], a[32:35], v[124:127]
s_waitcnt lgkmcnt(4)
v_cvt_pk_bf16_f32 v82, v84, v85
v_cvt_pk_bf16_f32 v83, v86, v87
v_mfma_f32_16x16x32_bf16 v[152:155], a[32:35], a[80:83], v[152:155]
ds_read_b64_tr_b16 a[104:105], v13 offset:16640
v_accvgpr_write_b32 a156, v80
v_accvgpr_write_b32 a157, v81
v_mfma_f32_16x16x32_bf16 v[152:155], a[48:51], a[84:87], v[152:155]
ds_read_b64_tr_b16 a[106:107], v13 offset:17664
s_add_u32 m0, s16, 0x1000
v_mfma_f32_16x16x32_bf16 v[156:159], a[52:55], a[84:87], v[156:159]
buffer_load_dwordx4 v22, s[44:47], s22 offen lds
v_mfma_f32_16x16x32_bf16 v[156:159], a[36:39], a[80:83], v[156:159]
ds_read_b64_tr_b16 a[108:109], v13 offset:24832
v_accvgpr_write_b32 a158, v82
v_accvgpr_write_b32 a159, v83
v_mfma_f32_16x16x32_bf16 v[160:163], a[40:43], a[80:83], v[160:163]
ds_read_b64_tr_b16 a[110:111], v13 offset:25856
v_cvt_pk_bf16_f32 v88, v88, v89
v_mfma_f32_16x16x32_bf16 v[160:163], a[56:59], a[84:87], v[160:163]
v_cvt_pk_bf16_f32 v89, v90, v91
v_cvt_pk_bf16_f32 v90, v92, v93
v_mfma_f32_16x16x32_bf16 v[164:167], a[60:63], a[84:87], v[164:167]
v_cvt_pk_bf16_f32 v91, v94, v95
v_accvgpr_write_b32 a160, v88
v_accvgpr_write_b32 a161, v89
v_mfma_f32_16x16x32_bf16 v[164:167], a[44:47], a[80:83], v[164:167]
v_accvgpr_write_b32 a162, v90
v_accvgpr_write_b32 a163, v91
v_mfma_f32_16x16x32_bf16 v[180:183], a[44:47], a[88:91], v[180:183]
ds_read_b64_tr_b16 a[80:81], v12 offset:16896
v_cvt_pk_bf16_f32 v96, v96, v97
v_mfma_f32_16x16x32_bf16 v[180:183], a[60:63], a[92:95], v[180:183]
ds_read_b64_tr_b16 a[82:83], v12 offset:17920
s_add_u32 m0, s16, 0x1400
v_cvt_pk_bf16_f32 v97, v98, v99
v_mfma_f32_16x16x32_bf16 v[176:179], a[56:59], a[92:95], v[176:179]
buffer_load_dwordx4 v23, s[44:47], s22 offen lds
v_mfma_f32_16x16x32_bf16 v[176:179], a[40:43], a[88:91], v[176:179]
ds_read_b64_tr_b16 a[84:85], v12 offset:25088
v_cvt_pk_bf16_f32 v98, v100, v101
v_mfma_f32_16x16x32_bf16 v[172:175], a[36:39], a[88:91], v[172:175]
ds_read_b64_tr_b16 a[86:87], v12 offset:26112
v_cvt_pk_bf16_f32 v99, v102, v103
v_accvgpr_write_b32 a164, v96
v_mfma_f32_16x16x32_bf16 v[172:175], a[52:55], a[92:95], v[172:175]
v_accvgpr_write_b32 a165, v97
v_accvgpr_write_b32 a166, v98
v_mfma_f32_16x16x32_bf16 v[168:171], a[48:51], a[92:95], v[168:171]
v_accvgpr_write_b32 a167, v99
v_cvt_pk_bf16_f32 v104, v104, v105
v_mfma_f32_16x16x32_bf16 v[168:171], a[32:35], a[88:91], v[168:171]
s_waitcnt lgkmcnt(4)
v_cvt_pk_bf16_f32 v105, v106, v107
v_cvt_pk_bf16_f32 v106, v108, v109
v_cvt_pk_bf16_f32 v107, v110, v111
v_mfma_f32_16x16x32_bf16 v[184:187], a[32:35], a[96:99], v[184:187]
ds_read_b64_tr_b16 a[88:89], v13 offset:16896
s_add_u32 m0, s16, 0x1800
v_mfma_f32_16x16x32_bf16 v[184:187], a[48:51], a[100:103], v[184:187]
buffer_load_dwordx4 v22, s[44:47], s23 offen lds
v_mfma_f32_16x16x32_bf16 v[188:191], a[52:55], a[100:103], v[188:191]
ds_read_b64_tr_b16 a[90:91], v13 offset:17920
v_accvgpr_write_b32 a168, v104
v_accvgpr_write_b32 a169, v105
v_mfma_f32_16x16x32_bf16 v[188:191], a[36:39], a[96:99], v[188:191]
ds_read_b64_tr_b16 a[92:93], v13 offset:25088
v_accvgpr_write_b32 a170, v106
v_mfma_f32_16x16x32_bf16 v[192:195], a[40:43], a[96:99], v[192:195]
ds_read_b64_tr_b16 a[94:95], v13 offset:26112
v_accvgpr_write_b32 a171, v107
v_mfma_f32_16x16x32_bf16 v[192:195], a[56:59], a[100:103], v[192:195]
L_padA4:
s_cmp_eq_u32 s95, 1
s_cbranch_scc1 L_padA8
v_cvt_pk_bf16_f32 v112, v112, v113
v_cvt_pk_bf16_f32 v113, v114, v115
v_cvt_pk_bf16_f32 v114, v116, v117
v_mfma_f32_16x16x32_bf16 v[196:199], a[60:63], a[100:103], v[196:199]
v_cvt_pk_bf16_f32 v115, v118, v119
v_accvgpr_write_b32 a172, v112
v_mfma_f32_16x16x32_bf16 v[196:199], a[44:47], a[96:99], v[196:199]
v_accvgpr_write_b32 a173, v113
v_accvgpr_write_b32 a174, v114
v_mfma_f32_16x16x32_bf16 v[212:215], a[44:47], a[104:107], v[212:215]
ds_read_b64_tr_b16 a[96:97], v12 offset:17152
s_add_u32 m0, s16, 0x1c00
v_accvgpr_write_b32 a175, v115
v_mfma_f32_16x16x32_bf16 v[212:215], a[60:63], a[108:111], v[212:215]
buffer_load_dwordx4 v23, s[44:47], s23 offen lds
v_mfma_f32_16x16x32_bf16 v[208:211], a[56:59], a[108:111], v[208:211]
ds_read_b64_tr_b16 a[98:99], v12 offset:18176
v_lshl_add_u32 v22, s42, 7, v22
v_mfma_f32_16x16x32_bf16 v[208:211], a[40:43], a[104:107], v[208:211]
ds_read_b64_tr_b16 a[100:101], v12 offset:25344
v_lshl_add_u32 v23, s42, 7, v23
v_cvt_pk_bf16_f32 v120, v120, v121
v_mfma_f32_16x16x32_bf16 v[204:207], a[36:39], a[104:107], v[204:207]
ds_read_b64_tr_b16 a[102:103], v12 offset:26368
v_cvt_pk_bf16_f32 v121, v122, v123
v_mfma_f32_16x16x32_bf16 v[204:207], a[52:55], a[108:111], v[204:207]
v_cvt_pk_bf16_f32 v122, v124, v125
v_cvt_pk_bf16_f32 v123, v126, v127
v_mfma_f32_16x16x32_bf16 v[200:203], a[48:51], a[108:111], v[200:203]
v_accvgpr_write_b32 a176, v120
v_accvgpr_write_b32 a177, v121
v_accvgpr_write_b32 a178, v122
v_mfma_f32_16x16x32_bf16 v[200:203], a[32:35], a[104:107], v[200:203]
s_mov_b32 s9, 0x600000
s_waitcnt lgkmcnt(4)
v_accvgpr_write_b32 a179, v123
v_mfma_f32_16x16x32_bf16 v[216:219], a[32:35], a[80:83], v[216:219]
buffer_load_dword a120, v18, s[52:55], s9 offen
v_mfma_f32_16x16x32_bf16 v[216:219], a[48:51], a[84:87], v[216:219]
ds_read_b64_tr_b16 a[104:105], v13 offset:17152
v_cvt_pk_bf16_f32 v128, v128, v129
v_cvt_pk_bf16_f32 v129, v130, v131
v_mfma_f32_16x16x32_bf16 v[220:223], a[52:55], a[84:87], v[220:223]
ds_read_b64_tr_b16 a[106:107], v13 offset:18176
v_cvt_pk_bf16_f32 v130, v132, v133
v_mfma_f32_16x16x32_bf16 v[220:223], a[36:39], a[80:83], v[220:223]
ds_read_b64_tr_b16 a[108:109], v13 offset:25344
v_cvt_pk_bf16_f32 v131, v134, v135
v_mfma_f32_16x16x32_bf16 v[224:227], a[40:43], a[80:83], v[224:227]
ds_read_b64_tr_b16 a[110:111], v13 offset:26368
v_add_u32 v12, 0x8000, v12
v_accvgpr_write_b32 a180, v128
v_mfma_f32_16x16x32_bf16 v[224:227], a[56:59], a[84:87], v[224:227]
v_add_u32 v13, 0x8000, v13
v_accvgpr_write_b32 a181, v129
v_mfma_f32_16x16x32_bf16 v[228:231], a[60:63], a[84:87], v[228:231]
v_accvgpr_write_b32 a182, v130
v_accvgpr_write_b32 a183, v131
v_mfma_f32_16x16x32_bf16 v[228:231], a[44:47], a[80:83], v[228:231]
v_cvt_pk_bf16_f32 v136, v136, v137
v_cvt_pk_bf16_f32 v137, v138, v139
v_cvt_pk_bf16_f32 v138, v140, v141
v_mfma_f32_16x16x32_bf16 v[244:247], a[44:47], a[88:91], v[244:247]
s_waitcnt vmcnt(27) lgkmcnt(0)
v_cvt_pk_bf16_f32 v139, v142, v143
v_accvgpr_write_b32 a184, v136
v_mfma_f32_16x16x32_bf16 v[244:247], a[60:63], a[92:95], v[244:247]
s_barrier
s_add_u32 m0, s17, 0x8000
v_accvgpr_write_b32 a185, v137
v_mfma_f32_16x16x32_bf16 v[240:243], a[56:59], a[92:95], v[240:243]
buffer_load_dwordx4 v5, s[52:55], 0 offen lds
v_accvgpr_write_b32 a186, v138
v_mfma_f32_16x16x32_bf16 v[240:243], a[40:43], a[88:91], v[240:243]
ds_read_b64_tr_b16 a[80:81], v12 offset:0
v_accvgpr_write_b32 a187, v139
v_mfma_f32_16x16x32_bf16 v[236:239], a[36:39], a[88:91], v[236:239]
ds_read_b64_tr_b16 a[82:83], v12 offset:1024
v_cvt_pk_bf16_f32 v144, v144, v145
v_mfma_f32_16x16x32_bf16 v[236:239], a[52:55], a[92:95], v[236:239]
ds_read_b64_tr_b16 a[84:85], v12 offset:8192
v_cvt_pk_bf16_f32 v145, v146, v147
v_cvt_pk_bf16_f32 v146, v148, v149
v_mfma_f32_16x16x32_bf16 v[232:235], a[48:51], a[92:95], v[232:235]
ds_read_b64_tr_b16 a[86:87], v12 offset:9216
v_cvt_pk_bf16_f32 v147, v150, v151
v_mfma_f32_16x16x32_bf16 v[232:235], a[32:35], a[88:91], v[232:235]
s_add_u32 m0, s17, 0x8400
s_waitcnt lgkmcnt(4)
v_accvgpr_write_b32 a188, v144
v_mfma_f32_16x16x32_bf16 v[248:251], a[32:35], a[96:99], v[248:251]
buffer_load_dwordx4 v5, s[52:55], s13 offen lds
v_accvgpr_write_b32 a189, v145
v_mfma_f32_16x16x32_bf16 v[248:251], a[48:51], a[100:103], v[248:251]
ds_read_b64_tr_b16 a[88:89], v13 offset:0
v_accvgpr_write_b32 a190, v146
v_mfma_f32_16x16x32_bf16 v[252:255], a[52:55], a[100:103], v[252:255]
ds_read_b64_tr_b16 a[90:91], v13 offset:1024
v_accvgpr_write_b32 a191, v147
v_mfma_f32_16x16x32_bf16 v[252:255], a[36:39], a[96:99], v[252:255]
ds_read_b64_tr_b16 a[92:93], v13 offset:8192
v_cvt_pk_bf16_f32 v152, v152, v153
v_cvt_pk_bf16_f32 v153, v154, v155
v_mfma_f32_16x16x32_bf16 a[232:235], a[40:43], a[96:99], a[232:235]
ds_read_b64_tr_b16 a[94:95], v13 offset:9216
v_cvt_pk_bf16_f32 v154, v156, v157
v_mfma_f32_16x16x32_bf16 a[232:235], a[56:59], a[100:103], a[232:235]
v_cvt_pk_bf16_f32 v155, v158, v159
v_accvgpr_write_b32 a192, v152
v_mfma_f32_16x16x32_bf16 a[236:239], a[60:63], a[100:103], a[236:239]
s_add_u32 m0, s17, 0x8800
v_accvgpr_write_b32 a193, v153
v_accvgpr_write_b32 a194, v154
v_accvgpr_write_b32 a195, v155
v_mfma_f32_16x16x32_bf16 a[236:239], a[44:47], a[96:99], a[236:239]
buffer_load_dwordx4 v6, s[52:55], 0 offen lds
v_mfma_f32_16x16x32_bf16 a[252:255], a[44:47], a[104:107], a[252:255]
ds_read_b64_tr_b16 a[96:97], v12 offset:256
v_cvt_pk_bf16_f32 v160, v160, v161
v_mfma_f32_16x16x32_bf16 a[252:255], a[60:63], a[108:111], a[252:255]
ds_read_b64_tr_b16 a[98:99], v12 offset:1280
v_cvt_pk_bf16_f32 v161, v162, v163
v_cvt_pk_bf16_f32 v162, v164, v165
v_mfma_f32_16x16x32_bf16 a[248:251], a[56:59], a[108:111], a[248:251]
ds_read_b64_tr_b16 a[100:101], v12 offset:8448
v_cvt_pk_bf16_f32 v163, v166, v167
v_mfma_f32_16x16x32_bf16 a[248:251], a[40:43], a[104:107], a[248:251]
ds_read_b64_tr_b16 a[102:103], v12 offset:9472
v_accvgpr_write_b32 a196, v160
v_mfma_f32_16x16x32_bf16 a[244:247], a[36:39], a[104:107], a[244:247]
v_accvgpr_write_b32 a197, v161
v_accvgpr_write_b32 a198, v162
v_accvgpr_write_b32 a199, v163
v_mfma_f32_16x16x32_bf16 a[244:247], a[52:55], a[108:111], a[244:247]
s_add_u32 m0, s17, 0x8c00
v_cvt_pk_bf16_f32 v168, v168, v169
v_cvt_pk_bf16_f32 v169, v170, v171
v_mfma_f32_16x16x32_bf16 a[240:243], a[48:51], a[108:111], a[240:243]
buffer_load_dwordx4 v6, s[52:55], s13 offen lds
v_mfma_f32_16x16x32_bf16 a[240:243], a[32:35], a[104:107], a[240:243]
s_waitcnt lgkmcnt(4)
v_cvt_pk_bf16_f32 v170, v172, v173
v_cvt_pk_bf16_f32 v171, v174, v175
v_accvgpr_write_b32 a200, v168
L_S8:
v_mfma_f32_16x16x32_bf16 v[24:27], a[80:83], a[0:3], 0
ds_read_b64_tr_b16 a[104:105], v13 offset:256
s_waitcnt vmcnt(22)
v_mfma_f32_16x16x32_bf16 v[24:27], a[84:87], a[16:19], v[24:27]
ds_read_b64_tr_b16 a[106:107], v13 offset:1280
v_accvgpr_write_b32 a201, v169
v_mfma_f32_16x16x32_bf16 v[32:35], a[84:87], a[20:23], 0
ds_read_b64_tr_b16 a[108:109], v13 offset:8448
v_accvgpr_write_b32 a202, v170
v_accvgpr_write_b32 a203, v171
v_mfma_f32_16x16x32_bf16 v[32:35], a[80:83], a[4:7], v[32:35]
ds_read_b64_tr_b16 a[110:111], v13 offset:9472
v_cvt_pk_bf16_f32 v176, v176, v177
v_mfma_f32_16x16x32_bf16 v[40:43], a[80:83], a[8:11], 0
ds_read_b128 a[32:35], v8 offset:32768
s_add_u32 m0, s18, 0xc000
v_mfma_f32_16x16x32_bf16 v[40:43], a[84:87], a[24:27], v[40:43]
buffer_load_dwordx4 v7, s[68:71], 0 offen lds
v_cvt_pk_bf16_f32 v177, v178, v179
v_mfma_f32_16x16x32_bf16 v[48:51], a[84:87], a[28:31], 0
ds_read_b128 a[48:51], v9 offset:32768
v_cvt_pk_bf16_f32 v178, v180, v181
v_mfma_f32_16x16x32_bf16 v[48:51], a[80:83], a[12:15], v[48:51]
ds_read_b128 a[36:39], v8 offset:34816
v_cvt_pk_bf16_f32 v179, v182, v183
v_mfma_f32_16x16x32_bf16 v[52:55], a[88:91], a[12:15], 0
ds_read_b64_tr_b16 a[80:81], v12 offset:512
v_accvgpr_write_b32 a204, v176
v_accvgpr_write_b32 a205, v177
v_mfma_f32_16x16x32_bf16 v[52:55], a[92:95], a[28:31], v[52:55]
ds_read_b64_tr_b16 a[82:83], v12 offset:1536
v_accvgpr_write_b32 a206, v178
v_mfma_f32_16x16x32_bf16 v[44:47], a[92:95], a[24:27], 0
ds_read_b64_tr_b16 a[84:85], v12 offset:8704
s_add_u32 s8, s28, 0x2000
v_mfma_f32_16x16x32_bf16 v[44:47], a[88:91], a[8:11], v[44:47]
buffer_store_dwordx4 a[128:131], v16, s[88:91], s8 offen sc1
v_accvgpr_write_b32 a207, v179
v_mfma_f32_16x16x32_bf16 v[36:39], a[88:91], a[4:7], 0
ds_read_b64_tr_b16 a[86:87], v12 offset:9728
v_cvt_pk_bf16_f32 v184, v184, v185
v_mfma_f32_16x16x32_bf16 v[36:39], a[92:95], a[20:23], v[36:39]
ds_read_b128 a[52:55], v9 offset:34816
v_cvt_pk_bf16_f32 v185, v186, v187
v_mfma_f32_16x16x32_bf16 v[28:31], a[92:95], a[16:19], 0
ds_read_b128 a[40:43], v8 offset:36864
v_cvt_pk_bf16_f32 v186, v188, v189
v_cvt_pk_bf16_f32 v187, v190, v191
v_mfma_f32_16x16x32_bf16 v[28:31], a[88:91], a[0:3], v[28:31]
ds_read_b128 a[56:59], v9 offset:36864
s_waitcnt lgkmcnt(10)
v_mfma_f32_16x16x32_bf16 v[56:59], a[96:99], a[0:3], 0
ds_read_b64_tr_b16 a[88:89], v13 offset:512
v_accvgpr_write_b32 a208, v184
v_mfma_f32_16x16x32_bf16 v[56:59], a[100:103], a[16:19], v[56:59]
ds_read_b64_tr_b16 a[90:91], v13 offset:1536
s_add_u32 m0, s18, 0xd000
v_accvgpr_write_b32 a209, v185
v_mfma_f32_16x16x32_bf16 v[64:67], a[100:103], a[20:23], 0
buffer_load_dwordx4 v7, s[68:71], s25 offen lds
v_mfma_f32_16x16x32_bf16 v[64:67], a[96:99], a[4:7], v[64:67]
ds_read_b64_tr_b16 a[92:93], v13 offset:8704
v_accvgpr_write_b32 a210, v186
v_mfma_f32_16x16x32_bf16 v[72:75], a[96:99], a[8:11], 0
ds_read_b64_tr_b16 a[94:95], v13 offset:9728
v_accvgpr_write_b32 a211, v187
v_cvt_pk_bf16_f32 v192, v192, v193
v_mfma_f32_16x16x32_bf16 v[72:75], a[100:103], a[24:27], v[72:75]
ds_read_b128 a[44:47], v8 offset:38912
v_cvt_pk_bf16_f32 v193, v194, v195
v_mfma_f32_16x16x32_bf16 v[80:83], a[100:103], a[28:31], 0
ds_read_b128 a[60:63], v9 offset:38912
v_cvt_pk_bf16_f32 v194, v196, v197
v_mfma_f32_16x16x32_bf16 v[80:83], a[96:99], a[12:15], v[80:83]
v_cvt_pk_bf16_f32 v195, v198, v199
v_accvgpr_write_b32 a212, v192
v_accvgpr_write_b32 a213, v193
v_mfma_f32_16x16x32_bf16 v[84:87], a[104:107], a[12:15], 0
ds_read_b64_tr_b16 a[96:97], v12 offset:768
s_add_u32 m0, s18, 0xe000
v_mfma_f32_16x16x32_bf16 v[84:87], a[108:111], a[28:31], v[84:87]
buffer_load_dwordx4 v7, s[68:71], s26 offen lds
v_mfma_f32_16x16x32_bf16 v[76:79], a[108:111], a[24:27], 0
ds_read_b64_tr_b16 a[98:99], v12 offset:1792
v_lshl_add_u32 v5, s42, 19, v5
v_accvgpr_write_b32 a214, v194
v_mfma_f32_16x16x32_bf16 v[76:79], a[104:107], a[8:11], v[76:79]
ds_read_b64_tr_b16 a[100:101], v12 offset:8960
v_lshl_add_u32 v6, s42, 19, v6
v_mfma_f32_16x16x32_bf16 v[68:71], a[104:107], a[4:7], 0
ds_read_b64_tr_b16 a[102:103], v12 offset:9984
v_lshl_add_u32 v7, s42, 18, v7
v_mfma_f32_16x16x32_bf16 v[68:71], a[108:111], a[20:23], v[68:71]
v_lshl_add_u32 v7, s42, 17, v7
v_accvgpr_write_b32 a215, v195
v_cvt_pk_bf16_f32 v200, v200, v201
v_mfma_f32_16x16x32_bf16 v[60:63], a[108:111], a[16:19], 0
v_cvt_pk_bf16_f32 v201, v202, v203
v_cvt_pk_bf16_f32 v202, v204, v205
v_mfma_f32_16x16x32_bf16 v[60:63], a[104:107], a[0:3], v[60:63]
s_add_u32 m0, s16, 0x8000
s_waitcnt lgkmcnt(4)
s_waitcnt lgkmcnt(6)
v_mfma_f32_16x16x32_bf16 v[88:91], a[80:83], a[0:3], 0
buffer_load_dwordx4 v22, s[44:47], s20 offen lds
v_cvt_pk_bf16_f32 v203, v206, v207
v_mfma_f32_16x16x32_bf16 v[88:91], a[84:87], a[16:19], v[88:91]
ds_read_b64_tr_b16 a[104:105], v13 offset:768
v_accvgpr_write_b32 a216, v200
v_mfma_f32_16x16x32_bf16 v[96:99], a[84:87], a[20:23], 0
ds_read_b64_tr_b16 a[106:107], v13 offset:1792
v_accvgpr_write_b32 a217, v201
v_mfma_f32_16x16x32_bf16 v[96:99], a[80:83], a[4:7], v[96:99]
ds_read_b64_tr_b16 a[108:109], v13 offset:8960
v_accvgpr_write_b32 a218, v202
v_accvgpr_write_b32 a219, v203
v_mfma_f32_16x16x32_bf16 v[104:107], a[80:83], a[8:11], 0
ds_read_b64_tr_b16 a[110:111], v13 offset:9984
s_add_u32 m0, s16, 0x8400
v_mfma_f32_16x16x32_bf16 v[104:107], a[84:87], a[24:27], v[104:107]
buffer_load_dwordx4 v23, s[44:47], s20 offen lds
v_mfma_f32_16x16x32_bf16 v[112:115], a[84:87], a[28:31], 0
v_cvt_pk_bf16_f32 v208, v208, v209
v_cvt_pk_bf16_f32 v209, v210, v211
v_cvt_pk_bf16_f32 v210, v212, v213
v_mfma_f32_16x16x32_bf16 v[112:115], a[80:83], a[12:15], v[112:115]
v_cvt_pk_bf16_f32 v211, v214, v215
v_accvgpr_write_b32 a220, v208
v_mfma_f32_16x16x32_bf16 v[116:119], a[88:91], a[12:15], 0
ds_read_b64_tr_b16 a[80:81], v14 offset:0
v_accvgpr_write_b32 a221, v209
v_mfma_f32_16x16x32_bf16 v[116:119], a[92:95], a[28:31], v[116:119]
ds_read_b64_tr_b16 a[82:83], v14 offset:256
v_accvgpr_write_b32 a222, v210
v_accvgpr_write_b32 a223, v211
v_mfma_f32_16x16x32_bf16 v[108:111], a[92:95], a[24:27], 0
ds_read_b64_tr_b16 a[84:85], v14 offset:2048
s_add_u32 m0, s16, 0x8800
v_mfma_f32_16x16x32_bf16 v[108:111], a[88:91], a[8:11], v[108:111]
buffer_load_dwordx4 v22, s[44:47], s21 offen lds
v_mfma_f32_16x16x32_bf16 v[100:103], a[88:91], a[4:7], 0
ds_read_b64_tr_b16 a[86:87], v14 offset:2304
v_cvt_pk_bf16_f32 v216, v216, v217
v_cvt_pk_bf16_f32 v217, v218, v219
v_mfma_f32_16x16x32_bf16 v[100:103], a[92:95], a[20:23], v[100:103]
v_cvt_pk_bf16_f32 v218, v220, v221
v_cvt_pk_bf16_f32 v219, v222, v223
v_mfma_f32_16x16x32_bf16 v[92:95], a[92:95], a[16:19], 0
v_accvgpr_write_b32 a224, v216
v_accvgpr_write_b32 a225, v217
v_mfma_f32_16x16x32_bf16 v[92:95], a[88:91], a[0:3], v[92:95]
s_add_u32 s8, s28, 0x3000
s_waitcnt lgkmcnt(4)
v_accvgpr_write_b32 a226, v218
v_accvgpr_write_b32 a227, v219
v_mfma_f32_16x16x32_bf16 v[120:123], a[96:99], a[0:3], 0
buffer_store_dwordx4 a[132:135], v16, s[88:91], s8 offen sc1
v_mfma_f32_16x16x32_bf16 v[120:123], a[100:103], a[16:19], v[120:123]
ds_read_b64_tr_b16 a[88:89], v15 offset:0
v_cvt_pk_bf16_f32 v224, v224, v225
v_mfma_f32_16x16x32_bf16 v[128:131], a[100:103], a[20:23], 0
ds_read_b64_tr_b16 a[90:91], v15 offset:256
v_cvt_pk_bf16_f32 v225, v226, v227
v_cvt_pk_bf16_f32 v226, v228, v229
v_mfma_f32_16x16x32_bf16 v[128:131], a[96:99], a[4:7], v[128:131]
ds_read_b64_tr_b16 a[92:93], v15 offset:2048
v_cvt_pk_bf16_f32 v227, v230, v231
v_mfma_f32_16x16x32_bf16 v[136:139], a[96:99], a[8:11], 0
ds_read_b64_tr_b16 a[94:95], v15 offset:2304
v_accvgpr_write_b32 a228, v224
v_mfma_f32_16x16x32_bf16 v[136:139], a[100:103], a[24:27], v[136:139]
s_add_u32 m0, s16, 0x8c00
v_accvgpr_write_b32 a229, v225
v_accvgpr_write_b32 a230, v226
v_accvgpr_write_b32 a231, v227
v_mfma_f32_16x16x32_bf16 v[144:147], a[100:103], a[28:31], 0
buffer_load_dwordx4 v23, s[44:47], s21 offen lds
v_mfma_f32_16x16x32_bf16 v[144:147], a[96:99], a[12:15], v[144:147]
v_cvt_pk_bf16_f32 v232, v232, v233
v_cvt_pk_bf16_f32 v233, v234, v235
v_mfma_f32_16x16x32_bf16 v[148:151], a[104:107], a[12:15], 0
ds_read_b64_tr_b16 a[96:97], v14 offset:4096
v_cvt_pk_bf16_f32 v234, v236, v237
v_cvt_pk_bf16_f32 v235, v238, v239
v_mfma_f32_16x16x32_bf16 v[148:151], a[108:111], a[28:31], v[148:151]
ds_read_b64_tr_b16 a[98:99], v14 offset:4352
v_accvgpr_write_b32 a112, v232
v_mfma_f32_16x16x32_bf16 v[140:143], a[108:111], a[24:27], 0
ds_read_b64_tr_b16 a[100:101], v14 offset:6144
v_accvgpr_write_b32 a113, v233
v_mfma_f32_16x16x32_bf16 v[140:143], a[104:107], a[8:11], v[140:143]
ds_read_b64_tr_b16 a[102:103], v14 offset:6400
s_add_u32 m0, s16, 0x9000
v_accvgpr_write_b32 a114, v234
v_mfma_f32_16x16x32_bf16 v[132:135], a[104:107], a[4:7], 0
buffer_load_dwordx4 v22, s[44:47], s22 offen lds
v_mfma_f32_16x16x32_bf16 v[132:135], a[108:111], a[20:23], v[132:135]
v_accvgpr_write_b32 a115, v235
v_cvt_pk_bf16_f32 v240, v240, v241
v_mfma_f32_16x16x32_bf16 v[124:127], a[108:111], a[16:19], 0
v_cvt_pk_bf16_f32 v241, v242, v243
v_cvt_pk_bf16_f32 v242, v244, v245
v_cvt_pk_bf16_f32 v243, v246, v247
v_mfma_f32_16x16x32_bf16 v[124:127], a[104:107], a[0:3], v[124:127]
s_waitcnt lgkmcnt(4)
v_accvgpr_write_b32 a116, v240
v_accvgpr_write_b32 a117, v241
v_mfma_f32_16x16x32_bf16 v[152:155], a[80:83], a[0:3], 0
ds_read_b64_tr_b16 a[104:105], v15 offset:4096
s_add_u32 m0, s16, 0x9400
v_mfma_f32_16x16x32_bf16 v[152:155], a[84:87], a[16:19], v[152:155]
buffer_load_dwordx4 v23, s[44:47], s22 offen lds
v_accvgpr_write_b32 a118, v242
v_mfma_f32_16x16x32_bf16 v[160:163], a[84:87], a[20:23], 0
ds_read_b64_tr_b16 a[106:107], v15 offset:4352
v_accvgpr_write_b32 a119, v243
v_mfma_f32_16x16x32_bf16 v[160:163], a[80:83], a[4:7], v[160:163]
ds_read_b64_tr_b16 a[108:109], v15 offset:6144
v_cvt_pk_bf16_f32 v248, v248, v249
v_mfma_f32_16x16x32_bf16 v[168:171], a[80:83], a[8:11], 0
ds_read_b64_tr_b16 a[110:111], v15 offset:6400
v_cvt_pk_bf16_f32 v249, v250, v251
v_cvt_pk_bf16_f32 v250, v252, v253
v_mfma_f32_16x16x32_bf16 v[168:171], a[84:87], a[24:27], v[168:171]
v_cvt_pk_bf16_f32 v251, v254, v255
v_accvgpr_write_b32 a124, v248
v_mfma_f32_16x16x32_bf16 v[176:179], a[84:87], a[28:31], 0
s_add_u32 m0, s16, 0x9800
v_accvgpr_write_b32 a125, v249
v_accvgpr_write_b32 a126, v250
v_mfma_f32_16x16x32_bf16 v[176:179], a[80:83], a[12:15], v[176:179]
buffer_load_dwordx4 v22, s[44:47], s23 offen lds
v_accvgpr_write_b32 a127, v251
v_mfma_f32_16x16x32_bf16 v[180:183], a[88:91], a[12:15], 0
ds_read_b64_tr_b16 a[80:81], v14 offset:8192
v_accvgpr_read_b32 v2, a232
v_mfma_f32_16x16x32_bf16 v[180:183], a[92:95], a[28:31], v[180:183]
ds_read_b64_tr_b16 a[82:83], v14 offset:8448
v_accvgpr_read_b32 v3, a233
v_mfma_f32_16x16x32_bf16 v[172:175], a[92:95], a[24:27], 0
ds_read_b64_tr_b16 a[84:85], v14 offset:10240
v_cvt_pk_bf16_f32 v2, v2, v3
v_accvgpr_write_b32 a232, v2
v_mfma_f32_16x16x32_bf16 v[172:175], a[88:91], a[8:11], v[172:175]
ds_read_b64_tr_b16 a[86:87], v14 offset:10496
s_add_u32 m0, s16, 0x9c00
v_mfma_f32_16x16x32_bf16 v[164:167], a[88:91], a[4:7], 0
buffer_load_dwordx4 v23, s[44:47], s23 offen lds
v_mfma_f32_16x16x32_bf16 v[164:167], a[92:95], a[20:23], v[164:167]
v_lshl_add_u32 v22, s42, 7, v22
v_lshl_add_u32 v23, s42, 7, v23
v_accvgpr_read_b32 v2, a234
v_mfma_f32_16x16x32_bf16 v[156:159], a[92:95], a[16:19], 0
v_accvgpr_read_b32 v3, a235
v_cvt_pk_bf16_f32 v2, v2, v3
v_mfma_f32_16x16x32_bf16 v[156:159], a[88:91], a[0:3], v[156:159]
s_waitcnt lgkmcnt(4)
v_accvgpr_write_b32 a233, v2
v_accvgpr_read_b32 v2, a236
v_mfma_f32_16x16x32_bf16 v[184:187], a[96:99], a[0:3], 0
ds_read_b64_tr_b16 a[88:89], v15 offset:8192
v_accvgpr_read_b32 v3, a237
v_cvt_pk_bf16_f32 v2, v2, v3
v_mfma_f32_16x16x32_bf16 v[184:187], a[100:103], a[16:19], v[184:187]
ds_read_b64_tr_b16 a[90:91], v15 offset:8448
s_add_u32 s8, s28, 0x6000
v_mfma_f32_16x16x32_bf16 v[192:195], a[100:103], a[20:23], 0
buffer_store_dwordx4 a[136:139], v16, s[88:91], s8 offen sc1
v_mfma_f32_16x16x32_bf16 v[192:195], a[96:99], a[4:7], v[192:195]
ds_read_b64_tr_b16 a[92:93], v15 offset:10240
v_accvgpr_write_b32 a234, v2
v_accvgpr_read_b32 v2, a238
v_mfma_f32_16x16x32_bf16 v[200:203], a[96:99], a[8:11], 0
ds_read_b64_tr_b16 a[94:95], v15 offset:10496
v_add_u32 v12, 0xffff0000, v12
v_mfma_f32_16x16x32_bf16 v[200:203], a[100:103], a[24:27], v[200:203]
v_add_u32 v13, 0xffff0000, v13
v_add_u32 v14, 0xffff0000, v14
v_mfma_f32_16x16x32_bf16 v[208:211], a[100:103], a[28:31], 0
v_add_u32 v15, 0xffff0000, v15
v_accvgpr_read_b32 v3, a239
v_cvt_pk_bf16_f32 v2, v2, v3
v_mfma_f32_16x16x32_bf16 v[208:211], a[96:99], a[12:15], v[208:211]
v_accvgpr_write_b32 a235, v2
v_accvgpr_read_b32 v2, a240
v_mfma_f32_16x16x32_bf16 v[212:215], a[104:107], a[12:15], 0
s_waitcnt vmcnt(28) lgkmcnt(0)
v_accvgpr_read_b32 v3, a241
v_cvt_pk_bf16_f32 v2, v2, v3
v_mfma_f32_16x16x32_bf16 v[212:215], a[108:111], a[28:31], v[212:215]
s_barrier
s_add_u32 m0, s17, 0x10000
v_accvgpr_write_b32 a240, v2
v_accvgpr_read_b32 v2, a242
v_mfma_f32_16x16x32_bf16 v[204:207], a[108:111], a[24:27], 0
buffer_load_dwordx4 v5, s[52:55], 0 offen lds
v_mfma_f32_16x16x32_bf16 v[204:207], a[104:107], a[8:11], v[204:207]
ds_read_b64_tr_b16 a[96:97], v12 offset:0
v_accvgpr_read_b32 v3, a243
v_mfma_f32_16x16x32_bf16 v[196:199], a[104:107], a[4:7], 0
ds_read_b64_tr_b16 a[98:99], v12 offset:1024
v_cvt_pk_bf16_f32 v2, v2, v3
v_accvgpr_write_b32 a241, v2
v_mfma_f32_16x16x32_bf16 v[196:199], a[108:111], a[20:23], v[196:199]
ds_read_b64_tr_b16 a[100:101], v12 offset:8192
v_accvgpr_read_b32 v2, a244
v_mfma_f32_16x16x32_bf16 v[188:191], a[108:111], a[16:19], 0
ds_read_b64_tr_b16 a[102:103], v12 offset:9216
v_accvgpr_read_b32 v3, a245
v_mfma_f32_16x16x32_bf16 v[188:191], a[104:107], a[0:3], v[188:191]
s_add_u32 m0, s17, 0x10400
s_waitcnt lgkmcnt(4)
v_cvt_pk_bf16_f32 v2, v2, v3
v_accvgpr_write_b32 a242, v2
v_mfma_f32_16x16x32_bf16 v[216:219], a[0:3], a[80:83], 0
buffer_load_dwordx4 v5, s[52:55], s13 offen lds
v_mfma_f32_16x16x32_bf16 v[216:219], a[16:19], a[84:87], v[216:219]
ds_read_b64_tr_b16 a[104:105], v13 offset:0
v_accvgpr_read_b32 v2, a246
v_mfma_f32_16x16x32_bf16 v[224:227], a[20:23], a[84:87], 0
ds_read_b64_tr_b16 a[106:107], v13 offset:1024
v_accvgpr_read_b32 v3, a247
v_cvt_pk_bf16_f32 v2, v2, v3
v_mfma_f32_16x16x32_bf16 v[224:227], a[4:7], a[80:83], v[224:227]
ds_read_b64_tr_b16 a[108:109], v13 offset:8192
v_accvgpr_write_b32 a243, v2
v_mfma_f32_16x16x32_bf16 v[232:235], a[8:11], a[80:83], 0
ds_read_b64_tr_b16 a[110:111], v13 offset:9216
v_accvgpr_read_b32 v2, a248
v_mfma_f32_16x16x32_bf16 v[232:235], a[24:27], a[84:87], v[232:235]
v_accvgpr_read_b32 v3, a249
v_cvt_pk_bf16_f32 v2, v2, v3
v_accvgpr_write_b32 a248, v2
v_mfma_f32_16x16x32_bf16 v[240:243], a[28:31], a[84:87], 0
s_add_u32 m0, s17, 0x10800
v_accvgpr_read_b32 v2, a250
v_accvgpr_read_b32 v3, a251
v_mfma_f32_16x16x32_bf16 v[240:243], a[12:15], a[80:83], v[240:243]
buffer_load_dwordx4 v6, s[52:55], 0 offen lds
v_mfma_f32_16x16x32_bf16 v[244:247], a[12:15], a[88:91], 0
ds_read_b64_tr_b16 a[80:81], v12 offset:256
v_cvt_pk_bf16_f32 v2, v2, v3
v_accvgpr_write_b32 a249, v2
v_mfma_f32_16x16x32_bf16 v[244:247], a[28:31], a[92:95], v[244:247]
ds_read_b64_tr_b16 a[82:83], v12 offset:1280
v_accvgpr_read_b32 v2, a252
v_mfma_f32_16x16x32_bf16 v[236:239], a[24:27], a[92:95], 0
ds_read_b64_tr_b16 a[84:85], v12 offset:8448
v_accvgpr_read_b32 v3, a253
v_mfma_f32_16x16x32_bf16 v[236:239], a[8:11], a[88:91], v[236:239]
ds_read_b64_tr_b16 a[86:87], v12 offset:9472
v_cvt_pk_bf16_f32 v2, v2, v3
v_accvgpr_write_b32 a250, v2
v_mfma_f32_16x16x32_bf16 v[228:231], a[4:7], a[88:91], 0
v_accvgpr_read_b32 v2, a254
v_accvgpr_read_b32 v3, a255
v_mfma_f32_16x16x32_bf16 v[228:231], a[20:23], a[92:95], v[228:231]
s_add_u32 m0, s17, 0x10c00
v_cvt_pk_bf16_f32 v2, v2, v3
v_accvgpr_write_b32 a251, v2
v_mfma_f32_16x16x32_bf16 v[220:223], a[16:19], a[92:95], 0
buffer_load_dwordx4 v6, s[52:55], s13 offen lds
v_mfma_f32_16x16x32_bf16 v[220:223], a[0:3], a[88:91], v[220:223]
s_waitcnt lgkmcnt(4)
L_S9:
v_mfma_f32_16x16x32_bf16 v[24:27], a[96:99], a[32:35], v[24:27]
ds_read_b64_tr_b16 a[88:89], v13 offset:256
s_waitcnt vmcnt(23)
v_mfma_f32_16x16x32_bf16 v[24:27], a[100:103], a[48:51], v[24:27]
ds_read_b64_tr_b16 a[90:91], v13 offset:1280
v_mfma_f32_16x16x32_bf16 v[32:35], a[100:103], a[52:55], v[32:35]
ds_read_b64_tr_b16 a[92:93], v13 offset:8448
L_padA5:
s_cmp_eq_u32 s95, 1
s_cbranch_scc1 L_padA9
v_mfma_f32_16x16x32_bf16 v[32:35], a[96:99], a[36:39], v[32:35]
ds_read_b64_tr_b16 a[94:95], v13 offset:9472
v_mfma_f32_16x16x32_bf16 v[40:43], a[96:99], a[40:43], v[40:43]
ds_read_b128 a[0:3], v8 offset:0
s_add_u32 m0, s18, 0x14000
v_mfma_f32_16x16x32_bf16 v[40:43], a[100:103], a[56:59], v[40:43]
buffer_load_dwordx4 v7, s[68:71], 0 offen lds
v_mfma_f32_16x16x32_bf16 v[48:51], a[100:103], a[60:63], v[48:51]
ds_read_b128 a[16:19], v9 offset:0
v_mfma_f32_16x16x32_bf16 v[48:51], a[96:99], a[44:47], v[48:51]
ds_read_b128 a[4:7], v8 offset:2048
v_mfma_f32_16x16x32_bf16 v[52:55], a[104:107], a[44:47], v[52:55]
ds_read_b64_tr_b16 a[96:97], v12 offset:512
v_mfma_f32_16x16x32_bf16 v[52:55], a[108:111], a[60:63], v[52:55]
ds_read_b64_tr_b16 a[98:99], v12 offset:1536
v_mfma_f32_16x16x32_bf16 v[44:47], a[108:111], a[56:59], v[44:47]
ds_read_b64_tr_b16 a[100:101], v12 offset:8704
s_add_u32 s8, s28, 0x7000
v_mfma_f32_16x16x32_bf16 v[44:47], a[104:107], a[40:43], v[44:47]
buffer_store_dwordx4 a[140:143], v16, s[88:91], s8 offen sc1
v_mfma_f32_16x16x32_bf16 v[36:39], a[104:107], a[36:39], v[36:39]
ds_read_b64_tr_b16 a[102:103], v12 offset:9728
v_mfma_f32_16x16x32_bf16 v[36:39], a[108:111], a[52:55], v[36:39]
ds_read_b128 a[20:23], v9 offset:2048
v_mfma_f32_16x16x32_bf16 v[28:31], a[108:111], a[48:51], v[28:31]
ds_read_b128 a[8:11], v8 offset:4096
v_mfma_f32_16x16x32_bf16 v[28:31], a[104:107], a[32:35], v[28:31]
ds_read_b128 a[24:27], v9 offset:4096
s_waitcnt lgkmcnt(10)
v_mfma_f32_16x16x32_bf16 v[56:59], a[80:83], a[32:35], v[56:59]
ds_read_b64_tr_b16 a[104:105], v13 offset:512
v_mfma_f32_16x16x32_bf16 v[56:59], a[84:87], a[48:51], v[56:59]
ds_read_b64_tr_b16 a[106:107], v13 offset:1536
s_add_u32 m0, s18, 0x15000
v_mfma_f32_16x16x32_bf16 v[64:67], a[84:87], a[52:55], v[64:67]
buffer_load_dwordx4 v7, s[68:71], s25 offen lds
v_mfma_f32_16x16x32_bf16 v[64:67], a[80:83], a[36:39], v[64:67]
ds_read_b64_tr_b16 a[108:109], v13 offset:8704
v_mfma_f32_16x16x32_bf16 v[72:75], a[80:83], a[40:43], v[72:75]
ds_read_b64_tr_b16 a[110:111], v13 offset:9728
v_mfma_f32_16x16x32_bf16 v[72:75], a[84:87], a[56:59], v[72:75]
ds_read_b128 a[12:15], v8 offset:6144
v_mfma_f32_16x16x32_bf16 v[80:83], a[84:87], a[60:63], v[80:83]
ds_read_b128 a[28:31], v9 offset:6144
v_mfma_f32_16x16x32_bf16 v[80:83], a[80:83], a[44:47], v[80:83]
v_mfma_f32_16x16x32_bf16 v[84:87], a[88:91], a[44:47], v[84:87]
ds_read_b64_tr_b16 a[80:81], v12 offset:768
s_add_u32 m0, s18, 0x16000
v_mfma_f32_16x16x32_bf16 v[84:87], a[92:95], a[60:63], v[84:87]
buffer_load_dwordx4 v7, s[68:71], s26 offen lds
v_mfma_f32_16x16x32_bf16 v[76:79], a[92:95], a[56:59], v[76:79]
ds_read_b64_tr_b16 a[82:83], v12 offset:1792
v_lshl_add_u32 v5, s42, 19, v5
v_mfma_f32_16x16x32_bf16 v[76:79], a[88:91], a[40:43], v[76:79]
ds_read_b64_tr_b16 a[84:85], v12 offset:8960
v_lshl_add_u32 v6, s42, 19, v6
v_mfma_f32_16x16x32_bf16 v[68:71], a[88:91], a[36:39], v[68:71]
ds_read_b64_tr_b16 a[86:87], v12 offset:9984
v_lshl_add_u32 v7, s42, 18, v7
v_mfma_f32_16x16x32_bf16 v[68:71], a[92:95], a[52:55], v[68:71]
v_lshl_add_u32 v7, s42, 17, v7
v_mfma_f32_16x16x32_bf16 v[60:63], a[92:95], a[48:51], v[60:63]
v_mfma_f32_16x16x32_bf16 v[60:63], a[88:91], a[32:35], v[60:63]
s_add_u32 m0, s16, 0x0
s_waitcnt lgkmcnt(4)
s_waitcnt lgkmcnt(6)
v_mfma_f32_16x16x32_bf16 v[88:91], a[96:99], a[32:35], v[88:91]
buffer_load_dwordx4 v22, s[44:47], s20 offen lds
v_mfma_f32_16x16x32_bf16 v[88:91], a[100:103], a[48:51], v[88:91]
ds_read_b64_tr_b16 a[88:89], v13 offset:768
v_mfma_f32_16x16x32_bf16 v[96:99], a[100:103], a[52:55], v[96:99]
ds_read_b64_tr_b16 a[90:91], v13 offset:1792
v_mfma_f32_16x16x32_bf16 v[96:99], a[96:99], a[36:39], v[96:99]
ds_read_b64_tr_b16 a[92:93], v13 offset:8960
v_mfma_f32_16x16x32_bf16 v[104:107], a[96:99], a[40:43], v[104:107]
ds_read_b64_tr_b16 a[94:95], v13 offset:9984
s_add_u32 m0, s16, 0x400
v_mfma_f32_16x16x32_bf16 v[104:107], a[100:103], a[56:59], v[104:107]
buffer_load_dwordx4 v23, s[44:47], s20 offen lds
v_mfma_f32_16x16x32_bf16 v[112:115], a[100:103], a[60:63], v[112:115]
v_mfma_f32_16x16x32_bf16 v[112:115], a[96:99], a[44:47], v[112:115]
v_mfma_f32_16x16x32_bf16 v[116:119], a[104:107], a[44:47], v[116:119]
ds_read_b64_tr_b16 a[96:97], v14 offset:0
v_mfma_f32_16x16x32_bf16 v[116:119], a[108:111], a[60:63], v[116:119]
ds_read_b64_tr_b16 a[98:99], v14 offset:256
v_mfma_f32_16x16x32_bf16 v[108:111], a[108:111], a[56:59], v[108:111]
ds_read_b64_tr_b16 a[100:101], v14 offset:2048
s_add_u32 m0, s16, 0x800
v_mfma_f32_16x16x32_bf16 v[108:111], a[104:107], a[40:43], v[108:111]
buffer_load_dwordx4 v22, s[44:47], s21 offen lds
v_mfma_f32_16x16x32_bf16 v[100:103], a[104:107], a[36:39], v[100:103]
ds_read_b64_tr_b16 a[102:103], v14 offset:2304
v_mfma_f32_16x16x32_bf16 v[100:103], a[108:111], a[52:55], v[100:103]
v_mfma_f32_16x16x32_bf16 v[92:95], a[108:111], a[48:51], v[92:95]
v_mfma_f32_16x16x32_bf16 v[92:95], a[104:107], a[32:35], v[92:95]
s_add_u32 s8, s28, 0x2400
s_waitcnt lgkmcnt(4)
v_mfma_f32_16x16x32_bf16 v[120:123], a[80:83], a[32:35], v[120:123]
buffer_store_dwordx4 a[144:147], v16, s[88:91], s8 offen sc1
v_mfma_f32_16x16x32_bf16 v[120:123], a[84:87], a[48:51], v[120:123]
ds_read_b64_tr_b16 a[104:105], v15 offset:0
v_mfma_f32_16x16x32_bf16 v[128:131], a[84:87], a[52:55], v[128:131]
ds_read_b64_tr_b16 a[106:107], v15 offset:256
v_mfma_f32_16x16x32_bf16 v[128:131], a[80:83], a[36:39], v[128:131]
ds_read_b64_tr_b16 a[108:109], v15 offset:2048
v_mfma_f32_16x16x32_bf16 v[136:139], a[80:83], a[40:43], v[136:139]
ds_read_b64_tr_b16 a[110:111], v15 offset:2304
v_mfma_f32_16x16x32_bf16 v[136:139], a[84:87], a[56:59], v[136:139]
s_add_u32 m0, s16, 0xc00
v_mfma_f32_16x16x32_bf16 v[144:147], a[84:87], a[60:63], v[144:147]
buffer_load_dwordx4 v23, s[44:47], s21 offen lds
v_mfma_f32_16x16x32_bf16 v[144:147], a[80:83], a[44:47], v[144:147]
v_mfma_f32_16x16x32_bf16 v[148:151], a[88:91], a[44:47], v[148:151]
ds_read_b64_tr_b16 a[80:81], v14 offset:4096
v_mfma_f32_16x16x32_bf16 v[148:151], a[92:95], a[60:63], v[148:151]
ds_read_b64_tr_b16 a[82:83], v14 offset:4352
v_mfma_f32_16x16x32_bf16 v[140:143], a[92:95], a[56:59], v[140:143]
ds_read_b64_tr_b16 a[84:85], v14 offset:6144
v_mfma_f32_16x16x32_bf16 v[140:143], a[88:91], a[40:43], v[140:143]
ds_read_b64_tr_b16 a[86:87], v14 offset:6400
s_add_u32 m0, s16, 0x1000
v_mfma_f32_16x16x32_bf16 v[132:135], a[88:91], a[36:39], v[132:135]
buffer_load_dwordx4 v22, s[44:47], s22 offen lds
v_mfma_f32_16x16x32_bf16 v[132:135], a[92:95], a[52:55], v[132:135]
v_mfma_f32_16x16x32_bf16 v[124:127], a[92:95], a[48:51], v[124:127]
v_mfma_f32_16x16x32_bf16 v[124:127], a[88:91], a[32:35], v[124:127]
s_waitcnt lgkmcnt(4)
v_mfma_f32_16x16x32_bf16 v[152:155], a[96:99], a[32:35], v[152:155]
ds_read_b64_tr_b16 a[88:89], v15 offset:4096
s_add_u32 m0, s16, 0x1400
v_mfma_f32_16x16x32_bf16 v[152:155], a[100:103], a[48:51], v[152:155]
buffer_load_dwordx4 v23, s[44:47], s22 offen lds
v_mfma_f32_16x16x32_bf16 v[160:163], a[100:103], a[52:55], v[160:163]
ds_read_b64_tr_b16 a[90:91], v15 offset:4352
v_mfma_f32_16x16x32_bf16 v[160:163], a[96:99], a[36:39], v[160:163]
ds_read_b64_tr_b16 a[92:93], v15 offset:6144
v_mfma_f32_16x16x32_bf16 v[168:171], a[96:99], a[40:43], v[168:171]
ds_read_b64_tr_b16 a[94:95], v15 offset:6400
v_mfma_f32_16x16x32_bf16 v[168:171], a[100:103], a[56:59], v[168:171]
v_mfma_f32_16x16x32_bf16 v[176:179], a[100:103], a[60:63], v[176:179]
s_add_u32 m0, s16, 0x1800
v_mfma_f32_16x16x32_bf16 v[176:179], a[96:99], a[44:47], v[176:179]
buffer_load_dwordx4 v22, s[44:47], s23 offen lds
v_mfma_f32_16x16x32_bf16 v[180:183], a[104:107], a[44:47], v[180:183]
ds_read_b64_tr_b16 a[96:97], v14 offset:8192
v_mfma_f32_16x16x32_bf16 v[180:183], a[108:111], a[60:63], v[180:183]
ds_read_b64_tr_b16 a[98:99], v14 offset:8448
v_mfma_f32_16x16x32_bf16 v[172:175], a[108:111], a[56:59], v[172:175]
ds_read_b64_tr_b16 a[100:101], v14 offset:10240
v_mfma_f32_16x16x32_bf16 v[172:175], a[104:107], a[40:43], v[172:175]
ds_read_b64_tr_b16 a[102:103], v14 offset:10496
s_add_u32 m0, s16, 0x1c00
v_mfma_f32_16x16x32_bf16 v[164:167], a[104:107], a[36:39], v[164:167]
buffer_load_dwordx4 v23, s[44:47], s23 offen lds
v_mfma_f32_16x16x32_bf16 v[164:167], a[108:111], a[52:55], v[164:167]
v_lshl_add_u32 v22, s42, 7, v22
v_lshl_add_u32 v23, s42, 7, v23
v_mfma_f32_16x16x32_bf16 v[156:159], a[108:111], a[48:51], v[156:159]
v_mfma_f32_16x16x32_bf16 v[156:159], a[104:107], a[32:35], v[156:159]
s_waitcnt lgkmcnt(4)
v_mfma_f32_16x16x32_bf16 v[184:187], a[80:83], a[32:35], v[184:187]
ds_read_b64_tr_b16 a[104:105], v15 offset:8192
v_mfma_f32_16x16x32_bf16 v[184:187], a[84:87], a[48:51], v[184:187]
ds_read_b64_tr_b16 a[106:107], v15 offset:8448
s_add_u32 s8, s28, 0x3400
v_mfma_f32_16x16x32_bf16 v[192:195], a[84:87], a[52:55], v[192:195]
buffer_store_dwordx4 a[148:151], v16, s[88:91], s8 offen sc1
v_mfma_f32_16x16x32_bf16 v[192:195], a[80:83], a[36:39], v[192:195]
ds_read_b64_tr_b16 a[108:109], v15 offset:10240
v_mfma_f32_16x16x32_bf16 v[200:203], a[80:83], a[40:43], v[200:203]
ds_read_b64_tr_b16 a[110:111], v15 offset:10496
v_add_u32 v12, 0x8000, v12
v_mfma_f32_16x16x32_bf16 v[200:203], a[84:87], a[56:59], v[200:203]
v_add_u32 v13, 0x8000, v13
v_add_u32 v14, 0x8000, v14
v_mfma_f32_16x16x32_bf16 v[208:211], a[84:87], a[60:63], v[208:211]
v_add_u32 v15, 0x8000, v15
v_mfma_f32_16x16x32_bf16 v[208:211], a[80:83], a[44:47], v[208:211]
v_mfma_f32_16x16x32_bf16 v[212:215], a[88:91], a[44:47], v[212:215]
s_waitcnt vmcnt(28) lgkmcnt(0)
v_mfma_f32_16x16x32_bf16 v[212:215], a[92:95], a[60:63], v[212:215]
s_barrier
s_add_u32 m0, s17, 0x0
v_mfma_f32_16x16x32_bf16 v[204:207], a[92:95], a[56:59], v[204:207]
buffer_load_dwordx4 v5, s[52:55], 0 offen lds
v_mfma_f32_16x16x32_bf16 v[204:207], a[88:91], a[40:43], v[204:207]
ds_read_b64_tr_b16 a[80:81], v12 offset:0
v_mfma_f32_16x16x32_bf16 v[196:199], a[88:91], a[36:39], v[196:199]
ds_read_b64_tr_b16 a[82:83], v12 offset:1024
v_mfma_f32_16x16x32_bf16 v[196:199], a[92:95], a[52:55], v[196:199]
ds_read_b64_tr_b16 a[84:85], v12 offset:8192
v_mfma_f32_16x16x32_bf16 v[188:191], a[92:95], a[48:51], v[188:191]
ds_read_b64_tr_b16 a[86:87], v12 offset:9216
v_mfma_f32_16x16x32_bf16 v[188:191], a[88:91], a[32:35], v[188:191]
s_add_u32 m0, s17, 0x400
s_waitcnt lgkmcnt(4)
v_mfma_f32_16x16x32_bf16 v[216:219], a[32:35], a[96:99], v[216:219]
buffer_load_dwordx4 v5, s[52:55], s13 offen lds
v_mfma_f32_16x16x32_bf16 v[216:219], a[48:51], a[100:103], v[216:219]
ds_read_b64_tr_b16 a[88:89], v13 offset:0
v_mfma_f32_16x16x32_bf16 v[224:227], a[52:55], a[100:103], v[224:227]
ds_read_b64_tr_b16 a[90:91], v13 offset:1024
v_mfma_f32_16x16x32_bf16 v[224:227], a[36:39], a[96:99], v[224:227]
ds_read_b64_tr_b16 a[92:93], v13 offset:8192
v_mfma_f32_16x16x32_bf16 v[232:235], a[40:43], a[96:99], v[232:235]
ds_read_b64_tr_b16 a[94:95], v13 offset:9216
v_mfma_f32_16x16x32_bf16 v[232:235], a[56:59], a[100:103], v[232:235]
v_mfma_f32_16x16x32_bf16 v[240:243], a[60:63], a[100:103], v[240:243]
s_add_u32 m0, s17, 0x800
v_mfma_f32_16x16x32_bf16 v[240:243], a[44:47], a[96:99], v[240:243]
buffer_load_dwordx4 v6, s[52:55], 0 offen lds
v_mfma_f32_16x16x32_bf16 v[244:247], a[44:47], a[104:107], v[244:247]
ds_read_b64_tr_b16 a[96:97], v12 offset:256
v_mfma_f32_16x16x32_bf16 v[244:247], a[60:63], a[108:111], v[244:247]
ds_read_b64_tr_b16 a[98:99], v12 offset:1280
v_mfma_f32_16x16x32_bf16 v[236:239], a[56:59], a[108:111], v[236:239]
ds_read_b64_tr_b16 a[100:101], v12 offset:8448
v_mfma_f32_16x16x32_bf16 v[236:239], a[40:43], a[104:107], v[236:239]
ds_read_b64_tr_b16 a[102:103], v12 offset:9472
v_mfma_f32_16x16x32_bf16 v[228:231], a[36:39], a[104:107], v[228:231]
v_mfma_f32_16x16x32_bf16 v[228:231], a[52:55], a[108:111], v[228:231]
s_add_u32 m0, s17, 0xc00
v_mfma_f32_16x16x32_bf16 v[220:223], a[48:51], a[108:111], v[220:223]
buffer_load_dwordx4 v6, s[52:55], s13 offen lds
v_mfma_f32_16x16x32_bf16 v[220:223], a[32:35], a[104:107], v[220:223]
s_waitcnt lgkmcnt(4)
L_S10:
v_mfma_f32_16x16x32_bf16 v[24:27], a[80:83], a[0:3], v[24:27]
ds_read_b64_tr_b16 a[104:105], v13 offset:256
s_waitcnt vmcnt(23)
v_mfma_f32_16x16x32_bf16 v[24:27], a[84:87], a[16:19], v[24:27]
ds_read_b64_tr_b16 a[106:107], v13 offset:1280
v_mfma_f32_16x16x32_bf16 v[32:35], a[84:87], a[20:23], v[32:35]
ds_read_b64_tr_b16 a[108:109], v13 offset:8448
v_mfma_f32_16x16x32_bf16 v[32:35], a[80:83], a[4:7], v[32:35]
ds_read_b64_tr_b16 a[110:111], v13 offset:9472
v_mfma_f32_16x16x32_bf16 v[40:43], a[80:83], a[8:11], v[40:43]
ds_read_b128 a[32:35], v8 offset:32768
s_add_u32 m0, s18, 0x4000
v_mfma_f32_16x16x32_bf16 v[40:43], a[84:87], a[24:27], v[40:43]
buffer_load_dwordx4 v7, s[68:71], 0 offen lds
v_mfma_f32_16x16x32_bf16 v[48:51], a[84:87], a[28:31], v[48:51]
ds_read_b128 a[48:51], v9 offset:32768
v_mfma_f32_16x16x32_bf16 v[48:51], a[80:83], a[12:15], v[48:51]
ds_read_b128 a[36:39], v8 offset:34816
v_mfma_f32_16x16x32_bf16 v[52:55], a[88:91], a[12:15], v[52:55]
ds_read_b64_tr_b16 a[80:81], v12 offset:512
v_mfma_f32_16x16x32_bf16 v[52:55], a[92:95], a[28:31], v[52:55]
ds_read_b64_tr_b16 a[82:83], v12 offset:1536
v_mfma_f32_16x16x32_bf16 v[44:47], a[92:95], a[24:27], v[44:47]
ds_read_b64_tr_b16 a[84:85], v12 offset:8704
s_add_u32 s8, s28, 0x6400
v_mfma_f32_16x16x32_bf16 v[44:47], a[88:91], a[8:11], v[44:47]
buffer_store_dwordx4 a[152:155], v16, s[88:91], s8 offen sc1
v_mfma_f32_16x16x32_bf16 v[36:39], a[88:91], a[4:7], v[36:39]
ds_read_b64_tr_b16 a[86:87], v12 offset:9728
v_mfma_f32_16x16x32_bf16 v[36:39], a[92:95], a[20:23], v[36:39]
ds_read_b128 a[52:55], v9 offset:34816
v_mfma_f32_16x16x32_bf16 v[28:31], a[92:95], a[16:19], v[28:31]
ds_read_b128 a[40:43], v8 offset:36864
v_mfma_f32_16x16x32_bf16 v[28:31], a[88:91], a[0:3], v[28:31]
ds_read_b128 a[56:59], v9 offset:36864
s_waitcnt lgkmcnt(10)
v_mfma_f32_16x16x32_bf16 v[56:59], a[96:99], a[0:3], v[56:59]
ds_read_b64_tr_b16 a[88:89], v13 offset:512
v_mfma_f32_16x16x32_bf16 v[56:59], a[100:103], a[16:19], v[56:59]
ds_read_b64_tr_b16 a[90:91], v13 offset:1536
s_add_u32 m0, s18, 0x5000
v_mfma_f32_16x16x32_bf16 v[64:67], a[100:103], a[20:23], v[64:67]
buffer_load_dwordx4 v7, s[68:71], s25 offen lds
v_mfma_f32_16x16x32_bf16 v[64:67], a[96:99], a[4:7], v[64:67]
ds_read_b64_tr_b16 a[92:93], v13 offset:8704
v_mfma_f32_16x16x32_bf16 v[72:75], a[96:99], a[8:11], v[72:75]
ds_read_b64_tr_b16 a[94:95], v13 offset:9728
v_mfma_f32_16x16x32_bf16 v[72:75], a[100:103], a[24:27], v[72:75]
ds_read_b128 a[44:47], v8 offset:38912
v_mfma_f32_16x16x32_bf16 v[80:83], a[100:103], a[28:31], v[80:83]
ds_read_b128 a[60:63], v9 offset:38912
v_mfma_f32_16x16x32_bf16 v[80:83], a[96:99], a[12:15], v[80:83]
v_mfma_f32_16x16x32_bf16 v[84:87], a[104:107], a[12:15], v[84:87]
ds_read_b64_tr_b16 a[96:97], v12 offset:768
s_add_u32 m0, s18, 0x6000
v_mfma_f32_16x16x32_bf16 v[84:87], a[108:111], a[28:31], v[84:87]
buffer_load_dwordx4 v7, s[68:71], s26 offen lds
v_mfma_f32_16x16x32_bf16 v[76:79], a[108:111], a[24:27], v[76:79]
ds_read_b64_tr_b16 a[98:99], v12 offset:1792
v_lshl_add_u32 v5, s42, 19, v5
v_mfma_f32_16x16x32_bf16 v[76:79], a[104:107], a[8:11], v[76:79]
ds_read_b64_tr_b16 a[100:101], v12 offset:8960
v_lshl_add_u32 v6, s42, 19, v6
v_mfma_f32_16x16x32_bf16 v[68:71], a[104:107], a[4:7], v[68:71]
ds_read_b64_tr_b16 a[102:103], v12 offset:9984
v_lshl_add_u32 v7, s42, 18, v7
v_mfma_f32_16x16x32_bf16 v[68:71], a[108:111], a[20:23], v[68:71]
v_lshl_add_u32 v7, s42, 17, v7
v_mfma_f32_16x16x32_bf16 v[60:63], a[108:111], a[16:19], v[60:63]
v_mfma_f32_16x16x32_bf16 v[60:63], a[104:107], a[0:3], v[60:63]
s_add_u32 m0, s16, 0x8000
s_waitcnt lgkmcnt(4)
s_waitcnt lgkmcnt(6)
v_mfma_f32_16x16x32_bf16 v[88:91], a[80:83], a[0:3], v[88:91]
buffer_load_dwordx4 v22, s[44:47], s20 offen lds
v_mfma_f32_16x16x32_bf16 v[88:91], a[84:87], a[16:19], v[88:91]
ds_read_b64_tr_b16 a[104:105], v13 offset:768
v_mfma_f32_16x16x32_bf16 v[96:99], a[84:87], a[20:23], v[96:99]
ds_read_b64_tr_b16 a[106:107], v13 offset:1792
v_mfma_f32_16x16x32_bf16 v[96:99], a[80:83], a[4:7], v[96:99]
ds_read_b64_tr_b16 a[108:109], v13 offset:8960
v_mfma_f32_16x16x32_bf16 v[104:107], a[80:83], a[8:11], v[104:107]
ds_read_b64_tr_b16 a[110:111], v13 offset:9984
s_add_u32 m0, s16, 0x8400
v_mfma_f32_16x16x32_bf16 v[104:107], a[84:87], a[24:27], v[104:107]
buffer_load_dwordx4 v23, s[44:47], s20 offen lds
v_mfma_f32_16x16x32_bf16 v[112:115], a[84:87], a[28:31], v[112:115]
v_mfma_f32_16x16x32_bf16 v[112:115], a[80:83], a[12:15], v[112:115]
v_mfma_f32_16x16x32_bf16 v[116:119], a[88:91], a[12:15], v[116:119]
ds_read_b64_tr_b16 a[80:81], v14 offset:0
v_mfma_f32_16x16x32_bf16 v[116:119], a[92:95], a[28:31], v[116:119]
ds_read_b64_tr_b16 a[82:83], v14 offset:256
v_mfma_f32_16x16x32_bf16 v[108:111], a[92:95], a[24:27], v[108:111]
ds_read_b64_tr_b16 a[84:85], v14 offset:2048
s_add_u32 m0, s16, 0x8800
v_mfma_f32_16x16x32_bf16 v[108:111], a[88:91], a[8:11], v[108:111]
buffer_load_dwordx4 v22, s[44:47], s21 offen lds
v_mfma_f32_16x16x32_bf16 v[100:103], a[88:91], a[4:7], v[100:103]
ds_read_b64_tr_b16 a[86:87], v14 offset:2304
v_mfma_f32_16x16x32_bf16 v[100:103], a[92:95], a[20:23], v[100:103]
v_mfma_f32_16x16x32_bf16 v[92:95], a[92:95], a[16:19], v[92:95]
v_mfma_f32_16x16x32_bf16 v[92:95], a[88:91], a[0:3], v[92:95]
s_add_u32 s8, s28, 0x7400
s_waitcnt lgkmcnt(4)
v_mfma_f32_16x16x32_bf16 v[120:123], a[96:99], a[0:3], v[120:123]
buffer_store_dwordx4 a[156:159], v16, s[88:91], s8 offen sc1
v_mfma_f32_16x16x32_bf16 v[120:123], a[100:103], a[16:19], v[120:123]
ds_read_b64_tr_b16 a[88:89], v15 offset:0
v_mfma_f32_16x16x32_bf16 v[128:131], a[100:103], a[20:23], v[128:131]
ds_read_b64_tr_b16 a[90:91], v15 offset:256
v_mfma_f32_16x16x32_bf16 v[128:131], a[96:99], a[4:7], v[128:131]
ds_read_b64_tr_b16 a[92:93], v15 offset:2048
v_mfma_f32_16x16x32_bf16 v[136:139], a[96:99], a[8:11], v[136:139]
ds_read_b64_tr_b16 a[94:95], v15 offset:2304
v_mfma_f32_16x16x32_bf16 v[136:139], a[100:103], a[24:27], v[136:139]
s_add_u32 m0, s16, 0x8c00
v_mfma_f32_16x16x32_bf16 v[144:147], a[100:103], a[28:31], v[144:147]
buffer_load_dwordx4 v23, s[44:47], s21 offen lds
v_mfma_f32_16x16x32_bf16 v[144:147], a[96:99], a[12:15], v[144:147]
v_mfma_f32_16x16x32_bf16 v[148:151], a[104:107], a[12:15], v[148:151]
ds_read_b64_tr_b16 a[96:97], v14 offset:4096
v_mfma_f32_16x16x32_bf16 v[148:151], a[108:111], a[28:31], v[148:151]
ds_read_b64_tr_b16 a[98:99], v14 offset:4352
v_mfma_f32_16x16x32_bf16 v[140:143], a[108:111], a[24:27], v[140:143]
ds_read_b64_tr_b16 a[100:101], v14 offset:6144
v_mfma_f32_16x16x32_bf16 v[140:143], a[104:107], a[8:11], v[140:143]
ds_read_b64_tr_b16 a[102:103], v14 offset:6400
s_add_u32 m0, s16, 0x9000
v_mfma_f32_16x16x32_bf16 v[132:135], a[104:107], a[4:7], v[132:135]
buffer_load_dwordx4 v22, s[44:47], s22 offen lds
v_mfma_f32_16x16x32_bf16 v[132:135], a[108:111], a[20:23], v[132:135]
v_mfma_f32_16x16x32_bf16 v[124:127], a[108:111], a[16:19], v[124:127]
v_mfma_f32_16x16x32_bf16 v[124:127], a[104:107], a[0:3], v[124:127]
s_waitcnt lgkmcnt(4)
v_mfma_f32_16x16x32_bf16 v[152:155], a[80:83], a[0:3], v[152:155]
ds_read_b64_tr_b16 a[104:105], v15 offset:4096
s_add_u32 m0, s16, 0x9400
v_mfma_f32_16x16x32_bf16 v[152:155], a[84:87], a[16:19], v[152:155]
buffer_load_dwordx4 v23, s[44:47], s22 offen lds
v_mfma_f32_16x16x32_bf16 v[160:163], a[84:87], a[20:23], v[160:163]
ds_read_b64_tr_b16 a[106:107], v15 offset:4352
v_mfma_f32_16x16x32_bf16 v[160:163], a[80:83], a[4:7], v[160:163]
ds_read_b64_tr_b16 a[108:109], v15 offset:6144
v_mfma_f32_16x16x32_bf16 v[168:171], a[80:83], a[8:11], v[168:171]
ds_read_b64_tr_b16 a[110:111], v15 offset:6400
v_mfma_f32_16x16x32_bf16 v[168:171], a[84:87], a[24:27], v[168:171]
v_mfma_f32_16x16x32_bf16 v[176:179], a[84:87], a[28:31], v[176:179]
s_add_u32 m0, s16, 0x9800
v_mfma_f32_16x16x32_bf16 v[176:179], a[80:83], a[12:15], v[176:179]
buffer_load_dwordx4 v22, s[44:47], s23 offen lds
v_mfma_f32_16x16x32_bf16 v[180:183], a[88:91], a[12:15], v[180:183]
ds_read_b64_tr_b16 a[80:81], v14 offset:8192
v_mfma_f32_16x16x32_bf16 v[180:183], a[92:95], a[28:31], v[180:183]
ds_read_b64_tr_b16 a[82:83], v14 offset:8448
v_mfma_f32_16x16x32_bf16 v[172:175], a[92:95], a[24:27], v[172:175]
ds_read_b64_tr_b16 a[84:85], v14 offset:10240
v_mfma_f32_16x16x32_bf16 v[172:175], a[88:91], a[8:11], v[172:175]
ds_read_b64_tr_b16 a[86:87], v14 offset:10496
s_add_u32 m0, s16, 0x9c00
v_mfma_f32_16x16x32_bf16 v[164:167], a[88:91], a[4:7], v[164:167]
buffer_load_dwordx4 v23, s[44:47], s23 offen lds
v_mfma_f32_16x16x32_bf16 v[164:167], a[92:95], a[20:23], v[164:167]
v_lshl_add_u32 v22, s42, 7, v22
v_lshl_add_u32 v23, s42, 7, v23
v_mfma_f32_16x16x32_bf16 v[156:159], a[92:95], a[16:19], v[156:159]
v_mfma_f32_16x16x32_bf16 v[156:159], a[88:91], a[0:3], v[156:159]
s_waitcnt lgkmcnt(4)
v_mfma_f32_16x16x32_bf16 v[184:187], a[96:99], a[0:3], v[184:187]
ds_read_b64_tr_b16 a[88:89], v15 offset:8192
v_mfma_f32_16x16x32_bf16 v[184:187], a[100:103], a[16:19], v[184:187]
ds_read_b64_tr_b16 a[90:91], v15 offset:8448
s_add_u32 s8, s28, 0x2800
v_mfma_f32_16x16x32_bf16 v[192:195], a[100:103], a[20:23], v[192:195]
buffer_store_dwordx4 a[160:163], v16, s[88:91], s8 offen sc1
v_mfma_f32_16x16x32_bf16 v[192:195], a[96:99], a[4:7], v[192:195]
ds_read_b64_tr_b16 a[92:93], v15 offset:10240
v_mfma_f32_16x16x32_bf16 v[200:203], a[96:99], a[8:11], v[200:203]
ds_read_b64_tr_b16 a[94:95], v15 offset:10496
v_add_u32 v12, 0x8000, v12
v_mfma_f32_16x16x32_bf16 v[200:203], a[100:103], a[24:27], v[200:203]
v_add_u32 v13, 0x8000, v13
v_add_u32 v14, 0x8000, v14
v_mfma_f32_16x16x32_bf16 v[208:211], a[100:103], a[28:31], v[208:211]
v_add_u32 v15, 0x8000, v15
v_mfma_f32_16x16x32_bf16 v[208:211], a[96:99], a[12:15], v[208:211]
v_mfma_f32_16x16x32_bf16 v[212:215], a[104:107], a[12:15], v[212:215]
s_waitcnt vmcnt(28) lgkmcnt(0)
v_mfma_f32_16x16x32_bf16 v[212:215], a[108:111], a[28:31], v[212:215]
s_barrier
s_add_u32 m0, s17, 0x8000
v_mfma_f32_16x16x32_bf16 v[204:207], a[108:111], a[24:27], v[204:207]
buffer_load_dwordx4 v5, s[52:55], 0 offen lds
v_mfma_f32_16x16x32_bf16 v[204:207], a[104:107], a[8:11], v[204:207]
ds_read_b64_tr_b16 a[96:97], v12 offset:0
v_mfma_f32_16x16x32_bf16 v[196:199], a[104:107], a[4:7], v[196:199]
ds_read_b64_tr_b16 a[98:99], v12 offset:1024
v_mfma_f32_16x16x32_bf16 v[196:199], a[108:111], a[20:23], v[196:199]
ds_read_b64_tr_b16 a[100:101], v12 offset:8192
v_mfma_f32_16x16x32_bf16 v[188:191], a[108:111], a[16:19], v[188:191]
ds_read_b64_tr_b16 a[102:103], v12 offset:9216
v_mfma_f32_16x16x32_bf16 v[188:191], a[104:107], a[0:3], v[188:191]
s_add_u32 m0, s17, 0x8400
s_waitcnt lgkmcnt(4)
v_mfma_f32_16x16x32_bf16 v[216:219], a[0:3], a[80:83], v[216:219]
buffer_load_dwordx4 v5, s[52:55], s13 offen lds
v_mfma_f32_16x16x32_bf16 v[216:219], a[16:19], a[84:87], v[216:219]
ds_read_b64_tr_b16 a[104:105], v13 offset:0
v_mfma_f32_16x16x32_bf16 v[224:227], a[20:23], a[84:87], v[224:227]
ds_read_b64_tr_b16 a[106:107], v13 offset:1024
v_mfma_f32_16x16x32_bf16 v[224:227], a[4:7], a[80:83], v[224:227]
ds_read_b64_tr_b16 a[108:109], v13 offset:8192
v_mfma_f32_16x16x32_bf16 v[232:235], a[8:11], a[80:83], v[232:235]
ds_read_b64_tr_b16 a[110:111], v13 offset:9216
v_mfma_f32_16x16x32_bf16 v[232:235], a[24:27], a[84:87], v[232:235]
v_mfma_f32_16x16x32_bf16 v[240:243], a[28:31], a[84:87], v[240:243]
s_add_u32 m0, s17, 0x8800
v_mfma_f32_16x16x32_bf16 v[240:243], a[12:15], a[80:83], v[240:243]
buffer_load_dwordx4 v6, s[52:55], 0 offen lds
v_mfma_f32_16x16x32_bf16 v[244:247], a[12:15], a[88:91], v[244:247]
ds_read_b64_tr_b16 a[80:81], v12 offset:256
v_mfma_f32_16x16x32_bf16 v[244:247], a[28:31], a[92:95], v[244:247]
ds_read_b64_tr_b16 a[82:83], v12 offset:1280
v_mfma_f32_16x16x32_bf16 v[236:239], a[24:27], a[92:95], v[236:239]
ds_read_b64_tr_b16 a[84:85], v12 offset:8448
v_mfma_f32_16x16x32_bf16 v[236:239], a[8:11], a[88:91], v[236:239]
ds_read_b64_tr_b16 a[86:87], v12 offset:9472
v_mfma_f32_16x16x32_bf16 v[228:231], a[4:7], a[88:91], v[228:231]
v_mfma_f32_16x16x32_bf16 v[228:231], a[20:23], a[92:95], v[228:231]
s_add_u32 m0, s17, 0x8c00
v_mfma_f32_16x16x32_bf16 v[220:223], a[16:19], a[92:95], v[220:223]
buffer_load_dwordx4 v6, s[52:55], s13 offen lds
v_mfma_f32_16x16x32_bf16 v[220:223], a[0:3], a[88:91], v[220:223]
s_waitcnt lgkmcnt(4)
L_S11:
v_mfma_f32_16x16x32_bf16 v[24:27], a[96:99], a[32:35], v[24:27]
ds_read_b64_tr_b16 a[88:89], v13 offset:256
s_waitcnt vmcnt(23)
v_mfma_f32_16x16x32_bf16 v[24:27], a[100:103], a[48:51], v[24:27]
ds_read_b64_tr_b16 a[90:91], v13 offset:1280
v_mfma_f32_16x16x32_bf16 v[32:35], a[100:103], a[52:55], v[32:35]
ds_read_b64_tr_b16 a[92:93], v13 offset:8448
v_mfma_f32_16x16x32_bf16 v[32:35], a[96:99], a[36:39], v[32:35]
ds_read_b64_tr_b16 a[94:95], v13 offset:9472
v_mfma_f32_16x16x32_bf16 v[40:43], a[96:99], a[40:43], v[40:43]
ds_read_b128 a[0:3], v8 offset:0
s_add_u32 m0, s18, 0xc000
v_mfma_f32_16x16x32_bf16 v[40:43], a[100:103], a[56:59], v[40:43]
buffer_load_dwordx4 v7, s[68:71], 0 offen lds
v_mfma_f32_16x16x32_bf16 v[48:51], a[100:103], a[60:63], v[48:51]
ds_read_b128 a[16:19], v9 offset:0
v_mfma_f32_16x16x32_bf16 v[48:51], a[96:99], a[44:47], v[48:51]
ds_read_b128 a[4:7], v8 offset:2048
v_mfma_f32_16x16x32_bf16 v[52:55], a[104:107], a[44:47], v[52:55]
ds_read_b64_tr_b16 a[96:97], v12 offset:512
v_mfma_f32_16x16x32_bf16 v[52:55], a[108:111], a[60:63], v[52:55]
ds_read_b64_tr_b16 a[98:99], v12 offset:1536
v_mfma_f32_16x16x32_bf16 v[44:47], a[108:111], a[56:59], v[44:47]
ds_read_b64_tr_b16 a[100:101], v12 offset:8704
s_add_u32 s8, s28, 0x3800
v_mfma_f32_16x16x32_bf16 v[44:47], a[104:107], a[40:43], v[44:47]
buffer_store_dwordx4 a[164:167], v16, s[88:91], s8 offen sc1
v_mfma_f32_16x16x32_bf16 v[36:39], a[104:107], a[36:39], v[36:39]
ds_read_b64_tr_b16 a[102:103], v12 offset:9728
v_mfma_f32_16x16x32_bf16 v[36:39], a[108:111], a[52:55], v[36:39]
ds_read_b128 a[20:23], v9 offset:2048
v_mfma_f32_16x16x32_bf16 v[28:31], a[108:111], a[48:51], v[28:31]
ds_read_b128 a[8:11], v8 offset:4096
v_mfma_f32_16x16x32_bf16 v[28:31], a[104:107], a[32:35], v[28:31]
ds_read_b128 a[24:27], v9 offset:4096
s_waitcnt lgkmcnt(10)
v_mfma_f32_16x16x32_bf16 v[56:59], a[80:83], a[32:35], v[56:59]
ds_read_b64_tr_b16 a[104:105], v13 offset:512
v_mfma_f32_16x16x32_bf16 v[56:59], a[84:87], a[48:51], v[56:59]
ds_read_b64_tr_b16 a[106:107], v13 offset:1536
s_add_u32 m0, s18, 0xd000
v_mfma_f32_16x16x32_bf16 v[64:67], a[84:87], a[52:55], v[64:67]
buffer_load_dwordx4 v7, s[68:71], s25 offen lds
v_mfma_f32_16x16x32_bf16 v[64:67], a[80:83], a[36:39], v[64:67]
ds_read_b64_tr_b16 a[108:109], v13 offset:8704
v_mfma_f32_16x16x32_bf16 v[72:75], a[80:83], a[40:43], v[72:75]
ds_read_b64_tr_b16 a[110:111], v13 offset:9728
v_mfma_f32_16x16x32_bf16 v[72:75], a[84:87], a[56:59], v[72:75]
ds_read_b128 a[12:15], v8 offset:6144
v_mfma_f32_16x16x32_bf16 v[80:83], a[84:87], a[60:63], v[80:83]
ds_read_b128 a[28:31], v9 offset:6144
v_mfma_f32_16x16x32_bf16 v[80:83], a[80:83], a[44:47], v[80:83]
v_mfma_f32_16x16x32_bf16 v[84:87], a[88:91], a[44:47], v[84:87]
ds_read_b64_tr_b16 a[80:81], v12 offset:768
s_add_u32 m0, s18, 0xe000
v_mfma_f32_16x16x32_bf16 v[84:87], a[92:95], a[60:63], v[84:87]
buffer_load_dwordx4 v7, s[68:71], s26 offen lds
v_mfma_f32_16x16x32_bf16 v[76:79], a[92:95], a[56:59], v[76:79]
ds_read_b64_tr_b16 a[82:83], v12 offset:1792
v_lshl_add_u32 v5, s42, 19, v5
v_mfma_f32_16x16x32_bf16 v[76:79], a[88:91], a[40:43], v[76:79]
ds_read_b64_tr_b16 a[84:85], v12 offset:8960
v_lshl_add_u32 v6, s42, 19, v6
v_mfma_f32_16x16x32_bf16 v[68:71], a[88:91], a[36:39], v[68:71]
ds_read_b64_tr_b16 a[86:87], v12 offset:9984
v_lshl_add_u32 v7, s42, 18, v7
v_mfma_f32_16x16x32_bf16 v[68:71], a[92:95], a[52:55], v[68:71]
L_padA6:
s_cmp_eq_u32 s95, 1
s_cbranch_scc1 L_padA10
v_lshl_add_u32 v7, s42, 17, v7
v_mfma_f32_16x16x32_bf16 v[60:63], a[92:95], a[48:51], v[60:63]
v_mfma_f32_16x16x32_bf16 v[60:63], a[88:91], a[32:35], v[60:63]
s_add_u32 m0, s16, 0x0
s_waitcnt lgkmcnt(4)
s_waitcnt lgkmcnt(6)
v_mfma_f32_16x16x32_bf16 v[88:91], a[96:99], a[32:35], v[88:91]
buffer_load_dwordx4 v22, s[44:47], s20 offen lds
v_mfma_f32_16x16x32_bf16 v[88:91], a[100:103], a[48:51], v[88:91]
ds_read_b64_tr_b16 a[88:89], v13 offset:768
v_mfma_f32_16x16x32_bf16 v[96:99], a[100:103], a[52:55], v[96:99]
ds_read_b64_tr_b16 a[90:91], v13 offset:1792
v_mfma_f32_16x16x32_bf16 v[96:99], a[96:99], a[36:39], v[96:99]
ds_read_b64_tr_b16 a[92:93], v13 offset:8960
v_mfma_f32_16x16x32_bf16 v[104:107], a[96:99], a[40:43], v[104:107]
ds_read_b64_tr_b16 a[94:95], v13 offset:9984
s_add_u32 m0, s16, 0x400
v_mfma_f32_16x16x32_bf16 v[104:107], a[100:103], a[56:59], v[104:107]
buffer_load_dwordx4 v23, s[44:47], s20 offen lds
v_mfma_f32_16x16x32_bf16 v[112:115], a[100:103], a[60:63], v[112:115]
v_mfma_f32_16x16x32_bf16 v[112:115], a[96:99], a[44:47], v[112:115]
v_mfma_f32_16x16x32_bf16 v[116:119], a[104:107], a[44:47], v[116:119]
ds_read_b64_tr_b16 a[96:97], v14 offset:0
v_mfma_f32_16x16x32_bf16 v[116:119], a[108:111], a[60:63], v[116:119]
ds_read_b64_tr_b16 a[98:99], v14 offset:256
v_mfma_f32_16x16x32_bf16 v[108:111], a[108:111], a[56:59], v[108:111]
ds_read_b64_tr_b16 a[100:101], v14 offset:2048
s_add_u32 m0, s16, 0x800
v_mfma_f32_16x16x32_bf16 v[108:111], a[104:107], a[40:43], v[108:111]
buffer_load_dwordx4 v22, s[44:47], s21 offen lds
v_mfma_f32_16x16x32_bf16 v[100:103], a[104:107], a[36:39], v[100:103]
ds_read_b64_tr_b16 a[102:103], v14 offset:2304
v_mfma_f32_16x16x32_bf16 v[100:103], a[108:111], a[52:55], v[100:103]
v_mfma_f32_16x16x32_bf16 v[92:95], a[108:111], a[48:51], v[92:95]
v_mfma_f32_16x16x32_bf16 v[92:95], a[104:107], a[32:35], v[92:95]
s_add_u32 s8, s28, 0x6800
s_waitcnt lgkmcnt(4)
v_mfma_f32_16x16x32_bf16 v[120:123], a[80:83], a[32:35], v[120:123]
buffer_store_dwordx4 a[168:171], v16, s[88:91], s8 offen sc1
v_mfma_f32_16x16x32_bf16 v[120:123], a[84:87], a[48:51], v[120:123]
ds_read_b64_tr_b16 a[104:105], v15 offset:0
v_mfma_f32_16x16x32_bf16 v[128:131], a[84:87], a[52:55], v[128:131]
ds_read_b64_tr_b16 a[106:107], v15 offset:256
v_mfma_f32_16x16x32_bf16 v[128:131], a[80:83], a[36:39], v[128:131]
ds_read_b64_tr_b16 a[108:109], v15 offset:2048
v_mfma_f32_16x16x32_bf16 v[136:139], a[80:83], a[40:43], v[136:139]
ds_read_b64_tr_b16 a[110:111], v15 offset:2304
v_mfma_f32_16x16x32_bf16 v[136:139], a[84:87], a[56:59], v[136:139]
s_add_u32 m0, s16, 0xc00
v_mfma_f32_16x16x32_bf16 v[144:147], a[84:87], a[60:63], v[144:147]
buffer_load_dwordx4 v23, s[44:47], s21 offen lds
v_mfma_f32_16x16x32_bf16 v[144:147], a[80:83], a[44:47], v[144:147]
v_mfma_f32_16x16x32_bf16 v[148:151], a[88:91], a[44:47], v[148:151]
ds_read_b64_tr_b16 a[80:81], v14 offset:4096
v_mfma_f32_16x16x32_bf16 v[148:151], a[92:95], a[60:63], v[148:151]
ds_read_b64_tr_b16 a[82:83], v14 offset:4352
v_mfma_f32_16x16x32_bf16 v[140:143], a[92:95], a[56:59], v[140:143]
ds_read_b64_tr_b16 a[84:85], v14 offset:6144
v_mfma_f32_16x16x32_bf16 v[140:143], a[88:91], a[40:43], v[140:143]
ds_read_b64_tr_b16 a[86:87], v14 offset:6400
s_add_u32 m0, s16, 0x1000
v_mfma_f32_16x16x32_bf16 v[132:135], a[88:91], a[36:39], v[132:135]
buffer_load_dwordx4 v22, s[44:47], s22 offen lds
v_mfma_f32_16x16x32_bf16 v[132:135], a[92:95], a[52:55], v[132:135]
v_mfma_f32_16x16x32_bf16 v[124:127], a[92:95], a[48:51], v[124:127]
v_mfma_f32_16x16x32_bf16 v[124:127], a[88:91], a[32:35], v[124:127]
s_waitcnt lgkmcnt(4)
v_mfma_f32_16x16x32_bf16 v[152:155], a[96:99], a[32:35], v[152:155]
ds_read_b64_tr_b16 a[88:89], v15 offset:4096
s_add_u32 m0, s16, 0x1400
v_mfma_f32_16x16x32_bf16 v[152:155], a[100:103], a[48:51], v[152:155]
buffer_load_dwordx4 v23, s[44:47], s22 offen lds
v_mfma_f32_16x16x32_bf16 v[160:163], a[100:103], a[52:55], v[160:163]
ds_read_b64_tr_b16 a[90:91], v15 offset:4352
v_mfma_f32_16x16x32_bf16 v[160:163], a[96:99], a[36:39], v[160:163]
ds_read_b64_tr_b16 a[92:93], v15 offset:6144
v_mfma_f32_16x16x32_bf16 v[168:171], a[96:99], a[40:43], v[168:171]
ds_read_b64_tr_b16 a[94:95], v15 offset:6400
v_mfma_f32_16x16x32_bf16 v[168:171], a[100:103], a[56:59], v[168:171]
v_mfma_f32_16x16x32_bf16 v[176:179], a[100:103], a[60:63], v[176:179]
s_add_u32 m0, s16, 0x1800
v_mfma_f32_16x16x32_bf16 v[176:179], a[96:99], a[44:47], v[176:179]
buffer_load_dwordx4 v22, s[44:47], s23 offen lds
v_mfma_f32_16x16x32_bf16 v[180:183], a[104:107], a[44:47], v[180:183]
ds_read_b64_tr_b16 a[96:97], v14 offset:8192
v_mfma_f32_16x16x32_bf16 v[180:183], a[108:111], a[60:63], v[180:183]
ds_read_b64_tr_b16 a[98:99], v14 offset:8448
v_mfma_f32_16x16x32_bf16 v[172:175], a[108:111], a[56:59], v[172:175]
ds_read_b64_tr_b16 a[100:101], v14 offset:10240
v_mfma_f32_16x16x32_bf16 v[172:175], a[104:107], a[40:43], v[172:175]
ds_read_b64_tr_b16 a[102:103], v14 offset:10496
s_add_u32 m0, s16, 0x1c00
v_mfma_f32_16x16x32_bf16 v[164:167], a[104:107], a[36:39], v[164:167]
buffer_load_dwordx4 v23, s[44:47], s23 offen lds
v_mfma_f32_16x16x32_bf16 v[164:167], a[108:111], a[52:55], v[164:167]
v_lshl_add_u32 v22, s42, 7, v22
v_lshl_add_u32 v23, s42, 7, v23
v_mfma_f32_16x16x32_bf16 v[156:159], a[108:111], a[48:51], v[156:159]
v_mfma_f32_16x16x32_bf16 v[156:159], a[104:107], a[32:35], v[156:159]
s_waitcnt lgkmcnt(4)
v_mfma_f32_16x16x32_bf16 v[184:187], a[80:83], a[32:35], v[184:187]
ds_read_b64_tr_b16 a[104:105], v15 offset:8192
v_mfma_f32_16x16x32_bf16 v[184:187], a[84:87], a[48:51], v[184:187]
ds_read_b64_tr_b16 a[106:107], v15 offset:8448
s_add_u32 s8, s28, 0x7800
v_mfma_f32_16x16x32_bf16 v[192:195], a[84:87], a[52:55], v[192:195]
buffer_store_dwordx4 a[172:175], v16, s[88:91], s8 offen sc1
v_mfma_f32_16x16x32_bf16 v[192:195], a[80:83], a[36:39], v[192:195]
ds_read_b64_tr_b16 a[108:109], v15 offset:10240
v_mfma_f32_16x16x32_bf16 v[200:203], a[80:83], a[40:43], v[200:203]
ds_read_b64_tr_b16 a[110:111], v15 offset:10496
v_add_u32 v12, 0xffff0000, v12
v_mfma_f32_16x16x32_bf16 v[200:203], a[84:87], a[56:59], v[200:203]
v_add_u32 v13, 0xffff0000, v13
v_add_u32 v14, 0xffff0000, v14
v_mfma_f32_16x16x32_bf16 v[208:211], a[84:87], a[60:63], v[208:211]
v_add_u32 v15, 0xffff0000, v15
v_mfma_f32_16x16x32_bf16 v[208:211], a[80:83], a[44:47], v[208:211]
v_mfma_f32_16x16x32_bf16 v[212:215], a[88:91], a[44:47], v[212:215]
s_waitcnt vmcnt(28) lgkmcnt(0)
v_mfma_f32_16x16x32_bf16 v[212:215], a[92:95], a[60:63], v[212:215]
s_barrier
s_add_u32 m0, s17, 0x10000
v_mfma_f32_16x16x32_bf16 v[204:207], a[92:95], a[56:59], v[204:207]
buffer_load_dwordx4 v5, s[52:55], 0 offen lds
v_mfma_f32_16x16x32_bf16 v[204:207], a[88:91], a[40:43], v[204:207]
ds_read_b64_tr_b16 a[80:81], v12 offset:0
v_mfma_f32_16x16x32_bf16 v[196:199], a[88:91], a[36:39], v[196:199]
ds_read_b64_tr_b16 a[82:83], v12 offset:1024
v_mfma_f32_16x16x32_bf16 v[196:199], a[92:95], a[52:55], v[196:199]
ds_read_b64_tr_b16 a[84:85], v12 offset:8192
v_mfma_f32_16x16x32_bf16 v[188:191], a[92:95], a[48:51], v[188:191]
ds_read_b64_tr_b16 a[86:87], v12 offset:9216
v_mfma_f32_16x16x32_bf16 v[188:191], a[88:91], a[32:35], v[188:191]
s_add_u32 m0, s17, 0x10400
s_waitcnt lgkmcnt(4)
v_mfma_f32_16x16x32_bf16 v[216:219], a[32:35], a[96:99], v[216:219]
buffer_load_dwordx4 v5, s[52:55], s13 offen lds
v_mfma_f32_16x16x32_bf16 v[216:219], a[48:51], a[100:103], v[216:219]
ds_read_b64_tr_b16 a[88:89], v13 offset:0
v_mfma_f32_16x16x32_bf16 v[224:227], a[52:55], a[100:103], v[224:227]
ds_read_b64_tr_b16 a[90:91], v13 offset:1024
v_mfma_f32_16x16x32_bf16 v[224:227], a[36:39], a[96:99], v[224:227]
ds_read_b64_tr_b16 a[92:93], v13 offset:8192
v_mfma_f32_16x16x32_bf16 v[232:235], a[40:43], a[96:99], v[232:235]
ds_read_b64_tr_b16 a[94:95], v13 offset:9216
v_mfma_f32_16x16x32_bf16 v[232:235], a[56:59], a[100:103], v[232:235]
s_add_u32 m0, s17, 0x10800
v_mfma_f32_16x16x32_bf16 v[240:243], a[60:63], a[100:103], v[240:243]
buffer_load_dwordx4 v6, s[52:55], 0 offen lds
v_mfma_f32_16x16x32_bf16 v[240:243], a[44:47], a[96:99], v[240:243]
v_mfma_f32_16x16x32_bf16 v[244:247], a[44:47], a[104:107], v[244:247]
ds_read_b64_tr_b16 a[96:97], v12 offset:256
v_mfma_f32_16x16x32_bf16 v[244:247], a[60:63], a[108:111], v[244:247]
ds_read_b64_tr_b16 a[98:99], v12 offset:1280
v_mfma_f32_16x16x32_bf16 v[236:239], a[56:59], a[108:111], v[236:239]
ds_read_b64_tr_b16 a[100:101], v12 offset:8448
v_mfma_f32_16x16x32_bf16 v[236:239], a[40:43], a[104:107], v[236:239]
ds_read_b64_tr_b16 a[102:103], v12 offset:9472
s_add_u32 s8, s28, 0x2c00
v_mfma_f32_16x16x32_bf16 v[228:231], a[36:39], a[104:107], v[228:231]
buffer_store_dwordx4 a[176:179], v16, s[88:91], s8 offen sc1
v_mfma_f32_16x16x32_bf16 v[228:231], a[52:55], a[108:111], v[228:231]
v_mfma_f32_16x16x32_bf16 v[220:223], a[48:51], a[108:111], v[220:223]
v_mfma_f32_16x16x32_bf16 v[220:223], a[32:35], a[104:107], v[220:223]
s_waitcnt lgkmcnt(4)
L_S12:
v_mfma_f32_16x16x32_bf16 v[24:27], a[80:83], a[0:3], v[24:27]
ds_read_b64_tr_b16 a[104:105], v13 offset:256
s_waitcnt vmcnt(23)
v_mfma_f32_16x16x32_bf16 v[24:27], a[84:87], a[16:19], v[24:27]
ds_read_b64_tr_b16 a[106:107], v13 offset:1280
s_add_u32 m0, s17, 0x10c00
v_mfma_f32_16x16x32_bf16 v[32:35], a[84:87], a[20:23], v[32:35]
buffer_load_dwordx4 v6, s[52:55], s13 offen lds
v_mfma_f32_16x16x32_bf16 v[32:35], a[80:83], a[4:7], v[32:35]
ds_read_b64_tr_b16 a[108:109], v13 offset:8448
v_mfma_f32_16x16x32_bf16 v[40:43], a[80:83], a[8:11], v[40:43]
ds_read_b64_tr_b16 a[110:111], v13 offset:9472
v_mfma_f32_16x16x32_bf16 v[40:43], a[84:87], a[24:27], v[40:43]
ds_read_b128 a[32:35], v8 offset:32768
v_mfma_f32_16x16x32_bf16 v[48:51], a[84:87], a[28:31], v[48:51]
ds_read_b128 a[48:51], v9 offset:32768
v_mfma_f32_16x16x32_bf16 v[48:51], a[80:83], a[12:15], v[48:51]
ds_read_b128 a[36:39], v8 offset:34816
s_add_u32 m0, s18, 0x14000
v_mfma_f32_16x16x32_bf16 v[52:55], a[88:91], a[12:15], v[52:55]
buffer_load_dwordx4 v7, s[68:71], 0 offen lds
v_mfma_f32_16x16x32_bf16 v[52:55], a[92:95], a[28:31], v[52:55]
ds_read_b64_tr_b16 a[80:81], v12 offset:512
v_mfma_f32_16x16x32_bf16 v[44:47], a[92:95], a[24:27], v[44:47]
ds_read_b64_tr_b16 a[82:83], v12 offset:1536
v_mfma_f32_16x16x32_bf16 v[44:47], a[88:91], a[8:11], v[44:47]
ds_read_b64_tr_b16 a[84:85], v12 offset:8704
v_mfma_f32_16x16x32_bf16 v[36:39], a[88:91], a[4:7], v[36:39]
ds_read_b64_tr_b16 a[86:87], v12 offset:9728
v_mfma_f32_16x16x32_bf16 v[36:39], a[92:95], a[20:23], v[36:39]
ds_read_b128 a[52:55], v9 offset:34816
s_add_u32 m0, s18, 0x15000
v_mfma_f32_16x16x32_bf16 v[28:31], a[92:95], a[16:19], v[28:31]
buffer_load_dwordx4 v7, s[68:71], s25 offen lds
v_mfma_f32_16x16x32_bf16 v[28:31], a[88:91], a[0:3], v[28:31]
ds_read_b128 a[40:43], v8 offset:36864
s_waitcnt lgkmcnt(9)
v_mfma_f32_16x16x32_bf16 v[56:59], a[96:99], a[0:3], v[56:59]
ds_read_b64_tr_b16 a[88:89], v13 offset:512
v_mfma_f32_16x16x32_bf16 v[56:59], a[100:103], a[16:19], v[56:59]
ds_read_b64_tr_b16 a[90:91], v13 offset:1536
v_mfma_f32_16x16x32_bf16 v[64:67], a[100:103], a[20:23], v[64:67]
ds_read_b64_tr_b16 a[92:93], v13 offset:8704
v_mfma_f32_16x16x32_bf16 v[64:67], a[96:99], a[4:7], v[64:67]
ds_read_b64_tr_b16 a[94:95], v13 offset:9728
s_add_u32 m0, s18, 0x16000
v_mfma_f32_16x16x32_bf16 v[72:75], a[96:99], a[8:11], v[72:75]
buffer_load_dwordx4 v7, s[68:71], s26 offen lds
v_mfma_f32_16x16x32_bf16 v[72:75], a[100:103], a[24:27], v[72:75]
ds_read_b128 a[56:59], v9 offset:36864
v_lshl_add_u32 v5, s42, 19, v5
v_mfma_f32_16x16x32_bf16 v[80:83], a[100:103], a[28:31], v[80:83]
ds_read_b128 a[44:47], v8 offset:38912
v_lshl_add_u32 v6, s42, 19, v6
v_mfma_f32_16x16x32_bf16 v[80:83], a[96:99], a[12:15], v[80:83]
ds_read_b128 a[60:63], v9 offset:38912
v_lshl_add_u32 v7, s42, 18, v7
v_mfma_f32_16x16x32_bf16 v[84:87], a[104:107], a[12:15], v[84:87]
ds_read_b64_tr_b16 a[96:97], v12 offset:768
v_lshl_add_u32 v7, s42, 17, v7
v_mfma_f32_16x16x32_bf16 v[84:87], a[108:111], a[28:31], v[84:87]
ds_read_b64_tr_b16 a[98:99], v12 offset:1792
s_add_u32 s8, s28, 0x3c00
v_mfma_f32_16x16x32_bf16 v[76:79], a[108:111], a[24:27], v[76:79]
buffer_store_dwordx4 a[180:183], v16, s[88:91], s8 offen sc1
v_mfma_f32_16x16x32_bf16 v[76:79], a[104:107], a[8:11], v[76:79]
ds_read_b64_tr_b16 a[100:101], v12 offset:8960
v_mfma_f32_16x16x32_bf16 v[68:71], a[104:107], a[4:7], v[68:71]
ds_read_b64_tr_b16 a[102:103], v12 offset:9984
v_mfma_f32_16x16x32_bf16 v[68:71], a[108:111], a[20:23], v[68:71]
v_mfma_f32_16x16x32_bf16 v[60:63], a[108:111], a[16:19], v[60:63]
v_mfma_f32_16x16x32_bf16 v[60:63], a[104:107], a[0:3], v[60:63]
s_add_u32 m0, s16, 0x8000
s_waitcnt lgkmcnt(4)
s_waitcnt lgkmcnt(7)
v_mfma_f32_16x16x32_bf16 v[88:91], a[80:83], a[0:3], v[88:91]
buffer_load_dwordx4 v22, s[44:47], s20 offen lds
v_mfma_f32_16x16x32_bf16 v[88:91], a[84:87], a[16:19], v[88:91]
ds_read_b64_tr_b16 a[104:105], v13 offset:768
v_mfma_f32_16x16x32_bf16 v[96:99], a[84:87], a[20:23], v[96:99]
ds_read_b64_tr_b16 a[106:107], v13 offset:1792
v_mfma_f32_16x16x32_bf16 v[96:99], a[80:83], a[4:7], v[96:99]
ds_read_b64_tr_b16 a[108:109], v13 offset:8960
v_mfma_f32_16x16x32_bf16 v[104:107], a[80:83], a[8:11], v[104:107]
ds_read_b64_tr_b16 a[110:111], v13 offset:9984
s_add_u32 m0, s16, 0x8400
v_mfma_f32_16x16x32_bf16 v[104:107], a[84:87], a[24:27], v[104:107]
buffer_load_dwordx4 v23, s[44:47], s20 offen lds
v_mfma_f32_16x16x32_bf16 v[112:115], a[84:87], a[28:31], v[112:115]
v_mfma_f32_16x16x32_bf16 v[112:115], a[80:83], a[12:15], v[112:115]
v_mfma_f32_16x16x32_bf16 v[116:119], a[88:91], a[12:15], v[116:119]
ds_read_b64_tr_b16 a[80:81], v14 offset:0
v_mfma_f32_16x16x32_bf16 v[116:119], a[92:95], a[28:31], v[116:119]
ds_read_b64_tr_b16 a[82:83], v14 offset:256
v_mfma_f32_16x16x32_bf16 v[108:111], a[92:95], a[24:27], v[108:111]
ds_read_b64_tr_b16 a[84:85], v14 offset:2048
s_add_u32 m0, s16, 0x8800
v_mfma_f32_16x16x32_bf16 v[108:111], a[88:91], a[8:11], v[108:111]
buffer_load_dwordx4 v22, s[44:47], s21 offen lds
v_mfma_f32_16x16x32_bf16 v[100:103], a[88:91], a[4:7], v[100:103]
ds_read_b64_tr_b16 a[86:87], v14 offset:2304
v_mfma_f32_16x16x32_bf16 v[100:103], a[92:95], a[20:23], v[100:103]
v_mfma_f32_16x16x32_bf16 v[92:95], a[92:95], a[16:19], v[92:95]
v_mfma_f32_16x16x32_bf16 v[92:95], a[88:91], a[0:3], v[92:95]
s_add_u32 m0, s16, 0x8c00
s_waitcnt lgkmcnt(4)
v_mfma_f32_16x16x32_bf16 v[120:123], a[96:99], a[0:3], v[120:123]
buffer_load_dwordx4 v23, s[44:47], s21 offen lds
v_mfma_f32_16x16x32_bf16 v[120:123], a[100:103], a[16:19], v[120:123]
ds_read_b64_tr_b16 a[88:89], v15 offset:0
v_mfma_f32_16x16x32_bf16 v[128:131], a[100:103], a[20:23], v[128:131]
ds_read_b64_tr_b16 a[90:91], v15 offset:256
v_mfma_f32_16x16x32_bf16 v[128:131], a[96:99], a[4:7], v[128:131]
ds_read_b64_tr_b16 a[92:93], v15 offset:2048
v_mfma_f32_16x16x32_bf16 v[136:139], a[96:99], a[8:11], v[136:139]
ds_read_b64_tr_b16 a[94:95], v15 offset:2304
v_mfma_f32_16x16x32_bf16 v[136:139], a[100:103], a[24:27], v[136:139]
s_add_u32 s8, s28, 0x6c00
v_mfma_f32_16x16x32_bf16 v[144:147], a[100:103], a[28:31], v[144:147]
buffer_store_dwordx4 a[184:187], v16, s[88:91], s8 offen sc1
v_mfma_f32_16x16x32_bf16 v[144:147], a[96:99], a[12:15], v[144:147]
v_mfma_f32_16x16x32_bf16 v[148:151], a[104:107], a[12:15], v[148:151]
ds_read_b64_tr_b16 a[96:97], v14 offset:4096
v_mfma_f32_16x16x32_bf16 v[148:151], a[108:111], a[28:31], v[148:151]
ds_read_b64_tr_b16 a[98:99], v14 offset:4352
v_mfma_f32_16x16x32_bf16 v[140:143], a[108:111], a[24:27], v[140:143]
ds_read_b64_tr_b16 a[100:101], v14 offset:6144
v_mfma_f32_16x16x32_bf16 v[140:143], a[104:107], a[8:11], v[140:143]
ds_read_b64_tr_b16 a[102:103], v14 offset:6400
s_add_u32 m0, s16, 0x9000
v_mfma_f32_16x16x32_bf16 v[132:135], a[104:107], a[4:7], v[132:135]
buffer_load_dwordx4 v22, s[44:47], s22 offen lds
v_mfma_f32_16x16x32_bf16 v[132:135], a[108:111], a[20:23], v[132:135]
v_mfma_f32_16x16x32_bf16 v[124:127], a[108:111], a[16:19], v[124:127]
v_mfma_f32_16x16x32_bf16 v[124:127], a[104:107], a[0:3], v[124:127]
s_waitcnt lgkmcnt(4)
v_mfma_f32_16x16x32_bf16 v[152:155], a[80:83], a[0:3], v[152:155]
ds_read_b64_tr_b16 a[104:105], v15 offset:4096
s_add_u32 m0, s16, 0x9400
v_mfma_f32_16x16x32_bf16 v[152:155], a[84:87], a[16:19], v[152:155]
buffer_load_dwordx4 v23, s[44:47], s22 offen lds
v_mfma_f32_16x16x32_bf16 v[160:163], a[84:87], a[20:23], v[160:163]
ds_read_b64_tr_b16 a[106:107], v15 offset:4352
v_mfma_f32_16x16x32_bf16 v[160:163], a[80:83], a[4:7], v[160:163]
ds_read_b64_tr_b16 a[108:109], v15 offset:6144
v_mfma_f32_16x16x32_bf16 v[168:171], a[80:83], a[8:11], v[168:171]
ds_read_b64_tr_b16 a[110:111], v15 offset:6400
v_mfma_f32_16x16x32_bf16 v[168:171], a[84:87], a[24:27], v[168:171]
v_mfma_f32_16x16x32_bf16 v[176:179], a[84:87], a[28:31], v[176:179]
s_add_u32 m0, s16, 0x9800
v_mfma_f32_16x16x32_bf16 v[176:179], a[80:83], a[12:15], v[176:179]
buffer_load_dwordx4 v22, s[44:47], s23 offen lds
v_mfma_f32_16x16x32_bf16 v[180:183], a[88:91], a[12:15], v[180:183]
ds_read_b64_tr_b16 a[80:81], v14 offset:8192
v_mfma_f32_16x16x32_bf16 v[180:183], a[92:95], a[28:31], v[180:183]
ds_read_b64_tr_b16 a[82:83], v14 offset:8448
v_mfma_f32_16x16x32_bf16 v[172:175], a[92:95], a[24:27], v[172:175]
ds_read_b64_tr_b16 a[84:85], v14 offset:10240
v_mfma_f32_16x16x32_bf16 v[172:175], a[88:91], a[8:11], v[172:175]
ds_read_b64_tr_b16 a[86:87], v14 offset:10496
s_add_u32 m0, s16, 0x9c00
v_mfma_f32_16x16x32_bf16 v[164:167], a[88:91], a[4:7], v[164:167]
buffer_load_dwordx4 v23, s[44:47], s23 offen lds
v_mfma_f32_16x16x32_bf16 v[164:167], a[92:95], a[20:23], v[164:167]
v_lshl_add_u32 v22, s42, 7, v22
v_lshl_add_u32 v23, s42, 7, v23
v_mfma_f32_16x16x32_bf16 v[156:159], a[92:95], a[16:19], v[156:159]
v_mfma_f32_16x16x32_bf16 v[156:159], a[88:91], a[0:3], v[156:159]
s_waitcnt lgkmcnt(4)
v_mfma_f32_16x16x32_bf16 v[184:187], a[96:99], a[0:3], v[184:187]
ds_read_b64_tr_b16 a[88:89], v15 offset:8192
v_mfma_f32_16x16x32_bf16 v[184:187], a[100:103], a[16:19], v[184:187]
ds_read_b64_tr_b16 a[90:91], v15 offset:8448
s_add_u32 s8, s28, 0x7c00
v_mfma_f32_16x16x32_bf16 v[192:195], a[100:103], a[20:23], v[192:195]
buffer_store_dwordx4 a[188:191], v16, s[88:91], s8 offen sc1
v_mfma_f32_16x16x32_bf16 v[192:195], a[96:99], a[4:7], v[192:195]
ds_read_b64_tr_b16 a[92:93], v15 offset:10240
v_mfma_f32_16x16x32_bf16 v[200:203], a[96:99], a[8:11], v[200:203]
ds_read_b64_tr_b16 a[94:95], v15 offset:10496
v_add_u32 v12, 0x8000, v12
v_mfma_f32_16x16x32_bf16 v[200:203], a[100:103], a[24:27], v[200:203]
v_add_u32 v13, 0x8000, v13
v_add_u32 v14, 0x8000, v14
v_mfma_f32_16x16x32_bf16 v[208:211], a[100:103], a[28:31], v[208:211]
v_add_u32 v15, 0x8000, v15
v_mfma_f32_16x16x32_bf16 v[208:211], a[96:99], a[12:15], v[208:211]
v_mfma_f32_16x16x32_bf16 v[212:215], a[104:107], a[12:15], v[212:215]
s_waitcnt vmcnt(29) lgkmcnt(0)
v_mfma_f32_16x16x32_bf16 v[212:215], a[108:111], a[28:31], v[212:215]
s_barrier
s_add_u32 m0, s17, 0x0
v_mfma_f32_16x16x32_bf16 v[204:207], a[108:111], a[24:27], v[204:207]
buffer_load_dwordx4 v5, s[52:55], 0 offen lds
v_mfma_f32_16x16x32_bf16 v[204:207], a[104:107], a[8:11], v[204:207]
ds_read_b64_tr_b16 a[96:97], v12 offset:0
v_mfma_f32_16x16x32_bf16 v[196:199], a[104:107], a[4:7], v[196:199]
ds_read_b64_tr_b16 a[98:99], v12 offset:1024
v_mfma_f32_16x16x32_bf16 v[196:199], a[108:111], a[20:23], v[196:199]
ds_read_b64_tr_b16 a[100:101], v12 offset:8192
v_mfma_f32_16x16x32_bf16 v[188:191], a[108:111], a[16:19], v[188:191]
ds_read_b64_tr_b16 a[102:103], v12 offset:9216
v_mfma_f32_16x16x32_bf16 v[188:191], a[104:107], a[0:3], v[188:191]
s_add_u32 m0, s17, 0x400
s_waitcnt lgkmcnt(4)
v_mfma_f32_16x16x32_bf16 v[216:219], a[0:3], a[80:83], v[216:219]
buffer_load_dwordx4 v5, s[52:55], s13 offen lds
v_mfma_f32_16x16x32_bf16 v[216:219], a[16:19], a[84:87], v[216:219]
ds_read_b64_tr_b16 a[104:105], v13 offset:0
v_mfma_f32_16x16x32_bf16 v[224:227], a[20:23], a[84:87], v[224:227]
ds_read_b64_tr_b16 a[106:107], v13 offset:1024
v_mfma_f32_16x16x32_bf16 v[224:227], a[4:7], a[80:83], v[224:227]
ds_read_b64_tr_b16 a[108:109], v13 offset:8192
v_mfma_f32_16x16x32_bf16 v[232:235], a[8:11], a[80:83], v[232:235]
ds_read_b64_tr_b16 a[110:111], v13 offset:9216
v_mfma_f32_16x16x32_bf16 v[232:235], a[24:27], a[84:87], v[232:235]
v_mfma_f32_16x16x32_bf16 v[240:243], a[28:31], a[84:87], v[240:243]
s_add_u32 m0, s17, 0x800
v_mfma_f32_16x16x32_bf16 v[240:243], a[12:15], a[80:83], v[240:243]
buffer_load_dwordx4 v6, s[52:55], 0 offen lds
v_mfma_f32_16x16x32_bf16 v[244:247], a[12:15], a[88:91], v[244:247]
ds_read_b64_tr_b16 a[80:81], v12 offset:256
v_mfma_f32_16x16x32_bf16 v[244:247], a[28:31], a[92:95], v[244:247]
ds_read_b64_tr_b16 a[82:83], v12 offset:1280
v_mfma_f32_16x16x32_bf16 v[236:239], a[24:27], a[92:95], v[236:239]
ds_read_b64_tr_b16 a[84:85], v12 offset:8448
v_mfma_f32_16x16x32_bf16 v[236:239], a[8:11], a[88:91], v[236:239]
ds_read_b64_tr_b16 a[86:87], v12 offset:9472
v_mfma_f32_16x16x32_bf16 v[228:231], a[4:7], a[88:91], v[228:231]
v_mfma_f32_16x16x32_bf16 v[228:231], a[20:23], a[92:95], v[228:231]
s_add_u32 m0, s17, 0xc00
v_mfma_f32_16x16x32_bf16 v[220:223], a[16:19], a[92:95], v[220:223]
buffer_load_dwordx4 v6, s[52:55], s13 offen lds
v_mfma_f32_16x16x32_bf16 v[220:223], a[0:3], a[88:91], v[220:223]
s_waitcnt lgkmcnt(4)
L_S13:
v_mfma_f32_16x16x32_bf16 v[24:27], a[96:99], a[32:35], v[24:27]
ds_read_b64_tr_b16 a[88:89], v13 offset:256
s_waitcnt vmcnt(24)
v_mfma_f32_16x16x32_bf16 v[24:27], a[100:103], a[48:51], v[24:27]
ds_read_b64_tr_b16 a[90:91], v13 offset:1280
v_mfma_f32_16x16x32_bf16 v[32:35], a[100:103], a[52:55], v[32:35]
ds_read_b64_tr_b16 a[92:93], v13 offset:8448
v_mfma_f32_16x16x32_bf16 v[32:35], a[96:99], a[36:39], v[32:35]
ds_read_b64_tr_b16 a[94:95], v13 offset:9472
v_mfma_f32_16x16x32_bf16 v[40:43], a[96:99], a[40:43], v[40:43]
ds_read_b128 a[0:3], v8 offset:0
s_add_u32 m0, s18, 0x4000
v_mfma_f32_16x16x32_bf16 v[40:43], a[100:103], a[56:59], v[40:43]
buffer_load_dwordx4 v7, s[68:71], 0 offen lds
v_mfma_f32_16x16x32_bf16 v[48:51], a[100:103], a[60:63], v[48:51]
ds_read_b128 a[16:19], v9 offset:0
v_mfma_f32_16x16x32_bf16 v[48:51], a[96:99], a[44:47], v[48:51]
ds_read_b128 a[4:7], v8 offset:2048
v_mfma_f32_16x16x32_bf16 v[52:55], a[104:107], a[44:47], v[52:55]
ds_read_b64_tr_b16 a[96:97], v12 offset:512
v_mfma_f32_16x16x32_bf16 v[52:55], a[108:111], a[60:63], v[52:55]
ds_read_b64_tr_b16 a[98:99], v12 offset:1536
v_mfma_f32_16x16x32_bf16 v[44:47], a[108:111], a[56:59], v[44:47]
ds_read_b64_tr_b16 a[100:101], v12 offset:8704
s_add_u32 s8, s28, 0x4000
v_mfma_f32_16x16x32_bf16 v[44:47], a[104:107], a[40:43], v[44:47]
buffer_store_dwordx4 a[192:195], v16, s[88:91], s8 offen sc1
v_mfma_f32_16x16x32_bf16 v[36:39], a[104:107], a[36:39], v[36:39]
ds_read_b64_tr_b16 a[102:103], v12 offset:9728
v_mfma_f32_16x16x32_bf16 v[36:39], a[108:111], a[52:55], v[36:39]
ds_read_b128 a[20:23], v9 offset:2048
v_mfma_f32_16x16x32_bf16 v[28:31], a[108:111], a[48:51], v[28:31]
ds_read_b128 a[8:11], v8 offset:4096
v_mfma_f32_16x16x32_bf16 v[28:31], a[104:107], a[32:35], v[28:31]
ds_read_b128 a[24:27], v9 offset:4096
s_waitcnt lgkmcnt(10)
v_mfma_f32_16x16x32_bf16 v[56:59], a[80:83], a[32:35], v[56:59]
ds_read_b64_tr_b16 a[104:105], v13 offset:512
v_mfma_f32_16x16x32_bf16 v[56:59], a[84:87], a[48:51], v[56:59]
ds_read_b64_tr_b16 a[106:107], v13 offset:1536
s_add_u32 m0, s18, 0x5000
v_mfma_f32_16x16x32_bf16 v[64:67], a[84:87], a[52:55], v[64:67]
buffer_load_dwordx4 v7, s[68:71], s25 offen lds
v_mfma_f32_16x16x32_bf16 v[64:67], a[80:83], a[36:39], v[64:67]
ds_read_b64_tr_b16 a[108:109], v13 offset:8704
v_mfma_f32_16x16x32_bf16 v[72:75], a[80:83], a[40:43], v[72:75]
ds_read_b64_tr_b16 a[110:111], v13 offset:9728
v_mfma_f32_16x16x32_bf16 v[72:75], a[84:87], a[56:59], v[72:75]
ds_read_b128 a[12:15], v8 offset:6144
v_mfma_f32_16x16x32_bf16 v[80:83], a[84:87], a[60:63], v[80:83]
ds_read_b128 a[28:31], v9 offset:6144
v_mfma_f32_16x16x32_bf16 v[80:83], a[80:83], a[44:47], v[80:83]
v_mfma_f32_16x16x32_bf16 v[84:87], a[88:91], a[44:47], v[84:87]
ds_read_b64_tr_b16 a[80:81], v12 offset:768
s_add_u32 m0, s18, 0x6000
v_mfma_f32_16x16x32_bf16 v[84:87], a[92:95], a[60:63], v[84:87]
buffer_load_dwordx4 v7, s[68:71], s26 offen lds
v_mfma_f32_16x16x32_bf16 v[76:79], a[92:95], a[56:59], v[76:79]
ds_read_b64_tr_b16 a[82:83], v12 offset:1792
v_lshl_add_u32 v5, s42, 19, v5
v_mfma_f32_16x16x32_bf16 v[76:79], a[88:91], a[40:43], v[76:79]
ds_read_b64_tr_b16 a[84:85], v12 offset:8960
v_lshl_add_u32 v6, s42, 19, v6
v_mfma_f32_16x16x32_bf16 v[68:71], a[88:91], a[36:39], v[68:71]
ds_read_b64_tr_b16 a[86:87], v12 offset:9984
v_lshl_add_u32 v7, s42, 18, v7
v_mfma_f32_16x16x32_bf16 v[68:71], a[92:95], a[52:55], v[68:71]
v_lshl_add_u32 v7, s42, 17, v7
v_mfma_f32_16x16x32_bf16 v[60:63], a[92:95], a[48:51], v[60:63]
v_mfma_f32_16x16x32_bf16 v[60:63], a[88:91], a[32:35], v[60:63]
s_add_u32 m0, s16, 0x0
s_waitcnt lgkmcnt(4)
s_waitcnt lgkmcnt(6)
v_mfma_f32_16x16x32_bf16 v[88:91], a[96:99], a[32:35], v[88:91]
buffer_load_dwordx4 v22, s[44:47], s20 offen lds
v_mfma_f32_16x16x32_bf16 v[88:91], a[100:103], a[48:51], v[88:91]
ds_read_b64_tr_b16 a[88:89], v13 offset:768
v_mfma_f32_16x16x32_bf16 v[96:99], a[100:103], a[52:55], v[96:99]
ds_read_b64_tr_b16 a[90:91], v13 offset:1792
v_mfma_f32_16x16x32_bf16 v[96:99], a[96:99], a[36:39], v[96:99]
ds_read_b64_tr_b16 a[92:93], v13 offset:8960
v_mfma_f32_16x16x32_bf16 v[104:107], a[96:99], a[40:43], v[104:107]
ds_read_b64_tr_b16 a[94:95], v13 offset:9984
s_add_u32 m0, s16, 0x400
v_mfma_f32_16x16x32_bf16 v[104:107], a[100:103], a[56:59], v[104:107]
buffer_load_dwordx4 v23, s[44:47], s20 offen lds
v_mfma_f32_16x16x32_bf16 v[112:115], a[100:103], a[60:63], v[112:115]
v_mfma_f32_16x16x32_bf16 v[112:115], a[96:99], a[44:47], v[112:115]
v_mfma_f32_16x16x32_bf16 v[116:119], a[104:107], a[44:47], v[116:119]
ds_read_b64_tr_b16 a[96:97], v14 offset:0
v_mfma_f32_16x16x32_bf16 v[116:119], a[108:111], a[60:63], v[116:119]
ds_read_b64_tr_b16 a[98:99], v14 offset:256
v_mfma_f32_16x16x32_bf16 v[108:111], a[108:111], a[56:59], v[108:111]
ds_read_b64_tr_b16 a[100:101], v14 offset:2048
s_add_u32 m0, s16, 0x800
v_mfma_f32_16x16x32_bf16 v[108:111], a[104:107], a[40:43], v[108:111]
buffer_load_dwordx4 v22, s[44:47], s21 offen lds
v_mfma_f32_16x16x32_bf16 v[100:103], a[104:107], a[36:39], v[100:103]
ds_read_b64_tr_b16 a[102:103], v14 offset:2304
v_mfma_f32_16x16x32_bf16 v[100:103], a[108:111], a[52:55], v[100:103]
v_mfma_f32_16x16x32_bf16 v[92:95], a[108:111], a[48:51], v[92:95]
v_mfma_f32_16x16x32_bf16 v[92:95], a[104:107], a[32:35], v[92:95]
s_add_u32 s8, s28, 0x8000
s_waitcnt lgkmcnt(4)
v_mfma_f32_16x16x32_bf16 v[120:123], a[80:83], a[32:35], v[120:123]
buffer_store_dwordx4 a[196:199], v16, s[88:91], s8 offen sc1
v_mfma_f32_16x16x32_bf16 v[120:123], a[84:87], a[48:51], v[120:123]
ds_read_b64_tr_b16 a[104:105], v15 offset:0
v_mfma_f32_16x16x32_bf16 v[128:131], a[84:87], a[52:55], v[128:131]
ds_read_b64_tr_b16 a[106:107], v15 offset:256
v_mfma_f32_16x16x32_bf16 v[128:131], a[80:83], a[36:39], v[128:131]
ds_read_b64_tr_b16 a[108:109], v15 offset:2048
v_mfma_f32_16x16x32_bf16 v[136:139], a[80:83], a[40:43], v[136:139]
ds_read_b64_tr_b16 a[110:111], v15 offset:2304
v_mfma_f32_16x16x32_bf16 v[136:139], a[84:87], a[56:59], v[136:139]
s_add_u32 m0, s16, 0xc00
v_mfma_f32_16x16x32_bf16 v[144:147], a[84:87], a[60:63], v[144:147]
buffer_load_dwordx4 v23, s[44:47], s21 offen lds
v_mfma_f32_16x16x32_bf16 v[144:147], a[80:83], a[44:47], v[144:147]
v_mfma_f32_16x16x32_bf16 v[148:151], a[88:91], a[44:47], v[148:151]
ds_read_b64_tr_b16 a[80:81], v14 offset:4096
v_mfma_f32_16x16x32_bf16 v[148:151], a[92:95], a[60:63], v[148:151]
ds_read_b64_tr_b16 a[82:83], v14 offset:4352
L_padA7:
s_cmp_eq_u32 s95, 1
s_cbranch_scc1 L_padA11
v_mfma_f32_16x16x32_bf16 v[140:143], a[92:95], a[56:59], v[140:143]
ds_read_b64_tr_b16 a[84:85], v14 offset:6144
v_mfma_f32_16x16x32_bf16 v[140:143], a[88:91], a[40:43], v[140:143]
ds_read_b64_tr_b16 a[86:87], v14 offset:6400
s_add_u32 m0, s16, 0x1000
v_mfma_f32_16x16x32_bf16 v[132:135], a[88:91], a[36:39], v[132:135]
buffer_load_dwordx4 v22, s[44:47], s22 offen lds
v_mfma_f32_16x16x32_bf16 v[132:135], a[92:95], a[52:55], v[132:135]
v_mfma_f32_16x16x32_bf16 v[124:127], a[92:95], a[48:51], v[124:127]
v_mfma_f32_16x16x32_bf16 v[124:127], a[88:91], a[32:35], v[124:127]
s_waitcnt lgkmcnt(4)
v_mfma_f32_16x16x32_bf16 v[152:155], a[96:99], a[32:35], v[152:155]
ds_read_b64_tr_b16 a[88:89], v15 offset:4096
s_add_u32 m0, s16, 0x1400
v_mfma_f32_16x16x32_bf16 v[152:155], a[100:103], a[48:51], v[152:155]
buffer_load_dwordx4 v23, s[44:47], s22 offen lds
v_mfma_f32_16x16x32_bf16 v[160:163], a[100:103], a[52:55], v[160:163]
ds_read_b64_tr_b16 a[90:91], v15 offset:4352
v_mfma_f32_16x16x32_bf16 v[160:163], a[96:99], a[36:39], v[160:163]
ds_read_b64_tr_b16 a[92:93], v15 offset:6144
v_mfma_f32_16x16x32_bf16 v[168:171], a[96:99], a[40:43], v[168:171]
ds_read_b64_tr_b16 a[94:95], v15 offset:6400
v_mfma_f32_16x16x32_bf16 v[168:171], a[100:103], a[56:59], v[168:171]
v_mfma_f32_16x16x32_bf16 v[176:179], a[100:103], a[60:63], v[176:179]
s_add_u32 m0, s16, 0x1800
v_mfma_f32_16x16x32_bf16 v[176:179], a[96:99], a[44:47], v[176:179]
buffer_load_dwordx4 v22, s[44:47], s23 offen lds
v_mfma_f32_16x16x32_bf16 v[180:183], a[104:107], a[44:47], v[180:183]
ds_read_b64_tr_b16 a[96:97], v14 offset:8192
v_mfma_f32_16x16x32_bf16 v[180:183], a[108:111], a[60:63], v[180:183]
ds_read_b64_tr_b16 a[98:99], v14 offset:8448
v_mfma_f32_16x16x32_bf16 v[172:175], a[108:111], a[56:59], v[172:175]
ds_read_b64_tr_b16 a[100:101], v14 offset:10240
v_mfma_f32_16x16x32_bf16 v[172:175], a[104:107], a[40:43], v[172:175]
ds_read_b64_tr_b16 a[102:103], v14 offset:10496
s_add_u32 m0, s16, 0x1c00
v_mfma_f32_16x16x32_bf16 v[164:167], a[104:107], a[36:39], v[164:167]
buffer_load_dwordx4 v23, s[44:47], s23 offen lds
v_mfma_f32_16x16x32_bf16 v[164:167], a[108:111], a[52:55], v[164:167]
v_lshl_add_u32 v22, s42, 7, v22
v_lshl_add_u32 v23, s42, 7, v23
v_mfma_f32_16x16x32_bf16 v[156:159], a[108:111], a[48:51], v[156:159]
v_mfma_f32_16x16x32_bf16 v[156:159], a[104:107], a[32:35], v[156:159]
s_waitcnt lgkmcnt(4)
v_mfma_f32_16x16x32_bf16 v[184:187], a[80:83], a[32:35], v[184:187]
ds_read_b64_tr_b16 a[104:105], v15 offset:8192
v_mfma_f32_16x16x32_bf16 v[184:187], a[84:87], a[48:51], v[184:187]
ds_read_b64_tr_b16 a[106:107], v15 offset:8448
s_add_u32 s8, s28, 0x4400
v_mfma_f32_16x16x32_bf16 v[192:195], a[84:87], a[52:55], v[192:195]
buffer_store_dwordx4 a[200:203], v16, s[88:91], s8 offen sc1
v_mfma_f32_16x16x32_bf16 v[192:195], a[80:83], a[36:39], v[192:195]
ds_read_b64_tr_b16 a[108:109], v15 offset:10240
v_mfma_f32_16x16x32_bf16 v[200:203], a[80:83], a[40:43], v[200:203]
ds_read_b64_tr_b16 a[110:111], v15 offset:10496
v_add_u32 v12, 0x8000, v12
v_mfma_f32_16x16x32_bf16 v[200:203], a[84:87], a[56:59], v[200:203]
v_add_u32 v13, 0x8000, v13
v_add_u32 v14, 0x8000, v14
v_mfma_f32_16x16x32_bf16 v[208:211], a[84:87], a[60:63], v[208:211]
v_add_u32 v15, 0x8000, v15
v_mfma_f32_16x16x32_bf16 v[208:211], a[80:83], a[44:47], v[208:211]
v_mfma_f32_16x16x32_bf16 v[212:215], a[88:91], a[44:47], v[212:215]
s_waitcnt vmcnt(29) lgkmcnt(0)
v_mfma_f32_16x16x32_bf16 v[212:215], a[92:95], a[60:63], v[212:215]
s_barrier
s_add_u32 m0, s17, 0x8000
v_mfma_f32_16x16x32_bf16 v[204:207], a[92:95], a[56:59], v[204:207]
buffer_load_dwordx4 v5, s[52:55], 0 offen lds
v_mfma_f32_16x16x32_bf16 v[204:207], a[88:91], a[40:43], v[204:207]
ds_read_b64_tr_b16 a[80:81], v12 offset:0
v_mfma_f32_16x16x32_bf16 v[196:199], a[88:91], a[36:39], v[196:199]
ds_read_b64_tr_b16 a[82:83], v12 offset:1024
v_mfma_f32_16x16x32_bf16 v[196:199], a[92:95], a[52:55], v[196:199]
ds_read_b64_tr_b16 a[84:85], v12 offset:8192
v_mfma_f32_16x16x32_bf16 v[188:191], a[92:95], a[48:51], v[188:191]
ds_read_b64_tr_b16 a[86:87], v12 offset:9216
v_mfma_f32_16x16x32_bf16 v[188:191], a[88:91], a[32:35], v[188:191]
s_add_u32 m0, s17, 0x8400
s_waitcnt lgkmcnt(4)
v_mfma_f32_16x16x32_bf16 v[216:219], a[32:35], a[96:99], v[216:219]
buffer_load_dwordx4 v5, s[52:55], s13 offen lds
v_mfma_f32_16x16x32_bf16 v[216:219], a[48:51], a[100:103], v[216:219]
ds_read_b64_tr_b16 a[88:89], v13 offset:0
v_mfma_f32_16x16x32_bf16 v[224:227], a[52:55], a[100:103], v[224:227]
ds_read_b64_tr_b16 a[90:91], v13 offset:1024
v_mfma_f32_16x16x32_bf16 v[224:227], a[36:39], a[96:99], v[224:227]
ds_read_b64_tr_b16 a[92:93], v13 offset:8192
v_mfma_f32_16x16x32_bf16 v[232:235], a[40:43], a[96:99], v[232:235]
ds_read_b64_tr_b16 a[94:95], v13 offset:9216
v_mfma_f32_16x16x32_bf16 v[232:235], a[56:59], a[100:103], v[232:235]
v_mfma_f32_16x16x32_bf16 v[240:243], a[60:63], a[100:103], v[240:243]
s_add_u32 m0, s17, 0x8800
v_mfma_f32_16x16x32_bf16 v[240:243], a[44:47], a[96:99], v[240:243]
buffer_load_dwordx4 v6, s[52:55], 0 offen lds
v_mfma_f32_16x16x32_bf16 v[244:247], a[44:47], a[104:107], v[244:247]
ds_read_b64_tr_b16 a[96:97], v12 offset:256
v_mfma_f32_16x16x32_bf16 v[244:247], a[60:63], a[108:111], v[244:247]
ds_read_b64_tr_b16 a[98:99], v12 offset:1280
v_mfma_f32_16x16x32_bf16 v[236:239], a[56:59], a[108:111], v[236:239]
ds_read_b64_tr_b16 a[100:101], v12 offset:8448
v_mfma_f32_16x16x32_bf16 v[236:239], a[40:43], a[104:107], v[236:239]
ds_read_b64_tr_b16 a[102:103], v12 offset:9472
v_mfma_f32_16x16x32_bf16 v[228:231], a[36:39], a[104:107], v[228:231]
v_mfma_f32_16x16x32_bf16 v[228:231], a[52:55], a[108:111], v[228:231]
s_add_u32 m0, s17, 0x8c00
v_mfma_f32_16x16x32_bf16 v[220:223], a[48:51], a[108:111], v[220:223]
buffer_load_dwordx4 v6, s[52:55], s13 offen lds
v_mfma_f32_16x16x32_bf16 v[220:223], a[32:35], a[104:107], v[220:223]
s_waitcnt lgkmcnt(4)
L_S14:
v_mfma_f32_16x16x32_bf16 v[24:27], a[80:83], a[0:3], v[24:27]
ds_read_b64_tr_b16 a[104:105], v13 offset:256
s_waitcnt vmcnt(23)
v_mfma_f32_16x16x32_bf16 v[24:27], a[84:87], a[16:19], v[24:27]
ds_read_b64_tr_b16 a[106:107], v13 offset:1280
v_mfma_f32_16x16x32_bf16 v[32:35], a[84:87], a[20:23], v[32:35]
ds_read_b64_tr_b16 a[108:109], v13 offset:8448
v_mfma_f32_16x16x32_bf16 v[32:35], a[80:83], a[4:7], v[32:35]
ds_read_b64_tr_b16 a[110:111], v13 offset:9472
v_mfma_f32_16x16x32_bf16 v[40:43], a[80:83], a[8:11], v[40:43]
ds_read_b128 a[32:35], v8 offset:32768
s_add_u32 m0, s18, 0xc000
v_mfma_f32_16x16x32_bf16 v[40:43], a[84:87], a[24:27], v[40:43]
buffer_load_dwordx4 v7, s[68:71], 0 offen lds
v_mfma_f32_16x16x32_bf16 v[48:51], a[84:87], a[28:31], v[48:51]
ds_read_b128 a[48:51], v9 offset:32768
v_mfma_f32_16x16x32_bf16 v[48:51], a[80:83], a[12:15], v[48:51]
ds_read_b128 a[36:39], v8 offset:34816
v_mfma_f32_16x16x32_bf16 v[52:55], a[88:91], a[12:15], v[52:55]
ds_read_b64_tr_b16 a[80:81], v12 offset:512
v_mfma_f32_16x16x32_bf16 v[52:55], a[92:95], a[28:31], v[52:55]
ds_read_b64_tr_b16 a[82:83], v12 offset:1536
v_mfma_f32_16x16x32_bf16 v[44:47], a[92:95], a[24:27], v[44:47]
ds_read_b64_tr_b16 a[84:85], v12 offset:8704
s_add_u32 s8, s28, 0x8400
v_mfma_f32_16x16x32_bf16 v[44:47], a[88:91], a[8:11], v[44:47]
buffer_store_dwordx4 a[204:207], v16, s[88:91], s8 offen sc1
v_mfma_f32_16x16x32_bf16 v[36:39], a[88:91], a[4:7], v[36:39]
ds_read_b64_tr_b16 a[86:87], v12 offset:9728
v_mfma_f32_16x16x32_bf16 v[36:39], a[92:95], a[20:23], v[36:39]
ds_read_b128 a[52:55], v9 offset:34816
v_mfma_f32_16x16x32_bf16 v[28:31], a[92:95], a[16:19], v[28:31]
ds_read_b128 a[40:43], v8 offset:36864
v_mfma_f32_16x16x32_bf16 v[28:31], a[88:91], a[0:3], v[28:31]
ds_read_b128 a[56:59], v9 offset:36864
s_waitcnt lgkmcnt(10)
v_mfma_f32_16x16x32_bf16 v[56:59], a[96:99], a[0:3], v[56:59]
ds_read_b64_tr_b16 a[88:89], v13 offset:512
v_mfma_f32_16x16x32_bf16 v[56:59], a[100:103], a[16:19], v[56:59]
ds_read_b64_tr_b16 a[90:91], v13 offset:1536
s_add_u32 m0, s18, 0xd000
v_mfma_f32_16x16x32_bf16 v[64:67], a[100:103], a[20:23], v[64:67]
buffer_load_dwordx4 v7, s[68:71], s25 offen lds
v_mfma_f32_16x16x32_bf16 v[64:67], a[96:99], a[4:7], v[64:67]
ds_read_b64_tr_b16 a[92:93], v13 offset:8704
v_mfma_f32_16x16x32_bf16 v[72:75], a[96:99], a[8:11], v[72:75]
ds_read_b64_tr_b16 a[94:95], v13 offset:9728
v_mfma_f32_16x16x32_bf16 v[72:75], a[100:103], a[24:27], v[72:75]
ds_read_b128 a[44:47], v8 offset:38912
v_mfma_f32_16x16x32_bf16 v[80:83], a[100:103], a[28:31], v[80:83]
ds_read_b128 a[60:63], v9 offset:38912
v_mfma_f32_16x16x32_bf16 v[80:83], a[96:99], a[12:15], v[80:83]
v_mfma_f32_16x16x32_bf16 v[84:87], a[104:107], a[12:15], v[84:87]
ds_read_b64_tr_b16 a[96:97], v12 offset:768
s_add_u32 m0, s18, 0xe000
v_mfma_f32_16x16x32_bf16 v[84:87], a[108:111], a[28:31], v[84:87]
buffer_load_dwordx4 v7, s[68:71], s26 offen lds
v_mfma_f32_16x16x32_bf16 v[76:79], a[108:111], a[24:27], v[76:79]
ds_read_b64_tr_b16 a[98:99], v12 offset:1792
v_lshl_add_u32 v5, s42, 19, v5
v_mfma_f32_16x16x32_bf16 v[76:79], a[104:107], a[8:11], v[76:79]
ds_read_b64_tr_b16 a[100:101], v12 offset:8960
v_lshl_add_u32 v6, s42, 19, v6
v_mfma_f32_16x16x32_bf16 v[68:71], a[104:107], a[4:7], v[68:71]
ds_read_b64_tr_b16 a[102:103], v12 offset:9984
v_lshl_add_u32 v7, s42, 18, v7
v_mfma_f32_16x16x32_bf16 v[68:71], a[108:111], a[20:23], v[68:71]
v_lshl_add_u32 v7, s42, 17, v7
v_mfma_f32_16x16x32_bf16 v[60:63], a[108:111], a[16:19], v[60:63]
v_mfma_f32_16x16x32_bf16 v[60:63], a[104:107], a[0:3], v[60:63]
s_add_u32 m0, s16, 0x8000
s_waitcnt lgkmcnt(4)
s_waitcnt lgkmcnt(6)
v_mfma_f32_16x16x32_bf16 v[88:91], a[80:83], a[0:3], v[88:91]
buffer_load_dwordx4 v22, s[44:47], s20 offen lds
v_mfma_f32_16x16x32_bf16 v[88:91], a[84:87], a[16:19], v[88:91]
ds_read_b64_tr_b16 a[104:105], v13 offset:768
v_mfma_f32_16x16x32_bf16 v[96:99], a[84:87], a[20:23], v[96:99]
ds_read_b64_tr_b16 a[106:107], v13 offset:1792
v_mfma_f32_16x16x32_bf16 v[96:99], a[80:83], a[4:7], v[96:99]
ds_read_b64_tr_b16 a[108:109], v13 offset:8960
v_mfma_f32_16x16x32_bf16 v[104:107], a[80:83], a[8:11], v[104:107]
ds_read_b64_tr_b16 a[110:111], v13 offset:9984
s_add_u32 m0, s16, 0x8400
v_mfma_f32_16x16x32_bf16 v[104:107], a[84:87], a[24:27], v[104:107]
buffer_load_dwordx4 v23, s[44:47], s20 offen lds
v_mfma_f32_16x16x32_bf16 v[112:115], a[84:87], a[28:31], v[112:115]
v_mfma_f32_16x16x32_bf16 v[112:115], a[80:83], a[12:15], v[112:115]
v_mfma_f32_16x16x32_bf16 v[116:119], a[88:91], a[12:15], v[116:119]
ds_read_b64_tr_b16 a[80:81], v14 offset:0
v_mfma_f32_16x16x32_bf16 v[116:119], a[92:95], a[28:31], v[116:119]
ds_read_b64_tr_b16 a[82:83], v14 offset:256
v_mfma_f32_16x16x32_bf16 v[108:111], a[92:95], a[24:27], v[108:111]
ds_read_b64_tr_b16 a[84:85], v14 offset:2048
s_add_u32 m0, s16, 0x8800
v_mfma_f32_16x16x32_bf16 v[108:111], a[88:91], a[8:11], v[108:111]
buffer_load_dwordx4 v22, s[44:47], s21 offen lds
v_mfma_f32_16x16x32_bf16 v[100:103], a[88:91], a[4:7], v[100:103]
ds_read_b64_tr_b16 a[86:87], v14 offset:2304
v_mfma_f32_16x16x32_bf16 v[100:103], a[92:95], a[20:23], v[100:103]
v_mfma_f32_16x16x32_bf16 v[92:95], a[92:95], a[16:19], v[92:95]
v_mfma_f32_16x16x32_bf16 v[92:95], a[88:91], a[0:3], v[92:95]
s_add_u32 s8, s28, 0x4800
s_waitcnt lgkmcnt(4)
v_mfma_f32_16x16x32_bf16 v[120:123], a[96:99], a[0:3], v[120:123]
buffer_store_dwordx4 a[208:211], v16, s[88:91], s8 offen sc1
v_mfma_f32_16x16x32_bf16 v[120:123], a[100:103], a[16:19], v[120:123]
ds_read_b64_tr_b16 a[88:89], v15 offset:0
v_mfma_f32_16x16x32_bf16 v[128:131], a[100:103], a[20:23], v[128:131]
ds_read_b64_tr_b16 a[90:91], v15 offset:256
v_mfma_f32_16x16x32_bf16 v[128:131], a[96:99], a[4:7], v[128:131]
ds_read_b64_tr_b16 a[92:93], v15 offset:2048
v_mfma_f32_16x16x32_bf16 v[136:139], a[96:99], a[8:11], v[136:139]
ds_read_b64_tr_b16 a[94:95], v15 offset:2304
v_mfma_f32_16x16x32_bf16 v[136:139], a[100:103], a[24:27], v[136:139]
s_add_u32 m0, s16, 0x8c00
v_mfma_f32_16x16x32_bf16 v[144:147], a[100:103], a[28:31], v[144:147]
buffer_load_dwordx4 v23, s[44:47], s21 offen lds
v_mfma_f32_16x16x32_bf16 v[144:147], a[96:99], a[12:15], v[144:147]
v_mfma_f32_16x16x32_bf16 v[148:151], a[104:107], a[12:15], v[148:151]
ds_read_b64_tr_b16 a[96:97], v14 offset:4096
v_mfma_f32_16x16x32_bf16 v[148:151], a[108:111], a[28:31], v[148:151]
ds_read_b64_tr_b16 a[98:99], v14 offset:4352
v_mfma_f32_16x16x32_bf16 v[140:143], a[108:111], a[24:27], v[140:143]
ds_read_b64_tr_b16 a[100:101], v14 offset:6144
v_mfma_f32_16x16x32_bf16 v[140:143], a[104:107], a[8:11], v[140:143]
ds_read_b64_tr_b16 a[102:103], v14 offset:6400
s_add_u32 m0, s16, 0x9000
v_mfma_f32_16x16x32_bf16 v[132:135], a[104:107], a[4:7], v[132:135]
buffer_load_dwordx4 v22, s[44:47], s22 offen lds
v_mfma_f32_16x16x32_bf16 v[132:135], a[108:111], a[20:23], v[132:135]
v_mfma_f32_16x16x32_bf16 v[124:127], a[108:111], a[16:19], v[124:127]
v_mfma_f32_16x16x32_bf16 v[124:127], a[104:107], a[0:3], v[124:127]
s_waitcnt lgkmcnt(4)
v_mfma_f32_16x16x32_bf16 v[152:155], a[80:83], a[0:3], v[152:155]
ds_read_b64_tr_b16 a[104:105], v15 offset:4096
s_add_u32 m0, s16, 0x9400
v_mfma_f32_16x16x32_bf16 v[152:155], a[84:87], a[16:19], v[152:155]
buffer_load_dwordx4 v23, s[44:47], s22 offen lds
v_mfma_f32_16x16x32_bf16 v[160:163], a[84:87], a[20:23], v[160:163]
ds_read_b64_tr_b16 a[106:107], v15 offset:4352
v_mfma_f32_16x16x32_bf16 v[160:163], a[80:83], a[4:7], v[160:163]
ds_read_b64_tr_b16 a[108:109], v15 offset:6144
v_mfma_f32_16x16x32_bf16 v[168:171], a[80:83], a[8:11], v[168:171]
ds_read_b64_tr_b16 a[110:111], v15 offset:6400
v_mfma_f32_16x16x32_bf16 v[168:171], a[84:87], a[24:27], v[168:171]
v_mfma_f32_16x16x32_bf16 v[176:179], a[84:87], a[28:31], v[176:179]
s_add_u32 m0, s16, 0x9800
v_mfma_f32_16x16x32_bf16 v[176:179], a[80:83], a[12:15], v[176:179]
buffer_load_dwordx4 v22, s[44:47], s23 offen lds
v_mfma_f32_16x16x32_bf16 v[180:183], a[88:91], a[12:15], v[180:183]
ds_read_b64_tr_b16 a[80:81], v14 offset:8192
v_mfma_f32_16x16x32_bf16 v[180:183], a[92:95], a[28:31], v[180:183]
ds_read_b64_tr_b16 a[82:83], v14 offset:8448
v_mfma_f32_16x16x32_bf16 v[172:175], a[92:95], a[24:27], v[172:175]
ds_read_b64_tr_b16 a[84:85], v14 offset:10240
v_mfma_f32_16x16x32_bf16 v[172:175], a[88:91], a[8:11], v[172:175]
ds_read_b64_tr_b16 a[86:87], v14 offset:10496
s_add_u32 m0, s16, 0x9c00
v_mfma_f32_16x16x32_bf16 v[164:167], a[88:91], a[4:7], v[164:167]
buffer_load_dwordx4 v23, s[44:47], s23 offen lds
v_mfma_f32_16x16x32_bf16 v[164:167], a[92:95], a[20:23], v[164:167]
v_lshl_add_u32 v22, s42, 7, v22
v_lshl_add_u32 v23, s42, 7, v23
v_mfma_f32_16x16x32_bf16 v[156:159], a[92:95], a[16:19], v[156:159]
v_mfma_f32_16x16x32_bf16 v[156:159], a[88:91], a[0:3], v[156:159]
s_waitcnt lgkmcnt(4)
v_mfma_f32_16x16x32_bf16 v[184:187], a[96:99], a[0:3], v[184:187]
ds_read_b64_tr_b16 a[88:89], v15 offset:8192
v_mfma_f32_16x16x32_bf16 v[184:187], a[100:103], a[16:19], v[184:187]
ds_read_b64_tr_b16 a[90:91], v15 offset:8448
s_add_u32 s8, s28, 0x8800
v_mfma_f32_16x16x32_bf16 v[192:195], a[100:103], a[20:23], v[192:195]
buffer_store_dwordx4 a[212:215], v16, s[88:91], s8 offen sc1
v_mfma_f32_16x16x32_bf16 v[192:195], a[96:99], a[4:7], v[192:195]
ds_read_b64_tr_b16 a[92:93], v15 offset:10240
v_mfma_f32_16x16x32_bf16 v[200:203], a[96:99], a[8:11], v[200:203]
ds_read_b64_tr_b16 a[94:95], v15 offset:10496
v_add_u32 v12, 0xffff0000, v12
v_mfma_f32_16x16x32_bf16 v[200:203], a[100:103], a[24:27], v[200:203]
v_add_u32 v13, 0xffff0000, v13
v_add_u32 v14, 0xffff0000, v14
v_mfma_f32_16x16x32_bf16 v[208:211], a[100:103], a[28:31], v[208:211]
v_add_u32 v15, 0xffff0000, v15
v_mfma_f32_16x16x32_bf16 v[208:211], a[96:99], a[12:15], v[208:211]
v_mfma_f32_16x16x32_bf16 v[212:215], a[104:107], a[12:15], v[212:215]
s_waitcnt vmcnt(28) lgkmcnt(0)
v_mfma_f32_16x16x32_bf16 v[212:215], a[108:111], a[28:31], v[212:215]
s_barrier
s_add_u32 m0, s17, 0x10000
v_mfma_f32_16x16x32_bf16 v[204:207], a[108:111], a[24:27], v[204:207]
buffer_load_dwordx4 v5, s[52:55], 0 offen lds
v_mfma_f32_16x16x32_bf16 v[204:207], a[104:107], a[8:11], v[204:207]
ds_read_b64_tr_b16 a[96:97], v12 offset:0
v_mfma_f32_16x16x32_bf16 v[196:199], a[104:107], a[4:7], v[196:199]
ds_read_b64_tr_b16 a[98:99], v12 offset:1024
v_mfma_f32_16x16x32_bf16 v[196:199], a[108:111], a[20:23], v[196:199]
ds_read_b64_tr_b16 a[100:101], v12 offset:8192
v_mfma_f32_16x16x32_bf16 v[188:191], a[108:111], a[16:19], v[188:191]
ds_read_b64_tr_b16 a[102:103], v12 offset:9216
v_mfma_f32_16x16x32_bf16 v[188:191], a[104:107], a[0:3], v[188:191]
s_add_u32 m0, s17, 0x10400
s_waitcnt lgkmcnt(4)
v_mfma_f32_16x16x32_bf16 v[216:219], a[0:3], a[80:83], v[216:219]
buffer_load_dwordx4 v5, s[52:55], s13 offen lds
v_mfma_f32_16x16x32_bf16 v[216:219], a[16:19], a[84:87], v[216:219]
ds_read_b64_tr_b16 a[104:105], v13 offset:0
v_mfma_f32_16x16x32_bf16 v[224:227], a[20:23], a[84:87], v[224:227]
ds_read_b64_tr_b16 a[106:107], v13 offset:1024
v_mfma_f32_16x16x32_bf16 v[224:227], a[4:7], a[80:83], v[224:227]
ds_read_b64_tr_b16 a[108:109], v13 offset:8192
v_mfma_f32_16x16x32_bf16 v[232:235], a[8:11], a[80:83], v[232:235]
ds_read_b64_tr_b16 a[110:111], v13 offset:9216
v_mfma_f32_16x16x32_bf16 v[232:235], a[24:27], a[84:87], v[232:235]
v_mfma_f32_16x16x32_bf16 v[240:243], a[28:31], a[84:87], v[240:243]
s_add_u32 m0, s17, 0x10800
v_mfma_f32_16x16x32_bf16 v[240:243], a[12:15], a[80:83], v[240:243]
buffer_load_dwordx4 v6, s[52:55], 0 offen lds
v_mfma_f32_16x16x32_bf16 v[244:247], a[12:15], a[88:91], v[244:247]
ds_read_b64_tr_b16 a[80:81], v12 offset:256
v_mfma_f32_16x16x32_bf16 v[244:247], a[28:31], a[92:95], v[244:247]
ds_read_b64_tr_b16 a[82:83], v12 offset:1280
v_mfma_f32_16x16x32_bf16 v[236:239], a[24:27], a[92:95], v[236:239]
ds_read_b64_tr_b16 a[84:85], v12 offset:8448
v_mfma_f32_16x16x32_bf16 v[236:239], a[8:11], a[88:91], v[236:239]
ds_read_b64_tr_b16 a[86:87], v12 offset:9472
v_mfma_f32_16x16x32_bf16 v[228:231], a[4:7], a[88:91], v[228:231]
v_mfma_f32_16x16x32_bf16 v[228:231], a[20:23], a[92:95], v[228:231]
s_add_u32 m0, s17, 0x10c00
v_mfma_f32_16x16x32_bf16 v[220:223], a[16:19], a[92:95], v[220:223]
buffer_load_dwordx4 v6, s[52:55], s13 offen lds
v_mfma_f32_16x16x32_bf16 v[220:223], a[0:3], a[88:91], v[220:223]
s_waitcnt lgkmcnt(4)
L_S15:
v_mfma_f32_16x16x32_bf16 v[24:27], a[96:99], a[32:35], v[24:27]
ds_read_b64_tr_b16 a[88:89], v13 offset:256
s_waitcnt vmcnt(23)
v_mfma_f32_16x16x32_bf16 v[24:27], a[100:103], a[48:51], v[24:27]
ds_read_b64_tr_b16 a[90:91], v13 offset:1280
v_mfma_f32_16x16x32_bf16 v[32:35], a[100:103], a[52:55], v[32:35]
ds_read_b64_tr_b16 a[92:93], v13 offset:8448
v_mfma_f32_16x16x32_bf16 v[32:35], a[96:99], a[36:39], v[32:35]
ds_read_b64_tr_b16 a[94:95], v13 offset:9472
v_mfma_f32_16x16x32_bf16 v[40:43], a[96:99], a[40:43], v[40:43]
ds_read_b128 a[0:3], v8 offset:0
s_add_u32 m0, s18, 0x14000
v_mfma_f32_16x16x32_bf16 v[40:43], a[100:103], a[56:59], v[40:43]
buffer_load_dwordx4 v7, s[68:71], 0 offen lds
v_mfma_f32_16x16x32_bf16 v[48:51], a[100:103], a[60:63], v[48:51]
ds_read_b128 a[16:19], v9 offset:0
v_mfma_f32_16x16x32_bf16 v[48:51], a[96:99], a[44:47], v[48:51]
ds_read_b128 a[4:7], v8 offset:2048
v_mfma_f32_16x16x32_bf16 v[52:55], a[104:107], a[44:47], v[52:55]
ds_read_b64_tr_b16 a[96:97], v12 offset:512
v_mfma_f32_16x16x32_bf16 v[52:55], a[108:111], a[60:63], v[52:55]
ds_read_b64_tr_b16 a[98:99], v12 offset:1536
v_mfma_f32_16x16x32_bf16 v[44:47], a[108:111], a[56:59], v[44:47]
ds_read_b64_tr_b16 a[100:101], v12 offset:8704
s_add_u32 s8, s28, 0x4c00
v_mfma_f32_16x16x32_bf16 v[44:47], a[104:107], a[40:43], v[44:47]
buffer_store_dwordx4 a[216:219], v16, s[88:91], s8 offen sc1
v_mfma_f32_16x16x32_bf16 v[36:39], a[104:107], a[36:39], v[36:39]
ds_read_b64_tr_b16 a[102:103], v12 offset:9728
v_mfma_f32_16x16x32_bf16 v[36:39], a[108:111], a[52:55], v[36:39]
ds_read_b128 a[20:23], v9 offset:2048
v_mfma_f32_16x16x32_bf16 v[28:31], a[108:111], a[48:51], v[28:31]
ds_read_b128 a[8:11], v8 offset:4096
v_mfma_f32_16x16x32_bf16 v[28:31], a[104:107], a[32:35], v[28:31]
ds_read_b128 a[24:27], v9 offset:4096
s_waitcnt lgkmcnt(10)
v_mfma_f32_16x16x32_bf16 v[56:59], a[80:83], a[32:35], v[56:59]
ds_read_b64_tr_b16 a[104:105], v13 offset:512
v_mfma_f32_16x16x32_bf16 v[56:59], a[84:87], a[48:51], v[56:59]
ds_read_b64_tr_b16 a[106:107], v13 offset:1536
s_add_u32 m0, s18, 0x15000
v_mfma_f32_16x16x32_bf16 v[64:67], a[84:87], a[52:55], v[64:67]
buffer_load_dwordx4 v7, s[68:71], s25 offen lds
v_mfma_f32_16x16x32_bf16 v[64:67], a[80:83], a[36:39], v[64:67]
ds_read_b64_tr_b16 a[108:109], v13 offset:8704
v_mfma_f32_16x16x32_bf16 v[72:75], a[80:83], a[40:43], v[72:75]
ds_read_b64_tr_b16 a[110:111], v13 offset:9728
v_mfma_f32_16x16x32_bf16 v[72:75], a[84:87], a[56:59], v[72:75]
ds_read_b128 a[12:15], v8 offset:6144
v_mfma_f32_16x16x32_bf16 v[80:83], a[84:87], a[60:63], v[80:83]
ds_read_b128 a[28:31], v9 offset:6144
v_mfma_f32_16x16x32_bf16 v[80:83], a[80:83], a[44:47], v[80:83]
v_mfma_f32_16x16x32_bf16 v[84:87], a[88:91], a[44:47], v[84:87]
ds_read_b64_tr_b16 a[80:81], v12 offset:768
s_add_u32 m0, s18, 0x16000
v_mfma_f32_16x16x32_bf16 v[84:87], a[92:95], a[60:63], v[84:87]
buffer_load_dwordx4 v7, s[68:71], s26 offen lds
v_mfma_f32_16x16x32_bf16 v[76:79], a[92:95], a[56:59], v[76:79]
ds_read_b64_tr_b16 a[82:83], v12 offset:1792
v_lshl_add_u32 v5, s42, 19, v5
v_mfma_f32_16x16x32_bf16 v[76:79], a[88:91], a[40:43], v[76:79]
ds_read_b64_tr_b16 a[84:85], v12 offset:8960
v_lshl_add_u32 v6, s42, 19, v6
v_mfma_f32_16x16x32_bf16 v[68:71], a[88:91], a[36:39], v[68:71]
ds_read_b64_tr_b16 a[86:87], v12 offset:9984
v_lshl_add_u32 v7, s42, 18, v7
v_mfma_f32_16x16x32_bf16 v[68:71], a[92:95], a[52:55], v[68:71]
v_lshl_add_u32 v7, s42, 17, v7
v_mfma_f32_16x16x32_bf16 v[60:63], a[92:95], a[48:51], v[60:63]
v_mfma_f32_16x16x32_bf16 v[60:63], a[88:91], a[32:35], v[60:63]
s_add_u32 m0, s16, 0x0
s_waitcnt lgkmcnt(4)
s_waitcnt lgkmcnt(6)
v_mfma_f32_16x16x32_bf16 v[88:91], a[96:99], a[32:35], v[88:91]
buffer_load_dwordx4 v22, s[44:47], s20 offen lds
v_mfma_f32_16x16x32_bf16 v[88:91], a[100:103], a[48:51], v[88:91]
ds_read_b64_tr_b16 a[88:89], v13 offset:768
v_mfma_f32_16x16x32_bf16 v[96:99], a[100:103], a[52:55], v[96:99]
ds_read_b64_tr_b16 a[90:91], v13 offset:1792
v_mfma_f32_16x16x32_bf16 v[96:99], a[96:99], a[36:39], v[96:99]
ds_read_b64_tr_b16 a[92:93], v13 offset:8960
v_mfma_f32_16x16x32_bf16 v[104:107], a[96:99], a[40:43], v[104:107]
ds_read_b64_tr_b16 a[94:95], v13 offset:9984
s_add_u32 m0, s16, 0x400
v_mfma_f32_16x16x32_bf16 v[104:107], a[100:103], a[56:59], v[104:107]
buffer_load_dwordx4 v23, s[44:47], s20 offen lds
v_mfma_f32_16x16x32_bf16 v[112:115], a[100:103], a[60:63], v[112:115]
v_mfma_f32_16x16x32_bf16 v[112:115], a[96:99], a[44:47], v[112:115]
v_mfma_f32_16x16x32_bf16 v[116:119], a[104:107], a[44:47], v[116:119]
ds_read_b64_tr_b16 a[96:97], v14 offset:0
v_mfma_f32_16x16x32_bf16 v[116:119], a[108:111], a[60:63], v[116:119]
ds_read_b64_tr_b16 a[98:99], v14 offset:256
v_mfma_f32_16x16x32_bf16 v[108:111], a[108:111], a[56:59], v[108:111]
ds_read_b64_tr_b16 a[100:101], v14 offset:2048
s_add_u32 m0, s16, 0x800
v_mfma_f32_16x16x32_bf16 v[108:111], a[104:107], a[40:43], v[108:111]
buffer_load_dwordx4 v22, s[44:47], s21 offen lds
v_mfma_f32_16x16x32_bf16 v[100:103], a[104:107], a[36:39], v[100:103]
ds_read_b64_tr_b16 a[102:103], v14 offset:2304
v_mfma_f32_16x16x32_bf16 v[100:103], a[108:111], a[52:55], v[100:103]
v_mfma_f32_16x16x32_bf16 v[92:95], a[108:111], a[48:51], v[92:95]
v_mfma_f32_16x16x32_bf16 v[92:95], a[104:107], a[32:35], v[92:95]
s_add_u32 s8, s28, 0x8c00
s_waitcnt lgkmcnt(4)
v_mfma_f32_16x16x32_bf16 v[120:123], a[80:83], a[32:35], v[120:123]
buffer_store_dwordx4 a[220:223], v16, s[88:91], s8 offen sc1
v_mfma_f32_16x16x32_bf16 v[120:123], a[84:87], a[48:51], v[120:123]
ds_read_b64_tr_b16 a[104:105], v15 offset:0
v_mfma_f32_16x16x32_bf16 v[128:131], a[84:87], a[52:55], v[128:131]
ds_read_b64_tr_b16 a[106:107], v15 offset:256
v_mfma_f32_16x16x32_bf16 v[128:131], a[80:83], a[36:39], v[128:131]
ds_read_b64_tr_b16 a[108:109], v15 offset:2048
v_mfma_f32_16x16x32_bf16 v[136:139], a[80:83], a[40:43], v[136:139]
ds_read_b64_tr_b16 a[110:111], v15 offset:2304
v_mfma_f32_16x16x32_bf16 v[136:139], a[84:87], a[56:59], v[136:139]
s_add_u32 m0, s16, 0xc00
v_mfma_f32_16x16x32_bf16 v[144:147], a[84:87], a[60:63], v[144:147]
buffer_load_dwordx4 v23, s[44:47], s21 offen lds
v_mfma_f32_16x16x32_bf16 v[144:147], a[80:83], a[44:47], v[144:147]
v_mfma_f32_16x16x32_bf16 v[148:151], a[88:91], a[44:47], v[148:151]
ds_read_b64_tr_b16 a[80:81], v14 offset:4096
v_mfma_f32_16x16x32_bf16 v[148:151], a[92:95], a[60:63], v[148:151]
ds_read_b64_tr_b16 a[82:83], v14 offset:4352
v_mfma_f32_16x16x32_bf16 v[140:143], a[92:95], a[56:59], v[140:143]
ds_read_b64_tr_b16 a[84:85], v14 offset:6144
v_mfma_f32_16x16x32_bf16 v[140:143], a[88:91], a[40:43], v[140:143]
ds_read_b64_tr_b16 a[86:87], v14 offset:6400
s_add_u32 m0, s16, 0x1000
v_mfma_f32_16x16x32_bf16 v[132:135], a[88:91], a[36:39], v[132:135]
buffer_load_dwordx4 v22, s[44:47], s22 offen lds
v_mfma_f32_16x16x32_bf16 v[132:135], a[92:95], a[52:55], v[132:135]
v_mfma_f32_16x16x32_bf16 v[124:127], a[92:95], a[48:51], v[124:127]
v_mfma_f32_16x16x32_bf16 v[124:127], a[88:91], a[32:35], v[124:127]
s_waitcnt lgkmcnt(4)
v_mfma_f32_16x16x32_bf16 v[152:155], a[96:99], a[32:35], v[152:155]
ds_read_b64_tr_b16 a[88:89], v15 offset:4096
s_add_u32 m0, s16, 0x1400
v_mfma_f32_16x16x32_bf16 v[152:155], a[100:103], a[48:51], v[152:155]
buffer_load_dwordx4 v23, s[44:47], s22 offen lds
v_mfma_f32_16x16x32_bf16 v[160:163], a[100:103], a[52:55], v[160:163]
ds_read_b64_tr_b16 a[90:91], v15 offset:4352
v_mfma_f32_16x16x32_bf16 v[160:163], a[96:99], a[36:39], v[160:163]
ds_read_b64_tr_b16 a[92:93], v15 offset:6144
v_mfma_f32_16x16x32_bf16 v[168:171], a[96:99], a[40:43], v[168:171]
ds_read_b64_tr_b16 a[94:95], v15 offset:6400
v_mfma_f32_16x16x32_bf16 v[168:171], a[100:103], a[56:59], v[168:171]
v_mfma_f32_16x16x32_bf16 v[176:179], a[100:103], a[60:63], v[176:179]
s_add_u32 m0, s16, 0x1800
v_mfma_f32_16x16x32_bf16 v[176:179], a[96:99], a[44:47], v[176:179]
buffer_load_dwordx4 v22, s[44:47], s23 offen lds
v_mfma_f32_16x16x32_bf16 v[180:183], a[104:107], a[44:47], v[180:183]
ds_read_b64_tr_b16 a[96:97], v14 offset:8192
v_mfma_f32_16x16x32_bf16 v[180:183], a[108:111], a[60:63], v[180:183]
ds_read_b64_tr_b16 a[98:99], v14 offset:8448
v_mfma_f32_16x16x32_bf16 v[172:175], a[108:111], a[56:59], v[172:175]
ds_read_b64_tr_b16 a[100:101], v14 offset:10240
v_mfma_f32_16x16x32_bf16 v[172:175], a[104:107], a[40:43], v[172:175]
ds_read_b64_tr_b16 a[102:103], v14 offset:10496
s_add_u32 m0, s16, 0x1c00
v_mfma_f32_16x16x32_bf16 v[164:167], a[104:107], a[36:39], v[164:167]
buffer_load_dwordx4 v23, s[44:47], s23 offen lds
v_mfma_f32_16x16x32_bf16 v[164:167], a[108:111], a[52:55], v[164:167]
v_lshl_add_u32 v22, s42, 7, v22
v_lshl_add_u32 v23, s42, 7, v23
v_mfma_f32_16x16x32_bf16 v[156:159], a[108:111], a[48:51], v[156:159]
v_mfma_f32_16x16x32_bf16 v[156:159], a[104:107], a[32:35], v[156:159]
s_waitcnt lgkmcnt(4)
v_mfma_f32_16x16x32_bf16 v[184:187], a[80:83], a[32:35], v[184:187]
ds_read_b64_tr_b16 a[104:105], v15 offset:8192
v_mfma_f32_16x16x32_bf16 v[184:187], a[84:87], a[48:51], v[184:187]
ds_read_b64_tr_b16 a[106:107], v15 offset:8448
s_add_u32 s8, s28, 0x5000
v_mfma_f32_16x16x32_bf16 v[192:195], a[84:87], a[52:55], v[192:195]
buffer_store_dwordx4 a[224:227], v16, s[88:91], s8 offen sc1
v_mfma_f32_16x16x32_bf16 v[192:195], a[80:83], a[36:39], v[192:195]
ds_read_b64_tr_b16 a[108:109], v15 offset:10240
v_mfma_f32_16x16x32_bf16 v[200:203], a[80:83], a[40:43], v[200:203]
ds_read_b64_tr_b16 a[110:111], v15 offset:10496
v_add_u32 v12, 0x8000, v12
v_mfma_f32_16x16x32_bf16 v[200:203], a[84:87], a[56:59], v[200:203]
v_add_u32 v13, 0x8000, v13
v_add_u32 v14, 0x8000, v14
v_mfma_f32_16x16x32_bf16 v[208:211], a[84:87], a[60:63], v[208:211]
L_padA8:
s_cmp_eq_u32 s95, 1
s_cbranch_scc1 L_padA12
v_add_u32 v15, 0x8000, v15
v_mfma_f32_16x16x32_bf16 v[208:211], a[80:83], a[44:47], v[208:211]
v_mfma_f32_16x16x32_bf16 v[212:215], a[88:91], a[44:47], v[212:215]
s_waitcnt vmcnt(28) lgkmcnt(0)
v_mfma_f32_16x16x32_bf16 v[212:215], a[92:95], a[60:63], v[212:215]
s_barrier
s_add_u32 m0, s17, 0x0
v_mfma_f32_16x16x32_bf16 v[204:207], a[92:95], a[56:59], v[204:207]
buffer_load_dwordx4 v5, s[52:55], 0 offen lds
v_mfma_f32_16x16x32_bf16 v[204:207], a[88:91], a[40:43], v[204:207]
ds_read_b64_tr_b16 a[80:81], v12 offset:0
v_mfma_f32_16x16x32_bf16 v[196:199], a[88:91], a[36:39], v[196:199]
ds_read_b64_tr_b16 a[82:83], v12 offset:1024
v_mfma_f32_16x16x32_bf16 v[196:199], a[92:95], a[52:55], v[196:199]
ds_read_b64_tr_b16 a[84:85], v12 offset:8192
v_mfma_f32_16x16x32_bf16 v[188:191], a[92:95], a[48:51], v[188:191]
ds_read_b64_tr_b16 a[86:87], v12 offset:9216
v_mfma_f32_16x16x32_bf16 v[188:191], a[88:91], a[32:35], v[188:191]
s_add_u32 m0, s17, 0x400
s_waitcnt lgkmcnt(4)
v_mfma_f32_16x16x32_bf16 v[216:219], a[32:35], a[96:99], v[216:219]
buffer_load_dwordx4 v5, s[52:55], s13 offen lds
v_mfma_f32_16x16x32_bf16 v[216:219], a[48:51], a[100:103], v[216:219]
ds_read_b64_tr_b16 a[88:89], v13 offset:0
v_mfma_f32_16x16x32_bf16 v[224:227], a[52:55], a[100:103], v[224:227]
ds_read_b64_tr_b16 a[90:91], v13 offset:1024
v_mfma_f32_16x16x32_bf16 v[224:227], a[36:39], a[96:99], v[224:227]
ds_read_b64_tr_b16 a[92:93], v13 offset:8192
v_mfma_f32_16x16x32_bf16 v[232:235], a[40:43], a[96:99], v[232:235]
ds_read_b64_tr_b16 a[94:95], v13 offset:9216
v_mfma_f32_16x16x32_bf16 v[232:235], a[56:59], a[100:103], v[232:235]
v_mfma_f32_16x16x32_bf16 v[240:243], a[60:63], a[100:103], v[240:243]
s_add_u32 m0, s17, 0x800
v_mfma_f32_16x16x32_bf16 v[240:243], a[44:47], a[96:99], v[240:243]
buffer_load_dwordx4 v6, s[52:55], 0 offen lds
v_mfma_f32_16x16x32_bf16 v[244:247], a[44:47], a[104:107], v[244:247]
ds_read_b64_tr_b16 a[96:97], v12 offset:256
v_mfma_f32_16x16x32_bf16 v[244:247], a[60:63], a[108:111], v[244:247]
ds_read_b64_tr_b16 a[98:99], v12 offset:1280
v_mfma_f32_16x16x32_bf16 v[236:239], a[56:59], a[108:111], v[236:239]
ds_read_b64_tr_b16 a[100:101], v12 offset:8448
v_mfma_f32_16x16x32_bf16 v[236:239], a[40:43], a[104:107], v[236:239]
ds_read_b64_tr_b16 a[102:103], v12 offset:9472
v_mfma_f32_16x16x32_bf16 v[228:231], a[36:39], a[104:107], v[228:231]
v_mfma_f32_16x16x32_bf16 v[228:231], a[52:55], a[108:111], v[228:231]
s_add_u32 m0, s17, 0xc00
v_mfma_f32_16x16x32_bf16 v[220:223], a[48:51], a[108:111], v[220:223]
buffer_load_dwordx4 v6, s[52:55], s13 offen lds
v_mfma_f32_16x16x32_bf16 v[220:223], a[32:35], a[104:107], v[220:223]
s_waitcnt lgkmcnt(4)
L_S16:
v_mfma_f32_16x16x32_bf16 v[24:27], a[80:83], a[0:3], v[24:27]
ds_read_b64_tr_b16 a[104:105], v13 offset:256
s_waitcnt vmcnt(23)
v_mfma_f32_16x16x32_bf16 v[24:27], a[84:87], a[16:19], v[24:27]
ds_read_b64_tr_b16 a[106:107], v13 offset:1280
v_mfma_f32_16x16x32_bf16 v[32:35], a[84:87], a[20:23], v[32:35]
ds_read_b64_tr_b16 a[108:109], v13 offset:8448
v_mfma_f32_16x16x32_bf16 v[32:35], a[80:83], a[4:7], v[32:35]
ds_read_b64_tr_b16 a[110:111], v13 offset:9472
v_mfma_f32_16x16x32_bf16 v[40:43], a[80:83], a[8:11], v[40:43]
ds_read_b128 a[32:35], v8 offset:32768
s_add_u32 m0, s18, 0x4000
v_mfma_f32_16x16x32_bf16 v[40:43], a[84:87], a[24:27], v[40:43]
buffer_load_dwordx4 v7, s[68:71], 0 offen lds
v_mfma_f32_16x16x32_bf16 v[48:51], a[84:87], a[28:31], v[48:51]
ds_read_b128 a[48:51], v9 offset:32768
v_mfma_f32_16x16x32_bf16 v[48:51], a[80:83], a[12:15], v[48:51]
ds_read_b128 a[36:39], v8 offset:34816
v_mfma_f32_16x16x32_bf16 v[52:55], a[88:91], a[12:15], v[52:55]
ds_read_b64_tr_b16 a[80:81], v12 offset:512
v_mfma_f32_16x16x32_bf16 v[52:55], a[92:95], a[28:31], v[52:55]
ds_read_b64_tr_b16 a[82:83], v12 offset:1536
v_mfma_f32_16x16x32_bf16 v[44:47], a[92:95], a[24:27], v[44:47]
ds_read_b64_tr_b16 a[84:85], v12 offset:8704
s_add_u32 s8, s28, 0x9000
v_mfma_f32_16x16x32_bf16 v[44:47], a[88:91], a[8:11], v[44:47]
buffer_store_dwordx4 a[228:231], v16, s[88:91], s8 offen sc1
v_mfma_f32_16x16x32_bf16 v[36:39], a[88:91], a[4:7], v[36:39]
ds_read_b64_tr_b16 a[86:87], v12 offset:9728
v_mfma_f32_16x16x32_bf16 v[36:39], a[92:95], a[20:23], v[36:39]
ds_read_b128 a[52:55], v9 offset:34816
v_mfma_f32_16x16x32_bf16 v[28:31], a[92:95], a[16:19], v[28:31]
ds_read_b128 a[40:43], v8 offset:36864
v_mfma_f32_16x16x32_bf16 v[28:31], a[88:91], a[0:3], v[28:31]
ds_read_b128 a[56:59], v9 offset:36864
s_waitcnt lgkmcnt(10)
v_mfma_f32_16x16x32_bf16 v[56:59], a[96:99], a[0:3], v[56:59]
ds_read_b64_tr_b16 a[88:89], v13 offset:512
v_mfma_f32_16x16x32_bf16 v[56:59], a[100:103], a[16:19], v[56:59]
ds_read_b64_tr_b16 a[90:91], v13 offset:1536
s_add_u32 m0, s18, 0x5000
v_mfma_f32_16x16x32_bf16 v[64:67], a[100:103], a[20:23], v[64:67]
buffer_load_dwordx4 v7, s[68:71], s25 offen lds
v_mfma_f32_16x16x32_bf16 v[64:67], a[96:99], a[4:7], v[64:67]
ds_read_b64_tr_b16 a[92:93], v13 offset:8704
v_mfma_f32_16x16x32_bf16 v[72:75], a[96:99], a[8:11], v[72:75]
ds_read_b64_tr_b16 a[94:95], v13 offset:9728
v_mfma_f32_16x16x32_bf16 v[72:75], a[100:103], a[24:27], v[72:75]
ds_read_b128 a[44:47], v8 offset:38912
v_mfma_f32_16x16x32_bf16 v[80:83], a[100:103], a[28:31], v[80:83]
ds_read_b128 a[60:63], v9 offset:38912
v_mfma_f32_16x16x32_bf16 v[80:83], a[96:99], a[12:15], v[80:83]
v_mfma_f32_16x16x32_bf16 v[84:87], a[104:107], a[12:15], v[84:87]
ds_read_b64_tr_b16 a[96:97], v12 offset:768
s_add_u32 m0, s18, 0x6000
v_mfma_f32_16x16x32_bf16 v[84:87], a[108:111], a[28:31], v[84:87]
buffer_load_dwordx4 v7, s[68:71], s26 offen lds
v_mfma_f32_16x16x32_bf16 v[76:79], a[108:111], a[24:27], v[76:79]
ds_read_b64_tr_b16 a[98:99], v12 offset:1792
v_lshl_add_u32 v5, s42, 19, v5
v_mfma_f32_16x16x32_bf16 v[76:79], a[104:107], a[8:11], v[76:79]
ds_read_b64_tr_b16 a[100:101], v12 offset:8960
v_lshl_add_u32 v6, s42, 19, v6
v_mfma_f32_16x16x32_bf16 v[68:71], a[104:107], a[4:7], v[68:71]
ds_read_b64_tr_b16 a[102:103], v12 offset:9984
v_lshl_add_u32 v7, s42, 18, v7
v_mfma_f32_16x16x32_bf16 v[68:71], a[108:111], a[20:23], v[68:71]
v_lshl_add_u32 v7, s42, 17, v7
v_mfma_f32_16x16x32_bf16 v[60:63], a[108:111], a[16:19], v[60:63]
v_mfma_f32_16x16x32_bf16 v[60:63], a[104:107], a[0:3], v[60:63]
s_add_u32 m0, s16, 0x8000
s_waitcnt lgkmcnt(4)
s_waitcnt lgkmcnt(6)
v_mfma_f32_16x16x32_bf16 v[88:91], a[80:83], a[0:3], v[88:91]
buffer_load_dwordx4 v22, s[44:47], s20 offen lds
v_mfma_f32_16x16x32_bf16 v[88:91], a[84:87], a[16:19], v[88:91]
ds_read_b64_tr_b16 a[104:105], v13 offset:768
v_mfma_f32_16x16x32_bf16 v[96:99], a[84:87], a[20:23], v[96:99]
ds_read_b64_tr_b16 a[106:107], v13 offset:1792
v_mfma_f32_16x16x32_bf16 v[96:99], a[80:83], a[4:7], v[96:99]
ds_read_b64_tr_b16 a[108:109], v13 offset:8960
v_mfma_f32_16x16x32_bf16 v[104:107], a[80:83], a[8:11], v[104:107]
ds_read_b64_tr_b16 a[110:111], v13 offset:9984
s_add_u32 m0, s16, 0x8400
v_mfma_f32_16x16x32_bf16 v[104:107], a[84:87], a[24:27], v[104:107]
buffer_load_dwordx4 v23, s[44:47], s20 offen lds
v_mfma_f32_16x16x32_bf16 v[112:115], a[84:87], a[28:31], v[112:115]
v_mfma_f32_16x16x32_bf16 v[112:115], a[80:83], a[12:15], v[112:115]
v_mfma_f32_16x16x32_bf16 v[116:119], a[88:91], a[12:15], v[116:119]
ds_read_b64_tr_b16 a[80:81], v14 offset:0
v_mfma_f32_16x16x32_bf16 v[116:119], a[92:95], a[28:31], v[116:119]
ds_read_b64_tr_b16 a[82:83], v14 offset:256
v_mfma_f32_16x16x32_bf16 v[108:111], a[92:95], a[24:27], v[108:111]
ds_read_b64_tr_b16 a[84:85], v14 offset:2048
s_add_u32 m0, s16, 0x8800
v_mfma_f32_16x16x32_bf16 v[108:111], a[88:91], a[8:11], v[108:111]
buffer_load_dwordx4 v22, s[44:47], s21 offen lds
v_mfma_f32_16x16x32_bf16 v[100:103], a[88:91], a[4:7], v[100:103]
ds_read_b64_tr_b16 a[86:87], v14 offset:2304
v_mfma_f32_16x16x32_bf16 v[100:103], a[92:95], a[20:23], v[100:103]
v_mfma_f32_16x16x32_bf16 v[92:95], a[92:95], a[16:19], v[92:95]
v_mfma_f32_16x16x32_bf16 v[92:95], a[88:91], a[0:3], v[92:95]
s_add_u32 s8, s28, 0x5400
s_waitcnt lgkmcnt(4)
v_mfma_f32_16x16x32_bf16 v[120:123], a[96:99], a[0:3], v[120:123]
buffer_store_dwordx4 a[112:115], v16, s[88:91], s8 offen sc1
v_mfma_f32_16x16x32_bf16 v[120:123], a[100:103], a[16:19], v[120:123]
ds_read_b64_tr_b16 a[88:89], v15 offset:0
v_mfma_f32_16x16x32_bf16 v[128:131], a[100:103], a[20:23], v[128:131]
ds_read_b64_tr_b16 a[90:91], v15 offset:256
v_mfma_f32_16x16x32_bf16 v[128:131], a[96:99], a[4:7], v[128:131]
ds_read_b64_tr_b16 a[92:93], v15 offset:2048
v_mfma_f32_16x16x32_bf16 v[136:139], a[96:99], a[8:11], v[136:139]
ds_read_b64_tr_b16 a[94:95], v15 offset:2304
v_mfma_f32_16x16x32_bf16 v[136:139], a[100:103], a[24:27], v[136:139]
s_add_u32 m0, s16, 0x8c00
v_mfma_f32_16x16x32_bf16 v[144:147], a[100:103], a[28:31], v[144:147]
buffer_load_dwordx4 v23, s[44:47], s21 offen lds
v_mfma_f32_16x16x32_bf16 v[144:147], a[96:99], a[12:15], v[144:147]
v_mfma_f32_16x16x32_bf16 v[148:151], a[104:107], a[12:15], v[148:151]
ds_read_b64_tr_b16 a[96:97], v14 offset:4096
v_mfma_f32_16x16x32_bf16 v[148:151], a[108:111], a[28:31], v[148:151]
ds_read_b64_tr_b16 a[98:99], v14 offset:4352
v_mfma_f32_16x16x32_bf16 v[140:143], a[108:111], a[24:27], v[140:143]
ds_read_b64_tr_b16 a[100:101], v14 offset:6144
v_mfma_f32_16x16x32_bf16 v[140:143], a[104:107], a[8:11], v[140:143]
ds_read_b64_tr_b16 a[102:103], v14 offset:6400
s_add_u32 m0, s16, 0x9000
v_mfma_f32_16x16x32_bf16 v[132:135], a[104:107], a[4:7], v[132:135]
buffer_load_dwordx4 v22, s[44:47], s22 offen lds
v_mfma_f32_16x16x32_bf16 v[132:135], a[108:111], a[20:23], v[132:135]
v_mfma_f32_16x16x32_bf16 v[124:127], a[108:111], a[16:19], v[124:127]
v_mfma_f32_16x16x32_bf16 v[124:127], a[104:107], a[0:3], v[124:127]
s_waitcnt lgkmcnt(4)
v_mfma_f32_16x16x32_bf16 v[152:155], a[80:83], a[0:3], v[152:155]
ds_read_b64_tr_b16 a[104:105], v15 offset:4096
s_add_u32 m0, s16, 0x9400
v_mfma_f32_16x16x32_bf16 v[152:155], a[84:87], a[16:19], v[152:155]
buffer_load_dwordx4 v23, s[44:47], s22 offen lds
v_mfma_f32_16x16x32_bf16 v[160:163], a[84:87], a[20:23], v[160:163]
ds_read_b64_tr_b16 a[106:107], v15 offset:4352
v_mfma_f32_16x16x32_bf16 v[160:163], a[80:83], a[4:7], v[160:163]
ds_read_b64_tr_b16 a[108:109], v15 offset:6144
v_mfma_f32_16x16x32_bf16 v[168:171], a[80:83], a[8:11], v[168:171]
ds_read_b64_tr_b16 a[110:111], v15 offset:6400
v_mfma_f32_16x16x32_bf16 v[168:171], a[84:87], a[24:27], v[168:171]
v_mfma_f32_16x16x32_bf16 v[176:179], a[84:87], a[28:31], v[176:179]
s_add_u32 m0, s16, 0x9800
v_mfma_f32_16x16x32_bf16 v[176:179], a[80:83], a[12:15], v[176:179]
buffer_load_dwordx4 v22, s[44:47], s23 offen lds
v_mfma_f32_16x16x32_bf16 v[180:183], a[88:91], a[12:15], v[180:183]
ds_read_b64_tr_b16 a[80:81], v14 offset:8192
v_mfma_f32_16x16x32_bf16 v[180:183], a[92:95], a[28:31], v[180:183]
ds_read_b64_tr_b16 a[82:83], v14 offset:8448
v_mfma_f32_16x16x32_bf16 v[172:175], a[92:95], a[24:27], v[172:175]
ds_read_b64_tr_b16 a[84:85], v14 offset:10240
v_mfma_f32_16x16x32_bf16 v[172:175], a[88:91], a[8:11], v[172:175]
ds_read_b64_tr_b16 a[86:87], v14 offset:10496
s_add_u32 m0, s16, 0x9c00
v_mfma_f32_16x16x32_bf16 v[164:167], a[88:91], a[4:7], v[164:167]
buffer_load_dwordx4 v23, s[44:47], s23 offen lds
v_mfma_f32_16x16x32_bf16 v[164:167], a[92:95], a[20:23], v[164:167]
v_lshl_add_u32 v22, s42, 7, v22
v_lshl_add_u32 v23, s42, 7, v23
v_mfma_f32_16x16x32_bf16 v[156:159], a[92:95], a[16:19], v[156:159]
v_mfma_f32_16x16x32_bf16 v[156:159], a[88:91], a[0:3], v[156:159]
s_waitcnt lgkmcnt(4)
v_mfma_f32_16x16x32_bf16 v[184:187], a[96:99], a[0:3], v[184:187]
ds_read_b64_tr_b16 a[88:89], v15 offset:8192
v_mfma_f32_16x16x32_bf16 v[184:187], a[100:103], a[16:19], v[184:187]
ds_read_b64_tr_b16 a[90:91], v15 offset:8448
s_add_u32 s8, s28, 0x9400
v_mfma_f32_16x16x32_bf16 v[192:195], a[100:103], a[20:23], v[192:195]
buffer_store_dwordx4 a[116:119], v16, s[88:91], s8 offen sc1
v_mfma_f32_16x16x32_bf16 v[192:195], a[96:99], a[4:7], v[192:195]
ds_read_b64_tr_b16 a[92:93], v15 offset:10240
v_mfma_f32_16x16x32_bf16 v[200:203], a[96:99], a[8:11], v[200:203]
ds_read_b64_tr_b16 a[94:95], v15 offset:10496
v_add_u32 v12, 0x8000, v12
v_mfma_f32_16x16x32_bf16 v[200:203], a[100:103], a[24:27], v[200:203]
v_add_u32 v13, 0x8000, v13
v_add_u32 v14, 0x8000, v14
v_mfma_f32_16x16x32_bf16 v[208:211], a[100:103], a[28:31], v[208:211]
v_add_u32 v15, 0x8000, v15
v_mfma_f32_16x16x32_bf16 v[208:211], a[96:99], a[12:15], v[208:211]
v_mfma_f32_16x16x32_bf16 v[212:215], a[104:107], a[12:15], v[212:215]
s_waitcnt vmcnt(28) lgkmcnt(0)
v_mfma_f32_16x16x32_bf16 v[212:215], a[108:111], a[28:31], v[212:215]
s_barrier
s_add_u32 m0, s17, 0x8000
v_mfma_f32_16x16x32_bf16 v[204:207], a[108:111], a[24:27], v[204:207]
buffer_load_dwordx4 v5, s[52:55], 0 offen lds
v_mfma_f32_16x16x32_bf16 v[204:207], a[104:107], a[8:11], v[204:207]
ds_read_b64_tr_b16 a[96:97], v12 offset:0
v_mfma_f32_16x16x32_bf16 v[196:199], a[104:107], a[4:7], v[196:199]
ds_read_b64_tr_b16 a[98:99], v12 offset:1024
v_mfma_f32_16x16x32_bf16 v[196:199], a[108:111], a[20:23], v[196:199]
ds_read_b64_tr_b16 a[100:101], v12 offset:8192
v_mfma_f32_16x16x32_bf16 v[188:191], a[108:111], a[16:19], v[188:191]
ds_read_b64_tr_b16 a[102:103], v12 offset:9216
v_mfma_f32_16x16x32_bf16 v[188:191], a[104:107], a[0:3], v[188:191]
s_add_u32 m0, s17, 0x8400
s_waitcnt lgkmcnt(4)
v_mfma_f32_16x16x32_bf16 v[216:219], a[0:3], a[80:83], v[216:219]
buffer_load_dwordx4 v5, s[52:55], s13 offen lds
v_mfma_f32_16x16x32_bf16 v[216:219], a[16:19], a[84:87], v[216:219]
ds_read_b64_tr_b16 a[104:105], v13 offset:0
v_mfma_f32_16x16x32_bf16 v[224:227], a[20:23], a[84:87], v[224:227]
ds_read_b64_tr_b16 a[106:107], v13 offset:1024
v_mfma_f32_16x16x32_bf16 v[224:227], a[4:7], a[80:83], v[224:227]
ds_read_b64_tr_b16 a[108:109], v13 offset:8192
v_mfma_f32_16x16x32_bf16 v[232:235], a[8:11], a[80:83], v[232:235]
ds_read_b64_tr_b16 a[110:111], v13 offset:9216
v_mfma_f32_16x16x32_bf16 v[232:235], a[24:27], a[84:87], v[232:235]
s_add_u32 m0, s17, 0x8800
v_mfma_f32_16x16x32_bf16 v[240:243], a[28:31], a[84:87], v[240:243]
buffer_load_dwordx4 v6, s[52:55], 0 offen lds
v_mfma_f32_16x16x32_bf16 v[240:243], a[12:15], a[80:83], v[240:243]
v_mfma_f32_16x16x32_bf16 v[244:247], a[12:15], a[88:91], v[244:247]
ds_read_b64_tr_b16 a[80:81], v12 offset:256
v_mfma_f32_16x16x32_bf16 v[244:247], a[28:31], a[92:95], v[244:247]
ds_read_b64_tr_b16 a[82:83], v12 offset:1280
v_mfma_f32_16x16x32_bf16 v[236:239], a[24:27], a[92:95], v[236:239]
ds_read_b64_tr_b16 a[84:85], v12 offset:8448
v_mfma_f32_16x16x32_bf16 v[236:239], a[8:11], a[88:91], v[236:239]
ds_read_b64_tr_b16 a[86:87], v12 offset:9472
s_add_u32 s8, s28, 0x5800
v_mfma_f32_16x16x32_bf16 v[228:231], a[4:7], a[88:91], v[228:231]
buffer_store_dwordx4 a[124:127], v16, s[88:91], s8 offen sc1
v_mfma_f32_16x16x32_bf16 v[228:231], a[20:23], a[92:95], v[228:231]
v_mfma_f32_16x16x32_bf16 v[220:223], a[16:19], a[92:95], v[220:223]
v_mfma_f32_16x16x32_bf16 v[220:223], a[0:3], a[88:91], v[220:223]
s_waitcnt lgkmcnt(4)
L_S17:
v_mfma_f32_16x16x32_bf16 v[24:27], a[96:99], a[32:35], v[24:27]
ds_read_b64_tr_b16 a[88:89], v13 offset:256
s_waitcnt vmcnt(23)
v_mfma_f32_16x16x32_bf16 v[24:27], a[100:103], a[48:51], v[24:27]
ds_read_b64_tr_b16 a[90:91], v13 offset:1280
s_add_u32 m0, s17, 0x8c00
v_mfma_f32_16x16x32_bf16 v[32:35], a[100:103], a[52:55], v[32:35]
buffer_load_dwordx4 v6, s[52:55], s13 offen lds
v_mfma_f32_16x16x32_bf16 v[32:35], a[96:99], a[36:39], v[32:35]
ds_read_b64_tr_b16 a[92:93], v13 offset:8448
v_mfma_f32_16x16x32_bf16 v[40:43], a[96:99], a[40:43], v[40:43]
ds_read_b64_tr_b16 a[94:95], v13 offset:9472
v_mfma_f32_16x16x32_bf16 v[40:43], a[100:103], a[56:59], v[40:43]
ds_read_b128 a[0:3], v8 offset:0
v_mfma_f32_16x16x32_bf16 v[48:51], a[100:103], a[60:63], v[48:51]
ds_read_b128 a[16:19], v9 offset:0
v_mfma_f32_16x16x32_bf16 v[48:51], a[96:99], a[44:47], v[48:51]
ds_read_b128 a[4:7], v8 offset:2048
s_add_u32 m0, s18, 0xc000
v_mfma_f32_16x16x32_bf16 v[52:55], a[104:107], a[44:47], v[52:55]
buffer_load_dwordx4 v7, s[68:71], 0 offen lds
v_mfma_f32_16x16x32_bf16 v[52:55], a[108:111], a[60:63], v[52:55]
ds_read_b64_tr_b16 a[96:97], v12 offset:512
v_mfma_f32_16x16x32_bf16 v[44:47], a[108:111], a[56:59], v[44:47]
ds_read_b64_tr_b16 a[98:99], v12 offset:1536
v_mfma_f32_16x16x32_bf16 v[44:47], a[104:107], a[40:43], v[44:47]
ds_read_b64_tr_b16 a[100:101], v12 offset:8704
v_mfma_f32_16x16x32_bf16 v[36:39], a[104:107], a[36:39], v[36:39]
ds_read_b64_tr_b16 a[102:103], v12 offset:9728
v_mfma_f32_16x16x32_bf16 v[36:39], a[108:111], a[52:55], v[36:39]
ds_read_b128 a[20:23], v9 offset:2048
s_add_u32 m0, s18, 0xd000
v_mfma_f32_16x16x32_bf16 v[28:31], a[108:111], a[48:51], v[28:31]
buffer_load_dwordx4 v7, s[68:71], s25 offen lds
v_mfma_f32_16x16x32_bf16 v[28:31], a[104:107], a[32:35], v[28:31]
ds_read_b128 a[8:11], v8 offset:4096
s_waitcnt lgkmcnt(9)
v_mfma_f32_16x16x32_bf16 v[56:59], a[80:83], a[32:35], v[56:59]
ds_read_b64_tr_b16 a[104:105], v13 offset:512
v_mfma_f32_16x16x32_bf16 v[56:59], a[84:87], a[48:51], v[56:59]
ds_read_b64_tr_b16 a[106:107], v13 offset:1536
v_mfma_f32_16x16x32_bf16 v[64:67], a[84:87], a[52:55], v[64:67]
ds_read_b64_tr_b16 a[108:109], v13 offset:8704
v_mfma_f32_16x16x32_bf16 v[64:67], a[80:83], a[36:39], v[64:67]
ds_read_b64_tr_b16 a[110:111], v13 offset:9728
s_add_u32 m0, s18, 0xe000
v_mfma_f32_16x16x32_bf16 v[72:75], a[80:83], a[40:43], v[72:75]
buffer_load_dwordx4 v7, s[68:71], s26 offen lds
v_mfma_f32_16x16x32_bf16 v[72:75], a[84:87], a[56:59], v[72:75]
ds_read_b128 a[24:27], v9 offset:4096
v_lshl_add_u32 v5, s42, 19, v5
v_mfma_f32_16x16x32_bf16 v[80:83], a[84:87], a[60:63], v[80:83]
ds_read_b128 a[12:15], v8 offset:6144
v_lshl_add_u32 v6, s42, 19, v6
v_mfma_f32_16x16x32_bf16 v[80:83], a[80:83], a[44:47], v[80:83]
ds_read_b128 a[28:31], v9 offset:6144
v_lshl_add_u32 v7, s42, 18, v7
v_mfma_f32_16x16x32_bf16 v[84:87], a[88:91], a[44:47], v[84:87]
ds_read_b64_tr_b16 a[80:81], v12 offset:768
v_lshl_add_u32 v7, s42, 17, v7
v_mfma_f32_16x16x32_bf16 v[84:87], a[92:95], a[60:63], v[84:87]
ds_read_b64_tr_b16 a[82:83], v12 offset:1792
s_add_u32 s8, s28, 0x9800
v_mfma_f32_16x16x32_bf16 v[76:79], a[92:95], a[56:59], v[76:79]
buffer_store_dwordx4 a[232:235], v16, s[88:91], s8 offen sc1
v_mfma_f32_16x16x32_bf16 v[76:79], a[88:91], a[40:43], v[76:79]
ds_read_b64_tr_b16 a[84:85], v12 offset:8960
v_mfma_f32_16x16x32_bf16 v[68:71], a[88:91], a[36:39], v[68:71]
ds_read_b64_tr_b16 a[86:87], v12 offset:9984
v_mfma_f32_16x16x32_bf16 v[68:71], a[92:95], a[52:55], v[68:71]
v_mfma_f32_16x16x32_bf16 v[60:63], a[92:95], a[48:51], v[60:63]
v_mfma_f32_16x16x32_bf16 v[60:63], a[88:91], a[32:35], v[60:63]
s_add_u32 m0, s16, 0x0
s_waitcnt lgkmcnt(4)
s_waitcnt lgkmcnt(7)
v_mfma_f32_16x16x32_bf16 v[88:91], a[96:99], a[32:35], v[88:91]
buffer_load_dwordx4 v22, s[44:47], s20 offen lds
v_mfma_f32_16x16x32_bf16 v[88:91], a[100:103], a[48:51], v[88:91]
ds_read_b64_tr_b16 a[88:89], v13 offset:768
v_mfma_f32_16x16x32_bf16 v[96:99], a[100:103], a[52:55], v[96:99]
ds_read_b64_tr_b16 a[90:91], v13 offset:1792
v_mfma_f32_16x16x32_bf16 v[96:99], a[96:99], a[36:39], v[96:99]
ds_read_b64_tr_b16 a[92:93], v13 offset:8960
v_mfma_f32_16x16x32_bf16 v[104:107], a[96:99], a[40:43], v[104:107]
ds_read_b64_tr_b16 a[94:95], v13 offset:9984
s_add_u32 m0, s16, 0x400
v_mfma_f32_16x16x32_bf16 v[104:107], a[100:103], a[56:59], v[104:107]
buffer_load_dwordx4 v23, s[44:47], s20 offen lds
v_mfma_f32_16x16x32_bf16 v[112:115], a[100:103], a[60:63], v[112:115]
v_mfma_f32_16x16x32_bf16 v[112:115], a[96:99], a[44:47], v[112:115]
v_mfma_f32_16x16x32_bf16 v[116:119], a[104:107], a[44:47], v[116:119]
ds_read_b64_tr_b16 a[96:97], v14 offset:0
v_mfma_f32_16x16x32_bf16 v[116:119], a[108:111], a[60:63], v[116:119]
ds_read_b64_tr_b16 a[98:99], v14 offset:256
v_mfma_f32_16x16x32_bf16 v[108:111], a[108:111], a[56:59], v[108:111]
ds_read_b64_tr_b16 a[100:101], v14 offset:2048
s_add_u32 m0, s16, 0x800
v_mfma_f32_16x16x32_bf16 v[108:111], a[104:107], a[40:43], v[108:111]
buffer_load_dwordx4 v22, s[44:47], s21 offen lds
v_mfma_f32_16x16x32_bf16 v[100:103], a[104:107], a[36:39], v[100:103]
ds_read_b64_tr_b16 a[102:103], v14 offset:2304
v_mfma_f32_16x16x32_bf16 v[100:103], a[108:111], a[52:55], v[100:103]
v_mfma_f32_16x16x32_bf16 v[92:95], a[108:111], a[48:51], v[92:95]
v_mfma_f32_16x16x32_bf16 v[92:95], a[104:107], a[32:35], v[92:95]
s_add_u32 m0, s16, 0xc00
s_waitcnt lgkmcnt(4)
v_mfma_f32_16x16x32_bf16 v[120:123], a[80:83], a[32:35], v[120:123]
buffer_load_dwordx4 v23, s[44:47], s21 offen lds
v_mfma_f32_16x16x32_bf16 v[120:123], a[84:87], a[48:51], v[120:123]
ds_read_b64_tr_b16 a[104:105], v15 offset:0
v_mfma_f32_16x16x32_bf16 v[128:131], a[84:87], a[52:55], v[128:131]
ds_read_b64_tr_b16 a[106:107], v15 offset:256
v_mfma_f32_16x16x32_bf16 v[128:131], a[80:83], a[36:39], v[128:131]
ds_read_b64_tr_b16 a[108:109], v15 offset:2048
v_mfma_f32_16x16x32_bf16 v[136:139], a[80:83], a[40:43], v[136:139]
ds_read_b64_tr_b16 a[110:111], v15 offset:2304
v_mfma_f32_16x16x32_bf16 v[136:139], a[84:87], a[56:59], v[136:139]
s_add_u32 s8, s28, 0x5c00
v_mfma_f32_16x16x32_bf16 v[144:147], a[84:87], a[60:63], v[144:147]
buffer_store_dwordx4 a[240:243], v16, s[88:91], s8 offen sc1
v_mfma_f32_16x16x32_bf16 v[144:147], a[80:83], a[44:47], v[144:147]
v_mfma_f32_16x16x32_bf16 v[148:151], a[88:91], a[44:47], v[148:151]
ds_read_b64_tr_b16 a[80:81], v14 offset:4096
v_mfma_f32_16x16x32_bf16 v[148:151], a[92:95], a[60:63], v[148:151]
ds_read_b64_tr_b16 a[82:83], v14 offset:4352
v_mfma_f32_16x16x32_bf16 v[140:143], a[92:95], a[56:59], v[140:143]
ds_read_b64_tr_b16 a[84:85], v14 offset:6144
v_mfma_f32_16x16x32_bf16 v[140:143], a[88:91], a[40:43], v[140:143]
ds_read_b64_tr_b16 a[86:87], v14 offset:6400
s_add_u32 m0, s16, 0x1000
v_mfma_f32_16x16x32_bf16 v[132:135], a[88:91], a[36:39], v[132:135]
buffer_load_dwordx4 v22, s[44:47], s22 offen lds
v_mfma_f32_16x16x32_bf16 v[132:135], a[92:95], a[52:55], v[132:135]
v_mfma_f32_16x16x32_bf16 v[124:127], a[92:95], a[48:51], v[124:127]
v_mfma_f32_16x16x32_bf16 v[124:127], a[88:91], a[32:35], v[124:127]
s_waitcnt lgkmcnt(4)
v_mfma_f32_16x16x32_bf16 v[152:155], a[96:99], a[32:35], v[152:155]
ds_read_b64_tr_b16 a[88:89], v15 offset:4096
s_add_u32 m0, s16, 0x1400
v_mfma_f32_16x16x32_bf16 v[152:155], a[100:103], a[48:51], v[152:155]
buffer_load_dwordx4 v23, s[44:47], s22 offen lds
v_mfma_f32_16x16x32_bf16 v[160:163], a[100:103], a[52:55], v[160:163]
ds_read_b64_tr_b16 a[90:91], v15 offset:4352
v_mfma_f32_16x16x32_bf16 v[160:163], a[96:99], a[36:39], v[160:163]
ds_read_b64_tr_b16 a[92:93], v15 offset:6144
v_mfma_f32_16x16x32_bf16 v[168:171], a[96:99], a[40:43], v[168:171]
ds_read_b64_tr_b16 a[94:95], v15 offset:6400
v_mfma_f32_16x16x32_bf16 v[168:171], a[100:103], a[56:59], v[168:171]
v_mfma_f32_16x16x32_bf16 v[176:179], a[100:103], a[60:63], v[176:179]
s_add_u32 m0, s16, 0x1800
v_mfma_f32_16x16x32_bf16 v[176:179], a[96:99], a[44:47], v[176:179]
buffer_load_dwordx4 v22, s[44:47], s23 offen lds
v_mfma_f32_16x16x32_bf16 v[180:183], a[104:107], a[44:47], v[180:183]
ds_read_b64_tr_b16 a[96:97], v14 offset:8192
v_mfma_f32_16x16x32_bf16 v[180:183], a[108:111], a[60:63], v[180:183]
ds_read_b64_tr_b16 a[98:99], v14 offset:8448
v_mfma_f32_16x16x32_bf16 v[172:175], a[108:111], a[56:59], v[172:175]
ds_read_b64_tr_b16 a[100:101], v14 offset:10240
v_mfma_f32_16x16x32_bf16 v[172:175], a[104:107], a[40:43], v[172:175]
ds_read_b64_tr_b16 a[102:103], v14 offset:10496
s_add_u32 m0, s16, 0x1c00
v_mfma_f32_16x16x32_bf16 v[164:167], a[104:107], a[36:39], v[164:167]
buffer_load_dwordx4 v23, s[44:47], s23 offen lds
v_mfma_f32_16x16x32_bf16 v[164:167], a[108:111], a[52:55], v[164:167]
v_lshl_add_u32 v22, s42, 7, v22
v_lshl_add_u32 v23, s42, 7, v23
v_mfma_f32_16x16x32_bf16 v[156:159], a[108:111], a[48:51], v[156:159]
v_mfma_f32_16x16x32_bf16 v[156:159], a[104:107], a[32:35], v[156:159]
s_waitcnt lgkmcnt(4)
v_mfma_f32_16x16x32_bf16 v[184:187], a[80:83], a[32:35], v[184:187]
ds_read_b64_tr_b16 a[104:105], v15 offset:8192
v_mfma_f32_16x16x32_bf16 v[184:187], a[84:87], a[48:51], v[184:187]
ds_read_b64_tr_b16 a[106:107], v15 offset:8448
s_add_u32 s8, s28, 0x9c00
v_mfma_f32_16x16x32_bf16 v[192:195], a[84:87], a[52:55], v[192:195]
buffer_store_dwordx4 a[248:251], v16, s[88:91], s8 offen sc1
v_mfma_f32_16x16x32_bf16 v[192:195], a[80:83], a[36:39], v[192:195]
ds_read_b64_tr_b16 a[108:109], v15 offset:10240
v_mfma_f32_16x16x32_bf16 v[200:203], a[80:83], a[40:43], v[200:203]
ds_read_b64_tr_b16 a[110:111], v15 offset:10496
v_add_u32 v12, 0xffff0000, v12
v_mfma_f32_16x16x32_bf16 v[200:203], a[84:87], a[56:59], v[200:203]
v_add_u32 v13, 0xffff0000, v13
v_add_u32 v14, 0xffff0000, v14
v_mfma_f32_16x16x32_bf16 v[208:211], a[84:87], a[60:63], v[208:211]
v_add_u32 v15, 0xffff0000, v15
v_mfma_f32_16x16x32_bf16 v[208:211], a[80:83], a[44:47], v[208:211]
v_mfma_f32_16x16x32_bf16 v[212:215], a[88:91], a[44:47], v[212:215]
s_waitcnt vmcnt(29) lgkmcnt(0)
v_mfma_f32_16x16x32_bf16 v[212:215], a[92:95], a[60:63], v[212:215]
s_barrier
s_add_u32 m0, s17, 0x10000
v_mfma_f32_16x16x32_bf16 v[204:207], a[92:95], a[56:59], v[204:207]
buffer_load_dwordx4 v5, s[52:55], 0 offen lds
v_mfma_f32_16x16x32_bf16 v[204:207], a[88:91], a[40:43], v[204:207]
ds_read_b64_tr_b16 a[80:81], v12 offset:0
v_mfma_f32_16x16x32_bf16 v[196:199], a[88:91], a[36:39], v[196:199]
ds_read_b64_tr_b16 a[82:83], v12 offset:1024
v_mfma_f32_16x16x32_bf16 v[196:199], a[92:95], a[52:55], v[196:199]
ds_read_b64_tr_b16 a[84:85], v12 offset:8192
v_mfma_f32_16x16x32_bf16 v[188:191], a[92:95], a[48:51], v[188:191]
ds_read_b64_tr_b16 a[86:87], v12 offset:9216
v_mfma_f32_16x16x32_bf16 v[188:191], a[88:91], a[32:35], v[188:191]
s_add_u32 m0, s17, 0x10400
s_waitcnt lgkmcnt(4)
v_mfma_f32_16x16x32_bf16 v[216:219], a[32:35], a[96:99], v[216:219]
buffer_load_dwordx4 v5, s[52:55], s13 offen lds
v_mfma_f32_16x16x32_bf16 v[216:219], a[48:51], a[100:103], v[216:219]
ds_read_b64_tr_b16 a[88:89], v13 offset:0
v_mfma_f32_16x16x32_bf16 v[224:227], a[52:55], a[100:103], v[224:227]
ds_read_b64_tr_b16 a[90:91], v13 offset:1024
v_mfma_f32_16x16x32_bf16 v[224:227], a[36:39], a[96:99], v[224:227]
ds_read_b64_tr_b16 a[92:93], v13 offset:8192
v_mfma_f32_16x16x32_bf16 v[232:235], a[40:43], a[96:99], v[232:235]
ds_read_b64_tr_b16 a[94:95], v13 offset:9216
v_mfma_f32_16x16x32_bf16 v[232:235], a[56:59], a[100:103], v[232:235]
v_mfma_f32_16x16x32_bf16 v[240:243], a[60:63], a[100:103], v[240:243]
s_add_u32 m0, s17, 0x10800
v_mfma_f32_16x16x32_bf16 v[240:243], a[44:47], a[96:99], v[240:243]
buffer_load_dwordx4 v6, s[52:55], 0 offen lds
v_mfma_f32_16x16x32_bf16 v[244:247], a[44:47], a[104:107], v[244:247]
ds_read_b64_tr_b16 a[96:97], v12 offset:256
v_mfma_f32_16x16x32_bf16 v[244:247], a[60:63], a[108:111], v[244:247]
ds_read_b64_tr_b16 a[98:99], v12 offset:1280
v_mfma_f32_16x16x32_bf16 v[236:239], a[56:59], a[108:111], v[236:239]
ds_read_b64_tr_b16 a[100:101], v12 offset:8448
v_mfma_f32_16x16x32_bf16 v[236:239], a[40:43], a[104:107], v[236:239]
ds_read_b64_tr_b16 a[102:103], v12 offset:9472
v_mfma_f32_16x16x32_bf16 v[228:231], a[36:39], a[104:107], v[228:231]
v_mfma_f32_16x16x32_bf16 v[228:231], a[52:55], a[108:111], v[228:231]
s_add_u32 m0, s17, 0x10c00
v_mfma_f32_16x16x32_bf16 v[220:223], a[48:51], a[108:111], v[220:223]
buffer_load_dwordx4 v6, s[52:55], s13 offen lds
v_mfma_f32_16x16x32_bf16 v[220:223], a[32:35], a[104:107], v[220:223]
s_waitcnt lgkmcnt(4)
L_S18:
v_mfma_f32_16x16x32_bf16 v[24:27], a[80:83], a[0:3], v[24:27]
ds_read_b64_tr_b16 a[104:105], v13 offset:256
s_waitcnt vmcnt(24)
v_mfma_f32_16x16x32_bf16 v[24:27], a[84:87], a[16:19], v[24:27]
ds_read_b64_tr_b16 a[106:107], v13 offset:1280
L_padA9:
s_cmp_eq_u32 s95, 1
s_cbranch_scc1 L_hopA_ret
v_mfma_f32_16x16x32_bf16 v[32:35], a[84:87], a[20:23], v[32:35]
ds_read_b64_tr_b16 a[108:109], v13 offset:8448
v_mfma_f32_16x16x32_bf16 v[32:35], a[80:83], a[4:7], v[32:35]
ds_read_b64_tr_b16 a[110:111], v13 offset:9472
v_mfma_f32_16x16x32_bf16 v[40:43], a[80:83], a[8:11], v[40:43]
ds_read_b128 a[32:35], v8 offset:32768
s_add_u32 m0, s18, 0x14000
v_mfma_f32_16x16x32_bf16 v[40:43], a[84:87], a[24:27], v[40:43]
buffer_load_dwordx4 v7, s[68:71], 0 offen lds
v_mfma_f32_16x16x32_bf16 v[48:51], a[84:87], a[28:31], v[48:51]
ds_read_b128 a[48:51], v9 offset:32768
v_mfma_f32_16x16x32_bf16 v[48:51], a[80:83], a[12:15], v[48:51]
ds_read_b128 a[36:39], v8 offset:34816
v_mfma_f32_16x16x32_bf16 v[52:55], a[88:91], a[12:15], v[52:55]
ds_read_b64_tr_b16 a[80:81], v12 offset:512
v_mfma_f32_16x16x32_bf16 v[52:55], a[92:95], a[28:31], v[52:55]
ds_read_b64_tr_b16 a[82:83], v12 offset:1536
v_mfma_f32_16x16x32_bf16 v[44:47], a[92:95], a[24:27], v[44:47]
ds_read_b64_tr_b16 a[84:85], v12 offset:8704
v_mfma_f32_16x16x32_bf16 v[44:47], a[88:91], a[8:11], v[44:47]
buffer_load_dwordx4 a[128:131], v16, s[44:47], s100 offen offset:0
v_mfma_f32_16x16x32_bf16 v[36:39], a[88:91], a[4:7], v[36:39]
ds_read_b64_tr_b16 a[86:87], v12 offset:9728
v_mfma_f32_16x16x32_bf16 v[36:39], a[92:95], a[20:23], v[36:39]
ds_read_b128 a[52:55], v9 offset:34816
v_mfma_f32_16x16x32_bf16 v[28:31], a[92:95], a[16:19], v[28:31]
ds_read_b128 a[40:43], v8 offset:36864
v_mfma_f32_16x16x32_bf16 v[28:31], a[88:91], a[0:3], v[28:31]
ds_read_b128 a[56:59], v9 offset:36864
s_waitcnt lgkmcnt(10)
v_mfma_f32_16x16x32_bf16 v[56:59], a[96:99], a[0:3], v[56:59]
ds_read_b64_tr_b16 a[88:89], v13 offset:512
v_mfma_f32_16x16x32_bf16 v[56:59], a[100:103], a[16:19], v[56:59]
ds_read_b64_tr_b16 a[90:91], v13 offset:1536
s_add_u32 m0, s18, 0x15000
v_mfma_f32_16x16x32_bf16 v[64:67], a[100:103], a[20:23], v[64:67]
buffer_load_dwordx4 v7, s[68:71], s25 offen lds
v_mfma_f32_16x16x32_bf16 v[64:67], a[96:99], a[4:7], v[64:67]
ds_read_b64_tr_b16 a[92:93], v13 offset:8704
v_mfma_f32_16x16x32_bf16 v[72:75], a[96:99], a[8:11], v[72:75]
ds_read_b64_tr_b16 a[94:95], v13 offset:9728
v_mfma_f32_16x16x32_bf16 v[72:75], a[100:103], a[24:27], v[72:75]
ds_read_b128 a[44:47], v8 offset:38912
v_mfma_f32_16x16x32_bf16 v[80:83], a[100:103], a[28:31], v[80:83]
ds_read_b128 a[60:63], v9 offset:38912
v_mfma_f32_16x16x32_bf16 v[80:83], a[96:99], a[12:15], v[80:83]
v_mfma_f32_16x16x32_bf16 v[84:87], a[104:107], a[12:15], v[84:87]
ds_read_b64_tr_b16 a[96:97], v12 offset:768
s_add_u32 m0, s18, 0x16000
v_mfma_f32_16x16x32_bf16 v[84:87], a[108:111], a[28:31], v[84:87]
buffer_load_dwordx4 v7, s[68:71], s26 offen lds
v_mfma_f32_16x16x32_bf16 v[76:79], a[108:111], a[24:27], v[76:79]
ds_read_b64_tr_b16 a[98:99], v12 offset:1792
v_lshl_add_u32 v5, s42, 19, v5
v_mfma_f32_16x16x32_bf16 v[76:79], a[104:107], a[8:11], v[76:79]
ds_read_b64_tr_b16 a[100:101], v12 offset:8960
v_lshl_add_u32 v6, s42, 19, v6
v_mfma_f32_16x16x32_bf16 v[68:71], a[104:107], a[4:7], v[68:71]
ds_read_b64_tr_b16 a[102:103], v12 offset:9984
v_lshl_add_u32 v7, s42, 18, v7
v_mfma_f32_16x16x32_bf16 v[68:71], a[108:111], a[20:23], v[68:71]
v_lshl_add_u32 v7, s42, 17, v7
v_mfma_f32_16x16x32_bf16 v[60:63], a[108:111], a[16:19], v[60:63]
v_mfma_f32_16x16x32_bf16 v[60:63], a[104:107], a[0:3], v[60:63]
s_add_u32 m0, s16, 0x8000
s_waitcnt lgkmcnt(4)
s_waitcnt lgkmcnt(6)
v_mfma_f32_16x16x32_bf16 v[88:91], a[80:83], a[0:3], v[88:91]
buffer_load_dwordx4 v22, s[44:47], s20 offen lds
v_mfma_f32_16x16x32_bf16 v[88:91], a[84:87], a[16:19], v[88:91]
ds_read_b64_tr_b16 a[104:105], v13 offset:768
v_mfma_f32_16x16x32_bf16 v[96:99], a[84:87], a[20:23], v[96:99]
ds_read_b64_tr_b16 a[106:107], v13 offset:1792
v_mfma_f32_16x16x32_bf16 v[96:99], a[80:83], a[4:7], v[96:99]
ds_read_b64_tr_b16 a[108:109], v13 offset:8960
v_mfma_f32_16x16x32_bf16 v[104:107], a[80:83], a[8:11], v[104:107]
ds_read_b64_tr_b16 a[110:111], v13 offset:9984
s_add_u32 m0, s16, 0x8400
v_mfma_f32_16x16x32_bf16 v[104:107], a[84:87], a[24:27], v[104:107]
buffer_load_dwordx4 v23, s[44:47], s20 offen lds
v_mfma_f32_16x16x32_bf16 v[112:115], a[84:87], a[28:31], v[112:115]
v_mfma_f32_16x16x32_bf16 v[112:115], a[80:83], a[12:15], v[112:115]
v_mfma_f32_16x16x32_bf16 v[116:119], a[88:91], a[12:15], v[116:119]
ds_read_b64_tr_b16 a[80:81], v14 offset:0
v_mfma_f32_16x16x32_bf16 v[116:119], a[92:95], a[28:31], v[116:119]
ds_read_b64_tr_b16 a[82:83], v14 offset:256
v_mfma_f32_16x16x32_bf16 v[108:111], a[92:95], a[24:27], v[108:111]
ds_read_b64_tr_b16 a[84:85], v14 offset:2048
s_add_u32 m0, s16, 0x8800
v_mfma_f32_16x16x32_bf16 v[108:111], a[88:91], a[8:11], v[108:111]
buffer_load_dwordx4 v22, s[44:47], s21 offen lds
v_mfma_f32_16x16x32_bf16 v[100:103], a[88:91], a[4:7], v[100:103]
ds_read_b64_tr_b16 a[86:87], v14 offset:2304
v_mfma_f32_16x16x32_bf16 v[100:103], a[92:95], a[20:23], v[100:103]
v_mfma_f32_16x16x32_bf16 v[92:95], a[92:95], a[16:19], v[92:95]
v_mfma_f32_16x16x32_bf16 v[92:95], a[88:91], a[0:3], v[92:95]
s_waitcnt lgkmcnt(4)
v_mfma_f32_16x16x32_bf16 v[120:123], a[96:99], a[0:3], v[120:123]
buffer_load_dwordx4 a[132:135], v16, s[44:47], s100 offen offset:1024
v_mfma_f32_16x16x32_bf16 v[120:123], a[100:103], a[16:19], v[120:123]
ds_read_b64_tr_b16 a[88:89], v15 offset:0
v_mfma_f32_16x16x32_bf16 v[128:131], a[100:103], a[20:23], v[128:131]
ds_read_b64_tr_b16 a[90:91], v15 offset:256
v_mfma_f32_16x16x32_bf16 v[128:131], a[96:99], a[4:7], v[128:131]
ds_read_b64_tr_b16 a[92:93], v15 offset:2048
v_mfma_f32_16x16x32_bf16 v[136:139], a[96:99], a[8:11], v[136:139]
ds_read_b64_tr_b16 a[94:95], v15 offset:2304
v_mfma_f32_16x16x32_bf16 v[136:139], a[100:103], a[24:27], v[136:139]
s_add_u32 m0, s16, 0x8c00
v_mfma_f32_16x16x32_bf16 v[144:147], a[100:103], a[28:31], v[144:147]
buffer_load_dwordx4 v23, s[44:47], s21 offen lds
v_mfma_f32_16x16x32_bf16 v[144:147], a[96:99], a[12:15], v[144:147]
v_mfma_f32_16x16x32_bf16 v[148:151], a[104:107], a[12:15], v[148:151]
ds_read_b64_tr_b16 a[96:97], v14 offset:4096
v_mfma_f32_16x16x32_bf16 v[148:151], a[108:111], a[28:31], v[148:151]
ds_read_b64_tr_b16 a[98:99], v14 offset:4352
v_mfma_f32_16x16x32_bf16 v[140:143], a[108:111], a[24:27], v[140:143]
ds_read_b64_tr_b16 a[100:101], v14 offset:6144
v_mfma_f32_16x16x32_bf16 v[140:143], a[104:107], a[8:11], v[140:143]
ds_read_b64_tr_b16 a[102:103], v14 offset:6400
s_add_u32 m0, s16, 0x9000
v_mfma_f32_16x16x32_bf16 v[132:135], a[104:107], a[4:7], v[132:135]
buffer_load_dwordx4 v22, s[44:47], s22 offen lds
v_mfma_f32_16x16x32_bf16 v[132:135], a[108:111], a[20:23], v[132:135]
v_mfma_f32_16x16x32_bf16 v[124:127], a[108:111], a[16:19], v[124:127]
v_mfma_f32_16x16x32_bf16 v[124:127], a[104:107], a[0:3], v[124:127]
s_waitcnt lgkmcnt(4)
v_mfma_f32_16x16x32_bf16 v[152:155], a[80:83], a[0:3], v[152:155]
ds_read_b64_tr_b16 a[104:105], v15 offset:4096
s_add_u32 m0, s16, 0x9400
v_mfma_f32_16x16x32_bf16 v[152:155], a[84:87], a[16:19], v[152:155]
buffer_load_dwordx4 v23, s[44:47], s22 offen lds
v_mfma_f32_16x16x32_bf16 v[160:163], a[84:87], a[20:23], v[160:163]
ds_read_b64_tr_b16 a[106:107], v15 offset:4352
v_mfma_f32_16x16x32_bf16 v[160:163], a[80:83], a[4:7], v[160:163]
ds_read_b64_tr_b16 a[108:109], v15 offset:6144
v_mfma_f32_16x16x32_bf16 v[168:171], a[80:83], a[8:11], v[168:171]
ds_read_b64_tr_b16 a[110:111], v15 offset:6400
v_mfma_f32_16x16x32_bf16 v[168:171], a[84:87], a[24:27], v[168:171]
v_mfma_f32_16x16x32_bf16 v[176:179], a[84:87], a[28:31], v[176:179]
s_add_u32 m0, s16, 0x9800
v_mfma_f32_16x16x32_bf16 v[176:179], a[80:83], a[12:15], v[176:179]
buffer_load_dwordx4 v22, s[44:47], s23 offen lds
v_mfma_f32_16x16x32_bf16 v[180:183], a[88:91], a[12:15], v[180:183]
ds_read_b64_tr_b16 a[80:81], v14 offset:8192
v_mfma_f32_16x16x32_bf16 v[180:183], a[92:95], a[28:31], v[180:183]
ds_read_b64_tr_b16 a[82:83], v14 offset:8448
v_mfma_f32_16x16x32_bf16 v[172:175], a[92:95], a[24:27], v[172:175]
ds_read_b64_tr_b16 a[84:85], v14 offset:10240
v_mfma_f32_16x16x32_bf16 v[172:175], a[88:91], a[8:11], v[172:175]
ds_read_b64_tr_b16 a[86:87], v14 offset:10496
s_add_u32 m0, s16, 0x9c00
v_mfma_f32_16x16x32_bf16 v[164:167], a[88:91], a[4:7], v[164:167]
buffer_load_dwordx4 v23, s[44:47], s23 offen lds
v_mfma_f32_16x16x32_bf16 v[164:167], a[92:95], a[20:23], v[164:167]
v_lshl_add_u32 v22, s42, 7, v22
v_lshl_add_u32 v23, s42, 7, v23
v_mfma_f32_16x16x32_bf16 v[156:159], a[92:95], a[16:19], v[156:159]
v_mfma_f32_16x16x32_bf16 v[156:159], a[88:91], a[0:3], v[156:159]
s_waitcnt lgkmcnt(4)
v_mfma_f32_16x16x32_bf16 v[184:187], a[96:99], a[0:3], v[184:187]
ds_read_b64_tr_b16 a[88:89], v15 offset:8192
v_mfma_f32_16x16x32_bf16 v[184:187], a[100:103], a[16:19], v[184:187]
ds_read_b64_tr_b16 a[90:91], v15 offset:8448
v_mfma_f32_16x16x32_bf16 v[192:195], a[100:103], a[20:23], v[192:195]
buffer_load_dwordx4 a[136:139], v16, s[44:47], s100 offen offset:2048
v_mfma_f32_16x16x32_bf16 v[192:195], a[96:99], a[4:7], v[192:195]
ds_read_b64_tr_b16 a[92:93], v15 offset:10240
v_mfma_f32_16x16x32_bf16 v[200:203], a[96:99], a[8:11], v[200:203]
ds_read_b64_tr_b16 a[94:95], v15 offset:10496
v_add_u32 v12, 0x8000, v12
v_mfma_f32_16x16x32_bf16 v[200:203], a[100:103], a[24:27], v[200:203]
v_add_u32 v13, 0x8000, v13
v_add_u32 v14, 0x8000, v14
v_mfma_f32_16x16x32_bf16 v[208:211], a[100:103], a[28:31], v[208:211]
v_add_u32 v15, 0x8000, v15
v_mfma_f32_16x16x32_bf16 v[208:211], a[96:99], a[12:15], v[208:211]
v_mfma_f32_16x16x32_bf16 v[212:215], a[104:107], a[12:15], v[212:215]
s_waitcnt vmcnt(18) lgkmcnt(0)
v_mfma_f32_16x16x32_bf16 v[212:215], a[108:111], a[28:31], v[212:215]
s_barrier
s_add_u32 m0, s17, 0x0
s_cmp_lg_u32 s4, 0
s_cbranch_scc1 L_sig_kv
v_mov_b32 v20, 1
s_mov_b64 exec, 1
buffer_atomic_add v20, off, s[84:87], s10 sc1
s_mov_b64 exec, -1
L_sig_kv:
v_mfma_f32_16x16x32_bf16 v[204:207], a[108:111], a[24:27], v[204:207]
buffer_load_dwordx4 v5, s[52:55], 0 offen lds
v_mfma_f32_16x16x32_bf16 v[204:207], a[104:107], a[8:11], v[204:207]
ds_read_b64_tr_b16 a[96:97], v12 offset:0
v_mfma_f32_16x16x32_bf16 v[196:199], a[104:107], a[4:7], v[196:199]
ds_read_b64_tr_b16 a[98:99], v12 offset:1024
v_mfma_f32_16x16x32_bf16 v[196:199], a[108:111], a[20:23], v[196:199]
ds_read_b64_tr_b16 a[100:101], v12 offset:8192
v_mfma_f32_16x16x32_bf16 v[188:191], a[108:111], a[16:19], v[188:191]
ds_read_b64_tr_b16 a[102:103], v12 offset:9216
v_mfma_f32_16x16x32_bf16 v[188:191], a[104:107], a[0:3], v[188:191]
s_add_u32 m0, s17, 0x400
s_waitcnt lgkmcnt(4)
v_mfma_f32_16x16x32_bf16 v[216:219], a[0:3], a[80:83], v[216:219]
buffer_load_dwordx4 v5, s[52:55], s13 offen lds
v_mfma_f32_16x16x32_bf16 v[216:219], a[16:19], a[84:87], v[216:219]
ds_read_b64_tr_b16 a[104:105], v13 offset:0
v_mfma_f32_16x16x32_bf16 v[224:227], a[20:23], a[84:87], v[224:227]
ds_read_b64_tr_b16 a[106:107], v13 offset:1024
v_mfma_f32_16x16x32_bf16 v[224:227], a[4:7], a[80:83], v[224:227]
ds_read_b64_tr_b16 a[108:109], v13 offset:8192
v_mfma_f32_16x16x32_bf16 v[232:235], a[8:11], a[80:83], v[232:235]
ds_read_b64_tr_b16 a[110:111], v13 offset:9216
v_mfma_f32_16x16x32_bf16 v[232:235], a[24:27], a[84:87], v[232:235]
v_mfma_f32_16x16x32_bf16 v[240:243], a[28:31], a[84:87], v[240:243]
s_add_u32 m0, s17, 0x800
v_mfma_f32_16x16x32_bf16 v[240:243], a[12:15], a[80:83], v[240:243]
buffer_load_dwordx4 v6, s[52:55], 0 offen lds
v_mfma_f32_16x16x32_bf16 v[244:247], a[12:15], a[88:91], v[244:247]
ds_read_b64_tr_b16 a[80:81], v12 offset:256
v_mfma_f32_16x16x32_bf16 v[244:247], a[28:31], a[92:95], v[244:247]
ds_read_b64_tr_b16 a[82:83], v12 offset:1280
v_mfma_f32_16x16x32_bf16 v[236:239], a[24:27], a[92:95], v[236:239]
ds_read_b64_tr_b16 a[84:85], v12 offset:8448
v_mfma_f32_16x16x32_bf16 v[236:239], a[8:11], a[88:91], v[236:239]
ds_read_b64_tr_b16 a[86:87], v12 offset:9472
v_mfma_f32_16x16x32_bf16 v[228:231], a[4:7], a[88:91], v[228:231]
v_mfma_f32_16x16x32_bf16 v[228:231], a[20:23], a[92:95], v[228:231]
s_add_u32 m0, s17, 0xc00
v_mfma_f32_16x16x32_bf16 v[220:223], a[16:19], a[92:95], v[220:223]
buffer_load_dwordx4 v6, s[52:55], s13 offen lds
v_mfma_f32_16x16x32_bf16 v[220:223], a[0:3], a[88:91], v[220:223]
s_waitcnt lgkmcnt(4)
L_S19:
v_mfma_f32_16x16x32_bf16 v[24:27], a[96:99], a[32:35], v[24:27]
ds_read_b64_tr_b16 a[88:89], v13 offset:256
s_waitcnt vmcnt(23)
v_mfma_f32_16x16x32_bf16 v[24:27], a[100:103], a[48:51], v[24:27]
ds_read_b64_tr_b16 a[90:91], v13 offset:1280
v_mfma_f32_16x16x32_bf16 v[32:35], a[100:103], a[52:55], v[32:35]
ds_read_b64_tr_b16 a[92:93], v13 offset:8448
v_mfma_f32_16x16x32_bf16 v[32:35], a[96:99], a[36:39], v[32:35]
ds_read_b64_tr_b16 a[94:95], v13 offset:9472
v_mfma_f32_16x16x32_bf16 v[40:43], a[96:99], a[40:43], v[40:43]
ds_read_b128 a[0:3], v8 offset:0
s_add_u32 m0, s18, 0x4000
v_mfma_f32_16x16x32_bf16 v[40:43], a[100:103], a[56:59], v[40:43]
buffer_load_dwordx4 v7, s[68:71], 0 offen lds
v_mfma_f32_16x16x32_bf16 v[48:51], a[100:103], a[60:63], v[48:51]
ds_read_b128 a[16:19], v9 offset:0
v_mfma_f32_16x16x32_bf16 v[48:51], a[96:99], a[44:47], v[48:51]
ds_read_b128 a[4:7], v8 offset:2048
v_mfma_f32_16x16x32_bf16 v[52:55], a[104:107], a[44:47], v[52:55]
ds_read_b64_tr_b16 a[96:97], v12 offset:512
v_mfma_f32_16x16x32_bf16 v[52:55], a[108:111], a[60:63], v[52:55]
ds_read_b64_tr_b16 a[98:99], v12 offset:1536
v_mfma_f32_16x16x32_bf16 v[44:47], a[108:111], a[56:59], v[44:47]
ds_read_b64_tr_b16 a[100:101], v12 offset:8704
v_mfma_f32_16x16x32_bf16 v[44:47], a[104:107], a[40:43], v[44:47]
buffer_load_dwordx4 a[140:143], v16, s[44:47], s100 offen offset:3072
v_mfma_f32_16x16x32_bf16 v[36:39], a[104:107], a[36:39], v[36:39]
ds_read_b64_tr_b16 a[102:103], v12 offset:9728
v_mfma_f32_16x16x32_bf16 v[36:39], a[108:111], a[52:55], v[36:39]
ds_read_b128 a[20:23], v9 offset:2048
v_mfma_f32_16x16x32_bf16 v[28:31], a[108:111], a[48:51], v[28:31]
ds_read_b128 a[8:11], v8 offset:4096
v_mfma_f32_16x16x32_bf16 v[28:31], a[104:107], a[32:35], v[28:31]
ds_read_b128 a[24:27], v9 offset:4096
s_waitcnt lgkmcnt(10)
v_mfma_f32_16x16x32_bf16 v[56:59], a[80:83], a[32:35], v[56:59]
ds_read_b64_tr_b16 a[104:105], v13 offset:512
v_mfma_f32_16x16x32_bf16 v[56:59], a[84:87], a[48:51], v[56:59]
ds_read_b64_tr_b16 a[106:107], v13 offset:1536
s_add_u32 m0, s18, 0x5000
v_mfma_f32_16x16x32_bf16 v[64:67], a[84:87], a[52:55], v[64:67]
buffer_load_dwordx4 v7, s[68:71], s25 offen lds
v_mfma_f32_16x16x32_bf16 v[64:67], a[80:83], a[36:39], v[64:67]
ds_read_b64_tr_b16 a[108:109], v13 offset:8704
v_mfma_f32_16x16x32_bf16 v[72:75], a[80:83], a[40:43], v[72:75]
ds_read_b64_tr_b16 a[110:111], v13 offset:9728
v_mfma_f32_16x16x32_bf16 v[72:75], a[84:87], a[56:59], v[72:75]
ds_read_b128 a[12:15], v8 offset:6144
v_mfma_f32_16x16x32_bf16 v[80:83], a[84:87], a[60:63], v[80:83]
ds_read_b128 a[28:31], v9 offset:6144
v_mfma_f32_16x16x32_bf16 v[80:83], a[80:83], a[44:47], v[80:83]
v_mfma_f32_16x16x32_bf16 v[84:87], a[88:91], a[44:47], v[84:87]
ds_read_b64_tr_b16 a[80:81], v12 offset:768
s_add_u32 m0, s18, 0x6000
v_mfma_f32_16x16x32_bf16 v[84:87], a[92:95], a[60:63], v[84:87]
buffer_load_dwordx4 v7, s[68:71], s26 offen lds
v_mfma_f32_16x16x32_bf16 v[76:79], a[92:95], a[56:59], v[76:79]
ds_read_b64_tr_b16 a[82:83], v12 offset:1792
v_lshl_add_u32 v5, s42, 19, v5
v_mfma_f32_16x16x32_bf16 v[76:79], a[88:91], a[40:43], v[76:79]
ds_read_b64_tr_b16 a[84:85], v12 offset:8960
v_lshl_add_u32 v6, s42, 19, v6
v_mfma_f32_16x16x32_bf16 v[68:71], a[88:91], a[36:39], v[68:71]
ds_read_b64_tr_b16 a[86:87], v12 offset:9984
v_lshl_add_u32 v7, s42, 18, v7
v_mfma_f32_16x16x32_bf16 v[68:71], a[92:95], a[52:55], v[68:71]
v_lshl_add_u32 v7, s42, 17, v7
v_mfma_f32_16x16x32_bf16 v[60:63], a[92:95], a[48:51], v[60:63]
v_mfma_f32_16x16x32_bf16 v[60:63], a[88:91], a[32:35], v[60:63]
s_add_u32 m0, s16, 0x0
s_waitcnt lgkmcnt(4)
s_waitcnt lgkmcnt(6)
v_mfma_f32_16x16x32_bf16 v[88:91], a[96:99], a[32:35], v[88:91]
buffer_load_dwordx4 v22, s[44:47], s20 offen lds
v_mfma_f32_16x16x32_bf16 v[88:91], a[100:103], a[48:51], v[88:91]
ds_read_b64_tr_b16 a[88:89], v13 offset:768
v_mfma_f32_16x16x32_bf16 v[96:99], a[100:103], a[52:55], v[96:99]
ds_read_b64_tr_b16 a[90:91], v13 offset:1792
v_mfma_f32_16x16x32_bf16 v[96:99], a[96:99], a[36:39], v[96:99]
ds_read_b64_tr_b16 a[92:93], v13 offset:8960
v_mfma_f32_16x16x32_bf16 v[104:107], a[96:99], a[40:43], v[104:107]
ds_read_b64_tr_b16 a[94:95], v13 offset:9984
s_add_u32 m0, s16, 0x400
v_mfma_f32_16x16x32_bf16 v[104:107], a[100:103], a[56:59], v[104:107]
buffer_load_dwordx4 v23, s[44:47], s20 offen lds
v_mfma_f32_16x16x32_bf16 v[112:115], a[100:103], a[60:63], v[112:115]
v_mfma_f32_16x16x32_bf16 v[112:115], a[96:99], a[44:47], v[112:115]
v_mfma_f32_16x16x32_bf16 v[116:119], a[104:107], a[44:47], v[116:119]
ds_read_b64_tr_b16 a[96:97], v14 offset:0
v_mfma_f32_16x16x32_bf16 v[116:119], a[108:111], a[60:63], v[116:119]
ds_read_b64_tr_b16 a[98:99], v14 offset:256
v_mfma_f32_16x16x32_bf16 v[108:111], a[108:111], a[56:59], v[108:111]
ds_read_b64_tr_b16 a[100:101], v14 offset:2048
s_add_u32 m0, s16, 0x800
v_mfma_f32_16x16x32_bf16 v[108:111], a[104:107], a[40:43], v[108:111]
buffer_load_dwordx4 v22, s[44:47], s21 offen lds
v_mfma_f32_16x16x32_bf16 v[100:103], a[104:107], a[36:39], v[100:103]
ds_read_b64_tr_b16 a[102:103], v14 offset:2304
v_mfma_f32_16x16x32_bf16 v[100:103], a[108:111], a[52:55], v[100:103]
v_mfma_f32_16x16x32_bf16 v[92:95], a[108:111], a[48:51], v[92:95]
v_mfma_f32_16x16x32_bf16 v[92:95], a[104:107], a[32:35], v[92:95]
s_waitcnt lgkmcnt(4)
v_mfma_f32_16x16x32_bf16 v[120:123], a[80:83], a[32:35], v[120:123]
buffer_load_dwordx4 a[144:147], v16, s[76:79], 0 offen offset:0
v_mfma_f32_16x16x32_bf16 v[120:123], a[84:87], a[48:51], v[120:123]
ds_read_b64_tr_b16 a[104:105], v15 offset:0
v_mfma_f32_16x16x32_bf16 v[128:131], a[84:87], a[52:55], v[128:131]
ds_read_b64_tr_b16 a[106:107], v15 offset:256
v_mfma_f32_16x16x32_bf16 v[128:131], a[80:83], a[36:39], v[128:131]
ds_read_b64_tr_b16 a[108:109], v15 offset:2048
v_mfma_f32_16x16x32_bf16 v[136:139], a[80:83], a[40:43], v[136:139]
ds_read_b64_tr_b16 a[110:111], v15 offset:2304
v_mfma_f32_16x16x32_bf16 v[136:139], a[84:87], a[56:59], v[136:139]
s_add_u32 m0, s16, 0xc00
v_mfma_f32_16x16x32_bf16 v[144:147], a[84:87], a[60:63], v[144:147]
buffer_load_dwordx4 v23, s[44:47], s21 offen lds
v_mfma_f32_16x16x32_bf16 v[144:147], a[80:83], a[44:47], v[144:147]
v_mfma_f32_16x16x32_bf16 v[148:151], a[88:91], a[44:47], v[148:151]
ds_read_b64_tr_b16 a[80:81], v14 offset:4096
v_mfma_f32_16x16x32_bf16 v[148:151], a[92:95], a[60:63], v[148:151]
ds_read_b64_tr_b16 a[82:83], v14 offset:4352
v_mfma_f32_16x16x32_bf16 v[140:143], a[92:95], a[56:59], v[140:143]
ds_read_b64_tr_b16 a[84:85], v14 offset:6144
v_mfma_f32_16x16x32_bf16 v[140:143], a[88:91], a[40:43], v[140:143]
ds_read_b64_tr_b16 a[86:87], v14 offset:6400
s_add_u32 m0, s16, 0x1000
v_mfma_f32_16x16x32_bf16 v[132:135], a[88:91], a[36:39], v[132:135]
buffer_load_dwordx4 v22, s[44:47], s22 offen lds
v_mfma_f32_16x16x32_bf16 v[132:135], a[92:95], a[52:55], v[132:135]
v_mfma_f32_16x16x32_bf16 v[124:127], a[92:95], a[48:51], v[124:127]
v_mfma_f32_16x16x32_bf16 v[124:127], a[88:91], a[32:35], v[124:127]
s_waitcnt lgkmcnt(4)
v_mfma_f32_16x16x32_bf16 v[152:155], a[96:99], a[32:35], v[152:155]
ds_read_b64_tr_b16 a[88:89], v15 offset:4096
s_add_u32 m0, s16, 0x1400
v_mfma_f32_16x16x32_bf16 v[152:155], a[100:103], a[48:51], v[152:155]
buffer_load_dwordx4 v23, s[44:47], s22 offen lds
v_mfma_f32_16x16x32_bf16 v[160:163], a[100:103], a[52:55], v[160:163]
ds_read_b64_tr_b16 a[90:91], v15 offset:4352
v_mfma_f32_16x16x32_bf16 v[160:163], a[96:99], a[36:39], v[160:163]
ds_read_b64_tr_b16 a[92:93], v15 offset:6144
v_mfma_f32_16x16x32_bf16 v[168:171], a[96:99], a[40:43], v[168:171]
ds_read_b64_tr_b16 a[94:95], v15 offset:6400
v_mfma_f32_16x16x32_bf16 v[168:171], a[100:103], a[56:59], v[168:171]
v_mfma_f32_16x16x32_bf16 v[176:179], a[100:103], a[60:63], v[176:179]
s_add_u32 m0, s16, 0x1800
v_mfma_f32_16x16x32_bf16 v[176:179], a[96:99], a[44:47], v[176:179]
buffer_load_dwordx4 v22, s[44:47], s23 offen lds
v_mfma_f32_16x16x32_bf16 v[180:183], a[104:107], a[44:47], v[180:183]
ds_read_b64_tr_b16 a[96:97], v14 offset:8192
v_mfma_f32_16x16x32_bf16 v[180:183], a[108:111], a[60:63], v[180:183]
ds_read_b64_tr_b16 a[98:99], v14 offset:8448
v_mfma_f32_16x16x32_bf16 v[172:175], a[108:111], a[56:59], v[172:175]
ds_read_b64_tr_b16 a[100:101], v14 offset:10240
v_mfma_f32_16x16x32_bf16 v[172:175], a[104:107], a[40:43], v[172:175]
ds_read_b64_tr_b16 a[102:103], v14 offset:10496
s_add_u32 m0, s16, 0x1c00
v_mfma_f32_16x16x32_bf16 v[164:167], a[104:107], a[36:39], v[164:167]
buffer_load_dwordx4 v23, s[44:47], s23 offen lds
v_mfma_f32_16x16x32_bf16 v[164:167], a[108:111], a[52:55], v[164:167]
v_lshl_add_u32 v22, s42, 7, v22
v_lshl_add_u32 v23, s42, 7, v23
v_mfma_f32_16x16x32_bf16 v[156:159], a[108:111], a[48:51], v[156:159]
v_mfma_f32_16x16x32_bf16 v[156:159], a[104:107], a[32:35], v[156:159]
s_waitcnt lgkmcnt(4)
v_mfma_f32_16x16x32_bf16 v[184:187], a[80:83], a[32:35], v[184:187]
ds_read_b64_tr_b16 a[104:105], v15 offset:8192
v_mfma_f32_16x16x32_bf16 v[184:187], a[84:87], a[48:51], v[184:187]
ds_read_b64_tr_b16 a[106:107], v15 offset:8448
v_mfma_f32_16x16x32_bf16 v[192:195], a[84:87], a[52:55], v[192:195]
buffer_load_dwordx4 a[148:151], v16, s[76:79], 0 offen offset:1024
v_mfma_f32_16x16x32_bf16 v[192:195], a[80:83], a[36:39], v[192:195]
ds_read_b64_tr_b16 a[108:109], v15 offset:10240
v_mfma_f32_16x16x32_bf16 v[200:203], a[80:83], a[40:43], v[200:203]
ds_read_b64_tr_b16 a[110:111], v15 offset:10496
v_add_u32 v12, 0x8000, v12
v_mfma_f32_16x16x32_bf16 v[200:203], a[84:87], a[56:59], v[200:203]
v_add_u32 v13, 0x8000, v13
v_add_u32 v14, 0x8000, v14
v_mfma_f32_16x16x32_bf16 v[208:211], a[84:87], a[60:63], v[208:211]
v_add_u32 v15, 0x8000, v15
v_mfma_f32_16x16x32_bf16 v[208:211], a[80:83], a[44:47], v[208:211]
v_mfma_f32_16x16x32_bf16 v[212:215], a[88:91], a[44:47], v[212:215]
s_waitcnt vmcnt(28) lgkmcnt(0)
v_mfma_f32_16x16x32_bf16 v[212:215], a[92:95], a[60:63], v[212:215]
s_barrier
s_add_u32 m0, s17, 0x8000
v_mfma_f32_16x16x32_bf16 v[204:207], a[92:95], a[56:59], v[204:207]
buffer_load_dwordx4 v5, s[52:55], 0 offen lds
v_mfma_f32_16x16x32_bf16 v[204:207], a[88:91], a[40:43], v[204:207]
ds_read_b64_tr_b16 a[80:81], v12 offset:0
v_mfma_f32_16x16x32_bf16 v[196:199], a[88:91], a[36:39], v[196:199]
ds_read_b64_tr_b16 a[82:83], v12 offset:1024
v_mfma_f32_16x16x32_bf16 v[196:199], a[92:95], a[52:55], v[196:199]
ds_read_b64_tr_b16 a[84:85], v12 offset:8192
v_mfma_f32_16x16x32_bf16 v[188:191], a[92:95], a[48:51], v[188:191]
ds_read_b64_tr_b16 a[86:87], v12 offset:9216
v_mfma_f32_16x16x32_bf16 v[188:191], a[88:91], a[32:35], v[188:191]
s_waitcnt lgkmcnt(4)
v_mfma_f32_16x16x32_bf16 v[216:219], a[32:35], a[96:99], v[216:219]
ds_read_b64_tr_b16 a[88:89], v13 offset:0
s_add_u32 m0, s17, 0x8400
v_mfma_f32_16x16x32_bf16 v[216:219], a[48:51], a[100:103], v[216:219]
buffer_load_dwordx4 v5, s[52:55], s13 offen lds
v_mfma_f32_16x16x32_bf16 v[224:227], a[52:55], a[100:103], v[224:227]
ds_read_b64_tr_b16 a[90:91], v13 offset:1024
v_mfma_f32_16x16x32_bf16 v[224:227], a[36:39], a[96:99], v[224:227]
ds_read_b64_tr_b16 a[92:93], v13 offset:8192
v_mfma_f32_16x16x32_bf16 v[232:235], a[40:43], a[96:99], v[232:235]
ds_read_b64_tr_b16 a[94:95], v13 offset:9216
v_mfma_f32_16x16x32_bf16 v[232:235], a[56:59], a[100:103], v[232:235]
v_mfma_f32_16x16x32_bf16 v[240:243], a[60:63], a[100:103], v[240:243]
v_mfma_f32_16x16x32_bf16 v[240:243], a[44:47], a[96:99], v[240:243]
v_mfma_f32_16x16x32_bf16 v[244:247], a[44:47], a[104:107], v[244:247]
ds_read_b64_tr_b16 a[96:97], v12 offset:256
s_add_u32 m0, s17, 0x8800
v_mfma_f32_16x16x32_bf16 v[244:247], a[60:63], a[108:111], v[244:247]
buffer_load_dwordx4 v6, s[52:55], 0 offen lds
v_mfma_f32_16x16x32_bf16 v[236:239], a[56:59], a[108:111], v[236:239]
ds_read_b64_tr_b16 a[98:99], v12 offset:1280
v_mfma_f32_16x16x32_bf16 v[236:239], a[40:43], a[104:107], v[236:239]
ds_read_b64_tr_b16 a[100:101], v12 offset:8448
v_mfma_f32_16x16x32_bf16 v[228:231], a[36:39], a[104:107], v[228:231]
ds_read_b64_tr_b16 a[102:103], v12 offset:9472
v_mfma_f32_16x16x32_bf16 v[228:231], a[52:55], a[108:111], v[228:231]
v_mfma_f32_16x16x32_bf16 v[220:223], a[48:51], a[108:111], v[220:223]
v_mfma_f32_16x16x32_bf16 v[220:223], a[32:35], a[104:107], v[220:223]
s_add_u32 m0, s17, 0x8c00
s_waitcnt lgkmcnt(4)
L_S20:
v_mfma_f32_16x16x32_bf16 v[24:27], a[80:83], a[0:3], v[24:27]
ds_read_b64_tr_b16 a[104:105], v13 offset:256
s_waitcnt vmcnt(22)
v_mfma_f32_16x16x32_bf16 v[24:27], a[84:87], a[16:19], v[24:27]
buffer_load_dwordx4 v6, s[52:55], s13 offen lds
v_mfma_f32_16x16x32_bf16 v[32:35], a[84:87], a[20:23], v[32:35]
ds_read_b64_tr_b16 a[106:107], v13 offset:1280
v_mfma_f32_16x16x32_bf16 v[32:35], a[80:83], a[4:7], v[32:35]
ds_read_b64_tr_b16 a[108:109], v13 offset:8448
v_mfma_f32_16x16x32_bf16 v[40:43], a[80:83], a[8:11], v[40:43]
ds_read_b64_tr_b16 a[110:111], v13 offset:9472
v_mfma_f32_16x16x32_bf16 v[40:43], a[84:87], a[24:27], v[40:43]
ds_read_b128 a[32:35], v8 offset:32768
v_mfma_f32_16x16x32_bf16 v[48:51], a[84:87], a[28:31], v[48:51]
ds_read_b128 a[48:51], v9 offset:32768
v_mfma_f32_16x16x32_bf16 v[48:51], a[80:83], a[12:15], v[48:51]
ds_read_b128 a[36:39], v8 offset:34816
s_add_u32 m0, s18, 0xc000
v_mfma_f32_16x16x32_bf16 v[52:55], a[88:91], a[12:15], v[52:55]
buffer_load_dwordx4 v7, s[68:71], 0 offen lds
v_mfma_f32_16x16x32_bf16 v[52:55], a[92:95], a[28:31], v[52:55]
ds_read_b64_tr_b16 a[80:81], v12 offset:512
v_mfma_f32_16x16x32_bf16 v[44:47], a[92:95], a[24:27], v[44:47]
ds_read_b64_tr_b16 a[82:83], v12 offset:1536
v_mfma_f32_16x16x32_bf16 v[44:47], a[88:91], a[8:11], v[44:47]
ds_read_b64_tr_b16 a[84:85], v12 offset:8704
v_mfma_f32_16x16x32_bf16 v[36:39], a[88:91], a[4:7], v[36:39]
ds_read_b64_tr_b16 a[86:87], v12 offset:9728
v_mfma_f32_16x16x32_bf16 v[36:39], a[92:95], a[20:23], v[36:39]
ds_read_b128 a[52:55], v9 offset:34816
v_mfma_f32_16x16x32_bf16 v[28:31], a[92:95], a[16:19], v[28:31]
ds_read_b128 a[40:43], v8 offset:36864
s_waitcnt lgkmcnt(9)
v_mfma_f32_16x16x32_bf16 v[28:31], a[88:91], a[0:3], v[28:31]
ds_read_b128 a[56:59], v9 offset:36864
s_add_u32 m0, s18, 0xd000
v_mfma_f32_16x16x32_bf16 v[56:59], a[96:99], a[0:3], v[56:59]
buffer_load_dwordx4 v7, s[68:71], s25 offen lds
v_mfma_f32_16x16x32_bf16 v[56:59], a[100:103], a[16:19], v[56:59]
ds_read_b64_tr_b16 a[88:89], v13 offset:512
v_mfma_f32_16x16x32_bf16 v[64:67], a[100:103], a[20:23], v[64:67]
ds_read_b64_tr_b16 a[90:91], v13 offset:1536
v_mfma_f32_16x16x32_bf16 v[64:67], a[96:99], a[4:7], v[64:67]
ds_read_b64_tr_b16 a[92:93], v13 offset:8704
v_mfma_f32_16x16x32_bf16 v[72:75], a[96:99], a[8:11], v[72:75]
ds_read_b64_tr_b16 a[94:95], v13 offset:9728
v_mfma_f32_16x16x32_bf16 v[72:75], a[100:103], a[24:27], v[72:75]
ds_read_b128 a[44:47], v8 offset:38912
v_mfma_f32_16x16x32_bf16 v[80:83], a[100:103], a[28:31], v[80:83]
ds_read_b128 a[60:63], v9 offset:38912
v_mfma_f32_16x16x32_bf16 v[80:83], a[96:99], a[12:15], v[80:83]
s_add_u32 m0, s18, 0xe000
v_mfma_f32_16x16x32_bf16 v[84:87], a[104:107], a[12:15], v[84:87]
buffer_load_dwordx4 v7, s[68:71], s26 offen lds
v_mfma_f32_16x16x32_bf16 v[84:87], a[108:111], a[28:31], v[84:87]
ds_read_b64_tr_b16 a[96:97], v12 offset:768
v_lshl_add_u32 v5, s42, 19, v5
v_mfma_f32_16x16x32_bf16 v[76:79], a[108:111], a[24:27], v[76:79]
ds_read_b64_tr_b16 a[98:99], v12 offset:1792
v_lshl_add_u32 v6, s42, 19, v6
v_mfma_f32_16x16x32_bf16 v[76:79], a[104:107], a[8:11], v[76:79]
ds_read_b64_tr_b16 a[100:101], v12 offset:8960
v_lshl_add_u32 v7, s42, 18, v7
v_mfma_f32_16x16x32_bf16 v[68:71], a[104:107], a[4:7], v[68:71]
ds_read_b64_tr_b16 a[102:103], v12 offset:9984
v_lshl_add_u32 v7, s42, 17, v7
v_mfma_f32_16x16x32_bf16 v[68:71], a[108:111], a[20:23], v[68:71]
s_waitcnt vmcnt(13)
v_accvgpr_read_b32 v18, a144
v_lshlrev_b32 v1, 16, v18
v_mfma_f32_16x16x32_bf16 v[60:63], a[108:111], a[16:19], v[60:63]
L_padA10:
s_cmp_eq_u32 s95, 1
s_cbranch_scc1 L_hopA_ret
v_and_b32 v18, 0xffff0000, v18
v_accvgpr_read_b32 v21, a128
v_mfma_f32_16x16x32_bf16 v[60:63], a[104:107], a[0:3], v[60:63]
s_add_u32 m0, s16, 0x8000
s_waitcnt lgkmcnt(4)
s_waitcnt lgkmcnt(6)
v_mfma_f32_16x16x32_bf16 v[88:91], a[80:83], a[0:3], v[88:91]
buffer_load_dwordx4 v22, s[44:47], s20 offen lds
v_mfma_f32_16x16x32_bf16 v[88:91], a[84:87], a[16:19], v[88:91]
ds_read_b64_tr_b16 a[104:105], v13 offset:768
v_lshlrev_b32 v20, 16, v21
v_mfma_f32_16x16x32_bf16 v[96:99], a[84:87], a[20:23], v[96:99]
ds_read_b64_tr_b16 a[106:107], v13 offset:1792
v_and_b32 v21, 0xffff0000, v21
v_mfma_f32_16x16x32_bf16 v[96:99], a[80:83], a[4:7], v[96:99]
ds_read_b64_tr_b16 a[108:109], v13 offset:8960
v_mul_f32 v2, v1, v20
v_mfma_f32_16x16x32_bf16 v[104:107], a[80:83], a[8:11], v[104:107]
ds_read_b64_tr_b16 a[110:111], v13 offset:9984
v_fmac_f32 v2, v18, v21
v_mfma_f32_16x16x32_bf16 v[104:107], a[84:87], a[24:27], v[104:107]
v_accvgpr_read_b32 v21, a136
v_lshlrev_b32 v20, 16, v21
v_mfma_f32_16x16x32_bf16 v[112:115], a[84:87], a[28:31], v[112:115]
s_add_u32 m0, s16, 0x8400
v_and_b32 v21, 0xffff0000, v21
v_mul_f32 v3, v1, v20
v_mfma_f32_16x16x32_bf16 v[112:115], a[80:83], a[12:15], v[112:115]
buffer_load_dwordx4 v23, s[44:47], s20 offen lds
v_mfma_f32_16x16x32_bf16 v[116:119], a[88:91], a[12:15], v[116:119]
ds_read_b64_tr_b16 a[80:81], v14 offset:0
v_fmac_f32 v3, v18, v21
v_mfma_f32_16x16x32_bf16 v[116:119], a[92:95], a[28:31], v[116:119]
ds_read_b64_tr_b16 a[82:83], v14 offset:256
v_accvgpr_read_b32 v18, a145
v_mfma_f32_16x16x32_bf16 v[108:111], a[92:95], a[24:27], v[108:111]
ds_read_b64_tr_b16 a[84:85], v14 offset:2048
v_lshlrev_b32 v1, 16, v18
v_mfma_f32_16x16x32_bf16 v[108:111], a[88:91], a[8:11], v[108:111]
ds_read_b64_tr_b16 a[86:87], v14 offset:2304
v_and_b32 v18, 0xffff0000, v18
v_mfma_f32_16x16x32_bf16 v[100:103], a[88:91], a[4:7], v[100:103]
v_accvgpr_read_b32 v21, a129
v_lshlrev_b32 v20, 16, v21
v_mfma_f32_16x16x32_bf16 v[100:103], a[92:95], a[20:23], v[100:103]
s_add_u32 m0, s16, 0x8800
v_and_b32 v21, 0xffff0000, v21
v_fmac_f32 v2, v1, v20
v_mfma_f32_16x16x32_bf16 v[92:95], a[92:95], a[16:19], v[92:95]
buffer_load_dwordx4 v22, s[44:47], s21 offen lds
v_mfma_f32_16x16x32_bf16 v[92:95], a[88:91], a[0:3], v[92:95]
s_waitcnt lgkmcnt(4)
v_fmac_f32 v2, v18, v21
v_accvgpr_read_b32 v21, a137
v_mfma_f32_16x16x32_bf16 v[120:123], a[96:99], a[0:3], v[120:123]
ds_read_b64_tr_b16 a[88:89], v15 offset:0
v_lshlrev_b32 v20, 16, v21
v_mfma_f32_16x16x32_bf16 v[120:123], a[100:103], a[16:19], v[120:123]
ds_read_b64_tr_b16 a[90:91], v15 offset:256
v_and_b32 v21, 0xffff0000, v21
v_mfma_f32_16x16x32_bf16 v[128:131], a[100:103], a[20:23], v[128:131]
ds_read_b64_tr_b16 a[92:93], v15 offset:2048
v_fmac_f32 v3, v1, v20
v_mfma_f32_16x16x32_bf16 v[128:131], a[96:99], a[4:7], v[128:131]
ds_read_b64_tr_b16 a[94:95], v15 offset:2304
v_fmac_f32 v3, v18, v21
v_mfma_f32_16x16x32_bf16 v[136:139], a[96:99], a[8:11], v[136:139]
s_add_u32 m0, s16, 0x8c00
v_accvgpr_read_b32 v18, a146
v_lshlrev_b32 v1, 16, v18
v_mfma_f32_16x16x32_bf16 v[136:139], a[100:103], a[24:27], v[136:139]
buffer_load_dwordx4 v23, s[44:47], s21 offen lds
v_mfma_f32_16x16x32_bf16 v[144:147], a[100:103], a[28:31], v[144:147]
v_and_b32 v18, 0xffff0000, v18
v_accvgpr_read_b32 v21, a130
v_mfma_f32_16x16x32_bf16 v[144:147], a[96:99], a[12:15], v[144:147]
v_lshlrev_b32 v20, 16, v21
v_and_b32 v21, 0xffff0000, v21
v_mfma_f32_16x16x32_bf16 v[148:151], a[104:107], a[12:15], v[148:151]
ds_read_b64_tr_b16 a[96:97], v14 offset:4096
v_fmac_f32 v2, v1, v20
v_mfma_f32_16x16x32_bf16 v[148:151], a[108:111], a[28:31], v[148:151]
ds_read_b64_tr_b16 a[98:99], v14 offset:4352
v_fmac_f32 v2, v18, v21
v_mfma_f32_16x16x32_bf16 v[140:143], a[108:111], a[24:27], v[140:143]
ds_read_b64_tr_b16 a[100:101], v14 offset:6144
v_accvgpr_read_b32 v21, a138
v_mfma_f32_16x16x32_bf16 v[140:143], a[104:107], a[8:11], v[140:143]
ds_read_b64_tr_b16 a[102:103], v14 offset:6400
s_add_u32 m0, s16, 0x9000
v_mfma_f32_16x16x32_bf16 v[132:135], a[104:107], a[4:7], v[132:135]
buffer_load_dwordx4 v22, s[44:47], s22 offen lds
v_mfma_f32_16x16x32_bf16 v[132:135], a[108:111], a[20:23], v[132:135]
v_lshlrev_b32 v20, 16, v21
v_and_b32 v21, 0xffff0000, v21
v_mfma_f32_16x16x32_bf16 v[124:127], a[108:111], a[16:19], v[124:127]
v_fmac_f32 v3, v1, v20
v_fmac_f32 v3, v18, v21
v_mfma_f32_16x16x32_bf16 v[124:127], a[104:107], a[0:3], v[124:127]
s_waitcnt lgkmcnt(4)
v_accvgpr_read_b32 v18, a147
v_lshlrev_b32 v1, 16, v18
v_mfma_f32_16x16x32_bf16 v[152:155], a[80:83], a[0:3], v[152:155]
ds_read_b64_tr_b16 a[104:105], v15 offset:4096
v_and_b32 v18, 0xffff0000, v18
v_mfma_f32_16x16x32_bf16 v[152:155], a[84:87], a[16:19], v[152:155]
ds_read_b64_tr_b16 a[106:107], v15 offset:4352
v_accvgpr_read_b32 v21, a131
v_mfma_f32_16x16x32_bf16 v[160:163], a[84:87], a[20:23], v[160:163]
ds_read_b64_tr_b16 a[108:109], v15 offset:6144
s_add_u32 m0, s16, 0x9400
v_mfma_f32_16x16x32_bf16 v[160:163], a[80:83], a[4:7], v[160:163]
buffer_load_dwordx4 v23, s[44:47], s22 offen lds
v_mfma_f32_16x16x32_bf16 v[168:171], a[80:83], a[8:11], v[168:171]
ds_read_b64_tr_b16 a[110:111], v15 offset:6400
v_lshlrev_b32 v20, 16, v21
v_mfma_f32_16x16x32_bf16 v[168:171], a[84:87], a[24:27], v[168:171]
v_and_b32 v21, 0xffff0000, v21
v_fmac_f32 v2, v1, v20
v_mfma_f32_16x16x32_bf16 v[176:179], a[84:87], a[28:31], v[176:179]
v_fmac_f32 v2, v18, v21
v_accvgpr_read_b32 v21, a139
v_mfma_f32_16x16x32_bf16 v[176:179], a[80:83], a[12:15], v[176:179]
v_lshlrev_b32 v20, 16, v21
v_and_b32 v21, 0xffff0000, v21
v_mfma_f32_16x16x32_bf16 v[180:183], a[88:91], a[12:15], v[180:183]
ds_read_b64_tr_b16 a[80:81], v14 offset:8192
v_fmac_f32 v3, v1, v20
v_mfma_f32_16x16x32_bf16 v[180:183], a[92:95], a[28:31], v[180:183]
ds_read_b64_tr_b16 a[82:83], v14 offset:8448
s_add_u32 m0, s16, 0x9800
v_mfma_f32_16x16x32_bf16 v[172:175], a[92:95], a[24:27], v[172:175]
buffer_load_dwordx4 v22, s[44:47], s23 offen lds
v_mfma_f32_16x16x32_bf16 v[172:175], a[88:91], a[8:11], v[172:175]
ds_read_b64_tr_b16 a[84:85], v14 offset:10240
v_fmac_f32 v3, v18, v21
v_mfma_f32_16x16x32_bf16 v[164:167], a[88:91], a[4:7], v[164:167]
ds_read_b64_tr_b16 a[86:87], v14 offset:10496
s_waitcnt vmcnt(14)
v_accvgpr_read_b32 v18, a148
v_mfma_f32_16x16x32_bf16 v[164:167], a[92:95], a[20:23], v[164:167]
v_lshlrev_b32 v1, 16, v18
v_and_b32 v18, 0xffff0000, v18
v_mfma_f32_16x16x32_bf16 v[156:159], a[92:95], a[16:19], v[156:159]
v_accvgpr_read_b32 v21, a132
v_lshlrev_b32 v20, 16, v21
v_mfma_f32_16x16x32_bf16 v[156:159], a[88:91], a[0:3], v[156:159]
s_waitcnt lgkmcnt(4)
v_and_b32 v21, 0xffff0000, v21
v_fmac_f32 v2, v1, v20
v_mfma_f32_16x16x32_bf16 v[184:187], a[96:99], a[0:3], v[184:187]
ds_read_b64_tr_b16 a[88:89], v15 offset:8192
s_add_u32 m0, s16, 0x9c00
v_mfma_f32_16x16x32_bf16 v[184:187], a[100:103], a[16:19], v[184:187]
buffer_load_dwordx4 v23, s[44:47], s23 offen lds
v_mfma_f32_16x16x32_bf16 v[192:195], a[100:103], a[20:23], v[192:195]
ds_read_b64_tr_b16 a[90:91], v15 offset:8448
v_fmac_f32 v2, v18, v21
v_mfma_f32_16x16x32_bf16 v[192:195], a[96:99], a[4:7], v[192:195]
ds_read_b64_tr_b16 a[92:93], v15 offset:10240
v_accvgpr_read_b32 v21, a140
v_mfma_f32_16x16x32_bf16 v[200:203], a[96:99], a[8:11], v[200:203]
ds_read_b64_tr_b16 a[94:95], v15 offset:10496
v_add_u32 v12, 0xffff0000, v12
v_mfma_f32_16x16x32_bf16 v[200:203], a[100:103], a[24:27], v[200:203]
v_add_u32 v13, 0xffff0000, v13
v_add_u32 v14, 0xffff0000, v14
v_mfma_f32_16x16x32_bf16 v[208:211], a[100:103], a[28:31], v[208:211]
v_add_u32 v15, 0xffff0000, v15
v_lshlrev_b32 v20, 16, v21
v_mfma_f32_16x16x32_bf16 v[208:211], a[96:99], a[12:15], v[208:211]
v_and_b32 v21, 0xffff0000, v21
v_fmac_f32 v3, v1, v20
v_mfma_f32_16x16x32_bf16 v[212:215], a[104:107], a[12:15], v[212:215]
s_waitcnt vmcnt(25) lgkmcnt(0)
v_fmac_f32 v3, v18, v21
v_accvgpr_read_b32 v18, a149
v_mfma_f32_16x16x32_bf16 v[212:215], a[108:111], a[28:31], v[212:215]
s_barrier
s_add_u32 m0, s17, 0x10000
v_lshlrev_b32 v1, 16, v18
v_mfma_f32_16x16x32_bf16 v[204:207], a[108:111], a[24:27], v[204:207]
buffer_load_dwordx4 v5, s[52:55], 0 offen lds
v_mfma_f32_16x16x32_bf16 v[204:207], a[104:107], a[8:11], v[204:207]
ds_read_b64_tr_b16 a[96:97], v12 offset:0
v_and_b32 v18, 0xffff0000, v18
v_mfma_f32_16x16x32_bf16 v[196:199], a[104:107], a[4:7], v[196:199]
ds_read_b64_tr_b16 a[98:99], v12 offset:1024
v_accvgpr_read_b32 v21, a133
v_mfma_f32_16x16x32_bf16 v[196:199], a[108:111], a[20:23], v[196:199]
ds_read_b64_tr_b16 a[100:101], v12 offset:8192
v_lshlrev_b32 v20, 16, v21
v_mfma_f32_16x16x32_bf16 v[188:191], a[108:111], a[16:19], v[188:191]
ds_read_b64_tr_b16 a[102:103], v12 offset:9216
v_and_b32 v21, 0xffff0000, v21
v_mfma_f32_16x16x32_bf16 v[188:191], a[104:107], a[0:3], v[188:191]
s_waitcnt lgkmcnt(4)
v_fmac_f32 v2, v1, v20
v_fmac_f32 v2, v18, v21
v_mfma_f32_16x16x32_bf16 v[216:219], a[0:3], a[80:83], v[216:219]
ds_read_b64_tr_b16 a[104:105], v13 offset:0
v_accvgpr_read_b32 v21, a141
v_mfma_f32_16x16x32_bf16 v[216:219], a[16:19], a[84:87], v[216:219]
ds_read_b64_tr_b16 a[106:107], v13 offset:1024
s_add_u32 m0, s17, 0x10400
v_mfma_f32_16x16x32_bf16 v[224:227], a[20:23], a[84:87], v[224:227]
buffer_load_dwordx4 v5, s[52:55], s13 offen lds
v_mfma_f32_16x16x32_bf16 v[224:227], a[4:7], a[80:83], v[224:227]
ds_read_b64_tr_b16 a[108:109], v13 offset:8192
v_lshlrev_b32 v20, 16, v21
v_mfma_f32_16x16x32_bf16 v[232:235], a[8:11], a[80:83], v[232:235]
ds_read_b64_tr_b16 a[110:111], v13 offset:9216
v_and_b32 v21, 0xffff0000, v21
v_mfma_f32_16x16x32_bf16 v[232:235], a[24:27], a[84:87], v[232:235]
s_lshl_b32 s15, s2, 2
v_fmac_f32 v3, v1, v20
v_fmac_f32 v3, v18, v21
v_mfma_f32_16x16x32_bf16 v[240:243], a[28:31], a[84:87], v[240:243]
s_add_u32 s15, s15, s4
v_accvgpr_read_b32 v18, a150
v_lshlrev_b32 v1, 16, v18
v_mfma_f32_16x16x32_bf16 v[240:243], a[12:15], a[80:83], v[240:243]
s_lshl_b32 s15, s15, 12
v_and_b32 v18, 0xffff0000, v18
v_accvgpr_read_b32 v21, a134
v_mfma_f32_16x16x32_bf16 v[244:247], a[12:15], a[88:91], v[244:247]
ds_read_b64_tr_b16 a[80:81], v12 offset:256
v_lshlrev_b32 v20, 16, v21
v_mfma_f32_16x16x32_bf16 v[244:247], a[28:31], a[92:95], v[244:247]
ds_read_b64_tr_b16 a[82:83], v12 offset:1280
v_and_b32 v21, 0xffff0000, v21
v_mfma_f32_16x16x32_bf16 v[236:239], a[24:27], a[92:95], v[236:239]
ds_read_b64_tr_b16 a[84:85], v12 offset:8448
s_add_u32 m0, s17, 0x10800
v_mfma_f32_16x16x32_bf16 v[236:239], a[8:11], a[88:91], v[236:239]
buffer_load_dwordx4 v6, s[52:55], 0 offen lds
v_mfma_f32_16x16x32_bf16 v[228:231], a[4:7], a[88:91], v[228:231]
ds_read_b64_tr_b16 a[86:87], v12 offset:9472
v_fmac_f32 v2, v1, v20
v_mfma_f32_16x16x32_bf16 v[228:231], a[20:23], a[92:95], v[228:231]
s_add_u32 s15, s15, 0x3800000
v_fmac_f32 v2, v18, v21
v_accvgpr_read_b32 v21, a142
v_mfma_f32_16x16x32_bf16 v[220:223], a[16:19], a[92:95], v[220:223]
v_lshlrev_b32 v20, 16, v21
v_and_b32 v21, 0xffff0000, v21
v_mfma_f32_16x16x32_bf16 v[220:223], a[0:3], a[88:91], v[220:223]
s_waitcnt lgkmcnt(4)
v_fmac_f32 v3, v1, v20
v_fmac_f32 v3, v18, v21
L_S21:
v_mfma_f32_16x16x32_bf16 v[24:27], a[96:99], a[32:35], v[24:27]
ds_read_b64_tr_b16 a[88:89], v13 offset:256
s_waitcnt vmcnt(19)
v_mfma_f32_16x16x32_bf16 v[24:27], a[100:103], a[48:51], v[24:27]
ds_read_b64_tr_b16 a[90:91], v13 offset:1280
v_accvgpr_read_b32 v18, a151
v_mfma_f32_16x16x32_bf16 v[32:35], a[100:103], a[52:55], v[32:35]
ds_read_b64_tr_b16 a[92:93], v13 offset:8448
s_add_u32 m0, s17, 0x10c00
v_mfma_f32_16x16x32_bf16 v[32:35], a[96:99], a[36:39], v[32:35]
buffer_load_dwordx4 v6, s[52:55], s13 offen lds
v_mfma_f32_16x16x32_bf16 v[40:43], a[96:99], a[40:43], v[40:43]
ds_read_b64_tr_b16 a[94:95], v13 offset:9472
v_lshlrev_b32 v1, 16, v18
v_mfma_f32_16x16x32_bf16 v[40:43], a[100:103], a[56:59], v[40:43]
ds_read_b128 a[0:3], v8 offset:0
v_and_b32 v18, 0xffff0000, v18
v_mfma_f32_16x16x32_bf16 v[48:51], a[100:103], a[60:63], v[48:51]
ds_read_b128 a[16:19], v9 offset:0
v_accvgpr_read_b32 v21, a135
v_mfma_f32_16x16x32_bf16 v[48:51], a[96:99], a[44:47], v[48:51]
ds_read_b128 a[4:7], v8 offset:2048
v_lshlrev_b32 v20, 16, v21
v_mfma_f32_16x16x32_bf16 v[52:55], a[104:107], a[44:47], v[52:55]
ds_read_b64_tr_b16 a[96:97], v12 offset:512
v_and_b32 v21, 0xffff0000, v21
v_mfma_f32_16x16x32_bf16 v[52:55], a[108:111], a[60:63], v[52:55]
ds_read_b64_tr_b16 a[98:99], v12 offset:1536
v_fmac_f32 v2, v1, v20
v_mfma_f32_16x16x32_bf16 v[44:47], a[108:111], a[56:59], v[44:47]
ds_read_b64_tr_b16 a[100:101], v12 offset:8704
v_fmac_f32 v2, v18, v21
v_mfma_f32_16x16x32_bf16 v[44:47], a[104:107], a[40:43], v[44:47]
ds_read_b64_tr_b16 a[102:103], v12 offset:9728
s_add_u32 m0, s18, 0x14000
v_mfma_f32_16x16x32_bf16 v[36:39], a[104:107], a[36:39], v[36:39]
buffer_load_dwordx4 v7, s[68:71], 0 offen lds
v_mfma_f32_16x16x32_bf16 v[36:39], a[108:111], a[52:55], v[36:39]
ds_read_b128 a[20:23], v9 offset:2048
v_accvgpr_read_b32 v21, a143
v_mfma_f32_16x16x32_bf16 v[28:31], a[108:111], a[48:51], v[28:31]
ds_read_b128 a[8:11], v8 offset:4096
v_lshlrev_b32 v20, 16, v21
v_mfma_f32_16x16x32_bf16 v[28:31], a[104:107], a[32:35], v[28:31]
ds_read_b128 a[24:27], v9 offset:4096
s_waitcnt lgkmcnt(10)
v_mfma_f32_16x16x32_bf16 v[56:59], a[80:83], a[32:35], v[56:59]
ds_read_b64_tr_b16 a[104:105], v13 offset:512
v_and_b32 v21, 0xffff0000, v21
v_mfma_f32_16x16x32_bf16 v[56:59], a[84:87], a[48:51], v[56:59]
ds_read_b64_tr_b16 a[106:107], v13 offset:1536
v_fmac_f32 v3, v1, v20
v_mfma_f32_16x16x32_bf16 v[64:67], a[84:87], a[52:55], v[64:67]
ds_read_b64_tr_b16 a[108:109], v13 offset:8704
v_fmac_f32 v3, v18, v21
v_mfma_f32_16x16x32_bf16 v[64:67], a[80:83], a[36:39], v[64:67]
ds_read_b64_tr_b16 a[110:111], v13 offset:9728
s_add_u32 m0, s18, 0x15000
v_mfma_f32_16x16x32_bf16 v[72:75], a[80:83], a[40:43], v[72:75]
buffer_load_dwordx4 v7, s[68:71], s25 offen lds
v_mfma_f32_16x16x32_bf16 v[72:75], a[84:87], a[56:59], v[72:75]
ds_read_b128 a[12:15], v8 offset:6144
v_add_f32_dpp v2, v2, v2 row_ror:8 row_mask:0xf bank_mask:0xf
v_mfma_f32_16x16x32_bf16 v[80:83], a[84:87], a[60:63], v[80:83]
ds_read_b128 a[28:31], v9 offset:6144
v_add_f32_dpp v3, v3, v3 row_ror:8 row_mask:0xf bank_mask:0xf
v_mfma_f32_16x16x32_bf16 v[80:83], a[80:83], a[44:47], v[80:83]
v_add_f32_dpp v2, v2, v2 row_ror:4 row_mask:0xf bank_mask:0xf
v_add_f32_dpp v3, v3, v3 row_ror:4 row_mask:0xf bank_mask:0xf
v_mfma_f32_16x16x32_bf16 v[84:87], a[88:91], a[44:47], v[84:87]
ds_read_b64_tr_b16 a[80:81], v12 offset:768
v_add_f32_dpp v2, v2, v2 row_ror:2 row_mask:0xf bank_mask:0xf
v_mfma_f32_16x16x32_bf16 v[84:87], a[92:95], a[60:63], v[84:87]
ds_read_b64_tr_b16 a[82:83], v12 offset:1792
v_add_f32_dpp v3, v3, v3 row_ror:2 row_mask:0xf bank_mask:0xf
v_mfma_f32_16x16x32_bf16 v[76:79], a[92:95], a[56:59], v[76:79]
ds_read_b64_tr_b16 a[84:85], v12 offset:8960
v_add_f32_dpp v2, v2, v2 row_ror:1 row_mask:0xf bank_mask:0xf
v_mfma_f32_16x16x32_bf16 v[76:79], a[88:91], a[40:43], v[76:79]
ds_read_b64_tr_b16 a[86:87], v12 offset:9984
v_add_f32_dpp v3, v3, v3 row_ror:1 row_mask:0xf bank_mask:0xf
v_mfma_f32_16x16x32_bf16 v[68:71], a[88:91], a[36:39], v[68:71]
s_add_u32 m0, s18, 0x16000
v_mov_b32 v1, v2
v_mov_b32 v18, v3
v_mfma_f32_16x16x32_bf16 v[68:71], a[92:95], a[52:55], v[68:71]
buffer_load_dwordx4 v7, s[68:71], s26 offen lds
v_mfma_f32_16x16x32_bf16 v[60:63], a[92:95], a[48:51], v[60:63]
v_permlane16_swap_b32 v1, v2
v_permlane16_swap_b32 v18, v3
v_mfma_f32_16x16x32_bf16 v[60:63], a[88:91], a[32:35], v[60:63]
s_waitcnt lgkmcnt(6)
v_add_f32 v2, v2, v1
v_add_f32 v3, v3, v18
v_mfma_f32_16x16x32_bf16 v[88:91], a[96:99], a[32:35], v[88:91]
ds_read_b64_tr_b16 a[88:89], v13 offset:768
v_mov_b32 v1, v2
v_mfma_f32_16x16x32_bf16 v[88:91], a[100:103], a[48:51], v[88:91]
ds_read_b64_tr_b16 a[90:91], v13 offset:1792
v_mov_b32 v18, v3
v_mfma_f32_16x16x32_bf16 v[96:99], a[100:103], a[52:55], v[96:99]
ds_read_b64_tr_b16 a[92:93], v13 offset:8960
v_permlane32_swap_b32 v1, v2
v_mfma_f32_16x16x32_bf16 v[96:99], a[96:99], a[36:39], v[96:99]
ds_read_b64_tr_b16 a[94:95], v13 offset:9984
v_permlane32_swap_b32 v18, v3
v_mfma_f32_16x16x32_bf16 v[104:107], a[96:99], a[40:43], v[104:107]
v_add_f32 v2, v2, v1
v_add_f32 v3, v3, v18
v_mfma_f32_16x16x32_bf16 v[104:107], a[100:103], a[56:59], v[104:107]
buffer_load_dword v23, off, s[84:87], s10 sc1
v_mfma_f32_16x16x32_bf16 v[112:115], a[100:103], a[60:63], v[112:115]
v_mul_f32 v2, 0xbfb8aa3b, v2
v_mul_f32 v3, 0xbfb8aa3b, v3
v_mfma_f32_16x16x32_bf16 v[112:115], a[96:99], a[44:47], v[112:115]
v_exp_f32 v2, v2
v_mfma_f32_16x16x32_bf16 v[116:119], a[104:107], a[44:47], v[116:119]
ds_read_b64_tr_b16 a[96:97], v14 offset:0
v_mfma_f32_16x16x32_bf16 v[116:119], a[108:111], a[60:63], v[116:119]
ds_read_b64_tr_b16 a[98:99], v14 offset:256
v_mfma_f32_16x16x32_bf16 v[108:111], a[108:111], a[56:59], v[108:111]
ds_read_b64_tr_b16 a[100:101], v14 offset:2048
v_mfma_f32_16x16x32_bf16 v[108:111], a[104:107], a[40:43], v[108:111]
ds_read_b64_tr_b16 a[102:103], v14 offset:2304
v_mfma_f32_16x16x32_bf16 v[100:103], a[104:107], a[36:39], v[100:103]
v_exp_f32 v3, v3
v_mfma_f32_16x16x32_bf16 v[100:103], a[108:111], a[52:55], v[100:103]
v_add_f32 v2, 1.0, v2
v_add_f32 v3, 1.0, v3
v_mfma_f32_16x16x32_bf16 v[92:95], a[108:111], a[48:51], v[92:95]
v_rcp_f32 v2, v2
v_mfma_f32_16x16x32_bf16 v[92:95], a[104:107], a[32:35], v[92:95]
s_waitcnt lgkmcnt(4)
v_rcp_f32 v3, v3
v_mfma_f32_16x16x32_bf16 v[120:123], a[80:83], a[32:35], v[120:123]
ds_read_b64_tr_b16 a[104:105], v15 offset:0
v_mfma_f32_16x16x32_bf16 v[120:123], a[84:87], a[48:51], v[120:123]
ds_read_b64_tr_b16 a[106:107], v15 offset:256
v_mfma_f32_16x16x32_bf16 v[128:131], a[84:87], a[52:55], v[128:131]
ds_read_b64_tr_b16 a[108:109], v15 offset:2048
v_mfma_f32_16x16x32_bf16 v[128:131], a[80:83], a[36:39], v[128:131]
ds_read_b64_tr_b16 a[110:111], v15 offset:2304
v_mfma_f32_16x16x32_bf16 v[136:139], a[80:83], a[40:43], v[136:139]
buffer_store_dwordx2 v[2:3], off, s[88:91], s101 sc1
v_mfma_f32_16x16x32_bf16 v[136:139], a[84:87], a[56:59], v[136:139]
v_mfma_f32_16x16x32_bf16 v[144:147], a[84:87], a[60:63], v[144:147]
v_mfma_f32_16x16x32_bf16 v[144:147], a[80:83], a[44:47], v[144:147]
v_mfma_f32_16x16x32_bf16 v[148:151], a[88:91], a[44:47], v[148:151]
ds_read_b64_tr_b16 a[80:81], v14 offset:4096
v_mfma_f32_16x16x32_bf16 v[148:151], a[92:95], a[60:63], v[148:151]
ds_read_b64_tr_b16 a[82:83], v14 offset:4352
v_mfma_f32_16x16x32_bf16 v[140:143], a[92:95], a[56:59], v[140:143]
ds_read_b64_tr_b16 a[84:85], v14 offset:6144
v_mfma_f32_16x16x32_bf16 v[140:143], a[88:91], a[40:43], v[140:143]
ds_read_b64_tr_b16 a[86:87], v14 offset:6400
v_mfma_f32_16x16x32_bf16 v[132:135], a[88:91], a[36:39], v[132:135]
v_mfma_f32_16x16x32_bf16 v[132:135], a[92:95], a[52:55], v[132:135]
v_mfma_f32_16x16x32_bf16 v[124:127], a[92:95], a[48:51], v[124:127]
v_mfma_f32_16x16x32_bf16 v[124:127], a[88:91], a[32:35], v[124:127]
s_waitcnt lgkmcnt(4)
v_mfma_f32_16x16x32_bf16 v[152:155], a[96:99], a[32:35], v[152:155]
ds_read_b64_tr_b16 a[88:89], v15 offset:4096
v_mfma_f32_16x16x32_bf16 v[152:155], a[100:103], a[48:51], v[152:155]
ds_read_b64_tr_b16 a[90:91], v15 offset:4352
v_mfma_f32_16x16x32_bf16 v[160:163], a[100:103], a[52:55], v[160:163]
ds_read_b64_tr_b16 a[92:93], v15 offset:6144
v_mfma_f32_16x16x32_bf16 v[160:163], a[96:99], a[36:39], v[160:163]
ds_read_b64_tr_b16 a[94:95], v15 offset:6400
v_mfma_f32_16x16x32_bf16 v[168:171], a[96:99], a[40:43], v[168:171]
v_mfma_f32_16x16x32_bf16 v[168:171], a[100:103], a[56:59], v[168:171]
v_mfma_f32_16x16x32_bf16 v[176:179], a[100:103], a[60:63], v[176:179]
v_mfma_f32_16x16x32_bf16 v[176:179], a[96:99], a[44:47], v[176:179]
v_mfma_f32_16x16x32_bf16 v[180:183], a[104:107], a[44:47], v[180:183]
ds_read_b64_tr_b16 a[96:97], v14 offset:8192
v_mfma_f32_16x16x32_bf16 v[180:183], a[108:111], a[60:63], v[180:183]
ds_read_b64_tr_b16 a[98:99], v14 offset:8448
v_mfma_f32_16x16x32_bf16 v[172:175], a[108:111], a[56:59], v[172:175]
ds_read_b64_tr_b16 a[100:101], v14 offset:10240
v_mfma_f32_16x16x32_bf16 v[172:175], a[104:107], a[40:43], v[172:175]
ds_read_b64_tr_b16 a[102:103], v14 offset:10496
v_mfma_f32_16x16x32_bf16 v[164:167], a[104:107], a[36:39], v[164:167]
v_mfma_f32_16x16x32_bf16 v[164:167], a[108:111], a[52:55], v[164:167]
v_mfma_f32_16x16x32_bf16 v[156:159], a[108:111], a[48:51], v[156:159]
v_mfma_f32_16x16x32_bf16 v[156:159], a[104:107], a[32:35], v[156:159]
s_waitcnt lgkmcnt(4)
v_mfma_f32_16x16x32_bf16 v[184:187], a[80:83], a[32:35], v[184:187]
ds_read_b64_tr_b16 a[104:105], v15 offset:8192
v_mfma_f32_16x16x32_bf16 v[184:187], a[84:87], a[48:51], v[184:187]
ds_read_b64_tr_b16 a[106:107], v15 offset:8448
v_mfma_f32_16x16x32_bf16 v[192:195], a[84:87], a[52:55], v[192:195]
ds_read_b64_tr_b16 a[108:109], v15 offset:10240
v_mfma_f32_16x16x32_bf16 v[192:195], a[80:83], a[36:39], v[192:195]
ds_read_b64_tr_b16 a[110:111], v15 offset:10496
v_add_u32 v12, 0x8000, v12
v_mfma_f32_16x16x32_bf16 v[200:203], a[80:83], a[40:43], v[200:203]
v_add_u32 v13, 0x8000, v13
v_add_u32 v14, 0x8000, v14
v_mfma_f32_16x16x32_bf16 v[200:203], a[84:87], a[56:59], v[200:203]
v_add_u32 v15, 0x8000, v15
v_mfma_f32_16x16x32_bf16 v[208:211], a[84:87], a[60:63], v[208:211]
v_mfma_f32_16x16x32_bf16 v[208:211], a[80:83], a[44:47], v[208:211]
v_mfma_f32_16x16x32_bf16 v[212:215], a[88:91], a[44:47], v[212:215]
s_waitcnt vmcnt(1) lgkmcnt(0)
s_mov_b32 s92, 200000
L_spin_kv:
v_readfirstlane_b32 s93, v23
s_nop 1
s_cmp_ge_u32 s93, 8
s_cbranch_scc1 L_spun_kv
s_sub_u32 s92, s92, 1
s_cbranch_scc1 L_spun_kv
s_sleep 4
buffer_load_dword v23, off, s[84:87], s10 sc1
s_waitcnt vmcnt(0)
s_branch L_spin_kv
L_spun_kv:
v_mfma_f32_16x16x32_bf16 v[212:215], a[92:95], a[60:63], v[212:215]
s_barrier
s_add_u32 m0, s19, 0x0
v_mfma_f32_16x16x32_bf16 v[204:207], a[92:95], a[56:59], v[204:207]
buffer_load_dwordx4 v16, s[48:51], s32 offen offset:0 sc1 lds
v_mfma_f32_16x16x32_bf16 v[204:207], a[88:91], a[40:43], v[204:207]
ds_read_b64_tr_b16 a[80:81], v12 offset:0
v_mov_b32 v3, v16
v_mfma_f32_16x16x32_bf16 v[196:199], a[88:91], a[36:39], v[196:199]
ds_read_b64_tr_b16 a[82:83], v12 offset:1024
v_mov_b32 v22, 0x3f803f80
v_mfma_f32_16x16x32_bf16 v[196:199], a[92:95], a[52:55], v[196:199]
ds_read_b64_tr_b16 a[84:85], v12 offset:8192
s_mov_b32 s33, 0
v_mfma_f32_16x16x32_bf16 v[188:191], a[92:95], a[48:51], v[188:191]
ds_read_b64_tr_b16 a[86:87], v12 offset:9216
v_accvgpr_write_b32 a240, v22
v_mfma_f32_16x16x32_bf16 v[188:191], a[88:91], a[32:35], v[188:191]
s_waitcnt lgkmcnt(4)
v_accvgpr_write_b32 a241, v22
v_accvgpr_write_b32 a242, v22
v_mfma_f32_16x16x32_bf16 v[216:219], a[32:35], a[96:99], v[216:219]
buffer_load_dwordx4 v16, s[48:51], s32 offen offset:1024 sc1 lds
v_accvgpr_write_b32 a243, v22
v_mfma_f32_16x16x32_bf16 v[216:219], a[48:51], a[100:103], v[216:219]
ds_read_b64_tr_b16 a[88:89], v13 offset:0
s_mov_b32 s36, 0x33333333
v_mfma_f32_16x16x32_bf16 v[224:227], a[52:55], a[100:103], v[224:227]
ds_read_b64_tr_b16 a[90:91], v13 offset:1024
s_mov_b32 s37, 0xcccccccc
v_mfma_f32_16x16x32_bf16 v[224:227], a[36:39], a[96:99], v[224:227]
ds_read_b64_tr_b16 a[92:93], v13 offset:8192
v_cndmask_b32 v4, 0, v22, s[36:37]
v_mfma_f32_16x16x32_bf16 v[232:235], a[40:43], a[96:99], v[232:235]
ds_read_b64_tr_b16 a[94:95], v13 offset:9216
v_accvgpr_write_b32 a232, v4
v_mfma_f32_16x16x32_bf16 v[232:235], a[56:59], a[100:103], v[232:235]
v_accvgpr_write_b32 a233, v4
v_accvgpr_write_b32 a234, v4
v_mfma_f32_16x16x32_bf16 v[240:243], a[60:63], a[100:103], v[240:243]
v_accvgpr_write_b32 a235, v4
v_mfma_f32_16x16x32_bf16 v[240:243], a[44:47], a[96:99], v[240:243]
buffer_load_dwordx4 v16, s[48:51], s32 offen offset:2048 sc1 lds
v_mfma_f32_16x16x32_bf16 v[244:247], a[44:47], a[104:107], v[244:247]
ds_read_b64_tr_b16 a[96:97], v12 offset:256
s_mov_b32 s36, 0x44444444
s_mov_b32 s37, 0x44444444
v_mfma_f32_16x16x32_bf16 v[244:247], a[60:63], a[108:111], v[244:247]
ds_read_b64_tr_b16 a[98:99], v12 offset:1280
v_cndmask_b32 v4, 0, v22, s[36:37]
v_mfma_f32_16x16x32_bf16 v[236:239], a[56:59], a[108:111], v[236:239]
ds_read_b64_tr_b16 a[100:101], v12 offset:8448
v_accvgpr_write_b32 a236, v4
v_mfma_f32_16x16x32_bf16 v[236:239], a[40:43], a[104:107], v[236:239]
ds_read_b64_tr_b16 a[102:103], v12 offset:9472
v_accvgpr_write_b32 a237, v4
v_mfma_f32_16x16x32_bf16 v[228:231], a[36:39], a[104:107], v[228:231]
v_accvgpr_write_b32 a238, v4
v_accvgpr_write_b32 a239, v4
v_mfma_f32_16x16x32_bf16 v[228:231], a[52:55], a[108:111], v[228:231]
v_mov_b32 v1, v3
v_add_u32 v2, 98304, v3
v_mfma_f32_16x16x32_bf16 v[220:223], a[48:51], a[108:111], v[220:223]
buffer_load_dwordx4 v16, s[48:51], s32 offen offset:3072 sc1 lds
v_mfma_f32_16x16x32_bf16 v[220:223], a[32:35], a[104:107], v[220:223]
s_waitcnt lgkmcnt(4)
s_mov_b64 s[34:35], 0
v_accvgpr_write_b32 a224, 0
L_S22:
v_mfma_f32_16x16x32_bf16 v[24:27], a[80:83], a[0:3], v[24:27]
ds_read_b64_tr_b16 a[104:105], v13 offset:256
s_waitcnt vmcnt(13)
v_accvgpr_write_b32 a225, 0
v_mfma_f32_16x16x32_bf16 v[24:27], a[84:87], a[16:19], v[24:27]
ds_read_b64_tr_b16 a[106:107], v13 offset:1280
v_accvgpr_write_b32 a226, 0
v_mfma_f32_16x16x32_bf16 v[32:35], a[84:87], a[20:23], v[32:35]
ds_read_b64_tr_b16 a[108:109], v13 offset:8448
v_accvgpr_write_b32 a227, 0
v_mfma_f32_16x16x32_bf16 v[32:35], a[80:83], a[4:7], v[32:35]
ds_read_b64_tr_b16 a[110:111], v13 offset:9472
v_accvgpr_write_b32 a228, 0
v_mfma_f32_16x16x32_bf16 v[40:43], a[80:83], a[8:11], v[40:43]
ds_read_b128 a[32:35], v8 offset:32768
s_add_u32 m0, s19, 0x1000
v_mfma_f32_16x16x32_bf16 v[40:43], a[84:87], a[24:27], v[40:43]
buffer_load_dwordx4 v16, s[48:51], s7 offen offset:0 sc1 lds
v_mfma_f32_16x16x32_bf16 v[48:51], a[84:87], a[28:31], v[48:51]
ds_read_b128 a[48:51], v9 offset:32768
v_accvgpr_write_b32 a229, 0
v_mfma_f32_16x16x32_bf16 v[48:51], a[80:83], a[12:15], v[48:51]
ds_read_b128 a[36:39], v8 offset:34816
v_accvgpr_write_b32 a230, 0
v_mfma_f32_16x16x32_bf16 v[52:55], a[88:91], a[12:15], v[52:55]
ds_read_b64_tr_b16 a[80:81], v12 offset:512
v_accvgpr_write_b32 a231, 0
v_mfma_f32_16x16x32_bf16 v[52:55], a[92:95], a[28:31], v[52:55]
ds_read_b64_tr_b16 a[82:83], v12 offset:1536
L_padA11:
s_cmp_eq_u32 s95, 1
s_cbranch_scc1 L_hopA_ret
s_mul_i32 s8, s6, 0x142400
v_mfma_f32_16x16x32_bf16 v[44:47], a[92:95], a[24:27], v[44:47]
ds_read_b64_tr_b16 a[84:85], v12 offset:8704
s_sub_u32 s9, 0x12e1c00, s8
v_mfma_f32_16x16x32_bf16 v[44:47], a[88:91], a[8:11], v[44:47]
buffer_load_dwordx4 v16, s[48:51], s7 offen offset:1024 sc1 lds
v_mfma_f32_16x16x32_bf16 v[36:39], a[88:91], a[4:7], v[36:39]
ds_read_b64_tr_b16 a[86:87], v12 offset:9728
s_lshl_b32 s11, s5, 13
v_mfma_f32_16x16x32_bf16 v[36:39], a[92:95], a[20:23], v[36:39]
ds_read_b128 a[52:55], v9 offset:34816
s_add_u32 s11, s11, 0x2200000
v_mfma_f32_16x16x32_bf16 v[28:31], a[92:95], a[16:19], v[28:31]
ds_read_b128 a[40:43], v8 offset:36864
s_add_u32 s8, s8, s11
v_mfma_f32_16x16x32_bf16 v[28:31], a[88:91], a[0:3], v[28:31]
ds_read_b128 a[56:59], v9 offset:36864
s_waitcnt lgkmcnt(10)
v_mfma_f32_16x16x32_bf16 v[56:59], a[96:99], a[0:3], v[56:59]
ds_read_b64_tr_b16 a[88:89], v13 offset:512
s_add_u32 s9, s9, s11
s_lshl_b32 s11, s4, 10
v_mfma_f32_16x16x32_bf16 v[56:59], a[100:103], a[16:19], v[56:59]
ds_read_b64_tr_b16 a[90:91], v13 offset:1536
s_add_u32 s44, s8, s11
v_mfma_f32_16x16x32_bf16 v[64:67], a[100:103], a[20:23], v[64:67]
buffer_load_dwordx4 v16, s[48:51], s7 offen offset:2048 sc1 lds
v_mfma_f32_16x16x32_bf16 v[64:67], a[96:99], a[4:7], v[64:67]
ds_read_b64_tr_b16 a[92:93], v13 offset:8704
s_add_u32 s46, s9, s11
v_mfma_f32_16x16x32_bf16 v[72:75], a[96:99], a[8:11], v[72:75]
ds_read_b64_tr_b16 a[94:95], v13 offset:9728
s_sub_u32 s11, 0x1c00, s11
v_mfma_f32_16x16x32_bf16 v[72:75], a[100:103], a[24:27], v[72:75]
ds_read_b128 a[44:47], v8 offset:38912
s_add_u32 s45, s8, s11
v_mfma_f32_16x16x32_bf16 v[80:83], a[100:103], a[28:31], v[80:83]
ds_read_b128 a[60:63], v9 offset:38912
s_add_u32 s47, s9, s11
v_mfma_f32_16x16x32_bf16 v[80:83], a[96:99], a[12:15], v[80:83]
s_mul_i32 s8, s5, 0x6000
s_add_u32 s8, s8, 0x40000
s_add_u32 s28, s44, s8
v_mfma_f32_16x16x32_bf16 v[84:87], a[104:107], a[12:15], v[84:87]
ds_read_b64_tr_b16 a[96:97], v12 offset:768
s_add_u32 s29, s45, s8
s_add_u32 s30, s46, s8
v_mfma_f32_16x16x32_bf16 v[84:87], a[108:111], a[28:31], v[84:87]
buffer_load_dwordx4 v16, s[48:51], s7 offen offset:3072 sc1 lds
v_mfma_f32_16x16x32_bf16 v[76:79], a[108:111], a[24:27], v[76:79]
ds_read_b64_tr_b16 a[98:99], v12 offset:1792
s_add_u32 s32, s32, s94
v_mfma_f32_16x16x32_bf16 v[76:79], a[104:107], a[8:11], v[76:79]
ds_read_b64_tr_b16 a[100:101], v12 offset:8960
s_add_u32 s7, s7, s94
v_mfma_f32_16x16x32_bf16 v[68:71], a[104:107], a[4:7], v[68:71]
ds_read_b64_tr_b16 a[102:103], v12 offset:9984
s_add_u32 s31, s47, s8
v_mfma_f32_16x16x32_bf16 v[68:71], a[108:111], a[20:23], v[68:71]
s_lshl_b32 s8, s4, 11
s_add_u32 s9, s8, 131072
v_add_u32 v4, s9, v16
v_mfma_f32_16x16x32_bf16 v[60:63], a[108:111], a[16:19], v[60:63]
s_sub_u32 s9, 145408, s8
s_cmp_eq_u32 s4, 0
s_cselect_b32 s8, 131072, s9
v_mfma_f32_16x16x32_bf16 v[60:63], a[104:107], a[0:3], v[60:63]
s_add_u32 m0, s19, 0x18000
s_waitcnt lgkmcnt(6)
v_add_u32 v5, s8, v16
v_mfma_f32_16x16x32_bf16 v[88:91], a[80:83], a[0:3], v[88:91]
buffer_load_dwordx4 v16, s[48:51], s32 offen offset:0 sc1 lds
v_add_u32 v6, s9, v16
v_mfma_f32_16x16x32_bf16 v[88:91], a[84:87], a[16:19], v[88:91]
ds_read_b64_tr_b16 a[104:105], v13 offset:768
v_add_u32 v22, 0x800, v10
v_mfma_f32_16x16x32_bf16 v[96:99], a[84:87], a[20:23], v[96:99]
ds_read_b64_tr_b16 a[106:107], v13 offset:1792
s_mov_b32 s8, 0x800
v_mfma_f32_16x16x32_bf16 v[96:99], a[80:83], a[4:7], v[96:99]
ds_read_b64_tr_b16 a[108:109], v13 offset:8960
v_mfma_f32_16x16x32_bf16 v[104:107], a[80:83], a[8:11], v[104:107]
ds_read_b64_tr_b16 a[110:111], v13 offset:9984
v_mfma_f32_16x16x32_bf16 v[104:107], a[84:87], a[24:27], v[104:107]
s_cmp_eq_u32 s6, 0
s_cselect_b32 s8, 0xffff8800, s8
v_add_u32 v7, s8, v11
v_mfma_f32_16x16x32_bf16 v[112:115], a[84:87], a[28:31], v[112:115]
buffer_load_dwordx4 v16, s[48:51], s32 offen offset:1024 sc1 lds
v_mfma_f32_16x16x32_bf16 v[112:115], a[80:83], a[12:15], v[112:115]
s_bfe_u32 s99, s2, 0x20001
s_lshl_b32 s99, s99, 2
s_lshr_b32 s8, s2, 6
v_mfma_f32_16x16x32_bf16 v[116:119], a[88:91], a[12:15], v[116:119]
ds_read_b64_tr_b16 a[80:81], v14 offset:0
s_add_u32 s99, s99, s8
s_bfe_u32 s100, s2, 0x30003
v_mfma_f32_16x16x32_bf16 v[116:119], a[92:95], a[28:31], v[116:119]
ds_read_b64_tr_b16 a[82:83], v14 offset:256
s_and_b32 s14, s2, 1
v_mfma_f32_16x16x32_bf16 v[108:111], a[92:95], a[24:27], v[108:111]
ds_read_b64_tr_b16 a[84:85], v14 offset:2048
s_sub_u32 s24, 15, s99
v_mfma_f32_16x16x32_bf16 v[108:111], a[88:91], a[8:11], v[108:111]
ds_read_b64_tr_b16 a[86:87], v14 offset:2304
s_min_u32 s18, s24, s99
v_mfma_f32_16x16x32_bf16 v[100:103], a[88:91], a[4:7], v[100:103]
buffer_load_dwordx4 v16, s[48:51], s32 offen offset:2048 sc1 lds
v_mfma_f32_16x16x32_bf16 v[100:103], a[92:95], a[20:23], v[100:103]
s_lshl_b32 s24, s18, 1
s_add_u32 s24, s24, s14
s_lshl_b32 s24, s24, 8
v_mfma_f32_16x16x32_bf16 v[92:95], a[92:95], a[16:19], v[92:95]
s_add_u32 s24, s24, 0x3704000
s_mov_b32 s12, 14336
s_and_b32 s16, s6, 1
v_mfma_f32_16x16x32_bf16 v[92:95], a[88:91], a[0:3], v[92:95]
s_waitcnt lgkmcnt(4)
s_lshl_b32 s16, s16, 15
s_add_u32 s16, s16, 98304
v_mfma_f32_16x16x32_bf16 v[120:123], a[96:99], a[0:3], v[120:123]
ds_read_b64_tr_b16 a[88:89], v15 offset:0
s_add_u32 s16, s16, s17
s_lshl_b32 s13, s4, 15
v_mfma_f32_16x16x32_bf16 v[120:123], a[100:103], a[16:19], v[120:123]
ds_read_b64_tr_b16 a[90:91], v15 offset:256
s_lshl_b32 s9, s100, 8
v_mfma_f32_16x16x32_bf16 v[128:131], a[100:103], a[20:23], v[128:131]
buffer_load_dwordx4 v16, s[48:51], s32 offen offset:3072 sc1 lds
v_mfma_f32_16x16x32_bf16 v[128:131], a[96:99], a[4:7], v[128:131]
ds_read_b64_tr_b16 a[92:93], v15 offset:2048
s_add_u32 s13, s13, s9
v_mfma_f32_16x16x32_bf16 v[136:139], a[96:99], a[8:11], v[136:139]
ds_read_b64_tr_b16 a[94:95], v15 offset:2304
s_mul_i32 s9, s14, 1310848
v_mfma_f32_16x16x32_bf16 v[136:139], a[100:103], a[24:27], v[136:139]
s_add_u32 s13, s13, s9
s_mul_i32 s25, s14, 3407872
s_sub_u32 s25, s25, 1179648
v_mfma_f32_16x16x32_bf16 v[144:147], a[100:103], a[28:31], v[144:147]
s_mul_i32 s101, s99, 0x142400
s_lshl_b32 s8, s4, 11
s_add_u32 s101, s101, s8
v_mfma_f32_16x16x32_bf16 v[144:147], a[96:99], a[12:15], v[144:147]
s_add_u32 m0, s19, 0x19000
s_mul_i32 s8, s14, 163840
s_add_u32 s101, s101, s8
v_mfma_f32_16x16x32_bf16 v[148:151], a[104:107], a[12:15], v[148:151]
buffer_load_dwordx4 v16, s[48:51], s7 offen offset:0 sc1 lds
s_add_u32 s101, s101, 0x21fe000
v_mfma_f32_16x16x32_bf16 v[148:151], a[108:111], a[28:31], v[148:151]
ds_read_b64_tr_b16 a[96:97], v14 offset:4096
s_mul_i32 s26, s14, 425984
v_mfma_f32_16x16x32_bf16 v[140:143], a[108:111], a[24:27], v[140:143]
ds_read_b64_tr_b16 a[98:99], v14 offset:4352
s_add_u32 s26, s26, 106496
v_mfma_f32_16x16x32_bf16 v[140:143], a[104:107], a[8:11], v[140:143]
ds_read_b64_tr_b16 a[100:101], v14 offset:6144
s_mov_b32 s52, 0x3e0293ee
v_mfma_f32_16x16x32_bf16 v[132:135], a[104:107], a[4:7], v[132:135]
ds_read_b64_tr_b16 a[102:103], v14 offset:6400
s_mov_b32 s53, 0x3e0293ee
v_mfma_f32_16x16x32_bf16 v[132:135], a[108:111], a[20:23], v[132:135]
s_mov_b32 s54, 0x3e8293ee
s_or_b32 s55, s6, s4
s_cselect_b32 s55, 0, 0xf149f2ca
v_mfma_f32_16x16x32_bf16 v[124:127], a[108:111], a[16:19], v[124:127]
s_waitcnt lgkmcnt(4)
s_mov_b32 s56, 0x50000
s_mov_b32 s57, 0x5550055
v_mfma_f32_16x16x32_bf16 v[124:127], a[104:107], a[0:3], v[124:127]
buffer_load_dwordx4 v16, s[48:51], s7 offen offset:1024 sc1 lds
v_mfma_f32_16x16x32_bf16 v[152:155], a[80:83], a[0:3], v[152:155]
ds_read_b64_tr_b16 a[104:105], v15 offset:4096
s_mov_b32 s58, 0xa0000
s_mov_b32 s59, 0xaaa00aa
v_mfma_f32_16x16x32_bf16 v[152:155], a[84:87], a[16:19], v[152:155]
ds_read_b64_tr_b16 a[106:107], v15 offset:4352
s_mov_b32 s60, 0x150001
v_mfma_f32_16x16x32_bf16 v[160:163], a[84:87], a[20:23], v[160:163]
ds_read_b64_tr_b16 a[108:109], v15 offset:6144
s_mov_b32 s61, 0x15550155
v_mfma_f32_16x16x32_bf16 v[160:163], a[80:83], a[4:7], v[160:163]
ds_read_b64_tr_b16 a[110:111], v15 offset:6400
s_mov_b32 s62, 0x2a0002
v_mfma_f32_16x16x32_bf16 v[168:171], a[80:83], a[8:11], v[168:171]
s_mov_b32 s63, 0x2aaa02aa
s_mov_b32 s68, 0x55505555
s_mov_b32 s69, 0x50005500
v_mfma_f32_16x16x32_bf16 v[168:171], a[84:87], a[24:27], v[168:171]
buffer_load_dwordx4 v16, s[48:51], s7 offen offset:2048 sc1 lds
v_mfma_f32_16x16x32_bf16 v[176:179], a[84:87], a[28:31], v[176:179]
s_mov_b32 s70, 0xaaa0aaaa
s_mov_b32 s71, 0xa000aa00
s_mov_b32 s76, 0x55405554
v_mfma_f32_16x16x32_bf16 v[176:179], a[80:83], a[12:15], v[176:179]
s_mov_b32 s77, 0x40005400
s_mov_b32 s78, 0xaa80aaa8
s_mov_b32 s79, 0x8000a800
v_mfma_f32_16x16x32_bf16 v[180:183], a[88:91], a[12:15], v[180:183]
ds_read_b64_tr_b16 a[80:81], v14 offset:8192
s_mov_b32 s11, 0xf149f2ca
s_mov_b32 s36, 0xfff0ffff
v_mfma_f32_16x16x32_bf16 v[180:183], a[92:95], a[28:31], v[180:183]
ds_read_b64_tr_b16 a[82:83], v14 offset:8448
s_mov_b32 s37, 0xf000ff00
v_mfma_f32_16x16x32_bf16 v[172:175], a[92:95], a[24:27], v[172:175]
ds_read_b64_tr_b16 a[84:85], v14 offset:10240
s_mov_b32 s38, 0xffe0fffe
v_mfma_f32_16x16x32_bf16 v[172:175], a[88:91], a[8:11], v[172:175]
buffer_load_dwordx4 v16, s[48:51], s7 offen offset:3072 sc1 lds
v_mfma_f32_16x16x32_bf16 v[164:167], a[88:91], a[4:7], v[164:167]
ds_read_b64_tr_b16 a[86:87], v14 offset:10496
s_add_u32 s32, s32, 0x8000
v_mfma_f32_16x16x32_bf16 v[164:167], a[92:95], a[20:23], v[164:167]
s_add_u32 s7, s7, 0x8000
s_mov_b32 s39, 0xe000fe00
s_mov_b32 s40, 0xffc0fffc
v_mfma_f32_16x16x32_bf16 v[156:159], a[92:95], a[16:19], v[156:159]
s_mov_b32 s41, 0xc000fc00
s_mov_b32 s42, 0xff80fff8
s_mov_b32 s43, 0x8000f800
v_mfma_f32_16x16x32_bf16 v[156:159], a[88:91], a[0:3], v[156:159]
s_waitcnt lgkmcnt(4)
v_mov_b32 v21, s1
v_mfma_f32_16x16x32_bf16 v[184:187], a[96:99], a[0:3], v[184:187]
ds_read_b64_tr_b16 a[88:89], v15 offset:8192
v_add_u32 v20, s0, v16
v_mfma_f32_16x16x32_bf16 v[184:187], a[100:103], a[16:19], v[184:187]
global_load_dword a120, v[20:21], off sc1
v_mfma_f32_16x16x32_bf16 v[192:195], a[100:103], a[20:23], v[192:195]
ds_read_b64_tr_b16 a[90:91], v15 offset:8448
v_mfma_f32_16x16x32_bf16 v[192:195], a[96:99], a[4:7], v[192:195]
ds_read_b64_tr_b16 a[92:93], v15 offset:10240
v_mfma_f32_16x16x32_bf16 v[200:203], a[96:99], a[8:11], v[200:203]
ds_read_b64_tr_b16 a[94:95], v15 offset:10496
v_add_u32 v12, 0x8000, v12
v_mfma_f32_16x16x32_bf16 v[200:203], a[100:103], a[24:27], v[200:203]
v_add_u32 v13, 0x8000, v13
v_add_u32 v14, 0x8000, v14
v_mfma_f32_16x16x32_bf16 v[208:211], a[100:103], a[28:31], v[208:211]
v_add_u32 v15, 0x8000, v15
v_mfma_f32_16x16x32_bf16 v[208:211], a[96:99], a[12:15], v[208:211]
s_bitcmp1_b32 s4, 0
s_cselect_b32 s8, 0x7f800000, s11
s_cselect_b32 s9, s11, 0x7f800000
v_mfma_f32_16x16x32_bf16 v[212:215], a[104:107], a[12:15], v[212:215]
s_waitcnt vmcnt(19) lgkmcnt(0)
v_mfma_f32_16x16x32_bf16 v[212:215], a[108:111], a[28:31], v[212:215]
s_barrier
s_add_u32 m0, s19, 0x8000
v_mfma_f32_16x16x32_bf16 v[204:207], a[108:111], a[24:27], v[204:207]
buffer_load_dwordx4 v16, s[48:51], s32 offen offset:0 sc1 lds
v_mfma_f32_16x16x32_bf16 v[204:207], a[104:107], a[8:11], v[204:207]
ds_read_b64_tr_b16 a[96:97], v14 offset:4096
v_mfma_f32_16x16x32_bf16 v[196:199], a[104:107], a[4:7], v[196:199]
ds_read_b64_tr_b16 a[98:99], v14 offset:4352
v_mfma_f32_16x16x32_bf16 v[196:199], a[108:111], a[20:23], v[196:199]
ds_read_b64_tr_b16 a[100:101], v14 offset:6144
v_mfma_f32_16x16x32_bf16 v[188:191], a[108:111], a[16:19], v[188:191]
buffer_load_dwordx4 v16, s[48:51], s32 offen offset:1024 sc1 lds
v_mfma_f32_16x16x32_bf16 v[188:191], a[104:107], a[0:3], v[188:191]
ds_read_b64_tr_b16 a[102:103], v14 offset:6400
s_waitcnt lgkmcnt(4)
v_mfma_f32_16x16x32_bf16 v[216:219], a[0:3], a[80:83], v[216:219]
ds_read_b64_tr_b16 a[104:105], v15 offset:4096
v_mfma_f32_16x16x32_bf16 v[216:219], a[16:19], a[84:87], v[216:219]
ds_read_b64_tr_b16 a[106:107], v15 offset:4352
v_mfma_f32_16x16x32_bf16 v[224:227], a[20:23], a[84:87], v[224:227]
ds_read_b64_tr_b16 a[108:109], v15 offset:6144
v_mfma_f32_16x16x32_bf16 v[224:227], a[4:7], a[80:83], v[224:227]
buffer_store_dwordx4 a[64:67], v16, s[88:91], s15 offen offset:0 sc1
v_mfma_f32_16x16x32_bf16 v[232:235], a[8:11], a[80:83], v[232:235]
ds_read_b64_tr_b16 a[110:111], v15 offset:6400
v_mfma_f32_16x16x32_bf16 v[232:235], a[24:27], a[84:87], v[232:235]
v_mfma_f32_16x16x32_bf16 v[240:243], a[28:31], a[84:87], v[240:243]
v_mfma_f32_16x16x32_bf16 v[240:243], a[12:15], a[80:83], v[240:243]
buffer_load_dwordx4 v16, s[48:51], s32 offen offset:2048 sc1 lds
v_mfma_f32_16x16x32_bf16 v[244:247], a[12:15], a[88:91], v[244:247]
ds_read_b64_tr_b16 a[80:81], v14 offset:8192
v_mfma_f32_16x16x32_bf16 v[244:247], a[28:31], a[92:95], v[244:247]
ds_read_b64_tr_b16 a[82:83], v14 offset:8448
v_mfma_f32_16x16x32_bf16 v[236:239], a[24:27], a[92:95], v[236:239]
ds_read_b64_tr_b16 a[84:85], v14 offset:10240
v_mfma_f32_16x16x32_bf16 v[236:239], a[8:11], a[88:91], v[236:239]
ds_read_b64_tr_b16 a[86:87], v14 offset:10496
v_mfma_f32_16x16x32_bf16 v[228:231], a[4:7], a[88:91], v[228:231]
buffer_load_dwordx4 v16, s[48:51], s32 offen offset:3072 sc1 lds
v_mfma_f32_16x16x32_bf16 v[228:231], a[20:23], a[92:95], v[228:231]
v_mfma_f32_16x16x32_bf16 v[220:223], a[16:19], a[92:95], v[220:223]
v_mfma_f32_16x16x32_bf16 v[220:223], a[0:3], a[88:91], v[220:223]
s_waitcnt lgkmcnt(4)
L_S23:
v_mfma_f32_16x16x32_bf16 v[184:187], a[96:99], a[32:35], v[184:187]
buffer_store_dwordx4 a[64:67], v16, s[88:91], s15 offen offset:1024 sc1
v_mov_b32 v8, v19
v_mfma_f32_16x16x32_bf16 v[184:187], a[100:103], a[48:51], v[184:187]
ds_read_b64_tr_b16 a[88:89], v15 offset:8192
v_mov_b32 v9, 0xf149f2ca
v_mfma_f32_16x16x32_bf16 v[192:195], a[100:103], a[52:55], v[192:195]
ds_read_b64_tr_b16 a[90:91], v15 offset:8448
v_mov_b32 v248, 0xffff
v_mfma_f32_16x16x32_bf16 v[192:195], a[96:99], a[36:39], v[192:195]
ds_read_b64_tr_b16 a[92:93], v15 offset:10240
v_mov_b32 v249, 0xffff0000
v_mfma_f32_16x16x32_bf16 v[200:203], a[96:99], a[40:43], v[200:203]
ds_read_b64_tr_b16 a[94:95], v15 offset:10496
s_add_u32 m0, s19, 0x9000
v_cndmask_b32 v252, 0, v248, s[56:57]
v_mfma_f32_16x16x32_bf16 v[200:203], a[100:103], a[56:59], v[200:203]
buffer_load_dwordx4 v16, s[48:51], s7 offen offset:0 sc1 lds
v_mfma_f32_16x16x32_bf16 v[208:211], a[100:103], a[60:63], v[208:211]
v_cndmask_b32 v252, v252, v249, s[58:59]
v_cndmask_b32 v253, 0, v248, s[60:61]
v_mfma_f32_16x16x32_bf16 v[208:211], a[96:99], a[44:47], v[208:211]
v_cndmask_b32 v253, v253, v249, s[62:63]
v_cndmask_b32 v254, 0, v248, s[68:69]
v_mfma_f32_16x16x32_bf16 v[212:215], a[104:107], a[44:47], v[212:215]
ds_read_b64_tr_b16 a[96:97], v14 offset:0
v_cndmask_b32 v254, v254, v249, s[70:71]
v_cndmask_b32 v255, 0, v248, s[76:77]
v_mfma_f32_16x16x32_bf16 v[212:215], a[108:111], a[60:63], v[212:215]
buffer_load_dwordx4 v16, s[48:51], s7 offen offset:1024 sc1 lds
v_mfma_f32_16x16x32_bf16 v[204:207], a[108:111], a[56:59], v[204:207]
ds_read_b64_tr_b16 a[98:99], v14 offset:256
v_cndmask_b32 v255, v255, v249, s[78:79]
v_mfma_f32_16x16x32_bf16 v[204:207], a[104:107], a[40:43], v[204:207]
ds_read_b64_tr_b16 a[100:101], v14 offset:2048
v_cndmask_b32 v248, v9, 0, s[68:69]
v_mfma_f32_16x16x32_bf16 v[196:199], a[104:107], a[36:39], v[196:199]
ds_read_b64_tr_b16 a[102:103], v14 offset:2304
v_cndmask_b32 v249, v9, 0, s[70:71]
v_cndmask_b32 v250, v9, 0, s[76:77]
v_mfma_f32_16x16x32_bf16 v[196:199], a[108:111], a[52:55], v[196:199]
v_cndmask_b32 v251, v9, 0, s[78:79]
v_mfma_f32_16x16x32_bf16 v[188:191], a[108:111], a[48:51], v[188:191]
buffer_store_dwordx4 a[64:67], v16, s[88:91], s15 offen offset:2048 sc1
v_mfma_f32_16x16x32_bf16 v[188:191], a[104:107], a[32:35], v[188:191]
s_waitcnt lgkmcnt(4)
v_mfma_f32_16x16x32_bf16 v[216:219], a[32:35], a[80:83], v[216:219]
ds_read_b64_tr_b16 a[104:105], v15 offset:0
v_mfma_f32_16x16x32_bf16 v[216:219], a[48:51], a[84:87], v[216:219]
ds_read_b64_tr_b16 a[106:107], v15 offset:256
v_mfma_f32_16x16x32_bf16 v[224:227], a[52:55], a[84:87], v[224:227]
buffer_load_dwordx4 v16, s[48:51], s7 offen offset:2048 sc1 lds
v_mfma_f32_16x16x32_bf16 v[224:227], a[36:39], a[80:83], v[224:227]
ds_read_b64_tr_b16 a[108:109], v15 offset:2048
v_cvt_pk_bf16_f32 v192, v192, v193
v_mfma_f32_16x16x32_bf16 v[232:235], a[40:43], a[80:83], v[232:235]
ds_read_b64_tr_b16 a[110:111], v15 offset:2304
v_cvt_pk_bf16_f32 v193, v194, v195
v_cvt_pk_bf16_f32 v194, v196, v197
v_mfma_f32_16x16x32_bf16 v[232:235], a[56:59], a[84:87], v[232:235]
v_cvt_pk_bf16_f32 v195, v198, v199
v_cvt_pk_bf16_f32 v208, v208, v209
v_mfma_f32_16x16x32_bf16 v[240:243], a[60:63], a[84:87], v[240:243]
v_cvt_pk_bf16_f32 v209, v210, v211
v_cvt_pk_bf16_f32 v210, v212, v213
v_mfma_f32_16x16x32_bf16 v[240:243], a[44:47], a[80:83], v[240:243]
buffer_load_dwordx4 v16, s[48:51], s7 offen offset:3072 sc1 lds
v_mfma_f32_16x16x32_bf16 v[244:247], a[44:47], a[88:91], v[244:247]
ds_read_b64_tr_b16 a[80:81], v12 offset:0
s_add_u32 s32, s32, 0x8000
v_cvt_pk_bf16_f32 v211, v214, v215
v_mfma_f32_16x16x32_bf16 v[244:247], a[60:63], a[92:95], v[244:247]
ds_read_b64_tr_b16 a[82:83], v12 offset:1024
s_add_u32 s7, s7, 0x8000
v_mfma_f32_16x16x32_bf16 v[236:239], a[56:59], a[92:95], v[236:239]
ds_read_b64_tr_b16 a[84:85], v12 offset:8192
v_mfma_f32_16x16x32_bf16 v[236:239], a[40:43], a[88:91], v[236:239]
buffer_store_dwordx4 a[64:67], v16, s[88:91], s15 offen offset:3072 sc1
v_mfma_f32_16x16x32_bf16 v[228:231], a[36:39], a[88:91], v[228:231]
ds_read_b64_tr_b16 a[86:87], v12 offset:9216
v_mfma_f32_16x16x32_bf16 v[228:231], a[52:55], a[92:95], v[228:231]
s_cmp_lg_u32 s4, 0
s_cbranch_scc1 L_hx0
buffer_store_dwordx4 v[192:195], v22, s[88:91], 0 offen offset:0 sc1
buffer_store_dwordx4 v[208:211], v7, s[88:91], 0 offen offset:0 sc1
L_hx0:
v_mfma_f32_16x16x32_bf16 v[220:223], a[48:51], a[92:95], v[220:223]
v_cvt_pk_bf16_f32 v184, v184, v185
v_cvt_pk_bf16_f32 v185, v186, v187
v_mfma_f32_16x16x32_bf16 v[220:223], a[32:35], a[88:91], v[220:223]
s_waitcnt lgkmcnt(4)
v_cvt_pk_bf16_f32 v186, v188, v189
v_cvt_pk_bf16_f32 v187, v190, v191
v_mfma_f32_16x16x32_bf16 v[152:155], a[96:99], a[32:35], v[152:155]
ds_read_b64_tr_b16 a[88:89], v13 offset:0
v_cvt_pk_bf16_f32 v200, v200, v201
v_cvt_pk_bf16_f32 v201, v202, v203
v_mfma_f32_16x16x32_bf16 v[152:155], a[100:103], a[48:51], v[152:155]
ds_read_b64_tr_b16 a[90:91], v13 offset:1024
v_cvt_pk_bf16_f32 v202, v204, v205
v_mfma_f32_16x16x32_bf16 v[160:163], a[100:103], a[52:55], v[160:163]
ds_read_b64_tr_b16 a[92:93], v13 offset:8192
v_cvt_pk_bf16_f32 v203, v206, v207
v_mfma_f32_16x16x32_bf16 v[160:163], a[96:99], a[36:39], v[160:163]
ds_read_b64_tr_b16 a[94:95], v13 offset:9216
v_mfma_f32_16x16x32_bf16 v[168:171], a[96:99], a[40:43], v[168:171]
ds_write_b128 v5, v[192:195] offset:2048
v_mfma_f32_16x16x32_bf16 v[168:171], a[100:103], a[56:59], v[168:171]
ds_write_b128 v5, v[208:211] offset:18432
v_mfma_f32_16x16x32_bf16 v[176:179], a[100:103], a[60:63], v[176:179]
ds_write_b128 v4, v[184:187] offset:2048
v_mfma_f32_16x16x32_bf16 v[176:179], a[96:99], a[44:47], v[176:179]
ds_write_b128 v4, v[200:203] offset:18432
v_mfma_f32_16x16x32_bf16 v[180:183], a[104:107], a[44:47], v[180:183]
ds_read_b64_tr_b16 a[96:97], v12 offset:256
v_cvt_pk_bf16_f32 v231, v230, v231
v_cvt_pk_bf16_f32 v230, v228, v229
v_mfma_f32_16x16x32_bf16 v[180:183], a[108:111], a[60:63], v[180:183]
ds_read_b64_tr_b16 a[98:99], v12 offset:1280
v_cvt_pk_bf16_f32 v228, v224, v225
v_mfma_f32_16x16x32_bf16 v[172:175], a[108:111], a[56:59], v[172:175]
ds_read_b64_tr_b16 a[100:101], v12 offset:8448
v_cvt_pk_bf16_f32 v229, v226, v227
v_mfma_f32_16x16x32_bf16 v[172:175], a[104:107], a[40:43], v[172:175]
ds_read_b64_tr_b16 a[102:103], v12 offset:9472
v_cvt_pk_bf16_f32 v227, v226, v227
v_mfma_f32_16x16x32_bf16 v[164:167], a[104:107], a[36:39], v[164:167]
v_cvt_pk_bf16_f32 v226, v224, v225
v_cvt_pk_bf16_f32 v247, v246, v247
v_cvt_pk_bf16_f32 v246, v244, v245
v_mfma_f32_16x16x32_bf16 v[164:167], a[108:111], a[52:55], v[164:167]
v_cvt_pk_bf16_f32 v244, v240, v241
v_cvt_pk_bf16_f32 v245, v242, v243
v_mfma_f32_16x16x32_bf16 v[156:159], a[108:111], a[48:51], v[156:159]
v_cvt_pk_bf16_f32 v243, v242, v243
v_cvt_pk_bf16_f32 v242, v240, v241
v_mfma_f32_16x16x32_bf16 v[156:159], a[104:107], a[32:35], v[156:159]
s_waitcnt lgkmcnt(4)
v_mfma_f32_16x16x32_bf16 v[24:27], a[80:83], a[32:35], v[24:27]
ds_read_b64_tr_b16 a[104:105], v13 offset:256
v_mfma_f32_16x16x32_bf16 v[24:27], a[84:87], a[48:51], v[24:27]
ds_read_b64_tr_b16 a[106:107], v13 offset:1280
v_mfma_f32_16x16x32_bf16 v[32:35], a[84:87], a[52:55], v[32:35]
ds_read_b64_tr_b16 a[108:109], v13 offset:8448
v_mfma_f32_16x16x32_bf16 v[32:35], a[80:83], a[36:39], v[32:35]
ds_read_b64_tr_b16 a[110:111], v13 offset:9472
v_mfma_f32_16x16x32_bf16 v[40:43], a[80:83], a[40:43], v[40:43]
s_cmp_lg_u32 s4, 0
s_cbranch_scc1 L_hx1
buffer_store_dwordx4 v[228:231], v22, s[88:91], 0 offen offset:1024 sc1
buffer_store_dwordx4 v[244:247], v7, s[88:91], 0 offen offset:1024 sc1
L_hx1:
v_mfma_f32_16x16x32_bf16 v[40:43], a[84:87], a[56:59], v[40:43]
v_cvt_pk_bf16_f32 v223, v222, v223
v_cvt_pk_bf16_f32 v222, v220, v221
v_mfma_f32_16x16x32_bf16 v[48:51], a[84:87], a[60:63], v[48:51]
v_cvt_pk_bf16_f32 v220, v216, v217
v_cvt_pk_bf16_f32 v221, v218, v219
v_mfma_f32_16x16x32_bf16 v[48:51], a[80:83], a[44:47], v[48:51]
v_cvt_pk_bf16_f32 v219, v218, v219
v_cvt_pk_bf16_f32 v218, v216, v217
v_mfma_f32_16x16x32_bf16 v[52:55], a[88:91], a[44:47], v[52:55]
ds_read_b64_tr_b16 a[80:81], v12 offset:512
v_cvt_pk_bf16_f32 v239, v238, v239
v_cvt_pk_bf16_f32 v238, v236, v237
v_mfma_f32_16x16x32_bf16 v[52:55], a[92:95], a[60:63], v[52:55]
ds_read_b64_tr_b16 a[82:83], v12 offset:1536
v_cvt_pk_bf16_f32 v236, v232, v233
v_mfma_f32_16x16x32_bf16 v[44:47], a[92:95], a[56:59], v[44:47]
ds_read_b64_tr_b16 a[84:85], v12 offset:8704
v_cvt_pk_bf16_f32 v237, v234, v235
v_mfma_f32_16x16x32_bf16 v[44:47], a[88:91], a[40:43], v[44:47]
ds_read_b64_tr_b16 a[86:87], v12 offset:9728
v_cvt_pk_bf16_f32 v235, v234, v235
v_mfma_f32_16x16x32_bf16 v[36:39], a[88:91], a[36:39], v[36:39]
v_cvt_pk_bf16_f32 v234, v232, v233
v_mfma_f32_16x16x32_bf16 v[36:39], a[92:95], a[52:55], v[36:39]
ds_write_b128 v5, v[228:231] offset:3072
v_mfma_f32_16x16x32_bf16 v[28:31], a[92:95], a[48:51], v[28:31]
ds_write_b128 v5, v[244:247] offset:19456
v_mfma_f32_16x16x32_bf16 v[28:31], a[88:91], a[32:35], v[28:31]
s_waitcnt lgkmcnt(4)
v_mfma_f32_16x16x32_bf16 v[56:59], a[96:99], a[32:35], v[56:59]
ds_read_b64_tr_b16 a[88:89], v13 offset:512
v_mfma_f32_16x16x32_bf16 v[56:59], a[100:103], a[48:51], v[56:59]
ds_read_b64_tr_b16 a[90:91], v13 offset:1536
v_mfma_f32_16x16x32_bf16 v[64:67], a[100:103], a[52:55], v[64:67]
ds_read_b64_tr_b16 a[92:93], v13 offset:8704
v_mfma_f32_16x16x32_bf16 v[64:67], a[96:99], a[36:39], v[64:67]
ds_read_b64_tr_b16 a[94:95], v13 offset:9728
v_mfma_f32_16x16x32_bf16 v[72:75], a[96:99], a[40:43], v[72:75]
ds_write_b128 v4, v[220:223] offset:3072
v_mfma_f32_16x16x32_bf16 v[72:75], a[100:103], a[56:59], v[72:75]
ds_write_b128 v4, v[236:239] offset:19456
v_mfma_f32_16x16x32_bf16 v[80:83], a[100:103], a[60:63], v[80:83]
v_cvt_pk_bf16_f32 v152, v152, v153
v_cvt_pk_bf16_f32 v153, v154, v155
v_mfma_f32_16x16x32_bf16 v[80:83], a[96:99], a[44:47], v[80:83]
v_cvt_pk_bf16_f32 v154, v156, v157
v_cvt_pk_bf16_f32 v155, v158, v159
v_mfma_f32_16x16x32_bf16 v[84:87], a[104:107], a[44:47], v[84:87]
ds_read_b64_tr_b16 a[96:97], v12 offset:768
v_cvt_pk_bf16_f32 v160, v160, v161
v_cvt_pk_bf16_f32 v161, v162, v163
v_mfma_f32_16x16x32_bf16 v[84:87], a[108:111], a[60:63], v[84:87]
ds_read_b64_tr_b16 a[98:99], v12 offset:1792
v_cvt_pk_bf16_f32 v162, v164, v165
v_mfma_f32_16x16x32_bf16 v[76:79], a[108:111], a[56:59], v[76:79]
ds_read_b64_tr_b16 a[100:101], v12 offset:8960
v_cvt_pk_bf16_f32 v163, v166, v167
v_mfma_f32_16x16x32_bf16 v[76:79], a[104:107], a[40:43], v[76:79]
ds_read_b64_tr_b16 a[102:103], v12 offset:9984
v_cvt_pk_bf16_f32 v168, v168, v169
v_mfma_f32_16x16x32_bf16 v[68:71], a[104:107], a[36:39], v[68:71]
v_cvt_pk_bf16_f32 v169, v170, v171
v_cvt_pk_bf16_f32 v170, v172, v173
v_cvt_pk_bf16_f32 v171, v174, v175
v_mfma_f32_16x16x32_bf16 v[68:71], a[108:111], a[52:55], v[68:71]
v_cvt_pk_bf16_f32 v176, v176, v177
v_cvt_pk_bf16_f32 v177, v178, v179
v_mfma_f32_16x16x32_bf16 v[60:63], a[108:111], a[48:51], v[60:63]
v_cvt_pk_bf16_f32 v178, v180, v181
v_cvt_pk_bf16_f32 v179, v182, v183
v_mfma_f32_16x16x32_bf16 v[60:63], a[104:107], a[32:35], v[60:63]
s_waitcnt lgkmcnt(4)
v_mfma_f32_16x16x32_bf16 v[88:91], a[80:83], a[32:35], v[88:91]
ds_read_b64_tr_b16 a[104:105], v13 offset:768
v_mfma_f32_16x16x32_bf16 v[88:91], a[84:87], a[48:51], v[88:91]
ds_read_b64_tr_b16 a[106:107], v13 offset:1792
v_mfma_f32_16x16x32_bf16 v[96:99], a[84:87], a[52:55], v[96:99]
ds_read_b64_tr_b16 a[108:109], v13 offset:8960
v_mfma_f32_16x16x32_bf16 v[96:99], a[80:83], a[36:39], v[96:99]
ds_read_b64_tr_b16 a[110:111], v13 offset:9984
v_mfma_f32_16x16x32_bf16 v[104:107], a[80:83], a[40:43], v[104:107]
v_mfma_f32_16x16x32_bf16 v[104:107], a[84:87], a[56:59], v[104:107]
v_mfma_f32_16x16x32_bf16 v[112:115], a[84:87], a[60:63], v[112:115]
v_mfma_f32_16x16x32_bf16 v[112:115], a[80:83], a[44:47], v[112:115]
v_mfma_f32_16x16x32_bf16 v[116:119], a[88:91], a[44:47], v[116:119]
v_mfma_f32_16x16x32_bf16 v[116:119], a[92:95], a[60:63], v[116:119]
v_mfma_f32_16x16x32_bf16 v[108:111], a[92:95], a[56:59], v[108:111]
v_mfma_f32_16x16x32_bf16 v[108:111], a[88:91], a[40:43], v[108:111]
v_mov_b32 v15, s6
v_xor_b32 v15, 0, v15
v_mfma_f32_16x16x32_bf16 v[100:103], a[88:91], a[36:39], v[100:103]
v_writelane_b32 v15, s18, 0
v_lshlrev_b32 v15, 2, v15
v_bfe_u32 v12, v0, 2, 2
v_mfma_f32_16x16x32_bf16 v[100:103], a[92:95], a[52:55], v[100:103]
v_lshlrev_b32 v12, 11, v12
v_lshrrev_b32 v13, 4, v0
v_mfma_f32_16x16x32_bf16 v[92:95], a[92:95], a[48:51], v[92:95]
v_lshl_add_u32 v12, v13, 6, v12
v_and_b32 v13, 3, v0
v_mfma_f32_16x16x32_bf16 v[92:95], a[88:91], a[32:35], v[92:95]
s_waitcnt lgkmcnt(0)
v_lshl_add_u32 v12, v13, 4, v12
v_xor_b32 v12, s13, v12
v_mfma_f32_16x16x32_bf16 v[120:123], a[96:99], a[32:35], v[120:123]
L_padA12:
s_cmp_eq_u32 s95, 1
s_cbranch_scc1 L_hopA_ret
v_xor_b32 v13, 32, v12
v_add_u32 v13, 7168, v13
v_mul_f32 v24, s52, v24
v_mfma_f32_16x16x32_bf16 v[120:123], a[100:103], a[48:51], v[120:123]
v_mul_f32 v25, s52, v25
v_mul_f32 v26, s52, v26
v_mfma_f32_16x16x32_bf16 v[128:131], a[100:103], a[52:55], v[128:131]
v_mul_f32 v27, s52, v27
v_mul_f32 v28, s52, v28
v_mfma_f32_16x16x32_bf16 v[128:131], a[96:99], a[36:39], v[128:131]
v_mul_f32 v29, s52, v29
v_mul_f32 v30, s52, v30
v_mfma_f32_16x16x32_bf16 v[136:139], a[96:99], a[40:43], v[136:139]
v_mul_f32 v31, s52, v31
v_cvt_pk_bf16_f32 v24, v24, v25
v_cvt_pk_bf16_f32 v25, v26, v27
v_mfma_f32_16x16x32_bf16 v[136:139], a[100:103], a[56:59], v[136:139]
v_cvt_pk_bf16_f32 v26, v28, v29
v_cvt_pk_bf16_f32 v27, v30, v31
v_mfma_f32_16x16x32_bf16 v[144:147], a[100:103], a[60:63], v[144:147]
v_accvgpr_write_b32 a160, v24
v_accvgpr_write_b32 a161, v25
v_mfma_f32_16x16x32_bf16 v[144:147], a[96:99], a[44:47], v[144:147]
v_accvgpr_write_b32 a162, v26
v_accvgpr_write_b32 a163, v27
v_mfma_f32_16x16x32_bf16 v[148:151], a[104:107], a[44:47], v[148:151]
v_mul_f32 v32, s52, v32
v_mul_f32 v33, s52, v33
v_mul_f32 v34, s52, v34
v_mfma_f32_16x16x32_bf16 v[148:151], a[108:111], a[60:63], v[148:151]
v_mul_f32 v35, s52, v35
v_mul_f32 v36, s52, v36
v_mfma_f32_16x16x32_bf16 v[140:143], a[108:111], a[56:59], v[140:143]
v_mul_f32 v37, s52, v37
v_mul_f32 v38, s52, v38
v_mfma_f32_16x16x32_bf16 v[140:143], a[104:107], a[40:43], v[140:143]
v_mul_f32 v39, s52, v39
v_cvt_pk_bf16_f32 v32, v32, v33
v_mfma_f32_16x16x32_bf16 v[132:135], a[104:107], a[36:39], v[132:135]
v_cvt_pk_bf16_f32 v33, v34, v35
v_cvt_pk_bf16_f32 v34, v36, v37
v_cvt_pk_bf16_f32 v35, v38, v39
v_mfma_f32_16x16x32_bf16 v[132:135], a[108:111], a[52:55], v[132:135]
v_accvgpr_write_b32 a176, v32
v_accvgpr_write_b32 a177, v33
v_mfma_f32_16x16x32_bf16 v[124:127], a[108:111], a[48:51], v[124:127]
v_accvgpr_write_b32 a178, v34
v_accvgpr_write_b32 a179, v35
v_mfma_f32_16x16x32_bf16 v[124:127], a[104:107], a[32:35], v[124:127]
L_trans:
s_waitcnt vmcnt(21) lgkmcnt(0)
s_barrier
s_cmp_eq_u32 s4, 0
s_cbranch_scc1 L_hx_ld
ds_read_b128 v[188:191], v4 offset:0
ds_read_b64 v[216:217], v4 offset:1024
ds_read_b64 v[220:221], v4 offset:1032
ds_read_b128 v[204:207], v4 offset:16384
ds_read_b64 v[232:233], v4 offset:17408
ds_read_b64 v[236:237], v4 offset:17416
s_branch L_hx_rd
L_hx_ld:
buffer_load_dwordx4 v[188:191], v10, s[88:91], 0 offen sc1
buffer_load_dwordx2 v[216:217], v10, s[88:91], 0 offen offset:1024 sc1
buffer_load_dwordx2 v[220:221], v10, s[88:91], 0 offen offset:1032 sc1
buffer_load_dwordx4 v[204:207], v11, s[88:91], 0 offen sc1
buffer_load_dwordx2 v[232:233], v11, s[88:91], 0 offen offset:1024 sc1
buffer_load_dwordx2 v[236:237], v11, s[88:91], 0 offen offset:1032 sc1
L_hx_rd:
ds_read_b128 v[196:199], v6 offset:0
ds_read_b64 v[224:225], v6 offset:1024
ds_read_b64 v[228:229], v6 offset:1032
ds_read_b128 v[212:215], v6 offset:16384
ds_read_b64 v[240:241], v6 offset:17408
ds_read_b64 v[244:245], v6 offset:17416
ds_read_b128 a[0:3], v1 offset:8192
ds_read_b128 a[4:7], v1 offset:9216
ds_read_b128 a[8:11], v1 offset:10240
ds_read_b128 a[12:15], v1 offset:11264
ds_read_b128 a[16:19], v1 offset:12288
ds_read_b128 a[20:23], v1 offset:13312
ds_read_b128 a[24:27], v1 offset:14336
ds_read_b128 a[28:31], v1 offset:15360
L_hopB:
s_mov_b32 s95, 0
v_pk_mul_f32 v[40:41], v[40:41], s[52:53]
v_pk_mul_f32 v[42:43], v[42:43], s[52:53]
v_pk_mul_f32 v[44:45], v[44:45], s[52:53]
v_pk_mul_f32 v[46:47], v[46:47], s[52:53]
v_cvt_pk_bf16_f32 v40, v40, v41
v_cvt_pk_bf16_f32 v41, v42, v43
v_cvt_pk_bf16_f32 v42, v44, v45
v_cvt_pk_bf16_f32 v43, v46, v47
v_accvgpr_write_b32 a192, v40
v_accvgpr_write_b32 a193, v41
v_accvgpr_write_b32 a194, v42
v_accvgpr_write_b32 a195, v43
v_pk_mul_f32 v[48:49], v[48:49], s[52:53]
v_pk_mul_f32 v[50:51], v[50:51], s[52:53]
v_pk_mul_f32 v[52:53], v[52:53], s[52:53]
v_pk_mul_f32 v[54:55], v[54:55], s[52:53]
v_cvt_pk_bf16_f32 v48, v48, v49
v_cvt_pk_bf16_f32 v49, v50, v51
v_cvt_pk_bf16_f32 v50, v52, v53
v_cvt_pk_bf16_f32 v51, v54, v55
v_accvgpr_write_b32 a208, v48
v_accvgpr_write_b32 a209, v49
v_accvgpr_write_b32 a210, v50
v_accvgpr_write_b32 a211, v51
v_mov_b32 v47, s55
v_cndmask_b32 v36, v9, 0, s[56:57]
v_min_f32 v32, s55, v36
v_cndmask_b32 v44, v47, 0, s[36:37]
v_cndmask_b32 v37, v9, 0, s[58:59]
v_min_f32 v33, s55, v37
v_cndmask_b32 v45, v47, 0, s[38:39]
v_cndmask_b32 v38, v9, 0, s[60:61]
v_min_f32 v34, s55, v38
v_cndmask_b32 v46, v47, 0, s[40:41]
v_cndmask_b32 v39, v9, 0, s[62:63]
v_min_f32 v35, s55, v39
v_cndmask_b32 v47, v47, 0, s[42:43]
v_pk_mul_f32 v[56:57], v[56:57], s[52:53]
v_pk_mul_f32 v[58:59], v[58:59], s[52:53]
v_pk_mul_f32 v[60:61], v[60:61], s[52:53]
v_pk_mul_f32 v[62:63], v[62:63], s[52:53]
v_cvt_pk_bf16_f32 v56, v56, v57
v_cvt_pk_bf16_f32 v57, v58, v59
v_cvt_pk_bf16_f32 v58, v60, v61
v_cvt_pk_bf16_f32 v59, v62, v63
v_accvgpr_write_b32 a164, v56
v_accvgpr_write_b32 a165, v57
v_accvgpr_write_b32 a166, v58
v_accvgpr_write_b32 a167, v59
v_pk_mul_f32 v[64:65], v[64:65], s[52:53]
v_pk_mul_f32 v[66:67], v[66:67], s[52:53]
v_pk_mul_f32 v[68:69], v[68:69], s[52:53]
v_pk_mul_f32 v[70:71], v[70:71], s[52:53]
v_cvt_pk_bf16_f32 v64, v64, v65
v_cvt_pk_bf16_f32 v65, v66, v67
v_cvt_pk_bf16_f32 v66, v68, v69
v_cvt_pk_bf16_f32 v67, v70, v71
v_accvgpr_write_b32 a180, v64
v_accvgpr_write_b32 a181, v65
v_accvgpr_write_b32 a182, v66
v_accvgpr_write_b32 a183, v67
v_pk_mul_f32 v[72:73], v[72:73], s[52:53]
v_pk_mul_f32 v[74:75], v[74:75], s[52:53]
v_pk_mul_f32 v[76:77], v[76:77], s[52:53]
v_pk_mul_f32 v[78:79], v[78:79], s[52:53]
v_cvt_pk_bf16_f32 v72, v72, v73
v_cvt_pk_bf16_f32 v73, v74, v75
v_cvt_pk_bf16_f32 v74, v76, v77
v_cvt_pk_bf16_f32 v75, v78, v79
v_accvgpr_write_b32 a196, v72
v_accvgpr_write_b32 a197, v73
v_accvgpr_write_b32 a198, v74
v_accvgpr_write_b32 a199, v75
v_pk_mul_f32 v[80:81], v[80:81], s[52:53]
v_pk_mul_f32 v[82:83], v[82:83], s[52:53]
v_pk_mul_f32 v[84:85], v[84:85], s[52:53]
v_pk_mul_f32 v[86:87], v[86:87], s[52:53]
v_cvt_pk_bf16_f32 v80, v80, v81
v_cvt_pk_bf16_f32 v81, v82, v83
v_cvt_pk_bf16_f32 v82, v84, v85
v_cvt_pk_bf16_f32 v83, v86, v87
v_accvgpr_write_b32 a212, v80
v_accvgpr_write_b32 a213, v81
v_accvgpr_write_b32 a214, v82
v_accvgpr_write_b32 a215, v83
v_pk_mul_f32 v[88:89], v[88:89], s[52:53]
v_pk_mul_f32 v[90:91], v[90:91], s[52:53]
v_pk_mul_f32 v[92:93], v[92:93], s[52:53]
v_pk_mul_f32 v[94:95], v[94:95], s[52:53]
v_cvt_pk_bf16_f32 v88, v88, v89
v_cvt_pk_bf16_f32 v89, v90, v91
v_cvt_pk_bf16_f32 v90, v92, v93
v_cvt_pk_bf16_f32 v91, v94, v95
v_accvgpr_write_b32 a168, v88
v_accvgpr_write_b32 a169, v89
v_accvgpr_write_b32 a170, v90
v_accvgpr_write_b32 a171, v91
v_pk_mul_f32 v[96:97], v[96:97], s[52:53]
v_pk_mul_f32 v[98:99], v[98:99], s[52:53]
v_pk_mul_f32 v[100:101], v[100:101], s[52:53]
v_pk_mul_f32 v[102:103], v[102:103], s[52:53]
v_cvt_pk_bf16_f32 v96, v96, v97
v_cvt_pk_bf16_f32 v97, v98, v99
v_cvt_pk_bf16_f32 v98, v100, v101
v_cvt_pk_bf16_f32 v99, v102, v103
v_accvgpr_write_b32 a184, v96
v_accvgpr_write_b32 a185, v97
v_accvgpr_write_b32 a186, v98
v_accvgpr_write_b32 a187, v99
v_pk_mul_f32 v[104:105], v[104:105], s[52:53]
v_pk_mul_f32 v[106:107], v[106:107], s[52:53]
v_pk_mul_f32 v[108:109], v[108:109], s[52:53]
v_pk_mul_f32 v[110:111], v[110:111], s[52:53]
v_cvt_pk_bf16_f32 v104, v104, v105
v_cvt_pk_bf16_f32 v105, v106, v107
v_cvt_pk_bf16_f32 v106, v108, v109
v_cvt_pk_bf16_f32 v107, v110, v111
v_accvgpr_write_b32 a200, v104
v_accvgpr_write_b32 a201, v105
v_accvgpr_write_b32 a202, v106
v_accvgpr_write_b32 a203, v107
v_pk_mul_f32 v[112:113], v[112:113], s[52:53]
v_pk_mul_f32 v[114:115], v[114:115], s[52:53]
v_pk_mul_f32 v[116:117], v[116:117], s[52:53]
v_pk_mul_f32 v[118:119], v[118:119], s[52:53]
v_cvt_pk_bf16_f32 v112, v112, v113
v_cvt_pk_bf16_f32 v113, v114, v115
v_cvt_pk_bf16_f32 v114, v116, v117
v_cvt_pk_bf16_f32 v115, v118, v119
v_accvgpr_write_b32 a216, v112
v_accvgpr_write_b32 a217, v113
v_accvgpr_write_b32 a218, v114
v_accvgpr_write_b32 a219, v115
v_pk_mul_f32 v[120:121], v[120:121], s[52:53]
v_pk_mul_f32 v[122:123], v[122:123], s[52:53]
v_pk_mul_f32 v[124:125], v[124:125], s[52:53]
v_pk_mul_f32 v[126:127], v[126:127], s[52:53]
v_cvt_pk_bf16_f32 v120, v120, v121
v_cvt_pk_bf16_f32 v121, v122, v123
v_cvt_pk_bf16_f32 v122, v124, v125
v_cvt_pk_bf16_f32 v123, v126, v127
v_accvgpr_write_b32 a172, v120
v_accvgpr_write_b32 a173, v121
v_accvgpr_write_b32 a174, v122
v_accvgpr_write_b32 a175, v123
v_pk_mul_f32 v[128:129], v[128:129], s[52:53]
v_pk_mul_f32 v[130:131], v[130:131], s[52:53]
v_pk_mul_f32 v[132:133], v[132:133], s[52:53]
v_pk_mul_f32 v[134:135], v[134:135], s[52:53]
v_cvt_pk_bf16_f32 v128, v128, v129
v_cvt_pk_bf16_f32 v129, v130, v131
v_cvt_pk_bf16_f32 v130, v132, v133
v_cvt_pk_bf16_f32 v131, v134, v135
v_accvgpr_write_b32 a188, v128
v_accvgpr_write_b32 a189, v129
v_accvgpr_write_b32 a190, v130
v_accvgpr_write_b32 a191, v131
v_pk_mul_f32 v[136:137], v[136:137], s[52:53]
v_pk_mul_f32 v[138:139], v[138:139], s[52:53]
v_pk_mul_f32 v[140:141], v[140:141], s[52:53]
v_pk_mul_f32 v[142:143], v[142:143], s[52:53]
v_cvt_pk_bf16_f32 v136, v136, v137
v_cvt_pk_bf16_f32 v137, v138, v139
v_cvt_pk_bf16_f32 v138, v140, v141
v_cvt_pk_bf16_f32 v139, v142, v143
v_accvgpr_write_b32 a204, v136
v_accvgpr_write_b32 a205, v137
v_accvgpr_write_b32 a206, v138
v_accvgpr_write_b32 a207, v139
v_pk_mul_f32 v[144:145], v[144:145], s[52:53]
v_pk_mul_f32 v[146:147], v[146:147], s[52:53]
v_pk_mul_f32 v[148:149], v[148:149], s[52:53]
v_pk_mul_f32 v[150:151], v[150:151], s[52:53]
v_cvt_pk_bf16_f32 v144, v144, v145
v_cvt_pk_bf16_f32 v145, v146, v147
v_cvt_pk_bf16_f32 v146, v148, v149
v_cvt_pk_bf16_f32 v147, v150, v151
v_accvgpr_write_b32 a220, v144
v_accvgpr_write_b32 a221, v145
v_accvgpr_write_b32 a222, v146
v_accvgpr_write_b32 a223, v147
s_cmp_lg_u32 s4, 0
s_cbranch_scc1 L_spun_hx
s_mov_b32 s92, 200000
L_spin_hx:
s_waitcnt vmcnt(0)
v_max3_u32 v128, v188, v189, 0
v_max3_u32 v128, v190, v191, v128
v_max3_u32 v128, v216, v217, v128
v_max3_u32 v128, v220, v221, v128
v_max3_u32 v128, v204, v205, v128
v_max3_u32 v128, v206, v207, v128
v_max3_u32 v128, v232, v233, v128
v_max3_u32 v128, v236, v237, v128
v_cmp_eq_u32 vcc, -1, v128
s_sub_u32 s92, s92, 1
s_cbranch_scc1 L_spun_hx
s_nop 3
s_cbranch_vccz L_spun_hx
s_sleep 2
buffer_load_dwordx4 v[188:191], v10, s[88:91], 0 offen sc1
buffer_load_dwordx2 v[216:217], v10, s[88:91], 0 offen offset:1024 sc1
buffer_load_dwordx2 v[220:221], v10, s[88:91], 0 offen offset:1032 sc1
buffer_load_dwordx4 v[204:207], v11, s[88:91], 0 offen sc1
buffer_load_dwordx2 v[232:233], v11, s[88:91], 0 offen offset:1024 sc1
buffer_load_dwordx2 v[236:237], v11, s[88:91], 0 offen offset:1032 sc1
s_branch L_spin_hx
L_spun_hx:
s_waitcnt lgkmcnt(0)
s_barrier
v_mfma_f32_16x16x32_bf16 v[52:55], v[184:187], v[152:155], v[248:251]
v_mov_b32 v140, 0
v_mov_b32 v141, 0
v_mfma_f32_16x16x32_bf16 v[48:51], v[188:191], v[152:155], v[32:35]
v_mov_b32 v142, 0
v_mov_b32 v143, 0
v_mfma_f32_16x16x32_bf16 v[60:63], v[192:195], v[160:163], v[248:251]
v_mov_b32 v144, 0
v_mov_b32 v145, 0
v_mfma_f32_16x16x32_bf16 v[56:59], v[196:199], v[160:163], v[36:39]
v_mov_b32 v146, 0
v_mov_b32 v147, 0
v_mfma_f32_16x16x32_bf16 v[68:71], v[200:203], v[168:171], v[248:251]
v_mov_b32 v148, 0
v_mov_b32 v149, 0
v_mfma_f32_16x16x32_bf16 v[64:67], v[204:207], v[168:171], v[36:39]
v_max3_f32 v52, v48, v49, v52
v_max3_f32 v54, v50, v51, v54
v_mfma_f32_16x16x32_bf16 v[76:79], v[208:211], v[176:179], v[248:251]
v_max_f32 v52, v52, v53
v_max_f32 v53, v54, v55
v_mfma_f32_16x16x32_bf16 v[72:75], v[212:215], v[176:179], v[36:39]
v_max_f32 v136, v52, v53
v_max3_f32 v60, v56, v57, v60
v_mfma_f32_16x16x32_bf16 v[16:19], a[0:3], a[160:163], v[44:47]
v_max3_f32 v62, v58, v59, v62
v_max_f32 v60, v60, v61
v_mfma_f32_16x16x32_bf16 v[16:19], a[4:7], a[164:167], v[16:19]
v_max_f32 v61, v62, v63
v_max_f32 v137, v60, v61
v_mfma_f32_16x16x32_bf16 v[16:19], a[8:11], a[168:171], v[16:19]
v_max3_f32 v68, v64, v65, v68
v_max3_f32 v70, v66, v67, v70
v_mfma_f32_16x16x32_bf16 v[16:19], a[12:15], a[172:175], v[16:19]
v_max_f32 v68, v68, v69
v_max_f32 v69, v70, v71
v_mfma_f32_16x16x32_bf16 v[20:23], a[0:3], a[176:179], 0
v_max_f32 v138, v68, v69
v_max3_f32 v76, v72, v73, v76
v_mfma_f32_16x16x32_bf16 v[20:23], a[4:7], a[180:183], v[20:23]
v_max3_f32 v78, v74, v75, v78
v_max_f32 v76, v76, v77
v_mfma_f32_16x16x32_bf16 v[20:23], a[8:11], a[184:187], v[20:23]
v_max_f32 v77, v78, v79
v_max_f32 v139, v76, v77
v_mfma_f32_16x16x32_bf16 v[20:23], a[12:15], a[188:191], v[20:23]
v_mov_b32 v150, 0
v_mov_b32 v151, 0
v_mfma_f32_16x16x32_bf16 v[24:27], a[0:3], a[192:195], 0
v_mov_b32 v248, 0
v_mov_b32 v249, 0
v_mfma_f32_16x16x32_bf16 v[24:27], a[4:7], a[196:199], v[24:27]
v_mov_b32 v250, 0
v_mov_b32 v251, 0
v_mfma_f32_16x16x32_bf16 v[24:27], a[8:11], a[200:203], v[24:27]
v_max3_f32 v80, v16, v17, v18
v_max_f32 v80, v80, v19
v_mfma_f32_16x16x32_bf16 v[24:27], a[12:15], a[204:207], v[24:27]
v_max3_f32 v84, v20, v21, v22
v_max_f32 v84, v84, v23
v_mfma_f32_16x16x32_bf16 v[28:31], a[0:3], a[208:211], 0
v_mov_b32 v128, v136
v_mov_b32 v129, v137
v_mfma_f32_16x16x32_bf16 v[28:31], a[4:7], a[212:215], v[28:31]
v_mov_b32 v130, v138
v_mov_b32 v131, v139
v_mfma_f32_16x16x32_bf16 v[28:31], a[8:11], a[216:219], v[28:31]
v_permlane16_swap_b32 v128, v136
v_permlane16_swap_b32 v129, v137
v_mfma_f32_16x16x32_bf16 v[28:31], a[12:15], a[220:223], v[28:31]
v_permlane16_swap_b32 v130, v138
v_permlane16_swap_b32 v131, v139
v_max_f32 v136, v136, v128
v_max_f32 v137, v137, v129
v_max_f32 v138, v138, v130
v_max_f32 v139, v139, v131
v_max3_f32 v88, v24, v25, v26
v_max_f32 v88, v88, v27
v_mov_b32 v128, v136
v_mov_b32 v129, v137
v_mov_b32 v130, v138
v_mov_b32 v131, v139
v_max3_f32 v92, v28, v29, v30
v_max_f32 v92, v92, v31
v_permlane32_swap_b32 v128, v136
v_permlane32_swap_b32 v129, v137
v_permlane32_swap_b32 v130, v138
v_permlane32_swap_b32 v131, v139
v_max_f32 v136, v136, v128
v_max_f32 v137, v137, v129
v_max_f32 v138, v138, v130
v_max_f32 v139, v139, v131
v_mul_f32 v136, s54, v136
v_mul_f32 v137, s54, v137
v_mul_f32 v138, s54, v138
v_mul_f32 v139, s54, v139
v_fma_f32 v52, v52, s54, -v136
v_fma_f32 v53, v53, s54, -v136
v_fma_f32 v60, v60, s54, -v137
v_fma_f32 v61, v61, s54, -v137
v_fma_f32 v68, v68, s54, -v138
v_fma_f32 v69, v69, s54, -v138
v_fma_f32 v76, v76, s54, -v139
v_fma_f32 v77, v77, s54, -v139
v_exp_f32 v52, v52
v_exp_f32 v53, v53
v_exp_f32 v60, v60
v_exp_f32 v61, v61
v_exp_f32 v68, v68
v_exp_f32 v69, v69
v_exp_f32 v76, v76
v_exp_f32 v77, v77
v_cvt_pk_bf16_f32 v52, v52, v52
v_cvt_pk_bf16_f32 v53, v53, v53
v_cvt_pk_bf16_f32 v60, v60, v60
v_cvt_pk_bf16_f32 v61, v61, v61
v_cvt_pk_bf16_f32 v68, v68, v68
v_cvt_pk_bf16_f32 v69, v69, v69
v_cvt_pk_bf16_f32 v76, v76, v76
v_cvt_pk_bf16_f32 v77, v77, v77
v_and_b32 v48, v252, v52
v_and_b32 v49, v253, v53
v_and_b32 v50, v254, v52
v_and_b32 v51, v255, v53
v_and_b32 v56, v252, v60
v_and_b32 v57, v253, v61
v_and_b32 v58, v254, v60
v_and_b32 v59, v255, v61
v_and_b32 v64, v252, v68
v_and_b32 v65, v253, v69
v_and_b32 v66, v254, v68
v_and_b32 v67, v255, v69
v_and_b32 v72, v252, v76
v_and_b32 v73, v253, v77
v_and_b32 v74, v254, v76
v_and_b32 v75, v255, v77
v_mfma_f32_16x16x32_bf16 v[156:159], a[240:243], v[48:51], 0
v_mov_b32 v128, v80
v_mov_b32 v129, v84
v_mfma_f32_16x16x32_bf16 v[164:167], a[240:243], v[56:59], 0
v_mov_b32 v130, v88
v_mov_b32 v131, v92
v_mfma_f32_16x16x32_bf16 v[172:175], a[240:243], v[64:67], 0
v_permlane16_swap_b32 v128, v80
v_permlane16_swap_b32 v129, v84
v_mfma_f32_16x16x32_bf16 v[180:183], a[240:243], v[72:75], 0
v_permlane16_swap_b32 v130, v88
v_permlane16_swap_b32 v131, v92
v_mfma_f32_16x16x32_bf16 v[184:187], v[216:219], v[48:51], 0
v_max_f32 v80, v80, v128
v_max_f32 v84, v84, v129
v_mfma_f32_16x16x32_bf16 v[188:191], v[220:223], v[48:51], 0
v_max_f32 v88, v88, v130
v_max_f32 v92, v92, v131
v_mfma_f32_16x16x32_bf16 v[192:195], v[224:227], v[56:59], 0
v_mov_b32 v128, v80
v_mov_b32 v129, v84
v_mfma_f32_16x16x32_bf16 v[196:199], v[228:231], v[56:59], 0
v_mov_b32 v130, v88
v_mov_b32 v131, v92
v_mfma_f32_16x16x32_bf16 v[200:203], v[232:235], v[64:67], 0
v_permlane32_swap_b32 v128, v80
v_permlane32_swap_b32 v129, v84
v_mfma_f32_16x16x32_bf16 v[204:207], v[236:239], v[64:67], 0
v_permlane32_swap_b32 v130, v88
v_permlane32_swap_b32 v131, v92
v_mfma_f32_16x16x32_bf16 v[208:211], v[240:243], v[72:75], 0
v_max_f32 v80, v80, v128
v_max_f32 v84, v84, v129
v_mfma_f32_16x16x32_bf16 v[212:215], v[244:247], v[72:75], 0
v_max_f32 v88, v88, v130
v_max_f32 v92, v92, v131
v_rcp_f32 v128, v156
v_rcp_f32 v130, v164
v_rcp_f32 v132, v172
v_rcp_f32 v134, v180
v_sub_f32 v83, 0, v80
v_sub_f32 v82, 0, v80
v_sub_f32 v81, 0, v80
v_sub_f32 v80, 0, v80
v_min_f32 v103, s8, v80
v_cndmask_b32 v96, v103, v80, s[36:37]
v_cndmask_b32 v97, v103, v80, s[38:39]
v_cndmask_b32 v98, v103, v80, s[40:41]
v_cndmask_b32 v99, v103, v80, s[42:43]
v_cndmask_b32 v100, v9, v103, s[36:37]
v_cndmask_b32 v101, v9, v103, s[38:39]
v_cndmask_b32 v102, v9, v103, s[40:41]
v_cndmask_b32 v103, v9, v103, s[42:43]
v_pk_mul_f32 v[184:185], v[184:185], v[128:129] op_sel_hi:[1,0]
v_pk_mul_f32 v[186:187], v[186:187], v[128:129] op_sel_hi:[1,0]
v_pk_mul_f32 v[188:189], v[188:189], v[128:129] op_sel_hi:[1,0]
v_pk_mul_f32 v[190:191], v[190:191], v[128:129] op_sel_hi:[1,0]
v_pk_mul_f32 v[192:193], v[192:193], v[130:131] op_sel_hi:[1,0]
v_pk_mul_f32 v[194:195], v[194:195], v[130:131] op_sel_hi:[1,0]
v_pk_mul_f32 v[196:197], v[196:197], v[130:131] op_sel_hi:[1,0]
v_pk_mul_f32 v[198:199], v[198:199], v[130:131] op_sel_hi:[1,0]
v_pk_mul_f32 v[200:201], v[200:201], v[132:133] op_sel_hi:[1,0]
v_pk_mul_f32 v[202:203], v[202:203], v[132:133] op_sel_hi:[1,0]
v_pk_mul_f32 v[204:205], v[204:205], v[132:133] op_sel_hi:[1,0]
v_pk_mul_f32 v[206:207], v[206:207], v[132:133] op_sel_hi:[1,0]
v_pk_mul_f32 v[208:209], v[208:209], v[134:135] op_sel_hi:[1,0]
v_pk_mul_f32 v[210:211], v[210:211], v[134:135] op_sel_hi:[1,0]
v_pk_mul_f32 v[212:213], v[212:213], v[134:135] op_sel_hi:[1,0]
v_pk_mul_f32 v[214:215], v[214:215], v[134:135] op_sel_hi:[1,0]
v_cvt_pk_bf16_f32 v32, v184, v185
v_cvt_pk_bf16_f32 v33, v186, v187
v_cvt_pk_bf16_f32 v34, v188, v189
v_cvt_pk_bf16_f32 v35, v190, v191
v_cvt_pk_bf16_f32 v36, v192, v193
v_cvt_pk_bf16_f32 v37, v194, v195
v_cvt_pk_bf16_f32 v38, v196, v197
v_cvt_pk_bf16_f32 v39, v198, v199
v_cvt_pk_bf16_f32 v40, v200, v201
v_cvt_pk_bf16_f32 v41, v202, v203
v_cvt_pk_bf16_f32 v42, v204, v205
v_cvt_pk_bf16_f32 v43, v206, v207
v_cvt_pk_bf16_f32 v44, v208, v209
v_cvt_pk_bf16_f32 v45, v210, v211
v_cvt_pk_bf16_f32 v46, v212, v213
v_cvt_pk_bf16_f32 v47, v214, v215
buffer_store_dwordx4 v[32:35], v3, s[88:91], s44 offen sc1
v_sub_f32 v87, 0, v84
v_sub_f32 v86, 0, v84
v_sub_f32 v85, 0, v84
v_sub_f32 v84, 0, v84
v_min_f32 v111, s9, v84
v_cndmask_b32 v104, v111, v84, s[36:37]
v_cndmask_b32 v105, v111, v84, s[38:39]
v_cndmask_b32 v106, v111, v84, s[40:41]
v_cndmask_b32 v107, v111, v84, s[42:43]
v_cndmask_b32 v108, v9, v111, s[36:37]
v_cndmask_b32 v109, v9, v111, s[38:39]
v_cndmask_b32 v110, v9, v111, s[40:41]
v_cndmask_b32 v111, v9, v111, s[42:43]
v_sub_f32 v91, 0, v88
v_sub_f32 v90, 0, v88
v_sub_f32 v89, 0, v88
v_sub_f32 v88, 0, v88
v_min_f32 v119, s8, v88
v_cndmask_b32 v112, v119, v88, s[36:37]
v_cndmask_b32 v113, v119, v88, s[38:39]
v_cndmask_b32 v114, v119, v88, s[40:41]
v_cndmask_b32 v115, v119, v88, s[42:43]
v_cndmask_b32 v116, v9, v119, s[36:37]
buffer_store_dwordx4 v[36:39], v3, s[88:91], s45 offen sc1
v_cndmask_b32 v117, v9, v119, s[38:39]
v_cndmask_b32 v118, v9, v119, s[40:41]
v_cndmask_b32 v119, v9, v119, s[42:43]
v_sub_f32 v95, 0, v92
v_sub_f32 v94, 0, v92
v_sub_f32 v93, 0, v92
v_sub_f32 v92, 0, v92
v_min_f32 v127, s9, v92
v_cndmask_b32 v120, v127, v92, s[36:37]
v_cndmask_b32 v121, v127, v92, s[38:39]
v_cndmask_b32 v122, v127, v92, s[40:41]
v_cndmask_b32 v123, v127, v92, s[42:43]
v_cndmask_b32 v124, v9, v127, s[36:37]
v_cndmask_b32 v125, v9, v127, s[38:39]
v_cndmask_b32 v126, v9, v127, s[40:41]
v_cndmask_b32 v127, v9, v127, s[42:43]
v_and_b32 v9, 1, v0
v_mul_u32_u24 v9, 0xaaaa, v9
v_add_u32 v9, 0x4444, v9
v_mov_b64 v[128:129], 0
v_mov_b64 v[130:131], 0
v_mov_b64 v[132:133], 0
v_mov_b64 v[134:135], 0
v_mov_b64 v[136:137], 0
buffer_store_dwordx4 v[40:43], v3, s[88:91], s46 offen sc1
v_mov_b64 v[138:139], 0
v_mov_b64 v[152:153], 0
v_mov_b64 v[154:155], 0
v_mov_b64 v[156:157], 0
v_mov_b64 v[158:159], 0
v_mov_b64 v[160:161], 0
v_mov_b64 v[162:163], 0
v_mov_b64 v[164:165], 0
v_mov_b64 v[166:167], 0
v_mov_b64 v[168:169], 0
v_mov_b64 v[170:171], 0
v_mov_b64 v[172:173], 0
v_mov_b64 v[174:175], 0
v_mov_b64 v[176:177], 0
v_mov_b64 v[178:179], 0
v_mov_b64 v[180:181], 0
v_mov_b64 v[182:183], 0
v_mov_b64 v[184:185], 0
v_mov_b64 v[186:187], 0
v_mov_b64 v[188:189], 0
v_mov_b64 v[190:191], 0
v_mov_b64 v[192:193], 0
v_mov_b64 v[194:195], 0
buffer_store_dwordx4 v[44:47], v3, s[88:91], s47 offen sc1
v_mov_b64 v[196:197], 0
v_mov_b64 v[198:199], 0
v_mov_b64 v[200:201], 0
v_mov_b64 v[202:203], 0
v_mov_b64 v[204:205], 0
v_mov_b64 v[206:207], 0
v_mov_b64 v[208:209], 0
v_mov_b64 v[210:211], 0
v_mov_b64 v[212:213], 0
v_mov_b64 v[214:215], 0
v_mov_b64 v[216:217], 0
v_mov_b64 v[218:219], 0
v_mov_b64 v[220:221], 0
v_mov_b64 v[222:223], 0
v_mov_b64 v[224:225], 0
v_mov_b64 v[226:227], 0
v_mov_b64 v[228:229], 0
v_mov_b64 v[230:231], 0
v_mov_b64 v[232:233], 0
v_mov_b64 v[234:235], 0
v_mov_b64 v[236:237], 0
v_mov_b64 v[238:239], 0
v_mov_b64 v[252:253], 0
v_mov_b64 v[254:255], 0
L_att_start:
s_mov_b32 s15, s6
s_cmp_eq_u32 s6, 0
s_cbranch_scc1 L_att_j0
v_mfma_f32_16x16x32_bf16 v[16:19], a[0:3], a[160:163], v[80:83]
ds_read_b128 a[128:131], v1 offset:24576
v_mov_b32 v240, 0
v_mfma_f32_16x16x32_bf16 v[16:19], a[4:7], a[164:167], v[16:19]
ds_read_b128 a[132:135], v1 offset:25600
v_mov_b32 v241, 0
v_mfma_f32_16x16x32_bf16 v[16:19], a[8:11], a[168:171], v[16:19]
ds_read_b128 a[136:139], v1 offset:26624
s_add_u32 m0, s27, 0x0
v_mfma_f32_16x16x32_bf16 v[16:19], a[12:15], a[172:175], v[16:19]
buffer_load_dwordx4 v3, s[48:51], s32 offen offset:0 sc1 lds
v_mfma_f32_16x16x32_bf16 v[20:23], a[0:3], a[176:179], v[84:87]
ds_read_b128 a[140:143], v1 offset:27648
v_mov_b32 v242, 0
v_mfma_f32_16x16x32_bf16 v[20:23], a[4:7], a[180:183], v[20:23]
ds_read_b128 a[144:147], v1 offset:28672
v_mov_b32 v243, 0
v_mfma_f32_16x16x32_bf16 v[20:23], a[8:11], a[184:187], v[20:23]
ds_read_b128 a[148:151], v1 offset:29696
v_mov_b32 v244, 0
v_mfma_f32_16x16x32_bf16 v[20:23], a[12:15], a[188:191], v[20:23]
ds_read_b128 a[152:155], v1 offset:30720
v_mov_b32 v245, 0
v_mfma_f32_16x16x32_bf16 v[24:27], a[0:3], a[192:195], v[88:91]
ds_read_b128 a[156:159], v1 offset:31744
v_exp_f32 v16, v16
v_mfma_f32_16x16x32_bf16 v[24:27], a[4:7], a[196:199], v[24:27]
v_exp_f32 v17, v17
v_mfma_f32_16x16x32_bf16 v[24:27], a[8:11], a[200:203], v[24:27]
buffer_load_dwordx4 v3, s[48:51], s32 offen offset:1024 sc1 lds
v_mfma_f32_16x16x32_bf16 v[24:27], a[12:15], a[204:207], v[24:27]
v_exp_f32 v18, v18
v_mfma_f32_16x16x32_bf16 v[28:31], a[0:3], a[208:211], v[92:95]
v_exp_f32 v19, v19
v_mfma_f32_16x16x32_bf16 v[28:31], a[4:7], a[212:215], v[28:31]
v_exp_f32 v20, v20
v_mfma_f32_16x16x32_bf16 v[28:31], a[8:11], a[216:219], v[28:31]
v_cvt_pk_bf16_f32 v48, v16, v17
v_cvt_pk_bf16_f32 v49, v18, v19
v_mfma_f32_16x16x32_bf16 v[28:31], a[12:15], a[220:223], v[28:31]
v_exp_f32 v21, v21
v_mfma_f32_16x16x32_bf16 v[32:35], a[16:19], a[160:163], v[80:83]
v_exp_f32 v22, v22
v_mfma_f32_16x16x32_bf16 v[32:35], a[20:23], a[164:167], v[32:35]
v_exp_f32 v23, v23
v_mfma_f32_16x16x32_bf16 v[32:35], a[24:27], a[168:171], v[32:35]
buffer_load_dwordx4 v3, s[48:51], s32 offen offset:2048 sc1 lds
v_mfma_f32_16x16x32_bf16 v[32:35], a[28:31], a[172:175], v[32:35]
v_exp_f32 v24, v24
v_mfma_f32_16x16x32_bf16 v[36:39], a[16:19], a[176:179], v[84:87]
v_exp_f32 v25, v25
v_mfma_f32_16x16x32_bf16 v[36:39], a[20:23], a[180:183], v[36:39]
v_cvt_pk_bf16_f32 v52, v20, v21
v_cvt_pk_bf16_f32 v53, v22, v23
v_mfma_f32_16x16x32_bf16 v[36:39], a[24:27], a[184:187], v[36:39]
v_exp_f32 v26, v26
v_mfma_f32_16x16x32_bf16 v[36:39], a[28:31], a[188:191], v[36:39]
v_exp_f32 v27, v27
v_mfma_f32_16x16x32_bf16 v[40:43], a[16:19], a[192:195], v[88:91]
v_exp_f32 v28, v28
v_mfma_f32_16x16x32_bf16 v[40:43], a[20:23], a[196:199], v[40:43]
buffer_load_dwordx4 v3, s[48:51], s32 offen offset:3072 sc1 lds
v_mfma_f32_16x16x32_bf16 v[40:43], a[24:27], a[200:203], v[40:43]
s_add_u32 s32, s32, 0x8000
v_exp_f32 v29, v29
v_mfma_f32_16x16x32_bf16 v[40:43], a[28:31], a[204:207], v[40:43]
v_exp_f32 v30, v30
v_mfma_f32_16x16x32_bf16 v[44:47], a[16:19], a[208:211], v[92:95]
v_exp_f32 v31, v31
v_mfma_f32_16x16x32_bf16 v[44:47], a[20:23], a[212:215], v[44:47]
v_exp_f32 v32, v32
v_mfma_f32_16x16x32_bf16 v[44:47], a[24:27], a[216:219], v[44:47]
v_exp_f32 v33, v33
v_mfma_f32_16x16x32_bf16 v[44:47], a[28:31], a[220:223], v[44:47]
s_waitcnt lgkmcnt(0)
v_cvt_pk_bf16_f32 v56, v24, v25
v_cvt_pk_bf16_f32 v57, v26, v27
v_mov_b32 v246, 0
v_mov_b32 v247, 0
v_mfma_f32_16x16x32_bf16 v[16:19], a[128:131], a[160:163], v[80:83]
ds_read_b128 a[32:35], v1 offset:16384
v_cvt_pk_bf16_f32 v60, v28, v29
v_mfma_f32_16x16x32_bf16 v[16:19], a[132:135], a[164:167], v[16:19]
v_exp_f32 v34, v34
v_mfma_f32_16x16x32_bf16 v[16:19], a[136:139], a[168:171], v[16:19]
s_add_u32 m0, s27, 0x1000
v_exp_f32 v35, v35
v_mfma_f32_16x16x32_bf16 v[16:19], a[140:143], a[172:175], v[16:19]
buffer_load_dwordx4 v3, s[48:51], s7 offen offset:0 sc1 lds
v_mfma_f32_16x16x32_bf16 v[20:23], a[128:131], a[176:179], v[84:87]
ds_read_b128 a[36:39], v1 offset:17408
v_cvt_pk_bf16_f32 v61, v30, v31
v_mfma_f32_16x16x32_bf16 v[20:23], a[132:135], a[180:183], v[20:23]
v_exp_f32 v36, v36
v_mfma_f32_16x16x32_bf16 v[20:23], a[136:139], a[184:187], v[20:23]
ds_read_b128 a[40:43], v1 offset:18432
v_cvt_pk_bf16_f32 v50, v32, v33
v_mfma_f32_16x16x32_bf16 v[20:23], a[140:143], a[188:191], v[20:23]
v_exp_f32 v37, v37
v_mfma_f32_16x16x32_bf16 v[24:27], a[128:131], a[192:195], v[88:91]
v_exp_f32 v38, v38
v_mfma_f32_16x16x32_bf16 v[24:27], a[132:135], a[196:199], v[24:27]
ds_read_b128 a[44:47], v1 offset:19456
v_cvt_pk_bf16_f32 v51, v34, v35
v_mfma_f32_16x16x32_bf16 v[24:27], a[136:139], a[200:203], v[24:27]
buffer_load_dwordx4 v3, s[48:51], s7 offen offset:1024 sc1 lds
v_mfma_f32_16x16x32_bf16 v[24:27], a[140:143], a[204:207], v[24:27]
v_exp_f32 v39, v39
v_mfma_f32_16x16x32_bf16 v[28:31], a[128:131], a[208:211], v[92:95]
v_exp_f32 v40, v40
v_mfma_f32_16x16x32_bf16 v[28:31], a[132:135], a[212:215], v[28:31]
ds_read_b128 a[48:51], v1 offset:20480
v_cvt_pk_bf16_f32 v54, v36, v37
v_mfma_f32_16x16x32_bf16 v[28:31], a[136:139], a[216:219], v[28:31]
v_exp_f32 v41, v41
v_mfma_f32_16x16x32_bf16 v[28:31], a[140:143], a[220:223], v[28:31]
v_exp_f32 v42, v42
v_mfma_f32_16x16x32_bf16 v[32:35], a[144:147], a[160:163], v[80:83]
buffer_load_dwordx4 v3, s[48:51], s7 offen offset:2048 sc1 lds
v_mfma_f32_16x16x32_bf16 v[32:35], a[148:151], a[164:167], v[32:35]
ds_read_b128 a[52:55], v1 offset:21504
v_cvt_pk_bf16_f32 v55, v38, v39
v_mfma_f32_16x16x32_bf16 v[32:35], a[152:155], a[168:171], v[32:35]
v_exp_f32 v43, v43
v_mfma_f32_16x16x32_bf16 v[32:35], a[156:159], a[172:175], v[32:35]
ds_read_b128 a[56:59], v1 offset:22528
v_cvt_pk_bf16_f32 v58, v40, v41
v_mfma_f32_16x16x32_bf16 v[36:39], a[144:147], a[176:179], v[84:87]
v_exp_f32 v44, v44
v_mfma_f32_16x16x32_bf16 v[36:39], a[148:151], a[180:183], v[36:39]
v_exp_f32 v45, v45
v_mfma_f32_16x16x32_bf16 v[36:39], a[152:155], a[184:187], v[36:39]
ds_read_b128 a[60:63], v1 offset:23552
v_xor_b32 v1, 0x8000, v1
v_mfma_f32_16x16x32_bf16 v[36:39], a[156:159], a[188:191], v[36:39]
buffer_load_dwordx4 v3, s[48:51], s7 offen offset:3072 sc1 lds
v_cvt_pk_bf16_f32 v59, v42, v43
v_mfma_f32_16x16x32_bf16 v[40:43], a[144:147], a[192:195], v[88:91]
s_add_u32 s7, s7, 0x8000
v_exp_f32 v46, v46
v_mfma_f32_16x16x32_bf16 v[40:43], a[148:151], a[196:199], v[40:43]
s_xor_b32 s27, s27, 0x38000
v_exp_f32 v47, v47
v_mfma_f32_16x16x32_bf16 v[40:43], a[152:155], a[200:203], v[40:43]
v_exp_f32 v16, v16
v_mfma_f32_16x16x32_bf16 v[40:43], a[156:159], a[204:207], v[40:43]
v_exp_f32 v17, v17
v_cvt_pk_bf16_f32 v62, v44, v45
v_cvt_pk_bf16_f32 v63, v46, v47
v_mfma_f32_16x16x32_bf16 v[44:47], a[144:147], a[208:211], v[92:95]
v_exp_f32 v18, v18
v_mfma_f32_16x16x32_bf16 v[44:47], a[148:151], a[212:215], v[44:47]
v_exp_f32 v19, v19
v_mfma_f32_16x16x32_bf16 v[44:47], a[152:155], a[216:219], v[44:47]
s_waitcnt vmcnt(8) lgkmcnt(0)
v_exp_f32 v20, v20
v_mfma_f32_16x16x32_bf16 v[44:47], a[156:159], a[220:223], v[44:47]
s_barrier
v_cvt_pk_bf16_f32 v64, v16, v17
v_exp_f32 v21, v21
v_exp_f32 v22, v22
v_exp_f32 v23, v23
v_exp_f32 v24, v24
v_exp_f32 v25, v25
v_exp_f32 v26, v26
v_exp_f32 v27, v27
v_cvt_pk_bf16_f32 v65, v18, v19
v_cvt_pk_bf16_f32 v68, v20, v21
v_cvt_pk_bf16_f32 v69, v22, v23
s_cmp_lg_u32 s33, 0
s_cbranch_scc1 L_sig_bd
s_lshl_b32 s8, s6, 2
s_add_u32 s8, s8, 192
s_cmp_lg_u32 s4, 0
s_cbranch_scc1 L_sig_bd
v_mov_b32 v4, 1
s_mov_b64 exec, 1
buffer_atomic_add v4, off, s[84:87], s8 sc1
s_mov_b64 exec, -1
L_sig_bd:
s_getreg_b32 s8, hwreg(HW_REG_HW_ID, 5, 1)
s_cmp_lg_u32 s8, 0
s_cbranch_scc1 L_att_dodd1
s_branch L_att_dodd0
L_att_deven0:
v_mfma_f32_16x16x32_bf16 v[128:131], a[32:35], v[48:51], v[128:131]
ds_read_b128 a[0:3], v1 offset:8192
v_cvt_pk_bf16_f32 v72, v24, v25
v_mfma_f32_16x16x32_bf16 v[160:163], a[32:35], v[52:55], v[160:163]
v_exp_f32 v28, v28
v_mfma_f32_16x16x32_bf16 v[192:195], a[32:35], v[56:59], v[192:195]
v_cvt_pk_bf16_f32 v73, v26, v27
v_mfma_f32_16x16x32_bf16 v[224:227], a[32:35], v[60:63], v[224:227]
ds_read_b128 a[4:7], v1 offset:9216
v_mfma_f32_16x16x32_bf16 v[228:231], a[36:39], v[60:63], v[228:231]
v_exp_f32 v29, v29
v_mfma_f32_16x16x32_bf16 v[196:199], a[36:39], v[56:59], v[196:199]
v_exp_f32 v30, v30
v_mfma_f32_16x16x32_bf16 v[164:167], a[36:39], v[52:55], v[164:167]
s_add_u32 m0, s27, 0x0
v_cvt_pk_bf16_f32 v76, v28, v29
v_mfma_f32_16x16x32_bf16 v[132:135], a[36:39], v[48:51], v[132:135]
buffer_load_dwordx4 v3, s[48:51], s32 offen offset:0 sc1 lds
v_mfma_f32_16x16x32_bf16 v[136:139], a[40:43], v[48:51], v[136:139]
ds_read_b128 a[8:11], v1 offset:10240
v_mfma_f32_16x16x32_bf16 v[168:171], a[40:43], v[52:55], v[168:171]
v_exp_f32 v31, v31
v_mfma_f32_16x16x32_bf16 v[200:203], a[40:43], v[56:59], v[200:203]
v_exp_f32 v32, v32
v_mfma_f32_16x16x32_bf16 v[232:235], a[40:43], v[60:63], v[232:235]
ds_read_b128 a[12:15], v1 offset:11264
v_cvt_pk_bf16_f32 v77, v30, v31
v_mfma_f32_16x16x32_bf16 v[236:239], a[44:47], v[60:63], v[236:239]
v_mfma_f32_16x16x32_bf16 v[204:207], a[44:47], v[56:59], v[204:207]
v_exp_f32 v33, v33
v_mfma_f32_16x16x32_bf16 v[172:175], a[44:47], v[52:55], v[172:175]
v_exp_f32 v34, v34
v_mfma_f32_16x16x32_bf16 v[140:143], a[44:47], v[48:51], v[140:143]
ds_read_b128 a[16:19], v1 offset:12288
v_cvt_pk_bf16_f32 v66, v32, v33
v_mfma_f32_16x16x32_bf16 v[144:147], a[48:51], v[48:51], v[144:147]
v_mfma_f32_16x16x32_bf16 v[176:179], a[48:51], v[52:55], v[176:179]
v_exp_f32 v35, v35
v_mfma_f32_16x16x32_bf16 v[208:211], a[48:51], v[56:59], v[208:211]
v_exp_f32 v36, v36
v_mfma_f32_16x16x32_bf16 v[240:243], a[48:51], v[60:63], v[240:243]
ds_read_b128 a[20:23], v1 offset:13312
v_cvt_pk_bf16_f32 v67, v34, v35
v_mfma_f32_16x16x32_bf16 v[244:247], a[52:55], v[60:63], v[244:247]
v_exp_f32 v37, v37
v_mfma_f32_16x16x32_bf16 v[212:215], a[52:55], v[56:59], v[212:215]
v_cvt_pk_bf16_f32 v70, v36, v37
v_mfma_f32_16x16x32_bf16 v[180:183], a[52:55], v[52:55], v[180:183]
ds_read_b128 a[24:27], v1 offset:14336
v_mfma_f32_16x16x32_bf16 v[148:151], a[52:55], v[48:51], v[148:151]
buffer_load_dwordx4 v3, s[48:51], s32 offen offset:1024 sc1 lds
v_mfma_f32_16x16x32_bf16 v[152:155], a[56:59], v[48:51], v[152:155]
v_exp_f32 v38, v38
v_mfma_f32_16x16x32_bf16 v[184:187], a[56:59], v[52:55], v[184:187]
v_exp_f32 v39, v39
v_mfma_f32_16x16x32_bf16 v[216:219], a[56:59], v[56:59], v[216:219]
ds_read_b128 a[28:31], v1 offset:15360
v_cvt_pk_bf16_f32 v71, v38, v39
v_mfma_f32_16x16x32_bf16 v[248:251], a[56:59], v[60:63], v[248:251]
v_mfma_f32_16x16x32_bf16 v[252:255], a[60:63], v[60:63], v[252:255]
v_exp_f32 v40, v40
v_mfma_f32_16x16x32_bf16 v[220:223], a[60:63], v[56:59], v[220:223]
v_exp_f32 v41, v41
v_mfma_f32_16x16x32_bf16 v[188:191], a[60:63], v[52:55], v[188:191]
ds_read_b128 a[32:35], v1 offset:0
v_cvt_pk_bf16_f32 v74, v40, v41
v_mfma_f32_16x16x32_bf16 v[156:159], a[60:63], v[48:51], v[156:159]
v_smfmac_f32_16x16x64_bf16 a[224:227], a[232:235], v[48:55], v9
v_exp_f32 v42, v42
v_smfmac_f32_16x16x64_bf16 a[228:231], a[232:235], v[56:63], v9
s_waitcnt lgkmcnt(5)
v_exp_f32 v43, v43
v_mfma_f32_16x16x32_bf16 v[16:19], a[0:3], a[160:163], v[80:83]
ds_read_b128 a[36:39], v1 offset:1024
v_cvt_pk_bf16_f32 v75, v42, v43
v_mfma_f32_16x16x32_bf16 v[16:19], a[4:7], a[164:167], v[16:19]
v_exp_f32 v44, v44
v_mfma_f32_16x16x32_bf16 v[16:19], a[8:11], a[168:171], v[16:19]
v_mfma_f32_16x16x32_bf16 v[16:19], a[12:15], a[172:175], v[16:19]
v_exp_f32 v45, v45
v_mfma_f32_16x16x32_bf16 v[20:23], a[0:3], a[176:179], v[84:87]
ds_read_b128 a[40:43], v1 offset:2048
v_cvt_pk_bf16_f32 v78, v44, v45
v_mfma_f32_16x16x32_bf16 v[20:23], a[4:7], a[180:183], v[20:23]
buffer_load_dwordx4 v3, s[48:51], s32 offen offset:2048 sc1 lds
v_mfma_f32_16x16x32_bf16 v[20:23], a[8:11], a[184:187], v[20:23]
v_exp_f32 v46, v46
v_mfma_f32_16x16x32_bf16 v[20:23], a[12:15], a[188:191], v[20:23]
ds_read_b128 a[44:47], v1 offset:3072
v_mfma_f32_16x16x32_bf16 v[24:27], a[0:3], a[192:195], v[88:91]
v_mfma_f32_16x16x32_bf16 v[24:27], a[4:7], a[196:199], v[24:27]
v_exp_f32 v47, v47
v_mfma_f32_16x16x32_bf16 v[24:27], a[8:11], a[200:203], v[24:27]
v_exp_f32 v16, v16
v_mfma_f32_16x16x32_bf16 v[24:27], a[12:15], a[204:207], v[24:27]
ds_read_b128 a[48:51], v1 offset:4096
v_cvt_pk_bf16_f32 v79, v46, v47
v_mfma_f32_16x16x32_bf16 v[28:31], a[0:3], a[208:211], v[92:95]
v_mfma_f32_16x16x32_bf16 v[28:31], a[4:7], a[212:215], v[28:31]
v_exp_f32 v17, v17
v_mfma_f32_16x16x32_bf16 v[28:31], a[8:11], a[216:219], v[28:31]
s_waitcnt lgkmcnt(5)
v_exp_f32 v18, v18
v_mfma_f32_16x16x32_bf16 v[28:31], a[12:15], a[220:223], v[28:31]
ds_read_b128 a[52:55], v1 offset:5120
v_cvt_pk_bf16_f32 v48, v16, v17
v_mfma_f32_16x16x32_bf16 v[32:35], a[16:19], a[160:163], v[80:83]
v_mfma_f32_16x16x32_bf16 v[32:35], a[20:23], a[164:167], v[32:35]
v_exp_f32 v19, v19
v_mfma_f32_16x16x32_bf16 v[32:35], a[24:27], a[168:171], v[32:35]
v_exp_f32 v20, v20
v_mfma_f32_16x16x32_bf16 v[32:35], a[28:31], a[172:175], v[32:35]
ds_read_b128 a[56:59], v1 offset:6144
v_cvt_pk_bf16_f32 v49, v18, v19
v_mfma_f32_16x16x32_bf16 v[36:39], a[16:19], a[176:179], v[84:87]
v_exp_f32 v21, v21
v_mfma_f32_16x16x32_bf16 v[36:39], a[20:23], a[180:183], v[36:39]
buffer_load_dwordx4 v3, s[48:51], s32 offen offset:3072 sc1 lds
v_mfma_f32_16x16x32_bf16 v[36:39], a[24:27], a[184:187], v[36:39]
s_add_u32 s32, s32, 0x8000
v_cvt_pk_bf16_f32 v52, v20, v21
v_mfma_f32_16x16x32_bf16 v[36:39], a[28:31], a[188:191], v[36:39]
ds_read_b128 a[60:63], v1 offset:7168
v_mfma_f32_16x16x32_bf16 v[40:43], a[16:19], a[192:195], v[88:91]
v_exp_f32 v22, v22
v_mfma_f32_16x16x32_bf16 v[40:43], a[20:23], a[196:199], v[40:43]
v_exp_f32 v23, v23
v_mfma_f32_16x16x32_bf16 v[40:43], a[24:27], a[200:203], v[40:43]
v_cvt_pk_bf16_f32 v53, v22, v23
v_mfma_f32_16x16x32_bf16 v[40:43], a[28:31], a[204:207], v[40:43]
v_exp_f32 v24, v24
v_mfma_f32_16x16x32_bf16 v[44:47], a[16:19], a[208:211], v[92:95]
v_exp_f32 v25, v25
v_mfma_f32_16x16x32_bf16 v[44:47], a[20:23], a[212:215], v[44:47]
v_exp_f32 v26, v26
v_mfma_f32_16x16x32_bf16 v[44:47], a[24:27], a[216:219], v[44:47]
v_exp_f32 v27, v27
v_mfma_f32_16x16x32_bf16 v[44:47], a[28:31], a[220:223], v[44:47]
s_waitcnt lgkmcnt(0)
v_mfma_f32_16x16x32_bf16 v[128:131], a[32:35], v[64:67], v[128:131]
ds_read_b128 a[0:3], v1 offset:24576
v_cvt_pk_bf16_f32 v56, v24, v25
v_mfma_f32_16x16x32_bf16 v[160:163], a[32:35], v[68:71], v[160:163]
v_exp_f32 v28, v28
v_mfma_f32_16x16x32_bf16 v[192:195], a[32:35], v[72:75], v[192:195]
v_cvt_pk_bf16_f32 v57, v26, v27
v_mfma_f32_16x16x32_bf16 v[224:227], a[32:35], v[76:79], v[224:227]
ds_read_b128 a[4:7], v1 offset:25600
v_mfma_f32_16x16x32_bf16 v[228:231], a[36:39], v[76:79], v[228:231]
v_exp_f32 v29, v29
v_mfma_f32_16x16x32_bf16 v[196:199], a[36:39], v[72:75], v[196:199]
v_exp_f32 v30, v30
v_mfma_f32_16x16x32_bf16 v[164:167], a[36:39], v[68:71], v[164:167]
s_add_u32 m0, s27, 0x1000
v_cvt_pk_bf16_f32 v60, v28, v29
v_mfma_f32_16x16x32_bf16 v[132:135], a[36:39], v[64:67], v[132:135]
buffer_load_dwordx4 v3, s[48:51], s7 offen offset:0 sc1 lds
v_mfma_f32_16x16x32_bf16 v[136:139], a[40:43], v[64:67], v[136:139]
ds_read_b128 a[8:11], v1 offset:26624
v_mfma_f32_16x16x32_bf16 v[168:171], a[40:43], v[68:71], v[168:171]
v_exp_f32 v31, v31
v_mfma_f32_16x16x32_bf16 v[200:203], a[40:43], v[72:75], v[200:203]
v_exp_f32 v32, v32
v_mfma_f32_16x16x32_bf16 v[232:235], a[40:43], v[76:79], v[232:235]
ds_read_b128 a[12:15], v1 offset:27648
v_cvt_pk_bf16_f32 v61, v30, v31
v_mfma_f32_16x16x32_bf16 v[236:239], a[44:47], v[76:79], v[236:239]
v_mfma_f32_16x16x32_bf16 v[204:207], a[44:47], v[72:75], v[204:207]
v_exp_f32 v33, v33
v_mfma_f32_16x16x32_bf16 v[172:175], a[44:47], v[68:71], v[172:175]
v_exp_f32 v34, v34
v_mfma_f32_16x16x32_bf16 v[140:143], a[44:47], v[64:67], v[140:143]
ds_read_b128 a[16:19], v1 offset:28672
v_cvt_pk_bf16_f32 v50, v32, v33
v_mfma_f32_16x16x32_bf16 v[144:147], a[48:51], v[64:67], v[144:147]
v_mfma_f32_16x16x32_bf16 v[176:179], a[48:51], v[68:71], v[176:179]
v_exp_f32 v35, v35
v_mfma_f32_16x16x32_bf16 v[208:211], a[48:51], v[72:75], v[208:211]
ds_read_b128 a[20:23], v1 offset:29696
v_cvt_pk_bf16_f32 v51, v34, v35
v_mfma_f32_16x16x32_bf16 v[240:243], a[48:51], v[76:79], v[240:243]
v_exp_f32 v36, v36
v_mfma_f32_16x16x32_bf16 v[244:247], a[52:55], v[76:79], v[244:247]
v_exp_f32 v37, v37
v_mfma_f32_16x16x32_bf16 v[212:215], a[52:55], v[72:75], v[212:215]
v_cvt_pk_bf16_f32 v54, v36, v37
v_mfma_f32_16x16x32_bf16 v[180:183], a[52:55], v[68:71], v[180:183]
buffer_load_dwordx4 v3, s[48:51], s7 offen offset:1024 sc1 lds
v_mfma_f32_16x16x32_bf16 v[148:151], a[52:55], v[64:67], v[148:151]
ds_read_b128 a[24:27], v1 offset:30720
v_mfma_f32_16x16x32_bf16 v[152:155], a[56:59], v[64:67], v[152:155]
v_exp_f32 v38, v38
v_mfma_f32_16x16x32_bf16 v[184:187], a[56:59], v[68:71], v[184:187]
v_exp_f32 v39, v39
v_mfma_f32_16x16x32_bf16 v[216:219], a[56:59], v[72:75], v[216:219]
ds_read_b128 a[28:31], v1 offset:31744
v_cvt_pk_bf16_f32 v55, v38, v39
v_mfma_f32_16x16x32_bf16 v[248:251], a[56:59], v[76:79], v[248:251]
v_mfma_f32_16x16x32_bf16 v[252:255], a[60:63], v[76:79], v[252:255]
v_exp_f32 v40, v40
v_mfma_f32_16x16x32_bf16 v[220:223], a[60:63], v[72:75], v[220:223]
v_exp_f32 v41, v41
v_mfma_f32_16x16x32_bf16 v[188:191], a[60:63], v[68:71], v[188:191]
ds_read_b128 a[32:35], v1 offset:16384
v_cvt_pk_bf16_f32 v58, v40, v41
v_mfma_f32_16x16x32_bf16 v[156:159], a[60:63], v[64:67], v[156:159]
v_smfmac_f32_16x16x64_bf16 a[224:227], a[232:235], v[64:71], v9
s_waitcnt lgkmcnt(5)
v_exp_f32 v42, v42
v_smfmac_f32_16x16x64_bf16 a[228:231], a[232:235], v[72:79], v9
ds_read_b128 a[36:39], v1 offset:17408
v_mfma_f32_16x16x32_bf16 v[16:19], a[0:3], a[160:163], v[80:83]
v_exp_f32 v43, v43
v_mfma_f32_16x16x32_bf16 v[16:19], a[4:7], a[164:167], v[16:19]
v_exp_f32 v44, v44
v_mfma_f32_16x16x32_bf16 v[16:19], a[8:11], a[168:171], v[16:19]
v_cvt_pk_bf16_f32 v59, v42, v43
v_mfma_f32_16x16x32_bf16 v[16:19], a[12:15], a[172:175], v[16:19]
ds_read_b128 a[40:43], v1 offset:18432
v_mfma_f32_16x16x32_bf16 v[20:23], a[0:3], a[176:179], v[84:87]
buffer_load_dwordx4 v3, s[48:51], s7 offen offset:2048 sc1 lds
v_mfma_f32_16x16x32_bf16 v[20:23], a[4:7], a[180:183], v[20:23]
v_exp_f32 v45, v45
v_mfma_f32_16x16x32_bf16 v[20:23], a[8:11], a[184:187], v[20:23]
v_exp_f32 v46, v46
v_mfma_f32_16x16x32_bf16 v[20:23], a[12:15], a[188:191], v[20:23]
ds_read_b128 a[44:47], v1 offset:19456
v_cvt_pk_bf16_f32 v62, v44, v45
v_mfma_f32_16x16x32_bf16 v[24:27], a[0:3], a[192:195], v[88:91]
v_mfma_f32_16x16x32_bf16 v[24:27], a[4:7], a[196:199], v[24:27]
v_exp_f32 v47, v47
v_mfma_f32_16x16x32_bf16 v[24:27], a[8:11], a[200:203], v[24:27]
v_exp_f32 v16, v16
v_mfma_f32_16x16x32_bf16 v[24:27], a[12:15], a[204:207], v[24:27]
ds_read_b128 a[48:51], v1 offset:20480
v_cvt_pk_bf16_f32 v63, v46, v47
v_mfma_f32_16x16x32_bf16 v[28:31], a[0:3], a[208:211], v[92:95]
v_mfma_f32_16x16x32_bf16 v[28:31], a[4:7], a[212:215], v[28:31]
v_exp_f32 v17, v17
v_mfma_f32_16x16x32_bf16 v[28:31], a[8:11], a[216:219], v[28:31]
ds_read_b128 a[52:55], v1 offset:21504
v_cvt_pk_bf16_f32 v64, v16, v17
v_mfma_f32_16x16x32_bf16 v[28:31], a[12:15], a[220:223], v[28:31]
s_waitcnt lgkmcnt(6)
v_exp_f32 v18, v18
v_mfma_f32_16x16x32_bf16 v[32:35], a[16:19], a[160:163], v[80:83]
v_mfma_f32_16x16x32_bf16 v[32:35], a[20:23], a[164:167], v[32:35]
v_exp_f32 v19, v19
v_mfma_f32_16x16x32_bf16 v[32:35], a[24:27], a[168:171], v[32:35]
ds_read_b128 a[56:59], v1 offset:22528
v_cvt_pk_bf16_f32 v65, v18, v19
v_mfma_f32_16x16x32_bf16 v[32:35], a[28:31], a[172:175], v[32:35]
buffer_load_dwordx4 v3, s[48:51], s7 offen offset:3072 sc1 lds
v_mfma_f32_16x16x32_bf16 v[36:39], a[16:19], a[176:179], v[84:87]
s_add_u32 s7, s7, 0x8000
v_exp_f32 v20, v20
v_mfma_f32_16x16x32_bf16 v[36:39], a[20:23], a[180:183], v[36:39]
s_xor_b32 s27, s27, 0x38000
v_exp_f32 v21, v21
v_mfma_f32_16x16x32_bf16 v[36:39], a[24:27], a[184:187], v[36:39]
ds_read_b128 a[60:63], v1 offset:23552
v_xor_b32 v1, 0x8000, v1
v_mfma_f32_16x16x32_bf16 v[36:39], a[28:31], a[188:191], v[36:39]
v_cvt_pk_bf16_f32 v68, v20, v21
v_mfma_f32_16x16x32_bf16 v[40:43], a[16:19], a[192:195], v[88:91]
v_exp_f32 v22, v22
v_mfma_f32_16x16x32_bf16 v[40:43], a[20:23], a[196:199], v[40:43]
v_exp_f32 v23, v23
v_mfma_f32_16x16x32_bf16 v[40:43], a[24:27], a[200:203], v[40:43]
v_cvt_pk_bf16_f32 v69, v22, v23
v_mfma_f32_16x16x32_bf16 v[40:43], a[28:31], a[204:207], v[40:43]
v_exp_f32 v24, v24
v_mfma_f32_16x16x32_bf16 v[44:47], a[16:19], a[208:211], v[92:95]
v_exp_f32 v25, v25
v_mfma_f32_16x16x32_bf16 v[44:47], a[20:23], a[212:215], v[44:47]
v_exp_f32 v26, v26
v_mfma_f32_16x16x32_bf16 v[44:47], a[24:27], a[216:219], v[44:47]
s_waitcnt vmcnt(16) lgkmcnt(0)
v_exp_f32 v27, v27
v_mfma_f32_16x16x32_bf16 v[44:47], a[28:31], a[220:223], v[44:47]
s_barrier
L_att_dodd0:
v_mfma_f32_16x16x32_bf16 v[128:131], a[32:35], v[48:51], v[128:131]
ds_read_b128 a[0:3], v2 offset:8192
v_cvt_pk_bf16_f32 v72, v24, v25
v_mfma_f32_16x16x32_bf16 v[160:163], a[32:35], v[52:55], v[160:163]
v_exp_f32 v28, v28
v_mfma_f32_16x16x32_bf16 v[192:195], a[32:35], v[56:59], v[192:195]
v_cvt_pk_bf16_f32 v73, v26, v27
v_mfma_f32_16x16x32_bf16 v[224:227], a[32:35], v[60:63], v[224:227]
ds_read_b128 a[4:7], v2 offset:9216
v_mfma_f32_16x16x32_bf16 v[228:231], a[36:39], v[60:63], v[228:231]
v_exp_f32 v29, v29
v_mfma_f32_16x16x32_bf16 v[196:199], a[36:39], v[56:59], v[196:199]
v_exp_f32 v30, v30
v_mfma_f32_16x16x32_bf16 v[164:167], a[36:39], v[52:55], v[164:167]
s_add_u32 m0, s19, 0x0
v_cvt_pk_bf16_f32 v76, v28, v29
v_mfma_f32_16x16x32_bf16 v[132:135], a[36:39], v[48:51], v[132:135]
buffer_load_dwordx4 v3, s[48:51], s32 offen offset:0 sc1 lds
v_mfma_f32_16x16x32_bf16 v[136:139], a[40:43], v[48:51], v[136:139]
ds_read_b128 a[8:11], v2 offset:10240
v_mfma_f32_16x16x32_bf16 v[168:171], a[40:43], v[52:55], v[168:171]
v_exp_f32 v31, v31
v_mfma_f32_16x16x32_bf16 v[200:203], a[40:43], v[56:59], v[200:203]
v_exp_f32 v32, v32
v_mfma_f32_16x16x32_bf16 v[232:235], a[40:43], v[60:63], v[232:235]
ds_read_b128 a[12:15], v2 offset:11264
v_cvt_pk_bf16_f32 v77, v30, v31
v_mfma_f32_16x16x32_bf16 v[236:239], a[44:47], v[60:63], v[236:239]
v_mfma_f32_16x16x32_bf16 v[204:207], a[44:47], v[56:59], v[204:207]
v_exp_f32 v33, v33
v_mfma_f32_16x16x32_bf16 v[172:175], a[44:47], v[52:55], v[172:175]
v_exp_f32 v34, v34
v_mfma_f32_16x16x32_bf16 v[140:143], a[44:47], v[48:51], v[140:143]
ds_read_b128 a[16:19], v2 offset:12288
v_cvt_pk_bf16_f32 v66, v32, v33
v_mfma_f32_16x16x32_bf16 v[144:147], a[48:51], v[48:51], v[144:147]
v_mfma_f32_16x16x32_bf16 v[176:179], a[48:51], v[52:55], v[176:179]
v_exp_f32 v35, v35
v_mfma_f32_16x16x32_bf16 v[208:211], a[48:51], v[56:59], v[208:211]
v_exp_f32 v36, v36
v_mfma_f32_16x16x32_bf16 v[240:243], a[48:51], v[60:63], v[240:243]
ds_read_b128 a[20:23], v2 offset:13312
v_cvt_pk_bf16_f32 v67, v34, v35
v_mfma_f32_16x16x32_bf16 v[244:247], a[52:55], v[60:63], v[244:247]
v_exp_f32 v37, v37
v_mfma_f32_16x16x32_bf16 v[212:215], a[52:55], v[56:59], v[212:215]
v_cvt_pk_bf16_f32 v70, v36, v37
v_mfma_f32_16x16x32_bf16 v[180:183], a[52:55], v[52:55], v[180:183]
ds_read_b128 a[24:27], v2 offset:14336
v_mfma_f32_16x16x32_bf16 v[148:151], a[52:55], v[48:51], v[148:151]
buffer_load_dwordx4 v3, s[48:51], s32 offen offset:1024 sc1 lds
v_mfma_f32_16x16x32_bf16 v[152:155], a[56:59], v[48:51], v[152:155]
v_exp_f32 v38, v38
v_mfma_f32_16x16x32_bf16 v[184:187], a[56:59], v[52:55], v[184:187]
v_exp_f32 v39, v39
v_mfma_f32_16x16x32_bf16 v[216:219], a[56:59], v[56:59], v[216:219]
ds_read_b128 a[28:31], v2 offset:15360
v_cvt_pk_bf16_f32 v71, v38, v39
v_mfma_f32_16x16x32_bf16 v[248:251], a[56:59], v[60:63], v[248:251]
v_mfma_f32_16x16x32_bf16 v[252:255], a[60:63], v[60:63], v[252:255]
v_exp_f32 v40, v40
v_mfma_f32_16x16x32_bf16 v[220:223], a[60:63], v[56:59], v[220:223]
v_exp_f32 v41, v41
v_mfma_f32_16x16x32_bf16 v[188:191], a[60:63], v[52:55], v[188:191]
ds_read_b128 a[32:35], v2 offset:0
v_cvt_pk_bf16_f32 v74, v40, v41
v_mfma_f32_16x16x32_bf16 v[156:159], a[60:63], v[48:51], v[156:159]
v_smfmac_f32_16x16x64_bf16 a[224:227], a[232:235], v[48:55], v9
v_exp_f32 v42, v42
v_smfmac_f32_16x16x64_bf16 a[228:231], a[232:235], v[56:63], v9
s_waitcnt lgkmcnt(5)
v_exp_f32 v43, v43
v_mfma_f32_16x16x32_bf16 v[16:19], a[0:3], a[160:163], v[80:83]
ds_read_b128 a[36:39], v2 offset:1024
v_cvt_pk_bf16_f32 v75, v42, v43
v_mfma_f32_16x16x32_bf16 v[16:19], a[4:7], a[164:167], v[16:19]
v_exp_f32 v44, v44
v_mfma_f32_16x16x32_bf16 v[16:19], a[8:11], a[168:171], v[16:19]
v_mfma_f32_16x16x32_bf16 v[16:19], a[12:15], a[172:175], v[16:19]
v_exp_f32 v45, v45
v_mfma_f32_16x16x32_bf16 v[20:23], a[0:3], a[176:179], v[84:87]
ds_read_b128 a[40:43], v2 offset:2048
v_cvt_pk_bf16_f32 v78, v44, v45
v_mfma_f32_16x16x32_bf16 v[20:23], a[4:7], a[180:183], v[20:23]
buffer_load_dwordx4 v3, s[48:51], s32 offen offset:2048 sc1 lds
v_mfma_f32_16x16x32_bf16 v[20:23], a[8:11], a[184:187], v[20:23]
v_exp_f32 v46, v46
v_mfma_f32_16x16x32_bf16 v[20:23], a[12:15], a[188:191], v[20:23]
ds_read_b128 a[44:47], v2 offset:3072
v_mfma_f32_16x16x32_bf16 v[24:27], a[0:3], a[192:195], v[88:91]
v_mfma_f32_16x16x32_bf16 v[24:27], a[4:7], a[196:199], v[24:27]
v_exp_f32 v47, v47
v_mfma_f32_16x16x32_bf16 v[24:27], a[8:11], a[200:203], v[24:27]
v_exp_f32 v16, v16
v_mfma_f32_16x16x32_bf16 v[24:27], a[12:15], a[204:207], v[24:27]
ds_read_b128 a[48:51], v2 offset:4096
v_cvt_pk_bf16_f32 v79, v46, v47
v_mfma_f32_16x16x32_bf16 v[28:31], a[0:3], a[208:211], v[92:95]
v_mfma_f32_16x16x32_bf16 v[28:31], a[4:7], a[212:215], v[28:31]
v_exp_f32 v17, v17
v_mfma_f32_16x16x32_bf16 v[28:31], a[8:11], a[216:219], v[28:31]
s_waitcnt lgkmcnt(5)
v_exp_f32 v18, v18
v_mfma_f32_16x16x32_bf16 v[28:31], a[12:15], a[220:223], v[28:31]
ds_read_b128 a[52:55], v2 offset:5120
v_cvt_pk_bf16_f32 v48, v16, v17
v_mfma_f32_16x16x32_bf16 v[32:35], a[16:19], a[160:163], v[80:83]
v_mfma_f32_16x16x32_bf16 v[32:35], a[20:23], a[164:167], v[32:35]
v_exp_f32 v19, v19
v_mfma_f32_16x16x32_bf16 v[32:35], a[24:27], a[168:171], v[32:35]
v_exp_f32 v20, v20
v_mfma_f32_16x16x32_bf16 v[32:35], a[28:31], a[172:175], v[32:35]
ds_read_b128 a[56:59], v2 offset:6144
v_cvt_pk_bf16_f32 v49, v18, v19
v_mfma_f32_16x16x32_bf16 v[36:39], a[16:19], a[176:179], v[84:87]
v_exp_f32 v21, v21
v_mfma_f32_16x16x32_bf16 v[36:39], a[20:23], a[180:183], v[36:39]
buffer_load_dwordx4 v3, s[48:51], s32 offen offset:3072 sc1 lds
v_mfma_f32_16x16x32_bf16 v[36:39], a[24:27], a[184:187], v[36:39]
s_add_u32 s32, s32, 0x8000
v_cvt_pk_bf16_f32 v52, v20, v21
v_mfma_f32_16x16x32_bf16 v[36:39], a[28:31], a[188:191], v[36:39]
ds_read_b128 a[60:63], v2 offset:7168
v_mfma_f32_16x16x32_bf16 v[40:43], a[16:19], a[192:195], v[88:91]
v_exp_f32 v22, v22
v_mfma_f32_16x16x32_bf16 v[40:43], a[20:23], a[196:199], v[40:43]
v_exp_f32 v23, v23
v_mfma_f32_16x16x32_bf16 v[40:43], a[24:27], a[200:203], v[40:43]
v_cvt_pk_bf16_f32 v53, v22, v23
v_mfma_f32_16x16x32_bf16 v[40:43], a[28:31], a[204:207], v[40:43]
v_exp_f32 v24, v24
v_mfma_f32_16x16x32_bf16 v[44:47], a[16:19], a[208:211], v[92:95]
v_exp_f32 v25, v25
v_mfma_f32_16x16x32_bf16 v[44:47], a[20:23], a[212:215], v[44:47]
v_exp_f32 v26, v26
v_mfma_f32_16x16x32_bf16 v[44:47], a[24:27], a[216:219], v[44:47]
v_exp_f32 v27, v27
v_mfma_f32_16x16x32_bf16 v[44:47], a[28:31], a[220:223], v[44:47]
s_waitcnt lgkmcnt(0)
v_mfma_f32_16x16x32_bf16 v[128:131], a[32:35], v[64:67], v[128:131]
ds_read_b128 a[0:3], v2 offset:24576
v_cvt_pk_bf16_f32 v56, v24, v25
v_mfma_f32_16x16x32_bf16 v[160:163], a[32:35], v[68:71], v[160:163]
v_exp_f32 v28, v28
v_mfma_f32_16x16x32_bf16 v[192:195], a[32:35], v[72:75], v[192:195]
v_cvt_pk_bf16_f32 v57, v26, v27
v_mfma_f32_16x16x32_bf16 v[224:227], a[32:35], v[76:79], v[224:227]
ds_read_b128 a[4:7], v2 offset:25600
v_mfma_f32_16x16x32_bf16 v[228:231], a[36:39], v[76:79], v[228:231]
v_exp_f32 v29, v29
v_mfma_f32_16x16x32_bf16 v[196:199], a[36:39], v[72:75], v[196:199]
v_exp_f32 v30, v30
v_mfma_f32_16x16x32_bf16 v[164:167], a[36:39], v[68:71], v[164:167]
s_add_u32 m0, s19, 0x1000
v_cvt_pk_bf16_f32 v60, v28, v29
v_mfma_f32_16x16x32_bf16 v[132:135], a[36:39], v[64:67], v[132:135]
buffer_load_dwordx4 v3, s[48:51], s7 offen offset:0 sc1 lds
v_mfma_f32_16x16x32_bf16 v[136:139], a[40:43], v[64:67], v[136:139]
ds_read_b128 a[8:11], v2 offset:26624
v_mfma_f32_16x16x32_bf16 v[168:171], a[40:43], v[68:71], v[168:171]
v_exp_f32 v31, v31
v_mfma_f32_16x16x32_bf16 v[200:203], a[40:43], v[72:75], v[200:203]
v_exp_f32 v32, v32
v_mfma_f32_16x16x32_bf16 v[232:235], a[40:43], v[76:79], v[232:235]
ds_read_b128 a[12:15], v2 offset:27648
v_cvt_pk_bf16_f32 v61, v30, v31
v_mfma_f32_16x16x32_bf16 v[236:239], a[44:47], v[76:79], v[236:239]
v_mfma_f32_16x16x32_bf16 v[204:207], a[44:47], v[72:75], v[204:207]
v_exp_f32 v33, v33
v_mfma_f32_16x16x32_bf16 v[172:175], a[44:47], v[68:71], v[172:175]
v_exp_f32 v34, v34
v_mfma_f32_16x16x32_bf16 v[140:143], a[44:47], v[64:67], v[140:143]
ds_read_b128 a[16:19], v2 offset:28672
v_cvt_pk_bf16_f32 v50, v32, v33
v_mfma_f32_16x16x32_bf16 v[144:147], a[48:51], v[64:67], v[144:147]
v_exp_f32 v35, v35
v_mfma_f32_16x16x32_bf16 v[176:179], a[48:51], v[68:71], v[176:179]
v_cvt_pk_bf16_f32 v51, v34, v35
v_mfma_f32_16x16x32_bf16 v[208:211], a[48:51], v[72:75], v[208:211]
ds_read_b128 a[20:23], v2 offset:29696
v_mfma_f32_16x16x32_bf16 v[240:243], a[48:51], v[76:79], v[240:243]
v_exp_f32 v36, v36
v_mfma_f32_16x16x32_bf16 v[244:247], a[52:55], v[76:79], v[244:247]
v_exp_f32 v37, v37
v_mfma_f32_16x16x32_bf16 v[212:215], a[52:55], v[72:75], v[212:215]
v_cvt_pk_bf16_f32 v54, v36, v37
v_mfma_f32_16x16x32_bf16 v[180:183], a[52:55], v[68:71], v[180:183]
buffer_load_dwordx4 v3, s[48:51], s7 offen offset:1024 sc1 lds
v_mfma_f32_16x16x32_bf16 v[148:151], a[52:55], v[64:67], v[148:151]
ds_read_b128 a[24:27], v2 offset:30720
v_mfma_f32_16x16x32_bf16 v[152:155], a[56:59], v[64:67], v[152:155]
v_exp_f32 v38, v38
v_mfma_f32_16x16x32_bf16 v[184:187], a[56:59], v[68:71], v[184:187]
v_exp_f32 v39, v39
v_mfma_f32_16x16x32_bf16 v[216:219], a[56:59], v[72:75], v[216:219]
ds_read_b128 a[28:31], v2 offset:31744
v_cvt_pk_bf16_f32 v55, v38, v39
v_mfma_f32_16x16x32_bf16 v[248:251], a[56:59], v[76:79], v[248:251]
v_exp_f32 v40, v40
v_mfma_f32_16x16x32_bf16 v[252:255], a[60:63], v[76:79], v[252:255]
v_mfma_f32_16x16x32_bf16 v[220:223], a[60:63], v[72:75], v[220:223]
v_exp_f32 v41, v41
v_mfma_f32_16x16x32_bf16 v[188:191], a[60:63], v[68:71], v[188:191]
ds_read_b128 a[32:35], v2 offset:16384
v_cvt_pk_bf16_f32 v58, v40, v41
v_mfma_f32_16x16x32_bf16 v[156:159], a[60:63], v[64:67], v[156:159]
v_exp_f32 v42, v42
v_smfmac_f32_16x16x64_bf16 a[224:227], a[232:235], v[64:71], v9
s_waitcnt lgkmcnt(5)
v_smfmac_f32_16x16x64_bf16 a[228:231], a[232:235], v[72:79], v9
ds_read_b128 a[36:39], v2 offset:17408
v_mfma_f32_16x16x32_bf16 v[16:19], a[0:3], a[160:163], v[80:83]
v_exp_f32 v43, v43
v_mfma_f32_16x16x32_bf16 v[16:19], a[4:7], a[164:167], v[16:19]
v_exp_f32 v44, v44
v_mfma_f32_16x16x32_bf16 v[16:19], a[8:11], a[168:171], v[16:19]
buffer_load_dwordx4 v3, s[48:51], s7 offen offset:2048 sc1 lds
v_mfma_f32_16x16x32_bf16 v[16:19], a[12:15], a[172:175], v[16:19]
ds_read_b128 a[40:43], v2 offset:18432
v_cvt_pk_bf16_f32 v59, v42, v43
v_mfma_f32_16x16x32_bf16 v[20:23], a[0:3], a[176:179], v[84:87]
v_exp_f32 v45, v45
v_mfma_f32_16x16x32_bf16 v[20:23], a[4:7], a[180:183], v[20:23]
v_cvt_pk_bf16_f32 v62, v44, v45
v_mfma_f32_16x16x32_bf16 v[20:23], a[8:11], a[184:187], v[20:23]
v_exp_f32 v46, v46
v_mfma_f32_16x16x32_bf16 v[20:23], a[12:15], a[188:191], v[20:23]
ds_read_b128 a[44:47], v2 offset:19456
v_mfma_f32_16x16x32_bf16 v[24:27], a[0:3], a[192:195], v[88:91]
v_exp_f32 v47, v47
v_mfma_f32_16x16x32_bf16 v[24:27], a[4:7], a[196:199], v[24:27]
v_cvt_pk_bf16_f32 v63, v46, v47
v_mfma_f32_16x16x32_bf16 v[24:27], a[8:11], a[200:203], v[24:27]
v_exp_f32 v16, v16
v_mfma_f32_16x16x32_bf16 v[24:27], a[12:15], a[204:207], v[24:27]
ds_read_b128 a[48:51], v2 offset:20480
v_mfma_f32_16x16x32_bf16 v[28:31], a[0:3], a[208:211], v[92:95]
v_exp_f32 v17, v17
v_mfma_f32_16x16x32_bf16 v[28:31], a[4:7], a[212:215], v[28:31]
v_exp_f32 v18, v18
v_mfma_f32_16x16x32_bf16 v[28:31], a[8:11], a[216:219], v[28:31]
ds_read_b128 a[52:55], v2 offset:21504
v_cvt_pk_bf16_f32 v64, v16, v17
v_mfma_f32_16x16x32_bf16 v[28:31], a[12:15], a[220:223], v[28:31]
s_waitcnt lgkmcnt(6)
v_mfma_f32_16x16x32_bf16 v[32:35], a[16:19], a[160:163], v[80:83]
v_exp_f32 v19, v19
v_mfma_f32_16x16x32_bf16 v[32:35], a[20:23], a[164:167], v[32:35]
buffer_load_dwordx4 v3, s[48:51], s7 offen offset:3072 sc1 lds
v_mfma_f32_16x16x32_bf16 v[32:35], a[24:27], a[168:171], v[32:35]
ds_read_b128 a[56:59], v2 offset:22528
v_cvt_pk_bf16_f32 v65, v18, v19
v_mfma_f32_16x16x32_bf16 v[32:35], a[28:31], a[172:175], v[32:35]
s_add_u32 s7, s7, 0x8000
v_exp_f32 v20, v20
v_mfma_f32_16x16x32_bf16 v[36:39], a[16:19], a[176:179], v[84:87]
s_xor_b32 s19, s19, 0x8000
v_mfma_f32_16x16x32_bf16 v[36:39], a[20:23], a[180:183], v[36:39]
s_sub_u32 s15, s15, 1
v_exp_f32 v21, v21
v_mfma_f32_16x16x32_bf16 v[36:39], a[24:27], a[184:187], v[36:39]
ds_read_b128 a[60:63], v2 offset:23552
v_xor_b32 v2, 0x38000, v2
v_mfma_f32_16x16x32_bf16 v[36:39], a[28:31], a[188:191], v[36:39]
s_cmp_lg_u32 s15, 0
v_exp_f32 v22, v22
v_mfma_f32_16x16x32_bf16 v[40:43], a[16:19], a[192:195], v[88:91]
v_exp_f32 v23, v23
v_mfma_f32_16x16x32_bf16 v[40:43], a[20:23], a[196:199], v[40:43]
v_cvt_pk_bf16_f32 v68, v20, v21
v_cvt_pk_bf16_f32 v69, v22, v23
v_mfma_f32_16x16x32_bf16 v[40:43], a[24:27], a[200:203], v[40:43]
v_exp_f32 v24, v24
v_mfma_f32_16x16x32_bf16 v[40:43], a[28:31], a[204:207], v[40:43]
v_exp_f32 v25, v25
v_mfma_f32_16x16x32_bf16 v[44:47], a[16:19], a[208:211], v[92:95]
v_exp_f32 v26, v26
v_mfma_f32_16x16x32_bf16 v[44:47], a[20:23], a[212:215], v[44:47]
v_exp_f32 v27, v27
v_mfma_f32_16x16x32_bf16 v[44:47], a[24:27], a[216:219], v[44:47]
s_waitcnt vmcnt(16) lgkmcnt(0)
v_mfma_f32_16x16x32_bf16 v[44:47], a[28:31], a[220:223], v[44:47]
s_barrier
s_cbranch_scc1 L_att_deven0
s_branch L_att_ddone
L_att_deven1:
v_mfma_f32_16x16x32_bf16 v[128:131], a[32:35], v[48:51], v[128:131]
ds_read_b128 a[0:3], v1 offset:8192
v_cvt_pk_bf16_f32 v72, v24, v25
v_mfma_f32_16x16x32_bf16 v[160:163], a[32:35], v[52:55], v[160:163]
v_exp_f32 v28, v28
v_mfma_f32_16x16x32_bf16 v[192:195], a[32:35], v[56:59], v[192:195]
v_cvt_pk_bf16_f32 v73, v26, v27
v_mfma_f32_16x16x32_bf16 v[224:227], a[32:35], v[60:63], v[224:227]
ds_read_b128 a[4:7], v1 offset:9216
v_mfma_f32_16x16x32_bf16 v[228:231], a[36:39], v[60:63], v[228:231]
v_exp_f32 v29, v29
v_mfma_f32_16x16x32_bf16 v[196:199], a[36:39], v[56:59], v[196:199]
v_exp_f32 v30, v30
v_mfma_f32_16x16x32_bf16 v[164:167], a[36:39], v[52:55], v[164:167]
s_add_u32 m0, s27, 0x0
v_cvt_pk_bf16_f32 v76, v28, v29
v_mfma_f32_16x16x32_bf16 v[132:135], a[36:39], v[48:51], v[132:135]
buffer_load_dwordx4 v3, s[48:51], s32 offen offset:0 sc1 lds
v_mfma_f32_16x16x32_bf16 v[136:139], a[40:43], v[48:51], v[136:139]
ds_read_b128 a[8:11], v1 offset:10240
v_mfma_f32_16x16x32_bf16 v[168:171], a[40:43], v[52:55], v[168:171]
v_exp_f32 v31, v31
v_mfma_f32_16x16x32_bf16 v[200:203], a[40:43], v[56:59], v[200:203]
v_exp_f32 v32, v32
v_mfma_f32_16x16x32_bf16 v[232:235], a[40:43], v[60:63], v[232:235]
ds_read_b128 a[12:15], v1 offset:11264
v_cvt_pk_bf16_f32 v77, v30, v31
v_mfma_f32_16x16x32_bf16 v[236:239], a[44:47], v[60:63], v[236:239]
v_mfma_f32_16x16x32_bf16 v[204:207], a[44:47], v[56:59], v[204:207]
v_exp_f32 v33, v33
v_mfma_f32_16x16x32_bf16 v[172:175], a[44:47], v[52:55], v[172:175]
v_exp_f32 v34, v34
v_mfma_f32_16x16x32_bf16 v[140:143], a[44:47], v[48:51], v[140:143]
ds_read_b128 a[16:19], v1 offset:12288
v_cvt_pk_bf16_f32 v66, v32, v33
v_mfma_f32_16x16x32_bf16 v[144:147], a[48:51], v[48:51], v[144:147]
v_mfma_f32_16x16x32_bf16 v[176:179], a[48:51], v[52:55], v[176:179]
v_exp_f32 v35, v35
v_mfma_f32_16x16x32_bf16 v[208:211], a[48:51], v[56:59], v[208:211]
v_exp_f32 v36, v36
v_mfma_f32_16x16x32_bf16 v[240:243], a[48:51], v[60:63], v[240:243]
ds_read_b128 a[20:23], v1 offset:13312
v_cvt_pk_bf16_f32 v67, v34, v35
v_mfma_f32_16x16x32_bf16 v[244:247], a[52:55], v[60:63], v[244:247]
v_exp_f32 v37, v37
v_mfma_f32_16x16x32_bf16 v[212:215], a[52:55], v[56:59], v[212:215]
v_cvt_pk_bf16_f32 v70, v36, v37
v_mfma_f32_16x16x32_bf16 v[180:183], a[52:55], v[52:55], v[180:183]
ds_read_b128 a[24:27], v1 offset:14336
v_mfma_f32_16x16x32_bf16 v[148:151], a[52:55], v[48:51], v[148:151]
buffer_load_dwordx4 v3, s[48:51], s32 offen offset:1024 sc1 lds
v_mfma_f32_16x16x32_bf16 v[152:155], a[56:59], v[48:51], v[152:155]
v_exp_f32 v38, v38
v_mfma_f32_16x16x32_bf16 v[184:187], a[56:59], v[52:55], v[184:187]
v_exp_f32 v39, v39
v_mfma_f32_16x16x32_bf16 v[216:219], a[56:59], v[56:59], v[216:219]
ds_read_b128 a[28:31], v1 offset:15360
v_cvt_pk_bf16_f32 v71, v38, v39
v_mfma_f32_16x16x32_bf16 v[248:251], a[56:59], v[60:63], v[248:251]
v_mfma_f32_16x16x32_bf16 v[252:255], a[60:63], v[60:63], v[252:255]
v_exp_f32 v40, v40
v_mfma_f32_16x16x32_bf16 v[220:223], a[60:63], v[56:59], v[220:223]
v_exp_f32 v41, v41
v_mfma_f32_16x16x32_bf16 v[188:191], a[60:63], v[52:55], v[188:191]
ds_read_b128 a[32:35], v1 offset:0
v_cvt_pk_bf16_f32 v74, v40, v41
v_mfma_f32_16x16x32_bf16 v[156:159], a[60:63], v[48:51], v[156:159]
v_smfmac_f32_16x16x64_bf16 a[224:227], a[232:235], v[48:55], v9
v_exp_f32 v42, v42
v_smfmac_f32_16x16x64_bf16 a[228:231], a[232:235], v[56:63], v9
s_waitcnt lgkmcnt(5)
v_exp_f32 v43, v43
v_mfma_f32_16x16x32_bf16 v[16:19], a[0:3], a[160:163], v[80:83]
ds_read_b128 a[36:39], v1 offset:1024
v_cvt_pk_bf16_f32 v75, v42, v43
v_mfma_f32_16x16x32_bf16 v[16:19], a[4:7], a[164:167], v[16:19]
v_exp_f32 v44, v44
v_mfma_f32_16x16x32_bf16 v[16:19], a[8:11], a[168:171], v[16:19]
v_mfma_f32_16x16x32_bf16 v[16:19], a[12:15], a[172:175], v[16:19]
v_exp_f32 v45, v45
v_mfma_f32_16x16x32_bf16 v[20:23], a[0:3], a[176:179], v[84:87]
ds_read_b128 a[40:43], v1 offset:2048
v_cvt_pk_bf16_f32 v78, v44, v45
v_mfma_f32_16x16x32_bf16 v[20:23], a[4:7], a[180:183], v[20:23]
buffer_load_dwordx4 v3, s[48:51], s32 offen offset:2048 sc1 lds
v_mfma_f32_16x16x32_bf16 v[20:23], a[8:11], a[184:187], v[20:23]
v_exp_f32 v46, v46
v_mfma_f32_16x16x32_bf16 v[20:23], a[12:15], a[188:191], v[20:23]
ds_read_b128 a[44:47], v1 offset:3072
v_mfma_f32_16x16x32_bf16 v[24:27], a[0:3], a[192:195], v[88:91]
v_mfma_f32_16x16x32_bf16 v[24:27], a[4:7], a[196:199], v[24:27]
v_exp_f32 v47, v47
v_mfma_f32_16x16x32_bf16 v[24:27], a[8:11], a[200:203], v[24:27]
v_exp_f32 v16, v16
v_mfma_f32_16x16x32_bf16 v[24:27], a[12:15], a[204:207], v[24:27]
ds_read_b128 a[48:51], v1 offset:4096
v_cvt_pk_bf16_f32 v79, v46, v47
v_mfma_f32_16x16x32_bf16 v[28:31], a[0:3], a[208:211], v[92:95]
v_mfma_f32_16x16x32_bf16 v[28:31], a[4:7], a[212:215], v[28:31]
v_exp_f32 v17, v17
v_mfma_f32_16x16x32_bf16 v[28:31], a[8:11], a[216:219], v[28:31]
s_waitcnt lgkmcnt(5)
v_exp_f32 v18, v18
v_mfma_f32_16x16x32_bf16 v[28:31], a[12:15], a[220:223], v[28:31]
ds_read_b128 a[52:55], v1 offset:5120
v_cvt_pk_bf16_f32 v48, v16, v17
v_mfma_f32_16x16x32_bf16 v[32:35], a[16:19], a[160:163], v[80:83]
v_mfma_f32_16x16x32_bf16 v[32:35], a[20:23], a[164:167], v[32:35]
v_exp_f32 v19, v19
v_mfma_f32_16x16x32_bf16 v[32:35], a[24:27], a[168:171], v[32:35]
v_exp_f32 v20, v20
v_mfma_f32_16x16x32_bf16 v[32:35], a[28:31], a[172:175], v[32:35]
ds_read_b128 a[56:59], v1 offset:6144
v_cvt_pk_bf16_f32 v49, v18, v19
v_mfma_f32_16x16x32_bf16 v[36:39], a[16:19], a[176:179], v[84:87]
v_exp_f32 v21, v21
v_mfma_f32_16x16x32_bf16 v[36:39], a[20:23], a[180:183], v[36:39]
buffer_load_dwordx4 v3, s[48:51], s32 offen offset:3072 sc1 lds
v_mfma_f32_16x16x32_bf16 v[36:39], a[24:27], a[184:187], v[36:39]
s_add_u32 s32, s32, 0x8000
v_cvt_pk_bf16_f32 v52, v20, v21
v_mfma_f32_16x16x32_bf16 v[36:39], a[28:31], a[188:191], v[36:39]
ds_read_b128 a[60:63], v1 offset:7168
v_mfma_f32_16x16x32_bf16 v[40:43], a[16:19], a[192:195], v[88:91]
v_exp_f32 v22, v22
v_mfma_f32_16x16x32_bf16 v[40:43], a[20:23], a[196:199], v[40:43]
v_exp_f32 v23, v23
v_mfma_f32_16x16x32_bf16 v[40:43], a[24:27], a[200:203], v[40:43]
v_cvt_pk_bf16_f32 v53, v22, v23
v_mfma_f32_16x16x32_bf16 v[40:43], a[28:31], a[204:207], v[40:43]
v_exp_f32 v24, v24
v_mfma_f32_16x16x32_bf16 v[44:47], a[16:19], a[208:211], v[92:95]
v_exp_f32 v25, v25
v_mfma_f32_16x16x32_bf16 v[44:47], a[20:23], a[212:215], v[44:47]
v_exp_f32 v26, v26
v_mfma_f32_16x16x32_bf16 v[44:47], a[24:27], a[216:219], v[44:47]
v_exp_f32 v27, v27
v_mfma_f32_16x16x32_bf16 v[44:47], a[28:31], a[220:223], v[44:47]
s_waitcnt lgkmcnt(0)
v_mfma_f32_16x16x32_bf16 v[128:131], a[32:35], v[64:67], v[128:131]
ds_read_b128 a[0:3], v1 offset:24576
v_cvt_pk_bf16_f32 v56, v24, v25
v_mfma_f32_16x16x32_bf16 v[160:163], a[32:35], v[68:71], v[160:163]
v_exp_f32 v28, v28
v_mfma_f32_16x16x32_bf16 v[192:195], a[32:35], v[72:75], v[192:195]
v_cvt_pk_bf16_f32 v57, v26, v27
v_mfma_f32_16x16x32_bf16 v[224:227], a[32:35], v[76:79], v[224:227]
ds_read_b128 a[4:7], v1 offset:25600
v_mfma_f32_16x16x32_bf16 v[228:231], a[36:39], v[76:79], v[228:231]
v_exp_f32 v29, v29
v_mfma_f32_16x16x32_bf16 v[196:199], a[36:39], v[72:75], v[196:199]
v_exp_f32 v30, v30
v_mfma_f32_16x16x32_bf16 v[164:167], a[36:39], v[68:71], v[164:167]
s_add_u32 m0, s27, 0x1000
v_cvt_pk_bf16_f32 v60, v28, v29
v_mfma_f32_16x16x32_bf16 v[132:135], a[36:39], v[64:67], v[132:135]
buffer_load_dwordx4 v3, s[48:51], s7 offen offset:0 sc1 lds
v_mfma_f32_16x16x32_bf16 v[136:139], a[40:43], v[64:67], v[136:139]
ds_read_b128 a[8:11], v1 offset:26624
v_mfma_f32_16x16x32_bf16 v[168:171], a[40:43], v[68:71], v[168:171]
v_exp_f32 v31, v31
v_mfma_f32_16x16x32_bf16 v[200:203], a[40:43], v[72:75], v[200:203]
v_exp_f32 v32, v32
v_mfma_f32_16x16x32_bf16 v[232:235], a[40:43], v[76:79], v[232:235]
ds_read_b128 a[12:15], v1 offset:27648
v_cvt_pk_bf16_f32 v61, v30, v31
v_mfma_f32_16x16x32_bf16 v[236:239], a[44:47], v[76:79], v[236:239]
v_mfma_f32_16x16x32_bf16 v[204:207], a[44:47], v[72:75], v[204:207]
v_exp_f32 v33, v33
v_mfma_f32_16x16x32_bf16 v[172:175], a[44:47], v[68:71], v[172:175]
v_exp_f32 v34, v34
v_mfma_f32_16x16x32_bf16 v[140:143], a[44:47], v[64:67], v[140:143]
ds_read_b128 a[16:19], v1 offset:28672
v_cvt_pk_bf16_f32 v50, v32, v33
v_mfma_f32_16x16x32_bf16 v[144:147], a[48:51], v[64:67], v[144:147]
v_mfma_f32_16x16x32_bf16 v[176:179], a[48:51], v[68:71], v[176:179]
v_exp_f32 v35, v35
v_mfma_f32_16x16x32_bf16 v[208:211], a[48:51], v[72:75], v[208:211]
ds_read_b128 a[20:23], v1 offset:29696
v_cvt_pk_bf16_f32 v51, v34, v35
v_mfma_f32_16x16x32_bf16 v[240:243], a[48:51], v[76:79], v[240:243]
v_exp_f32 v36, v36
v_mfma_f32_16x16x32_bf16 v[244:247], a[52:55], v[76:79], v[244:247]
v_exp_f32 v37, v37
v_mfma_f32_16x16x32_bf16 v[212:215], a[52:55], v[72:75], v[212:215]
v_cvt_pk_bf16_f32 v54, v36, v37
v_mfma_f32_16x16x32_bf16 v[180:183], a[52:55], v[68:71], v[180:183]
buffer_load_dwordx4 v3, s[48:51], s7 offen offset:1024 sc1 lds
v_mfma_f32_16x16x32_bf16 v[148:151], a[52:55], v[64:67], v[148:151]
ds_read_b128 a[24:27], v1 offset:30720
v_mfma_f32_16x16x32_bf16 v[152:155], a[56:59], v[64:67], v[152:155]
v_exp_f32 v38, v38
v_mfma_f32_16x16x32_bf16 v[184:187], a[56:59], v[68:71], v[184:187]
v_exp_f32 v39, v39
v_mfma_f32_16x16x32_bf16 v[216:219], a[56:59], v[72:75], v[216:219]
ds_read_b128 a[28:31], v1 offset:31744
v_cvt_pk_bf16_f32 v55, v38, v39
v_mfma_f32_16x16x32_bf16 v[248:251], a[56:59], v[76:79], v[248:251]
v_mfma_f32_16x16x32_bf16 v[252:255], a[60:63], v[76:79], v[252:255]
v_exp_f32 v40, v40
v_mfma_f32_16x16x32_bf16 v[220:223], a[60:63], v[72:75], v[220:223]
v_exp_f32 v41, v41
v_mfma_f32_16x16x32_bf16 v[188:191], a[60:63], v[68:71], v[188:191]
ds_read_b128 a[32:35], v1 offset:16384
v_cvt_pk_bf16_f32 v58, v40, v41
v_mfma_f32_16x16x32_bf16 v[156:159], a[60:63], v[64:67], v[156:159]
v_smfmac_f32_16x16x64_bf16 a[224:227], a[232:235], v[64:71], v9
s_waitcnt lgkmcnt(5)
v_exp_f32 v42, v42
v_smfmac_f32_16x16x64_bf16 a[228:231], a[232:235], v[72:79], v9
ds_read_b128 a[36:39], v1 offset:17408
v_mfma_f32_16x16x32_bf16 v[16:19], a[0:3], a[160:163], v[80:83]
v_exp_f32 v43, v43
v_mfma_f32_16x16x32_bf16 v[16:19], a[4:7], a[164:167], v[16:19]
v_exp_f32 v44, v44
v_mfma_f32_16x16x32_bf16 v[16:19], a[8:11], a[168:171], v[16:19]
v_cvt_pk_bf16_f32 v59, v42, v43
v_mfma_f32_16x16x32_bf16 v[16:19], a[12:15], a[172:175], v[16:19]
ds_read_b128 a[40:43], v1 offset:18432
v_mfma_f32_16x16x32_bf16 v[20:23], a[0:3], a[176:179], v[84:87]
buffer_load_dwordx4 v3, s[48:51], s7 offen offset:2048 sc1 lds
v_mfma_f32_16x16x32_bf16 v[20:23], a[4:7], a[180:183], v[20:23]
v_exp_f32 v45, v45
v_mfma_f32_16x16x32_bf16 v[20:23], a[8:11], a[184:187], v[20:23]
v_exp_f32 v46, v46
v_mfma_f32_16x16x32_bf16 v[20:23], a[12:15], a[188:191], v[20:23]
ds_read_b128 a[44:47], v1 offset:19456
v_cvt_pk_bf16_f32 v62, v44, v45
v_mfma_f32_16x16x32_bf16 v[24:27], a[0:3], a[192:195], v[88:91]
v_mfma_f32_16x16x32_bf16 v[24:27], a[4:7], a[196:199], v[24:27]
v_exp_f32 v47, v47
v_mfma_f32_16x16x32_bf16 v[24:27], a[8:11], a[200:203], v[24:27]
v_exp_f32 v16, v16
v_mfma_f32_16x16x32_bf16 v[24:27], a[12:15], a[204:207], v[24:27]
ds_read_b128 a[48:51], v1 offset:20480
v_cvt_pk_bf16_f32 v63, v46, v47
v_mfma_f32_16x16x32_bf16 v[28:31], a[0:3], a[208:211], v[92:95]
v_mfma_f32_16x16x32_bf16 v[28:31], a[4:7], a[212:215], v[28:31]
v_exp_f32 v17, v17
v_mfma_f32_16x16x32_bf16 v[28:31], a[8:11], a[216:219], v[28:31]
ds_read_b128 a[52:55], v1 offset:21504
v_cvt_pk_bf16_f32 v64, v16, v17
v_mfma_f32_16x16x32_bf16 v[28:31], a[12:15], a[220:223], v[28:31]
s_waitcnt lgkmcnt(6)
v_exp_f32 v18, v18
v_mfma_f32_16x16x32_bf16 v[32:35], a[16:19], a[160:163], v[80:83]
v_mfma_f32_16x16x32_bf16 v[32:35], a[20:23], a[164:167], v[32:35]
v_exp_f32 v19, v19
v_mfma_f32_16x16x32_bf16 v[32:35], a[24:27], a[168:171], v[32:35]
ds_read_b128 a[56:59], v1 offset:22528
v_cvt_pk_bf16_f32 v65, v18, v19
v_mfma_f32_16x16x32_bf16 v[32:35], a[28:31], a[172:175], v[32:35]
buffer_load_dwordx4 v3, s[48:51], s7 offen offset:3072 sc1 lds
v_mfma_f32_16x16x32_bf16 v[36:39], a[16:19], a[176:179], v[84:87]
s_add_u32 s7, s7, 0x8000
v_exp_f32 v20, v20
v_mfma_f32_16x16x32_bf16 v[36:39], a[20:23], a[180:183], v[36:39]
s_xor_b32 s27, s27, 0x38000
v_exp_f32 v21, v21
v_mfma_f32_16x16x32_bf16 v[36:39], a[24:27], a[184:187], v[36:39]
ds_read_b128 a[60:63], v1 offset:23552
v_xor_b32 v1, 0x8000, v1
v_mfma_f32_16x16x32_bf16 v[36:39], a[28:31], a[188:191], v[36:39]
v_cvt_pk_bf16_f32 v68, v20, v21
v_mfma_f32_16x16x32_bf16 v[40:43], a[16:19], a[192:195], v[88:91]
v_exp_f32 v22, v22
v_mfma_f32_16x16x32_bf16 v[40:43], a[20:23], a[196:199], v[40:43]
v_exp_f32 v23, v23
v_mfma_f32_16x16x32_bf16 v[40:43], a[24:27], a[200:203], v[40:43]
v_cvt_pk_bf16_f32 v69, v22, v23
v_mfma_f32_16x16x32_bf16 v[40:43], a[28:31], a[204:207], v[40:43]
v_exp_f32 v24, v24
v_mfma_f32_16x16x32_bf16 v[44:47], a[16:19], a[208:211], v[92:95]
s_waitcnt vmcnt(16) lgkmcnt(0)
v_exp_f32 v25, v25
v_mfma_f32_16x16x32_bf16 v[44:47], a[20:23], a[212:215], v[44:47]
s_barrier
v_exp_f32 v26, v26
v_mfma_f32_16x16x32_bf16 v[44:47], a[24:27], a[216:219], v[44:47]
v_exp_f32 v27, v27
v_mfma_f32_16x16x32_bf16 v[44:47], a[28:31], a[220:223], v[44:47]
L_att_dodd1:
v_mfma_f32_16x16x32_bf16 v[128:131], a[32:35], v[48:51], v[128:131]
ds_read_b128 a[0:3], v2 offset:8192
v_cvt_pk_bf16_f32 v72, v24, v25
v_mfma_f32_16x16x32_bf16 v[160:163], a[32:35], v[52:55], v[160:163]
v_exp_f32 v28, v28
v_mfma_f32_16x16x32_bf16 v[192:195], a[32:35], v[56:59], v[192:195]
v_cvt_pk_bf16_f32 v73, v26, v27
v_mfma_f32_16x16x32_bf16 v[224:227], a[32:35], v[60:63], v[224:227]
ds_read_b128 a[4:7], v2 offset:9216
v_mfma_f32_16x16x32_bf16 v[228:231], a[36:39], v[60:63], v[228:231]
v_exp_f32 v29, v29
v_mfma_f32_16x16x32_bf16 v[196:199], a[36:39], v[56:59], v[196:199]
v_exp_f32 v30, v30
v_mfma_f32_16x16x32_bf16 v[164:167], a[36:39], v[52:55], v[164:167]
s_add_u32 m0, s19, 0x0
v_cvt_pk_bf16_f32 v76, v28, v29
v_mfma_f32_16x16x32_bf16 v[132:135], a[36:39], v[48:51], v[132:135]
buffer_load_dwordx4 v3, s[48:51], s32 offen offset:0 sc1 lds
v_mfma_f32_16x16x32_bf16 v[136:139], a[40:43], v[48:51], v[136:139]
ds_read_b128 a[8:11], v2 offset:10240
v_mfma_f32_16x16x32_bf16 v[168:171], a[40:43], v[52:55], v[168:171]
v_exp_f32 v31, v31
v_mfma_f32_16x16x32_bf16 v[200:203], a[40:43], v[56:59], v[200:203]
v_exp_f32 v32, v32
v_mfma_f32_16x16x32_bf16 v[232:235], a[40:43], v[60:63], v[232:235]
ds_read_b128 a[12:15], v2 offset:11264
v_cvt_pk_bf16_f32 v77, v30, v31
v_mfma_f32_16x16x32_bf16 v[236:239], a[44:47], v[60:63], v[236:239]
v_mfma_f32_16x16x32_bf16 v[204:207], a[44:47], v[56:59], v[204:207]
v_exp_f32 v33, v33
v_mfma_f32_16x16x32_bf16 v[172:175], a[44:47], v[52:55], v[172:175]
v_exp_f32 v34, v34
v_mfma_f32_16x16x32_bf16 v[140:143], a[44:47], v[48:51], v[140:143]
ds_read_b128 a[16:19], v2 offset:12288
v_cvt_pk_bf16_f32 v66, v32, v33
v_mfma_f32_16x16x32_bf16 v[144:147], a[48:51], v[48:51], v[144:147]
v_mfma_f32_16x16x32_bf16 v[176:179], a[48:51], v[52:55], v[176:179]
v_exp_f32 v35, v35
v_mfma_f32_16x16x32_bf16 v[208:211], a[48:51], v[56:59], v[208:211]
v_exp_f32 v36, v36
v_mfma_f32_16x16x32_bf16 v[240:243], a[48:51], v[60:63], v[240:243]
ds_read_b128 a[20:23], v2 offset:13312
v_cvt_pk_bf16_f32 v67, v34, v35
v_mfma_f32_16x16x32_bf16 v[244:247], a[52:55], v[60:63], v[244:247]
v_exp_f32 v37, v37
v_mfma_f32_16x16x32_bf16 v[212:215], a[52:55], v[56:59], v[212:215]
v_cvt_pk_bf16_f32 v70, v36, v37
v_mfma_f32_16x16x32_bf16 v[180:183], a[52:55], v[52:55], v[180:183]
ds_read_b128 a[24:27], v2 offset:14336
v_mfma_f32_16x16x32_bf16 v[148:151], a[52:55], v[48:51], v[148:151]
buffer_load_dwordx4 v3, s[48:51], s32 offen offset:1024 sc1 lds
v_mfma_f32_16x16x32_bf16 v[152:155], a[56:59], v[48:51], v[152:155]
v_exp_f32 v38, v38
v_mfma_f32_16x16x32_bf16 v[184:187], a[56:59], v[52:55], v[184:187]
v_exp_f32 v39, v39
v_mfma_f32_16x16x32_bf16 v[216:219], a[56:59], v[56:59], v[216:219]
ds_read_b128 a[28:31], v2 offset:15360
v_cvt_pk_bf16_f32 v71, v38, v39
v_mfma_f32_16x16x32_bf16 v[248:251], a[56:59], v[60:63], v[248:251]
v_mfma_f32_16x16x32_bf16 v[252:255], a[60:63], v[60:63], v[252:255]
v_exp_f32 v40, v40
v_mfma_f32_16x16x32_bf16 v[220:223], a[60:63], v[56:59], v[220:223]
v_exp_f32 v41, v41
v_mfma_f32_16x16x32_bf16 v[188:191], a[60:63], v[52:55], v[188:191]
ds_read_b128 a[32:35], v2 offset:0
v_cvt_pk_bf16_f32 v74, v40, v41
v_mfma_f32_16x16x32_bf16 v[156:159], a[60:63], v[48:51], v[156:159]
v_smfmac_f32_16x16x64_bf16 a[224:227], a[232:235], v[48:55], v9
v_exp_f32 v42, v42
v_smfmac_f32_16x16x64_bf16 a[228:231], a[232:235], v[56:63], v9
s_waitcnt lgkmcnt(5)
v_exp_f32 v43, v43
v_mfma_f32_16x16x32_bf16 v[16:19], a[0:3], a[160:163], v[80:83]
ds_read_b128 a[36:39], v2 offset:1024
v_cvt_pk_bf16_f32 v75, v42, v43
v_mfma_f32_16x16x32_bf16 v[16:19], a[4:7], a[164:167], v[16:19]
v_exp_f32 v44, v44
v_mfma_f32_16x16x32_bf16 v[16:19], a[8:11], a[168:171], v[16:19]
v_mfma_f32_16x16x32_bf16 v[16:19], a[12:15], a[172:175], v[16:19]
v_exp_f32 v45, v45
v_mfma_f32_16x16x32_bf16 v[20:23], a[0:3], a[176:179], v[84:87]
ds_read_b128 a[40:43], v2 offset:2048
v_cvt_pk_bf16_f32 v78, v44, v45
v_mfma_f32_16x16x32_bf16 v[20:23], a[4:7], a[180:183], v[20:23]
buffer_load_dwordx4 v3, s[48:51], s32 offen offset:2048 sc1 lds
v_mfma_f32_16x16x32_bf16 v[20:23], a[8:11], a[184:187], v[20:23]
v_exp_f32 v46, v46
v_mfma_f32_16x16x32_bf16 v[20:23], a[12:15], a[188:191], v[20:23]
ds_read_b128 a[44:47], v2 offset:3072
v_mfma_f32_16x16x32_bf16 v[24:27], a[0:3], a[192:195], v[88:91]
v_mfma_f32_16x16x32_bf16 v[24:27], a[4:7], a[196:199], v[24:27]
v_exp_f32 v47, v47
v_mfma_f32_16x16x32_bf16 v[24:27], a[8:11], a[200:203], v[24:27]
v_exp_f32 v16, v16
v_mfma_f32_16x16x32_bf16 v[24:27], a[12:15], a[204:207], v[24:27]
ds_read_b128 a[48:51], v2 offset:4096
v_cvt_pk_bf16_f32 v79, v46, v47
v_mfma_f32_16x16x32_bf16 v[28:31], a[0:3], a[208:211], v[92:95]
v_mfma_f32_16x16x32_bf16 v[28:31], a[4:7], a[212:215], v[28:31]
v_exp_f32 v17, v17
v_mfma_f32_16x16x32_bf16 v[28:31], a[8:11], a[216:219], v[28:31]
s_waitcnt lgkmcnt(5)
v_exp_f32 v18, v18
v_mfma_f32_16x16x32_bf16 v[28:31], a[12:15], a[220:223], v[28:31]
ds_read_b128 a[52:55], v2 offset:5120
v_cvt_pk_bf16_f32 v48, v16, v17
v_mfma_f32_16x16x32_bf16 v[32:35], a[16:19], a[160:163], v[80:83]
v_mfma_f32_16x16x32_bf16 v[32:35], a[20:23], a[164:167], v[32:35]
v_exp_f32 v19, v19
v_mfma_f32_16x16x32_bf16 v[32:35], a[24:27], a[168:171], v[32:35]
v_exp_f32 v20, v20
v_mfma_f32_16x16x32_bf16 v[32:35], a[28:31], a[172:175], v[32:35]
ds_read_b128 a[56:59], v2 offset:6144
v_cvt_pk_bf16_f32 v49, v18, v19
v_mfma_f32_16x16x32_bf16 v[36:39], a[16:19], a[176:179], v[84:87]
v_exp_f32 v21, v21
v_mfma_f32_16x16x32_bf16 v[36:39], a[20:23], a[180:183], v[36:39]
buffer_load_dwordx4 v3, s[48:51], s32 offen offset:3072 sc1 lds
v_mfma_f32_16x16x32_bf16 v[36:39], a[24:27], a[184:187], v[36:39]
s_add_u32 s32, s32, 0x8000
v_cvt_pk_bf16_f32 v52, v20, v21
v_mfma_f32_16x16x32_bf16 v[36:39], a[28:31], a[188:191], v[36:39]
ds_read_b128 a[60:63], v2 offset:7168
v_mfma_f32_16x16x32_bf16 v[40:43], a[16:19], a[192:195], v[88:91]
v_exp_f32 v22, v22
v_mfma_f32_16x16x32_bf16 v[40:43], a[20:23], a[196:199], v[40:43]
v_exp_f32 v23, v23
v_mfma_f32_16x16x32_bf16 v[40:43], a[24:27], a[200:203], v[40:43]
v_cvt_pk_bf16_f32 v53, v22, v23
v_mfma_f32_16x16x32_bf16 v[40:43], a[28:31], a[204:207], v[40:43]
v_exp_f32 v24, v24
v_mfma_f32_16x16x32_bf16 v[44:47], a[16:19], a[208:211], v[92:95]
v_exp_f32 v25, v25
v_mfma_f32_16x16x32_bf16 v[44:47], a[20:23], a[212:215], v[44:47]
v_exp_f32 v26, v26
v_mfma_f32_16x16x32_bf16 v[44:47], a[24:27], a[216:219], v[44:47]
v_exp_f32 v27, v27
v_mfma_f32_16x16x32_bf16 v[44:47], a[28:31], a[220:223], v[44:47]
s_waitcnt lgkmcnt(0)
v_mfma_f32_16x16x32_bf16 v[128:131], a[32:35], v[64:67], v[128:131]
ds_read_b128 a[0:3], v2 offset:24576
v_cvt_pk_bf16_f32 v56, v24, v25
v_mfma_f32_16x16x32_bf16 v[160:163], a[32:35], v[68:71], v[160:163]
v_exp_f32 v28, v28
v_mfma_f32_16x16x32_bf16 v[192:195], a[32:35], v[72:75], v[192:195]
v_cvt_pk_bf16_f32 v57, v26, v27
v_mfma_f32_16x16x32_bf16 v[224:227], a[32:35], v[76:79], v[224:227]
ds_read_b128 a[4:7], v2 offset:25600
v_mfma_f32_16x16x32_bf16 v[228:231], a[36:39], v[76:79], v[228:231]
v_exp_f32 v29, v29
v_mfma_f32_16x16x32_bf16 v[196:199], a[36:39], v[72:75], v[196:199]
v_exp_f32 v30, v30
v_mfma_f32_16x16x32_bf16 v[164:167], a[36:39], v[68:71], v[164:167]
s_add_u32 m0, s19, 0x1000
v_cvt_pk_bf16_f32 v60, v28, v29
v_mfma_f32_16x16x32_bf16 v[132:135], a[36:39], v[64:67], v[132:135]
buffer_load_dwordx4 v3, s[48:51], s7 offen offset:0 sc1 lds
v_mfma_f32_16x16x32_bf16 v[136:139], a[40:43], v[64:67], v[136:139]
ds_read_b128 a[8:11], v2 offset:26624
v_mfma_f32_16x16x32_bf16 v[168:171], a[40:43], v[68:71], v[168:171]
v_exp_f32 v31, v31
v_mfma_f32_16x16x32_bf16 v[200:203], a[40:43], v[72:75], v[200:203]
v_exp_f32 v32, v32
v_mfma_f32_16x16x32_bf16 v[232:235], a[40:43], v[76:79], v[232:235]
ds_read_b128 a[12:15], v2 offset:27648
v_cvt_pk_bf16_f32 v61, v30, v31
v_mfma_f32_16x16x32_bf16 v[236:239], a[44:47], v[76:79], v[236:239]
v_mfma_f32_16x16x32_bf16 v[204:207], a[44:47], v[72:75], v[204:207]
v_exp_f32 v33, v33
v_mfma_f32_16x16x32_bf16 v[172:175], a[44:47], v[68:71], v[172:175]
v_exp_f32 v34, v34
v_mfma_f32_16x16x32_bf16 v[140:143], a[44:47], v[64:67], v[140:143]
ds_read_b128 a[16:19], v2 offset:28672
v_cvt_pk_bf16_f32 v50, v32, v33
v_mfma_f32_16x16x32_bf16 v[144:147], a[48:51], v[64:67], v[144:147]
v_exp_f32 v35, v35
v_mfma_f32_16x16x32_bf16 v[176:179], a[48:51], v[68:71], v[176:179]
v_cvt_pk_bf16_f32 v51, v34, v35
v_mfma_f32_16x16x32_bf16 v[208:211], a[48:51], v[72:75], v[208:211]
ds_read_b128 a[20:23], v2 offset:29696
v_mfma_f32_16x16x32_bf16 v[240:243], a[48:51], v[76:79], v[240:243]
v_exp_f32 v36, v36
v_mfma_f32_16x16x32_bf16 v[244:247], a[52:55], v[76:79], v[244:247]
v_exp_f32 v37, v37
v_mfma_f32_16x16x32_bf16 v[212:215], a[52:55], v[72:75], v[212:215]
v_cvt_pk_bf16_f32 v54, v36, v37
v_mfma_f32_16x16x32_bf16 v[180:183], a[52:55], v[68:71], v[180:183]
buffer_load_dwordx4 v3, s[48:51], s7 offen offset:1024 sc1 lds
v_mfma_f32_16x16x32_bf16 v[148:151], a[52:55], v[64:67], v[148:151]
ds_read_b128 a[24:27], v2 offset:30720
v_mfma_f32_16x16x32_bf16 v[152:155], a[56:59], v[64:67], v[152:155]
v_exp_f32 v38, v38
v_mfma_f32_16x16x32_bf16 v[184:187], a[56:59], v[68:71], v[184:187]
v_exp_f32 v39, v39
v_mfma_f32_16x16x32_bf16 v[216:219], a[56:59], v[72:75], v[216:219]
ds_read_b128 a[28:31], v2 offset:31744
v_cvt_pk_bf16_f32 v55, v38, v39
v_mfma_f32_16x16x32_bf16 v[248:251], a[56:59], v[76:79], v[248:251]
v_exp_f32 v40, v40
v_mfma_f32_16x16x32_bf16 v[252:255], a[60:63], v[76:79], v[252:255]
v_mfma_f32_16x16x32_bf16 v[220:223], a[60:63], v[72:75], v[220:223]
v_exp_f32 v41, v41
v_mfma_f32_16x16x32_bf16 v[188:191], a[60:63], v[68:71], v[188:191]
ds_read_b128 a[32:35], v2 offset:16384
v_cvt_pk_bf16_f32 v58, v40, v41
v_mfma_f32_16x16x32_bf16 v[156:159], a[60:63], v[64:67], v[156:159]
v_exp_f32 v42, v42
v_smfmac_f32_16x16x64_bf16 a[224:227], a[232:235], v[64:71], v9
s_waitcnt lgkmcnt(5)
v_smfmac_f32_16x16x64_bf16 a[228:231], a[232:235], v[72:79], v9
ds_read_b128 a[36:39], v2 offset:17408
v_mfma_f32_16x16x32_bf16 v[16:19], a[0:3], a[160:163], v[80:83]
v_exp_f32 v43, v43
v_mfma_f32_16x16x32_bf16 v[16:19], a[4:7], a[164:167], v[16:19]
v_exp_f32 v44, v44
v_mfma_f32_16x16x32_bf16 v[16:19], a[8:11], a[168:171], v[16:19]
buffer_load_dwordx4 v3, s[48:51], s7 offen offset:2048 sc1 lds
v_mfma_f32_16x16x32_bf16 v[16:19], a[12:15], a[172:175], v[16:19]
ds_read_b128 a[40:43], v2 offset:18432
v_cvt_pk_bf16_f32 v59, v42, v43
v_mfma_f32_16x16x32_bf16 v[20:23], a[0:3], a[176:179], v[84:87]
v_exp_f32 v45, v45
v_mfma_f32_16x16x32_bf16 v[20:23], a[4:7], a[180:183], v[20:23]
v_cvt_pk_bf16_f32 v62, v44, v45
v_mfma_f32_16x16x32_bf16 v[20:23], a[8:11], a[184:187], v[20:23]
v_exp_f32 v46, v46
v_mfma_f32_16x16x32_bf16 v[20:23], a[12:15], a[188:191], v[20:23]
ds_read_b128 a[44:47], v2 offset:19456
v_mfma_f32_16x16x32_bf16 v[24:27], a[0:3], a[192:195], v[88:91]
v_exp_f32 v47, v47
v_mfma_f32_16x16x32_bf16 v[24:27], a[4:7], a[196:199], v[24:27]
v_cvt_pk_bf16_f32 v63, v46, v47
v_mfma_f32_16x16x32_bf16 v[24:27], a[8:11], a[200:203], v[24:27]
v_exp_f32 v16, v16
v_mfma_f32_16x16x32_bf16 v[24:27], a[12:15], a[204:207], v[24:27]
ds_read_b128 a[48:51], v2 offset:20480
v_mfma_f32_16x16x32_bf16 v[28:31], a[0:3], a[208:211], v[92:95]
v_exp_f32 v17, v17
v_mfma_f32_16x16x32_bf16 v[28:31], a[4:7], a[212:215], v[28:31]
v_exp_f32 v18, v18
v_mfma_f32_16x16x32_bf16 v[28:31], a[8:11], a[216:219], v[28:31]
ds_read_b128 a[52:55], v2 offset:21504
v_cvt_pk_bf16_f32 v64, v16, v17
v_mfma_f32_16x16x32_bf16 v[28:31], a[12:15], a[220:223], v[28:31]
s_waitcnt lgkmcnt(6)
v_mfma_f32_16x16x32_bf16 v[32:35], a[16:19], a[160:163], v[80:83]
v_exp_f32 v19, v19
v_mfma_f32_16x16x32_bf16 v[32:35], a[20:23], a[164:167], v[32:35]
buffer_load_dwordx4 v3, s[48:51], s7 offen offset:3072 sc1 lds
v_mfma_f32_16x16x32_bf16 v[32:35], a[24:27], a[168:171], v[32:35]
ds_read_b128 a[56:59], v2 offset:22528
v_cvt_pk_bf16_f32 v65, v18, v19
v_mfma_f32_16x16x32_bf16 v[32:35], a[28:31], a[172:175], v[32:35]
s_add_u32 s7, s7, 0x8000
v_exp_f32 v20, v20
v_mfma_f32_16x16x32_bf16 v[36:39], a[16:19], a[176:179], v[84:87]
s_xor_b32 s19, s19, 0x8000
v_mfma_f32_16x16x32_bf16 v[36:39], a[20:23], a[180:183], v[36:39]
s_sub_u32 s15, s15, 1
v_exp_f32 v21, v21
v_mfma_f32_16x16x32_bf16 v[36:39], a[24:27], a[184:187], v[36:39]
ds_read_b128 a[60:63], v2 offset:23552
v_xor_b32 v2, 0x38000, v2
v_mfma_f32_16x16x32_bf16 v[36:39], a[28:31], a[188:191], v[36:39]
s_cmp_lg_u32 s15, 0
v_exp_f32 v22, v22
v_mfma_f32_16x16x32_bf16 v[40:43], a[16:19], a[192:195], v[88:91]
v_exp_f32 v23, v23
v_mfma_f32_16x16x32_bf16 v[40:43], a[20:23], a[196:199], v[40:43]
v_cvt_pk_bf16_f32 v68, v20, v21
v_cvt_pk_bf16_f32 v69, v22, v23
v_mfma_f32_16x16x32_bf16 v[40:43], a[24:27], a[200:203], v[40:43]
v_exp_f32 v24, v24
v_mfma_f32_16x16x32_bf16 v[40:43], a[28:31], a[204:207], v[40:43]
v_exp_f32 v25, v25
v_mfma_f32_16x16x32_bf16 v[44:47], a[16:19], a[208:211], v[92:95]
s_waitcnt vmcnt(16) lgkmcnt(0)
v_exp_f32 v26, v26
v_mfma_f32_16x16x32_bf16 v[44:47], a[20:23], a[212:215], v[44:47]
s_barrier
v_exp_f32 v27, v27
v_mfma_f32_16x16x32_bf16 v[44:47], a[24:27], a[216:219], v[44:47]
v_mfma_f32_16x16x32_bf16 v[44:47], a[28:31], a[220:223], v[44:47]
s_cbranch_scc1 L_att_deven1
L_att_ddone:
s_cmp_ge_u32 s4, 2
s_cbranch_scc1 L_att_dl0_1
L_att_dl0_0:
v_mfma_f32_16x16x32_bf16 v[128:131], a[32:35], v[48:51], v[128:131]
ds_read_b128 a[0:3], v1 offset:8192
v_cvt_pk_bf16_f32 v72, v24, v25
v_mfma_f32_16x16x32_bf16 v[160:163], a[32:35], v[52:55], v[160:163]
v_exp_f32 v28, v28
v_mfma_f32_16x16x32_bf16 v[192:195], a[32:35], v[56:59], v[192:195]
v_cvt_pk_bf16_f32 v73, v26, v27
v_mfma_f32_16x16x32_bf16 v[224:227], a[32:35], v[60:63], v[224:227]
ds_read_b128 a[4:7], v1 offset:9216
v_mfma_f32_16x16x32_bf16 v[228:231], a[36:39], v[60:63], v[228:231]
s_add_u32 m0, s27, 0x0
v_exp_f32 v29, v29
v_mfma_f32_16x16x32_bf16 v[196:199], a[36:39], v[56:59], v[196:199]
buffer_load_dwordx4 v3, s[48:51], s32 offen offset:0 sc1 lds
v_mfma_f32_16x16x32_bf16 v[164:167], a[36:39], v[52:55], v[164:167]
v_exp_f32 v30, v30
v_mfma_f32_16x16x32_bf16 v[132:135], a[36:39], v[48:51], v[132:135]
ds_read_b128 a[8:11], v1 offset:10240
v_cvt_pk_bf16_f32 v76, v28, v29
v_mfma_f32_16x16x32_bf16 v[136:139], a[40:43], v[48:51], v[136:139]
v_mfma_f32_16x16x32_bf16 v[168:171], a[40:43], v[52:55], v[168:171]
v_exp_f32 v31, v31
v_mfma_f32_16x16x32_bf16 v[200:203], a[40:43], v[56:59], v[200:203]
v_exp_f32 v32, v32
v_mfma_f32_16x16x32_bf16 v[232:235], a[40:43], v[60:63], v[232:235]
ds_read_b128 a[12:15], v1 offset:11264
v_cvt_pk_bf16_f32 v77, v30, v31
v_mfma_f32_16x16x32_bf16 v[236:239], a[44:47], v[60:63], v[236:239]
v_exp_f32 v33, v33
v_mfma_f32_16x16x32_bf16 v[204:207], a[44:47], v[56:59], v[204:207]
v_cvt_pk_bf16_f32 v66, v32, v33
v_mfma_f32_16x16x32_bf16 v[172:175], a[44:47], v[52:55], v[172:175]
s_mov_b32 s9, 0x0
v_exp_f32 v34, v34
v_mfma_f32_16x16x32_bf16 v[140:143], a[44:47], v[48:51], v[140:143]
ds_read_b128 a[16:19], v1 offset:12288
v_mfma_f32_16x16x32_bf16 v[144:147], a[48:51], v[48:51], v[144:147]
buffer_load_dword a244, v8, s[72:75], s9 offen
v_mfma_f32_16x16x32_bf16 v[176:179], a[48:51], v[52:55], v[176:179]
v_exp_f32 v35, v35
v_mfma_f32_16x16x32_bf16 v[208:211], a[48:51], v[56:59], v[208:211]
v_exp_f32 v36, v36
v_mfma_f32_16x16x32_bf16 v[240:243], a[48:51], v[60:63], v[240:243]
ds_read_b128 a[20:23], v1 offset:13312
v_cvt_pk_bf16_f32 v67, v34, v35
v_mfma_f32_16x16x32_bf16 v[244:247], a[52:55], v[60:63], v[244:247]
v_mfma_f32_16x16x32_bf16 v[212:215], a[52:55], v[56:59], v[212:215]
v_exp_f32 v37, v37
v_mfma_f32_16x16x32_bf16 v[180:183], a[52:55], v[52:55], v[180:183]
ds_read_b128 a[24:27], v1 offset:14336
v_cvt_pk_bf16_f32 v70, v36, v37
v_mfma_f32_16x16x32_bf16 v[148:151], a[52:55], v[48:51], v[148:151]
v_exp_f32 v38, v38
v_mfma_f32_16x16x32_bf16 v[152:155], a[56:59], v[48:51], v[152:155]
v_mfma_f32_16x16x32_bf16 v[184:187], a[56:59], v[52:55], v[184:187]
v_exp_f32 v39, v39
v_mfma_f32_16x16x32_bf16 v[216:219], a[56:59], v[56:59], v[216:219]
buffer_load_dwordx4 v3, s[48:51], s32 offen offset:1024 sc1 lds
v_mfma_f32_16x16x32_bf16 v[248:251], a[56:59], v[60:63], v[248:251]
ds_read_b128 a[28:31], v1 offset:15360
v_cvt_pk_bf16_f32 v71, v38, v39
v_mfma_f32_16x16x32_bf16 v[252:255], a[60:63], v[60:63], v[252:255]
v_exp_f32 v40, v40
v_mfma_f32_16x16x32_bf16 v[220:223], a[60:63], v[56:59], v[220:223]
v_exp_f32 v41, v41
v_mfma_f32_16x16x32_bf16 v[188:191], a[60:63], v[52:55], v[188:191]
ds_read_b128 a[32:35], v1 offset:0
v_cvt_pk_bf16_f32 v74, v40, v41
v_mfma_f32_16x16x32_bf16 v[156:159], a[60:63], v[48:51], v[156:159]
v_smfmac_f32_16x16x64_bf16 a[224:227], a[232:235], v[48:55], v9
v_exp_f32 v42, v42
v_smfmac_f32_16x16x64_bf16 a[228:231], a[232:235], v[56:63], v9
s_waitcnt lgkmcnt(5)
v_exp_f32 v43, v43
v_mfma_f32_16x16x32_bf16 v[16:19], a[0:3], a[160:163], v[96:99]
ds_read_b128 a[36:39], v1 offset:1024
v_cvt_pk_bf16_f32 v75, v42, v43
v_mfma_f32_16x16x32_bf16 v[16:19], a[4:7], a[164:167], v[16:19]
v_exp_f32 v44, v44
v_mfma_f32_16x16x32_bf16 v[16:19], a[8:11], a[168:171], v[16:19]
v_mfma_f32_16x16x32_bf16 v[16:19], a[12:15], a[172:175], v[16:19]
buffer_load_dwordx4 v3, s[48:51], s32 offen offset:2048 sc1 lds
v_mfma_f32_16x16x32_bf16 v[20:23], a[0:3], a[176:179], v[84:87]
ds_read_b128 a[40:43], v1 offset:2048
v_mfma_f32_16x16x32_bf16 v[20:23], a[4:7], a[180:183], v[20:23]
v_exp_f32 v45, v45
v_mfma_f32_16x16x32_bf16 v[20:23], a[8:11], a[184:187], v[20:23]
v_exp_f32 v46, v46
v_mfma_f32_16x16x32_bf16 v[20:23], a[12:15], a[188:191], v[20:23]
ds_read_b128 a[44:47], v1 offset:3072
v_cvt_pk_bf16_f32 v78, v44, v45
v_mfma_f32_16x16x32_bf16 v[24:27], a[0:3], a[192:195], v[88:91]
v_mfma_f32_16x16x32_bf16 v[24:27], a[4:7], a[196:199], v[24:27]
v_exp_f32 v47, v47
v_mfma_f32_16x16x32_bf16 v[24:27], a[8:11], a[200:203], v[24:27]
v_exp_f32 v16, v16
v_mfma_f32_16x16x32_bf16 v[24:27], a[12:15], a[204:207], v[24:27]
ds_read_b128 a[48:51], v1 offset:4096
v_cvt_pk_bf16_f32 v79, v46, v47
v_mfma_f32_16x16x32_bf16 v[28:31], a[0:3], a[208:211], v[92:95]
v_exp_f32 v17, v17
v_mfma_f32_16x16x32_bf16 v[28:31], a[4:7], a[212:215], v[28:31]
s_waitcnt lgkmcnt(5)
v_cvt_pk_bf16_f32 v48, v16, v17
v_mfma_f32_16x16x32_bf16 v[28:31], a[8:11], a[216:219], v[28:31]
buffer_load_dwordx4 v3, s[48:51], s32 offen offset:3072 sc1 lds
v_mfma_f32_16x16x32_bf16 v[28:31], a[12:15], a[220:223], v[28:31]
ds_read_b128 a[52:55], v1 offset:5120
v_mfma_f32_16x16x32_bf16 v[32:35], a[16:19], a[160:163], v[100:103]
v_exp_f32 v18, v18
v_mfma_f32_16x16x32_bf16 v[32:35], a[20:23], a[164:167], v[32:35]
v_exp_f32 v19, v19
v_mfma_f32_16x16x32_bf16 v[32:35], a[24:27], a[168:171], v[32:35]
v_exp_f32 v20, v20
v_mfma_f32_16x16x32_bf16 v[32:35], a[28:31], a[172:175], v[32:35]
ds_read_b128 a[56:59], v1 offset:6144
v_cvt_pk_bf16_f32 v49, v18, v19
v_mfma_f32_16x16x32_bf16 v[36:39], a[16:19], a[176:179], v[84:87]
v_mfma_f32_16x16x32_bf16 v[36:39], a[20:23], a[180:183], v[36:39]
v_exp_f32 v21, v21
v_mfma_f32_16x16x32_bf16 v[36:39], a[24:27], a[184:187], v[36:39]
s_mov_b32 s9, 0x0
v_exp_f32 v22, v22
v_mfma_f32_16x16x32_bf16 v[36:39], a[28:31], a[188:191], v[36:39]
ds_read_b128 a[60:63], v1 offset:7168
v_cvt_pk_bf16_f32 v52, v20, v21
v_mfma_f32_16x16x32_bf16 v[40:43], a[16:19], a[192:195], v[88:91]
buffer_load_dword a244, v8, s[64:67], s9 offen
v_mfma_f32_16x16x32_bf16 v[40:43], a[20:23], a[196:199], v[40:43]
v_mfma_f32_16x16x32_bf16 v[40:43], a[24:27], a[200:203], v[40:43]
v_exp_f32 v23, v23
v_mfma_f32_16x16x32_bf16 v[40:43], a[28:31], a[204:207], v[40:43]
v_exp_f32 v24, v24
v_mfma_f32_16x16x32_bf16 v[44:47], a[16:19], a[208:211], v[92:95]
v_exp_f32 v25, v25
v_mfma_f32_16x16x32_bf16 v[44:47], a[20:23], a[212:215], v[44:47]
v_exp_f32 v26, v26
v_mfma_f32_16x16x32_bf16 v[44:47], a[24:27], a[216:219], v[44:47]
v_exp_f32 v27, v27
v_mfma_f32_16x16x32_bf16 v[44:47], a[28:31], a[220:223], v[44:47]
s_waitcnt lgkmcnt(0)
v_cvt_pk_bf16_f32 v53, v22, v23
v_mfma_f32_16x16x32_bf16 v[128:131], a[32:35], v[64:67], v[128:131]
ds_read_b128 a[0:3], v1 offset:24576
v_cvt_pk_bf16_f32 v56, v24, v25
v_mfma_f32_16x16x32_bf16 v[160:163], a[32:35], v[68:71], v[160:163]
v_exp_f32 v28, v28
v_mfma_f32_16x16x32_bf16 v[192:195], a[32:35], v[72:75], v[192:195]
v_cvt_pk_bf16_f32 v57, v26, v27
v_mfma_f32_16x16x32_bf16 v[224:227], a[32:35], v[76:79], v[224:227]
ds_read_b128 a[4:7], v1 offset:25600
v_mfma_f32_16x16x32_bf16 v[228:231], a[36:39], v[76:79], v[228:231]
s_add_u32 m0, s27, 0x1000
v_exp_f32 v29, v29
v_mfma_f32_16x16x32_bf16 v[196:199], a[36:39], v[72:75], v[196:199]
buffer_load_dwordx4 v3, s[48:51], s7 offen offset:0 sc1 lds
v_mfma_f32_16x16x32_bf16 v[164:167], a[36:39], v[68:71], v[164:167]
ds_read_b128 a[8:11], v1 offset:26624
v_cvt_pk_bf16_f32 v60, v28, v29
v_mfma_f32_16x16x32_bf16 v[132:135], a[36:39], v[64:67], v[132:135]
v_exp_f32 v30, v30
v_mfma_f32_16x16x32_bf16 v[136:139], a[40:43], v[64:67], v[136:139]
v_exp_f32 v31, v31
v_mfma_f32_16x16x32_bf16 v[168:171], a[40:43], v[68:71], v[168:171]
ds_read_b128 a[12:15], v1 offset:27648
v_cvt_pk_bf16_f32 v61, v30, v31
v_mfma_f32_16x16x32_bf16 v[200:203], a[40:43], v[72:75], v[200:203]
v_mfma_f32_16x16x32_bf16 v[232:235], a[40:43], v[76:79], v[232:235]
v_exp_f32 v32, v32
v_mfma_f32_16x16x32_bf16 v[236:239], a[44:47], v[76:79], v[236:239]
v_exp_f32 v33, v33
v_mfma_f32_16x16x32_bf16 v[204:207], a[44:47], v[72:75], v[204:207]
ds_read_b128 a[16:19], v1 offset:28672
v_cvt_pk_bf16_f32 v50, v32, v33
v_mfma_f32_16x16x32_bf16 v[172:175], a[44:47], v[68:71], v[172:175]
v_exp_f32 v34, v34
v_mfma_f32_16x16x32_bf16 v[140:143], a[44:47], v[64:67], v[140:143]
buffer_load_dwordx4 v3, s[48:51], s7 offen offset:1024 sc1 lds
v_mfma_f32_16x16x32_bf16 v[144:147], a[48:51], v[64:67], v[144:147]
ds_read_b128 a[20:23], v1 offset:29696
v_mfma_f32_16x16x32_bf16 v[176:179], a[48:51], v[68:71], v[176:179]
v_mfma_f32_16x16x32_bf16 v[208:211], a[48:51], v[72:75], v[208:211]
v_exp_f32 v35, v35
v_mfma_f32_16x16x32_bf16 v[240:243], a[48:51], v[76:79], v[240:243]
ds_read_b128 a[24:27], v1 offset:30720
v_cvt_pk_bf16_f32 v51, v34, v35
v_mfma_f32_16x16x32_bf16 v[244:247], a[52:55], v[76:79], v[244:247]
v_exp_f32 v36, v36
v_mfma_f32_16x16x32_bf16 v[212:215], a[52:55], v[72:75], v[212:215]
v_exp_f32 v37, v37
v_mfma_f32_16x16x32_bf16 v[180:183], a[52:55], v[68:71], v[180:183]
ds_read_b128 a[28:31], v1 offset:31744
v_cvt_pk_bf16_f32 v54, v36, v37
v_mfma_f32_16x16x32_bf16 v[148:151], a[52:55], v[64:67], v[148:151]
v_mfma_f32_16x16x32_bf16 v[152:155], a[56:59], v[64:67], v[152:155]
v_exp_f32 v38, v38
v_mfma_f32_16x16x32_bf16 v[184:187], a[56:59], v[68:71], v[184:187]
v_exp_f32 v39, v39
v_mfma_f32_16x16x32_bf16 v[216:219], a[56:59], v[72:75], v[216:219]
buffer_load_dwordx4 v3, s[48:51], s7 offen offset:2048 sc1 lds
v_mfma_f32_16x16x32_bf16 v[248:251], a[56:59], v[76:79], v[248:251]
ds_read_b128 a[32:35], v1 offset:16384
v_cvt_pk_bf16_f32 v55, v38, v39
v_mfma_f32_16x16x32_bf16 v[252:255], a[60:63], v[76:79], v[252:255]
v_exp_f32 v40, v40
v_mfma_f32_16x16x32_bf16 v[220:223], a[60:63], v[72:75], v[220:223]
ds_read_b128 a[36:39], v1 offset:17408
v_mfma_f32_16x16x32_bf16 v[188:191], a[60:63], v[68:71], v[188:191]
v_mfma_f32_16x16x32_bf16 v[156:159], a[60:63], v[64:67], v[156:159]
v_exp_f32 v41, v41
v_smfmac_f32_16x16x64_bf16 a[224:227], a[232:235], v[64:71], v9
ds_read_b128 a[40:43], v1 offset:18432
v_cvt_pk_bf16_f32 v58, v40, v41
v_smfmac_f32_16x16x64_bf16 a[228:231], a[232:235], v[72:79], v9
s_waitcnt lgkmcnt(7)
v_exp_f32 v42, v42
v_mfma_f32_16x16x32_bf16 v[20:23], a[0:3], a[176:179], v[84:87]
s_mov_b32 s9, 0x400000
v_exp_f32 v43, v43
v_mfma_f32_16x16x32_bf16 v[20:23], a[4:7], a[180:183], v[20:23]
ds_read_b128 a[44:47], v1 offset:19456
v_cvt_pk_bf16_f32 v59, v42, v43
v_mfma_f32_16x16x32_bf16 v[20:23], a[8:11], a[184:187], v[20:23]
buffer_load_dword a244, v8, s[64:67], s9 offen
v_mfma_f32_16x16x32_bf16 v[20:23], a[12:15], a[188:191], v[20:23]
v_mfma_f32_16x16x32_bf16 v[24:27], a[0:3], a[192:195], v[88:91]
v_exp_f32 v44, v44
v_mfma_f32_16x16x32_bf16 v[24:27], a[4:7], a[196:199], v[24:27]
ds_read_b128 a[48:51], v1 offset:20480
v_mfma_f32_16x16x32_bf16 v[24:27], a[8:11], a[200:203], v[24:27]
v_exp_f32 v45, v45
v_mfma_f32_16x16x32_bf16 v[24:27], a[12:15], a[204:207], v[24:27]
v_exp_f32 v46, v46
v_mfma_f32_16x16x32_bf16 v[28:31], a[0:3], a[208:211], v[92:95]
ds_read_b128 a[52:55], v1 offset:21504
v_cvt_pk_bf16_f32 v62, v44, v45
v_mfma_f32_16x16x32_bf16 v[28:31], a[4:7], a[212:215], v[28:31]
v_mfma_f32_16x16x32_bf16 v[28:31], a[8:11], a[216:219], v[28:31]
s_waitcnt lgkmcnt(6)
v_exp_f32 v47, v47
v_mfma_f32_16x16x32_bf16 v[28:31], a[12:15], a[220:223], v[28:31]
ds_read_b128 a[56:59], v1 offset:22528
v_cvt_pk_bf16_f32 v63, v46, v47
v_mfma_f32_16x16x32_bf16 v[36:39], a[16:19], a[176:179], v[84:87]
buffer_load_dwordx4 v3, s[48:51], s7 offen offset:3072 sc1 lds
v_mfma_f32_16x16x32_bf16 v[36:39], a[20:23], a[180:183], v[36:39]
s_add_u32 s32, s32, 0x8000
v_exp_f32 v20, v20
v_mfma_f32_16x16x32_bf16 v[36:39], a[24:27], a[184:187], v[36:39]
ds_read_b128 a[60:63], v1 offset:23552
v_xor_b32 v1, 0x8000, v1
v_mfma_f32_16x16x32_bf16 v[36:39], a[28:31], a[188:191], v[36:39]
s_add_u32 s7, s7, 0x8000
v_exp_f32 v21, v21
v_mfma_f32_16x16x32_bf16 v[40:43], a[16:19], a[192:195], v[88:91]
s_xor_b32 s27, s27, 0x38000
v_cvt_pk_bf16_f32 v68, v20, v21
v_mfma_f32_16x16x32_bf16 v[40:43], a[20:23], a[196:199], v[40:43]
v_exp_f32 v22, v22
v_mfma_f32_16x16x32_bf16 v[40:43], a[24:27], a[200:203], v[40:43]
v_exp_f32 v23, v23
v_mfma_f32_16x16x32_bf16 v[40:43], a[28:31], a[204:207], v[40:43]
v_exp_f32 v24, v24
v_mfma_f32_16x16x32_bf16 v[44:47], a[16:19], a[208:211], v[92:95]
v_exp_f32 v25, v25
v_mfma_f32_16x16x32_bf16 v[44:47], a[20:23], a[212:215], v[44:47]
v_exp_f32 v26, v26
v_mfma_f32_16x16x32_bf16 v[44:47], a[24:27], a[216:219], v[44:47]
s_waitcnt vmcnt(19) lgkmcnt(0)
v_exp_f32 v27, v27
v_mfma_f32_16x16x32_bf16 v[44:47], a[28:31], a[220:223], v[44:47]
s_barrier
v_cvt_pk_bf16_f32 v69, v22, v23
L_att_l1_0:
v_mfma_f32_16x16x32_bf16 v[128:131], a[32:35], v[48:51], v[128:131]
ds_read_b128 a[0:3], v2 offset:8192
v_cvt_pk_bf16_f32 v72, v24, v25
v_mfma_f32_16x16x32_bf16 v[160:163], a[32:35], v[52:55], v[160:163]
s_lshr_b32 s44, s2, 6
v_exp_f32 v28, v28
v_mfma_f32_16x16x32_bf16 v[192:195], a[32:35], v[56:59], v[192:195]
s_add_u32 m0, s19, 0x0
s_lshl_b32 s45, s44, 1
v_cvt_pk_bf16_f32 v73, v26, v27
v_mfma_f32_16x16x32_bf16 v[224:227], a[32:35], v[60:63], v[224:227]
ds_read_b128 a[4:7], v2 offset:9216
s_add_u32 s45, s45, s100
v_mfma_f32_16x16x32_bf16 v[228:231], a[36:39], v[60:63], v[228:231]
buffer_load_dwordx4 v3, s[48:51], s32 offen offset:0 sc1 lds
v_mfma_f32_16x16x32_bf16 v[196:199], a[36:39], v[56:59], v[196:199]
s_and_b32 s60, s45, 3
v_exp_f32 v29, v29
v_mfma_f32_16x16x32_bf16 v[164:167], a[36:39], v[52:55], v[164:167]
ds_read_b128 a[8:11], v2 offset:10240
v_cvt_pk_bf16_f32 v76, v28, v29
v_mfma_f32_16x16x32_bf16 v[132:135], a[36:39], v[48:51], v[132:135]
s_sub_u32 s60, s60, s44
v_exp_f32 v30, v30
v_mfma_f32_16x16x32_bf16 v[136:139], a[40:43], v[48:51], v[136:139]
s_add_u32 s60, s60, 4
s_lshl_b32 s60, s60, 14
s_and_b32 s60, s60, 0x7c000
v_mfma_f32_16x16x32_bf16 v[168:171], a[40:43], v[52:55], v[168:171]
ds_read_b128 a[12:15], v2 offset:11264
s_lshl_b32 s61, s60, 3
v_mfma_f32_16x16x32_bf16 v[200:203], a[40:43], v[56:59], v[200:203]
s_add_u32 s62, s61, s12
v_exp_f32 v31, v31
v_mfma_f32_16x16x32_bf16 v[232:235], a[40:43], v[60:63], v[232:235]
s_mul_i32 s44, s44, -8
v_exp_f32 v36, v36
v_mfma_f32_16x16x32_bf16 v[236:239], a[44:47], v[60:63], v[236:239]
s_mov_b32 s9, 0x200000
s_lshl_b32 s44, 4, s44
v_cvt_pk_bf16_f32 v77, v30, v31
v_mfma_f32_16x16x32_bf16 v[204:207], a[44:47], v[56:59], v[204:207]
ds_read_b128 a[16:19], v2 offset:12288
s_mul_i32 s45, s45, -8
v_mfma_f32_16x16x32_bf16 v[172:175], a[44:47], v[52:55], v[172:175]
buffer_load_dword a244, v8, s[64:67], s9 offen
v_mfma_f32_16x16x32_bf16 v[140:143], a[44:47], v[48:51], v[140:143]
s_lshl_b32 s45, 4, s45
v_exp_f32 v37, v37
v_mfma_f32_16x16x32_bf16 v[144:147], a[48:51], v[48:51], v[144:147]
ds_read_b128 a[20:23], v2 offset:13312
v_cvt_pk_bf16_f32 v70, v36, v37
v_mfma_f32_16x16x32_bf16 v[176:179], a[48:51], v[52:55], v[176:179]
s_add_u32 s44, s44, 0x21212121
v_exp_f32 v38, v38
v_mfma_f32_16x16x32_bf16 v[208:211], a[48:51], v[56:59], v[208:211]
s_sub_u32 s44, s44, s45
s_bfe_u32 s56, s44, 0x80000
s_lshl_b32 s56, s56, 14
v_mfma_f32_16x16x32_bf16 v[240:243], a[48:51], v[60:63], v[240:243]
ds_read_b128 a[24:27], v2 offset:14336
s_bfe_u32 s57, s44, 0x80008
v_mfma_f32_16x16x32_bf16 v[244:247], a[52:55], v[60:63], v[244:247]
s_lshl_b32 s57, s57, 14
v_exp_f32 v39, v39
v_mfma_f32_16x16x32_bf16 v[212:215], a[52:55], v[56:59], v[212:215]
s_bfe_u32 s58, s44, 0x80010
v_exp_f32 v40, v40
v_mfma_f32_16x16x32_bf16 v[180:183], a[52:55], v[52:55], v[180:183]
s_lshl_b32 s58, s58, 14
s_bfe_u32 s59, s44, 0x80018
v_cvt_pk_bf16_f32 v71, v38, v39
v_mfma_f32_16x16x32_bf16 v[148:151], a[52:55], v[48:51], v[148:151]
buffer_load_dwordx4 v3, s[48:51], s32 offen offset:1024 sc1 lds
v_mfma_f32_16x16x32_bf16 v[152:155], a[56:59], v[48:51], v[152:155]
ds_read_b128 a[28:31], v2 offset:15360
s_lshl_b32 s59, s59, 14
v_mfma_f32_16x16x32_bf16 v[184:187], a[56:59], v[52:55], v[184:187]
v_exp_f32 v41, v41
v_mfma_f32_16x16x32_bf16 v[216:219], a[56:59], v[56:59], v[216:219]
ds_read_b128 a[32:35], v2 offset:0
v_cvt_pk_bf16_f32 v74, v40, v41
v_mfma_f32_16x16x32_bf16 v[248:251], a[56:59], v[60:63], v[248:251]
v_exp_f32 v42, v42
v_mfma_f32_16x16x32_bf16 v[252:255], a[60:63], v[60:63], v[252:255]
v_mfma_f32_16x16x32_bf16 v[220:223], a[60:63], v[56:59], v[220:223]
ds_read_b128 a[36:39], v2 offset:1024
v_mfma_f32_16x16x32_bf16 v[188:191], a[60:63], v[52:55], v[188:191]
v_exp_f32 v43, v43
v_mfma_f32_16x16x32_bf16 v[156:159], a[60:63], v[48:51], v[156:159]
s_waitcnt lgkmcnt(6)
v_exp_f32 v44, v44
v_smfmac_f32_16x16x64_bf16 a[224:227], a[232:235], v[48:55], v9
buffer_load_dwordx4 v3, s[48:51], s32 offen offset:2048 sc1 lds
v_smfmac_f32_16x16x64_bf16 a[228:231], a[232:235], v[56:63], v9
ds_read_b128 a[40:43], v2 offset:2048
v_cvt_pk_bf16_f32 v75, v42, v43
v_mfma_f32_16x16x32_bf16 v[20:23], a[0:3], a[176:179], v[84:87]
v_mfma_f32_16x16x32_bf16 v[20:23], a[4:7], a[180:183], v[20:23]
v_exp_f32 v45, v45
v_mfma_f32_16x16x32_bf16 v[20:23], a[8:11], a[184:187], v[20:23]
ds_read_b128 a[44:47], v2 offset:3072
v_cvt_pk_bf16_f32 v78, v44, v45
v_mfma_f32_16x16x32_bf16 v[20:23], a[12:15], a[188:191], v[20:23]
v_exp_f32 v46, v46
v_mfma_f32_16x16x32_bf16 v[24:27], a[0:3], a[192:195], v[88:91]
v_mfma_f32_16x16x32_bf16 v[24:27], a[4:7], a[196:199], v[24:27]
ds_read_b128 a[48:51], v2 offset:4096
v_mfma_f32_16x16x32_bf16 v[24:27], a[8:11], a[200:203], v[24:27]
v_exp_f32 v47, v47
v_mfma_f32_16x16x32_bf16 v[24:27], a[12:15], a[204:207], v[24:27]
s_nop 0
v_exp_f32 v20, v20
v_mfma_f32_16x16x32_bf16 v[28:31], a[0:3], a[208:211], v[92:95]
buffer_load_dwordx4 v3, s[48:51], s32 offen offset:3072 sc1 lds
v_mfma_f32_16x16x32_bf16 v[28:31], a[4:7], a[212:215], v[28:31]
ds_read_b128 a[52:55], v2 offset:5120
v_cvt_pk_bf16_f32 v79, v46, v47
v_mfma_f32_16x16x32_bf16 v[28:31], a[8:11], a[216:219], v[28:31]
v_mfma_f32_16x16x32_bf16 v[28:31], a[12:15], a[220:223], v[28:31]
s_waitcnt lgkmcnt(6)
v_exp_f32 v21, v21
v_mfma_f32_16x16x32_bf16 v[36:39], a[16:19], a[176:179], v[84:87]
ds_read_b128 a[56:59], v2 offset:6144
v_cvt_pk_bf16_f32 v52, v20, v21
v_mfma_f32_16x16x32_bf16 v[36:39], a[20:23], a[180:183], v[36:39]
v_exp_f32 v22, v22
v_mfma_f32_16x16x32_bf16 v[36:39], a[24:27], a[184:187], v[36:39]
v_mfma_f32_16x16x32_bf16 v[36:39], a[28:31], a[188:191], v[36:39]
ds_read_b128 a[60:63], v2 offset:7168
v_mfma_f32_16x16x32_bf16 v[40:43], a[16:19], a[192:195], v[88:91]
s_mov_b32 s9, 0x600000
v_exp_f32 v23, v23
v_mfma_f32_16x16x32_bf16 v[40:43], a[20:23], a[196:199], v[40:43]
buffer_load_dword a244, v8, s[64:67], s9 offen
v_mfma_f32_16x16x32_bf16 v[40:43], a[24:27], a[200:203], v[40:43]
v_exp_f32 v24, v24
v_mfma_f32_16x16x32_bf16 v[40:43], a[28:31], a[204:207], v[40:43]
v_cvt_pk_bf16_f32 v53, v22, v23
v_mfma_f32_16x16x32_bf16 v[44:47], a[16:19], a[208:211], v[92:95]
v_exp_f32 v25, v25
v_mfma_f32_16x16x32_bf16 v[44:47], a[20:23], a[212:215], v[44:47]
v_exp_f32 v26, v26
v_mfma_f32_16x16x32_bf16 v[44:47], a[24:27], a[216:219], v[44:47]
v_exp_f32 v27, v27
v_mfma_f32_16x16x32_bf16 v[44:47], a[28:31], a[220:223], v[44:47]
s_waitcnt lgkmcnt(0)
v_mfma_f32_16x16x32_bf16 v[160:163], a[32:35], v[68:71], v[160:163]
ds_read_b128 a[0:3], v2 offset:24576
v_cvt_pk_bf16_f32 v56, v24, v25
v_mfma_f32_16x16x32_bf16 v[192:195], a[32:35], v[72:75], v[192:195]
v_exp_f32 v28, v28
v_mfma_f32_16x16x32_bf16 v[224:227], a[32:35], v[76:79], v[224:227]
ds_read_b128 a[4:7], v2 offset:25600
v_cvt_pk_bf16_f32 v57, v26, v27
v_mfma_f32_16x16x32_bf16 v[228:231], a[36:39], v[76:79], v[228:231]
s_add_u32 m0, s19, 0x1000
v_mfma_f32_16x16x32_bf16 v[196:199], a[36:39], v[72:75], v[196:199]
buffer_load_dwordx4 v3, s[48:51], s7 offen offset:0 sc1 lds
v_mfma_f32_16x16x32_bf16 v[164:167], a[36:39], v[68:71], v[164:167]
ds_read_b128 a[8:11], v2 offset:26624
v_mfma_f32_16x16x32_bf16 v[168:171], a[40:43], v[68:71], v[168:171]
v_exp_f32 v29, v29
v_mfma_f32_16x16x32_bf16 v[200:203], a[40:43], v[72:75], v[200:203]
v_exp_f32 v30, v30
v_mfma_f32_16x16x32_bf16 v[232:235], a[40:43], v[76:79], v[232:235]
ds_read_b128 a[12:15], v2 offset:27648
v_cvt_pk_bf16_f32 v60, v28, v29
v_mfma_f32_16x16x32_bf16 v[236:239], a[44:47], v[76:79], v[236:239]
v_exp_f32 v31, v31
v_mfma_f32_16x16x32_bf16 v[204:207], a[44:47], v[72:75], v[204:207]
v_exp_f32 v36, v36
v_mfma_f32_16x16x32_bf16 v[172:175], a[44:47], v[68:71], v[172:175]
ds_read_b128 a[16:19], v2 offset:28672
v_cvt_pk_bf16_f32 v61, v30, v31
v_mfma_f32_16x16x32_bf16 v[176:179], a[48:51], v[68:71], v[176:179]
buffer_load_dwordx4 v3, s[48:51], s7 offen offset:1024 sc1 lds
v_mfma_f32_16x16x32_bf16 v[208:211], a[48:51], v[72:75], v[208:211]
ds_read_b128 a[20:23], v2 offset:29696
v_mfma_f32_16x16x32_bf16 v[240:243], a[48:51], v[76:79], v[240:243]
v_mfma_f32_16x16x32_bf16 v[244:247], a[52:55], v[76:79], v[244:247]
v_exp_f32 v37, v37
v_mfma_f32_16x16x32_bf16 v[212:215], a[52:55], v[72:75], v[212:215]
ds_read_b128 a[24:27], v2 offset:30720
v_cvt_pk_bf16_f32 v54, v36, v37
v_mfma_f32_16x16x32_bf16 v[180:183], a[52:55], v[68:71], v[180:183]
v_exp_f32 v38, v38
v_mfma_f32_16x16x32_bf16 v[184:187], a[56:59], v[68:71], v[184:187]
v_exp_f32 v39, v39
v_mfma_f32_16x16x32_bf16 v[216:219], a[56:59], v[72:75], v[216:219]
ds_read_b128 a[28:31], v2 offset:31744
v_cvt_pk_bf16_f32 v55, v38, v39
v_mfma_f32_16x16x32_bf16 v[248:251], a[56:59], v[76:79], v[248:251]
v_exp_f32 v40, v40
v_mfma_f32_16x16x32_bf16 v[252:255], a[60:63], v[76:79], v[252:255]
buffer_load_dwordx4 v3, s[48:51], s7 offen offset:2048 sc1 lds
v_mfma_f32_16x16x32_bf16 v[220:223], a[60:63], v[72:75], v[220:223]
ds_read_b128 a[32:35], v2 offset:16384
v_mfma_f32_16x16x32_bf16 v[188:191], a[60:63], v[68:71], v[188:191]
v_exp_f32 v41, v41
v_mfma_f32_16x16x32_bf16 a[224:227], a[236:239], v[68:71], a[224:227]
ds_read_b128 a[36:39], v2 offset:17408
v_cvt_pk_bf16_f32 v58, v40, v41
v_smfmac_f32_16x16x64_bf16 a[228:231], a[232:235], v[72:79], v9
s_waitcnt lgkmcnt(6)
v_exp_f32 v42, v42
v_mfma_f32_16x16x32_bf16 v[20:23], a[0:3], a[176:179], v[104:107]
v_exp_f32 v43, v43
v_mfma_f32_16x16x32_bf16 v[20:23], a[4:7], a[180:183], v[20:23]
ds_read_b128 a[40:43], v2 offset:18432
v_cvt_pk_bf16_f32 v59, v42, v43
v_mfma_f32_16x16x32_bf16 v[20:23], a[8:11], a[184:187], v[20:23]
v_exp_f32 v44, v44
v_mfma_f32_16x16x32_bf16 v[20:23], a[12:15], a[188:191], v[20:23]
buffer_load_dwordx4 v3, s[48:51], s7 offen offset:3072 sc1 lds
v_mfma_f32_16x16x32_bf16 v[24:27], a[0:3], a[192:195], v[88:91]
ds_read_b128 a[44:47], v2 offset:19456
v_mfma_f32_16x16x32_bf16 v[24:27], a[4:7], a[196:199], v[24:27]
v_exp_f32 v45, v45
v_mfma_f32_16x16x32_bf16 v[24:27], a[8:11], a[200:203], v[24:27]
v_exp_f32 v46, v46
v_mfma_f32_16x16x32_bf16 v[24:27], a[12:15], a[204:207], v[24:27]
ds_read_b128 a[48:51], v2 offset:20480
v_add_u32 v4, s0, v3
v_mfma_f32_16x16x32_bf16 v[28:31], a[0:3], a[208:211], v[92:95]
v_cvt_pk_bf16_f32 v62, v44, v45
v_mfma_f32_16x16x32_bf16 v[28:31], a[4:7], a[212:215], v[28:31]
ds_read_b128 a[52:55], v2 offset:21504
v_mov_b32 v5, s1
v_mfma_f32_16x16x32_bf16 v[28:31], a[8:11], a[216:219], v[28:31]
s_waitcnt lgkmcnt(6)
v_exp_f32 v47, v47
v_mfma_f32_16x16x32_bf16 v[28:31], a[12:15], a[220:223], v[28:31]
global_load_dword a244, v[4:5], off sc1
v_mfma_f32_16x16x32_bf16 v[36:39], a[16:19], a[176:179], v[108:111]
ds_read_b128 a[56:59], v2 offset:22528
v_cvt_pk_bf16_f32 v63, v46, v47
v_mfma_f32_16x16x32_bf16 v[36:39], a[20:23], a[180:183], v[36:39]
s_add_u32 s32, s32, 0x8000
v_exp_f32 v20, v20
v_mfma_f32_16x16x32_bf16 v[36:39], a[24:27], a[184:187], v[36:39]
s_add_u32 s7, s7, 0x8000
v_exp_f32 v21, v21
v_mfma_f32_16x16x32_bf16 v[36:39], a[28:31], a[188:191], v[36:39]
ds_read_b128 a[60:63], v2 offset:23552
v_xor_b32 v2, 0x38000, v2
v_mfma_f32_16x16x32_bf16 v[40:43], a[16:19], a[192:195], v[88:91]
s_xor_b32 s19, s19, 0x8000
v_exp_f32 v22, v22
v_mfma_f32_16x16x32_bf16 v[40:43], a[20:23], a[196:199], v[40:43]
s_sub_u32 s15, 7, s6
v_exp_f32 v23, v23
v_mfma_f32_16x16x32_bf16 v[40:43], a[24:27], a[200:203], v[40:43]
s_lshl_b32 s15, s15, 1
v_exp_f32 v24, v24
v_mfma_f32_16x16x32_bf16 v[40:43], a[28:31], a[204:207], v[40:43]
v_exp_f32 v25, v25
v_mfma_f32_16x16x32_bf16 v[44:47], a[16:19], a[208:211], v[92:95]
v_exp_f32 v26, v26
v_mfma_f32_16x16x32_bf16 v[44:47], a[20:23], a[212:215], v[44:47]
v_exp_f32 v27, v27
v_mfma_f32_16x16x32_bf16 v[44:47], a[24:27], a[216:219], v[44:47]
s_waitcnt vmcnt(22) lgkmcnt(0)
v_cvt_pk_bf16_f32 v68, v20, v21
v_cvt_pk_bf16_f32 v69, v22, v23
v_mfma_f32_16x16x32_bf16 v[44:47], a[28:31], a[220:223], v[44:47]
s_barrier
s_cbranch_scc0 L_att_lh0_0
v_mfma_f32_16x16x32_bf16 v[160:163], a[32:35], v[52:55], v[160:163]
ds_read_b128 a[0:3], v1 offset:8192
v_cvt_pk_bf16_f32 v72, v24, v25
v_mfma_f32_16x16x32_bf16 v[192:195], a[32:35], v[56:59], v[192:195]
v_exp_f32 v28, v28
v_mfma_f32_16x16x32_bf16 v[224:227], a[32:35], v[60:63], v[224:227]
ds_read_b128 a[4:7], v1 offset:9216
v_cvt_pk_bf16_f32 v73, v26, v27
v_mfma_f32_16x16x32_bf16 v[228:231], a[36:39], v[60:63], v[228:231]
s_add_u32 m0, s27, 0x0
v_exp_f32 v29, v29
v_mfma_f32_16x16x32_bf16 v[196:199], a[36:39], v[56:59], v[196:199]
buffer_load_dwordx4 v3, s[48:51], s32 offen offset:0 sc1 lds
v_mfma_f32_16x16x32_bf16 v[164:167], a[36:39], v[52:55], v[164:167]
ds_read_b128 a[8:11], v1 offset:10240
v_cvt_pk_bf16_f32 v76, v28, v29
v_mfma_f32_16x16x32_bf16 v[168:171], a[40:43], v[52:55], v[168:171]
ds_read_b128 a[12:15], v1 offset:11264
v_accvgpr_read_b32 v6, a224
v_mfma_f32_16x16x32_bf16 v[200:203], a[40:43], v[56:59], v[200:203]
v_exp_f32 v30, v30
v_mfma_f32_16x16x32_bf16 v[232:235], a[40:43], v[60:63], v[232:235]
v_exp_f32 v31, v31
v_mfma_f32_16x16x32_bf16 v[236:239], a[44:47], v[60:63], v[236:239]
ds_read_b128 a[16:19], v1 offset:12288
v_cvt_pk_bf16_f32 v77, v30, v31
v_mfma_f32_16x16x32_bf16 v[204:207], a[44:47], v[56:59], v[204:207]
v_exp_f32 v36, v36
v_mfma_f32_16x16x32_bf16 v[172:175], a[44:47], v[52:55], v[172:175]
ds_read_b128 a[20:23], v1 offset:13312
v_accvgpr_read_b32 v7, a225
v_mfma_f32_16x16x32_bf16 v[176:179], a[48:51], v[52:55], v[176:179]
v_exp_f32 v37, v37
v_mfma_f32_16x16x32_bf16 v[208:211], a[48:51], v[56:59], v[208:211]
ds_read_b128 a[24:27], v1 offset:14336
v_cvt_pk_bf16_f32 v70, v36, v37
v_mfma_f32_16x16x32_bf16 v[240:243], a[48:51], v[60:63], v[240:243]
buffer_load_dwordx4 v3, s[48:51], s32 offen offset:1024 sc1 lds
v_mfma_f32_16x16x32_bf16 v[244:247], a[52:55], v[60:63], v[244:247]
v_exp_f32 v38, v38
v_mfma_f32_16x16x32_bf16 v[212:215], a[52:55], v[56:59], v[212:215]
ds_read_b128 a[28:31], v1 offset:15360
v_add_f32 v6, v6, v7
v_mfma_f32_16x16x32_bf16 v[180:183], a[52:55], v[52:55], v[180:183]
v_exp_f32 v39, v39
v_mfma_f32_16x16x32_bf16 v[184:187], a[56:59], v[52:55], v[184:187]
ds_read_b128 a[32:35], v1 offset:0
v_cvt_pk_bf16_f32 v71, v38, v39
v_mfma_f32_16x16x32_bf16 v[216:219], a[56:59], v[56:59], v[216:219]
v_exp_f32 v40, v40
v_mfma_f32_16x16x32_bf16 v[248:251], a[56:59], v[60:63], v[248:251]
ds_read_b128 a[36:39], v1 offset:1024
v_cmp_nge_f32 vcc, 0x6f800000, v6
v_mfma_f32_16x16x32_bf16 v[252:255], a[60:63], v[60:63], v[252:255]
v_exp_f32 v41, v41
v_mfma_f32_16x16x32_bf16 v[220:223], a[60:63], v[56:59], v[220:223]
v_exp_f32 v42, v42
v_mfma_f32_16x16x32_bf16 v[188:191], a[60:63], v[52:55], v[188:191]
ds_read_b128 a[40:43], v1 offset:2048
v_cvt_pk_bf16_f32 v74, v40, v41
v_mfma_f32_16x16x32_bf16 a[224:227], a[236:239], v[52:55], a[224:227]
buffer_load_dwordx4 v3, s[48:51], s32 offen offset:2048 sc1 lds
v_smfmac_f32_16x16x64_bf16 a[228:231], a[232:235], v[56:63], v9
ds_read_b128 a[44:47], v1 offset:3072
s_waitcnt lgkmcnt(8)
v_mfma_f32_16x16x32_bf16 v[24:27], a[0:3], a[192:195], v[88:91]
v_exp_f32 v43, v43
v_mfma_f32_16x16x32_bf16 v[24:27], a[4:7], a[196:199], v[24:27]
ds_read_b128 a[48:51], v1 offset:4096
v_cvt_pk_bf16_f32 v75, v42, v43
v_mfma_f32_16x16x32_bf16 v[24:27], a[8:11], a[200:203], v[24:27]
v_exp_f32 v44, v44
v_mfma_f32_16x16x32_bf16 v[24:27], a[12:15], a[204:207], v[24:27]
v_exp_f32 v45, v45
v_mfma_f32_16x16x32_bf16 v[28:31], a[0:3], a[208:211], v[92:95]
ds_read_b128 a[52:55], v1 offset:5120
v_cvt_pk_bf16_f32 v78, v44, v45
v_mfma_f32_16x16x32_bf16 v[28:31], a[4:7], a[212:215], v[28:31]
v_exp_f32 v46, v46
v_mfma_f32_16x16x32_bf16 v[28:31], a[8:11], a[216:219], v[28:31]
ds_read_b128 a[56:59], v1 offset:6144
v_mfma_f32_16x16x32_bf16 v[28:31], a[12:15], a[220:223], v[28:31]
s_waitcnt lgkmcnt(7)
v_exp_f32 v47, v47
v_mfma_f32_16x16x32_bf16 v[40:43], a[16:19], a[192:195], v[88:91]
buffer_load_dwordx4 v3, s[48:51], s32 offen offset:3072 sc1 lds
v_mfma_f32_16x16x32_bf16 v[40:43], a[20:23], a[196:199], v[40:43]
ds_read_b128 a[60:63], v1 offset:7168
v_cvt_pk_bf16_f32 v79, v46, v47
v_mfma_f32_16x16x32_bf16 v[40:43], a[24:27], a[200:203], v[40:43]
s_add_u32 s32, s32, 0x8000
v_exp_f32 v24, v24
v_mfma_f32_16x16x32_bf16 v[40:43], a[28:31], a[204:207], v[40:43]
v_exp_f32 v25, v25
v_mfma_f32_16x16x32_bf16 v[44:47], a[16:19], a[208:211], v[92:95]
v_exp_f32 v26, v26
v_mfma_f32_16x16x32_bf16 v[44:47], a[20:23], a[212:215], v[44:47]
v_exp_f32 v27, v27
v_mfma_f32_16x16x32_bf16 v[44:47], a[24:27], a[216:219], v[44:47]
v_exp_f32 v28, v28
v_mfma_f32_16x16x32_bf16 v[44:47], a[28:31], a[220:223], v[44:47]
s_waitcnt lgkmcnt(0)
v_exp_f32 v29, v29
v_mfma_f32_16x16x32_bf16 v[160:163], a[32:35], v[68:71], v[160:163]
ds_read_b128 a[0:3], v1 offset:24576
v_cvt_pk_bf16_f32 v56, v24, v25
v_mfma_f32_16x16x32_bf16 v[192:195], a[32:35], v[72:75], v[192:195]
v_exp_f32 v30, v30
v_mfma_f32_16x16x32_bf16 v[224:227], a[32:35], v[76:79], v[224:227]
ds_read_b128 a[4:7], v1 offset:25600
v_cvt_pk_bf16_f32 v57, v26, v27
v_mfma_f32_16x16x32_bf16 v[228:231], a[36:39], v[76:79], v[228:231]
s_add_u32 m0, s27, 0x1000
v_cvt_pk_bf16_f32 v60, v28, v29
v_mfma_f32_16x16x32_bf16 v[196:199], a[36:39], v[72:75], v[196:199]
buffer_load_dwordx4 v3, s[48:51], s7 offen offset:0 sc1 lds
v_mfma_f32_16x16x32_bf16 v[164:167], a[36:39], v[68:71], v[164:167]
ds_read_b128 a[8:11], v1 offset:26624
v_mfma_f32_16x16x32_bf16 v[168:171], a[40:43], v[68:71], v[168:171]
ds_read_b128 a[12:15], v1 offset:27648
v_mfma_f32_16x16x32_bf16 v[200:203], a[40:43], v[72:75], v[200:203]
v_exp_f32 v31, v31
v_mfma_f32_16x16x32_bf16 v[232:235], a[40:43], v[76:79], v[232:235]
v_exp_f32 v40, v40
v_mfma_f32_16x16x32_bf16 v[236:239], a[44:47], v[76:79], v[236:239]
ds_read_b128 a[16:19], v1 offset:28672
v_cvt_pk_bf16_f32 v61, v30, v31
v_mfma_f32_16x16x32_bf16 v[204:207], a[44:47], v[72:75], v[204:207]
v_exp_f32 v41, v41
v_mfma_f32_16x16x32_bf16 v[172:175], a[44:47], v[68:71], v[172:175]
ds_read_b128 a[20:23], v1 offset:29696
v_cvt_pk_bf16_f32 v58, v40, v41
v_mfma_f32_16x16x32_bf16 v[176:179], a[48:51], v[68:71], v[176:179]
v_rcp_f32 v6, v6
v_mfma_f32_16x16x32_bf16 v[208:211], a[48:51], v[72:75], v[208:211]
buffer_load_dwordx4 v3, s[48:51], s7 offen offset:1024 sc1 lds
v_mfma_f32_16x16x32_bf16 v[240:243], a[48:51], v[76:79], v[240:243]
ds_read_b128 a[24:27], v1 offset:30720
s_or_b64 s[34:35], s[34:35], vcc
v_mfma_f32_16x16x32_bf16 v[244:247], a[52:55], v[76:79], v[244:247]
ds_read_b128 a[28:31], v1 offset:31744
s_add_u32 s8, s28, 0x0
v_mfma_f32_16x16x32_bf16 v[212:215], a[52:55], v[72:75], v[212:215]
v_exp_f32 v42, v42
v_mfma_f32_16x16x32_bf16 v[180:183], a[52:55], v[68:71], v[180:183]
v_exp_f32 v43, v43
v_mfma_f32_16x16x32_bf16 v[184:187], a[56:59], v[68:71], v[184:187]
ds_read_b128 a[32:35], v1 offset:16384
v_cvt_pk_bf16_f32 v59, v42, v43
v_mfma_f32_16x16x32_bf16 v[216:219], a[56:59], v[72:75], v[216:219]
v_exp_f32 v44, v44
v_mfma_f32_16x16x32_bf16 v[248:251], a[56:59], v[76:79], v[248:251]
ds_read_b128 a[36:39], v1 offset:17408
v_mul_f32 v128, v6, v128
v_mfma_f32_16x16x32_bf16 v[252:255], a[60:63], v[76:79], v[252:255]
v_mul_f32 v129, v6, v129
v_mul_f32 v130, v6, v130
v_mfma_f32_16x16x32_bf16 v[220:223], a[60:63], v[72:75], v[220:223]
ds_read_b128 a[40:43], v1 offset:18432
v_mul_f32 v131, v6, v131
v_mfma_f32_16x16x32_bf16 v[188:191], a[60:63], v[68:71], v[188:191]
buffer_load_dwordx4 v3, s[48:51], s7 offen offset:2048 sc1 lds
v_mfma_f32_16x16x32_bf16 a[224:227], a[236:239], v[68:71], a[224:227]
ds_read_b128 a[44:47], v1 offset:19456
v_mul_f32 v132, v6, v132
v_smfmac_f32_16x16x64_bf16 a[228:231], a[232:235], v[72:79], v9
s_waitcnt lgkmcnt(8)
v_exp_f32 v45, v45
v_mfma_f32_16x16x32_bf16 v[24:27], a[0:3], a[192:195], v[88:91]
v_exp_f32 v46, v46
v_mfma_f32_16x16x32_bf16 v[24:27], a[4:7], a[196:199], v[24:27]
ds_read_b128 a[48:51], v1 offset:20480
v_cvt_pk_bf16_f32 v62, v44, v45
v_mfma_f32_16x16x32_bf16 v[24:27], a[8:11], a[200:203], v[24:27]
v_exp_f32 v47, v47
v_mfma_f32_16x16x32_bf16 v[24:27], a[12:15], a[204:207], v[24:27]
ds_read_b128 a[52:55], v1 offset:21504
v_cvt_pk_bf16_f32 v63, v46, v47
v_mfma_f32_16x16x32_bf16 v[28:31], a[0:3], a[208:211], v[92:95]
v_mul_f32 v133, v6, v133
v_mul_f32 v134, v6, v134
v_mfma_f32_16x16x32_bf16 v[28:31], a[4:7], a[212:215], v[28:31]
ds_read_b128 a[56:59], v1 offset:22528
v_mul_f32 v135, v6, v135
v_mfma_f32_16x16x32_bf16 v[28:31], a[8:11], a[216:219], v[28:31]
buffer_load_dwordx4 v3, s[48:51], s7 offen offset:3072 sc1 lds
v_mfma_f32_16x16x32_bf16 v[28:31], a[12:15], a[220:223], v[28:31]
ds_read_b128 a[60:63], v1 offset:23552
s_waitcnt lgkmcnt(8)
v_mfma_f32_16x16x32_bf16 v[40:43], a[16:19], a[192:195], v[88:91]
s_add_u32 s7, s7, 0x8000
v_xor_b32 v1, 0x8000, v1
v_cvt_pk_bf16_f32 v128, v128, v129
v_mfma_f32_16x16x32_bf16 v[40:43], a[20:23], a[196:199], v[40:43]
s_xor_b32 s27, s27, 0x38000
v_exp_f32 v24, v24
v_mfma_f32_16x16x32_bf16 v[40:43], a[24:27], a[200:203], v[40:43]
v_exp_f32 v25, v25
v_mfma_f32_16x16x32_bf16 v[40:43], a[28:31], a[204:207], v[40:43]
v_exp_f32 v26, v26
v_mfma_f32_16x16x32_bf16 v[44:47], a[16:19], a[208:211], v[92:95]
v_exp_f32 v27, v27
v_mfma_f32_16x16x32_bf16 v[44:47], a[20:23], a[212:215], v[44:47]
v_exp_f32 v28, v28
v_mfma_f32_16x16x32_bf16 v[44:47], a[24:27], a[216:219], v[44:47]
s_waitcnt vmcnt(19) lgkmcnt(0)
v_exp_f32 v29, v29
v_mfma_f32_16x16x32_bf16 v[44:47], a[28:31], a[220:223], v[44:47]
s_barrier
v_cvt_pk_bf16_f32 v129, v130, v131
v_cvt_pk_bf16_f32 v130, v132, v133
v_cvt_pk_bf16_f32 v131, v134, v135
buffer_store_dwordx4 v[128:131], v3, s[88:91], s8 offen sc1
s_add_u32 s8, s28, 0x2000
v_mul_f32 v136, v6, v136
v_mul_f32 v137, v6, v137
v_mul_f32 v138, v6, v138
v_mul_f32 v139, v6, v139
v_mul_f32 v140, v6, v140
v_mul_f32 v141, v6, v141
v_mul_f32 v142, v6, v142
v_mul_f32 v143, v6, v143
v_cvt_pk_bf16_f32 v136, v136, v137
v_cvt_pk_bf16_f32 v137, v138, v139
v_cvt_pk_bf16_f32 v138, v140, v141
v_cvt_pk_bf16_f32 v139, v142, v143
buffer_store_dwordx4 v[136:139], v3, s[88:91], s8 offen sc1
s_add_u32 s8, s28, 0x4000
v_mul_f32 v144, v6, v144
v_mul_f32 v145, v6, v145
v_mul_f32 v146, v6, v146
v_mul_f32 v147, v6, v147
v_mul_f32 v148, v6, v148
v_mul_f32 v149, v6, v149
v_mul_f32 v150, v6, v150
v_mul_f32 v151, v6, v151
v_cvt_pk_bf16_f32 v144, v144, v145
v_cvt_pk_bf16_f32 v145, v146, v147
v_cvt_pk_bf16_f32 v146, v148, v149
v_cvt_pk_bf16_f32 v147, v150, v151
buffer_store_dwordx4 v[144:147], v3, s[88:91], s8 offen sc1
s_add_u32 s8, s28, 0x6000
v_mul_f32 v152, v6, v152
v_mul_f32 v153, v6, v153
v_mul_f32 v154, v6, v154
v_mul_f32 v155, v6, v155
v_mul_f32 v156, v6, v156
v_mul_f32 v157, v6, v157
v_mul_f32 v158, v6, v158
v_mul_f32 v159, v6, v159
v_cvt_pk_bf16_f32 v152, v152, v153
v_cvt_pk_bf16_f32 v153, v154, v155
v_cvt_pk_bf16_f32 v154, v156, v157
v_cvt_pk_bf16_f32 v155, v158, v159
buffer_store_dwordx4 v[152:155], v3, s[88:91], s8 offen sc1
v_accvgpr_read_b32 v6, a226
v_accvgpr_read_b32 v7, a227
v_add_f32 v6, v6, v7
v_cmp_nge_f32 vcc, 0x6f800000, v6
v_rcp_f32 v6, v6
s_or_b64 s[34:35], s[34:35], vcc
s_add_u32 s8, s29, 0x0
v_pk_mul_f32 v[160:161], v[160:161], v[6:7] op_sel_hi:[1,0]
v_pk_mul_f32 v[162:163], v[162:163], v[6:7] op_sel_hi:[1,0]
v_pk_mul_f32 v[164:165], v[164:165], v[6:7] op_sel_hi:[1,0]
v_pk_mul_f32 v[166:167], v[166:167], v[6:7] op_sel_hi:[1,0]
v_cvt_pk_bf16_f32 v160, v160, v161
v_cvt_pk_bf16_f32 v161, v162, v163
v_cvt_pk_bf16_f32 v162, v164, v165
v_cvt_pk_bf16_f32 v163, v166, v167
buffer_store_dwordx4 v[160:163], v3, s[88:91], s8 offen sc1
s_add_u32 s8, s29, 0x2000
v_pk_mul_f32 v[168:169], v[168:169], v[6:7] op_sel_hi:[1,0]
v_pk_mul_f32 v[170:171], v[170:171], v[6:7] op_sel_hi:[1,0]
v_pk_mul_f32 v[172:173], v[172:173], v[6:7] op_sel_hi:[1,0]
v_pk_mul_f32 v[174:175], v[174:175], v[6:7] op_sel_hi:[1,0]
v_cvt_pk_bf16_f32 v168, v168, v169
v_cvt_pk_bf16_f32 v169, v170, v171
v_cvt_pk_bf16_f32 v170, v172, v173
v_cvt_pk_bf16_f32 v171, v174, v175
buffer_store_dwordx4 v[168:171], v3, s[88:91], s8 offen sc1
s_add_u32 s8, s29, 0x4000
v_pk_mul_f32 v[176:177], v[176:177], v[6:7] op_sel_hi:[1,0]
v_pk_mul_f32 v[178:179], v[178:179], v[6:7] op_sel_hi:[1,0]
v_pk_mul_f32 v[180:181], v[180:181], v[6:7] op_sel_hi:[1,0]
v_pk_mul_f32 v[182:183], v[182:183], v[6:7] op_sel_hi:[1,0]
v_cvt_pk_bf16_f32 v176, v176, v177
v_cvt_pk_bf16_f32 v177, v178, v179
v_cvt_pk_bf16_f32 v178, v180, v181
v_cvt_pk_bf16_f32 v179, v182, v183
buffer_store_dwordx4 v[176:179], v3, s[88:91], s8 offen sc1
s_add_u32 s8, s29, 0x6000
v_pk_mul_f32 v[184:185], v[184:185], v[6:7] op_sel_hi:[1,0]
v_pk_mul_f32 v[186:187], v[186:187], v[6:7] op_sel_hi:[1,0]
v_pk_mul_f32 v[188:189], v[188:189], v[6:7] op_sel_hi:[1,0]
v_pk_mul_f32 v[190:191], v[190:191], v[6:7] op_sel_hi:[1,0]
v_cvt_pk_bf16_f32 v184, v184, v185
v_cvt_pk_bf16_f32 v185, v186, v187
v_cvt_pk_bf16_f32 v186, v188, v189
v_cvt_pk_bf16_f32 v187, v190, v191
buffer_store_dwordx4 v[184:187], v3, s[88:91], s8 offen sc1
s_getreg_b32 s8, hwreg(HW_REG_HW_ID, 5, 1)
s_cmp_lg_u32 s8, 0
s_cbranch_scc1 L_att_sodd1
s_branch L_att_sodd0
L_att_lh0_0:
v_mfma_f32_16x16x32_bf16 v[160:163], a[32:35], v[52:55], v[160:163]
v_exp_f32 v28, v28
v_mfma_f32_16x16x32_bf16 v[192:195], a[32:35], v[56:59], v[192:195]
buffer_load_dword v14, v15, s[84:87], 0 offen offset:192 sc1
v_mfma_f32_16x16x32_bf16 v[224:227], a[32:35], v[60:63], v[224:227]
v_exp_f32 v29, v29
v_mfma_f32_16x16x32_bf16 v[228:231], a[36:39], v[60:63], v[228:231]
v_exp_f32 v30, v30
v_mfma_f32_16x16x32_bf16 v[196:199], a[36:39], v[56:59], v[196:199]
s_add_u32 m0, s17, 0x10000
v_exp_f32 v31, v31
v_mfma_f32_16x16x32_bf16 v[164:167], a[36:39], v[52:55], v[164:167]
ds_read_b128 a[0:3], v1 offset:8192
v_cvt_pk_bf16_f32 v72, v24, v25
v_mfma_f32_16x16x32_bf16 v[168:171], a[40:43], v[52:55], v[168:171]
ds_read_b128 a[4:7], v1 offset:9216
v_cvt_pk_bf16_f32 v73, v26, v27
v_mfma_f32_16x16x32_bf16 v[200:203], a[40:43], v[56:59], v[200:203]
buffer_load_dwordx4 v12, s[72:75], 0 offen lds
v_mfma_f32_16x16x32_bf16 v[232:235], a[40:43], v[60:63], v[232:235]
ds_read_b128 a[8:11], v1 offset:10240
v_cvt_pk_bf16_f32 v76, v28, v29
v_mfma_f32_16x16x32_bf16 v[236:239], a[44:47], v[60:63], v[236:239]
v_exp_f32 v36, v36
v_mfma_f32_16x16x32_bf16 v[204:207], a[44:47], v[56:59], v[204:207]
v_exp_f32 v37, v37
v_mfma_f32_16x16x32_bf16 v[172:175], a[44:47], v[52:55], v[172:175]
ds_read_b128 a[12:15], v1 offset:11264
v_cvt_pk_bf16_f32 v77, v30, v31
v_mfma_f32_16x16x32_bf16 v[176:179], a[48:51], v[52:55], v[176:179]
buffer_load_dwordx4 v13, s[72:75], 0 offen offset:1024 lds
v_mfma_f32_16x16x32_bf16 v[208:211], a[48:51], v[56:59], v[208:211]
ds_read_b128 a[16:19], v1 offset:12288
v_cvt_pk_bf16_f32 v70, v36, v37
v_mfma_f32_16x16x32_bf16 v[240:243], a[48:51], v[60:63], v[240:243]
ds_read_b128 a[20:23], v1 offset:13312
v_exp_f32 v38, v38
v_mfma_f32_16x16x32_bf16 v[244:247], a[52:55], v[60:63], v[244:247]
ds_read_b128 a[24:27], v1 offset:14336
v_exp_f32 v39, v39
v_mfma_f32_16x16x32_bf16 v[212:215], a[52:55], v[56:59], v[212:215]
v_exp_f32 v40, v40
v_mfma_f32_16x16x32_bf16 v[180:183], a[52:55], v[52:55], v[180:183]
buffer_load_dwordx4 v12, s[72:75], s12 offen offset:2048 lds
v_mfma_f32_16x16x32_bf16 v[184:187], a[56:59], v[52:55], v[184:187]
ds_read_b128 a[28:31], v1 offset:15360
v_exp_f32 v41, v41
v_mfma_f32_16x16x32_bf16 v[216:219], a[56:59], v[56:59], v[216:219]
buffer_load_dwordx4 v13, s[72:75], s12 offen offset:3072 lds
v_mfma_f32_16x16x32_bf16 v[248:251], a[56:59], v[60:63], v[248:251]
s_add_u32 m0, s17, 0x14000
v_exp_f32 v42, v42
v_mfma_f32_16x16x32_bf16 v[252:255], a[60:63], v[60:63], v[252:255]
ds_read_b128 a[32:35], v1 offset:0
v_cvt_pk_bf16_f32 v71, v38, v39
v_mfma_f32_16x16x32_bf16 v[220:223], a[60:63], v[56:59], v[220:223]
ds_read_b128 a[36:39], v1 offset:1024
v_add_u32 v12, 0x20000, v12
v_mfma_f32_16x16x32_bf16 v[188:191], a[60:63], v[52:55], v[188:191]
buffer_load_dwordx4 v12, s[72:75], 0 offen lds
v_mfma_f32_16x16x32_bf16 a[224:227], a[236:239], v[52:55], a[224:227]
ds_read_b128 a[40:43], v1 offset:2048
v_exp_f32 v43, v43
v_smfmac_f32_16x16x64_bf16 a[228:231], a[232:235], v[56:63], v9
s_waitcnt lgkmcnt(7)
v_exp_f32 v44, v44
v_mfma_f32_16x16x32_bf16 v[24:27], a[0:3], a[192:195], v[112:115]
ds_read_b128 a[44:47], v1 offset:3072
v_exp_f32 v45, v45
v_mfma_f32_16x16x32_bf16 v[24:27], a[4:7], a[196:199], v[24:27]
ds_read_b128 a[48:51], v1 offset:4096
v_add_u32 v13, 0x20000, v13
v_mfma_f32_16x16x32_bf16 v[24:27], a[8:11], a[200:203], v[24:27]
v_exp_f32 v46, v46
v_mfma_f32_16x16x32_bf16 v[24:27], a[12:15], a[204:207], v[24:27]
buffer_load_dwordx4 v13, s[72:75], 0 offen offset:1024 lds
v_mfma_f32_16x16x32_bf16 v[28:31], a[0:3], a[208:211], v[92:95]
v_exp_f32 v47, v47
v_mfma_f32_16x16x32_bf16 v[28:31], a[4:7], a[212:215], v[28:31]
ds_read_b128 a[52:55], v1 offset:5120
v_cvt_pk_bf16_f32 v74, v40, v41
v_mfma_f32_16x16x32_bf16 v[28:31], a[8:11], a[216:219], v[28:31]
ds_read_b128 a[56:59], v1 offset:6144
v_cvt_pk_bf16_f32 v75, v42, v43
v_mfma_f32_16x16x32_bf16 v[28:31], a[12:15], a[220:223], v[28:31]
s_waitcnt lgkmcnt(7)
v_exp_f32 v24, v24
v_mfma_f32_16x16x32_bf16 v[40:43], a[16:19], a[192:195], v[116:119]
buffer_load_dwordx4 v12, s[72:75], s12 offen offset:2048 lds
v_mfma_f32_16x16x32_bf16 v[40:43], a[20:23], a[196:199], v[40:43]
ds_read_b128 a[60:63], v1 offset:7168
v_cvt_pk_bf16_f32 v78, v44, v45
v_mfma_f32_16x16x32_bf16 v[40:43], a[24:27], a[200:203], v[40:43]
v_exp_f32 v25, v25
v_mfma_f32_16x16x32_bf16 v[40:43], a[28:31], a[204:207], v[40:43]
buffer_load_dwordx4 v13, s[72:75], s12 offen offset:3072 lds
v_cvt_pk_bf16_f32 v79, v46, v47
v_mfma_f32_16x16x32_bf16 v[44:47], a[16:19], a[208:211], v[92:95]
v_exp_f32 v26, v26
v_mfma_f32_16x16x32_bf16 v[44:47], a[20:23], a[212:215], v[44:47]
v_exp_f32 v27, v27
v_mfma_f32_16x16x32_bf16 v[44:47], a[24:27], a[216:219], v[44:47]
v_exp_f32 v28, v28
v_mfma_f32_16x16x32_bf16 v[44:47], a[28:31], a[220:223], v[44:47]
s_waitcnt lgkmcnt(0)
v_exp_f32 v29, v29
v_mfma_f32_16x16x32_bf16 v[160:163], a[32:35], v[68:71], v[160:163]
ds_read_b128 a[0:3], v1 offset:24576
v_cvt_pk_bf16_f32 v56, v24, v25
v_mfma_f32_16x16x32_bf16 v[192:195], a[32:35], v[72:75], v[192:195]
ds_read_b128 a[4:7], v1 offset:25600
v_add_u32 v12, 0x20000, v12
v_mfma_f32_16x16x32_bf16 v[224:227], a[32:35], v[76:79], v[224:227]
s_add_u32 m0, s16, 0x0
v_exp_f32 v30, v30
v_mfma_f32_16x16x32_bf16 v[228:231], a[36:39], v[76:79], v[228:231]
buffer_load_dwordx4 v12, s[72:75], 0 offen lds
v_mfma_f32_16x16x32_bf16 v[196:199], a[36:39], v[72:75], v[196:199]
ds_read_b128 a[8:11], v1 offset:26624
v_add_u32 v13, 0x20000, v13
v_mfma_f32_16x16x32_bf16 v[164:167], a[36:39], v[68:71], v[164:167]
buffer_load_dwordx4 v13, s[72:75], 0 offen offset:1024 lds
v_mfma_f32_16x16x32_bf16 v[168:171], a[40:43], v[68:71], v[168:171]
ds_read_b128 a[12:15], v1 offset:27648
v_cvt_pk_bf16_f32 v57, v26, v27
v_mfma_f32_16x16x32_bf16 v[200:203], a[40:43], v[72:75], v[200:203]
v_exp_f32 v31, v31
v_mfma_f32_16x16x32_bf16 v[232:235], a[40:43], v[76:79], v[232:235]
ds_read_b128 a[16:19], v1 offset:28672
v_cvt_pk_bf16_f32 v60, v28, v29
v_mfma_f32_16x16x32_bf16 v[236:239], a[44:47], v[76:79], v[236:239]
buffer_load_dwordx4 v12, s[72:75], s12 offen offset:2048 lds
v_mfma_f32_16x16x32_bf16 v[204:207], a[44:47], v[72:75], v[204:207]
ds_read_b128 a[20:23], v1 offset:29696
v_cvt_pk_bf16_f32 v61, v30, v31
v_mfma_f32_16x16x32_bf16 v[172:175], a[44:47], v[68:71], v[172:175]
buffer_load_dwordx4 v13, s[72:75], s12 offen offset:3072 lds
v_mfma_f32_16x16x32_bf16 v[176:179], a[48:51], v[68:71], v[176:179]
ds_read_b128 a[24:27], v1 offset:30720
v_mfma_f32_16x16x32_bf16 v[208:211], a[48:51], v[72:75], v[208:211]
ds_read_b128 a[28:31], v1 offset:31744
v_mfma_f32_16x16x32_bf16 v[240:243], a[48:51], v[76:79], v[240:243]
v_exp_f32 v40, v40
v_mfma_f32_16x16x32_bf16 v[244:247], a[52:55], v[76:79], v[244:247]
s_add_u32 m0, s16, 0x4000
v_exp_f32 v41, v41
v_mfma_f32_16x16x32_bf16 v[212:215], a[52:55], v[72:75], v[212:215]
ds_read_b128 a[32:35], v1 offset:16384
v_cvt_pk_bf16_f32 v58, v40, v41
v_mfma_f32_16x16x32_bf16 v[180:183], a[52:55], v[68:71], v[180:183]
ds_read_b128 a[36:39], v1 offset:17408
v_add_u32 v12, 0x20000, v12
v_mfma_f32_16x16x32_bf16 v[184:187], a[56:59], v[68:71], v[184:187]
buffer_load_dwordx4 v12, s[72:75], 0 offen lds
v_mfma_f32_16x16x32_bf16 v[216:219], a[56:59], v[72:75], v[216:219]
ds_read_b128 a[40:43], v1 offset:18432
v_mfma_f32_16x16x32_bf16 v[248:251], a[56:59], v[76:79], v[248:251]
v_exp_f32 v42, v42
v_mfma_f32_16x16x32_bf16 v[252:255], a[60:63], v[76:79], v[252:255]
ds_read_b128 a[44:47], v1 offset:19456
v_add_u32 v13, 0x20000, v13
v_mfma_f32_16x16x32_bf16 v[220:223], a[60:63], v[72:75], v[220:223]
buffer_load_dwordx4 v13, s[72:75], 0 offen offset:1024 lds
v_mfma_f32_16x16x32_bf16 v[188:191], a[60:63], v[68:71], v[188:191]
ds_read_b128 a[48:51], v1 offset:20480
v_exp_f32 v43, v43
v_mfma_f32_16x16x32_bf16 a[224:227], a[236:239], v[68:71], a[224:227]
s_waitcnt lgkmcnt(9)
v_exp_f32 v44, v44
v_smfmac_f32_16x16x64_bf16 a[228:231], a[232:235], v[72:79], v9
ds_read_b128 a[52:55], v1 offset:21504
v_exp_f32 v45, v45
v_mfma_f32_16x16x32_bf16 v[28:31], a[0:3], a[208:211], v[92:95]
buffer_load_dwordx4 v12, s[72:75], s12 offen offset:2048 lds
v_mfma_f32_16x16x32_bf16 v[28:31], a[4:7], a[212:215], v[28:31]
ds_read_b128 a[56:59], v1 offset:22528
v_exp_f32 v46, v46
v_mfma_f32_16x16x32_bf16 v[28:31], a[8:11], a[216:219], v[28:31]
ds_read_b128 a[60:63], v1 offset:23552
v_xor_b32 v1, 0x8000, v1
v_mfma_f32_16x16x32_bf16 v[28:31], a[12:15], a[220:223], v[28:31]
s_waitcnt lgkmcnt(8)
v_exp_f32 v47, v47
v_cvt_pk_bf16_f32 v62, v44, v45
v_cvt_pk_bf16_f32 v63, v46, v47
v_mfma_f32_16x16x32_bf16 v[44:47], a[16:19], a[208:211], v[92:95]
buffer_load_dwordx4 v13, s[72:75], s12 offen offset:3072 lds
v_mfma_f32_16x16x32_bf16 v[44:47], a[20:23], a[212:215], v[44:47]
v_cvt_pk_bf16_f32 v59, v42, v43
v_mfma_f32_16x16x32_bf16 v[44:47], a[24:27], a[216:219], v[44:47]
v_mfma_f32_16x16x32_bf16 v[44:47], a[28:31], a[220:223], v[44:47]
v_accvgpr_read_b32 v6, a224
v_accvgpr_read_b32 v7, a225
v_add_f32 v6, v6, v7
v_cmp_nge_f32 vcc, 0x6f800000, v6
v_rcp_f32 v6, v6
s_or_b64 s[34:35], s[34:35], vcc
s_add_u32 s8, s28, 0x0
v_pk_mul_f32 v[128:129], v[128:129], v[6:7] op_sel_hi:[1,0]
v_pk_mul_f32 v[130:131], v[130:131], v[6:7] op_sel_hi:[1,0]
v_pk_mul_f32 v[132:133], v[132:133], v[6:7] op_sel_hi:[1,0]
v_pk_mul_f32 v[134:135], v[134:135], v[6:7] op_sel_hi:[1,0]
v_cvt_pk_bf16_f32 v128, v128, v129
v_cvt_pk_bf16_f32 v129, v130, v131
v_cvt_pk_bf16_f32 v130, v132, v133
v_cvt_pk_bf16_f32 v131, v134, v135
buffer_store_dwordx4 v[128:131], v3, s[88:91], s8 offen sc1
s_add_u32 s8, s28, 0x2000
v_pk_mul_f32 v[136:137], v[136:137], v[6:7] op_sel_hi:[1,0]
v_pk_mul_f32 v[138:139], v[138:139], v[6:7] op_sel_hi:[1,0]
v_pk_mul_f32 v[140:141], v[140:141], v[6:7] op_sel_hi:[1,0]
v_pk_mul_f32 v[142:143], v[142:143], v[6:7] op_sel_hi:[1,0]
v_cvt_pk_bf16_f32 v136, v136, v137
v_cvt_pk_bf16_f32 v137, v138, v139
v_cvt_pk_bf16_f32 v138, v140, v141
v_cvt_pk_bf16_f32 v139, v142, v143
buffer_store_dwordx4 v[136:139], v3, s[88:91], s8 offen sc1
s_add_u32 s8, s28, 0x4000
v_pk_mul_f32 v[144:145], v[144:145], v[6:7] op_sel_hi:[1,0]
v_pk_mul_f32 v[146:147], v[146:147], v[6:7] op_sel_hi:[1,0]
v_pk_mul_f32 v[148:149], v[148:149], v[6:7] op_sel_hi:[1,0]
v_pk_mul_f32 v[150:151], v[150:151], v[6:7] op_sel_hi:[1,0]
v_cvt_pk_bf16_f32 v144, v144, v145
v_cvt_pk_bf16_f32 v145, v146, v147
v_cvt_pk_bf16_f32 v146, v148, v149
v_cvt_pk_bf16_f32 v147, v150, v151
buffer_store_dwordx4 v[144:147], v3, s[88:91], s8 offen sc1
s_add_u32 s8, s28, 0x6000
v_pk_mul_f32 v[152:153], v[152:153], v[6:7] op_sel_hi:[1,0]
v_pk_mul_f32 v[154:155], v[154:155], v[6:7] op_sel_hi:[1,0]
v_pk_mul_f32 v[156:157], v[156:157], v[6:7] op_sel_hi:[1,0]
v_pk_mul_f32 v[158:159], v[158:159], v[6:7] op_sel_hi:[1,0]
v_cvt_pk_bf16_f32 v152, v152, v153
v_cvt_pk_bf16_f32 v153, v154, v155
v_cvt_pk_bf16_f32 v154, v156, v157
v_cvt_pk_bf16_f32 v155, v158, v159
buffer_store_dwordx4 v[152:155], v3, s[88:91], s8 offen sc1
v_accvgpr_read_b32 v6, a226
v_accvgpr_read_b32 v7, a227
v_add_f32 v6, v6, v7
v_cmp_nge_f32 vcc, 0x6f800000, v6
v_rcp_f32 v6, v6
s_or_b64 s[34:35], s[34:35], vcc
s_add_u32 s8, s29, 0x0
v_pk_mul_f32 v[160:161], v[160:161], v[6:7] op_sel_hi:[1,0]
v_pk_mul_f32 v[162:163], v[162:163], v[6:7] op_sel_hi:[1,0]
v_pk_mul_f32 v[164:165], v[164:165], v[6:7] op_sel_hi:[1,0]
v_pk_mul_f32 v[166:167], v[166:167], v[6:7] op_sel_hi:[1,0]
v_cvt_pk_bf16_f32 v160, v160, v161
v_cvt_pk_bf16_f32 v161, v162, v163
v_cvt_pk_bf16_f32 v162, v164, v165
v_cvt_pk_bf16_f32 v163, v166, v167
buffer_store_dwordx4 v[160:163], v3, s[88:91], s8 offen sc1
s_add_u32 s8, s29, 0x2000
v_pk_mul_f32 v[168:169], v[168:169], v[6:7] op_sel_hi:[1,0]
v_pk_mul_f32 v[170:171], v[170:171], v[6:7] op_sel_hi:[1,0]
v_pk_mul_f32 v[172:173], v[172:173], v[6:7] op_sel_hi:[1,0]
v_pk_mul_f32 v[174:175], v[174:175], v[6:7] op_sel_hi:[1,0]
v_cvt_pk_bf16_f32 v168, v168, v169
v_cvt_pk_bf16_f32 v169, v170, v171
v_cvt_pk_bf16_f32 v170, v172, v173
v_cvt_pk_bf16_f32 v171, v174, v175
buffer_store_dwordx4 v[168:171], v3, s[88:91], s8 offen sc1
s_add_u32 s8, s29, 0x4000
v_pk_mul_f32 v[176:177], v[176:177], v[6:7] op_sel_hi:[1,0]
v_pk_mul_f32 v[178:179], v[178:179], v[6:7] op_sel_hi:[1,0]
v_pk_mul_f32 v[180:181], v[180:181], v[6:7] op_sel_hi:[1,0]
v_pk_mul_f32 v[182:183], v[182:183], v[6:7] op_sel_hi:[1,0]
v_cvt_pk_bf16_f32 v176, v176, v177
v_cvt_pk_bf16_f32 v177, v178, v179
v_cvt_pk_bf16_f32 v178, v180, v181
v_cvt_pk_bf16_f32 v179, v182, v183
buffer_store_dwordx4 v[176:179], v3, s[88:91], s8 offen sc1
s_add_u32 s8, s29, 0x6000
v_pk_mul_f32 v[184:185], v[184:185], v[6:7] op_sel_hi:[1,0]
v_pk_mul_f32 v[186:187], v[186:187], v[6:7] op_sel_hi:[1,0]
v_pk_mul_f32 v[188:189], v[188:189], v[6:7] op_sel_hi:[1,0]
v_pk_mul_f32 v[190:191], v[190:191], v[6:7] op_sel_hi:[1,0]
v_cvt_pk_bf16_f32 v184, v184, v185
v_cvt_pk_bf16_f32 v185, v186, v187
v_cvt_pk_bf16_f32 v186, v188, v189
v_cvt_pk_bf16_f32 v187, v190, v191
buffer_store_dwordx4 v[184:187], v3, s[88:91], s8 offen sc1
s_branch L_att_h1_0
L_att_dl0_1:
v_mfma_f32_16x16x32_bf16 v[128:131], a[32:35], v[48:51], v[128:131]
ds_read_b128 a[0:3], v1 offset:8192
v_cvt_pk_bf16_f32 v72, v24, v25
v_mfma_f32_16x16x32_bf16 v[160:163], a[32:35], v[52:55], v[160:163]
v_exp_f32 v28, v28
v_mfma_f32_16x16x32_bf16 v[192:195], a[32:35], v[56:59], v[192:195]
v_cvt_pk_bf16_f32 v73, v26, v27
v_mfma_f32_16x16x32_bf16 v[224:227], a[32:35], v[60:63], v[224:227]
ds_read_b128 a[4:7], v1 offset:9216
v_mfma_f32_16x16x32_bf16 v[228:231], a[36:39], v[60:63], v[228:231]
s_add_u32 m0, s27, 0x0
v_exp_f32 v29, v29
v_mfma_f32_16x16x32_bf16 v[196:199], a[36:39], v[56:59], v[196:199]
buffer_load_dwordx4 v3, s[48:51], s32 offen offset:0 sc1 lds
v_mfma_f32_16x16x32_bf16 v[164:167], a[36:39], v[52:55], v[164:167]
v_exp_f32 v30, v30
v_mfma_f32_16x16x32_bf16 v[132:135], a[36:39], v[48:51], v[132:135]
ds_read_b128 a[8:11], v1 offset:10240
v_cvt_pk_bf16_f32 v76, v28, v29
v_mfma_f32_16x16x32_bf16 v[136:139], a[40:43], v[48:51], v[136:139]
v_mfma_f32_16x16x32_bf16 v[168:171], a[40:43], v[52:55], v[168:171]
v_exp_f32 v31, v31
v_mfma_f32_16x16x32_bf16 v[200:203], a[40:43], v[56:59], v[200:203]
v_exp_f32 v32, v32
v_mfma_f32_16x16x32_bf16 v[232:235], a[40:43], v[60:63], v[232:235]
ds_read_b128 a[12:15], v1 offset:11264
v_cvt_pk_bf16_f32 v77, v30, v31
v_mfma_f32_16x16x32_bf16 v[236:239], a[44:47], v[60:63], v[236:239]
v_exp_f32 v33, v33
v_mfma_f32_16x16x32_bf16 v[204:207], a[44:47], v[56:59], v[204:207]
v_cvt_pk_bf16_f32 v66, v32, v33
v_mfma_f32_16x16x32_bf16 v[172:175], a[44:47], v[52:55], v[172:175]
s_mov_b32 s9, 0x0
v_exp_f32 v34, v34
v_mfma_f32_16x16x32_bf16 v[140:143], a[44:47], v[48:51], v[140:143]
ds_read_b128 a[16:19], v1 offset:12288
v_mfma_f32_16x16x32_bf16 v[144:147], a[48:51], v[48:51], v[144:147]
buffer_load_dword a244, v8, s[72:75], s9 offen
v_mfma_f32_16x16x32_bf16 v[176:179], a[48:51], v[52:55], v[176:179]
v_exp_f32 v35, v35
v_mfma_f32_16x16x32_bf16 v[208:211], a[48:51], v[56:59], v[208:211]
v_exp_f32 v36, v36
v_mfma_f32_16x16x32_bf16 v[240:243], a[48:51], v[60:63], v[240:243]
ds_read_b128 a[20:23], v1 offset:13312
v_cvt_pk_bf16_f32 v67, v34, v35
v_mfma_f32_16x16x32_bf16 v[244:247], a[52:55], v[60:63], v[244:247]
v_mfma_f32_16x16x32_bf16 v[212:215], a[52:55], v[56:59], v[212:215]
v_exp_f32 v37, v37
v_mfma_f32_16x16x32_bf16 v[180:183], a[52:55], v[52:55], v[180:183]
ds_read_b128 a[24:27], v1 offset:14336
v_cvt_pk_bf16_f32 v70, v36, v37
v_mfma_f32_16x16x32_bf16 v[148:151], a[52:55], v[48:51], v[148:151]
v_exp_f32 v38, v38
v_mfma_f32_16x16x32_bf16 v[152:155], a[56:59], v[48:51], v[152:155]
v_mfma_f32_16x16x32_bf16 v[184:187], a[56:59], v[52:55], v[184:187]
v_exp_f32 v39, v39
v_mfma_f32_16x16x32_bf16 v[216:219], a[56:59], v[56:59], v[216:219]
buffer_load_dwordx4 v3, s[48:51], s32 offen offset:1024 sc1 lds
v_mfma_f32_16x16x32_bf16 v[248:251], a[56:59], v[60:63], v[248:251]
ds_read_b128 a[28:31], v1 offset:15360
v_cvt_pk_bf16_f32 v71, v38, v39
v_mfma_f32_16x16x32_bf16 v[252:255], a[60:63], v[60:63], v[252:255]
v_exp_f32 v40, v40
v_mfma_f32_16x16x32_bf16 v[220:223], a[60:63], v[56:59], v[220:223]
v_exp_f32 v41, v41
v_mfma_f32_16x16x32_bf16 v[188:191], a[60:63], v[52:55], v[188:191]
ds_read_b128 a[32:35], v1 offset:0
v_cvt_pk_bf16_f32 v74, v40, v41
v_mfma_f32_16x16x32_bf16 v[156:159], a[60:63], v[48:51], v[156:159]
v_smfmac_f32_16x16x64_bf16 a[224:227], a[232:235], v[48:55], v9
v_exp_f32 v42, v42
v_smfmac_f32_16x16x64_bf16 a[228:231], a[232:235], v[56:63], v9
s_waitcnt lgkmcnt(5)
v_exp_f32 v43, v43
v_mfma_f32_16x16x32_bf16 v[16:19], a[0:3], a[160:163], v[80:83]
ds_read_b128 a[36:39], v1 offset:1024
v_cvt_pk_bf16_f32 v75, v42, v43
v_mfma_f32_16x16x32_bf16 v[16:19], a[4:7], a[164:167], v[16:19]
v_exp_f32 v44, v44
v_mfma_f32_16x16x32_bf16 v[16:19], a[8:11], a[168:171], v[16:19]
v_mfma_f32_16x16x32_bf16 v[16:19], a[12:15], a[172:175], v[16:19]
buffer_load_dwordx4 v3, s[48:51], s32 offen offset:2048 sc1 lds
v_mfma_f32_16x16x32_bf16 v[20:23], a[0:3], a[176:179], v[84:87]
ds_read_b128 a[40:43], v1 offset:2048
v_mfma_f32_16x16x32_bf16 v[20:23], a[4:7], a[180:183], v[20:23]
v_exp_f32 v45, v45
v_mfma_f32_16x16x32_bf16 v[20:23], a[8:11], a[184:187], v[20:23]
v_exp_f32 v46, v46
v_mfma_f32_16x16x32_bf16 v[20:23], a[12:15], a[188:191], v[20:23]
ds_read_b128 a[44:47], v1 offset:3072
v_cvt_pk_bf16_f32 v78, v44, v45
v_mfma_f32_16x16x32_bf16 v[24:27], a[0:3], a[192:195], v[88:91]
v_mfma_f32_16x16x32_bf16 v[24:27], a[4:7], a[196:199], v[24:27]
v_exp_f32 v47, v47
v_mfma_f32_16x16x32_bf16 v[24:27], a[8:11], a[200:203], v[24:27]
v_exp_f32 v16, v16
v_mfma_f32_16x16x32_bf16 v[24:27], a[12:15], a[204:207], v[24:27]
ds_read_b128 a[48:51], v1 offset:4096
v_cvt_pk_bf16_f32 v79, v46, v47
v_mfma_f32_16x16x32_bf16 v[28:31], a[0:3], a[208:211], v[92:95]
v_exp_f32 v17, v17
v_mfma_f32_16x16x32_bf16 v[28:31], a[4:7], a[212:215], v[28:31]
s_waitcnt lgkmcnt(5)
v_cvt_pk_bf16_f32 v48, v16, v17
v_mfma_f32_16x16x32_bf16 v[28:31], a[8:11], a[216:219], v[28:31]
buffer_load_dwordx4 v3, s[48:51], s32 offen offset:3072 sc1 lds
v_mfma_f32_16x16x32_bf16 v[28:31], a[12:15], a[220:223], v[28:31]
ds_read_b128 a[52:55], v1 offset:5120
v_mfma_f32_16x16x32_bf16 v[32:35], a[16:19], a[160:163], v[80:83]
v_exp_f32 v18, v18
v_mfma_f32_16x16x32_bf16 v[32:35], a[20:23], a[164:167], v[32:35]
v_exp_f32 v19, v19
v_mfma_f32_16x16x32_bf16 v[32:35], a[24:27], a[168:171], v[32:35]
v_exp_f32 v20, v20
v_mfma_f32_16x16x32_bf16 v[32:35], a[28:31], a[172:175], v[32:35]
ds_read_b128 a[56:59], v1 offset:6144
v_cvt_pk_bf16_f32 v49, v18, v19
v_mfma_f32_16x16x32_bf16 v[36:39], a[16:19], a[176:179], v[84:87]
v_mfma_f32_16x16x32_bf16 v[36:39], a[20:23], a[180:183], v[36:39]
v_exp_f32 v21, v21
v_mfma_f32_16x16x32_bf16 v[36:39], a[24:27], a[184:187], v[36:39]
s_mov_b32 s9, 0x0
v_exp_f32 v22, v22
v_mfma_f32_16x16x32_bf16 v[36:39], a[28:31], a[188:191], v[36:39]
ds_read_b128 a[60:63], v1 offset:7168
v_cvt_pk_bf16_f32 v52, v20, v21
v_mfma_f32_16x16x32_bf16 v[40:43], a[16:19], a[192:195], v[88:91]
buffer_load_dword a244, v8, s[64:67], s9 offen
v_mfma_f32_16x16x32_bf16 v[40:43], a[20:23], a[196:199], v[40:43]
v_mfma_f32_16x16x32_bf16 v[40:43], a[24:27], a[200:203], v[40:43]
v_exp_f32 v23, v23
v_mfma_f32_16x16x32_bf16 v[40:43], a[28:31], a[204:207], v[40:43]
v_exp_f32 v24, v24
v_mfma_f32_16x16x32_bf16 v[44:47], a[16:19], a[208:211], v[92:95]
v_exp_f32 v25, v25
v_mfma_f32_16x16x32_bf16 v[44:47], a[20:23], a[212:215], v[44:47]
v_exp_f32 v26, v26
v_mfma_f32_16x16x32_bf16 v[44:47], a[24:27], a[216:219], v[44:47]
v_exp_f32 v27, v27
v_mfma_f32_16x16x32_bf16 v[44:47], a[28:31], a[220:223], v[44:47]
s_waitcnt lgkmcnt(0)
v_cvt_pk_bf16_f32 v53, v22, v23
v_mfma_f32_16x16x32_bf16 v[128:131], a[32:35], v[64:67], v[128:131]
ds_read_b128 a[0:3], v1 offset:24576
v_cvt_pk_bf16_f32 v56, v24, v25
v_mfma_f32_16x16x32_bf16 v[160:163], a[32:35], v[68:71], v[160:163]
v_exp_f32 v28, v28
v_mfma_f32_16x16x32_bf16 v[192:195], a[32:35], v[72:75], v[192:195]
v_cvt_pk_bf16_f32 v57, v26, v27
v_mfma_f32_16x16x32_bf16 v[224:227], a[32:35], v[76:79], v[224:227]
ds_read_b128 a[4:7], v1 offset:25600
v_mfma_f32_16x16x32_bf16 v[228:231], a[36:39], v[76:79], v[228:231]
v_exp_f32 v29, v29
v_mfma_f32_16x16x32_bf16 v[196:199], a[36:39], v[72:75], v[196:199]
s_add_u32 m0, s27, 0x1000
v_exp_f32 v30, v30
v_mfma_f32_16x16x32_bf16 v[164:167], a[36:39], v[68:71], v[164:167]
buffer_load_dwordx4 v3, s[48:51], s7 offen offset:0 sc1 lds
v_mfma_f32_16x16x32_bf16 v[132:135], a[36:39], v[64:67], v[132:135]
ds_read_b128 a[8:11], v1 offset:26624
v_cvt_pk_bf16_f32 v60, v28, v29
v_mfma_f32_16x16x32_bf16 v[136:139], a[40:43], v[64:67], v[136:139]
v_mfma_f32_16x16x32_bf16 v[168:171], a[40:43], v[68:71], v[168:171]
v_exp_f32 v31, v31
v_mfma_f32_16x16x32_bf16 v[200:203], a[40:43], v[72:75], v[200:203]
v_exp_f32 v32, v32
v_mfma_f32_16x16x32_bf16 v[232:235], a[40:43], v[76:79], v[232:235]
ds_read_b128 a[12:15], v1 offset:27648
v_cvt_pk_bf16_f32 v61, v30, v31
v_mfma_f32_16x16x32_bf16 v[236:239], a[44:47], v[76:79], v[236:239]
v_mfma_f32_16x16x32_bf16 v[204:207], a[44:47], v[72:75], v[204:207]
v_exp_f32 v33, v33
v_mfma_f32_16x16x32_bf16 v[172:175], a[44:47], v[68:71], v[172:175]
v_exp_f32 v34, v34
v_mfma_f32_16x16x32_bf16 v[140:143], a[44:47], v[64:67], v[140:143]
ds_read_b128 a[16:19], v1 offset:28672
v_cvt_pk_bf16_f32 v50, v32, v33
v_mfma_f32_16x16x32_bf16 v[144:147], a[48:51], v[64:67], v[144:147]
v_exp_f32 v35, v35
v_mfma_f32_16x16x32_bf16 v[176:179], a[48:51], v[68:71], v[176:179]
v_cvt_pk_bf16_f32 v51, v34, v35
v_mfma_f32_16x16x32_bf16 v[208:211], a[48:51], v[72:75], v[208:211]
buffer_load_dwordx4 v3, s[48:51], s7 offen offset:1024 sc1 lds
v_mfma_f32_16x16x32_bf16 v[240:243], a[48:51], v[76:79], v[240:243]
ds_read_b128 a[20:23], v1 offset:29696
v_mfma_f32_16x16x32_bf16 v[244:247], a[52:55], v[76:79], v[244:247]
v_exp_f32 v36, v36
v_mfma_f32_16x16x32_bf16 v[212:215], a[52:55], v[72:75], v[212:215]
v_exp_f32 v37, v37
v_mfma_f32_16x16x32_bf16 v[180:183], a[52:55], v[68:71], v[180:183]
ds_read_b128 a[24:27], v1 offset:30720
v_cvt_pk_bf16_f32 v54, v36, v37
v_mfma_f32_16x16x32_bf16 v[148:151], a[52:55], v[64:67], v[148:151]
v_mfma_f32_16x16x32_bf16 v[152:155], a[56:59], v[64:67], v[152:155]
v_exp_f32 v38, v38
v_mfma_f32_16x16x32_bf16 v[184:187], a[56:59], v[68:71], v[184:187]
v_exp_f32 v39, v39
v_mfma_f32_16x16x32_bf16 v[216:219], a[56:59], v[72:75], v[216:219]
ds_read_b128 a[28:31], v1 offset:31744
v_cvt_pk_bf16_f32 v55, v38, v39
v_mfma_f32_16x16x32_bf16 v[248:251], a[56:59], v[76:79], v[248:251]
v_exp_f32 v40, v40
v_mfma_f32_16x16x32_bf16 v[252:255], a[60:63], v[76:79], v[252:255]
v_mfma_f32_16x16x32_bf16 v[220:223], a[60:63], v[72:75], v[220:223]
v_exp_f32 v41, v41
v_mfma_f32_16x16x32_bf16 v[188:191], a[60:63], v[68:71], v[188:191]
buffer_load_dwordx4 v3, s[48:51], s7 offen offset:2048 sc1 lds
v_mfma_f32_16x16x32_bf16 v[156:159], a[60:63], v[64:67], v[156:159]
ds_read_b128 a[32:35], v1 offset:16384
v_cvt_pk_bf16_f32 v58, v40, v41
v_smfmac_f32_16x16x64_bf16 a[224:227], a[232:235], v[64:71], v9
s_waitcnt lgkmcnt(5)
v_exp_f32 v42, v42
v_smfmac_f32_16x16x64_bf16 a[228:231], a[232:235], v[72:79], v9
ds_read_b128 a[36:39], v1 offset:17408
v_mfma_f32_16x16x32_bf16 v[16:19], a[0:3], a[160:163], v[96:99]
v_mfma_f32_16x16x32_bf16 v[16:19], a[4:7], a[164:167], v[16:19]
v_exp_f32 v43, v43
v_mfma_f32_16x16x32_bf16 v[16:19], a[8:11], a[168:171], v[16:19]
v_exp_f32 v44, v44
v_mfma_f32_16x16x32_bf16 v[16:19], a[12:15], a[172:175], v[16:19]
ds_read_b128 a[40:43], v1 offset:18432
v_cvt_pk_bf16_f32 v59, v42, v43
v_mfma_f32_16x16x32_bf16 v[20:23], a[0:3], a[176:179], v[84:87]
v_exp_f32 v45, v45
v_mfma_f32_16x16x32_bf16 v[20:23], a[4:7], a[180:183], v[20:23]
v_cvt_pk_bf16_f32 v62, v44, v45
v_mfma_f32_16x16x32_bf16 v[20:23], a[8:11], a[184:187], v[20:23]
s_mov_b32 s9, 0x400000
v_exp_f32 v46, v46
v_mfma_f32_16x16x32_bf16 v[20:23], a[12:15], a[188:191], v[20:23]
ds_read_b128 a[44:47], v1 offset:19456
v_mfma_f32_16x16x32_bf16 v[24:27], a[0:3], a[192:195], v[88:91]
buffer_load_dword a244, v8, s[64:67], s9 offen
v_mfma_f32_16x16x32_bf16 v[24:27], a[4:7], a[196:199], v[24:27]
v_exp_f32 v47, v47
v_mfma_f32_16x16x32_bf16 v[24:27], a[8:11], a[200:203], v[24:27]
v_cvt_pk_bf16_f32 v63, v46, v47
v_mfma_f32_16x16x32_bf16 v[24:27], a[12:15], a[204:207], v[24:27]
ds_read_b128 a[48:51], v1 offset:20480
v_mfma_f32_16x16x32_bf16 v[28:31], a[0:3], a[208:211], v[92:95]
v_exp_f32 v16, v16
v_mfma_f32_16x16x32_bf16 v[28:31], a[4:7], a[212:215], v[28:31]
v_exp_f32 v17, v17
v_mfma_f32_16x16x32_bf16 v[28:31], a[8:11], a[216:219], v[28:31]
ds_read_b128 a[52:55], v1 offset:21504
v_cvt_pk_bf16_f32 v64, v16, v17
v_mfma_f32_16x16x32_bf16 v[28:31], a[12:15], a[220:223], v[28:31]
s_waitcnt lgkmcnt(6)
v_exp_f32 v18, v18
v_mfma_f32_16x16x32_bf16 v[32:35], a[16:19], a[160:163], v[100:103]
v_mfma_f32_16x16x32_bf16 v[32:35], a[20:23], a[164:167], v[32:35]
v_exp_f32 v19, v19
v_mfma_f32_16x16x32_bf16 v[32:35], a[24:27], a[168:171], v[32:35]
ds_read_b128 a[56:59], v1 offset:22528
v_cvt_pk_bf16_f32 v65, v18, v19
v_mfma_f32_16x16x32_bf16 v[32:35], a[28:31], a[172:175], v[32:35]
v_exp_f32 v20, v20
v_mfma_f32_16x16x32_bf16 v[36:39], a[16:19], a[176:179], v[84:87]
buffer_load_dwordx4 v3, s[48:51], s7 offen offset:3072 sc1 lds
v_mfma_f32_16x16x32_bf16 v[36:39], a[20:23], a[180:183], v[36:39]
s_add_u32 s32, s32, 0x8000
v_mfma_f32_16x16x32_bf16 v[36:39], a[24:27], a[184:187], v[36:39]
ds_read_b128 a[60:63], v1 offset:23552
v_xor_b32 v1, 0x8000, v1
v_mfma_f32_16x16x32_bf16 v[36:39], a[28:31], a[188:191], v[36:39]
s_add_u32 s7, s7, 0x8000
v_exp_f32 v21, v21
v_mfma_f32_16x16x32_bf16 v[40:43], a[16:19], a[192:195], v[88:91]
s_xor_b32 s27, s27, 0x38000
v_exp_f32 v22, v22
v_mfma_f32_16x16x32_bf16 v[40:43], a[20:23], a[196:199], v[40:43]
v_exp_f32 v23, v23
v_mfma_f32_16x16x32_bf16 v[40:43], a[24:27], a[200:203], v[40:43]
v_cvt_pk_bf16_f32 v68, v20, v21
v_cvt_pk_bf16_f32 v69, v22, v23
v_mfma_f32_16x16x32_bf16 v[40:43], a[28:31], a[204:207], v[40:43]
v_exp_f32 v24, v24
v_mfma_f32_16x16x32_bf16 v[44:47], a[16:19], a[208:211], v[92:95]
v_exp_f32 v25, v25
v_mfma_f32_16x16x32_bf16 v[44:47], a[20:23], a[212:215], v[44:47]
v_exp_f32 v26, v26
v_mfma_f32_16x16x32_bf16 v[44:47], a[24:27], a[216:219], v[44:47]
s_waitcnt vmcnt(19) lgkmcnt(0)
v_exp_f32 v27, v27
v_mfma_f32_16x16x32_bf16 v[44:47], a[28:31], a[220:223], v[44:47]
s_barrier
L_att_l1_1:
v_mfma_f32_16x16x32_bf16 v[128:131], a[32:35], v[48:51], v[128:131]
ds_read_b128 a[0:3], v2 offset:8192
v_cvt_pk_bf16_f32 v72, v24, v25
v_mfma_f32_16x16x32_bf16 v[160:163], a[32:35], v[52:55], v[160:163]
s_lshr_b32 s44, s2, 6
v_exp_f32 v28, v28
v_mfma_f32_16x16x32_bf16 v[192:195], a[32:35], v[56:59], v[192:195]
s_add_u32 m0, s19, 0x0
s_lshl_b32 s45, s44, 1
v_cvt_pk_bf16_f32 v73, v26, v27
v_mfma_f32_16x16x32_bf16 v[224:227], a[32:35], v[60:63], v[224:227]
ds_read_b128 a[4:7], v2 offset:9216
s_add_u32 s45, s45, s100
v_mfma_f32_16x16x32_bf16 v[228:231], a[36:39], v[60:63], v[228:231]
buffer_load_dwordx4 v3, s[48:51], s32 offen offset:0 sc1 lds
v_mfma_f32_16x16x32_bf16 v[196:199], a[36:39], v[56:59], v[196:199]
s_and_b32 s60, s45, 3
v_exp_f32 v29, v29
v_mfma_f32_16x16x32_bf16 v[164:167], a[36:39], v[52:55], v[164:167]
ds_read_b128 a[8:11], v2 offset:10240
v_cvt_pk_bf16_f32 v76, v28, v29
v_mfma_f32_16x16x32_bf16 v[132:135], a[36:39], v[48:51], v[132:135]
s_sub_u32 s60, s60, s44
v_exp_f32 v30, v30
v_mfma_f32_16x16x32_bf16 v[136:139], a[40:43], v[48:51], v[136:139]
s_add_u32 s60, s60, 4
v_exp_f32 v31, v31
v_mfma_f32_16x16x32_bf16 v[168:171], a[40:43], v[52:55], v[168:171]
ds_read_b128 a[12:15], v2 offset:11264
v_cvt_pk_bf16_f32 v77, v30, v31
v_mfma_f32_16x16x32_bf16 v[200:203], a[40:43], v[56:59], v[200:203]
s_lshl_b32 s60, s60, 14
s_and_b32 s60, s60, 0x7c000
s_lshl_b32 s61, s60, 3
v_mfma_f32_16x16x32_bf16 v[232:235], a[40:43], v[60:63], v[232:235]
s_add_u32 s62, s61, s12
v_exp_f32 v32, v32
v_mfma_f32_16x16x32_bf16 v[236:239], a[44:47], v[60:63], v[236:239]
s_mov_b32 s9, 0x200000
v_exp_f32 v33, v33
v_mfma_f32_16x16x32_bf16 v[204:207], a[44:47], v[56:59], v[204:207]
ds_read_b128 a[16:19], v2 offset:12288
v_cvt_pk_bf16_f32 v66, v32, v33
v_mfma_f32_16x16x32_bf16 v[172:175], a[44:47], v[52:55], v[172:175]
buffer_load_dword a244, v8, s[64:67], s9 offen
v_mfma_f32_16x16x32_bf16 v[140:143], a[44:47], v[48:51], v[140:143]
s_mul_i32 s44, s44, -8
v_exp_f32 v34, v34
v_mfma_f32_16x16x32_bf16 v[144:147], a[48:51], v[48:51], v[144:147]
ds_read_b128 a[20:23], v2 offset:13312
s_lshl_b32 s44, 4, s44
v_mfma_f32_16x16x32_bf16 v[176:179], a[48:51], v[52:55], v[176:179]
s_mul_i32 s45, s45, -8
v_exp_f32 v35, v35
v_mfma_f32_16x16x32_bf16 v[208:211], a[48:51], v[56:59], v[208:211]
s_lshl_b32 s45, 4, s45
s_add_u32 s44, s44, 0x21212121
v_cvt_pk_bf16_f32 v67, v34, v35
v_mfma_f32_16x16x32_bf16 v[240:243], a[48:51], v[60:63], v[240:243]
ds_read_b128 a[24:27], v2 offset:14336
s_sub_u32 s44, s44, s45
v_mfma_f32_16x16x32_bf16 v[244:247], a[52:55], v[60:63], v[244:247]
s_bfe_u32 s56, s44, 0x80000
v_exp_f32 v36, v36
v_mfma_f32_16x16x32_bf16 v[212:215], a[52:55], v[56:59], v[212:215]
s_lshl_b32 s56, s56, 14
v_exp_f32 v37, v37
v_mfma_f32_16x16x32_bf16 v[180:183], a[52:55], v[52:55], v[180:183]
s_bfe_u32 s57, s44, 0x80008
v_exp_f32 v38, v38
v_mfma_f32_16x16x32_bf16 v[148:151], a[52:55], v[48:51], v[148:151]
buffer_load_dwordx4 v3, s[48:51], s32 offen offset:1024 sc1 lds
v_mfma_f32_16x16x32_bf16 v[152:155], a[56:59], v[48:51], v[152:155]
ds_read_b128 a[28:31], v2 offset:15360
v_cvt_pk_bf16_f32 v70, v36, v37
v_mfma_f32_16x16x32_bf16 v[184:187], a[56:59], v[52:55], v[184:187]
s_lshl_b32 s57, s57, 14
s_bfe_u32 s58, s44, 0x80010
s_lshl_b32 s58, s58, 14
v_mfma_f32_16x16x32_bf16 v[216:219], a[56:59], v[56:59], v[216:219]
ds_read_b128 a[32:35], v2 offset:0
s_bfe_u32 s59, s44, 0x80018
v_mfma_f32_16x16x32_bf16 v[248:251], a[56:59], v[60:63], v[248:251]
s_lshl_b32 s59, s59, 14
v_exp_f32 v39, v39
v_mfma_f32_16x16x32_bf16 v[252:255], a[60:63], v[60:63], v[252:255]
v_exp_f32 v40, v40
v_mfma_f32_16x16x32_bf16 v[220:223], a[60:63], v[56:59], v[220:223]
ds_read_b128 a[36:39], v2 offset:1024
v_cvt_pk_bf16_f32 v71, v38, v39
v_mfma_f32_16x16x32_bf16 v[188:191], a[60:63], v[52:55], v[188:191]
v_exp_f32 v41, v41
v_mfma_f32_16x16x32_bf16 v[156:159], a[60:63], v[48:51], v[156:159]
s_waitcnt lgkmcnt(6)
v_exp_f32 v42, v42
v_smfmac_f32_16x16x64_bf16 a[224:227], a[232:235], v[48:55], v9
buffer_load_dwordx4 v3, s[48:51], s32 offen offset:2048 sc1 lds
v_smfmac_f32_16x16x64_bf16 a[228:231], a[232:235], v[56:63], v9
ds_read_b128 a[40:43], v2 offset:2048
v_cvt_pk_bf16_f32 v74, v40, v41
v_mfma_f32_16x16x32_bf16 v[20:23], a[0:3], a[176:179], v[104:107]
v_mfma_f32_16x16x32_bf16 v[20:23], a[4:7], a[180:183], v[20:23]
v_exp_f32 v43, v43
v_mfma_f32_16x16x32_bf16 v[20:23], a[8:11], a[184:187], v[20:23]
ds_read_b128 a[44:47], v2 offset:3072
v_cvt_pk_bf16_f32 v75, v42, v43
v_mfma_f32_16x16x32_bf16 v[20:23], a[12:15], a[188:191], v[20:23]
v_exp_f32 v44, v44
v_mfma_f32_16x16x32_bf16 v[24:27], a[0:3], a[192:195], v[88:91]
v_exp_f32 v45, v45
v_mfma_f32_16x16x32_bf16 v[24:27], a[4:7], a[196:199], v[24:27]
ds_read_b128 a[48:51], v2 offset:4096
v_cvt_pk_bf16_f32 v78, v44, v45
v_mfma_f32_16x16x32_bf16 v[24:27], a[8:11], a[200:203], v[24:27]
v_mfma_f32_16x16x32_bf16 v[24:27], a[12:15], a[204:207], v[24:27]
v_exp_f32 v46, v46
v_mfma_f32_16x16x32_bf16 v[28:31], a[0:3], a[208:211], v[92:95]
buffer_load_dwordx4 v3, s[48:51], s32 offen offset:3072 sc1 lds
v_mfma_f32_16x16x32_bf16 v[28:31], a[4:7], a[212:215], v[28:31]
ds_read_b128 a[52:55], v2 offset:5120
v_mfma_f32_16x16x32_bf16 v[28:31], a[8:11], a[216:219], v[28:31]
v_exp_f32 v47, v47
v_mfma_f32_16x16x32_bf16 v[28:31], a[12:15], a[220:223], v[28:31]
s_waitcnt lgkmcnt(6)
v_exp_f32 v20, v20
v_mfma_f32_16x16x32_bf16 v[36:39], a[16:19], a[176:179], v[108:111]
ds_read_b128 a[56:59], v2 offset:6144
v_cvt_pk_bf16_f32 v79, v46, v47
v_mfma_f32_16x16x32_bf16 v[36:39], a[20:23], a[180:183], v[36:39]
v_exp_f32 v21, v21
v_mfma_f32_16x16x32_bf16 v[36:39], a[24:27], a[184:187], v[36:39]
v_cvt_pk_bf16_f32 v52, v20, v21
v_mfma_f32_16x16x32_bf16 v[36:39], a[28:31], a[188:191], v[36:39]
ds_read_b128 a[60:63], v2 offset:7168
v_mfma_f32_16x16x32_bf16 v[40:43], a[16:19], a[192:195], v[88:91]
s_mov_b32 s9, 0x600000
v_exp_f32 v22, v22
v_mfma_f32_16x16x32_bf16 v[40:43], a[20:23], a[196:199], v[40:43]
buffer_load_dword a244, v8, s[64:67], s9 offen
v_mfma_f32_16x16x32_bf16 v[40:43], a[24:27], a[200:203], v[40:43]
v_exp_f32 v23, v23
v_mfma_f32_16x16x32_bf16 v[40:43], a[28:31], a[204:207], v[40:43]
v_exp_f32 v24, v24
v_mfma_f32_16x16x32_bf16 v[44:47], a[16:19], a[208:211], v[92:95]
v_exp_f32 v25, v25
v_mfma_f32_16x16x32_bf16 v[44:47], a[20:23], a[212:215], v[44:47]
v_exp_f32 v26, v26
v_mfma_f32_16x16x32_bf16 v[44:47], a[24:27], a[216:219], v[44:47]
v_exp_f32 v27, v27
v_mfma_f32_16x16x32_bf16 v[44:47], a[28:31], a[220:223], v[44:47]
s_waitcnt lgkmcnt(0)
v_cvt_pk_bf16_f32 v53, v22, v23
v_mfma_f32_16x16x32_bf16 v[128:131], a[32:35], v[64:67], v[128:131]
ds_read_b128 a[0:3], v2 offset:24576
v_cvt_pk_bf16_f32 v56, v24, v25
v_mfma_f32_16x16x32_bf16 v[160:163], a[32:35], v[68:71], v[160:163]
v_exp_f32 v28, v28
v_mfma_f32_16x16x32_bf16 v[192:195], a[32:35], v[72:75], v[192:195]
ds_read_b128 a[4:7], v2 offset:25600
v_cvt_pk_bf16_f32 v57, v26, v27
v_mfma_f32_16x16x32_bf16 v[224:227], a[32:35], v[76:79], v[224:227]
s_add_u32 m0, s19, 0x1000
v_mfma_f32_16x16x32_bf16 v[228:231], a[36:39], v[76:79], v[228:231]
buffer_load_dwordx4 v3, s[48:51], s7 offen offset:0 sc1 lds
v_mfma_f32_16x16x32_bf16 v[196:199], a[36:39], v[72:75], v[196:199]
ds_read_b128 a[8:11], v2 offset:26624
v_mfma_f32_16x16x32_bf16 v[164:167], a[36:39], v[68:71], v[164:167]
v_exp_f32 v29, v29
v_mfma_f32_16x16x32_bf16 v[132:135], a[36:39], v[64:67], v[132:135]
v_exp_f32 v30, v30
v_mfma_f32_16x16x32_bf16 v[136:139], a[40:43], v[64:67], v[136:139]
ds_read_b128 a[12:15], v2 offset:27648
v_cvt_pk_bf16_f32 v60, v28, v29
v_mfma_f32_16x16x32_bf16 v[168:171], a[40:43], v[68:71], v[168:171]
v_exp_f32 v31, v31
v_mfma_f32_16x16x32_bf16 v[200:203], a[40:43], v[72:75], v[200:203]
v_exp_f32 v36, v36
v_mfma_f32_16x16x32_bf16 v[232:235], a[40:43], v[76:79], v[232:235]
ds_read_b128 a[16:19], v2 offset:28672
v_cvt_pk_bf16_f32 v61, v30, v31
v_mfma_f32_16x16x32_bf16 v[236:239], a[44:47], v[76:79], v[236:239]
buffer_load_dwordx4 v3, s[48:51], s7 offen offset:1024 sc1 lds
v_mfma_f32_16x16x32_bf16 v[204:207], a[44:47], v[72:75], v[204:207]
ds_read_b128 a[20:23], v2 offset:29696
v_mfma_f32_16x16x32_bf16 v[172:175], a[44:47], v[68:71], v[172:175]
v_mfma_f32_16x16x32_bf16 v[140:143], a[44:47], v[64:67], v[140:143]
v_exp_f32 v37, v37
v_mfma_f32_16x16x32_bf16 v[144:147], a[48:51], v[64:67], v[144:147]
ds_read_b128 a[24:27], v2 offset:30720
v_cvt_pk_bf16_f32 v54, v36, v37
v_mfma_f32_16x16x32_bf16 v[176:179], a[48:51], v[68:71], v[176:179]
v_exp_f32 v38, v38
v_mfma_f32_16x16x32_bf16 v[208:211], a[48:51], v[72:75], v[208:211]
v_exp_f32 v39, v39
v_mfma_f32_16x16x32_bf16 v[240:243], a[48:51], v[76:79], v[240:243]
ds_read_b128 a[28:31], v2 offset:31744
v_cvt_pk_bf16_f32 v55, v38, v39
v_mfma_f32_16x16x32_bf16 v[244:247], a[52:55], v[76:79], v[244:247]
v_exp_f32 v40, v40
v_mfma_f32_16x16x32_bf16 v[212:215], a[52:55], v[72:75], v[212:215]
buffer_load_dwordx4 v3, s[48:51], s7 offen offset:2048 sc1 lds
v_mfma_f32_16x16x32_bf16 v[180:183], a[52:55], v[68:71], v[180:183]
ds_read_b128 a[32:35], v2 offset:16384
v_mfma_f32_16x16x32_bf16 v[148:151], a[52:55], v[64:67], v[148:151]
v_mfma_f32_16x16x32_bf16 v[152:155], a[56:59], v[64:67], v[152:155]
ds_read_b128 a[36:39], v2 offset:17408
v_mfma_f32_16x16x32_bf16 v[184:187], a[56:59], v[68:71], v[184:187]
v_exp_f32 v41, v41
v_mfma_f32_16x16x32_bf16 v[216:219], a[56:59], v[72:75], v[216:219]
v_exp_f32 v42, v42
v_mfma_f32_16x16x32_bf16 v[248:251], a[56:59], v[76:79], v[248:251]
ds_read_b128 a[40:43], v2 offset:18432
v_cvt_pk_bf16_f32 v58, v40, v41
v_mfma_f32_16x16x32_bf16 v[252:255], a[60:63], v[76:79], v[252:255]
v_exp_f32 v43, v43
v_mfma_f32_16x16x32_bf16 v[220:223], a[60:63], v[72:75], v[220:223]
buffer_load_dwordx4 v3, s[48:51], s7 offen offset:3072 sc1 lds
v_mfma_f32_16x16x32_bf16 v[188:191], a[60:63], v[68:71], v[188:191]
ds_read_b128 a[44:47], v2 offset:19456
v_cvt_pk_bf16_f32 v59, v42, v43
v_mfma_f32_16x16x32_bf16 v[156:159], a[60:63], v[64:67], v[156:159]
v_exp_f32 v44, v44
v_smfmac_f32_16x16x64_bf16 a[224:227], a[232:235], v[64:71], v9
s_waitcnt lgkmcnt(8)
v_exp_f32 v45, v45
v_smfmac_f32_16x16x64_bf16 a[228:231], a[232:235], v[72:79], v9
ds_read_b128 a[48:51], v2 offset:20480
v_add_u32 v4, s0, v3
v_mfma_f32_16x16x32_bf16 v[24:27], a[0:3], a[192:195], v[88:91]
v_cvt_pk_bf16_f32 v62, v44, v45
v_mfma_f32_16x16x32_bf16 v[24:27], a[4:7], a[196:199], v[24:27]
ds_read_b128 a[52:55], v2 offset:21504
v_mov_b32 v5, s1
v_mfma_f32_16x16x32_bf16 v[24:27], a[8:11], a[200:203], v[24:27]
v_exp_f32 v46, v46
v_mfma_f32_16x16x32_bf16 v[24:27], a[12:15], a[204:207], v[24:27]
global_load_dword a244, v[4:5], off sc1
v_mfma_f32_16x16x32_bf16 v[28:31], a[0:3], a[208:211], v[92:95]
ds_read_b128 a[56:59], v2 offset:22528
v_mfma_f32_16x16x32_bf16 v[28:31], a[4:7], a[212:215], v[28:31]
s_add_u32 s32, s32, 0x8000
v_exp_f32 v47, v47
v_mfma_f32_16x16x32_bf16 v[28:31], a[8:11], a[216:219], v[28:31]
s_waitcnt lgkmcnt(7)
v_cvt_pk_bf16_f32 v63, v46, v47
v_mfma_f32_16x16x32_bf16 v[28:31], a[12:15], a[220:223], v[28:31]
ds_read_b128 a[60:63], v2 offset:23552
s_add_u32 s7, s7, 0x8000
v_mfma_f32_16x16x32_bf16 v[40:43], a[16:19], a[192:195], v[88:91]
s_xor_b32 s19, s19, 0x8000
v_xor_b32 v2, 0x38000, v2
v_mfma_f32_16x16x32_bf16 v[40:43], a[20:23], a[196:199], v[40:43]
s_sub_u32 s15, 7, s6
v_exp_f32 v24, v24
v_mfma_f32_16x16x32_bf16 v[40:43], a[24:27], a[200:203], v[40:43]
s_lshl_b32 s15, s15, 1
v_exp_f32 v25, v25
v_mfma_f32_16x16x32_bf16 v[40:43], a[28:31], a[204:207], v[40:43]
v_exp_f32 v26, v26
v_mfma_f32_16x16x32_bf16 v[44:47], a[16:19], a[208:211], v[92:95]
v_exp_f32 v27, v27
v_mfma_f32_16x16x32_bf16 v[44:47], a[20:23], a[212:215], v[44:47]
v_exp_f32 v28, v28
v_mfma_f32_16x16x32_bf16 v[44:47], a[24:27], a[216:219], v[44:47]
s_waitcnt vmcnt(22) lgkmcnt(0)
v_exp_f32 v29, v29
v_mfma_f32_16x16x32_bf16 v[44:47], a[28:31], a[220:223], v[44:47]
s_barrier
s_cbranch_scc0 L_att_lh0_1
v_mfma_f32_16x16x32_bf16 v[160:163], a[32:35], v[52:55], v[160:163]
ds_read_b128 a[0:3], v1 offset:8192
v_cvt_pk_bf16_f32 v72, v24, v25
v_mfma_f32_16x16x32_bf16 v[192:195], a[32:35], v[56:59], v[192:195]
v_exp_f32 v30, v30
v_mfma_f32_16x16x32_bf16 v[224:227], a[32:35], v[60:63], v[224:227]
ds_read_b128 a[4:7], v1 offset:9216
v_cvt_pk_bf16_f32 v73, v26, v27
v_mfma_f32_16x16x32_bf16 v[228:231], a[36:39], v[60:63], v[228:231]
s_add_u32 m0, s27, 0x0
v_cvt_pk_bf16_f32 v76, v28, v29
v_accvgpr_read_b32 v6, a224
v_mfma_f32_16x16x32_bf16 v[196:199], a[36:39], v[56:59], v[196:199]
buffer_load_dwordx4 v3, s[48:51], s32 offen offset:0 sc1 lds
v_mfma_f32_16x16x32_bf16 v[164:167], a[36:39], v[52:55], v[164:167]
ds_read_b128 a[8:11], v1 offset:10240
v_accvgpr_read_b32 v7, a225
v_mfma_f32_16x16x32_bf16 v[168:171], a[40:43], v[52:55], v[168:171]
ds_read_b128 a[12:15], v1 offset:11264
v_add_f32 v6, v6, v7
v_mfma_f32_16x16x32_bf16 v[200:203], a[40:43], v[56:59], v[200:203]
v_exp_f32 v31, v31
v_mfma_f32_16x16x32_bf16 v[232:235], a[40:43], v[60:63], v[232:235]
v_exp_f32 v40, v40
v_mfma_f32_16x16x32_bf16 v[236:239], a[44:47], v[60:63], v[236:239]
ds_read_b128 a[16:19], v1 offset:12288
v_cvt_pk_bf16_f32 v77, v30, v31
v_mfma_f32_16x16x32_bf16 v[204:207], a[44:47], v[56:59], v[204:207]
v_cmp_nge_f32 vcc, 0x6f800000, v6
v_mfma_f32_16x16x32_bf16 v[172:175], a[44:47], v[52:55], v[172:175]
ds_read_b128 a[20:23], v1 offset:13312
v_mfma_f32_16x16x32_bf16 v[176:179], a[48:51], v[52:55], v[176:179]
v_exp_f32 v41, v41
v_mfma_f32_16x16x32_bf16 v[208:211], a[48:51], v[56:59], v[208:211]
ds_read_b128 a[24:27], v1 offset:14336
v_cvt_pk_bf16_f32 v74, v40, v41
v_mfma_f32_16x16x32_bf16 v[240:243], a[48:51], v[60:63], v[240:243]
buffer_load_dwordx4 v3, s[48:51], s32 offen offset:1024 sc1 lds
v_mfma_f32_16x16x32_bf16 v[244:247], a[52:55], v[60:63], v[244:247]
v_exp_f32 v42, v42
v_mfma_f32_16x16x32_bf16 v[212:215], a[52:55], v[56:59], v[212:215]
ds_read_b128 a[28:31], v1 offset:15360
v_mfma_f32_16x16x32_bf16 v[180:183], a[52:55], v[52:55], v[180:183]
v_exp_f32 v43, v43
v_mfma_f32_16x16x32_bf16 v[184:187], a[56:59], v[52:55], v[184:187]
ds_read_b128 a[32:35], v1 offset:0
v_cvt_pk_bf16_f32 v75, v42, v43
v_mfma_f32_16x16x32_bf16 v[216:219], a[56:59], v[56:59], v[216:219]
v_rcp_f32 v6, v6
v_mfma_f32_16x16x32_bf16 v[248:251], a[56:59], v[60:63], v[248:251]
ds_read_b128 a[36:39], v1 offset:1024
s_or_b64 s[34:35], s[34:35], vcc
v_mfma_f32_16x16x32_bf16 v[252:255], a[60:63], v[60:63], v[252:255]
s_add_u32 s8, s28, 0x0
v_exp_f32 v44, v44
v_mfma_f32_16x16x32_bf16 v[220:223], a[60:63], v[56:59], v[220:223]
v_exp_f32 v45, v45
v_mfma_f32_16x16x32_bf16 v[188:191], a[60:63], v[52:55], v[188:191]
ds_read_b128 a[40:43], v1 offset:2048
v_cvt_pk_bf16_f32 v78, v44, v45
v_mfma_f32_16x16x32_bf16 a[224:227], a[236:239], v[52:55], a[224:227]
buffer_load_dwordx4 v3, s[48:51], s32 offen offset:2048 sc1 lds
v_smfmac_f32_16x16x64_bf16 a[228:231], a[232:235], v[56:63], v9
ds_read_b128 a[44:47], v1 offset:3072
s_waitcnt lgkmcnt(8)
v_mfma_f32_16x16x32_bf16 v[24:27], a[0:3], a[192:195], v[88:91]
v_exp_f32 v46, v46
v_mfma_f32_16x16x32_bf16 v[24:27], a[4:7], a[196:199], v[24:27]
ds_read_b128 a[48:51], v1 offset:4096
v_mul_f32 v128, v6, v128
v_mfma_f32_16x16x32_bf16 v[24:27], a[8:11], a[200:203], v[24:27]
v_mul_f32 v129, v6, v129
v_mul_f32 v130, v6, v130
v_mfma_f32_16x16x32_bf16 v[24:27], a[12:15], a[204:207], v[24:27]
v_exp_f32 v47, v47
v_mfma_f32_16x16x32_bf16 v[28:31], a[0:3], a[208:211], v[92:95]
ds_read_b128 a[52:55], v1 offset:5120
v_cvt_pk_bf16_f32 v79, v46, v47
v_mfma_f32_16x16x32_bf16 v[28:31], a[4:7], a[212:215], v[28:31]
v_mul_f32 v131, v6, v131
v_mul_f32 v132, v6, v132
v_mfma_f32_16x16x32_bf16 v[28:31], a[8:11], a[216:219], v[28:31]
ds_read_b128 a[56:59], v1 offset:6144
v_mul_f32 v133, v6, v133
v_mfma_f32_16x16x32_bf16 v[28:31], a[12:15], a[220:223], v[28:31]
s_waitcnt lgkmcnt(7)
v_exp_f32 v24, v24
v_mfma_f32_16x16x32_bf16 v[40:43], a[16:19], a[192:195], v[88:91]
buffer_load_dwordx4 v3, s[48:51], s32 offen offset:3072 sc1 lds
v_mfma_f32_16x16x32_bf16 v[40:43], a[20:23], a[196:199], v[40:43]
ds_read_b128 a[60:63], v1 offset:7168
v_mul_f32 v134, v6, v134
v_mfma_f32_16x16x32_bf16 v[40:43], a[24:27], a[200:203], v[40:43]
s_add_u32 s32, s32, 0x8000
v_exp_f32 v25, v25
v_mfma_f32_16x16x32_bf16 v[40:43], a[28:31], a[204:207], v[40:43]
v_exp_f32 v26, v26
v_mfma_f32_16x16x32_bf16 v[44:47], a[16:19], a[208:211], v[92:95]
v_exp_f32 v27, v27
v_mfma_f32_16x16x32_bf16 v[44:47], a[20:23], a[212:215], v[44:47]
v_exp_f32 v28, v28
v_mfma_f32_16x16x32_bf16 v[44:47], a[24:27], a[216:219], v[44:47]
v_exp_f32 v29, v29
v_mfma_f32_16x16x32_bf16 v[44:47], a[28:31], a[220:223], v[44:47]
s_waitcnt lgkmcnt(0)
v_mul_f32 v135, v6, v135
v_cvt_pk_bf16_f32 v128, v128, v129
v_mfma_f32_16x16x32_bf16 v[192:195], a[32:35], v[72:75], v[192:195]
s_add_u32 m0, s27, 0x1000
v_exp_f32 v30, v30
v_mfma_f32_16x16x32_bf16 v[224:227], a[32:35], v[76:79], v[224:227]
buffer_load_dwordx4 v3, s[48:51], s7 offen offset:0 sc1 lds
v_mfma_f32_16x16x32_bf16 v[228:231], a[36:39], v[76:79], v[228:231]
v_exp_f32 v31, v31
v_mfma_f32_16x16x32_bf16 v[196:199], a[36:39], v[72:75], v[196:199]
ds_read_b128 a[0:3], v1 offset:24576
v_cvt_pk_bf16_f32 v56, v24, v25
v_mfma_f32_16x16x32_bf16 v[200:203], a[40:43], v[72:75], v[200:203]
ds_read_b128 a[4:7], v1 offset:25600
v_cvt_pk_bf16_f32 v57, v26, v27
v_mfma_f32_16x16x32_bf16 v[232:235], a[40:43], v[76:79], v[232:235]
v_exp_f32 v40, v40
v_mfma_f32_16x16x32_bf16 v[236:239], a[44:47], v[76:79], v[236:239]
ds_read_b128 a[8:11], v1 offset:26624
v_cvt_pk_bf16_f32 v60, v28, v29
v_mfma_f32_16x16x32_bf16 v[204:207], a[44:47], v[72:75], v[204:207]
v_exp_f32 v41, v41
v_mfma_f32_16x16x32_bf16 v[208:211], a[48:51], v[72:75], v[208:211]
ds_read_b128 a[12:15], v1 offset:27648
v_cvt_pk_bf16_f32 v61, v30, v31
v_mfma_f32_16x16x32_bf16 v[240:243], a[48:51], v[76:79], v[240:243]
ds_read_b128 a[16:19], v1 offset:28672
v_cvt_pk_bf16_f32 v58, v40, v41
v_mfma_f32_16x16x32_bf16 v[244:247], a[52:55], v[76:79], v[244:247]
v_exp_f32 v42, v42
v_mfma_f32_16x16x32_bf16 v[212:215], a[52:55], v[72:75], v[212:215]
buffer_load_dwordx4 v3, s[48:51], s7 offen offset:1024 sc1 lds
v_mfma_f32_16x16x32_bf16 v[216:219], a[56:59], v[72:75], v[216:219]
ds_read_b128 a[20:23], v1 offset:29696
v_cvt_pk_bf16_f32 v129, v130, v131
v_mfma_f32_16x16x32_bf16 v[248:251], a[56:59], v[76:79], v[248:251]
ds_read_b128 a[24:27], v1 offset:30720
v_cvt_pk_bf16_f32 v130, v132, v133
v_mfma_f32_16x16x32_bf16 v[252:255], a[60:63], v[76:79], v[252:255]
ds_read_b128 a[28:31], v1 offset:31744
v_cvt_pk_bf16_f32 v131, v134, v135
v_mfma_f32_16x16x32_bf16 v[220:223], a[60:63], v[72:75], v[220:223]
s_waitcnt lgkmcnt(4)
v_exp_f32 v43, v43
v_smfmac_f32_16x16x64_bf16 a[228:231], a[232:235], v[72:79], v9
ds_read_b128 a[32:35], v1 offset:16384
v_cvt_pk_bf16_f32 v59, v42, v43
v_mfma_f32_16x16x32_bf16 v[24:27], a[0:3], a[192:195], v[88:91]
ds_read_b128 a[36:39], v1 offset:17408
buffer_store_dwordx4 v[128:131], v3, s[88:91], s8 offen sc1
v_mfma_f32_16x16x32_bf16 v[24:27], a[4:7], a[196:199], v[24:27]
buffer_load_dwordx4 v3, s[48:51], s7 offen offset:2048 sc1 lds
v_mfma_f32_16x16x32_bf16 v[24:27], a[8:11], a[200:203], v[24:27]
ds_read_b128 a[40:43], v1 offset:18432
v_exp_f32 v44, v44
v_mfma_f32_16x16x32_bf16 v[24:27], a[12:15], a[204:207], v[24:27]
ds_read_b128 a[44:47], v1 offset:19456
v_exp_f32 v45, v45
v_mfma_f32_16x16x32_bf16 v[28:31], a[0:3], a[208:211], v[92:95]
ds_read_b128 a[48:51], v1 offset:20480
v_exp_f32 v46, v46
v_mfma_f32_16x16x32_bf16 v[28:31], a[4:7], a[212:215], v[28:31]
s_waitcnt lgkmcnt(5)
v_exp_f32 v47, v47
v_mfma_f32_16x16x32_bf16 v[28:31], a[8:11], a[216:219], v[28:31]
ds_read_b128 a[52:55], v1 offset:21504
v_cvt_pk_bf16_f32 v62, v44, v45
v_mfma_f32_16x16x32_bf16 v[28:31], a[12:15], a[220:223], v[28:31]
ds_read_b128 a[56:59], v1 offset:22528
v_cvt_pk_bf16_f32 v63, v46, v47
v_mfma_f32_16x16x32_bf16 v[40:43], a[16:19], a[192:195], v[88:91]
ds_read_b128 a[60:63], v1 offset:23552
v_xor_b32 v1, 0x8000, v1
v_mfma_f32_16x16x32_bf16 v[40:43], a[20:23], a[196:199], v[40:43]
buffer_load_dwordx4 v3, s[48:51], s7 offen offset:3072 sc1 lds
v_mfma_f32_16x16x32_bf16 v[40:43], a[24:27], a[200:203], v[40:43]
s_add_u32 s7, s7, 0x8000
v_exp_f32 v24, v24
v_mfma_f32_16x16x32_bf16 v[40:43], a[28:31], a[204:207], v[40:43]
s_xor_b32 s27, s27, 0x38000
v_exp_f32 v25, v25
v_mfma_f32_16x16x32_bf16 v[44:47], a[16:19], a[208:211], v[92:95]
s_add_u32 s8, s28, 0x2000
v_exp_f32 v26, v26
v_mfma_f32_16x16x32_bf16 v[44:47], a[20:23], a[212:215], v[44:47]
v_exp_f32 v27, v27
v_mfma_f32_16x16x32_bf16 v[44:47], a[24:27], a[216:219], v[44:47]
s_waitcnt vmcnt(19) lgkmcnt(0)
v_exp_f32 v28, v28
v_mfma_f32_16x16x32_bf16 v[44:47], a[28:31], a[220:223], v[44:47]
s_barrier
v_exp_f32 v29, v29
v_mul_f32 v136, v6, v136
v_mul_f32 v137, v6, v137
v_mul_f32 v138, v6, v138
v_mul_f32 v139, v6, v139
v_mul_f32 v140, v6, v140
v_mul_f32 v141, v6, v141
v_mul_f32 v142, v6, v142
v_mul_f32 v143, v6, v143
v_cvt_pk_bf16_f32 v136, v136, v137
v_cvt_pk_bf16_f32 v137, v138, v139
v_cvt_pk_bf16_f32 v138, v140, v141
v_cvt_pk_bf16_f32 v139, v142, v143
buffer_store_dwordx4 v[136:139], v3, s[88:91], s8 offen sc1
s_add_u32 s8, s28, 0x4000
v_mul_f32 v144, v6, v144
v_mul_f32 v145, v6, v145
v_mul_f32 v146, v6, v146
v_mul_f32 v147, v6, v147
v_mul_f32 v148, v6, v148
v_mul_f32 v149, v6, v149
v_mul_f32 v150, v6, v150
v_mul_f32 v151, v6, v151
v_cvt_pk_bf16_f32 v144, v144, v145
v_cvt_pk_bf16_f32 v145, v146, v147
v_cvt_pk_bf16_f32 v146, v148, v149
v_cvt_pk_bf16_f32 v147, v150, v151
buffer_store_dwordx4 v[144:147], v3, s[88:91], s8 offen sc1
s_add_u32 s8, s28, 0x6000
v_mul_f32 v152, v6, v152
v_mul_f32 v153, v6, v153
v_mul_f32 v154, v6, v154
v_mul_f32 v155, v6, v155
v_mul_f32 v156, v6, v156
v_mul_f32 v157, v6, v157
v_mul_f32 v158, v6, v158
v_mul_f32 v159, v6, v159
v_cvt_pk_bf16_f32 v152, v152, v153
v_cvt_pk_bf16_f32 v153, v154, v155
v_cvt_pk_bf16_f32 v154, v156, v157
v_cvt_pk_bf16_f32 v155, v158, v159
buffer_store_dwordx4 v[152:155], v3, s[88:91], s8 offen sc1
v_accvgpr_read_b32 v6, a226
v_accvgpr_read_b32 v7, a227
v_add_f32 v6, v6, v7
v_cmp_nge_f32 vcc, 0x6f800000, v6
v_rcp_f32 v6, v6
s_or_b64 s[34:35], s[34:35], vcc
s_add_u32 s8, s29, 0x0
v_pk_mul_f32 v[160:161], v[160:161], v[6:7] op_sel_hi:[1,0]
v_pk_mul_f32 v[162:163], v[162:163], v[6:7] op_sel_hi:[1,0]
v_pk_mul_f32 v[164:165], v[164:165], v[6:7] op_sel_hi:[1,0]
v_pk_mul_f32 v[166:167], v[166:167], v[6:7] op_sel_hi:[1,0]
v_cvt_pk_bf16_f32 v160, v160, v161
v_cvt_pk_bf16_f32 v161, v162, v163
v_cvt_pk_bf16_f32 v162, v164, v165
v_cvt_pk_bf16_f32 v163, v166, v167
buffer_store_dwordx4 v[160:163], v3, s[88:91], s8 offen sc1
s_add_u32 s8, s29, 0x2000
v_pk_mul_f32 v[168:169], v[168:169], v[6:7] op_sel_hi:[1,0]
v_pk_mul_f32 v[170:171], v[170:171], v[6:7] op_sel_hi:[1,0]
v_pk_mul_f32 v[172:173], v[172:173], v[6:7] op_sel_hi:[1,0]
v_pk_mul_f32 v[174:175], v[174:175], v[6:7] op_sel_hi:[1,0]
v_cvt_pk_bf16_f32 v168, v168, v169
v_cvt_pk_bf16_f32 v169, v170, v171
v_cvt_pk_bf16_f32 v170, v172, v173
v_cvt_pk_bf16_f32 v171, v174, v175
buffer_store_dwordx4 v[168:171], v3, s[88:91], s8 offen sc1
s_add_u32 s8, s29, 0x4000
v_pk_mul_f32 v[176:177], v[176:177], v[6:7] op_sel_hi:[1,0]
v_pk_mul_f32 v[178:179], v[178:179], v[6:7] op_sel_hi:[1,0]
v_pk_mul_f32 v[180:181], v[180:181], v[6:7] op_sel_hi:[1,0]
v_pk_mul_f32 v[182:183], v[182:183], v[6:7] op_sel_hi:[1,0]
v_cvt_pk_bf16_f32 v176, v176, v177
v_cvt_pk_bf16_f32 v177, v178, v179
v_cvt_pk_bf16_f32 v178, v180, v181
v_cvt_pk_bf16_f32 v179, v182, v183
buffer_store_dwordx4 v[176:179], v3, s[88:91], s8 offen sc1
s_add_u32 s8, s29, 0x6000
v_pk_mul_f32 v[184:185], v[184:185], v[6:7] op_sel_hi:[1,0]
v_pk_mul_f32 v[186:187], v[186:187], v[6:7] op_sel_hi:[1,0]
v_pk_mul_f32 v[188:189], v[188:189], v[6:7] op_sel_hi:[1,0]
v_pk_mul_f32 v[190:191], v[190:191], v[6:7] op_sel_hi:[1,0]
v_cvt_pk_bf16_f32 v184, v184, v185
v_cvt_pk_bf16_f32 v185, v186, v187
v_cvt_pk_bf16_f32 v186, v188, v189
v_cvt_pk_bf16_f32 v187, v190, v191
buffer_store_dwordx4 v[184:187], v3, s[88:91], s8 offen sc1
s_getreg_b32 s8, hwreg(HW_REG_HW_ID, 5, 1)
s_cmp_lg_u32 s8, 0
s_cbranch_scc1 L_att_sodd1
s_branch L_att_sodd0
L_att_lh0_1:
v_mfma_f32_16x16x32_bf16 v[160:163], a[32:35], v[52:55], v[160:163]
ds_read_b128 a[0:3], v1 offset:8192
v_cvt_pk_bf16_f32 v72, v24, v25
v_mfma_f32_16x16x32_bf16 v[192:195], a[32:35], v[56:59], v[192:195]
v_exp_f32 v30, v30
v_mfma_f32_16x16x32_bf16 v[224:227], a[32:35], v[60:63], v[224:227]
buffer_load_dword v14, v15, s[84:87], 0 offen offset:192 sc1
v_mfma_f32_16x16x32_bf16 v[228:231], a[36:39], v[60:63], v[228:231]
ds_read_b128 a[4:7], v1 offset:9216
v_cvt_pk_bf16_f32 v73, v26, v27
v_mfma_f32_16x16x32_bf16 v[196:199], a[36:39], v[56:59], v[196:199]
ds_read_b128 a[8:11], v1 offset:10240
v_cvt_pk_bf16_f32 v76, v28, v29
v_mfma_f32_16x16x32_bf16 v[164:167], a[36:39], v[52:55], v[164:167]
s_add_u32 m0, s17, 0x10000
v_exp_f32 v31, v31
v_mfma_f32_16x16x32_bf16 v[168:171], a[40:43], v[52:55], v[168:171]
buffer_load_dwordx4 v12, s[72:75], 0 offen lds
v_mfma_f32_16x16x32_bf16 v[200:203], a[40:43], v[56:59], v[200:203]
ds_read_b128 a[12:15], v1 offset:11264
v_cvt_pk_bf16_f32 v77, v30, v31
v_mfma_f32_16x16x32_bf16 v[232:235], a[40:43], v[60:63], v[232:235]
v_exp_f32 v40, v40
v_mfma_f32_16x16x32_bf16 v[236:239], a[44:47], v[60:63], v[236:239]
ds_read_b128 a[16:19], v1 offset:12288
v_mfma_f32_16x16x32_bf16 v[204:207], a[44:47], v[56:59], v[204:207]
v_exp_f32 v41, v41
v_mfma_f32_16x16x32_bf16 v[172:175], a[44:47], v[52:55], v[172:175]
buffer_load_dwordx4 v13, s[72:75], 0 offen offset:1024 lds
v_mfma_f32_16x16x32_bf16 v[176:179], a[48:51], v[52:55], v[176:179]
ds_read_b128 a[20:23], v1 offset:13312
v_cvt_pk_bf16_f32 v74, v40, v41
v_mfma_f32_16x16x32_bf16 v[208:211], a[48:51], v[56:59], v[208:211]
ds_read_b128 a[24:27], v1 offset:14336
v_mfma_f32_16x16x32_bf16 v[240:243], a[48:51], v[60:63], v[240:243]
v_exp_f32 v42, v42
v_mfma_f32_16x16x32_bf16 v[244:247], a[52:55], v[60:63], v[244:247]
buffer_load_dwordx4 v12, s[72:75], s12 offen offset:2048 lds
v_mfma_f32_16x16x32_bf16 v[212:215], a[52:55], v[56:59], v[212:215]
ds_read_b128 a[28:31], v1 offset:15360
v_mfma_f32_16x16x32_bf16 v[180:183], a[52:55], v[52:55], v[180:183]
v_exp_f32 v43, v43
v_mfma_f32_16x16x32_bf16 v[184:187], a[56:59], v[52:55], v[184:187]
ds_read_b128 a[32:35], v1 offset:0
v_cvt_pk_bf16_f32 v75, v42, v43
v_mfma_f32_16x16x32_bf16 v[216:219], a[56:59], v[56:59], v[216:219]
v_exp_f32 v44, v44
v_mfma_f32_16x16x32_bf16 v[248:251], a[56:59], v[60:63], v[248:251]
buffer_load_dwordx4 v13, s[72:75], s12 offen offset:3072 lds
v_mfma_f32_16x16x32_bf16 v[252:255], a[60:63], v[60:63], v[252:255]
ds_read_b128 a[36:39], v1 offset:1024
v_mfma_f32_16x16x32_bf16 v[220:223], a[60:63], v[56:59], v[220:223]
s_add_u32 m0, s17, 0x14000
v_exp_f32 v45, v45
v_mfma_f32_16x16x32_bf16 v[188:191], a[60:63], v[52:55], v[188:191]
ds_read_b128 a[40:43], v1 offset:2048
v_add_u32 v12, 0x20000, v12
v_mfma_f32_16x16x32_bf16 a[224:227], a[236:239], v[52:55], a[224:227]
buffer_load_dwordx4 v12, s[72:75], 0 offen lds
v_smfmac_f32_16x16x64_bf16 a[228:231], a[232:235], v[56:63], v9
ds_read_b128 a[44:47], v1 offset:3072
s_waitcnt lgkmcnt(8)
v_mfma_f32_16x16x32_bf16 v[24:27], a[0:3], a[192:195], v[88:91]
v_exp_f32 v46, v46
v_mfma_f32_16x16x32_bf16 v[24:27], a[4:7], a[196:199], v[24:27]
ds_read_b128 a[48:51], v1 offset:4096
v_add_u32 v13, 0x20000, v13
v_mfma_f32_16x16x32_bf16 v[24:27], a[8:11], a[200:203], v[24:27]
buffer_load_dwordx4 v13, s[72:75], 0 offen offset:1024 lds
v_mfma_f32_16x16x32_bf16 v[24:27], a[12:15], a[204:207], v[24:27]
v_exp_f32 v47, v47
v_mfma_f32_16x16x32_bf16 v[28:31], a[0:3], a[208:211], v[92:95]
ds_read_b128 a[52:55], v1 offset:5120
v_cvt_pk_bf16_f32 v78, v44, v45
v_mfma_f32_16x16x32_bf16 v[28:31], a[4:7], a[212:215], v[28:31]
s_waitcnt lgkmcnt(6)
v_cvt_pk_bf16_f32 v79, v46, v47
v_mfma_f32_16x16x32_bf16 v[28:31], a[8:11], a[216:219], v[28:31]
ds_read_b128 a[56:59], v1 offset:6144
v_mfma_f32_16x16x32_bf16 v[28:31], a[12:15], a[220:223], v[28:31]
buffer_load_dwordx4 v12, s[72:75], s12 offen offset:2048 lds
v_mfma_f32_16x16x32_bf16 v[40:43], a[16:19], a[192:195], v[88:91]
ds_read_b128 a[60:63], v1 offset:7168
v_mfma_f32_16x16x32_bf16 v[40:43], a[20:23], a[196:199], v[40:43]
v_exp_f32 v24, v24
v_mfma_f32_16x16x32_bf16 v[40:43], a[24:27], a[200:203], v[40:43]
v_exp_f32 v25, v25
v_mfma_f32_16x16x32_bf16 v[40:43], a[28:31], a[204:207], v[40:43]
buffer_load_dwordx4 v13, s[72:75], s12 offen offset:3072 lds
v_mfma_f32_16x16x32_bf16 v[44:47], a[16:19], a[208:211], v[92:95]
v_exp_f32 v26, v26
v_mfma_f32_16x16x32_bf16 v[44:47], a[20:23], a[212:215], v[44:47]
v_exp_f32 v27, v27
v_mfma_f32_16x16x32_bf16 v[44:47], a[24:27], a[216:219], v[44:47]
v_exp_f32 v28, v28
v_mfma_f32_16x16x32_bf16 v[44:47], a[28:31], a[220:223], v[44:47]
s_waitcnt lgkmcnt(0)
v_exp_f32 v29, v29
v_mfma_f32_16x16x32_bf16 v[192:195], a[32:35], v[72:75], v[192:195]
s_add_u32 m0, s16, 0x0
v_add_u32 v12, 0x20000, v12
v_cvt_pk_bf16_f32 v56, v24, v25
v_mfma_f32_16x16x32_bf16 v[224:227], a[32:35], v[76:79], v[224:227]
buffer_load_dwordx4 v12, s[72:75], 0 offen lds
v_mfma_f32_16x16x32_bf16 v[228:231], a[36:39], v[76:79], v[228:231]
ds_read_b128 a[0:3], v1 offset:24576
v_cvt_pk_bf16_f32 v57, v26, v27
v_mfma_f32_16x16x32_bf16 v[196:199], a[36:39], v[72:75], v[196:199]
v_exp_f32 v30, v30
v_mfma_f32_16x16x32_bf16 v[200:203], a[40:43], v[72:75], v[200:203]
ds_read_b128 a[4:7], v1 offset:25600
v_cvt_pk_bf16_f32 v60, v28, v29
v_mfma_f32_16x16x32_bf16 v[232:235], a[40:43], v[76:79], v[232:235]
ds_read_b128 a[8:11], v1 offset:26624
v_add_u32 v13, 0x20000, v13
v_mfma_f32_16x16x32_bf16 v[236:239], a[44:47], v[76:79], v[236:239]
buffer_load_dwordx4 v13, s[72:75], 0 offen offset:1024 lds
v_mfma_f32_16x16x32_bf16 v[204:207], a[44:47], v[72:75], v[204:207]
ds_read_b128 a[12:15], v1 offset:27648
v_exp_f32 v31, v31
v_mfma_f32_16x16x32_bf16 v[208:211], a[48:51], v[72:75], v[208:211]
buffer_load_dwordx4 v12, s[72:75], s12 offen offset:2048 lds
v_mfma_f32_16x16x32_bf16 v[240:243], a[48:51], v[76:79], v[240:243]
ds_read_b128 a[16:19], v1 offset:28672
v_exp_f32 v40, v40
v_mfma_f32_16x16x32_bf16 v[244:247], a[52:55], v[76:79], v[244:247]
ds_read_b128 a[20:23], v1 offset:29696
v_cvt_pk_bf16_f32 v61, v30, v31
v_mfma_f32_16x16x32_bf16 v[212:215], a[52:55], v[72:75], v[212:215]
buffer_load_dwordx4 v13, s[72:75], s12 offen offset:3072 lds
v_mfma_f32_16x16x32_bf16 v[216:219], a[56:59], v[72:75], v[216:219]
ds_read_b128 a[24:27], v1 offset:30720
v_exp_f32 v41, v41
v_mfma_f32_16x16x32_bf16 v[248:251], a[56:59], v[76:79], v[248:251]
ds_read_b128 a[28:31], v1 offset:31744
v_exp_f32 v42, v42
v_mfma_f32_16x16x32_bf16 v[252:255], a[60:63], v[76:79], v[252:255]
ds_read_b128 a[32:35], v1 offset:16384
v_cvt_pk_bf16_f32 v58, v40, v41
v_mfma_f32_16x16x32_bf16 v[220:223], a[60:63], v[72:75], v[220:223]
s_waitcnt lgkmcnt(5)
v_exp_f32 v43, v43
v_smfmac_f32_16x16x64_bf16 a[228:231], a[232:235], v[72:79], v9
ds_read_b128 a[36:39], v1 offset:17408
v_add_u32 v12, 0x20000, v12
v_mfma_f32_16x16x32_bf16 v[24:27], a[0:3], a[192:195], v[112:115]
s_add_u32 m0, s16, 0x4000
v_exp_f32 v44, v44
v_mfma_f32_16x16x32_bf16 v[24:27], a[4:7], a[196:199], v[24:27]
buffer_load_dwordx4 v12, s[72:75], 0 offen lds
v_mfma_f32_16x16x32_bf16 v[24:27], a[8:11], a[200:203], v[24:27]
ds_read_b128 a[40:43], v1 offset:18432
v_add_u32 v13, 0x20000, v13
v_mfma_f32_16x16x32_bf16 v[24:27], a[12:15], a[204:207], v[24:27]
buffer_load_dwordx4 v13, s[72:75], 0 offen offset:1024 lds
v_mfma_f32_16x16x32_bf16 v[28:31], a[0:3], a[208:211], v[92:95]
ds_read_b128 a[44:47], v1 offset:19456
v_cvt_pk_bf16_f32 v59, v42, v43
v_mfma_f32_16x16x32_bf16 v[28:31], a[4:7], a[212:215], v[28:31]
ds_read_b128 a[48:51], v1 offset:20480
v_exp_f32 v45, v45
v_mfma_f32_16x16x32_bf16 v[28:31], a[8:11], a[216:219], v[28:31]
s_waitcnt lgkmcnt(5)
v_exp_f32 v46, v46
v_mfma_f32_16x16x32_bf16 v[28:31], a[12:15], a[220:223], v[28:31]
buffer_load_dwordx4 v12, s[72:75], s12 offen offset:2048 lds
v_mfma_f32_16x16x32_bf16 v[40:43], a[16:19], a[192:195], v[116:119]
ds_read_b128 a[52:55], v1 offset:21504
v_exp_f32 v47, v47
v_mfma_f32_16x16x32_bf16 v[40:43], a[20:23], a[196:199], v[40:43]
ds_read_b128 a[56:59], v1 offset:22528
v_exp_f32 v24, v24
v_mfma_f32_16x16x32_bf16 v[40:43], a[24:27], a[200:203], v[40:43]
ds_read_b128 a[60:63], v1 offset:23552
v_xor_b32 v1, 0x8000, v1
v_mfma_f32_16x16x32_bf16 v[40:43], a[28:31], a[204:207], v[40:43]
v_exp_f32 v25, v25
v_cvt_pk_bf16_f32 v62, v44, v45
v_cvt_pk_bf16_f32 v63, v46, v47
v_mfma_f32_16x16x32_bf16 v[44:47], a[16:19], a[208:211], v[92:95]
v_exp_f32 v26, v26
v_mfma_f32_16x16x32_bf16 v[44:47], a[20:23], a[212:215], v[44:47]
buffer_load_dwordx4 v13, s[72:75], s12 offen offset:3072 lds
v_mfma_f32_16x16x32_bf16 v[44:47], a[24:27], a[216:219], v[44:47]
v_exp_f32 v27, v27
v_mfma_f32_16x16x32_bf16 v[44:47], a[28:31], a[220:223], v[44:47]
v_exp_f32 v28, v28
v_exp_f32 v29, v29
v_accvgpr_read_b32 v6, a224
v_accvgpr_read_b32 v7, a225
v_add_f32 v6, v6, v7
v_cmp_nge_f32 vcc, 0x6f800000, v6
v_rcp_f32 v6, v6
s_or_b64 s[34:35], s[34:35], vcc
s_add_u32 s8, s28, 0x0
v_pk_mul_f32 v[128:129], v[128:129], v[6:7] op_sel_hi:[1,0]
v_pk_mul_f32 v[130:131], v[130:131], v[6:7] op_sel_hi:[1,0]
v_pk_mul_f32 v[132:133], v[132:133], v[6:7] op_sel_hi:[1,0]
v_pk_mul_f32 v[134:135], v[134:135], v[6:7] op_sel_hi:[1,0]
v_cvt_pk_bf16_f32 v128, v128, v129
v_cvt_pk_bf16_f32 v129, v130, v131
v_cvt_pk_bf16_f32 v130, v132, v133
v_cvt_pk_bf16_f32 v131, v134, v135
buffer_store_dwordx4 v[128:131], v3, s[88:91], s8 offen sc1
s_add_u32 s8, s28, 0x2000
v_pk_mul_f32 v[136:137], v[136:137], v[6:7] op_sel_hi:[1,0]
v_pk_mul_f32 v[138:139], v[138:139], v[6:7] op_sel_hi:[1,0]
v_pk_mul_f32 v[140:141], v[140:141], v[6:7] op_sel_hi:[1,0]
v_pk_mul_f32 v[142:143], v[142:143], v[6:7] op_sel_hi:[1,0]
v_cvt_pk_bf16_f32 v136, v136, v137
v_cvt_pk_bf16_f32 v137, v138, v139
v_cvt_pk_bf16_f32 v138, v140, v141
v_cvt_pk_bf16_f32 v139, v142, v143
buffer_store_dwordx4 v[136:139], v3, s[88:91], s8 offen sc1
s_add_u32 s8, s28, 0x4000
v_pk_mul_f32 v[144:145], v[144:145], v[6:7] op_sel_hi:[1,0]
v_pk_mul_f32 v[146:147], v[146:147], v[6:7] op_sel_hi:[1,0]
v_pk_mul_f32 v[148:149], v[148:149], v[6:7] op_sel_hi:[1,0]
v_pk_mul_f32 v[150:151], v[150:151], v[6:7] op_sel_hi:[1,0]
v_cvt_pk_bf16_f32 v144, v144, v145
v_cvt_pk_bf16_f32 v145, v146, v147
v_cvt_pk_bf16_f32 v146, v148, v149
v_cvt_pk_bf16_f32 v147, v150, v151
buffer_store_dwordx4 v[144:147], v3, s[88:91], s8 offen sc1
s_add_u32 s8, s28, 0x6000
v_pk_mul_f32 v[152:153], v[152:153], v[6:7] op_sel_hi:[1,0]
v_pk_mul_f32 v[154:155], v[154:155], v[6:7] op_sel_hi:[1,0]
v_pk_mul_f32 v[156:157], v[156:157], v[6:7] op_sel_hi:[1,0]
v_pk_mul_f32 v[158:159], v[158:159], v[6:7] op_sel_hi:[1,0]
v_cvt_pk_bf16_f32 v152, v152, v153
v_cvt_pk_bf16_f32 v153, v154, v155
v_cvt_pk_bf16_f32 v154, v156, v157
v_cvt_pk_bf16_f32 v155, v158, v159
buffer_store_dwordx4 v[152:155], v3, s[88:91], s8 offen sc1
v_accvgpr_read_b32 v6, a226
v_accvgpr_read_b32 v7, a227
v_add_f32 v6, v6, v7
v_cmp_nge_f32 vcc, 0x6f800000, v6
v_rcp_f32 v6, v6
s_or_b64 s[34:35], s[34:35], vcc
s_add_u32 s8, s29, 0x0
v_pk_mul_f32 v[160:161], v[160:161], v[6:7] op_sel_hi:[1,0]
v_pk_mul_f32 v[162:163], v[162:163], v[6:7] op_sel_hi:[1,0]
v_pk_mul_f32 v[164:165], v[164:165], v[6:7] op_sel_hi:[1,0]
v_pk_mul_f32 v[166:167], v[166:167], v[6:7] op_sel_hi:[1,0]
v_cvt_pk_bf16_f32 v160, v160, v161
v_cvt_pk_bf16_f32 v161, v162, v163
v_cvt_pk_bf16_f32 v162, v164, v165
v_cvt_pk_bf16_f32 v163, v166, v167
buffer_store_dwordx4 v[160:163], v3, s[88:91], s8 offen sc1
s_add_u32 s8, s29, 0x2000
v_pk_mul_f32 v[168:169], v[168:169], v[6:7] op_sel_hi:[1,0]
v_pk_mul_f32 v[170:171], v[170:171], v[6:7] op_sel_hi:[1,0]
v_pk_mul_f32 v[172:173], v[172:173], v[6:7] op_sel_hi:[1,0]
v_pk_mul_f32 v[174:175], v[174:175], v[6:7] op_sel_hi:[1,0]
v_cvt_pk_bf16_f32 v168, v168, v169
v_cvt_pk_bf16_f32 v169, v170, v171
v_cvt_pk_bf16_f32 v170, v172, v173
v_cvt_pk_bf16_f32 v171, v174, v175
buffer_store_dwordx4 v[168:171], v3, s[88:91], s8 offen sc1
s_add_u32 s8, s29, 0x4000
v_pk_mul_f32 v[176:177], v[176:177], v[6:7] op_sel_hi:[1,0]
v_pk_mul_f32 v[178:179], v[178:179], v[6:7] op_sel_hi:[1,0]
v_pk_mul_f32 v[180:181], v[180:181], v[6:7] op_sel_hi:[1,0]
v_pk_mul_f32 v[182:183], v[182:183], v[6:7] op_sel_hi:[1,0]
v_cvt_pk_bf16_f32 v176, v176, v177
v_cvt_pk_bf16_f32 v177, v178, v179
v_cvt_pk_bf16_f32 v178, v180, v181
v_cvt_pk_bf16_f32 v179, v182, v183
buffer_store_dwordx4 v[176:179], v3, s[88:91], s8 offen sc1
s_add_u32 s8, s29, 0x6000
v_pk_mul_f32 v[184:185], v[184:185], v[6:7] op_sel_hi:[1,0]
v_pk_mul_f32 v[186:187], v[186:187], v[6:7] op_sel_hi:[1,0]
v_pk_mul_f32 v[188:189], v[188:189], v[6:7] op_sel_hi:[1,0]
v_pk_mul_f32 v[190:191], v[190:191], v[6:7] op_sel_hi:[1,0]
v_cvt_pk_bf16_f32 v184, v184, v185
v_cvt_pk_bf16_f32 v185, v186, v187
v_cvt_pk_bf16_f32 v186, v188, v189
v_cvt_pk_bf16_f32 v187, v190, v191
buffer_store_dwordx4 v[184:187], v3, s[88:91], s8 offen sc1
s_branch L_att_h1_1
L_att_j0:
s_cmp_ge_u32 s4, 2
s_cbranch_scc1 L_att_nl0_1
L_att_nl0_0:
v_mfma_f32_16x16x32_bf16 v[16:19], a[0:3], a[160:163], v[96:99]
ds_read_b128 a[128:131], v1 offset:24576
v_mov_b32 v240, 0
v_mfma_f32_16x16x32_bf16 v[16:19], a[4:7], a[164:167], v[16:19]
ds_read_b128 a[132:135], v1 offset:25600
s_add_u32 m0, s27, 0x0
v_mfma_f32_16x16x32_bf16 v[16:19], a[8:11], a[168:171], v[16:19]
buffer_load_dwordx4 v3, s[48:51], s32 offen offset:0 sc1 lds
v_mfma_f32_16x16x32_bf16 v[16:19], a[12:15], a[172:175], v[16:19]
ds_read_b128 a[136:139], v1 offset:26624
v_mov_b32 v241, 0
v_mfma_f32_16x16x32_bf16 v[20:23], a[0:3], a[176:179], v[84:87]
ds_read_b128 a[140:143], v1 offset:27648
v_mov_b32 v242, 0
v_mfma_f32_16x16x32_bf16 v[20:23], a[4:7], a[180:183], v[20:23]
ds_read_b128 a[144:147], v1 offset:28672
v_mov_b32 v243, 0
v_mfma_f32_16x16x32_bf16 v[20:23], a[8:11], a[184:187], v[20:23]
ds_read_b128 a[148:151], v1 offset:29696
s_mov_b32 s9, 0x0
v_mfma_f32_16x16x32_bf16 v[20:23], a[12:15], a[188:191], v[20:23]
buffer_load_dword a244, v8, s[72:75], s9 offen
v_mfma_f32_16x16x32_bf16 v[24:27], a[0:3], a[192:195], v[88:91]
ds_read_b128 a[152:155], v1 offset:30720
v_mov_b32 v244, 0
v_mfma_f32_16x16x32_bf16 v[24:27], a[4:7], a[196:199], v[24:27]
ds_read_b128 a[156:159], v1 offset:31744
v_exp_f32 v16, v16
v_mfma_f32_16x16x32_bf16 v[24:27], a[8:11], a[200:203], v[24:27]
v_exp_f32 v17, v17
v_mfma_f32_16x16x32_bf16 v[24:27], a[12:15], a[204:207], v[24:27]
v_exp_f32 v18, v18
v_mfma_f32_16x16x32_bf16 v[28:31], a[0:3], a[208:211], v[92:95]
buffer_load_dwordx4 v3, s[48:51], s32 offen offset:1024 sc1 lds
v_mfma_f32_16x16x32_bf16 v[28:31], a[4:7], a[212:215], v[28:31]
v_exp_f32 v19, v19
v_mfma_f32_16x16x32_bf16 v[28:31], a[8:11], a[216:219], v[28:31]
v_exp_f32 v20, v20
v_mfma_f32_16x16x32_bf16 v[28:31], a[12:15], a[220:223], v[28:31]
v_exp_f32 v21, v21
v_mfma_f32_16x16x32_bf16 v[32:35], a[16:19], a[160:163], v[100:103]
v_exp_f32 v22, v22
v_mfma_f32_16x16x32_bf16 v[32:35], a[20:23], a[164:167], v[32:35]
buffer_load_dwordx4 v3, s[48:51], s32 offen offset:2048 sc1 lds
v_mfma_f32_16x16x32_bf16 v[32:35], a[24:27], a[168:171], v[32:35]
v_exp_f32 v23, v23
v_mfma_f32_16x16x32_bf16 v[32:35], a[28:31], a[172:175], v[32:35]
v_exp_f32 v24, v24
v_mfma_f32_16x16x32_bf16 v[36:39], a[16:19], a[176:179], v[84:87]
v_exp_f32 v25, v25
v_mfma_f32_16x16x32_bf16 v[36:39], a[20:23], a[180:183], v[36:39]
v_exp_f32 v26, v26
v_mfma_f32_16x16x32_bf16 v[36:39], a[24:27], a[184:187], v[36:39]
buffer_load_dwordx4 v3, s[48:51], s32 offen offset:3072 sc1 lds
v_mfma_f32_16x16x32_bf16 v[36:39], a[28:31], a[188:191], v[36:39]
v_exp_f32 v27, v27
v_mfma_f32_16x16x32_bf16 v[40:43], a[16:19], a[192:195], v[88:91]
v_exp_f32 v28, v28
v_mfma_f32_16x16x32_bf16 v[40:43], a[20:23], a[196:199], v[40:43]
v_exp_f32 v29, v29
v_mfma_f32_16x16x32_bf16 v[40:43], a[24:27], a[200:203], v[40:43]
s_mov_b32 s9, 0x0
v_exp_f32 v30, v30
v_mfma_f32_16x16x32_bf16 v[40:43], a[28:31], a[204:207], v[40:43]
buffer_load_dword a244, v8, s[64:67], s9 offen
v_mfma_f32_16x16x32_bf16 v[44:47], a[16:19], a[208:211], v[92:95]
v_exp_f32 v31, v31
v_mfma_f32_16x16x32_bf16 v[44:47], a[20:23], a[212:215], v[44:47]
v_exp_f32 v32, v32
v_mfma_f32_16x16x32_bf16 v[44:47], a[24:27], a[216:219], v[44:47]
v_exp_f32 v33, v33
v_mfma_f32_16x16x32_bf16 v[44:47], a[28:31], a[220:223], v[44:47]
s_waitcnt lgkmcnt(0)
v_cvt_pk_bf16_f32 v48, v16, v17
v_cvt_pk_bf16_f32 v49, v18, v19
v_cvt_pk_bf16_f32 v52, v20, v21
v_cvt_pk_bf16_f32 v53, v22, v23
v_cvt_pk_bf16_f32 v56, v24, v25
v_cvt_pk_bf16_f32 v57, v26, v27
v_mov_b32 v245, 0
v_mov_b32 v246, 0
v_mov_b32 v247, 0
v_mfma_f32_16x16x32_bf16 v[20:23], a[128:131], a[176:179], v[84:87]
s_add_u32 m0, s27, 0x1000
v_exp_f32 v34, v34
v_mfma_f32_16x16x32_bf16 v[20:23], a[132:135], a[180:183], v[20:23]
buffer_load_dwordx4 v3, s[48:51], s7 offen offset:0 sc1 lds
v_mfma_f32_16x16x32_bf16 v[20:23], a[136:139], a[184:187], v[20:23]
v_exp_f32 v35, v35
v_mfma_f32_16x16x32_bf16 v[20:23], a[140:143], a[188:191], v[20:23]
ds_read_b128 a[32:35], v1 offset:16384
v_cvt_pk_bf16_f32 v60, v28, v29
v_mfma_f32_16x16x32_bf16 v[24:27], a[128:131], a[192:195], v[88:91]
v_exp_f32 v36, v36
v_mfma_f32_16x16x32_bf16 v[24:27], a[132:135], a[196:199], v[24:27]
ds_read_b128 a[36:39], v1 offset:17408
v_cvt_pk_bf16_f32 v61, v30, v31
v_mfma_f32_16x16x32_bf16 v[24:27], a[136:139], a[200:203], v[24:27]
buffer_load_dwordx4 v3, s[48:51], s7 offen offset:1024 sc1 lds
v_mfma_f32_16x16x32_bf16 v[24:27], a[140:143], a[204:207], v[24:27]
ds_read_b128 a[40:43], v1 offset:18432
v_cvt_pk_bf16_f32 v50, v32, v33
v_mfma_f32_16x16x32_bf16 v[28:31], a[128:131], a[208:211], v[92:95]
v_exp_f32 v37, v37
v_mfma_f32_16x16x32_bf16 v[28:31], a[132:135], a[212:215], v[28:31]
ds_read_b128 a[44:47], v1 offset:19456
v_cvt_pk_bf16_f32 v51, v34, v35
v_mfma_f32_16x16x32_bf16 v[28:31], a[136:139], a[216:219], v[28:31]
buffer_load_dwordx4 v3, s[48:51], s7 offen offset:2048 sc1 lds
v_mfma_f32_16x16x32_bf16 v[28:31], a[140:143], a[220:223], v[28:31]
s_mov_b32 s9, 0x400000
v_exp_f32 v38, v38
v_exp_f32 v39, v39
v_cvt_pk_bf16_f32 v54, v36, v37
v_cvt_pk_bf16_f32 v55, v38, v39
v_mfma_f32_16x16x32_bf16 v[36:39], a[144:147], a[176:179], v[84:87]
ds_read_b128 a[48:51], v1 offset:20480
v_exp_f32 v40, v40
v_mfma_f32_16x16x32_bf16 v[36:39], a[148:151], a[180:183], v[36:39]
ds_read_b128 a[52:55], v1 offset:21504
v_exp_f32 v41, v41
v_mfma_f32_16x16x32_bf16 v[36:39], a[152:155], a[184:187], v[36:39]
buffer_load_dword a244, v8, s[64:67], s9 offen
v_mfma_f32_16x16x32_bf16 v[36:39], a[156:159], a[188:191], v[36:39]
ds_read_b128 a[56:59], v1 offset:22528
v_cvt_pk_bf16_f32 v58, v40, v41
v_exp_f32 v42, v42
v_exp_f32 v43, v43
s_nop 0
v_cvt_pk_bf16_f32 v59, v42, v43
v_mfma_f32_16x16x32_bf16 v[40:43], a[144:147], a[192:195], v[88:91]
buffer_load_dwordx4 v3, s[48:51], s7 offen offset:3072 sc1 lds
v_mfma_f32_16x16x32_bf16 v[40:43], a[148:151], a[196:199], v[40:43]
ds_read_b128 a[60:63], v1 offset:23552
v_xor_b32 v1, 0x8000, v1
v_mfma_f32_16x16x32_bf16 v[40:43], a[152:155], a[200:203], v[40:43]
s_add_u32 s32, s32, 0x8000
v_exp_f32 v44, v44
v_mfma_f32_16x16x32_bf16 v[40:43], a[156:159], a[204:207], v[40:43]
s_add_u32 s7, s7, 0x8000
v_exp_f32 v45, v45
v_exp_f32 v46, v46
v_exp_f32 v47, v47
v_cvt_pk_bf16_f32 v62, v44, v45
v_cvt_pk_bf16_f32 v63, v46, v47
v_mfma_f32_16x16x32_bf16 v[44:47], a[144:147], a[208:211], v[92:95]
s_xor_b32 s27, s27, 0x38000
v_exp_f32 v20, v20
v_mfma_f32_16x16x32_bf16 v[44:47], a[148:151], a[212:215], v[44:47]
v_exp_f32 v21, v21
v_mfma_f32_16x16x32_bf16 v[44:47], a[152:155], a[216:219], v[44:47]
s_waitcnt vmcnt(11) lgkmcnt(0)
v_exp_f32 v22, v22
v_mfma_f32_16x16x32_bf16 v[44:47], a[156:159], a[220:223], v[44:47]
s_barrier
v_cvt_pk_bf16_f32 v68, v20, v21
v_exp_f32 v23, v23
v_exp_f32 v24, v24
v_exp_f32 v25, v25
v_exp_f32 v26, v26
v_exp_f32 v27, v27
v_cvt_pk_bf16_f32 v69, v22, v23
s_cmp_lg_u32 s33, 0
s_cbranch_scc1 L_sig_bn0
s_lshl_b32 s8, s6, 2
s_add_u32 s8, s8, 192
s_cmp_lg_u32 s4, 0
s_cbranch_scc1 L_sig_bn0
v_mov_b32 v4, 1
s_mov_b64 exec, 1
buffer_atomic_add v4, off, s[84:87], s8 sc1
s_mov_b64 exec, -1
L_sig_bn0:
s_branch L_att_l1_0
L_att_nl0_1:
v_mfma_f32_16x16x32_bf16 v[16:19], a[0:3], a[160:163], v[80:83]
ds_read_b128 a[128:131], v1 offset:24576
v_mov_b32 v240, 0
v_mfma_f32_16x16x32_bf16 v[16:19], a[4:7], a[164:167], v[16:19]
ds_read_b128 a[132:135], v1 offset:25600
s_add_u32 m0, s27, 0x0
v_mfma_f32_16x16x32_bf16 v[16:19], a[8:11], a[168:171], v[16:19]
buffer_load_dwordx4 v3, s[48:51], s32 offen offset:0 sc1 lds
v_mfma_f32_16x16x32_bf16 v[16:19], a[12:15], a[172:175], v[16:19]
ds_read_b128 a[136:139], v1 offset:26624
v_mov_b32 v241, 0
v_mfma_f32_16x16x32_bf16 v[20:23], a[0:3], a[176:179], v[84:87]
ds_read_b128 a[140:143], v1 offset:27648
v_mov_b32 v242, 0
v_mfma_f32_16x16x32_bf16 v[20:23], a[4:7], a[180:183], v[20:23]
ds_read_b128 a[144:147], v1 offset:28672
v_mov_b32 v243, 0
v_mfma_f32_16x16x32_bf16 v[20:23], a[8:11], a[184:187], v[20:23]
ds_read_b128 a[148:151], v1 offset:29696
s_mov_b32 s9, 0x0
v_mfma_f32_16x16x32_bf16 v[20:23], a[12:15], a[188:191], v[20:23]
buffer_load_dword a244, v8, s[72:75], s9 offen
v_mfma_f32_16x16x32_bf16 v[24:27], a[0:3], a[192:195], v[88:91]
ds_read_b128 a[152:155], v1 offset:30720
v_mov_b32 v244, 0
v_mfma_f32_16x16x32_bf16 v[24:27], a[4:7], a[196:199], v[24:27]
ds_read_b128 a[156:159], v1 offset:31744
v_exp_f32 v16, v16
v_mfma_f32_16x16x32_bf16 v[24:27], a[8:11], a[200:203], v[24:27]
v_exp_f32 v17, v17
v_mfma_f32_16x16x32_bf16 v[24:27], a[12:15], a[204:207], v[24:27]
v_exp_f32 v18, v18
v_mfma_f32_16x16x32_bf16 v[28:31], a[0:3], a[208:211], v[92:95]
buffer_load_dwordx4 v3, s[48:51], s32 offen offset:1024 sc1 lds
v_mfma_f32_16x16x32_bf16 v[28:31], a[4:7], a[212:215], v[28:31]
v_exp_f32 v19, v19
v_mfma_f32_16x16x32_bf16 v[28:31], a[8:11], a[216:219], v[28:31]
v_exp_f32 v20, v20
v_mfma_f32_16x16x32_bf16 v[28:31], a[12:15], a[220:223], v[28:31]
v_exp_f32 v21, v21
v_mfma_f32_16x16x32_bf16 v[32:35], a[16:19], a[160:163], v[80:83]
v_exp_f32 v22, v22
v_mfma_f32_16x16x32_bf16 v[32:35], a[20:23], a[164:167], v[32:35]
buffer_load_dwordx4 v3, s[48:51], s32 offen offset:2048 sc1 lds
v_mfma_f32_16x16x32_bf16 v[32:35], a[24:27], a[168:171], v[32:35]
v_exp_f32 v23, v23
v_mfma_f32_16x16x32_bf16 v[32:35], a[28:31], a[172:175], v[32:35]
v_exp_f32 v24, v24
v_mfma_f32_16x16x32_bf16 v[36:39], a[16:19], a[176:179], v[84:87]
v_exp_f32 v25, v25
v_mfma_f32_16x16x32_bf16 v[36:39], a[20:23], a[180:183], v[36:39]
v_exp_f32 v26, v26
v_mfma_f32_16x16x32_bf16 v[36:39], a[24:27], a[184:187], v[36:39]
buffer_load_dwordx4 v3, s[48:51], s32 offen offset:3072 sc1 lds
v_mfma_f32_16x16x32_bf16 v[36:39], a[28:31], a[188:191], v[36:39]
v_exp_f32 v27, v27
v_mfma_f32_16x16x32_bf16 v[40:43], a[16:19], a[192:195], v[88:91]
v_exp_f32 v28, v28
v_mfma_f32_16x16x32_bf16 v[40:43], a[20:23], a[196:199], v[40:43]
v_exp_f32 v29, v29
v_mfma_f32_16x16x32_bf16 v[40:43], a[24:27], a[200:203], v[40:43]
s_mov_b32 s9, 0x0
v_exp_f32 v30, v30
v_mfma_f32_16x16x32_bf16 v[40:43], a[28:31], a[204:207], v[40:43]
buffer_load_dword a244, v8, s[64:67], s9 offen
v_mfma_f32_16x16x32_bf16 v[44:47], a[16:19], a[208:211], v[92:95]
v_exp_f32 v31, v31
v_mfma_f32_16x16x32_bf16 v[44:47], a[20:23], a[212:215], v[44:47]
v_exp_f32 v32, v32
v_mfma_f32_16x16x32_bf16 v[44:47], a[24:27], a[216:219], v[44:47]
v_exp_f32 v33, v33
v_mfma_f32_16x16x32_bf16 v[44:47], a[28:31], a[220:223], v[44:47]
s_waitcnt lgkmcnt(0)
v_cvt_pk_bf16_f32 v48, v16, v17
v_cvt_pk_bf16_f32 v49, v18, v19
v_cvt_pk_bf16_f32 v52, v20, v21
v_cvt_pk_bf16_f32 v53, v22, v23
v_cvt_pk_bf16_f32 v56, v24, v25
v_cvt_pk_bf16_f32 v57, v26, v27
v_mov_b32 v245, 0
v_mov_b32 v246, 0
v_mov_b32 v247, 0
v_mfma_f32_16x16x32_bf16 v[16:19], a[128:131], a[160:163], v[96:99]
ds_read_b128 a[32:35], v1 offset:16384
v_cvt_pk_bf16_f32 v60, v28, v29
v_mfma_f32_16x16x32_bf16 v[16:19], a[132:135], a[164:167], v[16:19]
s_add_u32 m0, s27, 0x1000
v_exp_f32 v34, v34
v_mfma_f32_16x16x32_bf16 v[16:19], a[136:139], a[168:171], v[16:19]
buffer_load_dwordx4 v3, s[48:51], s7 offen offset:0 sc1 lds
v_mfma_f32_16x16x32_bf16 v[16:19], a[140:143], a[172:175], v[16:19]
ds_read_b128 a[36:39], v1 offset:17408
v_cvt_pk_bf16_f32 v61, v30, v31
v_mfma_f32_16x16x32_bf16 v[20:23], a[128:131], a[176:179], v[84:87]
v_exp_f32 v35, v35
v_mfma_f32_16x16x32_bf16 v[20:23], a[132:135], a[180:183], v[20:23]
v_exp_f32 v36, v36
v_mfma_f32_16x16x32_bf16 v[20:23], a[136:139], a[184:187], v[20:23]
ds_read_b128 a[40:43], v1 offset:18432
v_cvt_pk_bf16_f32 v50, v32, v33
v_mfma_f32_16x16x32_bf16 v[20:23], a[140:143], a[188:191], v[20:23]
buffer_load_dwordx4 v3, s[48:51], s7 offen offset:1024 sc1 lds
v_mfma_f32_16x16x32_bf16 v[24:27], a[128:131], a[192:195], v[88:91]
v_exp_f32 v37, v37
v_mfma_f32_16x16x32_bf16 v[24:27], a[132:135], a[196:199], v[24:27]
ds_read_b128 a[44:47], v1 offset:19456
v_cvt_pk_bf16_f32 v51, v34, v35
v_mfma_f32_16x16x32_bf16 v[24:27], a[136:139], a[200:203], v[24:27]
v_exp_f32 v38, v38
v_mfma_f32_16x16x32_bf16 v[24:27], a[140:143], a[204:207], v[24:27]
v_exp_f32 v39, v39
v_mfma_f32_16x16x32_bf16 v[28:31], a[128:131], a[208:211], v[92:95]
v_exp_f32 v40, v40
v_mfma_f32_16x16x32_bf16 v[28:31], a[132:135], a[212:215], v[28:31]
buffer_load_dwordx4 v3, s[48:51], s7 offen offset:2048 sc1 lds
v_mfma_f32_16x16x32_bf16 v[28:31], a[136:139], a[216:219], v[28:31]
ds_read_b128 a[48:51], v1 offset:20480
v_cvt_pk_bf16_f32 v54, v36, v37
v_mfma_f32_16x16x32_bf16 v[28:31], a[140:143], a[220:223], v[28:31]
v_exp_f32 v41, v41
v_mfma_f32_16x16x32_bf16 v[32:35], a[144:147], a[160:163], v[100:103]
ds_read_b128 a[52:55], v1 offset:21504
v_cvt_pk_bf16_f32 v55, v38, v39
v_mfma_f32_16x16x32_bf16 v[32:35], a[148:151], a[164:167], v[32:35]
s_mov_b32 s9, 0x400000
v_exp_f32 v42, v42
v_mfma_f32_16x16x32_bf16 v[32:35], a[152:155], a[168:171], v[32:35]
buffer_load_dword a244, v8, s[64:67], s9 offen
v_mfma_f32_16x16x32_bf16 v[32:35], a[156:159], a[172:175], v[32:35]
ds_read_b128 a[56:59], v1 offset:22528
v_cvt_pk_bf16_f32 v58, v40, v41
v_mfma_f32_16x16x32_bf16 v[36:39], a[144:147], a[176:179], v[84:87]
v_exp_f32 v43, v43
v_mfma_f32_16x16x32_bf16 v[36:39], a[148:151], a[180:183], v[36:39]
v_exp_f32 v44, v44
v_mfma_f32_16x16x32_bf16 v[36:39], a[152:155], a[184:187], v[36:39]
ds_read_b128 a[60:63], v1 offset:23552
v_xor_b32 v1, 0x8000, v1
v_mfma_f32_16x16x32_bf16 v[36:39], a[156:159], a[188:191], v[36:39]
buffer_load_dwordx4 v3, s[48:51], s7 offen offset:3072 sc1 lds
v_cvt_pk_bf16_f32 v59, v42, v43
v_mfma_f32_16x16x32_bf16 v[40:43], a[144:147], a[192:195], v[88:91]
s_add_u32 s32, s32, 0x8000
v_exp_f32 v45, v45
v_mfma_f32_16x16x32_bf16 v[40:43], a[148:151], a[196:199], v[40:43]
s_add_u32 s7, s7, 0x8000
v_exp_f32 v46, v46
v_mfma_f32_16x16x32_bf16 v[40:43], a[152:155], a[200:203], v[40:43]
s_xor_b32 s27, s27, 0x38000
v_exp_f32 v47, v47
v_mfma_f32_16x16x32_bf16 v[40:43], a[156:159], a[204:207], v[40:43]
v_exp_f32 v16, v16
v_cvt_pk_bf16_f32 v62, v44, v45
v_cvt_pk_bf16_f32 v63, v46, v47
v_mfma_f32_16x16x32_bf16 v[44:47], a[144:147], a[208:211], v[92:95]
v_exp_f32 v17, v17
v_mfma_f32_16x16x32_bf16 v[44:47], a[148:151], a[212:215], v[44:47]
v_exp_f32 v18, v18
v_mfma_f32_16x16x32_bf16 v[44:47], a[152:155], a[216:219], v[44:47]
s_waitcnt vmcnt(11) lgkmcnt(0)
v_exp_f32 v19, v19
v_mfma_f32_16x16x32_bf16 v[44:47], a[156:159], a[220:223], v[44:47]
s_barrier
v_cvt_pk_bf16_f32 v64, v16, v17
v_exp_f32 v20, v20
v_exp_f32 v21, v21
v_exp_f32 v22, v22
v_exp_f32 v23, v23
v_exp_f32 v24, v24
v_exp_f32 v25, v25
v_exp_f32 v26, v26
v_exp_f32 v27, v27
v_cvt_pk_bf16_f32 v65, v18, v19
v_cvt_pk_bf16_f32 v68, v20, v21
v_cvt_pk_bf16_f32 v69, v22, v23
s_cmp_lg_u32 s33, 0
s_cbranch_scc1 L_sig_bn1
s_lshl_b32 s8, s6, 2
s_add_u32 s8, s8, 192
s_cmp_lg_u32 s4, 0
s_cbranch_scc1 L_sig_bn1
v_mov_b32 v4, 1
s_mov_b64 exec, 1
buffer_atomic_add v4, off, s[84:87], s8 sc1
s_mov_b64 exec, -1
L_sig_bn1:
s_branch L_att_l1_1
L_att_seven0:
v_mfma_f32_16x16x32_bf16 v[192:195], a[32:35], v[56:59], v[192:195]
v_exp_f32 v30, v30
v_mfma_f32_16x16x32_bf16 v[224:227], a[32:35], v[60:63], v[224:227]
ds_read_b128 a[0:3], v1 offset:8192
v_cvt_pk_bf16_f32 v72, v24, v25
v_mfma_f32_16x16x32_bf16 v[228:231], a[36:39], v[60:63], v[228:231]
ds_read_b128 a[4:7], v1 offset:9216
v_cvt_pk_bf16_f32 v73, v26, v27
v_mfma_f32_16x16x32_bf16 v[196:199], a[36:39], v[56:59], v[196:199]
s_add_u32 m0, s27, 0x0
v_exp_f32 v31, v31
v_mfma_f32_16x16x32_bf16 v[200:203], a[40:43], v[56:59], v[200:203]
ds_read_b128 a[8:11], v1 offset:10240
v_cvt_pk_bf16_f32 v76, v28, v29
v_mfma_f32_16x16x32_bf16 v[232:235], a[40:43], v[60:63], v[232:235]
buffer_load_dwordx4 v3, s[48:51], s32 offen offset:0 sc1 lds
v_mfma_f32_16x16x32_bf16 v[236:239], a[44:47], v[60:63], v[236:239]
v_exp_f32 v40, v40
v_mfma_f32_16x16x32_bf16 v[204:207], a[44:47], v[56:59], v[204:207]
ds_read_b128 a[12:15], v1 offset:11264
v_cvt_pk_bf16_f32 v77, v30, v31
v_mfma_f32_16x16x32_bf16 v[208:211], a[48:51], v[56:59], v[208:211]
ds_read_b128 a[16:19], v1 offset:12288
v_mfma_f32_16x16x32_bf16 v[240:243], a[48:51], v[60:63], v[240:243]
buffer_load_dwordx4 v3, s[48:51], s32 offen offset:1024 sc1 lds
v_mfma_f32_16x16x32_bf16 v[244:247], a[52:55], v[60:63], v[244:247]
ds_read_b128 a[20:23], v1 offset:13312
v_mfma_f32_16x16x32_bf16 v[212:215], a[52:55], v[56:59], v[212:215]
ds_read_b128 a[24:27], v1 offset:14336
v_mfma_f32_16x16x32_bf16 v[216:219], a[56:59], v[56:59], v[216:219]
ds_read_b128 a[28:31], v1 offset:15360
v_mfma_f32_16x16x32_bf16 v[248:251], a[56:59], v[60:63], v[248:251]
ds_read_b128 a[32:35], v1 offset:0
v_exp_f32 v41, v41
v_mfma_f32_16x16x32_bf16 v[252:255], a[60:63], v[60:63], v[252:255]
v_exp_f32 v42, v42
v_mfma_f32_16x16x32_bf16 v[220:223], a[60:63], v[56:59], v[220:223]
s_waitcnt lgkmcnt(5)
v_exp_f32 v43, v43
v_smfmac_f32_16x16x64_bf16 a[228:231], a[232:235], v[56:63], v9
ds_read_b128 a[36:39], v1 offset:1024
v_cvt_pk_bf16_f32 v74, v40, v41
v_mfma_f32_16x16x32_bf16 v[24:27], a[0:3], a[192:195], v[88:91]
ds_read_b128 a[40:43], v1 offset:2048
v_exp_f32 v44, v44
v_mfma_f32_16x16x32_bf16 v[24:27], a[4:7], a[196:199], v[24:27]
buffer_load_dwordx4 v3, s[48:51], s32 offen offset:2048 sc1 lds
v_mfma_f32_16x16x32_bf16 v[24:27], a[8:11], a[200:203], v[24:27]
v_exp_f32 v45, v45
v_mfma_f32_16x16x32_bf16 v[24:27], a[12:15], a[204:207], v[24:27]
ds_read_b128 a[44:47], v1 offset:3072
v_cvt_pk_bf16_f32 v75, v42, v43
v_mfma_f32_16x16x32_bf16 v[28:31], a[0:3], a[208:211], v[92:95]
ds_read_b128 a[48:51], v1 offset:4096
v_exp_f32 v46, v46
v_mfma_f32_16x16x32_bf16 v[28:31], a[4:7], a[212:215], v[28:31]
s_waitcnt lgkmcnt(5)
v_exp_f32 v47, v47
v_mfma_f32_16x16x32_bf16 v[28:31], a[8:11], a[216:219], v[28:31]
ds_read_b128 a[52:55], v1 offset:5120
v_cvt_pk_bf16_f32 v78, v44, v45
v_mfma_f32_16x16x32_bf16 v[28:31], a[12:15], a[220:223], v[28:31]
buffer_load_dwordx4 v3, s[48:51], s32 offen offset:3072 sc1 lds
v_mfma_f32_16x16x32_bf16 v[40:43], a[16:19], a[192:195], v[88:91]
ds_read_b128 a[56:59], v1 offset:6144
s_add_u32 s32, s32, 0x8000
v_mfma_f32_16x16x32_bf16 v[40:43], a[20:23], a[196:199], v[40:43]
ds_read_b128 a[60:63], v1 offset:7168
v_cvt_pk_bf16_f32 v79, v46, v47
v_mfma_f32_16x16x32_bf16 v[40:43], a[24:27], a[200:203], v[40:43]
v_exp_f32 v24, v24
v_mfma_f32_16x16x32_bf16 v[40:43], a[28:31], a[204:207], v[40:43]
v_exp_f32 v25, v25
v_mfma_f32_16x16x32_bf16 v[44:47], a[16:19], a[208:211], v[92:95]
v_exp_f32 v26, v26
v_mfma_f32_16x16x32_bf16 v[44:47], a[20:23], a[212:215], v[44:47]
v_exp_f32 v27, v27
v_mfma_f32_16x16x32_bf16 v[44:47], a[24:27], a[216:219], v[44:47]
v_exp_f32 v28, v28
v_mfma_f32_16x16x32_bf16 v[44:47], a[28:31], a[220:223], v[44:47]
s_waitcnt lgkmcnt(0)
v_exp_f32 v29, v29
v_mfma_f32_16x16x32_bf16 v[192:195], a[32:35], v[72:75], v[192:195]
s_add_u32 m0, s27, 0x1000
v_exp_f32 v30, v30
v_mfma_f32_16x16x32_bf16 v[224:227], a[32:35], v[76:79], v[224:227]
buffer_load_dwordx4 v3, s[48:51], s7 offen offset:0 sc1 lds
v_mfma_f32_16x16x32_bf16 v[228:231], a[36:39], v[76:79], v[228:231]
v_exp_f32 v31, v31
v_mfma_f32_16x16x32_bf16 v[196:199], a[36:39], v[72:75], v[196:199]
ds_read_b128 a[0:3], v1 offset:24576
v_cvt_pk_bf16_f32 v56, v24, v25
v_mfma_f32_16x16x32_bf16 v[200:203], a[40:43], v[72:75], v[200:203]
ds_read_b128 a[4:7], v1 offset:25600
v_cvt_pk_bf16_f32 v57, v26, v27
v_mfma_f32_16x16x32_bf16 v[232:235], a[40:43], v[76:79], v[232:235]
v_exp_f32 v40, v40
v_mfma_f32_16x16x32_bf16 v[236:239], a[44:47], v[76:79], v[236:239]
ds_read_b128 a[8:11], v1 offset:26624
v_cvt_pk_bf16_f32 v60, v28, v29
v_mfma_f32_16x16x32_bf16 v[204:207], a[44:47], v[72:75], v[204:207]
v_exp_f32 v41, v41
v_mfma_f32_16x16x32_bf16 v[208:211], a[48:51], v[72:75], v[208:211]
ds_read_b128 a[12:15], v1 offset:27648
v_cvt_pk_bf16_f32 v61, v30, v31
v_mfma_f32_16x16x32_bf16 v[240:243], a[48:51], v[76:79], v[240:243]
ds_read_b128 a[16:19], v1 offset:28672
v_cvt_pk_bf16_f32 v58, v40, v41
v_mfma_f32_16x16x32_bf16 v[244:247], a[52:55], v[76:79], v[244:247]
v_exp_f32 v42, v42
v_mfma_f32_16x16x32_bf16 v[212:215], a[52:55], v[72:75], v[212:215]
buffer_load_dwordx4 v3, s[48:51], s7 offen offset:1024 sc1 lds
v_mfma_f32_16x16x32_bf16 v[216:219], a[56:59], v[72:75], v[216:219]
ds_read_b128 a[20:23], v1 offset:29696
v_mfma_f32_16x16x32_bf16 v[248:251], a[56:59], v[76:79], v[248:251]
ds_read_b128 a[24:27], v1 offset:30720
v_mfma_f32_16x16x32_bf16 v[252:255], a[60:63], v[76:79], v[252:255]
ds_read_b128 a[28:31], v1 offset:31744
v_mfma_f32_16x16x32_bf16 v[220:223], a[60:63], v[72:75], v[220:223]
s_waitcnt lgkmcnt(4)
v_exp_f32 v43, v43
v_smfmac_f32_16x16x64_bf16 a[228:231], a[232:235], v[72:79], v9
ds_read_b128 a[32:35], v1 offset:16384
v_cvt_pk_bf16_f32 v59, v42, v43
v_mfma_f32_16x16x32_bf16 v[24:27], a[0:3], a[192:195], v[88:91]
ds_read_b128 a[36:39], v1 offset:17408
v_mfma_f32_16x16x32_bf16 v[24:27], a[4:7], a[196:199], v[24:27]
buffer_load_dwordx4 v3, s[48:51], s7 offen offset:2048 sc1 lds
v_mfma_f32_16x16x32_bf16 v[24:27], a[8:11], a[200:203], v[24:27]
ds_read_b128 a[40:43], v1 offset:18432
v_exp_f32 v44, v44
v_mfma_f32_16x16x32_bf16 v[24:27], a[12:15], a[204:207], v[24:27]
ds_read_b128 a[44:47], v1 offset:19456
v_exp_f32 v45, v45
v_mfma_f32_16x16x32_bf16 v[28:31], a[0:3], a[208:211], v[92:95]
ds_read_b128 a[48:51], v1 offset:20480
v_exp_f32 v46, v46
v_mfma_f32_16x16x32_bf16 v[28:31], a[4:7], a[212:215], v[28:31]
s_waitcnt lgkmcnt(5)
v_exp_f32 v47, v47
v_mfma_f32_16x16x32_bf16 v[28:31], a[8:11], a[216:219], v[28:31]
ds_read_b128 a[52:55], v1 offset:21504
v_cvt_pk_bf16_f32 v62, v44, v45
v_mfma_f32_16x16x32_bf16 v[28:31], a[12:15], a[220:223], v[28:31]
ds_read_b128 a[56:59], v1 offset:22528
v_cvt_pk_bf16_f32 v63, v46, v47
v_mfma_f32_16x16x32_bf16 v[40:43], a[16:19], a[192:195], v[88:91]
ds_read_b128 a[60:63], v1 offset:23552
v_xor_b32 v1, 0x8000, v1
v_mfma_f32_16x16x32_bf16 v[40:43], a[20:23], a[196:199], v[40:43]
buffer_load_dwordx4 v3, s[48:51], s7 offen offset:3072 sc1 lds
v_mfma_f32_16x16x32_bf16 v[40:43], a[24:27], a[200:203], v[40:43]
s_add_u32 s7, s7, 0x8000
v_exp_f32 v24, v24
v_mfma_f32_16x16x32_bf16 v[40:43], a[28:31], a[204:207], v[40:43]
s_xor_b32 s27, s27, 0x38000
v_exp_f32 v25, v25
v_mfma_f32_16x16x32_bf16 v[44:47], a[16:19], a[208:211], v[92:95]
v_exp_f32 v26, v26
v_mfma_f32_16x16x32_bf16 v[44:47], a[20:23], a[212:215], v[44:47]
v_exp_f32 v27, v27
v_mfma_f32_16x16x32_bf16 v[44:47], a[24:27], a[216:219], v[44:47]
s_waitcnt vmcnt(16) lgkmcnt(0)
v_exp_f32 v28, v28
v_mfma_f32_16x16x32_bf16 v[44:47], a[28:31], a[220:223], v[44:47]
s_barrier
v_exp_f32 v29, v29
L_att_sodd0:
v_mfma_f32_16x16x32_bf16 v[192:195], a[32:35], v[56:59], v[192:195]
v_exp_f32 v30, v30
v_mfma_f32_16x16x32_bf16 v[224:227], a[32:35], v[60:63], v[224:227]
ds_read_b128 a[0:3], v2 offset:8192
v_cvt_pk_bf16_f32 v72, v24, v25
v_mfma_f32_16x16x32_bf16 v[228:231], a[36:39], v[60:63], v[228:231]
ds_read_b128 a[4:7], v2 offset:9216
v_cvt_pk_bf16_f32 v73, v26, v27
v_mfma_f32_16x16x32_bf16 v[196:199], a[36:39], v[56:59], v[196:199]
s_add_u32 m0, s19, 0x0
v_exp_f32 v31, v31
v_mfma_f32_16x16x32_bf16 v[200:203], a[40:43], v[56:59], v[200:203]
ds_read_b128 a[8:11], v2 offset:10240
v_cvt_pk_bf16_f32 v76, v28, v29
v_mfma_f32_16x16x32_bf16 v[232:235], a[40:43], v[60:63], v[232:235]
buffer_load_dwordx4 v3, s[48:51], s32 offen offset:0 sc1 lds
v_mfma_f32_16x16x32_bf16 v[236:239], a[44:47], v[60:63], v[236:239]
v_exp_f32 v40, v40
v_mfma_f32_16x16x32_bf16 v[204:207], a[44:47], v[56:59], v[204:207]
ds_read_b128 a[12:15], v2 offset:11264
v_cvt_pk_bf16_f32 v77, v30, v31
v_mfma_f32_16x16x32_bf16 v[208:211], a[48:51], v[56:59], v[208:211]
ds_read_b128 a[16:19], v2 offset:12288
v_mfma_f32_16x16x32_bf16 v[240:243], a[48:51], v[60:63], v[240:243]
buffer_load_dwordx4 v3, s[48:51], s32 offen offset:1024 sc1 lds
v_mfma_f32_16x16x32_bf16 v[244:247], a[52:55], v[60:63], v[244:247]
ds_read_b128 a[20:23], v2 offset:13312
v_mfma_f32_16x16x32_bf16 v[212:215], a[52:55], v[56:59], v[212:215]
ds_read_b128 a[24:27], v2 offset:14336
v_mfma_f32_16x16x32_bf16 v[216:219], a[56:59], v[56:59], v[216:219]
ds_read_b128 a[28:31], v2 offset:15360
v_mfma_f32_16x16x32_bf16 v[248:251], a[56:59], v[60:63], v[248:251]
ds_read_b128 a[32:35], v2 offset:0
v_exp_f32 v41, v41
v_mfma_f32_16x16x32_bf16 v[252:255], a[60:63], v[60:63], v[252:255]
v_exp_f32 v42, v42
v_mfma_f32_16x16x32_bf16 v[220:223], a[60:63], v[56:59], v[220:223]
s_waitcnt lgkmcnt(5)
v_exp_f32 v43, v43
v_smfmac_f32_16x16x64_bf16 a[228:231], a[232:235], v[56:63], v9
ds_read_b128 a[36:39], v2 offset:1024
v_cvt_pk_bf16_f32 v74, v40, v41
v_mfma_f32_16x16x32_bf16 v[24:27], a[0:3], a[192:195], v[88:91]
ds_read_b128 a[40:43], v2 offset:2048
v_exp_f32 v44, v44
v_mfma_f32_16x16x32_bf16 v[24:27], a[4:7], a[196:199], v[24:27]
buffer_load_dwordx4 v3, s[48:51], s32 offen offset:2048 sc1 lds
v_mfma_f32_16x16x32_bf16 v[24:27], a[8:11], a[200:203], v[24:27]
v_exp_f32 v45, v45
v_mfma_f32_16x16x32_bf16 v[24:27], a[12:15], a[204:207], v[24:27]
ds_read_b128 a[44:47], v2 offset:3072
v_cvt_pk_bf16_f32 v75, v42, v43
v_mfma_f32_16x16x32_bf16 v[28:31], a[0:3], a[208:211], v[92:95]
ds_read_b128 a[48:51], v2 offset:4096
v_exp_f32 v46, v46
v_mfma_f32_16x16x32_bf16 v[28:31], a[4:7], a[212:215], v[28:31]
s_waitcnt lgkmcnt(5)
v_exp_f32 v47, v47
v_mfma_f32_16x16x32_bf16 v[28:31], a[8:11], a[216:219], v[28:31]
ds_read_b128 a[52:55], v2 offset:5120
v_cvt_pk_bf16_f32 v78, v44, v45
v_mfma_f32_16x16x32_bf16 v[28:31], a[12:15], a[220:223], v[28:31]
buffer_load_dwordx4 v3, s[48:51], s32 offen offset:3072 sc1 lds
v_mfma_f32_16x16x32_bf16 v[40:43], a[16:19], a[192:195], v[88:91]
ds_read_b128 a[56:59], v2 offset:6144
s_add_u32 s32, s32, 0x8000
v_mfma_f32_16x16x32_bf16 v[40:43], a[20:23], a[196:199], v[40:43]
ds_read_b128 a[60:63], v2 offset:7168
v_cvt_pk_bf16_f32 v79, v46, v47
v_mfma_f32_16x16x32_bf16 v[40:43], a[24:27], a[200:203], v[40:43]
v_exp_f32 v24, v24
v_mfma_f32_16x16x32_bf16 v[40:43], a[28:31], a[204:207], v[40:43]
v_exp_f32 v25, v25
v_mfma_f32_16x16x32_bf16 v[44:47], a[16:19], a[208:211], v[92:95]
v_exp_f32 v26, v26
v_mfma_f32_16x16x32_bf16 v[44:47], a[20:23], a[212:215], v[44:47]
v_exp_f32 v27, v27
v_mfma_f32_16x16x32_bf16 v[44:47], a[24:27], a[216:219], v[44:47]
v_exp_f32 v28, v28
v_mfma_f32_16x16x32_bf16 v[44:47], a[28:31], a[220:223], v[44:47]
s_waitcnt lgkmcnt(0)
v_exp_f32 v29, v29
v_mfma_f32_16x16x32_bf16 v[192:195], a[32:35], v[72:75], v[192:195]
v_exp_f32 v30, v30
v_mfma_f32_16x16x32_bf16 v[224:227], a[32:35], v[76:79], v[224:227]
v_exp_f32 v31, v31
v_mfma_f32_16x16x32_bf16 v[228:231], a[36:39], v[76:79], v[228:231]
v_exp_f32 v40, v40
v_mfma_f32_16x16x32_bf16 v[196:199], a[36:39], v[72:75], v[196:199]
s_add_u32 m0, s19, 0x1000
v_exp_f32 v41, v41
v_mfma_f32_16x16x32_bf16 v[200:203], a[40:43], v[72:75], v[200:203]
ds_read_b128 a[0:3], v2 offset:24576
v_cvt_pk_bf16_f32 v56, v24, v25
v_mfma_f32_16x16x32_bf16 v[232:235], a[40:43], v[76:79], v[232:235]
buffer_load_dwordx4 v3, s[48:51], s7 offen offset:0 sc1 lds
v_mfma_f32_16x16x32_bf16 v[236:239], a[44:47], v[76:79], v[236:239]
ds_read_b128 a[4:7], v2 offset:25600
v_cvt_pk_bf16_f32 v57, v26, v27
v_mfma_f32_16x16x32_bf16 v[204:207], a[44:47], v[72:75], v[204:207]
ds_read_b128 a[8:11], v2 offset:26624
v_cvt_pk_bf16_f32 v60, v28, v29
v_mfma_f32_16x16x32_bf16 v[208:211], a[48:51], v[72:75], v[208:211]
ds_read_b128 a[12:15], v2 offset:27648
v_cvt_pk_bf16_f32 v61, v30, v31
v_mfma_f32_16x16x32_bf16 v[240:243], a[48:51], v[76:79], v[240:243]
ds_read_b128 a[16:19], v2 offset:28672
v_cvt_pk_bf16_f32 v58, v40, v41
v_mfma_f32_16x16x32_bf16 v[244:247], a[52:55], v[76:79], v[244:247]
buffer_load_dwordx4 v3, s[48:51], s7 offen offset:1024 sc1 lds
v_mfma_f32_16x16x32_bf16 v[212:215], a[52:55], v[72:75], v[212:215]
ds_read_b128 a[20:23], v2 offset:29696
v_mfma_f32_16x16x32_bf16 v[216:219], a[56:59], v[72:75], v[216:219]
v_exp_f32 v42, v42
v_mfma_f32_16x16x32_bf16 v[248:251], a[56:59], v[76:79], v[248:251]
ds_read_b128 a[24:27], v2 offset:30720
v_mfma_f32_16x16x32_bf16 v[252:255], a[60:63], v[76:79], v[252:255]
ds_read_b128 a[28:31], v2 offset:31744
v_exp_f32 v43, v43
v_mfma_f32_16x16x32_bf16 v[220:223], a[60:63], v[72:75], v[220:223]
ds_read_b128 a[32:35], v2 offset:16384
v_cvt_pk_bf16_f32 v59, v42, v43
v_smfmac_f32_16x16x64_bf16 a[228:231], a[232:235], v[72:79], v9
ds_read_b128 a[36:39], v2 offset:17408
s_waitcnt lgkmcnt(6)
v_mfma_f32_16x16x32_bf16 v[24:27], a[0:3], a[192:195], v[88:91]
buffer_load_dwordx4 v3, s[48:51], s7 offen offset:2048 sc1 lds
v_mfma_f32_16x16x32_bf16 v[24:27], a[4:7], a[196:199], v[24:27]
ds_read_b128 a[40:43], v2 offset:18432
v_exp_f32 v44, v44
v_mfma_f32_16x16x32_bf16 v[24:27], a[8:11], a[200:203], v[24:27]
ds_read_b128 a[44:47], v2 offset:19456
v_exp_f32 v45, v45
v_mfma_f32_16x16x32_bf16 v[24:27], a[12:15], a[204:207], v[24:27]
ds_read_b128 a[48:51], v2 offset:20480
v_cvt_pk_bf16_f32 v62, v44, v45
v_mfma_f32_16x16x32_bf16 v[28:31], a[0:3], a[208:211], v[92:95]
v_exp_f32 v46, v46
v_mfma_f32_16x16x32_bf16 v[28:31], a[4:7], a[212:215], v[28:31]
s_waitcnt lgkmcnt(5)
v_exp_f32 v47, v47
v_mfma_f32_16x16x32_bf16 v[28:31], a[8:11], a[216:219], v[28:31]
ds_read_b128 a[52:55], v2 offset:21504
v_cvt_pk_bf16_f32 v63, v46, v47
v_mfma_f32_16x16x32_bf16 v[28:31], a[12:15], a[220:223], v[28:31]
buffer_load_dwordx4 v3, s[48:51], s7 offen offset:3072 sc1 lds
v_mfma_f32_16x16x32_bf16 v[40:43], a[16:19], a[192:195], v[88:91]
ds_read_b128 a[56:59], v2 offset:22528
s_add_u32 s7, s7, 0x8000
v_mfma_f32_16x16x32_bf16 v[40:43], a[20:23], a[196:199], v[40:43]
ds_read_b128 a[60:63], v2 offset:23552
v_xor_b32 v2, 0x38000, v2
v_mfma_f32_16x16x32_bf16 v[40:43], a[24:27], a[200:203], v[40:43]
s_xor_b32 s19, s19, 0x8000
v_exp_f32 v24, v24
v_mfma_f32_16x16x32_bf16 v[40:43], a[28:31], a[204:207], v[40:43]
s_sub_u32 s15, s15, 1
v_exp_f32 v25, v25
v_mfma_f32_16x16x32_bf16 v[44:47], a[16:19], a[208:211], v[92:95]
s_cmp_lg_u32 s15, 0
v_exp_f32 v26, v26
v_mfma_f32_16x16x32_bf16 v[44:47], a[20:23], a[212:215], v[44:47]
v_exp_f32 v27, v27
v_mfma_f32_16x16x32_bf16 v[44:47], a[24:27], a[216:219], v[44:47]
s_waitcnt vmcnt(16) lgkmcnt(0)
v_exp_f32 v28, v28
v_mfma_f32_16x16x32_bf16 v[44:47], a[28:31], a[220:223], v[44:47]
s_barrier
v_exp_f32 v29, v29
s_cbranch_scc1 L_att_seven0
s_branch L_att_sdone
L_att_seven1:
v_mfma_f32_16x16x32_bf16 v[192:195], a[32:35], v[56:59], v[192:195]
v_exp_f32 v30, v30
v_mfma_f32_16x16x32_bf16 v[224:227], a[32:35], v[60:63], v[224:227]
ds_read_b128 a[0:3], v1 offset:8192
v_cvt_pk_bf16_f32 v72, v24, v25
v_mfma_f32_16x16x32_bf16 v[228:231], a[36:39], v[60:63], v[228:231]
ds_read_b128 a[4:7], v1 offset:9216
v_cvt_pk_bf16_f32 v73, v26, v27
v_mfma_f32_16x16x32_bf16 v[196:199], a[36:39], v[56:59], v[196:199]
s_add_u32 m0, s27, 0x0
v_exp_f32 v31, v31
v_mfma_f32_16x16x32_bf16 v[200:203], a[40:43], v[56:59], v[200:203]
ds_read_b128 a[8:11], v1 offset:10240
v_cvt_pk_bf16_f32 v76, v28, v29
v_mfma_f32_16x16x32_bf16 v[232:235], a[40:43], v[60:63], v[232:235]
buffer_load_dwordx4 v3, s[48:51], s32 offen offset:0 sc1 lds
v_mfma_f32_16x16x32_bf16 v[236:239], a[44:47], v[60:63], v[236:239]
v_exp_f32 v40, v40
v_mfma_f32_16x16x32_bf16 v[204:207], a[44:47], v[56:59], v[204:207]
ds_read_b128 a[12:15], v1 offset:11264
v_cvt_pk_bf16_f32 v77, v30, v31
v_mfma_f32_16x16x32_bf16 v[208:211], a[48:51], v[56:59], v[208:211]
ds_read_b128 a[16:19], v1 offset:12288
v_mfma_f32_16x16x32_bf16 v[240:243], a[48:51], v[60:63], v[240:243]
buffer_load_dwordx4 v3, s[48:51], s32 offen offset:1024 sc1 lds
v_mfma_f32_16x16x32_bf16 v[244:247], a[52:55], v[60:63], v[244:247]
ds_read_b128 a[20:23], v1 offset:13312
v_mfma_f32_16x16x32_bf16 v[212:215], a[52:55], v[56:59], v[212:215]
ds_read_b128 a[24:27], v1 offset:14336
v_mfma_f32_16x16x32_bf16 v[216:219], a[56:59], v[56:59], v[216:219]
ds_read_b128 a[28:31], v1 offset:15360
v_mfma_f32_16x16x32_bf16 v[248:251], a[56:59], v[60:63], v[248:251]
ds_read_b128 a[32:35], v1 offset:0
v_exp_f32 v41, v41
v_mfma_f32_16x16x32_bf16 v[252:255], a[60:63], v[60:63], v[252:255]
v_exp_f32 v42, v42
v_mfma_f32_16x16x32_bf16 v[220:223], a[60:63], v[56:59], v[220:223]
s_waitcnt lgkmcnt(5)
v_exp_f32 v43, v43
v_smfmac_f32_16x16x64_bf16 a[228:231], a[232:235], v[56:63], v9
ds_read_b128 a[36:39], v1 offset:1024
v_cvt_pk_bf16_f32 v74, v40, v41
v_mfma_f32_16x16x32_bf16 v[24:27], a[0:3], a[192:195], v[88:91]
ds_read_b128 a[40:43], v1 offset:2048
v_exp_f32 v44, v44
v_mfma_f32_16x16x32_bf16 v[24:27], a[4:7], a[196:199], v[24:27]
buffer_load_dwordx4 v3, s[48:51], s32 offen offset:2048 sc1 lds
v_mfma_f32_16x16x32_bf16 v[24:27], a[8:11], a[200:203], v[24:27]
v_exp_f32 v45, v45
v_mfma_f32_16x16x32_bf16 v[24:27], a[12:15], a[204:207], v[24:27]
ds_read_b128 a[44:47], v1 offset:3072
v_cvt_pk_bf16_f32 v75, v42, v43
v_mfma_f32_16x16x32_bf16 v[28:31], a[0:3], a[208:211], v[92:95]
ds_read_b128 a[48:51], v1 offset:4096
v_exp_f32 v46, v46
v_mfma_f32_16x16x32_bf16 v[28:31], a[4:7], a[212:215], v[28:31]
s_waitcnt lgkmcnt(5)
v_exp_f32 v47, v47
v_mfma_f32_16x16x32_bf16 v[28:31], a[8:11], a[216:219], v[28:31]
ds_read_b128 a[52:55], v1 offset:5120
v_cvt_pk_bf16_f32 v78, v44, v45
v_mfma_f32_16x16x32_bf16 v[28:31], a[12:15], a[220:223], v[28:31]
buffer_load_dwordx4 v3, s[48:51], s32 offen offset:3072 sc1 lds
v_mfma_f32_16x16x32_bf16 v[40:43], a[16:19], a[192:195], v[88:91]
ds_read_b128 a[56:59], v1 offset:6144
s_add_u32 s32, s32, 0x8000
v_mfma_f32_16x16x32_bf16 v[40:43], a[20:23], a[196:199], v[40:43]
ds_read_b128 a[60:63], v1 offset:7168
v_cvt_pk_bf16_f32 v79, v46, v47
v_mfma_f32_16x16x32_bf16 v[40:43], a[24:27], a[200:203], v[40:43]
v_exp_f32 v24, v24
v_mfma_f32_16x16x32_bf16 v[40:43], a[28:31], a[204:207], v[40:43]
v_exp_f32 v25, v25
v_mfma_f32_16x16x32_bf16 v[44:47], a[16:19], a[208:211], v[92:95]
v_exp_f32 v26, v26
v_mfma_f32_16x16x32_bf16 v[44:47], a[20:23], a[212:215], v[44:47]
v_exp_f32 v27, v27
v_mfma_f32_16x16x32_bf16 v[44:47], a[24:27], a[216:219], v[44:47]
v_exp_f32 v28, v28
v_mfma_f32_16x16x32_bf16 v[44:47], a[28:31], a[220:223], v[44:47]
s_waitcnt lgkmcnt(0)
v_exp_f32 v29, v29
v_mfma_f32_16x16x32_bf16 v[192:195], a[32:35], v[72:75], v[192:195]
s_add_u32 m0, s27, 0x1000
v_exp_f32 v30, v30
v_mfma_f32_16x16x32_bf16 v[224:227], a[32:35], v[76:79], v[224:227]
buffer_load_dwordx4 v3, s[48:51], s7 offen offset:0 sc1 lds
v_mfma_f32_16x16x32_bf16 v[228:231], a[36:39], v[76:79], v[228:231]
v_exp_f32 v31, v31
v_mfma_f32_16x16x32_bf16 v[196:199], a[36:39], v[72:75], v[196:199]
ds_read_b128 a[0:3], v1 offset:24576
v_cvt_pk_bf16_f32 v56, v24, v25
v_mfma_f32_16x16x32_bf16 v[200:203], a[40:43], v[72:75], v[200:203]
ds_read_b128 a[4:7], v1 offset:25600
v_cvt_pk_bf16_f32 v57, v26, v27
v_mfma_f32_16x16x32_bf16 v[232:235], a[40:43], v[76:79], v[232:235]
v_exp_f32 v40, v40
v_mfma_f32_16x16x32_bf16 v[236:239], a[44:47], v[76:79], v[236:239]
ds_read_b128 a[8:11], v1 offset:26624
v_cvt_pk_bf16_f32 v60, v28, v29
v_mfma_f32_16x16x32_bf16 v[204:207], a[44:47], v[72:75], v[204:207]
v_exp_f32 v41, v41
v_mfma_f32_16x16x32_bf16 v[208:211], a[48:51], v[72:75], v[208:211]
ds_read_b128 a[12:15], v1 offset:27648
v_cvt_pk_bf16_f32 v61, v30, v31
v_mfma_f32_16x16x32_bf16 v[240:243], a[48:51], v[76:79], v[240:243]
ds_read_b128 a[16:19], v1 offset:28672
v_cvt_pk_bf16_f32 v58, v40, v41
v_mfma_f32_16x16x32_bf16 v[244:247], a[52:55], v[76:79], v[244:247]
v_exp_f32 v42, v42
v_mfma_f32_16x16x32_bf16 v[212:215], a[52:55], v[72:75], v[212:215]
buffer_load_dwordx4 v3, s[48:51], s7 offen offset:1024 sc1 lds
v_mfma_f32_16x16x32_bf16 v[216:219], a[56:59], v[72:75], v[216:219]
ds_read_b128 a[20:23], v1 offset:29696
v_mfma_f32_16x16x32_bf16 v[248:251], a[56:59], v[76:79], v[248:251]
ds_read_b128 a[24:27], v1 offset:30720
v_mfma_f32_16x16x32_bf16 v[252:255], a[60:63], v[76:79], v[252:255]
ds_read_b128 a[28:31], v1 offset:31744
v_mfma_f32_16x16x32_bf16 v[220:223], a[60:63], v[72:75], v[220:223]
s_waitcnt lgkmcnt(4)
v_exp_f32 v43, v43
v_smfmac_f32_16x16x64_bf16 a[228:231], a[232:235], v[72:79], v9
ds_read_b128 a[32:35], v1 offset:16384
v_cvt_pk_bf16_f32 v59, v42, v43
v_mfma_f32_16x16x32_bf16 v[24:27], a[0:3], a[192:195], v[88:91]
ds_read_b128 a[36:39], v1 offset:17408
v_mfma_f32_16x16x32_bf16 v[24:27], a[4:7], a[196:199], v[24:27]
buffer_load_dwordx4 v3, s[48:51], s7 offen offset:2048 sc1 lds
v_mfma_f32_16x16x32_bf16 v[24:27], a[8:11], a[200:203], v[24:27]
ds_read_b128 a[40:43], v1 offset:18432
v_exp_f32 v44, v44
v_mfma_f32_16x16x32_bf16 v[24:27], a[12:15], a[204:207], v[24:27]
ds_read_b128 a[44:47], v1 offset:19456
v_exp_f32 v45, v45
v_mfma_f32_16x16x32_bf16 v[28:31], a[0:3], a[208:211], v[92:95]
ds_read_b128 a[48:51], v1 offset:20480
v_exp_f32 v46, v46
v_mfma_f32_16x16x32_bf16 v[28:31], a[4:7], a[212:215], v[28:31]
s_waitcnt lgkmcnt(5)
v_exp_f32 v47, v47
v_mfma_f32_16x16x32_bf16 v[28:31], a[8:11], a[216:219], v[28:31]
ds_read_b128 a[52:55], v1 offset:21504
v_cvt_pk_bf16_f32 v62, v44, v45
v_mfma_f32_16x16x32_bf16 v[28:31], a[12:15], a[220:223], v[28:31]
ds_read_b128 a[56:59], v1 offset:22528
v_cvt_pk_bf16_f32 v63, v46, v47
v_mfma_f32_16x16x32_bf16 v[40:43], a[16:19], a[192:195], v[88:91]
ds_read_b128 a[60:63], v1 offset:23552
v_xor_b32 v1, 0x8000, v1
v_mfma_f32_16x16x32_bf16 v[40:43], a[20:23], a[196:199], v[40:43]
buffer_load_dwordx4 v3, s[48:51], s7 offen offset:3072 sc1 lds
v_mfma_f32_16x16x32_bf16 v[40:43], a[24:27], a[200:203], v[40:43]
s_add_u32 s7, s7, 0x8000
v_exp_f32 v24, v24
v_mfma_f32_16x16x32_bf16 v[40:43], a[28:31], a[204:207], v[40:43]
s_xor_b32 s27, s27, 0x38000
v_exp_f32 v25, v25
v_mfma_f32_16x16x32_bf16 v[44:47], a[16:19], a[208:211], v[92:95]
s_waitcnt vmcnt(16) lgkmcnt(0)
v_exp_f32 v26, v26
v_mfma_f32_16x16x32_bf16 v[44:47], a[20:23], a[212:215], v[44:47]
s_barrier
v_exp_f32 v27, v27
v_mfma_f32_16x16x32_bf16 v[44:47], a[24:27], a[216:219], v[44:47]
v_exp_f32 v28, v28
v_mfma_f32_16x16x32_bf16 v[44:47], a[28:31], a[220:223], v[44:47]
v_exp_f32 v29, v29
L_att_sodd1:
v_mfma_f32_16x16x32_bf16 v[192:195], a[32:35], v[56:59], v[192:195]
v_exp_f32 v30, v30
v_mfma_f32_16x16x32_bf16 v[224:227], a[32:35], v[60:63], v[224:227]
ds_read_b128 a[0:3], v2 offset:8192
v_cvt_pk_bf16_f32 v72, v24, v25
v_mfma_f32_16x16x32_bf16 v[228:231], a[36:39], v[60:63], v[228:231]
ds_read_b128 a[4:7], v2 offset:9216
v_cvt_pk_bf16_f32 v73, v26, v27
v_mfma_f32_16x16x32_bf16 v[196:199], a[36:39], v[56:59], v[196:199]
s_add_u32 m0, s19, 0x0
v_exp_f32 v31, v31
v_mfma_f32_16x16x32_bf16 v[200:203], a[40:43], v[56:59], v[200:203]
ds_read_b128 a[8:11], v2 offset:10240
v_cvt_pk_bf16_f32 v76, v28, v29
v_mfma_f32_16x16x32_bf16 v[232:235], a[40:43], v[60:63], v[232:235]
buffer_load_dwordx4 v3, s[48:51], s32 offen offset:0 sc1 lds
v_mfma_f32_16x16x32_bf16 v[236:239], a[44:47], v[60:63], v[236:239]
v_exp_f32 v40, v40
v_mfma_f32_16x16x32_bf16 v[204:207], a[44:47], v[56:59], v[204:207]
ds_read_b128 a[12:15], v2 offset:11264
v_cvt_pk_bf16_f32 v77, v30, v31
v_mfma_f32_16x16x32_bf16 v[208:211], a[48:51], v[56:59], v[208:211]
ds_read_b128 a[16:19], v2 offset:12288
v_mfma_f32_16x16x32_bf16 v[240:243], a[48:51], v[60:63], v[240:243]
buffer_load_dwordx4 v3, s[48:51], s32 offen offset:1024 sc1 lds
v_mfma_f32_16x16x32_bf16 v[244:247], a[52:55], v[60:63], v[244:247]
ds_read_b128 a[20:23], v2 offset:13312
v_mfma_f32_16x16x32_bf16 v[212:215], a[52:55], v[56:59], v[212:215]
ds_read_b128 a[24:27], v2 offset:14336
v_mfma_f32_16x16x32_bf16 v[216:219], a[56:59], v[56:59], v[216:219]
ds_read_b128 a[28:31], v2 offset:15360
v_mfma_f32_16x16x32_bf16 v[248:251], a[56:59], v[60:63], v[248:251]
ds_read_b128 a[32:35], v2 offset:0
v_exp_f32 v41, v41
v_mfma_f32_16x16x32_bf16 v[252:255], a[60:63], v[60:63], v[252:255]
v_exp_f32 v42, v42
v_mfma_f32_16x16x32_bf16 v[220:223], a[60:63], v[56:59], v[220:223]
s_waitcnt lgkmcnt(5)
v_exp_f32 v43, v43
v_smfmac_f32_16x16x64_bf16 a[228:231], a[232:235], v[56:63], v9
ds_read_b128 a[36:39], v2 offset:1024
v_cvt_pk_bf16_f32 v74, v40, v41
v_mfma_f32_16x16x32_bf16 v[24:27], a[0:3], a[192:195], v[88:91]
ds_read_b128 a[40:43], v2 offset:2048
v_exp_f32 v44, v44
v_mfma_f32_16x16x32_bf16 v[24:27], a[4:7], a[196:199], v[24:27]
buffer_load_dwordx4 v3, s[48:51], s32 offen offset:2048 sc1 lds
v_mfma_f32_16x16x32_bf16 v[24:27], a[8:11], a[200:203], v[24:27]
v_exp_f32 v45, v45
v_mfma_f32_16x16x32_bf16 v[24:27], a[12:15], a[204:207], v[24:27]
ds_read_b128 a[44:47], v2 offset:3072
v_cvt_pk_bf16_f32 v75, v42, v43
v_mfma_f32_16x16x32_bf16 v[28:31], a[0:3], a[208:211], v[92:95]
ds_read_b128 a[48:51], v2 offset:4096
v_exp_f32 v46, v46
v_mfma_f32_16x16x32_bf16 v[28:31], a[4:7], a[212:215], v[28:31]
s_waitcnt lgkmcnt(5)
v_exp_f32 v47, v47
v_mfma_f32_16x16x32_bf16 v[28:31], a[8:11], a[216:219], v[28:31]
ds_read_b128 a[52:55], v2 offset:5120
v_cvt_pk_bf16_f32 v78, v44, v45
v_mfma_f32_16x16x32_bf16 v[28:31], a[12:15], a[220:223], v[28:31]
buffer_load_dwordx4 v3, s[48:51], s32 offen offset:3072 sc1 lds
v_mfma_f32_16x16x32_bf16 v[40:43], a[16:19], a[192:195], v[88:91]
ds_read_b128 a[56:59], v2 offset:6144
s_add_u32 s32, s32, 0x8000
v_mfma_f32_16x16x32_bf16 v[40:43], a[20:23], a[196:199], v[40:43]
ds_read_b128 a[60:63], v2 offset:7168
v_cvt_pk_bf16_f32 v79, v46, v47
v_mfma_f32_16x16x32_bf16 v[40:43], a[24:27], a[200:203], v[40:43]
v_exp_f32 v24, v24
v_mfma_f32_16x16x32_bf16 v[40:43], a[28:31], a[204:207], v[40:43]
v_exp_f32 v25, v25
v_mfma_f32_16x16x32_bf16 v[44:47], a[16:19], a[208:211], v[92:95]
v_exp_f32 v26, v26
v_mfma_f32_16x16x32_bf16 v[44:47], a[20:23], a[212:215], v[44:47]
v_exp_f32 v27, v27
v_mfma_f32_16x16x32_bf16 v[44:47], a[24:27], a[216:219], v[44:47]
v_exp_f32 v28, v28
v_mfma_f32_16x16x32_bf16 v[44:47], a[28:31], a[220:223], v[44:47]
s_waitcnt lgkmcnt(0)
v_exp_f32 v29, v29
v_mfma_f32_16x16x32_bf16 v[192:195], a[32:35], v[72:75], v[192:195]
v_exp_f32 v30, v30
v_mfma_f32_16x16x32_bf16 v[224:227], a[32:35], v[76:79], v[224:227]
v_exp_f32 v31, v31
v_mfma_f32_16x16x32_bf16 v[228:231], a[36:39], v[76:79], v[228:231]
v_exp_f32 v40, v40
v_mfma_f32_16x16x32_bf16 v[196:199], a[36:39], v[72:75], v[196:199]
s_add_u32 m0, s19, 0x1000
v_exp_f32 v41, v41
v_mfma_f32_16x16x32_bf16 v[200:203], a[40:43], v[72:75], v[200:203]
ds_read_b128 a[0:3], v2 offset:24576
v_cvt_pk_bf16_f32 v56, v24, v25
v_mfma_f32_16x16x32_bf16 v[232:235], a[40:43], v[76:79], v[232:235]
buffer_load_dwordx4 v3, s[48:51], s7 offen offset:0 sc1 lds
v_mfma_f32_16x16x32_bf16 v[236:239], a[44:47], v[76:79], v[236:239]
ds_read_b128 a[4:7], v2 offset:25600
v_cvt_pk_bf16_f32 v57, v26, v27
v_mfma_f32_16x16x32_bf16 v[204:207], a[44:47], v[72:75], v[204:207]
ds_read_b128 a[8:11], v2 offset:26624
v_cvt_pk_bf16_f32 v60, v28, v29
v_mfma_f32_16x16x32_bf16 v[208:211], a[48:51], v[72:75], v[208:211]
ds_read_b128 a[12:15], v2 offset:27648
v_cvt_pk_bf16_f32 v61, v30, v31
v_mfma_f32_16x16x32_bf16 v[240:243], a[48:51], v[76:79], v[240:243]
ds_read_b128 a[16:19], v2 offset:28672
v_cvt_pk_bf16_f32 v58, v40, v41
v_mfma_f32_16x16x32_bf16 v[244:247], a[52:55], v[76:79], v[244:247]
buffer_load_dwordx4 v3, s[48:51], s7 offen offset:1024 sc1 lds
v_mfma_f32_16x16x32_bf16 v[212:215], a[52:55], v[72:75], v[212:215]
ds_read_b128 a[20:23], v2 offset:29696
v_mfma_f32_16x16x32_bf16 v[216:219], a[56:59], v[72:75], v[216:219]
v_exp_f32 v42, v42
v_mfma_f32_16x16x32_bf16 v[248:251], a[56:59], v[76:79], v[248:251]
ds_read_b128 a[24:27], v2 offset:30720
v_mfma_f32_16x16x32_bf16 v[252:255], a[60:63], v[76:79], v[252:255]
ds_read_b128 a[28:31], v2 offset:31744
v_exp_f32 v43, v43
v_mfma_f32_16x16x32_bf16 v[220:223], a[60:63], v[72:75], v[220:223]
ds_read_b128 a[32:35], v2 offset:16384
v_cvt_pk_bf16_f32 v59, v42, v43
v_smfmac_f32_16x16x64_bf16 a[228:231], a[232:235], v[72:79], v9
ds_read_b128 a[36:39], v2 offset:17408
s_waitcnt lgkmcnt(6)
v_mfma_f32_16x16x32_bf16 v[24:27], a[0:3], a[192:195], v[88:91]
buffer_load_dwordx4 v3, s[48:51], s7 offen offset:2048 sc1 lds
v_mfma_f32_16x16x32_bf16 v[24:27], a[4:7], a[196:199], v[24:27]
ds_read_b128 a[40:43], v2 offset:18432
v_exp_f32 v44, v44
v_mfma_f32_16x16x32_bf16 v[24:27], a[8:11], a[200:203], v[24:27]
ds_read_b128 a[44:47], v2 offset:19456
v_exp_f32 v45, v45
v_mfma_f32_16x16x32_bf16 v[24:27], a[12:15], a[204:207], v[24:27]
ds_read_b128 a[48:51], v2 offset:20480
v_cvt_pk_bf16_f32 v62, v44, v45
v_mfma_f32_16x16x32_bf16 v[28:31], a[0:3], a[208:211], v[92:95]
v_exp_f32 v46, v46
v_mfma_f32_16x16x32_bf16 v[28:31], a[4:7], a[212:215], v[28:31]
s_waitcnt lgkmcnt(5)
v_exp_f32 v47, v47
v_mfma_f32_16x16x32_bf16 v[28:31], a[8:11], a[216:219], v[28:31]
ds_read_b128 a[52:55], v2 offset:21504
v_cvt_pk_bf16_f32 v63, v46, v47
v_mfma_f32_16x16x32_bf16 v[28:31], a[12:15], a[220:223], v[28:31]
buffer_load_dwordx4 v3, s[48:51], s7 offen offset:3072 sc1 lds
v_mfma_f32_16x16x32_bf16 v[40:43], a[16:19], a[192:195], v[88:91]
ds_read_b128 a[56:59], v2 offset:22528
s_add_u32 s7, s7, 0x8000
v_mfma_f32_16x16x32_bf16 v[40:43], a[20:23], a[196:199], v[40:43]
ds_read_b128 a[60:63], v2 offset:23552
v_xor_b32 v2, 0x38000, v2
v_mfma_f32_16x16x32_bf16 v[40:43], a[24:27], a[200:203], v[40:43]
s_xor_b32 s19, s19, 0x8000
v_exp_f32 v24, v24
v_mfma_f32_16x16x32_bf16 v[40:43], a[28:31], a[204:207], v[40:43]
s_sub_u32 s15, s15, 1
v_exp_f32 v25, v25
v_mfma_f32_16x16x32_bf16 v[44:47], a[16:19], a[208:211], v[92:95]
s_cmp_lg_u32 s15, 0
s_waitcnt vmcnt(16) lgkmcnt(0)
v_exp_f32 v26, v26
v_mfma_f32_16x16x32_bf16 v[44:47], a[20:23], a[212:215], v[44:47]
s_barrier
v_exp_f32 v27, v27
v_mfma_f32_16x16x32_bf16 v[44:47], a[24:27], a[216:219], v[44:47]
v_exp_f32 v28, v28
v_mfma_f32_16x16x32_bf16 v[44:47], a[28:31], a[220:223], v[44:47]
v_exp_f32 v29, v29
s_cbranch_scc1 L_att_seven1
L_att_sdone:
s_cmp_ge_u32 s4, 2
s_cbranch_scc1 L_att_sh0_1
L_att_sh0_0:
v_mfma_f32_16x16x32_bf16 v[192:195], a[32:35], v[56:59], v[192:195]
v_exp_f32 v30, v30
v_mfma_f32_16x16x32_bf16 v[224:227], a[32:35], v[60:63], v[224:227]
buffer_load_dword v14, v15, s[84:87], 0 offen offset:192 sc1
v_mfma_f32_16x16x32_bf16 v[228:231], a[36:39], v[60:63], v[228:231]
v_exp_f32 v31, v31
v_mfma_f32_16x16x32_bf16 v[196:199], a[36:39], v[56:59], v[196:199]
s_add_u32 m0, s17, 0x10000
v_exp_f32 v40, v40
v_mfma_f32_16x16x32_bf16 v[200:203], a[40:43], v[56:59], v[200:203]
ds_read_b128 a[0:3], v1 offset:8192
v_cvt_pk_bf16_f32 v72, v24, v25
v_mfma_f32_16x16x32_bf16 v[232:235], a[40:43], v[60:63], v[232:235]
ds_read_b128 a[4:7], v1 offset:9216
v_cvt_pk_bf16_f32 v73, v26, v27
v_mfma_f32_16x16x32_bf16 v[236:239], a[44:47], v[60:63], v[236:239]
buffer_load_dwordx4 v12, s[72:75], 0 offen lds
v_mfma_f32_16x16x32_bf16 v[204:207], a[44:47], v[56:59], v[204:207]
ds_read_b128 a[8:11], v1 offset:10240
v_cvt_pk_bf16_f32 v76, v28, v29
v_mfma_f32_16x16x32_bf16 v[208:211], a[48:51], v[56:59], v[208:211]
buffer_load_dwordx4 v13, s[72:75], 0 offen offset:1024 lds
v_mfma_f32_16x16x32_bf16 v[240:243], a[48:51], v[60:63], v[240:243]
ds_read_b128 a[12:15], v1 offset:11264
v_cvt_pk_bf16_f32 v77, v30, v31
v_mfma_f32_16x16x32_bf16 v[244:247], a[52:55], v[60:63], v[244:247]
buffer_load_dwordx4 v12, s[72:75], s12 offen offset:2048 lds
v_mfma_f32_16x16x32_bf16 v[212:215], a[52:55], v[56:59], v[212:215]
ds_read_b128 a[16:19], v1 offset:12288
v_exp_f32 v41, v41
v_mfma_f32_16x16x32_bf16 v[216:219], a[56:59], v[56:59], v[216:219]
ds_read_b128 a[20:23], v1 offset:13312
v_exp_f32 v42, v42
v_mfma_f32_16x16x32_bf16 v[248:251], a[56:59], v[60:63], v[248:251]
buffer_load_dwordx4 v13, s[72:75], s12 offen offset:3072 lds
v_mfma_f32_16x16x32_bf16 v[252:255], a[60:63], v[60:63], v[252:255]
ds_read_b128 a[24:27], v1 offset:14336
s_waitcnt lgkmcnt(3)
v_mfma_f32_16x16x32_bf16 v[220:223], a[60:63], v[56:59], v[220:223]
ds_read_b128 a[28:31], v1 offset:15360
v_add_u32 v12, 0x20000, v12
v_smfmac_f32_16x16x64_bf16 a[228:231], a[232:235], v[56:63], v9
s_add_u32 m0, s17, 0x14000
v_exp_f32 v43, v43
v_mfma_f32_16x16x32_bf16 v[24:27], a[0:3], a[192:195], v[112:115]
buffer_load_dwordx4 v12, s[72:75], 0 offen lds
v_mfma_f32_16x16x32_bf16 v[24:27], a[4:7], a[196:199], v[24:27]
ds_read_b128 a[32:35], v1 offset:0
v_cvt_pk_bf16_f32 v74, v40, v41
v_mfma_f32_16x16x32_bf16 v[24:27], a[8:11], a[200:203], v[24:27]
ds_read_b128 a[36:39], v1 offset:1024
v_exp_f32 v44, v44
v_mfma_f32_16x16x32_bf16 v[24:27], a[12:15], a[204:207], v[24:27]
ds_read_b128 a[40:43], v1 offset:2048
v_exp_f32 v45, v45
v_mfma_f32_16x16x32_bf16 v[28:31], a[0:3], a[208:211], v[92:95]
ds_read_b128 a[44:47], v1 offset:3072
v_exp_f32 v46, v46
v_mfma_f32_16x16x32_bf16 v[28:31], a[4:7], a[212:215], v[28:31]
s_waitcnt lgkmcnt(4)
v_exp_f32 v47, v47
v_mfma_f32_16x16x32_bf16 v[28:31], a[8:11], a[216:219], v[28:31]
ds_read_b128 a[48:51], v1 offset:4096
v_add_u32 v13, 0x20000, v13
v_mfma_f32_16x16x32_bf16 v[28:31], a[12:15], a[220:223], v[28:31]
buffer_load_dwordx4 v13, s[72:75], 0 offen offset:1024 lds
v_cvt_pk_bf16_f32 v75, v42, v43
v_mfma_f32_16x16x32_bf16 v[40:43], a[16:19], a[192:195], v[116:119]
ds_read_b128 a[52:55], v1 offset:5120
v_exp_f32 v24, v24
v_mfma_f32_16x16x32_bf16 v[40:43], a[20:23], a[196:199], v[40:43]
buffer_load_dwordx4 v12, s[72:75], s12 offen offset:2048 lds
v_mfma_f32_16x16x32_bf16 v[40:43], a[24:27], a[200:203], v[40:43]
ds_read_b128 a[56:59], v1 offset:6144
v_exp_f32 v25, v25
v_mfma_f32_16x16x32_bf16 v[40:43], a[28:31], a[204:207], v[40:43]
ds_read_b128 a[60:63], v1 offset:7168
v_cvt_pk_bf16_f32 v78, v44, v45
v_cvt_pk_bf16_f32 v79, v46, v47
v_mfma_f32_16x16x32_bf16 v[44:47], a[16:19], a[208:211], v[92:95]
buffer_load_dwordx4 v13, s[72:75], s12 offen offset:3072 lds
v_mfma_f32_16x16x32_bf16 v[44:47], a[20:23], a[212:215], v[44:47]
v_exp_f32 v26, v26
v_mfma_f32_16x16x32_bf16 v[44:47], a[24:27], a[216:219], v[44:47]
v_exp_f32 v27, v27
v_mfma_f32_16x16x32_bf16 v[44:47], a[28:31], a[220:223], v[44:47]
s_waitcnt lgkmcnt(0)
v_exp_f32 v28, v28
v_exp_f32 v29, v29
v_mfma_f32_16x16x32_bf16 v[192:195], a[32:35], v[72:75], v[192:195]
ds_read_b128 a[0:3], v1 offset:24576
v_cvt_pk_bf16_f32 v56, v24, v25
v_mfma_f32_16x16x32_bf16 v[224:227], a[32:35], v[76:79], v[224:227]
ds_read_b128 a[4:7], v1 offset:25600
v_add_u32 v12, 0x20000, v12
v_mfma_f32_16x16x32_bf16 v[228:231], a[36:39], v[76:79], v[228:231]
s_add_u32 m0, s16, 0x0
v_exp_f32 v30, v30
v_mfma_f32_16x16x32_bf16 v[196:199], a[36:39], v[72:75], v[196:199]
buffer_load_dwordx4 v12, s[72:75], 0 offen lds
v_mfma_f32_16x16x32_bf16 v[200:203], a[40:43], v[72:75], v[200:203]
ds_read_b128 a[8:11], v1 offset:26624
v_add_u32 v13, 0x20000, v13
v_mfma_f32_16x16x32_bf16 v[232:235], a[40:43], v[76:79], v[232:235]
buffer_load_dwordx4 v13, s[72:75], 0 offen offset:1024 lds
v_mfma_f32_16x16x32_bf16 v[236:239], a[44:47], v[76:79], v[236:239]
ds_read_b128 a[12:15], v1 offset:27648
v_cvt_pk_bf16_f32 v57, v26, v27
v_mfma_f32_16x16x32_bf16 v[204:207], a[44:47], v[72:75], v[204:207]
buffer_load_dwordx4 v12, s[72:75], s12 offen offset:2048 lds
v_mfma_f32_16x16x32_bf16 v[208:211], a[48:51], v[72:75], v[208:211]
ds_read_b128 a[16:19], v1 offset:28672
v_cvt_pk_bf16_f32 v60, v28, v29
v_mfma_f32_16x16x32_bf16 v[240:243], a[48:51], v[76:79], v[240:243]
buffer_load_dwordx4 v13, s[72:75], s12 offen offset:3072 lds
v_mfma_f32_16x16x32_bf16 v[244:247], a[52:55], v[76:79], v[244:247]
ds_read_b128 a[20:23], v1 offset:29696
v_exp_f32 v31, v31
v_mfma_f32_16x16x32_bf16 v[212:215], a[52:55], v[72:75], v[212:215]
ds_read_b128 a[24:27], v1 offset:30720
s_add_u32 m0, s16, 0x4000
v_mfma_f32_16x16x32_bf16 v[216:219], a[56:59], v[72:75], v[216:219]
ds_read_b128 a[28:31], v1 offset:31744
v_add_u32 v12, 0x20000, v12
v_mfma_f32_16x16x32_bf16 v[248:251], a[56:59], v[76:79], v[248:251]
buffer_load_dwordx4 v12, s[72:75], 0 offen lds
v_mfma_f32_16x16x32_bf16 v[252:255], a[60:63], v[76:79], v[252:255]
ds_read_b128 a[32:35], v1 offset:16384
s_waitcnt lgkmcnt(5)
v_mfma_f32_16x16x32_bf16 v[220:223], a[60:63], v[72:75], v[220:223]
ds_read_b128 a[36:39], v1 offset:17408
v_add_u32 v13, 0x20000, v13
v_smfmac_f32_16x16x64_bf16 a[228:231], a[232:235], v[72:79], v9
buffer_load_dwordx4 v13, s[72:75], 0 offen offset:1024 lds
v_cvt_pk_bf16_f32 v61, v30, v31
v_mfma_f32_16x16x32_bf16 v[28:31], a[0:3], a[208:211], v[92:95]
ds_read_b128 a[40:43], v1 offset:18432
v_exp_f32 v40, v40
v_mfma_f32_16x16x32_bf16 v[28:31], a[4:7], a[212:215], v[28:31]
buffer_load_dwordx4 v12, s[72:75], s12 offen offset:2048 lds
v_mfma_f32_16x16x32_bf16 v[28:31], a[8:11], a[216:219], v[28:31]
ds_read_b128 a[44:47], v1 offset:19456
v_exp_f32 v41, v41
v_mfma_f32_16x16x32_bf16 v[28:31], a[12:15], a[220:223], v[28:31]
ds_read_b128 a[48:51], v1 offset:20480
s_waitcnt lgkmcnt(5)
v_exp_f32 v42, v42
v_exp_f32 v43, v43
v_exp_f32 v44, v44
v_exp_f32 v45, v45
v_exp_f32 v46, v46
v_exp_f32 v47, v47
v_cvt_pk_bf16_f32 v62, v44, v45
v_cvt_pk_bf16_f32 v63, v46, v47
v_mfma_f32_16x16x32_bf16 v[44:47], a[16:19], a[208:211], v[92:95]
buffer_load_dwordx4 v13, s[72:75], s12 offen offset:3072 lds
v_mfma_f32_16x16x32_bf16 v[44:47], a[20:23], a[212:215], v[44:47]
ds_read_b128 a[52:55], v1 offset:21504
v_cvt_pk_bf16_f32 v58, v40, v41
v_mfma_f32_16x16x32_bf16 v[44:47], a[24:27], a[216:219], v[44:47]
ds_read_b128 a[56:59], v1 offset:22528
v_cvt_pk_bf16_f32 v59, v42, v43
v_mfma_f32_16x16x32_bf16 v[44:47], a[28:31], a[220:223], v[44:47]
ds_read_b128 a[60:63], v1 offset:23552
v_xor_b32 v1, 0x8000, v1
L_att_h1_0:
s_waitcnt vmcnt(16) lgkmcnt(0)
s_mov_b32 s92, 200000
L_spin_b0:
v_cmp_gt_u32 vcc, 32, v14
s_nop 4
s_cbranch_vccz L_spun_b0
s_sub_u32 s92, s92, 1
s_cbranch_scc1 L_spun_b0
s_sleep 6
buffer_load_dword v14, v15, s[84:87], 0 offen offset:192 sc1
s_waitcnt vmcnt(0)
s_branch L_spin_b0
L_spun_b0:
s_barrier
v_mfma_f32_16x16x32_bf16 v[192:195], a[32:35], v[56:59], v[192:195]
ds_read_b128 a[0:3], v2 offset:8192
v_exp_f32 v28, v28
v_mfma_f32_16x16x32_bf16 v[224:227], a[32:35], v[60:63], v[224:227]
ds_read_b128 a[4:7], v2 offset:9216
v_exp_f32 v29, v29
v_mfma_f32_16x16x32_bf16 v[228:231], a[36:39], v[60:63], v[228:231]
s_add_u32 s101, s101, 0x2000
v_exp_f32 v30, v30
v_mfma_f32_16x16x32_bf16 v[196:199], a[36:39], v[56:59], v[196:199]
buffer_load_dwordx4 a[64:67], v3, s[88:91], s101 offen sc1
v_mfma_f32_16x16x32_bf16 v[200:203], a[40:43], v[56:59], v[200:203]
ds_read_b128 a[8:11], v2 offset:10240
v_exp_f32 v31, v31
v_mfma_f32_16x16x32_bf16 v[232:235], a[40:43], v[60:63], v[232:235]
buffer_load_dwordx4 a[68:71], v3, s[88:91], s101 offen offset:1024 sc1
v_mfma_f32_16x16x32_bf16 v[236:239], a[44:47], v[60:63], v[236:239]
ds_read_b128 a[12:15], v2 offset:11264
s_add_u32 s101, s101, 0x2000
v_mfma_f32_16x16x32_bf16 v[204:207], a[44:47], v[56:59], v[204:207]
buffer_load_dwordx4 a[72:75], v3, s[88:91], s101 offen sc1
v_mfma_f32_16x16x32_bf16 v[208:211], a[48:51], v[56:59], v[208:211]
ds_read_b128 a[16:19], v2 offset:12288
v_cvt_pk_bf16_f32 v76, v28, v29
v_mfma_f32_16x16x32_bf16 v[240:243], a[48:51], v[60:63], v[240:243]
buffer_load_dwordx4 a[76:79], v3, s[88:91], s101 offen offset:1024 sc1
v_mfma_f32_16x16x32_bf16 v[244:247], a[52:55], v[60:63], v[244:247]
ds_read_b128 a[20:23], v2 offset:13312
v_exp_f32 v44, v44
v_mfma_f32_16x16x32_bf16 v[212:215], a[52:55], v[56:59], v[212:215]
ds_read_b128 a[24:27], v2 offset:14336
v_exp_f32 v45, v45
v_mfma_f32_16x16x32_bf16 v[216:219], a[56:59], v[56:59], v[216:219]
ds_read_b128 a[28:31], v2 offset:15360
s_add_u32 s101, s101, 0x2000
v_mfma_f32_16x16x32_bf16 v[248:251], a[56:59], v[60:63], v[248:251]
buffer_load_dwordx4 a[80:83], v3, s[88:91], s101 offen sc1
v_mfma_f32_16x16x32_bf16 v[252:255], a[60:63], v[60:63], v[252:255]
ds_read_b128 a[32:35], v2 offset:0
v_cvt_pk_bf16_f32 v77, v30, v31
v_mfma_f32_16x16x32_bf16 v[220:223], a[60:63], v[56:59], v[220:223]
ds_read_b128 a[36:39], v2 offset:1024
s_waitcnt lgkmcnt(6)
v_smfmac_f32_16x16x64_bf16 a[228:231], a[232:235], v[56:63], v9
buffer_load_dwordx4 a[84:87], v3, s[88:91], s101 offen offset:1024 sc1
v_mfma_f32_16x16x32_bf16 v[28:31], a[0:3], a[208:211], v[92:95]
ds_read_b128 a[40:43], v2 offset:2048
v_exp_f32 v46, v46
v_mfma_f32_16x16x32_bf16 v[28:31], a[4:7], a[212:215], v[28:31]
ds_read_b128 a[44:47], v2 offset:3072
s_add_u32 s101, s101, 0x2000
v_mfma_f32_16x16x32_bf16 v[28:31], a[8:11], a[216:219], v[28:31]
buffer_load_dwordx4 a[88:91], v3, s[88:91], s101 offen sc1
v_mfma_f32_16x16x32_bf16 v[28:31], a[12:15], a[220:223], v[28:31]
ds_read_b128 a[48:51], v2 offset:4096
s_waitcnt lgkmcnt(5)
v_exp_f32 v47, v47
v_cvt_pk_bf16_f32 v78, v44, v45
v_cvt_pk_bf16_f32 v79, v46, v47
v_mfma_f32_16x16x32_bf16 v[44:47], a[16:19], a[208:211], v[92:95]
ds_read_b128 a[52:55], v2 offset:5120
v_mfma_f32_16x16x32_bf16 v[44:47], a[20:23], a[212:215], v[44:47]
buffer_load_dwordx4 a[92:95], v3, s[88:91], s101 offen offset:1024 sc1
v_mfma_f32_16x16x32_bf16 v[44:47], a[24:27], a[216:219], v[44:47]
ds_read_b128 a[56:59], v2 offset:6144
v_mfma_f32_16x16x32_bf16 v[44:47], a[28:31], a[220:223], v[44:47]
ds_read_b128 a[60:63], v2 offset:7168
s_waitcnt lgkmcnt(0)
v_mfma_f32_16x16x32_bf16 v[224:227], a[32:35], v[76:79], v[224:227]
ds_read_b128 a[0:3], v2 offset:24576
s_add_u32 s101, s101, 0x2000
v_mfma_f32_16x16x32_bf16 v[228:231], a[36:39], v[76:79], v[228:231]
buffer_load_dwordx4 a[96:99], v3, s[88:91], s101 offen sc1
v_mfma_f32_16x16x32_bf16 v[232:235], a[40:43], v[76:79], v[232:235]
ds_read_b128 a[4:7], v2 offset:25600
v_exp_f32 v28, v28
v_mfma_f32_16x16x32_bf16 v[236:239], a[44:47], v[76:79], v[236:239]
buffer_load_dwordx4 a[100:103], v3, s[88:91], s101 offen offset:1024 sc1
v_mfma_f32_16x16x32_bf16 v[240:243], a[48:51], v[76:79], v[240:243]
ds_read_b128 a[8:11], v2 offset:26624
s_add_u32 s101, s101, 0x2000
v_mfma_f32_16x16x32_bf16 v[244:247], a[52:55], v[76:79], v[244:247]
buffer_load_dwordx4 a[104:107], v3, s[88:91], s101 offen sc1
v_mfma_f32_16x16x32_bf16 v[248:251], a[56:59], v[76:79], v[248:251]
ds_read_b128 a[12:15], v2 offset:27648
s_waitcnt lgkmcnt(0)
v_mfma_f32_16x16x32_bf16 v[252:255], a[60:63], v[76:79], v[252:255]
buffer_load_dwordx4 a[108:111], v3, s[88:91], s101 offen offset:1024 sc1
ds_read_b128 a[16:19], v2 offset:28672
v_mfma_f32_16x16x32_bf16 a[228:231], a[236:239], v[76:79], a[228:231]
ds_read_b128 a[20:23], v2 offset:29696
s_add_u32 s101, s101, 0x2000
v_exp_f32 v29, v29
v_exp_f32 v30, v30
v_exp_f32 v31, v31
v_cvt_pk_bf16_f32 v60, v28, v29
v_cvt_pk_bf16_f32 v61, v30, v31
v_mfma_f32_16x16x32_bf16 v[28:31], a[0:3], a[208:211], v[120:123]
buffer_load_dwordx4 a[112:115], v3, s[88:91], s101 offen sc1
ds_read_b128 a[24:27], v2 offset:30720
v_mfma_f32_16x16x32_bf16 v[28:31], a[4:7], a[212:215], v[28:31]
ds_read_b128 a[28:31], v2 offset:31744
s_waitcnt lgkmcnt(0)
v_mfma_f32_16x16x32_bf16 v[28:31], a[8:11], a[216:219], v[28:31]
buffer_load_dwordx4 a[116:119], v3, s[88:91], s101 offen offset:1024 sc1
v_mfma_f32_16x16x32_bf16 v[28:31], a[12:15], a[220:223], v[28:31]
ds_read_b128 a[32:35], v2 offset:16384
s_add_u32 s101, s101, 0x2000
v_exp_f32 v44, v44
v_exp_f32 v45, v45
v_exp_f32 v46, v46
v_exp_f32 v47, v47
v_cvt_pk_bf16_f32 v62, v44, v45
v_cvt_pk_bf16_f32 v63, v46, v47
v_mfma_f32_16x16x32_bf16 v[44:47], a[16:19], a[208:211], v[124:127]
buffer_load_dwordx4 a[120:123], v3, s[88:91], s101 offen sc1
v_mfma_f32_16x16x32_bf16 v[44:47], a[20:23], a[212:215], v[44:47]
buffer_load_dwordx4 a[124:127], v3, s[88:91], s101 offen offset:1024 sc1
v_mfma_f32_16x16x32_bf16 v[44:47], a[24:27], a[216:219], v[44:47]
ds_read_b128 a[36:39], v2 offset:17408
v_mfma_f32_16x16x32_bf16 v[44:47], a[28:31], a[220:223], v[44:47]
ds_read_b128 a[40:43], v2 offset:18432
ds_read_b128 a[44:47], v2 offset:19456
ds_read_b128 a[48:51], v2 offset:20480
ds_read_b128 a[52:55], v2 offset:21504
ds_read_b128 a[56:59], v2 offset:22528
ds_read_b128 a[60:63], v2 offset:23552
v_xor_b32 v2, 0x38000, v2
s_waitcnt lgkmcnt(0)
s_barrier
v_accvgpr_read_b32 v6, a228
v_accvgpr_read_b32 v7, a229
v_add_f32 v6, v6, v7
v_cmp_nge_f32 vcc, 0x6f800000, v6
v_rcp_f32 v6, v6
s_or_b64 s[34:35], s[34:35], vcc
v_mfma_f32_16x16x32_bf16 v[224:227], a[32:35], v[60:63], v[224:227]
ds_read_b128 a[32:35], v1 offset:0
v_exp_f32 v28, v28
v_mfma_f32_16x16x32_bf16 v[228:231], a[36:39], v[60:63], v[228:231]
ds_read_b128 a[36:39], v1 offset:1024
v_exp_f32 v29, v29
v_mfma_f32_16x16x32_bf16 v[232:235], a[40:43], v[60:63], v[232:235]
ds_read_b128 a[40:43], v1 offset:2048
v_exp_f32 v30, v30
v_mfma_f32_16x16x32_bf16 v[236:239], a[44:47], v[60:63], v[236:239]
ds_read_b128 a[44:47], v1 offset:3072
v_exp_f32 v31, v31
v_mfma_f32_16x16x32_bf16 v[240:243], a[48:51], v[60:63], v[240:243]
ds_read_b128 a[48:51], v1 offset:4096
v_exp_f32 v44, v44
v_mfma_f32_16x16x32_bf16 v[244:247], a[52:55], v[60:63], v[244:247]
ds_read_b128 a[52:55], v1 offset:5120
v_exp_f32 v45, v45
v_mfma_f32_16x16x32_bf16 v[248:251], a[56:59], v[60:63], v[248:251]
ds_read_b128 a[56:59], v1 offset:6144
v_exp_f32 v46, v46
v_mfma_f32_16x16x32_bf16 v[252:255], a[60:63], v[60:63], v[252:255]
ds_read_b128 a[60:63], v1 offset:7168
v_exp_f32 v47, v47
v_mfma_f32_16x16x32_bf16 a[228:231], a[236:239], v[60:63], a[228:231]
v_cvt_pk_bf16_f32 v76, v28, v29
v_cvt_pk_bf16_f32 v77, v30, v31
v_cvt_pk_bf16_f32 v78, v44, v45
v_cvt_pk_bf16_f32 v79, v46, v47
s_add_u32 s8, s30, 0x0
v_pk_mul_f32 v[192:193], v[192:193], v[6:7] op_sel_hi:[1,0]
v_pk_mul_f32 v[194:195], v[194:195], v[6:7] op_sel_hi:[1,0]
v_pk_mul_f32 v[196:197], v[196:197], v[6:7] op_sel_hi:[1,0]
v_pk_mul_f32 v[198:199], v[198:199], v[6:7] op_sel_hi:[1,0]
v_cvt_pk_bf16_f32 v192, v192, v193
v_cvt_pk_bf16_f32 v193, v194, v195
v_cvt_pk_bf16_f32 v194, v196, v197
v_cvt_pk_bf16_f32 v195, v198, v199
buffer_store_dwordx4 v[192:195], v3, s[88:91], s8 offen sc1
s_add_u32 s8, s30, 0x2000
v_pk_mul_f32 v[200:201], v[200:201], v[6:7] op_sel_hi:[1,0]
v_pk_mul_f32 v[202:203], v[202:203], v[6:7] op_sel_hi:[1,0]
v_pk_mul_f32 v[204:205], v[204:205], v[6:7] op_sel_hi:[1,0]
v_pk_mul_f32 v[206:207], v[206:207], v[6:7] op_sel_hi:[1,0]
v_cvt_pk_bf16_f32 v200, v200, v201
v_cvt_pk_bf16_f32 v201, v202, v203
v_cvt_pk_bf16_f32 v202, v204, v205
v_cvt_pk_bf16_f32 v203, v206, v207
buffer_store_dwordx4 v[200:203], v3, s[88:91], s8 offen sc1
s_waitcnt lgkmcnt(0)
v_mfma_f32_16x16x32_bf16 v[224:227], a[32:35], v[76:79], v[224:227]
s_add_u32 s8, s30, 0x4000
v_mul_f32 v208, v6, v208
v_mfma_f32_16x16x32_bf16 v[228:231], a[36:39], v[76:79], v[228:231]
v_mul_f32 v209, v6, v209
v_mul_f32 v210, v6, v210
v_mfma_f32_16x16x32_bf16 v[232:235], a[40:43], v[76:79], v[232:235]
v_mul_f32 v211, v6, v211
v_mul_f32 v212, v6, v212
v_mfma_f32_16x16x32_bf16 v[236:239], a[44:47], v[76:79], v[236:239]
v_mul_f32 v213, v6, v213
v_mul_f32 v214, v6, v214
v_mfma_f32_16x16x32_bf16 v[240:243], a[48:51], v[76:79], v[240:243]
v_mul_f32 v215, v6, v215
v_cvt_pk_bf16_f32 v208, v208, v209
v_mfma_f32_16x16x32_bf16 v[244:247], a[52:55], v[76:79], v[244:247]
v_cvt_pk_bf16_f32 v209, v210, v211
v_cvt_pk_bf16_f32 v210, v212, v213
v_mfma_f32_16x16x32_bf16 v[248:251], a[56:59], v[76:79], v[248:251]
v_cvt_pk_bf16_f32 v211, v214, v215
buffer_store_dwordx4 v[208:211], v3, s[88:91], s8 offen sc1
v_mfma_f32_16x16x32_bf16 v[252:255], a[60:63], v[76:79], v[252:255]
s_add_u32 s8, s30, 0x6000
v_mul_f32 v216, v6, v216
v_mfma_f32_16x16x32_bf16 a[228:231], a[236:239], v[76:79], a[228:231]
v_mul_f32 v217, v6, v217
v_mul_f32 v218, v6, v218
v_mul_f32 v219, v6, v219
v_mul_f32 v220, v6, v220
v_mul_f32 v221, v6, v221
v_mul_f32 v222, v6, v222
v_mul_f32 v223, v6, v223
v_cvt_pk_bf16_f32 v216, v216, v217
v_cvt_pk_bf16_f32 v217, v218, v219
v_cvt_pk_bf16_f32 v218, v220, v221
v_cvt_pk_bf16_f32 v219, v222, v223
buffer_store_dwordx4 v[216:219], v3, s[88:91], s8 offen sc1
s_branch L_att_fin
L_att_sh0_1:
v_mfma_f32_16x16x32_bf16 v[192:195], a[32:35], v[56:59], v[192:195]
v_exp_f32 v30, v30
v_mfma_f32_16x16x32_bf16 v[224:227], a[32:35], v[60:63], v[224:227]
buffer_load_dword v14, v15, s[84:87], 0 offen offset:192 sc1
v_mfma_f32_16x16x32_bf16 v[228:231], a[36:39], v[60:63], v[228:231]
v_exp_f32 v31, v31
v_mfma_f32_16x16x32_bf16 v[196:199], a[36:39], v[56:59], v[196:199]
s_add_u32 m0, s17, 0x10000
v_exp_f32 v40, v40
v_mfma_f32_16x16x32_bf16 v[200:203], a[40:43], v[56:59], v[200:203]
ds_read_b128 a[0:3], v1 offset:8192
v_cvt_pk_bf16_f32 v72, v24, v25
v_mfma_f32_16x16x32_bf16 v[232:235], a[40:43], v[60:63], v[232:235]
ds_read_b128 a[4:7], v1 offset:9216
v_cvt_pk_bf16_f32 v73, v26, v27
v_mfma_f32_16x16x32_bf16 v[236:239], a[44:47], v[60:63], v[236:239]
buffer_load_dwordx4 v12, s[72:75], 0 offen lds
v_mfma_f32_16x16x32_bf16 v[204:207], a[44:47], v[56:59], v[204:207]
ds_read_b128 a[8:11], v1 offset:10240
v_cvt_pk_bf16_f32 v76, v28, v29
v_mfma_f32_16x16x32_bf16 v[208:211], a[48:51], v[56:59], v[208:211]
buffer_load_dwordx4 v13, s[72:75], 0 offen offset:1024 lds
v_mfma_f32_16x16x32_bf16 v[240:243], a[48:51], v[60:63], v[240:243]
ds_read_b128 a[12:15], v1 offset:11264
v_cvt_pk_bf16_f32 v77, v30, v31
v_mfma_f32_16x16x32_bf16 v[244:247], a[52:55], v[60:63], v[244:247]
buffer_load_dwordx4 v12, s[72:75], s12 offen offset:2048 lds
v_mfma_f32_16x16x32_bf16 v[212:215], a[52:55], v[56:59], v[212:215]
ds_read_b128 a[16:19], v1 offset:12288
v_exp_f32 v41, v41
v_mfma_f32_16x16x32_bf16 v[216:219], a[56:59], v[56:59], v[216:219]
ds_read_b128 a[20:23], v1 offset:13312
v_exp_f32 v42, v42
v_mfma_f32_16x16x32_bf16 v[248:251], a[56:59], v[60:63], v[248:251]
buffer_load_dwordx4 v13, s[72:75], s12 offen offset:3072 lds
v_mfma_f32_16x16x32_bf16 v[252:255], a[60:63], v[60:63], v[252:255]
ds_read_b128 a[24:27], v1 offset:14336
s_waitcnt lgkmcnt(3)
v_mfma_f32_16x16x32_bf16 v[220:223], a[60:63], v[56:59], v[220:223]
ds_read_b128 a[28:31], v1 offset:15360
v_add_u32 v12, 0x20000, v12
v_smfmac_f32_16x16x64_bf16 a[228:231], a[232:235], v[56:63], v9
s_add_u32 m0, s17, 0x14000
v_exp_f32 v43, v43
v_mfma_f32_16x16x32_bf16 v[24:27], a[0:3], a[192:195], v[88:91]
buffer_load_dwordx4 v12, s[72:75], 0 offen lds
v_mfma_f32_16x16x32_bf16 v[24:27], a[4:7], a[196:199], v[24:27]
ds_read_b128 a[32:35], v1 offset:0
v_cvt_pk_bf16_f32 v74, v40, v41
v_mfma_f32_16x16x32_bf16 v[24:27], a[8:11], a[200:203], v[24:27]
ds_read_b128 a[36:39], v1 offset:1024
v_exp_f32 v44, v44
v_mfma_f32_16x16x32_bf16 v[24:27], a[12:15], a[204:207], v[24:27]
ds_read_b128 a[40:43], v1 offset:2048
v_exp_f32 v45, v45
v_mfma_f32_16x16x32_bf16 v[28:31], a[0:3], a[208:211], v[92:95]
ds_read_b128 a[44:47], v1 offset:3072
v_exp_f32 v46, v46
v_mfma_f32_16x16x32_bf16 v[28:31], a[4:7], a[212:215], v[28:31]
s_waitcnt lgkmcnt(4)
v_exp_f32 v47, v47
v_mfma_f32_16x16x32_bf16 v[28:31], a[8:11], a[216:219], v[28:31]
ds_read_b128 a[48:51], v1 offset:4096
v_add_u32 v13, 0x20000, v13
v_mfma_f32_16x16x32_bf16 v[28:31], a[12:15], a[220:223], v[28:31]
buffer_load_dwordx4 v13, s[72:75], 0 offen offset:1024 lds
v_cvt_pk_bf16_f32 v75, v42, v43
v_mfma_f32_16x16x32_bf16 v[40:43], a[16:19], a[192:195], v[88:91]
ds_read_b128 a[52:55], v1 offset:5120
v_exp_f32 v24, v24
v_mfma_f32_16x16x32_bf16 v[40:43], a[20:23], a[196:199], v[40:43]
buffer_load_dwordx4 v12, s[72:75], s12 offen offset:2048 lds
v_mfma_f32_16x16x32_bf16 v[40:43], a[24:27], a[200:203], v[40:43]
ds_read_b128 a[56:59], v1 offset:6144
v_exp_f32 v25, v25
v_mfma_f32_16x16x32_bf16 v[40:43], a[28:31], a[204:207], v[40:43]
ds_read_b128 a[60:63], v1 offset:7168
v_cvt_pk_bf16_f32 v78, v44, v45
v_cvt_pk_bf16_f32 v79, v46, v47
v_mfma_f32_16x16x32_bf16 v[44:47], a[16:19], a[208:211], v[92:95]
buffer_load_dwordx4 v13, s[72:75], s12 offen offset:3072 lds
v_mfma_f32_16x16x32_bf16 v[44:47], a[20:23], a[212:215], v[44:47]
v_exp_f32 v26, v26
v_mfma_f32_16x16x32_bf16 v[44:47], a[24:27], a[216:219], v[44:47]
v_exp_f32 v27, v27
v_mfma_f32_16x16x32_bf16 v[44:47], a[28:31], a[220:223], v[44:47]
s_waitcnt lgkmcnt(0)
v_exp_f32 v28, v28
v_exp_f32 v29, v29
v_mfma_f32_16x16x32_bf16 v[192:195], a[32:35], v[72:75], v[192:195]
s_add_u32 m0, s16, 0x0
v_add_u32 v12, 0x20000, v12
v_cvt_pk_bf16_f32 v56, v24, v25
v_mfma_f32_16x16x32_bf16 v[224:227], a[32:35], v[76:79], v[224:227]
buffer_load_dwordx4 v12, s[72:75], 0 offen lds
v_mfma_f32_16x16x32_bf16 v[228:231], a[36:39], v[76:79], v[228:231]
ds_read_b128 a[0:3], v1 offset:24576
v_cvt_pk_bf16_f32 v57, v26, v27
v_mfma_f32_16x16x32_bf16 v[196:199], a[36:39], v[72:75], v[196:199]
v_exp_f32 v30, v30
v_mfma_f32_16x16x32_bf16 v[200:203], a[40:43], v[72:75], v[200:203]
ds_read_b128 a[4:7], v1 offset:25600
v_cvt_pk_bf16_f32 v60, v28, v29
v_mfma_f32_16x16x32_bf16 v[232:235], a[40:43], v[76:79], v[232:235]
ds_read_b128 a[8:11], v1 offset:26624
v_add_u32 v13, 0x20000, v13
v_mfma_f32_16x16x32_bf16 v[236:239], a[44:47], v[76:79], v[236:239]
buffer_load_dwordx4 v13, s[72:75], 0 offen offset:1024 lds
v_mfma_f32_16x16x32_bf16 v[204:207], a[44:47], v[72:75], v[204:207]
ds_read_b128 a[12:15], v1 offset:27648
v_exp_f32 v31, v31
v_mfma_f32_16x16x32_bf16 v[208:211], a[48:51], v[72:75], v[208:211]
buffer_load_dwordx4 v12, s[72:75], s12 offen offset:2048 lds
v_mfma_f32_16x16x32_bf16 v[240:243], a[48:51], v[76:79], v[240:243]
ds_read_b128 a[16:19], v1 offset:28672
v_exp_f32 v40, v40
v_mfma_f32_16x16x32_bf16 v[244:247], a[52:55], v[76:79], v[244:247]
ds_read_b128 a[20:23], v1 offset:29696
v_cvt_pk_bf16_f32 v61, v30, v31
v_mfma_f32_16x16x32_bf16 v[212:215], a[52:55], v[72:75], v[212:215]
buffer_load_dwordx4 v13, s[72:75], s12 offen offset:3072 lds
v_mfma_f32_16x16x32_bf16 v[216:219], a[56:59], v[72:75], v[216:219]
ds_read_b128 a[24:27], v1 offset:30720
v_exp_f32 v41, v41
v_mfma_f32_16x16x32_bf16 v[248:251], a[56:59], v[76:79], v[248:251]
ds_read_b128 a[28:31], v1 offset:31744
v_exp_f32 v42, v42
v_mfma_f32_16x16x32_bf16 v[252:255], a[60:63], v[76:79], v[252:255]
ds_read_b128 a[32:35], v1 offset:16384
v_cvt_pk_bf16_f32 v58, v40, v41
v_mfma_f32_16x16x32_bf16 v[220:223], a[60:63], v[72:75], v[220:223]
s_waitcnt lgkmcnt(5)
v_exp_f32 v43, v43
v_smfmac_f32_16x16x64_bf16 a[228:231], a[232:235], v[72:79], v9
ds_read_b128 a[36:39], v1 offset:17408
v_add_u32 v12, 0x20000, v12
v_mfma_f32_16x16x32_bf16 v[24:27], a[0:3], a[192:195], v[112:115]
s_add_u32 m0, s16, 0x4000
v_exp_f32 v44, v44
v_mfma_f32_16x16x32_bf16 v[24:27], a[4:7], a[196:199], v[24:27]
buffer_load_dwordx4 v12, s[72:75], 0 offen lds
v_mfma_f32_16x16x32_bf16 v[24:27], a[8:11], a[200:203], v[24:27]
ds_read_b128 a[40:43], v1 offset:18432
v_add_u32 v13, 0x20000, v13
v_mfma_f32_16x16x32_bf16 v[24:27], a[12:15], a[204:207], v[24:27]
buffer_load_dwordx4 v13, s[72:75], 0 offen offset:1024 lds
v_mfma_f32_16x16x32_bf16 v[28:31], a[0:3], a[208:211], v[92:95]
ds_read_b128 a[44:47], v1 offset:19456
v_cvt_pk_bf16_f32 v59, v42, v43
v_mfma_f32_16x16x32_bf16 v[28:31], a[4:7], a[212:215], v[28:31]
ds_read_b128 a[48:51], v1 offset:20480
v_exp_f32 v45, v45
v_mfma_f32_16x16x32_bf16 v[28:31], a[8:11], a[216:219], v[28:31]
s_waitcnt lgkmcnt(5)
v_exp_f32 v46, v46
v_mfma_f32_16x16x32_bf16 v[28:31], a[12:15], a[220:223], v[28:31]
buffer_load_dwordx4 v12, s[72:75], s12 offen offset:2048 lds
v_mfma_f32_16x16x32_bf16 v[40:43], a[16:19], a[192:195], v[116:119]
ds_read_b128 a[52:55], v1 offset:21504
v_exp_f32 v47, v47
v_mfma_f32_16x16x32_bf16 v[40:43], a[20:23], a[196:199], v[40:43]
ds_read_b128 a[56:59], v1 offset:22528
v_exp_f32 v24, v24
v_mfma_f32_16x16x32_bf16 v[40:43], a[24:27], a[200:203], v[40:43]
ds_read_b128 a[60:63], v1 offset:23552
v_xor_b32 v1, 0x8000, v1
v_mfma_f32_16x16x32_bf16 v[40:43], a[28:31], a[204:207], v[40:43]
v_exp_f32 v25, v25
v_cvt_pk_bf16_f32 v62, v44, v45
v_cvt_pk_bf16_f32 v63, v46, v47
v_mfma_f32_16x16x32_bf16 v[44:47], a[16:19], a[208:211], v[92:95]
v_exp_f32 v26, v26
v_mfma_f32_16x16x32_bf16 v[44:47], a[20:23], a[212:215], v[44:47]
buffer_load_dwordx4 v13, s[72:75], s12 offen offset:3072 lds
v_mfma_f32_16x16x32_bf16 v[44:47], a[24:27], a[216:219], v[44:47]
v_exp_f32 v27, v27
v_mfma_f32_16x16x32_bf16 v[44:47], a[28:31], a[220:223], v[44:47]
v_exp_f32 v28, v28
v_exp_f32 v29, v29
L_att_h1_1:
s_waitcnt vmcnt(16) lgkmcnt(0)
s_mov_b32 s92, 200000
L_spin_b1:
v_cmp_gt_u32 vcc, 32, v14
s_nop 4
s_cbranch_vccz L_spun_b1
s_sub_u32 s92, s92, 1
s_cbranch_scc1 L_spun_b1
s_sleep 6
buffer_load_dword v14, v15, s[84:87], 0 offen offset:192 sc1
s_waitcnt vmcnt(0)
s_branch L_spin_b1
L_spun_b1:
s_barrier
v_mfma_f32_16x16x32_bf16 v[192:195], a[32:35], v[56:59], v[192:195]
ds_read_b128 a[0:3], v2 offset:8192
v_cvt_pk_bf16_f32 v72, v24, v25
v_mfma_f32_16x16x32_bf16 v[224:227], a[32:35], v[60:63], v[224:227]
ds_read_b128 a[4:7], v2 offset:9216
v_cvt_pk_bf16_f32 v73, v26, v27
v_mfma_f32_16x16x32_bf16 v[228:231], a[36:39], v[60:63], v[228:231]
s_add_u32 s101, s101, 0x2000
v_exp_f32 v30, v30
v_mfma_f32_16x16x32_bf16 v[196:199], a[36:39], v[56:59], v[196:199]
buffer_load_dwordx4 a[64:67], v3, s[88:91], s101 offen sc1
v_mfma_f32_16x16x32_bf16 v[200:203], a[40:43], v[56:59], v[200:203]
ds_read_b128 a[8:11], v2 offset:10240
v_cvt_pk_bf16_f32 v76, v28, v29
v_mfma_f32_16x16x32_bf16 v[232:235], a[40:43], v[60:63], v[232:235]
buffer_load_dwordx4 a[68:71], v3, s[88:91], s101 offen offset:1024 sc1
v_mfma_f32_16x16x32_bf16 v[236:239], a[44:47], v[60:63], v[236:239]
ds_read_b128 a[12:15], v2 offset:11264
s_add_u32 s101, s101, 0x2000
v_mfma_f32_16x16x32_bf16 v[204:207], a[44:47], v[56:59], v[204:207]
buffer_load_dwordx4 a[72:75], v3, s[88:91], s101 offen sc1
v_mfma_f32_16x16x32_bf16 v[208:211], a[48:51], v[56:59], v[208:211]
ds_read_b128 a[16:19], v2 offset:12288
v_exp_f32 v31, v31
v_mfma_f32_16x16x32_bf16 v[240:243], a[48:51], v[60:63], v[240:243]
buffer_load_dwordx4 a[76:79], v3, s[88:91], s101 offen offset:1024 sc1
v_mfma_f32_16x16x32_bf16 v[244:247], a[52:55], v[60:63], v[244:247]
ds_read_b128 a[20:23], v2 offset:13312
v_exp_f32 v40, v40
v_mfma_f32_16x16x32_bf16 v[212:215], a[52:55], v[56:59], v[212:215]
ds_read_b128 a[24:27], v2 offset:14336
v_exp_f32 v41, v41
v_mfma_f32_16x16x32_bf16 v[216:219], a[56:59], v[56:59], v[216:219]
ds_read_b128 a[28:31], v2 offset:15360
s_add_u32 s101, s101, 0x2000
v_mfma_f32_16x16x32_bf16 v[248:251], a[56:59], v[60:63], v[248:251]
buffer_load_dwordx4 a[80:83], v3, s[88:91], s101 offen sc1
v_mfma_f32_16x16x32_bf16 v[252:255], a[60:63], v[60:63], v[252:255]
ds_read_b128 a[32:35], v2 offset:0
v_cvt_pk_bf16_f32 v77, v30, v31
v_mfma_f32_16x16x32_bf16 v[220:223], a[60:63], v[56:59], v[220:223]
ds_read_b128 a[36:39], v2 offset:1024
s_waitcnt lgkmcnt(6)
v_smfmac_f32_16x16x64_bf16 a[228:231], a[232:235], v[56:63], v9
buffer_load_dwordx4 a[84:87], v3, s[88:91], s101 offen offset:1024 sc1
v_mfma_f32_16x16x32_bf16 v[28:31], a[0:3], a[208:211], v[120:123]
ds_read_b128 a[40:43], v2 offset:2048
v_exp_f32 v42, v42
v_mfma_f32_16x16x32_bf16 v[28:31], a[4:7], a[212:215], v[28:31]
ds_read_b128 a[44:47], v2 offset:3072
s_add_u32 s101, s101, 0x2000
v_mfma_f32_16x16x32_bf16 v[28:31], a[8:11], a[216:219], v[28:31]
buffer_load_dwordx4 a[88:91], v3, s[88:91], s101 offen sc1
v_mfma_f32_16x16x32_bf16 v[28:31], a[12:15], a[220:223], v[28:31]
ds_read_b128 a[48:51], v2 offset:4096
s_waitcnt lgkmcnt(5)
v_exp_f32 v43, v43
v_exp_f32 v44, v44
v_exp_f32 v45, v45
v_exp_f32 v46, v46
v_exp_f32 v47, v47
v_cvt_pk_bf16_f32 v78, v44, v45
v_cvt_pk_bf16_f32 v79, v46, v47
v_mfma_f32_16x16x32_bf16 v[44:47], a[16:19], a[208:211], v[124:127]
ds_read_b128 a[52:55], v2 offset:5120
v_cvt_pk_bf16_f32 v74, v40, v41
v_mfma_f32_16x16x32_bf16 v[44:47], a[20:23], a[212:215], v[44:47]
buffer_load_dwordx4 a[92:95], v3, s[88:91], s101 offen offset:1024 sc1
v_mfma_f32_16x16x32_bf16 v[44:47], a[24:27], a[216:219], v[44:47]
ds_read_b128 a[56:59], v2 offset:6144
v_cvt_pk_bf16_f32 v75, v42, v43
v_mfma_f32_16x16x32_bf16 v[44:47], a[28:31], a[220:223], v[44:47]
ds_read_b128 a[60:63], v2 offset:7168
s_waitcnt lgkmcnt(0)
v_mfma_f32_16x16x32_bf16 v[192:195], a[32:35], v[72:75], v[192:195]
s_add_u32 s101, s101, 0x2000
v_exp_f32 v28, v28
v_mfma_f32_16x16x32_bf16 v[224:227], a[32:35], v[76:79], v[224:227]
buffer_load_dwordx4 a[96:99], v3, s[88:91], s101 offen sc1
v_mfma_f32_16x16x32_bf16 v[228:231], a[36:39], v[76:79], v[228:231]
ds_read_b128 a[32:35], v2 offset:16384
v_exp_f32 v29, v29
v_mfma_f32_16x16x32_bf16 v[196:199], a[36:39], v[72:75], v[196:199]
buffer_load_dwordx4 a[100:103], v3, s[88:91], s101 offen offset:1024 sc1
v_mfma_f32_16x16x32_bf16 v[200:203], a[40:43], v[72:75], v[200:203]
ds_read_b128 a[36:39], v2 offset:17408
s_add_u32 s101, s101, 0x2000
v_mfma_f32_16x16x32_bf16 v[232:235], a[40:43], v[76:79], v[232:235]
buffer_load_dwordx4 a[104:107], v3, s[88:91], s101 offen sc1
v_mfma_f32_16x16x32_bf16 v[236:239], a[44:47], v[76:79], v[236:239]
ds_read_b128 a[40:43], v2 offset:18432
v_exp_f32 v30, v30
v_mfma_f32_16x16x32_bf16 v[204:207], a[44:47], v[72:75], v[204:207]
buffer_load_dwordx4 a[108:111], v3, s[88:91], s101 offen offset:1024 sc1
v_mfma_f32_16x16x32_bf16 v[208:211], a[48:51], v[72:75], v[208:211]
ds_read_b128 a[44:47], v2 offset:19456
s_add_u32 s101, s101, 0x2000
v_mfma_f32_16x16x32_bf16 v[240:243], a[48:51], v[76:79], v[240:243]
buffer_load_dwordx4 a[112:115], v3, s[88:91], s101 offen sc1
v_mfma_f32_16x16x32_bf16 v[244:247], a[52:55], v[76:79], v[244:247]
ds_read_b128 a[48:51], v2 offset:20480
v_exp_f32 v31, v31
v_mfma_f32_16x16x32_bf16 v[212:215], a[52:55], v[72:75], v[212:215]
buffer_load_dwordx4 a[116:119], v3, s[88:91], s101 offen offset:1024 sc1
v_mfma_f32_16x16x32_bf16 v[216:219], a[56:59], v[72:75], v[216:219]
ds_read_b128 a[52:55], v2 offset:21504
s_add_u32 s101, s101, 0x2000
v_mfma_f32_16x16x32_bf16 v[248:251], a[56:59], v[76:79], v[248:251]
buffer_load_dwordx4 a[120:123], v3, s[88:91], s101 offen sc1
v_mfma_f32_16x16x32_bf16 v[252:255], a[60:63], v[76:79], v[252:255]
buffer_load_dwordx4 a[124:127], v3, s[88:91], s101 offen offset:1024 sc1
v_mfma_f32_16x16x32_bf16 v[220:223], a[60:63], v[72:75], v[220:223]
ds_read_b128 a[56:59], v2 offset:22528
v_cvt_pk_bf16_f32 v60, v28, v29
v_smfmac_f32_16x16x64_bf16 a[228:231], a[232:235], v[72:79], v9
ds_read_b128 a[60:63], v2 offset:23552
v_xor_b32 v2, 0x38000, v2
v_exp_f32 v44, v44
v_exp_f32 v45, v45
v_exp_f32 v46, v46
v_exp_f32 v47, v47
v_cvt_pk_bf16_f32 v61, v30, v31
v_cvt_pk_bf16_f32 v62, v44, v45
v_cvt_pk_bf16_f32 v63, v46, v47
s_waitcnt lgkmcnt(0)
s_barrier
v_accvgpr_read_b32 v6, a228
v_accvgpr_read_b32 v7, a229
v_add_f32 v6, v6, v7
v_cmp_nge_f32 vcc, 0x6f800000, v6
v_rcp_f32 v6, v6
s_or_b64 s[34:35], s[34:35], vcc
v_mfma_f32_16x16x32_bf16 v[224:227], a[32:35], v[60:63], v[224:227]
s_add_u32 s8, s30, 0x0
v_mul_f32 v192, v6, v192
v_mfma_f32_16x16x32_bf16 v[228:231], a[36:39], v[60:63], v[228:231]
v_mul_f32 v193, v6, v193
v_mul_f32 v194, v6, v194
v_mfma_f32_16x16x32_bf16 v[232:235], a[40:43], v[60:63], v[232:235]
v_mul_f32 v195, v6, v195
v_mul_f32 v196, v6, v196
v_mfma_f32_16x16x32_bf16 v[236:239], a[44:47], v[60:63], v[236:239]
v_mul_f32 v197, v6, v197
v_mul_f32 v198, v6, v198
v_mfma_f32_16x16x32_bf16 v[240:243], a[48:51], v[60:63], v[240:243]
v_mul_f32 v199, v6, v199
v_cvt_pk_bf16_f32 v192, v192, v193
v_mfma_f32_16x16x32_bf16 v[244:247], a[52:55], v[60:63], v[244:247]
v_cvt_pk_bf16_f32 v193, v194, v195
v_cvt_pk_bf16_f32 v194, v196, v197
v_mfma_f32_16x16x32_bf16 v[248:251], a[56:59], v[60:63], v[248:251]
v_cvt_pk_bf16_f32 v195, v198, v199
buffer_store_dwordx4 v[192:195], v3, s[88:91], s8 offen sc1
v_mfma_f32_16x16x32_bf16 v[252:255], a[60:63], v[60:63], v[252:255]
v_mfma_f32_16x16x32_bf16 a[228:231], a[236:239], v[60:63], a[228:231]
s_add_u32 s8, s30, 0x2000
v_pk_mul_f32 v[200:201], v[200:201], v[6:7] op_sel_hi:[1,0]
v_pk_mul_f32 v[202:203], v[202:203], v[6:7] op_sel_hi:[1,0]
v_pk_mul_f32 v[204:205], v[204:205], v[6:7] op_sel_hi:[1,0]
v_pk_mul_f32 v[206:207], v[206:207], v[6:7] op_sel_hi:[1,0]
v_cvt_pk_bf16_f32 v200, v200, v201
v_cvt_pk_bf16_f32 v201, v202, v203
v_cvt_pk_bf16_f32 v202, v204, v205
v_cvt_pk_bf16_f32 v203, v206, v207
buffer_store_dwordx4 v[200:203], v3, s[88:91], s8 offen sc1
s_add_u32 s8, s30, 0x4000
v_pk_mul_f32 v[208:209], v[208:209], v[6:7] op_sel_hi:[1,0]
v_pk_mul_f32 v[210:211], v[210:211], v[6:7] op_sel_hi:[1,0]
v_pk_mul_f32 v[212:213], v[212:213], v[6:7] op_sel_hi:[1,0]
v_pk_mul_f32 v[214:215], v[214:215], v[6:7] op_sel_hi:[1,0]
v_cvt_pk_bf16_f32 v208, v208, v209
v_cvt_pk_bf16_f32 v209, v210, v211
v_cvt_pk_bf16_f32 v210, v212, v213
v_cvt_pk_bf16_f32 v211, v214, v215
buffer_store_dwordx4 v[208:211], v3, s[88:91], s8 offen sc1
s_add_u32 s8, s30, 0x6000
v_pk_mul_f32 v[216:217], v[216:217], v[6:7] op_sel_hi:[1,0]
v_pk_mul_f32 v[218:219], v[218:219], v[6:7] op_sel_hi:[1,0]
v_pk_mul_f32 v[220:221], v[220:221], v[6:7] op_sel_hi:[1,0]
v_pk_mul_f32 v[222:223], v[222:223], v[6:7] op_sel_hi:[1,0]
v_cvt_pk_bf16_f32 v216, v216, v217
v_cvt_pk_bf16_f32 v217, v218, v219
v_cvt_pk_bf16_f32 v218, v220, v221
v_cvt_pk_bf16_f32 v219, v222, v223
buffer_store_dwordx4 v[216:219], v3, s[88:91], s8 offen sc1
L_att_fin:
v_accvgpr_read_b32 v6, a230
v_accvgpr_read_b32 v7, a231
v_add_f32 v6, v6, v7
v_cmp_nge_f32 vcc, 0x6f800000, v6
v_rcp_f32 v6, v6
s_or_b64 s[34:35], s[34:35], vcc
s_add_u32 s8, s31, 0x0
v_pk_mul_f32 v[224:225], v[224:225], v[6:7] op_sel_hi:[1,0]
v_pk_mul_f32 v[226:227], v[226:227], v[6:7] op_sel_hi:[1,0]
v_pk_mul_f32 v[228:229], v[228:229], v[6:7] op_sel_hi:[1,0]
v_pk_mul_f32 v[230:231], v[230:231], v[6:7] op_sel_hi:[1,0]
v_cvt_pk_bf16_f32 v224, v224, v225
v_cvt_pk_bf16_f32 v225, v226, v227
v_cvt_pk_bf16_f32 v226, v228, v229
v_cvt_pk_bf16_f32 v227, v230, v231
buffer_store_dwordx4 v[224:227], v3, s[88:91], s8 offen sc1
s_add_u32 s8, s31, 0x2000
v_pk_mul_f32 v[232:233], v[232:233], v[6:7] op_sel_hi:[1,0]
v_pk_mul_f32 v[234:235], v[234:235], v[6:7] op_sel_hi:[1,0]
v_pk_mul_f32 v[236:237], v[236:237], v[6:7] op_sel_hi:[1,0]
v_pk_mul_f32 v[238:239], v[238:239], v[6:7] op_sel_hi:[1,0]
v_cvt_pk_bf16_f32 v232, v232, v233
v_cvt_pk_bf16_f32 v233, v234, v235
v_cvt_pk_bf16_f32 v234, v236, v237
v_cvt_pk_bf16_f32 v235, v238, v239
buffer_store_dwordx4 v[232:235], v3, s[88:91], s8 offen sc1
s_add_u32 s8, s31, 0x4000
v_pk_mul_f32 v[240:241], v[240:241], v[6:7] op_sel_hi:[1,0]
v_pk_mul_f32 v[242:243], v[242:243], v[6:7] op_sel_hi:[1,0]
v_pk_mul_f32 v[244:245], v[244:245], v[6:7] op_sel_hi:[1,0]
v_pk_mul_f32 v[246:247], v[246:247], v[6:7] op_sel_hi:[1,0]
v_cvt_pk_bf16_f32 v240, v240, v241
v_cvt_pk_bf16_f32 v241, v242, v243
v_cvt_pk_bf16_f32 v242, v244, v245
v_cvt_pk_bf16_f32 v243, v246, v247
buffer_store_dwordx4 v[240:243], v3, s[88:91], s8 offen sc1
s_add_u32 s8, s31, 0x6000
v_pk_mul_f32 v[248:249], v[248:249], v[6:7] op_sel_hi:[1,0]
v_pk_mul_f32 v[250:251], v[250:251], v[6:7] op_sel_hi:[1,0]
v_pk_mul_f32 v[252:253], v[252:253], v[6:7] op_sel_hi:[1,0]
v_pk_mul_f32 v[254:255], v[254:255], v[6:7] op_sel_hi:[1,0]
v_cvt_pk_bf16_f32 v248, v248, v249
v_cvt_pk_bf16_f32 v249, v250, v251
v_cvt_pk_bf16_f32 v250, v252, v253
v_cvt_pk_bf16_f32 v251, v254, v255
buffer_store_dwordx4 v[248:251], v3, s[88:91], s8 offen sc1
s_cmp_lg_u64 s[34:35], 0
s_cselect_b32 s8, 1, 0
s_lshl_b32 s9, s4, 2
s_add_u32 s9, s9, 24576
v_mov_b32 v4, s9
v_mov_b32 v5, s8
ds_write_b32 v4, v5
v_lshrrev_b32 v17, 4, v0
v_lshlrev_b32 v18, 10, v17
v_and_b32 v17, 1, v17
v_lshl_add_u32 v18, v17, 5, v18
v_bfe_u32 v17, v0, 2, 2
v_lshl_add_u32 v18, v17, 6, v18
v_and_b32 v17, 3, v0
v_lshl_add_u32 v4, v17, 3, v18
s_sub_u32 s8, s16, s17
v_add_u32 v6, s8, v4
v_xor_b32 v7, 32, v6
v_add_u32 v4, 65536, v4
v_xor_b32 v5, 32, v4
v_and_b32 v20, 15, v0
v_lshlrev_b32 v20, 2, v20
v_and_b32 v16, 28, v20
s_waitcnt vmcnt(20) lgkmcnt(0)
s_barrier
v_and_b32 v17, 3, v0
v_lshlrev_b32 v17, 2, v17
v_add_u32 v17, 24576, v17
ds_read_b32 v18, v17
s_waitcnt lgkmcnt(0)
v_cmp_ne_u32 vcc, 0, v18
s_cmp_lg_u32 s33, 0
s_cbranch_scc1 L_att_done
s_nop 4
s_cbranch_vccnz L_att_fallback
L_att_done:
ds_read_b64_tr_b16 v[152:153], v4 offset:512
ds_read_b64_tr_b16 v[154:155], v4 offset:4608
ds_read_b64_tr_b16 v[156:157], v4 offset:8704
ds_read_b64_tr_b16 v[158:159], v4 offset:12800
ds_read_b64_tr_b16 v[160:161], v5 offset:512
ds_read_b64_tr_b16 v[162:163], v5 offset:4608
ds_read_b64_tr_b16 v[164:165], v5 offset:8704
ds_read_b64_tr_b16 v[166:167], v5 offset:12800
ds_read_b64_tr_b16 v[168:169], v4 offset:768
ds_read_b64_tr_b16 v[170:171], v4 offset:4864
ds_read_b64_tr_b16 v[172:173], v4 offset:8960
ds_read_b64_tr_b16 v[174:175], v4 offset:13056
ds_read_b64_tr_b16 v[176:177], v5 offset:768
ds_read_b64_tr_b16 v[178:179], v5 offset:4864
ds_read_b64_tr_b16 v[180:181], v5 offset:8960
ds_read_b64_tr_b16 v[182:183], v5 offset:13056
s_lshl_b32 s29, s99, 7
s_lshl_b32 s9, s4, 5
s_add_u32 s29, s29, s9
s_lshl_b32 s9, s29, 2
s_add_u32 s9, s9, 0x3700000
buffer_load_dword v8, v20, s[88:91], s9 offen sc1
buffer_load_dword v9, v20, s[88:91], s9 offen offset:64 sc1
s_waitcnt lgkmcnt(8)
v_mfma_f32_16x16x32_bf16 v[56:59], v[152:155], a[64:67], 0
ds_read_b64_tr_b16 v[184:185], v4 offset:0
v_mov_b32 v88, 0
v_mfma_f32_16x16x32_bf16 v[56:59], v[156:159], a[72:75], v[56:59]
ds_read_b64_tr_b16 v[186:187], v4 offset:4096
v_mov_b32 v89, 0
v_mfma_f32_16x16x32_bf16 v[72:75], v[156:159], a[76:79], 0
ds_read_b64_tr_b16 v[188:189], v4 offset:8192
v_mov_b32 v90, 0
v_mfma_f32_16x16x32_bf16 v[72:75], v[152:155], a[68:71], v[72:75]
ds_read_b64_tr_b16 v[190:191], v4 offset:12288
v_mov_b32 v91, 0
v_mfma_f32_16x16x32_bf16 v[76:79], v[160:163], a[68:71], 0
ds_read_b64_tr_b16 v[192:193], v5 offset:0
v_mov_b32 v92, 0
v_mfma_f32_16x16x32_bf16 v[76:79], v[164:167], a[76:79], v[76:79]
ds_read_b64_tr_b16 v[194:195], v5 offset:4096
v_mov_b32 v93, 0
v_mfma_f32_16x16x32_bf16 v[60:63], v[164:167], a[72:75], 0
ds_read_b64_tr_b16 v[196:197], v5 offset:8192
s_waitcnt lgkmcnt(7)
v_mfma_f32_16x16x32_bf16 v[60:63], v[160:163], a[64:67], v[60:63]
ds_read_b64_tr_b16 v[198:199], v5 offset:12288
v_mov_b32 v94, 0
v_mfma_f32_16x16x32_bf16 v[64:67], v[168:171], a[64:67], 0
ds_read_b64_tr_b16 v[200:201], v4 offset:256
v_mov_b32 v95, 0
v_mfma_f32_16x16x32_bf16 v[64:67], v[172:175], a[72:75], v[64:67]
ds_read_b64_tr_b16 v[202:203], v4 offset:4352
v_mov_b32 v96, 0
v_mfma_f32_16x16x32_bf16 v[80:83], v[172:175], a[76:79], 0
ds_read_b64_tr_b16 v[204:205], v4 offset:8448
v_mov_b32 v97, 0
v_mfma_f32_16x16x32_bf16 v[80:83], v[168:171], a[68:71], v[80:83]
ds_read_b64_tr_b16 v[206:207], v4 offset:12544
v_mov_b32 v98, 0
v_mfma_f32_16x16x32_bf16 v[84:87], v[176:179], a[68:71], 0
ds_read_b64_tr_b16 v[208:209], v5 offset:256
v_mov_b32 v99, 0
v_mfma_f32_16x16x32_bf16 v[84:87], v[180:183], a[76:79], v[84:87]
ds_read_b64_tr_b16 v[210:211], v5 offset:4352
s_waitcnt vmcnt(2) lgkmcnt(6)
v_mfma_f32_16x16x32_bf16 v[68:71], v[180:183], a[72:75], 0
ds_read_b64_tr_b16 v[212:213], v5 offset:8448
s_barrier
v_mfma_f32_16x16x32_bf16 v[68:71], v[176:179], a[64:67], v[68:71]
ds_read_b64_tr_b16 v[214:215], v5 offset:12544
v_mov_b32 v100, 0
s_cmp_lg_u32 s4, 0
s_cbranch_scc1 L_flag_set
s_lshl_b32 s8, s6, 5
s_add_u32 s8, s8, s5
s_and_b32 s92, s8, 0xf0
s_mul_i32 s92, s92, 3
s_add_u32 s8, s8, s92
s_lshl_b32 s8, s8, 2
s_add_u32 s8, s8, 0x3704000
v_mov_b32 v21, 1
s_mov_b64 exec, 1
buffer_store_dword v21, off, s[88:91], s8 sc1
s_mov_b64 exec, -1
L_flag_set:
v_mfma_f32_16x16x32_bf16 v[24:27], v[184:187], a[64:67], 0
ds_read_b64_tr_b16 v[152:153], v4 offset:16896
s_lshl_b32 s29, s29, 11
v_mfma_f32_16x16x32_bf16 v[24:27], v[188:191], a[72:75], v[24:27]
ds_read_b64_tr_b16 v[154:155], v4 offset:20992
s_lshl_b32 s9, s100, 8
v_mfma_f32_16x16x32_bf16 v[40:43], v[188:191], a[76:79], 0
ds_read_b64_tr_b16 v[156:157], v4 offset:25088
s_add_u32 s29, s29, s9
v_mfma_f32_16x16x32_bf16 v[40:43], v[184:187], a[68:71], v[40:43]
ds_read_b64_tr_b16 v[158:159], v4 offset:29184
s_lshl_b32 s9, s14, 7
v_mfma_f32_16x16x32_bf16 v[44:47], v[192:195], a[68:71], 0
ds_read_b64_tr_b16 v[160:161], v5 offset:16896
s_add_u32 s29, s29, s9
v_mfma_f32_16x16x32_bf16 v[44:47], v[196:199], a[76:79], v[44:47]
ds_read_b64_tr_b16 v[162:163], v5 offset:20992
s_add_u32 s31, s29, 0x8000
v_mfma_f32_16x16x32_bf16 v[28:31], v[196:199], a[72:75], 0
ds_read_b64_tr_b16 v[164:165], v5 offset:25088
s_waitcnt lgkmcnt(7)
v_mfma_f32_16x16x32_bf16 v[28:31], v[192:195], a[64:67], v[28:31]
ds_read_b64_tr_b16 v[166:167], v5 offset:29184
s_lshl_b32 s28, s2, 2
v_mfma_f32_16x16x32_bf16 v[32:35], v[200:203], a[64:67], 0
ds_read_b64_tr_b16 v[168:169], v4 offset:17152
s_add_u32 s28, s28, s4
v_mfma_f32_16x16x32_bf16 v[32:35], v[204:207], a[72:75], v[32:35]
ds_read_b64_tr_b16 v[170:171], v4 offset:21248
s_lshl_b32 s28, s28, 12
v_mfma_f32_16x16x32_bf16 v[48:51], v[204:207], a[76:79], 0
ds_read_b64_tr_b16 v[172:173], v4 offset:25344
s_add_u32 s28, s28, 0x3800000
v_mfma_f32_16x16x32_bf16 v[48:51], v[200:203], a[68:71], v[48:51]
ds_read_b64_tr_b16 v[174:175], v4 offset:29440
s_xor_b32 s30, s28, 0x4000
v_mfma_f32_16x16x32_bf16 v[52:55], v[208:211], a[68:71], 0
ds_read_b64_tr_b16 v[176:177], v5 offset:17152
v_and_b32 v18, 16, v0
v_mfma_f32_16x16x32_bf16 v[52:55], v[212:215], a[76:79], v[52:55]
ds_read_b64_tr_b16 v[178:179], v5 offset:21248
s_waitcnt lgkmcnt(6)
v_mfma_f32_16x16x32_bf16 v[36:39], v[212:215], a[72:75], 0
ds_read_b64_tr_b16 v[180:181], v5 offset:25344
v_lshrrev_b32 v19, 5, v0
v_mfma_f32_16x16x32_bf16 v[36:39], v[208:211], a[64:67], v[36:39]
ds_read_b64_tr_b16 v[182:183], v5 offset:29440
v_lshlrev_b32 v19, 4, v19
v_mfma_f32_16x16x32_bf16 v[56:59], v[152:155], a[80:83], v[56:59]
ds_read_b64_tr_b16 v[184:185], v4 offset:16384
v_mov_b32 v101, 0
v_mfma_f32_16x16x32_bf16 v[56:59], v[156:159], a[88:91], v[56:59]
ds_read_b64_tr_b16 v[186:187], v4 offset:20480
v_mov_b32 v102, 0
v_mfma_f32_16x16x32_bf16 v[72:75], v[156:159], a[92:95], v[72:75]
ds_read_b64_tr_b16 v[188:189], v4 offset:24576
v_mov_b32 v103, 0
v_mfma_f32_16x16x32_bf16 v[72:75], v[152:155], a[84:87], v[72:75]
ds_read_b64_tr_b16 v[190:191], v4 offset:28672
v_mov_b32 v104, 0
v_mfma_f32_16x16x32_bf16 v[76:79], v[160:163], a[84:87], v[76:79]
ds_read_b64_tr_b16 v[192:193], v5 offset:16384
v_mov_b32 v105, 0
v_mfma_f32_16x16x32_bf16 v[76:79], v[164:167], a[92:95], v[76:79]
ds_read_b64_tr_b16 v[194:195], v5 offset:20480
v_mov_b32 v106, 0
v_mfma_f32_16x16x32_bf16 v[60:63], v[164:167], a[88:91], v[60:63]
ds_read_b64_tr_b16 v[196:197], v5 offset:24576
s_waitcnt lgkmcnt(7)
v_mfma_f32_16x16x32_bf16 v[60:63], v[160:163], a[80:83], v[60:63]
ds_read_b64_tr_b16 v[198:199], v5 offset:28672
v_mov_b32 v107, 0
v_mfma_f32_16x16x32_bf16 v[64:67], v[168:171], a[80:83], v[64:67]
ds_read_b64_tr_b16 v[200:201], v4 offset:16640
v_mov_b32 v108, 0
v_mfma_f32_16x16x32_bf16 v[64:67], v[172:175], a[88:91], v[64:67]
ds_read_b64_tr_b16 v[202:203], v4 offset:20736
v_mov_b32 v109, 0
v_mfma_f32_16x16x32_bf16 v[80:83], v[172:175], a[92:95], v[80:83]
ds_read_b64_tr_b16 v[204:205], v4 offset:24832
v_mov_b32 v110, 0
v_mfma_f32_16x16x32_bf16 v[80:83], v[168:171], a[84:87], v[80:83]
ds_read_b64_tr_b16 v[206:207], v4 offset:28928
v_mov_b32 v111, 0
v_mfma_f32_16x16x32_bf16 v[84:87], v[176:179], a[84:87], v[84:87]
ds_read_b64_tr_b16 v[208:209], v5 offset:16640
v_lshl_add_u32 v18, v18, 1, v19
v_mfma_f32_16x16x32_bf16 v[84:87], v[180:183], a[92:95], v[84:87]
ds_read_b64_tr_b16 v[210:211], v5 offset:20736
s_waitcnt vmcnt(14) lgkmcnt(6)
v_mfma_f32_16x16x32_bf16 v[68:71], v[180:183], a[88:91], v[68:71]
ds_read_b64_tr_b16 v[212:213], v5 offset:24832
s_barrier
v_mfma_f32_16x16x32_bf16 v[68:71], v[176:179], a[80:83], v[68:71]
ds_read_b64_tr_b16 v[214:215], v5 offset:28928
v_lshl_add_u32 v17, v20, 9, v18
s_cmp_eq_u32 s14, 1
s_cbranch_scc1 L_p4_skip
v_mfma_f32_16x16x32_bf16 v[24:27], v[184:187], a[80:83], v[24:27]
ds_read_b64_tr_b16 v[152:153], v6 offset:512
ds_read_b64_tr_b16 v[154:155], v6 offset:4608
v_mfma_f32_16x16x32_bf16 v[24:27], v[188:191], a[88:91], v[24:27]
ds_read_b64_tr_b16 v[156:157], v6 offset:8704
v_add_u32 v12, 0x20000, v12
v_mfma_f32_16x16x32_bf16 v[40:43], v[188:191], a[92:95], v[40:43]
ds_read_b64_tr_b16 v[158:159], v6 offset:12800
s_add_u32 m0, s17, 0x10000
v_mfma_f32_16x16x32_bf16 v[40:43], v[184:187], a[84:87], v[40:43]
buffer_load_dwordx4 v12, s[72:75], 0 offen lds
v_mfma_f32_16x16x32_bf16 v[44:47], v[192:195], a[84:87], v[44:47]
ds_read_b64_tr_b16 v[160:161], v7 offset:512
ds_read_b64_tr_b16 v[162:163], v7 offset:4608
v_mfma_f32_16x16x32_bf16 v[44:47], v[196:199], a[92:95], v[44:47]
ds_read_b64_tr_b16 v[164:165], v7 offset:8704
v_add_u32 v13, 0x20000, v13
v_mfma_f32_16x16x32_bf16 v[28:31], v[196:199], a[88:91], v[28:31]
ds_read_b64_tr_b16 v[166:167], v7 offset:12800
s_waitcnt lgkmcnt(8)
v_mfma_f32_16x16x32_bf16 v[28:31], v[192:195], a[80:83], v[28:31]
buffer_load_dwordx4 v13, s[72:75], 0 offen offset:1024 lds
v_mfma_f32_16x16x32_bf16 v[32:35], v[200:203], a[80:83], v[32:35]
ds_read_b64_tr_b16 v[168:169], v6 offset:768
ds_read_b64_tr_b16 v[170:171], v6 offset:4864
v_mfma_f32_16x16x32_bf16 v[32:35], v[204:207], a[88:91], v[32:35]
ds_read_b64_tr_b16 v[172:173], v6 offset:8960
v_mfma_f32_16x16x32_bf16 v[48:51], v[204:207], a[92:95], v[48:51]
ds_read_b64_tr_b16 v[174:175], v6 offset:13056
v_mfma_f32_16x16x32_bf16 v[48:51], v[200:203], a[84:87], v[48:51]
buffer_load_dwordx4 v12, s[72:75], s12 offen offset:2048 lds
v_mfma_f32_16x16x32_bf16 v[52:55], v[208:211], a[84:87], v[52:55]
ds_read_b64_tr_b16 v[176:177], v7 offset:768
ds_read_b64_tr_b16 v[178:179], v7 offset:4864
v_mfma_f32_16x16x32_bf16 v[52:55], v[212:215], a[92:95], v[52:55]
ds_read_b64_tr_b16 v[180:181], v7 offset:8960
s_waitcnt lgkmcnt(7)
v_mfma_f32_16x16x32_bf16 v[36:39], v[212:215], a[88:91], v[36:39]
ds_read_b64_tr_b16 v[182:183], v7 offset:13056
v_mfma_f32_16x16x32_bf16 v[36:39], v[208:211], a[80:83], v[36:39]
buffer_load_dwordx4 v13, s[72:75], s12 offen offset:3072 lds
v_mfma_f32_16x16x32_bf16 v[56:59], v[152:155], a[96:99], v[56:59]
ds_read_b64_tr_b16 v[184:185], v6 offset:0
ds_read_b64_tr_b16 v[186:187], v6 offset:4096
v_mfma_f32_16x16x32_bf16 v[56:59], v[156:159], a[104:107], v[56:59]
ds_read_b64_tr_b16 v[188:189], v6 offset:8192
v_mfma_f32_16x16x32_bf16 v[72:75], v[156:159], a[108:111], v[72:75]
ds_read_b64_tr_b16 v[190:191], v6 offset:12288
s_add_u32 s101, s101, 0x2000
v_mfma_f32_16x16x32_bf16 v[72:75], v[152:155], a[100:103], v[72:75]
buffer_load_dwordx4 a[64:67], v3, s[88:91], s101 offen sc1
v_mfma_f32_16x16x32_bf16 v[76:79], v[160:163], a[100:103], v[76:79]
ds_read_b64_tr_b16 v[192:193], v7 offset:0
ds_read_b64_tr_b16 v[194:195], v7 offset:4096
v_mfma_f32_16x16x32_bf16 v[76:79], v[164:167], a[108:111], v[76:79]
ds_read_b64_tr_b16 v[196:197], v7 offset:8192
v_mfma_f32_16x16x32_bf16 v[60:63], v[164:167], a[104:107], v[60:63]
ds_read_b64_tr_b16 v[198:199], v7 offset:12288
s_waitcnt lgkmcnt(8)
v_mfma_f32_16x16x32_bf16 v[60:63], v[160:163], a[96:99], v[60:63]
buffer_load_dwordx4 a[68:71], v3, s[88:91], s101 offen offset:1024 sc1
v_mfma_f32_16x16x32_bf16 v[64:67], v[168:171], a[96:99], v[64:67]
ds_read_b64_tr_b16 v[200:201], v6 offset:256
ds_read_b64_tr_b16 v[202:203], v6 offset:4352
v_mfma_f32_16x16x32_bf16 v[64:67], v[172:175], a[104:107], v[64:67]
ds_read_b64_tr_b16 v[204:205], v6 offset:8448
v_mfma_f32_16x16x32_bf16 v[80:83], v[172:175], a[108:111], v[80:83]
ds_read_b64_tr_b16 v[206:207], v6 offset:12544
s_add_u32 s101, s101, 0x2000
v_mfma_f32_16x16x32_bf16 v[80:83], v[168:171], a[100:103], v[80:83]
buffer_load_dwordx4 a[72:75], v3, s[88:91], s101 offen sc1
v_mfma_f32_16x16x32_bf16 v[84:87], v[176:179], a[100:103], v[84:87]
ds_read_b64_tr_b16 v[208:209], v7 offset:256
ds_read_b64_tr_b16 v[210:211], v7 offset:4352
v_mfma_f32_16x16x32_bf16 v[84:87], v[180:183], a[108:111], v[84:87]
ds_read_b64_tr_b16 v[212:213], v7 offset:8448
s_waitcnt vmcnt(17) lgkmcnt(7)
v_mfma_f32_16x16x32_bf16 v[68:71], v[180:183], a[104:107], v[68:71]
ds_read_b64_tr_b16 v[214:215], v7 offset:12544
s_barrier
v_mfma_f32_16x16x32_bf16 v[68:71], v[176:179], a[96:99], v[68:71]
buffer_load_dwordx4 a[76:79], v3, s[88:91], s101 offen offset:1024 sc1
v_mfma_f32_16x16x32_bf16 v[24:27], v[184:187], a[96:99], v[24:27]
ds_read_b64_tr_b16 v[152:153], v6 offset:16896
ds_read_b64_tr_b16 v[154:155], v6 offset:20992
v_mfma_f32_16x16x32_bf16 v[24:27], v[188:191], a[104:107], v[24:27]
ds_read_b64_tr_b16 v[156:157], v6 offset:25088
v_add_u32 v12, 0x20000, v12
v_mfma_f32_16x16x32_bf16 v[40:43], v[188:191], a[108:111], v[40:43]
ds_read_b64_tr_b16 v[158:159], v6 offset:29184
s_add_u32 m0, s17, 0x14000
v_mfma_f32_16x16x32_bf16 v[40:43], v[184:187], a[100:103], v[40:43]
buffer_load_dwordx4 v12, s[72:75], 0 offen lds
v_mfma_f32_16x16x32_bf16 v[44:47], v[192:195], a[100:103], v[44:47]
ds_read_b64_tr_b16 v[160:161], v7 offset:16896
ds_read_b64_tr_b16 v[162:163], v7 offset:20992
v_mfma_f32_16x16x32_bf16 v[44:47], v[196:199], a[108:111], v[44:47]
ds_read_b64_tr_b16 v[164:165], v7 offset:25088
v_add_u32 v13, 0x20000, v13
v_mfma_f32_16x16x32_bf16 v[28:31], v[196:199], a[104:107], v[28:31]
ds_read_b64_tr_b16 v[166:167], v7 offset:29184
s_waitcnt lgkmcnt(8)
v_mfma_f32_16x16x32_bf16 v[28:31], v[192:195], a[96:99], v[28:31]
buffer_load_dwordx4 v13, s[72:75], 0 offen offset:1024 lds
v_mfma_f32_16x16x32_bf16 v[32:35], v[200:203], a[96:99], v[32:35]
ds_read_b64_tr_b16 v[168:169], v6 offset:17152
ds_read_b64_tr_b16 v[170:171], v6 offset:21248
v_mfma_f32_16x16x32_bf16 v[32:35], v[204:207], a[104:107], v[32:35]
ds_read_b64_tr_b16 v[172:173], v6 offset:25344
v_mfma_f32_16x16x32_bf16 v[48:51], v[204:207], a[108:111], v[48:51]
ds_read_b64_tr_b16 v[174:175], v6 offset:29440
v_mfma_f32_16x16x32_bf16 v[48:51], v[200:203], a[100:103], v[48:51]
buffer_load_dwordx4 v12, s[72:75], s12 offen offset:2048 lds
v_mfma_f32_16x16x32_bf16 v[52:55], v[208:211], a[100:103], v[52:55]
ds_read_b64_tr_b16 v[176:177], v7 offset:17152
ds_read_b64_tr_b16 v[178:179], v7 offset:21248
v_mfma_f32_16x16x32_bf16 v[52:55], v[212:215], a[108:111], v[52:55]
ds_read_b64_tr_b16 v[180:181], v7 offset:25344
s_waitcnt lgkmcnt(7)
v_mfma_f32_16x16x32_bf16 v[36:39], v[212:215], a[104:107], v[36:39]
ds_read_b64_tr_b16 v[182:183], v7 offset:29440
v_mfma_f32_16x16x32_bf16 v[36:39], v[208:211], a[96:99], v[36:39]
buffer_load_dwordx4 v13, s[72:75], s12 offen offset:3072 lds
v_mfma_f32_16x16x32_bf16 v[56:59], v[152:155], a[112:115], v[56:59]
ds_read_b64_tr_b16 v[184:185], v6 offset:16384
ds_read_b64_tr_b16 v[186:187], v6 offset:20480
v_mfma_f32_16x16x32_bf16 v[56:59], v[156:159], a[120:123], v[56:59]
ds_read_b64_tr_b16 v[188:189], v6 offset:24576
v_mfma_f32_16x16x32_bf16 v[72:75], v[156:159], a[124:127], v[72:75]
ds_read_b64_tr_b16 v[190:191], v6 offset:28672
s_add_u32 s101, s101, 0x2000
v_mfma_f32_16x16x32_bf16 v[72:75], v[152:155], a[116:119], v[72:75]
buffer_load_dwordx4 a[80:83], v3, s[88:91], s101 offen sc1
v_mfma_f32_16x16x32_bf16 v[76:79], v[160:163], a[116:119], v[76:79]
ds_read_b64_tr_b16 v[192:193], v7 offset:16384
ds_read_b64_tr_b16 v[194:195], v7 offset:20480
v_mfma_f32_16x16x32_bf16 v[76:79], v[164:167], a[124:127], v[76:79]
ds_read_b64_tr_b16 v[196:197], v7 offset:24576
v_mfma_f32_16x16x32_bf16 v[60:63], v[164:167], a[120:123], v[60:63]
ds_read_b64_tr_b16 v[198:199], v7 offset:28672
s_waitcnt lgkmcnt(8)
v_mfma_f32_16x16x32_bf16 v[60:63], v[160:163], a[112:115], v[60:63]
buffer_load_dwordx4 a[84:87], v3, s[88:91], s101 offen offset:1024 sc1
v_mfma_f32_16x16x32_bf16 v[64:67], v[168:171], a[112:115], v[64:67]
ds_read_b64_tr_b16 v[200:201], v6 offset:16640
ds_read_b64_tr_b16 v[202:203], v6 offset:20736
v_mfma_f32_16x16x32_bf16 v[64:67], v[172:175], a[120:123], v[64:67]
ds_read_b64_tr_b16 v[204:205], v6 offset:24832
v_mfma_f32_16x16x32_bf16 v[80:83], v[172:175], a[124:127], v[80:83]
ds_read_b64_tr_b16 v[206:207], v6 offset:28928
s_add_u32 s101, s101, 0x2000
v_mfma_f32_16x16x32_bf16 v[80:83], v[168:171], a[116:119], v[80:83]
buffer_load_dwordx4 a[88:91], v3, s[88:91], s101 offen sc1
v_mfma_f32_16x16x32_bf16 v[84:87], v[176:179], a[116:119], v[84:87]
ds_read_b64_tr_b16 v[208:209], v7 offset:16640
ds_read_b64_tr_b16 v[210:211], v7 offset:20736
v_mfma_f32_16x16x32_bf16 v[84:87], v[180:183], a[124:127], v[84:87]
ds_read_b64_tr_b16 v[212:213], v7 offset:24832
s_waitcnt vmcnt(7) lgkmcnt(7)
v_mfma_f32_16x16x32_bf16 v[68:71], v[180:183], a[120:123], v[68:71]
ds_read_b64_tr_b16 v[214:215], v7 offset:28928
s_barrier
v_mfma_f32_16x16x32_bf16 v[68:71], v[176:179], a[112:115], v[68:71]
buffer_load_dwordx4 a[92:95], v3, s[88:91], s101 offen offset:1024 sc1
v_mfma_f32_16x16x32_bf16 v[24:27], v[184:187], a[112:115], v[24:27]
ds_read_b64_tr_b16 v[152:153], v4 offset:512
ds_read_b64_tr_b16 v[154:155], v4 offset:4608
v_mfma_f32_16x16x32_bf16 v[24:27], v[188:191], a[120:123], v[24:27]
ds_read_b64_tr_b16 v[156:157], v4 offset:8704
v_add_u32 v12, 0x20000, v12
v_mfma_f32_16x16x32_bf16 v[40:43], v[188:191], a[124:127], v[40:43]
ds_read_b64_tr_b16 v[158:159], v4 offset:12800
s_add_u32 m0, s16, 0x0
v_mfma_f32_16x16x32_bf16 v[40:43], v[184:187], a[116:119], v[40:43]
buffer_load_dwordx4 v12, s[72:75], 0 offen lds
v_mfma_f32_16x16x32_bf16 v[44:47], v[192:195], a[116:119], v[44:47]
ds_read_b64_tr_b16 v[160:161], v5 offset:512
ds_read_b64_tr_b16 v[162:163], v5 offset:4608
v_mfma_f32_16x16x32_bf16 v[44:47], v[196:199], a[124:127], v[44:47]
ds_read_b64_tr_b16 v[164:165], v5 offset:8704
v_add_u32 v13, 0x20000, v13
v_mfma_f32_16x16x32_bf16 v[28:31], v[196:199], a[120:123], v[28:31]
ds_read_b64_tr_b16 v[166:167], v5 offset:12800
s_waitcnt lgkmcnt(8)
v_mfma_f32_16x16x32_bf16 v[28:31], v[192:195], a[112:115], v[28:31]
buffer_load_dwordx4 v13, s[72:75], 0 offen offset:1024 lds
v_mfma_f32_16x16x32_bf16 v[32:35], v[200:203], a[112:115], v[32:35]
ds_read_b64_tr_b16 v[168:169], v4 offset:768
ds_read_b64_tr_b16 v[170:171], v4 offset:4864
v_mfma_f32_16x16x32_bf16 v[32:35], v[204:207], a[120:123], v[32:35]
ds_read_b64_tr_b16 v[172:173], v4 offset:8960
v_mfma_f32_16x16x32_bf16 v[48:51], v[204:207], a[124:127], v[48:51]
ds_read_b64_tr_b16 v[174:175], v4 offset:13056
v_mfma_f32_16x16x32_bf16 v[48:51], v[200:203], a[116:119], v[48:51]
buffer_load_dwordx4 v12, s[72:75], s12 offen offset:2048 lds
v_mfma_f32_16x16x32_bf16 v[52:55], v[208:211], a[116:119], v[52:55]
ds_read_b64_tr_b16 v[176:177], v5 offset:768
ds_read_b64_tr_b16 v[178:179], v5 offset:4864
v_mfma_f32_16x16x32_bf16 v[52:55], v[212:215], a[124:127], v[52:55]
ds_read_b64_tr_b16 v[180:181], v5 offset:8960
s_waitcnt lgkmcnt(7)
v_mfma_f32_16x16x32_bf16 v[36:39], v[212:215], a[120:123], v[36:39]
ds_read_b64_tr_b16 v[182:183], v5 offset:13056
v_mfma_f32_16x16x32_bf16 v[36:39], v[208:211], a[112:115], v[36:39]
buffer_load_dwordx4 v13, s[72:75], s12 offen offset:3072 lds
v_mfma_f32_16x16x32_bf16 v[56:59], v[152:155], a[64:67], v[56:59]
ds_read_b64_tr_b16 v[184:185], v4 offset:0
ds_read_b64_tr_b16 v[186:187], v4 offset:4096
v_mfma_f32_16x16x32_bf16 v[56:59], v[156:159], a[72:75], v[56:59]
ds_read_b64_tr_b16 v[188:189], v4 offset:8192
v_mfma_f32_16x16x32_bf16 v[72:75], v[156:159], a[76:79], v[72:75]
ds_read_b64_tr_b16 v[190:191], v4 offset:12288
s_add_u32 s101, s101, 0x2000
v_mfma_f32_16x16x32_bf16 v[72:75], v[152:155], a[68:71], v[72:75]
buffer_load_dwordx4 a[96:99], v3, s[88:91], s101 offen sc1
v_mfma_f32_16x16x32_bf16 v[76:79], v[160:163], a[68:71], v[76:79]
ds_read_b64_tr_b16 v[192:193], v5 offset:0
ds_read_b64_tr_b16 v[194:195], v5 offset:4096
v_mfma_f32_16x16x32_bf16 v[76:79], v[164:167], a[76:79], v[76:79]
ds_read_b64_tr_b16 v[196:197], v5 offset:8192
v_mfma_f32_16x16x32_bf16 v[60:63], v[164:167], a[72:75], v[60:63]
ds_read_b64_tr_b16 v[198:199], v5 offset:12288
s_waitcnt lgkmcnt(8)
v_mfma_f32_16x16x32_bf16 v[60:63], v[160:163], a[64:67], v[60:63]
buffer_load_dwordx4 a[100:103], v3, s[88:91], s101 offen offset:1024 sc1
v_mfma_f32_16x16x32_bf16 v[64:67], v[168:171], a[64:67], v[64:67]
ds_read_b64_tr_b16 v[200:201], v4 offset:256
ds_read_b64_tr_b16 v[202:203], v4 offset:4352
v_mfma_f32_16x16x32_bf16 v[64:67], v[172:175], a[72:75], v[64:67]
ds_read_b64_tr_b16 v[204:205], v4 offset:8448
v_mfma_f32_16x16x32_bf16 v[80:83], v[172:175], a[76:79], v[80:83]
ds_read_b64_tr_b16 v[206:207], v4 offset:12544
s_add_u32 s101, s101, 0x2000
v_mfma_f32_16x16x32_bf16 v[80:83], v[168:171], a[68:71], v[80:83]
buffer_load_dwordx4 a[104:107], v3, s[88:91], s101 offen sc1
v_mfma_f32_16x16x32_bf16 v[84:87], v[176:179], a[68:71], v[84:87]
ds_read_b64_tr_b16 v[208:209], v5 offset:256
ds_read_b64_tr_b16 v[210:211], v5 offset:4352
v_mfma_f32_16x16x32_bf16 v[84:87], v[180:183], a[76:79], v[84:87]
ds_read_b64_tr_b16 v[212:213], v5 offset:8448
s_waitcnt vmcnt(7) lgkmcnt(7)
v_mfma_f32_16x16x32_bf16 v[68:71], v[180:183], a[72:75], v[68:71]
ds_read_b64_tr_b16 v[214:215], v5 offset:12544
s_barrier
v_mfma_f32_16x16x32_bf16 v[68:71], v[176:179], a[64:67], v[68:71]
buffer_load_dwordx4 a[108:111], v3, s[88:91], s101 offen offset:1024 sc1
v_mfma_f32_16x16x32_bf16 v[24:27], v[184:187], a[64:67], v[24:27]
ds_read_b64_tr_b16 v[152:153], v4 offset:16896
ds_read_b64_tr_b16 v[154:155], v4 offset:20992
v_mfma_f32_16x16x32_bf16 v[24:27], v[188:191], a[72:75], v[24:27]
ds_read_b64_tr_b16 v[156:157], v4 offset:25088
v_add_u32 v12, 0x20000, v12
v_mfma_f32_16x16x32_bf16 v[40:43], v[188:191], a[76:79], v[40:43]
ds_read_b64_tr_b16 v[158:159], v4 offset:29184
s_add_u32 m0, s16, 0x4000
v_mfma_f32_16x16x32_bf16 v[40:43], v[184:187], a[68:71], v[40:43]
buffer_load_dwordx4 v12, s[72:75], 0 offen lds
v_mfma_f32_16x16x32_bf16 v[44:47], v[192:195], a[68:71], v[44:47]
ds_read_b64_tr_b16 v[160:161], v5 offset:16896
ds_read_b64_tr_b16 v[162:163], v5 offset:20992
v_mfma_f32_16x16x32_bf16 v[44:47], v[196:199], a[76:79], v[44:47]
ds_read_b64_tr_b16 v[164:165], v5 offset:25088
v_add_u32 v13, 0x20000, v13
v_mfma_f32_16x16x32_bf16 v[28:31], v[196:199], a[72:75], v[28:31]
ds_read_b64_tr_b16 v[166:167], v5 offset:29184
s_waitcnt lgkmcnt(8)
v_mfma_f32_16x16x32_bf16 v[28:31], v[192:195], a[64:67], v[28:31]
buffer_load_dwordx4 v13, s[72:75], 0 offen offset:1024 lds
v_mfma_f32_16x16x32_bf16 v[32:35], v[200:203], a[64:67], v[32:35]
ds_read_b64_tr_b16 v[168:169], v4 offset:17152
ds_read_b64_tr_b16 v[170:171], v4 offset:21248
v_mfma_f32_16x16x32_bf16 v[32:35], v[204:207], a[72:75], v[32:35]
ds_read_b64_tr_b16 v[172:173], v4 offset:25344
v_mfma_f32_16x16x32_bf16 v[48:51], v[204:207], a[76:79], v[48:51]
ds_read_b64_tr_b16 v[174:175], v4 offset:29440
v_mfma_f32_16x16x32_bf16 v[48:51], v[200:203], a[68:71], v[48:51]
buffer_load_dwordx4 v12, s[72:75], s12 offen offset:2048 lds
v_mfma_f32_16x16x32_bf16 v[52:55], v[208:211], a[68:71], v[52:55]
ds_read_b64_tr_b16 v[176:177], v5 offset:17152
ds_read_b64_tr_b16 v[178:179], v5 offset:21248
v_mfma_f32_16x16x32_bf16 v[52:55], v[212:215], a[76:79], v[52:55]
ds_read_b64_tr_b16 v[180:181], v5 offset:25344
s_waitcnt lgkmcnt(7)
v_mfma_f32_16x16x32_bf16 v[36:39], v[212:215], a[72:75], v[36:39]
ds_read_b64_tr_b16 v[182:183], v5 offset:29440
v_mfma_f32_16x16x32_bf16 v[36:39], v[208:211], a[64:67], v[36:39]
buffer_load_dwordx4 v13, s[72:75], s12 offen offset:3072 lds
v_mfma_f32_16x16x32_bf16 v[56:59], v[152:155], a[80:83], v[56:59]
ds_read_b64_tr_b16 v[184:185], v4 offset:16384
ds_read_b64_tr_b16 v[186:187], v4 offset:20480
v_mfma_f32_16x16x32_bf16 v[56:59], v[156:159], a[88:91], v[56:59]
ds_read_b64_tr_b16 v[188:189], v4 offset:24576
v_mfma_f32_16x16x32_bf16 v[72:75], v[156:159], a[92:95], v[72:75]
ds_read_b64_tr_b16 v[190:191], v4 offset:28672
s_add_u32 s101, s101, 0x2000
v_mfma_f32_16x16x32_bf16 v[72:75], v[152:155], a[84:87], v[72:75]
buffer_load_dwordx4 a[112:115], v3, s[88:91], s101 offen sc1
v_mfma_f32_16x16x32_bf16 v[76:79], v[160:163], a[84:87], v[76:79]
ds_read_b64_tr_b16 v[192:193], v5 offset:16384
ds_read_b64_tr_b16 v[194:195], v5 offset:20480
v_mfma_f32_16x16x32_bf16 v[76:79], v[164:167], a[92:95], v[76:79]
ds_read_b64_tr_b16 v[196:197], v5 offset:24576
v_mfma_f32_16x16x32_bf16 v[60:63], v[164:167], a[88:91], v[60:63]
ds_read_b64_tr_b16 v[198:199], v5 offset:28672
s_waitcnt lgkmcnt(8)
v_mfma_f32_16x16x32_bf16 v[60:63], v[160:163], a[80:83], v[60:63]
buffer_load_dwordx4 a[116:119], v3, s[88:91], s101 offen offset:1024 sc1
v_mfma_f32_16x16x32_bf16 v[64:67], v[168:171], a[80:83], v[64:67]
ds_read_b64_tr_b16 v[200:201], v4 offset:16640
ds_read_b64_tr_b16 v[202:203], v4 offset:20736
v_mfma_f32_16x16x32_bf16 v[64:67], v[172:175], a[88:91], v[64:67]
ds_read_b64_tr_b16 v[204:205], v4 offset:24832
v_mfma_f32_16x16x32_bf16 v[80:83], v[172:175], a[92:95], v[80:83]
ds_read_b64_tr_b16 v[206:207], v4 offset:28928
s_add_u32 s101, s101, 0x2000
v_mfma_f32_16x16x32_bf16 v[80:83], v[168:171], a[84:87], v[80:83]
buffer_load_dwordx4 a[120:123], v3, s[88:91], s101 offen sc1
v_mfma_f32_16x16x32_bf16 v[84:87], v[176:179], a[84:87], v[84:87]
ds_read_b64_tr_b16 v[208:209], v5 offset:16640
ds_read_b64_tr_b16 v[210:211], v5 offset:20736
v_mfma_f32_16x16x32_bf16 v[84:87], v[180:183], a[92:95], v[84:87]
ds_read_b64_tr_b16 v[212:213], v5 offset:24832
s_waitcnt vmcnt(7) lgkmcnt(7)
v_mfma_f32_16x16x32_bf16 v[68:71], v[180:183], a[88:91], v[68:71]
ds_read_b64_tr_b16 v[214:215], v5 offset:28928
s_barrier
v_mfma_f32_16x16x32_bf16 v[68:71], v[176:179], a[80:83], v[68:71]
buffer_load_dwordx4 a[124:127], v3, s[88:91], s101 offen offset:1024 sc1
L_p4_skip:
v_mfma_f32_16x16x32_bf16 v[24:27], v[184:187], a[80:83], v[24:27]
ds_read_b64_tr_b16 v[152:153], v6 offset:512
ds_read_b64_tr_b16 v[154:155], v6 offset:4608
v_mfma_f32_16x16x32_bf16 v[24:27], v[188:191], a[88:91], v[24:27]
ds_read_b64_tr_b16 v[156:157], v6 offset:8704
v_add_u32 v12, 0x20000, v12
v_mfma_f32_16x16x32_bf16 v[40:43], v[188:191], a[92:95], v[40:43]
ds_read_b64_tr_b16 v[158:159], v6 offset:12800
s_add_u32 m0, s17, 0x10000
v_mfma_f32_16x16x32_bf16 v[40:43], v[184:187], a[84:87], v[40:43]
buffer_load_dwordx4 v12, s[72:75], 0 offen lds
v_mfma_f32_16x16x32_bf16 v[44:47], v[192:195], a[84:87], v[44:47]
ds_read_b64_tr_b16 v[160:161], v7 offset:512
ds_read_b64_tr_b16 v[162:163], v7 offset:4608
v_mfma_f32_16x16x32_bf16 v[44:47], v[196:199], a[92:95], v[44:47]
ds_read_b64_tr_b16 v[164:165], v7 offset:8704
v_add_u32 v13, 0x20000, v13
v_mfma_f32_16x16x32_bf16 v[28:31], v[196:199], a[88:91], v[28:31]
ds_read_b64_tr_b16 v[166:167], v7 offset:12800
s_waitcnt lgkmcnt(8)
v_mfma_f32_16x16x32_bf16 v[28:31], v[192:195], a[80:83], v[28:31]
buffer_load_dwordx4 v13, s[72:75], 0 offen offset:1024 lds
v_mfma_f32_16x16x32_bf16 v[32:35], v[200:203], a[80:83], v[32:35]
ds_read_b64_tr_b16 v[168:169], v6 offset:768
ds_read_b64_tr_b16 v[170:171], v6 offset:4864
v_mfma_f32_16x16x32_bf16 v[32:35], v[204:207], a[88:91], v[32:35]
ds_read_b64_tr_b16 v[172:173], v6 offset:8960
v_mfma_f32_16x16x32_bf16 v[48:51], v[204:207], a[92:95], v[48:51]
ds_read_b64_tr_b16 v[174:175], v6 offset:13056
v_mfma_f32_16x16x32_bf16 v[48:51], v[200:203], a[84:87], v[48:51]
buffer_load_dwordx4 v12, s[72:75], s12 offen offset:2048 lds
v_mfma_f32_16x16x32_bf16 v[52:55], v[208:211], a[84:87], v[52:55]
ds_read_b64_tr_b16 v[176:177], v7 offset:768
ds_read_b64_tr_b16 v[178:179], v7 offset:4864
v_mfma_f32_16x16x32_bf16 v[52:55], v[212:215], a[92:95], v[52:55]
ds_read_b64_tr_b16 v[180:181], v7 offset:8960
s_waitcnt lgkmcnt(7)
v_mfma_f32_16x16x32_bf16 v[36:39], v[212:215], a[88:91], v[36:39]
ds_read_b64_tr_b16 v[182:183], v7 offset:13056
v_mfma_f32_16x16x32_bf16 v[36:39], v[208:211], a[80:83], v[36:39]
buffer_load_dwordx4 v13, s[72:75], s12 offen offset:3072 lds
v_mfma_f32_16x16x32_bf16 v[56:59], v[152:155], a[96:99], v[56:59]
ds_read_b64_tr_b16 v[184:185], v6 offset:0
ds_read_b64_tr_b16 v[186:187], v6 offset:4096
v_mfma_f32_16x16x32_bf16 v[56:59], v[156:159], a[104:107], v[56:59]
ds_read_b64_tr_b16 v[188:189], v6 offset:8192
v_mov_b32 v112, 0
v_mfma_f32_16x16x32_bf16 v[72:75], v[156:159], a[108:111], v[72:75]
ds_read_b64_tr_b16 v[190:191], v6 offset:12288
s_add_u32 s101, s101, 0x2000
v_mfma_f32_16x16x32_bf16 v[72:75], v[152:155], a[100:103], v[72:75]
buffer_load_dwordx4 a[64:67], v3, s[88:91], s101 offen sc1
v_mfma_f32_16x16x32_bf16 v[76:79], v[160:163], a[100:103], v[76:79]
ds_read_b64_tr_b16 v[192:193], v7 offset:0
ds_read_b64_tr_b16 v[194:195], v7 offset:4096
v_mfma_f32_16x16x32_bf16 v[76:79], v[164:167], a[108:111], v[76:79]
ds_read_b64_tr_b16 v[196:197], v7 offset:8192
v_mov_b32 v113, 0
v_mfma_f32_16x16x32_bf16 v[60:63], v[164:167], a[104:107], v[60:63]
ds_read_b64_tr_b16 v[198:199], v7 offset:12288
s_waitcnt lgkmcnt(8)
v_mfma_f32_16x16x32_bf16 v[60:63], v[160:163], a[96:99], v[60:63]
buffer_load_dwordx4 a[68:71], v3, s[88:91], s101 offen offset:1024 sc1
v_mfma_f32_16x16x32_bf16 v[64:67], v[168:171], a[96:99], v[64:67]
ds_read_b64_tr_b16 v[200:201], v6 offset:256
ds_read_b64_tr_b16 v[202:203], v6 offset:4352
v_mfma_f32_16x16x32_bf16 v[64:67], v[172:175], a[104:107], v[64:67]
ds_read_b64_tr_b16 v[204:205], v6 offset:8448
v_mov_b32 v114, 0
v_mfma_f32_16x16x32_bf16 v[80:83], v[172:175], a[108:111], v[80:83]
ds_read_b64_tr_b16 v[206:207], v6 offset:12544
s_add_u32 s101, s101, 0x2000
v_mfma_f32_16x16x32_bf16 v[80:83], v[168:171], a[100:103], v[80:83]
buffer_load_dwordx4 a[72:75], v3, s[88:91], s101 offen sc1
v_mfma_f32_16x16x32_bf16 v[84:87], v[176:179], a[100:103], v[84:87]
ds_read_b64_tr_b16 v[208:209], v7 offset:256
ds_read_b64_tr_b16 v[210:211], v7 offset:4352
v_mfma_f32_16x16x32_bf16 v[84:87], v[180:183], a[108:111], v[84:87]
ds_read_b64_tr_b16 v[212:213], v7 offset:8448
s_waitcnt vmcnt(7) lgkmcnt(7)
v_mfma_f32_16x16x32_bf16 v[68:71], v[180:183], a[104:107], v[68:71]
ds_read_b64_tr_b16 v[214:215], v7 offset:12544
s_barrier
v_mfma_f32_16x16x32_bf16 v[68:71], v[176:179], a[96:99], v[68:71]
buffer_load_dwordx4 a[76:79], v3, s[88:91], s101 offen offset:1024 sc1
v_mov_b32 v115, 0
buffer_load_dword v14, v16, s[88:91], s24 offen sc1
v_mfma_f32_16x16x32_bf16 v[24:27], v[184:187], a[96:99], v[24:27]
ds_read_b64_tr_b16 v[152:153], v6 offset:16896
ds_read_b64_tr_b16 v[154:155], v6 offset:20992
v_mfma_f32_16x16x32_bf16 v[24:27], v[188:191], a[104:107], v[24:27]
ds_read_b64_tr_b16 v[156:157], v6 offset:25088
v_add_u32 v12, 0x20000, v12
v_mfma_f32_16x16x32_bf16 v[40:43], v[188:191], a[108:111], v[40:43]
ds_read_b64_tr_b16 v[158:159], v6 offset:29184
s_add_u32 m0, s17, 0x14000
v_mfma_f32_16x16x32_bf16 v[40:43], v[184:187], a[100:103], v[40:43]
buffer_load_dwordx4 v12, s[72:75], 0 offen lds
v_mfma_f32_16x16x32_bf16 v[44:47], v[192:195], a[100:103], v[44:47]
ds_read_b64_tr_b16 v[160:161], v7 offset:16896
ds_read_b64_tr_b16 v[162:163], v7 offset:20992
v_mfma_f32_16x16x32_bf16 v[44:47], v[196:199], a[108:111], v[44:47]
ds_read_b64_tr_b16 v[164:165], v7 offset:25088
v_add_u32 v13, 0x20000, v13
v_mfma_f32_16x16x32_bf16 v[28:31], v[196:199], a[104:107], v[28:31]
ds_read_b64_tr_b16 v[166:167], v7 offset:29184
s_waitcnt lgkmcnt(8)
v_mfma_f32_16x16x32_bf16 v[28:31], v[192:195], a[96:99], v[28:31]
buffer_load_dwordx4 v13, s[72:75], 0 offen offset:1024 lds
v_mfma_f32_16x16x32_bf16 v[32:35], v[200:203], a[96:99], v[32:35]
ds_read_b64_tr_b16 v[168:169], v6 offset:17152
ds_read_b64_tr_b16 v[170:171], v6 offset:21248
v_mfma_f32_16x16x32_bf16 v[32:35], v[204:207], a[104:107], v[32:35]
ds_read_b64_tr_b16 v[172:173], v6 offset:25344
v_mfma_f32_16x16x32_bf16 v[48:51], v[204:207], a[108:111], v[48:51]
ds_read_b64_tr_b16 v[174:175], v6 offset:29440
v_mfma_f32_16x16x32_bf16 v[48:51], v[200:203], a[100:103], v[48:51]
buffer_load_dwordx4 v12, s[72:75], s12 offen offset:2048 lds
v_mfma_f32_16x16x32_bf16 v[52:55], v[208:211], a[100:103], v[52:55]
ds_read_b64_tr_b16 v[176:177], v7 offset:17152
ds_read_b64_tr_b16 v[178:179], v7 offset:21248
v_mfma_f32_16x16x32_bf16 v[52:55], v[212:215], a[108:111], v[52:55]
ds_read_b64_tr_b16 v[180:181], v7 offset:25344
s_waitcnt lgkmcnt(7)
v_mfma_f32_16x16x32_bf16 v[36:39], v[212:215], a[104:107], v[36:39]
ds_read_b64_tr_b16 v[182:183], v7 offset:29440
v_mfma_f32_16x16x32_bf16 v[36:39], v[208:211], a[96:99], v[36:39]
buffer_load_dwordx4 v13, s[72:75], s12 offen offset:3072 lds
v_mfma_f32_16x16x32_bf16 v[56:59], v[152:155], a[112:115], v[56:59]
ds_read_b64_tr_b16 v[184:185], v6 offset:16384
ds_read_b64_tr_b16 v[186:187], v6 offset:20480
v_mfma_f32_16x16x32_bf16 v[56:59], v[156:159], a[120:123], v[56:59]
ds_read_b64_tr_b16 v[188:189], v6 offset:24576
v_mov_b32 v116, 0
v_mfma_f32_16x16x32_bf16 v[72:75], v[156:159], a[124:127], v[72:75]
ds_read_b64_tr_b16 v[190:191], v6 offset:28672
s_add_u32 s101, s101, 0x2000
v_mfma_f32_16x16x32_bf16 v[72:75], v[152:155], a[116:119], v[72:75]
buffer_load_dwordx4 a[80:83], v3, s[88:91], s101 offen sc1
v_mfma_f32_16x16x32_bf16 v[76:79], v[160:163], a[116:119], v[76:79]
ds_read_b64_tr_b16 v[192:193], v7 offset:16384
ds_read_b64_tr_b16 v[194:195], v7 offset:20480
v_mfma_f32_16x16x32_bf16 v[76:79], v[164:167], a[124:127], v[76:79]
ds_read_b64_tr_b16 v[196:197], v7 offset:24576
v_mov_b32 v117, 0
v_mfma_f32_16x16x32_bf16 v[60:63], v[164:167], a[120:123], v[60:63]
ds_read_b64_tr_b16 v[198:199], v7 offset:28672
s_waitcnt lgkmcnt(8)
v_mfma_f32_16x16x32_bf16 v[60:63], v[160:163], a[112:115], v[60:63]
buffer_load_dwordx4 a[84:87], v3, s[88:91], s101 offen offset:1024 sc1
v_mfma_f32_16x16x32_bf16 v[64:67], v[168:171], a[112:115], v[64:67]
ds_read_b64_tr_b16 v[200:201], v6 offset:16640
ds_read_b64_tr_b16 v[202:203], v6 offset:20736
v_mfma_f32_16x16x32_bf16 v[64:67], v[172:175], a[120:123], v[64:67]
ds_read_b64_tr_b16 v[204:205], v6 offset:24832
v_mov_b32 v118, 0
v_mfma_f32_16x16x32_bf16 v[80:83], v[172:175], a[124:127], v[80:83]
ds_read_b64_tr_b16 v[206:207], v6 offset:28928
s_add_u32 s101, s101, 0x2000
v_mfma_f32_16x16x32_bf16 v[80:83], v[168:171], a[116:119], v[80:83]
buffer_load_dwordx4 a[88:91], v3, s[88:91], s101 offen sc1
v_mfma_f32_16x16x32_bf16 v[84:87], v[176:179], a[116:119], v[84:87]
ds_read_b64_tr_b16 v[208:209], v7 offset:16640
ds_read_b64_tr_b16 v[210:211], v7 offset:20736
v_mfma_f32_16x16x32_bf16 v[84:87], v[180:183], a[124:127], v[84:87]
ds_read_b64_tr_b16 v[212:213], v7 offset:24832
s_waitcnt vmcnt(7) lgkmcnt(7)
v_mfma_f32_16x16x32_bf16 v[68:71], v[180:183], a[120:123], v[68:71]
ds_read_b64_tr_b16 v[214:215], v7 offset:28928
s_barrier
v_mfma_f32_16x16x32_bf16 v[68:71], v[176:179], a[112:115], v[68:71]
buffer_load_dwordx4 a[92:95], v3, s[88:91], s101 offen offset:1024 sc1
v_mov_b32 v119, 0
s_mov_b32 s92, 200000
L_spin_c:
v_cmp_ne_u32 vcc, 1, v14
s_nop 4
s_cbranch_vccz L_spun_c
s_sub_u32 s92, s92, 1
s_cbranch_scc1 L_spun_c
s_sleep 6
buffer_load_dword v14, v16, s[88:91], s24 offen sc1
s_waitcnt vmcnt(0)
s_branch L_spin_c
L_spun_c:
v_mfma_f32_16x16x32_bf16 v[24:27], v[184:187], a[112:115], v[24:27]
ds_read_b64_tr_b16 v[152:153], v4 offset:512
ds_read_b64_tr_b16 v[154:155], v4 offset:4608
v_mfma_f32_16x16x32_bf16 v[24:27], v[188:191], a[120:123], v[24:27]
ds_read_b64_tr_b16 v[156:157], v4 offset:8704
v_add_u32 v12, s25, v12
v_mfma_f32_16x16x32_bf16 v[40:43], v[188:191], a[124:127], v[40:43]
ds_read_b64_tr_b16 v[158:159], v4 offset:12800
s_add_u32 m0, s16, 0x0
v_mfma_f32_16x16x32_bf16 v[40:43], v[184:187], a[116:119], v[40:43]
buffer_load_dwordx4 v12, s[64:67], s61 offen lds
v_mfma_f32_16x16x32_bf16 v[44:47], v[192:195], a[116:119], v[44:47]
ds_read_b64_tr_b16 v[160:161], v5 offset:512
ds_read_b64_tr_b16 v[162:163], v5 offset:4608
v_mfma_f32_16x16x32_bf16 v[44:47], v[196:199], a[124:127], v[44:47]
ds_read_b64_tr_b16 v[164:165], v5 offset:8704
v_add_u32 v13, s25, v13
v_mfma_f32_16x16x32_bf16 v[28:31], v[196:199], a[120:123], v[28:31]
ds_read_b64_tr_b16 v[166:167], v5 offset:12800
s_waitcnt lgkmcnt(8)
v_mfma_f32_16x16x32_bf16 v[28:31], v[192:195], a[112:115], v[28:31]
buffer_load_dwordx4 v13, s[64:67], s61 offen offset:1024 lds
v_mfma_f32_16x16x32_bf16 v[32:35], v[200:203], a[112:115], v[32:35]
ds_read_b64_tr_b16 v[168:169], v4 offset:768
ds_read_b64_tr_b16 v[170:171], v4 offset:4864
v_mfma_f32_16x16x32_bf16 v[32:35], v[204:207], a[120:123], v[32:35]
ds_read_b64_tr_b16 v[172:173], v4 offset:8960
s_add_u32 s63, s101, s26
v_mfma_f32_16x16x32_bf16 v[48:51], v[204:207], a[124:127], v[48:51]
ds_read_b64_tr_b16 v[174:175], v4 offset:13056
s_add_u32 s101, s63, s60
v_mfma_f32_16x16x32_bf16 v[48:51], v[200:203], a[116:119], v[48:51]
buffer_load_dwordx4 v12, s[64:67], s62 offen offset:2048 lds
v_mfma_f32_16x16x32_bf16 v[52:55], v[208:211], a[116:119], v[52:55]
ds_read_b64_tr_b16 v[176:177], v5 offset:768
ds_read_b64_tr_b16 v[178:179], v5 offset:4864
v_mfma_f32_16x16x32_bf16 v[52:55], v[212:215], a[124:127], v[52:55]
ds_read_b64_tr_b16 v[180:181], v5 offset:8960
s_waitcnt lgkmcnt(7)
v_mfma_f32_16x16x32_bf16 v[36:39], v[212:215], a[120:123], v[36:39]
ds_read_b64_tr_b16 v[182:183], v5 offset:13056
v_mfma_f32_16x16x32_bf16 v[36:39], v[208:211], a[112:115], v[36:39]
buffer_load_dwordx4 v13, s[64:67], s62 offen offset:3072 lds
v_mfma_f32_16x16x32_bf16 v[56:59], v[152:155], a[64:67], v[56:59]
ds_read_b64_tr_b16 v[184:185], v4 offset:0
ds_read_b64_tr_b16 v[186:187], v4 offset:4096
v_mfma_f32_16x16x32_bf16 v[56:59], v[156:159], a[72:75], v[56:59]
ds_read_b64_tr_b16 v[188:189], v4 offset:8192
s_add_u32 s60, s60, s57
v_mfma_f32_16x16x32_bf16 v[72:75], v[156:159], a[76:79], v[72:75]
ds_read_b64_tr_b16 v[190:191], v4 offset:12288
s_and_b32 s60, s60, 0x7c000
v_mfma_f32_16x16x32_bf16 v[72:75], v[152:155], a[68:71], v[72:75]
buffer_load_dwordx4 a[96:99], v3, s[88:91], s101 offen sc1
v_mfma_f32_16x16x32_bf16 v[76:79], v[160:163], a[68:71], v[76:79]
ds_read_b64_tr_b16 v[192:193], v5 offset:0
ds_read_b64_tr_b16 v[194:195], v5 offset:4096
v_mfma_f32_16x16x32_bf16 v[76:79], v[164:167], a[76:79], v[76:79]
ds_read_b64_tr_b16 v[196:197], v5 offset:8192
s_lshl_b32 s61, s60, 3
v_mfma_f32_16x16x32_bf16 v[60:63], v[164:167], a[72:75], v[60:63]
ds_read_b64_tr_b16 v[198:199], v5 offset:12288
s_waitcnt lgkmcnt(8)
v_mfma_f32_16x16x32_bf16 v[60:63], v[160:163], a[64:67], v[60:63]
buffer_load_dwordx4 a[100:103], v3, s[88:91], s101 offen offset:1024 sc1
v_mfma_f32_16x16x32_bf16 v[64:67], v[168:171], a[64:67], v[64:67]
ds_read_b64_tr_b16 v[200:201], v4 offset:256
ds_read_b64_tr_b16 v[202:203], v4 offset:4352
v_mfma_f32_16x16x32_bf16 v[64:67], v[172:175], a[72:75], v[64:67]
ds_read_b64_tr_b16 v[204:205], v4 offset:8448
s_add_u32 s62, s61, s12
v_mfma_f32_16x16x32_bf16 v[80:83], v[172:175], a[76:79], v[80:83]
ds_read_b64_tr_b16 v[206:207], v4 offset:12544
s_add_u32 s101, s101, 0x2000
v_mfma_f32_16x16x32_bf16 v[80:83], v[168:171], a[68:71], v[80:83]
buffer_load_dwordx4 a[104:107], v3, s[88:91], s101 offen sc1
v_mfma_f32_16x16x32_bf16 v[84:87], v[176:179], a[68:71], v[84:87]
ds_read_b64_tr_b16 v[208:209], v5 offset:256
ds_read_b64_tr_b16 v[210:211], v5 offset:4352
v_mfma_f32_16x16x32_bf16 v[84:87], v[180:183], a[76:79], v[84:87]
ds_read_b64_tr_b16 v[212:213], v5 offset:8448
s_waitcnt vmcnt(7) lgkmcnt(7)
v_mfma_f32_16x16x32_bf16 v[68:71], v[180:183], a[72:75], v[68:71]
ds_read_b64_tr_b16 v[214:215], v5 offset:12544
s_barrier
v_mfma_f32_16x16x32_bf16 v[68:71], v[176:179], a[64:67], v[68:71]
buffer_load_dwordx4 a[108:111], v3, s[88:91], s101 offen offset:1024 sc1
v_mfma_f32_16x16x32_bf16 v[24:27], v[184:187], a[64:67], v[24:27]
ds_read_b64_tr_b16 v[152:153], v4 offset:16896
ds_read_b64_tr_b16 v[154:155], v4 offset:20992
v_mfma_f32_16x16x32_bf16 v[24:27], v[188:191], a[72:75], v[24:27]
ds_read_b64_tr_b16 v[156:157], v4 offset:25088
s_add_u32 s101, s63, s60
v_mfma_f32_16x16x32_bf16 v[40:43], v[188:191], a[76:79], v[40:43]
ds_read_b64_tr_b16 v[158:159], v4 offset:29184
s_add_u32 m0, s16, 0x4000
v_mfma_f32_16x16x32_bf16 v[40:43], v[184:187], a[68:71], v[40:43]
buffer_load_dwordx4 v12, s[64:67], s61 offen lds
v_mfma_f32_16x16x32_bf16 v[44:47], v[192:195], a[68:71], v[44:47]
ds_read_b64_tr_b16 v[160:161], v5 offset:16896
ds_read_b64_tr_b16 v[162:163], v5 offset:20992
v_mfma_f32_16x16x32_bf16 v[44:47], v[196:199], a[76:79], v[44:47]
ds_read_b64_tr_b16 v[164:165], v5 offset:25088
v_mfma_f32_16x16x32_bf16 v[28:31], v[196:199], a[72:75], v[28:31]
ds_read_b64_tr_b16 v[166:167], v5 offset:29184
s_waitcnt lgkmcnt(8)
v_mfma_f32_16x16x32_bf16 v[28:31], v[192:195], a[64:67], v[28:31]
buffer_load_dwordx4 v13, s[64:67], s61 offen offset:1024 lds
v_mfma_f32_16x16x32_bf16 v[32:35], v[200:203], a[64:67], v[32:35]
ds_read_b64_tr_b16 v[168:169], v4 offset:17152
ds_read_b64_tr_b16 v[170:171], v4 offset:21248
v_mfma_f32_16x16x32_bf16 v[32:35], v[204:207], a[72:75], v[32:35]
ds_read_b64_tr_b16 v[172:173], v4 offset:25344
v_mfma_f32_16x16x32_bf16 v[48:51], v[204:207], a[76:79], v[48:51]
ds_read_b64_tr_b16 v[174:175], v4 offset:29440
v_mfma_f32_16x16x32_bf16 v[48:51], v[200:203], a[68:71], v[48:51]
buffer_load_dwordx4 v12, s[64:67], s62 offen offset:2048 lds
v_mfma_f32_16x16x32_bf16 v[52:55], v[208:211], a[68:71], v[52:55]
ds_read_b64_tr_b16 v[176:177], v5 offset:17152
ds_read_b64_tr_b16 v[178:179], v5 offset:21248
v_mfma_f32_16x16x32_bf16 v[52:55], v[212:215], a[76:79], v[52:55]
ds_read_b64_tr_b16 v[180:181], v5 offset:25344
s_waitcnt lgkmcnt(7)
v_mfma_f32_16x16x32_bf16 v[36:39], v[212:215], a[72:75], v[36:39]
ds_read_b64_tr_b16 v[182:183], v5 offset:29440
v_mfma_f32_16x16x32_bf16 v[36:39], v[208:211], a[64:67], v[36:39]
buffer_load_dwordx4 v13, s[64:67], s62 offen offset:3072 lds
v_mfma_f32_16x16x32_bf16 v[56:59], v[152:155], a[80:83], v[56:59]
ds_read_b64_tr_b16 v[184:185], v4 offset:16384
ds_read_b64_tr_b16 v[186:187], v4 offset:20480
v_mfma_f32_16x16x32_bf16 v[56:59], v[156:159], a[88:91], v[56:59]
ds_read_b64_tr_b16 v[188:189], v4 offset:24576
s_add_u32 s60, s60, s58
v_mfma_f32_16x16x32_bf16 v[72:75], v[156:159], a[92:95], v[72:75]
ds_read_b64_tr_b16 v[190:191], v4 offset:28672
s_and_b32 s60, s60, 0x7c000
v_mfma_f32_16x16x32_bf16 v[72:75], v[152:155], a[84:87], v[72:75]
buffer_load_dwordx4 a[112:115], v3, s[88:91], s101 offen sc1
v_mfma_f32_16x16x32_bf16 v[76:79], v[160:163], a[84:87], v[76:79]
ds_read_b64_tr_b16 v[192:193], v5 offset:16384
ds_read_b64_tr_b16 v[194:195], v5 offset:20480
v_mfma_f32_16x16x32_bf16 v[76:79], v[164:167], a[92:95], v[76:79]
ds_read_b64_tr_b16 v[196:197], v5 offset:24576
s_lshl_b32 s61, s60, 3
v_mfma_f32_16x16x32_bf16 v[60:63], v[164:167], a[88:91], v[60:63]
ds_read_b64_tr_b16 v[198:199], v5 offset:28672
s_waitcnt lgkmcnt(8)
v_mfma_f32_16x16x32_bf16 v[60:63], v[160:163], a[80:83], v[60:63]
buffer_load_dwordx4 a[116:119], v3, s[88:91], s101 offen offset:1024 sc1
v_mfma_f32_16x16x32_bf16 v[64:67], v[168:171], a[80:83], v[64:67]
ds_read_b64_tr_b16 v[200:201], v4 offset:16640
ds_read_b64_tr_b16 v[202:203], v4 offset:20736
v_mfma_f32_16x16x32_bf16 v[64:67], v[172:175], a[88:91], v[64:67]
ds_read_b64_tr_b16 v[204:205], v4 offset:24832
s_add_u32 s62, s61, s12
v_mfma_f32_16x16x32_bf16 v[80:83], v[172:175], a[92:95], v[80:83]
ds_read_b64_tr_b16 v[206:207], v4 offset:28928
s_add_u32 s101, s101, 0x2000
v_mfma_f32_16x16x32_bf16 v[80:83], v[168:171], a[84:87], v[80:83]
buffer_load_dwordx4 a[120:123], v3, s[88:91], s101 offen sc1
v_mfma_f32_16x16x32_bf16 v[84:87], v[176:179], a[84:87], v[84:87]
ds_read_b64_tr_b16 v[208:209], v5 offset:16640
ds_read_b64_tr_b16 v[210:211], v5 offset:20736
v_mfma_f32_16x16x32_bf16 v[84:87], v[180:183], a[92:95], v[84:87]
ds_read_b64_tr_b16 v[212:213], v5 offset:24832
s_waitcnt vmcnt(7) lgkmcnt(7)
v_mfma_f32_16x16x32_bf16 v[68:71], v[180:183], a[88:91], v[68:71]
ds_read_b64_tr_b16 v[214:215], v5 offset:28928
s_barrier
v_mfma_f32_16x16x32_bf16 v[68:71], v[176:179], a[80:83], v[68:71]
buffer_load_dwordx4 a[124:127], v3, s[88:91], s101 offen offset:1024 sc1
v_mfma_f32_16x16x32_bf16 v[24:27], v[184:187], a[80:83], v[24:27]
ds_read_b64_tr_b16 v[152:153], v6 offset:512
ds_read_b64_tr_b16 v[154:155], v6 offset:4608
v_mfma_f32_16x16x32_bf16 v[24:27], v[188:191], a[88:91], v[24:27]
ds_read_b64_tr_b16 v[156:157], v6 offset:8704
s_add_u32 s101, s63, s60
v_mfma_f32_16x16x32_bf16 v[40:43], v[188:191], a[92:95], v[40:43]
ds_read_b64_tr_b16 v[158:159], v6 offset:12800
s_add_u32 m0, s17, 0x10000
v_mfma_f32_16x16x32_bf16 v[40:43], v[184:187], a[84:87], v[40:43]
buffer_load_dwordx4 v12, s[64:67], s61 offen lds
v_mfma_f32_16x16x32_bf16 v[44:47], v[192:195], a[84:87], v[44:47]
ds_read_b64_tr_b16 v[160:161], v7 offset:512
ds_read_b64_tr_b16 v[162:163], v7 offset:4608
v_mfma_f32_16x16x32_bf16 v[44:47], v[196:199], a[92:95], v[44:47]
ds_read_b64_tr_b16 v[164:165], v7 offset:8704
v_mfma_f32_16x16x32_bf16 v[28:31], v[196:199], a[88:91], v[28:31]
ds_read_b64_tr_b16 v[166:167], v7 offset:12800
s_waitcnt lgkmcnt(8)
v_mfma_f32_16x16x32_bf16 v[28:31], v[192:195], a[80:83], v[28:31]
buffer_load_dwordx4 v13, s[64:67], s61 offen offset:1024 lds
v_mfma_f32_16x16x32_bf16 v[32:35], v[200:203], a[80:83], v[32:35]
ds_read_b64_tr_b16 v[168:169], v6 offset:768
ds_read_b64_tr_b16 v[170:171], v6 offset:4864
v_mfma_f32_16x16x32_bf16 v[32:35], v[204:207], a[88:91], v[32:35]
ds_read_b64_tr_b16 v[172:173], v6 offset:8960
v_mfma_f32_16x16x32_bf16 v[48:51], v[204:207], a[92:95], v[48:51]
ds_read_b64_tr_b16 v[174:175], v6 offset:13056
v_mfma_f32_16x16x32_bf16 v[48:51], v[200:203], a[84:87], v[48:51]
buffer_load_dwordx4 v12, s[64:67], s62 offen offset:2048 lds
v_mfma_f32_16x16x32_bf16 v[52:55], v[208:211], a[84:87], v[52:55]
ds_read_b64_tr_b16 v[176:177], v7 offset:768
ds_read_b64_tr_b16 v[178:179], v7 offset:4864
v_mfma_f32_16x16x32_bf16 v[52:55], v[212:215], a[92:95], v[52:55]
ds_read_b64_tr_b16 v[180:181], v7 offset:8960
s_waitcnt lgkmcnt(7)
v_mfma_f32_16x16x32_bf16 v[36:39], v[212:215], a[88:91], v[36:39]
ds_read_b64_tr_b16 v[182:183], v7 offset:13056
v_mfma_f32_16x16x32_bf16 v[36:39], v[208:211], a[80:83], v[36:39]
buffer_load_dwordx4 v13, s[64:67], s62 offen offset:3072 lds
v_mfma_f32_16x16x32_bf16 v[120:123], v[152:155], a[96:99], 0
ds_read_b64_tr_b16 v[184:185], v6 offset:0
ds_read_b64_tr_b16 v[186:187], v6 offset:4096
v_mfma_f32_16x16x32_bf16 v[120:123], v[156:159], a[104:107], v[120:123]
ds_read_b64_tr_b16 v[188:189], v6 offset:8192
s_add_u32 s60, s60, s59
v_mfma_f32_16x16x32_bf16 v[136:139], v[156:159], a[108:111], 0
ds_read_b64_tr_b16 v[190:191], v6 offset:12288
s_and_b32 s60, s60, 0x7c000
v_mfma_f32_16x16x32_bf16 v[136:139], v[152:155], a[100:103], v[136:139]
buffer_load_dwordx4 a[64:67], v3, s[88:91], s101 offen sc1
v_mfma_f32_16x16x32_bf16 v[140:143], v[160:163], a[100:103], 0
ds_read_b64_tr_b16 v[192:193], v7 offset:0
ds_read_b64_tr_b16 v[194:195], v7 offset:4096
v_mfma_f32_16x16x32_bf16 v[140:143], v[164:167], a[108:111], v[140:143]
ds_read_b64_tr_b16 v[196:197], v7 offset:8192
s_lshl_b32 s61, s60, 3
v_mfma_f32_16x16x32_bf16 v[124:127], v[164:167], a[104:107], 0
ds_read_b64_tr_b16 v[198:199], v7 offset:12288
s_waitcnt lgkmcnt(8)
v_mfma_f32_16x16x32_bf16 v[124:127], v[160:163], a[96:99], v[124:127]
buffer_load_dwordx4 a[68:71], v3, s[88:91], s101 offen offset:1024 sc1
v_mfma_f32_16x16x32_bf16 v[128:131], v[168:171], a[96:99], 0
ds_read_b64_tr_b16 v[200:201], v6 offset:256
ds_read_b64_tr_b16 v[202:203], v6 offset:4352
v_mfma_f32_16x16x32_bf16 v[128:131], v[172:175], a[104:107], v[128:131]
ds_read_b64_tr_b16 v[204:205], v6 offset:8448
s_add_u32 s62, s61, s12
v_mfma_f32_16x16x32_bf16 v[144:147], v[172:175], a[108:111], 0
ds_read_b64_tr_b16 v[206:207], v6 offset:12544
s_add_u32 s101, s101, 0x2000
v_mfma_f32_16x16x32_bf16 v[144:147], v[168:171], a[100:103], v[144:147]
buffer_load_dwordx4 a[72:75], v3, s[88:91], s101 offen sc1
v_mfma_f32_16x16x32_bf16 v[148:151], v[176:179], a[100:103], 0
ds_read_b64_tr_b16 v[208:209], v7 offset:256
ds_read_b64_tr_b16 v[210:211], v7 offset:4352
v_mfma_f32_16x16x32_bf16 v[148:151], v[180:183], a[108:111], v[148:151]
ds_read_b64_tr_b16 v[212:213], v7 offset:8448
s_waitcnt vmcnt(7) lgkmcnt(7)
v_mfma_f32_16x16x32_bf16 v[132:135], v[180:183], a[104:107], 0
ds_read_b64_tr_b16 v[214:215], v7 offset:12544
s_barrier
v_mfma_f32_16x16x32_bf16 v[132:135], v[176:179], a[96:99], v[132:135]
buffer_load_dwordx4 a[76:79], v3, s[88:91], s101 offen offset:1024 sc1
s_mov_b32 s15, 7
L_p4_loop:
v_mfma_f32_16x16x32_bf16 v[88:91], v[184:187], a[96:99], v[88:91]
ds_read_b64_tr_b16 v[152:153], v6 offset:16896
ds_read_b64_tr_b16 v[154:155], v6 offset:20992
v_mfma_f32_16x16x32_bf16 v[88:91], v[188:191], a[104:107], v[88:91]
ds_read_b64_tr_b16 v[156:157], v6 offset:25088
s_add_u32 s101, s63, s60
v_mfma_f32_16x16x32_bf16 v[104:107], v[188:191], a[108:111], v[104:107]
ds_read_b64_tr_b16 v[158:159], v6 offset:29184
s_add_u32 m0, s17, 0x14000
v_mfma_f32_16x16x32_bf16 v[104:107], v[184:187], a[100:103], v[104:107]
buffer_load_dwordx4 v12, s[64:67], s61 offen lds
v_mfma_f32_16x16x32_bf16 v[108:111], v[192:195], a[100:103], v[108:111]
ds_read_b64_tr_b16 v[160:161], v7 offset:16896
ds_read_b64_tr_b16 v[162:163], v7 offset:20992
v_mfma_f32_16x16x32_bf16 v[108:111], v[196:199], a[108:111], v[108:111]
ds_read_b64_tr_b16 v[164:165], v7 offset:25088
v_mfma_f32_16x16x32_bf16 v[92:95], v[196:199], a[104:107], v[92:95]
ds_read_b64_tr_b16 v[166:167], v7 offset:29184
s_waitcnt lgkmcnt(8)
v_mfma_f32_16x16x32_bf16 v[92:95], v[192:195], a[96:99], v[92:95]
buffer_load_dwordx4 v13, s[64:67], s61 offen offset:1024 lds
v_mfma_f32_16x16x32_bf16 v[96:99], v[200:203], a[96:99], v[96:99]
ds_read_b64_tr_b16 v[168:169], v6 offset:17152
ds_read_b64_tr_b16 v[170:171], v6 offset:21248
v_mfma_f32_16x16x32_bf16 v[96:99], v[204:207], a[104:107], v[96:99]
ds_read_b64_tr_b16 v[172:173], v6 offset:25344
v_mfma_f32_16x16x32_bf16 v[112:115], v[204:207], a[108:111], v[112:115]
ds_read_b64_tr_b16 v[174:175], v6 offset:29440
v_mfma_f32_16x16x32_bf16 v[112:115], v[200:203], a[100:103], v[112:115]
buffer_load_dwordx4 v12, s[64:67], s62 offen offset:2048 lds
v_mfma_f32_16x16x32_bf16 v[116:119], v[208:211], a[100:103], v[116:119]
ds_read_b64_tr_b16 v[176:177], v7 offset:17152
ds_read_b64_tr_b16 v[178:179], v7 offset:21248
v_mfma_f32_16x16x32_bf16 v[116:119], v[212:215], a[108:111], v[116:119]
ds_read_b64_tr_b16 v[180:181], v7 offset:25344
s_waitcnt lgkmcnt(7)
v_mfma_f32_16x16x32_bf16 v[100:103], v[212:215], a[104:107], v[100:103]
ds_read_b64_tr_b16 v[182:183], v7 offset:29440
v_mfma_f32_16x16x32_bf16 v[100:103], v[208:211], a[96:99], v[100:103]
buffer_load_dwordx4 v13, s[64:67], s62 offen offset:3072 lds
v_mfma_f32_16x16x32_bf16 v[120:123], v[152:155], a[112:115], v[120:123]
ds_read_b64_tr_b16 v[184:185], v6 offset:16384
ds_read_b64_tr_b16 v[186:187], v6 offset:20480
v_mfma_f32_16x16x32_bf16 v[120:123], v[156:159], a[120:123], v[120:123]
ds_read_b64_tr_b16 v[188:189], v6 offset:24576
s_add_u32 s60, s60, s56
v_mfma_f32_16x16x32_bf16 v[136:139], v[156:159], a[124:127], v[136:139]
ds_read_b64_tr_b16 v[190:191], v6 offset:28672
s_and_b32 s60, s60, 0x7c000
v_mfma_f32_16x16x32_bf16 v[136:139], v[152:155], a[116:119], v[136:139]
buffer_load_dwordx4 a[80:83], v3, s[88:91], s101 offen sc1
v_mfma_f32_16x16x32_bf16 v[140:143], v[160:163], a[116:119], v[140:143]
ds_read_b64_tr_b16 v[192:193], v7 offset:16384
ds_read_b64_tr_b16 v[194:195], v7 offset:20480
v_mfma_f32_16x16x32_bf16 v[140:143], v[164:167], a[124:127], v[140:143]
ds_read_b64_tr_b16 v[196:197], v7 offset:24576
s_lshl_b32 s61, s60, 3
v_mfma_f32_16x16x32_bf16 v[124:127], v[164:167], a[120:123], v[124:127]
ds_read_b64_tr_b16 v[198:199], v7 offset:28672
s_waitcnt lgkmcnt(8)
v_mfma_f32_16x16x32_bf16 v[124:127], v[160:163], a[112:115], v[124:127]
buffer_load_dwordx4 a[84:87], v3, s[88:91], s101 offen offset:1024 sc1
v_mfma_f32_16x16x32_bf16 v[128:131], v[168:171], a[112:115], v[128:131]
ds_read_b64_tr_b16 v[200:201], v6 offset:16640
ds_read_b64_tr_b16 v[202:203], v6 offset:20736
v_mfma_f32_16x16x32_bf16 v[128:131], v[172:175], a[120:123], v[128:131]
ds_read_b64_tr_b16 v[204:205], v6 offset:24832
s_add_u32 s62, s61, s12
v_mfma_f32_16x16x32_bf16 v[144:147], v[172:175], a[124:127], v[144:147]
ds_read_b64_tr_b16 v[206:207], v6 offset:28928
s_add_u32 s101, s101, 0x2000
v_mfma_f32_16x16x32_bf16 v[144:147], v[168:171], a[116:119], v[144:147]
buffer_load_dwordx4 a[88:91], v3, s[88:91], s101 offen sc1
v_mfma_f32_16x16x32_bf16 v[148:151], v[176:179], a[116:119], v[148:151]
ds_read_b64_tr_b16 v[208:209], v7 offset:16640
ds_read_b64_tr_b16 v[210:211], v7 offset:20736
v_mfma_f32_16x16x32_bf16 v[148:151], v[180:183], a[124:127], v[148:151]
ds_read_b64_tr_b16 v[212:213], v7 offset:24832
s_waitcnt vmcnt(7) lgkmcnt(7)
v_mfma_f32_16x16x32_bf16 v[132:135], v[180:183], a[120:123], v[132:135]
ds_read_b64_tr_b16 v[214:215], v7 offset:28928
s_barrier
v_mfma_f32_16x16x32_bf16 v[132:135], v[176:179], a[112:115], v[132:135]
buffer_load_dwordx4 a[92:95], v3, s[88:91], s101 offen offset:1024 sc1
v_mfma_f32_16x16x32_bf16 v[88:91], v[184:187], a[112:115], v[88:91]
ds_read_b64_tr_b16 v[152:153], v4 offset:512
ds_read_b64_tr_b16 v[154:155], v4 offset:4608
v_mfma_f32_16x16x32_bf16 v[88:91], v[188:191], a[120:123], v[88:91]
ds_read_b64_tr_b16 v[156:157], v4 offset:8704
s_add_u32 s101, s63, s60
v_mfma_f32_16x16x32_bf16 v[104:107], v[188:191], a[124:127], v[104:107]
ds_read_b64_tr_b16 v[158:159], v4 offset:12800
s_add_u32 m0, s16, 0x0
v_mfma_f32_16x16x32_bf16 v[104:107], v[184:187], a[116:119], v[104:107]
buffer_load_dwordx4 v12, s[64:67], s61 offen lds
v_mfma_f32_16x16x32_bf16 v[108:111], v[192:195], a[116:119], v[108:111]
ds_read_b64_tr_b16 v[160:161], v5 offset:512
ds_read_b64_tr_b16 v[162:163], v5 offset:4608
v_mfma_f32_16x16x32_bf16 v[108:111], v[196:199], a[124:127], v[108:111]
ds_read_b64_tr_b16 v[164:165], v5 offset:8704
v_mfma_f32_16x16x32_bf16 v[92:95], v[196:199], a[120:123], v[92:95]
ds_read_b64_tr_b16 v[166:167], v5 offset:12800
s_waitcnt lgkmcnt(8)
v_mfma_f32_16x16x32_bf16 v[92:95], v[192:195], a[112:115], v[92:95]
buffer_load_dwordx4 v13, s[64:67], s61 offen offset:1024 lds
v_mfma_f32_16x16x32_bf16 v[96:99], v[200:203], a[112:115], v[96:99]
ds_read_b64_tr_b16 v[168:169], v4 offset:768
ds_read_b64_tr_b16 v[170:171], v4 offset:4864
v_mfma_f32_16x16x32_bf16 v[96:99], v[204:207], a[120:123], v[96:99]
ds_read_b64_tr_b16 v[172:173], v4 offset:8960
v_mfma_f32_16x16x32_bf16 v[112:115], v[204:207], a[124:127], v[112:115]
ds_read_b64_tr_b16 v[174:175], v4 offset:13056
v_mfma_f32_16x16x32_bf16 v[112:115], v[200:203], a[116:119], v[112:115]
buffer_load_dwordx4 v12, s[64:67], s62 offen offset:2048 lds
v_mfma_f32_16x16x32_bf16 v[116:119], v[208:211], a[116:119], v[116:119]
ds_read_b64_tr_b16 v[176:177], v5 offset:768
ds_read_b64_tr_b16 v[178:179], v5 offset:4864
v_mfma_f32_16x16x32_bf16 v[116:119], v[212:215], a[124:127], v[116:119]
ds_read_b64_tr_b16 v[180:181], v5 offset:8960
s_waitcnt lgkmcnt(7)
v_mfma_f32_16x16x32_bf16 v[100:103], v[212:215], a[120:123], v[100:103]
ds_read_b64_tr_b16 v[182:183], v5 offset:13056
v_mfma_f32_16x16x32_bf16 v[100:103], v[208:211], a[112:115], v[100:103]
buffer_load_dwordx4 v13, s[64:67], s62 offen offset:3072 lds
v_mfma_f32_16x16x32_bf16 v[120:123], v[152:155], a[64:67], v[120:123]
ds_read_b64_tr_b16 v[184:185], v4 offset:0
ds_read_b64_tr_b16 v[186:187], v4 offset:4096
v_mfma_f32_16x16x32_bf16 v[120:123], v[156:159], a[72:75], v[120:123]
ds_read_b64_tr_b16 v[188:189], v4 offset:8192
s_add_u32 s60, s60, s57
v_mfma_f32_16x16x32_bf16 v[136:139], v[156:159], a[76:79], v[136:139]
ds_read_b64_tr_b16 v[190:191], v4 offset:12288
s_and_b32 s60, s60, 0x7c000
v_mfma_f32_16x16x32_bf16 v[136:139], v[152:155], a[68:71], v[136:139]
buffer_load_dwordx4 a[96:99], v3, s[88:91], s101 offen sc1
v_mfma_f32_16x16x32_bf16 v[140:143], v[160:163], a[68:71], v[140:143]
ds_read_b64_tr_b16 v[192:193], v5 offset:0
ds_read_b64_tr_b16 v[194:195], v5 offset:4096
v_mfma_f32_16x16x32_bf16 v[140:143], v[164:167], a[76:79], v[140:143]
ds_read_b64_tr_b16 v[196:197], v5 offset:8192
s_lshl_b32 s61, s60, 3
v_mfma_f32_16x16x32_bf16 v[124:127], v[164:167], a[72:75], v[124:127]
ds_read_b64_tr_b16 v[198:199], v5 offset:12288
s_waitcnt lgkmcnt(8)
v_mfma_f32_16x16x32_bf16 v[124:127], v[160:163], a[64:67], v[124:127]
buffer_load_dwordx4 a[100:103], v3, s[88:91], s101 offen offset:1024 sc1
v_mfma_f32_16x16x32_bf16 v[128:131], v[168:171], a[64:67], v[128:131]
ds_read_b64_tr_b16 v[200:201], v4 offset:256
ds_read_b64_tr_b16 v[202:203], v4 offset:4352
v_mfma_f32_16x16x32_bf16 v[128:131], v[172:175], a[72:75], v[128:131]
ds_read_b64_tr_b16 v[204:205], v4 offset:8448
s_add_u32 s62, s61, s12
v_mfma_f32_16x16x32_bf16 v[144:147], v[172:175], a[76:79], v[144:147]
ds_read_b64_tr_b16 v[206:207], v4 offset:12544
s_add_u32 s101, s101, 0x2000
v_mfma_f32_16x16x32_bf16 v[144:147], v[168:171], a[68:71], v[144:147]
buffer_load_dwordx4 a[104:107], v3, s[88:91], s101 offen sc1
v_mfma_f32_16x16x32_bf16 v[148:151], v[176:179], a[68:71], v[148:151]
ds_read_b64_tr_b16 v[208:209], v5 offset:256
ds_read_b64_tr_b16 v[210:211], v5 offset:4352
v_mfma_f32_16x16x32_bf16 v[148:151], v[180:183], a[76:79], v[148:151]
ds_read_b64_tr_b16 v[212:213], v5 offset:8448
s_waitcnt vmcnt(7) lgkmcnt(7)
v_mfma_f32_16x16x32_bf16 v[132:135], v[180:183], a[72:75], v[132:135]
ds_read_b64_tr_b16 v[214:215], v5 offset:12544
s_barrier
v_mfma_f32_16x16x32_bf16 v[132:135], v[176:179], a[64:67], v[132:135]
buffer_load_dwordx4 a[108:111], v3, s[88:91], s101 offen offset:1024 sc1
v_mfma_f32_16x16x32_bf16 v[88:91], v[184:187], a[64:67], v[88:91]
ds_read_b64_tr_b16 v[152:153], v4 offset:16896
ds_read_b64_tr_b16 v[154:155], v4 offset:20992
v_mfma_f32_16x16x32_bf16 v[88:91], v[188:191], a[72:75], v[88:91]
ds_read_b64_tr_b16 v[156:157], v4 offset:25088
s_add_u32 s101, s63, s60
v_mfma_f32_16x16x32_bf16 v[104:107], v[188:191], a[76:79], v[104:107]
ds_read_b64_tr_b16 v[158:159], v4 offset:29184
s_add_u32 m0, s16, 0x4000
v_mfma_f32_16x16x32_bf16 v[104:107], v[184:187], a[68:71], v[104:107]
buffer_load_dwordx4 v12, s[64:67], s61 offen lds
v_mfma_f32_16x16x32_bf16 v[108:111], v[192:195], a[68:71], v[108:111]
ds_read_b64_tr_b16 v[160:161], v5 offset:16896
ds_read_b64_tr_b16 v[162:163], v5 offset:20992
v_mfma_f32_16x16x32_bf16 v[108:111], v[196:199], a[76:79], v[108:111]
ds_read_b64_tr_b16 v[164:165], v5 offset:25088
v_mfma_f32_16x16x32_bf16 v[92:95], v[196:199], a[72:75], v[92:95]
ds_read_b64_tr_b16 v[166:167], v5 offset:29184
s_waitcnt lgkmcnt(8)
v_mfma_f32_16x16x32_bf16 v[92:95], v[192:195], a[64:67], v[92:95]
buffer_load_dwordx4 v13, s[64:67], s61 offen offset:1024 lds
v_mfma_f32_16x16x32_bf16 v[96:99], v[200:203], a[64:67], v[96:99]
ds_read_b64_tr_b16 v[168:169], v4 offset:17152
ds_read_b64_tr_b16 v[170:171], v4 offset:21248
v_mfma_f32_16x16x32_bf16 v[96:99], v[204:207], a[72:75], v[96:99]
ds_read_b64_tr_b16 v[172:173], v4 offset:25344
v_mfma_f32_16x16x32_bf16 v[112:115], v[204:207], a[76:79], v[112:115]
ds_read_b64_tr_b16 v[174:175], v4 offset:29440
v_mfma_f32_16x16x32_bf16 v[112:115], v[200:203], a[68:71], v[112:115]
buffer_load_dwordx4 v12, s[64:67], s62 offen offset:2048 lds
v_mfma_f32_16x16x32_bf16 v[116:119], v[208:211], a[68:71], v[116:119]
ds_read_b64_tr_b16 v[176:177], v5 offset:17152
ds_read_b64_tr_b16 v[178:179], v5 offset:21248
v_mfma_f32_16x16x32_bf16 v[116:119], v[212:215], a[76:79], v[116:119]
ds_read_b64_tr_b16 v[180:181], v5 offset:25344
s_waitcnt lgkmcnt(7)
v_mfma_f32_16x16x32_bf16 v[100:103], v[212:215], a[72:75], v[100:103]
ds_read_b64_tr_b16 v[182:183], v5 offset:29440
v_mfma_f32_16x16x32_bf16 v[100:103], v[208:211], a[64:67], v[100:103]
buffer_load_dwordx4 v13, s[64:67], s62 offen offset:3072 lds
v_mfma_f32_16x16x32_bf16 v[120:123], v[152:155], a[80:83], v[120:123]
ds_read_b64_tr_b16 v[184:185], v4 offset:16384
ds_read_b64_tr_b16 v[186:187], v4 offset:20480
v_mfma_f32_16x16x32_bf16 v[120:123], v[156:159], a[88:91], v[120:123]
ds_read_b64_tr_b16 v[188:189], v4 offset:24576
s_add_u32 s60, s60, s58
v_mfma_f32_16x16x32_bf16 v[136:139], v[156:159], a[92:95], v[136:139]
ds_read_b64_tr_b16 v[190:191], v4 offset:28672
s_and_b32 s60, s60, 0x7c000
v_mfma_f32_16x16x32_bf16 v[136:139], v[152:155], a[84:87], v[136:139]
buffer_load_dwordx4 a[112:115], v3, s[88:91], s101 offen sc1
v_mfma_f32_16x16x32_bf16 v[140:143], v[160:163], a[84:87], v[140:143]
ds_read_b64_tr_b16 v[192:193], v5 offset:16384
ds_read_b64_tr_b16 v[194:195], v5 offset:20480
v_mfma_f32_16x16x32_bf16 v[140:143], v[164:167], a[92:95], v[140:143]
ds_read_b64_tr_b16 v[196:197], v5 offset:24576
s_lshl_b32 s61, s60, 3
v_mfma_f32_16x16x32_bf16 v[124:127], v[164:167], a[88:91], v[124:127]
ds_read_b64_tr_b16 v[198:199], v5 offset:28672
s_waitcnt lgkmcnt(8)
v_mfma_f32_16x16x32_bf16 v[124:127], v[160:163], a[80:83], v[124:127]
buffer_load_dwordx4 a[116:119], v3, s[88:91], s101 offen offset:1024 sc1
v_mfma_f32_16x16x32_bf16 v[128:131], v[168:171], a[80:83], v[128:131]
ds_read_b64_tr_b16 v[200:201], v4 offset:16640
ds_read_b64_tr_b16 v[202:203], v4 offset:20736
v_mfma_f32_16x16x32_bf16 v[128:131], v[172:175], a[88:91], v[128:131]
ds_read_b64_tr_b16 v[204:205], v4 offset:24832
s_add_u32 s62, s61, s12
v_mfma_f32_16x16x32_bf16 v[144:147], v[172:175], a[92:95], v[144:147]
ds_read_b64_tr_b16 v[206:207], v4 offset:28928
s_add_u32 s101, s101, 0x2000
v_mfma_f32_16x16x32_bf16 v[144:147], v[168:171], a[84:87], v[144:147]
buffer_load_dwordx4 a[120:123], v3, s[88:91], s101 offen sc1
v_mfma_f32_16x16x32_bf16 v[148:151], v[176:179], a[84:87], v[148:151]
ds_read_b64_tr_b16 v[208:209], v5 offset:16640
ds_read_b64_tr_b16 v[210:211], v5 offset:20736
v_mfma_f32_16x16x32_bf16 v[148:151], v[180:183], a[92:95], v[148:151]
ds_read_b64_tr_b16 v[212:213], v5 offset:24832
s_waitcnt vmcnt(7) lgkmcnt(7)
v_mfma_f32_16x16x32_bf16 v[132:135], v[180:183], a[88:91], v[132:135]
ds_read_b64_tr_b16 v[214:215], v5 offset:28928
s_barrier
v_mfma_f32_16x16x32_bf16 v[132:135], v[176:179], a[80:83], v[132:135]
buffer_load_dwordx4 a[124:127], v3, s[88:91], s101 offen offset:1024 sc1
buffer_load_dword v14, v20, s[88:91], s24 offen sc1
v_mfma_f32_16x16x32_bf16 v[88:91], v[184:187], a[80:83], v[88:91]
ds_read_b64_tr_b16 v[152:153], v6 offset:512
ds_read_b64_tr_b16 v[154:155], v6 offset:4608
v_mfma_f32_16x16x32_bf16 v[88:91], v[188:191], a[88:91], v[88:91]
ds_read_b64_tr_b16 v[156:157], v6 offset:8704
s_add_u32 s101, s63, s60
v_mfma_f32_16x16x32_bf16 v[104:107], v[188:191], a[92:95], v[104:107]
ds_read_b64_tr_b16 v[158:159], v6 offset:12800
s_add_u32 m0, s17, 0x10000
v_mfma_f32_16x16x32_bf16 v[104:107], v[184:187], a[84:87], v[104:107]
buffer_load_dwordx4 v12, s[64:67], s61 offen lds
v_mfma_f32_16x16x32_bf16 v[108:111], v[192:195], a[84:87], v[108:111]
ds_read_b64_tr_b16 v[160:161], v7 offset:512
ds_read_b64_tr_b16 v[162:163], v7 offset:4608
v_mfma_f32_16x16x32_bf16 v[108:111], v[196:199], a[92:95], v[108:111]
ds_read_b64_tr_b16 v[164:165], v7 offset:8704
s_sub_u32 s15, s15, 1
v_mfma_f32_16x16x32_bf16 v[92:95], v[196:199], a[88:91], v[92:95]
ds_read_b64_tr_b16 v[166:167], v7 offset:12800
s_waitcnt lgkmcnt(8)
v_mfma_f32_16x16x32_bf16 v[92:95], v[192:195], a[80:83], v[92:95]
buffer_load_dwordx4 v13, s[64:67], s61 offen offset:1024 lds
v_mfma_f32_16x16x32_bf16 v[96:99], v[200:203], a[80:83], v[96:99]
ds_read_b64_tr_b16 v[168:169], v6 offset:768
ds_read_b64_tr_b16 v[170:171], v6 offset:4864
v_mfma_f32_16x16x32_bf16 v[96:99], v[204:207], a[88:91], v[96:99]
ds_read_b64_tr_b16 v[172:173], v6 offset:8960
v_mfma_f32_16x16x32_bf16 v[112:115], v[204:207], a[92:95], v[112:115]
ds_read_b64_tr_b16 v[174:175], v6 offset:13056
v_mfma_f32_16x16x32_bf16 v[112:115], v[200:203], a[84:87], v[112:115]
buffer_load_dwordx4 v12, s[64:67], s62 offen offset:2048 lds
v_mfma_f32_16x16x32_bf16 v[116:119], v[208:211], a[84:87], v[116:119]
ds_read_b64_tr_b16 v[176:177], v7 offset:768
ds_read_b64_tr_b16 v[178:179], v7 offset:4864
v_mfma_f32_16x16x32_bf16 v[116:119], v[212:215], a[92:95], v[116:119]
ds_read_b64_tr_b16 v[180:181], v7 offset:8960
s_waitcnt lgkmcnt(7)
v_mfma_f32_16x16x32_bf16 v[100:103], v[212:215], a[88:91], v[100:103]
ds_read_b64_tr_b16 v[182:183], v7 offset:13056
v_mfma_f32_16x16x32_bf16 v[100:103], v[208:211], a[80:83], v[100:103]
buffer_load_dwordx4 v13, s[64:67], s62 offen offset:3072 lds
v_mfma_f32_16x16x32_bf16 v[120:123], v[152:155], a[96:99], v[120:123]
ds_read_b64_tr_b16 v[184:185], v6 offset:0
ds_read_b64_tr_b16 v[186:187], v6 offset:4096
v_mfma_f32_16x16x32_bf16 v[120:123], v[156:159], a[104:107], v[120:123]
ds_read_b64_tr_b16 v[188:189], v6 offset:8192
s_add_u32 s60, s60, s59
v_mfma_f32_16x16x32_bf16 v[136:139], v[156:159], a[108:111], v[136:139]
ds_read_b64_tr_b16 v[190:191], v6 offset:12288
s_and_b32 s60, s60, 0x7c000
v_mfma_f32_16x16x32_bf16 v[136:139], v[152:155], a[100:103], v[136:139]
buffer_load_dwordx4 a[64:67], v3, s[88:91], s101 offen sc1
v_mfma_f32_16x16x32_bf16 v[140:143], v[160:163], a[100:103], v[140:143]
ds_read_b64_tr_b16 v[192:193], v7 offset:0
ds_read_b64_tr_b16 v[194:195], v7 offset:4096
v_mfma_f32_16x16x32_bf16 v[140:143], v[164:167], a[108:111], v[140:143]
ds_read_b64_tr_b16 v[196:197], v7 offset:8192
s_lshl_b32 s61, s60, 3
v_mfma_f32_16x16x32_bf16 v[124:127], v[164:167], a[104:107], v[124:127]
ds_read_b64_tr_b16 v[198:199], v7 offset:12288
s_waitcnt lgkmcnt(8)
v_mfma_f32_16x16x32_bf16 v[124:127], v[160:163], a[96:99], v[124:127]
buffer_load_dwordx4 a[68:71], v3, s[88:91], s101 offen offset:1024 sc1
v_mfma_f32_16x16x32_bf16 v[128:131], v[168:171], a[96:99], v[128:131]
ds_read_b64_tr_b16 v[200:201], v6 offset:256
ds_read_b64_tr_b16 v[202:203], v6 offset:4352
v_mfma_f32_16x16x32_bf16 v[128:131], v[172:175], a[104:107], v[128:131]
ds_read_b64_tr_b16 v[204:205], v6 offset:8448
s_add_u32 s62, s61, s12
v_mfma_f32_16x16x32_bf16 v[144:147], v[172:175], a[108:111], v[144:147]
ds_read_b64_tr_b16 v[206:207], v6 offset:12544
s_add_u32 s101, s101, 0x2000
v_mfma_f32_16x16x32_bf16 v[144:147], v[168:171], a[100:103], v[144:147]
buffer_load_dwordx4 a[72:75], v3, s[88:91], s101 offen sc1
v_mfma_f32_16x16x32_bf16 v[148:151], v[176:179], a[100:103], v[148:151]
ds_read_b64_tr_b16 v[208:209], v7 offset:256
ds_read_b64_tr_b16 v[210:211], v7 offset:4352
v_mfma_f32_16x16x32_bf16 v[148:151], v[180:183], a[108:111], v[148:151]
ds_read_b64_tr_b16 v[212:213], v7 offset:8448
s_waitcnt vmcnt(7) lgkmcnt(7)
v_mfma_f32_16x16x32_bf16 v[132:135], v[180:183], a[104:107], v[132:135]
ds_read_b64_tr_b16 v[214:215], v7 offset:12544
s_barrier
v_mfma_f32_16x16x32_bf16 v[132:135], v[176:179], a[96:99], v[132:135]
buffer_load_dwordx4 a[76:79], v3, s[88:91], s101 offen offset:1024 sc1
v_cmp_ne_u32 vcc, 1, v14
s_cmp_lg_u32 s15, 0
s_cbranch_scc0 L_p4_exit
s_cbranch_vccz L_p4_loop
s_mov_b32 s92, 200000
L_spin_d:
v_cmp_ne_u32 vcc, 1, v14
s_nop 4
s_cbranch_vccz L_spun_d
s_sub_u32 s92, s92, 1
s_cbranch_scc1 L_spun_d
s_sleep 6
buffer_load_dword v14, v20, s[88:91], s24 offen sc1
s_waitcnt vmcnt(0)
s_branch L_spin_d
L_spun_d:
s_branch L_p4_loop
L_p4_exit:
s_add_u32 s101, s63, s60
v_mfma_f32_16x16x32_bf16 v[88:91], v[184:187], a[96:99], v[88:91]
ds_read_b64_tr_b16 v[152:153], v6 offset:16896
ds_read_b64_tr_b16 v[154:155], v6 offset:20992
s_add_u32 m0, s17, 0x14000
v_mfma_f32_16x16x32_bf16 v[88:91], v[188:191], a[104:107], v[88:91]
buffer_load_dwordx4 v12, s[64:67], s61 offen lds
v_mfma_f32_16x16x32_bf16 v[104:107], v[188:191], a[108:111], v[104:107]
ds_read_b64_tr_b16 v[156:157], v6 offset:25088
ds_read_b64_tr_b16 v[158:159], v6 offset:29184
v_mfma_f32_16x16x32_bf16 v[104:107], v[184:187], a[100:103], v[104:107]
buffer_load_dwordx4 v13, s[64:67], s61 offen offset:1024 lds
v_mfma_f32_16x16x32_bf16 v[108:111], v[192:195], a[100:103], v[108:111]
ds_read_b64_tr_b16 v[160:161], v7 offset:16896
ds_read_b64_tr_b16 v[162:163], v7 offset:20992
v_mfma_f32_16x16x32_bf16 v[108:111], v[196:199], a[108:111], v[108:111]
buffer_load_dwordx4 v12, s[64:67], s62 offen offset:2048 lds
v_mfma_f32_16x16x32_bf16 v[92:95], v[196:199], a[104:107], v[92:95]
ds_read_b64_tr_b16 v[164:165], v7 offset:25088
ds_read_b64_tr_b16 v[166:167], v7 offset:29184
s_waitcnt lgkmcnt(8)
v_mfma_f32_16x16x32_bf16 v[92:95], v[192:195], a[96:99], v[92:95]
buffer_load_dwordx4 v13, s[64:67], s62 offen offset:3072 lds
v_mfma_f32_16x16x32_bf16 v[96:99], v[200:203], a[96:99], v[96:99]
ds_read_b64_tr_b16 v[168:169], v6 offset:17152
ds_read_b64_tr_b16 v[170:171], v6 offset:21248
v_mfma_f32_16x16x32_bf16 v[96:99], v[204:207], a[104:107], v[96:99]
buffer_load_dwordx4 a[80:83], v3, s[88:91], s101 offen sc1
v_mfma_f32_16x16x32_bf16 v[112:115], v[204:207], a[108:111], v[112:115]
ds_read_b64_tr_b16 v[172:173], v6 offset:25344
ds_read_b64_tr_b16 v[174:175], v6 offset:29440
v_mfma_f32_16x16x32_bf16 v[112:115], v[200:203], a[100:103], v[112:115]
buffer_load_dwordx4 a[84:87], v3, s[88:91], s101 offen offset:1024 sc1
v_mfma_f32_16x16x32_bf16 v[116:119], v[208:211], a[100:103], v[116:119]
ds_read_b64_tr_b16 v[176:177], v7 offset:17152
ds_read_b64_tr_b16 v[178:179], v7 offset:21248
s_add_u32 s101, s101, 0x2000
v_mfma_f32_16x16x32_bf16 v[116:119], v[212:215], a[108:111], v[116:119]
buffer_load_dwordx4 a[88:91], v3, s[88:91], s101 offen sc1
s_waitcnt vmcnt(7) lgkmcnt(6)
v_mfma_f32_16x16x32_bf16 v[100:103], v[212:215], a[104:107], v[100:103]
ds_read_b64_tr_b16 v[180:181], v7 offset:25344
ds_read_b64_tr_b16 v[182:183], v7 offset:29440
s_barrier
v_mfma_f32_16x16x32_bf16 v[100:103], v[208:211], a[96:99], v[100:103]
buffer_load_dwordx4 a[92:95], v3, s[88:91], s101 offen offset:1024 sc1
v_mfma_f32_16x16x32_bf16 v[120:123], v[152:155], a[112:115], v[120:123]
ds_read_b64_tr_b16 v[184:185], v4 offset:512
v_sub_f32 v10, 1.0, v8
v_mfma_f32_16x16x32_bf16 v[120:123], v[156:159], a[120:123], v[120:123]
ds_read_b64_tr_b16 v[186:187], v4 offset:4608
v_sub_f32 v11, 1.0, v9
v_mfma_f32_16x16x32_bf16 v[136:139], v[156:159], a[124:127], v[136:139]
ds_read_b64_tr_b16 v[188:189], v4 offset:8704
v_mul_f32 v56, v10, v56
v_mfma_f32_16x16x32_bf16 v[136:139], v[152:155], a[116:119], v[136:139]
ds_read_b64_tr_b16 v[190:191], v4 offset:12800
v_mul_f32 v57, v10, v57
v_mfma_f32_16x16x32_bf16 v[140:143], v[160:163], a[116:119], v[140:143]
ds_read_b64_tr_b16 v[192:193], v5 offset:512
v_mul_f32 v58, v10, v58
v_mfma_f32_16x16x32_bf16 v[140:143], v[164:167], a[124:127], v[140:143]
ds_read_b64_tr_b16 v[194:195], v5 offset:4608
v_mul_f32 v59, v10, v59
v_mfma_f32_16x16x32_bf16 v[124:127], v[164:167], a[120:123], v[124:127]
ds_read_b64_tr_b16 v[196:197], v5 offset:8704
s_waitcnt lgkmcnt(7)
v_mfma_f32_16x16x32_bf16 v[124:127], v[160:163], a[112:115], v[124:127]
ds_read_b64_tr_b16 v[198:199], v5 offset:12800
v_mul_f32 v60, v10, v60
v_mfma_f32_16x16x32_bf16 v[128:131], v[168:171], a[112:115], v[128:131]
ds_read_b64_tr_b16 v[200:201], v4 offset:768
v_mul_f32 v61, v10, v61
v_mfma_f32_16x16x32_bf16 v[128:131], v[172:175], a[120:123], v[128:131]
ds_read_b64_tr_b16 v[202:203], v4 offset:4864
v_mul_f32 v62, v10, v62
v_mfma_f32_16x16x32_bf16 v[144:147], v[172:175], a[124:127], v[144:147]
ds_read_b64_tr_b16 v[204:205], v4 offset:8960
v_mul_f32 v63, v10, v63
v_mfma_f32_16x16x32_bf16 v[144:147], v[168:171], a[116:119], v[144:147]
ds_read_b64_tr_b16 v[206:207], v4 offset:13056
v_mul_f32 v64, v10, v64
v_mfma_f32_16x16x32_bf16 v[148:151], v[176:179], a[116:119], v[148:151]
ds_read_b64_tr_b16 v[208:209], v5 offset:768
v_mul_f32 v65, v10, v65
v_mfma_f32_16x16x32_bf16 v[148:151], v[180:183], a[124:127], v[148:151]
ds_read_b64_tr_b16 v[210:211], v5 offset:4864
s_waitcnt vmcnt(0) lgkmcnt(6)
v_mfma_f32_16x16x32_bf16 v[132:135], v[180:183], a[120:123], v[132:135]
ds_read_b64_tr_b16 v[212:213], v5 offset:8960
s_barrier
v_mfma_f32_16x16x32_bf16 v[132:135], v[176:179], a[112:115], v[132:135]
ds_read_b64_tr_b16 v[214:215], v5 offset:13056
v_mul_f32 v66, v10, v66
v_mul_f32 v67, v10, v67
v_mfma_f32_16x16x32_bf16 v[120:123], v[184:187], a[64:67], v[120:123]
ds_read_b64_tr_b16 v[152:153], v4 offset:16896
v_mul_f32 v68, v10, v68
v_mfma_f32_16x16x32_bf16 v[120:123], v[188:191], a[72:75], v[120:123]
ds_read_b64_tr_b16 v[154:155], v4 offset:20992
v_mul_f32 v69, v10, v69
v_mfma_f32_16x16x32_bf16 v[136:139], v[188:191], a[76:79], v[136:139]
ds_read_b64_tr_b16 v[156:157], v4 offset:25088
v_mul_f32 v70, v10, v70
v_mfma_f32_16x16x32_bf16 v[136:139], v[184:187], a[68:71], v[136:139]
ds_read_b64_tr_b16 v[158:159], v4 offset:29184
v_mul_f32 v71, v10, v71
v_mfma_f32_16x16x32_bf16 v[140:143], v[192:195], a[68:71], v[140:143]
ds_read_b64_tr_b16 v[160:161], v5 offset:16896
v_mul_f32 v72, v11, v72
v_mfma_f32_16x16x32_bf16 v[140:143], v[196:199], a[76:79], v[140:143]
ds_read_b64_tr_b16 v[162:163], v5 offset:20992
v_mul_f32 v73, v11, v73
v_mfma_f32_16x16x32_bf16 v[124:127], v[196:199], a[72:75], v[124:127]
ds_read_b64_tr_b16 v[164:165], v5 offset:25088
s_waitcnt lgkmcnt(7)
v_mfma_f32_16x16x32_bf16 v[124:127], v[192:195], a[64:67], v[124:127]
ds_read_b64_tr_b16 v[166:167], v5 offset:29184
v_mul_f32 v74, v11, v74
v_mfma_f32_16x16x32_bf16 v[128:131], v[200:203], a[64:67], v[128:131]
ds_read_b64_tr_b16 v[168:169], v4 offset:17152
v_mul_f32 v75, v11, v75
v_mfma_f32_16x16x32_bf16 v[128:131], v[204:207], a[72:75], v[128:131]
ds_read_b64_tr_b16 v[170:171], v4 offset:21248
v_mul_f32 v76, v11, v76
v_mfma_f32_16x16x32_bf16 v[144:147], v[204:207], a[76:79], v[144:147]
ds_read_b64_tr_b16 v[172:173], v4 offset:25344
v_mul_f32 v77, v11, v77
v_mfma_f32_16x16x32_bf16 v[144:147], v[200:203], a[68:71], v[144:147]
ds_read_b64_tr_b16 v[174:175], v4 offset:29440
v_mul_f32 v78, v11, v78
v_mfma_f32_16x16x32_bf16 v[148:151], v[208:211], a[68:71], v[148:151]
ds_read_b64_tr_b16 v[176:177], v5 offset:17152
v_mul_f32 v79, v11, v79
v_mfma_f32_16x16x32_bf16 v[148:151], v[212:215], a[76:79], v[148:151]
ds_read_b64_tr_b16 v[178:179], v5 offset:21248
s_waitcnt lgkmcnt(6)
v_mfma_f32_16x16x32_bf16 v[132:135], v[212:215], a[72:75], v[132:135]
ds_read_b64_tr_b16 v[180:181], v5 offset:25344
v_mul_f32 v80, v11, v80
v_mfma_f32_16x16x32_bf16 v[132:135], v[208:211], a[64:67], v[132:135]
ds_read_b64_tr_b16 v[182:183], v5 offset:29440
v_mul_f32 v81, v11, v81
v_mfma_f32_16x16x32_bf16 v[120:123], v[152:155], a[80:83], v[120:123]
ds_read_b64_tr_b16 v[184:185], v6 offset:16384
v_mul_f32 v82, v11, v82
v_mfma_f32_16x16x32_bf16 v[120:123], v[156:159], a[88:91], v[120:123]
ds_read_b64_tr_b16 v[186:187], v6 offset:20480
v_mul_f32 v83, v11, v83
v_mfma_f32_16x16x32_bf16 v[136:139], v[156:159], a[92:95], v[136:139]
ds_read_b64_tr_b16 v[188:189], v6 offset:24576
v_mul_f32 v84, v11, v84
v_mfma_f32_16x16x32_bf16 v[136:139], v[152:155], a[84:87], v[136:139]
ds_read_b64_tr_b16 v[190:191], v6 offset:28672
v_mul_f32 v85, v11, v85
v_mfma_f32_16x16x32_bf16 v[140:143], v[160:163], a[84:87], v[140:143]
ds_read_b64_tr_b16 v[192:193], v7 offset:16384
v_mul_f32 v86, v11, v86
v_mfma_f32_16x16x32_bf16 v[140:143], v[164:167], a[92:95], v[140:143]
ds_read_b64_tr_b16 v[194:195], v7 offset:20480
v_mul_f32 v87, v11, v87
v_mfma_f32_16x16x32_bf16 v[124:127], v[164:167], a[88:91], v[124:127]
ds_read_b64_tr_b16 v[196:197], v7 offset:24576
s_waitcnt lgkmcnt(7)
v_mfma_f32_16x16x32_bf16 v[124:127], v[160:163], a[80:83], v[124:127]
ds_read_b64_tr_b16 v[198:199], v7 offset:28672
v_mul_f32 v24, v10, v24
v_mfma_f32_16x16x32_bf16 v[128:131], v[168:171], a[80:83], v[128:131]
ds_read_b64_tr_b16 v[200:201], v6 offset:16640
v_mul_f32 v25, v10, v25
v_mfma_f32_16x16x32_bf16 v[128:131], v[172:175], a[88:91], v[128:131]
ds_read_b64_tr_b16 v[202:203], v6 offset:20736
v_mul_f32 v26, v10, v26
v_mfma_f32_16x16x32_bf16 v[144:147], v[172:175], a[92:95], v[144:147]
ds_read_b64_tr_b16 v[204:205], v6 offset:24832
v_mul_f32 v27, v10, v27
v_mfma_f32_16x16x32_bf16 v[144:147], v[168:171], a[84:87], v[144:147]
ds_read_b64_tr_b16 v[206:207], v6 offset:28928
v_mul_f32 v28, v10, v28
v_mfma_f32_16x16x32_bf16 v[148:151], v[176:179], a[84:87], v[148:151]
ds_read_b64_tr_b16 v[208:209], v7 offset:16640
v_mul_f32 v29, v10, v29
v_mfma_f32_16x16x32_bf16 v[148:151], v[180:183], a[92:95], v[148:151]
ds_read_b64_tr_b16 v[210:211], v7 offset:20736
s_waitcnt lgkmcnt(6)
v_mfma_f32_16x16x32_bf16 v[132:135], v[180:183], a[88:91], v[132:135]
ds_read_b64_tr_b16 v[212:213], v7 offset:24832
v_mul_f32 v30, v10, v30
v_mfma_f32_16x16x32_bf16 v[132:135], v[176:179], a[80:83], v[132:135]
ds_read_b64_tr_b16 v[214:215], v7 offset:28928
v_mul_f32 v31, v10, v31
v_pk_fma_f32 v[56:57], v[120:121], v[8:9], v[56:57] op_sel_hi:[1,0,1]
v_pk_fma_f32 v[58:59], v[122:123], v[8:9], v[58:59] op_sel_hi:[1,0,1]
v_pk_fma_f32 v[60:61], v[124:125], v[8:9], v[60:61] op_sel_hi:[1,0,1]
v_pk_fma_f32 v[62:63], v[126:127], v[8:9], v[62:63] op_sel_hi:[1,0,1]
v_cvt_pk_bf16_f32 v56, v56, v57
v_cvt_pk_bf16_f32 v57, v58, v59
v_cvt_pk_bf16_f32 v58, v60, v61
v_cvt_pk_bf16_f32 v59, v62, v63
buffer_store_dwordx4 v[56:59], v3, s[88:91], s30 offen offset:0 sc1
v_pk_fma_f32 v[72:73], v[136:137], v[8:9], v[72:73] op_sel:[0,1,0] op_sel_hi:[1,1,1]
v_pk_fma_f32 v[74:75], v[138:139], v[8:9], v[74:75] op_sel:[0,1,0] op_sel_hi:[1,1,1]
v_pk_fma_f32 v[76:77], v[140:141], v[8:9], v[76:77] op_sel:[0,1,0] op_sel_hi:[1,1,1]
v_pk_fma_f32 v[78:79], v[142:143], v[8:9], v[78:79] op_sel:[0,1,0] op_sel_hi:[1,1,1]
v_cvt_pk_bf16_f32 v72, v72, v73
v_cvt_pk_bf16_f32 v73, v74, v75
v_cvt_pk_bf16_f32 v74, v76, v77
v_cvt_pk_bf16_f32 v75, v78, v79
buffer_store_dwordx4 v[72:75], v3, s[88:91], s30 offen offset:2048 sc1
v_pk_fma_f32 v[64:65], v[128:129], v[8:9], v[64:65] op_sel_hi:[1,0,1]
v_pk_fma_f32 v[66:67], v[130:131], v[8:9], v[66:67] op_sel_hi:[1,0,1]
v_pk_fma_f32 v[68:69], v[132:133], v[8:9], v[68:69] op_sel_hi:[1,0,1]
v_pk_fma_f32 v[70:71], v[134:135], v[8:9], v[70:71] op_sel_hi:[1,0,1]
v_cvt_pk_bf16_f32 v64, v64, v65
v_cvt_pk_bf16_f32 v65, v66, v67
v_cvt_pk_bf16_f32 v66, v68, v69
v_cvt_pk_bf16_f32 v67, v70, v71
buffer_store_dwordx4 v[64:67], v3, s[88:91], s30 offen offset:1024 sc1
v_pk_fma_f32 v[80:81], v[144:145], v[8:9], v[80:81] op_sel:[0,1,0] op_sel_hi:[1,1,1]
v_pk_fma_f32 v[82:83], v[146:147], v[8:9], v[82:83] op_sel:[0,1,0] op_sel_hi:[1,1,1]
v_pk_fma_f32 v[84:85], v[148:149], v[8:9], v[84:85] op_sel:[0,1,0] op_sel_hi:[1,1,1]
v_pk_fma_f32 v[86:87], v[150:151], v[8:9], v[86:87] op_sel:[0,1,0] op_sel_hi:[1,1,1]
v_cvt_pk_bf16_f32 v80, v80, v81
v_cvt_pk_bf16_f32 v81, v82, v83
v_cvt_pk_bf16_f32 v82, v84, v85
v_cvt_pk_bf16_f32 v83, v86, v87
buffer_store_dwordx4 v[80:83], v3, s[88:91], s30 offen offset:3072 sc1
v_mfma_f32_16x16x32_bf16 v[88:91], v[184:187], a[112:115], v[88:91]
ds_read_b64_tr_b16 v[152:153], v4 offset:0
v_mfma_f32_16x16x32_bf16 v[88:91], v[188:191], a[120:123], v[88:91]
ds_read_b64_tr_b16 v[154:155], v4 offset:4096
v_mfma_f32_16x16x32_bf16 v[104:107], v[188:191], a[124:127], v[104:107]
ds_read_b64_tr_b16 v[156:157], v4 offset:8192
v_mfma_f32_16x16x32_bf16 v[104:107], v[184:187], a[116:119], v[104:107]
ds_read_b64_tr_b16 v[158:159], v4 offset:12288
v_mfma_f32_16x16x32_bf16 v[108:111], v[192:195], a[116:119], v[108:111]
ds_read_b64_tr_b16 v[160:161], v5 offset:0
v_mfma_f32_16x16x32_bf16 v[108:111], v[196:199], a[124:127], v[108:111]
ds_read_b64_tr_b16 v[162:163], v5 offset:4096
v_mfma_f32_16x16x32_bf16 v[92:95], v[196:199], a[120:123], v[92:95]
ds_read_b64_tr_b16 v[164:165], v5 offset:8192
s_waitcnt lgkmcnt(7)
v_mfma_f32_16x16x32_bf16 v[92:95], v[192:195], a[112:115], v[92:95]
ds_read_b64_tr_b16 v[166:167], v5 offset:12288
v_mfma_f32_16x16x32_bf16 v[96:99], v[200:203], a[112:115], v[96:99]
ds_read_b64_tr_b16 v[168:169], v4 offset:256
v_mfma_f32_16x16x32_bf16 v[96:99], v[204:207], a[120:123], v[96:99]
ds_read_b64_tr_b16 v[170:171], v4 offset:4352
v_mfma_f32_16x16x32_bf16 v[112:115], v[204:207], a[124:127], v[112:115]
ds_read_b64_tr_b16 v[172:173], v4 offset:8448
v_mfma_f32_16x16x32_bf16 v[112:115], v[200:203], a[116:119], v[112:115]
ds_read_b64_tr_b16 v[174:175], v4 offset:12544
v_mfma_f32_16x16x32_bf16 v[116:119], v[208:211], a[116:119], v[116:119]
ds_read_b64_tr_b16 v[176:177], v5 offset:256
v_mfma_f32_16x16x32_bf16 v[116:119], v[212:215], a[124:127], v[116:119]
ds_read_b64_tr_b16 v[178:179], v5 offset:4352
s_waitcnt lgkmcnt(6)
v_mfma_f32_16x16x32_bf16 v[100:103], v[212:215], a[120:123], v[100:103]
ds_read_b64_tr_b16 v[180:181], v5 offset:8448
v_mfma_f32_16x16x32_bf16 v[100:103], v[208:211], a[112:115], v[100:103]
ds_read_b64_tr_b16 v[182:183], v5 offset:12544
v_mfma_f32_16x16x32_bf16 v[88:91], v[152:155], a[64:67], v[88:91]
ds_read_b64_tr_b16 v[184:185], v4 offset:16384
v_mul_f32 v32, v10, v32
v_mfma_f32_16x16x32_bf16 v[88:91], v[156:159], a[72:75], v[88:91]
ds_read_b64_tr_b16 v[186:187], v4 offset:20480
v_mul_f32 v33, v10, v33
v_mfma_f32_16x16x32_bf16 v[104:107], v[156:159], a[76:79], v[104:107]
ds_read_b64_tr_b16 v[188:189], v4 offset:24576
v_mul_f32 v34, v10, v34
v_mfma_f32_16x16x32_bf16 v[104:107], v[152:155], a[68:71], v[104:107]
ds_read_b64_tr_b16 v[190:191], v4 offset:28672
v_mul_f32 v35, v10, v35
v_mfma_f32_16x16x32_bf16 v[108:111], v[160:163], a[68:71], v[108:111]
ds_read_b64_tr_b16 v[192:193], v5 offset:16384
v_mul_f32 v36, v10, v36
v_mfma_f32_16x16x32_bf16 v[108:111], v[164:167], a[76:79], v[108:111]
ds_read_b64_tr_b16 v[194:195], v5 offset:20480
v_mul_f32 v37, v10, v37
v_mfma_f32_16x16x32_bf16 v[92:95], v[164:167], a[72:75], v[92:95]
ds_read_b64_tr_b16 v[196:197], v5 offset:24576
s_waitcnt lgkmcnt(7)
v_mfma_f32_16x16x32_bf16 v[92:95], v[160:163], a[64:67], v[92:95]
ds_read_b64_tr_b16 v[198:199], v5 offset:28672
v_mul_f32 v38, v10, v38
v_mfma_f32_16x16x32_bf16 v[96:99], v[168:171], a[64:67], v[96:99]
ds_read_b64_tr_b16 v[200:201], v4 offset:16640
v_mul_f32 v39, v10, v39
v_mfma_f32_16x16x32_bf16 v[96:99], v[172:175], a[72:75], v[96:99]
ds_read_b64_tr_b16 v[202:203], v4 offset:20736
v_mul_f32 v40, v11, v40
v_mfma_f32_16x16x32_bf16 v[112:115], v[172:175], a[76:79], v[112:115]
ds_read_b64_tr_b16 v[204:205], v4 offset:24832
v_mul_f32 v41, v11, v41
v_mfma_f32_16x16x32_bf16 v[112:115], v[168:171], a[68:71], v[112:115]
ds_read_b64_tr_b16 v[206:207], v4 offset:28928
v_mul_f32 v42, v11, v42
v_mfma_f32_16x16x32_bf16 v[116:119], v[176:179], a[68:71], v[116:119]
ds_read_b64_tr_b16 v[208:209], v5 offset:16640
v_mul_f32 v43, v11, v43
v_mfma_f32_16x16x32_bf16 v[116:119], v[180:183], a[76:79], v[116:119]
ds_read_b64_tr_b16 v[210:211], v5 offset:20736
s_waitcnt lgkmcnt(6)
v_mfma_f32_16x16x32_bf16 v[100:103], v[180:183], a[72:75], v[100:103]
ds_read_b64_tr_b16 v[212:213], v5 offset:24832
v_mul_f32 v44, v11, v44
v_mfma_f32_16x16x32_bf16 v[100:103], v[176:179], a[64:67], v[100:103]
ds_read_b64_tr_b16 v[214:215], v5 offset:28928
v_mul_f32 v45, v11, v45
v_mfma_f32_16x16x32_bf16 v[88:91], v[184:187], a[80:83], v[88:91]
v_mul_f32 v46, v11, v46
v_mul_f32 v47, v11, v47
v_mfma_f32_16x16x32_bf16 v[88:91], v[188:191], a[88:91], v[88:91]
v_mul_f32 v48, v11, v48
v_mul_f32 v49, v11, v49
v_mfma_f32_16x16x32_bf16 v[104:107], v[188:191], a[92:95], v[104:107]
v_mul_f32 v50, v11, v50
v_mul_f32 v51, v11, v51
v_mfma_f32_16x16x32_bf16 v[104:107], v[184:187], a[84:87], v[104:107]
v_mul_f32 v52, v11, v52
v_mul_f32 v53, v11, v53
v_mfma_f32_16x16x32_bf16 v[108:111], v[192:195], a[84:87], v[108:111]
v_mul_f32 v54, v11, v54
v_mul_f32 v55, v11, v55
v_mfma_f32_16x16x32_bf16 v[108:111], v[196:199], a[92:95], v[108:111]
v_mfma_f32_16x16x32_bf16 v[92:95], v[196:199], a[88:91], v[92:95]
s_waitcnt lgkmcnt(0)
v_mfma_f32_16x16x32_bf16 v[92:95], v[192:195], a[80:83], v[92:95]
v_mfma_f32_16x16x32_bf16 v[96:99], v[200:203], a[80:83], v[96:99]
v_mfma_f32_16x16x32_bf16 v[96:99], v[204:207], a[88:91], v[96:99]
v_mfma_f32_16x16x32_bf16 v[112:115], v[204:207], a[92:95], v[112:115]
v_mfma_f32_16x16x32_bf16 v[112:115], v[200:203], a[84:87], v[112:115]
v_mfma_f32_16x16x32_bf16 v[116:119], v[208:211], a[84:87], v[116:119]
v_mfma_f32_16x16x32_bf16 v[116:119], v[212:215], a[92:95], v[116:119]
v_mfma_f32_16x16x32_bf16 v[100:103], v[212:215], a[88:91], v[100:103]
v_mfma_f32_16x16x32_bf16 v[100:103], v[208:211], a[80:83], v[100:103]
buffer_load_dwordx4 v[152:155], v3, s[88:91], s28 offen offset:0 sc1
buffer_load_dwordx4 v[156:159], v3, s[88:91], s28 offen offset:1024 sc1
buffer_load_dwordx4 v[160:163], v3, s[88:91], s28 offen offset:2048 sc1
buffer_load_dwordx4 v[164:167], v3, s[88:91], s28 offen offset:3072 sc1
v_fmac_f32 v24, v8, v88
v_fmac_f32 v25, v8, v89
v_fmac_f32 v26, v8, v90
v_fmac_f32 v27, v8, v91
v_fmac_f32 v28, v8, v92
v_fmac_f32 v29, v8, v93
v_fmac_f32 v30, v8, v94
v_fmac_f32 v31, v8, v95
v_fmac_f32 v32, v8, v96
v_fmac_f32 v33, v8, v97
v_fmac_f32 v34, v8, v98
v_fmac_f32 v35, v8, v99
v_fmac_f32 v36, v8, v100
v_fmac_f32 v37, v8, v101
v_fmac_f32 v38, v8, v102
v_fmac_f32 v39, v8, v103
v_fmac_f32 v40, v9, v104
v_fmac_f32 v41, v9, v105
v_fmac_f32 v42, v9, v106
v_fmac_f32 v43, v9, v107
v_fmac_f32 v44, v9, v108
v_fmac_f32 v45, v9, v109
v_fmac_f32 v46, v9, v110
v_fmac_f32 v47, v9, v111
v_fmac_f32 v48, v9, v112
v_fmac_f32 v49, v9, v113
v_fmac_f32 v50, v9, v114
v_fmac_f32 v51, v9, v115
v_fmac_f32 v52, v9, v116
v_fmac_f32 v53, v9, v117
v_fmac_f32 v54, v9, v118
v_fmac_f32 v55, v9, v119
s_mov_b32 s92, 200000
L_spin_x:
s_waitcnt vmcnt(0)
v_max3_u32 v168, v152, v153, 0
v_max3_u32 v168, v154, v155, v168
v_max3_u32 v168, v156, v157, v168
v_max3_u32 v168, v158, v159, v168
v_max3_u32 v168, v160, v161, v168
v_max3_u32 v168, v162, v163, v168
v_max3_u32 v168, v164, v165, v168
v_max3_u32 v168, v166, v167, v168
v_cmp_eq_u32 vcc, -1, v168
s_sub_u32 s92, s92, 1
s_cbranch_scc1 L_spun_x
s_nop 3
s_cbranch_vccz L_spun_x
s_sleep 2
buffer_load_dwordx4 v[152:155], v3, s[88:91], s28 offen offset:0 sc1
buffer_load_dwordx4 v[156:159], v3, s[88:91], s28 offen offset:1024 sc1
buffer_load_dwordx4 v[160:163], v3, s[88:91], s28 offen offset:2048 sc1
buffer_load_dwordx4 v[164:167], v3, s[88:91], s28 offen offset:3072 sc1
s_branch L_spin_x
L_spun_x:
v_lshlrev_b32 v168, 16, v152
v_and_b32 v169, 0xffff0000, v152
v_pk_add_f32 v[24:25], v[24:25], v[168:169]
v_lshlrev_b32 v168, 16, v153
v_and_b32 v169, 0xffff0000, v153
v_pk_add_f32 v[26:27], v[26:27], v[168:169]
v_lshlrev_b32 v168, 16, v154
v_and_b32 v169, 0xffff0000, v154
v_pk_add_f32 v[28:29], v[28:29], v[168:169]
v_lshlrev_b32 v168, 16, v155
v_and_b32 v169, 0xffff0000, v155
v_pk_add_f32 v[30:31], v[30:31], v[168:169]
v_cvt_pk_bf16_f32 v24, v24, v25
v_cvt_pk_bf16_f32 v25, v26, v27
v_cvt_pk_bf16_f32 v26, v28, v29
v_cvt_pk_bf16_f32 v27, v30, v31
s_nop 1
v_permlane16_swap_b32 v24, v26
v_permlane16_swap_b32 v25, v27
buffer_store_dwordx4 v[24:27], v17, s[80:83], s29 offen offset:0 sc1
v_lshlrev_b32 v168, 16, v156
v_and_b32 v169, 0xffff0000, v156
v_pk_add_f32 v[32:33], v[32:33], v[168:169]
v_lshlrev_b32 v168, 16, v157
v_and_b32 v169, 0xffff0000, v157
v_pk_add_f32 v[34:35], v[34:35], v[168:169]
v_lshlrev_b32 v168, 16, v158
v_and_b32 v169, 0xffff0000, v158
v_pk_add_f32 v[36:37], v[36:37], v[168:169]
v_lshlrev_b32 v168, 16, v159
v_and_b32 v169, 0xffff0000, v159
v_pk_add_f32 v[38:39], v[38:39], v[168:169]
v_cvt_pk_bf16_f32 v32, v32, v33
v_cvt_pk_bf16_f32 v33, v34, v35
v_cvt_pk_bf16_f32 v34, v36, v37
v_cvt_pk_bf16_f32 v35, v38, v39
s_nop 1
v_permlane16_swap_b32 v32, v34
v_permlane16_swap_b32 v33, v35
buffer_store_dwordx4 v[32:35], v17, s[80:83], s29 offen offset:64 sc1
v_lshlrev_b32 v168, 16, v160
v_and_b32 v169, 0xffff0000, v160
v_pk_add_f32 v[40:41], v[40:41], v[168:169]
v_lshlrev_b32 v168, 16, v161
v_and_b32 v169, 0xffff0000, v161
v_pk_add_f32 v[42:43], v[42:43], v[168:169]
v_lshlrev_b32 v168, 16, v162
v_and_b32 v169, 0xffff0000, v162
v_pk_add_f32 v[44:45], v[44:45], v[168:169]
v_lshlrev_b32 v168, 16, v163
v_and_b32 v169, 0xffff0000, v163
v_pk_add_f32 v[46:47], v[46:47], v[168:169]
v_cvt_pk_bf16_f32 v40, v40, v41
v_cvt_pk_bf16_f32 v41, v42, v43
v_cvt_pk_bf16_f32 v42, v44, v45
v_cvt_pk_bf16_f32 v43, v46, v47
s_nop 1
v_permlane16_swap_b32 v40, v42
v_permlane16_swap_b32 v41, v43
buffer_store_dwordx4 v[40:43], v17, s[80:83], s31 offen offset:0 sc1
v_lshlrev_b32 v168, 16, v164
v_and_b32 v169, 0xffff0000, v164
v_pk_add_f32 v[48:49], v[48:49], v[168:169]
v_lshlrev_b32 v168, 16, v165
v_and_b32 v169, 0xffff0000, v165
v_pk_add_f32 v[50:51], v[50:51], v[168:169]
v_lshlrev_b32 v168, 16, v166
v_and_b32 v169, 0xffff0000, v166
v_pk_add_f32 v[52:53], v[52:53], v[168:169]
v_lshlrev_b32 v168, 16, v167
v_and_b32 v169, 0xffff0000, v167
v_pk_add_f32 v[54:55], v[54:55], v[168:169]
v_cvt_pk_bf16_f32 v48, v48, v49
v_cvt_pk_bf16_f32 v49, v50, v51
v_cvt_pk_bf16_f32 v50, v52, v53
v_cvt_pk_bf16_f32 v51, v54, v55
s_nop 1
v_permlane16_swap_b32 v48, v50
v_permlane16_swap_b32 v49, v51
buffer_store_dwordx4 v[48:51], v17, s[80:83], s31 offen offset:64 sc1
L_end:
s_endpgm
L_att_fallback:
s_waitcnt vmcnt(0)
s_mov_b32 s33, 1
s_mul_i32 s32, s5, 0x10c400
s_lshl_b32 s19, s4, 13
s_add_u32 s32, s32, s19
s_cmp_eq_u32 s4, 0
s_cselect_b32 s94, 0x200000, 0
s_add_u32 s32, s32, s94
s_sub_u32 s94, 0x8000, s94
s_add_u32 s7, s32, 0x1000
s_add_u32 s27, s19, 131072
v_and_b32 v5, 15, v0
v_lshrrev_b32 v6, 4, v0
v_lshlrev_b32 v6, 2, v6
v_sub_u32 v5, v5, v6
v_mov_b32 v9, 0xf149f2ca
s_lshr_b32 s8, s20, 11
v_add_u32 v96, s8, v5
v_mov_b32 v80, v9
s_lshr_b32 s8, s21, 11
v_add_u32 v97, s8, v5
v_mov_b32 v84, v9
s_lshr_b32 s8, s22, 11
v_add_u32 v98, s8, v5
v_mov_b32 v88, v9
s_lshr_b32 s8, s23, 11
v_add_u32 v99, s8, v5
v_mov_b32 v92, v9
s_sub_u32 s15, 16, s6
s_lshl_b32 s15, s15, 1
L_fb_loop:
s_waitcnt lgkmcnt(0)
s_barrier
s_add_u32 m0, s19, 0x0
s_nop 0
buffer_load_dwordx4 v3, s[48:51], s32 offen offset:0 sc1 lds
buffer_load_dwordx4 v3, s[48:51], s32 offen offset:1024 sc1 lds
buffer_load_dwordx4 v3, s[48:51], s32 offen offset:2048 sc1 lds
buffer_load_dwordx4 v3, s[48:51], s32 offen offset:3072 sc1 lds
s_add_u32 m0, s19, 0x1000
s_nop 0
buffer_load_dwordx4 v3, s[48:51], s7 offen offset:0 sc1 lds
buffer_load_dwordx4 v3, s[48:51], s7 offen offset:1024 sc1 lds
buffer_load_dwordx4 v3, s[48:51], s7 offen offset:2048 sc1 lds
buffer_load_dwordx4 v3, s[48:51], s7 offen offset:3072 sc1 lds
s_add_u32 s32, s32, s94
s_add_u32 s7, s7, s94
s_mov_b32 s94, 0x8000
s_waitcnt vmcnt(0)
s_barrier
ds_read_b128 a[0:3], v3 offset:8192
ds_read_b128 a[4:7], v3 offset:9216
ds_read_b128 a[8:11], v3 offset:10240
ds_read_b128 a[12:15], v3 offset:11264
ds_read_b128 a[16:19], v3 offset:12288
ds_read_b128 a[20:23], v3 offset:13312
ds_read_b128 a[24:27], v3 offset:14336
ds_read_b128 a[28:31], v3 offset:15360
s_waitcnt lgkmcnt(0)
v_mfma_f32_16x16x32_bf16 v[16:19], a[0:3], a[160:163], 0
v_mfma_f32_16x16x32_bf16 v[16:19], a[4:7], a[164:167], v[16:19]
v_mfma_f32_16x16x32_bf16 v[16:19], a[8:11], a[168:171], v[16:19]
v_mfma_f32_16x16x32_bf16 v[16:19], a[12:15], a[172:175], v[16:19]
v_mfma_f32_16x16x32_bf16 v[20:23], a[0:3], a[176:179], 0
v_mfma_f32_16x16x32_bf16 v[20:23], a[4:7], a[180:183], v[20:23]
v_mfma_f32_16x16x32_bf16 v[20:23], a[8:11], a[184:187], v[20:23]
v_mfma_f32_16x16x32_bf16 v[20:23], a[12:15], a[188:191], v[20:23]
v_mfma_f32_16x16x32_bf16 v[24:27], a[0:3], a[192:195], 0
v_mfma_f32_16x16x32_bf16 v[24:27], a[4:7], a[196:199], v[24:27]
v_mfma_f32_16x16x32_bf16 v[24:27], a[8:11], a[200:203], v[24:27]
v_mfma_f32_16x16x32_bf16 v[24:27], a[12:15], a[204:207], v[24:27]
v_mfma_f32_16x16x32_bf16 v[28:31], a[0:3], a[208:211], 0
v_mfma_f32_16x16x32_bf16 v[28:31], a[4:7], a[212:215], v[28:31]
v_mfma_f32_16x16x32_bf16 v[28:31], a[8:11], a[216:219], v[28:31]
v_mfma_f32_16x16x32_bf16 v[28:31], a[12:15], a[220:223], v[28:31]
v_mfma_f32_16x16x32_bf16 v[32:35], a[16:19], a[160:163], 0
v_mfma_f32_16x16x32_bf16 v[32:35], a[20:23], a[164:167], v[32:35]
v_mfma_f32_16x16x32_bf16 v[32:35], a[24:27], a[168:171], v[32:35]
v_mfma_f32_16x16x32_bf16 v[32:35], a[28:31], a[172:175], v[32:35]
v_mfma_f32_16x16x32_bf16 v[36:39], a[16:19], a[176:179], 0
v_mfma_f32_16x16x32_bf16 v[36:39], a[20:23], a[180:183], v[36:39]
v_mfma_f32_16x16x32_bf16 v[36:39], a[24:27], a[184:187], v[36:39]
v_mfma_f32_16x16x32_bf16 v[36:39], a[28:31], a[188:191], v[36:39]
v_mfma_f32_16x16x32_bf16 v[40:43], a[16:19], a[192:195], 0
v_mfma_f32_16x16x32_bf16 v[40:43], a[20:23], a[196:199], v[40:43]
v_mfma_f32_16x16x32_bf16 v[40:43], a[24:27], a[200:203], v[40:43]
v_mfma_f32_16x16x32_bf16 v[40:43], a[28:31], a[204:207], v[40:43]
v_mfma_f32_16x16x32_bf16 v[44:47], a[16:19], a[208:211], 0
v_mfma_f32_16x16x32_bf16 v[44:47], a[20:23], a[212:215], v[44:47]
v_mfma_f32_16x16x32_bf16 v[44:47], a[24:27], a[216:219], v[44:47]
v_mfma_f32_16x16x32_bf16 v[44:47], a[28:31], a[220:223], v[44:47]
s_nop 7
v_cmp_le_i32 s[36:37], 0, v96
v_cmp_le_i32 s[38:39], 1, v96
v_cmp_le_i32 s[40:41], 2, v96
v_cmp_le_i32 s[42:43], 3, v96
s_nop 1
v_cndmask_b32 v16, v9, v16, s[36:37]
v_cndmask_b32 v17, v9, v17, s[38:39]
v_cndmask_b32 v18, v9, v18, s[40:41]
v_cndmask_b32 v19, v9, v19, s[42:43]
v_max3_f32 v80, v80, v16, v17
v_max3_f32 v80, v80, v18, v19
v_cmp_le_i32 s[36:37], 0, v97
v_cmp_le_i32 s[38:39], 1, v97
v_cmp_le_i32 s[40:41], 2, v97
v_cmp_le_i32 s[42:43], 3, v97
s_nop 1
v_cndmask_b32 v20, v9, v20, s[36:37]
v_cndmask_b32 v21, v9, v21, s[38:39]
v_cndmask_b32 v22, v9, v22, s[40:41]
v_cndmask_b32 v23, v9, v23, s[42:43]
v_max3_f32 v84, v84, v20, v21
v_max3_f32 v84, v84, v22, v23
v_cmp_le_i32 s[36:37], 0, v98
v_cmp_le_i32 s[38:39], 1, v98
v_cmp_le_i32 s[40:41], 2, v98
v_cmp_le_i32 s[42:43], 3, v98
s_nop 1
v_cndmask_b32 v24, v9, v24, s[36:37]
v_cndmask_b32 v25, v9, v25, s[38:39]
v_cndmask_b32 v26, v9, v26, s[40:41]
v_cndmask_b32 v27, v9, v27, s[42:43]
v_max3_f32 v88, v88, v24, v25
v_max3_f32 v88, v88, v26, v27
v_cmp_le_i32 s[36:37], 0, v99
v_cmp_le_i32 s[38:39], 1, v99
v_cmp_le_i32 s[40:41], 2, v99
v_cmp_le_i32 s[42:43], 3, v99
s_nop 1
v_cndmask_b32 v28, v9, v28, s[36:37]
v_cndmask_b32 v29, v9, v29, s[38:39]
v_cndmask_b32 v30, v9, v30, s[40:41]
v_cndmask_b32 v31, v9, v31, s[42:43]
v_max3_f32 v92, v92, v28, v29
v_max3_f32 v92, v92, v30, v31
v_cmp_le_i32 s[36:37], 16, v96
v_cmp_le_i32 s[38:39], 17, v96
v_cmp_le_i32 s[40:41], 18, v96
v_cmp_le_i32 s[42:43], 19, v96
s_nop 1
v_cndmask_b32 v32, v9, v32, s[36:37]
v_cndmask_b32 v33, v9, v33, s[38:39]
v_cndmask_b32 v34, v9, v34, s[40:41]
v_cndmask_b32 v35, v9, v35, s[42:43]
v_max3_f32 v80, v80, v32, v33
v_max3_f32 v80, v80, v34, v35
v_cmp_le_i32 s[36:37], 16, v97
v_cmp_le_i32 s[38:39], 17, v97
v_cmp_le_i32 s[40:41], 18, v97
v_cmp_le_i32 s[42:43], 19, v97
s_nop 1
v_cndmask_b32 v36, v9, v36, s[36:37]
v_cndmask_b32 v37, v9, v37, s[38:39]
v_cndmask_b32 v38, v9, v38, s[40:41]
v_cndmask_b32 v39, v9, v39, s[42:43]
v_max3_f32 v84, v84, v36, v37
v_max3_f32 v84, v84, v38, v39
v_cmp_le_i32 s[36:37], 16, v98
v_cmp_le_i32 s[38:39], 17, v98
v_cmp_le_i32 s[40:41], 18, v98
v_cmp_le_i32 s[42:43], 19, v98
s_nop 1
v_cndmask_b32 v40, v9, v40, s[36:37]
v_cndmask_b32 v41, v9, v41, s[38:39]
v_cndmask_b32 v42, v9, v42, s[40:41]
v_cndmask_b32 v43, v9, v43, s[42:43]
v_max3_f32 v88, v88, v40, v41
v_max3_f32 v88, v88, v42, v43
v_cmp_le_i32 s[36:37], 16, v99
v_cmp_le_i32 s[38:39], 17, v99
v_cmp_le_i32 s[40:41], 18, v99
v_cmp_le_i32 s[42:43], 19, v99
s_nop 1
v_cndmask_b32 v44, v9, v44, s[36:37]
v_cndmask_b32 v45, v9, v45, s[38:39]
v_cndmask_b32 v46, v9, v46, s[40:41]
v_cndmask_b32 v47, v9, v47, s[42:43]
v_max3_f32 v92, v92, v44, v45
v_max3_f32 v92, v92, v46, v47
ds_read_b128 a[0:3], v3 offset:24576
ds_read_b128 a[4:7], v3 offset:25600
ds_read_b128 a[8:11], v3 offset:26624
ds_read_b128 a[12:15], v3 offset:27648
ds_read_b128 a[16:19], v3 offset:28672
ds_read_b128 a[20:23], v3 offset:29696
ds_read_b128 a[24:27], v3 offset:30720
ds_read_b128 a[28:31], v3 offset:31744
s_waitcnt lgkmcnt(0)
v_mfma_f32_16x16x32_bf16 v[16:19], a[0:3], a[160:163], 0
v_mfma_f32_16x16x32_bf16 v[16:19], a[4:7], a[164:167], v[16:19]
v_mfma_f32_16x16x32_bf16 v[16:19], a[8:11], a[168:171], v[16:19]
v_mfma_f32_16x16x32_bf16 v[16:19], a[12:15], a[172:175], v[16:19]
v_mfma_f32_16x16x32_bf16 v[20:23], a[0:3], a[176:179], 0
v_mfma_f32_16x16x32_bf16 v[20:23], a[4:7], a[180:183], v[20:23]
v_mfma_f32_16x16x32_bf16 v[20:23], a[8:11], a[184:187], v[20:23]
v_mfma_f32_16x16x32_bf16 v[20:23], a[12:15], a[188:191], v[20:23]
v_mfma_f32_16x16x32_bf16 v[24:27], a[0:3], a[192:195], 0
v_mfma_f32_16x16x32_bf16 v[24:27], a[4:7], a[196:199], v[24:27]
v_mfma_f32_16x16x32_bf16 v[24:27], a[8:11], a[200:203], v[24:27]
v_mfma_f32_16x16x32_bf16 v[24:27], a[12:15], a[204:207], v[24:27]
v_mfma_f32_16x16x32_bf16 v[28:31], a[0:3], a[208:211], 0
v_mfma_f32_16x16x32_bf16 v[28:31], a[4:7], a[212:215], v[28:31]
v_mfma_f32_16x16x32_bf16 v[28:31], a[8:11], a[216:219], v[28:31]
v_mfma_f32_16x16x32_bf16 v[28:31], a[12:15], a[220:223], v[28:31]
v_mfma_f32_16x16x32_bf16 v[32:35], a[16:19], a[160:163], 0
v_mfma_f32_16x16x32_bf16 v[32:35], a[20:23], a[164:167], v[32:35]
v_mfma_f32_16x16x32_bf16 v[32:35], a[24:27], a[168:171], v[32:35]
v_mfma_f32_16x16x32_bf16 v[32:35], a[28:31], a[172:175], v[32:35]
v_mfma_f32_16x16x32_bf16 v[36:39], a[16:19], a[176:179], 0
v_mfma_f32_16x16x32_bf16 v[36:39], a[20:23], a[180:183], v[36:39]
v_mfma_f32_16x16x32_bf16 v[36:39], a[24:27], a[184:187], v[36:39]
v_mfma_f32_16x16x32_bf16 v[36:39], a[28:31], a[188:191], v[36:39]
v_mfma_f32_16x16x32_bf16 v[40:43], a[16:19], a[192:195], 0
v_mfma_f32_16x16x32_bf16 v[40:43], a[20:23], a[196:199], v[40:43]
v_mfma_f32_16x16x32_bf16 v[40:43], a[24:27], a[200:203], v[40:43]
v_mfma_f32_16x16x32_bf16 v[40:43], a[28:31], a[204:207], v[40:43]
v_mfma_f32_16x16x32_bf16 v[44:47], a[16:19], a[208:211], 0
v_mfma_f32_16x16x32_bf16 v[44:47], a[20:23], a[212:215], v[44:47]
v_mfma_f32_16x16x32_bf16 v[44:47], a[24:27], a[216:219], v[44:47]
v_mfma_f32_16x16x32_bf16 v[44:47], a[28:31], a[220:223], v[44:47]
s_nop 7
v_cmp_le_i32 s[36:37], 32, v96
v_cmp_le_i32 s[38:39], 33, v96
v_cmp_le_i32 s[40:41], 34, v96
v_cmp_le_i32 s[42:43], 35, v96
s_nop 1
v_cndmask_b32 v16, v9, v16, s[36:37]
v_cndmask_b32 v17, v9, v17, s[38:39]
v_cndmask_b32 v18, v9, v18, s[40:41]
v_cndmask_b32 v19, v9, v19, s[42:43]
v_max3_f32 v80, v80, v16, v17
v_max3_f32 v80, v80, v18, v19
v_cmp_le_i32 s[36:37], 32, v97
v_cmp_le_i32 s[38:39], 33, v97
v_cmp_le_i32 s[40:41], 34, v97
v_cmp_le_i32 s[42:43], 35, v97
s_nop 1
v_cndmask_b32 v20, v9, v20, s[36:37]
v_cndmask_b32 v21, v9, v21, s[38:39]
v_cndmask_b32 v22, v9, v22, s[40:41]
v_cndmask_b32 v23, v9, v23, s[42:43]
v_max3_f32 v84, v84, v20, v21
v_max3_f32 v84, v84, v22, v23
v_cmp_le_i32 s[36:37], 32, v98
v_cmp_le_i32 s[38:39], 33, v98
v_cmp_le_i32 s[40:41], 34, v98
v_cmp_le_i32 s[42:43], 35, v98
s_nop 1
v_cndmask_b32 v24, v9, v24, s[36:37]
v_cndmask_b32 v25, v9, v25, s[38:39]
v_cndmask_b32 v26, v9, v26, s[40:41]
v_cndmask_b32 v27, v9, v27, s[42:43]
v_max3_f32 v88, v88, v24, v25
v_max3_f32 v88, v88, v26, v27
v_cmp_le_i32 s[36:37], 32, v99
v_cmp_le_i32 s[38:39], 33, v99
v_cmp_le_i32 s[40:41], 34, v99
v_cmp_le_i32 s[42:43], 35, v99
s_nop 1
v_cndmask_b32 v28, v9, v28, s[36:37]
v_cndmask_b32 v29, v9, v29, s[38:39]
v_cndmask_b32 v30, v9, v30, s[40:41]
v_cndmask_b32 v31, v9, v31, s[42:43]
v_max3_f32 v92, v92, v28, v29
v_max3_f32 v92, v92, v30, v31
v_cmp_le_i32 s[36:37], 48, v96
v_cmp_le_i32 s[38:39], 49, v96
v_cmp_le_i32 s[40:41], 50, v96
v_cmp_le_i32 s[42:43], 51, v96
s_nop 1
v_cndmask_b32 v32, v9, v32, s[36:37]
v_cndmask_b32 v33, v9, v33, s[38:39]
v_cndmask_b32 v34, v9, v34, s[40:41]
v_cndmask_b32 v35, v9, v35, s[42:43]
v_max3_f32 v80, v80, v32, v33
v_max3_f32 v80, v80, v34, v35
v_cmp_le_i32 s[36:37], 48, v97
v_cmp_le_i32 s[38:39], 49, v97
v_cmp_le_i32 s[40:41], 50, v97
v_cmp_le_i32 s[42:43], 51, v97
s_nop 1
v_cndmask_b32 v36, v9, v36, s[36:37]
v_cndmask_b32 v37, v9, v37, s[38:39]
v_cndmask_b32 v38, v9, v38, s[40:41]
v_cndmask_b32 v39, v9, v39, s[42:43]
v_max3_f32 v84, v84, v36, v37
v_max3_f32 v84, v84, v38, v39
v_cmp_le_i32 s[36:37], 48, v98
v_cmp_le_i32 s[38:39], 49, v98
v_cmp_le_i32 s[40:41], 50, v98
v_cmp_le_i32 s[42:43], 51, v98
s_nop 1
v_cndmask_b32 v40, v9, v40, s[36:37]
v_cndmask_b32 v41, v9, v41, s[38:39]
v_cndmask_b32 v42, v9, v42, s[40:41]
v_cndmask_b32 v43, v9, v43, s[42:43]
v_max3_f32 v88, v88, v40, v41
v_max3_f32 v88, v88, v42, v43
v_cmp_le_i32 s[36:37], 48, v99
v_cmp_le_i32 s[38:39], 49, v99
v_cmp_le_i32 s[40:41], 50, v99
v_cmp_le_i32 s[42:43], 51, v99
s_nop 1
v_cndmask_b32 v44, v9, v44, s[36:37]
v_cndmask_b32 v45, v9, v45, s[38:39]
v_cndmask_b32 v46, v9, v46, s[40:41]
v_cndmask_b32 v47, v9, v47, s[42:43]
v_max3_f32 v92, v92, v44, v45
v_max3_f32 v92, v92, v46, v47
v_subrev_u32 v96, 64, v96
v_subrev_u32 v97, 64, v97
v_subrev_u32 v98, 64, v98
v_subrev_u32 v99, 64, v99
s_sub_u32 s15, s15, 1
s_cmp_lg_u32 s15, 0
s_cbranch_scc1 L_fb_loop
v_mov_b32 v16, v80
v_mov_b32 v20, v84
v_mov_b32 v24, v88
v_mov_b32 v28, v92
v_permlane16_swap_b32 v16, v80
v_permlane16_swap_b32 v20, v84
v_permlane16_swap_b32 v24, v88
v_permlane16_swap_b32 v28, v92
v_max_f32 v80, v80, v16
v_max_f32 v84, v84, v20
v_max_f32 v88, v88, v24
v_max_f32 v92, v92, v28
v_mov_b32 v16, v80
v_mov_b32 v20, v84
v_mov_b32 v24, v88
v_mov_b32 v28, v92
v_permlane32_swap_b32 v16, v80
v_permlane32_swap_b32 v20, v84
v_permlane32_swap_b32 v24, v88
v_permlane32_swap_b32 v28, v92
v_max_f32 v80, v80, v16
v_max_f32 v84, v84, v20
v_max_f32 v88, v88, v24
v_max_f32 v92, v92, v28
s_barrier
s_mul_i32 s32, s5, 0x10c400
s_lshl_b32 s19, s4, 13
s_add_u32 s32, s32, s19
s_cmp_eq_u32 s4, 0
s_cselect_b32 s94, 0x200000, 0
s_add_u32 s32, s32, s94
s_sub_u32 s94, 0x8000, s94
s_add_u32 s7, s32, 0x1000
s_add_u32 s27, s19, 131072
s_add_u32 m0, s19, 0x0
s_nop 0
buffer_load_dwordx4 v3, s[48:51], s32 offen offset:0 sc1 lds
buffer_load_dwordx4 v3, s[48:51], s32 offen offset:1024 sc1 lds
buffer_load_dwordx4 v3, s[48:51], s32 offen offset:2048 sc1 lds
buffer_load_dwordx4 v3, s[48:51], s32 offen offset:3072 sc1 lds
s_add_u32 m0, s19, 0x1000
s_nop 0
buffer_load_dwordx4 v3, s[48:51], s7 offen offset:0 sc1 lds
buffer_load_dwordx4 v3, s[48:51], s7 offen offset:1024 sc1 lds
buffer_load_dwordx4 v3, s[48:51], s7 offen offset:2048 sc1 lds
buffer_load_dwordx4 v3, s[48:51], s7 offen offset:3072 sc1 lds
s_add_u32 s32, s32, s94
s_add_u32 s7, s7, s94
s_add_u32 m0, s19, 0x18000
s_nop 0
buffer_load_dwordx4 v3, s[48:51], s32 offen offset:0 sc1 lds
buffer_load_dwordx4 v3, s[48:51], s32 offen offset:1024 sc1 lds
buffer_load_dwordx4 v3, s[48:51], s32 offen offset:2048 sc1 lds
buffer_load_dwordx4 v3, s[48:51], s32 offen offset:3072 sc1 lds
s_add_u32 m0, s19, 0x19000
s_nop 0
buffer_load_dwordx4 v3, s[48:51], s7 offen offset:0 sc1 lds
buffer_load_dwordx4 v3, s[48:51], s7 offen offset:1024 sc1 lds
buffer_load_dwordx4 v3, s[48:51], s7 offen offset:2048 sc1 lds
buffer_load_dwordx4 v3, s[48:51], s7 offen offset:3072 sc1 lds
s_add_u32 s32, s32, 0x8000
s_add_u32 s7, s7, 0x8000
s_add_u32 m0, s19, 0x8000
s_nop 0
buffer_load_dwordx4 v3, s[48:51], s32 offen offset:0 sc1 lds
buffer_load_dwordx4 v3, s[48:51], s32 offen offset:1024 sc1 lds
buffer_load_dwordx4 v3, s[48:51], s32 offen offset:2048 sc1 lds
buffer_load_dwordx4 v3, s[48:51], s32 offen offset:3072 sc1 lds
s_add_u32 m0, s19, 0x9000
s_nop 0
buffer_load_dwordx4 v3, s[48:51], s7 offen offset:0 sc1 lds
buffer_load_dwordx4 v3, s[48:51], s7 offen offset:1024 sc1 lds
buffer_load_dwordx4 v3, s[48:51], s7 offen offset:2048 sc1 lds
buffer_load_dwordx4 v3, s[48:51], s7 offen offset:3072 sc1 lds
s_add_u32 s32, s32, 0x8000
s_add_u32 s7, s7, 0x8000
s_bfe_u32 s99, s2, 0x20001
s_lshl_b32 s99, s99, 2
s_lshr_b32 s8, s2, 6
s_add_u32 s99, s99, s8
s_bfe_u32 s100, s2, 0x30003
s_and_b32 s14, s2, 1
s_sub_u32 s24, 15, s99
s_min_u32 s18, s24, s99
s_lshl_b32 s24, s18, 1
s_add_u32 s24, s24, s14
s_lshl_b32 s24, s24, 8
s_add_u32 s24, s24, 0x3704000
s_mov_b32 s12, 14336
s_and_b32 s16, s6, 1
s_lshl_b32 s16, s16, 15
s_add_u32 s16, s16, 98304
s_add_u32 s16, s16, s17
s_lshl_b32 s13, s4, 15
s_lshl_b32 s9, s100, 8
s_add_u32 s13, s13, s9
s_mul_i32 s9, s14, 1310848
s_add_u32 s13, s13, s9
s_mul_i32 s25, s14, 3407872
s_sub_u32 s25, s25, 1179648
s_mul_i32 s101, s99, 0x142400
s_lshl_b32 s8, s4, 11
s_add_u32 s101, s101, s8
s_mul_i32 s8, s14, 163840
s_add_u32 s101, s101, s8
s_add_u32 s101, s101, 0x21fe000
s_mul_i32 s26, s14, 425984
s_add_u32 s26, s26, 106496
v_mov_b32 v15, s6
v_xor_b32 v15, 0, v15
v_writelane_b32 v15, s18, 0
v_lshlrev_b32 v15, 2, v15
v_bfe_u32 v12, v0, 2, 2
v_lshlrev_b32 v12, 11, v12
v_lshrrev_b32 v13, 4, v0
v_lshl_add_u32 v12, v13, 6, v12
v_and_b32 v13, 3, v0
v_lshl_add_u32 v12, v13, 4, v12
v_xor_b32 v12, s13, v12
v_xor_b32 v13, 32, v12
v_add_u32 v13, 7168, v13
s_mov_b32 s11, 0xf149f2ca
s_mov_b32 s36, 0xfff0ffff
s_mov_b32 s37, 0xf000ff00
s_mov_b32 s38, 0xffe0fffe
s_mov_b32 s39, 0xe000fe00
s_mov_b32 s40, 0xffc0fffc
s_mov_b32 s41, 0xc000fc00
s_mov_b32 s42, 0xff80fff8
s_mov_b32 s43, 0x8000f800
s_bitcmp1_b32 s4, 0
s_cselect_b32 s8, 0x7f800000, s11
s_cselect_b32 s9, s11, 0x7f800000
v_mov_b32 v1, v3
v_add_u32 v2, 98304, v3
s_mov_b64 s[34:35], 0
v_accvgpr_write_b32 a224, 0
v_accvgpr_write_b32 a225, 0
v_accvgpr_write_b32 a226, 0
v_accvgpr_write_b32 a227, 0
v_accvgpr_write_b32 a228, 0
v_accvgpr_write_b32 a229, 0
v_accvgpr_write_b32 a230, 0
v_accvgpr_write_b32 a231, 0
v_sub_f32 v83, 0, v80
v_sub_f32 v82, 0, v80
v_sub_f32 v81, 0, v80
v_sub_f32 v80, 0, v80
v_min_f32 v103, s8, v80
v_cndmask_b32 v96, v103, v80, s[36:37]
v_cndmask_b32 v97, v103, v80, s[38:39]
v_cndmask_b32 v98, v103, v80, s[40:41]
v_cndmask_b32 v99, v103, v80, s[42:43]
v_cndmask_b32 v100, v9, v103, s[36:37]
v_cndmask_b32 v101, v9, v103, s[38:39]
v_cndmask_b32 v102, v9, v103, s[40:41]
v_cndmask_b32 v103, v9, v103, s[42:43]
v_sub_f32 v87, 0, v84
v_sub_f32 v86, 0, v84
v_sub_f32 v85, 0, v84
v_sub_f32 v84, 0, v84
v_min_f32 v111, s9, v84
v_cndmask_b32 v104, v111, v84, s[36:37]
v_cndmask_b32 v105, v111, v84, s[38:39]
v_cndmask_b32 v106, v111, v84, s[40:41]
v_cndmask_b32 v107, v111, v84, s[42:43]
v_cndmask_b32 v108, v9, v111, s[36:37]
v_cndmask_b32 v109, v9, v111, s[38:39]
v_cndmask_b32 v110, v9, v111, s[40:41]
v_cndmask_b32 v111, v9, v111, s[42:43]
v_sub_f32 v91, 0, v88
v_sub_f32 v90, 0, v88
v_sub_f32 v89, 0, v88
v_sub_f32 v88, 0, v88
v_min_f32 v119, s8, v88
v_cndmask_b32 v112, v119, v88, s[36:37]
v_cndmask_b32 v113, v119, v88, s[38:39]
v_cndmask_b32 v114, v119, v88, s[40:41]
v_cndmask_b32 v115, v119, v88, s[42:43]
v_cndmask_b32 v116, v9, v119, s[36:37]
v_cndmask_b32 v117, v9, v119, s[38:39]
v_cndmask_b32 v118, v9, v119, s[40:41]
v_cndmask_b32 v119, v9, v119, s[42:43]
v_sub_f32 v95, 0, v92
v_sub_f32 v94, 0, v92
v_sub_f32 v93, 0, v92
v_sub_f32 v92, 0, v92
v_min_f32 v127, s9, v92
v_cndmask_b32 v120, v127, v92, s[36:37]
v_cndmask_b32 v121, v127, v92, s[38:39]
v_cndmask_b32 v122, v127, v92, s[40:41]
v_cndmask_b32 v123, v127, v92, s[42:43]
v_cndmask_b32 v124, v9, v127, s[36:37]
v_cndmask_b32 v125, v9, v127, s[38:39]
v_cndmask_b32 v126, v9, v127, s[40:41]
v_cndmask_b32 v127, v9, v127, s[42:43]
v_and_b32 v9, 1, v0
v_mul_u32_u24 v9, 0xaaaa, v9
v_add_u32 v9, 0x4444, v9
v_mov_b32 v128, 0
v_mov_b32 v129, 0
v_mov_b32 v130, 0
v_mov_b32 v131, 0
v_mov_b32 v132, 0
v_mov_b32 v133, 0
v_mov_b32 v134, 0
v_mov_b32 v135, 0
v_mov_b32 v136, 0
v_mov_b32 v137, 0
v_mov_b32 v138, 0
v_mov_b32 v139, 0
v_mov_b32 v140, 0
v_mov_b32 v141, 0
v_mov_b32 v142, 0
v_mov_b32 v143, 0
v_mov_b32 v144, 0
v_mov_b32 v145, 0
v_mov_b32 v146, 0
v_mov_b32 v147, 0
v_mov_b32 v148, 0
v_mov_b32 v149, 0
v_mov_b32 v150, 0
v_mov_b32 v151, 0
v_mov_b32 v152, 0
v_mov_b32 v153, 0
v_mov_b32 v154, 0
v_mov_b32 v155, 0
v_mov_b32 v156, 0
v_mov_b32 v157, 0
v_mov_b32 v158, 0
v_mov_b32 v159, 0
v_mov_b32 v160, 0
v_mov_b32 v161, 0
v_mov_b32 v162, 0
v_mov_b32 v163, 0
v_mov_b32 v164, 0
v_mov_b32 v165, 0
v_mov_b32 v166, 0
v_mov_b32 v167, 0
v_mov_b32 v168, 0
v_mov_b32 v169, 0
v_mov_b32 v170, 0
v_mov_b32 v171, 0
v_mov_b32 v172, 0
v_mov_b32 v173, 0
v_mov_b32 v174, 0
v_mov_b32 v175, 0
v_mov_b32 v176, 0
v_mov_b32 v177, 0
v_mov_b32 v178, 0
v_mov_b32 v179, 0
v_mov_b32 v180, 0
v_mov_b32 v181, 0
v_mov_b32 v182, 0
v_mov_b32 v183, 0
v_mov_b32 v184, 0
v_mov_b32 v185, 0
v_mov_b32 v186, 0
v_mov_b32 v187, 0
v_mov_b32 v188, 0
v_mov_b32 v189, 0
v_mov_b32 v190, 0
v_mov_b32 v191, 0
v_mov_b32 v192, 0
v_mov_b32 v193, 0
v_mov_b32 v194, 0
v_mov_b32 v195, 0
v_mov_b32 v196, 0
v_mov_b32 v197, 0
v_mov_b32 v198, 0
v_mov_b32 v199, 0
v_mov_b32 v200, 0
v_mov_b32 v201, 0
v_mov_b32 v202, 0
v_mov_b32 v203, 0
v_mov_b32 v204, 0
v_mov_b32 v205, 0
v_mov_b32 v206, 0
v_mov_b32 v207, 0
v_mov_b32 v208, 0
v_mov_b32 v209, 0
v_mov_b32 v210, 0
v_mov_b32 v211, 0
v_mov_b32 v212, 0
v_mov_b32 v213, 0
v_mov_b32 v214, 0
v_mov_b32 v215, 0
v_mov_b32 v216, 0
v_mov_b32 v217, 0
v_mov_b32 v218, 0
v_mov_b32 v219, 0
v_mov_b32 v220, 0
v_mov_b32 v221, 0
v_mov_b32 v222, 0
v_mov_b32 v223, 0
v_mov_b32 v224, 0
v_mov_b32 v225, 0
v_mov_b32 v226, 0
v_mov_b32 v227, 0
v_mov_b32 v228, 0
v_mov_b32 v229, 0
v_mov_b32 v230, 0
v_mov_b32 v231, 0
v_mov_b32 v232, 0
v_mov_b32 v233, 0
v_mov_b32 v234, 0
v_mov_b32 v235, 0
v_mov_b32 v236, 0
v_mov_b32 v237, 0
v_mov_b32 v238, 0
v_mov_b32 v239, 0
v_mov_b32 v240, 0
v_mov_b32 v241, 0
v_mov_b32 v242, 0
v_mov_b32 v243, 0
v_mov_b32 v244, 0
v_mov_b32 v245, 0
v_mov_b32 v246, 0
v_mov_b32 v247, 0
v_mov_b32 v248, 0
v_mov_b32 v249, 0
v_mov_b32 v250, 0
v_mov_b32 v251, 0
v_mov_b32 v252, 0
v_mov_b32 v253, 0
v_mov_b32 v254, 0
v_mov_b32 v255, 0
s_waitcnt vmcnt(16)
s_barrier
ds_read_b128 a[0:3], v1 offset:8192
ds_read_b128 a[4:7], v1 offset:9216
ds_read_b128 a[8:11], v1 offset:10240
ds_read_b128 a[12:15], v1 offset:11264
ds_read_b128 a[16:19], v1 offset:12288
ds_read_b128 a[20:23], v1 offset:13312
ds_read_b128 a[24:27], v1 offset:14336
ds_read_b128 a[28:31], v1 offset:15360
s_waitcnt lgkmcnt(0)
s_branch L_att_start
.section .rodata,"a"
.p2align 6
.amdhsa_kernel gated_mix__compressed_kv_cla__sliding_local_dilated__prompt_kernel
  .amdhsa_next_free_vgpr 512
  .amdhsa_next_free_sgpr 102
  .amdhsa_accum_offset 256
  .amdhsa_group_segment_fixed_size 0
  .amdhsa_kernarg_size 104
  .amdhsa_user_sgpr_count 2
  .amdhsa_user_sgpr_kernarg_segment_ptr 1
  .amdhsa_system_sgpr_workgroup_id_x 1
.end_amdhsa_kernel
```

```asm
; @launch grid=(256,1,1) block=(256,1,1) lds=163840
.amdgcn_target "amdgcn-amd-amdhsa--gfx950"
.text
.globl gated_mix__compressed_kv_cla__sliding_local_dilated__prompt_kernel
.p2align 8
.type gated_mix__compressed_kv_cla__sliding_local_dilated__prompt_kernel,@function
gated_mix__compressed_kv_cla__sliding_local_dilated__prompt_kernel:
s_load_dwordx16 s[16:31], s[0:1], 0
s_load_dwordx8 s[32:39], s[0:1], 64
s_load_dwordx2 s[88:89], s[0:1], 96
s_cmp_ge_u32 s2, 256
s_cbranch_scc1 L_end
v_lshrrev_b32 v1, 6, v0
v_and_b32 v0, 63, v0
v_readfirstlane_b32 s4, v1
v_lshlrev_b32 v16, 4, v0
s_lshr_b32 s8, s2, 3
s_lshl_b32 s8, s8, 2
s_add_u32 s8, s8, s4
s_min_u32 s8, s8, (L_end-L_page0)>>10
s_lshl_b32 s8, s8, 10
s_getpc_b64 s[92:93]
L_here:
s_add_u32 s8, s8, L_page0-L_here
s_add_u32 s92, s92, s8
s_addc_u32 s93, s93, 0
v_add_u32 v60, s92, v16
v_mov_b32 v61, s93
global_load_dword a120, v[60:61], off sc1
s_and_b32 s5, s2, 7
s_lshl_b32 s5, s5, 2
s_lshr_b32 s5, 0x75643120, s5
s_and_b32 s5, s5, 7
s_lshl_b32 s5, s5, 2
s_bfe_u32 s3, s2, 0x20003
s_add_u32 s5, s5, s3
s_lshr_b32 s6, s2, 5
s_mov_b32 s12, 0x4000
s_mov_b32 s13, 0x8000
s_mov_b32 s14, 0xc000
s_mov_b32 s46, 0x400000
s_mov_b32 s47, 0x20000
s_mov_b32 s50, 0x200000
s_mov_b32 s51, 0x20000
s_mov_b32 s54, 0x800000
s_mov_b32 s55, 0x20000
s_mov_b32 s58, 0x400000
s_mov_b32 s59, 0x20000
s_mov_b32 s62, 0x400000
s_mov_b32 s63, 0x20000
s_mov_b32 s66, 0x800000
s_mov_b32 s67, 0x20000
s_mov_b32 s70, 0x600000
s_mov_b32 s71, 0x20000
s_mov_b32 s74, 0x200000
s_mov_b32 s75, 0x20000
s_mov_b32 s78, 0x800
s_mov_b32 s79, 0x20000
s_mov_b32 s82, 0x400000
s_mov_b32 s83, 0x20000
s_mov_b32 s86, 0x100
s_mov_b32 s87, 0x20000
s_mov_b32 s90, 0x10000000
s_mov_b32 s91, 0x20000
v_bfe_u32 v17, v0, 2, 2
s_lshl_b32 s8, s4, 4
v_add_u32 v17, s8, v17
v_lshlrev_b32 v17, 13, v17
v_lshrrev_b32 v18, 4, v0
v_lshl_add_u32 v17, v18, 6, v17
v_and_b32 v18, 3, v0
v_lshl_add_u32 v17, v18, 4, v17
s_lshl_b32 s8, s5, 8
v_add_u32 v5, s8, v17
v_xor_b32 v6, 32, v5
v_add_u32 v6, 0x10000, v6
v_lshrrev_b32 v17, 4, v0
v_xor_b32 v17, v17, v0
v_and_b32 v17, 7, v17
v_lshlrev_b32 v17, 4, v17
v_lshrrev_b32 v18, 3, v0
v_lshl_add_u32 v2, v18, 10, v17
s_lshl_b32 s8, s6, 18
s_lshl_b32 s9, s4, 16
s_add_u32 s8, s8, s9
v_add_u32 v2, s8, v2
v_xor_b32 v3, 64, v2
v_add_u32 v3, 0x2000, v3
s_mov_b32 s41, 0
s_mov_b32 s43, 0
v_lshl_add_u32 v5, s41, 19, v5
v_lshl_add_u32 v6, s41, 19, v6
v_lshl_add_u32 v2, s41, 7, v2
v_lshl_add_u32 v3, s41, 7, v3
s_sub_u32 s10, 15, s6
s_cmp_lt_u32 s5, 16
s_cselect_b32 s10, s6, s10
s_lshl_b32 s10, s10, 4
s_and_b32 s11, s5, 15
s_add_u32 s10, s10, s11
s_lshl_b32 s10, s10, 3
s_lshl_b32 s11, s4, 1
s_add_u32 s10, s10, s11
s_lshl_b32 s100, s10, 11
s_lshl_b32 s101, s10, 2
s_add_u32 s101, s101, 0x3700000
s_lshl_b32 s8, s2, 2
s_add_u32 s8, s8, s4
s_lshl_b32 s8, s8, 11
v_lshrrev_b32 v19, 2, v0
v_lshl_add_u32 v19, v19, 7, s8
s_lshr_b32 s8, s2, 3
s_lshl_b32 s8, s8, 2
s_add_u32 s8, s8, s4
s_lshl_b32 s8, s8, 4
s_lshr_b32 s9, s5, 2
s_add_u32 s8, s8, s9
s_lshl_b32 s8, s8, 10
v_bfe_u32 v63, v0, 2, 3
v_lshl_add_u32 v63, v63, 7, s8
v_lshrrev_b32 v59, 5, v0
v_lshl_add_u32 v63, v59, 13, v63
s_lshr_b32 s8, s8, 14
s_mul_i32 s8, s8, 49152
s_lshl_b32 s9, s9, 8
s_add_u32 s8, s8, s9
v_lshrrev_b32 v59, 3, v0
v_mul_u32_u24 v59, 0x1800, v59
v_and_b32 v1, 4, v0
v_lshl_add_u32 v1, v1, 5, v59
v_add_u32 v1, s8, v1
v_mov_b32 v62, v19
s_waitcnt lgkmcnt(0)
s_mov_b64 s[48:49], s[18:19]
s_mov_b64 s[56:57], s[22:23]
s_mov_b64 s[60:61], s[24:25]
L_args:
s_mov_b64 s[0:1], s[92:93]
s_mov_b64 s[44:45], s[16:17]
s_mov_b64 s[76:77], s[34:35]
s_mov_b64 s[52:53], s[20:21]
s_mov_b64 s[64:65], s[26:27]
s_mov_b64 s[68:69], s[30:31]
s_mov_b64 s[72:73], s[32:33]
s_mov_b64 s[80:81], s[36:37]
s_mov_b64 s[84:85], s[38:39]
s_lshl_b32 s16, s4, 13
s_add_u32 s16, s16, 0x18000
s_lshl_b32 s17, s4, 12
s_lshl_b32 s18, s4, 10
s_mov_b32 s25, 0x800
s_mov_b32 s26, 0x1000
s_mov_b32 s3, 0
s_mov_b32 s9, 0x0
s_nop 0
buffer_load_dword a120, v63, s[56:59], s9 offen
s_mov_b32 s9, 0x0
s_nop 0
buffer_load_dword a120, v63, s[60:63], s9 offen
s_add_u32 m0, s17, 0x0
s_nop 0
buffer_load_dwordx4 v5, s[56:59], 0 offen lds
s_add_u32 m0, s17, 0x4000
s_nop 0
buffer_load_dwordx4 v5, s[60:63], 0 offen lds
s_add_u32 m0, s17, 0x400
s_nop 0
buffer_load_dwordx4 v5, s[56:59], s13 offen lds
s_add_u32 m0, s17, 0x4400
s_nop 0
buffer_load_dwordx4 v5, s[60:63], s13 offen lds
s_add_u32 m0, s17, 0x800
s_nop 0
buffer_load_dwordx4 v6, s[56:59], 0 offen lds
s_add_u32 m0, s17, 0x4800
s_nop 0
buffer_load_dwordx4 v6, s[60:63], 0 offen lds
s_add_u32 m0, s17, 0xc00
s_nop 0
buffer_load_dwordx4 v6, s[56:59], s13 offen lds
s_add_u32 m0, s17, 0x4c00
s_nop 0
buffer_load_dwordx4 v6, s[60:63], s13 offen lds
s_mov_b32 s42, 1
s_mov_b32 s41, 7
v_lshl_add_u32 v5, s42, 19, v5
v_lshl_add_u32 v6, s42, 19, v6
s_add_u32 m0, s16, 0x0
s_nop 0
buffer_load_dwordx4 v2, s[48:51], 0 offen lds
s_add_u32 m0, s16, 0x400
s_nop 0
buffer_load_dwordx4 v3, s[48:51], 0 offen lds
s_add_u32 m0, s16, 0x800
s_nop 0
buffer_load_dwordx4 v2, s[48:51], s12 offen lds
s_add_u32 m0, s16, 0xc00
s_nop 0
buffer_load_dwordx4 v3, s[48:51], s12 offen lds
s_add_u32 m0, s16, 0x1000
s_nop 0
buffer_load_dwordx4 v2, s[48:51], s13 offen lds
s_add_u32 m0, s16, 0x1400
s_nop 0
buffer_load_dwordx4 v3, s[48:51], s13 offen lds
s_add_u32 m0, s16, 0x1800
s_nop 0
buffer_load_dwordx4 v2, s[48:51], s14 offen lds
s_add_u32 m0, s16, 0x1c00
s_nop 0
buffer_load_dwordx4 v3, s[48:51], s14 offen lds
v_lshl_add_u32 v2, s42, 7, v2
v_lshl_add_u32 v3, s42, 7, v3
v_lshrrev_b32 v17, 4, v0
v_xor_b32 v17, v17, v0
v_and_b32 v17, 7, v17
v_lshlrev_b32 v17, 4, v17
v_lshrrev_b32 v18, 3, v0
v_lshl_add_u32 v22, v18, 11, v17
v_xor_b32 v23, 64, v22
v_add_u32 v23, 0x4000, v23
s_lshl_b32 s8, s6, 18
s_sub_u32 s9, 15, s6
s_lshl_b32 s9, s9, 18
s_lshl_b32 s10, s4, 15
s_sub_u32 s11, 0x38000, s10
s_add_u32 s20, s8, s10
s_add_u32 s21, s8, s11
s_add_u32 s22, s9, s10
s_add_u32 s23, s9, s11
s_lshl_b32 s10, s5, 15
s_add_u32 s10, s10, 0x3c00000
s_lshr_b32 s8, s8, 7
s_lshr_b32 s9, s9, 7
s_add_u32 s8, s8, s10
s_add_u32 s9, s9, s10
v_add_u32 v10, s8, v16
v_add_u32 v11, s9, v16
s_cmp_lt_u32 s4, 2
s_cselect_b32 s8, s8, s9
s_and_b32 s9, s4, 1
s_lshl_b32 s9, s9, 10
s_add_u32 s8, s8, s9
v_add_u32 v4, s8, v16
v_lshrrev_b32 v17, 2, v0
s_lshl_b32 s8, s4, 4
v_add_u32 v17, s8, v17
v_mul_u32_u24 v17, 0x1800, v17
v_and_b32 v18, 3, v0
v_lshlrev_b32 v18, 4, v18
v_and_b32 v19, 32, v0
v_xor_b32 v18, v18, v19
s_lshl_b32 s8, s5, 6
v_add3_u32 v7, v17, v18, s8
v_lshl_add_u32 v22, s43, 7, v22
v_lshl_add_u32 v23, s43, 7, v23
v_lshl_add_u32 v7, s43, 18, v7
v_lshl_add_u32 v7, s43, 17, v7
v_and_b32 v17, 15, v0
v_lshrrev_b32 v18, 1, v17
v_lshrrev_b32 v19, 4, v0
v_xor_b32 v18, v18, v19
v_lshlrev_b32 v18, 4, v18
v_lshl_add_u32 v8, v17, 7, v18
v_add_u32 v8, s16, v8
v_xor_b32 v9, 64, v8
v_lshrrev_b32 v17, 4, v0
v_lshlrev_b32 v18, 11, v17
v_and_b32 v17, 1, v17
v_lshl_add_u32 v18, v17, 5, v18
v_bfe_u32 v17, v0, 2, 2
v_lshl_add_u32 v18, v17, 6, v18
v_and_b32 v17, 3, v0
v_lshl_add_u32 v12, v17, 3, v18
v_xor_b32 v13, 32, v12
v_lshrrev_b32 v17, 4, v0
v_lshlrev_b32 v18, 9, v17
v_and_b32 v17, 1, v17
v_lshl_add_u32 v18, v17, 5, v18
v_bfe_u32 v17, v0, 2, 2
v_lshl_add_u32 v18, v17, 6, v18
v_and_b32 v17, 3, v0
v_lshl_add_u32 v14, v17, 3, v18
v_accvgpr_write_b32 a64, -1
v_accvgpr_write_b32 a65, -1
v_accvgpr_write_b32 a66, -1
v_accvgpr_write_b32 a67, -1
v_add_u32 v14, 81920, v14
v_xor_b32 v15, 32, v14
s_mul_i32 s32, s5, 0x10c400
s_lshl_b32 s19, s4, 13
s_add_u32 s32, s32, s19
s_cmp_eq_u32 s4, 0
s_cselect_b32 s94, 0x200000, 0
s_add_u32 s32, s32, s94
s_sub_u32 s94, 0x8000, s94
s_add_u32 s7, s32, 0x1000
s_add_u32 s27, s19, 131072
s_add_u32 m0, s16, 0x8000
s_nop 0
buffer_load_dwordx4 v2, s[48:51], 0 offen lds
s_add_u32 m0, s16, 0x8400
s_nop 0
buffer_load_dwordx4 v3, s[48:51], 0 offen lds
s_add_u32 m0, s16, 0x8800
s_nop 0
buffer_load_dwordx4 v2, s[48:51], s12 offen lds
s_add_u32 m0, s16, 0x8c00
s_nop 0
buffer_load_dwordx4 v3, s[48:51], s12 offen lds
s_add_u32 m0, s16, 0x9000
s_nop 0
buffer_load_dwordx4 v2, s[48:51], s13 offen lds
s_add_u32 m0, s16, 0x9400
s_nop 0
buffer_load_dwordx4 v3, s[48:51], s13 offen lds
s_add_u32 m0, s16, 0x9800
s_nop 0
buffer_load_dwordx4 v2, s[48:51], s14 offen lds
s_add_u32 m0, s16, 0x9c00
s_nop 0
buffer_load_dwordx4 v3, s[48:51], s14 offen lds
v_lshl_add_u32 v2, s42, 7, v2
v_lshl_add_u32 v3, s42, 7, v3
s_mov_b32 s9, 0x0
s_nop 0
buffer_load_dword a120, v62, s[48:51], s9 offen
L_hopA:
s_mov_b32 s95, 1
s_cmp_eq_u32 s4, 0
s_cbranch_scc1 L_padA0
s_cmp_eq_u32 s4, 1
s_cbranch_scc1 L_padA1
s_cmp_eq_u32 s4, 2
s_cbranch_scc1 L_padA2
s_branch L_padA3
L_hopA_ret:
s_mov_b32 s95, 0
v_mov_b32 v19, v62
v_mov_b32 v18, v63
s_cmp_lg_u32 s4, 0
s_cbranch_scc1 L_flag_clr
s_lshl_b32 s8, s6, 5
s_add_u32 s8, s8, s5
s_and_b32 s92, s8, 0xf0
s_mul_i32 s92, s92, 3
s_add_u32 s8, s8, s92
s_lshl_b32 s8, s8, 2
s_add_u32 s8, s8, 0x3704000
v_mov_b32 v17, 0
s_mov_b64 exec, 1
buffer_store_dword v17, off, s[88:91], s8 sc1
s_mov_b64 exec, -1
L_flag_clr:
s_waitcnt vmcnt(9)
s_barrier
s_branch L_main
.p2align 12
L_page0:
L_padA0:
s_branch L_padA4
L_main:
ds_read_b64_tr_b16 a[80:81], v12 offset:0
ds_read_b64_tr_b16 a[82:83], v12 offset:1024
ds_read_b64_tr_b16 a[84:85], v12 offset:8192
ds_read_b64_tr_b16 a[86:87], v12 offset:9216
ds_read_b128 a[0:3], v8 offset:0
ds_read_b128 a[16:19], v9 offset:0
ds_read_b128 a[4:7], v8 offset:2048
ds_read_b128 a[20:23], v9 offset:2048
ds_read_b128 a[8:11], v8 offset:4096
ds_read_b128 a[24:27], v9 offset:4096
ds_read_b128 a[12:15], v8 offset:6144
ds_read_b128 a[28:31], v9 offset:6144
ds_read_b64_tr_b16 a[88:89], v13 offset:0
ds_read_b64_tr_b16 a[90:91], v13 offset:1024
ds_read_b64_tr_b16 a[92:93], v13 offset:8192
ds_read_b64_tr_b16 a[94:95], v13 offset:9216
ds_read_b64_tr_b16 a[96:97], v12 offset:256
ds_read_b64_tr_b16 a[98:99], v12 offset:1280
ds_read_b64_tr_b16 a[100:101], v12 offset:8448
ds_read_b64_tr_b16 a[102:103], v12 offset:9472
s_waitcnt lgkmcnt(0)
L_S0:
v_mfma_f32_16x16x32_bf16 v[24:27], a[80:83], a[0:3], 0
ds_read_b64_tr_b16 a[104:105], v13 offset:256
s_add_u32 m0, s17, 0x8000
v_mfma_f32_16x16x32_bf16 v[24:27], a[84:87], a[16:19], v[24:27]
buffer_load_dwordx4 v5, s[56:59], 0 offen lds
v_mfma_f32_16x16x32_bf16 v[32:35], a[84:87], a[20:23], 0
ds_read_b64_tr_b16 a[106:107], v13 offset:1280
v_mfma_f32_16x16x32_bf16 v[32:35], a[80:83], a[4:7], v[32:35]
ds_read_b64_tr_b16 a[108:109], v13 offset:8448
v_mfma_f32_16x16x32_bf16 v[40:43], a[80:83], a[8:11], 0
ds_read_b64_tr_b16 a[110:111], v13 offset:9472
v_mfma_f32_16x16x32_bf16 v[40:43], a[84:87], a[24:27], v[40:43]
s_add_u32 m0, s17, 0xc000
v_mfma_f32_16x16x32_bf16 v[48:51], a[84:87], a[28:31], 0
buffer_load_dwordx4 v5, s[60:63], 0 offen lds
v_mfma_f32_16x16x32_bf16 v[48:51], a[80:83], a[12:15], v[48:51]
v_mfma_f32_16x16x32_bf16 v[52:55], a[88:91], a[12:15], 0
ds_read_b64_tr_b16 a[80:81], v12 offset:512
v_mfma_f32_16x16x32_bf16 v[52:55], a[92:95], a[28:31], v[52:55]
ds_read_b64_tr_b16 a[82:83], v12 offset:1536
v_mfma_f32_16x16x32_bf16 v[44:47], a[92:95], a[24:27], 0
ds_read_b64_tr_b16 a[84:85], v12 offset:8704
s_add_u32 m0, s17, 0x8400
v_mfma_f32_16x16x32_bf16 v[44:47], a[88:91], a[8:11], v[44:47]
buffer_load_dwordx4 v5, s[56:59], s13 offen lds
v_mfma_f32_16x16x32_bf16 v[36:39], a[88:91], a[4:7], 0
ds_read_b64_tr_b16 a[86:87], v12 offset:9728
v_mfma_f32_16x16x32_bf16 v[36:39], a[92:95], a[20:23], v[36:39]
v_mfma_f32_16x16x32_bf16 v[28:31], a[92:95], a[16:19], 0
v_mfma_f32_16x16x32_bf16 v[28:31], a[88:91], a[0:3], v[28:31]
s_add_u32 m0, s17, 0xc400
v_mfma_f32_16x16x32_bf16 v[56:59], a[96:99], a[0:3], 0
buffer_load_dwordx4 v5, s[60:63], s13 offen lds
v_mfma_f32_16x16x32_bf16 v[56:59], a[100:103], a[16:19], v[56:59]
ds_read_b64_tr_b16 a[88:89], v13 offset:512
v_mfma_f32_16x16x32_bf16 v[64:67], a[100:103], a[20:23], 0
ds_read_b64_tr_b16 a[90:91], v13 offset:1536
v_mfma_f32_16x16x32_bf16 v[64:67], a[96:99], a[4:7], v[64:67]
ds_read_b64_tr_b16 a[92:93], v13 offset:8704
v_mfma_f32_16x16x32_bf16 v[72:75], a[96:99], a[8:11], 0
ds_read_b64_tr_b16 a[94:95], v13 offset:9728
s_add_u32 m0, s17, 0x8800
v_mfma_f32_16x16x32_bf16 v[72:75], a[100:103], a[24:27], v[72:75]
buffer_load_dwordx4 v6, s[56:59], 0 offen lds
v_mfma_f32_16x16x32_bf16 v[80:83], a[100:103], a[28:31], 0
v_mfma_f32_16x16x32_bf16 v[80:83], a[96:99], a[12:15], v[80:83]
s_waitcnt lgkmcnt(10)
v_mfma_f32_16x16x32_bf16 v[84:87], a[104:107], a[12:15], 0
ds_read_b64_tr_b16 a[96:97], v12 offset:768
s_waitcnt lgkmcnt(9)
v_mfma_f32_16x16x32_bf16 v[84:87], a[108:111], a[28:31], v[84:87]
ds_read_b64_tr_b16 a[98:99], v12 offset:1792
s_add_u32 m0, s17, 0xc800
v_mfma_f32_16x16x32_bf16 v[76:79], a[108:111], a[24:27], 0
buffer_load_dwordx4 v6, s[60:63], 0 offen lds
v_mfma_f32_16x16x32_bf16 v[76:79], a[104:107], a[8:11], v[76:79]
ds_read_b64_tr_b16 a[100:101], v12 offset:8960
v_mfma_f32_16x16x32_bf16 v[68:71], a[104:107], a[4:7], 0
ds_read_b64_tr_b16 a[102:103], v12 offset:9984
v_mfma_f32_16x16x32_bf16 v[68:71], a[108:111], a[20:23], v[68:71]
v_mfma_f32_16x16x32_bf16 v[60:63], a[108:111], a[16:19], 0
s_add_u32 m0, s17, 0x8c00
s_waitcnt lgkmcnt(4)
v_mfma_f32_16x16x32_bf16 v[60:63], a[104:107], a[0:3], v[60:63]
buffer_load_dwordx4 v6, s[56:59], s13 offen lds
v_mfma_f32_16x16x32_bf16 v[88:91], a[80:83], a[0:3], 0
ds_read_b64_tr_b16 a[104:105], v13 offset:768
v_mfma_f32_16x16x32_bf16 v[88:91], a[84:87], a[16:19], v[88:91]
ds_read_b64_tr_b16 a[106:107], v13 offset:1792
v_mfma_f32_16x16x32_bf16 v[96:99], a[84:87], a[20:23], 0
ds_read_b64_tr_b16 a[108:109], v13 offset:8960
v_mfma_f32_16x16x32_bf16 v[96:99], a[80:83], a[4:7], v[96:99]
ds_read_b64_tr_b16 a[110:111], v13 offset:9984
s_add_u32 m0, s17, 0xcc00
v_mfma_f32_16x16x32_bf16 v[104:107], a[80:83], a[8:11], 0
buffer_load_dwordx4 v6, s[60:63], s13 offen lds
v_mfma_f32_16x16x32_bf16 v[104:107], a[84:87], a[24:27], v[104:107]
v_lshl_add_u32 v5, s42, 19, v5
v_lshl_add_u32 v6, s42, 19, v6
v_mfma_f32_16x16x32_bf16 v[112:115], a[84:87], a[28:31], 0
v_mfma_f32_16x16x32_bf16 v[112:115], a[80:83], a[12:15], v[112:115]
v_mfma_f32_16x16x32_bf16 v[116:119], a[88:91], a[12:15], 0
ds_read_b64_tr_b16 a[80:81], v12 offset:16384
s_add_u32 m0, s16, 0x0
v_mfma_f32_16x16x32_bf16 v[116:119], a[92:95], a[28:31], v[116:119]
buffer_load_dwordx4 v2, s[48:51], 0 offen lds
v_mfma_f32_16x16x32_bf16 v[108:111], a[92:95], a[24:27], 0
ds_read_b64_tr_b16 a[82:83], v12 offset:17408
v_mfma_f32_16x16x32_bf16 v[108:111], a[88:91], a[8:11], v[108:111]
ds_read_b64_tr_b16 a[84:85], v12 offset:24576
v_mfma_f32_16x16x32_bf16 v[100:103], a[88:91], a[4:7], 0
ds_read_b64_tr_b16 a[86:87], v12 offset:25600
v_mfma_f32_16x16x32_bf16 v[100:103], a[92:95], a[20:23], v[100:103]
s_add_u32 m0, s16, 0x400
v_mfma_f32_16x16x32_bf16 v[92:95], a[92:95], a[16:19], 0
buffer_load_dwordx4 v3, s[48:51], 0 offen lds
v_mfma_f32_16x16x32_bf16 v[92:95], a[88:91], a[0:3], v[92:95]
s_waitcnt lgkmcnt(4)
v_mfma_f32_16x16x32_bf16 v[120:123], a[96:99], a[0:3], 0
ds_read_b64_tr_b16 a[88:89], v13 offset:16384
s_waitcnt vmcnt(11)
v_mfma_f32_16x16x32_bf16 v[120:123], a[100:103], a[16:19], v[120:123]
ds_read_b64_tr_b16 a[90:91], v13 offset:17408
v_mfma_f32_16x16x32_bf16 v[128:131], a[100:103], a[20:23], 0
ds_read_b64_tr_b16 a[92:93], v13 offset:24576
s_add_u32 m0, s16, 0x800
v_mfma_f32_16x16x32_bf16 v[128:131], a[96:99], a[4:7], v[128:131]
buffer_load_dwordx4 v2, s[48:51], s12 offen lds
v_mfma_f32_16x16x32_bf16 v[136:139], a[96:99], a[8:11], 0
ds_read_b64_tr_b16 a[94:95], v13 offset:25600
v_mfma_f32_16x16x32_bf16 v[136:139], a[100:103], a[24:27], v[136:139]
ds_read_b128 a[32:35], v8 offset:32768
v_mfma_f32_16x16x32_bf16 v[144:147], a[100:103], a[28:31], 0
ds_read_b128 a[48:51], v9 offset:32768
v_mfma_f32_16x16x32_bf16 v[144:147], a[96:99], a[12:15], v[144:147]
ds_read_b128 a[36:39], v8 offset:34816
s_add_u32 m0, s16, 0xc00
v_mfma_f32_16x16x32_bf16 v[148:151], a[104:107], a[12:15], 0
buffer_load_dwordx4 v3, s[48:51], s12 offen lds
v_mfma_f32_16x16x32_bf16 v[148:151], a[108:111], a[28:31], v[148:151]
ds_read_b64_tr_b16 a[96:97], v12 offset:16640
v_mfma_f32_16x16x32_bf16 v[140:143], a[108:111], a[24:27], 0
ds_read_b64_tr_b16 a[98:99], v12 offset:17664
v_mfma_f32_16x16x32_bf16 v[140:143], a[104:107], a[8:11], v[140:143]
ds_read_b64_tr_b16 a[100:101], v12 offset:24832
v_mfma_f32_16x16x32_bf16 v[132:135], a[104:107], a[4:7], 0
ds_read_b64_tr_b16 a[102:103], v12 offset:25856
s_add_u32 m0, s16, 0x1000
v_mfma_f32_16x16x32_bf16 v[132:135], a[108:111], a[20:23], v[132:135]
buffer_load_dwordx4 v2, s[48:51], s13 offen lds
v_mfma_f32_16x16x32_bf16 v[124:127], a[108:111], a[16:19], 0
ds_read_b128 a[52:55], v9 offset:34816
v_mfma_f32_16x16x32_bf16 v[124:127], a[104:107], a[0:3], v[124:127]
ds_read_b128 a[40:43], v8 offset:36864
s_waitcnt lgkmcnt(9)
v_mfma_f32_16x16x32_bf16 v[152:155], a[0:3], a[80:83], 0
ds_read_b64_tr_b16 a[104:105], v13 offset:16640
v_mfma_f32_16x16x32_bf16 v[152:155], a[16:19], a[84:87], v[152:155]
ds_read_b64_tr_b16 a[106:107], v13 offset:17664
s_add_u32 m0, s16, 0x1400
v_mfma_f32_16x16x32_bf16 v[156:159], a[20:23], a[84:87], 0
buffer_load_dwordx4 v3, s[48:51], s13 offen lds
v_mfma_f32_16x16x32_bf16 v[156:159], a[4:7], a[80:83], v[156:159]
ds_read_b64_tr_b16 a[108:109], v13 offset:24832
v_mfma_f32_16x16x32_bf16 v[160:163], a[8:11], a[80:83], 0
ds_read_b64_tr_b16 a[110:111], v13 offset:25856
v_mfma_f32_16x16x32_bf16 v[160:163], a[24:27], a[84:87], v[160:163]
ds_read_b128 a[56:59], v9 offset:36864
v_mfma_f32_16x16x32_bf16 v[164:167], a[28:31], a[84:87], 0
ds_read_b128 a[44:47], v8 offset:38912
s_add_u32 m0, s16, 0x1800
v_mfma_f32_16x16x32_bf16 v[164:167], a[12:15], a[80:83], v[164:167]
buffer_load_dwordx4 v2, s[48:51], s14 offen lds
v_mfma_f32_16x16x32_bf16 v[180:183], a[12:15], a[88:91], 0
ds_read_b64_tr_b16 a[80:81], v12 offset:16896
v_mfma_f32_16x16x32_bf16 v[180:183], a[28:31], a[92:95], v[180:183]
ds_read_b64_tr_b16 a[82:83], v12 offset:17920
v_mfma_f32_16x16x32_bf16 v[176:179], a[24:27], a[92:95], 0
ds_read_b64_tr_b16 a[84:85], v12 offset:25088
v_mfma_f32_16x16x32_bf16 v[176:179], a[8:11], a[88:91], v[176:179]
ds_read_b64_tr_b16 a[86:87], v12 offset:26112
s_add_u32 m0, s16, 0x1c00
v_mfma_f32_16x16x32_bf16 v[172:175], a[4:7], a[88:91], 0
buffer_load_dwordx4 v3, s[48:51], s14 offen lds
v_mfma_f32_16x16x32_bf16 v[172:175], a[20:23], a[92:95], v[172:175]
ds_read_b128 a[60:63], v9 offset:38912
v_lshl_add_u32 v2, s42, 7, v2
v_mfma_f32_16x16x32_bf16 v[168:171], a[16:19], a[92:95], 0
v_lshl_add_u32 v3, s42, 7, v3
v_mfma_f32_16x16x32_bf16 v[168:171], a[0:3], a[88:91], v[168:171]
s_waitcnt lgkmcnt(7)
v_mfma_f32_16x16x32_bf16 v[184:187], a[0:3], a[96:99], 0
ds_read_b64_tr_b16 a[88:89], v13 offset:16896
s_add_u32 m0, s17, 0x10000
v_mfma_f32_16x16x32_bf16 v[184:187], a[16:19], a[100:103], v[184:187]
buffer_load_dwordx4 v5, s[56:59], 0 offen lds
v_mfma_f32_16x16x32_bf16 v[188:191], a[20:23], a[100:103], 0
ds_read_b64_tr_b16 a[90:91], v13 offset:17920
v_mfma_f32_16x16x32_bf16 v[188:191], a[4:7], a[96:99], v[188:191]
ds_read_b64_tr_b16 a[92:93], v13 offset:25088
v_mfma_f32_16x16x32_bf16 v[192:195], a[8:11], a[96:99], 0
ds_read_b64_tr_b16 a[94:95], v13 offset:26112
v_mfma_f32_16x16x32_bf16 v[192:195], a[24:27], a[100:103], v[192:195]
s_add_u32 m0, s17, 0x14000
v_mfma_f32_16x16x32_bf16 v[196:199], a[28:31], a[100:103], 0
buffer_load_dwordx4 v5, s[60:63], 0 offen lds
v_mfma_f32_16x16x32_bf16 v[196:199], a[12:15], a[96:99], v[196:199]
v_mfma_f32_16x16x32_bf16 v[212:215], a[12:15], a[104:107], 0
ds_read_b64_tr_b16 a[96:97], v12 offset:17152
v_mfma_f32_16x16x32_bf16 v[212:215], a[28:31], a[108:111], v[212:215]
ds_read_b64_tr_b16 a[98:99], v12 offset:18176
v_mfma_f32_16x16x32_bf16 v[208:211], a[24:27], a[108:111], 0
ds_read_b64_tr_b16 a[100:101], v12 offset:25344
s_add_u32 m0, s17, 0x10400
v_mfma_f32_16x16x32_bf16 v[208:211], a[8:11], a[104:107], v[208:211]
buffer_load_dwordx4 v5, s[56:59], s13 offen lds
v_mfma_f32_16x16x32_bf16 v[204:207], a[4:7], a[104:107], 0
ds_read_b64_tr_b16 a[102:103], v12 offset:26368
v_mfma_f32_16x16x32_bf16 v[204:207], a[20:23], a[108:111], v[204:207]
v_mfma_f32_16x16x32_bf16 v[200:203], a[16:19], a[108:111], 0
v_mfma_f32_16x16x32_bf16 v[200:203], a[0:3], a[104:107], v[200:203]
s_add_u32 m0, s17, 0x14400
s_waitcnt lgkmcnt(4)
v_mfma_f32_16x16x32_bf16 v[216:219], a[0:3], a[80:83], 0
buffer_load_dwordx4 v5, s[60:63], s13 offen lds
v_mfma_f32_16x16x32_bf16 v[216:219], a[16:19], a[84:87], v[216:219]
ds_read_b64_tr_b16 a[104:105], v13 offset:17152
v_mfma_f32_16x16x32_bf16 v[220:223], a[20:23], a[84:87], 0
ds_read_b64_tr_b16 a[106:107], v13 offset:18176
v_mfma_f32_16x16x32_bf16 v[220:223], a[4:7], a[80:83], v[220:223]
ds_read_b64_tr_b16 a[108:109], v13 offset:25344
v_mfma_f32_16x16x32_bf16 v[224:227], a[8:11], a[80:83], 0
ds_read_b64_tr_b16 a[110:111], v13 offset:26368
s_add_u32 m0, s17, 0x10800
v_mfma_f32_16x16x32_bf16 v[224:227], a[24:27], a[84:87], v[224:227]
buffer_load_dwordx4 v6, s[56:59], 0 offen lds
v_mfma_f32_16x16x32_bf16 v[228:231], a[28:31], a[84:87], 0
v_add_u32 v12, 0x8000, v12
v_add_u32 v13, 0x8000, v13
v_mfma_f32_16x16x32_bf16 v[228:231], a[12:15], a[80:83], v[228:231]
v_mfma_f32_16x16x32_bf16 v[244:247], a[12:15], a[88:91], 0
s_waitcnt vmcnt(13) lgkmcnt(0)
v_mfma_f32_16x16x32_bf16 v[244:247], a[28:31], a[92:95], v[244:247]
s_barrier
s_add_u32 m0, s17, 0x14800
v_mfma_f32_16x16x32_bf16 v[240:243], a[24:27], a[92:95], 0
buffer_load_dwordx4 v6, s[60:63], 0 offen lds
v_mfma_f32_16x16x32_bf16 v[240:243], a[8:11], a[88:91], v[240:243]
ds_read_b64_tr_b16 a[80:81], v12 offset:0
v_mfma_f32_16x16x32_bf16 v[236:239], a[4:7], a[88:91], 0
ds_read_b64_tr_b16 a[82:83], v12 offset:1024
v_mfma_f32_16x16x32_bf16 v[236:239], a[20:23], a[92:95], v[236:239]
ds_read_b64_tr_b16 a[84:85], v12 offset:8192
s_waitcnt lgkmcnt(3)
v_mfma_f32_16x16x32_bf16 v[232:235], a[16:19], a[92:95], 0
ds_read_b64_tr_b16 a[86:87], v12 offset:9216
s_add_u32 m0, s17, 0x10c00
v_mfma_f32_16x16x32_bf16 v[232:235], a[0:3], a[88:91], v[232:235]
buffer_load_dwordx4 v6, s[56:59], s13 offen lds
v_mfma_f32_16x16x32_bf16 v[248:251], a[0:3], a[96:99], 0
ds_read_b64_tr_b16 a[88:89], v13 offset:0
v_mfma_f32_16x16x32_bf16 v[248:251], a[16:19], a[100:103], v[248:251]
ds_read_b64_tr_b16 a[90:91], v13 offset:1024
v_mfma_f32_16x16x32_bf16 v[252:255], a[20:23], a[100:103], 0
ds_read_b64_tr_b16 a[92:93], v13 offset:8192
v_mfma_f32_16x16x32_bf16 v[252:255], a[4:7], a[96:99], v[252:255]
ds_read_b64_tr_b16 a[94:95], v13 offset:9216
s_add_u32 m0, s17, 0x14c00
v_mfma_f32_16x16x32_bf16 a[232:235], a[8:11], a[96:99], 0
buffer_load_dwordx4 v6, s[60:63], s13 offen lds
v_mfma_f32_16x16x32_bf16 a[232:235], a[24:27], a[100:103], a[232:235]
v_lshl_add_u32 v5, s42, 19, v5
v_lshl_add_u32 v6, s42, 19, v6
v_mfma_f32_16x16x32_bf16 a[236:239], a[28:31], a[100:103], 0
v_mfma_f32_16x16x32_bf16 a[236:239], a[12:15], a[96:99], a[236:239]
s_waitcnt lgkmcnt(15)
v_mfma_f32_16x16x32_bf16 a[252:255], a[12:15], a[104:107], 0
ds_read_b64_tr_b16 a[96:97], v12 offset:256
s_add_u32 m0, s16, 0x8000
v_mfma_f32_16x16x32_bf16 a[252:255], a[28:31], a[108:111], a[252:255]
buffer_load_dwordx4 v2, s[48:51], 0 offen lds
v_mfma_f32_16x16x32_bf16 a[248:251], a[24:27], a[108:111], 0
ds_read_b64_tr_b16 a[98:99], v12 offset:1280
v_mfma_f32_16x16x32_bf16 a[248:251], a[8:11], a[104:107], a[248:251]
ds_read_b64_tr_b16 a[100:101], v12 offset:8448
v_mfma_f32_16x16x32_bf16 a[244:247], a[4:7], a[104:107], 0
ds_read_b64_tr_b16 a[102:103], v12 offset:9472
v_mfma_f32_16x16x32_bf16 a[244:247], a[20:23], a[108:111], a[244:247]
s_add_u32 m0, s16, 0x8400
v_mfma_f32_16x16x32_bf16 a[240:243], a[16:19], a[108:111], 0
buffer_load_dwordx4 v3, s[48:51], 0 offen lds
v_mfma_f32_16x16x32_bf16 a[240:243], a[0:3], a[104:107], a[240:243]
s_waitcnt lgkmcnt(4)
L_S1:
v_mfma_f32_16x16x32_bf16 v[24:27], a[80:83], a[32:35], v[24:27]
ds_read_b64_tr_b16 a[104:105], v13 offset:256
v_mfma_f32_16x16x32_bf16 v[24:27], a[84:87], a[48:51], v[24:27]
ds_read_b64_tr_b16 a[106:107], v13 offset:1280
v_mfma_f32_16x16x32_bf16 v[32:35], a[84:87], a[52:55], v[32:35]
ds_read_b64_tr_b16 a[108:109], v13 offset:8448
s_add_u32 m0, s16, 0x8800
v_mfma_f32_16x16x32_bf16 v[32:35], a[80:83], a[36:39], v[32:35]
buffer_load_dwordx4 v2, s[48:51], s12 offen lds
v_mfma_f32_16x16x32_bf16 v[40:43], a[80:83], a[40:43], v[40:43]
ds_read_b64_tr_b16 a[110:111], v13 offset:9472
v_mfma_f32_16x16x32_bf16 v[40:43], a[84:87], a[56:59], v[40:43]
v_mfma_f32_16x16x32_bf16 v[48:51], a[84:87], a[60:63], v[48:51]
v_mfma_f32_16x16x32_bf16 v[48:51], a[80:83], a[44:47], v[48:51]
s_add_u32 m0, s16, 0x8c00
v_mfma_f32_16x16x32_bf16 v[52:55], a[88:91], a[44:47], v[52:55]
buffer_load_dwordx4 v3, s[48:51], s12 offen lds
v_mfma_f32_16x16x32_bf16 v[52:55], a[92:95], a[60:63], v[52:55]
ds_read_b64_tr_b16 a[80:81], v12 offset:512
v_mfma_f32_16x16x32_bf16 v[44:47], a[92:95], a[56:59], v[44:47]
ds_read_b64_tr_b16 a[82:83], v12 offset:1536
v_mfma_f32_16x16x32_bf16 v[44:47], a[88:91], a[40:43], v[44:47]
ds_read_b64_tr_b16 a[84:85], v12 offset:8704
v_mfma_f32_16x16x32_bf16 v[36:39], a[88:91], a[36:39], v[36:39]
ds_read_b64_tr_b16 a[86:87], v12 offset:9728
s_add_u32 m0, s16, 0x9000
v_mfma_f32_16x16x32_bf16 v[36:39], a[92:95], a[52:55], v[36:39]
buffer_load_dwordx4 v2, s[48:51], s13 offen lds
v_mfma_f32_16x16x32_bf16 v[28:31], a[92:95], a[48:51], v[28:31]
v_mfma_f32_16x16x32_bf16 v[28:31], a[88:91], a[32:35], v[28:31]
s_waitcnt lgkmcnt(4)
v_mfma_f32_16x16x32_bf16 v[56:59], a[96:99], a[32:35], v[56:59]
ds_read_b64_tr_b16 a[88:89], v13 offset:512
v_mfma_f32_16x16x32_bf16 v[56:59], a[100:103], a[48:51], v[56:59]
ds_read_b64_tr_b16 a[90:91], v13 offset:1536
s_add_u32 m0, s16, 0x9400
v_mfma_f32_16x16x32_bf16 v[64:67], a[100:103], a[52:55], v[64:67]
buffer_load_dwordx4 v3, s[48:51], s13 offen lds
v_mfma_f32_16x16x32_bf16 v[64:67], a[96:99], a[36:39], v[64:67]
ds_read_b64_tr_b16 a[92:93], v13 offset:8704
v_mfma_f32_16x16x32_bf16 v[72:75], a[96:99], a[40:43], v[72:75]
ds_read_b64_tr_b16 a[94:95], v13 offset:9728
v_mfma_f32_16x16x32_bf16 v[72:75], a[100:103], a[56:59], v[72:75]
v_mfma_f32_16x16x32_bf16 v[80:83], a[100:103], a[60:63], v[80:83]
s_add_u32 m0, s16, 0x9800
v_mfma_f32_16x16x32_bf16 v[80:83], a[96:99], a[44:47], v[80:83]
buffer_load_dwordx4 v2, s[48:51], s14 offen lds
v_mfma_f32_16x16x32_bf16 v[84:87], a[104:107], a[44:47], v[84:87]
ds_read_b64_tr_b16 a[96:97], v12 offset:768
v_mfma_f32_16x16x32_bf16 v[84:87], a[108:111], a[60:63], v[84:87]
ds_read_b64_tr_b16 a[98:99], v12 offset:1792
v_mfma_f32_16x16x32_bf16 v[76:79], a[108:111], a[56:59], v[76:79]
ds_read_b64_tr_b16 a[100:101], v12 offset:8960
v_mfma_f32_16x16x32_bf16 v[76:79], a[104:107], a[40:43], v[76:79]
ds_read_b64_tr_b16 a[102:103], v12 offset:9984
s_add_u32 m0, s16, 0x9c00
v_mfma_f32_16x16x32_bf16 v[68:71], a[104:107], a[36:39], v[68:71]
buffer_load_dwordx4 v3, s[48:51], s14 offen lds
v_mfma_f32_16x16x32_bf16 v[68:71], a[108:111], a[52:55], v[68:71]
v_lshl_add_u32 v2, s42, 7, v2
v_lshl_add_u32 v3, s42, 7, v3
v_mfma_f32_16x16x32_bf16 v[60:63], a[108:111], a[48:51], v[60:63]
v_mfma_f32_16x16x32_bf16 v[60:63], a[104:107], a[32:35], v[60:63]
s_add_u32 m0, s17, 0x0
s_waitcnt lgkmcnt(4)
v_mfma_f32_16x16x32_bf16 v[88:91], a[80:83], a[32:35], v[88:91]
ds_read_b64_tr_b16 a[104:105], v13 offset:768
s_waitcnt vmcnt(16)
v_mfma_f32_16x16x32_bf16 v[88:91], a[84:87], a[48:51], v[88:91]
buffer_load_dwordx4 v5, s[56:59], 0 offen lds
v_mfma_f32_16x16x32_bf16 v[96:99], a[84:87], a[52:55], v[96:99]
ds_read_b64_tr_b16 a[106:107], v13 offset:1792
v_mfma_f32_16x16x32_bf16 v[96:99], a[80:83], a[36:39], v[96:99]
ds_read_b64_tr_b16 a[108:109], v13 offset:8960
v_mfma_f32_16x16x32_bf16 v[104:107], a[80:83], a[40:43], v[104:107]
ds_read_b64_tr_b16 a[110:111], v13 offset:9984
v_mfma_f32_16x16x32_bf16 v[104:107], a[84:87], a[56:59], v[104:107]
ds_read_b128 a[0:3], v8 offset:0
s_add_u32 m0, s17, 0x4000
v_mfma_f32_16x16x32_bf16 v[112:115], a[84:87], a[60:63], v[112:115]
buffer_load_dwordx4 v5, s[60:63], 0 offen lds
v_mfma_f32_16x16x32_bf16 v[112:115], a[80:83], a[44:47], v[112:115]
ds_read_b128 a[16:19], v9 offset:0
v_mfma_f32_16x16x32_bf16 v[116:119], a[88:91], a[44:47], v[116:119]
ds_read_b64_tr_b16 a[80:81], v12 offset:16384
v_mfma_f32_16x16x32_bf16 v[116:119], a[92:95], a[60:63], v[116:119]
ds_read_b64_tr_b16 a[82:83], v12 offset:17408
v_mfma_f32_16x16x32_bf16 v[108:111], a[92:95], a[56:59], v[108:111]
ds_read_b64_tr_b16 a[84:85], v12 offset:24576
s_add_u32 m0, s17, 0x400
v_mfma_f32_16x16x32_bf16 v[108:111], a[88:91], a[40:43], v[108:111]
buffer_load_dwordx4 v5, s[56:59], s13 offen lds
v_mfma_f32_16x16x32_bf16 v[100:103], a[88:91], a[36:39], v[100:103]
ds_read_b64_tr_b16 a[86:87], v12 offset:25600
v_mfma_f32_16x16x32_bf16 v[100:103], a[92:95], a[52:55], v[100:103]
ds_read_b128 a[4:7], v8 offset:2048
v_mfma_f32_16x16x32_bf16 v[92:95], a[92:95], a[48:51], v[92:95]
ds_read_b128 a[20:23], v9 offset:2048
s_waitcnt lgkmcnt(8)
v_mfma_f32_16x16x32_bf16 v[92:95], a[88:91], a[32:35], v[92:95]
ds_read_b128 a[8:11], v8 offset:4096
s_add_u32 m0, s17, 0x4400
v_mfma_f32_16x16x32_bf16 v[120:123], a[96:99], a[32:35], v[120:123]
buffer_load_dwordx4 v5, s[60:63], s13 offen lds
v_mfma_f32_16x16x32_bf16 v[120:123], a[100:103], a[48:51], v[120:123]
ds_read_b64_tr_b16 a[88:89], v13 offset:16384
v_mfma_f32_16x16x32_bf16 v[128:131], a[100:103], a[52:55], v[128:131]
ds_read_b64_tr_b16 a[90:91], v13 offset:17408
v_mfma_f32_16x16x32_bf16 v[128:131], a[96:99], a[36:39], v[128:131]
ds_read_b64_tr_b16 a[92:93], v13 offset:24576
v_mfma_f32_16x16x32_bf16 v[136:139], a[96:99], a[40:43], v[136:139]
ds_read_b64_tr_b16 a[94:95], v13 offset:25600
s_add_u32 m0, s17, 0x800
v_mfma_f32_16x16x32_bf16 v[136:139], a[100:103], a[56:59], v[136:139]
buffer_load_dwordx4 v6, s[56:59], 0 offen lds
v_mfma_f32_16x16x32_bf16 v[144:147], a[100:103], a[60:63], v[144:147]
ds_read_b128 a[24:27], v9 offset:4096
v_mfma_f32_16x16x32_bf16 v[144:147], a[96:99], a[44:47], v[144:147]
ds_read_b128 a[12:15], v8 offset:6144
v_mfma_f32_16x16x32_bf16 v[148:151], a[104:107], a[44:47], v[148:151]
ds_read_b64_tr_b16 a[96:97], v12 offset:16640
v_mfma_f32_16x16x32_bf16 v[148:151], a[108:111], a[60:63], v[148:151]
ds_read_b64_tr_b16 a[98:99], v12 offset:17664
s_add_u32 m0, s17, 0x4800
v_mfma_f32_16x16x32_bf16 v[140:143], a[108:111], a[56:59], v[140:143]
buffer_load_dwordx4 v6, s[60:63], 0 offen lds
v_mfma_f32_16x16x32_bf16 v[140:143], a[104:107], a[40:43], v[140:143]
ds_read_b64_tr_b16 a[100:101], v12 offset:24832
v_mfma_f32_16x16x32_bf16 v[132:135], a[104:107], a[36:39], v[132:135]
ds_read_b64_tr_b16 a[102:103], v12 offset:25856
v_mfma_f32_16x16x32_bf16 v[132:135], a[108:111], a[52:55], v[132:135]
ds_read_b128 a[28:31], v9 offset:6144
v_mfma_f32_16x16x32_bf16 v[124:127], a[108:111], a[48:51], v[124:127]
s_add_u32 m0, s17, 0xc00
s_waitcnt lgkmcnt(7)
v_mfma_f32_16x16x32_bf16 v[124:127], a[104:107], a[32:35], v[124:127]
buffer_load_dwordx4 v6, s[56:59], s13 offen lds
v_mfma_f32_16x16x32_bf16 v[152:155], a[32:35], a[80:83], v[152:155]
ds_read_b64_tr_b16 a[104:105], v13 offset:16640
v_mfma_f32_16x16x32_bf16 v[152:155], a[48:51], a[84:87], v[152:155]
ds_read_b64_tr_b16 a[106:107], v13 offset:17664
v_mfma_f32_16x16x32_bf16 v[156:159], a[52:55], a[84:87], v[156:159]
ds_read_b64_tr_b16 a[108:109], v13 offset:24832
v_mfma_f32_16x16x32_bf16 v[156:159], a[36:39], a[80:83], v[156:159]
ds_read_b64_tr_b16 a[110:111], v13 offset:25856
s_add_u32 m0, s17, 0x4c00
v_mfma_f32_16x16x32_bf16 v[160:163], a[40:43], a[80:83], v[160:163]
buffer_load_dwordx4 v6, s[60:63], s13 offen lds
v_mfma_f32_16x16x32_bf16 v[160:163], a[56:59], a[84:87], v[160:163]
v_lshl_add_u32 v5, s42, 19, v5
v_lshl_add_u32 v6, s42, 19, v6
v_mfma_f32_16x16x32_bf16 v[164:167], a[60:63], a[84:87], v[164:167]
v_mfma_f32_16x16x32_bf16 v[164:167], a[44:47], a[80:83], v[164:167]
v_mfma_f32_16x16x32_bf16 v[180:183], a[44:47], a[88:91], v[180:183]
ds_read_b64_tr_b16 a[80:81], v12 offset:16896
s_mov_b32 s9, 0x200000
v_mfma_f32_16x16x32_bf16 v[180:183], a[60:63], a[92:95], v[180:183]
buffer_load_dword a120, v18, s[56:59], s9 offen
v_mfma_f32_16x16x32_bf16 v[176:179], a[56:59], a[92:95], v[176:179]
ds_read_b64_tr_b16 a[82:83], v12 offset:17920
v_mfma_f32_16x16x32_bf16 v[176:179], a[40:43], a[88:91], v[176:179]
ds_read_b64_tr_b16 a[84:85], v12 offset:25088
v_mfma_f32_16x16x32_bf16 v[172:175], a[36:39], a[88:91], v[172:175]
ds_read_b64_tr_b16 a[86:87], v12 offset:26112
v_mfma_f32_16x16x32_bf16 v[172:175], a[52:55], a[92:95], v[172:175]
s_add_u32 m0, s16, 0x0
s_waitcnt lgkmcnt(8)
v_mfma_f32_16x16x32_bf16 v[168:171], a[48:51], a[92:95], v[168:171]
buffer_load_dwordx4 v2, s[48:51], 0 offen lds
v_mfma_f32_16x16x32_bf16 v[168:171], a[32:35], a[88:91], v[168:171]
s_waitcnt lgkmcnt(4)
v_mfma_f32_16x16x32_bf16 v[184:187], a[32:35], a[96:99], v[184:187]
ds_read_b64_tr_b16 a[88:89], v13 offset:16896
v_mfma_f32_16x16x32_bf16 v[184:187], a[48:51], a[100:103], v[184:187]
ds_read_b64_tr_b16 a[90:91], v13 offset:17920
v_mfma_f32_16x16x32_bf16 v[188:191], a[52:55], a[100:103], v[188:191]
ds_read_b64_tr_b16 a[92:93], v13 offset:25088
s_add_u32 m0, s16, 0x400
v_mfma_f32_16x16x32_bf16 v[188:191], a[36:39], a[96:99], v[188:191]
buffer_load_dwordx4 v3, s[48:51], 0 offen lds
v_mfma_f32_16x16x32_bf16 v[192:195], a[40:43], a[96:99], v[192:195]
ds_read_b64_tr_b16 a[94:95], v13 offset:26112
v_mfma_f32_16x16x32_bf16 v[192:195], a[56:59], a[100:103], v[192:195]
v_mfma_f32_16x16x32_bf16 v[196:199], a[60:63], a[100:103], v[196:199]
v_mfma_f32_16x16x32_bf16 v[196:199], a[44:47], a[96:99], v[196:199]
s_add_u32 m0, s16, 0x800
v_mfma_f32_16x16x32_bf16 v[212:215], a[44:47], a[104:107], v[212:215]
buffer_load_dwordx4 v2, s[48:51], s12 offen lds
v_mfma_f32_16x16x32_bf16 v[212:215], a[60:63], a[108:111], v[212:215]
ds_read_b64_tr_b16 a[96:97], v12 offset:17152
v_mfma_f32_16x16x32_bf16 v[208:211], a[56:59], a[108:111], v[208:211]
ds_read_b64_tr_b16 a[98:99], v12 offset:18176
v_mfma_f32_16x16x32_bf16 v[208:211], a[40:43], a[104:107], v[208:211]
ds_read_b64_tr_b16 a[100:101], v12 offset:25344
v_mfma_f32_16x16x32_bf16 v[204:207], a[36:39], a[104:107], v[204:207]
ds_read_b64_tr_b16 a[102:103], v12 offset:26368
s_add_u32 m0, s16, 0xc00
v_mfma_f32_16x16x32_bf16 v[204:207], a[52:55], a[108:111], v[204:207]
buffer_load_dwordx4 v3, s[48:51], s12 offen lds
v_mfma_f32_16x16x32_bf16 v[200:203], a[48:51], a[108:111], v[200:203]
v_mfma_f32_16x16x32_bf16 v[200:203], a[32:35], a[104:107], v[200:203]
s_waitcnt lgkmcnt(4)
v_mfma_f32_16x16x32_bf16 v[216:219], a[32:35], a[80:83], v[216:219]
ds_read_b64_tr_b16 a[104:105], v13 offset:17152
v_mfma_f32_16x16x32_bf16 v[216:219], a[48:51], a[84:87], v[216:219]
ds_read_b64_tr_b16 a[106:107], v13 offset:18176
s_add_u32 m0, s16, 0x1000
v_mfma_f32_16x16x32_bf16 v[220:223], a[52:55], a[84:87], v[220:223]
buffer_load_dwordx4 v2, s[48:51], s13 offen lds
v_mfma_f32_16x16x32_bf16 v[220:223], a[36:39], a[80:83], v[220:223]
ds_read_b64_tr_b16 a[108:109], v13 offset:25344
v_mfma_f32_16x16x32_bf16 v[224:227], a[40:43], a[80:83], v[224:227]
ds_read_b64_tr_b16 a[110:111], v13 offset:26368
v_add_u32 v12, 0x8000, v12
v_mfma_f32_16x16x32_bf16 v[224:227], a[56:59], a[84:87], v[224:227]
v_add_u32 v13, 0x8000, v13
v_mfma_f32_16x16x32_bf16 v[228:231], a[60:63], a[84:87], v[228:231]
s_add_u32 m0, s16, 0x1400
v_mfma_f32_16x16x32_bf16 v[228:231], a[44:47], a[80:83], v[228:231]
buffer_load_dwordx4 v3, s[48:51], s13 offen lds
v_mfma_f32_16x16x32_bf16 v[244:247], a[44:47], a[88:91], v[244:247]
s_waitcnt vmcnt(23) lgkmcnt(0)
v_mfma_f32_16x16x32_bf16 v[244:247], a[60:63], a[92:95], v[244:247]
s_barrier
v_mfma_f32_16x16x32_bf16 v[240:243], a[56:59], a[92:95], v[240:243]
ds_read_b64_tr_b16 a[80:81], v12 offset:0
v_mfma_f32_16x16x32_bf16 v[240:243], a[40:43], a[88:91], v[240:243]
ds_read_b64_tr_b16 a[82:83], v12 offset:1024
s_add_u32 m0, s16, 0x1800
v_mfma_f32_16x16x32_bf16 v[236:239], a[36:39], a[88:91], v[236:239]
buffer_load_dwordx4 v2, s[48:51], s14 offen lds
v_mfma_f32_16x16x32_bf16 v[236:239], a[52:55], a[92:95], v[236:239]
ds_read_b64_tr_b16 a[84:85], v12 offset:8192
v_mfma_f32_16x16x32_bf16 v[232:235], a[48:51], a[92:95], v[232:235]
ds_read_b64_tr_b16 a[86:87], v12 offset:9216
v_mfma_f32_16x16x32_bf16 v[232:235], a[32:35], a[88:91], v[232:235]
L_padA1:
s_cmp_eq_u32 s95, 1
s_cbranch_scc1 L_padA5
s_waitcnt lgkmcnt(4)
v_mfma_f32_16x16x32_bf16 v[248:251], a[32:35], a[96:99], v[248:251]
ds_read_b64_tr_b16 a[88:89], v13 offset:0
s_add_u32 m0, s16, 0x1c00
v_mfma_f32_16x16x32_bf16 v[248:251], a[48:51], a[100:103], v[248:251]
buffer_load_dwordx4 v3, s[48:51], s14 offen lds
v_mfma_f32_16x16x32_bf16 v[252:255], a[52:55], a[100:103], v[252:255]
ds_read_b64_tr_b16 a[90:91], v13 offset:1024
v_lshl_add_u32 v2, s42, 7, v2
v_mfma_f32_16x16x32_bf16 v[252:255], a[36:39], a[96:99], v[252:255]
ds_read_b64_tr_b16 a[92:93], v13 offset:8192
v_lshl_add_u32 v3, s42, 7, v3
v_mfma_f32_16x16x32_bf16 a[232:235], a[40:43], a[96:99], a[232:235]
ds_read_b64_tr_b16 a[94:95], v13 offset:9216
v_mfma_f32_16x16x32_bf16 a[232:235], a[56:59], a[100:103], a[232:235]
s_mov_b32 s9, 0x200000
v_mfma_f32_16x16x32_bf16 a[236:239], a[60:63], a[100:103], a[236:239]
buffer_load_dword a120, v18, s[60:63], s9 offen
v_mfma_f32_16x16x32_bf16 a[236:239], a[44:47], a[96:99], a[236:239]
v_mfma_f32_16x16x32_bf16 a[252:255], a[44:47], a[104:107], a[252:255]
ds_read_b64_tr_b16 a[96:97], v12 offset:256
v_mfma_f32_16x16x32_bf16 a[252:255], a[60:63], a[108:111], a[252:255]
ds_read_b64_tr_b16 a[98:99], v12 offset:1280
v_mfma_f32_16x16x32_bf16 a[248:251], a[56:59], a[108:111], a[248:251]
ds_read_b64_tr_b16 a[100:101], v12 offset:8448
s_add_u32 m0, s17, 0x8000
v_mfma_f32_16x16x32_bf16 a[248:251], a[40:43], a[104:107], a[248:251]
buffer_load_dwordx4 v5, s[56:59], 0 offen lds
v_mfma_f32_16x16x32_bf16 a[244:247], a[36:39], a[104:107], a[244:247]
ds_read_b64_tr_b16 a[102:103], v12 offset:9472
v_mfma_f32_16x16x32_bf16 a[244:247], a[52:55], a[108:111], a[244:247]
v_mfma_f32_16x16x32_bf16 a[240:243], a[48:51], a[108:111], a[240:243]
v_mfma_f32_16x16x32_bf16 a[240:243], a[32:35], a[104:107], a[240:243]
s_add_u32 m0, s17, 0xc000
s_waitcnt lgkmcnt(4)
L_S2:
v_mfma_f32_16x16x32_bf16 v[24:27], a[80:83], a[0:3], v[24:27]
buffer_load_dwordx4 v5, s[60:63], 0 offen lds
v_mfma_f32_16x16x32_bf16 v[24:27], a[84:87], a[16:19], v[24:27]
ds_read_b64_tr_b16 a[104:105], v13 offset:256
s_waitcnt vmcnt(20)
v_mfma_f32_16x16x32_bf16 v[32:35], a[84:87], a[20:23], v[32:35]
ds_read_b64_tr_b16 a[106:107], v13 offset:1280
v_mfma_f32_16x16x32_bf16 v[32:35], a[80:83], a[4:7], v[32:35]
ds_read_b64_tr_b16 a[108:109], v13 offset:8448
v_mfma_f32_16x16x32_bf16 v[40:43], a[80:83], a[8:11], v[40:43]
ds_read_b64_tr_b16 a[110:111], v13 offset:9472
s_add_u32 m0, s17, 0x8400
v_mfma_f32_16x16x32_bf16 v[40:43], a[84:87], a[24:27], v[40:43]
buffer_load_dwordx4 v5, s[56:59], s13 offen lds
v_mfma_f32_16x16x32_bf16 v[48:51], a[84:87], a[28:31], v[48:51]
ds_read_b128 a[32:35], v8 offset:32768
v_mfma_f32_16x16x32_bf16 v[48:51], a[80:83], a[12:15], v[48:51]
ds_read_b128 a[48:51], v9 offset:32768
v_mfma_f32_16x16x32_bf16 v[52:55], a[88:91], a[12:15], v[52:55]
ds_read_b64_tr_b16 a[80:81], v12 offset:512
v_mfma_f32_16x16x32_bf16 v[52:55], a[92:95], a[28:31], v[52:55]
ds_read_b64_tr_b16 a[82:83], v12 offset:1536
s_add_u32 m0, s17, 0xc400
v_mfma_f32_16x16x32_bf16 v[44:47], a[92:95], a[24:27], v[44:47]
buffer_load_dwordx4 v5, s[60:63], s13 offen lds
v_mfma_f32_16x16x32_bf16 v[44:47], a[88:91], a[8:11], v[44:47]
ds_read_b64_tr_b16 a[84:85], v12 offset:8704
v_mfma_f32_16x16x32_bf16 v[36:39], a[88:91], a[4:7], v[36:39]
ds_read_b64_tr_b16 a[86:87], v12 offset:9728
v_mfma_f32_16x16x32_bf16 v[36:39], a[92:95], a[20:23], v[36:39]
ds_read_b128 a[36:39], v8 offset:34816
s_waitcnt lgkmcnt(7)
v_mfma_f32_16x16x32_bf16 v[28:31], a[92:95], a[16:19], v[28:31]
ds_read_b128 a[52:55], v9 offset:34816
s_add_u32 m0, s17, 0x8800
v_mfma_f32_16x16x32_bf16 v[28:31], a[88:91], a[0:3], v[28:31]
buffer_load_dwordx4 v6, s[56:59], 0 offen lds
v_mfma_f32_16x16x32_bf16 v[56:59], a[96:99], a[0:3], v[56:59]
ds_read_b64_tr_b16 a[88:89], v13 offset:512
v_mfma_f32_16x16x32_bf16 v[56:59], a[100:103], a[16:19], v[56:59]
ds_read_b64_tr_b16 a[90:91], v13 offset:1536
v_mfma_f32_16x16x32_bf16 v[64:67], a[100:103], a[20:23], v[64:67]
ds_read_b64_tr_b16 a[92:93], v13 offset:8704
v_mfma_f32_16x16x32_bf16 v[64:67], a[96:99], a[4:7], v[64:67]
ds_read_b64_tr_b16 a[94:95], v13 offset:9728
s_add_u32 m0, s17, 0xc800
v_mfma_f32_16x16x32_bf16 v[72:75], a[96:99], a[8:11], v[72:75]
buffer_load_dwordx4 v6, s[60:63], 0 offen lds
v_mfma_f32_16x16x32_bf16 v[72:75], a[100:103], a[24:27], v[72:75]
ds_read_b128 a[40:43], v8 offset:36864
v_mfma_f32_16x16x32_bf16 v[80:83], a[100:103], a[28:31], v[80:83]
ds_read_b128 a[56:59], v9 offset:36864
v_mfma_f32_16x16x32_bf16 v[80:83], a[96:99], a[12:15], v[80:83]
ds_read_b128 a[44:47], v8 offset:38912
v_mfma_f32_16x16x32_bf16 v[84:87], a[104:107], a[12:15], v[84:87]
ds_read_b64_tr_b16 a[96:97], v12 offset:768
s_add_u32 m0, s17, 0x8c00
v_mfma_f32_16x16x32_bf16 v[84:87], a[108:111], a[28:31], v[84:87]
buffer_load_dwordx4 v6, s[56:59], s13 offen lds
v_mfma_f32_16x16x32_bf16 v[76:79], a[108:111], a[24:27], v[76:79]
ds_read_b64_tr_b16 a[98:99], v12 offset:1792
v_mfma_f32_16x16x32_bf16 v[76:79], a[104:107], a[8:11], v[76:79]
ds_read_b64_tr_b16 a[100:101], v12 offset:8960
v_mfma_f32_16x16x32_bf16 v[68:71], a[104:107], a[4:7], v[68:71]
ds_read_b64_tr_b16 a[102:103], v12 offset:9984
v_mfma_f32_16x16x32_bf16 v[68:71], a[108:111], a[20:23], v[68:71]
ds_read_b128 a[60:63], v9 offset:38912
s_add_u32 m0, s17, 0xcc00
v_mfma_f32_16x16x32_bf16 v[60:63], a[108:111], a[16:19], v[60:63]
buffer_load_dwordx4 v6, s[60:63], s13 offen lds
v_mfma_f32_16x16x32_bf16 v[60:63], a[104:107], a[0:3], v[60:63]
s_waitcnt lgkmcnt(8)
v_lshl_add_u32 v5, s42, 19, v5
v_lshl_add_u32 v6, s42, 19, v6
v_mfma_f32_16x16x32_bf16 v[88:91], a[80:83], a[0:3], v[88:91]
ds_read_b64_tr_b16 a[104:105], v13 offset:768
v_mfma_f32_16x16x32_bf16 v[88:91], a[84:87], a[16:19], v[88:91]
ds_read_b64_tr_b16 a[106:107], v13 offset:1792
v_mfma_f32_16x16x32_bf16 v[96:99], a[84:87], a[20:23], v[96:99]
ds_read_b64_tr_b16 a[108:109], v13 offset:8960
v_mfma_f32_16x16x32_bf16 v[96:99], a[80:83], a[4:7], v[96:99]
ds_read_b64_tr_b16 a[110:111], v13 offset:9984
v_mfma_f32_16x16x32_bf16 v[104:107], a[80:83], a[8:11], v[104:107]
s_add_u32 m0, s16, 0x8000
s_waitcnt lgkmcnt(4)
v_mfma_f32_16x16x32_bf16 v[104:107], a[84:87], a[24:27], v[104:107]
buffer_load_dwordx4 v2, s[48:51], 0 offen lds
v_mfma_f32_16x16x32_bf16 v[112:115], a[84:87], a[28:31], v[112:115]
v_mfma_f32_16x16x32_bf16 v[112:115], a[80:83], a[12:15], v[112:115]
v_mfma_f32_16x16x32_bf16 v[116:119], a[88:91], a[12:15], v[116:119]
ds_read_b64_tr_b16 a[80:81], v12 offset:16384
v_mfma_f32_16x16x32_bf16 v[116:119], a[92:95], a[28:31], v[116:119]
ds_read_b64_tr_b16 a[82:83], v12 offset:17408
v_mfma_f32_16x16x32_bf16 v[108:111], a[92:95], a[24:27], v[108:111]
ds_read_b64_tr_b16 a[84:85], v12 offset:24576
v_mfma_f32_16x16x32_bf16 v[108:111], a[88:91], a[8:11], v[108:111]
ds_read_b64_tr_b16 a[86:87], v12 offset:25600
s_add_u32 m0, s16, 0x8400
v_mfma_f32_16x16x32_bf16 v[100:103], a[88:91], a[4:7], v[100:103]
buffer_load_dwordx4 v3, s[48:51], 0 offen lds
v_mfma_f32_16x16x32_bf16 v[100:103], a[92:95], a[20:23], v[100:103]
v_mfma_f32_16x16x32_bf16 v[92:95], a[92:95], a[16:19], v[92:95]
v_mfma_f32_16x16x32_bf16 v[92:95], a[88:91], a[0:3], v[92:95]
s_waitcnt lgkmcnt(4)
v_mfma_f32_16x16x32_bf16 v[120:123], a[96:99], a[0:3], v[120:123]
ds_read_b64_tr_b16 a[88:89], v13 offset:16384
v_mfma_f32_16x16x32_bf16 v[120:123], a[100:103], a[16:19], v[120:123]
ds_read_b64_tr_b16 a[90:91], v13 offset:17408
v_mfma_f32_16x16x32_bf16 v[128:131], a[100:103], a[20:23], v[128:131]
ds_read_b64_tr_b16 a[92:93], v13 offset:24576
v_mfma_f32_16x16x32_bf16 v[128:131], a[96:99], a[4:7], v[128:131]
ds_read_b64_tr_b16 a[94:95], v13 offset:25600
s_add_u32 m0, s16, 0x8800
v_mfma_f32_16x16x32_bf16 v[136:139], a[96:99], a[8:11], v[136:139]
buffer_load_dwordx4 v2, s[48:51], s12 offen lds
v_mfma_f32_16x16x32_bf16 v[136:139], a[100:103], a[24:27], v[136:139]
v_mfma_f32_16x16x32_bf16 v[144:147], a[100:103], a[28:31], v[144:147]
v_mfma_f32_16x16x32_bf16 v[144:147], a[96:99], a[12:15], v[144:147]
v_mfma_f32_16x16x32_bf16 v[148:151], a[104:107], a[12:15], v[148:151]
ds_read_b64_tr_b16 a[96:97], v12 offset:16640
v_mfma_f32_16x16x32_bf16 v[148:151], a[108:111], a[28:31], v[148:151]
ds_read_b64_tr_b16 a[98:99], v12 offset:17664
v_mfma_f32_16x16x32_bf16 v[140:143], a[108:111], a[24:27], v[140:143]
ds_read_b64_tr_b16 a[100:101], v12 offset:24832
s_add_u32 m0, s16, 0x8c00
v_mfma_f32_16x16x32_bf16 v[140:143], a[104:107], a[8:11], v[140:143]
buffer_load_dwordx4 v3, s[48:51], s12 offen lds
v_mfma_f32_16x16x32_bf16 v[132:135], a[104:107], a[4:7], v[132:135]
ds_read_b64_tr_b16 a[102:103], v12 offset:25856
v_mfma_f32_16x16x32_bf16 v[132:135], a[108:111], a[20:23], v[132:135]
v_mfma_f32_16x16x32_bf16 v[124:127], a[108:111], a[16:19], v[124:127]
v_mfma_f32_16x16x32_bf16 v[124:127], a[104:107], a[0:3], v[124:127]
s_waitcnt lgkmcnt(4)
v_mfma_f32_16x16x32_bf16 v[152:155], a[0:3], a[80:83], v[152:155]
ds_read_b64_tr_b16 a[104:105], v13 offset:16640
v_mfma_f32_16x16x32_bf16 v[152:155], a[16:19], a[84:87], v[152:155]
ds_read_b64_tr_b16 a[106:107], v13 offset:17664
s_add_u32 m0, s16, 0x9000
v_mfma_f32_16x16x32_bf16 v[156:159], a[20:23], a[84:87], v[156:159]
buffer_load_dwordx4 v2, s[48:51], s13 offen lds
v_mfma_f32_16x16x32_bf16 v[156:159], a[4:7], a[80:83], v[156:159]
ds_read_b64_tr_b16 a[108:109], v13 offset:24832
v_mfma_f32_16x16x32_bf16 v[160:163], a[8:11], a[80:83], v[160:163]
ds_read_b64_tr_b16 a[110:111], v13 offset:25856
v_mfma_f32_16x16x32_bf16 v[160:163], a[24:27], a[84:87], v[160:163]
v_mfma_f32_16x16x32_bf16 v[164:167], a[28:31], a[84:87], v[164:167]
v_mfma_f32_16x16x32_bf16 v[164:167], a[12:15], a[80:83], v[164:167]
v_mfma_f32_16x16x32_bf16 v[180:183], a[12:15], a[88:91], v[180:183]
ds_read_b64_tr_b16 a[80:81], v12 offset:16896
v_mfma_f32_16x16x32_bf16 v[180:183], a[28:31], a[92:95], v[180:183]
ds_read_b64_tr_b16 a[82:83], v12 offset:17920
s_add_u32 m0, s16, 0x9400
v_mfma_f32_16x16x32_bf16 v[176:179], a[24:27], a[92:95], v[176:179]
buffer_load_dwordx4 v3, s[48:51], s13 offen lds
v_mfma_f32_16x16x32_bf16 v[176:179], a[8:11], a[88:91], v[176:179]
ds_read_b64_tr_b16 a[84:85], v12 offset:25088
v_mfma_f32_16x16x32_bf16 v[172:175], a[4:7], a[88:91], v[172:175]
ds_read_b64_tr_b16 a[86:87], v12 offset:26112
v_mfma_f32_16x16x32_bf16 v[172:175], a[20:23], a[92:95], v[172:175]
v_mfma_f32_16x16x32_bf16 v[168:171], a[16:19], a[92:95], v[168:171]
v_mfma_f32_16x16x32_bf16 v[168:171], a[0:3], a[88:91], v[168:171]
s_waitcnt lgkmcnt(4)
v_mfma_f32_16x16x32_bf16 v[184:187], a[0:3], a[96:99], v[184:187]
ds_read_b64_tr_b16 a[88:89], v13 offset:16896
s_add_u32 m0, s16, 0x9800
v_mfma_f32_16x16x32_bf16 v[184:187], a[16:19], a[100:103], v[184:187]
buffer_load_dwordx4 v2, s[48:51], s14 offen lds
v_mfma_f32_16x16x32_bf16 v[188:191], a[20:23], a[100:103], v[188:191]
ds_read_b64_tr_b16 a[90:91], v13 offset:17920
v_mfma_f32_16x16x32_bf16 v[188:191], a[4:7], a[96:99], v[188:191]
ds_read_b64_tr_b16 a[92:93], v13 offset:25088
v_mfma_f32_16x16x32_bf16 v[192:195], a[8:11], a[96:99], v[192:195]
ds_read_b64_tr_b16 a[94:95], v13 offset:26112
v_mfma_f32_16x16x32_bf16 v[192:195], a[24:27], a[100:103], v[192:195]
v_mfma_f32_16x16x32_bf16 v[196:199], a[28:31], a[100:103], v[196:199]
v_mfma_f32_16x16x32_bf16 v[196:199], a[12:15], a[96:99], v[196:199]
v_mfma_f32_16x16x32_bf16 v[212:215], a[12:15], a[104:107], v[212:215]
ds_read_b64_tr_b16 a[96:97], v12 offset:17152
s_add_u32 m0, s16, 0x9c00
v_mfma_f32_16x16x32_bf16 v[212:215], a[28:31], a[108:111], v[212:215]
buffer_load_dwordx4 v3, s[48:51], s14 offen lds
v_mfma_f32_16x16x32_bf16 v[208:211], a[24:27], a[108:111], v[208:211]
ds_read_b64_tr_b16 a[98:99], v12 offset:18176
v_lshl_add_u32 v2, s42, 7, v2
v_mfma_f32_16x16x32_bf16 v[208:211], a[8:11], a[104:107], v[208:211]
ds_read_b64_tr_b16 a[100:101], v12 offset:25344
v_lshl_add_u32 v3, s42, 7, v3
v_mfma_f32_16x16x32_bf16 v[204:207], a[4:7], a[104:107], v[204:207]
ds_read_b64_tr_b16 a[102:103], v12 offset:26368
v_mfma_f32_16x16x32_bf16 v[204:207], a[20:23], a[108:111], v[204:207]
v_mfma_f32_16x16x32_bf16 v[200:203], a[16:19], a[108:111], v[200:203]
v_mfma_f32_16x16x32_bf16 v[200:203], a[0:3], a[104:107], v[200:203]
s_mov_b32 s9, 0x0
s_waitcnt lgkmcnt(4)
v_mfma_f32_16x16x32_bf16 v[216:219], a[0:3], a[80:83], v[216:219]
buffer_load_dword a120, v19, s[44:47], s9 offen
v_mfma_f32_16x16x32_bf16 v[216:219], a[16:19], a[84:87], v[216:219]
ds_read_b64_tr_b16 a[104:105], v13 offset:17152
v_mfma_f32_16x16x32_bf16 v[220:223], a[20:23], a[84:87], v[220:223]
ds_read_b64_tr_b16 a[106:107], v13 offset:18176
v_mfma_f32_16x16x32_bf16 v[220:223], a[4:7], a[80:83], v[220:223]
ds_read_b64_tr_b16 a[108:109], v13 offset:25344
v_mfma_f32_16x16x32_bf16 v[224:227], a[8:11], a[80:83], v[224:227]
ds_read_b64_tr_b16 a[110:111], v13 offset:26368
v_add_u32 v12, 0xffff0000, v12
v_mfma_f32_16x16x32_bf16 v[224:227], a[24:27], a[84:87], v[224:227]
v_add_u32 v13, 0xffff0000, v13
v_mfma_f32_16x16x32_bf16 v[228:231], a[28:31], a[84:87], v[228:231]
v_mfma_f32_16x16x32_bf16 v[228:231], a[12:15], a[80:83], v[228:231]
v_mfma_f32_16x16x32_bf16 v[244:247], a[12:15], a[88:91], v[244:247]
s_waitcnt vmcnt(27) lgkmcnt(0)
v_mfma_f32_16x16x32_bf16 v[244:247], a[28:31], a[92:95], v[244:247]
s_barrier
s_add_u32 m0, s17, 0x10000
v_mfma_f32_16x16x32_bf16 v[240:243], a[24:27], a[92:95], v[240:243]
buffer_load_dwordx4 v5, s[56:59], 0 offen lds
v_mfma_f32_16x16x32_bf16 v[240:243], a[8:11], a[88:91], v[240:243]
ds_read_b64_tr_b16 a[80:81], v12 offset:0
v_mfma_f32_16x16x32_bf16 v[236:239], a[4:7], a[88:91], v[236:239]
ds_read_b64_tr_b16 a[82:83], v12 offset:1024
v_mfma_f32_16x16x32_bf16 v[236:239], a[20:23], a[92:95], v[236:239]
ds_read_b64_tr_b16 a[84:85], v12 offset:8192
v_mfma_f32_16x16x32_bf16 v[232:235], a[16:19], a[92:95], v[232:235]
ds_read_b64_tr_b16 a[86:87], v12 offset:9216
v_mfma_f32_16x16x32_bf16 v[232:235], a[0:3], a[88:91], v[232:235]
s_waitcnt lgkmcnt(4)
v_mfma_f32_16x16x32_bf16 v[248:251], a[0:3], a[96:99], v[248:251]
ds_read_b64_tr_b16 a[88:89], v13 offset:0
s_add_u32 m0, s17, 0x14000
v_mfma_f32_16x16x32_bf16 v[248:251], a[16:19], a[100:103], v[248:251]
buffer_load_dwordx4 v5, s[60:63], 0 offen lds
v_mfma_f32_16x16x32_bf16 v[252:255], a[20:23], a[100:103], v[252:255]
ds_read_b64_tr_b16 a[90:91], v13 offset:1024
v_mfma_f32_16x16x32_bf16 v[252:255], a[4:7], a[96:99], v[252:255]
ds_read_b64_tr_b16 a[92:93], v13 offset:8192
v_mfma_f32_16x16x32_bf16 a[232:235], a[8:11], a[96:99], a[232:235]
ds_read_b64_tr_b16 a[94:95], v13 offset:9216
v_mfma_f32_16x16x32_bf16 a[232:235], a[24:27], a[100:103], a[232:235]
v_mfma_f32_16x16x32_bf16 a[236:239], a[28:31], a[100:103], a[236:239]
v_mfma_f32_16x16x32_bf16 a[236:239], a[12:15], a[96:99], a[236:239]
s_add_u32 m0, s17, 0x10400
v_mfma_f32_16x16x32_bf16 a[252:255], a[12:15], a[104:107], a[252:255]
buffer_load_dwordx4 v5, s[56:59], s13 offen lds
v_mfma_f32_16x16x32_bf16 a[252:255], a[28:31], a[108:111], a[252:255]
ds_read_b64_tr_b16 a[96:97], v12 offset:256
v_mfma_f32_16x16x32_bf16 a[248:251], a[24:27], a[108:111], a[248:251]
ds_read_b64_tr_b16 a[98:99], v12 offset:1280
v_mfma_f32_16x16x32_bf16 a[248:251], a[8:11], a[104:107], a[248:251]
ds_read_b64_tr_b16 a[100:101], v12 offset:8448
v_mfma_f32_16x16x32_bf16 a[244:247], a[4:7], a[104:107], a[244:247]
ds_read_b64_tr_b16 a[102:103], v12 offset:9472
v_mfma_f32_16x16x32_bf16 a[244:247], a[20:23], a[108:111], a[244:247]
v_mfma_f32_16x16x32_bf16 a[240:243], a[16:19], a[108:111], a[240:243]
s_add_u32 m0, s17, 0x14400
s_waitcnt lgkmcnt(4)
v_mfma_f32_16x16x32_bf16 a[240:243], a[0:3], a[104:107], a[240:243]
buffer_load_dwordx4 v5, s[60:63], s13 offen lds
L_S3:
v_mfma_f32_16x16x32_bf16 v[24:27], a[80:83], a[32:35], v[24:27]
ds_read_b64_tr_b16 a[104:105], v13 offset:256
s_waitcnt vmcnt(22)
v_mfma_f32_16x16x32_bf16 v[24:27], a[84:87], a[48:51], v[24:27]
ds_read_b64_tr_b16 a[106:107], v13 offset:1280
v_mfma_f32_16x16x32_bf16 v[32:35], a[84:87], a[52:55], v[32:35]
ds_read_b64_tr_b16 a[108:109], v13 offset:8448
v_mfma_f32_16x16x32_bf16 v[32:35], a[80:83], a[36:39], v[32:35]
ds_read_b64_tr_b16 a[110:111], v13 offset:9472
v_mfma_f32_16x16x32_bf16 v[40:43], a[80:83], a[40:43], v[40:43]
ds_read_b128 a[0:3], v8 offset:0
v_mfma_f32_16x16x32_bf16 v[40:43], a[84:87], a[56:59], v[40:43]
ds_read_b128 a[16:19], v9 offset:0
s_add_u32 m0, s17, 0x10800
v_mfma_f32_16x16x32_bf16 v[48:51], a[84:87], a[60:63], v[48:51]
buffer_load_dwordx4 v6, s[56:59], 0 offen lds
v_mfma_f32_16x16x32_bf16 v[48:51], a[80:83], a[44:47], v[48:51]
ds_read_b128 a[4:7], v8 offset:2048
v_mfma_f32_16x16x32_bf16 v[52:55], a[88:91], a[44:47], v[52:55]
ds_read_b64_tr_b16 a[80:81], v12 offset:512
v_mfma_f32_16x16x32_bf16 v[52:55], a[92:95], a[60:63], v[52:55]
ds_read_b64_tr_b16 a[82:83], v12 offset:1536
v_mfma_f32_16x16x32_bf16 v[44:47], a[92:95], a[56:59], v[44:47]
ds_read_b64_tr_b16 a[84:85], v12 offset:8704
v_mfma_f32_16x16x32_bf16 v[44:47], a[88:91], a[40:43], v[44:47]
ds_read_b64_tr_b16 a[86:87], v12 offset:9728
v_mfma_f32_16x16x32_bf16 v[36:39], a[88:91], a[36:39], v[36:39]
ds_read_b128 a[20:23], v9 offset:2048
s_add_u32 m0, s17, 0x14800
v_mfma_f32_16x16x32_bf16 v[36:39], a[92:95], a[52:55], v[36:39]
buffer_load_dwordx4 v6, s[60:63], 0 offen lds
v_mfma_f32_16x16x32_bf16 v[28:31], a[92:95], a[48:51], v[28:31]
ds_read_b128 a[8:11], v8 offset:4096
v_mfma_f32_16x16x32_bf16 v[28:31], a[88:91], a[32:35], v[28:31]
ds_read_b128 a[24:27], v9 offset:4096
s_waitcnt lgkmcnt(10)
v_mfma_f32_16x16x32_bf16 v[56:59], a[96:99], a[32:35], v[56:59]
ds_read_b64_tr_b16 a[88:89], v13 offset:512
v_mfma_f32_16x16x32_bf16 v[56:59], a[100:103], a[48:51], v[56:59]
ds_read_b64_tr_b16 a[90:91], v13 offset:1536
v_mfma_f32_16x16x32_bf16 v[64:67], a[100:103], a[52:55], v[64:67]
ds_read_b64_tr_b16 a[92:93], v13 offset:8704
v_mfma_f32_16x16x32_bf16 v[64:67], a[96:99], a[36:39], v[64:67]
ds_read_b64_tr_b16 a[94:95], v13 offset:9728
s_add_u32 m0, s17, 0x10c00
v_mfma_f32_16x16x32_bf16 v[72:75], a[96:99], a[40:43], v[72:75]
buffer_load_dwordx4 v6, s[56:59], s13 offen lds
v_mfma_f32_16x16x32_bf16 v[72:75], a[100:103], a[56:59], v[72:75]
ds_read_b128 a[12:15], v8 offset:6144
v_mfma_f32_16x16x32_bf16 v[80:83], a[100:103], a[60:63], v[80:83]
ds_read_b128 a[28:31], v9 offset:6144
v_mfma_f32_16x16x32_bf16 v[80:83], a[96:99], a[44:47], v[80:83]
v_mfma_f32_16x16x32_bf16 v[84:87], a[104:107], a[44:47], v[84:87]
ds_read_b64_tr_b16 a[96:97], v12 offset:768
v_mfma_f32_16x16x32_bf16 v[84:87], a[108:111], a[60:63], v[84:87]
ds_read_b64_tr_b16 a[98:99], v12 offset:1792
v_mfma_f32_16x16x32_bf16 v[76:79], a[108:111], a[56:59], v[76:79]
ds_read_b64_tr_b16 a[100:101], v12 offset:8960
s_add_u32 m0, s17, 0x14c00
v_mfma_f32_16x16x32_bf16 v[76:79], a[104:107], a[40:43], v[76:79]
buffer_load_dwordx4 v6, s[60:63], s13 offen lds
v_mfma_f32_16x16x32_bf16 v[68:71], a[104:107], a[36:39], v[68:71]
ds_read_b64_tr_b16 a[102:103], v12 offset:9984
v_lshl_add_u32 v5, s42, 19, v5
v_mfma_f32_16x16x32_bf16 v[68:71], a[108:111], a[52:55], v[68:71]
v_lshl_add_u32 v6, s42, 19, v6
v_mfma_f32_16x16x32_bf16 v[60:63], a[108:111], a[48:51], v[60:63]
v_mfma_f32_16x16x32_bf16 v[60:63], a[104:107], a[32:35], v[60:63]
s_waitcnt lgkmcnt(6)
v_mfma_f32_16x16x32_bf16 v[88:91], a[80:83], a[32:35], v[88:91]
ds_read_b64_tr_b16 a[104:105], v13 offset:768
v_mfma_f32_16x16x32_bf16 v[88:91], a[84:87], a[48:51], v[88:91]
ds_read_b64_tr_b16 a[106:107], v13 offset:1792
s_mov_b32 s9, 0x200000
v_mfma_f32_16x16x32_bf16 v[96:99], a[84:87], a[52:55], v[96:99]
buffer_load_dword a120, v19, s[44:47], s9 offen
v_mfma_f32_16x16x32_bf16 v[96:99], a[80:83], a[36:39], v[96:99]
ds_read_b64_tr_b16 a[108:109], v13 offset:8960
v_mfma_f32_16x16x32_bf16 v[104:107], a[80:83], a[40:43], v[104:107]
ds_read_b64_tr_b16 a[110:111], v13 offset:9984
v_mfma_f32_16x16x32_bf16 v[104:107], a[84:87], a[56:59], v[104:107]
v_mfma_f32_16x16x32_bf16 v[112:115], a[84:87], a[60:63], v[112:115]
v_mfma_f32_16x16x32_bf16 v[112:115], a[80:83], a[44:47], v[112:115]
s_waitcnt lgkmcnt(8)
v_mfma_f32_16x16x32_bf16 v[116:119], a[88:91], a[44:47], v[116:119]
ds_read_b64_tr_b16 a[80:81], v12 offset:16384
s_add_u32 m0, s16, 0x0
v_mfma_f32_16x16x32_bf16 v[116:119], a[92:95], a[60:63], v[116:119]
buffer_load_dwordx4 v2, s[48:51], 0 offen lds
v_mfma_f32_16x16x32_bf16 v[108:111], a[92:95], a[56:59], v[108:111]
ds_read_b64_tr_b16 a[82:83], v12 offset:17408
v_mfma_f32_16x16x32_bf16 v[108:111], a[88:91], a[40:43], v[108:111]
ds_read_b64_tr_b16 a[84:85], v12 offset:24576
v_mfma_f32_16x16x32_bf16 v[100:103], a[88:91], a[36:39], v[100:103]
ds_read_b64_tr_b16 a[86:87], v12 offset:25600
v_mfma_f32_16x16x32_bf16 v[100:103], a[92:95], a[52:55], v[100:103]
v_mfma_f32_16x16x32_bf16 v[92:95], a[92:95], a[48:51], v[92:95]
v_mfma_f32_16x16x32_bf16 v[92:95], a[88:91], a[32:35], v[92:95]
s_add_u32 m0, s16, 0x400
s_waitcnt lgkmcnt(4)
v_mfma_f32_16x16x32_bf16 v[120:123], a[96:99], a[32:35], v[120:123]
buffer_load_dwordx4 v3, s[48:51], 0 offen lds
v_mfma_f32_16x16x32_bf16 v[120:123], a[100:103], a[48:51], v[120:123]
ds_read_b64_tr_b16 a[88:89], v13 offset:16384
v_mfma_f32_16x16x32_bf16 v[128:131], a[100:103], a[52:55], v[128:131]
ds_read_b64_tr_b16 a[90:91], v13 offset:17408
v_mfma_f32_16x16x32_bf16 v[128:131], a[96:99], a[36:39], v[128:131]
ds_read_b64_tr_b16 a[92:93], v13 offset:24576
v_mfma_f32_16x16x32_bf16 v[136:139], a[96:99], a[40:43], v[136:139]
ds_read_b64_tr_b16 a[94:95], v13 offset:25600
v_mfma_f32_16x16x32_bf16 v[136:139], a[100:103], a[56:59], v[136:139]
v_mfma_f32_16x16x32_bf16 v[144:147], a[100:103], a[60:63], v[144:147]
s_add_u32 m0, s16, 0x800
v_mfma_f32_16x16x32_bf16 v[144:147], a[96:99], a[44:47], v[144:147]
buffer_load_dwordx4 v2, s[48:51], s12 offen lds
v_mfma_f32_16x16x32_bf16 v[148:151], a[104:107], a[44:47], v[148:151]
ds_read_b64_tr_b16 a[96:97], v12 offset:16640
v_mfma_f32_16x16x32_bf16 v[148:151], a[108:111], a[60:63], v[148:151]
ds_read_b64_tr_b16 a[98:99], v12 offset:17664
v_mfma_f32_16x16x32_bf16 v[140:143], a[108:111], a[56:59], v[140:143]
ds_read_b64_tr_b16 a[100:101], v12 offset:24832
v_mfma_f32_16x16x32_bf16 v[140:143], a[104:107], a[40:43], v[140:143]
ds_read_b64_tr_b16 a[102:103], v12 offset:25856
v_mfma_f32_16x16x32_bf16 v[132:135], a[104:107], a[36:39], v[132:135]
v_mfma_f32_16x16x32_bf16 v[132:135], a[108:111], a[52:55], v[132:135]
s_add_u32 m0, s16, 0xc00
v_mfma_f32_16x16x32_bf16 v[124:127], a[108:111], a[48:51], v[124:127]
buffer_load_dwordx4 v3, s[48:51], s12 offen lds
v_mfma_f32_16x16x32_bf16 v[124:127], a[104:107], a[32:35], v[124:127]
s_waitcnt lgkmcnt(4)
v_mfma_f32_16x16x32_bf16 v[152:155], a[32:35], a[80:83], v[152:155]
ds_read_b64_tr_b16 a[104:105], v13 offset:16640
v_mfma_f32_16x16x32_bf16 v[152:155], a[48:51], a[84:87], v[152:155]
ds_read_b64_tr_b16 a[106:107], v13 offset:17664
v_mfma_f32_16x16x32_bf16 v[156:159], a[52:55], a[84:87], v[156:159]
ds_read_b64_tr_b16 a[108:109], v13 offset:24832
v_mfma_f32_16x16x32_bf16 v[156:159], a[36:39], a[80:83], v[156:159]
ds_read_b64_tr_b16 a[110:111], v13 offset:25856
v_mfma_f32_16x16x32_bf16 v[160:163], a[40:43], a[80:83], v[160:163]
s_add_u32 m0, s16, 0x1000
v_mfma_f32_16x16x32_bf16 v[160:163], a[56:59], a[84:87], v[160:163]
buffer_load_dwordx4 v2, s[48:51], s13 offen lds
v_mfma_f32_16x16x32_bf16 v[164:167], a[60:63], a[84:87], v[164:167]
v_mfma_f32_16x16x32_bf16 v[164:167], a[44:47], a[80:83], v[164:167]
v_mfma_f32_16x16x32_bf16 v[180:183], a[44:47], a[88:91], v[180:183]
ds_read_b64_tr_b16 a[80:81], v12 offset:16896
v_mfma_f32_16x16x32_bf16 v[180:183], a[60:63], a[92:95], v[180:183]
ds_read_b64_tr_b16 a[82:83], v12 offset:17920
v_mfma_f32_16x16x32_bf16 v[176:179], a[56:59], a[92:95], v[176:179]
ds_read_b64_tr_b16 a[84:85], v12 offset:25088
v_mfma_f32_16x16x32_bf16 v[176:179], a[40:43], a[88:91], v[176:179]
ds_read_b64_tr_b16 a[86:87], v12 offset:26112
s_add_u32 m0, s16, 0x1400
v_mfma_f32_16x16x32_bf16 v[172:175], a[36:39], a[88:91], v[172:175]
buffer_load_dwordx4 v3, s[48:51], s13 offen lds
v_mfma_f32_16x16x32_bf16 v[172:175], a[52:55], a[92:95], v[172:175]
v_mfma_f32_16x16x32_bf16 v[168:171], a[48:51], a[92:95], v[168:171]
v_mfma_f32_16x16x32_bf16 v[168:171], a[32:35], a[88:91], v[168:171]
s_waitcnt lgkmcnt(4)
v_mfma_f32_16x16x32_bf16 v[184:187], a[32:35], a[96:99], v[184:187]
ds_read_b64_tr_b16 a[88:89], v13 offset:16896
v_mfma_f32_16x16x32_bf16 v[184:187], a[48:51], a[100:103], v[184:187]
ds_read_b64_tr_b16 a[90:91], v13 offset:17920
v_mfma_f32_16x16x32_bf16 v[188:191], a[52:55], a[100:103], v[188:191]
ds_read_b64_tr_b16 a[92:93], v13 offset:25088
s_add_u32 m0, s16, 0x1800
v_mfma_f32_16x16x32_bf16 v[188:191], a[36:39], a[96:99], v[188:191]
buffer_load_dwordx4 v2, s[48:51], s14 offen lds
v_mfma_f32_16x16x32_bf16 v[192:195], a[40:43], a[96:99], v[192:195]
ds_read_b64_tr_b16 a[94:95], v13 offset:26112
v_mfma_f32_16x16x32_bf16 v[192:195], a[56:59], a[100:103], v[192:195]
v_mfma_f32_16x16x32_bf16 v[196:199], a[60:63], a[100:103], v[196:199]
v_mfma_f32_16x16x32_bf16 v[196:199], a[44:47], a[96:99], v[196:199]
v_mfma_f32_16x16x32_bf16 v[212:215], a[44:47], a[104:107], v[212:215]
ds_read_b64_tr_b16 a[96:97], v12 offset:17152
v_mfma_f32_16x16x32_bf16 v[212:215], a[60:63], a[108:111], v[212:215]
ds_read_b64_tr_b16 a[98:99], v12 offset:18176
s_add_u32 m0, s16, 0x1c00
v_mfma_f32_16x16x32_bf16 v[208:211], a[56:59], a[108:111], v[208:211]
buffer_load_dwordx4 v3, s[48:51], s14 offen lds
v_mfma_f32_16x16x32_bf16 v[208:211], a[40:43], a[104:107], v[208:211]
ds_read_b64_tr_b16 a[100:101], v12 offset:25344
v_lshl_add_u32 v2, s42, 7, v2
v_mfma_f32_16x16x32_bf16 v[204:207], a[36:39], a[104:107], v[204:207]
ds_read_b64_tr_b16 a[102:103], v12 offset:26368
v_lshl_add_u32 v3, s42, 7, v3
v_mfma_f32_16x16x32_bf16 v[204:207], a[52:55], a[108:111], v[204:207]
v_mfma_f32_16x16x32_bf16 v[200:203], a[48:51], a[108:111], v[200:203]
v_mfma_f32_16x16x32_bf16 v[200:203], a[32:35], a[104:107], v[200:203]
s_waitcnt lgkmcnt(4)
v_mfma_f32_16x16x32_bf16 v[216:219], a[32:35], a[80:83], v[216:219]
ds_read_b64_tr_b16 a[104:105], v13 offset:17152
s_mov_b32 s9, 0x0
v_mfma_f32_16x16x32_bf16 v[216:219], a[48:51], a[84:87], v[216:219]
buffer_load_dword a120, v18, s[52:55], s9 offen
v_mfma_f32_16x16x32_bf16 v[220:223], a[52:55], a[84:87], v[220:223]
ds_read_b64_tr_b16 a[106:107], v13 offset:18176
v_mfma_f32_16x16x32_bf16 v[220:223], a[36:39], a[80:83], v[220:223]
ds_read_b64_tr_b16 a[108:109], v13 offset:25344
v_mfma_f32_16x16x32_bf16 v[224:227], a[40:43], a[80:83], v[224:227]
ds_read_b64_tr_b16 a[110:111], v13 offset:26368
v_add_u32 v12, 0x8000, v12
v_mfma_f32_16x16x32_bf16 v[224:227], a[56:59], a[84:87], v[224:227]
v_add_u32 v13, 0x8000, v13
v_mfma_f32_16x16x32_bf16 v[228:231], a[60:63], a[84:87], v[228:231]
v_mfma_f32_16x16x32_bf16 v[228:231], a[44:47], a[80:83], v[228:231]
v_mfma_f32_16x16x32_bf16 v[244:247], a[44:47], a[88:91], v[244:247]
s_waitcnt vmcnt(27) lgkmcnt(0)
v_mfma_f32_16x16x32_bf16 v[244:247], a[60:63], a[92:95], v[244:247]
s_barrier
s_add_u32 m0, s17, 0x0
v_mfma_f32_16x16x32_bf16 v[240:243], a[56:59], a[92:95], v[240:243]
buffer_load_dwordx4 v5, s[56:59], 0 offen lds
v_mfma_f32_16x16x32_bf16 v[240:243], a[40:43], a[88:91], v[240:243]
ds_read_b64_tr_b16 a[80:81], v12 offset:0
v_mfma_f32_16x16x32_bf16 v[236:239], a[36:39], a[88:91], v[236:239]
ds_read_b64_tr_b16 a[82:83], v12 offset:1024
v_mfma_f32_16x16x32_bf16 v[236:239], a[52:55], a[92:95], v[236:239]
ds_read_b64_tr_b16 a[84:85], v12 offset:8192
v_mfma_f32_16x16x32_bf16 v[232:235], a[48:51], a[92:95], v[232:235]
ds_read_b64_tr_b16 a[86:87], v12 offset:9216
v_mfma_f32_16x16x32_bf16 v[232:235], a[32:35], a[88:91], v[232:235]
s_waitcnt lgkmcnt(4)
v_mfma_f32_16x16x32_bf16 v[248:251], a[32:35], a[96:99], v[248:251]
ds_read_b64_tr_b16 a[88:89], v13 offset:0
s_add_u32 m0, s17, 0x4000
v_mfma_f32_16x16x32_bf16 v[248:251], a[48:51], a[100:103], v[248:251]
buffer_load_dwordx4 v5, s[60:63], 0 offen lds
v_mfma_f32_16x16x32_bf16 v[252:255], a[52:55], a[100:103], v[252:255]
ds_read_b64_tr_b16 a[90:91], v13 offset:1024
v_mfma_f32_16x16x32_bf16 v[252:255], a[36:39], a[96:99], v[252:255]
ds_read_b64_tr_b16 a[92:93], v13 offset:8192
v_mfma_f32_16x16x32_bf16 a[232:235], a[40:43], a[96:99], a[232:235]
ds_read_b64_tr_b16 a[94:95], v13 offset:9216
v_mfma_f32_16x16x32_bf16 a[232:235], a[56:59], a[100:103], a[232:235]
L_padA2:
s_cmp_eq_u32 s95, 1
s_cbranch_scc1 L_padA6
v_mfma_f32_16x16x32_bf16 a[236:239], a[60:63], a[100:103], a[236:239]
v_mfma_f32_16x16x32_bf16 a[236:239], a[44:47], a[96:99], a[236:239]
s_add_u32 m0, s17, 0x400
v_mfma_f32_16x16x32_bf16 a[252:255], a[44:47], a[104:107], a[252:255]
buffer_load_dwordx4 v5, s[56:59], s13 offen lds
v_mfma_f32_16x16x32_bf16 a[252:255], a[60:63], a[108:111], a[252:255]
ds_read_b64_tr_b16 a[96:97], v12 offset:256
v_mfma_f32_16x16x32_bf16 a[248:251], a[56:59], a[108:111], a[248:251]
ds_read_b64_tr_b16 a[98:99], v12 offset:1280
v_mfma_f32_16x16x32_bf16 a[248:251], a[40:43], a[104:107], a[248:251]
ds_read_b64_tr_b16 a[100:101], v12 offset:8448
v_mfma_f32_16x16x32_bf16 a[244:247], a[36:39], a[104:107], a[244:247]
ds_read_b64_tr_b16 a[102:103], v12 offset:9472
v_mfma_f32_16x16x32_bf16 a[244:247], a[52:55], a[108:111], a[244:247]
v_mfma_f32_16x16x32_bf16 a[240:243], a[48:51], a[108:111], a[240:243]
s_add_u32 m0, s17, 0x4400
s_waitcnt lgkmcnt(4)
v_mfma_f32_16x16x32_bf16 a[240:243], a[32:35], a[104:107], a[240:243]
buffer_load_dwordx4 v5, s[60:63], s13 offen lds
L_S4:
v_mfma_f32_16x16x32_bf16 v[24:27], a[80:83], a[0:3], v[24:27]
ds_read_b64_tr_b16 a[104:105], v13 offset:256
s_waitcnt vmcnt(23)
v_mfma_f32_16x16x32_bf16 v[24:27], a[84:87], a[16:19], v[24:27]
ds_read_b64_tr_b16 a[106:107], v13 offset:1280
v_mfma_f32_16x16x32_bf16 v[32:35], a[84:87], a[20:23], v[32:35]
ds_read_b64_tr_b16 a[108:109], v13 offset:8448
v_mfma_f32_16x16x32_bf16 v[32:35], a[80:83], a[4:7], v[32:35]
ds_read_b64_tr_b16 a[110:111], v13 offset:9472
v_mfma_f32_16x16x32_bf16 v[40:43], a[80:83], a[8:11], v[40:43]
ds_read_b128 a[32:35], v8 offset:32768
v_mfma_f32_16x16x32_bf16 v[40:43], a[84:87], a[24:27], v[40:43]
ds_read_b128 a[48:51], v9 offset:32768
s_add_u32 m0, s17, 0x800
v_mfma_f32_16x16x32_bf16 v[48:51], a[84:87], a[28:31], v[48:51]
buffer_load_dwordx4 v6, s[56:59], 0 offen lds
v_mfma_f32_16x16x32_bf16 v[48:51], a[80:83], a[12:15], v[48:51]
ds_read_b128 a[36:39], v8 offset:34816
v_mfma_f32_16x16x32_bf16 v[52:55], a[88:91], a[12:15], v[52:55]
ds_read_b64_tr_b16 a[80:81], v12 offset:512
v_mfma_f32_16x16x32_bf16 v[52:55], a[92:95], a[28:31], v[52:55]
ds_read_b64_tr_b16 a[82:83], v12 offset:1536
v_mfma_f32_16x16x32_bf16 v[44:47], a[92:95], a[24:27], v[44:47]
ds_read_b64_tr_b16 a[84:85], v12 offset:8704
v_mfma_f32_16x16x32_bf16 v[44:47], a[88:91], a[8:11], v[44:47]
ds_read_b64_tr_b16 a[86:87], v12 offset:9728
v_mfma_f32_16x16x32_bf16 v[36:39], a[88:91], a[4:7], v[36:39]
ds_read_b128 a[52:55], v9 offset:34816
s_add_u32 m0, s17, 0x4800
v_mfma_f32_16x16x32_bf16 v[36:39], a[92:95], a[20:23], v[36:39]
buffer_load_dwordx4 v6, s[60:63], 0 offen lds
v_mfma_f32_16x16x32_bf16 v[28:31], a[92:95], a[16:19], v[28:31]
ds_read_b128 a[40:43], v8 offset:36864
v_mfma_f32_16x16x32_bf16 v[28:31], a[88:91], a[0:3], v[28:31]
ds_read_b128 a[56:59], v9 offset:36864
s_waitcnt lgkmcnt(10)
v_mfma_f32_16x16x32_bf16 v[56:59], a[96:99], a[0:3], v[56:59]
ds_read_b64_tr_b16 a[88:89], v13 offset:512
v_mfma_f32_16x16x32_bf16 v[56:59], a[100:103], a[16:19], v[56:59]
ds_read_b64_tr_b16 a[90:91], v13 offset:1536
v_mfma_f32_16x16x32_bf16 v[64:67], a[100:103], a[20:23], v[64:67]
ds_read_b64_tr_b16 a[92:93], v13 offset:8704
v_mfma_f32_16x16x32_bf16 v[64:67], a[96:99], a[4:7], v[64:67]
ds_read_b64_tr_b16 a[94:95], v13 offset:9728
s_add_u32 m0, s17, 0xc00
v_mfma_f32_16x16x32_bf16 v[72:75], a[96:99], a[8:11], v[72:75]
buffer_load_dwordx4 v6, s[56:59], s13 offen lds
v_mfma_f32_16x16x32_bf16 v[72:75], a[100:103], a[24:27], v[72:75]
ds_read_b128 a[44:47], v8 offset:38912
v_mfma_f32_16x16x32_bf16 v[80:83], a[100:103], a[28:31], v[80:83]
ds_read_b128 a[60:63], v9 offset:38912
v_mfma_f32_16x16x32_bf16 v[80:83], a[96:99], a[12:15], v[80:83]
v_mfma_f32_16x16x32_bf16 v[84:87], a[104:107], a[12:15], v[84:87]
ds_read_b64_tr_b16 a[96:97], v12 offset:768
v_mfma_f32_16x16x32_bf16 v[84:87], a[108:111], a[28:31], v[84:87]
ds_read_b64_tr_b16 a[98:99], v12 offset:1792
v_mfma_f32_16x16x32_bf16 v[76:79], a[108:111], a[24:27], v[76:79]
ds_read_b64_tr_b16 a[100:101], v12 offset:8960
s_add_u32 m0, s17, 0x4c00
v_mfma_f32_16x16x32_bf16 v[76:79], a[104:107], a[8:11], v[76:79]
buffer_load_dwordx4 v6, s[60:63], s13 offen lds
v_mfma_f32_16x16x32_bf16 v[68:71], a[104:107], a[4:7], v[68:71]
ds_read_b64_tr_b16 a[102:103], v12 offset:9984
v_lshl_add_u32 v5, s42, 19, v5
v_mfma_f32_16x16x32_bf16 v[68:71], a[108:111], a[20:23], v[68:71]
v_lshl_add_u32 v6, s42, 19, v6
v_mfma_f32_16x16x32_bf16 v[60:63], a[108:111], a[16:19], v[60:63]
v_mfma_f32_16x16x32_bf16 v[60:63], a[104:107], a[0:3], v[60:63]
s_waitcnt lgkmcnt(6)
v_mfma_f32_16x16x32_bf16 v[88:91], a[80:83], a[0:3], v[88:91]
ds_read_b64_tr_b16 a[104:105], v13 offset:768
v_mfma_f32_16x16x32_bf16 v[88:91], a[84:87], a[16:19], v[88:91]
ds_read_b64_tr_b16 a[106:107], v13 offset:1792
s_mov_b32 s9, 0x0
v_mfma_f32_16x16x32_bf16 v[96:99], a[84:87], a[20:23], v[96:99]
buffer_load_dword a120, v1, s[68:71], s9 offen
v_mfma_f32_16x16x32_bf16 v[96:99], a[80:83], a[4:7], v[96:99]
ds_read_b64_tr_b16 a[108:109], v13 offset:8960
v_mfma_f32_16x16x32_bf16 v[104:107], a[80:83], a[8:11], v[104:107]
ds_read_b64_tr_b16 a[110:111], v13 offset:9984
v_mfma_f32_16x16x32_bf16 v[104:107], a[84:87], a[24:27], v[104:107]
v_mfma_f32_16x16x32_bf16 v[112:115], a[84:87], a[28:31], v[112:115]
v_mfma_f32_16x16x32_bf16 v[112:115], a[80:83], a[12:15], v[112:115]
s_waitcnt lgkmcnt(8)
v_mfma_f32_16x16x32_bf16 v[116:119], a[88:91], a[12:15], v[116:119]
ds_read_b64_tr_b16 a[80:81], v12 offset:16384
s_add_u32 m0, s16, 0x8000
v_mfma_f32_16x16x32_bf16 v[116:119], a[92:95], a[28:31], v[116:119]
buffer_load_dwordx4 v2, s[48:51], 0 offen lds
v_mfma_f32_16x16x32_bf16 v[108:111], a[92:95], a[24:27], v[108:111]
ds_read_b64_tr_b16 a[82:83], v12 offset:17408
v_mfma_f32_16x16x32_bf16 v[108:111], a[88:91], a[8:11], v[108:111]
ds_read_b64_tr_b16 a[84:85], v12 offset:24576
v_mfma_f32_16x16x32_bf16 v[100:103], a[88:91], a[4:7], v[100:103]
ds_read_b64_tr_b16 a[86:87], v12 offset:25600
v_mfma_f32_16x16x32_bf16 v[100:103], a[92:95], a[20:23], v[100:103]
v_mfma_f32_16x16x32_bf16 v[92:95], a[92:95], a[16:19], v[92:95]
v_mfma_f32_16x16x32_bf16 v[92:95], a[88:91], a[0:3], v[92:95]
s_add_u32 m0, s16, 0x8400
s_waitcnt lgkmcnt(4)
v_mfma_f32_16x16x32_bf16 v[120:123], a[96:99], a[0:3], v[120:123]
buffer_load_dwordx4 v3, s[48:51], 0 offen lds
v_mfma_f32_16x16x32_bf16 v[120:123], a[100:103], a[16:19], v[120:123]
ds_read_b64_tr_b16 a[88:89], v13 offset:16384
v_mfma_f32_16x16x32_bf16 v[128:131], a[100:103], a[20:23], v[128:131]
ds_read_b64_tr_b16 a[90:91], v13 offset:17408
v_mfma_f32_16x16x32_bf16 v[128:131], a[96:99], a[4:7], v[128:131]
ds_read_b64_tr_b16 a[92:93], v13 offset:24576
v_mfma_f32_16x16x32_bf16 v[136:139], a[96:99], a[8:11], v[136:139]
ds_read_b64_tr_b16 a[94:95], v13 offset:25600
v_mfma_f32_16x16x32_bf16 v[136:139], a[100:103], a[24:27], v[136:139]
v_mfma_f32_16x16x32_bf16 v[144:147], a[100:103], a[28:31], v[144:147]
s_add_u32 m0, s16, 0x8800
v_mfma_f32_16x16x32_bf16 v[144:147], a[96:99], a[12:15], v[144:147]
buffer_load_dwordx4 v2, s[48:51], s12 offen lds
v_mfma_f32_16x16x32_bf16 v[148:151], a[104:107], a[12:15], v[148:151]
ds_read_b64_tr_b16 a[96:97], v12 offset:16640
v_mfma_f32_16x16x32_bf16 v[148:151], a[108:111], a[28:31], v[148:151]
ds_read_b64_tr_b16 a[98:99], v12 offset:17664
v_mfma_f32_16x16x32_bf16 v[140:143], a[108:111], a[24:27], v[140:143]
ds_read_b64_tr_b16 a[100:101], v12 offset:24832
v_mfma_f32_16x16x32_bf16 v[140:143], a[104:107], a[8:11], v[140:143]
ds_read_b64_tr_b16 a[102:103], v12 offset:25856
v_mfma_f32_16x16x32_bf16 v[132:135], a[104:107], a[4:7], v[132:135]
v_mfma_f32_16x16x32_bf16 v[132:135], a[108:111], a[20:23], v[132:135]
s_add_u32 m0, s16, 0x8c00
v_mfma_f32_16x16x32_bf16 v[124:127], a[108:111], a[16:19], v[124:127]
buffer_load_dwordx4 v3, s[48:51], s12 offen lds
v_mfma_f32_16x16x32_bf16 v[124:127], a[104:107], a[0:3], v[124:127]
s_waitcnt lgkmcnt(4)
v_mfma_f32_16x16x32_bf16 v[152:155], a[0:3], a[80:83], v[152:155]
ds_read_b64_tr_b16 a[104:105], v13 offset:16640
v_mfma_f32_16x16x32_bf16 v[152:155], a[16:19], a[84:87], v[152:155]
ds_read_b64_tr_b16 a[106:107], v13 offset:17664
v_mfma_f32_16x16x32_bf16 v[156:159], a[20:23], a[84:87], v[156:159]
ds_read_b64_tr_b16 a[108:109], v13 offset:24832
v_mfma_f32_16x16x32_bf16 v[156:159], a[4:7], a[80:83], v[156:159]
ds_read_b64_tr_b16 a[110:111], v13 offset:25856
v_mfma_f32_16x16x32_bf16 v[160:163], a[8:11], a[80:83], v[160:163]
s_add_u32 m0, s16, 0x9000
v_mfma_f32_16x16x32_bf16 v[160:163], a[24:27], a[84:87], v[160:163]
buffer_load_dwordx4 v2, s[48:51], s13 offen lds
v_mfma_f32_16x16x32_bf16 v[164:167], a[28:31], a[84:87], v[164:167]
v_mfma_f32_16x16x32_bf16 v[164:167], a[12:15], a[80:83], v[164:167]
v_mfma_f32_16x16x32_bf16 v[180:183], a[12:15], a[88:91], v[180:183]
ds_read_b64_tr_b16 a[80:81], v12 offset:16896
v_mfma_f32_16x16x32_bf16 v[180:183], a[28:31], a[92:95], v[180:183]
ds_read_b64_tr_b16 a[82:83], v12 offset:17920
v_mfma_f32_16x16x32_bf16 v[176:179], a[24:27], a[92:95], v[176:179]
ds_read_b64_tr_b16 a[84:85], v12 offset:25088
v_mfma_f32_16x16x32_bf16 v[176:179], a[8:11], a[88:91], v[176:179]
ds_read_b64_tr_b16 a[86:87], v12 offset:26112
s_add_u32 m0, s16, 0x9400
v_mfma_f32_16x16x32_bf16 v[172:175], a[4:7], a[88:91], v[172:175]
buffer_load_dwordx4 v3, s[48:51], s13 offen lds
v_mfma_f32_16x16x32_bf16 v[172:175], a[20:23], a[92:95], v[172:175]
v_mfma_f32_16x16x32_bf16 v[168:171], a[16:19], a[92:95], v[168:171]
v_mfma_f32_16x16x32_bf16 v[168:171], a[0:3], a[88:91], v[168:171]
s_waitcnt lgkmcnt(4)
v_mfma_f32_16x16x32_bf16 v[184:187], a[0:3], a[96:99], v[184:187]
ds_read_b64_tr_b16 a[88:89], v13 offset:16896
v_mfma_f32_16x16x32_bf16 v[184:187], a[16:19], a[100:103], v[184:187]
ds_read_b64_tr_b16 a[90:91], v13 offset:17920
v_mfma_f32_16x16x32_bf16 v[188:191], a[20:23], a[100:103], v[188:191]
ds_read_b64_tr_b16 a[92:93], v13 offset:25088
s_add_u32 m0, s16, 0x9800
v_mfma_f32_16x16x32_bf16 v[188:191], a[4:7], a[96:99], v[188:191]
buffer_load_dwordx4 v2, s[48:51], s14 offen lds
v_mfma_f32_16x16x32_bf16 v[192:195], a[8:11], a[96:99], v[192:195]
ds_read_b64_tr_b16 a[94:95], v13 offset:26112
v_mfma_f32_16x16x32_bf16 v[192:195], a[24:27], a[100:103], v[192:195]
v_mfma_f32_16x16x32_bf16 v[196:199], a[28:31], a[100:103], v[196:199]
v_mfma_f32_16x16x32_bf16 v[196:199], a[12:15], a[96:99], v[196:199]
v_mfma_f32_16x16x32_bf16 v[212:215], a[12:15], a[104:107], v[212:215]
ds_read_b64_tr_b16 a[96:97], v12 offset:17152
v_mfma_f32_16x16x32_bf16 v[212:215], a[28:31], a[108:111], v[212:215]
ds_read_b64_tr_b16 a[98:99], v12 offset:18176
s_add_u32 m0, s16, 0x9c00
v_mfma_f32_16x16x32_bf16 v[208:211], a[24:27], a[108:111], v[208:211]
buffer_load_dwordx4 v3, s[48:51], s14 offen lds
v_mfma_f32_16x16x32_bf16 v[208:211], a[8:11], a[104:107], v[208:211]
ds_read_b64_tr_b16 a[100:101], v12 offset:25344
s_sub_u32 s42, s43, s41
v_mfma_f32_16x16x32_bf16 v[204:207], a[4:7], a[104:107], v[204:207]
ds_read_b64_tr_b16 a[102:103], v12 offset:26368
s_mov_b32 s41, s43
v_mfma_f32_16x16x32_bf16 v[204:207], a[20:23], a[108:111], v[204:207]
v_mfma_f32_16x16x32_bf16 v[200:203], a[16:19], a[108:111], v[200:203]
v_mfma_f32_16x16x32_bf16 v[200:203], a[0:3], a[104:107], v[200:203]
s_waitcnt lgkmcnt(4)
v_mfma_f32_16x16x32_bf16 v[216:219], a[0:3], a[80:83], v[216:219]
ds_read_b64_tr_b16 a[104:105], v13 offset:17152
s_mov_b32 s9, 0x800
v_mfma_f32_16x16x32_bf16 v[216:219], a[16:19], a[84:87], v[216:219]
buffer_load_dword a120, v1, s[68:71], s9 offen
v_mfma_f32_16x16x32_bf16 v[220:223], a[20:23], a[84:87], v[220:223]
ds_read_b64_tr_b16 a[106:107], v13 offset:18176
v_mfma_f32_16x16x32_bf16 v[220:223], a[4:7], a[80:83], v[220:223]
ds_read_b64_tr_b16 a[108:109], v13 offset:25344
v_mfma_f32_16x16x32_bf16 v[224:227], a[8:11], a[80:83], v[224:227]
ds_read_b64_tr_b16 a[110:111], v13 offset:26368
v_add_u32 v12, 0x8000, v12
v_mfma_f32_16x16x32_bf16 v[224:227], a[24:27], a[84:87], v[224:227]
v_add_u32 v13, 0x8000, v13
v_mfma_f32_16x16x32_bf16 v[228:231], a[28:31], a[84:87], v[228:231]
v_mfma_f32_16x16x32_bf16 v[228:231], a[12:15], a[80:83], v[228:231]
v_mfma_f32_16x16x32_bf16 v[244:247], a[12:15], a[88:91], v[244:247]
s_waitcnt vmcnt(28) lgkmcnt(0)
v_mfma_f32_16x16x32_bf16 v[244:247], a[28:31], a[92:95], v[244:247]
s_barrier
s_add_u32 m0, s17, 0x8000
v_mfma_f32_16x16x32_bf16 v[240:243], a[24:27], a[92:95], v[240:243]
buffer_load_dwordx4 v5, s[56:59], 0 offen lds
v_mfma_f32_16x16x32_bf16 v[240:243], a[8:11], a[88:91], v[240:243]
ds_read_b64_tr_b16 a[80:81], v12 offset:0
v_mfma_f32_16x16x32_bf16 v[236:239], a[4:7], a[88:91], v[236:239]
ds_read_b64_tr_b16 a[82:83], v12 offset:1024
v_mfma_f32_16x16x32_bf16 v[236:239], a[20:23], a[92:95], v[236:239]
ds_read_b64_tr_b16 a[84:85], v12 offset:8192
v_mfma_f32_16x16x32_bf16 v[232:235], a[16:19], a[92:95], v[232:235]
ds_read_b64_tr_b16 a[86:87], v12 offset:9216
v_mfma_f32_16x16x32_bf16 v[232:235], a[0:3], a[88:91], v[232:235]
s_waitcnt lgkmcnt(4)
v_mfma_f32_16x16x32_bf16 v[248:251], a[0:3], a[96:99], v[248:251]
ds_read_b64_tr_b16 a[88:89], v13 offset:0
s_add_u32 m0, s17, 0xc000
v_mfma_f32_16x16x32_bf16 v[248:251], a[16:19], a[100:103], v[248:251]
buffer_load_dwordx4 v5, s[60:63], 0 offen lds
v_mfma_f32_16x16x32_bf16 v[252:255], a[20:23], a[100:103], v[252:255]
ds_read_b64_tr_b16 a[90:91], v13 offset:1024
v_mfma_f32_16x16x32_bf16 v[252:255], a[4:7], a[96:99], v[252:255]
ds_read_b64_tr_b16 a[92:93], v13 offset:8192
v_mfma_f32_16x16x32_bf16 a[232:235], a[8:11], a[96:99], a[232:235]
ds_read_b64_tr_b16 a[94:95], v13 offset:9216
v_mfma_f32_16x16x32_bf16 a[232:235], a[24:27], a[100:103], a[232:235]
v_mfma_f32_16x16x32_bf16 a[236:239], a[28:31], a[100:103], a[236:239]
v_mfma_f32_16x16x32_bf16 a[236:239], a[12:15], a[96:99], a[236:239]
s_add_u32 m0, s17, 0x8400
v_mfma_f32_16x16x32_bf16 a[252:255], a[12:15], a[104:107], a[252:255]
buffer_load_dwordx4 v5, s[56:59], s13 offen lds
v_mfma_f32_16x16x32_bf16 a[252:255], a[28:31], a[108:111], a[252:255]
ds_read_b64_tr_b16 a[96:97], v12 offset:256
v_mfma_f32_16x16x32_bf16 a[248:251], a[24:27], a[108:111], a[248:251]
ds_read_b64_tr_b16 a[98:99], v12 offset:1280
v_mfma_f32_16x16x32_bf16 a[248:251], a[8:11], a[104:107], a[248:251]
ds_read_b64_tr_b16 a[100:101], v12 offset:8448
v_mfma_f32_16x16x32_bf16 a[244:247], a[4:7], a[104:107], a[244:247]
ds_read_b64_tr_b16 a[102:103], v12 offset:9472
v_mfma_f32_16x16x32_bf16 a[244:247], a[20:23], a[108:111], a[244:247]
v_mfma_f32_16x16x32_bf16 a[240:243], a[16:19], a[108:111], a[240:243]
v_mfma_f32_16x16x32_bf16 a[240:243], a[0:3], a[104:107], a[240:243]
s_add_u32 m0, s17, 0xc400
s_waitcnt lgkmcnt(4)
L_S5:
v_mfma_f32_16x16x32_bf16 v[24:27], a[80:83], a[32:35], v[24:27]
buffer_load_dwordx4 v5, s[60:63], s13 offen lds
v_mfma_f32_16x16x32_bf16 v[24:27], a[84:87], a[48:51], v[24:27]
ds_read_b64_tr_b16 a[104:105], v13 offset:256
s_waitcnt vmcnt(23)
v_mfma_f32_16x16x32_bf16 v[32:35], a[84:87], a[52:55], v[32:35]
ds_read_b64_tr_b16 a[106:107], v13 offset:1280
v_mfma_f32_16x16x32_bf16 v[32:35], a[80:83], a[36:39], v[32:35]
ds_read_b64_tr_b16 a[108:109], v13 offset:8448
v_mfma_f32_16x16x32_bf16 v[40:43], a[80:83], a[40:43], v[40:43]
ds_read_b64_tr_b16 a[110:111], v13 offset:9472
v_mfma_f32_16x16x32_bf16 v[40:43], a[84:87], a[56:59], v[40:43]
ds_read_b128 a[0:3], v8 offset:0
v_mfma_f32_16x16x32_bf16 v[48:51], a[84:87], a[60:63], v[48:51]
ds_read_b128 a[16:19], v9 offset:0
s_add_u32 m0, s17, 0x8800
v_mfma_f32_16x16x32_bf16 v[48:51], a[80:83], a[44:47], v[48:51]
buffer_load_dwordx4 v6, s[56:59], 0 offen lds
v_mfma_f32_16x16x32_bf16 v[52:55], a[88:91], a[44:47], v[52:55]
ds_read_b64_tr_b16 a[80:81], v12 offset:512
v_mfma_f32_16x16x32_bf16 v[52:55], a[92:95], a[60:63], v[52:55]
ds_read_b64_tr_b16 a[82:83], v12 offset:1536
v_mfma_f32_16x16x32_bf16 v[44:47], a[92:95], a[56:59], v[44:47]
ds_read_b64_tr_b16 a[84:85], v12 offset:8704
v_mfma_f32_16x16x32_bf16 v[44:47], a[88:91], a[40:43], v[44:47]
ds_read_b64_tr_b16 a[86:87], v12 offset:9728
v_mfma_f32_16x16x32_bf16 v[36:39], a[88:91], a[36:39], v[36:39]
ds_read_b128 a[4:7], v8 offset:2048
v_mfma_f32_16x16x32_bf16 v[36:39], a[92:95], a[52:55], v[36:39]
ds_read_b128 a[20:23], v9 offset:2048
s_waitcnt lgkmcnt(8)
v_mfma_f32_16x16x32_bf16 v[28:31], a[92:95], a[48:51], v[28:31]
ds_read_b128 a[8:11], v8 offset:4096
s_add_u32 m0, s17, 0xc800
v_mfma_f32_16x16x32_bf16 v[28:31], a[88:91], a[32:35], v[28:31]
buffer_load_dwordx4 v6, s[60:63], 0 offen lds
v_mfma_f32_16x16x32_bf16 v[56:59], a[96:99], a[32:35], v[56:59]
ds_read_b64_tr_b16 a[88:89], v13 offset:512
v_mfma_f32_16x16x32_bf16 v[56:59], a[100:103], a[48:51], v[56:59]
ds_read_b64_tr_b16 a[90:91], v13 offset:1536
v_mfma_f32_16x16x32_bf16 v[64:67], a[100:103], a[52:55], v[64:67]
ds_read_b64_tr_b16 a[92:93], v13 offset:8704
v_mfma_f32_16x16x32_bf16 v[64:67], a[96:99], a[36:39], v[64:67]
ds_read_b64_tr_b16 a[94:95], v13 offset:9728
v_mfma_f32_16x16x32_bf16 v[72:75], a[96:99], a[40:43], v[72:75]
ds_read_b128 a[24:27], v9 offset:4096
v_mfma_f32_16x16x32_bf16 v[72:75], a[100:103], a[56:59], v[72:75]
ds_read_b128 a[12:15], v8 offset:6144
s_add_u32 m0, s17, 0x8c00
v_mfma_f32_16x16x32_bf16 v[80:83], a[100:103], a[60:63], v[80:83]
buffer_load_dwordx4 v6, s[56:59], s13 offen lds
v_mfma_f32_16x16x32_bf16 v[80:83], a[96:99], a[44:47], v[80:83]
ds_read_b128 a[28:31], v9 offset:6144
v_mfma_f32_16x16x32_bf16 v[84:87], a[104:107], a[44:47], v[84:87]
ds_read_b64_tr_b16 a[96:97], v12 offset:768
v_mfma_f32_16x16x32_bf16 v[84:87], a[108:111], a[60:63], v[84:87]
ds_read_b64_tr_b16 a[98:99], v12 offset:1792
v_mfma_f32_16x16x32_bf16 v[76:79], a[108:111], a[56:59], v[76:79]
ds_read_b64_tr_b16 a[100:101], v12 offset:8960
v_mfma_f32_16x16x32_bf16 v[76:79], a[104:107], a[40:43], v[76:79]
ds_read_b64_tr_b16 a[102:103], v12 offset:9984
v_mfma_f32_16x16x32_bf16 v[68:71], a[104:107], a[36:39], v[68:71]
s_add_u32 m0, s17, 0xcc00
v_mfma_f32_16x16x32_bf16 v[68:71], a[108:111], a[52:55], v[68:71]
buffer_load_dwordx4 v6, s[60:63], s13 offen lds
v_mfma_f32_16x16x32_bf16 v[60:63], a[108:111], a[48:51], v[60:63]
v_lshl_add_u32 v5, s42, 19, v5
v_lshl_add_u32 v6, s42, 19, v6
v_mfma_f32_16x16x32_bf16 v[60:63], a[104:107], a[32:35], v[60:63]
s_waitcnt lgkmcnt(7)
v_mfma_f32_16x16x32_bf16 v[88:91], a[80:83], a[32:35], v[88:91]
ds_read_b64_tr_b16 a[104:105], v13 offset:768
v_mfma_f32_16x16x32_bf16 v[88:91], a[84:87], a[48:51], v[88:91]
ds_read_b64_tr_b16 a[106:107], v13 offset:1792
v_mfma_f32_16x16x32_bf16 v[96:99], a[84:87], a[52:55], v[96:99]
ds_read_b64_tr_b16 a[108:109], v13 offset:8960
v_mfma_f32_16x16x32_bf16 v[96:99], a[80:83], a[36:39], v[96:99]
ds_read_b64_tr_b16 a[110:111], v13 offset:9984
v_mfma_f32_16x16x32_bf16 v[104:107], a[80:83], a[40:43], v[104:107]
s_add_u32 m0, s16, 0x0
s_waitcnt lgkmcnt(8)
v_mfma_f32_16x16x32_bf16 v[104:107], a[84:87], a[56:59], v[104:107]
buffer_load_dwordx4 v22, s[44:47], s20 offen lds
v_mfma_f32_16x16x32_bf16 v[112:115], a[84:87], a[60:63], v[112:115]
v_mfma_f32_16x16x32_bf16 v[112:115], a[80:83], a[44:47], v[112:115]
v_mfma_f32_16x16x32_bf16 v[116:119], a[88:91], a[44:47], v[116:119]
ds_read_b64_tr_b16 a[80:81], v12 offset:16384
v_mfma_f32_16x16x32_bf16 v[116:119], a[92:95], a[60:63], v[116:119]
ds_read_b64_tr_b16 a[82:83], v12 offset:17408
v_mfma_f32_16x16x32_bf16 v[108:111], a[92:95], a[56:59], v[108:111]
ds_read_b64_tr_b16 a[84:85], v12 offset:24576
v_mfma_f32_16x16x32_bf16 v[108:111], a[88:91], a[40:43], v[108:111]
ds_read_b64_tr_b16 a[86:87], v12 offset:25600
s_add_u32 m0, s16, 0x400
v_mfma_f32_16x16x32_bf16 v[100:103], a[88:91], a[36:39], v[100:103]
buffer_load_dwordx4 v23, s[44:47], s20 offen lds
v_mfma_f32_16x16x32_bf16 v[100:103], a[92:95], a[52:55], v[100:103]
v_mfma_f32_16x16x32_bf16 v[92:95], a[92:95], a[48:51], v[92:95]
v_mfma_f32_16x16x32_bf16 v[92:95], a[88:91], a[32:35], v[92:95]
s_waitcnt lgkmcnt(4)
v_mfma_f32_16x16x32_bf16 v[120:123], a[96:99], a[32:35], v[120:123]
ds_read_b64_tr_b16 a[88:89], v13 offset:16384
v_mfma_f32_16x16x32_bf16 v[120:123], a[100:103], a[48:51], v[120:123]
ds_read_b64_tr_b16 a[90:91], v13 offset:17408
v_mfma_f32_16x16x32_bf16 v[128:131], a[100:103], a[52:55], v[128:131]
ds_read_b64_tr_b16 a[92:93], v13 offset:24576
v_mfma_f32_16x16x32_bf16 v[128:131], a[96:99], a[36:39], v[128:131]
ds_read_b64_tr_b16 a[94:95], v13 offset:25600
s_add_u32 m0, s16, 0x800
v_mfma_f32_16x16x32_bf16 v[136:139], a[96:99], a[40:43], v[136:139]
buffer_load_dwordx4 v22, s[44:47], s21 offen lds
v_mfma_f32_16x16x32_bf16 v[136:139], a[100:103], a[56:59], v[136:139]
v_mfma_f32_16x16x32_bf16 v[144:147], a[100:103], a[60:63], v[144:147]
v_mfma_f32_16x16x32_bf16 v[144:147], a[96:99], a[44:47], v[144:147]
v_mfma_f32_16x16x32_bf16 v[148:151], a[104:107], a[44:47], v[148:151]
ds_read_b64_tr_b16 a[96:97], v12 offset:16640
v_mfma_f32_16x16x32_bf16 v[148:151], a[108:111], a[60:63], v[148:151]
ds_read_b64_tr_b16 a[98:99], v12 offset:17664
v_mfma_f32_16x16x32_bf16 v[140:143], a[108:111], a[56:59], v[140:143]
ds_read_b64_tr_b16 a[100:101], v12 offset:24832
s_add_u32 m0, s16, 0xc00
v_mfma_f32_16x16x32_bf16 v[140:143], a[104:107], a[40:43], v[140:143]
buffer_load_dwordx4 v23, s[44:47], s21 offen lds
v_mfma_f32_16x16x32_bf16 v[132:135], a[104:107], a[36:39], v[132:135]
ds_read_b64_tr_b16 a[102:103], v12 offset:25856
v_mfma_f32_16x16x32_bf16 v[132:135], a[108:111], a[52:55], v[132:135]
v_mfma_f32_16x16x32_bf16 v[124:127], a[108:111], a[48:51], v[124:127]
v_mfma_f32_16x16x32_bf16 v[124:127], a[104:107], a[32:35], v[124:127]
s_waitcnt lgkmcnt(4)
v_mfma_f32_16x16x32_bf16 v[152:155], a[32:35], a[80:83], v[152:155]
ds_read_b64_tr_b16 a[104:105], v13 offset:16640
v_mfma_f32_16x16x32_bf16 v[152:155], a[48:51], a[84:87], v[152:155]
ds_read_b64_tr_b16 a[106:107], v13 offset:17664
s_add_u32 m0, s16, 0x1000
v_mfma_f32_16x16x32_bf16 v[156:159], a[52:55], a[84:87], v[156:159]
buffer_load_dwordx4 v22, s[44:47], s22 offen lds
v_mfma_f32_16x16x32_bf16 v[156:159], a[36:39], a[80:83], v[156:159]
ds_read_b64_tr_b16 a[108:109], v13 offset:24832
v_mfma_f32_16x16x32_bf16 v[160:163], a[40:43], a[80:83], v[160:163]
ds_read_b64_tr_b16 a[110:111], v13 offset:25856
v_mfma_f32_16x16x32_bf16 v[160:163], a[56:59], a[84:87], v[160:163]
v_mfma_f32_16x16x32_bf16 v[164:167], a[60:63], a[84:87], v[164:167]
v_mfma_f32_16x16x32_bf16 v[164:167], a[44:47], a[80:83], v[164:167]
v_mfma_f32_16x16x32_bf16 v[180:183], a[44:47], a[88:91], v[180:183]
ds_read_b64_tr_b16 a[80:81], v12 offset:16896
v_mfma_f32_16x16x32_bf16 v[180:183], a[60:63], a[92:95], v[180:183]
ds_read_b64_tr_b16 a[82:83], v12 offset:17920
s_add_u32 m0, s16, 0x1400
v_mfma_f32_16x16x32_bf16 v[176:179], a[56:59], a[92:95], v[176:179]
buffer_load_dwordx4 v23, s[44:47], s22 offen lds
v_mfma_f32_16x16x32_bf16 v[176:179], a[40:43], a[88:91], v[176:179]
ds_read_b64_tr_b16 a[84:85], v12 offset:25088
v_mfma_f32_16x16x32_bf16 v[172:175], a[36:39], a[88:91], v[172:175]
ds_read_b64_tr_b16 a[86:87], v12 offset:26112
v_mfma_f32_16x16x32_bf16 v[172:175], a[52:55], a[92:95], v[172:175]
v_mfma_f32_16x16x32_bf16 v[168:171], a[48:51], a[92:95], v[168:171]
v_mfma_f32_16x16x32_bf16 v[168:171], a[32:35], a[88:91], v[168:171]
s_waitcnt lgkmcnt(4)
v_mfma_f32_16x16x32_bf16 v[184:187], a[32:35], a[96:99], v[184:187]
ds_read_b64_tr_b16 a[88:89], v13 offset:16896
s_add_u32 m0, s16, 0x1800
v_mfma_f32_16x16x32_bf16 v[184:187], a[48:51], a[100:103], v[184:187]
buffer_load_dwordx4 v22, s[44:47], s23 offen lds
v_mfma_f32_16x16x32_bf16 v[188:191], a[52:55], a[100:103], v[188:191]
ds_read_b64_tr_b16 a[90:91], v13 offset:17920
v_mfma_f32_16x16x32_bf16 v[188:191], a[36:39], a[96:99], v[188:191]
ds_read_b64_tr_b16 a[92:93], v13 offset:25088
v_mfma_f32_16x16x32_bf16 v[192:195], a[40:43], a[96:99], v[192:195]
ds_read_b64_tr_b16 a[94:95], v13 offset:26112
v_mfma_f32_16x16x32_bf16 v[192:195], a[56:59], a[100:103], v[192:195]
v_mfma_f32_16x16x32_bf16 v[196:199], a[60:63], a[100:103], v[196:199]
v_mfma_f32_16x16x32_bf16 v[196:199], a[44:47], a[96:99], v[196:199]
v_mfma_f32_16x16x32_bf16 v[212:215], a[44:47], a[104:107], v[212:215]
ds_read_b64_tr_b16 a[96:97], v12 offset:17152
s_add_u32 m0, s16, 0x1c00
v_mfma_f32_16x16x32_bf16 v[212:215], a[60:63], a[108:111], v[212:215]
buffer_load_dwordx4 v23, s[44:47], s23 offen lds
v_mfma_f32_16x16x32_bf16 v[208:211], a[56:59], a[108:111], v[208:211]
ds_read_b64_tr_b16 a[98:99], v12 offset:18176
s_mov_b32 s42, 1
v_mfma_f32_16x16x32_bf16 v[208:211], a[40:43], a[104:107], v[208:211]
ds_read_b64_tr_b16 a[100:101], v12 offset:25344
v_lshl_add_u32 v22, s42, 7, v22
v_mfma_f32_16x16x32_bf16 v[204:207], a[36:39], a[104:107], v[204:207]
ds_read_b64_tr_b16 a[102:103], v12 offset:26368
v_lshl_add_u32 v23, s42, 7, v23
v_mfma_f32_16x16x32_bf16 v[204:207], a[52:55], a[108:111], v[204:207]
v_mfma_f32_16x16x32_bf16 v[200:203], a[48:51], a[108:111], v[200:203]
v_mfma_f32_16x16x32_bf16 v[200:203], a[32:35], a[104:107], v[200:203]
s_mov_b32 s9, 0x1000
s_waitcnt lgkmcnt(4)
v_mfma_f32_16x16x32_bf16 v[216:219], a[32:35], a[80:83], v[216:219]
buffer_load_dword a120, v1, s[68:71], s9 offen
v_mfma_f32_16x16x32_bf16 v[216:219], a[48:51], a[84:87], v[216:219]
ds_read_b64_tr_b16 a[104:105], v13 offset:17152
v_mfma_f32_16x16x32_bf16 v[220:223], a[52:55], a[84:87], v[220:223]
ds_read_b64_tr_b16 a[106:107], v13 offset:18176
v_mfma_f32_16x16x32_bf16 v[220:223], a[36:39], a[80:83], v[220:223]
ds_read_b64_tr_b16 a[108:109], v13 offset:25344
v_mfma_f32_16x16x32_bf16 v[224:227], a[40:43], a[80:83], v[224:227]
ds_read_b64_tr_b16 a[110:111], v13 offset:26368
v_add_u32 v12, 0xffff0000, v12
v_mfma_f32_16x16x32_bf16 v[224:227], a[56:59], a[84:87], v[224:227]
v_add_u32 v13, 0xffff0000, v13
v_mfma_f32_16x16x32_bf16 v[228:231], a[60:63], a[84:87], v[228:231]
v_mfma_f32_16x16x32_bf16 v[228:231], a[44:47], a[80:83], v[228:231]
v_mfma_f32_16x16x32_bf16 v[244:247], a[44:47], a[88:91], v[244:247]
s_waitcnt vmcnt(27) lgkmcnt(0)
v_mfma_f32_16x16x32_bf16 v[244:247], a[60:63], a[92:95], v[244:247]
s_barrier
s_add_u32 m0, s17, 0x10000
v_mfma_f32_16x16x32_bf16 v[240:243], a[56:59], a[92:95], v[240:243]
buffer_load_dwordx4 v5, s[52:55], 0 offen lds
v_mfma_f32_16x16x32_bf16 v[240:243], a[40:43], a[88:91], v[240:243]
ds_read_b64_tr_b16 a[80:81], v12 offset:0
s_mul_i32 s28, s5, 0x10c400
v_mfma_f32_16x16x32_bf16 v[236:239], a[36:39], a[88:91], v[236:239]
ds_read_b64_tr_b16 a[82:83], v12 offset:1024
s_mov_b32 s48, s88
v_mfma_f32_16x16x32_bf16 v[236:239], a[52:55], a[92:95], v[236:239]
ds_read_b64_tr_b16 a[84:85], v12 offset:8192
s_mov_b32 s49, s89
v_mfma_f32_16x16x32_bf16 v[232:235], a[48:51], a[92:95], v[232:235]
ds_read_b64_tr_b16 a[86:87], v12 offset:9216
s_sub_u32 s11, 16, s6
v_mfma_f32_16x16x32_bf16 v[232:235], a[32:35], a[88:91], v[232:235]
s_waitcnt lgkmcnt(4)
s_lshl_b32 s11, s11, 16
s_add_u32 s11, s11, s28
v_mfma_f32_16x16x32_bf16 v[248:251], a[32:35], a[96:99], v[248:251]
ds_read_b64_tr_b16 a[88:89], v13 offset:0
s_add_u32 m0, s17, 0x10400
v_mfma_f32_16x16x32_bf16 v[248:251], a[48:51], a[100:103], v[248:251]
buffer_load_dwordx4 v5, s[52:55], s13 offen lds
v_mfma_f32_16x16x32_bf16 v[252:255], a[52:55], a[100:103], v[252:255]
ds_read_b64_tr_b16 a[90:91], v13 offset:1024
s_add_u32 s50, s11, 0x2000
v_mfma_f32_16x16x32_bf16 v[252:255], a[36:39], a[96:99], v[252:255]
ds_read_b64_tr_b16 a[92:93], v13 offset:8192
s_lshl_b32 s11, s6, 17
v_mfma_f32_16x16x32_bf16 a[232:235], a[40:43], a[96:99], a[232:235]
ds_read_b64_tr_b16 a[94:95], v13 offset:9216
s_add_u32 s28, s28, s11
v_mfma_f32_16x16x32_bf16 a[232:235], a[56:59], a[100:103], a[232:235]
s_lshl_b32 s11, s4, 15
s_add_u32 s28, s28, s11
s_lshl_b32 s10, s5, 2
v_mfma_f32_16x16x32_bf16 a[236:239], a[60:63], a[100:103], a[236:239]
s_add_u32 s10, s10, 64
v_mfma_f32_16x16x32_bf16 a[236:239], a[44:47], a[96:99], a[236:239]
s_add_u32 m0, s17, 0x10800
v_mfma_f32_16x16x32_bf16 a[252:255], a[44:47], a[104:107], a[252:255]
buffer_load_dwordx4 v6, s[52:55], 0 offen lds
v_mfma_f32_16x16x32_bf16 a[252:255], a[60:63], a[108:111], a[252:255]
ds_read_b64_tr_b16 a[96:97], v12 offset:256
L_padA3:
s_cmp_eq_u32 s95, 1
s_cbranch_scc1 L_padA7
v_mfma_f32_16x16x32_bf16 a[248:251], a[56:59], a[108:111], a[248:251]
ds_read_b64_tr_b16 a[98:99], v12 offset:1280
v_mfma_f32_16x16x32_bf16 a[248:251], a[40:43], a[104:107], a[248:251]
ds_read_b64_tr_b16 a[100:101], v12 offset:8448
v_mfma_f32_16x16x32_bf16 a[244:247], a[36:39], a[104:107], a[244:247]
ds_read_b64_tr_b16 a[102:103], v12 offset:9472
v_mfma_f32_16x16x32_bf16 a[244:247], a[52:55], a[108:111], a[244:247]
v_mfma_f32_16x16x32_bf16 a[240:243], a[48:51], a[108:111], a[240:243]
v_mfma_f32_16x16x32_bf16 a[240:243], a[32:35], a[104:107], a[240:243]
s_add_u32 m0, s17, 0x10c00
s_waitcnt lgkmcnt(4)
L_S6:
v_mfma_f32_16x16x32_bf16 v[24:27], a[80:83], a[0:3], v[24:27]
buffer_load_dwordx4 v6, s[52:55], s13 offen lds
v_mfma_f32_16x16x32_bf16 v[24:27], a[84:87], a[16:19], v[24:27]
ds_read_b64_tr_b16 a[104:105], v13 offset:256
s_waitcnt vmcnt(22)
v_mfma_f32_16x16x32_bf16 v[32:35], a[84:87], a[20:23], v[32:35]
ds_read_b64_tr_b16 a[106:107], v13 offset:1280
v_mfma_f32_16x16x32_bf16 v[32:35], a[80:83], a[4:7], v[32:35]
ds_read_b64_tr_b16 a[108:109], v13 offset:8448
v_mfma_f32_16x16x32_bf16 v[40:43], a[80:83], a[8:11], v[40:43]
ds_read_b64_tr_b16 a[110:111], v13 offset:9472
v_mfma_f32_16x16x32_bf16 v[40:43], a[84:87], a[24:27], v[40:43]
ds_read_b128 a[32:35], v8 offset:32768
v_mfma_f32_16x16x32_bf16 v[48:51], a[84:87], a[28:31], v[48:51]
ds_read_b128 a[48:51], v9 offset:32768
s_add_u32 m0, s18, 0x14000
v_mfma_f32_16x16x32_bf16 v[48:51], a[80:83], a[12:15], v[48:51]
buffer_load_dwordx4 v7, s[68:71], 0 offen lds
v_mfma_f32_16x16x32_bf16 v[52:55], a[88:91], a[12:15], v[52:55]
ds_read_b64_tr_b16 a[80:81], v12 offset:512
v_mfma_f32_16x16x32_bf16 v[52:55], a[92:95], a[28:31], v[52:55]
ds_read_b64_tr_b16 a[82:83], v12 offset:1536
v_mfma_f32_16x16x32_bf16 v[44:47], a[92:95], a[24:27], v[44:47]
ds_read_b64_tr_b16 a[84:85], v12 offset:8704
v_mfma_f32_16x16x32_bf16 v[44:47], a[88:91], a[8:11], v[44:47]
ds_read_b64_tr_b16 a[86:87], v12 offset:9728
v_mfma_f32_16x16x32_bf16 v[36:39], a[88:91], a[4:7], v[36:39]
ds_read_b128 a[36:39], v8 offset:34816
v_mfma_f32_16x16x32_bf16 v[36:39], a[92:95], a[20:23], v[36:39]
ds_read_b128 a[52:55], v9 offset:34816
s_waitcnt lgkmcnt(8)
v_mfma_f32_16x16x32_bf16 v[28:31], a[92:95], a[16:19], v[28:31]
ds_read_b128 a[40:43], v8 offset:36864
s_add_u32 m0, s18, 0x15000
v_mfma_f32_16x16x32_bf16 v[28:31], a[88:91], a[0:3], v[28:31]
buffer_load_dwordx4 v7, s[68:71], s25 offen lds
v_mfma_f32_16x16x32_bf16 v[56:59], a[96:99], a[0:3], v[56:59]
ds_read_b64_tr_b16 a[88:89], v13 offset:512
v_mfma_f32_16x16x32_bf16 v[56:59], a[100:103], a[16:19], v[56:59]
ds_read_b64_tr_b16 a[90:91], v13 offset:1536
v_mfma_f32_16x16x32_bf16 v[64:67], a[100:103], a[20:23], v[64:67]
ds_read_b64_tr_b16 a[92:93], v13 offset:8704
v_mfma_f32_16x16x32_bf16 v[64:67], a[96:99], a[4:7], v[64:67]
ds_read_b64_tr_b16 a[94:95], v13 offset:9728
v_mfma_f32_16x16x32_bf16 v[72:75], a[96:99], a[8:11], v[72:75]
ds_read_b128 a[56:59], v9 offset:36864
v_mfma_f32_16x16x32_bf16 v[72:75], a[100:103], a[24:27], v[72:75]
ds_read_b128 a[44:47], v8 offset:38912
s_add_u32 m0, s18, 0x16000
v_mfma_f32_16x16x32_bf16 v[80:83], a[100:103], a[28:31], v[80:83]
buffer_load_dwordx4 v7, s[68:71], s26 offen lds
v_mfma_f32_16x16x32_bf16 v[80:83], a[96:99], a[12:15], v[80:83]
ds_read_b128 a[60:63], v9 offset:38912
v_lshl_add_u32 v5, s42, 19, v5
v_mfma_f32_16x16x32_bf16 v[84:87], a[104:107], a[12:15], v[84:87]
ds_read_b64_tr_b16 a[96:97], v12 offset:768
v_lshl_add_u32 v6, s42, 19, v6
v_mfma_f32_16x16x32_bf16 v[84:87], a[108:111], a[28:31], v[84:87]
ds_read_b64_tr_b16 a[98:99], v12 offset:1792
v_lshl_add_u32 v7, s42, 18, v7
v_mfma_f32_16x16x32_bf16 v[76:79], a[108:111], a[24:27], v[76:79]
ds_read_b64_tr_b16 a[100:101], v12 offset:8960
v_lshl_add_u32 v7, s42, 17, v7
v_mfma_f32_16x16x32_bf16 v[76:79], a[104:107], a[8:11], v[76:79]
ds_read_b64_tr_b16 a[102:103], v12 offset:9984
v_mfma_f32_16x16x32_bf16 v[68:71], a[104:107], a[4:7], v[68:71]
v_mfma_f32_16x16x32_bf16 v[68:71], a[108:111], a[20:23], v[68:71]
buffer_store_dwordx4 a[64:67], v4, s[88:91], 0 offen sc1
v_mfma_f32_16x16x32_bf16 v[60:63], a[108:111], a[16:19], v[60:63]
v_mfma_f32_16x16x32_bf16 v[60:63], a[104:107], a[0:3], v[60:63]
s_waitcnt lgkmcnt(7)
v_mfma_f32_16x16x32_bf16 v[88:91], a[80:83], a[0:3], v[88:91]
ds_read_b64_tr_b16 a[104:105], v13 offset:768
v_mfma_f32_16x16x32_bf16 v[88:91], a[84:87], a[16:19], v[88:91]
ds_read_b64_tr_b16 a[106:107], v13 offset:1792
v_mfma_f32_16x16x32_bf16 v[96:99], a[84:87], a[20:23], v[96:99]
ds_read_b64_tr_b16 a[108:109], v13 offset:8960
v_mfma_f32_16x16x32_bf16 v[96:99], a[80:83], a[4:7], v[96:99]
ds_read_b64_tr_b16 a[110:111], v13 offset:9984
v_mfma_f32_16x16x32_bf16 v[104:107], a[80:83], a[8:11], v[104:107]
s_add_u32 m0, s16, 0x8000
s_waitcnt lgkmcnt(8)
v_mfma_f32_16x16x32_bf16 v[104:107], a[84:87], a[24:27], v[104:107]
buffer_load_dwordx4 v22, s[44:47], s20 offen lds
v_mfma_f32_16x16x32_bf16 v[112:115], a[84:87], a[28:31], v[112:115]
v_mfma_f32_16x16x32_bf16 v[112:115], a[80:83], a[12:15], v[112:115]
v_mfma_f32_16x16x32_bf16 v[116:119], a[88:91], a[12:15], v[116:119]
ds_read_b64_tr_b16 a[80:81], v12 offset:16384
v_mfma_f32_16x16x32_bf16 v[116:119], a[92:95], a[28:31], v[116:119]
ds_read_b64_tr_b16 a[82:83], v12 offset:17408
v_mfma_f32_16x16x32_bf16 v[108:111], a[92:95], a[24:27], v[108:111]
ds_read_b64_tr_b16 a[84:85], v12 offset:24576
v_mfma_f32_16x16x32_bf16 v[108:111], a[88:91], a[8:11], v[108:111]
ds_read_b64_tr_b16 a[86:87], v12 offset:25600
s_add_u32 m0, s16, 0x8400
v_mfma_f32_16x16x32_bf16 v[100:103], a[88:91], a[4:7], v[100:103]
buffer_load_dwordx4 v23, s[44:47], s20 offen lds
v_mfma_f32_16x16x32_bf16 v[100:103], a[92:95], a[20:23], v[100:103]
v_mfma_f32_16x16x32_bf16 v[92:95], a[92:95], a[16:19], v[92:95]
v_mfma_f32_16x16x32_bf16 v[92:95], a[88:91], a[0:3], v[92:95]
s_waitcnt lgkmcnt(4)
v_mfma_f32_16x16x32_bf16 v[120:123], a[96:99], a[0:3], v[120:123]
ds_read_b64_tr_b16 a[88:89], v13 offset:16384
v_mfma_f32_16x16x32_bf16 v[120:123], a[100:103], a[16:19], v[120:123]
ds_read_b64_tr_b16 a[90:91], v13 offset:17408
v_mfma_f32_16x16x32_bf16 v[128:131], a[100:103], a[20:23], v[128:131]
ds_read_b64_tr_b16 a[92:93], v13 offset:24576
v_mfma_f32_16x16x32_bf16 v[128:131], a[96:99], a[4:7], v[128:131]
ds_read_b64_tr_b16 a[94:95], v13 offset:25600
s_add_u32 m0, s16, 0x8800
v_mfma_f32_16x16x32_bf16 v[136:139], a[96:99], a[8:11], v[136:139]
buffer_load_dwordx4 v22, s[44:47], s21 offen lds
v_mfma_f32_16x16x32_bf16 v[136:139], a[100:103], a[24:27], v[136:139]
v_mfma_f32_16x16x32_bf16 v[144:147], a[100:103], a[28:31], v[144:147]
v_mfma_f32_16x16x32_bf16 v[144:147], a[96:99], a[12:15], v[144:147]
v_mfma_f32_16x16x32_bf16 v[148:151], a[104:107], a[12:15], v[148:151]
ds_read_b64_tr_b16 a[96:97], v12 offset:16640
v_mfma_f32_16x16x32_bf16 v[148:151], a[108:111], a[28:31], v[148:151]
ds_read_b64_tr_b16 a[98:99], v12 offset:17664
v_mfma_f32_16x16x32_bf16 v[140:143], a[108:111], a[24:27], v[140:143]
ds_read_b64_tr_b16 a[100:101], v12 offset:24832
s_add_u32 m0, s16, 0x8c00
v_mfma_f32_16x16x32_bf16 v[140:143], a[104:107], a[8:11], v[140:143]
buffer_load_dwordx4 v23, s[44:47], s21 offen lds
v_mfma_f32_16x16x32_bf16 v[132:135], a[104:107], a[4:7], v[132:135]
ds_read_b64_tr_b16 a[102:103], v12 offset:25856
v_mfma_f32_16x16x32_bf16 v[132:135], a[108:111], a[20:23], v[132:135]
v_mfma_f32_16x16x32_bf16 v[124:127], a[108:111], a[16:19], v[124:127]
v_mfma_f32_16x16x32_bf16 v[124:127], a[104:107], a[0:3], v[124:127]
s_waitcnt lgkmcnt(4)
v_mfma_f32_16x16x32_bf16 v[152:155], a[0:3], a[80:83], v[152:155]
ds_read_b64_tr_b16 a[104:105], v13 offset:16640
v_mfma_f32_16x16x32_bf16 v[152:155], a[16:19], a[84:87], v[152:155]
ds_read_b64_tr_b16 a[106:107], v13 offset:17664
s_add_u32 m0, s16, 0x9000
v_mfma_f32_16x16x32_bf16 v[156:159], a[20:23], a[84:87], v[156:159]
buffer_load_dwordx4 v22, s[44:47], s22 offen lds
v_mfma_f32_16x16x32_bf16 v[156:159], a[4:7], a[80:83], v[156:159]
ds_read_b64_tr_b16 a[108:109], v13 offset:24832
v_mfma_f32_16x16x32_bf16 v[160:163], a[8:11], a[80:83], v[160:163]
ds_read_b64_tr_b16 a[110:111], v13 offset:25856
v_mfma_f32_16x16x32_bf16 v[160:163], a[24:27], a[84:87], v[160:163]
v_mfma_f32_16x16x32_bf16 v[164:167], a[28:31], a[84:87], v[164:167]
v_mfma_f32_16x16x32_bf16 v[164:167], a[12:15], a[80:83], v[164:167]
v_mfma_f32_16x16x32_bf16 v[180:183], a[12:15], a[88:91], v[180:183]
ds_read_b64_tr_b16 a[80:81], v12 offset:16896
v_mfma_f32_16x16x32_bf16 v[180:183], a[28:31], a[92:95], v[180:183]
ds_read_b64_tr_b16 a[82:83], v12 offset:17920
s_add_u32 m0, s16, 0x9400
v_mfma_f32_16x16x32_bf16 v[176:179], a[24:27], a[92:95], v[176:179]
buffer_load_dwordx4 v23, s[44:47], s22 offen lds
v_mfma_f32_16x16x32_bf16 v[176:179], a[8:11], a[88:91], v[176:179]
ds_read_b64_tr_b16 a[84:85], v12 offset:25088
v_mfma_f32_16x16x32_bf16 v[172:175], a[4:7], a[88:91], v[172:175]
ds_read_b64_tr_b16 a[86:87], v12 offset:26112
v_mfma_f32_16x16x32_bf16 v[172:175], a[20:23], a[92:95], v[172:175]
v_mfma_f32_16x16x32_bf16 v[168:171], a[16:19], a[92:95], v[168:171]
v_mfma_f32_16x16x32_bf16 v[168:171], a[0:3], a[88:91], v[168:171]
s_waitcnt lgkmcnt(4)
v_mfma_f32_16x16x32_bf16 v[184:187], a[0:3], a[96:99], v[184:187]
ds_read_b64_tr_b16 a[88:89], v13 offset:16896
s_add_u32 m0, s16, 0x9800
v_mfma_f32_16x16x32_bf16 v[184:187], a[16:19], a[100:103], v[184:187]
buffer_load_dwordx4 v22, s[44:47], s23 offen lds
v_mfma_f32_16x16x32_bf16 v[188:191], a[20:23], a[100:103], v[188:191]
ds_read_b64_tr_b16 a[90:91], v13 offset:17920
v_mfma_f32_16x16x32_bf16 v[188:191], a[4:7], a[96:99], v[188:191]
ds_read_b64_tr_b16 a[92:93], v13 offset:25088
v_mfma_f32_16x16x32_bf16 v[192:195], a[8:11], a[96:99], v[192:195]
ds_read_b64_tr_b16 a[94:95], v13 offset:26112
v_mfma_f32_16x16x32_bf16 v[192:195], a[24:27], a[100:103], v[192:195]
v_mfma_f32_16x16x32_bf16 v[196:199], a[28:31], a[100:103], v[196:199]
v_mfma_f32_16x16x32_bf16 v[196:199], a[12:15], a[96:99], v[196:199]
v_mfma_f32_16x16x32_bf16 v[212:215], a[12:15], a[104:107], v[212:215]
ds_read_b64_tr_b16 a[96:97], v12 offset:17152
s_add_u32 m0, s16, 0x9c00
v_mfma_f32_16x16x32_bf16 v[212:215], a[28:31], a[108:111], v[212:215]
buffer_load_dwordx4 v23, s[44:47], s23 offen lds
v_mfma_f32_16x16x32_bf16 v[208:211], a[24:27], a[108:111], v[208:211]
ds_read_b64_tr_b16 a[98:99], v12 offset:18176
v_lshl_add_u32 v22, s42, 7, v22
v_mfma_f32_16x16x32_bf16 v[208:211], a[8:11], a[104:107], v[208:211]
ds_read_b64_tr_b16 a[100:101], v12 offset:25344
v_lshl_add_u32 v23, s42, 7, v23
v_mfma_f32_16x16x32_bf16 v[204:207], a[4:7], a[104:107], v[204:207]
ds_read_b64_tr_b16 a[102:103], v12 offset:26368
v_mfma_f32_16x16x32_bf16 v[204:207], a[20:23], a[108:111], v[204:207]
v_mfma_f32_16x16x32_bf16 v[200:203], a[16:19], a[108:111], v[200:203]
v_mfma_f32_16x16x32_bf16 v[200:203], a[0:3], a[104:107], v[200:203]
s_mov_b32 s9, 0x200000
s_waitcnt lgkmcnt(4)
v_mfma_f32_16x16x32_bf16 v[216:219], a[0:3], a[80:83], v[216:219]
buffer_load_dword a120, v18, s[52:55], s9 offen
v_mfma_f32_16x16x32_bf16 v[216:219], a[16:19], a[84:87], v[216:219]
ds_read_b64_tr_b16 a[104:105], v13 offset:17152
v_mfma_f32_16x16x32_bf16 v[220:223], a[20:23], a[84:87], v[220:223]
ds_read_b64_tr_b16 a[106:107], v13 offset:18176
v_mfma_f32_16x16x32_bf16 v[220:223], a[4:7], a[80:83], v[220:223]
ds_read_b64_tr_b16 a[108:109], v13 offset:25344
v_mfma_f32_16x16x32_bf16 v[224:227], a[8:11], a[80:83], v[224:227]
ds_read_b64_tr_b16 a[110:111], v13 offset:26368
v_add_u32 v12, 0x8000, v12
v_mfma_f32_16x16x32_bf16 v[224:227], a[24:27], a[84:87], v[224:227]
v_add_u32 v13, 0x8000, v13
v_mfma_f32_16x16x32_bf16 v[228:231], a[28:31], a[84:87], v[228:231]
v_mfma_f32_16x16x32_bf16 v[228:231], a[12:15], a[80:83], v[228:231]
v_mfma_f32_16x16x32_bf16 v[244:247], a[12:15], a[88:91], v[244:247]
s_waitcnt vmcnt(26) lgkmcnt(0)
v_mfma_f32_16x16x32_bf16 v[244:247], a[28:31], a[92:95], v[244:247]
s_barrier
s_add_u32 m0, s17, 0x0
v_mfma_f32_16x16x32_bf16 v[240:243], a[24:27], a[92:95], v[240:243]
buffer_load_dwordx4 v5, s[52:55], 0 offen lds
v_mfma_f32_16x16x32_bf16 v[240:243], a[8:11], a[88:91], v[240:243]
ds_read_b64_tr_b16 a[80:81], v12 offset:0
v_mfma_f32_16x16x32_bf16 v[236:239], a[4:7], a[88:91], v[236:239]
ds_read_b64_tr_b16 a[82:83], v12 offset:1024
v_mfma_f32_16x16x32_bf16 v[236:239], a[20:23], a[92:95], v[236:239]
ds_read_b64_tr_b16 a[84:85], v12 offset:8192
v_mfma_f32_16x16x32_bf16 v[232:235], a[16:19], a[92:95], v[232:235]
ds_read_b64_tr_b16 a[86:87], v12 offset:9216
v_mfma_f32_16x16x32_bf16 v[232:235], a[0:3], a[88:91], v[232:235]
s_waitcnt lgkmcnt(4)
v_mfma_f32_16x16x32_bf16 v[248:251], a[0:3], a[96:99], v[248:251]
ds_read_b64_tr_b16 a[88:89], v13 offset:0
s_add_u32 m0, s17, 0x400
v_mfma_f32_16x16x32_bf16 v[248:251], a[16:19], a[100:103], v[248:251]
buffer_load_dwordx4 v5, s[52:55], s13 offen lds
v_mfma_f32_16x16x32_bf16 v[252:255], a[20:23], a[100:103], v[252:255]
ds_read_b64_tr_b16 a[90:91], v13 offset:1024
v_mfma_f32_16x16x32_bf16 v[252:255], a[4:7], a[96:99], v[252:255]
ds_read_b64_tr_b16 a[92:93], v13 offset:8192
v_mfma_f32_16x16x32_bf16 a[232:235], a[8:11], a[96:99], a[232:235]
ds_read_b64_tr_b16 a[94:95], v13 offset:9216
v_mfma_f32_16x16x32_bf16 a[232:235], a[24:27], a[100:103], a[232:235]
v_mfma_f32_16x16x32_bf16 a[236:239], a[28:31], a[100:103], a[236:239]
v_mfma_f32_16x16x32_bf16 a[236:239], a[12:15], a[96:99], a[236:239]
s_add_u32 m0, s17, 0x800
v_mfma_f32_16x16x32_bf16 a[252:255], a[12:15], a[104:107], a[252:255]
buffer_load_dwordx4 v6, s[52:55], 0 offen lds
v_mfma_f32_16x16x32_bf16 a[252:255], a[28:31], a[108:111], a[252:255]
ds_read_b64_tr_b16 a[96:97], v12 offset:256
v_mfma_f32_16x16x32_bf16 a[248:251], a[24:27], a[108:111], a[248:251]
ds_read_b64_tr_b16 a[98:99], v12 offset:1280
v_mfma_f32_16x16x32_bf16 a[248:251], a[8:11], a[104:107], a[248:251]
ds_read_b64_tr_b16 a[100:101], v12 offset:8448
v_mfma_f32_16x16x32_bf16 a[244:247], a[4:7], a[104:107], a[244:247]
ds_read_b64_tr_b16 a[102:103], v12 offset:9472
v_mfma_f32_16x16x32_bf16 a[244:247], a[20:23], a[108:111], a[244:247]
v_mfma_f32_16x16x32_bf16 a[240:243], a[16:19], a[108:111], a[240:243]
v_mfma_f32_16x16x32_bf16 a[240:243], a[0:3], a[104:107], a[240:243]
s_add_u32 m0, s17, 0xc00
s_waitcnt lgkmcnt(4)
L_S7:
v_mfma_f32_16x16x32_bf16 v[24:27], a[80:83], a[32:35], v[24:27]
buffer_load_dwordx4 v6, s[52:55], s13 offen lds
v_mfma_f32_16x16x32_bf16 v[24:27], a[84:87], a[48:51], v[24:27]
ds_read_b64_tr_b16 a[104:105], v13 offset:256
s_waitcnt vmcnt(22)
v_mfma_f32_16x16x32_bf16 v[32:35], a[84:87], a[52:55], v[32:35]
ds_read_b64_tr_b16 a[106:107], v13 offset:1280
v_mfma_f32_16x16x32_bf16 v[32:35], a[80:83], a[36:39], v[32:35]
ds_read_b64_tr_b16 a[108:109], v13 offset:8448
v_mfma_f32_16x16x32_bf16 v[40:43], a[80:83], a[40:43], v[40:43]
ds_read_b64_tr_b16 a[110:111], v13 offset:9472
v_mfma_f32_16x16x32_bf16 v[40:43], a[84:87], a[56:59], v[40:43]
ds_read_b128 a[0:3], v8 offset:0
v_mfma_f32_16x16x32_bf16 v[48:51], a[84:87], a[60:63], v[48:51]
ds_read_b128 a[16:19], v9 offset:0
s_add_u32 m0, s18, 0x4000
v_mfma_f32_16x16x32_bf16 v[48:51], a[80:83], a[44:47], v[48:51]
buffer_load_dwordx4 v7, s[68:71], 0 offen lds
v_mfma_f32_16x16x32_bf16 v[52:55], a[88:91], a[44:47], v[52:55]
ds_read_b64_tr_b16 a[80:81], v12 offset:512
v_mfma_f32_16x16x32_bf16 v[52:55], a[92:95], a[60:63], v[52:55]
ds_read_b64_tr_b16 a[82:83], v12 offset:1536
v_mfma_f32_16x16x32_bf16 v[44:47], a[92:95], a[56:59], v[44:47]
ds_read_b64_tr_b16 a[84:85], v12 offset:8704
v_mfma_f32_16x16x32_bf16 v[44:47], a[88:91], a[40:43], v[44:47]
ds_read_b64_tr_b16 a[86:87], v12 offset:9728
v_mfma_f32_16x16x32_bf16 v[36:39], a[88:91], a[36:39], v[36:39]
ds_read_b128 a[4:7], v8 offset:2048
v_mfma_f32_16x16x32_bf16 v[36:39], a[92:95], a[52:55], v[36:39]
ds_read_b128 a[20:23], v9 offset:2048
s_waitcnt lgkmcnt(8)
v_mfma_f32_16x16x32_bf16 v[28:31], a[92:95], a[48:51], v[28:31]
ds_read_b128 a[8:11], v8 offset:4096
s_add_u32 m0, s18, 0x5000
v_mfma_f32_16x16x32_bf16 v[28:31], a[88:91], a[32:35], v[28:31]
buffer_load_dwordx4 v7, s[68:71], s25 offen lds
v_mfma_f32_16x16x32_bf16 v[56:59], a[96:99], a[32:35], v[56:59]
ds_read_b64_tr_b16 a[88:89], v13 offset:512
v_mfma_f32_16x16x32_bf16 v[56:59], a[100:103], a[48:51], v[56:59]
ds_read_b64_tr_b16 a[90:91], v13 offset:1536
v_mfma_f32_16x16x32_bf16 v[64:67], a[100:103], a[52:55], v[64:67]
ds_read_b64_tr_b16 a[92:93], v13 offset:8704
v_mfma_f32_16x16x32_bf16 v[64:67], a[96:99], a[36:39], v[64:67]
ds_read_b64_tr_b16 a[94:95], v13 offset:9728
v_cvt_pk_bf16_f32 v24, v24, v25
v_cvt_pk_bf16_f32 v25, v26, v27
v_mfma_f32_16x16x32_bf16 v[72:75], a[96:99], a[40:43], v[72:75]
ds_read_b128 a[24:27], v9 offset:4096
v_cvt_pk_bf16_f32 v26, v28, v29
v_mfma_f32_16x16x32_bf16 v[72:75], a[100:103], a[56:59], v[72:75]
ds_read_b128 a[12:15], v8 offset:6144
s_add_u32 m0, s18, 0x6000
v_mfma_f32_16x16x32_bf16 v[80:83], a[100:103], a[60:63], v[80:83]
buffer_load_dwordx4 v7, s[68:71], s26 offen lds
v_cvt_pk_bf16_f32 v27, v30, v31
v_mfma_f32_16x16x32_bf16 v[80:83], a[96:99], a[44:47], v[80:83]
ds_read_b128 a[28:31], v9 offset:6144
v_lshl_add_u32 v5, s42, 19, v5
v_mfma_f32_16x16x32_bf16 v[84:87], a[104:107], a[44:47], v[84:87]
ds_read_b64_tr_b16 a[96:97], v12 offset:768
v_lshl_add_u32 v6, s42, 19, v6
v_mfma_f32_16x16x32_bf16 v[84:87], a[108:111], a[60:63], v[84:87]
ds_read_b64_tr_b16 a[98:99], v12 offset:1792
v_lshl_add_u32 v7, s42, 18, v7
v_accvgpr_write_b32 a128, v24
v_mfma_f32_16x16x32_bf16 v[76:79], a[108:111], a[56:59], v[76:79]
ds_read_b64_tr_b16 a[100:101], v12 offset:8960
v_lshl_add_u32 v7, s42, 17, v7
v_mfma_f32_16x16x32_bf16 v[76:79], a[104:107], a[40:43], v[76:79]
ds_read_b64_tr_b16 a[102:103], v12 offset:9984
v_accvgpr_write_b32 a129, v25
v_mfma_f32_16x16x32_bf16 v[68:71], a[104:107], a[36:39], v[68:71]
s_mov_b32 s9, 0x400000
v_accvgpr_write_b32 a130, v26
v_accvgpr_write_b32 a131, v27
v_cvt_pk_bf16_f32 v32, v32, v33
v_mfma_f32_16x16x32_bf16 v[68:71], a[108:111], a[52:55], v[68:71]
buffer_load_dword a120, v18, s[52:55], s9 offen
v_mfma_f32_16x16x32_bf16 v[60:63], a[108:111], a[48:51], v[60:63]
v_cvt_pk_bf16_f32 v33, v34, v35
v_cvt_pk_bf16_f32 v34, v36, v37
v_mfma_f32_16x16x32_bf16 v[60:63], a[104:107], a[32:35], v[60:63]
s_waitcnt lgkmcnt(7)
v_cvt_pk_bf16_f32 v35, v38, v39
v_accvgpr_write_b32 a132, v32
v_accvgpr_write_b32 a133, v33
v_mfma_f32_16x16x32_bf16 v[88:91], a[80:83], a[32:35], v[88:91]
ds_read_b64_tr_b16 a[104:105], v13 offset:768
v_accvgpr_write_b32 a134, v34
v_mfma_f32_16x16x32_bf16 v[88:91], a[84:87], a[48:51], v[88:91]
ds_read_b64_tr_b16 a[106:107], v13 offset:1792
v_accvgpr_write_b32 a135, v35
v_mfma_f32_16x16x32_bf16 v[96:99], a[84:87], a[52:55], v[96:99]
ds_read_b64_tr_b16 a[108:109], v13 offset:8960
v_cvt_pk_bf16_f32 v40, v40, v41
v_cvt_pk_bf16_f32 v41, v42, v43
v_mfma_f32_16x16x32_bf16 v[96:99], a[80:83], a[36:39], v[96:99]
ds_read_b64_tr_b16 a[110:111], v13 offset:9984
v_cvt_pk_bf16_f32 v42, v44, v45
v_mfma_f32_16x16x32_bf16 v[104:107], a[80:83], a[40:43], v[104:107]
s_add_u32 m0, s16, 0x0
s_waitcnt lgkmcnt(8)
v_cvt_pk_bf16_f32 v43, v46, v47
v_mfma_f32_16x16x32_bf16 v[104:107], a[84:87], a[56:59], v[104:107]
buffer_load_dwordx4 v22, s[44:47], s20 offen lds
v_accvgpr_write_b32 a136, v40
v_mfma_f32_16x16x32_bf16 v[112:115], a[84:87], a[60:63], v[112:115]
v_accvgpr_write_b32 a137, v41
v_accvgpr_write_b32 a138, v42
v_mfma_f32_16x16x32_bf16 v[112:115], a[80:83], a[44:47], v[112:115]
v_accvgpr_write_b32 a139, v43
v_cvt_pk_bf16_f32 v48, v48, v49
v_mfma_f32_16x16x32_bf16 v[116:119], a[88:91], a[44:47], v[116:119]
ds_read_b64_tr_b16 a[80:81], v12 offset:16384
v_cvt_pk_bf16_f32 v49, v50, v51
v_cvt_pk_bf16_f32 v50, v52, v53
v_mfma_f32_16x16x32_bf16 v[116:119], a[92:95], a[60:63], v[116:119]
ds_read_b64_tr_b16 a[82:83], v12 offset:17408
v_cvt_pk_bf16_f32 v51, v54, v55
v_mfma_f32_16x16x32_bf16 v[108:111], a[92:95], a[56:59], v[108:111]
ds_read_b64_tr_b16 a[84:85], v12 offset:24576
v_accvgpr_write_b32 a140, v48
v_mfma_f32_16x16x32_bf16 v[108:111], a[88:91], a[40:43], v[108:111]
ds_read_b64_tr_b16 a[86:87], v12 offset:25600
s_add_u32 m0, s16, 0x400
v_accvgpr_write_b32 a141, v49
v_mfma_f32_16x16x32_bf16 v[100:103], a[88:91], a[36:39], v[100:103]
buffer_load_dwordx4 v23, s[44:47], s20 offen lds
v_mfma_f32_16x16x32_bf16 v[100:103], a[92:95], a[52:55], v[100:103]
v_accvgpr_write_b32 a142, v50
v_accvgpr_write_b32 a143, v51
v_mfma_f32_16x16x32_bf16 v[92:95], a[92:95], a[48:51], v[92:95]
v_cvt_pk_bf16_f32 v56, v56, v57
v_cvt_pk_bf16_f32 v57, v58, v59
v_cvt_pk_bf16_f32 v58, v60, v61
v_mfma_f32_16x16x32_bf16 v[92:95], a[88:91], a[32:35], v[92:95]
s_waitcnt lgkmcnt(4)
v_cvt_pk_bf16_f32 v59, v62, v63
v_accvgpr_write_b32 a144, v56
v_mfma_f32_16x16x32_bf16 v[120:123], a[96:99], a[32:35], v[120:123]
ds_read_b64_tr_b16 a[88:89], v13 offset:16384
v_accvgpr_write_b32 a145, v57
v_mfma_f32_16x16x32_bf16 v[120:123], a[100:103], a[48:51], v[120:123]
ds_read_b64_tr_b16 a[90:91], v13 offset:17408
v_accvgpr_write_b32 a146, v58
v_accvgpr_write_b32 a147, v59
v_mfma_f32_16x16x32_bf16 v[128:131], a[100:103], a[52:55], v[128:131]
ds_read_b64_tr_b16 a[92:93], v13 offset:24576
v_cvt_pk_bf16_f32 v64, v64, v65
v_mfma_f32_16x16x32_bf16 v[128:131], a[96:99], a[36:39], v[128:131]
ds_read_b64_tr_b16 a[94:95], v13 offset:25600
s_add_u32 m0, s16, 0x800
v_mfma_f32_16x16x32_bf16 v[136:139], a[96:99], a[40:43], v[136:139]
buffer_load_dwordx4 v22, s[44:47], s21 offen lds
v_cvt_pk_bf16_f32 v65, v66, v67
v_mfma_f32_16x16x32_bf16 v[136:139], a[100:103], a[56:59], v[136:139]
v_cvt_pk_bf16_f32 v66, v68, v69
v_cvt_pk_bf16_f32 v67, v70, v71
v_mfma_f32_16x16x32_bf16 v[144:147], a[100:103], a[60:63], v[144:147]
v_accvgpr_write_b32 a148, v64
v_accvgpr_write_b32 a149, v65
v_mfma_f32_16x16x32_bf16 v[144:147], a[96:99], a[44:47], v[144:147]
v_accvgpr_write_b32 a150, v66
v_accvgpr_write_b32 a151, v67
v_cvt_pk_bf16_f32 v72, v72, v73
v_mfma_f32_16x16x32_bf16 v[148:151], a[104:107], a[44:47], v[148:151]
ds_read_b64_tr_b16 a[96:97], v12 offset:16640
v_cvt_pk_bf16_f32 v73, v74, v75
v_mfma_f32_16x16x32_bf16 v[148:151], a[108:111], a[60:63], v[148:151]
ds_read_b64_tr_b16 a[98:99], v12 offset:17664
v_cvt_pk_bf16_f32 v74, v76, v77
v_mfma_f32_16x16x32_bf16 v[140:143], a[108:111], a[56:59], v[140:143]
ds_read_b64_tr_b16 a[100:101], v12 offset:24832
s_add_u32 m0, s16, 0xc00
v_cvt_pk_bf16_f32 v75, v78, v79
v_mfma_f32_16x16x32_bf16 v[140:143], a[104:107], a[40:43], v[140:143]
buffer_load_dwordx4 v23, s[44:47], s21 offen lds
v_mfma_f32_16x16x32_bf16 v[132:135], a[104:107], a[36:39], v[132:135]
ds_read_b64_tr_b16 a[102:103], v12 offset:25856
v_accvgpr_write_b32 a152, v72
v_mfma_f32_16x16x32_bf16 v[132:135], a[108:111], a[52:55], v[132:135]
v_accvgpr_write_b32 a153, v73
v_accvgpr_write_b32 a154, v74
v_accvgpr_write_b32 a155, v75
v_mfma_f32_16x16x32_bf16 v[124:127], a[108:111], a[48:51], v[124:127]
v_cvt_pk_bf16_f32 v80, v80, v81
v_cvt_pk_bf16_f32 v81, v82, v83
v_mfma_f32_16x16x32_bf16 v[124:127], a[104:107], a[32:35], v[124:127]
s_waitcnt lgkmcnt(4)
v_cvt_pk_bf16_f32 v82, v84, v85
v_cvt_pk_bf16_f32 v83, v86, v87
v_mfma_f32_16x16x32_bf16 v[152:155], a[32:35], a[80:83], v[152:155]
ds_read_b64_tr_b16 a[104:105], v13 offset:16640
v_accvgpr_write_b32 a156, v80
v_accvgpr_write_b32 a157, v81
v_mfma_f32_16x16x32_bf16 v[152:155], a[48:51], a[84:87], v[152:155]
ds_read_b64_tr_b16 a[106:107], v13 offset:17664
s_add_u32 m0, s16, 0x1000
v_mfma_f32_16x16x32_bf16 v[156:159], a[52:55], a[84:87], v[156:159]
buffer_load_dwordx4 v22, s[44:47], s22 offen lds
v_mfma_f32_16x16x32_bf16 v[156:159], a[36:39], a[80:83], v[156:159]
ds_read_b64_tr_b16 a[108:109], v13 offset:24832
v_accvgpr_write_b32 a158, v82
v_accvgpr_write_b32 a159, v83
v_mfma_f32_16x16x32_bf16 v[160:163], a[40:43], a[80:83], v[160:163]
ds_read_b64_tr_b16 a[110:111], v13 offset:25856
v_cvt_pk_bf16_f32 v88, v88, v89
v_mfma_f32_16x16x32_bf16 v[160:163], a[56:59], a[84:87], v[160:163]
v_cvt_pk_bf16_f32 v89, v90, v91
v_cvt_pk_bf16_f32 v90, v92, v93
v_mfma_f32_16x16x32_bf16 v[164:167], a[60:63], a[84:87], v[164:167]
v_cvt_pk_bf16_f32 v91, v94, v95
v_accvgpr_write_b32 a160, v88
v_accvgpr_write_b32 a161, v89
v_mfma_f32_16x16x32_bf16 v[164:167], a[44:47], a[80:83], v[164:167]
v_accvgpr_write_b32 a162, v90
v_accvgpr_write_b32 a163, v91
v_mfma_f32_16x16x32_bf16 v[180:183], a[44:47], a[88:91], v[180:183]
ds_read_b64_tr_b16 a[80:81], v12 offset:16896
v_cvt_pk_bf16_f32 v96, v96, v97
v_mfma_f32_16x16x32_bf16 v[180:183], a[60:63], a[92:95], v[180:183]
ds_read_b64_tr_b16 a[82:83], v12 offset:17920
s_add_u32 m0, s16, 0x1400
v_cvt_pk_bf16_f32 v97, v98, v99
v_mfma_f32_16x16x32_bf16 v[176:179], a[56:59], a[92:95], v[176:179]
buffer_load_dwordx4 v23, s[44:47], s22 offen lds
v_mfma_f32_16x16x32_bf16 v[176:179], a[40:43], a[88:91], v[176:179]
ds_read_b64_tr_b16 a[84:85], v12 offset:25088
v_cvt_pk_bf16_f32 v98, v100, v101
v_mfma_f32_16x16x32_bf16 v[172:175], a[36:39], a[88:91], v[172:175]
ds_read_b64_tr_b16 a[86:87], v12 offset:26112
v_cvt_pk_bf16_f32 v99, v102, v103
v_accvgpr_write_b32 a164, v96
v_mfma_f32_16x16x32_bf16 v[172:175], a[52:55], a[92:95], v[172:175]
v_accvgpr_write_b32 a165, v97
v_accvgpr_write_b32 a166, v98
v_mfma_f32_16x16x32_bf16 v[168:171], a[48:51], a[92:95], v[168:171]
v_accvgpr_write_b32 a167, v99
v_cvt_pk_bf16_f32 v104, v104, v105
v_mfma_f32_16x16x32_bf16 v[168:171], a[32:35], a[88:91], v[168:171]
s_waitcnt lgkmcnt(4)
v_cvt_pk_bf16_f32 v105, v106, v107
v_cvt_pk_bf16_f32 v106, v108, v109
v_cvt_pk_bf16_f32 v107, v110, v111
v_mfma_f32_16x16x32_bf16 v[184:187], a[32:35], a[96:99], v[184:187]
ds_read_b64_tr_b16 a[88:89], v13 offset:16896
s_add_u32 m0, s16, 0x1800
v_mfma_f32_16x16x32_bf16 v[184:187], a[48:51], a[100:103], v[184:187]
buffer_load_dwordx4 v22, s[44:47], s23 offen lds
v_mfma_f32_16x16x32_bf16 v[188:191], a[52:55], a[100:103], v[188:191]
ds_read_b64_tr_b16 a[90:91], v13 offset:17920
v_accvgpr_write_b32 a168, v104
v_accvgpr_write_b32 a169, v105
v_mfma_f32_16x16x32_bf16 v[188:191], a[36:39], a[96:99], v[188:191]
ds_read_b64_tr_b16 a[92:93], v13 offset:25088
v_accvgpr_write_b32 a170, v106
v_mfma_f32_16x16x32_bf16 v[192:195], a[40:43], a[96:99], v[192:195]
ds_read_b64_tr_b16 a[94:95], v13 offset:26112
v_accvgpr_write_b32 a171, v107
v_mfma_f32_16x16x32_bf16 v[192:195], a[56:59], a[100:103], v[192:195]
L_padA4:
s_cmp_eq_u32 s95, 1
s_cbranch_scc1 L_padA8
v_cvt_pk_bf16_f32 v112, v112, v113
v_cvt_pk_bf16_f32 v113, v114, v115
v_cvt_pk_bf16_f32 v114, v116, v117
v_mfma_f32_16x16x32_bf16 v[196:199], a[60:63], a[100:103], v[196:199]
v_cvt_pk_bf16_f32 v115, v118, v119
v_accvgpr_write_b32 a172, v112
v_mfma_f32_16x16x32_bf16 v[196:199], a[44:47], a[96:99], v[196:199]
v_accvgpr_write_b32 a173, v113
v_accvgpr_write_b32 a174, v114
v_mfma_f32_16x16x32_bf16 v[212:215], a[44:47], a[104:107], v[212:215]
ds_read_b64_tr_b16 a[96:97], v12 offset:17152
s_add_u32 m0, s16, 0x1c00
v_accvgpr_write_b32 a175, v115
v_mfma_f32_16x16x32_bf16 v[212:215], a[60:63], a[108:111], v[212:215]
buffer_load_dwordx4 v23, s[44:47], s23 offen lds
v_mfma_f32_16x16x32_bf16 v[208:211], a[56:59], a[108:111], v[208:211]
ds_read_b64_tr_b16 a[98:99], v12 offset:18176
v_lshl_add_u32 v22, s42, 7, v22
v_mfma_f32_16x16x32_bf16 v[208:211], a[40:43], a[104:107], v[208:211]
ds_read_b64_tr_b16 a[100:101], v12 offset:25344
v_lshl_add_u32 v23, s42, 7, v23
v_cvt_pk_bf16_f32 v120, v120, v121
v_mfma_f32_16x16x32_bf16 v[204:207], a[36:39], a[104:107], v[204:207]
ds_read_b64_tr_b16 a[102:103], v12 offset:26368
v_cvt_pk_bf16_f32 v121, v122, v123
v_mfma_f32_16x16x32_bf16 v[204:207], a[52:55], a[108:111], v[204:207]
v_cvt_pk_bf16_f32 v122, v124, v125
v_cvt_pk_bf16_f32 v123, v126, v127
v_mfma_f32_16x16x32_bf16 v[200:203], a[48:51], a[108:111], v[200:203]
v_accvgpr_write_b32 a176, v120
v_accvgpr_write_b32 a177, v121
v_accvgpr_write_b32 a178, v122
v_mfma_f32_16x16x32_bf16 v[200:203], a[32:35], a[104:107], v[200:203]
s_mov_b32 s9, 0x600000
s_waitcnt lgkmcnt(4)
v_accvgpr_write_b32 a179, v123
v_mfma_f32_16x16x32_bf16 v[216:219], a[32:35], a[80:83], v[216:219]
buffer_load_dword a120, v18, s[52:55], s9 offen
v_mfma_f32_16x16x32_bf16 v[216:219], a[48:51], a[84:87], v[216:219]
ds_read_b64_tr_b16 a[104:105], v13 offset:17152
v_cvt_pk_bf16_f32 v128, v128, v129
v_cvt_pk_bf16_f32 v129, v130, v131
v_mfma_f32_16x16x32_bf16 v[220:223], a[52:55], a[84:87], v[220:223]
ds_read_b64_tr_b16 a[106:107], v13 offset:18176
v_cvt_pk_bf16_f32 v130, v132, v133
v_mfma_f32_16x16x32_bf16 v[220:223], a[36:39], a[80:83], v[220:223]
ds_read_b64_tr_b16 a[108:109], v13 offset:25344
v_cvt_pk_bf16_f32 v131, v134, v135
v_mfma_f32_16x16x32_bf16 v[224:227], a[40:43], a[80:83], v[224:227]
ds_read_b64_tr_b16 a[110:111], v13 offset:26368
v_add_u32 v12, 0x8000, v12
v_accvgpr_write_b32 a180, v128
v_mfma_f32_16x16x32_bf16 v[224:227], a[56:59], a[84:87], v[224:227]
v_add_u32 v13, 0x8000, v13
v_accvgpr_write_b32 a181, v129
v_mfma_f32_16x16x32_bf16 v[228:231], a[60:63], a[84:87], v[228:231]
v_accvgpr_write_b32 a182, v130
v_accvgpr_write_b32 a183, v131
v_mfma_f32_16x16x32_bf16 v[228:231], a[44:47], a[80:83], v[228:231]
v_cvt_pk_bf16_f32 v136, v136, v137
v_cvt_pk_bf16_f32 v137, v138, v139
v_cvt_pk_bf16_f32 v138, v140, v141
v_mfma_f32_16x16x32_bf16 v[244:247], a[44:47], a[88:91], v[244:247]
s_waitcnt vmcnt(27) lgkmcnt(0)
v_cvt_pk_bf16_f32 v139, v142, v143
v_accvgpr_write_b32 a184, v136
v_mfma_f32_16x16x32_bf16 v[244:247], a[60:63], a[92:95], v[244:247]
s_barrier
s_add_u32 m0, s17, 0x8000
v_accvgpr_write_b32 a185, v137
v_mfma_f32_16x16x32_bf16 v[240:243], a[56:59], a[92:95], v[240:243]
buffer_load_dwordx4 v5, s[52:55], 0 offen lds
v_accvgpr_write_b32 a186, v138
v_mfma_f32_16x16x32_bf16 v[240:243], a[40:43], a[88:91], v[240:243]
ds_read_b64_tr_b16 a[80:81], v12 offset:0
v_accvgpr_write_b32 a187, v139
v_mfma_f32_16x16x32_bf16 v[236:239], a[36:39], a[88:91], v[236:239]
ds_read_b64_tr_b16 a[82:83], v12 offset:1024
v_cvt_pk_bf16_f32 v144, v144, v145
v_mfma_f32_16x16x32_bf16 v[236:239], a[52:55], a[92:95], v[236:239]
ds_read_b64_tr_b16 a[84:85], v12 offset:8192
v_cvt_pk_bf16_f32 v145, v146, v147
v_cvt_pk_bf16_f32 v146, v148, v149
v_mfma_f32_16x16x32_bf16 v[232:235], a[48:51], a[92:95], v[232:235]
ds_read_b64_tr_b16 a[86:87], v12 offset:9216
v_cvt_pk_bf16_f32 v147, v150, v151
v_mfma_f32_16x16x32_bf16 v[232:235], a[32:35], a[88:91], v[232:235]
s_add_u32 m0, s17, 0x8400
s_waitcnt lgkmcnt(4)
v_accvgpr_write_b32 a188, v144
v_mfma_f32_16x16x32_bf16 v[248:251], a[32:35], a[96:99], v[248:251]
buffer_load_dwordx4 v5, s[52:55], s13 offen lds
v_accvgpr_write_b32 a189, v145
v_mfma_f32_16x16x32_bf16 v[248:251], a[48:51], a[100:103], v[248:251]
ds_read_b64_tr_b16 a[88:89], v13 offset:0
v_accvgpr_write_b32 a190, v146
v_mfma_f32_16x16x32_bf16 v[252:255], a[52:55], a[100:103], v[252:255]
ds_read_b64_tr_b16 a[90:91], v13 offset:1024
v_accvgpr_write_b32 a191, v147
v_mfma_f32_16x16x32_bf16 v[252:255], a[36:39], a[96:99], v[252:255]
ds_read_b64_tr_b16 a[92:93], v13 offset:8192
v_cvt_pk_bf16_f32 v152, v152, v153
v_cvt_pk_bf16_f32 v153, v154, v155
v_mfma_f32_16x16x32_bf16 a[232:235], a[40:43], a[96:99], a[232:235]
ds_read_b64_tr_b16 a[94:95], v13 offset:9216
v_cvt_pk_bf16_f32 v154, v156, v157
v_mfma_f32_16x16x32_bf16 a[232:235], a[56:59], a[100:103], a[232:235]
v_cvt_pk_bf16_f32 v155, v158, v159
v_accvgpr_write_b32 a192, v152
v_mfma_f32_16x16x32_bf16 a[236:239], a[60:63], a[100:103], a[236:239]
s_add_u32 m0, s17, 0x8800
v_accvgpr_write_b32 a193, v153
v_accvgpr_write_b32 a194, v154
v_accvgpr_write_b32 a195, v155
v_mfma_f32_16x16x32_bf16 a[236:239], a[44:47], a[96:99], a[236:239]
buffer_load_dwordx4 v6, s[52:55], 0 offen lds
v_mfma_f32_16x16x32_bf16 a[252:255], a[44:47], a[104:107], a[252:255]
ds_read_b64_tr_b16 a[96:97], v12 offset:256
v_cvt_pk_bf16_f32 v160, v160, v161
v_mfma_f32_16x16x32_bf16 a[252:255], a[60:63], a[108:111], a[252:255]
ds_read_b64_tr_b16 a[98:99], v12 offset:1280
v_cvt_pk_bf16_f32 v161, v162, v163
v_cvt_pk_bf16_f32 v162, v164, v165
v_mfma_f32_16x16x32_bf16 a[248:251], a[56:59], a[108:111], a[248:251]
ds_read_b64_tr_b16 a[100:101], v12 offset:8448
v_cvt_pk_bf16_f32 v163, v166, v167
v_mfma_f32_16x16x32_bf16 a[248:251], a[40:43], a[104:107], a[248:251]
ds_read_b64_tr_b16 a[102:103], v12 offset:9472
v_accvgpr_write_b32 a196, v160
v_mfma_f32_16x16x32_bf16 a[244:247], a[36:39], a[104:107], a[244:247]
v_accvgpr_write_b32 a197, v161
v_accvgpr_write_b32 a198, v162
v_accvgpr_write_b32 a199, v163
v_mfma_f32_16x16x32_bf16 a[244:247], a[52:55], a[108:111], a[244:247]
s_add_u32 m0, s17, 0x8c00
v_cvt_pk_bf16_f32 v168, v168, v169
v_cvt_pk_bf16_f32 v169, v170, v171
v_mfma_f32_16x16x32_bf16 a[240:243], a[48:51], a[108:111], a[240:243]
buffer_load_dwordx4 v6, s[52:55], s13 offen lds
v_mfma_f32_16x16x32_bf16 a[240:243], a[32:35], a[104:107], a[240:243]
s_waitcnt lgkmcnt(4)
v_cvt_pk_bf16_f32 v170, v172, v173
v_cvt_pk_bf16_f32 v171, v174, v175
v_accvgpr_write_b32 a200, v168
L_S8:
v_mfma_f32_16x16x32_bf16 v[24:27], a[80:83], a[0:3], 0
ds_read_b64_tr_b16 a[104:105], v13 offset:256
s_waitcnt vmcnt(22)
v_mfma_f32_16x16x32_bf16 v[24:27], a[84:87], a[16:19], v[24:27]
ds_read_b64_tr_b16 a[106:107], v13 offset:1280
v_accvgpr_write_b32 a201, v169
v_mfma_f32_16x16x32_bf16 v[32:35], a[84:87], a[20:23], 0
ds_read_b64_tr_b16 a[108:109], v13 offset:8448
v_accvgpr_write_b32 a202, v170
v_accvgpr_write_b32 a203, v171
v_mfma_f32_16x16x32_bf16 v[32:35], a[80:83], a[4:7], v[32:35]
ds_read_b64_tr_b16 a[110:111], v13 offset:9472
v_cvt_pk_bf16_f32 v176, v176, v177
v_mfma_f32_16x16x32_bf16 v[40:43], a[80:83], a[8:11], 0
ds_read_b128 a[32:35], v8 offset:32768
s_add_u32 m0, s18, 0xc000
v_mfma_f32_16x16x32_bf16 v[40:43], a[84:87], a[24:27], v[40:43]
buffer_load_dwordx4 v7, s[68:71], 0 offen lds
v_cvt_pk_bf16_f32 v177, v178, v179
v_mfma_f32_16x16x32_bf16 v[48:51], a[84:87], a[28:31], 0
ds_read_b128 a[48:51], v9 offset:32768
v_cvt_pk_bf16_f32 v178, v180, v181
v_mfma_f32_16x16x32_bf16 v[48:51], a[80:83], a[12:15], v[48:51]
ds_read_b128 a[36:39], v8 offset:34816
v_cvt_pk_bf16_f32 v179, v182, v183
v_mfma_f32_16x16x32_bf16 v[52:55], a[88:91], a[12:15], 0
ds_read_b64_tr_b16 a[80:81], v12 offset:512
v_accvgpr_write_b32 a204, v176
v_accvgpr_write_b32 a205, v177
v_mfma_f32_16x16x32_bf16 v[52:55], a[92:95], a[28:31], v[52:55]
ds_read_b64_tr_b16 a[82:83], v12 offset:1536
v_accvgpr_write_b32 a206, v178
v_mfma_f32_16x16x32_bf16 v[44:47], a[92:95], a[24:27], 0
ds_read_b64_tr_b16 a[84:85], v12 offset:8704
s_add_u32 s8, s28, 0x2000
v_mfma_f32_16x16x32_bf16 v[44:47], a[88:91], a[8:11], v[44:47]
buffer_store_dwordx4 a[128:131], v16, s[88:91], s8 offen sc1
v_accvgpr_write_b32 a207, v179
v_mfma_f32_16x16x32_bf16 v[36:39], a[88:91], a[4:7], 0
ds_read_b64_tr_b16 a[86:87], v12 offset:9728
v_cvt_pk_bf16_f32 v184, v184, v185
v_mfma_f32_16x16x32_bf16 v[36:39], a[92:95], a[20:23], v[36:39]
ds_read_b128 a[52:55], v9 offset:34816
v_cvt_pk_bf16_f32 v185, v186, v187
v_mfma_f32_16x16x32_bf16 v[28:31], a[92:95], a[16:19], 0
ds_read_b128 a[40:43], v8 offset:36864
v_cvt_pk_bf16_f32 v186, v188, v189
v_cvt_pk_bf16_f32 v187, v190, v191
v_mfma_f32_16x16x32_bf16 v[28:31], a[88:91], a[0:3], v[28:31]
ds_read_b128 a[56:59], v9 offset:36864
s_waitcnt lgkmcnt(10)
v_mfma_f32_16x16x32_bf16 v[56:59], a[96:99], a[0:3], 0
ds_read_b64_tr_b16 a[88:89], v13 offset:512
v_accvgpr_write_b32 a208, v184
v_mfma_f32_16x16x32_bf16 v[56:59], a[100:103], a[16:19], v[56:59]
ds_read_b64_tr_b16 a[90:91], v13 offset:1536
s_add_u32 m0, s18, 0xd000
v_accvgpr_write_b32 a209, v185
v_mfma_f32_16x16x32_bf16 v[64:67], a[100:103], a[20:23], 0
buffer_load_dwordx4 v7, s[68:71], s25 offen lds
v_mfma_f32_16x16x32_bf16 v[64:67], a[96:99], a[4:7], v[64:67]
ds_read_b64_tr_b16 a[92:93], v13 offset:8704
v_accvgpr_write_b32 a210, v186
v_mfma_f32_16x16x32_bf16 v[72:75], a[96:99], a[8:11], 0
ds_read_b64_tr_b16 a[94:95], v13 offset:9728
v_accvgpr_write_b32 a211, v187
v_cvt_pk_bf16_f32 v192, v192, v193
v_mfma_f32_16x16x32_bf16 v[72:75], a[100:103], a[24:27], v[72:75]
ds_read_b128 a[44:47], v8 offset:38912
v_cvt_pk_bf16_f32 v193, v194, v195
v_mfma_f32_16x16x32_bf16 v[80:83], a[100:103], a[28:31], 0
ds_read_b128 a[60:63], v9 offset:38912
v_cvt_pk_bf16_f32 v194, v196, v197
v_mfma_f32_16x16x32_bf16 v[80:83], a[96:99], a[12:15], v[80:83]
v_cvt_pk_bf16_f32 v195, v198, v199
v_accvgpr_write_b32 a212, v192
v_accvgpr_write_b32 a213, v193
v_mfma_f32_16x16x32_bf16 v[84:87], a[104:107], a[12:15], 0
ds_read_b64_tr_b16 a[96:97], v12 offset:768
s_add_u32 m0, s18, 0xe000
v_mfma_f32_16x16x32_bf16 v[84:87], a[108:111], a[28:31], v[84:87]
buffer_load_dwordx4 v7, s[68:71], s26 offen lds
v_mfma_f32_16x16x32_bf16 v[76:79], a[108:111], a[24:27], 0
ds_read_b64_tr_b16 a[98:99], v12 offset:1792
v_lshl_add_u32 v5, s42, 19, v5
v_accvgpr_write_b32 a214, v194
v_mfma_f32_16x16x32_bf16 v[76:79], a[104:107], a[8:11], v[76:79]
ds_read_b64_tr_b16 a[100:101], v12 offset:8960
v_lshl_add_u32 v6, s42, 19, v6
v_mfma_f32_16x16x32_bf16 v[68:71], a[104:107], a[4:7], 0
ds_read_b64_tr_b16 a[102:103], v12 offset:9984
v_lshl_add_u32 v7, s42, 18, v7
v_mfma_f32_16x16x32_bf16 v[68:71], a[108:111], a[20:23], v[68:71]
v_lshl_add_u32 v7, s42, 17, v7
v_accvgpr_write_b32 a215, v195
v_cvt_pk_bf16_f32 v200, v200, v201
v_mfma_f32_16x16x32_bf16 v[60:63], a[108:111], a[16:19], 0
v_cvt_pk_bf16_f32 v201, v202, v203
v_cvt_pk_bf16_f32 v202, v204, v205
v_mfma_f32_16x16x32_bf16 v[60:63], a[104:107], a[0:3], v[60:63]
s_add_u32 m0, s16, 0x8000
s_waitcnt lgkmcnt(4)
s_waitcnt lgkmcnt(6)
v_mfma_f32_16x16x32_bf16 v[88:91], a[80:83], a[0:3], 0
buffer_load_dwordx4 v22, s[44:47], s20 offen lds
v_cvt_pk_bf16_f32 v203, v206, v207
v_mfma_f32_16x16x32_bf16 v[88:91], a[84:87], a[16:19], v[88:91]
ds_read_b64_tr_b16 a[104:105], v13 offset:768
v_accvgpr_write_b32 a216, v200
v_mfma_f32_16x16x32_bf16 v[96:99], a[84:87], a[20:23], 0
ds_read_b64_tr_b16 a[106:107], v13 offset:1792
v_accvgpr_write_b32 a217, v201
v_mfma_f32_16x16x32_bf16 v[96:99], a[80:83], a[4:7], v[96:99]
ds_read_b64_tr_b16 a[108:109], v13 offset:8960
v_accvgpr_write_b32 a218, v202
v_accvgpr_write_b32 a219, v203
v_mfma_f32_16x16x32_bf16 v[104:107], a[80:83], a[8:11], 0
ds_read_b64_tr_b16 a[110:111], v13 offset:9984
s_add_u32 m0, s16, 0x8400
v_mfma_f32_16x16x32_bf16 v[104:107], a[84:87], a[24:27], v[104:107]
buffer_load_dwordx4 v23, s[44:47], s20 offen lds
v_mfma_f32_16x16x32_bf16 v[112:115], a[84:87], a[28:31], 0
v_cvt_pk_bf16_f32 v208, v208, v209
v_cvt_pk_bf16_f32 v209, v210, v211
v_cvt_pk_bf16_f32 v210, v212, v213
v_mfma_f32_16x16x32_bf16 v[112:115], a[80:83], a[12:15], v[112:115]
v_cvt_pk_bf16_f32 v211, v214, v215
v_accvgpr_write_b32 a220, v208
v_mfma_f32_16x16x32_bf16 v[116:119], a[88:91], a[12:15], 0
ds_read_b64_tr_b16 a[80:81], v14 offset:0
v_accvgpr_write_b32 a221, v209
v_mfma_f32_16x16x32_bf16 v[116:119], a[92:95], a[28:31], v[116:119]
ds_read_b64_tr_b16 a[82:83], v14 offset:256
v_accvgpr_write_b32 a222, v210
v_accvgpr_write_b32 a223, v211
v_mfma_f32_16x16x32_bf16 v[108:111], a[92:95], a[24:27], 0
ds_read_b64_tr_b16 a[84:85], v14 offset:2048
s_add_u32 m0, s16, 0x8800
v_mfma_f32_16x16x32_bf16 v[108:111], a[88:91], a[8:11], v[108:111]
buffer_load_dwordx4 v22, s[44:47], s21 offen lds
v_mfma_f32_16x16x32_bf16 v[100:103], a[88:91], a[4:7], 0
ds_read_b64_tr_b16 a[86:87], v14 offset:2304
v_cvt_pk_bf16_f32 v216, v216, v217
v_cvt_pk_bf16_f32 v217, v218, v219
v_mfma_f32_16x16x32_bf16 v[100:103], a[92:95], a[20:23], v[100:103]
v_cvt_pk_bf16_f32 v218, v220, v221
v_cvt_pk_bf16_f32 v219, v222, v223
v_mfma_f32_16x16x32_bf16 v[92:95], a[92:95], a[16:19], 0
v_accvgpr_write_b32 a224, v216
v_accvgpr_write_b32 a225, v217
v_mfma_f32_16x16x32_bf16 v[92:95], a[88:91], a[0:3], v[92:95]
s_add_u32 s8, s28, 0x3000
s_waitcnt lgkmcnt(4)
v_accvgpr_write_b32 a226, v218
v_accvgpr_write_b32 a227, v219
v_mfma_f32_16x16x32_bf16 v[120:123], a[96:99], a[0:3], 0
buffer_store_dwordx4 a[132:135], v16, s[88:91], s8 offen sc1
v_mfma_f32_16x16x32_bf16 v[120:123], a[100:103], a[16:19], v[120:123]
ds_read_b64_tr_b16 a[88:89], v15 offset:0
v_cvt_pk_bf16_f32 v224, v224, v225
v_mfma_f32_16x16x32_bf16 v[128:131], a[100:103], a[20:23], 0
ds_read_b64_tr_b16 a[90:91], v15 offset:256
v_cvt_pk_bf16_f32 v225, v226, v227
v_cvt_pk_bf16_f32 v226, v228, v229
v_mfma_f32_16x16x32_bf16 v[128:131], a[96:99], a[4:7], v[128:131]
ds_read_b64_tr_b16 a[92:93], v15 offset:2048
v_cvt_pk_bf16_f32 v227, v230, v231
v_mfma_f32_16x16x32_bf16 v[136:139], a[96:99], a[8:11], 0
ds_read_b64_tr_b16 a[94:95], v15 offset:2304
v_accvgpr_write_b32 a228, v224
v_mfma_f32_16x16x32_bf16 v[136:139], a[100:103], a[24:27], v[136:139]
s_add_u32 m0, s16, 0x8c00
v_accvgpr_write_b32 a229, v225
v_accvgpr_write_b32 a230, v226
v_accvgpr_write_b32 a231, v227
v_mfma_f32_16x16x32_bf16 v[144:147], a[100:103], a[28:31], 0
buffer_load_dwordx4 v23, s[44:47], s21 offen lds
v_mfma_f32_16x16x32_bf16 v[144:147], a[96:99], a[12:15], v[144:147]
v_cvt_pk_bf16_f32 v232, v232, v233
v_cvt_pk_bf16_f32 v233, v234, v235
v_mfma_f32_16x16x32_bf16 v[148:151], a[104:107], a[12:15], 0
ds_read_b64_tr_b16 a[96:97], v14 offset:4096
v_cvt_pk_bf16_f32 v234, v236, v237
v_cvt_pk_bf16_f32 v235, v238, v239
v_mfma_f32_16x16x32_bf16 v[148:151], a[108:111], a[28:31], v[148:151]
ds_read_b64_tr_b16 a[98:99], v14 offset:4352
v_accvgpr_write_b32 a112, v232
v_mfma_f32_16x16x32_bf16 v[140:143], a[108:111], a[24:27], 0
ds_read_b64_tr_b16 a[100:101], v14 offset:6144
v_accvgpr_write_b32 a113, v233
v_mfma_f32_16x16x32_bf16 v[140:143], a[104:107], a[8:11], v[140:143]
ds_read_b64_tr_b16 a[102:103], v14 offset:6400
s_add_u32 m0, s16, 0x9000
v_accvgpr_write_b32 a114, v234
v_mfma_f32_16x16x32_bf16 v[132:135], a[104:107], a[4:7], 0
buffer_load_dwordx4 v22, s[44:47], s22 offen lds
v_mfma_f32_16x16x32_bf16 v[132:135], a[108:111], a[20:23], v[132:135]
v_accvgpr_write_b32 a115, v235
v_cvt_pk_bf16_f32 v240, v240, v241
v_mfma_f32_16x16x32_bf16 v[124:127], a[108:111], a[16:19], 0
v_cvt_pk_bf16_f32 v241, v242, v243
v_cvt_pk_bf16_f32 v242, v244, v245
v_cvt_pk_bf16_f32 v243, v246, v247
v_mfma_f32_16x16x32_bf16 v[124:127], a[104:107], a[0:3], v[124:127]
s_waitcnt lgkmcnt(4)
v_accvgpr_write_b32 a116, v240
v_accvgpr_write_b32 a117, v241
v_mfma_f32_16x16x32_bf16 v[152:155], a[80:83], a[0:3], 0
ds_read_b64_tr_b16 a[104:105], v15 offset:4096
s_add_u32 m0, s16, 0x9400
v_mfma_f32_16x16x32_bf16 v[152:155], a[84:87], a[16:19], v[152:155]
buffer_load_dwordx4 v23, s[44:47], s22 offen lds
v_accvgpr_write_b32 a118, v242
v_mfma_f32_16x16x32_bf16 v[160:163], a[84:87], a[20:23], 0
ds_read_b64_tr_b16 a[106:107], v15 offset:4352
v_accvgpr_write_b32 a119, v243
v_mfma_f32_16x16x32_bf16 v[160:163], a[80:83], a[4:7], v[160:163]
ds_read_b64_tr_b16 a[108:109], v15 offset:6144
v_cvt_pk_bf16_f32 v248, v248, v249
v_mfma_f32_16x16x32_bf16 v[168:171], a[80:83], a[8:11], 0
ds_read_b64_tr_b16 a[110:111], v15 offset:6400
v_cvt_pk_bf16_f32 v249, v250, v251
v_cvt_pk_bf16_f32 v250, v252, v253
v_mfma_f32_16x16x32_bf16 v[168:171], a[84:87], a[24:27], v[168:171]
v_cvt_pk_bf16_f32 v251, v254, v255
v_accvgpr_write_b32 a124, v248
v_mfma_f32_16x16x32_bf16 v[176:179], a[84:87], a[28:31], 0
s_add_u32 m0, s16, 0x9800
v_accvgpr_write_b32 a125, v249
v_accvgpr_write_b32 a126, v250
v_mfma_f32_16x16x32_bf16 v[176:179], a[80:83], a[12:15], v[176:179]
buffer_load_dwordx4 v22, s[44:47], s23 offen lds
v_accvgpr_write_b32 a127, v251
v_mfma_f32_16x16x32_bf16 v[180:183], a[88:91], a[12:15], 0
ds_read_b64_tr_b16 a[80:81], v14 offset:8192
v_accvgpr_read_b32 v2, a232
v_mfma_f32_16x16x32_bf16 v[180:183], a[92:95], a[28:31], v[180:183]
ds_read_b64_tr_b16 a[82:83], v14 offset:8448
v_accvgpr_read_b32 v3, a233
v_mfma_f32_16x16x32_bf16 v[172:175], a[92:95], a[24:27], 0
ds_read_b64_tr_b16 a[84:85], v14 offset:10240
v_cvt_pk_bf16_f32 v2, v2, v3
v_accvgpr_write_b32 a232, v2
v_mfma_f32_16x16x32_bf16 v[172:175], a[88:91], a[8:11], v[172:175]
ds_read_b64_tr_b16 a[86:87], v14 offset:10496
s_add_u32 m0, s16, 0x9c00
v_mfma_f32_16x16x32_bf16 v[164:167], a[88:91], a[4:7], 0
buffer_load_dwordx4 v23, s[44:47], s23 offen lds
v_mfma_f32_16x16x32_bf16 v[164:167], a[92:95], a[20:23], v[164:167]
v_lshl_add_u32 v22, s42, 7, v22
v_lshl_add_u32 v23, s42, 7, v23
v_accvgpr_read_b32 v2, a234
v_mfma_f32_16x16x32_bf16 v[156:159], a[92:95], a[16:19], 0
v_accvgpr_read_b32 v3, a235
v_cvt_pk_bf16_f32 v2, v2, v3
v_mfma_f32_16x16x32_bf16 v[156:159], a[88:91], a[0:3], v[156:159]
s_waitcnt lgkmcnt(4)
v_accvgpr_write_b32 a233, v2
v_accvgpr_read_b32 v2, a236
v_mfma_f32_16x16x32_bf16 v[184:187], a[96:99], a[0:3], 0
ds_read_b64_tr_b16 a[88:89], v15 offset:8192
v_accvgpr_read_b32 v3, a237
v_cvt_pk_bf16_f32 v2, v2, v3
v_mfma_f32_16x16x32_bf16 v[184:187], a[100:103], a[16:19], v[184:187]
ds_read_b64_tr_b16 a[90:91], v15 offset:8448
s_add_u32 s8, s28, 0x6000
v_mfma_f32_16x16x32_bf16 v[192:195], a[100:103], a[20:23], 0
buffer_store_dwordx4 a[136:139], v16, s[88:91], s8 offen sc1
v_mfma_f32_16x16x32_bf16 v[192:195], a[96:99], a[4:7], v[192:195]
ds_read_b64_tr_b16 a[92:93], v15 offset:10240
v_accvgpr_write_b32 a234, v2
v_accvgpr_read_b32 v2, a238
v_mfma_f32_16x16x32_bf16 v[200:203], a[96:99], a[8:11], 0
ds_read_b64_tr_b16 a[94:95], v15 offset:10496
v_add_u32 v12, 0xffff0000, v12
v_mfma_f32_16x16x32_bf16 v[200:203], a[100:103], a[24:27], v[200:203]
v_add_u32 v13, 0xffff0000, v13
v_add_u32 v14, 0xffff0000, v14
v_mfma_f32_16x16x32_bf16 v[208:211], a[100:103], a[28:31], 0
v_add_u32 v15, 0xffff0000, v15
v_accvgpr_read_b32 v3, a239
v_cvt_pk_bf16_f32 v2, v2, v3
v_mfma_f32_16x16x32_bf16 v[208:211], a[96:99], a[12:15], v[208:211]
v_accvgpr_write_b32 a235, v2
v_accvgpr_read_b32 v2, a240
v_mfma_f32_16x16x32_bf16 v[212:215], a[104:107], a[12:15], 0
s_waitcnt vmcnt(28) lgkmcnt(0)
v_accvgpr_read_b32 v3, a241
v_cvt_pk_bf16_f32 v2, v2, v3
v_mfma_f32_16x16x32_bf16 v[212:215], a[108:111], a[28:31], v[212:215]
s_barrier
s_add_u32 m0, s17, 0x10000
v_accvgpr_write_b32 a240, v2
v_accvgpr_read_b32 v2, a242
v_mfma_f32_16x16x32_bf16 v[204:207], a[108:111], a[24:27], 0
buffer_load_dwordx4 v5, s[52:55], 0 offen lds
v_mfma_f32_16x16x32_bf16 v[204:207], a[104:107], a[8:11], v[204:207]
ds_read_b64_tr_b16 a[96:97], v12 offset:0
v_accvgpr_read_b32 v3, a243
v_mfma_f32_16x16x32_bf16 v[196:199], a[104:107], a[4:7], 0
ds_read_b64_tr_b16 a[98:99], v12 offset:1024
v_cvt_pk_bf16_f32 v2, v2, v3
v_accvgpr_write_b32 a241, v2
v_mfma_f32_16x16x32_bf16 v[196:199], a[108:111], a[20:23], v[196:199]
ds_read_b64_tr_b16 a[100:101], v12 offset:8192
v_accvgpr_read_b32 v2, a244
v_mfma_f32_16x16x32_bf16 v[188:191], a[108:111], a[16:19], 0
ds_read_b64_tr_b16 a[102:103], v12 offset:9216
v_accvgpr_read_b32 v3, a245
v_mfma_f32_16x16x32_bf16 v[188:191], a[104:107], a[0:3], v[188:191]
s_add_u32 m0, s17, 0x10400
s_waitcnt lgkmcnt(4)
v_cvt_pk_bf16_f32 v2, v2, v3
v_accvgpr_write_b32 a242, v2
v_mfma_f32_16x16x32_bf16 v[216:219], a[0:3], a[80:83], 0
buffer_load_dwordx4 v5, s[52:55], s13 offen lds
v_mfma_f32_16x16x32_bf16 v[216:219], a[16:19], a[84:87], v[216:219]
ds_read_b64_tr_b16 a[104:105], v13 offset:0
v_accvgpr_read_b32 v2, a246
v_mfma_f32_16x16x32_bf16 v[224:227], a[20:23], a[84:87], 0
ds_read_b64_tr_b16 a[106:107], v13 offset:1024
v_accvgpr_read_b32 v3, a247
v_cvt_pk_bf16_f32 v2, v2, v3
v_mfma_f32_16x16x32_bf16 v[224:227], a[4:7], a[80:83], v[224:227]
ds_read_b64_tr_b16 a[108:109], v13 offset:8192
v_accvgpr_write_b32 a243, v2
v_mfma_f32_16x16x32_bf16 v[232:235], a[8:11], a[80:83], 0
ds_read_b64_tr_b16 a[110:111], v13 offset:9216
v_accvgpr_read_b32 v2, a248
v_mfma_f32_16x16x32_bf16 v[232:235], a[24:27], a[84:87], v[232:235]
v_accvgpr_read_b32 v3, a249
v_cvt_pk_bf16_f32 v2, v2, v3
v_accvgpr_write_b32 a248, v2
v_mfma_f32_16x16x32_bf16 v[240:243], a[28:31], a[84:87], 0
s_add_u32 m0, s17, 0x10800
v_accvgpr_read_b32 v2, a250
v_accvgpr_read_b32 v3, a251
v_mfma_f32_16x16x32_bf16 v[240:243], a[12:15], a[80:83], v[240:243]
buffer_load_dwordx4 v6, s[52:55], 0 offen lds
v_mfma_f32_16x16x32_bf16 v[244:247], a[12:15], a[88:91], 0
ds_read_b64_tr_b16 a[80:81], v12 offset:256
v_cvt_pk_bf16_f32 v2, v2, v3
v_accvgpr_write_b32 a249, v2
v_mfma_f32_16x16x32_bf16 v[244:247], a[28:31], a[92:95], v[244:247]
ds_read_b64_tr_b16 a[82:83], v12 offset:1280
v_accvgpr_read_b32 v2, a252
v_mfma_f32_16x16x32_bf16 v[236:239], a[24:27], a[92:95], 0
ds_read_b64_tr_b16 a[84:85], v12 offset:8448
v_accvgpr_read_b32 v3, a253
v_mfma_f32_16x16x32_bf16 v[236:239], a[8:11], a[88:91], v[236:239]
ds_read_b64_tr_b16 a[86:87], v12 offset:9472
v_cvt_pk_bf16_f32 v2, v2, v3
v_accvgpr_write_b32 a250, v2
v_mfma_f32_16x16x32_bf16 v[228:231], a[4:7], a[88:91], 0
v_accvgpr_read_b32 v2, a254
v_accvgpr_read_b32 v3, a255
v_mfma_f32_16x16x32_bf16 v[228:231], a[20:23], a[92:95], v[228:231]
s_add_u32 m0, s17, 0x10c00
v_cvt_pk_bf16_f32 v2, v2, v3
v_accvgpr_write_b32 a251, v2
v_mfma_f32_16x16x32_bf16 v[220:223], a[16:19], a[92:95], 0
buffer_load_dwordx4 v6, s[52:55], s13 offen lds
v_mfma_f32_16x16x32_bf16 v[220:223], a[0:3], a[88:91], v[220:223]
s_waitcnt lgkmcnt(4)
L_S9:
v_mfma_f32_16x16x32_bf16 v[24:27], a[96:99], a[32:35], v[24:27]
ds_read_b64_tr_b16 a[88:89], v13 offset:256
s_waitcnt vmcnt(23)
v_mfma_f32_16x16x32_bf16 v[24:27], a[100:103], a[48:51], v[24:27]
ds_read_b64_tr_b16 a[90:91], v13 offset:1280
v_mfma_f32_16x16x32_bf16 v[32:35], a[100:103], a[52:55], v[32:35]
ds_read_b64_tr_b16 a[92:93], v13 offset:8448
L_padA5:
s_cmp_eq_u32 s95, 1
s_cbranch_scc1 L_padA9
v_mfma_f32_16x16x32_bf16 v[32:35], a[96:99], a[36:39], v[32:35]
ds_read_b64_tr_b16 a[94:95], v13 offset:9472
v_mfma_f32_16x16x32_bf16 v[40:43], a[96:99], a[40:43], v[40:43]
ds_read_b128 a[0:3], v8 offset:0
s_add_u32 m0, s18, 0x14000
v_mfma_f32_16x16x32_bf16 v[40:43], a[100:103], a[56:59], v[40:43]
buffer_load_dwordx4 v7, s[68:71], 0 offen lds
v_mfma_f32_16x16x32_bf16 v[48:51], a[100:103], a[60:63], v[48:51]
ds_read_b128 a[16:19], v9 offset:0
v_mfma_f32_16x16x32_bf16 v[48:51], a[96:99], a[44:47], v[48:51]
ds_read_b128 a[4:7], v8 offset:2048
v_mfma_f32_16x16x32_bf16 v[52:55], a[104:107], a[44:47], v[52:55]
ds_read_b64_tr_b16 a[96:97], v12 offset:512
v_mfma_f32_16x16x32_bf16 v[52:55], a[108:111], a[60:63], v[52:55]
ds_read_b64_tr_b16 a[98:99], v12 offset:1536
v_mfma_f32_16x16x32_bf16 v[44:47], a[108:111], a[56:59], v[44:47]
ds_read_b64_tr_b16 a[100:101], v12 offset:8704
s_add_u32 s8, s28, 0x7000
v_mfma_f32_16x16x32_bf16 v[44:47], a[104:107], a[40:43], v[44:47]
buffer_store_dwordx4 a[140:143], v16, s[88:91], s8 offen sc1
v_mfma_f32_16x16x32_bf16 v[36:39], a[104:107], a[36:39], v[36:39]
ds_read_b64_tr_b16 a[102:103], v12 offset:9728
v_mfma_f32_16x16x32_bf16 v[36:39], a[108:111], a[52:55], v[36:39]
ds_read_b128 a[20:23], v9 offset:2048
v_mfma_f32_16x16x32_bf16 v[28:31], a[108:111], a[48:51], v[28:31]
ds_read_b128 a[8:11], v8 offset:4096
v_mfma_f32_16x16x32_bf16 v[28:31], a[104:107], a[32:35], v[28:31]
ds_read_b128 a[24:27], v9 offset:4096
s_waitcnt lgkmcnt(10)
v_mfma_f32_16x16x32_bf16 v[56:59], a[80:83], a[32:35], v[56:59]
ds_read_b64_tr_b16 a[104:105], v13 offset:512
v_mfma_f32_16x16x32_bf16 v[56:59], a[84:87], a[48:51], v[56:59]
ds_read_b64_tr_b16 a[106:107], v13 offset:1536
s_add_u32 m0, s18, 0x15000
v_mfma_f32_16x16x32_bf16 v[64:67], a[84:87], a[52:55], v[64:67]
buffer_load_dwordx4 v7, s[68:71], s25 offen lds
v_mfma_f32_16x16x32_bf16 v[64:67], a[80:83], a[36:39], v[64:67]
ds_read_b64_tr_b16 a[108:109], v13 offset:8704
v_mfma_f32_16x16x32_bf16 v[72:75], a[80:83], a[40:43], v[72:75]
ds_read_b64_tr_b16 a[110:111], v13 offset:9728
v_mfma_f32_16x16x32_bf16 v[72:75], a[84:87], a[56:59], v[72:75]
ds_read_b128 a[12:15], v8 offset:6144
v_mfma_f32_16x16x32_bf16 v[80:83], a[84:87], a[60:63], v[80:83]
ds_read_b128 a[28:31], v9 offset:6144
v_mfma_f32_16x16x32_bf16 v[80:83], a[80:83], a[44:47], v[80:83]
v_mfma_f32_16x16x32_bf16 v[84:87], a[88:91], a[44:47], v[84:87]
ds_read_b64_tr_b16 a[80:81], v12 offset:768
s_add_u32 m0, s18, 0x16000
v_mfma_f32_16x16x32_bf16 v[84:87], a[92:95], a[60:63], v[84:87]
buffer_load_dwordx4 v7, s[68:71], s26 offen lds
v_mfma_f32_16x16x32_bf16 v[76:79], a[92:95], a[56:59], v[76:79]
ds_read_b64_tr_b16 a[82:83], v12 offset:1792
v_lshl_add_u32 v5, s42, 19, v5
v_mfma_f32_16x16x32_bf16 v[76:79], a[88:91], a[40:43], v[76:79]
ds_read_b64_tr_b16 a[84:85], v12 offset:8960
v_lshl_add_u32 v6, s42, 19, v6
v_mfma_f32_16x16x32_bf16 v[68:71], a[88:91], a[36:39], v[68:71]
ds_read_b64_tr_b16 a[86:87], v12 offset:9984
v_lshl_add_u32 v7, s42, 18, v7
v_mfma_f32_16x16x32_bf16 v[68:71], a[92:95], a[52:55], v[68:71]
v_lshl_add_u32 v7, s42, 17, v7
v_mfma_f32_16x16x32_bf16 v[60:63], a[92:95], a[48:51], v[60:63]
v_mfma_f32_16x16x32_bf16 v[60:63], a[88:91], a[32:35], v[60:63]
s_add_u32 m0, s16, 0x0
s_waitcnt lgkmcnt(4)
s_waitcnt lgkmcnt(6)
v_mfma_f32_16x16x32_bf16 v[88:91], a[96:99], a[32:35], v[88:91]
buffer_load_dwordx4 v22, s[44:47], s20 offen lds
v_mfma_f32_16x16x32_bf16 v[88:91], a[100:103], a[48:51], v[88:91]
ds_read_b64_tr_b16 a[88:89], v13 offset:768
v_mfma_f32_16x16x32_bf16 v[96:99], a[100:103], a[52:55], v[96:99]
ds_read_b64_tr_b16 a[90:91], v13 offset:1792
v_mfma_f32_16x16x32_bf16 v[96:99], a[96:99], a[36:39], v[96:99]
ds_read_b64_tr_b16 a[92:93], v13 offset:8960
v_mfma_f32_16x16x32_bf16 v[104:107], a[96:99], a[40:43], v[104:107]
ds_read_b64_tr_b16 a[94:95], v13 offset:9984
s_add_u32 m0, s16, 0x400
v_mfma_f32_16x16x32_bf16 v[104:107], a[100:103], a[56:59], v[104:107]
buffer_load_dwordx4 v23, s[44:47], s20 offen lds
v_mfma_f32_16x16x32_bf16 v[112:115], a[100:103], a[60:63], v[112:115]
v_mfma_f32_16x16x32_bf16 v[112:115], a[96:99], a[44:47], v[112:115]
v_mfma_f32_16x16x32_bf16 v[116:119], a[104:107], a[44:47], v[116:119]
ds_read_b64_tr_b16 a[96:97], v14 offset:0
v_mfma_f32_16x16x32_bf16 v[116:119], a[108:111], a[60:63], v[116:119]
ds_read_b64_tr_b16 a[98:99], v14 offset:256
v_mfma_f32_16x16x32_bf16 v[108:111], a[108:111], a[56:59], v[108:111]
ds_read_b64_tr_b16 a[100:101], v14 offset:2048
s_add_u32 m0, s16, 0x800
v_mfma_f32_16x16x32_bf16 v[108:111], a[104:107], a[40:43], v[108:111]
buffer_load_dwordx4 v22, s[44:47], s21 offen lds
v_mfma_f32_16x16x32_bf16 v[100:103], a[104:107], a[36:39], v[100:103]
ds_read_b64_tr_b16 a[102:103], v14 offset:2304
v_mfma_f32_16x16x32_bf16 v[100:103], a[108:111], a[52:55], v[100:103]
v_mfma_f32_16x16x32_bf16 v[92:95], a[108:111], a[48:51], v[92:95]
v_mfma_f32_16x16x32_bf16 v[92:95], a[104:107], a[32:35], v[92:95]
s_add_u32 s8, s28, 0x2400
s_waitcnt lgkmcnt(4)
v_mfma_f32_16x16x32_bf16 v[120:123], a[80:83], a[32:35], v[120:123]
buffer_store_dwordx4 a[144:147], v16, s[88:91], s8 offen sc1
v_mfma_f32_16x16x32_bf16 v[120:123], a[84:87], a[48:51], v[120:123]
ds_read_b64_tr_b16 a[104:105], v15 offset:0
v_mfma_f32_16x16x32_bf16 v[128:131], a[84:87], a[52:55], v[128:131]
ds_read_b64_tr_b16 a[106:107], v15 offset:256
v_mfma_f32_16x16x32_bf16 v[128:131], a[80:83], a[36:39], v[128:131]
ds_read_b64_tr_b16 a[108:109], v15 offset:2048
v_mfma_f32_16x16x32_bf16 v[136:139], a[80:83], a[40:43], v[136:139]
ds_read_b64_tr_b16 a[110:111], v15 offset:2304
v_mfma_f32_16x16x32_bf16 v[136:139], a[84:87], a[56:59], v[136:139]
s_add_u32 m0, s16, 0xc00
v_mfma_f32_16x16x32_bf16 v[144:147], a[84:87], a[60:63], v[144:147]
buffer_load_dwordx4 v23, s[44:47], s21 offen lds
v_mfma_f32_16x16x32_bf16 v[144:147], a[80:83], a[44:47], v[144:147]
v_mfma_f32_16x16x32_bf16 v[148:151], a[88:91], a[44:47], v[148:151]
ds_read_b64_tr_b16 a[80:81], v14 offset:4096
v_mfma_f32_16x16x32_bf16 v[148:151], a[92:95], a[60:63], v[148:151]
ds_read_b64_tr_b16 a[82:83], v14 offset:4352
v_mfma_f32_16x16x32_bf16 v[140:143], a[92:95], a[56:59], v[140:143]
ds_read_b64_tr_b16 a[84:85], v14 offset:6144
v_mfma_f32_16x16x32_bf16 v[140:143], a[88:91], a[40:43], v[140:143]
ds_read_b64_tr_b16 a[86:87], v14 offset:6400
s_add_u32 m0, s16, 0x1000
v_mfma_f32_16x16x32_bf16 v[132:135], a[88:91], a[36:39], v[132:135]
buffer_load_dwordx4 v22, s[44:47], s22 offen lds
v_mfma_f32_16x16x32_bf16 v[132:135], a[92:95], a[52:55], v[132:135]
v_mfma_f32_16x16x32_bf16 v[124:127], a[92:95], a[48:51], v[124:127]
v_mfma_f32_16x16x32_bf16 v[124:127], a[88:91], a[32:35], v[124:127]
s_waitcnt lgkmcnt(4)
v_mfma_f32_16x16x32_bf16 v[152:155], a[96:99], a[32:35], v[152:155]
ds_read_b64_tr_b16 a[88:89], v15 offset:4096
s_add_u32 m0, s16, 0x1400
v_mfma_f32_16x16x32_bf16 v[152:155], a[100:103], a[48:51], v[152:155]
buffer_load_dwordx4 v23, s[44:47], s22 offen lds
v_mfma_f32_16x16x32_bf16 v[160:163], a[100:103], a[52:55], v[160:163]
ds_read_b64_tr_b16 a[90:91], v15 offset:4352
v_mfma_f32_16x16x32_bf16 v[160:163], a[96:99], a[36:39], v[160:163]
ds_read_b64_tr_b16 a[92:93], v15 offset:6144
v_mfma_f32_16x16x32_bf16 v[168:171], a[96:99], a[40:43], v[168:171]
ds_read_b64_tr_b16 a[94:95], v15 offset:6400
v_mfma_f32_16x16x32_bf16 v[168:171], a[100:103], a[56:59], v[168:171]
v_mfma_f32_16x16x32_bf16 v[176:179], a[100:103], a[60:63], v[176:179]
s_add_u32 m0, s16, 0x1800
v_mfma_f32_16x16x32_bf16 v[176:179], a[96:99], a[44:47], v[176:179]
buffer_load_dwordx4 v22, s[44:47], s23 offen lds
v_mfma_f32_16x16x32_bf16 v[180:183], a[104:107], a[44:47], v[180:183]
ds_read_b64_tr_b16 a[96:97], v14 offset:8192
v_mfma_f32_16x16x32_bf16 v[180:183], a[108:111], a[60:63], v[180:183]
ds_read_b64_tr_b16 a[98:99], v14 offset:8448
v_mfma_f32_16x16x32_bf16 v[172:175], a[108:111], a[56:59], v[172:175]
ds_read_b64_tr_b16 a[100:101], v14 offset:10240
v_mfma_f32_16x16x32_bf16 v[172:175], a[104:107], a[40:43], v[172:175]
ds_read_b64_tr_b16 a[102:103], v14 offset:10496
s_add_u32 m0, s16, 0x1c00
v_mfma_f32_16x16x32_bf16 v[164:167], a[104:107], a[36:39], v[164:167]
buffer_load_dwordx4 v23, s[44:47], s23 offen lds
v_mfma_f32_16x16x32_bf16 v[164:167], a[108:111], a[52:55], v[164:167]
v_lshl_add_u32 v22, s42, 7, v22
v_lshl_add_u32 v23, s42, 7, v23
v_mfma_f32_16x16x32_bf16 v[156:159], a[108:111], a[48:51], v[156:159]
v_mfma_f32_16x16x32_bf16 v[156:159], a[104:107], a[32:35], v[156:159]
s_waitcnt lgkmcnt(4)
v_mfma_f32_16x16x32_bf16 v[184:187], a[80:83], a[32:35], v[184:187]
ds_read_b64_tr_b16 a[104:105], v15 offset:8192
v_mfma_f32_16x16x32_bf16 v[184:187], a[84:87], a[48:51], v[184:187]
ds_read_b64_tr_b16 a[106:107], v15 offset:8448
s_add_u32 s8, s28, 0x3400
v_mfma_f32_16x16x32_bf16 v[192:195], a[84:87], a[52:55], v[192:195]
buffer_store_dwordx4 a[148:151], v16, s[88:91], s8 offen sc1
v_mfma_f32_16x16x32_bf16 v[192:195], a[80:83], a[36:39], v[192:195]
ds_read_b64_tr_b16 a[108:109], v15 offset:10240
v_mfma_f32_16x16x32_bf16 v[200:203], a[80:83], a[40:43], v[200:203]
ds_read_b64_tr_b16 a[110:111], v15 offset:10496
v_add_u32 v12, 0x8000, v12
v_mfma_f32_16x16x32_bf16 v[200:203], a[84:87], a[56:59], v[200:203]
v_add_u32 v13, 0x8000, v13
v_add_u32 v14, 0x8000, v14
v_mfma_f32_16x16x32_bf16 v[208:211], a[84:87], a[60:63], v[208:211]
v_add_u32 v15, 0x8000, v15
v_mfma_f32_16x16x32_bf16 v[208:211], a[80:83], a[44:47], v[208:211]
v_mfma_f32_16x16x32_bf16 v[212:215], a[88:91], a[44:47], v[212:215]
s_waitcnt vmcnt(28) lgkmcnt(0)
v_mfma_f32_16x16x32_bf16 v[212:215], a[92:95], a[60:63], v[212:215]
s_barrier
s_add_u32 m0, s17, 0x0
v_mfma_f32_16x16x32_bf16 v[204:207], a[92:95], a[56:59], v[204:207]
buffer_load_dwordx4 v5, s[52:55], 0 offen lds
v_mfma_f32_16x16x32_bf16 v[204:207], a[88:91], a[40:43], v[204:207]
ds_read_b64_tr_b16 a[80:81], v12 offset:0
v_mfma_f32_16x16x32_bf16 v[196:199], a[88:91], a[36:39], v[196:199]
ds_read_b64_tr_b16 a[82:83], v12 offset:1024
v_mfma_f32_16x16x32_bf16 v[196:199], a[92:95], a[52:55], v[196:199]
ds_read_b64_tr_b16 a[84:85], v12 offset:8192
v_mfma_f32_16x16x32_bf16 v[188:191], a[92:95], a[48:51], v[188:191]
ds_read_b64_tr_b16 a[86:87], v12 offset:9216
v_mfma_f32_16x16x32_bf16 v[188:191], a[88:91], a[32:35], v[188:191]
s_add_u32 m0, s17, 0x400
s_waitcnt lgkmcnt(4)
v_mfma_f32_16x16x32_bf16 v[216:219], a[32:35], a[96:99], v[216:219]
buffer_load_dwordx4 v5, s[52:55], s13 offen lds
v_mfma_f32_16x16x32_bf16 v[216:219], a[48:51], a[100:103], v[216:219]
ds_read_b64_tr_b16 a[88:89], v13 offset:0
v_mfma_f32_16x16x32_bf16 v[224:227], a[52:55], a[100:103], v[224:227]
ds_read_b64_tr_b16 a[90:91], v13 offset:1024
v_mfma_f32_16x16x32_bf16 v[224:227], a[36:39], a[96:99], v[224:227]
ds_read_b64_tr_b16 a[92:93], v13 offset:8192
v_mfma_f32_16x16x32_bf16 v[232:235], a[40:43], a[96:99], v[232:235]
ds_read_b64_tr_b16 a[94:95], v13 offset:9216
v_mfma_f32_16x16x32_bf16 v[232:235], a[56:59], a[100:103], v[232:235]
v_mfma_f32_16x16x32_bf16 v[240:243], a[60:63], a[100:103], v[240:243]
s_add_u32 m0, s17, 0x800
v_mfma_f32_16x16x32_bf16 v[240:243], a[44:47], a[96:99], v[240:243]
buffer_load_dwordx4 v6, s[52:55], 0 offen lds
v_mfma_f32_16x16x32_bf16 v[244:247], a[44:47], a[104:107], v[244:247]
ds_read_b64_tr_b16 a[96:97], v12 offset:256
v_mfma_f32_16x16x32_bf16 v[244:247], a[60:63], a[108:111], v[244:247]
ds_read_b64_tr_b16 a[98:99], v12 offset:1280
v_mfma_f32_16x16x32_bf16 v[236:239], a[56:59], a[108:111], v[236:239]
ds_read_b64_tr_b16 a[100:101], v12 offset:8448
v_mfma_f32_16x16x32_bf16 v[236:239], a[40:43], a[104:107], v[236:239]
ds_read_b64_tr_b16 a[102:103], v12 offset:9472
v_mfma_f32_16x16x32_bf16 v[228:231], a[36:39], a[104:107], v[228:231]
v_mfma_f32_16x16x32_bf16 v[228:231], a[52:55], a[108:111], v[228:231]
s_add_u32 m0, s17, 0xc00
v_mfma_f32_16x16x32_bf16 v[220:223], a[48:51], a[108:111], v[220:223]
buffer_load_dwordx4 v6, s[52:55], s13 offen lds
v_mfma_f32_16x16x32_bf16 v[220:223], a[32:35], a[104:107], v[220:223]
s_waitcnt lgkmcnt(4)
L_S10:
v_mfma_f32_16x16x32_bf16 v[24:27], a[80:83], a[0:3], v[24:27]
ds_read_b64_tr_b16 a[104:105], v13 offset:256
s_waitcnt vmcnt(23)
v_mfma_f32_16x16x32_bf16 v[24:27], a[84:87], a[16:19], v[24:27]
ds_read_b64_tr_b16 a[106:107], v13 offset:1280
v_mfma_f32_16x16x32_bf16 v[32:35], a[84:87], a[20:23], v[32:35]
ds_read_b64_tr_b16 a[108:109], v13 offset:8448
v_mfma_f32_16x16x32_bf16 v[32:35], a[80:83], a[4:7], v[32:35]
ds_read_b64_tr_b16 a[110:111], v13 offset:9472
v_mfma_f32_16x16x32_bf16 v[40:43], a[80:83], a[8:11], v[40:43]
ds_read_b128 a[32:35], v8 offset:32768
s_add_u32 m0, s18, 0x4000
v_mfma_f32_16x16x32_bf16 v[40:43], a[84:87], a[24:27], v[40:43]
buffer_load_dwordx4 v7, s[68:71], 0 offen lds
v_mfma_f32_16x16x32_bf16 v[48:51], a[84:87], a[28:31], v[48:51]
ds_read_b128 a[48:51], v9 offset:32768
v_mfma_f32_16x16x32_bf16 v[48:51], a[80:83], a[12:15], v[48:51]
ds_read_b128 a[36:39], v8 offset:34816
v_mfma_f32_16x16x32_bf16 v[52:55], a[88:91], a[12:15], v[52:55]
ds_read_b64_tr_b16 a[80:81], v12 offset:512
v_mfma_f32_16x16x32_bf16 v[52:55], a[92:95], a[28:31], v[52:55]
ds_read_b64_tr_b16 a[82:83], v12 offset:1536
v_mfma_f32_16x16x32_bf16 v[44:47], a[92:95], a[24:27], v[44:47]
ds_read_b64_tr_b16 a[84:85], v12 offset:8704
s_add_u32 s8, s28, 0x6400
v_mfma_f32_16x16x32_bf16 v[44:47], a[88:91], a[8:11], v[44:47]
buffer_store_dwordx4 a[152:155], v16, s[88:91], s8 offen sc1
v_mfma_f32_16x16x32_bf16 v[36:39], a[88:91], a[4:7], v[36:39]
ds_read_b64_tr_b16 a[86:87], v12 offset:9728
v_mfma_f32_16x16x32_bf16 v[36:39], a[92:95], a[20:23], v[36:39]
ds_read_b128 a[52:55], v9 offset:34816
v_mfma_f32_16x16x32_bf16 v[28:31], a[92:95], a[16:19], v[28:31]
ds_read_b128 a[40:43], v8 offset:36864
v_mfma_f32_16x16x32_bf16 v[28:31], a[88:91], a[0:3], v[28:31]
ds_read_b128 a[56:59], v9 offset:36864
s_waitcnt lgkmcnt(10)
v_mfma_f32_16x16x32_bf16 v[56:59], a[96:99], a[0:3], v[56:59]
ds_read_b64_tr_b16 a[88:89], v13 offset:512
v_mfma_f32_16x16x32_bf16 v[56:59], a[100:103], a[16:19], v[56:59]
ds_read_b64_tr_b16 a[90:91], v13 offset:1536
s_add_u32 m0, s18, 0x5000
v_mfma_f32_16x16x32_bf16 v[64:67], a[100:103], a[20:23], v[64:67]
buffer_load_dwordx4 v7, s[68:71], s25 offen lds
v_mfma_f32_16x16x32_bf16 v[64:67], a[96:99], a[4:7], v[64:67]
ds_read_b64_tr_b16 a[92:93], v13 offset:8704
v_mfma_f32_16x16x32_bf16 v[72:75], a[96:99], a[8:11], v[72:75]
ds_read_b64_tr_b16 a[94:95], v13 offset:9728
v_mfma_f32_16x16x32_bf16 v[72:75], a[100:103], a[24:27], v[72:75]
ds_read_b128 a[44:47], v8 offset:38912
v_mfma_f32_16x16x32_bf16 v[80:83], a[100:103], a[28:31], v[80:83]
ds_read_b128 a[60:63], v9 offset:38912
v_mfma_f32_16x16x32_bf16 v[80:83], a[96:99], a[12:15], v[80:83]
v_mfma_f32_16x16x32_bf16 v[84:87], a[104:107], a[12:15], v[84:87]
ds_read_b64_tr_b16 a[96:97], v12 offset:768
s_add_u32 m0, s18, 0x6000
v_mfma_f32_16x16x32_bf16 v[84:87], a[108:111], a[28:31], v[84:87]
buffer_load_dwordx4 v7, s[68:71], s26 offen lds
v_mfma_f32_16x16x32_bf16 v[76:79], a[108:111], a[24:27], v[76:79]
ds_read_b64_tr_b16 a[98:99], v12 offset:1792
v_lshl_add_u32 v5, s42, 19, v5
v_mfma_f32_16x16x32_bf16 v[76:79], a[104:107], a[8:11], v[76:79]
ds_read_b64_tr_b16 a[100:101], v12 offset:8960
v_lshl_add_u32 v6, s42, 19, v6
v_mfma_f32_16x16x32_bf16 v[68:71], a[104:107], a[4:7], v[68:71]
ds_read_b64_tr_b16 a[102:103], v12 offset:9984
v_lshl_add_u32 v7, s42, 18, v7
v_mfma_f32_16x16x32_bf16 v[68:71], a[108:111], a[20:23], v[68:71]
v_lshl_add_u32 v7, s42, 17, v7
v_mfma_f32_16x16x32_bf16 v[60:63], a[108:111], a[16:19], v[60:63]
v_mfma_f32_16x16x32_bf16 v[60:63], a[104:107], a[0:3], v[60:63]
s_add_u32 m0, s16, 0x8000
s_waitcnt lgkmcnt(4)
s_waitcnt lgkmcnt(6)
v_mfma_f32_16x16x32_bf16 v[88:91], a[80:83], a[0:3], v[88:91]
buffer_load_dwordx4 v22, s[44:47], s20 offen lds
v_mfma_f32_16x16x32_bf16 v[88:91], a[84:87], a[16:19], v[88:91]
ds_read_b64_tr_b16 a[104:105], v13 offset:768
v_mfma_f32_16x16x32_bf16 v[96:99], a[84:87], a[20:23], v[96:99]
ds_read_b64_tr_b16 a[106:107], v13 offset:1792
v_mfma_f32_16x16x32_bf16 v[96:99], a[80:83], a[4:7], v[96:99]
ds_read_b64_tr_b16 a[108:109], v13 offset:8960
v_mfma_f32_16x16x32_bf16 v[104:107], a[80:83], a[8:11], v[104:107]
ds_read_b64_tr_b16 a[110:111], v13 offset:9984
s_add_u32 m0, s16, 0x8400
v_mfma_f32_16x16x32_bf16 v[104:107], a[84:87], a[24:27], v[104:107]
buffer_load_dwordx4 v23, s[44:47], s20 offen lds
v_mfma_f32_16x16x32_bf16 v[112:115], a[84:87], a[28:31], v[112:115]
v_mfma_f32_16x16x32_bf16 v[112:115], a[80:83], a[12:15], v[112:115]
v_mfma_f32_16x16x32_bf16 v[116:119], a[88:91], a[12:15], v[116:119]
ds_read_b64_tr_b16 a[80:81], v14 offset:0
v_mfma_f32_16x16x32_bf16 v[116:119], a[92:95], a[28:31], v[116:119]
ds_read_b64_tr_b16 a[82:83], v14 offset:256
v_mfma_f32_16x16x32_bf16 v[108:111], a[92:95], a[24:27], v[108:111]
ds_read_b64_tr_b16 a[84:85], v14 offset:2048
s_add_u32 m0, s16, 0x8800
v_mfma_f32_16x16x32_bf16 v[108:111], a[88:91], a[8:11], v[108:111]
buffer_load_dwordx4 v22, s[44:47], s21 offen lds
v_mfma_f32_16x16x32_bf16 v[100:103], a[88:91], a[4:7], v[100:103]
ds_read_b64_tr_b16 a[86:87], v14 offset:2304
v_mfma_f32_16x16x32_bf16 v[100:103], a[92:95], a[20:23], v[100:103]
v_mfma_f32_16x16x32_bf16 v[92:95], a[92:95], a[16:19], v[92:95]
v_mfma_f32_16x16x32_bf16 v[92:95], a[88:91], a[0:3], v[92:95]
s_add_u32 s8, s28, 0x7400
s_waitcnt lgkmcnt(4)
v_mfma_f32_16x16x32_bf16 v[120:123], a[96:99], a[0:3], v[120:123]
buffer_store_dwordx4 a[156:159], v16, s[88:91], s8 offen sc1
v_mfma_f32_16x16x32_bf16 v[120:123], a[100:103], a[16:19], v[120:123]
ds_read_b64_tr_b16 a[88:89], v15 offset:0
v_mfma_f32_16x16x32_bf16 v[128:131], a[100:103], a[20:23], v[128:131]
ds_read_b64_tr_b16 a[90:91], v15 offset:256
v_mfma_f32_16x16x32_bf16 v[128:131], a[96:99], a[4:7], v[128:131]
ds_read_b64_tr_b16 a[92:93], v15 offset:2048
v_mfma_f32_16x16x32_bf16 v[136:139], a[96:99], a[8:11], v[136:139]
ds_read_b64_tr_b16 a[94:95], v15 offset:2304
v_mfma_f32_16x16x32_bf16 v[136:139], a[100:103], a[24:27], v[136:139]
s_add_u32 m0, s16, 0x8c00
v_mfma_f32_16x16x32_bf16 v[144:147], a[100:103], a[28:31], v[144:147]
buffer_load_dwordx4 v23, s[44:47], s21 offen lds
v_mfma_f32_16x16x32_bf16 v[144:147], a[96:99], a[12:15], v[144:147]
v_mfma_f32_16x16x32_bf16 v[148:151], a[104:107], a[12:15], v[148:151]
ds_read_b64_tr_b16 a[96:97], v14 offset:4096
v_mfma_f32_16x16x32_bf16 v[148:151], a[108:111], a[28:31], v[148:151]
ds_read_b64_tr_b16 a[98:99], v14 offset:4352
v_mfma_f32_16x16x32_bf16 v[140:143], a[108:111], a[24:27], v[140:143]
ds_read_b64_tr_b16 a[100:101], v14 offset:6144
v_mfma_f32_16x16x32_bf16 v[140:143], a[104:107], a[8:11], v[140:143]
ds_read_b64_tr_b16 a[102:103], v14 offset:6400
s_add_u32 m0, s16, 0x9000
v_mfma_f32_16x16x32_bf16 v[132:135], a[104:107], a[4:7], v[132:135]
buffer_load_dwordx4 v22, s[44:47], s22 offen lds
v_mfma_f32_16x16x32_bf16 v[132:135], a[108:111], a[20:23], v[132:135]
v_mfma_f32_16x16x32_bf16 v[124:127], a[108:111], a[16:19], v[124:127]
v_mfma_f32_16x16x32_bf16 v[124:127], a[104:107], a[0:3], v[124:127]
s_waitcnt lgkmcnt(4)
v_mfma_f32_16x16x32_bf16 v[152:155], a[80:83], a[0:3], v[152:155]
ds_read_b64_tr_b16 a[104:105], v15 offset:4096
s_add_u32 m0, s16, 0x9400
v_mfma_f32_16x16x32_bf16 v[152:155], a[84:87], a[16:19], v[152:155]
buffer_load_dwordx4 v23, s[44:47], s22 offen lds
v_mfma_f32_16x16x32_bf16 v[160:163], a[84:87], a[20:23], v[160:163]
ds_read_b64_tr_b16 a[106:107], v15 offset:4352
v_mfma_f32_16x16x32_bf16 v[160:163], a[80:83], a[4:7], v[160:163]
ds_read_b64_tr_b16 a[108:109], v15 offset:6144
v_mfma_f32_16x16x32_bf16 v[168:171], a[80:83], a[8:11], v[168:171]
ds_read_b64_tr_b16 a[110:111], v15 offset:6400
v_mfma_f32_16x16x32_bf16 v[168:171], a[84:87], a[24:27], v[168:171]
v_mfma_f32_16x16x32_bf16 v[176:179], a[84:87], a[28:31], v[176:179]
s_add_u32 m0, s16, 0x9800
v_mfma_f32_16x16x32_bf16 v[176:179], a[80:83], a[12:15], v[176:179]
buffer_load_dwordx4 v22, s[44:47], s23 offen lds
v_mfma_f32_16x16x32_bf16 v[180:183], a[88:91], a[12:15], v[180:183]
ds_read_b64_tr_b16 a[80:81], v14 offset:8192
v_mfma_f32_16x16x32_bf16 v[180:183], a[92:95], a[28:31], v[180:183]
ds_read_b64_tr_b16 a[82:83], v14 offset:8448
v_mfma_f32_16x16x32_bf16 v[172:175], a[92:95], a[24:27], v[172:175]
ds_read_b64_tr_b16 a[84:85], v14 offset:10240
v_mfma_f32_16x16x32_bf16 v[172:175], a[88:91], a[8:11], v[172:175]
ds_read_b64_tr_b16 a[86:87], v14 offset:10496
s_add_u32 m0, s16, 0x9c00
v_mfma_f32_16x16x32_bf16 v[164:167], a[88:91], a[4:7], v[164:167]
buffer_load_dwordx4 v23, s[44:47], s23 offen lds
v_mfma_f32_16x16x32_bf16 v[164:167], a[92:95], a[20:23], v[164:167]
v_lshl_add_u32 v22, s42, 7, v22
v_lshl_add_u32 v23, s42, 7, v23
v_mfma_f32_16x16x32_bf16 v[156:159], a[92:95], a[16:19], v[156:159]
v_mfma_f32_16x16x32_bf16 v[156:159], a[88:91], a[0:3], v[156:159]
s_waitcnt lgkmcnt(4)
v_mfma_f32_16x16x32_bf16 v[184:187], a[96:99], a[0:3], v[184:187]
ds_read_b64_tr_b16 a[88:89], v15 offset:8192
v_mfma_f32_16x16x32_bf16 v[184:187], a[100:103], a[16:19], v[184:187]
ds_read_b64_tr_b16 a[90:91], v15 offset:8448
s_add_u32 s8, s28, 0x2800
v_mfma_f32_16x16x32_bf16 v[192:195], a[100:103], a[20:23], v[192:195]
buffer_store_dwordx4 a[160:163], v16, s[88:91], s8 offen sc1
v_mfma_f32_16x16x32_bf16 v[192:195], a[96:99], a[4:7], v[192:195]
ds_read_b64_tr_b16 a[92:93], v15 offset:10240
v_mfma_f32_16x16x32_bf16 v[200:203], a[96:99], a[8:11], v[200:203]
ds_read_b64_tr_b16 a[94:95], v15 offset:10496
v_add_u32 v12, 0x8000, v12
v_mfma_f32_16x16x32_bf16 v[200:203], a[100:103], a[24:27], v[200:203]
v_add_u32 v13, 0x8000, v13
v_add_u32 v14, 0x8000, v14
v_mfma_f32_16x16x32_bf16 v[208:211], a[100:103], a[28:31], v[208:211]
v_add_u32 v15, 0x8000, v15
v_mfma_f32_16x16x32_bf16 v[208:211], a[96:99], a[12:15], v[208:211]
v_mfma_f32_16x16x32_bf16 v[212:215], a[104:107], a[12:15], v[212:215]
s_waitcnt vmcnt(28) lgkmcnt(0)
v_mfma_f32_16x16x32_bf16 v[212:215], a[108:111], a[28:31], v[212:215]
s_barrier
s_add_u32 m0, s17, 0x8000
v_mfma_f32_16x16x32_bf16 v[204:207], a[108:111], a[24:27], v[204:207]
buffer_load_dwordx4 v5, s[52:55], 0 offen lds
v_mfma_f32_16x16x32_bf16 v[204:207], a[104:107], a[8:11], v[204:207]
ds_read_b64_tr_b16 a[96:97], v12 offset:0
v_mfma_f32_16x16x32_bf16 v[196:199], a[104:107], a[4:7], v[196:199]
ds_read_b64_tr_b16 a[98:99], v12 offset:1024
v_mfma_f32_16x16x32_bf16 v[196:199], a[108:111], a[20:23], v[196:199]
ds_read_b64_tr_b16 a[100:101], v12 offset:8192
v_mfma_f32_16x16x32_bf16 v[188:191], a[108:111], a[16:19], v[188:191]
ds_read_b64_tr_b16 a[102:103], v12 offset:9216
v_mfma_f32_16x16x32_bf16 v[188:191], a[104:107], a[0:3], v[188:191]
s_add_u32 m0, s17, 0x8400
s_waitcnt lgkmcnt(4)
v_mfma_f32_16x16x32_bf16 v[216:219], a[0:3], a[80:83], v[216:219]
buffer_load_dwordx4 v5, s[52:55], s13 offen lds
v_mfma_f32_16x16x32_bf16 v[216:219], a[16:19], a[84:87], v[216:219]
ds_read_b64_tr_b16 a[104:105], v13 offset:0
v_mfma_f32_16x16x32_bf16 v[224:227], a[20:23], a[84:87], v[224:227]
ds_read_b64_tr_b16 a[106:107], v13 offset:1024
v_mfma_f32_16x16x32_bf16 v[224:227], a[4:7], a[80:83], v[224:227]
ds_read_b64_tr_b16 a[108:109], v13 offset:8192
v_mfma_f32_16x16x32_bf16 v[232:235], a[8:11], a[80:83], v[232:235]
ds_read_b64_tr_b16 a[110:111], v13 offset:9216
v_mfma_f32_16x16x32_bf16 v[232:235], a[24:27], a[84:87], v[232:235]
v_mfma_f32_16x16x32_bf16 v[240:243], a[28:31], a[84:87], v[240:243]
s_add_u32 m0, s17, 0x8800
v_mfma_f32_16x16x32_bf16 v[240:243], a[12:15], a[80:83], v[240:243]
buffer_load_dwordx4 v6, s[52:55], 0 offen lds
v_mfma_f32_16x16x32_bf16 v[244:247], a[12:15], a[88:91], v[244:247]
ds_read_b64_tr_b16 a[80:81], v12 offset:256
v_mfma_f32_16x16x32_bf16 v[244:247], a[28:31], a[92:95], v[244:247]
ds_read_b64_tr_b16 a[82:83], v12 offset:1280
v_mfma_f32_16x16x32_bf16 v[236:239], a[24:27], a[92:95], v[236:239]
ds_read_b64_tr_b16 a[84:85], v12 offset:8448
v_mfma_f32_16x16x32_bf16 v[236:239], a[8:11], a[88:91], v[236:239]
ds_read_b64_tr_b16 a[86:87], v12 offset:9472
v_mfma_f32_16x16x32_bf16 v[228:231], a[4:7], a[88:91], v[228:231]
v_mfma_f32_16x16x32_bf16 v[228:231], a[20:23], a[92:95], v[228:231]
s_add_u32 m0, s17, 0x8c00
v_mfma_f32_16x16x32_bf16 v[220:223], a[16:19], a[92:95], v[220:223]
buffer_load_dwordx4 v6, s[52:55], s13 offen lds
v_mfma_f32_16x16x32_bf16 v[220:223], a[0:3], a[88:91], v[220:223]
s_waitcnt lgkmcnt(4)
L_S11:
v_mfma_f32_16x16x32_bf16 v[24:27], a[96:99], a[32:35], v[24:27]
ds_read_b64_tr_b16 a[88:89], v13 offset:256
s_waitcnt vmcnt(23)
v_mfma_f32_16x16x32_bf16 v[24:27], a[100:103], a[48:51], v[24:27]
ds_read_b64_tr_b16 a[90:91], v13 offset:1280
v_mfma_f32_16x16x32_bf16 v[32:35], a[100:103], a[52:55], v[32:35]
ds_read_b64_tr_b16 a[92:93], v13 offset:8448
v_mfma_f32_16x16x32_bf16 v[32:35], a[96:99], a[36:39], v[32:35]
ds_read_b64_tr_b16 a[94:95], v13 offset:9472
v_mfma_f32_16x16x32_bf16 v[40:43], a[96:99], a[40:43], v[40:43]
ds_read_b128 a[0:3], v8 offset:0
s_add_u32 m0, s18, 0xc000
v_mfma_f32_16x16x32_bf16 v[40:43], a[100:103], a[56:59], v[40:43]
buffer_load_dwordx4 v7, s[68:71], 0 offen lds
v_mfma_f32_16x16x32_bf16 v[48:51], a[100:103], a[60:63], v[48:51]
ds_read_b128 a[16:19], v9 offset:0
v_mfma_f32_16x16x32_bf16 v[48:51], a[96:99], a[44:47], v[48:51]
ds_read_b128 a[4:7], v8 offset:2048
v_mfma_f32_16x16x32_bf16 v[52:55], a[104:107], a[44:47], v[52:55]
ds_read_b64_tr_b16 a[96:97], v12 offset:512
v_mfma_f32_16x16x32_bf16 v[52:55], a[108:111], a[60:63], v[52:55]
ds_read_b64_tr_b16 a[98:99], v12 offset:1536
v_mfma_f32_16x16x32_bf16 v[44:47], a[108:111], a[56:59], v[44:47]
ds_read_b64_tr_b16 a[100:101], v12 offset:8704
s_add_u32 s8, s28, 0x3800
v_mfma_f32_16x16x32_bf16 v[44:47], a[104:107], a[40:43], v[44:47]
buffer_store_dwordx4 a[164:167], v16, s[88:91], s8 offen sc1
v_mfma_f32_16x16x32_bf16 v[36:39], a[104:107], a[36:39], v[36:39]
ds_read_b64_tr_b16 a[102:103], v12 offset:9728
v_mfma_f32_16x16x32_bf16 v[36:39], a[108:111], a[52:55], v[36:39]
ds_read_b128 a[20:23], v9 offset:2048
v_mfma_f32_16x16x32_bf16 v[28:31], a[108:111], a[48:51], v[28:31]
ds_read_b128 a[8:11], v8 offset:4096
v_mfma_f32_16x16x32_bf16 v[28:31], a[104:107], a[32:35], v[28:31]
ds_read_b128 a[24:27], v9 offset:4096
s_waitcnt lgkmcnt(10)
v_mfma_f32_16x16x32_bf16 v[56:59], a[80:83], a[32:35], v[56:59]
ds_read_b64_tr_b16 a[104:105], v13 offset:512
v_mfma_f32_16x16x32_bf16 v[56:59], a[84:87], a[48:51], v[56:59]
ds_read_b64_tr_b16 a[106:107], v13 offset:1536
s_add_u32 m0, s18, 0xd000
v_mfma_f32_16x16x32_bf16 v[64:67], a[84:87], a[52:55], v[64:67]
buffer_load_dwordx4 v7, s[68:71], s25 offen lds
v_mfma_f32_16x16x32_bf16 v[64:67], a[80:83], a[36:39], v[64:67]
ds_read_b64_tr_b16 a[108:109], v13 offset:8704
v_mfma_f32_16x16x32_bf16 v[72:75], a[80:83], a[40:43], v[72:75]
ds_read_b64_tr_b16 a[110:111], v13 offset:9728
v_mfma_f32_16x16x32_bf16 v[72:75], a[84:87], a[56:59], v[72:75]
ds_read_b128 a[12:15], v8 offset:6144
v_mfma_f32_16x16x32_bf16 v[80:83], a[84:87], a[60:63], v[80:83]
ds_read_b128 a[28:31], v9 offset:6144
v_mfma_f32_16x16x32_bf16 v[80:83], a[80:83], a[44:47], v[80:83]
v_mfma_f32_16x16x32_bf16 v[84:87], a[88:91], a[44:47], v[84:87]
ds_read_b64_tr_b16 a[80:81], v12 offset:768
s_add_u32 m0, s18, 0xe000
v_mfma_f32_16x16x32_bf16 v[84:87], a[92:95], a[60:63], v[84:87]
buffer_load_dwordx4 v7, s[68:71], s26 offen lds
v_mfma_f32_16x16x32_bf16 v[76:79], a[92:95], a[56:59], v[76:79]
ds_read_b64_tr_b16 a[82:83], v12 offset:1792
v_lshl_add_u32 v5, s42, 19, v5
v_mfma_f32_16x16x32_bf16 v[76:79], a[88:91], a[40:43], v[76:79]
ds_read_b64_tr_b16 a[84:85], v12 offset:8960
v_lshl_add_u32 v6, s42, 19, v6
v_mfma_f32_16x16x32_bf16 v[68:71], a[88:91], a[36:39], v[68:71]
ds_read_b64_tr_b16 a[86:87], v12 offset:9984
v_lshl_add_u32 v7, s42, 18, v7
v_mfma_f32_16x16x32_bf16 v[68:71], a[92:95], a[52:55], v[68:71]
L_padA6:
s_cmp_eq_u32 s95, 1
s_cbranch_scc1 L_padA10
v_lshl_add_u32 v7, s42, 17, v7
v_mfma_f32_16x16x32_bf16 v[60:63], a[92:95], a[48:51], v[60:63]
v_mfma_f32_16x16x32_bf16 v[60:63], a[88:91], a[32:35], v[60:63]
s_add_u32 m0, s16, 0x0
s_waitcnt lgkmcnt(4)
s_waitcnt lgkmcnt(6)
v_mfma_f32_16x16x32_bf16 v[88:91], a[96:99], a[32:35], v[88:91]
buffer_load_dwordx4 v22, s[44:47], s20 offen lds
v_mfma_f32_16x16x32_bf16 v[88:91], a[100:103], a[48:51], v[88:91]
ds_read_b64_tr_b16 a[88:89], v13 offset:768
v_mfma_f32_16x16x32_bf16 v[96:99], a[100:103], a[52:55], v[96:99]
ds_read_b64_tr_b16 a[90:91], v13 offset:1792
v_mfma_f32_16x16x32_bf16 v[96:99], a[96:99], a[36:39], v[96:99]
ds_read_b64_tr_b16 a[92:93], v13 offset:8960
v_mfma_f32_16x16x32_bf16 v[104:107], a[96:99], a[40:43], v[104:107]
ds_read_b64_tr_b16 a[94:95], v13 offset:9984
s_add_u32 m0, s16, 0x400
v_mfma_f32_16x16x32_bf16 v[104:107], a[100:103], a[56:59], v[104:107]
buffer_load_dwordx4 v23, s[44:47], s20 offen lds
v_mfma_f32_16x16x32_bf16 v[112:115], a[100:103], a[60:63], v[112:115]
v_mfma_f32_16x16x32_bf16 v[112:115], a[96:99], a[44:47], v[112:115]
v_mfma_f32_16x16x32_bf16 v[116:119], a[104:107], a[44:47], v[116:119]
ds_read_b64_tr_b16 a[96:97], v14 offset:0
v_mfma_f32_16x16x32_bf16 v[116:119], a[108:111], a[60:63], v[116:119]
ds_read_b64_tr_b16 a[98:99], v14 offset:256
v_mfma_f32_16x16x32_bf16 v[108:111], a[108:111], a[56:59], v[108:111]
ds_read_b64_tr_b16 a[100:101], v14 offset:2048
s_add_u32 m0, s16, 0x800
v_mfma_f32_16x16x32_bf16 v[108:111], a[104:107], a[40:43], v[108:111]
buffer_load_dwordx4 v22, s[44:47], s21 offen lds
v_mfma_f32_16x16x32_bf16 v[100:103], a[104:107], a[36:39], v[100:103]
ds_read_b64_tr_b16 a[102:103], v14 offset:2304
v_mfma_f32_16x16x32_bf16 v[100:103], a[108:111], a[52:55], v[100:103]
v_mfma_f32_16x16x32_bf16 v[92:95], a[108:111], a[48:51], v[92:95]
v_mfma_f32_16x16x32_bf16 v[92:95], a[104:107], a[32:35], v[92:95]
s_add_u32 s8, s28, 0x6800
s_waitcnt lgkmcnt(4)
v_mfma_f32_16x16x32_bf16 v[120:123], a[80:83], a[32:35], v[120:123]
buffer_store_dwordx4 a[168:171], v16, s[88:91], s8 offen sc1
v_mfma_f32_16x16x32_bf16 v[120:123], a[84:87], a[48:51], v[120:123]
ds_read_b64_tr_b16 a[104:105], v15 offset:0
v_mfma_f32_16x16x32_bf16 v[128:131], a[84:87], a[52:55], v[128:131]
ds_read_b64_tr_b16 a[106:107], v15 offset:256
v_mfma_f32_16x16x32_bf16 v[128:131], a[80:83], a[36:39], v[128:131]
ds_read_b64_tr_b16 a[108:109], v15 offset:2048
v_mfma_f32_16x16x32_bf16 v[136:139], a[80:83], a[40:43], v[136:139]
ds_read_b64_tr_b16 a[110:111], v15 offset:2304
v_mfma_f32_16x16x32_bf16 v[136:139], a[84:87], a[56:59], v[136:139]
s_add_u32 m0, s16, 0xc00
v_mfma_f32_16x16x32_bf16 v[144:147], a[84:87], a[60:63], v[144:147]
buffer_load_dwordx4 v23, s[44:47], s21 offen lds
v_mfma_f32_16x16x32_bf16 v[144:147], a[80:83], a[44:47], v[144:147]
v_mfma_f32_16x16x32_bf16 v[148:151], a[88:91], a[44:47], v[148:151]
ds_read_b64_tr_b16 a[80:81], v14 offset:4096
v_mfma_f32_16x16x32_bf16 v[148:151], a[92:95], a[60:63], v[148:151]
ds_read_b64_tr_b16 a[82:83], v14 offset:4352
v_mfma_f32_16x16x32_bf16 v[140:143], a[92:95], a[56:59], v[140:143]
ds_read_b64_tr_b16 a[84:85], v14 offset:6144
v_mfma_f32_16x16x32_bf16 v[140:143], a[88:91], a[40:43], v[140:143]
ds_read_b64_tr_b16 a[86:87], v14 offset:6400
s_add_u32 m0, s16, 0x1000
v_mfma_f32_16x16x32_bf16 v[132:135], a[88:91], a[36:39], v[132:135]
buffer_load_dwordx4 v22, s[44:47], s22 offen lds
v_mfma_f32_16x16x32_bf16 v[132:135], a[92:95], a[52:55], v[132:135]
v_mfma_f32_16x16x32_bf16 v[124:127], a[92:95], a[48:51], v[124:127]
v_mfma_f32_16x16x32_bf16 v[124:127], a[88:91], a[32:35], v[124:127]
s_waitcnt lgkmcnt(4)
v_mfma_f32_16x16x32_bf16 v[152:155], a[96:99], a[32:35], v[152:155]
ds_read_b64_tr_b16 a[88:89], v15 offset:4096
s_add_u32 m0, s16, 0x1400
v_mfma_f32_16x16x32_bf16 v[152:155], a[100:103], a[48:51], v[152:155]
buffer_load_dwordx4 v23, s[44:47], s22 offen lds
v_mfma_f32_16x16x32_bf16 v[160:163], a[100:103], a[52:55], v[160:163]
ds_read_b64_tr_b16 a[90:91], v15 offset:4352
v_mfma_f32_16x16x32_bf16 v[160:163], a[96:99], a[36:39], v[160:163]
ds_read_b64_tr_b16 a[92:93], v15 offset:6144
v_mfma_f32_16x16x32_bf16 v[168:171], a[96:99], a[40:43], v[168:171]
ds_read_b64_tr_b16 a[94:95], v15 offset:6400
v_mfma_f32_16x16x32_bf16 v[168:171], a[100:103], a[56:59], v[168:171]
v_mfma_f32_16x16x32_bf16 v[176:179], a[100:103], a[60:63], v[176:179]
s_add_u32 m0, s16, 0x1800
v_mfma_f32_16x16x32_bf16 v[176:179], a[96:99], a[44:47], v[176:179]
buffer_load_dwordx4 v22, s[44:47], s23 offen lds
v_mfma_f32_16x16x32_bf16 v[180:183], a[104:107], a[44:47], v[180:183]
ds_read_b64_tr_b16 a[96:97], v14 offset:8192
v_mfma_f32_16x16x32_bf16 v[180:183], a[108:111], a[60:63], v[180:183]
ds_read_b64_tr_b16 a[98:99], v14 offset:8448
v_mfma_f32_16x16x32_bf16 v[172:175], a[108:111], a[56:59], v[172:175]
ds_read_b64_tr_b16 a[100:101], v14 offset:10240
v_mfma_f32_16x16x32_bf16 v[172:175], a[104:107], a[40:43], v[172:175]
ds_read_b64_tr_b16 a[102:103], v14 offset:10496
s_add_u32 m0, s16, 0x1c00
v_mfma_f32_16x16x32_bf16 v[164:167], a[104:107], a[36:39], v[164:167]
buffer_load_dwordx4 v23, s[44:47], s23 offen lds
v_mfma_f32_16x16x32_bf16 v[164:167], a[108:111], a[52:55], v[164:167]
v_lshl_add_u32 v22, s42, 7, v22
v_lshl_add_u32 v23, s42, 7, v23
v_mfma_f32_16x16x32_bf16 v[156:159], a[108:111], a[48:51], v[156:159]
v_mfma_f32_16x16x32_bf16 v[156:159], a[104:107], a[32:35], v[156:159]
s_waitcnt lgkmcnt(4)
v_mfma_f32_16x16x32_bf16 v[184:187], a[80:83], a[32:35], v[184:187]
ds_read_b64_tr_b16 a[104:105], v15 offset:8192
v_mfma_f32_16x16x32_bf16 v[184:187], a[84:87], a[48:51], v[184:187]
ds_read_b64_tr_b16 a[106:107], v15 offset:8448
s_add_u32 s8, s28, 0x7800
v_mfma_f32_16x16x32_bf16 v[192:195], a[84:87], a[52:55], v[192:195]
buffer_store_dwordx4 a[172:175], v16, s[88:91], s8 offen sc1
v_mfma_f32_16x16x32_bf16 v[192:195], a[80:83], a[36:39], v[192:195]
ds_read_b64_tr_b16 a[108:109], v15 offset:10240
v_mfma_f32_16x16x32_bf16 v[200:203], a[80:83], a[40:43], v[200:203]
ds_read_b64_tr_b16 a[110:111], v15 offset:10496
v_add_u32 v12, 0xffff0000, v12
v_mfma_f32_16x16x32_bf16 v[200:203], a[84:87], a[56:59], v[200:203]
v_add_u32 v13, 0xffff0000, v13
v_add_u32 v14, 0xffff0000, v14
v_mfma_f32_16x16x32_bf16 v[208:211], a[84:87], a[60:63], v[208:211]
v_add_u32 v15, 0xffff0000, v15
v_mfma_f32_16x16x32_bf16 v[208:211], a[80:83], a[44:47], v[208:211]
v_mfma_f32_16x16x32_bf16 v[212:215], a[88:91], a[44:47], v[212:215]
s_waitcnt vmcnt(28) lgkmcnt(0)
v_mfma_f32_16x16x32_bf16 v[212:215], a[92:95], a[60:63], v[212:215]
s_barrier
s_add_u32 m0, s17, 0x10000
v_mfma_f32_16x16x32_bf16 v[204:207], a[92:95], a[56:59], v[204:207]
buffer_load_dwordx4 v5, s[52:55], 0 offen lds
v_mfma_f32_16x16x32_bf16 v[204:207], a[88:91], a[40:43], v[204:207]
ds_read_b64_tr_b16 a[80:81], v12 offset:0
v_mfma_f32_16x16x32_bf16 v[196:199], a[88:91], a[36:39], v[196:199]
ds_read_b64_tr_b16 a[82:83], v12 offset:1024
v_mfma_f32_16x16x32_bf16 v[196:199], a[92:95], a[52:55], v[196:199]
ds_read_b64_tr_b16 a[84:85], v12 offset:8192
v_mfma_f32_16x16x32_bf16 v[188:191], a[92:95], a[48:51], v[188:191]
ds_read_b64_tr_b16 a[86:87], v12 offset:9216
v_mfma_f32_16x16x32_bf16 v[188:191], a[88:91], a[32:35], v[188:191]
s_add_u32 m0, s17, 0x10400
s_waitcnt lgkmcnt(4)
v_mfma_f32_16x16x32_bf16 v[216:219], a[32:35], a[96:99], v[216:219]
buffer_load_dwordx4 v5, s[52:55], s13 offen lds
v_mfma_f32_16x16x32_bf16 v[216:219], a[48:51], a[100:103], v[216:219]
ds_read_b64_tr_b16 a[88:89], v13 offset:0
v_mfma_f32_16x16x32_bf16 v[224:227], a[52:55], a[100:103], v[224:227]
ds_read_b64_tr_b16 a[90:91], v13 offset:1024
v_mfma_f32_16x16x32_bf16 v[224:227], a[36:39], a[96:99], v[224:227]
ds_read_b64_tr_b16 a[92:93], v13 offset:8192
v_mfma_f32_16x16x32_bf16 v[232:235], a[40:43], a[96:99], v[232:235]
ds_read_b64_tr_b16 a[94:95], v13 offset:9216
v_mfma_f32_16x16x32_bf16 v[232:235], a[56:59], a[100:103], v[232:235]
s_add_u32 m0, s17, 0x10800
v_mfma_f32_16x16x32_bf16 v[240:243], a[60:63], a[100:103], v[240:243]
buffer_load_dwordx4 v6, s[52:55], 0 offen lds
v_mfma_f32_16x16x32_bf16 v[240:243], a[44:47], a[96:99], v[240:243]
v_mfma_f32_16x16x32_bf16 v[244:247], a[44:47], a[104:107], v[244:247]
ds_read_b64_tr_b16 a[96:97], v12 offset:256
v_mfma_f32_16x16x32_bf16 v[244:247], a[60:63], a[108:111], v[244:247]
ds_read_b64_tr_b16 a[98:99], v12 offset:1280
v_mfma_f32_16x16x32_bf16 v[236:239], a[56:59], a[108:111], v[236:239]
ds_read_b64_tr_b16 a[100:101], v12 offset:8448
v_mfma_f32_16x16x32_bf16 v[236:239], a[40:43], a[104:107], v[236:239]
ds_read_b64_tr_b16 a[102:103], v12 offset:9472
s_add_u32 s8, s28, 0x2c00
v_mfma_f32_16x16x32_bf16 v[228:231], a[36:39], a[104:107], v[228:231]
buffer_store_dwordx4 a[176:179], v16, s[88:91], s8 offen sc1
v_mfma_f32_16x16x32_bf16 v[228:231], a[52:55], a[108:111], v[228:231]
v_mfma_f32_16x16x32_bf16 v[220:223], a[48:51], a[108:111], v[220:223]
v_mfma_f32_16x16x32_bf16 v[220:223], a[32:35], a[104:107], v[220:223]
s_waitcnt lgkmcnt(4)
L_S12:
v_mfma_f32_16x16x32_bf16 v[24:27], a[80:83], a[0:3], v[24:27]
ds_read_b64_tr_b16 a[104:105], v13 offset:256
s_waitcnt vmcnt(23)
v_mfma_f32_16x16x32_bf16 v[24:27], a[84:87], a[16:19], v[24:27]
ds_read_b64_tr_b16 a[106:107], v13 offset:1280
s_add_u32 m0, s17, 0x10c00
v_mfma_f32_16x16x32_bf16 v[32:35], a[84:87], a[20:23], v[32:35]
buffer_load_dwordx4 v6, s[52:55], s13 offen lds
v_mfma_f32_16x16x32_bf16 v[32:35], a[80:83], a[4:7], v[32:35]
ds_read_b64_tr_b16 a[108:109], v13 offset:8448
v_mfma_f32_16x16x32_bf16 v[40:43], a[80:83], a[8:11], v[40:43]
ds_read_b64_tr_b16 a[110:111], v13 offset:9472
v_mfma_f32_16x16x32_bf16 v[40:43], a[84:87], a[24:27], v[40:43]
ds_read_b128 a[32:35], v8 offset:32768
v_mfma_f32_16x16x32_bf16 v[48:51], a[84:87], a[28:31], v[48:51]
ds_read_b128 a[48:51], v9 offset:32768
v_mfma_f32_16x16x32_bf16 v[48:51], a[80:83], a[12:15], v[48:51]
ds_read_b128 a[36:39], v8 offset:34816
s_add_u32 m0, s18, 0x14000
v_mfma_f32_16x16x32_bf16 v[52:55], a[88:91], a[12:15], v[52:55]
buffer_load_dwordx4 v7, s[68:71], 0 offen lds
v_mfma_f32_16x16x32_bf16 v[52:55], a[92:95], a[28:31], v[52:55]
ds_read_b64_tr_b16 a[80:81], v12 offset:512
v_mfma_f32_16x16x32_bf16 v[44:47], a[92:95], a[24:27], v[44:47]
ds_read_b64_tr_b16 a[82:83], v12 offset:1536
v_mfma_f32_16x16x32_bf16 v[44:47], a[88:91], a[8:11], v[44:47]
ds_read_b64_tr_b16 a[84:85], v12 offset:8704
v_mfma_f32_16x16x32_bf16 v[36:39], a[88:91], a[4:7], v[36:39]
ds_read_b64_tr_b16 a[86:87], v12 offset:9728
v_mfma_f32_16x16x32_bf16 v[36:39], a[92:95], a[20:23], v[36:39]
ds_read_b128 a[52:55], v9 offset:34816
s_add_u32 m0, s18, 0x15000
v_mfma_f32_16x16x32_bf16 v[28:31], a[92:95], a[16:19], v[28:31]
buffer_load_dwordx4 v7, s[68:71], s25 offen lds
v_mfma_f32_16x16x32_bf16 v[28:31], a[88:91], a[0:3], v[28:31]
ds_read_b128 a[40:43], v8 offset:36864
s_waitcnt lgkmcnt(9)
v_mfma_f32_16x16x32_bf16 v[56:59], a[96:99], a[0:3], v[56:59]
ds_read_b64_tr_b16 a[88:89], v13 offset:512
v_mfma_f32_16x16x32_bf16 v[56:59], a[100:103], a[16:19], v[56:59]
ds_read_b64_tr_b16 a[90:91], v13 offset:1536
v_mfma_f32_16x16x32_bf16 v[64:67], a[100:103], a[20:23], v[64:67]
ds_read_b64_tr_b16 a[92:93], v13 offset:8704
v_mfma_f32_16x16x32_bf16 v[64:67], a[96:99], a[4:7], v[64:67]
ds_read_b64_tr_b16 a[94:95], v13 offset:9728
s_add_u32 m0, s18, 0x16000
v_mfma_f32_16x16x32_bf16 v[72:75], a[96:99], a[8:11], v[72:75]
buffer_load_dwordx4 v7, s[68:71], s26 offen lds
v_mfma_f32_16x16x32_bf16 v[72:75], a[100:103], a[24:27], v[72:75]
ds_read_b128 a[56:59], v9 offset:36864
v_lshl_add_u32 v5, s42, 19, v5
v_mfma_f32_16x16x32_bf16 v[80:83], a[100:103], a[28:31], v[80:83]
ds_read_b128 a[44:47], v8 offset:38912
v_lshl_add_u32 v6, s42, 19, v6
v_mfma_f32_16x16x32_bf16 v[80:83], a[96:99], a[12:15], v[80:83]
ds_read_b128 a[60:63], v9 offset:38912
v_lshl_add_u32 v7, s42, 18, v7
v_mfma_f32_16x16x32_bf16 v[84:87], a[104:107], a[12:15], v[84:87]
ds_read_b64_tr_b16 a[96:97], v12 offset:768
v_lshl_add_u32 v7, s42, 17, v7
v_mfma_f32_16x16x32_bf16 v[84:87], a[108:111], a[28:31], v[84:87]
ds_read_b64_tr_b16 a[98:99], v12 offset:1792
s_add_u32 s8, s28, 0x3c00
v_mfma_f32_16x16x32_bf16 v[76:79], a[108:111], a[24:27], v[76:79]
buffer_store_dwordx4 a[180:183], v16, s[88:91], s8 offen sc1
v_mfma_f32_16x16x32_bf16 v[76:79], a[104:107], a[8:11], v[76:79]
ds_read_b64_tr_b16 a[100:101], v12 offset:8960
v_mfma_f32_16x16x32_bf16 v[68:71], a[104:107], a[4:7], v[68:71]
ds_read_b64_tr_b16 a[102:103], v12 offset:9984
v_mfma_f32_16x16x32_bf16 v[68:71], a[108:111], a[20:23], v[68:71]
v_mfma_f32_16x16x32_bf16 v[60:63], a[108:111], a[16:19], v[60:63]
v_mfma_f32_16x16x32_bf16 v[60:63], a[104:107], a[0:3], v[60:63]
s_add_u32 m0, s16, 0x8000
s_waitcnt lgkmcnt(4)
s_waitcnt lgkmcnt(7)
v_mfma_f32_16x16x32_bf16 v[88:91], a[80:83], a[0:3], v[88:91]
buffer_load_dwordx4 v22, s[44:47], s20 offen lds
v_mfma_f32_16x16x32_bf16 v[88:91], a[84:87], a[16:19], v[88:91]
ds_read_b64_tr_b16 a[104:105], v13 offset:768
v_mfma_f32_16x16x32_bf16 v[96:99], a[84:87], a[20:23], v[96:99]
ds_read_b64_tr_b16 a[106:107], v13 offset:1792
v_mfma_f32_16x16x32_bf16 v[96:99], a[80:83], a[4:7], v[96:99]
ds_read_b64_tr_b16 a[108:109], v13 offset:8960
v_mfma_f32_16x16x32_bf16 v[104:107], a[80:83], a[8:11], v[104:107]
ds_read_b64_tr_b16 a[110:111], v13 offset:9984
s_add_u32 m0, s16, 0x8400
v_mfma_f32_16x16x32_bf16 v[104:107], a[84:87], a[24:27], v[104:107]
buffer_load_dwordx4 v23, s[44:47], s20 offen lds
v_mfma_f32_16x16x32_bf16 v[112:115], a[84:87], a[28:31], v[112:115]
v_mfma_f32_16x16x32_bf16 v[112:115], a[80:83], a[12:15], v[112:115]
v_mfma_f32_16x16x32_bf16 v[116:119], a[88:91], a[12:15], v[116:119]
ds_read_b64_tr_b16 a[80:81], v14 offset:0
v_mfma_f32_16x16x32_bf16 v[116:119], a[92:95], a[28:31], v[116:119]
ds_read_b64_tr_b16 a[82:83], v14 offset:256
v_mfma_f32_16x16x32_bf16 v[108:111], a[92:95], a[24:27], v[108:111]
ds_read_b64_tr_b16 a[84:85], v14 offset:2048
s_add_u32 m0, s16, 0x8800
v_mfma_f32_16x16x32_bf16 v[108:111], a[88:91], a[8:11], v[108:111]
buffer_load_dwordx4 v22, s[44:47], s21 offen lds
v_mfma_f32_16x16x32_bf16 v[100:103], a[88:91], a[4:7], v[100:103]
ds_read_b64_tr_b16 a[86:87], v14 offset:2304
v_mfma_f32_16x16x32_bf16 v[100:103], a[92:95], a[20:23], v[100:103]
v_mfma_f32_16x16x32_bf16 v[92:95], a[92:95], a[16:19], v[92:95]
v_mfma_f32_16x16x32_bf16 v[92:95], a[88:91], a[0:3], v[92:95]
s_add_u32 m0, s16, 0x8c00
s_waitcnt lgkmcnt(4)
v_mfma_f32_16x16x32_bf16 v[120:123], a[96:99], a[0:3], v[120:123]
buffer_load_dwordx4 v23, s[44:47], s21 offen lds
v_mfma_f32_16x16x32_bf16 v[120:123], a[100:103], a[16:19], v[120:123]
ds_read_b64_tr_b16 a[88:89], v15 offset:0
v_mfma_f32_16x16x32_bf16 v[128:131], a[100:103], a[20:23], v[128:131]
ds_read_b64_tr_b16 a[90:91], v15 offset:256
v_mfma_f32_16x16x32_bf16 v[128:131], a[96:99], a[4:7], v[128:131]
ds_read_b64_tr_b16 a[92:93], v15 offset:2048
v_mfma_f32_16x16x32_bf16 v[136:139], a[96:99], a[8:11], v[136:139]
ds_read_b64_tr_b16 a[94:95], v15 offset:2304
v_mfma_f32_16x16x32_bf16 v[136:139], a[100:103], a[24:27], v[136:139]
s_add_u32 s8, s28, 0x6c00
v_mfma_f32_16x16x32_bf16 v[144:147], a[100:103], a[28:31], v[144:147]
buffer_store_dwordx4 a[184:187], v16, s[88:91], s8 offen sc1
v_mfma_f32_16x16x32_bf16 v[144:147], a[96:99], a[12:15], v[144:147]
v_mfma_f32_16x16x32_bf16 v[148:151], a[104:107], a[12:15], v[148:151]
ds_read_b64_tr_b16 a[96:97], v14 offset:4096
v_mfma_f32_16x16x32_bf16 v[148:151], a[108:111], a[28:31], v[148:151]
ds_read_b64_tr_b16 a[98:99], v14 offset:4352
v_mfma_f32_16x16x32_bf16 v[140:143], a[108:111], a[24:27], v[140:143]
ds_read_b64_tr_b16 a[100:101], v14 offset:6144
v_mfma_f32_16x16x32_bf16 v[140:143], a[104:107], a[8:11], v[140:143]
ds_read_b64_tr_b16 a[102:103], v14 offset:6400
s_add_u32 m0, s16, 0x9000
v_mfma_f32_16x16x32_bf16 v[132:135], a[104:107], a[4:7], v[132:135]
buffer_load_dwordx4 v22, s[44:47], s22 offen lds
v_mfma_f32_16x16x32_bf16 v[132:135], a[108:111], a[20:23], v[132:135]
v_mfma_f32_16x16x32_bf16 v[124:127], a[108:111], a[16:19], v[124:127]
v_mfma_f32_16x16x32_bf16 v[124:127], a[104:107], a[0:3], v[124:127]
s_waitcnt lgkmcnt(4)
v_mfma_f32_16x16x32_bf16 v[152:155], a[80:83], a[0:3], v[152:155]
ds_read_b64_tr_b16 a[104:105], v15 offset:4096
s_add_u32 m0, s16, 0x9400
v_mfma_f32_16x16x32_bf16 v[152:155], a[84:87], a[16:19], v[152:155]
buffer_load_dwordx4 v23, s[44:47], s22 offen lds
v_mfma_f32_16x16x32_bf16 v[160:163], a[84:87], a[20:23], v[160:163]
ds_read_b64_tr_b16 a[106:107], v15 offset:4352
v_mfma_f32_16x16x32_bf16 v[160:163], a[80:83], a[4:7], v[160:163]
ds_read_b64_tr_b16 a[108:109], v15 offset:6144
v_mfma_f32_16x16x32_bf16 v[168:171], a[80:83], a[8:11], v[168:171]
ds_read_b64_tr_b16 a[110:111], v15 offset:6400
v_mfma_f32_16x16x32_bf16 v[168:171], a[84:87], a[24:27], v[168:171]
v_mfma_f32_16x16x32_bf16 v[176:179], a[84:87], a[28:31], v[176:179]
s_add_u32 m0, s16, 0x9800
v_mfma_f32_16x16x32_bf16 v[176:179], a[80:83], a[12:15], v[176:179]
buffer_load_dwordx4 v22, s[44:47], s23 offen lds
v_mfma_f32_16x16x32_bf16 v[180:183], a[88:91], a[12:15], v[180:183]
ds_read_b64_tr_b16 a[80:81], v14 offset:8192
v_mfma_f32_16x16x32_bf16 v[180:183], a[92:95], a[28:31], v[180:183]
ds_read_b64_tr_b16 a[82:83], v14 offset:8448
v_mfma_f32_16x16x32_bf16 v[172:175], a[92:95], a[24:27], v[172:175]
ds_read_b64_tr_b16 a[84:85], v14 offset:10240
v_mfma_f32_16x16x32_bf16 v[172:175], a[88:91], a[8:11], v[172:175]
ds_read_b64_tr_b16 a[86:87], v14 offset:10496
s_add_u32 m0, s16, 0x9c00
v_mfma_f32_16x16x32_bf16 v[164:167], a[88:91], a[4:7], v[164:167]
buffer_load_dwordx4 v23, s[44:47], s23 offen lds
v_mfma_f32_16x16x32_bf16 v[164:167], a[92:95], a[20:23], v[164:167]
v_lshl_add_u32 v22, s42, 7, v22
v_lshl_add_u32 v23, s42, 7, v23
v_mfma_f32_16x16x32_bf16 v[156:159], a[92:95], a[16:19], v[156:159]
v_mfma_f32_16x16x32_bf16 v[156:159], a[88:91], a[0:3], v[156:159]
s_waitcnt lgkmcnt(4)
v_mfma_f32_16x16x32_bf16 v[184:187], a[96:99], a[0:3], v[184:187]
ds_read_b64_tr_b16 a[88:89], v15 offset:8192
v_mfma_f32_16x16x32_bf16 v[184:187], a[100:103], a[16:19], v[184:187]
ds_read_b64_tr_b16 a[90:91], v15 offset:8448
s_add_u32 s8, s28, 0x7c00
v_mfma_f32_16x16x32_bf16 v[192:195], a[100:103], a[20:23], v[192:195]
buffer_store_dwordx4 a[188:191], v16, s[88:91], s8 offen sc1
v_mfma_f32_16x16x32_bf16 v[192:195], a[96:99], a[4:7], v[192:195]
ds_read_b64_tr_b16 a[92:93], v15 offset:10240
v_mfma_f32_16x16x32_bf16 v[200:203], a[96:99], a[8:11], v[200:203]
ds_read_b64_tr_b16 a[94:95], v15 offset:10496
v_add_u32 v12, 0x8000, v12
v_mfma_f32_16x16x32_bf16 v[200:203], a[100:103], a[24:27], v[200:203]
v_add_u32 v13, 0x8000, v13
v_add_u32 v14, 0x8000, v14
v_mfma_f32_16x16x32_bf16 v[208:211], a[100:103], a[28:31], v[208:211]
v_add_u32 v15, 0x8000, v15
v_mfma_f32_16x16x32_bf16 v[208:211], a[96:99], a[12:15], v[208:211]
v_mfma_f32_16x16x32_bf16 v[212:215], a[104:107], a[12:15], v[212:215]
s_waitcnt vmcnt(29) lgkmcnt(0)
v_mfma_f32_16x16x32_bf16 v[212:215], a[108:111], a[28:31], v[212:215]
s_barrier
s_add_u32 m0, s17, 0x0
v_mfma_f32_16x16x32_bf16 v[204:207], a[108:111], a[24:27], v[204:207]
buffer_load_dwordx4 v5, s[52:55], 0 offen lds
v_mfma_f32_16x16x32_bf16 v[204:207], a[104:107], a[8:11], v[204:207]
ds_read_b64_tr_b16 a[96:97], v12 offset:0
v_mfma_f32_16x16x32_bf16 v[196:199], a[104:107], a[4:7], v[196:199]
ds_read_b64_tr_b16 a[98:99], v12 offset:1024
v_mfma_f32_16x16x32_bf16 v[196:199], a[108:111], a[20:23], v[196:199]
ds_read_b64_tr_b16 a[100:101], v12 offset:8192
v_mfma_f32_16x16x32_bf16 v[188:191], a[108:111], a[16:19], v[188:191]
ds_read_b64_tr_b16 a[102:103], v12 offset:9216
v_mfma_f32_16x16x32_bf16 v[188:191], a[104:107], a[0:3], v[188:191]
s_add_u32 m0, s17, 0x400
s_waitcnt lgkmcnt(4)
v_mfma_f32_16x16x32_bf16 v[216:219], a[0:3], a[80:83], v[216:219]
buffer_load_dwordx4 v5, s[52:55], s13 offen lds
v_mfma_f32_16x16x32_bf16 v[216:219], a[16:19], a[84:87], v[216:219]
ds_read_b64_tr_b16 a[104:105], v13 offset:0
v_mfma_f32_16x16x32_bf16 v[224:227], a[20:23], a[84:87], v[224:227]
ds_read_b64_tr_b16 a[106:107], v13 offset:1024
v_mfma_f32_16x16x32_bf16 v[224:227], a[4:7], a[80:83], v[224:227]
ds_read_b64_tr_b16 a[108:109], v13 offset:8192
v_mfma_f32_16x16x32_bf16 v[232:235], a[8:11], a[80:83], v[232:235]
ds_read_b64_tr_b16 a[110:111], v13 offset:9216
v_mfma_f32_16x16x32_bf16 v[232:235], a[24:27], a[84:87], v[232:235]
v_mfma_f32_16x16x32_bf16 v[240:243], a[28:31], a[84:87], v[240:243]
s_add_u32 m0, s17, 0x800
v_mfma_f32_16x16x32_bf16 v[240:243], a[12:15], a[80:83], v[240:243]
buffer_load_dwordx4 v6, s[52:55], 0 offen lds
v_mfma_f32_16x16x32_bf16 v[244:247], a[12:15], a[88:91], v[244:247]
ds_read_b64_tr_b16 a[80:81], v12 offset:256
v_mfma_f32_16x16x32_bf16 v[244:247], a[28:31], a[92:95], v[244:247]
ds_read_b64_tr_b16 a[82:83], v12 offset:1280
v_mfma_f32_16x16x32_bf16 v[236:239], a[24:27], a[92:95], v[236:239]
ds_read_b64_tr_b16 a[84:85], v12 offset:8448
v_mfma_f32_16x16x32_bf16 v[236:239], a[8:11], a[88:91], v[236:239]
ds_read_b64_tr_b16 a[86:87], v12 offset:9472
v_mfma_f32_16x16x32_bf16 v[228:231], a[4:7], a[88:91], v[228:231]
v_mfma_f32_16x16x32_bf16 v[228:231], a[20:23], a[92:95], v[228:231]
s_add_u32 m0, s17, 0xc00
v_mfma_f32_16x16x32_bf16 v[220:223], a[16:19], a[92:95], v[220:223]
buffer_load_dwordx4 v6, s[52:55], s13 offen lds
v_mfma_f32_16x16x32_bf16 v[220:223], a[0:3], a[88:91], v[220:223]
s_waitcnt lgkmcnt(4)
L_S13:
v_mfma_f32_16x16x32_bf16 v[24:27], a[96:99], a[32:35], v[24:27]
ds_read_b64_tr_b16 a[88:89], v13 offset:256
s_waitcnt vmcnt(24)
v_mfma_f32_16x16x32_bf16 v[24:27], a[100:103], a[48:51], v[24:27]
ds_read_b64_tr_b16 a[90:91], v13 offset:1280
v_mfma_f32_16x16x32_bf16 v[32:35], a[100:103], a[52:55], v[32:35]
ds_read_b64_tr_b16 a[92:93], v13 offset:8448
v_mfma_f32_16x16x32_bf16 v[32:35], a[96:99], a[36:39], v[32:35]
ds_read_b64_tr_b16 a[94:95], v13 offset:9472
v_mfma_f32_16x16x32_bf16 v[40:43], a[96:99], a[40:43], v[40:43]
ds_read_b128 a[0:3], v8 offset:0
s_add_u32 m0, s18, 0x4000
v_mfma_f32_16x16x32_bf16 v[40:43], a[100:103], a[56:59], v[40:43]
buffer_load_dwordx4 v7, s[68:71], 0 offen lds
v_mfma_f32_16x16x32_bf16 v[48:51], a[100:103], a[60:63], v[48:51]
ds_read_b128 a[16:19], v9 offset:0
v_mfma_f32_16x16x32_bf16 v[48:51], a[96:99], a[44:47], v[48:51]
ds_read_b128 a[4:7], v8 offset:2048
v_mfma_f32_16x16x32_bf16 v[52:55], a[104:107], a[44:47], v[52:55]
ds_read_b64_tr_b16 a[96:97], v12 offset:512
v_mfma_f32_16x16x32_bf16 v[52:55], a[108:111], a[60:63], v[52:55]
ds_read_b64_tr_b16 a[98:99], v12 offset:1536
v_mfma_f32_16x16x32_bf16 v[44:47], a[108:111], a[56:59], v[44:47]
ds_read_b64_tr_b16 a[100:101], v12 offset:8704
s_add_u32 s8, s28, 0x4000
v_mfma_f32_16x16x32_bf16 v[44:47], a[104:107], a[40:43], v[44:47]
buffer_store_dwordx4 a[192:195], v16, s[88:91], s8 offen sc1
v_mfma_f32_16x16x32_bf16 v[36:39], a[104:107], a[36:39], v[36:39]
ds_read_b64_tr_b16 a[102:103], v12 offset:9728
v_mfma_f32_16x16x32_bf16 v[36:39], a[108:111], a[52:55], v[36:39]
ds_read_b128 a[20:23], v9 offset:2048
v_mfma_f32_16x16x32_bf16 v[28:31], a[108:111], a[48:51], v[28:31]
ds_read_b128 a[8:11], v8 offset:4096
v_mfma_f32_16x16x32_bf16 v[28:31], a[104:107], a[32:35], v[28:31]
ds_read_b128 a[24:27], v9 offset:4096
s_waitcnt lgkmcnt(10)
v_mfma_f32_16x16x32_bf16 v[56:59], a[80:83], a[32:35], v[56:59]
ds_read_b64_tr_b16 a[104:105], v13 offset:512
v_mfma_f32_16x16x32_bf16 v[56:59], a[84:87], a[48:51], v[56:59]
ds_read_b64_tr_b16 a[106:107], v13 offset:1536
s_add_u32 m0, s18, 0x5000
v_mfma_f32_16x16x32_bf16 v[64:67], a[84:87], a[52:55], v[64:67]
buffer_load_dwordx4 v7, s[68:71], s25 offen lds
v_mfma_f32_16x16x32_bf16 v[64:67], a[80:83], a[36:39], v[64:67]
ds_read_b64_tr_b16 a[108:109], v13 offset:8704
v_mfma_f32_16x16x32_bf16 v[72:75], a[80:83], a[40:43], v[72:75]
ds_read_b64_tr_b16 a[110:111], v13 offset:9728
v_mfma_f32_16x16x32_bf16 v[72:75], a[84:87], a[56:59], v[72:75]
ds_read_b128 a[12:15], v8 offset:6144
v_mfma_f32_16x16x32_bf16 v[80:83], a[84:87], a[60:63], v[80:83]
ds_read_b128 a[28:31], v9 offset:6144
v_mfma_f32_16x16x32_bf16 v[80:83], a[80:83], a[44:47], v[80:83]
v_mfma_f32_16x16x32_bf16 v[84:87], a[88:91], a[44:47], v[84:87]
ds_read_b64_tr_b16 a[80:81], v12 offset:768
s_add_u32 m0, s18, 0x6000
v_mfma_f32_16x16x32_bf16 v[84:87], a[92:95], a[60:63], v[84:87]
buffer_load_dwordx4 v7, s[68:71], s26 offen lds
v_mfma_f32_16x16x32_bf16 v[76:79], a[92:95], a[56:59], v[76:79]
ds_read_b64_tr_b16 a[82:83], v12 offset:1792
v_lshl_add_u32 v5, s42, 19, v5
v_mfma_f32_16x16x32_bf16 v[76:79], a[88:91], a[40:43], v[76:79]
ds_read_b64_tr_b16 a[84:85], v12 offset:8960
v_lshl_add_u32 v6, s42, 19, v6
v_mfma_f32_16x16x32_bf16 v[68:71], a[88:91], a[36:39], v[68:71]
ds_read_b64_tr_b16 a[86:87], v12 offset:9984
v_lshl_add_u32 v7, s42, 18, v7
v_mfma_f32_16x16x32_bf16 v[68:71], a[92:95], a[52:55], v[68:71]
v_lshl_add_u32 v7, s42, 17, v7
v_mfma_f32_16x16x32_bf16 v[60:63], a[92:95], a[48:51], v[60:63]
v_mfma_f32_16x16x32_bf16 v[60:63], a[88:91], a[32:35], v[60:63]
s_add_u32 m0, s16, 0x0
s_waitcnt lgkmcnt(4)
s_waitcnt lgkmcnt(6)
v_mfma_f32_16x16x32_bf16 v[88:91], a[96:99], a[32:35], v[88:91]
buffer_load_dwordx4 v22, s[44:47], s20 offen lds
v_mfma_f32_16x16x32_bf16 v[88:91], a[100:103], a[48:51], v[88:91]
ds_read_b64_tr_b16 a[88:89], v13 offset:768
v_mfma_f32_16x16x32_bf16 v[96:99], a[100:103], a[52:55], v[96:99]
ds_read_b64_tr_b16 a[90:91], v13 offset:1792
v_mfma_f32_16x16x32_bf16 v[96:99], a[96:99], a[36:39], v[96:99]
ds_read_b64_tr_b16 a[92:93], v13 offset:8960
v_mfma_f32_16x16x32_bf16 v[104:107], a[96:99], a[40:43], v[104:107]
ds_read_b64_tr_b16 a[94:95], v13 offset:9984
s_add_u32 m0, s16, 0x400
v_mfma_f32_16x16x32_bf16 v[104:107], a[100:103], a[56:59], v[104:107]
buffer_load_dwordx4 v23, s[44:47], s20 offen lds
v_mfma_f32_16x16x32_bf16 v[112:115], a[100:103], a[60:63], v[112:115]
v_mfma_f32_16x16x32_bf16 v[112:115], a[96:99], a[44:47], v[112:115]
v_mfma_f32_16x16x32_bf16 v[116:119], a[104:107], a[44:47], v[116:119]
ds_read_b64_tr_b16 a[96:97], v14 offset:0
v_mfma_f32_16x16x32_bf16 v[116:119], a[108:111], a[60:63], v[116:119]
ds_read_b64_tr_b16 a[98:99], v14 offset:256
v_mfma_f32_16x16x32_bf16 v[108:111], a[108:111], a[56:59], v[108:111]
ds_read_b64_tr_b16 a[100:101], v14 offset:2048
s_add_u32 m0, s16, 0x800
v_mfma_f32_16x16x32_bf16 v[108:111], a[104:107], a[40:43], v[108:111]
buffer_load_dwordx4 v22, s[44:47], s21 offen lds
v_mfma_f32_16x16x32_bf16 v[100:103], a[104:107], a[36:39], v[100:103]
ds_read_b64_tr_b16 a[102:103], v14 offset:2304
v_mfma_f32_16x16x32_bf16 v[100:103], a[108:111], a[52:55], v[100:103]
v_mfma_f32_16x16x32_bf16 v[92:95], a[108:111], a[48:51], v[92:95]
v_mfma_f32_16x16x32_bf16 v[92:95], a[104:107], a[32:35], v[92:95]
s_add_u32 s8, s28, 0x8000
s_waitcnt lgkmcnt(4)
v_mfma_f32_16x16x32_bf16 v[120:123], a[80:83], a[32:35], v[120:123]
buffer_store_dwordx4 a[196:199], v16, s[88:91], s8 offen sc1
v_mfma_f32_16x16x32_bf16 v[120:123], a[84:87], a[48:51], v[120:123]
ds_read_b64_tr_b16 a[104:105], v15 offset:0
v_mfma_f32_16x16x32_bf16 v[128:131], a[84:87], a[52:55], v[128:131]
ds_read_b64_tr_b16 a[106:107], v15 offset:256
v_mfma_f32_16x16x32_bf16 v[128:131], a[80:83], a[36:39], v[128:131]
ds_read_b64_tr_b16 a[108:109], v15 offset:2048
v_mfma_f32_16x16x32_bf16 v[136:139], a[80:83], a[40:43], v[136:139]
ds_read_b64_tr_b16 a[110:111], v15 offset:2304
v_mfma_f32_16x16x32_bf16 v[136:139], a[84:87], a[56:59], v[136:139]
s_add_u32 m0, s16, 0xc00
v_mfma_f32_16x16x32_bf16 v[144:147], a[84:87], a[60:63], v[144:147]
buffer_load_dwordx4 v23, s[44:47], s21 offen lds
v_mfma_f32_16x16x32_bf16 v[144:147], a[80:83], a[44:47], v[144:147]
v_mfma_f32_16x16x32_bf16 v[148:151], a[88:91], a[44:47], v[148:151]
ds_read_b64_tr_b16 a[80:81], v14 offset:4096
v_mfma_f32_16x16x32_bf16 v[148:151], a[92:95], a[60:63], v[148:151]
ds_read_b64_tr_b16 a[82:83], v14 offset:4352
L_padA7:
s_cmp_eq_u32 s95, 1
s_cbranch_scc1 L_padA11
v_mfma_f32_16x16x32_bf16 v[140:143], a[92:95], a[56:59], v[140:143]
ds_read_b64_tr_b16 a[84:85], v14 offset:6144
v_mfma_f32_16x16x32_bf16 v[140:143], a[88:91], a[40:43], v[140:143]
ds_read_b64_tr_b16 a[86:87], v14 offset:6400
s_add_u32 m0, s16, 0x1000
v_mfma_f32_16x16x32_bf16 v[132:135], a[88:91], a[36:39], v[132:135]
buffer_load_dwordx4 v22, s[44:47], s22 offen lds
v_mfma_f32_16x16x32_bf16 v[132:135], a[92:95], a[52:55], v[132:135]
v_mfma_f32_16x16x32_bf16 v[124:127], a[92:95], a[48:51], v[124:127]
v_mfma_f32_16x16x32_bf16 v[124:127], a[88:91], a[32:35], v[124:127]
s_waitcnt lgkmcnt(4)
v_mfma_f32_16x16x32_bf16 v[152:155], a[96:99], a[32:35], v[152:155]
ds_read_b64_tr_b16 a[88:89], v15 offset:4096
s_add_u32 m0, s16, 0x1400
v_mfma_f32_16x16x32_bf16 v[152:155], a[100:103], a[48:51], v[152:155]
buffer_load_dwordx4 v23, s[44:47], s22 offen lds
v_mfma_f32_16x16x32_bf16 v[160:163], a[100:103], a[52:55], v[160:163]
ds_read_b64_tr_b16 a[90:91], v15 offset:4352
v_mfma_f32_16x16x32_bf16 v[160:163], a[96:99], a[36:39], v[160:163]
ds_read_b64_tr_b16 a[92:93], v15 offset:6144
v_mfma_f32_16x16x32_bf16 v[168:171], a[96:99], a[40:43], v[168:171]
ds_read_b64_tr_b16 a[94:95], v15 offset:6400
v_mfma_f32_16x16x32_bf16 v[168:171], a[100:103], a[56:59], v[168:171]
v_mfma_f32_16x16x32_bf16 v[176:179], a[100:103], a[60:63], v[176:179]
s_add_u32 m0, s16, 0x1800
v_mfma_f32_16x16x32_bf16 v[176:179], a[96:99], a[44:47], v[176:179]
buffer_load_dwordx4 v22, s[44:47], s23 offen lds
v_mfma_f32_16x16x32_bf16 v[180:183], a[104:107], a[44:47], v[180:183]
ds_read_b64_tr_b16 a[96:97], v14 offset:8192
v_mfma_f32_16x16x32_bf16 v[180:183], a[108:111], a[60:63], v[180:183]
ds_read_b64_tr_b16 a[98:99], v14 offset:8448
v_mfma_f32_16x16x32_bf16 v[172:175], a[108:111], a[56:59], v[172:175]
ds_read_b64_tr_b16 a[100:101], v14 offset:10240
v_mfma_f32_16x16x32_bf16 v[172:175], a[104:107], a[40:43], v[172:175]
ds_read_b64_tr_b16 a[102:103], v14 offset:10496
s_add_u32 m0, s16, 0x1c00
v_mfma_f32_16x16x32_bf16 v[164:167], a[104:107], a[36:39], v[164:167]
buffer_load_dwordx4 v23, s[44:47], s23 offen lds
v_mfma_f32_16x16x32_bf16 v[164:167], a[108:111], a[52:55], v[164:167]
v_lshl_add_u32 v22, s42, 7, v22
v_lshl_add_u32 v23, s42, 7, v23
v_mfma_f32_16x16x32_bf16 v[156:159], a[108:111], a[48:51], v[156:159]
v_mfma_f32_16x16x32_bf16 v[156:159], a[104:107], a[32:35], v[156:159]
s_waitcnt lgkmcnt(4)
v_mfma_f32_16x16x32_bf16 v[184:187], a[80:83], a[32:35], v[184:187]
ds_read_b64_tr_b16 a[104:105], v15 offset:8192
v_mfma_f32_16x16x32_bf16 v[184:187], a[84:87], a[48:51], v[184:187]
ds_read_b64_tr_b16 a[106:107], v15 offset:8448
s_add_u32 s8, s28, 0x4400
v_mfma_f32_16x16x32_bf16 v[192:195], a[84:87], a[52:55], v[192:195]
buffer_store_dwordx4 a[200:203], v16, s[88:91], s8 offen sc1
v_mfma_f32_16x16x32_bf16 v[192:195], a[80:83], a[36:39], v[192:195]
ds_read_b64_tr_b16 a[108:109], v15 offset:10240
v_mfma_f32_16x16x32_bf16 v[200:203], a[80:83], a[40:43], v[200:203]
ds_read_b64_tr_b16 a[110:111], v15 offset:10496
v_add_u32 v12, 0x8000, v12
v_mfma_f32_16x16x32_bf16 v[200:203], a[84:87], a[56:59], v[200:203]
v_add_u32 v13, 0x8000, v13
v_add_u32 v14, 0x8000, v14
v_mfma_f32_16x16x32_bf16 v[208:211], a[84:87], a[60:63], v[208:211]
v_add_u32 v15, 0x8000, v15
v_mfma_f32_16x16x32_bf16 v[208:211], a[80:83], a[44:47], v[208:211]
v_mfma_f32_16x16x32_bf16 v[212:215], a[88:91], a[44:47], v[212:215]
s_waitcnt vmcnt(29) lgkmcnt(0)
v_mfma_f32_16x16x32_bf16 v[212:215], a[92:95], a[60:63], v[212:215]
s_barrier
s_add_u32 m0, s17, 0x8000
v_mfma_f32_16x16x32_bf16 v[204:207], a[92:95], a[56:59], v[204:207]
buffer_load_dwordx4 v5, s[52:55], 0 offen lds
v_mfma_f32_16x16x32_bf16 v[204:207], a[88:91], a[40:43], v[204:207]
ds_read_b64_tr_b16 a[80:81], v12 offset:0
v_mfma_f32_16x16x32_bf16 v[196:199], a[88:91], a[36:39], v[196:199]
ds_read_b64_tr_b16 a[82:83], v12 offset:1024
v_mfma_f32_16x16x32_bf16 v[196:199], a[92:95], a[52:55], v[196:199]
ds_read_b64_tr_b16 a[84:85], v12 offset:8192
v_mfma_f32_16x16x32_bf16 v[188:191], a[92:95], a[48:51], v[188:191]
ds_read_b64_tr_b16 a[86:87], v12 offset:9216
v_mfma_f32_16x16x32_bf16 v[188:191], a[88:91], a[32:35], v[188:191]
s_add_u32 m0, s17, 0x8400
s_waitcnt lgkmcnt(4)
v_mfma_f32_16x16x32_bf16 v[216:219], a[32:35], a[96:99], v[216:219]
buffer_load_dwordx4 v5, s[52:55], s13 offen lds
v_mfma_f32_16x16x32_bf16 v[216:219], a[48:51], a[100:103], v[216:219]
ds_read_b64_tr_b16 a[88:89], v13 offset:0
v_mfma_f32_16x16x32_bf16 v[224:227], a[52:55], a[100:103], v[224:227]
ds_read_b64_tr_b16 a[90:91], v13 offset:1024
v_mfma_f32_16x16x32_bf16 v[224:227], a[36:39], a[96:99], v[224:227]
ds_read_b64_tr_b16 a[92:93], v13 offset:8192
v_mfma_f32_16x16x32_bf16 v[232:235], a[40:43], a[96:99], v[232:235]
ds_read_b64_tr_b16 a[94:95], v13 offset:9216
v_mfma_f32_16x16x32_bf16 v[232:235], a[56:59], a[100:103], v[232:235]
v_mfma_f32_16x16x32_bf16 v[240:243], a[60:63], a[100:103], v[240:243]
s_add_u32 m0, s17, 0x8800
v_mfma_f32_16x16x32_bf16 v[240:243], a[44:47], a[96:99], v[240:243]
buffer_load_dwordx4 v6, s[52:55], 0 offen lds
v_mfma_f32_16x16x32_bf16 v[244:247], a[44:47], a[104:107], v[244:247]
ds_read_b64_tr_b16 a[96:97], v12 offset:256
v_mfma_f32_16x16x32_bf16 v[244:247], a[60:63], a[108:111], v[244:247]
ds_read_b64_tr_b16 a[98:99], v12 offset:1280
v_mfma_f32_16x16x32_bf16 v[236:239], a[56:59], a[108:111], v[236:239]
ds_read_b64_tr_b16 a[100:101], v12 offset:8448
v_mfma_f32_16x16x32_bf16 v[236:239], a[40:43], a[104:107], v[236:239]
ds_read_b64_tr_b16 a[102:103], v12 offset:9472
v_mfma_f32_16x16x32_bf16 v[228:231], a[36:39], a[104:107], v[228:231]
v_mfma_f32_16x16x32_bf16 v[228:231], a[52:55], a[108:111], v[228:231]
s_add_u32 m0, s17, 0x8c00
v_mfma_f32_16x16x32_bf16 v[220:223], a[48:51], a[108:111], v[220:223]
buffer_load_dwordx4 v6, s[52:55], s13 offen lds
v_mfma_f32_16x16x32_bf16 v[220:223], a[32:35], a[104:107], v[220:223]
s_waitcnt lgkmcnt(4)
L_S14:
v_mfma_f32_16x16x32_bf16 v[24:27], a[80:83], a[0:3], v[24:27]
ds_read_b64_tr_b16 a[104:105], v13 offset:256
s_waitcnt vmcnt(23)
v_mfma_f32_16x16x32_bf16 v[24:27], a[84:87], a[16:19], v[24:27]
ds_read_b64_tr_b16 a[106:107], v13 offset:1280
v_mfma_f32_16x16x32_bf16 v[32:35], a[84:87], a[20:23], v[32:35]
ds_read_b64_tr_b16 a[108:109], v13 offset:8448
v_mfma_f32_16x16x32_bf16 v[32:35], a[80:83], a[4:7], v[32:35]
ds_read_b64_tr_b16 a[110:111], v13 offset:9472
v_mfma_f32_16x16x32_bf16 v[40:43], a[80:83], a[8:11], v[40:43]
ds_read_b128 a[32:35], v8 offset:32768
s_add_u32 m0, s18, 0xc000
v_mfma_f32_16x16x32_bf16 v[40:43], a[84:87], a[24:27], v[40:43]
buffer_load_dwordx4 v7, s[68:71], 0 offen lds
v_mfma_f32_16x16x32_bf16 v[48:51], a[84:87], a[28:31], v[48:51]
ds_read_b128 a[48:51], v9 offset:32768
v_mfma_f32_16x16x32_bf16 v[48:51], a[80:83], a[12:15], v[48:51]
ds_read_b128 a[36:39], v8 offset:34816
v_mfma_f32_16x16x32_bf16 v[52:55], a[88:91], a[12:15], v[52:55]
ds_read_b64_tr_b16 a[80:81], v12 offset:512
v_mfma_f32_16x16x32_bf16 v[52:55], a[92:95], a[28:31], v[52:55]
ds_read_b64_tr_b16 a[82:83], v12 offset:1536
v_mfma_f32_16x16x32_bf16 v[44:47], a[92:95], a[24:27], v[44:47]
ds_read_b64_tr_b16 a[84:85], v12 offset:8704
s_add_u32 s8, s28, 0x8400
v_mfma_f32_16x16x32_bf16 v[44:47], a[88:91], a[8:11], v[44:47]
buffer_store_dwordx4 a[204:207], v16, s[88:91], s8 offen sc1
v_mfma_f32_16x16x32_bf16 v[36:39], a[88:91], a[4:7], v[36:39]
ds_read_b64_tr_b16 a[86:87], v12 offset:9728
v_mfma_f32_16x16x32_bf16 v[36:39], a[92:95], a[20:23], v[36:39]
ds_read_b128 a[52:55], v9 offset:34816
v_mfma_f32_16x16x32_bf16 v[28:31], a[92:95], a[16:19], v[28:31]
ds_read_b128 a[40:43], v8 offset:36864
v_mfma_f32_16x16x32_bf16 v[28:31], a[88:91], a[0:3], v[28:31]
ds_read_b128 a[56:59], v9 offset:36864
s_waitcnt lgkmcnt(10)
v_mfma_f32_16x16x32_bf16 v[56:59], a[96:99], a[0:3], v[56:59]
ds_read_b64_tr_b16 a[88:89], v13 offset:512
v_mfma_f32_16x16x32_bf16 v[56:59], a[100:103], a[16:19], v[56:59]
ds_read_b64_tr_b16 a[90:91], v13 offset:1536
s_add_u32 m0, s18, 0xd000
v_mfma_f32_16x16x32_bf16 v[64:67], a[100:103], a[20:23], v[64:67]
buffer_load_dwordx4 v7, s[68:71], s25 offen lds
v_mfma_f32_16x16x32_bf16 v[64:67], a[96:99], a[4:7], v[64:67]
ds_read_b64_tr_b16 a[92:93], v13 offset:8704
v_mfma_f32_16x16x32_bf16 v[72:75], a[96:99], a[8:11], v[72:75]
ds_read_b64_tr_b16 a[94:95], v13 offset:9728
v_mfma_f32_16x16x32_bf16 v[72:75], a[100:103], a[24:27], v[72:75]
ds_read_b128 a[44:47], v8 offset:38912
v_mfma_f32_16x16x32_bf16 v[80:83], a[100:103], a[28:31], v[80:83]
ds_read_b128 a[60:63], v9 offset:38912
v_mfma_f32_16x16x32_bf16 v[80:83], a[96:99], a[12:15], v[80:83]
v_mfma_f32_16x16x32_bf16 v[84:87], a[104:107], a[12:15], v[84:87]
ds_read_b64_tr_b16 a[96:97], v12 offset:768
s_add_u32 m0, s18, 0xe000
v_mfma_f32_16x16x32_bf16 v[84:87], a[108:111], a[28:31], v[84:87]
buffer_load_dwordx4 v7, s[68:71], s26 offen lds
v_mfma_f32_16x16x32_bf16 v[76:79], a[108:111], a[24:27], v[76:79]
ds_read_b64_tr_b16 a[98:99], v12 offset:1792
v_lshl_add_u32 v5, s42, 19, v5
v_mfma_f32_16x16x32_bf16 v[76:79], a[104:107], a[8:11], v[76:79]
ds_read_b64_tr_b16 a[100:101], v12 offset:8960
v_lshl_add_u32 v6, s42, 19, v6
v_mfma_f32_16x16x32_bf16 v[68:71], a[104:107], a[4:7], v[68:71]
ds_read_b64_tr_b16 a[102:103], v12 offset:9984
v_lshl_add_u32 v7, s42, 18, v7
v_mfma_f32_16x16x32_bf16 v[68:71], a[108:111], a[20:23], v[68:71]
v_lshl_add_u32 v7, s42, 17, v7
v_mfma_f32_16x16x32_bf16 v[60:63], a[108:111], a[16:19], v[60:63]
v_mfma_f32_16x16x32_bf16 v[60:63], a[104:107], a[0:3], v[60:63]
s_add_u32 m0, s16, 0x8000
s_waitcnt lgkmcnt(4)
s_waitcnt lgkmcnt(6)
v_mfma_f32_16x16x32_bf16 v[88:91], a[80:83], a[0:3], v[88:91]
buffer_load_dwordx4 v22, s[44:47], s20 offen lds
v_mfma_f32_16x16x32_bf16 v[88:91], a[84:87], a[16:19], v[88:91]
ds_read_b64_tr_b16 a[104:105], v13 offset:768
v_mfma_f32_16x16x32_bf16 v[96:99], a[84:87], a[20:23], v[96:99]
ds_read_b64_tr_b16 a[106:107], v13 offset:1792
v_mfma_f32_16x16x32_bf16 v[96:99], a[80:83], a[4:7], v[96:99]
ds_read_b64_tr_b16 a[108:109], v13 offset:8960
v_mfma_f32_16x16x32_bf16 v[104:107], a[80:83], a[8:11], v[104:107]
ds_read_b64_tr_b16 a[110:111], v13 offset:9984
s_add_u32 m0, s16, 0x8400
v_mfma_f32_16x16x32_bf16 v[104:107], a[84:87], a[24:27], v[104:107]
buffer_load_dwordx4 v23, s[44:47], s20 offen lds
v_mfma_f32_16x16x32_bf16 v[112:115], a[84:87], a[28:31], v[112:115]
v_mfma_f32_16x16x32_bf16 v[112:115], a[80:83], a[12:15], v[112:115]
v_mfma_f32_16x16x32_bf16 v[116:119], a[88:91], a[12:15], v[116:119]
ds_read_b64_tr_b16 a[80:81], v14 offset:0
v_mfma_f32_16x16x32_bf16 v[116:119], a[92:95], a[28:31], v[116:119]
ds_read_b64_tr_b16 a[82:83], v14 offset:256
v_mfma_f32_16x16x32_bf16 v[108:111], a[92:95], a[24:27], v[108:111]
ds_read_b64_tr_b16 a[84:85], v14 offset:2048
s_add_u32 m0, s16, 0x8800
v_mfma_f32_16x16x32_bf16 v[108:111], a[88:91], a[8:11], v[108:111]
buffer_load_dwordx4 v22, s[44:47], s21 offen lds
v_mfma_f32_16x16x32_bf16 v[100:103], a[88:91], a[4:7], v[100:103]
ds_read_b64_tr_b16 a[86:87], v14 offset:2304
v_mfma_f32_16x16x32_bf16 v[100:103], a[92:95], a[20:23], v[100:103]
v_mfma_f32_16x16x32_bf16 v[92:95], a[92:95], a[16:19], v[92:95]
v_mfma_f32_16x16x32_bf16 v[92:95], a[88:91], a[0:3], v[92:95]
s_add_u32 s8, s28, 0x4800
s_waitcnt lgkmcnt(4)
v_mfma_f32_16x16x32_bf16 v[120:123], a[96:99], a[0:3], v[120:123]
buffer_store_dwordx4 a[208:211], v16, s[88:91], s8 offen sc1
v_mfma_f32_16x16x32_bf16 v[120:123], a[100:103], a[16:19], v[120:123]
ds_read_b64_tr_b16 a[88:89], v15 offset:0
v_mfma_f32_16x16x32_bf16 v[128:131], a[100:103], a[20:23], v[128:131]
ds_read_b64_tr_b16 a[90:91], v15 offset:256
v_mfma_f32_16x16x32_bf16 v[128:131], a[96:99], a[4:7], v[128:131]
ds_read_b64_tr_b16 a[92:93], v15 offset:2048
v_mfma_f32_16x16x32_bf16 v[136:139], a[96:99], a[8:11], v[136:139]
ds_read_b64_tr_b16 a[94:95], v15 offset:2304
v_mfma_f32_16x16x32_bf16 v[136:139], a[100:103], a[24:27], v[136:139]
s_add_u32 m0, s16, 0x8c00
v_mfma_f32_16x16x32_bf16 v[144:147], a[100:103], a[28:31], v[144:147]
buffer_load_dwordx4 v23, s[44:47], s21 offen lds
v_mfma_f32_16x16x32_bf16 v[144:147], a[96:99], a[12:15], v[144:147]
v_mfma_f32_16x16x32_bf16 v[148:151], a[104:107], a[12:15], v[148:151]
ds_read_b64_tr_b16 a[96:97], v14 offset:4096
v_mfma_f32_16x16x32_bf16 v[148:151], a[108:111], a[28:31], v[148:151]
ds_read_b64_tr_b16 a[98:99], v14 offset:4352
v_mfma_f32_16x16x32_bf16 v[140:143], a[108:111], a[24:27], v[140:143]
ds_read_b64_tr_b16 a[100:101], v14 offset:6144
v_mfma_f32_16x16x32_bf16 v[140:143], a[104:107], a[8:11], v[140:143]
ds_read_b64_tr_b16 a[102:103], v14 offset:6400
s_add_u32 m0, s16, 0x9000
v_mfma_f32_16x16x32_bf16 v[132:135], a[104:107], a[4:7], v[132:135]
buffer_load_dwordx4 v22, s[44:47], s22 offen lds
v_mfma_f32_16x16x32_bf16 v[132:135], a[108:111], a[20:23], v[132:135]
v_mfma_f32_16x16x32_bf16 v[124:127], a[108:111], a[16:19], v[124:127]
v_mfma_f32_16x16x32_bf16 v[124:127], a[104:107], a[0:3], v[124:127]
s_waitcnt lgkmcnt(4)
v_mfma_f32_16x16x32_bf16 v[152:155], a[80:83], a[0:3], v[152:155]
ds_read_b64_tr_b16 a[104:105], v15 offset:4096
s_add_u32 m0, s16, 0x9400
v_mfma_f32_16x16x32_bf16 v[152:155], a[84:87], a[16:19], v[152:155]
buffer_load_dwordx4 v23, s[44:47], s22 offen lds
v_mfma_f32_16x16x32_bf16 v[160:163], a[84:87], a[20:23], v[160:163]
ds_read_b64_tr_b16 a[106:107], v15 offset:4352
v_mfma_f32_16x16x32_bf16 v[160:163], a[80:83], a[4:7], v[160:163]
ds_read_b64_tr_b16 a[108:109], v15 offset:6144
v_mfma_f32_16x16x32_bf16 v[168:171], a[80:83], a[8:11], v[168:171]
ds_read_b64_tr_b16 a[110:111], v15 offset:6400
v_mfma_f32_16x16x32_bf16 v[168:171], a[84:87], a[24:27], v[168:171]
v_mfma_f32_16x16x32_bf16 v[176:179], a[84:87], a[28:31], v[176:179]
s_add_u32 m0, s16, 0x9800
v_mfma_f32_16x16x32_bf16 v[176:179], a[80:83], a[12:15], v[176:179]
buffer_load_dwordx4 v22, s[44:47], s23 offen lds
v_mfma_f32_16x16x32_bf16 v[180:183], a[88:91], a[12:15], v[180:183]
ds_read_b64_tr_b16 a[80:81], v14 offset:8192
v_mfma_f32_16x16x32_bf16 v[180:183], a[92:95], a[28:31], v[180:183]
ds_read_b64_tr_b16 a[82:83], v14 offset:8448
v_mfma_f32_16x16x32_bf16 v[172:175], a[92:95], a[24:27], v[172:175]
ds_read_b64_tr_b16 a[84:85], v14 offset:10240
v_mfma_f32_16x16x32_bf16 v[172:175], a[88:91], a[8:11], v[172:175]
ds_read_b64_tr_b16 a[86:87], v14 offset:10496
s_add_u32 m0, s16, 0x9c00
v_mfma_f32_16x16x32_bf16 v[164:167], a[88:91], a[4:7], v[164:167]
buffer_load_dwordx4 v23, s[44:47], s23 offen lds
v_mfma_f32_16x16x32_bf16 v[164:167], a[92:95], a[20:23], v[164:167]
v_lshl_add_u32 v22, s42, 7, v22
v_lshl_add_u32 v23, s42, 7, v23
v_mfma_f32_16x16x32_bf16 v[156:159], a[92:95], a[16:19], v[156:159]
v_mfma_f32_16x16x32_bf16 v[156:159], a[88:91], a[0:3], v[156:159]
s_waitcnt lgkmcnt(4)
v_mfma_f32_16x16x32_bf16 v[184:187], a[96:99], a[0:3], v[184:187]
ds_read_b64_tr_b16 a[88:89], v15 offset:8192
v_mfma_f32_16x16x32_bf16 v[184:187], a[100:103], a[16:19], v[184:187]
ds_read_b64_tr_b16 a[90:91], v15 offset:8448
s_add_u32 s8, s28, 0x8800
v_mfma_f32_16x16x32_bf16 v[192:195], a[100:103], a[20:23], v[192:195]
buffer_store_dwordx4 a[212:215], v16, s[88:91], s8 offen sc1
v_mfma_f32_16x16x32_bf16 v[192:195], a[96:99], a[4:7], v[192:195]
ds_read_b64_tr_b16 a[92:93], v15 offset:10240
v_mfma_f32_16x16x32_bf16 v[200:203], a[96:99], a[8:11], v[200:203]
ds_read_b64_tr_b16 a[94:95], v15 offset:10496
v_add_u32 v12, 0xffff0000, v12
v_mfma_f32_16x16x32_bf16 v[200:203], a[100:103], a[24:27], v[200:203]
v_add_u32 v13, 0xffff0000, v13
v_add_u32 v14, 0xffff0000, v14
v_mfma_f32_16x16x32_bf16 v[208:211], a[100:103], a[28:31], v[208:211]
v_add_u32 v15, 0xffff0000, v15
v_mfma_f32_16x16x32_bf16 v[208:211], a[96:99], a[12:15], v[208:211]
v_mfma_f32_16x16x32_bf16 v[212:215], a[104:107], a[12:15], v[212:215]
s_waitcnt vmcnt(28) lgkmcnt(0)
v_mfma_f32_16x16x32_bf16 v[212:215], a[108:111], a[28:31], v[212:215]
s_barrier
s_add_u32 m0, s17, 0x10000
v_mfma_f32_16x16x32_bf16 v[204:207], a[108:111], a[24:27], v[204:207]
buffer_load_dwordx4 v5, s[52:55], 0 offen lds
v_mfma_f32_16x16x32_bf16 v[204:207], a[104:107], a[8:11], v[204:207]
ds_read_b64_tr_b16 a[96:97], v12 offset:0
v_mfma_f32_16x16x32_bf16 v[196:199], a[104:107], a[4:7], v[196:199]
ds_read_b64_tr_b16 a[98:99], v12 offset:1024
v_mfma_f32_16x16x32_bf16 v[196:199], a[108:111], a[20:23], v[196:199]
ds_read_b64_tr_b16 a[100:101], v12 offset:8192
v_mfma_f32_16x16x32_bf16 v[188:191], a[108:111], a[16:19], v[188:191]
ds_read_b64_tr_b16 a[102:103], v12 offset:9216
v_mfma_f32_16x16x32_bf16 v[188:191], a[104:107], a[0:3], v[188:191]
s_add_u32 m0, s17, 0x10400
s_waitcnt lgkmcnt(4)
v_mfma_f32_16x16x32_bf16 v[216:219], a[0:3], a[80:83], v[216:219]
buffer_load_dwordx4 v5, s[52:55], s13 offen lds
v_mfma_f32_16x16x32_bf16 v[216:219], a[16:19], a[84:87], v[216:219]
ds_read_b64_tr_b16 a[104:105], v13 offset:0
v_mfma_f32_16x16x32_bf16 v[224:227], a[20:23], a[84:87], v[224:227]
ds_read_b64_tr_b16 a[106:107], v13 offset:1024
v_mfma_f32_16x16x32_bf16 v[224:227], a[4:7], a[80:83], v[224:227]
ds_read_b64_tr_b16 a[108:109], v13 offset:8192
v_mfma_f32_16x16x32_bf16 v[232:235], a[8:11], a[80:83], v[232:235]
ds_read_b64_tr_b16 a[110:111], v13 offset:9216
v_mfma_f32_16x16x32_bf16 v[232:235], a[24:27], a[84:87], v[232:235]
v_mfma_f32_16x16x32_bf16 v[240:243], a[28:31], a[84:87], v[240:243]
s_add_u32 m0, s17, 0x10800
v_mfma_f32_16x16x32_bf16 v[240:243], a[12:15], a[80:83], v[240:243]
buffer_load_dwordx4 v6, s[52:55], 0 offen lds
v_mfma_f32_16x16x32_bf16 v[244:247], a[12:15], a[88:91], v[244:247]
ds_read_b64_tr_b16 a[80:81], v12 offset:256
v_mfma_f32_16x16x32_bf16 v[244:247], a[28:31], a[92:95], v[244:247]
ds_read_b64_tr_b16 a[82:83], v12 offset:1280
v_mfma_f32_16x16x32_bf16 v[236:239], a[24:27], a[92:95], v[236:239]
ds_read_b64_tr_b16 a[84:85], v12 offset:8448
v_mfma_f32_16x16x32_bf16 v[236:239], a[8:11], a[88:91], v[236:239]
ds_read_b64_tr_b16 a[86:87], v12 offset:9472
v_mfma_f32_16x16x32_bf16 v[228:231], a[4:7], a[88:91], v[228:231]
v_mfma_f32_16x16x32_bf16 v[228:231], a[20:23], a[92:95], v[228:231]
s_add_u32 m0, s17, 0x10c00
v_mfma_f32_16x16x32_bf16 v[220:223], a[16:19], a[92:95], v[220:223]
buffer_load_dwordx4 v6, s[52:55], s13 offen lds
v_mfma_f32_16x16x32_bf16 v[220:223], a[0:3], a[88:91], v[220:223]
s_waitcnt lgkmcnt(4)
L_S15:
v_mfma_f32_16x16x32_bf16 v[24:27], a[96:99], a[32:35], v[24:27]
ds_read_b64_tr_b16 a[88:89], v13 offset:256
s_waitcnt vmcnt(23)
v_mfma_f32_16x16x32_bf16 v[24:27], a[100:103], a[48:51], v[24:27]
ds_read_b64_tr_b16 a[90:91], v13 offset:1280
v_mfma_f32_16x16x32_bf16 v[32:35], a[100:103], a[52:55], v[32:35]
ds_read_b64_tr_b16 a[92:93], v13 offset:8448
v_mfma_f32_16x16x32_bf16 v[32:35], a[96:99], a[36:39], v[32:35]
ds_read_b64_tr_b16 a[94:95], v13 offset:9472
v_mfma_f32_16x16x32_bf16 v[40:43], a[96:99], a[40:43], v[40:43]
ds_read_b128 a[0:3], v8 offset:0
s_add_u32 m0, s18, 0x14000
v_mfma_f32_16x16x32_bf16 v[40:43], a[100:103], a[56:59], v[40:43]
buffer_load_dwordx4 v7, s[68:71], 0 offen lds
v_mfma_f32_16x16x32_bf16 v[48:51], a[100:103], a[60:63], v[48:51]
ds_read_b128 a[16:19], v9 offset:0
v_mfma_f32_16x16x32_bf16 v[48:51], a[96:99], a[44:47], v[48:51]
ds_read_b128 a[4:7], v8 offset:2048
v_mfma_f32_16x16x32_bf16 v[52:55], a[104:107], a[44:47], v[52:55]
ds_read_b64_tr_b16 a[96:97], v12 offset:512
v_mfma_f32_16x16x32_bf16 v[52:55], a[108:111], a[60:63], v[52:55]
ds_read_b64_tr_b16 a[98:99], v12 offset:1536
v_mfma_f32_16x16x32_bf16 v[44:47], a[108:111], a[56:59], v[44:47]
ds_read_b64_tr_b16 a[100:101], v12 offset:8704
s_add_u32 s8, s28, 0x4c00
v_mfma_f32_16x16x32_bf16 v[44:47], a[104:107], a[40:43], v[44:47]
buffer_store_dwordx4 a[216:219], v16, s[88:91], s8 offen sc1
v_mfma_f32_16x16x32_bf16 v[36:39], a[104:107], a[36:39], v[36:39]
ds_read_b64_tr_b16 a[102:103], v12 offset:9728
v_mfma_f32_16x16x32_bf16 v[36:39], a[108:111], a[52:55], v[36:39]
ds_read_b128 a[20:23], v9 offset:2048
v_mfma_f32_16x16x32_bf16 v[28:31], a[108:111], a[48:51], v[28:31]
ds_read_b128 a[8:11], v8 offset:4096
v_mfma_f32_16x16x32_bf16 v[28:31], a[104:107], a[32:35], v[28:31]
ds_read_b128 a[24:27], v9 offset:4096
s_waitcnt lgkmcnt(10)
v_mfma_f32_16x16x32_bf16 v[56:59], a[80:83], a[32:35], v[56:59]
ds_read_b64_tr_b16 a[104:105], v13 offset:512
v_mfma_f32_16x16x32_bf16 v[56:59], a[84:87], a[48:51], v[56:59]
ds_read_b64_tr_b16 a[106:107], v13 offset:1536
s_add_u32 m0, s18, 0x15000
v_mfma_f32_16x16x32_bf16 v[64:67], a[84:87], a[52:55], v[64:67]
buffer_load_dwordx4 v7, s[68:71], s25 offen lds
v_mfma_f32_16x16x32_bf16 v[64:67], a[80:83], a[36:39], v[64:67]
ds_read_b64_tr_b16 a[108:109], v13 offset:8704
v_mfma_f32_16x16x32_bf16 v[72:75], a[80:83], a[40:43], v[72:75]
ds_read_b64_tr_b16 a[110:111], v13 offset:9728
v_mfma_f32_16x16x32_bf16 v[72:75], a[84:87], a[56:59], v[72:75]
ds_read_b128 a[12:15], v8 offset:6144
v_mfma_f32_16x16x32_bf16 v[80:83], a[84:87], a[60:63], v[80:83]
ds_read_b128 a[28:31], v9 offset:6144
v_mfma_f32_16x16x32_bf16 v[80:83], a[80:83], a[44:47], v[80:83]
v_mfma_f32_16x16x32_bf16 v[84:87], a[88:91], a[44:47], v[84:87]
ds_read_b64_tr_b16 a[80:81], v12 offset:768
s_add_u32 m0, s18, 0x16000
v_mfma_f32_16x16x32_bf16 v[84:87], a[92:95], a[60:63], v[84:87]
buffer_load_dwordx4 v7, s[68:71], s26 offen lds
v_mfma_f32_16x16x32_bf16 v[76:79], a[92:95], a[56:59], v[76:79]
ds_read_b64_tr_b16 a[82:83], v12 offset:1792
v_lshl_add_u32 v5, s42, 19, v5
v_mfma_f32_16x16x32_bf16 v[76:79], a[88:91], a[40:43], v[76:79]
ds_read_b64_tr_b16 a[84:85], v12 offset:8960
v_lshl_add_u32 v6, s42, 19, v6
v_mfma_f32_16x16x32_bf16 v[68:71], a[88:91], a[36:39], v[68:71]
ds_read_b64_tr_b16 a[86:87], v12 offset:9984
v_lshl_add_u32 v7, s42, 18, v7
v_mfma_f32_16x16x32_bf16 v[68:71], a[92:95], a[52:55], v[68:71]
v_lshl_add_u32 v7, s42, 17, v7
v_mfma_f32_16x16x32_bf16 v[60:63], a[92:95], a[48:51], v[60:63]
v_mfma_f32_16x16x32_bf16 v[60:63], a[88:91], a[32:35], v[60:63]
s_add_u32 m0, s16, 0x0
s_waitcnt lgkmcnt(4)
s_waitcnt lgkmcnt(6)
v_mfma_f32_16x16x32_bf16 v[88:91], a[96:99], a[32:35], v[88:91]
buffer_load_dwordx4 v22, s[44:47], s20 offen lds
v_mfma_f32_16x16x32_bf16 v[88:91], a[100:103], a[48:51], v[88:91]
ds_read_b64_tr_b16 a[88:89], v13 offset:768
v_mfma_f32_16x16x32_bf16 v[96:99], a[100:103], a[52:55], v[96:99]
ds_read_b64_tr_b16 a[90:91], v13 offset:1792
v_mfma_f32_16x16x32_bf16 v[96:99], a[96:99], a[36:39], v[96:99]
ds_read_b64_tr_b16 a[92:93], v13 offset:8960
v_mfma_f32_16x16x32_bf16 v[104:107], a[96:99], a[40:43], v[104:107]
ds_read_b64_tr_b16 a[94:95], v13 offset:9984
s_add_u32 m0, s16, 0x400
v_mfma_f32_16x16x32_bf16 v[104:107], a[100:103], a[56:59], v[104:107]
buffer_load_dwordx4 v23, s[44:47], s20 offen lds
v_mfma_f32_16x16x32_bf16 v[112:115], a[100:103], a[60:63], v[112:115]
v_mfma_f32_16x16x32_bf16 v[112:115], a[96:99], a[44:47], v[112:115]
v_mfma_f32_16x16x32_bf16 v[116:119], a[104:107], a[44:47], v[116:119]
ds_read_b64_tr_b16 a[96:97], v14 offset:0
v_mfma_f32_16x16x32_bf16 v[116:119], a[108:111], a[60:63], v[116:119]
ds_read_b64_tr_b16 a[98:99], v14 offset:256
v_mfma_f32_16x16x32_bf16 v[108:111], a[108:111], a[56:59], v[108:111]
ds_read_b64_tr_b16 a[100:101], v14 offset:2048
s_add_u32 m0, s16, 0x800
v_mfma_f32_16x16x32_bf16 v[108:111], a[104:107], a[40:43], v[108:111]
buffer_load_dwordx4 v22, s[44:47], s21 offen lds
v_mfma_f32_16x16x32_bf16 v[100:103], a[104:107], a[36:39], v[100:103]
ds_read_b64_tr_b16 a[102:103], v14 offset:2304
v_mfma_f32_16x16x32_bf16 v[100:103], a[108:111], a[52:55], v[100:103]
v_mfma_f32_16x16x32_bf16 v[92:95], a[108:111], a[48:51], v[92:95]
v_mfma_f32_16x16x32_bf16 v[92:95], a[104:107], a[32:35], v[92:95]
s_add_u32 s8, s28, 0x8c00
s_waitcnt lgkmcnt(4)
v_mfma_f32_16x16x32_bf16 v[120:123], a[80:83], a[32:35], v[120:123]
buffer_store_dwordx4 a[220:223], v16, s[88:91], s8 offen sc1
v_mfma_f32_16x16x32_bf16 v[120:123], a[84:87], a[48:51], v[120:123]
ds_read_b64_tr_b16 a[104:105], v15 offset:0
v_mfma_f32_16x16x32_bf16 v[128:131], a[84:87], a[52:55], v[128:131]
ds_read_b64_tr_b16 a[106:107], v15 offset:256
v_mfma_f32_16x16x32_bf16 v[128:131], a[80:83], a[36:39], v[128:131]
ds_read_b64_tr_b16 a[108:109], v15 offset:2048
v_mfma_f32_16x16x32_bf16 v[136:139], a[80:83], a[40:43], v[136:139]
ds_read_b64_tr_b16 a[110:111], v15 offset:2304
v_mfma_f32_16x16x32_bf16 v[136:139], a[84:87], a[56:59], v[136:139]
s_add_u32 m0, s16, 0xc00
v_mfma_f32_16x16x32_bf16 v[144:147], a[84:87], a[60:63], v[144:147]
buffer_load_dwordx4 v23, s[44:47], s21 offen lds
v_mfma_f32_16x16x32_bf16 v[144:147], a[80:83], a[44:47], v[144:147]
v_mfma_f32_16x16x32_bf16 v[148:151], a[88:91], a[44:47], v[148:151]
ds_read_b64_tr_b16 a[80:81], v14 offset:4096
v_mfma_f32_16x16x32_bf16 v[148:151], a[92:95], a[60:63], v[148:151]
ds_read_b64_tr_b16 a[82:83], v14 offset:4352
v_mfma_f32_16x16x32_bf16 v[140:143], a[92:95], a[56:59], v[140:143]
ds_read_b64_tr_b16 a[84:85], v14 offset:6144
v_mfma_f32_16x16x32_bf16 v[140:143], a[88:91], a[40:43], v[140:143]
ds_read_b64_tr_b16 a[86:87], v14 offset:6400
s_add_u32 m0, s16, 0x1000
v_mfma_f32_16x16x32_bf16 v[132:135], a[88:91], a[36:39], v[132:135]
buffer_load_dwordx4 v22, s[44:47], s22 offen lds
v_mfma_f32_16x16x32_bf16 v[132:135], a[92:95], a[52:55], v[132:135]
v_mfma_f32_16x16x32_bf16 v[124:127], a[92:95], a[48:51], v[124:127]
v_mfma_f32_16x16x32_bf16 v[124:127], a[88:91], a[32:35], v[124:127]
s_waitcnt lgkmcnt(4)
v_mfma_f32_16x16x32_bf16 v[152:155], a[96:99], a[32:35], v[152:155]
ds_read_b64_tr_b16 a[88:89], v15 offset:4096
s_add_u32 m0, s16, 0x1400
v_mfma_f32_16x16x32_bf16 v[152:155], a[100:103], a[48:51], v[152:155]
buffer_load_dwordx4 v23, s[44:47], s22 offen lds
v_mfma_f32_16x16x32_bf16 v[160:163], a[100:103], a[52:55], v[160:163]
ds_read_b64_tr_b16 a[90:91], v15 offset:4352
v_mfma_f32_16x16x32_bf16 v[160:163], a[96:99], a[36:39], v[160:163]
ds_read_b64_tr_b16 a[92:93], v15 offset:6144
v_mfma_f32_16x16x32_bf16 v[168:171], a[96:99], a[40:43], v[168:171]
ds_read_b64_tr_b16 a[94:95], v15 offset:6400
v_mfma_f32_16x16x32_bf16 v[168:171], a[100:103], a[56:59], v[168:171]
v_mfma_f32_16x16x32_bf16 v[176:179], a[100:103], a[60:63], v[176:179]
s_add_u32 m0, s16, 0x1800
v_mfma_f32_16x16x32_bf16 v[176:179], a[96:99], a[44:47], v[176:179]
buffer_load_dwordx4 v22, s[44:47], s23 offen lds
v_mfma_f32_16x16x32_bf16 v[180:183], a[104:107], a[44:47], v[180:183]
ds_read_b64_tr_b16 a[96:97], v14 offset:8192
v_mfma_f32_16x16x32_bf16 v[180:183], a[108:111], a[60:63], v[180:183]
ds_read_b64_tr_b16 a[98:99], v14 offset:8448
v_mfma_f32_16x16x32_bf16 v[172:175], a[108:111], a[56:59], v[172:175]
ds_read_b64_tr_b16 a[100:101], v14 offset:10240
v_mfma_f32_16x16x32_bf16 v[172:175], a[104:107], a[40:43], v[172:175]
ds_read_b64_tr_b16 a[102:103], v14 offset:10496
s_add_u32 m0, s16, 0x1c00
v_mfma_f32_16x16x32_bf16 v[164:167], a[104:107], a[36:39], v[164:167]
buffer_load_dwordx4 v23, s[44:47], s23 offen lds
v_mfma_f32_16x16x32_bf16 v[164:167], a[108:111], a[52:55], v[164:167]
v_lshl_add_u32 v22, s42, 7, v22
v_lshl_add_u32 v23, s42, 7, v23
v_mfma_f32_16x16x32_bf16 v[156:159], a[108:111], a[48:51], v[156:159]
v_mfma_f32_16x16x32_bf16 v[156:159], a[104:107], a[32:35], v[156:159]
s_waitcnt lgkmcnt(4)
v_mfma_f32_16x16x32_bf16 v[184:187], a[80:83], a[32:35], v[184:187]
ds_read_b64_tr_b16 a[104:105], v15 offset:8192
v_mfma_f32_16x16x32_bf16 v[184:187], a[84:87], a[48:51], v[184:187]
ds_read_b64_tr_b16 a[106:107], v15 offset:8448
s_add_u32 s8, s28, 0x5000
v_mfma_f32_16x16x32_bf16 v[192:195], a[84:87], a[52:55], v[192:195]
buffer_store_dwordx4 a[224:227], v16, s[88:91], s8 offen sc1
v_mfma_f32_16x16x32_bf16 v[192:195], a[80:83], a[36:39], v[192:195]
ds_read_b64_tr_b16 a[108:109], v15 offset:10240
v_mfma_f32_16x16x32_bf16 v[200:203], a[80:83], a[40:43], v[200:203]
ds_read_b64_tr_b16 a[110:111], v15 offset:10496
v_add_u32 v12, 0x8000, v12
v_mfma_f32_16x16x32_bf16 v[200:203], a[84:87], a[56:59], v[200:203]
v_add_u32 v13, 0x8000, v13
v_add_u32 v14, 0x8000, v14
v_mfma_f32_16x16x32_bf16 v[208:211], a[84:87], a[60:63], v[208:211]
L_padA8:
s_cmp_eq_u32 s95, 1
s_cbranch_scc1 L_padA12
v_add_u32 v15, 0x8000, v15
v_mfma_f32_16x16x32_bf16 v[208:211], a[80:83], a[44:47], v[208:211]
v_mfma_f32_16x16x32_bf16 v[212:215], a[88:91], a[44:47], v[212:215]
s_waitcnt vmcnt(28) lgkmcnt(0)
v_mfma_f32_16x16x32_bf16 v[212:215], a[92:95], a[60:63], v[212:215]
s_barrier
s_add_u32 m0, s17, 0x0
v_mfma_f32_16x16x32_bf16 v[204:207], a[92:95], a[56:59], v[204:207]
buffer_load_dwordx4 v5, s[52:55], 0 offen lds
v_mfma_f32_16x16x32_bf16 v[204:207], a[88:91], a[40:43], v[204:207]
ds_read_b64_tr_b16 a[80:81], v12 offset:0
v_mfma_f32_16x16x32_bf16 v[196:199], a[88:91], a[36:39], v[196:199]
ds_read_b64_tr_b16 a[82:83], v12 offset:1024
v_mfma_f32_16x16x32_bf16 v[196:199], a[92:95], a[52:55], v[196:199]
ds_read_b64_tr_b16 a[84:85], v12 offset:8192
v_mfma_f32_16x16x32_bf16 v[188:191], a[92:95], a[48:51], v[188:191]
ds_read_b64_tr_b16 a[86:87], v12 offset:9216
v_mfma_f32_16x16x32_bf16 v[188:191], a[88:91], a[32:35], v[188:191]
s_add_u32 m0, s17, 0x400
s_waitcnt lgkmcnt(4)
v_mfma_f32_16x16x32_bf16 v[216:219], a[32:35], a[96:99], v[216:219]
buffer_load_dwordx4 v5, s[52:55], s13 offen lds
v_mfma_f32_16x16x32_bf16 v[216:219], a[48:51], a[100:103], v[216:219]
ds_read_b64_tr_b16 a[88:89], v13 offset:0
v_mfma_f32_16x16x32_bf16 v[224:227], a[52:55], a[100:103], v[224:227]
ds_read_b64_tr_b16 a[90:91], v13 offset:1024
v_mfma_f32_16x16x32_bf16 v[224:227], a[36:39], a[96:99], v[224:227]
ds_read_b64_tr_b16 a[92:93], v13 offset:8192
v_mfma_f32_16x16x32_bf16 v[232:235], a[40:43], a[96:99], v[232:235]
ds_read_b64_tr_b16 a[94:95], v13 offset:9216
v_mfma_f32_16x16x32_bf16 v[232:235], a[56:59], a[100:103], v[232:235]
v_mfma_f32_16x16x32_bf16 v[240:243], a[60:63], a[100:103], v[240:243]
s_add_u32 m0, s17, 0x800
v_mfma_f32_16x16x32_bf16 v[240:243], a[44:47], a[96:99], v[240:243]
buffer_load_dwordx4 v6, s[52:55], 0 offen lds
v_mfma_f32_16x16x32_bf16 v[244:247], a[44:47], a[104:107], v[244:247]
ds_read_b64_tr_b16 a[96:97], v12 offset:256
v_mfma_f32_16x16x32_bf16 v[244:247], a[60:63], a[108:111], v[244:247]
ds_read_b64_tr_b16 a[98:99], v12 offset:1280
v_mfma_f32_16x16x32_bf16 v[236:239], a[56:59], a[108:111], v[236:239]
ds_read_b64_tr_b16 a[100:101], v12 offset:8448
v_mfma_f32_16x16x32_bf16 v[236:239], a[40:43], a[104:107], v[236:239]
ds_read_b64_tr_b16 a[102:103], v12 offset:9472
v_mfma_f32_16x16x32_bf16 v[228:231], a[36:39], a[104:107], v[228:231]
v_mfma_f32_16x16x32_bf16 v[228:231], a[52:55], a[108:111], v[228:231]
s_add_u32 m0, s17, 0xc00
v_mfma_f32_16x16x32_bf16 v[220:223], a[48:51], a[108:111], v[220:223]
buffer_load_dwordx4 v6, s[52:55], s13 offen lds
v_mfma_f32_16x16x32_bf16 v[220:223], a[32:35], a[104:107], v[220:223]
s_waitcnt lgkmcnt(4)
L_S16:
v_mfma_f32_16x16x32_bf16 v[24:27], a[80:83], a[0:3], v[24:27]
ds_read_b64_tr_b16 a[104:105], v13 offset:256
s_waitcnt vmcnt(23)
v_mfma_f32_16x16x32_bf16 v[24:27], a[84:87], a[16:19], v[24:27]
ds_read_b64_tr_b16 a[106:107], v13 offset:1280
v_mfma_f32_16x16x32_bf16 v[32:35], a[84:87], a[20:23], v[32:35]
ds_read_b64_tr_b16 a[108:109], v13 offset:8448
v_mfma_f32_16x16x32_bf16 v[32:35], a[80:83], a[4:7], v[32:35]
ds_read_b64_tr_b16 a[110:111], v13 offset:9472
v_mfma_f32_16x16x32_bf16 v[40:43], a[80:83], a[8:11], v[40:43]
ds_read_b128 a[32:35], v8 offset:32768
s_add_u32 m0, s18, 0x4000
v_mfma_f32_16x16x32_bf16 v[40:43], a[84:87], a[24:27], v[40:43]
buffer_load_dwordx4 v7, s[68:71], 0 offen lds
v_mfma_f32_16x16x32_bf16 v[48:51], a[84:87], a[28:31], v[48:51]
ds_read_b128 a[48:51], v9 offset:32768
v_mfma_f32_16x16x32_bf16 v[48:51], a[80:83], a[12:15], v[48:51]
ds_read_b128 a[36:39], v8 offset:34816
v_mfma_f32_16x16x32_bf16 v[52:55], a[88:91], a[12:15], v[52:55]
ds_read_b64_tr_b16 a[80:81], v12 offset:512
v_mfma_f32_16x16x32_bf16 v[52:55], a[92:95], a[28:31], v[52:55]
ds_read_b64_tr_b16 a[82:83], v12 offset:1536
v_mfma_f32_16x16x32_bf16 v[44:47], a[92:95], a[24:27], v[44:47]
ds_read_b64_tr_b16 a[84:85], v12 offset:8704
s_add_u32 s8, s28, 0x9000
v_mfma_f32_16x16x32_bf16 v[44:47], a[88:91], a[8:11], v[44:47]
buffer_store_dwordx4 a[228:231], v16, s[88:91], s8 offen sc1
v_mfma_f32_16x16x32_bf16 v[36:39], a[88:91], a[4:7], v[36:39]
ds_read_b64_tr_b16 a[86:87], v12 offset:9728
v_mfma_f32_16x16x32_bf16 v[36:39], a[92:95], a[20:23], v[36:39]
ds_read_b128 a[52:55], v9 offset:34816
v_mfma_f32_16x16x32_bf16 v[28:31], a[92:95], a[16:19], v[28:31]
ds_read_b128 a[40:43], v8 offset:36864
v_mfma_f32_16x16x32_bf16 v[28:31], a[88:91], a[0:3], v[28:31]
ds_read_b128 a[56:59], v9 offset:36864
s_waitcnt lgkmcnt(10)
v_mfma_f32_16x16x32_bf16 v[56:59], a[96:99], a[0:3], v[56:59]
ds_read_b64_tr_b16 a[88:89], v13 offset:512
v_mfma_f32_16x16x32_bf16 v[56:59], a[100:103], a[16:19], v[56:59]
ds_read_b64_tr_b16 a[90:91], v13 offset:1536
s_add_u32 m0, s18, 0x5000
v_mfma_f32_16x16x32_bf16 v[64:67], a[100:103], a[20:23], v[64:67]
buffer_load_dwordx4 v7, s[68:71], s25 offen lds
v_mfma_f32_16x16x32_bf16 v[64:67], a[96:99], a[4:7], v[64:67]
ds_read_b64_tr_b16 a[92:93], v13 offset:8704
v_mfma_f32_16x16x32_bf16 v[72:75], a[96:99], a[8:11], v[72:75]
ds_read_b64_tr_b16 a[94:95], v13 offset:9728
v_mfma_f32_16x16x32_bf16 v[72:75], a[100:103], a[24:27], v[72:75]
ds_read_b128 a[44:47], v8 offset:38912
v_mfma_f32_16x16x32_bf16 v[80:83], a[100:103], a[28:31], v[80:83]
ds_read_b128 a[60:63], v9 offset:38912
v_mfma_f32_16x16x32_bf16 v[80:83], a[96:99], a[12:15], v[80:83]
v_mfma_f32_16x16x32_bf16 v[84:87], a[104:107], a[12:15], v[84:87]
ds_read_b64_tr_b16 a[96:97], v12 offset:768
s_add_u32 m0, s18, 0x6000
v_mfma_f32_16x16x32_bf16 v[84:87], a[108:111], a[28:31], v[84:87]
buffer_load_dwordx4 v7, s[68:71], s26 offen lds
v_mfma_f32_16x16x32_bf16 v[76:79], a[108:111], a[24:27], v[76:79]
ds_read_b64_tr_b16 a[98:99], v12 offset:1792
v_lshl_add_u32 v5, s42, 19, v5
v_mfma_f32_16x16x32_bf16 v[76:79], a[104:107], a[8:11], v[76:79]
ds_read_b64_tr_b16 a[100:101], v12 offset:8960
v_lshl_add_u32 v6, s42, 19, v6
v_mfma_f32_16x16x32_bf16 v[68:71], a[104:107], a[4:7], v[68:71]
ds_read_b64_tr_b16 a[102:103], v12 offset:9984
v_lshl_add_u32 v7, s42, 18, v7
v_mfma_f32_16x16x32_bf16 v[68:71], a[108:111], a[20:23], v[68:71]
v_lshl_add_u32 v7, s42, 17, v7
v_mfma_f32_16x16x32_bf16 v[60:63], a[108:111], a[16:19], v[60:63]
v_mfma_f32_16x16x32_bf16 v[60:63], a[104:107], a[0:3], v[60:63]
s_add_u32 m0, s16, 0x8000
s_waitcnt lgkmcnt(4)
s_waitcnt lgkmcnt(6)
v_mfma_f32_16x16x32_bf16 v[88:91], a[80:83], a[0:3], v[88:91]
buffer_load_dwordx4 v22, s[44:47], s20 offen lds
v_mfma_f32_16x16x32_bf16 v[88:91], a[84:87], a[16:19], v[88:91]
ds_read_b64_tr_b16 a[104:105], v13 offset:768
v_mfma_f32_16x16x32_bf16 v[96:99], a[84:87], a[20:23], v[96:99]
ds_read_b64_tr_b16 a[106:107], v13 offset:1792
v_mfma_f32_16x16x32_bf16 v[96:99], a[80:83], a[4:7], v[96:99]
ds_read_b64_tr_b16 a[108:109], v13 offset:8960
v_mfma_f32_16x16x32_bf16 v[104:107], a[80:83], a[8:11], v[104:107]
ds_read_b64_tr_b16 a[110:111], v13 offset:9984
s_add_u32 m0, s16, 0x8400
v_mfma_f32_16x16x32_bf16 v[104:107], a[84:87], a[24:27], v[104:107]
buffer_load_dwordx4 v23, s[44:47], s20 offen lds
v_mfma_f32_16x16x32_bf16 v[112:115], a[84:87], a[28:31], v[112:115]
v_mfma_f32_16x16x32_bf16 v[112:115], a[80:83], a[12:15], v[112:115]
v_mfma_f32_16x16x32_bf16 v[116:119], a[88:91], a[12:15], v[116:119]
ds_read_b64_tr_b16 a[80:81], v14 offset:0
v_mfma_f32_16x16x32_bf16 v[116:119], a[92:95], a[28:31], v[116:119]
ds_read_b64_tr_b16 a[82:83], v14 offset:256
v_mfma_f32_16x16x32_bf16 v[108:111], a[92:95], a[24:27], v[108:111]
ds_read_b64_tr_b16 a[84:85], v14 offset:2048
s_add_u32 m0, s16, 0x8800
v_mfma_f32_16x16x32_bf16 v[108:111], a[88:91], a[8:11], v[108:111]
buffer_load_dwordx4 v22, s[44:47], s21 offen lds
v_mfma_f32_16x16x32_bf16 v[100:103], a[88:91], a[4:7], v[100:103]
ds_read_b64_tr_b16 a[86:87], v14 offset:2304
v_mfma_f32_16x16x32_bf16 v[100:103], a[92:95], a[20:23], v[100:103]
v_mfma_f32_16x16x32_bf16 v[92:95], a[92:95], a[16:19], v[92:95]
v_mfma_f32_16x16x32_bf16 v[92:95], a[88:91], a[0:3], v[92:95]
s_add_u32 s8, s28, 0x5400
s_waitcnt lgkmcnt(4)
v_mfma_f32_16x16x32_bf16 v[120:123], a[96:99], a[0:3], v[120:123]
buffer_store_dwordx4 a[112:115], v16, s[88:91], s8 offen sc1
v_mfma_f32_16x16x32_bf16 v[120:123], a[100:103], a[16:19], v[120:123]
ds_read_b64_tr_b16 a[88:89], v15 offset:0
v_mfma_f32_16x16x32_bf16 v[128:131], a[100:103], a[20:23], v[128:131]
ds_read_b64_tr_b16 a[90:91], v15 offset:256
v_mfma_f32_16x16x32_bf16 v[128:131], a[96:99], a[4:7], v[128:131]
ds_read_b64_tr_b16 a[92:93], v15 offset:2048
v_mfma_f32_16x16x32_bf16 v[136:139], a[96:99], a[8:11], v[136:139]
ds_read_b64_tr_b16 a[94:95], v15 offset:2304
v_mfma_f32_16x16x32_bf16 v[136:139], a[100:103], a[24:27], v[136:139]
s_add_u32 m0, s16, 0x8c00
v_mfma_f32_16x16x32_bf16 v[144:147], a[100:103], a[28:31], v[144:147]
buffer_load_dwordx4 v23, s[44:47], s21 offen lds
v_mfma_f32_16x16x32_bf16 v[144:147], a[96:99], a[12:15], v[144:147]
v_mfma_f32_16x16x32_bf16 v[148:151], a[104:107], a[12:15], v[148:151]
ds_read_b64_tr_b16 a[96:97], v14 offset:4096
v_mfma_f32_16x16x32_bf16 v[148:151], a[108:111], a[28:31], v[148:151]
ds_read_b64_tr_b16 a[98:99], v14 offset:4352
v_mfma_f32_16x16x32_bf16 v[140:143], a[108:111], a[24:27], v[140:143]
ds_read_b64_tr_b16 a[100:101], v14 offset:6144
v_mfma_f32_16x16x32_bf16 v[140:143], a[104:107], a[8:11], v[140:143]
ds_read_b64_tr_b16 a[102:103], v14 offset:6400
s_add_u32 m0, s16, 0x9000
v_mfma_f32_16x16x32_bf16 v[132:135], a[104:107], a[4:7], v[132:135]
buffer_load_dwordx4 v22, s[44:47], s22 offen lds
v_mfma_f32_16x16x32_bf16 v[132:135], a[108:111], a[20:23], v[132:135]
v_mfma_f32_16x16x32_bf16 v[124:127], a[108:111], a[16:19], v[124:127]
v_mfma_f32_16x16x32_bf16 v[124:127], a[104:107], a[0:3], v[124:127]
s_waitcnt lgkmcnt(4)
v_mfma_f32_16x16x32_bf16 v[152:155], a[80:83], a[0:3], v[152:155]
ds_read_b64_tr_b16 a[104:105], v15 offset:4096
s_add_u32 m0, s16, 0x9400
v_mfma_f32_16x16x32_bf16 v[152:155], a[84:87], a[16:19], v[152:155]
buffer_load_dwordx4 v23, s[44:47], s22 offen lds
v_mfma_f32_16x16x32_bf16 v[160:163], a[84:87], a[20:23], v[160:163]
ds_read_b64_tr_b16 a[106:107], v15 offset:4352
v_mfma_f32_16x16x32_bf16 v[160:163], a[80:83], a[4:7], v[160:163]
ds_read_b64_tr_b16 a[108:109], v15 offset:6144
v_mfma_f32_16x16x32_bf16 v[168:171], a[80:83], a[8:11], v[168:171]
ds_read_b64_tr_b16 a[110:111], v15 offset:6400
v_mfma_f32_16x16x32_bf16 v[168:171], a[84:87], a[24:27], v[168:171]
v_mfma_f32_16x16x32_bf16 v[176:179], a[84:87], a[28:31], v[176:179]
s_add_u32 m0, s16, 0x9800
v_mfma_f32_16x16x32_bf16 v[176:179], a[80:83], a[12:15], v[176:179]
buffer_load_dwordx4 v22, s[44:47], s23 offen lds
v_mfma_f32_16x16x32_bf16 v[180:183], a[88:91], a[12:15], v[180:183]
ds_read_b64_tr_b16 a[80:81], v14 offset:8192
v_mfma_f32_16x16x32_bf16 v[180:183], a[92:95], a[28:31], v[180:183]
ds_read_b64_tr_b16 a[82:83], v14 offset:8448
v_mfma_f32_16x16x32_bf16 v[172:175], a[92:95], a[24:27], v[172:175]
ds_read_b64_tr_b16 a[84:85], v14 offset:10240
v_mfma_f32_16x16x32_bf16 v[172:175], a[88:91], a[8:11], v[172:175]
ds_read_b64_tr_b16 a[86:87], v14 offset:10496
s_add_u32 m0, s16, 0x9c00
v_mfma_f32_16x16x32_bf16 v[164:167], a[88:91], a[4:7], v[164:167]
buffer_load_dwordx4 v23, s[44:47], s23 offen lds
v_mfma_f32_16x16x32_bf16 v[164:167], a[92:95], a[20:23], v[164:167]
v_lshl_add_u32 v22, s42, 7, v22
v_lshl_add_u32 v23, s42, 7, v23
v_mfma_f32_16x16x32_bf16 v[156:159], a[92:95], a[16:19], v[156:159]
v_mfma_f32_16x16x32_bf16 v[156:159], a[88:91], a[0:3], v[156:159]
s_waitcnt lgkmcnt(4)
v_mfma_f32_16x16x32_bf16 v[184:187], a[96:99], a[0:3], v[184:187]
ds_read_b64_tr_b16 a[88:89], v15 offset:8192
v_mfma_f32_16x16x32_bf16 v[184:187], a[100:103], a[16:19], v[184:187]
ds_read_b64_tr_b16 a[90:91], v15 offset:8448
s_add_u32 s8, s28, 0x9400
v_mfma_f32_16x16x32_bf16 v[192:195], a[100:103], a[20:23], v[192:195]
buffer_store_dwordx4 a[116:119], v16, s[88:91], s8 offen sc1
v_mfma_f32_16x16x32_bf16 v[192:195], a[96:99], a[4:7], v[192:195]
ds_read_b64_tr_b16 a[92:93], v15 offset:10240
v_mfma_f32_16x16x32_bf16 v[200:203], a[96:99], a[8:11], v[200:203]
ds_read_b64_tr_b16 a[94:95], v15 offset:10496
v_add_u32 v12, 0x8000, v12
v_mfma_f32_16x16x32_bf16 v[200:203], a[100:103], a[24:27], v[200:203]
v_add_u32 v13, 0x8000, v13
v_add_u32 v14, 0x8000, v14
v_mfma_f32_16x16x32_bf16 v[208:211], a[100:103], a[28:31], v[208:211]
v_add_u32 v15, 0x8000, v15
v_mfma_f32_16x16x32_bf16 v[208:211], a[96:99], a[12:15], v[208:211]
v_mfma_f32_16x16x32_bf16 v[212:215], a[104:107], a[12:15], v[212:215]
s_waitcnt vmcnt(28) lgkmcnt(0)
v_mfma_f32_16x16x32_bf16 v[212:215], a[108:111], a[28:31], v[212:215]
s_barrier
s_add_u32 m0, s17, 0x8000
v_mfma_f32_16x16x32_bf16 v[204:207], a[108:111], a[24:27], v[204:207]
buffer_load_dwordx4 v5, s[52:55], 0 offen lds
v_mfma_f32_16x16x32_bf16 v[204:207], a[104:107], a[8:11], v[204:207]
ds_read_b64_tr_b16 a[96:97], v12 offset:0
v_mfma_f32_16x16x32_bf16 v[196:199], a[104:107], a[4:7], v[196:199]
ds_read_b64_tr_b16 a[98:99], v12 offset:1024
v_mfma_f32_16x16x32_bf16 v[196:199], a[108:111], a[20:23], v[196:199]
ds_read_b64_tr_b16 a[100:101], v12 offset:8192
v_mfma_f32_16x16x32_bf16 v[188:191], a[108:111], a[16:19], v[188:191]
ds_read_b64_tr_b16 a[102:103], v12 offset:9216
v_mfma_f32_16x16x32_bf16 v[188:191], a[104:107], a[0:3], v[188:191]
s_add_u32 m0, s17, 0x8400
s_waitcnt lgkmcnt(4)
v_mfma_f32_16x16x32_bf16 v[216:219], a[0:3], a[80:83], v[216:219]
buffer_load_dwordx4 v5, s[52:55], s13 offen lds
v_mfma_f32_16x16x32_bf16 v[216:219], a[16:19], a[84:87], v[216:219]
ds_read_b64_tr_b16 a[104:105], v13 offset:0
v_mfma_f32_16x16x32_bf16 v[224:227], a[20:23], a[84:87], v[224:227]
ds_read_b64_tr_b16 a[106:107], v13 offset:1024
v_mfma_f32_16x16x32_bf16 v[224:227], a[4:7], a[80:83], v[224:227]
ds_read_b64_tr_b16 a[108:109], v13 offset:8192
v_mfma_f32_16x16x32_bf16 v[232:235], a[8:11], a[80:83], v[232:235]
ds_read_b64_tr_b16 a[110:111], v13 offset:9216
v_mfma_f32_16x16x32_bf16 v[232:235], a[24:27], a[84:87], v[232:235]
s_add_u32 m0, s17, 0x8800
v_mfma_f32_16x16x32_bf16 v[240:243], a[28:31], a[84:87], v[240:243]
buffer_load_dwordx4 v6, s[52:55], 0 offen lds
v_mfma_f32_16x16x32_bf16 v[240:243], a[12:15], a[80:83], v[240:243]
v_mfma_f32_16x16x32_bf16 v[244:247], a[12:15], a[88:91], v[244:247]
ds_read_b64_tr_b16 a[80:81], v12 offset:256
v_mfma_f32_16x16x32_bf16 v[244:247], a[28:31], a[92:95], v[244:247]
ds_read_b64_tr_b16 a[82:83], v12 offset:1280
v_mfma_f32_16x16x32_bf16 v[236:239], a[24:27], a[92:95], v[236:239]
ds_read_b64_tr_b16 a[84:85], v12 offset:8448
v_mfma_f32_16x16x32_bf16 v[236:239], a[8:11], a[88:91], v[236:239]
ds_read_b64_tr_b16 a[86:87], v12 offset:9472
s_add_u32 s8, s28, 0x5800
v_mfma_f32_16x16x32_bf16 v[228:231], a[4:7], a[88:91], v[228:231]
buffer_store_dwordx4 a[124:127], v16, s[88:91], s8 offen sc1
v_mfma_f32_16x16x32_bf16 v[228:231], a[20:23], a[92:95], v[228:231]
v_mfma_f32_16x16x32_bf16 v[220:223], a[16:19], a[92:95], v[220:223]
v_mfma_f32_16x16x32_bf16 v[220:223], a[0:3], a[88:91], v[220:223]
s_waitcnt lgkmcnt(4)
L_S17:
v_mfma_f32_16x16x32_bf16 v[24:27], a[96:99], a[32:35], v[24:27]
ds_read_b64_tr_b16 a[88:89], v13 offset:256
s_waitcnt vmcnt(23)
v_mfma_f32_16x16x32_bf16 v[24:27], a[100:103], a[48:51], v[24:27]
ds_read_b64_tr_b16 a[90:91], v13 offset:1280
s_add_u32 m0, s17, 0x8c00
v_mfma_f32_16x16x32_bf16 v[32:35], a[100:103], a[52:55], v[32:35]
buffer_load_dwordx4 v6, s[52:55], s13 offen lds
v_mfma_f32_16x16x32_bf16 v[32:35], a[96:99], a[36:39], v[32:35]
ds_read_b64_tr_b16 a[92:93], v13 offset:8448
v_mfma_f32_16x16x32_bf16 v[40:43], a[96:99], a[40:43], v[40:43]
ds_read_b64_tr_b16 a[94:95], v13 offset:9472
v_mfma_f32_16x16x32_bf16 v[40:43], a[100:103], a[56:59], v[40:43]
ds_read_b128 a[0:3], v8 offset:0
v_mfma_f32_16x16x32_bf16 v[48:51], a[100:103], a[60:63], v[48:51]
ds_read_b128 a[16:19], v9 offset:0
v_mfma_f32_16x16x32_bf16 v[48:51], a[96:99], a[44:47], v[48:51]
ds_read_b128 a[4:7], v8 offset:2048
s_add_u32 m0, s18, 0xc000
v_mfma_f32_16x16x32_bf16 v[52:55], a[104:107], a[44:47], v[52:55]
buffer_load_dwordx4 v7, s[68:71], 0 offen lds
v_mfma_f32_16x16x32_bf16 v[52:55], a[108:111], a[60:63], v[52:55]
ds_read_b64_tr_b16 a[96:97], v12 offset:512
v_mfma_f32_16x16x32_bf16 v[44:47], a[108:111], a[56:59], v[44:47]
ds_read_b64_tr_b16 a[98:99], v12 offset:1536
v_mfma_f32_16x16x32_bf16 v[44:47], a[104:107], a[40:43], v[44:47]
ds_read_b64_tr_b16 a[100:101], v12 offset:8704
v_mfma_f32_16x16x32_bf16 v[36:39], a[104:107], a[36:39], v[36:39]
ds_read_b64_tr_b16 a[102:103], v12 offset:9728
v_mfma_f32_16x16x32_bf16 v[36:39], a[108:111], a[52:55], v[36:39]
ds_read_b128 a[20:23], v9 offset:2048
s_add_u32 m0, s18, 0xd000
v_mfma_f32_16x16x32_bf16 v[28:31], a[108:111], a[48:51], v[28:31]
buffer_load_dwordx4 v7, s[68:71], s25 offen lds
v_mfma_f32_16x16x32_bf16 v[28:31], a[104:107], a[32:35], v[28:31]
ds_read_b128 a[8:11], v8 offset:4096
s_waitcnt lgkmcnt(9)
v_mfma_f32_16x16x32_bf16 v[56:59], a[80:83], a[32:35], v[56:59]
ds_read_b64_tr_b16 a[104:105], v13 offset:512
v_mfma_f32_16x16x32_bf16 v[56:59], a[84:87], a[48:51], v[56:59]
ds_read_b64_tr_b16 a[106:107], v13 offset:1536
v_mfma_f32_16x16x32_bf16 v[64:67], a[84:87], a[52:55], v[64:67]
ds_read_b64_tr_b16 a[108:109], v13 offset:8704
v_mfma_f32_16x16x32_bf16 v[64:67], a[80:83], a[36:39], v[64:67]
ds_read_b64_tr_b16 a[110:111], v13 offset:9728
s_add_u32 m0, s18, 0xe000
v_mfma_f32_16x16x32_bf16 v[72:75], a[80:83], a[40:43], v[72:75]
buffer_load_dwordx4 v7, s[68:71], s26 offen lds
v_mfma_f32_16x16x32_bf16 v[72:75], a[84:87], a[56:59], v[72:75]
ds_read_b128 a[24:27], v9 offset:4096
v_lshl_add_u32 v5, s42, 19, v5
v_mfma_f32_16x16x32_bf16 v[80:83], a[84:87], a[60:63], v[80:83]
ds_read_b128 a[12:15], v8 offset:6144
v_lshl_add_u32 v6, s42, 19, v6
v_mfma_f32_16x16x32_bf16 v[80:83], a[80:83], a[44:47], v[80:83]
ds_read_b128 a[28:31], v9 offset:6144
v_lshl_add_u32 v7, s42, 18, v7
v_mfma_f32_16x16x32_bf16 v[84:87], a[88:91], a[44:47], v[84:87]
ds_read_b64_tr_b16 a[80:81], v12 offset:768
v_lshl_add_u32 v7, s42, 17, v7
v_mfma_f32_16x16x32_bf16 v[84:87], a[92:95], a[60:63], v[84:87]
ds_read_b64_tr_b16 a[82:83], v12 offset:1792
s_add_u32 s8, s28, 0x9800
v_mfma_f32_16x16x32_bf16 v[76:79], a[92:95], a[56:59], v[76:79]
buffer_store_dwordx4 a[232:235], v16, s[88:91], s8 offen sc1
v_mfma_f32_16x16x32_bf16 v[76:79], a[88:91], a[40:43], v[76:79]
ds_read_b64_tr_b16 a[84:85], v12 offset:8960
v_mfma_f32_16x16x32_bf16 v[68:71], a[88:91], a[36:39], v[68:71]
ds_read_b64_tr_b16 a[86:87], v12 offset:9984
v_mfma_f32_16x16x32_bf16 v[68:71], a[92:95], a[52:55], v[68:71]
v_mfma_f32_16x16x32_bf16 v[60:63], a[92:95], a[48:51], v[60:63]
v_mfma_f32_16x16x32_bf16 v[60:63], a[88:91], a[32:35], v[60:63]
s_add_u32 m0, s16, 0x0
s_waitcnt lgkmcnt(4)
s_waitcnt lgkmcnt(7)
v_mfma_f32_16x16x32_bf16 v[88:91], a[96:99], a[32:35], v[88:91]
buffer_load_dwordx4 v22, s[44:47], s20 offen lds
v_mfma_f32_16x16x32_bf16 v[88:91], a[100:103], a[48:51], v[88:91]
ds_read_b64_tr_b16 a[88:89], v13 offset:768
v_mfma_f32_16x16x32_bf16 v[96:99], a[100:103], a[52:55], v[96:99]
ds_read_b64_tr_b16 a[90:91], v13 offset:1792
v_mfma_f32_16x16x32_bf16 v[96:99], a[96:99], a[36:39], v[96:99]
ds_read_b64_tr_b16 a[92:93], v13 offset:8960
v_mfma_f32_16x16x32_bf16 v[104:107], a[96:99], a[40:43], v[104:107]
ds_read_b64_tr_b16 a[94:95], v13 offset:9984
s_add_u32 m0, s16, 0x400
v_mfma_f32_16x16x32_bf16 v[104:107], a[100:103], a[56:59], v[104:107]
buffer_load_dwordx4 v23, s[44:47], s20 offen lds
v_mfma_f32_16x16x32_bf16 v[112:115], a[100:103], a[60:63], v[112:115]
v_mfma_f32_16x16x32_bf16 v[112:115], a[96:99], a[44:47], v[112:115]
v_mfma_f32_16x16x32_bf16 v[116:119], a[104:107], a[44:47], v[116:119]
ds_read_b64_tr_b16 a[96:97], v14 offset:0
v_mfma_f32_16x16x32_bf16 v[116:119], a[108:111], a[60:63], v[116:119]
ds_read_b64_tr_b16 a[98:99], v14 offset:256
v_mfma_f32_16x16x32_bf16 v[108:111], a[108:111], a[56:59], v[108:111]
ds_read_b64_tr_b16 a[100:101], v14 offset:2048
s_add_u32 m0, s16, 0x800
v_mfma_f32_16x16x32_bf16 v[108:111], a[104:107], a[40:43], v[108:111]
buffer_load_dwordx4 v22, s[44:47], s21 offen lds
v_mfma_f32_16x16x32_bf16 v[100:103], a[104:107], a[36:39], v[100:103]
ds_read_b64_tr_b16 a[102:103], v14 offset:2304
v_mfma_f32_16x16x32_bf16 v[100:103], a[108:111], a[52:55], v[100:103]
v_mfma_f32_16x16x32_bf16 v[92:95], a[108:111], a[48:51], v[92:95]
v_mfma_f32_16x16x32_bf16 v[92:95], a[104:107], a[32:35], v[92:95]
s_add_u32 m0, s16, 0xc00
s_waitcnt lgkmcnt(4)
v_mfma_f32_16x16x32_bf16 v[120:123], a[80:83], a[32:35], v[120:123]
buffer_load_dwordx4 v23, s[44:47], s21 offen lds
v_mfma_f32_16x16x32_bf16 v[120:123], a[84:87], a[48:51], v[120:123]
ds_read_b64_tr_b16 a[104:105], v15 offset:0
v_mfma_f32_16x16x32_bf16 v[128:131], a[84:87], a[52:55], v[128:131]
ds_read_b64_tr_b16 a[106:107], v15 offset:256
v_mfma_f32_16x16x32_bf16 v[128:131], a[80:83], a[36:39], v[128:131]
ds_read_b64_tr_b16 a[108:109], v15 offset:2048
v_mfma_f32_16x16x32_bf16 v[136:139], a[80:83], a[40:43], v[136:139]
ds_read_b64_tr_b16 a[110:111], v15 offset:2304
v_mfma_f32_16x16x32_bf16 v[136:139], a[84:87], a[56:59], v[136:139]
s_add_u32 s8, s28, 0x5c00
v_mfma_f32_16x16x32_bf16 v[144:147], a[84:87], a[60:63], v[144:147]
buffer_store_dwordx4 a[240:243], v16, s[88:91], s8 offen sc1
v_mfma_f32_16x16x32_bf16 v[144:147], a[80:83], a[44:47], v[144:147]
v_mfma_f32_16x16x32_bf16 v[148:151], a[88:91], a[44:47], v[148:151]
ds_read_b64_tr_b16 a[80:81], v14 offset:4096
v_mfma_f32_16x16x32_bf16 v[148:151], a[92:95], a[60:63], v[148:151]
ds_read_b64_tr_b16 a[82:83], v14 offset:4352
v_mfma_f32_16x16x32_bf16 v[140:143], a[92:95], a[56:59], v[140:143]
ds_read_b64_tr_b16 a[84:85], v14 offset:6144
v_mfma_f32_16x16x32_bf16 v[140:143], a[88:91], a[40:43], v[140:143]
ds_read_b64_tr_b16 a[86:87], v14 offset:6400
s_add_u32 m0, s16, 0x1000
v_mfma_f32_16x16x32_bf16 v[132:135], a[88:91], a[36:39], v[132:135]
buffer_load_dwordx4 v22, s[44:47], s22 offen lds
v_mfma_f32_16x16x32_bf16 v[132:135], a[92:95], a[52:55], v[132:135]
v_mfma_f32_16x16x32_bf16 v[124:127], a[92:95], a[48:51], v[124:127]
v_mfma_f32_16x16x32_bf16 v[124:127], a[88:91], a[32:35], v[124:127]
s_waitcnt lgkmcnt(4)
v_mfma_f32_16x16x32_bf16 v[152:155], a[96:99], a[32:35], v[152:155]
ds_read_b64_tr_b16 a[88:89], v15 offset:4096
s_add_u32 m0, s16, 0x1400
v_mfma_f32_16x16x32_bf16 v[152:155], a[100:103], a[48:51], v[152:155]
buffer_load_dwordx4 v23, s[44:47], s22 offen lds
v_mfma_f32_16x16x32_bf16 v[160:163], a[100:103], a[52:55], v[160:163]
ds_read_b64_tr_b16 a[90:91], v15 offset:4352
v_mfma_f32_16x16x32_bf16 v[160:163], a[96:99], a[36:39], v[160:163]
ds_read_b64_tr_b16 a[92:93], v15 offset:6144
v_mfma_f32_16x16x32_bf16 v[168:171], a[96:99], a[40:43], v[168:171]
ds_read_b64_tr_b16 a[94:95], v15 offset:6400
v_mfma_f32_16x16x32_bf16 v[168:171], a[100:103], a[56:59], v[168:171]
v_mfma_f32_16x16x32_bf16 v[176:179], a[100:103], a[60:63], v[176:179]
s_add_u32 m0, s16, 0x1800
v_mfma_f32_16x16x32_bf16 v[176:179], a[96:99], a[44:47], v[176:179]
buffer_load_dwordx4 v22, s[44:47], s23 offen lds
v_mfma_f32_16x16x32_bf16 v[180:183], a[104:107], a[44:47], v[180:183]
ds_read_b64_tr_b16 a[96:97], v14 offset:8192
v_mfma_f32_16x16x32_bf16 v[180:183], a[108:111], a[60:63], v[180:183]
ds_read_b64_tr_b16 a[98:99], v14 offset:8448
v_mfma_f32_16x16x32_bf16 v[172:175], a[108:111], a[56:59], v[172:175]
ds_read_b64_tr_b16 a[100:101], v14 offset:10240
v_mfma_f32_16x16x32_bf16 v[172:175], a[104:107], a[40:43], v[172:175]
ds_read_b64_tr_b16 a[102:103], v14 offset:10496
s_add_u32 m0, s16, 0x1c00
v_mfma_f32_16x16x32_bf16 v[164:167], a[104:107], a[36:39], v[164:167]
buffer_load_dwordx4 v23, s[44:47], s23 offen lds
v_mfma_f32_16x16x32_bf16 v[164:167], a[108:111], a[52:55], v[164:167]
v_lshl_add_u32 v22, s42, 7, v22
v_lshl_add_u32 v23, s42, 7, v23
v_mfma_f32_16x16x32_bf16 v[156:159], a[108:111], a[48:51], v[156:159]
v_mfma_f32_16x16x32_bf16 v[156:159], a[104:107], a[32:35], v[156:159]
s_waitcnt lgkmcnt(4)
v_mfma_f32_16x16x32_bf16 v[184:187], a[80:83], a[32:35], v[184:187]
ds_read_b64_tr_b16 a[104:105], v15 offset:8192
v_mfma_f32_16x16x32_bf16 v[184:187], a[84:87], a[48:51], v[184:187]
ds_read_b64_tr_b16 a[106:107], v15 offset:8448
s_add_u32 s8, s28, 0x9c00
v_mfma_f32_16x16x32_bf16 v[192:195], a[84:87], a[52:55], v[192:195]
buffer_store_dwordx4 a[248:251], v16, s[88:91], s8 offen sc1
v_mfma_f32_16x16x32_bf16 v[192:195], a[80:83], a[36:39], v[192:195]
ds_read_b64_tr_b16 a[108:109], v15 offset:10240
v_mfma_f32_16x16x32_bf16 v[200:203], a[80:83], a[40:43], v[200:203]
ds_read_b64_tr_b16 a[110:111], v15 offset:10496
v_add_u32 v12, 0xffff0000, v12
v_mfma_f32_16x16x32_bf16 v[200:203], a[84:87], a[56:59], v[200:203]
v_add_u32 v13, 0xffff0000, v13
v_add_u32 v14, 0xffff0000, v14
v_mfma_f32_16x16x32_bf16 v[208:211], a[84:87], a[60:63], v[208:211]
v_add_u32 v15, 0xffff0000, v15
v_mfma_f32_16x16x32_bf16 v[208:211], a[80:83], a[44:47], v[208:211]
v_mfma_f32_16x16x32_bf16 v[212:215], a[88:91], a[44:47], v[212:215]
s_waitcnt vmcnt(29) lgkmcnt(0)
v_mfma_f32_16x16x32_bf16 v[212:215], a[92:95], a[60:63], v[212:215]
s_barrier
s_add_u32 m0, s17, 0x10000
v_mfma_f32_16x16x32_bf16 v[204:207], a[92:95], a[56:59], v[204:207]
buffer_load_dwordx4 v5, s[52:55], 0 offen lds
v_mfma_f32_16x16x32_bf16 v[204:207], a[88:91], a[40:43], v[204:207]
ds_read_b64_tr_b16 a[80:81], v12 offset:0
v_mfma_f32_16x16x32_bf16 v[196:199], a[88:91], a[36:39], v[196:199]
ds_read_b64_tr_b16 a[82:83], v12 offset:1024
v_mfma_f32_16x16x32_bf16 v[196:199], a[92:95], a[52:55], v[196:199]
ds_read_b64_tr_b16 a[84:85], v12 offset:8192
v_mfma_f32_16x16x32_bf16 v[188:191], a[92:95], a[48:51], v[188:191]
ds_read_b64_tr_b16 a[86:87], v12 offset:9216
v_mfma_f32_16x16x32_bf16 v[188:191], a[88:91], a[32:35], v[188:191]
s_add_u32 m0, s17, 0x10400
s_waitcnt lgkmcnt(4)
v_mfma_f32_16x16x32_bf16 v[216:219], a[32:35], a[96:99], v[216:219]
buffer_load_dwordx4 v5, s[52:55], s13 offen lds
v_mfma_f32_16x16x32_bf16 v[216:219], a[48:51], a[100:103], v[216:219]
ds_read_b64_tr_b16 a[88:89], v13 offset:0
v_mfma_f32_16x16x32_bf16 v[224:227], a[52:55], a[100:103], v[224:227]
ds_read_b64_tr_b16 a[90:91], v13 offset:1024
v_mfma_f32_16x16x32_bf16 v[224:227], a[36:39], a[96:99], v[224:227]
ds_read_b64_tr_b16 a[92:93], v13 offset:8192
v_mfma_f32_16x16x32_bf16 v[232:235], a[40:43], a[96:99], v[232:235]
ds_read_b64_tr_b16 a[94:95], v13 offset:9216
v_mfma_f32_16x16x32_bf16 v[232:235], a[56:59], a[100:103], v[232:235]
v_mfma_f32_16x16x32_bf16 v[240:243], a[60:63], a[100:103], v[240:243]
s_add_u32 m0, s17, 0x10800
v_mfma_f32_16x16x32_bf16 v[240:243], a[44:47], a[96:99], v[240:243]
buffer_load_dwordx4 v6, s[52:55], 0 offen lds
v_mfma_f32_16x16x32_bf16 v[244:247], a[44:47], a[104:107], v[244:247]
ds_read_b64_tr_b16 a[96:97], v12 offset:256
v_mfma_f32_16x16x32_bf16 v[244:247], a[60:63], a[108:111], v[244:247]
ds_read_b64_tr_b16 a[98:99], v12 offset:1280
v_mfma_f32_16x16x32_bf16 v[236:239], a[56:59], a[108:111], v[236:239]
ds_read_b64_tr_b16 a[100:101], v12 offset:8448
v_mfma_f32_16x16x32_bf16 v[236:239], a[40:43], a[104:107], v[236:239]
ds_read_b64_tr_b16 a[102:103], v12 offset:9472
v_mfma_f32_16x16x32_bf16 v[228:231], a[36:39], a[104:107], v[228:231]
v_mfma_f32_16x16x32_bf16 v[228:231], a[52:55], a[108:111], v[228:231]
s_add_u32 m0, s17, 0x10c00
v_mfma_f32_16x16x32_bf16 v[220:223], a[48:51], a[108:111], v[220:223]
buffer_load_dwordx4 v6, s[52:55], s13 offen lds
v_mfma_f32_16x16x32_bf16 v[220:223], a[32:35], a[104:107], v[220:223]
s_waitcnt lgkmcnt(4)
L_S18:
v_mfma_f32_16x16x32_bf16 v[24:27], a[80:83], a[0:3], v[24:27]
ds_read_b64_tr_b16 a[104:105], v13 offset:256
s_waitcnt vmcnt(24)
v_mfma_f32_16x16x32_bf16 v[24:27], a[84:87], a[16:19], v[24:27]
ds_read_b64_tr_b16 a[106:107], v13 offset:1280
L_padA9:
s_cmp_eq_u32 s95, 1
s_cbranch_scc1 L_hopA_ret
v_mfma_f32_16x16x32_bf16 v[32:35], a[84:87], a[20:23], v[32:35]
ds_read_b64_tr_b16 a[108:109], v13 offset:8448
v_mfma_f32_16x16x32_bf16 v[32:35], a[80:83], a[4:7], v[32:35]
ds_read_b64_tr_b16 a[110:111], v13 offset:9472
v_mfma_f32_16x16x32_bf16 v[40:43], a[80:83], a[8:11], v[40:43]
ds_read_b128 a[32:35], v8 offset:32768
s_add_u32 m0, s18, 0x14000
v_mfma_f32_16x16x32_bf16 v[40:43], a[84:87], a[24:27], v[40:43]
buffer_load_dwordx4 v7, s[68:71], 0 offen lds
v_mfma_f32_16x16x32_bf16 v[48:51], a[84:87], a[28:31], v[48:51]
ds_read_b128 a[48:51], v9 offset:32768
v_mfma_f32_16x16x32_bf16 v[48:51], a[80:83], a[12:15], v[48:51]
ds_read_b128 a[36:39], v8 offset:34816
v_mfma_f32_16x16x32_bf16 v[52:55], a[88:91], a[12:15], v[52:55]
ds_read_b64_tr_b16 a[80:81], v12 offset:512
v_mfma_f32_16x16x32_bf16 v[52:55], a[92:95], a[28:31], v[52:55]
ds_read_b64_tr_b16 a[82:83], v12 offset:1536
v_mfma_f32_16x16x32_bf16 v[44:47], a[92:95], a[24:27], v[44:47]
ds_read_b64_tr_b16 a[84:85], v12 offset:8704
v_mfma_f32_16x16x32_bf16 v[44:47], a[88:91], a[8:11], v[44:47]
buffer_load_dwordx4 a[128:131], v16, s[44:47], s100 offen offset:0
v_mfma_f32_16x16x32_bf16 v[36:39], a[88:91], a[4:7], v[36:39]
ds_read_b64_tr_b16 a[86:87], v12 offset:9728
v_mfma_f32_16x16x32_bf16 v[36:39], a[92:95], a[20:23], v[36:39]
ds_read_b128 a[52:55], v9 offset:34816
v_mfma_f32_16x16x32_bf16 v[28:31], a[92:95], a[16:19], v[28:31]
ds_read_b128 a[40:43], v8 offset:36864
v_mfma_f32_16x16x32_bf16 v[28:31], a[88:91], a[0:3], v[28:31]
ds_read_b128 a[56:59], v9 offset:36864
s_waitcnt lgkmcnt(10)
v_mfma_f32_16x16x32_bf16 v[56:59], a[96:99], a[0:3], v[56:59]
ds_read_b64_tr_b16 a[88:89], v13 offset:512
v_mfma_f32_16x16x32_bf16 v[56:59], a[100:103], a[16:19], v[56:59]
ds_read_b64_tr_b16 a[90:91], v13 offset:1536
s_add_u32 m0, s18, 0x15000
v_mfma_f32_16x16x32_bf16 v[64:67], a[100:103], a[20:23], v[64:67]
buffer_load_dwordx4 v7, s[68:71], s25 offen lds
v_mfma_f32_16x16x32_bf16 v[64:67], a[96:99], a[4:7], v[64:67]
ds_read_b64_tr_b16 a[92:93], v13 offset:8704
v_mfma_f32_16x16x32_bf16 v[72:75], a[96:99], a[8:11], v[72:75]
ds_read_b64_tr_b16 a[94:95], v13 offset:9728
v_mfma_f32_16x16x32_bf16 v[72:75], a[100:103], a[24:27], v[72:75]
ds_read_b128 a[44:47], v8 offset:38912
v_mfma_f32_16x16x32_bf16 v[80:83], a[100:103], a[28:31], v[80:83]
ds_read_b128 a[60:63], v9 offset:38912
v_mfma_f32_16x16x32_bf16 v[80:83], a[96:99], a[12:15], v[80:83]
v_mfma_f32_16x16x32_bf16 v[84:87], a[104:107], a[12:15], v[84:87]
ds_read_b64_tr_b16 a[96:97], v12 offset:768
s_add_u32 m0, s18, 0x16000
v_mfma_f32_16x16x32_bf16 v[84:87], a[108:111], a[28:31], v[84:87]
buffer_load_dwordx4 v7, s[68:71], s26 offen lds
v_mfma_f32_16x16x32_bf16 v[76:79], a[108:111], a[24:27], v[76:79]
ds_read_b64_tr_b16 a[98:99], v12 offset:1792
v_lshl_add_u32 v5, s42, 19, v5
v_mfma_f32_16x16x32_bf16 v[76:79], a[104:107], a[8:11], v[76:79]
ds_read_b64_tr_b16 a[100:101], v12 offset:8960
v_lshl_add_u32 v6, s42, 19, v6
v_mfma_f32_16x16x32_bf16 v[68:71], a[104:107], a[4:7], v[68:71]
ds_read_b64_tr_b16 a[102:103], v12 offset:9984
v_lshl_add_u32 v7, s42, 18, v7
v_mfma_f32_16x16x32_bf16 v[68:71], a[108:111], a[20:23], v[68:71]
v_lshl_add_u32 v7, s42, 17, v7
v_mfma_f32_16x16x32_bf16 v[60:63], a[108:111], a[16:19], v[60:63]
v_mfma_f32_16x16x32_bf16 v[60:63], a[104:107], a[0:3], v[60:63]
s_add_u32 m0, s16, 0x8000
s_waitcnt lgkmcnt(4)
s_waitcnt lgkmcnt(6)
v_mfma_f32_16x16x32_bf16 v[88:91], a[80:83], a[0:3], v[88:91]
buffer_load_dwordx4 v22, s[44:47], s20 offen lds
v_mfma_f32_16x16x32_bf16 v[88:91], a[84:87], a[16:19], v[88:91]
ds_read_b64_tr_b16 a[104:105], v13 offset:768
v_mfma_f32_16x16x32_bf16 v[96:99], a[84:87], a[20:23], v[96:99]
ds_read_b64_tr_b16 a[106:107], v13 offset:1792
v_mfma_f32_16x16x32_bf16 v[96:99], a[80:83], a[4:7], v[96:99]
ds_read_b64_tr_b16 a[108:109], v13 offset:8960
v_mfma_f32_16x16x32_bf16 v[104:107], a[80:83], a[8:11], v[104:107]
ds_read_b64_tr_b16 a[110:111], v13 offset:9984
s_add_u32 m0, s16, 0x8400
v_mfma_f32_16x16x32_bf16 v[104:107], a[84:87], a[24:27], v[104:107]
buffer_load_dwordx4 v23, s[44:47], s20 offen lds
v_mfma_f32_16x16x32_bf16 v[112:115], a[84:87], a[28:31], v[112:115]
v_mfma_f32_16x16x32_bf16 v[112:115], a[80:83], a[12:15], v[112:115]
v_mfma_f32_16x16x32_bf16 v[116:119], a[88:91], a[12:15], v[116:119]
ds_read_b64_tr_b16 a[80:81], v14 offset:0
v_mfma_f32_16x16x32_bf16 v[116:119], a[92:95], a[28:31], v[116:119]
ds_read_b64_tr_b16 a[82:83], v14 offset:256
v_mfma_f32_16x16x32_bf16 v[108:111], a[92:95], a[24:27], v[108:111]
ds_read_b64_tr_b16 a[84:85], v14 offset:2048
s_add_u32 m0, s16, 0x8800
v_mfma_f32_16x16x32_bf16 v[108:111], a[88:91], a[8:11], v[108:111]
buffer_load_dwordx4 v22, s[44:47], s21 offen lds
v_mfma_f32_16x16x32_bf16 v[100:103], a[88:91], a[4:7], v[100:103]
ds_read_b64_tr_b16 a[86:87], v14 offset:2304
v_mfma_f32_16x16x32_bf16 v[100:103], a[92:95], a[20:23], v[100:103]
v_mfma_f32_16x16x32_bf16 v[92:95], a[92:95], a[16:19], v[92:95]
v_mfma_f32_16x16x32_bf16 v[92:95], a[88:91], a[0:3], v[92:95]
s_waitcnt lgkmcnt(4)
v_mfma_f32_16x16x32_bf16 v[120:123], a[96:99], a[0:3], v[120:123]
buffer_load_dwordx4 a[132:135], v16, s[44:47], s100 offen offset:1024
v_mfma_f32_16x16x32_bf16 v[120:123], a[100:103], a[16:19], v[120:123]
ds_read_b64_tr_b16 a[88:89], v15 offset:0
v_mfma_f32_16x16x32_bf16 v[128:131], a[100:103], a[20:23], v[128:131]
ds_read_b64_tr_b16 a[90:91], v15 offset:256
v_mfma_f32_16x16x32_bf16 v[128:131], a[96:99], a[4:7], v[128:131]
ds_read_b64_tr_b16 a[92:93], v15 offset:2048
v_mfma_f32_16x16x32_bf16 v[136:139], a[96:99], a[8:11], v[136:139]
ds_read_b64_tr_b16 a[94:95], v15 offset:2304
v_mfma_f32_16x16x32_bf16 v[136:139], a[100:103], a[24:27], v[136:139]
s_add_u32 m0, s16, 0x8c00
v_mfma_f32_16x16x32_bf16 v[144:147], a[100:103], a[28:31], v[144:147]
buffer_load_dwordx4 v23, s[44:47], s21 offen lds
v_mfma_f32_16x16x32_bf16 v[144:147], a[96:99], a[12:15], v[144:147]
v_mfma_f32_16x16x32_bf16 v[148:151], a[104:107], a[12:15], v[148:151]
ds_read_b64_tr_b16 a[96:97], v14 offset:4096
v_mfma_f32_16x16x32_bf16 v[148:151], a[108:111], a[28:31], v[148:151]
ds_read_b64_tr_b16 a[98:99], v14 offset:4352
v_mfma_f32_16x16x32_bf16 v[140:143], a[108:111], a[24:27], v[140:143]
ds_read_b64_tr_b16 a[100:101], v14 offset:6144
v_mfma_f32_16x16x32_bf16 v[140:143], a[104:107], a[8:11], v[140:143]
ds_read_b64_tr_b16 a[102:103], v14 offset:6400
s_add_u32 m0, s16, 0x9000
v_mfma_f32_16x16x32_bf16 v[132:135], a[104:107], a[4:7], v[132:135]
buffer_load_dwordx4 v22, s[44:47], s22 offen lds
v_mfma_f32_16x16x32_bf16 v[132:135], a[108:111], a[20:23], v[132:135]
v_mfma_f32_16x16x32_bf16 v[124:127], a[108:111], a[16:19], v[124:127]
v_mfma_f32_16x16x32_bf16 v[124:127], a[104:107], a[0:3], v[124:127]
s_waitcnt lgkmcnt(4)
v_mfma_f32_16x16x32_bf16 v[152:155], a[80:83], a[0:3], v[152:155]
ds_read_b64_tr_b16 a[104:105], v15 offset:4096
s_add_u32 m0, s16, 0x9400
v_mfma_f32_16x16x32_bf16 v[152:155], a[84:87], a[16:19], v[152:155]
buffer_load_dwordx4 v23, s[44:47], s22 offen lds
v_mfma_f32_16x16x32_bf16 v[160:163], a[84:87], a[20:23], v[160:163]
ds_read_b64_tr_b16 a[106:107], v15 offset:4352
v_mfma_f32_16x16x32_bf16 v[160:163], a[80:83], a[4:7], v[160:163]
ds_read_b64_tr_b16 a[108:109], v15 offset:6144
v_mfma_f32_16x16x32_bf16 v[168:171], a[80:83], a[8:11], v[168:171]
ds_read_b64_tr_b16 a[110:111], v15 offset:6400
v_mfma_f32_16x16x32_bf16 v[168:171], a[84:87], a[24:27], v[168:171]
v_mfma_f32_16x16x32_bf16 v[176:179], a[84:87], a[28:31], v[176:179]
s_add_u32 m0, s16, 0x9800
v_mfma_f32_16x16x32_bf16 v[176:179], a[80:83], a[12:15], v[176:179]
buffer_load_dwordx4 v22, s[44:47], s23 offen lds
v_mfma_f32_16x16x32_bf16 v[180:183], a[88:91], a[12:15], v[180:183]
ds_read_b64_tr_b16 a[80:81], v14 offset:8192
v_mfma_f32_16x16x32_bf16 v[180:183], a[92:95], a[28:31], v[180:183]
ds_read_b64_tr_b16 a[82:83], v14 offset:8448
v_mfma_f32_16x16x32_bf16 v[172:175], a[92:95], a[24:27], v[172:175]
ds_read_b64_tr_b16 a[84:85], v14 offset:10240
v_mfma_f32_16x16x32_bf16 v[172:175], a[88:91], a[8:11], v[172:175]
ds_read_b64_tr_b16 a[86:87], v14 offset:10496
s_add_u32 m0, s16, 0x9c00
v_mfma_f32_16x16x32_bf16 v[164:167], a[88:91], a[4:7], v[164:167]
buffer_load_dwordx4 v23, s[44:47], s23 offen lds
v_mfma_f32_16x16x32_bf16 v[164:167], a[92:95], a[20:23], v[164:167]
v_lshl_add_u32 v22, s42, 7, v22
v_lshl_add_u32 v23, s42, 7, v23
v_mfma_f32_16x16x32_bf16 v[156:159], a[92:95], a[16:19], v[156:159]
v_mfma_f32_16x16x32_bf16 v[156:159], a[88:91], a[0:3], v[156:159]
s_waitcnt lgkmcnt(4)
v_mfma_f32_16x16x32_bf16 v[184:187], a[96:99], a[0:3], v[184:187]
ds_read_b64_tr_b16 a[88:89], v15 offset:8192
v_mfma_f32_16x16x32_bf16 v[184:187], a[100:103], a[16:19], v[184:187]
ds_read_b64_tr_b16 a[90:91], v15 offset:8448
v_mfma_f32_16x16x32_bf16 v[192:195], a[100:103], a[20:23], v[192:195]
buffer_load_dwordx4 a[136:139], v16, s[44:47], s100 offen offset:2048
v_mfma_f32_16x16x32_bf16 v[192:195], a[96:99], a[4:7], v[192:195]
ds_read_b64_tr_b16 a[92:93], v15 offset:10240
v_mfma_f32_16x16x32_bf16 v[200:203], a[96:99], a[8:11], v[200:203]
ds_read_b64_tr_b16 a[94:95], v15 offset:10496
v_add_u32 v12, 0x8000, v12
v_mfma_f32_16x16x32_bf16 v[200:203], a[100:103], a[24:27], v[200:203]
v_add_u32 v13, 0x8000, v13
v_add_u32 v14, 0x8000, v14
v_mfma_f32_16x16x32_bf16 v[208:211], a[100:103], a[28:31], v[208:211]
v_add_u32 v15, 0x8000, v15
v_mfma_f32_16x16x32_bf16 v[208:211], a[96:99], a[12:15], v[208:211]
v_mfma_f32_16x16x32_bf16 v[212:215], a[104:107], a[12:15], v[212:215]
s_waitcnt vmcnt(18) lgkmcnt(0)
v_mfma_f32_16x16x32_bf16 v[212:215], a[108:111], a[28:31], v[212:215]
s_barrier
s_add_u32 m0, s17, 0x0
s_cmp_lg_u32 s4, 0
s_cbranch_scc1 L_sig_kv
v_mov_b32 v20, 1
s_mov_b64 exec, 1
buffer_atomic_add v20, off, s[84:87], s10 sc1
s_mov_b64 exec, -1
L_sig_kv:
v_mfma_f32_16x16x32_bf16 v[204:207], a[108:111], a[24:27], v[204:207]
buffer_load_dwordx4 v5, s[52:55], 0 offen lds
v_mfma_f32_16x16x32_bf16 v[204:207], a[104:107], a[8:11], v[204:207]
ds_read_b64_tr_b16 a[96:97], v12 offset:0
v_mfma_f32_16x16x32_bf16 v[196:199], a[104:107], a[4:7], v[196:199]
ds_read_b64_tr_b16 a[98:99], v12 offset:1024
v_mfma_f32_16x16x32_bf16 v[196:199], a[108:111], a[20:23], v[196:199]
ds_read_b64_tr_b16 a[100:101], v12 offset:8192
v_mfma_f32_16x16x32_bf16 v[188:191], a[108:111], a[16:19], v[188:191]
ds_read_b64_tr_b16 a[102:103], v12 offset:9216
v_mfma_f32_16x16x32_bf16 v[188:191], a[104:107], a[0:3], v[188:191]
s_add_u32 m0, s17, 0x400
s_waitcnt lgkmcnt(4)
v_mfma_f32_16x16x32_bf16 v[216:219], a[0:3], a[80:83], v[216:219]
buffer_load_dwordx4 v5, s[52:55], s13 offen lds
v_mfma_f32_16x16x32_bf16 v[216:219], a[16:19], a[84:87], v[216:219]
ds_read_b64_tr_b16 a[104:105], v13 offset:0
v_mfma_f32_16x16x32_bf16 v[224:227], a[20:23], a[84:87], v[224:227]
ds_read_b64_tr_b16 a[106:107], v13 offset:1024
v_mfma_f32_16x16x32_bf16 v[224:227], a[4:7], a[80:83], v[224:227]
ds_read_b64_tr_b16 a[108:109], v13 offset:8192
v_mfma_f32_16x16x32_bf16 v[232:235], a[8:11], a[80:83], v[232:235]
ds_read_b64_tr_b16 a[110:111], v13 offset:9216
v_mfma_f32_16x16x32_bf16 v[232:235], a[24:27], a[84:87], v[232:235]
v_mfma_f32_16x16x32_bf16 v[240:243], a[28:31], a[84:87], v[240:243]
s_add_u32 m0, s17, 0x800
v_mfma_f32_16x16x32_bf16 v[240:243], a[12:15], a[80:83], v[240:243]
buffer_load_dwordx4 v6, s[52:55], 0 offen lds
v_mfma_f32_16x16x32_bf16 v[244:247], a[12:15], a[88:91], v[244:247]
ds_read_b64_tr_b16 a[80:81], v12 offset:256
v_mfma_f32_16x16x32_bf16 v[244:247], a[28:31], a[92:95], v[244:247]
ds_read_b64_tr_b16 a[82:83], v12 offset:1280
v_mfma_f32_16x16x32_bf16 v[236:239], a[24:27], a[92:95], v[236:239]
ds_read_b64_tr_b16 a[84:85], v12 offset:8448
v_mfma_f32_16x16x32_bf16 v[236:239], a[8:11], a[88:91], v[236:239]
ds_read_b64_tr_b16 a[86:87], v12 offset:9472
v_mfma_f32_16x16x32_bf16 v[228:231], a[4:7], a[88:91], v[228:231]
v_mfma_f32_16x16x32_bf16 v[228:231], a[20:23], a[92:95], v[228:231]
s_add_u32 m0, s17, 0xc00
v_mfma_f32_16x16x32_bf16 v[220:223], a[16:19], a[92:95], v[220:223]
buffer_load_dwordx4 v6, s[52:55], s13 offen lds
v_mfma_f32_16x16x32_bf16 v[220:223], a[0:3], a[88:91], v[220:223]
s_waitcnt lgkmcnt(4)
L_S19:
v_mfma_f32_16x16x32_bf16 v[24:27], a[96:99], a[32:35], v[24:27]
ds_read_b64_tr_b16 a[88:89], v13 offset:256
s_waitcnt vmcnt(23)
v_mfma_f32_16x16x32_bf16 v[24:27], a[100:103], a[48:51], v[24:27]
ds_read_b64_tr_b16 a[90:91], v13 offset:1280
v_mfma_f32_16x16x32_bf16 v[32:35], a[100:103], a[52:55], v[32:35]
ds_read_b64_tr_b16 a[92:93], v13 offset:8448
v_mfma_f32_16x16x32_bf16 v[32:35], a[96:99], a[36:39], v[32:35]
ds_read_b64_tr_b16 a[94:95], v13 offset:9472
v_mfma_f32_16x16x32_bf16 v[40:43], a[96:99], a[40:43], v[40:43]
ds_read_b128 a[0:3], v8 offset:0
s_add_u32 m0, s18, 0x4000
v_mfma_f32_16x16x32_bf16 v[40:43], a[100:103], a[56:59], v[40:43]
buffer_load_dwordx4 v7, s[68:71], 0 offen lds
v_mfma_f32_16x16x32_bf16 v[48:51], a[100:103], a[60:63], v[48:51]
ds_read_b128 a[16:19], v9 offset:0
v_mfma_f32_16x16x32_bf16 v[48:51], a[96:99], a[44:47], v[48:51]
ds_read_b128 a[4:7], v8 offset:2048
v_mfma_f32_16x16x32_bf16 v[52:55], a[104:107], a[44:47], v[52:55]
ds_read_b64_tr_b16 a[96:97], v12 offset:512
v_mfma_f32_16x16x32_bf16 v[52:55], a[108:111], a[60:63], v[52:55]
ds_read_b64_tr_b16 a[98:99], v12 offset:1536
v_mfma_f32_16x16x32_bf16 v[44:47], a[108:111], a[56:59], v[44:47]
ds_read_b64_tr_b16 a[100:101], v12 offset:8704
v_mfma_f32_16x16x32_bf16 v[44:47], a[104:107], a[40:43], v[44:47]
buffer_load_dwordx4 a[140:143], v16, s[44:47], s100 offen offset:3072
v_mfma_f32_16x16x32_bf16 v[36:39], a[104:107], a[36:39], v[36:39]
ds_read_b64_tr_b16 a[102:103], v12 offset:9728
v_mfma_f32_16x16x32_bf16 v[36:39], a[108:111], a[52:55], v[36:39]
ds_read_b128 a[20:23], v9 offset:2048
v_mfma_f32_16x16x32_bf16 v[28:31], a[108:111], a[48:51], v[28:31]
ds_read_b128 a[8:11], v8 offset:4096
v_mfma_f32_16x16x32_bf16 v[28:31], a[104:107], a[32:35], v[28:31]
ds_read_b128 a[24:27], v9 offset:4096
s_waitcnt lgkmcnt(10)
v_mfma_f32_16x16x32_bf16 v[56:59], a[80:83], a[32:35], v[56:59]
ds_read_b64_tr_b16 a[104:105], v13 offset:512
v_mfma_f32_16x16x32_bf16 v[56:59], a[84:87], a[48:51], v[56:59]
ds_read_b64_tr_b16 a[106:107], v13 offset:1536
s_add_u32 m0, s18, 0x5000
v_mfma_f32_16x16x32_bf16 v[64:67], a[84:87], a[52:55], v[64:67]
buffer_load_dwordx4 v7, s[68:71], s25 offen lds
v_mfma_f32_16x16x32_bf16 v[64:67], a[80:83], a[36:39], v[64:67]
ds_read_b64_tr_b16 a[108:109], v13 offset:8704
v_mfma_f32_16x16x32_bf16 v[72:75], a[80:83], a[40:43], v[72:75]
ds_read_b64_tr_b16 a[110:111], v13 offset:9728
v_mfma_f32_16x16x32_bf16 v[72:75], a[84:87], a[56:59], v[72:75]
ds_read_b128 a[12:15], v8 offset:6144
v_mfma_f32_16x16x32_bf16 v[80:83], a[84:87], a[60:63], v[80:83]
ds_read_b128 a[28:31], v9 offset:6144
v_mfma_f32_16x16x32_bf16 v[80:83], a[80:83], a[44:47], v[80:83]
v_mfma_f32_16x16x32_bf16 v[84:87], a[88:91], a[44:47], v[84:87]
ds_read_b64_tr_b16 a[80:81], v12 offset:768
s_add_u32 m0, s18, 0x6000
v_mfma_f32_16x16x32_bf16 v[84:87], a[92:95], a[60:63], v[84:87]
buffer_load_dwordx4 v7, s[68:71], s26 offen lds
v_mfma_f32_16x16x32_bf16 v[76:79], a[92:95], a[56:59], v[76:79]
ds_read_b64_tr_b16 a[82:83], v12 offset:1792
v_lshl_add_u32 v5, s42, 19, v5
v_mfma_f32_16x16x32_bf16 v[76:79], a[88:91], a[40:43], v[76:79]
ds_read_b64_tr_b16 a[84:85], v12 offset:8960
v_lshl_add_u32 v6, s42, 19, v6
v_mfma_f32_16x16x32_bf16 v[68:71], a[88:91], a[36:39], v[68:71]
ds_read_b64_tr_b16 a[86:87], v12 offset:9984
v_lshl_add_u32 v7, s42, 18, v7
v_mfma_f32_16x16x32_bf16 v[68:71], a[92:95], a[52:55], v[68:71]
v_lshl_add_u32 v7, s42, 17, v7
v_mfma_f32_16x16x32_bf16 v[60:63], a[92:95], a[48:51], v[60:63]
v_mfma_f32_16x16x32_bf16 v[60:63], a[88:91], a[32:35], v[60:63]
s_add_u32 m0, s16, 0x0
s_waitcnt lgkmcnt(4)
s_waitcnt lgkmcnt(6)
v_mfma_f32_16x16x32_bf16 v[88:91], a[96:99], a[32:35], v[88:91]
buffer_load_dwordx4 v22, s[44:47], s20 offen lds
v_mfma_f32_16x16x32_bf16 v[88:91], a[100:103], a[48:51], v[88:91]
ds_read_b64_tr_b16 a[88:89], v13 offset:768
v_mfma_f32_16x16x32_bf16 v[96:99], a[100:103], a[52:55], v[96:99]
ds_read_b64_tr_b16 a[90:91], v13 offset:1792
v_mfma_f32_16x16x32_bf16 v[96:99], a[96:99], a[36:39], v[96:99]
ds_read_b64_tr_b16 a[92:93], v13 offset:8960
v_mfma_f32_16x16x32_bf16 v[104:107], a[96:99], a[40:43], v[104:107]
ds_read_b64_tr_b16 a[94:95], v13 offset:9984
s_add_u32 m0, s16, 0x400
v_mfma_f32_16x16x32_bf16 v[104:107], a[100:103], a[56:59], v[104:107]
buffer_load_dwordx4 v23, s[44:47], s20 offen lds
v_mfma_f32_16x16x32_bf16 v[112:115], a[100:103], a[60:63], v[112:115]
v_mfma_f32_16x16x32_bf16 v[112:115], a[96:99], a[44:47], v[112:115]
v_mfma_f32_16x16x32_bf16 v[116:119], a[104:107], a[44:47], v[116:119]
ds_read_b64_tr_b16 a[96:97], v14 offset:0
v_mfma_f32_16x16x32_bf16 v[116:119], a[108:111], a[60:63], v[116:119]
ds_read_b64_tr_b16 a[98:99], v14 offset:256
v_mfma_f32_16x16x32_bf16 v[108:111], a[108:111], a[56:59], v[108:111]
ds_read_b64_tr_b16 a[100:101], v14 offset:2048
s_add_u32 m0, s16, 0x800
v_mfma_f32_16x16x32_bf16 v[108:111], a[104:107], a[40:43], v[108:111]
buffer_load_dwordx4 v22, s[44:47], s21 offen lds
v_mfma_f32_16x16x32_bf16 v[100:103], a[104:107], a[36:39], v[100:103]
ds_read_b64_tr_b16 a[102:103], v14 offset:2304
v_mfma_f32_16x16x32_bf16 v[100:103], a[108:111], a[52:55], v[100:103]
v_mfma_f32_16x16x32_bf16 v[92:95], a[108:111], a[48:51], v[92:95]
v_mfma_f32_16x16x32_bf16 v[92:95], a[104:107], a[32:35], v[92:95]
s_waitcnt lgkmcnt(4)
v_mfma_f32_16x16x32_bf16 v[120:123], a[80:83], a[32:35], v[120:123]
buffer_load_dwordx4 a[144:147], v16, s[76:79], 0 offen offset:0
v_mfma_f32_16x16x32_bf16 v[120:123], a[84:87], a[48:51], v[120:123]
ds_read_b64_tr_b16 a[104:105], v15 offset:0
v_mfma_f32_16x16x32_bf16 v[128:131], a[84:87], a[52:55], v[128:131]
ds_read_b64_tr_b16 a[106:107], v15 offset:256
v_mfma_f32_16x16x32_bf16 v[128:131], a[80:83], a[36:39], v[128:131]
ds_read_b64_tr_b16 a[108:109], v15 offset:2048
v_mfma_f32_16x16x32_bf16 v[136:139], a[80:83], a[40:43], v[136:139]
ds_read_b64_tr_b16 a[110:111], v15 offset:2304
v_mfma_f32_16x16x32_bf16 v[136:139], a[84:87], a[56:59], v[136:139]
s_add_u32 m0, s16, 0xc00
v_mfma_f32_16x16x32_bf16 v[144:147], a[84:87], a[60:63], v[144:147]
buffer_load_dwordx4 v23, s[44:47], s21 offen lds
v_mfma_f32_16x16x32_bf16 v[144:147], a[80:83], a[44:47], v[144:147]
v_mfma_f32_16x16x32_bf16 v[148:151], a[88:91], a[44:47], v[148:151]
ds_read_b64_tr_b16 a[80:81], v14 offset:4096
v_mfma_f32_16x16x32_bf16 v[148:151], a[92:95], a[60:63], v[148:151]
ds_read_b64_tr_b16 a[82:83], v14 offset:4352
v_mfma_f32_16x16x32_bf16 v[140:143], a[92:95], a[56:59], v[140:143]
ds_read_b64_tr_b16 a[84:85], v14 offset:6144
v_mfma_f32_16x16x32_bf16 v[140:143], a[88:91], a[40:43], v[140:143]
ds_read_b64_tr_b16 a[86:87], v14 offset:6400
s_add_u32 m0, s16, 0x1000
v_mfma_f32_16x16x32_bf16 v[132:135], a[88:91], a[36:39], v[132:135]
buffer_load_dwordx4 v22, s[44:47], s22 offen lds
v_mfma_f32_16x16x32_bf16 v[132:135], a[92:95], a[52:55], v[132:135]
v_mfma_f32_16x16x32_bf16 v[124:127], a[92:95], a[48:51], v[124:127]
v_mfma_f32_16x16x32_bf16 v[124:127], a[88:91], a[32:35], v[124:127]
s_waitcnt lgkmcnt(4)
v_mfma_f32_16x16x32_bf16 v[152:155], a[96:99], a[32:35], v[152:155]
ds_read_b64_tr_b16 a[88:89], v15 offset:4096
s_add_u32 m0, s16, 0x1400
v_mfma_f32_16x16x32_bf16 v[152:155], a[100:103], a[48:51], v[152:155]
buffer_load_dwordx4 v23, s[44:47], s22 offen lds
v_mfma_f32_16x16x32_bf16 v[160:163], a[100:103], a[52:55], v[160:163]
ds_read_b64_tr_b16 a[90:91], v15 offset:4352
v_mfma_f32_16x16x32_bf16 v[160:163], a[96:99], a[36:39], v[160:163]
ds_read_b64_tr_b16 a[92:93], v15 offset:6144
v_mfma_f32_16x16x32_bf16 v[168:171], a[96:99], a[40:43], v[168:171]
ds_read_b64_tr_b16 a[94:95], v15 offset:6400
v_mfma_f32_16x16x32_bf16 v[168:171], a[100:103], a[56:59], v[168:171]
v_mfma_f32_16x16x32_bf16 v[176:179], a[100:103], a[60:63], v[176:179]
s_add_u32 m0, s16, 0x1800
v_mfma_f32_16x16x32_bf16 v[176:179], a[96:99], a[44:47], v[176:179]
buffer_load_dwordx4 v22, s[44:47], s23 offen lds
v_mfma_f32_16x16x32_bf16 v[180:183], a[104:107], a[44:47], v[180:183]
ds_read_b64_tr_b16 a[96:97], v14 offset:8192
v_mfma_f32_16x16x32_bf16 v[180:183], a[108:111], a[60:63], v[180:183]
ds_read_b64_tr_b16 a[98:99], v14 offset:8448
v_mfma_f32_16x16x32_bf16 v[172:175], a[108:111], a[56:59], v[172:175]
ds_read_b64_tr_b16 a[100:101], v14 offset:10240
v_mfma_f32_16x16x32_bf16 v[172:175], a[104:107], a[40:43], v[172:175]
ds_read_b64_tr_b16 a[102:103], v14 offset:10496
s_add_u32 m0, s16, 0x1c00
v_mfma_f32_16x16x32_bf16 v[164:167], a[104:107], a[36:39], v[164:167]
buffer_load_dwordx4 v23, s[44:47], s23 offen lds
v_mfma_f32_16x16x32_bf16 v[164:167], a[108:111], a[52:55], v[164:167]
v_lshl_add_u32 v22, s42, 7, v22
v_lshl_add_u32 v23, s42, 7, v23
v_mfma_f32_16x16x32_bf16 v[156:159], a[108:111], a[48:51], v[156:159]
v_mfma_f32_16x16x32_bf16 v[156:159], a[104:107], a[32:35], v[156:159]
s_waitcnt lgkmcnt(4)
v_mfma_f32_16x16x32_bf16 v[184:187], a[80:83], a[32:35], v[184:187]
ds_read_b64_tr_b16 a[104:105], v15 offset:8192
v_mfma_f32_16x16x32_bf16 v[184:187], a[84:87], a[48:51], v[184:187]
ds_read_b64_tr_b16 a[106:107], v15 offset:8448
v_mfma_f32_16x16x32_bf16 v[192:195], a[84:87], a[52:55], v[192:195]
buffer_load_dwordx4 a[148:151], v16, s[76:79], 0 offen offset:1024
v_mfma_f32_16x16x32_bf16 v[192:195], a[80:83], a[36:39], v[192:195]
ds_read_b64_tr_b16 a[108:109], v15 offset:10240
v_mfma_f32_16x16x32_bf16 v[200:203], a[80:83], a[40:43], v[200:203]
ds_read_b64_tr_b16 a[110:111], v15 offset:10496
v_add_u32 v12, 0x8000, v12
v_mfma_f32_16x16x32_bf16 v[200:203], a[84:87], a[56:59], v[200:203]
v_add_u32 v13, 0x8000, v13
v_add_u32 v14, 0x8000, v14
v_mfma_f32_16x16x32_bf16 v[208:211], a[84:87], a[60:63], v[208:211]
v_add_u32 v15, 0x8000, v15
v_mfma_f32_16x16x32_bf16 v[208:211], a[80:83], a[44:47], v[208:211]
v_mfma_f32_16x16x32_bf16 v[212:215], a[88:91], a[44:47], v[212:215]
s_waitcnt vmcnt(28) lgkmcnt(0)
v_mfma_f32_16x16x32_bf16 v[212:215], a[92:95], a[60:63], v[212:215]
s_barrier
s_add_u32 m0, s17, 0x8000
v_mfma_f32_16x16x32_bf16 v[204:207], a[92:95], a[56:59], v[204:207]
buffer_load_dwordx4 v5, s[52:55], 0 offen lds
v_mfma_f32_16x16x32_bf16 v[204:207], a[88:91], a[40:43], v[204:207]
ds_read_b64_tr_b16 a[80:81], v12 offset:0
v_mfma_f32_16x16x32_bf16 v[196:199], a[88:91], a[36:39], v[196:199]
ds_read_b64_tr_b16 a[82:83], v12 offset:1024
v_mfma_f32_16x16x32_bf16 v[196:199], a[92:95], a[52:55], v[196:199]
ds_read_b64_tr_b16 a[84:85], v12 offset:8192
v_mfma_f32_16x16x32_bf16 v[188:191], a[92:95], a[48:51], v[188:191]
ds_read_b64_tr_b16 a[86:87], v12 offset:9216
v_mfma_f32_16x16x32_bf16 v[188:191], a[88:91], a[32:35], v[188:191]
s_waitcnt lgkmcnt(4)
v_mfma_f32_16x16x32_bf16 v[216:219], a[32:35], a[96:99], v[216:219]
ds_read_b64_tr_b16 a[88:89], v13 offset:0
s_add_u32 m0, s17, 0x8400
v_mfma_f32_16x16x32_bf16 v[216:219], a[48:51], a[100:103], v[216:219]
buffer_load_dwordx4 v5, s[52:55], s13 offen lds
v_mfma_f32_16x16x32_bf16 v[224:227], a[52:55], a[100:103], v[224:227]
ds_read_b64_tr_b16 a[90:91], v13 offset:1024
v_mfma_f32_16x16x32_bf16 v[224:227], a[36:39], a[96:99], v[224:227]
ds_read_b64_tr_b16 a[92:93], v13 offset:8192
v_mfma_f32_16x16x32_bf16 v[232:235], a[40:43], a[96:99], v[232:235]
ds_read_b64_tr_b16 a[94:95], v13 offset:9216
v_mfma_f32_16x16x32_bf16 v[232:235], a[56:59], a[100:103], v[232:235]
v_mfma_f32_16x16x32_bf16 v[240:243], a[60:63], a[100:103], v[240:243]
v_mfma_f32_16x16x32_bf16 v[240:243], a[44:47], a[96:99], v[240:243]
v_mfma_f32_16x16x32_bf16 v[244:247], a[44:47], a[104:107], v[244:247]
ds_read_b64_tr_b16 a[96:97], v12 offset:256
s_add_u32 m0, s17, 0x8800
v_mfma_f32_16x16x32_bf16 v[244:247], a[60:63], a[108:111], v[244:247]
buffer_load_dwordx4 v6, s[52:55], 0 offen lds
v_mfma_f32_16x16x32_bf16 v[236:239], a[56:59], a[108:111], v[236:239]
ds_read_b64_tr_b16 a[98:99], v12 offset:1280
v_mfma_f32_16x16x32_bf16 v[236:239], a[40:43], a[104:107], v[236:239]
ds_read_b64_tr_b16 a[100:101], v12 offset:8448
v_mfma_f32_16x16x32_bf16 v[228:231], a[36:39], a[104:107], v[228:231]
ds_read_b64_tr_b16 a[102:103], v12 offset:9472
v_mfma_f32_16x16x32_bf16 v[228:231], a[52:55], a[108:111], v[228:231]
v_mfma_f32_16x16x32_bf16 v[220:223], a[48:51], a[108:111], v[220:223]
v_mfma_f32_16x16x32_bf16 v[220:223], a[32:35], a[104:107], v[220:223]
s_add_u32 m0, s17, 0x8c00
s_waitcnt lgkmcnt(4)
L_S20:
v_mfma_f32_16x16x32_bf16 v[24:27], a[80:83], a[0:3], v[24:27]
ds_read_b64_tr_b16 a[104:105], v13 offset:256
s_waitcnt vmcnt(22)
v_mfma_f32_16x16x32_bf16 v[24:27], a[84:87], a[16:19], v[24:27]
buffer_load_dwordx4 v6, s[52:55], s13 offen lds
v_mfma_f32_16x16x32_bf16 v[32:35], a[84:87], a[20:23], v[32:35]
ds_read_b64_tr_b16 a[106:107], v13 offset:1280
v_mfma_f32_16x16x32_bf16 v[32:35], a[80:83], a[4:7], v[32:35]
ds_read_b64_tr_b16 a[108:109], v13 offset:8448
v_mfma_f32_16x16x32_bf16 v[40:43], a[80:83], a[8:11], v[40:43]
ds_read_b64_tr_b16 a[110:111], v13 offset:9472
v_mfma_f32_16x16x32_bf16 v[40:43], a[84:87], a[24:27], v[40:43]
ds_read_b128 a[32:35], v8 offset:32768
v_mfma_f32_16x16x32_bf16 v[48:51], a[84:87], a[28:31], v[48:51]
ds_read_b128 a[48:51], v9 offset:32768
v_mfma_f32_16x16x32_bf16 v[48:51], a[80:83], a[12:15], v[48:51]
ds_read_b128 a[36:39], v8 offset:34816
s_add_u32 m0, s18, 0xc000
v_mfma_f32_16x16x32_bf16 v[52:55], a[88:91], a[12:15], v[52:55]
buffer_load_dwordx4 v7, s[68:71], 0 offen lds
v_mfma_f32_16x16x32_bf16 v[52:55], a[92:95], a[28:31], v[52:55]
ds_read_b64_tr_b16 a[80:81], v12 offset:512
v_mfma_f32_16x16x32_bf16 v[44:47], a[92:95], a[24:27], v[44:47]
ds_read_b64_tr_b16 a[82:83], v12 offset:1536
v_mfma_f32_16x16x32_bf16 v[44:47], a[88:91], a[8:11], v[44:47]
ds_read_b64_tr_b16 a[84:85], v12 offset:8704
v_mfma_f32_16x16x32_bf16 v[36:39], a[88:91], a[4:7], v[36:39]
ds_read_b64_tr_b16 a[86:87], v12 offset:9728
v_mfma_f32_16x16x32_bf16 v[36:39], a[92:95], a[20:23], v[36:39]
ds_read_b128 a[52:55], v9 offset:34816
v_mfma_f32_16x16x32_bf16 v[28:31], a[92:95], a[16:19], v[28:31]
ds_read_b128 a[40:43], v8 offset:36864
s_waitcnt lgkmcnt(9)
v_mfma_f32_16x16x32_bf16 v[28:31], a[88:91], a[0:3], v[28:31]
ds_read_b128 a[56:59], v9 offset:36864
s_add_u32 m0, s18, 0xd000
v_mfma_f32_16x16x32_bf16 v[56:59], a[96:99], a[0:3], v[56:59]
buffer_load_dwordx4 v7, s[68:71], s25 offen lds
v_mfma_f32_16x16x32_bf16 v[56:59], a[100:103], a[16:19], v[56:59]
ds_read_b64_tr_b16 a[88:89], v13 offset:512
v_mfma_f32_16x16x32_bf16 v[64:67], a[100:103], a[20:23], v[64:67]
ds_read_b64_tr_b16 a[90:91], v13 offset:1536
v_mfma_f32_16x16x32_bf16 v[64:67], a[96:99], a[4:7], v[64:67]
ds_read_b64_tr_b16 a[92:93], v13 offset:8704
v_mfma_f32_16x16x32_bf16 v[72:75], a[96:99], a[8:11], v[72:75]
ds_read_b64_tr_b16 a[94:95], v13 offset:9728
v_mfma_f32_16x16x32_bf16 v[72:75], a[100:103], a[24:27], v[72:75]
ds_read_b128 a[44:47], v8 offset:38912
v_mfma_f32_16x16x32_bf16 v[80:83], a[100:103], a[28:31], v[80:83]
ds_read_b128 a[60:63], v9 offset:38912
v_mfma_f32_16x16x32_bf16 v[80:83], a[96:99], a[12:15], v[80:83]
s_add_u32 m0, s18, 0xe000
v_mfma_f32_16x16x32_bf16 v[84:87], a[104:107], a[12:15], v[84:87]
buffer_load_dwordx4 v7, s[68:71], s26 offen lds
v_mfma_f32_16x16x32_bf16 v[84:87], a[108:111], a[28:31], v[84:87]
ds_read_b64_tr_b16 a[96:97], v12 offset:768
v_lshl_add_u32 v5, s42, 19, v5
v_mfma_f32_16x16x32_bf16 v[76:79], a[108:111], a[24:27], v[76:79]
ds_read_b64_tr_b16 a[98:99], v12 offset:1792
v_lshl_add_u32 v6, s42, 19, v6
v_mfma_f32_16x16x32_bf16 v[76:79], a[104:107], a[8:11], v[76:79]
ds_read_b64_tr_b16 a[100:101], v12 offset:8960
v_lshl_add_u32 v7, s42, 18, v7
v_mfma_f32_16x16x32_bf16 v[68:71], a[104:107], a[4:7], v[68:71]
ds_read_b64_tr_b16 a[102:103], v12 offset:9984
v_lshl_add_u32 v7, s42, 17, v7
v_mfma_f32_16x16x32_bf16 v[68:71], a[108:111], a[20:23], v[68:71]
s_waitcnt vmcnt(13)
v_accvgpr_read_b32 v18, a144
v_lshlrev_b32 v1, 16, v18
v_mfma_f32_16x16x32_bf16 v[60:63], a[108:111], a[16:19], v[60:63]
L_padA10:
s_cmp_eq_u32 s95, 1
s_cbranch_scc1 L_hopA_ret
v_and_b32 v18, 0xffff0000, v18
v_accvgpr_read_b32 v21, a128
v_mfma_f32_16x16x32_bf16 v[60:63], a[104:107], a[0:3], v[60:63]
s_add_u32 m0, s16, 0x8000
s_waitcnt lgkmcnt(4)
s_waitcnt lgkmcnt(6)
v_mfma_f32_16x16x32_bf16 v[88:91], a[80:83], a[0:3], v[88:91]
buffer_load_dwordx4 v22, s[44:47], s20 offen lds
v_mfma_f32_16x16x32_bf16 v[88:91], a[84:87], a[16:19], v[88:91]
ds_read_b64_tr_b16 a[104:105], v13 offset:768
v_lshlrev_b32 v20, 16, v21
v_mfma_f32_16x16x32_bf16 v[96:99], a[84:87], a[20:23], v[96:99]
ds_read_b64_tr_b16 a[106:107], v13 offset:1792
v_and_b32 v21, 0xffff0000, v21
v_mfma_f32_16x16x32_bf16 v[96:99], a[80:83], a[4:7], v[96:99]
ds_read_b64_tr_b16 a[108:109], v13 offset:8960
v_mul_f32 v2, v1, v20
v_mfma_f32_16x16x32_bf16 v[104:107], a[80:83], a[8:11], v[104:107]
ds_read_b64_tr_b16 a[110:111], v13 offset:9984
v_fmac_f32 v2, v18, v21
v_mfma_f32_16x16x32_bf16 v[104:107], a[84:87], a[24:27], v[104:107]
v_accvgpr_read_b32 v21, a136
v_lshlrev_b32 v20, 16, v21
v_mfma_f32_16x16x32_bf16 v[112:115], a[84:87], a[28:31], v[112:115]
s_add_u32 m0, s16, 0x8400
v_and_b32 v21, 0xffff0000, v21
v_mul_f32 v3, v1, v20
v_mfma_f32_16x16x32_bf16 v[112:115], a[80:83], a[12:15], v[112:115]
buffer_load_dwordx4 v23, s[44:47], s20 offen lds
v_mfma_f32_16x16x32_bf16 v[116:119], a[88:91], a[12:15], v[116:119]
ds_read_b64_tr_b16 a[80:81], v14 offset:0
v_fmac_f32 v3, v18, v21
v_mfma_f32_16x16x32_bf16 v[116:119], a[92:95], a[28:31], v[116:119]
ds_read_b64_tr_b16 a[82:83], v14 offset:256
v_accvgpr_read_b32 v18, a145
v_mfma_f32_16x16x32_bf16 v[108:111], a[92:95], a[24:27], v[108:111]
ds_read_b64_tr_b16 a[84:85], v14 offset:2048
v_lshlrev_b32 v1, 16, v18
v_mfma_f32_16x16x32_bf16 v[108:111], a[88:91], a[8:11], v[108:111]
ds_read_b64_tr_b16 a[86:87], v14 offset:2304
v_and_b32 v18, 0xffff0000, v18
v_mfma_f32_16x16x32_bf16 v[100:103], a[88:91], a[4:7], v[100:103]
v_accvgpr_read_b32 v21, a129
v_lshlrev_b32 v20, 16, v21
v_mfma_f32_16x16x32_bf16 v[100:103], a[92:95], a[20:23], v[100:103]
s_add_u32 m0, s16, 0x8800
v_and_b32 v21, 0xffff0000, v21
v_fmac_f32 v2, v1, v20
v_mfma_f32_16x16x32_bf16 v[92:95], a[92:95], a[16:19], v[92:95]
buffer_load_dwordx4 v22, s[44:47], s21 offen lds
v_mfma_f32_16x16x32_bf16 v[92:95], a[88:91], a[0:3], v[92:95]
s_waitcnt lgkmcnt(4)
v_fmac_f32 v2, v18, v21
v_accvgpr_read_b32 v21, a137
v_mfma_f32_16x16x32_bf16 v[120:123], a[96:99], a[0:3], v[120:123]
ds_read_b64_tr_b16 a[88:89], v15 offset:0
v_lshlrev_b32 v20, 16, v21
v_mfma_f32_16x16x32_bf16 v[120:123], a[100:103], a[16:19], v[120:123]
ds_read_b64_tr_b16 a[90:91], v15 offset:256
v_and_b32 v21, 0xffff0000, v21
v_mfma_f32_16x16x32_bf16 v[128:131], a[100:103], a[20:23], v[128:131]
ds_read_b64_tr_b16 a[92:93], v15 offset:2048
v_fmac_f32 v3, v1, v20
v_mfma_f32_16x16x32_bf16 v[128:131], a[96:99], a[4:7], v[128:131]
ds_read_b64_tr_b16 a[94:95], v15 offset:2304
v_fmac_f32 v3, v18, v21
v_mfma_f32_16x16x32_bf16 v[136:139], a[96:99], a[8:11], v[136:139]
s_add_u32 m0, s16, 0x8c00
v_accvgpr_read_b32 v18, a146
v_lshlrev_b32 v1, 16, v18
v_mfma_f32_16x16x32_bf16 v[136:139], a[100:103], a[24:27], v[136:139]
buffer_load_dwordx4 v23, s[44:47], s21 offen lds
v_mfma_f32_16x16x32_bf16 v[144:147], a[100:103], a[28:31], v[144:147]
v_and_b32 v18, 0xffff0000, v18
v_accvgpr_read_b32 v21, a130
v_mfma_f32_16x16x32_bf16 v[144:147], a[96:99], a[12:15], v[144:147]
v_lshlrev_b32 v20, 16, v21
v_and_b32 v21, 0xffff0000, v21
v_mfma_f32_16x16x32_bf16 v[148:151], a[104:107], a[12:15], v[148:151]
ds_read_b64_tr_b16 a[96:97], v14 offset:4096
v_fmac_f32 v2, v1, v20
v_mfma_f32_16x16x32_bf16 v[148:151], a[108:111], a[28:31], v[148:151]
ds_read_b64_tr_b16 a[98:99], v14 offset:4352
v_fmac_f32 v2, v18, v21
v_mfma_f32_16x16x32_bf16 v[140:143], a[108:111], a[24:27], v[140:143]
ds_read_b64_tr_b16 a[100:101], v14 offset:6144
v_accvgpr_read_b32 v21, a138
v_mfma_f32_16x16x32_bf16 v[140:143], a[104:107], a[8:11], v[140:143]
ds_read_b64_tr_b16 a[102:103], v14 offset:6400
s_add_u32 m0, s16, 0x9000
v_mfma_f32_16x16x32_bf16 v[132:135], a[104:107], a[4:7], v[132:135]
buffer_load_dwordx4 v22, s[44:47], s22 offen lds
v_mfma_f32_16x16x32_bf16 v[132:135], a[108:111], a[20:23], v[132:135]
v_lshlrev_b32 v20, 16, v21
v_and_b32 v21, 0xffff0000, v21
v_mfma_f32_16x16x32_bf16 v[124:127], a[108:111], a[16:19], v[124:127]
v_fmac_f32 v3, v1, v20
v_fmac_f32 v3, v18, v21
v_mfma_f32_16x16x32_bf16 v[124:127], a[104:107], a[0:3], v[124:127]
s_waitcnt lgkmcnt(4)
v_accvgpr_read_b32 v18, a147
v_lshlrev_b32 v1, 16, v18
v_mfma_f32_16x16x32_bf16 v[152:155], a[80:83], a[0:3], v[152:155]
ds_read_b64_tr_b16 a[104:105], v15 offset:4096
v_and_b32 v18, 0xffff0000, v18
v_mfma_f32_16x16x32_bf16 v[152:155], a[84:87], a[16:19], v[152:155]
ds_read_b64_tr_b16 a[106:107], v15 offset:4352
v_accvgpr_read_b32 v21, a131
v_mfma_f32_16x16x32_bf16 v[160:163], a[84:87], a[20:23], v[160:163]
ds_read_b64_tr_b16 a[108:109], v15 offset:6144
s_add_u32 m0, s16, 0x9400
v_mfma_f32_16x16x32_bf16 v[160:163], a[80:83], a[4:7], v[160:163]
buffer_load_dwordx4 v23, s[44:47], s22 offen lds
v_mfma_f32_16x16x32_bf16 v[168:171], a[80:83], a[8:11], v[168:171]
ds_read_b64_tr_b16 a[110:111], v15 offset:6400
v_lshlrev_b32 v20, 16, v21
v_mfma_f32_16x16x32_bf16 v[168:171], a[84:87], a[24:27], v[168:171]
v_and_b32 v21, 0xffff0000, v21
v_fmac_f32 v2, v1, v20
v_mfma_f32_16x16x32_bf16 v[176:179], a[84:87], a[28:31], v[176:179]
v_fmac_f32 v2, v18, v21
v_accvgpr_read_b32 v21, a139
v_mfma_f32_16x16x32_bf16 v[176:179], a[80:83], a[12:15], v[176:179]
v_lshlrev_b32 v20, 16, v21
v_and_b32 v21, 0xffff0000, v21
v_mfma_f32_16x16x32_bf16 v[180:183], a[88:91], a[12:15], v[180:183]
ds_read_b64_tr_b16 a[80:81], v14 offset:8192
v_fmac_f32 v3, v1, v20
v_mfma_f32_16x16x32_bf16 v[180:183], a[92:95], a[28:31], v[180:183]
ds_read_b64_tr_b16 a[82:83], v14 offset:8448
s_add_u32 m0, s16, 0x9800
v_mfma_f32_16x16x32_bf16 v[172:175], a[92:95], a[24:27], v[172:175]
buffer_load_dwordx4 v22, s[44:47], s23 offen lds
v_mfma_f32_16x16x32_bf16 v[172:175], a[88:91], a[8:11], v[172:175]
ds_read_b64_tr_b16 a[84:85], v14 offset:10240
v_fmac_f32 v3, v18, v21
v_mfma_f32_16x16x32_bf16 v[164:167], a[88:91], a[4:7], v[164:167]
ds_read_b64_tr_b16 a[86:87], v14 offset:10496
s_waitcnt vmcnt(14)
v_accvgpr_read_b32 v18, a148
v_mfma_f32_16x16x32_bf16 v[164:167], a[92:95], a[20:23], v[164:167]
v_lshlrev_b32 v1, 16, v18
v_and_b32 v18, 0xffff0000, v18
v_mfma_f32_16x16x32_bf16 v[156:159], a[92:95], a[16:19], v[156:159]
v_accvgpr_read_b32 v21, a132
v_lshlrev_b32 v20, 16, v21
v_mfma_f32_16x16x32_bf16 v[156:159], a[88:91], a[0:3], v[156:159]
s_waitcnt lgkmcnt(4)
v_and_b32 v21, 0xffff0000, v21
v_fmac_f32 v2, v1, v20
v_mfma_f32_16x16x32_bf16 v[184:187], a[96:99], a[0:3], v[184:187]
ds_read_b64_tr_b16 a[88:89], v15 offset:8192
s_add_u32 m0, s16, 0x9c00
v_mfma_f32_16x16x32_bf16 v[184:187], a[100:103], a[16:19], v[184:187]
buffer_load_dwordx4 v23, s[44:47], s23 offen lds
v_mfma_f32_16x16x32_bf16 v[192:195], a[100:103], a[20:23], v[192:195]
ds_read_b64_tr_b16 a[90:91], v15 offset:8448
v_fmac_f32 v2, v18, v21
v_mfma_f32_16x16x32_bf16 v[192:195], a[96:99], a[4:7], v[192:195]
ds_read_b64_tr_b16 a[92:93], v15 offset:10240
v_accvgpr_read_b32 v21, a140
v_mfma_f32_16x16x32_bf16 v[200:203], a[96:99], a[8:11], v[200:203]
ds_read_b64_tr_b16 a[94:95], v15 offset:10496
v_add_u32 v12, 0xffff0000, v12
v_mfma_f32_16x16x32_bf16 v[200:203], a[100:103], a[24:27], v[200:203]
v_add_u32 v13, 0xffff0000, v13
v_add_u32 v14, 0xffff0000, v14
v_mfma_f32_16x16x32_bf16 v[208:211], a[100:103], a[28:31], v[208:211]
v_add_u32 v15, 0xffff0000, v15
v_lshlrev_b32 v20, 16, v21
v_mfma_f32_16x16x32_bf16 v[208:211], a[96:99], a[12:15], v[208:211]
v_and_b32 v21, 0xffff0000, v21
v_fmac_f32 v3, v1, v20
v_mfma_f32_16x16x32_bf16 v[212:215], a[104:107], a[12:15], v[212:215]
s_waitcnt vmcnt(25) lgkmcnt(0)
v_fmac_f32 v3, v18, v21
v_accvgpr_read_b32 v18, a149
v_mfma_f32_16x16x32_bf16 v[212:215], a[108:111], a[28:31], v[212:215]
s_barrier
s_add_u32 m0, s17, 0x10000
v_lshlrev_b32 v1, 16, v18
v_mfma_f32_16x16x32_bf16 v[204:207], a[108:111], a[24:27], v[204:207]
buffer_load_dwordx4 v5, s[52:55], 0 offen lds
v_mfma_f32_16x16x32_bf16 v[204:207], a[104:107], a[8:11], v[204:207]
ds_read_b64_tr_b16 a[96:97], v12 offset:0
v_and_b32 v18, 0xffff0000, v18
v_mfma_f32_16x16x32_bf16 v[196:199], a[104:107], a[4:7], v[196:199]
ds_read_b64_tr_b16 a[98:99], v12 offset:1024
v_accvgpr_read_b32 v21, a133
v_mfma_f32_16x16x32_bf16 v[196:199], a[108:111], a[20:23], v[196:199]
ds_read_b64_tr_b16 a[100:101], v12 offset:8192
v_lshlrev_b32 v20, 16, v21
v_mfma_f32_16x16x32_bf16 v[188:191], a[108:111], a[16:19], v[188:191]
ds_read_b64_tr_b16 a[102:103], v12 offset:9216
v_and_b32 v21, 0xffff0000, v21
v_mfma_f32_16x16x32_bf16 v[188:191], a[104:107], a[0:3], v[188:191]
s_waitcnt lgkmcnt(4)
v_fmac_f32 v2, v1, v20
v_fmac_f32 v2, v18, v21
v_mfma_f32_16x16x32_bf16 v[216:219], a[0:3], a[80:83], v[216:219]
ds_read_b64_tr_b16 a[104:105], v13 offset:0
v_accvgpr_read_b32 v21, a141
v_mfma_f32_16x16x32_bf16 v[216:219], a[16:19], a[84:87], v[216:219]
ds_read_b64_tr_b16 a[106:107], v13 offset:1024
s_add_u32 m0, s17, 0x10400
v_mfma_f32_16x16x32_bf16 v[224:227], a[20:23], a[84:87], v[224:227]
buffer_load_dwordx4 v5, s[52:55], s13 offen lds
v_mfma_f32_16x16x32_bf16 v[224:227], a[4:7], a[80:83], v[224:227]
ds_read_b64_tr_b16 a[108:109], v13 offset:8192
v_lshlrev_b32 v20, 16, v21
v_mfma_f32_16x16x32_bf16 v[232:235], a[8:11], a[80:83], v[232:235]
ds_read_b64_tr_b16 a[110:111], v13 offset:9216
v_and_b32 v21, 0xffff0000, v21
v_mfma_f32_16x16x32_bf16 v[232:235], a[24:27], a[84:87], v[232:235]
s_lshl_b32 s15, s2, 2
v_fmac_f32 v3, v1, v20
v_fmac_f32 v3, v18, v21
v_mfma_f32_16x16x32_bf16 v[240:243], a[28:31], a[84:87], v[240:243]
s_add_u32 s15, s15, s4
v_accvgpr_read_b32 v18, a150
v_lshlrev_b32 v1, 16, v18
v_mfma_f32_16x16x32_bf16 v[240:243], a[12:15], a[80:83], v[240:243]
s_lshl_b32 s15, s15, 12
v_and_b32 v18, 0xffff0000, v18
v_accvgpr_read_b32 v21, a134
v_mfma_f32_16x16x32_bf16 v[244:247], a[12:15], a[88:91], v[244:247]
ds_read_b64_tr_b16 a[80:81], v12 offset:256
v_lshlrev_b32 v20, 16, v21
v_mfma_f32_16x16x32_bf16 v[244:247], a[28:31], a[92:95], v[244:247]
ds_read_b64_tr_b16 a[82:83], v12 offset:1280
v_and_b32 v21, 0xffff0000, v21
v_mfma_f32_16x16x32_bf16 v[236:239], a[24:27], a[92:95], v[236:239]
ds_read_b64_tr_b16 a[84:85], v12 offset:8448
s_add_u32 m0, s17, 0x10800
v_mfma_f32_16x16x32_bf16 v[236:239], a[8:11], a[88:91], v[236:239]
buffer_load_dwordx4 v6, s[52:55], 0 offen lds
v_mfma_f32_16x16x32_bf16 v[228:231], a[4:7], a[88:91], v[228:231]
ds_read_b64_tr_b16 a[86:87], v12 offset:9472
v_fmac_f32 v2, v1, v20
v_mfma_f32_16x16x32_bf16 v[228:231], a[20:23], a[92:95], v[228:231]
s_add_u32 s15, s15, 0x3800000
v_fmac_f32 v2, v18, v21
v_accvgpr_read_b32 v21, a142
v_mfma_f32_16x16x32_bf16 v[220:223], a[16:19], a[92:95], v[220:223]
v_lshlrev_b32 v20, 16, v21
v_and_b32 v21, 0xffff0000, v21
v_mfma_f32_16x16x32_bf16 v[220:223], a[0:3], a[88:91], v[220:223]
s_waitcnt lgkmcnt(4)
v_fmac_f32 v3, v1, v20
v_fmac_f32 v3, v18, v21
L_S21:
v_mfma_f32_16x16x32_bf16 v[24:27], a[96:99], a[32:35], v[24:27]
ds_read_b64_tr_b16 a[88:89], v13 offset:256
s_waitcnt vmcnt(19)
v_mfma_f32_16x16x32_bf16 v[24:27], a[100:103], a[48:51], v[24:27]
ds_read_b64_tr_b16 a[90:91], v13 offset:1280
v_accvgpr_read_b32 v18, a151
v_mfma_f32_16x16x32_bf16 v[32:35], a[100:103], a[52:55], v[32:35]
ds_read_b64_tr_b16 a[92:93], v13 offset:8448
s_add_u32 m0, s17, 0x10c00
v_mfma_f32_16x16x32_bf16 v[32:35], a[96:99], a[36:39], v[32:35]
buffer_load_dwordx4 v6, s[52:55], s13 offen lds
v_mfma_f32_16x16x32_bf16 v[40:43], a[96:99], a[40:43], v[40:43]
ds_read_b64_tr_b16 a[94:95], v13 offset:9472
v_lshlrev_b32 v1, 16, v18
v_mfma_f32_16x16x32_bf16 v[40:43], a[100:103], a[56:59], v[40:43]
ds_read_b128 a[0:3], v8 offset:0
v_and_b32 v18, 0xffff0000, v18
v_mfma_f32_16x16x32_bf16 v[48:51], a[100:103], a[60:63], v[48:51]
ds_read_b128 a[16:19], v9 offset:0
v_accvgpr_read_b32 v21, a135
v_mfma_f32_16x16x32_bf16 v[48:51], a[96:99], a[44:47], v[48:51]
ds_read_b128 a[4:7], v8 offset:2048
v_lshlrev_b32 v20, 16, v21
v_mfma_f32_16x16x32_bf16 v[52:55], a[104:107], a[44:47], v[52:55]
ds_read_b64_tr_b16 a[96:97], v12 offset:512
v_and_b32 v21, 0xffff0000, v21
v_mfma_f32_16x16x32_bf16 v[52:55], a[108:111], a[60:63], v[52:55]
ds_read_b64_tr_b16 a[98:99], v12 offset:1536
v_fmac_f32 v2, v1, v20
v_mfma_f32_16x16x32_bf16 v[44:47], a[108:111], a[56:59], v[44:47]
ds_read_b64_tr_b16 a[100:101], v12 offset:8704
v_fmac_f32 v2, v18, v21
v_mfma_f32_16x16x32_bf16 v[44:47], a[104:107], a[40:43], v[44:47]
ds_read_b64_tr_b16 a[102:103], v12 offset:9728
s_add_u32 m0, s18, 0x14000
v_mfma_f32_16x16x32_bf16 v[36:39], a[104:107], a[36:39], v[36:39]
buffer_load_dwordx4 v7, s[68:71], 0 offen lds
v_mfma_f32_16x16x32_bf16 v[36:39], a[108:111], a[52:55], v[36:39]
ds_read_b128 a[20:23], v9 offset:2048
v_accvgpr_read_b32 v21, a143
v_mfma_f32_16x16x32_bf16 v[28:31], a[108:111], a[48:51], v[28:31]
ds_read_b128 a[8:11], v8 offset:4096
v_lshlrev_b32 v20, 16, v21
v_mfma_f32_16x16x32_bf16 v[28:31], a[104:107], a[32:35], v[28:31]
ds_read_b128 a[24:27], v9 offset:4096
s_waitcnt lgkmcnt(10)
v_mfma_f32_16x16x32_bf16 v[56:59], a[80:83], a[32:35], v[56:59]
ds_read_b64_tr_b16 a[104:105], v13 offset:512
v_and_b32 v21, 0xffff0000, v21
v_mfma_f32_16x16x32_bf16 v[56:59], a[84:87], a[48:51], v[56:59]
ds_read_b64_tr_b16 a[106:107], v13 offset:1536
v_fmac_f32 v3, v1, v20
v_mfma_f32_16x16x32_bf16 v[64:67], a[84:87], a[52:55], v[64:67]
ds_read_b64_tr_b16 a[108:109], v13 offset:8704
v_fmac_f32 v3, v18, v21
v_mfma_f32_16x16x32_bf16 v[64:67], a[80:83], a[36:39], v[64:67]
ds_read_b64_tr_b16 a[110:111], v13 offset:9728
s_add_u32 m0, s18, 0x15000
v_mfma_f32_16x16x32_bf16 v[72:75], a[80:83], a[40:43], v[72:75]
buffer_load_dwordx4 v7, s[68:71], s25 offen lds
v_mfma_f32_16x16x32_bf16 v[72:75], a[84:87], a[56:59], v[72:75]
ds_read_b128 a[12:15], v8 offset:6144
v_add_f32_dpp v2, v2, v2 row_ror:8 row_mask:0xf bank_mask:0xf
v_mfma_f32_16x16x32_bf16 v[80:83], a[84:87], a[60:63], v[80:83]
ds_read_b128 a[28:31], v9 offset:6144
v_add_f32_dpp v3, v3, v3 row_ror:8 row_mask:0xf bank_mask:0xf
v_mfma_f32_16x16x32_bf16 v[80:83], a[80:83], a[44:47], v[80:83]
v_add_f32_dpp v2, v2, v2 row_ror:4 row_mask:0xf bank_mask:0xf
v_add_f32_dpp v3, v3, v3 row_ror:4 row_mask:0xf bank_mask:0xf
v_mfma_f32_16x16x32_bf16 v[84:87], a[88:91], a[44:47], v[84:87]
ds_read_b64_tr_b16 a[80:81], v12 offset:768
v_add_f32_dpp v2, v2, v2 row_ror:2 row_mask:0xf bank_mask:0xf
v_mfma_f32_16x16x32_bf16 v[84:87], a[92:95], a[60:63], v[84:87]
ds_read_b64_tr_b16 a[82:83], v12 offset:1792
v_add_f32_dpp v3, v3, v3 row_ror:2 row_mask:0xf bank_mask:0xf
v_mfma_f32_16x16x32_bf16 v[76:79], a[92:95], a[56:59], v[76:79]
ds_read_b64_tr_b16 a[84:85], v12 offset:8960
v_add_f32_dpp v2, v2, v2 row_ror:1 row_mask:0xf bank_mask:0xf
v_mfma_f32_16x16x32_bf16 v[76:79], a[88:91], a[40:43], v[76:79]
ds_read_b64_tr_b16 a[86:87], v12 offset:9984
v_add_f32_dpp v3, v3, v3 row_ror:1 row_mask:0xf bank_mask:0xf
v_mfma_f32_16x16x32_bf16 v[68:71], a[88:91], a[36:39], v[68:71]
s_add_u32 m0, s18, 0x16000
v_mov_b32 v1, v2
v_mov_b32 v18, v3
v_mfma_f32_16x16x32_bf16 v[68:71], a[92:95], a[52:55], v[68:71]
buffer_load_dwordx4 v7, s[68:71], s26 offen lds
v_mfma_f32_16x16x32_bf16 v[60:63], a[92:95], a[48:51], v[60:63]
v_permlane16_swap_b32 v1, v2
v_permlane16_swap_b32 v18, v3
v_mfma_f32_16x16x32_bf16 v[60:63], a[88:91], a[32:35], v[60:63]
s_waitcnt lgkmcnt(6)
v_add_f32 v2, v2, v1
v_add_f32 v3, v3, v18
v_mfma_f32_16x16x32_bf16 v[88:91], a[96:99], a[32:35], v[88:91]
ds_read_b64_tr_b16 a[88:89], v13 offset:768
v_mov_b32 v1, v2
v_mfma_f32_16x16x32_bf16 v[88:91], a[100:103], a[48:51], v[88:91]
ds_read_b64_tr_b16 a[90:91], v13 offset:1792
v_mov_b32 v18, v3
v_mfma_f32_16x16x32_bf16 v[96:99], a[100:103], a[52:55], v[96:99]
ds_read_b64_tr_b16 a[92:93], v13 offset:8960
v_permlane32_swap_b32 v1, v2
v_mfma_f32_16x16x32_bf16 v[96:99], a[96:99], a[36:39], v[96:99]
ds_read_b64_tr_b16 a[94:95], v13 offset:9984
v_permlane32_swap_b32 v18, v3
v_mfma_f32_16x16x32_bf16 v[104:107], a[96:99], a[40:43], v[104:107]
v_add_f32 v2, v2, v1
v_add_f32 v3, v3, v18
v_mfma_f32_16x16x32_bf16 v[104:107], a[100:103], a[56:59], v[104:107]
buffer_load_dword v23, off, s[84:87], s10 sc1
v_mfma_f32_16x16x32_bf16 v[112:115], a[100:103], a[60:63], v[112:115]
v_mul_f32 v2, 0xbfb8aa3b, v2
v_mul_f32 v3, 0xbfb8aa3b, v3
v_mfma_f32_16x16x32_bf16 v[112:115], a[96:99], a[44:47], v[112:115]
v_exp_f32 v2, v2
v_mfma_f32_16x16x32_bf16 v[116:119], a[104:107], a[44:47], v[116:119]
ds_read_b64_tr_b16 a[96:97], v14 offset:0
v_mfma_f32_16x16x32_bf16 v[116:119], a[108:111], a[60:63], v[116:119]
ds_read_b64_tr_b16 a[98:99], v14 offset:256
v_mfma_f32_16x16x32_bf16 v[108:111], a[108:111], a[56:59], v[108:111]
ds_read_b64_tr_b16 a[100:101], v14 offset:2048
v_mfma_f32_16x16x32_bf16 v[108:111], a[104:107], a[40:43], v[108:111]
ds_read_b64_tr_b16 a[102:103], v14 offset:2304
v_mfma_f32_16x16x32_bf16 v[100:103], a[104:107], a[36:39], v[100:103]
v_exp_f32 v3, v3
v_mfma_f32_16x16x32_bf16 v[100:103], a[108:111], a[52:55], v[100:103]
v_add_f32 v2, 1.0, v2
v_add_f32 v3, 1.0, v3
v_mfma_f32_16x16x32_bf16 v[92:95], a[108:111], a[48:51], v[92:95]
v_rcp_f32 v2, v2
v_mfma_f32_16x16x32_bf16 v[92:95], a[104:107], a[32:35], v[92:95]
s_waitcnt lgkmcnt(4)
v_rcp_f32 v3, v3
v_mfma_f32_16x16x32_bf16 v[120:123], a[80:83], a[32:35], v[120:123]
ds_read_b64_tr_b16 a[104:105], v15 offset:0
v_mfma_f32_16x16x32_bf16 v[120:123], a[84:87], a[48:51], v[120:123]
ds_read_b64_tr_b16 a[106:107], v15 offset:256
v_mfma_f32_16x16x32_bf16 v[128:131], a[84:87], a[52:55], v[128:131]
ds_read_b64_tr_b16 a[108:109], v15 offset:2048
v_mfma_f32_16x16x32_bf16 v[128:131], a[80:83], a[36:39], v[128:131]
ds_read_b64_tr_b16 a[110:111], v15 offset:2304
v_mfma_f32_16x16x32_bf16 v[136:139], a[80:83], a[40:43], v[136:139]
buffer_store_dwordx2 v[2:3], off, s[88:91], s101 sc1
v_mfma_f32_16x16x32_bf16 v[136:139], a[84:87], a[56:59], v[136:139]
v_mfma_f32_16x16x32_bf16 v[144:147], a[84:87], a[60:63], v[144:147]
v_mfma_f32_16x16x32_bf16 v[144:147], a[80:83], a[44:47], v[144:147]
v_mfma_f32_16x16x32_bf16 v[148:151], a[88:91], a[44:47], v[148:151]
ds_read_b64_tr_b16 a[80:81], v14 offset:4096
v_mfma_f32_16x16x32_bf16 v[148:151], a[92:95], a[60:63], v[148:151]
ds_read_b64_tr_b16 a[82:83], v14 offset:4352
v_mfma_f32_16x16x32_bf16 v[140:143], a[92:95], a[56:59], v[140:143]
ds_read_b64_tr_b16 a[84:85], v14 offset:6144
v_mfma_f32_16x16x32_bf16 v[140:143], a[88:91], a[40:43], v[140:143]
ds_read_b64_tr_b16 a[86:87], v14 offset:6400
v_mfma_f32_16x16x32_bf16 v[132:135], a[88:91], a[36:39], v[132:135]
v_mfma_f32_16x16x32_bf16 v[132:135], a[92:95], a[52:55], v[132:135]
v_mfma_f32_16x16x32_bf16 v[124:127], a[92:95], a[48:51], v[124:127]
v_mfma_f32_16x16x32_bf16 v[124:127], a[88:91], a[32:35], v[124:127]
s_waitcnt lgkmcnt(4)
v_mfma_f32_16x16x32_bf16 v[152:155], a[96:99], a[32:35], v[152:155]
ds_read_b64_tr_b16 a[88:89], v15 offset:4096
v_mfma_f32_16x16x32_bf16 v[152:155], a[100:103], a[48:51], v[152:155]
ds_read_b64_tr_b16 a[90:91], v15 offset:4352
v_mfma_f32_16x16x32_bf16 v[160:163], a[100:103], a[52:55], v[160:163]
ds_read_b64_tr_b16 a[92:93], v15 offset:6144
v_mfma_f32_16x16x32_bf16 v[160:163], a[96:99], a[36:39], v[160:163]
ds_read_b64_tr_b16 a[94:95], v15 offset:6400
v_mfma_f32_16x16x32_bf16 v[168:171], a[96:99], a[40:43], v[168:171]
v_mfma_f32_16x16x32_bf16 v[168:171], a[100:103], a[56:59], v[168:171]
v_mfma_f32_16x16x32_bf16 v[176:179], a[100:103], a[60:63], v[176:179]
v_mfma_f32_16x16x32_bf16 v[176:179], a[96:99], a[44:47], v[176:179]
v_mfma_f32_16x16x32_bf16 v[180:183], a[104:107], a[44:47], v[180:183]
ds_read_b64_tr_b16 a[96:97], v14 offset:8192
v_mfma_f32_16x16x32_bf16 v[180:183], a[108:111], a[60:63], v[180:183]
ds_read_b64_tr_b16 a[98:99], v14 offset:8448
v_mfma_f32_16x16x32_bf16 v[172:175], a[108:111], a[56:59], v[172:175]
ds_read_b64_tr_b16 a[100:101], v14 offset:10240
v_mfma_f32_16x16x32_bf16 v[172:175], a[104:107], a[40:43], v[172:175]
ds_read_b64_tr_b16 a[102:103], v14 offset:10496
v_mfma_f32_16x16x32_bf16 v[164:167], a[104:107], a[36:39], v[164:167]
v_mfma_f32_16x16x32_bf16 v[164:167], a[108:111], a[52:55], v[164:167]
v_mfma_f32_16x16x32_bf16 v[156:159], a[108:111], a[48:51], v[156:159]
v_mfma_f32_16x16x32_bf16 v[156:159], a[104:107], a[32:35], v[156:159]
s_waitcnt lgkmcnt(4)
v_mfma_f32_16x16x32_bf16 v[184:187], a[80:83], a[32:35], v[184:187]
ds_read_b64_tr_b16 a[104:105], v15 offset:8192
v_mfma_f32_16x16x32_bf16 v[184:187], a[84:87], a[48:51], v[184:187]
ds_read_b64_tr_b16 a[106:107], v15 offset:8448
v_mfma_f32_16x16x32_bf16 v[192:195], a[84:87], a[52:55], v[192:195]
ds_read_b64_tr_b16 a[108:109], v15 offset:10240
v_mfma_f32_16x16x32_bf16 v[192:195], a[80:83], a[36:39], v[192:195]
ds_read_b64_tr_b16 a[110:111], v15 offset:10496
v_add_u32 v12, 0x8000, v12
v_mfma_f32_16x16x32_bf16 v[200:203], a[80:83], a[40:43], v[200:203]
v_add_u32 v13, 0x8000, v13
v_add_u32 v14, 0x8000, v14
v_mfma_f32_16x16x32_bf16 v[200:203], a[84:87], a[56:59], v[200:203]
v_add_u32 v15, 0x8000, v15
v_mfma_f32_16x16x32_bf16 v[208:211], a[84:87], a[60:63], v[208:211]
v_mfma_f32_16x16x32_bf16 v[208:211], a[80:83], a[44:47], v[208:211]
v_mfma_f32_16x16x32_bf16 v[212:215], a[88:91], a[44:47], v[212:215]
s_waitcnt vmcnt(1) lgkmcnt(0)
s_mov_b32 s92, 200000
L_spin_kv:
v_readfirstlane_b32 s93, v23
s_nop 1
s_cmp_ge_u32 s93, 8
s_cbranch_scc1 L_spun_kv
s_sub_u32 s92, s92, 1
s_cbranch_scc1 L_spun_kv
s_sleep 4
buffer_load_dword v23, off, s[84:87], s10 sc1
s_waitcnt vmcnt(0)
s_branch L_spin_kv
L_spun_kv:
v_mfma_f32_16x16x32_bf16 v[212:215], a[92:95], a[60:63], v[212:215]
s_barrier
s_add_u32 m0, s19, 0x0
v_mfma_f32_16x16x32_bf16 v[204:207], a[92:95], a[56:59], v[204:207]
buffer_load_dwordx4 v16, s[48:51], s32 offen offset:0 sc1 lds
v_mfma_f32_16x16x32_bf16 v[204:207], a[88:91], a[40:43], v[204:207]
ds_read_b64_tr_b16 a[80:81], v12 offset:0
v_mov_b32 v3, v16
v_mfma_f32_16x16x32_bf16 v[196:199], a[88:91], a[36:39], v[196:199]
ds_read_b64_tr_b16 a[82:83], v12 offset:1024
v_mov_b32 v22, 0x3f803f80
v_mfma_f32_16x16x32_bf16 v[196:199], a[92:95], a[52:55], v[196:199]
ds_read_b64_tr_b16 a[84:85], v12 offset:8192
s_mov_b32 s33, 0
v_mfma_f32_16x16x32_bf16 v[188:191], a[92:95], a[48:51], v[188:191]
ds_read_b64_tr_b16 a[86:87], v12 offset:9216
v_accvgpr_write_b32 a240, v22
v_mfma_f32_16x16x32_bf16 v[188:191], a[88:91], a[32:35], v[188:191]
s_waitcnt lgkmcnt(4)
v_accvgpr_write_b32 a241, v22
v_accvgpr_write_b32 a242, v22
v_mfma_f32_16x16x32_bf16 v[216:219], a[32:35], a[96:99], v[216:219]
buffer_load_dwordx4 v16, s[48:51], s32 offen offset:1024 sc1 lds
v_accvgpr_write_b32 a243, v22
v_mfma_f32_16x16x32_bf16 v[216:219], a[48:51], a[100:103], v[216:219]
ds_read_b64_tr_b16 a[88:89], v13 offset:0
s_mov_b32 s36, 0x33333333
v_mfma_f32_16x16x32_bf16 v[224:227], a[52:55], a[100:103], v[224:227]
ds_read_b64_tr_b16 a[90:91], v13 offset:1024
s_mov_b32 s37, 0xcccccccc
v_mfma_f32_16x16x32_bf16 v[224:227], a[36:39], a[96:99], v[224:227]
ds_read_b64_tr_b16 a[92:93], v13 offset:8192
v_cndmask_b32 v4, 0, v22, s[36:37]
v_mfma_f32_16x16x32_bf16 v[232:235], a[40:43], a[96:99], v[232:235]
ds_read_b64_tr_b16 a[94:95], v13 offset:9216
v_accvgpr_write_b32 a232, v4
v_mfma_f32_16x16x32_bf16 v[232:235], a[56:59], a[100:103], v[232:235]
v_accvgpr_write_b32 a233, v4
v_accvgpr_write_b32 a234, v4
v_mfma_f32_16x16x32_bf16 v[240:243], a[60:63], a[100:103], v[240:243]
v_accvgpr_write_b32 a235, v4
v_mfma_f32_16x16x32_bf16 v[240:243], a[44:47], a[96:99], v[240:243]
buffer_load_dwordx4 v16, s[48:51], s32 offen offset:2048 sc1 lds
v_mfma_f32_16x16x32_bf16 v[244:247], a[44:47], a[104:107], v[244:247]
ds_read_b64_tr_b16 a[96:97], v12 offset:256
s_mov_b32 s36, 0x44444444
s_mov_b32 s37, 0x44444444
v_mfma_f32_16x16x32_bf16 v[244:247], a[60:63], a[108:111], v[244:247]
ds_read_b64_tr_b16 a[98:99], v12 offset:1280
v_cndmask_b32 v4, 0, v22, s[36:37]
v_mfma_f32_16x16x32_bf16 v[236:239], a[56:59], a[108:111], v[236:239]
ds_read_b64_tr_b16 a[100:101], v12 offset:8448
v_accvgpr_write_b32 a236, v4
v_mfma_f32_16x16x32_bf16 v[236:239], a[40:43], a[104:107], v[236:239]
ds_read_b64_tr_b16 a[102:103], v12 offset:9472
v_accvgpr_write_b32 a237, v4
v_mfma_f32_16x16x32_bf16 v[228:231], a[36:39], a[104:107], v[228:231]
v_accvgpr_write_b32 a238, v4
v_accvgpr_write_b32 a239, v4
v_mfma_f32_16x16x32_bf16 v[228:231], a[52:55], a[108:111], v[228:231]
v_mov_b32 v1, v3
v_add_u32 v2, 98304, v3
v_mfma_f32_16x16x32_bf16 v[220:223], a[48:51], a[108:111], v[220:223]
buffer_load_dwordx4 v16, s[48:51], s32 offen offset:3072 sc1 lds
v_mfma_f32_16x16x32_bf16 v[220:223], a[32:35], a[104:107], v[220:223]
s_waitcnt lgkmcnt(4)
s_mov_b64 s[34:35], 0
v_accvgpr_write_b32 a224, 0
L_S22:
v_mfma_f32_16x16x32_bf16 v[24:27], a[80:83], a[0:3], v[24:27]
ds_read_b64_tr_b16 a[104:105], v13 offset:256
s_waitcnt vmcnt(13)
v_accvgpr_write_b32 a225, 0
v_mfma_f32_16x16x32_bf16 v[24:27], a[84:87], a[16:19], v[24:27]
ds_read_b64_tr_b16 a[106:107], v13 offset:1280
v_accvgpr_write_b32 a226, 0
v_mfma_f32_16x16x32_bf16 v[32:35], a[84:87], a[20:23], v[32:35]
ds_read_b64_tr_b16 a[108:109], v13 offset:8448
v_accvgpr_write_b32 a227, 0
v_mfma_f32_16x16x32_bf16 v[32:35], a[80:83], a[4:7], v[32:35]
ds_read_b64_tr_b16 a[110:111], v13 offset:9472
v_accvgpr_write_b32 a228, 0
v_mfma_f32_16x16x32_bf16 v[40:43], a[80:83], a[8:11], v[40:43]
ds_read_b128 a[32:35], v8 offset:32768
s_add_u32 m0, s19, 0x1000
v_mfma_f32_16x16x32_bf16 v[40:43], a[84:87], a[24:27], v[40:43]
buffer_load_dwordx4 v16, s[48:51], s7 offen offset:0 sc1 lds
v_mfma_f32_16x16x32_bf16 v[48:51], a[84:87], a[28:31], v[48:51]
ds_read_b128 a[48:51], v9 offset:32768
v_accvgpr_write_b32 a229, 0
v_mfma_f32_16x16x32_bf16 v[48:51], a[80:83], a[12:15], v[48:51]
ds_read_b128 a[36:39], v8 offset:34816
v_accvgpr_write_b32 a230, 0
v_mfma_f32_16x16x32_bf16 v[52:55], a[88:91], a[12:15], v[52:55]
ds_read_b64_tr_b16 a[80:81], v12 offset:512
v_accvgpr_write_b32 a231, 0
v_mfma_f32_16x16x32_bf16 v[52:55], a[92:95], a[28:31], v[52:55]
ds_read_b64_tr_b16 a[82:83], v12 offset:1536
L_padA11:
s_cmp_eq_u32 s95, 1
s_cbranch_scc1 L_hopA_ret
s_mul_i32 s8, s6, 0x142400
v_mfma_f32_16x16x32_bf16 v[44:47], a[92:95], a[24:27], v[44:47]
ds_read_b64_tr_b16 a[84:85], v12 offset:8704
s_sub_u32 s9, 0x12e1c00, s8
v_mfma_f32_16x16x32_bf16 v[44:47], a[88:91], a[8:11], v[44:47]
buffer_load_dwordx4 v16, s[48:51], s7 offen offset:1024 sc1 lds
v_mfma_f32_16x16x32_bf16 v[36:39], a[88:91], a[4:7], v[36:39]
ds_read_b64_tr_b16 a[86:87], v12 offset:9728
s_lshl_b32 s11, s5, 13
v_mfma_f32_16x16x32_bf16 v[36:39], a[92:95], a[20:23], v[36:39]
ds_read_b128 a[52:55], v9 offset:34816
s_add_u32 s11, s11, 0x2200000
v_mfma_f32_16x16x32_bf16 v[28:31], a[92:95], a[16:19], v[28:31]
ds_read_b128 a[40:43], v8 offset:36864
s_add_u32 s8, s8, s11
v_mfma_f32_16x16x32_bf16 v[28:31], a[88:91], a[0:3], v[28:31]
ds_read_b128 a[56:59], v9 offset:36864
s_waitcnt lgkmcnt(10)
v_mfma_f32_16x16x32_bf16 v[56:59], a[96:99], a[0:3], v[56:59]
ds_read_b64_tr_b16 a[88:89], v13 offset:512
s_add_u32 s9, s9, s11
s_lshl_b32 s11, s4, 10
v_mfma_f32_16x16x32_bf16 v[56:59], a[100:103], a[16:19], v[56:59]
ds_read_b64_tr_b16 a[90:91], v13 offset:1536
s_add_u32 s44, s8, s11
v_mfma_f32_16x16x32_bf16 v[64:67], a[100:103], a[20:23], v[64:67]
buffer_load_dwordx4 v16, s[48:51], s7 offen offset:2048 sc1 lds
v_mfma_f32_16x16x32_bf16 v[64:67], a[96:99], a[4:7], v[64:67]
ds_read_b64_tr_b16 a[92:93], v13 offset:8704
s_add_u32 s46, s9, s11
v_mfma_f32_16x16x32_bf16 v[72:75], a[96:99], a[8:11], v[72:75]
ds_read_b64_tr_b16 a[94:95], v13 offset:9728
s_sub_u32 s11, 0x1c00, s11
v_mfma_f32_16x16x32_bf16 v[72:75], a[100:103], a[24:27], v[72:75]
ds_read_b128 a[44:47], v8 offset:38912
s_add_u32 s45, s8, s11
v_mfma_f32_16x16x32_bf16 v[80:83], a[100:103], a[28:31], v[80:83]
ds_read_b128 a[60:63], v9 offset:38912
s_add_u32 s47, s9, s11
v_mfma_f32_16x16x32_bf16 v[80:83], a[96:99], a[12:15], v[80:83]
s_mul_i32 s8, s5, 0x6000
s_add_u32 s8, s8, 0x40000
s_add_u32 s28, s44, s8
v_mfma_f32_16x16x32_bf16 v[84:87], a[104:107], a[12:15], v[84:87]
ds_read_b64_tr_b16 a[96:97], v12 offset:768
s_add_u32 s29, s45, s8
s_add_u32 s30, s46, s8
v_mfma_f32_16x16x32_bf16 v[84:87], a[108:111], a[28:31], v[84:87]
buffer_load_dwordx4 v16, s[48:51], s7 offen offset:3072 sc1 lds
v_mfma_f32_16x16x32_bf16 v[76:79], a[108:111], a[24:27], v[76:79]
ds_read_b64_tr_b16 a[98:99], v12 offset:1792
s_add_u32 s32, s32, s94
v_mfma_f32_16x16x32_bf16 v[76:79], a[104:107], a[8:11], v[76:79]
ds_read_b64_tr_b16 a[100:101], v12 offset:8960
s_add_u32 s7, s7, s94
v_mfma_f32_16x16x32_bf16 v[68:71], a[104:107], a[4:7], v[68:71]
ds_read_b64_tr_b16 a[102:103], v12 offset:9984
s_add_u32 s31, s47, s8
v_mfma_f32_16x16x32_bf16 v[68:71], a[108:111], a[20:23], v[68:71]
s_lshl_b32 s8, s4, 11
s_add_u32 s9, s8, 131072
v_add_u32 v4, s9, v16
v_mfma_f32_16x16x32_bf16 v[60:63], a[108:111], a[16:19], v[60:63]
s_sub_u32 s9, 145408, s8
s_cmp_eq_u32 s4, 0
s_cselect_b32 s8, 131072, s9
v_mfma_f32_16x16x32_bf16 v[60:63], a[104:107], a[0:3], v[60:63]
s_add_u32 m0, s19, 0x18000
s_waitcnt lgkmcnt(6)
v_add_u32 v5, s8, v16
v_mfma_f32_16x16x32_bf16 v[88:91], a[80:83], a[0:3], v[88:91]
buffer_load_dwordx4 v16, s[48:51], s32 offen offset:0 sc1 lds
v_add_u32 v6, s9, v16
v_mfma_f32_16x16x32_bf16 v[88:91], a[84:87], a[16:19], v[88:91]
ds_read_b64_tr_b16 a[104:105], v13 offset:768
v_add_u32 v22, 0x800, v10
v_mfma_f32_16x16x32_bf16 v[96:99], a[84:87], a[20:23], v[96:99]
ds_read_b64_tr_b16 a[106:107], v13 offset:1792
s_mov_b32 s8, 0x800
v_mfma_f32_16x16x32_bf16 v[96:99], a[80:83], a[4:7], v[96:99]
ds_read_b64_tr_b16 a[108:109], v13 offset:8960
v_mfma_f32_16x16x32_bf16 v[104:107], a[80:83], a[8:11], v[104:107]
ds_read_b64_tr_b16 a[110:111], v13 offset:9984
v_mfma_f32_16x16x32_bf16 v[104:107], a[84:87], a[24:27], v[104:107]
s_cmp_eq_u32 s6, 0
s_cselect_b32 s8, 0xffff8800, s8
v_add_u32 v7, s8, v11
v_mfma_f32_16x16x32_bf16 v[112:115], a[84:87], a[28:31], v[112:115]
buffer_load_dwordx4 v16, s[48:51], s32 offen offset:1024 sc1 lds
v_mfma_f32_16x16x32_bf16 v[112:115], a[80:83], a[12:15], v[112:115]
s_bfe_u32 s99, s2, 0x20001
s_lshl_b32 s99, s99, 2
s_lshr_b32 s8, s2, 6
v_mfma_f32_16x16x32_bf16 v[116:119], a[88:91], a[12:15], v[116:119]
ds_read_b64_tr_b16 a[80:81], v14 offset:0
s_add_u32 s99, s99, s8
s_bfe_u32 s100, s2, 0x30003
v_mfma_f32_16x16x32_bf16 v[116:119], a[92:95], a[28:31], v[116:119]
ds_read_b64_tr_b16 a[82:83], v14 offset:256
s_and_b32 s14, s2, 1
v_mfma_f32_16x16x32_bf16 v[108:111], a[92:95], a[24:27], v[108:111]
ds_read_b64_tr_b16 a[84:85], v14 offset:2048
s_sub_u32 s24, 15, s99
v_mfma_f32_16x16x32_bf16 v[108:111], a[88:91], a[8:11], v[108:111]
ds_read_b64_tr_b16 a[86:87], v14 offset:2304
s_min_u32 s18, s24, s99
v_mfma_f32_16x16x32_bf16 v[100:103], a[88:91], a[4:7], v[100:103]
buffer_load_dwordx4 v16, s[48:51], s32 offen offset:2048 sc1 lds
v_mfma_f32_16x16x32_bf16 v[100:103], a[92:95], a[20:23], v[100:103]
s_lshl_b32 s24, s18, 1
s_add_u32 s24, s24, s14
s_lshl_b32 s24, s24, 8
v_mfma_f32_16x16x32_bf16 v[92:95], a[92:95], a[16:19], v[92:95]
s_add_u32 s24, s24, 0x3704000
s_mov_b32 s12, 14336
s_and_b32 s16, s6, 1
v_mfma_f32_16x16x32_bf16 v[92:95], a[88:91], a[0:3], v[92:95]
s_waitcnt lgkmcnt(4)
s_lshl_b32 s16, s16, 15
s_add_u32 s16, s16, 98304
v_mfma_f32_16x16x32_bf16 v[120:123], a[96:99], a[0:3], v[120:123]
ds_read_b64_tr_b16 a[88:89], v15 offset:0
s_add_u32 s16, s16, s17
s_lshl_b32 s13, s4, 15
v_mfma_f32_16x16x32_bf16 v[120:123], a[100:103], a[16:19], v[120:123]
ds_read_b64_tr_b16 a[90:91], v15 offset:256
s_lshl_b32 s9, s100, 8
v_mfma_f32_16x16x32_bf16 v[128:131], a[100:103], a[20:23], v[128:131]
buffer_load_dwordx4 v16, s[48:51], s32 offen offset:3072 sc1 lds
v_mfma_f32_16x16x32_bf16 v[128:131], a[96:99], a[4:7], v[128:131]
ds_read_b64_tr_b16 a[92:93], v15 offset:2048
s_add_u32 s13, s13, s9
v_mfma_f32_16x16x32_bf16 v[136:139], a[96:99], a[8:11], v[136:139]
ds_read_b64_tr_b16 a[94:95], v15 offset:2304
s_mul_i32 s9, s14, 1310848
v_mfma_f32_16x16x32_bf16 v[136:139], a[100:103], a[24:27], v[136:139]
s_add_u32 s13, s13, s9
s_mul_i32 s25, s14, 3407872
s_sub_u32 s25, s25, 1179648
v_mfma_f32_16x16x32_bf16 v[144:147], a[100:103], a[28:31], v[144:147]
s_mul_i32 s101, s99, 0x142400
s_lshl_b32 s8, s4, 11
s_add_u32 s101, s101, s8
v_mfma_f32_16x16x32_bf16 v[144:147], a[96:99], a[12:15], v[144:147]
s_add_u32 m0, s19, 0x19000
s_mul_i32 s8, s14, 163840
s_add_u32 s101, s101, s8
v_mfma_f32_16x16x32_bf16 v[148:151], a[104:107], a[12:15], v[148:151]
buffer_load_dwordx4 v16, s[48:51], s7 offen offset:0 sc1 lds
s_add_u32 s101, s101, 0x21fe000
v_mfma_f32_16x16x32_bf16 v[148:151], a[108:111], a[28:31], v[148:151]
ds_read_b64_tr_b16 a[96:97], v14 offset:4096
s_mul_i32 s26, s14, 425984
v_mfma_f32_16x16x32_bf16 v[140:143], a[108:111], a[24:27], v[140:143]
ds_read_b64_tr_b16 a[98:99], v14 offset:4352
s_add_u32 s26, s26, 106496
v_mfma_f32_16x16x32_bf16 v[140:143], a[104:107], a[8:11], v[140:143]
ds_read_b64_tr_b16 a[100:101], v14 offset:6144
s_mov_b32 s52, 0x3e0293ee
v_mfma_f32_16x16x32_bf16 v[132:135], a[104:107], a[4:7], v[132:135]
ds_read_b64_tr_b16 a[102:103], v14 offset:6400
s_mov_b32 s53, 0x3e0293ee
v_mfma_f32_16x16x32_bf16 v[132:135], a[108:111], a[20:23], v[132:135]
s_mov_b32 s54, 0x3e8293ee
s_or_b32 s55, s6, s4
s_cselect_b32 s55, 0, 0xf149f2ca
v_mfma_f32_16x16x32_bf16 v[124:127], a[108:111], a[16:19], v[124:127]
s_waitcnt lgkmcnt(4)
s_mov_b32 s56, 0x50000
s_mov_b32 s57, 0x5550055
v_mfma_f32_16x16x32_bf16 v[124:127], a[104:107], a[0:3], v[124:127]
buffer_load_dwordx4 v16, s[48:51], s7 offen offset:1024 sc1 lds
v_mfma_f32_16x16x32_bf16 v[152:155], a[80:83], a[0:3], v[152:155]
ds_read_b64_tr_b16 a[104:105], v15 offset:4096
s_mov_b32 s58, 0xa0000
s_mov_b32 s59, 0xaaa00aa
v_mfma_f32_16x16x32_bf16 v[152:155], a[84:87], a[16:19], v[152:155]
ds_read_b64_tr_b16 a[106:107], v15 offset:4352
s_mov_b32 s60, 0x150001
v_mfma_f32_16x16x32_bf16 v[160:163], a[84:87], a[20:23], v[160:163]
ds_read_b64_tr_b16 a[108:109], v15 offset:6144
s_mov_b32 s61, 0x15550155
v_mfma_f32_16x16x32_bf16 v[160:163], a[80:83], a[4:7], v[160:163]
ds_read_b64_tr_b16 a[110:111], v15 offset:6400
s_mov_b32 s62, 0x2a0002
v_mfma_f32_16x16x32_bf16 v[168:171], a[80:83], a[8:11], v[168:171]
s_mov_b32 s63, 0x2aaa02aa
s_mov_b32 s68, 0x55505555
s_mov_b32 s69, 0x50005500
v_mfma_f32_16x16x32_bf16 v[168:171], a[84:87], a[24:27], v[168:171]
buffer_load_dwordx4 v16, s[48:51], s7 offen offset:2048 sc1 lds
v_mfma_f32_16x16x32_bf16 v[176:179], a[84:87], a[28:31], v[176:179]
s_mov_b32 s70, 0xaaa0aaaa
s_mov_b32 s71, 0xa000aa00
s_mov_b32 s76, 0x55405554
v_mfma_f32_16x16x32_bf16 v[176:179], a[80:83], a[12:15], v[176:179]
s_mov_b32 s77, 0x40005400
s_mov_b32 s78, 0xaa80aaa8
s_mov_b32 s79, 0x8000a800
v_mfma_f32_16x16x32_bf16 v[180:183], a[88:91], a[12:15], v[180:183]
ds_read_b64_tr_b16 a[80:81], v14 offset:8192
s_mov_b32 s11, 0xf149f2ca
s_mov_b32 s36, 0xfff0ffff
v_mfma_f32_16x16x32_bf16 v[180:183], a[92:95], a[28:31], v[180:183]
ds_read_b64_tr_b16 a[82:83], v14 offset:8448
s_mov_b32 s37, 0xf000ff00
v_mfma_f32_16x16x32_bf16 v[172:175], a[92:95], a[24:27], v[172:175]
ds_read_b64_tr_b16 a[84:85], v14 offset:10240
s_mov_b32 s38, 0xffe0fffe
v_mfma_f32_16x16x32_bf16 v[172:175], a[88:91], a[8:11], v[172:175]
buffer_load_dwordx4 v16, s[48:51], s7 offen offset:3072 sc1 lds
v_mfma_f32_16x16x32_bf16 v[164:167], a[88:91], a[4:7], v[164:167]
ds_read_b64_tr_b16 a[86:87], v14 offset:10496
s_add_u32 s32, s32, 0x8000
v_mfma_f32_16x16x32_bf16 v[164:167], a[92:95], a[20:23], v[164:167]
s_add_u32 s7, s7, 0x8000
s_mov_b32 s39, 0xe000fe00
s_mov_b32 s40, 0xffc0fffc
v_mfma_f32_16x16x32_bf16 v[156:159], a[92:95], a[16:19], v[156:159]
s_mov_b32 s41, 0xc000fc00
s_mov_b32 s42, 0xff80fff8
s_mov_b32 s43, 0x8000f800
v_mfma_f32_16x16x32_bf16 v[156:159], a[88:91], a[0:3], v[156:159]
s_waitcnt lgkmcnt(4)
v_mov_b32 v21, s1
v_mfma_f32_16x16x32_bf16 v[184:187], a[96:99], a[0:3], v[184:187]
ds_read_b64_tr_b16 a[88:89], v15 offset:8192
v_add_u32 v20, s0, v16
v_mfma_f32_16x16x32_bf16 v[184:187], a[100:103], a[16:19], v[184:187]
global_load_dword a120, v[20:21], off sc1
v_mfma_f32_16x16x32_bf16 v[192:195], a[100:103], a[20:23], v[192:195]
ds_read_b64_tr_b16 a[90:91], v15 offset:8448
v_mfma_f32_16x16x32_bf16 v[192:195], a[96:99], a[4:7], v[192:195]
ds_read_b64_tr_b16 a[92:93], v15 offset:10240
v_mfma_f32_16x16x32_bf16 v[200:203], a[96:99], a[8:11], v[200:203]
ds_read_b64_tr_b16 a[94:95], v15 offset:10496
v_add_u32 v12, 0x8000, v12
v_mfma_f32_16x16x32_bf16 v[200:203], a[100:103], a[24:27], v[200:203]
v_add_u32 v13, 0x8000, v13
v_add_u32 v14, 0x8000, v14
v_mfma_f32_16x16x32_bf16 v[208:211], a[100:103], a[28:31], v[208:211]
v_add_u32 v15, 0x8000, v15
v_mfma_f32_16x16x32_bf16 v[208:211], a[96:99], a[12:15], v[208:211]
s_bitcmp1_b32 s4, 0
s_cselect_b32 s8, 0x7f800000, s11
s_cselect_b32 s9, s11, 0x7f800000
v_mfma_f32_16x16x32_bf16 v[212:215], a[104:107], a[12:15], v[212:215]
s_waitcnt vmcnt(19) lgkmcnt(0)
v_mfma_f32_16x16x32_bf16 v[212:215], a[108:111], a[28:31], v[212:215]
s_barrier
s_add_u32 m0, s19, 0x8000
v_mfma_f32_16x16x32_bf16 v[204:207], a[108:111], a[24:27], v[204:207]
buffer_load_dwordx4 v16, s[48:51], s32 offen offset:0 sc1 lds
v_mfma_f32_16x16x32_bf16 v[204:207], a[104:107], a[8:11], v[204:207]
ds_read_b64_tr_b16 a[96:97], v14 offset:4096
v_mfma_f32_16x16x32_bf16 v[196:199], a[104:107], a[4:7], v[196:199]
ds_read_b64_tr_b16 a[98:99], v14 offset:4352
v_mfma_f32_16x16x32_bf16 v[196:199], a[108:111], a[20:23], v[196:199]
ds_read_b64_tr_b16 a[100:101], v14 offset:6144
v_mfma_f32_16x16x32_bf16 v[188:191], a[108:111], a[16:19], v[188:191]
buffer_load_dwordx4 v16, s[48:51], s32 offen offset:1024 sc1 lds
v_mfma_f32_16x16x32_bf16 v[188:191], a[104:107], a[0:3], v[188:191]
ds_read_b64_tr_b16 a[102:103], v14 offset:6400
s_waitcnt lgkmcnt(4)
v_mfma_f32_16x16x32_bf16 v[216:219], a[0:3], a[80:83], v[216:219]
ds_read_b64_tr_b16 a[104:105], v15 offset:4096
v_mfma_f32_16x16x32_bf16 v[216:219], a[16:19], a[84:87], v[216:219]
ds_read_b64_tr_b16 a[106:107], v15 offset:4352
v_mfma_f32_16x16x32_bf16 v[224:227], a[20:23], a[84:87], v[224:227]
ds_read_b64_tr_b16 a[108:109], v15 offset:6144
v_mfma_f32_16x16x32_bf16 v[224:227], a[4:7], a[80:83], v[224:227]
buffer_store_dwordx4 a[64:67], v16, s[88:91], s15 offen offset:0 sc1
v_mfma_f32_16x16x32_bf16 v[232:235], a[8:11], a[80:83], v[232:235]
ds_read_b64_tr_b16 a[110:111], v15 offset:6400
v_mfma_f32_16x16x32_bf16 v[232:235], a[24:27], a[84:87], v[232:235]
v_mfma_f32_16x16x32_bf16 v[240:243], a[28:31], a[84:87], v[240:243]
v_mfma_f32_16x16x32_bf16 v[240:243], a[12:15], a[80:83], v[240:243]
buffer_load_dwordx4 v16, s[48:51], s32 offen offset:2048 sc1 lds
v_mfma_f32_16x16x32_bf16 v[244:247], a[12:15], a[88:91], v[244:247]
ds_read_b64_tr_b16 a[80:81], v14 offset:8192
v_mfma_f32_16x16x32_bf16 v[244:247], a[28:31], a[92:95], v[244:247]
ds_read_b64_tr_b16 a[82:83], v14 offset:8448
v_mfma_f32_16x16x32_bf16 v[236:239], a[24:27], a[92:95], v[236:239]
ds_read_b64_tr_b16 a[84:85], v14 offset:10240
v_mfma_f32_16x16x32_bf16 v[236:239], a[8:11], a[88:91], v[236:239]
ds_read_b64_tr_b16 a[86:87], v14 offset:10496
v_mfma_f32_16x16x32_bf16 v[228:231], a[4:7], a[88:91], v[228:231]
buffer_load_dwordx4 v16, s[48:51], s32 offen offset:3072 sc1 lds
v_mfma_f32_16x16x32_bf16 v[228:231], a[20:23], a[92:95], v[228:231]
v_mfma_f32_16x16x32_bf16 v[220:223], a[16:19], a[92:95], v[220:223]
v_mfma_f32_16x16x32_bf16 v[220:223], a[0:3], a[88:91], v[220:223]
s_waitcnt lgkmcnt(4)
L_S23:
v_mfma_f32_16x16x32_bf16 v[184:187], a[96:99], a[32:35], v[184:187]
buffer_store_dwordx4 a[64:67], v16, s[88:91], s15 offen offset:1024 sc1
v_mov_b32 v8, v19
v_mfma_f32_16x16x32_bf16 v[184:187], a[100:103], a[48:51], v[184:187]
ds_read_b64_tr_b16 a[88:89], v15 offset:8192
v_mov_b32 v9, 0xf149f2ca
v_mfma_f32_16x16x32_bf16 v[192:195], a[100:103], a[52:55], v[192:195]
ds_read_b64_tr_b16 a[90:91], v15 offset:8448
v_mov_b32 v248, 0xffff
v_mfma_f32_16x16x32_bf16 v[192:195], a[96:99], a[36:39], v[192:195]
ds_read_b64_tr_b16 a[92:93], v15 offset:10240
v_mov_b32 v249, 0xffff0000
v_mfma_f32_16x16x32_bf16 v[200:203], a[96:99], a[40:43], v[200:203]
ds_read_b64_tr_b16 a[94:95], v15 offset:10496
s_add_u32 m0, s19, 0x9000
v_cndmask_b32 v252, 0, v248, s[56:57]
v_mfma_f32_16x16x32_bf16 v[200:203], a[100:103], a[56:59], v[200:203]
buffer_load_dwordx4 v16, s[48:51], s7 offen offset:0 sc1 lds
v_mfma_f32_16x16x32_bf16 v[208:211], a[100:103], a[60:63], v[208:211]
v_cndmask_b32 v252, v252, v249, s[58:59]
v_cndmask_b32 v253, 0, v248, s[60:61]
v_mfma_f32_16x16x32_bf16 v[208:211], a[96:99], a[44:47], v[208:211]
v_cndmask_b32 v253, v253, v249, s[62:63]
v_cndmask_b32 v254, 0, v248, s[68:69]
v_mfma_f32_16x16x32_bf16 v[212:215], a[104:107], a[44:47], v[212:215]
ds_read_b64_tr_b16 a[96:97], v14 offset:0
v_cndmask_b32 v254, v254, v249, s[70:71]
v_cndmask_b32 v255, 0, v248, s[76:77]
v_mfma_f32_16x16x32_bf16 v[212:215], a[108:111], a[60:63], v[212:215]
buffer_load_dwordx4 v16, s[48:51], s7 offen offset:1024 sc1 lds
v_mfma_f32_16x16x32_bf16 v[204:207], a[108:111], a[56:59], v[204:207]
ds_read_b64_tr_b16 a[98:99], v14 offset:256
v_cndmask_b32 v255, v255, v249, s[78:79]
v_mfma_f32_16x16x32_bf16 v[204:207], a[104:107], a[40:43], v[204:207]
ds_read_b64_tr_b16 a[100:101], v14 offset:2048
v_cndmask_b32 v248, v9, 0, s[68:69]
v_mfma_f32_16x16x32_bf16 v[196:199], a[104:107], a[36:39], v[196:199]
ds_read_b64_tr_b16 a[102:103], v14 offset:2304
v_cndmask_b32 v249, v9, 0, s[70:71]
v_cndmask_b32 v250, v9, 0, s[76:77]
v_mfma_f32_16x16x32_bf16 v[196:199], a[108:111], a[52:55], v[196:199]
v_cndmask_b32 v251, v9, 0, s[78:79]
v_mfma_f32_16x16x32_bf16 v[188:191], a[108:111], a[48:51], v[188:191]
buffer_store_dwordx4 a[64:67], v16, s[88:91], s15 offen offset:2048 sc1
v_mfma_f32_16x16x32_bf16 v[188:191], a[104:107], a[32:35], v[188:191]
s_waitcnt lgkmcnt(4)
v_mfma_f32_16x16x32_bf16 v[216:219], a[32:35], a[80:83], v[216:219]
ds_read_b64_tr_b16 a[104:105], v15 offset:0
v_mfma_f32_16x16x32_bf16 v[216:219], a[48:51], a[84:87], v[216:219]
ds_read_b64_tr_b16 a[106:107], v15 offset:256
v_mfma_f32_16x16x32_bf16 v[224:227], a[52:55], a[84:87], v[224:227]
buffer_load_dwordx4 v16, s[48:51], s7 offen offset:2048 sc1 lds
v_mfma_f32_16x16x32_bf16 v[224:227], a[36:39], a[80:83], v[224:227]
ds_read_b64_tr_b16 a[108:109], v15 offset:2048
v_cvt_pk_bf16_f32 v192, v192, v193
v_mfma_f32_16x16x32_bf16 v[232:235], a[40:43], a[80:83], v[232:235]
ds_read_b64_tr_b16 a[110:111], v15 offset:2304
v_cvt_pk_bf16_f32 v193, v194, v195
v_cvt_pk_bf16_f32 v194, v196, v197
v_mfma_f32_16x16x32_bf16 v[232:235], a[56:59], a[84:87], v[232:235]
v_cvt_pk_bf16_f32 v195, v198, v199
v_cvt_pk_bf16_f32 v208, v208, v209
v_mfma_f32_16x16x32_bf16 v[240:243], a[60:63], a[84:87], v[240:243]
v_cvt_pk_bf16_f32 v209, v210, v211
v_cvt_pk_bf16_f32 v210, v212, v213
v_mfma_f32_16x16x32_bf16 v[240:243], a[44:47], a[80:83], v[240:243]
buffer_load_dwordx4 v16, s[48:51], s7 offen offset:3072 sc1 lds
v_mfma_f32_16x16x32_bf16 v[244:247], a[44:47], a[88:91], v[244:247]
ds_read_b64_tr_b16 a[80:81], v12 offset:0
s_add_u32 s32, s32, 0x8000
v_cvt_pk_bf16_f32 v211, v214, v215
v_mfma_f32_16x16x32_bf16 v[244:247], a[60:63], a[92:95], v[244:247]
ds_read_b64_tr_b16 a[82:83], v12 offset:1024
s_add_u32 s7, s7, 0x8000
v_mfma_f32_16x16x32_bf16 v[236:239], a[56:59], a[92:95], v[236:239]
ds_read_b64_tr_b16 a[84:85], v12 offset:8192
v_mfma_f32_16x16x32_bf16 v[236:239], a[40:43], a[88:91], v[236:239]
buffer_store_dwordx4 a[64:67], v16, s[88:91], s15 offen offset:3072 sc1
v_mfma_f32_16x16x32_bf16 v[228:231], a[36:39], a[88:91], v[228:231]
ds_read_b64_tr_b16 a[86:87], v12 offset:9216
v_mfma_f32_16x16x32_bf16 v[228:231], a[52:55], a[92:95], v[228:231]
s_cmp_lg_u32 s4, 0
s_cbranch_scc1 L_hx0
buffer_store_dwordx4 v[192:195], v22, s[88:91], 0 offen offset:0 sc1
buffer_store_dwordx4 v[208:211], v7, s[88:91], 0 offen offset:0 sc1
L_hx0:
v_mfma_f32_16x16x32_bf16 v[220:223], a[48:51], a[92:95], v[220:223]
v_cvt_pk_bf16_f32 v184, v184, v185
v_cvt_pk_bf16_f32 v185, v186, v187
v_mfma_f32_16x16x32_bf16 v[220:223], a[32:35], a[88:91], v[220:223]
s_waitcnt lgkmcnt(4)
v_cvt_pk_bf16_f32 v186, v188, v189
v_cvt_pk_bf16_f32 v187, v190, v191
v_mfma_f32_16x16x32_bf16 v[152:155], a[96:99], a[32:35], v[152:155]
ds_read_b64_tr_b16 a[88:89], v13 offset:0
v_cvt_pk_bf16_f32 v200, v200, v201
v_cvt_pk_bf16_f32 v201, v202, v203
v_mfma_f32_16x16x32_bf16 v[152:155], a[100:103], a[48:51], v[152:155]
ds_read_b64_tr_b16 a[90:91], v13 offset:1024
v_cvt_pk_bf16_f32 v202, v204, v205
v_mfma_f32_16x16x32_bf16 v[160:163], a[100:103], a[52:55], v[160:163]
ds_read_b64_tr_b16 a[92:93], v13 offset:8192
v_cvt_pk_bf16_f32 v203, v206, v207
v_mfma_f32_16x16x32_bf16 v[160:163], a[96:99], a[36:39], v[160:163]
ds_read_b64_tr_b16 a[94:95], v13 offset:9216
v_mfma_f32_16x16x32_bf16 v[168:171], a[96:99], a[40:43], v[168:171]
ds_write_b128 v5, v[192:195] offset:2048
v_mfma_f32_16x16x32_bf16 v[168:171], a[100:103], a[56:59], v[168:171]
ds_write_b128 v5, v[208:211] offset:18432
v_mfma_f32_16x16x32_bf16 v[176:179], a[100:103], a[60:63], v[176:179]
ds_write_b128 v4, v[184:187] offset:2048
v_mfma_f32_16x16x32_bf16 v[176:179], a[96:99], a[44:47], v[176:179]
ds_write_b128 v4, v[200:203] offset:18432
v_mfma_f32_16x16x32_bf16 v[180:183], a[104:107], a[44:47], v[180:183]
ds_read_b64_tr_b16 a[96:97], v12 offset:256
v_cvt_pk_bf16_f32 v231, v230, v231
v_cvt_pk_bf16_f32 v230, v228, v229
v_mfma_f32_16x16x32_bf16 v[180:183], a[108:111], a[60:63], v[180:183]
ds_read_b64_tr_b16 a[98:99], v12 offset:1280
v_cvt_pk_bf16_f32 v228, v224, v225
v_mfma_f32_16x16x32_bf16 v[172:175], a[108:111], a[56:59], v[172:175]
ds_read_b64_tr_b16 a[100:101], v12 offset:8448
v_cvt_pk_bf16_f32 v229, v226, v227
v_mfma_f32_16x16x32_bf16 v[172:175], a[104:107], a[40:43], v[172:175]
ds_read_b64_tr_b16 a[102:103], v12 offset:9472
v_cvt_pk_bf16_f32 v227, v226, v227
v_mfma_f32_16x16x32_bf16 v[164:167], a[104:107], a[36:39], v[164:167]
v_cvt_pk_bf16_f32 v226, v224, v225
v_cvt_pk_bf16_f32 v247, v246, v247
v_cvt_pk_bf16_f32 v246, v244, v245
v_mfma_f32_16x16x32_bf16 v[164:167], a[108:111], a[52:55], v[164:167]
v_cvt_pk_bf16_f32 v244, v240, v241
v_cvt_pk_bf16_f32 v245, v242, v243
v_mfma_f32_16x16x32_bf16 v[156:159], a[108:111], a[48:51], v[156:159]
v_cvt_pk_bf16_f32 v243, v242, v243
v_cvt_pk_bf16_f32 v242, v240, v241
v_mfma_f32_16x16x32_bf16 v[156:159], a[104:107], a[32:35], v[156:159]
s_waitcnt lgkmcnt(4)
v_mfma_f32_16x16x32_bf16 v[24:27], a[80:83], a[32:35], v[24:27]
ds_read_b64_tr_b16 a[104:105], v13 offset:256
v_mfma_f32_16x16x32_bf16 v[24:27], a[84:87], a[48:51], v[24:27]
ds_read_b64_tr_b16 a[106:107], v13 offset:1280
v_mfma_f32_16x16x32_bf16 v[32:35], a[84:87], a[52:55], v[32:35]
ds_read_b64_tr_b16 a[108:109], v13 offset:8448
v_mfma_f32_16x16x32_bf16 v[32:35], a[80:83], a[36:39], v[32:35]
ds_read_b64_tr_b16 a[110:111], v13 offset:9472
v_mfma_f32_16x16x32_bf16 v[40:43], a[80:83], a[40:43], v[40:43]
s_cmp_lg_u32 s4, 0
s_cbranch_scc1 L_hx1
buffer_store_dwordx4 v[228:231], v22, s[88:91], 0 offen offset:1024 sc1
buffer_store_dwordx4 v[244:247], v7, s[88:91], 0 offen offset:1024 sc1
L_hx1:
v_mfma_f32_16x16x32_bf16 v[40:43], a[84:87], a[56:59], v[40:43]
v_cvt_pk_bf16_f32 v223, v222, v223
v_cvt_pk_bf16_f32 v222, v220, v221
v_mfma_f32_16x16x32_bf16 v[48:51], a[84:87], a[60:63], v[48:51]
v_cvt_pk_bf16_f32 v220, v216, v217
v_cvt_pk_bf16_f32 v221, v218, v219
v_mfma_f32_16x16x32_bf16 v[48:51], a[80:83], a[44:47], v[48:51]
v_cvt_pk_bf16_f32 v219, v218, v219
v_cvt_pk_bf16_f32 v218, v216, v217
v_mfma_f32_16x16x32_bf16 v[52:55], a[88:91], a[44:47], v[52:55]
ds_read_b64_tr_b16 a[80:81], v12 offset:512
v_cvt_pk_bf16_f32 v239, v238, v239
v_cvt_pk_bf16_f32 v238, v236, v237
v_mfma_f32_16x16x32_bf16 v[52:55], a[92:95], a[60:63], v[52:55]
ds_read_b64_tr_b16 a[82:83], v12 offset:1536
v_cvt_pk_bf16_f32 v236, v232, v233
v_mfma_f32_16x16x32_bf16 v[44:47], a[92:95], a[56:59], v[44:47]
ds_read_b64_tr_b16 a[84:85], v12 offset:8704
v_cvt_pk_bf16_f32 v237, v234, v235
v_mfma_f32_16x16x32_bf16 v[44:47], a[88:91], a[40:43], v[44:47]
ds_read_b64_tr_b16 a[86:87], v12 offset:9728
v_cvt_pk_bf16_f32 v235, v234, v235
v_mfma_f32_16x16x32_bf16 v[36:39], a[88:91], a[36:39], v[36:39]
v_cvt_pk_bf16_f32 v234, v232, v233
v_mfma_f32_16x16x32_bf16 v[36:39], a[92:95], a[52:55], v[36:39]
ds_write_b128 v5, v[228:231] offset:3072
v_mfma_f32_16x16x32_bf16 v[28:31], a[92:95], a[48:51], v[28:31]
ds_write_b128 v5, v[244:247] offset:19456
v_mfma_f32_16x16x32_bf16 v[28:31], a[88:91], a[32:35], v[28:31]
s_waitcnt lgkmcnt(4)
v_mfma_f32_16x16x32_bf16 v[56:59], a[96:99], a[32:35], v[56:59]
ds_read_b64_tr_b16 a[88:89], v13 offset:512
v_mfma_f32_16x16x32_bf16 v[56:59], a[100:103], a[48:51], v[56:59]
ds_read_b64_tr_b16 a[90:91], v13 offset:1536
v_mfma_f32_16x16x32_bf16 v[64:67], a[100:103], a[52:55], v[64:67]
ds_read_b64_tr_b16 a[92:93], v13 offset:8704
v_mfma_f32_16x16x32_bf16 v[64:67], a[96:99], a[36:39], v[64:67]
ds_read_b64_tr_b16 a[94:95], v13 offset:9728
v_mfma_f32_16x16x32_bf16 v[72:75], a[96:99], a[40:43], v[72:75]
ds_write_b128 v4, v[220:223] offset:3072
v_mfma_f32_16x16x32_bf16 v[72:75], a[100:103], a[56:59], v[72:75]
ds_write_b128 v4, v[236:239] offset:19456
v_mfma_f32_16x16x32_bf16 v[80:83], a[100:103], a[60:63], v[80:83]
v_cvt_pk_bf16_f32 v152, v152, v153
v_cvt_pk_bf16_f32 v153, v154, v155
v_mfma_f32_16x16x32_bf16 v[80:83], a[96:99], a[44:47], v[80:83]
v_cvt_pk_bf16_f32 v154, v156, v157
v_cvt_pk_bf16_f32 v155, v158, v159
v_mfma_f32_16x16x32_bf16 v[84:87], a[104:107], a[44:47], v[84:87]
ds_read_b64_tr_b16 a[96:97], v12 offset:768
v_cvt_pk_bf16_f32 v160, v160, v161
v_cvt_pk_bf16_f32 v161, v162, v163
v_mfma_f32_16x16x32_bf16 v[84:87], a[108:111], a[60:63], v[84:87]
ds_read_b64_tr_b16 a[98:99], v12 offset:1792
v_cvt_pk_bf16_f32 v162, v164, v165
v_mfma_f32_16x16x32_bf16 v[76:79], a[108:111], a[56:59], v[76:79]
ds_read_b64_tr_b16 a[100:101], v12 offset:8960
v_cvt_pk_bf16_f32 v163, v166, v167
v_mfma_f32_16x16x32_bf16 v[76:79], a[104:107], a[40:43], v[76:79]
ds_read_b64_tr_b16 a[102:103], v12 offset:9984
v_cvt_pk_bf16_f32 v168, v168, v169
v_mfma_f32_16x16x32_bf16 v[68:71], a[104:107], a[36:39], v[68:71]
v_cvt_pk_bf16_f32 v169, v170, v171
v_cvt_pk_bf16_f32 v170, v172, v173
v_cvt_pk_bf16_f32 v171, v174, v175
v_mfma_f32_16x16x32_bf16 v[68:71], a[108:111], a[52:55], v[68:71]
v_cvt_pk_bf16_f32 v176, v176, v177
v_cvt_pk_bf16_f32 v177, v178, v179
v_mfma_f32_16x16x32_bf16 v[60:63], a[108:111], a[48:51], v[60:63]
v_cvt_pk_bf16_f32 v178, v180, v181
v_cvt_pk_bf16_f32 v179, v182, v183
v_mfma_f32_16x16x32_bf16 v[60:63], a[104:107], a[32:35], v[60:63]
s_waitcnt lgkmcnt(4)
v_mfma_f32_16x16x32_bf16 v[88:91], a[80:83], a[32:35], v[88:91]
ds_read_b64_tr_b16 a[104:105], v13 offset:768
v_mfma_f32_16x16x32_bf16 v[88:91], a[84:87], a[48:51], v[88:91]
ds_read_b64_tr_b16 a[106:107], v13 offset:1792
v_mfma_f32_16x16x32_bf16 v[96:99], a[84:87], a[52:55], v[96:99]
ds_read_b64_tr_b16 a[108:109], v13 offset:8960
v_mfma_f32_16x16x32_bf16 v[96:99], a[80:83], a[36:39], v[96:99]
ds_read_b64_tr_b16 a[110:111], v13 offset:9984
v_mfma_f32_16x16x32_bf16 v[104:107], a[80:83], a[40:43], v[104:107]
v_mfma_f32_16x16x32_bf16 v[104:107], a[84:87], a[56:59], v[104:107]
v_mfma_f32_16x16x32_bf16 v[112:115], a[84:87], a[60:63], v[112:115]
v_mfma_f32_16x16x32_bf16 v[112:115], a[80:83], a[44:47], v[112:115]
v_mfma_f32_16x16x32_bf16 v[116:119], a[88:91], a[44:47], v[116:119]
v_mfma_f32_16x16x32_bf16 v[116:119], a[92:95], a[60:63], v[116:119]
v_mfma_f32_16x16x32_bf16 v[108:111], a[92:95], a[56:59], v[108:111]
v_mfma_f32_16x16x32_bf16 v[108:111], a[88:91], a[40:43], v[108:111]
v_mov_b32 v15, s6
v_xor_b32 v15, 0, v15
v_mfma_f32_16x16x32_bf16 v[100:103], a[88:91], a[36:39], v[100:103]
v_writelane_b32 v15, s18, 0
v_lshlrev_b32 v15, 2, v15
v_bfe_u32 v12, v0, 2, 2
v_mfma_f32_16x16x32_bf16 v[100:103], a[92:95], a[52:55], v[100:103]
v_lshlrev_b32 v12, 11, v12
v_lshrrev_b32 v13, 4, v0
v_mfma_f32_16x16x32_bf16 v[92:95], a[92:95], a[48:51], v[92:95]
v_lshl_add_u32 v12, v13, 6, v12
v_and_b32 v13, 3, v0
v_mfma_f32_16x16x32_bf16 v[92:95], a[88:91], a[32:35], v[92:95]
s_waitcnt lgkmcnt(0)
v_lshl_add_u32 v12, v13, 4, v12
v_xor_b32 v12, s13, v12
v_mfma_f32_16x16x32_bf16 v[120:123], a[96:99], a[32:35], v[120:123]
L_padA12:
s_cmp_eq_u32 s95, 1
s_cbranch_scc1 L_hopA_ret
v_xor_b32 v13, 32, v12
v_add_u32 v13, 7168, v13
v_mul_f32 v24, s52, v24
v_mfma_f32_16x16x32_bf16 v[120:123], a[100:103], a[48:51], v[120:123]
v_mul_f32 v25, s52, v25
v_mul_f32 v26, s52, v26
v_mfma_f32_16x16x32_bf16 v[128:131], a[100:103], a[52:55], v[128:131]
v_mul_f32 v27, s52, v27
v_mul_f32 v28, s52, v28
v_mfma_f32_16x16x32_bf16 v[128:131], a[96:99], a[36:39], v[128:131]
v_mul_f32 v29, s52, v29
v_mul_f32 v30, s52, v30
v_mfma_f32_16x16x32_bf16 v[136:139], a[96:99], a[40:43], v[136:139]
v_mul_f32 v31, s52, v31
v_cvt_pk_bf16_f32 v24, v24, v25
v_cvt_pk_bf16_f32 v25, v26, v27
v_mfma_f32_16x16x32_bf16 v[136:139], a[100:103], a[56:59], v[136:139]
v_cvt_pk_bf16_f32 v26, v28, v29
v_cvt_pk_bf16_f32 v27, v30, v31
v_mfma_f32_16x16x32_bf16 v[144:147], a[100:103], a[60:63], v[144:147]
v_accvgpr_write_b32 a160, v24
v_accvgpr_write_b32 a161, v25
v_mfma_f32_16x16x32_bf16 v[144:147], a[96:99], a[44:47], v[144:147]
v_accvgpr_write_b32 a162, v26
v_accvgpr_write_b32 a163, v27
v_mfma_f32_16x16x32_bf16 v[148:151], a[104:107], a[44:47], v[148:151]
v_mul_f32 v32, s52, v32
v_mul_f32 v33, s52, v33
v_mul_f32 v34, s52, v34
v_mfma_f32_16x16x32_bf16 v[148:151], a[108:111], a[60:63], v[148:151]
v_mul_f32 v35, s52, v35
v_mul_f32 v36, s52, v36
v_mfma_f32_16x16x32_bf16 v[140:143], a[108:111], a[56:59], v[140:143]
v_mul_f32 v37, s52, v37
v_mul_f32 v38, s52, v38
v_mfma_f32_16x16x32_bf16 v[140:143], a[104:107], a[40:43], v[140:143]
v_mul_f32 v39, s52, v39
v_cvt_pk_bf16_f32 v32, v32, v33
v_mfma_f32_16x16x32_bf16 v[132:135], a[104:107], a[36:39], v[132:135]
v_cvt_pk_bf16_f32 v33, v34, v35
v_cvt_pk_bf16_f32 v34, v36, v37
v_cvt_pk_bf16_f32 v35, v38, v39
v_mfma_f32_16x16x32_bf16 v[132:135], a[108:111], a[52:55], v[132:135]
v_accvgpr_write_b32 a176, v32
v_accvgpr_write_b32 a177, v33
v_mfma_f32_16x16x32_bf16 v[124:127], a[108:111], a[48:51], v[124:127]
v_accvgpr_write_b32 a178, v34
v_accvgpr_write_b32 a179, v35
v_mfma_f32_16x16x32_bf16 v[124:127], a[104:107], a[32:35], v[124:127]
L_trans:
s_waitcnt vmcnt(21) lgkmcnt(0)
s_barrier
s_cmp_eq_u32 s4, 0
s_cbranch_scc1 L_hx_ld
ds_read_b128 v[188:191], v4 offset:0
ds_read_b64 v[216:217], v4 offset:1024
ds_read_b64 v[220:221], v4 offset:1032
ds_read_b128 v[204:207], v4 offset:16384
ds_read_b64 v[232:233], v4 offset:17408
ds_read_b64 v[236:237], v4 offset:17416
s_branch L_hx_rd
L_hx_ld:
buffer_load_dwordx4 v[188:191], v10, s[88:91], 0 offen sc1
buffer_load_dwordx2 v[216:217], v10, s[88:91], 0 offen offset:1024 sc1
buffer_load_dwordx2 v[220:221], v10, s[88:91], 0 offen offset:1032 sc1
buffer_load_dwordx4 v[204:207], v11, s[88:91], 0 offen sc1
buffer_load_dwordx2 v[232:233], v11, s[88:91], 0 offen offset:1024 sc1
buffer_load_dwordx2 v[236:237], v11, s[88:91], 0 offen offset:1032 sc1
L_hx_rd:
ds_read_b128 v[196:199], v6 offset:0
ds_read_b64 v[224:225], v6 offset:1024
ds_read_b64 v[228:229], v6 offset:1032
ds_read_b128 v[212:215], v6 offset:16384
ds_read_b64 v[240:241], v6 offset:17408
ds_read_b64 v[244:245], v6 offset:17416
ds_read_b128 a[0:3], v1 offset:8192
ds_read_b128 a[4:7], v1 offset:9216
ds_read_b128 a[8:11], v1 offset:10240
ds_read_b128 a[12:15], v1 offset:11264
ds_read_b128 a[16:19], v1 offset:12288
ds_read_b128 a[20:23], v1 offset:13312
ds_read_b128 a[24:27], v1 offset:14336
ds_read_b128 a[28:31], v1 offset:15360
L_hopB:
s_mov_b32 s95, 0
v_pk_mul_f32 v[40:41], v[40:41], s[52:53]
v_pk_mul_f32 v[42:43], v[42:43], s[52:53]
v_pk_mul_f32 v[44:45], v[44:45], s[52:53]
v_pk_mul_f32 v[46:47], v[46:47], s[52:53]
v_cvt_pk_bf16_f32 v40, v40, v41
v_cvt_pk_bf16_f32 v41, v42, v43
v_cvt_pk_bf16_f32 v42, v44, v45
v_cvt_pk_bf16_f32 v43, v46, v47
v_accvgpr_write_b32 a192, v40
v_accvgpr_write_b32 a193, v41
v_accvgpr_write_b32 a194, v42
v_accvgpr_write_b32 a195, v43
v_pk_mul_f32 v[48:49], v[48:49], s[52:53]
v_pk_mul_f32 v[50:51], v[50:51], s[52:53]
v_pk_mul_f32 v[52:53], v[52:53], s[52:53]
v_pk_mul_f32 v[54:55], v[54:55], s[52:53]
v_cvt_pk_bf16_f32 v48, v48, v49
v_cvt_pk_bf16_f32 v49, v50, v51
v_cvt_pk_bf16_f32 v50, v52, v53
v_cvt_pk_bf16_f32 v51, v54, v55
v_accvgpr_write_b32 a208, v48
v_accvgpr_write_b32 a209, v49
v_accvgpr_write_b32 a210, v50
v_accvgpr_write_b32 a211, v51
v_mov_b32 v47, s55
v_cndmask_b32 v36, v9, 0, s[56:57]
v_min_f32 v32, s55, v36
v_cndmask_b32 v44, v47, 0, s[36:37]
v_cndmask_b32 v37, v9, 0, s[58:59]
v_min_f32 v33, s55, v37
v_cndmask_b32 v45, v47, 0, s[38:39]
v_cndmask_b32 v38, v9, 0, s[60:61]
v_min_f32 v34, s55, v38
v_cndmask_b32 v46, v47, 0, s[40:41]
v_cndmask_b32 v39, v9, 0, s[62:63]
v_min_f32 v35, s55, v39
v_cndmask_b32 v47, v47, 0, s[42:43]
v_pk_mul_f32 v[56:57], v[56:57], s[52:53]
v_pk_mul_f32 v[58:59], v[58:59], s[52:53]
v_pk_mul_f32 v[60:61], v[60:61], s[52:53]
v_pk_mul_f32 v[62:63], v[62:63], s[52:53]
v_cvt_pk_bf16_f32 v56, v56, v57
v_cvt_pk_bf16_f32 v57, v58, v59
v_cvt_pk_bf16_f32 v58, v60, v61
v_cvt_pk_bf16_f32 v59, v62, v63
v_accvgpr_write_b32 a164, v56
v_accvgpr_write_b32 a165, v57
v_accvgpr_write_b32 a166, v58
v_accvgpr_write_b32 a167, v59
v_pk_mul_f32 v[64:65], v[64:65], s[52:53]
v_pk_mul_f32 v[66:67], v[66:67], s[52:53]
v_pk_mul_f32 v[68:69], v[68:69], s[52:53]
v_pk_mul_f32 v[70:71], v[70:71], s[52:53]
v_cvt_pk_bf16_f32 v64, v64, v65
v_cvt_pk_bf16_f32 v65, v66, v67
v_cvt_pk_bf16_f32 v66, v68, v69
v_cvt_pk_bf16_f32 v67, v70, v71
v_accvgpr_write_b32 a180, v64
v_accvgpr_write_b32 a181, v65
v_accvgpr_write_b32 a182, v66
v_accvgpr_write_b32 a183, v67
v_pk_mul_f32 v[72:73], v[72:73], s[52:53]
v_pk_mul_f32 v[74:75], v[74:75], s[52:53]
v_pk_mul_f32 v[76:77], v[76:77], s[52:53]
v_pk_mul_f32 v[78:79], v[78:79], s[52:53]
v_cvt_pk_bf16_f32 v72, v72, v73
v_cvt_pk_bf16_f32 v73, v74, v75
v_cvt_pk_bf16_f32 v74, v76, v77
v_cvt_pk_bf16_f32 v75, v78, v79
v_accvgpr_write_b32 a196, v72
v_accvgpr_write_b32 a197, v73
v_accvgpr_write_b32 a198, v74
v_accvgpr_write_b32 a199, v75
v_pk_mul_f32 v[80:81], v[80:81], s[52:53]
v_pk_mul_f32 v[82:83], v[82:83], s[52:53]
v_pk_mul_f32 v[84:85], v[84:85], s[52:53]
v_pk_mul_f32 v[86:87], v[86:87], s[52:53]
v_cvt_pk_bf16_f32 v80, v80, v81
v_cvt_pk_bf16_f32 v81, v82, v83
v_cvt_pk_bf16_f32 v82, v84, v85
v_cvt_pk_bf16_f32 v83, v86, v87
v_accvgpr_write_b32 a212, v80
v_accvgpr_write_b32 a213, v81
v_accvgpr_write_b32 a214, v82
v_accvgpr_write_b32 a215, v83
v_pk_mul_f32 v[88:89], v[88:89], s[52:53]
v_pk_mul_f32 v[90:91], v[90:91], s[52:53]
v_pk_mul_f32 v[92:93], v[92:93], s[52:53]
v_pk_mul_f32 v[94:95], v[94:95], s[52:53]
v_cvt_pk_bf16_f32 v88, v88, v89
v_cvt_pk_bf16_f32 v89, v90, v91
v_cvt_pk_bf16_f32 v90, v92, v93
v_cvt_pk_bf16_f32 v91, v94, v95
v_accvgpr_write_b32 a168, v88
v_accvgpr_write_b32 a169, v89
v_accvgpr_write_b32 a170, v90
v_accvgpr_write_b32 a171, v91
v_pk_mul_f32 v[96:97], v[96:97], s[52:53]
v_pk_mul_f32 v[98:99], v[98:99], s[52:53]
v_pk_mul_f32 v[100:101], v[100:101], s[52:53]
v_pk_mul_f32 v[102:103], v[102:103], s[52:53]
v_cvt_pk_bf16_f32 v96, v96, v97
v_cvt_pk_bf16_f32 v97, v98, v99
v_cvt_pk_bf16_f32 v98, v100, v101
v_cvt_pk_bf16_f32 v99, v102, v103
v_accvgpr_write_b32 a184, v96
v_accvgpr_write_b32 a185, v97
v_accvgpr_write_b32 a186, v98
v_accvgpr_write_b32 a187, v99
v_pk_mul_f32 v[104:105], v[104:105], s[52:53]
v_pk_mul_f32 v[106:107], v[106:107], s[52:53]
v_pk_mul_f32 v[108:109], v[108:109], s[52:53]
v_pk_mul_f32 v[110:111], v[110:111], s[52:53]
v_cvt_pk_bf16_f32 v104, v104, v105
v_cvt_pk_bf16_f32 v105, v106, v107
v_cvt_pk_bf16_f32 v106, v108, v109
v_cvt_pk_bf16_f32 v107, v110, v111
v_accvgpr_write_b32 a200, v104
v_accvgpr_write_b32 a201, v105
v_accvgpr_write_b32 a202, v106
v_accvgpr_write_b32 a203, v107
v_pk_mul_f32 v[112:113], v[112:113], s[52:53]
v_pk_mul_f32 v[114:115], v[114:115], s[52:53]
v_pk_mul_f32 v[116:117], v[116:117], s[52:53]
v_pk_mul_f32 v[118:119], v[118:119], s[52:53]
v_cvt_pk_bf16_f32 v112, v112, v113
v_cvt_pk_bf16_f32 v113, v114, v115
v_cvt_pk_bf16_f32 v114, v116, v117
v_cvt_pk_bf16_f32 v115, v118, v119
v_accvgpr_write_b32 a216, v112
v_accvgpr_write_b32 a217, v113
v_accvgpr_write_b32 a218, v114
v_accvgpr_write_b32 a219, v115
v_pk_mul_f32 v[120:121], v[120:121], s[52:53]
v_pk_mul_f32 v[122:123], v[122:123], s[52:53]
v_pk_mul_f32 v[124:125], v[124:125], s[52:53]
v_pk_mul_f32 v[126:127], v[126:127], s[52:53]
v_cvt_pk_bf16_f32 v120, v120, v121
v_cvt_pk_bf16_f32 v121, v122, v123
v_cvt_pk_bf16_f32 v122, v124, v125
v_cvt_pk_bf16_f32 v123, v126, v127
v_accvgpr_write_b32 a172, v120
v_accvgpr_write_b32 a173, v121
v_accvgpr_write_b32 a174, v122
v_accvgpr_write_b32 a175, v123
v_pk_mul_f32 v[128:129], v[128:129], s[52:53]
v_pk_mul_f32 v[130:131], v[130:131], s[52:53]
v_pk_mul_f32 v[132:133], v[132:133], s[52:53]
v_pk_mul_f32 v[134:135], v[134:135], s[52:53]
v_cvt_pk_bf16_f32 v128, v128, v129
v_cvt_pk_bf16_f32 v129, v130, v131
v_cvt_pk_bf16_f32 v130, v132, v133
v_cvt_pk_bf16_f32 v131, v134, v135
v_accvgpr_write_b32 a188, v128
v_accvgpr_write_b32 a189, v129
v_accvgpr_write_b32 a190, v130
v_accvgpr_write_b32 a191, v131
v_pk_mul_f32 v[136:137], v[136:137], s[52:53]
v_pk_mul_f32 v[138:139], v[138:139], s[52:53]
v_pk_mul_f32 v[140:141], v[140:141], s[52:53]
v_pk_mul_f32 v[142:143], v[142:143], s[52:53]
v_cvt_pk_bf16_f32 v136, v136, v137
v_cvt_pk_bf16_f32 v137, v138, v139
v_cvt_pk_bf16_f32 v138, v140, v141
v_cvt_pk_bf16_f32 v139, v142, v143
v_accvgpr_write_b32 a204, v136
v_accvgpr_write_b32 a205, v137
v_accvgpr_write_b32 a206, v138
v_accvgpr_write_b32 a207, v139
v_pk_mul_f32 v[144:145], v[144:145], s[52:53]
v_pk_mul_f32 v[146:147], v[146:147], s[52:53]
v_pk_mul_f32 v[148:149], v[148:149], s[52:53]
v_pk_mul_f32 v[150:151], v[150:151], s[52:53]
v_cvt_pk_bf16_f32 v144, v144, v145
v_cvt_pk_bf16_f32 v145, v146, v147
v_cvt_pk_bf16_f32 v146, v148, v149
v_cvt_pk_bf16_f32 v147, v150, v151
v_accvgpr_write_b32 a220, v144
v_accvgpr_write_b32 a221, v145
v_accvgpr_write_b32 a222, v146
v_accvgpr_write_b32 a223, v147
s_cmp_lg_u32 s4, 0
s_cbranch_scc1 L_spun_hx
s_mov_b32 s92, 200000
L_spin_hx:
s_waitcnt vmcnt(0)
v_max3_u32 v128, v188, v189, 0
v_max3_u32 v128, v190, v191, v128
v_max3_u32 v128, v216, v217, v128
v_max3_u32 v128, v220, v221, v128
v_max3_u32 v128, v204, v205, v128
v_max3_u32 v128, v206, v207, v128
v_max3_u32 v128, v232, v233, v128
v_max3_u32 v128, v236, v237, v128
v_cmp_eq_u32 vcc, -1, v128
s_sub_u32 s92, s92, 1
s_cbranch_scc1 L_spun_hx
s_nop 3
s_cbranch_vccz L_spun_hx
s_sleep 2
buffer_load_dwordx4 v[188:191], v10, s[88:91], 0 offen sc1
buffer_load_dwordx2 v[216:217], v10, s[88:91], 0 offen offset:1024 sc1
buffer_load_dwordx2 v[220:221], v10, s[88:91], 0 offen offset:1032 sc1
buffer_load_dwordx4 v[204:207], v11, s[88:91], 0 offen sc1
buffer_load_dwordx2 v[232:233], v11, s[88:91], 0 offen offset:1024 sc1
buffer_load_dwordx2 v[236:237], v11, s[88:91], 0 offen offset:1032 sc1
s_branch L_spin_hx
L_spun_hx:
s_waitcnt lgkmcnt(0)
s_barrier
v_mfma_f32_16x16x32_bf16 v[52:55], v[184:187], v[152:155], v[248:251]
v_mov_b32 v140, 0
v_mov_b32 v141, 0
v_mfma_f32_16x16x32_bf16 v[48:51], v[188:191], v[152:155], v[32:35]
v_mov_b32 v142, 0
v_mov_b32 v143, 0
v_mfma_f32_16x16x32_bf16 v[60:63], v[192:195], v[160:163], v[248:251]
v_mov_b32 v144, 0
v_mov_b32 v145, 0
v_mfma_f32_16x16x32_bf16 v[56:59], v[196:199], v[160:163], v[36:39]
v_mov_b32 v146, 0
v_mov_b32 v147, 0
v_mfma_f32_16x16x32_bf16 v[68:71], v[200:203], v[168:171], v[248:251]
v_mov_b32 v148, 0
v_mov_b32 v149, 0
v_mfma_f32_16x16x32_bf16 v[64:67], v[204:207], v[168:171], v[36:39]
v_max3_f32 v52, v48, v49, v52
v_max3_f32 v54, v50, v51, v54
v_mfma_f32_16x16x32_bf16 v[76:79], v[208:211], v[176:179], v[248:251]
v_max_f32 v52, v52, v53
v_max_f32 v53, v54, v55
v_mfma_f32_16x16x32_bf16 v[72:75], v[212:215], v[176:179], v[36:39]
v_max_f32 v136, v52, v53
v_max3_f32 v60, v56, v57, v60
v_mfma_f32_16x16x32_bf16 v[16:19], a[0:3], a[160:163], v[44:47]
v_max3_f32 v62, v58, v59, v62
v_max_f32 v60, v60, v61
v_mfma_f32_16x16x32_bf16 v[16:19], a[4:7], a[164:167], v[16:19]
v_max_f32 v61, v62, v63
v_max_f32 v137, v60, v61
v_mfma_f32_16x16x32_bf16 v[16:19], a[8:11], a[168:171], v[16:19]
v_max3_f32 v68, v64, v65, v68
v_max3_f32 v70, v66, v67, v70
v_mfma_f32_16x16x32_bf16 v[16:19], a[12:15], a[172:175], v[16:19]
v_max_f32 v68, v68, v69
v_max_f32 v69, v70, v71
v_mfma_f32_16x16x32_bf16 v[20:23], a[0:3], a[176:179], 0
v_max_f32 v138, v68, v69
v_max3_f32 v76, v72, v73, v76
v_mfma_f32_16x16x32_bf16 v[20:23], a[4:7], a[180:183], v[20:23]
v_max3_f32 v78, v74, v75, v78
v_max_f32 v76, v76, v77
v_mfma_f32_16x16x32_bf16 v[20:23], a[8:11], a[184:187], v[20:23]
v_max_f32 v77, v78, v79
v_max_f32 v139, v76, v77
v_mfma_f32_16x16x32_bf16 v[20:23], a[12:15], a[188:191], v[20:23]
v_mov_b32 v150, 0
v_mov_b32 v151, 0
v_mfma_f32_16x16x32_bf16 v[24:27], a[0:3], a[192:195], 0
v_mov_b32 v248, 0
v_mov_b32 v249, 0
v_mfma_f32_16x16x32_bf16 v[24:27], a[4:7], a[196:199], v[24:27]
v_mov_b32 v250, 0
v_mov_b32 v251, 0
v_mfma_f32_16x16x32_bf16 v[24:27], a[8:11], a[200:203], v[24:27]
v_max3_f32 v80, v16, v17, v18
v_max_f32 v80, v80, v19
v_mfma_f32_16x16x32_bf16 v[24:27], a[12:15], a[204:207], v[24:27]
v_max3_f32 v84, v20, v21, v22
v_max_f32 v84, v84, v23
v_mfma_f32_16x16x32_bf16 v[28:31], a[0:3], a[208:211], 0
v_mov_b32 v128, v136
v_mov_b32 v129, v137
v_mfma_f32_16x16x32_bf16 v[28:31], a[4:7], a[212:215], v[28:31]
v_mov_b32 v130, v138
v_mov_b32 v131, v139
v_mfma_f32_16x16x32_bf16 v[28:31], a[8:11], a[216:219], v[28:31]
v_permlane16_swap_b32 v128, v136
v_permlane16_swap_b32 v129, v137
v_mfma_f32_16x16x32_bf16 v[28:31], a[12:15], a[220:223], v[28:31]
v_permlane16_swap_b32 v130, v138
v_permlane16_swap_b32 v131, v139
v_max_f32 v136, v136, v128
v_max_f32 v137, v137, v129
v_max_f32 v138, v138, v130
v_max_f32 v139, v139, v131
v_max3_f32 v88, v24, v25, v26
v_max_f32 v88, v88, v27
v_mov_b32 v128, v136
v_mov_b32 v129, v137
v_mov_b32 v130, v138
v_mov_b32 v131, v139
v_max3_f32 v92, v28, v29, v30
v_max_f32 v92, v92, v31
v_permlane32_swap_b32 v128, v136
v_permlane32_swap_b32 v129, v137
v_permlane32_swap_b32 v130, v138
v_permlane32_swap_b32 v131, v139
v_max_f32 v136, v136, v128
v_max_f32 v137, v137, v129
v_max_f32 v138, v138, v130
v_max_f32 v139, v139, v131
v_mul_f32 v136, s54, v136
v_mul_f32 v137, s54, v137
v_mul_f32 v138, s54, v138
v_mul_f32 v139, s54, v139
v_fma_f32 v52, v52, s54, -v136
v_fma_f32 v53, v53, s54, -v136
v_fma_f32 v60, v60, s54, -v137
v_fma_f32 v61, v61, s54, -v137
v_fma_f32 v68, v68, s54, -v138
v_fma_f32 v69, v69, s54, -v138
v_fma_f32 v76, v76, s54, -v139
v_fma_f32 v77, v77, s54, -v139
v_exp_f32 v52, v52
v_exp_f32 v53, v53
v_exp_f32 v60, v60
v_exp_f32 v61, v61
v_exp_f32 v68, v68
v_exp_f32 v69, v69
v_exp_f32 v76, v76
v_exp_f32 v77, v77
v_cvt_pk_bf16_f32 v52, v52, v52
v_cvt_pk_bf16_f32 v53, v53, v53
v_cvt_pk_bf16_f32 v60, v60, v60
v_cvt_pk_bf16_f32 v61, v61, v61
v_cvt_pk_bf16_f32 v68, v68, v68
v_cvt_pk_bf16_f32 v69, v69, v69
v_cvt_pk_bf16_f32 v76, v76, v76
v_cvt_pk_bf16_f32 v77, v77, v77
v_and_b32 v48, v252, v52
v_and_b32 v49, v253, v53
v_and_b32 v50, v254, v52
v_and_b32 v51, v255, v53
v_and_b32 v56, v252, v60
v_and_b32 v57, v253, v61
v_and_b32 v58, v254, v60
v_and_b32 v59, v255, v61
v_and_b32 v64, v252, v68
v_and_b32 v65, v253, v69
v_and_b32 v66, v254, v68
v_and_b32 v67, v255, v69
v_and_b32 v72, v252, v76
v_and_b32 v73, v253, v77
v_and_b32 v74, v254, v76
v_and_b32 v75, v255, v77
v_mfma_f32_16x16x32_bf16 v[156:159], a[240:243], v[48:51], 0
v_mov_b32 v128, v80
v_mov_b32 v129, v84
v_mfma_f32_16x16x32_bf16 v[164:167], a[240:243], v[56:59], 0
v_mov_b32 v130, v88
v_mov_b32 v131, v92
v_mfma_f32_16x16x32_bf16 v[172:175], a[240:243], v[64:67], 0
v_permlane16_swap_b32 v128, v80
v_permlane16_swap_b32 v129, v84
v_mfma_f32_16x16x32_bf16 v[180:183], a[240:243], v[72:75], 0
v_permlane16_swap_b32 v130, v88
v_permlane16_swap_b32 v131, v92
v_mfma_f32_16x16x32_bf16 v[184:187], v[216:219], v[48:51], 0
v_max_f32 v80, v80, v128
v_max_f32 v84, v84, v129
v_mfma_f32_16x16x32_bf16 v[188:191], v[220:223], v[48:51], 0
v_max_f32 v88, v88, v130
v_max_f32 v92, v92, v131
v_mfma_f32_16x16x32_bf16 v[192:195], v[224:227], v[56:59], 0
v_mov_b32 v128, v80
v_mov_b32 v129, v84
v_mfma_f32_16x16x32_bf16 v[196:199], v[228:231], v[56:59], 0
v_mov_b32 v130, v88
v_mov_b32 v131, v92
v_mfma_f32_16x16x32_bf16 v[200:203], v[232:235], v[64:67], 0
v_permlane32_swap_b32 v128, v80
v_permlane32_swap_b32 v129, v84
v_mfma_f32_16x16x32_bf16 v[204:207], v[236:239], v[64:67], 0
v_permlane32_swap_b32 v130, v88
v_permlane32_swap_b32 v131, v92
v_mfma_f32_16x16x32_bf16 v[208:211], v[240:243], v[72:75], 0
v_max_f32 v80, v80, v128
v_max_f32 v84, v84, v129
v_mfma_f32_16x16x32_bf16 v[212:215], v[244:247], v[72:75], 0
v_max_f32 v88, v88, v130
v_max_f32 v92, v92, v131
v_rcp_f32 v128, v156
v_rcp_f32 v130, v164
v_rcp_f32 v132, v172
v_rcp_f32 v134, v180
v_sub_f32 v83, 0, v80
v_sub_f32 v82, 0, v80
v_sub_f32 v81, 0, v80
v_sub_f32 v80, 0, v80
v_min_f32 v103, s8, v80
v_cndmask_b32 v96, v103, v80, s[36:37]
v_cndmask_b32 v97, v103, v80, s[38:39]
v_cndmask_b32 v98, v103, v80, s[40:41]
v_cndmask_b32 v99, v103, v80, s[42:43]
v_cndmask_b32 v100, v9, v103, s[36:37]
v_cndmask_b32 v101, v9, v103, s[38:39]
v_cndmask_b32 v102, v9, v103, s[40:41]
v_cndmask_b32 v103, v9, v103, s[42:43]
v_pk_mul_f32 v[184:185], v[184:185], v[128:129] op_sel_hi:[1,0]
v_pk_mul_f32 v[186:187], v[186:187], v[128:129] op_sel_hi:[1,0]
v_pk_mul_f32 v[188:189], v[188:189], v[128:129] op_sel_hi:[1,0]
v_pk_mul_f32 v[190:191], v[190:191], v[128:129] op_sel_hi:[1,0]
v_pk_mul_f32 v[192:193], v[192:193], v[130:131] op_sel_hi:[1,0]
v_pk_mul_f32 v[194:195], v[194:195], v[130:131] op_sel_hi:[1,0]
v_pk_mul_f32 v[196:197], v[196:197], v[130:131] op_sel_hi:[1,0]
v_pk_mul_f32 v[198:199], v[198:199], v[130:131] op_sel_hi:[1,0]
v_pk_mul_f32 v[200:201], v[200:201], v[132:133] op_sel_hi:[1,0]
v_pk_mul_f32 v[202:203], v[202:203], v[132:133] op_sel_hi:[1,0]
v_pk_mul_f32 v[204:205], v[204:205], v[132:133] op_sel_hi:[1,0]
v_pk_mul_f32 v[206:207], v[206:207], v[132:133] op_sel_hi:[1,0]
v_pk_mul_f32 v[208:209], v[208:209], v[134:135] op_sel_hi:[1,0]
v_pk_mul_f32 v[210:211], v[210:211], v[134:135] op_sel_hi:[1,0]
v_pk_mul_f32 v[212:213], v[212:213], v[134:135] op_sel_hi:[1,0]
v_pk_mul_f32 v[214:215], v[214:215], v[134:135] op_sel_hi:[1,0]
v_cvt_pk_bf16_f32 v32, v184, v185
v_cvt_pk_bf16_f32 v33, v186, v187
v_cvt_pk_bf16_f32 v34, v188, v189
v_cvt_pk_bf16_f32 v35, v190, v191
v_cvt_pk_bf16_f32 v36, v192, v193
v_cvt_pk_bf16_f32 v37, v194, v195
v_cvt_pk_bf16_f32 v38, v196, v197
v_cvt_pk_bf16_f32 v39, v198, v199
v_cvt_pk_bf16_f32 v40, v200, v201
v_cvt_pk_bf16_f32 v41, v202, v203
v_cvt_pk_bf16_f32 v42, v204, v205
v_cvt_pk_bf16_f32 v43, v206, v207
v_cvt_pk_bf16_f32 v44, v208, v209
v_cvt_pk_bf16_f32 v45, v210, v211
v_cvt_pk_bf16_f32 v46, v212, v213
v_cvt_pk_bf16_f32 v47, v214, v215
buffer_store_dwordx4 v[32:35], v3, s[88:91], s44 offen sc1
v_sub_f32 v87, 0, v84
v_sub_f32 v86, 0, v84
v_sub_f32 v85, 0, v84
v_sub_f32 v84, 0, v84
v_min_f32 v111, s9, v84
v_cndmask_b32 v104, v111, v84, s[36:37]
v_cndmask_b32 v105, v111, v84, s[38:39]
v_cndmask_b32 v106, v111, v84, s[40:41]
v_cndmask_b32 v107, v111, v84, s[42:43]
v_cndmask_b32 v108, v9, v111, s[36:37]
v_cndmask_b32 v109, v9, v111, s[38:39]
v_cndmask_b32 v110, v9, v111, s[40:41]
v_cndmask_b32 v111, v9, v111, s[42:43]
v_sub_f32 v91, 0, v88
v_sub_f32 v90, 0, v88
v_sub_f32 v89, 0, v88
v_sub_f32 v88, 0, v88
v_min_f32 v119, s8, v88
v_cndmask_b32 v112, v119, v88, s[36:37]
v_cndmask_b32 v113, v119, v88, s[38:39]
v_cndmask_b32 v114, v119, v88, s[40:41]
v_cndmask_b32 v115, v119, v88, s[42:43]
v_cndmask_b32 v116, v9, v119, s[36:37]
buffer_store_dwordx4 v[36:39], v3, s[88:91], s45 offen sc1
v_cndmask_b32 v117, v9, v119, s[38:39]
v_cndmask_b32 v118, v9, v119, s[40:41]
v_cndmask_b32 v119, v9, v119, s[42:43]
v_sub_f32 v95, 0, v92
v_sub_f32 v94, 0, v92
v_sub_f32 v93, 0, v92
v_sub_f32 v92, 0, v92
v_min_f32 v127, s9, v92
v_cndmask_b32 v120, v127, v92, s[36:37]
v_cndmask_b32 v121, v127, v92, s[38:39]
v_cndmask_b32 v122, v127, v92, s[40:41]
v_cndmask_b32 v123, v127, v92, s[42:43]
v_cndmask_b32 v124, v9, v127, s[36:37]
v_cndmask_b32 v125, v9, v127, s[38:39]
v_cndmask_b32 v126, v9, v127, s[40:41]
v_cndmask_b32 v127, v9, v127, s[42:43]
v_and_b32 v9, 1, v0
v_mul_u32_u24 v9, 0xaaaa, v9
v_add_u32 v9, 0x4444, v9
v_mov_b64 v[128:129], 0
v_mov_b64 v[130:131], 0
v_mov_b64 v[132:133], 0
v_mov_b64 v[134:135], 0
v_mov_b64 v[136:137], 0
buffer_store_dwordx4 v[40:43], v3, s[88:91], s46 offen sc1
v_mov_b64 v[138:139], 0
v_mov_b64 v[152:153], 0
v_mov_b64 v[154:155], 0
v_mov_b64 v[156:157], 0
v_mov_b64 v[158:159], 0
v_mov_b64 v[160:161], 0
v_mov_b64 v[162:163], 0
v_mov_b64 v[164:165], 0
v_mov_b64 v[166:167], 0
v_mov_b64 v[168:169], 0
v_mov_b64 v[170:171], 0
v_mov_b64 v[172:173], 0
v_mov_b64 v[174:175], 0
v_mov_b64 v[176:177], 0
v_mov_b64 v[178:179], 0
v_mov_b64 v[180:181], 0
v_mov_b64 v[182:183], 0
v_mov_b64 v[184:185], 0
v_mov_b64 v[186:187], 0
v_mov_b64 v[188:189], 0
v_mov_b64 v[190:191], 0
v_mov_b64 v[192:193], 0
v_mov_b64 v[194:195], 0
buffer_store_dwordx4 v[44:47], v3, s[88:91], s47 offen sc1
v_mov_b64 v[196:197], 0
v_mov_b64 v[198:199], 0
v_mov_b64 v[200:201], 0
v_mov_b64 v[202:203], 0
v_mov_b64 v[204:205], 0
v_mov_b64 v[206:207], 0
v_mov_b64 v[208:209], 0
v_mov_b64 v[210:211], 0
v_mov_b64 v[212:213], 0
v_mov_b64 v[214:215], 0
v_mov_b64 v[216:217], 0
v_mov_b64 v[218:219], 0
v_mov_b64 v[220:221], 0
v_mov_b64 v[222:223], 0
v_mov_b64 v[224:225], 0
v_mov_b64 v[226:227], 0
v_mov_b64 v[228:229], 0
v_mov_b64 v[230:231], 0
v_mov_b64 v[232:233], 0
v_mov_b64 v[234:235], 0
v_mov_b64 v[236:237], 0
v_mov_b64 v[238:239], 0
v_mov_b64 v[252:253], 0
v_mov_b64 v[254:255], 0
L_att_start:
s_mov_b32 s15, s6
s_cmp_eq_u32 s6, 0
s_cbranch_scc1 L_att_j0
v_mfma_f32_16x16x32_bf16 v[16:19], a[0:3], a[160:163], v[80:83]
ds_read_b128 a[128:131], v1 offset:24576
v_mov_b32 v240, 0
v_mfma_f32_16x16x32_bf16 v[16:19], a[4:7], a[164:167], v[16:19]
ds_read_b128 a[132:135], v1 offset:25600
v_mov_b32 v241, 0
v_mfma_f32_16x16x32_bf16 v[16:19], a[8:11], a[168:171], v[16:19]
ds_read_b128 a[136:139], v1 offset:26624
s_add_u32 m0, s27, 0x0
v_mfma_f32_16x16x32_bf16 v[16:19], a[12:15], a[172:175], v[16:19]
buffer_load_dwordx4 v3, s[48:51], s32 offen offset:0 sc1 lds
v_mfma_f32_16x16x32_bf16 v[20:23], a[0:3], a[176:179], v[84:87]
ds_read_b128 a[140:143], v1 offset:27648
v_mov_b32 v242, 0
v_mfma_f32_16x16x32_bf16 v[20:23], a[4:7], a[180:183], v[20:23]
ds_read_b128 a[144:147], v1 offset:28672
v_mov_b32 v243, 0
v_mfma_f32_16x16x32_bf16 v[20:23], a[8:11], a[184:187], v[20:23]
ds_read_b128 a[148:151], v1 offset:29696
v_mov_b32 v244, 0
v_mfma_f32_16x16x32_bf16 v[20:23], a[12:15], a[188:191], v[20:23]
ds_read_b128 a[152:155], v1 offset:30720
v_mov_b32 v245, 0
v_mfma_f32_16x16x32_bf16 v[24:27], a[0:3], a[192:195], v[88:91]
ds_read_b128 a[156:159], v1 offset:31744
v_exp_f32 v16, v16
v_mfma_f32_16x16x32_bf16 v[24:27], a[4:7], a[196:199], v[24:27]
v_exp_f32 v17, v17
v_mfma_f32_16x16x32_bf16 v[24:27], a[8:11], a[200:203], v[24:27]
buffer_load_dwordx4 v3, s[48:51], s32 offen offset:1024 sc1 lds
v_mfma_f32_16x16x32_bf16 v[24:27], a[12:15], a[204:207], v[24:27]
v_exp_f32 v18, v18
v_mfma_f32_16x16x32_bf16 v[28:31], a[0:3], a[208:211], v[92:95]
v_exp_f32 v19, v19
v_mfma_f32_16x16x32_bf16 v[28:31], a[4:7], a[212:215], v[28:31]
v_exp_f32 v20, v20
v_mfma_f32_16x16x32_bf16 v[28:31], a[8:11], a[216:219], v[28:31]
v_cvt_pk_bf16_f32 v48, v16, v17
v_cvt_pk_bf16_f32 v49, v18, v19
v_mfma_f32_16x16x32_bf16 v[28:31], a[12:15], a[220:223], v[28:31]
v_exp_f32 v21, v21
v_mfma_f32_16x16x32_bf16 v[32:35], a[16:19], a[160:163], v[80:83]
v_exp_f32 v22, v22
v_mfma_f32_16x16x32_bf16 v[32:35], a[20:23], a[164:167], v[32:35]
v_exp_f32 v23, v23
v_mfma_f32_16x16x32_bf16 v[32:35], a[24:27], a[168:171], v[32:35]
buffer_load_dwordx4 v3, s[48:51], s32 offen offset:2048 sc1 lds
v_mfma_f32_16x16x32_bf16 v[32:35], a[28:31], a[172:175], v[32:35]
v_exp_f32 v24, v24
v_mfma_f32_16x16x32_bf16 v[36:39], a[16:19], a[176:179], v[84:87]
v_exp_f32 v25, v25
v_mfma_f32_16x16x32_bf16 v[36:39], a[20:23], a[180:183], v[36:39]
v_cvt_pk_bf16_f32 v52, v20, v21
v_cvt_pk_bf16_f32 v53, v22, v23
v_mfma_f32_16x16x32_bf16 v[36:39], a[24:27], a[184:187], v[36:39]
v_exp_f32 v26, v26
v_mfma_f32_16x16x32_bf16 v[36:39], a[28:31], a[188:191], v[36:39]
v_exp_f32 v27, v27
v_mfma_f32_16x16x32_bf16 v[40:43], a[16:19], a[192:195], v[88:91]
v_exp_f32 v28, v28
v_mfma_f32_16x16x32_bf16 v[40:43], a[20:23], a[196:199], v[40:43]
buffer_load_dwordx4 v3, s[48:51], s32 offen offset:3072 sc1 lds
v_mfma_f32_16x16x32_bf16 v[40:43], a[24:27], a[200:203], v[40:43]
s_add_u32 s32, s32, 0x8000
v_exp_f32 v29, v29
v_mfma_f32_16x16x32_bf16 v[40:43], a[28:31], a[204:207], v[40:43]
v_exp_f32 v30, v30
v_mfma_f32_16x16x32_bf16 v[44:47], a[16:19], a[208:211], v[92:95]
v_exp_f32 v31, v31
v_mfma_f32_16x16x32_bf16 v[44:47], a[20:23], a[212:215], v[44:47]
v_exp_f32 v32, v32
v_mfma_f32_16x16x32_bf16 v[44:47], a[24:27], a[216:219], v[44:47]
v_exp_f32 v33, v33
v_mfma_f32_16x16x32_bf16 v[44:47], a[28:31], a[220:223], v[44:47]
s_waitcnt lgkmcnt(0)
v_cvt_pk_bf16_f32 v56, v24, v25
v_cvt_pk_bf16_f32 v57, v26, v27
v_mov_b32 v246, 0
v_mov_b32 v247, 0
v_mfma_f32_16x16x32_bf16 v[16:19], a[128:131], a[160:163], v[80:83]
ds_read_b128 a[32:35], v1 offset:16384
v_cvt_pk_bf16_f32 v60, v28, v29
v_mfma_f32_16x16x32_bf16 v[16:19], a[132:135], a[164:167], v[16:19]
v_exp_f32 v34, v34
v_mfma_f32_16x16x32_bf16 v[16:19], a[136:139], a[168:171], v[16:19]
s_add_u32 m0, s27, 0x1000
v_exp_f32 v35, v35
v_mfma_f32_16x16x32_bf16 v[16:19], a[140:143], a[172:175], v[16:19]
buffer_load_dwordx4 v3, s[48:51], s7 offen offset:0 sc1 lds
v_mfma_f32_16x16x32_bf16 v[20:23], a[128:131], a[176:179], v[84:87]
ds_read_b128 a[36:39], v1 offset:17408
v_cvt_pk_bf16_f32 v61, v30, v31
v_mfma_f32_16x16x32_bf16 v[20:23], a[132:135], a[180:183], v[20:23]
v_exp_f32 v36, v36
v_mfma_f32_16x16x32_bf16 v[20:23], a[136:139], a[184:187], v[20:23]
ds_read_b128 a[40:43], v1 offset:18432
v_cvt_pk_bf16_f32 v50, v32, v33
v_mfma_f32_16x16x32_bf16 v[20:23], a[140:143], a[188:191], v[20:23]
v_exp_f32 v37, v37
v_mfma_f32_16x16x32_bf16 v[24:27], a[128:131], a[192:195], v[88:91]
v_exp_f32 v38, v38
v_mfma_f32_16x16x32_bf16 v[24:27], a[132:135], a[196:199], v[24:27]
ds_read_b128 a[44:47], v1 offset:19456
v_cvt_pk_bf16_f32 v51, v34, v35
v_mfma_f32_16x16x32_bf16 v[24:27], a[136:139], a[200:203], v[24:27]
buffer_load_dwordx4 v3, s[48:51], s7 offen offset:1024 sc1 lds
v_mfma_f32_16x16x32_bf16 v[24:27], a[140:143], a[204:207], v[24:27]
v_exp_f32 v39, v39
v_mfma_f32_16x16x32_bf16 v[28:31], a[128:131], a[208:211], v[92:95]
v_exp_f32 v40, v40
v_mfma_f32_16x16x32_bf16 v[28:31], a[132:135], a[212:215], v[28:31]
ds_read_b128 a[48:51], v1 offset:20480
v_cvt_pk_bf16_f32 v54, v36, v37
v_mfma_f32_16x16x32_bf16 v[28:31], a[136:139], a[216:219], v[28:31]
v_exp_f32 v41, v41
v_mfma_f32_16x16x32_bf16 v[28:31], a[140:143], a[220:223], v[28:31]
v_exp_f32 v42, v42
v_mfma_f32_16x16x32_bf16 v[32:35], a[144:147], a[160:163], v[80:83]
buffer_load_dwordx4 v3, s[48:51], s7 offen offset:2048 sc1 lds
v_mfma_f32_16x16x32_bf16 v[32:35], a[148:151], a[164:167], v[32:35]
ds_read_b128 a[52:55], v1 offset:21504
v_cvt_pk_bf16_f32 v55, v38, v39
v_mfma_f32_16x16x32_bf16 v[32:35], a[152:155], a[168:171], v[32:35]
v_exp_f32 v43, v43
v_mfma_f32_16x16x32_bf16 v[32:35], a[156:159], a[172:175], v[32:35]
ds_read_b128 a[56:59], v1 offset:22528
v_cvt_pk_bf16_f32 v58, v40, v41
v_mfma_f32_16x16x32_bf16 v[36:39], a[144:147], a[176:179], v[84:87]
v_exp_f32 v44, v44
v_mfma_f32_16x16x32_bf16 v[36:39], a[148:151], a[180:183], v[36:39]
v_exp_f32 v45, v45
v_mfma_f32_16x16x32_bf16 v[36:39], a[152:155], a[184:187], v[36:39]
ds_read_b128 a[60:63], v1 offset:23552
v_xor_b32 v1, 0x8000, v1
v_mfma_f32_16x16x32_bf16 v[36:39], a[156:159], a[188:191], v[36:39]
buffer_load_dwordx4 v3, s[48:51], s7 offen offset:3072 sc1 lds
v_cvt_pk_bf16_f32 v59, v42, v43
v_mfma_f32_16x16x32_bf16 v[40:43], a[144:147], a[192:195], v[88:91]
s_add_u32 s7, s7, 0x8000
v_exp_f32 v46, v46
v_mfma_f32_16x16x32_bf16 v[40:43], a[148:151], a[196:199], v[40:43]
s_xor_b32 s27, s27, 0x38000
v_exp_f32 v47, v47
v_mfma_f32_16x16x32_bf16 v[40:43], a[152:155], a[200:203], v[40:43]
v_exp_f32 v16, v16
v_mfma_f32_16x16x32_bf16 v[40:43], a[156:159], a[204:207], v[40:43]
v_exp_f32 v17, v17
v_cvt_pk_bf16_f32 v62, v44, v45
v_cvt_pk_bf16_f32 v63, v46, v47
v_mfma_f32_16x16x32_bf16 v[44:47], a[144:147], a[208:211], v[92:95]
v_exp_f32 v18, v18
v_mfma_f32_16x16x32_bf16 v[44:47], a[148:151], a[212:215], v[44:47]
v_exp_f32 v19, v19
v_mfma_f32_16x16x32_bf16 v[44:47], a[152:155], a[216:219], v[44:47]
s_waitcnt vmcnt(8) lgkmcnt(0)
v_exp_f32 v20, v20
v_mfma_f32_16x16x32_bf16 v[44:47], a[156:159], a[220:223], v[44:47]
s_barrier
v_cvt_pk_bf16_f32 v64, v16, v17
v_exp_f32 v21, v21
v_exp_f32 v22, v22
v_exp_f32 v23, v23
v_exp_f32 v24, v24
v_exp_f32 v25, v25
v_exp_f32 v26, v26
v_exp_f32 v27, v27
v_cvt_pk_bf16_f32 v65, v18, v19
v_cvt_pk_bf16_f32 v68, v20, v21
v_cvt_pk_bf16_f32 v69, v22, v23
s_cmp_lg_u32 s33, 0
s_cbranch_scc1 L_sig_bd
s_lshl_b32 s8, s6, 2
s_add_u32 s8, s8, 192
s_cmp_lg_u32 s4, 0
s_cbranch_scc1 L_sig_bd
v_mov_b32 v4, 1
s_mov_b64 exec, 1
buffer_atomic_add v4, off, s[84:87], s8 sc1
s_mov_b64 exec, -1
L_sig_bd:
s_getreg_b32 s8, hwreg(HW_REG_HW_ID, 5, 1)
s_cmp_lg_u32 s8, 0
s_cbranch_scc1 L_att_dodd1
s_branch L_att_dodd0
L_att_deven0:
v_mfma_f32_16x16x32_bf16 v[128:131], a[32:35], v[48:51], v[128:131]
ds_read_b128 a[0:3], v1 offset:8192
v_cvt_pk_bf16_f32 v72, v24, v25
v_mfma_f32_16x16x32_bf16 v[160:163], a[32:35], v[52:55], v[160:163]
v_exp_f32 v28, v28
v_mfma_f32_16x16x32_bf16 v[192:195], a[32:35], v[56:59], v[192:195]
v_cvt_pk_bf16_f32 v73, v26, v27
v_mfma_f32_16x16x32_bf16 v[224:227], a[32:35], v[60:63], v[224:227]
ds_read_b128 a[4:7], v1 offset:9216
v_mfma_f32_16x16x32_bf16 v[228:231], a[36:39], v[60:63], v[228:231]
v_exp_f32 v29, v29
v_mfma_f32_16x16x32_bf16 v[196:199], a[36:39], v[56:59], v[196:199]
v_exp_f32 v30, v30
v_mfma_f32_16x16x32_bf16 v[164:167], a[36:39], v[52:55], v[164:167]
s_add_u32 m0, s27, 0x0
v_cvt_pk_bf16_f32 v76, v28, v29
v_mfma_f32_16x16x32_bf16 v[132:135], a[36:39], v[48:51], v[132:135]
buffer_load_dwordx4 v3, s[48:51], s32 offen offset:0 sc1 lds
v_mfma_f32_16x16x32_bf16 v[136:139], a[40:43], v[48:51], v[136:139]
ds_read_b128 a[8:11], v1 offset:10240
v_mfma_f32_16x16x32_bf16 v[168:171], a[40:43], v[52:55], v[168:171]
v_exp_f32 v31, v31
v_mfma_f32_16x16x32_bf16 v[200:203], a[40:43], v[56:59], v[200:203]
v_exp_f32 v32, v32
v_mfma_f32_16x16x32_bf16 v[232:235], a[40:43], v[60:63], v[232:235]
ds_read_b128 a[12:15], v1 offset:11264
v_cvt_pk_bf16_f32 v77, v30, v31
v_mfma_f32_16x16x32_bf16 v[236:239], a[44:47], v[60:63], v[236:239]
v_mfma_f32_16x16x32_bf16 v[204:207], a[44:47], v[56:59], v[204:207]
v_exp_f32 v33, v33
v_mfma_f32_16x16x32_bf16 v[172:175], a[44:47], v[52:55], v[172:175]
v_exp_f32 v34, v34
v_mfma_f32_16x16x32_bf16 v[140:143], a[44:47], v[48:51], v[140:143]
ds_read_b128 a[16:19], v1 offset:12288
v_cvt_pk_bf16_f32 v66, v32, v33
v_mfma_f32_16x16x32_bf16 v[144:147], a[48:51], v[48:51], v[144:147]
v_mfma_f32_16x16x32_bf16 v[176:179], a[48:51], v[52:55], v[176:179]
v_exp_f32 v35, v35
v_mfma_f32_16x16x32_bf16 v[208:211], a[48:51], v[56:59], v[208:211]
v_exp_f32 v36, v36
v_mfma_f32_16x16x32_bf16 v[240:243], a[48:51], v[60:63], v[240:243]
ds_read_b128 a[20:23], v1 offset:13312
v_cvt_pk_bf16_f32 v67, v34, v35
v_mfma_f32_16x16x32_bf16 v[244:247], a[52:55], v[60:63], v[244:247]
v_exp_f32 v37, v37
v_mfma_f32_16x16x32_bf16 v[212:215], a[52:55], v[56:59], v[212:215]
v_cvt_pk_bf16_f32 v70, v36, v37
v_mfma_f32_16x16x32_bf16 v[180:183], a[52:55], v[52:55], v[180:183]
ds_read_b128 a[24:27], v1 offset:14336
v_mfma_f32_16x16x32_bf16 v[148:151], a[52:55], v[48:51], v[148:151]
buffer_load_dwordx4 v3, s[48:51], s32 offen offset:1024 sc1 lds
v_mfma_f32_16x16x32_bf16 v[152:155], a[56:59], v[48:51], v[152:155]
v_exp_f32 v38, v38
v_mfma_f32_16x16x32_bf16 v[184:187], a[56:59], v[52:55], v[184:187]
v_exp_f32 v39, v39
v_mfma_f32_16x16x32_bf16 v[216:219], a[56:59], v[56:59], v[216:219]
ds_read_b128 a[28:31], v1 offset:15360
v_cvt_pk_bf16_f32 v71, v38, v39
v_mfma_f32_16x16x32_bf16 v[248:251], a[56:59], v[60:63], v[248:251]
v_mfma_f32_16x16x32_bf16 v[252:255], a[60:63], v[60:63], v[252:255]
v_exp_f32 v40, v40
v_mfma_f32_16x16x32_bf16 v[220:223], a[60:63], v[56:59], v[220:223]
v_exp_f32 v41, v41
v_mfma_f32_16x16x32_bf16 v[188:191], a[60:63], v[52:55], v[188:191]
ds_read_b128 a[32:35], v1 offset:0
v_cvt_pk_bf16_f32 v74, v40, v41
v_mfma_f32_16x16x32_bf16 v[156:159], a[60:63], v[48:51], v[156:159]
v_smfmac_f32_16x16x64_bf16 a[224:227], a[232:235], v[48:55], v9
v_exp_f32 v42, v42
v_smfmac_f32_16x16x64_bf16 a[228:231], a[232:235], v[56:63], v9
s_waitcnt lgkmcnt(5)
v_exp_f32 v43, v43
v_mfma_f32_16x16x32_bf16 v[16:19], a[0:3], a[160:163], v[80:83]
ds_read_b128 a[36:39], v1 offset:1024
v_cvt_pk_bf16_f32 v75, v42, v43
v_mfma_f32_16x16x32_bf16 v[16:19], a[4:7], a[164:167], v[16:19]
v_exp_f32 v44, v44
v_mfma_f32_16x16x32_bf16 v[16:19], a[8:11], a[168:171], v[16:19]
v_mfma_f32_16x16x32_bf16 v[16:19], a[12:15], a[172:175], v[16:19]
v_exp_f32 v45, v45
v_mfma_f32_16x16x32_bf16 v[20:23], a[0:3], a[176:179], v[84:87]
ds_read_b128 a[40:43], v1 offset:2048
v_cvt_pk_bf16_f32 v78, v44, v45
v_mfma_f32_16x16x32_bf16 v[20:23], a[4:7], a[180:183], v[20:23]
buffer_load_dwordx4 v3, s[48:51], s32 offen offset:2048 sc1 lds
v_mfma_f32_16x16x32_bf16 v[20:23], a[8:11], a[184:187], v[20:23]
v_exp_f32 v46, v46
v_mfma_f32_16x16x32_bf16 v[20:23], a[12:15], a[188:191], v[20:23]
ds_read_b128 a[44:47], v1 offset:3072
v_mfma_f32_16x16x32_bf16 v[24:27], a[0:3], a[192:195], v[88:91]
v_mfma_f32_16x16x32_bf16 v[24:27], a[4:7], a[196:199], v[24:27]
v_exp_f32 v47, v47
v_mfma_f32_16x16x32_bf16 v[24:27], a[8:11], a[200:203], v[24:27]
v_exp_f32 v16, v16
v_mfma_f32_16x16x32_bf16 v[24:27], a[12:15], a[204:207], v[24:27]
ds_read_b128 a[48:51], v1 offset:4096
v_cvt_pk_bf16_f32 v79, v46, v47
v_mfma_f32_16x16x32_bf16 v[28:31], a[0:3], a[208:211], v[92:95]
v_mfma_f32_16x16x32_bf16 v[28:31], a[4:7], a[212:215], v[28:31]
v_exp_f32 v17, v17
v_mfma_f32_16x16x32_bf16 v[28:31], a[8:11], a[216:219], v[28:31]
s_waitcnt lgkmcnt(5)
v_exp_f32 v18, v18
v_mfma_f32_16x16x32_bf16 v[28:31], a[12:15], a[220:223], v[28:31]
ds_read_b128 a[52:55], v1 offset:5120
v_cvt_pk_bf16_f32 v48, v16, v17
v_mfma_f32_16x16x32_bf16 v[32:35], a[16:19], a[160:163], v[80:83]
v_mfma_f32_16x16x32_bf16 v[32:35], a[20:23], a[164:167], v[32:35]
v_exp_f32 v19, v19
v_mfma_f32_16x16x32_bf16 v[32:35], a[24:27], a[168:171], v[32:35]
v_exp_f32 v20, v20
v_mfma_f32_16x16x32_bf16 v[32:35], a[28:31], a[172:175], v[32:35]
ds_read_b128 a[56:59], v1 offset:6144
v_cvt_pk_bf16_f32 v49, v18, v19
v_mfma_f32_16x16x32_bf16 v[36:39], a[16:19], a[176:179], v[84:87]
v_exp_f32 v21, v21
v_mfma_f32_16x16x32_bf16 v[36:39], a[20:23], a[180:183], v[36:39]
buffer_load_dwordx4 v3, s[48:51], s32 offen offset:3072 sc1 lds
v_mfma_f32_16x16x32_bf16 v[36:39], a[24:27], a[184:187], v[36:39]
s_add_u32 s32, s32, 0x8000
v_cvt_pk_bf16_f32 v52, v20, v21
v_mfma_f32_16x16x32_bf16 v[36:39], a[28:31], a[188:191], v[36:39]
ds_read_b128 a[60:63], v1 offset:7168
v_mfma_f32_16x16x32_bf16 v[40:43], a[16:19], a[192:195], v[88:91]
v_exp_f32 v22, v22
v_mfma_f32_16x16x32_bf16 v[40:43], a[20:23], a[196:199], v[40:43]
v_exp_f32 v23, v23
v_mfma_f32_16x16x32_bf16 v[40:43], a[24:27], a[200:203], v[40:43]
v_cvt_pk_bf16_f32 v53, v22, v23
v_mfma_f32_16x16x32_bf16 v[40:43], a[28:31], a[204:207], v[40:43]
v_exp_f32 v24, v24
v_mfma_f32_16x16x32_bf16 v[44:47], a[16:19], a[208:211], v[92:95]
v_exp_f32 v25, v25
v_mfma_f32_16x16x32_bf16 v[44:47], a[20:23], a[212:215], v[44:47]
v_exp_f32 v26, v26
v_mfma_f32_16x16x32_bf16 v[44:47], a[24:27], a[216:219], v[44:47]
v_exp_f32 v27, v27
v_mfma_f32_16x16x32_bf16 v[44:47], a[28:31], a[220:223], v[44:47]
s_waitcnt lgkmcnt(0)
v_mfma_f32_16x16x32_bf16 v[128:131], a[32:35], v[64:67], v[128:131]
ds_read_b128 a[0:3], v1 offset:24576
v_cvt_pk_bf16_f32 v56, v24, v25
v_mfma_f32_16x16x32_bf16 v[160:163], a[32:35], v[68:71], v[160:163]
v_exp_f32 v28, v28
v_mfma_f32_16x16x32_bf16 v[192:195], a[32:35], v[72:75], v[192:195]
v_cvt_pk_bf16_f32 v57, v26, v27
v_mfma_f32_16x16x32_bf16 v[224:227], a[32:35], v[76:79], v[224:227]
ds_read_b128 a[4:7], v1 offset:25600
v_mfma_f32_16x16x32_bf16 v[228:231], a[36:39], v[76:79], v[228:231]
v_exp_f32 v29, v29
v_mfma_f32_16x16x32_bf16 v[196:199], a[36:39], v[72:75], v[196:199]
v_exp_f32 v30, v30
v_mfma_f32_16x16x32_bf16 v[164:167], a[36:39], v[68:71], v[164:167]
s_add_u32 m0, s27, 0x1000
v_cvt_pk_bf16_f32 v60, v28, v29
v_mfma_f32_16x16x32_bf16 v[132:135], a[36:39], v[64:67], v[132:135]
buffer_load_dwordx4 v3, s[48:51], s7 offen offset:0 sc1 lds
v_mfma_f32_16x16x32_bf16 v[136:139], a[40:43], v[64:67], v[136:139]
ds_read_b128 a[8:11], v1 offset:26624
v_mfma_f32_16x16x32_bf16 v[168:171], a[40:43], v[68:71], v[168:171]
v_exp_f32 v31, v31
v_mfma_f32_16x16x32_bf16 v[200:203], a[40:43], v[72:75], v[200:203]
v_exp_f32 v32, v32
v_mfma_f32_16x16x32_bf16 v[232:235], a[40:43], v[76:79], v[232:235]
ds_read_b128 a[12:15], v1 offset:27648
v_cvt_pk_bf16_f32 v61, v30, v31
v_mfma_f32_16x16x32_bf16 v[236:239], a[44:47], v[76:79], v[236:239]
v_mfma_f32_16x16x32_bf16 v[204:207], a[44:47], v[72:75], v[204:207]
v_exp_f32 v33, v33
v_mfma_f32_16x16x32_bf16 v[172:175], a[44:47], v[68:71], v[172:175]
v_exp_f32 v34, v34
v_mfma_f32_16x16x32_bf16 v[140:143], a[44:47], v[64:67], v[140:143]
ds_read_b128 a[16:19], v1 offset:28672
v_cvt_pk_bf16_f32 v50, v32, v33
v_mfma_f32_16x16x32_bf16 v[144:147], a[48:51], v[64:67], v[144:147]
v_mfma_f32_16x16x32_bf16 v[176:179], a[48:51], v[68:71], v[176:179]
v_exp_f32 v35, v35
v_mfma_f32_16x16x32_bf16 v[208:211], a[48:51], v[72:75], v[208:211]
ds_read_b128 a[20:23], v1 offset:29696
v_cvt_pk_bf16_f32 v51, v34, v35
v_mfma_f32_16x16x32_bf16 v[240:243], a[48:51], v[76:79], v[240:243]
v_exp_f32 v36, v36
v_mfma_f32_16x16x32_bf16 v[244:247], a[52:55], v[76:79], v[244:247]
v_exp_f32 v37, v37
v_mfma_f32_16x16x32_bf16 v[212:215], a[52:55], v[72:75], v[212:215]
v_cvt_pk_bf16_f32 v54, v36, v37
v_mfma_f32_16x16x32_bf16 v[180:183], a[52:55], v[68:71], v[180:183]
buffer_load_dwordx4 v3, s[48:51], s7 offen offset:1024 sc1 lds
v_mfma_f32_16x16x32_bf16 v[148:151], a[52:55], v[64:67], v[148:151]
ds_read_b128 a[24:27], v1 offset:30720
v_mfma_f32_16x16x32_bf16 v[152:155], a[56:59], v[64:67], v[152:155]
v_exp_f32 v38, v38
v_mfma_f32_16x16x32_bf16 v[184:187], a[56:59], v[68:71], v[184:187]
v_exp_f32 v39, v39
v_mfma_f32_16x16x32_bf16 v[216:219], a[56:59], v[72:75], v[216:219]
ds_read_b128 a[28:31], v1 offset:31744
v_cvt_pk_bf16_f32 v55, v38, v39
v_mfma_f32_16x16x32_bf16 v[248:251], a[56:59], v[76:79], v[248:251]
v_mfma_f32_16x16x32_bf16 v[252:255], a[60:63], v[76:79], v[252:255]
v_exp_f32 v40, v40
v_mfma_f32_16x16x32_bf16 v[220:223], a[60:63], v[72:75], v[220:223]
v_exp_f32 v41, v41
v_mfma_f32_16x16x32_bf16 v[188:191], a[60:63], v[68:71], v[188:191]
ds_read_b128 a[32:35], v1 offset:16384
v_cvt_pk_bf16_f32 v58, v40, v41
v_mfma_f32_16x16x32_bf16 v[156:159], a[60:63], v[64:67], v[156:159]
v_smfmac_f32_16x16x64_bf16 a[224:227], a[232:235], v[64:71], v9
s_waitcnt lgkmcnt(5)
v_exp_f32 v42, v42
v_smfmac_f32_16x16x64_bf16 a[228:231], a[232:235], v[72:79], v9
ds_read_b128 a[36:39], v1 offset:17408
v_mfma_f32_16x16x32_bf16 v[16:19], a[0:3], a[160:163], v[80:83]
v_exp_f32 v43, v43
v_mfma_f32_16x16x32_bf16 v[16:19], a[4:7], a[164:167], v[16:19]
v_exp_f32 v44, v44
v_mfma_f32_16x16x32_bf16 v[16:19], a[8:11], a[168:171], v[16:19]
v_cvt_pk_bf16_f32 v59, v42, v43
v_mfma_f32_16x16x32_bf16 v[16:19], a[12:15], a[172:175], v[16:19]
ds_read_b128 a[40:43], v1 offset:18432
v_mfma_f32_16x16x32_bf16 v[20:23], a[0:3], a[176:179], v[84:87]
buffer_load_dwordx4 v3, s[48:51], s7 offen offset:2048 sc1 lds
v_mfma_f32_16x16x32_bf16 v[20:23], a[4:7], a[180:183], v[20:23]
v_exp_f32 v45, v45
v_mfma_f32_16x16x32_bf16 v[20:23], a[8:11], a[184:187], v[20:23]
v_exp_f32 v46, v46
v_mfma_f32_16x16x32_bf16 v[20:23], a[12:15], a[188:191], v[20:23]
ds_read_b128 a[44:47], v1 offset:19456
v_cvt_pk_bf16_f32 v62, v44, v45
v_mfma_f32_16x16x32_bf16 v[24:27], a[0:3], a[192:195], v[88:91]
v_mfma_f32_16x16x32_bf16 v[24:27], a[4:7], a[196:199], v[24:27]
v_exp_f32 v47, v47
v_mfma_f32_16x16x32_bf16 v[24:27], a[8:11], a[200:203], v[24:27]
v_exp_f32 v16, v16
v_mfma_f32_16x16x32_bf16 v[24:27], a[12:15], a[204:207], v[24:27]
ds_read_b128 a[48:51], v1 offset:20480
v_cvt_pk_bf16_f32 v63, v46, v47
v_mfma_f32_16x16x32_bf16 v[28:31], a[0:3], a[208:211], v[92:95]
v_mfma_f32_16x16x32_bf16 v[28:31], a[4:7], a[212:215], v[28:31]
v_exp_f32 v17, v17
v_mfma_f32_16x16x32_bf16 v[28:31], a[8:11], a[216:219], v[28:31]
ds_read_b128 a[52:55], v1 offset:21504
v_cvt_pk_bf16_f32 v64, v16, v17
v_mfma_f32_16x16x32_bf16 v[28:31], a[12:15], a[220:223], v[28:31]
s_waitcnt lgkmcnt(6)
v_exp_f32 v18, v18
v_mfma_f32_16x16x32_bf16 v[32:35], a[16:19], a[160:163], v[80:83]
v_mfma_f32_16x16x32_bf16 v[32:35], a[20:23], a[164:167], v[32:35]
v_exp_f32 v19, v19
v_mfma_f32_16x16x32_bf16 v[32:35], a[24:27], a[168:171], v[32:35]
ds_read_b128 a[56:59], v1 offset:22528
v_cvt_pk_bf16_f32 v65, v18, v19
v_mfma_f32_16x16x32_bf16 v[32:35], a[28:31], a[172:175], v[32:35]
buffer_load_dwordx4 v3, s[48:51], s7 offen offset:3072 sc1 lds
v_mfma_f32_16x16x32_bf16 v[36:39], a[16:19], a[176:179], v[84:87]
s_add_u32 s7, s7, 0x8000
v_exp_f32 v20, v20
v_mfma_f32_16x16x32_bf16 v[36:39], a[20:23], a[180:183], v[36:39]
s_xor_b32 s27, s27, 0x38000
v_exp_f32 v21, v21
v_mfma_f32_16x16x32_bf16 v[36:39], a[24:27], a[184:187], v[36:39]
ds_read_b128 a[60:63], v1 offset:23552
v_xor_b32 v1, 0x8000, v1
v_mfma_f32_16x16x32_bf16 v[36:39], a[28:31], a[188:191], v[36:39]
v_cvt_pk_bf16_f32 v68, v20, v21
v_mfma_f32_16x16x32_bf16 v[40:43], a[16:19], a[192:195], v[88:91]
v_exp_f32 v22, v22
v_mfma_f32_16x16x32_bf16 v[40:43], a[20:23], a[196:199], v[40:43]
v_exp_f32 v23, v23
v_mfma_f32_16x16x32_bf16 v[40:43], a[24:27], a[200:203], v[40:43]
v_cvt_pk_bf16_f32 v69, v22, v23
v_mfma_f32_16x16x32_bf16 v[40:43], a[28:31], a[204:207], v[40:43]
v_exp_f32 v24, v24
v_mfma_f32_16x16x32_bf16 v[44:47], a[16:19], a[208:211], v[92:95]
v_exp_f32 v25, v25
v_mfma_f32_16x16x32_bf16 v[44:47], a[20:23], a[212:215], v[44:47]
v_exp_f32 v26, v26
v_mfma_f32_16x16x32_bf16 v[44:47], a[24:27], a[216:219], v[44:47]
s_waitcnt vmcnt(16) lgkmcnt(0)
v_exp_f32 v27, v27
v_mfma_f32_16x16x32_bf16 v[44:47], a[28:31], a[220:223], v[44:47]
s_barrier
L_att_dodd0:
v_mfma_f32_16x16x32_bf16 v[128:131], a[32:35], v[48:51], v[128:131]
ds_read_b128 a[0:3], v2 offset:8192
v_cvt_pk_bf16_f32 v72, v24, v25
v_mfma_f32_16x16x32_bf16 v[160:163], a[32:35], v[52:55], v[160:163]
v_exp_f32 v28, v28
v_mfma_f32_16x16x32_bf16 v[192:195], a[32:35], v[56:59], v[192:195]
v_cvt_pk_bf16_f32 v73, v26, v27
v_mfma_f32_16x16x32_bf16 v[224:227], a[32:35], v[60:63], v[224:227]
ds_read_b128 a[4:7], v2 offset:9216
v_mfma_f32_16x16x32_bf16 v[228:231], a[36:39], v[60:63], v[228:231]
v_exp_f32 v29, v29
v_mfma_f32_16x16x32_bf16 v[196:199], a[36:39], v[56:59], v[196:199]
v_exp_f32 v30, v30
v_mfma_f32_16x16x32_bf16 v[164:167], a[36:39], v[52:55], v[164:167]
s_add_u32 m0, s19, 0x0
v_cvt_pk_bf16_f32 v76, v28, v29
v_mfma_f32_16x16x32_bf16 v[132:135], a[36:39], v[48:51], v[132:135]
buffer_load_dwordx4 v3, s[48:51], s32 offen offset:0 sc1 lds
v_mfma_f32_16x16x32_bf16 v[136:139], a[40:43], v[48:51], v[136:139]
ds_read_b128 a[8:11], v2 offset:10240
v_mfma_f32_16x16x32_bf16 v[168:171], a[40:43], v[52:55], v[168:171]
v_exp_f32 v31, v31
v_mfma_f32_16x16x32_bf16 v[200:203], a[40:43], v[56:59], v[200:203]
v_exp_f32 v32, v32
v_mfma_f32_16x16x32_bf16 v[232:235], a[40:43], v[60:63], v[232:235]
ds_read_b128 a[12:15], v2 offset:11264
v_cvt_pk_bf16_f32 v77, v30, v31
v_mfma_f32_16x16x32_bf16 v[236:239], a[44:47], v[60:63], v[236:239]
v_mfma_f32_16x16x32_bf16 v[204:207], a[44:47], v[56:59], v[204:207]
v_exp_f32 v33, v33
v_mfma_f32_16x16x32_bf16 v[172:175], a[44:47], v[52:55], v[172:175]
v_exp_f32 v34, v34
v_mfma_f32_16x16x32_bf16 v[140:143], a[44:47], v[48:51], v[140:143]
ds_read_b128 a[16:19], v2 offset:12288
v_cvt_pk_bf16_f32 v66, v32, v33
v_mfma_f32_16x16x32_bf16 v[144:147], a[48:51], v[48:51], v[144:147]
v_mfma_f32_16x16x32_bf16 v[176:179], a[48:51], v[52:55], v[176:179]
v_exp_f32 v35, v35
v_mfma_f32_16x16x32_bf16 v[208:211], a[48:51], v[56:59], v[208:211]
v_exp_f32 v36, v36
v_mfma_f32_16x16x32_bf16 v[240:243], a[48:51], v[60:63], v[240:243]
ds_read_b128 a[20:23], v2 offset:13312
v_cvt_pk_bf16_f32 v67, v34, v35
v_mfma_f32_16x16x32_bf16 v[244:247], a[52:55], v[60:63], v[244:247]
v_exp_f32 v37, v37
v_mfma_f32_16x16x32_bf16 v[212:215], a[52:55], v[56:59], v[212:215]
v_cvt_pk_bf16_f32 v70, v36, v37
v_mfma_f32_16x16x32_bf16 v[180:183], a[52:55], v[52:55], v[180:183]
ds_read_b128 a[24:27], v2 offset:14336
v_mfma_f32_16x16x32_bf16 v[148:151], a[52:55], v[48:51], v[148:151]
buffer_load_dwordx4 v3, s[48:51], s32 offen offset:1024 sc1 lds
v_mfma_f32_16x16x32_bf16 v[152:155], a[56:59], v[48:51], v[152:155]
v_exp_f32 v38, v38
v_mfma_f32_16x16x32_bf16 v[184:187], a[56:59], v[52:55], v[184:187]
v_exp_f32 v39, v39
v_mfma_f32_16x16x32_bf16 v[216:219], a[56:59], v[56:59], v[216:219]
ds_read_b128 a[28:31], v2 offset:15360
v_cvt_pk_bf16_f32 v71, v38, v39
v_mfma_f32_16x16x32_bf16 v[248:251], a[56:59], v[60:63], v[248:251]
v_mfma_f32_16x16x32_bf16 v[252:255], a[60:63], v[60:63], v[252:255]
v_exp_f32 v40, v40
v_mfma_f32_16x16x32_bf16 v[220:223], a[60:63], v[56:59], v[220:223]
v_exp_f32 v41, v41
v_mfma_f32_16x16x32_bf16 v[188:191], a[60:63], v[52:55], v[188:191]
ds_read_b128 a[32:35], v2 offset:0
v_cvt_pk_bf16_f32 v74, v40, v41
v_mfma_f32_16x16x32_bf16 v[156:159], a[60:63], v[48:51], v[156:159]
v_smfmac_f32_16x16x64_bf16 a[224:227], a[232:235], v[48:55], v9
v_exp_f32 v42, v42
v_smfmac_f32_16x16x64_bf16 a[228:231], a[232:235], v[56:63], v9
s_waitcnt lgkmcnt(5)
v_exp_f32 v43, v43
v_mfma_f32_16x16x32_bf16 v[16:19], a[0:3], a[160:163], v[80:83]
ds_read_b128 a[36:39], v2 offset:1024
v_cvt_pk_bf16_f32 v75, v42, v43
v_mfma_f32_16x16x32_bf16 v[16:19], a[4:7], a[164:167], v[16:19]
v_exp_f32 v44, v44
v_mfma_f32_16x16x32_bf16 v[16:19], a[8:11], a[168:171], v[16:19]
v_mfma_f32_16x16x32_bf16 v[16:19], a[12:15], a[172:175], v[16:19]
v_exp_f32 v45, v45
v_mfma_f32_16x16x32_bf16 v[20:23], a[0:3], a[176:179], v[84:87]
ds_read_b128 a[40:43], v2 offset:2048
v_cvt_pk_bf16_f32 v78, v44, v45
v_mfma_f32_16x16x32_bf16 v[20:23], a[4:7], a[180:183], v[20:23]
buffer_load_dwordx4 v3, s[48:51], s32 offen offset:2048 sc1 lds
v_mfma_f32_16x16x32_bf16 v[20:23], a[8:11], a[184:187], v[20:23]
v_exp_f32 v46, v46
v_mfma_f32_16x16x32_bf16 v[20:23], a[12:15], a[188:191], v[20:23]
ds_read_b128 a[44:47], v2 offset:3072
v_mfma_f32_16x16x32_bf16 v[24:27], a[0:3], a[192:195], v[88:91]
v_mfma_f32_16x16x32_bf16 v[24:27], a[4:7], a[196:199], v[24:27]
v_exp_f32 v47, v47
v_mfma_f32_16x16x32_bf16 v[24:27], a[8:11], a[200:203], v[24:27]
v_exp_f32 v16, v16
v_mfma_f32_16x16x32_bf16 v[24:27], a[12:15], a[204:207], v[24:27]
ds_read_b128 a[48:51], v2 offset:4096
v_cvt_pk_bf16_f32 v79, v46, v47
v_mfma_f32_16x16x32_bf16 v[28:31], a[0:3], a[208:211], v[92:95]
v_mfma_f32_16x16x32_bf16 v[28:31], a[4:7], a[212:215], v[28:31]
v_exp_f32 v17, v17
v_mfma_f32_16x16x32_bf16 v[28:31], a[8:11], a[216:219], v[28:31]
s_waitcnt lgkmcnt(5)
v_exp_f32 v18, v18
v_mfma_f32_16x16x32_bf16 v[28:31], a[12:15], a[220:223], v[28:31]
ds_read_b128 a[52:55], v2 offset:5120
v_cvt_pk_bf16_f32 v48, v16, v17
v_mfma_f32_16x16x32_bf16 v[32:35], a[16:19], a[160:163], v[80:83]
v_mfma_f32_16x16x32_bf16 v[32:35], a[20:23], a[164:167], v[32:35]
v_exp_f32 v19, v19
v_mfma_f32_16x16x32_bf16 v[32:35], a[24:27], a[168:171], v[32:35]
v_exp_f32 v20, v20
v_mfma_f32_16x16x32_bf16 v[32:35], a[28:31], a[172:175], v[32:35]
ds_read_b128 a[56:59], v2 offset:6144
v_cvt_pk_bf16_f32 v49, v18, v19
v_mfma_f32_16x16x32_bf16 v[36:39], a[16:19], a[176:179], v[84:87]
v_exp_f32 v21, v21
v_mfma_f32_16x16x32_bf16 v[36:39], a[20:23], a[180:183], v[36:39]
buffer_load_dwordx4 v3, s[48:51], s32 offen offset:3072 sc1 lds
v_mfma_f32_16x16x32_bf16 v[36:39], a[24:27], a[184:187], v[36:39]
s_add_u32 s32, s32, 0x8000
v_cvt_pk_bf16_f32 v52, v20, v21
v_mfma_f32_16x16x32_bf16 v[36:39], a[28:31], a[188:191], v[36:39]
ds_read_b128 a[60:63], v2 offset:7168
v_mfma_f32_16x16x32_bf16 v[40:43], a[16:19], a[192:195], v[88:91]
v_exp_f32 v22, v22
v_mfma_f32_16x16x32_bf16 v[40:43], a[20:23], a[196:199], v[40:43]
v_exp_f32 v23, v23
v_mfma_f32_16x16x32_bf16 v[40:43], a[24:27], a[200:203], v[40:43]
v_cvt_pk_bf16_f32 v53, v22, v23
v_mfma_f32_16x16x32_bf16 v[40:43], a[28:31], a[204:207], v[40:43]
v_exp_f32 v24, v24
v_mfma_f32_16x16x32_bf16 v[44:47], a[16:19], a[208:211], v[92:95]
v_exp_f32 v25, v25
v_mfma_f32_16x16x32_bf16 v[44:47], a[20:23], a[212:215], v[44:47]
v_exp_f32 v26, v26
v_mfma_f32_16x16x32_bf16 v[44:47], a[24:27], a[216:219], v[44:47]
v_exp_f32 v27, v27
v_mfma_f32_16x16x32_bf16 v[44:47], a[28:31], a[220:223], v[44:47]
s_waitcnt lgkmcnt(0)
v_mfma_f32_16x16x32_bf16 v[128:131], a[32:35], v[64:67], v[128:131]
ds_read_b128 a[0:3], v2 offset:24576
v_cvt_pk_bf16_f32 v56, v24, v25
v_mfma_f32_16x16x32_bf16 v[160:163], a[32:35], v[68:71], v[160:163]
v_exp_f32 v28, v28
v_mfma_f32_16x16x32_bf16 v[192:195], a[32:35], v[72:75], v[192:195]
v_cvt_pk_bf16_f32 v57, v26, v27
v_mfma_f32_16x16x32_bf16 v[224:227], a[32:35], v[76:79], v[224:227]
ds_read_b128 a[4:7], v2 offset:25600
v_mfma_f32_16x16x32_bf16 v[228:231], a[36:39], v[76:79], v[228:231]
v_exp_f32 v29, v29
v_mfma_f32_16x16x32_bf16 v[196:199], a[36:39], v[72:75], v[196:199]
v_exp_f32 v30, v30
v_mfma_f32_16x16x32_bf16 v[164:167], a[36:39], v[68:71], v[164:167]
s_add_u32 m0, s19, 0x1000
v_cvt_pk_bf16_f32 v60, v28, v29
v_mfma_f32_16x16x32_bf16 v[132:135], a[36:39], v[64:67], v[132:135]
buffer_load_dwordx4 v3, s[48:51], s7 offen offset:0 sc1 lds
v_mfma_f32_16x16x32_bf16 v[136:139], a[40:43], v[64:67], v[136:139]
ds_read_b128 a[8:11], v2 offset:26624
v_mfma_f32_16x16x32_bf16 v[168:171], a[40:43], v[68:71], v[168:171]
v_exp_f32 v31, v31
v_mfma_f32_16x16x32_bf16 v[200:203], a[40:43], v[72:75], v[200:203]
v_exp_f32 v32, v32
v_mfma_f32_16x16x32_bf16 v[232:235], a[40:43], v[76:79], v[232:235]
ds_read_b128 a[12:15], v2 offset:27648
v_cvt_pk_bf16_f32 v61, v30, v31
v_mfma_f32_16x16x32_bf16 v[236:239], a[44:47], v[76:79], v[236:239]
v_mfma_f32_16x16x32_bf16 v[204:207], a[44:47], v[72:75], v[204:207]
v_exp_f32 v33, v33
v_mfma_f32_16x16x32_bf16 v[172:175], a[44:47], v[68:71], v[172:175]
v_exp_f32 v34, v34
v_mfma_f32_16x16x32_bf16 v[140:143], a[44:47], v[64:67], v[140:143]
ds_read_b128 a[16:19], v2 offset:28672
v_cvt_pk_bf16_f32 v50, v32, v33
v_mfma_f32_16x16x32_bf16 v[144:147], a[48:51], v[64:67], v[144:147]
v_exp_f32 v35, v35
v_mfma_f32_16x16x32_bf16 v[176:179], a[48:51], v[68:71], v[176:179]
v_cvt_pk_bf16_f32 v51, v34, v35
v_mfma_f32_16x16x32_bf16 v[208:211], a[48:51], v[72:75], v[208:211]
ds_read_b128 a[20:23], v2 offset:29696
v_mfma_f32_16x16x32_bf16 v[240:243], a[48:51], v[76:79], v[240:243]
v_exp_f32 v36, v36
v_mfma_f32_16x16x32_bf16 v[244:247], a[52:55], v[76:79], v[244:247]
v_exp_f32 v37, v37
v_mfma_f32_16x16x32_bf16 v[212:215], a[52:55], v[72:75], v[212:215]
v_cvt_pk_bf16_f32 v54, v36, v37
v_mfma_f32_16x16x32_bf16 v[180:183], a[52:55], v[68:71], v[180:183]
buffer_load_dwordx4 v3, s[48:51], s7 offen offset:1024 sc1 lds
v_mfma_f32_16x16x32_bf16 v[148:151], a[52:55], v[64:67], v[148:151]
ds_read_b128 a[24:27], v2 offset:30720
v_mfma_f32_16x16x32_bf16 v[152:155], a[56:59], v[64:67], v[152:155]
v_exp_f32 v38, v38
v_mfma_f32_16x16x32_bf16 v[184:187], a[56:59], v[68:71], v[184:187]
v_exp_f32 v39, v39
v_mfma_f32_16x16x32_bf16 v[216:219], a[56:59], v[72:75], v[216:219]
ds_read_b128 a[28:31], v2 offset:31744
v_cvt_pk_bf16_f32 v55, v38, v39
v_mfma_f32_16x16x32_bf16 v[248:251], a[56:59], v[76:79], v[248:251]
v_exp_f32 v40, v40
v_mfma_f32_16x16x32_bf16 v[252:255], a[60:63], v[76:79], v[252:255]
v_mfma_f32_16x16x32_bf16 v[220:223], a[60:63], v[72:75], v[220:223]
v_exp_f32 v41, v41
v_mfma_f32_16x16x32_bf16 v[188:191], a[60:63], v[68:71], v[188:191]
ds_read_b128 a[32:35], v2 offset:16384
v_cvt_pk_bf16_f32 v58, v40, v41
v_mfma_f32_16x16x32_bf16 v[156:159], a[60:63], v[64:67], v[156:159]
v_exp_f32 v42, v42
v_smfmac_f32_16x16x64_bf16 a[224:227], a[232:235], v[64:71], v9
s_waitcnt lgkmcnt(5)
v_smfmac_f32_16x16x64_bf16 a[228:231], a[232:235], v[72:79], v9
ds_read_b128 a[36:39], v2 offset:17408
v_mfma_f32_16x16x32_bf16 v[16:19], a[0:3], a[160:163], v[80:83]
v_exp_f32 v43, v43
v_mfma_f32_16x16x32_bf16 v[16:19], a[4:7], a[164:167], v[16:19]
v_exp_f32 v44, v44
v_mfma_f32_16x16x32_bf16 v[16:19], a[8:11], a[168:171], v[16:19]
buffer_load_dwordx4 v3, s[48:51], s7 offen offset:2048 sc1 lds
v_mfma_f32_16x16x32_bf16 v[16:19], a[12:15], a[172:175], v[16:19]
ds_read_b128 a[40:43], v2 offset:18432
v_cvt_pk_bf16_f32 v59, v42, v43
v_mfma_f32_16x16x32_bf16 v[20:23], a[0:3], a[176:179], v[84:87]
v_exp_f32 v45, v45
v_mfma_f32_16x16x32_bf16 v[20:23], a[4:7], a[180:183], v[20:23]
v_cvt_pk_bf16_f32 v62, v44, v45
v_mfma_f32_16x16x32_bf16 v[20:23], a[8:11], a[184:187], v[20:23]
v_exp_f32 v46, v46
v_mfma_f32_16x16x32_bf16 v[20:23], a[12:15], a[188:191], v[20:23]
ds_read_b128 a[44:47], v2 offset:19456
v_mfma_f32_16x16x32_bf16 v[24:27], a[0:3], a[192:195], v[88:91]
v_exp_f32 v47, v47
v_mfma_f32_16x16x32_bf16 v[24:27], a[4:7], a[196:199], v[24:27]
v_cvt_pk_bf16_f32 v63, v46, v47
v_mfma_f32_16x16x32_bf16 v[24:27], a[8:11], a[200:203], v[24:27]
v_exp_f32 v16, v16
v_mfma_f32_16x16x32_bf16 v[24:27], a[12:15], a[204:207], v[24:27]
ds_read_b128 a[48:51], v2 offset:20480
v_mfma_f32_16x16x32_bf16 v[28:31], a[0:3], a[208:211], v[92:95]
v_exp_f32 v17, v17
v_mfma_f32_16x16x32_bf16 v[28:31], a[4:7], a[212:215], v[28:31]
v_exp_f32 v18, v18
v_mfma_f32_16x16x32_bf16 v[28:31], a[8:11], a[216:219], v[28:31]
ds_read_b128 a[52:55], v2 offset:21504
v_cvt_pk_bf16_f32 v64, v16, v17
v_mfma_f32_16x16x32_bf16 v[28:31], a[12:15], a[220:223], v[28:31]
s_waitcnt lgkmcnt(6)
v_mfma_f32_16x16x32_bf16 v[32:35], a[16:19], a[160:163], v[80:83]
v_exp_f32 v19, v19
v_mfma_f32_16x16x32_bf16 v[32:35], a[20:23], a[164:167], v[32:35]
buffer_load_dwordx4 v3, s[48:51], s7 offen offset:3072 sc1 lds
v_mfma_f32_16x16x32_bf16 v[32:35], a[24:27], a[168:171], v[32:35]
ds_read_b128 a[56:59], v2 offset:22528
v_cvt_pk_bf16_f32 v65, v18, v19
v_mfma_f32_16x16x32_bf16 v[32:35], a[28:31], a[172:175], v[32:35]
s_add_u32 s7, s7, 0x8000
v_exp_f32 v20, v20
v_mfma_f32_16x16x32_bf16 v[36:39], a[16:19], a[176:179], v[84:87]
s_xor_b32 s19, s19, 0x8000
v_mfma_f32_16x16x32_bf16 v[36:39], a[20:23], a[180:183], v[36:39]
s_sub_u32 s15, s15, 1
v_exp_f32 v21, v21
v_mfma_f32_16x16x32_bf16 v[36:39], a[24:27], a[184:187], v[36:39]
ds_read_b128 a[60:63], v2 offset:23552
v_xor_b32 v2, 0x38000, v2
v_mfma_f32_16x16x32_bf16 v[36:39], a[28:31], a[188:191], v[36:39]
s_cmp_lg_u32 s15, 0
v_exp_f32 v22, v22
v_mfma_f32_16x16x32_bf16 v[40:43], a[16:19], a[192:195], v[88:91]
v_exp_f32 v23, v23
v_mfma_f32_16x16x32_bf16 v[40:43], a[20:23], a[196:199], v[40:43]
v_cvt_pk_bf16_f32 v68, v20, v21
v_cvt_pk_bf16_f32 v69, v22, v23
v_mfma_f32_16x16x32_bf16 v[40:43], a[24:27], a[200:203], v[40:43]
v_exp_f32 v24, v24
v_mfma_f32_16x16x32_bf16 v[40:43], a[28:31], a[204:207], v[40:43]
v_exp_f32 v25, v25
v_mfma_f32_16x16x32_bf16 v[44:47], a[16:19], a[208:211], v[92:95]
v_exp_f32 v26, v26
v_mfma_f32_16x16x32_bf16 v[44:47], a[20:23], a[212:215], v[44:47]
v_exp_f32 v27, v27
v_mfma_f32_16x16x32_bf16 v[44:47], a[24:27], a[216:219], v[44:47]
s_waitcnt vmcnt(16) lgkmcnt(0)
v_mfma_f32_16x16x32_bf16 v[44:47], a[28:31], a[220:223], v[44:47]
s_barrier
s_cbranch_scc1 L_att_deven0
s_branch L_att_ddone
L_att_deven1:
v_mfma_f32_16x16x32_bf16 v[128:131], a[32:35], v[48:51], v[128:131]
ds_read_b128 a[0:3], v1 offset:8192
v_cvt_pk_bf16_f32 v72, v24, v25
v_mfma_f32_16x16x32_bf16 v[160:163], a[32:35], v[52:55], v[160:163]
v_exp_f32 v28, v28
v_mfma_f32_16x16x32_bf16 v[192:195], a[32:35], v[56:59], v[192:195]
v_cvt_pk_bf16_f32 v73, v26, v27
v_mfma_f32_16x16x32_bf16 v[224:227], a[32:35], v[60:63], v[224:227]
ds_read_b128 a[4:7], v1 offset:9216
v_mfma_f32_16x16x32_bf16 v[228:231], a[36:39], v[60:63], v[228:231]
v_exp_f32 v29, v29
v_mfma_f32_16x16x32_bf16 v[196:199], a[36:39], v[56:59], v[196:199]
v_exp_f32 v30, v30
v_mfma_f32_16x16x32_bf16 v[164:167], a[36:39], v[52:55], v[164:167]
s_add_u32 m0, s27, 0x0
v_cvt_pk_bf16_f32 v76, v28, v29
v_mfma_f32_16x16x32_bf16 v[132:135], a[36:39], v[48:51], v[132:135]
buffer_load_dwordx4 v3, s[48:51], s32 offen offset:0 sc1 lds
v_mfma_f32_16x16x32_bf16 v[136:139], a[40:43], v[48:51], v[136:139]
ds_read_b128 a[8:11], v1 offset:10240
v_mfma_f32_16x16x32_bf16 v[168:171], a[40:43], v[52:55], v[168:171]
v_exp_f32 v31, v31
v_mfma_f32_16x16x32_bf16 v[200:203], a[40:43], v[56:59], v[200:203]
v_exp_f32 v32, v32
v_mfma_f32_16x16x32_bf16 v[232:235], a[40:43], v[60:63], v[232:235]
ds_read_b128 a[12:15], v1 offset:11264
v_cvt_pk_bf16_f32 v77, v30, v31
v_mfma_f32_16x16x32_bf16 v[236:239], a[44:47], v[60:63], v[236:239]
v_mfma_f32_16x16x32_bf16 v[204:207], a[44:47], v[56:59], v[204:207]
v_exp_f32 v33, v33
v_mfma_f32_16x16x32_bf16 v[172:175], a[44:47], v[52:55], v[172:175]
v_exp_f32 v34, v34
v_mfma_f32_16x16x32_bf16 v[140:143], a[44:47], v[48:51], v[140:143]
ds_read_b128 a[16:19], v1 offset:12288
v_cvt_pk_bf16_f32 v66, v32, v33
v_mfma_f32_16x16x32_bf16 v[144:147], a[48:51], v[48:51], v[144:147]
v_mfma_f32_16x16x32_bf16 v[176:179], a[48:51], v[52:55], v[176:179]
v_exp_f32 v35, v35
v_mfma_f32_16x16x32_bf16 v[208:211], a[48:51], v[56:59], v[208:211]
v_exp_f32 v36, v36
v_mfma_f32_16x16x32_bf16 v[240:243], a[48:51], v[60:63], v[240:243]
ds_read_b128 a[20:23], v1 offset:13312
v_cvt_pk_bf16_f32 v67, v34, v35
v_mfma_f32_16x16x32_bf16 v[244:247], a[52:55], v[60:63], v[244:247]
v_exp_f32 v37, v37
v_mfma_f32_16x16x32_bf16 v[212:215], a[52:55], v[56:59], v[212:215]
v_cvt_pk_bf16_f32 v70, v36, v37
v_mfma_f32_16x16x32_bf16 v[180:183], a[52:55], v[52:55], v[180:183]
ds_read_b128 a[24:27], v1 offset:14336
v_mfma_f32_16x16x32_bf16 v[148:151], a[52:55], v[48:51], v[148:151]
buffer_load_dwordx4 v3, s[48:51], s32 offen offset:1024 sc1 lds
v_mfma_f32_16x16x32_bf16 v[152:155], a[56:59], v[48:51], v[152:155]
v_exp_f32 v38, v38
v_mfma_f32_16x16x32_bf16 v[184:187], a[56:59], v[52:55], v[184:187]
v_exp_f32 v39, v39
v_mfma_f32_16x16x32_bf16 v[216:219], a[56:59], v[56:59], v[216:219]
ds_read_b128 a[28:31], v1 offset:15360
v_cvt_pk_bf16_f32 v71, v38, v39
v_mfma_f32_16x16x32_bf16 v[248:251], a[56:59], v[60:63], v[248:251]
v_mfma_f32_16x16x32_bf16 v[252:255], a[60:63], v[60:63], v[252:255]
v_exp_f32 v40, v40
v_mfma_f32_16x16x32_bf16 v[220:223], a[60:63], v[56:59], v[220:223]
v_exp_f32 v41, v41
v_mfma_f32_16x16x32_bf16 v[188:191], a[60:63], v[52:55], v[188:191]
ds_read_b128 a[32:35], v1 offset:0
v_cvt_pk_bf16_f32 v74, v40, v41
v_mfma_f32_16x16x32_bf16 v[156:159], a[60:63], v[48:51], v[156:159]
v_smfmac_f32_16x16x64_bf16 a[224:227], a[232:235], v[48:55], v9
v_exp_f32 v42, v42
v_smfmac_f32_16x16x64_bf16 a[228:231], a[232:235], v[56:63], v9
s_waitcnt lgkmcnt(5)
v_exp_f32 v43, v43
v_mfma_f32_16x16x32_bf16 v[16:19], a[0:3], a[160:163], v[80:83]
ds_read_b128 a[36:39], v1 offset:1024
v_cvt_pk_bf16_f32 v75, v42, v43
v_mfma_f32_16x16x32_bf16 v[16:19], a[4:7], a[164:167], v[16:19]
v_exp_f32 v44, v44
v_mfma_f32_16x16x32_bf16 v[16:19], a[8:11], a[168:171], v[16:19]
v_mfma_f32_16x16x32_bf16 v[16:19], a[12:15], a[172:175], v[16:19]
v_exp_f32 v45, v45
v_mfma_f32_16x16x32_bf16 v[20:23], a[0:3], a[176:179], v[84:87]
ds_read_b128 a[40:43], v1 offset:2048
v_cvt_pk_bf16_f32 v78, v44, v45
v_mfma_f32_16x16x32_bf16 v[20:23], a[4:7], a[180:183], v[20:23]
buffer_load_dwordx4 v3, s[48:51], s32 offen offset:2048 sc1 lds
v_mfma_f32_16x16x32_bf16 v[20:23], a[8:11], a[184:187], v[20:23]
v_exp_f32 v46, v46
v_mfma_f32_16x16x32_bf16 v[20:23], a[12:15], a[188:191], v[20:23]
ds_read_b128 a[44:47], v1 offset:3072
v_mfma_f32_16x16x32_bf16 v[24:27], a[0:3], a[192:195], v[88:91]
v_mfma_f32_16x16x32_bf16 v[24:27], a[4:7], a[196:199], v[24:27]
v_exp_f32 v47, v47
v_mfma_f32_16x16x32_bf16 v[24:27], a[8:11], a[200:203], v[24:27]
v_exp_f32 v16, v16
v_mfma_f32_16x16x32_bf16 v[24:27], a[12:15], a[204:207], v[24:27]
ds_read_b128 a[48:51], v1 offset:4096
v_cvt_pk_bf16_f32 v79, v46, v47
v_mfma_f32_16x16x32_bf16 v[28:31], a[0:3], a[208:211], v[92:95]
v_mfma_f32_16x16x32_bf16 v[28:31], a[4:7], a[212:215], v[28:31]
v_exp_f32 v17, v17
v_mfma_f32_16x16x32_bf16 v[28:31], a[8:11], a[216:219], v[28:31]
s_waitcnt lgkmcnt(5)
v_exp_f32 v18, v18
v_mfma_f32_16x16x32_bf16 v[28:31], a[12:15], a[220:223], v[28:31]
ds_read_b128 a[52:55], v1 offset:5120
v_cvt_pk_bf16_f32 v48, v16, v17
v_mfma_f32_16x16x32_bf16 v[32:35], a[16:19], a[160:163], v[80:83]
v_mfma_f32_16x16x32_bf16 v[32:35], a[20:23], a[164:167], v[32:35]
v_exp_f32 v19, v19
v_mfma_f32_16x16x32_bf16 v[32:35], a[24:27], a[168:171], v[32:35]
v_exp_f32 v20, v20
v_mfma_f32_16x16x32_bf16 v[32:35], a[28:31], a[172:175], v[32:35]
ds_read_b128 a[56:59], v1 offset:6144
v_cvt_pk_bf16_f32 v49, v18, v19
v_mfma_f32_16x16x32_bf16 v[36:39], a[16:19], a[176:179], v[84:87]
v_exp_f32 v21, v21
v_mfma_f32_16x16x32_bf16 v[36:39], a[20:23], a[180:183], v[36:39]
buffer_load_dwordx4 v3, s[48:51], s32 offen offset:3072 sc1 lds
v_mfma_f32_16x16x32_bf16 v[36:39], a[24:27], a[184:187], v[36:39]
s_add_u32 s32, s32, 0x8000
v_cvt_pk_bf16_f32 v52, v20, v21
v_mfma_f32_16x16x32_bf16 v[36:39], a[28:31], a[188:191], v[36:39]
ds_read_b128 a[60:63], v1 offset:7168
v_mfma_f32_16x16x32_bf16 v[40:43], a[16:19], a[192:195], v[88:91]
v_exp_f32 v22, v22
v_mfma_f32_16x16x32_bf16 v[40:43], a[20:23], a[196:199], v[40:43]
v_exp_f32 v23, v23
v_mfma_f32_16x16x32_bf16 v[40:43], a[24:27], a[200:203], v[40:43]
v_cvt_pk_bf16_f32 v53, v22, v23
v_mfma_f32_16x16x32_bf16 v[40:43], a[28:31], a[204:207], v[40:43]
v_exp_f32 v24, v24
v_mfma_f32_16x16x32_bf16 v[44:47], a[16:19], a[208:211], v[92:95]
v_exp_f32 v25, v25
v_mfma_f32_16x16x32_bf16 v[44:47], a[20:23], a[212:215], v[44:47]
v_exp_f32 v26, v26
v_mfma_f32_16x16x32_bf16 v[44:47], a[24:27], a[216:219], v[44:47]
v_exp_f32 v27, v27
v_mfma_f32_16x16x32_bf16 v[44:47], a[28:31], a[220:223], v[44:47]
s_waitcnt lgkmcnt(0)
v_mfma_f32_16x16x32_bf16 v[128:131], a[32:35], v[64:67], v[128:131]
ds_read_b128 a[0:3], v1 offset:24576
v_cvt_pk_bf16_f32 v56, v24, v25
v_mfma_f32_16x16x32_bf16 v[160:163], a[32:35], v[68:71], v[160:163]
v_exp_f32 v28, v28
v_mfma_f32_16x16x32_bf16 v[192:195], a[32:35], v[72:75], v[192:195]
v_cvt_pk_bf16_f32 v57, v26, v27
v_mfma_f32_16x16x32_bf16 v[224:227], a[32:35], v[76:79], v[224:227]
ds_read_b128 a[4:7], v1 offset:25600
v_mfma_f32_16x16x32_bf16 v[228:231], a[36:39], v[76:79], v[228:231]
v_exp_f32 v29, v29
v_mfma_f32_16x16x32_bf16 v[196:199], a[36:39], v[72:75], v[196:199]
v_exp_f32 v30, v30
v_mfma_f32_16x16x32_bf16 v[164:167], a[36:39], v[68:71], v[164:167]
s_add_u32 m0, s27, 0x1000
v_cvt_pk_bf16_f32 v60, v28, v29
v_mfma_f32_16x16x32_bf16 v[132:135], a[36:39], v[64:67], v[132:135]
buffer_load_dwordx4 v3, s[48:51], s7 offen offset:0 sc1 lds
v_mfma_f32_16x16x32_bf16 v[136:139], a[40:43], v[64:67], v[136:139]
ds_read_b128 a[8:11], v1 offset:26624
v_mfma_f32_16x16x32_bf16 v[168:171], a[40:43], v[68:71], v[168:171]
v_exp_f32 v31, v31
v_mfma_f32_16x16x32_bf16 v[200:203], a[40:43], v[72:75], v[200:203]
v_exp_f32 v32, v32
v_mfma_f32_16x16x32_bf16 v[232:235], a[40:43], v[76:79], v[232:235]
ds_read_b128 a[12:15], v1 offset:27648
v_cvt_pk_bf16_f32 v61, v30, v31
v_mfma_f32_16x16x32_bf16 v[236:239], a[44:47], v[76:79], v[236:239]
v_mfma_f32_16x16x32_bf16 v[204:207], a[44:47], v[72:75], v[204:207]
v_exp_f32 v33, v33
v_mfma_f32_16x16x32_bf16 v[172:175], a[44:47], v[68:71], v[172:175]
v_exp_f32 v34, v34
v_mfma_f32_16x16x32_bf16 v[140:143], a[44:47], v[64:67], v[140:143]
ds_read_b128 a[16:19], v1 offset:28672
v_cvt_pk_bf16_f32 v50, v32, v33
v_mfma_f32_16x16x32_bf16 v[144:147], a[48:51], v[64:67], v[144:147]
v_mfma_f32_16x16x32_bf16 v[176:179], a[48:51], v[68:71], v[176:179]
v_exp_f32 v35, v35
v_mfma_f32_16x16x32_bf16 v[208:211], a[48:51], v[72:75], v[208:211]
ds_read_b128 a[20:23], v1 offset:29696
v_cvt_pk_bf16_f32 v51, v34, v35
v_mfma_f32_16x16x32_bf16 v[240:243], a[48:51], v[76:79], v[240:243]
v_exp_f32 v36, v36
v_mfma_f32_16x16x32_bf16 v[244:247], a[52:55], v[76:79], v[244:247]
v_exp_f32 v37, v37
v_mfma_f32_16x16x32_bf16 v[212:215], a[52:55], v[72:75], v[212:215]
v_cvt_pk_bf16_f32 v54, v36, v37
v_mfma_f32_16x16x32_bf16 v[180:183], a[52:55], v[68:71], v[180:183]
buffer_load_dwordx4 v3, s[48:51], s7 offen offset:1024 sc1 lds
v_mfma_f32_16x16x32_bf16 v[148:151], a[52:55], v[64:67], v[148:151]
ds_read_b128 a[24:27], v1 offset:30720
v_mfma_f32_16x16x32_bf16 v[152:155], a[56:59], v[64:67], v[152:155]
v_exp_f32 v38, v38
v_mfma_f32_16x16x32_bf16 v[184:187], a[56:59], v[68:71], v[184:187]
v_exp_f32 v39, v39
v_mfma_f32_16x16x32_bf16 v[216:219], a[56:59], v[72:75], v[216:219]
ds_read_b128 a[28:31], v1 offset:31744
v_cvt_pk_bf16_f32 v55, v38, v39
v_mfma_f32_16x16x32_bf16 v[248:251], a[56:59], v[76:79], v[248:251]
v_mfma_f32_16x16x32_bf16 v[252:255], a[60:63], v[76:79], v[252:255]
v_exp_f32 v40, v40
v_mfma_f32_16x16x32_bf16 v[220:223], a[60:63], v[72:75], v[220:223]
v_exp_f32 v41, v41
v_mfma_f32_16x16x32_bf16 v[188:191], a[60:63], v[68:71], v[188:191]
ds_read_b128 a[32:35], v1 offset:16384
v_cvt_pk_bf16_f32 v58, v40, v41
v_mfma_f32_16x16x32_bf16 v[156:159], a[60:63], v[64:67], v[156:159]
v_smfmac_f32_16x16x64_bf16 a[224:227], a[232:235], v[64:71], v9
s_waitcnt lgkmcnt(5)
v_exp_f32 v42, v42
v_smfmac_f32_16x16x64_bf16 a[228:231], a[232:235], v[72:79], v9
ds_read_b128 a[36:39], v1 offset:17408
v_mfma_f32_16x16x32_bf16 v[16:19], a[0:3], a[160:163], v[80:83]
v_exp_f32 v43, v43
v_mfma_f32_16x16x32_bf16 v[16:19], a[4:7], a[164:167], v[16:19]
v_exp_f32 v44, v44
v_mfma_f32_16x16x32_bf16 v[16:19], a[8:11], a[168:171], v[16:19]
v_cvt_pk_bf16_f32 v59, v42, v43
v_mfma_f32_16x16x32_bf16 v[16:19], a[12:15], a[172:175], v[16:19]
ds_read_b128 a[40:43], v1 offset:18432
v_mfma_f32_16x16x32_bf16 v[20:23], a[0:3], a[176:179], v[84:87]
buffer_load_dwordx4 v3, s[48:51], s7 offen offset:2048 sc1 lds
v_mfma_f32_16x16x32_bf16 v[20:23], a[4:7], a[180:183], v[20:23]
v_exp_f32 v45, v45
v_mfma_f32_16x16x32_bf16 v[20:23], a[8:11], a[184:187], v[20:23]
v_exp_f32 v46, v46
v_mfma_f32_16x16x32_bf16 v[20:23], a[12:15], a[188:191], v[20:23]
ds_read_b128 a[44:47], v1 offset:19456
v_cvt_pk_bf16_f32 v62, v44, v45
v_mfma_f32_16x16x32_bf16 v[24:27], a[0:3], a[192:195], v[88:91]
v_mfma_f32_16x16x32_bf16 v[24:27], a[4:7], a[196:199], v[24:27]
v_exp_f32 v47, v47
v_mfma_f32_16x16x32_bf16 v[24:27], a[8:11], a[200:203], v[24:27]
v_exp_f32 v16, v16
v_mfma_f32_16x16x32_bf16 v[24:27], a[12:15], a[204:207], v[24:27]
ds_read_b128 a[48:51], v1 offset:20480
v_cvt_pk_bf16_f32 v63, v46, v47
v_mfma_f32_16x16x32_bf16 v[28:31], a[0:3], a[208:211], v[92:95]
v_mfma_f32_16x16x32_bf16 v[28:31], a[4:7], a[212:215], v[28:31]
v_exp_f32 v17, v17
v_mfma_f32_16x16x32_bf16 v[28:31], a[8:11], a[216:219], v[28:31]
ds_read_b128 a[52:55], v1 offset:21504
v_cvt_pk_bf16_f32 v64, v16, v17
v_mfma_f32_16x16x32_bf16 v[28:31], a[12:15], a[220:223], v[28:31]
s_waitcnt lgkmcnt(6)
v_exp_f32 v18, v18
v_mfma_f32_16x16x32_bf16 v[32:35], a[16:19], a[160:163], v[80:83]
v_mfma_f32_16x16x32_bf16 v[32:35], a[20:23], a[164:167], v[32:35]
v_exp_f32 v19, v19
v_mfma_f32_16x16x32_bf16 v[32:35], a[24:27], a[168:171], v[32:35]
ds_read_b128 a[56:59], v1 offset:22528
v_cvt_pk_bf16_f32 v65, v18, v19
v_mfma_f32_16x16x32_bf16 v[32:35], a[28:31], a[172:175], v[32:35]
buffer_load_dwordx4 v3, s[48:51], s7 offen offset:3072 sc1 lds
v_mfma_f32_16x16x32_bf16 v[36:39], a[16:19], a[176:179], v[84:87]
s_add_u32 s7, s7, 0x8000
v_exp_f32 v20, v20
v_mfma_f32_16x16x32_bf16 v[36:39], a[20:23], a[180:183], v[36:39]
s_xor_b32 s27, s27, 0x38000
v_exp_f32 v21, v21
v_mfma_f32_16x16x32_bf16 v[36:39], a[24:27], a[184:187], v[36:39]
ds_read_b128 a[60:63], v1 offset:23552
v_xor_b32 v1, 0x8000, v1
v_mfma_f32_16x16x32_bf16 v[36:39], a[28:31], a[188:191], v[36:39]
v_cvt_pk_bf16_f32 v68, v20, v21
v_mfma_f32_16x16x32_bf16 v[40:43], a[16:19], a[192:195], v[88:91]
v_exp_f32 v22, v22
v_mfma_f32_16x16x32_bf16 v[40:43], a[20:23], a[196:199], v[40:43]
v_exp_f32 v23, v23
v_mfma_f32_16x16x32_bf16 v[40:43], a[24:27], a[200:203], v[40:43]
v_cvt_pk_bf16_f32 v69, v22, v23
v_mfma_f32_16x16x32_bf16 v[40:43], a[28:31], a[204:207], v[40:43]
v_exp_f32 v24, v24
v_mfma_f32_16x16x32_bf16 v[44:47], a[16:19], a[208:211], v[92:95]
s_waitcnt vmcnt(16) lgkmcnt(0)
v_exp_f32 v25, v25
v_mfma_f32_16x16x32_bf16 v[44:47], a[20:23], a[212:215], v[44:47]
s_barrier
v_exp_f32 v26, v26
v_mfma_f32_16x16x32_bf16 v[44:47], a[24:27], a[216:219], v[44:47]
v_exp_f32 v27, v27
v_mfma_f32_16x16x32_bf16 v[44:47], a[28:31], a[220:223], v[44:47]
L_att_dodd1:
v_mfma_f32_16x16x32_bf16 v[128:131], a[32:35], v[48:51], v[128:131]
ds_read_b128 a[0:3], v2 offset:8192
v_cvt_pk_bf16_f32 v72, v24, v25
v_mfma_f32_16x16x32_bf16 v[160:163], a[32:35], v[52:55], v[160:163]
v_exp_f32 v28, v28
v_mfma_f32_16x16x32_bf16 v[192:195], a[32:35], v[56:59], v[192:195]
v_cvt_pk_bf16_f32 v73, v26, v27
v_mfma_f32_16x16x32_bf16 v[224:227], a[32:35], v[60:63], v[224:227]
ds_read_b128 a[4:7], v2 offset:9216
v_mfma_f32_16x16x32_bf16 v[228:231], a[36:39], v[60:63], v[228:231]
v_exp_f32 v29, v29
v_mfma_f32_16x16x32_bf16 v[196:199], a[36:39], v[56:59], v[196:199]
v_exp_f32 v30, v30
v_mfma_f32_16x16x32_bf16 v[164:167], a[36:39], v[52:55], v[164:167]
s_add_u32 m0, s19, 0x0
v_cvt_pk_bf16_f32 v76, v28, v29
v_mfma_f32_16x16x32_bf16 v[132:135], a[36:39], v[48:51], v[132:135]
buffer_load_dwordx4 v3, s[48:51], s32 offen offset:0 sc1 lds
v_mfma_f32_16x16x32_bf16 v[136:139], a[40:43], v[48:51], v[136:139]
ds_read_b128 a[8:11], v2 offset:10240
v_mfma_f32_16x16x32_bf16 v[168:171], a[40:43], v[52:55], v[168:171]
v_exp_f32 v31, v31
v_mfma_f32_16x16x32_bf16 v[200:203], a[40:43], v[56:59], v[200:203]
v_exp_f32 v32, v32
v_mfma_f32_16x16x32_bf16 v[232:235], a[40:43], v[60:63], v[232:235]
ds_read_b128 a[12:15], v2 offset:11264
v_cvt_pk_bf16_f32 v77, v30, v31
v_mfma_f32_16x16x32_bf16 v[236:239], a[44:47], v[60:63], v[236:239]
v_mfma_f32_16x16x32_bf16 v[204:207], a[44:47], v[56:59], v[204:207]
v_exp_f32 v33, v33
v_mfma_f32_16x16x32_bf16 v[172:175], a[44:47], v[52:55], v[172:175]
v_exp_f32 v34, v34
v_mfma_f32_16x16x32_bf16 v[140:143], a[44:47], v[48:51], v[140:143]
ds_read_b128 a[16:19], v2 offset:12288
v_cvt_pk_bf16_f32 v66, v32, v33
v_mfma_f32_16x16x32_bf16 v[144:147], a[48:51], v[48:51], v[144:147]
v_mfma_f32_16x16x32_bf16 v[176:179], a[48:51], v[52:55], v[176:179]
v_exp_f32 v35, v35
v_mfma_f32_16x16x32_bf16 v[208:211], a[48:51], v[56:59], v[208:211]
v_exp_f32 v36, v36
v_mfma_f32_16x16x32_bf16 v[240:243], a[48:51], v[60:63], v[240:243]
ds_read_b128 a[20:23], v2 offset:13312
v_cvt_pk_bf16_f32 v67, v34, v35
v_mfma_f32_16x16x32_bf16 v[244:247], a[52:55], v[60:63], v[244:247]
v_exp_f32 v37, v37
v_mfma_f32_16x16x32_bf16 v[212:215], a[52:55], v[56:59], v[212:215]
v_cvt_pk_bf16_f32 v70, v36, v37
v_mfma_f32_16x16x32_bf16 v[180:183], a[52:55], v[52:55], v[180:183]
ds_read_b128 a[24:27], v2 offset:14336
v_mfma_f32_16x16x32_bf16 v[148:151], a[52:55], v[48:51], v[148:151]
buffer_load_dwordx4 v3, s[48:51], s32 offen offset:1024 sc1 lds
v_mfma_f32_16x16x32_bf16 v[152:155], a[56:59], v[48:51], v[152:155]
v_exp_f32 v38, v38
v_mfma_f32_16x16x32_bf16 v[184:187], a[56:59], v[52:55], v[184:187]
v_exp_f32 v39, v39
v_mfma_f32_16x16x32_bf16 v[216:219], a[56:59], v[56:59], v[216:219]
ds_read_b128 a[28:31], v2 offset:15360
v_cvt_pk_bf16_f32 v71, v38, v39
v_mfma_f32_16x16x32_bf16 v[248:251], a[56:59], v[60:63], v[248:251]
v_mfma_f32_16x16x32_bf16 v[252:255], a[60:63], v[60:63], v[252:255]
v_exp_f32 v40, v40
v_mfma_f32_16x16x32_bf16 v[220:223], a[60:63], v[56:59], v[220:223]
v_exp_f32 v41, v41
v_mfma_f32_16x16x32_bf16 v[188:191], a[60:63], v[52:55], v[188:191]
ds_read_b128 a[32:35], v2 offset:0
v_cvt_pk_bf16_f32 v74, v40, v41
v_mfma_f32_16x16x32_bf16 v[156:159], a[60:63], v[48:51], v[156:159]
v_smfmac_f32_16x16x64_bf16 a[224:227], a[232:235], v[48:55], v9
v_exp_f32 v42, v42
v_smfmac_f32_16x16x64_bf16 a[228:231], a[232:235], v[56:63], v9
s_waitcnt lgkmcnt(5)
v_exp_f32 v43, v43
v_mfma_f32_16x16x32_bf16 v[16:19], a[0:3], a[160:163], v[80:83]
ds_read_b128 a[36:39], v2 offset:1024
v_cvt_pk_bf16_f32 v75, v42, v43
v_mfma_f32_16x16x32_bf16 v[16:19], a[4:7], a[164:167], v[16:19]
v_exp_f32 v44, v44
v_mfma_f32_16x16x32_bf16 v[16:19], a[8:11], a[168:171], v[16:19]
v_mfma_f32_16x16x32_bf16 v[16:19], a[12:15], a[172:175], v[16:19]
v_exp_f32 v45, v45
v_mfma_f32_16x16x32_bf16 v[20:23], a[0:3], a[176:179], v[84:87]
ds_read_b128 a[40:43], v2 offset:2048
v_cvt_pk_bf16_f32 v78, v44, v45
v_mfma_f32_16x16x32_bf16 v[20:23], a[4:7], a[180:183], v[20:23]
buffer_load_dwordx4 v3, s[48:51], s32 offen offset:2048 sc1 lds
v_mfma_f32_16x16x32_bf16 v[20:23], a[8:11], a[184:187], v[20:23]
v_exp_f32 v46, v46
v_mfma_f32_16x16x32_bf16 v[20:23], a[12:15], a[188:191], v[20:23]
ds_read_b128 a[44:47], v2 offset:3072
v_mfma_f32_16x16x32_bf16 v[24:27], a[0:3], a[192:195], v[88:91]
v_mfma_f32_16x16x32_bf16 v[24:27], a[4:7], a[196:199], v[24:27]
v_exp_f32 v47, v47
v_mfma_f32_16x16x32_bf16 v[24:27], a[8:11], a[200:203], v[24:27]
v_exp_f32 v16, v16
v_mfma_f32_16x16x32_bf16 v[24:27], a[12:15], a[204:207], v[24:27]
ds_read_b128 a[48:51], v2 offset:4096
v_cvt_pk_bf16_f32 v79, v46, v47
v_mfma_f32_16x16x32_bf16 v[28:31], a[0:3], a[208:211], v[92:95]
v_mfma_f32_16x16x32_bf16 v[28:31], a[4:7], a[212:215], v[28:31]
v_exp_f32 v17, v17
v_mfma_f32_16x16x32_bf16 v[28:31], a[8:11], a[216:219], v[28:31]
s_waitcnt lgkmcnt(5)
v_exp_f32 v18, v18
v_mfma_f32_16x16x32_bf16 v[28:31], a[12:15], a[220:223], v[28:31]
ds_read_b128 a[52:55], v2 offset:5120
v_cvt_pk_bf16_f32 v48, v16, v17
v_mfma_f32_16x16x32_bf16 v[32:35], a[16:19], a[160:163], v[80:83]
v_mfma_f32_16x16x32_bf16 v[32:35], a[20:23], a[164:167], v[32:35]
v_exp_f32 v19, v19
v_mfma_f32_16x16x32_bf16 v[32:35], a[24:27], a[168:171], v[32:35]
v_exp_f32 v20, v20
v_mfma_f32_16x16x32_bf16 v[32:35], a[28:31], a[172:175], v[32:35]
ds_read_b128 a[56:59], v2 offset:6144
v_cvt_pk_bf16_f32 v49, v18, v19
v_mfma_f32_16x16x32_bf16 v[36:39], a[16:19], a[176:179], v[84:87]
v_exp_f32 v21, v21
v_mfma_f32_16x16x32_bf16 v[36:39], a[20:23], a[180:183], v[36:39]
buffer_load_dwordx4 v3, s[48:51], s32 offen offset:3072 sc1 lds
v_mfma_f32_16x16x32_bf16 v[36:39], a[24:27], a[184:187], v[36:39]
s_add_u32 s32, s32, 0x8000
v_cvt_pk_bf16_f32 v52, v20, v21
v_mfma_f32_16x16x32_bf16 v[36:39], a[28:31], a[188:191], v[36:39]
ds_read_b128 a[60:63], v2 offset:7168
v_mfma_f32_16x16x32_bf16 v[40:43], a[16:19], a[192:195], v[88:91]
v_exp_f32 v22, v22
v_mfma_f32_16x16x32_bf16 v[40:43], a[20:23], a[196:199], v[40:43]
v_exp_f32 v23, v23
v_mfma_f32_16x16x32_bf16 v[40:43], a[24:27], a[200:203], v[40:43]
v_cvt_pk_bf16_f32 v53, v22, v23
v_mfma_f32_16x16x32_bf16 v[40:43], a[28:31], a[204:207], v[40:43]
v_exp_f32 v24, v24
v_mfma_f32_16x16x32_bf16 v[44:47], a[16:19], a[208:211], v[92:95]
v_exp_f32 v25, v25
v_mfma_f32_16x16x32_bf16 v[44:47], a[20:23], a[212:215], v[44:47]
v_exp_f32 v26, v26
v_mfma_f32_16x16x32_bf16 v[44:47], a[24:27], a[216:219], v[44:47]
v_exp_f32 v27, v27
v_mfma_f32_16x16x32_bf16 v[44:47], a[28:31], a[220:223], v[44:47]
s_waitcnt lgkmcnt(0)
v_mfma_f32_16x16x32_bf16 v[128:131], a[32:35], v[64:67], v[128:131]
ds_read_b128 a[0:3], v2 offset:24576
v_cvt_pk_bf16_f32 v56, v24, v25
v_mfma_f32_16x16x32_bf16 v[160:163], a[32:35], v[68:71], v[160:163]
v_exp_f32 v28, v28
v_mfma_f32_16x16x32_bf16 v[192:195], a[32:35], v[72:75], v[192:195]
v_cvt_pk_bf16_f32 v57, v26, v27
v_mfma_f32_16x16x32_bf16 v[224:227], a[32:35], v[76:79], v[224:227]
ds_read_b128 a[4:7], v2 offset:25600
v_mfma_f32_16x16x32_bf16 v[228:231], a[36:39], v[76:79], v[228:231]
v_exp_f32 v29, v29
v_mfma_f32_16x16x32_bf16 v[196:199], a[36:39], v[72:75], v[196:199]
v_exp_f32 v30, v30
v_mfma_f32_16x16x32_bf16 v[164:167], a[36:39], v[68:71], v[164:167]
s_add_u32 m0, s19, 0x1000
v_cvt_pk_bf16_f32 v60, v28, v29
v_mfma_f32_16x16x32_bf16 v[132:135], a[36:39], v[64:67], v[132:135]
buffer_load_dwordx4 v3, s[48:51], s7 offen offset:0 sc1 lds
v_mfma_f32_16x16x32_bf16 v[136:139], a[40:43], v[64:67], v[136:139]
ds_read_b128 a[8:11], v2 offset:26624
v_mfma_f32_16x16x32_bf16 v[168:171], a[40:43], v[68:71], v[168:171]
v_exp_f32 v31, v31
v_mfma_f32_16x16x32_bf16 v[200:203], a[40:43], v[72:75], v[200:203]
v_exp_f32 v32, v32
v_mfma_f32_16x16x32_bf16 v[232:235], a[40:43], v[76:79], v[232:235]
ds_read_b128 a[12:15], v2 offset:27648
v_cvt_pk_bf16_f32 v61, v30, v31
v_mfma_f32_16x16x32_bf16 v[236:239], a[44:47], v[76:79], v[236:239]
v_mfma_f32_16x16x32_bf16 v[204:207], a[44:47], v[72:75], v[204:207]
v_exp_f32 v33, v33
v_mfma_f32_16x16x32_bf16 v[172:175], a[44:47], v[68:71], v[172:175]
v_exp_f32 v34, v34
v_mfma_f32_16x16x32_bf16 v[140:143], a[44:47], v[64:67], v[140:143]
ds_read_b128 a[16:19], v2 offset:28672
v_cvt_pk_bf16_f32 v50, v32, v33
v_mfma_f32_16x16x32_bf16 v[144:147], a[48:51], v[64:67], v[144:147]
v_exp_f32 v35, v35
v_mfma_f32_16x16x32_bf16 v[176:179], a[48:51], v[68:71], v[176:179]
v_cvt_pk_bf16_f32 v51, v34, v35
v_mfma_f32_16x16x32_bf16 v[208:211], a[48:51], v[72:75], v[208:211]
ds_read_b128 a[20:23], v2 offset:29696
v_mfma_f32_16x16x32_bf16 v[240:243], a[48:51], v[76:79], v[240:243]
v_exp_f32 v36, v36
v_mfma_f32_16x16x32_bf16 v[244:247], a[52:55], v[76:79], v[244:247]
v_exp_f32 v37, v37
v_mfma_f32_16x16x32_bf16 v[212:215], a[52:55], v[72:75], v[212:215]
v_cvt_pk_bf16_f32 v54, v36, v37
v_mfma_f32_16x16x32_bf16 v[180:183], a[52:55], v[68:71], v[180:183]
buffer_load_dwordx4 v3, s[48:51], s7 offen offset:1024 sc1 lds
v_mfma_f32_16x16x32_bf16 v[148:151], a[52:55], v[64:67], v[148:151]
ds_read_b128 a[24:27], v2 offset:30720
v_mfma_f32_16x16x32_bf16 v[152:155], a[56:59], v[64:67], v[152:155]
v_exp_f32 v38, v38
v_mfma_f32_16x16x32_bf16 v[184:187], a[56:59], v[68:71], v[184:187]
v_exp_f32 v39, v39
v_mfma_f32_16x16x32_bf16 v[216:219], a[56:59], v[72:75], v[216:219]
ds_read_b128 a[28:31], v2 offset:31744
v_cvt_pk_bf16_f32 v55, v38, v39
v_mfma_f32_16x16x32_bf16 v[248:251], a[56:59], v[76:79], v[248:251]
v_exp_f32 v40, v40
v_mfma_f32_16x16x32_bf16 v[252:255], a[60:63], v[76:79], v[252:255]
v_mfma_f32_16x16x32_bf16 v[220:223], a[60:63], v[72:75], v[220:223]
v_exp_f32 v41, v41
v_mfma_f32_16x16x32_bf16 v[188:191], a[60:63], v[68:71], v[188:191]
ds_read_b128 a[32:35], v2 offset:16384
v_cvt_pk_bf16_f32 v58, v40, v41
v_mfma_f32_16x16x32_bf16 v[156:159], a[60:63], v[64:67], v[156:159]
v_exp_f32 v42, v42
v_smfmac_f32_16x16x64_bf16 a[224:227], a[232:235], v[64:71], v9
s_waitcnt lgkmcnt(5)
v_smfmac_f32_16x16x64_bf16 a[228:231], a[232:235], v[72:79], v9
ds_read_b128 a[36:39], v2 offset:17408
v_mfma_f32_16x16x32_bf16 v[16:19], a[0:3], a[160:163], v[80:83]
v_exp_f32 v43, v43
v_mfma_f32_16x16x32_bf16 v[16:19], a[4:7], a[164:167], v[16:19]
v_exp_f32 v44, v44
v_mfma_f32_16x16x32_bf16 v[16:19], a[8:11], a[168:171], v[16:19]
buffer_load_dwordx4 v3, s[48:51], s7 offen offset:2048 sc1 lds
v_mfma_f32_16x16x32_bf16 v[16:19], a[12:15], a[172:175], v[16:19]
ds_read_b128 a[40:43], v2 offset:18432
v_cvt_pk_bf16_f32 v59, v42, v43
v_mfma_f32_16x16x32_bf16 v[20:23], a[0:3], a[176:179], v[84:87]
v_exp_f32 v45, v45
v_mfma_f32_16x16x32_bf16 v[20:23], a[4:7], a[180:183], v[20:23]
v_cvt_pk_bf16_f32 v62, v44, v45
v_mfma_f32_16x16x32_bf16 v[20:23], a[8:11], a[184:187], v[20:23]
v_exp_f32 v46, v46
v_mfma_f32_16x16x32_bf16 v[20:23], a[12:15], a[188:191], v[20:23]
ds_read_b128 a[44:47], v2 offset:19456
v_mfma_f32_16x16x32_bf16 v[24:27], a[0:3], a[192:195], v[88:91]
v_exp_f32 v47, v47
v_mfma_f32_16x16x32_bf16 v[24:27], a[4:7], a[196:199], v[24:27]
v_cvt_pk_bf16_f32 v63, v46, v47
v_mfma_f32_16x16x32_bf16 v[24:27], a[8:11], a[200:203], v[24:27]
v_exp_f32 v16, v16
v_mfma_f32_16x16x32_bf16 v[24:27], a[12:15], a[204:207], v[24:27]
ds_read_b128 a[48:51], v2 offset:20480
v_mfma_f32_16x16x32_bf16 v[28:31], a[0:3], a[208:211], v[92:95]
v_exp_f32 v17, v17
v_mfma_f32_16x16x32_bf16 v[28:31], a[4:7], a[212:215], v[28:31]
v_exp_f32 v18, v18
v_mfma_f32_16x16x32_bf16 v[28:31], a[8:11], a[216:219], v[28:31]
ds_read_b128 a[52:55], v2 offset:21504
v_cvt_pk_bf16_f32 v64, v16, v17
v_mfma_f32_16x16x32_bf16 v[28:31], a[12:15], a[220:223], v[28:31]
s_waitcnt lgkmcnt(6)
v_mfma_f32_16x16x32_bf16 v[32:35], a[16:19], a[160:163], v[80:83]
v_exp_f32 v19, v19
v_mfma_f32_16x16x32_bf16 v[32:35], a[20:23], a[164:167], v[32:35]
buffer_load_dwordx4 v3, s[48:51], s7 offen offset:3072 sc1 lds
v_mfma_f32_16x16x32_bf16 v[32:35], a[24:27], a[168:171], v[32:35]
ds_read_b128 a[56:59], v2 offset:22528
v_cvt_pk_bf16_f32 v65, v18, v19
v_mfma_f32_16x16x32_bf16 v[32:35], a[28:31], a[172:175], v[32:35]
s_add_u32 s7, s7, 0x8000
v_exp_f32 v20, v20
v_mfma_f32_16x16x32_bf16 v[36:39], a[16:19], a[176:179], v[84:87]
s_xor_b32 s19, s19, 0x8000
v_mfma_f32_16x16x32_bf16 v[36:39], a[20:23], a[180:183], v[36:39]
s_sub_u32 s15, s15, 1
v_exp_f32 v21, v21
v_mfma_f32_16x16x32_bf16 v[36:39], a[24:27], a[184:187], v[36:39]
ds_read_b128 a[60:63], v2 offset:23552
v_xor_b32 v2, 0x38000, v2
v_mfma_f32_16x16x32_bf16 v[36:39], a[28:31], a[188:191], v[36:39]
s_cmp_lg_u32 s15, 0
v_exp_f32 v22, v22
v_mfma_f32_16x16x32_bf16 v[40:43], a[16:19], a[192:195], v[88:91]
v_exp_f32 v23, v23
v_mfma_f32_16x16x32_bf16 v[40:43], a[20:23], a[196:199], v[40:43]
v_cvt_pk_bf16_f32 v68, v20, v21
v_cvt_pk_bf16_f32 v69, v22, v23
v_mfma_f32_16x16x32_bf16 v[40:43], a[24:27], a[200:203], v[40:43]
v_exp_f32 v24, v24
v_mfma_f32_16x16x32_bf16 v[40:43], a[28:31], a[204:207], v[40:43]
v_exp_f32 v25, v25
v_mfma_f32_16x16x32_bf16 v[44:47], a[16:19], a[208:211], v[92:95]
s_waitcnt vmcnt(16) lgkmcnt(0)
v_exp_f32 v26, v26
v_mfma_f32_16x16x32_bf16 v[44:47], a[20:23], a[212:215], v[44:47]
s_barrier
v_exp_f32 v27, v27
v_mfma_f32_16x16x32_bf16 v[44:47], a[24:27], a[216:219], v[44:47]
v_mfma_f32_16x16x32_bf16 v[44:47], a[28:31], a[220:223], v[44:47]
s_cbranch_scc1 L_att_deven1
L_att_ddone:
s_cmp_ge_u32 s4, 2
s_cbranch_scc1 L_att_dl0_1
L_att_dl0_0:
v_mfma_f32_16x16x32_bf16 v[128:131], a[32:35], v[48:51], v[128:131]
ds_read_b128 a[0:3], v1 offset:8192
v_cvt_pk_bf16_f32 v72, v24, v25
v_mfma_f32_16x16x32_bf16 v[160:163], a[32:35], v[52:55], v[160:163]
v_exp_f32 v28, v28
v_mfma_f32_16x16x32_bf16 v[192:195], a[32:35], v[56:59], v[192:195]
v_cvt_pk_bf16_f32 v73, v26, v27
v_mfma_f32_16x16x32_bf16 v[224:227], a[32:35], v[60:63], v[224:227]
ds_read_b128 a[4:7], v1 offset:9216
v_mfma_f32_16x16x32_bf16 v[228:231], a[36:39], v[60:63], v[228:231]
s_add_u32 m0, s27, 0x0
v_exp_f32 v29, v29
v_mfma_f32_16x16x32_bf16 v[196:199], a[36:39], v[56:59], v[196:199]
buffer_load_dwordx4 v3, s[48:51], s32 offen offset:0 sc1 lds
v_mfma_f32_16x16x32_bf16 v[164:167], a[36:39], v[52:55], v[164:167]
v_exp_f32 v30, v30
v_mfma_f32_16x16x32_bf16 v[132:135], a[36:39], v[48:51], v[132:135]
ds_read_b128 a[8:11], v1 offset:10240
v_cvt_pk_bf16_f32 v76, v28, v29
v_mfma_f32_16x16x32_bf16 v[136:139], a[40:43], v[48:51], v[136:139]
v_mfma_f32_16x16x32_bf16 v[168:171], a[40:43], v[52:55], v[168:171]
v_exp_f32 v31, v31
v_mfma_f32_16x16x32_bf16 v[200:203], a[40:43], v[56:59], v[200:203]
v_exp_f32 v32, v32
v_mfma_f32_16x16x32_bf16 v[232:235], a[40:43], v[60:63], v[232:235]
ds_read_b128 a[12:15], v1 offset:11264
v_cvt_pk_bf16_f32 v77, v30, v31
v_mfma_f32_16x16x32_bf16 v[236:239], a[44:47], v[60:63], v[236:239]
v_exp_f32 v33, v33
v_mfma_f32_16x16x32_bf16 v[204:207], a[44:47], v[56:59], v[204:207]
v_cvt_pk_bf16_f32 v66, v32, v33
v_mfma_f32_16x16x32_bf16 v[172:175], a[44:47], v[52:55], v[172:175]
v_exp_f32 v34, v34
v_mfma_f32_16x16x32_bf16 v[140:143], a[44:47], v[48:51], v[140:143]
ds_read_b128 a[16:19], v1 offset:12288
v_mfma_f32_16x16x32_bf16 v[144:147], a[48:51], v[48:51], v[144:147]
buffer_load_dwordx4 v3, s[48:51], s32 offen offset:1024 sc1 lds
v_mfma_f32_16x16x32_bf16 v[176:179], a[48:51], v[52:55], v[176:179]
v_exp_f32 v35, v35
v_mfma_f32_16x16x32_bf16 v[208:211], a[48:51], v[56:59], v[208:211]
v_exp_f32 v36, v36
v_mfma_f32_16x16x32_bf16 v[240:243], a[48:51], v[60:63], v[240:243]
ds_read_b128 a[20:23], v1 offset:13312
v_cvt_pk_bf16_f32 v67, v34, v35
v_mfma_f32_16x16x32_bf16 v[244:247], a[52:55], v[60:63], v[244:247]
v_mfma_f32_16x16x32_bf16 v[212:215], a[52:55], v[56:59], v[212:215]
v_exp_f32 v37, v37
v_mfma_f32_16x16x32_bf16 v[180:183], a[52:55], v[52:55], v[180:183]
ds_read_b128 a[24:27], v1 offset:14336
v_cvt_pk_bf16_f32 v70, v36, v37
v_mfma_f32_16x16x32_bf16 v[148:151], a[52:55], v[48:51], v[148:151]
v_exp_f32 v38, v38
v_mfma_f32_16x16x32_bf16 v[152:155], a[56:59], v[48:51], v[152:155]
v_mfma_f32_16x16x32_bf16 v[184:187], a[56:59], v[52:55], v[184:187]
v_exp_f32 v39, v39
v_mfma_f32_16x16x32_bf16 v[216:219], a[56:59], v[56:59], v[216:219]
buffer_load_dwordx4 v3, s[48:51], s32 offen offset:2048 sc1 lds
v_mfma_f32_16x16x32_bf16 v[248:251], a[56:59], v[60:63], v[248:251]
ds_read_b128 a[28:31], v1 offset:15360
v_cvt_pk_bf16_f32 v71, v38, v39
v_mfma_f32_16x16x32_bf16 v[252:255], a[60:63], v[60:63], v[252:255]
v_exp_f32 v40, v40
v_mfma_f32_16x16x32_bf16 v[220:223], a[60:63], v[56:59], v[220:223]
v_exp_f32 v41, v41
v_mfma_f32_16x16x32_bf16 v[188:191], a[60:63], v[52:55], v[188:191]
ds_read_b128 a[32:35], v1 offset:0
v_cvt_pk_bf16_f32 v74, v40, v41
v_mfma_f32_16x16x32_bf16 v[156:159], a[60:63], v[48:51], v[156:159]
v_smfmac_f32_16x16x64_bf16 a[224:227], a[232:235], v[48:55], v9
v_exp_f32 v42, v42
v_smfmac_f32_16x16x64_bf16 a[228:231], a[232:235], v[56:63], v9
s_waitcnt lgkmcnt(5)
v_exp_f32 v43, v43
v_mfma_f32_16x16x32_bf16 v[16:19], a[0:3], a[160:163], v[96:99]
ds_read_b128 a[36:39], v1 offset:1024
v_cvt_pk_bf16_f32 v75, v42, v43
v_mfma_f32_16x16x32_bf16 v[16:19], a[4:7], a[164:167], v[16:19]
v_exp_f32 v44, v44
v_mfma_f32_16x16x32_bf16 v[16:19], a[8:11], a[168:171], v[16:19]
v_mfma_f32_16x16x32_bf16 v[16:19], a[12:15], a[172:175], v[16:19]
buffer_load_dwordx4 v3, s[48:51], s32 offen offset:3072 sc1 lds
v_mfma_f32_16x16x32_bf16 v[20:23], a[0:3], a[176:179], v[84:87]
ds_read_b128 a[40:43], v1 offset:2048
v_mfma_f32_16x16x32_bf16 v[20:23], a[4:7], a[180:183], v[20:23]
v_exp_f32 v45, v45
v_mfma_f32_16x16x32_bf16 v[20:23], a[8:11], a[184:187], v[20:23]
v_exp_f32 v46, v46
v_mfma_f32_16x16x32_bf16 v[20:23], a[12:15], a[188:191], v[20:23]
ds_read_b128 a[44:47], v1 offset:3072
v_cvt_pk_bf16_f32 v78, v44, v45
v_mfma_f32_16x16x32_bf16 v[24:27], a[0:3], a[192:195], v[88:91]
v_mfma_f32_16x16x32_bf16 v[24:27], a[4:7], a[196:199], v[24:27]
v_exp_f32 v47, v47
v_mfma_f32_16x16x32_bf16 v[24:27], a[8:11], a[200:203], v[24:27]
v_exp_f32 v16, v16
v_mfma_f32_16x16x32_bf16 v[24:27], a[12:15], a[204:207], v[24:27]
ds_read_b128 a[48:51], v1 offset:4096
v_cvt_pk_bf16_f32 v79, v46, v47
v_mfma_f32_16x16x32_bf16 v[28:31], a[0:3], a[208:211], v[92:95]
v_exp_f32 v17, v17
v_mfma_f32_16x16x32_bf16 v[28:31], a[4:7], a[212:215], v[28:31]
s_add_u32 m0, s27, 0x1000
v_cvt_pk_bf16_f32 v48, v16, v17
v_mfma_f32_16x16x32_bf16 v[28:31], a[8:11], a[216:219], v[28:31]
buffer_load_dwordx4 v3, s[48:51], s7 offen offset:0 sc1 lds
v_mfma_f32_16x16x32_bf16 v[28:31], a[12:15], a[220:223], v[28:31]
ds_read_b128 a[52:55], v1 offset:5120
s_waitcnt lgkmcnt(6)
v_mfma_f32_16x16x32_bf16 v[32:35], a[16:19], a[160:163], v[100:103]
v_exp_f32 v18, v18
v_mfma_f32_16x16x32_bf16 v[32:35], a[20:23], a[164:167], v[32:35]
v_exp_f32 v19, v19
v_mfma_f32_16x16x32_bf16 v[32:35], a[24:27], a[168:171], v[32:35]
v_exp_f32 v20, v20
v_mfma_f32_16x16x32_bf16 v[32:35], a[28:31], a[172:175], v[32:35]
ds_read_b128 a[56:59], v1 offset:6144
v_cvt_pk_bf16_f32 v49, v18, v19
v_mfma_f32_16x16x32_bf16 v[36:39], a[16:19], a[176:179], v[84:87]
v_mfma_f32_16x16x32_bf16 v[36:39], a[20:23], a[180:183], v[36:39]
v_exp_f32 v21, v21
v_mfma_f32_16x16x32_bf16 v[36:39], a[24:27], a[184:187], v[36:39]
v_exp_f32 v22, v22
v_mfma_f32_16x16x32_bf16 v[36:39], a[28:31], a[188:191], v[36:39]
ds_read_b128 a[60:63], v1 offset:7168
v_cvt_pk_bf16_f32 v52, v20, v21
v_mfma_f32_16x16x32_bf16 v[40:43], a[16:19], a[192:195], v[88:91]
buffer_load_dwordx4 v3, s[48:51], s7 offen offset:1024 sc1 lds
v_mfma_f32_16x16x32_bf16 v[40:43], a[20:23], a[196:199], v[40:43]
v_mfma_f32_16x16x32_bf16 v[40:43], a[24:27], a[200:203], v[40:43]
v_exp_f32 v23, v23
v_mfma_f32_16x16x32_bf16 v[40:43], a[28:31], a[204:207], v[40:43]
v_exp_f32 v24, v24
v_mfma_f32_16x16x32_bf16 v[44:47], a[16:19], a[208:211], v[92:95]
v_exp_f32 v25, v25
v_mfma_f32_16x16x32_bf16 v[44:47], a[20:23], a[212:215], v[44:47]
v_exp_f32 v26, v26
v_mfma_f32_16x16x32_bf16 v[44:47], a[24:27], a[216:219], v[44:47]
v_exp_f32 v27, v27
v_mfma_f32_16x16x32_bf16 v[44:47], a[28:31], a[220:223], v[44:47]
s_waitcnt lgkmcnt(0)
v_cvt_pk_bf16_f32 v53, v22, v23
v_mfma_f32_16x16x32_bf16 v[128:131], a[32:35], v[64:67], v[128:131]
ds_read_b128 a[0:3], v1 offset:24576
v_cvt_pk_bf16_f32 v56, v24, v25
v_mfma_f32_16x16x32_bf16 v[160:163], a[32:35], v[68:71], v[160:163]
v_exp_f32 v28, v28
v_mfma_f32_16x16x32_bf16 v[192:195], a[32:35], v[72:75], v[192:195]
v_cvt_pk_bf16_f32 v57, v26, v27
v_mfma_f32_16x16x32_bf16 v[224:227], a[32:35], v[76:79], v[224:227]
ds_read_b128 a[4:7], v1 offset:25600
v_mfma_f32_16x16x32_bf16 v[228:231], a[36:39], v[76:79], v[228:231]
v_exp_f32 v29, v29
v_mfma_f32_16x16x32_bf16 v[196:199], a[36:39], v[72:75], v[196:199]
buffer_load_dwordx4 v3, s[48:51], s7 offen offset:2048 sc1 lds
v_mfma_f32_16x16x32_bf16 v[164:167], a[36:39], v[68:71], v[164:167]
ds_read_b128 a[8:11], v1 offset:26624
v_cvt_pk_bf16_f32 v60, v28, v29
v_mfma_f32_16x16x32_bf16 v[132:135], a[36:39], v[64:67], v[132:135]
v_exp_f32 v30, v30
v_mfma_f32_16x16x32_bf16 v[136:139], a[40:43], v[64:67], v[136:139]
v_exp_f32 v31, v31
v_mfma_f32_16x16x32_bf16 v[168:171], a[40:43], v[68:71], v[168:171]
ds_read_b128 a[12:15], v1 offset:27648
v_cvt_pk_bf16_f32 v61, v30, v31
v_mfma_f32_16x16x32_bf16 v[200:203], a[40:43], v[72:75], v[200:203]
v_mfma_f32_16x16x32_bf16 v[232:235], a[40:43], v[76:79], v[232:235]
v_exp_f32 v32, v32
v_mfma_f32_16x16x32_bf16 v[236:239], a[44:47], v[76:79], v[236:239]
v_exp_f32 v33, v33
v_mfma_f32_16x16x32_bf16 v[204:207], a[44:47], v[72:75], v[204:207]
ds_read_b128 a[16:19], v1 offset:28672
v_cvt_pk_bf16_f32 v50, v32, v33
v_mfma_f32_16x16x32_bf16 v[172:175], a[44:47], v[68:71], v[172:175]
v_exp_f32 v34, v34
v_mfma_f32_16x16x32_bf16 v[140:143], a[44:47], v[64:67], v[140:143]
buffer_load_dwordx4 v3, s[48:51], s7 offen offset:3072 sc1 lds
v_mfma_f32_16x16x32_bf16 v[144:147], a[48:51], v[64:67], v[144:147]
ds_read_b128 a[20:23], v1 offset:29696
v_mfma_f32_16x16x32_bf16 v[176:179], a[48:51], v[68:71], v[176:179]
v_mfma_f32_16x16x32_bf16 v[208:211], a[48:51], v[72:75], v[208:211]
v_exp_f32 v35, v35
v_mfma_f32_16x16x32_bf16 v[240:243], a[48:51], v[76:79], v[240:243]
ds_read_b128 a[24:27], v1 offset:30720
v_cvt_pk_bf16_f32 v51, v34, v35
v_mfma_f32_16x16x32_bf16 v[244:247], a[52:55], v[76:79], v[244:247]
v_exp_f32 v36, v36
v_mfma_f32_16x16x32_bf16 v[212:215], a[52:55], v[72:75], v[212:215]
v_exp_f32 v37, v37
v_mfma_f32_16x16x32_bf16 v[180:183], a[52:55], v[68:71], v[180:183]
ds_read_b128 a[28:31], v1 offset:31744
v_cvt_pk_bf16_f32 v54, v36, v37
v_mfma_f32_16x16x32_bf16 v[148:151], a[52:55], v[64:67], v[148:151]
v_mfma_f32_16x16x32_bf16 v[152:155], a[56:59], v[64:67], v[152:155]
v_exp_f32 v38, v38
v_mfma_f32_16x16x32_bf16 v[184:187], a[56:59], v[68:71], v[184:187]
s_mov_b32 s9, 0x0
v_exp_f32 v39, v39
v_mfma_f32_16x16x32_bf16 v[216:219], a[56:59], v[72:75], v[216:219]
buffer_load_dword a244, v8, s[72:75], s9 offen
v_mfma_f32_16x16x32_bf16 v[248:251], a[56:59], v[76:79], v[248:251]
ds_read_b128 a[32:35], v1 offset:16384
v_cvt_pk_bf16_f32 v55, v38, v39
v_mfma_f32_16x16x32_bf16 v[252:255], a[60:63], v[76:79], v[252:255]
v_exp_f32 v40, v40
v_mfma_f32_16x16x32_bf16 v[220:223], a[60:63], v[72:75], v[220:223]
ds_read_b128 a[36:39], v1 offset:17408
v_mfma_f32_16x16x32_bf16 v[188:191], a[60:63], v[68:71], v[188:191]
v_mfma_f32_16x16x32_bf16 v[156:159], a[60:63], v[64:67], v[156:159]
v_exp_f32 v41, v41
v_smfmac_f32_16x16x64_bf16 a[224:227], a[232:235], v[64:71], v9
ds_read_b128 a[40:43], v1 offset:18432
v_cvt_pk_bf16_f32 v58, v40, v41
v_smfmac_f32_16x16x64_bf16 a[228:231], a[232:235], v[72:79], v9
s_waitcnt lgkmcnt(7)
v_exp_f32 v42, v42
v_mfma_f32_16x16x32_bf16 v[20:23], a[0:3], a[176:179], v[84:87]
s_mov_b32 s9, 0x0
v_exp_f32 v43, v43
v_mfma_f32_16x16x32_bf16 v[20:23], a[4:7], a[180:183], v[20:23]
ds_read_b128 a[44:47], v1 offset:19456
v_cvt_pk_bf16_f32 v59, v42, v43
v_mfma_f32_16x16x32_bf16 v[20:23], a[8:11], a[184:187], v[20:23]
buffer_load_dword a244, v8, s[64:67], s9 offen
v_mfma_f32_16x16x32_bf16 v[20:23], a[12:15], a[188:191], v[20:23]
v_mfma_f32_16x16x32_bf16 v[24:27], a[0:3], a[192:195], v[88:91]
v_exp_f32 v44, v44
v_mfma_f32_16x16x32_bf16 v[24:27], a[4:7], a[196:199], v[24:27]
ds_read_b128 a[48:51], v1 offset:20480
v_mfma_f32_16x16x32_bf16 v[24:27], a[8:11], a[200:203], v[24:27]
v_exp_f32 v45, v45
v_mfma_f32_16x16x32_bf16 v[24:27], a[12:15], a[204:207], v[24:27]
v_exp_f32 v46, v46
v_mfma_f32_16x16x32_bf16 v[28:31], a[0:3], a[208:211], v[92:95]
ds_read_b128 a[52:55], v1 offset:21504
v_cvt_pk_bf16_f32 v62, v44, v45
v_mfma_f32_16x16x32_bf16 v[28:31], a[4:7], a[212:215], v[28:31]
s_waitcnt lgkmcnt(6)
v_mfma_f32_16x16x32_bf16 v[28:31], a[8:11], a[216:219], v[28:31]
s_mov_b32 s9, 0x400000
v_exp_f32 v47, v47
v_mfma_f32_16x16x32_bf16 v[28:31], a[12:15], a[220:223], v[28:31]
ds_read_b128 a[56:59], v1 offset:22528
v_cvt_pk_bf16_f32 v63, v46, v47
v_mfma_f32_16x16x32_bf16 v[36:39], a[16:19], a[176:179], v[84:87]
buffer_load_dword a244, v8, s[64:67], s9 offen
v_mfma_f32_16x16x32_bf16 v[36:39], a[20:23], a[180:183], v[36:39]
s_add_u32 s32, s32, 0x8000
v_exp_f32 v20, v20
v_mfma_f32_16x16x32_bf16 v[36:39], a[24:27], a[184:187], v[36:39]
ds_read_b128 a[60:63], v1 offset:23552
v_xor_b32 v1, 0x8000, v1
v_mfma_f32_16x16x32_bf16 v[36:39], a[28:31], a[188:191], v[36:39]
s_add_u32 s7, s7, 0x8000
v_exp_f32 v21, v21
v_mfma_f32_16x16x32_bf16 v[40:43], a[16:19], a[192:195], v[88:91]
s_xor_b32 s27, s27, 0x38000
v_cvt_pk_bf16_f32 v68, v20, v21
v_mfma_f32_16x16x32_bf16 v[40:43], a[20:23], a[196:199], v[40:43]
v_exp_f32 v22, v22
v_mfma_f32_16x16x32_bf16 v[40:43], a[24:27], a[200:203], v[40:43]
v_exp_f32 v23, v23
v_mfma_f32_16x16x32_bf16 v[40:43], a[28:31], a[204:207], v[40:43]
v_exp_f32 v24, v24
v_mfma_f32_16x16x32_bf16 v[44:47], a[16:19], a[208:211], v[92:95]
v_exp_f32 v25, v25
v_mfma_f32_16x16x32_bf16 v[44:47], a[20:23], a[212:215], v[44:47]
v_exp_f32 v26, v26
v_mfma_f32_16x16x32_bf16 v[44:47], a[24:27], a[216:219], v[44:47]
s_waitcnt vmcnt(19) lgkmcnt(0)
v_exp_f32 v27, v27
v_mfma_f32_16x16x32_bf16 v[44:47], a[28:31], a[220:223], v[44:47]
s_barrier
v_cvt_pk_bf16_f32 v69, v22, v23
L_att_l1_0:
v_mfma_f32_16x16x32_bf16 v[128:131], a[32:35], v[48:51], v[128:131]
ds_read_b128 a[0:3], v2 offset:8192
v_cvt_pk_bf16_f32 v72, v24, v25
v_mfma_f32_16x16x32_bf16 v[160:163], a[32:35], v[52:55], v[160:163]
s_lshr_b32 s44, s2, 6
v_exp_f32 v28, v28
v_mfma_f32_16x16x32_bf16 v[192:195], a[32:35], v[56:59], v[192:195]
s_add_u32 m0, s19, 0x0
s_lshl_b32 s45, s44, 1
v_cvt_pk_bf16_f32 v73, v26, v27
v_mfma_f32_16x16x32_bf16 v[224:227], a[32:35], v[60:63], v[224:227]
ds_read_b128 a[4:7], v2 offset:9216
s_add_u32 s45, s45, s100
v_mfma_f32_16x16x32_bf16 v[228:231], a[36:39], v[60:63], v[228:231]
buffer_load_dwordx4 v3, s[48:51], s32 offen offset:0 sc1 lds
v_mfma_f32_16x16x32_bf16 v[196:199], a[36:39], v[56:59], v[196:199]
s_and_b32 s60, s45, 3
v_exp_f32 v29, v29
v_mfma_f32_16x16x32_bf16 v[164:167], a[36:39], v[52:55], v[164:167]
ds_read_b128 a[8:11], v2 offset:10240
v_cvt_pk_bf16_f32 v76, v28, v29
v_mfma_f32_16x16x32_bf16 v[132:135], a[36:39], v[48:51], v[132:135]
s_sub_u32 s60, s60, s44
v_exp_f32 v30, v30
v_mfma_f32_16x16x32_bf16 v[136:139], a[40:43], v[48:51], v[136:139]
s_add_u32 s60, s60, 4
s_lshl_b32 s60, s60, 14
s_and_b32 s60, s60, 0x7c000
v_mfma_f32_16x16x32_bf16 v[168:171], a[40:43], v[52:55], v[168:171]
ds_read_b128 a[12:15], v2 offset:11264
s_lshl_b32 s61, s60, 3
v_mfma_f32_16x16x32_bf16 v[200:203], a[40:43], v[56:59], v[200:203]
s_add_u32 s62, s61, s12
v_exp_f32 v31, v31
v_mfma_f32_16x16x32_bf16 v[232:235], a[40:43], v[60:63], v[232:235]
s_mul_i32 s44, s44, -8
v_exp_f32 v36, v36
v_mfma_f32_16x16x32_bf16 v[236:239], a[44:47], v[60:63], v[236:239]
s_mov_b32 s9, 0x200000
s_lshl_b32 s44, 4, s44
v_cvt_pk_bf16_f32 v77, v30, v31
v_mfma_f32_16x16x32_bf16 v[204:207], a[44:47], v[56:59], v[204:207]
ds_read_b128 a[16:19], v2 offset:12288
s_mul_i32 s45, s45, -8
v_mfma_f32_16x16x32_bf16 v[172:175], a[44:47], v[52:55], v[172:175]
buffer_load_dword a244, v8, s[64:67], s9 offen
v_mfma_f32_16x16x32_bf16 v[140:143], a[44:47], v[48:51], v[140:143]
s_lshl_b32 s45, 4, s45
v_exp_f32 v37, v37
v_mfma_f32_16x16x32_bf16 v[144:147], a[48:51], v[48:51], v[144:147]
ds_read_b128 a[20:23], v2 offset:13312
v_cvt_pk_bf16_f32 v70, v36, v37
v_mfma_f32_16x16x32_bf16 v[176:179], a[48:51], v[52:55], v[176:179]
s_add_u32 s44, s44, 0x21212121
v_exp_f32 v38, v38
v_mfma_f32_16x16x32_bf16 v[208:211], a[48:51], v[56:59], v[208:211]
s_sub_u32 s44, s44, s45
s_bfe_u32 s56, s44, 0x80000
s_lshl_b32 s56, s56, 14
v_mfma_f32_16x16x32_bf16 v[240:243], a[48:51], v[60:63], v[240:243]
ds_read_b128 a[24:27], v2 offset:14336
s_bfe_u32 s57, s44, 0x80008
v_mfma_f32_16x16x32_bf16 v[244:247], a[52:55], v[60:63], v[244:247]
s_lshl_b32 s57, s57, 14
v_exp_f32 v39, v39
v_mfma_f32_16x16x32_bf16 v[212:215], a[52:55], v[56:59], v[212:215]
s_bfe_u32 s58, s44, 0x80010
v_exp_f32 v40, v40
v_mfma_f32_16x16x32_bf16 v[180:183], a[52:55], v[52:55], v[180:183]
s_lshl_b32 s58, s58, 14
s_bfe_u32 s59, s44, 0x80018
v_cvt_pk_bf16_f32 v71, v38, v39
v_mfma_f32_16x16x32_bf16 v[148:151], a[52:55], v[48:51], v[148:151]
buffer_load_dwordx4 v3, s[48:51], s32 offen offset:1024 sc1 lds
v_mfma_f32_16x16x32_bf16 v[152:155], a[56:59], v[48:51], v[152:155]
ds_read_b128 a[28:31], v2 offset:15360
s_lshl_b32 s59, s59, 14
v_mfma_f32_16x16x32_bf16 v[184:187], a[56:59], v[52:55], v[184:187]
v_exp_f32 v41, v41
v_mfma_f32_16x16x32_bf16 v[216:219], a[56:59], v[56:59], v[216:219]
ds_read_b128 a[32:35], v2 offset:0
v_cvt_pk_bf16_f32 v74, v40, v41
v_mfma_f32_16x16x32_bf16 v[248:251], a[56:59], v[60:63], v[248:251]
v_exp_f32 v42, v42
v_mfma_f32_16x16x32_bf16 v[252:255], a[60:63], v[60:63], v[252:255]
v_mfma_f32_16x16x32_bf16 v[220:223], a[60:63], v[56:59], v[220:223]
ds_read_b128 a[36:39], v2 offset:1024
v_mfma_f32_16x16x32_bf16 v[188:191], a[60:63], v[52:55], v[188:191]
v_exp_f32 v43, v43
v_mfma_f32_16x16x32_bf16 v[156:159], a[60:63], v[48:51], v[156:159]
s_waitcnt lgkmcnt(6)
v_exp_f32 v44, v44
v_smfmac_f32_16x16x64_bf16 a[224:227], a[232:235], v[48:55], v9
buffer_load_dwordx4 v3, s[48:51], s32 offen offset:2048 sc1 lds
v_smfmac_f32_16x16x64_bf16 a[228:231], a[232:235], v[56:63], v9
ds_read_b128 a[40:43], v2 offset:2048
v_cvt_pk_bf16_f32 v75, v42, v43
v_mfma_f32_16x16x32_bf16 v[20:23], a[0:3], a[176:179], v[84:87]
v_mfma_f32_16x16x32_bf16 v[20:23], a[4:7], a[180:183], v[20:23]
v_exp_f32 v45, v45
v_mfma_f32_16x16x32_bf16 v[20:23], a[8:11], a[184:187], v[20:23]
ds_read_b128 a[44:47], v2 offset:3072
v_cvt_pk_bf16_f32 v78, v44, v45
v_mfma_f32_16x16x32_bf16 v[20:23], a[12:15], a[188:191], v[20:23]
v_exp_f32 v46, v46
v_mfma_f32_16x16x32_bf16 v[24:27], a[0:3], a[192:195], v[88:91]
v_mfma_f32_16x16x32_bf16 v[24:27], a[4:7], a[196:199], v[24:27]
ds_read_b128 a[48:51], v2 offset:4096
v_mfma_f32_16x16x32_bf16 v[24:27], a[8:11], a[200:203], v[24:27]
v_exp_f32 v47, v47
v_mfma_f32_16x16x32_bf16 v[24:27], a[12:15], a[204:207], v[24:27]
s_nop 0
v_exp_f32 v20, v20
v_mfma_f32_16x16x32_bf16 v[28:31], a[0:3], a[208:211], v[92:95]
buffer_load_dwordx4 v3, s[48:51], s32 offen offset:3072 sc1 lds
v_mfma_f32_16x16x32_bf16 v[28:31], a[4:7], a[212:215], v[28:31]
ds_read_b128 a[52:55], v2 offset:5120
v_cvt_pk_bf16_f32 v79, v46, v47
v_mfma_f32_16x16x32_bf16 v[28:31], a[8:11], a[216:219], v[28:31]
v_mfma_f32_16x16x32_bf16 v[28:31], a[12:15], a[220:223], v[28:31]
s_waitcnt lgkmcnt(6)
v_exp_f32 v21, v21
v_mfma_f32_16x16x32_bf16 v[36:39], a[16:19], a[176:179], v[84:87]
ds_read_b128 a[56:59], v2 offset:6144
v_cvt_pk_bf16_f32 v52, v20, v21
v_mfma_f32_16x16x32_bf16 v[36:39], a[20:23], a[180:183], v[36:39]
v_exp_f32 v22, v22
v_mfma_f32_16x16x32_bf16 v[36:39], a[24:27], a[184:187], v[36:39]
v_mfma_f32_16x16x32_bf16 v[36:39], a[28:31], a[188:191], v[36:39]
ds_read_b128 a[60:63], v2 offset:7168
v_mfma_f32_16x16x32_bf16 v[40:43], a[16:19], a[192:195], v[88:91]
s_mov_b32 s9, 0x600000
v_exp_f32 v23, v23
v_mfma_f32_16x16x32_bf16 v[40:43], a[20:23], a[196:199], v[40:43]
buffer_load_dword a244, v8, s[64:67], s9 offen
v_mfma_f32_16x16x32_bf16 v[40:43], a[24:27], a[200:203], v[40:43]
v_exp_f32 v24, v24
v_mfma_f32_16x16x32_bf16 v[40:43], a[28:31], a[204:207], v[40:43]
v_cvt_pk_bf16_f32 v53, v22, v23
v_mfma_f32_16x16x32_bf16 v[44:47], a[16:19], a[208:211], v[92:95]
v_exp_f32 v25, v25
v_mfma_f32_16x16x32_bf16 v[44:47], a[20:23], a[212:215], v[44:47]
v_exp_f32 v26, v26
v_mfma_f32_16x16x32_bf16 v[44:47], a[24:27], a[216:219], v[44:47]
v_exp_f32 v27, v27
v_mfma_f32_16x16x32_bf16 v[44:47], a[28:31], a[220:223], v[44:47]
s_waitcnt lgkmcnt(0)
v_mfma_f32_16x16x32_bf16 v[160:163], a[32:35], v[68:71], v[160:163]
ds_read_b128 a[0:3], v2 offset:24576
v_cvt_pk_bf16_f32 v56, v24, v25
v_mfma_f32_16x16x32_bf16 v[192:195], a[32:35], v[72:75], v[192:195]
v_exp_f32 v28, v28
v_mfma_f32_16x16x32_bf16 v[224:227], a[32:35], v[76:79], v[224:227]
ds_read_b128 a[4:7], v2 offset:25600
v_cvt_pk_bf16_f32 v57, v26, v27
v_mfma_f32_16x16x32_bf16 v[228:231], a[36:39], v[76:79], v[228:231]
s_add_u32 m0, s19, 0x1000
v_mfma_f32_16x16x32_bf16 v[196:199], a[36:39], v[72:75], v[196:199]
buffer_load_dwordx4 v3, s[48:51], s7 offen offset:0 sc1 lds
v_mfma_f32_16x16x32_bf16 v[164:167], a[36:39], v[68:71], v[164:167]
ds_read_b128 a[8:11], v2 offset:26624
v_mfma_f32_16x16x32_bf16 v[168:171], a[40:43], v[68:71], v[168:171]
v_exp_f32 v29, v29
v_mfma_f32_16x16x32_bf16 v[200:203], a[40:43], v[72:75], v[200:203]
v_exp_f32 v30, v30
v_mfma_f32_16x16x32_bf16 v[232:235], a[40:43], v[76:79], v[232:235]
ds_read_b128 a[12:15], v2 offset:27648
v_cvt_pk_bf16_f32 v60, v28, v29
v_mfma_f32_16x16x32_bf16 v[236:239], a[44:47], v[76:79], v[236:239]
v_exp_f32 v31, v31
v_mfma_f32_16x16x32_bf16 v[204:207], a[44:47], v[72:75], v[204:207]
v_exp_f32 v36, v36
v_mfma_f32_16x16x32_bf16 v[172:175], a[44:47], v[68:71], v[172:175]
ds_read_b128 a[16:19], v2 offset:28672
v_cvt_pk_bf16_f32 v61, v30, v31
v_mfma_f32_16x16x32_bf16 v[176:179], a[48:51], v[68:71], v[176:179]
buffer_load_dwordx4 v3, s[48:51], s7 offen offset:1024 sc1 lds
v_mfma_f32_16x16x32_bf16 v[208:211], a[48:51], v[72:75], v[208:211]
ds_read_b128 a[20:23], v2 offset:29696
v_mfma_f32_16x16x32_bf16 v[240:243], a[48:51], v[76:79], v[240:243]
v_mfma_f32_16x16x32_bf16 v[244:247], a[52:55], v[76:79], v[244:247]
v_exp_f32 v37, v37
v_mfma_f32_16x16x32_bf16 v[212:215], a[52:55], v[72:75], v[212:215]
ds_read_b128 a[24:27], v2 offset:30720
v_cvt_pk_bf16_f32 v54, v36, v37
v_mfma_f32_16x16x32_bf16 v[180:183], a[52:55], v[68:71], v[180:183]
v_exp_f32 v38, v38
v_mfma_f32_16x16x32_bf16 v[184:187], a[56:59], v[68:71], v[184:187]
v_exp_f32 v39, v39
v_mfma_f32_16x16x32_bf16 v[216:219], a[56:59], v[72:75], v[216:219]
ds_read_b128 a[28:31], v2 offset:31744
v_cvt_pk_bf16_f32 v55, v38, v39
v_mfma_f32_16x16x32_bf16 v[248:251], a[56:59], v[76:79], v[248:251]
v_exp_f32 v40, v40
v_mfma_f32_16x16x32_bf16 v[252:255], a[60:63], v[76:79], v[252:255]
buffer_load_dwordx4 v3, s[48:51], s7 offen offset:2048 sc1 lds
v_mfma_f32_16x16x32_bf16 v[220:223], a[60:63], v[72:75], v[220:223]
ds_read_b128 a[32:35], v2 offset:16384
v_mfma_f32_16x16x32_bf16 v[188:191], a[60:63], v[68:71], v[188:191]
v_exp_f32 v41, v41
v_mfma_f32_16x16x32_bf16 a[224:227], a[236:239], v[68:71], a[224:227]
ds_read_b128 a[36:39], v2 offset:17408
v_cvt_pk_bf16_f32 v58, v40, v41
v_smfmac_f32_16x16x64_bf16 a[228:231], a[232:235], v[72:79], v9
s_waitcnt lgkmcnt(6)
v_exp_f32 v42, v42
v_mfma_f32_16x16x32_bf16 v[20:23], a[0:3], a[176:179], v[104:107]
v_exp_f32 v43, v43
v_mfma_f32_16x16x32_bf16 v[20:23], a[4:7], a[180:183], v[20:23]
ds_read_b128 a[40:43], v2 offset:18432
v_cvt_pk_bf16_f32 v59, v42, v43
v_mfma_f32_16x16x32_bf16 v[20:23], a[8:11], a[184:187], v[20:23]
v_exp_f32 v44, v44
v_mfma_f32_16x16x32_bf16 v[20:23], a[12:15], a[188:191], v[20:23]
buffer_load_dwordx4 v3, s[48:51], s7 offen offset:3072 sc1 lds
v_mfma_f32_16x16x32_bf16 v[24:27], a[0:3], a[192:195], v[88:91]
ds_read_b128 a[44:47], v2 offset:19456
v_mfma_f32_16x16x32_bf16 v[24:27], a[4:7], a[196:199], v[24:27]
v_exp_f32 v45, v45
v_mfma_f32_16x16x32_bf16 v[24:27], a[8:11], a[200:203], v[24:27]
v_exp_f32 v46, v46
v_mfma_f32_16x16x32_bf16 v[24:27], a[12:15], a[204:207], v[24:27]
ds_read_b128 a[48:51], v2 offset:20480
v_add_u32 v4, s0, v3
v_mfma_f32_16x16x32_bf16 v[28:31], a[0:3], a[208:211], v[92:95]
v_cvt_pk_bf16_f32 v62, v44, v45
v_mfma_f32_16x16x32_bf16 v[28:31], a[4:7], a[212:215], v[28:31]
ds_read_b128 a[52:55], v2 offset:21504
v_mov_b32 v5, s1
v_mfma_f32_16x16x32_bf16 v[28:31], a[8:11], a[216:219], v[28:31]
s_waitcnt lgkmcnt(6)
v_exp_f32 v47, v47
v_mfma_f32_16x16x32_bf16 v[28:31], a[12:15], a[220:223], v[28:31]
global_load_dword a244, v[4:5], off sc1
v_mfma_f32_16x16x32_bf16 v[36:39], a[16:19], a[176:179], v[108:111]
ds_read_b128 a[56:59], v2 offset:22528
v_cvt_pk_bf16_f32 v63, v46, v47
v_mfma_f32_16x16x32_bf16 v[36:39], a[20:23], a[180:183], v[36:39]
s_add_u32 s32, s32, 0x8000
v_exp_f32 v20, v20
v_mfma_f32_16x16x32_bf16 v[36:39], a[24:27], a[184:187], v[36:39]
s_add_u32 s7, s7, 0x8000
v_exp_f32 v21, v21
v_mfma_f32_16x16x32_bf16 v[36:39], a[28:31], a[188:191], v[36:39]
ds_read_b128 a[60:63], v2 offset:23552
v_xor_b32 v2, 0x38000, v2
v_mfma_f32_16x16x32_bf16 v[40:43], a[16:19], a[192:195], v[88:91]
s_xor_b32 s19, s19, 0x8000
v_exp_f32 v22, v22
v_mfma_f32_16x16x32_bf16 v[40:43], a[20:23], a[196:199], v[40:43]
s_sub_u32 s15, 7, s6
v_exp_f32 v23, v23
v_mfma_f32_16x16x32_bf16 v[40:43], a[24:27], a[200:203], v[40:43]
s_lshl_b32 s15, s15, 1
v_exp_f32 v24, v24
v_mfma_f32_16x16x32_bf16 v[40:43], a[28:31], a[204:207], v[40:43]
v_exp_f32 v25, v25
v_mfma_f32_16x16x32_bf16 v[44:47], a[16:19], a[208:211], v[92:95]
v_exp_f32 v26, v26
v_mfma_f32_16x16x32_bf16 v[44:47], a[20:23], a[212:215], v[44:47]
v_exp_f32 v27, v27
v_mfma_f32_16x16x32_bf16 v[44:47], a[24:27], a[216:219], v[44:47]
s_waitcnt vmcnt(22) lgkmcnt(0)
v_cvt_pk_bf16_f32 v68, v20, v21
v_cvt_pk_bf16_f32 v69, v22, v23
v_mfma_f32_16x16x32_bf16 v[44:47], a[28:31], a[220:223], v[44:47]
s_barrier
s_cbranch_scc0 L_att_lh0_0
v_mfma_f32_16x16x32_bf16 v[160:163], a[32:35], v[52:55], v[160:163]
ds_read_b128 a[0:3], v1 offset:8192
v_cvt_pk_bf16_f32 v72, v24, v25
v_mfma_f32_16x16x32_bf16 v[192:195], a[32:35], v[56:59], v[192:195]
v_exp_f32 v28, v28
v_mfma_f32_16x16x32_bf16 v[224:227], a[32:35], v[60:63], v[224:227]
ds_read_b128 a[4:7], v1 offset:9216
v_cvt_pk_bf16_f32 v73, v26, v27
v_mfma_f32_16x16x32_bf16 v[228:231], a[36:39], v[60:63], v[228:231]
s_add_u32 m0, s27, 0x0
v_exp_f32 v29, v29
v_mfma_f32_16x16x32_bf16 v[196:199], a[36:39], v[56:59], v[196:199]
buffer_load_dwordx4 v3, s[48:51], s32 offen offset:0 sc1 lds
v_mfma_f32_16x16x32_bf16 v[164:167], a[36:39], v[52:55], v[164:167]
ds_read_b128 a[8:11], v1 offset:10240
v_cvt_pk_bf16_f32 v76, v28, v29
v_mfma_f32_16x16x32_bf16 v[168:171], a[40:43], v[52:55], v[168:171]
ds_read_b128 a[12:15], v1 offset:11264
v_accvgpr_read_b32 v6, a224
v_mfma_f32_16x16x32_bf16 v[200:203], a[40:43], v[56:59], v[200:203]
v_exp_f32 v30, v30
v_mfma_f32_16x16x32_bf16 v[232:235], a[40:43], v[60:63], v[232:235]
v_exp_f32 v31, v31
v_mfma_f32_16x16x32_bf16 v[236:239], a[44:47], v[60:63], v[236:239]
ds_read_b128 a[16:19], v1 offset:12288
v_cvt_pk_bf16_f32 v77, v30, v31
v_mfma_f32_16x16x32_bf16 v[204:207], a[44:47], v[56:59], v[204:207]
v_exp_f32 v36, v36
v_mfma_f32_16x16x32_bf16 v[172:175], a[44:47], v[52:55], v[172:175]
ds_read_b128 a[20:23], v1 offset:13312
v_accvgpr_read_b32 v7, a225
v_mfma_f32_16x16x32_bf16 v[176:179], a[48:51], v[52:55], v[176:179]
v_exp_f32 v37, v37
v_mfma_f32_16x16x32_bf16 v[208:211], a[48:51], v[56:59], v[208:211]
ds_read_b128 a[24:27], v1 offset:14336
v_cvt_pk_bf16_f32 v70, v36, v37
v_mfma_f32_16x16x32_bf16 v[240:243], a[48:51], v[60:63], v[240:243]
buffer_load_dwordx4 v3, s[48:51], s32 offen offset:1024 sc1 lds
v_mfma_f32_16x16x32_bf16 v[244:247], a[52:55], v[60:63], v[244:247]
v_exp_f32 v38, v38
v_mfma_f32_16x16x32_bf16 v[212:215], a[52:55], v[56:59], v[212:215]
ds_read_b128 a[28:31], v1 offset:15360
v_add_f32 v6, v6, v7
v_mfma_f32_16x16x32_bf16 v[180:183], a[52:55], v[52:55], v[180:183]
v_exp_f32 v39, v39
v_mfma_f32_16x16x32_bf16 v[184:187], a[56:59], v[52:55], v[184:187]
ds_read_b128 a[32:35], v1 offset:0
v_cvt_pk_bf16_f32 v71, v38, v39
v_mfma_f32_16x16x32_bf16 v[216:219], a[56:59], v[56:59], v[216:219]
v_exp_f32 v40, v40
v_mfma_f32_16x16x32_bf16 v[248:251], a[56:59], v[60:63], v[248:251]
ds_read_b128 a[36:39], v1 offset:1024
v_cmp_nge_f32 vcc, 0x6f800000, v6
v_mfma_f32_16x16x32_bf16 v[252:255], a[60:63], v[60:63], v[252:255]
v_exp_f32 v41, v41
v_mfma_f32_16x16x32_bf16 v[220:223], a[60:63], v[56:59], v[220:223]
v_exp_f32 v42, v42
v_mfma_f32_16x16x32_bf16 v[188:191], a[60:63], v[52:55], v[188:191]
ds_read_b128 a[40:43], v1 offset:2048
v_cvt_pk_bf16_f32 v74, v40, v41
v_mfma_f32_16x16x32_bf16 a[224:227], a[236:239], v[52:55], a[224:227]
buffer_load_dwordx4 v3, s[48:51], s32 offen offset:2048 sc1 lds
v_smfmac_f32_16x16x64_bf16 a[228:231], a[232:235], v[56:63], v9
ds_read_b128 a[44:47], v1 offset:3072
s_waitcnt lgkmcnt(8)
v_mfma_f32_16x16x32_bf16 v[24:27], a[0:3], a[192:195], v[88:91]
v_exp_f32 v43, v43
v_mfma_f32_16x16x32_bf16 v[24:27], a[4:7], a[196:199], v[24:27]
ds_read_b128 a[48:51], v1 offset:4096
v_cvt_pk_bf16_f32 v75, v42, v43
v_mfma_f32_16x16x32_bf16 v[24:27], a[8:11], a[200:203], v[24:27]
v_exp_f32 v44, v44
v_mfma_f32_16x16x32_bf16 v[24:27], a[12:15], a[204:207], v[24:27]
v_exp_f32 v45, v45
v_mfma_f32_16x16x32_bf16 v[28:31], a[0:3], a[208:211], v[92:95]
ds_read_b128 a[52:55], v1 offset:5120
v_cvt_pk_bf16_f32 v78, v44, v45
v_mfma_f32_16x16x32_bf16 v[28:31], a[4:7], a[212:215], v[28:31]
v_exp_f32 v46, v46
v_mfma_f32_16x16x32_bf16 v[28:31], a[8:11], a[216:219], v[28:31]
ds_read_b128 a[56:59], v1 offset:6144
v_mfma_f32_16x16x32_bf16 v[28:31], a[12:15], a[220:223], v[28:31]
s_waitcnt lgkmcnt(7)
v_exp_f32 v47, v47
v_mfma_f32_16x16x32_bf16 v[40:43], a[16:19], a[192:195], v[88:91]
buffer_load_dwordx4 v3, s[48:51], s32 offen offset:3072 sc1 lds
v_mfma_f32_16x16x32_bf16 v[40:43], a[20:23], a[196:199], v[40:43]
ds_read_b128 a[60:63], v1 offset:7168
v_cvt_pk_bf16_f32 v79, v46, v47
v_mfma_f32_16x16x32_bf16 v[40:43], a[24:27], a[200:203], v[40:43]
s_add_u32 s32, s32, 0x8000
v_exp_f32 v24, v24
v_mfma_f32_16x16x32_bf16 v[40:43], a[28:31], a[204:207], v[40:43]
v_exp_f32 v25, v25
v_mfma_f32_16x16x32_bf16 v[44:47], a[16:19], a[208:211], v[92:95]
v_exp_f32 v26, v26
v_mfma_f32_16x16x32_bf16 v[44:47], a[20:23], a[212:215], v[44:47]
v_exp_f32 v27, v27
v_mfma_f32_16x16x32_bf16 v[44:47], a[24:27], a[216:219], v[44:47]
v_exp_f32 v28, v28
v_mfma_f32_16x16x32_bf16 v[44:47], a[28:31], a[220:223], v[44:47]
s_waitcnt lgkmcnt(0)
v_exp_f32 v29, v29
v_mfma_f32_16x16x32_bf16 v[160:163], a[32:35], v[68:71], v[160:163]
ds_read_b128 a[0:3], v1 offset:24576
v_cvt_pk_bf16_f32 v56, v24, v25
v_mfma_f32_16x16x32_bf16 v[192:195], a[32:35], v[72:75], v[192:195]
v_exp_f32 v30, v30
v_mfma_f32_16x16x32_bf16 v[224:227], a[32:35], v[76:79], v[224:227]
ds_read_b128 a[4:7], v1 offset:25600
v_cvt_pk_bf16_f32 v57, v26, v27
v_mfma_f32_16x16x32_bf16 v[228:231], a[36:39], v[76:79], v[228:231]
s_add_u32 m0, s27, 0x1000
v_cvt_pk_bf16_f32 v60, v28, v29
v_mfma_f32_16x16x32_bf16 v[196:199], a[36:39], v[72:75], v[196:199]
buffer_load_dwordx4 v3, s[48:51], s7 offen offset:0 sc1 lds
v_mfma_f32_16x16x32_bf16 v[164:167], a[36:39], v[68:71], v[164:167]
ds_read_b128 a[8:11], v1 offset:26624
v_mfma_f32_16x16x32_bf16 v[168:171], a[40:43], v[68:71], v[168:171]
ds_read_b128 a[12:15], v1 offset:27648
v_mfma_f32_16x16x32_bf16 v[200:203], a[40:43], v[72:75], v[200:203]
v_exp_f32 v31, v31
v_mfma_f32_16x16x32_bf16 v[232:235], a[40:43], v[76:79], v[232:235]
v_exp_f32 v40, v40
v_mfma_f32_16x16x32_bf16 v[236:239], a[44:47], v[76:79], v[236:239]
ds_read_b128 a[16:19], v1 offset:28672
v_cvt_pk_bf16_f32 v61, v30, v31
v_mfma_f32_16x16x32_bf16 v[204:207], a[44:47], v[72:75], v[204:207]
v_exp_f32 v41, v41
v_mfma_f32_16x16x32_bf16 v[172:175], a[44:47], v[68:71], v[172:175]
ds_read_b128 a[20:23], v1 offset:29696
v_cvt_pk_bf16_f32 v58, v40, v41
v_mfma_f32_16x16x32_bf16 v[176:179], a[48:51], v[68:71], v[176:179]
v_rcp_f32 v6, v6
v_mfma_f32_16x16x32_bf16 v[208:211], a[48:51], v[72:75], v[208:211]
buffer_load_dwordx4 v3, s[48:51], s7 offen offset:1024 sc1 lds
v_mfma_f32_16x16x32_bf16 v[240:243], a[48:51], v[76:79], v[240:243]
ds_read_b128 a[24:27], v1 offset:30720
s_or_b64 s[34:35], s[34:35], vcc
v_mfma_f32_16x16x32_bf16 v[244:247], a[52:55], v[76:79], v[244:247]
ds_read_b128 a[28:31], v1 offset:31744
s_add_u32 s8, s28, 0x0
v_mfma_f32_16x16x32_bf16 v[212:215], a[52:55], v[72:75], v[212:215]
v_exp_f32 v42, v42
v_mfma_f32_16x16x32_bf16 v[180:183], a[52:55], v[68:71], v[180:183]
v_exp_f32 v43, v43
v_mfma_f32_16x16x32_bf16 v[184:187], a[56:59], v[68:71], v[184:187]
ds_read_b128 a[32:35], v1 offset:16384
v_cvt_pk_bf16_f32 v59, v42, v43
v_mfma_f32_16x16x32_bf16 v[216:219], a[56:59], v[72:75], v[216:219]
v_exp_f32 v44, v44
v_mfma_f32_16x16x32_bf16 v[248:251], a[56:59], v[76:79], v[248:251]
ds_read_b128 a[36:39], v1 offset:17408
v_mul_f32 v128, v6, v128
v_mfma_f32_16x16x32_bf16 v[252:255], a[60:63], v[76:79], v[252:255]
v_mul_f32 v129, v6, v129
v_mul_f32 v130, v6, v130
v_mfma_f32_16x16x32_bf16 v[220:223], a[60:63], v[72:75], v[220:223]
ds_read_b128 a[40:43], v1 offset:18432
v_mul_f32 v131, v6, v131
v_mfma_f32_16x16x32_bf16 v[188:191], a[60:63], v[68:71], v[188:191]
buffer_load_dwordx4 v3, s[48:51], s7 offen offset:2048 sc1 lds
v_mfma_f32_16x16x32_bf16 a[224:227], a[236:239], v[68:71], a[224:227]
ds_read_b128 a[44:47], v1 offset:19456
v_mul_f32 v132, v6, v132
v_smfmac_f32_16x16x64_bf16 a[228:231], a[232:235], v[72:79], v9
s_waitcnt lgkmcnt(8)
v_exp_f32 v45, v45
v_mfma_f32_16x16x32_bf16 v[24:27], a[0:3], a[192:195], v[88:91]
v_exp_f32 v46, v46
v_mfma_f32_16x16x32_bf16 v[24:27], a[4:7], a[196:199], v[24:27]
ds_read_b128 a[48:51], v1 offset:20480
v_cvt_pk_bf16_f32 v62, v44, v45
v_mfma_f32_16x16x32_bf16 v[24:27], a[8:11], a[200:203], v[24:27]
v_exp_f32 v47, v47
v_mfma_f32_16x16x32_bf16 v[24:27], a[12:15], a[204:207], v[24:27]
ds_read_b128 a[52:55], v1 offset:21504
v_cvt_pk_bf16_f32 v63, v46, v47
v_mfma_f32_16x16x32_bf16 v[28:31], a[0:3], a[208:211], v[92:95]
v_mul_f32 v133, v6, v133
v_mul_f32 v134, v6, v134
v_mfma_f32_16x16x32_bf16 v[28:31], a[4:7], a[212:215], v[28:31]
ds_read_b128 a[56:59], v1 offset:22528
v_mul_f32 v135, v6, v135
v_mfma_f32_16x16x32_bf16 v[28:31], a[8:11], a[216:219], v[28:31]
buffer_load_dwordx4 v3, s[48:51], s7 offen offset:3072 sc1 lds
v_mfma_f32_16x16x32_bf16 v[28:31], a[12:15], a[220:223], v[28:31]
ds_read_b128 a[60:63], v1 offset:23552
s_waitcnt lgkmcnt(8)
v_mfma_f32_16x16x32_bf16 v[40:43], a[16:19], a[192:195], v[88:91]
s_add_u32 s7, s7, 0x8000
v_xor_b32 v1, 0x8000, v1
v_cvt_pk_bf16_f32 v128, v128, v129
v_mfma_f32_16x16x32_bf16 v[40:43], a[20:23], a[196:199], v[40:43]
s_xor_b32 s27, s27, 0x38000
v_exp_f32 v24, v24
v_mfma_f32_16x16x32_bf16 v[40:43], a[24:27], a[200:203], v[40:43]
v_exp_f32 v25, v25
v_mfma_f32_16x16x32_bf16 v[40:43], a[28:31], a[204:207], v[40:43]
v_exp_f32 v26, v26
v_mfma_f32_16x16x32_bf16 v[44:47], a[16:19], a[208:211], v[92:95]
v_exp_f32 v27, v27
v_mfma_f32_16x16x32_bf16 v[44:47], a[20:23], a[212:215], v[44:47]
v_exp_f32 v28, v28
v_mfma_f32_16x16x32_bf16 v[44:47], a[24:27], a[216:219], v[44:47]
s_waitcnt vmcnt(19) lgkmcnt(0)
v_exp_f32 v29, v29
v_mfma_f32_16x16x32_bf16 v[44:47], a[28:31], a[220:223], v[44:47]
s_barrier
v_cvt_pk_bf16_f32 v129, v130, v131
v_cvt_pk_bf16_f32 v130, v132, v133
v_cvt_pk_bf16_f32 v131, v134, v135
buffer_store_dwordx4 v[128:131], v3, s[88:91], s8 offen sc1
s_add_u32 s8, s28, 0x2000
v_mul_f32 v136, v6, v136
v_mul_f32 v137, v6, v137
v_mul_f32 v138, v6, v138
v_mul_f32 v139, v6, v139
v_mul_f32 v140, v6, v140
v_mul_f32 v141, v6, v141
v_mul_f32 v142, v6, v142
v_mul_f32 v143, v6, v143
v_cvt_pk_bf16_f32 v136, v136, v137
v_cvt_pk_bf16_f32 v137, v138, v139
v_cvt_pk_bf16_f32 v138, v140, v141
v_cvt_pk_bf16_f32 v139, v142, v143
buffer_store_dwordx4 v[136:139], v3, s[88:91], s8 offen sc1
s_add_u32 s8, s28, 0x4000
v_mul_f32 v144, v6, v144
v_mul_f32 v145, v6, v145
v_mul_f32 v146, v6, v146
v_mul_f32 v147, v6, v147
v_mul_f32 v148, v6, v148
v_mul_f32 v149, v6, v149
v_mul_f32 v150, v6, v150
v_mul_f32 v151, v6, v151
v_cvt_pk_bf16_f32 v144, v144, v145
v_cvt_pk_bf16_f32 v145, v146, v147
v_cvt_pk_bf16_f32 v146, v148, v149
v_cvt_pk_bf16_f32 v147, v150, v151
buffer_store_dwordx4 v[144:147], v3, s[88:91], s8 offen sc1
s_add_u32 s8, s28, 0x6000
v_mul_f32 v152, v6, v152
v_mul_f32 v153, v6, v153
v_mul_f32 v154, v6, v154
v_mul_f32 v155, v6, v155
v_mul_f32 v156, v6, v156
v_mul_f32 v157, v6, v157
v_mul_f32 v158, v6, v158
v_mul_f32 v159, v6, v159
v_cvt_pk_bf16_f32 v152, v152, v153
v_cvt_pk_bf16_f32 v153, v154, v155
v_cvt_pk_bf16_f32 v154, v156, v157
v_cvt_pk_bf16_f32 v155, v158, v159
buffer_store_dwordx4 v[152:155], v3, s[88:91], s8 offen sc1
v_accvgpr_read_b32 v6, a226
v_accvgpr_read_b32 v7, a227
v_add_f32 v6, v6, v7
v_cmp_nge_f32 vcc, 0x6f800000, v6
v_rcp_f32 v6, v6
s_or_b64 s[34:35], s[34:35], vcc
s_add_u32 s8, s29, 0x0
v_pk_mul_f32 v[160:161], v[160:161], v[6:7] op_sel_hi:[1,0]
v_pk_mul_f32 v[162:163], v[162:163], v[6:7] op_sel_hi:[1,0]
v_pk_mul_f32 v[164:165], v[164:165], v[6:7] op_sel_hi:[1,0]
v_pk_mul_f32 v[166:167], v[166:167], v[6:7] op_sel_hi:[1,0]
v_cvt_pk_bf16_f32 v160, v160, v161
v_cvt_pk_bf16_f32 v161, v162, v163
v_cvt_pk_bf16_f32 v162, v164, v165
v_cvt_pk_bf16_f32 v163, v166, v167
buffer_store_dwordx4 v[160:163], v3, s[88:91], s8 offen sc1
s_add_u32 s8, s29, 0x2000
v_pk_mul_f32 v[168:169], v[168:169], v[6:7] op_sel_hi:[1,0]
v_pk_mul_f32 v[170:171], v[170:171], v[6:7] op_sel_hi:[1,0]
v_pk_mul_f32 v[172:173], v[172:173], v[6:7] op_sel_hi:[1,0]
v_pk_mul_f32 v[174:175], v[174:175], v[6:7] op_sel_hi:[1,0]
v_cvt_pk_bf16_f32 v168, v168, v169
v_cvt_pk_bf16_f32 v169, v170, v171
v_cvt_pk_bf16_f32 v170, v172, v173
v_cvt_pk_bf16_f32 v171, v174, v175
buffer_store_dwordx4 v[168:171], v3, s[88:91], s8 offen sc1
s_add_u32 s8, s29, 0x4000
v_pk_mul_f32 v[176:177], v[176:177], v[6:7] op_sel_hi:[1,0]
v_pk_mul_f32 v[178:179], v[178:179], v[6:7] op_sel_hi:[1,0]
v_pk_mul_f32 v[180:181], v[180:181], v[6:7] op_sel_hi:[1,0]
v_pk_mul_f32 v[182:183], v[182:183], v[6:7] op_sel_hi:[1,0]
v_cvt_pk_bf16_f32 v176, v176, v177
v_cvt_pk_bf16_f32 v177, v178, v179
v_cvt_pk_bf16_f32 v178, v180, v181
v_cvt_pk_bf16_f32 v179, v182, v183
buffer_store_dwordx4 v[176:179], v3, s[88:91], s8 offen sc1
s_add_u32 s8, s29, 0x6000
v_pk_mul_f32 v[184:185], v[184:185], v[6:7] op_sel_hi:[1,0]
v_pk_mul_f32 v[186:187], v[186:187], v[6:7] op_sel_hi:[1,0]
v_pk_mul_f32 v[188:189], v[188:189], v[6:7] op_sel_hi:[1,0]
v_pk_mul_f32 v[190:191], v[190:191], v[6:7] op_sel_hi:[1,0]
v_cvt_pk_bf16_f32 v184, v184, v185
v_cvt_pk_bf16_f32 v185, v186, v187
v_cvt_pk_bf16_f32 v186, v188, v189
v_cvt_pk_bf16_f32 v187, v190, v191
buffer_store_dwordx4 v[184:187], v3, s[88:91], s8 offen sc1
s_getreg_b32 s8, hwreg(HW_REG_HW_ID, 5, 1)
s_cmp_lg_u32 s8, 0
s_cbranch_scc1 L_att_sodd1
s_branch L_att_sodd0
L_att_lh0_0:
v_mfma_f32_16x16x32_bf16 v[160:163], a[32:35], v[52:55], v[160:163]
v_exp_f32 v28, v28
v_mfma_f32_16x16x32_bf16 v[192:195], a[32:35], v[56:59], v[192:195]
buffer_load_dword v14, v15, s[84:87], 0 offen offset:192 sc1
v_mfma_f32_16x16x32_bf16 v[224:227], a[32:35], v[60:63], v[224:227]
v_exp_f32 v29, v29
v_mfma_f32_16x16x32_bf16 v[228:231], a[36:39], v[60:63], v[228:231]
v_exp_f32 v30, v30
v_mfma_f32_16x16x32_bf16 v[196:199], a[36:39], v[56:59], v[196:199]
s_add_u32 m0, s17, 0x10000
v_exp_f32 v31, v31
v_mfma_f32_16x16x32_bf16 v[164:167], a[36:39], v[52:55], v[164:167]
ds_read_b128 a[0:3], v1 offset:8192
v_cvt_pk_bf16_f32 v72, v24, v25
v_mfma_f32_16x16x32_bf16 v[168:171], a[40:43], v[52:55], v[168:171]
ds_read_b128 a[4:7], v1 offset:9216
v_cvt_pk_bf16_f32 v73, v26, v27
v_mfma_f32_16x16x32_bf16 v[200:203], a[40:43], v[56:59], v[200:203]
buffer_load_dwordx4 v12, s[72:75], 0 offen lds
v_mfma_f32_16x16x32_bf16 v[232:235], a[40:43], v[60:63], v[232:235]
ds_read_b128 a[8:11], v1 offset:10240
v_cvt_pk_bf16_f32 v76, v28, v29
v_mfma_f32_16x16x32_bf16 v[236:239], a[44:47], v[60:63], v[236:239]
v_exp_f32 v36, v36
v_mfma_f32_16x16x32_bf16 v[204:207], a[44:47], v[56:59], v[204:207]
v_exp_f32 v37, v37
v_mfma_f32_16x16x32_bf16 v[172:175], a[44:47], v[52:55], v[172:175]
ds_read_b128 a[12:15], v1 offset:11264
v_cvt_pk_bf16_f32 v77, v30, v31
v_mfma_f32_16x16x32_bf16 v[176:179], a[48:51], v[52:55], v[176:179]
buffer_load_dwordx4 v13, s[72:75], 0 offen offset:1024 lds
v_mfma_f32_16x16x32_bf16 v[208:211], a[48:51], v[56:59], v[208:211]
ds_read_b128 a[16:19], v1 offset:12288
v_cvt_pk_bf16_f32 v70, v36, v37
v_mfma_f32_16x16x32_bf16 v[240:243], a[48:51], v[60:63], v[240:243]
ds_read_b128 a[20:23], v1 offset:13312
v_exp_f32 v38, v38
v_mfma_f32_16x16x32_bf16 v[244:247], a[52:55], v[60:63], v[244:247]
ds_read_b128 a[24:27], v1 offset:14336
v_exp_f32 v39, v39
v_mfma_f32_16x16x32_bf16 v[212:215], a[52:55], v[56:59], v[212:215]
v_exp_f32 v40, v40
v_mfma_f32_16x16x32_bf16 v[180:183], a[52:55], v[52:55], v[180:183]
buffer_load_dwordx4 v12, s[72:75], s12 offen offset:2048 lds
v_mfma_f32_16x16x32_bf16 v[184:187], a[56:59], v[52:55], v[184:187]
ds_read_b128 a[28:31], v1 offset:15360
v_exp_f32 v41, v41
v_mfma_f32_16x16x32_bf16 v[216:219], a[56:59], v[56:59], v[216:219]
buffer_load_dwordx4 v13, s[72:75], s12 offen offset:3072 lds
v_mfma_f32_16x16x32_bf16 v[248:251], a[56:59], v[60:63], v[248:251]
s_add_u32 m0, s17, 0x14000
v_exp_f32 v42, v42
v_mfma_f32_16x16x32_bf16 v[252:255], a[60:63], v[60:63], v[252:255]
ds_read_b128 a[32:35], v1 offset:0
v_cvt_pk_bf16_f32 v71, v38, v39
v_mfma_f32_16x16x32_bf16 v[220:223], a[60:63], v[56:59], v[220:223]
ds_read_b128 a[36:39], v1 offset:1024
v_add_u32 v12, 0x20000, v12
v_mfma_f32_16x16x32_bf16 v[188:191], a[60:63], v[52:55], v[188:191]
buffer_load_dwordx4 v12, s[72:75], 0 offen lds
v_mfma_f32_16x16x32_bf16 a[224:227], a[236:239], v[52:55], a[224:227]
ds_read_b128 a[40:43], v1 offset:2048
v_exp_f32 v43, v43
v_smfmac_f32_16x16x64_bf16 a[228:231], a[232:235], v[56:63], v9
s_waitcnt lgkmcnt(7)
v_exp_f32 v44, v44
v_mfma_f32_16x16x32_bf16 v[24:27], a[0:3], a[192:195], v[112:115]
ds_read_b128 a[44:47], v1 offset:3072
v_exp_f32 v45, v45
v_mfma_f32_16x16x32_bf16 v[24:27], a[4:7], a[196:199], v[24:27]
ds_read_b128 a[48:51], v1 offset:4096
v_add_u32 v13, 0x20000, v13
v_mfma_f32_16x16x32_bf16 v[24:27], a[8:11], a[200:203], v[24:27]
v_exp_f32 v46, v46
v_mfma_f32_16x16x32_bf16 v[24:27], a[12:15], a[204:207], v[24:27]
buffer_load_dwordx4 v13, s[72:75], 0 offen offset:1024 lds
v_mfma_f32_16x16x32_bf16 v[28:31], a[0:3], a[208:211], v[92:95]
v_exp_f32 v47, v47
v_mfma_f32_16x16x32_bf16 v[28:31], a[4:7], a[212:215], v[28:31]
ds_read_b128 a[52:55], v1 offset:5120
v_cvt_pk_bf16_f32 v74, v40, v41
v_mfma_f32_16x16x32_bf16 v[28:31], a[8:11], a[216:219], v[28:31]
ds_read_b128 a[56:59], v1 offset:6144
v_cvt_pk_bf16_f32 v75, v42, v43
v_mfma_f32_16x16x32_bf16 v[28:31], a[12:15], a[220:223], v[28:31]
s_waitcnt lgkmcnt(7)
v_exp_f32 v24, v24
v_mfma_f32_16x16x32_bf16 v[40:43], a[16:19], a[192:195], v[116:119]
buffer_load_dwordx4 v12, s[72:75], s12 offen offset:2048 lds
v_mfma_f32_16x16x32_bf16 v[40:43], a[20:23], a[196:199], v[40:43]
ds_read_b128 a[60:63], v1 offset:7168
v_cvt_pk_bf16_f32 v78, v44, v45
v_mfma_f32_16x16x32_bf16 v[40:43], a[24:27], a[200:203], v[40:43]
v_exp_f32 v25, v25
v_mfma_f32_16x16x32_bf16 v[40:43], a[28:31], a[204:207], v[40:43]
buffer_load_dwordx4 v13, s[72:75], s12 offen offset:3072 lds
v_cvt_pk_bf16_f32 v79, v46, v47
v_mfma_f32_16x16x32_bf16 v[44:47], a[16:19], a[208:211], v[92:95]
v_exp_f32 v26, v26
v_mfma_f32_16x16x32_bf16 v[44:47], a[20:23], a[212:215], v[44:47]
v_exp_f32 v27, v27
v_mfma_f32_16x16x32_bf16 v[44:47], a[24:27], a[216:219], v[44:47]
v_exp_f32 v28, v28
v_mfma_f32_16x16x32_bf16 v[44:47], a[28:31], a[220:223], v[44:47]
s_waitcnt lgkmcnt(0)
v_exp_f32 v29, v29
v_mfma_f32_16x16x32_bf16 v[160:163], a[32:35], v[68:71], v[160:163]
ds_read_b128 a[0:3], v1 offset:24576
v_cvt_pk_bf16_f32 v56, v24, v25
v_mfma_f32_16x16x32_bf16 v[192:195], a[32:35], v[72:75], v[192:195]
ds_read_b128 a[4:7], v1 offset:25600
v_add_u32 v12, 0x20000, v12
v_mfma_f32_16x16x32_bf16 v[224:227], a[32:35], v[76:79], v[224:227]
s_add_u32 m0, s16, 0x0
v_exp_f32 v30, v30
v_mfma_f32_16x16x32_bf16 v[228:231], a[36:39], v[76:79], v[228:231]
buffer_load_dwordx4 v12, s[72:75], 0 offen lds
v_mfma_f32_16x16x32_bf16 v[196:199], a[36:39], v[72:75], v[196:199]
ds_read_b128 a[8:11], v1 offset:26624
v_add_u32 v13, 0x20000, v13
v_mfma_f32_16x16x32_bf16 v[164:167], a[36:39], v[68:71], v[164:167]
buffer_load_dwordx4 v13, s[72:75], 0 offen offset:1024 lds
v_mfma_f32_16x16x32_bf16 v[168:171], a[40:43], v[68:71], v[168:171]
ds_read_b128 a[12:15], v1 offset:27648
v_cvt_pk_bf16_f32 v57, v26, v27
v_mfma_f32_16x16x32_bf16 v[200:203], a[40:43], v[72:75], v[200:203]
v_exp_f32 v31, v31
v_mfma_f32_16x16x32_bf16 v[232:235], a[40:43], v[76:79], v[232:235]
ds_read_b128 a[16:19], v1 offset:28672
v_cvt_pk_bf16_f32 v60, v28, v29
v_mfma_f32_16x16x32_bf16 v[236:239], a[44:47], v[76:79], v[236:239]
buffer_load_dwordx4 v12, s[72:75], s12 offen offset:2048 lds
v_mfma_f32_16x16x32_bf16 v[204:207], a[44:47], v[72:75], v[204:207]
ds_read_b128 a[20:23], v1 offset:29696
v_cvt_pk_bf16_f32 v61, v30, v31
v_mfma_f32_16x16x32_bf16 v[172:175], a[44:47], v[68:71], v[172:175]
buffer_load_dwordx4 v13, s[72:75], s12 offen offset:3072 lds
v_mfma_f32_16x16x32_bf16 v[176:179], a[48:51], v[68:71], v[176:179]
ds_read_b128 a[24:27], v1 offset:30720
v_mfma_f32_16x16x32_bf16 v[208:211], a[48:51], v[72:75], v[208:211]
ds_read_b128 a[28:31], v1 offset:31744
v_mfma_f32_16x16x32_bf16 v[240:243], a[48:51], v[76:79], v[240:243]
v_exp_f32 v40, v40
v_mfma_f32_16x16x32_bf16 v[244:247], a[52:55], v[76:79], v[244:247]
s_add_u32 m0, s16, 0x4000
v_exp_f32 v41, v41
v_mfma_f32_16x16x32_bf16 v[212:215], a[52:55], v[72:75], v[212:215]
ds_read_b128 a[32:35], v1 offset:16384
v_cvt_pk_bf16_f32 v58, v40, v41
v_mfma_f32_16x16x32_bf16 v[180:183], a[52:55], v[68:71], v[180:183]
ds_read_b128 a[36:39], v1 offset:17408
v_add_u32 v12, 0x20000, v12
v_mfma_f32_16x16x32_bf16 v[184:187], a[56:59], v[68:71], v[184:187]
buffer_load_dwordx4 v12, s[72:75], 0 offen lds
v_mfma_f32_16x16x32_bf16 v[216:219], a[56:59], v[72:75], v[216:219]
ds_read_b128 a[40:43], v1 offset:18432
v_mfma_f32_16x16x32_bf16 v[248:251], a[56:59], v[76:79], v[248:251]
v_exp_f32 v42, v42
v_mfma_f32_16x16x32_bf16 v[252:255], a[60:63], v[76:79], v[252:255]
ds_read_b128 a[44:47], v1 offset:19456
v_add_u32 v13, 0x20000, v13
v_mfma_f32_16x16x32_bf16 v[220:223], a[60:63], v[72:75], v[220:223]
buffer_load_dwordx4 v13, s[72:75], 0 offen offset:1024 lds
v_mfma_f32_16x16x32_bf16 v[188:191], a[60:63], v[68:71], v[188:191]
ds_read_b128 a[48:51], v1 offset:20480
v_exp_f32 v43, v43
v_mfma_f32_16x16x32_bf16 a[224:227], a[236:239], v[68:71], a[224:227]
s_waitcnt lgkmcnt(9)
v_exp_f32 v44, v44
v_smfmac_f32_16x16x64_bf16 a[228:231], a[232:235], v[72:79], v9
ds_read_b128 a[52:55], v1 offset:21504
v_exp_f32 v45, v45
v_mfma_f32_16x16x32_bf16 v[28:31], a[0:3], a[208:211], v[92:95]
buffer_load_dwordx4 v12, s[72:75], s12 offen offset:2048 lds
v_mfma_f32_16x16x32_bf16 v[28:31], a[4:7], a[212:215], v[28:31]
ds_read_b128 a[56:59], v1 offset:22528
v_exp_f32 v46, v46
v_mfma_f32_16x16x32_bf16 v[28:31], a[8:11], a[216:219], v[28:31]
ds_read_b128 a[60:63], v1 offset:23552
v_xor_b32 v1, 0x8000, v1
v_mfma_f32_16x16x32_bf16 v[28:31], a[12:15], a[220:223], v[28:31]
s_waitcnt lgkmcnt(8)
v_exp_f32 v47, v47
v_cvt_pk_bf16_f32 v62, v44, v45
v_cvt_pk_bf16_f32 v63, v46, v47
v_mfma_f32_16x16x32_bf16 v[44:47], a[16:19], a[208:211], v[92:95]
buffer_load_dwordx4 v13, s[72:75], s12 offen offset:3072 lds
v_mfma_f32_16x16x32_bf16 v[44:47], a[20:23], a[212:215], v[44:47]
v_cvt_pk_bf16_f32 v59, v42, v43
v_mfma_f32_16x16x32_bf16 v[44:47], a[24:27], a[216:219], v[44:47]
v_mfma_f32_16x16x32_bf16 v[44:47], a[28:31], a[220:223], v[44:47]
v_accvgpr_read_b32 v6, a224
v_accvgpr_read_b32 v7, a225
v_add_f32 v6, v6, v7
v_cmp_nge_f32 vcc, 0x6f800000, v6
v_rcp_f32 v6, v6
s_or_b64 s[34:35], s[34:35], vcc
s_add_u32 s8, s28, 0x0
v_pk_mul_f32 v[128:129], v[128:129], v[6:7] op_sel_hi:[1,0]
v_pk_mul_f32 v[130:131], v[130:131], v[6:7] op_sel_hi:[1,0]
v_pk_mul_f32 v[132:133], v[132:133], v[6:7] op_sel_hi:[1,0]
v_pk_mul_f32 v[134:135], v[134:135], v[6:7] op_sel_hi:[1,0]
v_cvt_pk_bf16_f32 v128, v128, v129
v_cvt_pk_bf16_f32 v129, v130, v131
v_cvt_pk_bf16_f32 v130, v132, v133
v_cvt_pk_bf16_f32 v131, v134, v135
buffer_store_dwordx4 v[128:131], v3, s[88:91], s8 offen sc1
s_add_u32 s8, s28, 0x2000
v_pk_mul_f32 v[136:137], v[136:137], v[6:7] op_sel_hi:[1,0]
v_pk_mul_f32 v[138:139], v[138:139], v[6:7] op_sel_hi:[1,0]
v_pk_mul_f32 v[140:141], v[140:141], v[6:7] op_sel_hi:[1,0]
v_pk_mul_f32 v[142:143], v[142:143], v[6:7] op_sel_hi:[1,0]
v_cvt_pk_bf16_f32 v136, v136, v137
v_cvt_pk_bf16_f32 v137, v138, v139
v_cvt_pk_bf16_f32 v138, v140, v141
v_cvt_pk_bf16_f32 v139, v142, v143
buffer_store_dwordx4 v[136:139], v3, s[88:91], s8 offen sc1
s_add_u32 s8, s28, 0x4000
v_pk_mul_f32 v[144:145], v[144:145], v[6:7] op_sel_hi:[1,0]
v_pk_mul_f32 v[146:147], v[146:147], v[6:7] op_sel_hi:[1,0]
v_pk_mul_f32 v[148:149], v[148:149], v[6:7] op_sel_hi:[1,0]
v_pk_mul_f32 v[150:151], v[150:151], v[6:7] op_sel_hi:[1,0]
v_cvt_pk_bf16_f32 v144, v144, v145
v_cvt_pk_bf16_f32 v145, v146, v147
v_cvt_pk_bf16_f32 v146, v148, v149
v_cvt_pk_bf16_f32 v147, v150, v151
buffer_store_dwordx4 v[144:147], v3, s[88:91], s8 offen sc1
s_add_u32 s8, s28, 0x6000
v_pk_mul_f32 v[152:153], v[152:153], v[6:7] op_sel_hi:[1,0]
v_pk_mul_f32 v[154:155], v[154:155], v[6:7] op_sel_hi:[1,0]
v_pk_mul_f32 v[156:157], v[156:157], v[6:7] op_sel_hi:[1,0]
v_pk_mul_f32 v[158:159], v[158:159], v[6:7] op_sel_hi:[1,0]
v_cvt_pk_bf16_f32 v152, v152, v153
v_cvt_pk_bf16_f32 v153, v154, v155
v_cvt_pk_bf16_f32 v154, v156, v157
v_cvt_pk_bf16_f32 v155, v158, v159
buffer_store_dwordx4 v[152:155], v3, s[88:91], s8 offen sc1
v_accvgpr_read_b32 v6, a226
v_accvgpr_read_b32 v7, a227
v_add_f32 v6, v6, v7
v_cmp_nge_f32 vcc, 0x6f800000, v6
v_rcp_f32 v6, v6
s_or_b64 s[34:35], s[34:35], vcc
s_add_u32 s8, s29, 0x0
v_pk_mul_f32 v[160:161], v[160:161], v[6:7] op_sel_hi:[1,0]
v_pk_mul_f32 v[162:163], v[162:163], v[6:7] op_sel_hi:[1,0]
v_pk_mul_f32 v[164:165], v[164:165], v[6:7] op_sel_hi:[1,0]
v_pk_mul_f32 v[166:167], v[166:167], v[6:7] op_sel_hi:[1,0]
v_cvt_pk_bf16_f32 v160, v160, v161
v_cvt_pk_bf16_f32 v161, v162, v163
v_cvt_pk_bf16_f32 v162, v164, v165
v_cvt_pk_bf16_f32 v163, v166, v167
buffer_store_dwordx4 v[160:163], v3, s[88:91], s8 offen sc1
s_add_u32 s8, s29, 0x2000
v_pk_mul_f32 v[168:169], v[168:169], v[6:7] op_sel_hi:[1,0]
v_pk_mul_f32 v[170:171], v[170:171], v[6:7] op_sel_hi:[1,0]
v_pk_mul_f32 v[172:173], v[172:173], v[6:7] op_sel_hi:[1,0]
v_pk_mul_f32 v[174:175], v[174:175], v[6:7] op_sel_hi:[1,0]
v_cvt_pk_bf16_f32 v168, v168, v169
v_cvt_pk_bf16_f32 v169, v170, v171
v_cvt_pk_bf16_f32 v170, v172, v173
v_cvt_pk_bf16_f32 v171, v174, v175
buffer_store_dwordx4 v[168:171], v3, s[88:91], s8 offen sc1
s_add_u32 s8, s29, 0x4000
v_pk_mul_f32 v[176:177], v[176:177], v[6:7] op_sel_hi:[1,0]
v_pk_mul_f32 v[178:179], v[178:179], v[6:7] op_sel_hi:[1,0]
v_pk_mul_f32 v[180:181], v[180:181], v[6:7] op_sel_hi:[1,0]
v_pk_mul_f32 v[182:183], v[182:183], v[6:7] op_sel_hi:[1,0]
v_cvt_pk_bf16_f32 v176, v176, v177
v_cvt_pk_bf16_f32 v177, v178, v179
v_cvt_pk_bf16_f32 v178, v180, v181
v_cvt_pk_bf16_f32 v179, v182, v183
buffer_store_dwordx4 v[176:179], v3, s[88:91], s8 offen sc1
s_add_u32 s8, s29, 0x6000
v_pk_mul_f32 v[184:185], v[184:185], v[6:7] op_sel_hi:[1,0]
v_pk_mul_f32 v[186:187], v[186:187], v[6:7] op_sel_hi:[1,0]
v_pk_mul_f32 v[188:189], v[188:189], v[6:7] op_sel_hi:[1,0]
v_pk_mul_f32 v[190:191], v[190:191], v[6:7] op_sel_hi:[1,0]
v_cvt_pk_bf16_f32 v184, v184, v185
v_cvt_pk_bf16_f32 v185, v186, v187
v_cvt_pk_bf16_f32 v186, v188, v189
v_cvt_pk_bf16_f32 v187, v190, v191
buffer_store_dwordx4 v[184:187], v3, s[88:91], s8 offen sc1
s_branch L_att_h1_0
L_att_dl0_1:
v_mfma_f32_16x16x32_bf16 v[128:131], a[32:35], v[48:51], v[128:131]
ds_read_b128 a[0:3], v1 offset:8192
v_cvt_pk_bf16_f32 v72, v24, v25
v_mfma_f32_16x16x32_bf16 v[160:163], a[32:35], v[52:55], v[160:163]
v_exp_f32 v28, v28
v_mfma_f32_16x16x32_bf16 v[192:195], a[32:35], v[56:59], v[192:195]
v_cvt_pk_bf16_f32 v73, v26, v27
v_mfma_f32_16x16x32_bf16 v[224:227], a[32:35], v[60:63], v[224:227]
ds_read_b128 a[4:7], v1 offset:9216
v_mfma_f32_16x16x32_bf16 v[228:231], a[36:39], v[60:63], v[228:231]
s_add_u32 m0, s27, 0x0
v_exp_f32 v29, v29
v_mfma_f32_16x16x32_bf16 v[196:199], a[36:39], v[56:59], v[196:199]
buffer_load_dwordx4 v3, s[48:51], s32 offen offset:0 sc1 lds
v_mfma_f32_16x16x32_bf16 v[164:167], a[36:39], v[52:55], v[164:167]
v_exp_f32 v30, v30
v_mfma_f32_16x16x32_bf16 v[132:135], a[36:39], v[48:51], v[132:135]
ds_read_b128 a[8:11], v1 offset:10240
v_cvt_pk_bf16_f32 v76, v28, v29
v_mfma_f32_16x16x32_bf16 v[136:139], a[40:43], v[48:51], v[136:139]
v_mfma_f32_16x16x32_bf16 v[168:171], a[40:43], v[52:55], v[168:171]
v_exp_f32 v31, v31
v_mfma_f32_16x16x32_bf16 v[200:203], a[40:43], v[56:59], v[200:203]
v_exp_f32 v32, v32
v_mfma_f32_16x16x32_bf16 v[232:235], a[40:43], v[60:63], v[232:235]
ds_read_b128 a[12:15], v1 offset:11264
v_cvt_pk_bf16_f32 v77, v30, v31
v_mfma_f32_16x16x32_bf16 v[236:239], a[44:47], v[60:63], v[236:239]
v_exp_f32 v33, v33
v_mfma_f32_16x16x32_bf16 v[204:207], a[44:47], v[56:59], v[204:207]
v_cvt_pk_bf16_f32 v66, v32, v33
v_mfma_f32_16x16x32_bf16 v[172:175], a[44:47], v[52:55], v[172:175]
v_exp_f32 v34, v34
v_mfma_f32_16x16x32_bf16 v[140:143], a[44:47], v[48:51], v[140:143]
ds_read_b128 a[16:19], v1 offset:12288
v_mfma_f32_16x16x32_bf16 v[144:147], a[48:51], v[48:51], v[144:147]
buffer_load_dwordx4 v3, s[48:51], s32 offen offset:1024 sc1 lds
v_mfma_f32_16x16x32_bf16 v[176:179], a[48:51], v[52:55], v[176:179]
v_exp_f32 v35, v35
v_mfma_f32_16x16x32_bf16 v[208:211], a[48:51], v[56:59], v[208:211]
v_exp_f32 v36, v36
v_mfma_f32_16x16x32_bf16 v[240:243], a[48:51], v[60:63], v[240:243]
ds_read_b128 a[20:23], v1 offset:13312
v_cvt_pk_bf16_f32 v67, v34, v35
v_mfma_f32_16x16x32_bf16 v[244:247], a[52:55], v[60:63], v[244:247]
v_mfma_f32_16x16x32_bf16 v[212:215], a[52:55], v[56:59], v[212:215]
v_exp_f32 v37, v37
v_mfma_f32_16x16x32_bf16 v[180:183], a[52:55], v[52:55], v[180:183]
ds_read_b128 a[24:27], v1 offset:14336
v_cvt_pk_bf16_f32 v70, v36, v37
v_mfma_f32_16x16x32_bf16 v[148:151], a[52:55], v[48:51], v[148:151]
v_exp_f32 v38, v38
v_mfma_f32_16x16x32_bf16 v[152:155], a[56:59], v[48:51], v[152:155]
v_mfma_f32_16x16x32_bf16 v[184:187], a[56:59], v[52:55], v[184:187]
v_exp_f32 v39, v39
v_mfma_f32_16x16x32_bf16 v[216:219], a[56:59], v[56:59], v[216:219]
buffer_load_dwordx4 v3, s[48:51], s32 offen offset:2048 sc1 lds
v_mfma_f32_16x16x32_bf16 v[248:251], a[56:59], v[60:63], v[248:251]
ds_read_b128 a[28:31], v1 offset:15360
v_cvt_pk_bf16_f32 v71, v38, v39
v_mfma_f32_16x16x32_bf16 v[252:255], a[60:63], v[60:63], v[252:255]
v_exp_f32 v40, v40
v_mfma_f32_16x16x32_bf16 v[220:223], a[60:63], v[56:59], v[220:223]
v_exp_f32 v41, v41
v_mfma_f32_16x16x32_bf16 v[188:191], a[60:63], v[52:55], v[188:191]
ds_read_b128 a[32:35], v1 offset:0
v_cvt_pk_bf16_f32 v74, v40, v41
v_mfma_f32_16x16x32_bf16 v[156:159], a[60:63], v[48:51], v[156:159]
v_smfmac_f32_16x16x64_bf16 a[224:227], a[232:235], v[48:55], v9
v_exp_f32 v42, v42
v_smfmac_f32_16x16x64_bf16 a[228:231], a[232:235], v[56:63], v9
s_waitcnt lgkmcnt(5)
v_exp_f32 v43, v43
v_mfma_f32_16x16x32_bf16 v[16:19], a[0:3], a[160:163], v[80:83]
ds_read_b128 a[36:39], v1 offset:1024
v_cvt_pk_bf16_f32 v75, v42, v43
v_mfma_f32_16x16x32_bf16 v[16:19], a[4:7], a[164:167], v[16:19]
v_exp_f32 v44, v44
v_mfma_f32_16x16x32_bf16 v[16:19], a[8:11], a[168:171], v[16:19]
v_mfma_f32_16x16x32_bf16 v[16:19], a[12:15], a[172:175], v[16:19]
buffer_load_dwordx4 v3, s[48:51], s32 offen offset:3072 sc1 lds
v_mfma_f32_16x16x32_bf16 v[20:23], a[0:3], a[176:179], v[84:87]
ds_read_b128 a[40:43], v1 offset:2048
v_mfma_f32_16x16x32_bf16 v[20:23], a[4:7], a[180:183], v[20:23]
v_exp_f32 v45, v45
v_mfma_f32_16x16x32_bf16 v[20:23], a[8:11], a[184:187], v[20:23]
v_exp_f32 v46, v46
v_mfma_f32_16x16x32_bf16 v[20:23], a[12:15], a[188:191], v[20:23]
ds_read_b128 a[44:47], v1 offset:3072
v_cvt_pk_bf16_f32 v78, v44, v45
v_mfma_f32_16x16x32_bf16 v[24:27], a[0:3], a[192:195], v[88:91]
v_mfma_f32_16x16x32_bf16 v[24:27], a[4:7], a[196:199], v[24:27]
v_exp_f32 v47, v47
v_mfma_f32_16x16x32_bf16 v[24:27], a[8:11], a[200:203], v[24:27]
v_exp_f32 v16, v16
v_mfma_f32_16x16x32_bf16 v[24:27], a[12:15], a[204:207], v[24:27]
ds_read_b128 a[48:51], v1 offset:4096
v_cvt_pk_bf16_f32 v79, v46, v47
v_mfma_f32_16x16x32_bf16 v[28:31], a[0:3], a[208:211], v[92:95]
v_exp_f32 v17, v17
v_mfma_f32_16x16x32_bf16 v[28:31], a[4:7], a[212:215], v[28:31]
s_add_u32 m0, s27, 0x1000
v_cvt_pk_bf16_f32 v48, v16, v17
v_mfma_f32_16x16x32_bf16 v[28:31], a[8:11], a[216:219], v[28:31]
buffer_load_dwordx4 v3, s[48:51], s7 offen offset:0 sc1 lds
v_mfma_f32_16x16x32_bf16 v[28:31], a[12:15], a[220:223], v[28:31]
ds_read_b128 a[52:55], v1 offset:5120
s_waitcnt lgkmcnt(6)
v_mfma_f32_16x16x32_bf16 v[32:35], a[16:19], a[160:163], v[80:83]
v_exp_f32 v18, v18
v_mfma_f32_16x16x32_bf16 v[32:35], a[20:23], a[164:167], v[32:35]
v_exp_f32 v19, v19
v_mfma_f32_16x16x32_bf16 v[32:35], a[24:27], a[168:171], v[32:35]
v_exp_f32 v20, v20
v_mfma_f32_16x16x32_bf16 v[32:35], a[28:31], a[172:175], v[32:35]
ds_read_b128 a[56:59], v1 offset:6144
v_cvt_pk_bf16_f32 v49, v18, v19
v_mfma_f32_16x16x32_bf16 v[36:39], a[16:19], a[176:179], v[84:87]
v_mfma_f32_16x16x32_bf16 v[36:39], a[20:23], a[180:183], v[36:39]
v_exp_f32 v21, v21
v_mfma_f32_16x16x32_bf16 v[36:39], a[24:27], a[184:187], v[36:39]
v_exp_f32 v22, v22
v_mfma_f32_16x16x32_bf16 v[36:39], a[28:31], a[188:191], v[36:39]
ds_read_b128 a[60:63], v1 offset:7168
v_cvt_pk_bf16_f32 v52, v20, v21
v_mfma_f32_16x16x32_bf16 v[40:43], a[16:19], a[192:195], v[88:91]
buffer_load_dwordx4 v3, s[48:51], s7 offen offset:1024 sc1 lds
v_mfma_f32_16x16x32_bf16 v[40:43], a[20:23], a[196:199], v[40:43]
v_mfma_f32_16x16x32_bf16 v[40:43], a[24:27], a[200:203], v[40:43]
v_exp_f32 v23, v23
v_mfma_f32_16x16x32_bf16 v[40:43], a[28:31], a[204:207], v[40:43]
v_exp_f32 v24, v24
v_mfma_f32_16x16x32_bf16 v[44:47], a[16:19], a[208:211], v[92:95]
v_exp_f32 v25, v25
v_mfma_f32_16x16x32_bf16 v[44:47], a[20:23], a[212:215], v[44:47]
v_exp_f32 v26, v26
v_mfma_f32_16x16x32_bf16 v[44:47], a[24:27], a[216:219], v[44:47]
v_exp_f32 v27, v27
v_mfma_f32_16x16x32_bf16 v[44:47], a[28:31], a[220:223], v[44:47]
s_waitcnt lgkmcnt(0)
v_cvt_pk_bf16_f32 v53, v22, v23
v_mfma_f32_16x16x32_bf16 v[128:131], a[32:35], v[64:67], v[128:131]
ds_read_b128 a[0:3], v1 offset:24576
v_cvt_pk_bf16_f32 v56, v24, v25
v_mfma_f32_16x16x32_bf16 v[160:163], a[32:35], v[68:71], v[160:163]
v_exp_f32 v28, v28
v_mfma_f32_16x16x32_bf16 v[192:195], a[32:35], v[72:75], v[192:195]
v_cvt_pk_bf16_f32 v57, v26, v27
v_mfma_f32_16x16x32_bf16 v[224:227], a[32:35], v[76:79], v[224:227]
ds_read_b128 a[4:7], v1 offset:25600
v_mfma_f32_16x16x32_bf16 v[228:231], a[36:39], v[76:79], v[228:231]
v_exp_f32 v29, v29
v_mfma_f32_16x16x32_bf16 v[196:199], a[36:39], v[72:75], v[196:199]
v_exp_f32 v30, v30
v_mfma_f32_16x16x32_bf16 v[164:167], a[36:39], v[68:71], v[164:167]
buffer_load_dwordx4 v3, s[48:51], s7 offen offset:2048 sc1 lds
v_mfma_f32_16x16x32_bf16 v[132:135], a[36:39], v[64:67], v[132:135]
ds_read_b128 a[8:11], v1 offset:26624
v_cvt_pk_bf16_f32 v60, v28, v29
v_mfma_f32_16x16x32_bf16 v[136:139], a[40:43], v[64:67], v[136:139]
v_mfma_f32_16x16x32_bf16 v[168:171], a[40:43], v[68:71], v[168:171]
v_exp_f32 v31, v31
v_mfma_f32_16x16x32_bf16 v[200:203], a[40:43], v[72:75], v[200:203]
v_exp_f32 v32, v32
v_mfma_f32_16x16x32_bf16 v[232:235], a[40:43], v[76:79], v[232:235]
ds_read_b128 a[12:15], v1 offset:27648
v_cvt_pk_bf16_f32 v61, v30, v31
v_mfma_f32_16x16x32_bf16 v[236:239], a[44:47], v[76:79], v[236:239]
v_mfma_f32_16x16x32_bf16 v[204:207], a[44:47], v[72:75], v[204:207]
v_exp_f32 v33, v33
v_mfma_f32_16x16x32_bf16 v[172:175], a[44:47], v[68:71], v[172:175]
v_exp_f32 v34, v34
v_mfma_f32_16x16x32_bf16 v[140:143], a[44:47], v[64:67], v[140:143]
ds_read_b128 a[16:19], v1 offset:28672
v_cvt_pk_bf16_f32 v50, v32, v33
v_mfma_f32_16x16x32_bf16 v[144:147], a[48:51], v[64:67], v[144:147]
v_exp_f32 v35, v35
v_mfma_f32_16x16x32_bf16 v[176:179], a[48:51], v[68:71], v[176:179]
v_cvt_pk_bf16_f32 v51, v34, v35
v_mfma_f32_16x16x32_bf16 v[208:211], a[48:51], v[72:75], v[208:211]
buffer_load_dwordx4 v3, s[48:51], s7 offen offset:3072 sc1 lds
v_mfma_f32_16x16x32_bf16 v[240:243], a[48:51], v[76:79], v[240:243]
ds_read_b128 a[20:23], v1 offset:29696
v_mfma_f32_16x16x32_bf16 v[244:247], a[52:55], v[76:79], v[244:247]
v_exp_f32 v36, v36
v_mfma_f32_16x16x32_bf16 v[212:215], a[52:55], v[72:75], v[212:215]
v_exp_f32 v37, v37
v_mfma_f32_16x16x32_bf16 v[180:183], a[52:55], v[68:71], v[180:183]
ds_read_b128 a[24:27], v1 offset:30720
v_cvt_pk_bf16_f32 v54, v36, v37
v_mfma_f32_16x16x32_bf16 v[148:151], a[52:55], v[64:67], v[148:151]
v_mfma_f32_16x16x32_bf16 v[152:155], a[56:59], v[64:67], v[152:155]
v_exp_f32 v38, v38
v_mfma_f32_16x16x32_bf16 v[184:187], a[56:59], v[68:71], v[184:187]
v_exp_f32 v39, v39
v_mfma_f32_16x16x32_bf16 v[216:219], a[56:59], v[72:75], v[216:219]
ds_read_b128 a[28:31], v1 offset:31744
v_cvt_pk_bf16_f32 v55, v38, v39
v_mfma_f32_16x16x32_bf16 v[248:251], a[56:59], v[76:79], v[248:251]
v_exp_f32 v40, v40
v_mfma_f32_16x16x32_bf16 v[252:255], a[60:63], v[76:79], v[252:255]
v_mfma_f32_16x16x32_bf16 v[220:223], a[60:63], v[72:75], v[220:223]
s_mov_b32 s9, 0x0
v_exp_f32 v41, v41
v_mfma_f32_16x16x32_bf16 v[188:191], a[60:63], v[68:71], v[188:191]
buffer_load_dword a244, v8, s[72:75], s9 offen
v_mfma_f32_16x16x32_bf16 v[156:159], a[60:63], v[64:67], v[156:159]
ds_read_b128 a[32:35], v1 offset:16384
v_cvt_pk_bf16_f32 v58, v40, v41
v_smfmac_f32_16x16x64_bf16 a[224:227], a[232:235], v[64:71], v9
s_waitcnt lgkmcnt(5)
v_exp_f32 v42, v42
v_smfmac_f32_16x16x64_bf16 a[228:231], a[232:235], v[72:79], v9
ds_read_b128 a[36:39], v1 offset:17408
v_mfma_f32_16x16x32_bf16 v[16:19], a[0:3], a[160:163], v[96:99]
v_mfma_f32_16x16x32_bf16 v[16:19], a[4:7], a[164:167], v[16:19]
v_exp_f32 v43, v43
v_mfma_f32_16x16x32_bf16 v[16:19], a[8:11], a[168:171], v[16:19]
v_exp_f32 v44, v44
v_mfma_f32_16x16x32_bf16 v[16:19], a[12:15], a[172:175], v[16:19]
ds_read_b128 a[40:43], v1 offset:18432
v_cvt_pk_bf16_f32 v59, v42, v43
v_mfma_f32_16x16x32_bf16 v[20:23], a[0:3], a[176:179], v[84:87]
v_exp_f32 v45, v45
v_mfma_f32_16x16x32_bf16 v[20:23], a[4:7], a[180:183], v[20:23]
v_cvt_pk_bf16_f32 v62, v44, v45
v_mfma_f32_16x16x32_bf16 v[20:23], a[8:11], a[184:187], v[20:23]
s_mov_b32 s9, 0x0
v_exp_f32 v46, v46
v_mfma_f32_16x16x32_bf16 v[20:23], a[12:15], a[188:191], v[20:23]
ds_read_b128 a[44:47], v1 offset:19456
v_mfma_f32_16x16x32_bf16 v[24:27], a[0:3], a[192:195], v[88:91]
buffer_load_dword a244, v8, s[64:67], s9 offen
v_mfma_f32_16x16x32_bf16 v[24:27], a[4:7], a[196:199], v[24:27]
v_exp_f32 v47, v47
v_mfma_f32_16x16x32_bf16 v[24:27], a[8:11], a[200:203], v[24:27]
v_cvt_pk_bf16_f32 v63, v46, v47
v_mfma_f32_16x16x32_bf16 v[24:27], a[12:15], a[204:207], v[24:27]
ds_read_b128 a[48:51], v1 offset:20480
v_mfma_f32_16x16x32_bf16 v[28:31], a[0:3], a[208:211], v[92:95]
v_exp_f32 v16, v16
v_mfma_f32_16x16x32_bf16 v[28:31], a[4:7], a[212:215], v[28:31]
v_exp_f32 v17, v17
v_mfma_f32_16x16x32_bf16 v[28:31], a[8:11], a[216:219], v[28:31]
ds_read_b128 a[52:55], v1 offset:21504
v_cvt_pk_bf16_f32 v64, v16, v17
v_mfma_f32_16x16x32_bf16 v[28:31], a[12:15], a[220:223], v[28:31]
s_waitcnt lgkmcnt(6)
v_exp_f32 v18, v18
v_mfma_f32_16x16x32_bf16 v[32:35], a[16:19], a[160:163], v[100:103]
v_mfma_f32_16x16x32_bf16 v[32:35], a[20:23], a[164:167], v[32:35]
v_exp_f32 v19, v19
v_mfma_f32_16x16x32_bf16 v[32:35], a[24:27], a[168:171], v[32:35]
ds_read_b128 a[56:59], v1 offset:22528
v_cvt_pk_bf16_f32 v65, v18, v19
v_mfma_f32_16x16x32_bf16 v[32:35], a[28:31], a[172:175], v[32:35]
s_mov_b32 s9, 0x400000
v_exp_f32 v20, v20
v_mfma_f32_16x16x32_bf16 v[36:39], a[16:19], a[176:179], v[84:87]
buffer_load_dword a244, v8, s[64:67], s9 offen
v_mfma_f32_16x16x32_bf16 v[36:39], a[20:23], a[180:183], v[36:39]
s_add_u32 s32, s32, 0x8000
v_mfma_f32_16x16x32_bf16 v[36:39], a[24:27], a[184:187], v[36:39]
ds_read_b128 a[60:63], v1 offset:23552
v_xor_b32 v1, 0x8000, v1
v_mfma_f32_16x16x32_bf16 v[36:39], a[28:31], a[188:191], v[36:39]
s_add_u32 s7, s7, 0x8000
v_exp_f32 v21, v21
v_mfma_f32_16x16x32_bf16 v[40:43], a[16:19], a[192:195], v[88:91]
s_xor_b32 s27, s27, 0x38000
v_exp_f32 v22, v22
v_mfma_f32_16x16x32_bf16 v[40:43], a[20:23], a[196:199], v[40:43]
v_exp_f32 v23, v23
v_mfma_f32_16x16x32_bf16 v[40:43], a[24:27], a[200:203], v[40:43]
v_cvt_pk_bf16_f32 v68, v20, v21
v_cvt_pk_bf16_f32 v69, v22, v23
v_mfma_f32_16x16x32_bf16 v[40:43], a[28:31], a[204:207], v[40:43]
v_exp_f32 v24, v24
v_mfma_f32_16x16x32_bf16 v[44:47], a[16:19], a[208:211], v[92:95]
v_exp_f32 v25, v25
v_mfma_f32_16x16x32_bf16 v[44:47], a[20:23], a[212:215], v[44:47]
v_exp_f32 v26, v26
v_mfma_f32_16x16x32_bf16 v[44:47], a[24:27], a[216:219], v[44:47]
s_waitcnt vmcnt(19) lgkmcnt(0)
v_exp_f32 v27, v27
v_mfma_f32_16x16x32_bf16 v[44:47], a[28:31], a[220:223], v[44:47]
s_barrier
L_att_l1_1:
v_mfma_f32_16x16x32_bf16 v[128:131], a[32:35], v[48:51], v[128:131]
ds_read_b128 a[0:3], v2 offset:8192
v_cvt_pk_bf16_f32 v72, v24, v25
v_mfma_f32_16x16x32_bf16 v[160:163], a[32:35], v[52:55], v[160:163]
s_lshr_b32 s44, s2, 6
v_exp_f32 v28, v28
v_mfma_f32_16x16x32_bf16 v[192:195], a[32:35], v[56:59], v[192:195]
s_add_u32 m0, s19, 0x0
s_lshl_b32 s45, s44, 1
v_cvt_pk_bf16_f32 v73, v26, v27
v_mfma_f32_16x16x32_bf16 v[224:227], a[32:35], v[60:63], v[224:227]
ds_read_b128 a[4:7], v2 offset:9216
s_add_u32 s45, s45, s100
v_mfma_f32_16x16x32_bf16 v[228:231], a[36:39], v[60:63], v[228:231]
buffer_load_dwordx4 v3, s[48:51], s32 offen offset:0 sc1 lds
v_mfma_f32_16x16x32_bf16 v[196:199], a[36:39], v[56:59], v[196:199]
s_and_b32 s60, s45, 3
v_exp_f32 v29, v29
v_mfma_f32_16x16x32_bf16 v[164:167], a[36:39], v[52:55], v[164:167]
ds_read_b128 a[8:11], v2 offset:10240
v_cvt_pk_bf16_f32 v76, v28, v29
v_mfma_f32_16x16x32_bf16 v[132:135], a[36:39], v[48:51], v[132:135]
s_sub_u32 s60, s60, s44
v_exp_f32 v30, v30
v_mfma_f32_16x16x32_bf16 v[136:139], a[40:43], v[48:51], v[136:139]
s_add_u32 s60, s60, 4
v_exp_f32 v31, v31
v_mfma_f32_16x16x32_bf16 v[168:171], a[40:43], v[52:55], v[168:171]
ds_read_b128 a[12:15], v2 offset:11264
v_cvt_pk_bf16_f32 v77, v30, v31
v_mfma_f32_16x16x32_bf16 v[200:203], a[40:43], v[56:59], v[200:203]
s_lshl_b32 s60, s60, 14
s_and_b32 s60, s60, 0x7c000
s_lshl_b32 s61, s60, 3
v_mfma_f32_16x16x32_bf16 v[232:235], a[40:43], v[60:63], v[232:235]
s_add_u32 s62, s61, s12
v_exp_f32 v32, v32
v_mfma_f32_16x16x32_bf16 v[236:239], a[44:47], v[60:63], v[236:239]
s_mov_b32 s9, 0x200000
v_exp_f32 v33, v33
v_mfma_f32_16x16x32_bf16 v[204:207], a[44:47], v[56:59], v[204:207]
ds_read_b128 a[16:19], v2 offset:12288
v_cvt_pk_bf16_f32 v66, v32, v33
v_mfma_f32_16x16x32_bf16 v[172:175], a[44:47], v[52:55], v[172:175]
buffer_load_dword a244, v8, s[64:67], s9 offen
v_mfma_f32_16x16x32_bf16 v[140:143], a[44:47], v[48:51], v[140:143]
s_mul_i32 s44, s44, -8
v_exp_f32 v34, v34
v_mfma_f32_16x16x32_bf16 v[144:147], a[48:51], v[48:51], v[144:147]
ds_read_b128 a[20:23], v2 offset:13312
s_lshl_b32 s44, 4, s44
v_mfma_f32_16x16x32_bf16 v[176:179], a[48:51], v[52:55], v[176:179]
s_mul_i32 s45, s45, -8
v_exp_f32 v35, v35
v_mfma_f32_16x16x32_bf16 v[208:211], a[48:51], v[56:59], v[208:211]
s_lshl_b32 s45, 4, s45
s_add_u32 s44, s44, 0x21212121
v_cvt_pk_bf16_f32 v67, v34, v35
v_mfma_f32_16x16x32_bf16 v[240:243], a[48:51], v[60:63], v[240:243]
ds_read_b128 a[24:27], v2 offset:14336
s_sub_u32 s44, s44, s45
v_mfma_f32_16x16x32_bf16 v[244:247], a[52:55], v[60:63], v[244:247]
s_bfe_u32 s56, s44, 0x80000
v_exp_f32 v36, v36
v_mfma_f32_16x16x32_bf16 v[212:215], a[52:55], v[56:59], v[212:215]
s_lshl_b32 s56, s56, 14
v_exp_f32 v37, v37
v_mfma_f32_16x16x32_bf16 v[180:183], a[52:55], v[52:55], v[180:183]
s_bfe_u32 s57, s44, 0x80008
v_exp_f32 v38, v38
v_mfma_f32_16x16x32_bf16 v[148:151], a[52:55], v[48:51], v[148:151]
buffer_load_dwordx4 v3, s[48:51], s32 offen offset:1024 sc1 lds
v_mfma_f32_16x16x32_bf16 v[152:155], a[56:59], v[48:51], v[152:155]
ds_read_b128 a[28:31], v2 offset:15360
v_cvt_pk_bf16_f32 v70, v36, v37
v_mfma_f32_16x16x32_bf16 v[184:187], a[56:59], v[52:55], v[184:187]
s_lshl_b32 s57, s57, 14
s_bfe_u32 s58, s44, 0x80010
s_lshl_b32 s58, s58, 14
v_mfma_f32_16x16x32_bf16 v[216:219], a[56:59], v[56:59], v[216:219]
ds_read_b128 a[32:35], v2 offset:0
s_bfe_u32 s59, s44, 0x80018
v_mfma_f32_16x16x32_bf16 v[248:251], a[56:59], v[60:63], v[248:251]
s_lshl_b32 s59, s59, 14
v_exp_f32 v39, v39
v_mfma_f32_16x16x32_bf16 v[252:255], a[60:63], v[60:63], v[252:255]
v_exp_f32 v40, v40
v_mfma_f32_16x16x32_bf16 v[220:223], a[60:63], v[56:59], v[220:223]
ds_read_b128 a[36:39], v2 offset:1024
v_cvt_pk_bf16_f32 v71, v38, v39
v_mfma_f32_16x16x32_bf16 v[188:191], a[60:63], v[52:55], v[188:191]
v_exp_f32 v41, v41
v_mfma_f32_16x16x32_bf16 v[156:159], a[60:63], v[48:51], v[156:159]
s_waitcnt lgkmcnt(6)
v_exp_f32 v42, v42
v_smfmac_f32_16x16x64_bf16 a[224:227], a[232:235], v[48:55], v9
buffer_load_dwordx4 v3, s[48:51], s32 offen offset:2048 sc1 lds
v_smfmac_f32_16x16x64_bf16 a[228:231], a[232:235], v[56:63], v9
ds_read_b128 a[40:43], v2 offset:2048
v_cvt_pk_bf16_f32 v74, v40, v41
v_mfma_f32_16x16x32_bf16 v[20:23], a[0:3], a[176:179], v[104:107]
v_mfma_f32_16x16x32_bf16 v[20:23], a[4:7], a[180:183], v[20:23]
v_exp_f32 v43, v43
v_mfma_f32_16x16x32_bf16 v[20:23], a[8:11], a[184:187], v[20:23]
ds_read_b128 a[44:47], v2 offset:3072
v_cvt_pk_bf16_f32 v75, v42, v43
v_mfma_f32_16x16x32_bf16 v[20:23], a[12:15], a[188:191], v[20:23]
v_exp_f32 v44, v44
v_mfma_f32_16x16x32_bf16 v[24:27], a[0:3], a[192:195], v[88:91]
v_exp_f32 v45, v45
v_mfma_f32_16x16x32_bf16 v[24:27], a[4:7], a[196:199], v[24:27]
ds_read_b128 a[48:51], v2 offset:4096
v_cvt_pk_bf16_f32 v78, v44, v45
v_mfma_f32_16x16x32_bf16 v[24:27], a[8:11], a[200:203], v[24:27]
v_mfma_f32_16x16x32_bf16 v[24:27], a[12:15], a[204:207], v[24:27]
v_exp_f32 v46, v46
v_mfma_f32_16x16x32_bf16 v[28:31], a[0:3], a[208:211], v[92:95]
buffer_load_dwordx4 v3, s[48:51], s32 offen offset:3072 sc1 lds
v_mfma_f32_16x16x32_bf16 v[28:31], a[4:7], a[212:215], v[28:31]
ds_read_b128 a[52:55], v2 offset:5120
v_mfma_f32_16x16x32_bf16 v[28:31], a[8:11], a[216:219], v[28:31]
v_exp_f32 v47, v47
v_mfma_f32_16x16x32_bf16 v[28:31], a[12:15], a[220:223], v[28:31]
s_waitcnt lgkmcnt(6)
v_exp_f32 v20, v20
v_mfma_f32_16x16x32_bf16 v[36:39], a[16:19], a[176:179], v[108:111]
ds_read_b128 a[56:59], v2 offset:6144
v_cvt_pk_bf16_f32 v79, v46, v47
v_mfma_f32_16x16x32_bf16 v[36:39], a[20:23], a[180:183], v[36:39]
v_exp_f32 v21, v21
v_mfma_f32_16x16x32_bf16 v[36:39], a[24:27], a[184:187], v[36:39]
v_cvt_pk_bf16_f32 v52, v20, v21
v_mfma_f32_16x16x32_bf16 v[36:39], a[28:31], a[188:191], v[36:39]
ds_read_b128 a[60:63], v2 offset:7168
v_mfma_f32_16x16x32_bf16 v[40:43], a[16:19], a[192:195], v[88:91]
s_mov_b32 s9, 0x600000
v_exp_f32 v22, v22
v_mfma_f32_16x16x32_bf16 v[40:43], a[20:23], a[196:199], v[40:43]
buffer_load_dword a244, v8, s[64:67], s9 offen
v_mfma_f32_16x16x32_bf16 v[40:43], a[24:27], a[200:203], v[40:43]
v_exp_f32 v23, v23
v_mfma_f32_16x16x32_bf16 v[40:43], a[28:31], a[204:207], v[40:43]
v_exp_f32 v24, v24
v_mfma_f32_16x16x32_bf16 v[44:47], a[16:19], a[208:211], v[92:95]
v_exp_f32 v25, v25
v_mfma_f32_16x16x32_bf16 v[44:47], a[20:23], a[212:215], v[44:47]
v_exp_f32 v26, v26
v_mfma_f32_16x16x32_bf16 v[44:47], a[24:27], a[216:219], v[44:47]
v_exp_f32 v27, v27
v_mfma_f32_16x16x32_bf16 v[44:47], a[28:31], a[220:223], v[44:47]
s_waitcnt lgkmcnt(0)
v_cvt_pk_bf16_f32 v53, v22, v23
v_mfma_f32_16x16x32_bf16 v[128:131], a[32:35], v[64:67], v[128:131]
ds_read_b128 a[0:3], v2 offset:24576
v_cvt_pk_bf16_f32 v56, v24, v25
v_mfma_f32_16x16x32_bf16 v[160:163], a[32:35], v[68:71], v[160:163]
v_exp_f32 v28, v28
v_mfma_f32_16x16x32_bf16 v[192:195], a[32:35], v[72:75], v[192:195]
ds_read_b128 a[4:7], v2 offset:25600
v_cvt_pk_bf16_f32 v57, v26, v27
v_mfma_f32_16x16x32_bf16 v[224:227], a[32:35], v[76:79], v[224:227]
s_add_u32 m0, s19, 0x1000
v_mfma_f32_16x16x32_bf16 v[228:231], a[36:39], v[76:79], v[228:231]
buffer_load_dwordx4 v3, s[48:51], s7 offen offset:0 sc1 lds
v_mfma_f32_16x16x32_bf16 v[196:199], a[36:39], v[72:75], v[196:199]
ds_read_b128 a[8:11], v2 offset:26624
v_mfma_f32_16x16x32_bf16 v[164:167], a[36:39], v[68:71], v[164:167]
v_exp_f32 v29, v29
v_mfma_f32_16x16x32_bf16 v[132:135], a[36:39], v[64:67], v[132:135]
v_exp_f32 v30, v30
v_mfma_f32_16x16x32_bf16 v[136:139], a[40:43], v[64:67], v[136:139]
ds_read_b128 a[12:15], v2 offset:27648
v_cvt_pk_bf16_f32 v60, v28, v29
v_mfma_f32_16x16x32_bf16 v[168:171], a[40:43], v[68:71], v[168:171]
v_exp_f32 v31, v31
v_mfma_f32_16x16x32_bf16 v[200:203], a[40:43], v[72:75], v[200:203]
v_exp_f32 v36, v36
v_mfma_f32_16x16x32_bf16 v[232:235], a[40:43], v[76:79], v[232:235]
ds_read_b128 a[16:19], v2 offset:28672
v_cvt_pk_bf16_f32 v61, v30, v31
v_mfma_f32_16x16x32_bf16 v[236:239], a[44:47], v[76:79], v[236:239]
buffer_load_dwordx4 v3, s[48:51], s7 offen offset:1024 sc1 lds
v_mfma_f32_16x16x32_bf16 v[204:207], a[44:47], v[72:75], v[204:207]
ds_read_b128 a[20:23], v2 offset:29696
v_mfma_f32_16x16x32_bf16 v[172:175], a[44:47], v[68:71], v[172:175]
v_mfma_f32_16x16x32_bf16 v[140:143], a[44:47], v[64:67], v[140:143]
v_exp_f32 v37, v37
v_mfma_f32_16x16x32_bf16 v[144:147], a[48:51], v[64:67], v[144:147]
ds_read_b128 a[24:27], v2 offset:30720
v_cvt_pk_bf16_f32 v54, v36, v37
v_mfma_f32_16x16x32_bf16 v[176:179], a[48:51], v[68:71], v[176:179]
v_exp_f32 v38, v38
v_mfma_f32_16x16x32_bf16 v[208:211], a[48:51], v[72:75], v[208:211]
v_exp_f32 v39, v39
v_mfma_f32_16x16x32_bf16 v[240:243], a[48:51], v[76:79], v[240:243]
ds_read_b128 a[28:31], v2 offset:31744
v_cvt_pk_bf16_f32 v55, v38, v39
v_mfma_f32_16x16x32_bf16 v[244:247], a[52:55], v[76:79], v[244:247]
v_exp_f32 v40, v40
v_mfma_f32_16x16x32_bf16 v[212:215], a[52:55], v[72:75], v[212:215]
buffer_load_dwordx4 v3, s[48:51], s7 offen offset:2048 sc1 lds
v_mfma_f32_16x16x32_bf16 v[180:183], a[52:55], v[68:71], v[180:183]
ds_read_b128 a[32:35], v2 offset:16384
v_mfma_f32_16x16x32_bf16 v[148:151], a[52:55], v[64:67], v[148:151]
v_mfma_f32_16x16x32_bf16 v[152:155], a[56:59], v[64:67], v[152:155]
ds_read_b128 a[36:39], v2 offset:17408
v_mfma_f32_16x16x32_bf16 v[184:187], a[56:59], v[68:71], v[184:187]
v_exp_f32 v41, v41
v_mfma_f32_16x16x32_bf16 v[216:219], a[56:59], v[72:75], v[216:219]
v_exp_f32 v42, v42
v_mfma_f32_16x16x32_bf16 v[248:251], a[56:59], v[76:79], v[248:251]
ds_read_b128 a[40:43], v2 offset:18432
v_cvt_pk_bf16_f32 v58, v40, v41
v_mfma_f32_16x16x32_bf16 v[252:255], a[60:63], v[76:79], v[252:255]
v_exp_f32 v43, v43
v_mfma_f32_16x16x32_bf16 v[220:223], a[60:63], v[72:75], v[220:223]
buffer_load_dwordx4 v3, s[48:51], s7 offen offset:3072 sc1 lds
v_mfma_f32_16x16x32_bf16 v[188:191], a[60:63], v[68:71], v[188:191]
ds_read_b128 a[44:47], v2 offset:19456
v_cvt_pk_bf16_f32 v59, v42, v43
v_mfma_f32_16x16x32_bf16 v[156:159], a[60:63], v[64:67], v[156:159]
v_exp_f32 v44, v44
v_smfmac_f32_16x16x64_bf16 a[224:227], a[232:235], v[64:71], v9
s_waitcnt lgkmcnt(8)
v_exp_f32 v45, v45
v_smfmac_f32_16x16x64_bf16 a[228:231], a[232:235], v[72:79], v9
ds_read_b128 a[48:51], v2 offset:20480
v_add_u32 v4, s0, v3
v_mfma_f32_16x16x32_bf16 v[24:27], a[0:3], a[192:195], v[88:91]
v_cvt_pk_bf16_f32 v62, v44, v45
v_mfma_f32_16x16x32_bf16 v[24:27], a[4:7], a[196:199], v[24:27]
ds_read_b128 a[52:55], v2 offset:21504
v_mov_b32 v5, s1
v_mfma_f32_16x16x32_bf16 v[24:27], a[8:11], a[200:203], v[24:27]
v_exp_f32 v46, v46
v_mfma_f32_16x16x32_bf16 v[24:27], a[12:15], a[204:207], v[24:27]
global_load_dword a244, v[4:5], off sc1
v_mfma_f32_16x16x32_bf16 v[28:31], a[0:3], a[208:211], v[92:95]
ds_read_b128 a[56:59], v2 offset:22528
v_mfma_f32_16x16x32_bf16 v[28:31], a[4:7], a[212:215], v[28:31]
s_add_u32 s32, s32, 0x8000
v_exp_f32 v47, v47
v_mfma_f32_16x16x32_bf16 v[28:31], a[8:11], a[216:219], v[28:31]
s_waitcnt lgkmcnt(7)
v_cvt_pk_bf16_f32 v63, v46, v47
v_mfma_f32_16x16x32_bf16 v[28:31], a[12:15], a[220:223], v[28:31]
ds_read_b128 a[60:63], v2 offset:23552
s_add_u32 s7, s7, 0x8000
v_mfma_f32_16x16x32_bf16 v[40:43], a[16:19], a[192:195], v[88:91]
s_xor_b32 s19, s19, 0x8000
v_xor_b32 v2, 0x38000, v2
v_mfma_f32_16x16x32_bf16 v[40:43], a[20:23], a[196:199], v[40:43]
s_sub_u32 s15, 7, s6
v_exp_f32 v24, v24
v_mfma_f32_16x16x32_bf16 v[40:43], a[24:27], a[200:203], v[40:43]
s_lshl_b32 s15, s15, 1
v_exp_f32 v25, v25
v_mfma_f32_16x16x32_bf16 v[40:43], a[28:31], a[204:207], v[40:43]
v_exp_f32 v26, v26
v_mfma_f32_16x16x32_bf16 v[44:47], a[16:19], a[208:211], v[92:95]
v_exp_f32 v27, v27
v_mfma_f32_16x16x32_bf16 v[44:47], a[20:23], a[212:215], v[44:47]
v_exp_f32 v28, v28
v_mfma_f32_16x16x32_bf16 v[44:47], a[24:27], a[216:219], v[44:47]
s_waitcnt vmcnt(22) lgkmcnt(0)
v_exp_f32 v29, v29
v_mfma_f32_16x16x32_bf16 v[44:47], a[28:31], a[220:223], v[44:47]
s_barrier
s_cbranch_scc0 L_att_lh0_1
v_mfma_f32_16x16x32_bf16 v[160:163], a[32:35], v[52:55], v[160:163]
ds_read_b128 a[0:3], v1 offset:8192
v_cvt_pk_bf16_f32 v72, v24, v25
v_mfma_f32_16x16x32_bf16 v[192:195], a[32:35], v[56:59], v[192:195]
v_exp_f32 v30, v30
v_mfma_f32_16x16x32_bf16 v[224:227], a[32:35], v[60:63], v[224:227]
ds_read_b128 a[4:7], v1 offset:9216
v_cvt_pk_bf16_f32 v73, v26, v27
v_mfma_f32_16x16x32_bf16 v[228:231], a[36:39], v[60:63], v[228:231]
s_add_u32 m0, s27, 0x0
v_cvt_pk_bf16_f32 v76, v28, v29
v_accvgpr_read_b32 v6, a224
v_mfma_f32_16x16x32_bf16 v[196:199], a[36:39], v[56:59], v[196:199]
buffer_load_dwordx4 v3, s[48:51], s32 offen offset:0 sc1 lds
v_mfma_f32_16x16x32_bf16 v[164:167], a[36:39], v[52:55], v[164:167]
ds_read_b128 a[8:11], v1 offset:10240
v_accvgpr_read_b32 v7, a225
v_mfma_f32_16x16x32_bf16 v[168:171], a[40:43], v[52:55], v[168:171]
ds_read_b128 a[12:15], v1 offset:11264
v_add_f32 v6, v6, v7
v_mfma_f32_16x16x32_bf16 v[200:203], a[40:43], v[56:59], v[200:203]
v_exp_f32 v31, v31
v_mfma_f32_16x16x32_bf16 v[232:235], a[40:43], v[60:63], v[232:235]
v_exp_f32 v40, v40
v_mfma_f32_16x16x32_bf16 v[236:239], a[44:47], v[60:63], v[236:239]
ds_read_b128 a[16:19], v1 offset:12288
v_cvt_pk_bf16_f32 v77, v30, v31
v_mfma_f32_16x16x32_bf16 v[204:207], a[44:47], v[56:59], v[204:207]
v_cmp_nge_f32 vcc, 0x6f800000, v6
v_mfma_f32_16x16x32_bf16 v[172:175], a[44:47], v[52:55], v[172:175]
ds_read_b128 a[20:23], v1 offset:13312
v_mfma_f32_16x16x32_bf16 v[176:179], a[48:51], v[52:55], v[176:179]
v_exp_f32 v41, v41
v_mfma_f32_16x16x32_bf16 v[208:211], a[48:51], v[56:59], v[208:211]
ds_read_b128 a[24:27], v1 offset:14336
v_cvt_pk_bf16_f32 v74, v40, v41
v_mfma_f32_16x16x32_bf16 v[240:243], a[48:51], v[60:63], v[240:243]
buffer_load_dwordx4 v3, s[48:51], s32 offen offset:1024 sc1 lds
v_mfma_f32_16x16x32_bf16 v[244:247], a[52:55], v[60:63], v[244:247]
v_exp_f32 v42, v42
v_mfma_f32_16x16x32_bf16 v[212:215], a[52:55], v[56:59], v[212:215]
ds_read_b128 a[28:31], v1 offset:15360
v_mfma_f32_16x16x32_bf16 v[180:183], a[52:55], v[52:55], v[180:183]
v_exp_f32 v43, v43
v_mfma_f32_16x16x32_bf16 v[184:187], a[56:59], v[52:55], v[184:187]
ds_read_b128 a[32:35], v1 offset:0
v_cvt_pk_bf16_f32 v75, v42, v43
v_mfma_f32_16x16x32_bf16 v[216:219], a[56:59], v[56:59], v[216:219]
v_rcp_f32 v6, v6
v_mfma_f32_16x16x32_bf16 v[248:251], a[56:59], v[60:63], v[248:251]
ds_read_b128 a[36:39], v1 offset:1024
s_or_b64 s[34:35], s[34:35], vcc
v_mfma_f32_16x16x32_bf16 v[252:255], a[60:63], v[60:63], v[252:255]
s_add_u32 s8, s28, 0x0
v_exp_f32 v44, v44
v_mfma_f32_16x16x32_bf16 v[220:223], a[60:63], v[56:59], v[220:223]
v_exp_f32 v45, v45
v_mfma_f32_16x16x32_bf16 v[188:191], a[60:63], v[52:55], v[188:191]
ds_read_b128 a[40:43], v1 offset:2048
v_cvt_pk_bf16_f32 v78, v44, v45
v_mfma_f32_16x16x32_bf16 a[224:227], a[236:239], v[52:55], a[224:227]
buffer_load_dwordx4 v3, s[48:51], s32 offen offset:2048 sc1 lds
v_smfmac_f32_16x16x64_bf16 a[228:231], a[232:235], v[56:63], v9
ds_read_b128 a[44:47], v1 offset:3072
s_waitcnt lgkmcnt(8)
v_mfma_f32_16x16x32_bf16 v[24:27], a[0:3], a[192:195], v[88:91]
v_exp_f32 v46, v46
v_mfma_f32_16x16x32_bf16 v[24:27], a[4:7], a[196:199], v[24:27]
ds_read_b128 a[48:51], v1 offset:4096
v_mul_f32 v128, v6, v128
v_mfma_f32_16x16x32_bf16 v[24:27], a[8:11], a[200:203], v[24:27]
v_mul_f32 v129, v6, v129
v_mul_f32 v130, v6, v130
v_mfma_f32_16x16x32_bf16 v[24:27], a[12:15], a[204:207], v[24:27]
v_exp_f32 v47, v47
v_mfma_f32_16x16x32_bf16 v[28:31], a[0:3], a[208:211], v[92:95]
ds_read_b128 a[52:55], v1 offset:5120
v_cvt_pk_bf16_f32 v79, v46, v47
v_mfma_f32_16x16x32_bf16 v[28:31], a[4:7], a[212:215], v[28:31]
v_mul_f32 v131, v6, v131
v_mul_f32 v132, v6, v132
v_mfma_f32_16x16x32_bf16 v[28:31], a[8:11], a[216:219], v[28:31]
ds_read_b128 a[56:59], v1 offset:6144
v_mul_f32 v133, v6, v133
v_mfma_f32_16x16x32_bf16 v[28:31], a[12:15], a[220:223], v[28:31]
s_waitcnt lgkmcnt(7)
v_exp_f32 v24, v24
v_mfma_f32_16x16x32_bf16 v[40:43], a[16:19], a[192:195], v[88:91]
buffer_load_dwordx4 v3, s[48:51], s32 offen offset:3072 sc1 lds
v_mfma_f32_16x16x32_bf16 v[40:43], a[20:23], a[196:199], v[40:43]
ds_read_b128 a[60:63], v1 offset:7168
v_mul_f32 v134, v6, v134
v_mfma_f32_16x16x32_bf16 v[40:43], a[24:27], a[200:203], v[40:43]
s_add_u32 s32, s32, 0x8000
v_exp_f32 v25, v25
v_mfma_f32_16x16x32_bf16 v[40:43], a[28:31], a[204:207], v[40:43]
v_exp_f32 v26, v26
v_mfma_f32_16x16x32_bf16 v[44:47], a[16:19], a[208:211], v[92:95]
v_exp_f32 v27, v27
v_mfma_f32_16x16x32_bf16 v[44:47], a[20:23], a[212:215], v[44:47]
v_exp_f32 v28, v28
v_mfma_f32_16x16x32_bf16 v[44:47], a[24:27], a[216:219], v[44:47]
v_exp_f32 v29, v29
v_mfma_f32_16x16x32_bf16 v[44:47], a[28:31], a[220:223], v[44:47]
s_waitcnt lgkmcnt(0)
v_mul_f32 v135, v6, v135
v_cvt_pk_bf16_f32 v128, v128, v129
v_mfma_f32_16x16x32_bf16 v[192:195], a[32:35], v[72:75], v[192:195]
s_add_u32 m0, s27, 0x1000
v_exp_f32 v30, v30
v_mfma_f32_16x16x32_bf16 v[224:227], a[32:35], v[76:79], v[224:227]
buffer_load_dwordx4 v3, s[48:51], s7 offen offset:0 sc1 lds
v_mfma_f32_16x16x32_bf16 v[228:231], a[36:39], v[76:79], v[228:231]
v_exp_f32 v31, v31
v_mfma_f32_16x16x32_bf16 v[196:199], a[36:39], v[72:75], v[196:199]
ds_read_b128 a[0:3], v1 offset:24576
v_cvt_pk_bf16_f32 v56, v24, v25
v_mfma_f32_16x16x32_bf16 v[200:203], a[40:43], v[72:75], v[200:203]
ds_read_b128 a[4:7], v1 offset:25600
v_cvt_pk_bf16_f32 v57, v26, v27
v_mfma_f32_16x16x32_bf16 v[232:235], a[40:43], v[76:79], v[232:235]
v_exp_f32 v40, v40
v_mfma_f32_16x16x32_bf16 v[236:239], a[44:47], v[76:79], v[236:239]
ds_read_b128 a[8:11], v1 offset:26624
v_cvt_pk_bf16_f32 v60, v28, v29
v_mfma_f32_16x16x32_bf16 v[204:207], a[44:47], v[72:75], v[204:207]
v_exp_f32 v41, v41
v_mfma_f32_16x16x32_bf16 v[208:211], a[48:51], v[72:75], v[208:211]
ds_read_b128 a[12:15], v1 offset:27648
v_cvt_pk_bf16_f32 v61, v30, v31
v_mfma_f32_16x16x32_bf16 v[240:243], a[48:51], v[76:79], v[240:243]
ds_read_b128 a[16:19], v1 offset:28672
v_cvt_pk_bf16_f32 v58, v40, v41
v_mfma_f32_16x16x32_bf16 v[244:247], a[52:55], v[76:79], v[244:247]
v_exp_f32 v42, v42
v_mfma_f32_16x16x32_bf16 v[212:215], a[52:55], v[72:75], v[212:215]
buffer_load_dwordx4 v3, s[48:51], s7 offen offset:1024 sc1 lds
v_mfma_f32_16x16x32_bf16 v[216:219], a[56:59], v[72:75], v[216:219]
ds_read_b128 a[20:23], v1 offset:29696
v_cvt_pk_bf16_f32 v129, v130, v131
v_mfma_f32_16x16x32_bf16 v[248:251], a[56:59], v[76:79], v[248:251]
ds_read_b128 a[24:27], v1 offset:30720
v_cvt_pk_bf16_f32 v130, v132, v133
v_mfma_f32_16x16x32_bf16 v[252:255], a[60:63], v[76:79], v[252:255]
ds_read_b128 a[28:31], v1 offset:31744
v_cvt_pk_bf16_f32 v131, v134, v135
v_mfma_f32_16x16x32_bf16 v[220:223], a[60:63], v[72:75], v[220:223]
s_waitcnt lgkmcnt(4)
v_exp_f32 v43, v43
v_smfmac_f32_16x16x64_bf16 a[228:231], a[232:235], v[72:79], v9
ds_read_b128 a[32:35], v1 offset:16384
v_cvt_pk_bf16_f32 v59, v42, v43
v_mfma_f32_16x16x32_bf16 v[24:27], a[0:3], a[192:195], v[88:91]
ds_read_b128 a[36:39], v1 offset:17408
buffer_store_dwordx4 v[128:131], v3, s[88:91], s8 offen sc1
v_mfma_f32_16x16x32_bf16 v[24:27], a[4:7], a[196:199], v[24:27]
buffer_load_dwordx4 v3, s[48:51], s7 offen offset:2048 sc1 lds
v_mfma_f32_16x16x32_bf16 v[24:27], a[8:11], a[200:203], v[24:27]
ds_read_b128 a[40:43], v1 offset:18432
v_exp_f32 v44, v44
v_mfma_f32_16x16x32_bf16 v[24:27], a[12:15], a[204:207], v[24:27]
ds_read_b128 a[44:47], v1 offset:19456
v_exp_f32 v45, v45
v_mfma_f32_16x16x32_bf16 v[28:31], a[0:3], a[208:211], v[92:95]
ds_read_b128 a[48:51], v1 offset:20480
v_exp_f32 v46, v46
v_mfma_f32_16x16x32_bf16 v[28:31], a[4:7], a[212:215], v[28:31]
s_waitcnt lgkmcnt(5)
v_exp_f32 v47, v47
v_mfma_f32_16x16x32_bf16 v[28:31], a[8:11], a[216:219], v[28:31]
ds_read_b128 a[52:55], v1 offset:21504
v_cvt_pk_bf16_f32 v62, v44, v45
v_mfma_f32_16x16x32_bf16 v[28:31], a[12:15], a[220:223], v[28:31]
ds_read_b128 a[56:59], v1 offset:22528
v_cvt_pk_bf16_f32 v63, v46, v47
v_mfma_f32_16x16x32_bf16 v[40:43], a[16:19], a[192:195], v[88:91]
ds_read_b128 a[60:63], v1 offset:23552
v_xor_b32 v1, 0x8000, v1
v_mfma_f32_16x16x32_bf16 v[40:43], a[20:23], a[196:199], v[40:43]
buffer_load_dwordx4 v3, s[48:51], s7 offen offset:3072 sc1 lds
v_mfma_f32_16x16x32_bf16 v[40:43], a[24:27], a[200:203], v[40:43]
s_add_u32 s7, s7, 0x8000
v_exp_f32 v24, v24
v_mfma_f32_16x16x32_bf16 v[40:43], a[28:31], a[204:207], v[40:43]
s_xor_b32 s27, s27, 0x38000
v_exp_f32 v25, v25
v_mfma_f32_16x16x32_bf16 v[44:47], a[16:19], a[208:211], v[92:95]
s_add_u32 s8, s28, 0x2000
v_exp_f32 v26, v26
v_mfma_f32_16x16x32_bf16 v[44:47], a[20:23], a[212:215], v[44:47]
v_exp_f32 v27, v27
v_mfma_f32_16x16x32_bf16 v[44:47], a[24:27], a[216:219], v[44:47]
s_waitcnt vmcnt(19) lgkmcnt(0)
v_exp_f32 v28, v28
v_mfma_f32_16x16x32_bf16 v[44:47], a[28:31], a[220:223], v[44:47]
s_barrier
v_exp_f32 v29, v29
v_mul_f32 v136, v6, v136
v_mul_f32 v137, v6, v137
v_mul_f32 v138, v6, v138
v_mul_f32 v139, v6, v139
v_mul_f32 v140, v6, v140
v_mul_f32 v141, v6, v141
v_mul_f32 v142, v6, v142
v_mul_f32 v143, v6, v143
v_cvt_pk_bf16_f32 v136, v136, v137
v_cvt_pk_bf16_f32 v137, v138, v139
v_cvt_pk_bf16_f32 v138, v140, v141
v_cvt_pk_bf16_f32 v139, v142, v143
buffer_store_dwordx4 v[136:139], v3, s[88:91], s8 offen sc1
s_add_u32 s8, s28, 0x4000
v_mul_f32 v144, v6, v144
v_mul_f32 v145, v6, v145
v_mul_f32 v146, v6, v146
v_mul_f32 v147, v6, v147
v_mul_f32 v148, v6, v148
v_mul_f32 v149, v6, v149
v_mul_f32 v150, v6, v150
v_mul_f32 v151, v6, v151
v_cvt_pk_bf16_f32 v144, v144, v145
v_cvt_pk_bf16_f32 v145, v146, v147
v_cvt_pk_bf16_f32 v146, v148, v149
v_cvt_pk_bf16_f32 v147, v150, v151
buffer_store_dwordx4 v[144:147], v3, s[88:91], s8 offen sc1
s_add_u32 s8, s28, 0x6000
v_mul_f32 v152, v6, v152
v_mul_f32 v153, v6, v153
v_mul_f32 v154, v6, v154
v_mul_f32 v155, v6, v155
v_mul_f32 v156, v6, v156
v_mul_f32 v157, v6, v157
v_mul_f32 v158, v6, v158
v_mul_f32 v159, v6, v159
v_cvt_pk_bf16_f32 v152, v152, v153
v_cvt_pk_bf16_f32 v153, v154, v155
v_cvt_pk_bf16_f32 v154, v156, v157
v_cvt_pk_bf16_f32 v155, v158, v159
buffer_store_dwordx4 v[152:155], v3, s[88:91], s8 offen sc1
v_accvgpr_read_b32 v6, a226
v_accvgpr_read_b32 v7, a227
v_add_f32 v6, v6, v7
v_cmp_nge_f32 vcc, 0x6f800000, v6
v_rcp_f32 v6, v6
s_or_b64 s[34:35], s[34:35], vcc
s_add_u32 s8, s29, 0x0
v_pk_mul_f32 v[160:161], v[160:161], v[6:7] op_sel_hi:[1,0]
v_pk_mul_f32 v[162:163], v[162:163], v[6:7] op_sel_hi:[1,0]
v_pk_mul_f32 v[164:165], v[164:165], v[6:7] op_sel_hi:[1,0]
v_pk_mul_f32 v[166:167], v[166:167], v[6:7] op_sel_hi:[1,0]
v_cvt_pk_bf16_f32 v160, v160, v161
v_cvt_pk_bf16_f32 v161, v162, v163
v_cvt_pk_bf16_f32 v162, v164, v165
v_cvt_pk_bf16_f32 v163, v166, v167
buffer_store_dwordx4 v[160:163], v3, s[88:91], s8 offen sc1
s_add_u32 s8, s29, 0x2000
v_pk_mul_f32 v[168:169], v[168:169], v[6:7] op_sel_hi:[1,0]
v_pk_mul_f32 v[170:171], v[170:171], v[6:7] op_sel_hi:[1,0]
v_pk_mul_f32 v[172:173], v[172:173], v[6:7] op_sel_hi:[1,0]
v_pk_mul_f32 v[174:175], v[174:175], v[6:7] op_sel_hi:[1,0]
v_cvt_pk_bf16_f32 v168, v168, v169
v_cvt_pk_bf16_f32 v169, v170, v171
v_cvt_pk_bf16_f32 v170, v172, v173
v_cvt_pk_bf16_f32 v171, v174, v175
buffer_store_dwordx4 v[168:171], v3, s[88:91], s8 offen sc1
s_add_u32 s8, s29, 0x4000
v_pk_mul_f32 v[176:177], v[176:177], v[6:7] op_sel_hi:[1,0]
v_pk_mul_f32 v[178:179], v[178:179], v[6:7] op_sel_hi:[1,0]
v_pk_mul_f32 v[180:181], v[180:181], v[6:7] op_sel_hi:[1,0]
v_pk_mul_f32 v[182:183], v[182:183], v[6:7] op_sel_hi:[1,0]
v_cvt_pk_bf16_f32 v176, v176, v177
v_cvt_pk_bf16_f32 v177, v178, v179
v_cvt_pk_bf16_f32 v178, v180, v181
v_cvt_pk_bf16_f32 v179, v182, v183
buffer_store_dwordx4 v[176:179], v3, s[88:91], s8 offen sc1
s_add_u32 s8, s29, 0x6000
v_pk_mul_f32 v[184:185], v[184:185], v[6:7] op_sel_hi:[1,0]
v_pk_mul_f32 v[186:187], v[186:187], v[6:7] op_sel_hi:[1,0]
v_pk_mul_f32 v[188:189], v[188:189], v[6:7] op_sel_hi:[1,0]
v_pk_mul_f32 v[190:191], v[190:191], v[6:7] op_sel_hi:[1,0]
v_cvt_pk_bf16_f32 v184, v184, v185
v_cvt_pk_bf16_f32 v185, v186, v187
v_cvt_pk_bf16_f32 v186, v188, v189
v_cvt_pk_bf16_f32 v187, v190, v191
buffer_store_dwordx4 v[184:187], v3, s[88:91], s8 offen sc1
s_getreg_b32 s8, hwreg(HW_REG_HW_ID, 5, 1)
s_cmp_lg_u32 s8, 0
s_cbranch_scc1 L_att_sodd1
s_branch L_att_sodd0
L_att_lh0_1:
v_mfma_f32_16x16x32_bf16 v[160:163], a[32:35], v[52:55], v[160:163]
ds_read_b128 a[0:3], v1 offset:8192
v_cvt_pk_bf16_f32 v72, v24, v25
v_mfma_f32_16x16x32_bf16 v[192:195], a[32:35], v[56:59], v[192:195]
v_exp_f32 v30, v30
v_mfma_f32_16x16x32_bf16 v[224:227], a[32:35], v[60:63], v[224:227]
buffer_load_dword v14, v15, s[84:87], 0 offen offset:192 sc1
v_mfma_f32_16x16x32_bf16 v[228:231], a[36:39], v[60:63], v[228:231]
ds_read_b128 a[4:7], v1 offset:9216
v_cvt_pk_bf16_f32 v73, v26, v27
v_mfma_f32_16x16x32_bf16 v[196:199], a[36:39], v[56:59], v[196:199]
ds_read_b128 a[8:11], v1 offset:10240
v_cvt_pk_bf16_f32 v76, v28, v29
v_mfma_f32_16x16x32_bf16 v[164:167], a[36:39], v[52:55], v[164:167]
s_add_u32 m0, s17, 0x10000
v_exp_f32 v31, v31
v_mfma_f32_16x16x32_bf16 v[168:171], a[40:43], v[52:55], v[168:171]
buffer_load_dwordx4 v12, s[72:75], 0 offen lds
v_mfma_f32_16x16x32_bf16 v[200:203], a[40:43], v[56:59], v[200:203]
ds_read_b128 a[12:15], v1 offset:11264
v_cvt_pk_bf16_f32 v77, v30, v31
v_mfma_f32_16x16x32_bf16 v[232:235], a[40:43], v[60:63], v[232:235]
v_exp_f32 v40, v40
v_mfma_f32_16x16x32_bf16 v[236:239], a[44:47], v[60:63], v[236:239]
ds_read_b128 a[16:19], v1 offset:12288
v_mfma_f32_16x16x32_bf16 v[204:207], a[44:47], v[56:59], v[204:207]
v_exp_f32 v41, v41
v_mfma_f32_16x16x32_bf16 v[172:175], a[44:47], v[52:55], v[172:175]
buffer_load_dwordx4 v13, s[72:75], 0 offen offset:1024 lds
v_mfma_f32_16x16x32_bf16 v[176:179], a[48:51], v[52:55], v[176:179]
ds_read_b128 a[20:23], v1 offset:13312
v_cvt_pk_bf16_f32 v74, v40, v41
v_mfma_f32_16x16x32_bf16 v[208:211], a[48:51], v[56:59], v[208:211]
ds_read_b128 a[24:27], v1 offset:14336
v_mfma_f32_16x16x32_bf16 v[240:243], a[48:51], v[60:63], v[240:243]
v_exp_f32 v42, v42
v_mfma_f32_16x16x32_bf16 v[244:247], a[52:55], v[60:63], v[244:247]
buffer_load_dwordx4 v12, s[72:75], s12 offen offset:2048 lds
v_mfma_f32_16x16x32_bf16 v[212:215], a[52:55], v[56:59], v[212:215]
ds_read_b128 a[28:31], v1 offset:15360
v_mfma_f32_16x16x32_bf16 v[180:183], a[52:55], v[52:55], v[180:183]
v_exp_f32 v43, v43
v_mfma_f32_16x16x32_bf16 v[184:187], a[56:59], v[52:55], v[184:187]
ds_read_b128 a[32:35], v1 offset:0
v_cvt_pk_bf16_f32 v75, v42, v43
v_mfma_f32_16x16x32_bf16 v[216:219], a[56:59], v[56:59], v[216:219]
v_exp_f32 v44, v44
v_mfma_f32_16x16x32_bf16 v[248:251], a[56:59], v[60:63], v[248:251]
buffer_load_dwordx4 v13, s[72:75], s12 offen offset:3072 lds
v_mfma_f32_16x16x32_bf16 v[252:255], a[60:63], v[60:63], v[252:255]
ds_read_b128 a[36:39], v1 offset:1024
v_mfma_f32_16x16x32_bf16 v[220:223], a[60:63], v[56:59], v[220:223]
s_add_u32 m0, s17, 0x14000
v_exp_f32 v45, v45
v_mfma_f32_16x16x32_bf16 v[188:191], a[60:63], v[52:55], v[188:191]
ds_read_b128 a[40:43], v1 offset:2048
v_add_u32 v12, 0x20000, v12
v_mfma_f32_16x16x32_bf16 a[224:227], a[236:239], v[52:55], a[224:227]
buffer_load_dwordx4 v12, s[72:75], 0 offen lds
v_smfmac_f32_16x16x64_bf16 a[228:231], a[232:235], v[56:63], v9
ds_read_b128 a[44:47], v1 offset:3072
s_waitcnt lgkmcnt(8)
v_mfma_f32_16x16x32_bf16 v[24:27], a[0:3], a[192:195], v[88:91]
v_exp_f32 v46, v46
v_mfma_f32_16x16x32_bf16 v[24:27], a[4:7], a[196:199], v[24:27]
ds_read_b128 a[48:51], v1 offset:4096
v_add_u32 v13, 0x20000, v13
v_mfma_f32_16x16x32_bf16 v[24:27], a[8:11], a[200:203], v[24:27]
buffer_load_dwordx4 v13, s[72:75], 0 offen offset:1024 lds
v_mfma_f32_16x16x32_bf16 v[24:27], a[12:15], a[204:207], v[24:27]
v_exp_f32 v47, v47
v_mfma_f32_16x16x32_bf16 v[28:31], a[0:3], a[208:211], v[92:95]
ds_read_b128 a[52:55], v1 offset:5120
v_cvt_pk_bf16_f32 v78, v44, v45
v_mfma_f32_16x16x32_bf16 v[28:31], a[4:7], a[212:215], v[28:31]
s_waitcnt lgkmcnt(6)
v_cvt_pk_bf16_f32 v79, v46, v47
v_mfma_f32_16x16x32_bf16 v[28:31], a[8:11], a[216:219], v[28:31]
ds_read_b128 a[56:59], v1 offset:6144
v_mfma_f32_16x16x32_bf16 v[28:31], a[12:15], a[220:223], v[28:31]
buffer_load_dwordx4 v12, s[72:75], s12 offen offset:2048 lds
v_mfma_f32_16x16x32_bf16 v[40:43], a[16:19], a[192:195], v[88:91]
ds_read_b128 a[60:63], v1 offset:7168
v_mfma_f32_16x16x32_bf16 v[40:43], a[20:23], a[196:199], v[40:43]
v_exp_f32 v24, v24
v_mfma_f32_16x16x32_bf16 v[40:43], a[24:27], a[200:203], v[40:43]
v_exp_f32 v25, v25
v_mfma_f32_16x16x32_bf16 v[40:43], a[28:31], a[204:207], v[40:43]
buffer_load_dwordx4 v13, s[72:75], s12 offen offset:3072 lds
v_mfma_f32_16x16x32_bf16 v[44:47], a[16:19], a[208:211], v[92:95]
v_exp_f32 v26, v26
v_mfma_f32_16x16x32_bf16 v[44:47], a[20:23], a[212:215], v[44:47]
v_exp_f32 v27, v27
v_mfma_f32_16x16x32_bf16 v[44:47], a[24:27], a[216:219], v[44:47]
v_exp_f32 v28, v28
v_mfma_f32_16x16x32_bf16 v[44:47], a[28:31], a[220:223], v[44:47]
s_waitcnt lgkmcnt(0)
v_exp_f32 v29, v29
v_mfma_f32_16x16x32_bf16 v[192:195], a[32:35], v[72:75], v[192:195]
s_add_u32 m0, s16, 0x0
v_add_u32 v12, 0x20000, v12
v_cvt_pk_bf16_f32 v56, v24, v25
v_mfma_f32_16x16x32_bf16 v[224:227], a[32:35], v[76:79], v[224:227]
buffer_load_dwordx4 v12, s[72:75], 0 offen lds
v_mfma_f32_16x16x32_bf16 v[228:231], a[36:39], v[76:79], v[228:231]
ds_read_b128 a[0:3], v1 offset:24576
v_cvt_pk_bf16_f32 v57, v26, v27
v_mfma_f32_16x16x32_bf16 v[196:199], a[36:39], v[72:75], v[196:199]
v_exp_f32 v30, v30
v_mfma_f32_16x16x32_bf16 v[200:203], a[40:43], v[72:75], v[200:203]
ds_read_b128 a[4:7], v1 offset:25600
v_cvt_pk_bf16_f32 v60, v28, v29
v_mfma_f32_16x16x32_bf16 v[232:235], a[40:43], v[76:79], v[232:235]
ds_read_b128 a[8:11], v1 offset:26624
v_add_u32 v13, 0x20000, v13
v_mfma_f32_16x16x32_bf16 v[236:239], a[44:47], v[76:79], v[236:239]
buffer_load_dwordx4 v13, s[72:75], 0 offen offset:1024 lds
v_mfma_f32_16x16x32_bf16 v[204:207], a[44:47], v[72:75], v[204:207]
ds_read_b128 a[12:15], v1 offset:27648
v_exp_f32 v31, v31
v_mfma_f32_16x16x32_bf16 v[208:211], a[48:51], v[72:75], v[208:211]
buffer_load_dwordx4 v12, s[72:75], s12 offen offset:2048 lds
v_mfma_f32_16x16x32_bf16 v[240:243], a[48:51], v[76:79], v[240:243]
ds_read_b128 a[16:19], v1 offset:28672
v_exp_f32 v40, v40
v_mfma_f32_16x16x32_bf16 v[244:247], a[52:55], v[76:79], v[244:247]
ds_read_b128 a[20:23], v1 offset:29696
v_cvt_pk_bf16_f32 v61, v30, v31
v_mfma_f32_16x16x32_bf16 v[212:215], a[52:55], v[72:75], v[212:215]
buffer_load_dwordx4 v13, s[72:75], s12 offen offset:3072 lds
v_mfma_f32_16x16x32_bf16 v[216:219], a[56:59], v[72:75], v[216:219]
ds_read_b128 a[24:27], v1 offset:30720
v_exp_f32 v41, v41
v_mfma_f32_16x16x32_bf16 v[248:251], a[56:59], v[76:79], v[248:251]
ds_read_b128 a[28:31], v1 offset:31744
v_exp_f32 v42, v42
v_mfma_f32_16x16x32_bf16 v[252:255], a[60:63], v[76:79], v[252:255]
ds_read_b128 a[32:35], v1 offset:16384
v_cvt_pk_bf16_f32 v58, v40, v41
v_mfma_f32_16x16x32_bf16 v[220:223], a[60:63], v[72:75], v[220:223]
s_waitcnt lgkmcnt(5)
v_exp_f32 v43, v43
v_smfmac_f32_16x16x64_bf16 a[228:231], a[232:235], v[72:79], v9
ds_read_b128 a[36:39], v1 offset:17408
v_add_u32 v12, 0x20000, v12
v_mfma_f32_16x16x32_bf16 v[24:27], a[0:3], a[192:195], v[112:115]
s_add_u32 m0, s16, 0x4000
v_exp_f32 v44, v44
v_mfma_f32_16x16x32_bf16 v[24:27], a[4:7], a[196:199], v[24:27]
buffer_load_dwordx4 v12, s[72:75], 0 offen lds
v_mfma_f32_16x16x32_bf16 v[24:27], a[8:11], a[200:203], v[24:27]
ds_read_b128 a[40:43], v1 offset:18432
v_add_u32 v13, 0x20000, v13
v_mfma_f32_16x16x32_bf16 v[24:27], a[12:15], a[204:207], v[24:27]
buffer_load_dwordx4 v13, s[72:75], 0 offen offset:1024 lds
v_mfma_f32_16x16x32_bf16 v[28:31], a[0:3], a[208:211], v[92:95]
ds_read_b128 a[44:47], v1 offset:19456
v_cvt_pk_bf16_f32 v59, v42, v43
v_mfma_f32_16x16x32_bf16 v[28:31], a[4:7], a[212:215], v[28:31]
ds_read_b128 a[48:51], v1 offset:20480
v_exp_f32 v45, v45
v_mfma_f32_16x16x32_bf16 v[28:31], a[8:11], a[216:219], v[28:31]
s_waitcnt lgkmcnt(5)
v_exp_f32 v46, v46
v_mfma_f32_16x16x32_bf16 v[28:31], a[12:15], a[220:223], v[28:31]
buffer_load_dwordx4 v12, s[72:75], s12 offen offset:2048 lds
v_mfma_f32_16x16x32_bf16 v[40:43], a[16:19], a[192:195], v[116:119]
ds_read_b128 a[52:55], v1 offset:21504
v_exp_f32 v47, v47
v_mfma_f32_16x16x32_bf16 v[40:43], a[20:23], a[196:199], v[40:43]
ds_read_b128 a[56:59], v1 offset:22528
v_exp_f32 v24, v24
v_mfma_f32_16x16x32_bf16 v[40:43], a[24:27], a[200:203], v[40:43]
ds_read_b128 a[60:63], v1 offset:23552
v_xor_b32 v1, 0x8000, v1
v_mfma_f32_16x16x32_bf16 v[40:43], a[28:31], a[204:207], v[40:43]
v_exp_f32 v25, v25
v_cvt_pk_bf16_f32 v62, v44, v45
v_cvt_pk_bf16_f32 v63, v46, v47
v_mfma_f32_16x16x32_bf16 v[44:47], a[16:19], a[208:211], v[92:95]
v_exp_f32 v26, v26
v_mfma_f32_16x16x32_bf16 v[44:47], a[20:23], a[212:215], v[44:47]
buffer_load_dwordx4 v13, s[72:75], s12 offen offset:3072 lds
v_mfma_f32_16x16x32_bf16 v[44:47], a[24:27], a[216:219], v[44:47]
v_exp_f32 v27, v27
v_mfma_f32_16x16x32_bf16 v[44:47], a[28:31], a[220:223], v[44:47]
v_exp_f32 v28, v28
v_exp_f32 v29, v29
v_accvgpr_read_b32 v6, a224
v_accvgpr_read_b32 v7, a225
v_add_f32 v6, v6, v7
v_cmp_nge_f32 vcc, 0x6f800000, v6
v_rcp_f32 v6, v6
s_or_b64 s[34:35], s[34:35], vcc
s_add_u32 s8, s28, 0x0
v_pk_mul_f32 v[128:129], v[128:129], v[6:7] op_sel_hi:[1,0]
v_pk_mul_f32 v[130:131], v[130:131], v[6:7] op_sel_hi:[1,0]
v_pk_mul_f32 v[132:133], v[132:133], v[6:7] op_sel_hi:[1,0]
v_pk_mul_f32 v[134:135], v[134:135], v[6:7] op_sel_hi:[1,0]
v_cvt_pk_bf16_f32 v128, v128, v129
v_cvt_pk_bf16_f32 v129, v130, v131
v_cvt_pk_bf16_f32 v130, v132, v133
v_cvt_pk_bf16_f32 v131, v134, v135
buffer_store_dwordx4 v[128:131], v3, s[88:91], s8 offen sc1
s_add_u32 s8, s28, 0x2000
v_pk_mul_f32 v[136:137], v[136:137], v[6:7] op_sel_hi:[1,0]
v_pk_mul_f32 v[138:139], v[138:139], v[6:7] op_sel_hi:[1,0]
v_pk_mul_f32 v[140:141], v[140:141], v[6:7] op_sel_hi:[1,0]
v_pk_mul_f32 v[142:143], v[142:143], v[6:7] op_sel_hi:[1,0]
v_cvt_pk_bf16_f32 v136, v136, v137
v_cvt_pk_bf16_f32 v137, v138, v139
v_cvt_pk_bf16_f32 v138, v140, v141
v_cvt_pk_bf16_f32 v139, v142, v143
buffer_store_dwordx4 v[136:139], v3, s[88:91], s8 offen sc1
s_add_u32 s8, s28, 0x4000
v_pk_mul_f32 v[144:145], v[144:145], v[6:7] op_sel_hi:[1,0]
v_pk_mul_f32 v[146:147], v[146:147], v[6:7] op_sel_hi:[1,0]
v_pk_mul_f32 v[148:149], v[148:149], v[6:7] op_sel_hi:[1,0]
v_pk_mul_f32 v[150:151], v[150:151], v[6:7] op_sel_hi:[1,0]
v_cvt_pk_bf16_f32 v144, v144, v145
v_cvt_pk_bf16_f32 v145, v146, v147
v_cvt_pk_bf16_f32 v146, v148, v149
v_cvt_pk_bf16_f32 v147, v150, v151
buffer_store_dwordx4 v[144:147], v3, s[88:91], s8 offen sc1
s_add_u32 s8, s28, 0x6000
v_pk_mul_f32 v[152:153], v[152:153], v[6:7] op_sel_hi:[1,0]
v_pk_mul_f32 v[154:155], v[154:155], v[6:7] op_sel_hi:[1,0]
v_pk_mul_f32 v[156:157], v[156:157], v[6:7] op_sel_hi:[1,0]
v_pk_mul_f32 v[158:159], v[158:159], v[6:7] op_sel_hi:[1,0]
v_cvt_pk_bf16_f32 v152, v152, v153
v_cvt_pk_bf16_f32 v153, v154, v155
v_cvt_pk_bf16_f32 v154, v156, v157
v_cvt_pk_bf16_f32 v155, v158, v159
buffer_store_dwordx4 v[152:155], v3, s[88:91], s8 offen sc1
v_accvgpr_read_b32 v6, a226
v_accvgpr_read_b32 v7, a227
v_add_f32 v6, v6, v7
v_cmp_nge_f32 vcc, 0x6f800000, v6
v_rcp_f32 v6, v6
s_or_b64 s[34:35], s[34:35], vcc
s_add_u32 s8, s29, 0x0
v_pk_mul_f32 v[160:161], v[160:161], v[6:7] op_sel_hi:[1,0]
v_pk_mul_f32 v[162:163], v[162:163], v[6:7] op_sel_hi:[1,0]
v_pk_mul_f32 v[164:165], v[164:165], v[6:7] op_sel_hi:[1,0]
v_pk_mul_f32 v[166:167], v[166:167], v[6:7] op_sel_hi:[1,0]
v_cvt_pk_bf16_f32 v160, v160, v161
v_cvt_pk_bf16_f32 v161, v162, v163
v_cvt_pk_bf16_f32 v162, v164, v165
v_cvt_pk_bf16_f32 v163, v166, v167
buffer_store_dwordx4 v[160:163], v3, s[88:91], s8 offen sc1
s_add_u32 s8, s29, 0x2000
v_pk_mul_f32 v[168:169], v[168:169], v[6:7] op_sel_hi:[1,0]
v_pk_mul_f32 v[170:171], v[170:171], v[6:7] op_sel_hi:[1,0]
v_pk_mul_f32 v[172:173], v[172:173], v[6:7] op_sel_hi:[1,0]
v_pk_mul_f32 v[174:175], v[174:175], v[6:7] op_sel_hi:[1,0]
v_cvt_pk_bf16_f32 v168, v168, v169
v_cvt_pk_bf16_f32 v169, v170, v171
v_cvt_pk_bf16_f32 v170, v172, v173
v_cvt_pk_bf16_f32 v171, v174, v175
buffer_store_dwordx4 v[168:171], v3, s[88:91], s8 offen sc1
s_add_u32 s8, s29, 0x4000
v_pk_mul_f32 v[176:177], v[176:177], v[6:7] op_sel_hi:[1,0]
v_pk_mul_f32 v[178:179], v[178:179], v[6:7] op_sel_hi:[1,0]
v_pk_mul_f32 v[180:181], v[180:181], v[6:7] op_sel_hi:[1,0]
v_pk_mul_f32 v[182:183], v[182:183], v[6:7] op_sel_hi:[1,0]
v_cvt_pk_bf16_f32 v176, v176, v177
v_cvt_pk_bf16_f32 v177, v178, v179
v_cvt_pk_bf16_f32 v178, v180, v181
v_cvt_pk_bf16_f32 v179, v182, v183
buffer_store_dwordx4 v[176:179], v3, s[88:91], s8 offen sc1
s_add_u32 s8, s29, 0x6000
v_pk_mul_f32 v[184:185], v[184:185], v[6:7] op_sel_hi:[1,0]
v_pk_mul_f32 v[186:187], v[186:187], v[6:7] op_sel_hi:[1,0]
v_pk_mul_f32 v[188:189], v[188:189], v[6:7] op_sel_hi:[1,0]
v_pk_mul_f32 v[190:191], v[190:191], v[6:7] op_sel_hi:[1,0]
v_cvt_pk_bf16_f32 v184, v184, v185
v_cvt_pk_bf16_f32 v185, v186, v187
v_cvt_pk_bf16_f32 v186, v188, v189
v_cvt_pk_bf16_f32 v187, v190, v191
buffer_store_dwordx4 v[184:187], v3, s[88:91], s8 offen sc1
s_branch L_att_h1_1
L_att_j0:
s_cmp_ge_u32 s4, 2
s_cbranch_scc1 L_att_nl0_1
L_att_nl0_0:
v_mfma_f32_16x16x32_bf16 v[16:19], a[0:3], a[160:163], v[96:99]
ds_read_b128 a[128:131], v1 offset:24576
v_mov_b32 v240, 0
v_mfma_f32_16x16x32_bf16 v[16:19], a[4:7], a[164:167], v[16:19]
ds_read_b128 a[132:135], v1 offset:25600
s_add_u32 m0, s27, 0x0
v_mfma_f32_16x16x32_bf16 v[16:19], a[8:11], a[168:171], v[16:19]
buffer_load_dwordx4 v3, s[48:51], s32 offen offset:0 sc1 lds
v_mfma_f32_16x16x32_bf16 v[16:19], a[12:15], a[172:175], v[16:19]
ds_read_b128 a[136:139], v1 offset:26624
v_mov_b32 v241, 0
v_mfma_f32_16x16x32_bf16 v[20:23], a[0:3], a[176:179], v[84:87]
ds_read_b128 a[140:143], v1 offset:27648
v_mov_b32 v242, 0
v_mfma_f32_16x16x32_bf16 v[20:23], a[4:7], a[180:183], v[20:23]
ds_read_b128 a[144:147], v1 offset:28672
v_mov_b32 v243, 0
v_mfma_f32_16x16x32_bf16 v[20:23], a[8:11], a[184:187], v[20:23]
ds_read_b128 a[148:151], v1 offset:29696
v_mov_b32 v244, 0
v_mfma_f32_16x16x32_bf16 v[20:23], a[12:15], a[188:191], v[20:23]
buffer_load_dwordx4 v3, s[48:51], s32 offen offset:1024 sc1 lds
v_mfma_f32_16x16x32_bf16 v[24:27], a[0:3], a[192:195], v[88:91]
ds_read_b128 a[152:155], v1 offset:30720
v_mov_b32 v245, 0
v_mfma_f32_16x16x32_bf16 v[24:27], a[4:7], a[196:199], v[24:27]
ds_read_b128 a[156:159], v1 offset:31744
v_exp_f32 v16, v16
v_mfma_f32_16x16x32_bf16 v[24:27], a[8:11], a[200:203], v[24:27]
v_exp_f32 v17, v17
v_mfma_f32_16x16x32_bf16 v[24:27], a[12:15], a[204:207], v[24:27]
v_exp_f32 v18, v18
v_mfma_f32_16x16x32_bf16 v[28:31], a[0:3], a[208:211], v[92:95]
buffer_load_dwordx4 v3, s[48:51], s32 offen offset:2048 sc1 lds
v_mfma_f32_16x16x32_bf16 v[28:31], a[4:7], a[212:215], v[28:31]
v_exp_f32 v19, v19
v_mfma_f32_16x16x32_bf16 v[28:31], a[8:11], a[216:219], v[28:31]
v_exp_f32 v20, v20
v_mfma_f32_16x16x32_bf16 v[28:31], a[12:15], a[220:223], v[28:31]
v_exp_f32 v21, v21
v_mfma_f32_16x16x32_bf16 v[32:35], a[16:19], a[160:163], v[100:103]
v_exp_f32 v22, v22
v_mfma_f32_16x16x32_bf16 v[32:35], a[20:23], a[164:167], v[32:35]
buffer_load_dwordx4 v3, s[48:51], s32 offen offset:3072 sc1 lds
v_mfma_f32_16x16x32_bf16 v[32:35], a[24:27], a[168:171], v[32:35]
v_exp_f32 v23, v23
v_mfma_f32_16x16x32_bf16 v[32:35], a[28:31], a[172:175], v[32:35]
v_exp_f32 v24, v24
v_mfma_f32_16x16x32_bf16 v[36:39], a[16:19], a[176:179], v[84:87]
v_exp_f32 v25, v25
v_mfma_f32_16x16x32_bf16 v[36:39], a[20:23], a[180:183], v[36:39]
s_add_u32 m0, s27, 0x1000
v_exp_f32 v26, v26
v_mfma_f32_16x16x32_bf16 v[36:39], a[24:27], a[184:187], v[36:39]
buffer_load_dwordx4 v3, s[48:51], s7 offen offset:0 sc1 lds
v_mfma_f32_16x16x32_bf16 v[36:39], a[28:31], a[188:191], v[36:39]
v_exp_f32 v27, v27
v_mfma_f32_16x16x32_bf16 v[40:43], a[16:19], a[192:195], v[88:91]
v_exp_f32 v28, v28
v_mfma_f32_16x16x32_bf16 v[40:43], a[20:23], a[196:199], v[40:43]
v_exp_f32 v29, v29
v_mfma_f32_16x16x32_bf16 v[40:43], a[24:27], a[200:203], v[40:43]
v_exp_f32 v30, v30
v_mfma_f32_16x16x32_bf16 v[40:43], a[28:31], a[204:207], v[40:43]
buffer_load_dwordx4 v3, s[48:51], s7 offen offset:1024 sc1 lds
v_mfma_f32_16x16x32_bf16 v[44:47], a[16:19], a[208:211], v[92:95]
v_exp_f32 v31, v31
v_mfma_f32_16x16x32_bf16 v[44:47], a[20:23], a[212:215], v[44:47]
v_exp_f32 v32, v32
v_mfma_f32_16x16x32_bf16 v[44:47], a[24:27], a[216:219], v[44:47]
v_exp_f32 v33, v33
v_mfma_f32_16x16x32_bf16 v[44:47], a[28:31], a[220:223], v[44:47]
s_waitcnt lgkmcnt(0)
v_cvt_pk_bf16_f32 v48, v16, v17
v_cvt_pk_bf16_f32 v49, v18, v19
v_cvt_pk_bf16_f32 v52, v20, v21
v_cvt_pk_bf16_f32 v53, v22, v23
v_cvt_pk_bf16_f32 v56, v24, v25
v_cvt_pk_bf16_f32 v57, v26, v27
v_mov_b32 v246, 0
v_mov_b32 v247, 0
v_mfma_f32_16x16x32_bf16 v[20:23], a[128:131], a[176:179], v[84:87]
ds_read_b128 a[32:35], v1 offset:16384
v_cvt_pk_bf16_f32 v60, v28, v29
v_mfma_f32_16x16x32_bf16 v[20:23], a[132:135], a[180:183], v[20:23]
buffer_load_dwordx4 v3, s[48:51], s7 offen offset:2048 sc1 lds
v_mfma_f32_16x16x32_bf16 v[20:23], a[136:139], a[184:187], v[20:23]
v_exp_f32 v34, v34
v_mfma_f32_16x16x32_bf16 v[20:23], a[140:143], a[188:191], v[20:23]
buffer_load_dwordx4 v3, s[48:51], s7 offen offset:3072 sc1 lds
v_mfma_f32_16x16x32_bf16 v[24:27], a[128:131], a[192:195], v[88:91]
ds_read_b128 a[36:39], v1 offset:17408
v_cvt_pk_bf16_f32 v61, v30, v31
v_mfma_f32_16x16x32_bf16 v[24:27], a[132:135], a[196:199], v[24:27]
ds_read_b128 a[40:43], v1 offset:18432
v_cvt_pk_bf16_f32 v50, v32, v33
v_mfma_f32_16x16x32_bf16 v[24:27], a[136:139], a[200:203], v[24:27]
s_mov_b32 s9, 0x0
v_exp_f32 v35, v35
v_mfma_f32_16x16x32_bf16 v[24:27], a[140:143], a[204:207], v[24:27]
ds_read_b128 a[44:47], v1 offset:19456
v_cvt_pk_bf16_f32 v51, v34, v35
v_mfma_f32_16x16x32_bf16 v[28:31], a[128:131], a[208:211], v[92:95]
ds_read_b128 a[48:51], v1 offset:20480
v_exp_f32 v36, v36
v_mfma_f32_16x16x32_bf16 v[28:31], a[132:135], a[212:215], v[28:31]
buffer_load_dword a244, v8, s[72:75], s9 offen
v_mfma_f32_16x16x32_bf16 v[28:31], a[136:139], a[216:219], v[28:31]
s_mov_b32 s9, 0x0
v_exp_f32 v37, v37
v_mfma_f32_16x16x32_bf16 v[28:31], a[140:143], a[220:223], v[28:31]
buffer_load_dword a244, v8, s[64:67], s9 offen
v_exp_f32 v38, v38
v_exp_f32 v39, v39
v_cvt_pk_bf16_f32 v54, v36, v37
v_cvt_pk_bf16_f32 v55, v38, v39
v_mfma_f32_16x16x32_bf16 v[36:39], a[144:147], a[176:179], v[84:87]
ds_read_b128 a[52:55], v1 offset:21504
v_exp_f32 v40, v40
v_mfma_f32_16x16x32_bf16 v[36:39], a[148:151], a[180:183], v[36:39]
s_mov_b32 s9, 0x400000
v_exp_f32 v41, v41
v_mfma_f32_16x16x32_bf16 v[36:39], a[152:155], a[184:187], v[36:39]
ds_read_b128 a[56:59], v1 offset:22528
v_cvt_pk_bf16_f32 v58, v40, v41
v_mfma_f32_16x16x32_bf16 v[36:39], a[156:159], a[188:191], v[36:39]
ds_read_b128 a[60:63], v1 offset:23552
v_xor_b32 v1, 0x8000, v1
v_exp_f32 v42, v42
v_exp_f32 v43, v43
s_nop 0
v_cvt_pk_bf16_f32 v59, v42, v43
v_mfma_f32_16x16x32_bf16 v[40:43], a[144:147], a[192:195], v[88:91]
buffer_load_dword a244, v8, s[64:67], s9 offen
v_mfma_f32_16x16x32_bf16 v[40:43], a[148:151], a[196:199], v[40:43]
s_add_u32 s32, s32, 0x8000
v_exp_f32 v44, v44
v_mfma_f32_16x16x32_bf16 v[40:43], a[152:155], a[200:203], v[40:43]
s_add_u32 s7, s7, 0x8000
v_exp_f32 v45, v45
v_mfma_f32_16x16x32_bf16 v[40:43], a[156:159], a[204:207], v[40:43]
s_xor_b32 s27, s27, 0x38000
v_exp_f32 v46, v46
v_exp_f32 v47, v47
v_cvt_pk_bf16_f32 v62, v44, v45
v_cvt_pk_bf16_f32 v63, v46, v47
v_mfma_f32_16x16x32_bf16 v[44:47], a[144:147], a[208:211], v[92:95]
v_exp_f32 v20, v20
v_mfma_f32_16x16x32_bf16 v[44:47], a[148:151], a[212:215], v[44:47]
v_exp_f32 v21, v21
v_mfma_f32_16x16x32_bf16 v[44:47], a[152:155], a[216:219], v[44:47]
s_waitcnt vmcnt(11) lgkmcnt(0)
v_exp_f32 v22, v22
v_mfma_f32_16x16x32_bf16 v[44:47], a[156:159], a[220:223], v[44:47]
s_barrier
v_cvt_pk_bf16_f32 v68, v20, v21
v_exp_f32 v23, v23
v_exp_f32 v24, v24
v_exp_f32 v25, v25
v_exp_f32 v26, v26
v_exp_f32 v27, v27
v_cvt_pk_bf16_f32 v69, v22, v23
s_cmp_lg_u32 s33, 0
s_cbranch_scc1 L_sig_bn0
s_lshl_b32 s8, s6, 2
s_add_u32 s8, s8, 192
s_cmp_lg_u32 s4, 0
s_cbranch_scc1 L_sig_bn0
v_mov_b32 v4, 1
s_mov_b64 exec, 1
buffer_atomic_add v4, off, s[84:87], s8 sc1
s_mov_b64 exec, -1
L_sig_bn0:
s_branch L_att_l1_0
L_att_nl0_1:
v_mfma_f32_16x16x32_bf16 v[16:19], a[0:3], a[160:163], v[80:83]
ds_read_b128 a[128:131], v1 offset:24576
v_mov_b32 v240, 0
v_mfma_f32_16x16x32_bf16 v[16:19], a[4:7], a[164:167], v[16:19]
ds_read_b128 a[132:135], v1 offset:25600
s_add_u32 m0, s27, 0x0
v_mfma_f32_16x16x32_bf16 v[16:19], a[8:11], a[168:171], v[16:19]
buffer_load_dwordx4 v3, s[48:51], s32 offen offset:0 sc1 lds
v_mfma_f32_16x16x32_bf16 v[16:19], a[12:15], a[172:175], v[16:19]
ds_read_b128 a[136:139], v1 offset:26624
v_mov_b32 v241, 0
v_mfma_f32_16x16x32_bf16 v[20:23], a[0:3], a[176:179], v[84:87]
ds_read_b128 a[140:143], v1 offset:27648
v_mov_b32 v242, 0
v_mfma_f32_16x16x32_bf16 v[20:23], a[4:7], a[180:183], v[20:23]
ds_read_b128 a[144:147], v1 offset:28672
v_mov_b32 v243, 0
v_mfma_f32_16x16x32_bf16 v[20:23], a[8:11], a[184:187], v[20:23]
ds_read_b128 a[148:151], v1 offset:29696
v_mov_b32 v244, 0
v_mfma_f32_16x16x32_bf16 v[20:23], a[12:15], a[188:191], v[20:23]
buffer_load_dwordx4 v3, s[48:51], s32 offen offset:1024 sc1 lds
v_mfma_f32_16x16x32_bf16 v[24:27], a[0:3], a[192:195], v[88:91]
ds_read_b128 a[152:155], v1 offset:30720
v_mov_b32 v245, 0
v_mfma_f32_16x16x32_bf16 v[24:27], a[4:7], a[196:199], v[24:27]
ds_read_b128 a[156:159], v1 offset:31744
v_exp_f32 v16, v16
v_mfma_f32_16x16x32_bf16 v[24:27], a[8:11], a[200:203], v[24:27]
v_exp_f32 v17, v17
v_mfma_f32_16x16x32_bf16 v[24:27], a[12:15], a[204:207], v[24:27]
v_exp_f32 v18, v18
v_mfma_f32_16x16x32_bf16 v[28:31], a[0:3], a[208:211], v[92:95]
buffer_load_dwordx4 v3, s[48:51], s32 offen offset:2048 sc1 lds
v_mfma_f32_16x16x32_bf16 v[28:31], a[4:7], a[212:215], v[28:31]
v_exp_f32 v19, v19
v_mfma_f32_16x16x32_bf16 v[28:31], a[8:11], a[216:219], v[28:31]
v_exp_f32 v20, v20
v_mfma_f32_16x16x32_bf16 v[28:31], a[12:15], a[220:223], v[28:31]
v_exp_f32 v21, v21
v_mfma_f32_16x16x32_bf16 v[32:35], a[16:19], a[160:163], v[80:83]
v_exp_f32 v22, v22
v_mfma_f32_16x16x32_bf16 v[32:35], a[20:23], a[164:167], v[32:35]
buffer_load_dwordx4 v3, s[48:51], s32 offen offset:3072 sc1 lds
v_mfma_f32_16x16x32_bf16 v[32:35], a[24:27], a[168:171], v[32:35]
v_exp_f32 v23, v23
v_mfma_f32_16x16x32_bf16 v[32:35], a[28:31], a[172:175], v[32:35]
v_exp_f32 v24, v24
v_mfma_f32_16x16x32_bf16 v[36:39], a[16:19], a[176:179], v[84:87]
v_exp_f32 v25, v25
v_mfma_f32_16x16x32_bf16 v[36:39], a[20:23], a[180:183], v[36:39]
s_add_u32 m0, s27, 0x1000
v_exp_f32 v26, v26
v_mfma_f32_16x16x32_bf16 v[36:39], a[24:27], a[184:187], v[36:39]
buffer_load_dwordx4 v3, s[48:51], s7 offen offset:0 sc1 lds
v_mfma_f32_16x16x32_bf16 v[36:39], a[28:31], a[188:191], v[36:39]
v_exp_f32 v27, v27
v_mfma_f32_16x16x32_bf16 v[40:43], a[16:19], a[192:195], v[88:91]
v_exp_f32 v28, v28
v_mfma_f32_16x16x32_bf16 v[40:43], a[20:23], a[196:199], v[40:43]
v_exp_f32 v29, v29
v_mfma_f32_16x16x32_bf16 v[40:43], a[24:27], a[200:203], v[40:43]
v_exp_f32 v30, v30
v_mfma_f32_16x16x32_bf16 v[40:43], a[28:31], a[204:207], v[40:43]
buffer_load_dwordx4 v3, s[48:51], s7 offen offset:1024 sc1 lds
v_mfma_f32_16x16x32_bf16 v[44:47], a[16:19], a[208:211], v[92:95]
v_exp_f32 v31, v31
v_mfma_f32_16x16x32_bf16 v[44:47], a[20:23], a[212:215], v[44:47]
v_exp_f32 v32, v32
v_mfma_f32_16x16x32_bf16 v[44:47], a[24:27], a[216:219], v[44:47]
v_exp_f32 v33, v33
v_mfma_f32_16x16x32_bf16 v[44:47], a[28:31], a[220:223], v[44:47]
s_waitcnt lgkmcnt(0)
v_cvt_pk_bf16_f32 v48, v16, v17
v_cvt_pk_bf16_f32 v49, v18, v19
v_cvt_pk_bf16_f32 v52, v20, v21
v_cvt_pk_bf16_f32 v53, v22, v23
v_cvt_pk_bf16_f32 v56, v24, v25
v_cvt_pk_bf16_f32 v57, v26, v27
v_mov_b32 v246, 0
v_mov_b32 v247, 0
v_mfma_f32_16x16x32_bf16 v[16:19], a[128:131], a[160:163], v[96:99]
ds_read_b128 a[32:35], v1 offset:16384
v_cvt_pk_bf16_f32 v60, v28, v29
v_mfma_f32_16x16x32_bf16 v[16:19], a[132:135], a[164:167], v[16:19]
v_exp_f32 v34, v34
v_mfma_f32_16x16x32_bf16 v[16:19], a[136:139], a[168:171], v[16:19]
buffer_load_dwordx4 v3, s[48:51], s7 offen offset:2048 sc1 lds
v_mfma_f32_16x16x32_bf16 v[16:19], a[140:143], a[172:175], v[16:19]
ds_read_b128 a[36:39], v1 offset:17408
v_cvt_pk_bf16_f32 v61, v30, v31
v_mfma_f32_16x16x32_bf16 v[20:23], a[128:131], a[176:179], v[84:87]
v_exp_f32 v35, v35
v_mfma_f32_16x16x32_bf16 v[20:23], a[132:135], a[180:183], v[20:23]
v_exp_f32 v36, v36
v_mfma_f32_16x16x32_bf16 v[20:23], a[136:139], a[184:187], v[20:23]
ds_read_b128 a[40:43], v1 offset:18432
v_cvt_pk_bf16_f32 v50, v32, v33
v_mfma_f32_16x16x32_bf16 v[20:23], a[140:143], a[188:191], v[20:23]
buffer_load_dwordx4 v3, s[48:51], s7 offen offset:3072 sc1 lds
v_mfma_f32_16x16x32_bf16 v[24:27], a[128:131], a[192:195], v[88:91]
v_exp_f32 v37, v37
v_mfma_f32_16x16x32_bf16 v[24:27], a[132:135], a[196:199], v[24:27]
ds_read_b128 a[44:47], v1 offset:19456
v_cvt_pk_bf16_f32 v51, v34, v35
v_mfma_f32_16x16x32_bf16 v[24:27], a[136:139], a[200:203], v[24:27]
v_exp_f32 v38, v38
v_mfma_f32_16x16x32_bf16 v[24:27], a[140:143], a[204:207], v[24:27]
v_exp_f32 v39, v39
v_mfma_f32_16x16x32_bf16 v[28:31], a[128:131], a[208:211], v[92:95]
s_mov_b32 s9, 0x0
v_exp_f32 v40, v40
v_mfma_f32_16x16x32_bf16 v[28:31], a[132:135], a[212:215], v[28:31]
buffer_load_dword a244, v8, s[72:75], s9 offen
v_mfma_f32_16x16x32_bf16 v[28:31], a[136:139], a[216:219], v[28:31]
ds_read_b128 a[48:51], v1 offset:20480
v_cvt_pk_bf16_f32 v54, v36, v37
v_mfma_f32_16x16x32_bf16 v[28:31], a[140:143], a[220:223], v[28:31]
v_exp_f32 v41, v41
v_mfma_f32_16x16x32_bf16 v[32:35], a[144:147], a[160:163], v[100:103]
ds_read_b128 a[52:55], v1 offset:21504
v_cvt_pk_bf16_f32 v55, v38, v39
v_mfma_f32_16x16x32_bf16 v[32:35], a[148:151], a[164:167], v[32:35]
s_mov_b32 s9, 0x0
v_exp_f32 v42, v42
v_mfma_f32_16x16x32_bf16 v[32:35], a[152:155], a[168:171], v[32:35]
buffer_load_dword a244, v8, s[64:67], s9 offen
v_mfma_f32_16x16x32_bf16 v[32:35], a[156:159], a[172:175], v[32:35]
ds_read_b128 a[56:59], v1 offset:22528
v_cvt_pk_bf16_f32 v58, v40, v41
v_mfma_f32_16x16x32_bf16 v[36:39], a[144:147], a[176:179], v[84:87]
v_exp_f32 v43, v43
v_mfma_f32_16x16x32_bf16 v[36:39], a[148:151], a[180:183], v[36:39]
s_mov_b32 s9, 0x400000
v_exp_f32 v44, v44
v_mfma_f32_16x16x32_bf16 v[36:39], a[152:155], a[184:187], v[36:39]
ds_read_b128 a[60:63], v1 offset:23552
v_xor_b32 v1, 0x8000, v1
v_mfma_f32_16x16x32_bf16 v[36:39], a[156:159], a[188:191], v[36:39]
buffer_load_dword a244, v8, s[64:67], s9 offen
v_cvt_pk_bf16_f32 v59, v42, v43
v_mfma_f32_16x16x32_bf16 v[40:43], a[144:147], a[192:195], v[88:91]
s_add_u32 s32, s32, 0x8000
v_exp_f32 v45, v45
v_mfma_f32_16x16x32_bf16 v[40:43], a[148:151], a[196:199], v[40:43]
s_add_u32 s7, s7, 0x8000
v_exp_f32 v46, v46
v_mfma_f32_16x16x32_bf16 v[40:43], a[152:155], a[200:203], v[40:43]
s_xor_b32 s27, s27, 0x38000
v_exp_f32 v47, v47
v_mfma_f32_16x16x32_bf16 v[40:43], a[156:159], a[204:207], v[40:43]
v_exp_f32 v16, v16
v_cvt_pk_bf16_f32 v62, v44, v45
v_cvt_pk_bf16_f32 v63, v46, v47
v_mfma_f32_16x16x32_bf16 v[44:47], a[144:147], a[208:211], v[92:95]
v_exp_f32 v17, v17
v_mfma_f32_16x16x32_bf16 v[44:47], a[148:151], a[212:215], v[44:47]
v_exp_f32 v18, v18
v_mfma_f32_16x16x32_bf16 v[44:47], a[152:155], a[216:219], v[44:47]
s_waitcnt vmcnt(11) lgkmcnt(0)
v_exp_f32 v19, v19
v_mfma_f32_16x16x32_bf16 v[44:47], a[156:159], a[220:223], v[44:47]
s_barrier
v_cvt_pk_bf16_f32 v64, v16, v17
v_exp_f32 v20, v20
v_exp_f32 v21, v21
v_exp_f32 v22, v22
v_exp_f32 v23, v23
v_exp_f32 v24, v24
v_exp_f32 v25, v25
v_exp_f32 v26, v26
v_exp_f32 v27, v27
v_cvt_pk_bf16_f32 v65, v18, v19
v_cvt_pk_bf16_f32 v68, v20, v21
v_cvt_pk_bf16_f32 v69, v22, v23
s_cmp_lg_u32 s33, 0
s_cbranch_scc1 L_sig_bn1
s_lshl_b32 s8, s6, 2
s_add_u32 s8, s8, 192
s_cmp_lg_u32 s4, 0
s_cbranch_scc1 L_sig_bn1
v_mov_b32 v4, 1
s_mov_b64 exec, 1
buffer_atomic_add v4, off, s[84:87], s8 sc1
s_mov_b64 exec, -1
L_sig_bn1:
s_branch L_att_l1_1
L_att_seven0:
v_mfma_f32_16x16x32_bf16 v[192:195], a[32:35], v[56:59], v[192:195]
v_exp_f32 v30, v30
v_mfma_f32_16x16x32_bf16 v[224:227], a[32:35], v[60:63], v[224:227]
ds_read_b128 a[0:3], v1 offset:8192
v_cvt_pk_bf16_f32 v72, v24, v25
v_mfma_f32_16x16x32_bf16 v[228:231], a[36:39], v[60:63], v[228:231]
ds_read_b128 a[4:7], v1 offset:9216
v_cvt_pk_bf16_f32 v73, v26, v27
v_mfma_f32_16x16x32_bf16 v[196:199], a[36:39], v[56:59], v[196:199]
s_add_u32 m0, s27, 0x0
v_exp_f32 v31, v31
v_mfma_f32_16x16x32_bf16 v[200:203], a[40:43], v[56:59], v[200:203]
ds_read_b128 a[8:11], v1 offset:10240
v_cvt_pk_bf16_f32 v76, v28, v29
v_mfma_f32_16x16x32_bf16 v[232:235], a[40:43], v[60:63], v[232:235]
buffer_load_dwordx4 v3, s[48:51], s32 offen offset:0 sc1 lds
v_mfma_f32_16x16x32_bf16 v[236:239], a[44:47], v[60:63], v[236:239]
v_exp_f32 v40, v40
v_mfma_f32_16x16x32_bf16 v[204:207], a[44:47], v[56:59], v[204:207]
ds_read_b128 a[12:15], v1 offset:11264
v_cvt_pk_bf16_f32 v77, v30, v31
v_mfma_f32_16x16x32_bf16 v[208:211], a[48:51], v[56:59], v[208:211]
ds_read_b128 a[16:19], v1 offset:12288
v_mfma_f32_16x16x32_bf16 v[240:243], a[48:51], v[60:63], v[240:243]
buffer_load_dwordx4 v3, s[48:51], s32 offen offset:1024 sc1 lds
v_mfma_f32_16x16x32_bf16 v[244:247], a[52:55], v[60:63], v[244:247]
ds_read_b128 a[20:23], v1 offset:13312
v_mfma_f32_16x16x32_bf16 v[212:215], a[52:55], v[56:59], v[212:215]
ds_read_b128 a[24:27], v1 offset:14336
v_mfma_f32_16x16x32_bf16 v[216:219], a[56:59], v[56:59], v[216:219]
ds_read_b128 a[28:31], v1 offset:15360
v_mfma_f32_16x16x32_bf16 v[248:251], a[56:59], v[60:63], v[248:251]
ds_read_b128 a[32:35], v1 offset:0
v_exp_f32 v41, v41
v_mfma_f32_16x16x32_bf16 v[252:255], a[60:63], v[60:63], v[252:255]
v_exp_f32 v42, v42
v_mfma_f32_16x16x32_bf16 v[220:223], a[60:63], v[56:59], v[220:223]
s_waitcnt lgkmcnt(5)
v_exp_f32 v43, v43
v_smfmac_f32_16x16x64_bf16 a[228:231], a[232:235], v[56:63], v9
ds_read_b128 a[36:39], v1 offset:1024
v_cvt_pk_bf16_f32 v74, v40, v41
v_mfma_f32_16x16x32_bf16 v[24:27], a[0:3], a[192:195], v[88:91]
ds_read_b128 a[40:43], v1 offset:2048
v_exp_f32 v44, v44
v_mfma_f32_16x16x32_bf16 v[24:27], a[4:7], a[196:199], v[24:27]
buffer_load_dwordx4 v3, s[48:51], s32 offen offset:2048 sc1 lds
v_mfma_f32_16x16x32_bf16 v[24:27], a[8:11], a[200:203], v[24:27]
v_exp_f32 v45, v45
v_mfma_f32_16x16x32_bf16 v[24:27], a[12:15], a[204:207], v[24:27]
ds_read_b128 a[44:47], v1 offset:3072
v_cvt_pk_bf16_f32 v75, v42, v43
v_mfma_f32_16x16x32_bf16 v[28:31], a[0:3], a[208:211], v[92:95]
ds_read_b128 a[48:51], v1 offset:4096
v_exp_f32 v46, v46
v_mfma_f32_16x16x32_bf16 v[28:31], a[4:7], a[212:215], v[28:31]
s_waitcnt lgkmcnt(5)
v_exp_f32 v47, v47
v_mfma_f32_16x16x32_bf16 v[28:31], a[8:11], a[216:219], v[28:31]
ds_read_b128 a[52:55], v1 offset:5120
v_cvt_pk_bf16_f32 v78, v44, v45
v_mfma_f32_16x16x32_bf16 v[28:31], a[12:15], a[220:223], v[28:31]
buffer_load_dwordx4 v3, s[48:51], s32 offen offset:3072 sc1 lds
v_mfma_f32_16x16x32_bf16 v[40:43], a[16:19], a[192:195], v[88:91]
ds_read_b128 a[56:59], v1 offset:6144
s_add_u32 s32, s32, 0x8000
v_mfma_f32_16x16x32_bf16 v[40:43], a[20:23], a[196:199], v[40:43]
ds_read_b128 a[60:63], v1 offset:7168
v_cvt_pk_bf16_f32 v79, v46, v47
v_mfma_f32_16x16x32_bf16 v[40:43], a[24:27], a[200:203], v[40:43]
v_exp_f32 v24, v24
v_mfma_f32_16x16x32_bf16 v[40:43], a[28:31], a[204:207], v[40:43]
v_exp_f32 v25, v25
v_mfma_f32_16x16x32_bf16 v[44:47], a[16:19], a[208:211], v[92:95]
v_exp_f32 v26, v26
v_mfma_f32_16x16x32_bf16 v[44:47], a[20:23], a[212:215], v[44:47]
v_exp_f32 v27, v27
v_mfma_f32_16x16x32_bf16 v[44:47], a[24:27], a[216:219], v[44:47]
v_exp_f32 v28, v28
v_mfma_f32_16x16x32_bf16 v[44:47], a[28:31], a[220:223], v[44:47]
s_waitcnt lgkmcnt(0)
v_exp_f32 v29, v29
v_mfma_f32_16x16x32_bf16 v[192:195], a[32:35], v[72:75], v[192:195]
s_add_u32 m0, s27, 0x1000
v_exp_f32 v30, v30
v_mfma_f32_16x16x32_bf16 v[224:227], a[32:35], v[76:79], v[224:227]
buffer_load_dwordx4 v3, s[48:51], s7 offen offset:0 sc1 lds
v_mfma_f32_16x16x32_bf16 v[228:231], a[36:39], v[76:79], v[228:231]
v_exp_f32 v31, v31
v_mfma_f32_16x16x32_bf16 v[196:199], a[36:39], v[72:75], v[196:199]
ds_read_b128 a[0:3], v1 offset:24576
v_cvt_pk_bf16_f32 v56, v24, v25
v_mfma_f32_16x16x32_bf16 v[200:203], a[40:43], v[72:75], v[200:203]
ds_read_b128 a[4:7], v1 offset:25600
v_cvt_pk_bf16_f32 v57, v26, v27
v_mfma_f32_16x16x32_bf16 v[232:235], a[40:43], v[76:79], v[232:235]
v_exp_f32 v40, v40
v_mfma_f32_16x16x32_bf16 v[236:239], a[44:47], v[76:79], v[236:239]
ds_read_b128 a[8:11], v1 offset:26624
v_cvt_pk_bf16_f32 v60, v28, v29
v_mfma_f32_16x16x32_bf16 v[204:207], a[44:47], v[72:75], v[204:207]
v_exp_f32 v41, v41
v_mfma_f32_16x16x32_bf16 v[208:211], a[48:51], v[72:75], v[208:211]
ds_read_b128 a[12:15], v1 offset:27648
v_cvt_pk_bf16_f32 v61, v30, v31
v_mfma_f32_16x16x32_bf16 v[240:243], a[48:51], v[76:79], v[240:243]
ds_read_b128 a[16:19], v1 offset:28672
v_cvt_pk_bf16_f32 v58, v40, v41
v_mfma_f32_16x16x32_bf16 v[244:247], a[52:55], v[76:79], v[244:247]
v_exp_f32 v42, v42
v_mfma_f32_16x16x32_bf16 v[212:215], a[52:55], v[72:75], v[212:215]
buffer_load_dwordx4 v3, s[48:51], s7 offen offset:1024 sc1 lds
v_mfma_f32_16x16x32_bf16 v[216:219], a[56:59], v[72:75], v[216:219]
ds_read_b128 a[20:23], v1 offset:29696
v_mfma_f32_16x16x32_bf16 v[248:251], a[56:59], v[76:79], v[248:251]
ds_read_b128 a[24:27], v1 offset:30720
v_mfma_f32_16x16x32_bf16 v[252:255], a[60:63], v[76:79], v[252:255]
ds_read_b128 a[28:31], v1 offset:31744
v_mfma_f32_16x16x32_bf16 v[220:223], a[60:63], v[72:75], v[220:223]
s_waitcnt lgkmcnt(4)
v_exp_f32 v43, v43
v_smfmac_f32_16x16x64_bf16 a[228:231], a[232:235], v[72:79], v9
ds_read_b128 a[32:35], v1 offset:16384
v_cvt_pk_bf16_f32 v59, v42, v43
v_mfma_f32_16x16x32_bf16 v[24:27], a[0:3], a[192:195], v[88:91]
ds_read_b128 a[36:39], v1 offset:17408
v_mfma_f32_16x16x32_bf16 v[24:27], a[4:7], a[196:199], v[24:27]
buffer_load_dwordx4 v3, s[48:51], s7 offen offset:2048 sc1 lds
v_mfma_f32_16x16x32_bf16 v[24:27], a[8:11], a[200:203], v[24:27]
ds_read_b128 a[40:43], v1 offset:18432
v_exp_f32 v44, v44
v_mfma_f32_16x16x32_bf16 v[24:27], a[12:15], a[204:207], v[24:27]
ds_read_b128 a[44:47], v1 offset:19456
v_exp_f32 v45, v45
v_mfma_f32_16x16x32_bf16 v[28:31], a[0:3], a[208:211], v[92:95]
ds_read_b128 a[48:51], v1 offset:20480
v_exp_f32 v46, v46
v_mfma_f32_16x16x32_bf16 v[28:31], a[4:7], a[212:215], v[28:31]
s_waitcnt lgkmcnt(5)
v_exp_f32 v47, v47
v_mfma_f32_16x16x32_bf16 v[28:31], a[8:11], a[216:219], v[28:31]
ds_read_b128 a[52:55], v1 offset:21504
v_cvt_pk_bf16_f32 v62, v44, v45
v_mfma_f32_16x16x32_bf16 v[28:31], a[12:15], a[220:223], v[28:31]
ds_read_b128 a[56:59], v1 offset:22528
v_cvt_pk_bf16_f32 v63, v46, v47
v_mfma_f32_16x16x32_bf16 v[40:43], a[16:19], a[192:195], v[88:91]
ds_read_b128 a[60:63], v1 offset:23552
v_xor_b32 v1, 0x8000, v1
v_mfma_f32_16x16x32_bf16 v[40:43], a[20:23], a[196:199], v[40:43]
buffer_load_dwordx4 v3, s[48:51], s7 offen offset:3072 sc1 lds
v_mfma_f32_16x16x32_bf16 v[40:43], a[24:27], a[200:203], v[40:43]
s_add_u32 s7, s7, 0x8000
v_exp_f32 v24, v24
v_mfma_f32_16x16x32_bf16 v[40:43], a[28:31], a[204:207], v[40:43]
s_xor_b32 s27, s27, 0x38000
v_exp_f32 v25, v25
v_mfma_f32_16x16x32_bf16 v[44:47], a[16:19], a[208:211], v[92:95]
v_exp_f32 v26, v26
v_mfma_f32_16x16x32_bf16 v[44:47], a[20:23], a[212:215], v[44:47]
v_exp_f32 v27, v27
v_mfma_f32_16x16x32_bf16 v[44:47], a[24:27], a[216:219], v[44:47]
s_waitcnt vmcnt(16) lgkmcnt(0)
v_exp_f32 v28, v28
v_mfma_f32_16x16x32_bf16 v[44:47], a[28:31], a[220:223], v[44:47]
s_barrier
v_exp_f32 v29, v29
L_att_sodd0:
v_mfma_f32_16x16x32_bf16 v[192:195], a[32:35], v[56:59], v[192:195]
v_exp_f32 v30, v30
v_mfma_f32_16x16x32_bf16 v[224:227], a[32:35], v[60:63], v[224:227]
ds_read_b128 a[0:3], v2 offset:8192
v_cvt_pk_bf16_f32 v72, v24, v25
v_mfma_f32_16x16x32_bf16 v[228:231], a[36:39], v[60:63], v[228:231]
ds_read_b128 a[4:7], v2 offset:9216
v_cvt_pk_bf16_f32 v73, v26, v27
v_mfma_f32_16x16x32_bf16 v[196:199], a[36:39], v[56:59], v[196:199]
s_add_u32 m0, s19, 0x0
v_exp_f32 v31, v31
v_mfma_f32_16x16x32_bf16 v[200:203], a[40:43], v[56:59], v[200:203]
ds_read_b128 a[8:11], v2 offset:10240
v_cvt_pk_bf16_f32 v76, v28, v29
v_mfma_f32_16x16x32_bf16 v[232:235], a[40:43], v[60:63], v[232:235]
buffer_load_dwordx4 v3, s[48:51], s32 offen offset:0 sc1 lds
v_mfma_f32_16x16x32_bf16 v[236:239], a[44:47], v[60:63], v[236:239]
v_exp_f32 v40, v40
v_mfma_f32_16x16x32_bf16 v[204:207], a[44:47], v[56:59], v[204:207]
ds_read_b128 a[12:15], v2 offset:11264
v_cvt_pk_bf16_f32 v77, v30, v31
v_mfma_f32_16x16x32_bf16 v[208:211], a[48:51], v[56:59], v[208:211]
ds_read_b128 a[16:19], v2 offset:12288
v_mfma_f32_16x16x32_bf16 v[240:243], a[48:51], v[60:63], v[240:243]
buffer_load_dwordx4 v3, s[48:51], s32 offen offset:1024 sc1 lds
v_mfma_f32_16x16x32_bf16 v[244:247], a[52:55], v[60:63], v[244:247]
ds_read_b128 a[20:23], v2 offset:13312
v_mfma_f32_16x16x32_bf16 v[212:215], a[52:55], v[56:59], v[212:215]
ds_read_b128 a[24:27], v2 offset:14336
v_mfma_f32_16x16x32_bf16 v[216:219], a[56:59], v[56:59], v[216:219]
ds_read_b128 a[28:31], v2 offset:15360
v_mfma_f32_16x16x32_bf16 v[248:251], a[56:59], v[60:63], v[248:251]
ds_read_b128 a[32:35], v2 offset:0
v_exp_f32 v41, v41
v_mfma_f32_16x16x32_bf16 v[252:255], a[60:63], v[60:63], v[252:255]
v_exp_f32 v42, v42
v_mfma_f32_16x16x32_bf16 v[220:223], a[60:63], v[56:59], v[220:223]
s_waitcnt lgkmcnt(5)
v_exp_f32 v43, v43
v_smfmac_f32_16x16x64_bf16 a[228:231], a[232:235], v[56:63], v9
ds_read_b128 a[36:39], v2 offset:1024
v_cvt_pk_bf16_f32 v74, v40, v41
v_mfma_f32_16x16x32_bf16 v[24:27], a[0:3], a[192:195], v[88:91]
ds_read_b128 a[40:43], v2 offset:2048
v_exp_f32 v44, v44
v_mfma_f32_16x16x32_bf16 v[24:27], a[4:7], a[196:199], v[24:27]
buffer_load_dwordx4 v3, s[48:51], s32 offen offset:2048 sc1 lds
v_mfma_f32_16x16x32_bf16 v[24:27], a[8:11], a[200:203], v[24:27]
v_exp_f32 v45, v45
v_mfma_f32_16x16x32_bf16 v[24:27], a[12:15], a[204:207], v[24:27]
ds_read_b128 a[44:47], v2 offset:3072
v_cvt_pk_bf16_f32 v75, v42, v43
v_mfma_f32_16x16x32_bf16 v[28:31], a[0:3], a[208:211], v[92:95]
ds_read_b128 a[48:51], v2 offset:4096
v_exp_f32 v46, v46
v_mfma_f32_16x16x32_bf16 v[28:31], a[4:7], a[212:215], v[28:31]
s_waitcnt lgkmcnt(5)
v_exp_f32 v47, v47
v_mfma_f32_16x16x32_bf16 v[28:31], a[8:11], a[216:219], v[28:31]
ds_read_b128 a[52:55], v2 offset:5120
v_cvt_pk_bf16_f32 v78, v44, v45
v_mfma_f32_16x16x32_bf16 v[28:31], a[12:15], a[220:223], v[28:31]
buffer_load_dwordx4 v3, s[48:51], s32 offen offset:3072 sc1 lds
v_mfma_f32_16x16x32_bf16 v[40:43], a[16:19], a[192:195], v[88:91]
ds_read_b128 a[56:59], v2 offset:6144
s_add_u32 s32, s32, 0x8000
v_mfma_f32_16x16x32_bf16 v[40:43], a[20:23], a[196:199], v[40:43]
ds_read_b128 a[60:63], v2 offset:7168
v_cvt_pk_bf16_f32 v79, v46, v47
v_mfma_f32_16x16x32_bf16 v[40:43], a[24:27], a[200:203], v[40:43]
v_exp_f32 v24, v24
v_mfma_f32_16x16x32_bf16 v[40:43], a[28:31], a[204:207], v[40:43]
v_exp_f32 v25, v25
v_mfma_f32_16x16x32_bf16 v[44:47], a[16:19], a[208:211], v[92:95]
v_exp_f32 v26, v26
v_mfma_f32_16x16x32_bf16 v[44:47], a[20:23], a[212:215], v[44:47]
v_exp_f32 v27, v27
v_mfma_f32_16x16x32_bf16 v[44:47], a[24:27], a[216:219], v[44:47]
v_exp_f32 v28, v28
v_mfma_f32_16x16x32_bf16 v[44:47], a[28:31], a[220:223], v[44:47]
s_waitcnt lgkmcnt(0)
v_exp_f32 v29, v29
v_mfma_f32_16x16x32_bf16 v[192:195], a[32:35], v[72:75], v[192:195]
v_exp_f32 v30, v30
v_mfma_f32_16x16x32_bf16 v[224:227], a[32:35], v[76:79], v[224:227]
v_exp_f32 v31, v31
v_mfma_f32_16x16x32_bf16 v[228:231], a[36:39], v[76:79], v[228:231]
v_exp_f32 v40, v40
v_mfma_f32_16x16x32_bf16 v[196:199], a[36:39], v[72:75], v[196:199]
s_add_u32 m0, s19, 0x1000
v_exp_f32 v41, v41
v_mfma_f32_16x16x32_bf16 v[200:203], a[40:43], v[72:75], v[200:203]
ds_read_b128 a[0:3], v2 offset:24576
v_cvt_pk_bf16_f32 v56, v24, v25
v_mfma_f32_16x16x32_bf16 v[232:235], a[40:43], v[76:79], v[232:235]
buffer_load_dwordx4 v3, s[48:51], s7 offen offset:0 sc1 lds
v_mfma_f32_16x16x32_bf16 v[236:239], a[44:47], v[76:79], v[236:239]
ds_read_b128 a[4:7], v2 offset:25600
v_cvt_pk_bf16_f32 v57, v26, v27
v_mfma_f32_16x16x32_bf16 v[204:207], a[44:47], v[72:75], v[204:207]
ds_read_b128 a[8:11], v2 offset:26624
v_cvt_pk_bf16_f32 v60, v28, v29
v_mfma_f32_16x16x32_bf16 v[208:211], a[48:51], v[72:75], v[208:211]
ds_read_b128 a[12:15], v2 offset:27648
v_cvt_pk_bf16_f32 v61, v30, v31
v_mfma_f32_16x16x32_bf16 v[240:243], a[48:51], v[76:79], v[240:243]
ds_read_b128 a[16:19], v2 offset:28672
v_cvt_pk_bf16_f32 v58, v40, v41
v_mfma_f32_16x16x32_bf16 v[244:247], a[52:55], v[76:79], v[244:247]
buffer_load_dwordx4 v3, s[48:51], s7 offen offset:1024 sc1 lds
v_mfma_f32_16x16x32_bf16 v[212:215], a[52:55], v[72:75], v[212:215]
ds_read_b128 a[20:23], v2 offset:29696
v_mfma_f32_16x16x32_bf16 v[216:219], a[56:59], v[72:75], v[216:219]
v_exp_f32 v42, v42
v_mfma_f32_16x16x32_bf16 v[248:251], a[56:59], v[76:79], v[248:251]
ds_read_b128 a[24:27], v2 offset:30720
v_mfma_f32_16x16x32_bf16 v[252:255], a[60:63], v[76:79], v[252:255]
ds_read_b128 a[28:31], v2 offset:31744
v_exp_f32 v43, v43
v_mfma_f32_16x16x32_bf16 v[220:223], a[60:63], v[72:75], v[220:223]
ds_read_b128 a[32:35], v2 offset:16384
v_cvt_pk_bf16_f32 v59, v42, v43
v_smfmac_f32_16x16x64_bf16 a[228:231], a[232:235], v[72:79], v9
ds_read_b128 a[36:39], v2 offset:17408
s_waitcnt lgkmcnt(6)
v_mfma_f32_16x16x32_bf16 v[24:27], a[0:3], a[192:195], v[88:91]
buffer_load_dwordx4 v3, s[48:51], s7 offen offset:2048 sc1 lds
v_mfma_f32_16x16x32_bf16 v[24:27], a[4:7], a[196:199], v[24:27]
ds_read_b128 a[40:43], v2 offset:18432
v_exp_f32 v44, v44
v_mfma_f32_16x16x32_bf16 v[24:27], a[8:11], a[200:203], v[24:27]
ds_read_b128 a[44:47], v2 offset:19456
v_exp_f32 v45, v45
v_mfma_f32_16x16x32_bf16 v[24:27], a[12:15], a[204:207], v[24:27]
ds_read_b128 a[48:51], v2 offset:20480
v_cvt_pk_bf16_f32 v62, v44, v45
v_mfma_f32_16x16x32_bf16 v[28:31], a[0:3], a[208:211], v[92:95]
v_exp_f32 v46, v46
v_mfma_f32_16x16x32_bf16 v[28:31], a[4:7], a[212:215], v[28:31]
s_waitcnt lgkmcnt(5)
v_exp_f32 v47, v47
v_mfma_f32_16x16x32_bf16 v[28:31], a[8:11], a[216:219], v[28:31]
ds_read_b128 a[52:55], v2 offset:21504
v_cvt_pk_bf16_f32 v63, v46, v47
v_mfma_f32_16x16x32_bf16 v[28:31], a[12:15], a[220:223], v[28:31]
buffer_load_dwordx4 v3, s[48:51], s7 offen offset:3072 sc1 lds
v_mfma_f32_16x16x32_bf16 v[40:43], a[16:19], a[192:195], v[88:91]
ds_read_b128 a[56:59], v2 offset:22528
s_add_u32 s7, s7, 0x8000
v_mfma_f32_16x16x32_bf16 v[40:43], a[20:23], a[196:199], v[40:43]
ds_read_b128 a[60:63], v2 offset:23552
v_xor_b32 v2, 0x38000, v2
v_mfma_f32_16x16x32_bf16 v[40:43], a[24:27], a[200:203], v[40:43]
s_xor_b32 s19, s19, 0x8000
v_exp_f32 v24, v24
v_mfma_f32_16x16x32_bf16 v[40:43], a[28:31], a[204:207], v[40:43]
s_sub_u32 s15, s15, 1
v_exp_f32 v25, v25
v_mfma_f32_16x16x32_bf16 v[44:47], a[16:19], a[208:211], v[92:95]
s_cmp_lg_u32 s15, 0
v_exp_f32 v26, v26
v_mfma_f32_16x16x32_bf16 v[44:47], a[20:23], a[212:215], v[44:47]
v_exp_f32 v27, v27
v_mfma_f32_16x16x32_bf16 v[44:47], a[24:27], a[216:219], v[44:47]
s_waitcnt vmcnt(16) lgkmcnt(0)
v_exp_f32 v28, v28
v_mfma_f32_16x16x32_bf16 v[44:47], a[28:31], a[220:223], v[44:47]
s_barrier
v_exp_f32 v29, v29
s_cbranch_scc1 L_att_seven0
s_branch L_att_sdone
L_att_seven1:
v_mfma_f32_16x16x32_bf16 v[192:195], a[32:35], v[56:59], v[192:195]
v_exp_f32 v30, v30
v_mfma_f32_16x16x32_bf16 v[224:227], a[32:35], v[60:63], v[224:227]
ds_read_b128 a[0:3], v1 offset:8192
v_cvt_pk_bf16_f32 v72, v24, v25
v_mfma_f32_16x16x32_bf16 v[228:231], a[36:39], v[60:63], v[228:231]
ds_read_b128 a[4:7], v1 offset:9216
v_cvt_pk_bf16_f32 v73, v26, v27
v_mfma_f32_16x16x32_bf16 v[196:199], a[36:39], v[56:59], v[196:199]
s_add_u32 m0, s27, 0x0
v_exp_f32 v31, v31
v_mfma_f32_16x16x32_bf16 v[200:203], a[40:43], v[56:59], v[200:203]
ds_read_b128 a[8:11], v1 offset:10240
v_cvt_pk_bf16_f32 v76, v28, v29
v_mfma_f32_16x16x32_bf16 v[232:235], a[40:43], v[60:63], v[232:235]
buffer_load_dwordx4 v3, s[48:51], s32 offen offset:0 sc1 lds
v_mfma_f32_16x16x32_bf16 v[236:239], a[44:47], v[60:63], v[236:239]
v_exp_f32 v40, v40
v_mfma_f32_16x16x32_bf16 v[204:207], a[44:47], v[56:59], v[204:207]
ds_read_b128 a[12:15], v1 offset:11264
v_cvt_pk_bf16_f32 v77, v30, v31
v_mfma_f32_16x16x32_bf16 v[208:211], a[48:51], v[56:59], v[208:211]
ds_read_b128 a[16:19], v1 offset:12288
v_mfma_f32_16x16x32_bf16 v[240:243], a[48:51], v[60:63], v[240:243]
buffer_load_dwordx4 v3, s[48:51], s32 offen offset:1024 sc1 lds
v_mfma_f32_16x16x32_bf16 v[244:247], a[52:55], v[60:63], v[244:247]
ds_read_b128 a[20:23], v1 offset:13312
v_mfma_f32_16x16x32_bf16 v[212:215], a[52:55], v[56:59], v[212:215]
ds_read_b128 a[24:27], v1 offset:14336
v_mfma_f32_16x16x32_bf16 v[216:219], a[56:59], v[56:59], v[216:219]
ds_read_b128 a[28:31], v1 offset:15360
v_mfma_f32_16x16x32_bf16 v[248:251], a[56:59], v[60:63], v[248:251]
ds_read_b128 a[32:35], v1 offset:0
v_exp_f32 v41, v41
v_mfma_f32_16x16x32_bf16 v[252:255], a[60:63], v[60:63], v[252:255]
v_exp_f32 v42, v42
v_mfma_f32_16x16x32_bf16 v[220:223], a[60:63], v[56:59], v[220:223]
s_waitcnt lgkmcnt(5)
v_exp_f32 v43, v43
v_smfmac_f32_16x16x64_bf16 a[228:231], a[232:235], v[56:63], v9
ds_read_b128 a[36:39], v1 offset:1024
v_cvt_pk_bf16_f32 v74, v40, v41
v_mfma_f32_16x16x32_bf16 v[24:27], a[0:3], a[192:195], v[88:91]
ds_read_b128 a[40:43], v1 offset:2048
v_exp_f32 v44, v44
v_mfma_f32_16x16x32_bf16 v[24:27], a[4:7], a[196:199], v[24:27]
buffer_load_dwordx4 v3, s[48:51], s32 offen offset:2048 sc1 lds
v_mfma_f32_16x16x32_bf16 v[24:27], a[8:11], a[200:203], v[24:27]
v_exp_f32 v45, v45
v_mfma_f32_16x16x32_bf16 v[24:27], a[12:15], a[204:207], v[24:27]
ds_read_b128 a[44:47], v1 offset:3072
v_cvt_pk_bf16_f32 v75, v42, v43
v_mfma_f32_16x16x32_bf16 v[28:31], a[0:3], a[208:211], v[92:95]
ds_read_b128 a[48:51], v1 offset:4096
v_exp_f32 v46, v46
v_mfma_f32_16x16x32_bf16 v[28:31], a[4:7], a[212:215], v[28:31]
s_waitcnt lgkmcnt(5)
v_exp_f32 v47, v47
v_mfma_f32_16x16x32_bf16 v[28:31], a[8:11], a[216:219], v[28:31]
ds_read_b128 a[52:55], v1 offset:5120
v_cvt_pk_bf16_f32 v78, v44, v45
v_mfma_f32_16x16x32_bf16 v[28:31], a[12:15], a[220:223], v[28:31]
buffer_load_dwordx4 v3, s[48:51], s32 offen offset:3072 sc1 lds
v_mfma_f32_16x16x32_bf16 v[40:43], a[16:19], a[192:195], v[88:91]
ds_read_b128 a[56:59], v1 offset:6144
s_add_u32 s32, s32, 0x8000
v_mfma_f32_16x16x32_bf16 v[40:43], a[20:23], a[196:199], v[40:43]
ds_read_b128 a[60:63], v1 offset:7168
v_cvt_pk_bf16_f32 v79, v46, v47
v_mfma_f32_16x16x32_bf16 v[40:43], a[24:27], a[200:203], v[40:43]
v_exp_f32 v24, v24
v_mfma_f32_16x16x32_bf16 v[40:43], a[28:31], a[204:207], v[40:43]
v_exp_f32 v25, v25
v_mfma_f32_16x16x32_bf16 v[44:47], a[16:19], a[208:211], v[92:95]
v_exp_f32 v26, v26
v_mfma_f32_16x16x32_bf16 v[44:47], a[20:23], a[212:215], v[44:47]
v_exp_f32 v27, v27
v_mfma_f32_16x16x32_bf16 v[44:47], a[24:27], a[216:219], v[44:47]
v_exp_f32 v28, v28
v_mfma_f32_16x16x32_bf16 v[44:47], a[28:31], a[220:223], v[44:47]
s_waitcnt lgkmcnt(0)
v_exp_f32 v29, v29
v_mfma_f32_16x16x32_bf16 v[192:195], a[32:35], v[72:75], v[192:195]
s_add_u32 m0, s27, 0x1000
v_exp_f32 v30, v30
v_mfma_f32_16x16x32_bf16 v[224:227], a[32:35], v[76:79], v[224:227]
buffer_load_dwordx4 v3, s[48:51], s7 offen offset:0 sc1 lds
v_mfma_f32_16x16x32_bf16 v[228:231], a[36:39], v[76:79], v[228:231]
v_exp_f32 v31, v31
v_mfma_f32_16x16x32_bf16 v[196:199], a[36:39], v[72:75], v[196:199]
ds_read_b128 a[0:3], v1 offset:24576
v_cvt_pk_bf16_f32 v56, v24, v25
v_mfma_f32_16x16x32_bf16 v[200:203], a[40:43], v[72:75], v[200:203]
ds_read_b128 a[4:7], v1 offset:25600
v_cvt_pk_bf16_f32 v57, v26, v27
v_mfma_f32_16x16x32_bf16 v[232:235], a[40:43], v[76:79], v[232:235]
v_exp_f32 v40, v40
v_mfma_f32_16x16x32_bf16 v[236:239], a[44:47], v[76:79], v[236:239]
ds_read_b128 a[8:11], v1 offset:26624
v_cvt_pk_bf16_f32 v60, v28, v29
v_mfma_f32_16x16x32_bf16 v[204:207], a[44:47], v[72:75], v[204:207]
v_exp_f32 v41, v41
v_mfma_f32_16x16x32_bf16 v[208:211], a[48:51], v[72:75], v[208:211]
ds_read_b128 a[12:15], v1 offset:27648
v_cvt_pk_bf16_f32 v61, v30, v31
v_mfma_f32_16x16x32_bf16 v[240:243], a[48:51], v[76:79], v[240:243]
ds_read_b128 a[16:19], v1 offset:28672
v_cvt_pk_bf16_f32 v58, v40, v41
v_mfma_f32_16x16x32_bf16 v[244:247], a[52:55], v[76:79], v[244:247]
v_exp_f32 v42, v42
v_mfma_f32_16x16x32_bf16 v[212:215], a[52:55], v[72:75], v[212:215]
buffer_load_dwordx4 v3, s[48:51], s7 offen offset:1024 sc1 lds
v_mfma_f32_16x16x32_bf16 v[216:219], a[56:59], v[72:75], v[216:219]
ds_read_b128 a[20:23], v1 offset:29696
v_mfma_f32_16x16x32_bf16 v[248:251], a[56:59], v[76:79], v[248:251]
ds_read_b128 a[24:27], v1 offset:30720
v_mfma_f32_16x16x32_bf16 v[252:255], a[60:63], v[76:79], v[252:255]
ds_read_b128 a[28:31], v1 offset:31744
v_mfma_f32_16x16x32_bf16 v[220:223], a[60:63], v[72:75], v[220:223]
s_waitcnt lgkmcnt(4)
v_exp_f32 v43, v43
v_smfmac_f32_16x16x64_bf16 a[228:231], a[232:235], v[72:79], v9
ds_read_b128 a[32:35], v1 offset:16384
v_cvt_pk_bf16_f32 v59, v42, v43
v_mfma_f32_16x16x32_bf16 v[24:27], a[0:3], a[192:195], v[88:91]
ds_read_b128 a[36:39], v1 offset:17408
v_mfma_f32_16x16x32_bf16 v[24:27], a[4:7], a[196:199], v[24:27]
buffer_load_dwordx4 v3, s[48:51], s7 offen offset:2048 sc1 lds
v_mfma_f32_16x16x32_bf16 v[24:27], a[8:11], a[200:203], v[24:27]
ds_read_b128 a[40:43], v1 offset:18432
v_exp_f32 v44, v44
v_mfma_f32_16x16x32_bf16 v[24:27], a[12:15], a[204:207], v[24:27]
ds_read_b128 a[44:47], v1 offset:19456
v_exp_f32 v45, v45
v_mfma_f32_16x16x32_bf16 v[28:31], a[0:3], a[208:211], v[92:95]
ds_read_b128 a[48:51], v1 offset:20480
v_exp_f32 v46, v46
v_mfma_f32_16x16x32_bf16 v[28:31], a[4:7], a[212:215], v[28:31]
s_waitcnt lgkmcnt(5)
v_exp_f32 v47, v47
v_mfma_f32_16x16x32_bf16 v[28:31], a[8:11], a[216:219], v[28:31]
ds_read_b128 a[52:55], v1 offset:21504
v_cvt_pk_bf16_f32 v62, v44, v45
v_mfma_f32_16x16x32_bf16 v[28:31], a[12:15], a[220:223], v[28:31]
ds_read_b128 a[56:59], v1 offset:22528
v_cvt_pk_bf16_f32 v63, v46, v47
v_mfma_f32_16x16x32_bf16 v[40:43], a[16:19], a[192:195], v[88:91]
ds_read_b128 a[60:63], v1 offset:23552
v_xor_b32 v1, 0x8000, v1
v_mfma_f32_16x16x32_bf16 v[40:43], a[20:23], a[196:199], v[40:43]
buffer_load_dwordx4 v3, s[48:51], s7 offen offset:3072 sc1 lds
v_mfma_f32_16x16x32_bf16 v[40:43], a[24:27], a[200:203], v[40:43]
s_add_u32 s7, s7, 0x8000
v_exp_f32 v24, v24
v_mfma_f32_16x16x32_bf16 v[40:43], a[28:31], a[204:207], v[40:43]
s_xor_b32 s27, s27, 0x38000
v_exp_f32 v25, v25
v_mfma_f32_16x16x32_bf16 v[44:47], a[16:19], a[208:211], v[92:95]
s_waitcnt vmcnt(16) lgkmcnt(0)
v_exp_f32 v26, v26
v_mfma_f32_16x16x32_bf16 v[44:47], a[20:23], a[212:215], v[44:47]
s_barrier
v_exp_f32 v27, v27
v_mfma_f32_16x16x32_bf16 v[44:47], a[24:27], a[216:219], v[44:47]
v_exp_f32 v28, v28
v_mfma_f32_16x16x32_bf16 v[44:47], a[28:31], a[220:223], v[44:47]
v_exp_f32 v29, v29
L_att_sodd1:
v_mfma_f32_16x16x32_bf16 v[192:195], a[32:35], v[56:59], v[192:195]
v_exp_f32 v30, v30
v_mfma_f32_16x16x32_bf16 v[224:227], a[32:35], v[60:63], v[224:227]
ds_read_b128 a[0:3], v2 offset:8192
v_cvt_pk_bf16_f32 v72, v24, v25
v_mfma_f32_16x16x32_bf16 v[228:231], a[36:39], v[60:63], v[228:231]
ds_read_b128 a[4:7], v2 offset:9216
v_cvt_pk_bf16_f32 v73, v26, v27
v_mfma_f32_16x16x32_bf16 v[196:199], a[36:39], v[56:59], v[196:199]
s_add_u32 m0, s19, 0x0
v_exp_f32 v31, v31
v_mfma_f32_16x16x32_bf16 v[200:203], a[40:43], v[56:59], v[200:203]
ds_read_b128 a[8:11], v2 offset:10240
v_cvt_pk_bf16_f32 v76, v28, v29
v_mfma_f32_16x16x32_bf16 v[232:235], a[40:43], v[60:63], v[232:235]
buffer_load_dwordx4 v3, s[48:51], s32 offen offset:0 sc1 lds
v_mfma_f32_16x16x32_bf16 v[236:239], a[44:47], v[60:63], v[236:239]
v_exp_f32 v40, v40
v_mfma_f32_16x16x32_bf16 v[204:207], a[44:47], v[56:59], v[204:207]
ds_read_b128 a[12:15], v2 offset:11264
v_cvt_pk_bf16_f32 v77, v30, v31
v_mfma_f32_16x16x32_bf16 v[208:211], a[48:51], v[56:59], v[208:211]
ds_read_b128 a[16:19], v2 offset:12288
v_mfma_f32_16x16x32_bf16 v[240:243], a[48:51], v[60:63], v[240:243]
buffer_load_dwordx4 v3, s[48:51], s32 offen offset:1024 sc1 lds
v_mfma_f32_16x16x32_bf16 v[244:247], a[52:55], v[60:63], v[244:247]
ds_read_b128 a[20:23], v2 offset:13312
v_mfma_f32_16x16x32_bf16 v[212:215], a[52:55], v[56:59], v[212:215]
ds_read_b128 a[24:27], v2 offset:14336
v_mfma_f32_16x16x32_bf16 v[216:219], a[56:59], v[56:59], v[216:219]
ds_read_b128 a[28:31], v2 offset:15360
v_mfma_f32_16x16x32_bf16 v[248:251], a[56:59], v[60:63], v[248:251]
ds_read_b128 a[32:35], v2 offset:0
v_exp_f32 v41, v41
v_mfma_f32_16x16x32_bf16 v[252:255], a[60:63], v[60:63], v[252:255]
v_exp_f32 v42, v42
v_mfma_f32_16x16x32_bf16 v[220:223], a[60:63], v[56:59], v[220:223]
s_waitcnt lgkmcnt(5)
v_exp_f32 v43, v43
v_smfmac_f32_16x16x64_bf16 a[228:231], a[232:235], v[56:63], v9
ds_read_b128 a[36:39], v2 offset:1024
v_cvt_pk_bf16_f32 v74, v40, v41
v_mfma_f32_16x16x32_bf16 v[24:27], a[0:3], a[192:195], v[88:91]
ds_read_b128 a[40:43], v2 offset:2048
v_exp_f32 v44, v44
v_mfma_f32_16x16x32_bf16 v[24:27], a[4:7], a[196:199], v[24:27]
buffer_load_dwordx4 v3, s[48:51], s32 offen offset:2048 sc1 lds
v_mfma_f32_16x16x32_bf16 v[24:27], a[8:11], a[200:203], v[24:27]
v_exp_f32 v45, v45
v_mfma_f32_16x16x32_bf16 v[24:27], a[12:15], a[204:207], v[24:27]
ds_read_b128 a[44:47], v2 offset:3072
v_cvt_pk_bf16_f32 v75, v42, v43
v_mfma_f32_16x16x32_bf16 v[28:31], a[0:3], a[208:211], v[92:95]
ds_read_b128 a[48:51], v2 offset:4096
v_exp_f32 v46, v46
v_mfma_f32_16x16x32_bf16 v[28:31], a[4:7], a[212:215], v[28:31]
s_waitcnt lgkmcnt(5)
v_exp_f32 v47, v47
v_mfma_f32_16x16x32_bf16 v[28:31], a[8:11], a[216:219], v[28:31]
ds_read_b128 a[52:55], v2 offset:5120
v_cvt_pk_bf16_f32 v78, v44, v45
v_mfma_f32_16x16x32_bf16 v[28:31], a[12:15], a[220:223], v[28:31]
buffer_load_dwordx4 v3, s[48:51], s32 offen offset:3072 sc1 lds
v_mfma_f32_16x16x32_bf16 v[40:43], a[16:19], a[192:195], v[88:91]
ds_read_b128 a[56:59], v2 offset:6144
s_add_u32 s32, s32, 0x8000
v_mfma_f32_16x16x32_bf16 v[40:43], a[20:23], a[196:199], v[40:43]
ds_read_b128 a[60:63], v2 offset:7168
v_cvt_pk_bf16_f32 v79, v46, v47
v_mfma_f32_16x16x32_bf16 v[40:43], a[24:27], a[200:203], v[40:43]
v_exp_f32 v24, v24
v_mfma_f32_16x16x32_bf16 v[40:43], a[28:31], a[204:207], v[40:43]
v_exp_f32 v25, v25
v_mfma_f32_16x16x32_bf16 v[44:47], a[16:19], a[208:211], v[92:95]
v_exp_f32 v26, v26
v_mfma_f32_16x16x32_bf16 v[44:47], a[20:23], a[212:215], v[44:47]
v_exp_f32 v27, v27
v_mfma_f32_16x16x32_bf16 v[44:47], a[24:27], a[216:219], v[44:47]
v_exp_f32 v28, v28
v_mfma_f32_16x16x32_bf16 v[44:47], a[28:31], a[220:223], v[44:47]
s_waitcnt lgkmcnt(0)
v_exp_f32 v29, v29
v_mfma_f32_16x16x32_bf16 v[192:195], a[32:35], v[72:75], v[192:195]
v_exp_f32 v30, v30
v_mfma_f32_16x16x32_bf16 v[224:227], a[32:35], v[76:79], v[224:227]
v_exp_f32 v31, v31
v_mfma_f32_16x16x32_bf16 v[228:231], a[36:39], v[76:79], v[228:231]
v_exp_f32 v40, v40
v_mfma_f32_16x16x32_bf16 v[196:199], a[36:39], v[72:75], v[196:199]
s_add_u32 m0, s19, 0x1000
v_exp_f32 v41, v41
v_mfma_f32_16x16x32_bf16 v[200:203], a[40:43], v[72:75], v[200:203]
ds_read_b128 a[0:3], v2 offset:24576
v_cvt_pk_bf16_f32 v56, v24, v25
v_mfma_f32_16x16x32_bf16 v[232:235], a[40:43], v[76:79], v[232:235]
buffer_load_dwordx4 v3, s[48:51], s7 offen offset:0 sc1 lds
v_mfma_f32_16x16x32_bf16 v[236:239], a[44:47], v[76:79], v[236:239]
ds_read_b128 a[4:7], v2 offset:25600
v_cvt_pk_bf16_f32 v57, v26, v27
v_mfma_f32_16x16x32_bf16 v[204:207], a[44:47], v[72:75], v[204:207]
ds_read_b128 a[8:11], v2 offset:26624
v_cvt_pk_bf16_f32 v60, v28, v29
v_mfma_f32_16x16x32_bf16 v[208:211], a[48:51], v[72:75], v[208:211]
ds_read_b128 a[12:15], v2 offset:27648
v_cvt_pk_bf16_f32 v61, v30, v31
v_mfma_f32_16x16x32_bf16 v[240:243], a[48:51], v[76:79], v[240:243]
ds_read_b128 a[16:19], v2 offset:28672
v_cvt_pk_bf16_f32 v58, v40, v41
v_mfma_f32_16x16x32_bf16 v[244:247], a[52:55], v[76:79], v[244:247]
buffer_load_dwordx4 v3, s[48:51], s7 offen offset:1024 sc1 lds
v_mfma_f32_16x16x32_bf16 v[212:215], a[52:55], v[72:75], v[212:215]
ds_read_b128 a[20:23], v2 offset:29696
v_mfma_f32_16x16x32_bf16 v[216:219], a[56:59], v[72:75], v[216:219]
v_exp_f32 v42, v42
v_mfma_f32_16x16x32_bf16 v[248:251], a[56:59], v[76:79], v[248:251]
ds_read_b128 a[24:27], v2 offset:30720
v_mfma_f32_16x16x32_bf16 v[252:255], a[60:63], v[76:79], v[252:255]
ds_read_b128 a[28:31], v2 offset:31744
v_exp_f32 v43, v43
v_mfma_f32_16x16x32_bf16 v[220:223], a[60:63], v[72:75], v[220:223]
ds_read_b128 a[32:35], v2 offset:16384
v_cvt_pk_bf16_f32 v59, v42, v43
v_smfmac_f32_16x16x64_bf16 a[228:231], a[232:235], v[72:79], v9
ds_read_b128 a[36:39], v2 offset:17408
s_waitcnt lgkmcnt(6)
v_mfma_f32_16x16x32_bf16 v[24:27], a[0:3], a[192:195], v[88:91]
buffer_load_dwordx4 v3, s[48:51], s7 offen offset:2048 sc1 lds
v_mfma_f32_16x16x32_bf16 v[24:27], a[4:7], a[196:199], v[24:27]
ds_read_b128 a[40:43], v2 offset:18432
v_exp_f32 v44, v44
v_mfma_f32_16x16x32_bf16 v[24:27], a[8:11], a[200:203], v[24:27]
ds_read_b128 a[44:47], v2 offset:19456
v_exp_f32 v45, v45
v_mfma_f32_16x16x32_bf16 v[24:27], a[12:15], a[204:207], v[24:27]
ds_read_b128 a[48:51], v2 offset:20480
v_cvt_pk_bf16_f32 v62, v44, v45
v_mfma_f32_16x16x32_bf16 v[28:31], a[0:3], a[208:211], v[92:95]
v_exp_f32 v46, v46
v_mfma_f32_16x16x32_bf16 v[28:31], a[4:7], a[212:215], v[28:31]
s_waitcnt lgkmcnt(5)
v_exp_f32 v47, v47
v_mfma_f32_16x16x32_bf16 v[28:31], a[8:11], a[216:219], v[28:31]
ds_read_b128 a[52:55], v2 offset:21504
v_cvt_pk_bf16_f32 v63, v46, v47
v_mfma_f32_16x16x32_bf16 v[28:31], a[12:15], a[220:223], v[28:31]
buffer_load_dwordx4 v3, s[48:51], s7 offen offset:3072 sc1 lds
v_mfma_f32_16x16x32_bf16 v[40:43], a[16:19], a[192:195], v[88:91]
ds_read_b128 a[56:59], v2 offset:22528
s_add_u32 s7, s7, 0x8000
v_mfma_f32_16x16x32_bf16 v[40:43], a[20:23], a[196:199], v[40:43]
ds_read_b128 a[60:63], v2 offset:23552
v_xor_b32 v2, 0x38000, v2
v_mfma_f32_16x16x32_bf16 v[40:43], a[24:27], a[200:203], v[40:43]
s_xor_b32 s19, s19, 0x8000
v_exp_f32 v24, v24
v_mfma_f32_16x16x32_bf16 v[40:43], a[28:31], a[204:207], v[40:43]
s_sub_u32 s15, s15, 1
v_exp_f32 v25, v25
v_mfma_f32_16x16x32_bf16 v[44:47], a[16:19], a[208:211], v[92:95]
s_cmp_lg_u32 s15, 0
s_waitcnt vmcnt(16) lgkmcnt(0)
v_exp_f32 v26, v26
v_mfma_f32_16x16x32_bf16 v[44:47], a[20:23], a[212:215], v[44:47]
s_barrier
v_exp_f32 v27, v27
v_mfma_f32_16x16x32_bf16 v[44:47], a[24:27], a[216:219], v[44:47]
v_exp_f32 v28, v28
v_mfma_f32_16x16x32_bf16 v[44:47], a[28:31], a[220:223], v[44:47]
v_exp_f32 v29, v29
s_cbranch_scc1 L_att_seven1
L_att_sdone:
s_cmp_ge_u32 s4, 2
s_cbranch_scc1 L_att_sh0_1
L_att_sh0_0:
v_mfma_f32_16x16x32_bf16 v[192:195], a[32:35], v[56:59], v[192:195]
v_exp_f32 v30, v30
v_mfma_f32_16x16x32_bf16 v[224:227], a[32:35], v[60:63], v[224:227]
buffer_load_dword v14, v15, s[84:87], 0 offen offset:192 sc1
v_mfma_f32_16x16x32_bf16 v[228:231], a[36:39], v[60:63], v[228:231]
v_exp_f32 v31, v31
v_mfma_f32_16x16x32_bf16 v[196:199], a[36:39], v[56:59], v[196:199]
s_add_u32 m0, s17, 0x10000
v_exp_f32 v40, v40
v_mfma_f32_16x16x32_bf16 v[200:203], a[40:43], v[56:59], v[200:203]
ds_read_b128 a[0:3], v1 offset:8192
v_cvt_pk_bf16_f32 v72, v24, v25
v_mfma_f32_16x16x32_bf16 v[232:235], a[40:43], v[60:63], v[232:235]
ds_read_b128 a[4:7], v1 offset:9216
v_cvt_pk_bf16_f32 v73, v26, v27
v_mfma_f32_16x16x32_bf16 v[236:239], a[44:47], v[60:63], v[236:239]
buffer_load_dwordx4 v12, s[72:75], 0 offen lds
v_mfma_f32_16x16x32_bf16 v[204:207], a[44:47], v[56:59], v[204:207]
ds_read_b128 a[8:11], v1 offset:10240
v_cvt_pk_bf16_f32 v76, v28, v29
v_mfma_f32_16x16x32_bf16 v[208:211], a[48:51], v[56:59], v[208:211]
buffer_load_dwordx4 v13, s[72:75], 0 offen offset:1024 lds
v_mfma_f32_16x16x32_bf16 v[240:243], a[48:51], v[60:63], v[240:243]
ds_read_b128 a[12:15], v1 offset:11264
v_cvt_pk_bf16_f32 v77, v30, v31
v_mfma_f32_16x16x32_bf16 v[244:247], a[52:55], v[60:63], v[244:247]
buffer_load_dwordx4 v12, s[72:75], s12 offen offset:2048 lds
v_mfma_f32_16x16x32_bf16 v[212:215], a[52:55], v[56:59], v[212:215]
ds_read_b128 a[16:19], v1 offset:12288
v_exp_f32 v41, v41
v_mfma_f32_16x16x32_bf16 v[216:219], a[56:59], v[56:59], v[216:219]
ds_read_b128 a[20:23], v1 offset:13312
v_exp_f32 v42, v42
v_mfma_f32_16x16x32_bf16 v[248:251], a[56:59], v[60:63], v[248:251]
buffer_load_dwordx4 v13, s[72:75], s12 offen offset:3072 lds
v_mfma_f32_16x16x32_bf16 v[252:255], a[60:63], v[60:63], v[252:255]
ds_read_b128 a[24:27], v1 offset:14336
s_waitcnt lgkmcnt(3)
v_mfma_f32_16x16x32_bf16 v[220:223], a[60:63], v[56:59], v[220:223]
ds_read_b128 a[28:31], v1 offset:15360
v_add_u32 v12, 0x20000, v12
v_smfmac_f32_16x16x64_bf16 a[228:231], a[232:235], v[56:63], v9
s_add_u32 m0, s17, 0x14000
v_exp_f32 v43, v43
v_mfma_f32_16x16x32_bf16 v[24:27], a[0:3], a[192:195], v[112:115]
buffer_load_dwordx4 v12, s[72:75], 0 offen lds
v_mfma_f32_16x16x32_bf16 v[24:27], a[4:7], a[196:199], v[24:27]
ds_read_b128 a[32:35], v1 offset:0
v_cvt_pk_bf16_f32 v74, v40, v41
v_mfma_f32_16x16x32_bf16 v[24:27], a[8:11], a[200:203], v[24:27]
ds_read_b128 a[36:39], v1 offset:1024
v_exp_f32 v44, v44
v_mfma_f32_16x16x32_bf16 v[24:27], a[12:15], a[204:207], v[24:27]
ds_read_b128 a[40:43], v1 offset:2048
v_exp_f32 v45, v45
v_mfma_f32_16x16x32_bf16 v[28:31], a[0:3], a[208:211], v[92:95]
ds_read_b128 a[44:47], v1 offset:3072
v_exp_f32 v46, v46
v_mfma_f32_16x16x32_bf16 v[28:31], a[4:7], a[212:215], v[28:31]
s_waitcnt lgkmcnt(4)
v_exp_f32 v47, v47
v_mfma_f32_16x16x32_bf16 v[28:31], a[8:11], a[216:219], v[28:31]
ds_read_b128 a[48:51], v1 offset:4096
v_add_u32 v13, 0x20000, v13
v_mfma_f32_16x16x32_bf16 v[28:31], a[12:15], a[220:223], v[28:31]
buffer_load_dwordx4 v13, s[72:75], 0 offen offset:1024 lds
v_cvt_pk_bf16_f32 v75, v42, v43
v_mfma_f32_16x16x32_bf16 v[40:43], a[16:19], a[192:195], v[116:119]
ds_read_b128 a[52:55], v1 offset:5120
v_exp_f32 v24, v24
v_mfma_f32_16x16x32_bf16 v[40:43], a[20:23], a[196:199], v[40:43]
buffer_load_dwordx4 v12, s[72:75], s12 offen offset:2048 lds
v_mfma_f32_16x16x32_bf16 v[40:43], a[24:27], a[200:203], v[40:43]
ds_read_b128 a[56:59], v1 offset:6144
v_exp_f32 v25, v25
v_mfma_f32_16x16x32_bf16 v[40:43], a[28:31], a[204:207], v[40:43]
ds_read_b128 a[60:63], v1 offset:7168
v_cvt_pk_bf16_f32 v78, v44, v45
v_cvt_pk_bf16_f32 v79, v46, v47
v_mfma_f32_16x16x32_bf16 v[44:47], a[16:19], a[208:211], v[92:95]
buffer_load_dwordx4 v13, s[72:75], s12 offen offset:3072 lds
v_mfma_f32_16x16x32_bf16 v[44:47], a[20:23], a[212:215], v[44:47]
v_exp_f32 v26, v26
v_mfma_f32_16x16x32_bf16 v[44:47], a[24:27], a[216:219], v[44:47]
v_exp_f32 v27, v27
v_mfma_f32_16x16x32_bf16 v[44:47], a[28:31], a[220:223], v[44:47]
s_waitcnt lgkmcnt(0)
v_exp_f32 v28, v28
v_exp_f32 v29, v29
v_mfma_f32_16x16x32_bf16 v[192:195], a[32:35], v[72:75], v[192:195]
ds_read_b128 a[0:3], v1 offset:24576
v_cvt_pk_bf16_f32 v56, v24, v25
v_mfma_f32_16x16x32_bf16 v[224:227], a[32:35], v[76:79], v[224:227]
ds_read_b128 a[4:7], v1 offset:25600
v_add_u32 v12, 0x20000, v12
v_mfma_f32_16x16x32_bf16 v[228:231], a[36:39], v[76:79], v[228:231]
s_add_u32 m0, s16, 0x0
v_exp_f32 v30, v30
v_mfma_f32_16x16x32_bf16 v[196:199], a[36:39], v[72:75], v[196:199]
buffer_load_dwordx4 v12, s[72:75], 0 offen lds
v_mfma_f32_16x16x32_bf16 v[200:203], a[40:43], v[72:75], v[200:203]
ds_read_b128 a[8:11], v1 offset:26624
v_add_u32 v13, 0x20000, v13
v_mfma_f32_16x16x32_bf16 v[232:235], a[40:43], v[76:79], v[232:235]
buffer_load_dwordx4 v13, s[72:75], 0 offen offset:1024 lds
v_mfma_f32_16x16x32_bf16 v[236:239], a[44:47], v[76:79], v[236:239]
ds_read_b128 a[12:15], v1 offset:27648
v_cvt_pk_bf16_f32 v57, v26, v27
v_mfma_f32_16x16x32_bf16 v[204:207], a[44:47], v[72:75], v[204:207]
buffer_load_dwordx4 v12, s[72:75], s12 offen offset:2048 lds
v_mfma_f32_16x16x32_bf16 v[208:211], a[48:51], v[72:75], v[208:211]
ds_read_b128 a[16:19], v1 offset:28672
v_cvt_pk_bf16_f32 v60, v28, v29
v_mfma_f32_16x16x32_bf16 v[240:243], a[48:51], v[76:79], v[240:243]
buffer_load_dwordx4 v13, s[72:75], s12 offen offset:3072 lds
v_mfma_f32_16x16x32_bf16 v[244:247], a[52:55], v[76:79], v[244:247]
ds_read_b128 a[20:23], v1 offset:29696
v_exp_f32 v31, v31
v_mfma_f32_16x16x32_bf16 v[212:215], a[52:55], v[72:75], v[212:215]
ds_read_b128 a[24:27], v1 offset:30720
s_add_u32 m0, s16, 0x4000
v_mfma_f32_16x16x32_bf16 v[216:219], a[56:59], v[72:75], v[216:219]
ds_read_b128 a[28:31], v1 offset:31744
v_add_u32 v12, 0x20000, v12
v_mfma_f32_16x16x32_bf16 v[248:251], a[56:59], v[76:79], v[248:251]
buffer_load_dwordx4 v12, s[72:75], 0 offen lds
v_mfma_f32_16x16x32_bf16 v[252:255], a[60:63], v[76:79], v[252:255]
ds_read_b128 a[32:35], v1 offset:16384
s_waitcnt lgkmcnt(5)
v_mfma_f32_16x16x32_bf16 v[220:223], a[60:63], v[72:75], v[220:223]
ds_read_b128 a[36:39], v1 offset:17408
v_add_u32 v13, 0x20000, v13
v_smfmac_f32_16x16x64_bf16 a[228:231], a[232:235], v[72:79], v9
buffer_load_dwordx4 v13, s[72:75], 0 offen offset:1024 lds
v_cvt_pk_bf16_f32 v61, v30, v31
v_mfma_f32_16x16x32_bf16 v[28:31], a[0:3], a[208:211], v[92:95]
ds_read_b128 a[40:43], v1 offset:18432
v_exp_f32 v40, v40
v_mfma_f32_16x16x32_bf16 v[28:31], a[4:7], a[212:215], v[28:31]
buffer_load_dwordx4 v12, s[72:75], s12 offen offset:2048 lds
v_mfma_f32_16x16x32_bf16 v[28:31], a[8:11], a[216:219], v[28:31]
ds_read_b128 a[44:47], v1 offset:19456
v_exp_f32 v41, v41
v_mfma_f32_16x16x32_bf16 v[28:31], a[12:15], a[220:223], v[28:31]
ds_read_b128 a[48:51], v1 offset:20480
s_waitcnt lgkmcnt(5)
v_exp_f32 v42, v42
v_exp_f32 v43, v43
v_exp_f32 v44, v44
v_exp_f32 v45, v45
v_exp_f32 v46, v46
v_exp_f32 v47, v47
v_cvt_pk_bf16_f32 v62, v44, v45
v_cvt_pk_bf16_f32 v63, v46, v47
v_mfma_f32_16x16x32_bf16 v[44:47], a[16:19], a[208:211], v[92:95]
buffer_load_dwordx4 v13, s[72:75], s12 offen offset:3072 lds
v_mfma_f32_16x16x32_bf16 v[44:47], a[20:23], a[212:215], v[44:47]
ds_read_b128 a[52:55], v1 offset:21504
v_cvt_pk_bf16_f32 v58, v40, v41
v_mfma_f32_16x16x32_bf16 v[44:47], a[24:27], a[216:219], v[44:47]
ds_read_b128 a[56:59], v1 offset:22528
v_cvt_pk_bf16_f32 v59, v42, v43
v_mfma_f32_16x16x32_bf16 v[44:47], a[28:31], a[220:223], v[44:47]
ds_read_b128 a[60:63], v1 offset:23552
v_xor_b32 v1, 0x8000, v1
L_att_h1_0:
s_waitcnt vmcnt(16) lgkmcnt(0)
s_mov_b32 s92, 200000
L_spin_b0:
v_cmp_gt_u32 vcc, 32, v14
s_nop 4
s_cbranch_vccz L_spun_b0
s_sub_u32 s92, s92, 1
s_cbranch_scc1 L_spun_b0
s_sleep 6
buffer_load_dword v14, v15, s[84:87], 0 offen offset:192 sc1
s_waitcnt vmcnt(0)
s_branch L_spin_b0
L_spun_b0:
s_barrier
v_mfma_f32_16x16x32_bf16 v[192:195], a[32:35], v[56:59], v[192:195]
ds_read_b128 a[0:3], v2 offset:8192
v_exp_f32 v28, v28
v_mfma_f32_16x16x32_bf16 v[224:227], a[32:35], v[60:63], v[224:227]
ds_read_b128 a[4:7], v2 offset:9216
v_exp_f32 v29, v29
v_mfma_f32_16x16x32_bf16 v[228:231], a[36:39], v[60:63], v[228:231]
s_add_u32 s101, s101, 0x2000
v_exp_f32 v30, v30
v_mfma_f32_16x16x32_bf16 v[196:199], a[36:39], v[56:59], v[196:199]
buffer_load_dwordx4 a[64:67], v3, s[88:91], s101 offen sc1
v_mfma_f32_16x16x32_bf16 v[200:203], a[40:43], v[56:59], v[200:203]
ds_read_b128 a[8:11], v2 offset:10240
v_exp_f32 v31, v31
v_mfma_f32_16x16x32_bf16 v[232:235], a[40:43], v[60:63], v[232:235]
buffer_load_dwordx4 a[68:71], v3, s[88:91], s101 offen offset:1024 sc1
v_mfma_f32_16x16x32_bf16 v[236:239], a[44:47], v[60:63], v[236:239]
ds_read_b128 a[12:15], v2 offset:11264
s_add_u32 s101, s101, 0x2000
v_mfma_f32_16x16x32_bf16 v[204:207], a[44:47], v[56:59], v[204:207]
buffer_load_dwordx4 a[72:75], v3, s[88:91], s101 offen sc1
v_mfma_f32_16x16x32_bf16 v[208:211], a[48:51], v[56:59], v[208:211]
ds_read_b128 a[16:19], v2 offset:12288
v_cvt_pk_bf16_f32 v76, v28, v29
v_mfma_f32_16x16x32_bf16 v[240:243], a[48:51], v[60:63], v[240:243]
buffer_load_dwordx4 a[76:79], v3, s[88:91], s101 offen offset:1024 sc1
v_mfma_f32_16x16x32_bf16 v[244:247], a[52:55], v[60:63], v[244:247]
ds_read_b128 a[20:23], v2 offset:13312
v_exp_f32 v44, v44
v_mfma_f32_16x16x32_bf16 v[212:215], a[52:55], v[56:59], v[212:215]
ds_read_b128 a[24:27], v2 offset:14336
v_exp_f32 v45, v45
v_mfma_f32_16x16x32_bf16 v[216:219], a[56:59], v[56:59], v[216:219]
ds_read_b128 a[28:31], v2 offset:15360
s_add_u32 s101, s101, 0x2000
v_mfma_f32_16x16x32_bf16 v[248:251], a[56:59], v[60:63], v[248:251]
buffer_load_dwordx4 a[80:83], v3, s[88:91], s101 offen sc1
v_mfma_f32_16x16x32_bf16 v[252:255], a[60:63], v[60:63], v[252:255]
ds_read_b128 a[32:35], v2 offset:0
v_cvt_pk_bf16_f32 v77, v30, v31
v_mfma_f32_16x16x32_bf16 v[220:223], a[60:63], v[56:59], v[220:223]
ds_read_b128 a[36:39], v2 offset:1024
s_waitcnt lgkmcnt(6)
v_smfmac_f32_16x16x64_bf16 a[228:231], a[232:235], v[56:63], v9
buffer_load_dwordx4 a[84:87], v3, s[88:91], s101 offen offset:1024 sc1
v_mfma_f32_16x16x32_bf16 v[28:31], a[0:3], a[208:211], v[92:95]
ds_read_b128 a[40:43], v2 offset:2048
v_exp_f32 v46, v46
v_mfma_f32_16x16x32_bf16 v[28:31], a[4:7], a[212:215], v[28:31]
ds_read_b128 a[44:47], v2 offset:3072
s_add_u32 s101, s101, 0x2000
v_mfma_f32_16x16x32_bf16 v[28:31], a[8:11], a[216:219], v[28:31]
buffer_load_dwordx4 a[88:91], v3, s[88:91], s101 offen sc1
v_mfma_f32_16x16x32_bf16 v[28:31], a[12:15], a[220:223], v[28:31]
ds_read_b128 a[48:51], v2 offset:4096
s_waitcnt lgkmcnt(5)
v_exp_f32 v47, v47
v_cvt_pk_bf16_f32 v78, v44, v45
v_cvt_pk_bf16_f32 v79, v46, v47
v_mfma_f32_16x16x32_bf16 v[44:47], a[16:19], a[208:211], v[92:95]
ds_read_b128 a[52:55], v2 offset:5120
v_mfma_f32_16x16x32_bf16 v[44:47], a[20:23], a[212:215], v[44:47]
buffer_load_dwordx4 a[92:95], v3, s[88:91], s101 offen offset:1024 sc1
v_mfma_f32_16x16x32_bf16 v[44:47], a[24:27], a[216:219], v[44:47]
ds_read_b128 a[56:59], v2 offset:6144
v_mfma_f32_16x16x32_bf16 v[44:47], a[28:31], a[220:223], v[44:47]
ds_read_b128 a[60:63], v2 offset:7168
s_waitcnt lgkmcnt(0)
v_mfma_f32_16x16x32_bf16 v[224:227], a[32:35], v[76:79], v[224:227]
ds_read_b128 a[0:3], v2 offset:24576
s_add_u32 s101, s101, 0x2000
v_mfma_f32_16x16x32_bf16 v[228:231], a[36:39], v[76:79], v[228:231]
buffer_load_dwordx4 a[96:99], v3, s[88:91], s101 offen sc1
v_mfma_f32_16x16x32_bf16 v[232:235], a[40:43], v[76:79], v[232:235]
ds_read_b128 a[4:7], v2 offset:25600
v_exp_f32 v28, v28
v_mfma_f32_16x16x32_bf16 v[236:239], a[44:47], v[76:79], v[236:239]
buffer_load_dwordx4 a[100:103], v3, s[88:91], s101 offen offset:1024 sc1
v_mfma_f32_16x16x32_bf16 v[240:243], a[48:51], v[76:79], v[240:243]
ds_read_b128 a[8:11], v2 offset:26624
s_add_u32 s101, s101, 0x2000
v_mfma_f32_16x16x32_bf16 v[244:247], a[52:55], v[76:79], v[244:247]
buffer_load_dwordx4 a[104:107], v3, s[88:91], s101 offen sc1
v_mfma_f32_16x16x32_bf16 v[248:251], a[56:59], v[76:79], v[248:251]
ds_read_b128 a[12:15], v2 offset:27648
s_waitcnt lgkmcnt(0)
v_mfma_f32_16x16x32_bf16 v[252:255], a[60:63], v[76:79], v[252:255]
buffer_load_dwordx4 a[108:111], v3, s[88:91], s101 offen offset:1024 sc1
ds_read_b128 a[16:19], v2 offset:28672
v_mfma_f32_16x16x32_bf16 a[228:231], a[236:239], v[76:79], a[228:231]
ds_read_b128 a[20:23], v2 offset:29696
s_add_u32 s101, s101, 0x2000
v_exp_f32 v29, v29
v_exp_f32 v30, v30
v_exp_f32 v31, v31
v_cvt_pk_bf16_f32 v60, v28, v29
v_cvt_pk_bf16_f32 v61, v30, v31
v_mfma_f32_16x16x32_bf16 v[28:31], a[0:3], a[208:211], v[120:123]
buffer_load_dwordx4 a[112:115], v3, s[88:91], s101 offen sc1
ds_read_b128 a[24:27], v2 offset:30720
v_mfma_f32_16x16x32_bf16 v[28:31], a[4:7], a[212:215], v[28:31]
ds_read_b128 a[28:31], v2 offset:31744
s_waitcnt lgkmcnt(0)
v_mfma_f32_16x16x32_bf16 v[28:31], a[8:11], a[216:219], v[28:31]
buffer_load_dwordx4 a[116:119], v3, s[88:91], s101 offen offset:1024 sc1
v_mfma_f32_16x16x32_bf16 v[28:31], a[12:15], a[220:223], v[28:31]
ds_read_b128 a[32:35], v2 offset:16384
s_add_u32 s101, s101, 0x2000
v_exp_f32 v44, v44
v_exp_f32 v45, v45
v_exp_f32 v46, v46
v_exp_f32 v47, v47
v_cvt_pk_bf16_f32 v62, v44, v45
v_cvt_pk_bf16_f32 v63, v46, v47
v_mfma_f32_16x16x32_bf16 v[44:47], a[16:19], a[208:211], v[124:127]
buffer_load_dwordx4 a[120:123], v3, s[88:91], s101 offen sc1
v_mfma_f32_16x16x32_bf16 v[44:47], a[20:23], a[212:215], v[44:47]
buffer_load_dwordx4 a[124:127], v3, s[88:91], s101 offen offset:1024 sc1
v_mfma_f32_16x16x32_bf16 v[44:47], a[24:27], a[216:219], v[44:47]
ds_read_b128 a[36:39], v2 offset:17408
v_mfma_f32_16x16x32_bf16 v[44:47], a[28:31], a[220:223], v[44:47]
ds_read_b128 a[40:43], v2 offset:18432
ds_read_b128 a[44:47], v2 offset:19456
ds_read_b128 a[48:51], v2 offset:20480
ds_read_b128 a[52:55], v2 offset:21504
ds_read_b128 a[56:59], v2 offset:22528
ds_read_b128 a[60:63], v2 offset:23552
v_xor_b32 v2, 0x38000, v2
s_waitcnt lgkmcnt(0)
s_barrier
v_accvgpr_read_b32 v6, a228
v_accvgpr_read_b32 v7, a229
v_add_f32 v6, v6, v7
v_cmp_nge_f32 vcc, 0x6f800000, v6
v_rcp_f32 v6, v6
s_or_b64 s[34:35], s[34:35], vcc
v_mfma_f32_16x16x32_bf16 v[224:227], a[32:35], v[60:63], v[224:227]
ds_read_b128 a[32:35], v1 offset:0
v_exp_f32 v28, v28
v_mfma_f32_16x16x32_bf16 v[228:231], a[36:39], v[60:63], v[228:231]
ds_read_b128 a[36:39], v1 offset:1024
v_exp_f32 v29, v29
v_mfma_f32_16x16x32_bf16 v[232:235], a[40:43], v[60:63], v[232:235]
ds_read_b128 a[40:43], v1 offset:2048
v_exp_f32 v30, v30
v_mfma_f32_16x16x32_bf16 v[236:239], a[44:47], v[60:63], v[236:239]
ds_read_b128 a[44:47], v1 offset:3072
v_exp_f32 v31, v31
v_mfma_f32_16x16x32_bf16 v[240:243], a[48:51], v[60:63], v[240:243]
ds_read_b128 a[48:51], v1 offset:4096
v_exp_f32 v44, v44
v_mfma_f32_16x16x32_bf16 v[244:247], a[52:55], v[60:63], v[244:247]
ds_read_b128 a[52:55], v1 offset:5120
v_exp_f32 v45, v45
v_mfma_f32_16x16x32_bf16 v[248:251], a[56:59], v[60:63], v[248:251]
ds_read_b128 a[56:59], v1 offset:6144
v_exp_f32 v46, v46
v_mfma_f32_16x16x32_bf16 v[252:255], a[60:63], v[60:63], v[252:255]
ds_read_b128 a[60:63], v1 offset:7168
v_exp_f32 v47, v47
v_mfma_f32_16x16x32_bf16 a[228:231], a[236:239], v[60:63], a[228:231]
v_cvt_pk_bf16_f32 v76, v28, v29
v_cvt_pk_bf16_f32 v77, v30, v31
v_cvt_pk_bf16_f32 v78, v44, v45
v_cvt_pk_bf16_f32 v79, v46, v47
s_add_u32 s8, s30, 0x0
v_pk_mul_f32 v[192:193], v[192:193], v[6:7] op_sel_hi:[1,0]
v_pk_mul_f32 v[194:195], v[194:195], v[6:7] op_sel_hi:[1,0]
v_pk_mul_f32 v[196:197], v[196:197], v[6:7] op_sel_hi:[1,0]
v_pk_mul_f32 v[198:199], v[198:199], v[6:7] op_sel_hi:[1,0]
v_cvt_pk_bf16_f32 v192, v192, v193
v_cvt_pk_bf16_f32 v193, v194, v195
v_cvt_pk_bf16_f32 v194, v196, v197
v_cvt_pk_bf16_f32 v195, v198, v199
buffer_store_dwordx4 v[192:195], v3, s[88:91], s8 offen sc1
s_add_u32 s8, s30, 0x2000
v_pk_mul_f32 v[200:201], v[200:201], v[6:7] op_sel_hi:[1,0]
v_pk_mul_f32 v[202:203], v[202:203], v[6:7] op_sel_hi:[1,0]
v_pk_mul_f32 v[204:205], v[204:205], v[6:7] op_sel_hi:[1,0]
v_pk_mul_f32 v[206:207], v[206:207], v[6:7] op_sel_hi:[1,0]
v_cvt_pk_bf16_f32 v200, v200, v201
v_cvt_pk_bf16_f32 v201, v202, v203
v_cvt_pk_bf16_f32 v202, v204, v205
v_cvt_pk_bf16_f32 v203, v206, v207
buffer_store_dwordx4 v[200:203], v3, s[88:91], s8 offen sc1
s_waitcnt lgkmcnt(0)
v_mfma_f32_16x16x32_bf16 v[224:227], a[32:35], v[76:79], v[224:227]
s_add_u32 s8, s30, 0x4000
v_mul_f32 v208, v6, v208
v_mfma_f32_16x16x32_bf16 v[228:231], a[36:39], v[76:79], v[228:231]
v_mul_f32 v209, v6, v209
v_mul_f32 v210, v6, v210
v_mfma_f32_16x16x32_bf16 v[232:235], a[40:43], v[76:79], v[232:235]
v_mul_f32 v211, v6, v211
v_mul_f32 v212, v6, v212
v_mfma_f32_16x16x32_bf16 v[236:239], a[44:47], v[76:79], v[236:239]
v_mul_f32 v213, v6, v213
v_mul_f32 v214, v6, v214
v_mfma_f32_16x16x32_bf16 v[240:243], a[48:51], v[76:79], v[240:243]
v_mul_f32 v215, v6, v215
v_cvt_pk_bf16_f32 v208, v208, v209
v_mfma_f32_16x16x32_bf16 v[244:247], a[52:55], v[76:79], v[244:247]
v_cvt_pk_bf16_f32 v209, v210, v211
v_cvt_pk_bf16_f32 v210, v212, v213
v_mfma_f32_16x16x32_bf16 v[248:251], a[56:59], v[76:79], v[248:251]
v_cvt_pk_bf16_f32 v211, v214, v215
buffer_store_dwordx4 v[208:211], v3, s[88:91], s8 offen sc1
v_mfma_f32_16x16x32_bf16 v[252:255], a[60:63], v[76:79], v[252:255]
s_add_u32 s8, s30, 0x6000
v_mul_f32 v216, v6, v216
v_mfma_f32_16x16x32_bf16 a[228:231], a[236:239], v[76:79], a[228:231]
v_mul_f32 v217, v6, v217
v_mul_f32 v218, v6, v218
v_mul_f32 v219, v6, v219
v_mul_f32 v220, v6, v220
v_mul_f32 v221, v6, v221
v_mul_f32 v222, v6, v222
v_mul_f32 v223, v6, v223
v_cvt_pk_bf16_f32 v216, v216, v217
v_cvt_pk_bf16_f32 v217, v218, v219
v_cvt_pk_bf16_f32 v218, v220, v221
v_cvt_pk_bf16_f32 v219, v222, v223
buffer_store_dwordx4 v[216:219], v3, s[88:91], s8 offen sc1
s_branch L_att_fin
L_att_sh0_1:
v_mfma_f32_16x16x32_bf16 v[192:195], a[32:35], v[56:59], v[192:195]
v_exp_f32 v30, v30
v_mfma_f32_16x16x32_bf16 v[224:227], a[32:35], v[60:63], v[224:227]
buffer_load_dword v14, v15, s[84:87], 0 offen offset:192 sc1
v_mfma_f32_16x16x32_bf16 v[228:231], a[36:39], v[60:63], v[228:231]
v_exp_f32 v31, v31
v_mfma_f32_16x16x32_bf16 v[196:199], a[36:39], v[56:59], v[196:199]
s_add_u32 m0, s17, 0x10000
v_exp_f32 v40, v40
v_mfma_f32_16x16x32_bf16 v[200:203], a[40:43], v[56:59], v[200:203]
ds_read_b128 a[0:3], v1 offset:8192
v_cvt_pk_bf16_f32 v72, v24, v25
v_mfma_f32_16x16x32_bf16 v[232:235], a[40:43], v[60:63], v[232:235]
ds_read_b128 a[4:7], v1 offset:9216
v_cvt_pk_bf16_f32 v73, v26, v27
v_mfma_f32_16x16x32_bf16 v[236:239], a[44:47], v[60:63], v[236:239]
buffer_load_dwordx4 v12, s[72:75], 0 offen lds
v_mfma_f32_16x16x32_bf16 v[204:207], a[44:47], v[56:59], v[204:207]
ds_read_b128 a[8:11], v1 offset:10240
v_cvt_pk_bf16_f32 v76, v28, v29
v_mfma_f32_16x16x32_bf16 v[208:211], a[48:51], v[56:59], v[208:211]
buffer_load_dwordx4 v13, s[72:75], 0 offen offset:1024 lds
v_mfma_f32_16x16x32_bf16 v[240:243], a[48:51], v[60:63], v[240:243]
ds_read_b128 a[12:15], v1 offset:11264
v_cvt_pk_bf16_f32 v77, v30, v31
v_mfma_f32_16x16x32_bf16 v[244:247], a[52:55], v[60:63], v[244:247]
buffer_load_dwordx4 v12, s[72:75], s12 offen offset:2048 lds
v_mfma_f32_16x16x32_bf16 v[212:215], a[52:55], v[56:59], v[212:215]
ds_read_b128 a[16:19], v1 offset:12288
v_exp_f32 v41, v41
v_mfma_f32_16x16x32_bf16 v[216:219], a[56:59], v[56:59], v[216:219]
ds_read_b128 a[20:23], v1 offset:13312
v_exp_f32 v42, v42
v_mfma_f32_16x16x32_bf16 v[248:251], a[56:59], v[60:63], v[248:251]
buffer_load_dwordx4 v13, s[72:75], s12 offen offset:3072 lds
v_mfma_f32_16x16x32_bf16 v[252:255], a[60:63], v[60:63], v[252:255]
ds_read_b128 a[24:27], v1 offset:14336
s_waitcnt lgkmcnt(3)
v_mfma_f32_16x16x32_bf16 v[220:223], a[60:63], v[56:59], v[220:223]
ds_read_b128 a[28:31], v1 offset:15360
v_add_u32 v12, 0x20000, v12
v_smfmac_f32_16x16x64_bf16 a[228:231], a[232:235], v[56:63], v9
s_add_u32 m0, s17, 0x14000
v_exp_f32 v43, v43
v_mfma_f32_16x16x32_bf16 v[24:27], a[0:3], a[192:195], v[88:91]
buffer_load_dwordx4 v12, s[72:75], 0 offen lds
v_mfma_f32_16x16x32_bf16 v[24:27], a[4:7], a[196:199], v[24:27]
ds_read_b128 a[32:35], v1 offset:0
v_cvt_pk_bf16_f32 v74, v40, v41
v_mfma_f32_16x16x32_bf16 v[24:27], a[8:11], a[200:203], v[24:27]
ds_read_b128 a[36:39], v1 offset:1024
v_exp_f32 v44, v44
v_mfma_f32_16x16x32_bf16 v[24:27], a[12:15], a[204:207], v[24:27]
ds_read_b128 a[40:43], v1 offset:2048
v_exp_f32 v45, v45
v_mfma_f32_16x16x32_bf16 v[28:31], a[0:3], a[208:211], v[92:95]
ds_read_b128 a[44:47], v1 offset:3072
v_exp_f32 v46, v46
v_mfma_f32_16x16x32_bf16 v[28:31], a[4:7], a[212:215], v[28:31]
s_waitcnt lgkmcnt(4)
v_exp_f32 v47, v47
v_mfma_f32_16x16x32_bf16 v[28:31], a[8:11], a[216:219], v[28:31]
ds_read_b128 a[48:51], v1 offset:4096
v_add_u32 v13, 0x20000, v13
v_mfma_f32_16x16x32_bf16 v[28:31], a[12:15], a[220:223], v[28:31]
buffer_load_dwordx4 v13, s[72:75], 0 offen offset:1024 lds
v_cvt_pk_bf16_f32 v75, v42, v43
v_mfma_f32_16x16x32_bf16 v[40:43], a[16:19], a[192:195], v[88:91]
ds_read_b128 a[52:55], v1 offset:5120
v_exp_f32 v24, v24
v_mfma_f32_16x16x32_bf16 v[40:43], a[20:23], a[196:199], v[40:43]
buffer_load_dwordx4 v12, s[72:75], s12 offen offset:2048 lds
v_mfma_f32_16x16x32_bf16 v[40:43], a[24:27], a[200:203], v[40:43]
ds_read_b128 a[56:59], v1 offset:6144
v_exp_f32 v25, v25
v_mfma_f32_16x16x32_bf16 v[40:43], a[28:31], a[204:207], v[40:43]
ds_read_b128 a[60:63], v1 offset:7168
v_cvt_pk_bf16_f32 v78, v44, v45
v_cvt_pk_bf16_f32 v79, v46, v47
v_mfma_f32_16x16x32_bf16 v[44:47], a[16:19], a[208:211], v[92:95]
buffer_load_dwordx4 v13, s[72:75], s12 offen offset:3072 lds
v_mfma_f32_16x16x32_bf16 v[44:47], a[20:23], a[212:215], v[44:47]
v_exp_f32 v26, v26
v_mfma_f32_16x16x32_bf16 v[44:47], a[24:27], a[216:219], v[44:47]
v_exp_f32 v27, v27
v_mfma_f32_16x16x32_bf16 v[44:47], a[28:31], a[220:223], v[44:47]
s_waitcnt lgkmcnt(0)
v_exp_f32 v28, v28
v_exp_f32 v29, v29
v_mfma_f32_16x16x32_bf16 v[192:195], a[32:35], v[72:75], v[192:195]
s_add_u32 m0, s16, 0x0
v_add_u32 v12, 0x20000, v12
v_cvt_pk_bf16_f32 v56, v24, v25
v_mfma_f32_16x16x32_bf16 v[224:227], a[32:35], v[76:79], v[224:227]
buffer_load_dwordx4 v12, s[72:75], 0 offen lds
v_mfma_f32_16x16x32_bf16 v[228:231], a[36:39], v[76:79], v[228:231]
ds_read_b128 a[0:3], v1 offset:24576
v_cvt_pk_bf16_f32 v57, v26, v27
v_mfma_f32_16x16x32_bf16 v[196:199], a[36:39], v[72:75], v[196:199]
v_exp_f32 v30, v30
v_mfma_f32_16x16x32_bf16 v[200:203], a[40:43], v[72:75], v[200:203]
ds_read_b128 a[4:7], v1 offset:25600
v_cvt_pk_bf16_f32 v60, v28, v29
v_mfma_f32_16x16x32_bf16 v[232:235], a[40:43], v[76:79], v[232:235]
ds_read_b128 a[8:11], v1 offset:26624
v_add_u32 v13, 0x20000, v13
v_mfma_f32_16x16x32_bf16 v[236:239], a[44:47], v[76:79], v[236:239]
buffer_load_dwordx4 v13, s[72:75], 0 offen offset:1024 lds
v_mfma_f32_16x16x32_bf16 v[204:207], a[44:47], v[72:75], v[204:207]
ds_read_b128 a[12:15], v1 offset:27648
v_exp_f32 v31, v31
v_mfma_f32_16x16x32_bf16 v[208:211], a[48:51], v[72:75], v[208:211]
buffer_load_dwordx4 v12, s[72:75], s12 offen offset:2048 lds
v_mfma_f32_16x16x32_bf16 v[240:243], a[48:51], v[76:79], v[240:243]
ds_read_b128 a[16:19], v1 offset:28672
v_exp_f32 v40, v40
v_mfma_f32_16x16x32_bf16 v[244:247], a[52:55], v[76:79], v[244:247]
ds_read_b128 a[20:23], v1 offset:29696
v_cvt_pk_bf16_f32 v61, v30, v31
v_mfma_f32_16x16x32_bf16 v[212:215], a[52:55], v[72:75], v[212:215]
buffer_load_dwordx4 v13, s[72:75], s12 offen offset:3072 lds
v_mfma_f32_16x16x32_bf16 v[216:219], a[56:59], v[72:75], v[216:219]
ds_read_b128 a[24:27], v1 offset:30720
v_exp_f32 v41, v41
v_mfma_f32_16x16x32_bf16 v[248:251], a[56:59], v[76:79], v[248:251]
ds_read_b128 a[28:31], v1 offset:31744
v_exp_f32 v42, v42
v_mfma_f32_16x16x32_bf16 v[252:255], a[60:63], v[76:79], v[252:255]
ds_read_b128 a[32:35], v1 offset:16384
v_cvt_pk_bf16_f32 v58, v40, v41
v_mfma_f32_16x16x32_bf16 v[220:223], a[60:63], v[72:75], v[220:223]
s_waitcnt lgkmcnt(5)
v_exp_f32 v43, v43
v_smfmac_f32_16x16x64_bf16 a[228:231], a[232:235], v[72:79], v9
ds_read_b128 a[36:39], v1 offset:17408
v_add_u32 v12, 0x20000, v12
v_mfma_f32_16x16x32_bf16 v[24:27], a[0:3], a[192:195], v[112:115]
s_add_u32 m0, s16, 0x4000
v_exp_f32 v44, v44
v_mfma_f32_16x16x32_bf16 v[24:27], a[4:7], a[196:199], v[24:27]
buffer_load_dwordx4 v12, s[72:75], 0 offen lds
v_mfma_f32_16x16x32_bf16 v[24:27], a[8:11], a[200:203], v[24:27]
ds_read_b128 a[40:43], v1 offset:18432
v_add_u32 v13, 0x20000, v13
v_mfma_f32_16x16x32_bf16 v[24:27], a[12:15], a[204:207], v[24:27]
buffer_load_dwordx4 v13, s[72:75], 0 offen offset:1024 lds
v_mfma_f32_16x16x32_bf16 v[28:31], a[0:3], a[208:211], v[92:95]
ds_read_b128 a[44:47], v1 offset:19456
v_cvt_pk_bf16_f32 v59, v42, v43
v_mfma_f32_16x16x32_bf16 v[28:31], a[4:7], a[212:215], v[28:31]
ds_read_b128 a[48:51], v1 offset:20480
v_exp_f32 v45, v45
v_mfma_f32_16x16x32_bf16 v[28:31], a[8:11], a[216:219], v[28:31]
s_waitcnt lgkmcnt(5)
v_exp_f32 v46, v46
v_mfma_f32_16x16x32_bf16 v[28:31], a[12:15], a[220:223], v[28:31]
buffer_load_dwordx4 v12, s[72:75], s12 offen offset:2048 lds
v_mfma_f32_16x16x32_bf16 v[40:43], a[16:19], a[192:195], v[116:119]
ds_read_b128 a[52:55], v1 offset:21504
v_exp_f32 v47, v47
v_mfma_f32_16x16x32_bf16 v[40:43], a[20:23], a[196:199], v[40:43]
ds_read_b128 a[56:59], v1 offset:22528
v_exp_f32 v24, v24
v_mfma_f32_16x16x32_bf16 v[40:43], a[24:27], a[200:203], v[40:43]
ds_read_b128 a[60:63], v1 offset:23552
v_xor_b32 v1, 0x8000, v1
v_mfma_f32_16x16x32_bf16 v[40:43], a[28:31], a[204:207], v[40:43]
v_exp_f32 v25, v25
v_cvt_pk_bf16_f32 v62, v44, v45
v_cvt_pk_bf16_f32 v63, v46, v47
v_mfma_f32_16x16x32_bf16 v[44:47], a[16:19], a[208:211], v[92:95]
v_exp_f32 v26, v26
v_mfma_f32_16x16x32_bf16 v[44:47], a[20:23], a[212:215], v[44:47]
buffer_load_dwordx4 v13, s[72:75], s12 offen offset:3072 lds
v_mfma_f32_16x16x32_bf16 v[44:47], a[24:27], a[216:219], v[44:47]
v_exp_f32 v27, v27
v_mfma_f32_16x16x32_bf16 v[44:47], a[28:31], a[220:223], v[44:47]
v_exp_f32 v28, v28
v_exp_f32 v29, v29
L_att_h1_1:
s_waitcnt vmcnt(16) lgkmcnt(0)
s_mov_b32 s92, 200000
L_spin_b1:
v_cmp_gt_u32 vcc, 32, v14
s_nop 4
s_cbranch_vccz L_spun_b1
s_sub_u32 s92, s92, 1
s_cbranch_scc1 L_spun_b1
s_sleep 6
buffer_load_dword v14, v15, s[84:87], 0 offen offset:192 sc1
s_waitcnt vmcnt(0)
s_branch L_spin_b1
L_spun_b1:
s_barrier
v_mfma_f32_16x16x32_bf16 v[192:195], a[32:35], v[56:59], v[192:195]
ds_read_b128 a[0:3], v2 offset:8192
v_cvt_pk_bf16_f32 v72, v24, v25
v_mfma_f32_16x16x32_bf16 v[224:227], a[32:35], v[60:63], v[224:227]
ds_read_b128 a[4:7], v2 offset:9216
v_cvt_pk_bf16_f32 v73, v26, v27
v_mfma_f32_16x16x32_bf16 v[228:231], a[36:39], v[60:63], v[228:231]
s_add_u32 s101, s101, 0x2000
v_exp_f32 v30, v30
v_mfma_f32_16x16x32_bf16 v[196:199], a[36:39], v[56:59], v[196:199]
buffer_load_dwordx4 a[64:67], v3, s[88:91], s101 offen sc1
v_mfma_f32_16x16x32_bf16 v[200:203], a[40:43], v[56:59], v[200:203]
ds_read_b128 a[8:11], v2 offset:10240
v_cvt_pk_bf16_f32 v76, v28, v29
v_mfma_f32_16x16x32_bf16 v[232:235], a[40:43], v[60:63], v[232:235]
buffer_load_dwordx4 a[68:71], v3, s[88:91], s101 offen offset:1024 sc1
v_mfma_f32_16x16x32_bf16 v[236:239], a[44:47], v[60:63], v[236:239]
ds_read_b128 a[12:15], v2 offset:11264
s_add_u32 s101, s101, 0x2000
v_mfma_f32_16x16x32_bf16 v[204:207], a[44:47], v[56:59], v[204:207]
buffer_load_dwordx4 a[72:75], v3, s[88:91], s101 offen sc1
v_mfma_f32_16x16x32_bf16 v[208:211], a[48:51], v[56:59], v[208:211]
ds_read_b128 a[16:19], v2 offset:12288
v_exp_f32 v31, v31
v_mfma_f32_16x16x32_bf16 v[240:243], a[48:51], v[60:63], v[240:243]
buffer_load_dwordx4 a[76:79], v3, s[88:91], s101 offen offset:1024 sc1
v_mfma_f32_16x16x32_bf16 v[244:247], a[52:55], v[60:63], v[244:247]
ds_read_b128 a[20:23], v2 offset:13312
v_exp_f32 v40, v40
v_mfma_f32_16x16x32_bf16 v[212:215], a[52:55], v[56:59], v[212:215]
ds_read_b128 a[24:27], v2 offset:14336
v_exp_f32 v41, v41
v_mfma_f32_16x16x32_bf16 v[216:219], a[56:59], v[56:59], v[216:219]
ds_read_b128 a[28:31], v2 offset:15360
s_add_u32 s101, s101, 0x2000
v_mfma_f32_16x16x32_bf16 v[248:251], a[56:59], v[60:63], v[248:251]
buffer_load_dwordx4 a[80:83], v3, s[88:91], s101 offen sc1
v_mfma_f32_16x16x32_bf16 v[252:255], a[60:63], v[60:63], v[252:255]
ds_read_b128 a[32:35], v2 offset:0
v_cvt_pk_bf16_f32 v77, v30, v31
v_mfma_f32_16x16x32_bf16 v[220:223], a[60:63], v[56:59], v[220:223]
ds_read_b128 a[36:39], v2 offset:1024
s_waitcnt lgkmcnt(6)
v_smfmac_f32_16x16x64_bf16 a[228:231], a[232:235], v[56:63], v9
buffer_load_dwordx4 a[84:87], v3, s[88:91], s101 offen offset:1024 sc1
v_mfma_f32_16x16x32_bf16 v[28:31], a[0:3], a[208:211], v[120:123]
ds_read_b128 a[40:43], v2 offset:2048
v_exp_f32 v42, v42
v_mfma_f32_16x16x32_bf16 v[28:31], a[4:7], a[212:215], v[28:31]
ds_read_b128 a[44:47], v2 offset:3072
s_add_u32 s101, s101, 0x2000
v_mfma_f32_16x16x32_bf16 v[28:31], a[8:11], a[216:219], v[28:31]
buffer_load_dwordx4 a[88:91], v3, s[88:91], s101 offen sc1
v_mfma_f32_16x16x32_bf16 v[28:31], a[12:15], a[220:223], v[28:31]
ds_read_b128 a[48:51], v2 offset:4096
s_waitcnt lgkmcnt(5)
v_exp_f32 v43, v43
v_exp_f32 v44, v44
v_exp_f32 v45, v45
v_exp_f32 v46, v46
v_exp_f32 v47, v47
v_cvt_pk_bf16_f32 v78, v44, v45
v_cvt_pk_bf16_f32 v79, v46, v47
v_mfma_f32_16x16x32_bf16 v[44:47], a[16:19], a[208:211], v[124:127]
ds_read_b128 a[52:55], v2 offset:5120
v_cvt_pk_bf16_f32 v74, v40, v41
v_mfma_f32_16x16x32_bf16 v[44:47], a[20:23], a[212:215], v[44:47]
buffer_load_dwordx4 a[92:95], v3, s[88:91], s101 offen offset:1024 sc1
v_mfma_f32_16x16x32_bf16 v[44:47], a[24:27], a[216:219], v[44:47]
ds_read_b128 a[56:59], v2 offset:6144
v_cvt_pk_bf16_f32 v75, v42, v43
v_mfma_f32_16x16x32_bf16 v[44:47], a[28:31], a[220:223], v[44:47]
ds_read_b128 a[60:63], v2 offset:7168
s_waitcnt lgkmcnt(0)
v_mfma_f32_16x16x32_bf16 v[192:195], a[32:35], v[72:75], v[192:195]
s_add_u32 s101, s101, 0x2000
v_exp_f32 v28, v28
v_mfma_f32_16x16x32_bf16 v[224:227], a[32:35], v[76:79], v[224:227]
buffer_load_dwordx4 a[96:99], v3, s[88:91], s101 offen sc1
v_mfma_f32_16x16x32_bf16 v[228:231], a[36:39], v[76:79], v[228:231]
ds_read_b128 a[32:35], v2 offset:16384
v_exp_f32 v29, v29
v_mfma_f32_16x16x32_bf16 v[196:199], a[36:39], v[72:75], v[196:199]
buffer_load_dwordx4 a[100:103], v3, s[88:91], s101 offen offset:1024 sc1
v_mfma_f32_16x16x32_bf16 v[200:203], a[40:43], v[72:75], v[200:203]
ds_read_b128 a[36:39], v2 offset:17408
s_add_u32 s101, s101, 0x2000
v_mfma_f32_16x16x32_bf16 v[232:235], a[40:43], v[76:79], v[232:235]
buffer_load_dwordx4 a[104:107], v3, s[88:91], s101 offen sc1
v_mfma_f32_16x16x32_bf16 v[236:239], a[44:47], v[76:79], v[236:239]
ds_read_b128 a[40:43], v2 offset:18432
v_exp_f32 v30, v30
v_mfma_f32_16x16x32_bf16 v[204:207], a[44:47], v[72:75], v[204:207]
buffer_load_dwordx4 a[108:111], v3, s[88:91], s101 offen offset:1024 sc1
v_mfma_f32_16x16x32_bf16 v[208:211], a[48:51], v[72:75], v[208:211]
ds_read_b128 a[44:47], v2 offset:19456
s_add_u32 s101, s101, 0x2000
v_mfma_f32_16x16x32_bf16 v[240:243], a[48:51], v[76:79], v[240:243]
buffer_load_dwordx4 a[112:115], v3, s[88:91], s101 offen sc1
v_mfma_f32_16x16x32_bf16 v[244:247], a[52:55], v[76:79], v[244:247]
ds_read_b128 a[48:51], v2 offset:20480
v_exp_f32 v31, v31
v_mfma_f32_16x16x32_bf16 v[212:215], a[52:55], v[72:75], v[212:215]
buffer_load_dwordx4 a[116:119], v3, s[88:91], s101 offen offset:1024 sc1
v_mfma_f32_16x16x32_bf16 v[216:219], a[56:59], v[72:75], v[216:219]
ds_read_b128 a[52:55], v2 offset:21504
s_add_u32 s101, s101, 0x2000
v_mfma_f32_16x16x32_bf16 v[248:251], a[56:59], v[76:79], v[248:251]
buffer_load_dwordx4 a[120:123], v3, s[88:91], s101 offen sc1
v_mfma_f32_16x16x32_bf16 v[252:255], a[60:63], v[76:79], v[252:255]
buffer_load_dwordx4 a[124:127], v3, s[88:91], s101 offen offset:1024 sc1
v_mfma_f32_16x16x32_bf16 v[220:223], a[60:63], v[72:75], v[220:223]
ds_read_b128 a[56:59], v2 offset:22528
v_cvt_pk_bf16_f32 v60, v28, v29
v_smfmac_f32_16x16x64_bf16 a[228:231], a[232:235], v[72:79], v9
ds_read_b128 a[60:63], v2 offset:23552
v_xor_b32 v2, 0x38000, v2
v_exp_f32 v44, v44
v_exp_f32 v45, v45
v_exp_f32 v46, v46
v_exp_f32 v47, v47
v_cvt_pk_bf16_f32 v61, v30, v31
v_cvt_pk_bf16_f32 v62, v44, v45
v_cvt_pk_bf16_f32 v63, v46, v47
s_waitcnt lgkmcnt(0)
s_barrier
v_accvgpr_read_b32 v6, a228
v_accvgpr_read_b32 v7, a229
v_add_f32 v6, v6, v7
v_cmp_nge_f32 vcc, 0x6f800000, v6
v_rcp_f32 v6, v6
s_or_b64 s[34:35], s[34:35], vcc
v_mfma_f32_16x16x32_bf16 v[224:227], a[32:35], v[60:63], v[224:227]
s_add_u32 s8, s30, 0x0
v_mul_f32 v192, v6, v192
v_mfma_f32_16x16x32_bf16 v[228:231], a[36:39], v[60:63], v[228:231]
v_mul_f32 v193, v6, v193
v_mul_f32 v194, v6, v194
v_mfma_f32_16x16x32_bf16 v[232:235], a[40:43], v[60:63], v[232:235]
v_mul_f32 v195, v6, v195
v_mul_f32 v196, v6, v196
v_mfma_f32_16x16x32_bf16 v[236:239], a[44:47], v[60:63], v[236:239]
v_mul_f32 v197, v6, v197
v_mul_f32 v198, v6, v198
v_mfma_f32_16x16x32_bf16 v[240:243], a[48:51], v[60:63], v[240:243]
v_mul_f32 v199, v6, v199
v_cvt_pk_bf16_f32 v192, v192, v193
v_mfma_f32_16x16x32_bf16 v[244:247], a[52:55], v[60:63], v[244:247]
v_cvt_pk_bf16_f32 v193, v194, v195
v_cvt_pk_bf16_f32 v194, v196, v197
v_mfma_f32_16x16x32_bf16 v[248:251], a[56:59], v[60:63], v[248:251]
v_cvt_pk_bf16_f32 v195, v198, v199
buffer_store_dwordx4 v[192:195], v3, s[88:91], s8 offen sc1
v_mfma_f32_16x16x32_bf16 v[252:255], a[60:63], v[60:63], v[252:255]
v_mfma_f32_16x16x32_bf16 a[228:231], a[236:239], v[60:63], a[228:231]
s_add_u32 s8, s30, 0x2000
v_pk_mul_f32 v[200:201], v[200:201], v[6:7] op_sel_hi:[1,0]
v_pk_mul_f32 v[202:203], v[202:203], v[6:7] op_sel_hi:[1,0]
v_pk_mul_f32 v[204:205], v[204:205], v[6:7] op_sel_hi:[1,0]
v_pk_mul_f32 v[206:207], v[206:207], v[6:7] op_sel_hi:[1,0]
v_cvt_pk_bf16_f32 v200, v200, v201
v_cvt_pk_bf16_f32 v201, v202, v203
v_cvt_pk_bf16_f32 v202, v204, v205
v_cvt_pk_bf16_f32 v203, v206, v207
buffer_store_dwordx4 v[200:203], v3, s[88:91], s8 offen sc1
s_add_u32 s8, s30, 0x4000
v_pk_mul_f32 v[208:209], v[208:209], v[6:7] op_sel_hi:[1,0]
v_pk_mul_f32 v[210:211], v[210:211], v[6:7] op_sel_hi:[1,0]
v_pk_mul_f32 v[212:213], v[212:213], v[6:7] op_sel_hi:[1,0]
v_pk_mul_f32 v[214:215], v[214:215], v[6:7] op_sel_hi:[1,0]
v_cvt_pk_bf16_f32 v208, v208, v209
v_cvt_pk_bf16_f32 v209, v210, v211
v_cvt_pk_bf16_f32 v210, v212, v213
v_cvt_pk_bf16_f32 v211, v214, v215
buffer_store_dwordx4 v[208:211], v3, s[88:91], s8 offen sc1
s_add_u32 s8, s30, 0x6000
v_pk_mul_f32 v[216:217], v[216:217], v[6:7] op_sel_hi:[1,0]
v_pk_mul_f32 v[218:219], v[218:219], v[6:7] op_sel_hi:[1,0]
v_pk_mul_f32 v[220:221], v[220:221], v[6:7] op_sel_hi:[1,0]
v_pk_mul_f32 v[222:223], v[222:223], v[6:7] op_sel_hi:[1,0]
v_cvt_pk_bf16_f32 v216, v216, v217
v_cvt_pk_bf16_f32 v217, v218, v219
v_cvt_pk_bf16_f32 v218, v220, v221
v_cvt_pk_bf16_f32 v219, v222, v223
buffer_store_dwordx4 v[216:219], v3, s[88:91], s8 offen sc1
L_att_fin:
v_accvgpr_read_b32 v6, a230
v_accvgpr_read_b32 v7, a231
v_add_f32 v6, v6, v7
v_cmp_nge_f32 vcc, 0x6f800000, v6
v_rcp_f32 v6, v6
s_or_b64 s[34:35], s[34:35], vcc
s_add_u32 s8, s31, 0x0
v_pk_mul_f32 v[224:225], v[224:225], v[6:7] op_sel_hi:[1,0]
v_pk_mul_f32 v[226:227], v[226:227], v[6:7] op_sel_hi:[1,0]
v_pk_mul_f32 v[228:229], v[228:229], v[6:7] op_sel_hi:[1,0]
v_pk_mul_f32 v[230:231], v[230:231], v[6:7] op_sel_hi:[1,0]
v_cvt_pk_bf16_f32 v224, v224, v225
v_cvt_pk_bf16_f32 v225, v226, v227
v_cvt_pk_bf16_f32 v226, v228, v229
v_cvt_pk_bf16_f32 v227, v230, v231
buffer_store_dwordx4 v[224:227], v3, s[88:91], s8 offen sc1
s_add_u32 s8, s31, 0x2000
v_pk_mul_f32 v[232:233], v[232:233], v[6:7] op_sel_hi:[1,0]
v_pk_mul_f32 v[234:235], v[234:235], v[6:7] op_sel_hi:[1,0]
v_pk_mul_f32 v[236:237], v[236:237], v[6:7] op_sel_hi:[1,0]
v_pk_mul_f32 v[238:239], v[238:239], v[6:7] op_sel_hi:[1,0]
v_cvt_pk_bf16_f32 v232, v232, v233
v_cvt_pk_bf16_f32 v233, v234, v235
v_cvt_pk_bf16_f32 v234, v236, v237
v_cvt_pk_bf16_f32 v235, v238, v239
buffer_store_dwordx4 v[232:235], v3, s[88:91], s8 offen sc1
s_add_u32 s8, s31, 0x4000
v_pk_mul_f32 v[240:241], v[240:241], v[6:7] op_sel_hi:[1,0]
v_pk_mul_f32 v[242:243], v[242:243], v[6:7] op_sel_hi:[1,0]
v_pk_mul_f32 v[244:245], v[244:245], v[6:7] op_sel_hi:[1,0]
v_pk_mul_f32 v[246:247], v[246:247], v[6:7] op_sel_hi:[1,0]
v_cvt_pk_bf16_f32 v240, v240, v241
v_cvt_pk_bf16_f32 v241, v242, v243
v_cvt_pk_bf16_f32 v242, v244, v245
v_cvt_pk_bf16_f32 v243, v246, v247
buffer_store_dwordx4 v[240:243], v3, s[88:91], s8 offen sc1
s_add_u32 s8, s31, 0x6000
v_pk_mul_f32 v[248:249], v[248:249], v[6:7] op_sel_hi:[1,0]
v_pk_mul_f32 v[250:251], v[250:251], v[6:7] op_sel_hi:[1,0]
v_pk_mul_f32 v[252:253], v[252:253], v[6:7] op_sel_hi:[1,0]
v_pk_mul_f32 v[254:255], v[254:255], v[6:7] op_sel_hi:[1,0]
v_cvt_pk_bf16_f32 v248, v248, v249
v_cvt_pk_bf16_f32 v249, v250, v251
v_cvt_pk_bf16_f32 v250, v252, v253
v_cvt_pk_bf16_f32 v251, v254, v255
buffer_store_dwordx4 v[248:251], v3, s[88:91], s8 offen sc1
s_cmp_lg_u64 s[34:35], 0
s_cselect_b32 s8, 1, 0
s_lshl_b32 s9, s4, 2
s_add_u32 s9, s9, 24576
v_mov_b32 v4, s9
v_mov_b32 v5, s8
ds_write_b32 v4, v5
v_lshrrev_b32 v17, 4, v0
v_lshlrev_b32 v18, 10, v17
v_and_b32 v17, 1, v17
v_lshl_add_u32 v18, v17, 5, v18
v_bfe_u32 v17, v0, 2, 2
v_lshl_add_u32 v18, v17, 6, v18
v_and_b32 v17, 3, v0
v_lshl_add_u32 v4, v17, 3, v18
s_sub_u32 s8, s16, s17
v_add_u32 v6, s8, v4
v_xor_b32 v7, 32, v6
v_add_u32 v4, 65536, v4
v_xor_b32 v5, 32, v4
v_and_b32 v20, 15, v0
v_lshlrev_b32 v20, 2, v20
v_and_b32 v16, 28, v20
s_waitcnt vmcnt(20) lgkmcnt(0)
s_barrier
v_and_b32 v17, 3, v0
v_lshlrev_b32 v17, 2, v17
v_add_u32 v17, 24576, v17
ds_read_b32 v18, v17
s_waitcnt lgkmcnt(0)
v_cmp_ne_u32 vcc, 0, v18
s_cmp_lg_u32 s33, 0
s_cbranch_scc1 L_att_done
s_nop 4
s_cbranch_vccnz L_att_fallback
L_att_done:
ds_read_b64_tr_b16 v[152:153], v4 offset:512
ds_read_b64_tr_b16 v[154:155], v4 offset:4608
ds_read_b64_tr_b16 v[156:157], v4 offset:8704
ds_read_b64_tr_b16 v[158:159], v4 offset:12800
ds_read_b64_tr_b16 v[160:161], v5 offset:512
ds_read_b64_tr_b16 v[162:163], v5 offset:4608
ds_read_b64_tr_b16 v[164:165], v5 offset:8704
ds_read_b64_tr_b16 v[166:167], v5 offset:12800
ds_read_b64_tr_b16 v[168:169], v4 offset:768
ds_read_b64_tr_b16 v[170:171], v4 offset:4864
ds_read_b64_tr_b16 v[172:173], v4 offset:8960
ds_read_b64_tr_b16 v[174:175], v4 offset:13056
ds_read_b64_tr_b16 v[176:177], v5 offset:768
ds_read_b64_tr_b16 v[178:179], v5 offset:4864
ds_read_b64_tr_b16 v[180:181], v5 offset:8960
ds_read_b64_tr_b16 v[182:183], v5 offset:13056
s_lshl_b32 s29, s99, 7
s_lshl_b32 s9, s4, 5
s_add_u32 s29, s29, s9
s_lshl_b32 s9, s29, 2
s_add_u32 s9, s9, 0x3700000
buffer_load_dword v8, v20, s[88:91], s9 offen sc1
buffer_load_dword v9, v20, s[88:91], s9 offen offset:64 sc1
s_waitcnt lgkmcnt(8)
v_mfma_f32_16x16x32_bf16 v[56:59], v[152:155], a[64:67], 0
ds_read_b64_tr_b16 v[184:185], v4 offset:0
v_mov_b32 v88, 0
v_mfma_f32_16x16x32_bf16 v[56:59], v[156:159], a[72:75], v[56:59]
ds_read_b64_tr_b16 v[186:187], v4 offset:4096
v_mov_b32 v89, 0
v_mfma_f32_16x16x32_bf16 v[72:75], v[156:159], a[76:79], 0
ds_read_b64_tr_b16 v[188:189], v4 offset:8192
v_mov_b32 v90, 0
v_mfma_f32_16x16x32_bf16 v[72:75], v[152:155], a[68:71], v[72:75]
ds_read_b64_tr_b16 v[190:191], v4 offset:12288
v_mov_b32 v91, 0
v_mfma_f32_16x16x32_bf16 v[76:79], v[160:163], a[68:71], 0
ds_read_b64_tr_b16 v[192:193], v5 offset:0
v_mov_b32 v92, 0
v_mfma_f32_16x16x32_bf16 v[76:79], v[164:167], a[76:79], v[76:79]
ds_read_b64_tr_b16 v[194:195], v5 offset:4096
v_mov_b32 v93, 0
v_mfma_f32_16x16x32_bf16 v[60:63], v[164:167], a[72:75], 0
ds_read_b64_tr_b16 v[196:197], v5 offset:8192
s_waitcnt lgkmcnt(7)
v_mfma_f32_16x16x32_bf16 v[60:63], v[160:163], a[64:67], v[60:63]
ds_read_b64_tr_b16 v[198:199], v5 offset:12288
v_mov_b32 v94, 0
v_mfma_f32_16x16x32_bf16 v[64:67], v[168:171], a[64:67], 0
ds_read_b64_tr_b16 v[200:201], v4 offset:256
v_mov_b32 v95, 0
v_mfma_f32_16x16x32_bf16 v[64:67], v[172:175], a[72:75], v[64:67]
ds_read_b64_tr_b16 v[202:203], v4 offset:4352
v_mov_b32 v96, 0
v_mfma_f32_16x16x32_bf16 v[80:83], v[172:175], a[76:79], 0
ds_read_b64_tr_b16 v[204:205], v4 offset:8448
v_mov_b32 v97, 0
v_mfma_f32_16x16x32_bf16 v[80:83], v[168:171], a[68:71], v[80:83]
ds_read_b64_tr_b16 v[206:207], v4 offset:12544
v_mov_b32 v98, 0
v_mfma_f32_16x16x32_bf16 v[84:87], v[176:179], a[68:71], 0
ds_read_b64_tr_b16 v[208:209], v5 offset:256
v_mov_b32 v99, 0
v_mfma_f32_16x16x32_bf16 v[84:87], v[180:183], a[76:79], v[84:87]
ds_read_b64_tr_b16 v[210:211], v5 offset:4352
s_waitcnt vmcnt(2) lgkmcnt(6)
v_mfma_f32_16x16x32_bf16 v[68:71], v[180:183], a[72:75], 0
ds_read_b64_tr_b16 v[212:213], v5 offset:8448
s_barrier
v_mfma_f32_16x16x32_bf16 v[68:71], v[176:179], a[64:67], v[68:71]
ds_read_b64_tr_b16 v[214:215], v5 offset:12544
v_mov_b32 v100, 0
s_cmp_lg_u32 s4, 0
s_cbranch_scc1 L_flag_set
s_lshl_b32 s8, s6, 5
s_add_u32 s8, s8, s5
s_and_b32 s92, s8, 0xf0
s_mul_i32 s92, s92, 3
s_add_u32 s8, s8, s92
s_lshl_b32 s8, s8, 2
s_add_u32 s8, s8, 0x3704000
v_mov_b32 v21, 1
s_mov_b64 exec, 1
buffer_store_dword v21, off, s[88:91], s8 sc1
s_mov_b64 exec, -1
L_flag_set:
v_mfma_f32_16x16x32_bf16 v[24:27], v[184:187], a[64:67], 0
ds_read_b64_tr_b16 v[152:153], v4 offset:16896
s_lshl_b32 s29, s29, 11
v_mfma_f32_16x16x32_bf16 v[24:27], v[188:191], a[72:75], v[24:27]
ds_read_b64_tr_b16 v[154:155], v4 offset:20992
s_lshl_b32 s9, s100, 8
v_mfma_f32_16x16x32_bf16 v[40:43], v[188:191], a[76:79], 0
ds_read_b64_tr_b16 v[156:157], v4 offset:25088
s_add_u32 s29, s29, s9
v_mfma_f32_16x16x32_bf16 v[40:43], v[184:187], a[68:71], v[40:43]
ds_read_b64_tr_b16 v[158:159], v4 offset:29184
s_lshl_b32 s9, s14, 7
v_mfma_f32_16x16x32_bf16 v[44:47], v[192:195], a[68:71], 0
ds_read_b64_tr_b16 v[160:161], v5 offset:16896
s_add_u32 s29, s29, s9
v_mfma_f32_16x16x32_bf16 v[44:47], v[196:199], a[76:79], v[44:47]
ds_read_b64_tr_b16 v[162:163], v5 offset:20992
s_add_u32 s31, s29, 0x8000
v_mfma_f32_16x16x32_bf16 v[28:31], v[196:199], a[72:75], 0
ds_read_b64_tr_b16 v[164:165], v5 offset:25088
s_waitcnt lgkmcnt(7)
v_mfma_f32_16x16x32_bf16 v[28:31], v[192:195], a[64:67], v[28:31]
ds_read_b64_tr_b16 v[166:167], v5 offset:29184
s_lshl_b32 s28, s2, 2
v_mfma_f32_16x16x32_bf16 v[32:35], v[200:203], a[64:67], 0
ds_read_b64_tr_b16 v[168:169], v4 offset:17152
s_add_u32 s28, s28, s4
v_mfma_f32_16x16x32_bf16 v[32:35], v[204:207], a[72:75], v[32:35]
ds_read_b64_tr_b16 v[170:171], v4 offset:21248
s_lshl_b32 s28, s28, 12
v_mfma_f32_16x16x32_bf16 v[48:51], v[204:207], a[76:79], 0
ds_read_b64_tr_b16 v[172:173], v4 offset:25344
s_add_u32 s28, s28, 0x3800000
v_mfma_f32_16x16x32_bf16 v[48:51], v[200:203], a[68:71], v[48:51]
ds_read_b64_tr_b16 v[174:175], v4 offset:29440
s_xor_b32 s30, s28, 0x4000
v_mfma_f32_16x16x32_bf16 v[52:55], v[208:211], a[68:71], 0
ds_read_b64_tr_b16 v[176:177], v5 offset:17152
v_and_b32 v18, 16, v0
v_mfma_f32_16x16x32_bf16 v[52:55], v[212:215], a[76:79], v[52:55]
ds_read_b64_tr_b16 v[178:179], v5 offset:21248
s_waitcnt lgkmcnt(6)
v_mfma_f32_16x16x32_bf16 v[36:39], v[212:215], a[72:75], 0
ds_read_b64_tr_b16 v[180:181], v5 offset:25344
v_lshrrev_b32 v19, 5, v0
v_mfma_f32_16x16x32_bf16 v[36:39], v[208:211], a[64:67], v[36:39]
ds_read_b64_tr_b16 v[182:183], v5 offset:29440
v_lshlrev_b32 v19, 4, v19
v_mfma_f32_16x16x32_bf16 v[56:59], v[152:155], a[80:83], v[56:59]
ds_read_b64_tr_b16 v[184:185], v4 offset:16384
v_mov_b32 v101, 0
v_mfma_f32_16x16x32_bf16 v[56:59], v[156:159], a[88:91], v[56:59]
ds_read_b64_tr_b16 v[186:187], v4 offset:20480
v_mov_b32 v102, 0
v_mfma_f32_16x16x32_bf16 v[72:75], v[156:159], a[92:95], v[72:75]
ds_read_b64_tr_b16 v[188:189], v4 offset:24576
v_mov_b32 v103, 0
v_mfma_f32_16x16x32_bf16 v[72:75], v[152:155], a[84:87], v[72:75]
ds_read_b64_tr_b16 v[190:191], v4 offset:28672
v_mov_b32 v104, 0
v_mfma_f32_16x16x32_bf16 v[76:79], v[160:163], a[84:87], v[76:79]
ds_read_b64_tr_b16 v[192:193], v5 offset:16384
v_mov_b32 v105, 0
v_mfma_f32_16x16x32_bf16 v[76:79], v[164:167], a[92:95], v[76:79]
ds_read_b64_tr_b16 v[194:195], v5 offset:20480
v_mov_b32 v106, 0
v_mfma_f32_16x16x32_bf16 v[60:63], v[164:167], a[88:91], v[60:63]
ds_read_b64_tr_b16 v[196:197], v5 offset:24576
s_waitcnt lgkmcnt(7)
v_mfma_f32_16x16x32_bf16 v[60:63], v[160:163], a[80:83], v[60:63]
ds_read_b64_tr_b16 v[198:199], v5 offset:28672
v_mov_b32 v107, 0
v_mfma_f32_16x16x32_bf16 v[64:67], v[168:171], a[80:83], v[64:67]
ds_read_b64_tr_b16 v[200:201], v4 offset:16640
v_mov_b32 v108, 0
v_mfma_f32_16x16x32_bf16 v[64:67], v[172:175], a[88:91], v[64:67]
ds_read_b64_tr_b16 v[202:203], v4 offset:20736
v_mov_b32 v109, 0
v_mfma_f32_16x16x32_bf16 v[80:83], v[172:175], a[92:95], v[80:83]
ds_read_b64_tr_b16 v[204:205], v4 offset:24832
v_mov_b32 v110, 0
v_mfma_f32_16x16x32_bf16 v[80:83], v[168:171], a[84:87], v[80:83]
ds_read_b64_tr_b16 v[206:207], v4 offset:28928
v_mov_b32 v111, 0
v_mfma_f32_16x16x32_bf16 v[84:87], v[176:179], a[84:87], v[84:87]
ds_read_b64_tr_b16 v[208:209], v5 offset:16640
v_lshl_add_u32 v18, v18, 1, v19
v_mfma_f32_16x16x32_bf16 v[84:87], v[180:183], a[92:95], v[84:87]
ds_read_b64_tr_b16 v[210:211], v5 offset:20736
s_waitcnt vmcnt(14) lgkmcnt(6)
v_mfma_f32_16x16x32_bf16 v[68:71], v[180:183], a[88:91], v[68:71]
ds_read_b64_tr_b16 v[212:213], v5 offset:24832
s_barrier
v_mfma_f32_16x16x32_bf16 v[68:71], v[176:179], a[80:83], v[68:71]
ds_read_b64_tr_b16 v[214:215], v5 offset:28928
v_lshl_add_u32 v17, v20, 9, v18
s_cmp_eq_u32 s14, 1
s_cbranch_scc1 L_p4_skip
v_mfma_f32_16x16x32_bf16 v[24:27], v[184:187], a[80:83], v[24:27]
ds_read_b64_tr_b16 v[152:153], v6 offset:512
ds_read_b64_tr_b16 v[154:155], v6 offset:4608
v_mfma_f32_16x16x32_bf16 v[24:27], v[188:191], a[88:91], v[24:27]
ds_read_b64_tr_b16 v[156:157], v6 offset:8704
v_add_u32 v12, 0x20000, v12
v_mfma_f32_16x16x32_bf16 v[40:43], v[188:191], a[92:95], v[40:43]
ds_read_b64_tr_b16 v[158:159], v6 offset:12800
s_add_u32 m0, s17, 0x10000
v_mfma_f32_16x16x32_bf16 v[40:43], v[184:187], a[84:87], v[40:43]
buffer_load_dwordx4 v12, s[72:75], 0 offen lds
v_mfma_f32_16x16x32_bf16 v[44:47], v[192:195], a[84:87], v[44:47]
ds_read_b64_tr_b16 v[160:161], v7 offset:512
ds_read_b64_tr_b16 v[162:163], v7 offset:4608
v_mfma_f32_16x16x32_bf16 v[44:47], v[196:199], a[92:95], v[44:47]
ds_read_b64_tr_b16 v[164:165], v7 offset:8704
v_add_u32 v13, 0x20000, v13
v_mfma_f32_16x16x32_bf16 v[28:31], v[196:199], a[88:91], v[28:31]
ds_read_b64_tr_b16 v[166:167], v7 offset:12800
s_waitcnt lgkmcnt(8)
v_mfma_f32_16x16x32_bf16 v[28:31], v[192:195], a[80:83], v[28:31]
buffer_load_dwordx4 v13, s[72:75], 0 offen offset:1024 lds
v_mfma_f32_16x16x32_bf16 v[32:35], v[200:203], a[80:83], v[32:35]
ds_read_b64_tr_b16 v[168:169], v6 offset:768
ds_read_b64_tr_b16 v[170:171], v6 offset:4864
v_mfma_f32_16x16x32_bf16 v[32:35], v[204:207], a[88:91], v[32:35]
ds_read_b64_tr_b16 v[172:173], v6 offset:8960
v_mfma_f32_16x16x32_bf16 v[48:51], v[204:207], a[92:95], v[48:51]
ds_read_b64_tr_b16 v[174:175], v6 offset:13056
v_mfma_f32_16x16x32_bf16 v[48:51], v[200:203], a[84:87], v[48:51]
buffer_load_dwordx4 v12, s[72:75], s12 offen offset:2048 lds
v_mfma_f32_16x16x32_bf16 v[52:55], v[208:211], a[84:87], v[52:55]
ds_read_b64_tr_b16 v[176:177], v7 offset:768
ds_read_b64_tr_b16 v[178:179], v7 offset:4864
v_mfma_f32_16x16x32_bf16 v[52:55], v[212:215], a[92:95], v[52:55]
ds_read_b64_tr_b16 v[180:181], v7 offset:8960
s_waitcnt lgkmcnt(7)
v_mfma_f32_16x16x32_bf16 v[36:39], v[212:215], a[88:91], v[36:39]
ds_read_b64_tr_b16 v[182:183], v7 offset:13056
v_mfma_f32_16x16x32_bf16 v[36:39], v[208:211], a[80:83], v[36:39]
buffer_load_dwordx4 v13, s[72:75], s12 offen offset:3072 lds
v_mfma_f32_16x16x32_bf16 v[56:59], v[152:155], a[96:99], v[56:59]
ds_read_b64_tr_b16 v[184:185], v6 offset:0
ds_read_b64_tr_b16 v[186:187], v6 offset:4096
v_mfma_f32_16x16x32_bf16 v[56:59], v[156:159], a[104:107], v[56:59]
ds_read_b64_tr_b16 v[188:189], v6 offset:8192
v_mfma_f32_16x16x32_bf16 v[72:75], v[156:159], a[108:111], v[72:75]
ds_read_b64_tr_b16 v[190:191], v6 offset:12288
s_add_u32 s101, s101, 0x2000
v_mfma_f32_16x16x32_bf16 v[72:75], v[152:155], a[100:103], v[72:75]
buffer_load_dwordx4 a[64:67], v3, s[88:91], s101 offen sc1
v_mfma_f32_16x16x32_bf16 v[76:79], v[160:163], a[100:103], v[76:79]
ds_read_b64_tr_b16 v[192:193], v7 offset:0
ds_read_b64_tr_b16 v[194:195], v7 offset:4096
v_mfma_f32_16x16x32_bf16 v[76:79], v[164:167], a[108:111], v[76:79]
ds_read_b64_tr_b16 v[196:197], v7 offset:8192
v_mfma_f32_16x16x32_bf16 v[60:63], v[164:167], a[104:107], v[60:63]
ds_read_b64_tr_b16 v[198:199], v7 offset:12288
s_waitcnt lgkmcnt(8)
v_mfma_f32_16x16x32_bf16 v[60:63], v[160:163], a[96:99], v[60:63]
buffer_load_dwordx4 a[68:71], v3, s[88:91], s101 offen offset:1024 sc1
v_mfma_f32_16x16x32_bf16 v[64:67], v[168:171], a[96:99], v[64:67]
ds_read_b64_tr_b16 v[200:201], v6 offset:256
ds_read_b64_tr_b16 v[202:203], v6 offset:4352
v_mfma_f32_16x16x32_bf16 v[64:67], v[172:175], a[104:107], v[64:67]
ds_read_b64_tr_b16 v[204:205], v6 offset:8448
v_mfma_f32_16x16x32_bf16 v[80:83], v[172:175], a[108:111], v[80:83]
ds_read_b64_tr_b16 v[206:207], v6 offset:12544
s_add_u32 s101, s101, 0x2000
v_mfma_f32_16x16x32_bf16 v[80:83], v[168:171], a[100:103], v[80:83]
buffer_load_dwordx4 a[72:75], v3, s[88:91], s101 offen sc1
v_mfma_f32_16x16x32_bf16 v[84:87], v[176:179], a[100:103], v[84:87]
ds_read_b64_tr_b16 v[208:209], v7 offset:256
ds_read_b64_tr_b16 v[210:211], v7 offset:4352
v_mfma_f32_16x16x32_bf16 v[84:87], v[180:183], a[108:111], v[84:87]
ds_read_b64_tr_b16 v[212:213], v7 offset:8448
s_waitcnt vmcnt(17) lgkmcnt(7)
v_mfma_f32_16x16x32_bf16 v[68:71], v[180:183], a[104:107], v[68:71]
ds_read_b64_tr_b16 v[214:215], v7 offset:12544
s_barrier
v_mfma_f32_16x16x32_bf16 v[68:71], v[176:179], a[96:99], v[68:71]
buffer_load_dwordx4 a[76:79], v3, s[88:91], s101 offen offset:1024 sc1
v_mfma_f32_16x16x32_bf16 v[24:27], v[184:187], a[96:99], v[24:27]
ds_read_b64_tr_b16 v[152:153], v6 offset:16896
ds_read_b64_tr_b16 v[154:155], v6 offset:20992
v_mfma_f32_16x16x32_bf16 v[24:27], v[188:191], a[104:107], v[24:27]
ds_read_b64_tr_b16 v[156:157], v6 offset:25088
v_add_u32 v12, 0x20000, v12
v_mfma_f32_16x16x32_bf16 v[40:43], v[188:191], a[108:111], v[40:43]
ds_read_b64_tr_b16 v[158:159], v6 offset:29184
s_add_u32 m0, s17, 0x14000
v_mfma_f32_16x16x32_bf16 v[40:43], v[184:187], a[100:103], v[40:43]
buffer_load_dwordx4 v12, s[72:75], 0 offen lds
v_mfma_f32_16x16x32_bf16 v[44:47], v[192:195], a[100:103], v[44:47]
ds_read_b64_tr_b16 v[160:161], v7 offset:16896
ds_read_b64_tr_b16 v[162:163], v7 offset:20992
v_mfma_f32_16x16x32_bf16 v[44:47], v[196:199], a[108:111], v[44:47]
ds_read_b64_tr_b16 v[164:165], v7 offset:25088
v_add_u32 v13, 0x20000, v13
v_mfma_f32_16x16x32_bf16 v[28:31], v[196:199], a[104:107], v[28:31]
ds_read_b64_tr_b16 v[166:167], v7 offset:29184
s_waitcnt lgkmcnt(8)
v_mfma_f32_16x16x32_bf16 v[28:31], v[192:195], a[96:99], v[28:31]
buffer_load_dwordx4 v13, s[72:75], 0 offen offset:1024 lds
v_mfma_f32_16x16x32_bf16 v[32:35], v[200:203], a[96:99], v[32:35]
ds_read_b64_tr_b16 v[168:169], v6 offset:17152
ds_read_b64_tr_b16 v[170:171], v6 offset:21248
v_mfma_f32_16x16x32_bf16 v[32:35], v[204:207], a[104:107], v[32:35]
ds_read_b64_tr_b16 v[172:173], v6 offset:25344
v_mfma_f32_16x16x32_bf16 v[48:51], v[204:207], a[108:111], v[48:51]
ds_read_b64_tr_b16 v[174:175], v6 offset:29440
v_mfma_f32_16x16x32_bf16 v[48:51], v[200:203], a[100:103], v[48:51]
buffer_load_dwordx4 v12, s[72:75], s12 offen offset:2048 lds
v_mfma_f32_16x16x32_bf16 v[52:55], v[208:211], a[100:103], v[52:55]
ds_read_b64_tr_b16 v[176:177], v7 offset:17152
ds_read_b64_tr_b16 v[178:179], v7 offset:21248
v_mfma_f32_16x16x32_bf16 v[52:55], v[212:215], a[108:111], v[52:55]
ds_read_b64_tr_b16 v[180:181], v7 offset:25344
s_waitcnt lgkmcnt(7)
v_mfma_f32_16x16x32_bf16 v[36:39], v[212:215], a[104:107], v[36:39]
ds_read_b64_tr_b16 v[182:183], v7 offset:29440
v_mfma_f32_16x16x32_bf16 v[36:39], v[208:211], a[96:99], v[36:39]
buffer_load_dwordx4 v13, s[72:75], s12 offen offset:3072 lds
v_mfma_f32_16x16x32_bf16 v[56:59], v[152:155], a[112:115], v[56:59]
ds_read_b64_tr_b16 v[184:185], v6 offset:16384
ds_read_b64_tr_b16 v[186:187], v6 offset:20480
v_mfma_f32_16x16x32_bf16 v[56:59], v[156:159], a[120:123], v[56:59]
ds_read_b64_tr_b16 v[188:189], v6 offset:24576
v_mfma_f32_16x16x32_bf16 v[72:75], v[156:159], a[124:127], v[72:75]
ds_read_b64_tr_b16 v[190:191], v6 offset:28672
s_add_u32 s101, s101, 0x2000
v_mfma_f32_16x16x32_bf16 v[72:75], v[152:155], a[116:119], v[72:75]
buffer_load_dwordx4 a[80:83], v3, s[88:91], s101 offen sc1
v_mfma_f32_16x16x32_bf16 v[76:79], v[160:163], a[116:119], v[76:79]
ds_read_b64_tr_b16 v[192:193], v7 offset:16384
ds_read_b64_tr_b16 v[194:195], v7 offset:20480
v_mfma_f32_16x16x32_bf16 v[76:79], v[164:167], a[124:127], v[76:79]
ds_read_b64_tr_b16 v[196:197], v7 offset:24576
v_mfma_f32_16x16x32_bf16 v[60:63], v[164:167], a[120:123], v[60:63]
ds_read_b64_tr_b16 v[198:199], v7 offset:28672
s_waitcnt lgkmcnt(8)
v_mfma_f32_16x16x32_bf16 v[60:63], v[160:163], a[112:115], v[60:63]
buffer_load_dwordx4 a[84:87], v3, s[88:91], s101 offen offset:1024 sc1
v_mfma_f32_16x16x32_bf16 v[64:67], v[168:171], a[112:115], v[64:67]
ds_read_b64_tr_b16 v[200:201], v6 offset:16640
ds_read_b64_tr_b16 v[202:203], v6 offset:20736
v_mfma_f32_16x16x32_bf16 v[64:67], v[172:175], a[120:123], v[64:67]
ds_read_b64_tr_b16 v[204:205], v6 offset:24832
v_mfma_f32_16x16x32_bf16 v[80:83], v[172:175], a[124:127], v[80:83]
ds_read_b64_tr_b16 v[206:207], v6 offset:28928
s_add_u32 s101, s101, 0x2000
v_mfma_f32_16x16x32_bf16 v[80:83], v[168:171], a[116:119], v[80:83]
buffer_load_dwordx4 a[88:91], v3, s[88:91], s101 offen sc1
v_mfma_f32_16x16x32_bf16 v[84:87], v[176:179], a[116:119], v[84:87]
ds_read_b64_tr_b16 v[208:209], v7 offset:16640
ds_read_b64_tr_b16 v[210:211], v7 offset:20736
v_mfma_f32_16x16x32_bf16 v[84:87], v[180:183], a[124:127], v[84:87]
ds_read_b64_tr_b16 v[212:213], v7 offset:24832
s_waitcnt vmcnt(7) lgkmcnt(7)
v_mfma_f32_16x16x32_bf16 v[68:71], v[180:183], a[120:123], v[68:71]
ds_read_b64_tr_b16 v[214:215], v7 offset:28928
s_barrier
v_mfma_f32_16x16x32_bf16 v[68:71], v[176:179], a[112:115], v[68:71]
buffer_load_dwordx4 a[92:95], v3, s[88:91], s101 offen offset:1024 sc1
v_mfma_f32_16x16x32_bf16 v[24:27], v[184:187], a[112:115], v[24:27]
ds_read_b64_tr_b16 v[152:153], v4 offset:512
ds_read_b64_tr_b16 v[154:155], v4 offset:4608
v_mfma_f32_16x16x32_bf16 v[24:27], v[188:191], a[120:123], v[24:27]
ds_read_b64_tr_b16 v[156:157], v4 offset:8704
v_add_u32 v12, 0x20000, v12
v_mfma_f32_16x16x32_bf16 v[40:43], v[188:191], a[124:127], v[40:43]
ds_read_b64_tr_b16 v[158:159], v4 offset:12800
s_add_u32 m0, s16, 0x0
v_mfma_f32_16x16x32_bf16 v[40:43], v[184:187], a[116:119], v[40:43]
buffer_load_dwordx4 v12, s[72:75], 0 offen lds
v_mfma_f32_16x16x32_bf16 v[44:47], v[192:195], a[116:119], v[44:47]
ds_read_b64_tr_b16 v[160:161], v5 offset:512
ds_read_b64_tr_b16 v[162:163], v5 offset:4608
v_mfma_f32_16x16x32_bf16 v[44:47], v[196:199], a[124:127], v[44:47]
ds_read_b64_tr_b16 v[164:165], v5 offset:8704
v_add_u32 v13, 0x20000, v13
v_mfma_f32_16x16x32_bf16 v[28:31], v[196:199], a[120:123], v[28:31]
ds_read_b64_tr_b16 v[166:167], v5 offset:12800
s_waitcnt lgkmcnt(8)
v_mfma_f32_16x16x32_bf16 v[28:31], v[192:195], a[112:115], v[28:31]
buffer_load_dwordx4 v13, s[72:75], 0 offen offset:1024 lds
v_mfma_f32_16x16x32_bf16 v[32:35], v[200:203], a[112:115], v[32:35]
ds_read_b64_tr_b16 v[168:169], v4 offset:768
ds_read_b64_tr_b16 v[170:171], v4 offset:4864
v_mfma_f32_16x16x32_bf16 v[32:35], v[204:207], a[120:123], v[32:35]
ds_read_b64_tr_b16 v[172:173], v4 offset:8960
v_mfma_f32_16x16x32_bf16 v[48:51], v[204:207], a[124:127], v[48:51]
ds_read_b64_tr_b16 v[174:175], v4 offset:13056
v_mfma_f32_16x16x32_bf16 v[48:51], v[200:203], a[116:119], v[48:51]
buffer_load_dwordx4 v12, s[72:75], s12 offen offset:2048 lds
v_mfma_f32_16x16x32_bf16 v[52:55], v[208:211], a[116:119], v[52:55]
ds_read_b64_tr_b16 v[176:177], v5 offset:768
ds_read_b64_tr_b16 v[178:179], v5 offset:4864
v_mfma_f32_16x16x32_bf16 v[52:55], v[212:215], a[124:127], v[52:55]
ds_read_b64_tr_b16 v[180:181], v5 offset:8960
s_waitcnt lgkmcnt(7)
v_mfma_f32_16x16x32_bf16 v[36:39], v[212:215], a[120:123], v[36:39]
ds_read_b64_tr_b16 v[182:183], v5 offset:13056
v_mfma_f32_16x16x32_bf16 v[36:39], v[208:211], a[112:115], v[36:39]
buffer_load_dwordx4 v13, s[72:75], s12 offen offset:3072 lds
v_mfma_f32_16x16x32_bf16 v[56:59], v[152:155], a[64:67], v[56:59]
ds_read_b64_tr_b16 v[184:185], v4 offset:0
ds_read_b64_tr_b16 v[186:187], v4 offset:4096
v_mfma_f32_16x16x32_bf16 v[56:59], v[156:159], a[72:75], v[56:59]
ds_read_b64_tr_b16 v[188:189], v4 offset:8192
v_mfma_f32_16x16x32_bf16 v[72:75], v[156:159], a[76:79], v[72:75]
ds_read_b64_tr_b16 v[190:191], v4 offset:12288
s_add_u32 s101, s101, 0x2000
v_mfma_f32_16x16x32_bf16 v[72:75], v[152:155], a[68:71], v[72:75]
buffer_load_dwordx4 a[96:99], v3, s[88:91], s101 offen sc1
v_mfma_f32_16x16x32_bf16 v[76:79], v[160:163], a[68:71], v[76:79]
ds_read_b64_tr_b16 v[192:193], v5 offset:0
ds_read_b64_tr_b16 v[194:195], v5 offset:4096
v_mfma_f32_16x16x32_bf16 v[76:79], v[164:167], a[76:79], v[76:79]
ds_read_b64_tr_b16 v[196:197], v5 offset:8192
v_mfma_f32_16x16x32_bf16 v[60:63], v[164:167], a[72:75], v[60:63]
ds_read_b64_tr_b16 v[198:199], v5 offset:12288
s_waitcnt lgkmcnt(8)
v_mfma_f32_16x16x32_bf16 v[60:63], v[160:163], a[64:67], v[60:63]
buffer_load_dwordx4 a[100:103], v3, s[88:91], s101 offen offset:1024 sc1
v_mfma_f32_16x16x32_bf16 v[64:67], v[168:171], a[64:67], v[64:67]
ds_read_b64_tr_b16 v[200:201], v4 offset:256
ds_read_b64_tr_b16 v[202:203], v4 offset:4352
v_mfma_f32_16x16x32_bf16 v[64:67], v[172:175], a[72:75], v[64:67]
ds_read_b64_tr_b16 v[204:205], v4 offset:8448
v_mfma_f32_16x16x32_bf16 v[80:83], v[172:175], a[76:79], v[80:83]
ds_read_b64_tr_b16 v[206:207], v4 offset:12544
s_add_u32 s101, s101, 0x2000
v_mfma_f32_16x16x32_bf16 v[80:83], v[168:171], a[68:71], v[80:83]
buffer_load_dwordx4 a[104:107], v3, s[88:91], s101 offen sc1
v_mfma_f32_16x16x32_bf16 v[84:87], v[176:179], a[68:71], v[84:87]
ds_read_b64_tr_b16 v[208:209], v5 offset:256
ds_read_b64_tr_b16 v[210:211], v5 offset:4352
v_mfma_f32_16x16x32_bf16 v[84:87], v[180:183], a[76:79], v[84:87]
ds_read_b64_tr_b16 v[212:213], v5 offset:8448
s_waitcnt vmcnt(7) lgkmcnt(7)
v_mfma_f32_16x16x32_bf16 v[68:71], v[180:183], a[72:75], v[68:71]
ds_read_b64_tr_b16 v[214:215], v5 offset:12544
s_barrier
v_mfma_f32_16x16x32_bf16 v[68:71], v[176:179], a[64:67], v[68:71]
buffer_load_dwordx4 a[108:111], v3, s[88:91], s101 offen offset:1024 sc1
v_mfma_f32_16x16x32_bf16 v[24:27], v[184:187], a[64:67], v[24:27]
ds_read_b64_tr_b16 v[152:153], v4 offset:16896
ds_read_b64_tr_b16 v[154:155], v4 offset:20992
v_mfma_f32_16x16x32_bf16 v[24:27], v[188:191], a[72:75], v[24:27]
ds_read_b64_tr_b16 v[156:157], v4 offset:25088
v_add_u32 v12, 0x20000, v12
v_mfma_f32_16x16x32_bf16 v[40:43], v[188:191], a[76:79], v[40:43]
ds_read_b64_tr_b16 v[158:159], v4 offset:29184
s_add_u32 m0, s16, 0x4000
v_mfma_f32_16x16x32_bf16 v[40:43], v[184:187], a[68:71], v[40:43]
buffer_load_dwordx4 v12, s[72:75], 0 offen lds
v_mfma_f32_16x16x32_bf16 v[44:47], v[192:195], a[68:71], v[44:47]
ds_read_b64_tr_b16 v[160:161], v5 offset:16896
ds_read_b64_tr_b16 v[162:163], v5 offset:20992
v_mfma_f32_16x16x32_bf16 v[44:47], v[196:199], a[76:79], v[44:47]
ds_read_b64_tr_b16 v[164:165], v5 offset:25088
v_add_u32 v13, 0x20000, v13
v_mfma_f32_16x16x32_bf16 v[28:31], v[196:199], a[72:75], v[28:31]
ds_read_b64_tr_b16 v[166:167], v5 offset:29184
s_waitcnt lgkmcnt(8)
v_mfma_f32_16x16x32_bf16 v[28:31], v[192:195], a[64:67], v[28:31]
buffer_load_dwordx4 v13, s[72:75], 0 offen offset:1024 lds
v_mfma_f32_16x16x32_bf16 v[32:35], v[200:203], a[64:67], v[32:35]
ds_read_b64_tr_b16 v[168:169], v4 offset:17152
ds_read_b64_tr_b16 v[170:171], v4 offset:21248
v_mfma_f32_16x16x32_bf16 v[32:35], v[204:207], a[72:75], v[32:35]
ds_read_b64_tr_b16 v[172:173], v4 offset:25344
v_mfma_f32_16x16x32_bf16 v[48:51], v[204:207], a[76:79], v[48:51]
ds_read_b64_tr_b16 v[174:175], v4 offset:29440
v_mfma_f32_16x16x32_bf16 v[48:51], v[200:203], a[68:71], v[48:51]
buffer_load_dwordx4 v12, s[72:75], s12 offen offset:2048 lds
v_mfma_f32_16x16x32_bf16 v[52:55], v[208:211], a[68:71], v[52:55]
ds_read_b64_tr_b16 v[176:177], v5 offset:17152
ds_read_b64_tr_b16 v[178:179], v5 offset:21248
v_mfma_f32_16x16x32_bf16 v[52:55], v[212:215], a[76:79], v[52:55]
ds_read_b64_tr_b16 v[180:181], v5 offset:25344
s_waitcnt lgkmcnt(7)
v_mfma_f32_16x16x32_bf16 v[36:39], v[212:215], a[72:75], v[36:39]
ds_read_b64_tr_b16 v[182:183], v5 offset:29440
v_mfma_f32_16x16x32_bf16 v[36:39], v[208:211], a[64:67], v[36:39]
buffer_load_dwordx4 v13, s[72:75], s12 offen offset:3072 lds
v_mfma_f32_16x16x32_bf16 v[56:59], v[152:155], a[80:83], v[56:59]
ds_read_b64_tr_b16 v[184:185], v4 offset:16384
ds_read_b64_tr_b16 v[186:187], v4 offset:20480
v_mfma_f32_16x16x32_bf16 v[56:59], v[156:159], a[88:91], v[56:59]
ds_read_b64_tr_b16 v[188:189], v4 offset:24576
v_mfma_f32_16x16x32_bf16 v[72:75], v[156:159], a[92:95], v[72:75]
ds_read_b64_tr_b16 v[190:191], v4 offset:28672
s_add_u32 s101, s101, 0x2000
v_mfma_f32_16x16x32_bf16 v[72:75], v[152:155], a[84:87], v[72:75]
buffer_load_dwordx4 a[112:115], v3, s[88:91], s101 offen sc1
v_mfma_f32_16x16x32_bf16 v[76:79], v[160:163], a[84:87], v[76:79]
ds_read_b64_tr_b16 v[192:193], v5 offset:16384
ds_read_b64_tr_b16 v[194:195], v5 offset:20480
v_mfma_f32_16x16x32_bf16 v[76:79], v[164:167], a[92:95], v[76:79]
ds_read_b64_tr_b16 v[196:197], v5 offset:24576
v_mfma_f32_16x16x32_bf16 v[60:63], v[164:167], a[88:91], v[60:63]
ds_read_b64_tr_b16 v[198:199], v5 offset:28672
s_waitcnt lgkmcnt(8)
v_mfma_f32_16x16x32_bf16 v[60:63], v[160:163], a[80:83], v[60:63]
buffer_load_dwordx4 a[116:119], v3, s[88:91], s101 offen offset:1024 sc1
v_mfma_f32_16x16x32_bf16 v[64:67], v[168:171], a[80:83], v[64:67]
ds_read_b64_tr_b16 v[200:201], v4 offset:16640
ds_read_b64_tr_b16 v[202:203], v4 offset:20736
v_mfma_f32_16x16x32_bf16 v[64:67], v[172:175], a[88:91], v[64:67]
ds_read_b64_tr_b16 v[204:205], v4 offset:24832
v_mfma_f32_16x16x32_bf16 v[80:83], v[172:175], a[92:95], v[80:83]
ds_read_b64_tr_b16 v[206:207], v4 offset:28928
s_add_u32 s101, s101, 0x2000
v_mfma_f32_16x16x32_bf16 v[80:83], v[168:171], a[84:87], v[80:83]
buffer_load_dwordx4 a[120:123], v3, s[88:91], s101 offen sc1
v_mfma_f32_16x16x32_bf16 v[84:87], v[176:179], a[84:87], v[84:87]
ds_read_b64_tr_b16 v[208:209], v5 offset:16640
ds_read_b64_tr_b16 v[210:211], v5 offset:20736
v_mfma_f32_16x16x32_bf16 v[84:87], v[180:183], a[92:95], v[84:87]
ds_read_b64_tr_b16 v[212:213], v5 offset:24832
s_waitcnt vmcnt(7) lgkmcnt(7)
v_mfma_f32_16x16x32_bf16 v[68:71], v[180:183], a[88:91], v[68:71]
ds_read_b64_tr_b16 v[214:215], v5 offset:28928
s_barrier
v_mfma_f32_16x16x32_bf16 v[68:71], v[176:179], a[80:83], v[68:71]
buffer_load_dwordx4 a[124:127], v3, s[88:91], s101 offen offset:1024 sc1
L_p4_skip:
v_mfma_f32_16x16x32_bf16 v[24:27], v[184:187], a[80:83], v[24:27]
ds_read_b64_tr_b16 v[152:153], v6 offset:512
ds_read_b64_tr_b16 v[154:155], v6 offset:4608
v_mfma_f32_16x16x32_bf16 v[24:27], v[188:191], a[88:91], v[24:27]
ds_read_b64_tr_b16 v[156:157], v6 offset:8704
v_add_u32 v12, 0x20000, v12
v_mfma_f32_16x16x32_bf16 v[40:43], v[188:191], a[92:95], v[40:43]
ds_read_b64_tr_b16 v[158:159], v6 offset:12800
s_add_u32 m0, s17, 0x10000
v_mfma_f32_16x16x32_bf16 v[40:43], v[184:187], a[84:87], v[40:43]
buffer_load_dwordx4 v12, s[72:75], 0 offen lds
v_mfma_f32_16x16x32_bf16 v[44:47], v[192:195], a[84:87], v[44:47]
ds_read_b64_tr_b16 v[160:161], v7 offset:512
ds_read_b64_tr_b16 v[162:163], v7 offset:4608
v_mfma_f32_16x16x32_bf16 v[44:47], v[196:199], a[92:95], v[44:47]
ds_read_b64_tr_b16 v[164:165], v7 offset:8704
v_add_u32 v13, 0x20000, v13
v_mfma_f32_16x16x32_bf16 v[28:31], v[196:199], a[88:91], v[28:31]
ds_read_b64_tr_b16 v[166:167], v7 offset:12800
s_waitcnt lgkmcnt(8)
v_mfma_f32_16x16x32_bf16 v[28:31], v[192:195], a[80:83], v[28:31]
buffer_load_dwordx4 v13, s[72:75], 0 offen offset:1024 lds
v_mfma_f32_16x16x32_bf16 v[32:35], v[200:203], a[80:83], v[32:35]
ds_read_b64_tr_b16 v[168:169], v6 offset:768
ds_read_b64_tr_b16 v[170:171], v6 offset:4864
v_mfma_f32_16x16x32_bf16 v[32:35], v[204:207], a[88:91], v[32:35]
ds_read_b64_tr_b16 v[172:173], v6 offset:8960
v_mfma_f32_16x16x32_bf16 v[48:51], v[204:207], a[92:95], v[48:51]
ds_read_b64_tr_b16 v[174:175], v6 offset:13056
v_mfma_f32_16x16x32_bf16 v[48:51], v[200:203], a[84:87], v[48:51]
buffer_load_dwordx4 v12, s[72:75], s12 offen offset:2048 lds
v_mfma_f32_16x16x32_bf16 v[52:55], v[208:211], a[84:87], v[52:55]
ds_read_b64_tr_b16 v[176:177], v7 offset:768
ds_read_b64_tr_b16 v[178:179], v7 offset:4864
v_mfma_f32_16x16x32_bf16 v[52:55], v[212:215], a[92:95], v[52:55]
ds_read_b64_tr_b16 v[180:181], v7 offset:8960
s_waitcnt lgkmcnt(7)
v_mfma_f32_16x16x32_bf16 v[36:39], v[212:215], a[88:91], v[36:39]
ds_read_b64_tr_b16 v[182:183], v7 offset:13056
v_mfma_f32_16x16x32_bf16 v[36:39], v[208:211], a[80:83], v[36:39]
buffer_load_dwordx4 v13, s[72:75], s12 offen offset:3072 lds
v_mfma_f32_16x16x32_bf16 v[56:59], v[152:155], a[96:99], v[56:59]
ds_read_b64_tr_b16 v[184:185], v6 offset:0
ds_read_b64_tr_b16 v[186:187], v6 offset:4096
v_mfma_f32_16x16x32_bf16 v[56:59], v[156:159], a[104:107], v[56:59]
ds_read_b64_tr_b16 v[188:189], v6 offset:8192
v_mov_b32 v112, 0
v_mfma_f32_16x16x32_bf16 v[72:75], v[156:159], a[108:111], v[72:75]
ds_read_b64_tr_b16 v[190:191], v6 offset:12288
s_add_u32 s101, s101, 0x2000
v_mfma_f32_16x16x32_bf16 v[72:75], v[152:155], a[100:103], v[72:75]
buffer_load_dwordx4 a[64:67], v3, s[88:91], s101 offen sc1
v_mfma_f32_16x16x32_bf16 v[76:79], v[160:163], a[100:103], v[76:79]
ds_read_b64_tr_b16 v[192:193], v7 offset:0
ds_read_b64_tr_b16 v[194:195], v7 offset:4096
v_mfma_f32_16x16x32_bf16 v[76:79], v[164:167], a[108:111], v[76:79]
ds_read_b64_tr_b16 v[196:197], v7 offset:8192
v_mov_b32 v113, 0
v_mfma_f32_16x16x32_bf16 v[60:63], v[164:167], a[104:107], v[60:63]
ds_read_b64_tr_b16 v[198:199], v7 offset:12288
s_waitcnt lgkmcnt(8)
v_mfma_f32_16x16x32_bf16 v[60:63], v[160:163], a[96:99], v[60:63]
buffer_load_dwordx4 a[68:71], v3, s[88:91], s101 offen offset:1024 sc1
v_mfma_f32_16x16x32_bf16 v[64:67], v[168:171], a[96:99], v[64:67]
ds_read_b64_tr_b16 v[200:201], v6 offset:256
ds_read_b64_tr_b16 v[202:203], v6 offset:4352
v_mfma_f32_16x16x32_bf16 v[64:67], v[172:175], a[104:107], v[64:67]
ds_read_b64_tr_b16 v[204:205], v6 offset:8448
v_mov_b32 v114, 0
v_mfma_f32_16x16x32_bf16 v[80:83], v[172:175], a[108:111], v[80:83]
ds_read_b64_tr_b16 v[206:207], v6 offset:12544
s_add_u32 s101, s101, 0x2000
v_mfma_f32_16x16x32_bf16 v[80:83], v[168:171], a[100:103], v[80:83]
buffer_load_dwordx4 a[72:75], v3, s[88:91], s101 offen sc1
v_mfma_f32_16x16x32_bf16 v[84:87], v[176:179], a[100:103], v[84:87]
ds_read_b64_tr_b16 v[208:209], v7 offset:256
ds_read_b64_tr_b16 v[210:211], v7 offset:4352
v_mfma_f32_16x16x32_bf16 v[84:87], v[180:183], a[108:111], v[84:87]
ds_read_b64_tr_b16 v[212:213], v7 offset:8448
s_waitcnt vmcnt(7) lgkmcnt(7)
v_mfma_f32_16x16x32_bf16 v[68:71], v[180:183], a[104:107], v[68:71]
ds_read_b64_tr_b16 v[214:215], v7 offset:12544
s_barrier
v_mfma_f32_16x16x32_bf16 v[68:71], v[176:179], a[96:99], v[68:71]
buffer_load_dwordx4 a[76:79], v3, s[88:91], s101 offen offset:1024 sc1
v_mov_b32 v115, 0
buffer_load_dword v14, v16, s[88:91], s24 offen sc1
v_mfma_f32_16x16x32_bf16 v[24:27], v[184:187], a[96:99], v[24:27]
ds_read_b64_tr_b16 v[152:153], v6 offset:16896
ds_read_b64_tr_b16 v[154:155], v6 offset:20992
v_mfma_f32_16x16x32_bf16 v[24:27], v[188:191], a[104:107], v[24:27]
ds_read_b64_tr_b16 v[156:157], v6 offset:25088
v_add_u32 v12, 0x20000, v12
v_mfma_f32_16x16x32_bf16 v[40:43], v[188:191], a[108:111], v[40:43]
ds_read_b64_tr_b16 v[158:159], v6 offset:29184
s_add_u32 m0, s17, 0x14000
v_mfma_f32_16x16x32_bf16 v[40:43], v[184:187], a[100:103], v[40:43]
buffer_load_dwordx4 v12, s[72:75], 0 offen lds
v_mfma_f32_16x16x32_bf16 v[44:47], v[192:195], a[100:103], v[44:47]
ds_read_b64_tr_b16 v[160:161], v7 offset:16896
ds_read_b64_tr_b16 v[162:163], v7 offset:20992
v_mfma_f32_16x16x32_bf16 v[44:47], v[196:199], a[108:111], v[44:47]
ds_read_b64_tr_b16 v[164:165], v7 offset:25088
v_add_u32 v13, 0x20000, v13
v_mfma_f32_16x16x32_bf16 v[28:31], v[196:199], a[104:107], v[28:31]
ds_read_b64_tr_b16 v[166:167], v7 offset:29184
s_waitcnt lgkmcnt(8)
v_mfma_f32_16x16x32_bf16 v[28:31], v[192:195], a[96:99], v[28:31]
buffer_load_dwordx4 v13, s[72:75], 0 offen offset:1024 lds
v_mfma_f32_16x16x32_bf16 v[32:35], v[200:203], a[96:99], v[32:35]
ds_read_b64_tr_b16 v[168:169], v6 offset:17152
ds_read_b64_tr_b16 v[170:171], v6 offset:21248
v_mfma_f32_16x16x32_bf16 v[32:35], v[204:207], a[104:107], v[32:35]
ds_read_b64_tr_b16 v[172:173], v6 offset:25344
v_mfma_f32_16x16x32_bf16 v[48:51], v[204:207], a[108:111], v[48:51]
ds_read_b64_tr_b16 v[174:175], v6 offset:29440
v_mfma_f32_16x16x32_bf16 v[48:51], v[200:203], a[100:103], v[48:51]
buffer_load_dwordx4 v12, s[72:75], s12 offen offset:2048 lds
v_mfma_f32_16x16x32_bf16 v[52:55], v[208:211], a[100:103], v[52:55]
ds_read_b64_tr_b16 v[176:177], v7 offset:17152
ds_read_b64_tr_b16 v[178:179], v7 offset:21248
v_mfma_f32_16x16x32_bf16 v[52:55], v[212:215], a[108:111], v[52:55]
ds_read_b64_tr_b16 v[180:181], v7 offset:25344
s_waitcnt lgkmcnt(7)
v_mfma_f32_16x16x32_bf16 v[36:39], v[212:215], a[104:107], v[36:39]
ds_read_b64_tr_b16 v[182:183], v7 offset:29440
v_mfma_f32_16x16x32_bf16 v[36:39], v[208:211], a[96:99], v[36:39]
buffer_load_dwordx4 v13, s[72:75], s12 offen offset:3072 lds
v_mfma_f32_16x16x32_bf16 v[56:59], v[152:155], a[112:115], v[56:59]
ds_read_b64_tr_b16 v[184:185], v6 offset:16384
ds_read_b64_tr_b16 v[186:187], v6 offset:20480
v_mfma_f32_16x16x32_bf16 v[56:59], v[156:159], a[120:123], v[56:59]
ds_read_b64_tr_b16 v[188:189], v6 offset:24576
v_mov_b32 v116, 0
v_mfma_f32_16x16x32_bf16 v[72:75], v[156:159], a[124:127], v[72:75]
ds_read_b64_tr_b16 v[190:191], v6 offset:28672
s_add_u32 s101, s101, 0x2000
v_mfma_f32_16x16x32_bf16 v[72:75], v[152:155], a[116:119], v[72:75]
buffer_load_dwordx4 a[80:83], v3, s[88:91], s101 offen sc1
v_mfma_f32_16x16x32_bf16 v[76:79], v[160:163], a[116:119], v[76:79]
ds_read_b64_tr_b16 v[192:193], v7 offset:16384
ds_read_b64_tr_b16 v[194:195], v7 offset:20480
v_mfma_f32_16x16x32_bf16 v[76:79], v[164:167], a[124:127], v[76:79]
ds_read_b64_tr_b16 v[196:197], v7 offset:24576
v_mov_b32 v117, 0
v_mfma_f32_16x16x32_bf16 v[60:63], v[164:167], a[120:123], v[60:63]
ds_read_b64_tr_b16 v[198:199], v7 offset:28672
s_waitcnt lgkmcnt(8)
v_mfma_f32_16x16x32_bf16 v[60:63], v[160:163], a[112:115], v[60:63]
buffer_load_dwordx4 a[84:87], v3, s[88:91], s101 offen offset:1024 sc1
v_mfma_f32_16x16x32_bf16 v[64:67], v[168:171], a[112:115], v[64:67]
ds_read_b64_tr_b16 v[200:201], v6 offset:16640
ds_read_b64_tr_b16 v[202:203], v6 offset:20736
v_mfma_f32_16x16x32_bf16 v[64:67], v[172:175], a[120:123], v[64:67]
ds_read_b64_tr_b16 v[204:205], v6 offset:24832
v_mov_b32 v118, 0
v_mfma_f32_16x16x32_bf16 v[80:83], v[172:175], a[124:127], v[80:83]
ds_read_b64_tr_b16 v[206:207], v6 offset:28928
s_add_u32 s101, s101, 0x2000
v_mfma_f32_16x16x32_bf16 v[80:83], v[168:171], a[116:119], v[80:83]
buffer_load_dwordx4 a[88:91], v3, s[88:91], s101 offen sc1
v_mfma_f32_16x16x32_bf16 v[84:87], v[176:179], a[116:119], v[84:87]
ds_read_b64_tr_b16 v[208:209], v7 offset:16640
ds_read_b64_tr_b16 v[210:211], v7 offset:20736
v_mfma_f32_16x16x32_bf16 v[84:87], v[180:183], a[124:127], v[84:87]
ds_read_b64_tr_b16 v[212:213], v7 offset:24832
s_waitcnt vmcnt(7) lgkmcnt(7)
v_mfma_f32_16x16x32_bf16 v[68:71], v[180:183], a[120:123], v[68:71]
ds_read_b64_tr_b16 v[214:215], v7 offset:28928
s_barrier
v_mfma_f32_16x16x32_bf16 v[68:71], v[176:179], a[112:115], v[68:71]
buffer_load_dwordx4 a[92:95], v3, s[88:91], s101 offen offset:1024 sc1
v_mov_b32 v119, 0
s_mov_b32 s92, 200000
L_spin_c:
v_cmp_ne_u32 vcc, 1, v14
s_nop 4
s_cbranch_vccz L_spun_c
s_sub_u32 s92, s92, 1
s_cbranch_scc1 L_spun_c
s_sleep 6
buffer_load_dword v14, v16, s[88:91], s24 offen sc1
s_waitcnt vmcnt(0)
s_branch L_spin_c
L_spun_c:
v_mfma_f32_16x16x32_bf16 v[24:27], v[184:187], a[112:115], v[24:27]
ds_read_b64_tr_b16 v[152:153], v4 offset:512
ds_read_b64_tr_b16 v[154:155], v4 offset:4608
v_mfma_f32_16x16x32_bf16 v[24:27], v[188:191], a[120:123], v[24:27]
ds_read_b64_tr_b16 v[156:157], v4 offset:8704
v_add_u32 v12, s25, v12
v_mfma_f32_16x16x32_bf16 v[40:43], v[188:191], a[124:127], v[40:43]
ds_read_b64_tr_b16 v[158:159], v4 offset:12800
s_add_u32 m0, s16, 0x0
v_mfma_f32_16x16x32_bf16 v[40:43], v[184:187], a[116:119], v[40:43]
buffer_load_dwordx4 v12, s[64:67], s61 offen lds
v_mfma_f32_16x16x32_bf16 v[44:47], v[192:195], a[116:119], v[44:47]
ds_read_b64_tr_b16 v[160:161], v5 offset:512
ds_read_b64_tr_b16 v[162:163], v5 offset:4608
v_mfma_f32_16x16x32_bf16 v[44:47], v[196:199], a[124:127], v[44:47]
ds_read_b64_tr_b16 v[164:165], v5 offset:8704
v_add_u32 v13, s25, v13
v_mfma_f32_16x16x32_bf16 v[28:31], v[196:199], a[120:123], v[28:31]
ds_read_b64_tr_b16 v[166:167], v5 offset:12800
s_waitcnt lgkmcnt(8)
v_mfma_f32_16x16x32_bf16 v[28:31], v[192:195], a[112:115], v[28:31]
buffer_load_dwordx4 v13, s[64:67], s61 offen offset:1024 lds
v_mfma_f32_16x16x32_bf16 v[32:35], v[200:203], a[112:115], v[32:35]
ds_read_b64_tr_b16 v[168:169], v4 offset:768
ds_read_b64_tr_b16 v[170:171], v4 offset:4864
v_mfma_f32_16x16x32_bf16 v[32:35], v[204:207], a[120:123], v[32:35]
ds_read_b64_tr_b16 v[172:173], v4 offset:8960
s_add_u32 s63, s101, s26
v_mfma_f32_16x16x32_bf16 v[48:51], v[204:207], a[124:127], v[48:51]
ds_read_b64_tr_b16 v[174:175], v4 offset:13056
s_add_u32 s101, s63, s60
v_mfma_f32_16x16x32_bf16 v[48:51], v[200:203], a[116:119], v[48:51]
buffer_load_dwordx4 v12, s[64:67], s62 offen offset:2048 lds
v_mfma_f32_16x16x32_bf16 v[52:55], v[208:211], a[116:119], v[52:55]
ds_read_b64_tr_b16 v[176:177], v5 offset:768
ds_read_b64_tr_b16 v[178:179], v5 offset:4864
v_mfma_f32_16x16x32_bf16 v[52:55], v[212:215], a[124:127], v[52:55]
ds_read_b64_tr_b16 v[180:181], v5 offset:8960
s_waitcnt lgkmcnt(7)
v_mfma_f32_16x16x32_bf16 v[36:39], v[212:215], a[120:123], v[36:39]
ds_read_b64_tr_b16 v[182:183], v5 offset:13056
v_mfma_f32_16x16x32_bf16 v[36:39], v[208:211], a[112:115], v[36:39]
buffer_load_dwordx4 v13, s[64:67], s62 offen offset:3072 lds
v_mfma_f32_16x16x32_bf16 v[56:59], v[152:155], a[64:67], v[56:59]
ds_read_b64_tr_b16 v[184:185], v4 offset:0
ds_read_b64_tr_b16 v[186:187], v4 offset:4096
v_mfma_f32_16x16x32_bf16 v[56:59], v[156:159], a[72:75], v[56:59]
ds_read_b64_tr_b16 v[188:189], v4 offset:8192
s_add_u32 s60, s60, s57
v_mfma_f32_16x16x32_bf16 v[72:75], v[156:159], a[76:79], v[72:75]
ds_read_b64_tr_b16 v[190:191], v4 offset:12288
s_and_b32 s60, s60, 0x7c000
v_mfma_f32_16x16x32_bf16 v[72:75], v[152:155], a[68:71], v[72:75]
buffer_load_dwordx4 a[96:99], v3, s[88:91], s101 offen sc1
v_mfma_f32_16x16x32_bf16 v[76:79], v[160:163], a[68:71], v[76:79]
ds_read_b64_tr_b16 v[192:193], v5 offset:0
ds_read_b64_tr_b16 v[194:195], v5 offset:4096
v_mfma_f32_16x16x32_bf16 v[76:79], v[164:167], a[76:79], v[76:79]
ds_read_b64_tr_b16 v[196:197], v5 offset:8192
s_lshl_b32 s61, s60, 3
v_mfma_f32_16x16x32_bf16 v[60:63], v[164:167], a[72:75], v[60:63]
ds_read_b64_tr_b16 v[198:199], v5 offset:12288
s_waitcnt lgkmcnt(8)
v_mfma_f32_16x16x32_bf16 v[60:63], v[160:163], a[64:67], v[60:63]
buffer_load_dwordx4 a[100:103], v3, s[88:91], s101 offen offset:1024 sc1
v_mfma_f32_16x16x32_bf16 v[64:67], v[168:171], a[64:67], v[64:67]
ds_read_b64_tr_b16 v[200:201], v4 offset:256
ds_read_b64_tr_b16 v[202:203], v4 offset:4352
v_mfma_f32_16x16x32_bf16 v[64:67], v[172:175], a[72:75], v[64:67]
ds_read_b64_tr_b16 v[204:205], v4 offset:8448
s_add_u32 s62, s61, s12
v_mfma_f32_16x16x32_bf16 v[80:83], v[172:175], a[76:79], v[80:83]
ds_read_b64_tr_b16 v[206:207], v4 offset:12544
s_add_u32 s101, s101, 0x2000
v_mfma_f32_16x16x32_bf16 v[80:83], v[168:171], a[68:71], v[80:83]
buffer_load_dwordx4 a[104:107], v3, s[88:91], s101 offen sc1
v_mfma_f32_16x16x32_bf16 v[84:87], v[176:179], a[68:71], v[84:87]
ds_read_b64_tr_b16 v[208:209], v5 offset:256
ds_read_b64_tr_b16 v[210:211], v5 offset:4352
v_mfma_f32_16x16x32_bf16 v[84:87], v[180:183], a[76:79], v[84:87]
ds_read_b64_tr_b16 v[212:213], v5 offset:8448
s_waitcnt vmcnt(7) lgkmcnt(7)
v_mfma_f32_16x16x32_bf16 v[68:71], v[180:183], a[72:75], v[68:71]
ds_read_b64_tr_b16 v[214:215], v5 offset:12544
s_barrier
v_mfma_f32_16x16x32_bf16 v[68:71], v[176:179], a[64:67], v[68:71]
buffer_load_dwordx4 a[108:111], v3, s[88:91], s101 offen offset:1024 sc1
v_mfma_f32_16x16x32_bf16 v[24:27], v[184:187], a[64:67], v[24:27]
ds_read_b64_tr_b16 v[152:153], v4 offset:16896
ds_read_b64_tr_b16 v[154:155], v4 offset:20992
v_mfma_f32_16x16x32_bf16 v[24:27], v[188:191], a[72:75], v[24:27]
ds_read_b64_tr_b16 v[156:157], v4 offset:25088
s_add_u32 s101, s63, s60
v_mfma_f32_16x16x32_bf16 v[40:43], v[188:191], a[76:79], v[40:43]
ds_read_b64_tr_b16 v[158:159], v4 offset:29184
s_add_u32 m0, s16, 0x4000
v_mfma_f32_16x16x32_bf16 v[40:43], v[184:187], a[68:71], v[40:43]
buffer_load_dwordx4 v12, s[64:67], s61 offen lds
v_mfma_f32_16x16x32_bf16 v[44:47], v[192:195], a[68:71], v[44:47]
ds_read_b64_tr_b16 v[160:161], v5 offset:16896
ds_read_b64_tr_b16 v[162:163], v5 offset:20992
v_mfma_f32_16x16x32_bf16 v[44:47], v[196:199], a[76:79], v[44:47]
ds_read_b64_tr_b16 v[164:165], v5 offset:25088
v_mfma_f32_16x16x32_bf16 v[28:31], v[196:199], a[72:75], v[28:31]
ds_read_b64_tr_b16 v[166:167], v5 offset:29184
s_waitcnt lgkmcnt(8)
v_mfma_f32_16x16x32_bf16 v[28:31], v[192:195], a[64:67], v[28:31]
buffer_load_dwordx4 v13, s[64:67], s61 offen offset:1024 lds
v_mfma_f32_16x16x32_bf16 v[32:35], v[200:203], a[64:67], v[32:35]
ds_read_b64_tr_b16 v[168:169], v4 offset:17152
ds_read_b64_tr_b16 v[170:171], v4 offset:21248
v_mfma_f32_16x16x32_bf16 v[32:35], v[204:207], a[72:75], v[32:35]
ds_read_b64_tr_b16 v[172:173], v4 offset:25344
v_mfma_f32_16x16x32_bf16 v[48:51], v[204:207], a[76:79], v[48:51]
ds_read_b64_tr_b16 v[174:175], v4 offset:29440
v_mfma_f32_16x16x32_bf16 v[48:51], v[200:203], a[68:71], v[48:51]
buffer_load_dwordx4 v12, s[64:67], s62 offen offset:2048 lds
v_mfma_f32_16x16x32_bf16 v[52:55], v[208:211], a[68:71], v[52:55]
ds_read_b64_tr_b16 v[176:177], v5 offset:17152
ds_read_b64_tr_b16 v[178:179], v5 offset:21248
v_mfma_f32_16x16x32_bf16 v[52:55], v[212:215], a[76:79], v[52:55]
ds_read_b64_tr_b16 v[180:181], v5 offset:25344
s_waitcnt lgkmcnt(7)
v_mfma_f32_16x16x32_bf16 v[36:39], v[212:215], a[72:75], v[36:39]
ds_read_b64_tr_b16 v[182:183], v5 offset:29440
v_mfma_f32_16x16x32_bf16 v[36:39], v[208:211], a[64:67], v[36:39]
buffer_load_dwordx4 v13, s[64:67], s62 offen offset:3072 lds
v_mfma_f32_16x16x32_bf16 v[56:59], v[152:155], a[80:83], v[56:59]
ds_read_b64_tr_b16 v[184:185], v4 offset:16384
ds_read_b64_tr_b16 v[186:187], v4 offset:20480
v_mfma_f32_16x16x32_bf16 v[56:59], v[156:159], a[88:91], v[56:59]
ds_read_b64_tr_b16 v[188:189], v4 offset:24576
s_add_u32 s60, s60, s58
v_mfma_f32_16x16x32_bf16 v[72:75], v[156:159], a[92:95], v[72:75]
ds_read_b64_tr_b16 v[190:191], v4 offset:28672
s_and_b32 s60, s60, 0x7c000
v_mfma_f32_16x16x32_bf16 v[72:75], v[152:155], a[84:87], v[72:75]
buffer_load_dwordx4 a[112:115], v3, s[88:91], s101 offen sc1
v_mfma_f32_16x16x32_bf16 v[76:79], v[160:163], a[84:87], v[76:79]
ds_read_b64_tr_b16 v[192:193], v5 offset:16384
ds_read_b64_tr_b16 v[194:195], v5 offset:20480
v_mfma_f32_16x16x32_bf16 v[76:79], v[164:167], a[92:95], v[76:79]
ds_read_b64_tr_b16 v[196:197], v5 offset:24576
s_lshl_b32 s61, s60, 3
v_mfma_f32_16x16x32_bf16 v[60:63], v[164:167], a[88:91], v[60:63]
ds_read_b64_tr_b16 v[198:199], v5 offset:28672
s_waitcnt lgkmcnt(8)
v_mfma_f32_16x16x32_bf16 v[60:63], v[160:163], a[80:83], v[60:63]
buffer_load_dwordx4 a[116:119], v3, s[88:91], s101 offen offset:1024 sc1
v_mfma_f32_16x16x32_bf16 v[64:67], v[168:171], a[80:83], v[64:67]
ds_read_b64_tr_b16 v[200:201], v4 offset:16640
ds_read_b64_tr_b16 v[202:203], v4 offset:20736
v_mfma_f32_16x16x32_bf16 v[64:67], v[172:175], a[88:91], v[64:67]
ds_read_b64_tr_b16 v[204:205], v4 offset:24832
s_add_u32 s62, s61, s12
v_mfma_f32_16x16x32_bf16 v[80:83], v[172:175], a[92:95], v[80:83]
ds_read_b64_tr_b16 v[206:207], v4 offset:28928
s_add_u32 s101, s101, 0x2000
v_mfma_f32_16x16x32_bf16 v[80:83], v[168:171], a[84:87], v[80:83]
buffer_load_dwordx4 a[120:123], v3, s[88:91], s101 offen sc1
v_mfma_f32_16x16x32_bf16 v[84:87], v[176:179], a[84:87], v[84:87]
ds_read_b64_tr_b16 v[208:209], v5 offset:16640
ds_read_b64_tr_b16 v[210:211], v5 offset:20736
v_mfma_f32_16x16x32_bf16 v[84:87], v[180:183], a[92:95], v[84:87]
ds_read_b64_tr_b16 v[212:213], v5 offset:24832
s_waitcnt vmcnt(7) lgkmcnt(7)
v_mfma_f32_16x16x32_bf16 v[68:71], v[180:183], a[88:91], v[68:71]
ds_read_b64_tr_b16 v[214:215], v5 offset:28928
s_barrier
v_mfma_f32_16x16x32_bf16 v[68:71], v[176:179], a[80:83], v[68:71]
buffer_load_dwordx4 a[124:127], v3, s[88:91], s101 offen offset:1024 sc1
v_mfma_f32_16x16x32_bf16 v[24:27], v[184:187], a[80:83], v[24:27]
ds_read_b64_tr_b16 v[152:153], v6 offset:512
ds_read_b64_tr_b16 v[154:155], v6 offset:4608
v_mfma_f32_16x16x32_bf16 v[24:27], v[188:191], a[88:91], v[24:27]
ds_read_b64_tr_b16 v[156:157], v6 offset:8704
s_add_u32 s101, s63, s60
v_mfma_f32_16x16x32_bf16 v[40:43], v[188:191], a[92:95], v[40:43]
ds_read_b64_tr_b16 v[158:159], v6 offset:12800
s_add_u32 m0, s17, 0x10000
v_mfma_f32_16x16x32_bf16 v[40:43], v[184:187], a[84:87], v[40:43]
buffer_load_dwordx4 v12, s[64:67], s61 offen lds
v_mfma_f32_16x16x32_bf16 v[44:47], v[192:195], a[84:87], v[44:47]
ds_read_b64_tr_b16 v[160:161], v7 offset:512
ds_read_b64_tr_b16 v[162:163], v7 offset:4608
v_mfma_f32_16x16x32_bf16 v[44:47], v[196:199], a[92:95], v[44:47]
ds_read_b64_tr_b16 v[164:165], v7 offset:8704
v_mfma_f32_16x16x32_bf16 v[28:31], v[196:199], a[88:91], v[28:31]
ds_read_b64_tr_b16 v[166:167], v7 offset:12800
s_waitcnt lgkmcnt(8)
v_mfma_f32_16x16x32_bf16 v[28:31], v[192:195], a[80:83], v[28:31]
buffer_load_dwordx4 v13, s[64:67], s61 offen offset:1024 lds
v_mfma_f32_16x16x32_bf16 v[32:35], v[200:203], a[80:83], v[32:35]
ds_read_b64_tr_b16 v[168:169], v6 offset:768
ds_read_b64_tr_b16 v[170:171], v6 offset:4864
v_mfma_f32_16x16x32_bf16 v[32:35], v[204:207], a[88:91], v[32:35]
ds_read_b64_tr_b16 v[172:173], v6 offset:8960
v_mfma_f32_16x16x32_bf16 v[48:51], v[204:207], a[92:95], v[48:51]
ds_read_b64_tr_b16 v[174:175], v6 offset:13056
v_mfma_f32_16x16x32_bf16 v[48:51], v[200:203], a[84:87], v[48:51]
buffer_load_dwordx4 v12, s[64:67], s62 offen offset:2048 lds
v_mfma_f32_16x16x32_bf16 v[52:55], v[208:211], a[84:87], v[52:55]
ds_read_b64_tr_b16 v[176:177], v7 offset:768
ds_read_b64_tr_b16 v[178:179], v7 offset:4864
v_mfma_f32_16x16x32_bf16 v[52:55], v[212:215], a[92:95], v[52:55]
ds_read_b64_tr_b16 v[180:181], v7 offset:8960
s_waitcnt lgkmcnt(7)
v_mfma_f32_16x16x32_bf16 v[36:39], v[212:215], a[88:91], v[36:39]
ds_read_b64_tr_b16 v[182:183], v7 offset:13056
v_mfma_f32_16x16x32_bf16 v[36:39], v[208:211], a[80:83], v[36:39]
buffer_load_dwordx4 v13, s[64:67], s62 offen offset:3072 lds
v_mfma_f32_16x16x32_bf16 v[120:123], v[152:155], a[96:99], 0
ds_read_b64_tr_b16 v[184:185], v6 offset:0
ds_read_b64_tr_b16 v[186:187], v6 offset:4096
v_mfma_f32_16x16x32_bf16 v[120:123], v[156:159], a[104:107], v[120:123]
ds_read_b64_tr_b16 v[188:189], v6 offset:8192
s_add_u32 s60, s60, s59
v_mfma_f32_16x16x32_bf16 v[136:139], v[156:159], a[108:111], 0
ds_read_b64_tr_b16 v[190:191], v6 offset:12288
s_and_b32 s60, s60, 0x7c000
v_mfma_f32_16x16x32_bf16 v[136:139], v[152:155], a[100:103], v[136:139]
buffer_load_dwordx4 a[64:67], v3, s[88:91], s101 offen sc1
v_mfma_f32_16x16x32_bf16 v[140:143], v[160:163], a[100:103], 0
ds_read_b64_tr_b16 v[192:193], v7 offset:0
ds_read_b64_tr_b16 v[194:195], v7 offset:4096
v_mfma_f32_16x16x32_bf16 v[140:143], v[164:167], a[108:111], v[140:143]
ds_read_b64_tr_b16 v[196:197], v7 offset:8192
s_lshl_b32 s61, s60, 3
v_mfma_f32_16x16x32_bf16 v[124:127], v[164:167], a[104:107], 0
ds_read_b64_tr_b16 v[198:199], v7 offset:12288
s_waitcnt lgkmcnt(8)
v_mfma_f32_16x16x32_bf16 v[124:127], v[160:163], a[96:99], v[124:127]
buffer_load_dwordx4 a[68:71], v3, s[88:91], s101 offen offset:1024 sc1
v_mfma_f32_16x16x32_bf16 v[128:131], v[168:171], a[96:99], 0
ds_read_b64_tr_b16 v[200:201], v6 offset:256
ds_read_b64_tr_b16 v[202:203], v6 offset:4352
v_mfma_f32_16x16x32_bf16 v[128:131], v[172:175], a[104:107], v[128:131]
ds_read_b64_tr_b16 v[204:205], v6 offset:8448
s_add_u32 s62, s61, s12
v_mfma_f32_16x16x32_bf16 v[144:147], v[172:175], a[108:111], 0
ds_read_b64_tr_b16 v[206:207], v6 offset:12544
s_add_u32 s101, s101, 0x2000
v_mfma_f32_16x16x32_bf16 v[144:147], v[168:171], a[100:103], v[144:147]
buffer_load_dwordx4 a[72:75], v3, s[88:91], s101 offen sc1
v_mfma_f32_16x16x32_bf16 v[148:151], v[176:179], a[100:103], 0
ds_read_b64_tr_b16 v[208:209], v7 offset:256
ds_read_b64_tr_b16 v[210:211], v7 offset:4352
v_mfma_f32_16x16x32_bf16 v[148:151], v[180:183], a[108:111], v[148:151]
ds_read_b64_tr_b16 v[212:213], v7 offset:8448
s_waitcnt vmcnt(7) lgkmcnt(7)
v_mfma_f32_16x16x32_bf16 v[132:135], v[180:183], a[104:107], 0
ds_read_b64_tr_b16 v[214:215], v7 offset:12544
s_barrier
v_mfma_f32_16x16x32_bf16 v[132:135], v[176:179], a[96:99], v[132:135]
buffer_load_dwordx4 a[76:79], v3, s[88:91], s101 offen offset:1024 sc1
s_mov_b32 s15, 7
s_getreg_b32 s8, hwreg(HW_REG_HW_ID, 5, 1)
s_cmp_lg_u32 s8, 0
s_cbranch_scc1 L_p4_loop1
L_p4_loop0:
v_mfma_f32_16x16x32_bf16 v[88:91], v[184:187], a[96:99], v[88:91]
ds_read_b64_tr_b16 v[152:153], v6 offset:16896
ds_read_b64_tr_b16 v[154:155], v6 offset:20992
v_mfma_f32_16x16x32_bf16 v[88:91], v[188:191], a[104:107], v[88:91]
ds_read_b64_tr_b16 v[156:157], v6 offset:25088
s_add_u32 s101, s63, s60
v_mfma_f32_16x16x32_bf16 v[104:107], v[188:191], a[108:111], v[104:107]
ds_read_b64_tr_b16 v[158:159], v6 offset:29184
s_add_u32 m0, s17, 0x14000
v_mfma_f32_16x16x32_bf16 v[104:107], v[184:187], a[100:103], v[104:107]
buffer_load_dwordx4 v12, s[64:67], s61 offen lds
v_mfma_f32_16x16x32_bf16 v[108:111], v[192:195], a[100:103], v[108:111]
ds_read_b64_tr_b16 v[160:161], v7 offset:16896
ds_read_b64_tr_b16 v[162:163], v7 offset:20992
v_mfma_f32_16x16x32_bf16 v[108:111], v[196:199], a[108:111], v[108:111]
ds_read_b64_tr_b16 v[164:165], v7 offset:25088
v_mfma_f32_16x16x32_bf16 v[92:95], v[196:199], a[104:107], v[92:95]
ds_read_b64_tr_b16 v[166:167], v7 offset:29184
s_waitcnt lgkmcnt(8)
v_mfma_f32_16x16x32_bf16 v[92:95], v[192:195], a[96:99], v[92:95]
buffer_load_dwordx4 v13, s[64:67], s61 offen offset:1024 lds
v_mfma_f32_16x16x32_bf16 v[96:99], v[200:203], a[96:99], v[96:99]
ds_read_b64_tr_b16 v[168:169], v6 offset:17152
ds_read_b64_tr_b16 v[170:171], v6 offset:21248
v_mfma_f32_16x16x32_bf16 v[96:99], v[204:207], a[104:107], v[96:99]
ds_read_b64_tr_b16 v[172:173], v6 offset:25344
v_mfma_f32_16x16x32_bf16 v[112:115], v[204:207], a[108:111], v[112:115]
ds_read_b64_tr_b16 v[174:175], v6 offset:29440
v_mfma_f32_16x16x32_bf16 v[112:115], v[200:203], a[100:103], v[112:115]
buffer_load_dwordx4 v12, s[64:67], s62 offen offset:2048 lds
v_mfma_f32_16x16x32_bf16 v[116:119], v[208:211], a[100:103], v[116:119]
ds_read_b64_tr_b16 v[176:177], v7 offset:17152
ds_read_b64_tr_b16 v[178:179], v7 offset:21248
v_mfma_f32_16x16x32_bf16 v[116:119], v[212:215], a[108:111], v[116:119]
ds_read_b64_tr_b16 v[180:181], v7 offset:25344
s_waitcnt lgkmcnt(7)
v_mfma_f32_16x16x32_bf16 v[100:103], v[212:215], a[104:107], v[100:103]
ds_read_b64_tr_b16 v[182:183], v7 offset:29440
v_mfma_f32_16x16x32_bf16 v[100:103], v[208:211], a[96:99], v[100:103]
buffer_load_dwordx4 v13, s[64:67], s62 offen offset:3072 lds
v_mfma_f32_16x16x32_bf16 v[120:123], v[152:155], a[112:115], v[120:123]
ds_read_b64_tr_b16 v[184:185], v6 offset:16384
ds_read_b64_tr_b16 v[186:187], v6 offset:20480
v_mfma_f32_16x16x32_bf16 v[120:123], v[156:159], a[120:123], v[120:123]
ds_read_b64_tr_b16 v[188:189], v6 offset:24576
s_add_u32 s60, s60, s56
v_mfma_f32_16x16x32_bf16 v[136:139], v[156:159], a[124:127], v[136:139]
ds_read_b64_tr_b16 v[190:191], v6 offset:28672
s_and_b32 s60, s60, 0x7c000
v_mfma_f32_16x16x32_bf16 v[136:139], v[152:155], a[116:119], v[136:139]
buffer_load_dwordx4 a[80:83], v3, s[88:91], s101 offen sc1
v_mfma_f32_16x16x32_bf16 v[140:143], v[160:163], a[116:119], v[140:143]
ds_read_b64_tr_b16 v[192:193], v7 offset:16384
ds_read_b64_tr_b16 v[194:195], v7 offset:20480
v_mfma_f32_16x16x32_bf16 v[140:143], v[164:167], a[124:127], v[140:143]
ds_read_b64_tr_b16 v[196:197], v7 offset:24576
s_lshl_b32 s61, s60, 3
v_mfma_f32_16x16x32_bf16 v[124:127], v[164:167], a[120:123], v[124:127]
ds_read_b64_tr_b16 v[198:199], v7 offset:28672
s_waitcnt lgkmcnt(8)
v_mfma_f32_16x16x32_bf16 v[124:127], v[160:163], a[112:115], v[124:127]
buffer_load_dwordx4 a[84:87], v3, s[88:91], s101 offen offset:1024 sc1
v_mfma_f32_16x16x32_bf16 v[128:131], v[168:171], a[112:115], v[128:131]
ds_read_b64_tr_b16 v[200:201], v6 offset:16640
ds_read_b64_tr_b16 v[202:203], v6 offset:20736
v_mfma_f32_16x16x32_bf16 v[128:131], v[172:175], a[120:123], v[128:131]
ds_read_b64_tr_b16 v[204:205], v6 offset:24832
s_add_u32 s62, s61, s12
v_mfma_f32_16x16x32_bf16 v[144:147], v[172:175], a[124:127], v[144:147]
ds_read_b64_tr_b16 v[206:207], v6 offset:28928
s_add_u32 s101, s101, 0x2000
v_mfma_f32_16x16x32_bf16 v[144:147], v[168:171], a[116:119], v[144:147]
buffer_load_dwordx4 a[88:91], v3, s[88:91], s101 offen sc1
v_mfma_f32_16x16x32_bf16 v[148:151], v[176:179], a[116:119], v[148:151]
ds_read_b64_tr_b16 v[208:209], v7 offset:16640
ds_read_b64_tr_b16 v[210:211], v7 offset:20736
v_mfma_f32_16x16x32_bf16 v[148:151], v[180:183], a[124:127], v[148:151]
ds_read_b64_tr_b16 v[212:213], v7 offset:24832
v_mfma_f32_16x16x32_bf16 v[132:135], v[180:183], a[120:123], v[132:135]
ds_read_b64_tr_b16 v[214:215], v7 offset:28928
s_waitcnt vmcnt(7) lgkmcnt(8)
v_mfma_f32_16x16x32_bf16 v[132:135], v[176:179], a[112:115], v[132:135]
buffer_load_dwordx4 a[92:95], v3, s[88:91], s101 offen offset:1024 sc1
s_barrier
v_mfma_f32_16x16x32_bf16 v[88:91], v[184:187], a[112:115], v[88:91]
ds_read_b64_tr_b16 v[152:153], v4 offset:512
ds_read_b64_tr_b16 v[154:155], v4 offset:4608
v_mfma_f32_16x16x32_bf16 v[88:91], v[188:191], a[120:123], v[88:91]
ds_read_b64_tr_b16 v[156:157], v4 offset:8704
s_add_u32 s101, s63, s60
v_mfma_f32_16x16x32_bf16 v[104:107], v[188:191], a[124:127], v[104:107]
ds_read_b64_tr_b16 v[158:159], v4 offset:12800
s_add_u32 m0, s16, 0x0
v_mfma_f32_16x16x32_bf16 v[104:107], v[184:187], a[116:119], v[104:107]
buffer_load_dwordx4 v12, s[64:67], s61 offen lds
v_mfma_f32_16x16x32_bf16 v[108:111], v[192:195], a[116:119], v[108:111]
ds_read_b64_tr_b16 v[160:161], v5 offset:512
ds_read_b64_tr_b16 v[162:163], v5 offset:4608
v_mfma_f32_16x16x32_bf16 v[108:111], v[196:199], a[124:127], v[108:111]
ds_read_b64_tr_b16 v[164:165], v5 offset:8704
v_mfma_f32_16x16x32_bf16 v[92:95], v[196:199], a[120:123], v[92:95]
ds_read_b64_tr_b16 v[166:167], v5 offset:12800
s_waitcnt lgkmcnt(8)
v_mfma_f32_16x16x32_bf16 v[92:95], v[192:195], a[112:115], v[92:95]
buffer_load_dwordx4 v13, s[64:67], s61 offen offset:1024 lds
v_mfma_f32_16x16x32_bf16 v[96:99], v[200:203], a[112:115], v[96:99]
ds_read_b64_tr_b16 v[168:169], v4 offset:768
ds_read_b64_tr_b16 v[170:171], v4 offset:4864
v_mfma_f32_16x16x32_bf16 v[96:99], v[204:207], a[120:123], v[96:99]
ds_read_b64_tr_b16 v[172:173], v4 offset:8960
v_mfma_f32_16x16x32_bf16 v[112:115], v[204:207], a[124:127], v[112:115]
ds_read_b64_tr_b16 v[174:175], v4 offset:13056
v_mfma_f32_16x16x32_bf16 v[112:115], v[200:203], a[116:119], v[112:115]
buffer_load_dwordx4 v12, s[64:67], s62 offen offset:2048 lds
v_mfma_f32_16x16x32_bf16 v[116:119], v[208:211], a[116:119], v[116:119]
ds_read_b64_tr_b16 v[176:177], v5 offset:768
ds_read_b64_tr_b16 v[178:179], v5 offset:4864
v_mfma_f32_16x16x32_bf16 v[116:119], v[212:215], a[124:127], v[116:119]
ds_read_b64_tr_b16 v[180:181], v5 offset:8960
s_waitcnt lgkmcnt(7)
v_mfma_f32_16x16x32_bf16 v[100:103], v[212:215], a[120:123], v[100:103]
ds_read_b64_tr_b16 v[182:183], v5 offset:13056
v_mfma_f32_16x16x32_bf16 v[100:103], v[208:211], a[112:115], v[100:103]
buffer_load_dwordx4 v13, s[64:67], s62 offen offset:3072 lds
v_mfma_f32_16x16x32_bf16 v[120:123], v[152:155], a[64:67], v[120:123]
ds_read_b64_tr_b16 v[184:185], v4 offset:0
ds_read_b64_tr_b16 v[186:187], v4 offset:4096
v_mfma_f32_16x16x32_bf16 v[120:123], v[156:159], a[72:75], v[120:123]
ds_read_b64_tr_b16 v[188:189], v4 offset:8192
s_add_u32 s60, s60, s57
v_mfma_f32_16x16x32_bf16 v[136:139], v[156:159], a[76:79], v[136:139]
ds_read_b64_tr_b16 v[190:191], v4 offset:12288
s_and_b32 s60, s60, 0x7c000
v_mfma_f32_16x16x32_bf16 v[136:139], v[152:155], a[68:71], v[136:139]
buffer_load_dwordx4 a[96:99], v3, s[88:91], s101 offen sc1
v_mfma_f32_16x16x32_bf16 v[140:143], v[160:163], a[68:71], v[140:143]
ds_read_b64_tr_b16 v[192:193], v5 offset:0
ds_read_b64_tr_b16 v[194:195], v5 offset:4096
v_mfma_f32_16x16x32_bf16 v[140:143], v[164:167], a[76:79], v[140:143]
ds_read_b64_tr_b16 v[196:197], v5 offset:8192
s_lshl_b32 s61, s60, 3
v_mfma_f32_16x16x32_bf16 v[124:127], v[164:167], a[72:75], v[124:127]
ds_read_b64_tr_b16 v[198:199], v5 offset:12288
s_waitcnt lgkmcnt(8)
v_mfma_f32_16x16x32_bf16 v[124:127], v[160:163], a[64:67], v[124:127]
buffer_load_dwordx4 a[100:103], v3, s[88:91], s101 offen offset:1024 sc1
v_mfma_f32_16x16x32_bf16 v[128:131], v[168:171], a[64:67], v[128:131]
ds_read_b64_tr_b16 v[200:201], v4 offset:256
ds_read_b64_tr_b16 v[202:203], v4 offset:4352
v_mfma_f32_16x16x32_bf16 v[128:131], v[172:175], a[72:75], v[128:131]
ds_read_b64_tr_b16 v[204:205], v4 offset:8448
s_add_u32 s62, s61, s12
v_mfma_f32_16x16x32_bf16 v[144:147], v[172:175], a[76:79], v[144:147]
ds_read_b64_tr_b16 v[206:207], v4 offset:12544
s_add_u32 s101, s101, 0x2000
v_mfma_f32_16x16x32_bf16 v[144:147], v[168:171], a[68:71], v[144:147]
buffer_load_dwordx4 a[104:107], v3, s[88:91], s101 offen sc1
v_mfma_f32_16x16x32_bf16 v[148:151], v[176:179], a[68:71], v[148:151]
ds_read_b64_tr_b16 v[208:209], v5 offset:256
ds_read_b64_tr_b16 v[210:211], v5 offset:4352
v_mfma_f32_16x16x32_bf16 v[148:151], v[180:183], a[76:79], v[148:151]
ds_read_b64_tr_b16 v[212:213], v5 offset:8448
v_mfma_f32_16x16x32_bf16 v[132:135], v[180:183], a[72:75], v[132:135]
ds_read_b64_tr_b16 v[214:215], v5 offset:12544
s_waitcnt vmcnt(7) lgkmcnt(8)
v_mfma_f32_16x16x32_bf16 v[132:135], v[176:179], a[64:67], v[132:135]
buffer_load_dwordx4 a[108:111], v3, s[88:91], s101 offen offset:1024 sc1
s_barrier
v_mfma_f32_16x16x32_bf16 v[88:91], v[184:187], a[64:67], v[88:91]
ds_read_b64_tr_b16 v[152:153], v4 offset:16896
ds_read_b64_tr_b16 v[154:155], v4 offset:20992
v_mfma_f32_16x16x32_bf16 v[88:91], v[188:191], a[72:75], v[88:91]
ds_read_b64_tr_b16 v[156:157], v4 offset:25088
s_add_u32 s101, s63, s60
v_mfma_f32_16x16x32_bf16 v[104:107], v[188:191], a[76:79], v[104:107]
ds_read_b64_tr_b16 v[158:159], v4 offset:29184
s_add_u32 m0, s16, 0x4000
v_mfma_f32_16x16x32_bf16 v[104:107], v[184:187], a[68:71], v[104:107]
buffer_load_dwordx4 v12, s[64:67], s61 offen lds
v_mfma_f32_16x16x32_bf16 v[108:111], v[192:195], a[68:71], v[108:111]
ds_read_b64_tr_b16 v[160:161], v5 offset:16896
ds_read_b64_tr_b16 v[162:163], v5 offset:20992
v_mfma_f32_16x16x32_bf16 v[108:111], v[196:199], a[76:79], v[108:111]
ds_read_b64_tr_b16 v[164:165], v5 offset:25088
v_mfma_f32_16x16x32_bf16 v[92:95], v[196:199], a[72:75], v[92:95]
ds_read_b64_tr_b16 v[166:167], v5 offset:29184
s_waitcnt lgkmcnt(8)
v_mfma_f32_16x16x32_bf16 v[92:95], v[192:195], a[64:67], v[92:95]
buffer_load_dwordx4 v13, s[64:67], s61 offen offset:1024 lds
v_mfma_f32_16x16x32_bf16 v[96:99], v[200:203], a[64:67], v[96:99]
ds_read_b64_tr_b16 v[168:169], v4 offset:17152
ds_read_b64_tr_b16 v[170:171], v4 offset:21248
v_mfma_f32_16x16x32_bf16 v[96:99], v[204:207], a[72:75], v[96:99]
ds_read_b64_tr_b16 v[172:173], v4 offset:25344
v_mfma_f32_16x16x32_bf16 v[112:115], v[204:207], a[76:79], v[112:115]
ds_read_b64_tr_b16 v[174:175], v4 offset:29440
v_mfma_f32_16x16x32_bf16 v[112:115], v[200:203], a[68:71], v[112:115]
buffer_load_dwordx4 v12, s[64:67], s62 offen offset:2048 lds
v_mfma_f32_16x16x32_bf16 v[116:119], v[208:211], a[68:71], v[116:119]
ds_read_b64_tr_b16 v[176:177], v5 offset:17152
ds_read_b64_tr_b16 v[178:179], v5 offset:21248
v_mfma_f32_16x16x32_bf16 v[116:119], v[212:215], a[76:79], v[116:119]
ds_read_b64_tr_b16 v[180:181], v5 offset:25344
s_waitcnt lgkmcnt(7)
v_mfma_f32_16x16x32_bf16 v[100:103], v[212:215], a[72:75], v[100:103]
ds_read_b64_tr_b16 v[182:183], v5 offset:29440
v_mfma_f32_16x16x32_bf16 v[100:103], v[208:211], a[64:67], v[100:103]
buffer_load_dwordx4 v13, s[64:67], s62 offen offset:3072 lds
v_mfma_f32_16x16x32_bf16 v[120:123], v[152:155], a[80:83], v[120:123]
ds_read_b64_tr_b16 v[184:185], v4 offset:16384
ds_read_b64_tr_b16 v[186:187], v4 offset:20480
v_mfma_f32_16x16x32_bf16 v[120:123], v[156:159], a[88:91], v[120:123]
ds_read_b64_tr_b16 v[188:189], v4 offset:24576
s_add_u32 s60, s60, s58
v_mfma_f32_16x16x32_bf16 v[136:139], v[156:159], a[92:95], v[136:139]
ds_read_b64_tr_b16 v[190:191], v4 offset:28672
s_and_b32 s60, s60, 0x7c000
v_mfma_f32_16x16x32_bf16 v[136:139], v[152:155], a[84:87], v[136:139]
buffer_load_dwordx4 a[112:115], v3, s[88:91], s101 offen sc1
v_mfma_f32_16x16x32_bf16 v[140:143], v[160:163], a[84:87], v[140:143]
ds_read_b64_tr_b16 v[192:193], v5 offset:16384
ds_read_b64_tr_b16 v[194:195], v5 offset:20480
v_mfma_f32_16x16x32_bf16 v[140:143], v[164:167], a[92:95], v[140:143]
ds_read_b64_tr_b16 v[196:197], v5 offset:24576
s_lshl_b32 s61, s60, 3
v_mfma_f32_16x16x32_bf16 v[124:127], v[164:167], a[88:91], v[124:127]
ds_read_b64_tr_b16 v[198:199], v5 offset:28672
s_waitcnt lgkmcnt(8)
v_mfma_f32_16x16x32_bf16 v[124:127], v[160:163], a[80:83], v[124:127]
buffer_load_dwordx4 a[116:119], v3, s[88:91], s101 offen offset:1024 sc1
v_mfma_f32_16x16x32_bf16 v[128:131], v[168:171], a[80:83], v[128:131]
ds_read_b64_tr_b16 v[200:201], v4 offset:16640
ds_read_b64_tr_b16 v[202:203], v4 offset:20736
v_mfma_f32_16x16x32_bf16 v[128:131], v[172:175], a[88:91], v[128:131]
ds_read_b64_tr_b16 v[204:205], v4 offset:24832
s_add_u32 s62, s61, s12
v_mfma_f32_16x16x32_bf16 v[144:147], v[172:175], a[92:95], v[144:147]
ds_read_b64_tr_b16 v[206:207], v4 offset:28928
s_add_u32 s101, s101, 0x2000
v_mfma_f32_16x16x32_bf16 v[144:147], v[168:171], a[84:87], v[144:147]
buffer_load_dwordx4 a[120:123], v3, s[88:91], s101 offen sc1
v_mfma_f32_16x16x32_bf16 v[148:151], v[176:179], a[84:87], v[148:151]
ds_read_b64_tr_b16 v[208:209], v5 offset:16640
ds_read_b64_tr_b16 v[210:211], v5 offset:20736
v_mfma_f32_16x16x32_bf16 v[148:151], v[180:183], a[92:95], v[148:151]
ds_read_b64_tr_b16 v[212:213], v5 offset:24832
v_mfma_f32_16x16x32_bf16 v[132:135], v[180:183], a[88:91], v[132:135]
ds_read_b64_tr_b16 v[214:215], v5 offset:28928
s_waitcnt vmcnt(7) lgkmcnt(8)
v_mfma_f32_16x16x32_bf16 v[132:135], v[176:179], a[80:83], v[132:135]
buffer_load_dwordx4 a[124:127], v3, s[88:91], s101 offen offset:1024 sc1
s_barrier
buffer_load_dword v14, v20, s[88:91], s24 offen sc1
v_mfma_f32_16x16x32_bf16 v[88:91], v[184:187], a[80:83], v[88:91]
ds_read_b64_tr_b16 v[152:153], v6 offset:512
ds_read_b64_tr_b16 v[154:155], v6 offset:4608
v_mfma_f32_16x16x32_bf16 v[88:91], v[188:191], a[88:91], v[88:91]
ds_read_b64_tr_b16 v[156:157], v6 offset:8704
s_add_u32 s101, s63, s60
v_mfma_f32_16x16x32_bf16 v[104:107], v[188:191], a[92:95], v[104:107]
ds_read_b64_tr_b16 v[158:159], v6 offset:12800
s_add_u32 m0, s17, 0x10000
v_mfma_f32_16x16x32_bf16 v[104:107], v[184:187], a[84:87], v[104:107]
buffer_load_dwordx4 v12, s[64:67], s61 offen lds
v_mfma_f32_16x16x32_bf16 v[108:111], v[192:195], a[84:87], v[108:111]
ds_read_b64_tr_b16 v[160:161], v7 offset:512
ds_read_b64_tr_b16 v[162:163], v7 offset:4608
v_mfma_f32_16x16x32_bf16 v[108:111], v[196:199], a[92:95], v[108:111]
ds_read_b64_tr_b16 v[164:165], v7 offset:8704
s_sub_u32 s15, s15, 1
v_mfma_f32_16x16x32_bf16 v[92:95], v[196:199], a[88:91], v[92:95]
ds_read_b64_tr_b16 v[166:167], v7 offset:12800
s_waitcnt lgkmcnt(8)
v_mfma_f32_16x16x32_bf16 v[92:95], v[192:195], a[80:83], v[92:95]
buffer_load_dwordx4 v13, s[64:67], s61 offen offset:1024 lds
v_mfma_f32_16x16x32_bf16 v[96:99], v[200:203], a[80:83], v[96:99]
ds_read_b64_tr_b16 v[168:169], v6 offset:768
ds_read_b64_tr_b16 v[170:171], v6 offset:4864
v_mfma_f32_16x16x32_bf16 v[96:99], v[204:207], a[88:91], v[96:99]
ds_read_b64_tr_b16 v[172:173], v6 offset:8960
v_mfma_f32_16x16x32_bf16 v[112:115], v[204:207], a[92:95], v[112:115]
ds_read_b64_tr_b16 v[174:175], v6 offset:13056
v_mfma_f32_16x16x32_bf16 v[112:115], v[200:203], a[84:87], v[112:115]
buffer_load_dwordx4 v12, s[64:67], s62 offen offset:2048 lds
v_mfma_f32_16x16x32_bf16 v[116:119], v[208:211], a[84:87], v[116:119]
ds_read_b64_tr_b16 v[176:177], v7 offset:768
ds_read_b64_tr_b16 v[178:179], v7 offset:4864
v_mfma_f32_16x16x32_bf16 v[116:119], v[212:215], a[92:95], v[116:119]
ds_read_b64_tr_b16 v[180:181], v7 offset:8960
s_waitcnt lgkmcnt(7)
v_mfma_f32_16x16x32_bf16 v[100:103], v[212:215], a[88:91], v[100:103]
ds_read_b64_tr_b16 v[182:183], v7 offset:13056
v_mfma_f32_16x16x32_bf16 v[100:103], v[208:211], a[80:83], v[100:103]
buffer_load_dwordx4 v13, s[64:67], s62 offen offset:3072 lds
v_mfma_f32_16x16x32_bf16 v[120:123], v[152:155], a[96:99], v[120:123]
ds_read_b64_tr_b16 v[184:185], v6 offset:0
ds_read_b64_tr_b16 v[186:187], v6 offset:4096
v_mfma_f32_16x16x32_bf16 v[120:123], v[156:159], a[104:107], v[120:123]
ds_read_b64_tr_b16 v[188:189], v6 offset:8192
s_add_u32 s60, s60, s59
v_mfma_f32_16x16x32_bf16 v[136:139], v[156:159], a[108:111], v[136:139]
ds_read_b64_tr_b16 v[190:191], v6 offset:12288
s_and_b32 s60, s60, 0x7c000
v_mfma_f32_16x16x32_bf16 v[136:139], v[152:155], a[100:103], v[136:139]
buffer_load_dwordx4 a[64:67], v3, s[88:91], s101 offen sc1
v_mfma_f32_16x16x32_bf16 v[140:143], v[160:163], a[100:103], v[140:143]
ds_read_b64_tr_b16 v[192:193], v7 offset:0
ds_read_b64_tr_b16 v[194:195], v7 offset:4096
v_mfma_f32_16x16x32_bf16 v[140:143], v[164:167], a[108:111], v[140:143]
ds_read_b64_tr_b16 v[196:197], v7 offset:8192
s_lshl_b32 s61, s60, 3
v_mfma_f32_16x16x32_bf16 v[124:127], v[164:167], a[104:107], v[124:127]
ds_read_b64_tr_b16 v[198:199], v7 offset:12288
s_waitcnt lgkmcnt(8)
v_mfma_f32_16x16x32_bf16 v[124:127], v[160:163], a[96:99], v[124:127]
buffer_load_dwordx4 a[68:71], v3, s[88:91], s101 offen offset:1024 sc1
v_mfma_f32_16x16x32_bf16 v[128:131], v[168:171], a[96:99], v[128:131]
ds_read_b64_tr_b16 v[200:201], v6 offset:256
ds_read_b64_tr_b16 v[202:203], v6 offset:4352
v_mfma_f32_16x16x32_bf16 v[128:131], v[172:175], a[104:107], v[128:131]
ds_read_b64_tr_b16 v[204:205], v6 offset:8448
s_add_u32 s62, s61, s12
v_mfma_f32_16x16x32_bf16 v[144:147], v[172:175], a[108:111], v[144:147]
ds_read_b64_tr_b16 v[206:207], v6 offset:12544
s_add_u32 s101, s101, 0x2000
v_mfma_f32_16x16x32_bf16 v[144:147], v[168:171], a[100:103], v[144:147]
buffer_load_dwordx4 a[72:75], v3, s[88:91], s101 offen sc1
v_mfma_f32_16x16x32_bf16 v[148:151], v[176:179], a[100:103], v[148:151]
ds_read_b64_tr_b16 v[208:209], v7 offset:256
ds_read_b64_tr_b16 v[210:211], v7 offset:4352
v_mfma_f32_16x16x32_bf16 v[148:151], v[180:183], a[108:111], v[148:151]
ds_read_b64_tr_b16 v[212:213], v7 offset:8448
v_mfma_f32_16x16x32_bf16 v[132:135], v[180:183], a[104:107], v[132:135]
ds_read_b64_tr_b16 v[214:215], v7 offset:12544
s_waitcnt vmcnt(7) lgkmcnt(8)
v_mfma_f32_16x16x32_bf16 v[132:135], v[176:179], a[96:99], v[132:135]
buffer_load_dwordx4 a[76:79], v3, s[88:91], s101 offen offset:1024 sc1
s_barrier
v_cmp_ne_u32 vcc, 1, v14
s_cmp_lg_u32 s15, 0
s_cbranch_scc0 L_p4_exit
s_cbranch_vccz L_p4_loop0
s_mov_b32 s92, 200000
L_spin_d0:
v_cmp_ne_u32 vcc, 1, v14
s_nop 4
s_cbranch_vccz L_spun_d0
s_sub_u32 s92, s92, 1
s_cbranch_scc1 L_spun_d0
s_sleep 6
buffer_load_dword v14, v20, s[88:91], s24 offen sc1
s_waitcnt vmcnt(0)
s_branch L_spin_d0
L_spun_d0:
s_branch L_p4_loop0
L_p4_loop1:
v_mfma_f32_16x16x32_bf16 v[88:91], v[184:187], a[96:99], v[88:91]
ds_read_b64_tr_b16 v[152:153], v6 offset:16896
ds_read_b64_tr_b16 v[154:155], v6 offset:20992
v_mfma_f32_16x16x32_bf16 v[88:91], v[188:191], a[104:107], v[88:91]
ds_read_b64_tr_b16 v[156:157], v6 offset:25088
s_add_u32 s101, s63, s60
v_mfma_f32_16x16x32_bf16 v[104:107], v[188:191], a[108:111], v[104:107]
ds_read_b64_tr_b16 v[158:159], v6 offset:29184
s_add_u32 m0, s17, 0x14000
v_mfma_f32_16x16x32_bf16 v[104:107], v[184:187], a[100:103], v[104:107]
buffer_load_dwordx4 v12, s[64:67], s61 offen lds
v_mfma_f32_16x16x32_bf16 v[108:111], v[192:195], a[100:103], v[108:111]
ds_read_b64_tr_b16 v[160:161], v7 offset:16896
ds_read_b64_tr_b16 v[162:163], v7 offset:20992
v_mfma_f32_16x16x32_bf16 v[108:111], v[196:199], a[108:111], v[108:111]
ds_read_b64_tr_b16 v[164:165], v7 offset:25088
v_mfma_f32_16x16x32_bf16 v[92:95], v[196:199], a[104:107], v[92:95]
ds_read_b64_tr_b16 v[166:167], v7 offset:29184
s_waitcnt lgkmcnt(8)
v_mfma_f32_16x16x32_bf16 v[92:95], v[192:195], a[96:99], v[92:95]
buffer_load_dwordx4 v13, s[64:67], s61 offen offset:1024 lds
v_mfma_f32_16x16x32_bf16 v[96:99], v[200:203], a[96:99], v[96:99]
ds_read_b64_tr_b16 v[168:169], v6 offset:17152
ds_read_b64_tr_b16 v[170:171], v6 offset:21248
v_mfma_f32_16x16x32_bf16 v[96:99], v[204:207], a[104:107], v[96:99]
ds_read_b64_tr_b16 v[172:173], v6 offset:25344
v_mfma_f32_16x16x32_bf16 v[112:115], v[204:207], a[108:111], v[112:115]
ds_read_b64_tr_b16 v[174:175], v6 offset:29440
v_mfma_f32_16x16x32_bf16 v[112:115], v[200:203], a[100:103], v[112:115]
buffer_load_dwordx4 v12, s[64:67], s62 offen offset:2048 lds
v_mfma_f32_16x16x32_bf16 v[116:119], v[208:211], a[100:103], v[116:119]
ds_read_b64_tr_b16 v[176:177], v7 offset:17152
ds_read_b64_tr_b16 v[178:179], v7 offset:21248
v_mfma_f32_16x16x32_bf16 v[116:119], v[212:215], a[108:111], v[116:119]
ds_read_b64_tr_b16 v[180:181], v7 offset:25344
s_waitcnt lgkmcnt(7)
v_mfma_f32_16x16x32_bf16 v[100:103], v[212:215], a[104:107], v[100:103]
ds_read_b64_tr_b16 v[182:183], v7 offset:29440
v_mfma_f32_16x16x32_bf16 v[100:103], v[208:211], a[96:99], v[100:103]
buffer_load_dwordx4 v13, s[64:67], s62 offen offset:3072 lds
v_mfma_f32_16x16x32_bf16 v[120:123], v[152:155], a[112:115], v[120:123]
ds_read_b64_tr_b16 v[184:185], v6 offset:16384
ds_read_b64_tr_b16 v[186:187], v6 offset:20480
v_mfma_f32_16x16x32_bf16 v[120:123], v[156:159], a[120:123], v[120:123]
ds_read_b64_tr_b16 v[188:189], v6 offset:24576
s_add_u32 s60, s60, s56
v_mfma_f32_16x16x32_bf16 v[136:139], v[156:159], a[124:127], v[136:139]
ds_read_b64_tr_b16 v[190:191], v6 offset:28672
s_and_b32 s60, s60, 0x7c000
v_mfma_f32_16x16x32_bf16 v[136:139], v[152:155], a[116:119], v[136:139]
buffer_load_dwordx4 a[80:83], v3, s[88:91], s101 offen sc1
v_mfma_f32_16x16x32_bf16 v[140:143], v[160:163], a[116:119], v[140:143]
ds_read_b64_tr_b16 v[192:193], v7 offset:16384
ds_read_b64_tr_b16 v[194:195], v7 offset:20480
v_mfma_f32_16x16x32_bf16 v[140:143], v[164:167], a[124:127], v[140:143]
ds_read_b64_tr_b16 v[196:197], v7 offset:24576
s_lshl_b32 s61, s60, 3
v_mfma_f32_16x16x32_bf16 v[124:127], v[164:167], a[120:123], v[124:127]
ds_read_b64_tr_b16 v[198:199], v7 offset:28672
s_waitcnt lgkmcnt(8)
v_mfma_f32_16x16x32_bf16 v[124:127], v[160:163], a[112:115], v[124:127]
buffer_load_dwordx4 a[84:87], v3, s[88:91], s101 offen offset:1024 sc1
v_mfma_f32_16x16x32_bf16 v[128:131], v[168:171], a[112:115], v[128:131]
ds_read_b64_tr_b16 v[200:201], v6 offset:16640
ds_read_b64_tr_b16 v[202:203], v6 offset:20736
v_mfma_f32_16x16x32_bf16 v[128:131], v[172:175], a[120:123], v[128:131]
ds_read_b64_tr_b16 v[204:205], v6 offset:24832
s_add_u32 s62, s61, s12
v_mfma_f32_16x16x32_bf16 v[144:147], v[172:175], a[124:127], v[144:147]
ds_read_b64_tr_b16 v[206:207], v6 offset:28928
s_add_u32 s101, s101, 0x2000
v_mfma_f32_16x16x32_bf16 v[144:147], v[168:171], a[116:119], v[144:147]
buffer_load_dwordx4 a[88:91], v3, s[88:91], s101 offen sc1
v_mfma_f32_16x16x32_bf16 v[148:151], v[176:179], a[116:119], v[148:151]
ds_read_b64_tr_b16 v[208:209], v7 offset:16640
ds_read_b64_tr_b16 v[210:211], v7 offset:20736
s_waitcnt vmcnt(7) lgkmcnt(6)
v_mfma_f32_16x16x32_bf16 v[148:151], v[180:183], a[124:127], v[148:151]
ds_read_b64_tr_b16 v[212:213], v7 offset:24832
s_barrier
v_mfma_f32_16x16x32_bf16 v[132:135], v[180:183], a[120:123], v[132:135]
ds_read_b64_tr_b16 v[214:215], v7 offset:28928
v_mfma_f32_16x16x32_bf16 v[132:135], v[176:179], a[112:115], v[132:135]
buffer_load_dwordx4 a[92:95], v3, s[88:91], s101 offen offset:1024 sc1
v_mfma_f32_16x16x32_bf16 v[88:91], v[184:187], a[112:115], v[88:91]
ds_read_b64_tr_b16 v[152:153], v4 offset:512
ds_read_b64_tr_b16 v[154:155], v4 offset:4608
v_mfma_f32_16x16x32_bf16 v[88:91], v[188:191], a[120:123], v[88:91]
ds_read_b64_tr_b16 v[156:157], v4 offset:8704
s_add_u32 s101, s63, s60
v_mfma_f32_16x16x32_bf16 v[104:107], v[188:191], a[124:127], v[104:107]
ds_read_b64_tr_b16 v[158:159], v4 offset:12800
s_add_u32 m0, s16, 0x0
v_mfma_f32_16x16x32_bf16 v[104:107], v[184:187], a[116:119], v[104:107]
buffer_load_dwordx4 v12, s[64:67], s61 offen lds
v_mfma_f32_16x16x32_bf16 v[108:111], v[192:195], a[116:119], v[108:111]
ds_read_b64_tr_b16 v[160:161], v5 offset:512
ds_read_b64_tr_b16 v[162:163], v5 offset:4608
v_mfma_f32_16x16x32_bf16 v[108:111], v[196:199], a[124:127], v[108:111]
ds_read_b64_tr_b16 v[164:165], v5 offset:8704
v_mfma_f32_16x16x32_bf16 v[92:95], v[196:199], a[120:123], v[92:95]
ds_read_b64_tr_b16 v[166:167], v5 offset:12800
s_waitcnt lgkmcnt(8)
v_mfma_f32_16x16x32_bf16 v[92:95], v[192:195], a[112:115], v[92:95]
buffer_load_dwordx4 v13, s[64:67], s61 offen offset:1024 lds
v_mfma_f32_16x16x32_bf16 v[96:99], v[200:203], a[112:115], v[96:99]
ds_read_b64_tr_b16 v[168:169], v4 offset:768
ds_read_b64_tr_b16 v[170:171], v4 offset:4864
v_mfma_f32_16x16x32_bf16 v[96:99], v[204:207], a[120:123], v[96:99]
ds_read_b64_tr_b16 v[172:173], v4 offset:8960
v_mfma_f32_16x16x32_bf16 v[112:115], v[204:207], a[124:127], v[112:115]
ds_read_b64_tr_b16 v[174:175], v4 offset:13056
v_mfma_f32_16x16x32_bf16 v[112:115], v[200:203], a[116:119], v[112:115]
buffer_load_dwordx4 v12, s[64:67], s62 offen offset:2048 lds
v_mfma_f32_16x16x32_bf16 v[116:119], v[208:211], a[116:119], v[116:119]
ds_read_b64_tr_b16 v[176:177], v5 offset:768
ds_read_b64_tr_b16 v[178:179], v5 offset:4864
v_mfma_f32_16x16x32_bf16 v[116:119], v[212:215], a[124:127], v[116:119]
ds_read_b64_tr_b16 v[180:181], v5 offset:8960
s_waitcnt lgkmcnt(7)
v_mfma_f32_16x16x32_bf16 v[100:103], v[212:215], a[120:123], v[100:103]
ds_read_b64_tr_b16 v[182:183], v5 offset:13056
v_mfma_f32_16x16x32_bf16 v[100:103], v[208:211], a[112:115], v[100:103]
buffer_load_dwordx4 v13, s[64:67], s62 offen offset:3072 lds
v_mfma_f32_16x16x32_bf16 v[120:123], v[152:155], a[64:67], v[120:123]
ds_read_b64_tr_b16 v[184:185], v4 offset:0
ds_read_b64_tr_b16 v[186:187], v4 offset:4096
v_mfma_f32_16x16x32_bf16 v[120:123], v[156:159], a[72:75], v[120:123]
ds_read_b64_tr_b16 v[188:189], v4 offset:8192
s_add_u32 s60, s60, s57
v_mfma_f32_16x16x32_bf16 v[136:139], v[156:159], a[76:79], v[136:139]
ds_read_b64_tr_b16 v[190:191], v4 offset:12288
s_and_b32 s60, s60, 0x7c000
v_mfma_f32_16x16x32_bf16 v[136:139], v[152:155], a[68:71], v[136:139]
buffer_load_dwordx4 a[96:99], v3, s[88:91], s101 offen sc1
v_mfma_f32_16x16x32_bf16 v[140:143], v[160:163], a[68:71], v[140:143]
ds_read_b64_tr_b16 v[192:193], v5 offset:0
ds_read_b64_tr_b16 v[194:195], v5 offset:4096
v_mfma_f32_16x16x32_bf16 v[140:143], v[164:167], a[76:79], v[140:143]
ds_read_b64_tr_b16 v[196:197], v5 offset:8192
s_lshl_b32 s61, s60, 3
v_mfma_f32_16x16x32_bf16 v[124:127], v[164:167], a[72:75], v[124:127]
ds_read_b64_tr_b16 v[198:199], v5 offset:12288
s_waitcnt lgkmcnt(8)
v_mfma_f32_16x16x32_bf16 v[124:127], v[160:163], a[64:67], v[124:127]
buffer_load_dwordx4 a[100:103], v3, s[88:91], s101 offen offset:1024 sc1
v_mfma_f32_16x16x32_bf16 v[128:131], v[168:171], a[64:67], v[128:131]
ds_read_b64_tr_b16 v[200:201], v4 offset:256
ds_read_b64_tr_b16 v[202:203], v4 offset:4352
v_mfma_f32_16x16x32_bf16 v[128:131], v[172:175], a[72:75], v[128:131]
ds_read_b64_tr_b16 v[204:205], v4 offset:8448
s_add_u32 s62, s61, s12
v_mfma_f32_16x16x32_bf16 v[144:147], v[172:175], a[76:79], v[144:147]
ds_read_b64_tr_b16 v[206:207], v4 offset:12544
s_add_u32 s101, s101, 0x2000
v_mfma_f32_16x16x32_bf16 v[144:147], v[168:171], a[68:71], v[144:147]
buffer_load_dwordx4 a[104:107], v3, s[88:91], s101 offen sc1
v_mfma_f32_16x16x32_bf16 v[148:151], v[176:179], a[68:71], v[148:151]
ds_read_b64_tr_b16 v[208:209], v5 offset:256
ds_read_b64_tr_b16 v[210:211], v5 offset:4352
s_waitcnt vmcnt(7) lgkmcnt(6)
v_mfma_f32_16x16x32_bf16 v[148:151], v[180:183], a[76:79], v[148:151]
ds_read_b64_tr_b16 v[212:213], v5 offset:8448
s_barrier
v_mfma_f32_16x16x32_bf16 v[132:135], v[180:183], a[72:75], v[132:135]
ds_read_b64_tr_b16 v[214:215], v5 offset:12544
v_mfma_f32_16x16x32_bf16 v[132:135], v[176:179], a[64:67], v[132:135]
buffer_load_dwordx4 a[108:111], v3, s[88:91], s101 offen offset:1024 sc1
v_mfma_f32_16x16x32_bf16 v[88:91], v[184:187], a[64:67], v[88:91]
ds_read_b64_tr_b16 v[152:153], v4 offset:16896
ds_read_b64_tr_b16 v[154:155], v4 offset:20992
v_mfma_f32_16x16x32_bf16 v[88:91], v[188:191], a[72:75], v[88:91]
ds_read_b64_tr_b16 v[156:157], v4 offset:25088
s_add_u32 s101, s63, s60
v_mfma_f32_16x16x32_bf16 v[104:107], v[188:191], a[76:79], v[104:107]
ds_read_b64_tr_b16 v[158:159], v4 offset:29184
s_add_u32 m0, s16, 0x4000
v_mfma_f32_16x16x32_bf16 v[104:107], v[184:187], a[68:71], v[104:107]
buffer_load_dwordx4 v12, s[64:67], s61 offen lds
v_mfma_f32_16x16x32_bf16 v[108:111], v[192:195], a[68:71], v[108:111]
ds_read_b64_tr_b16 v[160:161], v5 offset:16896
ds_read_b64_tr_b16 v[162:163], v5 offset:20992
v_mfma_f32_16x16x32_bf16 v[108:111], v[196:199], a[76:79], v[108:111]
ds_read_b64_tr_b16 v[164:165], v5 offset:25088
v_mfma_f32_16x16x32_bf16 v[92:95], v[196:199], a[72:75], v[92:95]
ds_read_b64_tr_b16 v[166:167], v5 offset:29184
s_waitcnt lgkmcnt(8)
v_mfma_f32_16x16x32_bf16 v[92:95], v[192:195], a[64:67], v[92:95]
buffer_load_dwordx4 v13, s[64:67], s61 offen offset:1024 lds
v_mfma_f32_16x16x32_bf16 v[96:99], v[200:203], a[64:67], v[96:99]
ds_read_b64_tr_b16 v[168:169], v4 offset:17152
ds_read_b64_tr_b16 v[170:171], v4 offset:21248
v_mfma_f32_16x16x32_bf16 v[96:99], v[204:207], a[72:75], v[96:99]
ds_read_b64_tr_b16 v[172:173], v4 offset:25344
v_mfma_f32_16x16x32_bf16 v[112:115], v[204:207], a[76:79], v[112:115]
ds_read_b64_tr_b16 v[174:175], v4 offset:29440
v_mfma_f32_16x16x32_bf16 v[112:115], v[200:203], a[68:71], v[112:115]
buffer_load_dwordx4 v12, s[64:67], s62 offen offset:2048 lds
v_mfma_f32_16x16x32_bf16 v[116:119], v[208:211], a[68:71], v[116:119]
ds_read_b64_tr_b16 v[176:177], v5 offset:17152
ds_read_b64_tr_b16 v[178:179], v5 offset:21248
v_mfma_f32_16x16x32_bf16 v[116:119], v[212:215], a[76:79], v[116:119]
ds_read_b64_tr_b16 v[180:181], v5 offset:25344
s_waitcnt lgkmcnt(7)
v_mfma_f32_16x16x32_bf16 v[100:103], v[212:215], a[72:75], v[100:103]
ds_read_b64_tr_b16 v[182:183], v5 offset:29440
v_mfma_f32_16x16x32_bf16 v[100:103], v[208:211], a[64:67], v[100:103]
buffer_load_dwordx4 v13, s[64:67], s62 offen offset:3072 lds
v_mfma_f32_16x16x32_bf16 v[120:123], v[152:155], a[80:83], v[120:123]
ds_read_b64_tr_b16 v[184:185], v4 offset:16384
ds_read_b64_tr_b16 v[186:187], v4 offset:20480
v_mfma_f32_16x16x32_bf16 v[120:123], v[156:159], a[88:91], v[120:123]
ds_read_b64_tr_b16 v[188:189], v4 offset:24576
s_add_u32 s60, s60, s58
v_mfma_f32_16x16x32_bf16 v[136:139], v[156:159], a[92:95], v[136:139]
ds_read_b64_tr_b16 v[190:191], v4 offset:28672
s_and_b32 s60, s60, 0x7c000
v_mfma_f32_16x16x32_bf16 v[136:139], v[152:155], a[84:87], v[136:139]
buffer_load_dwordx4 a[112:115], v3, s[88:91], s101 offen sc1
v_mfma_f32_16x16x32_bf16 v[140:143], v[160:163], a[84:87], v[140:143]
ds_read_b64_tr_b16 v[192:193], v5 offset:16384
ds_read_b64_tr_b16 v[194:195], v5 offset:20480
v_mfma_f32_16x16x32_bf16 v[140:143], v[164:167], a[92:95], v[140:143]
ds_read_b64_tr_b16 v[196:197], v5 offset:24576
s_lshl_b32 s61, s60, 3
v_mfma_f32_16x16x32_bf16 v[124:127], v[164:167], a[88:91], v[124:127]
ds_read_b64_tr_b16 v[198:199], v5 offset:28672
s_waitcnt lgkmcnt(8)
v_mfma_f32_16x16x32_bf16 v[124:127], v[160:163], a[80:83], v[124:127]
buffer_load_dwordx4 a[116:119], v3, s[88:91], s101 offen offset:1024 sc1
v_mfma_f32_16x16x32_bf16 v[128:131], v[168:171], a[80:83], v[128:131]
ds_read_b64_tr_b16 v[200:201], v4 offset:16640
ds_read_b64_tr_b16 v[202:203], v4 offset:20736
v_mfma_f32_16x16x32_bf16 v[128:131], v[172:175], a[88:91], v[128:131]
ds_read_b64_tr_b16 v[204:205], v4 offset:24832
s_add_u32 s62, s61, s12
v_mfma_f32_16x16x32_bf16 v[144:147], v[172:175], a[92:95], v[144:147]
ds_read_b64_tr_b16 v[206:207], v4 offset:28928
s_add_u32 s101, s101, 0x2000
v_mfma_f32_16x16x32_bf16 v[144:147], v[168:171], a[84:87], v[144:147]
buffer_load_dwordx4 a[120:123], v3, s[88:91], s101 offen sc1
v_mfma_f32_16x16x32_bf16 v[148:151], v[176:179], a[84:87], v[148:151]
ds_read_b64_tr_b16 v[208:209], v5 offset:16640
ds_read_b64_tr_b16 v[210:211], v5 offset:20736
s_waitcnt vmcnt(7) lgkmcnt(6)
v_mfma_f32_16x16x32_bf16 v[148:151], v[180:183], a[92:95], v[148:151]
ds_read_b64_tr_b16 v[212:213], v5 offset:24832
s_barrier
v_mfma_f32_16x16x32_bf16 v[132:135], v[180:183], a[88:91], v[132:135]
ds_read_b64_tr_b16 v[214:215], v5 offset:28928
v_mfma_f32_16x16x32_bf16 v[132:135], v[176:179], a[80:83], v[132:135]
buffer_load_dwordx4 a[124:127], v3, s[88:91], s101 offen offset:1024 sc1
buffer_load_dword v14, v20, s[88:91], s24 offen sc1
v_mfma_f32_16x16x32_bf16 v[88:91], v[184:187], a[80:83], v[88:91]
ds_read_b64_tr_b16 v[152:153], v6 offset:512
ds_read_b64_tr_b16 v[154:155], v6 offset:4608
v_mfma_f32_16x16x32_bf16 v[88:91], v[188:191], a[88:91], v[88:91]
ds_read_b64_tr_b16 v[156:157], v6 offset:8704
s_add_u32 s101, s63, s60
v_mfma_f32_16x16x32_bf16 v[104:107], v[188:191], a[92:95], v[104:107]
ds_read_b64_tr_b16 v[158:159], v6 offset:12800
s_add_u32 m0, s17, 0x10000
v_mfma_f32_16x16x32_bf16 v[104:107], v[184:187], a[84:87], v[104:107]
buffer_load_dwordx4 v12, s[64:67], s61 offen lds
v_mfma_f32_16x16x32_bf16 v[108:111], v[192:195], a[84:87], v[108:111]
ds_read_b64_tr_b16 v[160:161], v7 offset:512
ds_read_b64_tr_b16 v[162:163], v7 offset:4608
v_mfma_f32_16x16x32_bf16 v[108:111], v[196:199], a[92:95], v[108:111]
ds_read_b64_tr_b16 v[164:165], v7 offset:8704
s_sub_u32 s15, s15, 1
v_mfma_f32_16x16x32_bf16 v[92:95], v[196:199], a[88:91], v[92:95]
ds_read_b64_tr_b16 v[166:167], v7 offset:12800
s_waitcnt lgkmcnt(8)
v_mfma_f32_16x16x32_bf16 v[92:95], v[192:195], a[80:83], v[92:95]
buffer_load_dwordx4 v13, s[64:67], s61 offen offset:1024 lds
v_mfma_f32_16x16x32_bf16 v[96:99], v[200:203], a[80:83], v[96:99]
ds_read_b64_tr_b16 v[168:169], v6 offset:768
ds_read_b64_tr_b16 v[170:171], v6 offset:4864
v_mfma_f32_16x16x32_bf16 v[96:99], v[204:207], a[88:91], v[96:99]
ds_read_b64_tr_b16 v[172:173], v6 offset:8960
v_mfma_f32_16x16x32_bf16 v[112:115], v[204:207], a[92:95], v[112:115]
ds_read_b64_tr_b16 v[174:175], v6 offset:13056
v_mfma_f32_16x16x32_bf16 v[112:115], v[200:203], a[84:87], v[112:115]
buffer_load_dwordx4 v12, s[64:67], s62 offen offset:2048 lds
v_mfma_f32_16x16x32_bf16 v[116:119], v[208:211], a[84:87], v[116:119]
ds_read_b64_tr_b16 v[176:177], v7 offset:768
ds_read_b64_tr_b16 v[178:179], v7 offset:4864
v_mfma_f32_16x16x32_bf16 v[116:119], v[212:215], a[92:95], v[116:119]
ds_read_b64_tr_b16 v[180:181], v7 offset:8960
s_waitcnt lgkmcnt(7)
v_mfma_f32_16x16x32_bf16 v[100:103], v[212:215], a[88:91], v[100:103]
ds_read_b64_tr_b16 v[182:183], v7 offset:13056
v_mfma_f32_16x16x32_bf16 v[100:103], v[208:211], a[80:83], v[100:103]
buffer_load_dwordx4 v13, s[64:67], s62 offen offset:3072 lds
v_mfma_f32_16x16x32_bf16 v[120:123], v[152:155], a[96:99], v[120:123]
ds_read_b64_tr_b16 v[184:185], v6 offset:0
ds_read_b64_tr_b16 v[186:187], v6 offset:4096
v_mfma_f32_16x16x32_bf16 v[120:123], v[156:159], a[104:107], v[120:123]
ds_read_b64_tr_b16 v[188:189], v6 offset:8192
s_add_u32 s60, s60, s59
v_mfma_f32_16x16x32_bf16 v[136:139], v[156:159], a[108:111], v[136:139]
ds_read_b64_tr_b16 v[190:191], v6 offset:12288
s_and_b32 s60, s60, 0x7c000
v_mfma_f32_16x16x32_bf16 v[136:139], v[152:155], a[100:103], v[136:139]
buffer_load_dwordx4 a[64:67], v3, s[88:91], s101 offen sc1
v_mfma_f32_16x16x32_bf16 v[140:143], v[160:163], a[100:103], v[140:143]
ds_read_b64_tr_b16 v[192:193], v7 offset:0
ds_read_b64_tr_b16 v[194:195], v7 offset:4096
v_mfma_f32_16x16x32_bf16 v[140:143], v[164:167], a[108:111], v[140:143]
ds_read_b64_tr_b16 v[196:197], v7 offset:8192
s_lshl_b32 s61, s60, 3
v_mfma_f32_16x16x32_bf16 v[124:127], v[164:167], a[104:107], v[124:127]
ds_read_b64_tr_b16 v[198:199], v7 offset:12288
s_waitcnt lgkmcnt(8)
v_mfma_f32_16x16x32_bf16 v[124:127], v[160:163], a[96:99], v[124:127]
buffer_load_dwordx4 a[68:71], v3, s[88:91], s101 offen offset:1024 sc1
v_mfma_f32_16x16x32_bf16 v[128:131], v[168:171], a[96:99], v[128:131]
ds_read_b64_tr_b16 v[200:201], v6 offset:256
ds_read_b64_tr_b16 v[202:203], v6 offset:4352
v_mfma_f32_16x16x32_bf16 v[128:131], v[172:175], a[104:107], v[128:131]
ds_read_b64_tr_b16 v[204:205], v6 offset:8448
s_add_u32 s62, s61, s12
v_mfma_f32_16x16x32_bf16 v[144:147], v[172:175], a[108:111], v[144:147]
ds_read_b64_tr_b16 v[206:207], v6 offset:12544
s_add_u32 s101, s101, 0x2000
v_mfma_f32_16x16x32_bf16 v[144:147], v[168:171], a[100:103], v[144:147]
buffer_load_dwordx4 a[72:75], v3, s[88:91], s101 offen sc1
v_mfma_f32_16x16x32_bf16 v[148:151], v[176:179], a[100:103], v[148:151]
ds_read_b64_tr_b16 v[208:209], v7 offset:256
ds_read_b64_tr_b16 v[210:211], v7 offset:4352
s_waitcnt vmcnt(7) lgkmcnt(6)
v_mfma_f32_16x16x32_bf16 v[148:151], v[180:183], a[108:111], v[148:151]
ds_read_b64_tr_b16 v[212:213], v7 offset:8448
s_barrier
v_mfma_f32_16x16x32_bf16 v[132:135], v[180:183], a[104:107], v[132:135]
ds_read_b64_tr_b16 v[214:215], v7 offset:12544
v_mfma_f32_16x16x32_bf16 v[132:135], v[176:179], a[96:99], v[132:135]
buffer_load_dwordx4 a[76:79], v3, s[88:91], s101 offen offset:1024 sc1
v_cmp_ne_u32 vcc, 1, v14
s_cmp_lg_u32 s15, 0
s_cbranch_scc0 L_p4_exit
s_cbranch_vccz L_p4_loop1
s_mov_b32 s92, 200000
L_spin_d1:
v_cmp_ne_u32 vcc, 1, v14
s_nop 4
s_cbranch_vccz L_spun_d1
s_sub_u32 s92, s92, 1
s_cbranch_scc1 L_spun_d1
s_sleep 6
buffer_load_dword v14, v20, s[88:91], s24 offen sc1
s_waitcnt vmcnt(0)
s_branch L_spin_d1
L_spun_d1:
s_branch L_p4_loop1
L_p4_exit:
s_add_u32 s101, s63, s60
v_mfma_f32_16x16x32_bf16 v[88:91], v[184:187], a[96:99], v[88:91]
ds_read_b64_tr_b16 v[152:153], v6 offset:16896
ds_read_b64_tr_b16 v[154:155], v6 offset:20992
s_add_u32 m0, s17, 0x14000
v_mfma_f32_16x16x32_bf16 v[88:91], v[188:191], a[104:107], v[88:91]
buffer_load_dwordx4 v12, s[64:67], s61 offen lds
v_mfma_f32_16x16x32_bf16 v[104:107], v[188:191], a[108:111], v[104:107]
ds_read_b64_tr_b16 v[156:157], v6 offset:25088
ds_read_b64_tr_b16 v[158:159], v6 offset:29184
v_mfma_f32_16x16x32_bf16 v[104:107], v[184:187], a[100:103], v[104:107]
buffer_load_dwordx4 v13, s[64:67], s61 offen offset:1024 lds
v_mfma_f32_16x16x32_bf16 v[108:111], v[192:195], a[100:103], v[108:111]
ds_read_b64_tr_b16 v[160:161], v7 offset:16896
ds_read_b64_tr_b16 v[162:163], v7 offset:20992
v_mfma_f32_16x16x32_bf16 v[108:111], v[196:199], a[108:111], v[108:111]
buffer_load_dwordx4 v12, s[64:67], s62 offen offset:2048 lds
v_mfma_f32_16x16x32_bf16 v[92:95], v[196:199], a[104:107], v[92:95]
ds_read_b64_tr_b16 v[164:165], v7 offset:25088
ds_read_b64_tr_b16 v[166:167], v7 offset:29184
s_waitcnt lgkmcnt(8)
v_mfma_f32_16x16x32_bf16 v[92:95], v[192:195], a[96:99], v[92:95]
buffer_load_dwordx4 v13, s[64:67], s62 offen offset:3072 lds
v_mfma_f32_16x16x32_bf16 v[96:99], v[200:203], a[96:99], v[96:99]
ds_read_b64_tr_b16 v[168:169], v6 offset:17152
ds_read_b64_tr_b16 v[170:171], v6 offset:21248
v_mfma_f32_16x16x32_bf16 v[96:99], v[204:207], a[104:107], v[96:99]
buffer_load_dwordx4 a[80:83], v3, s[88:91], s101 offen sc1
v_mfma_f32_16x16x32_bf16 v[112:115], v[204:207], a[108:111], v[112:115]
ds_read_b64_tr_b16 v[172:173], v6 offset:25344
ds_read_b64_tr_b16 v[174:175], v6 offset:29440
v_mfma_f32_16x16x32_bf16 v[112:115], v[200:203], a[100:103], v[112:115]
buffer_load_dwordx4 a[84:87], v3, s[88:91], s101 offen offset:1024 sc1
v_mfma_f32_16x16x32_bf16 v[116:119], v[208:211], a[100:103], v[116:119]
ds_read_b64_tr_b16 v[176:177], v7 offset:17152
ds_read_b64_tr_b16 v[178:179], v7 offset:21248
s_add_u32 s101, s101, 0x2000
v_mfma_f32_16x16x32_bf16 v[116:119], v[212:215], a[108:111], v[116:119]
buffer_load_dwordx4 a[88:91], v3, s[88:91], s101 offen sc1
s_waitcnt vmcnt(7) lgkmcnt(6)
v_mfma_f32_16x16x32_bf16 v[100:103], v[212:215], a[104:107], v[100:103]
ds_read_b64_tr_b16 v[180:181], v7 offset:25344
ds_read_b64_tr_b16 v[182:183], v7 offset:29440
s_barrier
v_mfma_f32_16x16x32_bf16 v[100:103], v[208:211], a[96:99], v[100:103]
buffer_load_dwordx4 a[92:95], v3, s[88:91], s101 offen offset:1024 sc1
v_mfma_f32_16x16x32_bf16 v[120:123], v[152:155], a[112:115], v[120:123]
ds_read_b64_tr_b16 v[184:185], v4 offset:512
v_sub_f32 v10, 1.0, v8
v_mfma_f32_16x16x32_bf16 v[120:123], v[156:159], a[120:123], v[120:123]
ds_read_b64_tr_b16 v[186:187], v4 offset:4608
v_sub_f32 v11, 1.0, v9
v_mfma_f32_16x16x32_bf16 v[136:139], v[156:159], a[124:127], v[136:139]
ds_read_b64_tr_b16 v[188:189], v4 offset:8704
v_mul_f32 v56, v10, v56
v_mfma_f32_16x16x32_bf16 v[136:139], v[152:155], a[116:119], v[136:139]
ds_read_b64_tr_b16 v[190:191], v4 offset:12800
v_mul_f32 v57, v10, v57
v_mfma_f32_16x16x32_bf16 v[140:143], v[160:163], a[116:119], v[140:143]
ds_read_b64_tr_b16 v[192:193], v5 offset:512
v_mul_f32 v58, v10, v58
v_mfma_f32_16x16x32_bf16 v[140:143], v[164:167], a[124:127], v[140:143]
ds_read_b64_tr_b16 v[194:195], v5 offset:4608
v_mul_f32 v59, v10, v59
v_mfma_f32_16x16x32_bf16 v[124:127], v[164:167], a[120:123], v[124:127]
ds_read_b64_tr_b16 v[196:197], v5 offset:8704
s_waitcnt lgkmcnt(7)
v_mfma_f32_16x16x32_bf16 v[124:127], v[160:163], a[112:115], v[124:127]
ds_read_b64_tr_b16 v[198:199], v5 offset:12800
v_mul_f32 v60, v10, v60
v_mfma_f32_16x16x32_bf16 v[128:131], v[168:171], a[112:115], v[128:131]
ds_read_b64_tr_b16 v[200:201], v4 offset:768
v_mul_f32 v61, v10, v61
v_mfma_f32_16x16x32_bf16 v[128:131], v[172:175], a[120:123], v[128:131]
ds_read_b64_tr_b16 v[202:203], v4 offset:4864
v_mul_f32 v62, v10, v62
v_mfma_f32_16x16x32_bf16 v[144:147], v[172:175], a[124:127], v[144:147]
ds_read_b64_tr_b16 v[204:205], v4 offset:8960
v_mul_f32 v63, v10, v63
v_mfma_f32_16x16x32_bf16 v[144:147], v[168:171], a[116:119], v[144:147]
ds_read_b64_tr_b16 v[206:207], v4 offset:13056
v_mul_f32 v64, v10, v64
v_mfma_f32_16x16x32_bf16 v[148:151], v[176:179], a[116:119], v[148:151]
ds_read_b64_tr_b16 v[208:209], v5 offset:768
v_mul_f32 v65, v10, v65
v_mfma_f32_16x16x32_bf16 v[148:151], v[180:183], a[124:127], v[148:151]
ds_read_b64_tr_b16 v[210:211], v5 offset:4864
s_waitcnt vmcnt(0) lgkmcnt(6)
v_mfma_f32_16x16x32_bf16 v[132:135], v[180:183], a[120:123], v[132:135]
ds_read_b64_tr_b16 v[212:213], v5 offset:8960
s_barrier
v_mfma_f32_16x16x32_bf16 v[132:135], v[176:179], a[112:115], v[132:135]
ds_read_b64_tr_b16 v[214:215], v5 offset:13056
v_mul_f32 v66, v10, v66
v_mul_f32 v67, v10, v67
v_mfma_f32_16x16x32_bf16 v[120:123], v[184:187], a[64:67], v[120:123]
ds_read_b64_tr_b16 v[152:153], v4 offset:16896
v_mul_f32 v68, v10, v68
v_mfma_f32_16x16x32_bf16 v[120:123], v[188:191], a[72:75], v[120:123]
ds_read_b64_tr_b16 v[154:155], v4 offset:20992
v_mul_f32 v69, v10, v69
v_mfma_f32_16x16x32_bf16 v[136:139], v[188:191], a[76:79], v[136:139]
ds_read_b64_tr_b16 v[156:157], v4 offset:25088
v_mul_f32 v70, v10, v70
v_mfma_f32_16x16x32_bf16 v[136:139], v[184:187], a[68:71], v[136:139]
ds_read_b64_tr_b16 v[158:159], v4 offset:29184
v_mul_f32 v71, v10, v71
v_mfma_f32_16x16x32_bf16 v[140:143], v[192:195], a[68:71], v[140:143]
ds_read_b64_tr_b16 v[160:161], v5 offset:16896
v_mul_f32 v72, v11, v72
v_mfma_f32_16x16x32_bf16 v[140:143], v[196:199], a[76:79], v[140:143]
ds_read_b64_tr_b16 v[162:163], v5 offset:20992
v_mul_f32 v73, v11, v73
v_mfma_f32_16x16x32_bf16 v[124:127], v[196:199], a[72:75], v[124:127]
ds_read_b64_tr_b16 v[164:165], v5 offset:25088
s_waitcnt lgkmcnt(7)
v_mfma_f32_16x16x32_bf16 v[124:127], v[192:195], a[64:67], v[124:127]
ds_read_b64_tr_b16 v[166:167], v5 offset:29184
v_mul_f32 v74, v11, v74
v_mfma_f32_16x16x32_bf16 v[128:131], v[200:203], a[64:67], v[128:131]
ds_read_b64_tr_b16 v[168:169], v4 offset:17152
v_mul_f32 v75, v11, v75
v_mfma_f32_16x16x32_bf16 v[128:131], v[204:207], a[72:75], v[128:131]
ds_read_b64_tr_b16 v[170:171], v4 offset:21248
v_mul_f32 v76, v11, v76
v_mfma_f32_16x16x32_bf16 v[144:147], v[204:207], a[76:79], v[144:147]
ds_read_b64_tr_b16 v[172:173], v4 offset:25344
v_mul_f32 v77, v11, v77
v_mfma_f32_16x16x32_bf16 v[144:147], v[200:203], a[68:71], v[144:147]
ds_read_b64_tr_b16 v[174:175], v4 offset:29440
v_mul_f32 v78, v11, v78
v_mfma_f32_16x16x32_bf16 v[148:151], v[208:211], a[68:71], v[148:151]
ds_read_b64_tr_b16 v[176:177], v5 offset:17152
v_mul_f32 v79, v11, v79
v_mfma_f32_16x16x32_bf16 v[148:151], v[212:215], a[76:79], v[148:151]
ds_read_b64_tr_b16 v[178:179], v5 offset:21248
s_waitcnt lgkmcnt(6)
v_mfma_f32_16x16x32_bf16 v[132:135], v[212:215], a[72:75], v[132:135]
ds_read_b64_tr_b16 v[180:181], v5 offset:25344
v_mul_f32 v80, v11, v80
v_mfma_f32_16x16x32_bf16 v[132:135], v[208:211], a[64:67], v[132:135]
ds_read_b64_tr_b16 v[182:183], v5 offset:29440
v_mul_f32 v81, v11, v81
v_mfma_f32_16x16x32_bf16 v[120:123], v[152:155], a[80:83], v[120:123]
ds_read_b64_tr_b16 v[184:185], v6 offset:16384
v_mul_f32 v82, v11, v82
v_mfma_f32_16x16x32_bf16 v[120:123], v[156:159], a[88:91], v[120:123]
ds_read_b64_tr_b16 v[186:187], v6 offset:20480
v_mul_f32 v83, v11, v83
v_mfma_f32_16x16x32_bf16 v[136:139], v[156:159], a[92:95], v[136:139]
ds_read_b64_tr_b16 v[188:189], v6 offset:24576
v_mul_f32 v84, v11, v84
v_mfma_f32_16x16x32_bf16 v[136:139], v[152:155], a[84:87], v[136:139]
ds_read_b64_tr_b16 v[190:191], v6 offset:28672
v_mul_f32 v85, v11, v85
v_mfma_f32_16x16x32_bf16 v[140:143], v[160:163], a[84:87], v[140:143]
ds_read_b64_tr_b16 v[192:193], v7 offset:16384
v_mul_f32 v86, v11, v86
v_mfma_f32_16x16x32_bf16 v[140:143], v[164:167], a[92:95], v[140:143]
ds_read_b64_tr_b16 v[194:195], v7 offset:20480
v_mul_f32 v87, v11, v87
v_mfma_f32_16x16x32_bf16 v[124:127], v[164:167], a[88:91], v[124:127]
ds_read_b64_tr_b16 v[196:197], v7 offset:24576
s_waitcnt lgkmcnt(7)
v_mfma_f32_16x16x32_bf16 v[124:127], v[160:163], a[80:83], v[124:127]
ds_read_b64_tr_b16 v[198:199], v7 offset:28672
v_mul_f32 v24, v10, v24
v_mfma_f32_16x16x32_bf16 v[128:131], v[168:171], a[80:83], v[128:131]
ds_read_b64_tr_b16 v[200:201], v6 offset:16640
v_mul_f32 v25, v10, v25
v_mfma_f32_16x16x32_bf16 v[128:131], v[172:175], a[88:91], v[128:131]
ds_read_b64_tr_b16 v[202:203], v6 offset:20736
v_mul_f32 v26, v10, v26
v_mfma_f32_16x16x32_bf16 v[144:147], v[172:175], a[92:95], v[144:147]
ds_read_b64_tr_b16 v[204:205], v6 offset:24832
v_mul_f32 v27, v10, v27
v_mfma_f32_16x16x32_bf16 v[144:147], v[168:171], a[84:87], v[144:147]
ds_read_b64_tr_b16 v[206:207], v6 offset:28928
v_mul_f32 v28, v10, v28
v_mfma_f32_16x16x32_bf16 v[148:151], v[176:179], a[84:87], v[148:151]
ds_read_b64_tr_b16 v[208:209], v7 offset:16640
v_mul_f32 v29, v10, v29
v_mfma_f32_16x16x32_bf16 v[148:151], v[180:183], a[92:95], v[148:151]
ds_read_b64_tr_b16 v[210:211], v7 offset:20736
s_waitcnt lgkmcnt(6)
v_mfma_f32_16x16x32_bf16 v[132:135], v[180:183], a[88:91], v[132:135]
ds_read_b64_tr_b16 v[212:213], v7 offset:24832
v_mul_f32 v30, v10, v30
v_mfma_f32_16x16x32_bf16 v[132:135], v[176:179], a[80:83], v[132:135]
ds_read_b64_tr_b16 v[214:215], v7 offset:28928
v_mul_f32 v31, v10, v31
v_pk_fma_f32 v[56:57], v[120:121], v[8:9], v[56:57] op_sel_hi:[1,0,1]
v_pk_fma_f32 v[58:59], v[122:123], v[8:9], v[58:59] op_sel_hi:[1,0,1]
v_pk_fma_f32 v[60:61], v[124:125], v[8:9], v[60:61] op_sel_hi:[1,0,1]
v_pk_fma_f32 v[62:63], v[126:127], v[8:9], v[62:63] op_sel_hi:[1,0,1]
v_cvt_pk_bf16_f32 v56, v56, v57
v_cvt_pk_bf16_f32 v57, v58, v59
v_cvt_pk_bf16_f32 v58, v60, v61
v_cvt_pk_bf16_f32 v59, v62, v63
buffer_store_dwordx4 v[56:59], v3, s[88:91], s30 offen offset:0 sc1
v_pk_fma_f32 v[72:73], v[136:137], v[8:9], v[72:73] op_sel:[0,1,0] op_sel_hi:[1,1,1]
v_pk_fma_f32 v[74:75], v[138:139], v[8:9], v[74:75] op_sel:[0,1,0] op_sel_hi:[1,1,1]
v_pk_fma_f32 v[76:77], v[140:141], v[8:9], v[76:77] op_sel:[0,1,0] op_sel_hi:[1,1,1]
v_pk_fma_f32 v[78:79], v[142:143], v[8:9], v[78:79] op_sel:[0,1,0] op_sel_hi:[1,1,1]
v_cvt_pk_bf16_f32 v72, v72, v73
v_cvt_pk_bf16_f32 v73, v74, v75
v_cvt_pk_bf16_f32 v74, v76, v77
v_cvt_pk_bf16_f32 v75, v78, v79
buffer_store_dwordx4 v[72:75], v3, s[88:91], s30 offen offset:2048 sc1
v_pk_fma_f32 v[64:65], v[128:129], v[8:9], v[64:65] op_sel_hi:[1,0,1]
v_pk_fma_f32 v[66:67], v[130:131], v[8:9], v[66:67] op_sel_hi:[1,0,1]
v_pk_fma_f32 v[68:69], v[132:133], v[8:9], v[68:69] op_sel_hi:[1,0,1]
v_pk_fma_f32 v[70:71], v[134:135], v[8:9], v[70:71] op_sel_hi:[1,0,1]
v_cvt_pk_bf16_f32 v64, v64, v65
v_cvt_pk_bf16_f32 v65, v66, v67
v_cvt_pk_bf16_f32 v66, v68, v69
v_cvt_pk_bf16_f32 v67, v70, v71
buffer_store_dwordx4 v[64:67], v3, s[88:91], s30 offen offset:1024 sc1
v_pk_fma_f32 v[80:81], v[144:145], v[8:9], v[80:81] op_sel:[0,1,0] op_sel_hi:[1,1,1]
v_pk_fma_f32 v[82:83], v[146:147], v[8:9], v[82:83] op_sel:[0,1,0] op_sel_hi:[1,1,1]
v_pk_fma_f32 v[84:85], v[148:149], v[8:9], v[84:85] op_sel:[0,1,0] op_sel_hi:[1,1,1]
v_pk_fma_f32 v[86:87], v[150:151], v[8:9], v[86:87] op_sel:[0,1,0] op_sel_hi:[1,1,1]
v_cvt_pk_bf16_f32 v80, v80, v81
v_cvt_pk_bf16_f32 v81, v82, v83
v_cvt_pk_bf16_f32 v82, v84, v85
v_cvt_pk_bf16_f32 v83, v86, v87
buffer_store_dwordx4 v[80:83], v3, s[88:91], s30 offen offset:3072 sc1
v_mfma_f32_16x16x32_bf16 v[88:91], v[184:187], a[112:115], v[88:91]
ds_read_b64_tr_b16 v[152:153], v4 offset:0
v_mfma_f32_16x16x32_bf16 v[88:91], v[188:191], a[120:123], v[88:91]
ds_read_b64_tr_b16 v[154:155], v4 offset:4096
v_mfma_f32_16x16x32_bf16 v[104:107], v[188:191], a[124:127], v[104:107]
ds_read_b64_tr_b16 v[156:157], v4 offset:8192
v_mfma_f32_16x16x32_bf16 v[104:107], v[184:187], a[116:119], v[104:107]
ds_read_b64_tr_b16 v[158:159], v4 offset:12288
v_mfma_f32_16x16x32_bf16 v[108:111], v[192:195], a[116:119], v[108:111]
ds_read_b64_tr_b16 v[160:161], v5 offset:0
v_mfma_f32_16x16x32_bf16 v[108:111], v[196:199], a[124:127], v[108:111]
ds_read_b64_tr_b16 v[162:163], v5 offset:4096
v_mfma_f32_16x16x32_bf16 v[92:95], v[196:199], a[120:123], v[92:95]
ds_read_b64_tr_b16 v[164:165], v5 offset:8192
s_waitcnt lgkmcnt(7)
v_mfma_f32_16x16x32_bf16 v[92:95], v[192:195], a[112:115], v[92:95]
ds_read_b64_tr_b16 v[166:167], v5 offset:12288
v_mfma_f32_16x16x32_bf16 v[96:99], v[200:203], a[112:115], v[96:99]
ds_read_b64_tr_b16 v[168:169], v4 offset:256
v_mfma_f32_16x16x32_bf16 v[96:99], v[204:207], a[120:123], v[96:99]
ds_read_b64_tr_b16 v[170:171], v4 offset:4352
v_mfma_f32_16x16x32_bf16 v[112:115], v[204:207], a[124:127], v[112:115]
ds_read_b64_tr_b16 v[172:173], v4 offset:8448
v_mfma_f32_16x16x32_bf16 v[112:115], v[200:203], a[116:119], v[112:115]
ds_read_b64_tr_b16 v[174:175], v4 offset:12544
v_mfma_f32_16x16x32_bf16 v[116:119], v[208:211], a[116:119], v[116:119]
ds_read_b64_tr_b16 v[176:177], v5 offset:256
v_mfma_f32_16x16x32_bf16 v[116:119], v[212:215], a[124:127], v[116:119]
ds_read_b64_tr_b16 v[178:179], v5 offset:4352
s_waitcnt lgkmcnt(6)
v_mfma_f32_16x16x32_bf16 v[100:103], v[212:215], a[120:123], v[100:103]
ds_read_b64_tr_b16 v[180:181], v5 offset:8448
v_mfma_f32_16x16x32_bf16 v[100:103], v[208:211], a[112:115], v[100:103]
ds_read_b64_tr_b16 v[182:183], v5 offset:12544
v_mfma_f32_16x16x32_bf16 v[88:91], v[152:155], a[64:67], v[88:91]
ds_read_b64_tr_b16 v[184:185], v4 offset:16384
v_mul_f32 v32, v10, v32
v_mfma_f32_16x16x32_bf16 v[88:91], v[156:159], a[72:75], v[88:91]
ds_read_b64_tr_b16 v[186:187], v4 offset:20480
v_mul_f32 v33, v10, v33
v_mfma_f32_16x16x32_bf16 v[104:107], v[156:159], a[76:79], v[104:107]
ds_read_b64_tr_b16 v[188:189], v4 offset:24576
v_mul_f32 v34, v10, v34
v_mfma_f32_16x16x32_bf16 v[104:107], v[152:155], a[68:71], v[104:107]
ds_read_b64_tr_b16 v[190:191], v4 offset:28672
v_mul_f32 v35, v10, v35
v_mfma_f32_16x16x32_bf16 v[108:111], v[160:163], a[68:71], v[108:111]
ds_read_b64_tr_b16 v[192:193], v5 offset:16384
v_mul_f32 v36, v10, v36
v_mfma_f32_16x16x32_bf16 v[108:111], v[164:167], a[76:79], v[108:111]
ds_read_b64_tr_b16 v[194:195], v5 offset:20480
v_mul_f32 v37, v10, v37
v_mfma_f32_16x16x32_bf16 v[92:95], v[164:167], a[72:75], v[92:95]
ds_read_b64_tr_b16 v[196:197], v5 offset:24576
s_waitcnt lgkmcnt(7)
v_mfma_f32_16x16x32_bf16 v[92:95], v[160:163], a[64:67], v[92:95]
ds_read_b64_tr_b16 v[198:199], v5 offset:28672
v_mul_f32 v38, v10, v38
v_mfma_f32_16x16x32_bf16 v[96:99], v[168:171], a[64:67], v[96:99]
ds_read_b64_tr_b16 v[200:201], v4 offset:16640
v_mul_f32 v39, v10, v39
v_mfma_f32_16x16x32_bf16 v[96:99], v[172:175], a[72:75], v[96:99]
ds_read_b64_tr_b16 v[202:203], v4 offset:20736
v_mul_f32 v40, v11, v40
v_mfma_f32_16x16x32_bf16 v[112:115], v[172:175], a[76:79], v[112:115]
ds_read_b64_tr_b16 v[204:205], v4 offset:24832
v_mul_f32 v41, v11, v41
v_mfma_f32_16x16x32_bf16 v[112:115], v[168:171], a[68:71], v[112:115]
ds_read_b64_tr_b16 v[206:207], v4 offset:28928
v_mul_f32 v42, v11, v42
v_mfma_f32_16x16x32_bf16 v[116:119], v[176:179], a[68:71], v[116:119]
ds_read_b64_tr_b16 v[208:209], v5 offset:16640
v_mul_f32 v43, v11, v43
v_mfma_f32_16x16x32_bf16 v[116:119], v[180:183], a[76:79], v[116:119]
ds_read_b64_tr_b16 v[210:211], v5 offset:20736
s_waitcnt lgkmcnt(6)
v_mfma_f32_16x16x32_bf16 v[100:103], v[180:183], a[72:75], v[100:103]
ds_read_b64_tr_b16 v[212:213], v5 offset:24832
v_mul_f32 v44, v11, v44
v_mfma_f32_16x16x32_bf16 v[100:103], v[176:179], a[64:67], v[100:103]
ds_read_b64_tr_b16 v[214:215], v5 offset:28928
v_mul_f32 v45, v11, v45
v_mfma_f32_16x16x32_bf16 v[88:91], v[184:187], a[80:83], v[88:91]
v_mul_f32 v46, v11, v46
v_mul_f32 v47, v11, v47
v_mfma_f32_16x16x32_bf16 v[88:91], v[188:191], a[88:91], v[88:91]
v_mul_f32 v48, v11, v48
v_mul_f32 v49, v11, v49
v_mfma_f32_16x16x32_bf16 v[104:107], v[188:191], a[92:95], v[104:107]
v_mul_f32 v50, v11, v50
v_mul_f32 v51, v11, v51
v_mfma_f32_16x16x32_bf16 v[104:107], v[184:187], a[84:87], v[104:107]
v_mul_f32 v52, v11, v52
v_mul_f32 v53, v11, v53
v_mfma_f32_16x16x32_bf16 v[108:111], v[192:195], a[84:87], v[108:111]
v_mul_f32 v54, v11, v54
v_mul_f32 v55, v11, v55
v_mfma_f32_16x16x32_bf16 v[108:111], v[196:199], a[92:95], v[108:111]
v_mfma_f32_16x16x32_bf16 v[92:95], v[196:199], a[88:91], v[92:95]
s_waitcnt lgkmcnt(0)
v_mfma_f32_16x16x32_bf16 v[92:95], v[192:195], a[80:83], v[92:95]
v_mfma_f32_16x16x32_bf16 v[96:99], v[200:203], a[80:83], v[96:99]
v_mfma_f32_16x16x32_bf16 v[96:99], v[204:207], a[88:91], v[96:99]
v_mfma_f32_16x16x32_bf16 v[112:115], v[204:207], a[92:95], v[112:115]
v_mfma_f32_16x16x32_bf16 v[112:115], v[200:203], a[84:87], v[112:115]
v_mfma_f32_16x16x32_bf16 v[116:119], v[208:211], a[84:87], v[116:119]
v_mfma_f32_16x16x32_bf16 v[116:119], v[212:215], a[92:95], v[116:119]
v_mfma_f32_16x16x32_bf16 v[100:103], v[212:215], a[88:91], v[100:103]
v_mfma_f32_16x16x32_bf16 v[100:103], v[208:211], a[80:83], v[100:103]
buffer_load_dwordx4 v[152:155], v3, s[88:91], s28 offen offset:0 sc1
buffer_load_dwordx4 v[156:159], v3, s[88:91], s28 offen offset:1024 sc1
buffer_load_dwordx4 v[160:163], v3, s[88:91], s28 offen offset:2048 sc1
buffer_load_dwordx4 v[164:167], v3, s[88:91], s28 offen offset:3072 sc1
v_fmac_f32 v24, v8, v88
v_fmac_f32 v25, v8, v89
v_fmac_f32 v26, v8, v90
v_fmac_f32 v27, v8, v91
v_fmac_f32 v28, v8, v92
v_fmac_f32 v29, v8, v93
v_fmac_f32 v30, v8, v94
v_fmac_f32 v31, v8, v95
v_fmac_f32 v32, v8, v96
v_fmac_f32 v33, v8, v97
v_fmac_f32 v34, v8, v98
v_fmac_f32 v35, v8, v99
v_fmac_f32 v36, v8, v100
v_fmac_f32 v37, v8, v101
v_fmac_f32 v38, v8, v102
v_fmac_f32 v39, v8, v103
v_fmac_f32 v40, v9, v104
v_fmac_f32 v41, v9, v105
v_fmac_f32 v42, v9, v106
v_fmac_f32 v43, v9, v107
v_fmac_f32 v44, v9, v108
v_fmac_f32 v45, v9, v109
v_fmac_f32 v46, v9, v110
v_fmac_f32 v47, v9, v111
v_fmac_f32 v48, v9, v112
v_fmac_f32 v49, v9, v113
v_fmac_f32 v50, v9, v114
v_fmac_f32 v51, v9, v115
v_fmac_f32 v52, v9, v116
v_fmac_f32 v53, v9, v117
v_fmac_f32 v54, v9, v118
v_fmac_f32 v55, v9, v119
s_mov_b32 s92, 200000
L_spin_x:
s_waitcnt vmcnt(0)
v_max3_u32 v168, v152, v153, 0
v_max3_u32 v168, v154, v155, v168
v_max3_u32 v168, v156, v157, v168
v_max3_u32 v168, v158, v159, v168
v_max3_u32 v168, v160, v161, v168
v_max3_u32 v168, v162, v163, v168
v_max3_u32 v168, v164, v165, v168
v_max3_u32 v168, v166, v167, v168
v_cmp_eq_u32 vcc, -1, v168
s_sub_u32 s92, s92, 1
s_cbranch_scc1 L_spun_x
s_nop 3
s_cbranch_vccz L_spun_x
s_sleep 2
buffer_load_dwordx4 v[152:155], v3, s[88:91], s28 offen offset:0 sc1
buffer_load_dwordx4 v[156:159], v3, s[88:91], s28 offen offset:1024 sc1
buffer_load_dwordx4 v[160:163], v3, s[88:91], s28 offen offset:2048 sc1
buffer_load_dwordx4 v[164:167], v3, s[88:91], s28 offen offset:3072 sc1
s_branch L_spin_x
L_spun_x:
v_lshlrev_b32 v168, 16, v152
v_and_b32 v169, 0xffff0000, v152
v_pk_add_f32 v[24:25], v[24:25], v[168:169]
v_lshlrev_b32 v168, 16, v153
v_and_b32 v169, 0xffff0000, v153
v_pk_add_f32 v[26:27], v[26:27], v[168:169]
v_lshlrev_b32 v168, 16, v154
v_and_b32 v169, 0xffff0000, v154
v_pk_add_f32 v[28:29], v[28:29], v[168:169]
v_lshlrev_b32 v168, 16, v155
v_and_b32 v169, 0xffff0000, v155
v_pk_add_f32 v[30:31], v[30:31], v[168:169]
v_cvt_pk_bf16_f32 v24, v24, v25
v_cvt_pk_bf16_f32 v25, v26, v27
v_cvt_pk_bf16_f32 v26, v28, v29
v_cvt_pk_bf16_f32 v27, v30, v31
s_nop 1
v_permlane16_swap_b32 v24, v26
v_permlane16_swap_b32 v25, v27
buffer_store_dwordx4 v[24:27], v17, s[80:83], s29 offen offset:0 sc1
v_lshlrev_b32 v168, 16, v156
v_and_b32 v169, 0xffff0000, v156
v_pk_add_f32 v[32:33], v[32:33], v[168:169]
v_lshlrev_b32 v168, 16, v157
v_and_b32 v169, 0xffff0000, v157
v_pk_add_f32 v[34:35], v[34:35], v[168:169]
v_lshlrev_b32 v168, 16, v158
v_and_b32 v169, 0xffff0000, v158
v_pk_add_f32 v[36:37], v[36:37], v[168:169]
v_lshlrev_b32 v168, 16, v159
v_and_b32 v169, 0xffff0000, v159
v_pk_add_f32 v[38:39], v[38:39], v[168:169]
v_cvt_pk_bf16_f32 v32, v32, v33
v_cvt_pk_bf16_f32 v33, v34, v35
v_cvt_pk_bf16_f32 v34, v36, v37
v_cvt_pk_bf16_f32 v35, v38, v39
s_nop 1
v_permlane16_swap_b32 v32, v34
v_permlane16_swap_b32 v33, v35
buffer_store_dwordx4 v[32:35], v17, s[80:83], s29 offen offset:64 sc1
v_lshlrev_b32 v168, 16, v160
v_and_b32 v169, 0xffff0000, v160
v_pk_add_f32 v[40:41], v[40:41], v[168:169]
v_lshlrev_b32 v168, 16, v161
v_and_b32 v169, 0xffff0000, v161
v_pk_add_f32 v[42:43], v[42:43], v[168:169]
v_lshlrev_b32 v168, 16, v162
v_and_b32 v169, 0xffff0000, v162
v_pk_add_f32 v[44:45], v[44:45], v[168:169]
v_lshlrev_b32 v168, 16, v163
v_and_b32 v169, 0xffff0000, v163
v_pk_add_f32 v[46:47], v[46:47], v[168:169]
v_cvt_pk_bf16_f32 v40, v40, v41
v_cvt_pk_bf16_f32 v41, v42, v43
v_cvt_pk_bf16_f32 v42, v44, v45
v_cvt_pk_bf16_f32 v43, v46, v47
s_nop 1
v_permlane16_swap_b32 v40, v42
v_permlane16_swap_b32 v41, v43
buffer_store_dwordx4 v[40:43], v17, s[80:83], s31 offen offset:0 sc1
v_lshlrev_b32 v168, 16, v164
v_and_b32 v169, 0xffff0000, v164
v_pk_add_f32 v[48:49], v[48:49], v[168:169]
v_lshlrev_b32 v168, 16, v165
v_and_b32 v169, 0xffff0000, v165
v_pk_add_f32 v[50:51], v[50:51], v[168:169]
v_lshlrev_b32 v168, 16, v166
v_and_b32 v169, 0xffff0000, v166
v_pk_add_f32 v[52:53], v[52:53], v[168:169]
v_lshlrev_b32 v168, 16, v167
v_and_b32 v169, 0xffff0000, v167
v_pk_add_f32 v[54:55], v[54:55], v[168:169]
v_cvt_pk_bf16_f32 v48, v48, v49
v_cvt_pk_bf16_f32 v49, v50, v51
v_cvt_pk_bf16_f32 v50, v52, v53
v_cvt_pk_bf16_f32 v51, v54, v55
s_nop 1
v_permlane16_swap_b32 v48, v50
v_permlane16_swap_b32 v49, v51
buffer_store_dwordx4 v[48:51], v17, s[80:83], s31 offen offset:64 sc1
L_end:
s_endpgm
L_att_fallback:
s_waitcnt vmcnt(0)
s_mov_b32 s33, 1
s_mul_i32 s32, s5, 0x10c400
s_lshl_b32 s19, s4, 13
s_add_u32 s32, s32, s19
s_cmp_eq_u32 s4, 0
s_cselect_b32 s94, 0x200000, 0
s_add_u32 s32, s32, s94
s_sub_u32 s94, 0x8000, s94
s_add_u32 s7, s32, 0x1000
s_add_u32 s27, s19, 131072
v_and_b32 v5, 15, v0
v_lshrrev_b32 v6, 4, v0
v_lshlrev_b32 v6, 2, v6
v_sub_u32 v5, v5, v6
v_mov_b32 v9, 0xf149f2ca
s_lshr_b32 s8, s20, 11
v_add_u32 v96, s8, v5
v_mov_b32 v80, v9
s_lshr_b32 s8, s21, 11
v_add_u32 v97, s8, v5
v_mov_b32 v84, v9
s_lshr_b32 s8, s22, 11
v_add_u32 v98, s8, v5
v_mov_b32 v88, v9
s_lshr_b32 s8, s23, 11
v_add_u32 v99, s8, v5
v_mov_b32 v92, v9
s_sub_u32 s15, 16, s6
s_lshl_b32 s15, s15, 1
L_fb_loop:
s_waitcnt lgkmcnt(0)
s_barrier
s_add_u32 m0, s19, 0x0
s_nop 0
buffer_load_dwordx4 v3, s[48:51], s32 offen offset:0 sc1 lds
buffer_load_dwordx4 v3, s[48:51], s32 offen offset:1024 sc1 lds
buffer_load_dwordx4 v3, s[48:51], s32 offen offset:2048 sc1 lds
buffer_load_dwordx4 v3, s[48:51], s32 offen offset:3072 sc1 lds
s_add_u32 m0, s19, 0x1000
s_nop 0
buffer_load_dwordx4 v3, s[48:51], s7 offen offset:0 sc1 lds
buffer_load_dwordx4 v3, s[48:51], s7 offen offset:1024 sc1 lds
buffer_load_dwordx4 v3, s[48:51], s7 offen offset:2048 sc1 lds
buffer_load_dwordx4 v3, s[48:51], s7 offen offset:3072 sc1 lds
s_add_u32 s32, s32, s94
s_add_u32 s7, s7, s94
s_mov_b32 s94, 0x8000
s_waitcnt vmcnt(0)
s_barrier
ds_read_b128 a[0:3], v3 offset:8192
ds_read_b128 a[4:7], v3 offset:9216
ds_read_b128 a[8:11], v3 offset:10240
ds_read_b128 a[12:15], v3 offset:11264
ds_read_b128 a[16:19], v3 offset:12288
ds_read_b128 a[20:23], v3 offset:13312
ds_read_b128 a[24:27], v3 offset:14336
ds_read_b128 a[28:31], v3 offset:15360
s_waitcnt lgkmcnt(0)
v_mfma_f32_16x16x32_bf16 v[16:19], a[0:3], a[160:163], 0
v_mfma_f32_16x16x32_bf16 v[16:19], a[4:7], a[164:167], v[16:19]
v_mfma_f32_16x16x32_bf16 v[16:19], a[8:11], a[168:171], v[16:19]
v_mfma_f32_16x16x32_bf16 v[16:19], a[12:15], a[172:175], v[16:19]
v_mfma_f32_16x16x32_bf16 v[20:23], a[0:3], a[176:179], 0
v_mfma_f32_16x16x32_bf16 v[20:23], a[4:7], a[180:183], v[20:23]
v_mfma_f32_16x16x32_bf16 v[20:23], a[8:11], a[184:187], v[20:23]
v_mfma_f32_16x16x32_bf16 v[20:23], a[12:15], a[188:191], v[20:23]
v_mfma_f32_16x16x32_bf16 v[24:27], a[0:3], a[192:195], 0
v_mfma_f32_16x16x32_bf16 v[24:27], a[4:7], a[196:199], v[24:27]
v_mfma_f32_16x16x32_bf16 v[24:27], a[8:11], a[200:203], v[24:27]
v_mfma_f32_16x16x32_bf16 v[24:27], a[12:15], a[204:207], v[24:27]
v_mfma_f32_16x16x32_bf16 v[28:31], a[0:3], a[208:211], 0
v_mfma_f32_16x16x32_bf16 v[28:31], a[4:7], a[212:215], v[28:31]
v_mfma_f32_16x16x32_bf16 v[28:31], a[8:11], a[216:219], v[28:31]
v_mfma_f32_16x16x32_bf16 v[28:31], a[12:15], a[220:223], v[28:31]
v_mfma_f32_16x16x32_bf16 v[32:35], a[16:19], a[160:163], 0
v_mfma_f32_16x16x32_bf16 v[32:35], a[20:23], a[164:167], v[32:35]
v_mfma_f32_16x16x32_bf16 v[32:35], a[24:27], a[168:171], v[32:35]
v_mfma_f32_16x16x32_bf16 v[32:35], a[28:31], a[172:175], v[32:35]
v_mfma_f32_16x16x32_bf16 v[36:39], a[16:19], a[176:179], 0
v_mfma_f32_16x16x32_bf16 v[36:39], a[20:23], a[180:183], v[36:39]
v_mfma_f32_16x16x32_bf16 v[36:39], a[24:27], a[184:187], v[36:39]
v_mfma_f32_16x16x32_bf16 v[36:39], a[28:31], a[188:191], v[36:39]
v_mfma_f32_16x16x32_bf16 v[40:43], a[16:19], a[192:195], 0
v_mfma_f32_16x16x32_bf16 v[40:43], a[20:23], a[196:199], v[40:43]
v_mfma_f32_16x16x32_bf16 v[40:43], a[24:27], a[200:203], v[40:43]
v_mfma_f32_16x16x32_bf16 v[40:43], a[28:31], a[204:207], v[40:43]
v_mfma_f32_16x16x32_bf16 v[44:47], a[16:19], a[208:211], 0
v_mfma_f32_16x16x32_bf16 v[44:47], a[20:23], a[212:215], v[44:47]
v_mfma_f32_16x16x32_bf16 v[44:47], a[24:27], a[216:219], v[44:47]
v_mfma_f32_16x16x32_bf16 v[44:47], a[28:31], a[220:223], v[44:47]
s_nop 7
v_cmp_le_i32 s[36:37], 0, v96
v_cmp_le_i32 s[38:39], 1, v96
v_cmp_le_i32 s[40:41], 2, v96
v_cmp_le_i32 s[42:43], 3, v96
s_nop 1
v_cndmask_b32 v16, v9, v16, s[36:37]
v_cndmask_b32 v17, v9, v17, s[38:39]
v_cndmask_b32 v18, v9, v18, s[40:41]
v_cndmask_b32 v19, v9, v19, s[42:43]
v_max3_f32 v80, v80, v16, v17
v_max3_f32 v80, v80, v18, v19
v_cmp_le_i32 s[36:37], 0, v97
v_cmp_le_i32 s[38:39], 1, v97
v_cmp_le_i32 s[40:41], 2, v97
v_cmp_le_i32 s[42:43], 3, v97
s_nop 1
v_cndmask_b32 v20, v9, v20, s[36:37]
v_cndmask_b32 v21, v9, v21, s[38:39]
v_cndmask_b32 v22, v9, v22, s[40:41]
v_cndmask_b32 v23, v9, v23, s[42:43]
v_max3_f32 v84, v84, v20, v21
v_max3_f32 v84, v84, v22, v23
v_cmp_le_i32 s[36:37], 0, v98
v_cmp_le_i32 s[38:39], 1, v98
v_cmp_le_i32 s[40:41], 2, v98
v_cmp_le_i32 s[42:43], 3, v98
s_nop 1
v_cndmask_b32 v24, v9, v24, s[36:37]
v_cndmask_b32 v25, v9, v25, s[38:39]
v_cndmask_b32 v26, v9, v26, s[40:41]
v_cndmask_b32 v27, v9, v27, s[42:43]
v_max3_f32 v88, v88, v24, v25
v_max3_f32 v88, v88, v26, v27
v_cmp_le_i32 s[36:37], 0, v99
v_cmp_le_i32 s[38:39], 1, v99
v_cmp_le_i32 s[40:41], 2, v99
v_cmp_le_i32 s[42:43], 3, v99
s_nop 1
v_cndmask_b32 v28, v9, v28, s[36:37]
v_cndmask_b32 v29, v9, v29, s[38:39]
v_cndmask_b32 v30, v9, v30, s[40:41]
v_cndmask_b32 v31, v9, v31, s[42:43]
v_max3_f32 v92, v92, v28, v29
v_max3_f32 v92, v92, v30, v31
v_cmp_le_i32 s[36:37], 16, v96
v_cmp_le_i32 s[38:39], 17, v96
v_cmp_le_i32 s[40:41], 18, v96
v_cmp_le_i32 s[42:43], 19, v96
s_nop 1
v_cndmask_b32 v32, v9, v32, s[36:37]
v_cndmask_b32 v33, v9, v33, s[38:39]
v_cndmask_b32 v34, v9, v34, s[40:41]
v_cndmask_b32 v35, v9, v35, s[42:43]
v_max3_f32 v80, v80, v32, v33
v_max3_f32 v80, v80, v34, v35
v_cmp_le_i32 s[36:37], 16, v97
v_cmp_le_i32 s[38:39], 17, v97
v_cmp_le_i32 s[40:41], 18, v97
v_cmp_le_i32 s[42:43], 19, v97
s_nop 1
v_cndmask_b32 v36, v9, v36, s[36:37]
v_cndmask_b32 v37, v9, v37, s[38:39]
v_cndmask_b32 v38, v9, v38, s[40:41]
v_cndmask_b32 v39, v9, v39, s[42:43]
v_max3_f32 v84, v84, v36, v37
v_max3_f32 v84, v84, v38, v39
v_cmp_le_i32 s[36:37], 16, v98
v_cmp_le_i32 s[38:39], 17, v98
v_cmp_le_i32 s[40:41], 18, v98
v_cmp_le_i32 s[42:43], 19, v98
s_nop 1
v_cndmask_b32 v40, v9, v40, s[36:37]
v_cndmask_b32 v41, v9, v41, s[38:39]
v_cndmask_b32 v42, v9, v42, s[40:41]
v_cndmask_b32 v43, v9, v43, s[42:43]
v_max3_f32 v88, v88, v40, v41
v_max3_f32 v88, v88, v42, v43
v_cmp_le_i32 s[36:37], 16, v99
v_cmp_le_i32 s[38:39], 17, v99
v_cmp_le_i32 s[40:41], 18, v99
v_cmp_le_i32 s[42:43], 19, v99
s_nop 1
v_cndmask_b32 v44, v9, v44, s[36:37]
v_cndmask_b32 v45, v9, v45, s[38:39]
v_cndmask_b32 v46, v9, v46, s[40:41]
v_cndmask_b32 v47, v9, v47, s[42:43]
v_max3_f32 v92, v92, v44, v45
v_max3_f32 v92, v92, v46, v47
ds_read_b128 a[0:3], v3 offset:24576
ds_read_b128 a[4:7], v3 offset:25600
ds_read_b128 a[8:11], v3 offset:26624
ds_read_b128 a[12:15], v3 offset:27648
ds_read_b128 a[16:19], v3 offset:28672
ds_read_b128 a[20:23], v3 offset:29696
ds_read_b128 a[24:27], v3 offset:30720
ds_read_b128 a[28:31], v3 offset:31744
s_waitcnt lgkmcnt(0)
v_mfma_f32_16x16x32_bf16 v[16:19], a[0:3], a[160:163], 0
v_mfma_f32_16x16x32_bf16 v[16:19], a[4:7], a[164:167], v[16:19]
v_mfma_f32_16x16x32_bf16 v[16:19], a[8:11], a[168:171], v[16:19]
v_mfma_f32_16x16x32_bf16 v[16:19], a[12:15], a[172:175], v[16:19]
v_mfma_f32_16x16x32_bf16 v[20:23], a[0:3], a[176:179], 0
v_mfma_f32_16x16x32_bf16 v[20:23], a[4:7], a[180:183], v[20:23]
v_mfma_f32_16x16x32_bf16 v[20:23], a[8:11], a[184:187], v[20:23]
v_mfma_f32_16x16x32_bf16 v[20:23], a[12:15], a[188:191], v[20:23]
v_mfma_f32_16x16x32_bf16 v[24:27], a[0:3], a[192:195], 0
v_mfma_f32_16x16x32_bf16 v[24:27], a[4:7], a[196:199], v[24:27]
v_mfma_f32_16x16x32_bf16 v[24:27], a[8:11], a[200:203], v[24:27]
v_mfma_f32_16x16x32_bf16 v[24:27], a[12:15], a[204:207], v[24:27]
v_mfma_f32_16x16x32_bf16 v[28:31], a[0:3], a[208:211], 0
v_mfma_f32_16x16x32_bf16 v[28:31], a[4:7], a[212:215], v[28:31]
v_mfma_f32_16x16x32_bf16 v[28:31], a[8:11], a[216:219], v[28:31]
v_mfma_f32_16x16x32_bf16 v[28:31], a[12:15], a[220:223], v[28:31]
v_mfma_f32_16x16x32_bf16 v[32:35], a[16:19], a[160:163], 0
v_mfma_f32_16x16x32_bf16 v[32:35], a[20:23], a[164:167], v[32:35]
v_mfma_f32_16x16x32_bf16 v[32:35], a[24:27], a[168:171], v[32:35]
v_mfma_f32_16x16x32_bf16 v[32:35], a[28:31], a[172:175], v[32:35]
v_mfma_f32_16x16x32_bf16 v[36:39], a[16:19], a[176:179], 0
v_mfma_f32_16x16x32_bf16 v[36:39], a[20:23], a[180:183], v[36:39]
v_mfma_f32_16x16x32_bf16 v[36:39], a[24:27], a[184:187], v[36:39]
v_mfma_f32_16x16x32_bf16 v[36:39], a[28:31], a[188:191], v[36:39]
v_mfma_f32_16x16x32_bf16 v[40:43], a[16:19], a[192:195], 0
v_mfma_f32_16x16x32_bf16 v[40:43], a[20:23], a[196:199], v[40:43]
v_mfma_f32_16x16x32_bf16 v[40:43], a[24:27], a[200:203], v[40:43]
v_mfma_f32_16x16x32_bf16 v[40:43], a[28:31], a[204:207], v[40:43]
v_mfma_f32_16x16x32_bf16 v[44:47], a[16:19], a[208:211], 0
v_mfma_f32_16x16x32_bf16 v[44:47], a[20:23], a[212:215], v[44:47]
v_mfma_f32_16x16x32_bf16 v[44:47], a[24:27], a[216:219], v[44:47]
v_mfma_f32_16x16x32_bf16 v[44:47], a[28:31], a[220:223], v[44:47]
s_nop 7
v_cmp_le_i32 s[36:37], 32, v96
v_cmp_le_i32 s[38:39], 33, v96
v_cmp_le_i32 s[40:41], 34, v96
v_cmp_le_i32 s[42:43], 35, v96
s_nop 1
v_cndmask_b32 v16, v9, v16, s[36:37]
v_cndmask_b32 v17, v9, v17, s[38:39]
v_cndmask_b32 v18, v9, v18, s[40:41]
v_cndmask_b32 v19, v9, v19, s[42:43]
v_max3_f32 v80, v80, v16, v17
v_max3_f32 v80, v80, v18, v19
v_cmp_le_i32 s[36:37], 32, v97
v_cmp_le_i32 s[38:39], 33, v97
v_cmp_le_i32 s[40:41], 34, v97
v_cmp_le_i32 s[42:43], 35, v97
s_nop 1
v_cndmask_b32 v20, v9, v20, s[36:37]
v_cndmask_b32 v21, v9, v21, s[38:39]
v_cndmask_b32 v22, v9, v22, s[40:41]
v_cndmask_b32 v23, v9, v23, s[42:43]
v_max3_f32 v84, v84, v20, v21
v_max3_f32 v84, v84, v22, v23
v_cmp_le_i32 s[36:37], 32, v98
v_cmp_le_i32 s[38:39], 33, v98
v_cmp_le_i32 s[40:41], 34, v98
v_cmp_le_i32 s[42:43], 35, v98
s_nop 1
v_cndmask_b32 v24, v9, v24, s[36:37]
v_cndmask_b32 v25, v9, v25, s[38:39]
v_cndmask_b32 v26, v9, v26, s[40:41]
v_cndmask_b32 v27, v9, v27, s[42:43]
v_max3_f32 v88, v88, v24, v25
v_max3_f32 v88, v88, v26, v27
v_cmp_le_i32 s[36:37], 32, v99
v_cmp_le_i32 s[38:39], 33, v99
v_cmp_le_i32 s[40:41], 34, v99
v_cmp_le_i32 s[42:43], 35, v99
s_nop 1
v_cndmask_b32 v28, v9, v28, s[36:37]
v_cndmask_b32 v29, v9, v29, s[38:39]
v_cndmask_b32 v30, v9, v30, s[40:41]
v_cndmask_b32 v31, v9, v31, s[42:43]
v_max3_f32 v92, v92, v28, v29
v_max3_f32 v92, v92, v30, v31
v_cmp_le_i32 s[36:37], 48, v96
v_cmp_le_i32 s[38:39], 49, v96
v_cmp_le_i32 s[40:41], 50, v96
v_cmp_le_i32 s[42:43], 51, v96
s_nop 1
v_cndmask_b32 v32, v9, v32, s[36:37]
v_cndmask_b32 v33, v9, v33, s[38:39]
v_cndmask_b32 v34, v9, v34, s[40:41]
v_cndmask_b32 v35, v9, v35, s[42:43]
v_max3_f32 v80, v80, v32, v33
v_max3_f32 v80, v80, v34, v35
v_cmp_le_i32 s[36:37], 48, v97
v_cmp_le_i32 s[38:39], 49, v97
v_cmp_le_i32 s[40:41], 50, v97
v_cmp_le_i32 s[42:43], 51, v97
s_nop 1
v_cndmask_b32 v36, v9, v36, s[36:37]
v_cndmask_b32 v37, v9, v37, s[38:39]
v_cndmask_b32 v38, v9, v38, s[40:41]
v_cndmask_b32 v39, v9, v39, s[42:43]
v_max3_f32 v84, v84, v36, v37
v_max3_f32 v84, v84, v38, v39
v_cmp_le_i32 s[36:37], 48, v98
v_cmp_le_i32 s[38:39], 49, v98
v_cmp_le_i32 s[40:41], 50, v98
v_cmp_le_i32 s[42:43], 51, v98
s_nop 1
v_cndmask_b32 v40, v9, v40, s[36:37]
v_cndmask_b32 v41, v9, v41, s[38:39]
v_cndmask_b32 v42, v9, v42, s[40:41]
v_cndmask_b32 v43, v9, v43, s[42:43]
v_max3_f32 v88, v88, v40, v41
v_max3_f32 v88, v88, v42, v43
v_cmp_le_i32 s[36:37], 48, v99
v_cmp_le_i32 s[38:39], 49, v99
v_cmp_le_i32 s[40:41], 50, v99
v_cmp_le_i32 s[42:43], 51, v99
s_nop 1
v_cndmask_b32 v44, v9, v44, s[36:37]
v_cndmask_b32 v45, v9, v45, s[38:39]
v_cndmask_b32 v46, v9, v46, s[40:41]
v_cndmask_b32 v47, v9, v47, s[42:43]
v_max3_f32 v92, v92, v44, v45
v_max3_f32 v92, v92, v46, v47
v_subrev_u32 v96, 64, v96
v_subrev_u32 v97, 64, v97
v_subrev_u32 v98, 64, v98
v_subrev_u32 v99, 64, v99
s_sub_u32 s15, s15, 1
s_cmp_lg_u32 s15, 0
s_cbranch_scc1 L_fb_loop
v_mov_b32 v16, v80
v_mov_b32 v20, v84
v_mov_b32 v24, v88
v_mov_b32 v28, v92
v_permlane16_swap_b32 v16, v80
v_permlane16_swap_b32 v20, v84
v_permlane16_swap_b32 v24, v88
v_permlane16_swap_b32 v28, v92
v_max_f32 v80, v80, v16
v_max_f32 v84, v84, v20
v_max_f32 v88, v88, v24
v_max_f32 v92, v92, v28
v_mov_b32 v16, v80
v_mov_b32 v20, v84
v_mov_b32 v24, v88
v_mov_b32 v28, v92
v_permlane32_swap_b32 v16, v80
v_permlane32_swap_b32 v20, v84
v_permlane32_swap_b32 v24, v88
v_permlane32_swap_b32 v28, v92
v_max_f32 v80, v80, v16
v_max_f32 v84, v84, v20
v_max_f32 v88, v88, v24
v_max_f32 v92, v92, v28
s_barrier
s_mul_i32 s32, s5, 0x10c400
s_lshl_b32 s19, s4, 13
s_add_u32 s32, s32, s19
s_cmp_eq_u32 s4, 0
s_cselect_b32 s94, 0x200000, 0
s_add_u32 s32, s32, s94
s_sub_u32 s94, 0x8000, s94
s_add_u32 s7, s32, 0x1000
s_add_u32 s27, s19, 131072
s_add_u32 m0, s19, 0x0
s_nop 0
buffer_load_dwordx4 v3, s[48:51], s32 offen offset:0 sc1 lds
buffer_load_dwordx4 v3, s[48:51], s32 offen offset:1024 sc1 lds
buffer_load_dwordx4 v3, s[48:51], s32 offen offset:2048 sc1 lds
buffer_load_dwordx4 v3, s[48:51], s32 offen offset:3072 sc1 lds
s_add_u32 m0, s19, 0x1000
s_nop 0
buffer_load_dwordx4 v3, s[48:51], s7 offen offset:0 sc1 lds
buffer_load_dwordx4 v3, s[48:51], s7 offen offset:1024 sc1 lds
buffer_load_dwordx4 v3, s[48:51], s7 offen offset:2048 sc1 lds
buffer_load_dwordx4 v3, s[48:51], s7 offen offset:3072 sc1 lds
s_add_u32 s32, s32, s94
s_add_u32 s7, s7, s94
s_add_u32 m0, s19, 0x18000
s_nop 0
buffer_load_dwordx4 v3, s[48:51], s32 offen offset:0 sc1 lds
buffer_load_dwordx4 v3, s[48:51], s32 offen offset:1024 sc1 lds
buffer_load_dwordx4 v3, s[48:51], s32 offen offset:2048 sc1 lds
buffer_load_dwordx4 v3, s[48:51], s32 offen offset:3072 sc1 lds
s_add_u32 m0, s19, 0x19000
s_nop 0
buffer_load_dwordx4 v3, s[48:51], s7 offen offset:0 sc1 lds
buffer_load_dwordx4 v3, s[48:51], s7 offen offset:1024 sc1 lds
buffer_load_dwordx4 v3, s[48:51], s7 offen offset:2048 sc1 lds
buffer_load_dwordx4 v3, s[48:51], s7 offen offset:3072 sc1 lds
s_add_u32 s32, s32, 0x8000
s_add_u32 s7, s7, 0x8000
s_add_u32 m0, s19, 0x8000
s_nop 0
buffer_load_dwordx4 v3, s[48:51], s32 offen offset:0 sc1 lds
buffer_load_dwordx4 v3, s[48:51], s32 offen offset:1024 sc1 lds
buffer_load_dwordx4 v3, s[48:51], s32 offen offset:2048 sc1 lds
buffer_load_dwordx4 v3, s[48:51], s32 offen offset:3072 sc1 lds
s_add_u32 m0, s19, 0x9000
s_nop 0
buffer_load_dwordx4 v3, s[48:51], s7 offen offset:0 sc1 lds
buffer_load_dwordx4 v3, s[48:51], s7 offen offset:1024 sc1 lds
buffer_load_dwordx4 v3, s[48:51], s7 offen offset:2048 sc1 lds
buffer_load_dwordx4 v3, s[48:51], s7 offen offset:3072 sc1 lds
s_add_u32 s32, s32, 0x8000
s_add_u32 s7, s7, 0x8000
s_bfe_u32 s99, s2, 0x20001
s_lshl_b32 s99, s99, 2
s_lshr_b32 s8, s2, 6
s_add_u32 s99, s99, s8
s_bfe_u32 s100, s2, 0x30003
s_and_b32 s14, s2, 1
s_sub_u32 s24, 15, s99
s_min_u32 s18, s24, s99
s_lshl_b32 s24, s18, 1
s_add_u32 s24, s24, s14
s_lshl_b32 s24, s24, 8
s_add_u32 s24, s24, 0x3704000
s_mov_b32 s12, 14336
s_and_b32 s16, s6, 1
s_lshl_b32 s16, s16, 15
s_add_u32 s16, s16, 98304
s_add_u32 s16, s16, s17
s_lshl_b32 s13, s4, 15
s_lshl_b32 s9, s100, 8
s_add_u32 s13, s13, s9
s_mul_i32 s9, s14, 1310848
s_add_u32 s13, s13, s9
s_mul_i32 s25, s14, 3407872
s_sub_u32 s25, s25, 1179648
s_mul_i32 s101, s99, 0x142400
s_lshl_b32 s8, s4, 11
s_add_u32 s101, s101, s8
s_mul_i32 s8, s14, 163840
s_add_u32 s101, s101, s8
s_add_u32 s101, s101, 0x21fe000
s_mul_i32 s26, s14, 425984
s_add_u32 s26, s26, 106496
v_mov_b32 v15, s6
v_xor_b32 v15, 0, v15
v_writelane_b32 v15, s18, 0
v_lshlrev_b32 v15, 2, v15
v_bfe_u32 v12, v0, 2, 2
v_lshlrev_b32 v12, 11, v12
v_lshrrev_b32 v13, 4, v0
v_lshl_add_u32 v12, v13, 6, v12
v_and_b32 v13, 3, v0
v_lshl_add_u32 v12, v13, 4, v12
v_xor_b32 v12, s13, v12
v_xor_b32 v13, 32, v12
v_add_u32 v13, 7168, v13
s_mov_b32 s11, 0xf149f2ca
s_mov_b32 s36, 0xfff0ffff
s_mov_b32 s37, 0xf000ff00
s_mov_b32 s38, 0xffe0fffe
s_mov_b32 s39, 0xe000fe00
s_mov_b32 s40, 0xffc0fffc
s_mov_b32 s41, 0xc000fc00
s_mov_b32 s42, 0xff80fff8
s_mov_b32 s43, 0x8000f800
s_bitcmp1_b32 s4, 0
s_cselect_b32 s8, 0x7f800000, s11
s_cselect_b32 s9, s11, 0x7f800000
v_mov_b32 v1, v3
v_add_u32 v2, 98304, v3
s_mov_b64 s[34:35], 0
v_accvgpr_write_b32 a224, 0
v_accvgpr_write_b32 a225, 0
v_accvgpr_write_b32 a226, 0
v_accvgpr_write_b32 a227, 0
v_accvgpr_write_b32 a228, 0
v_accvgpr_write_b32 a229, 0
v_accvgpr_write_b32 a230, 0
v_accvgpr_write_b32 a231, 0
v_sub_f32 v83, 0, v80
v_sub_f32 v82, 0, v80
v_sub_f32 v81, 0, v80
v_sub_f32 v80, 0, v80
v_min_f32 v103, s8, v80
v_cndmask_b32 v96, v103, v80, s[36:37]
v_cndmask_b32 v97, v103, v80, s[38:39]
v_cndmask_b32 v98, v103, v80, s[40:41]
v_cndmask_b32 v99, v103, v80, s[42:43]
v_cndmask_b32 v100, v9, v103, s[36:37]
v_cndmask_b32 v101, v9, v103, s[38:39]
v_cndmask_b32 v102, v9, v103, s[40:41]
v_cndmask_b32 v103, v9, v103, s[42:43]
v_sub_f32 v87, 0, v84
v_sub_f32 v86, 0, v84
v_sub_f32 v85, 0, v84
v_sub_f32 v84, 0, v84
v_min_f32 v111, s9, v84
v_cndmask_b32 v104, v111, v84, s[36:37]
v_cndmask_b32 v105, v111, v84, s[38:39]
v_cndmask_b32 v106, v111, v84, s[40:41]
v_cndmask_b32 v107, v111, v84, s[42:43]
v_cndmask_b32 v108, v9, v111, s[36:37]
v_cndmask_b32 v109, v9, v111, s[38:39]
v_cndmask_b32 v110, v9, v111, s[40:41]
v_cndmask_b32 v111, v9, v111, s[42:43]
v_sub_f32 v91, 0, v88
v_sub_f32 v90, 0, v88
v_sub_f32 v89, 0, v88
v_sub_f32 v88, 0, v88
v_min_f32 v119, s8, v88
v_cndmask_b32 v112, v119, v88, s[36:37]
v_cndmask_b32 v113, v119, v88, s[38:39]
v_cndmask_b32 v114, v119, v88, s[40:41]
v_cndmask_b32 v115, v119, v88, s[42:43]
v_cndmask_b32 v116, v9, v119, s[36:37]
v_cndmask_b32 v117, v9, v119, s[38:39]
v_cndmask_b32 v118, v9, v119, s[40:41]
v_cndmask_b32 v119, v9, v119, s[42:43]
v_sub_f32 v95, 0, v92
v_sub_f32 v94, 0, v92
v_sub_f32 v93, 0, v92
v_sub_f32 v92, 0, v92
v_min_f32 v127, s9, v92
v_cndmask_b32 v120, v127, v92, s[36:37]
v_cndmask_b32 v121, v127, v92, s[38:39]
v_cndmask_b32 v122, v127, v92, s[40:41]
v_cndmask_b32 v123, v127, v92, s[42:43]
v_cndmask_b32 v124, v9, v127, s[36:37]
v_cndmask_b32 v125, v9, v127, s[38:39]
v_cndmask_b32 v126, v9, v127, s[40:41]
v_cndmask_b32 v127, v9, v127, s[42:43]
v_and_b32 v9, 1, v0
v_mul_u32_u24 v9, 0xaaaa, v9
v_add_u32 v9, 0x4444, v9
v_mov_b32 v128, 0
v_mov_b32 v129, 0
v_mov_b32 v130, 0
v_mov_b32 v131, 0
v_mov_b32 v132, 0
v_mov_b32 v133, 0
v_mov_b32 v134, 0
v_mov_b32 v135, 0
v_mov_b32 v136, 0
v_mov_b32 v137, 0
v_mov_b32 v138, 0
v_mov_b32 v139, 0
v_mov_b32 v140, 0
v_mov_b32 v141, 0
v_mov_b32 v142, 0
v_mov_b32 v143, 0
v_mov_b32 v144, 0
v_mov_b32 v145, 0
v_mov_b32 v146, 0
v_mov_b32 v147, 0
v_mov_b32 v148, 0
v_mov_b32 v149, 0
v_mov_b32 v150, 0
v_mov_b32 v151, 0
v_mov_b32 v152, 0
v_mov_b32 v153, 0
v_mov_b32 v154, 0
v_mov_b32 v155, 0
v_mov_b32 v156, 0
v_mov_b32 v157, 0
v_mov_b32 v158, 0
v_mov_b32 v159, 0
v_mov_b32 v160, 0
v_mov_b32 v161, 0
v_mov_b32 v162, 0
v_mov_b32 v163, 0
v_mov_b32 v164, 0
v_mov_b32 v165, 0
v_mov_b32 v166, 0
v_mov_b32 v167, 0
v_mov_b32 v168, 0
v_mov_b32 v169, 0
v_mov_b32 v170, 0
v_mov_b32 v171, 0
v_mov_b32 v172, 0
v_mov_b32 v173, 0
v_mov_b32 v174, 0
v_mov_b32 v175, 0
v_mov_b32 v176, 0
v_mov_b32 v177, 0
v_mov_b32 v178, 0
v_mov_b32 v179, 0
v_mov_b32 v180, 0
v_mov_b32 v181, 0
v_mov_b32 v182, 0
v_mov_b32 v183, 0
v_mov_b32 v184, 0
v_mov_b32 v185, 0
v_mov_b32 v186, 0
v_mov_b32 v187, 0
v_mov_b32 v188, 0
v_mov_b32 v189, 0
v_mov_b32 v190, 0
v_mov_b32 v191, 0
v_mov_b32 v192, 0
v_mov_b32 v193, 0
v_mov_b32 v194, 0
v_mov_b32 v195, 0
v_mov_b32 v196, 0
v_mov_b32 v197, 0
v_mov_b32 v198, 0
v_mov_b32 v199, 0
v_mov_b32 v200, 0
v_mov_b32 v201, 0
v_mov_b32 v202, 0
v_mov_b32 v203, 0
v_mov_b32 v204, 0
v_mov_b32 v205, 0
v_mov_b32 v206, 0
v_mov_b32 v207, 0
v_mov_b32 v208, 0
v_mov_b32 v209, 0
v_mov_b32 v210, 0
v_mov_b32 v211, 0
v_mov_b32 v212, 0
v_mov_b32 v213, 0
v_mov_b32 v214, 0
v_mov_b32 v215, 0
v_mov_b32 v216, 0
v_mov_b32 v217, 0
v_mov_b32 v218, 0
v_mov_b32 v219, 0
v_mov_b32 v220, 0
v_mov_b32 v221, 0
v_mov_b32 v222, 0
v_mov_b32 v223, 0
v_mov_b32 v224, 0
v_mov_b32 v225, 0
v_mov_b32 v226, 0
v_mov_b32 v227, 0
v_mov_b32 v228, 0
v_mov_b32 v229, 0
v_mov_b32 v230, 0
v_mov_b32 v231, 0
v_mov_b32 v232, 0
v_mov_b32 v233, 0
v_mov_b32 v234, 0
v_mov_b32 v235, 0
v_mov_b32 v236, 0
v_mov_b32 v237, 0
v_mov_b32 v238, 0
v_mov_b32 v239, 0
v_mov_b32 v240, 0
v_mov_b32 v241, 0
v_mov_b32 v242, 0
v_mov_b32 v243, 0
v_mov_b32 v244, 0
v_mov_b32 v245, 0
v_mov_b32 v246, 0
v_mov_b32 v247, 0
v_mov_b32 v248, 0
v_mov_b32 v249, 0
v_mov_b32 v250, 0
v_mov_b32 v251, 0
v_mov_b32 v252, 0
v_mov_b32 v253, 0
v_mov_b32 v254, 0
v_mov_b32 v255, 0
s_waitcnt vmcnt(16)
s_barrier
ds_read_b128 a[0:3], v1 offset:8192
ds_read_b128 a[4:7], v1 offset:9216
ds_read_b128 a[8:11], v1 offset:10240
ds_read_b128 a[12:15], v1 offset:11264
ds_read_b128 a[16:19], v1 offset:12288
ds_read_b128 a[20:23], v1 offset:13312
ds_read_b128 a[24:27], v1 offset:14336
ds_read_b128 a[28:31], v1 offset:15360
s_waitcnt lgkmcnt(0)
s_branch L_att_start
.section .rodata,"a"
.p2align 6
.amdhsa_kernel gated_mix__compressed_kv_cla__sliding_local_dilated__prompt_kernel
  .amdhsa_next_free_vgpr 512
  .amdhsa_next_free_sgpr 102
  .amdhsa_accum_offset 256
  .amdhsa_group_segment_fixed_size 0
  .amdhsa_kernarg_size 104
  .amdhsa_user_sgpr_count 2
  .amdhsa_user_sgpr_kernarg_segment_ptr 1
  .amdhsa_system_sgpr_workgroup_id_x 1
.end_amdhsa_kernel
```

```asm
; @launch grid=(256,1,1) block=(256,1,1) lds=163840
.amdgcn_target "amdgcn-amd-amdhsa--gfx950"
.text
.globl gated_mix__compressed_kv_cla__sliding_local_dilated__prompt_kernel
.p2align 8
.type gated_mix__compressed_kv_cla__sliding_local_dilated__prompt_kernel,@function
gated_mix__compressed_kv_cla__sliding_local_dilated__prompt_kernel:
s_load_dwordx16 s[16:31], s[0:1], 0
s_load_dwordx8 s[32:39], s[0:1], 64
s_load_dwordx2 s[88:89], s[0:1], 96
s_cmp_ge_u32 s2, 256
s_cbranch_scc1 L_end
v_lshrrev_b32 v1, 6, v0
v_and_b32 v0, 63, v0
v_readfirstlane_b32 s4, v1
v_lshlrev_b32 v16, 4, v0
s_lshr_b32 s8, s2, 3
s_lshl_b32 s8, s8, 2
s_add_u32 s8, s8, s4
s_min_u32 s8, s8, (L_end-L_page0)>>10
s_lshl_b32 s8, s8, 10
s_getpc_b64 s[92:93]
L_here:
s_add_u32 s8, s8, L_page0-L_here
s_add_u32 s92, s92, s8
s_addc_u32 s93, s93, 0
v_add_u32 v60, s92, v16
v_mov_b32 v61, s93
global_load_dword a120, v[60:61], off sc1
s_and_b32 s5, s2, 7
s_lshl_b32 s5, s5, 2
s_lshr_b32 s5, 0x75643120, s5
s_and_b32 s5, s5, 7
s_lshl_b32 s5, s5, 2
s_bfe_u32 s3, s2, 0x20003
s_add_u32 s5, s5, s3
s_lshr_b32 s6, s2, 5
s_mov_b32 s12, 0x4000
s_mov_b32 s13, 0x8000
s_mov_b32 s14, 0xc000
s_mov_b32 s46, 0x400000
s_mov_b32 s47, 0x20000
s_mov_b32 s50, 0x200000
s_mov_b32 s51, 0x20000
s_mov_b32 s54, 0x800000
s_mov_b32 s55, 0x20000
s_mov_b32 s58, 0x400000
s_mov_b32 s59, 0x20000
s_mov_b32 s62, 0x400000
s_mov_b32 s63, 0x20000
s_mov_b32 s66, 0x800000
s_mov_b32 s67, 0x20000
s_mov_b32 s70, 0x600000
s_mov_b32 s71, 0x20000
s_mov_b32 s74, 0x200000
s_mov_b32 s75, 0x20000
s_mov_b32 s78, 0x800
s_mov_b32 s79, 0x20000
s_mov_b32 s82, 0x400000
s_mov_b32 s83, 0x20000
s_mov_b32 s86, 0x100
s_mov_b32 s87, 0x20000
s_mov_b32 s90, 0x10000000
s_mov_b32 s91, 0x20000
v_bfe_u32 v17, v0, 2, 2
s_lshl_b32 s8, s4, 4
v_add_u32 v17, s8, v17
v_lshlrev_b32 v17, 13, v17
v_lshrrev_b32 v18, 4, v0
v_lshl_add_u32 v17, v18, 6, v17
v_and_b32 v18, 3, v0
v_lshl_add_u32 v17, v18, 4, v17
s_lshl_b32 s8, s5, 8
v_add_u32 v5, s8, v17
v_xor_b32 v6, 32, v5
v_add_u32 v6, 0x10000, v6
v_lshrrev_b32 v17, 4, v0
v_xor_b32 v17, v17, v0
v_and_b32 v17, 7, v17
v_lshlrev_b32 v17, 4, v17
v_lshrrev_b32 v18, 3, v0
v_lshl_add_u32 v2, v18, 10, v17
s_lshl_b32 s8, s6, 18
s_lshl_b32 s9, s4, 16
s_add_u32 s8, s8, s9
v_add_u32 v2, s8, v2
v_xor_b32 v3, 64, v2
v_add_u32 v3, 0x2000, v3
s_mov_b32 s41, 0
s_mov_b32 s43, 0
v_lshl_add_u32 v5, s41, 19, v5
v_lshl_add_u32 v6, s41, 19, v6
v_lshl_add_u32 v2, s41, 7, v2
v_lshl_add_u32 v3, s41, 7, v3
s_sub_u32 s10, 15, s6
s_cmp_lt_u32 s5, 16
s_cselect_b32 s10, s6, s10
s_lshl_b32 s10, s10, 4
s_and_b32 s11, s5, 15
s_add_u32 s10, s10, s11
s_lshl_b32 s10, s10, 3
s_lshl_b32 s11, s4, 1
s_add_u32 s10, s10, s11
s_lshl_b32 s100, s10, 11
s_lshl_b32 s101, s10, 2
s_add_u32 s101, s101, 0x3700000
s_lshl_b32 s8, s2, 2
s_add_u32 s8, s8, s4
s_lshl_b32 s8, s8, 11
v_lshrrev_b32 v19, 2, v0
v_lshl_add_u32 v19, v19, 7, s8
s_lshr_b32 s8, s2, 3
s_lshl_b32 s8, s8, 2
s_add_u32 s8, s8, s4
s_lshl_b32 s8, s8, 4
s_lshr_b32 s9, s5, 2
s_add_u32 s8, s8, s9
s_lshl_b32 s8, s8, 10
v_bfe_u32 v63, v0, 2, 3
v_lshl_add_u32 v63, v63, 7, s8
v_lshrrev_b32 v59, 5, v0
v_lshl_add_u32 v63, v59, 13, v63
s_lshr_b32 s8, s8, 14
s_mul_i32 s8, s8, 49152
s_lshl_b32 s9, s9, 8
s_add_u32 s8, s8, s9
v_lshrrev_b32 v59, 3, v0
v_mul_u32_u24 v59, 0x1800, v59
v_and_b32 v1, 4, v0
v_lshl_add_u32 v1, v1, 5, v59
v_add_u32 v1, s8, v1
v_mov_b32 v62, v19
s_waitcnt lgkmcnt(0)
s_mov_b64 s[48:49], s[18:19]
s_mov_b64 s[56:57], s[22:23]
s_mov_b64 s[60:61], s[24:25]
L_args:
s_mov_b64 s[0:1], s[92:93]
s_mov_b64 s[44:45], s[16:17]
s_mov_b64 s[76:77], s[34:35]
s_mov_b64 s[52:53], s[20:21]
s_mov_b64 s[64:65], s[26:27]
s_mov_b64 s[68:69], s[30:31]
s_mov_b64 s[72:73], s[32:33]
s_mov_b64 s[80:81], s[36:37]
s_mov_b64 s[84:85], s[38:39]
s_lshl_b32 s16, s4, 13
s_add_u32 s16, s16, 0x18000
s_lshl_b32 s17, s4, 12
s_lshl_b32 s18, s4, 10
s_mov_b32 s25, 0x800
s_mov_b32 s26, 0x1000
s_mov_b32 s3, 0
s_mov_b32 s9, 0x0
s_nop 0
buffer_load_dword a120, v63, s[56:59], s9 offen
s_mov_b32 s9, 0x0
s_nop 0
buffer_load_dword a120, v63, s[60:63], s9 offen
s_add_u32 m0, s17, 0x0
s_nop 0
buffer_load_dwordx4 v5, s[56:59], 0 offen lds
s_add_u32 m0, s17, 0x4000
s_nop 0
buffer_load_dwordx4 v5, s[60:63], 0 offen lds
s_add_u32 m0, s17, 0x400
s_nop 0
buffer_load_dwordx4 v5, s[56:59], s13 offen lds
s_add_u32 m0, s17, 0x4400
s_nop 0
buffer_load_dwordx4 v5, s[60:63], s13 offen lds
s_add_u32 m0, s17, 0x800
s_nop 0
buffer_load_dwordx4 v6, s[56:59], 0 offen lds
s_add_u32 m0, s17, 0x4800
s_nop 0
buffer_load_dwordx4 v6, s[60:63], 0 offen lds
s_add_u32 m0, s17, 0xc00
s_nop 0
buffer_load_dwordx4 v6, s[56:59], s13 offen lds
s_add_u32 m0, s17, 0x4c00
s_nop 0
buffer_load_dwordx4 v6, s[60:63], s13 offen lds
s_mov_b32 s42, 1
s_mov_b32 s41, 7
v_lshl_add_u32 v5, s42, 19, v5
v_lshl_add_u32 v6, s42, 19, v6
s_add_u32 m0, s16, 0x0
s_nop 0
buffer_load_dwordx4 v2, s[48:51], 0 offen lds
s_add_u32 m0, s16, 0x400
s_nop 0
buffer_load_dwordx4 v3, s[48:51], 0 offen lds
s_add_u32 m0, s16, 0x800
s_nop 0
buffer_load_dwordx4 v2, s[48:51], s12 offen lds
s_add_u32 m0, s16, 0xc00
s_nop 0
buffer_load_dwordx4 v3, s[48:51], s12 offen lds
s_add_u32 m0, s16, 0x1000
s_nop 0
buffer_load_dwordx4 v2, s[48:51], s13 offen lds
s_add_u32 m0, s16, 0x1400
s_nop 0
buffer_load_dwordx4 v3, s[48:51], s13 offen lds
s_add_u32 m0, s16, 0x1800
s_nop 0
buffer_load_dwordx4 v2, s[48:51], s14 offen lds
s_add_u32 m0, s16, 0x1c00
s_nop 0
buffer_load_dwordx4 v3, s[48:51], s14 offen lds
v_lshl_add_u32 v2, s42, 7, v2
v_lshl_add_u32 v3, s42, 7, v3
v_lshrrev_b32 v17, 4, v0
v_xor_b32 v17, v17, v0
v_and_b32 v17, 7, v17
v_lshlrev_b32 v17, 4, v17
v_lshrrev_b32 v18, 3, v0
v_lshl_add_u32 v22, v18, 11, v17
v_xor_b32 v23, 64, v22
v_add_u32 v23, 0x4000, v23
s_lshl_b32 s8, s6, 18
s_sub_u32 s9, 15, s6
s_lshl_b32 s9, s9, 18
s_lshl_b32 s10, s4, 15
s_sub_u32 s11, 0x38000, s10
s_add_u32 s20, s8, s10
s_add_u32 s21, s8, s11
s_add_u32 s22, s9, s10
s_add_u32 s23, s9, s11
s_lshl_b32 s10, s5, 15
s_add_u32 s10, s10, 0x3c00000
s_lshr_b32 s8, s8, 7
s_lshr_b32 s9, s9, 7
s_add_u32 s8, s8, s10
s_add_u32 s9, s9, s10
v_add_u32 v10, s8, v16
v_add_u32 v11, s9, v16
s_cmp_lt_u32 s4, 2
s_cselect_b32 s8, s8, s9
s_and_b32 s9, s4, 1
s_lshl_b32 s9, s9, 10
s_add_u32 s8, s8, s9
v_add_u32 v4, s8, v16
v_lshrrev_b32 v17, 2, v0
s_lshl_b32 s8, s4, 4
v_add_u32 v17, s8, v17
v_mul_u32_u24 v17, 0x1800, v17
v_and_b32 v18, 3, v0
v_lshlrev_b32 v18, 4, v18
v_and_b32 v19, 32, v0
v_xor_b32 v18, v18, v19
s_lshl_b32 s8, s5, 6
v_add3_u32 v7, v17, v18, s8
v_lshl_add_u32 v22, s43, 7, v22
v_lshl_add_u32 v23, s43, 7, v23
v_lshl_add_u32 v7, s43, 18, v7
v_lshl_add_u32 v7, s43, 17, v7
v_and_b32 v17, 15, v0
v_lshrrev_b32 v18, 1, v17
v_lshrrev_b32 v19, 4, v0
v_xor_b32 v18, v18, v19
v_lshlrev_b32 v18, 4, v18
v_lshl_add_u32 v8, v17, 7, v18
v_add_u32 v8, s16, v8
v_xor_b32 v9, 64, v8
v_lshrrev_b32 v17, 4, v0
v_lshlrev_b32 v18, 11, v17
v_and_b32 v17, 1, v17
v_lshl_add_u32 v18, v17, 5, v18
v_bfe_u32 v17, v0, 2, 2
v_lshl_add_u32 v18, v17, 6, v18
v_and_b32 v17, 3, v0
v_lshl_add_u32 v12, v17, 3, v18
v_xor_b32 v13, 32, v12
v_lshrrev_b32 v17, 4, v0
v_lshlrev_b32 v18, 9, v17
v_and_b32 v17, 1, v17
v_lshl_add_u32 v18, v17, 5, v18
v_bfe_u32 v17, v0, 2, 2
v_lshl_add_u32 v18, v17, 6, v18
v_and_b32 v17, 3, v0
v_lshl_add_u32 v14, v17, 3, v18
v_accvgpr_write_b32 a64, -1
v_accvgpr_write_b32 a65, -1
v_accvgpr_write_b32 a66, -1
v_accvgpr_write_b32 a67, -1
v_add_u32 v14, 81920, v14
v_xor_b32 v15, 32, v14
s_mul_i32 s32, s5, 0x10c400
s_lshl_b32 s19, s4, 13
s_add_u32 s32, s32, s19
s_cmp_eq_u32 s4, 0
s_cselect_b32 s94, 0x200000, 0
s_add_u32 s32, s32, s94
s_sub_u32 s94, 0x8000, s94
s_add_u32 s7, s32, 0x1000
s_add_u32 s27, s19, 131072
s_add_u32 m0, s16, 0x8000
s_nop 0
buffer_load_dwordx4 v2, s[48:51], 0 offen lds
s_add_u32 m0, s16, 0x8400
s_nop 0
buffer_load_dwordx4 v3, s[48:51], 0 offen lds
s_add_u32 m0, s16, 0x8800
s_nop 0
buffer_load_dwordx4 v2, s[48:51], s12 offen lds
s_add_u32 m0, s16, 0x8c00
s_nop 0
buffer_load_dwordx4 v3, s[48:51], s12 offen lds
s_add_u32 m0, s16, 0x9000
s_nop 0
buffer_load_dwordx4 v2, s[48:51], s13 offen lds
s_add_u32 m0, s16, 0x9400
s_nop 0
buffer_load_dwordx4 v3, s[48:51], s13 offen lds
s_add_u32 m0, s16, 0x9800
s_nop 0
buffer_load_dwordx4 v2, s[48:51], s14 offen lds
s_add_u32 m0, s16, 0x9c00
s_nop 0
buffer_load_dwordx4 v3, s[48:51], s14 offen lds
v_lshl_add_u32 v2, s42, 7, v2
v_lshl_add_u32 v3, s42, 7, v3
s_mov_b32 s9, 0x0
s_nop 0
buffer_load_dword a120, v62, s[48:51], s9 offen
L_hopA:
s_mov_b32 s95, 1
s_cmp_eq_u32 s4, 0
s_cbranch_scc1 L_padA0
s_cmp_eq_u32 s4, 1
s_cbranch_scc1 L_padA1
s_cmp_eq_u32 s4, 2
s_cbranch_scc1 L_padA2
s_branch L_padA3
L_hopA_ret:
s_mov_b32 s95, 0
v_mov_b32 v19, v62
v_mov_b32 v18, v63
s_cmp_lg_u32 s4, 0
s_cbranch_scc1 L_flag_clr
s_lshl_b32 s8, s6, 5
s_add_u32 s8, s8, s5
s_and_b32 s92, s8, 0xf0
s_mul_i32 s92, s92, 3
s_add_u32 s8, s8, s92
s_lshl_b32 s8, s8, 2
s_add_u32 s8, s8, 0x3704000
v_mov_b32 v17, 0
s_mov_b64 exec, 1
buffer_store_dword v17, off, s[88:91], s8 sc1
s_mov_b64 exec, -1
L_flag_clr:
s_waitcnt vmcnt(9)
s_barrier
s_branch L_main
.p2align 12
L_page0:
L_padA0:
s_branch L_padA4
L_main:
ds_read_b64_tr_b16 a[80:81], v12 offset:0
ds_read_b64_tr_b16 a[82:83], v12 offset:1024
ds_read_b64_tr_b16 a[84:85], v12 offset:8192
ds_read_b64_tr_b16 a[86:87], v12 offset:9216
ds_read_b128 a[0:3], v8 offset:0
ds_read_b128 a[16:19], v9 offset:0
ds_read_b128 a[4:7], v8 offset:2048
ds_read_b128 a[20:23], v9 offset:2048
ds_read_b128 a[8:11], v8 offset:4096
ds_read_b128 a[24:27], v9 offset:4096
ds_read_b128 a[12:15], v8 offset:6144
ds_read_b128 a[28:31], v9 offset:6144
ds_read_b64_tr_b16 a[88:89], v13 offset:0
ds_read_b64_tr_b16 a[90:91], v13 offset:1024
ds_read_b64_tr_b16 a[92:93], v13 offset:8192
ds_read_b64_tr_b16 a[94:95], v13 offset:9216
ds_read_b64_tr_b16 a[96:97], v12 offset:256
ds_read_b64_tr_b16 a[98:99], v12 offset:1280
ds_read_b64_tr_b16 a[100:101], v12 offset:8448
ds_read_b64_tr_b16 a[102:103], v12 offset:9472
s_waitcnt lgkmcnt(0)
L_S0:
v_mfma_f32_16x16x32_bf16 v[24:27], a[80:83], a[0:3], 0
ds_read_b64_tr_b16 a[104:105], v13 offset:256
s_add_u32 m0, s17, 0x8000
v_mfma_f32_16x16x32_bf16 v[24:27], a[84:87], a[16:19], v[24:27]
buffer_load_dwordx4 v5, s[56:59], 0 offen lds
v_mfma_f32_16x16x32_bf16 v[32:35], a[84:87], a[20:23], 0
ds_read_b64_tr_b16 a[106:107], v13 offset:1280
v_mfma_f32_16x16x32_bf16 v[32:35], a[80:83], a[4:7], v[32:35]
ds_read_b64_tr_b16 a[108:109], v13 offset:8448
v_mfma_f32_16x16x32_bf16 v[40:43], a[80:83], a[8:11], 0
ds_read_b64_tr_b16 a[110:111], v13 offset:9472
v_mfma_f32_16x16x32_bf16 v[40:43], a[84:87], a[24:27], v[40:43]
s_add_u32 m0, s17, 0xc000
v_mfma_f32_16x16x32_bf16 v[48:51], a[84:87], a[28:31], 0
buffer_load_dwordx4 v5, s[60:63], 0 offen lds
v_mfma_f32_16x16x32_bf16 v[48:51], a[80:83], a[12:15], v[48:51]
v_mfma_f32_16x16x32_bf16 v[52:55], a[88:91], a[12:15], 0
ds_read_b64_tr_b16 a[80:81], v12 offset:512
v_mfma_f32_16x16x32_bf16 v[52:55], a[92:95], a[28:31], v[52:55]
ds_read_b64_tr_b16 a[82:83], v12 offset:1536
v_mfma_f32_16x16x32_bf16 v[44:47], a[92:95], a[24:27], 0
ds_read_b64_tr_b16 a[84:85], v12 offset:8704
s_add_u32 m0, s17, 0x8400
v_mfma_f32_16x16x32_bf16 v[44:47], a[88:91], a[8:11], v[44:47]
buffer_load_dwordx4 v5, s[56:59], s13 offen lds
v_mfma_f32_16x16x32_bf16 v[36:39], a[88:91], a[4:7], 0
ds_read_b64_tr_b16 a[86:87], v12 offset:9728
v_mfma_f32_16x16x32_bf16 v[36:39], a[92:95], a[20:23], v[36:39]
v_mfma_f32_16x16x32_bf16 v[28:31], a[92:95], a[16:19], 0
v_mfma_f32_16x16x32_bf16 v[28:31], a[88:91], a[0:3], v[28:31]
s_add_u32 m0, s17, 0xc400
v_mfma_f32_16x16x32_bf16 v[56:59], a[96:99], a[0:3], 0
buffer_load_dwordx4 v5, s[60:63], s13 offen lds
v_mfma_f32_16x16x32_bf16 v[56:59], a[100:103], a[16:19], v[56:59]
ds_read_b64_tr_b16 a[88:89], v13 offset:512
v_mfma_f32_16x16x32_bf16 v[64:67], a[100:103], a[20:23], 0
ds_read_b64_tr_b16 a[90:91], v13 offset:1536
v_mfma_f32_16x16x32_bf16 v[64:67], a[96:99], a[4:7], v[64:67]
ds_read_b64_tr_b16 a[92:93], v13 offset:8704
v_mfma_f32_16x16x32_bf16 v[72:75], a[96:99], a[8:11], 0
ds_read_b64_tr_b16 a[94:95], v13 offset:9728
s_add_u32 m0, s17, 0x8800
v_mfma_f32_16x16x32_bf16 v[72:75], a[100:103], a[24:27], v[72:75]
buffer_load_dwordx4 v6, s[56:59], 0 offen lds
v_mfma_f32_16x16x32_bf16 v[80:83], a[100:103], a[28:31], 0
v_mfma_f32_16x16x32_bf16 v[80:83], a[96:99], a[12:15], v[80:83]
s_waitcnt lgkmcnt(10)
v_mfma_f32_16x16x32_bf16 v[84:87], a[104:107], a[12:15], 0
ds_read_b64_tr_b16 a[96:97], v12 offset:768
s_waitcnt lgkmcnt(9)
v_mfma_f32_16x16x32_bf16 v[84:87], a[108:111], a[28:31], v[84:87]
ds_read_b64_tr_b16 a[98:99], v12 offset:1792
s_add_u32 m0, s17, 0xc800
v_mfma_f32_16x16x32_bf16 v[76:79], a[108:111], a[24:27], 0
buffer_load_dwordx4 v6, s[60:63], 0 offen lds
v_mfma_f32_16x16x32_bf16 v[76:79], a[104:107], a[8:11], v[76:79]
ds_read_b64_tr_b16 a[100:101], v12 offset:8960
v_mfma_f32_16x16x32_bf16 v[68:71], a[104:107], a[4:7], 0
ds_read_b64_tr_b16 a[102:103], v12 offset:9984
v_mfma_f32_16x16x32_bf16 v[68:71], a[108:111], a[20:23], v[68:71]
v_mfma_f32_16x16x32_bf16 v[60:63], a[108:111], a[16:19], 0
s_add_u32 m0, s17, 0x8c00
s_waitcnt lgkmcnt(4)
v_mfma_f32_16x16x32_bf16 v[60:63], a[104:107], a[0:3], v[60:63]
buffer_load_dwordx4 v6, s[56:59], s13 offen lds
v_mfma_f32_16x16x32_bf16 v[88:91], a[80:83], a[0:3], 0
ds_read_b64_tr_b16 a[104:105], v13 offset:768
v_mfma_f32_16x16x32_bf16 v[88:91], a[84:87], a[16:19], v[88:91]
ds_read_b64_tr_b16 a[106:107], v13 offset:1792
v_mfma_f32_16x16x32_bf16 v[96:99], a[84:87], a[20:23], 0
ds_read_b64_tr_b16 a[108:109], v13 offset:8960
v_mfma_f32_16x16x32_bf16 v[96:99], a[80:83], a[4:7], v[96:99]
ds_read_b64_tr_b16 a[110:111], v13 offset:9984
s_add_u32 m0, s17, 0xcc00
v_mfma_f32_16x16x32_bf16 v[104:107], a[80:83], a[8:11], 0
buffer_load_dwordx4 v6, s[60:63], s13 offen lds
v_mfma_f32_16x16x32_bf16 v[104:107], a[84:87], a[24:27], v[104:107]
v_lshl_add_u32 v5, s42, 19, v5
v_lshl_add_u32 v6, s42, 19, v6
v_mfma_f32_16x16x32_bf16 v[112:115], a[84:87], a[28:31], 0
v_mfma_f32_16x16x32_bf16 v[112:115], a[80:83], a[12:15], v[112:115]
v_mfma_f32_16x16x32_bf16 v[116:119], a[88:91], a[12:15], 0
ds_read_b64_tr_b16 a[80:81], v12 offset:16384
s_add_u32 m0, s16, 0x0
v_mfma_f32_16x16x32_bf16 v[116:119], a[92:95], a[28:31], v[116:119]
buffer_load_dwordx4 v2, s[48:51], 0 offen lds
v_mfma_f32_16x16x32_bf16 v[108:111], a[92:95], a[24:27], 0
ds_read_b64_tr_b16 a[82:83], v12 offset:17408
v_mfma_f32_16x16x32_bf16 v[108:111], a[88:91], a[8:11], v[108:111]
ds_read_b64_tr_b16 a[84:85], v12 offset:24576
v_mfma_f32_16x16x32_bf16 v[100:103], a[88:91], a[4:7], 0
ds_read_b64_tr_b16 a[86:87], v12 offset:25600
v_mfma_f32_16x16x32_bf16 v[100:103], a[92:95], a[20:23], v[100:103]
s_add_u32 m0, s16, 0x400
v_mfma_f32_16x16x32_bf16 v[92:95], a[92:95], a[16:19], 0
buffer_load_dwordx4 v3, s[48:51], 0 offen lds
v_mfma_f32_16x16x32_bf16 v[92:95], a[88:91], a[0:3], v[92:95]
s_waitcnt lgkmcnt(4)
v_mfma_f32_16x16x32_bf16 v[120:123], a[96:99], a[0:3], 0
ds_read_b64_tr_b16 a[88:89], v13 offset:16384
s_waitcnt vmcnt(11)
v_mfma_f32_16x16x32_bf16 v[120:123], a[100:103], a[16:19], v[120:123]
ds_read_b64_tr_b16 a[90:91], v13 offset:17408
v_mfma_f32_16x16x32_bf16 v[128:131], a[100:103], a[20:23], 0
ds_read_b64_tr_b16 a[92:93], v13 offset:24576
s_add_u32 m0, s16, 0x800
v_mfma_f32_16x16x32_bf16 v[128:131], a[96:99], a[4:7], v[128:131]
buffer_load_dwordx4 v2, s[48:51], s12 offen lds
v_mfma_f32_16x16x32_bf16 v[136:139], a[96:99], a[8:11], 0
ds_read_b64_tr_b16 a[94:95], v13 offset:25600
v_mfma_f32_16x16x32_bf16 v[136:139], a[100:103], a[24:27], v[136:139]
ds_read_b128 a[32:35], v8 offset:32768
v_mfma_f32_16x16x32_bf16 v[144:147], a[100:103], a[28:31], 0
ds_read_b128 a[48:51], v9 offset:32768
v_mfma_f32_16x16x32_bf16 v[144:147], a[96:99], a[12:15], v[144:147]
ds_read_b128 a[36:39], v8 offset:34816
s_add_u32 m0, s16, 0xc00
v_mfma_f32_16x16x32_bf16 v[148:151], a[104:107], a[12:15], 0
buffer_load_dwordx4 v3, s[48:51], s12 offen lds
v_mfma_f32_16x16x32_bf16 v[148:151], a[108:111], a[28:31], v[148:151]
ds_read_b64_tr_b16 a[96:97], v12 offset:16640
v_mfma_f32_16x16x32_bf16 v[140:143], a[108:111], a[24:27], 0
ds_read_b64_tr_b16 a[98:99], v12 offset:17664
v_mfma_f32_16x16x32_bf16 v[140:143], a[104:107], a[8:11], v[140:143]
ds_read_b64_tr_b16 a[100:101], v12 offset:24832
v_mfma_f32_16x16x32_bf16 v[132:135], a[104:107], a[4:7], 0
ds_read_b64_tr_b16 a[102:103], v12 offset:25856
s_add_u32 m0, s16, 0x1000
v_mfma_f32_16x16x32_bf16 v[132:135], a[108:111], a[20:23], v[132:135]
buffer_load_dwordx4 v2, s[48:51], s13 offen lds
v_mfma_f32_16x16x32_bf16 v[124:127], a[108:111], a[16:19], 0
ds_read_b128 a[52:55], v9 offset:34816
v_mfma_f32_16x16x32_bf16 v[124:127], a[104:107], a[0:3], v[124:127]
ds_read_b128 a[40:43], v8 offset:36864
s_waitcnt lgkmcnt(9)
v_mfma_f32_16x16x32_bf16 v[152:155], a[0:3], a[80:83], 0
ds_read_b64_tr_b16 a[104:105], v13 offset:16640
v_mfma_f32_16x16x32_bf16 v[152:155], a[16:19], a[84:87], v[152:155]
ds_read_b64_tr_b16 a[106:107], v13 offset:17664
s_add_u32 m0, s16, 0x1400
v_mfma_f32_16x16x32_bf16 v[156:159], a[20:23], a[84:87], 0
buffer_load_dwordx4 v3, s[48:51], s13 offen lds
v_mfma_f32_16x16x32_bf16 v[156:159], a[4:7], a[80:83], v[156:159]
ds_read_b64_tr_b16 a[108:109], v13 offset:24832
v_mfma_f32_16x16x32_bf16 v[160:163], a[8:11], a[80:83], 0
ds_read_b64_tr_b16 a[110:111], v13 offset:25856
v_mfma_f32_16x16x32_bf16 v[160:163], a[24:27], a[84:87], v[160:163]
ds_read_b128 a[56:59], v9 offset:36864
v_mfma_f32_16x16x32_bf16 v[164:167], a[28:31], a[84:87], 0
ds_read_b128 a[44:47], v8 offset:38912
s_add_u32 m0, s16, 0x1800
v_mfma_f32_16x16x32_bf16 v[164:167], a[12:15], a[80:83], v[164:167]
buffer_load_dwordx4 v2, s[48:51], s14 offen lds
v_mfma_f32_16x16x32_bf16 v[180:183], a[12:15], a[88:91], 0
ds_read_b64_tr_b16 a[80:81], v12 offset:16896
v_mfma_f32_16x16x32_bf16 v[180:183], a[28:31], a[92:95], v[180:183]
ds_read_b64_tr_b16 a[82:83], v12 offset:17920
v_mfma_f32_16x16x32_bf16 v[176:179], a[24:27], a[92:95], 0
ds_read_b64_tr_b16 a[84:85], v12 offset:25088
v_mfma_f32_16x16x32_bf16 v[176:179], a[8:11], a[88:91], v[176:179]
ds_read_b64_tr_b16 a[86:87], v12 offset:26112
s_add_u32 m0, s16, 0x1c00
v_mfma_f32_16x16x32_bf16 v[172:175], a[4:7], a[88:91], 0
buffer_load_dwordx4 v3, s[48:51], s14 offen lds
v_mfma_f32_16x16x32_bf16 v[172:175], a[20:23], a[92:95], v[172:175]
ds_read_b128 a[60:63], v9 offset:38912
v_lshl_add_u32 v2, s42, 7, v2
v_mfma_f32_16x16x32_bf16 v[168:171], a[16:19], a[92:95], 0
v_lshl_add_u32 v3, s42, 7, v3
v_mfma_f32_16x16x32_bf16 v[168:171], a[0:3], a[88:91], v[168:171]
s_waitcnt lgkmcnt(7)
v_mfma_f32_16x16x32_bf16 v[184:187], a[0:3], a[96:99], 0
ds_read_b64_tr_b16 a[88:89], v13 offset:16896
s_add_u32 m0, s17, 0x10000
v_mfma_f32_16x16x32_bf16 v[184:187], a[16:19], a[100:103], v[184:187]
buffer_load_dwordx4 v5, s[56:59], 0 offen lds
v_mfma_f32_16x16x32_bf16 v[188:191], a[20:23], a[100:103], 0
ds_read_b64_tr_b16 a[90:91], v13 offset:17920
v_mfma_f32_16x16x32_bf16 v[188:191], a[4:7], a[96:99], v[188:191]
ds_read_b64_tr_b16 a[92:93], v13 offset:25088
v_mfma_f32_16x16x32_bf16 v[192:195], a[8:11], a[96:99], 0
ds_read_b64_tr_b16 a[94:95], v13 offset:26112
v_mfma_f32_16x16x32_bf16 v[192:195], a[24:27], a[100:103], v[192:195]
s_add_u32 m0, s17, 0x14000
v_mfma_f32_16x16x32_bf16 v[196:199], a[28:31], a[100:103], 0
buffer_load_dwordx4 v5, s[60:63], 0 offen lds
v_mfma_f32_16x16x32_bf16 v[196:199], a[12:15], a[96:99], v[196:199]
v_mfma_f32_16x16x32_bf16 v[212:215], a[12:15], a[104:107], 0
ds_read_b64_tr_b16 a[96:97], v12 offset:17152
v_mfma_f32_16x16x32_bf16 v[212:215], a[28:31], a[108:111], v[212:215]
ds_read_b64_tr_b16 a[98:99], v12 offset:18176
v_mfma_f32_16x16x32_bf16 v[208:211], a[24:27], a[108:111], 0
ds_read_b64_tr_b16 a[100:101], v12 offset:25344
s_add_u32 m0, s17, 0x10400
v_mfma_f32_16x16x32_bf16 v[208:211], a[8:11], a[104:107], v[208:211]
buffer_load_dwordx4 v5, s[56:59], s13 offen lds
v_mfma_f32_16x16x32_bf16 v[204:207], a[4:7], a[104:107], 0
ds_read_b64_tr_b16 a[102:103], v12 offset:26368
v_mfma_f32_16x16x32_bf16 v[204:207], a[20:23], a[108:111], v[204:207]
v_mfma_f32_16x16x32_bf16 v[200:203], a[16:19], a[108:111], 0
v_mfma_f32_16x16x32_bf16 v[200:203], a[0:3], a[104:107], v[200:203]
s_add_u32 m0, s17, 0x14400
s_waitcnt lgkmcnt(4)
v_mfma_f32_16x16x32_bf16 v[216:219], a[0:3], a[80:83], 0
buffer_load_dwordx4 v5, s[60:63], s13 offen lds
v_mfma_f32_16x16x32_bf16 v[216:219], a[16:19], a[84:87], v[216:219]
ds_read_b64_tr_b16 a[104:105], v13 offset:17152
v_mfma_f32_16x16x32_bf16 v[220:223], a[20:23], a[84:87], 0
ds_read_b64_tr_b16 a[106:107], v13 offset:18176
v_mfma_f32_16x16x32_bf16 v[220:223], a[4:7], a[80:83], v[220:223]
ds_read_b64_tr_b16 a[108:109], v13 offset:25344
v_mfma_f32_16x16x32_bf16 v[224:227], a[8:11], a[80:83], 0
ds_read_b64_tr_b16 a[110:111], v13 offset:26368
s_add_u32 m0, s17, 0x10800
v_mfma_f32_16x16x32_bf16 v[224:227], a[24:27], a[84:87], v[224:227]
buffer_load_dwordx4 v6, s[56:59], 0 offen lds
v_mfma_f32_16x16x32_bf16 v[228:231], a[28:31], a[84:87], 0
v_add_u32 v12, 0x8000, v12
v_add_u32 v13, 0x8000, v13
v_mfma_f32_16x16x32_bf16 v[228:231], a[12:15], a[80:83], v[228:231]
v_mfma_f32_16x16x32_bf16 v[244:247], a[12:15], a[88:91], 0
s_waitcnt vmcnt(13) lgkmcnt(0)
v_mfma_f32_16x16x32_bf16 v[244:247], a[28:31], a[92:95], v[244:247]
s_barrier
s_add_u32 m0, s17, 0x14800
v_mfma_f32_16x16x32_bf16 v[240:243], a[24:27], a[92:95], 0
buffer_load_dwordx4 v6, s[60:63], 0 offen lds
v_mfma_f32_16x16x32_bf16 v[240:243], a[8:11], a[88:91], v[240:243]
ds_read_b64_tr_b16 a[80:81], v12 offset:0
v_mfma_f32_16x16x32_bf16 v[236:239], a[4:7], a[88:91], 0
ds_read_b64_tr_b16 a[82:83], v12 offset:1024
v_mfma_f32_16x16x32_bf16 v[236:239], a[20:23], a[92:95], v[236:239]
ds_read_b64_tr_b16 a[84:85], v12 offset:8192
s_waitcnt lgkmcnt(3)
v_mfma_f32_16x16x32_bf16 v[232:235], a[16:19], a[92:95], 0
ds_read_b64_tr_b16 a[86:87], v12 offset:9216
s_add_u32 m0, s17, 0x10c00
v_mfma_f32_16x16x32_bf16 v[232:235], a[0:3], a[88:91], v[232:235]
buffer_load_dwordx4 v6, s[56:59], s13 offen lds
v_mfma_f32_16x16x32_bf16 v[248:251], a[0:3], a[96:99], 0
ds_read_b64_tr_b16 a[88:89], v13 offset:0
v_mfma_f32_16x16x32_bf16 v[248:251], a[16:19], a[100:103], v[248:251]
ds_read_b64_tr_b16 a[90:91], v13 offset:1024
v_mfma_f32_16x16x32_bf16 v[252:255], a[20:23], a[100:103], 0
ds_read_b64_tr_b16 a[92:93], v13 offset:8192
v_mfma_f32_16x16x32_bf16 v[252:255], a[4:7], a[96:99], v[252:255]
ds_read_b64_tr_b16 a[94:95], v13 offset:9216
s_add_u32 m0, s17, 0x14c00
v_mfma_f32_16x16x32_bf16 a[232:235], a[8:11], a[96:99], 0
buffer_load_dwordx4 v6, s[60:63], s13 offen lds
v_mfma_f32_16x16x32_bf16 a[232:235], a[24:27], a[100:103], a[232:235]
v_lshl_add_u32 v5, s42, 19, v5
v_lshl_add_u32 v6, s42, 19, v6
v_mfma_f32_16x16x32_bf16 a[236:239], a[28:31], a[100:103], 0
v_mfma_f32_16x16x32_bf16 a[236:239], a[12:15], a[96:99], a[236:239]
s_waitcnt lgkmcnt(15)
v_mfma_f32_16x16x32_bf16 a[252:255], a[12:15], a[104:107], 0
ds_read_b64_tr_b16 a[96:97], v12 offset:256
s_add_u32 m0, s16, 0x8000
v_mfma_f32_16x16x32_bf16 a[252:255], a[28:31], a[108:111], a[252:255]
buffer_load_dwordx4 v2, s[48:51], 0 offen lds
v_mfma_f32_16x16x32_bf16 a[248:251], a[24:27], a[108:111], 0
ds_read_b64_tr_b16 a[98:99], v12 offset:1280
v_mfma_f32_16x16x32_bf16 a[248:251], a[8:11], a[104:107], a[248:251]
ds_read_b64_tr_b16 a[100:101], v12 offset:8448
v_mfma_f32_16x16x32_bf16 a[244:247], a[4:7], a[104:107], 0
ds_read_b64_tr_b16 a[102:103], v12 offset:9472
v_mfma_f32_16x16x32_bf16 a[244:247], a[20:23], a[108:111], a[244:247]
s_add_u32 m0, s16, 0x8400
v_mfma_f32_16x16x32_bf16 a[240:243], a[16:19], a[108:111], 0
buffer_load_dwordx4 v3, s[48:51], 0 offen lds
v_mfma_f32_16x16x32_bf16 a[240:243], a[0:3], a[104:107], a[240:243]
s_waitcnt lgkmcnt(4)
L_S1:
v_mfma_f32_16x16x32_bf16 v[24:27], a[80:83], a[32:35], v[24:27]
ds_read_b64_tr_b16 a[104:105], v13 offset:256
v_mfma_f32_16x16x32_bf16 v[24:27], a[84:87], a[48:51], v[24:27]
ds_read_b64_tr_b16 a[106:107], v13 offset:1280
v_mfma_f32_16x16x32_bf16 v[32:35], a[84:87], a[52:55], v[32:35]
ds_read_b64_tr_b16 a[108:109], v13 offset:8448
s_add_u32 m0, s16, 0x8800
v_mfma_f32_16x16x32_bf16 v[32:35], a[80:83], a[36:39], v[32:35]
buffer_load_dwordx4 v2, s[48:51], s12 offen lds
v_mfma_f32_16x16x32_bf16 v[40:43], a[80:83], a[40:43], v[40:43]
ds_read_b64_tr_b16 a[110:111], v13 offset:9472
v_mfma_f32_16x16x32_bf16 v[40:43], a[84:87], a[56:59], v[40:43]
v_mfma_f32_16x16x32_bf16 v[48:51], a[84:87], a[60:63], v[48:51]
v_mfma_f32_16x16x32_bf16 v[48:51], a[80:83], a[44:47], v[48:51]
s_add_u32 m0, s16, 0x8c00
v_mfma_f32_16x16x32_bf16 v[52:55], a[88:91], a[44:47], v[52:55]
buffer_load_dwordx4 v3, s[48:51], s12 offen lds
v_mfma_f32_16x16x32_bf16 v[52:55], a[92:95], a[60:63], v[52:55]
ds_read_b64_tr_b16 a[80:81], v12 offset:512
v_mfma_f32_16x16x32_bf16 v[44:47], a[92:95], a[56:59], v[44:47]
ds_read_b64_tr_b16 a[82:83], v12 offset:1536
v_mfma_f32_16x16x32_bf16 v[44:47], a[88:91], a[40:43], v[44:47]
ds_read_b64_tr_b16 a[84:85], v12 offset:8704
v_mfma_f32_16x16x32_bf16 v[36:39], a[88:91], a[36:39], v[36:39]
ds_read_b64_tr_b16 a[86:87], v12 offset:9728
s_add_u32 m0, s16, 0x9000
v_mfma_f32_16x16x32_bf16 v[36:39], a[92:95], a[52:55], v[36:39]
buffer_load_dwordx4 v2, s[48:51], s13 offen lds
v_mfma_f32_16x16x32_bf16 v[28:31], a[92:95], a[48:51], v[28:31]
v_mfma_f32_16x16x32_bf16 v[28:31], a[88:91], a[32:35], v[28:31]
s_waitcnt lgkmcnt(4)
v_mfma_f32_16x16x32_bf16 v[56:59], a[96:99], a[32:35], v[56:59]
ds_read_b64_tr_b16 a[88:89], v13 offset:512
v_mfma_f32_16x16x32_bf16 v[56:59], a[100:103], a[48:51], v[56:59]
ds_read_b64_tr_b16 a[90:91], v13 offset:1536
s_add_u32 m0, s16, 0x9400
v_mfma_f32_16x16x32_bf16 v[64:67], a[100:103], a[52:55], v[64:67]
buffer_load_dwordx4 v3, s[48:51], s13 offen lds
v_mfma_f32_16x16x32_bf16 v[64:67], a[96:99], a[36:39], v[64:67]
ds_read_b64_tr_b16 a[92:93], v13 offset:8704
v_mfma_f32_16x16x32_bf16 v[72:75], a[96:99], a[40:43], v[72:75]
ds_read_b64_tr_b16 a[94:95], v13 offset:9728
v_mfma_f32_16x16x32_bf16 v[72:75], a[100:103], a[56:59], v[72:75]
v_mfma_f32_16x16x32_bf16 v[80:83], a[100:103], a[60:63], v[80:83]
s_add_u32 m0, s16, 0x9800
v_mfma_f32_16x16x32_bf16 v[80:83], a[96:99], a[44:47], v[80:83]
buffer_load_dwordx4 v2, s[48:51], s14 offen lds
v_mfma_f32_16x16x32_bf16 v[84:87], a[104:107], a[44:47], v[84:87]
ds_read_b64_tr_b16 a[96:97], v12 offset:768
v_mfma_f32_16x16x32_bf16 v[84:87], a[108:111], a[60:63], v[84:87]
ds_read_b64_tr_b16 a[98:99], v12 offset:1792
v_mfma_f32_16x16x32_bf16 v[76:79], a[108:111], a[56:59], v[76:79]
ds_read_b64_tr_b16 a[100:101], v12 offset:8960
v_mfma_f32_16x16x32_bf16 v[76:79], a[104:107], a[40:43], v[76:79]
ds_read_b64_tr_b16 a[102:103], v12 offset:9984
s_add_u32 m0, s16, 0x9c00
v_mfma_f32_16x16x32_bf16 v[68:71], a[104:107], a[36:39], v[68:71]
buffer_load_dwordx4 v3, s[48:51], s14 offen lds
v_mfma_f32_16x16x32_bf16 v[68:71], a[108:111], a[52:55], v[68:71]
v_lshl_add_u32 v2, s42, 7, v2
v_lshl_add_u32 v3, s42, 7, v3
v_mfma_f32_16x16x32_bf16 v[60:63], a[108:111], a[48:51], v[60:63]
v_mfma_f32_16x16x32_bf16 v[60:63], a[104:107], a[32:35], v[60:63]
s_add_u32 m0, s17, 0x0
s_waitcnt lgkmcnt(4)
v_mfma_f32_16x16x32_bf16 v[88:91], a[80:83], a[32:35], v[88:91]
ds_read_b64_tr_b16 a[104:105], v13 offset:768
s_waitcnt vmcnt(16)
v_mfma_f32_16x16x32_bf16 v[88:91], a[84:87], a[48:51], v[88:91]
buffer_load_dwordx4 v5, s[56:59], 0 offen lds
v_mfma_f32_16x16x32_bf16 v[96:99], a[84:87], a[52:55], v[96:99]
ds_read_b64_tr_b16 a[106:107], v13 offset:1792
v_mfma_f32_16x16x32_bf16 v[96:99], a[80:83], a[36:39], v[96:99]
ds_read_b64_tr_b16 a[108:109], v13 offset:8960
v_mfma_f32_16x16x32_bf16 v[104:107], a[80:83], a[40:43], v[104:107]
ds_read_b64_tr_b16 a[110:111], v13 offset:9984
v_mfma_f32_16x16x32_bf16 v[104:107], a[84:87], a[56:59], v[104:107]
ds_read_b128 a[0:3], v8 offset:0
s_add_u32 m0, s17, 0x4000
v_mfma_f32_16x16x32_bf16 v[112:115], a[84:87], a[60:63], v[112:115]
buffer_load_dwordx4 v5, s[60:63], 0 offen lds
v_mfma_f32_16x16x32_bf16 v[112:115], a[80:83], a[44:47], v[112:115]
ds_read_b128 a[16:19], v9 offset:0
v_mfma_f32_16x16x32_bf16 v[116:119], a[88:91], a[44:47], v[116:119]
ds_read_b64_tr_b16 a[80:81], v12 offset:16384
v_mfma_f32_16x16x32_bf16 v[116:119], a[92:95], a[60:63], v[116:119]
ds_read_b64_tr_b16 a[82:83], v12 offset:17408
v_mfma_f32_16x16x32_bf16 v[108:111], a[92:95], a[56:59], v[108:111]
ds_read_b64_tr_b16 a[84:85], v12 offset:24576
s_add_u32 m0, s17, 0x400
v_mfma_f32_16x16x32_bf16 v[108:111], a[88:91], a[40:43], v[108:111]
buffer_load_dwordx4 v5, s[56:59], s13 offen lds
v_mfma_f32_16x16x32_bf16 v[100:103], a[88:91], a[36:39], v[100:103]
ds_read_b64_tr_b16 a[86:87], v12 offset:25600
v_mfma_f32_16x16x32_bf16 v[100:103], a[92:95], a[52:55], v[100:103]
ds_read_b128 a[4:7], v8 offset:2048
v_mfma_f32_16x16x32_bf16 v[92:95], a[92:95], a[48:51], v[92:95]
ds_read_b128 a[20:23], v9 offset:2048
s_waitcnt lgkmcnt(8)
v_mfma_f32_16x16x32_bf16 v[92:95], a[88:91], a[32:35], v[92:95]
ds_read_b128 a[8:11], v8 offset:4096
s_add_u32 m0, s17, 0x4400
v_mfma_f32_16x16x32_bf16 v[120:123], a[96:99], a[32:35], v[120:123]
buffer_load_dwordx4 v5, s[60:63], s13 offen lds
v_mfma_f32_16x16x32_bf16 v[120:123], a[100:103], a[48:51], v[120:123]
ds_read_b64_tr_b16 a[88:89], v13 offset:16384
v_mfma_f32_16x16x32_bf16 v[128:131], a[100:103], a[52:55], v[128:131]
ds_read_b64_tr_b16 a[90:91], v13 offset:17408
v_mfma_f32_16x16x32_bf16 v[128:131], a[96:99], a[36:39], v[128:131]
ds_read_b64_tr_b16 a[92:93], v13 offset:24576
v_mfma_f32_16x16x32_bf16 v[136:139], a[96:99], a[40:43], v[136:139]
ds_read_b64_tr_b16 a[94:95], v13 offset:25600
s_add_u32 m0, s17, 0x800
v_mfma_f32_16x16x32_bf16 v[136:139], a[100:103], a[56:59], v[136:139]
buffer_load_dwordx4 v6, s[56:59], 0 offen lds
v_mfma_f32_16x16x32_bf16 v[144:147], a[100:103], a[60:63], v[144:147]
ds_read_b128 a[24:27], v9 offset:4096
v_mfma_f32_16x16x32_bf16 v[144:147], a[96:99], a[44:47], v[144:147]
ds_read_b128 a[12:15], v8 offset:6144
v_mfma_f32_16x16x32_bf16 v[148:151], a[104:107], a[44:47], v[148:151]
ds_read_b64_tr_b16 a[96:97], v12 offset:16640
v_mfma_f32_16x16x32_bf16 v[148:151], a[108:111], a[60:63], v[148:151]
ds_read_b64_tr_b16 a[98:99], v12 offset:17664
s_add_u32 m0, s17, 0x4800
v_mfma_f32_16x16x32_bf16 v[140:143], a[108:111], a[56:59], v[140:143]
buffer_load_dwordx4 v6, s[60:63], 0 offen lds
v_mfma_f32_16x16x32_bf16 v[140:143], a[104:107], a[40:43], v[140:143]
ds_read_b64_tr_b16 a[100:101], v12 offset:24832
v_mfma_f32_16x16x32_bf16 v[132:135], a[104:107], a[36:39], v[132:135]
ds_read_b64_tr_b16 a[102:103], v12 offset:25856
v_mfma_f32_16x16x32_bf16 v[132:135], a[108:111], a[52:55], v[132:135]
ds_read_b128 a[28:31], v9 offset:6144
v_mfma_f32_16x16x32_bf16 v[124:127], a[108:111], a[48:51], v[124:127]
s_add_u32 m0, s17, 0xc00
s_waitcnt lgkmcnt(7)
v_mfma_f32_16x16x32_bf16 v[124:127], a[104:107], a[32:35], v[124:127]
buffer_load_dwordx4 v6, s[56:59], s13 offen lds
v_mfma_f32_16x16x32_bf16 v[152:155], a[32:35], a[80:83], v[152:155]
ds_read_b64_tr_b16 a[104:105], v13 offset:16640
v_mfma_f32_16x16x32_bf16 v[152:155], a[48:51], a[84:87], v[152:155]
ds_read_b64_tr_b16 a[106:107], v13 offset:17664
v_mfma_f32_16x16x32_bf16 v[156:159], a[52:55], a[84:87], v[156:159]
ds_read_b64_tr_b16 a[108:109], v13 offset:24832
v_mfma_f32_16x16x32_bf16 v[156:159], a[36:39], a[80:83], v[156:159]
ds_read_b64_tr_b16 a[110:111], v13 offset:25856
s_add_u32 m0, s17, 0x4c00
v_mfma_f32_16x16x32_bf16 v[160:163], a[40:43], a[80:83], v[160:163]
buffer_load_dwordx4 v6, s[60:63], s13 offen lds
v_mfma_f32_16x16x32_bf16 v[160:163], a[56:59], a[84:87], v[160:163]
v_lshl_add_u32 v5, s42, 19, v5
v_lshl_add_u32 v6, s42, 19, v6
v_mfma_f32_16x16x32_bf16 v[164:167], a[60:63], a[84:87], v[164:167]
v_mfma_f32_16x16x32_bf16 v[164:167], a[44:47], a[80:83], v[164:167]
v_mfma_f32_16x16x32_bf16 v[180:183], a[44:47], a[88:91], v[180:183]
ds_read_b64_tr_b16 a[80:81], v12 offset:16896
s_mov_b32 s9, 0x200000
v_mfma_f32_16x16x32_bf16 v[180:183], a[60:63], a[92:95], v[180:183]
buffer_load_dword a120, v18, s[56:59], s9 offen
v_mfma_f32_16x16x32_bf16 v[176:179], a[56:59], a[92:95], v[176:179]
ds_read_b64_tr_b16 a[82:83], v12 offset:17920
v_mfma_f32_16x16x32_bf16 v[176:179], a[40:43], a[88:91], v[176:179]
ds_read_b64_tr_b16 a[84:85], v12 offset:25088
v_mfma_f32_16x16x32_bf16 v[172:175], a[36:39], a[88:91], v[172:175]
ds_read_b64_tr_b16 a[86:87], v12 offset:26112
v_mfma_f32_16x16x32_bf16 v[172:175], a[52:55], a[92:95], v[172:175]
s_add_u32 m0, s16, 0x0
s_waitcnt lgkmcnt(8)
v_mfma_f32_16x16x32_bf16 v[168:171], a[48:51], a[92:95], v[168:171]
buffer_load_dwordx4 v2, s[48:51], 0 offen lds
v_mfma_f32_16x16x32_bf16 v[168:171], a[32:35], a[88:91], v[168:171]
s_waitcnt lgkmcnt(4)
v_mfma_f32_16x16x32_bf16 v[184:187], a[32:35], a[96:99], v[184:187]
ds_read_b64_tr_b16 a[88:89], v13 offset:16896
v_mfma_f32_16x16x32_bf16 v[184:187], a[48:51], a[100:103], v[184:187]
ds_read_b64_tr_b16 a[90:91], v13 offset:17920
v_mfma_f32_16x16x32_bf16 v[188:191], a[52:55], a[100:103], v[188:191]
ds_read_b64_tr_b16 a[92:93], v13 offset:25088
s_add_u32 m0, s16, 0x400
v_mfma_f32_16x16x32_bf16 v[188:191], a[36:39], a[96:99], v[188:191]
buffer_load_dwordx4 v3, s[48:51], 0 offen lds
v_mfma_f32_16x16x32_bf16 v[192:195], a[40:43], a[96:99], v[192:195]
ds_read_b64_tr_b16 a[94:95], v13 offset:26112
v_mfma_f32_16x16x32_bf16 v[192:195], a[56:59], a[100:103], v[192:195]
v_mfma_f32_16x16x32_bf16 v[196:199], a[60:63], a[100:103], v[196:199]
v_mfma_f32_16x16x32_bf16 v[196:199], a[44:47], a[96:99], v[196:199]
s_add_u32 m0, s16, 0x800
v_mfma_f32_16x16x32_bf16 v[212:215], a[44:47], a[104:107], v[212:215]
buffer_load_dwordx4 v2, s[48:51], s12 offen lds
v_mfma_f32_16x16x32_bf16 v[212:215], a[60:63], a[108:111], v[212:215]
ds_read_b64_tr_b16 a[96:97], v12 offset:17152
v_mfma_f32_16x16x32_bf16 v[208:211], a[56:59], a[108:111], v[208:211]
ds_read_b64_tr_b16 a[98:99], v12 offset:18176
v_mfma_f32_16x16x32_bf16 v[208:211], a[40:43], a[104:107], v[208:211]
ds_read_b64_tr_b16 a[100:101], v12 offset:25344
v_mfma_f32_16x16x32_bf16 v[204:207], a[36:39], a[104:107], v[204:207]
ds_read_b64_tr_b16 a[102:103], v12 offset:26368
s_add_u32 m0, s16, 0xc00
v_mfma_f32_16x16x32_bf16 v[204:207], a[52:55], a[108:111], v[204:207]
buffer_load_dwordx4 v3, s[48:51], s12 offen lds
v_mfma_f32_16x16x32_bf16 v[200:203], a[48:51], a[108:111], v[200:203]
v_mfma_f32_16x16x32_bf16 v[200:203], a[32:35], a[104:107], v[200:203]
s_waitcnt lgkmcnt(4)
v_mfma_f32_16x16x32_bf16 v[216:219], a[32:35], a[80:83], v[216:219]
ds_read_b64_tr_b16 a[104:105], v13 offset:17152
v_mfma_f32_16x16x32_bf16 v[216:219], a[48:51], a[84:87], v[216:219]
ds_read_b64_tr_b16 a[106:107], v13 offset:18176
s_add_u32 m0, s16, 0x1000
v_mfma_f32_16x16x32_bf16 v[220:223], a[52:55], a[84:87], v[220:223]
buffer_load_dwordx4 v2, s[48:51], s13 offen lds
v_mfma_f32_16x16x32_bf16 v[220:223], a[36:39], a[80:83], v[220:223]
ds_read_b64_tr_b16 a[108:109], v13 offset:25344
v_mfma_f32_16x16x32_bf16 v[224:227], a[40:43], a[80:83], v[224:227]
ds_read_b64_tr_b16 a[110:111], v13 offset:26368
v_add_u32 v12, 0x8000, v12
v_mfma_f32_16x16x32_bf16 v[224:227], a[56:59], a[84:87], v[224:227]
v_add_u32 v13, 0x8000, v13
v_mfma_f32_16x16x32_bf16 v[228:231], a[60:63], a[84:87], v[228:231]
s_add_u32 m0, s16, 0x1400
v_mfma_f32_16x16x32_bf16 v[228:231], a[44:47], a[80:83], v[228:231]
buffer_load_dwordx4 v3, s[48:51], s13 offen lds
v_mfma_f32_16x16x32_bf16 v[244:247], a[44:47], a[88:91], v[244:247]
s_waitcnt vmcnt(23) lgkmcnt(0)
v_mfma_f32_16x16x32_bf16 v[244:247], a[60:63], a[92:95], v[244:247]
s_barrier
v_mfma_f32_16x16x32_bf16 v[240:243], a[56:59], a[92:95], v[240:243]
ds_read_b64_tr_b16 a[80:81], v12 offset:0
v_mfma_f32_16x16x32_bf16 v[240:243], a[40:43], a[88:91], v[240:243]
ds_read_b64_tr_b16 a[82:83], v12 offset:1024
s_add_u32 m0, s16, 0x1800
v_mfma_f32_16x16x32_bf16 v[236:239], a[36:39], a[88:91], v[236:239]
buffer_load_dwordx4 v2, s[48:51], s14 offen lds
v_mfma_f32_16x16x32_bf16 v[236:239], a[52:55], a[92:95], v[236:239]
ds_read_b64_tr_b16 a[84:85], v12 offset:8192
v_mfma_f32_16x16x32_bf16 v[232:235], a[48:51], a[92:95], v[232:235]
ds_read_b64_tr_b16 a[86:87], v12 offset:9216
v_mfma_f32_16x16x32_bf16 v[232:235], a[32:35], a[88:91], v[232:235]
L_padA1:
s_cmp_eq_u32 s95, 1
s_cbranch_scc1 L_padA5
s_waitcnt lgkmcnt(4)
v_mfma_f32_16x16x32_bf16 v[248:251], a[32:35], a[96:99], v[248:251]
ds_read_b64_tr_b16 a[88:89], v13 offset:0
s_add_u32 m0, s16, 0x1c00
v_mfma_f32_16x16x32_bf16 v[248:251], a[48:51], a[100:103], v[248:251]
buffer_load_dwordx4 v3, s[48:51], s14 offen lds
v_mfma_f32_16x16x32_bf16 v[252:255], a[52:55], a[100:103], v[252:255]
ds_read_b64_tr_b16 a[90:91], v13 offset:1024
v_lshl_add_u32 v2, s42, 7, v2
v_mfma_f32_16x16x32_bf16 v[252:255], a[36:39], a[96:99], v[252:255]
ds_read_b64_tr_b16 a[92:93], v13 offset:8192
v_lshl_add_u32 v3, s42, 7, v3
v_mfma_f32_16x16x32_bf16 a[232:235], a[40:43], a[96:99], a[232:235]
ds_read_b64_tr_b16 a[94:95], v13 offset:9216
v_mfma_f32_16x16x32_bf16 a[232:235], a[56:59], a[100:103], a[232:235]
s_mov_b32 s9, 0x200000
v_mfma_f32_16x16x32_bf16 a[236:239], a[60:63], a[100:103], a[236:239]
buffer_load_dword a120, v18, s[60:63], s9 offen
v_mfma_f32_16x16x32_bf16 a[236:239], a[44:47], a[96:99], a[236:239]
v_mfma_f32_16x16x32_bf16 a[252:255], a[44:47], a[104:107], a[252:255]
ds_read_b64_tr_b16 a[96:97], v12 offset:256
v_mfma_f32_16x16x32_bf16 a[252:255], a[60:63], a[108:111], a[252:255]
ds_read_b64_tr_b16 a[98:99], v12 offset:1280
v_mfma_f32_16x16x32_bf16 a[248:251], a[56:59], a[108:111], a[248:251]
ds_read_b64_tr_b16 a[100:101], v12 offset:8448
s_add_u32 m0, s17, 0x8000
v_mfma_f32_16x16x32_bf16 a[248:251], a[40:43], a[104:107], a[248:251]
buffer_load_dwordx4 v5, s[56:59], 0 offen lds
v_mfma_f32_16x16x32_bf16 a[244:247], a[36:39], a[104:107], a[244:247]
ds_read_b64_tr_b16 a[102:103], v12 offset:9472
v_mfma_f32_16x16x32_bf16 a[244:247], a[52:55], a[108:111], a[244:247]
v_mfma_f32_16x16x32_bf16 a[240:243], a[48:51], a[108:111], a[240:243]
v_mfma_f32_16x16x32_bf16 a[240:243], a[32:35], a[104:107], a[240:243]
s_add_u32 m0, s17, 0xc000
s_waitcnt lgkmcnt(4)
L_S2:
v_mfma_f32_16x16x32_bf16 v[24:27], a[80:83], a[0:3], v[24:27]
buffer_load_dwordx4 v5, s[60:63], 0 offen lds
v_mfma_f32_16x16x32_bf16 v[24:27], a[84:87], a[16:19], v[24:27]
ds_read_b64_tr_b16 a[104:105], v13 offset:256
s_waitcnt vmcnt(20)
v_mfma_f32_16x16x32_bf16 v[32:35], a[84:87], a[20:23], v[32:35]
ds_read_b64_tr_b16 a[106:107], v13 offset:1280
v_mfma_f32_16x16x32_bf16 v[32:35], a[80:83], a[4:7], v[32:35]
ds_read_b64_tr_b16 a[108:109], v13 offset:8448
v_mfma_f32_16x16x32_bf16 v[40:43], a[80:83], a[8:11], v[40:43]
ds_read_b64_tr_b16 a[110:111], v13 offset:9472
s_add_u32 m0, s17, 0x8400
v_mfma_f32_16x16x32_bf16 v[40:43], a[84:87], a[24:27], v[40:43]
buffer_load_dwordx4 v5, s[56:59], s13 offen lds
v_mfma_f32_16x16x32_bf16 v[48:51], a[84:87], a[28:31], v[48:51]
ds_read_b128 a[32:35], v8 offset:32768
v_mfma_f32_16x16x32_bf16 v[48:51], a[80:83], a[12:15], v[48:51]
ds_read_b128 a[48:51], v9 offset:32768
v_mfma_f32_16x16x32_bf16 v[52:55], a[88:91], a[12:15], v[52:55]
ds_read_b64_tr_b16 a[80:81], v12 offset:512
v_mfma_f32_16x16x32_bf16 v[52:55], a[92:95], a[28:31], v[52:55]
ds_read_b64_tr_b16 a[82:83], v12 offset:1536
s_add_u32 m0, s17, 0xc400
v_mfma_f32_16x16x32_bf16 v[44:47], a[92:95], a[24:27], v[44:47]
buffer_load_dwordx4 v5, s[60:63], s13 offen lds
v_mfma_f32_16x16x32_bf16 v[44:47], a[88:91], a[8:11], v[44:47]
ds_read_b64_tr_b16 a[84:85], v12 offset:8704
v_mfma_f32_16x16x32_bf16 v[36:39], a[88:91], a[4:7], v[36:39]
ds_read_b64_tr_b16 a[86:87], v12 offset:9728
v_mfma_f32_16x16x32_bf16 v[36:39], a[92:95], a[20:23], v[36:39]
ds_read_b128 a[36:39], v8 offset:34816
s_waitcnt lgkmcnt(7)
v_mfma_f32_16x16x32_bf16 v[28:31], a[92:95], a[16:19], v[28:31]
ds_read_b128 a[52:55], v9 offset:34816
s_add_u32 m0, s17, 0x8800
v_mfma_f32_16x16x32_bf16 v[28:31], a[88:91], a[0:3], v[28:31]
buffer_load_dwordx4 v6, s[56:59], 0 offen lds
v_mfma_f32_16x16x32_bf16 v[56:59], a[96:99], a[0:3], v[56:59]
ds_read_b64_tr_b16 a[88:89], v13 offset:512
v_mfma_f32_16x16x32_bf16 v[56:59], a[100:103], a[16:19], v[56:59]
ds_read_b64_tr_b16 a[90:91], v13 offset:1536
v_mfma_f32_16x16x32_bf16 v[64:67], a[100:103], a[20:23], v[64:67]
ds_read_b64_tr_b16 a[92:93], v13 offset:8704
v_mfma_f32_16x16x32_bf16 v[64:67], a[96:99], a[4:7], v[64:67]
ds_read_b64_tr_b16 a[94:95], v13 offset:9728
s_add_u32 m0, s17, 0xc800
v_mfma_f32_16x16x32_bf16 v[72:75], a[96:99], a[8:11], v[72:75]
buffer_load_dwordx4 v6, s[60:63], 0 offen lds
v_mfma_f32_16x16x32_bf16 v[72:75], a[100:103], a[24:27], v[72:75]
ds_read_b128 a[40:43], v8 offset:36864
v_mfma_f32_16x16x32_bf16 v[80:83], a[100:103], a[28:31], v[80:83]
ds_read_b128 a[56:59], v9 offset:36864
v_mfma_f32_16x16x32_bf16 v[80:83], a[96:99], a[12:15], v[80:83]
ds_read_b128 a[44:47], v8 offset:38912
v_mfma_f32_16x16x32_bf16 v[84:87], a[104:107], a[12:15], v[84:87]
ds_read_b64_tr_b16 a[96:97], v12 offset:768
s_add_u32 m0, s17, 0x8c00
v_mfma_f32_16x16x32_bf16 v[84:87], a[108:111], a[28:31], v[84:87]
buffer_load_dwordx4 v6, s[56:59], s13 offen lds
v_mfma_f32_16x16x32_bf16 v[76:79], a[108:111], a[24:27], v[76:79]
ds_read_b64_tr_b16 a[98:99], v12 offset:1792
v_mfma_f32_16x16x32_bf16 v[76:79], a[104:107], a[8:11], v[76:79]
ds_read_b64_tr_b16 a[100:101], v12 offset:8960
v_mfma_f32_16x16x32_bf16 v[68:71], a[104:107], a[4:7], v[68:71]
ds_read_b64_tr_b16 a[102:103], v12 offset:9984
v_mfma_f32_16x16x32_bf16 v[68:71], a[108:111], a[20:23], v[68:71]
ds_read_b128 a[60:63], v9 offset:38912
s_add_u32 m0, s17, 0xcc00
v_mfma_f32_16x16x32_bf16 v[60:63], a[108:111], a[16:19], v[60:63]
buffer_load_dwordx4 v6, s[60:63], s13 offen lds
v_mfma_f32_16x16x32_bf16 v[60:63], a[104:107], a[0:3], v[60:63]
s_waitcnt lgkmcnt(8)
v_lshl_add_u32 v5, s42, 19, v5
v_lshl_add_u32 v6, s42, 19, v6
v_mfma_f32_16x16x32_bf16 v[88:91], a[80:83], a[0:3], v[88:91]
ds_read_b64_tr_b16 a[104:105], v13 offset:768
v_mfma_f32_16x16x32_bf16 v[88:91], a[84:87], a[16:19], v[88:91]
ds_read_b64_tr_b16 a[106:107], v13 offset:1792
v_mfma_f32_16x16x32_bf16 v[96:99], a[84:87], a[20:23], v[96:99]
ds_read_b64_tr_b16 a[108:109], v13 offset:8960
v_mfma_f32_16x16x32_bf16 v[96:99], a[80:83], a[4:7], v[96:99]
ds_read_b64_tr_b16 a[110:111], v13 offset:9984
v_mfma_f32_16x16x32_bf16 v[104:107], a[80:83], a[8:11], v[104:107]
s_add_u32 m0, s16, 0x8000
s_waitcnt lgkmcnt(4)
v_mfma_f32_16x16x32_bf16 v[104:107], a[84:87], a[24:27], v[104:107]
buffer_load_dwordx4 v2, s[48:51], 0 offen lds
v_mfma_f32_16x16x32_bf16 v[112:115], a[84:87], a[28:31], v[112:115]
v_mfma_f32_16x16x32_bf16 v[112:115], a[80:83], a[12:15], v[112:115]
v_mfma_f32_16x16x32_bf16 v[116:119], a[88:91], a[12:15], v[116:119]
ds_read_b64_tr_b16 a[80:81], v12 offset:16384
v_mfma_f32_16x16x32_bf16 v[116:119], a[92:95], a[28:31], v[116:119]
ds_read_b64_tr_b16 a[82:83], v12 offset:17408
v_mfma_f32_16x16x32_bf16 v[108:111], a[92:95], a[24:27], v[108:111]
ds_read_b64_tr_b16 a[84:85], v12 offset:24576
v_mfma_f32_16x16x32_bf16 v[108:111], a[88:91], a[8:11], v[108:111]
ds_read_b64_tr_b16 a[86:87], v12 offset:25600
s_add_u32 m0, s16, 0x8400
v_mfma_f32_16x16x32_bf16 v[100:103], a[88:91], a[4:7], v[100:103]
buffer_load_dwordx4 v3, s[48:51], 0 offen lds
v_mfma_f32_16x16x32_bf16 v[100:103], a[92:95], a[20:23], v[100:103]
v_mfma_f32_16x16x32_bf16 v[92:95], a[92:95], a[16:19], v[92:95]
v_mfma_f32_16x16x32_bf16 v[92:95], a[88:91], a[0:3], v[92:95]
s_waitcnt lgkmcnt(4)
v_mfma_f32_16x16x32_bf16 v[120:123], a[96:99], a[0:3], v[120:123]
ds_read_b64_tr_b16 a[88:89], v13 offset:16384
v_mfma_f32_16x16x32_bf16 v[120:123], a[100:103], a[16:19], v[120:123]
ds_read_b64_tr_b16 a[90:91], v13 offset:17408
v_mfma_f32_16x16x32_bf16 v[128:131], a[100:103], a[20:23], v[128:131]
ds_read_b64_tr_b16 a[92:93], v13 offset:24576
v_mfma_f32_16x16x32_bf16 v[128:131], a[96:99], a[4:7], v[128:131]
ds_read_b64_tr_b16 a[94:95], v13 offset:25600
s_add_u32 m0, s16, 0x8800
v_mfma_f32_16x16x32_bf16 v[136:139], a[96:99], a[8:11], v[136:139]
buffer_load_dwordx4 v2, s[48:51], s12 offen lds
v_mfma_f32_16x16x32_bf16 v[136:139], a[100:103], a[24:27], v[136:139]
v_mfma_f32_16x16x32_bf16 v[144:147], a[100:103], a[28:31], v[144:147]
v_mfma_f32_16x16x32_bf16 v[144:147], a[96:99], a[12:15], v[144:147]
v_mfma_f32_16x16x32_bf16 v[148:151], a[104:107], a[12:15], v[148:151]
ds_read_b64_tr_b16 a[96:97], v12 offset:16640
v_mfma_f32_16x16x32_bf16 v[148:151], a[108:111], a[28:31], v[148:151]
ds_read_b64_tr_b16 a[98:99], v12 offset:17664
v_mfma_f32_16x16x32_bf16 v[140:143], a[108:111], a[24:27], v[140:143]
ds_read_b64_tr_b16 a[100:101], v12 offset:24832
s_add_u32 m0, s16, 0x8c00
v_mfma_f32_16x16x32_bf16 v[140:143], a[104:107], a[8:11], v[140:143]
buffer_load_dwordx4 v3, s[48:51], s12 offen lds
v_mfma_f32_16x16x32_bf16 v[132:135], a[104:107], a[4:7], v[132:135]
ds_read_b64_tr_b16 a[102:103], v12 offset:25856
v_mfma_f32_16x16x32_bf16 v[132:135], a[108:111], a[20:23], v[132:135]
v_mfma_f32_16x16x32_bf16 v[124:127], a[108:111], a[16:19], v[124:127]
v_mfma_f32_16x16x32_bf16 v[124:127], a[104:107], a[0:3], v[124:127]
s_waitcnt lgkmcnt(4)
v_mfma_f32_16x16x32_bf16 v[152:155], a[0:3], a[80:83], v[152:155]
ds_read_b64_tr_b16 a[104:105], v13 offset:16640
v_mfma_f32_16x16x32_bf16 v[152:155], a[16:19], a[84:87], v[152:155]
ds_read_b64_tr_b16 a[106:107], v13 offset:17664
s_add_u32 m0, s16, 0x9000
v_mfma_f32_16x16x32_bf16 v[156:159], a[20:23], a[84:87], v[156:159]
buffer_load_dwordx4 v2, s[48:51], s13 offen lds
v_mfma_f32_16x16x32_bf16 v[156:159], a[4:7], a[80:83], v[156:159]
ds_read_b64_tr_b16 a[108:109], v13 offset:24832
v_mfma_f32_16x16x32_bf16 v[160:163], a[8:11], a[80:83], v[160:163]
ds_read_b64_tr_b16 a[110:111], v13 offset:25856
v_mfma_f32_16x16x32_bf16 v[160:163], a[24:27], a[84:87], v[160:163]
v_mfma_f32_16x16x32_bf16 v[164:167], a[28:31], a[84:87], v[164:167]
v_mfma_f32_16x16x32_bf16 v[164:167], a[12:15], a[80:83], v[164:167]
v_mfma_f32_16x16x32_bf16 v[180:183], a[12:15], a[88:91], v[180:183]
ds_read_b64_tr_b16 a[80:81], v12 offset:16896
v_mfma_f32_16x16x32_bf16 v[180:183], a[28:31], a[92:95], v[180:183]
ds_read_b64_tr_b16 a[82:83], v12 offset:17920
s_add_u32 m0, s16, 0x9400
v_mfma_f32_16x16x32_bf16 v[176:179], a[24:27], a[92:95], v[176:179]
buffer_load_dwordx4 v3, s[48:51], s13 offen lds
v_mfma_f32_16x16x32_bf16 v[176:179], a[8:11], a[88:91], v[176:179]
ds_read_b64_tr_b16 a[84:85], v12 offset:25088
v_mfma_f32_16x16x32_bf16 v[172:175], a[4:7], a[88:91], v[172:175]
ds_read_b64_tr_b16 a[86:87], v12 offset:26112
v_mfma_f32_16x16x32_bf16 v[172:175], a[20:23], a[92:95], v[172:175]
v_mfma_f32_16x16x32_bf16 v[168:171], a[16:19], a[92:95], v[168:171]
v_mfma_f32_16x16x32_bf16 v[168:171], a[0:3], a[88:91], v[168:171]
s_waitcnt lgkmcnt(4)
v_mfma_f32_16x16x32_bf16 v[184:187], a[0:3], a[96:99], v[184:187]
ds_read_b64_tr_b16 a[88:89], v13 offset:16896
s_add_u32 m0, s16, 0x9800
v_mfma_f32_16x16x32_bf16 v[184:187], a[16:19], a[100:103], v[184:187]
buffer_load_dwordx4 v2, s[48:51], s14 offen lds
v_mfma_f32_16x16x32_bf16 v[188:191], a[20:23], a[100:103], v[188:191]
ds_read_b64_tr_b16 a[90:91], v13 offset:17920
v_mfma_f32_16x16x32_bf16 v[188:191], a[4:7], a[96:99], v[188:191]
ds_read_b64_tr_b16 a[92:93], v13 offset:25088
v_mfma_f32_16x16x32_bf16 v[192:195], a[8:11], a[96:99], v[192:195]
ds_read_b64_tr_b16 a[94:95], v13 offset:26112
v_mfma_f32_16x16x32_bf16 v[192:195], a[24:27], a[100:103], v[192:195]
v_mfma_f32_16x16x32_bf16 v[196:199], a[28:31], a[100:103], v[196:199]
v_mfma_f32_16x16x32_bf16 v[196:199], a[12:15], a[96:99], v[196:199]
v_mfma_f32_16x16x32_bf16 v[212:215], a[12:15], a[104:107], v[212:215]
ds_read_b64_tr_b16 a[96:97], v12 offset:17152
s_add_u32 m0, s16, 0x9c00
v_mfma_f32_16x16x32_bf16 v[212:215], a[28:31], a[108:111], v[212:215]
buffer_load_dwordx4 v3, s[48:51], s14 offen lds
v_mfma_f32_16x16x32_bf16 v[208:211], a[24:27], a[108:111], v[208:211]
ds_read_b64_tr_b16 a[98:99], v12 offset:18176
v_lshl_add_u32 v2, s42, 7, v2
v_mfma_f32_16x16x32_bf16 v[208:211], a[8:11], a[104:107], v[208:211]
ds_read_b64_tr_b16 a[100:101], v12 offset:25344
v_lshl_add_u32 v3, s42, 7, v3
v_mfma_f32_16x16x32_bf16 v[204:207], a[4:7], a[104:107], v[204:207]
ds_read_b64_tr_b16 a[102:103], v12 offset:26368
v_mfma_f32_16x16x32_bf16 v[204:207], a[20:23], a[108:111], v[204:207]
v_mfma_f32_16x16x32_bf16 v[200:203], a[16:19], a[108:111], v[200:203]
v_mfma_f32_16x16x32_bf16 v[200:203], a[0:3], a[104:107], v[200:203]
s_mov_b32 s9, 0x0
s_waitcnt lgkmcnt(4)
v_mfma_f32_16x16x32_bf16 v[216:219], a[0:3], a[80:83], v[216:219]
buffer_load_dword a120, v19, s[44:47], s9 offen
v_mfma_f32_16x16x32_bf16 v[216:219], a[16:19], a[84:87], v[216:219]
ds_read_b64_tr_b16 a[104:105], v13 offset:17152
v_mfma_f32_16x16x32_bf16 v[220:223], a[20:23], a[84:87], v[220:223]
ds_read_b64_tr_b16 a[106:107], v13 offset:18176
v_mfma_f32_16x16x32_bf16 v[220:223], a[4:7], a[80:83], v[220:223]
ds_read_b64_tr_b16 a[108:109], v13 offset:25344
v_mfma_f32_16x16x32_bf16 v[224:227], a[8:11], a[80:83], v[224:227]
ds_read_b64_tr_b16 a[110:111], v13 offset:26368
v_add_u32 v12, 0xffff0000, v12
v_mfma_f32_16x16x32_bf16 v[224:227], a[24:27], a[84:87], v[224:227]
v_add_u32 v13, 0xffff0000, v13
v_mfma_f32_16x16x32_bf16 v[228:231], a[28:31], a[84:87], v[228:231]
v_mfma_f32_16x16x32_bf16 v[228:231], a[12:15], a[80:83], v[228:231]
v_mfma_f32_16x16x32_bf16 v[244:247], a[12:15], a[88:91], v[244:247]
s_waitcnt vmcnt(27) lgkmcnt(0)
v_mfma_f32_16x16x32_bf16 v[244:247], a[28:31], a[92:95], v[244:247]
s_barrier
s_add_u32 m0, s17, 0x10000
v_mfma_f32_16x16x32_bf16 v[240:243], a[24:27], a[92:95], v[240:243]
buffer_load_dwordx4 v5, s[56:59], 0 offen lds
v_mfma_f32_16x16x32_bf16 v[240:243], a[8:11], a[88:91], v[240:243]
ds_read_b64_tr_b16 a[80:81], v12 offset:0
v_mfma_f32_16x16x32_bf16 v[236:239], a[4:7], a[88:91], v[236:239]
ds_read_b64_tr_b16 a[82:83], v12 offset:1024
v_mfma_f32_16x16x32_bf16 v[236:239], a[20:23], a[92:95], v[236:239]
ds_read_b64_tr_b16 a[84:85], v12 offset:8192
v_mfma_f32_16x16x32_bf16 v[232:235], a[16:19], a[92:95], v[232:235]
ds_read_b64_tr_b16 a[86:87], v12 offset:9216
v_mfma_f32_16x16x32_bf16 v[232:235], a[0:3], a[88:91], v[232:235]
s_waitcnt lgkmcnt(4)
v_mfma_f32_16x16x32_bf16 v[248:251], a[0:3], a[96:99], v[248:251]
ds_read_b64_tr_b16 a[88:89], v13 offset:0
s_add_u32 m0, s17, 0x14000
v_mfma_f32_16x16x32_bf16 v[248:251], a[16:19], a[100:103], v[248:251]
buffer_load_dwordx4 v5, s[60:63], 0 offen lds
v_mfma_f32_16x16x32_bf16 v[252:255], a[20:23], a[100:103], v[252:255]
ds_read_b64_tr_b16 a[90:91], v13 offset:1024
v_mfma_f32_16x16x32_bf16 v[252:255], a[4:7], a[96:99], v[252:255]
ds_read_b64_tr_b16 a[92:93], v13 offset:8192
v_mfma_f32_16x16x32_bf16 a[232:235], a[8:11], a[96:99], a[232:235]
ds_read_b64_tr_b16 a[94:95], v13 offset:9216
v_mfma_f32_16x16x32_bf16 a[232:235], a[24:27], a[100:103], a[232:235]
v_mfma_f32_16x16x32_bf16 a[236:239], a[28:31], a[100:103], a[236:239]
v_mfma_f32_16x16x32_bf16 a[236:239], a[12:15], a[96:99], a[236:239]
s_add_u32 m0, s17, 0x10400
v_mfma_f32_16x16x32_bf16 a[252:255], a[12:15], a[104:107], a[252:255]
buffer_load_dwordx4 v5, s[56:59], s13 offen lds
v_mfma_f32_16x16x32_bf16 a[252:255], a[28:31], a[108:111], a[252:255]
ds_read_b64_tr_b16 a[96:97], v12 offset:256
v_mfma_f32_16x16x32_bf16 a[248:251], a[24:27], a[108:111], a[248:251]
ds_read_b64_tr_b16 a[98:99], v12 offset:1280
v_mfma_f32_16x16x32_bf16 a[248:251], a[8:11], a[104:107], a[248:251]
ds_read_b64_tr_b16 a[100:101], v12 offset:8448
v_mfma_f32_16x16x32_bf16 a[244:247], a[4:7], a[104:107], a[244:247]
ds_read_b64_tr_b16 a[102:103], v12 offset:9472
v_mfma_f32_16x16x32_bf16 a[244:247], a[20:23], a[108:111], a[244:247]
v_mfma_f32_16x16x32_bf16 a[240:243], a[16:19], a[108:111], a[240:243]
s_add_u32 m0, s17, 0x14400
s_waitcnt lgkmcnt(4)
v_mfma_f32_16x16x32_bf16 a[240:243], a[0:3], a[104:107], a[240:243]
buffer_load_dwordx4 v5, s[60:63], s13 offen lds
L_S3:
v_mfma_f32_16x16x32_bf16 v[24:27], a[80:83], a[32:35], v[24:27]
ds_read_b64_tr_b16 a[104:105], v13 offset:256
s_waitcnt vmcnt(22)
v_mfma_f32_16x16x32_bf16 v[24:27], a[84:87], a[48:51], v[24:27]
ds_read_b64_tr_b16 a[106:107], v13 offset:1280
v_mfma_f32_16x16x32_bf16 v[32:35], a[84:87], a[52:55], v[32:35]
ds_read_b64_tr_b16 a[108:109], v13 offset:8448
v_mfma_f32_16x16x32_bf16 v[32:35], a[80:83], a[36:39], v[32:35]
ds_read_b64_tr_b16 a[110:111], v13 offset:9472
v_mfma_f32_16x16x32_bf16 v[40:43], a[80:83], a[40:43], v[40:43]
ds_read_b128 a[0:3], v8 offset:0
v_mfma_f32_16x16x32_bf16 v[40:43], a[84:87], a[56:59], v[40:43]
ds_read_b128 a[16:19], v9 offset:0
s_add_u32 m0, s17, 0x10800
v_mfma_f32_16x16x32_bf16 v[48:51], a[84:87], a[60:63], v[48:51]
buffer_load_dwordx4 v6, s[56:59], 0 offen lds
v_mfma_f32_16x16x32_bf16 v[48:51], a[80:83], a[44:47], v[48:51]
ds_read_b128 a[4:7], v8 offset:2048
v_mfma_f32_16x16x32_bf16 v[52:55], a[88:91], a[44:47], v[52:55]
ds_read_b64_tr_b16 a[80:81], v12 offset:512
v_mfma_f32_16x16x32_bf16 v[52:55], a[92:95], a[60:63], v[52:55]
ds_read_b64_tr_b16 a[82:83], v12 offset:1536
v_mfma_f32_16x16x32_bf16 v[44:47], a[92:95], a[56:59], v[44:47]
ds_read_b64_tr_b16 a[84:85], v12 offset:8704
v_mfma_f32_16x16x32_bf16 v[44:47], a[88:91], a[40:43], v[44:47]
ds_read_b64_tr_b16 a[86:87], v12 offset:9728
v_mfma_f32_16x16x32_bf16 v[36:39], a[88:91], a[36:39], v[36:39]
ds_read_b128 a[20:23], v9 offset:2048
s_add_u32 m0, s17, 0x14800
v_mfma_f32_16x16x32_bf16 v[36:39], a[92:95], a[52:55], v[36:39]
buffer_load_dwordx4 v6, s[60:63], 0 offen lds
v_mfma_f32_16x16x32_bf16 v[28:31], a[92:95], a[48:51], v[28:31]
ds_read_b128 a[8:11], v8 offset:4096
v_mfma_f32_16x16x32_bf16 v[28:31], a[88:91], a[32:35], v[28:31]
ds_read_b128 a[24:27], v9 offset:4096
s_waitcnt lgkmcnt(10)
v_mfma_f32_16x16x32_bf16 v[56:59], a[96:99], a[32:35], v[56:59]
ds_read_b64_tr_b16 a[88:89], v13 offset:512
v_mfma_f32_16x16x32_bf16 v[56:59], a[100:103], a[48:51], v[56:59]
ds_read_b64_tr_b16 a[90:91], v13 offset:1536
v_mfma_f32_16x16x32_bf16 v[64:67], a[100:103], a[52:55], v[64:67]
ds_read_b64_tr_b16 a[92:93], v13 offset:8704
v_mfma_f32_16x16x32_bf16 v[64:67], a[96:99], a[36:39], v[64:67]
ds_read_b64_tr_b16 a[94:95], v13 offset:9728
s_add_u32 m0, s17, 0x10c00
v_mfma_f32_16x16x32_bf16 v[72:75], a[96:99], a[40:43], v[72:75]
buffer_load_dwordx4 v6, s[56:59], s13 offen lds
v_mfma_f32_16x16x32_bf16 v[72:75], a[100:103], a[56:59], v[72:75]
ds_read_b128 a[12:15], v8 offset:6144
v_mfma_f32_16x16x32_bf16 v[80:83], a[100:103], a[60:63], v[80:83]
ds_read_b128 a[28:31], v9 offset:6144
v_mfma_f32_16x16x32_bf16 v[80:83], a[96:99], a[44:47], v[80:83]
v_mfma_f32_16x16x32_bf16 v[84:87], a[104:107], a[44:47], v[84:87]
ds_read_b64_tr_b16 a[96:97], v12 offset:768
v_mfma_f32_16x16x32_bf16 v[84:87], a[108:111], a[60:63], v[84:87]
ds_read_b64_tr_b16 a[98:99], v12 offset:1792
v_mfma_f32_16x16x32_bf16 v[76:79], a[108:111], a[56:59], v[76:79]
ds_read_b64_tr_b16 a[100:101], v12 offset:8960
s_add_u32 m0, s17, 0x14c00
v_mfma_f32_16x16x32_bf16 v[76:79], a[104:107], a[40:43], v[76:79]
buffer_load_dwordx4 v6, s[60:63], s13 offen lds
v_mfma_f32_16x16x32_bf16 v[68:71], a[104:107], a[36:39], v[68:71]
ds_read_b64_tr_b16 a[102:103], v12 offset:9984
v_lshl_add_u32 v5, s42, 19, v5
v_mfma_f32_16x16x32_bf16 v[68:71], a[108:111], a[52:55], v[68:71]
v_lshl_add_u32 v6, s42, 19, v6
v_mfma_f32_16x16x32_bf16 v[60:63], a[108:111], a[48:51], v[60:63]
v_mfma_f32_16x16x32_bf16 v[60:63], a[104:107], a[32:35], v[60:63]
s_waitcnt lgkmcnt(6)
v_mfma_f32_16x16x32_bf16 v[88:91], a[80:83], a[32:35], v[88:91]
ds_read_b64_tr_b16 a[104:105], v13 offset:768
v_mfma_f32_16x16x32_bf16 v[88:91], a[84:87], a[48:51], v[88:91]
ds_read_b64_tr_b16 a[106:107], v13 offset:1792
s_mov_b32 s9, 0x200000
v_mfma_f32_16x16x32_bf16 v[96:99], a[84:87], a[52:55], v[96:99]
buffer_load_dword a120, v19, s[44:47], s9 offen
v_mfma_f32_16x16x32_bf16 v[96:99], a[80:83], a[36:39], v[96:99]
ds_read_b64_tr_b16 a[108:109], v13 offset:8960
v_mfma_f32_16x16x32_bf16 v[104:107], a[80:83], a[40:43], v[104:107]
ds_read_b64_tr_b16 a[110:111], v13 offset:9984
v_mfma_f32_16x16x32_bf16 v[104:107], a[84:87], a[56:59], v[104:107]
v_mfma_f32_16x16x32_bf16 v[112:115], a[84:87], a[60:63], v[112:115]
v_mfma_f32_16x16x32_bf16 v[112:115], a[80:83], a[44:47], v[112:115]
s_waitcnt lgkmcnt(8)
v_mfma_f32_16x16x32_bf16 v[116:119], a[88:91], a[44:47], v[116:119]
ds_read_b64_tr_b16 a[80:81], v12 offset:16384
s_add_u32 m0, s16, 0x0
v_mfma_f32_16x16x32_bf16 v[116:119], a[92:95], a[60:63], v[116:119]
buffer_load_dwordx4 v2, s[48:51], 0 offen lds
v_mfma_f32_16x16x32_bf16 v[108:111], a[92:95], a[56:59], v[108:111]
ds_read_b64_tr_b16 a[82:83], v12 offset:17408
v_mfma_f32_16x16x32_bf16 v[108:111], a[88:91], a[40:43], v[108:111]
ds_read_b64_tr_b16 a[84:85], v12 offset:24576
v_mfma_f32_16x16x32_bf16 v[100:103], a[88:91], a[36:39], v[100:103]
ds_read_b64_tr_b16 a[86:87], v12 offset:25600
v_mfma_f32_16x16x32_bf16 v[100:103], a[92:95], a[52:55], v[100:103]
v_mfma_f32_16x16x32_bf16 v[92:95], a[92:95], a[48:51], v[92:95]
v_mfma_f32_16x16x32_bf16 v[92:95], a[88:91], a[32:35], v[92:95]
s_add_u32 m0, s16, 0x400
s_waitcnt lgkmcnt(4)
v_mfma_f32_16x16x32_bf16 v[120:123], a[96:99], a[32:35], v[120:123]
buffer_load_dwordx4 v3, s[48:51], 0 offen lds
v_mfma_f32_16x16x32_bf16 v[120:123], a[100:103], a[48:51], v[120:123]
ds_read_b64_tr_b16 a[88:89], v13 offset:16384
v_mfma_f32_16x16x32_bf16 v[128:131], a[100:103], a[52:55], v[128:131]
ds_read_b64_tr_b16 a[90:91], v13 offset:17408
v_mfma_f32_16x16x32_bf16 v[128:131], a[96:99], a[36:39], v[128:131]
ds_read_b64_tr_b16 a[92:93], v13 offset:24576
v_mfma_f32_16x16x32_bf16 v[136:139], a[96:99], a[40:43], v[136:139]
ds_read_b64_tr_b16 a[94:95], v13 offset:25600
v_mfma_f32_16x16x32_bf16 v[136:139], a[100:103], a[56:59], v[136:139]
v_mfma_f32_16x16x32_bf16 v[144:147], a[100:103], a[60:63], v[144:147]
s_add_u32 m0, s16, 0x800
v_mfma_f32_16x16x32_bf16 v[144:147], a[96:99], a[44:47], v[144:147]
buffer_load_dwordx4 v2, s[48:51], s12 offen lds
v_mfma_f32_16x16x32_bf16 v[148:151], a[104:107], a[44:47], v[148:151]
ds_read_b64_tr_b16 a[96:97], v12 offset:16640
v_mfma_f32_16x16x32_bf16 v[148:151], a[108:111], a[60:63], v[148:151]
ds_read_b64_tr_b16 a[98:99], v12 offset:17664
v_mfma_f32_16x16x32_bf16 v[140:143], a[108:111], a[56:59], v[140:143]
ds_read_b64_tr_b16 a[100:101], v12 offset:24832
v_mfma_f32_16x16x32_bf16 v[140:143], a[104:107], a[40:43], v[140:143]
ds_read_b64_tr_b16 a[102:103], v12 offset:25856
v_mfma_f32_16x16x32_bf16 v[132:135], a[104:107], a[36:39], v[132:135]
v_mfma_f32_16x16x32_bf16 v[132:135], a[108:111], a[52:55], v[132:135]
s_add_u32 m0, s16, 0xc00
v_mfma_f32_16x16x32_bf16 v[124:127], a[108:111], a[48:51], v[124:127]
buffer_load_dwordx4 v3, s[48:51], s12 offen lds
v_mfma_f32_16x16x32_bf16 v[124:127], a[104:107], a[32:35], v[124:127]
s_waitcnt lgkmcnt(4)
v_mfma_f32_16x16x32_bf16 v[152:155], a[32:35], a[80:83], v[152:155]
ds_read_b64_tr_b16 a[104:105], v13 offset:16640
v_mfma_f32_16x16x32_bf16 v[152:155], a[48:51], a[84:87], v[152:155]
ds_read_b64_tr_b16 a[106:107], v13 offset:17664
v_mfma_f32_16x16x32_bf16 v[156:159], a[52:55], a[84:87], v[156:159]
ds_read_b64_tr_b16 a[108:109], v13 offset:24832
v_mfma_f32_16x16x32_bf16 v[156:159], a[36:39], a[80:83], v[156:159]
ds_read_b64_tr_b16 a[110:111], v13 offset:25856
v_mfma_f32_16x16x32_bf16 v[160:163], a[40:43], a[80:83], v[160:163]
s_add_u32 m0, s16, 0x1000
v_mfma_f32_16x16x32_bf16 v[160:163], a[56:59], a[84:87], v[160:163]
buffer_load_dwordx4 v2, s[48:51], s13 offen lds
v_mfma_f32_16x16x32_bf16 v[164:167], a[60:63], a[84:87], v[164:167]
v_mfma_f32_16x16x32_bf16 v[164:167], a[44:47], a[80:83], v[164:167]
v_mfma_f32_16x16x32_bf16 v[180:183], a[44:47], a[88:91], v[180:183]
ds_read_b64_tr_b16 a[80:81], v12 offset:16896
v_mfma_f32_16x16x32_bf16 v[180:183], a[60:63], a[92:95], v[180:183]
ds_read_b64_tr_b16 a[82:83], v12 offset:17920
v_mfma_f32_16x16x32_bf16 v[176:179], a[56:59], a[92:95], v[176:179]
ds_read_b64_tr_b16 a[84:85], v12 offset:25088
v_mfma_f32_16x16x32_bf16 v[176:179], a[40:43], a[88:91], v[176:179]
ds_read_b64_tr_b16 a[86:87], v12 offset:26112
s_add_u32 m0, s16, 0x1400
v_mfma_f32_16x16x32_bf16 v[172:175], a[36:39], a[88:91], v[172:175]
buffer_load_dwordx4 v3, s[48:51], s13 offen lds
v_mfma_f32_16x16x32_bf16 v[172:175], a[52:55], a[92:95], v[172:175]
v_mfma_f32_16x16x32_bf16 v[168:171], a[48:51], a[92:95], v[168:171]
v_mfma_f32_16x16x32_bf16 v[168:171], a[32:35], a[88:91], v[168:171]
s_waitcnt lgkmcnt(4)
v_mfma_f32_16x16x32_bf16 v[184:187], a[32:35], a[96:99], v[184:187]
ds_read_b64_tr_b16 a[88:89], v13 offset:16896
v_mfma_f32_16x16x32_bf16 v[184:187], a[48:51], a[100:103], v[184:187]
ds_read_b64_tr_b16 a[90:91], v13 offset:17920
v_mfma_f32_16x16x32_bf16 v[188:191], a[52:55], a[100:103], v[188:191]
ds_read_b64_tr_b16 a[92:93], v13 offset:25088
s_add_u32 m0, s16, 0x1800
v_mfma_f32_16x16x32_bf16 v[188:191], a[36:39], a[96:99], v[188:191]
buffer_load_dwordx4 v2, s[48:51], s14 offen lds
v_mfma_f32_16x16x32_bf16 v[192:195], a[40:43], a[96:99], v[192:195]
ds_read_b64_tr_b16 a[94:95], v13 offset:26112
v_mfma_f32_16x16x32_bf16 v[192:195], a[56:59], a[100:103], v[192:195]
v_mfma_f32_16x16x32_bf16 v[196:199], a[60:63], a[100:103], v[196:199]
v_mfma_f32_16x16x32_bf16 v[196:199], a[44:47], a[96:99], v[196:199]
v_mfma_f32_16x16x32_bf16 v[212:215], a[44:47], a[104:107], v[212:215]
ds_read_b64_tr_b16 a[96:97], v12 offset:17152
v_mfma_f32_16x16x32_bf16 v[212:215], a[60:63], a[108:111], v[212:215]
ds_read_b64_tr_b16 a[98:99], v12 offset:18176
s_add_u32 m0, s16, 0x1c00
v_mfma_f32_16x16x32_bf16 v[208:211], a[56:59], a[108:111], v[208:211]
buffer_load_dwordx4 v3, s[48:51], s14 offen lds
v_mfma_f32_16x16x32_bf16 v[208:211], a[40:43], a[104:107], v[208:211]
ds_read_b64_tr_b16 a[100:101], v12 offset:25344
v_lshl_add_u32 v2, s42, 7, v2
v_mfma_f32_16x16x32_bf16 v[204:207], a[36:39], a[104:107], v[204:207]
ds_read_b64_tr_b16 a[102:103], v12 offset:26368
v_lshl_add_u32 v3, s42, 7, v3
v_mfma_f32_16x16x32_bf16 v[204:207], a[52:55], a[108:111], v[204:207]
v_mfma_f32_16x16x32_bf16 v[200:203], a[48:51], a[108:111], v[200:203]
v_mfma_f32_16x16x32_bf16 v[200:203], a[32:35], a[104:107], v[200:203]
s_waitcnt lgkmcnt(4)
v_mfma_f32_16x16x32_bf16 v[216:219], a[32:35], a[80:83], v[216:219]
ds_read_b64_tr_b16 a[104:105], v13 offset:17152
s_mov_b32 s9, 0x0
v_mfma_f32_16x16x32_bf16 v[216:219], a[48:51], a[84:87], v[216:219]
buffer_load_dword a120, v18, s[52:55], s9 offen
v_mfma_f32_16x16x32_bf16 v[220:223], a[52:55], a[84:87], v[220:223]
ds_read_b64_tr_b16 a[106:107], v13 offset:18176
v_mfma_f32_16x16x32_bf16 v[220:223], a[36:39], a[80:83], v[220:223]
ds_read_b64_tr_b16 a[108:109], v13 offset:25344
v_mfma_f32_16x16x32_bf16 v[224:227], a[40:43], a[80:83], v[224:227]
ds_read_b64_tr_b16 a[110:111], v13 offset:26368
v_add_u32 v12, 0x8000, v12
v_mfma_f32_16x16x32_bf16 v[224:227], a[56:59], a[84:87], v[224:227]
v_add_u32 v13, 0x8000, v13
v_mfma_f32_16x16x32_bf16 v[228:231], a[60:63], a[84:87], v[228:231]
v_mfma_f32_16x16x32_bf16 v[228:231], a[44:47], a[80:83], v[228:231]
v_mfma_f32_16x16x32_bf16 v[244:247], a[44:47], a[88:91], v[244:247]
s_waitcnt vmcnt(27) lgkmcnt(0)
v_mfma_f32_16x16x32_bf16 v[244:247], a[60:63], a[92:95], v[244:247]
s_barrier
s_add_u32 m0, s17, 0x0
v_mfma_f32_16x16x32_bf16 v[240:243], a[56:59], a[92:95], v[240:243]
buffer_load_dwordx4 v5, s[56:59], 0 offen lds
v_mfma_f32_16x16x32_bf16 v[240:243], a[40:43], a[88:91], v[240:243]
ds_read_b64_tr_b16 a[80:81], v12 offset:0
v_mfma_f32_16x16x32_bf16 v[236:239], a[36:39], a[88:91], v[236:239]
ds_read_b64_tr_b16 a[82:83], v12 offset:1024
v_mfma_f32_16x16x32_bf16 v[236:239], a[52:55], a[92:95], v[236:239]
ds_read_b64_tr_b16 a[84:85], v12 offset:8192
v_mfma_f32_16x16x32_bf16 v[232:235], a[48:51], a[92:95], v[232:235]
ds_read_b64_tr_b16 a[86:87], v12 offset:9216
v_mfma_f32_16x16x32_bf16 v[232:235], a[32:35], a[88:91], v[232:235]
s_waitcnt lgkmcnt(4)
v_mfma_f32_16x16x32_bf16 v[248:251], a[32:35], a[96:99], v[248:251]
ds_read_b64_tr_b16 a[88:89], v13 offset:0
s_add_u32 m0, s17, 0x4000
v_mfma_f32_16x16x32_bf16 v[248:251], a[48:51], a[100:103], v[248:251]
buffer_load_dwordx4 v5, s[60:63], 0 offen lds
v_mfma_f32_16x16x32_bf16 v[252:255], a[52:55], a[100:103], v[252:255]
ds_read_b64_tr_b16 a[90:91], v13 offset:1024
v_mfma_f32_16x16x32_bf16 v[252:255], a[36:39], a[96:99], v[252:255]
ds_read_b64_tr_b16 a[92:93], v13 offset:8192
v_mfma_f32_16x16x32_bf16 a[232:235], a[40:43], a[96:99], a[232:235]
ds_read_b64_tr_b16 a[94:95], v13 offset:9216
v_mfma_f32_16x16x32_bf16 a[232:235], a[56:59], a[100:103], a[232:235]
L_padA2:
s_cmp_eq_u32 s95, 1
s_cbranch_scc1 L_padA6
v_mfma_f32_16x16x32_bf16 a[236:239], a[60:63], a[100:103], a[236:239]
v_mfma_f32_16x16x32_bf16 a[236:239], a[44:47], a[96:99], a[236:239]
s_add_u32 m0, s17, 0x400
v_mfma_f32_16x16x32_bf16 a[252:255], a[44:47], a[104:107], a[252:255]
buffer_load_dwordx4 v5, s[56:59], s13 offen lds
v_mfma_f32_16x16x32_bf16 a[252:255], a[60:63], a[108:111], a[252:255]
ds_read_b64_tr_b16 a[96:97], v12 offset:256
v_mfma_f32_16x16x32_bf16 a[248:251], a[56:59], a[108:111], a[248:251]
ds_read_b64_tr_b16 a[98:99], v12 offset:1280
v_mfma_f32_16x16x32_bf16 a[248:251], a[40:43], a[104:107], a[248:251]
ds_read_b64_tr_b16 a[100:101], v12 offset:8448
v_mfma_f32_16x16x32_bf16 a[244:247], a[36:39], a[104:107], a[244:247]
ds_read_b64_tr_b16 a[102:103], v12 offset:9472
v_mfma_f32_16x16x32_bf16 a[244:247], a[52:55], a[108:111], a[244:247]
v_mfma_f32_16x16x32_bf16 a[240:243], a[48:51], a[108:111], a[240:243]
s_add_u32 m0, s17, 0x4400
s_waitcnt lgkmcnt(4)
v_mfma_f32_16x16x32_bf16 a[240:243], a[32:35], a[104:107], a[240:243]
buffer_load_dwordx4 v5, s[60:63], s13 offen lds
L_S4:
v_mfma_f32_16x16x32_bf16 v[24:27], a[80:83], a[0:3], v[24:27]
ds_read_b64_tr_b16 a[104:105], v13 offset:256
s_waitcnt vmcnt(23)
v_mfma_f32_16x16x32_bf16 v[24:27], a[84:87], a[16:19], v[24:27]
ds_read_b64_tr_b16 a[106:107], v13 offset:1280
v_mfma_f32_16x16x32_bf16 v[32:35], a[84:87], a[20:23], v[32:35]
ds_read_b64_tr_b16 a[108:109], v13 offset:8448
v_mfma_f32_16x16x32_bf16 v[32:35], a[80:83], a[4:7], v[32:35]
ds_read_b64_tr_b16 a[110:111], v13 offset:9472
v_mfma_f32_16x16x32_bf16 v[40:43], a[80:83], a[8:11], v[40:43]
ds_read_b128 a[32:35], v8 offset:32768
v_mfma_f32_16x16x32_bf16 v[40:43], a[84:87], a[24:27], v[40:43]
ds_read_b128 a[48:51], v9 offset:32768
s_add_u32 m0, s17, 0x800
v_mfma_f32_16x16x32_bf16 v[48:51], a[84:87], a[28:31], v[48:51]
buffer_load_dwordx4 v6, s[56:59], 0 offen lds
v_mfma_f32_16x16x32_bf16 v[48:51], a[80:83], a[12:15], v[48:51]
ds_read_b128 a[36:39], v8 offset:34816
v_mfma_f32_16x16x32_bf16 v[52:55], a[88:91], a[12:15], v[52:55]
ds_read_b64_tr_b16 a[80:81], v12 offset:512
v_mfma_f32_16x16x32_bf16 v[52:55], a[92:95], a[28:31], v[52:55]
ds_read_b64_tr_b16 a[82:83], v12 offset:1536
v_mfma_f32_16x16x32_bf16 v[44:47], a[92:95], a[24:27], v[44:47]
ds_read_b64_tr_b16 a[84:85], v12 offset:8704
v_mfma_f32_16x16x32_bf16 v[44:47], a[88:91], a[8:11], v[44:47]
ds_read_b64_tr_b16 a[86:87], v12 offset:9728
v_mfma_f32_16x16x32_bf16 v[36:39], a[88:91], a[4:7], v[36:39]
ds_read_b128 a[52:55], v9 offset:34816
s_add_u32 m0, s17, 0x4800
v_mfma_f32_16x16x32_bf16 v[36:39], a[92:95], a[20:23], v[36:39]
buffer_load_dwordx4 v6, s[60:63], 0 offen lds
v_mfma_f32_16x16x32_bf16 v[28:31], a[92:95], a[16:19], v[28:31]
ds_read_b128 a[40:43], v8 offset:36864
v_mfma_f32_16x16x32_bf16 v[28:31], a[88:91], a[0:3], v[28:31]
ds_read_b128 a[56:59], v9 offset:36864
s_waitcnt lgkmcnt(10)
v_mfma_f32_16x16x32_bf16 v[56:59], a[96:99], a[0:3], v[56:59]
ds_read_b64_tr_b16 a[88:89], v13 offset:512
v_mfma_f32_16x16x32_bf16 v[56:59], a[100:103], a[16:19], v[56:59]
ds_read_b64_tr_b16 a[90:91], v13 offset:1536
v_mfma_f32_16x16x32_bf16 v[64:67], a[100:103], a[20:23], v[64:67]
ds_read_b64_tr_b16 a[92:93], v13 offset:8704
v_mfma_f32_16x16x32_bf16 v[64:67], a[96:99], a[4:7], v[64:67]
ds_read_b64_tr_b16 a[94:95], v13 offset:9728
s_add_u32 m0, s17, 0xc00
v_mfma_f32_16x16x32_bf16 v[72:75], a[96:99], a[8:11], v[72:75]
buffer_load_dwordx4 v6, s[56:59], s13 offen lds
v_mfma_f32_16x16x32_bf16 v[72:75], a[100:103], a[24:27], v[72:75]
ds_read_b128 a[44:47], v8 offset:38912
v_mfma_f32_16x16x32_bf16 v[80:83], a[100:103], a[28:31], v[80:83]
ds_read_b128 a[60:63], v9 offset:38912
v_mfma_f32_16x16x32_bf16 v[80:83], a[96:99], a[12:15], v[80:83]
v_mfma_f32_16x16x32_bf16 v[84:87], a[104:107], a[12:15], v[84:87]
ds_read_b64_tr_b16 a[96:97], v12 offset:768
v_mfma_f32_16x16x32_bf16 v[84:87], a[108:111], a[28:31], v[84:87]
ds_read_b64_tr_b16 a[98:99], v12 offset:1792
v_mfma_f32_16x16x32_bf16 v[76:79], a[108:111], a[24:27], v[76:79]
ds_read_b64_tr_b16 a[100:101], v12 offset:8960
s_add_u32 m0, s17, 0x4c00
v_mfma_f32_16x16x32_bf16 v[76:79], a[104:107], a[8:11], v[76:79]
buffer_load_dwordx4 v6, s[60:63], s13 offen lds
v_mfma_f32_16x16x32_bf16 v[68:71], a[104:107], a[4:7], v[68:71]
ds_read_b64_tr_b16 a[102:103], v12 offset:9984
v_lshl_add_u32 v5, s42, 19, v5
v_mfma_f32_16x16x32_bf16 v[68:71], a[108:111], a[20:23], v[68:71]
v_lshl_add_u32 v6, s42, 19, v6
v_mfma_f32_16x16x32_bf16 v[60:63], a[108:111], a[16:19], v[60:63]
v_mfma_f32_16x16x32_bf16 v[60:63], a[104:107], a[0:3], v[60:63]
s_waitcnt lgkmcnt(6)
v_mfma_f32_16x16x32_bf16 v[88:91], a[80:83], a[0:3], v[88:91]
ds_read_b64_tr_b16 a[104:105], v13 offset:768
v_mfma_f32_16x16x32_bf16 v[88:91], a[84:87], a[16:19], v[88:91]
ds_read_b64_tr_b16 a[106:107], v13 offset:1792
s_mov_b32 s9, 0x0
v_mfma_f32_16x16x32_bf16 v[96:99], a[84:87], a[20:23], v[96:99]
buffer_load_dword a120, v1, s[68:71], s9 offen
v_mfma_f32_16x16x32_bf16 v[96:99], a[80:83], a[4:7], v[96:99]
ds_read_b64_tr_b16 a[108:109], v13 offset:8960
v_mfma_f32_16x16x32_bf16 v[104:107], a[80:83], a[8:11], v[104:107]
ds_read_b64_tr_b16 a[110:111], v13 offset:9984
v_mfma_f32_16x16x32_bf16 v[104:107], a[84:87], a[24:27], v[104:107]
v_mfma_f32_16x16x32_bf16 v[112:115], a[84:87], a[28:31], v[112:115]
v_mfma_f32_16x16x32_bf16 v[112:115], a[80:83], a[12:15], v[112:115]
s_waitcnt lgkmcnt(8)
v_mfma_f32_16x16x32_bf16 v[116:119], a[88:91], a[12:15], v[116:119]
ds_read_b64_tr_b16 a[80:81], v12 offset:16384
s_add_u32 m0, s16, 0x8000
v_mfma_f32_16x16x32_bf16 v[116:119], a[92:95], a[28:31], v[116:119]
buffer_load_dwordx4 v2, s[48:51], 0 offen lds
v_mfma_f32_16x16x32_bf16 v[108:111], a[92:95], a[24:27], v[108:111]
ds_read_b64_tr_b16 a[82:83], v12 offset:17408
v_mfma_f32_16x16x32_bf16 v[108:111], a[88:91], a[8:11], v[108:111]
ds_read_b64_tr_b16 a[84:85], v12 offset:24576
v_mfma_f32_16x16x32_bf16 v[100:103], a[88:91], a[4:7], v[100:103]
ds_read_b64_tr_b16 a[86:87], v12 offset:25600
v_mfma_f32_16x16x32_bf16 v[100:103], a[92:95], a[20:23], v[100:103]
v_mfma_f32_16x16x32_bf16 v[92:95], a[92:95], a[16:19], v[92:95]
v_mfma_f32_16x16x32_bf16 v[92:95], a[88:91], a[0:3], v[92:95]
s_add_u32 m0, s16, 0x8400
s_waitcnt lgkmcnt(4)
v_mfma_f32_16x16x32_bf16 v[120:123], a[96:99], a[0:3], v[120:123]
buffer_load_dwordx4 v3, s[48:51], 0 offen lds
v_mfma_f32_16x16x32_bf16 v[120:123], a[100:103], a[16:19], v[120:123]
ds_read_b64_tr_b16 a[88:89], v13 offset:16384
v_mfma_f32_16x16x32_bf16 v[128:131], a[100:103], a[20:23], v[128:131]
ds_read_b64_tr_b16 a[90:91], v13 offset:17408
v_mfma_f32_16x16x32_bf16 v[128:131], a[96:99], a[4:7], v[128:131]
ds_read_b64_tr_b16 a[92:93], v13 offset:24576
v_mfma_f32_16x16x32_bf16 v[136:139], a[96:99], a[8:11], v[136:139]
ds_read_b64_tr_b16 a[94:95], v13 offset:25600
v_mfma_f32_16x16x32_bf16 v[136:139], a[100:103], a[24:27], v[136:139]
v_mfma_f32_16x16x32_bf16 v[144:147], a[100:103], a[28:31], v[144:147]
s_add_u32 m0, s16, 0x8800
v_mfma_f32_16x16x32_bf16 v[144:147], a[96:99], a[12:15], v[144:147]
buffer_load_dwordx4 v2, s[48:51], s12 offen lds
v_mfma_f32_16x16x32_bf16 v[148:151], a[104:107], a[12:15], v[148:151]
ds_read_b64_tr_b16 a[96:97], v12 offset:16640
v_mfma_f32_16x16x32_bf16 v[148:151], a[108:111], a[28:31], v[148:151]
ds_read_b64_tr_b16 a[98:99], v12 offset:17664
v_mfma_f32_16x16x32_bf16 v[140:143], a[108:111], a[24:27], v[140:143]
ds_read_b64_tr_b16 a[100:101], v12 offset:24832
v_mfma_f32_16x16x32_bf16 v[140:143], a[104:107], a[8:11], v[140:143]
ds_read_b64_tr_b16 a[102:103], v12 offset:25856
v_mfma_f32_16x16x32_bf16 v[132:135], a[104:107], a[4:7], v[132:135]
v_mfma_f32_16x16x32_bf16 v[132:135], a[108:111], a[20:23], v[132:135]
s_add_u32 m0, s16, 0x8c00
v_mfma_f32_16x16x32_bf16 v[124:127], a[108:111], a[16:19], v[124:127]
buffer_load_dwordx4 v3, s[48:51], s12 offen lds
v_mfma_f32_16x16x32_bf16 v[124:127], a[104:107], a[0:3], v[124:127]
s_waitcnt lgkmcnt(4)
v_mfma_f32_16x16x32_bf16 v[152:155], a[0:3], a[80:83], v[152:155]
ds_read_b64_tr_b16 a[104:105], v13 offset:16640
v_mfma_f32_16x16x32_bf16 v[152:155], a[16:19], a[84:87], v[152:155]
ds_read_b64_tr_b16 a[106:107], v13 offset:17664
v_mfma_f32_16x16x32_bf16 v[156:159], a[20:23], a[84:87], v[156:159]
ds_read_b64_tr_b16 a[108:109], v13 offset:24832
v_mfma_f32_16x16x32_bf16 v[156:159], a[4:7], a[80:83], v[156:159]
ds_read_b64_tr_b16 a[110:111], v13 offset:25856
v_mfma_f32_16x16x32_bf16 v[160:163], a[8:11], a[80:83], v[160:163]
s_add_u32 m0, s16, 0x9000
v_mfma_f32_16x16x32_bf16 v[160:163], a[24:27], a[84:87], v[160:163]
buffer_load_dwordx4 v2, s[48:51], s13 offen lds
v_mfma_f32_16x16x32_bf16 v[164:167], a[28:31], a[84:87], v[164:167]
v_mfma_f32_16x16x32_bf16 v[164:167], a[12:15], a[80:83], v[164:167]
v_mfma_f32_16x16x32_bf16 v[180:183], a[12:15], a[88:91], v[180:183]
ds_read_b64_tr_b16 a[80:81], v12 offset:16896
v_mfma_f32_16x16x32_bf16 v[180:183], a[28:31], a[92:95], v[180:183]
ds_read_b64_tr_b16 a[82:83], v12 offset:17920
v_mfma_f32_16x16x32_bf16 v[176:179], a[24:27], a[92:95], v[176:179]
ds_read_b64_tr_b16 a[84:85], v12 offset:25088
v_mfma_f32_16x16x32_bf16 v[176:179], a[8:11], a[88:91], v[176:179]
ds_read_b64_tr_b16 a[86:87], v12 offset:26112
s_add_u32 m0, s16, 0x9400
v_mfma_f32_16x16x32_bf16 v[172:175], a[4:7], a[88:91], v[172:175]
buffer_load_dwordx4 v3, s[48:51], s13 offen lds
v_mfma_f32_16x16x32_bf16 v[172:175], a[20:23], a[92:95], v[172:175]
v_mfma_f32_16x16x32_bf16 v[168:171], a[16:19], a[92:95], v[168:171]
v_mfma_f32_16x16x32_bf16 v[168:171], a[0:3], a[88:91], v[168:171]
s_waitcnt lgkmcnt(4)
v_mfma_f32_16x16x32_bf16 v[184:187], a[0:3], a[96:99], v[184:187]
ds_read_b64_tr_b16 a[88:89], v13 offset:16896
v_mfma_f32_16x16x32_bf16 v[184:187], a[16:19], a[100:103], v[184:187]
ds_read_b64_tr_b16 a[90:91], v13 offset:17920
v_mfma_f32_16x16x32_bf16 v[188:191], a[20:23], a[100:103], v[188:191]
ds_read_b64_tr_b16 a[92:93], v13 offset:25088
s_add_u32 m0, s16, 0x9800
v_mfma_f32_16x16x32_bf16 v[188:191], a[4:7], a[96:99], v[188:191]
buffer_load_dwordx4 v2, s[48:51], s14 offen lds
v_mfma_f32_16x16x32_bf16 v[192:195], a[8:11], a[96:99], v[192:195]
ds_read_b64_tr_b16 a[94:95], v13 offset:26112
v_mfma_f32_16x16x32_bf16 v[192:195], a[24:27], a[100:103], v[192:195]
v_mfma_f32_16x16x32_bf16 v[196:199], a[28:31], a[100:103], v[196:199]
v_mfma_f32_16x16x32_bf16 v[196:199], a[12:15], a[96:99], v[196:199]
v_mfma_f32_16x16x32_bf16 v[212:215], a[12:15], a[104:107], v[212:215]
ds_read_b64_tr_b16 a[96:97], v12 offset:17152
v_mfma_f32_16x16x32_bf16 v[212:215], a[28:31], a[108:111], v[212:215]
ds_read_b64_tr_b16 a[98:99], v12 offset:18176
s_add_u32 m0, s16, 0x9c00
v_mfma_f32_16x16x32_bf16 v[208:211], a[24:27], a[108:111], v[208:211]
buffer_load_dwordx4 v3, s[48:51], s14 offen lds
v_mfma_f32_16x16x32_bf16 v[208:211], a[8:11], a[104:107], v[208:211]
ds_read_b64_tr_b16 a[100:101], v12 offset:25344
s_sub_u32 s42, s43, s41
v_mfma_f32_16x16x32_bf16 v[204:207], a[4:7], a[104:107], v[204:207]
ds_read_b64_tr_b16 a[102:103], v12 offset:26368
s_mov_b32 s41, s43
v_mfma_f32_16x16x32_bf16 v[204:207], a[20:23], a[108:111], v[204:207]
v_mfma_f32_16x16x32_bf16 v[200:203], a[16:19], a[108:111], v[200:203]
v_mfma_f32_16x16x32_bf16 v[200:203], a[0:3], a[104:107], v[200:203]
s_waitcnt lgkmcnt(4)
v_mfma_f32_16x16x32_bf16 v[216:219], a[0:3], a[80:83], v[216:219]
ds_read_b64_tr_b16 a[104:105], v13 offset:17152
s_mov_b32 s9, 0x800
v_mfma_f32_16x16x32_bf16 v[216:219], a[16:19], a[84:87], v[216:219]
buffer_load_dword a120, v1, s[68:71], s9 offen
v_mfma_f32_16x16x32_bf16 v[220:223], a[20:23], a[84:87], v[220:223]
ds_read_b64_tr_b16 a[106:107], v13 offset:18176
v_mfma_f32_16x16x32_bf16 v[220:223], a[4:7], a[80:83], v[220:223]
ds_read_b64_tr_b16 a[108:109], v13 offset:25344
v_mfma_f32_16x16x32_bf16 v[224:227], a[8:11], a[80:83], v[224:227]
ds_read_b64_tr_b16 a[110:111], v13 offset:26368
v_add_u32 v12, 0x8000, v12
v_mfma_f32_16x16x32_bf16 v[224:227], a[24:27], a[84:87], v[224:227]
v_add_u32 v13, 0x8000, v13
v_mfma_f32_16x16x32_bf16 v[228:231], a[28:31], a[84:87], v[228:231]
v_mfma_f32_16x16x32_bf16 v[228:231], a[12:15], a[80:83], v[228:231]
v_mfma_f32_16x16x32_bf16 v[244:247], a[12:15], a[88:91], v[244:247]
s_waitcnt vmcnt(28) lgkmcnt(0)
v_mfma_f32_16x16x32_bf16 v[244:247], a[28:31], a[92:95], v[244:247]
s_barrier
s_add_u32 m0, s17, 0x8000
v_mfma_f32_16x16x32_bf16 v[240:243], a[24:27], a[92:95], v[240:243]
buffer_load_dwordx4 v5, s[56:59], 0 offen lds
v_mfma_f32_16x16x32_bf16 v[240:243], a[8:11], a[88:91], v[240:243]
ds_read_b64_tr_b16 a[80:81], v12 offset:0
v_mfma_f32_16x16x32_bf16 v[236:239], a[4:7], a[88:91], v[236:239]
ds_read_b64_tr_b16 a[82:83], v12 offset:1024
v_mfma_f32_16x16x32_bf16 v[236:239], a[20:23], a[92:95], v[236:239]
ds_read_b64_tr_b16 a[84:85], v12 offset:8192
v_mfma_f32_16x16x32_bf16 v[232:235], a[16:19], a[92:95], v[232:235]
ds_read_b64_tr_b16 a[86:87], v12 offset:9216
v_mfma_f32_16x16x32_bf16 v[232:235], a[0:3], a[88:91], v[232:235]
s_waitcnt lgkmcnt(4)
v_mfma_f32_16x16x32_bf16 v[248:251], a[0:3], a[96:99], v[248:251]
ds_read_b64_tr_b16 a[88:89], v13 offset:0
s_add_u32 m0, s17, 0xc000
v_mfma_f32_16x16x32_bf16 v[248:251], a[16:19], a[100:103], v[248:251]
buffer_load_dwordx4 v5, s[60:63], 0 offen lds
v_mfma_f32_16x16x32_bf16 v[252:255], a[20:23], a[100:103], v[252:255]
ds_read_b64_tr_b16 a[90:91], v13 offset:1024
v_mfma_f32_16x16x32_bf16 v[252:255], a[4:7], a[96:99], v[252:255]
ds_read_b64_tr_b16 a[92:93], v13 offset:8192
v_mfma_f32_16x16x32_bf16 a[232:235], a[8:11], a[96:99], a[232:235]
ds_read_b64_tr_b16 a[94:95], v13 offset:9216
v_mfma_f32_16x16x32_bf16 a[232:235], a[24:27], a[100:103], a[232:235]
v_mfma_f32_16x16x32_bf16 a[236:239], a[28:31], a[100:103], a[236:239]
v_mfma_f32_16x16x32_bf16 a[236:239], a[12:15], a[96:99], a[236:239]
s_add_u32 m0, s17, 0x8400
v_mfma_f32_16x16x32_bf16 a[252:255], a[12:15], a[104:107], a[252:255]
buffer_load_dwordx4 v5, s[56:59], s13 offen lds
v_mfma_f32_16x16x32_bf16 a[252:255], a[28:31], a[108:111], a[252:255]
ds_read_b64_tr_b16 a[96:97], v12 offset:256
v_mfma_f32_16x16x32_bf16 a[248:251], a[24:27], a[108:111], a[248:251]
ds_read_b64_tr_b16 a[98:99], v12 offset:1280
v_mfma_f32_16x16x32_bf16 a[248:251], a[8:11], a[104:107], a[248:251]
ds_read_b64_tr_b16 a[100:101], v12 offset:8448
v_mfma_f32_16x16x32_bf16 a[244:247], a[4:7], a[104:107], a[244:247]
ds_read_b64_tr_b16 a[102:103], v12 offset:9472
v_mfma_f32_16x16x32_bf16 a[244:247], a[20:23], a[108:111], a[244:247]
v_mfma_f32_16x16x32_bf16 a[240:243], a[16:19], a[108:111], a[240:243]
v_mfma_f32_16x16x32_bf16 a[240:243], a[0:3], a[104:107], a[240:243]
s_add_u32 m0, s17, 0xc400
s_waitcnt lgkmcnt(4)
L_S5:
v_mfma_f32_16x16x32_bf16 v[24:27], a[80:83], a[32:35], v[24:27]
buffer_load_dwordx4 v5, s[60:63], s13 offen lds
v_mfma_f32_16x16x32_bf16 v[24:27], a[84:87], a[48:51], v[24:27]
ds_read_b64_tr_b16 a[104:105], v13 offset:256
s_waitcnt vmcnt(23)
v_mfma_f32_16x16x32_bf16 v[32:35], a[84:87], a[52:55], v[32:35]
ds_read_b64_tr_b16 a[106:107], v13 offset:1280
v_mfma_f32_16x16x32_bf16 v[32:35], a[80:83], a[36:39], v[32:35]
ds_read_b64_tr_b16 a[108:109], v13 offset:8448
v_mfma_f32_16x16x32_bf16 v[40:43], a[80:83], a[40:43], v[40:43]
ds_read_b64_tr_b16 a[110:111], v13 offset:9472
v_mfma_f32_16x16x32_bf16 v[40:43], a[84:87], a[56:59], v[40:43]
ds_read_b128 a[0:3], v8 offset:0
v_mfma_f32_16x16x32_bf16 v[48:51], a[84:87], a[60:63], v[48:51]
ds_read_b128 a[16:19], v9 offset:0
s_add_u32 m0, s17, 0x8800
v_mfma_f32_16x16x32_bf16 v[48:51], a[80:83], a[44:47], v[48:51]
buffer_load_dwordx4 v6, s[56:59], 0 offen lds
v_mfma_f32_16x16x32_bf16 v[52:55], a[88:91], a[44:47], v[52:55]
ds_read_b64_tr_b16 a[80:81], v12 offset:512
v_mfma_f32_16x16x32_bf16 v[52:55], a[92:95], a[60:63], v[52:55]
ds_read_b64_tr_b16 a[82:83], v12 offset:1536
v_mfma_f32_16x16x32_bf16 v[44:47], a[92:95], a[56:59], v[44:47]
ds_read_b64_tr_b16 a[84:85], v12 offset:8704
v_mfma_f32_16x16x32_bf16 v[44:47], a[88:91], a[40:43], v[44:47]
ds_read_b64_tr_b16 a[86:87], v12 offset:9728
v_mfma_f32_16x16x32_bf16 v[36:39], a[88:91], a[36:39], v[36:39]
ds_read_b128 a[4:7], v8 offset:2048
v_mfma_f32_16x16x32_bf16 v[36:39], a[92:95], a[52:55], v[36:39]
ds_read_b128 a[20:23], v9 offset:2048
s_waitcnt lgkmcnt(8)
v_mfma_f32_16x16x32_bf16 v[28:31], a[92:95], a[48:51], v[28:31]
ds_read_b128 a[8:11], v8 offset:4096
s_add_u32 m0, s17, 0xc800
v_mfma_f32_16x16x32_bf16 v[28:31], a[88:91], a[32:35], v[28:31]
buffer_load_dwordx4 v6, s[60:63], 0 offen lds
v_mfma_f32_16x16x32_bf16 v[56:59], a[96:99], a[32:35], v[56:59]
ds_read_b64_tr_b16 a[88:89], v13 offset:512
v_mfma_f32_16x16x32_bf16 v[56:59], a[100:103], a[48:51], v[56:59]
ds_read_b64_tr_b16 a[90:91], v13 offset:1536
v_mfma_f32_16x16x32_bf16 v[64:67], a[100:103], a[52:55], v[64:67]
ds_read_b64_tr_b16 a[92:93], v13 offset:8704
v_mfma_f32_16x16x32_bf16 v[64:67], a[96:99], a[36:39], v[64:67]
ds_read_b64_tr_b16 a[94:95], v13 offset:9728
v_mfma_f32_16x16x32_bf16 v[72:75], a[96:99], a[40:43], v[72:75]
ds_read_b128 a[24:27], v9 offset:4096
v_mfma_f32_16x16x32_bf16 v[72:75], a[100:103], a[56:59], v[72:75]
ds_read_b128 a[12:15], v8 offset:6144
s_add_u32 m0, s17, 0x8c00
v_mfma_f32_16x16x32_bf16 v[80:83], a[100:103], a[60:63], v[80:83]
buffer_load_dwordx4 v6, s[56:59], s13 offen lds
v_mfma_f32_16x16x32_bf16 v[80:83], a[96:99], a[44:47], v[80:83]
ds_read_b128 a[28:31], v9 offset:6144
v_mfma_f32_16x16x32_bf16 v[84:87], a[104:107], a[44:47], v[84:87]
ds_read_b64_tr_b16 a[96:97], v12 offset:768
v_mfma_f32_16x16x32_bf16 v[84:87], a[108:111], a[60:63], v[84:87]
ds_read_b64_tr_b16 a[98:99], v12 offset:1792
v_mfma_f32_16x16x32_bf16 v[76:79], a[108:111], a[56:59], v[76:79]
ds_read_b64_tr_b16 a[100:101], v12 offset:8960
v_mfma_f32_16x16x32_bf16 v[76:79], a[104:107], a[40:43], v[76:79]
ds_read_b64_tr_b16 a[102:103], v12 offset:9984
v_mfma_f32_16x16x32_bf16 v[68:71], a[104:107], a[36:39], v[68:71]
s_add_u32 m0, s17, 0xcc00
v_mfma_f32_16x16x32_bf16 v[68:71], a[108:111], a[52:55], v[68:71]
buffer_load_dwordx4 v6, s[60:63], s13 offen lds
v_mfma_f32_16x16x32_bf16 v[60:63], a[108:111], a[48:51], v[60:63]
v_lshl_add_u32 v5, s42, 19, v5
v_lshl_add_u32 v6, s42, 19, v6
v_mfma_f32_16x16x32_bf16 v[60:63], a[104:107], a[32:35], v[60:63]
s_waitcnt lgkmcnt(7)
v_mfma_f32_16x16x32_bf16 v[88:91], a[80:83], a[32:35], v[88:91]
ds_read_b64_tr_b16 a[104:105], v13 offset:768
v_mfma_f32_16x16x32_bf16 v[88:91], a[84:87], a[48:51], v[88:91]
ds_read_b64_tr_b16 a[106:107], v13 offset:1792
v_mfma_f32_16x16x32_bf16 v[96:99], a[84:87], a[52:55], v[96:99]
ds_read_b64_tr_b16 a[108:109], v13 offset:8960
v_mfma_f32_16x16x32_bf16 v[96:99], a[80:83], a[36:39], v[96:99]
ds_read_b64_tr_b16 a[110:111], v13 offset:9984
v_mfma_f32_16x16x32_bf16 v[104:107], a[80:83], a[40:43], v[104:107]
s_add_u32 m0, s16, 0x0
s_waitcnt lgkmcnt(8)
v_mfma_f32_16x16x32_bf16 v[104:107], a[84:87], a[56:59], v[104:107]
buffer_load_dwordx4 v22, s[44:47], s20 offen lds
v_mfma_f32_16x16x32_bf16 v[112:115], a[84:87], a[60:63], v[112:115]
v_mfma_f32_16x16x32_bf16 v[112:115], a[80:83], a[44:47], v[112:115]
v_mfma_f32_16x16x32_bf16 v[116:119], a[88:91], a[44:47], v[116:119]
ds_read_b64_tr_b16 a[80:81], v12 offset:16384
v_mfma_f32_16x16x32_bf16 v[116:119], a[92:95], a[60:63], v[116:119]
ds_read_b64_tr_b16 a[82:83], v12 offset:17408
v_mfma_f32_16x16x32_bf16 v[108:111], a[92:95], a[56:59], v[108:111]
ds_read_b64_tr_b16 a[84:85], v12 offset:24576
v_mfma_f32_16x16x32_bf16 v[108:111], a[88:91], a[40:43], v[108:111]
ds_read_b64_tr_b16 a[86:87], v12 offset:25600
s_add_u32 m0, s16, 0x400
v_mfma_f32_16x16x32_bf16 v[100:103], a[88:91], a[36:39], v[100:103]
buffer_load_dwordx4 v23, s[44:47], s20 offen lds
v_mfma_f32_16x16x32_bf16 v[100:103], a[92:95], a[52:55], v[100:103]
v_mfma_f32_16x16x32_bf16 v[92:95], a[92:95], a[48:51], v[92:95]
v_mfma_f32_16x16x32_bf16 v[92:95], a[88:91], a[32:35], v[92:95]
s_waitcnt lgkmcnt(4)
v_mfma_f32_16x16x32_bf16 v[120:123], a[96:99], a[32:35], v[120:123]
ds_read_b64_tr_b16 a[88:89], v13 offset:16384
v_mfma_f32_16x16x32_bf16 v[120:123], a[100:103], a[48:51], v[120:123]
ds_read_b64_tr_b16 a[90:91], v13 offset:17408
v_mfma_f32_16x16x32_bf16 v[128:131], a[100:103], a[52:55], v[128:131]
ds_read_b64_tr_b16 a[92:93], v13 offset:24576
v_mfma_f32_16x16x32_bf16 v[128:131], a[96:99], a[36:39], v[128:131]
ds_read_b64_tr_b16 a[94:95], v13 offset:25600
s_add_u32 m0, s16, 0x800
v_mfma_f32_16x16x32_bf16 v[136:139], a[96:99], a[40:43], v[136:139]
buffer_load_dwordx4 v22, s[44:47], s21 offen lds
v_mfma_f32_16x16x32_bf16 v[136:139], a[100:103], a[56:59], v[136:139]
v_mfma_f32_16x16x32_bf16 v[144:147], a[100:103], a[60:63], v[144:147]
v_mfma_f32_16x16x32_bf16 v[144:147], a[96:99], a[44:47], v[144:147]
v_mfma_f32_16x16x32_bf16 v[148:151], a[104:107], a[44:47], v[148:151]
ds_read_b64_tr_b16 a[96:97], v12 offset:16640
v_mfma_f32_16x16x32_bf16 v[148:151], a[108:111], a[60:63], v[148:151]
ds_read_b64_tr_b16 a[98:99], v12 offset:17664
v_mfma_f32_16x16x32_bf16 v[140:143], a[108:111], a[56:59], v[140:143]
ds_read_b64_tr_b16 a[100:101], v12 offset:24832
s_add_u32 m0, s16, 0xc00
v_mfma_f32_16x16x32_bf16 v[140:143], a[104:107], a[40:43], v[140:143]
buffer_load_dwordx4 v23, s[44:47], s21 offen lds
v_mfma_f32_16x16x32_bf16 v[132:135], a[104:107], a[36:39], v[132:135]
ds_read_b64_tr_b16 a[102:103], v12 offset:25856
v_mfma_f32_16x16x32_bf16 v[132:135], a[108:111], a[52:55], v[132:135]
v_mfma_f32_16x16x32_bf16 v[124:127], a[108:111], a[48:51], v[124:127]
v_mfma_f32_16x16x32_bf16 v[124:127], a[104:107], a[32:35], v[124:127]
s_waitcnt lgkmcnt(4)
v_mfma_f32_16x16x32_bf16 v[152:155], a[32:35], a[80:83], v[152:155]
ds_read_b64_tr_b16 a[104:105], v13 offset:16640
v_mfma_f32_16x16x32_bf16 v[152:155], a[48:51], a[84:87], v[152:155]
ds_read_b64_tr_b16 a[106:107], v13 offset:17664
s_add_u32 m0, s16, 0x1000
v_mfma_f32_16x16x32_bf16 v[156:159], a[52:55], a[84:87], v[156:159]
buffer_load_dwordx4 v22, s[44:47], s22 offen lds
v_mfma_f32_16x16x32_bf16 v[156:159], a[36:39], a[80:83], v[156:159]
ds_read_b64_tr_b16 a[108:109], v13 offset:24832
v_mfma_f32_16x16x32_bf16 v[160:163], a[40:43], a[80:83], v[160:163]
ds_read_b64_tr_b16 a[110:111], v13 offset:25856
v_mfma_f32_16x16x32_bf16 v[160:163], a[56:59], a[84:87], v[160:163]
v_mfma_f32_16x16x32_bf16 v[164:167], a[60:63], a[84:87], v[164:167]
v_mfma_f32_16x16x32_bf16 v[164:167], a[44:47], a[80:83], v[164:167]
v_mfma_f32_16x16x32_bf16 v[180:183], a[44:47], a[88:91], v[180:183]
ds_read_b64_tr_b16 a[80:81], v12 offset:16896
v_mfma_f32_16x16x32_bf16 v[180:183], a[60:63], a[92:95], v[180:183]
ds_read_b64_tr_b16 a[82:83], v12 offset:17920
s_add_u32 m0, s16, 0x1400
v_mfma_f32_16x16x32_bf16 v[176:179], a[56:59], a[92:95], v[176:179]
buffer_load_dwordx4 v23, s[44:47], s22 offen lds
v_mfma_f32_16x16x32_bf16 v[176:179], a[40:43], a[88:91], v[176:179]
ds_read_b64_tr_b16 a[84:85], v12 offset:25088
v_mfma_f32_16x16x32_bf16 v[172:175], a[36:39], a[88:91], v[172:175]
ds_read_b64_tr_b16 a[86:87], v12 offset:26112
v_mfma_f32_16x16x32_bf16 v[172:175], a[52:55], a[92:95], v[172:175]
v_mfma_f32_16x16x32_bf16 v[168:171], a[48:51], a[92:95], v[168:171]
v_mfma_f32_16x16x32_bf16 v[168:171], a[32:35], a[88:91], v[168:171]
s_waitcnt lgkmcnt(4)
v_mfma_f32_16x16x32_bf16 v[184:187], a[32:35], a[96:99], v[184:187]
ds_read_b64_tr_b16 a[88:89], v13 offset:16896
s_add_u32 m0, s16, 0x1800
v_mfma_f32_16x16x32_bf16 v[184:187], a[48:51], a[100:103], v[184:187]
buffer_load_dwordx4 v22, s[44:47], s23 offen lds
v_mfma_f32_16x16x32_bf16 v[188:191], a[52:55], a[100:103], v[188:191]
ds_read_b64_tr_b16 a[90:91], v13 offset:17920
v_mfma_f32_16x16x32_bf16 v[188:191], a[36:39], a[96:99], v[188:191]
ds_read_b64_tr_b16 a[92:93], v13 offset:25088
v_mfma_f32_16x16x32_bf16 v[192:195], a[40:43], a[96:99], v[192:195]
ds_read_b64_tr_b16 a[94:95], v13 offset:26112
v_mfma_f32_16x16x32_bf16 v[192:195], a[56:59], a[100:103], v[192:195]
v_mfma_f32_16x16x32_bf16 v[196:199], a[60:63], a[100:103], v[196:199]
v_mfma_f32_16x16x32_bf16 v[196:199], a[44:47], a[96:99], v[196:199]
v_mfma_f32_16x16x32_bf16 v[212:215], a[44:47], a[104:107], v[212:215]
ds_read_b64_tr_b16 a[96:97], v12 offset:17152
s_add_u32 m0, s16, 0x1c00
v_mfma_f32_16x16x32_bf16 v[212:215], a[60:63], a[108:111], v[212:215]
buffer_load_dwordx4 v23, s[44:47], s23 offen lds
v_mfma_f32_16x16x32_bf16 v[208:211], a[56:59], a[108:111], v[208:211]
ds_read_b64_tr_b16 a[98:99], v12 offset:18176
s_mov_b32 s42, 1
v_mfma_f32_16x16x32_bf16 v[208:211], a[40:43], a[104:107], v[208:211]
ds_read_b64_tr_b16 a[100:101], v12 offset:25344
v_lshl_add_u32 v22, s42, 7, v22
v_mfma_f32_16x16x32_bf16 v[204:207], a[36:39], a[104:107], v[204:207]
ds_read_b64_tr_b16 a[102:103], v12 offset:26368
v_lshl_add_u32 v23, s42, 7, v23
v_mfma_f32_16x16x32_bf16 v[204:207], a[52:55], a[108:111], v[204:207]
v_mfma_f32_16x16x32_bf16 v[200:203], a[48:51], a[108:111], v[200:203]
v_mfma_f32_16x16x32_bf16 v[200:203], a[32:35], a[104:107], v[200:203]
s_mov_b32 s9, 0x1000
s_waitcnt lgkmcnt(4)
v_mfma_f32_16x16x32_bf16 v[216:219], a[32:35], a[80:83], v[216:219]
buffer_load_dword a120, v1, s[68:71], s9 offen
v_mfma_f32_16x16x32_bf16 v[216:219], a[48:51], a[84:87], v[216:219]
ds_read_b64_tr_b16 a[104:105], v13 offset:17152
v_mfma_f32_16x16x32_bf16 v[220:223], a[52:55], a[84:87], v[220:223]
ds_read_b64_tr_b16 a[106:107], v13 offset:18176
v_mfma_f32_16x16x32_bf16 v[220:223], a[36:39], a[80:83], v[220:223]
ds_read_b64_tr_b16 a[108:109], v13 offset:25344
v_mfma_f32_16x16x32_bf16 v[224:227], a[40:43], a[80:83], v[224:227]
ds_read_b64_tr_b16 a[110:111], v13 offset:26368
v_add_u32 v12, 0xffff0000, v12
v_mfma_f32_16x16x32_bf16 v[224:227], a[56:59], a[84:87], v[224:227]
v_add_u32 v13, 0xffff0000, v13
v_mfma_f32_16x16x32_bf16 v[228:231], a[60:63], a[84:87], v[228:231]
v_mfma_f32_16x16x32_bf16 v[228:231], a[44:47], a[80:83], v[228:231]
v_mfma_f32_16x16x32_bf16 v[244:247], a[44:47], a[88:91], v[244:247]
s_waitcnt vmcnt(27) lgkmcnt(0)
v_mfma_f32_16x16x32_bf16 v[244:247], a[60:63], a[92:95], v[244:247]
s_barrier
s_add_u32 m0, s17, 0x10000
v_mfma_f32_16x16x32_bf16 v[240:243], a[56:59], a[92:95], v[240:243]
buffer_load_dwordx4 v5, s[52:55], 0 offen lds
v_mfma_f32_16x16x32_bf16 v[240:243], a[40:43], a[88:91], v[240:243]
ds_read_b64_tr_b16 a[80:81], v12 offset:0
s_mul_i32 s28, s5, 0x10c400
v_mfma_f32_16x16x32_bf16 v[236:239], a[36:39], a[88:91], v[236:239]
ds_read_b64_tr_b16 a[82:83], v12 offset:1024
s_mov_b32 s48, s88
v_mfma_f32_16x16x32_bf16 v[236:239], a[52:55], a[92:95], v[236:239]
ds_read_b64_tr_b16 a[84:85], v12 offset:8192
s_mov_b32 s49, s89
v_mfma_f32_16x16x32_bf16 v[232:235], a[48:51], a[92:95], v[232:235]
ds_read_b64_tr_b16 a[86:87], v12 offset:9216
s_sub_u32 s11, 16, s6
v_mfma_f32_16x16x32_bf16 v[232:235], a[32:35], a[88:91], v[232:235]
s_waitcnt lgkmcnt(4)
s_lshl_b32 s11, s11, 16
s_add_u32 s11, s11, s28
v_mfma_f32_16x16x32_bf16 v[248:251], a[32:35], a[96:99], v[248:251]
ds_read_b64_tr_b16 a[88:89], v13 offset:0
s_add_u32 m0, s17, 0x10400
v_mfma_f32_16x16x32_bf16 v[248:251], a[48:51], a[100:103], v[248:251]
buffer_load_dwordx4 v5, s[52:55], s13 offen lds
v_mfma_f32_16x16x32_bf16 v[252:255], a[52:55], a[100:103], v[252:255]
ds_read_b64_tr_b16 a[90:91], v13 offset:1024
s_add_u32 s50, s11, 0x2000
v_mfma_f32_16x16x32_bf16 v[252:255], a[36:39], a[96:99], v[252:255]
ds_read_b64_tr_b16 a[92:93], v13 offset:8192
s_lshl_b32 s11, s6, 17
v_mfma_f32_16x16x32_bf16 a[232:235], a[40:43], a[96:99], a[232:235]
ds_read_b64_tr_b16 a[94:95], v13 offset:9216
s_add_u32 s28, s28, s11
v_mfma_f32_16x16x32_bf16 a[232:235], a[56:59], a[100:103], a[232:235]
s_lshl_b32 s11, s4, 15
s_add_u32 s28, s28, s11
s_lshl_b32 s10, s5, 2
v_mfma_f32_16x16x32_bf16 a[236:239], a[60:63], a[100:103], a[236:239]
s_add_u32 s10, s10, 64
v_mfma_f32_16x16x32_bf16 a[236:239], a[44:47], a[96:99], a[236:239]
s_add_u32 m0, s17, 0x10800
v_mfma_f32_16x16x32_bf16 a[252:255], a[44:47], a[104:107], a[252:255]
buffer_load_dwordx4 v6, s[52:55], 0 offen lds
v_mfma_f32_16x16x32_bf16 a[252:255], a[60:63], a[108:111], a[252:255]
ds_read_b64_tr_b16 a[96:97], v12 offset:256
L_padA3:
s_cmp_eq_u32 s95, 1
s_cbranch_scc1 L_padA7
v_mfma_f32_16x16x32_bf16 a[248:251], a[56:59], a[108:111], a[248:251]
ds_read_b64_tr_b16 a[98:99], v12 offset:1280
v_mfma_f32_16x16x32_bf16 a[248:251], a[40:43], a[104:107], a[248:251]
ds_read_b64_tr_b16 a[100:101], v12 offset:8448
v_mfma_f32_16x16x32_bf16 a[244:247], a[36:39], a[104:107], a[244:247]
ds_read_b64_tr_b16 a[102:103], v12 offset:9472
v_mfma_f32_16x16x32_bf16 a[244:247], a[52:55], a[108:111], a[244:247]
v_mfma_f32_16x16x32_bf16 a[240:243], a[48:51], a[108:111], a[240:243]
v_mfma_f32_16x16x32_bf16 a[240:243], a[32:35], a[104:107], a[240:243]
s_add_u32 m0, s17, 0x10c00
s_waitcnt lgkmcnt(4)
L_S6:
v_mfma_f32_16x16x32_bf16 v[24:27], a[80:83], a[0:3], v[24:27]
buffer_load_dwordx4 v6, s[52:55], s13 offen lds
v_mfma_f32_16x16x32_bf16 v[24:27], a[84:87], a[16:19], v[24:27]
ds_read_b64_tr_b16 a[104:105], v13 offset:256
s_waitcnt vmcnt(22)
v_mfma_f32_16x16x32_bf16 v[32:35], a[84:87], a[20:23], v[32:35]
ds_read_b64_tr_b16 a[106:107], v13 offset:1280
v_mfma_f32_16x16x32_bf16 v[32:35], a[80:83], a[4:7], v[32:35]
ds_read_b64_tr_b16 a[108:109], v13 offset:8448
v_mfma_f32_16x16x32_bf16 v[40:43], a[80:83], a[8:11], v[40:43]
ds_read_b64_tr_b16 a[110:111], v13 offset:9472
v_mfma_f32_16x16x32_bf16 v[40:43], a[84:87], a[24:27], v[40:43]
ds_read_b128 a[32:35], v8 offset:32768
v_mfma_f32_16x16x32_bf16 v[48:51], a[84:87], a[28:31], v[48:51]
ds_read_b128 a[48:51], v9 offset:32768
s_add_u32 m0, s18, 0x14000
v_mfma_f32_16x16x32_bf16 v[48:51], a[80:83], a[12:15], v[48:51]
buffer_load_dwordx4 v7, s[68:71], 0 offen lds
v_mfma_f32_16x16x32_bf16 v[52:55], a[88:91], a[12:15], v[52:55]
ds_read_b64_tr_b16 a[80:81], v12 offset:512
v_mfma_f32_16x16x32_bf16 v[52:55], a[92:95], a[28:31], v[52:55]
ds_read_b64_tr_b16 a[82:83], v12 offset:1536
v_mfma_f32_16x16x32_bf16 v[44:47], a[92:95], a[24:27], v[44:47]
ds_read_b64_tr_b16 a[84:85], v12 offset:8704
v_mfma_f32_16x16x32_bf16 v[44:47], a[88:91], a[8:11], v[44:47]
ds_read_b64_tr_b16 a[86:87], v12 offset:9728
v_mfma_f32_16x16x32_bf16 v[36:39], a[88:91], a[4:7], v[36:39]
ds_read_b128 a[36:39], v8 offset:34816
v_mfma_f32_16x16x32_bf16 v[36:39], a[92:95], a[20:23], v[36:39]
ds_read_b128 a[52:55], v9 offset:34816
s_waitcnt lgkmcnt(8)
v_mfma_f32_16x16x32_bf16 v[28:31], a[92:95], a[16:19], v[28:31]
ds_read_b128 a[40:43], v8 offset:36864
s_add_u32 m0, s18, 0x15000
v_mfma_f32_16x16x32_bf16 v[28:31], a[88:91], a[0:3], v[28:31]
buffer_load_dwordx4 v7, s[68:71], s25 offen lds
v_mfma_f32_16x16x32_bf16 v[56:59], a[96:99], a[0:3], v[56:59]
ds_read_b64_tr_b16 a[88:89], v13 offset:512
v_mfma_f32_16x16x32_bf16 v[56:59], a[100:103], a[16:19], v[56:59]
ds_read_b64_tr_b16 a[90:91], v13 offset:1536
v_mfma_f32_16x16x32_bf16 v[64:67], a[100:103], a[20:23], v[64:67]
ds_read_b64_tr_b16 a[92:93], v13 offset:8704
v_mfma_f32_16x16x32_bf16 v[64:67], a[96:99], a[4:7], v[64:67]
ds_read_b64_tr_b16 a[94:95], v13 offset:9728
v_mfma_f32_16x16x32_bf16 v[72:75], a[96:99], a[8:11], v[72:75]
ds_read_b128 a[56:59], v9 offset:36864
v_mfma_f32_16x16x32_bf16 v[72:75], a[100:103], a[24:27], v[72:75]
ds_read_b128 a[44:47], v8 offset:38912
s_add_u32 m0, s18, 0x16000
v_mfma_f32_16x16x32_bf16 v[80:83], a[100:103], a[28:31], v[80:83]
buffer_load_dwordx4 v7, s[68:71], s26 offen lds
v_mfma_f32_16x16x32_bf16 v[80:83], a[96:99], a[12:15], v[80:83]
ds_read_b128 a[60:63], v9 offset:38912
v_lshl_add_u32 v5, s42, 19, v5
v_mfma_f32_16x16x32_bf16 v[84:87], a[104:107], a[12:15], v[84:87]
ds_read_b64_tr_b16 a[96:97], v12 offset:768
v_lshl_add_u32 v6, s42, 19, v6
v_mfma_f32_16x16x32_bf16 v[84:87], a[108:111], a[28:31], v[84:87]
ds_read_b64_tr_b16 a[98:99], v12 offset:1792
v_lshl_add_u32 v7, s42, 18, v7
v_mfma_f32_16x16x32_bf16 v[76:79], a[108:111], a[24:27], v[76:79]
ds_read_b64_tr_b16 a[100:101], v12 offset:8960
v_lshl_add_u32 v7, s42, 17, v7
v_mfma_f32_16x16x32_bf16 v[76:79], a[104:107], a[8:11], v[76:79]
ds_read_b64_tr_b16 a[102:103], v12 offset:9984
v_mfma_f32_16x16x32_bf16 v[68:71], a[104:107], a[4:7], v[68:71]
v_mfma_f32_16x16x32_bf16 v[68:71], a[108:111], a[20:23], v[68:71]
buffer_store_dwordx4 a[64:67], v4, s[88:91], 0 offen sc1
v_mfma_f32_16x16x32_bf16 v[60:63], a[108:111], a[16:19], v[60:63]
v_mfma_f32_16x16x32_bf16 v[60:63], a[104:107], a[0:3], v[60:63]
s_waitcnt lgkmcnt(7)
v_mfma_f32_16x16x32_bf16 v[88:91], a[80:83], a[0:3], v[88:91]
ds_read_b64_tr_b16 a[104:105], v13 offset:768
v_mfma_f32_16x16x32_bf16 v[88:91], a[84:87], a[16:19], v[88:91]
ds_read_b64_tr_b16 a[106:107], v13 offset:1792
v_mfma_f32_16x16x32_bf16 v[96:99], a[84:87], a[20:23], v[96:99]
ds_read_b64_tr_b16 a[108:109], v13 offset:8960
v_mfma_f32_16x16x32_bf16 v[96:99], a[80:83], a[4:7], v[96:99]
ds_read_b64_tr_b16 a[110:111], v13 offset:9984
v_mfma_f32_16x16x32_bf16 v[104:107], a[80:83], a[8:11], v[104:107]
s_add_u32 m0, s16, 0x8000
s_waitcnt lgkmcnt(8)
v_mfma_f32_16x16x32_bf16 v[104:107], a[84:87], a[24:27], v[104:107]
buffer_load_dwordx4 v22, s[44:47], s20 offen lds
v_mfma_f32_16x16x32_bf16 v[112:115], a[84:87], a[28:31], v[112:115]
v_mfma_f32_16x16x32_bf16 v[112:115], a[80:83], a[12:15], v[112:115]
v_mfma_f32_16x16x32_bf16 v[116:119], a[88:91], a[12:15], v[116:119]
ds_read_b64_tr_b16 a[80:81], v12 offset:16384
v_mfma_f32_16x16x32_bf16 v[116:119], a[92:95], a[28:31], v[116:119]
ds_read_b64_tr_b16 a[82:83], v12 offset:17408
v_mfma_f32_16x16x32_bf16 v[108:111], a[92:95], a[24:27], v[108:111]
ds_read_b64_tr_b16 a[84:85], v12 offset:24576
v_mfma_f32_16x16x32_bf16 v[108:111], a[88:91], a[8:11], v[108:111]
ds_read_b64_tr_b16 a[86:87], v12 offset:25600
s_add_u32 m0, s16, 0x8400
v_mfma_f32_16x16x32_bf16 v[100:103], a[88:91], a[4:7], v[100:103]
buffer_load_dwordx4 v23, s[44:47], s20 offen lds
v_mfma_f32_16x16x32_bf16 v[100:103], a[92:95], a[20:23], v[100:103]
v_mfma_f32_16x16x32_bf16 v[92:95], a[92:95], a[16:19], v[92:95]
v_mfma_f32_16x16x32_bf16 v[92:95], a[88:91], a[0:3], v[92:95]
s_waitcnt lgkmcnt(4)
v_mfma_f32_16x16x32_bf16 v[120:123], a[96:99], a[0:3], v[120:123]
ds_read_b64_tr_b16 a[88:89], v13 offset:16384
v_mfma_f32_16x16x32_bf16 v[120:123], a[100:103], a[16:19], v[120:123]
ds_read_b64_tr_b16 a[90:91], v13 offset:17408
v_mfma_f32_16x16x32_bf16 v[128:131], a[100:103], a[20:23], v[128:131]
ds_read_b64_tr_b16 a[92:93], v13 offset:24576
v_mfma_f32_16x16x32_bf16 v[128:131], a[96:99], a[4:7], v[128:131]
ds_read_b64_tr_b16 a[94:95], v13 offset:25600
s_add_u32 m0, s16, 0x8800
v_mfma_f32_16x16x32_bf16 v[136:139], a[96:99], a[8:11], v[136:139]
buffer_load_dwordx4 v22, s[44:47], s21 offen lds
v_mfma_f32_16x16x32_bf16 v[136:139], a[100:103], a[24:27], v[136:139]
v_mfma_f32_16x16x32_bf16 v[144:147], a[100:103], a[28:31], v[144:147]
v_mfma_f32_16x16x32_bf16 v[144:147], a[96:99], a[12:15], v[144:147]
v_mfma_f32_16x16x32_bf16 v[148:151], a[104:107], a[12:15], v[148:151]
ds_read_b64_tr_b16 a[96:97], v12 offset:16640
v_mfma_f32_16x16x32_bf16 v[148:151], a[108:111], a[28:31], v[148:151]
ds_read_b64_tr_b16 a[98:99], v12 offset:17664
v_mfma_f32_16x16x32_bf16 v[140:143], a[108:111], a[24:27], v[140:143]
ds_read_b64_tr_b16 a[100:101], v12 offset:24832
s_add_u32 m0, s16, 0x8c00
v_mfma_f32_16x16x32_bf16 v[140:143], a[104:107], a[8:11], v[140:143]
buffer_load_dwordx4 v23, s[44:47], s21 offen lds
v_mfma_f32_16x16x32_bf16 v[132:135], a[104:107], a[4:7], v[132:135]
ds_read_b64_tr_b16 a[102:103], v12 offset:25856
v_mfma_f32_16x16x32_bf16 v[132:135], a[108:111], a[20:23], v[132:135]
v_mfma_f32_16x16x32_bf16 v[124:127], a[108:111], a[16:19], v[124:127]
v_mfma_f32_16x16x32_bf16 v[124:127], a[104:107], a[0:3], v[124:127]
s_waitcnt lgkmcnt(4)
v_mfma_f32_16x16x32_bf16 v[152:155], a[0:3], a[80:83], v[152:155]
ds_read_b64_tr_b16 a[104:105], v13 offset:16640
v_mfma_f32_16x16x32_bf16 v[152:155], a[16:19], a[84:87], v[152:155]
ds_read_b64_tr_b16 a[106:107], v13 offset:17664
s_add_u32 m0, s16, 0x9000
v_mfma_f32_16x16x32_bf16 v[156:159], a[20:23], a[84:87], v[156:159]
buffer_load_dwordx4 v22, s[44:47], s22 offen lds
v_mfma_f32_16x16x32_bf16 v[156:159], a[4:7], a[80:83], v[156:159]
ds_read_b64_tr_b16 a[108:109], v13 offset:24832
v_mfma_f32_16x16x32_bf16 v[160:163], a[8:11], a[80:83], v[160:163]
ds_read_b64_tr_b16 a[110:111], v13 offset:25856
v_mfma_f32_16x16x32_bf16 v[160:163], a[24:27], a[84:87], v[160:163]
v_mfma_f32_16x16x32_bf16 v[164:167], a[28:31], a[84:87], v[164:167]
v_mfma_f32_16x16x32_bf16 v[164:167], a[12:15], a[80:83], v[164:167]
v_mfma_f32_16x16x32_bf16 v[180:183], a[12:15], a[88:91], v[180:183]
ds_read_b64_tr_b16 a[80:81], v12 offset:16896
v_mfma_f32_16x16x32_bf16 v[180:183], a[28:31], a[92:95], v[180:183]
ds_read_b64_tr_b16 a[82:83], v12 offset:17920
s_add_u32 m0, s16, 0x9400
v_mfma_f32_16x16x32_bf16 v[176:179], a[24:27], a[92:95], v[176:179]
buffer_load_dwordx4 v23, s[44:47], s22 offen lds
v_mfma_f32_16x16x32_bf16 v[176:179], a[8:11], a[88:91], v[176:179]
ds_read_b64_tr_b16 a[84:85], v12 offset:25088
v_mfma_f32_16x16x32_bf16 v[172:175], a[4:7], a[88:91], v[172:175]
ds_read_b64_tr_b16 a[86:87], v12 offset:26112
v_mfma_f32_16x16x32_bf16 v[172:175], a[20:23], a[92:95], v[172:175]
v_mfma_f32_16x16x32_bf16 v[168:171], a[16:19], a[92:95], v[168:171]
v_mfma_f32_16x16x32_bf16 v[168:171], a[0:3], a[88:91], v[168:171]
s_waitcnt lgkmcnt(4)
v_mfma_f32_16x16x32_bf16 v[184:187], a[0:3], a[96:99], v[184:187]
ds_read_b64_tr_b16 a[88:89], v13 offset:16896
s_add_u32 m0, s16, 0x9800
v_mfma_f32_16x16x32_bf16 v[184:187], a[16:19], a[100:103], v[184:187]
buffer_load_dwordx4 v22, s[44:47], s23 offen lds
v_mfma_f32_16x16x32_bf16 v[188:191], a[20:23], a[100:103], v[188:191]
ds_read_b64_tr_b16 a[90:91], v13 offset:17920
v_mfma_f32_16x16x32_bf16 v[188:191], a[4:7], a[96:99], v[188:191]
ds_read_b64_tr_b16 a[92:93], v13 offset:25088
v_mfma_f32_16x16x32_bf16 v[192:195], a[8:11], a[96:99], v[192:195]
ds_read_b64_tr_b16 a[94:95], v13 offset:26112
v_mfma_f32_16x16x32_bf16 v[192:195], a[24:27], a[100:103], v[192:195]
v_mfma_f32_16x16x32_bf16 v[196:199], a[28:31], a[100:103], v[196:199]
v_mfma_f32_16x16x32_bf16 v[196:199], a[12:15], a[96:99], v[196:199]
v_mfma_f32_16x16x32_bf16 v[212:215], a[12:15], a[104:107], v[212:215]
ds_read_b64_tr_b16 a[96:97], v12 offset:17152
s_add_u32 m0, s16, 0x9c00
v_mfma_f32_16x16x32_bf16 v[212:215], a[28:31], a[108:111], v[212:215]
buffer_load_dwordx4 v23, s[44:47], s23 offen lds
v_mfma_f32_16x16x32_bf16 v[208:211], a[24:27], a[108:111], v[208:211]
ds_read_b64_tr_b16 a[98:99], v12 offset:18176
v_lshl_add_u32 v22, s42, 7, v22
v_mfma_f32_16x16x32_bf16 v[208:211], a[8:11], a[104:107], v[208:211]
ds_read_b64_tr_b16 a[100:101], v12 offset:25344
v_lshl_add_u32 v23, s42, 7, v23
v_mfma_f32_16x16x32_bf16 v[204:207], a[4:7], a[104:107], v[204:207]
ds_read_b64_tr_b16 a[102:103], v12 offset:26368
v_mfma_f32_16x16x32_bf16 v[204:207], a[20:23], a[108:111], v[204:207]
v_mfma_f32_16x16x32_bf16 v[200:203], a[16:19], a[108:111], v[200:203]
v_mfma_f32_16x16x32_bf16 v[200:203], a[0:3], a[104:107], v[200:203]
s_mov_b32 s9, 0x200000
s_waitcnt lgkmcnt(4)
v_mfma_f32_16x16x32_bf16 v[216:219], a[0:3], a[80:83], v[216:219]
buffer_load_dword a120, v18, s[52:55], s9 offen
v_mfma_f32_16x16x32_bf16 v[216:219], a[16:19], a[84:87], v[216:219]
ds_read_b64_tr_b16 a[104:105], v13 offset:17152
v_mfma_f32_16x16x32_bf16 v[220:223], a[20:23], a[84:87], v[220:223]
ds_read_b64_tr_b16 a[106:107], v13 offset:18176
v_mfma_f32_16x16x32_bf16 v[220:223], a[4:7], a[80:83], v[220:223]
ds_read_b64_tr_b16 a[108:109], v13 offset:25344
v_mfma_f32_16x16x32_bf16 v[224:227], a[8:11], a[80:83], v[224:227]
ds_read_b64_tr_b16 a[110:111], v13 offset:26368
v_add_u32 v12, 0x8000, v12
v_mfma_f32_16x16x32_bf16 v[224:227], a[24:27], a[84:87], v[224:227]
v_add_u32 v13, 0x8000, v13
v_mfma_f32_16x16x32_bf16 v[228:231], a[28:31], a[84:87], v[228:231]
v_mfma_f32_16x16x32_bf16 v[228:231], a[12:15], a[80:83], v[228:231]
v_mfma_f32_16x16x32_bf16 v[244:247], a[12:15], a[88:91], v[244:247]
s_waitcnt vmcnt(26) lgkmcnt(0)
v_mfma_f32_16x16x32_bf16 v[244:247], a[28:31], a[92:95], v[244:247]
s_barrier
s_add_u32 m0, s17, 0x0
v_mfma_f32_16x16x32_bf16 v[240:243], a[24:27], a[92:95], v[240:243]
buffer_load_dwordx4 v5, s[52:55], 0 offen lds
v_mfma_f32_16x16x32_bf16 v[240:243], a[8:11], a[88:91], v[240:243]
ds_read_b64_tr_b16 a[80:81], v12 offset:0
v_mfma_f32_16x16x32_bf16 v[236:239], a[4:7], a[88:91], v[236:239]
ds_read_b64_tr_b16 a[82:83], v12 offset:1024
v_mfma_f32_16x16x32_bf16 v[236:239], a[20:23], a[92:95], v[236:239]
ds_read_b64_tr_b16 a[84:85], v12 offset:8192
v_mfma_f32_16x16x32_bf16 v[232:235], a[16:19], a[92:95], v[232:235]
ds_read_b64_tr_b16 a[86:87], v12 offset:9216
v_mfma_f32_16x16x32_bf16 v[232:235], a[0:3], a[88:91], v[232:235]
s_waitcnt lgkmcnt(4)
v_mfma_f32_16x16x32_bf16 v[248:251], a[0:3], a[96:99], v[248:251]
ds_read_b64_tr_b16 a[88:89], v13 offset:0
s_add_u32 m0, s17, 0x400
v_mfma_f32_16x16x32_bf16 v[248:251], a[16:19], a[100:103], v[248:251]
buffer_load_dwordx4 v5, s[52:55], s13 offen lds
v_mfma_f32_16x16x32_bf16 v[252:255], a[20:23], a[100:103], v[252:255]
ds_read_b64_tr_b16 a[90:91], v13 offset:1024
v_mfma_f32_16x16x32_bf16 v[252:255], a[4:7], a[96:99], v[252:255]
ds_read_b64_tr_b16 a[92:93], v13 offset:8192
v_mfma_f32_16x16x32_bf16 a[232:235], a[8:11], a[96:99], a[232:235]
ds_read_b64_tr_b16 a[94:95], v13 offset:9216
v_mfma_f32_16x16x32_bf16 a[232:235], a[24:27], a[100:103], a[232:235]
v_mfma_f32_16x16x32_bf16 a[236:239], a[28:31], a[100:103], a[236:239]
v_mfma_f32_16x16x32_bf16 a[236:239], a[12:15], a[96:99], a[236:239]
s_add_u32 m0, s17, 0x800
v_mfma_f32_16x16x32_bf16 a[252:255], a[12:15], a[104:107], a[252:255]
buffer_load_dwordx4 v6, s[52:55], 0 offen lds
v_mfma_f32_16x16x32_bf16 a[252:255], a[28:31], a[108:111], a[252:255]
ds_read_b64_tr_b16 a[96:97], v12 offset:256
v_mfma_f32_16x16x32_bf16 a[248:251], a[24:27], a[108:111], a[248:251]
ds_read_b64_tr_b16 a[98:99], v12 offset:1280
v_mfma_f32_16x16x32_bf16 a[248:251], a[8:11], a[104:107], a[248:251]
ds_read_b64_tr_b16 a[100:101], v12 offset:8448
v_mfma_f32_16x16x32_bf16 a[244:247], a[4:7], a[104:107], a[244:247]
ds_read_b64_tr_b16 a[102:103], v12 offset:9472
v_mfma_f32_16x16x32_bf16 a[244:247], a[20:23], a[108:111], a[244:247]
v_mfma_f32_16x16x32_bf16 a[240:243], a[16:19], a[108:111], a[240:243]
v_mfma_f32_16x16x32_bf16 a[240:243], a[0:3], a[104:107], a[240:243]
s_add_u32 m0, s17, 0xc00
s_waitcnt lgkmcnt(4)
L_S7:
v_mfma_f32_16x16x32_bf16 v[24:27], a[80:83], a[32:35], v[24:27]
buffer_load_dwordx4 v6, s[52:55], s13 offen lds
v_mfma_f32_16x16x32_bf16 v[24:27], a[84:87], a[48:51], v[24:27]
ds_read_b64_tr_b16 a[104:105], v13 offset:256
s_waitcnt vmcnt(22)
v_mfma_f32_16x16x32_bf16 v[32:35], a[84:87], a[52:55], v[32:35]
ds_read_b64_tr_b16 a[106:107], v13 offset:1280
v_mfma_f32_16x16x32_bf16 v[32:35], a[80:83], a[36:39], v[32:35]
ds_read_b64_tr_b16 a[108:109], v13 offset:8448
v_mfma_f32_16x16x32_bf16 v[40:43], a[80:83], a[40:43], v[40:43]
ds_read_b64_tr_b16 a[110:111], v13 offset:9472
v_mfma_f32_16x16x32_bf16 v[40:43], a[84:87], a[56:59], v[40:43]
ds_read_b128 a[0:3], v8 offset:0
v_mfma_f32_16x16x32_bf16 v[48:51], a[84:87], a[60:63], v[48:51]
ds_read_b128 a[16:19], v9 offset:0
s_add_u32 m0, s18, 0x4000
v_mfma_f32_16x16x32_bf16 v[48:51], a[80:83], a[44:47], v[48:51]
buffer_load_dwordx4 v7, s[68:71], 0 offen lds
v_mfma_f32_16x16x32_bf16 v[52:55], a[88:91], a[44:47], v[52:55]
ds_read_b64_tr_b16 a[80:81], v12 offset:512
v_mfma_f32_16x16x32_bf16 v[52:55], a[92:95], a[60:63], v[52:55]
ds_read_b64_tr_b16 a[82:83], v12 offset:1536
v_mfma_f32_16x16x32_bf16 v[44:47], a[92:95], a[56:59], v[44:47]
ds_read_b64_tr_b16 a[84:85], v12 offset:8704
v_mfma_f32_16x16x32_bf16 v[44:47], a[88:91], a[40:43], v[44:47]
ds_read_b64_tr_b16 a[86:87], v12 offset:9728
v_mfma_f32_16x16x32_bf16 v[36:39], a[88:91], a[36:39], v[36:39]
ds_read_b128 a[4:7], v8 offset:2048
v_mfma_f32_16x16x32_bf16 v[36:39], a[92:95], a[52:55], v[36:39]
ds_read_b128 a[20:23], v9 offset:2048
s_waitcnt lgkmcnt(8)
v_mfma_f32_16x16x32_bf16 v[28:31], a[92:95], a[48:51], v[28:31]
ds_read_b128 a[8:11], v8 offset:4096
s_add_u32 m0, s18, 0x5000
v_mfma_f32_16x16x32_bf16 v[28:31], a[88:91], a[32:35], v[28:31]
buffer_load_dwordx4 v7, s[68:71], s25 offen lds
v_mfma_f32_16x16x32_bf16 v[56:59], a[96:99], a[32:35], v[56:59]
ds_read_b64_tr_b16 a[88:89], v13 offset:512
v_mfma_f32_16x16x32_bf16 v[56:59], a[100:103], a[48:51], v[56:59]
ds_read_b64_tr_b16 a[90:91], v13 offset:1536
v_mfma_f32_16x16x32_bf16 v[64:67], a[100:103], a[52:55], v[64:67]
ds_read_b64_tr_b16 a[92:93], v13 offset:8704
v_mfma_f32_16x16x32_bf16 v[64:67], a[96:99], a[36:39], v[64:67]
ds_read_b64_tr_b16 a[94:95], v13 offset:9728
v_cvt_pk_bf16_f32 v24, v24, v25
v_cvt_pk_bf16_f32 v25, v26, v27
v_mfma_f32_16x16x32_bf16 v[72:75], a[96:99], a[40:43], v[72:75]
ds_read_b128 a[24:27], v9 offset:4096
v_cvt_pk_bf16_f32 v26, v28, v29
v_mfma_f32_16x16x32_bf16 v[72:75], a[100:103], a[56:59], v[72:75]
ds_read_b128 a[12:15], v8 offset:6144
s_add_u32 m0, s18, 0x6000
v_mfma_f32_16x16x32_bf16 v[80:83], a[100:103], a[60:63], v[80:83]
buffer_load_dwordx4 v7, s[68:71], s26 offen lds
v_cvt_pk_bf16_f32 v27, v30, v31
v_mfma_f32_16x16x32_bf16 v[80:83], a[96:99], a[44:47], v[80:83]
ds_read_b128 a[28:31], v9 offset:6144
v_lshl_add_u32 v5, s42, 19, v5
v_mfma_f32_16x16x32_bf16 v[84:87], a[104:107], a[44:47], v[84:87]
ds_read_b64_tr_b16 a[96:97], v12 offset:768
v_lshl_add_u32 v6, s42, 19, v6
v_mfma_f32_16x16x32_bf16 v[84:87], a[108:111], a[60:63], v[84:87]
ds_read_b64_tr_b16 a[98:99], v12 offset:1792
v_lshl_add_u32 v7, s42, 18, v7
v_accvgpr_write_b32 a128, v24
v_mfma_f32_16x16x32_bf16 v[76:79], a[108:111], a[56:59], v[76:79]
ds_read_b64_tr_b16 a[100:101], v12 offset:8960
v_lshl_add_u32 v7, s42, 17, v7
v_mfma_f32_16x16x32_bf16 v[76:79], a[104:107], a[40:43], v[76:79]
ds_read_b64_tr_b16 a[102:103], v12 offset:9984
v_accvgpr_write_b32 a129, v25
v_mfma_f32_16x16x32_bf16 v[68:71], a[104:107], a[36:39], v[68:71]
s_mov_b32 s9, 0x400000
v_accvgpr_write_b32 a130, v26
v_accvgpr_write_b32 a131, v27
v_cvt_pk_bf16_f32 v32, v32, v33
v_mfma_f32_16x16x32_bf16 v[68:71], a[108:111], a[52:55], v[68:71]
buffer_load_dword a120, v18, s[52:55], s9 offen
v_mfma_f32_16x16x32_bf16 v[60:63], a[108:111], a[48:51], v[60:63]
v_cvt_pk_bf16_f32 v33, v34, v35
v_cvt_pk_bf16_f32 v34, v36, v37
v_mfma_f32_16x16x32_bf16 v[60:63], a[104:107], a[32:35], v[60:63]
s_waitcnt lgkmcnt(7)
v_cvt_pk_bf16_f32 v35, v38, v39
v_accvgpr_write_b32 a132, v32
v_accvgpr_write_b32 a133, v33
v_mfma_f32_16x16x32_bf16 v[88:91], a[80:83], a[32:35], v[88:91]
ds_read_b64_tr_b16 a[104:105], v13 offset:768
v_accvgpr_write_b32 a134, v34
v_mfma_f32_16x16x32_bf16 v[88:91], a[84:87], a[48:51], v[88:91]
ds_read_b64_tr_b16 a[106:107], v13 offset:1792
v_accvgpr_write_b32 a135, v35
v_mfma_f32_16x16x32_bf16 v[96:99], a[84:87], a[52:55], v[96:99]
ds_read_b64_tr_b16 a[108:109], v13 offset:8960
v_cvt_pk_bf16_f32 v40, v40, v41
v_cvt_pk_bf16_f32 v41, v42, v43
v_mfma_f32_16x16x32_bf16 v[96:99], a[80:83], a[36:39], v[96:99]
ds_read_b64_tr_b16 a[110:111], v13 offset:9984
v_cvt_pk_bf16_f32 v42, v44, v45
v_mfma_f32_16x16x32_bf16 v[104:107], a[80:83], a[40:43], v[104:107]
s_add_u32 m0, s16, 0x0
s_waitcnt lgkmcnt(8)
v_cvt_pk_bf16_f32 v43, v46, v47
v_mfma_f32_16x16x32_bf16 v[104:107], a[84:87], a[56:59], v[104:107]
buffer_load_dwordx4 v22, s[44:47], s20 offen lds
v_accvgpr_write_b32 a136, v40
v_mfma_f32_16x16x32_bf16 v[112:115], a[84:87], a[60:63], v[112:115]
v_accvgpr_write_b32 a137, v41
v_accvgpr_write_b32 a138, v42
v_mfma_f32_16x16x32_bf16 v[112:115], a[80:83], a[44:47], v[112:115]
v_accvgpr_write_b32 a139, v43
v_cvt_pk_bf16_f32 v48, v48, v49
v_mfma_f32_16x16x32_bf16 v[116:119], a[88:91], a[44:47], v[116:119]
ds_read_b64_tr_b16 a[80:81], v12 offset:16384
v_cvt_pk_bf16_f32 v49, v50, v51
v_cvt_pk_bf16_f32 v50, v52, v53
v_mfma_f32_16x16x32_bf16 v[116:119], a[92:95], a[60:63], v[116:119]
ds_read_b64_tr_b16 a[82:83], v12 offset:17408
v_cvt_pk_bf16_f32 v51, v54, v55
v_mfma_f32_16x16x32_bf16 v[108:111], a[92:95], a[56:59], v[108:111]
ds_read_b64_tr_b16 a[84:85], v12 offset:24576
v_accvgpr_write_b32 a140, v48
v_mfma_f32_16x16x32_bf16 v[108:111], a[88:91], a[40:43], v[108:111]
ds_read_b64_tr_b16 a[86:87], v12 offset:25600
s_add_u32 m0, s16, 0x400
v_accvgpr_write_b32 a141, v49
v_mfma_f32_16x16x32_bf16 v[100:103], a[88:91], a[36:39], v[100:103]
buffer_load_dwordx4 v23, s[44:47], s20 offen lds
v_mfma_f32_16x16x32_bf16 v[100:103], a[92:95], a[52:55], v[100:103]
v_accvgpr_write_b32 a142, v50
v_accvgpr_write_b32 a143, v51
v_mfma_f32_16x16x32_bf16 v[92:95], a[92:95], a[48:51], v[92:95]
v_cvt_pk_bf16_f32 v56, v56, v57
v_cvt_pk_bf16_f32 v57, v58, v59
v_cvt_pk_bf16_f32 v58, v60, v61
v_mfma_f32_16x16x32_bf16 v[92:95], a[88:91], a[32:35], v[92:95]
s_waitcnt lgkmcnt(4)
v_cvt_pk_bf16_f32 v59, v62, v63
v_accvgpr_write_b32 a144, v56
v_mfma_f32_16x16x32_bf16 v[120:123], a[96:99], a[32:35], v[120:123]
ds_read_b64_tr_b16 a[88:89], v13 offset:16384
v_accvgpr_write_b32 a145, v57
v_mfma_f32_16x16x32_bf16 v[120:123], a[100:103], a[48:51], v[120:123]
ds_read_b64_tr_b16 a[90:91], v13 offset:17408
v_accvgpr_write_b32 a146, v58
v_accvgpr_write_b32 a147, v59
v_mfma_f32_16x16x32_bf16 v[128:131], a[100:103], a[52:55], v[128:131]
ds_read_b64_tr_b16 a[92:93], v13 offset:24576
v_cvt_pk_bf16_f32 v64, v64, v65
v_mfma_f32_16x16x32_bf16 v[128:131], a[96:99], a[36:39], v[128:131]
ds_read_b64_tr_b16 a[94:95], v13 offset:25600
s_add_u32 m0, s16, 0x800
v_mfma_f32_16x16x32_bf16 v[136:139], a[96:99], a[40:43], v[136:139]
buffer_load_dwordx4 v22, s[44:47], s21 offen lds
v_cvt_pk_bf16_f32 v65, v66, v67
v_mfma_f32_16x16x32_bf16 v[136:139], a[100:103], a[56:59], v[136:139]
v_cvt_pk_bf16_f32 v66, v68, v69
v_cvt_pk_bf16_f32 v67, v70, v71
v_mfma_f32_16x16x32_bf16 v[144:147], a[100:103], a[60:63], v[144:147]
v_accvgpr_write_b32 a148, v64
v_accvgpr_write_b32 a149, v65
v_mfma_f32_16x16x32_bf16 v[144:147], a[96:99], a[44:47], v[144:147]
v_accvgpr_write_b32 a150, v66
v_accvgpr_write_b32 a151, v67
v_cvt_pk_bf16_f32 v72, v72, v73
v_mfma_f32_16x16x32_bf16 v[148:151], a[104:107], a[44:47], v[148:151]
ds_read_b64_tr_b16 a[96:97], v12 offset:16640
v_cvt_pk_bf16_f32 v73, v74, v75
v_mfma_f32_16x16x32_bf16 v[148:151], a[108:111], a[60:63], v[148:151]
ds_read_b64_tr_b16 a[98:99], v12 offset:17664
v_cvt_pk_bf16_f32 v74, v76, v77
v_mfma_f32_16x16x32_bf16 v[140:143], a[108:111], a[56:59], v[140:143]
ds_read_b64_tr_b16 a[100:101], v12 offset:24832
s_add_u32 m0, s16, 0xc00
v_cvt_pk_bf16_f32 v75, v78, v79
v_mfma_f32_16x16x32_bf16 v[140:143], a[104:107], a[40:43], v[140:143]
buffer_load_dwordx4 v23, s[44:47], s21 offen lds
v_mfma_f32_16x16x32_bf16 v[132:135], a[104:107], a[36:39], v[132:135]
ds_read_b64_tr_b16 a[102:103], v12 offset:25856
v_accvgpr_write_b32 a152, v72
v_mfma_f32_16x16x32_bf16 v[132:135], a[108:111], a[52:55], v[132:135]
v_accvgpr_write_b32 a153, v73
v_accvgpr_write_b32 a154, v74
v_accvgpr_write_b32 a155, v75
v_mfma_f32_16x16x32_bf16 v[124:127], a[108:111], a[48:51], v[124:127]
v_cvt_pk_bf16_f32 v80, v80, v81
v_cvt_pk_bf16_f32 v81, v82, v83
v_mfma_f32_16x16x32_bf16 v[124:127], a[104:107], a[32:35], v[124:127]
s_waitcnt lgkmcnt(4)
v_cvt_pk_bf16_f32 v82, v84, v85
v_cvt_pk_bf16_f32 v83, v86, v87
v_mfma_f32_16x16x32_bf16 v[152:155], a[32:35], a[80:83], v[152:155]
ds_read_b64_tr_b16 a[104:105], v13 offset:16640
v_accvgpr_write_b32 a156, v80
v_accvgpr_write_b32 a157, v81
v_mfma_f32_16x16x32_bf16 v[152:155], a[48:51], a[84:87], v[152:155]
ds_read_b64_tr_b16 a[106:107], v13 offset:17664
s_add_u32 m0, s16, 0x1000
v_mfma_f32_16x16x32_bf16 v[156:159], a[52:55], a[84:87], v[156:159]
buffer_load_dwordx4 v22, s[44:47], s22 offen lds
v_mfma_f32_16x16x32_bf16 v[156:159], a[36:39], a[80:83], v[156:159]
ds_read_b64_tr_b16 a[108:109], v13 offset:24832
v_accvgpr_write_b32 a158, v82
v_accvgpr_write_b32 a159, v83
v_mfma_f32_16x16x32_bf16 v[160:163], a[40:43], a[80:83], v[160:163]
ds_read_b64_tr_b16 a[110:111], v13 offset:25856
v_cvt_pk_bf16_f32 v88, v88, v89
v_mfma_f32_16x16x32_bf16 v[160:163], a[56:59], a[84:87], v[160:163]
v_cvt_pk_bf16_f32 v89, v90, v91
v_cvt_pk_bf16_f32 v90, v92, v93
v_mfma_f32_16x16x32_bf16 v[164:167], a[60:63], a[84:87], v[164:167]
v_cvt_pk_bf16_f32 v91, v94, v95
v_accvgpr_write_b32 a160, v88
v_accvgpr_write_b32 a161, v89
v_mfma_f32_16x16x32_bf16 v[164:167], a[44:47], a[80:83], v[164:167]
v_accvgpr_write_b32 a162, v90
v_accvgpr_write_b32 a163, v91
v_mfma_f32_16x16x32_bf16 v[180:183], a[44:47], a[88:91], v[180:183]
ds_read_b64_tr_b16 a[80:81], v12 offset:16896
v_cvt_pk_bf16_f32 v96, v96, v97
v_mfma_f32_16x16x32_bf16 v[180:183], a[60:63], a[92:95], v[180:183]
ds_read_b64_tr_b16 a[82:83], v12 offset:17920
s_add_u32 m0, s16, 0x1400
v_cvt_pk_bf16_f32 v97, v98, v99
v_mfma_f32_16x16x32_bf16 v[176:179], a[56:59], a[92:95], v[176:179]
buffer_load_dwordx4 v23, s[44:47], s22 offen lds
v_mfma_f32_16x16x32_bf16 v[176:179], a[40:43], a[88:91], v[176:179]
ds_read_b64_tr_b16 a[84:85], v12 offset:25088
v_cvt_pk_bf16_f32 v98, v100, v101
v_mfma_f32_16x16x32_bf16 v[172:175], a[36:39], a[88:91], v[172:175]
ds_read_b64_tr_b16 a[86:87], v12 offset:26112
v_cvt_pk_bf16_f32 v99, v102, v103
v_accvgpr_write_b32 a164, v96
v_mfma_f32_16x16x32_bf16 v[172:175], a[52:55], a[92:95], v[172:175]
v_accvgpr_write_b32 a165, v97
v_accvgpr_write_b32 a166, v98
v_mfma_f32_16x16x32_bf16 v[168:171], a[48:51], a[92:95], v[168:171]
v_accvgpr_write_b32 a167, v99
v_cvt_pk_bf16_f32 v104, v104, v105
v_mfma_f32_16x16x32_bf16 v[168:171], a[32:35], a[88:91], v[168:171]
s_waitcnt lgkmcnt(4)
v_cvt_pk_bf16_f32 v105, v106, v107
v_cvt_pk_bf16_f32 v106, v108, v109
v_cvt_pk_bf16_f32 v107, v110, v111
v_mfma_f32_16x16x32_bf16 v[184:187], a[32:35], a[96:99], v[184:187]
ds_read_b64_tr_b16 a[88:89], v13 offset:16896
s_add_u32 m0, s16, 0x1800
v_mfma_f32_16x16x32_bf16 v[184:187], a[48:51], a[100:103], v[184:187]
buffer_load_dwordx4 v22, s[44:47], s23 offen lds
v_mfma_f32_16x16x32_bf16 v[188:191], a[52:55], a[100:103], v[188:191]
ds_read_b64_tr_b16 a[90:91], v13 offset:17920
v_accvgpr_write_b32 a168, v104
v_accvgpr_write_b32 a169, v105
v_mfma_f32_16x16x32_bf16 v[188:191], a[36:39], a[96:99], v[188:191]
ds_read_b64_tr_b16 a[92:93], v13 offset:25088
v_accvgpr_write_b32 a170, v106
v_mfma_f32_16x16x32_bf16 v[192:195], a[40:43], a[96:99], v[192:195]
ds_read_b64_tr_b16 a[94:95], v13 offset:26112
v_accvgpr_write_b32 a171, v107
v_mfma_f32_16x16x32_bf16 v[192:195], a[56:59], a[100:103], v[192:195]
L_padA4:
s_cmp_eq_u32 s95, 1
s_cbranch_scc1 L_padA8
v_cvt_pk_bf16_f32 v112, v112, v113
v_cvt_pk_bf16_f32 v113, v114, v115
v_cvt_pk_bf16_f32 v114, v116, v117
v_mfma_f32_16x16x32_bf16 v[196:199], a[60:63], a[100:103], v[196:199]
v_cvt_pk_bf16_f32 v115, v118, v119
v_accvgpr_write_b32 a172, v112
v_mfma_f32_16x16x32_bf16 v[196:199], a[44:47], a[96:99], v[196:199]
v_accvgpr_write_b32 a173, v113
v_accvgpr_write_b32 a174, v114
v_mfma_f32_16x16x32_bf16 v[212:215], a[44:47], a[104:107], v[212:215]
ds_read_b64_tr_b16 a[96:97], v12 offset:17152
s_add_u32 m0, s16, 0x1c00
v_accvgpr_write_b32 a175, v115
v_mfma_f32_16x16x32_bf16 v[212:215], a[60:63], a[108:111], v[212:215]
buffer_load_dwordx4 v23, s[44:47], s23 offen lds
v_mfma_f32_16x16x32_bf16 v[208:211], a[56:59], a[108:111], v[208:211]
ds_read_b64_tr_b16 a[98:99], v12 offset:18176
v_lshl_add_u32 v22, s42, 7, v22
v_mfma_f32_16x16x32_bf16 v[208:211], a[40:43], a[104:107], v[208:211]
ds_read_b64_tr_b16 a[100:101], v12 offset:25344
v_lshl_add_u32 v23, s42, 7, v23
v_cvt_pk_bf16_f32 v120, v120, v121
v_mfma_f32_16x16x32_bf16 v[204:207], a[36:39], a[104:107], v[204:207]
ds_read_b64_tr_b16 a[102:103], v12 offset:26368
v_cvt_pk_bf16_f32 v121, v122, v123
v_mfma_f32_16x16x32_bf16 v[204:207], a[52:55], a[108:111], v[204:207]
v_cvt_pk_bf16_f32 v122, v124, v125
v_cvt_pk_bf16_f32 v123, v126, v127
v_mfma_f32_16x16x32_bf16 v[200:203], a[48:51], a[108:111], v[200:203]
v_accvgpr_write_b32 a176, v120
v_accvgpr_write_b32 a177, v121
v_accvgpr_write_b32 a178, v122
v_mfma_f32_16x16x32_bf16 v[200:203], a[32:35], a[104:107], v[200:203]
s_mov_b32 s9, 0x600000
s_waitcnt lgkmcnt(4)
v_accvgpr_write_b32 a179, v123
v_mfma_f32_16x16x32_bf16 v[216:219], a[32:35], a[80:83], v[216:219]
buffer_load_dword a120, v18, s[52:55], s9 offen
v_mfma_f32_16x16x32_bf16 v[216:219], a[48:51], a[84:87], v[216:219]
ds_read_b64_tr_b16 a[104:105], v13 offset:17152
v_cvt_pk_bf16_f32 v128, v128, v129
v_cvt_pk_bf16_f32 v129, v130, v131
v_mfma_f32_16x16x32_bf16 v[220:223], a[52:55], a[84:87], v[220:223]
ds_read_b64_tr_b16 a[106:107], v13 offset:18176
v_cvt_pk_bf16_f32 v130, v132, v133
v_mfma_f32_16x16x32_bf16 v[220:223], a[36:39], a[80:83], v[220:223]
ds_read_b64_tr_b16 a[108:109], v13 offset:25344
v_cvt_pk_bf16_f32 v131, v134, v135
v_mfma_f32_16x16x32_bf16 v[224:227], a[40:43], a[80:83], v[224:227]
ds_read_b64_tr_b16 a[110:111], v13 offset:26368
v_add_u32 v12, 0x8000, v12
v_accvgpr_write_b32 a180, v128
v_mfma_f32_16x16x32_bf16 v[224:227], a[56:59], a[84:87], v[224:227]
v_add_u32 v13, 0x8000, v13
v_accvgpr_write_b32 a181, v129
v_mfma_f32_16x16x32_bf16 v[228:231], a[60:63], a[84:87], v[228:231]
v_accvgpr_write_b32 a182, v130
v_accvgpr_write_b32 a183, v131
v_mfma_f32_16x16x32_bf16 v[228:231], a[44:47], a[80:83], v[228:231]
v_cvt_pk_bf16_f32 v136, v136, v137
v_cvt_pk_bf16_f32 v137, v138, v139
v_cvt_pk_bf16_f32 v138, v140, v141
v_mfma_f32_16x16x32_bf16 v[244:247], a[44:47], a[88:91], v[244:247]
s_waitcnt vmcnt(27) lgkmcnt(0)
v_cvt_pk_bf16_f32 v139, v142, v143
v_accvgpr_write_b32 a184, v136
v_mfma_f32_16x16x32_bf16 v[244:247], a[60:63], a[92:95], v[244:247]
s_barrier
s_add_u32 m0, s17, 0x8000
v_accvgpr_write_b32 a185, v137
v_mfma_f32_16x16x32_bf16 v[240:243], a[56:59], a[92:95], v[240:243]
buffer_load_dwordx4 v5, s[52:55], 0 offen lds
v_accvgpr_write_b32 a186, v138
v_mfma_f32_16x16x32_bf16 v[240:243], a[40:43], a[88:91], v[240:243]
ds_read_b64_tr_b16 a[80:81], v12 offset:0
v_accvgpr_write_b32 a187, v139
v_mfma_f32_16x16x32_bf16 v[236:239], a[36:39], a[88:91], v[236:239]
ds_read_b64_tr_b16 a[82:83], v12 offset:1024
v_cvt_pk_bf16_f32 v144, v144, v145
v_mfma_f32_16x16x32_bf16 v[236:239], a[52:55], a[92:95], v[236:239]
ds_read_b64_tr_b16 a[84:85], v12 offset:8192
v_cvt_pk_bf16_f32 v145, v146, v147
v_cvt_pk_bf16_f32 v146, v148, v149
v_mfma_f32_16x16x32_bf16 v[232:235], a[48:51], a[92:95], v[232:235]
ds_read_b64_tr_b16 a[86:87], v12 offset:9216
v_cvt_pk_bf16_f32 v147, v150, v151
v_mfma_f32_16x16x32_bf16 v[232:235], a[32:35], a[88:91], v[232:235]
s_add_u32 m0, s17, 0x8400
s_waitcnt lgkmcnt(4)
v_accvgpr_write_b32 a188, v144
v_mfma_f32_16x16x32_bf16 v[248:251], a[32:35], a[96:99], v[248:251]
buffer_load_dwordx4 v5, s[52:55], s13 offen lds
v_accvgpr_write_b32 a189, v145
v_mfma_f32_16x16x32_bf16 v[248:251], a[48:51], a[100:103], v[248:251]
ds_read_b64_tr_b16 a[88:89], v13 offset:0
v_accvgpr_write_b32 a190, v146
v_mfma_f32_16x16x32_bf16 v[252:255], a[52:55], a[100:103], v[252:255]
ds_read_b64_tr_b16 a[90:91], v13 offset:1024
v_accvgpr_write_b32 a191, v147
v_mfma_f32_16x16x32_bf16 v[252:255], a[36:39], a[96:99], v[252:255]
ds_read_b64_tr_b16 a[92:93], v13 offset:8192
v_cvt_pk_bf16_f32 v152, v152, v153
v_cvt_pk_bf16_f32 v153, v154, v155
v_mfma_f32_16x16x32_bf16 a[232:235], a[40:43], a[96:99], a[232:235]
ds_read_b64_tr_b16 a[94:95], v13 offset:9216
v_cvt_pk_bf16_f32 v154, v156, v157
v_mfma_f32_16x16x32_bf16 a[232:235], a[56:59], a[100:103], a[232:235]
v_cvt_pk_bf16_f32 v155, v158, v159
v_accvgpr_write_b32 a192, v152
v_mfma_f32_16x16x32_bf16 a[236:239], a[60:63], a[100:103], a[236:239]
s_add_u32 m0, s17, 0x8800
v_accvgpr_write_b32 a193, v153
v_accvgpr_write_b32 a194, v154
v_accvgpr_write_b32 a195, v155
v_mfma_f32_16x16x32_bf16 a[236:239], a[44:47], a[96:99], a[236:239]
buffer_load_dwordx4 v6, s[52:55], 0 offen lds
v_mfma_f32_16x16x32_bf16 a[252:255], a[44:47], a[104:107], a[252:255]
ds_read_b64_tr_b16 a[96:97], v12 offset:256
v_cvt_pk_bf16_f32 v160, v160, v161
v_mfma_f32_16x16x32_bf16 a[252:255], a[60:63], a[108:111], a[252:255]
ds_read_b64_tr_b16 a[98:99], v12 offset:1280
v_cvt_pk_bf16_f32 v161, v162, v163
v_cvt_pk_bf16_f32 v162, v164, v165
v_mfma_f32_16x16x32_bf16 a[248:251], a[56:59], a[108:111], a[248:251]
ds_read_b64_tr_b16 a[100:101], v12 offset:8448
v_cvt_pk_bf16_f32 v163, v166, v167
v_mfma_f32_16x16x32_bf16 a[248:251], a[40:43], a[104:107], a[248:251]
ds_read_b64_tr_b16 a[102:103], v12 offset:9472
v_accvgpr_write_b32 a196, v160
v_mfma_f32_16x16x32_bf16 a[244:247], a[36:39], a[104:107], a[244:247]
v_accvgpr_write_b32 a197, v161
v_accvgpr_write_b32 a198, v162
v_accvgpr_write_b32 a199, v163
v_mfma_f32_16x16x32_bf16 a[244:247], a[52:55], a[108:111], a[244:247]
s_add_u32 m0, s17, 0x8c00
v_cvt_pk_bf16_f32 v168, v168, v169
v_cvt_pk_bf16_f32 v169, v170, v171
v_mfma_f32_16x16x32_bf16 a[240:243], a[48:51], a[108:111], a[240:243]
buffer_load_dwordx4 v6, s[52:55], s13 offen lds
v_mfma_f32_16x16x32_bf16 a[240:243], a[32:35], a[104:107], a[240:243]
s_waitcnt lgkmcnt(4)
v_cvt_pk_bf16_f32 v170, v172, v173
v_cvt_pk_bf16_f32 v171, v174, v175
v_accvgpr_write_b32 a200, v168
L_S8:
v_mfma_f32_16x16x32_bf16 v[24:27], a[80:83], a[0:3], 0
ds_read_b64_tr_b16 a[104:105], v13 offset:256
s_waitcnt vmcnt(22)
v_mfma_f32_16x16x32_bf16 v[24:27], a[84:87], a[16:19], v[24:27]
ds_read_b64_tr_b16 a[106:107], v13 offset:1280
v_accvgpr_write_b32 a201, v169
v_mfma_f32_16x16x32_bf16 v[32:35], a[84:87], a[20:23], 0
ds_read_b64_tr_b16 a[108:109], v13 offset:8448
v_accvgpr_write_b32 a202, v170
v_accvgpr_write_b32 a203, v171
v_mfma_f32_16x16x32_bf16 v[32:35], a[80:83], a[4:7], v[32:35]
ds_read_b64_tr_b16 a[110:111], v13 offset:9472
v_cvt_pk_bf16_f32 v176, v176, v177
v_mfma_f32_16x16x32_bf16 v[40:43], a[80:83], a[8:11], 0
ds_read_b128 a[32:35], v8 offset:32768
s_add_u32 m0, s18, 0xc000
v_mfma_f32_16x16x32_bf16 v[40:43], a[84:87], a[24:27], v[40:43]
buffer_load_dwordx4 v7, s[68:71], 0 offen lds
v_cvt_pk_bf16_f32 v177, v178, v179
v_mfma_f32_16x16x32_bf16 v[48:51], a[84:87], a[28:31], 0
ds_read_b128 a[48:51], v9 offset:32768
v_cvt_pk_bf16_f32 v178, v180, v181
v_mfma_f32_16x16x32_bf16 v[48:51], a[80:83], a[12:15], v[48:51]
ds_read_b128 a[36:39], v8 offset:34816
v_cvt_pk_bf16_f32 v179, v182, v183
v_mfma_f32_16x16x32_bf16 v[52:55], a[88:91], a[12:15], 0
ds_read_b64_tr_b16 a[80:81], v12 offset:512
v_accvgpr_write_b32 a204, v176
v_accvgpr_write_b32 a205, v177
v_mfma_f32_16x16x32_bf16 v[52:55], a[92:95], a[28:31], v[52:55]
ds_read_b64_tr_b16 a[82:83], v12 offset:1536
v_accvgpr_write_b32 a206, v178
v_mfma_f32_16x16x32_bf16 v[44:47], a[92:95], a[24:27], 0
ds_read_b64_tr_b16 a[84:85], v12 offset:8704
s_add_u32 s8, s28, 0x2000
v_mfma_f32_16x16x32_bf16 v[44:47], a[88:91], a[8:11], v[44:47]
buffer_store_dwordx4 a[128:131], v16, s[88:91], s8 offen sc1
v_accvgpr_write_b32 a207, v179
v_mfma_f32_16x16x32_bf16 v[36:39], a[88:91], a[4:7], 0
ds_read_b64_tr_b16 a[86:87], v12 offset:9728
v_cvt_pk_bf16_f32 v184, v184, v185
v_mfma_f32_16x16x32_bf16 v[36:39], a[92:95], a[20:23], v[36:39]
ds_read_b128 a[52:55], v9 offset:34816
v_cvt_pk_bf16_f32 v185, v186, v187
v_mfma_f32_16x16x32_bf16 v[28:31], a[92:95], a[16:19], 0
ds_read_b128 a[40:43], v8 offset:36864
v_cvt_pk_bf16_f32 v186, v188, v189
v_cvt_pk_bf16_f32 v187, v190, v191
v_mfma_f32_16x16x32_bf16 v[28:31], a[88:91], a[0:3], v[28:31]
ds_read_b128 a[56:59], v9 offset:36864
s_waitcnt lgkmcnt(10)
v_mfma_f32_16x16x32_bf16 v[56:59], a[96:99], a[0:3], 0
ds_read_b64_tr_b16 a[88:89], v13 offset:512
v_accvgpr_write_b32 a208, v184
v_mfma_f32_16x16x32_bf16 v[56:59], a[100:103], a[16:19], v[56:59]
ds_read_b64_tr_b16 a[90:91], v13 offset:1536
s_add_u32 m0, s18, 0xd000
v_accvgpr_write_b32 a209, v185
v_mfma_f32_16x16x32_bf16 v[64:67], a[100:103], a[20:23], 0
buffer_load_dwordx4 v7, s[68:71], s25 offen lds
v_mfma_f32_16x16x32_bf16 v[64:67], a[96:99], a[4:7], v[64:67]
ds_read_b64_tr_b16 a[92:93], v13 offset:8704
v_accvgpr_write_b32 a210, v186
v_mfma_f32_16x16x32_bf16 v[72:75], a[96:99], a[8:11], 0
ds_read_b64_tr_b16 a[94:95], v13 offset:9728
v_accvgpr_write_b32 a211, v187
v_cvt_pk_bf16_f32 v192, v192, v193
v_mfma_f32_16x16x32_bf16 v[72:75], a[100:103], a[24:27], v[72:75]
ds_read_b128 a[44:47], v8 offset:38912
v_cvt_pk_bf16_f32 v193, v194, v195
v_mfma_f32_16x16x32_bf16 v[80:83], a[100:103], a[28:31], 0
ds_read_b128 a[60:63], v9 offset:38912
v_cvt_pk_bf16_f32 v194, v196, v197
v_mfma_f32_16x16x32_bf16 v[80:83], a[96:99], a[12:15], v[80:83]
v_cvt_pk_bf16_f32 v195, v198, v199
v_accvgpr_write_b32 a212, v192
v_accvgpr_write_b32 a213, v193
v_mfma_f32_16x16x32_bf16 v[84:87], a[104:107], a[12:15], 0
ds_read_b64_tr_b16 a[96:97], v12 offset:768
s_add_u32 m0, s18, 0xe000
v_mfma_f32_16x16x32_bf16 v[84:87], a[108:111], a[28:31], v[84:87]
buffer_load_dwordx4 v7, s[68:71], s26 offen lds
v_mfma_f32_16x16x32_bf16 v[76:79], a[108:111], a[24:27], 0
ds_read_b64_tr_b16 a[98:99], v12 offset:1792
v_lshl_add_u32 v5, s42, 19, v5
v_accvgpr_write_b32 a214, v194
v_mfma_f32_16x16x32_bf16 v[76:79], a[104:107], a[8:11], v[76:79]
ds_read_b64_tr_b16 a[100:101], v12 offset:8960
v_lshl_add_u32 v6, s42, 19, v6
v_mfma_f32_16x16x32_bf16 v[68:71], a[104:107], a[4:7], 0
ds_read_b64_tr_b16 a[102:103], v12 offset:9984
v_lshl_add_u32 v7, s42, 18, v7
v_mfma_f32_16x16x32_bf16 v[68:71], a[108:111], a[20:23], v[68:71]
v_lshl_add_u32 v7, s42, 17, v7
v_accvgpr_write_b32 a215, v195
v_cvt_pk_bf16_f32 v200, v200, v201
v_mfma_f32_16x16x32_bf16 v[60:63], a[108:111], a[16:19], 0
v_cvt_pk_bf16_f32 v201, v202, v203
v_cvt_pk_bf16_f32 v202, v204, v205
v_mfma_f32_16x16x32_bf16 v[60:63], a[104:107], a[0:3], v[60:63]
s_add_u32 m0, s16, 0x8000
s_waitcnt lgkmcnt(4)
s_waitcnt lgkmcnt(6)
v_mfma_f32_16x16x32_bf16 v[88:91], a[80:83], a[0:3], 0
buffer_load_dwordx4 v22, s[44:47], s20 offen lds
v_cvt_pk_bf16_f32 v203, v206, v207
v_mfma_f32_16x16x32_bf16 v[88:91], a[84:87], a[16:19], v[88:91]
ds_read_b64_tr_b16 a[104:105], v13 offset:768
v_accvgpr_write_b32 a216, v200
v_mfma_f32_16x16x32_bf16 v[96:99], a[84:87], a[20:23], 0
ds_read_b64_tr_b16 a[106:107], v13 offset:1792
v_accvgpr_write_b32 a217, v201
v_mfma_f32_16x16x32_bf16 v[96:99], a[80:83], a[4:7], v[96:99]
ds_read_b64_tr_b16 a[108:109], v13 offset:8960
v_accvgpr_write_b32 a218, v202
v_accvgpr_write_b32 a219, v203
v_mfma_f32_16x16x32_bf16 v[104:107], a[80:83], a[8:11], 0
ds_read_b64_tr_b16 a[110:111], v13 offset:9984
s_add_u32 m0, s16, 0x8400
v_mfma_f32_16x16x32_bf16 v[104:107], a[84:87], a[24:27], v[104:107]
buffer_load_dwordx4 v23, s[44:47], s20 offen lds
v_mfma_f32_16x16x32_bf16 v[112:115], a[84:87], a[28:31], 0
v_cvt_pk_bf16_f32 v208, v208, v209
v_cvt_pk_bf16_f32 v209, v210, v211
v_cvt_pk_bf16_f32 v210, v212, v213
v_mfma_f32_16x16x32_bf16 v[112:115], a[80:83], a[12:15], v[112:115]
v_cvt_pk_bf16_f32 v211, v214, v215
v_accvgpr_write_b32 a220, v208
v_mfma_f32_16x16x32_bf16 v[116:119], a[88:91], a[12:15], 0
ds_read_b64_tr_b16 a[80:81], v14 offset:0
v_accvgpr_write_b32 a221, v209
v_mfma_f32_16x16x32_bf16 v[116:119], a[92:95], a[28:31], v[116:119]
ds_read_b64_tr_b16 a[82:83], v14 offset:256
v_accvgpr_write_b32 a222, v210
v_accvgpr_write_b32 a223, v211
v_mfma_f32_16x16x32_bf16 v[108:111], a[92:95], a[24:27], 0
ds_read_b64_tr_b16 a[84:85], v14 offset:2048
s_add_u32 m0, s16, 0x8800
v_mfma_f32_16x16x32_bf16 v[108:111], a[88:91], a[8:11], v[108:111]
buffer_load_dwordx4 v22, s[44:47], s21 offen lds
v_mfma_f32_16x16x32_bf16 v[100:103], a[88:91], a[4:7], 0
ds_read_b64_tr_b16 a[86:87], v14 offset:2304
v_cvt_pk_bf16_f32 v216, v216, v217
v_cvt_pk_bf16_f32 v217, v218, v219
v_mfma_f32_16x16x32_bf16 v[100:103], a[92:95], a[20:23], v[100:103]
v_cvt_pk_bf16_f32 v218, v220, v221
v_cvt_pk_bf16_f32 v219, v222, v223
v_mfma_f32_16x16x32_bf16 v[92:95], a[92:95], a[16:19], 0
v_accvgpr_write_b32 a224, v216
v_accvgpr_write_b32 a225, v217
v_mfma_f32_16x16x32_bf16 v[92:95], a[88:91], a[0:3], v[92:95]
s_add_u32 s8, s28, 0x3000
s_waitcnt lgkmcnt(4)
v_accvgpr_write_b32 a226, v218
v_accvgpr_write_b32 a227, v219
v_mfma_f32_16x16x32_bf16 v[120:123], a[96:99], a[0:3], 0
buffer_store_dwordx4 a[132:135], v16, s[88:91], s8 offen sc1
v_mfma_f32_16x16x32_bf16 v[120:123], a[100:103], a[16:19], v[120:123]
ds_read_b64_tr_b16 a[88:89], v15 offset:0
v_cvt_pk_bf16_f32 v224, v224, v225
v_mfma_f32_16x16x32_bf16 v[128:131], a[100:103], a[20:23], 0
ds_read_b64_tr_b16 a[90:91], v15 offset:256
v_cvt_pk_bf16_f32 v225, v226, v227
v_cvt_pk_bf16_f32 v226, v228, v229
v_mfma_f32_16x16x32_bf16 v[128:131], a[96:99], a[4:7], v[128:131]
ds_read_b64_tr_b16 a[92:93], v15 offset:2048
v_cvt_pk_bf16_f32 v227, v230, v231
v_mfma_f32_16x16x32_bf16 v[136:139], a[96:99], a[8:11], 0
ds_read_b64_tr_b16 a[94:95], v15 offset:2304
v_accvgpr_write_b32 a228, v224
v_mfma_f32_16x16x32_bf16 v[136:139], a[100:103], a[24:27], v[136:139]
s_add_u32 m0, s16, 0x8c00
v_accvgpr_write_b32 a229, v225
v_accvgpr_write_b32 a230, v226
v_accvgpr_write_b32 a231, v227
v_mfma_f32_16x16x32_bf16 v[144:147], a[100:103], a[28:31], 0
buffer_load_dwordx4 v23, s[44:47], s21 offen lds
v_mfma_f32_16x16x32_bf16 v[144:147], a[96:99], a[12:15], v[144:147]
v_cvt_pk_bf16_f32 v232, v232, v233
v_cvt_pk_bf16_f32 v233, v234, v235
v_mfma_f32_16x16x32_bf16 v[148:151], a[104:107], a[12:15], 0
ds_read_b64_tr_b16 a[96:97], v14 offset:4096
v_cvt_pk_bf16_f32 v234, v236, v237
v_cvt_pk_bf16_f32 v235, v238, v239
v_mfma_f32_16x16x32_bf16 v[148:151], a[108:111], a[28:31], v[148:151]
ds_read_b64_tr_b16 a[98:99], v14 offset:4352
v_accvgpr_write_b32 a112, v232
v_mfma_f32_16x16x32_bf16 v[140:143], a[108:111], a[24:27], 0
ds_read_b64_tr_b16 a[100:101], v14 offset:6144
v_accvgpr_write_b32 a113, v233
v_mfma_f32_16x16x32_bf16 v[140:143], a[104:107], a[8:11], v[140:143]
ds_read_b64_tr_b16 a[102:103], v14 offset:6400
s_add_u32 m0, s16, 0x9000
v_accvgpr_write_b32 a114, v234
v_mfma_f32_16x16x32_bf16 v[132:135], a[104:107], a[4:7], 0
buffer_load_dwordx4 v22, s[44:47], s22 offen lds
v_mfma_f32_16x16x32_bf16 v[132:135], a[108:111], a[20:23], v[132:135]
v_accvgpr_write_b32 a115, v235
v_cvt_pk_bf16_f32 v240, v240, v241
v_mfma_f32_16x16x32_bf16 v[124:127], a[108:111], a[16:19], 0
v_cvt_pk_bf16_f32 v241, v242, v243
v_cvt_pk_bf16_f32 v242, v244, v245
v_cvt_pk_bf16_f32 v243, v246, v247
v_mfma_f32_16x16x32_bf16 v[124:127], a[104:107], a[0:3], v[124:127]
s_waitcnt lgkmcnt(4)
v_accvgpr_write_b32 a116, v240
v_accvgpr_write_b32 a117, v241
v_mfma_f32_16x16x32_bf16 v[152:155], a[80:83], a[0:3], 0
ds_read_b64_tr_b16 a[104:105], v15 offset:4096
s_add_u32 m0, s16, 0x9400
v_mfma_f32_16x16x32_bf16 v[152:155], a[84:87], a[16:19], v[152:155]
buffer_load_dwordx4 v23, s[44:47], s22 offen lds
v_accvgpr_write_b32 a118, v242
v_mfma_f32_16x16x32_bf16 v[160:163], a[84:87], a[20:23], 0
ds_read_b64_tr_b16 a[106:107], v15 offset:4352
v_accvgpr_write_b32 a119, v243
v_mfma_f32_16x16x32_bf16 v[160:163], a[80:83], a[4:7], v[160:163]
ds_read_b64_tr_b16 a[108:109], v15 offset:6144
v_cvt_pk_bf16_f32 v248, v248, v249
v_mfma_f32_16x16x32_bf16 v[168:171], a[80:83], a[8:11], 0
ds_read_b64_tr_b16 a[110:111], v15 offset:6400
v_cvt_pk_bf16_f32 v249, v250, v251
v_cvt_pk_bf16_f32 v250, v252, v253
v_mfma_f32_16x16x32_bf16 v[168:171], a[84:87], a[24:27], v[168:171]
v_cvt_pk_bf16_f32 v251, v254, v255
v_accvgpr_write_b32 a124, v248
v_mfma_f32_16x16x32_bf16 v[176:179], a[84:87], a[28:31], 0
s_add_u32 m0, s16, 0x9800
v_accvgpr_write_b32 a125, v249
v_accvgpr_write_b32 a126, v250
v_mfma_f32_16x16x32_bf16 v[176:179], a[80:83], a[12:15], v[176:179]
buffer_load_dwordx4 v22, s[44:47], s23 offen lds
v_accvgpr_write_b32 a127, v251
v_mfma_f32_16x16x32_bf16 v[180:183], a[88:91], a[12:15], 0
ds_read_b64_tr_b16 a[80:81], v14 offset:8192
v_accvgpr_read_b32 v2, a232
v_mfma_f32_16x16x32_bf16 v[180:183], a[92:95], a[28:31], v[180:183]
ds_read_b64_tr_b16 a[82:83], v14 offset:8448
v_accvgpr_read_b32 v3, a233
v_mfma_f32_16x16x32_bf16 v[172:175], a[92:95], a[24:27], 0
ds_read_b64_tr_b16 a[84:85], v14 offset:10240
v_cvt_pk_bf16_f32 v2, v2, v3
v_accvgpr_write_b32 a232, v2
v_mfma_f32_16x16x32_bf16 v[172:175], a[88:91], a[8:11], v[172:175]
ds_read_b64_tr_b16 a[86:87], v14 offset:10496
s_add_u32 m0, s16, 0x9c00
v_mfma_f32_16x16x32_bf16 v[164:167], a[88:91], a[4:7], 0
buffer_load_dwordx4 v23, s[44:47], s23 offen lds
v_mfma_f32_16x16x32_bf16 v[164:167], a[92:95], a[20:23], v[164:167]
v_lshl_add_u32 v22, s42, 7, v22
v_lshl_add_u32 v23, s42, 7, v23
v_accvgpr_read_b32 v2, a234
v_mfma_f32_16x16x32_bf16 v[156:159], a[92:95], a[16:19], 0
v_accvgpr_read_b32 v3, a235
v_cvt_pk_bf16_f32 v2, v2, v3
v_mfma_f32_16x16x32_bf16 v[156:159], a[88:91], a[0:3], v[156:159]
s_waitcnt lgkmcnt(4)
v_accvgpr_write_b32 a233, v2
v_accvgpr_read_b32 v2, a236
v_mfma_f32_16x16x32_bf16 v[184:187], a[96:99], a[0:3], 0
ds_read_b64_tr_b16 a[88:89], v15 offset:8192
v_accvgpr_read_b32 v3, a237
v_cvt_pk_bf16_f32 v2, v2, v3
v_mfma_f32_16x16x32_bf16 v[184:187], a[100:103], a[16:19], v[184:187]
ds_read_b64_tr_b16 a[90:91], v15 offset:8448
s_add_u32 s8, s28, 0x6000
v_mfma_f32_16x16x32_bf16 v[192:195], a[100:103], a[20:23], 0
buffer_store_dwordx4 a[136:139], v16, s[88:91], s8 offen sc1
v_mfma_f32_16x16x32_bf16 v[192:195], a[96:99], a[4:7], v[192:195]
ds_read_b64_tr_b16 a[92:93], v15 offset:10240
v_accvgpr_write_b32 a234, v2
v_accvgpr_read_b32 v2, a238
v_mfma_f32_16x16x32_bf16 v[200:203], a[96:99], a[8:11], 0
ds_read_b64_tr_b16 a[94:95], v15 offset:10496
v_add_u32 v12, 0xffff0000, v12
v_mfma_f32_16x16x32_bf16 v[200:203], a[100:103], a[24:27], v[200:203]
v_add_u32 v13, 0xffff0000, v13
v_add_u32 v14, 0xffff0000, v14
v_mfma_f32_16x16x32_bf16 v[208:211], a[100:103], a[28:31], 0
v_add_u32 v15, 0xffff0000, v15
v_accvgpr_read_b32 v3, a239
v_cvt_pk_bf16_f32 v2, v2, v3
v_mfma_f32_16x16x32_bf16 v[208:211], a[96:99], a[12:15], v[208:211]
v_accvgpr_write_b32 a235, v2
v_accvgpr_read_b32 v2, a240
v_mfma_f32_16x16x32_bf16 v[212:215], a[104:107], a[12:15], 0
s_waitcnt vmcnt(28) lgkmcnt(0)
v_accvgpr_read_b32 v3, a241
v_cvt_pk_bf16_f32 v2, v2, v3
v_mfma_f32_16x16x32_bf16 v[212:215], a[108:111], a[28:31], v[212:215]
s_barrier
s_add_u32 m0, s17, 0x10000
v_accvgpr_write_b32 a240, v2
v_accvgpr_read_b32 v2, a242
v_mfma_f32_16x16x32_bf16 v[204:207], a[108:111], a[24:27], 0
buffer_load_dwordx4 v5, s[52:55], 0 offen lds
v_mfma_f32_16x16x32_bf16 v[204:207], a[104:107], a[8:11], v[204:207]
ds_read_b64_tr_b16 a[96:97], v12 offset:0
v_accvgpr_read_b32 v3, a243
v_mfma_f32_16x16x32_bf16 v[196:199], a[104:107], a[4:7], 0
ds_read_b64_tr_b16 a[98:99], v12 offset:1024
v_cvt_pk_bf16_f32 v2, v2, v3
v_accvgpr_write_b32 a241, v2
v_mfma_f32_16x16x32_bf16 v[196:199], a[108:111], a[20:23], v[196:199]
ds_read_b64_tr_b16 a[100:101], v12 offset:8192
v_accvgpr_read_b32 v2, a244
v_mfma_f32_16x16x32_bf16 v[188:191], a[108:111], a[16:19], 0
ds_read_b64_tr_b16 a[102:103], v12 offset:9216
v_accvgpr_read_b32 v3, a245
v_mfma_f32_16x16x32_bf16 v[188:191], a[104:107], a[0:3], v[188:191]
s_add_u32 m0, s17, 0x10400
s_waitcnt lgkmcnt(4)
v_cvt_pk_bf16_f32 v2, v2, v3
v_accvgpr_write_b32 a242, v2
v_mfma_f32_16x16x32_bf16 v[216:219], a[0:3], a[80:83], 0
buffer_load_dwordx4 v5, s[52:55], s13 offen lds
v_mfma_f32_16x16x32_bf16 v[216:219], a[16:19], a[84:87], v[216:219]
ds_read_b64_tr_b16 a[104:105], v13 offset:0
v_accvgpr_read_b32 v2, a246
v_mfma_f32_16x16x32_bf16 v[224:227], a[20:23], a[84:87], 0
ds_read_b64_tr_b16 a[106:107], v13 offset:1024
v_accvgpr_read_b32 v3, a247
v_cvt_pk_bf16_f32 v2, v2, v3
v_mfma_f32_16x16x32_bf16 v[224:227], a[4:7], a[80:83], v[224:227]
ds_read_b64_tr_b16 a[108:109], v13 offset:8192
v_accvgpr_write_b32 a243, v2
v_mfma_f32_16x16x32_bf16 v[232:235], a[8:11], a[80:83], 0
ds_read_b64_tr_b16 a[110:111], v13 offset:9216
v_accvgpr_read_b32 v2, a248
v_mfma_f32_16x16x32_bf16 v[232:235], a[24:27], a[84:87], v[232:235]
v_accvgpr_read_b32 v3, a249
v_cvt_pk_bf16_f32 v2, v2, v3
v_accvgpr_write_b32 a248, v2
v_mfma_f32_16x16x32_bf16 v[240:243], a[28:31], a[84:87], 0
s_add_u32 m0, s17, 0x10800
v_accvgpr_read_b32 v2, a250
v_accvgpr_read_b32 v3, a251
v_mfma_f32_16x16x32_bf16 v[240:243], a[12:15], a[80:83], v[240:243]
buffer_load_dwordx4 v6, s[52:55], 0 offen lds
v_mfma_f32_16x16x32_bf16 v[244:247], a[12:15], a[88:91], 0
ds_read_b64_tr_b16 a[80:81], v12 offset:256
v_cvt_pk_bf16_f32 v2, v2, v3
v_accvgpr_write_b32 a249, v2
v_mfma_f32_16x16x32_bf16 v[244:247], a[28:31], a[92:95], v[244:247]
ds_read_b64_tr_b16 a[82:83], v12 offset:1280
v_accvgpr_read_b32 v2, a252
v_mfma_f32_16x16x32_bf16 v[236:239], a[24:27], a[92:95], 0
ds_read_b64_tr_b16 a[84:85], v12 offset:8448
v_accvgpr_read_b32 v3, a253
v_mfma_f32_16x16x32_bf16 v[236:239], a[8:11], a[88:91], v[236:239]
ds_read_b64_tr_b16 a[86:87], v12 offset:9472
v_cvt_pk_bf16_f32 v2, v2, v3
v_accvgpr_write_b32 a250, v2
v_mfma_f32_16x16x32_bf16 v[228:231], a[4:7], a[88:91], 0
v_accvgpr_read_b32 v2, a254
v_accvgpr_read_b32 v3, a255
v_mfma_f32_16x16x32_bf16 v[228:231], a[20:23], a[92:95], v[228:231]
s_add_u32 m0, s17, 0x10c00
v_cvt_pk_bf16_f32 v2, v2, v3
v_accvgpr_write_b32 a251, v2
v_mfma_f32_16x16x32_bf16 v[220:223], a[16:19], a[92:95], 0
buffer_load_dwordx4 v6, s[52:55], s13 offen lds
v_mfma_f32_16x16x32_bf16 v[220:223], a[0:3], a[88:91], v[220:223]
s_waitcnt lgkmcnt(4)
L_S9:
v_mfma_f32_16x16x32_bf16 v[24:27], a[96:99], a[32:35], v[24:27]
ds_read_b64_tr_b16 a[88:89], v13 offset:256
s_waitcnt vmcnt(23)
v_mfma_f32_16x16x32_bf16 v[24:27], a[100:103], a[48:51], v[24:27]
ds_read_b64_tr_b16 a[90:91], v13 offset:1280
v_mfma_f32_16x16x32_bf16 v[32:35], a[100:103], a[52:55], v[32:35]
ds_read_b64_tr_b16 a[92:93], v13 offset:8448
L_padA5:
s_cmp_eq_u32 s95, 1
s_cbranch_scc1 L_padA9
v_mfma_f32_16x16x32_bf16 v[32:35], a[96:99], a[36:39], v[32:35]
ds_read_b64_tr_b16 a[94:95], v13 offset:9472
v_mfma_f32_16x16x32_bf16 v[40:43], a[96:99], a[40:43], v[40:43]
ds_read_b128 a[0:3], v8 offset:0
s_add_u32 m0, s18, 0x14000
v_mfma_f32_16x16x32_bf16 v[40:43], a[100:103], a[56:59], v[40:43]
buffer_load_dwordx4 v7, s[68:71], 0 offen lds
v_mfma_f32_16x16x32_bf16 v[48:51], a[100:103], a[60:63], v[48:51]
ds_read_b128 a[16:19], v9 offset:0
v_mfma_f32_16x16x32_bf16 v[48:51], a[96:99], a[44:47], v[48:51]
ds_read_b128 a[4:7], v8 offset:2048
v_mfma_f32_16x16x32_bf16 v[52:55], a[104:107], a[44:47], v[52:55]
ds_read_b64_tr_b16 a[96:97], v12 offset:512
v_mfma_f32_16x16x32_bf16 v[52:55], a[108:111], a[60:63], v[52:55]
ds_read_b64_tr_b16 a[98:99], v12 offset:1536
v_mfma_f32_16x16x32_bf16 v[44:47], a[108:111], a[56:59], v[44:47]
ds_read_b64_tr_b16 a[100:101], v12 offset:8704
s_add_u32 s8, s28, 0x7000
v_mfma_f32_16x16x32_bf16 v[44:47], a[104:107], a[40:43], v[44:47]
buffer_store_dwordx4 a[140:143], v16, s[88:91], s8 offen sc1
v_mfma_f32_16x16x32_bf16 v[36:39], a[104:107], a[36:39], v[36:39]
ds_read_b64_tr_b16 a[102:103], v12 offset:9728
v_mfma_f32_16x16x32_bf16 v[36:39], a[108:111], a[52:55], v[36:39]
ds_read_b128 a[20:23], v9 offset:2048
v_mfma_f32_16x16x32_bf16 v[28:31], a[108:111], a[48:51], v[28:31]
ds_read_b128 a[8:11], v8 offset:4096
v_mfma_f32_16x16x32_bf16 v[28:31], a[104:107], a[32:35], v[28:31]
ds_read_b128 a[24:27], v9 offset:4096
s_waitcnt lgkmcnt(10)
v_mfma_f32_16x16x32_bf16 v[56:59], a[80:83], a[32:35], v[56:59]
ds_read_b64_tr_b16 a[104:105], v13 offset:512
v_mfma_f32_16x16x32_bf16 v[56:59], a[84:87], a[48:51], v[56:59]
ds_read_b64_tr_b16 a[106:107], v13 offset:1536
s_add_u32 m0, s18, 0x15000
v_mfma_f32_16x16x32_bf16 v[64:67], a[84:87], a[52:55], v[64:67]
buffer_load_dwordx4 v7, s[68:71], s25 offen lds
v_mfma_f32_16x16x32_bf16 v[64:67], a[80:83], a[36:39], v[64:67]
ds_read_b64_tr_b16 a[108:109], v13 offset:8704
v_mfma_f32_16x16x32_bf16 v[72:75], a[80:83], a[40:43], v[72:75]
ds_read_b64_tr_b16 a[110:111], v13 offset:9728
v_mfma_f32_16x16x32_bf16 v[72:75], a[84:87], a[56:59], v[72:75]
ds_read_b128 a[12:15], v8 offset:6144
v_mfma_f32_16x16x32_bf16 v[80:83], a[84:87], a[60:63], v[80:83]
ds_read_b128 a[28:31], v9 offset:6144
v_mfma_f32_16x16x32_bf16 v[80:83], a[80:83], a[44:47], v[80:83]
v_mfma_f32_16x16x32_bf16 v[84:87], a[88:91], a[44:47], v[84:87]
ds_read_b64_tr_b16 a[80:81], v12 offset:768
s_add_u32 m0, s18, 0x16000
v_mfma_f32_16x16x32_bf16 v[84:87], a[92:95], a[60:63], v[84:87]
buffer_load_dwordx4 v7, s[68:71], s26 offen lds
v_mfma_f32_16x16x32_bf16 v[76:79], a[92:95], a[56:59], v[76:79]
ds_read_b64_tr_b16 a[82:83], v12 offset:1792
v_lshl_add_u32 v5, s42, 19, v5
v_mfma_f32_16x16x32_bf16 v[76:79], a[88:91], a[40:43], v[76:79]
ds_read_b64_tr_b16 a[84:85], v12 offset:8960
v_lshl_add_u32 v6, s42, 19, v6
v_mfma_f32_16x16x32_bf16 v[68:71], a[88:91], a[36:39], v[68:71]
ds_read_b64_tr_b16 a[86:87], v12 offset:9984
v_lshl_add_u32 v7, s42, 18, v7
v_mfma_f32_16x16x32_bf16 v[68:71], a[92:95], a[52:55], v[68:71]
v_lshl_add_u32 v7, s42, 17, v7
v_mfma_f32_16x16x32_bf16 v[60:63], a[92:95], a[48:51], v[60:63]
v_mfma_f32_16x16x32_bf16 v[60:63], a[88:91], a[32:35], v[60:63]
s_add_u32 m0, s16, 0x0
s_waitcnt lgkmcnt(4)
s_waitcnt lgkmcnt(6)
v_mfma_f32_16x16x32_bf16 v[88:91], a[96:99], a[32:35], v[88:91]
buffer_load_dwordx4 v22, s[44:47], s20 offen lds
v_mfma_f32_16x16x32_bf16 v[88:91], a[100:103], a[48:51], v[88:91]
ds_read_b64_tr_b16 a[88:89], v13 offset:768
v_mfma_f32_16x16x32_bf16 v[96:99], a[100:103], a[52:55], v[96:99]
ds_read_b64_tr_b16 a[90:91], v13 offset:1792
v_mfma_f32_16x16x32_bf16 v[96:99], a[96:99], a[36:39], v[96:99]
ds_read_b64_tr_b16 a[92:93], v13 offset:8960
v_mfma_f32_16x16x32_bf16 v[104:107], a[96:99], a[40:43], v[104:107]
ds_read_b64_tr_b16 a[94:95], v13 offset:9984
s_add_u32 m0, s16, 0x400
v_mfma_f32_16x16x32_bf16 v[104:107], a[100:103], a[56:59], v[104:107]
buffer_load_dwordx4 v23, s[44:47], s20 offen lds
v_mfma_f32_16x16x32_bf16 v[112:115], a[100:103], a[60:63], v[112:115]
v_mfma_f32_16x16x32_bf16 v[112:115], a[96:99], a[44:47], v[112:115]
v_mfma_f32_16x16x32_bf16 v[116:119], a[104:107], a[44:47], v[116:119]
ds_read_b64_tr_b16 a[96:97], v14 offset:0
v_mfma_f32_16x16x32_bf16 v[116:119], a[108:111], a[60:63], v[116:119]
ds_read_b64_tr_b16 a[98:99], v14 offset:256
v_mfma_f32_16x16x32_bf16 v[108:111], a[108:111], a[56:59], v[108:111]
ds_read_b64_tr_b16 a[100:101], v14 offset:2048
s_add_u32 m0, s16, 0x800
v_mfma_f32_16x16x32_bf16 v[108:111], a[104:107], a[40:43], v[108:111]
buffer_load_dwordx4 v22, s[44:47], s21 offen lds
v_mfma_f32_16x16x32_bf16 v[100:103], a[104:107], a[36:39], v[100:103]
ds_read_b64_tr_b16 a[102:103], v14 offset:2304
v_mfma_f32_16x16x32_bf16 v[100:103], a[108:111], a[52:55], v[100:103]
v_mfma_f32_16x16x32_bf16 v[92:95], a[108:111], a[48:51], v[92:95]
v_mfma_f32_16x16x32_bf16 v[92:95], a[104:107], a[32:35], v[92:95]
s_add_u32 s8, s28, 0x2400
s_waitcnt lgkmcnt(4)
v_mfma_f32_16x16x32_bf16 v[120:123], a[80:83], a[32:35], v[120:123]
buffer_store_dwordx4 a[144:147], v16, s[88:91], s8 offen sc1
v_mfma_f32_16x16x32_bf16 v[120:123], a[84:87], a[48:51], v[120:123]
ds_read_b64_tr_b16 a[104:105], v15 offset:0
v_mfma_f32_16x16x32_bf16 v[128:131], a[84:87], a[52:55], v[128:131]
ds_read_b64_tr_b16 a[106:107], v15 offset:256
v_mfma_f32_16x16x32_bf16 v[128:131], a[80:83], a[36:39], v[128:131]
ds_read_b64_tr_b16 a[108:109], v15 offset:2048
v_mfma_f32_16x16x32_bf16 v[136:139], a[80:83], a[40:43], v[136:139]
ds_read_b64_tr_b16 a[110:111], v15 offset:2304
v_mfma_f32_16x16x32_bf16 v[136:139], a[84:87], a[56:59], v[136:139]
s_add_u32 m0, s16, 0xc00
v_mfma_f32_16x16x32_bf16 v[144:147], a[84:87], a[60:63], v[144:147]
buffer_load_dwordx4 v23, s[44:47], s21 offen lds
v_mfma_f32_16x16x32_bf16 v[144:147], a[80:83], a[44:47], v[144:147]
v_mfma_f32_16x16x32_bf16 v[148:151], a[88:91], a[44:47], v[148:151]
ds_read_b64_tr_b16 a[80:81], v14 offset:4096
v_mfma_f32_16x16x32_bf16 v[148:151], a[92:95], a[60:63], v[148:151]
ds_read_b64_tr_b16 a[82:83], v14 offset:4352
v_mfma_f32_16x16x32_bf16 v[140:143], a[92:95], a[56:59], v[140:143]
ds_read_b64_tr_b16 a[84:85], v14 offset:6144
v_mfma_f32_16x16x32_bf16 v[140:143], a[88:91], a[40:43], v[140:143]
ds_read_b64_tr_b16 a[86:87], v14 offset:6400
s_add_u32 m0, s16, 0x1000
v_mfma_f32_16x16x32_bf16 v[132:135], a[88:91], a[36:39], v[132:135]
buffer_load_dwordx4 v22, s[44:47], s22 offen lds
v_mfma_f32_16x16x32_bf16 v[132:135], a[92:95], a[52:55], v[132:135]
v_mfma_f32_16x16x32_bf16 v[124:127], a[92:95], a[48:51], v[124:127]
v_mfma_f32_16x16x32_bf16 v[124:127], a[88:91], a[32:35], v[124:127]
s_waitcnt lgkmcnt(4)
v_mfma_f32_16x16x32_bf16 v[152:155], a[96:99], a[32:35], v[152:155]
ds_read_b64_tr_b16 a[88:89], v15 offset:4096
s_add_u32 m0, s16, 0x1400
v_mfma_f32_16x16x32_bf16 v[152:155], a[100:103], a[48:51], v[152:155]
buffer_load_dwordx4 v23, s[44:47], s22 offen lds
v_mfma_f32_16x16x32_bf16 v[160:163], a[100:103], a[52:55], v[160:163]
ds_read_b64_tr_b16 a[90:91], v15 offset:4352
v_mfma_f32_16x16x32_bf16 v[160:163], a[96:99], a[36:39], v[160:163]
ds_read_b64_tr_b16 a[92:93], v15 offset:6144
v_mfma_f32_16x16x32_bf16 v[168:171], a[96:99], a[40:43], v[168:171]
ds_read_b64_tr_b16 a[94:95], v15 offset:6400
v_mfma_f32_16x16x32_bf16 v[168:171], a[100:103], a[56:59], v[168:171]
v_mfma_f32_16x16x32_bf16 v[176:179], a[100:103], a[60:63], v[176:179]
s_add_u32 m0, s16, 0x1800
v_mfma_f32_16x16x32_bf16 v[176:179], a[96:99], a[44:47], v[176:179]
buffer_load_dwordx4 v22, s[44:47], s23 offen lds
v_mfma_f32_16x16x32_bf16 v[180:183], a[104:107], a[44:47], v[180:183]
ds_read_b64_tr_b16 a[96:97], v14 offset:8192
v_mfma_f32_16x16x32_bf16 v[180:183], a[108:111], a[60:63], v[180:183]
ds_read_b64_tr_b16 a[98:99], v14 offset:8448
v_mfma_f32_16x16x32_bf16 v[172:175], a[108:111], a[56:59], v[172:175]
ds_read_b64_tr_b16 a[100:101], v14 offset:10240
v_mfma_f32_16x16x32_bf16 v[172:175], a[104:107], a[40:43], v[172:175]
ds_read_b64_tr_b16 a[102:103], v14 offset:10496
s_add_u32 m0, s16, 0x1c00
v_mfma_f32_16x16x32_bf16 v[164:167], a[104:107], a[36:39], v[164:167]
buffer_load_dwordx4 v23, s[44:47], s23 offen lds
v_mfma_f32_16x16x32_bf16 v[164:167], a[108:111], a[52:55], v[164:167]
v_lshl_add_u32 v22, s42, 7, v22
v_lshl_add_u32 v23, s42, 7, v23
v_mfma_f32_16x16x32_bf16 v[156:159], a[108:111], a[48:51], v[156:159]
v_mfma_f32_16x16x32_bf16 v[156:159], a[104:107], a[32:35], v[156:159]
s_waitcnt lgkmcnt(4)
v_mfma_f32_16x16x32_bf16 v[184:187], a[80:83], a[32:35], v[184:187]
ds_read_b64_tr_b16 a[104:105], v15 offset:8192
v_mfma_f32_16x16x32_bf16 v[184:187], a[84:87], a[48:51], v[184:187]
ds_read_b64_tr_b16 a[106:107], v15 offset:8448
s_add_u32 s8, s28, 0x3400
v_mfma_f32_16x16x32_bf16 v[192:195], a[84:87], a[52:55], v[192:195]
buffer_store_dwordx4 a[148:151], v16, s[88:91], s8 offen sc1
v_mfma_f32_16x16x32_bf16 v[192:195], a[80:83], a[36:39], v[192:195]
ds_read_b64_tr_b16 a[108:109], v15 offset:10240
v_mfma_f32_16x16x32_bf16 v[200:203], a[80:83], a[40:43], v[200:203]
ds_read_b64_tr_b16 a[110:111], v15 offset:10496
v_add_u32 v12, 0x8000, v12
v_mfma_f32_16x16x32_bf16 v[200:203], a[84:87], a[56:59], v[200:203]
v_add_u32 v13, 0x8000, v13
v_add_u32 v14, 0x8000, v14
v_mfma_f32_16x16x32_bf16 v[208:211], a[84:87], a[60:63], v[208:211]
v_add_u32 v15, 0x8000, v15
v_mfma_f32_16x16x32_bf16 v[208:211], a[80:83], a[44:47], v[208:211]
v_mfma_f32_16x16x32_bf16 v[212:215], a[88:91], a[44:47], v[212:215]
s_waitcnt vmcnt(28) lgkmcnt(0)
v_mfma_f32_16x16x32_bf16 v[212:215], a[92:95], a[60:63], v[212:215]
s_barrier
s_add_u32 m0, s17, 0x0
v_mfma_f32_16x16x32_bf16 v[204:207], a[92:95], a[56:59], v[204:207]
buffer_load_dwordx4 v5, s[52:55], 0 offen lds
v_mfma_f32_16x16x32_bf16 v[204:207], a[88:91], a[40:43], v[204:207]
ds_read_b64_tr_b16 a[80:81], v12 offset:0
v_mfma_f32_16x16x32_bf16 v[196:199], a[88:91], a[36:39], v[196:199]
ds_read_b64_tr_b16 a[82:83], v12 offset:1024
v_mfma_f32_16x16x32_bf16 v[196:199], a[92:95], a[52:55], v[196:199]
ds_read_b64_tr_b16 a[84:85], v12 offset:8192
v_mfma_f32_16x16x32_bf16 v[188:191], a[92:95], a[48:51], v[188:191]
ds_read_b64_tr_b16 a[86:87], v12 offset:9216
v_mfma_f32_16x16x32_bf16 v[188:191], a[88:91], a[32:35], v[188:191]
s_add_u32 m0, s17, 0x400
s_waitcnt lgkmcnt(4)
v_mfma_f32_16x16x32_bf16 v[216:219], a[32:35], a[96:99], v[216:219]
buffer_load_dwordx4 v5, s[52:55], s13 offen lds
v_mfma_f32_16x16x32_bf16 v[216:219], a[48:51], a[100:103], v[216:219]
ds_read_b64_tr_b16 a[88:89], v13 offset:0
v_mfma_f32_16x16x32_bf16 v[224:227], a[52:55], a[100:103], v[224:227]
ds_read_b64_tr_b16 a[90:91], v13 offset:1024
v_mfma_f32_16x16x32_bf16 v[224:227], a[36:39], a[96:99], v[224:227]
ds_read_b64_tr_b16 a[92:93], v13 offset:8192
v_mfma_f32_16x16x32_bf16 v[232:235], a[40:43], a[96:99], v[232:235]
ds_read_b64_tr_b16 a[94:95], v13 offset:9216
v_mfma_f32_16x16x32_bf16 v[232:235], a[56:59], a[100:103], v[232:235]
v_mfma_f32_16x16x32_bf16 v[240:243], a[60:63], a[100:103], v[240:243]
s_add_u32 m0, s17, 0x800
v_mfma_f32_16x16x32_bf16 v[240:243], a[44:47], a[96:99], v[240:243]
buffer_load_dwordx4 v6, s[52:55], 0 offen lds
v_mfma_f32_16x16x32_bf16 v[244:247], a[44:47], a[104:107], v[244:247]
ds_read_b64_tr_b16 a[96:97], v12 offset:256
v_mfma_f32_16x16x32_bf16 v[244:247], a[60:63], a[108:111], v[244:247]
ds_read_b64_tr_b16 a[98:99], v12 offset:1280
v_mfma_f32_16x16x32_bf16 v[236:239], a[56:59], a[108:111], v[236:239]
ds_read_b64_tr_b16 a[100:101], v12 offset:8448
v_mfma_f32_16x16x32_bf16 v[236:239], a[40:43], a[104:107], v[236:239]
ds_read_b64_tr_b16 a[102:103], v12 offset:9472
v_mfma_f32_16x16x32_bf16 v[228:231], a[36:39], a[104:107], v[228:231]
v_mfma_f32_16x16x32_bf16 v[228:231], a[52:55], a[108:111], v[228:231]
s_add_u32 m0, s17, 0xc00
v_mfma_f32_16x16x32_bf16 v[220:223], a[48:51], a[108:111], v[220:223]
buffer_load_dwordx4 v6, s[52:55], s13 offen lds
v_mfma_f32_16x16x32_bf16 v[220:223], a[32:35], a[104:107], v[220:223]
s_waitcnt lgkmcnt(4)
L_S10:
v_mfma_f32_16x16x32_bf16 v[24:27], a[80:83], a[0:3], v[24:27]
ds_read_b64_tr_b16 a[104:105], v13 offset:256
s_waitcnt vmcnt(23)
v_mfma_f32_16x16x32_bf16 v[24:27], a[84:87], a[16:19], v[24:27]
ds_read_b64_tr_b16 a[106:107], v13 offset:1280
v_mfma_f32_16x16x32_bf16 v[32:35], a[84:87], a[20:23], v[32:35]
ds_read_b64_tr_b16 a[108:109], v13 offset:8448
v_mfma_f32_16x16x32_bf16 v[32:35], a[80:83], a[4:7], v[32:35]
ds_read_b64_tr_b16 a[110:111], v13 offset:9472
v_mfma_f32_16x16x32_bf16 v[40:43], a[80:83], a[8:11], v[40:43]
ds_read_b128 a[32:35], v8 offset:32768
s_add_u32 m0, s18, 0x4000
v_mfma_f32_16x16x32_bf16 v[40:43], a[84:87], a[24:27], v[40:43]
buffer_load_dwordx4 v7, s[68:71], 0 offen lds
v_mfma_f32_16x16x32_bf16 v[48:51], a[84:87], a[28:31], v[48:51]
ds_read_b128 a[48:51], v9 offset:32768
v_mfma_f32_16x16x32_bf16 v[48:51], a[80:83], a[12:15], v[48:51]
ds_read_b128 a[36:39], v8 offset:34816
v_mfma_f32_16x16x32_bf16 v[52:55], a[88:91], a[12:15], v[52:55]
ds_read_b64_tr_b16 a[80:81], v12 offset:512
v_mfma_f32_16x16x32_bf16 v[52:55], a[92:95], a[28:31], v[52:55]
ds_read_b64_tr_b16 a[82:83], v12 offset:1536
v_mfma_f32_16x16x32_bf16 v[44:47], a[92:95], a[24:27], v[44:47]
ds_read_b64_tr_b16 a[84:85], v12 offset:8704
s_add_u32 s8, s28, 0x6400
v_mfma_f32_16x16x32_bf16 v[44:47], a[88:91], a[8:11], v[44:47]
buffer_store_dwordx4 a[152:155], v16, s[88:91], s8 offen sc1
v_mfma_f32_16x16x32_bf16 v[36:39], a[88:91], a[4:7], v[36:39]
ds_read_b64_tr_b16 a[86:87], v12 offset:9728
v_mfma_f32_16x16x32_bf16 v[36:39], a[92:95], a[20:23], v[36:39]
ds_read_b128 a[52:55], v9 offset:34816
v_mfma_f32_16x16x32_bf16 v[28:31], a[92:95], a[16:19], v[28:31]
ds_read_b128 a[40:43], v8 offset:36864
v_mfma_f32_16x16x32_bf16 v[28:31], a[88:91], a[0:3], v[28:31]
ds_read_b128 a[56:59], v9 offset:36864
s_waitcnt lgkmcnt(10)
v_mfma_f32_16x16x32_bf16 v[56:59], a[96:99], a[0:3], v[56:59]
ds_read_b64_tr_b16 a[88:89], v13 offset:512
v_mfma_f32_16x16x32_bf16 v[56:59], a[100:103], a[16:19], v[56:59]
ds_read_b64_tr_b16 a[90:91], v13 offset:1536
s_add_u32 m0, s18, 0x5000
v_mfma_f32_16x16x32_bf16 v[64:67], a[100:103], a[20:23], v[64:67]
buffer_load_dwordx4 v7, s[68:71], s25 offen lds
v_mfma_f32_16x16x32_bf16 v[64:67], a[96:99], a[4:7], v[64:67]
ds_read_b64_tr_b16 a[92:93], v13 offset:8704
v_mfma_f32_16x16x32_bf16 v[72:75], a[96:99], a[8:11], v[72:75]
ds_read_b64_tr_b16 a[94:95], v13 offset:9728
v_mfma_f32_16x16x32_bf16 v[72:75], a[100:103], a[24:27], v[72:75]
ds_read_b128 a[44:47], v8 offset:38912
v_mfma_f32_16x16x32_bf16 v[80:83], a[100:103], a[28:31], v[80:83]
ds_read_b128 a[60:63], v9 offset:38912
v_mfma_f32_16x16x32_bf16 v[80:83], a[96:99], a[12:15], v[80:83]
v_mfma_f32_16x16x32_bf16 v[84:87], a[104:107], a[12:15], v[84:87]
ds_read_b64_tr_b16 a[96:97], v12 offset:768
s_add_u32 m0, s18, 0x6000
v_mfma_f32_16x16x32_bf16 v[84:87], a[108:111], a[28:31], v[84:87]
buffer_load_dwordx4 v7, s[68:71], s26 offen lds
v_mfma_f32_16x16x32_bf16 v[76:79], a[108:111], a[24:27], v[76:79]
ds_read_b64_tr_b16 a[98:99], v12 offset:1792
v_lshl_add_u32 v5, s42, 19, v5
v_mfma_f32_16x16x32_bf16 v[76:79], a[104:107], a[8:11], v[76:79]
ds_read_b64_tr_b16 a[100:101], v12 offset:8960
v_lshl_add_u32 v6, s42, 19, v6
v_mfma_f32_16x16x32_bf16 v[68:71], a[104:107], a[4:7], v[68:71]
ds_read_b64_tr_b16 a[102:103], v12 offset:9984
v_lshl_add_u32 v7, s42, 18, v7
v_mfma_f32_16x16x32_bf16 v[68:71], a[108:111], a[20:23], v[68:71]
v_lshl_add_u32 v7, s42, 17, v7
v_mfma_f32_16x16x32_bf16 v[60:63], a[108:111], a[16:19], v[60:63]
v_mfma_f32_16x16x32_bf16 v[60:63], a[104:107], a[0:3], v[60:63]
s_add_u32 m0, s16, 0x8000
s_waitcnt lgkmcnt(4)
s_waitcnt lgkmcnt(6)
v_mfma_f32_16x16x32_bf16 v[88:91], a[80:83], a[0:3], v[88:91]
buffer_load_dwordx4 v22, s[44:47], s20 offen lds
v_mfma_f32_16x16x32_bf16 v[88:91], a[84:87], a[16:19], v[88:91]
ds_read_b64_tr_b16 a[104:105], v13 offset:768
v_mfma_f32_16x16x32_bf16 v[96:99], a[84:87], a[20:23], v[96:99]
ds_read_b64_tr_b16 a[106:107], v13 offset:1792
v_mfma_f32_16x16x32_bf16 v[96:99], a[80:83], a[4:7], v[96:99]
ds_read_b64_tr_b16 a[108:109], v13 offset:8960
v_mfma_f32_16x16x32_bf16 v[104:107], a[80:83], a[8:11], v[104:107]
ds_read_b64_tr_b16 a[110:111], v13 offset:9984
s_add_u32 m0, s16, 0x8400
v_mfma_f32_16x16x32_bf16 v[104:107], a[84:87], a[24:27], v[104:107]
buffer_load_dwordx4 v23, s[44:47], s20 offen lds
v_mfma_f32_16x16x32_bf16 v[112:115], a[84:87], a[28:31], v[112:115]
v_mfma_f32_16x16x32_bf16 v[112:115], a[80:83], a[12:15], v[112:115]
v_mfma_f32_16x16x32_bf16 v[116:119], a[88:91], a[12:15], v[116:119]
ds_read_b64_tr_b16 a[80:81], v14 offset:0
v_mfma_f32_16x16x32_bf16 v[116:119], a[92:95], a[28:31], v[116:119]
ds_read_b64_tr_b16 a[82:83], v14 offset:256
v_mfma_f32_16x16x32_bf16 v[108:111], a[92:95], a[24:27], v[108:111]
ds_read_b64_tr_b16 a[84:85], v14 offset:2048
s_add_u32 m0, s16, 0x8800
v_mfma_f32_16x16x32_bf16 v[108:111], a[88:91], a[8:11], v[108:111]
buffer_load_dwordx4 v22, s[44:47], s21 offen lds
v_mfma_f32_16x16x32_bf16 v[100:103], a[88:91], a[4:7], v[100:103]
ds_read_b64_tr_b16 a[86:87], v14 offset:2304
v_mfma_f32_16x16x32_bf16 v[100:103], a[92:95], a[20:23], v[100:103]
v_mfma_f32_16x16x32_bf16 v[92:95], a[92:95], a[16:19], v[92:95]
v_mfma_f32_16x16x32_bf16 v[92:95], a[88:91], a[0:3], v[92:95]
s_add_u32 s8, s28, 0x7400
s_waitcnt lgkmcnt(4)
v_mfma_f32_16x16x32_bf16 v[120:123], a[96:99], a[0:3], v[120:123]
buffer_store_dwordx4 a[156:159], v16, s[88:91], s8 offen sc1
v_mfma_f32_16x16x32_bf16 v[120:123], a[100:103], a[16:19], v[120:123]
ds_read_b64_tr_b16 a[88:89], v15 offset:0
v_mfma_f32_16x16x32_bf16 v[128:131], a[100:103], a[20:23], v[128:131]
ds_read_b64_tr_b16 a[90:91], v15 offset:256
v_mfma_f32_16x16x32_bf16 v[128:131], a[96:99], a[4:7], v[128:131]
ds_read_b64_tr_b16 a[92:93], v15 offset:2048
v_mfma_f32_16x16x32_bf16 v[136:139], a[96:99], a[8:11], v[136:139]
ds_read_b64_tr_b16 a[94:95], v15 offset:2304
v_mfma_f32_16x16x32_bf16 v[136:139], a[100:103], a[24:27], v[136:139]
s_add_u32 m0, s16, 0x8c00
v_mfma_f32_16x16x32_bf16 v[144:147], a[100:103], a[28:31], v[144:147]
buffer_load_dwordx4 v23, s[44:47], s21 offen lds
v_mfma_f32_16x16x32_bf16 v[144:147], a[96:99], a[12:15], v[144:147]
v_mfma_f32_16x16x32_bf16 v[148:151], a[104:107], a[12:15], v[148:151]
ds_read_b64_tr_b16 a[96:97], v14 offset:4096
v_mfma_f32_16x16x32_bf16 v[148:151], a[108:111], a[28:31], v[148:151]
ds_read_b64_tr_b16 a[98:99], v14 offset:4352
v_mfma_f32_16x16x32_bf16 v[140:143], a[108:111], a[24:27], v[140:143]
ds_read_b64_tr_b16 a[100:101], v14 offset:6144
v_mfma_f32_16x16x32_bf16 v[140:143], a[104:107], a[8:11], v[140:143]
ds_read_b64_tr_b16 a[102:103], v14 offset:6400
s_add_u32 m0, s16, 0x9000
v_mfma_f32_16x16x32_bf16 v[132:135], a[104:107], a[4:7], v[132:135]
buffer_load_dwordx4 v22, s[44:47], s22 offen lds
v_mfma_f32_16x16x32_bf16 v[132:135], a[108:111], a[20:23], v[132:135]
v_mfma_f32_16x16x32_bf16 v[124:127], a[108:111], a[16:19], v[124:127]
v_mfma_f32_16x16x32_bf16 v[124:127], a[104:107], a[0:3], v[124:127]
s_waitcnt lgkmcnt(4)
v_mfma_f32_16x16x32_bf16 v[152:155], a[80:83], a[0:3], v[152:155]
ds_read_b64_tr_b16 a[104:105], v15 offset:4096
s_add_u32 m0, s16, 0x9400
v_mfma_f32_16x16x32_bf16 v[152:155], a[84:87], a[16:19], v[152:155]
buffer_load_dwordx4 v23, s[44:47], s22 offen lds
v_mfma_f32_16x16x32_bf16 v[160:163], a[84:87], a[20:23], v[160:163]
ds_read_b64_tr_b16 a[106:107], v15 offset:4352
v_mfma_f32_16x16x32_bf16 v[160:163], a[80:83], a[4:7], v[160:163]
ds_read_b64_tr_b16 a[108:109], v15 offset:6144
v_mfma_f32_16x16x32_bf16 v[168:171], a[80:83], a[8:11], v[168:171]
ds_read_b64_tr_b16 a[110:111], v15 offset:6400
v_mfma_f32_16x16x32_bf16 v[168:171], a[84:87], a[24:27], v[168:171]
v_mfma_f32_16x16x32_bf16 v[176:179], a[84:87], a[28:31], v[176:179]
s_add_u32 m0, s16, 0x9800
v_mfma_f32_16x16x32_bf16 v[176:179], a[80:83], a[12:15], v[176:179]
buffer_load_dwordx4 v22, s[44:47], s23 offen lds
v_mfma_f32_16x16x32_bf16 v[180:183], a[88:91], a[12:15], v[180:183]
ds_read_b64_tr_b16 a[80:81], v14 offset:8192
v_mfma_f32_16x16x32_bf16 v[180:183], a[92:95], a[28:31], v[180:183]
ds_read_b64_tr_b16 a[82:83], v14 offset:8448
v_mfma_f32_16x16x32_bf16 v[172:175], a[92:95], a[24:27], v[172:175]
ds_read_b64_tr_b16 a[84:85], v14 offset:10240
v_mfma_f32_16x16x32_bf16 v[172:175], a[88:91], a[8:11], v[172:175]
ds_read_b64_tr_b16 a[86:87], v14 offset:10496
s_add_u32 m0, s16, 0x9c00
v_mfma_f32_16x16x32_bf16 v[164:167], a[88:91], a[4:7], v[164:167]
buffer_load_dwordx4 v23, s[44:47], s23 offen lds
v_mfma_f32_16x16x32_bf16 v[164:167], a[92:95], a[20:23], v[164:167]
v_lshl_add_u32 v22, s42, 7, v22
v_lshl_add_u32 v23, s42, 7, v23
v_mfma_f32_16x16x32_bf16 v[156:159], a[92:95], a[16:19], v[156:159]
v_mfma_f32_16x16x32_bf16 v[156:159], a[88:91], a[0:3], v[156:159]
s_waitcnt lgkmcnt(4)
v_mfma_f32_16x16x32_bf16 v[184:187], a[96:99], a[0:3], v[184:187]
ds_read_b64_tr_b16 a[88:89], v15 offset:8192
v_mfma_f32_16x16x32_bf16 v[184:187], a[100:103], a[16:19], v[184:187]
ds_read_b64_tr_b16 a[90:91], v15 offset:8448
s_add_u32 s8, s28, 0x2800
v_mfma_f32_16x16x32_bf16 v[192:195], a[100:103], a[20:23], v[192:195]
buffer_store_dwordx4 a[160:163], v16, s[88:91], s8 offen sc1
v_mfma_f32_16x16x32_bf16 v[192:195], a[96:99], a[4:7], v[192:195]
ds_read_b64_tr_b16 a[92:93], v15 offset:10240
v_mfma_f32_16x16x32_bf16 v[200:203], a[96:99], a[8:11], v[200:203]
ds_read_b64_tr_b16 a[94:95], v15 offset:10496
v_add_u32 v12, 0x8000, v12
v_mfma_f32_16x16x32_bf16 v[200:203], a[100:103], a[24:27], v[200:203]
v_add_u32 v13, 0x8000, v13
v_add_u32 v14, 0x8000, v14
v_mfma_f32_16x16x32_bf16 v[208:211], a[100:103], a[28:31], v[208:211]
v_add_u32 v15, 0x8000, v15
v_mfma_f32_16x16x32_bf16 v[208:211], a[96:99], a[12:15], v[208:211]
v_mfma_f32_16x16x32_bf16 v[212:215], a[104:107], a[12:15], v[212:215]
s_waitcnt vmcnt(28) lgkmcnt(0)
v_mfma_f32_16x16x32_bf16 v[212:215], a[108:111], a[28:31], v[212:215]
s_barrier
s_add_u32 m0, s17, 0x8000
v_mfma_f32_16x16x32_bf16 v[204:207], a[108:111], a[24:27], v[204:207]
buffer_load_dwordx4 v5, s[52:55], 0 offen lds
v_mfma_f32_16x16x32_bf16 v[204:207], a[104:107], a[8:11], v[204:207]
ds_read_b64_tr_b16 a[96:97], v12 offset:0
v_mfma_f32_16x16x32_bf16 v[196:199], a[104:107], a[4:7], v[196:199]
ds_read_b64_tr_b16 a[98:99], v12 offset:1024
v_mfma_f32_16x16x32_bf16 v[196:199], a[108:111], a[20:23], v[196:199]
ds_read_b64_tr_b16 a[100:101], v12 offset:8192
v_mfma_f32_16x16x32_bf16 v[188:191], a[108:111], a[16:19], v[188:191]
ds_read_b64_tr_b16 a[102:103], v12 offset:9216
v_mfma_f32_16x16x32_bf16 v[188:191], a[104:107], a[0:3], v[188:191]
s_add_u32 m0, s17, 0x8400
s_waitcnt lgkmcnt(4)
v_mfma_f32_16x16x32_bf16 v[216:219], a[0:3], a[80:83], v[216:219]
buffer_load_dwordx4 v5, s[52:55], s13 offen lds
v_mfma_f32_16x16x32_bf16 v[216:219], a[16:19], a[84:87], v[216:219]
ds_read_b64_tr_b16 a[104:105], v13 offset:0
v_mfma_f32_16x16x32_bf16 v[224:227], a[20:23], a[84:87], v[224:227]
ds_read_b64_tr_b16 a[106:107], v13 offset:1024
v_mfma_f32_16x16x32_bf16 v[224:227], a[4:7], a[80:83], v[224:227]
ds_read_b64_tr_b16 a[108:109], v13 offset:8192
v_mfma_f32_16x16x32_bf16 v[232:235], a[8:11], a[80:83], v[232:235]
ds_read_b64_tr_b16 a[110:111], v13 offset:9216
v_mfma_f32_16x16x32_bf16 v[232:235], a[24:27], a[84:87], v[232:235]
v_mfma_f32_16x16x32_bf16 v[240:243], a[28:31], a[84:87], v[240:243]
s_add_u32 m0, s17, 0x8800
v_mfma_f32_16x16x32_bf16 v[240:243], a[12:15], a[80:83], v[240:243]
buffer_load_dwordx4 v6, s[52:55], 0 offen lds
v_mfma_f32_16x16x32_bf16 v[244:247], a[12:15], a[88:91], v[244:247]
ds_read_b64_tr_b16 a[80:81], v12 offset:256
v_mfma_f32_16x16x32_bf16 v[244:247], a[28:31], a[92:95], v[244:247]
ds_read_b64_tr_b16 a[82:83], v12 offset:1280
v_mfma_f32_16x16x32_bf16 v[236:239], a[24:27], a[92:95], v[236:239]
ds_read_b64_tr_b16 a[84:85], v12 offset:8448
v_mfma_f32_16x16x32_bf16 v[236:239], a[8:11], a[88:91], v[236:239]
ds_read_b64_tr_b16 a[86:87], v12 offset:9472
v_mfma_f32_16x16x32_bf16 v[228:231], a[4:7], a[88:91], v[228:231]
v_mfma_f32_16x16x32_bf16 v[228:231], a[20:23], a[92:95], v[228:231]
s_add_u32 m0, s17, 0x8c00
v_mfma_f32_16x16x32_bf16 v[220:223], a[16:19], a[92:95], v[220:223]
buffer_load_dwordx4 v6, s[52:55], s13 offen lds
v_mfma_f32_16x16x32_bf16 v[220:223], a[0:3], a[88:91], v[220:223]
s_waitcnt lgkmcnt(4)
L_S11:
v_mfma_f32_16x16x32_bf16 v[24:27], a[96:99], a[32:35], v[24:27]
ds_read_b64_tr_b16 a[88:89], v13 offset:256
s_waitcnt vmcnt(23)
v_mfma_f32_16x16x32_bf16 v[24:27], a[100:103], a[48:51], v[24:27]
ds_read_b64_tr_b16 a[90:91], v13 offset:1280
v_mfma_f32_16x16x32_bf16 v[32:35], a[100:103], a[52:55], v[32:35]
ds_read_b64_tr_b16 a[92:93], v13 offset:8448
v_mfma_f32_16x16x32_bf16 v[32:35], a[96:99], a[36:39], v[32:35]
ds_read_b64_tr_b16 a[94:95], v13 offset:9472
v_mfma_f32_16x16x32_bf16 v[40:43], a[96:99], a[40:43], v[40:43]
ds_read_b128 a[0:3], v8 offset:0
s_add_u32 m0, s18, 0xc000
v_mfma_f32_16x16x32_bf16 v[40:43], a[100:103], a[56:59], v[40:43]
buffer_load_dwordx4 v7, s[68:71], 0 offen lds
v_mfma_f32_16x16x32_bf16 v[48:51], a[100:103], a[60:63], v[48:51]
ds_read_b128 a[16:19], v9 offset:0
v_mfma_f32_16x16x32_bf16 v[48:51], a[96:99], a[44:47], v[48:51]
ds_read_b128 a[4:7], v8 offset:2048
v_mfma_f32_16x16x32_bf16 v[52:55], a[104:107], a[44:47], v[52:55]
ds_read_b64_tr_b16 a[96:97], v12 offset:512
v_mfma_f32_16x16x32_bf16 v[52:55], a[108:111], a[60:63], v[52:55]
ds_read_b64_tr_b16 a[98:99], v12 offset:1536
v_mfma_f32_16x16x32_bf16 v[44:47], a[108:111], a[56:59], v[44:47]
ds_read_b64_tr_b16 a[100:101], v12 offset:8704
s_add_u32 s8, s28, 0x3800
v_mfma_f32_16x16x32_bf16 v[44:47], a[104:107], a[40:43], v[44:47]
buffer_store_dwordx4 a[164:167], v16, s[88:91], s8 offen sc1
v_mfma_f32_16x16x32_bf16 v[36:39], a[104:107], a[36:39], v[36:39]
ds_read_b64_tr_b16 a[102:103], v12 offset:9728
v_mfma_f32_16x16x32_bf16 v[36:39], a[108:111], a[52:55], v[36:39]
ds_read_b128 a[20:23], v9 offset:2048
v_mfma_f32_16x16x32_bf16 v[28:31], a[108:111], a[48:51], v[28:31]
ds_read_b128 a[8:11], v8 offset:4096
v_mfma_f32_16x16x32_bf16 v[28:31], a[104:107], a[32:35], v[28:31]
ds_read_b128 a[24:27], v9 offset:4096
s_waitcnt lgkmcnt(10)
v_mfma_f32_16x16x32_bf16 v[56:59], a[80:83], a[32:35], v[56:59]
ds_read_b64_tr_b16 a[104:105], v13 offset:512
v_mfma_f32_16x16x32_bf16 v[56:59], a[84:87], a[48:51], v[56:59]
ds_read_b64_tr_b16 a[106:107], v13 offset:1536
s_add_u32 m0, s18, 0xd000
v_mfma_f32_16x16x32_bf16 v[64:67], a[84:87], a[52:55], v[64:67]
buffer_load_dwordx4 v7, s[68:71], s25 offen lds
v_mfma_f32_16x16x32_bf16 v[64:67], a[80:83], a[36:39], v[64:67]
ds_read_b64_tr_b16 a[108:109], v13 offset:8704
v_mfma_f32_16x16x32_bf16 v[72:75], a[80:83], a[40:43], v[72:75]
ds_read_b64_tr_b16 a[110:111], v13 offset:9728
v_mfma_f32_16x16x32_bf16 v[72:75], a[84:87], a[56:59], v[72:75]
ds_read_b128 a[12:15], v8 offset:6144
v_mfma_f32_16x16x32_bf16 v[80:83], a[84:87], a[60:63], v[80:83]
ds_read_b128 a[28:31], v9 offset:6144
v_mfma_f32_16x16x32_bf16 v[80:83], a[80:83], a[44:47], v[80:83]
v_mfma_f32_16x16x32_bf16 v[84:87], a[88:91], a[44:47], v[84:87]
ds_read_b64_tr_b16 a[80:81], v12 offset:768
s_add_u32 m0, s18, 0xe000
v_mfma_f32_16x16x32_bf16 v[84:87], a[92:95], a[60:63], v[84:87]
buffer_load_dwordx4 v7, s[68:71], s26 offen lds
v_mfma_f32_16x16x32_bf16 v[76:79], a[92:95], a[56:59], v[76:79]
ds_read_b64_tr_b16 a[82:83], v12 offset:1792
v_lshl_add_u32 v5, s42, 19, v5
v_mfma_f32_16x16x32_bf16 v[76:79], a[88:91], a[40:43], v[76:79]
ds_read_b64_tr_b16 a[84:85], v12 offset:8960
v_lshl_add_u32 v6, s42, 19, v6
v_mfma_f32_16x16x32_bf16 v[68:71], a[88:91], a[36:39], v[68:71]
ds_read_b64_tr_b16 a[86:87], v12 offset:9984
v_lshl_add_u32 v7, s42, 18, v7
v_mfma_f32_16x16x32_bf16 v[68:71], a[92:95], a[52:55], v[68:71]
L_padA6:
s_cmp_eq_u32 s95, 1
s_cbranch_scc1 L_padA10
v_lshl_add_u32 v7, s42, 17, v7
v_mfma_f32_16x16x32_bf16 v[60:63], a[92:95], a[48:51], v[60:63]
v_mfma_f32_16x16x32_bf16 v[60:63], a[88:91], a[32:35], v[60:63]
s_add_u32 m0, s16, 0x0
s_waitcnt lgkmcnt(4)
s_waitcnt lgkmcnt(6)
v_mfma_f32_16x16x32_bf16 v[88:91], a[96:99], a[32:35], v[88:91]
buffer_load_dwordx4 v22, s[44:47], s20 offen lds
v_mfma_f32_16x16x32_bf16 v[88:91], a[100:103], a[48:51], v[88:91]
ds_read_b64_tr_b16 a[88:89], v13 offset:768
v_mfma_f32_16x16x32_bf16 v[96:99], a[100:103], a[52:55], v[96:99]
ds_read_b64_tr_b16 a[90:91], v13 offset:1792
v_mfma_f32_16x16x32_bf16 v[96:99], a[96:99], a[36:39], v[96:99]
ds_read_b64_tr_b16 a[92:93], v13 offset:8960
v_mfma_f32_16x16x32_bf16 v[104:107], a[96:99], a[40:43], v[104:107]
ds_read_b64_tr_b16 a[94:95], v13 offset:9984
s_add_u32 m0, s16, 0x400
v_mfma_f32_16x16x32_bf16 v[104:107], a[100:103], a[56:59], v[104:107]
buffer_load_dwordx4 v23, s[44:47], s20 offen lds
v_mfma_f32_16x16x32_bf16 v[112:115], a[100:103], a[60:63], v[112:115]
v_mfma_f32_16x16x32_bf16 v[112:115], a[96:99], a[44:47], v[112:115]
v_mfma_f32_16x16x32_bf16 v[116:119], a[104:107], a[44:47], v[116:119]
ds_read_b64_tr_b16 a[96:97], v14 offset:0
v_mfma_f32_16x16x32_bf16 v[116:119], a[108:111], a[60:63], v[116:119]
ds_read_b64_tr_b16 a[98:99], v14 offset:256
v_mfma_f32_16x16x32_bf16 v[108:111], a[108:111], a[56:59], v[108:111]
ds_read_b64_tr_b16 a[100:101], v14 offset:2048
s_add_u32 m0, s16, 0x800
v_mfma_f32_16x16x32_bf16 v[108:111], a[104:107], a[40:43], v[108:111]
buffer_load_dwordx4 v22, s[44:47], s21 offen lds
v_mfma_f32_16x16x32_bf16 v[100:103], a[104:107], a[36:39], v[100:103]
ds_read_b64_tr_b16 a[102:103], v14 offset:2304
v_mfma_f32_16x16x32_bf16 v[100:103], a[108:111], a[52:55], v[100:103]
v_mfma_f32_16x16x32_bf16 v[92:95], a[108:111], a[48:51], v[92:95]
v_mfma_f32_16x16x32_bf16 v[92:95], a[104:107], a[32:35], v[92:95]
s_add_u32 s8, s28, 0x6800
s_waitcnt lgkmcnt(4)
v_mfma_f32_16x16x32_bf16 v[120:123], a[80:83], a[32:35], v[120:123]
buffer_store_dwordx4 a[168:171], v16, s[88:91], s8 offen sc1
v_mfma_f32_16x16x32_bf16 v[120:123], a[84:87], a[48:51], v[120:123]
ds_read_b64_tr_b16 a[104:105], v15 offset:0
v_mfma_f32_16x16x32_bf16 v[128:131], a[84:87], a[52:55], v[128:131]
ds_read_b64_tr_b16 a[106:107], v15 offset:256
v_mfma_f32_16x16x32_bf16 v[128:131], a[80:83], a[36:39], v[128:131]
ds_read_b64_tr_b16 a[108:109], v15 offset:2048
v_mfma_f32_16x16x32_bf16 v[136:139], a[80:83], a[40:43], v[136:139]
ds_read_b64_tr_b16 a[110:111], v15 offset:2304
v_mfma_f32_16x16x32_bf16 v[136:139], a[84:87], a[56:59], v[136:139]
s_add_u32 m0, s16, 0xc00
v_mfma_f32_16x16x32_bf16 v[144:147], a[84:87], a[60:63], v[144:147]
buffer_load_dwordx4 v23, s[44:47], s21 offen lds
v_mfma_f32_16x16x32_bf16 v[144:147], a[80:83], a[44:47], v[144:147]
v_mfma_f32_16x16x32_bf16 v[148:151], a[88:91], a[44:47], v[148:151]
ds_read_b64_tr_b16 a[80:81], v14 offset:4096
v_mfma_f32_16x16x32_bf16 v[148:151], a[92:95], a[60:63], v[148:151]
ds_read_b64_tr_b16 a[82:83], v14 offset:4352
v_mfma_f32_16x16x32_bf16 v[140:143], a[92:95], a[56:59], v[140:143]
ds_read_b64_tr_b16 a[84:85], v14 offset:6144
v_mfma_f32_16x16x32_bf16 v[140:143], a[88:91], a[40:43], v[140:143]
ds_read_b64_tr_b16 a[86:87], v14 offset:6400
s_add_u32 m0, s16, 0x1000
v_mfma_f32_16x16x32_bf16 v[132:135], a[88:91], a[36:39], v[132:135]
buffer_load_dwordx4 v22, s[44:47], s22 offen lds
v_mfma_f32_16x16x32_bf16 v[132:135], a[92:95], a[52:55], v[132:135]
v_mfma_f32_16x16x32_bf16 v[124:127], a[92:95], a[48:51], v[124:127]
v_mfma_f32_16x16x32_bf16 v[124:127], a[88:91], a[32:35], v[124:127]
s_waitcnt lgkmcnt(4)
v_mfma_f32_16x16x32_bf16 v[152:155], a[96:99], a[32:35], v[152:155]
ds_read_b64_tr_b16 a[88:89], v15 offset:4096
s_add_u32 m0, s16, 0x1400
v_mfma_f32_16x16x32_bf16 v[152:155], a[100:103], a[48:51], v[152:155]
buffer_load_dwordx4 v23, s[44:47], s22 offen lds
v_mfma_f32_16x16x32_bf16 v[160:163], a[100:103], a[52:55], v[160:163]
ds_read_b64_tr_b16 a[90:91], v15 offset:4352
v_mfma_f32_16x16x32_bf16 v[160:163], a[96:99], a[36:39], v[160:163]
ds_read_b64_tr_b16 a[92:93], v15 offset:6144
v_mfma_f32_16x16x32_bf16 v[168:171], a[96:99], a[40:43], v[168:171]
ds_read_b64_tr_b16 a[94:95], v15 offset:6400
v_mfma_f32_16x16x32_bf16 v[168:171], a[100:103], a[56:59], v[168:171]
v_mfma_f32_16x16x32_bf16 v[176:179], a[100:103], a[60:63], v[176:179]
s_add_u32 m0, s16, 0x1800
v_mfma_f32_16x16x32_bf16 v[176:179], a[96:99], a[44:47], v[176:179]
buffer_load_dwordx4 v22, s[44:47], s23 offen lds
v_mfma_f32_16x16x32_bf16 v[180:183], a[104:107], a[44:47], v[180:183]
ds_read_b64_tr_b16 a[96:97], v14 offset:8192
v_mfma_f32_16x16x32_bf16 v[180:183], a[108:111], a[60:63], v[180:183]
ds_read_b64_tr_b16 a[98:99], v14 offset:8448
v_mfma_f32_16x16x32_bf16 v[172:175], a[108:111], a[56:59], v[172:175]
ds_read_b64_tr_b16 a[100:101], v14 offset:10240
v_mfma_f32_16x16x32_bf16 v[172:175], a[104:107], a[40:43], v[172:175]
ds_read_b64_tr_b16 a[102:103], v14 offset:10496
s_add_u32 m0, s16, 0x1c00
v_mfma_f32_16x16x32_bf16 v[164:167], a[104:107], a[36:39], v[164:167]
buffer_load_dwordx4 v23, s[44:47], s23 offen lds
v_mfma_f32_16x16x32_bf16 v[164:167], a[108:111], a[52:55], v[164:167]
v_lshl_add_u32 v22, s42, 7, v22
v_lshl_add_u32 v23, s42, 7, v23
v_mfma_f32_16x16x32_bf16 v[156:159], a[108:111], a[48:51], v[156:159]
v_mfma_f32_16x16x32_bf16 v[156:159], a[104:107], a[32:35], v[156:159]
s_waitcnt lgkmcnt(4)
v_mfma_f32_16x16x32_bf16 v[184:187], a[80:83], a[32:35], v[184:187]
ds_read_b64_tr_b16 a[104:105], v15 offset:8192
v_mfma_f32_16x16x32_bf16 v[184:187], a[84:87], a[48:51], v[184:187]
ds_read_b64_tr_b16 a[106:107], v15 offset:8448
s_add_u32 s8, s28, 0x7800
v_mfma_f32_16x16x32_bf16 v[192:195], a[84:87], a[52:55], v[192:195]
buffer_store_dwordx4 a[172:175], v16, s[88:91], s8 offen sc1
v_mfma_f32_16x16x32_bf16 v[192:195], a[80:83], a[36:39], v[192:195]
ds_read_b64_tr_b16 a[108:109], v15 offset:10240
v_mfma_f32_16x16x32_bf16 v[200:203], a[80:83], a[40:43], v[200:203]
ds_read_b64_tr_b16 a[110:111], v15 offset:10496
v_add_u32 v12, 0xffff0000, v12
v_mfma_f32_16x16x32_bf16 v[200:203], a[84:87], a[56:59], v[200:203]
v_add_u32 v13, 0xffff0000, v13
v_add_u32 v14, 0xffff0000, v14
v_mfma_f32_16x16x32_bf16 v[208:211], a[84:87], a[60:63], v[208:211]
v_add_u32 v15, 0xffff0000, v15
v_mfma_f32_16x16x32_bf16 v[208:211], a[80:83], a[44:47], v[208:211]
v_mfma_f32_16x16x32_bf16 v[212:215], a[88:91], a[44:47], v[212:215]
s_waitcnt vmcnt(28) lgkmcnt(0)
v_mfma_f32_16x16x32_bf16 v[212:215], a[92:95], a[60:63], v[212:215]
s_barrier
s_add_u32 m0, s17, 0x10000
v_mfma_f32_16x16x32_bf16 v[204:207], a[92:95], a[56:59], v[204:207]
buffer_load_dwordx4 v5, s[52:55], 0 offen lds
v_mfma_f32_16x16x32_bf16 v[204:207], a[88:91], a[40:43], v[204:207]
ds_read_b64_tr_b16 a[80:81], v12 offset:0
v_mfma_f32_16x16x32_bf16 v[196:199], a[88:91], a[36:39], v[196:199]
ds_read_b64_tr_b16 a[82:83], v12 offset:1024
v_mfma_f32_16x16x32_bf16 v[196:199], a[92:95], a[52:55], v[196:199]
ds_read_b64_tr_b16 a[84:85], v12 offset:8192
v_mfma_f32_16x16x32_bf16 v[188:191], a[92:95], a[48:51], v[188:191]
ds_read_b64_tr_b16 a[86:87], v12 offset:9216
v_mfma_f32_16x16x32_bf16 v[188:191], a[88:91], a[32:35], v[188:191]
s_add_u32 m0, s17, 0x10400
s_waitcnt lgkmcnt(4)
v_mfma_f32_16x16x32_bf16 v[216:219], a[32:35], a[96:99], v[216:219]
buffer_load_dwordx4 v5, s[52:55], s13 offen lds
v_mfma_f32_16x16x32_bf16 v[216:219], a[48:51], a[100:103], v[216:219]
ds_read_b64_tr_b16 a[88:89], v13 offset:0
v_mfma_f32_16x16x32_bf16 v[224:227], a[52:55], a[100:103], v[224:227]
ds_read_b64_tr_b16 a[90:91], v13 offset:1024
v_mfma_f32_16x16x32_bf16 v[224:227], a[36:39], a[96:99], v[224:227]
ds_read_b64_tr_b16 a[92:93], v13 offset:8192
v_mfma_f32_16x16x32_bf16 v[232:235], a[40:43], a[96:99], v[232:235]
ds_read_b64_tr_b16 a[94:95], v13 offset:9216
v_mfma_f32_16x16x32_bf16 v[232:235], a[56:59], a[100:103], v[232:235]
s_add_u32 m0, s17, 0x10800
v_mfma_f32_16x16x32_bf16 v[240:243], a[60:63], a[100:103], v[240:243]
buffer_load_dwordx4 v6, s[52:55], 0 offen lds
v_mfma_f32_16x16x32_bf16 v[240:243], a[44:47], a[96:99], v[240:243]
v_mfma_f32_16x16x32_bf16 v[244:247], a[44:47], a[104:107], v[244:247]
ds_read_b64_tr_b16 a[96:97], v12 offset:256
v_mfma_f32_16x16x32_bf16 v[244:247], a[60:63], a[108:111], v[244:247]
ds_read_b64_tr_b16 a[98:99], v12 offset:1280
v_mfma_f32_16x16x32_bf16 v[236:239], a[56:59], a[108:111], v[236:239]
ds_read_b64_tr_b16 a[100:101], v12 offset:8448
v_mfma_f32_16x16x32_bf16 v[236:239], a[40:43], a[104:107], v[236:239]
ds_read_b64_tr_b16 a[102:103], v12 offset:9472
s_add_u32 s8, s28, 0x2c00
v_mfma_f32_16x16x32_bf16 v[228:231], a[36:39], a[104:107], v[228:231]
buffer_store_dwordx4 a[176:179], v16, s[88:91], s8 offen sc1
v_mfma_f32_16x16x32_bf16 v[228:231], a[52:55], a[108:111], v[228:231]
v_mfma_f32_16x16x32_bf16 v[220:223], a[48:51], a[108:111], v[220:223]
v_mfma_f32_16x16x32_bf16 v[220:223], a[32:35], a[104:107], v[220:223]
s_waitcnt lgkmcnt(4)
L_S12:
v_mfma_f32_16x16x32_bf16 v[24:27], a[80:83], a[0:3], v[24:27]
ds_read_b64_tr_b16 a[104:105], v13 offset:256
s_waitcnt vmcnt(23)
v_mfma_f32_16x16x32_bf16 v[24:27], a[84:87], a[16:19], v[24:27]
ds_read_b64_tr_b16 a[106:107], v13 offset:1280
s_add_u32 m0, s17, 0x10c00
v_mfma_f32_16x16x32_bf16 v[32:35], a[84:87], a[20:23], v[32:35]
buffer_load_dwordx4 v6, s[52:55], s13 offen lds
v_mfma_f32_16x16x32_bf16 v[32:35], a[80:83], a[4:7], v[32:35]
ds_read_b64_tr_b16 a[108:109], v13 offset:8448
v_mfma_f32_16x16x32_bf16 v[40:43], a[80:83], a[8:11], v[40:43]
ds_read_b64_tr_b16 a[110:111], v13 offset:9472
v_mfma_f32_16x16x32_bf16 v[40:43], a[84:87], a[24:27], v[40:43]
ds_read_b128 a[32:35], v8 offset:32768
v_mfma_f32_16x16x32_bf16 v[48:51], a[84:87], a[28:31], v[48:51]
ds_read_b128 a[48:51], v9 offset:32768
v_mfma_f32_16x16x32_bf16 v[48:51], a[80:83], a[12:15], v[48:51]
ds_read_b128 a[36:39], v8 offset:34816
s_add_u32 m0, s18, 0x14000
v_mfma_f32_16x16x32_bf16 v[52:55], a[88:91], a[12:15], v[52:55]
buffer_load_dwordx4 v7, s[68:71], 0 offen lds
v_mfma_f32_16x16x32_bf16 v[52:55], a[92:95], a[28:31], v[52:55]
ds_read_b64_tr_b16 a[80:81], v12 offset:512
v_mfma_f32_16x16x32_bf16 v[44:47], a[92:95], a[24:27], v[44:47]
ds_read_b64_tr_b16 a[82:83], v12 offset:1536
v_mfma_f32_16x16x32_bf16 v[44:47], a[88:91], a[8:11], v[44:47]
ds_read_b64_tr_b16 a[84:85], v12 offset:8704
v_mfma_f32_16x16x32_bf16 v[36:39], a[88:91], a[4:7], v[36:39]
ds_read_b64_tr_b16 a[86:87], v12 offset:9728
v_mfma_f32_16x16x32_bf16 v[36:39], a[92:95], a[20:23], v[36:39]
ds_read_b128 a[52:55], v9 offset:34816
s_add_u32 m0, s18, 0x15000
v_mfma_f32_16x16x32_bf16 v[28:31], a[92:95], a[16:19], v[28:31]
buffer_load_dwordx4 v7, s[68:71], s25 offen lds
v_mfma_f32_16x16x32_bf16 v[28:31], a[88:91], a[0:3], v[28:31]
ds_read_b128 a[40:43], v8 offset:36864
s_waitcnt lgkmcnt(9)
v_mfma_f32_16x16x32_bf16 v[56:59], a[96:99], a[0:3], v[56:59]
ds_read_b64_tr_b16 a[88:89], v13 offset:512
v_mfma_f32_16x16x32_bf16 v[56:59], a[100:103], a[16:19], v[56:59]
ds_read_b64_tr_b16 a[90:91], v13 offset:1536
v_mfma_f32_16x16x32_bf16 v[64:67], a[100:103], a[20:23], v[64:67]
ds_read_b64_tr_b16 a[92:93], v13 offset:8704
v_mfma_f32_16x16x32_bf16 v[64:67], a[96:99], a[4:7], v[64:67]
ds_read_b64_tr_b16 a[94:95], v13 offset:9728
s_add_u32 m0, s18, 0x16000
v_mfma_f32_16x16x32_bf16 v[72:75], a[96:99], a[8:11], v[72:75]
buffer_load_dwordx4 v7, s[68:71], s26 offen lds
v_mfma_f32_16x16x32_bf16 v[72:75], a[100:103], a[24:27], v[72:75]
ds_read_b128 a[56:59], v9 offset:36864
v_lshl_add_u32 v5, s42, 19, v5
v_mfma_f32_16x16x32_bf16 v[80:83], a[100:103], a[28:31], v[80:83]
ds_read_b128 a[44:47], v8 offset:38912
v_lshl_add_u32 v6, s42, 19, v6
v_mfma_f32_16x16x32_bf16 v[80:83], a[96:99], a[12:15], v[80:83]
ds_read_b128 a[60:63], v9 offset:38912
v_lshl_add_u32 v7, s42, 18, v7
v_mfma_f32_16x16x32_bf16 v[84:87], a[104:107], a[12:15], v[84:87]
ds_read_b64_tr_b16 a[96:97], v12 offset:768
v_lshl_add_u32 v7, s42, 17, v7
v_mfma_f32_16x16x32_bf16 v[84:87], a[108:111], a[28:31], v[84:87]
ds_read_b64_tr_b16 a[98:99], v12 offset:1792
s_add_u32 s8, s28, 0x3c00
v_mfma_f32_16x16x32_bf16 v[76:79], a[108:111], a[24:27], v[76:79]
buffer_store_dwordx4 a[180:183], v16, s[88:91], s8 offen sc1
v_mfma_f32_16x16x32_bf16 v[76:79], a[104:107], a[8:11], v[76:79]
ds_read_b64_tr_b16 a[100:101], v12 offset:8960
v_mfma_f32_16x16x32_bf16 v[68:71], a[104:107], a[4:7], v[68:71]
ds_read_b64_tr_b16 a[102:103], v12 offset:9984
v_mfma_f32_16x16x32_bf16 v[68:71], a[108:111], a[20:23], v[68:71]
v_mfma_f32_16x16x32_bf16 v[60:63], a[108:111], a[16:19], v[60:63]
v_mfma_f32_16x16x32_bf16 v[60:63], a[104:107], a[0:3], v[60:63]
s_add_u32 m0, s16, 0x8000
s_waitcnt lgkmcnt(4)
s_waitcnt lgkmcnt(7)
v_mfma_f32_16x16x32_bf16 v[88:91], a[80:83], a[0:3], v[88:91]
buffer_load_dwordx4 v22, s[44:47], s20 offen lds
v_mfma_f32_16x16x32_bf16 v[88:91], a[84:87], a[16:19], v[88:91]
ds_read_b64_tr_b16 a[104:105], v13 offset:768
v_mfma_f32_16x16x32_bf16 v[96:99], a[84:87], a[20:23], v[96:99]
ds_read_b64_tr_b16 a[106:107], v13 offset:1792
v_mfma_f32_16x16x32_bf16 v[96:99], a[80:83], a[4:7], v[96:99]
ds_read_b64_tr_b16 a[108:109], v13 offset:8960
v_mfma_f32_16x16x32_bf16 v[104:107], a[80:83], a[8:11], v[104:107]
ds_read_b64_tr_b16 a[110:111], v13 offset:9984
s_add_u32 m0, s16, 0x8400
v_mfma_f32_16x16x32_bf16 v[104:107], a[84:87], a[24:27], v[104:107]
buffer_load_dwordx4 v23, s[44:47], s20 offen lds
v_mfma_f32_16x16x32_bf16 v[112:115], a[84:87], a[28:31], v[112:115]
v_mfma_f32_16x16x32_bf16 v[112:115], a[80:83], a[12:15], v[112:115]
v_mfma_f32_16x16x32_bf16 v[116:119], a[88:91], a[12:15], v[116:119]
ds_read_b64_tr_b16 a[80:81], v14 offset:0
v_mfma_f32_16x16x32_bf16 v[116:119], a[92:95], a[28:31], v[116:119]
ds_read_b64_tr_b16 a[82:83], v14 offset:256
v_mfma_f32_16x16x32_bf16 v[108:111], a[92:95], a[24:27], v[108:111]
ds_read_b64_tr_b16 a[84:85], v14 offset:2048
s_add_u32 m0, s16, 0x8800
v_mfma_f32_16x16x32_bf16 v[108:111], a[88:91], a[8:11], v[108:111]
buffer_load_dwordx4 v22, s[44:47], s21 offen lds
v_mfma_f32_16x16x32_bf16 v[100:103], a[88:91], a[4:7], v[100:103]
ds_read_b64_tr_b16 a[86:87], v14 offset:2304
v_mfma_f32_16x16x32_bf16 v[100:103], a[92:95], a[20:23], v[100:103]
v_mfma_f32_16x16x32_bf16 v[92:95], a[92:95], a[16:19], v[92:95]
v_mfma_f32_16x16x32_bf16 v[92:95], a[88:91], a[0:3], v[92:95]
s_add_u32 m0, s16, 0x8c00
s_waitcnt lgkmcnt(4)
v_mfma_f32_16x16x32_bf16 v[120:123], a[96:99], a[0:3], v[120:123]
buffer_load_dwordx4 v23, s[44:47], s21 offen lds
v_mfma_f32_16x16x32_bf16 v[120:123], a[100:103], a[16:19], v[120:123]
ds_read_b64_tr_b16 a[88:89], v15 offset:0
v_mfma_f32_16x16x32_bf16 v[128:131], a[100:103], a[20:23], v[128:131]
ds_read_b64_tr_b16 a[90:91], v15 offset:256
v_mfma_f32_16x16x32_bf16 v[128:131], a[96:99], a[4:7], v[128:131]
ds_read_b64_tr_b16 a[92:93], v15 offset:2048
v_mfma_f32_16x16x32_bf16 v[136:139], a[96:99], a[8:11], v[136:139]
ds_read_b64_tr_b16 a[94:95], v15 offset:2304
v_mfma_f32_16x16x32_bf16 v[136:139], a[100:103], a[24:27], v[136:139]
s_add_u32 s8, s28, 0x6c00
v_mfma_f32_16x16x32_bf16 v[144:147], a[100:103], a[28:31], v[144:147]
buffer_store_dwordx4 a[184:187], v16, s[88:91], s8 offen sc1
v_mfma_f32_16x16x32_bf16 v[144:147], a[96:99], a[12:15], v[144:147]
v_mfma_f32_16x16x32_bf16 v[148:151], a[104:107], a[12:15], v[148:151]
ds_read_b64_tr_b16 a[96:97], v14 offset:4096
v_mfma_f32_16x16x32_bf16 v[148:151], a[108:111], a[28:31], v[148:151]
ds_read_b64_tr_b16 a[98:99], v14 offset:4352
v_mfma_f32_16x16x32_bf16 v[140:143], a[108:111], a[24:27], v[140:143]
ds_read_b64_tr_b16 a[100:101], v14 offset:6144
v_mfma_f32_16x16x32_bf16 v[140:143], a[104:107], a[8:11], v[140:143]
ds_read_b64_tr_b16 a[102:103], v14 offset:6400
s_add_u32 m0, s16, 0x9000
v_mfma_f32_16x16x32_bf16 v[132:135], a[104:107], a[4:7], v[132:135]
buffer_load_dwordx4 v22, s[44:47], s22 offen lds
v_mfma_f32_16x16x32_bf16 v[132:135], a[108:111], a[20:23], v[132:135]
v_mfma_f32_16x16x32_bf16 v[124:127], a[108:111], a[16:19], v[124:127]
v_mfma_f32_16x16x32_bf16 v[124:127], a[104:107], a[0:3], v[124:127]
s_waitcnt lgkmcnt(4)
v_mfma_f32_16x16x32_bf16 v[152:155], a[80:83], a[0:3], v[152:155]
ds_read_b64_tr_b16 a[104:105], v15 offset:4096
s_add_u32 m0, s16, 0x9400
v_mfma_f32_16x16x32_bf16 v[152:155], a[84:87], a[16:19], v[152:155]
buffer_load_dwordx4 v23, s[44:47], s22 offen lds
v_mfma_f32_16x16x32_bf16 v[160:163], a[84:87], a[20:23], v[160:163]
ds_read_b64_tr_b16 a[106:107], v15 offset:4352
v_mfma_f32_16x16x32_bf16 v[160:163], a[80:83], a[4:7], v[160:163]
ds_read_b64_tr_b16 a[108:109], v15 offset:6144
v_mfma_f32_16x16x32_bf16 v[168:171], a[80:83], a[8:11], v[168:171]
ds_read_b64_tr_b16 a[110:111], v15 offset:6400
v_mfma_f32_16x16x32_bf16 v[168:171], a[84:87], a[24:27], v[168:171]
v_mfma_f32_16x16x32_bf16 v[176:179], a[84:87], a[28:31], v[176:179]
s_add_u32 m0, s16, 0x9800
v_mfma_f32_16x16x32_bf16 v[176:179], a[80:83], a[12:15], v[176:179]
buffer_load_dwordx4 v22, s[44:47], s23 offen lds
v_mfma_f32_16x16x32_bf16 v[180:183], a[88:91], a[12:15], v[180:183]
ds_read_b64_tr_b16 a[80:81], v14 offset:8192
v_mfma_f32_16x16x32_bf16 v[180:183], a[92:95], a[28:31], v[180:183]
ds_read_b64_tr_b16 a[82:83], v14 offset:8448
v_mfma_f32_16x16x32_bf16 v[172:175], a[92:95], a[24:27], v[172:175]
ds_read_b64_tr_b16 a[84:85], v14 offset:10240
v_mfma_f32_16x16x32_bf16 v[172:175], a[88:91], a[8:11], v[172:175]
ds_read_b64_tr_b16 a[86:87], v14 offset:10496
s_add_u32 m0, s16, 0x9c00
v_mfma_f32_16x16x32_bf16 v[164:167], a[88:91], a[4:7], v[164:167]
buffer_load_dwordx4 v23, s[44:47], s23 offen lds
v_mfma_f32_16x16x32_bf16 v[164:167], a[92:95], a[20:23], v[164:167]
v_lshl_add_u32 v22, s42, 7, v22
v_lshl_add_u32 v23, s42, 7, v23
v_mfma_f32_16x16x32_bf16 v[156:159], a[92:95], a[16:19], v[156:159]
v_mfma_f32_16x16x32_bf16 v[156:159], a[88:91], a[0:3], v[156:159]
s_waitcnt lgkmcnt(4)
v_mfma_f32_16x16x32_bf16 v[184:187], a[96:99], a[0:3], v[184:187]
ds_read_b64_tr_b16 a[88:89], v15 offset:8192
v_mfma_f32_16x16x32_bf16 v[184:187], a[100:103], a[16:19], v[184:187]
ds_read_b64_tr_b16 a[90:91], v15 offset:8448
s_add_u32 s8, s28, 0x7c00
v_mfma_f32_16x16x32_bf16 v[192:195], a[100:103], a[20:23], v[192:195]
buffer_store_dwordx4 a[188:191], v16, s[88:91], s8 offen sc1
v_mfma_f32_16x16x32_bf16 v[192:195], a[96:99], a[4:7], v[192:195]
ds_read_b64_tr_b16 a[92:93], v15 offset:10240
v_mfma_f32_16x16x32_bf16 v[200:203], a[96:99], a[8:11], v[200:203]
ds_read_b64_tr_b16 a[94:95], v15 offset:10496
v_add_u32 v12, 0x8000, v12
v_mfma_f32_16x16x32_bf16 v[200:203], a[100:103], a[24:27], v[200:203]
v_add_u32 v13, 0x8000, v13
v_add_u32 v14, 0x8000, v14
v_mfma_f32_16x16x32_bf16 v[208:211], a[100:103], a[28:31], v[208:211]
v_add_u32 v15, 0x8000, v15
v_mfma_f32_16x16x32_bf16 v[208:211], a[96:99], a[12:15], v[208:211]
v_mfma_f32_16x16x32_bf16 v[212:215], a[104:107], a[12:15], v[212:215]
s_waitcnt vmcnt(29) lgkmcnt(0)
v_mfma_f32_16x16x32_bf16 v[212:215], a[108:111], a[28:31], v[212:215]
s_barrier
s_add_u32 m0, s17, 0x0
v_mfma_f32_16x16x32_bf16 v[204:207], a[108:111], a[24:27], v[204:207]
buffer_load_dwordx4 v5, s[52:55], 0 offen lds
v_mfma_f32_16x16x32_bf16 v[204:207], a[104:107], a[8:11], v[204:207]
ds_read_b64_tr_b16 a[96:97], v12 offset:0
v_mfma_f32_16x16x32_bf16 v[196:199], a[104:107], a[4:7], v[196:199]
ds_read_b64_tr_b16 a[98:99], v12 offset:1024
v_mfma_f32_16x16x32_bf16 v[196:199], a[108:111], a[20:23], v[196:199]
ds_read_b64_tr_b16 a[100:101], v12 offset:8192
v_mfma_f32_16x16x32_bf16 v[188:191], a[108:111], a[16:19], v[188:191]
ds_read_b64_tr_b16 a[102:103], v12 offset:9216
v_mfma_f32_16x16x32_bf16 v[188:191], a[104:107], a[0:3], v[188:191]
s_add_u32 m0, s17, 0x400
s_waitcnt lgkmcnt(4)
v_mfma_f32_16x16x32_bf16 v[216:219], a[0:3], a[80:83], v[216:219]
buffer_load_dwordx4 v5, s[52:55], s13 offen lds
v_mfma_f32_16x16x32_bf16 v[216:219], a[16:19], a[84:87], v[216:219]
ds_read_b64_tr_b16 a[104:105], v13 offset:0
v_mfma_f32_16x16x32_bf16 v[224:227], a[20:23], a[84:87], v[224:227]
ds_read_b64_tr_b16 a[106:107], v13 offset:1024
v_mfma_f32_16x16x32_bf16 v[224:227], a[4:7], a[80:83], v[224:227]
ds_read_b64_tr_b16 a[108:109], v13 offset:8192
v_mfma_f32_16x16x32_bf16 v[232:235], a[8:11], a[80:83], v[232:235]
ds_read_b64_tr_b16 a[110:111], v13 offset:9216
v_mfma_f32_16x16x32_bf16 v[232:235], a[24:27], a[84:87], v[232:235]
v_mfma_f32_16x16x32_bf16 v[240:243], a[28:31], a[84:87], v[240:243]
s_add_u32 m0, s17, 0x800
v_mfma_f32_16x16x32_bf16 v[240:243], a[12:15], a[80:83], v[240:243]
buffer_load_dwordx4 v6, s[52:55], 0 offen lds
v_mfma_f32_16x16x32_bf16 v[244:247], a[12:15], a[88:91], v[244:247]
ds_read_b64_tr_b16 a[80:81], v12 offset:256
v_mfma_f32_16x16x32_bf16 v[244:247], a[28:31], a[92:95], v[244:247]
ds_read_b64_tr_b16 a[82:83], v12 offset:1280
v_mfma_f32_16x16x32_bf16 v[236:239], a[24:27], a[92:95], v[236:239]
ds_read_b64_tr_b16 a[84:85], v12 offset:8448
v_mfma_f32_16x16x32_bf16 v[236:239], a[8:11], a[88:91], v[236:239]
ds_read_b64_tr_b16 a[86:87], v12 offset:9472
v_mfma_f32_16x16x32_bf16 v[228:231], a[4:7], a[88:91], v[228:231]
v_mfma_f32_16x16x32_bf16 v[228:231], a[20:23], a[92:95], v[228:231]
s_add_u32 m0, s17, 0xc00
v_mfma_f32_16x16x32_bf16 v[220:223], a[16:19], a[92:95], v[220:223]
buffer_load_dwordx4 v6, s[52:55], s13 offen lds
v_mfma_f32_16x16x32_bf16 v[220:223], a[0:3], a[88:91], v[220:223]
s_waitcnt lgkmcnt(4)
L_S13:
v_mfma_f32_16x16x32_bf16 v[24:27], a[96:99], a[32:35], v[24:27]
ds_read_b64_tr_b16 a[88:89], v13 offset:256
s_waitcnt vmcnt(24)
v_mfma_f32_16x16x32_bf16 v[24:27], a[100:103], a[48:51], v[24:27]
ds_read_b64_tr_b16 a[90:91], v13 offset:1280
v_mfma_f32_16x16x32_bf16 v[32:35], a[100:103], a[52:55], v[32:35]
ds_read_b64_tr_b16 a[92:93], v13 offset:8448
v_mfma_f32_16x16x32_bf16 v[32:35], a[96:99], a[36:39], v[32:35]
ds_read_b64_tr_b16 a[94:95], v13 offset:9472
v_mfma_f32_16x16x32_bf16 v[40:43], a[96:99], a[40:43], v[40:43]
ds_read_b128 a[0:3], v8 offset:0
s_add_u32 m0, s18, 0x4000
v_mfma_f32_16x16x32_bf16 v[40:43], a[100:103], a[56:59], v[40:43]
buffer_load_dwordx4 v7, s[68:71], 0 offen lds
v_mfma_f32_16x16x32_bf16 v[48:51], a[100:103], a[60:63], v[48:51]
ds_read_b128 a[16:19], v9 offset:0
v_mfma_f32_16x16x32_bf16 v[48:51], a[96:99], a[44:47], v[48:51]
ds_read_b128 a[4:7], v8 offset:2048
v_mfma_f32_16x16x32_bf16 v[52:55], a[104:107], a[44:47], v[52:55]
ds_read_b64_tr_b16 a[96:97], v12 offset:512
v_mfma_f32_16x16x32_bf16 v[52:55], a[108:111], a[60:63], v[52:55]
ds_read_b64_tr_b16 a[98:99], v12 offset:1536
v_mfma_f32_16x16x32_bf16 v[44:47], a[108:111], a[56:59], v[44:47]
ds_read_b64_tr_b16 a[100:101], v12 offset:8704
s_add_u32 s8, s28, 0x4000
v_mfma_f32_16x16x32_bf16 v[44:47], a[104:107], a[40:43], v[44:47]
buffer_store_dwordx4 a[192:195], v16, s[88:91], s8 offen sc1
v_mfma_f32_16x16x32_bf16 v[36:39], a[104:107], a[36:39], v[36:39]
ds_read_b64_tr_b16 a[102:103], v12 offset:9728
v_mfma_f32_16x16x32_bf16 v[36:39], a[108:111], a[52:55], v[36:39]
ds_read_b128 a[20:23], v9 offset:2048
v_mfma_f32_16x16x32_bf16 v[28:31], a[108:111], a[48:51], v[28:31]
ds_read_b128 a[8:11], v8 offset:4096
v_mfma_f32_16x16x32_bf16 v[28:31], a[104:107], a[32:35], v[28:31]
ds_read_b128 a[24:27], v9 offset:4096
s_waitcnt lgkmcnt(10)
v_mfma_f32_16x16x32_bf16 v[56:59], a[80:83], a[32:35], v[56:59]
ds_read_b64_tr_b16 a[104:105], v13 offset:512
v_mfma_f32_16x16x32_bf16 v[56:59], a[84:87], a[48:51], v[56:59]
ds_read_b64_tr_b16 a[106:107], v13 offset:1536
s_add_u32 m0, s18, 0x5000
v_mfma_f32_16x16x32_bf16 v[64:67], a[84:87], a[52:55], v[64:67]
buffer_load_dwordx4 v7, s[68:71], s25 offen lds
v_mfma_f32_16x16x32_bf16 v[64:67], a[80:83], a[36:39], v[64:67]
ds_read_b64_tr_b16 a[108:109], v13 offset:8704
v_mfma_f32_16x16x32_bf16 v[72:75], a[80:83], a[40:43], v[72:75]
ds_read_b64_tr_b16 a[110:111], v13 offset:9728
v_mfma_f32_16x16x32_bf16 v[72:75], a[84:87], a[56:59], v[72:75]
ds_read_b128 a[12:15], v8 offset:6144
v_mfma_f32_16x16x32_bf16 v[80:83], a[84:87], a[60:63], v[80:83]
ds_read_b128 a[28:31], v9 offset:6144
v_mfma_f32_16x16x32_bf16 v[80:83], a[80:83], a[44:47], v[80:83]
v_mfma_f32_16x16x32_bf16 v[84:87], a[88:91], a[44:47], v[84:87]
ds_read_b64_tr_b16 a[80:81], v12 offset:768
s_add_u32 m0, s18, 0x6000
v_mfma_f32_16x16x32_bf16 v[84:87], a[92:95], a[60:63], v[84:87]
buffer_load_dwordx4 v7, s[68:71], s26 offen lds
v_mfma_f32_16x16x32_bf16 v[76:79], a[92:95], a[56:59], v[76:79]
ds_read_b64_tr_b16 a[82:83], v12 offset:1792
v_lshl_add_u32 v5, s42, 19, v5
v_mfma_f32_16x16x32_bf16 v[76:79], a[88:91], a[40:43], v[76:79]
ds_read_b64_tr_b16 a[84:85], v12 offset:8960
v_lshl_add_u32 v6, s42, 19, v6
v_mfma_f32_16x16x32_bf16 v[68:71], a[88:91], a[36:39], v[68:71]
ds_read_b64_tr_b16 a[86:87], v12 offset:9984
v_lshl_add_u32 v7, s42, 18, v7
v_mfma_f32_16x16x32_bf16 v[68:71], a[92:95], a[52:55], v[68:71]
v_lshl_add_u32 v7, s42, 17, v7
v_mfma_f32_16x16x32_bf16 v[60:63], a[92:95], a[48:51], v[60:63]
v_mfma_f32_16x16x32_bf16 v[60:63], a[88:91], a[32:35], v[60:63]
s_add_u32 m0, s16, 0x0
s_waitcnt lgkmcnt(4)
s_waitcnt lgkmcnt(6)
v_mfma_f32_16x16x32_bf16 v[88:91], a[96:99], a[32:35], v[88:91]
buffer_load_dwordx4 v22, s[44:47], s20 offen lds
v_mfma_f32_16x16x32_bf16 v[88:91], a[100:103], a[48:51], v[88:91]
ds_read_b64_tr_b16 a[88:89], v13 offset:768
v_mfma_f32_16x16x32_bf16 v[96:99], a[100:103], a[52:55], v[96:99]
ds_read_b64_tr_b16 a[90:91], v13 offset:1792
v_mfma_f32_16x16x32_bf16 v[96:99], a[96:99], a[36:39], v[96:99]
ds_read_b64_tr_b16 a[92:93], v13 offset:8960
v_mfma_f32_16x16x32_bf16 v[104:107], a[96:99], a[40:43], v[104:107]
ds_read_b64_tr_b16 a[94:95], v13 offset:9984
s_add_u32 m0, s16, 0x400
v_mfma_f32_16x16x32_bf16 v[104:107], a[100:103], a[56:59], v[104:107]
buffer_load_dwordx4 v23, s[44:47], s20 offen lds
v_mfma_f32_16x16x32_bf16 v[112:115], a[100:103], a[60:63], v[112:115]
v_mfma_f32_16x16x32_bf16 v[112:115], a[96:99], a[44:47], v[112:115]
v_mfma_f32_16x16x32_bf16 v[116:119], a[104:107], a[44:47], v[116:119]
ds_read_b64_tr_b16 a[96:97], v14 offset:0
v_mfma_f32_16x16x32_bf16 v[116:119], a[108:111], a[60:63], v[116:119]
ds_read_b64_tr_b16 a[98:99], v14 offset:256
v_mfma_f32_16x16x32_bf16 v[108:111], a[108:111], a[56:59], v[108:111]
ds_read_b64_tr_b16 a[100:101], v14 offset:2048
s_add_u32 m0, s16, 0x800
v_mfma_f32_16x16x32_bf16 v[108:111], a[104:107], a[40:43], v[108:111]
buffer_load_dwordx4 v22, s[44:47], s21 offen lds
v_mfma_f32_16x16x32_bf16 v[100:103], a[104:107], a[36:39], v[100:103]
ds_read_b64_tr_b16 a[102:103], v14 offset:2304
v_mfma_f32_16x16x32_bf16 v[100:103], a[108:111], a[52:55], v[100:103]
v_mfma_f32_16x16x32_bf16 v[92:95], a[108:111], a[48:51], v[92:95]
v_mfma_f32_16x16x32_bf16 v[92:95], a[104:107], a[32:35], v[92:95]
s_add_u32 s8, s28, 0x8000
s_waitcnt lgkmcnt(4)
v_mfma_f32_16x16x32_bf16 v[120:123], a[80:83], a[32:35], v[120:123]
buffer_store_dwordx4 a[196:199], v16, s[88:91], s8 offen sc1
v_mfma_f32_16x16x32_bf16 v[120:123], a[84:87], a[48:51], v[120:123]
ds_read_b64_tr_b16 a[104:105], v15 offset:0
v_mfma_f32_16x16x32_bf16 v[128:131], a[84:87], a[52:55], v[128:131]
ds_read_b64_tr_b16 a[106:107], v15 offset:256
v_mfma_f32_16x16x32_bf16 v[128:131], a[80:83], a[36:39], v[128:131]
ds_read_b64_tr_b16 a[108:109], v15 offset:2048
v_mfma_f32_16x16x32_bf16 v[136:139], a[80:83], a[40:43], v[136:139]
ds_read_b64_tr_b16 a[110:111], v15 offset:2304
v_mfma_f32_16x16x32_bf16 v[136:139], a[84:87], a[56:59], v[136:139]
s_add_u32 m0, s16, 0xc00
v_mfma_f32_16x16x32_bf16 v[144:147], a[84:87], a[60:63], v[144:147]
buffer_load_dwordx4 v23, s[44:47], s21 offen lds
v_mfma_f32_16x16x32_bf16 v[144:147], a[80:83], a[44:47], v[144:147]
v_mfma_f32_16x16x32_bf16 v[148:151], a[88:91], a[44:47], v[148:151]
ds_read_b64_tr_b16 a[80:81], v14 offset:4096
v_mfma_f32_16x16x32_bf16 v[148:151], a[92:95], a[60:63], v[148:151]
ds_read_b64_tr_b16 a[82:83], v14 offset:4352
L_padA7:
s_cmp_eq_u32 s95, 1
s_cbranch_scc1 L_padA11
v_mfma_f32_16x16x32_bf16 v[140:143], a[92:95], a[56:59], v[140:143]
ds_read_b64_tr_b16 a[84:85], v14 offset:6144
v_mfma_f32_16x16x32_bf16 v[140:143], a[88:91], a[40:43], v[140:143]
ds_read_b64_tr_b16 a[86:87], v14 offset:6400
s_add_u32 m0, s16, 0x1000
v_mfma_f32_16x16x32_bf16 v[132:135], a[88:91], a[36:39], v[132:135]
buffer_load_dwordx4 v22, s[44:47], s22 offen lds
v_mfma_f32_16x16x32_bf16 v[132:135], a[92:95], a[52:55], v[132:135]
v_mfma_f32_16x16x32_bf16 v[124:127], a[92:95], a[48:51], v[124:127]
v_mfma_f32_16x16x32_bf16 v[124:127], a[88:91], a[32:35], v[124:127]
s_waitcnt lgkmcnt(4)
v_mfma_f32_16x16x32_bf16 v[152:155], a[96:99], a[32:35], v[152:155]
ds_read_b64_tr_b16 a[88:89], v15 offset:4096
s_add_u32 m0, s16, 0x1400
v_mfma_f32_16x16x32_bf16 v[152:155], a[100:103], a[48:51], v[152:155]
buffer_load_dwordx4 v23, s[44:47], s22 offen lds
v_mfma_f32_16x16x32_bf16 v[160:163], a[100:103], a[52:55], v[160:163]
ds_read_b64_tr_b16 a[90:91], v15 offset:4352
v_mfma_f32_16x16x32_bf16 v[160:163], a[96:99], a[36:39], v[160:163]
ds_read_b64_tr_b16 a[92:93], v15 offset:6144
v_mfma_f32_16x16x32_bf16 v[168:171], a[96:99], a[40:43], v[168:171]
ds_read_b64_tr_b16 a[94:95], v15 offset:6400
v_mfma_f32_16x16x32_bf16 v[168:171], a[100:103], a[56:59], v[168:171]
v_mfma_f32_16x16x32_bf16 v[176:179], a[100:103], a[60:63], v[176:179]
s_add_u32 m0, s16, 0x1800
v_mfma_f32_16x16x32_bf16 v[176:179], a[96:99], a[44:47], v[176:179]
buffer_load_dwordx4 v22, s[44:47], s23 offen lds
v_mfma_f32_16x16x32_bf16 v[180:183], a[104:107], a[44:47], v[180:183]
ds_read_b64_tr_b16 a[96:97], v14 offset:8192
v_mfma_f32_16x16x32_bf16 v[180:183], a[108:111], a[60:63], v[180:183]
ds_read_b64_tr_b16 a[98:99], v14 offset:8448
v_mfma_f32_16x16x32_bf16 v[172:175], a[108:111], a[56:59], v[172:175]
ds_read_b64_tr_b16 a[100:101], v14 offset:10240
v_mfma_f32_16x16x32_bf16 v[172:175], a[104:107], a[40:43], v[172:175]
ds_read_b64_tr_b16 a[102:103], v14 offset:10496
s_add_u32 m0, s16, 0x1c00
v_mfma_f32_16x16x32_bf16 v[164:167], a[104:107], a[36:39], v[164:167]
buffer_load_dwordx4 v23, s[44:47], s23 offen lds
v_mfma_f32_16x16x32_bf16 v[164:167], a[108:111], a[52:55], v[164:167]
v_lshl_add_u32 v22, s42, 7, v22
v_lshl_add_u32 v23, s42, 7, v23
v_mfma_f32_16x16x32_bf16 v[156:159], a[108:111], a[48:51], v[156:159]
v_mfma_f32_16x16x32_bf16 v[156:159], a[104:107], a[32:35], v[156:159]
s_waitcnt lgkmcnt(4)
v_mfma_f32_16x16x32_bf16 v[184:187], a[80:83], a[32:35], v[184:187]
ds_read_b64_tr_b16 a[104:105], v15 offset:8192
v_mfma_f32_16x16x32_bf16 v[184:187], a[84:87], a[48:51], v[184:187]
ds_read_b64_tr_b16 a[106:107], v15 offset:8448
s_add_u32 s8, s28, 0x4400
v_mfma_f32_16x16x32_bf16 v[192:195], a[84:87], a[52:55], v[192:195]
buffer_store_dwordx4 a[200:203], v16, s[88:91], s8 offen sc1
v_mfma_f32_16x16x32_bf16 v[192:195], a[80:83], a[36:39], v[192:195]
ds_read_b64_tr_b16 a[108:109], v15 offset:10240
v_mfma_f32_16x16x32_bf16 v[200:203], a[80:83], a[40:43], v[200:203]
ds_read_b64_tr_b16 a[110:111], v15 offset:10496
v_add_u32 v12, 0x8000, v12
v_mfma_f32_16x16x32_bf16 v[200:203], a[84:87], a[56:59], v[200:203]
v_add_u32 v13, 0x8000, v13
v_add_u32 v14, 0x8000, v14
v_mfma_f32_16x16x32_bf16 v[208:211], a[84:87], a[60:63], v[208:211]
v_add_u32 v15, 0x8000, v15
v_mfma_f32_16x16x32_bf16 v[208:211], a[80:83], a[44:47], v[208:211]
v_mfma_f32_16x16x32_bf16 v[212:215], a[88:91], a[44:47], v[212:215]
s_waitcnt vmcnt(29) lgkmcnt(0)
v_mfma_f32_16x16x32_bf16 v[212:215], a[92:95], a[60:63], v[212:215]
s_barrier
s_add_u32 m0, s17, 0x8000
v_mfma_f32_16x16x32_bf16 v[204:207], a[92:95], a[56:59], v[204:207]
buffer_load_dwordx4 v5, s[52:55], 0 offen lds
v_mfma_f32_16x16x32_bf16 v[204:207], a[88:91], a[40:43], v[204:207]
ds_read_b64_tr_b16 a[80:81], v12 offset:0
v_mfma_f32_16x16x32_bf16 v[196:199], a[88:91], a[36:39], v[196:199]
ds_read_b64_tr_b16 a[82:83], v12 offset:1024
v_mfma_f32_16x16x32_bf16 v[196:199], a[92:95], a[52:55], v[196:199]
ds_read_b64_tr_b16 a[84:85], v12 offset:8192
v_mfma_f32_16x16x32_bf16 v[188:191], a[92:95], a[48:51], v[188:191]
ds_read_b64_tr_b16 a[86:87], v12 offset:9216
v_mfma_f32_16x16x32_bf16 v[188:191], a[88:91], a[32:35], v[188:191]
s_add_u32 m0, s17, 0x8400
s_waitcnt lgkmcnt(4)
v_mfma_f32_16x16x32_bf16 v[216:219], a[32:35], a[96:99], v[216:219]
buffer_load_dwordx4 v5, s[52:55], s13 offen lds
v_mfma_f32_16x16x32_bf16 v[216:219], a[48:51], a[100:103], v[216:219]
ds_read_b64_tr_b16 a[88:89], v13 offset:0
v_mfma_f32_16x16x32_bf16 v[224:227], a[52:55], a[100:103], v[224:227]
ds_read_b64_tr_b16 a[90:91], v13 offset:1024
v_mfma_f32_16x16x32_bf16 v[224:227], a[36:39], a[96:99], v[224:227]
ds_read_b64_tr_b16 a[92:93], v13 offset:8192
v_mfma_f32_16x16x32_bf16 v[232:235], a[40:43], a[96:99], v[232:235]
ds_read_b64_tr_b16 a[94:95], v13 offset:9216
v_mfma_f32_16x16x32_bf16 v[232:235], a[56:59], a[100:103], v[232:235]
v_mfma_f32_16x16x32_bf16 v[240:243], a[60:63], a[100:103], v[240:243]
s_add_u32 m0, s17, 0x8800
v_mfma_f32_16x16x32_bf16 v[240:243], a[44:47], a[96:99], v[240:243]
buffer_load_dwordx4 v6, s[52:55], 0 offen lds
v_mfma_f32_16x16x32_bf16 v[244:247], a[44:47], a[104:107], v[244:247]
ds_read_b64_tr_b16 a[96:97], v12 offset:256
v_mfma_f32_16x16x32_bf16 v[244:247], a[60:63], a[108:111], v[244:247]
ds_read_b64_tr_b16 a[98:99], v12 offset:1280
v_mfma_f32_16x16x32_bf16 v[236:239], a[56:59], a[108:111], v[236:239]
ds_read_b64_tr_b16 a[100:101], v12 offset:8448
v_mfma_f32_16x16x32_bf16 v[236:239], a[40:43], a[104:107], v[236:239]
ds_read_b64_tr_b16 a[102:103], v12 offset:9472
v_mfma_f32_16x16x32_bf16 v[228:231], a[36:39], a[104:107], v[228:231]
v_mfma_f32_16x16x32_bf16 v[228:231], a[52:55], a[108:111], v[228:231]
s_add_u32 m0, s17, 0x8c00
v_mfma_f32_16x16x32_bf16 v[220:223], a[48:51], a[108:111], v[220:223]
buffer_load_dwordx4 v6, s[52:55], s13 offen lds
v_mfma_f32_16x16x32_bf16 v[220:223], a[32:35], a[104:107], v[220:223]
s_waitcnt lgkmcnt(4)
L_S14:
v_mfma_f32_16x16x32_bf16 v[24:27], a[80:83], a[0:3], v[24:27]
ds_read_b64_tr_b16 a[104:105], v13 offset:256
s_waitcnt vmcnt(23)
v_mfma_f32_16x16x32_bf16 v[24:27], a[84:87], a[16:19], v[24:27]
ds_read_b64_tr_b16 a[106:107], v13 offset:1280
v_mfma_f32_16x16x32_bf16 v[32:35], a[84:87], a[20:23], v[32:35]
ds_read_b64_tr_b16 a[108:109], v13 offset:8448
v_mfma_f32_16x16x32_bf16 v[32:35], a[80:83], a[4:7], v[32:35]
ds_read_b64_tr_b16 a[110:111], v13 offset:9472
v_mfma_f32_16x16x32_bf16 v[40:43], a[80:83], a[8:11], v[40:43]
ds_read_b128 a[32:35], v8 offset:32768
s_add_u32 m0, s18, 0xc000
v_mfma_f32_16x16x32_bf16 v[40:43], a[84:87], a[24:27], v[40:43]
buffer_load_dwordx4 v7, s[68:71], 0 offen lds
v_mfma_f32_16x16x32_bf16 v[48:51], a[84:87], a[28:31], v[48:51]
ds_read_b128 a[48:51], v9 offset:32768
v_mfma_f32_16x16x32_bf16 v[48:51], a[80:83], a[12:15], v[48:51]
ds_read_b128 a[36:39], v8 offset:34816
v_mfma_f32_16x16x32_bf16 v[52:55], a[88:91], a[12:15], v[52:55]
ds_read_b64_tr_b16 a[80:81], v12 offset:512
v_mfma_f32_16x16x32_bf16 v[52:55], a[92:95], a[28:31], v[52:55]
ds_read_b64_tr_b16 a[82:83], v12 offset:1536
v_mfma_f32_16x16x32_bf16 v[44:47], a[92:95], a[24:27], v[44:47]
ds_read_b64_tr_b16 a[84:85], v12 offset:8704
s_add_u32 s8, s28, 0x8400
v_mfma_f32_16x16x32_bf16 v[44:47], a[88:91], a[8:11], v[44:47]
buffer_store_dwordx4 a[204:207], v16, s[88:91], s8 offen sc1
v_mfma_f32_16x16x32_bf16 v[36:39], a[88:91], a[4:7], v[36:39]
ds_read_b64_tr_b16 a[86:87], v12 offset:9728
v_mfma_f32_16x16x32_bf16 v[36:39], a[92:95], a[20:23], v[36:39]
ds_read_b128 a[52:55], v9 offset:34816
v_mfma_f32_16x16x32_bf16 v[28:31], a[92:95], a[16:19], v[28:31]
ds_read_b128 a[40:43], v8 offset:36864
v_mfma_f32_16x16x32_bf16 v[28:31], a[88:91], a[0:3], v[28:31]
ds_read_b128 a[56:59], v9 offset:36864
s_waitcnt lgkmcnt(10)
v_mfma_f32_16x16x32_bf16 v[56:59], a[96:99], a[0:3], v[56:59]
ds_read_b64_tr_b16 a[88:89], v13 offset:512
v_mfma_f32_16x16x32_bf16 v[56:59], a[100:103], a[16:19], v[56:59]
ds_read_b64_tr_b16 a[90:91], v13 offset:1536
s_add_u32 m0, s18, 0xd000
v_mfma_f32_16x16x32_bf16 v[64:67], a[100:103], a[20:23], v[64:67]
buffer_load_dwordx4 v7, s[68:71], s25 offen lds
v_mfma_f32_16x16x32_bf16 v[64:67], a[96:99], a[4:7], v[64:67]
ds_read_b64_tr_b16 a[92:93], v13 offset:8704
v_mfma_f32_16x16x32_bf16 v[72:75], a[96:99], a[8:11], v[72:75]
ds_read_b64_tr_b16 a[94:95], v13 offset:9728
v_mfma_f32_16x16x32_bf16 v[72:75], a[100:103], a[24:27], v[72:75]
ds_read_b128 a[44:47], v8 offset:38912
v_mfma_f32_16x16x32_bf16 v[80:83], a[100:103], a[28:31], v[80:83]
ds_read_b128 a[60:63], v9 offset:38912
v_mfma_f32_16x16x32_bf16 v[80:83], a[96:99], a[12:15], v[80:83]
v_mfma_f32_16x16x32_bf16 v[84:87], a[104:107], a[12:15], v[84:87]
ds_read_b64_tr_b16 a[96:97], v12 offset:768
s_add_u32 m0, s18, 0xe000
v_mfma_f32_16x16x32_bf16 v[84:87], a[108:111], a[28:31], v[84:87]
buffer_load_dwordx4 v7, s[68:71], s26 offen lds
v_mfma_f32_16x16x32_bf16 v[76:79], a[108:111], a[24:27], v[76:79]
ds_read_b64_tr_b16 a[98:99], v12 offset:1792
v_lshl_add_u32 v5, s42, 19, v5
v_mfma_f32_16x16x32_bf16 v[76:79], a[104:107], a[8:11], v[76:79]
ds_read_b64_tr_b16 a[100:101], v12 offset:8960
v_lshl_add_u32 v6, s42, 19, v6
v_mfma_f32_16x16x32_bf16 v[68:71], a[104:107], a[4:7], v[68:71]
ds_read_b64_tr_b16 a[102:103], v12 offset:9984
v_lshl_add_u32 v7, s42, 18, v7
v_mfma_f32_16x16x32_bf16 v[68:71], a[108:111], a[20:23], v[68:71]
v_lshl_add_u32 v7, s42, 17, v7
v_mfma_f32_16x16x32_bf16 v[60:63], a[108:111], a[16:19], v[60:63]
v_mfma_f32_16x16x32_bf16 v[60:63], a[104:107], a[0:3], v[60:63]
s_add_u32 m0, s16, 0x8000
s_waitcnt lgkmcnt(4)
s_waitcnt lgkmcnt(6)
v_mfma_f32_16x16x32_bf16 v[88:91], a[80:83], a[0:3], v[88:91]
buffer_load_dwordx4 v22, s[44:47], s20 offen lds
v_mfma_f32_16x16x32_bf16 v[88:91], a[84:87], a[16:19], v[88:91]
ds_read_b64_tr_b16 a[104:105], v13 offset:768
v_mfma_f32_16x16x32_bf16 v[96:99], a[84:87], a[20:23], v[96:99]
ds_read_b64_tr_b16 a[106:107], v13 offset:1792
v_mfma_f32_16x16x32_bf16 v[96:99], a[80:83], a[4:7], v[96:99]
ds_read_b64_tr_b16 a[108:109], v13 offset:8960
v_mfma_f32_16x16x32_bf16 v[104:107], a[80:83], a[8:11], v[104:107]
ds_read_b64_tr_b16 a[110:111], v13 offset:9984
s_add_u32 m0, s16, 0x8400
v_mfma_f32_16x16x32_bf16 v[104:107], a[84:87], a[24:27], v[104:107]
buffer_load_dwordx4 v23, s[44:47], s20 offen lds
v_mfma_f32_16x16x32_bf16 v[112:115], a[84:87], a[28:31], v[112:115]
v_mfma_f32_16x16x32_bf16 v[112:115], a[80:83], a[12:15], v[112:115]
v_mfma_f32_16x16x32_bf16 v[116:119], a[88:91], a[12:15], v[116:119]
ds_read_b64_tr_b16 a[80:81], v14 offset:0
v_mfma_f32_16x16x32_bf16 v[116:119], a[92:95], a[28:31], v[116:119]
ds_read_b64_tr_b16 a[82:83], v14 offset:256
v_mfma_f32_16x16x32_bf16 v[108:111], a[92:95], a[24:27], v[108:111]
ds_read_b64_tr_b16 a[84:85], v14 offset:2048
s_add_u32 m0, s16, 0x8800
v_mfma_f32_16x16x32_bf16 v[108:111], a[88:91], a[8:11], v[108:111]
buffer_load_dwordx4 v22, s[44:47], s21 offen lds
v_mfma_f32_16x16x32_bf16 v[100:103], a[88:91], a[4:7], v[100:103]
ds_read_b64_tr_b16 a[86:87], v14 offset:2304
v_mfma_f32_16x16x32_bf16 v[100:103], a[92:95], a[20:23], v[100:103]
v_mfma_f32_16x16x32_bf16 v[92:95], a[92:95], a[16:19], v[92:95]
v_mfma_f32_16x16x32_bf16 v[92:95], a[88:91], a[0:3], v[92:95]
s_add_u32 s8, s28, 0x4800
s_waitcnt lgkmcnt(4)
v_mfma_f32_16x16x32_bf16 v[120:123], a[96:99], a[0:3], v[120:123]
buffer_store_dwordx4 a[208:211], v16, s[88:91], s8 offen sc1
v_mfma_f32_16x16x32_bf16 v[120:123], a[100:103], a[16:19], v[120:123]
ds_read_b64_tr_b16 a[88:89], v15 offset:0
v_mfma_f32_16x16x32_bf16 v[128:131], a[100:103], a[20:23], v[128:131]
ds_read_b64_tr_b16 a[90:91], v15 offset:256
v_mfma_f32_16x16x32_bf16 v[128:131], a[96:99], a[4:7], v[128:131]
ds_read_b64_tr_b16 a[92:93], v15 offset:2048
v_mfma_f32_16x16x32_bf16 v[136:139], a[96:99], a[8:11], v[136:139]
ds_read_b64_tr_b16 a[94:95], v15 offset:2304
v_mfma_f32_16x16x32_bf16 v[136:139], a[100:103], a[24:27], v[136:139]
s_add_u32 m0, s16, 0x8c00
v_mfma_f32_16x16x32_bf16 v[144:147], a[100:103], a[28:31], v[144:147]
buffer_load_dwordx4 v23, s[44:47], s21 offen lds
v_mfma_f32_16x16x32_bf16 v[144:147], a[96:99], a[12:15], v[144:147]
v_mfma_f32_16x16x32_bf16 v[148:151], a[104:107], a[12:15], v[148:151]
ds_read_b64_tr_b16 a[96:97], v14 offset:4096
v_mfma_f32_16x16x32_bf16 v[148:151], a[108:111], a[28:31], v[148:151]
ds_read_b64_tr_b16 a[98:99], v14 offset:4352
v_mfma_f32_16x16x32_bf16 v[140:143], a[108:111], a[24:27], v[140:143]
ds_read_b64_tr_b16 a[100:101], v14 offset:6144
v_mfma_f32_16x16x32_bf16 v[140:143], a[104:107], a[8:11], v[140:143]
ds_read_b64_tr_b16 a[102:103], v14 offset:6400
s_add_u32 m0, s16, 0x9000
v_mfma_f32_16x16x32_bf16 v[132:135], a[104:107], a[4:7], v[132:135]
buffer_load_dwordx4 v22, s[44:47], s22 offen lds
v_mfma_f32_16x16x32_bf16 v[132:135], a[108:111], a[20:23], v[132:135]
v_mfma_f32_16x16x32_bf16 v[124:127], a[108:111], a[16:19], v[124:127]
v_mfma_f32_16x16x32_bf16 v[124:127], a[104:107], a[0:3], v[124:127]
s_waitcnt lgkmcnt(4)
v_mfma_f32_16x16x32_bf16 v[152:155], a[80:83], a[0:3], v[152:155]
ds_read_b64_tr_b16 a[104:105], v15 offset:4096
s_add_u32 m0, s16, 0x9400
v_mfma_f32_16x16x32_bf16 v[152:155], a[84:87], a[16:19], v[152:155]
buffer_load_dwordx4 v23, s[44:47], s22 offen lds
v_mfma_f32_16x16x32_bf16 v[160:163], a[84:87], a[20:23], v[160:163]
ds_read_b64_tr_b16 a[106:107], v15 offset:4352
v_mfma_f32_16x16x32_bf16 v[160:163], a[80:83], a[4:7], v[160:163]
ds_read_b64_tr_b16 a[108:109], v15 offset:6144
v_mfma_f32_16x16x32_bf16 v[168:171], a[80:83], a[8:11], v[168:171]
ds_read_b64_tr_b16 a[110:111], v15 offset:6400
v_mfma_f32_16x16x32_bf16 v[168:171], a[84:87], a[24:27], v[168:171]
v_mfma_f32_16x16x32_bf16 v[176:179], a[84:87], a[28:31], v[176:179]
s_add_u32 m0, s16, 0x9800
v_mfma_f32_16x16x32_bf16 v[176:179], a[80:83], a[12:15], v[176:179]
buffer_load_dwordx4 v22, s[44:47], s23 offen lds
v_mfma_f32_16x16x32_bf16 v[180:183], a[88:91], a[12:15], v[180:183]
ds_read_b64_tr_b16 a[80:81], v14 offset:8192
v_mfma_f32_16x16x32_bf16 v[180:183], a[92:95], a[28:31], v[180:183]
ds_read_b64_tr_b16 a[82:83], v14 offset:8448
v_mfma_f32_16x16x32_bf16 v[172:175], a[92:95], a[24:27], v[172:175]
ds_read_b64_tr_b16 a[84:85], v14 offset:10240
v_mfma_f32_16x16x32_bf16 v[172:175], a[88:91], a[8:11], v[172:175]
ds_read_b64_tr_b16 a[86:87], v14 offset:10496
s_add_u32 m0, s16, 0x9c00
v_mfma_f32_16x16x32_bf16 v[164:167], a[88:91], a[4:7], v[164:167]
buffer_load_dwordx4 v23, s[44:47], s23 offen lds
v_mfma_f32_16x16x32_bf16 v[164:167], a[92:95], a[20:23], v[164:167]
v_lshl_add_u32 v22, s42, 7, v22
v_lshl_add_u32 v23, s42, 7, v23
v_mfma_f32_16x16x32_bf16 v[156:159], a[92:95], a[16:19], v[156:159]
v_mfma_f32_16x16x32_bf16 v[156:159], a[88:91], a[0:3], v[156:159]
s_waitcnt lgkmcnt(4)
v_mfma_f32_16x16x32_bf16 v[184:187], a[96:99], a[0:3], v[184:187]
ds_read_b64_tr_b16 a[88:89], v15 offset:8192
v_mfma_f32_16x16x32_bf16 v[184:187], a[100:103], a[16:19], v[184:187]
ds_read_b64_tr_b16 a[90:91], v15 offset:8448
s_add_u32 s8, s28, 0x8800
v_mfma_f32_16x16x32_bf16 v[192:195], a[100:103], a[20:23], v[192:195]
buffer_store_dwordx4 a[212:215], v16, s[88:91], s8 offen sc1
v_mfma_f32_16x16x32_bf16 v[192:195], a[96:99], a[4:7], v[192:195]
ds_read_b64_tr_b16 a[92:93], v15 offset:10240
v_mfma_f32_16x16x32_bf16 v[200:203], a[96:99], a[8:11], v[200:203]
ds_read_b64_tr_b16 a[94:95], v15 offset:10496
v_add_u32 v12, 0xffff0000, v12
v_mfma_f32_16x16x32_bf16 v[200:203], a[100:103], a[24:27], v[200:203]
v_add_u32 v13, 0xffff0000, v13
v_add_u32 v14, 0xffff0000, v14
v_mfma_f32_16x16x32_bf16 v[208:211], a[100:103], a[28:31], v[208:211]
v_add_u32 v15, 0xffff0000, v15
v_mfma_f32_16x16x32_bf16 v[208:211], a[96:99], a[12:15], v[208:211]
v_mfma_f32_16x16x32_bf16 v[212:215], a[104:107], a[12:15], v[212:215]
s_waitcnt vmcnt(28) lgkmcnt(0)
v_mfma_f32_16x16x32_bf16 v[212:215], a[108:111], a[28:31], v[212:215]
s_barrier
s_add_u32 m0, s17, 0x10000
v_mfma_f32_16x16x32_bf16 v[204:207], a[108:111], a[24:27], v[204:207]
buffer_load_dwordx4 v5, s[52:55], 0 offen lds
v_mfma_f32_16x16x32_bf16 v[204:207], a[104:107], a[8:11], v[204:207]
ds_read_b64_tr_b16 a[96:97], v12 offset:0
v_mfma_f32_16x16x32_bf16 v[196:199], a[104:107], a[4:7], v[196:199]
ds_read_b64_tr_b16 a[98:99], v12 offset:1024
v_mfma_f32_16x16x32_bf16 v[196:199], a[108:111], a[20:23], v[196:199]
ds_read_b64_tr_b16 a[100:101], v12 offset:8192
v_mfma_f32_16x16x32_bf16 v[188:191], a[108:111], a[16:19], v[188:191]
ds_read_b64_tr_b16 a[102:103], v12 offset:9216
v_mfma_f32_16x16x32_bf16 v[188:191], a[104:107], a[0:3], v[188:191]
s_add_u32 m0, s17, 0x10400
s_waitcnt lgkmcnt(4)
v_mfma_f32_16x16x32_bf16 v[216:219], a[0:3], a[80:83], v[216:219]
buffer_load_dwordx4 v5, s[52:55], s13 offen lds
v_mfma_f32_16x16x32_bf16 v[216:219], a[16:19], a[84:87], v[216:219]
ds_read_b64_tr_b16 a[104:105], v13 offset:0
v_mfma_f32_16x16x32_bf16 v[224:227], a[20:23], a[84:87], v[224:227]
ds_read_b64_tr_b16 a[106:107], v13 offset:1024
v_mfma_f32_16x16x32_bf16 v[224:227], a[4:7], a[80:83], v[224:227]
ds_read_b64_tr_b16 a[108:109], v13 offset:8192
v_mfma_f32_16x16x32_bf16 v[232:235], a[8:11], a[80:83], v[232:235]
ds_read_b64_tr_b16 a[110:111], v13 offset:9216
v_mfma_f32_16x16x32_bf16 v[232:235], a[24:27], a[84:87], v[232:235]
v_mfma_f32_16x16x32_bf16 v[240:243], a[28:31], a[84:87], v[240:243]
s_add_u32 m0, s17, 0x10800
v_mfma_f32_16x16x32_bf16 v[240:243], a[12:15], a[80:83], v[240:243]
buffer_load_dwordx4 v6, s[52:55], 0 offen lds
v_mfma_f32_16x16x32_bf16 v[244:247], a[12:15], a[88:91], v[244:247]
ds_read_b64_tr_b16 a[80:81], v12 offset:256
v_mfma_f32_16x16x32_bf16 v[244:247], a[28:31], a[92:95], v[244:247]
ds_read_b64_tr_b16 a[82:83], v12 offset:1280
v_mfma_f32_16x16x32_bf16 v[236:239], a[24:27], a[92:95], v[236:239]
ds_read_b64_tr_b16 a[84:85], v12 offset:8448
v_mfma_f32_16x16x32_bf16 v[236:239], a[8:11], a[88:91], v[236:239]
ds_read_b64_tr_b16 a[86:87], v12 offset:9472
v_mfma_f32_16x16x32_bf16 v[228:231], a[4:7], a[88:91], v[228:231]
v_mfma_f32_16x16x32_bf16 v[228:231], a[20:23], a[92:95], v[228:231]
s_add_u32 m0, s17, 0x10c00
v_mfma_f32_16x16x32_bf16 v[220:223], a[16:19], a[92:95], v[220:223]
buffer_load_dwordx4 v6, s[52:55], s13 offen lds
v_mfma_f32_16x16x32_bf16 v[220:223], a[0:3], a[88:91], v[220:223]
s_waitcnt lgkmcnt(4)
L_S15:
v_mfma_f32_16x16x32_bf16 v[24:27], a[96:99], a[32:35], v[24:27]
ds_read_b64_tr_b16 a[88:89], v13 offset:256
s_waitcnt vmcnt(23)
v_mfma_f32_16x16x32_bf16 v[24:27], a[100:103], a[48:51], v[24:27]
ds_read_b64_tr_b16 a[90:91], v13 offset:1280
v_mfma_f32_16x16x32_bf16 v[32:35], a[100:103], a[52:55], v[32:35]
ds_read_b64_tr_b16 a[92:93], v13 offset:8448
v_mfma_f32_16x16x32_bf16 v[32:35], a[96:99], a[36:39], v[32:35]
ds_read_b64_tr_b16 a[94:95], v13 offset:9472
v_mfma_f32_16x16x32_bf16 v[40:43], a[96:99], a[40:43], v[40:43]
ds_read_b128 a[0:3], v8 offset:0
s_add_u32 m0, s18, 0x14000
v_mfma_f32_16x16x32_bf16 v[40:43], a[100:103], a[56:59], v[40:43]
buffer_load_dwordx4 v7, s[68:71], 0 offen lds
v_mfma_f32_16x16x32_bf16 v[48:51], a[100:103], a[60:63], v[48:51]
ds_read_b128 a[16:19], v9 offset:0
v_mfma_f32_16x16x32_bf16 v[48:51], a[96:99], a[44:47], v[48:51]
ds_read_b128 a[4:7], v8 offset:2048
v_mfma_f32_16x16x32_bf16 v[52:55], a[104:107], a[44:47], v[52:55]
ds_read_b64_tr_b16 a[96:97], v12 offset:512
v_mfma_f32_16x16x32_bf16 v[52:55], a[108:111], a[60:63], v[52:55]
ds_read_b64_tr_b16 a[98:99], v12 offset:1536
v_mfma_f32_16x16x32_bf16 v[44:47], a[108:111], a[56:59], v[44:47]
ds_read_b64_tr_b16 a[100:101], v12 offset:8704
s_add_u32 s8, s28, 0x4c00
v_mfma_f32_16x16x32_bf16 v[44:47], a[104:107], a[40:43], v[44:47]
buffer_store_dwordx4 a[216:219], v16, s[88:91], s8 offen sc1
v_mfma_f32_16x16x32_bf16 v[36:39], a[104:107], a[36:39], v[36:39]
ds_read_b64_tr_b16 a[102:103], v12 offset:9728
v_mfma_f32_16x16x32_bf16 v[36:39], a[108:111], a[52:55], v[36:39]
ds_read_b128 a[20:23], v9 offset:2048
v_mfma_f32_16x16x32_bf16 v[28:31], a[108:111], a[48:51], v[28:31]
ds_read_b128 a[8:11], v8 offset:4096
v_mfma_f32_16x16x32_bf16 v[28:31], a[104:107], a[32:35], v[28:31]
ds_read_b128 a[24:27], v9 offset:4096
s_waitcnt lgkmcnt(10)
v_mfma_f32_16x16x32_bf16 v[56:59], a[80:83], a[32:35], v[56:59]
ds_read_b64_tr_b16 a[104:105], v13 offset:512
v_mfma_f32_16x16x32_bf16 v[56:59], a[84:87], a[48:51], v[56:59]
ds_read_b64_tr_b16 a[106:107], v13 offset:1536
s_add_u32 m0, s18, 0x15000
v_mfma_f32_16x16x32_bf16 v[64:67], a[84:87], a[52:55], v[64:67]
buffer_load_dwordx4 v7, s[68:71], s25 offen lds
v_mfma_f32_16x16x32_bf16 v[64:67], a[80:83], a[36:39], v[64:67]
ds_read_b64_tr_b16 a[108:109], v13 offset:8704
v_mfma_f32_16x16x32_bf16 v[72:75], a[80:83], a[40:43], v[72:75]
ds_read_b64_tr_b16 a[110:111], v13 offset:9728
v_mfma_f32_16x16x32_bf16 v[72:75], a[84:87], a[56:59], v[72:75]
ds_read_b128 a[12:15], v8 offset:6144
v_mfma_f32_16x16x32_bf16 v[80:83], a[84:87], a[60:63], v[80:83]
ds_read_b128 a[28:31], v9 offset:6144
v_mfma_f32_16x16x32_bf16 v[80:83], a[80:83], a[44:47], v[80:83]
v_mfma_f32_16x16x32_bf16 v[84:87], a[88:91], a[44:47], v[84:87]
ds_read_b64_tr_b16 a[80:81], v12 offset:768
s_add_u32 m0, s18, 0x16000
v_mfma_f32_16x16x32_bf16 v[84:87], a[92:95], a[60:63], v[84:87]
buffer_load_dwordx4 v7, s[68:71], s26 offen lds
v_mfma_f32_16x16x32_bf16 v[76:79], a[92:95], a[56:59], v[76:79]
ds_read_b64_tr_b16 a[82:83], v12 offset:1792
v_lshl_add_u32 v5, s42, 19, v5
v_mfma_f32_16x16x32_bf16 v[76:79], a[88:91], a[40:43], v[76:79]
ds_read_b64_tr_b16 a[84:85], v12 offset:8960
v_lshl_add_u32 v6, s42, 19, v6
v_mfma_f32_16x16x32_bf16 v[68:71], a[88:91], a[36:39], v[68:71]
ds_read_b64_tr_b16 a[86:87], v12 offset:9984
v_lshl_add_u32 v7, s42, 18, v7
v_mfma_f32_16x16x32_bf16 v[68:71], a[92:95], a[52:55], v[68:71]
v_lshl_add_u32 v7, s42, 17, v7
v_mfma_f32_16x16x32_bf16 v[60:63], a[92:95], a[48:51], v[60:63]
v_mfma_f32_16x16x32_bf16 v[60:63], a[88:91], a[32:35], v[60:63]
s_add_u32 m0, s16, 0x0
s_waitcnt lgkmcnt(4)
s_waitcnt lgkmcnt(6)
v_mfma_f32_16x16x32_bf16 v[88:91], a[96:99], a[32:35], v[88:91]
buffer_load_dwordx4 v22, s[44:47], s20 offen lds
v_mfma_f32_16x16x32_bf16 v[88:91], a[100:103], a[48:51], v[88:91]
ds_read_b64_tr_b16 a[88:89], v13 offset:768
v_mfma_f32_16x16x32_bf16 v[96:99], a[100:103], a[52:55], v[96:99]
ds_read_b64_tr_b16 a[90:91], v13 offset:1792
v_mfma_f32_16x16x32_bf16 v[96:99], a[96:99], a[36:39], v[96:99]
ds_read_b64_tr_b16 a[92:93], v13 offset:8960
v_mfma_f32_16x16x32_bf16 v[104:107], a[96:99], a[40:43], v[104:107]
ds_read_b64_tr_b16 a[94:95], v13 offset:9984
s_add_u32 m0, s16, 0x400
v_mfma_f32_16x16x32_bf16 v[104:107], a[100:103], a[56:59], v[104:107]
buffer_load_dwordx4 v23, s[44:47], s20 offen lds
v_mfma_f32_16x16x32_bf16 v[112:115], a[100:103], a[60:63], v[112:115]
v_mfma_f32_16x16x32_bf16 v[112:115], a[96:99], a[44:47], v[112:115]
v_mfma_f32_16x16x32_bf16 v[116:119], a[104:107], a[44:47], v[116:119]
ds_read_b64_tr_b16 a[96:97], v14 offset:0
v_mfma_f32_16x16x32_bf16 v[116:119], a[108:111], a[60:63], v[116:119]
ds_read_b64_tr_b16 a[98:99], v14 offset:256
v_mfma_f32_16x16x32_bf16 v[108:111], a[108:111], a[56:59], v[108:111]
ds_read_b64_tr_b16 a[100:101], v14 offset:2048
s_add_u32 m0, s16, 0x800
v_mfma_f32_16x16x32_bf16 v[108:111], a[104:107], a[40:43], v[108:111]
buffer_load_dwordx4 v22, s[44:47], s21 offen lds
v_mfma_f32_16x16x32_bf16 v[100:103], a[104:107], a[36:39], v[100:103]
ds_read_b64_tr_b16 a[102:103], v14 offset:2304
v_mfma_f32_16x16x32_bf16 v[100:103], a[108:111], a[52:55], v[100:103]
v_mfma_f32_16x16x32_bf16 v[92:95], a[108:111], a[48:51], v[92:95]
v_mfma_f32_16x16x32_bf16 v[92:95], a[104:107], a[32:35], v[92:95]
s_add_u32 s8, s28, 0x8c00
s_waitcnt lgkmcnt(4)
v_mfma_f32_16x16x32_bf16 v[120:123], a[80:83], a[32:35], v[120:123]
buffer_store_dwordx4 a[220:223], v16, s[88:91], s8 offen sc1
v_mfma_f32_16x16x32_bf16 v[120:123], a[84:87], a[48:51], v[120:123]
ds_read_b64_tr_b16 a[104:105], v15 offset:0
v_mfma_f32_16x16x32_bf16 v[128:131], a[84:87], a[52:55], v[128:131]
ds_read_b64_tr_b16 a[106:107], v15 offset:256
v_mfma_f32_16x16x32_bf16 v[128:131], a[80:83], a[36:39], v[128:131]
ds_read_b64_tr_b16 a[108:109], v15 offset:2048
v_mfma_f32_16x16x32_bf16 v[136:139], a[80:83], a[40:43], v[136:139]
ds_read_b64_tr_b16 a[110:111], v15 offset:2304
v_mfma_f32_16x16x32_bf16 v[136:139], a[84:87], a[56:59], v[136:139]
s_add_u32 m0, s16, 0xc00
v_mfma_f32_16x16x32_bf16 v[144:147], a[84:87], a[60:63], v[144:147]
buffer_load_dwordx4 v23, s[44:47], s21 offen lds
v_mfma_f32_16x16x32_bf16 v[144:147], a[80:83], a[44:47], v[144:147]
v_mfma_f32_16x16x32_bf16 v[148:151], a[88:91], a[44:47], v[148:151]
ds_read_b64_tr_b16 a[80:81], v14 offset:4096
v_mfma_f32_16x16x32_bf16 v[148:151], a[92:95], a[60:63], v[148:151]
ds_read_b64_tr_b16 a[82:83], v14 offset:4352
v_mfma_f32_16x16x32_bf16 v[140:143], a[92:95], a[56:59], v[140:143]
ds_read_b64_tr_b16 a[84:85], v14 offset:6144
v_mfma_f32_16x16x32_bf16 v[140:143], a[88:91], a[40:43], v[140:143]
ds_read_b64_tr_b16 a[86:87], v14 offset:6400
s_add_u32 m0, s16, 0x1000
v_mfma_f32_16x16x32_bf16 v[132:135], a[88:91], a[36:39], v[132:135]
buffer_load_dwordx4 v22, s[44:47], s22 offen lds
v_mfma_f32_16x16x32_bf16 v[132:135], a[92:95], a[52:55], v[132:135]
v_mfma_f32_16x16x32_bf16 v[124:127], a[92:95], a[48:51], v[124:127]
v_mfma_f32_16x16x32_bf16 v[124:127], a[88:91], a[32:35], v[124:127]
s_waitcnt lgkmcnt(4)
v_mfma_f32_16x16x32_bf16 v[152:155], a[96:99], a[32:35], v[152:155]
ds_read_b64_tr_b16 a[88:89], v15 offset:4096
s_add_u32 m0, s16, 0x1400
v_mfma_f32_16x16x32_bf16 v[152:155], a[100:103], a[48:51], v[152:155]
buffer_load_dwordx4 v23, s[44:47], s22 offen lds
v_mfma_f32_16x16x32_bf16 v[160:163], a[100:103], a[52:55], v[160:163]
ds_read_b64_tr_b16 a[90:91], v15 offset:4352
v_mfma_f32_16x16x32_bf16 v[160:163], a[96:99], a[36:39], v[160:163]
ds_read_b64_tr_b16 a[92:93], v15 offset:6144
v_mfma_f32_16x16x32_bf16 v[168:171], a[96:99], a[40:43], v[168:171]
ds_read_b64_tr_b16 a[94:95], v15 offset:6400
v_mfma_f32_16x16x32_bf16 v[168:171], a[100:103], a[56:59], v[168:171]
v_mfma_f32_16x16x32_bf16 v[176:179], a[100:103], a[60:63], v[176:179]
s_add_u32 m0, s16, 0x1800
v_mfma_f32_16x16x32_bf16 v[176:179], a[96:99], a[44:47], v[176:179]
buffer_load_dwordx4 v22, s[44:47], s23 offen lds
v_mfma_f32_16x16x32_bf16 v[180:183], a[104:107], a[44:47], v[180:183]
ds_read_b64_tr_b16 a[96:97], v14 offset:8192
v_mfma_f32_16x16x32_bf16 v[180:183], a[108:111], a[60:63], v[180:183]
ds_read_b64_tr_b16 a[98:99], v14 offset:8448
v_mfma_f32_16x16x32_bf16 v[172:175], a[108:111], a[56:59], v[172:175]
ds_read_b64_tr_b16 a[100:101], v14 offset:10240
v_mfma_f32_16x16x32_bf16 v[172:175], a[104:107], a[40:43], v[172:175]
ds_read_b64_tr_b16 a[102:103], v14 offset:10496
s_add_u32 m0, s16, 0x1c00
v_mfma_f32_16x16x32_bf16 v[164:167], a[104:107], a[36:39], v[164:167]
buffer_load_dwordx4 v23, s[44:47], s23 offen lds
v_mfma_f32_16x16x32_bf16 v[164:167], a[108:111], a[52:55], v[164:167]
v_lshl_add_u32 v22, s42, 7, v22
v_lshl_add_u32 v23, s42, 7, v23
v_mfma_f32_16x16x32_bf16 v[156:159], a[108:111], a[48:51], v[156:159]
v_mfma_f32_16x16x32_bf16 v[156:159], a[104:107], a[32:35], v[156:159]
s_waitcnt lgkmcnt(4)
v_mfma_f32_16x16x32_bf16 v[184:187], a[80:83], a[32:35], v[184:187]
ds_read_b64_tr_b16 a[104:105], v15 offset:8192
v_mfma_f32_16x16x32_bf16 v[184:187], a[84:87], a[48:51], v[184:187]
ds_read_b64_tr_b16 a[106:107], v15 offset:8448
s_add_u32 s8, s28, 0x5000
v_mfma_f32_16x16x32_bf16 v[192:195], a[84:87], a[52:55], v[192:195]
buffer_store_dwordx4 a[224:227], v16, s[88:91], s8 offen sc1
v_mfma_f32_16x16x32_bf16 v[192:195], a[80:83], a[36:39], v[192:195]
ds_read_b64_tr_b16 a[108:109], v15 offset:10240
v_mfma_f32_16x16x32_bf16 v[200:203], a[80:83], a[40:43], v[200:203]
ds_read_b64_tr_b16 a[110:111], v15 offset:10496
v_add_u32 v12, 0x8000, v12
v_mfma_f32_16x16x32_bf16 v[200:203], a[84:87], a[56:59], v[200:203]
v_add_u32 v13, 0x8000, v13
v_add_u32 v14, 0x8000, v14
v_mfma_f32_16x16x32_bf16 v[208:211], a[84:87], a[60:63], v[208:211]
L_padA8:
s_cmp_eq_u32 s95, 1
s_cbranch_scc1 L_padA12
v_add_u32 v15, 0x8000, v15
v_mfma_f32_16x16x32_bf16 v[208:211], a[80:83], a[44:47], v[208:211]
v_mfma_f32_16x16x32_bf16 v[212:215], a[88:91], a[44:47], v[212:215]
s_waitcnt vmcnt(28) lgkmcnt(0)
v_mfma_f32_16x16x32_bf16 v[212:215], a[92:95], a[60:63], v[212:215]
s_barrier
s_add_u32 m0, s17, 0x0
v_mfma_f32_16x16x32_bf16 v[204:207], a[92:95], a[56:59], v[204:207]
buffer_load_dwordx4 v5, s[52:55], 0 offen lds
v_mfma_f32_16x16x32_bf16 v[204:207], a[88:91], a[40:43], v[204:207]
ds_read_b64_tr_b16 a[80:81], v12 offset:0
v_mfma_f32_16x16x32_bf16 v[196:199], a[88:91], a[36:39], v[196:199]
ds_read_b64_tr_b16 a[82:83], v12 offset:1024
v_mfma_f32_16x16x32_bf16 v[196:199], a[92:95], a[52:55], v[196:199]
ds_read_b64_tr_b16 a[84:85], v12 offset:8192
v_mfma_f32_16x16x32_bf16 v[188:191], a[92:95], a[48:51], v[188:191]
ds_read_b64_tr_b16 a[86:87], v12 offset:9216
v_mfma_f32_16x16x32_bf16 v[188:191], a[88:91], a[32:35], v[188:191]
s_add_u32 m0, s17, 0x400
s_waitcnt lgkmcnt(4)
v_mfma_f32_16x16x32_bf16 v[216:219], a[32:35], a[96:99], v[216:219]
buffer_load_dwordx4 v5, s[52:55], s13 offen lds
v_mfma_f32_16x16x32_bf16 v[216:219], a[48:51], a[100:103], v[216:219]
ds_read_b64_tr_b16 a[88:89], v13 offset:0
v_mfma_f32_16x16x32_bf16 v[224:227], a[52:55], a[100:103], v[224:227]
ds_read_b64_tr_b16 a[90:91], v13 offset:1024
v_mfma_f32_16x16x32_bf16 v[224:227], a[36:39], a[96:99], v[224:227]
ds_read_b64_tr_b16 a[92:93], v13 offset:8192
v_mfma_f32_16x16x32_bf16 v[232:235], a[40:43], a[96:99], v[232:235]
ds_read_b64_tr_b16 a[94:95], v13 offset:9216
v_mfma_f32_16x16x32_bf16 v[232:235], a[56:59], a[100:103], v[232:235]
v_mfma_f32_16x16x32_bf16 v[240:243], a[60:63], a[100:103], v[240:243]
s_add_u32 m0, s17, 0x800
v_mfma_f32_16x16x32_bf16 v[240:243], a[44:47], a[96:99], v[240:243]
buffer_load_dwordx4 v6, s[52:55], 0 offen lds
v_mfma_f32_16x16x32_bf16 v[244:247], a[44:47], a[104:107], v[244:247]
ds_read_b64_tr_b16 a[96:97], v12 offset:256
v_mfma_f32_16x16x32_bf16 v[244:247], a[60:63], a[108:111], v[244:247]
ds_read_b64_tr_b16 a[98:99], v12 offset:1280
v_mfma_f32_16x16x32_bf16 v[236:239], a[56:59], a[108:111], v[236:239]
ds_read_b64_tr_b16 a[100:101], v12 offset:8448
v_mfma_f32_16x16x32_bf16 v[236:239], a[40:43], a[104:107], v[236:239]
ds_read_b64_tr_b16 a[102:103], v12 offset:9472
v_mfma_f32_16x16x32_bf16 v[228:231], a[36:39], a[104:107], v[228:231]
v_mfma_f32_16x16x32_bf16 v[228:231], a[52:55], a[108:111], v[228:231]
s_add_u32 m0, s17, 0xc00
v_mfma_f32_16x16x32_bf16 v[220:223], a[48:51], a[108:111], v[220:223]
buffer_load_dwordx4 v6, s[52:55], s13 offen lds
v_mfma_f32_16x16x32_bf16 v[220:223], a[32:35], a[104:107], v[220:223]
s_waitcnt lgkmcnt(4)
L_S16:
v_mfma_f32_16x16x32_bf16 v[24:27], a[80:83], a[0:3], v[24:27]
ds_read_b64_tr_b16 a[104:105], v13 offset:256
s_waitcnt vmcnt(23)
v_mfma_f32_16x16x32_bf16 v[24:27], a[84:87], a[16:19], v[24:27]
ds_read_b64_tr_b16 a[106:107], v13 offset:1280
v_mfma_f32_16x16x32_bf16 v[32:35], a[84:87], a[20:23], v[32:35]
ds_read_b64_tr_b16 a[108:109], v13 offset:8448
v_mfma_f32_16x16x32_bf16 v[32:35], a[80:83], a[4:7], v[32:35]
ds_read_b64_tr_b16 a[110:111], v13 offset:9472
v_mfma_f32_16x16x32_bf16 v[40:43], a[80:83], a[8:11], v[40:43]
ds_read_b128 a[32:35], v8 offset:32768
s_add_u32 m0, s18, 0x4000
v_mfma_f32_16x16x32_bf16 v[40:43], a[84:87], a[24:27], v[40:43]
buffer_load_dwordx4 v7, s[68:71], 0 offen lds
v_mfma_f32_16x16x32_bf16 v[48:51], a[84:87], a[28:31], v[48:51]
ds_read_b128 a[48:51], v9 offset:32768
v_mfma_f32_16x16x32_bf16 v[48:51], a[80:83], a[12:15], v[48:51]
ds_read_b128 a[36:39], v8 offset:34816
v_mfma_f32_16x16x32_bf16 v[52:55], a[88:91], a[12:15], v[52:55]
ds_read_b64_tr_b16 a[80:81], v12 offset:512
v_mfma_f32_16x16x32_bf16 v[52:55], a[92:95], a[28:31], v[52:55]
ds_read_b64_tr_b16 a[82:83], v12 offset:1536
v_mfma_f32_16x16x32_bf16 v[44:47], a[92:95], a[24:27], v[44:47]
ds_read_b64_tr_b16 a[84:85], v12 offset:8704
s_add_u32 s8, s28, 0x9000
v_mfma_f32_16x16x32_bf16 v[44:47], a[88:91], a[8:11], v[44:47]
buffer_store_dwordx4 a[228:231], v16, s[88:91], s8 offen sc1
v_mfma_f32_16x16x32_bf16 v[36:39], a[88:91], a[4:7], v[36:39]
ds_read_b64_tr_b16 a[86:87], v12 offset:9728
v_mfma_f32_16x16x32_bf16 v[36:39], a[92:95], a[20:23], v[36:39]
ds_read_b128 a[52:55], v9 offset:34816
v_mfma_f32_16x16x32_bf16 v[28:31], a[92:95], a[16:19], v[28:31]
ds_read_b128 a[40:43], v8 offset:36864
v_mfma_f32_16x16x32_bf16 v[28:31], a[88:91], a[0:3], v[28:31]
ds_read_b128 a[56:59], v9 offset:36864
s_waitcnt lgkmcnt(10)
v_mfma_f32_16x16x32_bf16 v[56:59], a[96:99], a[0:3], v[56:59]
ds_read_b64_tr_b16 a[88:89], v13 offset:512
v_mfma_f32_16x16x32_bf16 v[56:59], a[100:103], a[16:19], v[56:59]
ds_read_b64_tr_b16 a[90:91], v13 offset:1536
s_add_u32 m0, s18, 0x5000
v_mfma_f32_16x16x32_bf16 v[64:67], a[100:103], a[20:23], v[64:67]
buffer_load_dwordx4 v7, s[68:71], s25 offen lds
v_mfma_f32_16x16x32_bf16 v[64:67], a[96:99], a[4:7], v[64:67]
ds_read_b64_tr_b16 a[92:93], v13 offset:8704
v_mfma_f32_16x16x32_bf16 v[72:75], a[96:99], a[8:11], v[72:75]
ds_read_b64_tr_b16 a[94:95], v13 offset:9728
v_mfma_f32_16x16x32_bf16 v[72:75], a[100:103], a[24:27], v[72:75]
ds_read_b128 a[44:47], v8 offset:38912
v_mfma_f32_16x16x32_bf16 v[80:83], a[100:103], a[28:31], v[80:83]
ds_read_b128 a[60:63], v9 offset:38912
v_mfma_f32_16x16x32_bf16 v[80:83], a[96:99], a[12:15], v[80:83]
v_mfma_f32_16x16x32_bf16 v[84:87], a[104:107], a[12:15], v[84:87]
ds_read_b64_tr_b16 a[96:97], v12 offset:768
s_add_u32 m0, s18, 0x6000
v_mfma_f32_16x16x32_bf16 v[84:87], a[108:111], a[28:31], v[84:87]
buffer_load_dwordx4 v7, s[68:71], s26 offen lds
v_mfma_f32_16x16x32_bf16 v[76:79], a[108:111], a[24:27], v[76:79]
ds_read_b64_tr_b16 a[98:99], v12 offset:1792
v_lshl_add_u32 v5, s42, 19, v5
v_mfma_f32_16x16x32_bf16 v[76:79], a[104:107], a[8:11], v[76:79]
ds_read_b64_tr_b16 a[100:101], v12 offset:8960
v_lshl_add_u32 v6, s42, 19, v6
v_mfma_f32_16x16x32_bf16 v[68:71], a[104:107], a[4:7], v[68:71]
ds_read_b64_tr_b16 a[102:103], v12 offset:9984
v_lshl_add_u32 v7, s42, 18, v7
v_mfma_f32_16x16x32_bf16 v[68:71], a[108:111], a[20:23], v[68:71]
v_lshl_add_u32 v7, s42, 17, v7
v_mfma_f32_16x16x32_bf16 v[60:63], a[108:111], a[16:19], v[60:63]
v_mfma_f32_16x16x32_bf16 v[60:63], a[104:107], a[0:3], v[60:63]
s_add_u32 m0, s16, 0x8000
s_waitcnt lgkmcnt(4)
s_waitcnt lgkmcnt(6)
v_mfma_f32_16x16x32_bf16 v[88:91], a[80:83], a[0:3], v[88:91]
buffer_load_dwordx4 v22, s[44:47], s20 offen lds
v_mfma_f32_16x16x32_bf16 v[88:91], a[84:87], a[16:19], v[88:91]
ds_read_b64_tr_b16 a[104:105], v13 offset:768
v_mfma_f32_16x16x32_bf16 v[96:99], a[84:87], a[20:23], v[96:99]
ds_read_b64_tr_b16 a[106:107], v13 offset:1792
v_mfma_f32_16x16x32_bf16 v[96:99], a[80:83], a[4:7], v[96:99]
ds_read_b64_tr_b16 a[108:109], v13 offset:8960
v_mfma_f32_16x16x32_bf16 v[104:107], a[80:83], a[8:11], v[104:107]
ds_read_b64_tr_b16 a[110:111], v13 offset:9984
s_add_u32 m0, s16, 0x8400
v_mfma_f32_16x16x32_bf16 v[104:107], a[84:87], a[24:27], v[104:107]
buffer_load_dwordx4 v23, s[44:47], s20 offen lds
v_mfma_f32_16x16x32_bf16 v[112:115], a[84:87], a[28:31], v[112:115]
v_mfma_f32_16x16x32_bf16 v[112:115], a[80:83], a[12:15], v[112:115]
v_mfma_f32_16x16x32_bf16 v[116:119], a[88:91], a[12:15], v[116:119]
ds_read_b64_tr_b16 a[80:81], v14 offset:0
v_mfma_f32_16x16x32_bf16 v[116:119], a[92:95], a[28:31], v[116:119]
ds_read_b64_tr_b16 a[82:83], v14 offset:256
v_mfma_f32_16x16x32_bf16 v[108:111], a[92:95], a[24:27], v[108:111]
ds_read_b64_tr_b16 a[84:85], v14 offset:2048
s_add_u32 m0, s16, 0x8800
v_mfma_f32_16x16x32_bf16 v[108:111], a[88:91], a[8:11], v[108:111]
buffer_load_dwordx4 v22, s[44:47], s21 offen lds
v_mfma_f32_16x16x32_bf16 v[100:103], a[88:91], a[4:7], v[100:103]
ds_read_b64_tr_b16 a[86:87], v14 offset:2304
v_mfma_f32_16x16x32_bf16 v[100:103], a[92:95], a[20:23], v[100:103]
v_mfma_f32_16x16x32_bf16 v[92:95], a[92:95], a[16:19], v[92:95]
v_mfma_f32_16x16x32_bf16 v[92:95], a[88:91], a[0:3], v[92:95]
s_add_u32 s8, s28, 0x5400
s_waitcnt lgkmcnt(4)
v_mfma_f32_16x16x32_bf16 v[120:123], a[96:99], a[0:3], v[120:123]
buffer_store_dwordx4 a[112:115], v16, s[88:91], s8 offen sc1
v_mfma_f32_16x16x32_bf16 v[120:123], a[100:103], a[16:19], v[120:123]
ds_read_b64_tr_b16 a[88:89], v15 offset:0
v_mfma_f32_16x16x32_bf16 v[128:131], a[100:103], a[20:23], v[128:131]
ds_read_b64_tr_b16 a[90:91], v15 offset:256
v_mfma_f32_16x16x32_bf16 v[128:131], a[96:99], a[4:7], v[128:131]
ds_read_b64_tr_b16 a[92:93], v15 offset:2048
v_mfma_f32_16x16x32_bf16 v[136:139], a[96:99], a[8:11], v[136:139]
ds_read_b64_tr_b16 a[94:95], v15 offset:2304
v_mfma_f32_16x16x32_bf16 v[136:139], a[100:103], a[24:27], v[136:139]
s_add_u32 m0, s16, 0x8c00
v_mfma_f32_16x16x32_bf16 v[144:147], a[100:103], a[28:31], v[144:147]
buffer_load_dwordx4 v23, s[44:47], s21 offen lds
v_mfma_f32_16x16x32_bf16 v[144:147], a[96:99], a[12:15], v[144:147]
v_mfma_f32_16x16x32_bf16 v[148:151], a[104:107], a[12:15], v[148:151]
ds_read_b64_tr_b16 a[96:97], v14 offset:4096
v_mfma_f32_16x16x32_bf16 v[148:151], a[108:111], a[28:31], v[148:151]
ds_read_b64_tr_b16 a[98:99], v14 offset:4352
v_mfma_f32_16x16x32_bf16 v[140:143], a[108:111], a[24:27], v[140:143]
ds_read_b64_tr_b16 a[100:101], v14 offset:6144
v_mfma_f32_16x16x32_bf16 v[140:143], a[104:107], a[8:11], v[140:143]
ds_read_b64_tr_b16 a[102:103], v14 offset:6400
s_add_u32 m0, s16, 0x9000
v_mfma_f32_16x16x32_bf16 v[132:135], a[104:107], a[4:7], v[132:135]
buffer_load_dwordx4 v22, s[44:47], s22 offen lds
v_mfma_f32_16x16x32_bf16 v[132:135], a[108:111], a[20:23], v[132:135]
v_mfma_f32_16x16x32_bf16 v[124:127], a[108:111], a[16:19], v[124:127]
v_mfma_f32_16x16x32_bf16 v[124:127], a[104:107], a[0:3], v[124:127]
s_waitcnt lgkmcnt(4)
v_mfma_f32_16x16x32_bf16 v[152:155], a[80:83], a[0:3], v[152:155]
ds_read_b64_tr_b16 a[104:105], v15 offset:4096
s_add_u32 m0, s16, 0x9400
v_mfma_f32_16x16x32_bf16 v[152:155], a[84:87], a[16:19], v[152:155]
buffer_load_dwordx4 v23, s[44:47], s22 offen lds
v_mfma_f32_16x16x32_bf16 v[160:163], a[84:87], a[20:23], v[160:163]
ds_read_b64_tr_b16 a[106:107], v15 offset:4352
v_mfma_f32_16x16x32_bf16 v[160:163], a[80:83], a[4:7], v[160:163]
ds_read_b64_tr_b16 a[108:109], v15 offset:6144
v_mfma_f32_16x16x32_bf16 v[168:171], a[80:83], a[8:11], v[168:171]
ds_read_b64_tr_b16 a[110:111], v15 offset:6400
v_mfma_f32_16x16x32_bf16 v[168:171], a[84:87], a[24:27], v[168:171]
v_mfma_f32_16x16x32_bf16 v[176:179], a[84:87], a[28:31], v[176:179]
s_add_u32 m0, s16, 0x9800
v_mfma_f32_16x16x32_bf16 v[176:179], a[80:83], a[12:15], v[176:179]
buffer_load_dwordx4 v22, s[44:47], s23 offen lds
v_mfma_f32_16x16x32_bf16 v[180:183], a[88:91], a[12:15], v[180:183]
ds_read_b64_tr_b16 a[80:81], v14 offset:8192
v_mfma_f32_16x16x32_bf16 v[180:183], a[92:95], a[28:31], v[180:183]
ds_read_b64_tr_b16 a[82:83], v14 offset:8448
v_mfma_f32_16x16x32_bf16 v[172:175], a[92:95], a[24:27], v[172:175]
ds_read_b64_tr_b16 a[84:85], v14 offset:10240
v_mfma_f32_16x16x32_bf16 v[172:175], a[88:91], a[8:11], v[172:175]
ds_read_b64_tr_b16 a[86:87], v14 offset:10496
s_add_u32 m0, s16, 0x9c00
v_mfma_f32_16x16x32_bf16 v[164:167], a[88:91], a[4:7], v[164:167]
buffer_load_dwordx4 v23, s[44:47], s23 offen lds
v_mfma_f32_16x16x32_bf16 v[164:167], a[92:95], a[20:23], v[164:167]
v_lshl_add_u32 v22, s42, 7, v22
v_lshl_add_u32 v23, s42, 7, v23
v_mfma_f32_16x16x32_bf16 v[156:159], a[92:95], a[16:19], v[156:159]
v_mfma_f32_16x16x32_bf16 v[156:159], a[88:91], a[0:3], v[156:159]
s_waitcnt lgkmcnt(4)
v_mfma_f32_16x16x32_bf16 v[184:187], a[96:99], a[0:3], v[184:187]
ds_read_b64_tr_b16 a[88:89], v15 offset:8192
v_mfma_f32_16x16x32_bf16 v[184:187], a[100:103], a[16:19], v[184:187]
ds_read_b64_tr_b16 a[90:91], v15 offset:8448
s_add_u32 s8, s28, 0x9400
v_mfma_f32_16x16x32_bf16 v[192:195], a[100:103], a[20:23], v[192:195]
buffer_store_dwordx4 a[116:119], v16, s[88:91], s8 offen sc1
v_mfma_f32_16x16x32_bf16 v[192:195], a[96:99], a[4:7], v[192:195]
ds_read_b64_tr_b16 a[92:93], v15 offset:10240
v_mfma_f32_16x16x32_bf16 v[200:203], a[96:99], a[8:11], v[200:203]
ds_read_b64_tr_b16 a[94:95], v15 offset:10496
v_add_u32 v12, 0x8000, v12
v_mfma_f32_16x16x32_bf16 v[200:203], a[100:103], a[24:27], v[200:203]
v_add_u32 v13, 0x8000, v13
v_add_u32 v14, 0x8000, v14
v_mfma_f32_16x16x32_bf16 v[208:211], a[100:103], a[28:31], v[208:211]
v_add_u32 v15, 0x8000, v15
v_mfma_f32_16x16x32_bf16 v[208:211], a[96:99], a[12:15], v[208:211]
v_mfma_f32_16x16x32_bf16 v[212:215], a[104:107], a[12:15], v[212:215]
s_waitcnt vmcnt(28) lgkmcnt(0)
v_mfma_f32_16x16x32_bf16 v[212:215], a[108:111], a[28:31], v[212:215]
s_barrier
s_add_u32 m0, s17, 0x8000
v_mfma_f32_16x16x32_bf16 v[204:207], a[108:111], a[24:27], v[204:207]
buffer_load_dwordx4 v5, s[52:55], 0 offen lds
v_mfma_f32_16x16x32_bf16 v[204:207], a[104:107], a[8:11], v[204:207]
ds_read_b64_tr_b16 a[96:97], v12 offset:0
v_mfma_f32_16x16x32_bf16 v[196:199], a[104:107], a[4:7], v[196:199]
ds_read_b64_tr_b16 a[98:99], v12 offset:1024
v_mfma_f32_16x16x32_bf16 v[196:199], a[108:111], a[20:23], v[196:199]
ds_read_b64_tr_b16 a[100:101], v12 offset:8192
v_mfma_f32_16x16x32_bf16 v[188:191], a[108:111], a[16:19], v[188:191]
ds_read_b64_tr_b16 a[102:103], v12 offset:9216
v_mfma_f32_16x16x32_bf16 v[188:191], a[104:107], a[0:3], v[188:191]
s_add_u32 m0, s17, 0x8400
s_waitcnt lgkmcnt(4)
v_mfma_f32_16x16x32_bf16 v[216:219], a[0:3], a[80:83], v[216:219]
buffer_load_dwordx4 v5, s[52:55], s13 offen lds
v_mfma_f32_16x16x32_bf16 v[216:219], a[16:19], a[84:87], v[216:219]
ds_read_b64_tr_b16 a[104:105], v13 offset:0
v_mfma_f32_16x16x32_bf16 v[224:227], a[20:23], a[84:87], v[224:227]
ds_read_b64_tr_b16 a[106:107], v13 offset:1024
v_mfma_f32_16x16x32_bf16 v[224:227], a[4:7], a[80:83], v[224:227]
ds_read_b64_tr_b16 a[108:109], v13 offset:8192
v_mfma_f32_16x16x32_bf16 v[232:235], a[8:11], a[80:83], v[232:235]
ds_read_b64_tr_b16 a[110:111], v13 offset:9216
v_mfma_f32_16x16x32_bf16 v[232:235], a[24:27], a[84:87], v[232:235]
s_add_u32 m0, s17, 0x8800
v_mfma_f32_16x16x32_bf16 v[240:243], a[28:31], a[84:87], v[240:243]
buffer_load_dwordx4 v6, s[52:55], 0 offen lds
v_mfma_f32_16x16x32_bf16 v[240:243], a[12:15], a[80:83], v[240:243]
v_mfma_f32_16x16x32_bf16 v[244:247], a[12:15], a[88:91], v[244:247]
ds_read_b64_tr_b16 a[80:81], v12 offset:256
v_mfma_f32_16x16x32_bf16 v[244:247], a[28:31], a[92:95], v[244:247]
ds_read_b64_tr_b16 a[82:83], v12 offset:1280
v_mfma_f32_16x16x32_bf16 v[236:239], a[24:27], a[92:95], v[236:239]
ds_read_b64_tr_b16 a[84:85], v12 offset:8448
v_mfma_f32_16x16x32_bf16 v[236:239], a[8:11], a[88:91], v[236:239]
ds_read_b64_tr_b16 a[86:87], v12 offset:9472
s_add_u32 s8, s28, 0x5800
v_mfma_f32_16x16x32_bf16 v[228:231], a[4:7], a[88:91], v[228:231]
buffer_store_dwordx4 a[124:127], v16, s[88:91], s8 offen sc1
v_mfma_f32_16x16x32_bf16 v[228:231], a[20:23], a[92:95], v[228:231]
v_mfma_f32_16x16x32_bf16 v[220:223], a[16:19], a[92:95], v[220:223]
v_mfma_f32_16x16x32_bf16 v[220:223], a[0:3], a[88:91], v[220:223]
s_waitcnt lgkmcnt(4)
L_S17:
v_mfma_f32_16x16x32_bf16 v[24:27], a[96:99], a[32:35], v[24:27]
ds_read_b64_tr_b16 a[88:89], v13 offset:256
s_waitcnt vmcnt(23)
v_mfma_f32_16x16x32_bf16 v[24:27], a[100:103], a[48:51], v[24:27]
ds_read_b64_tr_b16 a[90:91], v13 offset:1280
s_add_u32 m0, s17, 0x8c00
v_mfma_f32_16x16x32_bf16 v[32:35], a[100:103], a[52:55], v[32:35]
buffer_load_dwordx4 v6, s[52:55], s13 offen lds
v_mfma_f32_16x16x32_bf16 v[32:35], a[96:99], a[36:39], v[32:35]
ds_read_b64_tr_b16 a[92:93], v13 offset:8448
v_mfma_f32_16x16x32_bf16 v[40:43], a[96:99], a[40:43], v[40:43]
ds_read_b64_tr_b16 a[94:95], v13 offset:9472
v_mfma_f32_16x16x32_bf16 v[40:43], a[100:103], a[56:59], v[40:43]
ds_read_b128 a[0:3], v8 offset:0
v_mfma_f32_16x16x32_bf16 v[48:51], a[100:103], a[60:63], v[48:51]
ds_read_b128 a[16:19], v9 offset:0
v_mfma_f32_16x16x32_bf16 v[48:51], a[96:99], a[44:47], v[48:51]
ds_read_b128 a[4:7], v8 offset:2048
s_add_u32 m0, s18, 0xc000
v_mfma_f32_16x16x32_bf16 v[52:55], a[104:107], a[44:47], v[52:55]
buffer_load_dwordx4 v7, s[68:71], 0 offen lds
v_mfma_f32_16x16x32_bf16 v[52:55], a[108:111], a[60:63], v[52:55]
ds_read_b64_tr_b16 a[96:97], v12 offset:512
v_mfma_f32_16x16x32_bf16 v[44:47], a[108:111], a[56:59], v[44:47]
ds_read_b64_tr_b16 a[98:99], v12 offset:1536
v_mfma_f32_16x16x32_bf16 v[44:47], a[104:107], a[40:43], v[44:47]
ds_read_b64_tr_b16 a[100:101], v12 offset:8704
v_mfma_f32_16x16x32_bf16 v[36:39], a[104:107], a[36:39], v[36:39]
ds_read_b64_tr_b16 a[102:103], v12 offset:9728
v_mfma_f32_16x16x32_bf16 v[36:39], a[108:111], a[52:55], v[36:39]
ds_read_b128 a[20:23], v9 offset:2048
s_add_u32 m0, s18, 0xd000
v_mfma_f32_16x16x32_bf16 v[28:31], a[108:111], a[48:51], v[28:31]
buffer_load_dwordx4 v7, s[68:71], s25 offen lds
v_mfma_f32_16x16x32_bf16 v[28:31], a[104:107], a[32:35], v[28:31]
ds_read_b128 a[8:11], v8 offset:4096
s_waitcnt lgkmcnt(9)
v_mfma_f32_16x16x32_bf16 v[56:59], a[80:83], a[32:35], v[56:59]
ds_read_b64_tr_b16 a[104:105], v13 offset:512
v_mfma_f32_16x16x32_bf16 v[56:59], a[84:87], a[48:51], v[56:59]
ds_read_b64_tr_b16 a[106:107], v13 offset:1536
v_mfma_f32_16x16x32_bf16 v[64:67], a[84:87], a[52:55], v[64:67]
ds_read_b64_tr_b16 a[108:109], v13 offset:8704
v_mfma_f32_16x16x32_bf16 v[64:67], a[80:83], a[36:39], v[64:67]
ds_read_b64_tr_b16 a[110:111], v13 offset:9728
s_add_u32 m0, s18, 0xe000
v_mfma_f32_16x16x32_bf16 v[72:75], a[80:83], a[40:43], v[72:75]
buffer_load_dwordx4 v7, s[68:71], s26 offen lds
v_mfma_f32_16x16x32_bf16 v[72:75], a[84:87], a[56:59], v[72:75]
ds_read_b128 a[24:27], v9 offset:4096
v_lshl_add_u32 v5, s42, 19, v5
v_mfma_f32_16x16x32_bf16 v[80:83], a[84:87], a[60:63], v[80:83]
ds_read_b128 a[12:15], v8 offset:6144
v_lshl_add_u32 v6, s42, 19, v6
v_mfma_f32_16x16x32_bf16 v[80:83], a[80:83], a[44:47], v[80:83]
ds_read_b128 a[28:31], v9 offset:6144
v_lshl_add_u32 v7, s42, 18, v7
v_mfma_f32_16x16x32_bf16 v[84:87], a[88:91], a[44:47], v[84:87]
ds_read_b64_tr_b16 a[80:81], v12 offset:768
v_lshl_add_u32 v7, s42, 17, v7
v_mfma_f32_16x16x32_bf16 v[84:87], a[92:95], a[60:63], v[84:87]
ds_read_b64_tr_b16 a[82:83], v12 offset:1792
s_add_u32 s8, s28, 0x9800
v_mfma_f32_16x16x32_bf16 v[76:79], a[92:95], a[56:59], v[76:79]
buffer_store_dwordx4 a[232:235], v16, s[88:91], s8 offen sc1
v_mfma_f32_16x16x32_bf16 v[76:79], a[88:91], a[40:43], v[76:79]
ds_read_b64_tr_b16 a[84:85], v12 offset:8960
v_mfma_f32_16x16x32_bf16 v[68:71], a[88:91], a[36:39], v[68:71]
ds_read_b64_tr_b16 a[86:87], v12 offset:9984
v_mfma_f32_16x16x32_bf16 v[68:71], a[92:95], a[52:55], v[68:71]
v_mfma_f32_16x16x32_bf16 v[60:63], a[92:95], a[48:51], v[60:63]
v_mfma_f32_16x16x32_bf16 v[60:63], a[88:91], a[32:35], v[60:63]
s_add_u32 m0, s16, 0x0
s_waitcnt lgkmcnt(4)
s_waitcnt lgkmcnt(7)
v_mfma_f32_16x16x32_bf16 v[88:91], a[96:99], a[32:35], v[88:91]
buffer_load_dwordx4 v22, s[44:47], s20 offen lds
v_mfma_f32_16x16x32_bf16 v[88:91], a[100:103], a[48:51], v[88:91]
ds_read_b64_tr_b16 a[88:89], v13 offset:768
v_mfma_f32_16x16x32_bf16 v[96:99], a[100:103], a[52:55], v[96:99]
ds_read_b64_tr_b16 a[90:91], v13 offset:1792
v_mfma_f32_16x16x32_bf16 v[96:99], a[96:99], a[36:39], v[96:99]
ds_read_b64_tr_b16 a[92:93], v13 offset:8960
v_mfma_f32_16x16x32_bf16 v[104:107], a[96:99], a[40:43], v[104:107]
ds_read_b64_tr_b16 a[94:95], v13 offset:9984
s_add_u32 m0, s16, 0x400
v_mfma_f32_16x16x32_bf16 v[104:107], a[100:103], a[56:59], v[104:107]
buffer_load_dwordx4 v23, s[44:47], s20 offen lds
v_mfma_f32_16x16x32_bf16 v[112:115], a[100:103], a[60:63], v[112:115]
v_mfma_f32_16x16x32_bf16 v[112:115], a[96:99], a[44:47], v[112:115]
v_mfma_f32_16x16x32_bf16 v[116:119], a[104:107], a[44:47], v[116:119]
ds_read_b64_tr_b16 a[96:97], v14 offset:0
v_mfma_f32_16x16x32_bf16 v[116:119], a[108:111], a[60:63], v[116:119]
ds_read_b64_tr_b16 a[98:99], v14 offset:256
v_mfma_f32_16x16x32_bf16 v[108:111], a[108:111], a[56:59], v[108:111]
ds_read_b64_tr_b16 a[100:101], v14 offset:2048
s_add_u32 m0, s16, 0x800
v_mfma_f32_16x16x32_bf16 v[108:111], a[104:107], a[40:43], v[108:111]
buffer_load_dwordx4 v22, s[44:47], s21 offen lds
v_mfma_f32_16x16x32_bf16 v[100:103], a[104:107], a[36:39], v[100:103]
ds_read_b64_tr_b16 a[102:103], v14 offset:2304
v_mfma_f32_16x16x32_bf16 v[100:103], a[108:111], a[52:55], v[100:103]
v_mfma_f32_16x16x32_bf16 v[92:95], a[108:111], a[48:51], v[92:95]
v_mfma_f32_16x16x32_bf16 v[92:95], a[104:107], a[32:35], v[92:95]
s_add_u32 m0, s16, 0xc00
s_waitcnt lgkmcnt(4)
v_mfma_f32_16x16x32_bf16 v[120:123], a[80:83], a[32:35], v[120:123]
buffer_load_dwordx4 v23, s[44:47], s21 offen lds
v_mfma_f32_16x16x32_bf16 v[120:123], a[84:87], a[48:51], v[120:123]
ds_read_b64_tr_b16 a[104:105], v15 offset:0
v_mfma_f32_16x16x32_bf16 v[128:131], a[84:87], a[52:55], v[128:131]
ds_read_b64_tr_b16 a[106:107], v15 offset:256
v_mfma_f32_16x16x32_bf16 v[128:131], a[80:83], a[36:39], v[128:131]
ds_read_b64_tr_b16 a[108:109], v15 offset:2048
v_mfma_f32_16x16x32_bf16 v[136:139], a[80:83], a[40:43], v[136:139]
ds_read_b64_tr_b16 a[110:111], v15 offset:2304
v_mfma_f32_16x16x32_bf16 v[136:139], a[84:87], a[56:59], v[136:139]
s_add_u32 s8, s28, 0x5c00
v_mfma_f32_16x16x32_bf16 v[144:147], a[84:87], a[60:63], v[144:147]
buffer_store_dwordx4 a[240:243], v16, s[88:91], s8 offen sc1
v_mfma_f32_16x16x32_bf16 v[144:147], a[80:83], a[44:47], v[144:147]
v_mfma_f32_16x16x32_bf16 v[148:151], a[88:91], a[44:47], v[148:151]
ds_read_b64_tr_b16 a[80:81], v14 offset:4096
v_mfma_f32_16x16x32_bf16 v[148:151], a[92:95], a[60:63], v[148:151]
ds_read_b64_tr_b16 a[82:83], v14 offset:4352
v_mfma_f32_16x16x32_bf16 v[140:143], a[92:95], a[56:59], v[140:143]
ds_read_b64_tr_b16 a[84:85], v14 offset:6144
v_mfma_f32_16x16x32_bf16 v[140:143], a[88:91], a[40:43], v[140:143]
ds_read_b64_tr_b16 a[86:87], v14 offset:6400
s_add_u32 m0, s16, 0x1000
v_mfma_f32_16x16x32_bf16 v[132:135], a[88:91], a[36:39], v[132:135]
buffer_load_dwordx4 v22, s[44:47], s22 offen lds
v_mfma_f32_16x16x32_bf16 v[132:135], a[92:95], a[52:55], v[132:135]
v_mfma_f32_16x16x32_bf16 v[124:127], a[92:95], a[48:51], v[124:127]
v_mfma_f32_16x16x32_bf16 v[124:127], a[88:91], a[32:35], v[124:127]
s_waitcnt lgkmcnt(4)
v_mfma_f32_16x16x32_bf16 v[152:155], a[96:99], a[32:35], v[152:155]
ds_read_b64_tr_b16 a[88:89], v15 offset:4096
s_add_u32 m0, s16, 0x1400
v_mfma_f32_16x16x32_bf16 v[152:155], a[100:103], a[48:51], v[152:155]
buffer_load_dwordx4 v23, s[44:47], s22 offen lds
v_mfma_f32_16x16x32_bf16 v[160:163], a[100:103], a[52:55], v[160:163]
ds_read_b64_tr_b16 a[90:91], v15 offset:4352
v_mfma_f32_16x16x32_bf16 v[160:163], a[96:99], a[36:39], v[160:163]
ds_read_b64_tr_b16 a[92:93], v15 offset:6144
v_mfma_f32_16x16x32_bf16 v[168:171], a[96:99], a[40:43], v[168:171]
ds_read_b64_tr_b16 a[94:95], v15 offset:6400
v_mfma_f32_16x16x32_bf16 v[168:171], a[100:103], a[56:59], v[168:171]
v_mfma_f32_16x16x32_bf16 v[176:179], a[100:103], a[60:63], v[176:179]
s_add_u32 m0, s16, 0x1800
v_mfma_f32_16x16x32_bf16 v[176:179], a[96:99], a[44:47], v[176:179]
buffer_load_dwordx4 v22, s[44:47], s23 offen lds
v_mfma_f32_16x16x32_bf16 v[180:183], a[104:107], a[44:47], v[180:183]
ds_read_b64_tr_b16 a[96:97], v14 offset:8192
v_mfma_f32_16x16x32_bf16 v[180:183], a[108:111], a[60:63], v[180:183]
ds_read_b64_tr_b16 a[98:99], v14 offset:8448
v_mfma_f32_16x16x32_bf16 v[172:175], a[108:111], a[56:59], v[172:175]
ds_read_b64_tr_b16 a[100:101], v14 offset:10240
v_mfma_f32_16x16x32_bf16 v[172:175], a[104:107], a[40:43], v[172:175]
ds_read_b64_tr_b16 a[102:103], v14 offset:10496
s_add_u32 m0, s16, 0x1c00
v_mfma_f32_16x16x32_bf16 v[164:167], a[104:107], a[36:39], v[164:167]
buffer_load_dwordx4 v23, s[44:47], s23 offen lds
v_mfma_f32_16x16x32_bf16 v[164:167], a[108:111], a[52:55], v[164:167]
v_lshl_add_u32 v22, s42, 7, v22
v_lshl_add_u32 v23, s42, 7, v23
v_mfma_f32_16x16x32_bf16 v[156:159], a[108:111], a[48:51], v[156:159]
v_mfma_f32_16x16x32_bf16 v[156:159], a[104:107], a[32:35], v[156:159]
s_waitcnt lgkmcnt(4)
v_mfma_f32_16x16x32_bf16 v[184:187], a[80:83], a[32:35], v[184:187]
ds_read_b64_tr_b16 a[104:105], v15 offset:8192
v_mfma_f32_16x16x32_bf16 v[184:187], a[84:87], a[48:51], v[184:187]
ds_read_b64_tr_b16 a[106:107], v15 offset:8448
s_add_u32 s8, s28, 0x9c00
v_mfma_f32_16x16x32_bf16 v[192:195], a[84:87], a[52:55], v[192:195]
buffer_store_dwordx4 a[248:251], v16, s[88:91], s8 offen sc1
v_mfma_f32_16x16x32_bf16 v[192:195], a[80:83], a[36:39], v[192:195]
ds_read_b64_tr_b16 a[108:109], v15 offset:10240
v_mfma_f32_16x16x32_bf16 v[200:203], a[80:83], a[40:43], v[200:203]
ds_read_b64_tr_b16 a[110:111], v15 offset:10496
v_add_u32 v12, 0xffff0000, v12
v_mfma_f32_16x16x32_bf16 v[200:203], a[84:87], a[56:59], v[200:203]
v_add_u32 v13, 0xffff0000, v13
v_add_u32 v14, 0xffff0000, v14
v_mfma_f32_16x16x32_bf16 v[208:211], a[84:87], a[60:63], v[208:211]
v_add_u32 v15, 0xffff0000, v15
v_mfma_f32_16x16x32_bf16 v[208:211], a[80:83], a[44:47], v[208:211]
v_mfma_f32_16x16x32_bf16 v[212:215], a[88:91], a[44:47], v[212:215]
s_waitcnt vmcnt(29) lgkmcnt(0)
v_mfma_f32_16x16x32_bf16 v[212:215], a[92:95], a[60:63], v[212:215]
s_barrier
s_add_u32 m0, s17, 0x10000
v_mfma_f32_16x16x32_bf16 v[204:207], a[92:95], a[56:59], v[204:207]
buffer_load_dwordx4 v5, s[52:55], 0 offen lds
v_mfma_f32_16x16x32_bf16 v[204:207], a[88:91], a[40:43], v[204:207]
ds_read_b64_tr_b16 a[80:81], v12 offset:0
v_mfma_f32_16x16x32_bf16 v[196:199], a[88:91], a[36:39], v[196:199]
ds_read_b64_tr_b16 a[82:83], v12 offset:1024
v_mfma_f32_16x16x32_bf16 v[196:199], a[92:95], a[52:55], v[196:199]
ds_read_b64_tr_b16 a[84:85], v12 offset:8192
v_mfma_f32_16x16x32_bf16 v[188:191], a[92:95], a[48:51], v[188:191]
ds_read_b64_tr_b16 a[86:87], v12 offset:9216
v_mfma_f32_16x16x32_bf16 v[188:191], a[88:91], a[32:35], v[188:191]
s_add_u32 m0, s17, 0x10400
s_waitcnt lgkmcnt(4)
v_mfma_f32_16x16x32_bf16 v[216:219], a[32:35], a[96:99], v[216:219]
buffer_load_dwordx4 v5, s[52:55], s13 offen lds
v_mfma_f32_16x16x32_bf16 v[216:219], a[48:51], a[100:103], v[216:219]
ds_read_b64_tr_b16 a[88:89], v13 offset:0
v_mfma_f32_16x16x32_bf16 v[224:227], a[52:55], a[100:103], v[224:227]
ds_read_b64_tr_b16 a[90:91], v13 offset:1024
v_mfma_f32_16x16x32_bf16 v[224:227], a[36:39], a[96:99], v[224:227]
ds_read_b64_tr_b16 a[92:93], v13 offset:8192
v_mfma_f32_16x16x32_bf16 v[232:235], a[40:43], a[96:99], v[232:235]
ds_read_b64_tr_b16 a[94:95], v13 offset:9216
v_mfma_f32_16x16x32_bf16 v[232:235], a[56:59], a[100:103], v[232:235]
v_mfma_f32_16x16x32_bf16 v[240:243], a[60:63], a[100:103], v[240:243]
s_add_u32 m0, s17, 0x10800
v_mfma_f32_16x16x32_bf16 v[240:243], a[44:47], a[96:99], v[240:243]
buffer_load_dwordx4 v6, s[52:55], 0 offen lds
v_mfma_f32_16x16x32_bf16 v[244:247], a[44:47], a[104:107], v[244:247]
ds_read_b64_tr_b16 a[96:97], v12 offset:256
v_mfma_f32_16x16x32_bf16 v[244:247], a[60:63], a[108:111], v[244:247]
ds_read_b64_tr_b16 a[98:99], v12 offset:1280
v_mfma_f32_16x16x32_bf16 v[236:239], a[56:59], a[108:111], v[236:239]
ds_read_b64_tr_b16 a[100:101], v12 offset:8448
v_mfma_f32_16x16x32_bf16 v[236:239], a[40:43], a[104:107], v[236:239]
ds_read_b64_tr_b16 a[102:103], v12 offset:9472
v_mfma_f32_16x16x32_bf16 v[228:231], a[36:39], a[104:107], v[228:231]
v_mfma_f32_16x16x32_bf16 v[228:231], a[52:55], a[108:111], v[228:231]
s_add_u32 m0, s17, 0x10c00
v_mfma_f32_16x16x32_bf16 v[220:223], a[48:51], a[108:111], v[220:223]
buffer_load_dwordx4 v6, s[52:55], s13 offen lds
v_mfma_f32_16x16x32_bf16 v[220:223], a[32:35], a[104:107], v[220:223]
s_waitcnt lgkmcnt(4)
L_S18:
v_mfma_f32_16x16x32_bf16 v[24:27], a[80:83], a[0:3], v[24:27]
ds_read_b64_tr_b16 a[104:105], v13 offset:256
s_waitcnt vmcnt(24)
v_mfma_f32_16x16x32_bf16 v[24:27], a[84:87], a[16:19], v[24:27]
ds_read_b64_tr_b16 a[106:107], v13 offset:1280
L_padA9:
s_cmp_eq_u32 s95, 1
s_cbranch_scc1 L_hopA_ret
v_mfma_f32_16x16x32_bf16 v[32:35], a[84:87], a[20:23], v[32:35]
ds_read_b64_tr_b16 a[108:109], v13 offset:8448
v_mfma_f32_16x16x32_bf16 v[32:35], a[80:83], a[4:7], v[32:35]
ds_read_b64_tr_b16 a[110:111], v13 offset:9472
v_mfma_f32_16x16x32_bf16 v[40:43], a[80:83], a[8:11], v[40:43]
ds_read_b128 a[32:35], v8 offset:32768
s_add_u32 m0, s18, 0x14000
v_mfma_f32_16x16x32_bf16 v[40:43], a[84:87], a[24:27], v[40:43]
buffer_load_dwordx4 v7, s[68:71], 0 offen lds
v_mfma_f32_16x16x32_bf16 v[48:51], a[84:87], a[28:31], v[48:51]
ds_read_b128 a[48:51], v9 offset:32768
v_mfma_f32_16x16x32_bf16 v[48:51], a[80:83], a[12:15], v[48:51]
ds_read_b128 a[36:39], v8 offset:34816
v_mfma_f32_16x16x32_bf16 v[52:55], a[88:91], a[12:15], v[52:55]
ds_read_b64_tr_b16 a[80:81], v12 offset:512
v_mfma_f32_16x16x32_bf16 v[52:55], a[92:95], a[28:31], v[52:55]
ds_read_b64_tr_b16 a[82:83], v12 offset:1536
v_mfma_f32_16x16x32_bf16 v[44:47], a[92:95], a[24:27], v[44:47]
ds_read_b64_tr_b16 a[84:85], v12 offset:8704
v_mfma_f32_16x16x32_bf16 v[44:47], a[88:91], a[8:11], v[44:47]
buffer_load_dwordx4 a[128:131], v16, s[44:47], s100 offen offset:0
v_mfma_f32_16x16x32_bf16 v[36:39], a[88:91], a[4:7], v[36:39]
ds_read_b64_tr_b16 a[86:87], v12 offset:9728
v_mfma_f32_16x16x32_bf16 v[36:39], a[92:95], a[20:23], v[36:39]
ds_read_b128 a[52:55], v9 offset:34816
v_mfma_f32_16x16x32_bf16 v[28:31], a[92:95], a[16:19], v[28:31]
ds_read_b128 a[40:43], v8 offset:36864
v_mfma_f32_16x16x32_bf16 v[28:31], a[88:91], a[0:3], v[28:31]
ds_read_b128 a[56:59], v9 offset:36864
s_waitcnt lgkmcnt(10)
v_mfma_f32_16x16x32_bf16 v[56:59], a[96:99], a[0:3], v[56:59]
ds_read_b64_tr_b16 a[88:89], v13 offset:512
v_mfma_f32_16x16x32_bf16 v[56:59], a[100:103], a[16:19], v[56:59]
ds_read_b64_tr_b16 a[90:91], v13 offset:1536
s_add_u32 m0, s18, 0x15000
v_mfma_f32_16x16x32_bf16 v[64:67], a[100:103], a[20:23], v[64:67]
buffer_load_dwordx4 v7, s[68:71], s25 offen lds
v_mfma_f32_16x16x32_bf16 v[64:67], a[96:99], a[4:7], v[64:67]
ds_read_b64_tr_b16 a[92:93], v13 offset:8704
v_mfma_f32_16x16x32_bf16 v[72:75], a[96:99], a[8:11], v[72:75]
ds_read_b64_tr_b16 a[94:95], v13 offset:9728
v_mfma_f32_16x16x32_bf16 v[72:75], a[100:103], a[24:27], v[72:75]
ds_read_b128 a[44:47], v8 offset:38912
v_mfma_f32_16x16x32_bf16 v[80:83], a[100:103], a[28:31], v[80:83]
ds_read_b128 a[60:63], v9 offset:38912
v_mfma_f32_16x16x32_bf16 v[80:83], a[96:99], a[12:15], v[80:83]
v_mfma_f32_16x16x32_bf16 v[84:87], a[104:107], a[12:15], v[84:87]
ds_read_b64_tr_b16 a[96:97], v12 offset:768
s_add_u32 m0, s18, 0x16000
v_mfma_f32_16x16x32_bf16 v[84:87], a[108:111], a[28:31], v[84:87]
buffer_load_dwordx4 v7, s[68:71], s26 offen lds
v_mfma_f32_16x16x32_bf16 v[76:79], a[108:111], a[24:27], v[76:79]
ds_read_b64_tr_b16 a[98:99], v12 offset:1792
v_lshl_add_u32 v5, s42, 19, v5
v_mfma_f32_16x16x32_bf16 v[76:79], a[104:107], a[8:11], v[76:79]
ds_read_b64_tr_b16 a[100:101], v12 offset:8960
v_lshl_add_u32 v6, s42, 19, v6
v_mfma_f32_16x16x32_bf16 v[68:71], a[104:107], a[4:7], v[68:71]
ds_read_b64_tr_b16 a[102:103], v12 offset:9984
v_lshl_add_u32 v7, s42, 18, v7
v_mfma_f32_16x16x32_bf16 v[68:71], a[108:111], a[20:23], v[68:71]
v_lshl_add_u32 v7, s42, 17, v7
v_mfma_f32_16x16x32_bf16 v[60:63], a[108:111], a[16:19], v[60:63]
v_mfma_f32_16x16x32_bf16 v[60:63], a[104:107], a[0:3], v[60:63]
s_add_u32 m0, s16, 0x8000
s_waitcnt lgkmcnt(4)
s_waitcnt lgkmcnt(6)
v_mfma_f32_16x16x32_bf16 v[88:91], a[80:83], a[0:3], v[88:91]
buffer_load_dwordx4 v22, s[44:47], s20 offen lds
v_mfma_f32_16x16x32_bf16 v[88:91], a[84:87], a[16:19], v[88:91]
ds_read_b64_tr_b16 a[104:105], v13 offset:768
v_mfma_f32_16x16x32_bf16 v[96:99], a[84:87], a[20:23], v[96:99]
ds_read_b64_tr_b16 a[106:107], v13 offset:1792
v_mfma_f32_16x16x32_bf16 v[96:99], a[80:83], a[4:7], v[96:99]
ds_read_b64_tr_b16 a[108:109], v13 offset:8960
v_mfma_f32_16x16x32_bf16 v[104:107], a[80:83], a[8:11], v[104:107]
ds_read_b64_tr_b16 a[110:111], v13 offset:9984
s_add_u32 m0, s16, 0x8400
v_mfma_f32_16x16x32_bf16 v[104:107], a[84:87], a[24:27], v[104:107]
buffer_load_dwordx4 v23, s[44:47], s20 offen lds
v_mfma_f32_16x16x32_bf16 v[112:115], a[84:87], a[28:31], v[112:115]
v_mfma_f32_16x16x32_bf16 v[112:115], a[80:83], a[12:15], v[112:115]
v_mfma_f32_16x16x32_bf16 v[116:119], a[88:91], a[12:15], v[116:119]
ds_read_b64_tr_b16 a[80:81], v14 offset:0
v_mfma_f32_16x16x32_bf16 v[116:119], a[92:95], a[28:31], v[116:119]
ds_read_b64_tr_b16 a[82:83], v14 offset:256
v_mfma_f32_16x16x32_bf16 v[108:111], a[92:95], a[24:27], v[108:111]
ds_read_b64_tr_b16 a[84:85], v14 offset:2048
s_add_u32 m0, s16, 0x8800
v_mfma_f32_16x16x32_bf16 v[108:111], a[88:91], a[8:11], v[108:111]
buffer_load_dwordx4 v22, s[44:47], s21 offen lds
v_mfma_f32_16x16x32_bf16 v[100:103], a[88:91], a[4:7], v[100:103]
ds_read_b64_tr_b16 a[86:87], v14 offset:2304
v_mfma_f32_16x16x32_bf16 v[100:103], a[92:95], a[20:23], v[100:103]
v_mfma_f32_16x16x32_bf16 v[92:95], a[92:95], a[16:19], v[92:95]
v_mfma_f32_16x16x32_bf16 v[92:95], a[88:91], a[0:3], v[92:95]
s_waitcnt lgkmcnt(4)
v_mfma_f32_16x16x32_bf16 v[120:123], a[96:99], a[0:3], v[120:123]
buffer_load_dwordx4 a[132:135], v16, s[44:47], s100 offen offset:1024
v_mfma_f32_16x16x32_bf16 v[120:123], a[100:103], a[16:19], v[120:123]
ds_read_b64_tr_b16 a[88:89], v15 offset:0
v_mfma_f32_16x16x32_bf16 v[128:131], a[100:103], a[20:23], v[128:131]
ds_read_b64_tr_b16 a[90:91], v15 offset:256
v_mfma_f32_16x16x32_bf16 v[128:131], a[96:99], a[4:7], v[128:131]
ds_read_b64_tr_b16 a[92:93], v15 offset:2048
v_mfma_f32_16x16x32_bf16 v[136:139], a[96:99], a[8:11], v[136:139]
ds_read_b64_tr_b16 a[94:95], v15 offset:2304
v_mfma_f32_16x16x32_bf16 v[136:139], a[100:103], a[24:27], v[136:139]
s_add_u32 m0, s16, 0x8c00
v_mfma_f32_16x16x32_bf16 v[144:147], a[100:103], a[28:31], v[144:147]
buffer_load_dwordx4 v23, s[44:47], s21 offen lds
v_mfma_f32_16x16x32_bf16 v[144:147], a[96:99], a[12:15], v[144:147]
v_mfma_f32_16x16x32_bf16 v[148:151], a[104:107], a[12:15], v[148:151]
ds_read_b64_tr_b16 a[96:97], v14 offset:4096
v_mfma_f32_16x16x32_bf16 v[148:151], a[108:111], a[28:31], v[148:151]
ds_read_b64_tr_b16 a[98:99], v14 offset:4352
v_mfma_f32_16x16x32_bf16 v[140:143], a[108:111], a[24:27], v[140:143]
ds_read_b64_tr_b16 a[100:101], v14 offset:6144
v_mfma_f32_16x16x32_bf16 v[140:143], a[104:107], a[8:11], v[140:143]
ds_read_b64_tr_b16 a[102:103], v14 offset:6400
s_add_u32 m0, s16, 0x9000
v_mfma_f32_16x16x32_bf16 v[132:135], a[104:107], a[4:7], v[132:135]
buffer_load_dwordx4 v22, s[44:47], s22 offen lds
v_mfma_f32_16x16x32_bf16 v[132:135], a[108:111], a[20:23], v[132:135]
v_mfma_f32_16x16x32_bf16 v[124:127], a[108:111], a[16:19], v[124:127]
v_mfma_f32_16x16x32_bf16 v[124:127], a[104:107], a[0:3], v[124:127]
s_waitcnt lgkmcnt(4)
v_mfma_f32_16x16x32_bf16 v[152:155], a[80:83], a[0:3], v[152:155]
ds_read_b64_tr_b16 a[104:105], v15 offset:4096
s_add_u32 m0, s16, 0x9400
v_mfma_f32_16x16x32_bf16 v[152:155], a[84:87], a[16:19], v[152:155]
buffer_load_dwordx4 v23, s[44:47], s22 offen lds
v_mfma_f32_16x16x32_bf16 v[160:163], a[84:87], a[20:23], v[160:163]
ds_read_b64_tr_b16 a[106:107], v15 offset:4352
v_mfma_f32_16x16x32_bf16 v[160:163], a[80:83], a[4:7], v[160:163]
ds_read_b64_tr_b16 a[108:109], v15 offset:6144
v_mfma_f32_16x16x32_bf16 v[168:171], a[80:83], a[8:11], v[168:171]
ds_read_b64_tr_b16 a[110:111], v15 offset:6400
v_mfma_f32_16x16x32_bf16 v[168:171], a[84:87], a[24:27], v[168:171]
v_mfma_f32_16x16x32_bf16 v[176:179], a[84:87], a[28:31], v[176:179]
s_add_u32 m0, s16, 0x9800
v_mfma_f32_16x16x32_bf16 v[176:179], a[80:83], a[12:15], v[176:179]
buffer_load_dwordx4 v22, s[44:47], s23 offen lds
v_mfma_f32_16x16x32_bf16 v[180:183], a[88:91], a[12:15], v[180:183]
ds_read_b64_tr_b16 a[80:81], v14 offset:8192
v_mfma_f32_16x16x32_bf16 v[180:183], a[92:95], a[28:31], v[180:183]
ds_read_b64_tr_b16 a[82:83], v14 offset:8448
v_mfma_f32_16x16x32_bf16 v[172:175], a[92:95], a[24:27], v[172:175]
ds_read_b64_tr_b16 a[84:85], v14 offset:10240
v_mfma_f32_16x16x32_bf16 v[172:175], a[88:91], a[8:11], v[172:175]
ds_read_b64_tr_b16 a[86:87], v14 offset:10496
s_add_u32 m0, s16, 0x9c00
v_mfma_f32_16x16x32_bf16 v[164:167], a[88:91], a[4:7], v[164:167]
buffer_load_dwordx4 v23, s[44:47], s23 offen lds
v_mfma_f32_16x16x32_bf16 v[164:167], a[92:95], a[20:23], v[164:167]
v_lshl_add_u32 v22, s42, 7, v22
v_lshl_add_u32 v23, s42, 7, v23
v_mfma_f32_16x16x32_bf16 v[156:159], a[92:95], a[16:19], v[156:159]
v_mfma_f32_16x16x32_bf16 v[156:159], a[88:91], a[0:3], v[156:159]
s_waitcnt lgkmcnt(4)
v_mfma_f32_16x16x32_bf16 v[184:187], a[96:99], a[0:3], v[184:187]
ds_read_b64_tr_b16 a[88:89], v15 offset:8192
v_mfma_f32_16x16x32_bf16 v[184:187], a[100:103], a[16:19], v[184:187]
ds_read_b64_tr_b16 a[90:91], v15 offset:8448
v_mfma_f32_16x16x32_bf16 v[192:195], a[100:103], a[20:23], v[192:195]
buffer_load_dwordx4 a[136:139], v16, s[44:47], s100 offen offset:2048
v_mfma_f32_16x16x32_bf16 v[192:195], a[96:99], a[4:7], v[192:195]
ds_read_b64_tr_b16 a[92:93], v15 offset:10240
v_mfma_f32_16x16x32_bf16 v[200:203], a[96:99], a[8:11], v[200:203]
ds_read_b64_tr_b16 a[94:95], v15 offset:10496
v_add_u32 v12, 0x8000, v12
v_mfma_f32_16x16x32_bf16 v[200:203], a[100:103], a[24:27], v[200:203]
v_add_u32 v13, 0x8000, v13
v_add_u32 v14, 0x8000, v14
v_mfma_f32_16x16x32_bf16 v[208:211], a[100:103], a[28:31], v[208:211]
v_add_u32 v15, 0x8000, v15
v_mfma_f32_16x16x32_bf16 v[208:211], a[96:99], a[12:15], v[208:211]
v_mfma_f32_16x16x32_bf16 v[212:215], a[104:107], a[12:15], v[212:215]
s_waitcnt vmcnt(18) lgkmcnt(0)
v_mfma_f32_16x16x32_bf16 v[212:215], a[108:111], a[28:31], v[212:215]
s_barrier
s_add_u32 m0, s17, 0x0
s_cmp_lg_u32 s4, 0
s_cbranch_scc1 L_sig_kv
v_mov_b32 v20, 1
s_mov_b64 exec, 1
buffer_atomic_add v20, off, s[84:87], s10 sc1
s_mov_b64 exec, -1
L_sig_kv:
v_mfma_f32_16x16x32_bf16 v[204:207], a[108:111], a[24:27], v[204:207]
buffer_load_dwordx4 v5, s[52:55], 0 offen lds
v_mfma_f32_16x16x32_bf16 v[204:207], a[104:107], a[8:11], v[204:207]
ds_read_b64_tr_b16 a[96:97], v12 offset:0
v_mfma_f32_16x16x32_bf16 v[196:199], a[104:107], a[4:7], v[196:199]
ds_read_b64_tr_b16 a[98:99], v12 offset:1024
v_mfma_f32_16x16x32_bf16 v[196:199], a[108:111], a[20:23], v[196:199]
ds_read_b64_tr_b16 a[100:101], v12 offset:8192
v_mfma_f32_16x16x32_bf16 v[188:191], a[108:111], a[16:19], v[188:191]
ds_read_b64_tr_b16 a[102:103], v12 offset:9216
v_mfma_f32_16x16x32_bf16 v[188:191], a[104:107], a[0:3], v[188:191]
s_add_u32 m0, s17, 0x400
s_waitcnt lgkmcnt(4)
v_mfma_f32_16x16x32_bf16 v[216:219], a[0:3], a[80:83], v[216:219]
buffer_load_dwordx4 v5, s[52:55], s13 offen lds
v_mfma_f32_16x16x32_bf16 v[216:219], a[16:19], a[84:87], v[216:219]
ds_read_b64_tr_b16 a[104:105], v13 offset:0
v_mfma_f32_16x16x32_bf16 v[224:227], a[20:23], a[84:87], v[224:227]
ds_read_b64_tr_b16 a[106:107], v13 offset:1024
v_mfma_f32_16x16x32_bf16 v[224:227], a[4:7], a[80:83], v[224:227]
ds_read_b64_tr_b16 a[108:109], v13 offset:8192
v_mfma_f32_16x16x32_bf16 v[232:235], a[8:11], a[80:83], v[232:235]
ds_read_b64_tr_b16 a[110:111], v13 offset:9216
v_mfma_f32_16x16x32_bf16 v[232:235], a[24:27], a[84:87], v[232:235]
v_mfma_f32_16x16x32_bf16 v[240:243], a[28:31], a[84:87], v[240:243]
s_add_u32 m0, s17, 0x800
v_mfma_f32_16x16x32_bf16 v[240:243], a[12:15], a[80:83], v[240:243]
buffer_load_dwordx4 v6, s[52:55], 0 offen lds
v_mfma_f32_16x16x32_bf16 v[244:247], a[12:15], a[88:91], v[244:247]
ds_read_b64_tr_b16 a[80:81], v12 offset:256
v_mfma_f32_16x16x32_bf16 v[244:247], a[28:31], a[92:95], v[244:247]
ds_read_b64_tr_b16 a[82:83], v12 offset:1280
v_mfma_f32_16x16x32_bf16 v[236:239], a[24:27], a[92:95], v[236:239]
ds_read_b64_tr_b16 a[84:85], v12 offset:8448
v_mfma_f32_16x16x32_bf16 v[236:239], a[8:11], a[88:91], v[236:239]
ds_read_b64_tr_b16 a[86:87], v12 offset:9472
v_mfma_f32_16x16x32_bf16 v[228:231], a[4:7], a[88:91], v[228:231]
v_mfma_f32_16x16x32_bf16 v[228:231], a[20:23], a[92:95], v[228:231]
s_add_u32 m0, s17, 0xc00
v_mfma_f32_16x16x32_bf16 v[220:223], a[16:19], a[92:95], v[220:223]
buffer_load_dwordx4 v6, s[52:55], s13 offen lds
v_mfma_f32_16x16x32_bf16 v[220:223], a[0:3], a[88:91], v[220:223]
s_waitcnt lgkmcnt(4)
L_S19:
v_mfma_f32_16x16x32_bf16 v[24:27], a[96:99], a[32:35], v[24:27]
ds_read_b64_tr_b16 a[88:89], v13 offset:256
s_waitcnt vmcnt(23)
v_mfma_f32_16x16x32_bf16 v[24:27], a[100:103], a[48:51], v[24:27]
ds_read_b64_tr_b16 a[90:91], v13 offset:1280
v_mfma_f32_16x16x32_bf16 v[32:35], a[100:103], a[52:55], v[32:35]
ds_read_b64_tr_b16 a[92:93], v13 offset:8448
v_mfma_f32_16x16x32_bf16 v[32:35], a[96:99], a[36:39], v[32:35]
ds_read_b64_tr_b16 a[94:95], v13 offset:9472
v_mfma_f32_16x16x32_bf16 v[40:43], a[96:99], a[40:43], v[40:43]
ds_read_b128 a[0:3], v8 offset:0
s_add_u32 m0, s18, 0x4000
v_mfma_f32_16x16x32_bf16 v[40:43], a[100:103], a[56:59], v[40:43]
buffer_load_dwordx4 v7, s[68:71], 0 offen lds
v_mfma_f32_16x16x32_bf16 v[48:51], a[100:103], a[60:63], v[48:51]
ds_read_b128 a[16:19], v9 offset:0
v_mfma_f32_16x16x32_bf16 v[48:51], a[96:99], a[44:47], v[48:51]
ds_read_b128 a[4:7], v8 offset:2048
v_mfma_f32_16x16x32_bf16 v[52:55], a[104:107], a[44:47], v[52:55]
ds_read_b64_tr_b16 a[96:97], v12 offset:512
v_mfma_f32_16x16x32_bf16 v[52:55], a[108:111], a[60:63], v[52:55]
ds_read_b64_tr_b16 a[98:99], v12 offset:1536
v_mfma_f32_16x16x32_bf16 v[44:47], a[108:111], a[56:59], v[44:47]
ds_read_b64_tr_b16 a[100:101], v12 offset:8704
v_mfma_f32_16x16x32_bf16 v[44:47], a[104:107], a[40:43], v[44:47]
buffer_load_dwordx4 a[140:143], v16, s[44:47], s100 offen offset:3072
v_mfma_f32_16x16x32_bf16 v[36:39], a[104:107], a[36:39], v[36:39]
ds_read_b64_tr_b16 a[102:103], v12 offset:9728
v_mfma_f32_16x16x32_bf16 v[36:39], a[108:111], a[52:55], v[36:39]
ds_read_b128 a[20:23], v9 offset:2048
v_mfma_f32_16x16x32_bf16 v[28:31], a[108:111], a[48:51], v[28:31]
ds_read_b128 a[8:11], v8 offset:4096
v_mfma_f32_16x16x32_bf16 v[28:31], a[104:107], a[32:35], v[28:31]
ds_read_b128 a[24:27], v9 offset:4096
s_waitcnt lgkmcnt(10)
v_mfma_f32_16x16x32_bf16 v[56:59], a[80:83], a[32:35], v[56:59]
ds_read_b64_tr_b16 a[104:105], v13 offset:512
v_mfma_f32_16x16x32_bf16 v[56:59], a[84:87], a[48:51], v[56:59]
ds_read_b64_tr_b16 a[106:107], v13 offset:1536
s_add_u32 m0, s18, 0x5000
v_mfma_f32_16x16x32_bf16 v[64:67], a[84:87], a[52:55], v[64:67]
buffer_load_dwordx4 v7, s[68:71], s25 offen lds
v_mfma_f32_16x16x32_bf16 v[64:67], a[80:83], a[36:39], v[64:67]
ds_read_b64_tr_b16 a[108:109], v13 offset:8704
v_mfma_f32_16x16x32_bf16 v[72:75], a[80:83], a[40:43], v[72:75]
ds_read_b64_tr_b16 a[110:111], v13 offset:9728
v_mfma_f32_16x16x32_bf16 v[72:75], a[84:87], a[56:59], v[72:75]
ds_read_b128 a[12:15], v8 offset:6144
v_mfma_f32_16x16x32_bf16 v[80:83], a[84:87], a[60:63], v[80:83]
ds_read_b128 a[28:31], v9 offset:6144
v_mfma_f32_16x16x32_bf16 v[80:83], a[80:83], a[44:47], v[80:83]
v_mfma_f32_16x16x32_bf16 v[84:87], a[88:91], a[44:47], v[84:87]
ds_read_b64_tr_b16 a[80:81], v12 offset:768
s_add_u32 m0, s18, 0x6000
v_mfma_f32_16x16x32_bf16 v[84:87], a[92:95], a[60:63], v[84:87]
buffer_load_dwordx4 v7, s[68:71], s26 offen lds
v_mfma_f32_16x16x32_bf16 v[76:79], a[92:95], a[56:59], v[76:79]
ds_read_b64_tr_b16 a[82:83], v12 offset:1792
v_lshl_add_u32 v5, s42, 19, v5
v_mfma_f32_16x16x32_bf16 v[76:79], a[88:91], a[40:43], v[76:79]
ds_read_b64_tr_b16 a[84:85], v12 offset:8960
v_lshl_add_u32 v6, s42, 19, v6
v_mfma_f32_16x16x32_bf16 v[68:71], a[88:91], a[36:39], v[68:71]
ds_read_b64_tr_b16 a[86:87], v12 offset:9984
v_lshl_add_u32 v7, s42, 18, v7
v_mfma_f32_16x16x32_bf16 v[68:71], a[92:95], a[52:55], v[68:71]
v_lshl_add_u32 v7, s42, 17, v7
v_mfma_f32_16x16x32_bf16 v[60:63], a[92:95], a[48:51], v[60:63]
v_mfma_f32_16x16x32_bf16 v[60:63], a[88:91], a[32:35], v[60:63]
s_add_u32 m0, s16, 0x0
s_waitcnt lgkmcnt(4)
s_waitcnt lgkmcnt(6)
v_mfma_f32_16x16x32_bf16 v[88:91], a[96:99], a[32:35], v[88:91]
buffer_load_dwordx4 v22, s[44:47], s20 offen lds
v_mfma_f32_16x16x32_bf16 v[88:91], a[100:103], a[48:51], v[88:91]
ds_read_b64_tr_b16 a[88:89], v13 offset:768
v_mfma_f32_16x16x32_bf16 v[96:99], a[100:103], a[52:55], v[96:99]
ds_read_b64_tr_b16 a[90:91], v13 offset:1792
v_mfma_f32_16x16x32_bf16 v[96:99], a[96:99], a[36:39], v[96:99]
ds_read_b64_tr_b16 a[92:93], v13 offset:8960
v_mfma_f32_16x16x32_bf16 v[104:107], a[96:99], a[40:43], v[104:107]
ds_read_b64_tr_b16 a[94:95], v13 offset:9984
s_add_u32 m0, s16, 0x400
v_mfma_f32_16x16x32_bf16 v[104:107], a[100:103], a[56:59], v[104:107]
buffer_load_dwordx4 v23, s[44:47], s20 offen lds
v_mfma_f32_16x16x32_bf16 v[112:115], a[100:103], a[60:63], v[112:115]
v_mfma_f32_16x16x32_bf16 v[112:115], a[96:99], a[44:47], v[112:115]
v_mfma_f32_16x16x32_bf16 v[116:119], a[104:107], a[44:47], v[116:119]
ds_read_b64_tr_b16 a[96:97], v14 offset:0
v_mfma_f32_16x16x32_bf16 v[116:119], a[108:111], a[60:63], v[116:119]
ds_read_b64_tr_b16 a[98:99], v14 offset:256
v_mfma_f32_16x16x32_bf16 v[108:111], a[108:111], a[56:59], v[108:111]
ds_read_b64_tr_b16 a[100:101], v14 offset:2048
s_add_u32 m0, s16, 0x800
v_mfma_f32_16x16x32_bf16 v[108:111], a[104:107], a[40:43], v[108:111]
buffer_load_dwordx4 v22, s[44:47], s21 offen lds
v_mfma_f32_16x16x32_bf16 v[100:103], a[104:107], a[36:39], v[100:103]
ds_read_b64_tr_b16 a[102:103], v14 offset:2304
v_mfma_f32_16x16x32_bf16 v[100:103], a[108:111], a[52:55], v[100:103]
v_mfma_f32_16x16x32_bf16 v[92:95], a[108:111], a[48:51], v[92:95]
v_mfma_f32_16x16x32_bf16 v[92:95], a[104:107], a[32:35], v[92:95]
s_waitcnt lgkmcnt(4)
v_mfma_f32_16x16x32_bf16 v[120:123], a[80:83], a[32:35], v[120:123]
buffer_load_dwordx4 a[144:147], v16, s[76:79], 0 offen offset:0
v_mfma_f32_16x16x32_bf16 v[120:123], a[84:87], a[48:51], v[120:123]
ds_read_b64_tr_b16 a[104:105], v15 offset:0
v_mfma_f32_16x16x32_bf16 v[128:131], a[84:87], a[52:55], v[128:131]
ds_read_b64_tr_b16 a[106:107], v15 offset:256
v_mfma_f32_16x16x32_bf16 v[128:131], a[80:83], a[36:39], v[128:131]
ds_read_b64_tr_b16 a[108:109], v15 offset:2048
v_mfma_f32_16x16x32_bf16 v[136:139], a[80:83], a[40:43], v[136:139]
ds_read_b64_tr_b16 a[110:111], v15 offset:2304
v_mfma_f32_16x16x32_bf16 v[136:139], a[84:87], a[56:59], v[136:139]
s_add_u32 m0, s16, 0xc00
v_mfma_f32_16x16x32_bf16 v[144:147], a[84:87], a[60:63], v[144:147]
buffer_load_dwordx4 v23, s[44:47], s21 offen lds
v_mfma_f32_16x16x32_bf16 v[144:147], a[80:83], a[44:47], v[144:147]
v_mfma_f32_16x16x32_bf16 v[148:151], a[88:91], a[44:47], v[148:151]
ds_read_b64_tr_b16 a[80:81], v14 offset:4096
v_mfma_f32_16x16x32_bf16 v[148:151], a[92:95], a[60:63], v[148:151]
ds_read_b64_tr_b16 a[82:83], v14 offset:4352
v_mfma_f32_16x16x32_bf16 v[140:143], a[92:95], a[56:59], v[140:143]
ds_read_b64_tr_b16 a[84:85], v14 offset:6144
v_mfma_f32_16x16x32_bf16 v[140:143], a[88:91], a[40:43], v[140:143]
ds_read_b64_tr_b16 a[86:87], v14 offset:6400
s_add_u32 m0, s16, 0x1000
v_mfma_f32_16x16x32_bf16 v[132:135], a[88:91], a[36:39], v[132:135]
buffer_load_dwordx4 v22, s[44:47], s22 offen lds
v_mfma_f32_16x16x32_bf16 v[132:135], a[92:95], a[52:55], v[132:135]
v_mfma_f32_16x16x32_bf16 v[124:127], a[92:95], a[48:51], v[124:127]
v_mfma_f32_16x16x32_bf16 v[124:127], a[88:91], a[32:35], v[124:127]
s_waitcnt lgkmcnt(4)
v_mfma_f32_16x16x32_bf16 v[152:155], a[96:99], a[32:35], v[152:155]
ds_read_b64_tr_b16 a[88:89], v15 offset:4096
s_add_u32 m0, s16, 0x1400
v_mfma_f32_16x16x32_bf16 v[152:155], a[100:103], a[48:51], v[152:155]
buffer_load_dwordx4 v23, s[44:47], s22 offen lds
v_mfma_f32_16x16x32_bf16 v[160:163], a[100:103], a[52:55], v[160:163]
ds_read_b64_tr_b16 a[90:91], v15 offset:4352
v_mfma_f32_16x16x32_bf16 v[160:163], a[96:99], a[36:39], v[160:163]
ds_read_b64_tr_b16 a[92:93], v15 offset:6144
v_mfma_f32_16x16x32_bf16 v[168:171], a[96:99], a[40:43], v[168:171]
ds_read_b64_tr_b16 a[94:95], v15 offset:6400
v_mfma_f32_16x16x32_bf16 v[168:171], a[100:103], a[56:59], v[168:171]
v_mfma_f32_16x16x32_bf16 v[176:179], a[100:103], a[60:63], v[176:179]
s_add_u32 m0, s16, 0x1800
v_mfma_f32_16x16x32_bf16 v[176:179], a[96:99], a[44:47], v[176:179]
buffer_load_dwordx4 v22, s[44:47], s23 offen lds
v_mfma_f32_16x16x32_bf16 v[180:183], a[104:107], a[44:47], v[180:183]
ds_read_b64_tr_b16 a[96:97], v14 offset:8192
v_mfma_f32_16x16x32_bf16 v[180:183], a[108:111], a[60:63], v[180:183]
ds_read_b64_tr_b16 a[98:99], v14 offset:8448
v_mfma_f32_16x16x32_bf16 v[172:175], a[108:111], a[56:59], v[172:175]
ds_read_b64_tr_b16 a[100:101], v14 offset:10240
v_mfma_f32_16x16x32_bf16 v[172:175], a[104:107], a[40:43], v[172:175]
ds_read_b64_tr_b16 a[102:103], v14 offset:10496
s_add_u32 m0, s16, 0x1c00
v_mfma_f32_16x16x32_bf16 v[164:167], a[104:107], a[36:39], v[164:167]
buffer_load_dwordx4 v23, s[44:47], s23 offen lds
v_mfma_f32_16x16x32_bf16 v[164:167], a[108:111], a[52:55], v[164:167]
v_lshl_add_u32 v22, s42, 7, v22
v_lshl_add_u32 v23, s42, 7, v23
v_mfma_f32_16x16x32_bf16 v[156:159], a[108:111], a[48:51], v[156:159]
v_mfma_f32_16x16x32_bf16 v[156:159], a[104:107], a[32:35], v[156:159]
s_waitcnt lgkmcnt(4)
v_mfma_f32_16x16x32_bf16 v[184:187], a[80:83], a[32:35], v[184:187]
ds_read_b64_tr_b16 a[104:105], v15 offset:8192
v_mfma_f32_16x16x32_bf16 v[184:187], a[84:87], a[48:51], v[184:187]
ds_read_b64_tr_b16 a[106:107], v15 offset:8448
v_mfma_f32_16x16x32_bf16 v[192:195], a[84:87], a[52:55], v[192:195]
buffer_load_dwordx4 a[148:151], v16, s[76:79], 0 offen offset:1024
v_mfma_f32_16x16x32_bf16 v[192:195], a[80:83], a[36:39], v[192:195]
ds_read_b64_tr_b16 a[108:109], v15 offset:10240
v_mfma_f32_16x16x32_bf16 v[200:203], a[80:83], a[40:43], v[200:203]
ds_read_b64_tr_b16 a[110:111], v15 offset:10496
v_add_u32 v12, 0x8000, v12
v_mfma_f32_16x16x32_bf16 v[200:203], a[84:87], a[56:59], v[200:203]
v_add_u32 v13, 0x8000, v13
v_add_u32 v14, 0x8000, v14
v_mfma_f32_16x16x32_bf16 v[208:211], a[84:87], a[60:63], v[208:211]
v_add_u32 v15, 0x8000, v15
v_mfma_f32_16x16x32_bf16 v[208:211], a[80:83], a[44:47], v[208:211]
v_mfma_f32_16x16x32_bf16 v[212:215], a[88:91], a[44:47], v[212:215]
s_waitcnt vmcnt(28) lgkmcnt(0)
v_mfma_f32_16x16x32_bf16 v[212:215], a[92:95], a[60:63], v[212:215]
s_barrier
s_add_u32 m0, s17, 0x8000
v_mfma_f32_16x16x32_bf16 v[204:207], a[92:95], a[56:59], v[204:207]
buffer_load_dwordx4 v5, s[52:55], 0 offen lds
v_mfma_f32_16x16x32_bf16 v[204:207], a[88:91], a[40:43], v[204:207]
ds_read_b64_tr_b16 a[80:81], v12 offset:0
v_mfma_f32_16x16x32_bf16 v[196:199], a[88:91], a[36:39], v[196:199]
ds_read_b64_tr_b16 a[82:83], v12 offset:1024
v_mfma_f32_16x16x32_bf16 v[196:199], a[92:95], a[52:55], v[196:199]
ds_read_b64_tr_b16 a[84:85], v12 offset:8192
v_mfma_f32_16x16x32_bf16 v[188:191], a[92:95], a[48:51], v[188:191]
ds_read_b64_tr_b16 a[86:87], v12 offset:9216
v_mfma_f32_16x16x32_bf16 v[188:191], a[88:91], a[32:35], v[188:191]
s_waitcnt lgkmcnt(4)
v_mfma_f32_16x16x32_bf16 v[216:219], a[32:35], a[96:99], v[216:219]
ds_read_b64_tr_b16 a[88:89], v13 offset:0
s_add_u32 m0, s17, 0x8400
v_mfma_f32_16x16x32_bf16 v[216:219], a[48:51], a[100:103], v[216:219]
buffer_load_dwordx4 v5, s[52:55], s13 offen lds
v_mfma_f32_16x16x32_bf16 v[224:227], a[52:55], a[100:103], v[224:227]
ds_read_b64_tr_b16 a[90:91], v13 offset:1024
v_mfma_f32_16x16x32_bf16 v[224:227], a[36:39], a[96:99], v[224:227]
ds_read_b64_tr_b16 a[92:93], v13 offset:8192
v_mfma_f32_16x16x32_bf16 v[232:235], a[40:43], a[96:99], v[232:235]
ds_read_b64_tr_b16 a[94:95], v13 offset:9216
v_mfma_f32_16x16x32_bf16 v[232:235], a[56:59], a[100:103], v[232:235]
v_mfma_f32_16x16x32_bf16 v[240:243], a[60:63], a[100:103], v[240:243]
v_mfma_f32_16x16x32_bf16 v[240:243], a[44:47], a[96:99], v[240:243]
v_mfma_f32_16x16x32_bf16 v[244:247], a[44:47], a[104:107], v[244:247]
ds_read_b64_tr_b16 a[96:97], v12 offset:256
s_add_u32 m0, s17, 0x8800
v_mfma_f32_16x16x32_bf16 v[244:247], a[60:63], a[108:111], v[244:247]
buffer_load_dwordx4 v6, s[52:55], 0 offen lds
v_mfma_f32_16x16x32_bf16 v[236:239], a[56:59], a[108:111], v[236:239]
ds_read_b64_tr_b16 a[98:99], v12 offset:1280
v_mfma_f32_16x16x32_bf16 v[236:239], a[40:43], a[104:107], v[236:239]
ds_read_b64_tr_b16 a[100:101], v12 offset:8448
v_mfma_f32_16x16x32_bf16 v[228:231], a[36:39], a[104:107], v[228:231]
ds_read_b64_tr_b16 a[102:103], v12 offset:9472
v_mfma_f32_16x16x32_bf16 v[228:231], a[52:55], a[108:111], v[228:231]
v_mfma_f32_16x16x32_bf16 v[220:223], a[48:51], a[108:111], v[220:223]
v_mfma_f32_16x16x32_bf16 v[220:223], a[32:35], a[104:107], v[220:223]
s_add_u32 m0, s17, 0x8c00
s_waitcnt lgkmcnt(4)
L_S20:
v_mfma_f32_16x16x32_bf16 v[24:27], a[80:83], a[0:3], v[24:27]
ds_read_b64_tr_b16 a[104:105], v13 offset:256
s_waitcnt vmcnt(22)
v_mfma_f32_16x16x32_bf16 v[24:27], a[84:87], a[16:19], v[24:27]
buffer_load_dwordx4 v6, s[52:55], s13 offen lds
v_mfma_f32_16x16x32_bf16 v[32:35], a[84:87], a[20:23], v[32:35]
ds_read_b64_tr_b16 a[106:107], v13 offset:1280
v_mfma_f32_16x16x32_bf16 v[32:35], a[80:83], a[4:7], v[32:35]
ds_read_b64_tr_b16 a[108:109], v13 offset:8448
v_mfma_f32_16x16x32_bf16 v[40:43], a[80:83], a[8:11], v[40:43]
ds_read_b64_tr_b16 a[110:111], v13 offset:9472
v_mfma_f32_16x16x32_bf16 v[40:43], a[84:87], a[24:27], v[40:43]
ds_read_b128 a[32:35], v8 offset:32768
v_mfma_f32_16x16x32_bf16 v[48:51], a[84:87], a[28:31], v[48:51]
ds_read_b128 a[48:51], v9 offset:32768
v_mfma_f32_16x16x32_bf16 v[48:51], a[80:83], a[12:15], v[48:51]
ds_read_b128 a[36:39], v8 offset:34816
s_add_u32 m0, s18, 0xc000
v_mfma_f32_16x16x32_bf16 v[52:55], a[88:91], a[12:15], v[52:55]
buffer_load_dwordx4 v7, s[68:71], 0 offen lds
v_mfma_f32_16x16x32_bf16 v[52:55], a[92:95], a[28:31], v[52:55]
ds_read_b64_tr_b16 a[80:81], v12 offset:512
v_mfma_f32_16x16x32_bf16 v[44:47], a[92:95], a[24:27], v[44:47]
ds_read_b64_tr_b16 a[82:83], v12 offset:1536
v_mfma_f32_16x16x32_bf16 v[44:47], a[88:91], a[8:11], v[44:47]
ds_read_b64_tr_b16 a[84:85], v12 offset:8704
v_mfma_f32_16x16x32_bf16 v[36:39], a[88:91], a[4:7], v[36:39]
ds_read_b64_tr_b16 a[86:87], v12 offset:9728
v_mfma_f32_16x16x32_bf16 v[36:39], a[92:95], a[20:23], v[36:39]
ds_read_b128 a[52:55], v9 offset:34816
v_mfma_f32_16x16x32_bf16 v[28:31], a[92:95], a[16:19], v[28:31]
ds_read_b128 a[40:43], v8 offset:36864
s_waitcnt lgkmcnt(9)
v_mfma_f32_16x16x32_bf16 v[28:31], a[88:91], a[0:3], v[28:31]
ds_read_b128 a[56:59], v9 offset:36864
s_add_u32 m0, s18, 0xd000
v_mfma_f32_16x16x32_bf16 v[56:59], a[96:99], a[0:3], v[56:59]
buffer_load_dwordx4 v7, s[68:71], s25 offen lds
v_mfma_f32_16x16x32_bf16 v[56:59], a[100:103], a[16:19], v[56:59]
ds_read_b64_tr_b16 a[88:89], v13 offset:512
v_mfma_f32_16x16x32_bf16 v[64:67], a[100:103], a[20:23], v[64:67]
ds_read_b64_tr_b16 a[90:91], v13 offset:1536
v_mfma_f32_16x16x32_bf16 v[64:67], a[96:99], a[4:7], v[64:67]
ds_read_b64_tr_b16 a[92:93], v13 offset:8704
v_mfma_f32_16x16x32_bf16 v[72:75], a[96:99], a[8:11], v[72:75]
ds_read_b64_tr_b16 a[94:95], v13 offset:9728
v_mfma_f32_16x16x32_bf16 v[72:75], a[100:103], a[24:27], v[72:75]
ds_read_b128 a[44:47], v8 offset:38912
v_mfma_f32_16x16x32_bf16 v[80:83], a[100:103], a[28:31], v[80:83]
ds_read_b128 a[60:63], v9 offset:38912
v_mfma_f32_16x16x32_bf16 v[80:83], a[96:99], a[12:15], v[80:83]
s_add_u32 m0, s18, 0xe000
v_mfma_f32_16x16x32_bf16 v[84:87], a[104:107], a[12:15], v[84:87]
buffer_load_dwordx4 v7, s[68:71], s26 offen lds
v_mfma_f32_16x16x32_bf16 v[84:87], a[108:111], a[28:31], v[84:87]
ds_read_b64_tr_b16 a[96:97], v12 offset:768
v_lshl_add_u32 v5, s42, 19, v5
v_mfma_f32_16x16x32_bf16 v[76:79], a[108:111], a[24:27], v[76:79]
ds_read_b64_tr_b16 a[98:99], v12 offset:1792
v_lshl_add_u32 v6, s42, 19, v6
v_mfma_f32_16x16x32_bf16 v[76:79], a[104:107], a[8:11], v[76:79]
ds_read_b64_tr_b16 a[100:101], v12 offset:8960
v_lshl_add_u32 v7, s42, 18, v7
v_mfma_f32_16x16x32_bf16 v[68:71], a[104:107], a[4:7], v[68:71]
ds_read_b64_tr_b16 a[102:103], v12 offset:9984
v_lshl_add_u32 v7, s42, 17, v7
v_mfma_f32_16x16x32_bf16 v[68:71], a[108:111], a[20:23], v[68:71]
s_waitcnt vmcnt(13)
v_accvgpr_read_b32 v18, a144
v_lshlrev_b32 v1, 16, v18
v_mfma_f32_16x16x32_bf16 v[60:63], a[108:111], a[16:19], v[60:63]
L_padA10:
s_cmp_eq_u32 s95, 1
s_cbranch_scc1 L_hopA_ret
v_and_b32 v18, 0xffff0000, v18
v_accvgpr_read_b32 v21, a128
v_mfma_f32_16x16x32_bf16 v[60:63], a[104:107], a[0:3], v[60:63]
s_add_u32 m0, s16, 0x8000
s_waitcnt lgkmcnt(4)
s_waitcnt lgkmcnt(6)
v_mfma_f32_16x16x32_bf16 v[88:91], a[80:83], a[0:3], v[88:91]
buffer_load_dwordx4 v22, s[44:47], s20 offen lds
v_mfma_f32_16x16x32_bf16 v[88:91], a[84:87], a[16:19], v[88:91]
ds_read_b64_tr_b16 a[104:105], v13 offset:768
v_lshlrev_b32 v20, 16, v21
v_mfma_f32_16x16x32_bf16 v[96:99], a[84:87], a[20:23], v[96:99]
ds_read_b64_tr_b16 a[106:107], v13 offset:1792
v_and_b32 v21, 0xffff0000, v21
v_mfma_f32_16x16x32_bf16 v[96:99], a[80:83], a[4:7], v[96:99]
ds_read_b64_tr_b16 a[108:109], v13 offset:8960
v_mul_f32 v2, v1, v20
v_mfma_f32_16x16x32_bf16 v[104:107], a[80:83], a[8:11], v[104:107]
ds_read_b64_tr_b16 a[110:111], v13 offset:9984
v_fmac_f32 v2, v18, v21
v_mfma_f32_16x16x32_bf16 v[104:107], a[84:87], a[24:27], v[104:107]
v_accvgpr_read_b32 v21, a136
v_lshlrev_b32 v20, 16, v21
v_mfma_f32_16x16x32_bf16 v[112:115], a[84:87], a[28:31], v[112:115]
s_add_u32 m0, s16, 0x8400
v_and_b32 v21, 0xffff0000, v21
v_mul_f32 v3, v1, v20
v_mfma_f32_16x16x32_bf16 v[112:115], a[80:83], a[12:15], v[112:115]
buffer_load_dwordx4 v23, s[44:47], s20 offen lds
v_mfma_f32_16x16x32_bf16 v[116:119], a[88:91], a[12:15], v[116:119]
ds_read_b64_tr_b16 a[80:81], v14 offset:0
v_fmac_f32 v3, v18, v21
v_mfma_f32_16x16x32_bf16 v[116:119], a[92:95], a[28:31], v[116:119]
ds_read_b64_tr_b16 a[82:83], v14 offset:256
v_accvgpr_read_b32 v18, a145
v_mfma_f32_16x16x32_bf16 v[108:111], a[92:95], a[24:27], v[108:111]
ds_read_b64_tr_b16 a[84:85], v14 offset:2048
v_lshlrev_b32 v1, 16, v18
v_mfma_f32_16x16x32_bf16 v[108:111], a[88:91], a[8:11], v[108:111]
ds_read_b64_tr_b16 a[86:87], v14 offset:2304
v_and_b32 v18, 0xffff0000, v18
v_mfma_f32_16x16x32_bf16 v[100:103], a[88:91], a[4:7], v[100:103]
v_accvgpr_read_b32 v21, a129
v_lshlrev_b32 v20, 16, v21
v_mfma_f32_16x16x32_bf16 v[100:103], a[92:95], a[20:23], v[100:103]
s_add_u32 m0, s16, 0x8800
v_and_b32 v21, 0xffff0000, v21
v_fmac_f32 v2, v1, v20
v_mfma_f32_16x16x32_bf16 v[92:95], a[92:95], a[16:19], v[92:95]
buffer_load_dwordx4 v22, s[44:47], s21 offen lds
v_mfma_f32_16x16x32_bf16 v[92:95], a[88:91], a[0:3], v[92:95]
s_waitcnt lgkmcnt(4)
v_fmac_f32 v2, v18, v21
v_accvgpr_read_b32 v21, a137
v_mfma_f32_16x16x32_bf16 v[120:123], a[96:99], a[0:3], v[120:123]
ds_read_b64_tr_b16 a[88:89], v15 offset:0
v_lshlrev_b32 v20, 16, v21
v_mfma_f32_16x16x32_bf16 v[120:123], a[100:103], a[16:19], v[120:123]
ds_read_b64_tr_b16 a[90:91], v15 offset:256
v_and_b32 v21, 0xffff0000, v21
v_mfma_f32_16x16x32_bf16 v[128:131], a[100:103], a[20:23], v[128:131]
ds_read_b64_tr_b16 a[92:93], v15 offset:2048
v_fmac_f32 v3, v1, v20
v_mfma_f32_16x16x32_bf16 v[128:131], a[96:99], a[4:7], v[128:131]
ds_read_b64_tr_b16 a[94:95], v15 offset:2304
v_fmac_f32 v3, v18, v21
v_mfma_f32_16x16x32_bf16 v[136:139], a[96:99], a[8:11], v[136:139]
s_add_u32 m0, s16, 0x8c00
v_accvgpr_read_b32 v18, a146
v_lshlrev_b32 v1, 16, v18
v_mfma_f32_16x16x32_bf16 v[136:139], a[100:103], a[24:27], v[136:139]
buffer_load_dwordx4 v23, s[44:47], s21 offen lds
v_mfma_f32_16x16x32_bf16 v[144:147], a[100:103], a[28:31], v[144:147]
v_and_b32 v18, 0xffff0000, v18
v_accvgpr_read_b32 v21, a130
v_mfma_f32_16x16x32_bf16 v[144:147], a[96:99], a[12:15], v[144:147]
v_lshlrev_b32 v20, 16, v21
v_and_b32 v21, 0xffff0000, v21
v_mfma_f32_16x16x32_bf16 v[148:151], a[104:107], a[12:15], v[148:151]
ds_read_b64_tr_b16 a[96:97], v14 offset:4096
v_fmac_f32 v2, v1, v20
v_mfma_f32_16x16x32_bf16 v[148:151], a[108:111], a[28:31], v[148:151]
ds_read_b64_tr_b16 a[98:99], v14 offset:4352
v_fmac_f32 v2, v18, v21
v_mfma_f32_16x16x32_bf16 v[140:143], a[108:111], a[24:27], v[140:143]
ds_read_b64_tr_b16 a[100:101], v14 offset:6144
v_accvgpr_read_b32 v21, a138
v_mfma_f32_16x16x32_bf16 v[140:143], a[104:107], a[8:11], v[140:143]
ds_read_b64_tr_b16 a[102:103], v14 offset:6400
s_add_u32 m0, s16, 0x9000
v_mfma_f32_16x16x32_bf16 v[132:135], a[104:107], a[4:7], v[132:135]
buffer_load_dwordx4 v22, s[44:47], s22 offen lds
v_mfma_f32_16x16x32_bf16 v[132:135], a[108:111], a[20:23], v[132:135]
v_lshlrev_b32 v20, 16, v21
v_and_b32 v21, 0xffff0000, v21
v_mfma_f32_16x16x32_bf16 v[124:127], a[108:111], a[16:19], v[124:127]
v_fmac_f32 v3, v1, v20
v_fmac_f32 v3, v18, v21
v_mfma_f32_16x16x32_bf16 v[124:127], a[104:107], a[0:3], v[124:127]
s_waitcnt lgkmcnt(4)
v_accvgpr_read_b32 v18, a147
v_lshlrev_b32 v1, 16, v18
v_mfma_f32_16x16x32_bf16 v[152:155], a[80:83], a[0:3], v[152:155]
ds_read_b64_tr_b16 a[104:105], v15 offset:4096
v_and_b32 v18, 0xffff0000, v18
v_mfma_f32_16x16x32_bf16 v[152:155], a[84:87], a[16:19], v[152:155]
ds_read_b64_tr_b16 a[106:107], v15 offset:4352
v_accvgpr_read_b32 v21, a131
v_mfma_f32_16x16x32_bf16 v[160:163], a[84:87], a[20:23], v[160:163]
ds_read_b64_tr_b16 a[108:109], v15 offset:6144
s_add_u32 m0, s16, 0x9400
v_mfma_f32_16x16x32_bf16 v[160:163], a[80:83], a[4:7], v[160:163]
buffer_load_dwordx4 v23, s[44:47], s22 offen lds
v_mfma_f32_16x16x32_bf16 v[168:171], a[80:83], a[8:11], v[168:171]
ds_read_b64_tr_b16 a[110:111], v15 offset:6400
v_lshlrev_b32 v20, 16, v21
v_mfma_f32_16x16x32_bf16 v[168:171], a[84:87], a[24:27], v[168:171]
v_and_b32 v21, 0xffff0000, v21
v_fmac_f32 v2, v1, v20
v_mfma_f32_16x16x32_bf16 v[176:179], a[84:87], a[28:31], v[176:179]
v_fmac_f32 v2, v18, v21
v_accvgpr_read_b32 v21, a139
v_mfma_f32_16x16x32_bf16 v[176:179], a[80:83], a[12:15], v[176:179]
v_lshlrev_b32 v20, 16, v21
v_and_b32 v21, 0xffff0000, v21
v_mfma_f32_16x16x32_bf16 v[180:183], a[88:91], a[12:15], v[180:183]
ds_read_b64_tr_b16 a[80:81], v14 offset:8192
v_fmac_f32 v3, v1, v20
v_mfma_f32_16x16x32_bf16 v[180:183], a[92:95], a[28:31], v[180:183]
ds_read_b64_tr_b16 a[82:83], v14 offset:8448
s_add_u32 m0, s16, 0x9800
v_mfma_f32_16x16x32_bf16 v[172:175], a[92:95], a[24:27], v[172:175]
buffer_load_dwordx4 v22, s[44:47], s23 offen lds
v_mfma_f32_16x16x32_bf16 v[172:175], a[88:91], a[8:11], v[172:175]
ds_read_b64_tr_b16 a[84:85], v14 offset:10240
v_fmac_f32 v3, v18, v21
v_mfma_f32_16x16x32_bf16 v[164:167], a[88:91], a[4:7], v[164:167]
ds_read_b64_tr_b16 a[86:87], v14 offset:10496
s_waitcnt vmcnt(14)
v_accvgpr_read_b32 v18, a148
v_mfma_f32_16x16x32_bf16 v[164:167], a[92:95], a[20:23], v[164:167]
v_lshlrev_b32 v1, 16, v18
v_and_b32 v18, 0xffff0000, v18
v_mfma_f32_16x16x32_bf16 v[156:159], a[92:95], a[16:19], v[156:159]
v_accvgpr_read_b32 v21, a132
v_lshlrev_b32 v20, 16, v21
v_mfma_f32_16x16x32_bf16 v[156:159], a[88:91], a[0:3], v[156:159]
s_waitcnt lgkmcnt(4)
v_and_b32 v21, 0xffff0000, v21
v_fmac_f32 v2, v1, v20
v_mfma_f32_16x16x32_bf16 v[184:187], a[96:99], a[0:3], v[184:187]
ds_read_b64_tr_b16 a[88:89], v15 offset:8192
s_add_u32 m0, s16, 0x9c00
v_mfma_f32_16x16x32_bf16 v[184:187], a[100:103], a[16:19], v[184:187]
buffer_load_dwordx4 v23, s[44:47], s23 offen lds
v_mfma_f32_16x16x32_bf16 v[192:195], a[100:103], a[20:23], v[192:195]
ds_read_b64_tr_b16 a[90:91], v15 offset:8448
v_fmac_f32 v2, v18, v21
v_mfma_f32_16x16x32_bf16 v[192:195], a[96:99], a[4:7], v[192:195]
ds_read_b64_tr_b16 a[92:93], v15 offset:10240
v_accvgpr_read_b32 v21, a140
v_mfma_f32_16x16x32_bf16 v[200:203], a[96:99], a[8:11], v[200:203]
ds_read_b64_tr_b16 a[94:95], v15 offset:10496
v_add_u32 v12, 0xffff0000, v12
v_mfma_f32_16x16x32_bf16 v[200:203], a[100:103], a[24:27], v[200:203]
v_add_u32 v13, 0xffff0000, v13
v_add_u32 v14, 0xffff0000, v14
v_mfma_f32_16x16x32_bf16 v[208:211], a[100:103], a[28:31], v[208:211]
v_add_u32 v15, 0xffff0000, v15
v_lshlrev_b32 v20, 16, v21
v_mfma_f32_16x16x32_bf16 v[208:211], a[96:99], a[12:15], v[208:211]
v_and_b32 v21, 0xffff0000, v21
v_fmac_f32 v3, v1, v20
v_mfma_f32_16x16x32_bf16 v[212:215], a[104:107], a[12:15], v[212:215]
s_waitcnt vmcnt(25) lgkmcnt(0)
v_fmac_f32 v3, v18, v21
v_accvgpr_read_b32 v18, a149
v_mfma_f32_16x16x32_bf16 v[212:215], a[108:111], a[28:31], v[212:215]
s_barrier
s_add_u32 m0, s17, 0x10000
v_lshlrev_b32 v1, 16, v18
v_mfma_f32_16x16x32_bf16 v[204:207], a[108:111], a[24:27], v[204:207]
buffer_load_dwordx4 v5, s[52:55], 0 offen lds
v_mfma_f32_16x16x32_bf16 v[204:207], a[104:107], a[8:11], v[204:207]
ds_read_b64_tr_b16 a[96:97], v12 offset:0
v_and_b32 v18, 0xffff0000, v18
v_mfma_f32_16x16x32_bf16 v[196:199], a[104:107], a[4:7], v[196:199]
ds_read_b64_tr_b16 a[98:99], v12 offset:1024
v_accvgpr_read_b32 v21, a133
v_mfma_f32_16x16x32_bf16 v[196:199], a[108:111], a[20:23], v[196:199]
ds_read_b64_tr_b16 a[100:101], v12 offset:8192
v_lshlrev_b32 v20, 16, v21
v_mfma_f32_16x16x32_bf16 v[188:191], a[108:111], a[16:19], v[188:191]
ds_read_b64_tr_b16 a[102:103], v12 offset:9216
v_and_b32 v21, 0xffff0000, v21
v_mfma_f32_16x16x32_bf16 v[188:191], a[104:107], a[0:3], v[188:191]
s_waitcnt lgkmcnt(4)
v_fmac_f32 v2, v1, v20
v_fmac_f32 v2, v18, v21
v_mfma_f32_16x16x32_bf16 v[216:219], a[0:3], a[80:83], v[216:219]
ds_read_b64_tr_b16 a[104:105], v13 offset:0
v_accvgpr_read_b32 v21, a141
v_mfma_f32_16x16x32_bf16 v[216:219], a[16:19], a[84:87], v[216:219]
ds_read_b64_tr_b16 a[106:107], v13 offset:1024
s_add_u32 m0, s17, 0x10400
v_mfma_f32_16x16x32_bf16 v[224:227], a[20:23], a[84:87], v[224:227]
buffer_load_dwordx4 v5, s[52:55], s13 offen lds
v_mfma_f32_16x16x32_bf16 v[224:227], a[4:7], a[80:83], v[224:227]
ds_read_b64_tr_b16 a[108:109], v13 offset:8192
v_lshlrev_b32 v20, 16, v21
v_mfma_f32_16x16x32_bf16 v[232:235], a[8:11], a[80:83], v[232:235]
ds_read_b64_tr_b16 a[110:111], v13 offset:9216
v_and_b32 v21, 0xffff0000, v21
v_mfma_f32_16x16x32_bf16 v[232:235], a[24:27], a[84:87], v[232:235]
s_lshl_b32 s15, s2, 2
v_fmac_f32 v3, v1, v20
v_fmac_f32 v3, v18, v21
v_mfma_f32_16x16x32_bf16 v[240:243], a[28:31], a[84:87], v[240:243]
s_add_u32 s15, s15, s4
v_accvgpr_read_b32 v18, a150
v_lshlrev_b32 v1, 16, v18
v_mfma_f32_16x16x32_bf16 v[240:243], a[12:15], a[80:83], v[240:243]
s_lshl_b32 s15, s15, 12
v_and_b32 v18, 0xffff0000, v18
v_accvgpr_read_b32 v21, a134
v_mfma_f32_16x16x32_bf16 v[244:247], a[12:15], a[88:91], v[244:247]
ds_read_b64_tr_b16 a[80:81], v12 offset:256
v_lshlrev_b32 v20, 16, v21
v_mfma_f32_16x16x32_bf16 v[244:247], a[28:31], a[92:95], v[244:247]
ds_read_b64_tr_b16 a[82:83], v12 offset:1280
v_and_b32 v21, 0xffff0000, v21
v_mfma_f32_16x16x32_bf16 v[236:239], a[24:27], a[92:95], v[236:239]
ds_read_b64_tr_b16 a[84:85], v12 offset:8448
s_add_u32 m0, s17, 0x10800
v_mfma_f32_16x16x32_bf16 v[236:239], a[8:11], a[88:91], v[236:239]
buffer_load_dwordx4 v6, s[52:55], 0 offen lds
v_mfma_f32_16x16x32_bf16 v[228:231], a[4:7], a[88:91], v[228:231]
ds_read_b64_tr_b16 a[86:87], v12 offset:9472
v_fmac_f32 v2, v1, v20
v_mfma_f32_16x16x32_bf16 v[228:231], a[20:23], a[92:95], v[228:231]
s_add_u32 s15, s15, 0x3800000
v_fmac_f32 v2, v18, v21
v_accvgpr_read_b32 v21, a142
v_mfma_f32_16x16x32_bf16 v[220:223], a[16:19], a[92:95], v[220:223]
v_lshlrev_b32 v20, 16, v21
v_and_b32 v21, 0xffff0000, v21
v_mfma_f32_16x16x32_bf16 v[220:223], a[0:3], a[88:91], v[220:223]
s_waitcnt lgkmcnt(4)
v_fmac_f32 v3, v1, v20
v_fmac_f32 v3, v18, v21
L_S21:
v_mfma_f32_16x16x32_bf16 v[24:27], a[96:99], a[32:35], v[24:27]
ds_read_b64_tr_b16 a[88:89], v13 offset:256
s_waitcnt vmcnt(19)
v_mfma_f32_16x16x32_bf16 v[24:27], a[100:103], a[48:51], v[24:27]
ds_read_b64_tr_b16 a[90:91], v13 offset:1280
v_accvgpr_read_b32 v18, a151
v_mfma_f32_16x16x32_bf16 v[32:35], a[100:103], a[52:55], v[32:35]
ds_read_b64_tr_b16 a[92:93], v13 offset:8448
s_add_u32 m0, s17, 0x10c00
v_mfma_f32_16x16x32_bf16 v[32:35], a[96:99], a[36:39], v[32:35]
buffer_load_dwordx4 v6, s[52:55], s13 offen lds
v_mfma_f32_16x16x32_bf16 v[40:43], a[96:99], a[40:43], v[40:43]
ds_read_b64_tr_b16 a[94:95], v13 offset:9472
v_lshlrev_b32 v1, 16, v18
v_mfma_f32_16x16x32_bf16 v[40:43], a[100:103], a[56:59], v[40:43]
ds_read_b128 a[0:3], v8 offset:0
v_and_b32 v18, 0xffff0000, v18
v_mfma_f32_16x16x32_bf16 v[48:51], a[100:103], a[60:63], v[48:51]
ds_read_b128 a[16:19], v9 offset:0
v_accvgpr_read_b32 v21, a135
v_mfma_f32_16x16x32_bf16 v[48:51], a[96:99], a[44:47], v[48:51]
ds_read_b128 a[4:7], v8 offset:2048
v_lshlrev_b32 v20, 16, v21
v_mfma_f32_16x16x32_bf16 v[52:55], a[104:107], a[44:47], v[52:55]
ds_read_b64_tr_b16 a[96:97], v12 offset:512
v_and_b32 v21, 0xffff0000, v21
v_mfma_f32_16x16x32_bf16 v[52:55], a[108:111], a[60:63], v[52:55]
ds_read_b64_tr_b16 a[98:99], v12 offset:1536
v_fmac_f32 v2, v1, v20
v_mfma_f32_16x16x32_bf16 v[44:47], a[108:111], a[56:59], v[44:47]
ds_read_b64_tr_b16 a[100:101], v12 offset:8704
v_fmac_f32 v2, v18, v21
v_mfma_f32_16x16x32_bf16 v[44:47], a[104:107], a[40:43], v[44:47]
ds_read_b64_tr_b16 a[102:103], v12 offset:9728
s_add_u32 m0, s18, 0x14000
v_mfma_f32_16x16x32_bf16 v[36:39], a[104:107], a[36:39], v[36:39]
buffer_load_dwordx4 v7, s[68:71], 0 offen lds
v_mfma_f32_16x16x32_bf16 v[36:39], a[108:111], a[52:55], v[36:39]
ds_read_b128 a[20:23], v9 offset:2048
v_accvgpr_read_b32 v21, a143
v_mfma_f32_16x16x32_bf16 v[28:31], a[108:111], a[48:51], v[28:31]
ds_read_b128 a[8:11], v8 offset:4096
v_lshlrev_b32 v20, 16, v21
v_mfma_f32_16x16x32_bf16 v[28:31], a[104:107], a[32:35], v[28:31]
ds_read_b128 a[24:27], v9 offset:4096
s_waitcnt lgkmcnt(10)
v_mfma_f32_16x16x32_bf16 v[56:59], a[80:83], a[32:35], v[56:59]
ds_read_b64_tr_b16 a[104:105], v13 offset:512
v_and_b32 v21, 0xffff0000, v21
v_mfma_f32_16x16x32_bf16 v[56:59], a[84:87], a[48:51], v[56:59]
ds_read_b64_tr_b16 a[106:107], v13 offset:1536
v_fmac_f32 v3, v1, v20
v_mfma_f32_16x16x32_bf16 v[64:67], a[84:87], a[52:55], v[64:67]
ds_read_b64_tr_b16 a[108:109], v13 offset:8704
v_fmac_f32 v3, v18, v21
v_mfma_f32_16x16x32_bf16 v[64:67], a[80:83], a[36:39], v[64:67]
ds_read_b64_tr_b16 a[110:111], v13 offset:9728
s_add_u32 m0, s18, 0x15000
v_mfma_f32_16x16x32_bf16 v[72:75], a[80:83], a[40:43], v[72:75]
buffer_load_dwordx4 v7, s[68:71], s25 offen lds
v_mfma_f32_16x16x32_bf16 v[72:75], a[84:87], a[56:59], v[72:75]
ds_read_b128 a[12:15], v8 offset:6144
v_add_f32_dpp v2, v2, v2 row_ror:8 row_mask:0xf bank_mask:0xf
v_mfma_f32_16x16x32_bf16 v[80:83], a[84:87], a[60:63], v[80:83]
ds_read_b128 a[28:31], v9 offset:6144
v_add_f32_dpp v3, v3, v3 row_ror:8 row_mask:0xf bank_mask:0xf
v_mfma_f32_16x16x32_bf16 v[80:83], a[80:83], a[44:47], v[80:83]
v_add_f32_dpp v2, v2, v2 row_ror:4 row_mask:0xf bank_mask:0xf
v_add_f32_dpp v3, v3, v3 row_ror:4 row_mask:0xf bank_mask:0xf
v_mfma_f32_16x16x32_bf16 v[84:87], a[88:91], a[44:47], v[84:87]
ds_read_b64_tr_b16 a[80:81], v12 offset:768
v_add_f32_dpp v2, v2, v2 row_ror:2 row_mask:0xf bank_mask:0xf
v_mfma_f32_16x16x32_bf16 v[84:87], a[92:95], a[60:63], v[84:87]
ds_read_b64_tr_b16 a[82:83], v12 offset:1792
v_add_f32_dpp v3, v3, v3 row_ror:2 row_mask:0xf bank_mask:0xf
v_mfma_f32_16x16x32_bf16 v[76:79], a[92:95], a[56:59], v[76:79]
ds_read_b64_tr_b16 a[84:85], v12 offset:8960
v_add_f32_dpp v2, v2, v2 row_ror:1 row_mask:0xf bank_mask:0xf
v_mfma_f32_16x16x32_bf16 v[76:79], a[88:91], a[40:43], v[76:79]
ds_read_b64_tr_b16 a[86:87], v12 offset:9984
v_add_f32_dpp v3, v3, v3 row_ror:1 row_mask:0xf bank_mask:0xf
v_mfma_f32_16x16x32_bf16 v[68:71], a[88:91], a[36:39], v[68:71]
s_add_u32 m0, s18, 0x16000
v_mov_b32 v1, v2
v_mov_b32 v18, v3
v_mfma_f32_16x16x32_bf16 v[68:71], a[92:95], a[52:55], v[68:71]
buffer_load_dwordx4 v7, s[68:71], s26 offen lds
v_mfma_f32_16x16x32_bf16 v[60:63], a[92:95], a[48:51], v[60:63]
v_permlane16_swap_b32 v1, v2
v_permlane16_swap_b32 v18, v3
v_mfma_f32_16x16x32_bf16 v[60:63], a[88:91], a[32:35], v[60:63]
s_waitcnt lgkmcnt(6)
v_add_f32 v2, v2, v1
v_add_f32 v3, v3, v18
v_mfma_f32_16x16x32_bf16 v[88:91], a[96:99], a[32:35], v[88:91]
ds_read_b64_tr_b16 a[88:89], v13 offset:768
v_mov_b32 v1, v2
v_mfma_f32_16x16x32_bf16 v[88:91], a[100:103], a[48:51], v[88:91]
ds_read_b64_tr_b16 a[90:91], v13 offset:1792
v_mov_b32 v18, v3
v_mfma_f32_16x16x32_bf16 v[96:99], a[100:103], a[52:55], v[96:99]
ds_read_b64_tr_b16 a[92:93], v13 offset:8960
v_permlane32_swap_b32 v1, v2
v_mfma_f32_16x16x32_bf16 v[96:99], a[96:99], a[36:39], v[96:99]
ds_read_b64_tr_b16 a[94:95], v13 offset:9984
v_permlane32_swap_b32 v18, v3
v_mfma_f32_16x16x32_bf16 v[104:107], a[96:99], a[40:43], v[104:107]
v_add_f32 v2, v2, v1
v_add_f32 v3, v3, v18
v_mfma_f32_16x16x32_bf16 v[104:107], a[100:103], a[56:59], v[104:107]
buffer_load_dword v23, off, s[84:87], s10 sc1
v_mfma_f32_16x16x32_bf16 v[112:115], a[100:103], a[60:63], v[112:115]
v_mul_f32 v2, 0xbfb8aa3b, v2
v_mul_f32 v3, 0xbfb8aa3b, v3
v_mfma_f32_16x16x32_bf16 v[112:115], a[96:99], a[44:47], v[112:115]
v_exp_f32 v2, v2
v_mfma_f32_16x16x32_bf16 v[116:119], a[104:107], a[44:47], v[116:119]
ds_read_b64_tr_b16 a[96:97], v14 offset:0
v_mfma_f32_16x16x32_bf16 v[116:119], a[108:111], a[60:63], v[116:119]
ds_read_b64_tr_b16 a[98:99], v14 offset:256
v_mfma_f32_16x16x32_bf16 v[108:111], a[108:111], a[56:59], v[108:111]
ds_read_b64_tr_b16 a[100:101], v14 offset:2048
v_mfma_f32_16x16x32_bf16 v[108:111], a[104:107], a[40:43], v[108:111]
ds_read_b64_tr_b16 a[102:103], v14 offset:2304
v_mfma_f32_16x16x32_bf16 v[100:103], a[104:107], a[36:39], v[100:103]
v_exp_f32 v3, v3
v_mfma_f32_16x16x32_bf16 v[100:103], a[108:111], a[52:55], v[100:103]
v_add_f32 v2, 1.0, v2
v_add_f32 v3, 1.0, v3
v_mfma_f32_16x16x32_bf16 v[92:95], a[108:111], a[48:51], v[92:95]
v_rcp_f32 v2, v2
v_mfma_f32_16x16x32_bf16 v[92:95], a[104:107], a[32:35], v[92:95]
s_waitcnt lgkmcnt(4)
v_rcp_f32 v3, v3
v_mfma_f32_16x16x32_bf16 v[120:123], a[80:83], a[32:35], v[120:123]
ds_read_b64_tr_b16 a[104:105], v15 offset:0
v_mfma_f32_16x16x32_bf16 v[120:123], a[84:87], a[48:51], v[120:123]
ds_read_b64_tr_b16 a[106:107], v15 offset:256
v_mfma_f32_16x16x32_bf16 v[128:131], a[84:87], a[52:55], v[128:131]
ds_read_b64_tr_b16 a[108:109], v15 offset:2048
v_mfma_f32_16x16x32_bf16 v[128:131], a[80:83], a[36:39], v[128:131]
ds_read_b64_tr_b16 a[110:111], v15 offset:2304
v_mfma_f32_16x16x32_bf16 v[136:139], a[80:83], a[40:43], v[136:139]
buffer_store_dwordx2 v[2:3], off, s[88:91], s101 sc1
v_mfma_f32_16x16x32_bf16 v[136:139], a[84:87], a[56:59], v[136:139]
v_mfma_f32_16x16x32_bf16 v[144:147], a[84:87], a[60:63], v[144:147]
v_mfma_f32_16x16x32_bf16 v[144:147], a[80:83], a[44:47], v[144:147]
v_mfma_f32_16x16x32_bf16 v[148:151], a[88:91], a[44:47], v[148:151]
ds_read_b64_tr_b16 a[80:81], v14 offset:4096
v_mfma_f32_16x16x32_bf16 v[148:151], a[92:95], a[60:63], v[148:151]
ds_read_b64_tr_b16 a[82:83], v14 offset:4352
v_mfma_f32_16x16x32_bf16 v[140:143], a[92:95], a[56:59], v[140:143]
ds_read_b64_tr_b16 a[84:85], v14 offset:6144
v_mfma_f32_16x16x32_bf16 v[140:143], a[88:91], a[40:43], v[140:143]
ds_read_b64_tr_b16 a[86:87], v14 offset:6400
v_mfma_f32_16x16x32_bf16 v[132:135], a[88:91], a[36:39], v[132:135]
v_mfma_f32_16x16x32_bf16 v[132:135], a[92:95], a[52:55], v[132:135]
v_mfma_f32_16x16x32_bf16 v[124:127], a[92:95], a[48:51], v[124:127]
v_mfma_f32_16x16x32_bf16 v[124:127], a[88:91], a[32:35], v[124:127]
s_waitcnt lgkmcnt(4)
v_mfma_f32_16x16x32_bf16 v[152:155], a[96:99], a[32:35], v[152:155]
ds_read_b64_tr_b16 a[88:89], v15 offset:4096
v_mfma_f32_16x16x32_bf16 v[152:155], a[100:103], a[48:51], v[152:155]
ds_read_b64_tr_b16 a[90:91], v15 offset:4352
v_mfma_f32_16x16x32_bf16 v[160:163], a[100:103], a[52:55], v[160:163]
ds_read_b64_tr_b16 a[92:93], v15 offset:6144
v_mfma_f32_16x16x32_bf16 v[160:163], a[96:99], a[36:39], v[160:163]
ds_read_b64_tr_b16 a[94:95], v15 offset:6400
v_mfma_f32_16x16x32_bf16 v[168:171], a[96:99], a[40:43], v[168:171]
v_mfma_f32_16x16x32_bf16 v[168:171], a[100:103], a[56:59], v[168:171]
v_mfma_f32_16x16x32_bf16 v[176:179], a[100:103], a[60:63], v[176:179]
v_mfma_f32_16x16x32_bf16 v[176:179], a[96:99], a[44:47], v[176:179]
v_mfma_f32_16x16x32_bf16 v[180:183], a[104:107], a[44:47], v[180:183]
ds_read_b64_tr_b16 a[96:97], v14 offset:8192
v_mfma_f32_16x16x32_bf16 v[180:183], a[108:111], a[60:63], v[180:183]
ds_read_b64_tr_b16 a[98:99], v14 offset:8448
v_mfma_f32_16x16x32_bf16 v[172:175], a[108:111], a[56:59], v[172:175]
ds_read_b64_tr_b16 a[100:101], v14 offset:10240
v_mfma_f32_16x16x32_bf16 v[172:175], a[104:107], a[40:43], v[172:175]
ds_read_b64_tr_b16 a[102:103], v14 offset:10496
v_mfma_f32_16x16x32_bf16 v[164:167], a[104:107], a[36:39], v[164:167]
v_mfma_f32_16x16x32_bf16 v[164:167], a[108:111], a[52:55], v[164:167]
v_mfma_f32_16x16x32_bf16 v[156:159], a[108:111], a[48:51], v[156:159]
v_mfma_f32_16x16x32_bf16 v[156:159], a[104:107], a[32:35], v[156:159]
s_waitcnt lgkmcnt(4)
v_mfma_f32_16x16x32_bf16 v[184:187], a[80:83], a[32:35], v[184:187]
ds_read_b64_tr_b16 a[104:105], v15 offset:8192
v_mfma_f32_16x16x32_bf16 v[184:187], a[84:87], a[48:51], v[184:187]
ds_read_b64_tr_b16 a[106:107], v15 offset:8448
v_mfma_f32_16x16x32_bf16 v[192:195], a[84:87], a[52:55], v[192:195]
ds_read_b64_tr_b16 a[108:109], v15 offset:10240
v_mfma_f32_16x16x32_bf16 v[192:195], a[80:83], a[36:39], v[192:195]
ds_read_b64_tr_b16 a[110:111], v15 offset:10496
v_add_u32 v12, 0x8000, v12
v_mfma_f32_16x16x32_bf16 v[200:203], a[80:83], a[40:43], v[200:203]
v_add_u32 v13, 0x8000, v13
v_add_u32 v14, 0x8000, v14
v_mfma_f32_16x16x32_bf16 v[200:203], a[84:87], a[56:59], v[200:203]
v_add_u32 v15, 0x8000, v15
v_mfma_f32_16x16x32_bf16 v[208:211], a[84:87], a[60:63], v[208:211]
v_mfma_f32_16x16x32_bf16 v[208:211], a[80:83], a[44:47], v[208:211]
v_mfma_f32_16x16x32_bf16 v[212:215], a[88:91], a[44:47], v[212:215]
s_waitcnt vmcnt(1) lgkmcnt(0)
s_mov_b32 s92, 200000
L_spin_kv:
v_readfirstlane_b32 s93, v23
s_nop 1
s_cmp_ge_u32 s93, 8
s_cbranch_scc1 L_spun_kv
s_sub_u32 s92, s92, 1
s_cbranch_scc1 L_spun_kv
s_sleep 4
buffer_load_dword v23, off, s[84:87], s10 sc1
s_waitcnt vmcnt(0)
s_branch L_spin_kv
L_spun_kv:
v_mfma_f32_16x16x32_bf16 v[212:215], a[92:95], a[60:63], v[212:215]
s_barrier
s_add_u32 m0, s19, 0x0
v_mfma_f32_16x16x32_bf16 v[204:207], a[92:95], a[56:59], v[204:207]
buffer_load_dwordx4 v16, s[48:51], s32 offen offset:0 sc1 lds
v_mfma_f32_16x16x32_bf16 v[204:207], a[88:91], a[40:43], v[204:207]
ds_read_b64_tr_b16 a[80:81], v12 offset:0
v_mov_b32 v3, v16
v_mfma_f32_16x16x32_bf16 v[196:199], a[88:91], a[36:39], v[196:199]
ds_read_b64_tr_b16 a[82:83], v12 offset:1024
v_mov_b32 v22, 0x3f803f80
v_mfma_f32_16x16x32_bf16 v[196:199], a[92:95], a[52:55], v[196:199]
ds_read_b64_tr_b16 a[84:85], v12 offset:8192
s_mov_b32 s33, 0
v_mfma_f32_16x16x32_bf16 v[188:191], a[92:95], a[48:51], v[188:191]
ds_read_b64_tr_b16 a[86:87], v12 offset:9216
v_accvgpr_write_b32 a240, v22
v_mfma_f32_16x16x32_bf16 v[188:191], a[88:91], a[32:35], v[188:191]
s_waitcnt lgkmcnt(4)
v_accvgpr_write_b32 a241, v22
v_accvgpr_write_b32 a242, v22
v_mfma_f32_16x16x32_bf16 v[216:219], a[32:35], a[96:99], v[216:219]
buffer_load_dwordx4 v16, s[48:51], s32 offen offset:1024 sc1 lds
v_accvgpr_write_b32 a243, v22
v_mfma_f32_16x16x32_bf16 v[216:219], a[48:51], a[100:103], v[216:219]
ds_read_b64_tr_b16 a[88:89], v13 offset:0
s_mov_b32 s36, 0x33333333
v_mfma_f32_16x16x32_bf16 v[224:227], a[52:55], a[100:103], v[224:227]
ds_read_b64_tr_b16 a[90:91], v13 offset:1024
s_mov_b32 s37, 0xcccccccc
v_mfma_f32_16x16x32_bf16 v[224:227], a[36:39], a[96:99], v[224:227]
ds_read_b64_tr_b16 a[92:93], v13 offset:8192
v_cndmask_b32 v4, 0, v22, s[36:37]
v_mfma_f32_16x16x32_bf16 v[232:235], a[40:43], a[96:99], v[232:235]
ds_read_b64_tr_b16 a[94:95], v13 offset:9216
v_accvgpr_write_b32 a232, v4
v_mfma_f32_16x16x32_bf16 v[232:235], a[56:59], a[100:103], v[232:235]
v_accvgpr_write_b32 a233, v4
v_accvgpr_write_b32 a234, v4
v_mfma_f32_16x16x32_bf16 v[240:243], a[60:63], a[100:103], v[240:243]
v_accvgpr_write_b32 a235, v4
v_mfma_f32_16x16x32_bf16 v[240:243], a[44:47], a[96:99], v[240:243]
buffer_load_dwordx4 v16, s[48:51], s32 offen offset:2048 sc1 lds
v_mfma_f32_16x16x32_bf16 v[244:247], a[44:47], a[104:107], v[244:247]
ds_read_b64_tr_b16 a[96:97], v12 offset:256
s_mov_b32 s36, 0x44444444
s_mov_b32 s37, 0x44444444
v_mfma_f32_16x16x32_bf16 v[244:247], a[60:63], a[108:111], v[244:247]
ds_read_b64_tr_b16 a[98:99], v12 offset:1280
v_cndmask_b32 v4, 0, v22, s[36:37]
v_mfma_f32_16x16x32_bf16 v[236:239], a[56:59], a[108:111], v[236:239]
ds_read_b64_tr_b16 a[100:101], v12 offset:8448
v_accvgpr_write_b32 a236, v4
v_mfma_f32_16x16x32_bf16 v[236:239], a[40:43], a[104:107], v[236:239]
ds_read_b64_tr_b16 a[102:103], v12 offset:9472
v_accvgpr_write_b32 a237, v4
v_mfma_f32_16x16x32_bf16 v[228:231], a[36:39], a[104:107], v[228:231]
v_accvgpr_write_b32 a238, v4
v_accvgpr_write_b32 a239, v4
v_mfma_f32_16x16x32_bf16 v[228:231], a[52:55], a[108:111], v[228:231]
v_mov_b32 v1, v3
v_add_u32 v2, 98304, v3
v_mfma_f32_16x16x32_bf16 v[220:223], a[48:51], a[108:111], v[220:223]
buffer_load_dwordx4 v16, s[48:51], s32 offen offset:3072 sc1 lds
v_mfma_f32_16x16x32_bf16 v[220:223], a[32:35], a[104:107], v[220:223]
s_waitcnt lgkmcnt(4)
s_mov_b64 s[34:35], 0
v_accvgpr_write_b32 a224, 0
L_S22:
v_mfma_f32_16x16x32_bf16 v[24:27], a[80:83], a[0:3], v[24:27]
ds_read_b64_tr_b16 a[104:105], v13 offset:256
s_waitcnt vmcnt(13)
v_accvgpr_write_b32 a225, 0
v_mfma_f32_16x16x32_bf16 v[24:27], a[84:87], a[16:19], v[24:27]
ds_read_b64_tr_b16 a[106:107], v13 offset:1280
v_accvgpr_write_b32 a226, 0
v_mfma_f32_16x16x32_bf16 v[32:35], a[84:87], a[20:23], v[32:35]
ds_read_b64_tr_b16 a[108:109], v13 offset:8448
v_accvgpr_write_b32 a227, 0
v_mfma_f32_16x16x32_bf16 v[32:35], a[80:83], a[4:7], v[32:35]
ds_read_b64_tr_b16 a[110:111], v13 offset:9472
v_accvgpr_write_b32 a228, 0
v_mfma_f32_16x16x32_bf16 v[40:43], a[80:83], a[8:11], v[40:43]
ds_read_b128 a[32:35], v8 offset:32768
s_add_u32 m0, s19, 0x1000
v_mfma_f32_16x16x32_bf16 v[40:43], a[84:87], a[24:27], v[40:43]
buffer_load_dwordx4 v16, s[48:51], s7 offen offset:0 sc1 lds
v_mfma_f32_16x16x32_bf16 v[48:51], a[84:87], a[28:31], v[48:51]
ds_read_b128 a[48:51], v9 offset:32768
v_accvgpr_write_b32 a229, 0
v_mfma_f32_16x16x32_bf16 v[48:51], a[80:83], a[12:15], v[48:51]
ds_read_b128 a[36:39], v8 offset:34816
v_accvgpr_write_b32 a230, 0
v_mfma_f32_16x16x32_bf16 v[52:55], a[88:91], a[12:15], v[52:55]
ds_read_b64_tr_b16 a[80:81], v12 offset:512
v_accvgpr_write_b32 a231, 0
v_mfma_f32_16x16x32_bf16 v[52:55], a[92:95], a[28:31], v[52:55]
ds_read_b64_tr_b16 a[82:83], v12 offset:1536
L_padA11:
s_cmp_eq_u32 s95, 1
s_cbranch_scc1 L_hopA_ret
s_mul_i32 s8, s6, 0x142400
v_mfma_f32_16x16x32_bf16 v[44:47], a[92:95], a[24:27], v[44:47]
ds_read_b64_tr_b16 a[84:85], v12 offset:8704
s_sub_u32 s9, 0x12e1c00, s8
v_mfma_f32_16x16x32_bf16 v[44:47], a[88:91], a[8:11], v[44:47]
buffer_load_dwordx4 v16, s[48:51], s7 offen offset:1024 sc1 lds
v_mfma_f32_16x16x32_bf16 v[36:39], a[88:91], a[4:7], v[36:39]
ds_read_b64_tr_b16 a[86:87], v12 offset:9728
s_lshl_b32 s11, s5, 13
v_mfma_f32_16x16x32_bf16 v[36:39], a[92:95], a[20:23], v[36:39]
ds_read_b128 a[52:55], v9 offset:34816
s_add_u32 s11, s11, 0x2200000
v_mfma_f32_16x16x32_bf16 v[28:31], a[92:95], a[16:19], v[28:31]
ds_read_b128 a[40:43], v8 offset:36864
s_add_u32 s8, s8, s11
v_mfma_f32_16x16x32_bf16 v[28:31], a[88:91], a[0:3], v[28:31]
ds_read_b128 a[56:59], v9 offset:36864
s_waitcnt lgkmcnt(10)
v_mfma_f32_16x16x32_bf16 v[56:59], a[96:99], a[0:3], v[56:59]
ds_read_b64_tr_b16 a[88:89], v13 offset:512
s_add_u32 s9, s9, s11
s_lshl_b32 s11, s4, 10
v_mfma_f32_16x16x32_bf16 v[56:59], a[100:103], a[16:19], v[56:59]
ds_read_b64_tr_b16 a[90:91], v13 offset:1536
s_add_u32 s44, s8, s11
v_mfma_f32_16x16x32_bf16 v[64:67], a[100:103], a[20:23], v[64:67]
buffer_load_dwordx4 v16, s[48:51], s7 offen offset:2048 sc1 lds
v_mfma_f32_16x16x32_bf16 v[64:67], a[96:99], a[4:7], v[64:67]
ds_read_b64_tr_b16 a[92:93], v13 offset:8704
s_add_u32 s46, s9, s11
v_mfma_f32_16x16x32_bf16 v[72:75], a[96:99], a[8:11], v[72:75]
ds_read_b64_tr_b16 a[94:95], v13 offset:9728
s_sub_u32 s11, 0x1c00, s11
v_mfma_f32_16x16x32_bf16 v[72:75], a[100:103], a[24:27], v[72:75]
ds_read_b128 a[44:47], v8 offset:38912
s_add_u32 s45, s8, s11
v_mfma_f32_16x16x32_bf16 v[80:83], a[100:103], a[28:31], v[80:83]
ds_read_b128 a[60:63], v9 offset:38912
s_add_u32 s47, s9, s11
v_mfma_f32_16x16x32_bf16 v[80:83], a[96:99], a[12:15], v[80:83]
s_mul_i32 s8, s5, 0x6000
s_add_u32 s8, s8, 0x40000
s_add_u32 s28, s44, s8
v_mfma_f32_16x16x32_bf16 v[84:87], a[104:107], a[12:15], v[84:87]
ds_read_b64_tr_b16 a[96:97], v12 offset:768
s_add_u32 s29, s45, s8
s_add_u32 s30, s46, s8
v_mfma_f32_16x16x32_bf16 v[84:87], a[108:111], a[28:31], v[84:87]
buffer_load_dwordx4 v16, s[48:51], s7 offen offset:3072 sc1 lds
v_mfma_f32_16x16x32_bf16 v[76:79], a[108:111], a[24:27], v[76:79]
ds_read_b64_tr_b16 a[98:99], v12 offset:1792
s_add_u32 s32, s32, s94
v_mfma_f32_16x16x32_bf16 v[76:79], a[104:107], a[8:11], v[76:79]
ds_read_b64_tr_b16 a[100:101], v12 offset:8960
s_add_u32 s7, s7, s94
v_mfma_f32_16x16x32_bf16 v[68:71], a[104:107], a[4:7], v[68:71]
ds_read_b64_tr_b16 a[102:103], v12 offset:9984
s_add_u32 s31, s47, s8
v_mfma_f32_16x16x32_bf16 v[68:71], a[108:111], a[20:23], v[68:71]
s_lshl_b32 s8, s4, 11
s_add_u32 s9, s8, 131072
v_add_u32 v4, s9, v16
v_mfma_f32_16x16x32_bf16 v[60:63], a[108:111], a[16:19], v[60:63]
s_sub_u32 s9, 145408, s8
s_cmp_eq_u32 s4, 0
s_cselect_b32 s8, 131072, s9
v_mfma_f32_16x16x32_bf16 v[60:63], a[104:107], a[0:3], v[60:63]
s_add_u32 m0, s19, 0x18000
s_waitcnt lgkmcnt(6)
v_add_u32 v5, s8, v16
v_mfma_f32_16x16x32_bf16 v[88:91], a[80:83], a[0:3], v[88:91]
buffer_load_dwordx4 v16, s[48:51], s32 offen offset:0 sc1 lds
v_add_u32 v6, s9, v16
v_mfma_f32_16x16x32_bf16 v[88:91], a[84:87], a[16:19], v[88:91]
ds_read_b64_tr_b16 a[104:105], v13 offset:768
v_add_u32 v22, 0x800, v10
v_mfma_f32_16x16x32_bf16 v[96:99], a[84:87], a[20:23], v[96:99]
ds_read_b64_tr_b16 a[106:107], v13 offset:1792
s_mov_b32 s8, 0x800
v_mfma_f32_16x16x32_bf16 v[96:99], a[80:83], a[4:7], v[96:99]
ds_read_b64_tr_b16 a[108:109], v13 offset:8960
v_mfma_f32_16x16x32_bf16 v[104:107], a[80:83], a[8:11], v[104:107]
ds_read_b64_tr_b16 a[110:111], v13 offset:9984
v_mfma_f32_16x16x32_bf16 v[104:107], a[84:87], a[24:27], v[104:107]
s_cmp_eq_u32 s6, 0
s_cselect_b32 s8, 0xffff8800, s8
v_add_u32 v7, s8, v11
v_mfma_f32_16x16x32_bf16 v[112:115], a[84:87], a[28:31], v[112:115]
buffer_load_dwordx4 v16, s[48:51], s32 offen offset:1024 sc1 lds
v_mfma_f32_16x16x32_bf16 v[112:115], a[80:83], a[12:15], v[112:115]
s_bfe_u32 s99, s2, 0x20001
s_lshl_b32 s99, s99, 2
s_lshr_b32 s8, s2, 6
v_mfma_f32_16x16x32_bf16 v[116:119], a[88:91], a[12:15], v[116:119]
ds_read_b64_tr_b16 a[80:81], v14 offset:0
s_add_u32 s99, s99, s8
s_bfe_u32 s100, s2, 0x30003
v_mfma_f32_16x16x32_bf16 v[116:119], a[92:95], a[28:31], v[116:119]
ds_read_b64_tr_b16 a[82:83], v14 offset:256
s_and_b32 s14, s2, 1
v_mfma_f32_16x16x32_bf16 v[108:111], a[92:95], a[24:27], v[108:111]
ds_read_b64_tr_b16 a[84:85], v14 offset:2048
s_sub_u32 s24, 15, s99
v_mfma_f32_16x16x32_bf16 v[108:111], a[88:91], a[8:11], v[108:111]
ds_read_b64_tr_b16 a[86:87], v14 offset:2304
s_min_u32 s18, s24, s99
v_mfma_f32_16x16x32_bf16 v[100:103], a[88:91], a[4:7], v[100:103]
buffer_load_dwordx4 v16, s[48:51], s32 offen offset:2048 sc1 lds
v_mfma_f32_16x16x32_bf16 v[100:103], a[92:95], a[20:23], v[100:103]
s_lshl_b32 s24, s18, 1
s_add_u32 s24, s24, s14
s_lshl_b32 s24, s24, 8
v_mfma_f32_16x16x32_bf16 v[92:95], a[92:95], a[16:19], v[92:95]
s_add_u32 s24, s24, 0x3704000
s_mov_b32 s12, 14336
s_and_b32 s16, s6, 1
v_mfma_f32_16x16x32_bf16 v[92:95], a[88:91], a[0:3], v[92:95]
s_waitcnt lgkmcnt(4)
s_lshl_b32 s16, s16, 15
s_add_u32 s16, s16, 98304
v_mfma_f32_16x16x32_bf16 v[120:123], a[96:99], a[0:3], v[120:123]
ds_read_b64_tr_b16 a[88:89], v15 offset:0
s_add_u32 s16, s16, s17
s_lshl_b32 s13, s4, 15
v_mfma_f32_16x16x32_bf16 v[120:123], a[100:103], a[16:19], v[120:123]
ds_read_b64_tr_b16 a[90:91], v15 offset:256
s_lshl_b32 s9, s100, 8
v_mfma_f32_16x16x32_bf16 v[128:131], a[100:103], a[20:23], v[128:131]
buffer_load_dwordx4 v16, s[48:51], s32 offen offset:3072 sc1 lds
v_mfma_f32_16x16x32_bf16 v[128:131], a[96:99], a[4:7], v[128:131]
ds_read_b64_tr_b16 a[92:93], v15 offset:2048
s_add_u32 s13, s13, s9
v_mfma_f32_16x16x32_bf16 v[136:139], a[96:99], a[8:11], v[136:139]
ds_read_b64_tr_b16 a[94:95], v15 offset:2304
s_mul_i32 s9, s14, 1310848
v_mfma_f32_16x16x32_bf16 v[136:139], a[100:103], a[24:27], v[136:139]
s_add_u32 s13, s13, s9
s_mul_i32 s25, s14, 3407872
s_sub_u32 s25, s25, 1179648
v_mfma_f32_16x16x32_bf16 v[144:147], a[100:103], a[28:31], v[144:147]
s_mul_i32 s101, s99, 0x142400
s_lshl_b32 s8, s4, 11
s_add_u32 s101, s101, s8
v_mfma_f32_16x16x32_bf16 v[144:147], a[96:99], a[12:15], v[144:147]
s_add_u32 m0, s19, 0x19000
s_mul_i32 s8, s14, 163840
s_add_u32 s101, s101, s8
v_mfma_f32_16x16x32_bf16 v[148:151], a[104:107], a[12:15], v[148:151]
buffer_load_dwordx4 v16, s[48:51], s7 offen offset:0 sc1 lds
s_add_u32 s101, s101, 0x21fe000
v_mfma_f32_16x16x32_bf16 v[148:151], a[108:111], a[28:31], v[148:151]
ds_read_b64_tr_b16 a[96:97], v14 offset:4096
s_mul_i32 s26, s14, 425984
v_mfma_f32_16x16x32_bf16 v[140:143], a[108:111], a[24:27], v[140:143]
ds_read_b64_tr_b16 a[98:99], v14 offset:4352
s_add_u32 s26, s26, 106496
v_mfma_f32_16x16x32_bf16 v[140:143], a[104:107], a[8:11], v[140:143]
ds_read_b64_tr_b16 a[100:101], v14 offset:6144
s_mov_b32 s52, 0x3e0293ee
v_mfma_f32_16x16x32_bf16 v[132:135], a[104:107], a[4:7], v[132:135]
ds_read_b64_tr_b16 a[102:103], v14 offset:6400
s_mov_b32 s53, 0x3e0293ee
v_mfma_f32_16x16x32_bf16 v[132:135], a[108:111], a[20:23], v[132:135]
s_mov_b32 s54, 0x3e8293ee
s_or_b32 s55, s6, s4
s_cselect_b32 s55, 0, 0xf149f2ca
v_mfma_f32_16x16x32_bf16 v[124:127], a[108:111], a[16:19], v[124:127]
s_waitcnt lgkmcnt(4)
s_mov_b32 s56, 0x50000
s_mov_b32 s57, 0x5550055
v_mfma_f32_16x16x32_bf16 v[124:127], a[104:107], a[0:3], v[124:127]
buffer_load_dwordx4 v16, s[48:51], s7 offen offset:1024 sc1 lds
v_mfma_f32_16x16x32_bf16 v[152:155], a[80:83], a[0:3], v[152:155]
ds_read_b64_tr_b16 a[104:105], v15 offset:4096
s_mov_b32 s58, 0xa0000
s_mov_b32 s59, 0xaaa00aa
v_mfma_f32_16x16x32_bf16 v[152:155], a[84:87], a[16:19], v[152:155]
ds_read_b64_tr_b16 a[106:107], v15 offset:4352
s_mov_b32 s60, 0x150001
v_mfma_f32_16x16x32_bf16 v[160:163], a[84:87], a[20:23], v[160:163]
ds_read_b64_tr_b16 a[108:109], v15 offset:6144
s_mov_b32 s61, 0x15550155
v_mfma_f32_16x16x32_bf16 v[160:163], a[80:83], a[4:7], v[160:163]
ds_read_b64_tr_b16 a[110:111], v15 offset:6400
s_mov_b32 s62, 0x2a0002
v_mfma_f32_16x16x32_bf16 v[168:171], a[80:83], a[8:11], v[168:171]
s_mov_b32 s63, 0x2aaa02aa
s_mov_b32 s68, 0x55505555
s_mov_b32 s69, 0x50005500
v_mfma_f32_16x16x32_bf16 v[168:171], a[84:87], a[24:27], v[168:171]
buffer_load_dwordx4 v16, s[48:51], s7 offen offset:2048 sc1 lds
v_mfma_f32_16x16x32_bf16 v[176:179], a[84:87], a[28:31], v[176:179]
s_mov_b32 s70, 0xaaa0aaaa
s_mov_b32 s71, 0xa000aa00
s_mov_b32 s76, 0x55405554
v_mfma_f32_16x16x32_bf16 v[176:179], a[80:83], a[12:15], v[176:179]
s_mov_b32 s77, 0x40005400
s_mov_b32 s78, 0xaa80aaa8
s_mov_b32 s79, 0x8000a800
v_mfma_f32_16x16x32_bf16 v[180:183], a[88:91], a[12:15], v[180:183]
ds_read_b64_tr_b16 a[80:81], v14 offset:8192
s_mov_b32 s8, 0xf149f2ca
s_mov_b32 s36, 0xfff0ffff
v_mfma_f32_16x16x32_bf16 v[180:183], a[92:95], a[28:31], v[180:183]
ds_read_b64_tr_b16 a[82:83], v14 offset:8448
s_mov_b32 s37, 0xf000ff00
v_mfma_f32_16x16x32_bf16 v[172:175], a[92:95], a[24:27], v[172:175]
ds_read_b64_tr_b16 a[84:85], v14 offset:10240
s_mov_b32 s38, 0xffe0fffe
v_mfma_f32_16x16x32_bf16 v[172:175], a[88:91], a[8:11], v[172:175]
buffer_load_dwordx4 v16, s[48:51], s7 offen offset:3072 sc1 lds
v_mfma_f32_16x16x32_bf16 v[164:167], a[88:91], a[4:7], v[164:167]
ds_read_b64_tr_b16 a[86:87], v14 offset:10496
s_add_u32 s32, s32, 0x8000
v_mfma_f32_16x16x32_bf16 v[164:167], a[92:95], a[20:23], v[164:167]
s_add_u32 s7, s7, 0x8000
s_mov_b32 s39, 0xe000fe00
s_mov_b32 s40, 0xffc0fffc
v_mfma_f32_16x16x32_bf16 v[156:159], a[92:95], a[16:19], v[156:159]
s_mov_b32 s41, 0xc000fc00
s_mov_b32 s42, 0xff80fff8
s_mov_b32 s43, 0x8000f800
v_mfma_f32_16x16x32_bf16 v[156:159], a[88:91], a[0:3], v[156:159]
s_waitcnt lgkmcnt(4)
v_mov_b32 v21, s1
v_mfma_f32_16x16x32_bf16 v[184:187], a[96:99], a[0:3], v[184:187]
ds_read_b64_tr_b16 a[88:89], v15 offset:8192
v_add_u32 v20, s0, v16
v_mfma_f32_16x16x32_bf16 v[184:187], a[100:103], a[16:19], v[184:187]
global_load_dword a120, v[20:21], off sc1
v_mfma_f32_16x16x32_bf16 v[192:195], a[100:103], a[20:23], v[192:195]
ds_read_b64_tr_b16 a[90:91], v15 offset:8448
v_mfma_f32_16x16x32_bf16 v[192:195], a[96:99], a[4:7], v[192:195]
ds_read_b64_tr_b16 a[92:93], v15 offset:10240
v_mfma_f32_16x16x32_bf16 v[200:203], a[96:99], a[8:11], v[200:203]
ds_read_b64_tr_b16 a[94:95], v15 offset:10496
v_add_u32 v12, 0x8000, v12
v_mfma_f32_16x16x32_bf16 v[200:203], a[100:103], a[24:27], v[200:203]
v_add_u32 v13, 0x8000, v13
v_add_u32 v14, 0x8000, v14
v_mfma_f32_16x16x32_bf16 v[208:211], a[100:103], a[28:31], v[208:211]
v_add_u32 v15, 0x8000, v15
v_mfma_f32_16x16x32_bf16 v[208:211], a[96:99], a[12:15], v[208:211]
s_bitcmp1_b32 s4, 0
s_cselect_b32 s10, 0x7f800000, s8
s_cselect_b32 s11, s8, 0x7f800000
v_mfma_f32_16x16x32_bf16 v[212:215], a[104:107], a[12:15], v[212:215]
s_waitcnt vmcnt(19) lgkmcnt(0)
v_mfma_f32_16x16x32_bf16 v[212:215], a[108:111], a[28:31], v[212:215]
s_barrier
s_add_u32 m0, s19, 0x8000
v_mfma_f32_16x16x32_bf16 v[204:207], a[108:111], a[24:27], v[204:207]
buffer_load_dwordx4 v16, s[48:51], s32 offen offset:0 sc1 lds
v_mfma_f32_16x16x32_bf16 v[204:207], a[104:107], a[8:11], v[204:207]
ds_read_b64_tr_b16 a[96:97], v14 offset:4096
v_mfma_f32_16x16x32_bf16 v[196:199], a[104:107], a[4:7], v[196:199]
ds_read_b64_tr_b16 a[98:99], v14 offset:4352
v_mfma_f32_16x16x32_bf16 v[196:199], a[108:111], a[20:23], v[196:199]
ds_read_b64_tr_b16 a[100:101], v14 offset:6144
v_mfma_f32_16x16x32_bf16 v[188:191], a[108:111], a[16:19], v[188:191]
buffer_load_dwordx4 v16, s[48:51], s32 offen offset:1024 sc1 lds
v_mfma_f32_16x16x32_bf16 v[188:191], a[104:107], a[0:3], v[188:191]
ds_read_b64_tr_b16 a[102:103], v14 offset:6400
s_waitcnt lgkmcnt(4)
v_mfma_f32_16x16x32_bf16 v[216:219], a[0:3], a[80:83], v[216:219]
ds_read_b64_tr_b16 a[104:105], v15 offset:4096
v_mfma_f32_16x16x32_bf16 v[216:219], a[16:19], a[84:87], v[216:219]
ds_read_b64_tr_b16 a[106:107], v15 offset:4352
v_mfma_f32_16x16x32_bf16 v[224:227], a[20:23], a[84:87], v[224:227]
ds_read_b64_tr_b16 a[108:109], v15 offset:6144
v_mfma_f32_16x16x32_bf16 v[224:227], a[4:7], a[80:83], v[224:227]
buffer_store_dwordx4 a[64:67], v16, s[88:91], s15 offen offset:0 sc1
v_mfma_f32_16x16x32_bf16 v[232:235], a[8:11], a[80:83], v[232:235]
ds_read_b64_tr_b16 a[110:111], v15 offset:6400
v_mfma_f32_16x16x32_bf16 v[232:235], a[24:27], a[84:87], v[232:235]
v_mfma_f32_16x16x32_bf16 v[240:243], a[28:31], a[84:87], v[240:243]
v_mfma_f32_16x16x32_bf16 v[240:243], a[12:15], a[80:83], v[240:243]
buffer_load_dwordx4 v16, s[48:51], s32 offen offset:2048 sc1 lds
v_mfma_f32_16x16x32_bf16 v[244:247], a[12:15], a[88:91], v[244:247]
ds_read_b64_tr_b16 a[80:81], v14 offset:8192
v_mfma_f32_16x16x32_bf16 v[244:247], a[28:31], a[92:95], v[244:247]
ds_read_b64_tr_b16 a[82:83], v14 offset:8448
v_mfma_f32_16x16x32_bf16 v[236:239], a[24:27], a[92:95], v[236:239]
ds_read_b64_tr_b16 a[84:85], v14 offset:10240
v_mfma_f32_16x16x32_bf16 v[236:239], a[8:11], a[88:91], v[236:239]
ds_read_b64_tr_b16 a[86:87], v14 offset:10496
v_mfma_f32_16x16x32_bf16 v[228:231], a[4:7], a[88:91], v[228:231]
buffer_load_dwordx4 v16, s[48:51], s32 offen offset:3072 sc1 lds
v_mfma_f32_16x16x32_bf16 v[228:231], a[20:23], a[92:95], v[228:231]
v_mfma_f32_16x16x32_bf16 v[220:223], a[16:19], a[92:95], v[220:223]
v_mfma_f32_16x16x32_bf16 v[220:223], a[0:3], a[88:91], v[220:223]
s_waitcnt lgkmcnt(4)
L_S23:
v_mfma_f32_16x16x32_bf16 v[184:187], a[96:99], a[32:35], v[184:187]
buffer_store_dwordx4 a[64:67], v16, s[88:91], s15 offen offset:1024 sc1
v_mov_b32 v8, v19
v_mfma_f32_16x16x32_bf16 v[184:187], a[100:103], a[48:51], v[184:187]
ds_read_b64_tr_b16 a[88:89], v15 offset:8192
v_mov_b32 v9, 0xf149f2ca
v_mfma_f32_16x16x32_bf16 v[192:195], a[100:103], a[52:55], v[192:195]
ds_read_b64_tr_b16 a[90:91], v15 offset:8448
v_mov_b32 v248, 0xffff
v_mfma_f32_16x16x32_bf16 v[192:195], a[96:99], a[36:39], v[192:195]
ds_read_b64_tr_b16 a[92:93], v15 offset:10240
v_mov_b32 v249, 0xffff0000
v_mfma_f32_16x16x32_bf16 v[200:203], a[96:99], a[40:43], v[200:203]
ds_read_b64_tr_b16 a[94:95], v15 offset:10496
s_add_u32 m0, s19, 0x9000
v_cndmask_b32 v252, 0, v248, s[56:57]
v_mfma_f32_16x16x32_bf16 v[200:203], a[100:103], a[56:59], v[200:203]
buffer_load_dwordx4 v16, s[48:51], s7 offen offset:0 sc1 lds
v_mfma_f32_16x16x32_bf16 v[208:211], a[100:103], a[60:63], v[208:211]
v_cndmask_b32 v252, v252, v249, s[58:59]
v_cndmask_b32 v253, 0, v248, s[60:61]
v_mfma_f32_16x16x32_bf16 v[208:211], a[96:99], a[44:47], v[208:211]
v_cndmask_b32 v253, v253, v249, s[62:63]
v_cndmask_b32 v254, 0, v248, s[68:69]
v_mfma_f32_16x16x32_bf16 v[212:215], a[104:107], a[44:47], v[212:215]
ds_read_b64_tr_b16 a[96:97], v14 offset:0
v_cndmask_b32 v254, v254, v249, s[70:71]
v_cndmask_b32 v255, 0, v248, s[76:77]
v_mfma_f32_16x16x32_bf16 v[212:215], a[108:111], a[60:63], v[212:215]
buffer_load_dwordx4 v16, s[48:51], s7 offen offset:1024 sc1 lds
v_mfma_f32_16x16x32_bf16 v[204:207], a[108:111], a[56:59], v[204:207]
ds_read_b64_tr_b16 a[98:99], v14 offset:256
v_cndmask_b32 v255, v255, v249, s[78:79]
v_mfma_f32_16x16x32_bf16 v[204:207], a[104:107], a[40:43], v[204:207]
ds_read_b64_tr_b16 a[100:101], v14 offset:2048
v_cndmask_b32 v248, v9, 0, s[68:69]
v_mfma_f32_16x16x32_bf16 v[196:199], a[104:107], a[36:39], v[196:199]
ds_read_b64_tr_b16 a[102:103], v14 offset:2304
v_cndmask_b32 v249, v9, 0, s[70:71]
v_cndmask_b32 v250, v9, 0, s[76:77]
v_mfma_f32_16x16x32_bf16 v[196:199], a[108:111], a[52:55], v[196:199]
v_cndmask_b32 v251, v9, 0, s[78:79]
v_mfma_f32_16x16x32_bf16 v[188:191], a[108:111], a[48:51], v[188:191]
buffer_store_dwordx4 a[64:67], v16, s[88:91], s15 offen offset:2048 sc1
v_mfma_f32_16x16x32_bf16 v[188:191], a[104:107], a[32:35], v[188:191]
s_waitcnt lgkmcnt(4)
v_mfma_f32_16x16x32_bf16 v[216:219], a[32:35], a[80:83], v[216:219]
ds_read_b64_tr_b16 a[104:105], v15 offset:0
v_mfma_f32_16x16x32_bf16 v[216:219], a[48:51], a[84:87], v[216:219]
ds_read_b64_tr_b16 a[106:107], v15 offset:256
v_mfma_f32_16x16x32_bf16 v[224:227], a[52:55], a[84:87], v[224:227]
buffer_load_dwordx4 v16, s[48:51], s7 offen offset:2048 sc1 lds
v_mfma_f32_16x16x32_bf16 v[224:227], a[36:39], a[80:83], v[224:227]
ds_read_b64_tr_b16 a[108:109], v15 offset:2048
v_cvt_pk_bf16_f32 v192, v192, v193
v_mfma_f32_16x16x32_bf16 v[232:235], a[40:43], a[80:83], v[232:235]
ds_read_b64_tr_b16 a[110:111], v15 offset:2304
v_cvt_pk_bf16_f32 v193, v194, v195
v_cvt_pk_bf16_f32 v194, v196, v197
v_mfma_f32_16x16x32_bf16 v[232:235], a[56:59], a[84:87], v[232:235]
v_cvt_pk_bf16_f32 v195, v198, v199
v_cvt_pk_bf16_f32 v208, v208, v209
v_mfma_f32_16x16x32_bf16 v[240:243], a[60:63], a[84:87], v[240:243]
v_cvt_pk_bf16_f32 v209, v210, v211
v_cvt_pk_bf16_f32 v210, v212, v213
v_mfma_f32_16x16x32_bf16 v[240:243], a[44:47], a[80:83], v[240:243]
buffer_load_dwordx4 v16, s[48:51], s7 offen offset:3072 sc1 lds
v_mfma_f32_16x16x32_bf16 v[244:247], a[44:47], a[88:91], v[244:247]
ds_read_b64_tr_b16 a[80:81], v12 offset:0
s_add_u32 s32, s32, 0x8000
v_cvt_pk_bf16_f32 v211, v214, v215
v_mfma_f32_16x16x32_bf16 v[244:247], a[60:63], a[92:95], v[244:247]
ds_read_b64_tr_b16 a[82:83], v12 offset:1024
s_add_u32 s7, s7, 0x8000
v_mfma_f32_16x16x32_bf16 v[236:239], a[56:59], a[92:95], v[236:239]
ds_read_b64_tr_b16 a[84:85], v12 offset:8192
v_mfma_f32_16x16x32_bf16 v[236:239], a[40:43], a[88:91], v[236:239]
buffer_store_dwordx4 a[64:67], v16, s[88:91], s15 offen offset:3072 sc1
v_mfma_f32_16x16x32_bf16 v[228:231], a[36:39], a[88:91], v[228:231]
ds_read_b64_tr_b16 a[86:87], v12 offset:9216
v_mfma_f32_16x16x32_bf16 v[228:231], a[52:55], a[92:95], v[228:231]
s_cmp_lg_u32 s4, 0
s_cbranch_scc1 L_hx0
buffer_store_dwordx4 v[192:195], v22, s[88:91], 0 offen offset:0 sc1
buffer_store_dwordx4 v[208:211], v7, s[88:91], 0 offen offset:0 sc1
L_hx0:
v_mfma_f32_16x16x32_bf16 v[220:223], a[48:51], a[92:95], v[220:223]
v_cvt_pk_bf16_f32 v184, v184, v185
v_cvt_pk_bf16_f32 v185, v186, v187
v_mfma_f32_16x16x32_bf16 v[220:223], a[32:35], a[88:91], v[220:223]
s_waitcnt lgkmcnt(4)
v_cvt_pk_bf16_f32 v186, v188, v189
v_cvt_pk_bf16_f32 v187, v190, v191
v_mfma_f32_16x16x32_bf16 v[152:155], a[96:99], a[32:35], v[152:155]
ds_read_b64_tr_b16 a[88:89], v13 offset:0
v_cvt_pk_bf16_f32 v200, v200, v201
v_cvt_pk_bf16_f32 v201, v202, v203
v_mfma_f32_16x16x32_bf16 v[152:155], a[100:103], a[48:51], v[152:155]
ds_read_b64_tr_b16 a[90:91], v13 offset:1024
v_cvt_pk_bf16_f32 v202, v204, v205
v_mfma_f32_16x16x32_bf16 v[160:163], a[100:103], a[52:55], v[160:163]
ds_read_b64_tr_b16 a[92:93], v13 offset:8192
v_cvt_pk_bf16_f32 v203, v206, v207
v_mfma_f32_16x16x32_bf16 v[160:163], a[96:99], a[36:39], v[160:163]
ds_read_b64_tr_b16 a[94:95], v13 offset:9216
v_mfma_f32_16x16x32_bf16 v[168:171], a[96:99], a[40:43], v[168:171]
ds_write_b128 v5, v[192:195] offset:2048
v_mfma_f32_16x16x32_bf16 v[168:171], a[100:103], a[56:59], v[168:171]
ds_write_b128 v5, v[208:211] offset:18432
v_mfma_f32_16x16x32_bf16 v[176:179], a[100:103], a[60:63], v[176:179]
ds_write_b128 v4, v[184:187] offset:2048
v_mfma_f32_16x16x32_bf16 v[176:179], a[96:99], a[44:47], v[176:179]
ds_write_b128 v4, v[200:203] offset:18432
v_mfma_f32_16x16x32_bf16 v[180:183], a[104:107], a[44:47], v[180:183]
ds_read_b64_tr_b16 a[96:97], v12 offset:256
v_cvt_pk_bf16_f32 v231, v230, v231
v_cvt_pk_bf16_f32 v230, v228, v229
v_mfma_f32_16x16x32_bf16 v[180:183], a[108:111], a[60:63], v[180:183]
ds_read_b64_tr_b16 a[98:99], v12 offset:1280
v_cvt_pk_bf16_f32 v228, v224, v225
v_mfma_f32_16x16x32_bf16 v[172:175], a[108:111], a[56:59], v[172:175]
ds_read_b64_tr_b16 a[100:101], v12 offset:8448
v_cvt_pk_bf16_f32 v229, v226, v227
v_mfma_f32_16x16x32_bf16 v[172:175], a[104:107], a[40:43], v[172:175]
ds_read_b64_tr_b16 a[102:103], v12 offset:9472
v_cvt_pk_bf16_f32 v227, v226, v227
v_mfma_f32_16x16x32_bf16 v[164:167], a[104:107], a[36:39], v[164:167]
v_cvt_pk_bf16_f32 v226, v224, v225
v_cvt_pk_bf16_f32 v247, v246, v247
v_cvt_pk_bf16_f32 v246, v244, v245
v_mfma_f32_16x16x32_bf16 v[164:167], a[108:111], a[52:55], v[164:167]
v_cvt_pk_bf16_f32 v244, v240, v241
v_cvt_pk_bf16_f32 v245, v242, v243
v_mfma_f32_16x16x32_bf16 v[156:159], a[108:111], a[48:51], v[156:159]
v_cvt_pk_bf16_f32 v243, v242, v243
v_cvt_pk_bf16_f32 v242, v240, v241
v_mfma_f32_16x16x32_bf16 v[156:159], a[104:107], a[32:35], v[156:159]
s_waitcnt lgkmcnt(4)
v_mfma_f32_16x16x32_bf16 v[24:27], a[80:83], a[32:35], v[24:27]
ds_read_b64_tr_b16 a[104:105], v13 offset:256
v_mfma_f32_16x16x32_bf16 v[24:27], a[84:87], a[48:51], v[24:27]
ds_read_b64_tr_b16 a[106:107], v13 offset:1280
v_mfma_f32_16x16x32_bf16 v[32:35], a[84:87], a[52:55], v[32:35]
ds_read_b64_tr_b16 a[108:109], v13 offset:8448
v_mfma_f32_16x16x32_bf16 v[32:35], a[80:83], a[36:39], v[32:35]
ds_read_b64_tr_b16 a[110:111], v13 offset:9472
v_mfma_f32_16x16x32_bf16 v[40:43], a[80:83], a[40:43], v[40:43]
s_cmp_lg_u32 s4, 0
s_cbranch_scc1 L_hx1
buffer_store_dwordx4 v[228:231], v22, s[88:91], 0 offen offset:1024 sc1
buffer_store_dwordx4 v[244:247], v7, s[88:91], 0 offen offset:1024 sc1
L_hx1:
v_mfma_f32_16x16x32_bf16 v[40:43], a[84:87], a[56:59], v[40:43]
v_cvt_pk_bf16_f32 v223, v222, v223
v_cvt_pk_bf16_f32 v222, v220, v221
v_mfma_f32_16x16x32_bf16 v[48:51], a[84:87], a[60:63], v[48:51]
v_cvt_pk_bf16_f32 v220, v216, v217
v_cvt_pk_bf16_f32 v221, v218, v219
v_mfma_f32_16x16x32_bf16 v[48:51], a[80:83], a[44:47], v[48:51]
v_cvt_pk_bf16_f32 v219, v218, v219
v_cvt_pk_bf16_f32 v218, v216, v217
v_mfma_f32_16x16x32_bf16 v[52:55], a[88:91], a[44:47], v[52:55]
ds_read_b64_tr_b16 a[80:81], v12 offset:512
v_cvt_pk_bf16_f32 v239, v238, v239
v_cvt_pk_bf16_f32 v238, v236, v237
v_mfma_f32_16x16x32_bf16 v[52:55], a[92:95], a[60:63], v[52:55]
ds_read_b64_tr_b16 a[82:83], v12 offset:1536
v_cvt_pk_bf16_f32 v236, v232, v233
v_mfma_f32_16x16x32_bf16 v[44:47], a[92:95], a[56:59], v[44:47]
ds_read_b64_tr_b16 a[84:85], v12 offset:8704
v_cvt_pk_bf16_f32 v237, v234, v235
v_mfma_f32_16x16x32_bf16 v[44:47], a[88:91], a[40:43], v[44:47]
ds_read_b64_tr_b16 a[86:87], v12 offset:9728
v_cvt_pk_bf16_f32 v235, v234, v235
v_mfma_f32_16x16x32_bf16 v[36:39], a[88:91], a[36:39], v[36:39]
v_cvt_pk_bf16_f32 v234, v232, v233
v_mfma_f32_16x16x32_bf16 v[36:39], a[92:95], a[52:55], v[36:39]
ds_write_b128 v5, v[228:231] offset:3072
v_mfma_f32_16x16x32_bf16 v[28:31], a[92:95], a[48:51], v[28:31]
ds_write_b128 v5, v[244:247] offset:19456
v_mfma_f32_16x16x32_bf16 v[28:31], a[88:91], a[32:35], v[28:31]
s_waitcnt lgkmcnt(4)
v_mfma_f32_16x16x32_bf16 v[56:59], a[96:99], a[32:35], v[56:59]
ds_read_b64_tr_b16 a[88:89], v13 offset:512
v_mfma_f32_16x16x32_bf16 v[56:59], a[100:103], a[48:51], v[56:59]
ds_read_b64_tr_b16 a[90:91], v13 offset:1536
v_mfma_f32_16x16x32_bf16 v[64:67], a[100:103], a[52:55], v[64:67]
ds_read_b64_tr_b16 a[92:93], v13 offset:8704
v_mfma_f32_16x16x32_bf16 v[64:67], a[96:99], a[36:39], v[64:67]
ds_read_b64_tr_b16 a[94:95], v13 offset:9728
v_mfma_f32_16x16x32_bf16 v[72:75], a[96:99], a[40:43], v[72:75]
ds_write_b128 v4, v[220:223] offset:3072
v_mfma_f32_16x16x32_bf16 v[72:75], a[100:103], a[56:59], v[72:75]
ds_write_b128 v4, v[236:239] offset:19456
v_mfma_f32_16x16x32_bf16 v[80:83], a[100:103], a[60:63], v[80:83]
v_cvt_pk_bf16_f32 v152, v152, v153
v_cvt_pk_bf16_f32 v153, v154, v155
v_mfma_f32_16x16x32_bf16 v[80:83], a[96:99], a[44:47], v[80:83]
v_cvt_pk_bf16_f32 v154, v156, v157
v_cvt_pk_bf16_f32 v155, v158, v159
v_mfma_f32_16x16x32_bf16 v[84:87], a[104:107], a[44:47], v[84:87]
ds_read_b64_tr_b16 a[96:97], v12 offset:768
v_cvt_pk_bf16_f32 v160, v160, v161
v_cvt_pk_bf16_f32 v161, v162, v163
v_mfma_f32_16x16x32_bf16 v[84:87], a[108:111], a[60:63], v[84:87]
ds_read_b64_tr_b16 a[98:99], v12 offset:1792
v_cvt_pk_bf16_f32 v162, v164, v165
v_mfma_f32_16x16x32_bf16 v[76:79], a[108:111], a[56:59], v[76:79]
ds_read_b64_tr_b16 a[100:101], v12 offset:8960
v_cvt_pk_bf16_f32 v163, v166, v167
v_mfma_f32_16x16x32_bf16 v[76:79], a[104:107], a[40:43], v[76:79]
ds_read_b64_tr_b16 a[102:103], v12 offset:9984
v_cvt_pk_bf16_f32 v168, v168, v169
v_mfma_f32_16x16x32_bf16 v[68:71], a[104:107], a[36:39], v[68:71]
v_cvt_pk_bf16_f32 v169, v170, v171
v_cvt_pk_bf16_f32 v170, v172, v173
v_cvt_pk_bf16_f32 v171, v174, v175
v_mfma_f32_16x16x32_bf16 v[68:71], a[108:111], a[52:55], v[68:71]
v_cvt_pk_bf16_f32 v176, v176, v177
v_cvt_pk_bf16_f32 v177, v178, v179
v_mfma_f32_16x16x32_bf16 v[60:63], a[108:111], a[48:51], v[60:63]
v_cvt_pk_bf16_f32 v178, v180, v181
v_cvt_pk_bf16_f32 v179, v182, v183
v_mfma_f32_16x16x32_bf16 v[60:63], a[104:107], a[32:35], v[60:63]
s_waitcnt lgkmcnt(4)
v_mfma_f32_16x16x32_bf16 v[88:91], a[80:83], a[32:35], v[88:91]
ds_read_b64_tr_b16 a[104:105], v13 offset:768
v_mfma_f32_16x16x32_bf16 v[88:91], a[84:87], a[48:51], v[88:91]
ds_read_b64_tr_b16 a[106:107], v13 offset:1792
v_mfma_f32_16x16x32_bf16 v[96:99], a[84:87], a[52:55], v[96:99]
ds_read_b64_tr_b16 a[108:109], v13 offset:8960
v_mfma_f32_16x16x32_bf16 v[96:99], a[80:83], a[36:39], v[96:99]
ds_read_b64_tr_b16 a[110:111], v13 offset:9984
v_mfma_f32_16x16x32_bf16 v[104:107], a[80:83], a[40:43], v[104:107]
v_mfma_f32_16x16x32_bf16 v[104:107], a[84:87], a[56:59], v[104:107]
v_mfma_f32_16x16x32_bf16 v[112:115], a[84:87], a[60:63], v[112:115]
v_mfma_f32_16x16x32_bf16 v[112:115], a[80:83], a[44:47], v[112:115]
v_mfma_f32_16x16x32_bf16 v[116:119], a[88:91], a[44:47], v[116:119]
v_mfma_f32_16x16x32_bf16 v[116:119], a[92:95], a[60:63], v[116:119]
v_mfma_f32_16x16x32_bf16 v[108:111], a[92:95], a[56:59], v[108:111]
v_mfma_f32_16x16x32_bf16 v[108:111], a[88:91], a[40:43], v[108:111]
v_mov_b32 v15, s6
v_xor_b32 v15, 0, v15
v_mfma_f32_16x16x32_bf16 v[100:103], a[88:91], a[36:39], v[100:103]
v_writelane_b32 v15, s18, 0
v_lshlrev_b32 v15, 2, v15
v_bfe_u32 v12, v0, 2, 2
v_mfma_f32_16x16x32_bf16 v[100:103], a[92:95], a[52:55], v[100:103]
v_lshlrev_b32 v12, 11, v12
v_lshrrev_b32 v13, 4, v0
v_mfma_f32_16x16x32_bf16 v[92:95], a[92:95], a[48:51], v[92:95]
v_lshl_add_u32 v12, v13, 6, v12
v_and_b32 v13, 3, v0
v_mfma_f32_16x16x32_bf16 v[92:95], a[88:91], a[32:35], v[92:95]
s_waitcnt lgkmcnt(0)
v_lshl_add_u32 v12, v13, 4, v12
v_xor_b32 v12, s13, v12
v_mfma_f32_16x16x32_bf16 v[120:123], a[96:99], a[32:35], v[120:123]
L_padA12:
s_cmp_eq_u32 s95, 1
s_cbranch_scc1 L_hopA_ret
v_xor_b32 v13, 32, v12
v_add_u32 v13, 7168, v13
v_mul_f32 v24, s52, v24
v_mfma_f32_16x16x32_bf16 v[120:123], a[100:103], a[48:51], v[120:123]
v_mul_f32 v25, s52, v25
v_mul_f32 v26, s52, v26
v_mfma_f32_16x16x32_bf16 v[128:131], a[100:103], a[52:55], v[128:131]
v_mul_f32 v27, s52, v27
v_mul_f32 v28, s52, v28
v_mfma_f32_16x16x32_bf16 v[128:131], a[96:99], a[36:39], v[128:131]
v_mul_f32 v29, s52, v29
v_mul_f32 v30, s52, v30
v_mfma_f32_16x16x32_bf16 v[136:139], a[96:99], a[40:43], v[136:139]
v_mul_f32 v31, s52, v31
v_cvt_pk_bf16_f32 v24, v24, v25
v_cvt_pk_bf16_f32 v25, v26, v27
v_mfma_f32_16x16x32_bf16 v[136:139], a[100:103], a[56:59], v[136:139]
v_cvt_pk_bf16_f32 v26, v28, v29
v_cvt_pk_bf16_f32 v27, v30, v31
v_mfma_f32_16x16x32_bf16 v[144:147], a[100:103], a[60:63], v[144:147]
v_accvgpr_write_b32 a160, v24
v_accvgpr_write_b32 a161, v25
v_mfma_f32_16x16x32_bf16 v[144:147], a[96:99], a[44:47], v[144:147]
v_accvgpr_write_b32 a162, v26
v_accvgpr_write_b32 a163, v27
v_mfma_f32_16x16x32_bf16 v[148:151], a[104:107], a[44:47], v[148:151]
v_mul_f32 v32, s52, v32
v_mul_f32 v33, s52, v33
v_mul_f32 v34, s52, v34
v_mfma_f32_16x16x32_bf16 v[148:151], a[108:111], a[60:63], v[148:151]
v_mul_f32 v35, s52, v35
v_mul_f32 v36, s52, v36
v_mfma_f32_16x16x32_bf16 v[140:143], a[108:111], a[56:59], v[140:143]
v_mul_f32 v37, s52, v37
v_mul_f32 v38, s52, v38
v_mfma_f32_16x16x32_bf16 v[140:143], a[104:107], a[40:43], v[140:143]
v_mul_f32 v39, s52, v39
v_cvt_pk_bf16_f32 v32, v32, v33
v_mfma_f32_16x16x32_bf16 v[132:135], a[104:107], a[36:39], v[132:135]
v_cvt_pk_bf16_f32 v33, v34, v35
v_cvt_pk_bf16_f32 v34, v36, v37
v_cvt_pk_bf16_f32 v35, v38, v39
v_mfma_f32_16x16x32_bf16 v[132:135], a[108:111], a[52:55], v[132:135]
v_accvgpr_write_b32 a176, v32
v_accvgpr_write_b32 a177, v33
v_mfma_f32_16x16x32_bf16 v[124:127], a[108:111], a[48:51], v[124:127]
v_accvgpr_write_b32 a178, v34
v_accvgpr_write_b32 a179, v35
v_mfma_f32_16x16x32_bf16 v[124:127], a[104:107], a[32:35], v[124:127]
L_trans:
s_waitcnt vmcnt(21) lgkmcnt(0)
s_barrier
s_cmp_eq_u32 s4, 0
s_cbranch_scc1 L_hx_ld
ds_read_b128 v[188:191], v4 offset:0
ds_read_b64 v[216:217], v4 offset:1024
ds_read_b64 v[220:221], v4 offset:1032
ds_read_b128 v[204:207], v4 offset:16384
ds_read_b64 v[232:233], v4 offset:17408
ds_read_b64 v[236:237], v4 offset:17416
s_branch L_hx_rd
L_hx_ld:
buffer_load_dwordx4 v[188:191], v10, s[88:91], 0 offen sc1
buffer_load_dwordx2 v[216:217], v10, s[88:91], 0 offen offset:1024 sc1
buffer_load_dwordx2 v[220:221], v10, s[88:91], 0 offen offset:1032 sc1
buffer_load_dwordx4 v[204:207], v11, s[88:91], 0 offen sc1
buffer_load_dwordx2 v[232:233], v11, s[88:91], 0 offen offset:1024 sc1
buffer_load_dwordx2 v[236:237], v11, s[88:91], 0 offen offset:1032 sc1
L_hx_rd:
ds_read_b128 v[196:199], v6 offset:0
ds_read_b64 v[224:225], v6 offset:1024
ds_read_b64 v[228:229], v6 offset:1032
ds_read_b128 v[212:215], v6 offset:16384
ds_read_b64 v[240:241], v6 offset:17408
ds_read_b64 v[244:245], v6 offset:17416
ds_read_b128 a[0:3], v1 offset:8192
ds_read_b128 a[4:7], v1 offset:9216
ds_read_b128 a[8:11], v1 offset:10240
ds_read_b128 a[12:15], v1 offset:11264
ds_read_b128 a[16:19], v1 offset:12288
ds_read_b128 a[20:23], v1 offset:13312
ds_read_b128 a[24:27], v1 offset:14336
ds_read_b128 a[28:31], v1 offset:15360
L_hopB:
s_mov_b32 s95, 0
v_pk_mul_f32 v[40:41], v[40:41], s[52:53]
v_pk_mul_f32 v[42:43], v[42:43], s[52:53]
v_pk_mul_f32 v[44:45], v[44:45], s[52:53]
v_pk_mul_f32 v[46:47], v[46:47], s[52:53]
v_cvt_pk_bf16_f32 v40, v40, v41
v_cvt_pk_bf16_f32 v41, v42, v43
v_cvt_pk_bf16_f32 v42, v44, v45
v_cvt_pk_bf16_f32 v43, v46, v47
v_accvgpr_write_b32 a192, v40
v_accvgpr_write_b32 a193, v41
v_accvgpr_write_b32 a194, v42
v_accvgpr_write_b32 a195, v43
v_pk_mul_f32 v[48:49], v[48:49], s[52:53]
v_pk_mul_f32 v[50:51], v[50:51], s[52:53]
v_pk_mul_f32 v[52:53], v[52:53], s[52:53]
v_pk_mul_f32 v[54:55], v[54:55], s[52:53]
v_cvt_pk_bf16_f32 v48, v48, v49
v_cvt_pk_bf16_f32 v49, v50, v51
v_cvt_pk_bf16_f32 v50, v52, v53
v_cvt_pk_bf16_f32 v51, v54, v55
v_accvgpr_write_b32 a208, v48
v_accvgpr_write_b32 a209, v49
v_accvgpr_write_b32 a210, v50
v_accvgpr_write_b32 a211, v51
v_mov_b32 v47, s55
v_cndmask_b32 v36, v9, 0, s[56:57]
v_min_f32 v32, s55, v36
v_cndmask_b32 v44, v47, 0, s[36:37]
v_cndmask_b32 v37, v9, 0, s[58:59]
v_min_f32 v33, s55, v37
v_cndmask_b32 v45, v47, 0, s[38:39]
v_cndmask_b32 v38, v9, 0, s[60:61]
v_min_f32 v34, s55, v38
v_cndmask_b32 v46, v47, 0, s[40:41]
v_cndmask_b32 v39, v9, 0, s[62:63]
v_min_f32 v35, s55, v39
v_cndmask_b32 v47, v47, 0, s[42:43]
v_pk_mul_f32 v[56:57], v[56:57], s[52:53]
v_pk_mul_f32 v[58:59], v[58:59], s[52:53]
v_pk_mul_f32 v[60:61], v[60:61], s[52:53]
v_pk_mul_f32 v[62:63], v[62:63], s[52:53]
v_cvt_pk_bf16_f32 v56, v56, v57
v_cvt_pk_bf16_f32 v57, v58, v59
v_cvt_pk_bf16_f32 v58, v60, v61
v_cvt_pk_bf16_f32 v59, v62, v63
v_accvgpr_write_b32 a164, v56
v_accvgpr_write_b32 a165, v57
v_accvgpr_write_b32 a166, v58
v_accvgpr_write_b32 a167, v59
v_pk_mul_f32 v[64:65], v[64:65], s[52:53]
v_pk_mul_f32 v[66:67], v[66:67], s[52:53]
v_pk_mul_f32 v[68:69], v[68:69], s[52:53]
v_pk_mul_f32 v[70:71], v[70:71], s[52:53]
v_cvt_pk_bf16_f32 v64, v64, v65
v_cvt_pk_bf16_f32 v65, v66, v67
v_cvt_pk_bf16_f32 v66, v68, v69
v_cvt_pk_bf16_f32 v67, v70, v71
v_accvgpr_write_b32 a180, v64
v_accvgpr_write_b32 a181, v65
v_accvgpr_write_b32 a182, v66
v_accvgpr_write_b32 a183, v67
v_pk_mul_f32 v[72:73], v[72:73], s[52:53]
v_pk_mul_f32 v[74:75], v[74:75], s[52:53]
v_pk_mul_f32 v[76:77], v[76:77], s[52:53]
v_pk_mul_f32 v[78:79], v[78:79], s[52:53]
v_cvt_pk_bf16_f32 v72, v72, v73
v_cvt_pk_bf16_f32 v73, v74, v75
v_cvt_pk_bf16_f32 v74, v76, v77
v_cvt_pk_bf16_f32 v75, v78, v79
v_accvgpr_write_b32 a196, v72
v_accvgpr_write_b32 a197, v73
v_accvgpr_write_b32 a198, v74
v_accvgpr_write_b32 a199, v75
v_pk_mul_f32 v[80:81], v[80:81], s[52:53]
v_pk_mul_f32 v[82:83], v[82:83], s[52:53]
v_pk_mul_f32 v[84:85], v[84:85], s[52:53]
v_pk_mul_f32 v[86:87], v[86:87], s[52:53]
v_cvt_pk_bf16_f32 v80, v80, v81
v_cvt_pk_bf16_f32 v81, v82, v83
v_cvt_pk_bf16_f32 v82, v84, v85
v_cvt_pk_bf16_f32 v83, v86, v87
v_accvgpr_write_b32 a212, v80
v_accvgpr_write_b32 a213, v81
v_accvgpr_write_b32 a214, v82
v_accvgpr_write_b32 a215, v83
v_pk_mul_f32 v[88:89], v[88:89], s[52:53]
v_pk_mul_f32 v[90:91], v[90:91], s[52:53]
v_pk_mul_f32 v[92:93], v[92:93], s[52:53]
v_pk_mul_f32 v[94:95], v[94:95], s[52:53]
v_cvt_pk_bf16_f32 v88, v88, v89
v_cvt_pk_bf16_f32 v89, v90, v91
v_cvt_pk_bf16_f32 v90, v92, v93
v_cvt_pk_bf16_f32 v91, v94, v95
v_accvgpr_write_b32 a168, v88
v_accvgpr_write_b32 a169, v89
v_accvgpr_write_b32 a170, v90
v_accvgpr_write_b32 a171, v91
v_pk_mul_f32 v[96:97], v[96:97], s[52:53]
v_pk_mul_f32 v[98:99], v[98:99], s[52:53]
v_pk_mul_f32 v[100:101], v[100:101], s[52:53]
v_pk_mul_f32 v[102:103], v[102:103], s[52:53]
v_cvt_pk_bf16_f32 v96, v96, v97
v_cvt_pk_bf16_f32 v97, v98, v99
v_cvt_pk_bf16_f32 v98, v100, v101
v_cvt_pk_bf16_f32 v99, v102, v103
v_accvgpr_write_b32 a184, v96
v_accvgpr_write_b32 a185, v97
v_accvgpr_write_b32 a186, v98
v_accvgpr_write_b32 a187, v99
v_pk_mul_f32 v[104:105], v[104:105], s[52:53]
v_pk_mul_f32 v[106:107], v[106:107], s[52:53]
v_pk_mul_f32 v[108:109], v[108:109], s[52:53]
v_pk_mul_f32 v[110:111], v[110:111], s[52:53]
v_cvt_pk_bf16_f32 v104, v104, v105
v_cvt_pk_bf16_f32 v105, v106, v107
v_cvt_pk_bf16_f32 v106, v108, v109
v_cvt_pk_bf16_f32 v107, v110, v111
v_accvgpr_write_b32 a200, v104
v_accvgpr_write_b32 a201, v105
v_accvgpr_write_b32 a202, v106
v_accvgpr_write_b32 a203, v107
v_pk_mul_f32 v[112:113], v[112:113], s[52:53]
v_pk_mul_f32 v[114:115], v[114:115], s[52:53]
v_pk_mul_f32 v[116:117], v[116:117], s[52:53]
v_pk_mul_f32 v[118:119], v[118:119], s[52:53]
v_cvt_pk_bf16_f32 v112, v112, v113
v_cvt_pk_bf16_f32 v113, v114, v115
v_cvt_pk_bf16_f32 v114, v116, v117
v_cvt_pk_bf16_f32 v115, v118, v119
v_accvgpr_write_b32 a216, v112
v_accvgpr_write_b32 a217, v113
v_accvgpr_write_b32 a218, v114
v_accvgpr_write_b32 a219, v115
v_pk_mul_f32 v[120:121], v[120:121], s[52:53]
v_pk_mul_f32 v[122:123], v[122:123], s[52:53]
v_pk_mul_f32 v[124:125], v[124:125], s[52:53]
v_pk_mul_f32 v[126:127], v[126:127], s[52:53]
v_cvt_pk_bf16_f32 v120, v120, v121
v_cvt_pk_bf16_f32 v121, v122, v123
v_cvt_pk_bf16_f32 v122, v124, v125
v_cvt_pk_bf16_f32 v123, v126, v127
v_accvgpr_write_b32 a172, v120
v_accvgpr_write_b32 a173, v121
v_accvgpr_write_b32 a174, v122
v_accvgpr_write_b32 a175, v123
v_pk_mul_f32 v[128:129], v[128:129], s[52:53]
v_pk_mul_f32 v[130:131], v[130:131], s[52:53]
v_pk_mul_f32 v[132:133], v[132:133], s[52:53]
v_pk_mul_f32 v[134:135], v[134:135], s[52:53]
v_cvt_pk_bf16_f32 v128, v128, v129
v_cvt_pk_bf16_f32 v129, v130, v131
v_cvt_pk_bf16_f32 v130, v132, v133
v_cvt_pk_bf16_f32 v131, v134, v135
v_accvgpr_write_b32 a188, v128
v_accvgpr_write_b32 a189, v129
v_accvgpr_write_b32 a190, v130
v_accvgpr_write_b32 a191, v131
v_pk_mul_f32 v[136:137], v[136:137], s[52:53]
v_pk_mul_f32 v[138:139], v[138:139], s[52:53]
v_pk_mul_f32 v[140:141], v[140:141], s[52:53]
v_pk_mul_f32 v[142:143], v[142:143], s[52:53]
v_cvt_pk_bf16_f32 v136, v136, v137
v_cvt_pk_bf16_f32 v137, v138, v139
v_cvt_pk_bf16_f32 v138, v140, v141
v_cvt_pk_bf16_f32 v139, v142, v143
v_accvgpr_write_b32 a204, v136
v_accvgpr_write_b32 a205, v137
v_accvgpr_write_b32 a206, v138
v_accvgpr_write_b32 a207, v139
v_pk_mul_f32 v[144:145], v[144:145], s[52:53]
v_pk_mul_f32 v[146:147], v[146:147], s[52:53]
v_pk_mul_f32 v[148:149], v[148:149], s[52:53]
v_pk_mul_f32 v[150:151], v[150:151], s[52:53]
v_cvt_pk_bf16_f32 v144, v144, v145
v_cvt_pk_bf16_f32 v145, v146, v147
v_cvt_pk_bf16_f32 v146, v148, v149
v_cvt_pk_bf16_f32 v147, v150, v151
v_accvgpr_write_b32 a220, v144
v_accvgpr_write_b32 a221, v145
v_accvgpr_write_b32 a222, v146
v_accvgpr_write_b32 a223, v147
s_cmp_lg_u32 s4, 0
s_cbranch_scc1 L_spun_hx
s_mov_b32 s92, 200000
L_spin_hx:
s_waitcnt vmcnt(0)
v_max3_u32 v128, v188, v189, 0
v_max3_u32 v128, v190, v191, v128
v_max3_u32 v128, v216, v217, v128
v_max3_u32 v128, v220, v221, v128
v_max3_u32 v128, v204, v205, v128
v_max3_u32 v128, v206, v207, v128
v_max3_u32 v128, v232, v233, v128
v_max3_u32 v128, v236, v237, v128
v_cmp_eq_u32 vcc, -1, v128
s_sub_u32 s92, s92, 1
s_cbranch_scc1 L_spun_hx
s_nop 3
s_cbranch_vccz L_spun_hx
s_sleep 2
buffer_load_dwordx4 v[188:191], v10, s[88:91], 0 offen sc1
buffer_load_dwordx2 v[216:217], v10, s[88:91], 0 offen offset:1024 sc1
buffer_load_dwordx2 v[220:221], v10, s[88:91], 0 offen offset:1032 sc1
buffer_load_dwordx4 v[204:207], v11, s[88:91], 0 offen sc1
buffer_load_dwordx2 v[232:233], v11, s[88:91], 0 offen offset:1024 sc1
buffer_load_dwordx2 v[236:237], v11, s[88:91], 0 offen offset:1032 sc1
s_branch L_spin_hx
L_spun_hx:
s_waitcnt lgkmcnt(0)
s_barrier
v_mfma_f32_16x16x32_bf16 v[52:55], v[184:187], v[152:155], v[248:251]
v_mov_b32 v140, 0
v_mov_b32 v141, 0
v_mfma_f32_16x16x32_bf16 v[48:51], v[188:191], v[152:155], v[32:35]
v_mov_b32 v142, 0
v_mov_b32 v143, 0
v_mfma_f32_16x16x32_bf16 v[60:63], v[192:195], v[160:163], v[248:251]
v_mov_b32 v144, 0
v_mov_b32 v145, 0
v_mfma_f32_16x16x32_bf16 v[56:59], v[196:199], v[160:163], v[36:39]
v_mov_b32 v146, 0
v_mov_b32 v147, 0
v_mfma_f32_16x16x32_bf16 v[68:71], v[200:203], v[168:171], v[248:251]
v_mov_b32 v148, 0
v_mov_b32 v149, 0
v_mfma_f32_16x16x32_bf16 v[64:67], v[204:207], v[168:171], v[36:39]
v_max3_f32 v52, v48, v49, v52
v_max3_f32 v54, v50, v51, v54
v_mfma_f32_16x16x32_bf16 v[76:79], v[208:211], v[176:179], v[248:251]
v_max_f32 v52, v52, v53
v_max_f32 v53, v54, v55
v_mfma_f32_16x16x32_bf16 v[72:75], v[212:215], v[176:179], v[36:39]
v_max_f32 v136, v52, v53
v_max3_f32 v60, v56, v57, v60
v_mfma_f32_16x16x32_bf16 v[16:19], a[0:3], a[160:163], v[44:47]
v_max3_f32 v62, v58, v59, v62
v_max_f32 v60, v60, v61
v_mfma_f32_16x16x32_bf16 v[16:19], a[4:7], a[164:167], v[16:19]
v_max_f32 v61, v62, v63
v_max_f32 v137, v60, v61
v_mfma_f32_16x16x32_bf16 v[16:19], a[8:11], a[168:171], v[16:19]
v_max3_f32 v68, v64, v65, v68
v_max3_f32 v70, v66, v67, v70
v_mfma_f32_16x16x32_bf16 v[16:19], a[12:15], a[172:175], v[16:19]
v_max_f32 v68, v68, v69
v_max_f32 v69, v70, v71
v_mfma_f32_16x16x32_bf16 v[20:23], a[0:3], a[176:179], 0
v_max_f32 v138, v68, v69
v_max3_f32 v76, v72, v73, v76
v_mfma_f32_16x16x32_bf16 v[20:23], a[4:7], a[180:183], v[20:23]
v_max3_f32 v78, v74, v75, v78
v_max_f32 v76, v76, v77
v_mfma_f32_16x16x32_bf16 v[20:23], a[8:11], a[184:187], v[20:23]
v_max_f32 v77, v78, v79
v_max_f32 v139, v76, v77
v_mfma_f32_16x16x32_bf16 v[20:23], a[12:15], a[188:191], v[20:23]
v_mov_b32 v150, 0
v_mov_b32 v151, 0
v_mfma_f32_16x16x32_bf16 v[24:27], a[0:3], a[192:195], 0
v_mov_b32 v248, 0
v_mov_b32 v249, 0
v_mfma_f32_16x16x32_bf16 v[24:27], a[4:7], a[196:199], v[24:27]
v_mov_b32 v250, 0
v_mov_b32 v251, 0
v_mfma_f32_16x16x32_bf16 v[24:27], a[8:11], a[200:203], v[24:27]
v_max3_f32 v80, v16, v17, v18
v_max_f32 v80, v80, v19
v_mfma_f32_16x16x32_bf16 v[24:27], a[12:15], a[204:207], v[24:27]
v_max3_f32 v84, v20, v21, v22
v_max_f32 v84, v84, v23
v_mfma_f32_16x16x32_bf16 v[28:31], a[0:3], a[208:211], 0
v_mov_b32 v128, v136
v_mov_b32 v129, v137
v_mfma_f32_16x16x32_bf16 v[28:31], a[4:7], a[212:215], v[28:31]
v_mov_b32 v130, v138
v_mov_b32 v131, v139
v_mfma_f32_16x16x32_bf16 v[28:31], a[8:11], a[216:219], v[28:31]
v_permlane16_swap_b32 v128, v136
v_permlane16_swap_b32 v129, v137
v_mfma_f32_16x16x32_bf16 v[28:31], a[12:15], a[220:223], v[28:31]
v_permlane16_swap_b32 v130, v138
v_permlane16_swap_b32 v131, v139
v_max_f32 v136, v136, v128
v_max_f32 v137, v137, v129
v_max_f32 v138, v138, v130
v_max_f32 v139, v139, v131
v_max3_f32 v88, v24, v25, v26
v_max_f32 v88, v88, v27
v_mov_b32 v128, v136
v_mov_b32 v129, v137
v_mov_b32 v130, v138
v_mov_b32 v131, v139
v_max3_f32 v92, v28, v29, v30
v_max_f32 v92, v92, v31
v_permlane32_swap_b32 v128, v136
v_permlane32_swap_b32 v129, v137
v_permlane32_swap_b32 v130, v138
v_permlane32_swap_b32 v131, v139
v_max_f32 v136, v136, v128
v_max_f32 v137, v137, v129
v_max_f32 v138, v138, v130
v_max_f32 v139, v139, v131
v_mul_f32 v136, s54, v136
v_mul_f32 v137, s54, v137
v_mul_f32 v138, s54, v138
v_mul_f32 v139, s54, v139
v_fma_f32 v52, v52, s54, -v136
v_fma_f32 v53, v53, s54, -v136
v_fma_f32 v60, v60, s54, -v137
v_fma_f32 v61, v61, s54, -v137
v_fma_f32 v68, v68, s54, -v138
v_fma_f32 v69, v69, s54, -v138
v_fma_f32 v76, v76, s54, -v139
v_fma_f32 v77, v77, s54, -v139
v_exp_f32 v52, v52
v_exp_f32 v53, v53
v_exp_f32 v60, v60
v_exp_f32 v61, v61
v_exp_f32 v68, v68
v_exp_f32 v69, v69
v_exp_f32 v76, v76
v_exp_f32 v77, v77
v_cvt_pk_bf16_f32 v52, v52, v52
v_cvt_pk_bf16_f32 v53, v53, v53
v_cvt_pk_bf16_f32 v60, v60, v60
v_cvt_pk_bf16_f32 v61, v61, v61
v_cvt_pk_bf16_f32 v68, v68, v68
v_cvt_pk_bf16_f32 v69, v69, v69
v_cvt_pk_bf16_f32 v76, v76, v76
v_cvt_pk_bf16_f32 v77, v77, v77
v_and_b32 v48, v252, v52
v_and_b32 v49, v253, v53
v_and_b32 v50, v254, v52
v_and_b32 v51, v255, v53
v_and_b32 v56, v252, v60
v_and_b32 v57, v253, v61
v_and_b32 v58, v254, v60
v_and_b32 v59, v255, v61
v_and_b32 v64, v252, v68
v_and_b32 v65, v253, v69
v_and_b32 v66, v254, v68
v_and_b32 v67, v255, v69
v_and_b32 v72, v252, v76
v_and_b32 v73, v253, v77
v_and_b32 v74, v254, v76
v_and_b32 v75, v255, v77
v_mfma_f32_16x16x32_bf16 v[156:159], a[240:243], v[48:51], 0
v_mov_b32 v128, v80
v_mov_b32 v129, v84
v_mfma_f32_16x16x32_bf16 v[164:167], a[240:243], v[56:59], 0
v_mov_b32 v130, v88
v_mov_b32 v131, v92
v_mfma_f32_16x16x32_bf16 v[172:175], a[240:243], v[64:67], 0
v_permlane16_swap_b32 v128, v80
v_permlane16_swap_b32 v129, v84
v_mfma_f32_16x16x32_bf16 v[180:183], a[240:243], v[72:75], 0
v_permlane16_swap_b32 v130, v88
v_permlane16_swap_b32 v131, v92
v_mfma_f32_16x16x32_bf16 v[184:187], v[216:219], v[48:51], 0
v_max_f32 v80, v80, v128
v_max_f32 v84, v84, v129
v_mfma_f32_16x16x32_bf16 v[188:191], v[220:223], v[48:51], 0
v_max_f32 v88, v88, v130
v_max_f32 v92, v92, v131
v_mfma_f32_16x16x32_bf16 v[192:195], v[224:227], v[56:59], 0
v_mov_b32 v128, v80
v_mov_b32 v129, v84
v_mfma_f32_16x16x32_bf16 v[196:199], v[228:231], v[56:59], 0
v_mov_b32 v130, v88
v_mov_b32 v131, v92
v_mfma_f32_16x16x32_bf16 v[200:203], v[232:235], v[64:67], 0
v_permlane32_swap_b32 v128, v80
v_permlane32_swap_b32 v129, v84
v_mfma_f32_16x16x32_bf16 v[204:207], v[236:239], v[64:67], 0
v_permlane32_swap_b32 v130, v88
v_permlane32_swap_b32 v131, v92
v_mfma_f32_16x16x32_bf16 v[208:211], v[240:243], v[72:75], 0
v_max_f32 v80, v80, v128
v_max_f32 v84, v84, v129
v_mfma_f32_16x16x32_bf16 v[212:215], v[244:247], v[72:75], 0
v_max_f32 v88, v88, v130
v_max_f32 v92, v92, v131
v_rcp_f32 v128, v156
v_rcp_f32 v130, v164
v_rcp_f32 v132, v172
v_rcp_f32 v134, v180
v_sub_f32 v83, 0, v80
v_sub_f32 v82, 0, v80
v_sub_f32 v81, 0, v80
v_sub_f32 v80, 0, v80
v_sub_f32 v87, 0, v84
v_sub_f32 v86, 0, v84
v_sub_f32 v85, 0, v84
v_sub_f32 v84, 0, v84
v_sub_f32 v91, 0, v88
v_sub_f32 v90, 0, v88
v_sub_f32 v89, 0, v88
v_sub_f32 v88, 0, v88
v_sub_f32 v95, 0, v92
v_pk_mul_f32 v[184:185], v[184:185], v[128:129] op_sel_hi:[1,0]
v_pk_mul_f32 v[186:187], v[186:187], v[128:129] op_sel_hi:[1,0]
v_pk_mul_f32 v[188:189], v[188:189], v[128:129] op_sel_hi:[1,0]
v_pk_mul_f32 v[190:191], v[190:191], v[128:129] op_sel_hi:[1,0]
v_pk_mul_f32 v[192:193], v[192:193], v[130:131] op_sel_hi:[1,0]
v_pk_mul_f32 v[194:195], v[194:195], v[130:131] op_sel_hi:[1,0]
v_pk_mul_f32 v[196:197], v[196:197], v[130:131] op_sel_hi:[1,0]
v_pk_mul_f32 v[198:199], v[198:199], v[130:131] op_sel_hi:[1,0]
v_pk_mul_f32 v[200:201], v[200:201], v[132:133] op_sel_hi:[1,0]
v_pk_mul_f32 v[202:203], v[202:203], v[132:133] op_sel_hi:[1,0]
v_pk_mul_f32 v[204:205], v[204:205], v[132:133] op_sel_hi:[1,0]
v_pk_mul_f32 v[206:207], v[206:207], v[132:133] op_sel_hi:[1,0]
v_pk_mul_f32 v[208:209], v[208:209], v[134:135] op_sel_hi:[1,0]
v_pk_mul_f32 v[210:211], v[210:211], v[134:135] op_sel_hi:[1,0]
v_pk_mul_f32 v[212:213], v[212:213], v[134:135] op_sel_hi:[1,0]
v_pk_mul_f32 v[214:215], v[214:215], v[134:135] op_sel_hi:[1,0]
v_cvt_pk_bf16_f32 v32, v184, v185
v_cvt_pk_bf16_f32 v33, v186, v187
v_cvt_pk_bf16_f32 v34, v188, v189
v_cvt_pk_bf16_f32 v35, v190, v191
v_cvt_pk_bf16_f32 v36, v192, v193
v_cvt_pk_bf16_f32 v37, v194, v195
v_cvt_pk_bf16_f32 v38, v196, v197
v_cvt_pk_bf16_f32 v39, v198, v199
v_cvt_pk_bf16_f32 v40, v200, v201
v_cvt_pk_bf16_f32 v41, v202, v203
v_cvt_pk_bf16_f32 v42, v204, v205
v_cvt_pk_bf16_f32 v43, v206, v207
v_cvt_pk_bf16_f32 v44, v208, v209
v_cvt_pk_bf16_f32 v45, v210, v211
v_cvt_pk_bf16_f32 v46, v212, v213
v_cvt_pk_bf16_f32 v47, v214, v215
buffer_store_dwordx4 v[32:35], v3, s[88:91], s44 offen sc1
v_sub_f32 v94, 0, v92
v_sub_f32 v93, 0, v92
v_sub_f32 v92, 0, v92
v_min_f32 v103, s10, v80
v_cndmask_b32 v96, v103, v80, s[36:37]
v_cndmask_b32 v97, v103, v80, s[38:39]
v_cndmask_b32 v98, v103, v80, s[40:41]
v_cndmask_b32 v99, v103, v80, s[42:43]
v_cndmask_b32 v100, v9, v103, s[36:37]
v_cndmask_b32 v101, v9, v103, s[38:39]
v_cndmask_b32 v102, v9, v103, s[40:41]
v_cndmask_b32 v103, v9, v103, s[42:43]
v_min_f32 v111, s11, v84
v_cndmask_b32 v104, v111, v84, s[36:37]
v_cndmask_b32 v105, v111, v84, s[38:39]
v_cndmask_b32 v106, v111, v84, s[40:41]
v_cndmask_b32 v107, v111, v84, s[42:43]
v_cndmask_b32 v108, v9, v111, s[36:37]
v_cndmask_b32 v109, v9, v111, s[38:39]
buffer_store_dwordx4 v[36:39], v3, s[88:91], s45 offen sc1
v_cndmask_b32 v110, v9, v111, s[40:41]
v_cndmask_b32 v111, v9, v111, s[42:43]
v_and_b32 v9, 1, v0
v_mul_u32_u24 v9, 0xaaaa, v9
v_add_u32 v9, 0x4444, v9
v_mov_b64 v[128:129], 0
v_mov_b64 v[130:131], 0
v_mov_b64 v[132:133], 0
v_mov_b64 v[134:135], 0
v_mov_b64 v[136:137], 0
v_mov_b64 v[138:139], 0
v_mov_b64 v[152:153], 0
v_mov_b64 v[154:155], 0
v_mov_b64 v[156:157], 0
v_mov_b64 v[158:159], 0
v_mov_b64 v[160:161], 0
v_mov_b64 v[162:163], 0
v_mov_b64 v[164:165], 0
v_mov_b64 v[166:167], 0
buffer_store_dwordx4 v[40:43], v3, s[88:91], s46 offen sc1
v_mov_b64 v[168:169], 0
v_mov_b64 v[170:171], 0
v_mov_b64 v[172:173], 0
v_mov_b64 v[174:175], 0
v_mov_b64 v[176:177], 0
v_mov_b64 v[178:179], 0
v_mov_b64 v[180:181], 0
v_mov_b64 v[182:183], 0
v_mov_b64 v[184:185], 0
v_mov_b64 v[186:187], 0
v_mov_b64 v[188:189], 0
v_mov_b64 v[190:191], 0
v_mov_b64 v[192:193], 0
v_mov_b64 v[194:195], 0
v_mov_b64 v[196:197], 0
v_mov_b64 v[198:199], 0
v_mov_b64 v[200:201], 0
v_mov_b64 v[202:203], 0
v_mov_b64 v[204:205], 0
buffer_store_dwordx4 v[44:47], v3, s[88:91], s47 offen sc1
v_mov_b64 v[206:207], 0
v_mov_b64 v[208:209], 0
v_mov_b64 v[210:211], 0
v_mov_b64 v[212:213], 0
v_mov_b64 v[214:215], 0
v_mov_b64 v[216:217], 0
v_mov_b64 v[218:219], 0
v_mov_b64 v[220:221], 0
v_mov_b64 v[222:223], 0
v_mov_b64 v[224:225], 0
v_mov_b64 v[226:227], 0
v_mov_b64 v[228:229], 0
v_mov_b64 v[230:231], 0
v_mov_b64 v[232:233], 0
v_mov_b64 v[234:235], 0
v_mov_b64 v[236:237], 0
v_mov_b64 v[238:239], 0
v_mov_b64 v[252:253], 0
v_mov_b64 v[254:255], 0
L_att_start:
s_mov_b32 s15, s6
s_cmp_eq_u32 s6, 0
s_cbranch_scc1 L_att_j0
v_mfma_f32_16x16x32_bf16 v[16:19], a[0:3], a[160:163], v[80:83]
ds_read_b128 a[128:131], v1 offset:24576
v_mov_b32 v240, 0
v_mfma_f32_16x16x32_bf16 v[16:19], a[4:7], a[164:167], v[16:19]
ds_read_b128 a[132:135], v1 offset:25600
v_mov_b32 v241, 0
v_mfma_f32_16x16x32_bf16 v[16:19], a[8:11], a[168:171], v[16:19]
ds_read_b128 a[136:139], v1 offset:26624
s_add_u32 m0, s27, 0x0
v_mfma_f32_16x16x32_bf16 v[16:19], a[12:15], a[172:175], v[16:19]
buffer_load_dwordx4 v3, s[48:51], s32 offen offset:0 sc1 lds
v_mfma_f32_16x16x32_bf16 v[20:23], a[0:3], a[176:179], v[84:87]
ds_read_b128 a[140:143], v1 offset:27648
v_mov_b32 v242, 0
v_mfma_f32_16x16x32_bf16 v[20:23], a[4:7], a[180:183], v[20:23]
ds_read_b128 a[144:147], v1 offset:28672
v_mov_b32 v243, 0
v_mfma_f32_16x16x32_bf16 v[20:23], a[8:11], a[184:187], v[20:23]
ds_read_b128 a[148:151], v1 offset:29696
v_mov_b32 v244, 0
v_mfma_f32_16x16x32_bf16 v[20:23], a[12:15], a[188:191], v[20:23]
ds_read_b128 a[152:155], v1 offset:30720
v_mov_b32 v245, 0
v_mfma_f32_16x16x32_bf16 v[24:27], a[0:3], a[192:195], v[88:91]
ds_read_b128 a[156:159], v1 offset:31744
v_exp_f32 v16, v16
v_mfma_f32_16x16x32_bf16 v[24:27], a[4:7], a[196:199], v[24:27]
v_exp_f32 v17, v17
v_mfma_f32_16x16x32_bf16 v[24:27], a[8:11], a[200:203], v[24:27]
buffer_load_dwordx4 v3, s[48:51], s32 offen offset:1024 sc1 lds
v_mfma_f32_16x16x32_bf16 v[24:27], a[12:15], a[204:207], v[24:27]
v_exp_f32 v18, v18
v_mfma_f32_16x16x32_bf16 v[28:31], a[0:3], a[208:211], v[92:95]
v_exp_f32 v19, v19
v_mfma_f32_16x16x32_bf16 v[28:31], a[4:7], a[212:215], v[28:31]
v_exp_f32 v20, v20
v_mfma_f32_16x16x32_bf16 v[28:31], a[8:11], a[216:219], v[28:31]
v_cvt_pk_bf16_f32 v48, v16, v17
v_cvt_pk_bf16_f32 v49, v18, v19
v_mfma_f32_16x16x32_bf16 v[28:31], a[12:15], a[220:223], v[28:31]
v_exp_f32 v21, v21
v_mfma_f32_16x16x32_bf16 v[32:35], a[16:19], a[160:163], v[80:83]
v_exp_f32 v22, v22
v_mfma_f32_16x16x32_bf16 v[32:35], a[20:23], a[164:167], v[32:35]
v_exp_f32 v23, v23
v_mfma_f32_16x16x32_bf16 v[32:35], a[24:27], a[168:171], v[32:35]
buffer_load_dwordx4 v3, s[48:51], s32 offen offset:2048 sc1 lds
v_mfma_f32_16x16x32_bf16 v[32:35], a[28:31], a[172:175], v[32:35]
v_exp_f32 v24, v24
v_mfma_f32_16x16x32_bf16 v[36:39], a[16:19], a[176:179], v[84:87]
v_exp_f32 v25, v25
v_mfma_f32_16x16x32_bf16 v[36:39], a[20:23], a[180:183], v[36:39]
v_cvt_pk_bf16_f32 v52, v20, v21
v_cvt_pk_bf16_f32 v53, v22, v23
v_mfma_f32_16x16x32_bf16 v[36:39], a[24:27], a[184:187], v[36:39]
v_exp_f32 v26, v26
v_mfma_f32_16x16x32_bf16 v[36:39], a[28:31], a[188:191], v[36:39]
v_exp_f32 v27, v27
v_mfma_f32_16x16x32_bf16 v[40:43], a[16:19], a[192:195], v[88:91]
v_exp_f32 v28, v28
v_mfma_f32_16x16x32_bf16 v[40:43], a[20:23], a[196:199], v[40:43]
buffer_load_dwordx4 v3, s[48:51], s32 offen offset:3072 sc1 lds
v_mfma_f32_16x16x32_bf16 v[40:43], a[24:27], a[200:203], v[40:43]
s_add_u32 s32, s32, 0x8000
v_exp_f32 v29, v29
v_mfma_f32_16x16x32_bf16 v[40:43], a[28:31], a[204:207], v[40:43]
v_exp_f32 v30, v30
v_mfma_f32_16x16x32_bf16 v[44:47], a[16:19], a[208:211], v[92:95]
v_exp_f32 v31, v31
v_mfma_f32_16x16x32_bf16 v[44:47], a[20:23], a[212:215], v[44:47]
v_exp_f32 v32, v32
v_mfma_f32_16x16x32_bf16 v[44:47], a[24:27], a[216:219], v[44:47]
v_exp_f32 v33, v33
v_mfma_f32_16x16x32_bf16 v[44:47], a[28:31], a[220:223], v[44:47]
s_waitcnt lgkmcnt(0)
v_cvt_pk_bf16_f32 v56, v24, v25
v_cvt_pk_bf16_f32 v57, v26, v27
v_mov_b32 v246, 0
v_mov_b32 v247, 0
v_mfma_f32_16x16x32_bf16 v[16:19], a[128:131], a[160:163], v[80:83]
ds_read_b128 a[32:35], v1 offset:16384
v_cvt_pk_bf16_f32 v60, v28, v29
v_mfma_f32_16x16x32_bf16 v[16:19], a[132:135], a[164:167], v[16:19]
v_exp_f32 v34, v34
v_mfma_f32_16x16x32_bf16 v[16:19], a[136:139], a[168:171], v[16:19]
s_add_u32 m0, s27, 0x1000
v_exp_f32 v35, v35
v_mfma_f32_16x16x32_bf16 v[16:19], a[140:143], a[172:175], v[16:19]
buffer_load_dwordx4 v3, s[48:51], s7 offen offset:0 sc1 lds
v_mfma_f32_16x16x32_bf16 v[20:23], a[128:131], a[176:179], v[84:87]
ds_read_b128 a[36:39], v1 offset:17408
v_cvt_pk_bf16_f32 v61, v30, v31
v_mfma_f32_16x16x32_bf16 v[20:23], a[132:135], a[180:183], v[20:23]
v_exp_f32 v36, v36
v_mfma_f32_16x16x32_bf16 v[20:23], a[136:139], a[184:187], v[20:23]
ds_read_b128 a[40:43], v1 offset:18432
v_cvt_pk_bf16_f32 v50, v32, v33
v_mfma_f32_16x16x32_bf16 v[20:23], a[140:143], a[188:191], v[20:23]
v_exp_f32 v37, v37
v_mfma_f32_16x16x32_bf16 v[24:27], a[128:131], a[192:195], v[88:91]
v_exp_f32 v38, v38
v_mfma_f32_16x16x32_bf16 v[24:27], a[132:135], a[196:199], v[24:27]
ds_read_b128 a[44:47], v1 offset:19456
v_cvt_pk_bf16_f32 v51, v34, v35
v_mfma_f32_16x16x32_bf16 v[24:27], a[136:139], a[200:203], v[24:27]
buffer_load_dwordx4 v3, s[48:51], s7 offen offset:1024 sc1 lds
v_mfma_f32_16x16x32_bf16 v[24:27], a[140:143], a[204:207], v[24:27]
v_exp_f32 v39, v39
v_mfma_f32_16x16x32_bf16 v[28:31], a[128:131], a[208:211], v[92:95]
v_exp_f32 v40, v40
v_mfma_f32_16x16x32_bf16 v[28:31], a[132:135], a[212:215], v[28:31]
ds_read_b128 a[48:51], v1 offset:20480
v_cvt_pk_bf16_f32 v54, v36, v37
v_mfma_f32_16x16x32_bf16 v[28:31], a[136:139], a[216:219], v[28:31]
v_exp_f32 v41, v41
v_mfma_f32_16x16x32_bf16 v[28:31], a[140:143], a[220:223], v[28:31]
v_exp_f32 v42, v42
v_mfma_f32_16x16x32_bf16 v[32:35], a[144:147], a[160:163], v[80:83]
buffer_load_dwordx4 v3, s[48:51], s7 offen offset:2048 sc1 lds
v_mfma_f32_16x16x32_bf16 v[32:35], a[148:151], a[164:167], v[32:35]
ds_read_b128 a[52:55], v1 offset:21504
v_cvt_pk_bf16_f32 v55, v38, v39
v_mfma_f32_16x16x32_bf16 v[32:35], a[152:155], a[168:171], v[32:35]
v_exp_f32 v43, v43
v_mfma_f32_16x16x32_bf16 v[32:35], a[156:159], a[172:175], v[32:35]
ds_read_b128 a[56:59], v1 offset:22528
v_cvt_pk_bf16_f32 v58, v40, v41
v_mfma_f32_16x16x32_bf16 v[36:39], a[144:147], a[176:179], v[84:87]
v_exp_f32 v44, v44
v_mfma_f32_16x16x32_bf16 v[36:39], a[148:151], a[180:183], v[36:39]
v_exp_f32 v45, v45
v_mfma_f32_16x16x32_bf16 v[36:39], a[152:155], a[184:187], v[36:39]
ds_read_b128 a[60:63], v1 offset:23552
v_xor_b32 v1, 0x8000, v1
v_mfma_f32_16x16x32_bf16 v[36:39], a[156:159], a[188:191], v[36:39]
buffer_load_dwordx4 v3, s[48:51], s7 offen offset:3072 sc1 lds
v_cvt_pk_bf16_f32 v59, v42, v43
v_mfma_f32_16x16x32_bf16 v[40:43], a[144:147], a[192:195], v[88:91]
s_add_u32 s7, s7, 0x8000
v_exp_f32 v46, v46
v_mfma_f32_16x16x32_bf16 v[40:43], a[148:151], a[196:199], v[40:43]
s_xor_b32 s27, s27, 0x38000
v_exp_f32 v47, v47
v_mfma_f32_16x16x32_bf16 v[40:43], a[152:155], a[200:203], v[40:43]
v_exp_f32 v16, v16
v_mfma_f32_16x16x32_bf16 v[40:43], a[156:159], a[204:207], v[40:43]
v_exp_f32 v17, v17
v_cvt_pk_bf16_f32 v62, v44, v45
v_cvt_pk_bf16_f32 v63, v46, v47
v_mfma_f32_16x16x32_bf16 v[44:47], a[144:147], a[208:211], v[92:95]
v_exp_f32 v18, v18
v_mfma_f32_16x16x32_bf16 v[44:47], a[148:151], a[212:215], v[44:47]
v_exp_f32 v19, v19
v_mfma_f32_16x16x32_bf16 v[44:47], a[152:155], a[216:219], v[44:47]
s_waitcnt vmcnt(8) lgkmcnt(0)
v_exp_f32 v20, v20
v_mfma_f32_16x16x32_bf16 v[44:47], a[156:159], a[220:223], v[44:47]
s_barrier
v_cvt_pk_bf16_f32 v64, v16, v17
v_exp_f32 v21, v21
v_exp_f32 v22, v22
v_exp_f32 v23, v23
v_exp_f32 v24, v24
v_exp_f32 v25, v25
v_exp_f32 v26, v26
v_exp_f32 v27, v27
v_cvt_pk_bf16_f32 v65, v18, v19
v_cvt_pk_bf16_f32 v68, v20, v21
v_cvt_pk_bf16_f32 v69, v22, v23
s_cmp_lg_u32 s33, 0
s_cbranch_scc1 L_sig_bd
s_lshl_b32 s8, s6, 2
s_add_u32 s8, s8, 192
s_cmp_lg_u32 s4, 0
s_cbranch_scc1 L_sig_bd
v_mov_b32 v4, 1
s_mov_b64 exec, 1
buffer_atomic_add v4, off, s[84:87], s8 sc1
s_mov_b64 exec, -1
L_sig_bd:
s_getreg_b32 s8, hwreg(HW_REG_HW_ID, 5, 1)
s_cmp_lg_u32 s8, 0
s_cbranch_scc1 L_att_dodd1
s_branch L_att_dodd0
L_att_deven0:
v_mfma_f32_16x16x32_bf16 v[128:131], a[32:35], v[48:51], v[128:131]
ds_read_b128 a[0:3], v1 offset:8192
v_cvt_pk_bf16_f32 v72, v24, v25
v_mfma_f32_16x16x32_bf16 v[160:163], a[32:35], v[52:55], v[160:163]
v_exp_f32 v28, v28
v_mfma_f32_16x16x32_bf16 v[192:195], a[32:35], v[56:59], v[192:195]
v_cvt_pk_bf16_f32 v73, v26, v27
v_mfma_f32_16x16x32_bf16 v[224:227], a[32:35], v[60:63], v[224:227]
ds_read_b128 a[4:7], v1 offset:9216
v_mfma_f32_16x16x32_bf16 v[228:231], a[36:39], v[60:63], v[228:231]
v_exp_f32 v29, v29
v_mfma_f32_16x16x32_bf16 v[196:199], a[36:39], v[56:59], v[196:199]
v_exp_f32 v30, v30
v_mfma_f32_16x16x32_bf16 v[164:167], a[36:39], v[52:55], v[164:167]
s_add_u32 m0, s27, 0x0
v_cvt_pk_bf16_f32 v76, v28, v29
v_mfma_f32_16x16x32_bf16 v[132:135], a[36:39], v[48:51], v[132:135]
buffer_load_dwordx4 v3, s[48:51], s32 offen offset:0 sc1 lds
v_mfma_f32_16x16x32_bf16 v[136:139], a[40:43], v[48:51], v[136:139]
ds_read_b128 a[8:11], v1 offset:10240
v_mfma_f32_16x16x32_bf16 v[168:171], a[40:43], v[52:55], v[168:171]
v_exp_f32 v31, v31
v_mfma_f32_16x16x32_bf16 v[200:203], a[40:43], v[56:59], v[200:203]
v_exp_f32 v32, v32
v_mfma_f32_16x16x32_bf16 v[232:235], a[40:43], v[60:63], v[232:235]
ds_read_b128 a[12:15], v1 offset:11264
v_cvt_pk_bf16_f32 v77, v30, v31
v_mfma_f32_16x16x32_bf16 v[236:239], a[44:47], v[60:63], v[236:239]
v_mfma_f32_16x16x32_bf16 v[204:207], a[44:47], v[56:59], v[204:207]
v_exp_f32 v33, v33
v_mfma_f32_16x16x32_bf16 v[172:175], a[44:47], v[52:55], v[172:175]
v_exp_f32 v34, v34
v_mfma_f32_16x16x32_bf16 v[140:143], a[44:47], v[48:51], v[140:143]
ds_read_b128 a[16:19], v1 offset:12288
v_cvt_pk_bf16_f32 v66, v32, v33
v_mfma_f32_16x16x32_bf16 v[144:147], a[48:51], v[48:51], v[144:147]
v_mfma_f32_16x16x32_bf16 v[176:179], a[48:51], v[52:55], v[176:179]
v_exp_f32 v35, v35
v_mfma_f32_16x16x32_bf16 v[208:211], a[48:51], v[56:59], v[208:211]
v_exp_f32 v36, v36
v_mfma_f32_16x16x32_bf16 v[240:243], a[48:51], v[60:63], v[240:243]
ds_read_b128 a[20:23], v1 offset:13312
v_cvt_pk_bf16_f32 v67, v34, v35
v_mfma_f32_16x16x32_bf16 v[244:247], a[52:55], v[60:63], v[244:247]
v_exp_f32 v37, v37
v_mfma_f32_16x16x32_bf16 v[212:215], a[52:55], v[56:59], v[212:215]
v_cvt_pk_bf16_f32 v70, v36, v37
v_mfma_f32_16x16x32_bf16 v[180:183], a[52:55], v[52:55], v[180:183]
ds_read_b128 a[24:27], v1 offset:14336
v_mfma_f32_16x16x32_bf16 v[148:151], a[52:55], v[48:51], v[148:151]
buffer_load_dwordx4 v3, s[48:51], s32 offen offset:1024 sc1 lds
v_mfma_f32_16x16x32_bf16 v[152:155], a[56:59], v[48:51], v[152:155]
v_exp_f32 v38, v38
v_mfma_f32_16x16x32_bf16 v[184:187], a[56:59], v[52:55], v[184:187]
v_exp_f32 v39, v39
v_mfma_f32_16x16x32_bf16 v[216:219], a[56:59], v[56:59], v[216:219]
ds_read_b128 a[28:31], v1 offset:15360
v_cvt_pk_bf16_f32 v71, v38, v39
v_mfma_f32_16x16x32_bf16 v[248:251], a[56:59], v[60:63], v[248:251]
v_mfma_f32_16x16x32_bf16 v[252:255], a[60:63], v[60:63], v[252:255]
v_exp_f32 v40, v40
v_mfma_f32_16x16x32_bf16 v[220:223], a[60:63], v[56:59], v[220:223]
v_exp_f32 v41, v41
v_mfma_f32_16x16x32_bf16 v[188:191], a[60:63], v[52:55], v[188:191]
ds_read_b128 a[32:35], v1 offset:0
v_cvt_pk_bf16_f32 v74, v40, v41
v_mfma_f32_16x16x32_bf16 v[156:159], a[60:63], v[48:51], v[156:159]
v_smfmac_f32_16x16x64_bf16 a[224:227], a[232:235], v[48:55], v9
v_exp_f32 v42, v42
v_smfmac_f32_16x16x64_bf16 a[228:231], a[232:235], v[56:63], v9
s_waitcnt lgkmcnt(5)
v_exp_f32 v43, v43
v_mfma_f32_16x16x32_bf16 v[16:19], a[0:3], a[160:163], v[80:83]
ds_read_b128 a[36:39], v1 offset:1024
v_cvt_pk_bf16_f32 v75, v42, v43
v_mfma_f32_16x16x32_bf16 v[16:19], a[4:7], a[164:167], v[16:19]
v_exp_f32 v44, v44
v_mfma_f32_16x16x32_bf16 v[16:19], a[8:11], a[168:171], v[16:19]
v_mfma_f32_16x16x32_bf16 v[16:19], a[12:15], a[172:175], v[16:19]
v_exp_f32 v45, v45
v_mfma_f32_16x16x32_bf16 v[20:23], a[0:3], a[176:179], v[84:87]
ds_read_b128 a[40:43], v1 offset:2048
v_cvt_pk_bf16_f32 v78, v44, v45
v_mfma_f32_16x16x32_bf16 v[20:23], a[4:7], a[180:183], v[20:23]
buffer_load_dwordx4 v3, s[48:51], s32 offen offset:2048 sc1 lds
v_mfma_f32_16x16x32_bf16 v[20:23], a[8:11], a[184:187], v[20:23]
v_exp_f32 v46, v46
v_mfma_f32_16x16x32_bf16 v[20:23], a[12:15], a[188:191], v[20:23]
ds_read_b128 a[44:47], v1 offset:3072
v_mfma_f32_16x16x32_bf16 v[24:27], a[0:3], a[192:195], v[88:91]
v_mfma_f32_16x16x32_bf16 v[24:27], a[4:7], a[196:199], v[24:27]
v_exp_f32 v47, v47
v_mfma_f32_16x16x32_bf16 v[24:27], a[8:11], a[200:203], v[24:27]
v_exp_f32 v16, v16
v_mfma_f32_16x16x32_bf16 v[24:27], a[12:15], a[204:207], v[24:27]
ds_read_b128 a[48:51], v1 offset:4096
v_cvt_pk_bf16_f32 v79, v46, v47
v_mfma_f32_16x16x32_bf16 v[28:31], a[0:3], a[208:211], v[92:95]
v_mfma_f32_16x16x32_bf16 v[28:31], a[4:7], a[212:215], v[28:31]
v_exp_f32 v17, v17
v_mfma_f32_16x16x32_bf16 v[28:31], a[8:11], a[216:219], v[28:31]
s_waitcnt lgkmcnt(5)
v_exp_f32 v18, v18
v_mfma_f32_16x16x32_bf16 v[28:31], a[12:15], a[220:223], v[28:31]
ds_read_b128 a[52:55], v1 offset:5120
v_cvt_pk_bf16_f32 v48, v16, v17
v_mfma_f32_16x16x32_bf16 v[32:35], a[16:19], a[160:163], v[80:83]
v_mfma_f32_16x16x32_bf16 v[32:35], a[20:23], a[164:167], v[32:35]
v_exp_f32 v19, v19
v_mfma_f32_16x16x32_bf16 v[32:35], a[24:27], a[168:171], v[32:35]
v_exp_f32 v20, v20
v_mfma_f32_16x16x32_bf16 v[32:35], a[28:31], a[172:175], v[32:35]
ds_read_b128 a[56:59], v1 offset:6144
v_cvt_pk_bf16_f32 v49, v18, v19
v_mfma_f32_16x16x32_bf16 v[36:39], a[16:19], a[176:179], v[84:87]
v_exp_f32 v21, v21
v_mfma_f32_16x16x32_bf16 v[36:39], a[20:23], a[180:183], v[36:39]
buffer_load_dwordx4 v3, s[48:51], s32 offen offset:3072 sc1 lds
v_mfma_f32_16x16x32_bf16 v[36:39], a[24:27], a[184:187], v[36:39]
s_add_u32 s32, s32, 0x8000
v_cvt_pk_bf16_f32 v52, v20, v21
v_mfma_f32_16x16x32_bf16 v[36:39], a[28:31], a[188:191], v[36:39]
ds_read_b128 a[60:63], v1 offset:7168
v_mfma_f32_16x16x32_bf16 v[40:43], a[16:19], a[192:195], v[88:91]
v_exp_f32 v22, v22
v_mfma_f32_16x16x32_bf16 v[40:43], a[20:23], a[196:199], v[40:43]
v_exp_f32 v23, v23
v_mfma_f32_16x16x32_bf16 v[40:43], a[24:27], a[200:203], v[40:43]
v_cvt_pk_bf16_f32 v53, v22, v23
v_mfma_f32_16x16x32_bf16 v[40:43], a[28:31], a[204:207], v[40:43]
v_exp_f32 v24, v24
v_mfma_f32_16x16x32_bf16 v[44:47], a[16:19], a[208:211], v[92:95]
v_exp_f32 v25, v25
v_mfma_f32_16x16x32_bf16 v[44:47], a[20:23], a[212:215], v[44:47]
v_exp_f32 v26, v26
v_mfma_f32_16x16x32_bf16 v[44:47], a[24:27], a[216:219], v[44:47]
v_exp_f32 v27, v27
v_mfma_f32_16x16x32_bf16 v[44:47], a[28:31], a[220:223], v[44:47]
s_waitcnt lgkmcnt(0)
v_mfma_f32_16x16x32_bf16 v[128:131], a[32:35], v[64:67], v[128:131]
ds_read_b128 a[0:3], v1 offset:24576
v_cvt_pk_bf16_f32 v56, v24, v25
v_mfma_f32_16x16x32_bf16 v[160:163], a[32:35], v[68:71], v[160:163]
v_exp_f32 v28, v28
v_mfma_f32_16x16x32_bf16 v[192:195], a[32:35], v[72:75], v[192:195]
v_cvt_pk_bf16_f32 v57, v26, v27
v_mfma_f32_16x16x32_bf16 v[224:227], a[32:35], v[76:79], v[224:227]
ds_read_b128 a[4:7], v1 offset:25600
v_mfma_f32_16x16x32_bf16 v[228:231], a[36:39], v[76:79], v[228:231]
v_exp_f32 v29, v29
v_mfma_f32_16x16x32_bf16 v[196:199], a[36:39], v[72:75], v[196:199]
v_exp_f32 v30, v30
v_mfma_f32_16x16x32_bf16 v[164:167], a[36:39], v[68:71], v[164:167]
s_add_u32 m0, s27, 0x1000
v_cvt_pk_bf16_f32 v60, v28, v29
v_mfma_f32_16x16x32_bf16 v[132:135], a[36:39], v[64:67], v[132:135]
buffer_load_dwordx4 v3, s[48:51], s7 offen offset:0 sc1 lds
v_mfma_f32_16x16x32_bf16 v[136:139], a[40:43], v[64:67], v[136:139]
ds_read_b128 a[8:11], v1 offset:26624
v_mfma_f32_16x16x32_bf16 v[168:171], a[40:43], v[68:71], v[168:171]
v_exp_f32 v31, v31
v_mfma_f32_16x16x32_bf16 v[200:203], a[40:43], v[72:75], v[200:203]
v_exp_f32 v32, v32
v_mfma_f32_16x16x32_bf16 v[232:235], a[40:43], v[76:79], v[232:235]
ds_read_b128 a[12:15], v1 offset:27648
v_cvt_pk_bf16_f32 v61, v30, v31
v_mfma_f32_16x16x32_bf16 v[236:239], a[44:47], v[76:79], v[236:239]
v_mfma_f32_16x16x32_bf16 v[204:207], a[44:47], v[72:75], v[204:207]
v_exp_f32 v33, v33
v_mfma_f32_16x16x32_bf16 v[172:175], a[44:47], v[68:71], v[172:175]
v_exp_f32 v34, v34
v_mfma_f32_16x16x32_bf16 v[140:143], a[44:47], v[64:67], v[140:143]
ds_read_b128 a[16:19], v1 offset:28672
v_cvt_pk_bf16_f32 v50, v32, v33
v_mfma_f32_16x16x32_bf16 v[144:147], a[48:51], v[64:67], v[144:147]
v_mfma_f32_16x16x32_bf16 v[176:179], a[48:51], v[68:71], v[176:179]
v_exp_f32 v35, v35
v_mfma_f32_16x16x32_bf16 v[208:211], a[48:51], v[72:75], v[208:211]
ds_read_b128 a[20:23], v1 offset:29696
v_cvt_pk_bf16_f32 v51, v34, v35
v_mfma_f32_16x16x32_bf16 v[240:243], a[48:51], v[76:79], v[240:243]
v_exp_f32 v36, v36
v_mfma_f32_16x16x32_bf16 v[244:247], a[52:55], v[76:79], v[244:247]
v_exp_f32 v37, v37
v_mfma_f32_16x16x32_bf16 v[212:215], a[52:55], v[72:75], v[212:215]
v_cvt_pk_bf16_f32 v54, v36, v37
v_mfma_f32_16x16x32_bf16 v[180:183], a[52:55], v[68:71], v[180:183]
buffer_load_dwordx4 v3, s[48:51], s7 offen offset:1024 sc1 lds
v_mfma_f32_16x16x32_bf16 v[148:151], a[52:55], v[64:67], v[148:151]
ds_read_b128 a[24:27], v1 offset:30720
v_mfma_f32_16x16x32_bf16 v[152:155], a[56:59], v[64:67], v[152:155]
v_exp_f32 v38, v38
v_mfma_f32_16x16x32_bf16 v[184:187], a[56:59], v[68:71], v[184:187]
v_exp_f32 v39, v39
v_mfma_f32_16x16x32_bf16 v[216:219], a[56:59], v[72:75], v[216:219]
ds_read_b128 a[28:31], v1 offset:31744
v_cvt_pk_bf16_f32 v55, v38, v39
v_mfma_f32_16x16x32_bf16 v[248:251], a[56:59], v[76:79], v[248:251]
v_mfma_f32_16x16x32_bf16 v[252:255], a[60:63], v[76:79], v[252:255]
v_exp_f32 v40, v40
v_mfma_f32_16x16x32_bf16 v[220:223], a[60:63], v[72:75], v[220:223]
v_exp_f32 v41, v41
v_mfma_f32_16x16x32_bf16 v[188:191], a[60:63], v[68:71], v[188:191]
ds_read_b128 a[32:35], v1 offset:16384
v_cvt_pk_bf16_f32 v58, v40, v41
v_mfma_f32_16x16x32_bf16 v[156:159], a[60:63], v[64:67], v[156:159]
v_smfmac_f32_16x16x64_bf16 a[224:227], a[232:235], v[64:71], v9
s_waitcnt lgkmcnt(5)
v_exp_f32 v42, v42
v_smfmac_f32_16x16x64_bf16 a[228:231], a[232:235], v[72:79], v9
ds_read_b128 a[36:39], v1 offset:17408
v_mfma_f32_16x16x32_bf16 v[16:19], a[0:3], a[160:163], v[80:83]
v_exp_f32 v43, v43
v_mfma_f32_16x16x32_bf16 v[16:19], a[4:7], a[164:167], v[16:19]
v_exp_f32 v44, v44
v_mfma_f32_16x16x32_bf16 v[16:19], a[8:11], a[168:171], v[16:19]
v_cvt_pk_bf16_f32 v59, v42, v43
v_mfma_f32_16x16x32_bf16 v[16:19], a[12:15], a[172:175], v[16:19]
ds_read_b128 a[40:43], v1 offset:18432
v_mfma_f32_16x16x32_bf16 v[20:23], a[0:3], a[176:179], v[84:87]
buffer_load_dwordx4 v3, s[48:51], s7 offen offset:2048 sc1 lds
v_mfma_f32_16x16x32_bf16 v[20:23], a[4:7], a[180:183], v[20:23]
v_exp_f32 v45, v45
v_mfma_f32_16x16x32_bf16 v[20:23], a[8:11], a[184:187], v[20:23]
v_exp_f32 v46, v46
v_mfma_f32_16x16x32_bf16 v[20:23], a[12:15], a[188:191], v[20:23]
ds_read_b128 a[44:47], v1 offset:19456
v_cvt_pk_bf16_f32 v62, v44, v45
v_mfma_f32_16x16x32_bf16 v[24:27], a[0:3], a[192:195], v[88:91]
v_mfma_f32_16x16x32_bf16 v[24:27], a[4:7], a[196:199], v[24:27]
v_exp_f32 v47, v47
v_mfma_f32_16x16x32_bf16 v[24:27], a[8:11], a[200:203], v[24:27]
v_exp_f32 v16, v16
v_mfma_f32_16x16x32_bf16 v[24:27], a[12:15], a[204:207], v[24:27]
ds_read_b128 a[48:51], v1 offset:20480
v_cvt_pk_bf16_f32 v63, v46, v47
v_mfma_f32_16x16x32_bf16 v[28:31], a[0:3], a[208:211], v[92:95]
v_mfma_f32_16x16x32_bf16 v[28:31], a[4:7], a[212:215], v[28:31]
v_exp_f32 v17, v17
v_mfma_f32_16x16x32_bf16 v[28:31], a[8:11], a[216:219], v[28:31]
ds_read_b128 a[52:55], v1 offset:21504
v_cvt_pk_bf16_f32 v64, v16, v17
v_mfma_f32_16x16x32_bf16 v[28:31], a[12:15], a[220:223], v[28:31]
s_waitcnt lgkmcnt(6)
v_exp_f32 v18, v18
v_mfma_f32_16x16x32_bf16 v[32:35], a[16:19], a[160:163], v[80:83]
v_mfma_f32_16x16x32_bf16 v[32:35], a[20:23], a[164:167], v[32:35]
v_exp_f32 v19, v19
v_mfma_f32_16x16x32_bf16 v[32:35], a[24:27], a[168:171], v[32:35]
ds_read_b128 a[56:59], v1 offset:22528
v_cvt_pk_bf16_f32 v65, v18, v19
v_mfma_f32_16x16x32_bf16 v[32:35], a[28:31], a[172:175], v[32:35]
buffer_load_dwordx4 v3, s[48:51], s7 offen offset:3072 sc1 lds
v_mfma_f32_16x16x32_bf16 v[36:39], a[16:19], a[176:179], v[84:87]
s_add_u32 s7, s7, 0x8000
v_exp_f32 v20, v20
v_mfma_f32_16x16x32_bf16 v[36:39], a[20:23], a[180:183], v[36:39]
s_xor_b32 s27, s27, 0x38000
v_exp_f32 v21, v21
v_mfma_f32_16x16x32_bf16 v[36:39], a[24:27], a[184:187], v[36:39]
ds_read_b128 a[60:63], v1 offset:23552
v_xor_b32 v1, 0x8000, v1
v_mfma_f32_16x16x32_bf16 v[36:39], a[28:31], a[188:191], v[36:39]
v_cvt_pk_bf16_f32 v68, v20, v21
v_mfma_f32_16x16x32_bf16 v[40:43], a[16:19], a[192:195], v[88:91]
v_exp_f32 v22, v22
v_mfma_f32_16x16x32_bf16 v[40:43], a[20:23], a[196:199], v[40:43]
v_exp_f32 v23, v23
v_mfma_f32_16x16x32_bf16 v[40:43], a[24:27], a[200:203], v[40:43]
v_cvt_pk_bf16_f32 v69, v22, v23
v_mfma_f32_16x16x32_bf16 v[40:43], a[28:31], a[204:207], v[40:43]
v_exp_f32 v24, v24
v_mfma_f32_16x16x32_bf16 v[44:47], a[16:19], a[208:211], v[92:95]
v_exp_f32 v25, v25
v_mfma_f32_16x16x32_bf16 v[44:47], a[20:23], a[212:215], v[44:47]
v_exp_f32 v26, v26
v_mfma_f32_16x16x32_bf16 v[44:47], a[24:27], a[216:219], v[44:47]
s_waitcnt vmcnt(16) lgkmcnt(0)
v_exp_f32 v27, v27
v_mfma_f32_16x16x32_bf16 v[44:47], a[28:31], a[220:223], v[44:47]
s_barrier
L_att_dodd0:
v_mfma_f32_16x16x32_bf16 v[128:131], a[32:35], v[48:51], v[128:131]
ds_read_b128 a[0:3], v2 offset:8192
v_cvt_pk_bf16_f32 v72, v24, v25
v_mfma_f32_16x16x32_bf16 v[160:163], a[32:35], v[52:55], v[160:163]
v_exp_f32 v28, v28
v_mfma_f32_16x16x32_bf16 v[192:195], a[32:35], v[56:59], v[192:195]
v_cvt_pk_bf16_f32 v73, v26, v27
v_mfma_f32_16x16x32_bf16 v[224:227], a[32:35], v[60:63], v[224:227]
ds_read_b128 a[4:7], v2 offset:9216
v_mfma_f32_16x16x32_bf16 v[228:231], a[36:39], v[60:63], v[228:231]
v_exp_f32 v29, v29
v_mfma_f32_16x16x32_bf16 v[196:199], a[36:39], v[56:59], v[196:199]
v_exp_f32 v30, v30
v_mfma_f32_16x16x32_bf16 v[164:167], a[36:39], v[52:55], v[164:167]
s_add_u32 m0, s19, 0x0
v_cvt_pk_bf16_f32 v76, v28, v29
v_mfma_f32_16x16x32_bf16 v[132:135], a[36:39], v[48:51], v[132:135]
buffer_load_dwordx4 v3, s[48:51], s32 offen offset:0 sc1 lds
v_mfma_f32_16x16x32_bf16 v[136:139], a[40:43], v[48:51], v[136:139]
ds_read_b128 a[8:11], v2 offset:10240
v_mfma_f32_16x16x32_bf16 v[168:171], a[40:43], v[52:55], v[168:171]
v_exp_f32 v31, v31
v_mfma_f32_16x16x32_bf16 v[200:203], a[40:43], v[56:59], v[200:203]
v_exp_f32 v32, v32
v_mfma_f32_16x16x32_bf16 v[232:235], a[40:43], v[60:63], v[232:235]
ds_read_b128 a[12:15], v2 offset:11264
v_cvt_pk_bf16_f32 v77, v30, v31
v_mfma_f32_16x16x32_bf16 v[236:239], a[44:47], v[60:63], v[236:239]
v_mfma_f32_16x16x32_bf16 v[204:207], a[44:47], v[56:59], v[204:207]
v_exp_f32 v33, v33
v_mfma_f32_16x16x32_bf16 v[172:175], a[44:47], v[52:55], v[172:175]
v_exp_f32 v34, v34
v_mfma_f32_16x16x32_bf16 v[140:143], a[44:47], v[48:51], v[140:143]
ds_read_b128 a[16:19], v2 offset:12288
v_cvt_pk_bf16_f32 v66, v32, v33
v_mfma_f32_16x16x32_bf16 v[144:147], a[48:51], v[48:51], v[144:147]
v_mfma_f32_16x16x32_bf16 v[176:179], a[48:51], v[52:55], v[176:179]
v_exp_f32 v35, v35
v_mfma_f32_16x16x32_bf16 v[208:211], a[48:51], v[56:59], v[208:211]
v_exp_f32 v36, v36
v_mfma_f32_16x16x32_bf16 v[240:243], a[48:51], v[60:63], v[240:243]
ds_read_b128 a[20:23], v2 offset:13312
v_cvt_pk_bf16_f32 v67, v34, v35
v_mfma_f32_16x16x32_bf16 v[244:247], a[52:55], v[60:63], v[244:247]
v_exp_f32 v37, v37
v_mfma_f32_16x16x32_bf16 v[212:215], a[52:55], v[56:59], v[212:215]
v_cvt_pk_bf16_f32 v70, v36, v37
v_mfma_f32_16x16x32_bf16 v[180:183], a[52:55], v[52:55], v[180:183]
ds_read_b128 a[24:27], v2 offset:14336
v_mfma_f32_16x16x32_bf16 v[148:151], a[52:55], v[48:51], v[148:151]
buffer_load_dwordx4 v3, s[48:51], s32 offen offset:1024 sc1 lds
v_mfma_f32_16x16x32_bf16 v[152:155], a[56:59], v[48:51], v[152:155]
v_exp_f32 v38, v38
v_mfma_f32_16x16x32_bf16 v[184:187], a[56:59], v[52:55], v[184:187]
v_exp_f32 v39, v39
v_mfma_f32_16x16x32_bf16 v[216:219], a[56:59], v[56:59], v[216:219]
ds_read_b128 a[28:31], v2 offset:15360
v_cvt_pk_bf16_f32 v71, v38, v39
v_mfma_f32_16x16x32_bf16 v[248:251], a[56:59], v[60:63], v[248:251]
v_mfma_f32_16x16x32_bf16 v[252:255], a[60:63], v[60:63], v[252:255]
v_exp_f32 v40, v40
v_mfma_f32_16x16x32_bf16 v[220:223], a[60:63], v[56:59], v[220:223]
v_exp_f32 v41, v41
v_mfma_f32_16x16x32_bf16 v[188:191], a[60:63], v[52:55], v[188:191]
ds_read_b128 a[32:35], v2 offset:0
v_cvt_pk_bf16_f32 v74, v40, v41
v_mfma_f32_16x16x32_bf16 v[156:159], a[60:63], v[48:51], v[156:159]
v_smfmac_f32_16x16x64_bf16 a[224:227], a[232:235], v[48:55], v9
v_exp_f32 v42, v42
v_smfmac_f32_16x16x64_bf16 a[228:231], a[232:235], v[56:63], v9
s_waitcnt lgkmcnt(5)
v_exp_f32 v43, v43
v_mfma_f32_16x16x32_bf16 v[16:19], a[0:3], a[160:163], v[80:83]
ds_read_b128 a[36:39], v2 offset:1024
v_cvt_pk_bf16_f32 v75, v42, v43
v_mfma_f32_16x16x32_bf16 v[16:19], a[4:7], a[164:167], v[16:19]
v_exp_f32 v44, v44
v_mfma_f32_16x16x32_bf16 v[16:19], a[8:11], a[168:171], v[16:19]
v_mfma_f32_16x16x32_bf16 v[16:19], a[12:15], a[172:175], v[16:19]
v_exp_f32 v45, v45
v_mfma_f32_16x16x32_bf16 v[20:23], a[0:3], a[176:179], v[84:87]
ds_read_b128 a[40:43], v2 offset:2048
v_cvt_pk_bf16_f32 v78, v44, v45
v_mfma_f32_16x16x32_bf16 v[20:23], a[4:7], a[180:183], v[20:23]
buffer_load_dwordx4 v3, s[48:51], s32 offen offset:2048 sc1 lds
v_mfma_f32_16x16x32_bf16 v[20:23], a[8:11], a[184:187], v[20:23]
v_exp_f32 v46, v46
v_mfma_f32_16x16x32_bf16 v[20:23], a[12:15], a[188:191], v[20:23]
ds_read_b128 a[44:47], v2 offset:3072
v_mfma_f32_16x16x32_bf16 v[24:27], a[0:3], a[192:195], v[88:91]
v_mfma_f32_16x16x32_bf16 v[24:27], a[4:7], a[196:199], v[24:27]
v_exp_f32 v47, v47
v_mfma_f32_16x16x32_bf16 v[24:27], a[8:11], a[200:203], v[24:27]
v_exp_f32 v16, v16
v_mfma_f32_16x16x32_bf16 v[24:27], a[12:15], a[204:207], v[24:27]
ds_read_b128 a[48:51], v2 offset:4096
v_cvt_pk_bf16_f32 v79, v46, v47
v_mfma_f32_16x16x32_bf16 v[28:31], a[0:3], a[208:211], v[92:95]
v_mfma_f32_16x16x32_bf16 v[28:31], a[4:7], a[212:215], v[28:31]
v_exp_f32 v17, v17
v_mfma_f32_16x16x32_bf16 v[28:31], a[8:11], a[216:219], v[28:31]
s_waitcnt lgkmcnt(5)
v_exp_f32 v18, v18
v_mfma_f32_16x16x32_bf16 v[28:31], a[12:15], a[220:223], v[28:31]
ds_read_b128 a[52:55], v2 offset:5120
v_cvt_pk_bf16_f32 v48, v16, v17
v_mfma_f32_16x16x32_bf16 v[32:35], a[16:19], a[160:163], v[80:83]
v_mfma_f32_16x16x32_bf16 v[32:35], a[20:23], a[164:167], v[32:35]
v_exp_f32 v19, v19
v_mfma_f32_16x16x32_bf16 v[32:35], a[24:27], a[168:171], v[32:35]
v_exp_f32 v20, v20
v_mfma_f32_16x16x32_bf16 v[32:35], a[28:31], a[172:175], v[32:35]
ds_read_b128 a[56:59], v2 offset:6144
v_cvt_pk_bf16_f32 v49, v18, v19
v_mfma_f32_16x16x32_bf16 v[36:39], a[16:19], a[176:179], v[84:87]
v_exp_f32 v21, v21
v_mfma_f32_16x16x32_bf16 v[36:39], a[20:23], a[180:183], v[36:39]
buffer_load_dwordx4 v3, s[48:51], s32 offen offset:3072 sc1 lds
v_mfma_f32_16x16x32_bf16 v[36:39], a[24:27], a[184:187], v[36:39]
s_add_u32 s32, s32, 0x8000
v_cvt_pk_bf16_f32 v52, v20, v21
v_mfma_f32_16x16x32_bf16 v[36:39], a[28:31], a[188:191], v[36:39]
ds_read_b128 a[60:63], v2 offset:7168
v_mfma_f32_16x16x32_bf16 v[40:43], a[16:19], a[192:195], v[88:91]
v_exp_f32 v22, v22
v_mfma_f32_16x16x32_bf16 v[40:43], a[20:23], a[196:199], v[40:43]
v_exp_f32 v23, v23
v_mfma_f32_16x16x32_bf16 v[40:43], a[24:27], a[200:203], v[40:43]
v_cvt_pk_bf16_f32 v53, v22, v23
v_mfma_f32_16x16x32_bf16 v[40:43], a[28:31], a[204:207], v[40:43]
v_exp_f32 v24, v24
v_mfma_f32_16x16x32_bf16 v[44:47], a[16:19], a[208:211], v[92:95]
v_exp_f32 v25, v25
v_mfma_f32_16x16x32_bf16 v[44:47], a[20:23], a[212:215], v[44:47]
v_exp_f32 v26, v26
v_mfma_f32_16x16x32_bf16 v[44:47], a[24:27], a[216:219], v[44:47]
v_exp_f32 v27, v27
v_mfma_f32_16x16x32_bf16 v[44:47], a[28:31], a[220:223], v[44:47]
s_waitcnt lgkmcnt(0)
v_mfma_f32_16x16x32_bf16 v[128:131], a[32:35], v[64:67], v[128:131]
ds_read_b128 a[0:3], v2 offset:24576
v_cvt_pk_bf16_f32 v56, v24, v25
v_mfma_f32_16x16x32_bf16 v[160:163], a[32:35], v[68:71], v[160:163]
v_exp_f32 v28, v28
v_mfma_f32_16x16x32_bf16 v[192:195], a[32:35], v[72:75], v[192:195]
v_cvt_pk_bf16_f32 v57, v26, v27
v_mfma_f32_16x16x32_bf16 v[224:227], a[32:35], v[76:79], v[224:227]
ds_read_b128 a[4:7], v2 offset:25600
v_mfma_f32_16x16x32_bf16 v[228:231], a[36:39], v[76:79], v[228:231]
v_exp_f32 v29, v29
v_mfma_f32_16x16x32_bf16 v[196:199], a[36:39], v[72:75], v[196:199]
v_exp_f32 v30, v30
v_mfma_f32_16x16x32_bf16 v[164:167], a[36:39], v[68:71], v[164:167]
s_add_u32 m0, s19, 0x1000
v_cvt_pk_bf16_f32 v60, v28, v29
v_mfma_f32_16x16x32_bf16 v[132:135], a[36:39], v[64:67], v[132:135]
buffer_load_dwordx4 v3, s[48:51], s7 offen offset:0 sc1 lds
v_mfma_f32_16x16x32_bf16 v[136:139], a[40:43], v[64:67], v[136:139]
ds_read_b128 a[8:11], v2 offset:26624
v_mfma_f32_16x16x32_bf16 v[168:171], a[40:43], v[68:71], v[168:171]
v_exp_f32 v31, v31
v_mfma_f32_16x16x32_bf16 v[200:203], a[40:43], v[72:75], v[200:203]
v_exp_f32 v32, v32
v_mfma_f32_16x16x32_bf16 v[232:235], a[40:43], v[76:79], v[232:235]
ds_read_b128 a[12:15], v2 offset:27648
v_cvt_pk_bf16_f32 v61, v30, v31
v_mfma_f32_16x16x32_bf16 v[236:239], a[44:47], v[76:79], v[236:239]
v_mfma_f32_16x16x32_bf16 v[204:207], a[44:47], v[72:75], v[204:207]
v_exp_f32 v33, v33
v_mfma_f32_16x16x32_bf16 v[172:175], a[44:47], v[68:71], v[172:175]
v_exp_f32 v34, v34
v_mfma_f32_16x16x32_bf16 v[140:143], a[44:47], v[64:67], v[140:143]
ds_read_b128 a[16:19], v2 offset:28672
v_cvt_pk_bf16_f32 v50, v32, v33
v_mfma_f32_16x16x32_bf16 v[144:147], a[48:51], v[64:67], v[144:147]
v_exp_f32 v35, v35
v_mfma_f32_16x16x32_bf16 v[176:179], a[48:51], v[68:71], v[176:179]
v_cvt_pk_bf16_f32 v51, v34, v35
v_mfma_f32_16x16x32_bf16 v[208:211], a[48:51], v[72:75], v[208:211]
ds_read_b128 a[20:23], v2 offset:29696
v_mfma_f32_16x16x32_bf16 v[240:243], a[48:51], v[76:79], v[240:243]
v_exp_f32 v36, v36
v_mfma_f32_16x16x32_bf16 v[244:247], a[52:55], v[76:79], v[244:247]
v_exp_f32 v37, v37
v_mfma_f32_16x16x32_bf16 v[212:215], a[52:55], v[72:75], v[212:215]
v_cvt_pk_bf16_f32 v54, v36, v37
v_mfma_f32_16x16x32_bf16 v[180:183], a[52:55], v[68:71], v[180:183]
buffer_load_dwordx4 v3, s[48:51], s7 offen offset:1024 sc1 lds
v_mfma_f32_16x16x32_bf16 v[148:151], a[52:55], v[64:67], v[148:151]
ds_read_b128 a[24:27], v2 offset:30720
v_mfma_f32_16x16x32_bf16 v[152:155], a[56:59], v[64:67], v[152:155]
v_exp_f32 v38, v38
v_mfma_f32_16x16x32_bf16 v[184:187], a[56:59], v[68:71], v[184:187]
v_exp_f32 v39, v39
v_mfma_f32_16x16x32_bf16 v[216:219], a[56:59], v[72:75], v[216:219]
ds_read_b128 a[28:31], v2 offset:31744
v_cvt_pk_bf16_f32 v55, v38, v39
v_mfma_f32_16x16x32_bf16 v[248:251], a[56:59], v[76:79], v[248:251]
v_exp_f32 v40, v40
v_mfma_f32_16x16x32_bf16 v[252:255], a[60:63], v[76:79], v[252:255]
v_mfma_f32_16x16x32_bf16 v[220:223], a[60:63], v[72:75], v[220:223]
v_exp_f32 v41, v41
v_mfma_f32_16x16x32_bf16 v[188:191], a[60:63], v[68:71], v[188:191]
ds_read_b128 a[32:35], v2 offset:16384
v_cvt_pk_bf16_f32 v58, v40, v41
v_mfma_f32_16x16x32_bf16 v[156:159], a[60:63], v[64:67], v[156:159]
v_exp_f32 v42, v42
v_smfmac_f32_16x16x64_bf16 a[224:227], a[232:235], v[64:71], v9
s_waitcnt lgkmcnt(5)
v_smfmac_f32_16x16x64_bf16 a[228:231], a[232:235], v[72:79], v9
ds_read_b128 a[36:39], v2 offset:17408
v_mfma_f32_16x16x32_bf16 v[16:19], a[0:3], a[160:163], v[80:83]
v_exp_f32 v43, v43
v_mfma_f32_16x16x32_bf16 v[16:19], a[4:7], a[164:167], v[16:19]
v_exp_f32 v44, v44
v_mfma_f32_16x16x32_bf16 v[16:19], a[8:11], a[168:171], v[16:19]
buffer_load_dwordx4 v3, s[48:51], s7 offen offset:2048 sc1 lds
v_mfma_f32_16x16x32_bf16 v[16:19], a[12:15], a[172:175], v[16:19]
ds_read_b128 a[40:43], v2 offset:18432
v_cvt_pk_bf16_f32 v59, v42, v43
v_mfma_f32_16x16x32_bf16 v[20:23], a[0:3], a[176:179], v[84:87]
v_exp_f32 v45, v45
v_mfma_f32_16x16x32_bf16 v[20:23], a[4:7], a[180:183], v[20:23]
v_cvt_pk_bf16_f32 v62, v44, v45
v_mfma_f32_16x16x32_bf16 v[20:23], a[8:11], a[184:187], v[20:23]
v_exp_f32 v46, v46
v_mfma_f32_16x16x32_bf16 v[20:23], a[12:15], a[188:191], v[20:23]
ds_read_b128 a[44:47], v2 offset:19456
v_mfma_f32_16x16x32_bf16 v[24:27], a[0:3], a[192:195], v[88:91]
v_exp_f32 v47, v47
v_mfma_f32_16x16x32_bf16 v[24:27], a[4:7], a[196:199], v[24:27]
v_cvt_pk_bf16_f32 v63, v46, v47
v_mfma_f32_16x16x32_bf16 v[24:27], a[8:11], a[200:203], v[24:27]
v_exp_f32 v16, v16
v_mfma_f32_16x16x32_bf16 v[24:27], a[12:15], a[204:207], v[24:27]
ds_read_b128 a[48:51], v2 offset:20480
v_mfma_f32_16x16x32_bf16 v[28:31], a[0:3], a[208:211], v[92:95]
v_exp_f32 v17, v17
v_mfma_f32_16x16x32_bf16 v[28:31], a[4:7], a[212:215], v[28:31]
v_exp_f32 v18, v18
v_mfma_f32_16x16x32_bf16 v[28:31], a[8:11], a[216:219], v[28:31]
ds_read_b128 a[52:55], v2 offset:21504
v_cvt_pk_bf16_f32 v64, v16, v17
v_mfma_f32_16x16x32_bf16 v[28:31], a[12:15], a[220:223], v[28:31]
s_waitcnt lgkmcnt(6)
v_mfma_f32_16x16x32_bf16 v[32:35], a[16:19], a[160:163], v[80:83]
v_exp_f32 v19, v19
v_mfma_f32_16x16x32_bf16 v[32:35], a[20:23], a[164:167], v[32:35]
buffer_load_dwordx4 v3, s[48:51], s7 offen offset:3072 sc1 lds
v_mfma_f32_16x16x32_bf16 v[32:35], a[24:27], a[168:171], v[32:35]
ds_read_b128 a[56:59], v2 offset:22528
v_cvt_pk_bf16_f32 v65, v18, v19
v_mfma_f32_16x16x32_bf16 v[32:35], a[28:31], a[172:175], v[32:35]
s_add_u32 s7, s7, 0x8000
v_exp_f32 v20, v20
v_mfma_f32_16x16x32_bf16 v[36:39], a[16:19], a[176:179], v[84:87]
s_xor_b32 s19, s19, 0x8000
v_mfma_f32_16x16x32_bf16 v[36:39], a[20:23], a[180:183], v[36:39]
s_sub_u32 s15, s15, 1
v_exp_f32 v21, v21
v_mfma_f32_16x16x32_bf16 v[36:39], a[24:27], a[184:187], v[36:39]
ds_read_b128 a[60:63], v2 offset:23552
v_xor_b32 v2, 0x38000, v2
v_mfma_f32_16x16x32_bf16 v[36:39], a[28:31], a[188:191], v[36:39]
s_cmp_lg_u32 s15, 0
v_exp_f32 v22, v22
v_mfma_f32_16x16x32_bf16 v[40:43], a[16:19], a[192:195], v[88:91]
v_exp_f32 v23, v23
v_mfma_f32_16x16x32_bf16 v[40:43], a[20:23], a[196:199], v[40:43]
v_cvt_pk_bf16_f32 v68, v20, v21
v_cvt_pk_bf16_f32 v69, v22, v23
v_mfma_f32_16x16x32_bf16 v[40:43], a[24:27], a[200:203], v[40:43]
v_exp_f32 v24, v24
v_mfma_f32_16x16x32_bf16 v[40:43], a[28:31], a[204:207], v[40:43]
v_exp_f32 v25, v25
v_mfma_f32_16x16x32_bf16 v[44:47], a[16:19], a[208:211], v[92:95]
v_exp_f32 v26, v26
v_mfma_f32_16x16x32_bf16 v[44:47], a[20:23], a[212:215], v[44:47]
v_exp_f32 v27, v27
v_mfma_f32_16x16x32_bf16 v[44:47], a[24:27], a[216:219], v[44:47]
s_waitcnt vmcnt(16) lgkmcnt(0)
v_mfma_f32_16x16x32_bf16 v[44:47], a[28:31], a[220:223], v[44:47]
s_barrier
s_cbranch_scc1 L_att_deven0
s_branch L_att_ddone
L_att_deven1:
v_mfma_f32_16x16x32_bf16 v[128:131], a[32:35], v[48:51], v[128:131]
ds_read_b128 a[0:3], v1 offset:8192
v_cvt_pk_bf16_f32 v72, v24, v25
v_mfma_f32_16x16x32_bf16 v[160:163], a[32:35], v[52:55], v[160:163]
v_exp_f32 v28, v28
v_mfma_f32_16x16x32_bf16 v[192:195], a[32:35], v[56:59], v[192:195]
v_cvt_pk_bf16_f32 v73, v26, v27
v_mfma_f32_16x16x32_bf16 v[224:227], a[32:35], v[60:63], v[224:227]
ds_read_b128 a[4:7], v1 offset:9216
v_mfma_f32_16x16x32_bf16 v[228:231], a[36:39], v[60:63], v[228:231]
v_exp_f32 v29, v29
v_mfma_f32_16x16x32_bf16 v[196:199], a[36:39], v[56:59], v[196:199]
v_exp_f32 v30, v30
v_mfma_f32_16x16x32_bf16 v[164:167], a[36:39], v[52:55], v[164:167]
s_add_u32 m0, s27, 0x0
v_cvt_pk_bf16_f32 v76, v28, v29
v_mfma_f32_16x16x32_bf16 v[132:135], a[36:39], v[48:51], v[132:135]
buffer_load_dwordx4 v3, s[48:51], s32 offen offset:0 sc1 lds
v_mfma_f32_16x16x32_bf16 v[136:139], a[40:43], v[48:51], v[136:139]
ds_read_b128 a[8:11], v1 offset:10240
v_mfma_f32_16x16x32_bf16 v[168:171], a[40:43], v[52:55], v[168:171]
v_exp_f32 v31, v31
v_mfma_f32_16x16x32_bf16 v[200:203], a[40:43], v[56:59], v[200:203]
v_exp_f32 v32, v32
v_mfma_f32_16x16x32_bf16 v[232:235], a[40:43], v[60:63], v[232:235]
ds_read_b128 a[12:15], v1 offset:11264
v_cvt_pk_bf16_f32 v77, v30, v31
v_mfma_f32_16x16x32_bf16 v[236:239], a[44:47], v[60:63], v[236:239]
v_mfma_f32_16x16x32_bf16 v[204:207], a[44:47], v[56:59], v[204:207]
v_exp_f32 v33, v33
v_mfma_f32_16x16x32_bf16 v[172:175], a[44:47], v[52:55], v[172:175]
v_exp_f32 v34, v34
v_mfma_f32_16x16x32_bf16 v[140:143], a[44:47], v[48:51], v[140:143]
ds_read_b128 a[16:19], v1 offset:12288
v_cvt_pk_bf16_f32 v66, v32, v33
v_mfma_f32_16x16x32_bf16 v[144:147], a[48:51], v[48:51], v[144:147]
v_mfma_f32_16x16x32_bf16 v[176:179], a[48:51], v[52:55], v[176:179]
v_exp_f32 v35, v35
v_mfma_f32_16x16x32_bf16 v[208:211], a[48:51], v[56:59], v[208:211]
v_exp_f32 v36, v36
v_mfma_f32_16x16x32_bf16 v[240:243], a[48:51], v[60:63], v[240:243]
ds_read_b128 a[20:23], v1 offset:13312
v_cvt_pk_bf16_f32 v67, v34, v35
v_mfma_f32_16x16x32_bf16 v[244:247], a[52:55], v[60:63], v[244:247]
v_exp_f32 v37, v37
v_mfma_f32_16x16x32_bf16 v[212:215], a[52:55], v[56:59], v[212:215]
v_cvt_pk_bf16_f32 v70, v36, v37
v_mfma_f32_16x16x32_bf16 v[180:183], a[52:55], v[52:55], v[180:183]
ds_read_b128 a[24:27], v1 offset:14336
v_mfma_f32_16x16x32_bf16 v[148:151], a[52:55], v[48:51], v[148:151]
buffer_load_dwordx4 v3, s[48:51], s32 offen offset:1024 sc1 lds
v_mfma_f32_16x16x32_bf16 v[152:155], a[56:59], v[48:51], v[152:155]
v_exp_f32 v38, v38
v_mfma_f32_16x16x32_bf16 v[184:187], a[56:59], v[52:55], v[184:187]
v_exp_f32 v39, v39
v_mfma_f32_16x16x32_bf16 v[216:219], a[56:59], v[56:59], v[216:219]
ds_read_b128 a[28:31], v1 offset:15360
v_cvt_pk_bf16_f32 v71, v38, v39
v_mfma_f32_16x16x32_bf16 v[248:251], a[56:59], v[60:63], v[248:251]
v_mfma_f32_16x16x32_bf16 v[252:255], a[60:63], v[60:63], v[252:255]
v_exp_f32 v40, v40
v_mfma_f32_16x16x32_bf16 v[220:223], a[60:63], v[56:59], v[220:223]
v_exp_f32 v41, v41
v_mfma_f32_16x16x32_bf16 v[188:191], a[60:63], v[52:55], v[188:191]
ds_read_b128 a[32:35], v1 offset:0
v_cvt_pk_bf16_f32 v74, v40, v41
v_mfma_f32_16x16x32_bf16 v[156:159], a[60:63], v[48:51], v[156:159]
v_smfmac_f32_16x16x64_bf16 a[224:227], a[232:235], v[48:55], v9
v_exp_f32 v42, v42
v_smfmac_f32_16x16x64_bf16 a[228:231], a[232:235], v[56:63], v9
s_waitcnt lgkmcnt(5)
v_exp_f32 v43, v43
v_mfma_f32_16x16x32_bf16 v[16:19], a[0:3], a[160:163], v[80:83]
ds_read_b128 a[36:39], v1 offset:1024
v_cvt_pk_bf16_f32 v75, v42, v43
v_mfma_f32_16x16x32_bf16 v[16:19], a[4:7], a[164:167], v[16:19]
v_exp_f32 v44, v44
v_mfma_f32_16x16x32_bf16 v[16:19], a[8:11], a[168:171], v[16:19]
v_mfma_f32_16x16x32_bf16 v[16:19], a[12:15], a[172:175], v[16:19]
v_exp_f32 v45, v45
v_mfma_f32_16x16x32_bf16 v[20:23], a[0:3], a[176:179], v[84:87]
ds_read_b128 a[40:43], v1 offset:2048
v_cvt_pk_bf16_f32 v78, v44, v45
v_mfma_f32_16x16x32_bf16 v[20:23], a[4:7], a[180:183], v[20:23]
buffer_load_dwordx4 v3, s[48:51], s32 offen offset:2048 sc1 lds
v_mfma_f32_16x16x32_bf16 v[20:23], a[8:11], a[184:187], v[20:23]
v_exp_f32 v46, v46
v_mfma_f32_16x16x32_bf16 v[20:23], a[12:15], a[188:191], v[20:23]
ds_read_b128 a[44:47], v1 offset:3072
v_mfma_f32_16x16x32_bf16 v[24:27], a[0:3], a[192:195], v[88:91]
v_mfma_f32_16x16x32_bf16 v[24:27], a[4:7], a[196:199], v[24:27]
v_exp_f32 v47, v47
v_mfma_f32_16x16x32_bf16 v[24:27], a[8:11], a[200:203], v[24:27]
v_exp_f32 v16, v16
v_mfma_f32_16x16x32_bf16 v[24:27], a[12:15], a[204:207], v[24:27]
ds_read_b128 a[48:51], v1 offset:4096
v_cvt_pk_bf16_f32 v79, v46, v47
v_mfma_f32_16x16x32_bf16 v[28:31], a[0:3], a[208:211], v[92:95]
v_mfma_f32_16x16x32_bf16 v[28:31], a[4:7], a[212:215], v[28:31]
v_exp_f32 v17, v17
v_mfma_f32_16x16x32_bf16 v[28:31], a[8:11], a[216:219], v[28:31]
s_waitcnt lgkmcnt(5)
v_exp_f32 v18, v18
v_mfma_f32_16x16x32_bf16 v[28:31], a[12:15], a[220:223], v[28:31]
ds_read_b128 a[52:55], v1 offset:5120
v_cvt_pk_bf16_f32 v48, v16, v17
v_mfma_f32_16x16x32_bf16 v[32:35], a[16:19], a[160:163], v[80:83]
v_mfma_f32_16x16x32_bf16 v[32:35], a[20:23], a[164:167], v[32:35]
v_exp_f32 v19, v19
v_mfma_f32_16x16x32_bf16 v[32:35], a[24:27], a[168:171], v[32:35]
v_exp_f32 v20, v20
v_mfma_f32_16x16x32_bf16 v[32:35], a[28:31], a[172:175], v[32:35]
ds_read_b128 a[56:59], v1 offset:6144
v_cvt_pk_bf16_f32 v49, v18, v19
v_mfma_f32_16x16x32_bf16 v[36:39], a[16:19], a[176:179], v[84:87]
v_exp_f32 v21, v21
v_mfma_f32_16x16x32_bf16 v[36:39], a[20:23], a[180:183], v[36:39]
buffer_load_dwordx4 v3, s[48:51], s32 offen offset:3072 sc1 lds
v_mfma_f32_16x16x32_bf16 v[36:39], a[24:27], a[184:187], v[36:39]
s_add_u32 s32, s32, 0x8000
v_cvt_pk_bf16_f32 v52, v20, v21
v_mfma_f32_16x16x32_bf16 v[36:39], a[28:31], a[188:191], v[36:39]
ds_read_b128 a[60:63], v1 offset:7168
v_mfma_f32_16x16x32_bf16 v[40:43], a[16:19], a[192:195], v[88:91]
v_exp_f32 v22, v22
v_mfma_f32_16x16x32_bf16 v[40:43], a[20:23], a[196:199], v[40:43]
v_exp_f32 v23, v23
v_mfma_f32_16x16x32_bf16 v[40:43], a[24:27], a[200:203], v[40:43]
v_cvt_pk_bf16_f32 v53, v22, v23
v_mfma_f32_16x16x32_bf16 v[40:43], a[28:31], a[204:207], v[40:43]
v_exp_f32 v24, v24
v_mfma_f32_16x16x32_bf16 v[44:47], a[16:19], a[208:211], v[92:95]
v_exp_f32 v25, v25
v_mfma_f32_16x16x32_bf16 v[44:47], a[20:23], a[212:215], v[44:47]
v_exp_f32 v26, v26
v_mfma_f32_16x16x32_bf16 v[44:47], a[24:27], a[216:219], v[44:47]
v_exp_f32 v27, v27
v_mfma_f32_16x16x32_bf16 v[44:47], a[28:31], a[220:223], v[44:47]
s_waitcnt lgkmcnt(0)
v_mfma_f32_16x16x32_bf16 v[128:131], a[32:35], v[64:67], v[128:131]
ds_read_b128 a[0:3], v1 offset:24576
v_cvt_pk_bf16_f32 v56, v24, v25
v_mfma_f32_16x16x32_bf16 v[160:163], a[32:35], v[68:71], v[160:163]
v_exp_f32 v28, v28
v_mfma_f32_16x16x32_bf16 v[192:195], a[32:35], v[72:75], v[192:195]
v_cvt_pk_bf16_f32 v57, v26, v27
v_mfma_f32_16x16x32_bf16 v[224:227], a[32:35], v[76:79], v[224:227]
ds_read_b128 a[4:7], v1 offset:25600
v_mfma_f32_16x16x32_bf16 v[228:231], a[36:39], v[76:79], v[228:231]
v_exp_f32 v29, v29
v_mfma_f32_16x16x32_bf16 v[196:199], a[36:39], v[72:75], v[196:199]
v_exp_f32 v30, v30
v_mfma_f32_16x16x32_bf16 v[164:167], a[36:39], v[68:71], v[164:167]
s_add_u32 m0, s27, 0x1000
v_cvt_pk_bf16_f32 v60, v28, v29
v_mfma_f32_16x16x32_bf16 v[132:135], a[36:39], v[64:67], v[132:135]
buffer_load_dwordx4 v3, s[48:51], s7 offen offset:0 sc1 lds
v_mfma_f32_16x16x32_bf16 v[136:139], a[40:43], v[64:67], v[136:139]
ds_read_b128 a[8:11], v1 offset:26624
v_mfma_f32_16x16x32_bf16 v[168:171], a[40:43], v[68:71], v[168:171]
v_exp_f32 v31, v31
v_mfma_f32_16x16x32_bf16 v[200:203], a[40:43], v[72:75], v[200:203]
v_exp_f32 v32, v32
v_mfma_f32_16x16x32_bf16 v[232:235], a[40:43], v[76:79], v[232:235]
ds_read_b128 a[12:15], v1 offset:27648
v_cvt_pk_bf16_f32 v61, v30, v31
v_mfma_f32_16x16x32_bf16 v[236:239], a[44:47], v[76:79], v[236:239]
v_mfma_f32_16x16x32_bf16 v[204:207], a[44:47], v[72:75], v[204:207]
v_exp_f32 v33, v33
v_mfma_f32_16x16x32_bf16 v[172:175], a[44:47], v[68:71], v[172:175]
v_exp_f32 v34, v34
v_mfma_f32_16x16x32_bf16 v[140:143], a[44:47], v[64:67], v[140:143]
ds_read_b128 a[16:19], v1 offset:28672
v_cvt_pk_bf16_f32 v50, v32, v33
v_mfma_f32_16x16x32_bf16 v[144:147], a[48:51], v[64:67], v[144:147]
v_mfma_f32_16x16x32_bf16 v[176:179], a[48:51], v[68:71], v[176:179]
v_exp_f32 v35, v35
v_mfma_f32_16x16x32_bf16 v[208:211], a[48:51], v[72:75], v[208:211]
ds_read_b128 a[20:23], v1 offset:29696
v_cvt_pk_bf16_f32 v51, v34, v35
v_mfma_f32_16x16x32_bf16 v[240:243], a[48:51], v[76:79], v[240:243]
v_exp_f32 v36, v36
v_mfma_f32_16x16x32_bf16 v[244:247], a[52:55], v[76:79], v[244:247]
v_exp_f32 v37, v37
v_mfma_f32_16x16x32_bf16 v[212:215], a[52:55], v[72:75], v[212:215]
v_cvt_pk_bf16_f32 v54, v36, v37
v_mfma_f32_16x16x32_bf16 v[180:183], a[52:55], v[68:71], v[180:183]
buffer_load_dwordx4 v3, s[48:51], s7 offen offset:1024 sc1 lds
v_mfma_f32_16x16x32_bf16 v[148:151], a[52:55], v[64:67], v[148:151]
ds_read_b128 a[24:27], v1 offset:30720
v_mfma_f32_16x16x32_bf16 v[152:155], a[56:59], v[64:67], v[152:155]
v_exp_f32 v38, v38
v_mfma_f32_16x16x32_bf16 v[184:187], a[56:59], v[68:71], v[184:187]
v_exp_f32 v39, v39
v_mfma_f32_16x16x32_bf16 v[216:219], a[56:59], v[72:75], v[216:219]
ds_read_b128 a[28:31], v1 offset:31744
v_cvt_pk_bf16_f32 v55, v38, v39
v_mfma_f32_16x16x32_bf16 v[248:251], a[56:59], v[76:79], v[248:251]
v_mfma_f32_16x16x32_bf16 v[252:255], a[60:63], v[76:79], v[252:255]
v_exp_f32 v40, v40
v_mfma_f32_16x16x32_bf16 v[220:223], a[60:63], v[72:75], v[220:223]
v_exp_f32 v41, v41
v_mfma_f32_16x16x32_bf16 v[188:191], a[60:63], v[68:71], v[188:191]
ds_read_b128 a[32:35], v1 offset:16384
v_cvt_pk_bf16_f32 v58, v40, v41
v_mfma_f32_16x16x32_bf16 v[156:159], a[60:63], v[64:67], v[156:159]
v_smfmac_f32_16x16x64_bf16 a[224:227], a[232:235], v[64:71], v9
s_waitcnt lgkmcnt(5)
v_exp_f32 v42, v42
v_smfmac_f32_16x16x64_bf16 a[228:231], a[232:235], v[72:79], v9
ds_read_b128 a[36:39], v1 offset:17408
v_mfma_f32_16x16x32_bf16 v[16:19], a[0:3], a[160:163], v[80:83]
v_exp_f32 v43, v43
v_mfma_f32_16x16x32_bf16 v[16:19], a[4:7], a[164:167], v[16:19]
v_exp_f32 v44, v44
v_mfma_f32_16x16x32_bf16 v[16:19], a[8:11], a[168:171], v[16:19]
v_cvt_pk_bf16_f32 v59, v42, v43
v_mfma_f32_16x16x32_bf16 v[16:19], a[12:15], a[172:175], v[16:19]
ds_read_b128 a[40:43], v1 offset:18432
v_mfma_f32_16x16x32_bf16 v[20:23], a[0:3], a[176:179], v[84:87]
buffer_load_dwordx4 v3, s[48:51], s7 offen offset:2048 sc1 lds
v_mfma_f32_16x16x32_bf16 v[20:23], a[4:7], a[180:183], v[20:23]
v_exp_f32 v45, v45
v_mfma_f32_16x16x32_bf16 v[20:23], a[8:11], a[184:187], v[20:23]
v_exp_f32 v46, v46
v_mfma_f32_16x16x32_bf16 v[20:23], a[12:15], a[188:191], v[20:23]
ds_read_b128 a[44:47], v1 offset:19456
v_cvt_pk_bf16_f32 v62, v44, v45
v_mfma_f32_16x16x32_bf16 v[24:27], a[0:3], a[192:195], v[88:91]
v_mfma_f32_16x16x32_bf16 v[24:27], a[4:7], a[196:199], v[24:27]
v_exp_f32 v47, v47
v_mfma_f32_16x16x32_bf16 v[24:27], a[8:11], a[200:203], v[24:27]
v_exp_f32 v16, v16
v_mfma_f32_16x16x32_bf16 v[24:27], a[12:15], a[204:207], v[24:27]
ds_read_b128 a[48:51], v1 offset:20480
v_cvt_pk_bf16_f32 v63, v46, v47
v_mfma_f32_16x16x32_bf16 v[28:31], a[0:3], a[208:211], v[92:95]
v_mfma_f32_16x16x32_bf16 v[28:31], a[4:7], a[212:215], v[28:31]
v_exp_f32 v17, v17
v_mfma_f32_16x16x32_bf16 v[28:31], a[8:11], a[216:219], v[28:31]
ds_read_b128 a[52:55], v1 offset:21504
v_cvt_pk_bf16_f32 v64, v16, v17
v_mfma_f32_16x16x32_bf16 v[28:31], a[12:15], a[220:223], v[28:31]
s_waitcnt lgkmcnt(6)
v_exp_f32 v18, v18
v_mfma_f32_16x16x32_bf16 v[32:35], a[16:19], a[160:163], v[80:83]
v_mfma_f32_16x16x32_bf16 v[32:35], a[20:23], a[164:167], v[32:35]
v_exp_f32 v19, v19
v_mfma_f32_16x16x32_bf16 v[32:35], a[24:27], a[168:171], v[32:35]
ds_read_b128 a[56:59], v1 offset:22528
v_cvt_pk_bf16_f32 v65, v18, v19
v_mfma_f32_16x16x32_bf16 v[32:35], a[28:31], a[172:175], v[32:35]
buffer_load_dwordx4 v3, s[48:51], s7 offen offset:3072 sc1 lds
v_mfma_f32_16x16x32_bf16 v[36:39], a[16:19], a[176:179], v[84:87]
s_add_u32 s7, s7, 0x8000
v_exp_f32 v20, v20
v_mfma_f32_16x16x32_bf16 v[36:39], a[20:23], a[180:183], v[36:39]
s_xor_b32 s27, s27, 0x38000
v_exp_f32 v21, v21
v_mfma_f32_16x16x32_bf16 v[36:39], a[24:27], a[184:187], v[36:39]
ds_read_b128 a[60:63], v1 offset:23552
v_xor_b32 v1, 0x8000, v1
v_mfma_f32_16x16x32_bf16 v[36:39], a[28:31], a[188:191], v[36:39]
v_cvt_pk_bf16_f32 v68, v20, v21
v_mfma_f32_16x16x32_bf16 v[40:43], a[16:19], a[192:195], v[88:91]
v_exp_f32 v22, v22
v_mfma_f32_16x16x32_bf16 v[40:43], a[20:23], a[196:199], v[40:43]
v_exp_f32 v23, v23
v_mfma_f32_16x16x32_bf16 v[40:43], a[24:27], a[200:203], v[40:43]
v_cvt_pk_bf16_f32 v69, v22, v23
v_mfma_f32_16x16x32_bf16 v[40:43], a[28:31], a[204:207], v[40:43]
v_exp_f32 v24, v24
v_mfma_f32_16x16x32_bf16 v[44:47], a[16:19], a[208:211], v[92:95]
s_waitcnt vmcnt(16) lgkmcnt(0)
v_exp_f32 v25, v25
v_mfma_f32_16x16x32_bf16 v[44:47], a[20:23], a[212:215], v[44:47]
s_barrier
v_exp_f32 v26, v26
v_mfma_f32_16x16x32_bf16 v[44:47], a[24:27], a[216:219], v[44:47]
v_exp_f32 v27, v27
v_mfma_f32_16x16x32_bf16 v[44:47], a[28:31], a[220:223], v[44:47]
L_att_dodd1:
v_mfma_f32_16x16x32_bf16 v[128:131], a[32:35], v[48:51], v[128:131]
ds_read_b128 a[0:3], v2 offset:8192
v_cvt_pk_bf16_f32 v72, v24, v25
v_mfma_f32_16x16x32_bf16 v[160:163], a[32:35], v[52:55], v[160:163]
v_exp_f32 v28, v28
v_mfma_f32_16x16x32_bf16 v[192:195], a[32:35], v[56:59], v[192:195]
v_cvt_pk_bf16_f32 v73, v26, v27
v_mfma_f32_16x16x32_bf16 v[224:227], a[32:35], v[60:63], v[224:227]
ds_read_b128 a[4:7], v2 offset:9216
v_mfma_f32_16x16x32_bf16 v[228:231], a[36:39], v[60:63], v[228:231]
v_exp_f32 v29, v29
v_mfma_f32_16x16x32_bf16 v[196:199], a[36:39], v[56:59], v[196:199]
v_exp_f32 v30, v30
v_mfma_f32_16x16x32_bf16 v[164:167], a[36:39], v[52:55], v[164:167]
s_add_u32 m0, s19, 0x0
v_cvt_pk_bf16_f32 v76, v28, v29
v_mfma_f32_16x16x32_bf16 v[132:135], a[36:39], v[48:51], v[132:135]
buffer_load_dwordx4 v3, s[48:51], s32 offen offset:0 sc1 lds
v_mfma_f32_16x16x32_bf16 v[136:139], a[40:43], v[48:51], v[136:139]
ds_read_b128 a[8:11], v2 offset:10240
v_mfma_f32_16x16x32_bf16 v[168:171], a[40:43], v[52:55], v[168:171]
v_exp_f32 v31, v31
v_mfma_f32_16x16x32_bf16 v[200:203], a[40:43], v[56:59], v[200:203]
v_exp_f32 v32, v32
v_mfma_f32_16x16x32_bf16 v[232:235], a[40:43], v[60:63], v[232:235]
ds_read_b128 a[12:15], v2 offset:11264
v_cvt_pk_bf16_f32 v77, v30, v31
v_mfma_f32_16x16x32_bf16 v[236:239], a[44:47], v[60:63], v[236:239]
v_mfma_f32_16x16x32_bf16 v[204:207], a[44:47], v[56:59], v[204:207]
v_exp_f32 v33, v33
v_mfma_f32_16x16x32_bf16 v[172:175], a[44:47], v[52:55], v[172:175]
v_exp_f32 v34, v34
v_mfma_f32_16x16x32_bf16 v[140:143], a[44:47], v[48:51], v[140:143]
ds_read_b128 a[16:19], v2 offset:12288
v_cvt_pk_bf16_f32 v66, v32, v33
v_mfma_f32_16x16x32_bf16 v[144:147], a[48:51], v[48:51], v[144:147]
v_mfma_f32_16x16x32_bf16 v[176:179], a[48:51], v[52:55], v[176:179]
v_exp_f32 v35, v35
v_mfma_f32_16x16x32_bf16 v[208:211], a[48:51], v[56:59], v[208:211]
v_exp_f32 v36, v36
v_mfma_f32_16x16x32_bf16 v[240:243], a[48:51], v[60:63], v[240:243]
ds_read_b128 a[20:23], v2 offset:13312
v_cvt_pk_bf16_f32 v67, v34, v35
v_mfma_f32_16x16x32_bf16 v[244:247], a[52:55], v[60:63], v[244:247]
v_exp_f32 v37, v37
v_mfma_f32_16x16x32_bf16 v[212:215], a[52:55], v[56:59], v[212:215]
v_cvt_pk_bf16_f32 v70, v36, v37
v_mfma_f32_16x16x32_bf16 v[180:183], a[52:55], v[52:55], v[180:183]
ds_read_b128 a[24:27], v2 offset:14336
v_mfma_f32_16x16x32_bf16 v[148:151], a[52:55], v[48:51], v[148:151]
buffer_load_dwordx4 v3, s[48:51], s32 offen offset:1024 sc1 lds
v_mfma_f32_16x16x32_bf16 v[152:155], a[56:59], v[48:51], v[152:155]
v_exp_f32 v38, v38
v_mfma_f32_16x16x32_bf16 v[184:187], a[56:59], v[52:55], v[184:187]
v_exp_f32 v39, v39
v_mfma_f32_16x16x32_bf16 v[216:219], a[56:59], v[56:59], v[216:219]
ds_read_b128 a[28:31], v2 offset:15360
v_cvt_pk_bf16_f32 v71, v38, v39
v_mfma_f32_16x16x32_bf16 v[248:251], a[56:59], v[60:63], v[248:251]
v_mfma_f32_16x16x32_bf16 v[252:255], a[60:63], v[60:63], v[252:255]
v_exp_f32 v40, v40
v_mfma_f32_16x16x32_bf16 v[220:223], a[60:63], v[56:59], v[220:223]
v_exp_f32 v41, v41
v_mfma_f32_16x16x32_bf16 v[188:191], a[60:63], v[52:55], v[188:191]
ds_read_b128 a[32:35], v2 offset:0
v_cvt_pk_bf16_f32 v74, v40, v41
v_mfma_f32_16x16x32_bf16 v[156:159], a[60:63], v[48:51], v[156:159]
v_smfmac_f32_16x16x64_bf16 a[224:227], a[232:235], v[48:55], v9
v_exp_f32 v42, v42
v_smfmac_f32_16x16x64_bf16 a[228:231], a[232:235], v[56:63], v9
s_waitcnt lgkmcnt(5)
v_exp_f32 v43, v43
v_mfma_f32_16x16x32_bf16 v[16:19], a[0:3], a[160:163], v[80:83]
ds_read_b128 a[36:39], v2 offset:1024
v_cvt_pk_bf16_f32 v75, v42, v43
v_mfma_f32_16x16x32_bf16 v[16:19], a[4:7], a[164:167], v[16:19]
v_exp_f32 v44, v44
v_mfma_f32_16x16x32_bf16 v[16:19], a[8:11], a[168:171], v[16:19]
v_mfma_f32_16x16x32_bf16 v[16:19], a[12:15], a[172:175], v[16:19]
v_exp_f32 v45, v45
v_mfma_f32_16x16x32_bf16 v[20:23], a[0:3], a[176:179], v[84:87]
ds_read_b128 a[40:43], v2 offset:2048
v_cvt_pk_bf16_f32 v78, v44, v45
v_mfma_f32_16x16x32_bf16 v[20:23], a[4:7], a[180:183], v[20:23]
buffer_load_dwordx4 v3, s[48:51], s32 offen offset:2048 sc1 lds
v_mfma_f32_16x16x32_bf16 v[20:23], a[8:11], a[184:187], v[20:23]
v_exp_f32 v46, v46
v_mfma_f32_16x16x32_bf16 v[20:23], a[12:15], a[188:191], v[20:23]
ds_read_b128 a[44:47], v2 offset:3072
v_mfma_f32_16x16x32_bf16 v[24:27], a[0:3], a[192:195], v[88:91]
v_mfma_f32_16x16x32_bf16 v[24:27], a[4:7], a[196:199], v[24:27]
v_exp_f32 v47, v47
v_mfma_f32_16x16x32_bf16 v[24:27], a[8:11], a[200:203], v[24:27]
v_exp_f32 v16, v16
v_mfma_f32_16x16x32_bf16 v[24:27], a[12:15], a[204:207], v[24:27]
ds_read_b128 a[48:51], v2 offset:4096
v_cvt_pk_bf16_f32 v79, v46, v47
v_mfma_f32_16x16x32_bf16 v[28:31], a[0:3], a[208:211], v[92:95]
v_mfma_f32_16x16x32_bf16 v[28:31], a[4:7], a[212:215], v[28:31]
v_exp_f32 v17, v17
v_mfma_f32_16x16x32_bf16 v[28:31], a[8:11], a[216:219], v[28:31]
s_waitcnt lgkmcnt(5)
v_exp_f32 v18, v18
v_mfma_f32_16x16x32_bf16 v[28:31], a[12:15], a[220:223], v[28:31]
ds_read_b128 a[52:55], v2 offset:5120
v_cvt_pk_bf16_f32 v48, v16, v17
v_mfma_f32_16x16x32_bf16 v[32:35], a[16:19], a[160:163], v[80:83]
v_mfma_f32_16x16x32_bf16 v[32:35], a[20:23], a[164:167], v[32:35]
v_exp_f32 v19, v19
v_mfma_f32_16x16x32_bf16 v[32:35], a[24:27], a[168:171], v[32:35]
v_exp_f32 v20, v20
v_mfma_f32_16x16x32_bf16 v[32:35], a[28:31], a[172:175], v[32:35]
ds_read_b128 a[56:59], v2 offset:6144
v_cvt_pk_bf16_f32 v49, v18, v19
v_mfma_f32_16x16x32_bf16 v[36:39], a[16:19], a[176:179], v[84:87]
v_exp_f32 v21, v21
v_mfma_f32_16x16x32_bf16 v[36:39], a[20:23], a[180:183], v[36:39]
buffer_load_dwordx4 v3, s[48:51], s32 offen offset:3072 sc1 lds
v_mfma_f32_16x16x32_bf16 v[36:39], a[24:27], a[184:187], v[36:39]
s_add_u32 s32, s32, 0x8000
v_cvt_pk_bf16_f32 v52, v20, v21
v_mfma_f32_16x16x32_bf16 v[36:39], a[28:31], a[188:191], v[36:39]
ds_read_b128 a[60:63], v2 offset:7168
v_mfma_f32_16x16x32_bf16 v[40:43], a[16:19], a[192:195], v[88:91]
v_exp_f32 v22, v22
v_mfma_f32_16x16x32_bf16 v[40:43], a[20:23], a[196:199], v[40:43]
v_exp_f32 v23, v23
v_mfma_f32_16x16x32_bf16 v[40:43], a[24:27], a[200:203], v[40:43]
v_cvt_pk_bf16_f32 v53, v22, v23
v_mfma_f32_16x16x32_bf16 v[40:43], a[28:31], a[204:207], v[40:43]
v_exp_f32 v24, v24
v_mfma_f32_16x16x32_bf16 v[44:47], a[16:19], a[208:211], v[92:95]
v_exp_f32 v25, v25
v_mfma_f32_16x16x32_bf16 v[44:47], a[20:23], a[212:215], v[44:47]
v_exp_f32 v26, v26
v_mfma_f32_16x16x32_bf16 v[44:47], a[24:27], a[216:219], v[44:47]
v_exp_f32 v27, v27
v_mfma_f32_16x16x32_bf16 v[44:47], a[28:31], a[220:223], v[44:47]
s_waitcnt lgkmcnt(0)
v_mfma_f32_16x16x32_bf16 v[128:131], a[32:35], v[64:67], v[128:131]
ds_read_b128 a[0:3], v2 offset:24576
v_cvt_pk_bf16_f32 v56, v24, v25
v_mfma_f32_16x16x32_bf16 v[160:163], a[32:35], v[68:71], v[160:163]
v_exp_f32 v28, v28
v_mfma_f32_16x16x32_bf16 v[192:195], a[32:35], v[72:75], v[192:195]
v_cvt_pk_bf16_f32 v57, v26, v27
v_mfma_f32_16x16x32_bf16 v[224:227], a[32:35], v[76:79], v[224:227]
ds_read_b128 a[4:7], v2 offset:25600
v_mfma_f32_16x16x32_bf16 v[228:231], a[36:39], v[76:79], v[228:231]
v_exp_f32 v29, v29
v_mfma_f32_16x16x32_bf16 v[196:199], a[36:39], v[72:75], v[196:199]
v_exp_f32 v30, v30
v_mfma_f32_16x16x32_bf16 v[164:167], a[36:39], v[68:71], v[164:167]
s_add_u32 m0, s19, 0x1000
v_cvt_pk_bf16_f32 v60, v28, v29
v_mfma_f32_16x16x32_bf16 v[132:135], a[36:39], v[64:67], v[132:135]
buffer_load_dwordx4 v3, s[48:51], s7 offen offset:0 sc1 lds
v_mfma_f32_16x16x32_bf16 v[136:139], a[40:43], v[64:67], v[136:139]
ds_read_b128 a[8:11], v2 offset:26624
v_mfma_f32_16x16x32_bf16 v[168:171], a[40:43], v[68:71], v[168:171]
v_exp_f32 v31, v31
v_mfma_f32_16x16x32_bf16 v[200:203], a[40:43], v[72:75], v[200:203]
v_exp_f32 v32, v32
v_mfma_f32_16x16x32_bf16 v[232:235], a[40:43], v[76:79], v[232:235]
ds_read_b128 a[12:15], v2 offset:27648
v_cvt_pk_bf16_f32 v61, v30, v31
v_mfma_f32_16x16x32_bf16 v[236:239], a[44:47], v[76:79], v[236:239]
v_mfma_f32_16x16x32_bf16 v[204:207], a[44:47], v[72:75], v[204:207]
v_exp_f32 v33, v33
v_mfma_f32_16x16x32_bf16 v[172:175], a[44:47], v[68:71], v[172:175]
v_exp_f32 v34, v34
v_mfma_f32_16x16x32_bf16 v[140:143], a[44:47], v[64:67], v[140:143]
ds_read_b128 a[16:19], v2 offset:28672
v_cvt_pk_bf16_f32 v50, v32, v33
v_mfma_f32_16x16x32_bf16 v[144:147], a[48:51], v[64:67], v[144:147]
v_exp_f32 v35, v35
v_mfma_f32_16x16x32_bf16 v[176:179], a[48:51], v[68:71], v[176:179]
v_cvt_pk_bf16_f32 v51, v34, v35
v_mfma_f32_16x16x32_bf16 v[208:211], a[48:51], v[72:75], v[208:211]
ds_read_b128 a[20:23], v2 offset:29696
v_mfma_f32_16x16x32_bf16 v[240:243], a[48:51], v[76:79], v[240:243]
v_exp_f32 v36, v36
v_mfma_f32_16x16x32_bf16 v[244:247], a[52:55], v[76:79], v[244:247]
v_exp_f32 v37, v37
v_mfma_f32_16x16x32_bf16 v[212:215], a[52:55], v[72:75], v[212:215]
v_cvt_pk_bf16_f32 v54, v36, v37
v_mfma_f32_16x16x32_bf16 v[180:183], a[52:55], v[68:71], v[180:183]
buffer_load_dwordx4 v3, s[48:51], s7 offen offset:1024 sc1 lds
v_mfma_f32_16x16x32_bf16 v[148:151], a[52:55], v[64:67], v[148:151]
ds_read_b128 a[24:27], v2 offset:30720
v_mfma_f32_16x16x32_bf16 v[152:155], a[56:59], v[64:67], v[152:155]
v_exp_f32 v38, v38
v_mfma_f32_16x16x32_bf16 v[184:187], a[56:59], v[68:71], v[184:187]
v_exp_f32 v39, v39
v_mfma_f32_16x16x32_bf16 v[216:219], a[56:59], v[72:75], v[216:219]
ds_read_b128 a[28:31], v2 offset:31744
v_cvt_pk_bf16_f32 v55, v38, v39
v_mfma_f32_16x16x32_bf16 v[248:251], a[56:59], v[76:79], v[248:251]
v_exp_f32 v40, v40
v_mfma_f32_16x16x32_bf16 v[252:255], a[60:63], v[76:79], v[252:255]
v_mfma_f32_16x16x32_bf16 v[220:223], a[60:63], v[72:75], v[220:223]
v_exp_f32 v41, v41
v_mfma_f32_16x16x32_bf16 v[188:191], a[60:63], v[68:71], v[188:191]
ds_read_b128 a[32:35], v2 offset:16384
v_cvt_pk_bf16_f32 v58, v40, v41
v_mfma_f32_16x16x32_bf16 v[156:159], a[60:63], v[64:67], v[156:159]
v_exp_f32 v42, v42
v_smfmac_f32_16x16x64_bf16 a[224:227], a[232:235], v[64:71], v9
s_waitcnt lgkmcnt(5)
v_smfmac_f32_16x16x64_bf16 a[228:231], a[232:235], v[72:79], v9
ds_read_b128 a[36:39], v2 offset:17408
v_mfma_f32_16x16x32_bf16 v[16:19], a[0:3], a[160:163], v[80:83]
v_exp_f32 v43, v43
v_mfma_f32_16x16x32_bf16 v[16:19], a[4:7], a[164:167], v[16:19]
v_exp_f32 v44, v44
v_mfma_f32_16x16x32_bf16 v[16:19], a[8:11], a[168:171], v[16:19]
buffer_load_dwordx4 v3, s[48:51], s7 offen offset:2048 sc1 lds
v_mfma_f32_16x16x32_bf16 v[16:19], a[12:15], a[172:175], v[16:19]
ds_read_b128 a[40:43], v2 offset:18432
v_cvt_pk_bf16_f32 v59, v42, v43
v_mfma_f32_16x16x32_bf16 v[20:23], a[0:3], a[176:179], v[84:87]
v_exp_f32 v45, v45
v_mfma_f32_16x16x32_bf16 v[20:23], a[4:7], a[180:183], v[20:23]
v_cvt_pk_bf16_f32 v62, v44, v45
v_mfma_f32_16x16x32_bf16 v[20:23], a[8:11], a[184:187], v[20:23]
v_exp_f32 v46, v46
v_mfma_f32_16x16x32_bf16 v[20:23], a[12:15], a[188:191], v[20:23]
ds_read_b128 a[44:47], v2 offset:19456
v_mfma_f32_16x16x32_bf16 v[24:27], a[0:3], a[192:195], v[88:91]
v_exp_f32 v47, v47
v_mfma_f32_16x16x32_bf16 v[24:27], a[4:7], a[196:199], v[24:27]
v_cvt_pk_bf16_f32 v63, v46, v47
v_mfma_f32_16x16x32_bf16 v[24:27], a[8:11], a[200:203], v[24:27]
v_exp_f32 v16, v16
v_mfma_f32_16x16x32_bf16 v[24:27], a[12:15], a[204:207], v[24:27]
ds_read_b128 a[48:51], v2 offset:20480
v_mfma_f32_16x16x32_bf16 v[28:31], a[0:3], a[208:211], v[92:95]
v_exp_f32 v17, v17
v_mfma_f32_16x16x32_bf16 v[28:31], a[4:7], a[212:215], v[28:31]
v_exp_f32 v18, v18
v_mfma_f32_16x16x32_bf16 v[28:31], a[8:11], a[216:219], v[28:31]
ds_read_b128 a[52:55], v2 offset:21504
v_cvt_pk_bf16_f32 v64, v16, v17
v_mfma_f32_16x16x32_bf16 v[28:31], a[12:15], a[220:223], v[28:31]
s_waitcnt lgkmcnt(6)
v_mfma_f32_16x16x32_bf16 v[32:35], a[16:19], a[160:163], v[80:83]
v_exp_f32 v19, v19
v_mfma_f32_16x16x32_bf16 v[32:35], a[20:23], a[164:167], v[32:35]
buffer_load_dwordx4 v3, s[48:51], s7 offen offset:3072 sc1 lds
v_mfma_f32_16x16x32_bf16 v[32:35], a[24:27], a[168:171], v[32:35]
ds_read_b128 a[56:59], v2 offset:22528
v_cvt_pk_bf16_f32 v65, v18, v19
v_mfma_f32_16x16x32_bf16 v[32:35], a[28:31], a[172:175], v[32:35]
s_add_u32 s7, s7, 0x8000
v_exp_f32 v20, v20
v_mfma_f32_16x16x32_bf16 v[36:39], a[16:19], a[176:179], v[84:87]
s_xor_b32 s19, s19, 0x8000
v_mfma_f32_16x16x32_bf16 v[36:39], a[20:23], a[180:183], v[36:39]
s_sub_u32 s15, s15, 1
v_exp_f32 v21, v21
v_mfma_f32_16x16x32_bf16 v[36:39], a[24:27], a[184:187], v[36:39]
ds_read_b128 a[60:63], v2 offset:23552
v_xor_b32 v2, 0x38000, v2
v_mfma_f32_16x16x32_bf16 v[36:39], a[28:31], a[188:191], v[36:39]
s_cmp_lg_u32 s15, 0
v_exp_f32 v22, v22
v_mfma_f32_16x16x32_bf16 v[40:43], a[16:19], a[192:195], v[88:91]
v_exp_f32 v23, v23
v_mfma_f32_16x16x32_bf16 v[40:43], a[20:23], a[196:199], v[40:43]
v_cvt_pk_bf16_f32 v68, v20, v21
v_cvt_pk_bf16_f32 v69, v22, v23
v_mfma_f32_16x16x32_bf16 v[40:43], a[24:27], a[200:203], v[40:43]
v_exp_f32 v24, v24
v_mfma_f32_16x16x32_bf16 v[40:43], a[28:31], a[204:207], v[40:43]
v_exp_f32 v25, v25
v_mfma_f32_16x16x32_bf16 v[44:47], a[16:19], a[208:211], v[92:95]
s_waitcnt vmcnt(16) lgkmcnt(0)
v_exp_f32 v26, v26
v_mfma_f32_16x16x32_bf16 v[44:47], a[20:23], a[212:215], v[44:47]
s_barrier
v_exp_f32 v27, v27
v_mfma_f32_16x16x32_bf16 v[44:47], a[24:27], a[216:219], v[44:47]
v_mfma_f32_16x16x32_bf16 v[44:47], a[28:31], a[220:223], v[44:47]
s_cbranch_scc1 L_att_deven1
L_att_ddone:
s_cmp_ge_u32 s4, 2
s_cbranch_scc1 L_att_dl0_1
L_att_dl0_0:
v_mfma_f32_16x16x32_bf16 v[128:131], a[32:35], v[48:51], v[128:131]
ds_read_b128 a[0:3], v1 offset:8192
v_cvt_pk_bf16_f32 v72, v24, v25
v_mfma_f32_16x16x32_bf16 v[160:163], a[32:35], v[52:55], v[160:163]
v_exp_f32 v28, v28
v_mfma_f32_16x16x32_bf16 v[192:195], a[32:35], v[56:59], v[192:195]
v_cvt_pk_bf16_f32 v73, v26, v27
v_mfma_f32_16x16x32_bf16 v[224:227], a[32:35], v[60:63], v[224:227]
ds_read_b128 a[4:7], v1 offset:9216
v_mfma_f32_16x16x32_bf16 v[228:231], a[36:39], v[60:63], v[228:231]
s_add_u32 m0, s27, 0x0
v_exp_f32 v29, v29
v_mfma_f32_16x16x32_bf16 v[196:199], a[36:39], v[56:59], v[196:199]
buffer_load_dwordx4 v3, s[48:51], s32 offen offset:0 sc1 lds
v_mfma_f32_16x16x32_bf16 v[164:167], a[36:39], v[52:55], v[164:167]
v_exp_f32 v30, v30
v_mfma_f32_16x16x32_bf16 v[132:135], a[36:39], v[48:51], v[132:135]
ds_read_b128 a[8:11], v1 offset:10240
v_cvt_pk_bf16_f32 v76, v28, v29
v_mfma_f32_16x16x32_bf16 v[136:139], a[40:43], v[48:51], v[136:139]
v_mfma_f32_16x16x32_bf16 v[168:171], a[40:43], v[52:55], v[168:171]
v_exp_f32 v31, v31
v_mfma_f32_16x16x32_bf16 v[200:203], a[40:43], v[56:59], v[200:203]
v_exp_f32 v32, v32
v_mfma_f32_16x16x32_bf16 v[232:235], a[40:43], v[60:63], v[232:235]
ds_read_b128 a[12:15], v1 offset:11264
v_cvt_pk_bf16_f32 v77, v30, v31
v_mfma_f32_16x16x32_bf16 v[236:239], a[44:47], v[60:63], v[236:239]
v_exp_f32 v33, v33
v_mfma_f32_16x16x32_bf16 v[204:207], a[44:47], v[56:59], v[204:207]
v_cvt_pk_bf16_f32 v66, v32, v33
v_mfma_f32_16x16x32_bf16 v[172:175], a[44:47], v[52:55], v[172:175]
v_exp_f32 v34, v34
v_mfma_f32_16x16x32_bf16 v[140:143], a[44:47], v[48:51], v[140:143]
ds_read_b128 a[16:19], v1 offset:12288
v_mfma_f32_16x16x32_bf16 v[144:147], a[48:51], v[48:51], v[144:147]
buffer_load_dwordx4 v3, s[48:51], s32 offen offset:1024 sc1 lds
v_mfma_f32_16x16x32_bf16 v[176:179], a[48:51], v[52:55], v[176:179]
v_exp_f32 v35, v35
v_mfma_f32_16x16x32_bf16 v[208:211], a[48:51], v[56:59], v[208:211]
v_exp_f32 v36, v36
v_mfma_f32_16x16x32_bf16 v[240:243], a[48:51], v[60:63], v[240:243]
ds_read_b128 a[20:23], v1 offset:13312
v_cvt_pk_bf16_f32 v67, v34, v35
v_mfma_f32_16x16x32_bf16 v[244:247], a[52:55], v[60:63], v[244:247]
v_mfma_f32_16x16x32_bf16 v[212:215], a[52:55], v[56:59], v[212:215]
v_exp_f32 v37, v37
v_mfma_f32_16x16x32_bf16 v[180:183], a[52:55], v[52:55], v[180:183]
ds_read_b128 a[24:27], v1 offset:14336
v_cvt_pk_bf16_f32 v70, v36, v37
v_mfma_f32_16x16x32_bf16 v[148:151], a[52:55], v[48:51], v[148:151]
v_exp_f32 v38, v38
v_mfma_f32_16x16x32_bf16 v[152:155], a[56:59], v[48:51], v[152:155]
v_mfma_f32_16x16x32_bf16 v[184:187], a[56:59], v[52:55], v[184:187]
v_exp_f32 v39, v39
v_mfma_f32_16x16x32_bf16 v[216:219], a[56:59], v[56:59], v[216:219]
buffer_load_dwordx4 v3, s[48:51], s32 offen offset:2048 sc1 lds
v_mfma_f32_16x16x32_bf16 v[248:251], a[56:59], v[60:63], v[248:251]
ds_read_b128 a[28:31], v1 offset:15360
v_cvt_pk_bf16_f32 v71, v38, v39
v_mfma_f32_16x16x32_bf16 v[252:255], a[60:63], v[60:63], v[252:255]
v_exp_f32 v40, v40
v_mfma_f32_16x16x32_bf16 v[220:223], a[60:63], v[56:59], v[220:223]
v_exp_f32 v41, v41
v_mfma_f32_16x16x32_bf16 v[188:191], a[60:63], v[52:55], v[188:191]
ds_read_b128 a[32:35], v1 offset:0
v_cvt_pk_bf16_f32 v74, v40, v41
v_mfma_f32_16x16x32_bf16 v[156:159], a[60:63], v[48:51], v[156:159]
v_smfmac_f32_16x16x64_bf16 a[224:227], a[232:235], v[48:55], v9
v_exp_f32 v42, v42
v_smfmac_f32_16x16x64_bf16 a[228:231], a[232:235], v[56:63], v9
s_waitcnt lgkmcnt(5)
v_exp_f32 v43, v43
v_mfma_f32_16x16x32_bf16 v[16:19], a[0:3], a[160:163], v[96:99]
ds_read_b128 a[36:39], v1 offset:1024
v_cvt_pk_bf16_f32 v75, v42, v43
v_mfma_f32_16x16x32_bf16 v[16:19], a[4:7], a[164:167], v[16:19]
v_exp_f32 v44, v44
v_mfma_f32_16x16x32_bf16 v[16:19], a[8:11], a[168:171], v[16:19]
v_mfma_f32_16x16x32_bf16 v[16:19], a[12:15], a[172:175], v[16:19]
buffer_load_dwordx4 v3, s[48:51], s32 offen offset:3072 sc1 lds
v_mfma_f32_16x16x32_bf16 v[20:23], a[0:3], a[176:179], v[84:87]
ds_read_b128 a[40:43], v1 offset:2048
v_mfma_f32_16x16x32_bf16 v[20:23], a[4:7], a[180:183], v[20:23]
v_exp_f32 v45, v45
v_mfma_f32_16x16x32_bf16 v[20:23], a[8:11], a[184:187], v[20:23]
v_exp_f32 v46, v46
v_mfma_f32_16x16x32_bf16 v[20:23], a[12:15], a[188:191], v[20:23]
ds_read_b128 a[44:47], v1 offset:3072
v_cvt_pk_bf16_f32 v78, v44, v45
v_mfma_f32_16x16x32_bf16 v[24:27], a[0:3], a[192:195], v[88:91]
v_mfma_f32_16x16x32_bf16 v[24:27], a[4:7], a[196:199], v[24:27]
v_exp_f32 v47, v47
v_mfma_f32_16x16x32_bf16 v[24:27], a[8:11], a[200:203], v[24:27]
v_exp_f32 v16, v16
v_mfma_f32_16x16x32_bf16 v[24:27], a[12:15], a[204:207], v[24:27]
ds_read_b128 a[48:51], v1 offset:4096
v_cvt_pk_bf16_f32 v79, v46, v47
v_mfma_f32_16x16x32_bf16 v[28:31], a[0:3], a[208:211], v[92:95]
v_exp_f32 v17, v17
v_mfma_f32_16x16x32_bf16 v[28:31], a[4:7], a[212:215], v[28:31]
s_add_u32 m0, s27, 0x1000
v_cvt_pk_bf16_f32 v48, v16, v17
v_mfma_f32_16x16x32_bf16 v[28:31], a[8:11], a[216:219], v[28:31]
buffer_load_dwordx4 v3, s[48:51], s7 offen offset:0 sc1 lds
v_mfma_f32_16x16x32_bf16 v[28:31], a[12:15], a[220:223], v[28:31]
ds_read_b128 a[52:55], v1 offset:5120
s_waitcnt lgkmcnt(6)
v_mfma_f32_16x16x32_bf16 v[32:35], a[16:19], a[160:163], v[100:103]
v_exp_f32 v18, v18
v_mfma_f32_16x16x32_bf16 v[32:35], a[20:23], a[164:167], v[32:35]
v_exp_f32 v19, v19
v_mfma_f32_16x16x32_bf16 v[32:35], a[24:27], a[168:171], v[32:35]
v_exp_f32 v20, v20
v_mfma_f32_16x16x32_bf16 v[32:35], a[28:31], a[172:175], v[32:35]
ds_read_b128 a[56:59], v1 offset:6144
v_cvt_pk_bf16_f32 v49, v18, v19
v_mfma_f32_16x16x32_bf16 v[36:39], a[16:19], a[176:179], v[84:87]
v_mfma_f32_16x16x32_bf16 v[36:39], a[20:23], a[180:183], v[36:39]
v_exp_f32 v21, v21
v_mfma_f32_16x16x32_bf16 v[36:39], a[24:27], a[184:187], v[36:39]
v_exp_f32 v22, v22
v_mfma_f32_16x16x32_bf16 v[36:39], a[28:31], a[188:191], v[36:39]
ds_read_b128 a[60:63], v1 offset:7168
v_cvt_pk_bf16_f32 v52, v20, v21
v_mfma_f32_16x16x32_bf16 v[40:43], a[16:19], a[192:195], v[88:91]
buffer_load_dwordx4 v3, s[48:51], s7 offen offset:1024 sc1 lds
v_mfma_f32_16x16x32_bf16 v[40:43], a[20:23], a[196:199], v[40:43]
v_mfma_f32_16x16x32_bf16 v[40:43], a[24:27], a[200:203], v[40:43]
v_exp_f32 v23, v23
v_mfma_f32_16x16x32_bf16 v[40:43], a[28:31], a[204:207], v[40:43]
v_exp_f32 v24, v24
v_mfma_f32_16x16x32_bf16 v[44:47], a[16:19], a[208:211], v[92:95]
v_exp_f32 v25, v25
v_mfma_f32_16x16x32_bf16 v[44:47], a[20:23], a[212:215], v[44:47]
v_exp_f32 v26, v26
v_mfma_f32_16x16x32_bf16 v[44:47], a[24:27], a[216:219], v[44:47]
v_exp_f32 v27, v27
v_mfma_f32_16x16x32_bf16 v[44:47], a[28:31], a[220:223], v[44:47]
s_waitcnt lgkmcnt(0)
v_cvt_pk_bf16_f32 v53, v22, v23
v_mfma_f32_16x16x32_bf16 v[128:131], a[32:35], v[64:67], v[128:131]
ds_read_b128 a[0:3], v1 offset:24576
v_cvt_pk_bf16_f32 v56, v24, v25
v_mfma_f32_16x16x32_bf16 v[160:163], a[32:35], v[68:71], v[160:163]
v_exp_f32 v28, v28
v_mfma_f32_16x16x32_bf16 v[192:195], a[32:35], v[72:75], v[192:195]
v_cvt_pk_bf16_f32 v57, v26, v27
v_mfma_f32_16x16x32_bf16 v[224:227], a[32:35], v[76:79], v[224:227]
ds_read_b128 a[4:7], v1 offset:25600
v_mfma_f32_16x16x32_bf16 v[228:231], a[36:39], v[76:79], v[228:231]
v_exp_f32 v29, v29
v_mfma_f32_16x16x32_bf16 v[196:199], a[36:39], v[72:75], v[196:199]
buffer_load_dwordx4 v3, s[48:51], s7 offen offset:2048 sc1 lds
v_mfma_f32_16x16x32_bf16 v[164:167], a[36:39], v[68:71], v[164:167]
ds_read_b128 a[8:11], v1 offset:26624
v_cvt_pk_bf16_f32 v60, v28, v29
v_mfma_f32_16x16x32_bf16 v[132:135], a[36:39], v[64:67], v[132:135]
v_exp_f32 v30, v30
v_mfma_f32_16x16x32_bf16 v[136:139], a[40:43], v[64:67], v[136:139]
v_exp_f32 v31, v31
v_mfma_f32_16x16x32_bf16 v[168:171], a[40:43], v[68:71], v[168:171]
ds_read_b128 a[12:15], v1 offset:27648
v_cvt_pk_bf16_f32 v61, v30, v31
v_mfma_f32_16x16x32_bf16 v[200:203], a[40:43], v[72:75], v[200:203]
v_mfma_f32_16x16x32_bf16 v[232:235], a[40:43], v[76:79], v[232:235]
v_exp_f32 v32, v32
v_mfma_f32_16x16x32_bf16 v[236:239], a[44:47], v[76:79], v[236:239]
v_exp_f32 v33, v33
v_mfma_f32_16x16x32_bf16 v[204:207], a[44:47], v[72:75], v[204:207]
ds_read_b128 a[16:19], v1 offset:28672
v_cvt_pk_bf16_f32 v50, v32, v33
v_mfma_f32_16x16x32_bf16 v[172:175], a[44:47], v[68:71], v[172:175]
v_exp_f32 v34, v34
v_mfma_f32_16x16x32_bf16 v[140:143], a[44:47], v[64:67], v[140:143]
buffer_load_dwordx4 v3, s[48:51], s7 offen offset:3072 sc1 lds
v_mfma_f32_16x16x32_bf16 v[144:147], a[48:51], v[64:67], v[144:147]
ds_read_b128 a[20:23], v1 offset:29696
v_mfma_f32_16x16x32_bf16 v[176:179], a[48:51], v[68:71], v[176:179]
v_mfma_f32_16x16x32_bf16 v[208:211], a[48:51], v[72:75], v[208:211]
v_exp_f32 v35, v35
v_mfma_f32_16x16x32_bf16 v[240:243], a[48:51], v[76:79], v[240:243]
ds_read_b128 a[24:27], v1 offset:30720
v_cvt_pk_bf16_f32 v51, v34, v35
v_mfma_f32_16x16x32_bf16 v[244:247], a[52:55], v[76:79], v[244:247]
v_exp_f32 v36, v36
v_mfma_f32_16x16x32_bf16 v[212:215], a[52:55], v[72:75], v[212:215]
v_exp_f32 v37, v37
v_mfma_f32_16x16x32_bf16 v[180:183], a[52:55], v[68:71], v[180:183]
ds_read_b128 a[28:31], v1 offset:31744
v_cvt_pk_bf16_f32 v54, v36, v37
v_mfma_f32_16x16x32_bf16 v[148:151], a[52:55], v[64:67], v[148:151]
v_mfma_f32_16x16x32_bf16 v[152:155], a[56:59], v[64:67], v[152:155]
v_exp_f32 v38, v38
v_mfma_f32_16x16x32_bf16 v[184:187], a[56:59], v[68:71], v[184:187]
s_mov_b32 s9, 0x0
v_exp_f32 v39, v39
v_mfma_f32_16x16x32_bf16 v[216:219], a[56:59], v[72:75], v[216:219]
buffer_load_dword a244, v8, s[72:75], s9 offen
v_mfma_f32_16x16x32_bf16 v[248:251], a[56:59], v[76:79], v[248:251]
ds_read_b128 a[32:35], v1 offset:16384
v_cvt_pk_bf16_f32 v55, v38, v39
v_mfma_f32_16x16x32_bf16 v[252:255], a[60:63], v[76:79], v[252:255]
v_exp_f32 v40, v40
v_mfma_f32_16x16x32_bf16 v[220:223], a[60:63], v[72:75], v[220:223]
ds_read_b128 a[36:39], v1 offset:17408
v_mfma_f32_16x16x32_bf16 v[188:191], a[60:63], v[68:71], v[188:191]
v_mfma_f32_16x16x32_bf16 v[156:159], a[60:63], v[64:67], v[156:159]
v_exp_f32 v41, v41
v_smfmac_f32_16x16x64_bf16 a[224:227], a[232:235], v[64:71], v9
ds_read_b128 a[40:43], v1 offset:18432
v_cvt_pk_bf16_f32 v58, v40, v41
v_smfmac_f32_16x16x64_bf16 a[228:231], a[232:235], v[72:79], v9
s_waitcnt lgkmcnt(7)
v_exp_f32 v42, v42
v_mfma_f32_16x16x32_bf16 v[20:23], a[0:3], a[176:179], v[84:87]
s_mov_b32 s9, 0x0
v_exp_f32 v43, v43
v_mfma_f32_16x16x32_bf16 v[20:23], a[4:7], a[180:183], v[20:23]
ds_read_b128 a[44:47], v1 offset:19456
v_cvt_pk_bf16_f32 v59, v42, v43
v_mfma_f32_16x16x32_bf16 v[20:23], a[8:11], a[184:187], v[20:23]
buffer_load_dword a244, v8, s[64:67], s9 offen
v_mfma_f32_16x16x32_bf16 v[20:23], a[12:15], a[188:191], v[20:23]
v_mfma_f32_16x16x32_bf16 v[24:27], a[0:3], a[192:195], v[88:91]
v_exp_f32 v44, v44
v_mfma_f32_16x16x32_bf16 v[24:27], a[4:7], a[196:199], v[24:27]
ds_read_b128 a[48:51], v1 offset:20480
v_mfma_f32_16x16x32_bf16 v[24:27], a[8:11], a[200:203], v[24:27]
v_exp_f32 v45, v45
v_mfma_f32_16x16x32_bf16 v[24:27], a[12:15], a[204:207], v[24:27]
v_exp_f32 v46, v46
v_mfma_f32_16x16x32_bf16 v[28:31], a[0:3], a[208:211], v[92:95]
ds_read_b128 a[52:55], v1 offset:21504
v_cvt_pk_bf16_f32 v62, v44, v45
v_mfma_f32_16x16x32_bf16 v[28:31], a[4:7], a[212:215], v[28:31]
s_waitcnt lgkmcnt(6)
v_mfma_f32_16x16x32_bf16 v[28:31], a[8:11], a[216:219], v[28:31]
s_mov_b32 s9, 0x400000
v_exp_f32 v47, v47
v_mfma_f32_16x16x32_bf16 v[28:31], a[12:15], a[220:223], v[28:31]
ds_read_b128 a[56:59], v1 offset:22528
v_cvt_pk_bf16_f32 v63, v46, v47
v_mfma_f32_16x16x32_bf16 v[36:39], a[16:19], a[176:179], v[84:87]
buffer_load_dword a244, v8, s[64:67], s9 offen
v_mfma_f32_16x16x32_bf16 v[36:39], a[20:23], a[180:183], v[36:39]
s_add_u32 s32, s32, 0x8000
v_exp_f32 v20, v20
v_mfma_f32_16x16x32_bf16 v[36:39], a[24:27], a[184:187], v[36:39]
ds_read_b128 a[60:63], v1 offset:23552
v_xor_b32 v1, 0x8000, v1
v_mfma_f32_16x16x32_bf16 v[36:39], a[28:31], a[188:191], v[36:39]
s_add_u32 s7, s7, 0x8000
v_exp_f32 v21, v21
v_mfma_f32_16x16x32_bf16 v[40:43], a[16:19], a[192:195], v[88:91]
s_xor_b32 s27, s27, 0x38000
v_cvt_pk_bf16_f32 v68, v20, v21
v_mfma_f32_16x16x32_bf16 v[40:43], a[20:23], a[196:199], v[40:43]
v_exp_f32 v22, v22
v_mfma_f32_16x16x32_bf16 v[40:43], a[24:27], a[200:203], v[40:43]
v_exp_f32 v23, v23
v_mfma_f32_16x16x32_bf16 v[40:43], a[28:31], a[204:207], v[40:43]
v_exp_f32 v24, v24
v_mfma_f32_16x16x32_bf16 v[44:47], a[16:19], a[208:211], v[92:95]
v_exp_f32 v25, v25
v_mfma_f32_16x16x32_bf16 v[44:47], a[20:23], a[212:215], v[44:47]
v_exp_f32 v26, v26
v_mfma_f32_16x16x32_bf16 v[44:47], a[24:27], a[216:219], v[44:47]
s_waitcnt vmcnt(19) lgkmcnt(0)
v_exp_f32 v27, v27
v_mfma_f32_16x16x32_bf16 v[44:47], a[28:31], a[220:223], v[44:47]
s_barrier
v_cvt_pk_bf16_f32 v69, v22, v23
L_att_l1_0:
v_mfma_f32_16x16x32_bf16 v[128:131], a[32:35], v[48:51], v[128:131]
ds_read_b128 a[0:3], v2 offset:8192
v_cvt_pk_bf16_f32 v72, v24, v25
v_mfma_f32_16x16x32_bf16 v[160:163], a[32:35], v[52:55], v[160:163]
s_lshr_b32 s44, s2, 6
v_exp_f32 v28, v28
v_mfma_f32_16x16x32_bf16 v[192:195], a[32:35], v[56:59], v[192:195]
s_add_u32 m0, s19, 0x0
s_lshl_b32 s45, s44, 1
v_cvt_pk_bf16_f32 v73, v26, v27
v_mfma_f32_16x16x32_bf16 v[224:227], a[32:35], v[60:63], v[224:227]
ds_read_b128 a[4:7], v2 offset:9216
s_add_u32 s45, s45, s100
v_mfma_f32_16x16x32_bf16 v[228:231], a[36:39], v[60:63], v[228:231]
buffer_load_dwordx4 v3, s[48:51], s32 offen offset:0 sc1 lds
v_mfma_f32_16x16x32_bf16 v[196:199], a[36:39], v[56:59], v[196:199]
s_and_b32 s60, s45, 3
v_exp_f32 v29, v29
v_mfma_f32_16x16x32_bf16 v[164:167], a[36:39], v[52:55], v[164:167]
ds_read_b128 a[8:11], v2 offset:10240
v_cvt_pk_bf16_f32 v76, v28, v29
v_mfma_f32_16x16x32_bf16 v[132:135], a[36:39], v[48:51], v[132:135]
s_sub_u32 s60, s60, s44
v_exp_f32 v30, v30
v_mfma_f32_16x16x32_bf16 v[136:139], a[40:43], v[48:51], v[136:139]
s_add_u32 s60, s60, 4
s_lshl_b32 s60, s60, 14
s_and_b32 s60, s60, 0x7c000
v_mfma_f32_16x16x32_bf16 v[168:171], a[40:43], v[52:55], v[168:171]
ds_read_b128 a[12:15], v2 offset:11264
s_lshl_b32 s61, s60, 3
v_mfma_f32_16x16x32_bf16 v[200:203], a[40:43], v[56:59], v[200:203]
s_add_u32 s62, s61, s12
v_exp_f32 v31, v31
v_mfma_f32_16x16x32_bf16 v[232:235], a[40:43], v[60:63], v[232:235]
s_mul_i32 s44, s44, -8
v_exp_f32 v36, v36
v_mfma_f32_16x16x32_bf16 v[236:239], a[44:47], v[60:63], v[236:239]
s_mov_b32 s9, 0x200000
s_lshl_b32 s44, 4, s44
v_cvt_pk_bf16_f32 v77, v30, v31
v_mfma_f32_16x16x32_bf16 v[204:207], a[44:47], v[56:59], v[204:207]
ds_read_b128 a[16:19], v2 offset:12288
s_mul_i32 s45, s45, -8
v_mfma_f32_16x16x32_bf16 v[172:175], a[44:47], v[52:55], v[172:175]
buffer_load_dword a244, v8, s[64:67], s9 offen
v_mfma_f32_16x16x32_bf16 v[140:143], a[44:47], v[48:51], v[140:143]
s_lshl_b32 s45, 4, s45
v_exp_f32 v37, v37
v_mfma_f32_16x16x32_bf16 v[144:147], a[48:51], v[48:51], v[144:147]
ds_read_b128 a[20:23], v2 offset:13312
v_cvt_pk_bf16_f32 v70, v36, v37
v_mfma_f32_16x16x32_bf16 v[176:179], a[48:51], v[52:55], v[176:179]
s_add_u32 s44, s44, 0x21212121
v_exp_f32 v38, v38
v_mfma_f32_16x16x32_bf16 v[208:211], a[48:51], v[56:59], v[208:211]
s_sub_u32 s44, s44, s45
s_bfe_u32 s56, s44, 0x80000
s_lshl_b32 s56, s56, 14
v_mfma_f32_16x16x32_bf16 v[240:243], a[48:51], v[60:63], v[240:243]
ds_read_b128 a[24:27], v2 offset:14336
s_bfe_u32 s57, s44, 0x80008
v_mfma_f32_16x16x32_bf16 v[244:247], a[52:55], v[60:63], v[244:247]
s_lshl_b32 s57, s57, 14
v_exp_f32 v39, v39
v_mfma_f32_16x16x32_bf16 v[212:215], a[52:55], v[56:59], v[212:215]
s_bfe_u32 s58, s44, 0x80010
v_exp_f32 v40, v40
v_mfma_f32_16x16x32_bf16 v[180:183], a[52:55], v[52:55], v[180:183]
s_lshl_b32 s58, s58, 14
s_bfe_u32 s59, s44, 0x80018
v_cvt_pk_bf16_f32 v71, v38, v39
v_mfma_f32_16x16x32_bf16 v[148:151], a[52:55], v[48:51], v[148:151]
buffer_load_dwordx4 v3, s[48:51], s32 offen offset:1024 sc1 lds
v_mfma_f32_16x16x32_bf16 v[152:155], a[56:59], v[48:51], v[152:155]
ds_read_b128 a[28:31], v2 offset:15360
s_lshl_b32 s59, s59, 14
v_mfma_f32_16x16x32_bf16 v[184:187], a[56:59], v[52:55], v[184:187]
v_exp_f32 v41, v41
v_mfma_f32_16x16x32_bf16 v[216:219], a[56:59], v[56:59], v[216:219]
ds_read_b128 a[32:35], v2 offset:0
v_cvt_pk_bf16_f32 v74, v40, v41
v_mfma_f32_16x16x32_bf16 v[248:251], a[56:59], v[60:63], v[248:251]
v_exp_f32 v42, v42
v_mfma_f32_16x16x32_bf16 v[252:255], a[60:63], v[60:63], v[252:255]
v_mov_b32 v6, 0xf149f2ca
v_min_f32 v119, s10, v88
v_mfma_f32_16x16x32_bf16 v[220:223], a[60:63], v[56:59], v[220:223]
ds_read_b128 a[36:39], v2 offset:1024
v_cndmask_b32 v112, v119, v88, s[36:37]
v_mfma_f32_16x16x32_bf16 v[188:191], a[60:63], v[52:55], v[188:191]
v_exp_f32 v43, v43
v_mfma_f32_16x16x32_bf16 v[156:159], a[60:63], v[48:51], v[156:159]
s_waitcnt lgkmcnt(6)
v_exp_f32 v44, v44
v_smfmac_f32_16x16x64_bf16 a[224:227], a[232:235], v[48:55], v9
buffer_load_dwordx4 v3, s[48:51], s32 offen offset:2048 sc1 lds
v_smfmac_f32_16x16x64_bf16 a[228:231], a[232:235], v[56:63], v9
ds_read_b128 a[40:43], v2 offset:2048
v_cvt_pk_bf16_f32 v75, v42, v43
v_mfma_f32_16x16x32_bf16 v[20:23], a[0:3], a[176:179], v[84:87]
v_cndmask_b32 v113, v119, v88, s[38:39]
v_cndmask_b32 v114, v119, v88, s[40:41]
v_mfma_f32_16x16x32_bf16 v[20:23], a[4:7], a[180:183], v[20:23]
v_exp_f32 v45, v45
v_mfma_f32_16x16x32_bf16 v[20:23], a[8:11], a[184:187], v[20:23]
ds_read_b128 a[44:47], v2 offset:3072
v_cvt_pk_bf16_f32 v78, v44, v45
v_mfma_f32_16x16x32_bf16 v[20:23], a[12:15], a[188:191], v[20:23]
v_exp_f32 v46, v46
v_mfma_f32_16x16x32_bf16 v[24:27], a[0:3], a[192:195], v[88:91]
v_cndmask_b32 v115, v119, v88, s[42:43]
v_cndmask_b32 v116, v6, v119, s[36:37]
v_mfma_f32_16x16x32_bf16 v[24:27], a[4:7], a[196:199], v[24:27]
ds_read_b128 a[48:51], v2 offset:4096
v_cndmask_b32 v117, v6, v119, s[38:39]
v_mfma_f32_16x16x32_bf16 v[24:27], a[8:11], a[200:203], v[24:27]
v_exp_f32 v47, v47
v_mfma_f32_16x16x32_bf16 v[24:27], a[12:15], a[204:207], v[24:27]
v_exp_f32 v20, v20
v_mfma_f32_16x16x32_bf16 v[28:31], a[0:3], a[208:211], v[92:95]
buffer_load_dwordx4 v3, s[48:51], s32 offen offset:3072 sc1 lds
v_mfma_f32_16x16x32_bf16 v[28:31], a[4:7], a[212:215], v[28:31]
ds_read_b128 a[52:55], v2 offset:5120
v_cvt_pk_bf16_f32 v79, v46, v47
v_mfma_f32_16x16x32_bf16 v[28:31], a[8:11], a[216:219], v[28:31]
v_cndmask_b32 v118, v6, v119, s[40:41]
v_cndmask_b32 v119, v6, v119, s[42:43]
v_mfma_f32_16x16x32_bf16 v[28:31], a[12:15], a[220:223], v[28:31]
s_waitcnt lgkmcnt(6)
v_exp_f32 v21, v21
v_mfma_f32_16x16x32_bf16 v[36:39], a[16:19], a[176:179], v[84:87]
ds_read_b128 a[56:59], v2 offset:6144
v_cvt_pk_bf16_f32 v52, v20, v21
v_mfma_f32_16x16x32_bf16 v[36:39], a[20:23], a[180:183], v[36:39]
v_exp_f32 v22, v22
v_mfma_f32_16x16x32_bf16 v[36:39], a[24:27], a[184:187], v[36:39]
v_min_f32 v127, s11, v92
v_cndmask_b32 v120, v127, v92, s[36:37]
v_mfma_f32_16x16x32_bf16 v[36:39], a[28:31], a[188:191], v[36:39]
ds_read_b128 a[60:63], v2 offset:7168
v_cndmask_b32 v121, v127, v92, s[38:39]
v_mfma_f32_16x16x32_bf16 v[40:43], a[16:19], a[192:195], v[88:91]
s_mov_b32 s9, 0x600000
v_exp_f32 v23, v23
v_mfma_f32_16x16x32_bf16 v[40:43], a[20:23], a[196:199], v[40:43]
buffer_load_dword a244, v8, s[64:67], s9 offen
v_mfma_f32_16x16x32_bf16 v[40:43], a[24:27], a[200:203], v[40:43]
v_exp_f32 v24, v24
v_mfma_f32_16x16x32_bf16 v[40:43], a[28:31], a[204:207], v[40:43]
v_cvt_pk_bf16_f32 v53, v22, v23
v_cndmask_b32 v122, v127, v92, s[40:41]
v_mfma_f32_16x16x32_bf16 v[44:47], a[16:19], a[208:211], v[92:95]
v_exp_f32 v25, v25
v_mfma_f32_16x16x32_bf16 v[44:47], a[20:23], a[212:215], v[44:47]
v_exp_f32 v26, v26
v_mfma_f32_16x16x32_bf16 v[44:47], a[24:27], a[216:219], v[44:47]
v_exp_f32 v27, v27
v_mfma_f32_16x16x32_bf16 v[44:47], a[28:31], a[220:223], v[44:47]
s_waitcnt lgkmcnt(0)
v_cndmask_b32 v123, v127, v92, s[42:43]
v_cndmask_b32 v124, v6, v127, s[36:37]
v_cndmask_b32 v125, v6, v127, s[38:39]
v_cndmask_b32 v126, v6, v127, s[40:41]
v_cndmask_b32 v127, v6, v127, s[42:43]
v_mfma_f32_16x16x32_bf16 v[160:163], a[32:35], v[68:71], v[160:163]
ds_read_b128 a[0:3], v2 offset:24576
v_cvt_pk_bf16_f32 v56, v24, v25
v_mfma_f32_16x16x32_bf16 v[192:195], a[32:35], v[72:75], v[192:195]
v_exp_f32 v28, v28
v_mfma_f32_16x16x32_bf16 v[224:227], a[32:35], v[76:79], v[224:227]
ds_read_b128 a[4:7], v2 offset:25600
v_cvt_pk_bf16_f32 v57, v26, v27
v_mfma_f32_16x16x32_bf16 v[228:231], a[36:39], v[76:79], v[228:231]
s_add_u32 m0, s19, 0x1000
v_mfma_f32_16x16x32_bf16 v[196:199], a[36:39], v[72:75], v[196:199]
buffer_load_dwordx4 v3, s[48:51], s7 offen offset:0 sc1 lds
v_mfma_f32_16x16x32_bf16 v[164:167], a[36:39], v[68:71], v[164:167]
ds_read_b128 a[8:11], v2 offset:26624
v_mfma_f32_16x16x32_bf16 v[168:171], a[40:43], v[68:71], v[168:171]
v_exp_f32 v29, v29
v_mfma_f32_16x16x32_bf16 v[200:203], a[40:43], v[72:75], v[200:203]
v_exp_f32 v30, v30
v_mfma_f32_16x16x32_bf16 v[232:235], a[40:43], v[76:79], v[232:235]
ds_read_b128 a[12:15], v2 offset:27648
v_cvt_pk_bf16_f32 v60, v28, v29
v_mfma_f32_16x16x32_bf16 v[236:239], a[44:47], v[76:79], v[236:239]
v_exp_f32 v31, v31
v_mfma_f32_16x16x32_bf16 v[204:207], a[44:47], v[72:75], v[204:207]
v_exp_f32 v36, v36
v_mfma_f32_16x16x32_bf16 v[172:175], a[44:47], v[68:71], v[172:175]
ds_read_b128 a[16:19], v2 offset:28672
v_cvt_pk_bf16_f32 v61, v30, v31
v_mfma_f32_16x16x32_bf16 v[176:179], a[48:51], v[68:71], v[176:179]
buffer_load_dwordx4 v3, s[48:51], s7 offen offset:1024 sc1 lds
v_mfma_f32_16x16x32_bf16 v[208:211], a[48:51], v[72:75], v[208:211]
ds_read_b128 a[20:23], v2 offset:29696
v_mfma_f32_16x16x32_bf16 v[240:243], a[48:51], v[76:79], v[240:243]
v_mfma_f32_16x16x32_bf16 v[244:247], a[52:55], v[76:79], v[244:247]
v_exp_f32 v37, v37
v_mfma_f32_16x16x32_bf16 v[212:215], a[52:55], v[72:75], v[212:215]
ds_read_b128 a[24:27], v2 offset:30720
v_cvt_pk_bf16_f32 v54, v36, v37
v_mfma_f32_16x16x32_bf16 v[180:183], a[52:55], v[68:71], v[180:183]
v_exp_f32 v38, v38
v_mfma_f32_16x16x32_bf16 v[184:187], a[56:59], v[68:71], v[184:187]
v_exp_f32 v39, v39
v_mfma_f32_16x16x32_bf16 v[216:219], a[56:59], v[72:75], v[216:219]
ds_read_b128 a[28:31], v2 offset:31744
v_cvt_pk_bf16_f32 v55, v38, v39
v_mfma_f32_16x16x32_bf16 v[248:251], a[56:59], v[76:79], v[248:251]
v_exp_f32 v40, v40
v_mfma_f32_16x16x32_bf16 v[252:255], a[60:63], v[76:79], v[252:255]
buffer_load_dwordx4 v3, s[48:51], s7 offen offset:2048 sc1 lds
v_mfma_f32_16x16x32_bf16 v[220:223], a[60:63], v[72:75], v[220:223]
ds_read_b128 a[32:35], v2 offset:16384
v_mfma_f32_16x16x32_bf16 v[188:191], a[60:63], v[68:71], v[188:191]
v_exp_f32 v41, v41
v_mfma_f32_16x16x32_bf16 a[224:227], a[236:239], v[68:71], a[224:227]
ds_read_b128 a[36:39], v2 offset:17408
v_cvt_pk_bf16_f32 v58, v40, v41
v_smfmac_f32_16x16x64_bf16 a[228:231], a[232:235], v[72:79], v9
s_waitcnt lgkmcnt(6)
v_exp_f32 v42, v42
v_mfma_f32_16x16x32_bf16 v[20:23], a[0:3], a[176:179], v[104:107]
v_exp_f32 v43, v43
v_mfma_f32_16x16x32_bf16 v[20:23], a[4:7], a[180:183], v[20:23]
ds_read_b128 a[40:43], v2 offset:18432
v_cvt_pk_bf16_f32 v59, v42, v43
v_mfma_f32_16x16x32_bf16 v[20:23], a[8:11], a[184:187], v[20:23]
v_exp_f32 v44, v44
v_mfma_f32_16x16x32_bf16 v[20:23], a[12:15], a[188:191], v[20:23]
buffer_load_dwordx4 v3, s[48:51], s7 offen offset:3072 sc1 lds
v_mfma_f32_16x16x32_bf16 v[24:27], a[0:3], a[192:195], v[88:91]
ds_read_b128 a[44:47], v2 offset:19456
v_mfma_f32_16x16x32_bf16 v[24:27], a[4:7], a[196:199], v[24:27]
v_exp_f32 v45, v45
v_mfma_f32_16x16x32_bf16 v[24:27], a[8:11], a[200:203], v[24:27]
v_exp_f32 v46, v46
v_mfma_f32_16x16x32_bf16 v[24:27], a[12:15], a[204:207], v[24:27]
ds_read_b128 a[48:51], v2 offset:20480
v_add_u32 v4, s0, v3
v_mfma_f32_16x16x32_bf16 v[28:31], a[0:3], a[208:211], v[92:95]
v_cvt_pk_bf16_f32 v62, v44, v45
v_mfma_f32_16x16x32_bf16 v[28:31], a[4:7], a[212:215], v[28:31]
ds_read_b128 a[52:55], v2 offset:21504
v_mov_b32 v5, s1
v_mfma_f32_16x16x32_bf16 v[28:31], a[8:11], a[216:219], v[28:31]
s_waitcnt lgkmcnt(6)
v_exp_f32 v47, v47
v_mfma_f32_16x16x32_bf16 v[28:31], a[12:15], a[220:223], v[28:31]
global_load_dword a244, v[4:5], off sc1
v_mfma_f32_16x16x32_bf16 v[36:39], a[16:19], a[176:179], v[108:111]
ds_read_b128 a[56:59], v2 offset:22528
v_cvt_pk_bf16_f32 v63, v46, v47
v_mfma_f32_16x16x32_bf16 v[36:39], a[20:23], a[180:183], v[36:39]
s_add_u32 s32, s32, 0x8000
v_exp_f32 v20, v20
v_mfma_f32_16x16x32_bf16 v[36:39], a[24:27], a[184:187], v[36:39]
s_add_u32 s7, s7, 0x8000
v_exp_f32 v21, v21
v_mfma_f32_16x16x32_bf16 v[36:39], a[28:31], a[188:191], v[36:39]
ds_read_b128 a[60:63], v2 offset:23552
v_xor_b32 v2, 0x38000, v2
v_mfma_f32_16x16x32_bf16 v[40:43], a[16:19], a[192:195], v[88:91]
s_xor_b32 s19, s19, 0x8000
v_exp_f32 v22, v22
v_mfma_f32_16x16x32_bf16 v[40:43], a[20:23], a[196:199], v[40:43]
s_sub_u32 s15, 7, s6
v_exp_f32 v23, v23
v_mfma_f32_16x16x32_bf16 v[40:43], a[24:27], a[200:203], v[40:43]
s_lshl_b32 s15, s15, 1
v_exp_f32 v24, v24
v_mfma_f32_16x16x32_bf16 v[40:43], a[28:31], a[204:207], v[40:43]
v_exp_f32 v25, v25
v_mfma_f32_16x16x32_bf16 v[44:47], a[16:19], a[208:211], v[92:95]
v_exp_f32 v26, v26
v_mfma_f32_16x16x32_bf16 v[44:47], a[20:23], a[212:215], v[44:47]
v_exp_f32 v27, v27
v_mfma_f32_16x16x32_bf16 v[44:47], a[24:27], a[216:219], v[44:47]
s_waitcnt vmcnt(22) lgkmcnt(0)
v_cvt_pk_bf16_f32 v68, v20, v21
v_cvt_pk_bf16_f32 v69, v22, v23
v_mfma_f32_16x16x32_bf16 v[44:47], a[28:31], a[220:223], v[44:47]
s_barrier
s_cbranch_scc0 L_att_lh0_0
L_att_ls_0:
v_mfma_f32_16x16x32_bf16 v[160:163], a[32:35], v[52:55], v[160:163]
ds_read_b128 a[0:3], v1 offset:8192
v_cvt_pk_bf16_f32 v72, v24, v25
v_mfma_f32_16x16x32_bf16 v[192:195], a[32:35], v[56:59], v[192:195]
v_exp_f32 v28, v28
v_mfma_f32_16x16x32_bf16 v[224:227], a[32:35], v[60:63], v[224:227]
ds_read_b128 a[4:7], v1 offset:9216
v_cvt_pk_bf16_f32 v73, v26, v27
v_mfma_f32_16x16x32_bf16 v[228:231], a[36:39], v[60:63], v[228:231]
s_add_u32 m0, s27, 0x0
v_exp_f32 v29, v29
v_mfma_f32_16x16x32_bf16 v[196:199], a[36:39], v[56:59], v[196:199]
buffer_load_dwordx4 v3, s[48:51], s32 offen offset:0 sc1 lds
v_mfma_f32_16x16x32_bf16 v[164:167], a[36:39], v[52:55], v[164:167]
ds_read_b128 a[8:11], v1 offset:10240
v_cvt_pk_bf16_f32 v76, v28, v29
v_mfma_f32_16x16x32_bf16 v[168:171], a[40:43], v[52:55], v[168:171]
ds_read_b128 a[12:15], v1 offset:11264
v_accvgpr_read_b32 v6, a224
v_mfma_f32_16x16x32_bf16 v[200:203], a[40:43], v[56:59], v[200:203]
v_exp_f32 v30, v30
v_mfma_f32_16x16x32_bf16 v[232:235], a[40:43], v[60:63], v[232:235]
v_exp_f32 v31, v31
v_mfma_f32_16x16x32_bf16 v[236:239], a[44:47], v[60:63], v[236:239]
ds_read_b128 a[16:19], v1 offset:12288
v_cvt_pk_bf16_f32 v77, v30, v31
v_mfma_f32_16x16x32_bf16 v[204:207], a[44:47], v[56:59], v[204:207]
v_exp_f32 v36, v36
v_mfma_f32_16x16x32_bf16 v[172:175], a[44:47], v[52:55], v[172:175]
ds_read_b128 a[20:23], v1 offset:13312
v_accvgpr_read_b32 v7, a225
v_mfma_f32_16x16x32_bf16 v[176:179], a[48:51], v[52:55], v[176:179]
v_exp_f32 v37, v37
v_mfma_f32_16x16x32_bf16 v[208:211], a[48:51], v[56:59], v[208:211]
ds_read_b128 a[24:27], v1 offset:14336
v_cvt_pk_bf16_f32 v70, v36, v37
v_mfma_f32_16x16x32_bf16 v[240:243], a[48:51], v[60:63], v[240:243]
buffer_load_dwordx4 v3, s[48:51], s32 offen offset:1024 sc1 lds
v_mfma_f32_16x16x32_bf16 v[244:247], a[52:55], v[60:63], v[244:247]
v_exp_f32 v38, v38
v_mfma_f32_16x16x32_bf16 v[212:215], a[52:55], v[56:59], v[212:215]
ds_read_b128 a[28:31], v1 offset:15360
v_add_f32 v6, v6, v7
v_mfma_f32_16x16x32_bf16 v[180:183], a[52:55], v[52:55], v[180:183]
v_exp_f32 v39, v39
v_mfma_f32_16x16x32_bf16 v[184:187], a[56:59], v[52:55], v[184:187]
ds_read_b128 a[32:35], v1 offset:0
v_cvt_pk_bf16_f32 v71, v38, v39
v_mfma_f32_16x16x32_bf16 v[216:219], a[56:59], v[56:59], v[216:219]
v_exp_f32 v40, v40
v_mfma_f32_16x16x32_bf16 v[248:251], a[56:59], v[60:63], v[248:251]
ds_read_b128 a[36:39], v1 offset:1024
v_cmp_nge_f32 vcc, 0x6f800000, v6
v_mfma_f32_16x16x32_bf16 v[252:255], a[60:63], v[60:63], v[252:255]
v_exp_f32 v41, v41
v_mfma_f32_16x16x32_bf16 v[220:223], a[60:63], v[56:59], v[220:223]
v_exp_f32 v42, v42
v_mfma_f32_16x16x32_bf16 v[188:191], a[60:63], v[52:55], v[188:191]
ds_read_b128 a[40:43], v1 offset:2048
v_cvt_pk_bf16_f32 v74, v40, v41
v_mfma_f32_16x16x32_bf16 a[224:227], a[236:239], v[52:55], a[224:227]
buffer_load_dwordx4 v3, s[48:51], s32 offen offset:2048 sc1 lds
v_smfmac_f32_16x16x64_bf16 a[228:231], a[232:235], v[56:63], v9
ds_read_b128 a[44:47], v1 offset:3072
s_waitcnt lgkmcnt(8)
v_mfma_f32_16x16x32_bf16 v[24:27], a[0:3], a[192:195], v[88:91]
v_exp_f32 v43, v43
v_mfma_f32_16x16x32_bf16 v[24:27], a[4:7], a[196:199], v[24:27]
ds_read_b128 a[48:51], v1 offset:4096
v_cvt_pk_bf16_f32 v75, v42, v43
v_mfma_f32_16x16x32_bf16 v[24:27], a[8:11], a[200:203], v[24:27]
v_exp_f32 v44, v44
v_mfma_f32_16x16x32_bf16 v[24:27], a[12:15], a[204:207], v[24:27]
v_exp_f32 v45, v45
v_mfma_f32_16x16x32_bf16 v[28:31], a[0:3], a[208:211], v[92:95]
ds_read_b128 a[52:55], v1 offset:5120
v_cvt_pk_bf16_f32 v78, v44, v45
v_mfma_f32_16x16x32_bf16 v[28:31], a[4:7], a[212:215], v[28:31]
v_exp_f32 v46, v46
v_mfma_f32_16x16x32_bf16 v[28:31], a[8:11], a[216:219], v[28:31]
ds_read_b128 a[56:59], v1 offset:6144
v_mfma_f32_16x16x32_bf16 v[28:31], a[12:15], a[220:223], v[28:31]
s_waitcnt lgkmcnt(7)
v_exp_f32 v47, v47
v_mfma_f32_16x16x32_bf16 v[40:43], a[16:19], a[192:195], v[88:91]
buffer_load_dwordx4 v3, s[48:51], s32 offen offset:3072 sc1 lds
v_mfma_f32_16x16x32_bf16 v[40:43], a[20:23], a[196:199], v[40:43]
ds_read_b128 a[60:63], v1 offset:7168
v_cvt_pk_bf16_f32 v79, v46, v47
v_mfma_f32_16x16x32_bf16 v[40:43], a[24:27], a[200:203], v[40:43]
s_add_u32 s32, s32, 0x8000
v_exp_f32 v24, v24
v_mfma_f32_16x16x32_bf16 v[40:43], a[28:31], a[204:207], v[40:43]
v_exp_f32 v25, v25
v_mfma_f32_16x16x32_bf16 v[44:47], a[16:19], a[208:211], v[92:95]
v_exp_f32 v26, v26
v_mfma_f32_16x16x32_bf16 v[44:47], a[20:23], a[212:215], v[44:47]
v_exp_f32 v27, v27
v_mfma_f32_16x16x32_bf16 v[44:47], a[24:27], a[216:219], v[44:47]
v_exp_f32 v28, v28
v_mfma_f32_16x16x32_bf16 v[44:47], a[28:31], a[220:223], v[44:47]
s_waitcnt lgkmcnt(0)
v_exp_f32 v29, v29
v_mfma_f32_16x16x32_bf16 v[160:163], a[32:35], v[68:71], v[160:163]
ds_read_b128 a[0:3], v1 offset:24576
v_cvt_pk_bf16_f32 v56, v24, v25
v_mfma_f32_16x16x32_bf16 v[192:195], a[32:35], v[72:75], v[192:195]
v_exp_f32 v30, v30
v_mfma_f32_16x16x32_bf16 v[224:227], a[32:35], v[76:79], v[224:227]
ds_read_b128 a[4:7], v1 offset:25600
v_cvt_pk_bf16_f32 v57, v26, v27
v_mfma_f32_16x16x32_bf16 v[228:231], a[36:39], v[76:79], v[228:231]
s_add_u32 m0, s27, 0x1000
v_cvt_pk_bf16_f32 v60, v28, v29
v_mfma_f32_16x16x32_bf16 v[196:199], a[36:39], v[72:75], v[196:199]
buffer_load_dwordx4 v3, s[48:51], s7 offen offset:0 sc1 lds
v_mfma_f32_16x16x32_bf16 v[164:167], a[36:39], v[68:71], v[164:167]
ds_read_b128 a[8:11], v1 offset:26624
v_mfma_f32_16x16x32_bf16 v[168:171], a[40:43], v[68:71], v[168:171]
ds_read_b128 a[12:15], v1 offset:27648
v_mfma_f32_16x16x32_bf16 v[200:203], a[40:43], v[72:75], v[200:203]
v_exp_f32 v31, v31
v_mfma_f32_16x16x32_bf16 v[232:235], a[40:43], v[76:79], v[232:235]
v_exp_f32 v40, v40
v_mfma_f32_16x16x32_bf16 v[236:239], a[44:47], v[76:79], v[236:239]
ds_read_b128 a[16:19], v1 offset:28672
v_cvt_pk_bf16_f32 v61, v30, v31
v_mfma_f32_16x16x32_bf16 v[204:207], a[44:47], v[72:75], v[204:207]
v_exp_f32 v41, v41
v_mfma_f32_16x16x32_bf16 v[172:175], a[44:47], v[68:71], v[172:175]
ds_read_b128 a[20:23], v1 offset:29696
v_cvt_pk_bf16_f32 v58, v40, v41
v_mfma_f32_16x16x32_bf16 v[176:179], a[48:51], v[68:71], v[176:179]
v_rcp_f32 v6, v6
v_mfma_f32_16x16x32_bf16 v[208:211], a[48:51], v[72:75], v[208:211]
buffer_load_dwordx4 v3, s[48:51], s7 offen offset:1024 sc1 lds
v_mfma_f32_16x16x32_bf16 v[240:243], a[48:51], v[76:79], v[240:243]
ds_read_b128 a[24:27], v1 offset:30720
s_or_b64 s[34:35], s[34:35], vcc
v_mfma_f32_16x16x32_bf16 v[244:247], a[52:55], v[76:79], v[244:247]
ds_read_b128 a[28:31], v1 offset:31744
s_add_u32 s8, s28, 0x0
v_mfma_f32_16x16x32_bf16 v[212:215], a[52:55], v[72:75], v[212:215]
v_exp_f32 v42, v42
v_mfma_f32_16x16x32_bf16 v[180:183], a[52:55], v[68:71], v[180:183]
v_exp_f32 v43, v43
v_mfma_f32_16x16x32_bf16 v[184:187], a[56:59], v[68:71], v[184:187]
ds_read_b128 a[32:35], v1 offset:16384
v_cvt_pk_bf16_f32 v59, v42, v43
v_mfma_f32_16x16x32_bf16 v[216:219], a[56:59], v[72:75], v[216:219]
v_exp_f32 v44, v44
v_mfma_f32_16x16x32_bf16 v[248:251], a[56:59], v[76:79], v[248:251]
ds_read_b128 a[36:39], v1 offset:17408
v_mul_f32 v128, v6, v128
v_mfma_f32_16x16x32_bf16 v[252:255], a[60:63], v[76:79], v[252:255]
v_mul_f32 v129, v6, v129
v_mul_f32 v130, v6, v130
v_mfma_f32_16x16x32_bf16 v[220:223], a[60:63], v[72:75], v[220:223]
ds_read_b128 a[40:43], v1 offset:18432
v_mul_f32 v131, v6, v131
v_mfma_f32_16x16x32_bf16 v[188:191], a[60:63], v[68:71], v[188:191]
buffer_load_dwordx4 v3, s[48:51], s7 offen offset:2048 sc1 lds
v_mfma_f32_16x16x32_bf16 a[224:227], a[236:239], v[68:71], a[224:227]
ds_read_b128 a[44:47], v1 offset:19456
v_mul_f32 v132, v6, v132
v_smfmac_f32_16x16x64_bf16 a[228:231], a[232:235], v[72:79], v9
s_waitcnt lgkmcnt(8)
v_exp_f32 v45, v45
v_mfma_f32_16x16x32_bf16 v[24:27], a[0:3], a[192:195], v[88:91]
v_exp_f32 v46, v46
v_mfma_f32_16x16x32_bf16 v[24:27], a[4:7], a[196:199], v[24:27]
ds_read_b128 a[48:51], v1 offset:20480
v_cvt_pk_bf16_f32 v62, v44, v45
v_mfma_f32_16x16x32_bf16 v[24:27], a[8:11], a[200:203], v[24:27]
v_exp_f32 v47, v47
v_mfma_f32_16x16x32_bf16 v[24:27], a[12:15], a[204:207], v[24:27]
ds_read_b128 a[52:55], v1 offset:21504
v_cvt_pk_bf16_f32 v63, v46, v47
v_mfma_f32_16x16x32_bf16 v[28:31], a[0:3], a[208:211], v[92:95]
v_mul_f32 v133, v6, v133
v_mul_f32 v134, v6, v134
v_mfma_f32_16x16x32_bf16 v[28:31], a[4:7], a[212:215], v[28:31]
ds_read_b128 a[56:59], v1 offset:22528
v_mul_f32 v135, v6, v135
v_mfma_f32_16x16x32_bf16 v[28:31], a[8:11], a[216:219], v[28:31]
buffer_load_dwordx4 v3, s[48:51], s7 offen offset:3072 sc1 lds
v_mfma_f32_16x16x32_bf16 v[28:31], a[12:15], a[220:223], v[28:31]
ds_read_b128 a[60:63], v1 offset:23552
s_waitcnt lgkmcnt(8)
v_mfma_f32_16x16x32_bf16 v[40:43], a[16:19], a[192:195], v[88:91]
s_add_u32 s7, s7, 0x8000
v_xor_b32 v1, 0x8000, v1
v_cvt_pk_bf16_f32 v128, v128, v129
v_mfma_f32_16x16x32_bf16 v[40:43], a[20:23], a[196:199], v[40:43]
s_xor_b32 s27, s27, 0x38000
v_exp_f32 v24, v24
v_mfma_f32_16x16x32_bf16 v[40:43], a[24:27], a[200:203], v[40:43]
v_exp_f32 v25, v25
v_mfma_f32_16x16x32_bf16 v[40:43], a[28:31], a[204:207], v[40:43]
v_exp_f32 v26, v26
v_mfma_f32_16x16x32_bf16 v[44:47], a[16:19], a[208:211], v[92:95]
v_exp_f32 v27, v27
v_mfma_f32_16x16x32_bf16 v[44:47], a[20:23], a[212:215], v[44:47]
v_exp_f32 v28, v28
v_mfma_f32_16x16x32_bf16 v[44:47], a[24:27], a[216:219], v[44:47]
s_waitcnt vmcnt(19) lgkmcnt(0)
v_exp_f32 v29, v29
v_mfma_f32_16x16x32_bf16 v[44:47], a[28:31], a[220:223], v[44:47]
s_barrier
v_cvt_pk_bf16_f32 v129, v130, v131
v_cvt_pk_bf16_f32 v130, v132, v133
v_cvt_pk_bf16_f32 v131, v134, v135
buffer_store_dwordx4 v[128:131], v3, s[88:91], s8 offen sc1
s_add_u32 s8, s28, 0x2000
v_mul_f32 v136, v6, v136
v_mul_f32 v137, v6, v137
v_mul_f32 v138, v6, v138
v_mul_f32 v139, v6, v139
v_mul_f32 v140, v6, v140
v_mul_f32 v141, v6, v141
v_mul_f32 v142, v6, v142
v_mul_f32 v143, v6, v143
v_cvt_pk_bf16_f32 v136, v136, v137
v_cvt_pk_bf16_f32 v137, v138, v139
v_cvt_pk_bf16_f32 v138, v140, v141
v_cvt_pk_bf16_f32 v139, v142, v143
buffer_store_dwordx4 v[136:139], v3, s[88:91], s8 offen sc1
s_add_u32 s8, s28, 0x4000
v_mul_f32 v144, v6, v144
v_mul_f32 v145, v6, v145
v_mul_f32 v146, v6, v146
v_mul_f32 v147, v6, v147
v_mul_f32 v148, v6, v148
v_mul_f32 v149, v6, v149
v_mul_f32 v150, v6, v150
v_mul_f32 v151, v6, v151
v_cvt_pk_bf16_f32 v144, v144, v145
v_cvt_pk_bf16_f32 v145, v146, v147
v_cvt_pk_bf16_f32 v146, v148, v149
v_cvt_pk_bf16_f32 v147, v150, v151
buffer_store_dwordx4 v[144:147], v3, s[88:91], s8 offen sc1
s_add_u32 s8, s28, 0x6000
v_mul_f32 v152, v6, v152
v_mul_f32 v153, v6, v153
v_mul_f32 v154, v6, v154
v_mul_f32 v155, v6, v155
v_mul_f32 v156, v6, v156
v_mul_f32 v157, v6, v157
v_mul_f32 v158, v6, v158
v_mul_f32 v159, v6, v159
v_cvt_pk_bf16_f32 v152, v152, v153
v_cvt_pk_bf16_f32 v153, v154, v155
v_cvt_pk_bf16_f32 v154, v156, v157
v_cvt_pk_bf16_f32 v155, v158, v159
buffer_store_dwordx4 v[152:155], v3, s[88:91], s8 offen sc1
v_accvgpr_read_b32 v6, a226
v_accvgpr_read_b32 v7, a227
v_add_f32 v6, v6, v7
v_cmp_nge_f32 vcc, 0x6f800000, v6
v_rcp_f32 v6, v6
s_or_b64 s[34:35], s[34:35], vcc
s_add_u32 s8, s29, 0x0
v_pk_mul_f32 v[160:161], v[160:161], v[6:7] op_sel_hi:[1,0]
v_pk_mul_f32 v[162:163], v[162:163], v[6:7] op_sel_hi:[1,0]
v_pk_mul_f32 v[164:165], v[164:165], v[6:7] op_sel_hi:[1,0]
v_pk_mul_f32 v[166:167], v[166:167], v[6:7] op_sel_hi:[1,0]
v_cvt_pk_bf16_f32 v160, v160, v161
v_cvt_pk_bf16_f32 v161, v162, v163
v_cvt_pk_bf16_f32 v162, v164, v165
v_cvt_pk_bf16_f32 v163, v166, v167
buffer_store_dwordx4 v[160:163], v3, s[88:91], s8 offen sc1
s_add_u32 s8, s29, 0x2000
v_pk_mul_f32 v[168:169], v[168:169], v[6:7] op_sel_hi:[1,0]
v_pk_mul_f32 v[170:171], v[170:171], v[6:7] op_sel_hi:[1,0]
v_pk_mul_f32 v[172:173], v[172:173], v[6:7] op_sel_hi:[1,0]
v_pk_mul_f32 v[174:175], v[174:175], v[6:7] op_sel_hi:[1,0]
v_cvt_pk_bf16_f32 v168, v168, v169
v_cvt_pk_bf16_f32 v169, v170, v171
v_cvt_pk_bf16_f32 v170, v172, v173
v_cvt_pk_bf16_f32 v171, v174, v175
buffer_store_dwordx4 v[168:171], v3, s[88:91], s8 offen sc1
s_add_u32 s8, s29, 0x4000
v_pk_mul_f32 v[176:177], v[176:177], v[6:7] op_sel_hi:[1,0]
v_pk_mul_f32 v[178:179], v[178:179], v[6:7] op_sel_hi:[1,0]
v_pk_mul_f32 v[180:181], v[180:181], v[6:7] op_sel_hi:[1,0]
v_pk_mul_f32 v[182:183], v[182:183], v[6:7] op_sel_hi:[1,0]
v_cvt_pk_bf16_f32 v176, v176, v177
v_cvt_pk_bf16_f32 v177, v178, v179
v_cvt_pk_bf16_f32 v178, v180, v181
v_cvt_pk_bf16_f32 v179, v182, v183
buffer_store_dwordx4 v[176:179], v3, s[88:91], s8 offen sc1
s_add_u32 s8, s29, 0x6000
v_pk_mul_f32 v[184:185], v[184:185], v[6:7] op_sel_hi:[1,0]
v_pk_mul_f32 v[186:187], v[186:187], v[6:7] op_sel_hi:[1,0]
v_pk_mul_f32 v[188:189], v[188:189], v[6:7] op_sel_hi:[1,0]
v_pk_mul_f32 v[190:191], v[190:191], v[6:7] op_sel_hi:[1,0]
v_cvt_pk_bf16_f32 v184, v184, v185
v_cvt_pk_bf16_f32 v185, v186, v187
v_cvt_pk_bf16_f32 v186, v188, v189
v_cvt_pk_bf16_f32 v187, v190, v191
buffer_store_dwordx4 v[184:187], v3, s[88:91], s8 offen sc1
s_getreg_b32 s8, hwreg(HW_REG_HW_ID, 5, 1)
s_cmp_lg_u32 s8, 0
s_cbranch_scc1 L_att_sodd1
s_branch L_att_sodd0
L_att_lh0_0:
v_mfma_f32_16x16x32_bf16 v[160:163], a[32:35], v[52:55], v[160:163]
v_exp_f32 v28, v28
v_mfma_f32_16x16x32_bf16 v[192:195], a[32:35], v[56:59], v[192:195]
buffer_load_dword v14, v15, s[84:87], 0 offen offset:192 sc1
v_mfma_f32_16x16x32_bf16 v[224:227], a[32:35], v[60:63], v[224:227]
v_exp_f32 v29, v29
v_mfma_f32_16x16x32_bf16 v[228:231], a[36:39], v[60:63], v[228:231]
v_exp_f32 v30, v30
v_mfma_f32_16x16x32_bf16 v[196:199], a[36:39], v[56:59], v[196:199]
s_add_u32 m0, s17, 0x10000
v_exp_f32 v31, v31
v_mfma_f32_16x16x32_bf16 v[164:167], a[36:39], v[52:55], v[164:167]
ds_read_b128 a[0:3], v1 offset:8192
v_cvt_pk_bf16_f32 v72, v24, v25
v_mfma_f32_16x16x32_bf16 v[168:171], a[40:43], v[52:55], v[168:171]
ds_read_b128 a[4:7], v1 offset:9216
v_cvt_pk_bf16_f32 v73, v26, v27
v_mfma_f32_16x16x32_bf16 v[200:203], a[40:43], v[56:59], v[200:203]
buffer_load_dwordx4 v12, s[72:75], 0 offen lds
v_mfma_f32_16x16x32_bf16 v[232:235], a[40:43], v[60:63], v[232:235]
ds_read_b128 a[8:11], v1 offset:10240
v_cvt_pk_bf16_f32 v76, v28, v29
v_mfma_f32_16x16x32_bf16 v[236:239], a[44:47], v[60:63], v[236:239]
v_exp_f32 v36, v36
v_mfma_f32_16x16x32_bf16 v[204:207], a[44:47], v[56:59], v[204:207]
v_exp_f32 v37, v37
v_mfma_f32_16x16x32_bf16 v[172:175], a[44:47], v[52:55], v[172:175]
ds_read_b128 a[12:15], v1 offset:11264
v_cvt_pk_bf16_f32 v77, v30, v31
v_mfma_f32_16x16x32_bf16 v[176:179], a[48:51], v[52:55], v[176:179]
buffer_load_dwordx4 v13, s[72:75], 0 offen offset:1024 lds
v_mfma_f32_16x16x32_bf16 v[208:211], a[48:51], v[56:59], v[208:211]
ds_read_b128 a[16:19], v1 offset:12288
v_cvt_pk_bf16_f32 v70, v36, v37
v_mfma_f32_16x16x32_bf16 v[240:243], a[48:51], v[60:63], v[240:243]
ds_read_b128 a[20:23], v1 offset:13312
v_exp_f32 v38, v38
v_mfma_f32_16x16x32_bf16 v[244:247], a[52:55], v[60:63], v[244:247]
ds_read_b128 a[24:27], v1 offset:14336
v_exp_f32 v39, v39
v_mfma_f32_16x16x32_bf16 v[212:215], a[52:55], v[56:59], v[212:215]
v_exp_f32 v40, v40
v_mfma_f32_16x16x32_bf16 v[180:183], a[52:55], v[52:55], v[180:183]
buffer_load_dwordx4 v12, s[72:75], s12 offen offset:2048 lds
v_mfma_f32_16x16x32_bf16 v[184:187], a[56:59], v[52:55], v[184:187]
ds_read_b128 a[28:31], v1 offset:15360
v_exp_f32 v41, v41
v_mfma_f32_16x16x32_bf16 v[216:219], a[56:59], v[56:59], v[216:219]
buffer_load_dwordx4 v13, s[72:75], s12 offen offset:3072 lds
v_mfma_f32_16x16x32_bf16 v[248:251], a[56:59], v[60:63], v[248:251]
s_add_u32 m0, s17, 0x14000
v_exp_f32 v42, v42
v_mfma_f32_16x16x32_bf16 v[252:255], a[60:63], v[60:63], v[252:255]
ds_read_b128 a[32:35], v1 offset:0
v_cvt_pk_bf16_f32 v71, v38, v39
v_mfma_f32_16x16x32_bf16 v[220:223], a[60:63], v[56:59], v[220:223]
ds_read_b128 a[36:39], v1 offset:1024
v_add_u32 v12, 0x20000, v12
v_mfma_f32_16x16x32_bf16 v[188:191], a[60:63], v[52:55], v[188:191]
buffer_load_dwordx4 v12, s[72:75], 0 offen lds
v_mfma_f32_16x16x32_bf16 a[224:227], a[236:239], v[52:55], a[224:227]
ds_read_b128 a[40:43], v1 offset:2048
v_exp_f32 v43, v43
v_smfmac_f32_16x16x64_bf16 a[228:231], a[232:235], v[56:63], v9
s_waitcnt lgkmcnt(7)
v_exp_f32 v44, v44
v_mfma_f32_16x16x32_bf16 v[24:27], a[0:3], a[192:195], v[112:115]
ds_read_b128 a[44:47], v1 offset:3072
v_exp_f32 v45, v45
v_mfma_f32_16x16x32_bf16 v[24:27], a[4:7], a[196:199], v[24:27]
ds_read_b128 a[48:51], v1 offset:4096
v_add_u32 v13, 0x20000, v13
v_mfma_f32_16x16x32_bf16 v[24:27], a[8:11], a[200:203], v[24:27]
v_exp_f32 v46, v46
v_mfma_f32_16x16x32_bf16 v[24:27], a[12:15], a[204:207], v[24:27]
buffer_load_dwordx4 v13, s[72:75], 0 offen offset:1024 lds
v_mfma_f32_16x16x32_bf16 v[28:31], a[0:3], a[208:211], v[92:95]
v_exp_f32 v47, v47
v_mfma_f32_16x16x32_bf16 v[28:31], a[4:7], a[212:215], v[28:31]
ds_read_b128 a[52:55], v1 offset:5120
v_cvt_pk_bf16_f32 v74, v40, v41
v_mfma_f32_16x16x32_bf16 v[28:31], a[8:11], a[216:219], v[28:31]
ds_read_b128 a[56:59], v1 offset:6144
v_cvt_pk_bf16_f32 v75, v42, v43
v_mfma_f32_16x16x32_bf16 v[28:31], a[12:15], a[220:223], v[28:31]
s_waitcnt lgkmcnt(7)
v_exp_f32 v24, v24
v_mfma_f32_16x16x32_bf16 v[40:43], a[16:19], a[192:195], v[116:119]
buffer_load_dwordx4 v12, s[72:75], s12 offen offset:2048 lds
v_mfma_f32_16x16x32_bf16 v[40:43], a[20:23], a[196:199], v[40:43]
ds_read_b128 a[60:63], v1 offset:7168
v_cvt_pk_bf16_f32 v78, v44, v45
v_mfma_f32_16x16x32_bf16 v[40:43], a[24:27], a[200:203], v[40:43]
v_exp_f32 v25, v25
v_mfma_f32_16x16x32_bf16 v[40:43], a[28:31], a[204:207], v[40:43]
buffer_load_dwordx4 v13, s[72:75], s12 offen offset:3072 lds
v_cvt_pk_bf16_f32 v79, v46, v47
v_mfma_f32_16x16x32_bf16 v[44:47], a[16:19], a[208:211], v[92:95]
v_exp_f32 v26, v26
v_mfma_f32_16x16x32_bf16 v[44:47], a[20:23], a[212:215], v[44:47]
v_exp_f32 v27, v27
v_mfma_f32_16x16x32_bf16 v[44:47], a[24:27], a[216:219], v[44:47]
v_exp_f32 v28, v28
v_mfma_f32_16x16x32_bf16 v[44:47], a[28:31], a[220:223], v[44:47]
s_waitcnt lgkmcnt(0)
v_exp_f32 v29, v29
v_mfma_f32_16x16x32_bf16 v[160:163], a[32:35], v[68:71], v[160:163]
ds_read_b128 a[0:3], v1 offset:24576
v_cvt_pk_bf16_f32 v56, v24, v25
v_mfma_f32_16x16x32_bf16 v[192:195], a[32:35], v[72:75], v[192:195]
ds_read_b128 a[4:7], v1 offset:25600
v_add_u32 v12, 0x20000, v12
v_mfma_f32_16x16x32_bf16 v[224:227], a[32:35], v[76:79], v[224:227]
s_add_u32 m0, s16, 0x0
v_exp_f32 v30, v30
v_mfma_f32_16x16x32_bf16 v[228:231], a[36:39], v[76:79], v[228:231]
buffer_load_dwordx4 v12, s[72:75], 0 offen lds
v_mfma_f32_16x16x32_bf16 v[196:199], a[36:39], v[72:75], v[196:199]
ds_read_b128 a[8:11], v1 offset:26624
v_add_u32 v13, 0x20000, v13
v_mfma_f32_16x16x32_bf16 v[164:167], a[36:39], v[68:71], v[164:167]
buffer_load_dwordx4 v13, s[72:75], 0 offen offset:1024 lds
v_mfma_f32_16x16x32_bf16 v[168:171], a[40:43], v[68:71], v[168:171]
ds_read_b128 a[12:15], v1 offset:27648
v_cvt_pk_bf16_f32 v57, v26, v27
v_mfma_f32_16x16x32_bf16 v[200:203], a[40:43], v[72:75], v[200:203]
v_exp_f32 v31, v31
v_mfma_f32_16x16x32_bf16 v[232:235], a[40:43], v[76:79], v[232:235]
ds_read_b128 a[16:19], v1 offset:28672
v_cvt_pk_bf16_f32 v60, v28, v29
v_mfma_f32_16x16x32_bf16 v[236:239], a[44:47], v[76:79], v[236:239]
buffer_load_dwordx4 v12, s[72:75], s12 offen offset:2048 lds
v_mfma_f32_16x16x32_bf16 v[204:207], a[44:47], v[72:75], v[204:207]
ds_read_b128 a[20:23], v1 offset:29696
v_cvt_pk_bf16_f32 v61, v30, v31
v_mfma_f32_16x16x32_bf16 v[172:175], a[44:47], v[68:71], v[172:175]
buffer_load_dwordx4 v13, s[72:75], s12 offen offset:3072 lds
v_mfma_f32_16x16x32_bf16 v[176:179], a[48:51], v[68:71], v[176:179]
ds_read_b128 a[24:27], v1 offset:30720
v_mfma_f32_16x16x32_bf16 v[208:211], a[48:51], v[72:75], v[208:211]
ds_read_b128 a[28:31], v1 offset:31744
v_mfma_f32_16x16x32_bf16 v[240:243], a[48:51], v[76:79], v[240:243]
v_exp_f32 v40, v40
v_mfma_f32_16x16x32_bf16 v[244:247], a[52:55], v[76:79], v[244:247]
s_add_u32 m0, s16, 0x4000
v_exp_f32 v41, v41
v_mfma_f32_16x16x32_bf16 v[212:215], a[52:55], v[72:75], v[212:215]
ds_read_b128 a[32:35], v1 offset:16384
v_cvt_pk_bf16_f32 v58, v40, v41
v_mfma_f32_16x16x32_bf16 v[180:183], a[52:55], v[68:71], v[180:183]
ds_read_b128 a[36:39], v1 offset:17408
v_add_u32 v12, 0x20000, v12
v_mfma_f32_16x16x32_bf16 v[184:187], a[56:59], v[68:71], v[184:187]
buffer_load_dwordx4 v12, s[72:75], 0 offen lds
v_mfma_f32_16x16x32_bf16 v[216:219], a[56:59], v[72:75], v[216:219]
ds_read_b128 a[40:43], v1 offset:18432
v_mfma_f32_16x16x32_bf16 v[248:251], a[56:59], v[76:79], v[248:251]
v_exp_f32 v42, v42
v_mfma_f32_16x16x32_bf16 v[252:255], a[60:63], v[76:79], v[252:255]
ds_read_b128 a[44:47], v1 offset:19456
v_add_u32 v13, 0x20000, v13
v_mfma_f32_16x16x32_bf16 v[220:223], a[60:63], v[72:75], v[220:223]
buffer_load_dwordx4 v13, s[72:75], 0 offen offset:1024 lds
v_mfma_f32_16x16x32_bf16 v[188:191], a[60:63], v[68:71], v[188:191]
ds_read_b128 a[48:51], v1 offset:20480
v_exp_f32 v43, v43
v_mfma_f32_16x16x32_bf16 a[224:227], a[236:239], v[68:71], a[224:227]
s_waitcnt lgkmcnt(9)
v_exp_f32 v44, v44
v_smfmac_f32_16x16x64_bf16 a[228:231], a[232:235], v[72:79], v9
ds_read_b128 a[52:55], v1 offset:21504
v_exp_f32 v45, v45
v_mfma_f32_16x16x32_bf16 v[28:31], a[0:3], a[208:211], v[92:95]
buffer_load_dwordx4 v12, s[72:75], s12 offen offset:2048 lds
v_mfma_f32_16x16x32_bf16 v[28:31], a[4:7], a[212:215], v[28:31]
ds_read_b128 a[56:59], v1 offset:22528
v_exp_f32 v46, v46
v_mfma_f32_16x16x32_bf16 v[28:31], a[8:11], a[216:219], v[28:31]
ds_read_b128 a[60:63], v1 offset:23552
v_xor_b32 v1, 0x8000, v1
v_mfma_f32_16x16x32_bf16 v[28:31], a[12:15], a[220:223], v[28:31]
s_waitcnt lgkmcnt(8)
v_exp_f32 v47, v47
v_cvt_pk_bf16_f32 v62, v44, v45
v_cvt_pk_bf16_f32 v63, v46, v47
v_mfma_f32_16x16x32_bf16 v[44:47], a[16:19], a[208:211], v[92:95]
buffer_load_dwordx4 v13, s[72:75], s12 offen offset:3072 lds
v_mfma_f32_16x16x32_bf16 v[44:47], a[20:23], a[212:215], v[44:47]
v_cvt_pk_bf16_f32 v59, v42, v43
v_mfma_f32_16x16x32_bf16 v[44:47], a[24:27], a[216:219], v[44:47]
v_mfma_f32_16x16x32_bf16 v[44:47], a[28:31], a[220:223], v[44:47]
v_accvgpr_read_b32 v6, a224
v_accvgpr_read_b32 v7, a225
v_add_f32 v6, v6, v7
v_cmp_nge_f32 vcc, 0x6f800000, v6
v_rcp_f32 v6, v6
s_or_b64 s[34:35], s[34:35], vcc
s_add_u32 s8, s28, 0x0
v_pk_mul_f32 v[128:129], v[128:129], v[6:7] op_sel_hi:[1,0]
v_pk_mul_f32 v[130:131], v[130:131], v[6:7] op_sel_hi:[1,0]
v_pk_mul_f32 v[132:133], v[132:133], v[6:7] op_sel_hi:[1,0]
v_pk_mul_f32 v[134:135], v[134:135], v[6:7] op_sel_hi:[1,0]
v_cvt_pk_bf16_f32 v128, v128, v129
v_cvt_pk_bf16_f32 v129, v130, v131
v_cvt_pk_bf16_f32 v130, v132, v133
v_cvt_pk_bf16_f32 v131, v134, v135
buffer_store_dwordx4 v[128:131], v3, s[88:91], s8 offen sc1
s_add_u32 s8, s28, 0x2000
v_pk_mul_f32 v[136:137], v[136:137], v[6:7] op_sel_hi:[1,0]
v_pk_mul_f32 v[138:139], v[138:139], v[6:7] op_sel_hi:[1,0]
v_pk_mul_f32 v[140:141], v[140:141], v[6:7] op_sel_hi:[1,0]
v_pk_mul_f32 v[142:143], v[142:143], v[6:7] op_sel_hi:[1,0]
v_cvt_pk_bf16_f32 v136, v136, v137
v_cvt_pk_bf16_f32 v137, v138, v139
v_cvt_pk_bf16_f32 v138, v140, v141
v_cvt_pk_bf16_f32 v139, v142, v143
buffer_store_dwordx4 v[136:139], v3, s[88:91], s8 offen sc1
s_add_u32 s8, s28, 0x4000
v_pk_mul_f32 v[144:145], v[144:145], v[6:7] op_sel_hi:[1,0]
v_pk_mul_f32 v[146:147], v[146:147], v[6:7] op_sel_hi:[1,0]
v_pk_mul_f32 v[148:149], v[148:149], v[6:7] op_sel_hi:[1,0]
v_pk_mul_f32 v[150:151], v[150:151], v[6:7] op_sel_hi:[1,0]
v_cvt_pk_bf16_f32 v144, v144, v145
v_cvt_pk_bf16_f32 v145, v146, v147
v_cvt_pk_bf16_f32 v146, v148, v149
v_cvt_pk_bf16_f32 v147, v150, v151
buffer_store_dwordx4 v[144:147], v3, s[88:91], s8 offen sc1
s_add_u32 s8, s28, 0x6000
v_pk_mul_f32 v[152:153], v[152:153], v[6:7] op_sel_hi:[1,0]
v_pk_mul_f32 v[154:155], v[154:155], v[6:7] op_sel_hi:[1,0]
v_pk_mul_f32 v[156:157], v[156:157], v[6:7] op_sel_hi:[1,0]
v_pk_mul_f32 v[158:159], v[158:159], v[6:7] op_sel_hi:[1,0]
v_cvt_pk_bf16_f32 v152, v152, v153
v_cvt_pk_bf16_f32 v153, v154, v155
v_cvt_pk_bf16_f32 v154, v156, v157
v_cvt_pk_bf16_f32 v155, v158, v159
buffer_store_dwordx4 v[152:155], v3, s[88:91], s8 offen sc1
v_accvgpr_read_b32 v6, a226
v_accvgpr_read_b32 v7, a227
v_add_f32 v6, v6, v7
v_cmp_nge_f32 vcc, 0x6f800000, v6
v_rcp_f32 v6, v6
s_or_b64 s[34:35], s[34:35], vcc
s_add_u32 s8, s29, 0x0
v_pk_mul_f32 v[160:161], v[160:161], v[6:7] op_sel_hi:[1,0]
v_pk_mul_f32 v[162:163], v[162:163], v[6:7] op_sel_hi:[1,0]
v_pk_mul_f32 v[164:165], v[164:165], v[6:7] op_sel_hi:[1,0]
v_pk_mul_f32 v[166:167], v[166:167], v[6:7] op_sel_hi:[1,0]
v_cvt_pk_bf16_f32 v160, v160, v161
v_cvt_pk_bf16_f32 v161, v162, v163
v_cvt_pk_bf16_f32 v162, v164, v165
v_cvt_pk_bf16_f32 v163, v166, v167
buffer_store_dwordx4 v[160:163], v3, s[88:91], s8 offen sc1
s_add_u32 s8, s29, 0x2000
v_pk_mul_f32 v[168:169], v[168:169], v[6:7] op_sel_hi:[1,0]
v_pk_mul_f32 v[170:171], v[170:171], v[6:7] op_sel_hi:[1,0]
v_pk_mul_f32 v[172:173], v[172:173], v[6:7] op_sel_hi:[1,0]
v_pk_mul_f32 v[174:175], v[174:175], v[6:7] op_sel_hi:[1,0]
v_cvt_pk_bf16_f32 v168, v168, v169
v_cvt_pk_bf16_f32 v169, v170, v171
v_cvt_pk_bf16_f32 v170, v172, v173
v_cvt_pk_bf16_f32 v171, v174, v175
buffer_store_dwordx4 v[168:171], v3, s[88:91], s8 offen sc1
s_add_u32 s8, s29, 0x4000
v_pk_mul_f32 v[176:177], v[176:177], v[6:7] op_sel_hi:[1,0]
v_pk_mul_f32 v[178:179], v[178:179], v[6:7] op_sel_hi:[1,0]
v_pk_mul_f32 v[180:181], v[180:181], v[6:7] op_sel_hi:[1,0]
v_pk_mul_f32 v[182:183], v[182:183], v[6:7] op_sel_hi:[1,0]
v_cvt_pk_bf16_f32 v176, v176, v177
v_cvt_pk_bf16_f32 v177, v178, v179
v_cvt_pk_bf16_f32 v178, v180, v181
v_cvt_pk_bf16_f32 v179, v182, v183
buffer_store_dwordx4 v[176:179], v3, s[88:91], s8 offen sc1
s_add_u32 s8, s29, 0x6000
v_pk_mul_f32 v[184:185], v[184:185], v[6:7] op_sel_hi:[1,0]
v_pk_mul_f32 v[186:187], v[186:187], v[6:7] op_sel_hi:[1,0]
v_pk_mul_f32 v[188:189], v[188:189], v[6:7] op_sel_hi:[1,0]
v_pk_mul_f32 v[190:191], v[190:191], v[6:7] op_sel_hi:[1,0]
v_cvt_pk_bf16_f32 v184, v184, v185
v_cvt_pk_bf16_f32 v185, v186, v187
v_cvt_pk_bf16_f32 v186, v188, v189
v_cvt_pk_bf16_f32 v187, v190, v191
buffer_store_dwordx4 v[184:187], v3, s[88:91], s8 offen sc1
s_branch L_att_h1_0
L_att_dl0_1:
v_mfma_f32_16x16x32_bf16 v[128:131], a[32:35], v[48:51], v[128:131]
ds_read_b128 a[0:3], v1 offset:8192
v_cvt_pk_bf16_f32 v72, v24, v25
v_mfma_f32_16x16x32_bf16 v[160:163], a[32:35], v[52:55], v[160:163]
v_exp_f32 v28, v28
v_mfma_f32_16x16x32_bf16 v[192:195], a[32:35], v[56:59], v[192:195]
v_cvt_pk_bf16_f32 v73, v26, v27
v_mfma_f32_16x16x32_bf16 v[224:227], a[32:35], v[60:63], v[224:227]
ds_read_b128 a[4:7], v1 offset:9216
v_mfma_f32_16x16x32_bf16 v[228:231], a[36:39], v[60:63], v[228:231]
s_add_u32 m0, s27, 0x0
v_exp_f32 v29, v29
v_mfma_f32_16x16x32_bf16 v[196:199], a[36:39], v[56:59], v[196:199]
buffer_load_dwordx4 v3, s[48:51], s32 offen offset:0 sc1 lds
v_mfma_f32_16x16x32_bf16 v[164:167], a[36:39], v[52:55], v[164:167]
v_exp_f32 v30, v30
v_mfma_f32_16x16x32_bf16 v[132:135], a[36:39], v[48:51], v[132:135]
ds_read_b128 a[8:11], v1 offset:10240
v_cvt_pk_bf16_f32 v76, v28, v29
v_mfma_f32_16x16x32_bf16 v[136:139], a[40:43], v[48:51], v[136:139]
v_mfma_f32_16x16x32_bf16 v[168:171], a[40:43], v[52:55], v[168:171]
v_exp_f32 v31, v31
v_mfma_f32_16x16x32_bf16 v[200:203], a[40:43], v[56:59], v[200:203]
v_exp_f32 v32, v32
v_mfma_f32_16x16x32_bf16 v[232:235], a[40:43], v[60:63], v[232:235]
ds_read_b128 a[12:15], v1 offset:11264
v_cvt_pk_bf16_f32 v77, v30, v31
v_mfma_f32_16x16x32_bf16 v[236:239], a[44:47], v[60:63], v[236:239]
v_exp_f32 v33, v33
v_mfma_f32_16x16x32_bf16 v[204:207], a[44:47], v[56:59], v[204:207]
v_cvt_pk_bf16_f32 v66, v32, v33
v_mfma_f32_16x16x32_bf16 v[172:175], a[44:47], v[52:55], v[172:175]
v_exp_f32 v34, v34
v_mfma_f32_16x16x32_bf16 v[140:143], a[44:47], v[48:51], v[140:143]
ds_read_b128 a[16:19], v1 offset:12288
v_mfma_f32_16x16x32_bf16 v[144:147], a[48:51], v[48:51], v[144:147]
buffer_load_dwordx4 v3, s[48:51], s32 offen offset:1024 sc1 lds
v_mfma_f32_16x16x32_bf16 v[176:179], a[48:51], v[52:55], v[176:179]
v_exp_f32 v35, v35
v_mfma_f32_16x16x32_bf16 v[208:211], a[48:51], v[56:59], v[208:211]
v_exp_f32 v36, v36
v_mfma_f32_16x16x32_bf16 v[240:243], a[48:51], v[60:63], v[240:243]
ds_read_b128 a[20:23], v1 offset:13312
v_cvt_pk_bf16_f32 v67, v34, v35
v_mfma_f32_16x16x32_bf16 v[244:247], a[52:55], v[60:63], v[244:247]
v_mfma_f32_16x16x32_bf16 v[212:215], a[52:55], v[56:59], v[212:215]
v_exp_f32 v37, v37
v_mfma_f32_16x16x32_bf16 v[180:183], a[52:55], v[52:55], v[180:183]
ds_read_b128 a[24:27], v1 offset:14336
v_cvt_pk_bf16_f32 v70, v36, v37
v_mfma_f32_16x16x32_bf16 v[148:151], a[52:55], v[48:51], v[148:151]
v_exp_f32 v38, v38
v_mfma_f32_16x16x32_bf16 v[152:155], a[56:59], v[48:51], v[152:155]
v_mfma_f32_16x16x32_bf16 v[184:187], a[56:59], v[52:55], v[184:187]
v_exp_f32 v39, v39
v_mfma_f32_16x16x32_bf16 v[216:219], a[56:59], v[56:59], v[216:219]
buffer_load_dwordx4 v3, s[48:51], s32 offen offset:2048 sc1 lds
v_mfma_f32_16x16x32_bf16 v[248:251], a[56:59], v[60:63], v[248:251]
ds_read_b128 a[28:31], v1 offset:15360
v_cvt_pk_bf16_f32 v71, v38, v39
v_mfma_f32_16x16x32_bf16 v[252:255], a[60:63], v[60:63], v[252:255]
v_exp_f32 v40, v40
v_mfma_f32_16x16x32_bf16 v[220:223], a[60:63], v[56:59], v[220:223]
v_exp_f32 v41, v41
v_mfma_f32_16x16x32_bf16 v[188:191], a[60:63], v[52:55], v[188:191]
ds_read_b128 a[32:35], v1 offset:0
v_cvt_pk_bf16_f32 v74, v40, v41
v_mfma_f32_16x16x32_bf16 v[156:159], a[60:63], v[48:51], v[156:159]
v_smfmac_f32_16x16x64_bf16 a[224:227], a[232:235], v[48:55], v9
v_exp_f32 v42, v42
v_smfmac_f32_16x16x64_bf16 a[228:231], a[232:235], v[56:63], v9
s_waitcnt lgkmcnt(5)
v_exp_f32 v43, v43
v_mfma_f32_16x16x32_bf16 v[16:19], a[0:3], a[160:163], v[80:83]
ds_read_b128 a[36:39], v1 offset:1024
v_cvt_pk_bf16_f32 v75, v42, v43
v_mfma_f32_16x16x32_bf16 v[16:19], a[4:7], a[164:167], v[16:19]
v_exp_f32 v44, v44
v_mfma_f32_16x16x32_bf16 v[16:19], a[8:11], a[168:171], v[16:19]
v_mfma_f32_16x16x32_bf16 v[16:19], a[12:15], a[172:175], v[16:19]
buffer_load_dwordx4 v3, s[48:51], s32 offen offset:3072 sc1 lds
v_mfma_f32_16x16x32_bf16 v[20:23], a[0:3], a[176:179], v[84:87]
ds_read_b128 a[40:43], v1 offset:2048
v_mfma_f32_16x16x32_bf16 v[20:23], a[4:7], a[180:183], v[20:23]
v_exp_f32 v45, v45
v_mfma_f32_16x16x32_bf16 v[20:23], a[8:11], a[184:187], v[20:23]
v_exp_f32 v46, v46
v_mfma_f32_16x16x32_bf16 v[20:23], a[12:15], a[188:191], v[20:23]
ds_read_b128 a[44:47], v1 offset:3072
v_cvt_pk_bf16_f32 v78, v44, v45
v_mfma_f32_16x16x32_bf16 v[24:27], a[0:3], a[192:195], v[88:91]
v_mfma_f32_16x16x32_bf16 v[24:27], a[4:7], a[196:199], v[24:27]
v_exp_f32 v47, v47
v_mfma_f32_16x16x32_bf16 v[24:27], a[8:11], a[200:203], v[24:27]
v_exp_f32 v16, v16
v_mfma_f32_16x16x32_bf16 v[24:27], a[12:15], a[204:207], v[24:27]
ds_read_b128 a[48:51], v1 offset:4096
v_cvt_pk_bf16_f32 v79, v46, v47
v_mfma_f32_16x16x32_bf16 v[28:31], a[0:3], a[208:211], v[92:95]
v_exp_f32 v17, v17
v_mfma_f32_16x16x32_bf16 v[28:31], a[4:7], a[212:215], v[28:31]
s_add_u32 m0, s27, 0x1000
v_cvt_pk_bf16_f32 v48, v16, v17
v_mfma_f32_16x16x32_bf16 v[28:31], a[8:11], a[216:219], v[28:31]
buffer_load_dwordx4 v3, s[48:51], s7 offen offset:0 sc1 lds
v_mfma_f32_16x16x32_bf16 v[28:31], a[12:15], a[220:223], v[28:31]
ds_read_b128 a[52:55], v1 offset:5120
s_waitcnt lgkmcnt(6)
v_mfma_f32_16x16x32_bf16 v[32:35], a[16:19], a[160:163], v[80:83]
v_exp_f32 v18, v18
v_mfma_f32_16x16x32_bf16 v[32:35], a[20:23], a[164:167], v[32:35]
v_exp_f32 v19, v19
v_mfma_f32_16x16x32_bf16 v[32:35], a[24:27], a[168:171], v[32:35]
v_exp_f32 v20, v20
v_mfma_f32_16x16x32_bf16 v[32:35], a[28:31], a[172:175], v[32:35]
ds_read_b128 a[56:59], v1 offset:6144
v_cvt_pk_bf16_f32 v49, v18, v19
v_mfma_f32_16x16x32_bf16 v[36:39], a[16:19], a[176:179], v[84:87]
v_mfma_f32_16x16x32_bf16 v[36:39], a[20:23], a[180:183], v[36:39]
v_exp_f32 v21, v21
v_mfma_f32_16x16x32_bf16 v[36:39], a[24:27], a[184:187], v[36:39]
v_exp_f32 v22, v22
v_mfma_f32_16x16x32_bf16 v[36:39], a[28:31], a[188:191], v[36:39]
ds_read_b128 a[60:63], v1 offset:7168
v_cvt_pk_bf16_f32 v52, v20, v21
v_mfma_f32_16x16x32_bf16 v[40:43], a[16:19], a[192:195], v[88:91]
buffer_load_dwordx4 v3, s[48:51], s7 offen offset:1024 sc1 lds
v_mfma_f32_16x16x32_bf16 v[40:43], a[20:23], a[196:199], v[40:43]
v_mfma_f32_16x16x32_bf16 v[40:43], a[24:27], a[200:203], v[40:43]
v_exp_f32 v23, v23
v_mfma_f32_16x16x32_bf16 v[40:43], a[28:31], a[204:207], v[40:43]
v_exp_f32 v24, v24
v_mfma_f32_16x16x32_bf16 v[44:47], a[16:19], a[208:211], v[92:95]
v_exp_f32 v25, v25
v_mfma_f32_16x16x32_bf16 v[44:47], a[20:23], a[212:215], v[44:47]
v_exp_f32 v26, v26
v_mfma_f32_16x16x32_bf16 v[44:47], a[24:27], a[216:219], v[44:47]
v_exp_f32 v27, v27
v_mfma_f32_16x16x32_bf16 v[44:47], a[28:31], a[220:223], v[44:47]
s_waitcnt lgkmcnt(0)
v_cvt_pk_bf16_f32 v53, v22, v23
v_mfma_f32_16x16x32_bf16 v[128:131], a[32:35], v[64:67], v[128:131]
ds_read_b128 a[0:3], v1 offset:24576
v_cvt_pk_bf16_f32 v56, v24, v25
v_mfma_f32_16x16x32_bf16 v[160:163], a[32:35], v[68:71], v[160:163]
v_exp_f32 v28, v28
v_mfma_f32_16x16x32_bf16 v[192:195], a[32:35], v[72:75], v[192:195]
v_cvt_pk_bf16_f32 v57, v26, v27
v_mfma_f32_16x16x32_bf16 v[224:227], a[32:35], v[76:79], v[224:227]
ds_read_b128 a[4:7], v1 offset:25600
v_mfma_f32_16x16x32_bf16 v[228:231], a[36:39], v[76:79], v[228:231]
v_exp_f32 v29, v29
v_mfma_f32_16x16x32_bf16 v[196:199], a[36:39], v[72:75], v[196:199]
v_exp_f32 v30, v30
v_mfma_f32_16x16x32_bf16 v[164:167], a[36:39], v[68:71], v[164:167]
buffer_load_dwordx4 v3, s[48:51], s7 offen offset:2048 sc1 lds
v_mfma_f32_16x16x32_bf16 v[132:135], a[36:39], v[64:67], v[132:135]
ds_read_b128 a[8:11], v1 offset:26624
v_cvt_pk_bf16_f32 v60, v28, v29
v_mfma_f32_16x16x32_bf16 v[136:139], a[40:43], v[64:67], v[136:139]
v_mfma_f32_16x16x32_bf16 v[168:171], a[40:43], v[68:71], v[168:171]
v_exp_f32 v31, v31
v_mfma_f32_16x16x32_bf16 v[200:203], a[40:43], v[72:75], v[200:203]
v_exp_f32 v32, v32
v_mfma_f32_16x16x32_bf16 v[232:235], a[40:43], v[76:79], v[232:235]
ds_read_b128 a[12:15], v1 offset:27648
v_cvt_pk_bf16_f32 v61, v30, v31
v_mfma_f32_16x16x32_bf16 v[236:239], a[44:47], v[76:79], v[236:239]
v_mfma_f32_16x16x32_bf16 v[204:207], a[44:47], v[72:75], v[204:207]
v_exp_f32 v33, v33
v_mfma_f32_16x16x32_bf16 v[172:175], a[44:47], v[68:71], v[172:175]
v_exp_f32 v34, v34
v_mfma_f32_16x16x32_bf16 v[140:143], a[44:47], v[64:67], v[140:143]
ds_read_b128 a[16:19], v1 offset:28672
v_cvt_pk_bf16_f32 v50, v32, v33
v_mfma_f32_16x16x32_bf16 v[144:147], a[48:51], v[64:67], v[144:147]
v_exp_f32 v35, v35
v_mfma_f32_16x16x32_bf16 v[176:179], a[48:51], v[68:71], v[176:179]
v_cvt_pk_bf16_f32 v51, v34, v35
v_mfma_f32_16x16x32_bf16 v[208:211], a[48:51], v[72:75], v[208:211]
buffer_load_dwordx4 v3, s[48:51], s7 offen offset:3072 sc1 lds
v_mfma_f32_16x16x32_bf16 v[240:243], a[48:51], v[76:79], v[240:243]
ds_read_b128 a[20:23], v1 offset:29696
v_mfma_f32_16x16x32_bf16 v[244:247], a[52:55], v[76:79], v[244:247]
v_exp_f32 v36, v36
v_mfma_f32_16x16x32_bf16 v[212:215], a[52:55], v[72:75], v[212:215]
v_exp_f32 v37, v37
v_mfma_f32_16x16x32_bf16 v[180:183], a[52:55], v[68:71], v[180:183]
ds_read_b128 a[24:27], v1 offset:30720
v_cvt_pk_bf16_f32 v54, v36, v37
v_mfma_f32_16x16x32_bf16 v[148:151], a[52:55], v[64:67], v[148:151]
v_mfma_f32_16x16x32_bf16 v[152:155], a[56:59], v[64:67], v[152:155]
v_exp_f32 v38, v38
v_mfma_f32_16x16x32_bf16 v[184:187], a[56:59], v[68:71], v[184:187]
v_exp_f32 v39, v39
v_mfma_f32_16x16x32_bf16 v[216:219], a[56:59], v[72:75], v[216:219]
ds_read_b128 a[28:31], v1 offset:31744
v_cvt_pk_bf16_f32 v55, v38, v39
v_mfma_f32_16x16x32_bf16 v[248:251], a[56:59], v[76:79], v[248:251]
v_exp_f32 v40, v40
v_mfma_f32_16x16x32_bf16 v[252:255], a[60:63], v[76:79], v[252:255]
v_mfma_f32_16x16x32_bf16 v[220:223], a[60:63], v[72:75], v[220:223]
s_mov_b32 s9, 0x0
v_exp_f32 v41, v41
v_mfma_f32_16x16x32_bf16 v[188:191], a[60:63], v[68:71], v[188:191]
buffer_load_dword a244, v8, s[72:75], s9 offen
v_mfma_f32_16x16x32_bf16 v[156:159], a[60:63], v[64:67], v[156:159]
ds_read_b128 a[32:35], v1 offset:16384
v_cvt_pk_bf16_f32 v58, v40, v41
v_smfmac_f32_16x16x64_bf16 a[224:227], a[232:235], v[64:71], v9
s_waitcnt lgkmcnt(5)
v_exp_f32 v42, v42
v_smfmac_f32_16x16x64_bf16 a[228:231], a[232:235], v[72:79], v9
ds_read_b128 a[36:39], v1 offset:17408
v_mfma_f32_16x16x32_bf16 v[16:19], a[0:3], a[160:163], v[96:99]
v_mfma_f32_16x16x32_bf16 v[16:19], a[4:7], a[164:167], v[16:19]
v_exp_f32 v43, v43
v_mfma_f32_16x16x32_bf16 v[16:19], a[8:11], a[168:171], v[16:19]
v_exp_f32 v44, v44
v_mfma_f32_16x16x32_bf16 v[16:19], a[12:15], a[172:175], v[16:19]
ds_read_b128 a[40:43], v1 offset:18432
v_cvt_pk_bf16_f32 v59, v42, v43
v_mfma_f32_16x16x32_bf16 v[20:23], a[0:3], a[176:179], v[84:87]
v_exp_f32 v45, v45
v_mfma_f32_16x16x32_bf16 v[20:23], a[4:7], a[180:183], v[20:23]
v_cvt_pk_bf16_f32 v62, v44, v45
v_mfma_f32_16x16x32_bf16 v[20:23], a[8:11], a[184:187], v[20:23]
s_mov_b32 s9, 0x0
v_exp_f32 v46, v46
v_mfma_f32_16x16x32_bf16 v[20:23], a[12:15], a[188:191], v[20:23]
ds_read_b128 a[44:47], v1 offset:19456
v_mfma_f32_16x16x32_bf16 v[24:27], a[0:3], a[192:195], v[88:91]
buffer_load_dword a244, v8, s[64:67], s9 offen
v_mfma_f32_16x16x32_bf16 v[24:27], a[4:7], a[196:199], v[24:27]
v_exp_f32 v47, v47
v_mfma_f32_16x16x32_bf16 v[24:27], a[8:11], a[200:203], v[24:27]
v_cvt_pk_bf16_f32 v63, v46, v47
v_mfma_f32_16x16x32_bf16 v[24:27], a[12:15], a[204:207], v[24:27]
ds_read_b128 a[48:51], v1 offset:20480
v_mfma_f32_16x16x32_bf16 v[28:31], a[0:3], a[208:211], v[92:95]
v_exp_f32 v16, v16
v_mfma_f32_16x16x32_bf16 v[28:31], a[4:7], a[212:215], v[28:31]
v_exp_f32 v17, v17
v_mfma_f32_16x16x32_bf16 v[28:31], a[8:11], a[216:219], v[28:31]
ds_read_b128 a[52:55], v1 offset:21504
v_cvt_pk_bf16_f32 v64, v16, v17
v_mfma_f32_16x16x32_bf16 v[28:31], a[12:15], a[220:223], v[28:31]
s_waitcnt lgkmcnt(6)
v_exp_f32 v18, v18
v_mfma_f32_16x16x32_bf16 v[32:35], a[16:19], a[160:163], v[100:103]
v_mfma_f32_16x16x32_bf16 v[32:35], a[20:23], a[164:167], v[32:35]
v_exp_f32 v19, v19
v_mfma_f32_16x16x32_bf16 v[32:35], a[24:27], a[168:171], v[32:35]
ds_read_b128 a[56:59], v1 offset:22528
v_cvt_pk_bf16_f32 v65, v18, v19
v_mfma_f32_16x16x32_bf16 v[32:35], a[28:31], a[172:175], v[32:35]
s_mov_b32 s9, 0x400000
v_exp_f32 v20, v20
v_mfma_f32_16x16x32_bf16 v[36:39], a[16:19], a[176:179], v[84:87]
buffer_load_dword a244, v8, s[64:67], s9 offen
v_mfma_f32_16x16x32_bf16 v[36:39], a[20:23], a[180:183], v[36:39]
s_add_u32 s32, s32, 0x8000
v_mfma_f32_16x16x32_bf16 v[36:39], a[24:27], a[184:187], v[36:39]
ds_read_b128 a[60:63], v1 offset:23552
v_xor_b32 v1, 0x8000, v1
v_mfma_f32_16x16x32_bf16 v[36:39], a[28:31], a[188:191], v[36:39]
s_add_u32 s7, s7, 0x8000
v_exp_f32 v21, v21
v_mfma_f32_16x16x32_bf16 v[40:43], a[16:19], a[192:195], v[88:91]
s_xor_b32 s27, s27, 0x38000
v_exp_f32 v22, v22
v_mfma_f32_16x16x32_bf16 v[40:43], a[20:23], a[196:199], v[40:43]
v_exp_f32 v23, v23
v_mfma_f32_16x16x32_bf16 v[40:43], a[24:27], a[200:203], v[40:43]
v_cvt_pk_bf16_f32 v68, v20, v21
v_cvt_pk_bf16_f32 v69, v22, v23
v_mfma_f32_16x16x32_bf16 v[40:43], a[28:31], a[204:207], v[40:43]
v_exp_f32 v24, v24
v_mfma_f32_16x16x32_bf16 v[44:47], a[16:19], a[208:211], v[92:95]
v_exp_f32 v25, v25
v_mfma_f32_16x16x32_bf16 v[44:47], a[20:23], a[212:215], v[44:47]
v_exp_f32 v26, v26
v_mfma_f32_16x16x32_bf16 v[44:47], a[24:27], a[216:219], v[44:47]
s_waitcnt vmcnt(19) lgkmcnt(0)
v_exp_f32 v27, v27
v_mfma_f32_16x16x32_bf16 v[44:47], a[28:31], a[220:223], v[44:47]
s_barrier
L_att_l1_1:
v_mfma_f32_16x16x32_bf16 v[128:131], a[32:35], v[48:51], v[128:131]
ds_read_b128 a[0:3], v2 offset:8192
v_cvt_pk_bf16_f32 v72, v24, v25
v_mfma_f32_16x16x32_bf16 v[160:163], a[32:35], v[52:55], v[160:163]
s_lshr_b32 s44, s2, 6
v_exp_f32 v28, v28
v_mfma_f32_16x16x32_bf16 v[192:195], a[32:35], v[56:59], v[192:195]
s_add_u32 m0, s19, 0x0
s_lshl_b32 s45, s44, 1
v_cvt_pk_bf16_f32 v73, v26, v27
v_mfma_f32_16x16x32_bf16 v[224:227], a[32:35], v[60:63], v[224:227]
ds_read_b128 a[4:7], v2 offset:9216
s_add_u32 s45, s45, s100
v_mfma_f32_16x16x32_bf16 v[228:231], a[36:39], v[60:63], v[228:231]
buffer_load_dwordx4 v3, s[48:51], s32 offen offset:0 sc1 lds
v_mfma_f32_16x16x32_bf16 v[196:199], a[36:39], v[56:59], v[196:199]
s_and_b32 s60, s45, 3
v_exp_f32 v29, v29
v_mfma_f32_16x16x32_bf16 v[164:167], a[36:39], v[52:55], v[164:167]
ds_read_b128 a[8:11], v2 offset:10240
v_cvt_pk_bf16_f32 v76, v28, v29
v_mfma_f32_16x16x32_bf16 v[132:135], a[36:39], v[48:51], v[132:135]
s_sub_u32 s60, s60, s44
v_exp_f32 v30, v30
v_mfma_f32_16x16x32_bf16 v[136:139], a[40:43], v[48:51], v[136:139]
s_add_u32 s60, s60, 4
v_exp_f32 v31, v31
v_mfma_f32_16x16x32_bf16 v[168:171], a[40:43], v[52:55], v[168:171]
ds_read_b128 a[12:15], v2 offset:11264
v_cvt_pk_bf16_f32 v77, v30, v31
v_mfma_f32_16x16x32_bf16 v[200:203], a[40:43], v[56:59], v[200:203]
s_lshl_b32 s60, s60, 14
s_and_b32 s60, s60, 0x7c000
s_lshl_b32 s61, s60, 3
v_mfma_f32_16x16x32_bf16 v[232:235], a[40:43], v[60:63], v[232:235]
s_add_u32 s62, s61, s12
v_exp_f32 v32, v32
v_mfma_f32_16x16x32_bf16 v[236:239], a[44:47], v[60:63], v[236:239]
s_mov_b32 s9, 0x200000
v_exp_f32 v33, v33
v_mfma_f32_16x16x32_bf16 v[204:207], a[44:47], v[56:59], v[204:207]
ds_read_b128 a[16:19], v2 offset:12288
v_cvt_pk_bf16_f32 v66, v32, v33
v_mfma_f32_16x16x32_bf16 v[172:175], a[44:47], v[52:55], v[172:175]
buffer_load_dword a244, v8, s[64:67], s9 offen
v_mfma_f32_16x16x32_bf16 v[140:143], a[44:47], v[48:51], v[140:143]
s_mul_i32 s44, s44, -8
v_exp_f32 v34, v34
v_mfma_f32_16x16x32_bf16 v[144:147], a[48:51], v[48:51], v[144:147]
ds_read_b128 a[20:23], v2 offset:13312
s_lshl_b32 s44, 4, s44
v_mfma_f32_16x16x32_bf16 v[176:179], a[48:51], v[52:55], v[176:179]
s_mul_i32 s45, s45, -8
v_exp_f32 v35, v35
v_mfma_f32_16x16x32_bf16 v[208:211], a[48:51], v[56:59], v[208:211]
s_lshl_b32 s45, 4, s45
s_add_u32 s44, s44, 0x21212121
v_cvt_pk_bf16_f32 v67, v34, v35
v_mfma_f32_16x16x32_bf16 v[240:243], a[48:51], v[60:63], v[240:243]
ds_read_b128 a[24:27], v2 offset:14336
s_sub_u32 s44, s44, s45
v_mfma_f32_16x16x32_bf16 v[244:247], a[52:55], v[60:63], v[244:247]
s_bfe_u32 s56, s44, 0x80000
v_exp_f32 v36, v36
v_mfma_f32_16x16x32_bf16 v[212:215], a[52:55], v[56:59], v[212:215]
s_lshl_b32 s56, s56, 14
v_exp_f32 v37, v37
v_mfma_f32_16x16x32_bf16 v[180:183], a[52:55], v[52:55], v[180:183]
s_bfe_u32 s57, s44, 0x80008
v_exp_f32 v38, v38
v_mfma_f32_16x16x32_bf16 v[148:151], a[52:55], v[48:51], v[148:151]
buffer_load_dwordx4 v3, s[48:51], s32 offen offset:1024 sc1 lds
v_mfma_f32_16x16x32_bf16 v[152:155], a[56:59], v[48:51], v[152:155]
ds_read_b128 a[28:31], v2 offset:15360
v_cvt_pk_bf16_f32 v70, v36, v37
v_mfma_f32_16x16x32_bf16 v[184:187], a[56:59], v[52:55], v[184:187]
s_lshl_b32 s57, s57, 14
s_bfe_u32 s58, s44, 0x80010
s_lshl_b32 s58, s58, 14
v_mfma_f32_16x16x32_bf16 v[216:219], a[56:59], v[56:59], v[216:219]
ds_read_b128 a[32:35], v2 offset:0
s_bfe_u32 s59, s44, 0x80018
v_mfma_f32_16x16x32_bf16 v[248:251], a[56:59], v[60:63], v[248:251]
s_lshl_b32 s59, s59, 14
v_exp_f32 v39, v39
v_mfma_f32_16x16x32_bf16 v[252:255], a[60:63], v[60:63], v[252:255]
v_exp_f32 v40, v40
v_mfma_f32_16x16x32_bf16 v[220:223], a[60:63], v[56:59], v[220:223]
ds_read_b128 a[36:39], v2 offset:1024
v_cvt_pk_bf16_f32 v71, v38, v39
v_mfma_f32_16x16x32_bf16 v[188:191], a[60:63], v[52:55], v[188:191]
v_exp_f32 v41, v41
v_mfma_f32_16x16x32_bf16 v[156:159], a[60:63], v[48:51], v[156:159]
s_waitcnt lgkmcnt(6)
v_exp_f32 v42, v42
v_smfmac_f32_16x16x64_bf16 a[224:227], a[232:235], v[48:55], v9
buffer_load_dwordx4 v3, s[48:51], s32 offen offset:2048 sc1 lds
v_smfmac_f32_16x16x64_bf16 a[228:231], a[232:235], v[56:63], v9
ds_read_b128 a[40:43], v2 offset:2048
v_cvt_pk_bf16_f32 v74, v40, v41
v_mfma_f32_16x16x32_bf16 v[20:23], a[0:3], a[176:179], v[104:107]
v_mov_b32 v6, 0xf149f2ca
v_min_f32 v119, s10, v88
v_mfma_f32_16x16x32_bf16 v[20:23], a[4:7], a[180:183], v[20:23]
v_exp_f32 v43, v43
v_mfma_f32_16x16x32_bf16 v[20:23], a[8:11], a[184:187], v[20:23]
ds_read_b128 a[44:47], v2 offset:3072
v_cvt_pk_bf16_f32 v75, v42, v43
v_mfma_f32_16x16x32_bf16 v[20:23], a[12:15], a[188:191], v[20:23]
v_exp_f32 v44, v44
v_mfma_f32_16x16x32_bf16 v[24:27], a[0:3], a[192:195], v[88:91]
v_exp_f32 v45, v45
v_mfma_f32_16x16x32_bf16 v[24:27], a[4:7], a[196:199], v[24:27]
ds_read_b128 a[48:51], v2 offset:4096
v_cvt_pk_bf16_f32 v78, v44, v45
v_mfma_f32_16x16x32_bf16 v[24:27], a[8:11], a[200:203], v[24:27]
v_cndmask_b32 v112, v119, v88, s[36:37]
v_cndmask_b32 v113, v119, v88, s[38:39]
v_mfma_f32_16x16x32_bf16 v[24:27], a[12:15], a[204:207], v[24:27]
v_exp_f32 v46, v46
v_mfma_f32_16x16x32_bf16 v[28:31], a[0:3], a[208:211], v[92:95]
buffer_load_dwordx4 v3, s[48:51], s32 offen offset:3072 sc1 lds
v_mfma_f32_16x16x32_bf16 v[28:31], a[4:7], a[212:215], v[28:31]
ds_read_b128 a[52:55], v2 offset:5120
v_cndmask_b32 v114, v119, v88, s[40:41]
v_mfma_f32_16x16x32_bf16 v[28:31], a[8:11], a[216:219], v[28:31]
v_exp_f32 v47, v47
v_mfma_f32_16x16x32_bf16 v[28:31], a[12:15], a[220:223], v[28:31]
s_waitcnt lgkmcnt(6)
v_exp_f32 v20, v20
v_mfma_f32_16x16x32_bf16 v[36:39], a[16:19], a[176:179], v[108:111]
ds_read_b128 a[56:59], v2 offset:6144
v_cvt_pk_bf16_f32 v79, v46, v47
v_mfma_f32_16x16x32_bf16 v[36:39], a[20:23], a[180:183], v[36:39]
v_exp_f32 v21, v21
v_mfma_f32_16x16x32_bf16 v[36:39], a[24:27], a[184:187], v[36:39]
v_cvt_pk_bf16_f32 v52, v20, v21
v_cndmask_b32 v115, v119, v88, s[42:43]
v_mfma_f32_16x16x32_bf16 v[36:39], a[28:31], a[188:191], v[36:39]
ds_read_b128 a[60:63], v2 offset:7168
v_cndmask_b32 v116, v6, v119, s[36:37]
v_mfma_f32_16x16x32_bf16 v[40:43], a[16:19], a[192:195], v[88:91]
s_mov_b32 s9, 0x600000
v_exp_f32 v22, v22
v_mfma_f32_16x16x32_bf16 v[40:43], a[20:23], a[196:199], v[40:43]
buffer_load_dword a244, v8, s[64:67], s9 offen
v_mfma_f32_16x16x32_bf16 v[40:43], a[24:27], a[200:203], v[40:43]
v_exp_f32 v23, v23
v_mfma_f32_16x16x32_bf16 v[40:43], a[28:31], a[204:207], v[40:43]
v_exp_f32 v24, v24
v_mfma_f32_16x16x32_bf16 v[44:47], a[16:19], a[208:211], v[92:95]
v_exp_f32 v25, v25
v_mfma_f32_16x16x32_bf16 v[44:47], a[20:23], a[212:215], v[44:47]
v_exp_f32 v26, v26
v_mfma_f32_16x16x32_bf16 v[44:47], a[24:27], a[216:219], v[44:47]
v_exp_f32 v27, v27
v_mfma_f32_16x16x32_bf16 v[44:47], a[28:31], a[220:223], v[44:47]
s_waitcnt lgkmcnt(0)
v_cvt_pk_bf16_f32 v53, v22, v23
v_cndmask_b32 v117, v6, v119, s[38:39]
v_cndmask_b32 v118, v6, v119, s[40:41]
v_cndmask_b32 v119, v6, v119, s[42:43]
v_min_f32 v127, s11, v92
v_cndmask_b32 v120, v127, v92, s[36:37]
v_cndmask_b32 v121, v127, v92, s[38:39]
v_cndmask_b32 v122, v127, v92, s[40:41]
v_cndmask_b32 v123, v127, v92, s[42:43]
v_cndmask_b32 v124, v6, v127, s[36:37]
v_cndmask_b32 v125, v6, v127, s[38:39]
v_cndmask_b32 v126, v6, v127, s[40:41]
v_cndmask_b32 v127, v6, v127, s[42:43]
v_mfma_f32_16x16x32_bf16 v[128:131], a[32:35], v[64:67], v[128:131]
ds_read_b128 a[0:3], v2 offset:24576
v_cvt_pk_bf16_f32 v56, v24, v25
v_mfma_f32_16x16x32_bf16 v[160:163], a[32:35], v[68:71], v[160:163]
v_exp_f32 v28, v28
v_mfma_f32_16x16x32_bf16 v[192:195], a[32:35], v[72:75], v[192:195]
ds_read_b128 a[4:7], v2 offset:25600
v_cvt_pk_bf16_f32 v57, v26, v27
v_mfma_f32_16x16x32_bf16 v[224:227], a[32:35], v[76:79], v[224:227]
s_add_u32 m0, s19, 0x1000
v_mfma_f32_16x16x32_bf16 v[228:231], a[36:39], v[76:79], v[228:231]
buffer_load_dwordx4 v3, s[48:51], s7 offen offset:0 sc1 lds
v_mfma_f32_16x16x32_bf16 v[196:199], a[36:39], v[72:75], v[196:199]
ds_read_b128 a[8:11], v2 offset:26624
v_mfma_f32_16x16x32_bf16 v[164:167], a[36:39], v[68:71], v[164:167]
v_exp_f32 v29, v29
v_mfma_f32_16x16x32_bf16 v[132:135], a[36:39], v[64:67], v[132:135]
v_exp_f32 v30, v30
v_mfma_f32_16x16x32_bf16 v[136:139], a[40:43], v[64:67], v[136:139]
ds_read_b128 a[12:15], v2 offset:27648
v_cvt_pk_bf16_f32 v60, v28, v29
v_mfma_f32_16x16x32_bf16 v[168:171], a[40:43], v[68:71], v[168:171]
v_exp_f32 v31, v31
v_mfma_f32_16x16x32_bf16 v[200:203], a[40:43], v[72:75], v[200:203]
v_exp_f32 v36, v36
v_mfma_f32_16x16x32_bf16 v[232:235], a[40:43], v[76:79], v[232:235]
ds_read_b128 a[16:19], v2 offset:28672
v_cvt_pk_bf16_f32 v61, v30, v31
v_mfma_f32_16x16x32_bf16 v[236:239], a[44:47], v[76:79], v[236:239]
buffer_load_dwordx4 v3, s[48:51], s7 offen offset:1024 sc1 lds
v_mfma_f32_16x16x32_bf16 v[204:207], a[44:47], v[72:75], v[204:207]
ds_read_b128 a[20:23], v2 offset:29696
v_mfma_f32_16x16x32_bf16 v[172:175], a[44:47], v[68:71], v[172:175]
v_mfma_f32_16x16x32_bf16 v[140:143], a[44:47], v[64:67], v[140:143]
v_exp_f32 v37, v37
v_mfma_f32_16x16x32_bf16 v[144:147], a[48:51], v[64:67], v[144:147]
ds_read_b128 a[24:27], v2 offset:30720
v_cvt_pk_bf16_f32 v54, v36, v37
v_mfma_f32_16x16x32_bf16 v[176:179], a[48:51], v[68:71], v[176:179]
v_exp_f32 v38, v38
v_mfma_f32_16x16x32_bf16 v[208:211], a[48:51], v[72:75], v[208:211]
v_exp_f32 v39, v39
v_mfma_f32_16x16x32_bf16 v[240:243], a[48:51], v[76:79], v[240:243]
ds_read_b128 a[28:31], v2 offset:31744
v_cvt_pk_bf16_f32 v55, v38, v39
v_mfma_f32_16x16x32_bf16 v[244:247], a[52:55], v[76:79], v[244:247]
v_exp_f32 v40, v40
v_mfma_f32_16x16x32_bf16 v[212:215], a[52:55], v[72:75], v[212:215]
buffer_load_dwordx4 v3, s[48:51], s7 offen offset:2048 sc1 lds
v_mfma_f32_16x16x32_bf16 v[180:183], a[52:55], v[68:71], v[180:183]
ds_read_b128 a[32:35], v2 offset:16384
v_mfma_f32_16x16x32_bf16 v[148:151], a[52:55], v[64:67], v[148:151]
v_mfma_f32_16x16x32_bf16 v[152:155], a[56:59], v[64:67], v[152:155]
ds_read_b128 a[36:39], v2 offset:17408
v_mfma_f32_16x16x32_bf16 v[184:187], a[56:59], v[68:71], v[184:187]
v_exp_f32 v41, v41
v_mfma_f32_16x16x32_bf16 v[216:219], a[56:59], v[72:75], v[216:219]
v_exp_f32 v42, v42
v_mfma_f32_16x16x32_bf16 v[248:251], a[56:59], v[76:79], v[248:251]
ds_read_b128 a[40:43], v2 offset:18432
v_cvt_pk_bf16_f32 v58, v40, v41
v_mfma_f32_16x16x32_bf16 v[252:255], a[60:63], v[76:79], v[252:255]
v_exp_f32 v43, v43
v_mfma_f32_16x16x32_bf16 v[220:223], a[60:63], v[72:75], v[220:223]
buffer_load_dwordx4 v3, s[48:51], s7 offen offset:3072 sc1 lds
v_mfma_f32_16x16x32_bf16 v[188:191], a[60:63], v[68:71], v[188:191]
ds_read_b128 a[44:47], v2 offset:19456
v_cvt_pk_bf16_f32 v59, v42, v43
v_mfma_f32_16x16x32_bf16 v[156:159], a[60:63], v[64:67], v[156:159]
v_exp_f32 v44, v44
v_smfmac_f32_16x16x64_bf16 a[224:227], a[232:235], v[64:71], v9
s_waitcnt lgkmcnt(8)
v_exp_f32 v45, v45
v_smfmac_f32_16x16x64_bf16 a[228:231], a[232:235], v[72:79], v9
ds_read_b128 a[48:51], v2 offset:20480
v_add_u32 v4, s0, v3
v_mfma_f32_16x16x32_bf16 v[24:27], a[0:3], a[192:195], v[88:91]
v_cvt_pk_bf16_f32 v62, v44, v45
v_mfma_f32_16x16x32_bf16 v[24:27], a[4:7], a[196:199], v[24:27]
ds_read_b128 a[52:55], v2 offset:21504
v_mov_b32 v5, s1
v_mfma_f32_16x16x32_bf16 v[24:27], a[8:11], a[200:203], v[24:27]
v_exp_f32 v46, v46
v_mfma_f32_16x16x32_bf16 v[24:27], a[12:15], a[204:207], v[24:27]
global_load_dword a244, v[4:5], off sc1
v_mfma_f32_16x16x32_bf16 v[28:31], a[0:3], a[208:211], v[92:95]
ds_read_b128 a[56:59], v2 offset:22528
v_mfma_f32_16x16x32_bf16 v[28:31], a[4:7], a[212:215], v[28:31]
s_add_u32 s32, s32, 0x8000
v_exp_f32 v47, v47
v_mfma_f32_16x16x32_bf16 v[28:31], a[8:11], a[216:219], v[28:31]
s_waitcnt lgkmcnt(7)
v_cvt_pk_bf16_f32 v63, v46, v47
v_mfma_f32_16x16x32_bf16 v[28:31], a[12:15], a[220:223], v[28:31]
ds_read_b128 a[60:63], v2 offset:23552
s_add_u32 s7, s7, 0x8000
v_mfma_f32_16x16x32_bf16 v[40:43], a[16:19], a[192:195], v[88:91]
s_xor_b32 s19, s19, 0x8000
v_xor_b32 v2, 0x38000, v2
v_mfma_f32_16x16x32_bf16 v[40:43], a[20:23], a[196:199], v[40:43]
s_sub_u32 s15, 7, s6
v_exp_f32 v24, v24
v_mfma_f32_16x16x32_bf16 v[40:43], a[24:27], a[200:203], v[40:43]
s_lshl_b32 s15, s15, 1
v_exp_f32 v25, v25
v_mfma_f32_16x16x32_bf16 v[40:43], a[28:31], a[204:207], v[40:43]
v_exp_f32 v26, v26
v_mfma_f32_16x16x32_bf16 v[44:47], a[16:19], a[208:211], v[92:95]
v_exp_f32 v27, v27
v_mfma_f32_16x16x32_bf16 v[44:47], a[20:23], a[212:215], v[44:47]
v_exp_f32 v28, v28
v_mfma_f32_16x16x32_bf16 v[44:47], a[24:27], a[216:219], v[44:47]
s_waitcnt vmcnt(22) lgkmcnt(0)
v_exp_f32 v29, v29
v_mfma_f32_16x16x32_bf16 v[44:47], a[28:31], a[220:223], v[44:47]
s_barrier
s_cbranch_scc0 L_att_lh0_1
L_att_ls_1:
v_mfma_f32_16x16x32_bf16 v[160:163], a[32:35], v[52:55], v[160:163]
ds_read_b128 a[0:3], v1 offset:8192
v_cvt_pk_bf16_f32 v72, v24, v25
v_mfma_f32_16x16x32_bf16 v[192:195], a[32:35], v[56:59], v[192:195]
v_exp_f32 v30, v30
v_mfma_f32_16x16x32_bf16 v[224:227], a[32:35], v[60:63], v[224:227]
ds_read_b128 a[4:7], v1 offset:9216
v_cvt_pk_bf16_f32 v73, v26, v27
v_mfma_f32_16x16x32_bf16 v[228:231], a[36:39], v[60:63], v[228:231]
s_add_u32 m0, s27, 0x0
v_cvt_pk_bf16_f32 v76, v28, v29
v_accvgpr_read_b32 v6, a224
v_mfma_f32_16x16x32_bf16 v[196:199], a[36:39], v[56:59], v[196:199]
buffer_load_dwordx4 v3, s[48:51], s32 offen offset:0 sc1 lds
v_mfma_f32_16x16x32_bf16 v[164:167], a[36:39], v[52:55], v[164:167]
ds_read_b128 a[8:11], v1 offset:10240
v_accvgpr_read_b32 v7, a225
v_mfma_f32_16x16x32_bf16 v[168:171], a[40:43], v[52:55], v[168:171]
ds_read_b128 a[12:15], v1 offset:11264
v_add_f32 v6, v6, v7
v_mfma_f32_16x16x32_bf16 v[200:203], a[40:43], v[56:59], v[200:203]
v_exp_f32 v31, v31
v_mfma_f32_16x16x32_bf16 v[232:235], a[40:43], v[60:63], v[232:235]
v_exp_f32 v40, v40
v_mfma_f32_16x16x32_bf16 v[236:239], a[44:47], v[60:63], v[236:239]
ds_read_b128 a[16:19], v1 offset:12288
v_cvt_pk_bf16_f32 v77, v30, v31
v_mfma_f32_16x16x32_bf16 v[204:207], a[44:47], v[56:59], v[204:207]
v_cmp_nge_f32 vcc, 0x6f800000, v6
v_mfma_f32_16x16x32_bf16 v[172:175], a[44:47], v[52:55], v[172:175]
ds_read_b128 a[20:23], v1 offset:13312
v_mfma_f32_16x16x32_bf16 v[176:179], a[48:51], v[52:55], v[176:179]
v_exp_f32 v41, v41
v_mfma_f32_16x16x32_bf16 v[208:211], a[48:51], v[56:59], v[208:211]
ds_read_b128 a[24:27], v1 offset:14336
v_cvt_pk_bf16_f32 v74, v40, v41
v_mfma_f32_16x16x32_bf16 v[240:243], a[48:51], v[60:63], v[240:243]
buffer_load_dwordx4 v3, s[48:51], s32 offen offset:1024 sc1 lds
v_mfma_f32_16x16x32_bf16 v[244:247], a[52:55], v[60:63], v[244:247]
v_exp_f32 v42, v42
v_mfma_f32_16x16x32_bf16 v[212:215], a[52:55], v[56:59], v[212:215]
ds_read_b128 a[28:31], v1 offset:15360
v_mfma_f32_16x16x32_bf16 v[180:183], a[52:55], v[52:55], v[180:183]
v_exp_f32 v43, v43
v_mfma_f32_16x16x32_bf16 v[184:187], a[56:59], v[52:55], v[184:187]
ds_read_b128 a[32:35], v1 offset:0
v_cvt_pk_bf16_f32 v75, v42, v43
v_mfma_f32_16x16x32_bf16 v[216:219], a[56:59], v[56:59], v[216:219]
v_rcp_f32 v6, v6
v_mfma_f32_16x16x32_bf16 v[248:251], a[56:59], v[60:63], v[248:251]
ds_read_b128 a[36:39], v1 offset:1024
s_or_b64 s[34:35], s[34:35], vcc
v_mfma_f32_16x16x32_bf16 v[252:255], a[60:63], v[60:63], v[252:255]
s_add_u32 s8, s28, 0x0
v_exp_f32 v44, v44
v_mfma_f32_16x16x32_bf16 v[220:223], a[60:63], v[56:59], v[220:223]
v_exp_f32 v45, v45
v_mfma_f32_16x16x32_bf16 v[188:191], a[60:63], v[52:55], v[188:191]
ds_read_b128 a[40:43], v1 offset:2048
v_cvt_pk_bf16_f32 v78, v44, v45
v_mfma_f32_16x16x32_bf16 a[224:227], a[236:239], v[52:55], a[224:227]
buffer_load_dwordx4 v3, s[48:51], s32 offen offset:2048 sc1 lds
v_smfmac_f32_16x16x64_bf16 a[228:231], a[232:235], v[56:63], v9
ds_read_b128 a[44:47], v1 offset:3072
s_waitcnt lgkmcnt(8)
v_mfma_f32_16x16x32_bf16 v[24:27], a[0:3], a[192:195], v[88:91]
v_exp_f32 v46, v46
v_mfma_f32_16x16x32_bf16 v[24:27], a[4:7], a[196:199], v[24:27]
ds_read_b128 a[48:51], v1 offset:4096
v_mul_f32 v128, v6, v128
v_mfma_f32_16x16x32_bf16 v[24:27], a[8:11], a[200:203], v[24:27]
v_mul_f32 v129, v6, v129
v_mul_f32 v130, v6, v130
v_mfma_f32_16x16x32_bf16 v[24:27], a[12:15], a[204:207], v[24:27]
v_exp_f32 v47, v47
v_mfma_f32_16x16x32_bf16 v[28:31], a[0:3], a[208:211], v[92:95]
ds_read_b128 a[52:55], v1 offset:5120
v_cvt_pk_bf16_f32 v79, v46, v47
v_mfma_f32_16x16x32_bf16 v[28:31], a[4:7], a[212:215], v[28:31]
v_mul_f32 v131, v6, v131
v_mul_f32 v132, v6, v132
v_mfma_f32_16x16x32_bf16 v[28:31], a[8:11], a[216:219], v[28:31]
ds_read_b128 a[56:59], v1 offset:6144
v_mul_f32 v133, v6, v133
v_mfma_f32_16x16x32_bf16 v[28:31], a[12:15], a[220:223], v[28:31]
s_waitcnt lgkmcnt(7)
v_exp_f32 v24, v24
v_mfma_f32_16x16x32_bf16 v[40:43], a[16:19], a[192:195], v[88:91]
buffer_load_dwordx4 v3, s[48:51], s32 offen offset:3072 sc1 lds
v_mfma_f32_16x16x32_bf16 v[40:43], a[20:23], a[196:199], v[40:43]
ds_read_b128 a[60:63], v1 offset:7168
v_mul_f32 v134, v6, v134
v_mfma_f32_16x16x32_bf16 v[40:43], a[24:27], a[200:203], v[40:43]
s_add_u32 s32, s32, 0x8000
v_exp_f32 v25, v25
v_mfma_f32_16x16x32_bf16 v[40:43], a[28:31], a[204:207], v[40:43]
v_exp_f32 v26, v26
v_mfma_f32_16x16x32_bf16 v[44:47], a[16:19], a[208:211], v[92:95]
v_exp_f32 v27, v27
v_mfma_f32_16x16x32_bf16 v[44:47], a[20:23], a[212:215], v[44:47]
v_exp_f32 v28, v28
v_mfma_f32_16x16x32_bf16 v[44:47], a[24:27], a[216:219], v[44:47]
v_exp_f32 v29, v29
v_mfma_f32_16x16x32_bf16 v[44:47], a[28:31], a[220:223], v[44:47]
s_waitcnt lgkmcnt(0)
v_mul_f32 v135, v6, v135
v_cvt_pk_bf16_f32 v128, v128, v129
v_mfma_f32_16x16x32_bf16 v[192:195], a[32:35], v[72:75], v[192:195]
s_add_u32 m0, s27, 0x1000
v_exp_f32 v30, v30
v_mfma_f32_16x16x32_bf16 v[224:227], a[32:35], v[76:79], v[224:227]
buffer_load_dwordx4 v3, s[48:51], s7 offen offset:0 sc1 lds
v_mfma_f32_16x16x32_bf16 v[228:231], a[36:39], v[76:79], v[228:231]
v_exp_f32 v31, v31
v_mfma_f32_16x16x32_bf16 v[196:199], a[36:39], v[72:75], v[196:199]
ds_read_b128 a[0:3], v1 offset:24576
v_cvt_pk_bf16_f32 v56, v24, v25
v_mfma_f32_16x16x32_bf16 v[200:203], a[40:43], v[72:75], v[200:203]
ds_read_b128 a[4:7], v1 offset:25600
v_cvt_pk_bf16_f32 v57, v26, v27
v_mfma_f32_16x16x32_bf16 v[232:235], a[40:43], v[76:79], v[232:235]
v_exp_f32 v40, v40
v_mfma_f32_16x16x32_bf16 v[236:239], a[44:47], v[76:79], v[236:239]
ds_read_b128 a[8:11], v1 offset:26624
v_cvt_pk_bf16_f32 v60, v28, v29
v_mfma_f32_16x16x32_bf16 v[204:207], a[44:47], v[72:75], v[204:207]
v_exp_f32 v41, v41
v_mfma_f32_16x16x32_bf16 v[208:211], a[48:51], v[72:75], v[208:211]
ds_read_b128 a[12:15], v1 offset:27648
v_cvt_pk_bf16_f32 v61, v30, v31
v_mfma_f32_16x16x32_bf16 v[240:243], a[48:51], v[76:79], v[240:243]
ds_read_b128 a[16:19], v1 offset:28672
v_cvt_pk_bf16_f32 v58, v40, v41
v_mfma_f32_16x16x32_bf16 v[244:247], a[52:55], v[76:79], v[244:247]
v_exp_f32 v42, v42
v_mfma_f32_16x16x32_bf16 v[212:215], a[52:55], v[72:75], v[212:215]
buffer_load_dwordx4 v3, s[48:51], s7 offen offset:1024 sc1 lds
v_mfma_f32_16x16x32_bf16 v[216:219], a[56:59], v[72:75], v[216:219]
ds_read_b128 a[20:23], v1 offset:29696
v_cvt_pk_bf16_f32 v129, v130, v131
v_mfma_f32_16x16x32_bf16 v[248:251], a[56:59], v[76:79], v[248:251]
ds_read_b128 a[24:27], v1 offset:30720
v_cvt_pk_bf16_f32 v130, v132, v133
v_mfma_f32_16x16x32_bf16 v[252:255], a[60:63], v[76:79], v[252:255]
ds_read_b128 a[28:31], v1 offset:31744
v_cvt_pk_bf16_f32 v131, v134, v135
v_mfma_f32_16x16x32_bf16 v[220:223], a[60:63], v[72:75], v[220:223]
s_waitcnt lgkmcnt(4)
v_exp_f32 v43, v43
v_smfmac_f32_16x16x64_bf16 a[228:231], a[232:235], v[72:79], v9
ds_read_b128 a[32:35], v1 offset:16384
v_cvt_pk_bf16_f32 v59, v42, v43
v_mfma_f32_16x16x32_bf16 v[24:27], a[0:3], a[192:195], v[88:91]
ds_read_b128 a[36:39], v1 offset:17408
buffer_store_dwordx4 v[128:131], v3, s[88:91], s8 offen sc1
v_mfma_f32_16x16x32_bf16 v[24:27], a[4:7], a[196:199], v[24:27]
buffer_load_dwordx4 v3, s[48:51], s7 offen offset:2048 sc1 lds
v_mfma_f32_16x16x32_bf16 v[24:27], a[8:11], a[200:203], v[24:27]
ds_read_b128 a[40:43], v1 offset:18432
v_exp_f32 v44, v44
v_mfma_f32_16x16x32_bf16 v[24:27], a[12:15], a[204:207], v[24:27]
ds_read_b128 a[44:47], v1 offset:19456
v_exp_f32 v45, v45
v_mfma_f32_16x16x32_bf16 v[28:31], a[0:3], a[208:211], v[92:95]
ds_read_b128 a[48:51], v1 offset:20480
v_exp_f32 v46, v46
v_mfma_f32_16x16x32_bf16 v[28:31], a[4:7], a[212:215], v[28:31]
s_waitcnt lgkmcnt(5)
v_exp_f32 v47, v47
v_mfma_f32_16x16x32_bf16 v[28:31], a[8:11], a[216:219], v[28:31]
ds_read_b128 a[52:55], v1 offset:21504
v_cvt_pk_bf16_f32 v62, v44, v45
v_mfma_f32_16x16x32_bf16 v[28:31], a[12:15], a[220:223], v[28:31]
ds_read_b128 a[56:59], v1 offset:22528
v_cvt_pk_bf16_f32 v63, v46, v47
v_mfma_f32_16x16x32_bf16 v[40:43], a[16:19], a[192:195], v[88:91]
ds_read_b128 a[60:63], v1 offset:23552
v_xor_b32 v1, 0x8000, v1
v_mfma_f32_16x16x32_bf16 v[40:43], a[20:23], a[196:199], v[40:43]
buffer_load_dwordx4 v3, s[48:51], s7 offen offset:3072 sc1 lds
v_mfma_f32_16x16x32_bf16 v[40:43], a[24:27], a[200:203], v[40:43]
s_add_u32 s7, s7, 0x8000
v_exp_f32 v24, v24
v_mfma_f32_16x16x32_bf16 v[40:43], a[28:31], a[204:207], v[40:43]
s_xor_b32 s27, s27, 0x38000
v_exp_f32 v25, v25
v_mfma_f32_16x16x32_bf16 v[44:47], a[16:19], a[208:211], v[92:95]
s_add_u32 s8, s28, 0x2000
v_exp_f32 v26, v26
v_mfma_f32_16x16x32_bf16 v[44:47], a[20:23], a[212:215], v[44:47]
v_exp_f32 v27, v27
v_mfma_f32_16x16x32_bf16 v[44:47], a[24:27], a[216:219], v[44:47]
s_waitcnt vmcnt(19) lgkmcnt(0)
v_exp_f32 v28, v28
v_mfma_f32_16x16x32_bf16 v[44:47], a[28:31], a[220:223], v[44:47]
s_barrier
v_exp_f32 v29, v29
v_mul_f32 v136, v6, v136
v_mul_f32 v137, v6, v137
v_mul_f32 v138, v6, v138
v_mul_f32 v139, v6, v139
v_mul_f32 v140, v6, v140
v_mul_f32 v141, v6, v141
v_mul_f32 v142, v6, v142
v_mul_f32 v143, v6, v143
v_cvt_pk_bf16_f32 v136, v136, v137
v_cvt_pk_bf16_f32 v137, v138, v139
v_cvt_pk_bf16_f32 v138, v140, v141
v_cvt_pk_bf16_f32 v139, v142, v143
buffer_store_dwordx4 v[136:139], v3, s[88:91], s8 offen sc1
s_add_u32 s8, s28, 0x4000
v_mul_f32 v144, v6, v144
v_mul_f32 v145, v6, v145
v_mul_f32 v146, v6, v146
v_mul_f32 v147, v6, v147
v_mul_f32 v148, v6, v148
v_mul_f32 v149, v6, v149
v_mul_f32 v150, v6, v150
v_mul_f32 v151, v6, v151
v_cvt_pk_bf16_f32 v144, v144, v145
v_cvt_pk_bf16_f32 v145, v146, v147
v_cvt_pk_bf16_f32 v146, v148, v149
v_cvt_pk_bf16_f32 v147, v150, v151
buffer_store_dwordx4 v[144:147], v3, s[88:91], s8 offen sc1
s_add_u32 s8, s28, 0x6000
v_mul_f32 v152, v6, v152
v_mul_f32 v153, v6, v153
v_mul_f32 v154, v6, v154
v_mul_f32 v155, v6, v155
v_mul_f32 v156, v6, v156
v_mul_f32 v157, v6, v157
v_mul_f32 v158, v6, v158
v_mul_f32 v159, v6, v159
v_cvt_pk_bf16_f32 v152, v152, v153
v_cvt_pk_bf16_f32 v153, v154, v155
v_cvt_pk_bf16_f32 v154, v156, v157
v_cvt_pk_bf16_f32 v155, v158, v159
buffer_store_dwordx4 v[152:155], v3, s[88:91], s8 offen sc1
v_accvgpr_read_b32 v6, a226
v_accvgpr_read_b32 v7, a227
v_add_f32 v6, v6, v7
v_cmp_nge_f32 vcc, 0x6f800000, v6
v_rcp_f32 v6, v6
s_or_b64 s[34:35], s[34:35], vcc
s_add_u32 s8, s29, 0x0
v_pk_mul_f32 v[160:161], v[160:161], v[6:7] op_sel_hi:[1,0]
v_pk_mul_f32 v[162:163], v[162:163], v[6:7] op_sel_hi:[1,0]
v_pk_mul_f32 v[164:165], v[164:165], v[6:7] op_sel_hi:[1,0]
v_pk_mul_f32 v[166:167], v[166:167], v[6:7] op_sel_hi:[1,0]
v_cvt_pk_bf16_f32 v160, v160, v161
v_cvt_pk_bf16_f32 v161, v162, v163
v_cvt_pk_bf16_f32 v162, v164, v165
v_cvt_pk_bf16_f32 v163, v166, v167
buffer_store_dwordx4 v[160:163], v3, s[88:91], s8 offen sc1
s_add_u32 s8, s29, 0x2000
v_pk_mul_f32 v[168:169], v[168:169], v[6:7] op_sel_hi:[1,0]
v_pk_mul_f32 v[170:171], v[170:171], v[6:7] op_sel_hi:[1,0]
v_pk_mul_f32 v[172:173], v[172:173], v[6:7] op_sel_hi:[1,0]
v_pk_mul_f32 v[174:175], v[174:175], v[6:7] op_sel_hi:[1,0]
v_cvt_pk_bf16_f32 v168, v168, v169
v_cvt_pk_bf16_f32 v169, v170, v171
v_cvt_pk_bf16_f32 v170, v172, v173
v_cvt_pk_bf16_f32 v171, v174, v175
buffer_store_dwordx4 v[168:171], v3, s[88:91], s8 offen sc1
s_add_u32 s8, s29, 0x4000
v_pk_mul_f32 v[176:177], v[176:177], v[6:7] op_sel_hi:[1,0]
v_pk_mul_f32 v[178:179], v[178:179], v[6:7] op_sel_hi:[1,0]
v_pk_mul_f32 v[180:181], v[180:181], v[6:7] op_sel_hi:[1,0]
v_pk_mul_f32 v[182:183], v[182:183], v[6:7] op_sel_hi:[1,0]
v_cvt_pk_bf16_f32 v176, v176, v177
v_cvt_pk_bf16_f32 v177, v178, v179
v_cvt_pk_bf16_f32 v178, v180, v181
v_cvt_pk_bf16_f32 v179, v182, v183
buffer_store_dwordx4 v[176:179], v3, s[88:91], s8 offen sc1
s_add_u32 s8, s29, 0x6000
v_pk_mul_f32 v[184:185], v[184:185], v[6:7] op_sel_hi:[1,0]
v_pk_mul_f32 v[186:187], v[186:187], v[6:7] op_sel_hi:[1,0]
v_pk_mul_f32 v[188:189], v[188:189], v[6:7] op_sel_hi:[1,0]
v_pk_mul_f32 v[190:191], v[190:191], v[6:7] op_sel_hi:[1,0]
v_cvt_pk_bf16_f32 v184, v184, v185
v_cvt_pk_bf16_f32 v185, v186, v187
v_cvt_pk_bf16_f32 v186, v188, v189
v_cvt_pk_bf16_f32 v187, v190, v191
buffer_store_dwordx4 v[184:187], v3, s[88:91], s8 offen sc1
s_getreg_b32 s8, hwreg(HW_REG_HW_ID, 5, 1)
s_cmp_lg_u32 s8, 0
s_cbranch_scc1 L_att_sodd1
s_branch L_att_sodd0
L_att_lh0_1:
v_mfma_f32_16x16x32_bf16 v[160:163], a[32:35], v[52:55], v[160:163]
ds_read_b128 a[0:3], v1 offset:8192
v_cvt_pk_bf16_f32 v72, v24, v25
v_mfma_f32_16x16x32_bf16 v[192:195], a[32:35], v[56:59], v[192:195]
v_exp_f32 v30, v30
v_mfma_f32_16x16x32_bf16 v[224:227], a[32:35], v[60:63], v[224:227]
buffer_load_dword v14, v15, s[84:87], 0 offen offset:192 sc1
v_mfma_f32_16x16x32_bf16 v[228:231], a[36:39], v[60:63], v[228:231]
ds_read_b128 a[4:7], v1 offset:9216
v_cvt_pk_bf16_f32 v73, v26, v27
v_mfma_f32_16x16x32_bf16 v[196:199], a[36:39], v[56:59], v[196:199]
ds_read_b128 a[8:11], v1 offset:10240
v_cvt_pk_bf16_f32 v76, v28, v29
v_mfma_f32_16x16x32_bf16 v[164:167], a[36:39], v[52:55], v[164:167]
s_add_u32 m0, s17, 0x10000
v_exp_f32 v31, v31
v_mfma_f32_16x16x32_bf16 v[168:171], a[40:43], v[52:55], v[168:171]
buffer_load_dwordx4 v12, s[72:75], 0 offen lds
v_mfma_f32_16x16x32_bf16 v[200:203], a[40:43], v[56:59], v[200:203]
ds_read_b128 a[12:15], v1 offset:11264
v_cvt_pk_bf16_f32 v77, v30, v31
v_mfma_f32_16x16x32_bf16 v[232:235], a[40:43], v[60:63], v[232:235]
v_exp_f32 v40, v40
v_mfma_f32_16x16x32_bf16 v[236:239], a[44:47], v[60:63], v[236:239]
ds_read_b128 a[16:19], v1 offset:12288
v_mfma_f32_16x16x32_bf16 v[204:207], a[44:47], v[56:59], v[204:207]
v_exp_f32 v41, v41
v_mfma_f32_16x16x32_bf16 v[172:175], a[44:47], v[52:55], v[172:175]
buffer_load_dwordx4 v13, s[72:75], 0 offen offset:1024 lds
v_mfma_f32_16x16x32_bf16 v[176:179], a[48:51], v[52:55], v[176:179]
ds_read_b128 a[20:23], v1 offset:13312
v_cvt_pk_bf16_f32 v74, v40, v41
v_mfma_f32_16x16x32_bf16 v[208:211], a[48:51], v[56:59], v[208:211]
ds_read_b128 a[24:27], v1 offset:14336
v_mfma_f32_16x16x32_bf16 v[240:243], a[48:51], v[60:63], v[240:243]
v_exp_f32 v42, v42
v_mfma_f32_16x16x32_bf16 v[244:247], a[52:55], v[60:63], v[244:247]
buffer_load_dwordx4 v12, s[72:75], s12 offen offset:2048 lds
v_mfma_f32_16x16x32_bf16 v[212:215], a[52:55], v[56:59], v[212:215]
ds_read_b128 a[28:31], v1 offset:15360
v_mfma_f32_16x16x32_bf16 v[180:183], a[52:55], v[52:55], v[180:183]
v_exp_f32 v43, v43
v_mfma_f32_16x16x32_bf16 v[184:187], a[56:59], v[52:55], v[184:187]
ds_read_b128 a[32:35], v1 offset:0
v_cvt_pk_bf16_f32 v75, v42, v43
v_mfma_f32_16x16x32_bf16 v[216:219], a[56:59], v[56:59], v[216:219]
v_exp_f32 v44, v44
v_mfma_f32_16x16x32_bf16 v[248:251], a[56:59], v[60:63], v[248:251]
buffer_load_dwordx4 v13, s[72:75], s12 offen offset:3072 lds
v_mfma_f32_16x16x32_bf16 v[252:255], a[60:63], v[60:63], v[252:255]
ds_read_b128 a[36:39], v1 offset:1024
v_mfma_f32_16x16x32_bf16 v[220:223], a[60:63], v[56:59], v[220:223]
s_add_u32 m0, s17, 0x14000
v_exp_f32 v45, v45
v_mfma_f32_16x16x32_bf16 v[188:191], a[60:63], v[52:55], v[188:191]
ds_read_b128 a[40:43], v1 offset:2048
v_add_u32 v12, 0x20000, v12
v_mfma_f32_16x16x32_bf16 a[224:227], a[236:239], v[52:55], a[224:227]
buffer_load_dwordx4 v12, s[72:75], 0 offen lds
v_smfmac_f32_16x16x64_bf16 a[228:231], a[232:235], v[56:63], v9
ds_read_b128 a[44:47], v1 offset:3072
s_waitcnt lgkmcnt(8)
v_mfma_f32_16x16x32_bf16 v[24:27], a[0:3], a[192:195], v[88:91]
v_exp_f32 v46, v46
v_mfma_f32_16x16x32_bf16 v[24:27], a[4:7], a[196:199], v[24:27]
ds_read_b128 a[48:51], v1 offset:4096
v_add_u32 v13, 0x20000, v13
v_mfma_f32_16x16x32_bf16 v[24:27], a[8:11], a[200:203], v[24:27]
buffer_load_dwordx4 v13, s[72:75], 0 offen offset:1024 lds
v_mfma_f32_16x16x32_bf16 v[24:27], a[12:15], a[204:207], v[24:27]
v_exp_f32 v47, v47
v_mfma_f32_16x16x32_bf16 v[28:31], a[0:3], a[208:211], v[92:95]
ds_read_b128 a[52:55], v1 offset:5120
v_cvt_pk_bf16_f32 v78, v44, v45
v_mfma_f32_16x16x32_bf16 v[28:31], a[4:7], a[212:215], v[28:31]
s_waitcnt lgkmcnt(6)
v_cvt_pk_bf16_f32 v79, v46, v47
v_mfma_f32_16x16x32_bf16 v[28:31], a[8:11], a[216:219], v[28:31]
ds_read_b128 a[56:59], v1 offset:6144
v_mfma_f32_16x16x32_bf16 v[28:31], a[12:15], a[220:223], v[28:31]
buffer_load_dwordx4 v12, s[72:75], s12 offen offset:2048 lds
v_mfma_f32_16x16x32_bf16 v[40:43], a[16:19], a[192:195], v[88:91]
ds_read_b128 a[60:63], v1 offset:7168
v_mfma_f32_16x16x32_bf16 v[40:43], a[20:23], a[196:199], v[40:43]
v_exp_f32 v24, v24
v_mfma_f32_16x16x32_bf16 v[40:43], a[24:27], a[200:203], v[40:43]
v_exp_f32 v25, v25
v_mfma_f32_16x16x32_bf16 v[40:43], a[28:31], a[204:207], v[40:43]
buffer_load_dwordx4 v13, s[72:75], s12 offen offset:3072 lds
v_mfma_f32_16x16x32_bf16 v[44:47], a[16:19], a[208:211], v[92:95]
v_exp_f32 v26, v26
v_mfma_f32_16x16x32_bf16 v[44:47], a[20:23], a[212:215], v[44:47]
v_exp_f32 v27, v27
v_mfma_f32_16x16x32_bf16 v[44:47], a[24:27], a[216:219], v[44:47]
v_exp_f32 v28, v28
v_mfma_f32_16x16x32_bf16 v[44:47], a[28:31], a[220:223], v[44:47]
s_waitcnt lgkmcnt(0)
v_exp_f32 v29, v29
v_mfma_f32_16x16x32_bf16 v[192:195], a[32:35], v[72:75], v[192:195]
s_add_u32 m0, s16, 0x0
v_add_u32 v12, 0x20000, v12
v_cvt_pk_bf16_f32 v56, v24, v25
v_mfma_f32_16x16x32_bf16 v[224:227], a[32:35], v[76:79], v[224:227]
buffer_load_dwordx4 v12, s[72:75], 0 offen lds
v_mfma_f32_16x16x32_bf16 v[228:231], a[36:39], v[76:79], v[228:231]
ds_read_b128 a[0:3], v1 offset:24576
v_cvt_pk_bf16_f32 v57, v26, v27
v_mfma_f32_16x16x32_bf16 v[196:199], a[36:39], v[72:75], v[196:199]
v_exp_f32 v30, v30
v_mfma_f32_16x16x32_bf16 v[200:203], a[40:43], v[72:75], v[200:203]
ds_read_b128 a[4:7], v1 offset:25600
v_cvt_pk_bf16_f32 v60, v28, v29
v_mfma_f32_16x16x32_bf16 v[232:235], a[40:43], v[76:79], v[232:235]
ds_read_b128 a[8:11], v1 offset:26624
v_add_u32 v13, 0x20000, v13
v_mfma_f32_16x16x32_bf16 v[236:239], a[44:47], v[76:79], v[236:239]
buffer_load_dwordx4 v13, s[72:75], 0 offen offset:1024 lds
v_mfma_f32_16x16x32_bf16 v[204:207], a[44:47], v[72:75], v[204:207]
ds_read_b128 a[12:15], v1 offset:27648
v_exp_f32 v31, v31
v_mfma_f32_16x16x32_bf16 v[208:211], a[48:51], v[72:75], v[208:211]
buffer_load_dwordx4 v12, s[72:75], s12 offen offset:2048 lds
v_mfma_f32_16x16x32_bf16 v[240:243], a[48:51], v[76:79], v[240:243]
ds_read_b128 a[16:19], v1 offset:28672
v_exp_f32 v40, v40
v_mfma_f32_16x16x32_bf16 v[244:247], a[52:55], v[76:79], v[244:247]
ds_read_b128 a[20:23], v1 offset:29696
v_cvt_pk_bf16_f32 v61, v30, v31
v_mfma_f32_16x16x32_bf16 v[212:215], a[52:55], v[72:75], v[212:215]
buffer_load_dwordx4 v13, s[72:75], s12 offen offset:3072 lds
v_mfma_f32_16x16x32_bf16 v[216:219], a[56:59], v[72:75], v[216:219]
ds_read_b128 a[24:27], v1 offset:30720
v_exp_f32 v41, v41
v_mfma_f32_16x16x32_bf16 v[248:251], a[56:59], v[76:79], v[248:251]
ds_read_b128 a[28:31], v1 offset:31744
v_exp_f32 v42, v42
v_mfma_f32_16x16x32_bf16 v[252:255], a[60:63], v[76:79], v[252:255]
ds_read_b128 a[32:35], v1 offset:16384
v_cvt_pk_bf16_f32 v58, v40, v41
v_mfma_f32_16x16x32_bf16 v[220:223], a[60:63], v[72:75], v[220:223]
s_waitcnt lgkmcnt(5)
v_exp_f32 v43, v43
v_smfmac_f32_16x16x64_bf16 a[228:231], a[232:235], v[72:79], v9
ds_read_b128 a[36:39], v1 offset:17408
v_add_u32 v12, 0x20000, v12
v_mfma_f32_16x16x32_bf16 v[24:27], a[0:3], a[192:195], v[112:115]
s_add_u32 m0, s16, 0x4000
v_exp_f32 v44, v44
v_mfma_f32_16x16x32_bf16 v[24:27], a[4:7], a[196:199], v[24:27]
buffer_load_dwordx4 v12, s[72:75], 0 offen lds
v_mfma_f32_16x16x32_bf16 v[24:27], a[8:11], a[200:203], v[24:27]
ds_read_b128 a[40:43], v1 offset:18432
v_add_u32 v13, 0x20000, v13
v_mfma_f32_16x16x32_bf16 v[24:27], a[12:15], a[204:207], v[24:27]
buffer_load_dwordx4 v13, s[72:75], 0 offen offset:1024 lds
v_mfma_f32_16x16x32_bf16 v[28:31], a[0:3], a[208:211], v[92:95]
ds_read_b128 a[44:47], v1 offset:19456
v_cvt_pk_bf16_f32 v59, v42, v43
v_mfma_f32_16x16x32_bf16 v[28:31], a[4:7], a[212:215], v[28:31]
ds_read_b128 a[48:51], v1 offset:20480
v_exp_f32 v45, v45
v_mfma_f32_16x16x32_bf16 v[28:31], a[8:11], a[216:219], v[28:31]
s_waitcnt lgkmcnt(5)
v_exp_f32 v46, v46
v_mfma_f32_16x16x32_bf16 v[28:31], a[12:15], a[220:223], v[28:31]
buffer_load_dwordx4 v12, s[72:75], s12 offen offset:2048 lds
v_mfma_f32_16x16x32_bf16 v[40:43], a[16:19], a[192:195], v[116:119]
ds_read_b128 a[52:55], v1 offset:21504
v_exp_f32 v47, v47
v_mfma_f32_16x16x32_bf16 v[40:43], a[20:23], a[196:199], v[40:43]
ds_read_b128 a[56:59], v1 offset:22528
v_exp_f32 v24, v24
v_mfma_f32_16x16x32_bf16 v[40:43], a[24:27], a[200:203], v[40:43]
ds_read_b128 a[60:63], v1 offset:23552
v_xor_b32 v1, 0x8000, v1
v_mfma_f32_16x16x32_bf16 v[40:43], a[28:31], a[204:207], v[40:43]
v_exp_f32 v25, v25
v_cvt_pk_bf16_f32 v62, v44, v45
v_cvt_pk_bf16_f32 v63, v46, v47
v_mfma_f32_16x16x32_bf16 v[44:47], a[16:19], a[208:211], v[92:95]
v_exp_f32 v26, v26
v_mfma_f32_16x16x32_bf16 v[44:47], a[20:23], a[212:215], v[44:47]
buffer_load_dwordx4 v13, s[72:75], s12 offen offset:3072 lds
v_mfma_f32_16x16x32_bf16 v[44:47], a[24:27], a[216:219], v[44:47]
v_exp_f32 v27, v27
v_mfma_f32_16x16x32_bf16 v[44:47], a[28:31], a[220:223], v[44:47]
v_exp_f32 v28, v28
v_exp_f32 v29, v29
v_accvgpr_read_b32 v6, a224
v_accvgpr_read_b32 v7, a225
v_add_f32 v6, v6, v7
v_cmp_nge_f32 vcc, 0x6f800000, v6
v_rcp_f32 v6, v6
s_or_b64 s[34:35], s[34:35], vcc
s_add_u32 s8, s28, 0x0
v_pk_mul_f32 v[128:129], v[128:129], v[6:7] op_sel_hi:[1,0]
v_pk_mul_f32 v[130:131], v[130:131], v[6:7] op_sel_hi:[1,0]
v_pk_mul_f32 v[132:133], v[132:133], v[6:7] op_sel_hi:[1,0]
v_pk_mul_f32 v[134:135], v[134:135], v[6:7] op_sel_hi:[1,0]
v_cvt_pk_bf16_f32 v128, v128, v129
v_cvt_pk_bf16_f32 v129, v130, v131
v_cvt_pk_bf16_f32 v130, v132, v133
v_cvt_pk_bf16_f32 v131, v134, v135
buffer_store_dwordx4 v[128:131], v3, s[88:91], s8 offen sc1
s_add_u32 s8, s28, 0x2000
v_pk_mul_f32 v[136:137], v[136:137], v[6:7] op_sel_hi:[1,0]
v_pk_mul_f32 v[138:139], v[138:139], v[6:7] op_sel_hi:[1,0]
v_pk_mul_f32 v[140:141], v[140:141], v[6:7] op_sel_hi:[1,0]
v_pk_mul_f32 v[142:143], v[142:143], v[6:7] op_sel_hi:[1,0]
v_cvt_pk_bf16_f32 v136, v136, v137
v_cvt_pk_bf16_f32 v137, v138, v139
v_cvt_pk_bf16_f32 v138, v140, v141
v_cvt_pk_bf16_f32 v139, v142, v143
buffer_store_dwordx4 v[136:139], v3, s[88:91], s8 offen sc1
s_add_u32 s8, s28, 0x4000
v_pk_mul_f32 v[144:145], v[144:145], v[6:7] op_sel_hi:[1,0]
v_pk_mul_f32 v[146:147], v[146:147], v[6:7] op_sel_hi:[1,0]
v_pk_mul_f32 v[148:149], v[148:149], v[6:7] op_sel_hi:[1,0]
v_pk_mul_f32 v[150:151], v[150:151], v[6:7] op_sel_hi:[1,0]
v_cvt_pk_bf16_f32 v144, v144, v145
v_cvt_pk_bf16_f32 v145, v146, v147
v_cvt_pk_bf16_f32 v146, v148, v149
v_cvt_pk_bf16_f32 v147, v150, v151
buffer_store_dwordx4 v[144:147], v3, s[88:91], s8 offen sc1
s_add_u32 s8, s28, 0x6000
v_pk_mul_f32 v[152:153], v[152:153], v[6:7] op_sel_hi:[1,0]
v_pk_mul_f32 v[154:155], v[154:155], v[6:7] op_sel_hi:[1,0]
v_pk_mul_f32 v[156:157], v[156:157], v[6:7] op_sel_hi:[1,0]
v_pk_mul_f32 v[158:159], v[158:159], v[6:7] op_sel_hi:[1,0]
v_cvt_pk_bf16_f32 v152, v152, v153
v_cvt_pk_bf16_f32 v153, v154, v155
v_cvt_pk_bf16_f32 v154, v156, v157
v_cvt_pk_bf16_f32 v155, v158, v159
buffer_store_dwordx4 v[152:155], v3, s[88:91], s8 offen sc1
v_accvgpr_read_b32 v6, a226
v_accvgpr_read_b32 v7, a227
v_add_f32 v6, v6, v7
v_cmp_nge_f32 vcc, 0x6f800000, v6
v_rcp_f32 v6, v6
s_or_b64 s[34:35], s[34:35], vcc
s_add_u32 s8, s29, 0x0
v_pk_mul_f32 v[160:161], v[160:161], v[6:7] op_sel_hi:[1,0]
v_pk_mul_f32 v[162:163], v[162:163], v[6:7] op_sel_hi:[1,0]
v_pk_mul_f32 v[164:165], v[164:165], v[6:7] op_sel_hi:[1,0]
v_pk_mul_f32 v[166:167], v[166:167], v[6:7] op_sel_hi:[1,0]
v_cvt_pk_bf16_f32 v160, v160, v161
v_cvt_pk_bf16_f32 v161, v162, v163
v_cvt_pk_bf16_f32 v162, v164, v165
v_cvt_pk_bf16_f32 v163, v166, v167
buffer_store_dwordx4 v[160:163], v3, s[88:91], s8 offen sc1
s_add_u32 s8, s29, 0x2000
v_pk_mul_f32 v[168:169], v[168:169], v[6:7] op_sel_hi:[1,0]
v_pk_mul_f32 v[170:171], v[170:171], v[6:7] op_sel_hi:[1,0]
v_pk_mul_f32 v[172:173], v[172:173], v[6:7] op_sel_hi:[1,0]
v_pk_mul_f32 v[174:175], v[174:175], v[6:7] op_sel_hi:[1,0]
v_cvt_pk_bf16_f32 v168, v168, v169
v_cvt_pk_bf16_f32 v169, v170, v171
v_cvt_pk_bf16_f32 v170, v172, v173
v_cvt_pk_bf16_f32 v171, v174, v175
buffer_store_dwordx4 v[168:171], v3, s[88:91], s8 offen sc1
s_add_u32 s8, s29, 0x4000
v_pk_mul_f32 v[176:177], v[176:177], v[6:7] op_sel_hi:[1,0]
v_pk_mul_f32 v[178:179], v[178:179], v[6:7] op_sel_hi:[1,0]
v_pk_mul_f32 v[180:181], v[180:181], v[6:7] op_sel_hi:[1,0]
v_pk_mul_f32 v[182:183], v[182:183], v[6:7] op_sel_hi:[1,0]
v_cvt_pk_bf16_f32 v176, v176, v177
v_cvt_pk_bf16_f32 v177, v178, v179
v_cvt_pk_bf16_f32 v178, v180, v181
v_cvt_pk_bf16_f32 v179, v182, v183
buffer_store_dwordx4 v[176:179], v3, s[88:91], s8 offen sc1
s_add_u32 s8, s29, 0x6000
v_pk_mul_f32 v[184:185], v[184:185], v[6:7] op_sel_hi:[1,0]
v_pk_mul_f32 v[186:187], v[186:187], v[6:7] op_sel_hi:[1,0]
v_pk_mul_f32 v[188:189], v[188:189], v[6:7] op_sel_hi:[1,0]
v_pk_mul_f32 v[190:191], v[190:191], v[6:7] op_sel_hi:[1,0]
v_cvt_pk_bf16_f32 v184, v184, v185
v_cvt_pk_bf16_f32 v185, v186, v187
v_cvt_pk_bf16_f32 v186, v188, v189
v_cvt_pk_bf16_f32 v187, v190, v191
buffer_store_dwordx4 v[184:187], v3, s[88:91], s8 offen sc1
s_branch L_att_h1_1
L_att_j0:
s_cmp_ge_u32 s4, 2
s_cbranch_scc1 L_att_nl0_1
L_att_nl0_0:
v_mfma_f32_16x16x32_bf16 v[16:19], a[0:3], a[160:163], v[96:99]
ds_read_b128 a[128:131], v1 offset:24576
v_mov_b32 v240, 0
v_mfma_f32_16x16x32_bf16 v[16:19], a[4:7], a[164:167], v[16:19]
ds_read_b128 a[132:135], v1 offset:25600
s_add_u32 m0, s27, 0x0
v_mfma_f32_16x16x32_bf16 v[16:19], a[8:11], a[168:171], v[16:19]
buffer_load_dwordx4 v3, s[48:51], s32 offen offset:0 sc1 lds
v_mfma_f32_16x16x32_bf16 v[16:19], a[12:15], a[172:175], v[16:19]
ds_read_b128 a[136:139], v1 offset:26624
v_mov_b32 v241, 0
v_mfma_f32_16x16x32_bf16 v[20:23], a[0:3], a[176:179], v[84:87]
ds_read_b128 a[140:143], v1 offset:27648
v_mov_b32 v242, 0
v_mfma_f32_16x16x32_bf16 v[20:23], a[4:7], a[180:183], v[20:23]
ds_read_b128 a[144:147], v1 offset:28672
v_mov_b32 v243, 0
v_mfma_f32_16x16x32_bf16 v[20:23], a[8:11], a[184:187], v[20:23]
ds_read_b128 a[148:151], v1 offset:29696
v_mov_b32 v244, 0
v_mfma_f32_16x16x32_bf16 v[20:23], a[12:15], a[188:191], v[20:23]
buffer_load_dwordx4 v3, s[48:51], s32 offen offset:1024 sc1 lds
v_mfma_f32_16x16x32_bf16 v[24:27], a[0:3], a[192:195], v[88:91]
ds_read_b128 a[152:155], v1 offset:30720
v_mov_b32 v245, 0
v_mfma_f32_16x16x32_bf16 v[24:27], a[4:7], a[196:199], v[24:27]
ds_read_b128 a[156:159], v1 offset:31744
v_exp_f32 v16, v16
v_mfma_f32_16x16x32_bf16 v[24:27], a[8:11], a[200:203], v[24:27]
v_exp_f32 v17, v17
v_mfma_f32_16x16x32_bf16 v[24:27], a[12:15], a[204:207], v[24:27]
v_exp_f32 v18, v18
v_mfma_f32_16x16x32_bf16 v[28:31], a[0:3], a[208:211], v[92:95]
buffer_load_dwordx4 v3, s[48:51], s32 offen offset:2048 sc1 lds
v_mfma_f32_16x16x32_bf16 v[28:31], a[4:7], a[212:215], v[28:31]
v_exp_f32 v19, v19
v_mfma_f32_16x16x32_bf16 v[28:31], a[8:11], a[216:219], v[28:31]
v_exp_f32 v20, v20
v_mfma_f32_16x16x32_bf16 v[28:31], a[12:15], a[220:223], v[28:31]
v_exp_f32 v21, v21
v_mfma_f32_16x16x32_bf16 v[32:35], a[16:19], a[160:163], v[100:103]
v_exp_f32 v22, v22
v_mfma_f32_16x16x32_bf16 v[32:35], a[20:23], a[164:167], v[32:35]
buffer_load_dwordx4 v3, s[48:51], s32 offen offset:3072 sc1 lds
v_mfma_f32_16x16x32_bf16 v[32:35], a[24:27], a[168:171], v[32:35]
v_exp_f32 v23, v23
v_mfma_f32_16x16x32_bf16 v[32:35], a[28:31], a[172:175], v[32:35]
v_exp_f32 v24, v24
v_mfma_f32_16x16x32_bf16 v[36:39], a[16:19], a[176:179], v[84:87]
v_exp_f32 v25, v25
v_mfma_f32_16x16x32_bf16 v[36:39], a[20:23], a[180:183], v[36:39]
s_add_u32 m0, s27, 0x1000
v_exp_f32 v26, v26
v_mfma_f32_16x16x32_bf16 v[36:39], a[24:27], a[184:187], v[36:39]
buffer_load_dwordx4 v3, s[48:51], s7 offen offset:0 sc1 lds
v_mfma_f32_16x16x32_bf16 v[36:39], a[28:31], a[188:191], v[36:39]
v_exp_f32 v27, v27
v_mfma_f32_16x16x32_bf16 v[40:43], a[16:19], a[192:195], v[88:91]
v_exp_f32 v28, v28
v_mfma_f32_16x16x32_bf16 v[40:43], a[20:23], a[196:199], v[40:43]
v_exp_f32 v29, v29
v_mfma_f32_16x16x32_bf16 v[40:43], a[24:27], a[200:203], v[40:43]
v_exp_f32 v30, v30
v_mfma_f32_16x16x32_bf16 v[40:43], a[28:31], a[204:207], v[40:43]
buffer_load_dwordx4 v3, s[48:51], s7 offen offset:1024 sc1 lds
v_mfma_f32_16x16x32_bf16 v[44:47], a[16:19], a[208:211], v[92:95]
v_exp_f32 v31, v31
v_mfma_f32_16x16x32_bf16 v[44:47], a[20:23], a[212:215], v[44:47]
v_exp_f32 v32, v32
v_mfma_f32_16x16x32_bf16 v[44:47], a[24:27], a[216:219], v[44:47]
v_exp_f32 v33, v33
v_mfma_f32_16x16x32_bf16 v[44:47], a[28:31], a[220:223], v[44:47]
s_waitcnt lgkmcnt(0)
v_cvt_pk_bf16_f32 v48, v16, v17
v_cvt_pk_bf16_f32 v49, v18, v19
v_cvt_pk_bf16_f32 v52, v20, v21
v_cvt_pk_bf16_f32 v53, v22, v23
v_cvt_pk_bf16_f32 v56, v24, v25
v_cvt_pk_bf16_f32 v57, v26, v27
v_mov_b32 v246, 0
v_mov_b32 v247, 0
v_mfma_f32_16x16x32_bf16 v[20:23], a[128:131], a[176:179], v[84:87]
ds_read_b128 a[32:35], v1 offset:16384
v_cvt_pk_bf16_f32 v60, v28, v29
v_mfma_f32_16x16x32_bf16 v[20:23], a[132:135], a[180:183], v[20:23]
buffer_load_dwordx4 v3, s[48:51], s7 offen offset:2048 sc1 lds
v_mfma_f32_16x16x32_bf16 v[20:23], a[136:139], a[184:187], v[20:23]
v_exp_f32 v34, v34
v_mfma_f32_16x16x32_bf16 v[20:23], a[140:143], a[188:191], v[20:23]
buffer_load_dwordx4 v3, s[48:51], s7 offen offset:3072 sc1 lds
v_mfma_f32_16x16x32_bf16 v[24:27], a[128:131], a[192:195], v[88:91]
ds_read_b128 a[36:39], v1 offset:17408
v_cvt_pk_bf16_f32 v61, v30, v31
v_mfma_f32_16x16x32_bf16 v[24:27], a[132:135], a[196:199], v[24:27]
ds_read_b128 a[40:43], v1 offset:18432
v_cvt_pk_bf16_f32 v50, v32, v33
v_mfma_f32_16x16x32_bf16 v[24:27], a[136:139], a[200:203], v[24:27]
s_mov_b32 s9, 0x0
v_exp_f32 v35, v35
v_mfma_f32_16x16x32_bf16 v[24:27], a[140:143], a[204:207], v[24:27]
ds_read_b128 a[44:47], v1 offset:19456
v_cvt_pk_bf16_f32 v51, v34, v35
v_mfma_f32_16x16x32_bf16 v[28:31], a[128:131], a[208:211], v[92:95]
ds_read_b128 a[48:51], v1 offset:20480
v_exp_f32 v36, v36
v_mfma_f32_16x16x32_bf16 v[28:31], a[132:135], a[212:215], v[28:31]
buffer_load_dword a244, v8, s[72:75], s9 offen
v_mfma_f32_16x16x32_bf16 v[28:31], a[136:139], a[216:219], v[28:31]
s_mov_b32 s9, 0x0
v_exp_f32 v37, v37
v_mfma_f32_16x16x32_bf16 v[28:31], a[140:143], a[220:223], v[28:31]
buffer_load_dword a244, v8, s[64:67], s9 offen
v_exp_f32 v38, v38
v_exp_f32 v39, v39
v_cvt_pk_bf16_f32 v54, v36, v37
v_cvt_pk_bf16_f32 v55, v38, v39
v_mfma_f32_16x16x32_bf16 v[36:39], a[144:147], a[176:179], v[84:87]
ds_read_b128 a[52:55], v1 offset:21504
v_exp_f32 v40, v40
v_mfma_f32_16x16x32_bf16 v[36:39], a[148:151], a[180:183], v[36:39]
s_mov_b32 s9, 0x400000
v_exp_f32 v41, v41
v_mfma_f32_16x16x32_bf16 v[36:39], a[152:155], a[184:187], v[36:39]
ds_read_b128 a[56:59], v1 offset:22528
v_cvt_pk_bf16_f32 v58, v40, v41
v_mfma_f32_16x16x32_bf16 v[36:39], a[156:159], a[188:191], v[36:39]
ds_read_b128 a[60:63], v1 offset:23552
v_xor_b32 v1, 0x8000, v1
v_exp_f32 v42, v42
v_exp_f32 v43, v43
s_nop 0
v_cvt_pk_bf16_f32 v59, v42, v43
v_mfma_f32_16x16x32_bf16 v[40:43], a[144:147], a[192:195], v[88:91]
buffer_load_dword a244, v8, s[64:67], s9 offen
v_mfma_f32_16x16x32_bf16 v[40:43], a[148:151], a[196:199], v[40:43]
s_add_u32 s32, s32, 0x8000
v_exp_f32 v44, v44
v_mfma_f32_16x16x32_bf16 v[40:43], a[152:155], a[200:203], v[40:43]
s_add_u32 s7, s7, 0x8000
v_exp_f32 v45, v45
v_mfma_f32_16x16x32_bf16 v[40:43], a[156:159], a[204:207], v[40:43]
s_xor_b32 s27, s27, 0x38000
v_exp_f32 v46, v46
v_exp_f32 v47, v47
v_cvt_pk_bf16_f32 v62, v44, v45
v_cvt_pk_bf16_f32 v63, v46, v47
v_mfma_f32_16x16x32_bf16 v[44:47], a[144:147], a[208:211], v[92:95]
v_exp_f32 v20, v20
v_mfma_f32_16x16x32_bf16 v[44:47], a[148:151], a[212:215], v[44:47]
v_exp_f32 v21, v21
v_mfma_f32_16x16x32_bf16 v[44:47], a[152:155], a[216:219], v[44:47]
s_waitcnt vmcnt(11) lgkmcnt(0)
v_exp_f32 v22, v22
v_mfma_f32_16x16x32_bf16 v[44:47], a[156:159], a[220:223], v[44:47]
s_barrier
v_cvt_pk_bf16_f32 v68, v20, v21
v_exp_f32 v23, v23
v_exp_f32 v24, v24
v_exp_f32 v25, v25
v_exp_f32 v26, v26
v_exp_f32 v27, v27
v_cvt_pk_bf16_f32 v69, v22, v23
s_cmp_lg_u32 s33, 0
s_cbranch_scc1 L_sig_bn0
s_lshl_b32 s8, s6, 2
s_add_u32 s8, s8, 192
s_cmp_lg_u32 s4, 0
s_cbranch_scc1 L_sig_bn0
v_mov_b32 v4, 1
s_mov_b64 exec, 1
buffer_atomic_add v4, off, s[84:87], s8 sc1
s_mov_b64 exec, -1
L_sig_bn0:
s_branch L_att_l1_0
L_att_nl0_1:
v_mfma_f32_16x16x32_bf16 v[16:19], a[0:3], a[160:163], v[80:83]
ds_read_b128 a[128:131], v1 offset:24576
v_mov_b32 v240, 0
v_mfma_f32_16x16x32_bf16 v[16:19], a[4:7], a[164:167], v[16:19]
ds_read_b128 a[132:135], v1 offset:25600
s_add_u32 m0, s27, 0x0
v_mfma_f32_16x16x32_bf16 v[16:19], a[8:11], a[168:171], v[16:19]
buffer_load_dwordx4 v3, s[48:51], s32 offen offset:0 sc1 lds
v_mfma_f32_16x16x32_bf16 v[16:19], a[12:15], a[172:175], v[16:19]
ds_read_b128 a[136:139], v1 offset:26624
v_mov_b32 v241, 0
v_mfma_f32_16x16x32_bf16 v[20:23], a[0:3], a[176:179], v[84:87]
ds_read_b128 a[140:143], v1 offset:27648
v_mov_b32 v242, 0
v_mfma_f32_16x16x32_bf16 v[20:23], a[4:7], a[180:183], v[20:23]
ds_read_b128 a[144:147], v1 offset:28672
v_mov_b32 v243, 0
v_mfma_f32_16x16x32_bf16 v[20:23], a[8:11], a[184:187], v[20:23]
ds_read_b128 a[148:151], v1 offset:29696
v_mov_b32 v244, 0
v_mfma_f32_16x16x32_bf16 v[20:23], a[12:15], a[188:191], v[20:23]
buffer_load_dwordx4 v3, s[48:51], s32 offen offset:1024 sc1 lds
v_mfma_f32_16x16x32_bf16 v[24:27], a[0:3], a[192:195], v[88:91]
ds_read_b128 a[152:155], v1 offset:30720
v_mov_b32 v245, 0
v_mfma_f32_16x16x32_bf16 v[24:27], a[4:7], a[196:199], v[24:27]
ds_read_b128 a[156:159], v1 offset:31744
v_exp_f32 v16, v16
v_mfma_f32_16x16x32_bf16 v[24:27], a[8:11], a[200:203], v[24:27]
v_exp_f32 v17, v17
v_mfma_f32_16x16x32_bf16 v[24:27], a[12:15], a[204:207], v[24:27]
v_exp_f32 v18, v18
v_mfma_f32_16x16x32_bf16 v[28:31], a[0:3], a[208:211], v[92:95]
buffer_load_dwordx4 v3, s[48:51], s32 offen offset:2048 sc1 lds
v_mfma_f32_16x16x32_bf16 v[28:31], a[4:7], a[212:215], v[28:31]
v_exp_f32 v19, v19
v_mfma_f32_16x16x32_bf16 v[28:31], a[8:11], a[216:219], v[28:31]
v_exp_f32 v20, v20
v_mfma_f32_16x16x32_bf16 v[28:31], a[12:15], a[220:223], v[28:31]
v_exp_f32 v21, v21
v_mfma_f32_16x16x32_bf16 v[32:35], a[16:19], a[160:163], v[80:83]
v_exp_f32 v22, v22
v_mfma_f32_16x16x32_bf16 v[32:35], a[20:23], a[164:167], v[32:35]
buffer_load_dwordx4 v3, s[48:51], s32 offen offset:3072 sc1 lds
v_mfma_f32_16x16x32_bf16 v[32:35], a[24:27], a[168:171], v[32:35]
v_exp_f32 v23, v23
v_mfma_f32_16x16x32_bf16 v[32:35], a[28:31], a[172:175], v[32:35]
v_exp_f32 v24, v24
v_mfma_f32_16x16x32_bf16 v[36:39], a[16:19], a[176:179], v[84:87]
v_exp_f32 v25, v25
v_mfma_f32_16x16x32_bf16 v[36:39], a[20:23], a[180:183], v[36:39]
s_add_u32 m0, s27, 0x1000
v_exp_f32 v26, v26
v_mfma_f32_16x16x32_bf16 v[36:39], a[24:27], a[184:187], v[36:39]
buffer_load_dwordx4 v3, s[48:51], s7 offen offset:0 sc1 lds
v_mfma_f32_16x16x32_bf16 v[36:39], a[28:31], a[188:191], v[36:39]
v_exp_f32 v27, v27
v_mfma_f32_16x16x32_bf16 v[40:43], a[16:19], a[192:195], v[88:91]
v_exp_f32 v28, v28
v_mfma_f32_16x16x32_bf16 v[40:43], a[20:23], a[196:199], v[40:43]
v_exp_f32 v29, v29
v_mfma_f32_16x16x32_bf16 v[40:43], a[24:27], a[200:203], v[40:43]
v_exp_f32 v30, v30
v_mfma_f32_16x16x32_bf16 v[40:43], a[28:31], a[204:207], v[40:43]
buffer_load_dwordx4 v3, s[48:51], s7 offen offset:1024 sc1 lds
v_mfma_f32_16x16x32_bf16 v[44:47], a[16:19], a[208:211], v[92:95]
v_exp_f32 v31, v31
v_mfma_f32_16x16x32_bf16 v[44:47], a[20:23], a[212:215], v[44:47]
v_exp_f32 v32, v32
v_mfma_f32_16x16x32_bf16 v[44:47], a[24:27], a[216:219], v[44:47]
v_exp_f32 v33, v33
v_mfma_f32_16x16x32_bf16 v[44:47], a[28:31], a[220:223], v[44:47]
s_waitcnt lgkmcnt(0)
v_cvt_pk_bf16_f32 v48, v16, v17
v_cvt_pk_bf16_f32 v49, v18, v19
v_cvt_pk_bf16_f32 v52, v20, v21
v_cvt_pk_bf16_f32 v53, v22, v23
v_cvt_pk_bf16_f32 v56, v24, v25
v_cvt_pk_bf16_f32 v57, v26, v27
v_mov_b32 v246, 0
v_mov_b32 v247, 0
v_mfma_f32_16x16x32_bf16 v[16:19], a[128:131], a[160:163], v[96:99]
ds_read_b128 a[32:35], v1 offset:16384
v_cvt_pk_bf16_f32 v60, v28, v29
v_mfma_f32_16x16x32_bf16 v[16:19], a[132:135], a[164:167], v[16:19]
v_exp_f32 v34, v34
v_mfma_f32_16x16x32_bf16 v[16:19], a[136:139], a[168:171], v[16:19]
buffer_load_dwordx4 v3, s[48:51], s7 offen offset:2048 sc1 lds
v_mfma_f32_16x16x32_bf16 v[16:19], a[140:143], a[172:175], v[16:19]
ds_read_b128 a[36:39], v1 offset:17408
v_cvt_pk_bf16_f32 v61, v30, v31
v_mfma_f32_16x16x32_bf16 v[20:23], a[128:131], a[176:179], v[84:87]
v_exp_f32 v35, v35
v_mfma_f32_16x16x32_bf16 v[20:23], a[132:135], a[180:183], v[20:23]
v_exp_f32 v36, v36
v_mfma_f32_16x16x32_bf16 v[20:23], a[136:139], a[184:187], v[20:23]
ds_read_b128 a[40:43], v1 offset:18432
v_cvt_pk_bf16_f32 v50, v32, v33
v_mfma_f32_16x16x32_bf16 v[20:23], a[140:143], a[188:191], v[20:23]
buffer_load_dwordx4 v3, s[48:51], s7 offen offset:3072 sc1 lds
v_mfma_f32_16x16x32_bf16 v[24:27], a[128:131], a[192:195], v[88:91]
v_exp_f32 v37, v37
v_mfma_f32_16x16x32_bf16 v[24:27], a[132:135], a[196:199], v[24:27]
ds_read_b128 a[44:47], v1 offset:19456
v_cvt_pk_bf16_f32 v51, v34, v35
v_mfma_f32_16x16x32_bf16 v[24:27], a[136:139], a[200:203], v[24:27]
v_exp_f32 v38, v38
v_mfma_f32_16x16x32_bf16 v[24:27], a[140:143], a[204:207], v[24:27]
v_exp_f32 v39, v39
v_mfma_f32_16x16x32_bf16 v[28:31], a[128:131], a[208:211], v[92:95]
s_mov_b32 s9, 0x0
v_exp_f32 v40, v40
v_mfma_f32_16x16x32_bf16 v[28:31], a[132:135], a[212:215], v[28:31]
buffer_load_dword a244, v8, s[72:75], s9 offen
v_mfma_f32_16x16x32_bf16 v[28:31], a[136:139], a[216:219], v[28:31]
ds_read_b128 a[48:51], v1 offset:20480
v_cvt_pk_bf16_f32 v54, v36, v37
v_mfma_f32_16x16x32_bf16 v[28:31], a[140:143], a[220:223], v[28:31]
v_exp_f32 v41, v41
v_mfma_f32_16x16x32_bf16 v[32:35], a[144:147], a[160:163], v[100:103]
ds_read_b128 a[52:55], v1 offset:21504
v_cvt_pk_bf16_f32 v55, v38, v39
v_mfma_f32_16x16x32_bf16 v[32:35], a[148:151], a[164:167], v[32:35]
s_mov_b32 s9, 0x0
v_exp_f32 v42, v42
v_mfma_f32_16x16x32_bf16 v[32:35], a[152:155], a[168:171], v[32:35]
buffer_load_dword a244, v8, s[64:67], s9 offen
v_mfma_f32_16x16x32_bf16 v[32:35], a[156:159], a[172:175], v[32:35]
ds_read_b128 a[56:59], v1 offset:22528
v_cvt_pk_bf16_f32 v58, v40, v41
v_mfma_f32_16x16x32_bf16 v[36:39], a[144:147], a[176:179], v[84:87]
v_exp_f32 v43, v43
v_mfma_f32_16x16x32_bf16 v[36:39], a[148:151], a[180:183], v[36:39]
s_mov_b32 s9, 0x400000
v_exp_f32 v44, v44
v_mfma_f32_16x16x32_bf16 v[36:39], a[152:155], a[184:187], v[36:39]
ds_read_b128 a[60:63], v1 offset:23552
v_xor_b32 v1, 0x8000, v1
v_mfma_f32_16x16x32_bf16 v[36:39], a[156:159], a[188:191], v[36:39]
buffer_load_dword a244, v8, s[64:67], s9 offen
v_cvt_pk_bf16_f32 v59, v42, v43
v_mfma_f32_16x16x32_bf16 v[40:43], a[144:147], a[192:195], v[88:91]
s_add_u32 s32, s32, 0x8000
v_exp_f32 v45, v45
v_mfma_f32_16x16x32_bf16 v[40:43], a[148:151], a[196:199], v[40:43]
s_add_u32 s7, s7, 0x8000
v_exp_f32 v46, v46
v_mfma_f32_16x16x32_bf16 v[40:43], a[152:155], a[200:203], v[40:43]
s_xor_b32 s27, s27, 0x38000
v_exp_f32 v47, v47
v_mfma_f32_16x16x32_bf16 v[40:43], a[156:159], a[204:207], v[40:43]
v_exp_f32 v16, v16
v_cvt_pk_bf16_f32 v62, v44, v45
v_cvt_pk_bf16_f32 v63, v46, v47
v_mfma_f32_16x16x32_bf16 v[44:47], a[144:147], a[208:211], v[92:95]
v_exp_f32 v17, v17
v_mfma_f32_16x16x32_bf16 v[44:47], a[148:151], a[212:215], v[44:47]
v_exp_f32 v18, v18
v_mfma_f32_16x16x32_bf16 v[44:47], a[152:155], a[216:219], v[44:47]
s_waitcnt vmcnt(11) lgkmcnt(0)
v_exp_f32 v19, v19
v_mfma_f32_16x16x32_bf16 v[44:47], a[156:159], a[220:223], v[44:47]
s_barrier
v_cvt_pk_bf16_f32 v64, v16, v17
v_exp_f32 v20, v20
v_exp_f32 v21, v21
v_exp_f32 v22, v22
v_exp_f32 v23, v23
v_exp_f32 v24, v24
v_exp_f32 v25, v25
v_exp_f32 v26, v26
v_exp_f32 v27, v27
v_cvt_pk_bf16_f32 v65, v18, v19
v_cvt_pk_bf16_f32 v68, v20, v21
v_cvt_pk_bf16_f32 v69, v22, v23
s_cmp_lg_u32 s33, 0
s_cbranch_scc1 L_sig_bn1
s_lshl_b32 s8, s6, 2
s_add_u32 s8, s8, 192
s_cmp_lg_u32 s4, 0
s_cbranch_scc1 L_sig_bn1
v_mov_b32 v4, 1
s_mov_b64 exec, 1
buffer_atomic_add v4, off, s[84:87], s8 sc1
s_mov_b64 exec, -1
L_sig_bn1:
s_branch L_att_l1_1
L_att_seven0:
v_mfma_f32_16x16x32_bf16 v[192:195], a[32:35], v[56:59], v[192:195]
v_exp_f32 v30, v30
v_mfma_f32_16x16x32_bf16 v[224:227], a[32:35], v[60:63], v[224:227]
ds_read_b128 a[0:3], v1 offset:8192
v_cvt_pk_bf16_f32 v72, v24, v25
v_mfma_f32_16x16x32_bf16 v[228:231], a[36:39], v[60:63], v[228:231]
ds_read_b128 a[4:7], v1 offset:9216
v_cvt_pk_bf16_f32 v73, v26, v27
v_mfma_f32_16x16x32_bf16 v[196:199], a[36:39], v[56:59], v[196:199]
s_add_u32 m0, s27, 0x0
v_exp_f32 v31, v31
v_mfma_f32_16x16x32_bf16 v[200:203], a[40:43], v[56:59], v[200:203]
ds_read_b128 a[8:11], v1 offset:10240
v_cvt_pk_bf16_f32 v76, v28, v29
v_mfma_f32_16x16x32_bf16 v[232:235], a[40:43], v[60:63], v[232:235]
buffer_load_dwordx4 v3, s[48:51], s32 offen offset:0 sc1 lds
v_mfma_f32_16x16x32_bf16 v[236:239], a[44:47], v[60:63], v[236:239]
v_exp_f32 v40, v40
v_mfma_f32_16x16x32_bf16 v[204:207], a[44:47], v[56:59], v[204:207]
ds_read_b128 a[12:15], v1 offset:11264
v_cvt_pk_bf16_f32 v77, v30, v31
v_mfma_f32_16x16x32_bf16 v[208:211], a[48:51], v[56:59], v[208:211]
ds_read_b128 a[16:19], v1 offset:12288
v_mfma_f32_16x16x32_bf16 v[240:243], a[48:51], v[60:63], v[240:243]
buffer_load_dwordx4 v3, s[48:51], s32 offen offset:1024 sc1 lds
v_mfma_f32_16x16x32_bf16 v[244:247], a[52:55], v[60:63], v[244:247]
ds_read_b128 a[20:23], v1 offset:13312
v_mfma_f32_16x16x32_bf16 v[212:215], a[52:55], v[56:59], v[212:215]
ds_read_b128 a[24:27], v1 offset:14336
v_mfma_f32_16x16x32_bf16 v[216:219], a[56:59], v[56:59], v[216:219]
ds_read_b128 a[28:31], v1 offset:15360
v_mfma_f32_16x16x32_bf16 v[248:251], a[56:59], v[60:63], v[248:251]
ds_read_b128 a[32:35], v1 offset:0
v_exp_f32 v41, v41
v_mfma_f32_16x16x32_bf16 v[252:255], a[60:63], v[60:63], v[252:255]
v_exp_f32 v42, v42
v_mfma_f32_16x16x32_bf16 v[220:223], a[60:63], v[56:59], v[220:223]
s_waitcnt lgkmcnt(5)
v_exp_f32 v43, v43
v_smfmac_f32_16x16x64_bf16 a[228:231], a[232:235], v[56:63], v9
ds_read_b128 a[36:39], v1 offset:1024
v_cvt_pk_bf16_f32 v74, v40, v41
v_mfma_f32_16x16x32_bf16 v[24:27], a[0:3], a[192:195], v[88:91]
ds_read_b128 a[40:43], v1 offset:2048
v_exp_f32 v44, v44
v_mfma_f32_16x16x32_bf16 v[24:27], a[4:7], a[196:199], v[24:27]
buffer_load_dwordx4 v3, s[48:51], s32 offen offset:2048 sc1 lds
v_mfma_f32_16x16x32_bf16 v[24:27], a[8:11], a[200:203], v[24:27]
v_exp_f32 v45, v45
v_mfma_f32_16x16x32_bf16 v[24:27], a[12:15], a[204:207], v[24:27]
ds_read_b128 a[44:47], v1 offset:3072
v_cvt_pk_bf16_f32 v75, v42, v43
v_mfma_f32_16x16x32_bf16 v[28:31], a[0:3], a[208:211], v[92:95]
ds_read_b128 a[48:51], v1 offset:4096
v_exp_f32 v46, v46
v_mfma_f32_16x16x32_bf16 v[28:31], a[4:7], a[212:215], v[28:31]
s_waitcnt lgkmcnt(5)
v_exp_f32 v47, v47
v_mfma_f32_16x16x32_bf16 v[28:31], a[8:11], a[216:219], v[28:31]
ds_read_b128 a[52:55], v1 offset:5120
v_cvt_pk_bf16_f32 v78, v44, v45
v_mfma_f32_16x16x32_bf16 v[28:31], a[12:15], a[220:223], v[28:31]
buffer_load_dwordx4 v3, s[48:51], s32 offen offset:3072 sc1 lds
v_mfma_f32_16x16x32_bf16 v[40:43], a[16:19], a[192:195], v[88:91]
ds_read_b128 a[56:59], v1 offset:6144
s_add_u32 s32, s32, 0x8000
v_mfma_f32_16x16x32_bf16 v[40:43], a[20:23], a[196:199], v[40:43]
ds_read_b128 a[60:63], v1 offset:7168
v_cvt_pk_bf16_f32 v79, v46, v47
v_mfma_f32_16x16x32_bf16 v[40:43], a[24:27], a[200:203], v[40:43]
v_exp_f32 v24, v24
v_mfma_f32_16x16x32_bf16 v[40:43], a[28:31], a[204:207], v[40:43]
v_exp_f32 v25, v25
v_mfma_f32_16x16x32_bf16 v[44:47], a[16:19], a[208:211], v[92:95]
v_exp_f32 v26, v26
v_mfma_f32_16x16x32_bf16 v[44:47], a[20:23], a[212:215], v[44:47]
v_exp_f32 v27, v27
v_mfma_f32_16x16x32_bf16 v[44:47], a[24:27], a[216:219], v[44:47]
v_exp_f32 v28, v28
v_mfma_f32_16x16x32_bf16 v[44:47], a[28:31], a[220:223], v[44:47]
s_waitcnt lgkmcnt(0)
v_exp_f32 v29, v29
v_mfma_f32_16x16x32_bf16 v[192:195], a[32:35], v[72:75], v[192:195]
s_add_u32 m0, s27, 0x1000
v_exp_f32 v30, v30
v_mfma_f32_16x16x32_bf16 v[224:227], a[32:35], v[76:79], v[224:227]
buffer_load_dwordx4 v3, s[48:51], s7 offen offset:0 sc1 lds
v_mfma_f32_16x16x32_bf16 v[228:231], a[36:39], v[76:79], v[228:231]
v_exp_f32 v31, v31
v_mfma_f32_16x16x32_bf16 v[196:199], a[36:39], v[72:75], v[196:199]
ds_read_b128 a[0:3], v1 offset:24576
v_cvt_pk_bf16_f32 v56, v24, v25
v_mfma_f32_16x16x32_bf16 v[200:203], a[40:43], v[72:75], v[200:203]
ds_read_b128 a[4:7], v1 offset:25600
v_cvt_pk_bf16_f32 v57, v26, v27
v_mfma_f32_16x16x32_bf16 v[232:235], a[40:43], v[76:79], v[232:235]
v_exp_f32 v40, v40
v_mfma_f32_16x16x32_bf16 v[236:239], a[44:47], v[76:79], v[236:239]
ds_read_b128 a[8:11], v1 offset:26624
v_cvt_pk_bf16_f32 v60, v28, v29
v_mfma_f32_16x16x32_bf16 v[204:207], a[44:47], v[72:75], v[204:207]
v_exp_f32 v41, v41
v_mfma_f32_16x16x32_bf16 v[208:211], a[48:51], v[72:75], v[208:211]
ds_read_b128 a[12:15], v1 offset:27648
v_cvt_pk_bf16_f32 v61, v30, v31
v_mfma_f32_16x16x32_bf16 v[240:243], a[48:51], v[76:79], v[240:243]
ds_read_b128 a[16:19], v1 offset:28672
v_cvt_pk_bf16_f32 v58, v40, v41
v_mfma_f32_16x16x32_bf16 v[244:247], a[52:55], v[76:79], v[244:247]
v_exp_f32 v42, v42
v_mfma_f32_16x16x32_bf16 v[212:215], a[52:55], v[72:75], v[212:215]
buffer_load_dwordx4 v3, s[48:51], s7 offen offset:1024 sc1 lds
v_mfma_f32_16x16x32_bf16 v[216:219], a[56:59], v[72:75], v[216:219]
ds_read_b128 a[20:23], v1 offset:29696
v_mfma_f32_16x16x32_bf16 v[248:251], a[56:59], v[76:79], v[248:251]
ds_read_b128 a[24:27], v1 offset:30720
v_mfma_f32_16x16x32_bf16 v[252:255], a[60:63], v[76:79], v[252:255]
ds_read_b128 a[28:31], v1 offset:31744
v_mfma_f32_16x16x32_bf16 v[220:223], a[60:63], v[72:75], v[220:223]
s_waitcnt lgkmcnt(4)
v_exp_f32 v43, v43
v_smfmac_f32_16x16x64_bf16 a[228:231], a[232:235], v[72:79], v9
ds_read_b128 a[32:35], v1 offset:16384
v_cvt_pk_bf16_f32 v59, v42, v43
v_mfma_f32_16x16x32_bf16 v[24:27], a[0:3], a[192:195], v[88:91]
ds_read_b128 a[36:39], v1 offset:17408
v_mfma_f32_16x16x32_bf16 v[24:27], a[4:7], a[196:199], v[24:27]
buffer_load_dwordx4 v3, s[48:51], s7 offen offset:2048 sc1 lds
v_mfma_f32_16x16x32_bf16 v[24:27], a[8:11], a[200:203], v[24:27]
ds_read_b128 a[40:43], v1 offset:18432
v_exp_f32 v44, v44
v_mfma_f32_16x16x32_bf16 v[24:27], a[12:15], a[204:207], v[24:27]
ds_read_b128 a[44:47], v1 offset:19456
v_exp_f32 v45, v45
v_mfma_f32_16x16x32_bf16 v[28:31], a[0:3], a[208:211], v[92:95]
ds_read_b128 a[48:51], v1 offset:20480
v_exp_f32 v46, v46
v_mfma_f32_16x16x32_bf16 v[28:31], a[4:7], a[212:215], v[28:31]
s_waitcnt lgkmcnt(5)
v_exp_f32 v47, v47
v_mfma_f32_16x16x32_bf16 v[28:31], a[8:11], a[216:219], v[28:31]
ds_read_b128 a[52:55], v1 offset:21504
v_cvt_pk_bf16_f32 v62, v44, v45
v_mfma_f32_16x16x32_bf16 v[28:31], a[12:15], a[220:223], v[28:31]
ds_read_b128 a[56:59], v1 offset:22528
v_cvt_pk_bf16_f32 v63, v46, v47
v_mfma_f32_16x16x32_bf16 v[40:43], a[16:19], a[192:195], v[88:91]
ds_read_b128 a[60:63], v1 offset:23552
v_xor_b32 v1, 0x8000, v1
v_mfma_f32_16x16x32_bf16 v[40:43], a[20:23], a[196:199], v[40:43]
buffer_load_dwordx4 v3, s[48:51], s7 offen offset:3072 sc1 lds
v_mfma_f32_16x16x32_bf16 v[40:43], a[24:27], a[200:203], v[40:43]
s_add_u32 s7, s7, 0x8000
v_exp_f32 v24, v24
v_mfma_f32_16x16x32_bf16 v[40:43], a[28:31], a[204:207], v[40:43]
s_xor_b32 s27, s27, 0x38000
v_exp_f32 v25, v25
v_mfma_f32_16x16x32_bf16 v[44:47], a[16:19], a[208:211], v[92:95]
v_exp_f32 v26, v26
v_mfma_f32_16x16x32_bf16 v[44:47], a[20:23], a[212:215], v[44:47]
v_exp_f32 v27, v27
v_mfma_f32_16x16x32_bf16 v[44:47], a[24:27], a[216:219], v[44:47]
s_waitcnt vmcnt(16) lgkmcnt(0)
v_exp_f32 v28, v28
v_mfma_f32_16x16x32_bf16 v[44:47], a[28:31], a[220:223], v[44:47]
s_barrier
v_exp_f32 v29, v29
L_att_sodd0:
v_mfma_f32_16x16x32_bf16 v[192:195], a[32:35], v[56:59], v[192:195]
v_exp_f32 v30, v30
v_mfma_f32_16x16x32_bf16 v[224:227], a[32:35], v[60:63], v[224:227]
ds_read_b128 a[0:3], v2 offset:8192
v_cvt_pk_bf16_f32 v72, v24, v25
v_mfma_f32_16x16x32_bf16 v[228:231], a[36:39], v[60:63], v[228:231]
ds_read_b128 a[4:7], v2 offset:9216
v_cvt_pk_bf16_f32 v73, v26, v27
v_mfma_f32_16x16x32_bf16 v[196:199], a[36:39], v[56:59], v[196:199]
s_add_u32 m0, s19, 0x0
v_exp_f32 v31, v31
v_mfma_f32_16x16x32_bf16 v[200:203], a[40:43], v[56:59], v[200:203]
ds_read_b128 a[8:11], v2 offset:10240
v_cvt_pk_bf16_f32 v76, v28, v29
v_mfma_f32_16x16x32_bf16 v[232:235], a[40:43], v[60:63], v[232:235]
buffer_load_dwordx4 v3, s[48:51], s32 offen offset:0 sc1 lds
v_mfma_f32_16x16x32_bf16 v[236:239], a[44:47], v[60:63], v[236:239]
v_exp_f32 v40, v40
v_mfma_f32_16x16x32_bf16 v[204:207], a[44:47], v[56:59], v[204:207]
ds_read_b128 a[12:15], v2 offset:11264
v_cvt_pk_bf16_f32 v77, v30, v31
v_mfma_f32_16x16x32_bf16 v[208:211], a[48:51], v[56:59], v[208:211]
ds_read_b128 a[16:19], v2 offset:12288
v_mfma_f32_16x16x32_bf16 v[240:243], a[48:51], v[60:63], v[240:243]
buffer_load_dwordx4 v3, s[48:51], s32 offen offset:1024 sc1 lds
v_mfma_f32_16x16x32_bf16 v[244:247], a[52:55], v[60:63], v[244:247]
ds_read_b128 a[20:23], v2 offset:13312
v_mfma_f32_16x16x32_bf16 v[212:215], a[52:55], v[56:59], v[212:215]
ds_read_b128 a[24:27], v2 offset:14336
v_mfma_f32_16x16x32_bf16 v[216:219], a[56:59], v[56:59], v[216:219]
ds_read_b128 a[28:31], v2 offset:15360
v_mfma_f32_16x16x32_bf16 v[248:251], a[56:59], v[60:63], v[248:251]
ds_read_b128 a[32:35], v2 offset:0
v_exp_f32 v41, v41
v_mfma_f32_16x16x32_bf16 v[252:255], a[60:63], v[60:63], v[252:255]
v_exp_f32 v42, v42
v_mfma_f32_16x16x32_bf16 v[220:223], a[60:63], v[56:59], v[220:223]
s_waitcnt lgkmcnt(5)
v_exp_f32 v43, v43
v_smfmac_f32_16x16x64_bf16 a[228:231], a[232:235], v[56:63], v9
ds_read_b128 a[36:39], v2 offset:1024
v_cvt_pk_bf16_f32 v74, v40, v41
v_mfma_f32_16x16x32_bf16 v[24:27], a[0:3], a[192:195], v[88:91]
ds_read_b128 a[40:43], v2 offset:2048
v_exp_f32 v44, v44
v_mfma_f32_16x16x32_bf16 v[24:27], a[4:7], a[196:199], v[24:27]
buffer_load_dwordx4 v3, s[48:51], s32 offen offset:2048 sc1 lds
v_mfma_f32_16x16x32_bf16 v[24:27], a[8:11], a[200:203], v[24:27]
v_exp_f32 v45, v45
v_mfma_f32_16x16x32_bf16 v[24:27], a[12:15], a[204:207], v[24:27]
ds_read_b128 a[44:47], v2 offset:3072
v_cvt_pk_bf16_f32 v75, v42, v43
v_mfma_f32_16x16x32_bf16 v[28:31], a[0:3], a[208:211], v[92:95]
ds_read_b128 a[48:51], v2 offset:4096
v_exp_f32 v46, v46
v_mfma_f32_16x16x32_bf16 v[28:31], a[4:7], a[212:215], v[28:31]
s_waitcnt lgkmcnt(5)
v_exp_f32 v47, v47
v_mfma_f32_16x16x32_bf16 v[28:31], a[8:11], a[216:219], v[28:31]
ds_read_b128 a[52:55], v2 offset:5120
v_cvt_pk_bf16_f32 v78, v44, v45
v_mfma_f32_16x16x32_bf16 v[28:31], a[12:15], a[220:223], v[28:31]
buffer_load_dwordx4 v3, s[48:51], s32 offen offset:3072 sc1 lds
v_mfma_f32_16x16x32_bf16 v[40:43], a[16:19], a[192:195], v[88:91]
ds_read_b128 a[56:59], v2 offset:6144
s_add_u32 s32, s32, 0x8000
v_mfma_f32_16x16x32_bf16 v[40:43], a[20:23], a[196:199], v[40:43]
ds_read_b128 a[60:63], v2 offset:7168
v_cvt_pk_bf16_f32 v79, v46, v47
v_mfma_f32_16x16x32_bf16 v[40:43], a[24:27], a[200:203], v[40:43]
v_exp_f32 v24, v24
v_mfma_f32_16x16x32_bf16 v[40:43], a[28:31], a[204:207], v[40:43]
v_exp_f32 v25, v25
v_mfma_f32_16x16x32_bf16 v[44:47], a[16:19], a[208:211], v[92:95]
v_exp_f32 v26, v26
v_mfma_f32_16x16x32_bf16 v[44:47], a[20:23], a[212:215], v[44:47]
v_exp_f32 v27, v27
v_mfma_f32_16x16x32_bf16 v[44:47], a[24:27], a[216:219], v[44:47]
v_exp_f32 v28, v28
v_mfma_f32_16x16x32_bf16 v[44:47], a[28:31], a[220:223], v[44:47]
s_waitcnt lgkmcnt(0)
v_exp_f32 v29, v29
v_mfma_f32_16x16x32_bf16 v[192:195], a[32:35], v[72:75], v[192:195]
v_exp_f32 v30, v30
v_mfma_f32_16x16x32_bf16 v[224:227], a[32:35], v[76:79], v[224:227]
v_exp_f32 v31, v31
v_mfma_f32_16x16x32_bf16 v[228:231], a[36:39], v[76:79], v[228:231]
v_exp_f32 v40, v40
v_mfma_f32_16x16x32_bf16 v[196:199], a[36:39], v[72:75], v[196:199]
s_add_u32 m0, s19, 0x1000
v_exp_f32 v41, v41
v_mfma_f32_16x16x32_bf16 v[200:203], a[40:43], v[72:75], v[200:203]
ds_read_b128 a[0:3], v2 offset:24576
v_cvt_pk_bf16_f32 v56, v24, v25
v_mfma_f32_16x16x32_bf16 v[232:235], a[40:43], v[76:79], v[232:235]
buffer_load_dwordx4 v3, s[48:51], s7 offen offset:0 sc1 lds
v_mfma_f32_16x16x32_bf16 v[236:239], a[44:47], v[76:79], v[236:239]
ds_read_b128 a[4:7], v2 offset:25600
v_cvt_pk_bf16_f32 v57, v26, v27
v_mfma_f32_16x16x32_bf16 v[204:207], a[44:47], v[72:75], v[204:207]
ds_read_b128 a[8:11], v2 offset:26624
v_cvt_pk_bf16_f32 v60, v28, v29
v_mfma_f32_16x16x32_bf16 v[208:211], a[48:51], v[72:75], v[208:211]
ds_read_b128 a[12:15], v2 offset:27648
v_cvt_pk_bf16_f32 v61, v30, v31
v_mfma_f32_16x16x32_bf16 v[240:243], a[48:51], v[76:79], v[240:243]
ds_read_b128 a[16:19], v2 offset:28672
v_cvt_pk_bf16_f32 v58, v40, v41
v_mfma_f32_16x16x32_bf16 v[244:247], a[52:55], v[76:79], v[244:247]
buffer_load_dwordx4 v3, s[48:51], s7 offen offset:1024 sc1 lds
v_mfma_f32_16x16x32_bf16 v[212:215], a[52:55], v[72:75], v[212:215]
ds_read_b128 a[20:23], v2 offset:29696
v_mfma_f32_16x16x32_bf16 v[216:219], a[56:59], v[72:75], v[216:219]
v_exp_f32 v42, v42
v_mfma_f32_16x16x32_bf16 v[248:251], a[56:59], v[76:79], v[248:251]
ds_read_b128 a[24:27], v2 offset:30720
v_mfma_f32_16x16x32_bf16 v[252:255], a[60:63], v[76:79], v[252:255]
ds_read_b128 a[28:31], v2 offset:31744
v_exp_f32 v43, v43
v_mfma_f32_16x16x32_bf16 v[220:223], a[60:63], v[72:75], v[220:223]
ds_read_b128 a[32:35], v2 offset:16384
v_cvt_pk_bf16_f32 v59, v42, v43
v_smfmac_f32_16x16x64_bf16 a[228:231], a[232:235], v[72:79], v9
ds_read_b128 a[36:39], v2 offset:17408
s_waitcnt lgkmcnt(6)
v_mfma_f32_16x16x32_bf16 v[24:27], a[0:3], a[192:195], v[88:91]
buffer_load_dwordx4 v3, s[48:51], s7 offen offset:2048 sc1 lds
v_mfma_f32_16x16x32_bf16 v[24:27], a[4:7], a[196:199], v[24:27]
ds_read_b128 a[40:43], v2 offset:18432
v_exp_f32 v44, v44
v_mfma_f32_16x16x32_bf16 v[24:27], a[8:11], a[200:203], v[24:27]
ds_read_b128 a[44:47], v2 offset:19456
v_exp_f32 v45, v45
v_mfma_f32_16x16x32_bf16 v[24:27], a[12:15], a[204:207], v[24:27]
ds_read_b128 a[48:51], v2 offset:20480
v_cvt_pk_bf16_f32 v62, v44, v45
v_mfma_f32_16x16x32_bf16 v[28:31], a[0:3], a[208:211], v[92:95]
v_exp_f32 v46, v46
v_mfma_f32_16x16x32_bf16 v[28:31], a[4:7], a[212:215], v[28:31]
s_waitcnt lgkmcnt(5)
v_exp_f32 v47, v47
v_mfma_f32_16x16x32_bf16 v[28:31], a[8:11], a[216:219], v[28:31]
ds_read_b128 a[52:55], v2 offset:21504
v_cvt_pk_bf16_f32 v63, v46, v47
v_mfma_f32_16x16x32_bf16 v[28:31], a[12:15], a[220:223], v[28:31]
buffer_load_dwordx4 v3, s[48:51], s7 offen offset:3072 sc1 lds
v_mfma_f32_16x16x32_bf16 v[40:43], a[16:19], a[192:195], v[88:91]
ds_read_b128 a[56:59], v2 offset:22528
s_add_u32 s7, s7, 0x8000
v_mfma_f32_16x16x32_bf16 v[40:43], a[20:23], a[196:199], v[40:43]
ds_read_b128 a[60:63], v2 offset:23552
v_xor_b32 v2, 0x38000, v2
v_mfma_f32_16x16x32_bf16 v[40:43], a[24:27], a[200:203], v[40:43]
s_xor_b32 s19, s19, 0x8000
v_exp_f32 v24, v24
v_mfma_f32_16x16x32_bf16 v[40:43], a[28:31], a[204:207], v[40:43]
s_sub_u32 s15, s15, 1
v_exp_f32 v25, v25
v_mfma_f32_16x16x32_bf16 v[44:47], a[16:19], a[208:211], v[92:95]
s_cmp_lg_u32 s15, 0
v_exp_f32 v26, v26
v_mfma_f32_16x16x32_bf16 v[44:47], a[20:23], a[212:215], v[44:47]
v_exp_f32 v27, v27
v_mfma_f32_16x16x32_bf16 v[44:47], a[24:27], a[216:219], v[44:47]
s_waitcnt vmcnt(16) lgkmcnt(0)
v_exp_f32 v28, v28
v_mfma_f32_16x16x32_bf16 v[44:47], a[28:31], a[220:223], v[44:47]
s_barrier
v_exp_f32 v29, v29
s_cbranch_scc1 L_att_seven0
s_branch L_att_sdone
L_att_seven1:
v_mfma_f32_16x16x32_bf16 v[192:195], a[32:35], v[56:59], v[192:195]
v_exp_f32 v30, v30
v_mfma_f32_16x16x32_bf16 v[224:227], a[32:35], v[60:63], v[224:227]
ds_read_b128 a[0:3], v1 offset:8192
v_cvt_pk_bf16_f32 v72, v24, v25
v_mfma_f32_16x16x32_bf16 v[228:231], a[36:39], v[60:63], v[228:231]
ds_read_b128 a[4:7], v1 offset:9216
v_cvt_pk_bf16_f32 v73, v26, v27
v_mfma_f32_16x16x32_bf16 v[196:199], a[36:39], v[56:59], v[196:199]
s_add_u32 m0, s27, 0x0
v_exp_f32 v31, v31
v_mfma_f32_16x16x32_bf16 v[200:203], a[40:43], v[56:59], v[200:203]
ds_read_b128 a[8:11], v1 offset:10240
v_cvt_pk_bf16_f32 v76, v28, v29
v_mfma_f32_16x16x32_bf16 v[232:235], a[40:43], v[60:63], v[232:235]
buffer_load_dwordx4 v3, s[48:51], s32 offen offset:0 sc1 lds
v_mfma_f32_16x16x32_bf16 v[236:239], a[44:47], v[60:63], v[236:239]
v_exp_f32 v40, v40
v_mfma_f32_16x16x32_bf16 v[204:207], a[44:47], v[56:59], v[204:207]
ds_read_b128 a[12:15], v1 offset:11264
v_cvt_pk_bf16_f32 v77, v30, v31
v_mfma_f32_16x16x32_bf16 v[208:211], a[48:51], v[56:59], v[208:211]
ds_read_b128 a[16:19], v1 offset:12288
v_mfma_f32_16x16x32_bf16 v[240:243], a[48:51], v[60:63], v[240:243]
buffer_load_dwordx4 v3, s[48:51], s32 offen offset:1024 sc1 lds
v_mfma_f32_16x16x32_bf16 v[244:247], a[52:55], v[60:63], v[244:247]
ds_read_b128 a[20:23], v1 offset:13312
v_mfma_f32_16x16x32_bf16 v[212:215], a[52:55], v[56:59], v[212:215]
ds_read_b128 a[24:27], v1 offset:14336
v_mfma_f32_16x16x32_bf16 v[216:219], a[56:59], v[56:59], v[216:219]
ds_read_b128 a[28:31], v1 offset:15360
v_mfma_f32_16x16x32_bf16 v[248:251], a[56:59], v[60:63], v[248:251]
ds_read_b128 a[32:35], v1 offset:0
v_exp_f32 v41, v41
v_mfma_f32_16x16x32_bf16 v[252:255], a[60:63], v[60:63], v[252:255]
v_exp_f32 v42, v42
v_mfma_f32_16x16x32_bf16 v[220:223], a[60:63], v[56:59], v[220:223]
s_waitcnt lgkmcnt(5)
v_exp_f32 v43, v43
v_smfmac_f32_16x16x64_bf16 a[228:231], a[232:235], v[56:63], v9
ds_read_b128 a[36:39], v1 offset:1024
v_cvt_pk_bf16_f32 v74, v40, v41
v_mfma_f32_16x16x32_bf16 v[24:27], a[0:3], a[192:195], v[88:91]
ds_read_b128 a[40:43], v1 offset:2048
v_exp_f32 v44, v44
v_mfma_f32_16x16x32_bf16 v[24:27], a[4:7], a[196:199], v[24:27]
buffer_load_dwordx4 v3, s[48:51], s32 offen offset:2048 sc1 lds
v_mfma_f32_16x16x32_bf16 v[24:27], a[8:11], a[200:203], v[24:27]
v_exp_f32 v45, v45
v_mfma_f32_16x16x32_bf16 v[24:27], a[12:15], a[204:207], v[24:27]
ds_read_b128 a[44:47], v1 offset:3072
v_cvt_pk_bf16_f32 v75, v42, v43
v_mfma_f32_16x16x32_bf16 v[28:31], a[0:3], a[208:211], v[92:95]
ds_read_b128 a[48:51], v1 offset:4096
v_exp_f32 v46, v46
v_mfma_f32_16x16x32_bf16 v[28:31], a[4:7], a[212:215], v[28:31]
s_waitcnt lgkmcnt(5)
v_exp_f32 v47, v47
v_mfma_f32_16x16x32_bf16 v[28:31], a[8:11], a[216:219], v[28:31]
ds_read_b128 a[52:55], v1 offset:5120
v_cvt_pk_bf16_f32 v78, v44, v45
v_mfma_f32_16x16x32_bf16 v[28:31], a[12:15], a[220:223], v[28:31]
buffer_load_dwordx4 v3, s[48:51], s32 offen offset:3072 sc1 lds
v_mfma_f32_16x16x32_bf16 v[40:43], a[16:19], a[192:195], v[88:91]
ds_read_b128 a[56:59], v1 offset:6144
s_add_u32 s32, s32, 0x8000
v_mfma_f32_16x16x32_bf16 v[40:43], a[20:23], a[196:199], v[40:43]
ds_read_b128 a[60:63], v1 offset:7168
v_cvt_pk_bf16_f32 v79, v46, v47
v_mfma_f32_16x16x32_bf16 v[40:43], a[24:27], a[200:203], v[40:43]
v_exp_f32 v24, v24
v_mfma_f32_16x16x32_bf16 v[40:43], a[28:31], a[204:207], v[40:43]
v_exp_f32 v25, v25
v_mfma_f32_16x16x32_bf16 v[44:47], a[16:19], a[208:211], v[92:95]
v_exp_f32 v26, v26
v_mfma_f32_16x16x32_bf16 v[44:47], a[20:23], a[212:215], v[44:47]
v_exp_f32 v27, v27
v_mfma_f32_16x16x32_bf16 v[44:47], a[24:27], a[216:219], v[44:47]
v_exp_f32 v28, v28
v_mfma_f32_16x16x32_bf16 v[44:47], a[28:31], a[220:223], v[44:47]
s_waitcnt lgkmcnt(0)
v_exp_f32 v29, v29
v_mfma_f32_16x16x32_bf16 v[192:195], a[32:35], v[72:75], v[192:195]
s_add_u32 m0, s27, 0x1000
v_exp_f32 v30, v30
v_mfma_f32_16x16x32_bf16 v[224:227], a[32:35], v[76:79], v[224:227]
buffer_load_dwordx4 v3, s[48:51], s7 offen offset:0 sc1 lds
v_mfma_f32_16x16x32_bf16 v[228:231], a[36:39], v[76:79], v[228:231]
v_exp_f32 v31, v31
v_mfma_f32_16x16x32_bf16 v[196:199], a[36:39], v[72:75], v[196:199]
ds_read_b128 a[0:3], v1 offset:24576
v_cvt_pk_bf16_f32 v56, v24, v25
v_mfma_f32_16x16x32_bf16 v[200:203], a[40:43], v[72:75], v[200:203]
ds_read_b128 a[4:7], v1 offset:25600
v_cvt_pk_bf16_f32 v57, v26, v27
v_mfma_f32_16x16x32_bf16 v[232:235], a[40:43], v[76:79], v[232:235]
v_exp_f32 v40, v40
v_mfma_f32_16x16x32_bf16 v[236:239], a[44:47], v[76:79], v[236:239]
ds_read_b128 a[8:11], v1 offset:26624
v_cvt_pk_bf16_f32 v60, v28, v29
v_mfma_f32_16x16x32_bf16 v[204:207], a[44:47], v[72:75], v[204:207]
v_exp_f32 v41, v41
v_mfma_f32_16x16x32_bf16 v[208:211], a[48:51], v[72:75], v[208:211]
ds_read_b128 a[12:15], v1 offset:27648
v_cvt_pk_bf16_f32 v61, v30, v31
v_mfma_f32_16x16x32_bf16 v[240:243], a[48:51], v[76:79], v[240:243]
ds_read_b128 a[16:19], v1 offset:28672
v_cvt_pk_bf16_f32 v58, v40, v41
v_mfma_f32_16x16x32_bf16 v[244:247], a[52:55], v[76:79], v[244:247]
v_exp_f32 v42, v42
v_mfma_f32_16x16x32_bf16 v[212:215], a[52:55], v[72:75], v[212:215]
buffer_load_dwordx4 v3, s[48:51], s7 offen offset:1024 sc1 lds
v_mfma_f32_16x16x32_bf16 v[216:219], a[56:59], v[72:75], v[216:219]
ds_read_b128 a[20:23], v1 offset:29696
v_mfma_f32_16x16x32_bf16 v[248:251], a[56:59], v[76:79], v[248:251]
ds_read_b128 a[24:27], v1 offset:30720
v_mfma_f32_16x16x32_bf16 v[252:255], a[60:63], v[76:79], v[252:255]
ds_read_b128 a[28:31], v1 offset:31744
v_mfma_f32_16x16x32_bf16 v[220:223], a[60:63], v[72:75], v[220:223]
s_waitcnt lgkmcnt(4)
v_exp_f32 v43, v43
v_smfmac_f32_16x16x64_bf16 a[228:231], a[232:235], v[72:79], v9
ds_read_b128 a[32:35], v1 offset:16384
v_cvt_pk_bf16_f32 v59, v42, v43
v_mfma_f32_16x16x32_bf16 v[24:27], a[0:3], a[192:195], v[88:91]
ds_read_b128 a[36:39], v1 offset:17408
v_mfma_f32_16x16x32_bf16 v[24:27], a[4:7], a[196:199], v[24:27]
buffer_load_dwordx4 v3, s[48:51], s7 offen offset:2048 sc1 lds
v_mfma_f32_16x16x32_bf16 v[24:27], a[8:11], a[200:203], v[24:27]
ds_read_b128 a[40:43], v1 offset:18432
v_exp_f32 v44, v44
v_mfma_f32_16x16x32_bf16 v[24:27], a[12:15], a[204:207], v[24:27]
ds_read_b128 a[44:47], v1 offset:19456
v_exp_f32 v45, v45
v_mfma_f32_16x16x32_bf16 v[28:31], a[0:3], a[208:211], v[92:95]
ds_read_b128 a[48:51], v1 offset:20480
v_exp_f32 v46, v46
v_mfma_f32_16x16x32_bf16 v[28:31], a[4:7], a[212:215], v[28:31]
s_waitcnt lgkmcnt(5)
v_exp_f32 v47, v47
v_mfma_f32_16x16x32_bf16 v[28:31], a[8:11], a[216:219], v[28:31]
ds_read_b128 a[52:55], v1 offset:21504
v_cvt_pk_bf16_f32 v62, v44, v45
v_mfma_f32_16x16x32_bf16 v[28:31], a[12:15], a[220:223], v[28:31]
ds_read_b128 a[56:59], v1 offset:22528
v_cvt_pk_bf16_f32 v63, v46, v47
v_mfma_f32_16x16x32_bf16 v[40:43], a[16:19], a[192:195], v[88:91]
ds_read_b128 a[60:63], v1 offset:23552
v_xor_b32 v1, 0x8000, v1
v_mfma_f32_16x16x32_bf16 v[40:43], a[20:23], a[196:199], v[40:43]
buffer_load_dwordx4 v3, s[48:51], s7 offen offset:3072 sc1 lds
v_mfma_f32_16x16x32_bf16 v[40:43], a[24:27], a[200:203], v[40:43]
s_add_u32 s7, s7, 0x8000
v_exp_f32 v24, v24
v_mfma_f32_16x16x32_bf16 v[40:43], a[28:31], a[204:207], v[40:43]
s_xor_b32 s27, s27, 0x38000
v_exp_f32 v25, v25
v_mfma_f32_16x16x32_bf16 v[44:47], a[16:19], a[208:211], v[92:95]
s_waitcnt vmcnt(16) lgkmcnt(0)
v_exp_f32 v26, v26
v_mfma_f32_16x16x32_bf16 v[44:47], a[20:23], a[212:215], v[44:47]
s_barrier
v_exp_f32 v27, v27
v_mfma_f32_16x16x32_bf16 v[44:47], a[24:27], a[216:219], v[44:47]
v_exp_f32 v28, v28
v_mfma_f32_16x16x32_bf16 v[44:47], a[28:31], a[220:223], v[44:47]
v_exp_f32 v29, v29
L_att_sodd1:
v_mfma_f32_16x16x32_bf16 v[192:195], a[32:35], v[56:59], v[192:195]
v_exp_f32 v30, v30
v_mfma_f32_16x16x32_bf16 v[224:227], a[32:35], v[60:63], v[224:227]
ds_read_b128 a[0:3], v2 offset:8192
v_cvt_pk_bf16_f32 v72, v24, v25
v_mfma_f32_16x16x32_bf16 v[228:231], a[36:39], v[60:63], v[228:231]
ds_read_b128 a[4:7], v2 offset:9216
v_cvt_pk_bf16_f32 v73, v26, v27
v_mfma_f32_16x16x32_bf16 v[196:199], a[36:39], v[56:59], v[196:199]
s_add_u32 m0, s19, 0x0
v_exp_f32 v31, v31
v_mfma_f32_16x16x32_bf16 v[200:203], a[40:43], v[56:59], v[200:203]
ds_read_b128 a[8:11], v2 offset:10240
v_cvt_pk_bf16_f32 v76, v28, v29
v_mfma_f32_16x16x32_bf16 v[232:235], a[40:43], v[60:63], v[232:235]
buffer_load_dwordx4 v3, s[48:51], s32 offen offset:0 sc1 lds
v_mfma_f32_16x16x32_bf16 v[236:239], a[44:47], v[60:63], v[236:239]
v_exp_f32 v40, v40
v_mfma_f32_16x16x32_bf16 v[204:207], a[44:47], v[56:59], v[204:207]
ds_read_b128 a[12:15], v2 offset:11264
v_cvt_pk_bf16_f32 v77, v30, v31
v_mfma_f32_16x16x32_bf16 v[208:211], a[48:51], v[56:59], v[208:211]
ds_read_b128 a[16:19], v2 offset:12288
v_mfma_f32_16x16x32_bf16 v[240:243], a[48:51], v[60:63], v[240:243]
buffer_load_dwordx4 v3, s[48:51], s32 offen offset:1024 sc1 lds
v_mfma_f32_16x16x32_bf16 v[244:247], a[52:55], v[60:63], v[244:247]
ds_read_b128 a[20:23], v2 offset:13312
v_mfma_f32_16x16x32_bf16 v[212:215], a[52:55], v[56:59], v[212:215]
ds_read_b128 a[24:27], v2 offset:14336
v_mfma_f32_16x16x32_bf16 v[216:219], a[56:59], v[56:59], v[216:219]
ds_read_b128 a[28:31], v2 offset:15360
v_mfma_f32_16x16x32_bf16 v[248:251], a[56:59], v[60:63], v[248:251]
ds_read_b128 a[32:35], v2 offset:0
v_exp_f32 v41, v41
v_mfma_f32_16x16x32_bf16 v[252:255], a[60:63], v[60:63], v[252:255]
v_exp_f32 v42, v42
v_mfma_f32_16x16x32_bf16 v[220:223], a[60:63], v[56:59], v[220:223]
s_waitcnt lgkmcnt(5)
v_exp_f32 v43, v43
v_smfmac_f32_16x16x64_bf16 a[228:231], a[232:235], v[56:63], v9
ds_read_b128 a[36:39], v2 offset:1024
v_cvt_pk_bf16_f32 v74, v40, v41
v_mfma_f32_16x16x32_bf16 v[24:27], a[0:3], a[192:195], v[88:91]
ds_read_b128 a[40:43], v2 offset:2048
v_exp_f32 v44, v44
v_mfma_f32_16x16x32_bf16 v[24:27], a[4:7], a[196:199], v[24:27]
buffer_load_dwordx4 v3, s[48:51], s32 offen offset:2048 sc1 lds
v_mfma_f32_16x16x32_bf16 v[24:27], a[8:11], a[200:203], v[24:27]
v_exp_f32 v45, v45
v_mfma_f32_16x16x32_bf16 v[24:27], a[12:15], a[204:207], v[24:27]
ds_read_b128 a[44:47], v2 offset:3072
v_cvt_pk_bf16_f32 v75, v42, v43
v_mfma_f32_16x16x32_bf16 v[28:31], a[0:3], a[208:211], v[92:95]
ds_read_b128 a[48:51], v2 offset:4096
v_exp_f32 v46, v46
v_mfma_f32_16x16x32_bf16 v[28:31], a[4:7], a[212:215], v[28:31]
s_waitcnt lgkmcnt(5)
v_exp_f32 v47, v47
v_mfma_f32_16x16x32_bf16 v[28:31], a[8:11], a[216:219], v[28:31]
ds_read_b128 a[52:55], v2 offset:5120
v_cvt_pk_bf16_f32 v78, v44, v45
v_mfma_f32_16x16x32_bf16 v[28:31], a[12:15], a[220:223], v[28:31]
buffer_load_dwordx4 v3, s[48:51], s32 offen offset:3072 sc1 lds
v_mfma_f32_16x16x32_bf16 v[40:43], a[16:19], a[192:195], v[88:91]
ds_read_b128 a[56:59], v2 offset:6144
s_add_u32 s32, s32, 0x8000
v_mfma_f32_16x16x32_bf16 v[40:43], a[20:23], a[196:199], v[40:43]
ds_read_b128 a[60:63], v2 offset:7168
v_cvt_pk_bf16_f32 v79, v46, v47
v_mfma_f32_16x16x32_bf16 v[40:43], a[24:27], a[200:203], v[40:43]
v_exp_f32 v24, v24
v_mfma_f32_16x16x32_bf16 v[40:43], a[28:31], a[204:207], v[40:43]
v_exp_f32 v25, v25
v_mfma_f32_16x16x32_bf16 v[44:47], a[16:19], a[208:211], v[92:95]
v_exp_f32 v26, v26
v_mfma_f32_16x16x32_bf16 v[44:47], a[20:23], a[212:215], v[44:47]
v_exp_f32 v27, v27
v_mfma_f32_16x16x32_bf16 v[44:47], a[24:27], a[216:219], v[44:47]
v_exp_f32 v28, v28
v_mfma_f32_16x16x32_bf16 v[44:47], a[28:31], a[220:223], v[44:47]
s_waitcnt lgkmcnt(0)
v_exp_f32 v29, v29
v_mfma_f32_16x16x32_bf16 v[192:195], a[32:35], v[72:75], v[192:195]
v_exp_f32 v30, v30
v_mfma_f32_16x16x32_bf16 v[224:227], a[32:35], v[76:79], v[224:227]
v_exp_f32 v31, v31
v_mfma_f32_16x16x32_bf16 v[228:231], a[36:39], v[76:79], v[228:231]
v_exp_f32 v40, v40
v_mfma_f32_16x16x32_bf16 v[196:199], a[36:39], v[72:75], v[196:199]
s_add_u32 m0, s19, 0x1000
v_exp_f32 v41, v41
v_mfma_f32_16x16x32_bf16 v[200:203], a[40:43], v[72:75], v[200:203]
ds_read_b128 a[0:3], v2 offset:24576
v_cvt_pk_bf16_f32 v56, v24, v25
v_mfma_f32_16x16x32_bf16 v[232:235], a[40:43], v[76:79], v[232:235]
buffer_load_dwordx4 v3, s[48:51], s7 offen offset:0 sc1 lds
v_mfma_f32_16x16x32_bf16 v[236:239], a[44:47], v[76:79], v[236:239]
ds_read_b128 a[4:7], v2 offset:25600
v_cvt_pk_bf16_f32 v57, v26, v27
v_mfma_f32_16x16x32_bf16 v[204:207], a[44:47], v[72:75], v[204:207]
ds_read_b128 a[8:11], v2 offset:26624
v_cvt_pk_bf16_f32 v60, v28, v29
v_mfma_f32_16x16x32_bf16 v[208:211], a[48:51], v[72:75], v[208:211]
ds_read_b128 a[12:15], v2 offset:27648
v_cvt_pk_bf16_f32 v61, v30, v31
v_mfma_f32_16x16x32_bf16 v[240:243], a[48:51], v[76:79], v[240:243]
ds_read_b128 a[16:19], v2 offset:28672
v_cvt_pk_bf16_f32 v58, v40, v41
v_mfma_f32_16x16x32_bf16 v[244:247], a[52:55], v[76:79], v[244:247]
buffer_load_dwordx4 v3, s[48:51], s7 offen offset:1024 sc1 lds
v_mfma_f32_16x16x32_bf16 v[212:215], a[52:55], v[72:75], v[212:215]
ds_read_b128 a[20:23], v2 offset:29696
v_mfma_f32_16x16x32_bf16 v[216:219], a[56:59], v[72:75], v[216:219]
v_exp_f32 v42, v42
v_mfma_f32_16x16x32_bf16 v[248:251], a[56:59], v[76:79], v[248:251]
ds_read_b128 a[24:27], v2 offset:30720
v_mfma_f32_16x16x32_bf16 v[252:255], a[60:63], v[76:79], v[252:255]
ds_read_b128 a[28:31], v2 offset:31744
v_exp_f32 v43, v43
v_mfma_f32_16x16x32_bf16 v[220:223], a[60:63], v[72:75], v[220:223]
ds_read_b128 a[32:35], v2 offset:16384
v_cvt_pk_bf16_f32 v59, v42, v43
v_smfmac_f32_16x16x64_bf16 a[228:231], a[232:235], v[72:79], v9
ds_read_b128 a[36:39], v2 offset:17408
s_waitcnt lgkmcnt(6)
v_mfma_f32_16x16x32_bf16 v[24:27], a[0:3], a[192:195], v[88:91]
buffer_load_dwordx4 v3, s[48:51], s7 offen offset:2048 sc1 lds
v_mfma_f32_16x16x32_bf16 v[24:27], a[4:7], a[196:199], v[24:27]
ds_read_b128 a[40:43], v2 offset:18432
v_exp_f32 v44, v44
v_mfma_f32_16x16x32_bf16 v[24:27], a[8:11], a[200:203], v[24:27]
ds_read_b128 a[44:47], v2 offset:19456
v_exp_f32 v45, v45
v_mfma_f32_16x16x32_bf16 v[24:27], a[12:15], a[204:207], v[24:27]
ds_read_b128 a[48:51], v2 offset:20480
v_cvt_pk_bf16_f32 v62, v44, v45
v_mfma_f32_16x16x32_bf16 v[28:31], a[0:3], a[208:211], v[92:95]
v_exp_f32 v46, v46
v_mfma_f32_16x16x32_bf16 v[28:31], a[4:7], a[212:215], v[28:31]
s_waitcnt lgkmcnt(5)
v_exp_f32 v47, v47
v_mfma_f32_16x16x32_bf16 v[28:31], a[8:11], a[216:219], v[28:31]
ds_read_b128 a[52:55], v2 offset:21504
v_cvt_pk_bf16_f32 v63, v46, v47
v_mfma_f32_16x16x32_bf16 v[28:31], a[12:15], a[220:223], v[28:31]
buffer_load_dwordx4 v3, s[48:51], s7 offen offset:3072 sc1 lds
v_mfma_f32_16x16x32_bf16 v[40:43], a[16:19], a[192:195], v[88:91]
ds_read_b128 a[56:59], v2 offset:22528
s_add_u32 s7, s7, 0x8000
v_mfma_f32_16x16x32_bf16 v[40:43], a[20:23], a[196:199], v[40:43]
ds_read_b128 a[60:63], v2 offset:23552
v_xor_b32 v2, 0x38000, v2
v_mfma_f32_16x16x32_bf16 v[40:43], a[24:27], a[200:203], v[40:43]
s_xor_b32 s19, s19, 0x8000
v_exp_f32 v24, v24
v_mfma_f32_16x16x32_bf16 v[40:43], a[28:31], a[204:207], v[40:43]
s_sub_u32 s15, s15, 1
v_exp_f32 v25, v25
v_mfma_f32_16x16x32_bf16 v[44:47], a[16:19], a[208:211], v[92:95]
s_cmp_lg_u32 s15, 0
s_waitcnt vmcnt(16) lgkmcnt(0)
v_exp_f32 v26, v26
v_mfma_f32_16x16x32_bf16 v[44:47], a[20:23], a[212:215], v[44:47]
s_barrier
v_exp_f32 v27, v27
v_mfma_f32_16x16x32_bf16 v[44:47], a[24:27], a[216:219], v[44:47]
v_exp_f32 v28, v28
v_mfma_f32_16x16x32_bf16 v[44:47], a[28:31], a[220:223], v[44:47]
v_exp_f32 v29, v29
s_cbranch_scc1 L_att_seven1
L_att_sdone:
s_cmp_ge_u32 s4, 2
s_cbranch_scc1 L_att_sh0_1
L_att_sh0_0:
v_mfma_f32_16x16x32_bf16 v[192:195], a[32:35], v[56:59], v[192:195]
v_exp_f32 v30, v30
v_mfma_f32_16x16x32_bf16 v[224:227], a[32:35], v[60:63], v[224:227]
buffer_load_dword v14, v15, s[84:87], 0 offen offset:192 sc1
v_mfma_f32_16x16x32_bf16 v[228:231], a[36:39], v[60:63], v[228:231]
v_exp_f32 v31, v31
v_mfma_f32_16x16x32_bf16 v[196:199], a[36:39], v[56:59], v[196:199]
s_add_u32 m0, s17, 0x10000
v_exp_f32 v40, v40
v_mfma_f32_16x16x32_bf16 v[200:203], a[40:43], v[56:59], v[200:203]
ds_read_b128 a[0:3], v1 offset:8192
v_cvt_pk_bf16_f32 v72, v24, v25
v_mfma_f32_16x16x32_bf16 v[232:235], a[40:43], v[60:63], v[232:235]
ds_read_b128 a[4:7], v1 offset:9216
v_cvt_pk_bf16_f32 v73, v26, v27
v_mfma_f32_16x16x32_bf16 v[236:239], a[44:47], v[60:63], v[236:239]
buffer_load_dwordx4 v12, s[72:75], 0 offen lds
v_mfma_f32_16x16x32_bf16 v[204:207], a[44:47], v[56:59], v[204:207]
ds_read_b128 a[8:11], v1 offset:10240
v_cvt_pk_bf16_f32 v76, v28, v29
v_mfma_f32_16x16x32_bf16 v[208:211], a[48:51], v[56:59], v[208:211]
buffer_load_dwordx4 v13, s[72:75], 0 offen offset:1024 lds
v_mfma_f32_16x16x32_bf16 v[240:243], a[48:51], v[60:63], v[240:243]
ds_read_b128 a[12:15], v1 offset:11264
v_cvt_pk_bf16_f32 v77, v30, v31
v_mfma_f32_16x16x32_bf16 v[244:247], a[52:55], v[60:63], v[244:247]
buffer_load_dwordx4 v12, s[72:75], s12 offen offset:2048 lds
v_mfma_f32_16x16x32_bf16 v[212:215], a[52:55], v[56:59], v[212:215]
ds_read_b128 a[16:19], v1 offset:12288
v_exp_f32 v41, v41
v_mfma_f32_16x16x32_bf16 v[216:219], a[56:59], v[56:59], v[216:219]
ds_read_b128 a[20:23], v1 offset:13312
v_exp_f32 v42, v42
v_mfma_f32_16x16x32_bf16 v[248:251], a[56:59], v[60:63], v[248:251]
buffer_load_dwordx4 v13, s[72:75], s12 offen offset:3072 lds
v_mfma_f32_16x16x32_bf16 v[252:255], a[60:63], v[60:63], v[252:255]
ds_read_b128 a[24:27], v1 offset:14336
s_waitcnt lgkmcnt(3)
v_mfma_f32_16x16x32_bf16 v[220:223], a[60:63], v[56:59], v[220:223]
ds_read_b128 a[28:31], v1 offset:15360
v_add_u32 v12, 0x20000, v12
v_smfmac_f32_16x16x64_bf16 a[228:231], a[232:235], v[56:63], v9
s_add_u32 m0, s17, 0x14000
v_exp_f32 v43, v43
v_mfma_f32_16x16x32_bf16 v[24:27], a[0:3], a[192:195], v[112:115]
buffer_load_dwordx4 v12, s[72:75], 0 offen lds
v_mfma_f32_16x16x32_bf16 v[24:27], a[4:7], a[196:199], v[24:27]
ds_read_b128 a[32:35], v1 offset:0
v_cvt_pk_bf16_f32 v74, v40, v41
v_mfma_f32_16x16x32_bf16 v[24:27], a[8:11], a[200:203], v[24:27]
ds_read_b128 a[36:39], v1 offset:1024
v_exp_f32 v44, v44
v_mfma_f32_16x16x32_bf16 v[24:27], a[12:15], a[204:207], v[24:27]
ds_read_b128 a[40:43], v1 offset:2048
v_exp_f32 v45, v45
v_mfma_f32_16x16x32_bf16 v[28:31], a[0:3], a[208:211], v[92:95]
ds_read_b128 a[44:47], v1 offset:3072
v_exp_f32 v46, v46
v_mfma_f32_16x16x32_bf16 v[28:31], a[4:7], a[212:215], v[28:31]
s_waitcnt lgkmcnt(4)
v_exp_f32 v47, v47
v_mfma_f32_16x16x32_bf16 v[28:31], a[8:11], a[216:219], v[28:31]
ds_read_b128 a[48:51], v1 offset:4096
v_add_u32 v13, 0x20000, v13
v_mfma_f32_16x16x32_bf16 v[28:31], a[12:15], a[220:223], v[28:31]
buffer_load_dwordx4 v13, s[72:75], 0 offen offset:1024 lds
v_cvt_pk_bf16_f32 v75, v42, v43
v_mfma_f32_16x16x32_bf16 v[40:43], a[16:19], a[192:195], v[116:119]
ds_read_b128 a[52:55], v1 offset:5120
v_exp_f32 v24, v24
v_mfma_f32_16x16x32_bf16 v[40:43], a[20:23], a[196:199], v[40:43]
buffer_load_dwordx4 v12, s[72:75], s12 offen offset:2048 lds
v_mfma_f32_16x16x32_bf16 v[40:43], a[24:27], a[200:203], v[40:43]
ds_read_b128 a[56:59], v1 offset:6144
v_exp_f32 v25, v25
v_mfma_f32_16x16x32_bf16 v[40:43], a[28:31], a[204:207], v[40:43]
ds_read_b128 a[60:63], v1 offset:7168
v_cvt_pk_bf16_f32 v78, v44, v45
v_cvt_pk_bf16_f32 v79, v46, v47
v_mfma_f32_16x16x32_bf16 v[44:47], a[16:19], a[208:211], v[92:95]
buffer_load_dwordx4 v13, s[72:75], s12 offen offset:3072 lds
v_mfma_f32_16x16x32_bf16 v[44:47], a[20:23], a[212:215], v[44:47]
v_exp_f32 v26, v26
v_mfma_f32_16x16x32_bf16 v[44:47], a[24:27], a[216:219], v[44:47]
v_exp_f32 v27, v27
v_mfma_f32_16x16x32_bf16 v[44:47], a[28:31], a[220:223], v[44:47]
s_waitcnt lgkmcnt(0)
v_exp_f32 v28, v28
v_exp_f32 v29, v29
v_mfma_f32_16x16x32_bf16 v[192:195], a[32:35], v[72:75], v[192:195]
ds_read_b128 a[0:3], v1 offset:24576
v_cvt_pk_bf16_f32 v56, v24, v25
v_mfma_f32_16x16x32_bf16 v[224:227], a[32:35], v[76:79], v[224:227]
ds_read_b128 a[4:7], v1 offset:25600
v_add_u32 v12, 0x20000, v12
v_mfma_f32_16x16x32_bf16 v[228:231], a[36:39], v[76:79], v[228:231]
s_add_u32 m0, s16, 0x0
v_exp_f32 v30, v30
v_mfma_f32_16x16x32_bf16 v[196:199], a[36:39], v[72:75], v[196:199]
buffer_load_dwordx4 v12, s[72:75], 0 offen lds
v_mfma_f32_16x16x32_bf16 v[200:203], a[40:43], v[72:75], v[200:203]
ds_read_b128 a[8:11], v1 offset:26624
v_add_u32 v13, 0x20000, v13
v_mfma_f32_16x16x32_bf16 v[232:235], a[40:43], v[76:79], v[232:235]
buffer_load_dwordx4 v13, s[72:75], 0 offen offset:1024 lds
v_mfma_f32_16x16x32_bf16 v[236:239], a[44:47], v[76:79], v[236:239]
ds_read_b128 a[12:15], v1 offset:27648
v_cvt_pk_bf16_f32 v57, v26, v27
v_mfma_f32_16x16x32_bf16 v[204:207], a[44:47], v[72:75], v[204:207]
buffer_load_dwordx4 v12, s[72:75], s12 offen offset:2048 lds
v_mfma_f32_16x16x32_bf16 v[208:211], a[48:51], v[72:75], v[208:211]
ds_read_b128 a[16:19], v1 offset:28672
v_cvt_pk_bf16_f32 v60, v28, v29
v_mfma_f32_16x16x32_bf16 v[240:243], a[48:51], v[76:79], v[240:243]
buffer_load_dwordx4 v13, s[72:75], s12 offen offset:3072 lds
v_mfma_f32_16x16x32_bf16 v[244:247], a[52:55], v[76:79], v[244:247]
ds_read_b128 a[20:23], v1 offset:29696
v_exp_f32 v31, v31
v_mfma_f32_16x16x32_bf16 v[212:215], a[52:55], v[72:75], v[212:215]
ds_read_b128 a[24:27], v1 offset:30720
s_add_u32 m0, s16, 0x4000
v_mfma_f32_16x16x32_bf16 v[216:219], a[56:59], v[72:75], v[216:219]
ds_read_b128 a[28:31], v1 offset:31744
v_add_u32 v12, 0x20000, v12
v_mfma_f32_16x16x32_bf16 v[248:251], a[56:59], v[76:79], v[248:251]
buffer_load_dwordx4 v12, s[72:75], 0 offen lds
v_mfma_f32_16x16x32_bf16 v[252:255], a[60:63], v[76:79], v[252:255]
ds_read_b128 a[32:35], v1 offset:16384
s_waitcnt lgkmcnt(5)
v_mfma_f32_16x16x32_bf16 v[220:223], a[60:63], v[72:75], v[220:223]
ds_read_b128 a[36:39], v1 offset:17408
v_add_u32 v13, 0x20000, v13
v_smfmac_f32_16x16x64_bf16 a[228:231], a[232:235], v[72:79], v9
buffer_load_dwordx4 v13, s[72:75], 0 offen offset:1024 lds
v_cvt_pk_bf16_f32 v61, v30, v31
v_mfma_f32_16x16x32_bf16 v[28:31], a[0:3], a[208:211], v[92:95]
ds_read_b128 a[40:43], v1 offset:18432
v_exp_f32 v40, v40
v_mfma_f32_16x16x32_bf16 v[28:31], a[4:7], a[212:215], v[28:31]
buffer_load_dwordx4 v12, s[72:75], s12 offen offset:2048 lds
v_mfma_f32_16x16x32_bf16 v[28:31], a[8:11], a[216:219], v[28:31]
ds_read_b128 a[44:47], v1 offset:19456
v_exp_f32 v41, v41
v_mfma_f32_16x16x32_bf16 v[28:31], a[12:15], a[220:223], v[28:31]
ds_read_b128 a[48:51], v1 offset:20480
s_waitcnt lgkmcnt(5)
v_exp_f32 v42, v42
v_exp_f32 v43, v43
v_exp_f32 v44, v44
v_exp_f32 v45, v45
v_exp_f32 v46, v46
v_exp_f32 v47, v47
v_cvt_pk_bf16_f32 v62, v44, v45
v_cvt_pk_bf16_f32 v63, v46, v47
v_mfma_f32_16x16x32_bf16 v[44:47], a[16:19], a[208:211], v[92:95]
buffer_load_dwordx4 v13, s[72:75], s12 offen offset:3072 lds
v_mfma_f32_16x16x32_bf16 v[44:47], a[20:23], a[212:215], v[44:47]
ds_read_b128 a[52:55], v1 offset:21504
v_cvt_pk_bf16_f32 v58, v40, v41
v_mfma_f32_16x16x32_bf16 v[44:47], a[24:27], a[216:219], v[44:47]
ds_read_b128 a[56:59], v1 offset:22528
v_cvt_pk_bf16_f32 v59, v42, v43
v_mfma_f32_16x16x32_bf16 v[44:47], a[28:31], a[220:223], v[44:47]
ds_read_b128 a[60:63], v1 offset:23552
v_xor_b32 v1, 0x8000, v1
L_att_h1_0:
s_waitcnt vmcnt(16) lgkmcnt(0)
s_mov_b32 s92, 200000
L_spin_b0:
v_cmp_gt_u32 vcc, 32, v14
s_nop 4
s_cbranch_vccz L_spun_b0
s_sub_u32 s92, s92, 1
s_cbranch_scc1 L_spun_b0
s_sleep 6
buffer_load_dword v14, v15, s[84:87], 0 offen offset:192 sc1
s_waitcnt vmcnt(0)
s_branch L_spin_b0
L_spun_b0:
s_barrier
v_mfma_f32_16x16x32_bf16 v[192:195], a[32:35], v[56:59], v[192:195]
ds_read_b128 a[0:3], v2 offset:8192
v_exp_f32 v28, v28
v_mfma_f32_16x16x32_bf16 v[224:227], a[32:35], v[60:63], v[224:227]
ds_read_b128 a[4:7], v2 offset:9216
v_exp_f32 v29, v29
v_mfma_f32_16x16x32_bf16 v[228:231], a[36:39], v[60:63], v[228:231]
s_add_u32 s101, s101, 0x2000
v_exp_f32 v30, v30
v_mfma_f32_16x16x32_bf16 v[196:199], a[36:39], v[56:59], v[196:199]
buffer_load_dwordx4 a[64:67], v3, s[88:91], s101 offen sc1
v_mfma_f32_16x16x32_bf16 v[200:203], a[40:43], v[56:59], v[200:203]
ds_read_b128 a[8:11], v2 offset:10240
v_exp_f32 v31, v31
v_mfma_f32_16x16x32_bf16 v[232:235], a[40:43], v[60:63], v[232:235]
buffer_load_dwordx4 a[68:71], v3, s[88:91], s101 offen offset:1024 sc1
v_mfma_f32_16x16x32_bf16 v[236:239], a[44:47], v[60:63], v[236:239]
ds_read_b128 a[12:15], v2 offset:11264
s_add_u32 s101, s101, 0x2000
v_mfma_f32_16x16x32_bf16 v[204:207], a[44:47], v[56:59], v[204:207]
buffer_load_dwordx4 a[72:75], v3, s[88:91], s101 offen sc1
v_mfma_f32_16x16x32_bf16 v[208:211], a[48:51], v[56:59], v[208:211]
ds_read_b128 a[16:19], v2 offset:12288
v_cvt_pk_bf16_f32 v76, v28, v29
v_mfma_f32_16x16x32_bf16 v[240:243], a[48:51], v[60:63], v[240:243]
buffer_load_dwordx4 a[76:79], v3, s[88:91], s101 offen offset:1024 sc1
v_mfma_f32_16x16x32_bf16 v[244:247], a[52:55], v[60:63], v[244:247]
ds_read_b128 a[20:23], v2 offset:13312
v_exp_f32 v44, v44
v_mfma_f32_16x16x32_bf16 v[212:215], a[52:55], v[56:59], v[212:215]
ds_read_b128 a[24:27], v2 offset:14336
v_exp_f32 v45, v45
v_mfma_f32_16x16x32_bf16 v[216:219], a[56:59], v[56:59], v[216:219]
ds_read_b128 a[28:31], v2 offset:15360
s_add_u32 s101, s101, 0x2000
v_mfma_f32_16x16x32_bf16 v[248:251], a[56:59], v[60:63], v[248:251]
buffer_load_dwordx4 a[80:83], v3, s[88:91], s101 offen sc1
v_mfma_f32_16x16x32_bf16 v[252:255], a[60:63], v[60:63], v[252:255]
ds_read_b128 a[32:35], v2 offset:0
v_cvt_pk_bf16_f32 v77, v30, v31
v_mfma_f32_16x16x32_bf16 v[220:223], a[60:63], v[56:59], v[220:223]
ds_read_b128 a[36:39], v2 offset:1024
s_waitcnt lgkmcnt(6)
v_smfmac_f32_16x16x64_bf16 a[228:231], a[232:235], v[56:63], v9
buffer_load_dwordx4 a[84:87], v3, s[88:91], s101 offen offset:1024 sc1
v_mfma_f32_16x16x32_bf16 v[28:31], a[0:3], a[208:211], v[92:95]
ds_read_b128 a[40:43], v2 offset:2048
v_exp_f32 v46, v46
v_mfma_f32_16x16x32_bf16 v[28:31], a[4:7], a[212:215], v[28:31]
ds_read_b128 a[44:47], v2 offset:3072
s_add_u32 s101, s101, 0x2000
v_mfma_f32_16x16x32_bf16 v[28:31], a[8:11], a[216:219], v[28:31]
buffer_load_dwordx4 a[88:91], v3, s[88:91], s101 offen sc1
v_mfma_f32_16x16x32_bf16 v[28:31], a[12:15], a[220:223], v[28:31]
ds_read_b128 a[48:51], v2 offset:4096
s_waitcnt lgkmcnt(5)
v_exp_f32 v47, v47
v_cvt_pk_bf16_f32 v78, v44, v45
v_cvt_pk_bf16_f32 v79, v46, v47
v_mfma_f32_16x16x32_bf16 v[44:47], a[16:19], a[208:211], v[92:95]
ds_read_b128 a[52:55], v2 offset:5120
v_mfma_f32_16x16x32_bf16 v[44:47], a[20:23], a[212:215], v[44:47]
buffer_load_dwordx4 a[92:95], v3, s[88:91], s101 offen offset:1024 sc1
v_mfma_f32_16x16x32_bf16 v[44:47], a[24:27], a[216:219], v[44:47]
ds_read_b128 a[56:59], v2 offset:6144
v_mfma_f32_16x16x32_bf16 v[44:47], a[28:31], a[220:223], v[44:47]
ds_read_b128 a[60:63], v2 offset:7168
s_waitcnt lgkmcnt(0)
v_mfma_f32_16x16x32_bf16 v[224:227], a[32:35], v[76:79], v[224:227]
ds_read_b128 a[0:3], v2 offset:24576
s_add_u32 s101, s101, 0x2000
v_mfma_f32_16x16x32_bf16 v[228:231], a[36:39], v[76:79], v[228:231]
buffer_load_dwordx4 a[96:99], v3, s[88:91], s101 offen sc1
v_mfma_f32_16x16x32_bf16 v[232:235], a[40:43], v[76:79], v[232:235]
ds_read_b128 a[4:7], v2 offset:25600
v_exp_f32 v28, v28
v_mfma_f32_16x16x32_bf16 v[236:239], a[44:47], v[76:79], v[236:239]
buffer_load_dwordx4 a[100:103], v3, s[88:91], s101 offen offset:1024 sc1
v_mfma_f32_16x16x32_bf16 v[240:243], a[48:51], v[76:79], v[240:243]
ds_read_b128 a[8:11], v2 offset:26624
s_add_u32 s101, s101, 0x2000
v_mfma_f32_16x16x32_bf16 v[244:247], a[52:55], v[76:79], v[244:247]
buffer_load_dwordx4 a[104:107], v3, s[88:91], s101 offen sc1
v_mfma_f32_16x16x32_bf16 v[248:251], a[56:59], v[76:79], v[248:251]
ds_read_b128 a[12:15], v2 offset:27648
s_waitcnt lgkmcnt(0)
v_mfma_f32_16x16x32_bf16 v[252:255], a[60:63], v[76:79], v[252:255]
buffer_load_dwordx4 a[108:111], v3, s[88:91], s101 offen offset:1024 sc1
ds_read_b128 a[16:19], v2 offset:28672
v_mfma_f32_16x16x32_bf16 a[228:231], a[236:239], v[76:79], a[228:231]
ds_read_b128 a[20:23], v2 offset:29696
s_add_u32 s101, s101, 0x2000
v_exp_f32 v29, v29
v_exp_f32 v30, v30
v_exp_f32 v31, v31
v_cvt_pk_bf16_f32 v60, v28, v29
v_cvt_pk_bf16_f32 v61, v30, v31
v_mfma_f32_16x16x32_bf16 v[28:31], a[0:3], a[208:211], v[120:123]
buffer_load_dwordx4 a[112:115], v3, s[88:91], s101 offen sc1
ds_read_b128 a[24:27], v2 offset:30720
v_mfma_f32_16x16x32_bf16 v[28:31], a[4:7], a[212:215], v[28:31]
ds_read_b128 a[28:31], v2 offset:31744
s_waitcnt lgkmcnt(0)
v_mfma_f32_16x16x32_bf16 v[28:31], a[8:11], a[216:219], v[28:31]
buffer_load_dwordx4 a[116:119], v3, s[88:91], s101 offen offset:1024 sc1
v_mfma_f32_16x16x32_bf16 v[28:31], a[12:15], a[220:223], v[28:31]
ds_read_b128 a[32:35], v2 offset:16384
s_add_u32 s101, s101, 0x2000
v_exp_f32 v44, v44
v_exp_f32 v45, v45
v_exp_f32 v46, v46
v_exp_f32 v47, v47
v_cvt_pk_bf16_f32 v62, v44, v45
v_cvt_pk_bf16_f32 v63, v46, v47
v_mfma_f32_16x16x32_bf16 v[44:47], a[16:19], a[208:211], v[124:127]
buffer_load_dwordx4 a[120:123], v3, s[88:91], s101 offen sc1
v_mfma_f32_16x16x32_bf16 v[44:47], a[20:23], a[212:215], v[44:47]
buffer_load_dwordx4 a[124:127], v3, s[88:91], s101 offen offset:1024 sc1
v_mfma_f32_16x16x32_bf16 v[44:47], a[24:27], a[216:219], v[44:47]
ds_read_b128 a[36:39], v2 offset:17408
v_mfma_f32_16x16x32_bf16 v[44:47], a[28:31], a[220:223], v[44:47]
ds_read_b128 a[40:43], v2 offset:18432
ds_read_b128 a[44:47], v2 offset:19456
ds_read_b128 a[48:51], v2 offset:20480
ds_read_b128 a[52:55], v2 offset:21504
ds_read_b128 a[56:59], v2 offset:22528
ds_read_b128 a[60:63], v2 offset:23552
v_xor_b32 v2, 0x38000, v2
s_waitcnt lgkmcnt(0)
s_barrier
v_accvgpr_read_b32 v6, a228
v_accvgpr_read_b32 v7, a229
v_add_f32 v6, v6, v7
v_cmp_nge_f32 vcc, 0x6f800000, v6
v_rcp_f32 v6, v6
s_or_b64 s[34:35], s[34:35], vcc
v_mfma_f32_16x16x32_bf16 v[224:227], a[32:35], v[60:63], v[224:227]
ds_read_b128 a[32:35], v1 offset:0
v_exp_f32 v28, v28
v_mfma_f32_16x16x32_bf16 v[228:231], a[36:39], v[60:63], v[228:231]
ds_read_b128 a[36:39], v1 offset:1024
v_exp_f32 v29, v29
v_mfma_f32_16x16x32_bf16 v[232:235], a[40:43], v[60:63], v[232:235]
ds_read_b128 a[40:43], v1 offset:2048
v_exp_f32 v30, v30
v_mfma_f32_16x16x32_bf16 v[236:239], a[44:47], v[60:63], v[236:239]
ds_read_b128 a[44:47], v1 offset:3072
v_exp_f32 v31, v31
v_mfma_f32_16x16x32_bf16 v[240:243], a[48:51], v[60:63], v[240:243]
ds_read_b128 a[48:51], v1 offset:4096
v_exp_f32 v44, v44
v_mfma_f32_16x16x32_bf16 v[244:247], a[52:55], v[60:63], v[244:247]
ds_read_b128 a[52:55], v1 offset:5120
v_exp_f32 v45, v45
v_mfma_f32_16x16x32_bf16 v[248:251], a[56:59], v[60:63], v[248:251]
ds_read_b128 a[56:59], v1 offset:6144
v_exp_f32 v46, v46
v_mfma_f32_16x16x32_bf16 v[252:255], a[60:63], v[60:63], v[252:255]
ds_read_b128 a[60:63], v1 offset:7168
v_exp_f32 v47, v47
v_mfma_f32_16x16x32_bf16 a[228:231], a[236:239], v[60:63], a[228:231]
v_cvt_pk_bf16_f32 v76, v28, v29
v_cvt_pk_bf16_f32 v77, v30, v31
v_cvt_pk_bf16_f32 v78, v44, v45
v_cvt_pk_bf16_f32 v79, v46, v47
s_add_u32 s8, s30, 0x0
v_pk_mul_f32 v[192:193], v[192:193], v[6:7] op_sel_hi:[1,0]
v_pk_mul_f32 v[194:195], v[194:195], v[6:7] op_sel_hi:[1,0]
v_pk_mul_f32 v[196:197], v[196:197], v[6:7] op_sel_hi:[1,0]
v_pk_mul_f32 v[198:199], v[198:199], v[6:7] op_sel_hi:[1,0]
v_cvt_pk_bf16_f32 v192, v192, v193
v_cvt_pk_bf16_f32 v193, v194, v195
v_cvt_pk_bf16_f32 v194, v196, v197
v_cvt_pk_bf16_f32 v195, v198, v199
buffer_store_dwordx4 v[192:195], v3, s[88:91], s8 offen sc1
s_add_u32 s8, s30, 0x2000
v_pk_mul_f32 v[200:201], v[200:201], v[6:7] op_sel_hi:[1,0]
v_pk_mul_f32 v[202:203], v[202:203], v[6:7] op_sel_hi:[1,0]
v_pk_mul_f32 v[204:205], v[204:205], v[6:7] op_sel_hi:[1,0]
v_pk_mul_f32 v[206:207], v[206:207], v[6:7] op_sel_hi:[1,0]
v_cvt_pk_bf16_f32 v200, v200, v201
v_cvt_pk_bf16_f32 v201, v202, v203
v_cvt_pk_bf16_f32 v202, v204, v205
v_cvt_pk_bf16_f32 v203, v206, v207
buffer_store_dwordx4 v[200:203], v3, s[88:91], s8 offen sc1
s_waitcnt lgkmcnt(0)
v_mfma_f32_16x16x32_bf16 v[224:227], a[32:35], v[76:79], v[224:227]
s_add_u32 s8, s30, 0x4000
v_mul_f32 v208, v6, v208
v_mfma_f32_16x16x32_bf16 v[228:231], a[36:39], v[76:79], v[228:231]
v_mul_f32 v209, v6, v209
v_mul_f32 v210, v6, v210
v_mfma_f32_16x16x32_bf16 v[232:235], a[40:43], v[76:79], v[232:235]
v_mul_f32 v211, v6, v211
v_mul_f32 v212, v6, v212
v_mfma_f32_16x16x32_bf16 v[236:239], a[44:47], v[76:79], v[236:239]
v_mul_f32 v213, v6, v213
v_mul_f32 v214, v6, v214
v_mfma_f32_16x16x32_bf16 v[240:243], a[48:51], v[76:79], v[240:243]
v_mul_f32 v215, v6, v215
v_cvt_pk_bf16_f32 v208, v208, v209
v_mfma_f32_16x16x32_bf16 v[244:247], a[52:55], v[76:79], v[244:247]
v_cvt_pk_bf16_f32 v209, v210, v211
v_cvt_pk_bf16_f32 v210, v212, v213
v_mfma_f32_16x16x32_bf16 v[248:251], a[56:59], v[76:79], v[248:251]
v_cvt_pk_bf16_f32 v211, v214, v215
buffer_store_dwordx4 v[208:211], v3, s[88:91], s8 offen sc1
v_mfma_f32_16x16x32_bf16 v[252:255], a[60:63], v[76:79], v[252:255]
s_add_u32 s8, s30, 0x6000
v_mul_f32 v216, v6, v216
v_mfma_f32_16x16x32_bf16 a[228:231], a[236:239], v[76:79], a[228:231]
v_mul_f32 v217, v6, v217
v_mul_f32 v218, v6, v218
v_mul_f32 v219, v6, v219
v_mul_f32 v220, v6, v220
v_mul_f32 v221, v6, v221
v_mul_f32 v222, v6, v222
v_mul_f32 v223, v6, v223
v_cvt_pk_bf16_f32 v216, v216, v217
v_cvt_pk_bf16_f32 v217, v218, v219
v_cvt_pk_bf16_f32 v218, v220, v221
v_cvt_pk_bf16_f32 v219, v222, v223
buffer_store_dwordx4 v[216:219], v3, s[88:91], s8 offen sc1
s_branch L_att_fin
L_att_sh0_1:
v_mfma_f32_16x16x32_bf16 v[192:195], a[32:35], v[56:59], v[192:195]
v_exp_f32 v30, v30
v_mfma_f32_16x16x32_bf16 v[224:227], a[32:35], v[60:63], v[224:227]
buffer_load_dword v14, v15, s[84:87], 0 offen offset:192 sc1
v_mfma_f32_16x16x32_bf16 v[228:231], a[36:39], v[60:63], v[228:231]
v_exp_f32 v31, v31
v_mfma_f32_16x16x32_bf16 v[196:199], a[36:39], v[56:59], v[196:199]
s_add_u32 m0, s17, 0x10000
v_exp_f32 v40, v40
v_mfma_f32_16x16x32_bf16 v[200:203], a[40:43], v[56:59], v[200:203]
ds_read_b128 a[0:3], v1 offset:8192
v_cvt_pk_bf16_f32 v72, v24, v25
v_mfma_f32_16x16x32_bf16 v[232:235], a[40:43], v[60:63], v[232:235]
ds_read_b128 a[4:7], v1 offset:9216
v_cvt_pk_bf16_f32 v73, v26, v27
v_mfma_f32_16x16x32_bf16 v[236:239], a[44:47], v[60:63], v[236:239]
buffer_load_dwordx4 v12, s[72:75], 0 offen lds
v_mfma_f32_16x16x32_bf16 v[204:207], a[44:47], v[56:59], v[204:207]
ds_read_b128 a[8:11], v1 offset:10240
v_cvt_pk_bf16_f32 v76, v28, v29
v_mfma_f32_16x16x32_bf16 v[208:211], a[48:51], v[56:59], v[208:211]
buffer_load_dwordx4 v13, s[72:75], 0 offen offset:1024 lds
v_mfma_f32_16x16x32_bf16 v[240:243], a[48:51], v[60:63], v[240:243]
ds_read_b128 a[12:15], v1 offset:11264
v_cvt_pk_bf16_f32 v77, v30, v31
v_mfma_f32_16x16x32_bf16 v[244:247], a[52:55], v[60:63], v[244:247]
buffer_load_dwordx4 v12, s[72:75], s12 offen offset:2048 lds
v_mfma_f32_16x16x32_bf16 v[212:215], a[52:55], v[56:59], v[212:215]
ds_read_b128 a[16:19], v1 offset:12288
v_exp_f32 v41, v41
v_mfma_f32_16x16x32_bf16 v[216:219], a[56:59], v[56:59], v[216:219]
ds_read_b128 a[20:23], v1 offset:13312
v_exp_f32 v42, v42
v_mfma_f32_16x16x32_bf16 v[248:251], a[56:59], v[60:63], v[248:251]
buffer_load_dwordx4 v13, s[72:75], s12 offen offset:3072 lds
v_mfma_f32_16x16x32_bf16 v[252:255], a[60:63], v[60:63], v[252:255]
ds_read_b128 a[24:27], v1 offset:14336
s_waitcnt lgkmcnt(3)
v_mfma_f32_16x16x32_bf16 v[220:223], a[60:63], v[56:59], v[220:223]
ds_read_b128 a[28:31], v1 offset:15360
v_add_u32 v12, 0x20000, v12
v_smfmac_f32_16x16x64_bf16 a[228:231], a[232:235], v[56:63], v9
s_add_u32 m0, s17, 0x14000
v_exp_f32 v43, v43
v_mfma_f32_16x16x32_bf16 v[24:27], a[0:3], a[192:195], v[88:91]
buffer_load_dwordx4 v12, s[72:75], 0 offen lds
v_mfma_f32_16x16x32_bf16 v[24:27], a[4:7], a[196:199], v[24:27]
ds_read_b128 a[32:35], v1 offset:0
v_cvt_pk_bf16_f32 v74, v40, v41
v_mfma_f32_16x16x32_bf16 v[24:27], a[8:11], a[200:203], v[24:27]
ds_read_b128 a[36:39], v1 offset:1024
v_exp_f32 v44, v44
v_mfma_f32_16x16x32_bf16 v[24:27], a[12:15], a[204:207], v[24:27]
ds_read_b128 a[40:43], v1 offset:2048
v_exp_f32 v45, v45
v_mfma_f32_16x16x32_bf16 v[28:31], a[0:3], a[208:211], v[92:95]
ds_read_b128 a[44:47], v1 offset:3072
v_exp_f32 v46, v46
v_mfma_f32_16x16x32_bf16 v[28:31], a[4:7], a[212:215], v[28:31]
s_waitcnt lgkmcnt(4)
v_exp_f32 v47, v47
v_mfma_f32_16x16x32_bf16 v[28:31], a[8:11], a[216:219], v[28:31]
ds_read_b128 a[48:51], v1 offset:4096
v_add_u32 v13, 0x20000, v13
v_mfma_f32_16x16x32_bf16 v[28:31], a[12:15], a[220:223], v[28:31]
buffer_load_dwordx4 v13, s[72:75], 0 offen offset:1024 lds
v_cvt_pk_bf16_f32 v75, v42, v43
v_mfma_f32_16x16x32_bf16 v[40:43], a[16:19], a[192:195], v[88:91]
ds_read_b128 a[52:55], v1 offset:5120
v_exp_f32 v24, v24
v_mfma_f32_16x16x32_bf16 v[40:43], a[20:23], a[196:199], v[40:43]
buffer_load_dwordx4 v12, s[72:75], s12 offen offset:2048 lds
v_mfma_f32_16x16x32_bf16 v[40:43], a[24:27], a[200:203], v[40:43]
ds_read_b128 a[56:59], v1 offset:6144
v_exp_f32 v25, v25
v_mfma_f32_16x16x32_bf16 v[40:43], a[28:31], a[204:207], v[40:43]
ds_read_b128 a[60:63], v1 offset:7168
v_cvt_pk_bf16_f32 v78, v44, v45
v_cvt_pk_bf16_f32 v79, v46, v47
v_mfma_f32_16x16x32_bf16 v[44:47], a[16:19], a[208:211], v[92:95]
buffer_load_dwordx4 v13, s[72:75], s12 offen offset:3072 lds
v_mfma_f32_16x16x32_bf16 v[44:47], a[20:23], a[212:215], v[44:47]
v_exp_f32 v26, v26
v_mfma_f32_16x16x32_bf16 v[44:47], a[24:27], a[216:219], v[44:47]
v_exp_f32 v27, v27
v_mfma_f32_16x16x32_bf16 v[44:47], a[28:31], a[220:223], v[44:47]
s_waitcnt lgkmcnt(0)
v_exp_f32 v28, v28
v_exp_f32 v29, v29
v_mfma_f32_16x16x32_bf16 v[192:195], a[32:35], v[72:75], v[192:195]
s_add_u32 m0, s16, 0x0
v_add_u32 v12, 0x20000, v12
v_cvt_pk_bf16_f32 v56, v24, v25
v_mfma_f32_16x16x32_bf16 v[224:227], a[32:35], v[76:79], v[224:227]
buffer_load_dwordx4 v12, s[72:75], 0 offen lds
v_mfma_f32_16x16x32_bf16 v[228:231], a[36:39], v[76:79], v[228:231]
ds_read_b128 a[0:3], v1 offset:24576
v_cvt_pk_bf16_f32 v57, v26, v27
v_mfma_f32_16x16x32_bf16 v[196:199], a[36:39], v[72:75], v[196:199]
v_exp_f32 v30, v30
v_mfma_f32_16x16x32_bf16 v[200:203], a[40:43], v[72:75], v[200:203]
ds_read_b128 a[4:7], v1 offset:25600
v_cvt_pk_bf16_f32 v60, v28, v29
v_mfma_f32_16x16x32_bf16 v[232:235], a[40:43], v[76:79], v[232:235]
ds_read_b128 a[8:11], v1 offset:26624
v_add_u32 v13, 0x20000, v13
v_mfma_f32_16x16x32_bf16 v[236:239], a[44:47], v[76:79], v[236:239]
buffer_load_dwordx4 v13, s[72:75], 0 offen offset:1024 lds
v_mfma_f32_16x16x32_bf16 v[204:207], a[44:47], v[72:75], v[204:207]
ds_read_b128 a[12:15], v1 offset:27648
v_exp_f32 v31, v31
v_mfma_f32_16x16x32_bf16 v[208:211], a[48:51], v[72:75], v[208:211]
buffer_load_dwordx4 v12, s[72:75], s12 offen offset:2048 lds
v_mfma_f32_16x16x32_bf16 v[240:243], a[48:51], v[76:79], v[240:243]
ds_read_b128 a[16:19], v1 offset:28672
v_exp_f32 v40, v40
v_mfma_f32_16x16x32_bf16 v[244:247], a[52:55], v[76:79], v[244:247]
ds_read_b128 a[20:23], v1 offset:29696
v_cvt_pk_bf16_f32 v61, v30, v31
v_mfma_f32_16x16x32_bf16 v[212:215], a[52:55], v[72:75], v[212:215]
buffer_load_dwordx4 v13, s[72:75], s12 offen offset:3072 lds
v_mfma_f32_16x16x32_bf16 v[216:219], a[56:59], v[72:75], v[216:219]
ds_read_b128 a[24:27], v1 offset:30720
v_exp_f32 v41, v41
v_mfma_f32_16x16x32_bf16 v[248:251], a[56:59], v[76:79], v[248:251]
ds_read_b128 a[28:31], v1 offset:31744
v_exp_f32 v42, v42
v_mfma_f32_16x16x32_bf16 v[252:255], a[60:63], v[76:79], v[252:255]
ds_read_b128 a[32:35], v1 offset:16384
v_cvt_pk_bf16_f32 v58, v40, v41
v_mfma_f32_16x16x32_bf16 v[220:223], a[60:63], v[72:75], v[220:223]
s_waitcnt lgkmcnt(5)
v_exp_f32 v43, v43
v_smfmac_f32_16x16x64_bf16 a[228:231], a[232:235], v[72:79], v9
ds_read_b128 a[36:39], v1 offset:17408
v_add_u32 v12, 0x20000, v12
v_mfma_f32_16x16x32_bf16 v[24:27], a[0:3], a[192:195], v[112:115]
s_add_u32 m0, s16, 0x4000
v_exp_f32 v44, v44
v_mfma_f32_16x16x32_bf16 v[24:27], a[4:7], a[196:199], v[24:27]
buffer_load_dwordx4 v12, s[72:75], 0 offen lds
v_mfma_f32_16x16x32_bf16 v[24:27], a[8:11], a[200:203], v[24:27]
ds_read_b128 a[40:43], v1 offset:18432
v_add_u32 v13, 0x20000, v13
v_mfma_f32_16x16x32_bf16 v[24:27], a[12:15], a[204:207], v[24:27]
buffer_load_dwordx4 v13, s[72:75], 0 offen offset:1024 lds
v_mfma_f32_16x16x32_bf16 v[28:31], a[0:3], a[208:211], v[92:95]
ds_read_b128 a[44:47], v1 offset:19456
v_cvt_pk_bf16_f32 v59, v42, v43
v_mfma_f32_16x16x32_bf16 v[28:31], a[4:7], a[212:215], v[28:31]
ds_read_b128 a[48:51], v1 offset:20480
v_exp_f32 v45, v45
v_mfma_f32_16x16x32_bf16 v[28:31], a[8:11], a[216:219], v[28:31]
s_waitcnt lgkmcnt(5)
v_exp_f32 v46, v46
v_mfma_f32_16x16x32_bf16 v[28:31], a[12:15], a[220:223], v[28:31]
buffer_load_dwordx4 v12, s[72:75], s12 offen offset:2048 lds
v_mfma_f32_16x16x32_bf16 v[40:43], a[16:19], a[192:195], v[116:119]
ds_read_b128 a[52:55], v1 offset:21504
v_exp_f32 v47, v47
v_mfma_f32_16x16x32_bf16 v[40:43], a[20:23], a[196:199], v[40:43]
ds_read_b128 a[56:59], v1 offset:22528
v_exp_f32 v24, v24
v_mfma_f32_16x16x32_bf16 v[40:43], a[24:27], a[200:203], v[40:43]
ds_read_b128 a[60:63], v1 offset:23552
v_xor_b32 v1, 0x8000, v1
v_mfma_f32_16x16x32_bf16 v[40:43], a[28:31], a[204:207], v[40:43]
v_exp_f32 v25, v25
v_cvt_pk_bf16_f32 v62, v44, v45
v_cvt_pk_bf16_f32 v63, v46, v47
v_mfma_f32_16x16x32_bf16 v[44:47], a[16:19], a[208:211], v[92:95]
v_exp_f32 v26, v26
v_mfma_f32_16x16x32_bf16 v[44:47], a[20:23], a[212:215], v[44:47]
buffer_load_dwordx4 v13, s[72:75], s12 offen offset:3072 lds
v_mfma_f32_16x16x32_bf16 v[44:47], a[24:27], a[216:219], v[44:47]
v_exp_f32 v27, v27
v_mfma_f32_16x16x32_bf16 v[44:47], a[28:31], a[220:223], v[44:47]
v_exp_f32 v28, v28
v_exp_f32 v29, v29
L_att_h1_1:
s_waitcnt vmcnt(16) lgkmcnt(0)
s_mov_b32 s92, 200000
L_spin_b1:
v_cmp_gt_u32 vcc, 32, v14
s_nop 4
s_cbranch_vccz L_spun_b1
s_sub_u32 s92, s92, 1
s_cbranch_scc1 L_spun_b1
s_sleep 6
buffer_load_dword v14, v15, s[84:87], 0 offen offset:192 sc1
s_waitcnt vmcnt(0)
s_branch L_spin_b1
L_spun_b1:
s_barrier
v_mfma_f32_16x16x32_bf16 v[192:195], a[32:35], v[56:59], v[192:195]
ds_read_b128 a[0:3], v2 offset:8192
v_cvt_pk_bf16_f32 v72, v24, v25
v_mfma_f32_16x16x32_bf16 v[224:227], a[32:35], v[60:63], v[224:227]
ds_read_b128 a[4:7], v2 offset:9216
v_cvt_pk_bf16_f32 v73, v26, v27
v_mfma_f32_16x16x32_bf16 v[228:231], a[36:39], v[60:63], v[228:231]
s_add_u32 s101, s101, 0x2000
v_exp_f32 v30, v30
v_mfma_f32_16x16x32_bf16 v[196:199], a[36:39], v[56:59], v[196:199]
buffer_load_dwordx4 a[64:67], v3, s[88:91], s101 offen sc1
v_mfma_f32_16x16x32_bf16 v[200:203], a[40:43], v[56:59], v[200:203]
ds_read_b128 a[8:11], v2 offset:10240
v_cvt_pk_bf16_f32 v76, v28, v29
v_mfma_f32_16x16x32_bf16 v[232:235], a[40:43], v[60:63], v[232:235]
buffer_load_dwordx4 a[68:71], v3, s[88:91], s101 offen offset:1024 sc1
v_mfma_f32_16x16x32_bf16 v[236:239], a[44:47], v[60:63], v[236:239]
ds_read_b128 a[12:15], v2 offset:11264
s_add_u32 s101, s101, 0x2000
v_mfma_f32_16x16x32_bf16 v[204:207], a[44:47], v[56:59], v[204:207]
buffer_load_dwordx4 a[72:75], v3, s[88:91], s101 offen sc1
v_mfma_f32_16x16x32_bf16 v[208:211], a[48:51], v[56:59], v[208:211]
ds_read_b128 a[16:19], v2 offset:12288
v_exp_f32 v31, v31
v_mfma_f32_16x16x32_bf16 v[240:243], a[48:51], v[60:63], v[240:243]
buffer_load_dwordx4 a[76:79], v3, s[88:91], s101 offen offset:1024 sc1
v_mfma_f32_16x16x32_bf16 v[244:247], a[52:55], v[60:63], v[244:247]
ds_read_b128 a[20:23], v2 offset:13312
v_exp_f32 v40, v40
v_mfma_f32_16x16x32_bf16 v[212:215], a[52:55], v[56:59], v[212:215]
ds_read_b128 a[24:27], v2 offset:14336
v_exp_f32 v41, v41
v_mfma_f32_16x16x32_bf16 v[216:219], a[56:59], v[56:59], v[216:219]
ds_read_b128 a[28:31], v2 offset:15360
s_add_u32 s101, s101, 0x2000
v_mfma_f32_16x16x32_bf16 v[248:251], a[56:59], v[60:63], v[248:251]
buffer_load_dwordx4 a[80:83], v3, s[88:91], s101 offen sc1
v_mfma_f32_16x16x32_bf16 v[252:255], a[60:63], v[60:63], v[252:255]
ds_read_b128 a[32:35], v2 offset:0
v_cvt_pk_bf16_f32 v77, v30, v31
v_mfma_f32_16x16x32_bf16 v[220:223], a[60:63], v[56:59], v[220:223]
ds_read_b128 a[36:39], v2 offset:1024
s_waitcnt lgkmcnt(6)
v_smfmac_f32_16x16x64_bf16 a[228:231], a[232:235], v[56:63], v9
buffer_load_dwordx4 a[84:87], v3, s[88:91], s101 offen offset:1024 sc1
v_mfma_f32_16x16x32_bf16 v[28:31], a[0:3], a[208:211], v[120:123]
ds_read_b128 a[40:43], v2 offset:2048
v_exp_f32 v42, v42
v_mfma_f32_16x16x32_bf16 v[28:31], a[4:7], a[212:215], v[28:31]
ds_read_b128 a[44:47], v2 offset:3072
s_add_u32 s101, s101, 0x2000
v_mfma_f32_16x16x32_bf16 v[28:31], a[8:11], a[216:219], v[28:31]
buffer_load_dwordx4 a[88:91], v3, s[88:91], s101 offen sc1
v_mfma_f32_16x16x32_bf16 v[28:31], a[12:15], a[220:223], v[28:31]
ds_read_b128 a[48:51], v2 offset:4096
s_waitcnt lgkmcnt(5)
v_exp_f32 v43, v43
v_exp_f32 v44, v44
v_exp_f32 v45, v45
v_exp_f32 v46, v46
v_exp_f32 v47, v47
v_cvt_pk_bf16_f32 v78, v44, v45
v_cvt_pk_bf16_f32 v79, v46, v47
v_mfma_f32_16x16x32_bf16 v[44:47], a[16:19], a[208:211], v[124:127]
ds_read_b128 a[52:55], v2 offset:5120
v_cvt_pk_bf16_f32 v74, v40, v41
v_mfma_f32_16x16x32_bf16 v[44:47], a[20:23], a[212:215], v[44:47]
buffer_load_dwordx4 a[92:95], v3, s[88:91], s101 offen offset:1024 sc1
v_mfma_f32_16x16x32_bf16 v[44:47], a[24:27], a[216:219], v[44:47]
ds_read_b128 a[56:59], v2 offset:6144
v_cvt_pk_bf16_f32 v75, v42, v43
v_mfma_f32_16x16x32_bf16 v[44:47], a[28:31], a[220:223], v[44:47]
ds_read_b128 a[60:63], v2 offset:7168
s_waitcnt lgkmcnt(0)
v_mfma_f32_16x16x32_bf16 v[192:195], a[32:35], v[72:75], v[192:195]
s_add_u32 s101, s101, 0x2000
v_exp_f32 v28, v28
v_mfma_f32_16x16x32_bf16 v[224:227], a[32:35], v[76:79], v[224:227]
buffer_load_dwordx4 a[96:99], v3, s[88:91], s101 offen sc1
v_mfma_f32_16x16x32_bf16 v[228:231], a[36:39], v[76:79], v[228:231]
ds_read_b128 a[32:35], v2 offset:16384
v_exp_f32 v29, v29
v_mfma_f32_16x16x32_bf16 v[196:199], a[36:39], v[72:75], v[196:199]
buffer_load_dwordx4 a[100:103], v3, s[88:91], s101 offen offset:1024 sc1
v_mfma_f32_16x16x32_bf16 v[200:203], a[40:43], v[72:75], v[200:203]
ds_read_b128 a[36:39], v2 offset:17408
s_add_u32 s101, s101, 0x2000
v_mfma_f32_16x16x32_bf16 v[232:235], a[40:43], v[76:79], v[232:235]
buffer_load_dwordx4 a[104:107], v3, s[88:91], s101 offen sc1
v_mfma_f32_16x16x32_bf16 v[236:239], a[44:47], v[76:79], v[236:239]
ds_read_b128 a[40:43], v2 offset:18432
v_exp_f32 v30, v30
v_mfma_f32_16x16x32_bf16 v[204:207], a[44:47], v[72:75], v[204:207]
buffer_load_dwordx4 a[108:111], v3, s[88:91], s101 offen offset:1024 sc1
v_mfma_f32_16x16x32_bf16 v[208:211], a[48:51], v[72:75], v[208:211]
ds_read_b128 a[44:47], v2 offset:19456
s_add_u32 s101, s101, 0x2000
v_mfma_f32_16x16x32_bf16 v[240:243], a[48:51], v[76:79], v[240:243]
buffer_load_dwordx4 a[112:115], v3, s[88:91], s101 offen sc1
v_mfma_f32_16x16x32_bf16 v[244:247], a[52:55], v[76:79], v[244:247]
ds_read_b128 a[48:51], v2 offset:20480
v_exp_f32 v31, v31
v_mfma_f32_16x16x32_bf16 v[212:215], a[52:55], v[72:75], v[212:215]
buffer_load_dwordx4 a[116:119], v3, s[88:91], s101 offen offset:1024 sc1
v_mfma_f32_16x16x32_bf16 v[216:219], a[56:59], v[72:75], v[216:219]
ds_read_b128 a[52:55], v2 offset:21504
s_add_u32 s101, s101, 0x2000
v_mfma_f32_16x16x32_bf16 v[248:251], a[56:59], v[76:79], v[248:251]
buffer_load_dwordx4 a[120:123], v3, s[88:91], s101 offen sc1
v_mfma_f32_16x16x32_bf16 v[252:255], a[60:63], v[76:79], v[252:255]
buffer_load_dwordx4 a[124:127], v3, s[88:91], s101 offen offset:1024 sc1
v_mfma_f32_16x16x32_bf16 v[220:223], a[60:63], v[72:75], v[220:223]
ds_read_b128 a[56:59], v2 offset:22528
v_cvt_pk_bf16_f32 v60, v28, v29
v_smfmac_f32_16x16x64_bf16 a[228:231], a[232:235], v[72:79], v9
ds_read_b128 a[60:63], v2 offset:23552
v_xor_b32 v2, 0x38000, v2
v_exp_f32 v44, v44
v_exp_f32 v45, v45
v_exp_f32 v46, v46
v_exp_f32 v47, v47
v_cvt_pk_bf16_f32 v61, v30, v31
v_cvt_pk_bf16_f32 v62, v44, v45
v_cvt_pk_bf16_f32 v63, v46, v47
s_waitcnt lgkmcnt(0)
s_barrier
v_accvgpr_read_b32 v6, a228
v_accvgpr_read_b32 v7, a229
v_add_f32 v6, v6, v7
v_cmp_nge_f32 vcc, 0x6f800000, v6
v_rcp_f32 v6, v6
s_or_b64 s[34:35], s[34:35], vcc
v_mfma_f32_16x16x32_bf16 v[224:227], a[32:35], v[60:63], v[224:227]
s_add_u32 s8, s30, 0x0
v_mul_f32 v192, v6, v192
v_mfma_f32_16x16x32_bf16 v[228:231], a[36:39], v[60:63], v[228:231]
v_mul_f32 v193, v6, v193
v_mul_f32 v194, v6, v194
v_mfma_f32_16x16x32_bf16 v[232:235], a[40:43], v[60:63], v[232:235]
v_mul_f32 v195, v6, v195
v_mul_f32 v196, v6, v196
v_mfma_f32_16x16x32_bf16 v[236:239], a[44:47], v[60:63], v[236:239]
v_mul_f32 v197, v6, v197
v_mul_f32 v198, v6, v198
v_mfma_f32_16x16x32_bf16 v[240:243], a[48:51], v[60:63], v[240:243]
v_mul_f32 v199, v6, v199
v_cvt_pk_bf16_f32 v192, v192, v193
v_mfma_f32_16x16x32_bf16 v[244:247], a[52:55], v[60:63], v[244:247]
v_cvt_pk_bf16_f32 v193, v194, v195
v_cvt_pk_bf16_f32 v194, v196, v197
v_mfma_f32_16x16x32_bf16 v[248:251], a[56:59], v[60:63], v[248:251]
v_cvt_pk_bf16_f32 v195, v198, v199
buffer_store_dwordx4 v[192:195], v3, s[88:91], s8 offen sc1
v_mfma_f32_16x16x32_bf16 v[252:255], a[60:63], v[60:63], v[252:255]
v_mfma_f32_16x16x32_bf16 a[228:231], a[236:239], v[60:63], a[228:231]
s_add_u32 s8, s30, 0x2000
v_pk_mul_f32 v[200:201], v[200:201], v[6:7] op_sel_hi:[1,0]
v_pk_mul_f32 v[202:203], v[202:203], v[6:7] op_sel_hi:[1,0]
v_pk_mul_f32 v[204:205], v[204:205], v[6:7] op_sel_hi:[1,0]
v_pk_mul_f32 v[206:207], v[206:207], v[6:7] op_sel_hi:[1,0]
v_cvt_pk_bf16_f32 v200, v200, v201
v_cvt_pk_bf16_f32 v201, v202, v203
v_cvt_pk_bf16_f32 v202, v204, v205
v_cvt_pk_bf16_f32 v203, v206, v207
buffer_store_dwordx4 v[200:203], v3, s[88:91], s8 offen sc1
s_add_u32 s8, s30, 0x4000
v_pk_mul_f32 v[208:209], v[208:209], v[6:7] op_sel_hi:[1,0]
v_pk_mul_f32 v[210:211], v[210:211], v[6:7] op_sel_hi:[1,0]
v_pk_mul_f32 v[212:213], v[212:213], v[6:7] op_sel_hi:[1,0]
v_pk_mul_f32 v[214:215], v[214:215], v[6:7] op_sel_hi:[1,0]
v_cvt_pk_bf16_f32 v208, v208, v209
v_cvt_pk_bf16_f32 v209, v210, v211
v_cvt_pk_bf16_f32 v210, v212, v213
v_cvt_pk_bf16_f32 v211, v214, v215
buffer_store_dwordx4 v[208:211], v3, s[88:91], s8 offen sc1
s_add_u32 s8, s30, 0x6000
v_pk_mul_f32 v[216:217], v[216:217], v[6:7] op_sel_hi:[1,0]
v_pk_mul_f32 v[218:219], v[218:219], v[6:7] op_sel_hi:[1,0]
v_pk_mul_f32 v[220:221], v[220:221], v[6:7] op_sel_hi:[1,0]
v_pk_mul_f32 v[222:223], v[222:223], v[6:7] op_sel_hi:[1,0]
v_cvt_pk_bf16_f32 v216, v216, v217
v_cvt_pk_bf16_f32 v217, v218, v219
v_cvt_pk_bf16_f32 v218, v220, v221
v_cvt_pk_bf16_f32 v219, v222, v223
buffer_store_dwordx4 v[216:219], v3, s[88:91], s8 offen sc1
L_att_fin:
v_accvgpr_read_b32 v6, a230
v_accvgpr_read_b32 v7, a231
v_add_f32 v6, v6, v7
v_cmp_nge_f32 vcc, 0x6f800000, v6
v_rcp_f32 v6, v6
s_or_b64 s[34:35], s[34:35], vcc
s_add_u32 s8, s31, 0x0
v_pk_mul_f32 v[224:225], v[224:225], v[6:7] op_sel_hi:[1,0]
v_pk_mul_f32 v[226:227], v[226:227], v[6:7] op_sel_hi:[1,0]
v_pk_mul_f32 v[228:229], v[228:229], v[6:7] op_sel_hi:[1,0]
v_pk_mul_f32 v[230:231], v[230:231], v[6:7] op_sel_hi:[1,0]
v_cvt_pk_bf16_f32 v224, v224, v225
v_cvt_pk_bf16_f32 v225, v226, v227
v_cvt_pk_bf16_f32 v226, v228, v229
v_cvt_pk_bf16_f32 v227, v230, v231
buffer_store_dwordx4 v[224:227], v3, s[88:91], s8 offen sc1
s_add_u32 s8, s31, 0x2000
v_pk_mul_f32 v[232:233], v[232:233], v[6:7] op_sel_hi:[1,0]
v_pk_mul_f32 v[234:235], v[234:235], v[6:7] op_sel_hi:[1,0]
v_pk_mul_f32 v[236:237], v[236:237], v[6:7] op_sel_hi:[1,0]
v_pk_mul_f32 v[238:239], v[238:239], v[6:7] op_sel_hi:[1,0]
v_cvt_pk_bf16_f32 v232, v232, v233
v_cvt_pk_bf16_f32 v233, v234, v235
v_cvt_pk_bf16_f32 v234, v236, v237
v_cvt_pk_bf16_f32 v235, v238, v239
buffer_store_dwordx4 v[232:235], v3, s[88:91], s8 offen sc1
s_add_u32 s8, s31, 0x4000
v_pk_mul_f32 v[240:241], v[240:241], v[6:7] op_sel_hi:[1,0]
v_pk_mul_f32 v[242:243], v[242:243], v[6:7] op_sel_hi:[1,0]
v_pk_mul_f32 v[244:245], v[244:245], v[6:7] op_sel_hi:[1,0]
v_pk_mul_f32 v[246:247], v[246:247], v[6:7] op_sel_hi:[1,0]
v_cvt_pk_bf16_f32 v240, v240, v241
v_cvt_pk_bf16_f32 v241, v242, v243
v_cvt_pk_bf16_f32 v242, v244, v245
v_cvt_pk_bf16_f32 v243, v246, v247
buffer_store_dwordx4 v[240:243], v3, s[88:91], s8 offen sc1
s_add_u32 s8, s31, 0x6000
v_pk_mul_f32 v[248:249], v[248:249], v[6:7] op_sel_hi:[1,0]
v_pk_mul_f32 v[250:251], v[250:251], v[6:7] op_sel_hi:[1,0]
v_pk_mul_f32 v[252:253], v[252:253], v[6:7] op_sel_hi:[1,0]
v_pk_mul_f32 v[254:255], v[254:255], v[6:7] op_sel_hi:[1,0]
v_cvt_pk_bf16_f32 v248, v248, v249
v_cvt_pk_bf16_f32 v249, v250, v251
v_cvt_pk_bf16_f32 v250, v252, v253
v_cvt_pk_bf16_f32 v251, v254, v255
buffer_store_dwordx4 v[248:251], v3, s[88:91], s8 offen sc1
s_cmp_lg_u64 s[34:35], 0
s_cselect_b32 s8, 1, 0
s_lshl_b32 s9, s4, 2
s_add_u32 s9, s9, 24576
v_mov_b32 v4, s9
v_mov_b32 v5, s8
ds_write_b32 v4, v5
v_lshrrev_b32 v17, 4, v0
v_lshlrev_b32 v18, 10, v17
v_and_b32 v17, 1, v17
v_lshl_add_u32 v18, v17, 5, v18
v_bfe_u32 v17, v0, 2, 2
v_lshl_add_u32 v18, v17, 6, v18
v_and_b32 v17, 3, v0
v_lshl_add_u32 v4, v17, 3, v18
s_sub_u32 s8, s16, s17
v_add_u32 v6, s8, v4
v_xor_b32 v7, 32, v6
v_add_u32 v4, 65536, v4
v_xor_b32 v5, 32, v4
v_and_b32 v20, 15, v0
v_lshlrev_b32 v20, 2, v20
v_and_b32 v16, 28, v20
s_waitcnt vmcnt(20) lgkmcnt(0)
s_barrier
v_and_b32 v17, 3, v0
v_lshlrev_b32 v17, 2, v17
v_add_u32 v17, 24576, v17
ds_read_b32 v18, v17
s_waitcnt lgkmcnt(0)
v_cmp_ne_u32 vcc, 0, v18
s_cmp_lg_u32 s33, 0
s_cbranch_scc1 L_att_done
s_nop 4
s_cbranch_vccnz L_att_fallback
L_att_done:
ds_read_b64_tr_b16 v[152:153], v4 offset:512
ds_read_b64_tr_b16 v[154:155], v4 offset:4608
ds_read_b64_tr_b16 v[156:157], v4 offset:8704
ds_read_b64_tr_b16 v[158:159], v4 offset:12800
ds_read_b64_tr_b16 v[160:161], v5 offset:512
ds_read_b64_tr_b16 v[162:163], v5 offset:4608
ds_read_b64_tr_b16 v[164:165], v5 offset:8704
ds_read_b64_tr_b16 v[166:167], v5 offset:12800
ds_read_b64_tr_b16 v[168:169], v4 offset:768
ds_read_b64_tr_b16 v[170:171], v4 offset:4864
ds_read_b64_tr_b16 v[172:173], v4 offset:8960
ds_read_b64_tr_b16 v[174:175], v4 offset:13056
ds_read_b64_tr_b16 v[176:177], v5 offset:768
ds_read_b64_tr_b16 v[178:179], v5 offset:4864
ds_read_b64_tr_b16 v[180:181], v5 offset:8960
ds_read_b64_tr_b16 v[182:183], v5 offset:13056
s_lshl_b32 s29, s99, 7
s_lshl_b32 s9, s4, 5
s_add_u32 s29, s29, s9
s_lshl_b32 s9, s29, 2
s_add_u32 s9, s9, 0x3700000
buffer_load_dword v8, v20, s[88:91], s9 offen sc1
buffer_load_dword v9, v20, s[88:91], s9 offen offset:64 sc1
s_waitcnt lgkmcnt(8)
v_mfma_f32_16x16x32_bf16 v[56:59], v[152:155], a[64:67], 0
ds_read_b64_tr_b16 v[184:185], v4 offset:0
v_mov_b32 v88, 0
v_mfma_f32_16x16x32_bf16 v[56:59], v[156:159], a[72:75], v[56:59]
ds_read_b64_tr_b16 v[186:187], v4 offset:4096
v_mov_b32 v89, 0
v_mfma_f32_16x16x32_bf16 v[72:75], v[156:159], a[76:79], 0
ds_read_b64_tr_b16 v[188:189], v4 offset:8192
v_mov_b32 v90, 0
v_mfma_f32_16x16x32_bf16 v[72:75], v[152:155], a[68:71], v[72:75]
ds_read_b64_tr_b16 v[190:191], v4 offset:12288
v_mov_b32 v91, 0
v_mfma_f32_16x16x32_bf16 v[76:79], v[160:163], a[68:71], 0
ds_read_b64_tr_b16 v[192:193], v5 offset:0
v_mov_b32 v92, 0
v_mfma_f32_16x16x32_bf16 v[76:79], v[164:167], a[76:79], v[76:79]
ds_read_b64_tr_b16 v[194:195], v5 offset:4096
v_mov_b32 v93, 0
v_mfma_f32_16x16x32_bf16 v[60:63], v[164:167], a[72:75], 0
ds_read_b64_tr_b16 v[196:197], v5 offset:8192
s_waitcnt lgkmcnt(7)
v_mfma_f32_16x16x32_bf16 v[60:63], v[160:163], a[64:67], v[60:63]
ds_read_b64_tr_b16 v[198:199], v5 offset:12288
v_mov_b32 v94, 0
v_mfma_f32_16x16x32_bf16 v[64:67], v[168:171], a[64:67], 0
ds_read_b64_tr_b16 v[200:201], v4 offset:256
v_mov_b32 v95, 0
v_mfma_f32_16x16x32_bf16 v[64:67], v[172:175], a[72:75], v[64:67]
ds_read_b64_tr_b16 v[202:203], v4 offset:4352
v_mov_b32 v96, 0
v_mfma_f32_16x16x32_bf16 v[80:83], v[172:175], a[76:79], 0
ds_read_b64_tr_b16 v[204:205], v4 offset:8448
v_mov_b32 v97, 0
v_mfma_f32_16x16x32_bf16 v[80:83], v[168:171], a[68:71], v[80:83]
ds_read_b64_tr_b16 v[206:207], v4 offset:12544
v_mov_b32 v98, 0
v_mfma_f32_16x16x32_bf16 v[84:87], v[176:179], a[68:71], 0
ds_read_b64_tr_b16 v[208:209], v5 offset:256
v_mov_b32 v99, 0
v_mfma_f32_16x16x32_bf16 v[84:87], v[180:183], a[76:79], v[84:87]
ds_read_b64_tr_b16 v[210:211], v5 offset:4352
s_waitcnt vmcnt(2) lgkmcnt(6)
v_mfma_f32_16x16x32_bf16 v[68:71], v[180:183], a[72:75], 0
ds_read_b64_tr_b16 v[212:213], v5 offset:8448
s_barrier
v_mfma_f32_16x16x32_bf16 v[68:71], v[176:179], a[64:67], v[68:71]
ds_read_b64_tr_b16 v[214:215], v5 offset:12544
v_mov_b32 v100, 0
s_cmp_lg_u32 s4, 0
s_cbranch_scc1 L_flag_set
s_lshl_b32 s8, s6, 5
s_add_u32 s8, s8, s5
s_and_b32 s92, s8, 0xf0
s_mul_i32 s92, s92, 3
s_add_u32 s8, s8, s92
s_lshl_b32 s8, s8, 2
s_add_u32 s8, s8, 0x3704000
v_mov_b32 v21, 1
s_mov_b64 exec, 1
buffer_store_dword v21, off, s[88:91], s8 sc1
s_mov_b64 exec, -1
L_flag_set:
v_mfma_f32_16x16x32_bf16 v[24:27], v[184:187], a[64:67], 0
ds_read_b64_tr_b16 v[152:153], v4 offset:16896
s_lshl_b32 s29, s29, 11
v_mfma_f32_16x16x32_bf16 v[24:27], v[188:191], a[72:75], v[24:27]
ds_read_b64_tr_b16 v[154:155], v4 offset:20992
s_lshl_b32 s9, s100, 8
v_mfma_f32_16x16x32_bf16 v[40:43], v[188:191], a[76:79], 0
ds_read_b64_tr_b16 v[156:157], v4 offset:25088
s_add_u32 s29, s29, s9
v_mfma_f32_16x16x32_bf16 v[40:43], v[184:187], a[68:71], v[40:43]
ds_read_b64_tr_b16 v[158:159], v4 offset:29184
s_lshl_b32 s9, s14, 7
v_mfma_f32_16x16x32_bf16 v[44:47], v[192:195], a[68:71], 0
ds_read_b64_tr_b16 v[160:161], v5 offset:16896
s_add_u32 s29, s29, s9
v_mfma_f32_16x16x32_bf16 v[44:47], v[196:199], a[76:79], v[44:47]
ds_read_b64_tr_b16 v[162:163], v5 offset:20992
s_add_u32 s31, s29, 0x8000
v_mfma_f32_16x16x32_bf16 v[28:31], v[196:199], a[72:75], 0
ds_read_b64_tr_b16 v[164:165], v5 offset:25088
s_waitcnt lgkmcnt(7)
v_mfma_f32_16x16x32_bf16 v[28:31], v[192:195], a[64:67], v[28:31]
ds_read_b64_tr_b16 v[166:167], v5 offset:29184
s_lshl_b32 s28, s2, 2
v_mfma_f32_16x16x32_bf16 v[32:35], v[200:203], a[64:67], 0
ds_read_b64_tr_b16 v[168:169], v4 offset:17152
s_add_u32 s28, s28, s4
v_mfma_f32_16x16x32_bf16 v[32:35], v[204:207], a[72:75], v[32:35]
ds_read_b64_tr_b16 v[170:171], v4 offset:21248
s_lshl_b32 s28, s28, 12
v_mfma_f32_16x16x32_bf16 v[48:51], v[204:207], a[76:79], 0
ds_read_b64_tr_b16 v[172:173], v4 offset:25344
s_add_u32 s28, s28, 0x3800000
v_mfma_f32_16x16x32_bf16 v[48:51], v[200:203], a[68:71], v[48:51]
ds_read_b64_tr_b16 v[174:175], v4 offset:29440
s_xor_b32 s30, s28, 0x4000
v_mfma_f32_16x16x32_bf16 v[52:55], v[208:211], a[68:71], 0
ds_read_b64_tr_b16 v[176:177], v5 offset:17152
v_and_b32 v18, 16, v0
v_mfma_f32_16x16x32_bf16 v[52:55], v[212:215], a[76:79], v[52:55]
ds_read_b64_tr_b16 v[178:179], v5 offset:21248
s_waitcnt lgkmcnt(6)
v_mfma_f32_16x16x32_bf16 v[36:39], v[212:215], a[72:75], 0
ds_read_b64_tr_b16 v[180:181], v5 offset:25344
v_lshrrev_b32 v19, 5, v0
v_mfma_f32_16x16x32_bf16 v[36:39], v[208:211], a[64:67], v[36:39]
ds_read_b64_tr_b16 v[182:183], v5 offset:29440
v_lshlrev_b32 v19, 4, v19
v_mfma_f32_16x16x32_bf16 v[56:59], v[152:155], a[80:83], v[56:59]
ds_read_b64_tr_b16 v[184:185], v4 offset:16384
v_mov_b32 v101, 0
v_mfma_f32_16x16x32_bf16 v[56:59], v[156:159], a[88:91], v[56:59]
ds_read_b64_tr_b16 v[186:187], v4 offset:20480
v_mov_b32 v102, 0
v_mfma_f32_16x16x32_bf16 v[72:75], v[156:159], a[92:95], v[72:75]
ds_read_b64_tr_b16 v[188:189], v4 offset:24576
v_mov_b32 v103, 0
v_mfma_f32_16x16x32_bf16 v[72:75], v[152:155], a[84:87], v[72:75]
ds_read_b64_tr_b16 v[190:191], v4 offset:28672
v_mov_b32 v104, 0
v_mfma_f32_16x16x32_bf16 v[76:79], v[160:163], a[84:87], v[76:79]
ds_read_b64_tr_b16 v[192:193], v5 offset:16384
v_mov_b32 v105, 0
v_mfma_f32_16x16x32_bf16 v[76:79], v[164:167], a[92:95], v[76:79]
ds_read_b64_tr_b16 v[194:195], v5 offset:20480
v_mov_b32 v106, 0
v_mfma_f32_16x16x32_bf16 v[60:63], v[164:167], a[88:91], v[60:63]
ds_read_b64_tr_b16 v[196:197], v5 offset:24576
s_waitcnt lgkmcnt(7)
v_mfma_f32_16x16x32_bf16 v[60:63], v[160:163], a[80:83], v[60:63]
ds_read_b64_tr_b16 v[198:199], v5 offset:28672
v_mov_b32 v107, 0
v_mfma_f32_16x16x32_bf16 v[64:67], v[168:171], a[80:83], v[64:67]
ds_read_b64_tr_b16 v[200:201], v4 offset:16640
v_mov_b32 v108, 0
v_mfma_f32_16x16x32_bf16 v[64:67], v[172:175], a[88:91], v[64:67]
ds_read_b64_tr_b16 v[202:203], v4 offset:20736
v_mov_b32 v109, 0
v_mfma_f32_16x16x32_bf16 v[80:83], v[172:175], a[92:95], v[80:83]
ds_read_b64_tr_b16 v[204:205], v4 offset:24832
v_mov_b32 v110, 0
v_mfma_f32_16x16x32_bf16 v[80:83], v[168:171], a[84:87], v[80:83]
ds_read_b64_tr_b16 v[206:207], v4 offset:28928
v_mov_b32 v111, 0
v_mfma_f32_16x16x32_bf16 v[84:87], v[176:179], a[84:87], v[84:87]
ds_read_b64_tr_b16 v[208:209], v5 offset:16640
v_lshl_add_u32 v18, v18, 1, v19
v_mfma_f32_16x16x32_bf16 v[84:87], v[180:183], a[92:95], v[84:87]
ds_read_b64_tr_b16 v[210:211], v5 offset:20736
s_waitcnt vmcnt(14) lgkmcnt(6)
v_mfma_f32_16x16x32_bf16 v[68:71], v[180:183], a[88:91], v[68:71]
ds_read_b64_tr_b16 v[212:213], v5 offset:24832
s_barrier
v_mfma_f32_16x16x32_bf16 v[68:71], v[176:179], a[80:83], v[68:71]
ds_read_b64_tr_b16 v[214:215], v5 offset:28928
v_lshl_add_u32 v17, v20, 9, v18
s_cmp_eq_u32 s14, 1
s_cbranch_scc1 L_p4_skip
v_mfma_f32_16x16x32_bf16 v[24:27], v[184:187], a[80:83], v[24:27]
ds_read_b64_tr_b16 v[152:153], v6 offset:512
ds_read_b64_tr_b16 v[154:155], v6 offset:4608
v_mfma_f32_16x16x32_bf16 v[24:27], v[188:191], a[88:91], v[24:27]
ds_read_b64_tr_b16 v[156:157], v6 offset:8704
v_add_u32 v12, 0x20000, v12
v_mfma_f32_16x16x32_bf16 v[40:43], v[188:191], a[92:95], v[40:43]
ds_read_b64_tr_b16 v[158:159], v6 offset:12800
s_add_u32 m0, s17, 0x10000
v_mfma_f32_16x16x32_bf16 v[40:43], v[184:187], a[84:87], v[40:43]
buffer_load_dwordx4 v12, s[72:75], 0 offen lds
v_mfma_f32_16x16x32_bf16 v[44:47], v[192:195], a[84:87], v[44:47]
ds_read_b64_tr_b16 v[160:161], v7 offset:512
ds_read_b64_tr_b16 v[162:163], v7 offset:4608
v_mfma_f32_16x16x32_bf16 v[44:47], v[196:199], a[92:95], v[44:47]
ds_read_b64_tr_b16 v[164:165], v7 offset:8704
v_add_u32 v13, 0x20000, v13
v_mfma_f32_16x16x32_bf16 v[28:31], v[196:199], a[88:91], v[28:31]
ds_read_b64_tr_b16 v[166:167], v7 offset:12800
s_waitcnt lgkmcnt(8)
v_mfma_f32_16x16x32_bf16 v[28:31], v[192:195], a[80:83], v[28:31]
buffer_load_dwordx4 v13, s[72:75], 0 offen offset:1024 lds
v_mfma_f32_16x16x32_bf16 v[32:35], v[200:203], a[80:83], v[32:35]
ds_read_b64_tr_b16 v[168:169], v6 offset:768
ds_read_b64_tr_b16 v[170:171], v6 offset:4864
v_mfma_f32_16x16x32_bf16 v[32:35], v[204:207], a[88:91], v[32:35]
ds_read_b64_tr_b16 v[172:173], v6 offset:8960
v_mfma_f32_16x16x32_bf16 v[48:51], v[204:207], a[92:95], v[48:51]
ds_read_b64_tr_b16 v[174:175], v6 offset:13056
v_mfma_f32_16x16x32_bf16 v[48:51], v[200:203], a[84:87], v[48:51]
buffer_load_dwordx4 v12, s[72:75], s12 offen offset:2048 lds
v_mfma_f32_16x16x32_bf16 v[52:55], v[208:211], a[84:87], v[52:55]
ds_read_b64_tr_b16 v[176:177], v7 offset:768
ds_read_b64_tr_b16 v[178:179], v7 offset:4864
v_mfma_f32_16x16x32_bf16 v[52:55], v[212:215], a[92:95], v[52:55]
ds_read_b64_tr_b16 v[180:181], v7 offset:8960
s_waitcnt lgkmcnt(7)
v_mfma_f32_16x16x32_bf16 v[36:39], v[212:215], a[88:91], v[36:39]
ds_read_b64_tr_b16 v[182:183], v7 offset:13056
v_mfma_f32_16x16x32_bf16 v[36:39], v[208:211], a[80:83], v[36:39]
buffer_load_dwordx4 v13, s[72:75], s12 offen offset:3072 lds
v_mfma_f32_16x16x32_bf16 v[56:59], v[152:155], a[96:99], v[56:59]
ds_read_b64_tr_b16 v[184:185], v6 offset:0
ds_read_b64_tr_b16 v[186:187], v6 offset:4096
v_mfma_f32_16x16x32_bf16 v[56:59], v[156:159], a[104:107], v[56:59]
ds_read_b64_tr_b16 v[188:189], v6 offset:8192
v_mfma_f32_16x16x32_bf16 v[72:75], v[156:159], a[108:111], v[72:75]
ds_read_b64_tr_b16 v[190:191], v6 offset:12288
s_add_u32 s101, s101, 0x2000
v_mfma_f32_16x16x32_bf16 v[72:75], v[152:155], a[100:103], v[72:75]
buffer_load_dwordx4 a[64:67], v3, s[88:91], s101 offen sc1
v_mfma_f32_16x16x32_bf16 v[76:79], v[160:163], a[100:103], v[76:79]
ds_read_b64_tr_b16 v[192:193], v7 offset:0
ds_read_b64_tr_b16 v[194:195], v7 offset:4096
v_mfma_f32_16x16x32_bf16 v[76:79], v[164:167], a[108:111], v[76:79]
ds_read_b64_tr_b16 v[196:197], v7 offset:8192
v_mfma_f32_16x16x32_bf16 v[60:63], v[164:167], a[104:107], v[60:63]
ds_read_b64_tr_b16 v[198:199], v7 offset:12288
s_waitcnt lgkmcnt(8)
v_mfma_f32_16x16x32_bf16 v[60:63], v[160:163], a[96:99], v[60:63]
buffer_load_dwordx4 a[68:71], v3, s[88:91], s101 offen offset:1024 sc1
v_mfma_f32_16x16x32_bf16 v[64:67], v[168:171], a[96:99], v[64:67]
ds_read_b64_tr_b16 v[200:201], v6 offset:256
ds_read_b64_tr_b16 v[202:203], v6 offset:4352
v_mfma_f32_16x16x32_bf16 v[64:67], v[172:175], a[104:107], v[64:67]
ds_read_b64_tr_b16 v[204:205], v6 offset:8448
v_mfma_f32_16x16x32_bf16 v[80:83], v[172:175], a[108:111], v[80:83]
ds_read_b64_tr_b16 v[206:207], v6 offset:12544
s_add_u32 s101, s101, 0x2000
v_mfma_f32_16x16x32_bf16 v[80:83], v[168:171], a[100:103], v[80:83]
buffer_load_dwordx4 a[72:75], v3, s[88:91], s101 offen sc1
v_mfma_f32_16x16x32_bf16 v[84:87], v[176:179], a[100:103], v[84:87]
ds_read_b64_tr_b16 v[208:209], v7 offset:256
ds_read_b64_tr_b16 v[210:211], v7 offset:4352
v_mfma_f32_16x16x32_bf16 v[84:87], v[180:183], a[108:111], v[84:87]
ds_read_b64_tr_b16 v[212:213], v7 offset:8448
s_waitcnt vmcnt(17) lgkmcnt(7)
v_mfma_f32_16x16x32_bf16 v[68:71], v[180:183], a[104:107], v[68:71]
ds_read_b64_tr_b16 v[214:215], v7 offset:12544
s_barrier
v_mfma_f32_16x16x32_bf16 v[68:71], v[176:179], a[96:99], v[68:71]
buffer_load_dwordx4 a[76:79], v3, s[88:91], s101 offen offset:1024 sc1
v_mfma_f32_16x16x32_bf16 v[24:27], v[184:187], a[96:99], v[24:27]
ds_read_b64_tr_b16 v[152:153], v6 offset:16896
ds_read_b64_tr_b16 v[154:155], v6 offset:20992
v_mfma_f32_16x16x32_bf16 v[24:27], v[188:191], a[104:107], v[24:27]
ds_read_b64_tr_b16 v[156:157], v6 offset:25088
v_add_u32 v12, 0x20000, v12
v_mfma_f32_16x16x32_bf16 v[40:43], v[188:191], a[108:111], v[40:43]
ds_read_b64_tr_b16 v[158:159], v6 offset:29184
s_add_u32 m0, s17, 0x14000
v_mfma_f32_16x16x32_bf16 v[40:43], v[184:187], a[100:103], v[40:43]
buffer_load_dwordx4 v12, s[72:75], 0 offen lds
v_mfma_f32_16x16x32_bf16 v[44:47], v[192:195], a[100:103], v[44:47]
ds_read_b64_tr_b16 v[160:161], v7 offset:16896
ds_read_b64_tr_b16 v[162:163], v7 offset:20992
v_mfma_f32_16x16x32_bf16 v[44:47], v[196:199], a[108:111], v[44:47]
ds_read_b64_tr_b16 v[164:165], v7 offset:25088
v_add_u32 v13, 0x20000, v13
v_mfma_f32_16x16x32_bf16 v[28:31], v[196:199], a[104:107], v[28:31]
ds_read_b64_tr_b16 v[166:167], v7 offset:29184
s_waitcnt lgkmcnt(8)
v_mfma_f32_16x16x32_bf16 v[28:31], v[192:195], a[96:99], v[28:31]
buffer_load_dwordx4 v13, s[72:75], 0 offen offset:1024 lds
v_mfma_f32_16x16x32_bf16 v[32:35], v[200:203], a[96:99], v[32:35]
ds_read_b64_tr_b16 v[168:169], v6 offset:17152
ds_read_b64_tr_b16 v[170:171], v6 offset:21248
v_mfma_f32_16x16x32_bf16 v[32:35], v[204:207], a[104:107], v[32:35]
ds_read_b64_tr_b16 v[172:173], v6 offset:25344
v_mfma_f32_16x16x32_bf16 v[48:51], v[204:207], a[108:111], v[48:51]
ds_read_b64_tr_b16 v[174:175], v6 offset:29440
v_mfma_f32_16x16x32_bf16 v[48:51], v[200:203], a[100:103], v[48:51]
buffer_load_dwordx4 v12, s[72:75], s12 offen offset:2048 lds
v_mfma_f32_16x16x32_bf16 v[52:55], v[208:211], a[100:103], v[52:55]
ds_read_b64_tr_b16 v[176:177], v7 offset:17152
ds_read_b64_tr_b16 v[178:179], v7 offset:21248
v_mfma_f32_16x16x32_bf16 v[52:55], v[212:215], a[108:111], v[52:55]
ds_read_b64_tr_b16 v[180:181], v7 offset:25344
s_waitcnt lgkmcnt(7)
v_mfma_f32_16x16x32_bf16 v[36:39], v[212:215], a[104:107], v[36:39]
ds_read_b64_tr_b16 v[182:183], v7 offset:29440
v_mfma_f32_16x16x32_bf16 v[36:39], v[208:211], a[96:99], v[36:39]
buffer_load_dwordx4 v13, s[72:75], s12 offen offset:3072 lds
v_mfma_f32_16x16x32_bf16 v[56:59], v[152:155], a[112:115], v[56:59]
ds_read_b64_tr_b16 v[184:185], v6 offset:16384
ds_read_b64_tr_b16 v[186:187], v6 offset:20480
v_mfma_f32_16x16x32_bf16 v[56:59], v[156:159], a[120:123], v[56:59]
ds_read_b64_tr_b16 v[188:189], v6 offset:24576
v_mfma_f32_16x16x32_bf16 v[72:75], v[156:159], a[124:127], v[72:75]
ds_read_b64_tr_b16 v[190:191], v6 offset:28672
s_add_u32 s101, s101, 0x2000
v_mfma_f32_16x16x32_bf16 v[72:75], v[152:155], a[116:119], v[72:75]
buffer_load_dwordx4 a[80:83], v3, s[88:91], s101 offen sc1
v_mfma_f32_16x16x32_bf16 v[76:79], v[160:163], a[116:119], v[76:79]
ds_read_b64_tr_b16 v[192:193], v7 offset:16384
ds_read_b64_tr_b16 v[194:195], v7 offset:20480
v_mfma_f32_16x16x32_bf16 v[76:79], v[164:167], a[124:127], v[76:79]
ds_read_b64_tr_b16 v[196:197], v7 offset:24576
v_mfma_f32_16x16x32_bf16 v[60:63], v[164:167], a[120:123], v[60:63]
ds_read_b64_tr_b16 v[198:199], v7 offset:28672
s_waitcnt lgkmcnt(8)
v_mfma_f32_16x16x32_bf16 v[60:63], v[160:163], a[112:115], v[60:63]
buffer_load_dwordx4 a[84:87], v3, s[88:91], s101 offen offset:1024 sc1
v_mfma_f32_16x16x32_bf16 v[64:67], v[168:171], a[112:115], v[64:67]
ds_read_b64_tr_b16 v[200:201], v6 offset:16640
ds_read_b64_tr_b16 v[202:203], v6 offset:20736
v_mfma_f32_16x16x32_bf16 v[64:67], v[172:175], a[120:123], v[64:67]
ds_read_b64_tr_b16 v[204:205], v6 offset:24832
v_mfma_f32_16x16x32_bf16 v[80:83], v[172:175], a[124:127], v[80:83]
ds_read_b64_tr_b16 v[206:207], v6 offset:28928
s_add_u32 s101, s101, 0x2000
v_mfma_f32_16x16x32_bf16 v[80:83], v[168:171], a[116:119], v[80:83]
buffer_load_dwordx4 a[88:91], v3, s[88:91], s101 offen sc1
v_mfma_f32_16x16x32_bf16 v[84:87], v[176:179], a[116:119], v[84:87]
ds_read_b64_tr_b16 v[208:209], v7 offset:16640
ds_read_b64_tr_b16 v[210:211], v7 offset:20736
v_mfma_f32_16x16x32_bf16 v[84:87], v[180:183], a[124:127], v[84:87]
ds_read_b64_tr_b16 v[212:213], v7 offset:24832
s_waitcnt vmcnt(7) lgkmcnt(7)
v_mfma_f32_16x16x32_bf16 v[68:71], v[180:183], a[120:123], v[68:71]
ds_read_b64_tr_b16 v[214:215], v7 offset:28928
s_barrier
v_mfma_f32_16x16x32_bf16 v[68:71], v[176:179], a[112:115], v[68:71]
buffer_load_dwordx4 a[92:95], v3, s[88:91], s101 offen offset:1024 sc1
v_mfma_f32_16x16x32_bf16 v[24:27], v[184:187], a[112:115], v[24:27]
ds_read_b64_tr_b16 v[152:153], v4 offset:512
ds_read_b64_tr_b16 v[154:155], v4 offset:4608
v_mfma_f32_16x16x32_bf16 v[24:27], v[188:191], a[120:123], v[24:27]
ds_read_b64_tr_b16 v[156:157], v4 offset:8704
v_add_u32 v12, 0x20000, v12
v_mfma_f32_16x16x32_bf16 v[40:43], v[188:191], a[124:127], v[40:43]
ds_read_b64_tr_b16 v[158:159], v4 offset:12800
s_add_u32 m0, s16, 0x0
v_mfma_f32_16x16x32_bf16 v[40:43], v[184:187], a[116:119], v[40:43]
buffer_load_dwordx4 v12, s[72:75], 0 offen lds
v_mfma_f32_16x16x32_bf16 v[44:47], v[192:195], a[116:119], v[44:47]
ds_read_b64_tr_b16 v[160:161], v5 offset:512
ds_read_b64_tr_b16 v[162:163], v5 offset:4608
v_mfma_f32_16x16x32_bf16 v[44:47], v[196:199], a[124:127], v[44:47]
ds_read_b64_tr_b16 v[164:165], v5 offset:8704
v_add_u32 v13, 0x20000, v13
v_mfma_f32_16x16x32_bf16 v[28:31], v[196:199], a[120:123], v[28:31]
ds_read_b64_tr_b16 v[166:167], v5 offset:12800
s_waitcnt lgkmcnt(8)
v_mfma_f32_16x16x32_bf16 v[28:31], v[192:195], a[112:115], v[28:31]
buffer_load_dwordx4 v13, s[72:75], 0 offen offset:1024 lds
v_mfma_f32_16x16x32_bf16 v[32:35], v[200:203], a[112:115], v[32:35]
ds_read_b64_tr_b16 v[168:169], v4 offset:768
ds_read_b64_tr_b16 v[170:171], v4 offset:4864
v_mfma_f32_16x16x32_bf16 v[32:35], v[204:207], a[120:123], v[32:35]
ds_read_b64_tr_b16 v[172:173], v4 offset:8960
v_mfma_f32_16x16x32_bf16 v[48:51], v[204:207], a[124:127], v[48:51]
ds_read_b64_tr_b16 v[174:175], v4 offset:13056
v_mfma_f32_16x16x32_bf16 v[48:51], v[200:203], a[116:119], v[48:51]
buffer_load_dwordx4 v12, s[72:75], s12 offen offset:2048 lds
v_mfma_f32_16x16x32_bf16 v[52:55], v[208:211], a[116:119], v[52:55]
ds_read_b64_tr_b16 v[176:177], v5 offset:768
ds_read_b64_tr_b16 v[178:179], v5 offset:4864
v_mfma_f32_16x16x32_bf16 v[52:55], v[212:215], a[124:127], v[52:55]
ds_read_b64_tr_b16 v[180:181], v5 offset:8960
s_waitcnt lgkmcnt(7)
v_mfma_f32_16x16x32_bf16 v[36:39], v[212:215], a[120:123], v[36:39]
ds_read_b64_tr_b16 v[182:183], v5 offset:13056
v_mfma_f32_16x16x32_bf16 v[36:39], v[208:211], a[112:115], v[36:39]
buffer_load_dwordx4 v13, s[72:75], s12 offen offset:3072 lds
v_mfma_f32_16x16x32_bf16 v[56:59], v[152:155], a[64:67], v[56:59]
ds_read_b64_tr_b16 v[184:185], v4 offset:0
ds_read_b64_tr_b16 v[186:187], v4 offset:4096
v_mfma_f32_16x16x32_bf16 v[56:59], v[156:159], a[72:75], v[56:59]
ds_read_b64_tr_b16 v[188:189], v4 offset:8192
v_mfma_f32_16x16x32_bf16 v[72:75], v[156:159], a[76:79], v[72:75]
ds_read_b64_tr_b16 v[190:191], v4 offset:12288
s_add_u32 s101, s101, 0x2000
v_mfma_f32_16x16x32_bf16 v[72:75], v[152:155], a[68:71], v[72:75]
buffer_load_dwordx4 a[96:99], v3, s[88:91], s101 offen sc1
v_mfma_f32_16x16x32_bf16 v[76:79], v[160:163], a[68:71], v[76:79]
ds_read_b64_tr_b16 v[192:193], v5 offset:0
ds_read_b64_tr_b16 v[194:195], v5 offset:4096
v_mfma_f32_16x16x32_bf16 v[76:79], v[164:167], a[76:79], v[76:79]
ds_read_b64_tr_b16 v[196:197], v5 offset:8192
v_mfma_f32_16x16x32_bf16 v[60:63], v[164:167], a[72:75], v[60:63]
ds_read_b64_tr_b16 v[198:199], v5 offset:12288
s_waitcnt lgkmcnt(8)
v_mfma_f32_16x16x32_bf16 v[60:63], v[160:163], a[64:67], v[60:63]
buffer_load_dwordx4 a[100:103], v3, s[88:91], s101 offen offset:1024 sc1
v_mfma_f32_16x16x32_bf16 v[64:67], v[168:171], a[64:67], v[64:67]
ds_read_b64_tr_b16 v[200:201], v4 offset:256
ds_read_b64_tr_b16 v[202:203], v4 offset:4352
v_mfma_f32_16x16x32_bf16 v[64:67], v[172:175], a[72:75], v[64:67]
ds_read_b64_tr_b16 v[204:205], v4 offset:8448
v_mfma_f32_16x16x32_bf16 v[80:83], v[172:175], a[76:79], v[80:83]
ds_read_b64_tr_b16 v[206:207], v4 offset:12544
s_add_u32 s101, s101, 0x2000
v_mfma_f32_16x16x32_bf16 v[80:83], v[168:171], a[68:71], v[80:83]
buffer_load_dwordx4 a[104:107], v3, s[88:91], s101 offen sc1
v_mfma_f32_16x16x32_bf16 v[84:87], v[176:179], a[68:71], v[84:87]
ds_read_b64_tr_b16 v[208:209], v5 offset:256
ds_read_b64_tr_b16 v[210:211], v5 offset:4352
v_mfma_f32_16x16x32_bf16 v[84:87], v[180:183], a[76:79], v[84:87]
ds_read_b64_tr_b16 v[212:213], v5 offset:8448
s_waitcnt vmcnt(7) lgkmcnt(7)
v_mfma_f32_16x16x32_bf16 v[68:71], v[180:183], a[72:75], v[68:71]
ds_read_b64_tr_b16 v[214:215], v5 offset:12544
s_barrier
v_mfma_f32_16x16x32_bf16 v[68:71], v[176:179], a[64:67], v[68:71]
buffer_load_dwordx4 a[108:111], v3, s[88:91], s101 offen offset:1024 sc1
v_mfma_f32_16x16x32_bf16 v[24:27], v[184:187], a[64:67], v[24:27]
ds_read_b64_tr_b16 v[152:153], v4 offset:16896
ds_read_b64_tr_b16 v[154:155], v4 offset:20992
v_mfma_f32_16x16x32_bf16 v[24:27], v[188:191], a[72:75], v[24:27]
ds_read_b64_tr_b16 v[156:157], v4 offset:25088
v_add_u32 v12, 0x20000, v12
v_mfma_f32_16x16x32_bf16 v[40:43], v[188:191], a[76:79], v[40:43]
ds_read_b64_tr_b16 v[158:159], v4 offset:29184
s_add_u32 m0, s16, 0x4000
v_mfma_f32_16x16x32_bf16 v[40:43], v[184:187], a[68:71], v[40:43]
buffer_load_dwordx4 v12, s[72:75], 0 offen lds
v_mfma_f32_16x16x32_bf16 v[44:47], v[192:195], a[68:71], v[44:47]
ds_read_b64_tr_b16 v[160:161], v5 offset:16896
ds_read_b64_tr_b16 v[162:163], v5 offset:20992
v_mfma_f32_16x16x32_bf16 v[44:47], v[196:199], a[76:79], v[44:47]
ds_read_b64_tr_b16 v[164:165], v5 offset:25088
v_add_u32 v13, 0x20000, v13
v_mfma_f32_16x16x32_bf16 v[28:31], v[196:199], a[72:75], v[28:31]
ds_read_b64_tr_b16 v[166:167], v5 offset:29184
s_waitcnt lgkmcnt(8)
v_mfma_f32_16x16x32_bf16 v[28:31], v[192:195], a[64:67], v[28:31]
buffer_load_dwordx4 v13, s[72:75], 0 offen offset:1024 lds
v_mfma_f32_16x16x32_bf16 v[32:35], v[200:203], a[64:67], v[32:35]
ds_read_b64_tr_b16 v[168:169], v4 offset:17152
ds_read_b64_tr_b16 v[170:171], v4 offset:21248
v_mfma_f32_16x16x32_bf16 v[32:35], v[204:207], a[72:75], v[32:35]
ds_read_b64_tr_b16 v[172:173], v4 offset:25344
v_mfma_f32_16x16x32_bf16 v[48:51], v[204:207], a[76:79], v[48:51]
ds_read_b64_tr_b16 v[174:175], v4 offset:29440
v_mfma_f32_16x16x32_bf16 v[48:51], v[200:203], a[68:71], v[48:51]
buffer_load_dwordx4 v12, s[72:75], s12 offen offset:2048 lds
v_mfma_f32_16x16x32_bf16 v[52:55], v[208:211], a[68:71], v[52:55]
ds_read_b64_tr_b16 v[176:177], v5 offset:17152
ds_read_b64_tr_b16 v[178:179], v5 offset:21248
v_mfma_f32_16x16x32_bf16 v[52:55], v[212:215], a[76:79], v[52:55]
ds_read_b64_tr_b16 v[180:181], v5 offset:25344
s_waitcnt lgkmcnt(7)
v_mfma_f32_16x16x32_bf16 v[36:39], v[212:215], a[72:75], v[36:39]
ds_read_b64_tr_b16 v[182:183], v5 offset:29440
v_mfma_f32_16x16x32_bf16 v[36:39], v[208:211], a[64:67], v[36:39]
buffer_load_dwordx4 v13, s[72:75], s12 offen offset:3072 lds
v_mfma_f32_16x16x32_bf16 v[56:59], v[152:155], a[80:83], v[56:59]
ds_read_b64_tr_b16 v[184:185], v4 offset:16384
ds_read_b64_tr_b16 v[186:187], v4 offset:20480
v_mfma_f32_16x16x32_bf16 v[56:59], v[156:159], a[88:91], v[56:59]
ds_read_b64_tr_b16 v[188:189], v4 offset:24576
v_mfma_f32_16x16x32_bf16 v[72:75], v[156:159], a[92:95], v[72:75]
ds_read_b64_tr_b16 v[190:191], v4 offset:28672
s_add_u32 s101, s101, 0x2000
v_mfma_f32_16x16x32_bf16 v[72:75], v[152:155], a[84:87], v[72:75]
buffer_load_dwordx4 a[112:115], v3, s[88:91], s101 offen sc1
v_mfma_f32_16x16x32_bf16 v[76:79], v[160:163], a[84:87], v[76:79]
ds_read_b64_tr_b16 v[192:193], v5 offset:16384
ds_read_b64_tr_b16 v[194:195], v5 offset:20480
v_mfma_f32_16x16x32_bf16 v[76:79], v[164:167], a[92:95], v[76:79]
ds_read_b64_tr_b16 v[196:197], v5 offset:24576
v_mfma_f32_16x16x32_bf16 v[60:63], v[164:167], a[88:91], v[60:63]
ds_read_b64_tr_b16 v[198:199], v5 offset:28672
s_waitcnt lgkmcnt(8)
v_mfma_f32_16x16x32_bf16 v[60:63], v[160:163], a[80:83], v[60:63]
buffer_load_dwordx4 a[116:119], v3, s[88:91], s101 offen offset:1024 sc1
v_mfma_f32_16x16x32_bf16 v[64:67], v[168:171], a[80:83], v[64:67]
ds_read_b64_tr_b16 v[200:201], v4 offset:16640
ds_read_b64_tr_b16 v[202:203], v4 offset:20736
v_mfma_f32_16x16x32_bf16 v[64:67], v[172:175], a[88:91], v[64:67]
ds_read_b64_tr_b16 v[204:205], v4 offset:24832
v_mfma_f32_16x16x32_bf16 v[80:83], v[172:175], a[92:95], v[80:83]
ds_read_b64_tr_b16 v[206:207], v4 offset:28928
s_add_u32 s101, s101, 0x2000
v_mfma_f32_16x16x32_bf16 v[80:83], v[168:171], a[84:87], v[80:83]
buffer_load_dwordx4 a[120:123], v3, s[88:91], s101 offen sc1
v_mfma_f32_16x16x32_bf16 v[84:87], v[176:179], a[84:87], v[84:87]
ds_read_b64_tr_b16 v[208:209], v5 offset:16640
ds_read_b64_tr_b16 v[210:211], v5 offset:20736
v_mfma_f32_16x16x32_bf16 v[84:87], v[180:183], a[92:95], v[84:87]
ds_read_b64_tr_b16 v[212:213], v5 offset:24832
s_waitcnt vmcnt(7) lgkmcnt(7)
v_mfma_f32_16x16x32_bf16 v[68:71], v[180:183], a[88:91], v[68:71]
ds_read_b64_tr_b16 v[214:215], v5 offset:28928
s_barrier
v_mfma_f32_16x16x32_bf16 v[68:71], v[176:179], a[80:83], v[68:71]
buffer_load_dwordx4 a[124:127], v3, s[88:91], s101 offen offset:1024 sc1
L_p4_skip:
v_mfma_f32_16x16x32_bf16 v[24:27], v[184:187], a[80:83], v[24:27]
ds_read_b64_tr_b16 v[152:153], v6 offset:512
ds_read_b64_tr_b16 v[154:155], v6 offset:4608
v_mfma_f32_16x16x32_bf16 v[24:27], v[188:191], a[88:91], v[24:27]
ds_read_b64_tr_b16 v[156:157], v6 offset:8704
v_add_u32 v12, 0x20000, v12
v_mfma_f32_16x16x32_bf16 v[40:43], v[188:191], a[92:95], v[40:43]
ds_read_b64_tr_b16 v[158:159], v6 offset:12800
s_add_u32 m0, s17, 0x10000
v_mfma_f32_16x16x32_bf16 v[40:43], v[184:187], a[84:87], v[40:43]
buffer_load_dwordx4 v12, s[72:75], 0 offen lds
v_mfma_f32_16x16x32_bf16 v[44:47], v[192:195], a[84:87], v[44:47]
ds_read_b64_tr_b16 v[160:161], v7 offset:512
ds_read_b64_tr_b16 v[162:163], v7 offset:4608
v_mfma_f32_16x16x32_bf16 v[44:47], v[196:199], a[92:95], v[44:47]
ds_read_b64_tr_b16 v[164:165], v7 offset:8704
v_add_u32 v13, 0x20000, v13
v_mfma_f32_16x16x32_bf16 v[28:31], v[196:199], a[88:91], v[28:31]
ds_read_b64_tr_b16 v[166:167], v7 offset:12800
s_waitcnt lgkmcnt(8)
v_mfma_f32_16x16x32_bf16 v[28:31], v[192:195], a[80:83], v[28:31]
buffer_load_dwordx4 v13, s[72:75], 0 offen offset:1024 lds
v_mfma_f32_16x16x32_bf16 v[32:35], v[200:203], a[80:83], v[32:35]
ds_read_b64_tr_b16 v[168:169], v6 offset:768
ds_read_b64_tr_b16 v[170:171], v6 offset:4864
v_mfma_f32_16x16x32_bf16 v[32:35], v[204:207], a[88:91], v[32:35]
ds_read_b64_tr_b16 v[172:173], v6 offset:8960
v_mfma_f32_16x16x32_bf16 v[48:51], v[204:207], a[92:95], v[48:51]
ds_read_b64_tr_b16 v[174:175], v6 offset:13056
v_mfma_f32_16x16x32_bf16 v[48:51], v[200:203], a[84:87], v[48:51]
buffer_load_dwordx4 v12, s[72:75], s12 offen offset:2048 lds
v_mfma_f32_16x16x32_bf16 v[52:55], v[208:211], a[84:87], v[52:55]
ds_read_b64_tr_b16 v[176:177], v7 offset:768
ds_read_b64_tr_b16 v[178:179], v7 offset:4864
v_mfma_f32_16x16x32_bf16 v[52:55], v[212:215], a[92:95], v[52:55]
ds_read_b64_tr_b16 v[180:181], v7 offset:8960
s_waitcnt lgkmcnt(7)
v_mfma_f32_16x16x32_bf16 v[36:39], v[212:215], a[88:91], v[36:39]
ds_read_b64_tr_b16 v[182:183], v7 offset:13056
v_mfma_f32_16x16x32_bf16 v[36:39], v[208:211], a[80:83], v[36:39]
buffer_load_dwordx4 v13, s[72:75], s12 offen offset:3072 lds
v_mfma_f32_16x16x32_bf16 v[56:59], v[152:155], a[96:99], v[56:59]
ds_read_b64_tr_b16 v[184:185], v6 offset:0
ds_read_b64_tr_b16 v[186:187], v6 offset:4096
v_mfma_f32_16x16x32_bf16 v[56:59], v[156:159], a[104:107], v[56:59]
ds_read_b64_tr_b16 v[188:189], v6 offset:8192
v_mov_b32 v112, 0
v_mfma_f32_16x16x32_bf16 v[72:75], v[156:159], a[108:111], v[72:75]
ds_read_b64_tr_b16 v[190:191], v6 offset:12288
s_add_u32 s101, s101, 0x2000
v_mfma_f32_16x16x32_bf16 v[72:75], v[152:155], a[100:103], v[72:75]
buffer_load_dwordx4 a[64:67], v3, s[88:91], s101 offen sc1
v_mfma_f32_16x16x32_bf16 v[76:79], v[160:163], a[100:103], v[76:79]
ds_read_b64_tr_b16 v[192:193], v7 offset:0
ds_read_b64_tr_b16 v[194:195], v7 offset:4096
v_mfma_f32_16x16x32_bf16 v[76:79], v[164:167], a[108:111], v[76:79]
ds_read_b64_tr_b16 v[196:197], v7 offset:8192
v_mov_b32 v113, 0
v_mfma_f32_16x16x32_bf16 v[60:63], v[164:167], a[104:107], v[60:63]
ds_read_b64_tr_b16 v[198:199], v7 offset:12288
s_waitcnt lgkmcnt(8)
v_mfma_f32_16x16x32_bf16 v[60:63], v[160:163], a[96:99], v[60:63]
buffer_load_dwordx4 a[68:71], v3, s[88:91], s101 offen offset:1024 sc1
v_mfma_f32_16x16x32_bf16 v[64:67], v[168:171], a[96:99], v[64:67]
ds_read_b64_tr_b16 v[200:201], v6 offset:256
ds_read_b64_tr_b16 v[202:203], v6 offset:4352
v_mfma_f32_16x16x32_bf16 v[64:67], v[172:175], a[104:107], v[64:67]
ds_read_b64_tr_b16 v[204:205], v6 offset:8448
v_mov_b32 v114, 0
v_mfma_f32_16x16x32_bf16 v[80:83], v[172:175], a[108:111], v[80:83]
ds_read_b64_tr_b16 v[206:207], v6 offset:12544
s_add_u32 s101, s101, 0x2000
v_mfma_f32_16x16x32_bf16 v[80:83], v[168:171], a[100:103], v[80:83]
buffer_load_dwordx4 a[72:75], v3, s[88:91], s101 offen sc1
v_mfma_f32_16x16x32_bf16 v[84:87], v[176:179], a[100:103], v[84:87]
ds_read_b64_tr_b16 v[208:209], v7 offset:256
ds_read_b64_tr_b16 v[210:211], v7 offset:4352
v_mfma_f32_16x16x32_bf16 v[84:87], v[180:183], a[108:111], v[84:87]
ds_read_b64_tr_b16 v[212:213], v7 offset:8448
s_waitcnt vmcnt(7) lgkmcnt(7)
v_mfma_f32_16x16x32_bf16 v[68:71], v[180:183], a[104:107], v[68:71]
ds_read_b64_tr_b16 v[214:215], v7 offset:12544
s_barrier
v_mfma_f32_16x16x32_bf16 v[68:71], v[176:179], a[96:99], v[68:71]
buffer_load_dwordx4 a[76:79], v3, s[88:91], s101 offen offset:1024 sc1
v_mov_b32 v115, 0
buffer_load_dword v14, v16, s[88:91], s24 offen sc1
v_mfma_f32_16x16x32_bf16 v[24:27], v[184:187], a[96:99], v[24:27]
ds_read_b64_tr_b16 v[152:153], v6 offset:16896
ds_read_b64_tr_b16 v[154:155], v6 offset:20992
v_mfma_f32_16x16x32_bf16 v[24:27], v[188:191], a[104:107], v[24:27]
ds_read_b64_tr_b16 v[156:157], v6 offset:25088
v_add_u32 v12, 0x20000, v12
v_mfma_f32_16x16x32_bf16 v[40:43], v[188:191], a[108:111], v[40:43]
ds_read_b64_tr_b16 v[158:159], v6 offset:29184
s_add_u32 m0, s17, 0x14000
v_mfma_f32_16x16x32_bf16 v[40:43], v[184:187], a[100:103], v[40:43]
buffer_load_dwordx4 v12, s[72:75], 0 offen lds
v_mfma_f32_16x16x32_bf16 v[44:47], v[192:195], a[100:103], v[44:47]
ds_read_b64_tr_b16 v[160:161], v7 offset:16896
ds_read_b64_tr_b16 v[162:163], v7 offset:20992
v_mfma_f32_16x16x32_bf16 v[44:47], v[196:199], a[108:111], v[44:47]
ds_read_b64_tr_b16 v[164:165], v7 offset:25088
v_add_u32 v13, 0x20000, v13
v_mfma_f32_16x16x32_bf16 v[28:31], v[196:199], a[104:107], v[28:31]
ds_read_b64_tr_b16 v[166:167], v7 offset:29184
s_waitcnt lgkmcnt(8)
v_mfma_f32_16x16x32_bf16 v[28:31], v[192:195], a[96:99], v[28:31]
buffer_load_dwordx4 v13, s[72:75], 0 offen offset:1024 lds
v_mfma_f32_16x16x32_bf16 v[32:35], v[200:203], a[96:99], v[32:35]
ds_read_b64_tr_b16 v[168:169], v6 offset:17152
ds_read_b64_tr_b16 v[170:171], v6 offset:21248
v_mfma_f32_16x16x32_bf16 v[32:35], v[204:207], a[104:107], v[32:35]
ds_read_b64_tr_b16 v[172:173], v6 offset:25344
v_mfma_f32_16x16x32_bf16 v[48:51], v[204:207], a[108:111], v[48:51]
ds_read_b64_tr_b16 v[174:175], v6 offset:29440
v_mfma_f32_16x16x32_bf16 v[48:51], v[200:203], a[100:103], v[48:51]
buffer_load_dwordx4 v12, s[72:75], s12 offen offset:2048 lds
v_mfma_f32_16x16x32_bf16 v[52:55], v[208:211], a[100:103], v[52:55]
ds_read_b64_tr_b16 v[176:177], v7 offset:17152
ds_read_b64_tr_b16 v[178:179], v7 offset:21248
v_mfma_f32_16x16x32_bf16 v[52:55], v[212:215], a[108:111], v[52:55]
ds_read_b64_tr_b16 v[180:181], v7 offset:25344
s_waitcnt lgkmcnt(7)
v_mfma_f32_16x16x32_bf16 v[36:39], v[212:215], a[104:107], v[36:39]
ds_read_b64_tr_b16 v[182:183], v7 offset:29440
v_mfma_f32_16x16x32_bf16 v[36:39], v[208:211], a[96:99], v[36:39]
buffer_load_dwordx4 v13, s[72:75], s12 offen offset:3072 lds
v_mfma_f32_16x16x32_bf16 v[56:59], v[152:155], a[112:115], v[56:59]
ds_read_b64_tr_b16 v[184:185], v6 offset:16384
ds_read_b64_tr_b16 v[186:187], v6 offset:20480
v_mfma_f32_16x16x32_bf16 v[56:59], v[156:159], a[120:123], v[56:59]
ds_read_b64_tr_b16 v[188:189], v6 offset:24576
v_mov_b32 v116, 0
v_mfma_f32_16x16x32_bf16 v[72:75], v[156:159], a[124:127], v[72:75]
ds_read_b64_tr_b16 v[190:191], v6 offset:28672
s_add_u32 s101, s101, 0x2000
v_mfma_f32_16x16x32_bf16 v[72:75], v[152:155], a[116:119], v[72:75]
buffer_load_dwordx4 a[80:83], v3, s[88:91], s101 offen sc1
v_mfma_f32_16x16x32_bf16 v[76:79], v[160:163], a[116:119], v[76:79]
ds_read_b64_tr_b16 v[192:193], v7 offset:16384
ds_read_b64_tr_b16 v[194:195], v7 offset:20480
v_mfma_f32_16x16x32_bf16 v[76:79], v[164:167], a[124:127], v[76:79]
ds_read_b64_tr_b16 v[196:197], v7 offset:24576
v_mov_b32 v117, 0
v_mfma_f32_16x16x32_bf16 v[60:63], v[164:167], a[120:123], v[60:63]
ds_read_b64_tr_b16 v[198:199], v7 offset:28672
s_waitcnt lgkmcnt(8)
v_mfma_f32_16x16x32_bf16 v[60:63], v[160:163], a[112:115], v[60:63]
buffer_load_dwordx4 a[84:87], v3, s[88:91], s101 offen offset:1024 sc1
v_mfma_f32_16x16x32_bf16 v[64:67], v[168:171], a[112:115], v[64:67]
ds_read_b64_tr_b16 v[200:201], v6 offset:16640
ds_read_b64_tr_b16 v[202:203], v6 offset:20736
v_mfma_f32_16x16x32_bf16 v[64:67], v[172:175], a[120:123], v[64:67]
ds_read_b64_tr_b16 v[204:205], v6 offset:24832
v_mov_b32 v118, 0
v_mfma_f32_16x16x32_bf16 v[80:83], v[172:175], a[124:127], v[80:83]
ds_read_b64_tr_b16 v[206:207], v6 offset:28928
s_add_u32 s101, s101, 0x2000
v_mfma_f32_16x16x32_bf16 v[80:83], v[168:171], a[116:119], v[80:83]
buffer_load_dwordx4 a[88:91], v3, s[88:91], s101 offen sc1
v_mfma_f32_16x16x32_bf16 v[84:87], v[176:179], a[116:119], v[84:87]
ds_read_b64_tr_b16 v[208:209], v7 offset:16640
ds_read_b64_tr_b16 v[210:211], v7 offset:20736
v_mfma_f32_16x16x32_bf16 v[84:87], v[180:183], a[124:127], v[84:87]
ds_read_b64_tr_b16 v[212:213], v7 offset:24832
s_waitcnt vmcnt(7) lgkmcnt(7)
v_mfma_f32_16x16x32_bf16 v[68:71], v[180:183], a[120:123], v[68:71]
ds_read_b64_tr_b16 v[214:215], v7 offset:28928
s_barrier
v_mfma_f32_16x16x32_bf16 v[68:71], v[176:179], a[112:115], v[68:71]
buffer_load_dwordx4 a[92:95], v3, s[88:91], s101 offen offset:1024 sc1
v_mov_b32 v119, 0
s_mov_b32 s92, 200000
L_spin_c:
v_cmp_ne_u32 vcc, 1, v14
s_nop 4
s_cbranch_vccz L_spun_c
s_sub_u32 s92, s92, 1
s_cbranch_scc1 L_spun_c
s_sleep 6
buffer_load_dword v14, v16, s[88:91], s24 offen sc1
s_waitcnt vmcnt(0)
s_branch L_spin_c
L_spun_c:
v_mfma_f32_16x16x32_bf16 v[24:27], v[184:187], a[112:115], v[24:27]
ds_read_b64_tr_b16 v[152:153], v4 offset:512
ds_read_b64_tr_b16 v[154:155], v4 offset:4608
v_mfma_f32_16x16x32_bf16 v[24:27], v[188:191], a[120:123], v[24:27]
ds_read_b64_tr_b16 v[156:157], v4 offset:8704
v_add_u32 v12, s25, v12
v_mfma_f32_16x16x32_bf16 v[40:43], v[188:191], a[124:127], v[40:43]
ds_read_b64_tr_b16 v[158:159], v4 offset:12800
s_add_u32 m0, s16, 0x0
v_mfma_f32_16x16x32_bf16 v[40:43], v[184:187], a[116:119], v[40:43]
buffer_load_dwordx4 v12, s[64:67], s61 offen lds
v_mfma_f32_16x16x32_bf16 v[44:47], v[192:195], a[116:119], v[44:47]
ds_read_b64_tr_b16 v[160:161], v5 offset:512
ds_read_b64_tr_b16 v[162:163], v5 offset:4608
v_mfma_f32_16x16x32_bf16 v[44:47], v[196:199], a[124:127], v[44:47]
ds_read_b64_tr_b16 v[164:165], v5 offset:8704
v_add_u32 v13, s25, v13
v_mfma_f32_16x16x32_bf16 v[28:31], v[196:199], a[120:123], v[28:31]
ds_read_b64_tr_b16 v[166:167], v5 offset:12800
s_waitcnt lgkmcnt(8)
v_mfma_f32_16x16x32_bf16 v[28:31], v[192:195], a[112:115], v[28:31]
buffer_load_dwordx4 v13, s[64:67], s61 offen offset:1024 lds
v_mfma_f32_16x16x32_bf16 v[32:35], v[200:203], a[112:115], v[32:35]
ds_read_b64_tr_b16 v[168:169], v4 offset:768
ds_read_b64_tr_b16 v[170:171], v4 offset:4864
v_mfma_f32_16x16x32_bf16 v[32:35], v[204:207], a[120:123], v[32:35]
ds_read_b64_tr_b16 v[172:173], v4 offset:8960
s_add_u32 s63, s101, s26
v_mfma_f32_16x16x32_bf16 v[48:51], v[204:207], a[124:127], v[48:51]
ds_read_b64_tr_b16 v[174:175], v4 offset:13056
s_add_u32 s101, s63, s60
v_mfma_f32_16x16x32_bf16 v[48:51], v[200:203], a[116:119], v[48:51]
buffer_load_dwordx4 v12, s[64:67], s62 offen offset:2048 lds
v_mfma_f32_16x16x32_bf16 v[52:55], v[208:211], a[116:119], v[52:55]
ds_read_b64_tr_b16 v[176:177], v5 offset:768
ds_read_b64_tr_b16 v[178:179], v5 offset:4864
v_mfma_f32_16x16x32_bf16 v[52:55], v[212:215], a[124:127], v[52:55]
ds_read_b64_tr_b16 v[180:181], v5 offset:8960
s_waitcnt lgkmcnt(7)
v_mfma_f32_16x16x32_bf16 v[36:39], v[212:215], a[120:123], v[36:39]
ds_read_b64_tr_b16 v[182:183], v5 offset:13056
v_mfma_f32_16x16x32_bf16 v[36:39], v[208:211], a[112:115], v[36:39]
buffer_load_dwordx4 v13, s[64:67], s62 offen offset:3072 lds
v_mfma_f32_16x16x32_bf16 v[56:59], v[152:155], a[64:67], v[56:59]
ds_read_b64_tr_b16 v[184:185], v4 offset:0
ds_read_b64_tr_b16 v[186:187], v4 offset:4096
v_mfma_f32_16x16x32_bf16 v[56:59], v[156:159], a[72:75], v[56:59]
ds_read_b64_tr_b16 v[188:189], v4 offset:8192
s_add_u32 s60, s60, s57
v_mfma_f32_16x16x32_bf16 v[72:75], v[156:159], a[76:79], v[72:75]
ds_read_b64_tr_b16 v[190:191], v4 offset:12288
s_and_b32 s60, s60, 0x7c000
v_mfma_f32_16x16x32_bf16 v[72:75], v[152:155], a[68:71], v[72:75]
buffer_load_dwordx4 a[96:99], v3, s[88:91], s101 offen sc1
v_mfma_f32_16x16x32_bf16 v[76:79], v[160:163], a[68:71], v[76:79]
ds_read_b64_tr_b16 v[192:193], v5 offset:0
ds_read_b64_tr_b16 v[194:195], v5 offset:4096
v_mfma_f32_16x16x32_bf16 v[76:79], v[164:167], a[76:79], v[76:79]
ds_read_b64_tr_b16 v[196:197], v5 offset:8192
s_lshl_b32 s61, s60, 3
v_mfma_f32_16x16x32_bf16 v[60:63], v[164:167], a[72:75], v[60:63]
ds_read_b64_tr_b16 v[198:199], v5 offset:12288
s_waitcnt lgkmcnt(8)
v_mfma_f32_16x16x32_bf16 v[60:63], v[160:163], a[64:67], v[60:63]
buffer_load_dwordx4 a[100:103], v3, s[88:91], s101 offen offset:1024 sc1
v_mfma_f32_16x16x32_bf16 v[64:67], v[168:171], a[64:67], v[64:67]
ds_read_b64_tr_b16 v[200:201], v4 offset:256
ds_read_b64_tr_b16 v[202:203], v4 offset:4352
v_mfma_f32_16x16x32_bf16 v[64:67], v[172:175], a[72:75], v[64:67]
ds_read_b64_tr_b16 v[204:205], v4 offset:8448
s_add_u32 s62, s61, s12
v_mfma_f32_16x16x32_bf16 v[80:83], v[172:175], a[76:79], v[80:83]
ds_read_b64_tr_b16 v[206:207], v4 offset:12544
s_add_u32 s101, s101, 0x2000
v_mfma_f32_16x16x32_bf16 v[80:83], v[168:171], a[68:71], v[80:83]
buffer_load_dwordx4 a[104:107], v3, s[88:91], s101 offen sc1
v_mfma_f32_16x16x32_bf16 v[84:87], v[176:179], a[68:71], v[84:87]
ds_read_b64_tr_b16 v[208:209], v5 offset:256
ds_read_b64_tr_b16 v[210:211], v5 offset:4352
v_mfma_f32_16x16x32_bf16 v[84:87], v[180:183], a[76:79], v[84:87]
ds_read_b64_tr_b16 v[212:213], v5 offset:8448
s_waitcnt vmcnt(7) lgkmcnt(7)
v_mfma_f32_16x16x32_bf16 v[68:71], v[180:183], a[72:75], v[68:71]
ds_read_b64_tr_b16 v[214:215], v5 offset:12544
s_barrier
v_mfma_f32_16x16x32_bf16 v[68:71], v[176:179], a[64:67], v[68:71]
buffer_load_dwordx4 a[108:111], v3, s[88:91], s101 offen offset:1024 sc1
v_mfma_f32_16x16x32_bf16 v[24:27], v[184:187], a[64:67], v[24:27]
ds_read_b64_tr_b16 v[152:153], v4 offset:16896
ds_read_b64_tr_b16 v[154:155], v4 offset:20992
v_mfma_f32_16x16x32_bf16 v[24:27], v[188:191], a[72:75], v[24:27]
ds_read_b64_tr_b16 v[156:157], v4 offset:25088
s_add_u32 s101, s63, s60
v_mfma_f32_16x16x32_bf16 v[40:43], v[188:191], a[76:79], v[40:43]
ds_read_b64_tr_b16 v[158:159], v4 offset:29184
s_add_u32 m0, s16, 0x4000
v_mfma_f32_16x16x32_bf16 v[40:43], v[184:187], a[68:71], v[40:43]
buffer_load_dwordx4 v12, s[64:67], s61 offen lds
v_mfma_f32_16x16x32_bf16 v[44:47], v[192:195], a[68:71], v[44:47]
ds_read_b64_tr_b16 v[160:161], v5 offset:16896
ds_read_b64_tr_b16 v[162:163], v5 offset:20992
v_mfma_f32_16x16x32_bf16 v[44:47], v[196:199], a[76:79], v[44:47]
ds_read_b64_tr_b16 v[164:165], v5 offset:25088
v_mfma_f32_16x16x32_bf16 v[28:31], v[196:199], a[72:75], v[28:31]
ds_read_b64_tr_b16 v[166:167], v5 offset:29184
s_waitcnt lgkmcnt(8)
v_mfma_f32_16x16x32_bf16 v[28:31], v[192:195], a[64:67], v[28:31]
buffer_load_dwordx4 v13, s[64:67], s61 offen offset:1024 lds
v_mfma_f32_16x16x32_bf16 v[32:35], v[200:203], a[64:67], v[32:35]
ds_read_b64_tr_b16 v[168:169], v4 offset:17152
ds_read_b64_tr_b16 v[170:171], v4 offset:21248
v_mfma_f32_16x16x32_bf16 v[32:35], v[204:207], a[72:75], v[32:35]
ds_read_b64_tr_b16 v[172:173], v4 offset:25344
v_mfma_f32_16x16x32_bf16 v[48:51], v[204:207], a[76:79], v[48:51]
ds_read_b64_tr_b16 v[174:175], v4 offset:29440
v_mfma_f32_16x16x32_bf16 v[48:51], v[200:203], a[68:71], v[48:51]
buffer_load_dwordx4 v12, s[64:67], s62 offen offset:2048 lds
v_mfma_f32_16x16x32_bf16 v[52:55], v[208:211], a[68:71], v[52:55]
ds_read_b64_tr_b16 v[176:177], v5 offset:17152
ds_read_b64_tr_b16 v[178:179], v5 offset:21248
v_mfma_f32_16x16x32_bf16 v[52:55], v[212:215], a[76:79], v[52:55]
ds_read_b64_tr_b16 v[180:181], v5 offset:25344
s_waitcnt lgkmcnt(7)
v_mfma_f32_16x16x32_bf16 v[36:39], v[212:215], a[72:75], v[36:39]
ds_read_b64_tr_b16 v[182:183], v5 offset:29440
v_mfma_f32_16x16x32_bf16 v[36:39], v[208:211], a[64:67], v[36:39]
buffer_load_dwordx4 v13, s[64:67], s62 offen offset:3072 lds
v_mfma_f32_16x16x32_bf16 v[56:59], v[152:155], a[80:83], v[56:59]
ds_read_b64_tr_b16 v[184:185], v4 offset:16384
ds_read_b64_tr_b16 v[186:187], v4 offset:20480
v_mfma_f32_16x16x32_bf16 v[56:59], v[156:159], a[88:91], v[56:59]
ds_read_b64_tr_b16 v[188:189], v4 offset:24576
s_add_u32 s60, s60, s58
v_mfma_f32_16x16x32_bf16 v[72:75], v[156:159], a[92:95], v[72:75]
ds_read_b64_tr_b16 v[190:191], v4 offset:28672
s_and_b32 s60, s60, 0x7c000
v_mfma_f32_16x16x32_bf16 v[72:75], v[152:155], a[84:87], v[72:75]
buffer_load_dwordx4 a[112:115], v3, s[88:91], s101 offen sc1
v_mfma_f32_16x16x32_bf16 v[76:79], v[160:163], a[84:87], v[76:79]
ds_read_b64_tr_b16 v[192:193], v5 offset:16384
ds_read_b64_tr_b16 v[194:195], v5 offset:20480
v_mfma_f32_16x16x32_bf16 v[76:79], v[164:167], a[92:95], v[76:79]
ds_read_b64_tr_b16 v[196:197], v5 offset:24576
s_lshl_b32 s61, s60, 3
v_mfma_f32_16x16x32_bf16 v[60:63], v[164:167], a[88:91], v[60:63]
ds_read_b64_tr_b16 v[198:199], v5 offset:28672
s_waitcnt lgkmcnt(8)
v_mfma_f32_16x16x32_bf16 v[60:63], v[160:163], a[80:83], v[60:63]
buffer_load_dwordx4 a[116:119], v3, s[88:91], s101 offen offset:1024 sc1
v_mfma_f32_16x16x32_bf16 v[64:67], v[168:171], a[80:83], v[64:67]
ds_read_b64_tr_b16 v[200:201], v4 offset:16640
ds_read_b64_tr_b16 v[202:203], v4 offset:20736
v_mfma_f32_16x16x32_bf16 v[64:67], v[172:175], a[88:91], v[64:67]
ds_read_b64_tr_b16 v[204:205], v4 offset:24832
s_add_u32 s62, s61, s12
v_mfma_f32_16x16x32_bf16 v[80:83], v[172:175], a[92:95], v[80:83]
ds_read_b64_tr_b16 v[206:207], v4 offset:28928
s_add_u32 s101, s101, 0x2000
v_mfma_f32_16x16x32_bf16 v[80:83], v[168:171], a[84:87], v[80:83]
buffer_load_dwordx4 a[120:123], v3, s[88:91], s101 offen sc1
v_mfma_f32_16x16x32_bf16 v[84:87], v[176:179], a[84:87], v[84:87]
ds_read_b64_tr_b16 v[208:209], v5 offset:16640
ds_read_b64_tr_b16 v[210:211], v5 offset:20736
v_mfma_f32_16x16x32_bf16 v[84:87], v[180:183], a[92:95], v[84:87]
ds_read_b64_tr_b16 v[212:213], v5 offset:24832
s_waitcnt vmcnt(7) lgkmcnt(7)
v_mfma_f32_16x16x32_bf16 v[68:71], v[180:183], a[88:91], v[68:71]
ds_read_b64_tr_b16 v[214:215], v5 offset:28928
s_barrier
v_mfma_f32_16x16x32_bf16 v[68:71], v[176:179], a[80:83], v[68:71]
buffer_load_dwordx4 a[124:127], v3, s[88:91], s101 offen offset:1024 sc1
v_mfma_f32_16x16x32_bf16 v[24:27], v[184:187], a[80:83], v[24:27]
ds_read_b64_tr_b16 v[152:153], v6 offset:512
ds_read_b64_tr_b16 v[154:155], v6 offset:4608
v_mfma_f32_16x16x32_bf16 v[24:27], v[188:191], a[88:91], v[24:27]
ds_read_b64_tr_b16 v[156:157], v6 offset:8704
s_add_u32 s101, s63, s60
v_mfma_f32_16x16x32_bf16 v[40:43], v[188:191], a[92:95], v[40:43]
ds_read_b64_tr_b16 v[158:159], v6 offset:12800
s_add_u32 m0, s17, 0x10000
v_mfma_f32_16x16x32_bf16 v[40:43], v[184:187], a[84:87], v[40:43]
buffer_load_dwordx4 v12, s[64:67], s61 offen lds
v_mfma_f32_16x16x32_bf16 v[44:47], v[192:195], a[84:87], v[44:47]
ds_read_b64_tr_b16 v[160:161], v7 offset:512
ds_read_b64_tr_b16 v[162:163], v7 offset:4608
v_mfma_f32_16x16x32_bf16 v[44:47], v[196:199], a[92:95], v[44:47]
ds_read_b64_tr_b16 v[164:165], v7 offset:8704
v_mfma_f32_16x16x32_bf16 v[28:31], v[196:199], a[88:91], v[28:31]
ds_read_b64_tr_b16 v[166:167], v7 offset:12800
s_waitcnt lgkmcnt(8)
v_mfma_f32_16x16x32_bf16 v[28:31], v[192:195], a[80:83], v[28:31]
buffer_load_dwordx4 v13, s[64:67], s61 offen offset:1024 lds
v_mfma_f32_16x16x32_bf16 v[32:35], v[200:203], a[80:83], v[32:35]
ds_read_b64_tr_b16 v[168:169], v6 offset:768
ds_read_b64_tr_b16 v[170:171], v6 offset:4864
v_mfma_f32_16x16x32_bf16 v[32:35], v[204:207], a[88:91], v[32:35]
ds_read_b64_tr_b16 v[172:173], v6 offset:8960
v_mfma_f32_16x16x32_bf16 v[48:51], v[204:207], a[92:95], v[48:51]
ds_read_b64_tr_b16 v[174:175], v6 offset:13056
v_mfma_f32_16x16x32_bf16 v[48:51], v[200:203], a[84:87], v[48:51]
buffer_load_dwordx4 v12, s[64:67], s62 offen offset:2048 lds
v_mfma_f32_16x16x32_bf16 v[52:55], v[208:211], a[84:87], v[52:55]
ds_read_b64_tr_b16 v[176:177], v7 offset:768
ds_read_b64_tr_b16 v[178:179], v7 offset:4864
v_mfma_f32_16x16x32_bf16 v[52:55], v[212:215], a[92:95], v[52:55]
ds_read_b64_tr_b16 v[180:181], v7 offset:8960
s_waitcnt lgkmcnt(7)
v_mfma_f32_16x16x32_bf16 v[36:39], v[212:215], a[88:91], v[36:39]
ds_read_b64_tr_b16 v[182:183], v7 offset:13056
v_mfma_f32_16x16x32_bf16 v[36:39], v[208:211], a[80:83], v[36:39]
buffer_load_dwordx4 v13, s[64:67], s62 offen offset:3072 lds
v_mfma_f32_16x16x32_bf16 v[120:123], v[152:155], a[96:99], 0
ds_read_b64_tr_b16 v[184:185], v6 offset:0
ds_read_b64_tr_b16 v[186:187], v6 offset:4096
v_mfma_f32_16x16x32_bf16 v[120:123], v[156:159], a[104:107], v[120:123]
ds_read_b64_tr_b16 v[188:189], v6 offset:8192
s_add_u32 s60, s60, s59
v_mfma_f32_16x16x32_bf16 v[136:139], v[156:159], a[108:111], 0
ds_read_b64_tr_b16 v[190:191], v6 offset:12288
s_and_b32 s60, s60, 0x7c000
v_mfma_f32_16x16x32_bf16 v[136:139], v[152:155], a[100:103], v[136:139]
buffer_load_dwordx4 a[64:67], v3, s[88:91], s101 offen sc1
v_mfma_f32_16x16x32_bf16 v[140:143], v[160:163], a[100:103], 0
ds_read_b64_tr_b16 v[192:193], v7 offset:0
ds_read_b64_tr_b16 v[194:195], v7 offset:4096
v_mfma_f32_16x16x32_bf16 v[140:143], v[164:167], a[108:111], v[140:143]
ds_read_b64_tr_b16 v[196:197], v7 offset:8192
s_lshl_b32 s61, s60, 3
v_mfma_f32_16x16x32_bf16 v[124:127], v[164:167], a[104:107], 0
ds_read_b64_tr_b16 v[198:199], v7 offset:12288
s_waitcnt lgkmcnt(8)
v_mfma_f32_16x16x32_bf16 v[124:127], v[160:163], a[96:99], v[124:127]
buffer_load_dwordx4 a[68:71], v3, s[88:91], s101 offen offset:1024 sc1
v_mfma_f32_16x16x32_bf16 v[128:131], v[168:171], a[96:99], 0
ds_read_b64_tr_b16 v[200:201], v6 offset:256
ds_read_b64_tr_b16 v[202:203], v6 offset:4352
v_mfma_f32_16x16x32_bf16 v[128:131], v[172:175], a[104:107], v[128:131]
ds_read_b64_tr_b16 v[204:205], v6 offset:8448
s_add_u32 s62, s61, s12
v_mfma_f32_16x16x32_bf16 v[144:147], v[172:175], a[108:111], 0
ds_read_b64_tr_b16 v[206:207], v6 offset:12544
s_add_u32 s101, s101, 0x2000
v_mfma_f32_16x16x32_bf16 v[144:147], v[168:171], a[100:103], v[144:147]
buffer_load_dwordx4 a[72:75], v3, s[88:91], s101 offen sc1
v_mfma_f32_16x16x32_bf16 v[148:151], v[176:179], a[100:103], 0
ds_read_b64_tr_b16 v[208:209], v7 offset:256
ds_read_b64_tr_b16 v[210:211], v7 offset:4352
v_mfma_f32_16x16x32_bf16 v[148:151], v[180:183], a[108:111], v[148:151]
ds_read_b64_tr_b16 v[212:213], v7 offset:8448
s_waitcnt vmcnt(7) lgkmcnt(7)
v_mfma_f32_16x16x32_bf16 v[132:135], v[180:183], a[104:107], 0
ds_read_b64_tr_b16 v[214:215], v7 offset:12544
s_barrier
v_mfma_f32_16x16x32_bf16 v[132:135], v[176:179], a[96:99], v[132:135]
buffer_load_dwordx4 a[76:79], v3, s[88:91], s101 offen offset:1024 sc1
s_mov_b32 s15, 7
s_getreg_b32 s8, hwreg(HW_REG_HW_ID, 5, 1)
s_cmp_lg_u32 s8, 0
s_cbranch_scc1 L_p4_loop1
L_p4_loop0:
v_mfma_f32_16x16x32_bf16 v[88:91], v[184:187], a[96:99], v[88:91]
ds_read_b64_tr_b16 v[152:153], v6 offset:16896
ds_read_b64_tr_b16 v[154:155], v6 offset:20992
v_mfma_f32_16x16x32_bf16 v[88:91], v[188:191], a[104:107], v[88:91]
ds_read_b64_tr_b16 v[156:157], v6 offset:25088
s_add_u32 s101, s63, s60
v_mfma_f32_16x16x32_bf16 v[104:107], v[188:191], a[108:111], v[104:107]
ds_read_b64_tr_b16 v[158:159], v6 offset:29184
s_add_u32 m0, s17, 0x14000
v_mfma_f32_16x16x32_bf16 v[104:107], v[184:187], a[100:103], v[104:107]
buffer_load_dwordx4 v12, s[64:67], s61 offen lds
v_mfma_f32_16x16x32_bf16 v[108:111], v[192:195], a[100:103], v[108:111]
ds_read_b64_tr_b16 v[160:161], v7 offset:16896
ds_read_b64_tr_b16 v[162:163], v7 offset:20992
v_mfma_f32_16x16x32_bf16 v[108:111], v[196:199], a[108:111], v[108:111]
ds_read_b64_tr_b16 v[164:165], v7 offset:25088
v_mfma_f32_16x16x32_bf16 v[92:95], v[196:199], a[104:107], v[92:95]
ds_read_b64_tr_b16 v[166:167], v7 offset:29184
s_waitcnt lgkmcnt(8)
v_mfma_f32_16x16x32_bf16 v[92:95], v[192:195], a[96:99], v[92:95]
buffer_load_dwordx4 v13, s[64:67], s61 offen offset:1024 lds
v_mfma_f32_16x16x32_bf16 v[96:99], v[200:203], a[96:99], v[96:99]
ds_read_b64_tr_b16 v[168:169], v6 offset:17152
ds_read_b64_tr_b16 v[170:171], v6 offset:21248
v_mfma_f32_16x16x32_bf16 v[96:99], v[204:207], a[104:107], v[96:99]
ds_read_b64_tr_b16 v[172:173], v6 offset:25344
v_mfma_f32_16x16x32_bf16 v[112:115], v[204:207], a[108:111], v[112:115]
ds_read_b64_tr_b16 v[174:175], v6 offset:29440
v_mfma_f32_16x16x32_bf16 v[112:115], v[200:203], a[100:103], v[112:115]
buffer_load_dwordx4 v12, s[64:67], s62 offen offset:2048 lds
v_mfma_f32_16x16x32_bf16 v[116:119], v[208:211], a[100:103], v[116:119]
ds_read_b64_tr_b16 v[176:177], v7 offset:17152
ds_read_b64_tr_b16 v[178:179], v7 offset:21248
v_mfma_f32_16x16x32_bf16 v[116:119], v[212:215], a[108:111], v[116:119]
ds_read_b64_tr_b16 v[180:181], v7 offset:25344
s_waitcnt lgkmcnt(7)
v_mfma_f32_16x16x32_bf16 v[100:103], v[212:215], a[104:107], v[100:103]
ds_read_b64_tr_b16 v[182:183], v7 offset:29440
v_mfma_f32_16x16x32_bf16 v[100:103], v[208:211], a[96:99], v[100:103]
buffer_load_dwordx4 v13, s[64:67], s62 offen offset:3072 lds
v_mfma_f32_16x16x32_bf16 v[120:123], v[152:155], a[112:115], v[120:123]
ds_read_b64_tr_b16 v[184:185], v6 offset:16384
ds_read_b64_tr_b16 v[186:187], v6 offset:20480
v_mfma_f32_16x16x32_bf16 v[120:123], v[156:159], a[120:123], v[120:123]
ds_read_b64_tr_b16 v[188:189], v6 offset:24576
s_add_u32 s60, s60, s56
v_mfma_f32_16x16x32_bf16 v[136:139], v[156:159], a[124:127], v[136:139]
ds_read_b64_tr_b16 v[190:191], v6 offset:28672
s_and_b32 s60, s60, 0x7c000
v_mfma_f32_16x16x32_bf16 v[136:139], v[152:155], a[116:119], v[136:139]
buffer_load_dwordx4 a[80:83], v3, s[88:91], s101 offen sc1
v_mfma_f32_16x16x32_bf16 v[140:143], v[160:163], a[116:119], v[140:143]
ds_read_b64_tr_b16 v[192:193], v7 offset:16384
ds_read_b64_tr_b16 v[194:195], v7 offset:20480
v_mfma_f32_16x16x32_bf16 v[140:143], v[164:167], a[124:127], v[140:143]
ds_read_b64_tr_b16 v[196:197], v7 offset:24576
s_lshl_b32 s61, s60, 3
v_mfma_f32_16x16x32_bf16 v[124:127], v[164:167], a[120:123], v[124:127]
ds_read_b64_tr_b16 v[198:199], v7 offset:28672
s_waitcnt lgkmcnt(8)
v_mfma_f32_16x16x32_bf16 v[124:127], v[160:163], a[112:115], v[124:127]
buffer_load_dwordx4 a[84:87], v3, s[88:91], s101 offen offset:1024 sc1
v_mfma_f32_16x16x32_bf16 v[128:131], v[168:171], a[112:115], v[128:131]
ds_read_b64_tr_b16 v[200:201], v6 offset:16640
ds_read_b64_tr_b16 v[202:203], v6 offset:20736
v_mfma_f32_16x16x32_bf16 v[128:131], v[172:175], a[120:123], v[128:131]
ds_read_b64_tr_b16 v[204:205], v6 offset:24832
s_add_u32 s62, s61, s12
v_mfma_f32_16x16x32_bf16 v[144:147], v[172:175], a[124:127], v[144:147]
ds_read_b64_tr_b16 v[206:207], v6 offset:28928
s_add_u32 s101, s101, 0x2000
v_mfma_f32_16x16x32_bf16 v[144:147], v[168:171], a[116:119], v[144:147]
buffer_load_dwordx4 a[88:91], v3, s[88:91], s101 offen sc1
v_mfma_f32_16x16x32_bf16 v[148:151], v[176:179], a[116:119], v[148:151]
ds_read_b64_tr_b16 v[208:209], v7 offset:16640
ds_read_b64_tr_b16 v[210:211], v7 offset:20736
v_mfma_f32_16x16x32_bf16 v[148:151], v[180:183], a[124:127], v[148:151]
ds_read_b64_tr_b16 v[212:213], v7 offset:24832
v_mfma_f32_16x16x32_bf16 v[132:135], v[180:183], a[120:123], v[132:135]
ds_read_b64_tr_b16 v[214:215], v7 offset:28928
s_waitcnt vmcnt(7) lgkmcnt(8)
v_mfma_f32_16x16x32_bf16 v[132:135], v[176:179], a[112:115], v[132:135]
buffer_load_dwordx4 a[92:95], v3, s[88:91], s101 offen offset:1024 sc1
s_barrier
v_mfma_f32_16x16x32_bf16 v[88:91], v[184:187], a[112:115], v[88:91]
ds_read_b64_tr_b16 v[152:153], v4 offset:512
ds_read_b64_tr_b16 v[154:155], v4 offset:4608
v_mfma_f32_16x16x32_bf16 v[88:91], v[188:191], a[120:123], v[88:91]
ds_read_b64_tr_b16 v[156:157], v4 offset:8704
s_add_u32 s101, s63, s60
v_mfma_f32_16x16x32_bf16 v[104:107], v[188:191], a[124:127], v[104:107]
ds_read_b64_tr_b16 v[158:159], v4 offset:12800
s_add_u32 m0, s16, 0x0
v_mfma_f32_16x16x32_bf16 v[104:107], v[184:187], a[116:119], v[104:107]
buffer_load_dwordx4 v12, s[64:67], s61 offen lds
v_mfma_f32_16x16x32_bf16 v[108:111], v[192:195], a[116:119], v[108:111]
ds_read_b64_tr_b16 v[160:161], v5 offset:512
ds_read_b64_tr_b16 v[162:163], v5 offset:4608
v_mfma_f32_16x16x32_bf16 v[108:111], v[196:199], a[124:127], v[108:111]
ds_read_b64_tr_b16 v[164:165], v5 offset:8704
v_mfma_f32_16x16x32_bf16 v[92:95], v[196:199], a[120:123], v[92:95]
ds_read_b64_tr_b16 v[166:167], v5 offset:12800
s_waitcnt lgkmcnt(8)
v_mfma_f32_16x16x32_bf16 v[92:95], v[192:195], a[112:115], v[92:95]
buffer_load_dwordx4 v13, s[64:67], s61 offen offset:1024 lds
v_mfma_f32_16x16x32_bf16 v[96:99], v[200:203], a[112:115], v[96:99]
ds_read_b64_tr_b16 v[168:169], v4 offset:768
ds_read_b64_tr_b16 v[170:171], v4 offset:4864
v_mfma_f32_16x16x32_bf16 v[96:99], v[204:207], a[120:123], v[96:99]
ds_read_b64_tr_b16 v[172:173], v4 offset:8960
v_mfma_f32_16x16x32_bf16 v[112:115], v[204:207], a[124:127], v[112:115]
ds_read_b64_tr_b16 v[174:175], v4 offset:13056
v_mfma_f32_16x16x32_bf16 v[112:115], v[200:203], a[116:119], v[112:115]
buffer_load_dwordx4 v12, s[64:67], s62 offen offset:2048 lds
v_mfma_f32_16x16x32_bf16 v[116:119], v[208:211], a[116:119], v[116:119]
ds_read_b64_tr_b16 v[176:177], v5 offset:768
ds_read_b64_tr_b16 v[178:179], v5 offset:4864
v_mfma_f32_16x16x32_bf16 v[116:119], v[212:215], a[124:127], v[116:119]
ds_read_b64_tr_b16 v[180:181], v5 offset:8960
s_waitcnt lgkmcnt(7)
v_mfma_f32_16x16x32_bf16 v[100:103], v[212:215], a[120:123], v[100:103]
ds_read_b64_tr_b16 v[182:183], v5 offset:13056
v_mfma_f32_16x16x32_bf16 v[100:103], v[208:211], a[112:115], v[100:103]
buffer_load_dwordx4 v13, s[64:67], s62 offen offset:3072 lds
v_mfma_f32_16x16x32_bf16 v[120:123], v[152:155], a[64:67], v[120:123]
ds_read_b64_tr_b16 v[184:185], v4 offset:0
ds_read_b64_tr_b16 v[186:187], v4 offset:4096
v_mfma_f32_16x16x32_bf16 v[120:123], v[156:159], a[72:75], v[120:123]
ds_read_b64_tr_b16 v[188:189], v4 offset:8192
s_add_u32 s60, s60, s57
v_mfma_f32_16x16x32_bf16 v[136:139], v[156:159], a[76:79], v[136:139]
ds_read_b64_tr_b16 v[190:191], v4 offset:12288
s_and_b32 s60, s60, 0x7c000
v_mfma_f32_16x16x32_bf16 v[136:139], v[152:155], a[68:71], v[136:139]
buffer_load_dwordx4 a[96:99], v3, s[88:91], s101 offen sc1
v_mfma_f32_16x16x32_bf16 v[140:143], v[160:163], a[68:71], v[140:143]
ds_read_b64_tr_b16 v[192:193], v5 offset:0
ds_read_b64_tr_b16 v[194:195], v5 offset:4096
v_mfma_f32_16x16x32_bf16 v[140:143], v[164:167], a[76:79], v[140:143]
ds_read_b64_tr_b16 v[196:197], v5 offset:8192
s_lshl_b32 s61, s60, 3
v_mfma_f32_16x16x32_bf16 v[124:127], v[164:167], a[72:75], v[124:127]
ds_read_b64_tr_b16 v[198:199], v5 offset:12288
s_waitcnt lgkmcnt(8)
v_mfma_f32_16x16x32_bf16 v[124:127], v[160:163], a[64:67], v[124:127]
buffer_load_dwordx4 a[100:103], v3, s[88:91], s101 offen offset:1024 sc1
v_mfma_f32_16x16x32_bf16 v[128:131], v[168:171], a[64:67], v[128:131]
ds_read_b64_tr_b16 v[200:201], v4 offset:256
ds_read_b64_tr_b16 v[202:203], v4 offset:4352
v_mfma_f32_16x16x32_bf16 v[128:131], v[172:175], a[72:75], v[128:131]
ds_read_b64_tr_b16 v[204:205], v4 offset:8448
s_add_u32 s62, s61, s12
v_mfma_f32_16x16x32_bf16 v[144:147], v[172:175], a[76:79], v[144:147]
ds_read_b64_tr_b16 v[206:207], v4 offset:12544
s_add_u32 s101, s101, 0x2000
v_mfma_f32_16x16x32_bf16 v[144:147], v[168:171], a[68:71], v[144:147]
buffer_load_dwordx4 a[104:107], v3, s[88:91], s101 offen sc1
v_mfma_f32_16x16x32_bf16 v[148:151], v[176:179], a[68:71], v[148:151]
ds_read_b64_tr_b16 v[208:209], v5 offset:256
ds_read_b64_tr_b16 v[210:211], v5 offset:4352
v_mfma_f32_16x16x32_bf16 v[148:151], v[180:183], a[76:79], v[148:151]
ds_read_b64_tr_b16 v[212:213], v5 offset:8448
v_mfma_f32_16x16x32_bf16 v[132:135], v[180:183], a[72:75], v[132:135]
ds_read_b64_tr_b16 v[214:215], v5 offset:12544
s_waitcnt vmcnt(7) lgkmcnt(8)
v_mfma_f32_16x16x32_bf16 v[132:135], v[176:179], a[64:67], v[132:135]
buffer_load_dwordx4 a[108:111], v3, s[88:91], s101 offen offset:1024 sc1
s_barrier
v_mfma_f32_16x16x32_bf16 v[88:91], v[184:187], a[64:67], v[88:91]
ds_read_b64_tr_b16 v[152:153], v4 offset:16896
ds_read_b64_tr_b16 v[154:155], v4 offset:20992
v_mfma_f32_16x16x32_bf16 v[88:91], v[188:191], a[72:75], v[88:91]
ds_read_b64_tr_b16 v[156:157], v4 offset:25088
s_add_u32 s101, s63, s60
v_mfma_f32_16x16x32_bf16 v[104:107], v[188:191], a[76:79], v[104:107]
ds_read_b64_tr_b16 v[158:159], v4 offset:29184
s_add_u32 m0, s16, 0x4000
v_mfma_f32_16x16x32_bf16 v[104:107], v[184:187], a[68:71], v[104:107]
buffer_load_dwordx4 v12, s[64:67], s61 offen lds
v_mfma_f32_16x16x32_bf16 v[108:111], v[192:195], a[68:71], v[108:111]
ds_read_b64_tr_b16 v[160:161], v5 offset:16896
ds_read_b64_tr_b16 v[162:163], v5 offset:20992
v_mfma_f32_16x16x32_bf16 v[108:111], v[196:199], a[76:79], v[108:111]
ds_read_b64_tr_b16 v[164:165], v5 offset:25088
v_mfma_f32_16x16x32_bf16 v[92:95], v[196:199], a[72:75], v[92:95]
ds_read_b64_tr_b16 v[166:167], v5 offset:29184
s_waitcnt lgkmcnt(8)
v_mfma_f32_16x16x32_bf16 v[92:95], v[192:195], a[64:67], v[92:95]
buffer_load_dwordx4 v13, s[64:67], s61 offen offset:1024 lds
v_mfma_f32_16x16x32_bf16 v[96:99], v[200:203], a[64:67], v[96:99]
ds_read_b64_tr_b16 v[168:169], v4 offset:17152
ds_read_b64_tr_b16 v[170:171], v4 offset:21248
v_mfma_f32_16x16x32_bf16 v[96:99], v[204:207], a[72:75], v[96:99]
ds_read_b64_tr_b16 v[172:173], v4 offset:25344
v_mfma_f32_16x16x32_bf16 v[112:115], v[204:207], a[76:79], v[112:115]
ds_read_b64_tr_b16 v[174:175], v4 offset:29440
v_mfma_f32_16x16x32_bf16 v[112:115], v[200:203], a[68:71], v[112:115]
buffer_load_dwordx4 v12, s[64:67], s62 offen offset:2048 lds
v_mfma_f32_16x16x32_bf16 v[116:119], v[208:211], a[68:71], v[116:119]
ds_read_b64_tr_b16 v[176:177], v5 offset:17152
ds_read_b64_tr_b16 v[178:179], v5 offset:21248
v_mfma_f32_16x16x32_bf16 v[116:119], v[212:215], a[76:79], v[116:119]
ds_read_b64_tr_b16 v[180:181], v5 offset:25344
s_waitcnt lgkmcnt(7)
v_mfma_f32_16x16x32_bf16 v[100:103], v[212:215], a[72:75], v[100:103]
ds_read_b64_tr_b16 v[182:183], v5 offset:29440
v_mfma_f32_16x16x32_bf16 v[100:103], v[208:211], a[64:67], v[100:103]
buffer_load_dwordx4 v13, s[64:67], s62 offen offset:3072 lds
v_mfma_f32_16x16x32_bf16 v[120:123], v[152:155], a[80:83], v[120:123]
ds_read_b64_tr_b16 v[184:185], v4 offset:16384
ds_read_b64_tr_b16 v[186:187], v4 offset:20480
v_mfma_f32_16x16x32_bf16 v[120:123], v[156:159], a[88:91], v[120:123]
ds_read_b64_tr_b16 v[188:189], v4 offset:24576
s_add_u32 s60, s60, s58
v_mfma_f32_16x16x32_bf16 v[136:139], v[156:159], a[92:95], v[136:139]
ds_read_b64_tr_b16 v[190:191], v4 offset:28672
s_and_b32 s60, s60, 0x7c000
v_mfma_f32_16x16x32_bf16 v[136:139], v[152:155], a[84:87], v[136:139]
buffer_load_dwordx4 a[112:115], v3, s[88:91], s101 offen sc1
v_mfma_f32_16x16x32_bf16 v[140:143], v[160:163], a[84:87], v[140:143]
ds_read_b64_tr_b16 v[192:193], v5 offset:16384
ds_read_b64_tr_b16 v[194:195], v5 offset:20480
v_mfma_f32_16x16x32_bf16 v[140:143], v[164:167], a[92:95], v[140:143]
ds_read_b64_tr_b16 v[196:197], v5 offset:24576
s_lshl_b32 s61, s60, 3
v_mfma_f32_16x16x32_bf16 v[124:127], v[164:167], a[88:91], v[124:127]
ds_read_b64_tr_b16 v[198:199], v5 offset:28672
s_waitcnt lgkmcnt(8)
v_mfma_f32_16x16x32_bf16 v[124:127], v[160:163], a[80:83], v[124:127]
buffer_load_dwordx4 a[116:119], v3, s[88:91], s101 offen offset:1024 sc1
v_mfma_f32_16x16x32_bf16 v[128:131], v[168:171], a[80:83], v[128:131]
ds_read_b64_tr_b16 v[200:201], v4 offset:16640
ds_read_b64_tr_b16 v[202:203], v4 offset:20736
v_mfma_f32_16x16x32_bf16 v[128:131], v[172:175], a[88:91], v[128:131]
ds_read_b64_tr_b16 v[204:205], v4 offset:24832
s_add_u32 s62, s61, s12
v_mfma_f32_16x16x32_bf16 v[144:147], v[172:175], a[92:95], v[144:147]
ds_read_b64_tr_b16 v[206:207], v4 offset:28928
s_add_u32 s101, s101, 0x2000
v_mfma_f32_16x16x32_bf16 v[144:147], v[168:171], a[84:87], v[144:147]
buffer_load_dwordx4 a[120:123], v3, s[88:91], s101 offen sc1
v_mfma_f32_16x16x32_bf16 v[148:151], v[176:179], a[84:87], v[148:151]
ds_read_b64_tr_b16 v[208:209], v5 offset:16640
ds_read_b64_tr_b16 v[210:211], v5 offset:20736
v_mfma_f32_16x16x32_bf16 v[148:151], v[180:183], a[92:95], v[148:151]
ds_read_b64_tr_b16 v[212:213], v5 offset:24832
v_mfma_f32_16x16x32_bf16 v[132:135], v[180:183], a[88:91], v[132:135]
ds_read_b64_tr_b16 v[214:215], v5 offset:28928
s_waitcnt vmcnt(7) lgkmcnt(8)
v_mfma_f32_16x16x32_bf16 v[132:135], v[176:179], a[80:83], v[132:135]
buffer_load_dwordx4 a[124:127], v3, s[88:91], s101 offen offset:1024 sc1
s_barrier
buffer_load_dword v14, v20, s[88:91], s24 offen sc1
v_mfma_f32_16x16x32_bf16 v[88:91], v[184:187], a[80:83], v[88:91]
ds_read_b64_tr_b16 v[152:153], v6 offset:512
ds_read_b64_tr_b16 v[154:155], v6 offset:4608
v_mfma_f32_16x16x32_bf16 v[88:91], v[188:191], a[88:91], v[88:91]
ds_read_b64_tr_b16 v[156:157], v6 offset:8704
s_add_u32 s101, s63, s60
v_mfma_f32_16x16x32_bf16 v[104:107], v[188:191], a[92:95], v[104:107]
ds_read_b64_tr_b16 v[158:159], v6 offset:12800
s_add_u32 m0, s17, 0x10000
v_mfma_f32_16x16x32_bf16 v[104:107], v[184:187], a[84:87], v[104:107]
buffer_load_dwordx4 v12, s[64:67], s61 offen lds
v_mfma_f32_16x16x32_bf16 v[108:111], v[192:195], a[84:87], v[108:111]
ds_read_b64_tr_b16 v[160:161], v7 offset:512
ds_read_b64_tr_b16 v[162:163], v7 offset:4608
v_mfma_f32_16x16x32_bf16 v[108:111], v[196:199], a[92:95], v[108:111]
ds_read_b64_tr_b16 v[164:165], v7 offset:8704
s_sub_u32 s15, s15, 1
v_mfma_f32_16x16x32_bf16 v[92:95], v[196:199], a[88:91], v[92:95]
ds_read_b64_tr_b16 v[166:167], v7 offset:12800
s_waitcnt lgkmcnt(8)
v_mfma_f32_16x16x32_bf16 v[92:95], v[192:195], a[80:83], v[92:95]
buffer_load_dwordx4 v13, s[64:67], s61 offen offset:1024 lds
v_mfma_f32_16x16x32_bf16 v[96:99], v[200:203], a[80:83], v[96:99]
ds_read_b64_tr_b16 v[168:169], v6 offset:768
ds_read_b64_tr_b16 v[170:171], v6 offset:4864
v_mfma_f32_16x16x32_bf16 v[96:99], v[204:207], a[88:91], v[96:99]
ds_read_b64_tr_b16 v[172:173], v6 offset:8960
v_mfma_f32_16x16x32_bf16 v[112:115], v[204:207], a[92:95], v[112:115]
ds_read_b64_tr_b16 v[174:175], v6 offset:13056
v_mfma_f32_16x16x32_bf16 v[112:115], v[200:203], a[84:87], v[112:115]
buffer_load_dwordx4 v12, s[64:67], s62 offen offset:2048 lds
v_mfma_f32_16x16x32_bf16 v[116:119], v[208:211], a[84:87], v[116:119]
ds_read_b64_tr_b16 v[176:177], v7 offset:768
ds_read_b64_tr_b16 v[178:179], v7 offset:4864
v_mfma_f32_16x16x32_bf16 v[116:119], v[212:215], a[92:95], v[116:119]
ds_read_b64_tr_b16 v[180:181], v7 offset:8960
s_waitcnt lgkmcnt(7)
v_mfma_f32_16x16x32_bf16 v[100:103], v[212:215], a[88:91], v[100:103]
ds_read_b64_tr_b16 v[182:183], v7 offset:13056
v_mfma_f32_16x16x32_bf16 v[100:103], v[208:211], a[80:83], v[100:103]
buffer_load_dwordx4 v13, s[64:67], s62 offen offset:3072 lds
v_mfma_f32_16x16x32_bf16 v[120:123], v[152:155], a[96:99], v[120:123]
ds_read_b64_tr_b16 v[184:185], v6 offset:0
ds_read_b64_tr_b16 v[186:187], v6 offset:4096
v_mfma_f32_16x16x32_bf16 v[120:123], v[156:159], a[104:107], v[120:123]
ds_read_b64_tr_b16 v[188:189], v6 offset:8192
s_add_u32 s60, s60, s59
v_mfma_f32_16x16x32_bf16 v[136:139], v[156:159], a[108:111], v[136:139]
ds_read_b64_tr_b16 v[190:191], v6 offset:12288
s_and_b32 s60, s60, 0x7c000
v_mfma_f32_16x16x32_bf16 v[136:139], v[152:155], a[100:103], v[136:139]
buffer_load_dwordx4 a[64:67], v3, s[88:91], s101 offen sc1
v_mfma_f32_16x16x32_bf16 v[140:143], v[160:163], a[100:103], v[140:143]
ds_read_b64_tr_b16 v[192:193], v7 offset:0
ds_read_b64_tr_b16 v[194:195], v7 offset:4096
v_mfma_f32_16x16x32_bf16 v[140:143], v[164:167], a[108:111], v[140:143]
ds_read_b64_tr_b16 v[196:197], v7 offset:8192
s_lshl_b32 s61, s60, 3
v_mfma_f32_16x16x32_bf16 v[124:127], v[164:167], a[104:107], v[124:127]
ds_read_b64_tr_b16 v[198:199], v7 offset:12288
s_waitcnt lgkmcnt(8)
v_mfma_f32_16x16x32_bf16 v[124:127], v[160:163], a[96:99], v[124:127]
buffer_load_dwordx4 a[68:71], v3, s[88:91], s101 offen offset:1024 sc1
v_mfma_f32_16x16x32_bf16 v[128:131], v[168:171], a[96:99], v[128:131]
ds_read_b64_tr_b16 v[200:201], v6 offset:256
ds_read_b64_tr_b16 v[202:203], v6 offset:4352
v_mfma_f32_16x16x32_bf16 v[128:131], v[172:175], a[104:107], v[128:131]
ds_read_b64_tr_b16 v[204:205], v6 offset:8448
s_add_u32 s62, s61, s12
v_mfma_f32_16x16x32_bf16 v[144:147], v[172:175], a[108:111], v[144:147]
ds_read_b64_tr_b16 v[206:207], v6 offset:12544
s_add_u32 s101, s101, 0x2000
v_mfma_f32_16x16x32_bf16 v[144:147], v[168:171], a[100:103], v[144:147]
buffer_load_dwordx4 a[72:75], v3, s[88:91], s101 offen sc1
v_mfma_f32_16x16x32_bf16 v[148:151], v[176:179], a[100:103], v[148:151]
ds_read_b64_tr_b16 v[208:209], v7 offset:256
ds_read_b64_tr_b16 v[210:211], v7 offset:4352
v_mfma_f32_16x16x32_bf16 v[148:151], v[180:183], a[108:111], v[148:151]
ds_read_b64_tr_b16 v[212:213], v7 offset:8448
v_mfma_f32_16x16x32_bf16 v[132:135], v[180:183], a[104:107], v[132:135]
ds_read_b64_tr_b16 v[214:215], v7 offset:12544
s_waitcnt vmcnt(7) lgkmcnt(8)
v_mfma_f32_16x16x32_bf16 v[132:135], v[176:179], a[96:99], v[132:135]
buffer_load_dwordx4 a[76:79], v3, s[88:91], s101 offen offset:1024 sc1
s_barrier
v_cmp_ne_u32 vcc, 1, v14
s_cmp_lg_u32 s15, 0
s_cbranch_scc0 L_p4_exit
s_cbranch_vccz L_p4_loop0
s_mov_b32 s92, 200000
L_spin_d0:
v_cmp_ne_u32 vcc, 1, v14
s_nop 4
s_cbranch_vccz L_spun_d0
s_sub_u32 s92, s92, 1
s_cbranch_scc1 L_spun_d0
s_sleep 6
buffer_load_dword v14, v20, s[88:91], s24 offen sc1
s_waitcnt vmcnt(0)
s_branch L_spin_d0
L_spun_d0:
s_branch L_p4_loop0
L_p4_loop1:
v_mfma_f32_16x16x32_bf16 v[88:91], v[184:187], a[96:99], v[88:91]
ds_read_b64_tr_b16 v[152:153], v6 offset:16896
ds_read_b64_tr_b16 v[154:155], v6 offset:20992
v_mfma_f32_16x16x32_bf16 v[88:91], v[188:191], a[104:107], v[88:91]
ds_read_b64_tr_b16 v[156:157], v6 offset:25088
s_add_u32 s101, s63, s60
v_mfma_f32_16x16x32_bf16 v[104:107], v[188:191], a[108:111], v[104:107]
ds_read_b64_tr_b16 v[158:159], v6 offset:29184
s_add_u32 m0, s17, 0x14000
v_mfma_f32_16x16x32_bf16 v[104:107], v[184:187], a[100:103], v[104:107]
buffer_load_dwordx4 v12, s[64:67], s61 offen lds
v_mfma_f32_16x16x32_bf16 v[108:111], v[192:195], a[100:103], v[108:111]
ds_read_b64_tr_b16 v[160:161], v7 offset:16896
ds_read_b64_tr_b16 v[162:163], v7 offset:20992
v_mfma_f32_16x16x32_bf16 v[108:111], v[196:199], a[108:111], v[108:111]
ds_read_b64_tr_b16 v[164:165], v7 offset:25088
v_mfma_f32_16x16x32_bf16 v[92:95], v[196:199], a[104:107], v[92:95]
ds_read_b64_tr_b16 v[166:167], v7 offset:29184
s_waitcnt lgkmcnt(8)
v_mfma_f32_16x16x32_bf16 v[92:95], v[192:195], a[96:99], v[92:95]
buffer_load_dwordx4 v13, s[64:67], s61 offen offset:1024 lds
v_mfma_f32_16x16x32_bf16 v[96:99], v[200:203], a[96:99], v[96:99]
ds_read_b64_tr_b16 v[168:169], v6 offset:17152
ds_read_b64_tr_b16 v[170:171], v6 offset:21248
v_mfma_f32_16x16x32_bf16 v[96:99], v[204:207], a[104:107], v[96:99]
ds_read_b64_tr_b16 v[172:173], v6 offset:25344
v_mfma_f32_16x16x32_bf16 v[112:115], v[204:207], a[108:111], v[112:115]
ds_read_b64_tr_b16 v[174:175], v6 offset:29440
v_mfma_f32_16x16x32_bf16 v[112:115], v[200:203], a[100:103], v[112:115]
buffer_load_dwordx4 v12, s[64:67], s62 offen offset:2048 lds
v_mfma_f32_16x16x32_bf16 v[116:119], v[208:211], a[100:103], v[116:119]
ds_read_b64_tr_b16 v[176:177], v7 offset:17152
ds_read_b64_tr_b16 v[178:179], v7 offset:21248
v_mfma_f32_16x16x32_bf16 v[116:119], v[212:215], a[108:111], v[116:119]
ds_read_b64_tr_b16 v[180:181], v7 offset:25344
s_waitcnt lgkmcnt(7)
v_mfma_f32_16x16x32_bf16 v[100:103], v[212:215], a[104:107], v[100:103]
ds_read_b64_tr_b16 v[182:183], v7 offset:29440
v_mfma_f32_16x16x32_bf16 v[100:103], v[208:211], a[96:99], v[100:103]
buffer_load_dwordx4 v13, s[64:67], s62 offen offset:3072 lds
v_mfma_f32_16x16x32_bf16 v[120:123], v[152:155], a[112:115], v[120:123]
ds_read_b64_tr_b16 v[184:185], v6 offset:16384
ds_read_b64_tr_b16 v[186:187], v6 offset:20480
v_mfma_f32_16x16x32_bf16 v[120:123], v[156:159], a[120:123], v[120:123]
ds_read_b64_tr_b16 v[188:189], v6 offset:24576
s_add_u32 s60, s60, s56
v_mfma_f32_16x16x32_bf16 v[136:139], v[156:159], a[124:127], v[136:139]
ds_read_b64_tr_b16 v[190:191], v6 offset:28672
s_and_b32 s60, s60, 0x7c000
v_mfma_f32_16x16x32_bf16 v[136:139], v[152:155], a[116:119], v[136:139]
buffer_load_dwordx4 a[80:83], v3, s[88:91], s101 offen sc1
v_mfma_f32_16x16x32_bf16 v[140:143], v[160:163], a[116:119], v[140:143]
ds_read_b64_tr_b16 v[192:193], v7 offset:16384
ds_read_b64_tr_b16 v[194:195], v7 offset:20480
v_mfma_f32_16x16x32_bf16 v[140:143], v[164:167], a[124:127], v[140:143]
ds_read_b64_tr_b16 v[196:197], v7 offset:24576
s_lshl_b32 s61, s60, 3
v_mfma_f32_16x16x32_bf16 v[124:127], v[164:167], a[120:123], v[124:127]
ds_read_b64_tr_b16 v[198:199], v7 offset:28672
s_waitcnt lgkmcnt(8)
v_mfma_f32_16x16x32_bf16 v[124:127], v[160:163], a[112:115], v[124:127]
buffer_load_dwordx4 a[84:87], v3, s[88:91], s101 offen offset:1024 sc1
v_mfma_f32_16x16x32_bf16 v[128:131], v[168:171], a[112:115], v[128:131]
ds_read_b64_tr_b16 v[200:201], v6 offset:16640
ds_read_b64_tr_b16 v[202:203], v6 offset:20736
v_mfma_f32_16x16x32_bf16 v[128:131], v[172:175], a[120:123], v[128:131]
ds_read_b64_tr_b16 v[204:205], v6 offset:24832
s_add_u32 s62, s61, s12
v_mfma_f32_16x16x32_bf16 v[144:147], v[172:175], a[124:127], v[144:147]
ds_read_b64_tr_b16 v[206:207], v6 offset:28928
s_add_u32 s101, s101, 0x2000
v_mfma_f32_16x16x32_bf16 v[144:147], v[168:171], a[116:119], v[144:147]
buffer_load_dwordx4 a[88:91], v3, s[88:91], s101 offen sc1
v_mfma_f32_16x16x32_bf16 v[148:151], v[176:179], a[116:119], v[148:151]
ds_read_b64_tr_b16 v[208:209], v7 offset:16640
ds_read_b64_tr_b16 v[210:211], v7 offset:20736
s_waitcnt vmcnt(7) lgkmcnt(6)
v_mfma_f32_16x16x32_bf16 v[148:151], v[180:183], a[124:127], v[148:151]
ds_read_b64_tr_b16 v[212:213], v7 offset:24832
s_barrier
v_mfma_f32_16x16x32_bf16 v[132:135], v[180:183], a[120:123], v[132:135]
ds_read_b64_tr_b16 v[214:215], v7 offset:28928
v_mfma_f32_16x16x32_bf16 v[132:135], v[176:179], a[112:115], v[132:135]
buffer_load_dwordx4 a[92:95], v3, s[88:91], s101 offen offset:1024 sc1
v_mfma_f32_16x16x32_bf16 v[88:91], v[184:187], a[112:115], v[88:91]
ds_read_b64_tr_b16 v[152:153], v4 offset:512
ds_read_b64_tr_b16 v[154:155], v4 offset:4608
v_mfma_f32_16x16x32_bf16 v[88:91], v[188:191], a[120:123], v[88:91]
ds_read_b64_tr_b16 v[156:157], v4 offset:8704
s_add_u32 s101, s63, s60
v_mfma_f32_16x16x32_bf16 v[104:107], v[188:191], a[124:127], v[104:107]
ds_read_b64_tr_b16 v[158:159], v4 offset:12800
s_add_u32 m0, s16, 0x0
v_mfma_f32_16x16x32_bf16 v[104:107], v[184:187], a[116:119], v[104:107]
buffer_load_dwordx4 v12, s[64:67], s61 offen lds
v_mfma_f32_16x16x32_bf16 v[108:111], v[192:195], a[116:119], v[108:111]
ds_read_b64_tr_b16 v[160:161], v5 offset:512
ds_read_b64_tr_b16 v[162:163], v5 offset:4608
v_mfma_f32_16x16x32_bf16 v[108:111], v[196:199], a[124:127], v[108:111]
ds_read_b64_tr_b16 v[164:165], v5 offset:8704
v_mfma_f32_16x16x32_bf16 v[92:95], v[196:199], a[120:123], v[92:95]
ds_read_b64_tr_b16 v[166:167], v5 offset:12800
s_waitcnt lgkmcnt(8)
v_mfma_f32_16x16x32_bf16 v[92:95], v[192:195], a[112:115], v[92:95]
buffer_load_dwordx4 v13, s[64:67], s61 offen offset:1024 lds
v_mfma_f32_16x16x32_bf16 v[96:99], v[200:203], a[112:115], v[96:99]
ds_read_b64_tr_b16 v[168:169], v4 offset:768
ds_read_b64_tr_b16 v[170:171], v4 offset:4864
v_mfma_f32_16x16x32_bf16 v[96:99], v[204:207], a[120:123], v[96:99]
ds_read_b64_tr_b16 v[172:173], v4 offset:8960
v_mfma_f32_16x16x32_bf16 v[112:115], v[204:207], a[124:127], v[112:115]
ds_read_b64_tr_b16 v[174:175], v4 offset:13056
v_mfma_f32_16x16x32_bf16 v[112:115], v[200:203], a[116:119], v[112:115]
buffer_load_dwordx4 v12, s[64:67], s62 offen offset:2048 lds
v_mfma_f32_16x16x32_bf16 v[116:119], v[208:211], a[116:119], v[116:119]
ds_read_b64_tr_b16 v[176:177], v5 offset:768
ds_read_b64_tr_b16 v[178:179], v5 offset:4864
v_mfma_f32_16x16x32_bf16 v[116:119], v[212:215], a[124:127], v[116:119]
ds_read_b64_tr_b16 v[180:181], v5 offset:8960
s_waitcnt lgkmcnt(7)
v_mfma_f32_16x16x32_bf16 v[100:103], v[212:215], a[120:123], v[100:103]
ds_read_b64_tr_b16 v[182:183], v5 offset:13056
v_mfma_f32_16x16x32_bf16 v[100:103], v[208:211], a[112:115], v[100:103]
buffer_load_dwordx4 v13, s[64:67], s62 offen offset:3072 lds
v_mfma_f32_16x16x32_bf16 v[120:123], v[152:155], a[64:67], v[120:123]
ds_read_b64_tr_b16 v[184:185], v4 offset:0
ds_read_b64_tr_b16 v[186:187], v4 offset:4096
v_mfma_f32_16x16x32_bf16 v[120:123], v[156:159], a[72:75], v[120:123]
ds_read_b64_tr_b16 v[188:189], v4 offset:8192
s_add_u32 s60, s60, s57
v_mfma_f32_16x16x32_bf16 v[136:139], v[156:159], a[76:79], v[136:139]
ds_read_b64_tr_b16 v[190:191], v4 offset:12288
s_and_b32 s60, s60, 0x7c000
v_mfma_f32_16x16x32_bf16 v[136:139], v[152:155], a[68:71], v[136:139]
buffer_load_dwordx4 a[96:99], v3, s[88:91], s101 offen sc1
v_mfma_f32_16x16x32_bf16 v[140:143], v[160:163], a[68:71], v[140:143]
ds_read_b64_tr_b16 v[192:193], v5 offset:0
ds_read_b64_tr_b16 v[194:195], v5 offset:4096
v_mfma_f32_16x16x32_bf16 v[140:143], v[164:167], a[76:79], v[140:143]
ds_read_b64_tr_b16 v[196:197], v5 offset:8192
s_lshl_b32 s61, s60, 3
v_mfma_f32_16x16x32_bf16 v[124:127], v[164:167], a[72:75], v[124:127]
ds_read_b64_tr_b16 v[198:199], v5 offset:12288
s_waitcnt lgkmcnt(8)
v_mfma_f32_16x16x32_bf16 v[124:127], v[160:163], a[64:67], v[124:127]
buffer_load_dwordx4 a[100:103], v3, s[88:91], s101 offen offset:1024 sc1
v_mfma_f32_16x16x32_bf16 v[128:131], v[168:171], a[64:67], v[128:131]
ds_read_b64_tr_b16 v[200:201], v4 offset:256
ds_read_b64_tr_b16 v[202:203], v4 offset:4352
v_mfma_f32_16x16x32_bf16 v[128:131], v[172:175], a[72:75], v[128:131]
ds_read_b64_tr_b16 v[204:205], v4 offset:8448
s_add_u32 s62, s61, s12
v_mfma_f32_16x16x32_bf16 v[144:147], v[172:175], a[76:79], v[144:147]
ds_read_b64_tr_b16 v[206:207], v4 offset:12544
s_add_u32 s101, s101, 0x2000
v_mfma_f32_16x16x32_bf16 v[144:147], v[168:171], a[68:71], v[144:147]
buffer_load_dwordx4 a[104:107], v3, s[88:91], s101 offen sc1
v_mfma_f32_16x16x32_bf16 v[148:151], v[176:179], a[68:71], v[148:151]
ds_read_b64_tr_b16 v[208:209], v5 offset:256
ds_read_b64_tr_b16 v[210:211], v5 offset:4352
s_waitcnt vmcnt(7) lgkmcnt(6)
v_mfma_f32_16x16x32_bf16 v[148:151], v[180:183], a[76:79], v[148:151]
ds_read_b64_tr_b16 v[212:213], v5 offset:8448
s_barrier
v_mfma_f32_16x16x32_bf16 v[132:135], v[180:183], a[72:75], v[132:135]
ds_read_b64_tr_b16 v[214:215], v5 offset:12544
v_mfma_f32_16x16x32_bf16 v[132:135], v[176:179], a[64:67], v[132:135]
buffer_load_dwordx4 a[108:111], v3, s[88:91], s101 offen offset:1024 sc1
v_mfma_f32_16x16x32_bf16 v[88:91], v[184:187], a[64:67], v[88:91]
ds_read_b64_tr_b16 v[152:153], v4 offset:16896
ds_read_b64_tr_b16 v[154:155], v4 offset:20992
v_mfma_f32_16x16x32_bf16 v[88:91], v[188:191], a[72:75], v[88:91]
ds_read_b64_tr_b16 v[156:157], v4 offset:25088
s_add_u32 s101, s63, s60
v_mfma_f32_16x16x32_bf16 v[104:107], v[188:191], a[76:79], v[104:107]
ds_read_b64_tr_b16 v[158:159], v4 offset:29184
s_add_u32 m0, s16, 0x4000
v_mfma_f32_16x16x32_bf16 v[104:107], v[184:187], a[68:71], v[104:107]
buffer_load_dwordx4 v12, s[64:67], s61 offen lds
v_mfma_f32_16x16x32_bf16 v[108:111], v[192:195], a[68:71], v[108:111]
ds_read_b64_tr_b16 v[160:161], v5 offset:16896
ds_read_b64_tr_b16 v[162:163], v5 offset:20992
v_mfma_f32_16x16x32_bf16 v[108:111], v[196:199], a[76:79], v[108:111]
ds_read_b64_tr_b16 v[164:165], v5 offset:25088
v_mfma_f32_16x16x32_bf16 v[92:95], v[196:199], a[72:75], v[92:95]
ds_read_b64_tr_b16 v[166:167], v5 offset:29184
s_waitcnt lgkmcnt(8)
v_mfma_f32_16x16x32_bf16 v[92:95], v[192:195], a[64:67], v[92:95]
buffer_load_dwordx4 v13, s[64:67], s61 offen offset:1024 lds
v_mfma_f32_16x16x32_bf16 v[96:99], v[200:203], a[64:67], v[96:99]
ds_read_b64_tr_b16 v[168:169], v4 offset:17152
ds_read_b64_tr_b16 v[170:171], v4 offset:21248
v_mfma_f32_16x16x32_bf16 v[96:99], v[204:207], a[72:75], v[96:99]
ds_read_b64_tr_b16 v[172:173], v4 offset:25344
v_mfma_f32_16x16x32_bf16 v[112:115], v[204:207], a[76:79], v[112:115]
ds_read_b64_tr_b16 v[174:175], v4 offset:29440
v_mfma_f32_16x16x32_bf16 v[112:115], v[200:203], a[68:71], v[112:115]
buffer_load_dwordx4 v12, s[64:67], s62 offen offset:2048 lds
v_mfma_f32_16x16x32_bf16 v[116:119], v[208:211], a[68:71], v[116:119]
ds_read_b64_tr_b16 v[176:177], v5 offset:17152
ds_read_b64_tr_b16 v[178:179], v5 offset:21248
v_mfma_f32_16x16x32_bf16 v[116:119], v[212:215], a[76:79], v[116:119]
ds_read_b64_tr_b16 v[180:181], v5 offset:25344
s_waitcnt lgkmcnt(7)
v_mfma_f32_16x16x32_bf16 v[100:103], v[212:215], a[72:75], v[100:103]
ds_read_b64_tr_b16 v[182:183], v5 offset:29440
v_mfma_f32_16x16x32_bf16 v[100:103], v[208:211], a[64:67], v[100:103]
buffer_load_dwordx4 v13, s[64:67], s62 offen offset:3072 lds
v_mfma_f32_16x16x32_bf16 v[120:123], v[152:155], a[80:83], v[120:123]
ds_read_b64_tr_b16 v[184:185], v4 offset:16384
ds_read_b64_tr_b16 v[186:187], v4 offset:20480
v_mfma_f32_16x16x32_bf16 v[120:123], v[156:159], a[88:91], v[120:123]
ds_read_b64_tr_b16 v[188:189], v4 offset:24576
s_add_u32 s60, s60, s58
v_mfma_f32_16x16x32_bf16 v[136:139], v[156:159], a[92:95], v[136:139]
ds_read_b64_tr_b16 v[190:191], v4 offset:28672
s_and_b32 s60, s60, 0x7c000
v_mfma_f32_16x16x32_bf16 v[136:139], v[152:155], a[84:87], v[136:139]
buffer_load_dwordx4 a[112:115], v3, s[88:91], s101 offen sc1
v_mfma_f32_16x16x32_bf16 v[140:143], v[160:163], a[84:87], v[140:143]
ds_read_b64_tr_b16 v[192:193], v5 offset:16384
ds_read_b64_tr_b16 v[194:195], v5 offset:20480
v_mfma_f32_16x16x32_bf16 v[140:143], v[164:167], a[92:95], v[140:143]
ds_read_b64_tr_b16 v[196:197], v5 offset:24576
s_lshl_b32 s61, s60, 3
v_mfma_f32_16x16x32_bf16 v[124:127], v[164:167], a[88:91], v[124:127]
ds_read_b64_tr_b16 v[198:199], v5 offset:28672
s_waitcnt lgkmcnt(8)
v_mfma_f32_16x16x32_bf16 v[124:127], v[160:163], a[80:83], v[124:127]
buffer_load_dwordx4 a[116:119], v3, s[88:91], s101 offen offset:1024 sc1
v_mfma_f32_16x16x32_bf16 v[128:131], v[168:171], a[80:83], v[128:131]
ds_read_b64_tr_b16 v[200:201], v4 offset:16640
ds_read_b64_tr_b16 v[202:203], v4 offset:20736
v_mfma_f32_16x16x32_bf16 v[128:131], v[172:175], a[88:91], v[128:131]
ds_read_b64_tr_b16 v[204:205], v4 offset:24832
s_add_u32 s62, s61, s12
v_mfma_f32_16x16x32_bf16 v[144:147], v[172:175], a[92:95], v[144:147]
ds_read_b64_tr_b16 v[206:207], v4 offset:28928
s_add_u32 s101, s101, 0x2000
v_mfma_f32_16x16x32_bf16 v[144:147], v[168:171], a[84:87], v[144:147]
buffer_load_dwordx4 a[120:123], v3, s[88:91], s101 offen sc1
v_mfma_f32_16x16x32_bf16 v[148:151], v[176:179], a[84:87], v[148:151]
ds_read_b64_tr_b16 v[208:209], v5 offset:16640
ds_read_b64_tr_b16 v[210:211], v5 offset:20736
s_waitcnt vmcnt(7) lgkmcnt(6)
v_mfma_f32_16x16x32_bf16 v[148:151], v[180:183], a[92:95], v[148:151]
ds_read_b64_tr_b16 v[212:213], v5 offset:24832
s_barrier
v_mfma_f32_16x16x32_bf16 v[132:135], v[180:183], a[88:91], v[132:135]
ds_read_b64_tr_b16 v[214:215], v5 offset:28928
v_mfma_f32_16x16x32_bf16 v[132:135], v[176:179], a[80:83], v[132:135]
buffer_load_dwordx4 a[124:127], v3, s[88:91], s101 offen offset:1024 sc1
buffer_load_dword v14, v20, s[88:91], s24 offen sc1
v_mfma_f32_16x16x32_bf16 v[88:91], v[184:187], a[80:83], v[88:91]
ds_read_b64_tr_b16 v[152:153], v6 offset:512
ds_read_b64_tr_b16 v[154:155], v6 offset:4608
v_mfma_f32_16x16x32_bf16 v[88:91], v[188:191], a[88:91], v[88:91]
ds_read_b64_tr_b16 v[156:157], v6 offset:8704
s_add_u32 s101, s63, s60
v_mfma_f32_16x16x32_bf16 v[104:107], v[188:191], a[92:95], v[104:107]
ds_read_b64_tr_b16 v[158:159], v6 offset:12800
s_add_u32 m0, s17, 0x10000
v_mfma_f32_16x16x32_bf16 v[104:107], v[184:187], a[84:87], v[104:107]
buffer_load_dwordx4 v12, s[64:67], s61 offen lds
v_mfma_f32_16x16x32_bf16 v[108:111], v[192:195], a[84:87], v[108:111]
ds_read_b64_tr_b16 v[160:161], v7 offset:512
ds_read_b64_tr_b16 v[162:163], v7 offset:4608
v_mfma_f32_16x16x32_bf16 v[108:111], v[196:199], a[92:95], v[108:111]
ds_read_b64_tr_b16 v[164:165], v7 offset:8704
s_sub_u32 s15, s15, 1
v_mfma_f32_16x16x32_bf16 v[92:95], v[196:199], a[88:91], v[92:95]
ds_read_b64_tr_b16 v[166:167], v7 offset:12800
s_waitcnt lgkmcnt(8)
v_mfma_f32_16x16x32_bf16 v[92:95], v[192:195], a[80:83], v[92:95]
buffer_load_dwordx4 v13, s[64:67], s61 offen offset:1024 lds
v_mfma_f32_16x16x32_bf16 v[96:99], v[200:203], a[80:83], v[96:99]
ds_read_b64_tr_b16 v[168:169], v6 offset:768
ds_read_b64_tr_b16 v[170:171], v6 offset:4864
v_mfma_f32_16x16x32_bf16 v[96:99], v[204:207], a[88:91], v[96:99]
ds_read_b64_tr_b16 v[172:173], v6 offset:8960
v_mfma_f32_16x16x32_bf16 v[112:115], v[204:207], a[92:95], v[112:115]
ds_read_b64_tr_b16 v[174:175], v6 offset:13056
v_mfma_f32_16x16x32_bf16 v[112:115], v[200:203], a[84:87], v[112:115]
buffer_load_dwordx4 v12, s[64:67], s62 offen offset:2048 lds
v_mfma_f32_16x16x32_bf16 v[116:119], v[208:211], a[84:87], v[116:119]
ds_read_b64_tr_b16 v[176:177], v7 offset:768
ds_read_b64_tr_b16 v[178:179], v7 offset:4864
v_mfma_f32_16x16x32_bf16 v[116:119], v[212:215], a[92:95], v[116:119]
ds_read_b64_tr_b16 v[180:181], v7 offset:8960
s_waitcnt lgkmcnt(7)
v_mfma_f32_16x16x32_bf16 v[100:103], v[212:215], a[88:91], v[100:103]
ds_read_b64_tr_b16 v[182:183], v7 offset:13056
v_mfma_f32_16x16x32_bf16 v[100:103], v[208:211], a[80:83], v[100:103]
buffer_load_dwordx4 v13, s[64:67], s62 offen offset:3072 lds
v_mfma_f32_16x16x32_bf16 v[120:123], v[152:155], a[96:99], v[120:123]
ds_read_b64_tr_b16 v[184:185], v6 offset:0
ds_read_b64_tr_b16 v[186:187], v6 offset:4096
v_mfma_f32_16x16x32_bf16 v[120:123], v[156:159], a[104:107], v[120:123]
ds_read_b64_tr_b16 v[188:189], v6 offset:8192
s_add_u32 s60, s60, s59
v_mfma_f32_16x16x32_bf16 v[136:139], v[156:159], a[108:111], v[136:139]
ds_read_b64_tr_b16 v[190:191], v6 offset:12288
s_and_b32 s60, s60, 0x7c000
v_mfma_f32_16x16x32_bf16 v[136:139], v[152:155], a[100:103], v[136:139]
buffer_load_dwordx4 a[64:67], v3, s[88:91], s101 offen sc1
v_mfma_f32_16x16x32_bf16 v[140:143], v[160:163], a[100:103], v[140:143]
ds_read_b64_tr_b16 v[192:193], v7 offset:0
ds_read_b64_tr_b16 v[194:195], v7 offset:4096
v_mfma_f32_16x16x32_bf16 v[140:143], v[164:167], a[108:111], v[140:143]
ds_read_b64_tr_b16 v[196:197], v7 offset:8192
s_lshl_b32 s61, s60, 3
v_mfma_f32_16x16x32_bf16 v[124:127], v[164:167], a[104:107], v[124:127]
ds_read_b64_tr_b16 v[198:199], v7 offset:12288
s_waitcnt lgkmcnt(8)
v_mfma_f32_16x16x32_bf16 v[124:127], v[160:163], a[96:99], v[124:127]
buffer_load_dwordx4 a[68:71], v3, s[88:91], s101 offen offset:1024 sc1
v_mfma_f32_16x16x32_bf16 v[128:131], v[168:171], a[96:99], v[128:131]
ds_read_b64_tr_b16 v[200:201], v6 offset:256
ds_read_b64_tr_b16 v[202:203], v6 offset:4352
v_mfma_f32_16x16x32_bf16 v[128:131], v[172:175], a[104:107], v[128:131]
ds_read_b64_tr_b16 v[204:205], v6 offset:8448
s_add_u32 s62, s61, s12
v_mfma_f32_16x16x32_bf16 v[144:147], v[172:175], a[108:111], v[144:147]
ds_read_b64_tr_b16 v[206:207], v6 offset:12544
s_add_u32 s101, s101, 0x2000
v_mfma_f32_16x16x32_bf16 v[144:147], v[168:171], a[100:103], v[144:147]
buffer_load_dwordx4 a[72:75], v3, s[88:91], s101 offen sc1
v_mfma_f32_16x16x32_bf16 v[148:151], v[176:179], a[100:103], v[148:151]
ds_read_b64_tr_b16 v[208:209], v7 offset:256
ds_read_b64_tr_b16 v[210:211], v7 offset:4352
s_waitcnt vmcnt(7) lgkmcnt(6)
v_mfma_f32_16x16x32_bf16 v[148:151], v[180:183], a[108:111], v[148:151]
ds_read_b64_tr_b16 v[212:213], v7 offset:8448
s_barrier
v_mfma_f32_16x16x32_bf16 v[132:135], v[180:183], a[104:107], v[132:135]
ds_read_b64_tr_b16 v[214:215], v7 offset:12544
v_mfma_f32_16x16x32_bf16 v[132:135], v[176:179], a[96:99], v[132:135]
buffer_load_dwordx4 a[76:79], v3, s[88:91], s101 offen offset:1024 sc1
v_cmp_ne_u32 vcc, 1, v14
s_cmp_lg_u32 s15, 0
s_cbranch_scc0 L_p4_exit
s_cbranch_vccz L_p4_loop1
s_mov_b32 s92, 200000
L_spin_d1:
v_cmp_ne_u32 vcc, 1, v14
s_nop 4
s_cbranch_vccz L_spun_d1
s_sub_u32 s92, s92, 1
s_cbranch_scc1 L_spun_d1
s_sleep 6
buffer_load_dword v14, v20, s[88:91], s24 offen sc1
s_waitcnt vmcnt(0)
s_branch L_spin_d1
L_spun_d1:
s_branch L_p4_loop1
L_p4_exit:
s_add_u32 s101, s63, s60
v_mfma_f32_16x16x32_bf16 v[88:91], v[184:187], a[96:99], v[88:91]
ds_read_b64_tr_b16 v[152:153], v6 offset:16896
ds_read_b64_tr_b16 v[154:155], v6 offset:20992
s_add_u32 m0, s17, 0x14000
v_mfma_f32_16x16x32_bf16 v[88:91], v[188:191], a[104:107], v[88:91]
buffer_load_dwordx4 v12, s[64:67], s61 offen lds
v_mfma_f32_16x16x32_bf16 v[104:107], v[188:191], a[108:111], v[104:107]
ds_read_b64_tr_b16 v[156:157], v6 offset:25088
ds_read_b64_tr_b16 v[158:159], v6 offset:29184
v_mfma_f32_16x16x32_bf16 v[104:107], v[184:187], a[100:103], v[104:107]
buffer_load_dwordx4 v13, s[64:67], s61 offen offset:1024 lds
v_mfma_f32_16x16x32_bf16 v[108:111], v[192:195], a[100:103], v[108:111]
ds_read_b64_tr_b16 v[160:161], v7 offset:16896
ds_read_b64_tr_b16 v[162:163], v7 offset:20992
v_mfma_f32_16x16x32_bf16 v[108:111], v[196:199], a[108:111], v[108:111]
buffer_load_dwordx4 v12, s[64:67], s62 offen offset:2048 lds
v_mfma_f32_16x16x32_bf16 v[92:95], v[196:199], a[104:107], v[92:95]
ds_read_b64_tr_b16 v[164:165], v7 offset:25088
ds_read_b64_tr_b16 v[166:167], v7 offset:29184
s_waitcnt lgkmcnt(8)
v_mfma_f32_16x16x32_bf16 v[92:95], v[192:195], a[96:99], v[92:95]
buffer_load_dwordx4 v13, s[64:67], s62 offen offset:3072 lds
v_mfma_f32_16x16x32_bf16 v[96:99], v[200:203], a[96:99], v[96:99]
ds_read_b64_tr_b16 v[168:169], v6 offset:17152
ds_read_b64_tr_b16 v[170:171], v6 offset:21248
v_mfma_f32_16x16x32_bf16 v[96:99], v[204:207], a[104:107], v[96:99]
buffer_load_dwordx4 a[80:83], v3, s[88:91], s101 offen sc1
v_mfma_f32_16x16x32_bf16 v[112:115], v[204:207], a[108:111], v[112:115]
ds_read_b64_tr_b16 v[172:173], v6 offset:25344
ds_read_b64_tr_b16 v[174:175], v6 offset:29440
v_mfma_f32_16x16x32_bf16 v[112:115], v[200:203], a[100:103], v[112:115]
buffer_load_dwordx4 a[84:87], v3, s[88:91], s101 offen offset:1024 sc1
v_mfma_f32_16x16x32_bf16 v[116:119], v[208:211], a[100:103], v[116:119]
ds_read_b64_tr_b16 v[176:177], v7 offset:17152
ds_read_b64_tr_b16 v[178:179], v7 offset:21248
s_add_u32 s101, s101, 0x2000
v_mfma_f32_16x16x32_bf16 v[116:119], v[212:215], a[108:111], v[116:119]
buffer_load_dwordx4 a[88:91], v3, s[88:91], s101 offen sc1
s_waitcnt vmcnt(7) lgkmcnt(6)
v_mfma_f32_16x16x32_bf16 v[100:103], v[212:215], a[104:107], v[100:103]
ds_read_b64_tr_b16 v[180:181], v7 offset:25344
ds_read_b64_tr_b16 v[182:183], v7 offset:29440
s_barrier
v_mfma_f32_16x16x32_bf16 v[100:103], v[208:211], a[96:99], v[100:103]
buffer_load_dwordx4 a[92:95], v3, s[88:91], s101 offen offset:1024 sc1
v_mfma_f32_16x16x32_bf16 v[120:123], v[152:155], a[112:115], v[120:123]
ds_read_b64_tr_b16 v[184:185], v4 offset:512
v_sub_f32 v10, 1.0, v8
v_mfma_f32_16x16x32_bf16 v[120:123], v[156:159], a[120:123], v[120:123]
ds_read_b64_tr_b16 v[186:187], v4 offset:4608
v_sub_f32 v11, 1.0, v9
v_mfma_f32_16x16x32_bf16 v[136:139], v[156:159], a[124:127], v[136:139]
ds_read_b64_tr_b16 v[188:189], v4 offset:8704
v_mul_f32 v56, v10, v56
v_mfma_f32_16x16x32_bf16 v[136:139], v[152:155], a[116:119], v[136:139]
ds_read_b64_tr_b16 v[190:191], v4 offset:12800
v_mul_f32 v57, v10, v57
v_mfma_f32_16x16x32_bf16 v[140:143], v[160:163], a[116:119], v[140:143]
ds_read_b64_tr_b16 v[192:193], v5 offset:512
v_mul_f32 v58, v10, v58
v_mfma_f32_16x16x32_bf16 v[140:143], v[164:167], a[124:127], v[140:143]
ds_read_b64_tr_b16 v[194:195], v5 offset:4608
v_mul_f32 v59, v10, v59
v_mfma_f32_16x16x32_bf16 v[124:127], v[164:167], a[120:123], v[124:127]
ds_read_b64_tr_b16 v[196:197], v5 offset:8704
s_waitcnt lgkmcnt(7)
v_mfma_f32_16x16x32_bf16 v[124:127], v[160:163], a[112:115], v[124:127]
ds_read_b64_tr_b16 v[198:199], v5 offset:12800
v_mul_f32 v60, v10, v60
v_mfma_f32_16x16x32_bf16 v[128:131], v[168:171], a[112:115], v[128:131]
ds_read_b64_tr_b16 v[200:201], v4 offset:768
v_mul_f32 v61, v10, v61
v_mfma_f32_16x16x32_bf16 v[128:131], v[172:175], a[120:123], v[128:131]
ds_read_b64_tr_b16 v[202:203], v4 offset:4864
v_mul_f32 v62, v10, v62
v_mfma_f32_16x16x32_bf16 v[144:147], v[172:175], a[124:127], v[144:147]
ds_read_b64_tr_b16 v[204:205], v4 offset:8960
v_mul_f32 v63, v10, v63
v_mfma_f32_16x16x32_bf16 v[144:147], v[168:171], a[116:119], v[144:147]
ds_read_b64_tr_b16 v[206:207], v4 offset:13056
v_mul_f32 v64, v10, v64
v_mfma_f32_16x16x32_bf16 v[148:151], v[176:179], a[116:119], v[148:151]
ds_read_b64_tr_b16 v[208:209], v5 offset:768
v_mul_f32 v65, v10, v65
v_mfma_f32_16x16x32_bf16 v[148:151], v[180:183], a[124:127], v[148:151]
ds_read_b64_tr_b16 v[210:211], v5 offset:4864
s_waitcnt vmcnt(0) lgkmcnt(6)
v_mfma_f32_16x16x32_bf16 v[132:135], v[180:183], a[120:123], v[132:135]
ds_read_b64_tr_b16 v[212:213], v5 offset:8960
s_barrier
v_mfma_f32_16x16x32_bf16 v[132:135], v[176:179], a[112:115], v[132:135]
ds_read_b64_tr_b16 v[214:215], v5 offset:13056
v_mul_f32 v66, v10, v66
v_mul_f32 v67, v10, v67
v_mfma_f32_16x16x32_bf16 v[120:123], v[184:187], a[64:67], v[120:123]
ds_read_b64_tr_b16 v[152:153], v4 offset:16896
v_mul_f32 v68, v10, v68
v_mfma_f32_16x16x32_bf16 v[120:123], v[188:191], a[72:75], v[120:123]
ds_read_b64_tr_b16 v[154:155], v4 offset:20992
v_mul_f32 v69, v10, v69
v_mfma_f32_16x16x32_bf16 v[136:139], v[188:191], a[76:79], v[136:139]
ds_read_b64_tr_b16 v[156:157], v4 offset:25088
v_mul_f32 v70, v10, v70
v_mfma_f32_16x16x32_bf16 v[136:139], v[184:187], a[68:71], v[136:139]
ds_read_b64_tr_b16 v[158:159], v4 offset:29184
v_mul_f32 v71, v10, v71
v_mfma_f32_16x16x32_bf16 v[140:143], v[192:195], a[68:71], v[140:143]
ds_read_b64_tr_b16 v[160:161], v5 offset:16896
v_mul_f32 v72, v11, v72
v_mfma_f32_16x16x32_bf16 v[140:143], v[196:199], a[76:79], v[140:143]
ds_read_b64_tr_b16 v[162:163], v5 offset:20992
v_mul_f32 v73, v11, v73
v_mfma_f32_16x16x32_bf16 v[124:127], v[196:199], a[72:75], v[124:127]
ds_read_b64_tr_b16 v[164:165], v5 offset:25088
s_waitcnt lgkmcnt(7)
v_mfma_f32_16x16x32_bf16 v[124:127], v[192:195], a[64:67], v[124:127]
ds_read_b64_tr_b16 v[166:167], v5 offset:29184
v_mul_f32 v74, v11, v74
v_mfma_f32_16x16x32_bf16 v[128:131], v[200:203], a[64:67], v[128:131]
ds_read_b64_tr_b16 v[168:169], v4 offset:17152
v_mul_f32 v75, v11, v75
v_mfma_f32_16x16x32_bf16 v[128:131], v[204:207], a[72:75], v[128:131]
ds_read_b64_tr_b16 v[170:171], v4 offset:21248
v_mul_f32 v76, v11, v76
v_mfma_f32_16x16x32_bf16 v[144:147], v[204:207], a[76:79], v[144:147]
ds_read_b64_tr_b16 v[172:173], v4 offset:25344
v_mul_f32 v77, v11, v77
v_mfma_f32_16x16x32_bf16 v[144:147], v[200:203], a[68:71], v[144:147]
ds_read_b64_tr_b16 v[174:175], v4 offset:29440
v_mul_f32 v78, v11, v78
v_mfma_f32_16x16x32_bf16 v[148:151], v[208:211], a[68:71], v[148:151]
ds_read_b64_tr_b16 v[176:177], v5 offset:17152
v_mul_f32 v79, v11, v79
v_mfma_f32_16x16x32_bf16 v[148:151], v[212:215], a[76:79], v[148:151]
ds_read_b64_tr_b16 v[178:179], v5 offset:21248
s_waitcnt lgkmcnt(6)
v_mfma_f32_16x16x32_bf16 v[132:135], v[212:215], a[72:75], v[132:135]
ds_read_b64_tr_b16 v[180:181], v5 offset:25344
v_mul_f32 v80, v11, v80
v_mfma_f32_16x16x32_bf16 v[132:135], v[208:211], a[64:67], v[132:135]
ds_read_b64_tr_b16 v[182:183], v5 offset:29440
v_mul_f32 v81, v11, v81
v_mfma_f32_16x16x32_bf16 v[120:123], v[152:155], a[80:83], v[120:123]
ds_read_b64_tr_b16 v[184:185], v6 offset:16384
v_mul_f32 v82, v11, v82
v_mfma_f32_16x16x32_bf16 v[120:123], v[156:159], a[88:91], v[120:123]
ds_read_b64_tr_b16 v[186:187], v6 offset:20480
v_mul_f32 v83, v11, v83
v_mfma_f32_16x16x32_bf16 v[136:139], v[156:159], a[92:95], v[136:139]
ds_read_b64_tr_b16 v[188:189], v6 offset:24576
v_mul_f32 v84, v11, v84
v_mfma_f32_16x16x32_bf16 v[136:139], v[152:155], a[84:87], v[136:139]
ds_read_b64_tr_b16 v[190:191], v6 offset:28672
v_mul_f32 v85, v11, v85
v_mfma_f32_16x16x32_bf16 v[140:143], v[160:163], a[84:87], v[140:143]
ds_read_b64_tr_b16 v[192:193], v7 offset:16384
v_mul_f32 v86, v11, v86
v_mfma_f32_16x16x32_bf16 v[140:143], v[164:167], a[92:95], v[140:143]
ds_read_b64_tr_b16 v[194:195], v7 offset:20480
v_mul_f32 v87, v11, v87
v_mfma_f32_16x16x32_bf16 v[124:127], v[164:167], a[88:91], v[124:127]
ds_read_b64_tr_b16 v[196:197], v7 offset:24576
s_waitcnt lgkmcnt(7)
v_mfma_f32_16x16x32_bf16 v[124:127], v[160:163], a[80:83], v[124:127]
ds_read_b64_tr_b16 v[198:199], v7 offset:28672
v_mul_f32 v24, v10, v24
v_mfma_f32_16x16x32_bf16 v[128:131], v[168:171], a[80:83], v[128:131]
ds_read_b64_tr_b16 v[200:201], v6 offset:16640
v_mul_f32 v25, v10, v25
v_mfma_f32_16x16x32_bf16 v[128:131], v[172:175], a[88:91], v[128:131]
ds_read_b64_tr_b16 v[202:203], v6 offset:20736
v_mul_f32 v26, v10, v26
v_mfma_f32_16x16x32_bf16 v[144:147], v[172:175], a[92:95], v[144:147]
ds_read_b64_tr_b16 v[204:205], v6 offset:24832
v_mul_f32 v27, v10, v27
v_mfma_f32_16x16x32_bf16 v[144:147], v[168:171], a[84:87], v[144:147]
ds_read_b64_tr_b16 v[206:207], v6 offset:28928
v_mul_f32 v28, v10, v28
v_mfma_f32_16x16x32_bf16 v[148:151], v[176:179], a[84:87], v[148:151]
ds_read_b64_tr_b16 v[208:209], v7 offset:16640
v_mul_f32 v29, v10, v29
v_mfma_f32_16x16x32_bf16 v[148:151], v[180:183], a[92:95], v[148:151]
ds_read_b64_tr_b16 v[210:211], v7 offset:20736
s_waitcnt lgkmcnt(6)
v_mfma_f32_16x16x32_bf16 v[132:135], v[180:183], a[88:91], v[132:135]
ds_read_b64_tr_b16 v[212:213], v7 offset:24832
v_mul_f32 v30, v10, v30
v_mfma_f32_16x16x32_bf16 v[132:135], v[176:179], a[80:83], v[132:135]
ds_read_b64_tr_b16 v[214:215], v7 offset:28928
v_mul_f32 v31, v10, v31
v_pk_fma_f32 v[56:57], v[120:121], v[8:9], v[56:57] op_sel_hi:[1,0,1]
v_pk_fma_f32 v[58:59], v[122:123], v[8:9], v[58:59] op_sel_hi:[1,0,1]
v_pk_fma_f32 v[60:61], v[124:125], v[8:9], v[60:61] op_sel_hi:[1,0,1]
v_pk_fma_f32 v[62:63], v[126:127], v[8:9], v[62:63] op_sel_hi:[1,0,1]
v_cvt_pk_bf16_f32 v56, v56, v57
v_cvt_pk_bf16_f32 v57, v58, v59
v_cvt_pk_bf16_f32 v58, v60, v61
v_cvt_pk_bf16_f32 v59, v62, v63
buffer_store_dwordx4 v[56:59], v3, s[88:91], s30 offen offset:0 sc1
v_pk_fma_f32 v[72:73], v[136:137], v[8:9], v[72:73] op_sel:[0,1,0] op_sel_hi:[1,1,1]
v_pk_fma_f32 v[74:75], v[138:139], v[8:9], v[74:75] op_sel:[0,1,0] op_sel_hi:[1,1,1]
v_pk_fma_f32 v[76:77], v[140:141], v[8:9], v[76:77] op_sel:[0,1,0] op_sel_hi:[1,1,1]
v_pk_fma_f32 v[78:79], v[142:143], v[8:9], v[78:79] op_sel:[0,1,0] op_sel_hi:[1,1,1]
v_cvt_pk_bf16_f32 v72, v72, v73
v_cvt_pk_bf16_f32 v73, v74, v75
v_cvt_pk_bf16_f32 v74, v76, v77
v_cvt_pk_bf16_f32 v75, v78, v79
buffer_store_dwordx4 v[72:75], v3, s[88:91], s30 offen offset:2048 sc1
v_pk_fma_f32 v[64:65], v[128:129], v[8:9], v[64:65] op_sel_hi:[1,0,1]
v_pk_fma_f32 v[66:67], v[130:131], v[8:9], v[66:67] op_sel_hi:[1,0,1]
v_pk_fma_f32 v[68:69], v[132:133], v[8:9], v[68:69] op_sel_hi:[1,0,1]
v_pk_fma_f32 v[70:71], v[134:135], v[8:9], v[70:71] op_sel_hi:[1,0,1]
v_cvt_pk_bf16_f32 v64, v64, v65
v_cvt_pk_bf16_f32 v65, v66, v67
v_cvt_pk_bf16_f32 v66, v68, v69
v_cvt_pk_bf16_f32 v67, v70, v71
buffer_store_dwordx4 v[64:67], v3, s[88:91], s30 offen offset:1024 sc1
v_pk_fma_f32 v[80:81], v[144:145], v[8:9], v[80:81] op_sel:[0,1,0] op_sel_hi:[1,1,1]
v_pk_fma_f32 v[82:83], v[146:147], v[8:9], v[82:83] op_sel:[0,1,0] op_sel_hi:[1,1,1]
v_pk_fma_f32 v[84:85], v[148:149], v[8:9], v[84:85] op_sel:[0,1,0] op_sel_hi:[1,1,1]
v_pk_fma_f32 v[86:87], v[150:151], v[8:9], v[86:87] op_sel:[0,1,0] op_sel_hi:[1,1,1]
v_cvt_pk_bf16_f32 v80, v80, v81
v_cvt_pk_bf16_f32 v81, v82, v83
v_cvt_pk_bf16_f32 v82, v84, v85
v_cvt_pk_bf16_f32 v83, v86, v87
buffer_store_dwordx4 v[80:83], v3, s[88:91], s30 offen offset:3072 sc1
v_mfma_f32_16x16x32_bf16 v[88:91], v[184:187], a[112:115], v[88:91]
ds_read_b64_tr_b16 v[152:153], v4 offset:0
v_mfma_f32_16x16x32_bf16 v[88:91], v[188:191], a[120:123], v[88:91]
ds_read_b64_tr_b16 v[154:155], v4 offset:4096
v_mfma_f32_16x16x32_bf16 v[104:107], v[188:191], a[124:127], v[104:107]
ds_read_b64_tr_b16 v[156:157], v4 offset:8192
v_mfma_f32_16x16x32_bf16 v[104:107], v[184:187], a[116:119], v[104:107]
ds_read_b64_tr_b16 v[158:159], v4 offset:12288
v_mfma_f32_16x16x32_bf16 v[108:111], v[192:195], a[116:119], v[108:111]
ds_read_b64_tr_b16 v[160:161], v5 offset:0
v_mfma_f32_16x16x32_bf16 v[108:111], v[196:199], a[124:127], v[108:111]
ds_read_b64_tr_b16 v[162:163], v5 offset:4096
v_mfma_f32_16x16x32_bf16 v[92:95], v[196:199], a[120:123], v[92:95]
ds_read_b64_tr_b16 v[164:165], v5 offset:8192
s_waitcnt lgkmcnt(7)
v_mfma_f32_16x16x32_bf16 v[92:95], v[192:195], a[112:115], v[92:95]
ds_read_b64_tr_b16 v[166:167], v5 offset:12288
v_mfma_f32_16x16x32_bf16 v[96:99], v[200:203], a[112:115], v[96:99]
ds_read_b64_tr_b16 v[168:169], v4 offset:256
v_mfma_f32_16x16x32_bf16 v[96:99], v[204:207], a[120:123], v[96:99]
ds_read_b64_tr_b16 v[170:171], v4 offset:4352
v_mfma_f32_16x16x32_bf16 v[112:115], v[204:207], a[124:127], v[112:115]
ds_read_b64_tr_b16 v[172:173], v4 offset:8448
v_mfma_f32_16x16x32_bf16 v[112:115], v[200:203], a[116:119], v[112:115]
ds_read_b64_tr_b16 v[174:175], v4 offset:12544
v_mfma_f32_16x16x32_bf16 v[116:119], v[208:211], a[116:119], v[116:119]
ds_read_b64_tr_b16 v[176:177], v5 offset:256
v_mfma_f32_16x16x32_bf16 v[116:119], v[212:215], a[124:127], v[116:119]
ds_read_b64_tr_b16 v[178:179], v5 offset:4352
s_waitcnt lgkmcnt(6)
v_mfma_f32_16x16x32_bf16 v[100:103], v[212:215], a[120:123], v[100:103]
ds_read_b64_tr_b16 v[180:181], v5 offset:8448
v_mfma_f32_16x16x32_bf16 v[100:103], v[208:211], a[112:115], v[100:103]
ds_read_b64_tr_b16 v[182:183], v5 offset:12544
v_mfma_f32_16x16x32_bf16 v[88:91], v[152:155], a[64:67], v[88:91]
ds_read_b64_tr_b16 v[184:185], v4 offset:16384
v_mul_f32 v32, v10, v32
v_mfma_f32_16x16x32_bf16 v[88:91], v[156:159], a[72:75], v[88:91]
ds_read_b64_tr_b16 v[186:187], v4 offset:20480
v_mul_f32 v33, v10, v33
v_mfma_f32_16x16x32_bf16 v[104:107], v[156:159], a[76:79], v[104:107]
ds_read_b64_tr_b16 v[188:189], v4 offset:24576
v_mul_f32 v34, v10, v34
v_mfma_f32_16x16x32_bf16 v[104:107], v[152:155], a[68:71], v[104:107]
ds_read_b64_tr_b16 v[190:191], v4 offset:28672
v_mul_f32 v35, v10, v35
v_mfma_f32_16x16x32_bf16 v[108:111], v[160:163], a[68:71], v[108:111]
ds_read_b64_tr_b16 v[192:193], v5 offset:16384
v_mul_f32 v36, v10, v36
v_mfma_f32_16x16x32_bf16 v[108:111], v[164:167], a[76:79], v[108:111]
ds_read_b64_tr_b16 v[194:195], v5 offset:20480
v_mul_f32 v37, v10, v37
v_mfma_f32_16x16x32_bf16 v[92:95], v[164:167], a[72:75], v[92:95]
ds_read_b64_tr_b16 v[196:197], v5 offset:24576
s_waitcnt lgkmcnt(7)
v_mfma_f32_16x16x32_bf16 v[92:95], v[160:163], a[64:67], v[92:95]
ds_read_b64_tr_b16 v[198:199], v5 offset:28672
v_mul_f32 v38, v10, v38
v_mfma_f32_16x16x32_bf16 v[96:99], v[168:171], a[64:67], v[96:99]
ds_read_b64_tr_b16 v[200:201], v4 offset:16640
v_mul_f32 v39, v10, v39
v_mfma_f32_16x16x32_bf16 v[96:99], v[172:175], a[72:75], v[96:99]
ds_read_b64_tr_b16 v[202:203], v4 offset:20736
v_mul_f32 v40, v11, v40
v_mfma_f32_16x16x32_bf16 v[112:115], v[172:175], a[76:79], v[112:115]
ds_read_b64_tr_b16 v[204:205], v4 offset:24832
v_mul_f32 v41, v11, v41
v_mfma_f32_16x16x32_bf16 v[112:115], v[168:171], a[68:71], v[112:115]
ds_read_b64_tr_b16 v[206:207], v4 offset:28928
v_mul_f32 v42, v11, v42
v_mfma_f32_16x16x32_bf16 v[116:119], v[176:179], a[68:71], v[116:119]
ds_read_b64_tr_b16 v[208:209], v5 offset:16640
v_mul_f32 v43, v11, v43
v_mfma_f32_16x16x32_bf16 v[116:119], v[180:183], a[76:79], v[116:119]
ds_read_b64_tr_b16 v[210:211], v5 offset:20736
s_waitcnt lgkmcnt(6)
v_mfma_f32_16x16x32_bf16 v[100:103], v[180:183], a[72:75], v[100:103]
ds_read_b64_tr_b16 v[212:213], v5 offset:24832
v_mul_f32 v44, v11, v44
v_mfma_f32_16x16x32_bf16 v[100:103], v[176:179], a[64:67], v[100:103]
ds_read_b64_tr_b16 v[214:215], v5 offset:28928
v_mul_f32 v45, v11, v45
v_mfma_f32_16x16x32_bf16 v[88:91], v[184:187], a[80:83], v[88:91]
v_mul_f32 v46, v11, v46
v_mul_f32 v47, v11, v47
v_mfma_f32_16x16x32_bf16 v[88:91], v[188:191], a[88:91], v[88:91]
v_mul_f32 v48, v11, v48
v_mul_f32 v49, v11, v49
v_mfma_f32_16x16x32_bf16 v[104:107], v[188:191], a[92:95], v[104:107]
v_mul_f32 v50, v11, v50
v_mul_f32 v51, v11, v51
v_mfma_f32_16x16x32_bf16 v[104:107], v[184:187], a[84:87], v[104:107]
v_mul_f32 v52, v11, v52
v_mul_f32 v53, v11, v53
v_mfma_f32_16x16x32_bf16 v[108:111], v[192:195], a[84:87], v[108:111]
v_mul_f32 v54, v11, v54
v_mul_f32 v55, v11, v55
v_mfma_f32_16x16x32_bf16 v[108:111], v[196:199], a[92:95], v[108:111]
v_mfma_f32_16x16x32_bf16 v[92:95], v[196:199], a[88:91], v[92:95]
s_waitcnt lgkmcnt(0)
v_mfma_f32_16x16x32_bf16 v[92:95], v[192:195], a[80:83], v[92:95]
v_mfma_f32_16x16x32_bf16 v[96:99], v[200:203], a[80:83], v[96:99]
v_mfma_f32_16x16x32_bf16 v[96:99], v[204:207], a[88:91], v[96:99]
v_mfma_f32_16x16x32_bf16 v[112:115], v[204:207], a[92:95], v[112:115]
v_mfma_f32_16x16x32_bf16 v[112:115], v[200:203], a[84:87], v[112:115]
v_mfma_f32_16x16x32_bf16 v[116:119], v[208:211], a[84:87], v[116:119]
v_mfma_f32_16x16x32_bf16 v[116:119], v[212:215], a[92:95], v[116:119]
v_mfma_f32_16x16x32_bf16 v[100:103], v[212:215], a[88:91], v[100:103]
v_mfma_f32_16x16x32_bf16 v[100:103], v[208:211], a[80:83], v[100:103]
buffer_load_dwordx4 v[152:155], v3, s[88:91], s28 offen offset:0 sc1
buffer_load_dwordx4 v[156:159], v3, s[88:91], s28 offen offset:1024 sc1
buffer_load_dwordx4 v[160:163], v3, s[88:91], s28 offen offset:2048 sc1
buffer_load_dwordx4 v[164:167], v3, s[88:91], s28 offen offset:3072 sc1
v_fmac_f32 v24, v8, v88
v_fmac_f32 v25, v8, v89
v_fmac_f32 v26, v8, v90
v_fmac_f32 v27, v8, v91
v_fmac_f32 v28, v8, v92
v_fmac_f32 v29, v8, v93
v_fmac_f32 v30, v8, v94
v_fmac_f32 v31, v8, v95
v_fmac_f32 v32, v8, v96
v_fmac_f32 v33, v8, v97
v_fmac_f32 v34, v8, v98
v_fmac_f32 v35, v8, v99
v_fmac_f32 v36, v8, v100
v_fmac_f32 v37, v8, v101
v_fmac_f32 v38, v8, v102
v_fmac_f32 v39, v8, v103
v_fmac_f32 v40, v9, v104
v_fmac_f32 v41, v9, v105
v_fmac_f32 v42, v9, v106
v_fmac_f32 v43, v9, v107
v_fmac_f32 v44, v9, v108
v_fmac_f32 v45, v9, v109
v_fmac_f32 v46, v9, v110
v_fmac_f32 v47, v9, v111
v_fmac_f32 v48, v9, v112
v_fmac_f32 v49, v9, v113
v_fmac_f32 v50, v9, v114
v_fmac_f32 v51, v9, v115
v_fmac_f32 v52, v9, v116
v_fmac_f32 v53, v9, v117
v_fmac_f32 v54, v9, v118
v_fmac_f32 v55, v9, v119
s_mov_b32 s92, 200000
L_spin_x:
s_waitcnt vmcnt(0)
v_max3_u32 v168, v152, v153, 0
v_max3_u32 v168, v154, v155, v168
v_max3_u32 v168, v156, v157, v168
v_max3_u32 v168, v158, v159, v168
v_max3_u32 v168, v160, v161, v168
v_max3_u32 v168, v162, v163, v168
v_max3_u32 v168, v164, v165, v168
v_max3_u32 v168, v166, v167, v168
v_cmp_eq_u32 vcc, -1, v168
s_sub_u32 s92, s92, 1
s_cbranch_scc1 L_spun_x
s_nop 3
s_cbranch_vccz L_spun_x
s_sleep 2
buffer_load_dwordx4 v[152:155], v3, s[88:91], s28 offen offset:0 sc1
buffer_load_dwordx4 v[156:159], v3, s[88:91], s28 offen offset:1024 sc1
buffer_load_dwordx4 v[160:163], v3, s[88:91], s28 offen offset:2048 sc1
buffer_load_dwordx4 v[164:167], v3, s[88:91], s28 offen offset:3072 sc1
s_branch L_spin_x
L_spun_x:
v_lshlrev_b32 v168, 16, v152
v_and_b32 v169, 0xffff0000, v152
v_pk_add_f32 v[24:25], v[24:25], v[168:169]
v_lshlrev_b32 v168, 16, v153
v_and_b32 v169, 0xffff0000, v153
v_pk_add_f32 v[26:27], v[26:27], v[168:169]
v_lshlrev_b32 v168, 16, v154
v_and_b32 v169, 0xffff0000, v154
v_pk_add_f32 v[28:29], v[28:29], v[168:169]
v_lshlrev_b32 v168, 16, v155
v_and_b32 v169, 0xffff0000, v155
v_pk_add_f32 v[30:31], v[30:31], v[168:169]
v_cvt_pk_bf16_f32 v24, v24, v25
v_cvt_pk_bf16_f32 v25, v26, v27
v_cvt_pk_bf16_f32 v26, v28, v29
v_cvt_pk_bf16_f32 v27, v30, v31
s_nop 1
v_permlane16_swap_b32 v24, v26
v_permlane16_swap_b32 v25, v27
buffer_store_dwordx4 v[24:27], v17, s[80:83], s29 offen offset:0 sc1
v_lshlrev_b32 v168, 16, v156
v_and_b32 v169, 0xffff0000, v156
v_pk_add_f32 v[32:33], v[32:33], v[168:169]
v_lshlrev_b32 v168, 16, v157
v_and_b32 v169, 0xffff0000, v157
v_pk_add_f32 v[34:35], v[34:35], v[168:169]
v_lshlrev_b32 v168, 16, v158
v_and_b32 v169, 0xffff0000, v158
v_pk_add_f32 v[36:37], v[36:37], v[168:169]
v_lshlrev_b32 v168, 16, v159
v_and_b32 v169, 0xffff0000, v159
v_pk_add_f32 v[38:39], v[38:39], v[168:169]
v_cvt_pk_bf16_f32 v32, v32, v33
v_cvt_pk_bf16_f32 v33, v34, v35
v_cvt_pk_bf16_f32 v34, v36, v37
v_cvt_pk_bf16_f32 v35, v38, v39
s_nop 1
v_permlane16_swap_b32 v32, v34
v_permlane16_swap_b32 v33, v35
buffer_store_dwordx4 v[32:35], v17, s[80:83], s29 offen offset:64 sc1
v_lshlrev_b32 v168, 16, v160
v_and_b32 v169, 0xffff0000, v160
v_pk_add_f32 v[40:41], v[40:41], v[168:169]
v_lshlrev_b32 v168, 16, v161
v_and_b32 v169, 0xffff0000, v161
v_pk_add_f32 v[42:43], v[42:43], v[168:169]
v_lshlrev_b32 v168, 16, v162
v_and_b32 v169, 0xffff0000, v162
v_pk_add_f32 v[44:45], v[44:45], v[168:169]
v_lshlrev_b32 v168, 16, v163
v_and_b32 v169, 0xffff0000, v163
v_pk_add_f32 v[46:47], v[46:47], v[168:169]
v_cvt_pk_bf16_f32 v40, v40, v41
v_cvt_pk_bf16_f32 v41, v42, v43
v_cvt_pk_bf16_f32 v42, v44, v45
v_cvt_pk_bf16_f32 v43, v46, v47
s_nop 1
v_permlane16_swap_b32 v40, v42
v_permlane16_swap_b32 v41, v43
buffer_store_dwordx4 v[40:43], v17, s[80:83], s31 offen offset:0 sc1
v_lshlrev_b32 v168, 16, v164
v_and_b32 v169, 0xffff0000, v164
v_pk_add_f32 v[48:49], v[48:49], v[168:169]
v_lshlrev_b32 v168, 16, v165
v_and_b32 v169, 0xffff0000, v165
v_pk_add_f32 v[50:51], v[50:51], v[168:169]
v_lshlrev_b32 v168, 16, v166
v_and_b32 v169, 0xffff0000, v166
v_pk_add_f32 v[52:53], v[52:53], v[168:169]
v_lshlrev_b32 v168, 16, v167
v_and_b32 v169, 0xffff0000, v167
v_pk_add_f32 v[54:55], v[54:55], v[168:169]
v_cvt_pk_bf16_f32 v48, v48, v49
v_cvt_pk_bf16_f32 v49, v50, v51
v_cvt_pk_bf16_f32 v50, v52, v53
v_cvt_pk_bf16_f32 v51, v54, v55
s_nop 1
v_permlane16_swap_b32 v48, v50
v_permlane16_swap_b32 v49, v51
buffer_store_dwordx4 v[48:51], v17, s[80:83], s31 offen offset:64 sc1
L_end:
s_endpgm
L_att_fallback:
s_waitcnt vmcnt(0)
s_mov_b32 s33, 1
s_mul_i32 s32, s5, 0x10c400
s_lshl_b32 s19, s4, 13
s_add_u32 s32, s32, s19
s_cmp_eq_u32 s4, 0
s_cselect_b32 s94, 0x200000, 0
s_add_u32 s32, s32, s94
s_sub_u32 s94, 0x8000, s94
s_add_u32 s7, s32, 0x1000
s_add_u32 s27, s19, 131072
v_and_b32 v5, 15, v0
v_lshrrev_b32 v6, 4, v0
v_lshlrev_b32 v6, 2, v6
v_sub_u32 v5, v5, v6
v_mov_b32 v9, 0xf149f2ca
s_lshr_b32 s8, s20, 11
v_add_u32 v96, s8, v5
v_mov_b32 v80, v9
s_lshr_b32 s8, s21, 11
v_add_u32 v97, s8, v5
v_mov_b32 v84, v9
s_lshr_b32 s8, s22, 11
v_add_u32 v98, s8, v5
v_mov_b32 v88, v9
s_lshr_b32 s8, s23, 11
v_add_u32 v99, s8, v5
v_mov_b32 v92, v9
s_sub_u32 s15, 16, s6
s_lshl_b32 s15, s15, 1
L_fb_loop:
s_waitcnt lgkmcnt(0)
s_barrier
s_add_u32 m0, s19, 0x0
s_nop 0
buffer_load_dwordx4 v3, s[48:51], s32 offen offset:0 sc1 lds
buffer_load_dwordx4 v3, s[48:51], s32 offen offset:1024 sc1 lds
buffer_load_dwordx4 v3, s[48:51], s32 offen offset:2048 sc1 lds
buffer_load_dwordx4 v3, s[48:51], s32 offen offset:3072 sc1 lds
s_add_u32 m0, s19, 0x1000
s_nop 0
buffer_load_dwordx4 v3, s[48:51], s7 offen offset:0 sc1 lds
buffer_load_dwordx4 v3, s[48:51], s7 offen offset:1024 sc1 lds
buffer_load_dwordx4 v3, s[48:51], s7 offen offset:2048 sc1 lds
buffer_load_dwordx4 v3, s[48:51], s7 offen offset:3072 sc1 lds
s_add_u32 s32, s32, s94
s_add_u32 s7, s7, s94
s_mov_b32 s94, 0x8000
s_waitcnt vmcnt(0)
s_barrier
ds_read_b128 a[0:3], v3 offset:8192
ds_read_b128 a[4:7], v3 offset:9216
ds_read_b128 a[8:11], v3 offset:10240
ds_read_b128 a[12:15], v3 offset:11264
ds_read_b128 a[16:19], v3 offset:12288
ds_read_b128 a[20:23], v3 offset:13312
ds_read_b128 a[24:27], v3 offset:14336
ds_read_b128 a[28:31], v3 offset:15360
s_waitcnt lgkmcnt(0)
v_mfma_f32_16x16x32_bf16 v[16:19], a[0:3], a[160:163], 0
v_mfma_f32_16x16x32_bf16 v[16:19], a[4:7], a[164:167], v[16:19]
v_mfma_f32_16x16x32_bf16 v[16:19], a[8:11], a[168:171], v[16:19]
v_mfma_f32_16x16x32_bf16 v[16:19], a[12:15], a[172:175], v[16:19]
v_mfma_f32_16x16x32_bf16 v[20:23], a[0:3], a[176:179], 0
v_mfma_f32_16x16x32_bf16 v[20:23], a[4:7], a[180:183], v[20:23]
v_mfma_f32_16x16x32_bf16 v[20:23], a[8:11], a[184:187], v[20:23]
v_mfma_f32_16x16x32_bf16 v[20:23], a[12:15], a[188:191], v[20:23]
v_mfma_f32_16x16x32_bf16 v[24:27], a[0:3], a[192:195], 0
v_mfma_f32_16x16x32_bf16 v[24:27], a[4:7], a[196:199], v[24:27]
v_mfma_f32_16x16x32_bf16 v[24:27], a[8:11], a[200:203], v[24:27]
v_mfma_f32_16x16x32_bf16 v[24:27], a[12:15], a[204:207], v[24:27]
v_mfma_f32_16x16x32_bf16 v[28:31], a[0:3], a[208:211], 0
v_mfma_f32_16x16x32_bf16 v[28:31], a[4:7], a[212:215], v[28:31]
v_mfma_f32_16x16x32_bf16 v[28:31], a[8:11], a[216:219], v[28:31]
v_mfma_f32_16x16x32_bf16 v[28:31], a[12:15], a[220:223], v[28:31]
v_mfma_f32_16x16x32_bf16 v[32:35], a[16:19], a[160:163], 0
v_mfma_f32_16x16x32_bf16 v[32:35], a[20:23], a[164:167], v[32:35]
v_mfma_f32_16x16x32_bf16 v[32:35], a[24:27], a[168:171], v[32:35]
v_mfma_f32_16x16x32_bf16 v[32:35], a[28:31], a[172:175], v[32:35]
v_mfma_f32_16x16x32_bf16 v[36:39], a[16:19], a[176:179], 0
v_mfma_f32_16x16x32_bf16 v[36:39], a[20:23], a[180:183], v[36:39]
v_mfma_f32_16x16x32_bf16 v[36:39], a[24:27], a[184:187], v[36:39]
v_mfma_f32_16x16x32_bf16 v[36:39], a[28:31], a[188:191], v[36:39]
v_mfma_f32_16x16x32_bf16 v[40:43], a[16:19], a[192:195], 0
v_mfma_f32_16x16x32_bf16 v[40:43], a[20:23], a[196:199], v[40:43]
v_mfma_f32_16x16x32_bf16 v[40:43], a[24:27], a[200:203], v[40:43]
v_mfma_f32_16x16x32_bf16 v[40:43], a[28:31], a[204:207], v[40:43]
v_mfma_f32_16x16x32_bf16 v[44:47], a[16:19], a[208:211], 0
v_mfma_f32_16x16x32_bf16 v[44:47], a[20:23], a[212:215], v[44:47]
v_mfma_f32_16x16x32_bf16 v[44:47], a[24:27], a[216:219], v[44:47]
v_mfma_f32_16x16x32_bf16 v[44:47], a[28:31], a[220:223], v[44:47]
s_nop 7
v_cmp_le_i32 s[36:37], 0, v96
v_cmp_le_i32 s[38:39], 1, v96
v_cmp_le_i32 s[40:41], 2, v96
v_cmp_le_i32 s[42:43], 3, v96
s_nop 1
v_cndmask_b32 v16, v9, v16, s[36:37]
v_cndmask_b32 v17, v9, v17, s[38:39]
v_cndmask_b32 v18, v9, v18, s[40:41]
v_cndmask_b32 v19, v9, v19, s[42:43]
v_max3_f32 v80, v80, v16, v17
v_max3_f32 v80, v80, v18, v19
v_cmp_le_i32 s[36:37], 0, v97
v_cmp_le_i32 s[38:39], 1, v97
v_cmp_le_i32 s[40:41], 2, v97
v_cmp_le_i32 s[42:43], 3, v97
s_nop 1
v_cndmask_b32 v20, v9, v20, s[36:37]
v_cndmask_b32 v21, v9, v21, s[38:39]
v_cndmask_b32 v22, v9, v22, s[40:41]
v_cndmask_b32 v23, v9, v23, s[42:43]
v_max3_f32 v84, v84, v20, v21
v_max3_f32 v84, v84, v22, v23
v_cmp_le_i32 s[36:37], 0, v98
v_cmp_le_i32 s[38:39], 1, v98
v_cmp_le_i32 s[40:41], 2, v98
v_cmp_le_i32 s[42:43], 3, v98
s_nop 1
v_cndmask_b32 v24, v9, v24, s[36:37]
v_cndmask_b32 v25, v9, v25, s[38:39]
v_cndmask_b32 v26, v9, v26, s[40:41]
v_cndmask_b32 v27, v9, v27, s[42:43]
v_max3_f32 v88, v88, v24, v25
v_max3_f32 v88, v88, v26, v27
v_cmp_le_i32 s[36:37], 0, v99
v_cmp_le_i32 s[38:39], 1, v99
v_cmp_le_i32 s[40:41], 2, v99
v_cmp_le_i32 s[42:43], 3, v99
s_nop 1
v_cndmask_b32 v28, v9, v28, s[36:37]
v_cndmask_b32 v29, v9, v29, s[38:39]
v_cndmask_b32 v30, v9, v30, s[40:41]
v_cndmask_b32 v31, v9, v31, s[42:43]
v_max3_f32 v92, v92, v28, v29
v_max3_f32 v92, v92, v30, v31
v_cmp_le_i32 s[36:37], 16, v96
v_cmp_le_i32 s[38:39], 17, v96
v_cmp_le_i32 s[40:41], 18, v96
v_cmp_le_i32 s[42:43], 19, v96
s_nop 1
v_cndmask_b32 v32, v9, v32, s[36:37]
v_cndmask_b32 v33, v9, v33, s[38:39]
v_cndmask_b32 v34, v9, v34, s[40:41]
v_cndmask_b32 v35, v9, v35, s[42:43]
v_max3_f32 v80, v80, v32, v33
v_max3_f32 v80, v80, v34, v35
v_cmp_le_i32 s[36:37], 16, v97
v_cmp_le_i32 s[38:39], 17, v97
v_cmp_le_i32 s[40:41], 18, v97
v_cmp_le_i32 s[42:43], 19, v97
s_nop 1
v_cndmask_b32 v36, v9, v36, s[36:37]
v_cndmask_b32 v37, v9, v37, s[38:39]
v_cndmask_b32 v38, v9, v38, s[40:41]
v_cndmask_b32 v39, v9, v39, s[42:43]
v_max3_f32 v84, v84, v36, v37
v_max3_f32 v84, v84, v38, v39
v_cmp_le_i32 s[36:37], 16, v98
v_cmp_le_i32 s[38:39], 17, v98
v_cmp_le_i32 s[40:41], 18, v98
v_cmp_le_i32 s[42:43], 19, v98
s_nop 1
v_cndmask_b32 v40, v9, v40, s[36:37]
v_cndmask_b32 v41, v9, v41, s[38:39]
v_cndmask_b32 v42, v9, v42, s[40:41]
v_cndmask_b32 v43, v9, v43, s[42:43]
v_max3_f32 v88, v88, v40, v41
v_max3_f32 v88, v88, v42, v43
v_cmp_le_i32 s[36:37], 16, v99
v_cmp_le_i32 s[38:39], 17, v99
v_cmp_le_i32 s[40:41], 18, v99
v_cmp_le_i32 s[42:43], 19, v99
s_nop 1
v_cndmask_b32 v44, v9, v44, s[36:37]
v_cndmask_b32 v45, v9, v45, s[38:39]
v_cndmask_b32 v46, v9, v46, s[40:41]
v_cndmask_b32 v47, v9, v47, s[42:43]
v_max3_f32 v92, v92, v44, v45
v_max3_f32 v92, v92, v46, v47
ds_read_b128 a[0:3], v3 offset:24576
ds_read_b128 a[4:7], v3 offset:25600
ds_read_b128 a[8:11], v3 offset:26624
ds_read_b128 a[12:15], v3 offset:27648
ds_read_b128 a[16:19], v3 offset:28672
ds_read_b128 a[20:23], v3 offset:29696
ds_read_b128 a[24:27], v3 offset:30720
ds_read_b128 a[28:31], v3 offset:31744
s_waitcnt lgkmcnt(0)
v_mfma_f32_16x16x32_bf16 v[16:19], a[0:3], a[160:163], 0
v_mfma_f32_16x16x32_bf16 v[16:19], a[4:7], a[164:167], v[16:19]
v_mfma_f32_16x16x32_bf16 v[16:19], a[8:11], a[168:171], v[16:19]
v_mfma_f32_16x16x32_bf16 v[16:19], a[12:15], a[172:175], v[16:19]
v_mfma_f32_16x16x32_bf16 v[20:23], a[0:3], a[176:179], 0
v_mfma_f32_16x16x32_bf16 v[20:23], a[4:7], a[180:183], v[20:23]
v_mfma_f32_16x16x32_bf16 v[20:23], a[8:11], a[184:187], v[20:23]
v_mfma_f32_16x16x32_bf16 v[20:23], a[12:15], a[188:191], v[20:23]
v_mfma_f32_16x16x32_bf16 v[24:27], a[0:3], a[192:195], 0
v_mfma_f32_16x16x32_bf16 v[24:27], a[4:7], a[196:199], v[24:27]
v_mfma_f32_16x16x32_bf16 v[24:27], a[8:11], a[200:203], v[24:27]
v_mfma_f32_16x16x32_bf16 v[24:27], a[12:15], a[204:207], v[24:27]
v_mfma_f32_16x16x32_bf16 v[28:31], a[0:3], a[208:211], 0
v_mfma_f32_16x16x32_bf16 v[28:31], a[4:7], a[212:215], v[28:31]
v_mfma_f32_16x16x32_bf16 v[28:31], a[8:11], a[216:219], v[28:31]
v_mfma_f32_16x16x32_bf16 v[28:31], a[12:15], a[220:223], v[28:31]
v_mfma_f32_16x16x32_bf16 v[32:35], a[16:19], a[160:163], 0
v_mfma_f32_16x16x32_bf16 v[32:35], a[20:23], a[164:167], v[32:35]
v_mfma_f32_16x16x32_bf16 v[32:35], a[24:27], a[168:171], v[32:35]
v_mfma_f32_16x16x32_bf16 v[32:35], a[28:31], a[172:175], v[32:35]
v_mfma_f32_16x16x32_bf16 v[36:39], a[16:19], a[176:179], 0
v_mfma_f32_16x16x32_bf16 v[36:39], a[20:23], a[180:183], v[36:39]
v_mfma_f32_16x16x32_bf16 v[36:39], a[24:27], a[184:187], v[36:39]
v_mfma_f32_16x16x32_bf16 v[36:39], a[28:31], a[188:191], v[36:39]
v_mfma_f32_16x16x32_bf16 v[40:43], a[16:19], a[192:195], 0
v_mfma_f32_16x16x32_bf16 v[40:43], a[20:23], a[196:199], v[40:43]
v_mfma_f32_16x16x32_bf16 v[40:43], a[24:27], a[200:203], v[40:43]
v_mfma_f32_16x16x32_bf16 v[40:43], a[28:31], a[204:207], v[40:43]
v_mfma_f32_16x16x32_bf16 v[44:47], a[16:19], a[208:211], 0
v_mfma_f32_16x16x32_bf16 v[44:47], a[20:23], a[212:215], v[44:47]
v_mfma_f32_16x16x32_bf16 v[44:47], a[24:27], a[216:219], v[44:47]
v_mfma_f32_16x16x32_bf16 v[44:47], a[28:31], a[220:223], v[44:47]
s_nop 7
v_cmp_le_i32 s[36:37], 32, v96
v_cmp_le_i32 s[38:39], 33, v96
v_cmp_le_i32 s[40:41], 34, v96
v_cmp_le_i32 s[42:43], 35, v96
s_nop 1
v_cndmask_b32 v16, v9, v16, s[36:37]
v_cndmask_b32 v17, v9, v17, s[38:39]
v_cndmask_b32 v18, v9, v18, s[40:41]
v_cndmask_b32 v19, v9, v19, s[42:43]
v_max3_f32 v80, v80, v16, v17
v_max3_f32 v80, v80, v18, v19
v_cmp_le_i32 s[36:37], 32, v97
v_cmp_le_i32 s[38:39], 33, v97
v_cmp_le_i32 s[40:41], 34, v97
v_cmp_le_i32 s[42:43], 35, v97
s_nop 1
v_cndmask_b32 v20, v9, v20, s[36:37]
v_cndmask_b32 v21, v9, v21, s[38:39]
v_cndmask_b32 v22, v9, v22, s[40:41]
v_cndmask_b32 v23, v9, v23, s[42:43]
v_max3_f32 v84, v84, v20, v21
v_max3_f32 v84, v84, v22, v23
v_cmp_le_i32 s[36:37], 32, v98
v_cmp_le_i32 s[38:39], 33, v98
v_cmp_le_i32 s[40:41], 34, v98
v_cmp_le_i32 s[42:43], 35, v98
s_nop 1
v_cndmask_b32 v24, v9, v24, s[36:37]
v_cndmask_b32 v25, v9, v25, s[38:39]
v_cndmask_b32 v26, v9, v26, s[40:41]
v_cndmask_b32 v27, v9, v27, s[42:43]
v_max3_f32 v88, v88, v24, v25
v_max3_f32 v88, v88, v26, v27
v_cmp_le_i32 s[36:37], 32, v99
v_cmp_le_i32 s[38:39], 33, v99
v_cmp_le_i32 s[40:41], 34, v99
v_cmp_le_i32 s[42:43], 35, v99
s_nop 1
v_cndmask_b32 v28, v9, v28, s[36:37]
v_cndmask_b32 v29, v9, v29, s[38:39]
v_cndmask_b32 v30, v9, v30, s[40:41]
v_cndmask_b32 v31, v9, v31, s[42:43]
v_max3_f32 v92, v92, v28, v29
v_max3_f32 v92, v92, v30, v31
v_cmp_le_i32 s[36:37], 48, v96
v_cmp_le_i32 s[38:39], 49, v96
v_cmp_le_i32 s[40:41], 50, v96
v_cmp_le_i32 s[42:43], 51, v96
s_nop 1
v_cndmask_b32 v32, v9, v32, s[36:37]
v_cndmask_b32 v33, v9, v33, s[38:39]
v_cndmask_b32 v34, v9, v34, s[40:41]
v_cndmask_b32 v35, v9, v35, s[42:43]
v_max3_f32 v80, v80, v32, v33
v_max3_f32 v80, v80, v34, v35
v_cmp_le_i32 s[36:37], 48, v97
v_cmp_le_i32 s[38:39], 49, v97
v_cmp_le_i32 s[40:41], 50, v97
v_cmp_le_i32 s[42:43], 51, v97
s_nop 1
v_cndmask_b32 v36, v9, v36, s[36:37]
v_cndmask_b32 v37, v9, v37, s[38:39]
v_cndmask_b32 v38, v9, v38, s[40:41]
v_cndmask_b32 v39, v9, v39, s[42:43]
v_max3_f32 v84, v84, v36, v37
v_max3_f32 v84, v84, v38, v39
v_cmp_le_i32 s[36:37], 48, v98
v_cmp_le_i32 s[38:39], 49, v98
v_cmp_le_i32 s[40:41], 50, v98
v_cmp_le_i32 s[42:43], 51, v98
s_nop 1
v_cndmask_b32 v40, v9, v40, s[36:37]
v_cndmask_b32 v41, v9, v41, s[38:39]
v_cndmask_b32 v42, v9, v42, s[40:41]
v_cndmask_b32 v43, v9, v43, s[42:43]
v_max3_f32 v88, v88, v40, v41
v_max3_f32 v88, v88, v42, v43
v_cmp_le_i32 s[36:37], 48, v99
v_cmp_le_i32 s[38:39], 49, v99
v_cmp_le_i32 s[40:41], 50, v99
v_cmp_le_i32 s[42:43], 51, v99
s_nop 1
v_cndmask_b32 v44, v9, v44, s[36:37]
v_cndmask_b32 v45, v9, v45, s[38:39]
v_cndmask_b32 v46, v9, v46, s[40:41]
v_cndmask_b32 v47, v9, v47, s[42:43]
v_max3_f32 v92, v92, v44, v45
v_max3_f32 v92, v92, v46, v47
v_subrev_u32 v96, 64, v96
v_subrev_u32 v97, 64, v97
v_subrev_u32 v98, 64, v98
v_subrev_u32 v99, 64, v99
s_sub_u32 s15, s15, 1
s_cmp_lg_u32 s15, 0
s_cbranch_scc1 L_fb_loop
v_mov_b32 v16, v80
v_mov_b32 v20, v84
v_mov_b32 v24, v88
v_mov_b32 v28, v92
v_permlane16_swap_b32 v16, v80
v_permlane16_swap_b32 v20, v84
v_permlane16_swap_b32 v24, v88
v_permlane16_swap_b32 v28, v92
v_max_f32 v80, v80, v16
v_max_f32 v84, v84, v20
v_max_f32 v88, v88, v24
v_max_f32 v92, v92, v28
v_mov_b32 v16, v80
v_mov_b32 v20, v84
v_mov_b32 v24, v88
v_mov_b32 v28, v92
v_permlane32_swap_b32 v16, v80
v_permlane32_swap_b32 v20, v84
v_permlane32_swap_b32 v24, v88
v_permlane32_swap_b32 v28, v92
v_max_f32 v80, v80, v16
v_max_f32 v84, v84, v20
v_max_f32 v88, v88, v24
v_max_f32 v92, v92, v28
s_barrier
s_mul_i32 s32, s5, 0x10c400
s_lshl_b32 s19, s4, 13
s_add_u32 s32, s32, s19
s_cmp_eq_u32 s4, 0
s_cselect_b32 s94, 0x200000, 0
s_add_u32 s32, s32, s94
s_sub_u32 s94, 0x8000, s94
s_add_u32 s7, s32, 0x1000
s_add_u32 s27, s19, 131072
s_add_u32 m0, s19, 0x0
s_nop 0
buffer_load_dwordx4 v3, s[48:51], s32 offen offset:0 sc1 lds
buffer_load_dwordx4 v3, s[48:51], s32 offen offset:1024 sc1 lds
buffer_load_dwordx4 v3, s[48:51], s32 offen offset:2048 sc1 lds
buffer_load_dwordx4 v3, s[48:51], s32 offen offset:3072 sc1 lds
s_add_u32 m0, s19, 0x1000
s_nop 0
buffer_load_dwordx4 v3, s[48:51], s7 offen offset:0 sc1 lds
buffer_load_dwordx4 v3, s[48:51], s7 offen offset:1024 sc1 lds
buffer_load_dwordx4 v3, s[48:51], s7 offen offset:2048 sc1 lds
buffer_load_dwordx4 v3, s[48:51], s7 offen offset:3072 sc1 lds
s_add_u32 s32, s32, s94
s_add_u32 s7, s7, s94
s_add_u32 m0, s19, 0x18000
s_nop 0
buffer_load_dwordx4 v3, s[48:51], s32 offen offset:0 sc1 lds
buffer_load_dwordx4 v3, s[48:51], s32 offen offset:1024 sc1 lds
buffer_load_dwordx4 v3, s[48:51], s32 offen offset:2048 sc1 lds
buffer_load_dwordx4 v3, s[48:51], s32 offen offset:3072 sc1 lds
s_add_u32 m0, s19, 0x19000
s_nop 0
buffer_load_dwordx4 v3, s[48:51], s7 offen offset:0 sc1 lds
buffer_load_dwordx4 v3, s[48:51], s7 offen offset:1024 sc1 lds
buffer_load_dwordx4 v3, s[48:51], s7 offen offset:2048 sc1 lds
buffer_load_dwordx4 v3, s[48:51], s7 offen offset:3072 sc1 lds
s_add_u32 s32, s32, 0x8000
s_add_u32 s7, s7, 0x8000
s_add_u32 m0, s19, 0x8000
s_nop 0
buffer_load_dwordx4 v3, s[48:51], s32 offen offset:0 sc1 lds
buffer_load_dwordx4 v3, s[48:51], s32 offen offset:1024 sc1 lds
buffer_load_dwordx4 v3, s[48:51], s32 offen offset:2048 sc1 lds
buffer_load_dwordx4 v3, s[48:51], s32 offen offset:3072 sc1 lds
s_add_u32 m0, s19, 0x9000
s_nop 0
buffer_load_dwordx4 v3, s[48:51], s7 offen offset:0 sc1 lds
buffer_load_dwordx4 v3, s[48:51], s7 offen offset:1024 sc1 lds
buffer_load_dwordx4 v3, s[48:51], s7 offen offset:2048 sc1 lds
buffer_load_dwordx4 v3, s[48:51], s7 offen offset:3072 sc1 lds
s_add_u32 s32, s32, 0x8000
s_add_u32 s7, s7, 0x8000
s_bfe_u32 s99, s2, 0x20001
s_lshl_b32 s99, s99, 2
s_lshr_b32 s8, s2, 6
s_add_u32 s99, s99, s8
s_bfe_u32 s100, s2, 0x30003
s_and_b32 s14, s2, 1
s_sub_u32 s24, 15, s99
s_min_u32 s18, s24, s99
s_lshl_b32 s24, s18, 1
s_add_u32 s24, s24, s14
s_lshl_b32 s24, s24, 8
s_add_u32 s24, s24, 0x3704000
s_mov_b32 s12, 14336
s_and_b32 s16, s6, 1
s_lshl_b32 s16, s16, 15
s_add_u32 s16, s16, 98304
s_add_u32 s16, s16, s17
s_lshl_b32 s13, s4, 15
s_lshl_b32 s9, s100, 8
s_add_u32 s13, s13, s9
s_mul_i32 s9, s14, 1310848
s_add_u32 s13, s13, s9
s_mul_i32 s25, s14, 3407872
s_sub_u32 s25, s25, 1179648
s_mul_i32 s101, s99, 0x142400
s_lshl_b32 s8, s4, 11
s_add_u32 s101, s101, s8
s_mul_i32 s8, s14, 163840
s_add_u32 s101, s101, s8
s_add_u32 s101, s101, 0x21fe000
s_mul_i32 s26, s14, 425984
s_add_u32 s26, s26, 106496
v_mov_b32 v15, s6
v_xor_b32 v15, 0, v15
v_writelane_b32 v15, s18, 0
v_lshlrev_b32 v15, 2, v15
v_bfe_u32 v12, v0, 2, 2
v_lshlrev_b32 v12, 11, v12
v_lshrrev_b32 v13, 4, v0
v_lshl_add_u32 v12, v13, 6, v12
v_and_b32 v13, 3, v0
v_lshl_add_u32 v12, v13, 4, v12
v_xor_b32 v12, s13, v12
v_xor_b32 v13, 32, v12
v_add_u32 v13, 7168, v13
s_mov_b32 s8, 0xf149f2ca
s_mov_b32 s36, 0xfff0ffff
s_mov_b32 s37, 0xf000ff00
s_mov_b32 s38, 0xffe0fffe
s_mov_b32 s39, 0xe000fe00
s_mov_b32 s40, 0xffc0fffc
s_mov_b32 s41, 0xc000fc00
s_mov_b32 s42, 0xff80fff8
s_mov_b32 s43, 0x8000f800
s_bitcmp1_b32 s4, 0
s_cselect_b32 s10, 0x7f800000, s8
s_cselect_b32 s11, s8, 0x7f800000
v_mov_b32 v1, v3
v_add_u32 v2, 98304, v3
s_mov_b64 s[34:35], 0
v_accvgpr_write_b32 a224, 0
v_accvgpr_write_b32 a225, 0
v_accvgpr_write_b32 a226, 0
v_accvgpr_write_b32 a227, 0
v_accvgpr_write_b32 a228, 0
v_accvgpr_write_b32 a229, 0
v_accvgpr_write_b32 a230, 0
v_accvgpr_write_b32 a231, 0
v_sub_f32 v83, 0, v80
v_sub_f32 v82, 0, v80
v_sub_f32 v81, 0, v80
v_sub_f32 v80, 0, v80
v_sub_f32 v87, 0, v84
v_sub_f32 v86, 0, v84
v_sub_f32 v85, 0, v84
v_sub_f32 v84, 0, v84
v_sub_f32 v91, 0, v88
v_sub_f32 v90, 0, v88
v_sub_f32 v89, 0, v88
v_sub_f32 v88, 0, v88
v_sub_f32 v95, 0, v92
v_sub_f32 v94, 0, v92
v_sub_f32 v93, 0, v92
v_sub_f32 v92, 0, v92
v_min_f32 v103, s10, v80
v_cndmask_b32 v96, v103, v80, s[36:37]
v_cndmask_b32 v97, v103, v80, s[38:39]
v_cndmask_b32 v98, v103, v80, s[40:41]
v_cndmask_b32 v99, v103, v80, s[42:43]
v_cndmask_b32 v100, v9, v103, s[36:37]
v_cndmask_b32 v101, v9, v103, s[38:39]
v_cndmask_b32 v102, v9, v103, s[40:41]
v_cndmask_b32 v103, v9, v103, s[42:43]
v_min_f32 v111, s11, v84
v_cndmask_b32 v104, v111, v84, s[36:37]
v_cndmask_b32 v105, v111, v84, s[38:39]
v_cndmask_b32 v106, v111, v84, s[40:41]
v_cndmask_b32 v107, v111, v84, s[42:43]
v_cndmask_b32 v108, v9, v111, s[36:37]
v_cndmask_b32 v109, v9, v111, s[38:39]
v_cndmask_b32 v110, v9, v111, s[40:41]
v_cndmask_b32 v111, v9, v111, s[42:43]
v_and_b32 v9, 1, v0
v_mul_u32_u24 v9, 0xaaaa, v9
v_add_u32 v9, 0x4444, v9
v_mov_b32 v128, 0
v_mov_b32 v129, 0
v_mov_b32 v130, 0
v_mov_b32 v131, 0
v_mov_b32 v132, 0
v_mov_b32 v133, 0
v_mov_b32 v134, 0
v_mov_b32 v135, 0
v_mov_b32 v136, 0
v_mov_b32 v137, 0
v_mov_b32 v138, 0
v_mov_b32 v139, 0
v_mov_b32 v140, 0
v_mov_b32 v141, 0
v_mov_b32 v142, 0
v_mov_b32 v143, 0
v_mov_b32 v144, 0
v_mov_b32 v145, 0
v_mov_b32 v146, 0
v_mov_b32 v147, 0
v_mov_b32 v148, 0
v_mov_b32 v149, 0
v_mov_b32 v150, 0
v_mov_b32 v151, 0
v_mov_b32 v152, 0
v_mov_b32 v153, 0
v_mov_b32 v154, 0
v_mov_b32 v155, 0
v_mov_b32 v156, 0
v_mov_b32 v157, 0
v_mov_b32 v158, 0
v_mov_b32 v159, 0
v_mov_b32 v160, 0
v_mov_b32 v161, 0
v_mov_b32 v162, 0
v_mov_b32 v163, 0
v_mov_b32 v164, 0
v_mov_b32 v165, 0
v_mov_b32 v166, 0
v_mov_b32 v167, 0
v_mov_b32 v168, 0
v_mov_b32 v169, 0
v_mov_b32 v170, 0
v_mov_b32 v171, 0
v_mov_b32 v172, 0
v_mov_b32 v173, 0
v_mov_b32 v174, 0
v_mov_b32 v175, 0
v_mov_b32 v176, 0
v_mov_b32 v177, 0
v_mov_b32 v178, 0
v_mov_b32 v179, 0
v_mov_b32 v180, 0
v_mov_b32 v181, 0
v_mov_b32 v182, 0
v_mov_b32 v183, 0
v_mov_b32 v184, 0
v_mov_b32 v185, 0
v_mov_b32 v186, 0
v_mov_b32 v187, 0
v_mov_b32 v188, 0
v_mov_b32 v189, 0
v_mov_b32 v190, 0
v_mov_b32 v191, 0
v_mov_b32 v192, 0
v_mov_b32 v193, 0
v_mov_b32 v194, 0
v_mov_b32 v195, 0
v_mov_b32 v196, 0
v_mov_b32 v197, 0
v_mov_b32 v198, 0
v_mov_b32 v199, 0
v_mov_b32 v200, 0
v_mov_b32 v201, 0
v_mov_b32 v202, 0
v_mov_b32 v203, 0
v_mov_b32 v204, 0
v_mov_b32 v205, 0
v_mov_b32 v206, 0
v_mov_b32 v207, 0
v_mov_b32 v208, 0
v_mov_b32 v209, 0
v_mov_b32 v210, 0
v_mov_b32 v211, 0
v_mov_b32 v212, 0
v_mov_b32 v213, 0
v_mov_b32 v214, 0
v_mov_b32 v215, 0
v_mov_b32 v216, 0
v_mov_b32 v217, 0
v_mov_b32 v218, 0
v_mov_b32 v219, 0
v_mov_b32 v220, 0
v_mov_b32 v221, 0
v_mov_b32 v222, 0
v_mov_b32 v223, 0
v_mov_b32 v224, 0
v_mov_b32 v225, 0
v_mov_b32 v226, 0
v_mov_b32 v227, 0
v_mov_b32 v228, 0
v_mov_b32 v229, 0
v_mov_b32 v230, 0
v_mov_b32 v231, 0
v_mov_b32 v232, 0
v_mov_b32 v233, 0
v_mov_b32 v234, 0
v_mov_b32 v235, 0
v_mov_b32 v236, 0
v_mov_b32 v237, 0
v_mov_b32 v238, 0
v_mov_b32 v239, 0
v_mov_b32 v240, 0
v_mov_b32 v241, 0
v_mov_b32 v242, 0
v_mov_b32 v243, 0
v_mov_b32 v244, 0
v_mov_b32 v245, 0
v_mov_b32 v246, 0
v_mov_b32 v247, 0
v_mov_b32 v248, 0
v_mov_b32 v249, 0
v_mov_b32 v250, 0
v_mov_b32 v251, 0
v_mov_b32 v252, 0
v_mov_b32 v253, 0
v_mov_b32 v254, 0
v_mov_b32 v255, 0
s_waitcnt vmcnt(16)
s_barrier
ds_read_b128 a[0:3], v1 offset:8192
ds_read_b128 a[4:7], v1 offset:9216
ds_read_b128 a[8:11], v1 offset:10240
ds_read_b128 a[12:15], v1 offset:11264
ds_read_b128 a[16:19], v1 offset:12288
ds_read_b128 a[20:23], v1 offset:13312
ds_read_b128 a[24:27], v1 offset:14336
ds_read_b128 a[28:31], v1 offset:15360
s_waitcnt lgkmcnt(0)
s_branch L_att_start
.section .rodata,"a"
.p2align 6
.amdhsa_kernel gated_mix__compressed_kv_cla__sliding_local_dilated__prompt_kernel
  .amdhsa_next_free_vgpr 512
  .amdhsa_next_free_sgpr 102
  .amdhsa_accum_offset 256
  .amdhsa_group_segment_fixed_size 0
  .amdhsa_kernarg_size 104
  .amdhsa_user_sgpr_count 2
  .amdhsa_user_sgpr_kernarg_segment_ptr 1
  .amdhsa_system_sgpr_workgroup_id_x 1
.end_amdhsa_kernel
```

```asm
; @launch grid=(256,1,1) block=(256,1,1) lds=163840
.amdgcn_target "amdgcn-amd-amdhsa--gfx950"
.text
.globl gated_mix__compressed_kv_cla__sliding_local_dilated__prompt_kernel
.p2align 8
.type gated_mix__compressed_kv_cla__sliding_local_dilated__prompt_kernel,@function
gated_mix__compressed_kv_cla__sliding_local_dilated__prompt_kernel:
s_load_dwordx16 s[16:31], s[0:1], 0
s_load_dwordx8 s[32:39], s[0:1], 64
s_load_dwordx2 s[88:89], s[0:1], 96
s_cmp_ge_u32 s2, 256
s_cbranch_scc1 L_end
v_lshrrev_b32 v1, 6, v0
v_and_b32 v0, 63, v0
v_readfirstlane_b32 s4, v1
v_lshlrev_b32 v16, 4, v0
s_lshr_b32 s8, s2, 3
s_lshl_b32 s8, s8, 2
s_add_u32 s8, s8, s4
s_min_u32 s8, s8, (L_end-L_page0)>>10
s_lshl_b32 s8, s8, 10
s_getpc_b64 s[92:93]
L_here:
s_add_u32 s8, s8, L_page0-L_here
s_add_u32 s92, s92, s8
s_addc_u32 s93, s93, 0
v_add_u32 v60, s92, v16
v_mov_b32 v61, s93
global_load_dword a120, v[60:61], off sc1
s_and_b32 s5, s2, 7
s_xor_b32 s5, s5, 1
s_lshl_b32 s5, s5, 2
s_bfe_u32 s3, s2, 0x20003
s_add_u32 s5, s5, s3
s_lshr_b32 s6, s2, 5
s_mov_b32 s12, 0x4000
s_mov_b32 s13, 0x8000
s_mov_b32 s14, 0xc000
s_mov_b32 s46, 0x400000
s_mov_b32 s47, 0x20000
s_mov_b32 s50, 0x200000
s_mov_b32 s51, 0x20000
s_mov_b32 s54, 0x800000
s_mov_b32 s55, 0x20000
s_mov_b32 s58, 0x400000
s_mov_b32 s59, 0x20000
s_mov_b32 s62, 0x400000
s_mov_b32 s63, 0x20000
s_mov_b32 s66, 0x800000
s_mov_b32 s67, 0x20000
s_mov_b32 s70, 0x600000
s_mov_b32 s71, 0x20000
s_mov_b32 s74, 0x200000
s_mov_b32 s75, 0x20000
s_mov_b32 s78, 0x800
s_mov_b32 s79, 0x20000
s_mov_b32 s82, 0x400000
s_mov_b32 s83, 0x20000
s_mov_b32 s86, 0x100
s_mov_b32 s87, 0x20000
s_mov_b32 s90, 0x10000000
s_mov_b32 s91, 0x20000
v_bfe_u32 v17, v0, 2, 2
s_lshl_b32 s8, s4, 4
v_add_u32 v17, s8, v17
v_lshlrev_b32 v17, 13, v17
v_lshrrev_b32 v18, 4, v0
v_lshl_add_u32 v17, v18, 6, v17
v_and_b32 v18, 3, v0
v_lshl_add_u32 v17, v18, 4, v17
s_lshl_b32 s8, s5, 8
v_add_u32 v5, s8, v17
v_xor_b32 v6, 32, v5
v_add_u32 v6, 0x10000, v6
v_lshrrev_b32 v17, 4, v0
v_xor_b32 v17, v17, v0
v_and_b32 v17, 7, v17
v_lshlrev_b32 v17, 4, v17
v_lshrrev_b32 v18, 3, v0
v_lshl_add_u32 v2, v18, 10, v17
s_lshl_b32 s8, s6, 18
s_lshl_b32 s9, s4, 16
s_add_u32 s8, s8, s9
v_add_u32 v2, s8, v2
v_xor_b32 v3, 64, v2
v_add_u32 v3, 0x2000, v3
s_mov_b32 s41, 0
s_mov_b32 s43, 0
v_lshl_add_u32 v5, s41, 19, v5
v_lshl_add_u32 v6, s41, 19, v6
v_lshl_add_u32 v2, s41, 7, v2
v_lshl_add_u32 v3, s41, 7, v3
s_sub_u32 s10, 15, s6
s_cmp_lt_u32 s5, 16
s_cselect_b32 s10, s6, s10
s_lshl_b32 s10, s10, 4
s_and_b32 s11, s5, 15
s_add_u32 s10, s10, s11
s_lshl_b32 s10, s10, 3
s_lshl_b32 s11, s4, 1
s_add_u32 s10, s10, s11
s_lshl_b32 s100, s10, 11
s_lshl_b32 s101, s10, 2
s_add_u32 s101, s101, 0x3700000
s_lshl_b32 s8, s2, 2
s_add_u32 s8, s8, s4
s_lshl_b32 s8, s8, 11
v_lshrrev_b32 v19, 2, v0
v_lshl_add_u32 v19, v19, 7, s8
s_lshr_b32 s8, s2, 3
s_lshl_b32 s8, s8, 2
s_add_u32 s8, s8, s4
s_lshl_b32 s8, s8, 4
s_lshr_b32 s9, s5, 2
s_add_u32 s8, s8, s9
s_lshl_b32 s8, s8, 10
v_bfe_u32 v63, v0, 2, 3
v_lshl_add_u32 v63, v63, 7, s8
v_lshrrev_b32 v59, 5, v0
v_lshl_add_u32 v63, v59, 13, v63
s_lshr_b32 s8, s8, 14
s_mul_i32 s8, s8, 49152
s_lshl_b32 s9, s9, 8
s_add_u32 s8, s8, s9
v_lshrrev_b32 v59, 3, v0
v_mul_u32_u24 v59, 0x1800, v59
v_and_b32 v1, 4, v0
v_lshl_add_u32 v1, v1, 5, v59
v_add_u32 v1, s8, v1
v_mov_b32 v62, v19
s_waitcnt lgkmcnt(0)
s_mov_b64 s[48:49], s[18:19]
s_mov_b64 s[56:57], s[22:23]
s_mov_b64 s[60:61], s[24:25]
L_args:
s_mov_b64 s[0:1], s[92:93]
s_mov_b64 s[44:45], s[16:17]
s_mov_b64 s[76:77], s[34:35]
s_mov_b64 s[52:53], s[20:21]
s_mov_b64 s[64:65], s[26:27]
s_mov_b64 s[68:69], s[30:31]
s_mov_b64 s[72:73], s[32:33]
s_mov_b64 s[80:81], s[36:37]
s_mov_b64 s[84:85], s[38:39]
s_lshl_b32 s16, s4, 13
s_add_u32 s16, s16, 0x18000
s_lshl_b32 s17, s4, 12
s_lshl_b32 s18, s4, 10
s_mov_b32 s25, 0x800
s_mov_b32 s26, 0x1000
s_mov_b32 s3, 0
s_mov_b32 s9, 0x0
s_nop 0
buffer_load_dword a120, v63, s[56:59], s9 offen
s_mov_b32 s9, 0x0
s_nop 0
buffer_load_dword a120, v63, s[60:63], s9 offen
s_add_u32 m0, s17, 0x0
s_nop 0
buffer_load_dwordx4 v5, s[56:59], 0 offen lds
s_add_u32 m0, s17, 0x4000
s_nop 0
buffer_load_dwordx4 v5, s[60:63], 0 offen lds
s_add_u32 m0, s17, 0x400
s_nop 0
buffer_load_dwordx4 v5, s[56:59], s13 offen lds
s_add_u32 m0, s17, 0x4400
s_nop 0
buffer_load_dwordx4 v5, s[60:63], s13 offen lds
s_add_u32 m0, s17, 0x800
s_nop 0
buffer_load_dwordx4 v6, s[56:59], 0 offen lds
s_add_u32 m0, s17, 0x4800
s_nop 0
buffer_load_dwordx4 v6, s[60:63], 0 offen lds
s_add_u32 m0, s17, 0xc00
s_nop 0
buffer_load_dwordx4 v6, s[56:59], s13 offen lds
s_add_u32 m0, s17, 0x4c00
s_nop 0
buffer_load_dwordx4 v6, s[60:63], s13 offen lds
s_mov_b32 s42, 1
s_mov_b32 s41, 7
v_lshl_add_u32 v5, s42, 19, v5
v_lshl_add_u32 v6, s42, 19, v6
s_add_u32 m0, s16, 0x0
s_nop 0
buffer_load_dwordx4 v2, s[48:51], 0 offen lds
s_add_u32 m0, s16, 0x400
s_nop 0
buffer_load_dwordx4 v3, s[48:51], 0 offen lds
s_add_u32 m0, s16, 0x800
s_nop 0
buffer_load_dwordx4 v2, s[48:51], s12 offen lds
s_add_u32 m0, s16, 0xc00
s_nop 0
buffer_load_dwordx4 v3, s[48:51], s12 offen lds
s_add_u32 m0, s16, 0x1000
s_nop 0
buffer_load_dwordx4 v2, s[48:51], s13 offen lds
s_add_u32 m0, s16, 0x1400
s_nop 0
buffer_load_dwordx4 v3, s[48:51], s13 offen lds
s_add_u32 m0, s16, 0x1800
s_nop 0
buffer_load_dwordx4 v2, s[48:51], s14 offen lds
s_add_u32 m0, s16, 0x1c00
s_nop 0
buffer_load_dwordx4 v3, s[48:51], s14 offen lds
v_lshl_add_u32 v2, s42, 7, v2
v_lshl_add_u32 v3, s42, 7, v3
v_lshrrev_b32 v17, 4, v0
v_xor_b32 v17, v17, v0
v_and_b32 v17, 7, v17
v_lshlrev_b32 v17, 4, v17
v_lshrrev_b32 v18, 3, v0
v_lshl_add_u32 v22, v18, 11, v17
v_xor_b32 v23, 64, v22
v_add_u32 v23, 0x4000, v23
s_lshl_b32 s8, s6, 18
s_sub_u32 s9, 15, s6
s_lshl_b32 s9, s9, 18
s_lshl_b32 s10, s4, 15
s_sub_u32 s11, 0x38000, s10
s_add_u32 s20, s8, s10
s_add_u32 s21, s8, s11
s_add_u32 s22, s9, s10
s_add_u32 s23, s9, s11
s_lshl_b32 s10, s5, 15
s_add_u32 s10, s10, 0x3c00000
s_lshr_b32 s8, s8, 7
s_lshr_b32 s9, s9, 7
s_add_u32 s8, s8, s10
s_add_u32 s9, s9, s10
v_add_u32 v10, s8, v16
v_add_u32 v11, s9, v16
s_cmp_lt_u32 s4, 2
s_cselect_b32 s8, s8, s9
s_and_b32 s9, s4, 1
s_lshl_b32 s9, s9, 10
s_add_u32 s8, s8, s9
v_add_u32 v4, s8, v16
v_lshrrev_b32 v17, 2, v0
s_lshl_b32 s8, s4, 4
v_add_u32 v17, s8, v17
v_mul_u32_u24 v17, 0x1800, v17
v_and_b32 v18, 3, v0
v_lshlrev_b32 v18, 4, v18
v_and_b32 v19, 32, v0
v_xor_b32 v18, v18, v19
s_lshl_b32 s8, s5, 6
v_add3_u32 v7, v17, v18, s8
v_lshl_add_u32 v22, s43, 7, v22
v_lshl_add_u32 v23, s43, 7, v23
v_lshl_add_u32 v7, s43, 18, v7
v_lshl_add_u32 v7, s43, 17, v7
v_and_b32 v17, 15, v0
v_lshrrev_b32 v18, 1, v17
v_lshrrev_b32 v19, 4, v0
v_xor_b32 v18, v18, v19
v_lshlrev_b32 v18, 4, v18
v_lshl_add_u32 v8, v17, 7, v18
v_add_u32 v8, s16, v8
v_xor_b32 v9, 64, v8
v_lshrrev_b32 v17, 4, v0
v_lshlrev_b32 v18, 11, v17
v_and_b32 v17, 1, v17
v_lshl_add_u32 v18, v17, 5, v18
v_bfe_u32 v17, v0, 2, 2
v_lshl_add_u32 v18, v17, 6, v18
v_and_b32 v17, 3, v0
v_lshl_add_u32 v12, v17, 3, v18
v_xor_b32 v13, 32, v12
v_lshrrev_b32 v17, 4, v0
v_lshlrev_b32 v18, 9, v17
v_and_b32 v17, 1, v17
v_lshl_add_u32 v18, v17, 5, v18
v_bfe_u32 v17, v0, 2, 2
v_lshl_add_u32 v18, v17, 6, v18
v_and_b32 v17, 3, v0
v_lshl_add_u32 v14, v17, 3, v18
v_accvgpr_write_b32 a64, -1
v_accvgpr_write_b32 a65, -1
v_accvgpr_write_b32 a66, -1
v_accvgpr_write_b32 a67, -1
v_add_u32 v14, 81920, v14
v_xor_b32 v15, 32, v14
s_mul_i32 s32, s5, 0x10c400
s_lshl_b32 s19, s4, 13
s_add_u32 s32, s32, s19
s_cmp_eq_u32 s4, 0
s_cselect_b32 s94, 0x200000, 0
s_add_u32 s32, s32, s94
s_sub_u32 s94, 0x8000, s94
s_add_u32 s7, s32, 0x1000
s_add_u32 s27, s19, 131072
s_add_u32 m0, s16, 0x8000
s_nop 0
buffer_load_dwordx4 v2, s[48:51], 0 offen lds
s_add_u32 m0, s16, 0x8400
s_nop 0
buffer_load_dwordx4 v3, s[48:51], 0 offen lds
s_add_u32 m0, s16, 0x8800
s_nop 0
buffer_load_dwordx4 v2, s[48:51], s12 offen lds
s_add_u32 m0, s16, 0x8c00
s_nop 0
buffer_load_dwordx4 v3, s[48:51], s12 offen lds
s_add_u32 m0, s16, 0x9000
s_nop 0
buffer_load_dwordx4 v2, s[48:51], s13 offen lds
s_add_u32 m0, s16, 0x9400
s_nop 0
buffer_load_dwordx4 v3, s[48:51], s13 offen lds
s_add_u32 m0, s16, 0x9800
s_nop 0
buffer_load_dwordx4 v2, s[48:51], s14 offen lds
s_add_u32 m0, s16, 0x9c00
s_nop 0
buffer_load_dwordx4 v3, s[48:51], s14 offen lds
v_lshl_add_u32 v2, s42, 7, v2
v_lshl_add_u32 v3, s42, 7, v3
s_mov_b32 s9, 0x0
s_nop 0
buffer_load_dword a120, v62, s[48:51], s9 offen
L_hopA:
s_mov_b32 s95, 1
s_cmp_eq_u32 s4, 0
s_cbranch_scc1 L_padA0
s_cmp_eq_u32 s4, 1
s_cbranch_scc1 L_padA1
s_cmp_eq_u32 s4, 2
s_cbranch_scc1 L_padA2
s_branch L_padA3
L_hopA_ret:
s_mov_b32 s95, 0
v_mov_b32 v19, v62
v_mov_b32 v18, v63
s_cmp_lg_u32 s4, 0
s_cbranch_scc1 L_flag_clr
s_lshl_b32 s8, s6, 5
s_add_u32 s8, s8, s5
s_and_b32 s92, s8, 0xf8
s_mul_i32 s92, s92, 7
s_add_u32 s8, s8, s92
s_lshl_b32 s8, s8, 2
s_add_u32 s8, s8, 0x3704000
v_mov_b32 v17, 0
s_mov_b64 exec, 1
buffer_store_dword v17, off, s[88:91], s8 sc1
s_mov_b64 exec, -1
L_flag_clr:
s_waitcnt vmcnt(9)
s_barrier
s_branch L_main
.p2align 12
L_page0:
L_padA0:
s_branch L_padA4
L_main:
ds_read_b64_tr_b16 a[80:81], v12 offset:0
ds_read_b64_tr_b16 a[82:83], v12 offset:1024
ds_read_b64_tr_b16 a[84:85], v12 offset:8192
ds_read_b64_tr_b16 a[86:87], v12 offset:9216
ds_read_b128 a[0:3], v8 offset:0
ds_read_b128 a[16:19], v9 offset:0
ds_read_b128 a[4:7], v8 offset:2048
ds_read_b128 a[20:23], v9 offset:2048
ds_read_b128 a[8:11], v8 offset:4096
ds_read_b128 a[24:27], v9 offset:4096
ds_read_b128 a[12:15], v8 offset:6144
ds_read_b128 a[28:31], v9 offset:6144
ds_read_b64_tr_b16 a[88:89], v13 offset:0
ds_read_b64_tr_b16 a[90:91], v13 offset:1024
ds_read_b64_tr_b16 a[92:93], v13 offset:8192
ds_read_b64_tr_b16 a[94:95], v13 offset:9216
ds_read_b64_tr_b16 a[96:97], v12 offset:256
ds_read_b64_tr_b16 a[98:99], v12 offset:1280
ds_read_b64_tr_b16 a[100:101], v12 offset:8448
ds_read_b64_tr_b16 a[102:103], v12 offset:9472
s_waitcnt lgkmcnt(0)
L_S0:
v_mfma_f32_16x16x32_bf16 v[24:27], a[80:83], a[0:3], 0
ds_read_b64_tr_b16 a[104:105], v13 offset:256
s_add_u32 m0, s17, 0x8000
v_mfma_f32_16x16x32_bf16 v[24:27], a[84:87], a[16:19], v[24:27]
buffer_load_dwordx4 v5, s[56:59], 0 offen lds
v_mfma_f32_16x16x32_bf16 v[32:35], a[84:87], a[20:23], 0
ds_read_b64_tr_b16 a[106:107], v13 offset:1280
v_mfma_f32_16x16x32_bf16 v[32:35], a[80:83], a[4:7], v[32:35]
ds_read_b64_tr_b16 a[108:109], v13 offset:8448
v_mfma_f32_16x16x32_bf16 v[40:43], a[80:83], a[8:11], 0
ds_read_b64_tr_b16 a[110:111], v13 offset:9472
v_mfma_f32_16x16x32_bf16 v[40:43], a[84:87], a[24:27], v[40:43]
s_add_u32 m0, s17, 0xc000
v_mfma_f32_16x16x32_bf16 v[48:51], a[84:87], a[28:31], 0
buffer_load_dwordx4 v5, s[60:63], 0 offen lds
v_mfma_f32_16x16x32_bf16 v[48:51], a[80:83], a[12:15], v[48:51]
v_mfma_f32_16x16x32_bf16 v[52:55], a[88:91], a[12:15], 0
ds_read_b64_tr_b16 a[80:81], v12 offset:512
v_mfma_f32_16x16x32_bf16 v[52:55], a[92:95], a[28:31], v[52:55]
ds_read_b64_tr_b16 a[82:83], v12 offset:1536
v_mfma_f32_16x16x32_bf16 v[44:47], a[92:95], a[24:27], 0
ds_read_b64_tr_b16 a[84:85], v12 offset:8704
s_add_u32 m0, s17, 0x8400
v_mfma_f32_16x16x32_bf16 v[44:47], a[88:91], a[8:11], v[44:47]
buffer_load_dwordx4 v5, s[56:59], s13 offen lds
v_mfma_f32_16x16x32_bf16 v[36:39], a[88:91], a[4:7], 0
ds_read_b64_tr_b16 a[86:87], v12 offset:9728
v_mfma_f32_16x16x32_bf16 v[36:39], a[92:95], a[20:23], v[36:39]
v_mfma_f32_16x16x32_bf16 v[28:31], a[92:95], a[16:19], 0
v_mfma_f32_16x16x32_bf16 v[28:31], a[88:91], a[0:3], v[28:31]
s_add_u32 m0, s17, 0xc400
v_mfma_f32_16x16x32_bf16 v[56:59], a[96:99], a[0:3], 0
buffer_load_dwordx4 v5, s[60:63], s13 offen lds
v_mfma_f32_16x16x32_bf16 v[56:59], a[100:103], a[16:19], v[56:59]
ds_read_b64_tr_b16 a[88:89], v13 offset:512
v_mfma_f32_16x16x32_bf16 v[64:67], a[100:103], a[20:23], 0
ds_read_b64_tr_b16 a[90:91], v13 offset:1536
v_mfma_f32_16x16x32_bf16 v[64:67], a[96:99], a[4:7], v[64:67]
ds_read_b64_tr_b16 a[92:93], v13 offset:8704
v_mfma_f32_16x16x32_bf16 v[72:75], a[96:99], a[8:11], 0
ds_read_b64_tr_b16 a[94:95], v13 offset:9728
s_add_u32 m0, s17, 0x8800
v_mfma_f32_16x16x32_bf16 v[72:75], a[100:103], a[24:27], v[72:75]
buffer_load_dwordx4 v6, s[56:59], 0 offen lds
v_mfma_f32_16x16x32_bf16 v[80:83], a[100:103], a[28:31], 0
v_mfma_f32_16x16x32_bf16 v[80:83], a[96:99], a[12:15], v[80:83]
s_waitcnt lgkmcnt(10)
v_mfma_f32_16x16x32_bf16 v[84:87], a[104:107], a[12:15], 0
ds_read_b64_tr_b16 a[96:97], v12 offset:768
s_waitcnt lgkmcnt(9)
v_mfma_f32_16x16x32_bf16 v[84:87], a[108:111], a[28:31], v[84:87]
ds_read_b64_tr_b16 a[98:99], v12 offset:1792
s_add_u32 m0, s17, 0xc800
v_mfma_f32_16x16x32_bf16 v[76:79], a[108:111], a[24:27], 0
buffer_load_dwordx4 v6, s[60:63], 0 offen lds
v_mfma_f32_16x16x32_bf16 v[76:79], a[104:107], a[8:11], v[76:79]
ds_read_b64_tr_b16 a[100:101], v12 offset:8960
v_mfma_f32_16x16x32_bf16 v[68:71], a[104:107], a[4:7], 0
ds_read_b64_tr_b16 a[102:103], v12 offset:9984
v_mfma_f32_16x16x32_bf16 v[68:71], a[108:111], a[20:23], v[68:71]
v_mfma_f32_16x16x32_bf16 v[60:63], a[108:111], a[16:19], 0
s_add_u32 m0, s17, 0x8c00
s_waitcnt lgkmcnt(4)
v_mfma_f32_16x16x32_bf16 v[60:63], a[104:107], a[0:3], v[60:63]
buffer_load_dwordx4 v6, s[56:59], s13 offen lds
v_mfma_f32_16x16x32_bf16 v[88:91], a[80:83], a[0:3], 0
ds_read_b64_tr_b16 a[104:105], v13 offset:768
v_mfma_f32_16x16x32_bf16 v[88:91], a[84:87], a[16:19], v[88:91]
ds_read_b64_tr_b16 a[106:107], v13 offset:1792
v_mfma_f32_16x16x32_bf16 v[96:99], a[84:87], a[20:23], 0
ds_read_b64_tr_b16 a[108:109], v13 offset:8960
v_mfma_f32_16x16x32_bf16 v[96:99], a[80:83], a[4:7], v[96:99]
ds_read_b64_tr_b16 a[110:111], v13 offset:9984
s_add_u32 m0, s17, 0xcc00
v_mfma_f32_16x16x32_bf16 v[104:107], a[80:83], a[8:11], 0
buffer_load_dwordx4 v6, s[60:63], s13 offen lds
v_mfma_f32_16x16x32_bf16 v[104:107], a[84:87], a[24:27], v[104:107]
v_lshl_add_u32 v5, s42, 19, v5
v_lshl_add_u32 v6, s42, 19, v6
v_mfma_f32_16x16x32_bf16 v[112:115], a[84:87], a[28:31], 0
v_mfma_f32_16x16x32_bf16 v[112:115], a[80:83], a[12:15], v[112:115]
v_mfma_f32_16x16x32_bf16 v[116:119], a[88:91], a[12:15], 0
ds_read_b64_tr_b16 a[80:81], v12 offset:16384
s_add_u32 m0, s16, 0x0
v_mfma_f32_16x16x32_bf16 v[116:119], a[92:95], a[28:31], v[116:119]
buffer_load_dwordx4 v2, s[48:51], 0 offen lds
v_mfma_f32_16x16x32_bf16 v[108:111], a[92:95], a[24:27], 0
ds_read_b64_tr_b16 a[82:83], v12 offset:17408
v_mfma_f32_16x16x32_bf16 v[108:111], a[88:91], a[8:11], v[108:111]
ds_read_b64_tr_b16 a[84:85], v12 offset:24576
v_mfma_f32_16x16x32_bf16 v[100:103], a[88:91], a[4:7], 0
ds_read_b64_tr_b16 a[86:87], v12 offset:25600
v_mfma_f32_16x16x32_bf16 v[100:103], a[92:95], a[20:23], v[100:103]
s_add_u32 m0, s16, 0x400
v_mfma_f32_16x16x32_bf16 v[92:95], a[92:95], a[16:19], 0
buffer_load_dwordx4 v3, s[48:51], 0 offen lds
v_mfma_f32_16x16x32_bf16 v[92:95], a[88:91], a[0:3], v[92:95]
s_waitcnt lgkmcnt(4)
v_mfma_f32_16x16x32_bf16 v[120:123], a[96:99], a[0:3], 0
ds_read_b64_tr_b16 a[88:89], v13 offset:16384
s_waitcnt vmcnt(11)
v_mfma_f32_16x16x32_bf16 v[120:123], a[100:103], a[16:19], v[120:123]
ds_read_b64_tr_b16 a[90:91], v13 offset:17408
v_mfma_f32_16x16x32_bf16 v[128:131], a[100:103], a[20:23], 0
ds_read_b64_tr_b16 a[92:93], v13 offset:24576
s_add_u32 m0, s16, 0x800
v_mfma_f32_16x16x32_bf16 v[128:131], a[96:99], a[4:7], v[128:131]
buffer_load_dwordx4 v2, s[48:51], s12 offen lds
v_mfma_f32_16x16x32_bf16 v[136:139], a[96:99], a[8:11], 0
ds_read_b64_tr_b16 a[94:95], v13 offset:25600
v_mfma_f32_16x16x32_bf16 v[136:139], a[100:103], a[24:27], v[136:139]
ds_read_b128 a[32:35], v8 offset:32768
v_mfma_f32_16x16x32_bf16 v[144:147], a[100:103], a[28:31], 0
ds_read_b128 a[48:51], v9 offset:32768
v_mfma_f32_16x16x32_bf16 v[144:147], a[96:99], a[12:15], v[144:147]
ds_read_b128 a[36:39], v8 offset:34816
s_add_u32 m0, s16, 0xc00
v_mfma_f32_16x16x32_bf16 v[148:151], a[104:107], a[12:15], 0
buffer_load_dwordx4 v3, s[48:51], s12 offen lds
v_mfma_f32_16x16x32_bf16 v[148:151], a[108:111], a[28:31], v[148:151]
ds_read_b64_tr_b16 a[96:97], v12 offset:16640
v_mfma_f32_16x16x32_bf16 v[140:143], a[108:111], a[24:27], 0
ds_read_b64_tr_b16 a[98:99], v12 offset:17664
v_mfma_f32_16x16x32_bf16 v[140:143], a[104:107], a[8:11], v[140:143]
ds_read_b64_tr_b16 a[100:101], v12 offset:24832
v_mfma_f32_16x16x32_bf16 v[132:135], a[104:107], a[4:7], 0
ds_read_b64_tr_b16 a[102:103], v12 offset:25856
s_add_u32 m0, s16, 0x1000
v_mfma_f32_16x16x32_bf16 v[132:135], a[108:111], a[20:23], v[132:135]
buffer_load_dwordx4 v2, s[48:51], s13 offen lds
v_mfma_f32_16x16x32_bf16 v[124:127], a[108:111], a[16:19], 0
ds_read_b128 a[52:55], v9 offset:34816
v_mfma_f32_16x16x32_bf16 v[124:127], a[104:107], a[0:3], v[124:127]
ds_read_b128 a[40:43], v8 offset:36864
s_waitcnt lgkmcnt(9)
v_mfma_f32_16x16x32_bf16 v[152:155], a[0:3], a[80:83], 0
ds_read_b64_tr_b16 a[104:105], v13 offset:16640
v_mfma_f32_16x16x32_bf16 v[152:155], a[16:19], a[84:87], v[152:155]
ds_read_b64_tr_b16 a[106:107], v13 offset:17664
s_add_u32 m0, s16, 0x1400
v_mfma_f32_16x16x32_bf16 v[156:159], a[20:23], a[84:87], 0
buffer_load_dwordx4 v3, s[48:51], s13 offen lds
v_mfma_f32_16x16x32_bf16 v[156:159], a[4:7], a[80:83], v[156:159]
ds_read_b64_tr_b16 a[108:109], v13 offset:24832
v_mfma_f32_16x16x32_bf16 v[160:163], a[8:11], a[80:83], 0
ds_read_b64_tr_b16 a[110:111], v13 offset:25856
v_mfma_f32_16x16x32_bf16 v[160:163], a[24:27], a[84:87], v[160:163]
ds_read_b128 a[56:59], v9 offset:36864
v_mfma_f32_16x16x32_bf16 v[164:167], a[28:31], a[84:87], 0
ds_read_b128 a[44:47], v8 offset:38912
s_add_u32 m0, s16, 0x1800
v_mfma_f32_16x16x32_bf16 v[164:167], a[12:15], a[80:83], v[164:167]
buffer_load_dwordx4 v2, s[48:51], s14 offen lds
v_mfma_f32_16x16x32_bf16 v[180:183], a[12:15], a[88:91], 0
ds_read_b64_tr_b16 a[80:81], v12 offset:16896
v_mfma_f32_16x16x32_bf16 v[180:183], a[28:31], a[92:95], v[180:183]
ds_read_b64_tr_b16 a[82:83], v12 offset:17920
v_mfma_f32_16x16x32_bf16 v[176:179], a[24:27], a[92:95], 0
ds_read_b64_tr_b16 a[84:85], v12 offset:25088
v_mfma_f32_16x16x32_bf16 v[176:179], a[8:11], a[88:91], v[176:179]
ds_read_b64_tr_b16 a[86:87], v12 offset:26112
s_add_u32 m0, s16, 0x1c00
v_mfma_f32_16x16x32_bf16 v[172:175], a[4:7], a[88:91], 0
buffer_load_dwordx4 v3, s[48:51], s14 offen lds
v_mfma_f32_16x16x32_bf16 v[172:175], a[20:23], a[92:95], v[172:175]
ds_read_b128 a[60:63], v9 offset:38912
v_lshl_add_u32 v2, s42, 7, v2
v_mfma_f32_16x16x32_bf16 v[168:171], a[16:19], a[92:95], 0
v_lshl_add_u32 v3, s42, 7, v3
v_mfma_f32_16x16x32_bf16 v[168:171], a[0:3], a[88:91], v[168:171]
s_waitcnt lgkmcnt(7)
v_mfma_f32_16x16x32_bf16 v[184:187], a[0:3], a[96:99], 0
ds_read_b64_tr_b16 a[88:89], v13 offset:16896
s_add_u32 m0, s17, 0x10000
v_mfma_f32_16x16x32_bf16 v[184:187], a[16:19], a[100:103], v[184:187]
buffer_load_dwordx4 v5, s[56:59], 0 offen lds
v_mfma_f32_16x16x32_bf16 v[188:191], a[20:23], a[100:103], 0
ds_read_b64_tr_b16 a[90:91], v13 offset:17920
v_mfma_f32_16x16x32_bf16 v[188:191], a[4:7], a[96:99], v[188:191]
ds_read_b64_tr_b16 a[92:93], v13 offset:25088
v_mfma_f32_16x16x32_bf16 v[192:195], a[8:11], a[96:99], 0
ds_read_b64_tr_b16 a[94:95], v13 offset:26112
v_mfma_f32_16x16x32_bf16 v[192:195], a[24:27], a[100:103], v[192:195]
s_add_u32 m0, s17, 0x14000
v_mfma_f32_16x16x32_bf16 v[196:199], a[28:31], a[100:103], 0
buffer_load_dwordx4 v5, s[60:63], 0 offen lds
v_mfma_f32_16x16x32_bf16 v[196:199], a[12:15], a[96:99], v[196:199]
v_mfma_f32_16x16x32_bf16 v[212:215], a[12:15], a[104:107], 0
ds_read_b64_tr_b16 a[96:97], v12 offset:17152
v_mfma_f32_16x16x32_bf16 v[212:215], a[28:31], a[108:111], v[212:215]
ds_read_b64_tr_b16 a[98:99], v12 offset:18176
v_mfma_f32_16x16x32_bf16 v[208:211], a[24:27], a[108:111], 0
ds_read_b64_tr_b16 a[100:101], v12 offset:25344
s_add_u32 m0, s17, 0x10400
v_mfma_f32_16x16x32_bf16 v[208:211], a[8:11], a[104:107], v[208:211]
buffer_load_dwordx4 v5, s[56:59], s13 offen lds
v_mfma_f32_16x16x32_bf16 v[204:207], a[4:7], a[104:107], 0
ds_read_b64_tr_b16 a[102:103], v12 offset:26368
v_mfma_f32_16x16x32_bf16 v[204:207], a[20:23], a[108:111], v[204:207]
v_mfma_f32_16x16x32_bf16 v[200:203], a[16:19], a[108:111], 0
v_mfma_f32_16x16x32_bf16 v[200:203], a[0:3], a[104:107], v[200:203]
s_add_u32 m0, s17, 0x14400
s_waitcnt lgkmcnt(4)
v_mfma_f32_16x16x32_bf16 v[216:219], a[0:3], a[80:83], 0
buffer_load_dwordx4 v5, s[60:63], s13 offen lds
v_mfma_f32_16x16x32_bf16 v[216:219], a[16:19], a[84:87], v[216:219]
ds_read_b64_tr_b16 a[104:105], v13 offset:17152
v_mfma_f32_16x16x32_bf16 v[220:223], a[20:23], a[84:87], 0
ds_read_b64_tr_b16 a[106:107], v13 offset:18176
v_mfma_f32_16x16x32_bf16 v[220:223], a[4:7], a[80:83], v[220:223]
ds_read_b64_tr_b16 a[108:109], v13 offset:25344
v_mfma_f32_16x16x32_bf16 v[224:227], a[8:11], a[80:83], 0
ds_read_b64_tr_b16 a[110:111], v13 offset:26368
s_add_u32 m0, s17, 0x10800
v_mfma_f32_16x16x32_bf16 v[224:227], a[24:27], a[84:87], v[224:227]
buffer_load_dwordx4 v6, s[56:59], 0 offen lds
v_mfma_f32_16x16x32_bf16 v[228:231], a[28:31], a[84:87], 0
v_add_u32 v12, 0x8000, v12
v_add_u32 v13, 0x8000, v13
v_mfma_f32_16x16x32_bf16 v[228:231], a[12:15], a[80:83], v[228:231]
v_mfma_f32_16x16x32_bf16 v[244:247], a[12:15], a[88:91], 0
s_waitcnt vmcnt(13) lgkmcnt(0)
v_mfma_f32_16x16x32_bf16 v[244:247], a[28:31], a[92:95], v[244:247]
s_barrier
s_add_u32 m0, s17, 0x14800
v_mfma_f32_16x16x32_bf16 v[240:243], a[24:27], a[92:95], 0
buffer_load_dwordx4 v6, s[60:63], 0 offen lds
v_mfma_f32_16x16x32_bf16 v[240:243], a[8:11], a[88:91], v[240:243]
ds_read_b64_tr_b16 a[80:81], v12 offset:0
v_mfma_f32_16x16x32_bf16 v[236:239], a[4:7], a[88:91], 0
ds_read_b64_tr_b16 a[82:83], v12 offset:1024
v_mfma_f32_16x16x32_bf16 v[236:239], a[20:23], a[92:95], v[236:239]
ds_read_b64_tr_b16 a[84:85], v12 offset:8192
s_waitcnt lgkmcnt(3)
v_mfma_f32_16x16x32_bf16 v[232:235], a[16:19], a[92:95], 0
ds_read_b64_tr_b16 a[86:87], v12 offset:9216
s_add_u32 m0, s17, 0x10c00
v_mfma_f32_16x16x32_bf16 v[232:235], a[0:3], a[88:91], v[232:235]
buffer_load_dwordx4 v6, s[56:59], s13 offen lds
v_mfma_f32_16x16x32_bf16 v[248:251], a[0:3], a[96:99], 0
ds_read_b64_tr_b16 a[88:89], v13 offset:0
v_mfma_f32_16x16x32_bf16 v[248:251], a[16:19], a[100:103], v[248:251]
ds_read_b64_tr_b16 a[90:91], v13 offset:1024
v_mfma_f32_16x16x32_bf16 v[252:255], a[20:23], a[100:103], 0
ds_read_b64_tr_b16 a[92:93], v13 offset:8192
v_mfma_f32_16x16x32_bf16 v[252:255], a[4:7], a[96:99], v[252:255]
ds_read_b64_tr_b16 a[94:95], v13 offset:9216
s_add_u32 m0, s17, 0x14c00
v_mfma_f32_16x16x32_bf16 a[232:235], a[8:11], a[96:99], 0
buffer_load_dwordx4 v6, s[60:63], s13 offen lds
v_mfma_f32_16x16x32_bf16 a[232:235], a[24:27], a[100:103], a[232:235]
v_lshl_add_u32 v5, s42, 19, v5
v_lshl_add_u32 v6, s42, 19, v6
v_mfma_f32_16x16x32_bf16 a[236:239], a[28:31], a[100:103], 0
v_mfma_f32_16x16x32_bf16 a[236:239], a[12:15], a[96:99], a[236:239]
s_waitcnt lgkmcnt(15)
v_mfma_f32_16x16x32_bf16 a[252:255], a[12:15], a[104:107], 0
ds_read_b64_tr_b16 a[96:97], v12 offset:256
s_add_u32 m0, s16, 0x8000
v_mfma_f32_16x16x32_bf16 a[252:255], a[28:31], a[108:111], a[252:255]
buffer_load_dwordx4 v2, s[48:51], 0 offen lds
v_mfma_f32_16x16x32_bf16 a[248:251], a[24:27], a[108:111], 0
ds_read_b64_tr_b16 a[98:99], v12 offset:1280
v_mfma_f32_16x16x32_bf16 a[248:251], a[8:11], a[104:107], a[248:251]
ds_read_b64_tr_b16 a[100:101], v12 offset:8448
v_mfma_f32_16x16x32_bf16 a[244:247], a[4:7], a[104:107], 0
ds_read_b64_tr_b16 a[102:103], v12 offset:9472
v_mfma_f32_16x16x32_bf16 a[244:247], a[20:23], a[108:111], a[244:247]
s_add_u32 m0, s16, 0x8400
v_mfma_f32_16x16x32_bf16 a[240:243], a[16:19], a[108:111], 0
buffer_load_dwordx4 v3, s[48:51], 0 offen lds
v_mfma_f32_16x16x32_bf16 a[240:243], a[0:3], a[104:107], a[240:243]
s_waitcnt lgkmcnt(4)
L_S1:
v_mfma_f32_16x16x32_bf16 v[24:27], a[80:83], a[32:35], v[24:27]
ds_read_b64_tr_b16 a[104:105], v13 offset:256
v_mfma_f32_16x16x32_bf16 v[24:27], a[84:87], a[48:51], v[24:27]
ds_read_b64_tr_b16 a[106:107], v13 offset:1280
v_mfma_f32_16x16x32_bf16 v[32:35], a[84:87], a[52:55], v[32:35]
ds_read_b64_tr_b16 a[108:109], v13 offset:8448
s_add_u32 m0, s16, 0x8800
v_mfma_f32_16x16x32_bf16 v[32:35], a[80:83], a[36:39], v[32:35]
buffer_load_dwordx4 v2, s[48:51], s12 offen lds
v_mfma_f32_16x16x32_bf16 v[40:43], a[80:83], a[40:43], v[40:43]
ds_read_b64_tr_b16 a[110:111], v13 offset:9472
v_mfma_f32_16x16x32_bf16 v[40:43], a[84:87], a[56:59], v[40:43]
v_mfma_f32_16x16x32_bf16 v[48:51], a[84:87], a[60:63], v[48:51]
v_mfma_f32_16x16x32_bf16 v[48:51], a[80:83], a[44:47], v[48:51]
s_add_u32 m0, s16, 0x8c00
v_mfma_f32_16x16x32_bf16 v[52:55], a[88:91], a[44:47], v[52:55]
buffer_load_dwordx4 v3, s[48:51], s12 offen lds
v_mfma_f32_16x16x32_bf16 v[52:55], a[92:95], a[60:63], v[52:55]
ds_read_b64_tr_b16 a[80:81], v12 offset:512
v_mfma_f32_16x16x32_bf16 v[44:47], a[92:95], a[56:59], v[44:47]
ds_read_b64_tr_b16 a[82:83], v12 offset:1536
v_mfma_f32_16x16x32_bf16 v[44:47], a[88:91], a[40:43], v[44:47]
ds_read_b64_tr_b16 a[84:85], v12 offset:8704
v_mfma_f32_16x16x32_bf16 v[36:39], a[88:91], a[36:39], v[36:39]
ds_read_b64_tr_b16 a[86:87], v12 offset:9728
s_add_u32 m0, s16, 0x9000
v_mfma_f32_16x16x32_bf16 v[36:39], a[92:95], a[52:55], v[36:39]
buffer_load_dwordx4 v2, s[48:51], s13 offen lds
v_mfma_f32_16x16x32_bf16 v[28:31], a[92:95], a[48:51], v[28:31]
v_mfma_f32_16x16x32_bf16 v[28:31], a[88:91], a[32:35], v[28:31]
s_waitcnt lgkmcnt(4)
v_mfma_f32_16x16x32_bf16 v[56:59], a[96:99], a[32:35], v[56:59]
ds_read_b64_tr_b16 a[88:89], v13 offset:512
v_mfma_f32_16x16x32_bf16 v[56:59], a[100:103], a[48:51], v[56:59]
ds_read_b64_tr_b16 a[90:91], v13 offset:1536
s_add_u32 m0, s16, 0x9400
v_mfma_f32_16x16x32_bf16 v[64:67], a[100:103], a[52:55], v[64:67]
buffer_load_dwordx4 v3, s[48:51], s13 offen lds
v_mfma_f32_16x16x32_bf16 v[64:67], a[96:99], a[36:39], v[64:67]
ds_read_b64_tr_b16 a[92:93], v13 offset:8704
v_mfma_f32_16x16x32_bf16 v[72:75], a[96:99], a[40:43], v[72:75]
ds_read_b64_tr_b16 a[94:95], v13 offset:9728
v_mfma_f32_16x16x32_bf16 v[72:75], a[100:103], a[56:59], v[72:75]
v_mfma_f32_16x16x32_bf16 v[80:83], a[100:103], a[60:63], v[80:83]
s_add_u32 m0, s16, 0x9800
v_mfma_f32_16x16x32_bf16 v[80:83], a[96:99], a[44:47], v[80:83]
buffer_load_dwordx4 v2, s[48:51], s14 offen lds
v_mfma_f32_16x16x32_bf16 v[84:87], a[104:107], a[44:47], v[84:87]
ds_read_b64_tr_b16 a[96:97], v12 offset:768
v_mfma_f32_16x16x32_bf16 v[84:87], a[108:111], a[60:63], v[84:87]
ds_read_b64_tr_b16 a[98:99], v12 offset:1792
v_mfma_f32_16x16x32_bf16 v[76:79], a[108:111], a[56:59], v[76:79]
ds_read_b64_tr_b16 a[100:101], v12 offset:8960
v_mfma_f32_16x16x32_bf16 v[76:79], a[104:107], a[40:43], v[76:79]
ds_read_b64_tr_b16 a[102:103], v12 offset:9984
s_add_u32 m0, s16, 0x9c00
v_mfma_f32_16x16x32_bf16 v[68:71], a[104:107], a[36:39], v[68:71]
buffer_load_dwordx4 v3, s[48:51], s14 offen lds
v_mfma_f32_16x16x32_bf16 v[68:71], a[108:111], a[52:55], v[68:71]
v_lshl_add_u32 v2, s42, 7, v2
v_lshl_add_u32 v3, s42, 7, v3
v_mfma_f32_16x16x32_bf16 v[60:63], a[108:111], a[48:51], v[60:63]
v_mfma_f32_16x16x32_bf16 v[60:63], a[104:107], a[32:35], v[60:63]
s_add_u32 m0, s17, 0x0
s_waitcnt lgkmcnt(4)
v_mfma_f32_16x16x32_bf16 v[88:91], a[80:83], a[32:35], v[88:91]
ds_read_b64_tr_b16 a[104:105], v13 offset:768
s_waitcnt vmcnt(16)
v_mfma_f32_16x16x32_bf16 v[88:91], a[84:87], a[48:51], v[88:91]
buffer_load_dwordx4 v5, s[56:59], 0 offen lds
v_mfma_f32_16x16x32_bf16 v[96:99], a[84:87], a[52:55], v[96:99]
ds_read_b64_tr_b16 a[106:107], v13 offset:1792
v_mfma_f32_16x16x32_bf16 v[96:99], a[80:83], a[36:39], v[96:99]
ds_read_b64_tr_b16 a[108:109], v13 offset:8960
v_mfma_f32_16x16x32_bf16 v[104:107], a[80:83], a[40:43], v[104:107]
ds_read_b64_tr_b16 a[110:111], v13 offset:9984
v_mfma_f32_16x16x32_bf16 v[104:107], a[84:87], a[56:59], v[104:107]
ds_read_b128 a[0:3], v8 offset:0
s_add_u32 m0, s17, 0x4000
v_mfma_f32_16x16x32_bf16 v[112:115], a[84:87], a[60:63], v[112:115]
buffer_load_dwordx4 v5, s[60:63], 0 offen lds
v_mfma_f32_16x16x32_bf16 v[112:115], a[80:83], a[44:47], v[112:115]
ds_read_b128 a[16:19], v9 offset:0
v_mfma_f32_16x16x32_bf16 v[116:119], a[88:91], a[44:47], v[116:119]
ds_read_b64_tr_b16 a[80:81], v12 offset:16384
v_mfma_f32_16x16x32_bf16 v[116:119], a[92:95], a[60:63], v[116:119]
ds_read_b64_tr_b16 a[82:83], v12 offset:17408
v_mfma_f32_16x16x32_bf16 v[108:111], a[92:95], a[56:59], v[108:111]
ds_read_b64_tr_b16 a[84:85], v12 offset:24576
s_add_u32 m0, s17, 0x400
v_mfma_f32_16x16x32_bf16 v[108:111], a[88:91], a[40:43], v[108:111]
buffer_load_dwordx4 v5, s[56:59], s13 offen lds
v_mfma_f32_16x16x32_bf16 v[100:103], a[88:91], a[36:39], v[100:103]
ds_read_b64_tr_b16 a[86:87], v12 offset:25600
v_mfma_f32_16x16x32_bf16 v[100:103], a[92:95], a[52:55], v[100:103]
ds_read_b128 a[4:7], v8 offset:2048
v_mfma_f32_16x16x32_bf16 v[92:95], a[92:95], a[48:51], v[92:95]
ds_read_b128 a[20:23], v9 offset:2048
s_waitcnt lgkmcnt(8)
v_mfma_f32_16x16x32_bf16 v[92:95], a[88:91], a[32:35], v[92:95]
ds_read_b128 a[8:11], v8 offset:4096
s_add_u32 m0, s17, 0x4400
v_mfma_f32_16x16x32_bf16 v[120:123], a[96:99], a[32:35], v[120:123]
buffer_load_dwordx4 v5, s[60:63], s13 offen lds
v_mfma_f32_16x16x32_bf16 v[120:123], a[100:103], a[48:51], v[120:123]
ds_read_b64_tr_b16 a[88:89], v13 offset:16384
v_mfma_f32_16x16x32_bf16 v[128:131], a[100:103], a[52:55], v[128:131]
ds_read_b64_tr_b16 a[90:91], v13 offset:17408
v_mfma_f32_16x16x32_bf16 v[128:131], a[96:99], a[36:39], v[128:131]
ds_read_b64_tr_b16 a[92:93], v13 offset:24576
v_mfma_f32_16x16x32_bf16 v[136:139], a[96:99], a[40:43], v[136:139]
ds_read_b64_tr_b16 a[94:95], v13 offset:25600
s_add_u32 m0, s17, 0x800
v_mfma_f32_16x16x32_bf16 v[136:139], a[100:103], a[56:59], v[136:139]
buffer_load_dwordx4 v6, s[56:59], 0 offen lds
v_mfma_f32_16x16x32_bf16 v[144:147], a[100:103], a[60:63], v[144:147]
ds_read_b128 a[24:27], v9 offset:4096
v_mfma_f32_16x16x32_bf16 v[144:147], a[96:99], a[44:47], v[144:147]
ds_read_b128 a[12:15], v8 offset:6144
v_mfma_f32_16x16x32_bf16 v[148:151], a[104:107], a[44:47], v[148:151]
ds_read_b64_tr_b16 a[96:97], v12 offset:16640
v_mfma_f32_16x16x32_bf16 v[148:151], a[108:111], a[60:63], v[148:151]
ds_read_b64_tr_b16 a[98:99], v12 offset:17664
s_add_u32 m0, s17, 0x4800
v_mfma_f32_16x16x32_bf16 v[140:143], a[108:111], a[56:59], v[140:143]
buffer_load_dwordx4 v6, s[60:63], 0 offen lds
v_mfma_f32_16x16x32_bf16 v[140:143], a[104:107], a[40:43], v[140:143]
ds_read_b64_tr_b16 a[100:101], v12 offset:24832
v_mfma_f32_16x16x32_bf16 v[132:135], a[104:107], a[36:39], v[132:135]
ds_read_b64_tr_b16 a[102:103], v12 offset:25856
v_mfma_f32_16x16x32_bf16 v[132:135], a[108:111], a[52:55], v[132:135]
ds_read_b128 a[28:31], v9 offset:6144
v_mfma_f32_16x16x32_bf16 v[124:127], a[108:111], a[48:51], v[124:127]
s_add_u32 m0, s17, 0xc00
s_waitcnt lgkmcnt(7)
v_mfma_f32_16x16x32_bf16 v[124:127], a[104:107], a[32:35], v[124:127]
buffer_load_dwordx4 v6, s[56:59], s13 offen lds
v_mfma_f32_16x16x32_bf16 v[152:155], a[32:35], a[80:83], v[152:155]
ds_read_b64_tr_b16 a[104:105], v13 offset:16640
v_mfma_f32_16x16x32_bf16 v[152:155], a[48:51], a[84:87], v[152:155]
ds_read_b64_tr_b16 a[106:107], v13 offset:17664
v_mfma_f32_16x16x32_bf16 v[156:159], a[52:55], a[84:87], v[156:159]
ds_read_b64_tr_b16 a[108:109], v13 offset:24832
v_mfma_f32_16x16x32_bf16 v[156:159], a[36:39], a[80:83], v[156:159]
ds_read_b64_tr_b16 a[110:111], v13 offset:25856
s_add_u32 m0, s17, 0x4c00
v_mfma_f32_16x16x32_bf16 v[160:163], a[40:43], a[80:83], v[160:163]
buffer_load_dwordx4 v6, s[60:63], s13 offen lds
v_mfma_f32_16x16x32_bf16 v[160:163], a[56:59], a[84:87], v[160:163]
v_lshl_add_u32 v5, s42, 19, v5
v_lshl_add_u32 v6, s42, 19, v6
v_mfma_f32_16x16x32_bf16 v[164:167], a[60:63], a[84:87], v[164:167]
v_mfma_f32_16x16x32_bf16 v[164:167], a[44:47], a[80:83], v[164:167]
v_mfma_f32_16x16x32_bf16 v[180:183], a[44:47], a[88:91], v[180:183]
ds_read_b64_tr_b16 a[80:81], v12 offset:16896
s_mov_b32 s9, 0x200000
v_mfma_f32_16x16x32_bf16 v[180:183], a[60:63], a[92:95], v[180:183]
buffer_load_dword a120, v18, s[56:59], s9 offen
v_mfma_f32_16x16x32_bf16 v[176:179], a[56:59], a[92:95], v[176:179]
ds_read_b64_tr_b16 a[82:83], v12 offset:17920
v_mfma_f32_16x16x32_bf16 v[176:179], a[40:43], a[88:91], v[176:179]
ds_read_b64_tr_b16 a[84:85], v12 offset:25088
v_mfma_f32_16x16x32_bf16 v[172:175], a[36:39], a[88:91], v[172:175]
ds_read_b64_tr_b16 a[86:87], v12 offset:26112
v_mfma_f32_16x16x32_bf16 v[172:175], a[52:55], a[92:95], v[172:175]
s_add_u32 m0, s16, 0x0
s_waitcnt lgkmcnt(8)
v_mfma_f32_16x16x32_bf16 v[168:171], a[48:51], a[92:95], v[168:171]
buffer_load_dwordx4 v2, s[48:51], 0 offen lds
v_mfma_f32_16x16x32_bf16 v[168:171], a[32:35], a[88:91], v[168:171]
s_waitcnt lgkmcnt(4)
v_mfma_f32_16x16x32_bf16 v[184:187], a[32:35], a[96:99], v[184:187]
ds_read_b64_tr_b16 a[88:89], v13 offset:16896
v_mfma_f32_16x16x32_bf16 v[184:187], a[48:51], a[100:103], v[184:187]
ds_read_b64_tr_b16 a[90:91], v13 offset:17920
v_mfma_f32_16x16x32_bf16 v[188:191], a[52:55], a[100:103], v[188:191]
ds_read_b64_tr_b16 a[92:93], v13 offset:25088
s_add_u32 m0, s16, 0x400
v_mfma_f32_16x16x32_bf16 v[188:191], a[36:39], a[96:99], v[188:191]
buffer_load_dwordx4 v3, s[48:51], 0 offen lds
v_mfma_f32_16x16x32_bf16 v[192:195], a[40:43], a[96:99], v[192:195]
ds_read_b64_tr_b16 a[94:95], v13 offset:26112
v_mfma_f32_16x16x32_bf16 v[192:195], a[56:59], a[100:103], v[192:195]
v_mfma_f32_16x16x32_bf16 v[196:199], a[60:63], a[100:103], v[196:199]
v_mfma_f32_16x16x32_bf16 v[196:199], a[44:47], a[96:99], v[196:199]
s_add_u32 m0, s16, 0x800
v_mfma_f32_16x16x32_bf16 v[212:215], a[44:47], a[104:107], v[212:215]
buffer_load_dwordx4 v2, s[48:51], s12 offen lds
v_mfma_f32_16x16x32_bf16 v[212:215], a[60:63], a[108:111], v[212:215]
ds_read_b64_tr_b16 a[96:97], v12 offset:17152
v_mfma_f32_16x16x32_bf16 v[208:211], a[56:59], a[108:111], v[208:211]
ds_read_b64_tr_b16 a[98:99], v12 offset:18176
v_mfma_f32_16x16x32_bf16 v[208:211], a[40:43], a[104:107], v[208:211]
ds_read_b64_tr_b16 a[100:101], v12 offset:25344
v_mfma_f32_16x16x32_bf16 v[204:207], a[36:39], a[104:107], v[204:207]
ds_read_b64_tr_b16 a[102:103], v12 offset:26368
s_add_u32 m0, s16, 0xc00
v_mfma_f32_16x16x32_bf16 v[204:207], a[52:55], a[108:111], v[204:207]
buffer_load_dwordx4 v3, s[48:51], s12 offen lds
v_mfma_f32_16x16x32_bf16 v[200:203], a[48:51], a[108:111], v[200:203]
v_mfma_f32_16x16x32_bf16 v[200:203], a[32:35], a[104:107], v[200:203]
s_waitcnt lgkmcnt(4)
v_mfma_f32_16x16x32_bf16 v[216:219], a[32:35], a[80:83], v[216:219]
ds_read_b64_tr_b16 a[104:105], v13 offset:17152
v_mfma_f32_16x16x32_bf16 v[216:219], a[48:51], a[84:87], v[216:219]
ds_read_b64_tr_b16 a[106:107], v13 offset:18176
s_add_u32 m0, s16, 0x1000
v_mfma_f32_16x16x32_bf16 v[220:223], a[52:55], a[84:87], v[220:223]
buffer_load_dwordx4 v2, s[48:51], s13 offen lds
v_mfma_f32_16x16x32_bf16 v[220:223], a[36:39], a[80:83], v[220:223]
ds_read_b64_tr_b16 a[108:109], v13 offset:25344
v_mfma_f32_16x16x32_bf16 v[224:227], a[40:43], a[80:83], v[224:227]
ds_read_b64_tr_b16 a[110:111], v13 offset:26368
v_add_u32 v12, 0x8000, v12
v_mfma_f32_16x16x32_bf16 v[224:227], a[56:59], a[84:87], v[224:227]
v_add_u32 v13, 0x8000, v13
v_mfma_f32_16x16x32_bf16 v[228:231], a[60:63], a[84:87], v[228:231]
s_add_u32 m0, s16, 0x1400
v_mfma_f32_16x16x32_bf16 v[228:231], a[44:47], a[80:83], v[228:231]
buffer_load_dwordx4 v3, s[48:51], s13 offen lds
v_mfma_f32_16x16x32_bf16 v[244:247], a[44:47], a[88:91], v[244:247]
s_waitcnt vmcnt(23) lgkmcnt(0)
v_mfma_f32_16x16x32_bf16 v[244:247], a[60:63], a[92:95], v[244:247]
s_barrier
v_mfma_f32_16x16x32_bf16 v[240:243], a[56:59], a[92:95], v[240:243]
ds_read_b64_tr_b16 a[80:81], v12 offset:0
s_lshl_b32 s15, s2, 2
v_mfma_f32_16x16x32_bf16 v[240:243], a[40:43], a[88:91], v[240:243]
ds_read_b64_tr_b16 a[82:83], v12 offset:1024
s_add_u32 m0, s16, 0x1800
v_mfma_f32_16x16x32_bf16 v[236:239], a[36:39], a[88:91], v[236:239]
buffer_load_dwordx4 v2, s[48:51], s14 offen lds
v_mfma_f32_16x16x32_bf16 v[236:239], a[52:55], a[92:95], v[236:239]
ds_read_b64_tr_b16 a[84:85], v12 offset:8192
s_add_u32 s15, s15, s4
v_mfma_f32_16x16x32_bf16 v[232:235], a[48:51], a[92:95], v[232:235]
ds_read_b64_tr_b16 a[86:87], v12 offset:9216
s_lshl_b32 s15, s15, 12
v_mfma_f32_16x16x32_bf16 v[232:235], a[32:35], a[88:91], v[232:235]
L_padA1:
s_cmp_eq_u32 s95, 1
s_cbranch_scc1 L_padA5
s_waitcnt lgkmcnt(4)
s_add_u32 s15, s15, 0x4800000
v_mfma_f32_16x16x32_bf16 v[248:251], a[32:35], a[96:99], v[248:251]
ds_read_b64_tr_b16 a[88:89], v13 offset:0
s_add_u32 m0, s16, 0x1c00
v_mfma_f32_16x16x32_bf16 v[248:251], a[48:51], a[100:103], v[248:251]
buffer_load_dwordx4 v3, s[48:51], s14 offen lds
v_mfma_f32_16x16x32_bf16 v[252:255], a[52:55], a[100:103], v[252:255]
ds_read_b64_tr_b16 a[90:91], v13 offset:1024
v_lshl_add_u32 v2, s42, 7, v2
v_mfma_f32_16x16x32_bf16 v[252:255], a[36:39], a[96:99], v[252:255]
ds_read_b64_tr_b16 a[92:93], v13 offset:8192
v_lshl_add_u32 v3, s42, 7, v3
v_mfma_f32_16x16x32_bf16 a[232:235], a[40:43], a[96:99], a[232:235]
ds_read_b64_tr_b16 a[94:95], v13 offset:9216
v_mfma_f32_16x16x32_bf16 a[232:235], a[56:59], a[100:103], a[232:235]
s_mov_b32 s9, 0x200000
v_mfma_f32_16x16x32_bf16 a[236:239], a[60:63], a[100:103], a[236:239]
buffer_load_dword a120, v18, s[60:63], s9 offen
v_mfma_f32_16x16x32_bf16 a[236:239], a[44:47], a[96:99], a[236:239]
v_mfma_f32_16x16x32_bf16 a[252:255], a[44:47], a[104:107], a[252:255]
ds_read_b64_tr_b16 a[96:97], v12 offset:256
v_mfma_f32_16x16x32_bf16 a[252:255], a[60:63], a[108:111], a[252:255]
ds_read_b64_tr_b16 a[98:99], v12 offset:1280
v_mfma_f32_16x16x32_bf16 a[248:251], a[56:59], a[108:111], a[248:251]
ds_read_b64_tr_b16 a[100:101], v12 offset:8448
s_add_u32 m0, s17, 0x8000
v_mfma_f32_16x16x32_bf16 a[248:251], a[40:43], a[104:107], a[248:251]
buffer_load_dwordx4 v5, s[56:59], 0 offen lds
v_mfma_f32_16x16x32_bf16 a[244:247], a[36:39], a[104:107], a[244:247]
ds_read_b64_tr_b16 a[102:103], v12 offset:9472
v_mfma_f32_16x16x32_bf16 a[244:247], a[52:55], a[108:111], a[244:247]
v_mfma_f32_16x16x32_bf16 a[240:243], a[48:51], a[108:111], a[240:243]
v_mfma_f32_16x16x32_bf16 a[240:243], a[32:35], a[104:107], a[240:243]
s_add_u32 m0, s17, 0xc000
s_waitcnt lgkmcnt(4)
L_S2:
v_mfma_f32_16x16x32_bf16 v[24:27], a[80:83], a[0:3], v[24:27]
buffer_load_dwordx4 v5, s[60:63], 0 offen lds
v_mfma_f32_16x16x32_bf16 v[24:27], a[84:87], a[16:19], v[24:27]
ds_read_b64_tr_b16 a[104:105], v13 offset:256
s_waitcnt vmcnt(20)
v_mfma_f32_16x16x32_bf16 v[32:35], a[84:87], a[20:23], v[32:35]
ds_read_b64_tr_b16 a[106:107], v13 offset:1280
v_mfma_f32_16x16x32_bf16 v[32:35], a[80:83], a[4:7], v[32:35]
ds_read_b64_tr_b16 a[108:109], v13 offset:8448
v_mfma_f32_16x16x32_bf16 v[40:43], a[80:83], a[8:11], v[40:43]
ds_read_b64_tr_b16 a[110:111], v13 offset:9472
s_add_u32 m0, s17, 0x8400
v_mfma_f32_16x16x32_bf16 v[40:43], a[84:87], a[24:27], v[40:43]
buffer_load_dwordx4 v5, s[56:59], s13 offen lds
v_mfma_f32_16x16x32_bf16 v[48:51], a[84:87], a[28:31], v[48:51]
ds_read_b128 a[32:35], v8 offset:32768
v_mfma_f32_16x16x32_bf16 v[48:51], a[80:83], a[12:15], v[48:51]
ds_read_b128 a[48:51], v9 offset:32768
v_mfma_f32_16x16x32_bf16 v[52:55], a[88:91], a[12:15], v[52:55]
ds_read_b64_tr_b16 a[80:81], v12 offset:512
v_mfma_f32_16x16x32_bf16 v[52:55], a[92:95], a[28:31], v[52:55]
ds_read_b64_tr_b16 a[82:83], v12 offset:1536
s_add_u32 m0, s17, 0xc400
v_mfma_f32_16x16x32_bf16 v[44:47], a[92:95], a[24:27], v[44:47]
buffer_load_dwordx4 v5, s[60:63], s13 offen lds
v_mfma_f32_16x16x32_bf16 v[44:47], a[88:91], a[8:11], v[44:47]
ds_read_b64_tr_b16 a[84:85], v12 offset:8704
v_mfma_f32_16x16x32_bf16 v[36:39], a[88:91], a[4:7], v[36:39]
ds_read_b64_tr_b16 a[86:87], v12 offset:9728
v_mfma_f32_16x16x32_bf16 v[36:39], a[92:95], a[20:23], v[36:39]
ds_read_b128 a[36:39], v8 offset:34816
s_waitcnt lgkmcnt(7)
v_mfma_f32_16x16x32_bf16 v[28:31], a[92:95], a[16:19], v[28:31]
ds_read_b128 a[52:55], v9 offset:34816
s_add_u32 m0, s17, 0x8800
v_mfma_f32_16x16x32_bf16 v[28:31], a[88:91], a[0:3], v[28:31]
buffer_load_dwordx4 v6, s[56:59], 0 offen lds
v_mfma_f32_16x16x32_bf16 v[56:59], a[96:99], a[0:3], v[56:59]
ds_read_b64_tr_b16 a[88:89], v13 offset:512
v_mfma_f32_16x16x32_bf16 v[56:59], a[100:103], a[16:19], v[56:59]
ds_read_b64_tr_b16 a[90:91], v13 offset:1536
v_mfma_f32_16x16x32_bf16 v[64:67], a[100:103], a[20:23], v[64:67]
ds_read_b64_tr_b16 a[92:93], v13 offset:8704
v_mfma_f32_16x16x32_bf16 v[64:67], a[96:99], a[4:7], v[64:67]
ds_read_b64_tr_b16 a[94:95], v13 offset:9728
s_add_u32 m0, s17, 0xc800
v_mfma_f32_16x16x32_bf16 v[72:75], a[96:99], a[8:11], v[72:75]
buffer_load_dwordx4 v6, s[60:63], 0 offen lds
v_mfma_f32_16x16x32_bf16 v[72:75], a[100:103], a[24:27], v[72:75]
ds_read_b128 a[40:43], v8 offset:36864
v_mfma_f32_16x16x32_bf16 v[80:83], a[100:103], a[28:31], v[80:83]
ds_read_b128 a[56:59], v9 offset:36864
v_mfma_f32_16x16x32_bf16 v[80:83], a[96:99], a[12:15], v[80:83]
ds_read_b128 a[44:47], v8 offset:38912
v_mfma_f32_16x16x32_bf16 v[84:87], a[104:107], a[12:15], v[84:87]
ds_read_b64_tr_b16 a[96:97], v12 offset:768
s_add_u32 m0, s17, 0x8c00
v_mfma_f32_16x16x32_bf16 v[84:87], a[108:111], a[28:31], v[84:87]
buffer_load_dwordx4 v6, s[56:59], s13 offen lds
v_mfma_f32_16x16x32_bf16 v[76:79], a[108:111], a[24:27], v[76:79]
ds_read_b64_tr_b16 a[98:99], v12 offset:1792
v_mfma_f32_16x16x32_bf16 v[76:79], a[104:107], a[8:11], v[76:79]
ds_read_b64_tr_b16 a[100:101], v12 offset:8960
v_mfma_f32_16x16x32_bf16 v[68:71], a[104:107], a[4:7], v[68:71]
ds_read_b64_tr_b16 a[102:103], v12 offset:9984
v_mfma_f32_16x16x32_bf16 v[68:71], a[108:111], a[20:23], v[68:71]
ds_read_b128 a[60:63], v9 offset:38912
s_add_u32 m0, s17, 0xcc00
v_mfma_f32_16x16x32_bf16 v[60:63], a[108:111], a[16:19], v[60:63]
buffer_load_dwordx4 v6, s[60:63], s13 offen lds
v_mfma_f32_16x16x32_bf16 v[60:63], a[104:107], a[0:3], v[60:63]
s_waitcnt lgkmcnt(8)
v_lshl_add_u32 v5, s42, 19, v5
v_lshl_add_u32 v6, s42, 19, v6
v_mfma_f32_16x16x32_bf16 v[88:91], a[80:83], a[0:3], v[88:91]
ds_read_b64_tr_b16 a[104:105], v13 offset:768
v_mfma_f32_16x16x32_bf16 v[88:91], a[84:87], a[16:19], v[88:91]
ds_read_b64_tr_b16 a[106:107], v13 offset:1792
v_mfma_f32_16x16x32_bf16 v[96:99], a[84:87], a[20:23], v[96:99]
ds_read_b64_tr_b16 a[108:109], v13 offset:8960
v_mfma_f32_16x16x32_bf16 v[96:99], a[80:83], a[4:7], v[96:99]
ds_read_b64_tr_b16 a[110:111], v13 offset:9984
v_mfma_f32_16x16x32_bf16 v[104:107], a[80:83], a[8:11], v[104:107]
s_add_u32 m0, s16, 0x8000
s_waitcnt lgkmcnt(4)
v_mfma_f32_16x16x32_bf16 v[104:107], a[84:87], a[24:27], v[104:107]
buffer_load_dwordx4 v2, s[48:51], 0 offen lds
v_mfma_f32_16x16x32_bf16 v[112:115], a[84:87], a[28:31], v[112:115]
v_mfma_f32_16x16x32_bf16 v[112:115], a[80:83], a[12:15], v[112:115]
v_mfma_f32_16x16x32_bf16 v[116:119], a[88:91], a[12:15], v[116:119]
ds_read_b64_tr_b16 a[80:81], v12 offset:16384
v_mfma_f32_16x16x32_bf16 v[116:119], a[92:95], a[28:31], v[116:119]
ds_read_b64_tr_b16 a[82:83], v12 offset:17408
v_mfma_f32_16x16x32_bf16 v[108:111], a[92:95], a[24:27], v[108:111]
ds_read_b64_tr_b16 a[84:85], v12 offset:24576
v_mfma_f32_16x16x32_bf16 v[108:111], a[88:91], a[8:11], v[108:111]
ds_read_b64_tr_b16 a[86:87], v12 offset:25600
s_add_u32 m0, s16, 0x8400
v_mfma_f32_16x16x32_bf16 v[100:103], a[88:91], a[4:7], v[100:103]
buffer_load_dwordx4 v3, s[48:51], 0 offen lds
v_mfma_f32_16x16x32_bf16 v[100:103], a[92:95], a[20:23], v[100:103]
v_mfma_f32_16x16x32_bf16 v[92:95], a[92:95], a[16:19], v[92:95]
v_mfma_f32_16x16x32_bf16 v[92:95], a[88:91], a[0:3], v[92:95]
s_waitcnt lgkmcnt(4)
v_mfma_f32_16x16x32_bf16 v[120:123], a[96:99], a[0:3], v[120:123]
ds_read_b64_tr_b16 a[88:89], v13 offset:16384
v_mfma_f32_16x16x32_bf16 v[120:123], a[100:103], a[16:19], v[120:123]
ds_read_b64_tr_b16 a[90:91], v13 offset:17408
v_mfma_f32_16x16x32_bf16 v[128:131], a[100:103], a[20:23], v[128:131]
ds_read_b64_tr_b16 a[92:93], v13 offset:24576
v_mfma_f32_16x16x32_bf16 v[128:131], a[96:99], a[4:7], v[128:131]
ds_read_b64_tr_b16 a[94:95], v13 offset:25600
s_add_u32 m0, s16, 0x8800
v_mfma_f32_16x16x32_bf16 v[136:139], a[96:99], a[8:11], v[136:139]
buffer_load_dwordx4 v2, s[48:51], s12 offen lds
v_mfma_f32_16x16x32_bf16 v[136:139], a[100:103], a[24:27], v[136:139]
v_mfma_f32_16x16x32_bf16 v[144:147], a[100:103], a[28:31], v[144:147]
v_mfma_f32_16x16x32_bf16 v[144:147], a[96:99], a[12:15], v[144:147]
v_mfma_f32_16x16x32_bf16 v[148:151], a[104:107], a[12:15], v[148:151]
ds_read_b64_tr_b16 a[96:97], v12 offset:16640
v_mfma_f32_16x16x32_bf16 v[148:151], a[108:111], a[28:31], v[148:151]
ds_read_b64_tr_b16 a[98:99], v12 offset:17664
v_mfma_f32_16x16x32_bf16 v[140:143], a[108:111], a[24:27], v[140:143]
ds_read_b64_tr_b16 a[100:101], v12 offset:24832
s_add_u32 m0, s16, 0x8c00
v_mfma_f32_16x16x32_bf16 v[140:143], a[104:107], a[8:11], v[140:143]
buffer_load_dwordx4 v3, s[48:51], s12 offen lds
v_mfma_f32_16x16x32_bf16 v[132:135], a[104:107], a[4:7], v[132:135]
ds_read_b64_tr_b16 a[102:103], v12 offset:25856
v_mfma_f32_16x16x32_bf16 v[132:135], a[108:111], a[20:23], v[132:135]
v_mfma_f32_16x16x32_bf16 v[124:127], a[108:111], a[16:19], v[124:127]
v_mfma_f32_16x16x32_bf16 v[124:127], a[104:107], a[0:3], v[124:127]
s_waitcnt lgkmcnt(4)
v_mfma_f32_16x16x32_bf16 v[152:155], a[0:3], a[80:83], v[152:155]
ds_read_b64_tr_b16 a[104:105], v13 offset:16640
v_mfma_f32_16x16x32_bf16 v[152:155], a[16:19], a[84:87], v[152:155]
ds_read_b64_tr_b16 a[106:107], v13 offset:17664
s_add_u32 m0, s16, 0x9000
v_mfma_f32_16x16x32_bf16 v[156:159], a[20:23], a[84:87], v[156:159]
buffer_load_dwordx4 v2, s[48:51], s13 offen lds
v_mfma_f32_16x16x32_bf16 v[156:159], a[4:7], a[80:83], v[156:159]
ds_read_b64_tr_b16 a[108:109], v13 offset:24832
v_mfma_f32_16x16x32_bf16 v[160:163], a[8:11], a[80:83], v[160:163]
ds_read_b64_tr_b16 a[110:111], v13 offset:25856
v_mfma_f32_16x16x32_bf16 v[160:163], a[24:27], a[84:87], v[160:163]
v_mfma_f32_16x16x32_bf16 v[164:167], a[28:31], a[84:87], v[164:167]
v_mfma_f32_16x16x32_bf16 v[164:167], a[12:15], a[80:83], v[164:167]
v_mfma_f32_16x16x32_bf16 v[180:183], a[12:15], a[88:91], v[180:183]
ds_read_b64_tr_b16 a[80:81], v12 offset:16896
v_mfma_f32_16x16x32_bf16 v[180:183], a[28:31], a[92:95], v[180:183]
ds_read_b64_tr_b16 a[82:83], v12 offset:17920
s_add_u32 m0, s16, 0x9400
v_mfma_f32_16x16x32_bf16 v[176:179], a[24:27], a[92:95], v[176:179]
buffer_load_dwordx4 v3, s[48:51], s13 offen lds
v_mfma_f32_16x16x32_bf16 v[176:179], a[8:11], a[88:91], v[176:179]
ds_read_b64_tr_b16 a[84:85], v12 offset:25088
v_mfma_f32_16x16x32_bf16 v[172:175], a[4:7], a[88:91], v[172:175]
ds_read_b64_tr_b16 a[86:87], v12 offset:26112
v_mfma_f32_16x16x32_bf16 v[172:175], a[20:23], a[92:95], v[172:175]
v_mfma_f32_16x16x32_bf16 v[168:171], a[16:19], a[92:95], v[168:171]
v_mfma_f32_16x16x32_bf16 v[168:171], a[0:3], a[88:91], v[168:171]
s_waitcnt lgkmcnt(4)
v_mfma_f32_16x16x32_bf16 v[184:187], a[0:3], a[96:99], v[184:187]
ds_read_b64_tr_b16 a[88:89], v13 offset:16896
s_add_u32 m0, s16, 0x9800
v_mfma_f32_16x16x32_bf16 v[184:187], a[16:19], a[100:103], v[184:187]
buffer_load_dwordx4 v2, s[48:51], s14 offen lds
v_mfma_f32_16x16x32_bf16 v[188:191], a[20:23], a[100:103], v[188:191]
ds_read_b64_tr_b16 a[90:91], v13 offset:17920
v_mfma_f32_16x16x32_bf16 v[188:191], a[4:7], a[96:99], v[188:191]
ds_read_b64_tr_b16 a[92:93], v13 offset:25088
v_mfma_f32_16x16x32_bf16 v[192:195], a[8:11], a[96:99], v[192:195]
ds_read_b64_tr_b16 a[94:95], v13 offset:26112
v_mfma_f32_16x16x32_bf16 v[192:195], a[24:27], a[100:103], v[192:195]
v_mfma_f32_16x16x32_bf16 v[196:199], a[28:31], a[100:103], v[196:199]
v_mfma_f32_16x16x32_bf16 v[196:199], a[12:15], a[96:99], v[196:199]
v_mfma_f32_16x16x32_bf16 v[212:215], a[12:15], a[104:107], v[212:215]
ds_read_b64_tr_b16 a[96:97], v12 offset:17152
s_add_u32 m0, s16, 0x9c00
v_mfma_f32_16x16x32_bf16 v[212:215], a[28:31], a[108:111], v[212:215]
buffer_load_dwordx4 v3, s[48:51], s14 offen lds
v_mfma_f32_16x16x32_bf16 v[208:211], a[24:27], a[108:111], v[208:211]
ds_read_b64_tr_b16 a[98:99], v12 offset:18176
v_lshl_add_u32 v2, s42, 7, v2
v_mfma_f32_16x16x32_bf16 v[208:211], a[8:11], a[104:107], v[208:211]
ds_read_b64_tr_b16 a[100:101], v12 offset:25344
v_lshl_add_u32 v3, s42, 7, v3
v_mfma_f32_16x16x32_bf16 v[204:207], a[4:7], a[104:107], v[204:207]
ds_read_b64_tr_b16 a[102:103], v12 offset:26368
v_mfma_f32_16x16x32_bf16 v[204:207], a[20:23], a[108:111], v[204:207]
v_mfma_f32_16x16x32_bf16 v[200:203], a[16:19], a[108:111], v[200:203]
v_mfma_f32_16x16x32_bf16 v[200:203], a[0:3], a[104:107], v[200:203]
s_mov_b32 s9, 0x0
s_waitcnt lgkmcnt(4)
v_mfma_f32_16x16x32_bf16 v[216:219], a[0:3], a[80:83], v[216:219]
buffer_load_dword a120, v19, s[44:47], s9 offen
v_mfma_f32_16x16x32_bf16 v[216:219], a[16:19], a[84:87], v[216:219]
ds_read_b64_tr_b16 a[104:105], v13 offset:17152
v_mfma_f32_16x16x32_bf16 v[220:223], a[20:23], a[84:87], v[220:223]
ds_read_b64_tr_b16 a[106:107], v13 offset:18176
v_mfma_f32_16x16x32_bf16 v[220:223], a[4:7], a[80:83], v[220:223]
ds_read_b64_tr_b16 a[108:109], v13 offset:25344
v_mfma_f32_16x16x32_bf16 v[224:227], a[8:11], a[80:83], v[224:227]
ds_read_b64_tr_b16 a[110:111], v13 offset:26368
v_add_u32 v12, 0xffff0000, v12
v_mfma_f32_16x16x32_bf16 v[224:227], a[24:27], a[84:87], v[224:227]
v_add_u32 v13, 0xffff0000, v13
v_mfma_f32_16x16x32_bf16 v[228:231], a[28:31], a[84:87], v[228:231]
v_mfma_f32_16x16x32_bf16 v[228:231], a[12:15], a[80:83], v[228:231]
v_mfma_f32_16x16x32_bf16 v[244:247], a[12:15], a[88:91], v[244:247]
s_waitcnt vmcnt(27) lgkmcnt(0)
v_mfma_f32_16x16x32_bf16 v[244:247], a[28:31], a[92:95], v[244:247]
s_barrier
s_add_u32 m0, s17, 0x10000
v_mfma_f32_16x16x32_bf16 v[240:243], a[24:27], a[92:95], v[240:243]
buffer_load_dwordx4 v5, s[56:59], 0 offen lds
v_mfma_f32_16x16x32_bf16 v[240:243], a[8:11], a[88:91], v[240:243]
ds_read_b64_tr_b16 a[80:81], v12 offset:0
v_mfma_f32_16x16x32_bf16 v[236:239], a[4:7], a[88:91], v[236:239]
ds_read_b64_tr_b16 a[82:83], v12 offset:1024
v_mfma_f32_16x16x32_bf16 v[236:239], a[20:23], a[92:95], v[236:239]
ds_read_b64_tr_b16 a[84:85], v12 offset:8192
v_mfma_f32_16x16x32_bf16 v[232:235], a[16:19], a[92:95], v[232:235]
ds_read_b64_tr_b16 a[86:87], v12 offset:9216
v_mfma_f32_16x16x32_bf16 v[232:235], a[0:3], a[88:91], v[232:235]
s_waitcnt lgkmcnt(4)
v_mfma_f32_16x16x32_bf16 v[248:251], a[0:3], a[96:99], v[248:251]
ds_read_b64_tr_b16 a[88:89], v13 offset:0
s_add_u32 m0, s17, 0x14000
v_mfma_f32_16x16x32_bf16 v[248:251], a[16:19], a[100:103], v[248:251]
buffer_load_dwordx4 v5, s[60:63], 0 offen lds
v_mfma_f32_16x16x32_bf16 v[252:255], a[20:23], a[100:103], v[252:255]
ds_read_b64_tr_b16 a[90:91], v13 offset:1024
v_mfma_f32_16x16x32_bf16 v[252:255], a[4:7], a[96:99], v[252:255]
ds_read_b64_tr_b16 a[92:93], v13 offset:8192
v_mfma_f32_16x16x32_bf16 a[232:235], a[8:11], a[96:99], a[232:235]
ds_read_b64_tr_b16 a[94:95], v13 offset:9216
v_mfma_f32_16x16x32_bf16 a[232:235], a[24:27], a[100:103], a[232:235]
v_mfma_f32_16x16x32_bf16 a[236:239], a[28:31], a[100:103], a[236:239]
v_mfma_f32_16x16x32_bf16 a[236:239], a[12:15], a[96:99], a[236:239]
s_add_u32 m0, s17, 0x10400
v_mfma_f32_16x16x32_bf16 a[252:255], a[12:15], a[104:107], a[252:255]
buffer_load_dwordx4 v5, s[56:59], s13 offen lds
v_mfma_f32_16x16x32_bf16 a[252:255], a[28:31], a[108:111], a[252:255]
ds_read_b64_tr_b16 a[96:97], v12 offset:256
v_mfma_f32_16x16x32_bf16 a[248:251], a[24:27], a[108:111], a[248:251]
ds_read_b64_tr_b16 a[98:99], v12 offset:1280
v_mfma_f32_16x16x32_bf16 a[248:251], a[8:11], a[104:107], a[248:251]
ds_read_b64_tr_b16 a[100:101], v12 offset:8448
v_mfma_f32_16x16x32_bf16 a[244:247], a[4:7], a[104:107], a[244:247]
ds_read_b64_tr_b16 a[102:103], v12 offset:9472
v_mfma_f32_16x16x32_bf16 a[244:247], a[20:23], a[108:111], a[244:247]
v_mfma_f32_16x16x32_bf16 a[240:243], a[16:19], a[108:111], a[240:243]
s_add_u32 m0, s17, 0x14400
s_waitcnt lgkmcnt(4)
v_mfma_f32_16x16x32_bf16 a[240:243], a[0:3], a[104:107], a[240:243]
buffer_load_dwordx4 v5, s[60:63], s13 offen lds
L_S3:
v_mfma_f32_16x16x32_bf16 v[24:27], a[80:83], a[32:35], v[24:27]
ds_read_b64_tr_b16 a[104:105], v13 offset:256
s_waitcnt vmcnt(22)
v_mfma_f32_16x16x32_bf16 v[24:27], a[84:87], a[48:51], v[24:27]
ds_read_b64_tr_b16 a[106:107], v13 offset:1280
v_mfma_f32_16x16x32_bf16 v[32:35], a[84:87], a[52:55], v[32:35]
ds_read_b64_tr_b16 a[108:109], v13 offset:8448
v_mfma_f32_16x16x32_bf16 v[32:35], a[80:83], a[36:39], v[32:35]
ds_read_b64_tr_b16 a[110:111], v13 offset:9472
v_mfma_f32_16x16x32_bf16 v[40:43], a[80:83], a[40:43], v[40:43]
ds_read_b128 a[0:3], v8 offset:0
v_mfma_f32_16x16x32_bf16 v[40:43], a[84:87], a[56:59], v[40:43]
ds_read_b128 a[16:19], v9 offset:0
s_add_u32 m0, s17, 0x10800
v_mfma_f32_16x16x32_bf16 v[48:51], a[84:87], a[60:63], v[48:51]
buffer_load_dwordx4 v6, s[56:59], 0 offen lds
v_mfma_f32_16x16x32_bf16 v[48:51], a[80:83], a[44:47], v[48:51]
ds_read_b128 a[4:7], v8 offset:2048
v_mfma_f32_16x16x32_bf16 v[52:55], a[88:91], a[44:47], v[52:55]
ds_read_b64_tr_b16 a[80:81], v12 offset:512
v_mfma_f32_16x16x32_bf16 v[52:55], a[92:95], a[60:63], v[52:55]
ds_read_b64_tr_b16 a[82:83], v12 offset:1536
v_mfma_f32_16x16x32_bf16 v[44:47], a[92:95], a[56:59], v[44:47]
ds_read_b64_tr_b16 a[84:85], v12 offset:8704
v_mfma_f32_16x16x32_bf16 v[44:47], a[88:91], a[40:43], v[44:47]
ds_read_b64_tr_b16 a[86:87], v12 offset:9728
v_mfma_f32_16x16x32_bf16 v[36:39], a[88:91], a[36:39], v[36:39]
ds_read_b128 a[20:23], v9 offset:2048
s_add_u32 m0, s17, 0x14800
v_mfma_f32_16x16x32_bf16 v[36:39], a[92:95], a[52:55], v[36:39]
buffer_load_dwordx4 v6, s[60:63], 0 offen lds
v_mfma_f32_16x16x32_bf16 v[28:31], a[92:95], a[48:51], v[28:31]
ds_read_b128 a[8:11], v8 offset:4096
v_mfma_f32_16x16x32_bf16 v[28:31], a[88:91], a[32:35], v[28:31]
ds_read_b128 a[24:27], v9 offset:4096
s_waitcnt lgkmcnt(10)
v_mfma_f32_16x16x32_bf16 v[56:59], a[96:99], a[32:35], v[56:59]
ds_read_b64_tr_b16 a[88:89], v13 offset:512
v_mfma_f32_16x16x32_bf16 v[56:59], a[100:103], a[48:51], v[56:59]
ds_read_b64_tr_b16 a[90:91], v13 offset:1536
v_mfma_f32_16x16x32_bf16 v[64:67], a[100:103], a[52:55], v[64:67]
ds_read_b64_tr_b16 a[92:93], v13 offset:8704
v_mfma_f32_16x16x32_bf16 v[64:67], a[96:99], a[36:39], v[64:67]
ds_read_b64_tr_b16 a[94:95], v13 offset:9728
s_add_u32 m0, s17, 0x10c00
v_mfma_f32_16x16x32_bf16 v[72:75], a[96:99], a[40:43], v[72:75]
buffer_load_dwordx4 v6, s[56:59], s13 offen lds
v_mfma_f32_16x16x32_bf16 v[72:75], a[100:103], a[56:59], v[72:75]
ds_read_b128 a[12:15], v8 offset:6144
v_mfma_f32_16x16x32_bf16 v[80:83], a[100:103], a[60:63], v[80:83]
ds_read_b128 a[28:31], v9 offset:6144
v_mfma_f32_16x16x32_bf16 v[80:83], a[96:99], a[44:47], v[80:83]
v_mfma_f32_16x16x32_bf16 v[84:87], a[104:107], a[44:47], v[84:87]
ds_read_b64_tr_b16 a[96:97], v12 offset:768
v_mfma_f32_16x16x32_bf16 v[84:87], a[108:111], a[60:63], v[84:87]
ds_read_b64_tr_b16 a[98:99], v12 offset:1792
v_mfma_f32_16x16x32_bf16 v[76:79], a[108:111], a[56:59], v[76:79]
ds_read_b64_tr_b16 a[100:101], v12 offset:8960
s_add_u32 m0, s17, 0x14c00
v_mfma_f32_16x16x32_bf16 v[76:79], a[104:107], a[40:43], v[76:79]
buffer_load_dwordx4 v6, s[60:63], s13 offen lds
v_mfma_f32_16x16x32_bf16 v[68:71], a[104:107], a[36:39], v[68:71]
ds_read_b64_tr_b16 a[102:103], v12 offset:9984
v_lshl_add_u32 v5, s42, 19, v5
v_mfma_f32_16x16x32_bf16 v[68:71], a[108:111], a[52:55], v[68:71]
v_lshl_add_u32 v6, s42, 19, v6
v_mfma_f32_16x16x32_bf16 v[60:63], a[108:111], a[48:51], v[60:63]
v_mfma_f32_16x16x32_bf16 v[60:63], a[104:107], a[32:35], v[60:63]
s_waitcnt lgkmcnt(6)
v_mfma_f32_16x16x32_bf16 v[88:91], a[80:83], a[32:35], v[88:91]
ds_read_b64_tr_b16 a[104:105], v13 offset:768
v_mfma_f32_16x16x32_bf16 v[88:91], a[84:87], a[48:51], v[88:91]
ds_read_b64_tr_b16 a[106:107], v13 offset:1792
s_mov_b32 s9, 0x200000
v_mfma_f32_16x16x32_bf16 v[96:99], a[84:87], a[52:55], v[96:99]
buffer_load_dword a120, v19, s[44:47], s9 offen
v_mfma_f32_16x16x32_bf16 v[96:99], a[80:83], a[36:39], v[96:99]
ds_read_b64_tr_b16 a[108:109], v13 offset:8960
v_mfma_f32_16x16x32_bf16 v[104:107], a[80:83], a[40:43], v[104:107]
ds_read_b64_tr_b16 a[110:111], v13 offset:9984
v_mfma_f32_16x16x32_bf16 v[104:107], a[84:87], a[56:59], v[104:107]
v_mfma_f32_16x16x32_bf16 v[112:115], a[84:87], a[60:63], v[112:115]
v_mfma_f32_16x16x32_bf16 v[112:115], a[80:83], a[44:47], v[112:115]
s_waitcnt lgkmcnt(8)
v_mfma_f32_16x16x32_bf16 v[116:119], a[88:91], a[44:47], v[116:119]
ds_read_b64_tr_b16 a[80:81], v12 offset:16384
s_add_u32 m0, s16, 0x0
v_mfma_f32_16x16x32_bf16 v[116:119], a[92:95], a[60:63], v[116:119]
buffer_load_dwordx4 v2, s[48:51], 0 offen lds
v_mfma_f32_16x16x32_bf16 v[108:111], a[92:95], a[56:59], v[108:111]
ds_read_b64_tr_b16 a[82:83], v12 offset:17408
v_mfma_f32_16x16x32_bf16 v[108:111], a[88:91], a[40:43], v[108:111]
ds_read_b64_tr_b16 a[84:85], v12 offset:24576
v_mfma_f32_16x16x32_bf16 v[100:103], a[88:91], a[36:39], v[100:103]
ds_read_b64_tr_b16 a[86:87], v12 offset:25600
v_mfma_f32_16x16x32_bf16 v[100:103], a[92:95], a[52:55], v[100:103]
v_mfma_f32_16x16x32_bf16 v[92:95], a[92:95], a[48:51], v[92:95]
v_mfma_f32_16x16x32_bf16 v[92:95], a[88:91], a[32:35], v[92:95]
s_add_u32 m0, s16, 0x400
s_waitcnt lgkmcnt(4)
v_mfma_f32_16x16x32_bf16 v[120:123], a[96:99], a[32:35], v[120:123]
buffer_load_dwordx4 v3, s[48:51], 0 offen lds
v_mfma_f32_16x16x32_bf16 v[120:123], a[100:103], a[48:51], v[120:123]
ds_read_b64_tr_b16 a[88:89], v13 offset:16384
v_mfma_f32_16x16x32_bf16 v[128:131], a[100:103], a[52:55], v[128:131]
ds_read_b64_tr_b16 a[90:91], v13 offset:17408
v_mfma_f32_16x16x32_bf16 v[128:131], a[96:99], a[36:39], v[128:131]
ds_read_b64_tr_b16 a[92:93], v13 offset:24576
v_mfma_f32_16x16x32_bf16 v[136:139], a[96:99], a[40:43], v[136:139]
ds_read_b64_tr_b16 a[94:95], v13 offset:25600
v_mfma_f32_16x16x32_bf16 v[136:139], a[100:103], a[56:59], v[136:139]
v_mfma_f32_16x16x32_bf16 v[144:147], a[100:103], a[60:63], v[144:147]
s_add_u32 m0, s16, 0x800
v_mfma_f32_16x16x32_bf16 v[144:147], a[96:99], a[44:47], v[144:147]
buffer_load_dwordx4 v2, s[48:51], s12 offen lds
v_mfma_f32_16x16x32_bf16 v[148:151], a[104:107], a[44:47], v[148:151]
ds_read_b64_tr_b16 a[96:97], v12 offset:16640
v_mfma_f32_16x16x32_bf16 v[148:151], a[108:111], a[60:63], v[148:151]
ds_read_b64_tr_b16 a[98:99], v12 offset:17664
v_mfma_f32_16x16x32_bf16 v[140:143], a[108:111], a[56:59], v[140:143]
ds_read_b64_tr_b16 a[100:101], v12 offset:24832
v_mfma_f32_16x16x32_bf16 v[140:143], a[104:107], a[40:43], v[140:143]
ds_read_b64_tr_b16 a[102:103], v12 offset:25856
v_mfma_f32_16x16x32_bf16 v[132:135], a[104:107], a[36:39], v[132:135]
v_mfma_f32_16x16x32_bf16 v[132:135], a[108:111], a[52:55], v[132:135]
s_add_u32 m0, s16, 0xc00
v_mfma_f32_16x16x32_bf16 v[124:127], a[108:111], a[48:51], v[124:127]
buffer_load_dwordx4 v3, s[48:51], s12 offen lds
v_mfma_f32_16x16x32_bf16 v[124:127], a[104:107], a[32:35], v[124:127]
s_waitcnt lgkmcnt(4)
v_mfma_f32_16x16x32_bf16 v[152:155], a[32:35], a[80:83], v[152:155]
ds_read_b64_tr_b16 a[104:105], v13 offset:16640
v_mfma_f32_16x16x32_bf16 v[152:155], a[48:51], a[84:87], v[152:155]
ds_read_b64_tr_b16 a[106:107], v13 offset:17664
v_mfma_f32_16x16x32_bf16 v[156:159], a[52:55], a[84:87], v[156:159]
ds_read_b64_tr_b16 a[108:109], v13 offset:24832
v_mfma_f32_16x16x32_bf16 v[156:159], a[36:39], a[80:83], v[156:159]
ds_read_b64_tr_b16 a[110:111], v13 offset:25856
v_mfma_f32_16x16x32_bf16 v[160:163], a[40:43], a[80:83], v[160:163]
s_add_u32 m0, s16, 0x1000
v_mfma_f32_16x16x32_bf16 v[160:163], a[56:59], a[84:87], v[160:163]
buffer_load_dwordx4 v2, s[48:51], s13 offen lds
v_mfma_f32_16x16x32_bf16 v[164:167], a[60:63], a[84:87], v[164:167]
v_mfma_f32_16x16x32_bf16 v[164:167], a[44:47], a[80:83], v[164:167]
v_mfma_f32_16x16x32_bf16 v[180:183], a[44:47], a[88:91], v[180:183]
ds_read_b64_tr_b16 a[80:81], v12 offset:16896
v_mfma_f32_16x16x32_bf16 v[180:183], a[60:63], a[92:95], v[180:183]
ds_read_b64_tr_b16 a[82:83], v12 offset:17920
v_mfma_f32_16x16x32_bf16 v[176:179], a[56:59], a[92:95], v[176:179]
ds_read_b64_tr_b16 a[84:85], v12 offset:25088
v_mfma_f32_16x16x32_bf16 v[176:179], a[40:43], a[88:91], v[176:179]
ds_read_b64_tr_b16 a[86:87], v12 offset:26112
s_add_u32 m0, s16, 0x1400
v_mfma_f32_16x16x32_bf16 v[172:175], a[36:39], a[88:91], v[172:175]
buffer_load_dwordx4 v3, s[48:51], s13 offen lds
v_mfma_f32_16x16x32_bf16 v[172:175], a[52:55], a[92:95], v[172:175]
v_mfma_f32_16x16x32_bf16 v[168:171], a[48:51], a[92:95], v[168:171]
v_mfma_f32_16x16x32_bf16 v[168:171], a[32:35], a[88:91], v[168:171]
s_waitcnt lgkmcnt(4)
v_mfma_f32_16x16x32_bf16 v[184:187], a[32:35], a[96:99], v[184:187]
ds_read_b64_tr_b16 a[88:89], v13 offset:16896
v_mfma_f32_16x16x32_bf16 v[184:187], a[48:51], a[100:103], v[184:187]
ds_read_b64_tr_b16 a[90:91], v13 offset:17920
v_mfma_f32_16x16x32_bf16 v[188:191], a[52:55], a[100:103], v[188:191]
ds_read_b64_tr_b16 a[92:93], v13 offset:25088
s_add_u32 m0, s16, 0x1800
v_mfma_f32_16x16x32_bf16 v[188:191], a[36:39], a[96:99], v[188:191]
buffer_load_dwordx4 v2, s[48:51], s14 offen lds
v_mfma_f32_16x16x32_bf16 v[192:195], a[40:43], a[96:99], v[192:195]
ds_read_b64_tr_b16 a[94:95], v13 offset:26112
v_mfma_f32_16x16x32_bf16 v[192:195], a[56:59], a[100:103], v[192:195]
v_mfma_f32_16x16x32_bf16 v[196:199], a[60:63], a[100:103], v[196:199]
v_mfma_f32_16x16x32_bf16 v[196:199], a[44:47], a[96:99], v[196:199]
v_mfma_f32_16x16x32_bf16 v[212:215], a[44:47], a[104:107], v[212:215]
ds_read_b64_tr_b16 a[96:97], v12 offset:17152
v_mfma_f32_16x16x32_bf16 v[212:215], a[60:63], a[108:111], v[212:215]
ds_read_b64_tr_b16 a[98:99], v12 offset:18176
s_add_u32 m0, s16, 0x1c00
v_mfma_f32_16x16x32_bf16 v[208:211], a[56:59], a[108:111], v[208:211]
buffer_load_dwordx4 v3, s[48:51], s14 offen lds
v_mfma_f32_16x16x32_bf16 v[208:211], a[40:43], a[104:107], v[208:211]
ds_read_b64_tr_b16 a[100:101], v12 offset:25344
v_lshl_add_u32 v2, s42, 7, v2
v_mfma_f32_16x16x32_bf16 v[204:207], a[36:39], a[104:107], v[204:207]
ds_read_b64_tr_b16 a[102:103], v12 offset:26368
v_lshl_add_u32 v3, s42, 7, v3
v_mfma_f32_16x16x32_bf16 v[204:207], a[52:55], a[108:111], v[204:207]
v_mfma_f32_16x16x32_bf16 v[200:203], a[48:51], a[108:111], v[200:203]
v_mfma_f32_16x16x32_bf16 v[200:203], a[32:35], a[104:107], v[200:203]
s_waitcnt lgkmcnt(4)
v_mfma_f32_16x16x32_bf16 v[216:219], a[32:35], a[80:83], v[216:219]
ds_read_b64_tr_b16 a[104:105], v13 offset:17152
s_mov_b32 s9, 0x0
v_mfma_f32_16x16x32_bf16 v[216:219], a[48:51], a[84:87], v[216:219]
buffer_load_dword a120, v18, s[52:55], s9 offen
v_mfma_f32_16x16x32_bf16 v[220:223], a[52:55], a[84:87], v[220:223]
ds_read_b64_tr_b16 a[106:107], v13 offset:18176
v_mfma_f32_16x16x32_bf16 v[220:223], a[36:39], a[80:83], v[220:223]
ds_read_b64_tr_b16 a[108:109], v13 offset:25344
v_mfma_f32_16x16x32_bf16 v[224:227], a[40:43], a[80:83], v[224:227]
ds_read_b64_tr_b16 a[110:111], v13 offset:26368
v_add_u32 v12, 0x8000, v12
v_mfma_f32_16x16x32_bf16 v[224:227], a[56:59], a[84:87], v[224:227]
v_add_u32 v13, 0x8000, v13
v_mfma_f32_16x16x32_bf16 v[228:231], a[60:63], a[84:87], v[228:231]
v_mfma_f32_16x16x32_bf16 v[228:231], a[44:47], a[80:83], v[228:231]
v_mfma_f32_16x16x32_bf16 v[244:247], a[44:47], a[88:91], v[244:247]
s_waitcnt vmcnt(27) lgkmcnt(0)
v_mfma_f32_16x16x32_bf16 v[244:247], a[60:63], a[92:95], v[244:247]
s_barrier
s_add_u32 m0, s17, 0x0
v_mfma_f32_16x16x32_bf16 v[240:243], a[56:59], a[92:95], v[240:243]
buffer_load_dwordx4 v5, s[56:59], 0 offen lds
v_mfma_f32_16x16x32_bf16 v[240:243], a[40:43], a[88:91], v[240:243]
ds_read_b64_tr_b16 a[80:81], v12 offset:0
v_mfma_f32_16x16x32_bf16 v[236:239], a[36:39], a[88:91], v[236:239]
ds_read_b64_tr_b16 a[82:83], v12 offset:1024
v_mfma_f32_16x16x32_bf16 v[236:239], a[52:55], a[92:95], v[236:239]
ds_read_b64_tr_b16 a[84:85], v12 offset:8192
v_mfma_f32_16x16x32_bf16 v[232:235], a[48:51], a[92:95], v[232:235]
ds_read_b64_tr_b16 a[86:87], v12 offset:9216
v_mfma_f32_16x16x32_bf16 v[232:235], a[32:35], a[88:91], v[232:235]
s_waitcnt lgkmcnt(4)
v_mfma_f32_16x16x32_bf16 v[248:251], a[32:35], a[96:99], v[248:251]
ds_read_b64_tr_b16 a[88:89], v13 offset:0
s_add_u32 m0, s17, 0x4000
v_mfma_f32_16x16x32_bf16 v[248:251], a[48:51], a[100:103], v[248:251]
buffer_load_dwordx4 v5, s[60:63], 0 offen lds
v_mfma_f32_16x16x32_bf16 v[252:255], a[52:55], a[100:103], v[252:255]
ds_read_b64_tr_b16 a[90:91], v13 offset:1024
L_padA2:
s_cmp_eq_u32 s95, 1
s_cbranch_scc1 L_padA6
v_mfma_f32_16x16x32_bf16 v[252:255], a[36:39], a[96:99], v[252:255]
ds_read_b64_tr_b16 a[92:93], v13 offset:8192
v_mfma_f32_16x16x32_bf16 a[232:235], a[40:43], a[96:99], a[232:235]
ds_read_b64_tr_b16 a[94:95], v13 offset:9216
v_mfma_f32_16x16x32_bf16 a[232:235], a[56:59], a[100:103], a[232:235]
v_mfma_f32_16x16x32_bf16 a[236:239], a[60:63], a[100:103], a[236:239]
v_mfma_f32_16x16x32_bf16 a[236:239], a[44:47], a[96:99], a[236:239]
s_add_u32 m0, s17, 0x400
v_mfma_f32_16x16x32_bf16 a[252:255], a[44:47], a[104:107], a[252:255]
buffer_load_dwordx4 v5, s[56:59], s13 offen lds
v_mfma_f32_16x16x32_bf16 a[252:255], a[60:63], a[108:111], a[252:255]
ds_read_b64_tr_b16 a[96:97], v12 offset:256
v_mfma_f32_16x16x32_bf16 a[248:251], a[56:59], a[108:111], a[248:251]
ds_read_b64_tr_b16 a[98:99], v12 offset:1280
v_mfma_f32_16x16x32_bf16 a[248:251], a[40:43], a[104:107], a[248:251]
ds_read_b64_tr_b16 a[100:101], v12 offset:8448
v_mfma_f32_16x16x32_bf16 a[244:247], a[36:39], a[104:107], a[244:247]
ds_read_b64_tr_b16 a[102:103], v12 offset:9472
v_mfma_f32_16x16x32_bf16 a[244:247], a[52:55], a[108:111], a[244:247]
v_mfma_f32_16x16x32_bf16 a[240:243], a[48:51], a[108:111], a[240:243]
s_add_u32 m0, s17, 0x4400
s_waitcnt lgkmcnt(4)
v_mfma_f32_16x16x32_bf16 a[240:243], a[32:35], a[104:107], a[240:243]
buffer_load_dwordx4 v5, s[60:63], s13 offen lds
L_S4:
v_mfma_f32_16x16x32_bf16 v[24:27], a[80:83], a[0:3], v[24:27]
ds_read_b64_tr_b16 a[104:105], v13 offset:256
s_waitcnt vmcnt(23)
v_mfma_f32_16x16x32_bf16 v[24:27], a[84:87], a[16:19], v[24:27]
ds_read_b64_tr_b16 a[106:107], v13 offset:1280
v_mfma_f32_16x16x32_bf16 v[32:35], a[84:87], a[20:23], v[32:35]
ds_read_b64_tr_b16 a[108:109], v13 offset:8448
v_mfma_f32_16x16x32_bf16 v[32:35], a[80:83], a[4:7], v[32:35]
ds_read_b64_tr_b16 a[110:111], v13 offset:9472
v_mfma_f32_16x16x32_bf16 v[40:43], a[80:83], a[8:11], v[40:43]
ds_read_b128 a[32:35], v8 offset:32768
v_mfma_f32_16x16x32_bf16 v[40:43], a[84:87], a[24:27], v[40:43]
ds_read_b128 a[48:51], v9 offset:32768
s_add_u32 m0, s17, 0x800
v_mfma_f32_16x16x32_bf16 v[48:51], a[84:87], a[28:31], v[48:51]
buffer_load_dwordx4 v6, s[56:59], 0 offen lds
v_mfma_f32_16x16x32_bf16 v[48:51], a[80:83], a[12:15], v[48:51]
ds_read_b128 a[36:39], v8 offset:34816
v_mfma_f32_16x16x32_bf16 v[52:55], a[88:91], a[12:15], v[52:55]
ds_read_b64_tr_b16 a[80:81], v12 offset:512
v_mfma_f32_16x16x32_bf16 v[52:55], a[92:95], a[28:31], v[52:55]
ds_read_b64_tr_b16 a[82:83], v12 offset:1536
v_mfma_f32_16x16x32_bf16 v[44:47], a[92:95], a[24:27], v[44:47]
ds_read_b64_tr_b16 a[84:85], v12 offset:8704
v_mfma_f32_16x16x32_bf16 v[44:47], a[88:91], a[8:11], v[44:47]
ds_read_b64_tr_b16 a[86:87], v12 offset:9728
v_mfma_f32_16x16x32_bf16 v[36:39], a[88:91], a[4:7], v[36:39]
ds_read_b128 a[52:55], v9 offset:34816
s_add_u32 m0, s17, 0x4800
v_mfma_f32_16x16x32_bf16 v[36:39], a[92:95], a[20:23], v[36:39]
buffer_load_dwordx4 v6, s[60:63], 0 offen lds
v_mfma_f32_16x16x32_bf16 v[28:31], a[92:95], a[16:19], v[28:31]
ds_read_b128 a[40:43], v8 offset:36864
v_mfma_f32_16x16x32_bf16 v[28:31], a[88:91], a[0:3], v[28:31]
ds_read_b128 a[56:59], v9 offset:36864
s_waitcnt lgkmcnt(10)
v_mfma_f32_16x16x32_bf16 v[56:59], a[96:99], a[0:3], v[56:59]
ds_read_b64_tr_b16 a[88:89], v13 offset:512
v_mfma_f32_16x16x32_bf16 v[56:59], a[100:103], a[16:19], v[56:59]
ds_read_b64_tr_b16 a[90:91], v13 offset:1536
v_mfma_f32_16x16x32_bf16 v[64:67], a[100:103], a[20:23], v[64:67]
ds_read_b64_tr_b16 a[92:93], v13 offset:8704
v_mfma_f32_16x16x32_bf16 v[64:67], a[96:99], a[4:7], v[64:67]
ds_read_b64_tr_b16 a[94:95], v13 offset:9728
s_add_u32 m0, s17, 0xc00
v_mfma_f32_16x16x32_bf16 v[72:75], a[96:99], a[8:11], v[72:75]
buffer_load_dwordx4 v6, s[56:59], s13 offen lds
v_mfma_f32_16x16x32_bf16 v[72:75], a[100:103], a[24:27], v[72:75]
ds_read_b128 a[44:47], v8 offset:38912
v_mfma_f32_16x16x32_bf16 v[80:83], a[100:103], a[28:31], v[80:83]
ds_read_b128 a[60:63], v9 offset:38912
v_mfma_f32_16x16x32_bf16 v[80:83], a[96:99], a[12:15], v[80:83]
v_mfma_f32_16x16x32_bf16 v[84:87], a[104:107], a[12:15], v[84:87]
ds_read_b64_tr_b16 a[96:97], v12 offset:768
v_mfma_f32_16x16x32_bf16 v[84:87], a[108:111], a[28:31], v[84:87]
ds_read_b64_tr_b16 a[98:99], v12 offset:1792
v_mfma_f32_16x16x32_bf16 v[76:79], a[108:111], a[24:27], v[76:79]
ds_read_b64_tr_b16 a[100:101], v12 offset:8960
s_add_u32 m0, s17, 0x4c00
v_mfma_f32_16x16x32_bf16 v[76:79], a[104:107], a[8:11], v[76:79]
buffer_load_dwordx4 v6, s[60:63], s13 offen lds
v_mfma_f32_16x16x32_bf16 v[68:71], a[104:107], a[4:7], v[68:71]
ds_read_b64_tr_b16 a[102:103], v12 offset:9984
v_lshl_add_u32 v5, s42, 19, v5
v_mfma_f32_16x16x32_bf16 v[68:71], a[108:111], a[20:23], v[68:71]
v_lshl_add_u32 v6, s42, 19, v6
v_mfma_f32_16x16x32_bf16 v[60:63], a[108:111], a[16:19], v[60:63]
v_mfma_f32_16x16x32_bf16 v[60:63], a[104:107], a[0:3], v[60:63]
s_waitcnt lgkmcnt(6)
v_mfma_f32_16x16x32_bf16 v[88:91], a[80:83], a[0:3], v[88:91]
ds_read_b64_tr_b16 a[104:105], v13 offset:768
v_mfma_f32_16x16x32_bf16 v[88:91], a[84:87], a[16:19], v[88:91]
ds_read_b64_tr_b16 a[106:107], v13 offset:1792
s_mov_b32 s9, 0x0
v_mfma_f32_16x16x32_bf16 v[96:99], a[84:87], a[20:23], v[96:99]
buffer_load_dword a120, v1, s[68:71], s9 offen
v_mfma_f32_16x16x32_bf16 v[96:99], a[80:83], a[4:7], v[96:99]
ds_read_b64_tr_b16 a[108:109], v13 offset:8960
v_mfma_f32_16x16x32_bf16 v[104:107], a[80:83], a[8:11], v[104:107]
ds_read_b64_tr_b16 a[110:111], v13 offset:9984
v_mfma_f32_16x16x32_bf16 v[104:107], a[84:87], a[24:27], v[104:107]
v_mfma_f32_16x16x32_bf16 v[112:115], a[84:87], a[28:31], v[112:115]
v_mfma_f32_16x16x32_bf16 v[112:115], a[80:83], a[12:15], v[112:115]
s_waitcnt lgkmcnt(8)
v_mfma_f32_16x16x32_bf16 v[116:119], a[88:91], a[12:15], v[116:119]
ds_read_b64_tr_b16 a[80:81], v12 offset:16384
s_add_u32 m0, s16, 0x8000
v_mfma_f32_16x16x32_bf16 v[116:119], a[92:95], a[28:31], v[116:119]
buffer_load_dwordx4 v2, s[48:51], 0 offen lds
v_mfma_f32_16x16x32_bf16 v[108:111], a[92:95], a[24:27], v[108:111]
ds_read_b64_tr_b16 a[82:83], v12 offset:17408
v_mfma_f32_16x16x32_bf16 v[108:111], a[88:91], a[8:11], v[108:111]
ds_read_b64_tr_b16 a[84:85], v12 offset:24576
v_mfma_f32_16x16x32_bf16 v[100:103], a[88:91], a[4:7], v[100:103]
ds_read_b64_tr_b16 a[86:87], v12 offset:25600
v_mfma_f32_16x16x32_bf16 v[100:103], a[92:95], a[20:23], v[100:103]
v_mfma_f32_16x16x32_bf16 v[92:95], a[92:95], a[16:19], v[92:95]
v_mfma_f32_16x16x32_bf16 v[92:95], a[88:91], a[0:3], v[92:95]
s_add_u32 m0, s16, 0x8400
s_waitcnt lgkmcnt(4)
v_mfma_f32_16x16x32_bf16 v[120:123], a[96:99], a[0:3], v[120:123]
buffer_load_dwordx4 v3, s[48:51], 0 offen lds
v_mfma_f32_16x16x32_bf16 v[120:123], a[100:103], a[16:19], v[120:123]
ds_read_b64_tr_b16 a[88:89], v13 offset:16384
v_mfma_f32_16x16x32_bf16 v[128:131], a[100:103], a[20:23], v[128:131]
ds_read_b64_tr_b16 a[90:91], v13 offset:17408
v_mfma_f32_16x16x32_bf16 v[128:131], a[96:99], a[4:7], v[128:131]
ds_read_b64_tr_b16 a[92:93], v13 offset:24576
v_mfma_f32_16x16x32_bf16 v[136:139], a[96:99], a[8:11], v[136:139]
ds_read_b64_tr_b16 a[94:95], v13 offset:25600
v_mfma_f32_16x16x32_bf16 v[136:139], a[100:103], a[24:27], v[136:139]
v_mfma_f32_16x16x32_bf16 v[144:147], a[100:103], a[28:31], v[144:147]
s_add_u32 m0, s16, 0x8800
v_mfma_f32_16x16x32_bf16 v[144:147], a[96:99], a[12:15], v[144:147]
buffer_load_dwordx4 v2, s[48:51], s12 offen lds
v_mfma_f32_16x16x32_bf16 v[148:151], a[104:107], a[12:15], v[148:151]
ds_read_b64_tr_b16 a[96:97], v12 offset:16640
v_mfma_f32_16x16x32_bf16 v[148:151], a[108:111], a[28:31], v[148:151]
ds_read_b64_tr_b16 a[98:99], v12 offset:17664
v_mfma_f32_16x16x32_bf16 v[140:143], a[108:111], a[24:27], v[140:143]
ds_read_b64_tr_b16 a[100:101], v12 offset:24832
v_mfma_f32_16x16x32_bf16 v[140:143], a[104:107], a[8:11], v[140:143]
ds_read_b64_tr_b16 a[102:103], v12 offset:25856
v_mfma_f32_16x16x32_bf16 v[132:135], a[104:107], a[4:7], v[132:135]
v_mfma_f32_16x16x32_bf16 v[132:135], a[108:111], a[20:23], v[132:135]
s_add_u32 m0, s16, 0x8c00
v_mfma_f32_16x16x32_bf16 v[124:127], a[108:111], a[16:19], v[124:127]
buffer_load_dwordx4 v3, s[48:51], s12 offen lds
v_mfma_f32_16x16x32_bf16 v[124:127], a[104:107], a[0:3], v[124:127]
s_waitcnt lgkmcnt(4)
v_mfma_f32_16x16x32_bf16 v[152:155], a[0:3], a[80:83], v[152:155]
ds_read_b64_tr_b16 a[104:105], v13 offset:16640
v_mfma_f32_16x16x32_bf16 v[152:155], a[16:19], a[84:87], v[152:155]
ds_read_b64_tr_b16 a[106:107], v13 offset:17664
v_mfma_f32_16x16x32_bf16 v[156:159], a[20:23], a[84:87], v[156:159]
ds_read_b64_tr_b16 a[108:109], v13 offset:24832
v_mfma_f32_16x16x32_bf16 v[156:159], a[4:7], a[80:83], v[156:159]
ds_read_b64_tr_b16 a[110:111], v13 offset:25856
v_mfma_f32_16x16x32_bf16 v[160:163], a[8:11], a[80:83], v[160:163]
s_add_u32 m0, s16, 0x9000
v_mfma_f32_16x16x32_bf16 v[160:163], a[24:27], a[84:87], v[160:163]
buffer_load_dwordx4 v2, s[48:51], s13 offen lds
v_mfma_f32_16x16x32_bf16 v[164:167], a[28:31], a[84:87], v[164:167]
v_mfma_f32_16x16x32_bf16 v[164:167], a[12:15], a[80:83], v[164:167]
v_mfma_f32_16x16x32_bf16 v[180:183], a[12:15], a[88:91], v[180:183]
ds_read_b64_tr_b16 a[80:81], v12 offset:16896
v_mfma_f32_16x16x32_bf16 v[180:183], a[28:31], a[92:95], v[180:183]
ds_read_b64_tr_b16 a[82:83], v12 offset:17920
v_mfma_f32_16x16x32_bf16 v[176:179], a[24:27], a[92:95], v[176:179]
ds_read_b64_tr_b16 a[84:85], v12 offset:25088
v_mfma_f32_16x16x32_bf16 v[176:179], a[8:11], a[88:91], v[176:179]
ds_read_b64_tr_b16 a[86:87], v12 offset:26112
s_add_u32 m0, s16, 0x9400
v_mfma_f32_16x16x32_bf16 v[172:175], a[4:7], a[88:91], v[172:175]
buffer_load_dwordx4 v3, s[48:51], s13 offen lds
v_mfma_f32_16x16x32_bf16 v[172:175], a[20:23], a[92:95], v[172:175]
v_mfma_f32_16x16x32_bf16 v[168:171], a[16:19], a[92:95], v[168:171]
v_mfma_f32_16x16x32_bf16 v[168:171], a[0:3], a[88:91], v[168:171]
s_waitcnt lgkmcnt(4)
v_mfma_f32_16x16x32_bf16 v[184:187], a[0:3], a[96:99], v[184:187]
ds_read_b64_tr_b16 a[88:89], v13 offset:16896
v_mfma_f32_16x16x32_bf16 v[184:187], a[16:19], a[100:103], v[184:187]
ds_read_b64_tr_b16 a[90:91], v13 offset:17920
v_mfma_f32_16x16x32_bf16 v[188:191], a[20:23], a[100:103], v[188:191]
ds_read_b64_tr_b16 a[92:93], v13 offset:25088
s_add_u32 m0, s16, 0x9800
v_mfma_f32_16x16x32_bf16 v[188:191], a[4:7], a[96:99], v[188:191]
buffer_load_dwordx4 v2, s[48:51], s14 offen lds
v_mfma_f32_16x16x32_bf16 v[192:195], a[8:11], a[96:99], v[192:195]
ds_read_b64_tr_b16 a[94:95], v13 offset:26112
v_mfma_f32_16x16x32_bf16 v[192:195], a[24:27], a[100:103], v[192:195]
v_mfma_f32_16x16x32_bf16 v[196:199], a[28:31], a[100:103], v[196:199]
v_mfma_f32_16x16x32_bf16 v[196:199], a[12:15], a[96:99], v[196:199]
v_mfma_f32_16x16x32_bf16 v[212:215], a[12:15], a[104:107], v[212:215]
ds_read_b64_tr_b16 a[96:97], v12 offset:17152
v_mfma_f32_16x16x32_bf16 v[212:215], a[28:31], a[108:111], v[212:215]
ds_read_b64_tr_b16 a[98:99], v12 offset:18176
s_add_u32 m0, s16, 0x9c00
v_mfma_f32_16x16x32_bf16 v[208:211], a[24:27], a[108:111], v[208:211]
buffer_load_dwordx4 v3, s[48:51], s14 offen lds
v_mfma_f32_16x16x32_bf16 v[208:211], a[8:11], a[104:107], v[208:211]
ds_read_b64_tr_b16 a[100:101], v12 offset:25344
s_sub_u32 s42, s43, s41
v_mfma_f32_16x16x32_bf16 v[204:207], a[4:7], a[104:107], v[204:207]
ds_read_b64_tr_b16 a[102:103], v12 offset:26368
s_mov_b32 s41, s43
v_mfma_f32_16x16x32_bf16 v[204:207], a[20:23], a[108:111], v[204:207]
v_mfma_f32_16x16x32_bf16 v[200:203], a[16:19], a[108:111], v[200:203]
v_mfma_f32_16x16x32_bf16 v[200:203], a[0:3], a[104:107], v[200:203]
s_waitcnt lgkmcnt(4)
v_mfma_f32_16x16x32_bf16 v[216:219], a[0:3], a[80:83], v[216:219]
ds_read_b64_tr_b16 a[104:105], v13 offset:17152
s_mov_b32 s9, 0x800
v_mfma_f32_16x16x32_bf16 v[216:219], a[16:19], a[84:87], v[216:219]
buffer_load_dword a120, v1, s[68:71], s9 offen
v_mfma_f32_16x16x32_bf16 v[220:223], a[20:23], a[84:87], v[220:223]
ds_read_b64_tr_b16 a[106:107], v13 offset:18176
v_mfma_f32_16x16x32_bf16 v[220:223], a[4:7], a[80:83], v[220:223]
ds_read_b64_tr_b16 a[108:109], v13 offset:25344
v_mfma_f32_16x16x32_bf16 v[224:227], a[8:11], a[80:83], v[224:227]
ds_read_b64_tr_b16 a[110:111], v13 offset:26368
v_add_u32 v12, 0x8000, v12
v_mfma_f32_16x16x32_bf16 v[224:227], a[24:27], a[84:87], v[224:227]
v_add_u32 v13, 0x8000, v13
v_mfma_f32_16x16x32_bf16 v[228:231], a[28:31], a[84:87], v[228:231]
v_mfma_f32_16x16x32_bf16 v[228:231], a[12:15], a[80:83], v[228:231]
v_mfma_f32_16x16x32_bf16 v[244:247], a[12:15], a[88:91], v[244:247]
s_waitcnt vmcnt(28) lgkmcnt(0)
v_mfma_f32_16x16x32_bf16 v[244:247], a[28:31], a[92:95], v[244:247]
s_barrier
s_add_u32 m0, s17, 0x8000
v_mfma_f32_16x16x32_bf16 v[240:243], a[24:27], a[92:95], v[240:243]
buffer_load_dwordx4 v5, s[56:59], 0 offen lds
v_mfma_f32_16x16x32_bf16 v[240:243], a[8:11], a[88:91], v[240:243]
ds_read_b64_tr_b16 a[80:81], v12 offset:0
v_mfma_f32_16x16x32_bf16 v[236:239], a[4:7], a[88:91], v[236:239]
ds_read_b64_tr_b16 a[82:83], v12 offset:1024
v_mfma_f32_16x16x32_bf16 v[236:239], a[20:23], a[92:95], v[236:239]
ds_read_b64_tr_b16 a[84:85], v12 offset:8192
v_mfma_f32_16x16x32_bf16 v[232:235], a[16:19], a[92:95], v[232:235]
ds_read_b64_tr_b16 a[86:87], v12 offset:9216
v_mfma_f32_16x16x32_bf16 v[232:235], a[0:3], a[88:91], v[232:235]
s_waitcnt lgkmcnt(4)
v_mfma_f32_16x16x32_bf16 v[248:251], a[0:3], a[96:99], v[248:251]
ds_read_b64_tr_b16 a[88:89], v13 offset:0
s_add_u32 m0, s17, 0xc000
v_mfma_f32_16x16x32_bf16 v[248:251], a[16:19], a[100:103], v[248:251]
buffer_load_dwordx4 v5, s[60:63], 0 offen lds
v_mfma_f32_16x16x32_bf16 v[252:255], a[20:23], a[100:103], v[252:255]
ds_read_b64_tr_b16 a[90:91], v13 offset:1024
v_mfma_f32_16x16x32_bf16 v[252:255], a[4:7], a[96:99], v[252:255]
ds_read_b64_tr_b16 a[92:93], v13 offset:8192
v_mfma_f32_16x16x32_bf16 a[232:235], a[8:11], a[96:99], a[232:235]
ds_read_b64_tr_b16 a[94:95], v13 offset:9216
v_mfma_f32_16x16x32_bf16 a[232:235], a[24:27], a[100:103], a[232:235]
v_mfma_f32_16x16x32_bf16 a[236:239], a[28:31], a[100:103], a[236:239]
v_mfma_f32_16x16x32_bf16 a[236:239], a[12:15], a[96:99], a[236:239]
s_add_u32 m0, s17, 0x8400
v_mfma_f32_16x16x32_bf16 a[252:255], a[12:15], a[104:107], a[252:255]
buffer_load_dwordx4 v5, s[56:59], s13 offen lds
v_mfma_f32_16x16x32_bf16 a[252:255], a[28:31], a[108:111], a[252:255]
ds_read_b64_tr_b16 a[96:97], v12 offset:256
v_mfma_f32_16x16x32_bf16 a[248:251], a[24:27], a[108:111], a[248:251]
ds_read_b64_tr_b16 a[98:99], v12 offset:1280
v_mfma_f32_16x16x32_bf16 a[248:251], a[8:11], a[104:107], a[248:251]
ds_read_b64_tr_b16 a[100:101], v12 offset:8448
v_mfma_f32_16x16x32_bf16 a[244:247], a[4:7], a[104:107], a[244:247]
ds_read_b64_tr_b16 a[102:103], v12 offset:9472
v_mfma_f32_16x16x32_bf16 a[244:247], a[20:23], a[108:111], a[244:247]
v_mfma_f32_16x16x32_bf16 a[240:243], a[16:19], a[108:111], a[240:243]
v_mfma_f32_16x16x32_bf16 a[240:243], a[0:3], a[104:107], a[240:243]
s_add_u32 m0, s17, 0xc400
s_waitcnt lgkmcnt(4)
L_S5:
v_mfma_f32_16x16x32_bf16 v[24:27], a[80:83], a[32:35], v[24:27]
buffer_load_dwordx4 v5, s[60:63], s13 offen lds
v_mfma_f32_16x16x32_bf16 v[24:27], a[84:87], a[48:51], v[24:27]
ds_read_b64_tr_b16 a[104:105], v13 offset:256
s_waitcnt vmcnt(23)
v_mfma_f32_16x16x32_bf16 v[32:35], a[84:87], a[52:55], v[32:35]
ds_read_b64_tr_b16 a[106:107], v13 offset:1280
v_mfma_f32_16x16x32_bf16 v[32:35], a[80:83], a[36:39], v[32:35]
ds_read_b64_tr_b16 a[108:109], v13 offset:8448
v_mfma_f32_16x16x32_bf16 v[40:43], a[80:83], a[40:43], v[40:43]
ds_read_b64_tr_b16 a[110:111], v13 offset:9472
v_mfma_f32_16x16x32_bf16 v[40:43], a[84:87], a[56:59], v[40:43]
ds_read_b128 a[0:3], v8 offset:0
v_mfma_f32_16x16x32_bf16 v[48:51], a[84:87], a[60:63], v[48:51]
ds_read_b128 a[16:19], v9 offset:0
s_add_u32 m0, s17, 0x8800
v_mfma_f32_16x16x32_bf16 v[48:51], a[80:83], a[44:47], v[48:51]
buffer_load_dwordx4 v6, s[56:59], 0 offen lds
v_mfma_f32_16x16x32_bf16 v[52:55], a[88:91], a[44:47], v[52:55]
ds_read_b64_tr_b16 a[80:81], v12 offset:512
v_mfma_f32_16x16x32_bf16 v[52:55], a[92:95], a[60:63], v[52:55]
ds_read_b64_tr_b16 a[82:83], v12 offset:1536
v_mfma_f32_16x16x32_bf16 v[44:47], a[92:95], a[56:59], v[44:47]
ds_read_b64_tr_b16 a[84:85], v12 offset:8704
v_mfma_f32_16x16x32_bf16 v[44:47], a[88:91], a[40:43], v[44:47]
ds_read_b64_tr_b16 a[86:87], v12 offset:9728
v_mfma_f32_16x16x32_bf16 v[36:39], a[88:91], a[36:39], v[36:39]
ds_read_b128 a[4:7], v8 offset:2048
v_mfma_f32_16x16x32_bf16 v[36:39], a[92:95], a[52:55], v[36:39]
ds_read_b128 a[20:23], v9 offset:2048
s_waitcnt lgkmcnt(8)
v_mfma_f32_16x16x32_bf16 v[28:31], a[92:95], a[48:51], v[28:31]
ds_read_b128 a[8:11], v8 offset:4096
s_add_u32 m0, s17, 0xc800
v_mfma_f32_16x16x32_bf16 v[28:31], a[88:91], a[32:35], v[28:31]
buffer_load_dwordx4 v6, s[60:63], 0 offen lds
v_mfma_f32_16x16x32_bf16 v[56:59], a[96:99], a[32:35], v[56:59]
ds_read_b64_tr_b16 a[88:89], v13 offset:512
v_mfma_f32_16x16x32_bf16 v[56:59], a[100:103], a[48:51], v[56:59]
ds_read_b64_tr_b16 a[90:91], v13 offset:1536
v_mfma_f32_16x16x32_bf16 v[64:67], a[100:103], a[52:55], v[64:67]
ds_read_b64_tr_b16 a[92:93], v13 offset:8704
v_mfma_f32_16x16x32_bf16 v[64:67], a[96:99], a[36:39], v[64:67]
ds_read_b64_tr_b16 a[94:95], v13 offset:9728
v_mfma_f32_16x16x32_bf16 v[72:75], a[96:99], a[40:43], v[72:75]
ds_read_b128 a[24:27], v9 offset:4096
v_mfma_f32_16x16x32_bf16 v[72:75], a[100:103], a[56:59], v[72:75]
ds_read_b128 a[12:15], v8 offset:6144
s_add_u32 m0, s17, 0x8c00
v_mfma_f32_16x16x32_bf16 v[80:83], a[100:103], a[60:63], v[80:83]
buffer_load_dwordx4 v6, s[56:59], s13 offen lds
v_mfma_f32_16x16x32_bf16 v[80:83], a[96:99], a[44:47], v[80:83]
ds_read_b128 a[28:31], v9 offset:6144
v_mfma_f32_16x16x32_bf16 v[84:87], a[104:107], a[44:47], v[84:87]
ds_read_b64_tr_b16 a[96:97], v12 offset:768
v_mfma_f32_16x16x32_bf16 v[84:87], a[108:111], a[60:63], v[84:87]
ds_read_b64_tr_b16 a[98:99], v12 offset:1792
v_mfma_f32_16x16x32_bf16 v[76:79], a[108:111], a[56:59], v[76:79]
ds_read_b64_tr_b16 a[100:101], v12 offset:8960
v_mfma_f32_16x16x32_bf16 v[76:79], a[104:107], a[40:43], v[76:79]
ds_read_b64_tr_b16 a[102:103], v12 offset:9984
v_mfma_f32_16x16x32_bf16 v[68:71], a[104:107], a[36:39], v[68:71]
s_add_u32 m0, s17, 0xcc00
v_mfma_f32_16x16x32_bf16 v[68:71], a[108:111], a[52:55], v[68:71]
buffer_load_dwordx4 v6, s[60:63], s13 offen lds
v_mfma_f32_16x16x32_bf16 v[60:63], a[108:111], a[48:51], v[60:63]
v_lshl_add_u32 v5, s42, 19, v5
v_lshl_add_u32 v6, s42, 19, v6
v_mfma_f32_16x16x32_bf16 v[60:63], a[104:107], a[32:35], v[60:63]
s_waitcnt lgkmcnt(7)
v_mfma_f32_16x16x32_bf16 v[88:91], a[80:83], a[32:35], v[88:91]
ds_read_b64_tr_b16 a[104:105], v13 offset:768
v_mfma_f32_16x16x32_bf16 v[88:91], a[84:87], a[48:51], v[88:91]
ds_read_b64_tr_b16 a[106:107], v13 offset:1792
v_mfma_f32_16x16x32_bf16 v[96:99], a[84:87], a[52:55], v[96:99]
ds_read_b64_tr_b16 a[108:109], v13 offset:8960
v_mfma_f32_16x16x32_bf16 v[96:99], a[80:83], a[36:39], v[96:99]
ds_read_b64_tr_b16 a[110:111], v13 offset:9984
v_mfma_f32_16x16x32_bf16 v[104:107], a[80:83], a[40:43], v[104:107]
s_add_u32 m0, s16, 0x0
s_waitcnt lgkmcnt(8)
v_mfma_f32_16x16x32_bf16 v[104:107], a[84:87], a[56:59], v[104:107]
buffer_load_dwordx4 v22, s[44:47], s20 offen lds
v_mfma_f32_16x16x32_bf16 v[112:115], a[84:87], a[60:63], v[112:115]
v_mfma_f32_16x16x32_bf16 v[112:115], a[80:83], a[44:47], v[112:115]
v_mfma_f32_16x16x32_bf16 v[116:119], a[88:91], a[44:47], v[116:119]
ds_read_b64_tr_b16 a[80:81], v12 offset:16384
v_mfma_f32_16x16x32_bf16 v[116:119], a[92:95], a[60:63], v[116:119]
ds_read_b64_tr_b16 a[82:83], v12 offset:17408
v_mfma_f32_16x16x32_bf16 v[108:111], a[92:95], a[56:59], v[108:111]
ds_read_b64_tr_b16 a[84:85], v12 offset:24576
v_mfma_f32_16x16x32_bf16 v[108:111], a[88:91], a[40:43], v[108:111]
ds_read_b64_tr_b16 a[86:87], v12 offset:25600
s_add_u32 m0, s16, 0x400
v_mfma_f32_16x16x32_bf16 v[100:103], a[88:91], a[36:39], v[100:103]
buffer_load_dwordx4 v23, s[44:47], s20 offen lds
v_mfma_f32_16x16x32_bf16 v[100:103], a[92:95], a[52:55], v[100:103]
v_mfma_f32_16x16x32_bf16 v[92:95], a[92:95], a[48:51], v[92:95]
v_mfma_f32_16x16x32_bf16 v[92:95], a[88:91], a[32:35], v[92:95]
s_waitcnt lgkmcnt(4)
v_mfma_f32_16x16x32_bf16 v[120:123], a[96:99], a[32:35], v[120:123]
ds_read_b64_tr_b16 a[88:89], v13 offset:16384
v_mfma_f32_16x16x32_bf16 v[120:123], a[100:103], a[48:51], v[120:123]
ds_read_b64_tr_b16 a[90:91], v13 offset:17408
v_mfma_f32_16x16x32_bf16 v[128:131], a[100:103], a[52:55], v[128:131]
ds_read_b64_tr_b16 a[92:93], v13 offset:24576
v_mfma_f32_16x16x32_bf16 v[128:131], a[96:99], a[36:39], v[128:131]
ds_read_b64_tr_b16 a[94:95], v13 offset:25600
s_add_u32 m0, s16, 0x800
v_mfma_f32_16x16x32_bf16 v[136:139], a[96:99], a[40:43], v[136:139]
buffer_load_dwordx4 v22, s[44:47], s21 offen lds
v_mfma_f32_16x16x32_bf16 v[136:139], a[100:103], a[56:59], v[136:139]
v_mfma_f32_16x16x32_bf16 v[144:147], a[100:103], a[60:63], v[144:147]
v_mfma_f32_16x16x32_bf16 v[144:147], a[96:99], a[44:47], v[144:147]
v_mfma_f32_16x16x32_bf16 v[148:151], a[104:107], a[44:47], v[148:151]
ds_read_b64_tr_b16 a[96:97], v12 offset:16640
v_mfma_f32_16x16x32_bf16 v[148:151], a[108:111], a[60:63], v[148:151]
ds_read_b64_tr_b16 a[98:99], v12 offset:17664
v_mfma_f32_16x16x32_bf16 v[140:143], a[108:111], a[56:59], v[140:143]
ds_read_b64_tr_b16 a[100:101], v12 offset:24832
s_add_u32 m0, s16, 0xc00
v_mfma_f32_16x16x32_bf16 v[140:143], a[104:107], a[40:43], v[140:143]
buffer_load_dwordx4 v23, s[44:47], s21 offen lds
v_mfma_f32_16x16x32_bf16 v[132:135], a[104:107], a[36:39], v[132:135]
ds_read_b64_tr_b16 a[102:103], v12 offset:25856
v_mfma_f32_16x16x32_bf16 v[132:135], a[108:111], a[52:55], v[132:135]
v_mfma_f32_16x16x32_bf16 v[124:127], a[108:111], a[48:51], v[124:127]
v_mfma_f32_16x16x32_bf16 v[124:127], a[104:107], a[32:35], v[124:127]
s_waitcnt lgkmcnt(4)
v_mfma_f32_16x16x32_bf16 v[152:155], a[32:35], a[80:83], v[152:155]
ds_read_b64_tr_b16 a[104:105], v13 offset:16640
v_mfma_f32_16x16x32_bf16 v[152:155], a[48:51], a[84:87], v[152:155]
ds_read_b64_tr_b16 a[106:107], v13 offset:17664
s_add_u32 m0, s16, 0x1000
v_mfma_f32_16x16x32_bf16 v[156:159], a[52:55], a[84:87], v[156:159]
buffer_load_dwordx4 v22, s[44:47], s22 offen lds
v_mfma_f32_16x16x32_bf16 v[156:159], a[36:39], a[80:83], v[156:159]
ds_read_b64_tr_b16 a[108:109], v13 offset:24832
v_mfma_f32_16x16x32_bf16 v[160:163], a[40:43], a[80:83], v[160:163]
ds_read_b64_tr_b16 a[110:111], v13 offset:25856
v_mfma_f32_16x16x32_bf16 v[160:163], a[56:59], a[84:87], v[160:163]
v_mfma_f32_16x16x32_bf16 v[164:167], a[60:63], a[84:87], v[164:167]
v_mfma_f32_16x16x32_bf16 v[164:167], a[44:47], a[80:83], v[164:167]
v_mfma_f32_16x16x32_bf16 v[180:183], a[44:47], a[88:91], v[180:183]
ds_read_b64_tr_b16 a[80:81], v12 offset:16896
v_mfma_f32_16x16x32_bf16 v[180:183], a[60:63], a[92:95], v[180:183]
ds_read_b64_tr_b16 a[82:83], v12 offset:17920
s_add_u32 m0, s16, 0x1400
v_mfma_f32_16x16x32_bf16 v[176:179], a[56:59], a[92:95], v[176:179]
buffer_load_dwordx4 v23, s[44:47], s22 offen lds
v_mfma_f32_16x16x32_bf16 v[176:179], a[40:43], a[88:91], v[176:179]
ds_read_b64_tr_b16 a[84:85], v12 offset:25088
v_mfma_f32_16x16x32_bf16 v[172:175], a[36:39], a[88:91], v[172:175]
ds_read_b64_tr_b16 a[86:87], v12 offset:26112
v_mfma_f32_16x16x32_bf16 v[172:175], a[52:55], a[92:95], v[172:175]
v_mfma_f32_16x16x32_bf16 v[168:171], a[48:51], a[92:95], v[168:171]
v_mfma_f32_16x16x32_bf16 v[168:171], a[32:35], a[88:91], v[168:171]
s_waitcnt lgkmcnt(4)
v_mfma_f32_16x16x32_bf16 v[184:187], a[32:35], a[96:99], v[184:187]
ds_read_b64_tr_b16 a[88:89], v13 offset:16896
s_add_u32 m0, s16, 0x1800
v_mfma_f32_16x16x32_bf16 v[184:187], a[48:51], a[100:103], v[184:187]
buffer_load_dwordx4 v22, s[44:47], s23 offen lds
v_mfma_f32_16x16x32_bf16 v[188:191], a[52:55], a[100:103], v[188:191]
ds_read_b64_tr_b16 a[90:91], v13 offset:17920
v_mfma_f32_16x16x32_bf16 v[188:191], a[36:39], a[96:99], v[188:191]
ds_read_b64_tr_b16 a[92:93], v13 offset:25088
v_mfma_f32_16x16x32_bf16 v[192:195], a[40:43], a[96:99], v[192:195]
ds_read_b64_tr_b16 a[94:95], v13 offset:26112
v_mfma_f32_16x16x32_bf16 v[192:195], a[56:59], a[100:103], v[192:195]
v_mfma_f32_16x16x32_bf16 v[196:199], a[60:63], a[100:103], v[196:199]
v_mfma_f32_16x16x32_bf16 v[196:199], a[44:47], a[96:99], v[196:199]
v_mfma_f32_16x16x32_bf16 v[212:215], a[44:47], a[104:107], v[212:215]
ds_read_b64_tr_b16 a[96:97], v12 offset:17152
s_add_u32 m0, s16, 0x1c00
v_mfma_f32_16x16x32_bf16 v[212:215], a[60:63], a[108:111], v[212:215]
buffer_load_dwordx4 v23, s[44:47], s23 offen lds
v_mfma_f32_16x16x32_bf16 v[208:211], a[56:59], a[108:111], v[208:211]
ds_read_b64_tr_b16 a[98:99], v12 offset:18176
s_mov_b32 s42, 1
v_mfma_f32_16x16x32_bf16 v[208:211], a[40:43], a[104:107], v[208:211]
ds_read_b64_tr_b16 a[100:101], v12 offset:25344
v_lshl_add_u32 v22, s42, 7, v22
v_mfma_f32_16x16x32_bf16 v[204:207], a[36:39], a[104:107], v[204:207]
ds_read_b64_tr_b16 a[102:103], v12 offset:26368
v_lshl_add_u32 v23, s42, 7, v23
v_mfma_f32_16x16x32_bf16 v[204:207], a[52:55], a[108:111], v[204:207]
v_mfma_f32_16x16x32_bf16 v[200:203], a[48:51], a[108:111], v[200:203]
v_mfma_f32_16x16x32_bf16 v[200:203], a[32:35], a[104:107], v[200:203]
s_mov_b32 s9, 0x1000
s_waitcnt lgkmcnt(4)
v_mfma_f32_16x16x32_bf16 v[216:219], a[32:35], a[80:83], v[216:219]
buffer_load_dword a120, v1, s[68:71], s9 offen
v_mfma_f32_16x16x32_bf16 v[216:219], a[48:51], a[84:87], v[216:219]
ds_read_b64_tr_b16 a[104:105], v13 offset:17152
v_mfma_f32_16x16x32_bf16 v[220:223], a[52:55], a[84:87], v[220:223]
ds_read_b64_tr_b16 a[106:107], v13 offset:18176
v_mfma_f32_16x16x32_bf16 v[220:223], a[36:39], a[80:83], v[220:223]
ds_read_b64_tr_b16 a[108:109], v13 offset:25344
v_mfma_f32_16x16x32_bf16 v[224:227], a[40:43], a[80:83], v[224:227]
ds_read_b64_tr_b16 a[110:111], v13 offset:26368
v_add_u32 v12, 0xffff0000, v12
v_mfma_f32_16x16x32_bf16 v[224:227], a[56:59], a[84:87], v[224:227]
v_add_u32 v13, 0xffff0000, v13
v_mfma_f32_16x16x32_bf16 v[228:231], a[60:63], a[84:87], v[228:231]
v_mfma_f32_16x16x32_bf16 v[228:231], a[44:47], a[80:83], v[228:231]
v_mfma_f32_16x16x32_bf16 v[244:247], a[44:47], a[88:91], v[244:247]
s_waitcnt vmcnt(27) lgkmcnt(0)
v_mfma_f32_16x16x32_bf16 v[244:247], a[60:63], a[92:95], v[244:247]
s_barrier
s_add_u32 m0, s17, 0x10000
v_mfma_f32_16x16x32_bf16 v[240:243], a[56:59], a[92:95], v[240:243]
buffer_load_dwordx4 v5, s[52:55], 0 offen lds
v_mfma_f32_16x16x32_bf16 v[240:243], a[40:43], a[88:91], v[240:243]
ds_read_b64_tr_b16 a[80:81], v12 offset:0
s_mul_i32 s28, s5, 0x10c400
v_mfma_f32_16x16x32_bf16 v[236:239], a[36:39], a[88:91], v[236:239]
ds_read_b64_tr_b16 a[82:83], v12 offset:1024
s_mov_b32 s48, s88
v_mfma_f32_16x16x32_bf16 v[236:239], a[52:55], a[92:95], v[236:239]
ds_read_b64_tr_b16 a[84:85], v12 offset:8192
s_mov_b32 s49, s89
v_mfma_f32_16x16x32_bf16 v[232:235], a[48:51], a[92:95], v[232:235]
ds_read_b64_tr_b16 a[86:87], v12 offset:9216
s_sub_u32 s11, 16, s6
v_mfma_f32_16x16x32_bf16 v[232:235], a[32:35], a[88:91], v[232:235]
s_waitcnt lgkmcnt(4)
s_lshl_b32 s11, s11, 16
s_add_u32 s11, s11, s28
v_mfma_f32_16x16x32_bf16 v[248:251], a[32:35], a[96:99], v[248:251]
ds_read_b64_tr_b16 a[88:89], v13 offset:0
s_add_u32 m0, s17, 0x10400
v_mfma_f32_16x16x32_bf16 v[248:251], a[48:51], a[100:103], v[248:251]
buffer_load_dwordx4 v5, s[52:55], s13 offen lds
v_mfma_f32_16x16x32_bf16 v[252:255], a[52:55], a[100:103], v[252:255]
ds_read_b64_tr_b16 a[90:91], v13 offset:1024
s_add_u32 s50, s11, 0x2000
v_mfma_f32_16x16x32_bf16 v[252:255], a[36:39], a[96:99], v[252:255]
ds_read_b64_tr_b16 a[92:93], v13 offset:8192
s_lshl_b32 s11, s6, 17
v_mfma_f32_16x16x32_bf16 a[232:235], a[40:43], a[96:99], a[232:235]
ds_read_b64_tr_b16 a[94:95], v13 offset:9216
s_add_u32 s28, s28, s11
v_mfma_f32_16x16x32_bf16 a[232:235], a[56:59], a[100:103], a[232:235]
s_lshl_b32 s11, s4, 15
s_add_u32 s28, s28, s11
s_lshl_b32 s10, s5, 2
v_mfma_f32_16x16x32_bf16 a[236:239], a[60:63], a[100:103], a[236:239]
s_add_u32 s10, s10, 64
v_mfma_f32_16x16x32_bf16 a[236:239], a[44:47], a[96:99], a[236:239]
L_padA3:
s_cmp_eq_u32 s95, 1
s_cbranch_scc1 L_padA7
s_add_u32 m0, s17, 0x10800
v_mfma_f32_16x16x32_bf16 a[252:255], a[44:47], a[104:107], a[252:255]
buffer_load_dwordx4 v6, s[52:55], 0 offen lds
v_mfma_f32_16x16x32_bf16 a[252:255], a[60:63], a[108:111], a[252:255]
ds_read_b64_tr_b16 a[96:97], v12 offset:256
v_mfma_f32_16x16x32_bf16 a[248:251], a[56:59], a[108:111], a[248:251]
ds_read_b64_tr_b16 a[98:99], v12 offset:1280
v_mfma_f32_16x16x32_bf16 a[248:251], a[40:43], a[104:107], a[248:251]
ds_read_b64_tr_b16 a[100:101], v12 offset:8448
v_mfma_f32_16x16x32_bf16 a[244:247], a[36:39], a[104:107], a[244:247]
ds_read_b64_tr_b16 a[102:103], v12 offset:9472
v_mfma_f32_16x16x32_bf16 a[244:247], a[52:55], a[108:111], a[244:247]
v_mfma_f32_16x16x32_bf16 a[240:243], a[48:51], a[108:111], a[240:243]
v_mfma_f32_16x16x32_bf16 a[240:243], a[32:35], a[104:107], a[240:243]
s_add_u32 m0, s17, 0x10c00
s_waitcnt lgkmcnt(4)
L_S6:
v_mfma_f32_16x16x32_bf16 v[24:27], a[80:83], a[0:3], v[24:27]
buffer_load_dwordx4 v6, s[52:55], s13 offen lds
v_mfma_f32_16x16x32_bf16 v[24:27], a[84:87], a[16:19], v[24:27]
ds_read_b64_tr_b16 a[104:105], v13 offset:256
s_waitcnt vmcnt(22)
v_mfma_f32_16x16x32_bf16 v[32:35], a[84:87], a[20:23], v[32:35]
ds_read_b64_tr_b16 a[106:107], v13 offset:1280
v_mfma_f32_16x16x32_bf16 v[32:35], a[80:83], a[4:7], v[32:35]
ds_read_b64_tr_b16 a[108:109], v13 offset:8448
v_mfma_f32_16x16x32_bf16 v[40:43], a[80:83], a[8:11], v[40:43]
ds_read_b64_tr_b16 a[110:111], v13 offset:9472
v_mfma_f32_16x16x32_bf16 v[40:43], a[84:87], a[24:27], v[40:43]
ds_read_b128 a[32:35], v8 offset:32768
v_mfma_f32_16x16x32_bf16 v[48:51], a[84:87], a[28:31], v[48:51]
ds_read_b128 a[48:51], v9 offset:32768
s_add_u32 m0, s18, 0x14000
v_mfma_f32_16x16x32_bf16 v[48:51], a[80:83], a[12:15], v[48:51]
buffer_load_dwordx4 v7, s[68:71], 0 offen lds
v_mfma_f32_16x16x32_bf16 v[52:55], a[88:91], a[12:15], v[52:55]
ds_read_b64_tr_b16 a[80:81], v12 offset:512
v_mfma_f32_16x16x32_bf16 v[52:55], a[92:95], a[28:31], v[52:55]
ds_read_b64_tr_b16 a[82:83], v12 offset:1536
v_mfma_f32_16x16x32_bf16 v[44:47], a[92:95], a[24:27], v[44:47]
ds_read_b64_tr_b16 a[84:85], v12 offset:8704
v_mfma_f32_16x16x32_bf16 v[44:47], a[88:91], a[8:11], v[44:47]
ds_read_b64_tr_b16 a[86:87], v12 offset:9728
v_mfma_f32_16x16x32_bf16 v[36:39], a[88:91], a[4:7], v[36:39]
ds_read_b128 a[36:39], v8 offset:34816
v_mfma_f32_16x16x32_bf16 v[36:39], a[92:95], a[20:23], v[36:39]
ds_read_b128 a[52:55], v9 offset:34816
s_waitcnt lgkmcnt(8)
v_mfma_f32_16x16x32_bf16 v[28:31], a[92:95], a[16:19], v[28:31]
ds_read_b128 a[40:43], v8 offset:36864
s_add_u32 m0, s18, 0x15000
v_mfma_f32_16x16x32_bf16 v[28:31], a[88:91], a[0:3], v[28:31]
buffer_load_dwordx4 v7, s[68:71], s25 offen lds
v_mfma_f32_16x16x32_bf16 v[56:59], a[96:99], a[0:3], v[56:59]
ds_read_b64_tr_b16 a[88:89], v13 offset:512
v_mfma_f32_16x16x32_bf16 v[56:59], a[100:103], a[16:19], v[56:59]
ds_read_b64_tr_b16 a[90:91], v13 offset:1536
v_mfma_f32_16x16x32_bf16 v[64:67], a[100:103], a[20:23], v[64:67]
ds_read_b64_tr_b16 a[92:93], v13 offset:8704
v_mfma_f32_16x16x32_bf16 v[64:67], a[96:99], a[4:7], v[64:67]
ds_read_b64_tr_b16 a[94:95], v13 offset:9728
v_mfma_f32_16x16x32_bf16 v[72:75], a[96:99], a[8:11], v[72:75]
ds_read_b128 a[56:59], v9 offset:36864
v_mfma_f32_16x16x32_bf16 v[72:75], a[100:103], a[24:27], v[72:75]
ds_read_b128 a[44:47], v8 offset:38912
s_add_u32 m0, s18, 0x16000
v_mfma_f32_16x16x32_bf16 v[80:83], a[100:103], a[28:31], v[80:83]
buffer_load_dwordx4 v7, s[68:71], s26 offen lds
v_mfma_f32_16x16x32_bf16 v[80:83], a[96:99], a[12:15], v[80:83]
ds_read_b128 a[60:63], v9 offset:38912
v_lshl_add_u32 v5, s42, 19, v5
v_mfma_f32_16x16x32_bf16 v[84:87], a[104:107], a[12:15], v[84:87]
ds_read_b64_tr_b16 a[96:97], v12 offset:768
v_lshl_add_u32 v6, s42, 19, v6
v_mfma_f32_16x16x32_bf16 v[84:87], a[108:111], a[28:31], v[84:87]
ds_read_b64_tr_b16 a[98:99], v12 offset:1792
v_lshl_add_u32 v7, s42, 18, v7
v_mfma_f32_16x16x32_bf16 v[76:79], a[108:111], a[24:27], v[76:79]
ds_read_b64_tr_b16 a[100:101], v12 offset:8960
v_lshl_add_u32 v7, s42, 17, v7
v_mfma_f32_16x16x32_bf16 v[76:79], a[104:107], a[8:11], v[76:79]
ds_read_b64_tr_b16 a[102:103], v12 offset:9984
v_mfma_f32_16x16x32_bf16 v[68:71], a[104:107], a[4:7], v[68:71]
v_mfma_f32_16x16x32_bf16 v[68:71], a[108:111], a[20:23], v[68:71]
buffer_store_dwordx4 a[64:67], v4, s[88:91], 0 offen sc1
v_mfma_f32_16x16x32_bf16 v[60:63], a[108:111], a[16:19], v[60:63]
v_mfma_f32_16x16x32_bf16 v[60:63], a[104:107], a[0:3], v[60:63]
s_waitcnt lgkmcnt(7)
v_mfma_f32_16x16x32_bf16 v[88:91], a[80:83], a[0:3], v[88:91]
ds_read_b64_tr_b16 a[104:105], v13 offset:768
v_mfma_f32_16x16x32_bf16 v[88:91], a[84:87], a[16:19], v[88:91]
ds_read_b64_tr_b16 a[106:107], v13 offset:1792
v_mfma_f32_16x16x32_bf16 v[96:99], a[84:87], a[20:23], v[96:99]
ds_read_b64_tr_b16 a[108:109], v13 offset:8960
v_mfma_f32_16x16x32_bf16 v[96:99], a[80:83], a[4:7], v[96:99]
ds_read_b64_tr_b16 a[110:111], v13 offset:9984
v_mfma_f32_16x16x32_bf16 v[104:107], a[80:83], a[8:11], v[104:107]
s_add_u32 m0, s16, 0x8000
s_waitcnt lgkmcnt(8)
v_mfma_f32_16x16x32_bf16 v[104:107], a[84:87], a[24:27], v[104:107]
buffer_load_dwordx4 v22, s[44:47], s20 offen lds
v_mfma_f32_16x16x32_bf16 v[112:115], a[84:87], a[28:31], v[112:115]
v_mfma_f32_16x16x32_bf16 v[112:115], a[80:83], a[12:15], v[112:115]
v_mfma_f32_16x16x32_bf16 v[116:119], a[88:91], a[12:15], v[116:119]
ds_read_b64_tr_b16 a[80:81], v12 offset:16384
v_mfma_f32_16x16x32_bf16 v[116:119], a[92:95], a[28:31], v[116:119]
ds_read_b64_tr_b16 a[82:83], v12 offset:17408
v_mfma_f32_16x16x32_bf16 v[108:111], a[92:95], a[24:27], v[108:111]
ds_read_b64_tr_b16 a[84:85], v12 offset:24576
v_mfma_f32_16x16x32_bf16 v[108:111], a[88:91], a[8:11], v[108:111]
ds_read_b64_tr_b16 a[86:87], v12 offset:25600
s_add_u32 m0, s16, 0x8400
v_mfma_f32_16x16x32_bf16 v[100:103], a[88:91], a[4:7], v[100:103]
buffer_load_dwordx4 v23, s[44:47], s20 offen lds
v_mfma_f32_16x16x32_bf16 v[100:103], a[92:95], a[20:23], v[100:103]
v_mfma_f32_16x16x32_bf16 v[92:95], a[92:95], a[16:19], v[92:95]
v_mfma_f32_16x16x32_bf16 v[92:95], a[88:91], a[0:3], v[92:95]
s_waitcnt lgkmcnt(4)
v_mfma_f32_16x16x32_bf16 v[120:123], a[96:99], a[0:3], v[120:123]
ds_read_b64_tr_b16 a[88:89], v13 offset:16384
v_mfma_f32_16x16x32_bf16 v[120:123], a[100:103], a[16:19], v[120:123]
ds_read_b64_tr_b16 a[90:91], v13 offset:17408
v_mfma_f32_16x16x32_bf16 v[128:131], a[100:103], a[20:23], v[128:131]
ds_read_b64_tr_b16 a[92:93], v13 offset:24576
v_mfma_f32_16x16x32_bf16 v[128:131], a[96:99], a[4:7], v[128:131]
ds_read_b64_tr_b16 a[94:95], v13 offset:25600
s_add_u32 m0, s16, 0x8800
v_mfma_f32_16x16x32_bf16 v[136:139], a[96:99], a[8:11], v[136:139]
buffer_load_dwordx4 v22, s[44:47], s21 offen lds
v_mfma_f32_16x16x32_bf16 v[136:139], a[100:103], a[24:27], v[136:139]
v_mfma_f32_16x16x32_bf16 v[144:147], a[100:103], a[28:31], v[144:147]
v_mfma_f32_16x16x32_bf16 v[144:147], a[96:99], a[12:15], v[144:147]
v_mfma_f32_16x16x32_bf16 v[148:151], a[104:107], a[12:15], v[148:151]
ds_read_b64_tr_b16 a[96:97], v12 offset:16640
v_mfma_f32_16x16x32_bf16 v[148:151], a[108:111], a[28:31], v[148:151]
ds_read_b64_tr_b16 a[98:99], v12 offset:17664
v_mfma_f32_16x16x32_bf16 v[140:143], a[108:111], a[24:27], v[140:143]
ds_read_b64_tr_b16 a[100:101], v12 offset:24832
s_add_u32 m0, s16, 0x8c00
v_mfma_f32_16x16x32_bf16 v[140:143], a[104:107], a[8:11], v[140:143]
buffer_load_dwordx4 v23, s[44:47], s21 offen lds
v_mfma_f32_16x16x32_bf16 v[132:135], a[104:107], a[4:7], v[132:135]
ds_read_b64_tr_b16 a[102:103], v12 offset:25856
v_mfma_f32_16x16x32_bf16 v[132:135], a[108:111], a[20:23], v[132:135]
v_mfma_f32_16x16x32_bf16 v[124:127], a[108:111], a[16:19], v[124:127]
v_mfma_f32_16x16x32_bf16 v[124:127], a[104:107], a[0:3], v[124:127]
s_waitcnt lgkmcnt(4)
v_mfma_f32_16x16x32_bf16 v[152:155], a[0:3], a[80:83], v[152:155]
ds_read_b64_tr_b16 a[104:105], v13 offset:16640
v_mfma_f32_16x16x32_bf16 v[152:155], a[16:19], a[84:87], v[152:155]
ds_read_b64_tr_b16 a[106:107], v13 offset:17664
s_add_u32 m0, s16, 0x9000
v_mfma_f32_16x16x32_bf16 v[156:159], a[20:23], a[84:87], v[156:159]
buffer_load_dwordx4 v22, s[44:47], s22 offen lds
v_mfma_f32_16x16x32_bf16 v[156:159], a[4:7], a[80:83], v[156:159]
ds_read_b64_tr_b16 a[108:109], v13 offset:24832
v_mfma_f32_16x16x32_bf16 v[160:163], a[8:11], a[80:83], v[160:163]
ds_read_b64_tr_b16 a[110:111], v13 offset:25856
v_mfma_f32_16x16x32_bf16 v[160:163], a[24:27], a[84:87], v[160:163]
v_mfma_f32_16x16x32_bf16 v[164:167], a[28:31], a[84:87], v[164:167]
v_mfma_f32_16x16x32_bf16 v[164:167], a[12:15], a[80:83], v[164:167]
v_mfma_f32_16x16x32_bf16 v[180:183], a[12:15], a[88:91], v[180:183]
ds_read_b64_tr_b16 a[80:81], v12 offset:16896
v_mfma_f32_16x16x32_bf16 v[180:183], a[28:31], a[92:95], v[180:183]
ds_read_b64_tr_b16 a[82:83], v12 offset:17920
s_add_u32 m0, s16, 0x9400
v_mfma_f32_16x16x32_bf16 v[176:179], a[24:27], a[92:95], v[176:179]
buffer_load_dwordx4 v23, s[44:47], s22 offen lds
v_mfma_f32_16x16x32_bf16 v[176:179], a[8:11], a[88:91], v[176:179]
ds_read_b64_tr_b16 a[84:85], v12 offset:25088
v_mfma_f32_16x16x32_bf16 v[172:175], a[4:7], a[88:91], v[172:175]
ds_read_b64_tr_b16 a[86:87], v12 offset:26112
v_mfma_f32_16x16x32_bf16 v[172:175], a[20:23], a[92:95], v[172:175]
v_mfma_f32_16x16x32_bf16 v[168:171], a[16:19], a[92:95], v[168:171]
v_mfma_f32_16x16x32_bf16 v[168:171], a[0:3], a[88:91], v[168:171]
s_waitcnt lgkmcnt(4)
v_mfma_f32_16x16x32_bf16 v[184:187], a[0:3], a[96:99], v[184:187]
ds_read_b64_tr_b16 a[88:89], v13 offset:16896
s_add_u32 m0, s16, 0x9800
v_mfma_f32_16x16x32_bf16 v[184:187], a[16:19], a[100:103], v[184:187]
buffer_load_dwordx4 v22, s[44:47], s23 offen lds
v_mfma_f32_16x16x32_bf16 v[188:191], a[20:23], a[100:103], v[188:191]
ds_read_b64_tr_b16 a[90:91], v13 offset:17920
v_mfma_f32_16x16x32_bf16 v[188:191], a[4:7], a[96:99], v[188:191]
ds_read_b64_tr_b16 a[92:93], v13 offset:25088
v_mfma_f32_16x16x32_bf16 v[192:195], a[8:11], a[96:99], v[192:195]
ds_read_b64_tr_b16 a[94:95], v13 offset:26112
v_mfma_f32_16x16x32_bf16 v[192:195], a[24:27], a[100:103], v[192:195]
v_mfma_f32_16x16x32_bf16 v[196:199], a[28:31], a[100:103], v[196:199]
v_mfma_f32_16x16x32_bf16 v[196:199], a[12:15], a[96:99], v[196:199]
v_mfma_f32_16x16x32_bf16 v[212:215], a[12:15], a[104:107], v[212:215]
ds_read_b64_tr_b16 a[96:97], v12 offset:17152
s_add_u32 m0, s16, 0x9c00
v_mfma_f32_16x16x32_bf16 v[212:215], a[28:31], a[108:111], v[212:215]
buffer_load_dwordx4 v23, s[44:47], s23 offen lds
v_mfma_f32_16x16x32_bf16 v[208:211], a[24:27], a[108:111], v[208:211]
ds_read_b64_tr_b16 a[98:99], v12 offset:18176
v_lshl_add_u32 v22, s42, 7, v22
v_mfma_f32_16x16x32_bf16 v[208:211], a[8:11], a[104:107], v[208:211]
ds_read_b64_tr_b16 a[100:101], v12 offset:25344
v_lshl_add_u32 v23, s42, 7, v23
v_mfma_f32_16x16x32_bf16 v[204:207], a[4:7], a[104:107], v[204:207]
ds_read_b64_tr_b16 a[102:103], v12 offset:26368
v_mfma_f32_16x16x32_bf16 v[204:207], a[20:23], a[108:111], v[204:207]
v_mfma_f32_16x16x32_bf16 v[200:203], a[16:19], a[108:111], v[200:203]
v_mfma_f32_16x16x32_bf16 v[200:203], a[0:3], a[104:107], v[200:203]
s_mov_b32 s9, 0x200000
s_waitcnt lgkmcnt(4)
v_mfma_f32_16x16x32_bf16 v[216:219], a[0:3], a[80:83], v[216:219]
buffer_load_dword a120, v18, s[52:55], s9 offen
v_mfma_f32_16x16x32_bf16 v[216:219], a[16:19], a[84:87], v[216:219]
ds_read_b64_tr_b16 a[104:105], v13 offset:17152
v_mfma_f32_16x16x32_bf16 v[220:223], a[20:23], a[84:87], v[220:223]
ds_read_b64_tr_b16 a[106:107], v13 offset:18176
v_mfma_f32_16x16x32_bf16 v[220:223], a[4:7], a[80:83], v[220:223]
ds_read_b64_tr_b16 a[108:109], v13 offset:25344
v_mfma_f32_16x16x32_bf16 v[224:227], a[8:11], a[80:83], v[224:227]
ds_read_b64_tr_b16 a[110:111], v13 offset:26368
v_add_u32 v12, 0x8000, v12
v_mfma_f32_16x16x32_bf16 v[224:227], a[24:27], a[84:87], v[224:227]
v_add_u32 v13, 0x8000, v13
v_mfma_f32_16x16x32_bf16 v[228:231], a[28:31], a[84:87], v[228:231]
v_mfma_f32_16x16x32_bf16 v[228:231], a[12:15], a[80:83], v[228:231]
v_mfma_f32_16x16x32_bf16 v[244:247], a[12:15], a[88:91], v[244:247]
s_waitcnt vmcnt(26) lgkmcnt(0)
v_mfma_f32_16x16x32_bf16 v[244:247], a[28:31], a[92:95], v[244:247]
s_barrier
s_add_u32 m0, s17, 0x0
v_mfma_f32_16x16x32_bf16 v[240:243], a[24:27], a[92:95], v[240:243]
buffer_load_dwordx4 v5, s[52:55], 0 offen lds
v_mfma_f32_16x16x32_bf16 v[240:243], a[8:11], a[88:91], v[240:243]
ds_read_b64_tr_b16 a[80:81], v12 offset:0
v_mfma_f32_16x16x32_bf16 v[236:239], a[4:7], a[88:91], v[236:239]
ds_read_b64_tr_b16 a[82:83], v12 offset:1024
v_mfma_f32_16x16x32_bf16 v[236:239], a[20:23], a[92:95], v[236:239]
ds_read_b64_tr_b16 a[84:85], v12 offset:8192
v_mfma_f32_16x16x32_bf16 v[232:235], a[16:19], a[92:95], v[232:235]
ds_read_b64_tr_b16 a[86:87], v12 offset:9216
v_mfma_f32_16x16x32_bf16 v[232:235], a[0:3], a[88:91], v[232:235]
s_waitcnt lgkmcnt(4)
v_mfma_f32_16x16x32_bf16 v[248:251], a[0:3], a[96:99], v[248:251]
ds_read_b64_tr_b16 a[88:89], v13 offset:0
s_add_u32 m0, s17, 0x400
v_mfma_f32_16x16x32_bf16 v[248:251], a[16:19], a[100:103], v[248:251]
buffer_load_dwordx4 v5, s[52:55], s13 offen lds
v_mfma_f32_16x16x32_bf16 v[252:255], a[20:23], a[100:103], v[252:255]
ds_read_b64_tr_b16 a[90:91], v13 offset:1024
v_mfma_f32_16x16x32_bf16 v[252:255], a[4:7], a[96:99], v[252:255]
ds_read_b64_tr_b16 a[92:93], v13 offset:8192
v_mfma_f32_16x16x32_bf16 a[232:235], a[8:11], a[96:99], a[232:235]
ds_read_b64_tr_b16 a[94:95], v13 offset:9216
v_mfma_f32_16x16x32_bf16 a[232:235], a[24:27], a[100:103], a[232:235]
v_mfma_f32_16x16x32_bf16 a[236:239], a[28:31], a[100:103], a[236:239]
v_mfma_f32_16x16x32_bf16 a[236:239], a[12:15], a[96:99], a[236:239]
s_add_u32 m0, s17, 0x800
v_mfma_f32_16x16x32_bf16 a[252:255], a[12:15], a[104:107], a[252:255]
buffer_load_dwordx4 v6, s[52:55], 0 offen lds
v_mfma_f32_16x16x32_bf16 a[252:255], a[28:31], a[108:111], a[252:255]
ds_read_b64_tr_b16 a[96:97], v12 offset:256
v_mfma_f32_16x16x32_bf16 a[248:251], a[24:27], a[108:111], a[248:251]
ds_read_b64_tr_b16 a[98:99], v12 offset:1280
v_mfma_f32_16x16x32_bf16 a[248:251], a[8:11], a[104:107], a[248:251]
ds_read_b64_tr_b16 a[100:101], v12 offset:8448
v_mfma_f32_16x16x32_bf16 a[244:247], a[4:7], a[104:107], a[244:247]
ds_read_b64_tr_b16 a[102:103], v12 offset:9472
v_mfma_f32_16x16x32_bf16 a[244:247], a[20:23], a[108:111], a[244:247]
v_mfma_f32_16x16x32_bf16 a[240:243], a[16:19], a[108:111], a[240:243]
v_mfma_f32_16x16x32_bf16 a[240:243], a[0:3], a[104:107], a[240:243]
s_add_u32 m0, s17, 0xc00
s_waitcnt lgkmcnt(4)
L_S7:
v_mfma_f32_16x16x32_bf16 v[24:27], a[80:83], a[32:35], v[24:27]
buffer_load_dwordx4 v6, s[52:55], s13 offen lds
v_mfma_f32_16x16x32_bf16 v[24:27], a[84:87], a[48:51], v[24:27]
ds_read_b64_tr_b16 a[104:105], v13 offset:256
s_waitcnt vmcnt(22)
v_mfma_f32_16x16x32_bf16 v[32:35], a[84:87], a[52:55], v[32:35]
ds_read_b64_tr_b16 a[106:107], v13 offset:1280
v_mfma_f32_16x16x32_bf16 v[32:35], a[80:83], a[36:39], v[32:35]
ds_read_b64_tr_b16 a[108:109], v13 offset:8448
v_mfma_f32_16x16x32_bf16 v[40:43], a[80:83], a[40:43], v[40:43]
ds_read_b64_tr_b16 a[110:111], v13 offset:9472
v_mfma_f32_16x16x32_bf16 v[40:43], a[84:87], a[56:59], v[40:43]
ds_read_b128 a[0:3], v8 offset:0
v_mfma_f32_16x16x32_bf16 v[48:51], a[84:87], a[60:63], v[48:51]
ds_read_b128 a[16:19], v9 offset:0
s_add_u32 m0, s18, 0x4000
v_mfma_f32_16x16x32_bf16 v[48:51], a[80:83], a[44:47], v[48:51]
buffer_load_dwordx4 v7, s[68:71], 0 offen lds
v_mfma_f32_16x16x32_bf16 v[52:55], a[88:91], a[44:47], v[52:55]
ds_read_b64_tr_b16 a[80:81], v12 offset:512
v_mfma_f32_16x16x32_bf16 v[52:55], a[92:95], a[60:63], v[52:55]
ds_read_b64_tr_b16 a[82:83], v12 offset:1536
v_mfma_f32_16x16x32_bf16 v[44:47], a[92:95], a[56:59], v[44:47]
ds_read_b64_tr_b16 a[84:85], v12 offset:8704
v_mfma_f32_16x16x32_bf16 v[44:47], a[88:91], a[40:43], v[44:47]
ds_read_b64_tr_b16 a[86:87], v12 offset:9728
v_mfma_f32_16x16x32_bf16 v[36:39], a[88:91], a[36:39], v[36:39]
ds_read_b128 a[4:7], v8 offset:2048
v_mfma_f32_16x16x32_bf16 v[36:39], a[92:95], a[52:55], v[36:39]
ds_read_b128 a[20:23], v9 offset:2048
s_waitcnt lgkmcnt(8)
v_mfma_f32_16x16x32_bf16 v[28:31], a[92:95], a[48:51], v[28:31]
ds_read_b128 a[8:11], v8 offset:4096
s_add_u32 m0, s18, 0x5000
v_mfma_f32_16x16x32_bf16 v[28:31], a[88:91], a[32:35], v[28:31]
buffer_load_dwordx4 v7, s[68:71], s25 offen lds
v_mfma_f32_16x16x32_bf16 v[56:59], a[96:99], a[32:35], v[56:59]
ds_read_b64_tr_b16 a[88:89], v13 offset:512
v_mfma_f32_16x16x32_bf16 v[56:59], a[100:103], a[48:51], v[56:59]
ds_read_b64_tr_b16 a[90:91], v13 offset:1536
v_mfma_f32_16x16x32_bf16 v[64:67], a[100:103], a[52:55], v[64:67]
ds_read_b64_tr_b16 a[92:93], v13 offset:8704
v_mfma_f32_16x16x32_bf16 v[64:67], a[96:99], a[36:39], v[64:67]
ds_read_b64_tr_b16 a[94:95], v13 offset:9728
v_cvt_pk_bf16_f32 v24, v24, v25
v_cvt_pk_bf16_f32 v25, v26, v27
v_mfma_f32_16x16x32_bf16 v[72:75], a[96:99], a[40:43], v[72:75]
ds_read_b128 a[24:27], v9 offset:4096
v_cvt_pk_bf16_f32 v26, v28, v29
v_mfma_f32_16x16x32_bf16 v[72:75], a[100:103], a[56:59], v[72:75]
ds_read_b128 a[12:15], v8 offset:6144
s_add_u32 m0, s18, 0x6000
v_mfma_f32_16x16x32_bf16 v[80:83], a[100:103], a[60:63], v[80:83]
buffer_load_dwordx4 v7, s[68:71], s26 offen lds
v_cvt_pk_bf16_f32 v27, v30, v31
v_mfma_f32_16x16x32_bf16 v[80:83], a[96:99], a[44:47], v[80:83]
ds_read_b128 a[28:31], v9 offset:6144
v_lshl_add_u32 v5, s42, 19, v5
v_mfma_f32_16x16x32_bf16 v[84:87], a[104:107], a[44:47], v[84:87]
ds_read_b64_tr_b16 a[96:97], v12 offset:768
v_lshl_add_u32 v6, s42, 19, v6
v_mfma_f32_16x16x32_bf16 v[84:87], a[108:111], a[60:63], v[84:87]
ds_read_b64_tr_b16 a[98:99], v12 offset:1792
v_lshl_add_u32 v7, s42, 18, v7
v_accvgpr_write_b32 a128, v24
v_mfma_f32_16x16x32_bf16 v[76:79], a[108:111], a[56:59], v[76:79]
ds_read_b64_tr_b16 a[100:101], v12 offset:8960
v_lshl_add_u32 v7, s42, 17, v7
v_mfma_f32_16x16x32_bf16 v[76:79], a[104:107], a[40:43], v[76:79]
ds_read_b64_tr_b16 a[102:103], v12 offset:9984
v_accvgpr_write_b32 a129, v25
v_mfma_f32_16x16x32_bf16 v[68:71], a[104:107], a[36:39], v[68:71]
s_mov_b32 s9, 0x400000
v_accvgpr_write_b32 a130, v26
v_accvgpr_write_b32 a131, v27
v_cvt_pk_bf16_f32 v32, v32, v33
v_mfma_f32_16x16x32_bf16 v[68:71], a[108:111], a[52:55], v[68:71]
buffer_load_dword a120, v18, s[52:55], s9 offen
v_mfma_f32_16x16x32_bf16 v[60:63], a[108:111], a[48:51], v[60:63]
v_cvt_pk_bf16_f32 v33, v34, v35
v_cvt_pk_bf16_f32 v34, v36, v37
v_mfma_f32_16x16x32_bf16 v[60:63], a[104:107], a[32:35], v[60:63]
s_waitcnt lgkmcnt(7)
v_cvt_pk_bf16_f32 v35, v38, v39
v_accvgpr_write_b32 a132, v32
v_accvgpr_write_b32 a133, v33
v_mfma_f32_16x16x32_bf16 v[88:91], a[80:83], a[32:35], v[88:91]
ds_read_b64_tr_b16 a[104:105], v13 offset:768
v_accvgpr_write_b32 a134, v34
v_mfma_f32_16x16x32_bf16 v[88:91], a[84:87], a[48:51], v[88:91]
ds_read_b64_tr_b16 a[106:107], v13 offset:1792
v_accvgpr_write_b32 a135, v35
v_mfma_f32_16x16x32_bf16 v[96:99], a[84:87], a[52:55], v[96:99]
ds_read_b64_tr_b16 a[108:109], v13 offset:8960
v_cvt_pk_bf16_f32 v40, v40, v41
v_cvt_pk_bf16_f32 v41, v42, v43
v_mfma_f32_16x16x32_bf16 v[96:99], a[80:83], a[36:39], v[96:99]
ds_read_b64_tr_b16 a[110:111], v13 offset:9984
v_cvt_pk_bf16_f32 v42, v44, v45
v_mfma_f32_16x16x32_bf16 v[104:107], a[80:83], a[40:43], v[104:107]
s_add_u32 m0, s16, 0x0
s_waitcnt lgkmcnt(8)
v_cvt_pk_bf16_f32 v43, v46, v47
v_mfma_f32_16x16x32_bf16 v[104:107], a[84:87], a[56:59], v[104:107]
buffer_load_dwordx4 v22, s[44:47], s20 offen lds
v_accvgpr_write_b32 a136, v40
v_mfma_f32_16x16x32_bf16 v[112:115], a[84:87], a[60:63], v[112:115]
v_accvgpr_write_b32 a137, v41
v_accvgpr_write_b32 a138, v42
v_mfma_f32_16x16x32_bf16 v[112:115], a[80:83], a[44:47], v[112:115]
v_accvgpr_write_b32 a139, v43
v_cvt_pk_bf16_f32 v48, v48, v49
v_mfma_f32_16x16x32_bf16 v[116:119], a[88:91], a[44:47], v[116:119]
ds_read_b64_tr_b16 a[80:81], v12 offset:16384
v_cvt_pk_bf16_f32 v49, v50, v51
v_cvt_pk_bf16_f32 v50, v52, v53
v_mfma_f32_16x16x32_bf16 v[116:119], a[92:95], a[60:63], v[116:119]
ds_read_b64_tr_b16 a[82:83], v12 offset:17408
v_cvt_pk_bf16_f32 v51, v54, v55
v_mfma_f32_16x16x32_bf16 v[108:111], a[92:95], a[56:59], v[108:111]
ds_read_b64_tr_b16 a[84:85], v12 offset:24576
v_accvgpr_write_b32 a140, v48
v_mfma_f32_16x16x32_bf16 v[108:111], a[88:91], a[40:43], v[108:111]
ds_read_b64_tr_b16 a[86:87], v12 offset:25600
s_add_u32 m0, s16, 0x400
v_accvgpr_write_b32 a141, v49
v_mfma_f32_16x16x32_bf16 v[100:103], a[88:91], a[36:39], v[100:103]
buffer_load_dwordx4 v23, s[44:47], s20 offen lds
v_mfma_f32_16x16x32_bf16 v[100:103], a[92:95], a[52:55], v[100:103]
v_accvgpr_write_b32 a142, v50
v_accvgpr_write_b32 a143, v51
v_mfma_f32_16x16x32_bf16 v[92:95], a[92:95], a[48:51], v[92:95]
v_cvt_pk_bf16_f32 v56, v56, v57
v_cvt_pk_bf16_f32 v57, v58, v59
v_cvt_pk_bf16_f32 v58, v60, v61
v_mfma_f32_16x16x32_bf16 v[92:95], a[88:91], a[32:35], v[92:95]
s_waitcnt lgkmcnt(4)
v_cvt_pk_bf16_f32 v59, v62, v63
v_accvgpr_write_b32 a144, v56
v_mfma_f32_16x16x32_bf16 v[120:123], a[96:99], a[32:35], v[120:123]
ds_read_b64_tr_b16 a[88:89], v13 offset:16384
v_accvgpr_write_b32 a145, v57
v_mfma_f32_16x16x32_bf16 v[120:123], a[100:103], a[48:51], v[120:123]
ds_read_b64_tr_b16 a[90:91], v13 offset:17408
v_accvgpr_write_b32 a146, v58
v_accvgpr_write_b32 a147, v59
v_mfma_f32_16x16x32_bf16 v[128:131], a[100:103], a[52:55], v[128:131]
ds_read_b64_tr_b16 a[92:93], v13 offset:24576
v_cvt_pk_bf16_f32 v64, v64, v65
v_mfma_f32_16x16x32_bf16 v[128:131], a[96:99], a[36:39], v[128:131]
ds_read_b64_tr_b16 a[94:95], v13 offset:25600
s_add_u32 m0, s16, 0x800
v_mfma_f32_16x16x32_bf16 v[136:139], a[96:99], a[40:43], v[136:139]
buffer_load_dwordx4 v22, s[44:47], s21 offen lds
v_cvt_pk_bf16_f32 v65, v66, v67
v_mfma_f32_16x16x32_bf16 v[136:139], a[100:103], a[56:59], v[136:139]
v_cvt_pk_bf16_f32 v66, v68, v69
v_cvt_pk_bf16_f32 v67, v70, v71
v_mfma_f32_16x16x32_bf16 v[144:147], a[100:103], a[60:63], v[144:147]
v_accvgpr_write_b32 a148, v64
v_accvgpr_write_b32 a149, v65
v_mfma_f32_16x16x32_bf16 v[144:147], a[96:99], a[44:47], v[144:147]
v_accvgpr_write_b32 a150, v66
v_accvgpr_write_b32 a151, v67
v_cvt_pk_bf16_f32 v72, v72, v73
v_mfma_f32_16x16x32_bf16 v[148:151], a[104:107], a[44:47], v[148:151]
ds_read_b64_tr_b16 a[96:97], v12 offset:16640
v_cvt_pk_bf16_f32 v73, v74, v75
v_mfma_f32_16x16x32_bf16 v[148:151], a[108:111], a[60:63], v[148:151]
ds_read_b64_tr_b16 a[98:99], v12 offset:17664
v_cvt_pk_bf16_f32 v74, v76, v77
v_mfma_f32_16x16x32_bf16 v[140:143], a[108:111], a[56:59], v[140:143]
ds_read_b64_tr_b16 a[100:101], v12 offset:24832
s_add_u32 m0, s16, 0xc00
v_cvt_pk_bf16_f32 v75, v78, v79
v_mfma_f32_16x16x32_bf16 v[140:143], a[104:107], a[40:43], v[140:143]
buffer_load_dwordx4 v23, s[44:47], s21 offen lds
v_mfma_f32_16x16x32_bf16 v[132:135], a[104:107], a[36:39], v[132:135]
ds_read_b64_tr_b16 a[102:103], v12 offset:25856
v_accvgpr_write_b32 a152, v72
v_mfma_f32_16x16x32_bf16 v[132:135], a[108:111], a[52:55], v[132:135]
v_accvgpr_write_b32 a153, v73
v_accvgpr_write_b32 a154, v74
v_accvgpr_write_b32 a155, v75
v_mfma_f32_16x16x32_bf16 v[124:127], a[108:111], a[48:51], v[124:127]
v_cvt_pk_bf16_f32 v80, v80, v81
v_cvt_pk_bf16_f32 v81, v82, v83
v_mfma_f32_16x16x32_bf16 v[124:127], a[104:107], a[32:35], v[124:127]
s_waitcnt lgkmcnt(4)
v_cvt_pk_bf16_f32 v82, v84, v85
v_cvt_pk_bf16_f32 v83, v86, v87
v_mfma_f32_16x16x32_bf16 v[152:155], a[32:35], a[80:83], v[152:155]
ds_read_b64_tr_b16 a[104:105], v13 offset:16640
v_accvgpr_write_b32 a156, v80
v_accvgpr_write_b32 a157, v81
v_mfma_f32_16x16x32_bf16 v[152:155], a[48:51], a[84:87], v[152:155]
ds_read_b64_tr_b16 a[106:107], v13 offset:17664
s_add_u32 m0, s16, 0x1000
v_mfma_f32_16x16x32_bf16 v[156:159], a[52:55], a[84:87], v[156:159]
buffer_load_dwordx4 v22, s[44:47], s22 offen lds
v_mfma_f32_16x16x32_bf16 v[156:159], a[36:39], a[80:83], v[156:159]
ds_read_b64_tr_b16 a[108:109], v13 offset:24832
v_accvgpr_write_b32 a158, v82
v_accvgpr_write_b32 a159, v83
v_mfma_f32_16x16x32_bf16 v[160:163], a[40:43], a[80:83], v[160:163]
ds_read_b64_tr_b16 a[110:111], v13 offset:25856
v_cvt_pk_bf16_f32 v88, v88, v89
v_mfma_f32_16x16x32_bf16 v[160:163], a[56:59], a[84:87], v[160:163]
v_cvt_pk_bf16_f32 v89, v90, v91
v_cvt_pk_bf16_f32 v90, v92, v93
v_mfma_f32_16x16x32_bf16 v[164:167], a[60:63], a[84:87], v[164:167]
v_cvt_pk_bf16_f32 v91, v94, v95
v_accvgpr_write_b32 a160, v88
v_accvgpr_write_b32 a161, v89
v_mfma_f32_16x16x32_bf16 v[164:167], a[44:47], a[80:83], v[164:167]
v_accvgpr_write_b32 a162, v90
v_accvgpr_write_b32 a163, v91
v_mfma_f32_16x16x32_bf16 v[180:183], a[44:47], a[88:91], v[180:183]
ds_read_b64_tr_b16 a[80:81], v12 offset:16896
v_cvt_pk_bf16_f32 v96, v96, v97
v_mfma_f32_16x16x32_bf16 v[180:183], a[60:63], a[92:95], v[180:183]
ds_read_b64_tr_b16 a[82:83], v12 offset:17920
s_add_u32 m0, s16, 0x1400
v_cvt_pk_bf16_f32 v97, v98, v99
v_mfma_f32_16x16x32_bf16 v[176:179], a[56:59], a[92:95], v[176:179]
buffer_load_dwordx4 v23, s[44:47], s22 offen lds
v_mfma_f32_16x16x32_bf16 v[176:179], a[40:43], a[88:91], v[176:179]
ds_read_b64_tr_b16 a[84:85], v12 offset:25088
v_cvt_pk_bf16_f32 v98, v100, v101
v_mfma_f32_16x16x32_bf16 v[172:175], a[36:39], a[88:91], v[172:175]
ds_read_b64_tr_b16 a[86:87], v12 offset:26112
v_cvt_pk_bf16_f32 v99, v102, v103
v_accvgpr_write_b32 a164, v96
v_mfma_f32_16x16x32_bf16 v[172:175], a[52:55], a[92:95], v[172:175]
v_accvgpr_write_b32 a165, v97
v_accvgpr_write_b32 a166, v98
v_mfma_f32_16x16x32_bf16 v[168:171], a[48:51], a[92:95], v[168:171]
v_accvgpr_write_b32 a167, v99
v_cvt_pk_bf16_f32 v104, v104, v105
v_mfma_f32_16x16x32_bf16 v[168:171], a[32:35], a[88:91], v[168:171]
s_waitcnt lgkmcnt(4)
v_cvt_pk_bf16_f32 v105, v106, v107
v_cvt_pk_bf16_f32 v106, v108, v109
v_cvt_pk_bf16_f32 v107, v110, v111
v_mfma_f32_16x16x32_bf16 v[184:187], a[32:35], a[96:99], v[184:187]
ds_read_b64_tr_b16 a[88:89], v13 offset:16896
s_add_u32 m0, s16, 0x1800
v_mfma_f32_16x16x32_bf16 v[184:187], a[48:51], a[100:103], v[184:187]
buffer_load_dwordx4 v22, s[44:47], s23 offen lds
v_mfma_f32_16x16x32_bf16 v[188:191], a[52:55], a[100:103], v[188:191]
ds_read_b64_tr_b16 a[90:91], v13 offset:17920
v_accvgpr_write_b32 a168, v104
v_accvgpr_write_b32 a169, v105
v_mfma_f32_16x16x32_bf16 v[188:191], a[36:39], a[96:99], v[188:191]
ds_read_b64_tr_b16 a[92:93], v13 offset:25088
v_accvgpr_write_b32 a170, v106
v_mfma_f32_16x16x32_bf16 v[192:195], a[40:43], a[96:99], v[192:195]
ds_read_b64_tr_b16 a[94:95], v13 offset:26112
v_accvgpr_write_b32 a171, v107
v_mfma_f32_16x16x32_bf16 v[192:195], a[56:59], a[100:103], v[192:195]
L_padA4:
s_cmp_eq_u32 s95, 1
s_cbranch_scc1 L_padA8
v_cvt_pk_bf16_f32 v112, v112, v113
v_cvt_pk_bf16_f32 v113, v114, v115
v_cvt_pk_bf16_f32 v114, v116, v117
v_mfma_f32_16x16x32_bf16 v[196:199], a[60:63], a[100:103], v[196:199]
v_cvt_pk_bf16_f32 v115, v118, v119
v_accvgpr_write_b32 a172, v112
v_mfma_f32_16x16x32_bf16 v[196:199], a[44:47], a[96:99], v[196:199]
v_accvgpr_write_b32 a173, v113
v_accvgpr_write_b32 a174, v114
v_mfma_f32_16x16x32_bf16 v[212:215], a[44:47], a[104:107], v[212:215]
ds_read_b64_tr_b16 a[96:97], v12 offset:17152
s_add_u32 m0, s16, 0x1c00
v_accvgpr_write_b32 a175, v115
v_mfma_f32_16x16x32_bf16 v[212:215], a[60:63], a[108:111], v[212:215]
buffer_load_dwordx4 v23, s[44:47], s23 offen lds
v_mfma_f32_16x16x32_bf16 v[208:211], a[56:59], a[108:111], v[208:211]
ds_read_b64_tr_b16 a[98:99], v12 offset:18176
v_lshl_add_u32 v22, s42, 7, v22
v_mfma_f32_16x16x32_bf16 v[208:211], a[40:43], a[104:107], v[208:211]
ds_read_b64_tr_b16 a[100:101], v12 offset:25344
v_lshl_add_u32 v23, s42, 7, v23
v_cvt_pk_bf16_f32 v120, v120, v121
v_mfma_f32_16x16x32_bf16 v[204:207], a[36:39], a[104:107], v[204:207]
ds_read_b64_tr_b16 a[102:103], v12 offset:26368
v_cvt_pk_bf16_f32 v121, v122, v123
v_mfma_f32_16x16x32_bf16 v[204:207], a[52:55], a[108:111], v[204:207]
v_cvt_pk_bf16_f32 v122, v124, v125
v_cvt_pk_bf16_f32 v123, v126, v127
v_mfma_f32_16x16x32_bf16 v[200:203], a[48:51], a[108:111], v[200:203]
v_accvgpr_write_b32 a176, v120
v_accvgpr_write_b32 a177, v121
v_accvgpr_write_b32 a178, v122
v_mfma_f32_16x16x32_bf16 v[200:203], a[32:35], a[104:107], v[200:203]
s_mov_b32 s9, 0x600000
s_waitcnt lgkmcnt(4)
v_accvgpr_write_b32 a179, v123
v_mfma_f32_16x16x32_bf16 v[216:219], a[32:35], a[80:83], v[216:219]
buffer_load_dword a120, v18, s[52:55], s9 offen
v_mfma_f32_16x16x32_bf16 v[216:219], a[48:51], a[84:87], v[216:219]
ds_read_b64_tr_b16 a[104:105], v13 offset:17152
v_cvt_pk_bf16_f32 v128, v128, v129
v_cvt_pk_bf16_f32 v129, v130, v131
v_mfma_f32_16x16x32_bf16 v[220:223], a[52:55], a[84:87], v[220:223]
ds_read_b64_tr_b16 a[106:107], v13 offset:18176
v_cvt_pk_bf16_f32 v130, v132, v133
v_mfma_f32_16x16x32_bf16 v[220:223], a[36:39], a[80:83], v[220:223]
ds_read_b64_tr_b16 a[108:109], v13 offset:25344
v_cvt_pk_bf16_f32 v131, v134, v135
v_mfma_f32_16x16x32_bf16 v[224:227], a[40:43], a[80:83], v[224:227]
ds_read_b64_tr_b16 a[110:111], v13 offset:26368
v_add_u32 v12, 0x8000, v12
v_accvgpr_write_b32 a180, v128
v_mfma_f32_16x16x32_bf16 v[224:227], a[56:59], a[84:87], v[224:227]
v_add_u32 v13, 0x8000, v13
v_accvgpr_write_b32 a181, v129
v_mfma_f32_16x16x32_bf16 v[228:231], a[60:63], a[84:87], v[228:231]
v_accvgpr_write_b32 a182, v130
v_accvgpr_write_b32 a183, v131
v_mfma_f32_16x16x32_bf16 v[228:231], a[44:47], a[80:83], v[228:231]
v_cvt_pk_bf16_f32 v136, v136, v137
v_cvt_pk_bf16_f32 v137, v138, v139
v_cvt_pk_bf16_f32 v138, v140, v141
v_mfma_f32_16x16x32_bf16 v[244:247], a[44:47], a[88:91], v[244:247]
s_waitcnt vmcnt(27) lgkmcnt(0)
v_cvt_pk_bf16_f32 v139, v142, v143
v_accvgpr_write_b32 a184, v136
v_mfma_f32_16x16x32_bf16 v[244:247], a[60:63], a[92:95], v[244:247]
s_barrier
s_add_u32 m0, s17, 0x8000
v_accvgpr_write_b32 a185, v137
v_mfma_f32_16x16x32_bf16 v[240:243], a[56:59], a[92:95], v[240:243]
buffer_load_dwordx4 v5, s[52:55], 0 offen lds
v_accvgpr_write_b32 a186, v138
v_mfma_f32_16x16x32_bf16 v[240:243], a[40:43], a[88:91], v[240:243]
ds_read_b64_tr_b16 a[80:81], v12 offset:0
v_accvgpr_write_b32 a187, v139
v_mfma_f32_16x16x32_bf16 v[236:239], a[36:39], a[88:91], v[236:239]
ds_read_b64_tr_b16 a[82:83], v12 offset:1024
v_cvt_pk_bf16_f32 v144, v144, v145
v_mfma_f32_16x16x32_bf16 v[236:239], a[52:55], a[92:95], v[236:239]
ds_read_b64_tr_b16 a[84:85], v12 offset:8192
v_cvt_pk_bf16_f32 v145, v146, v147
v_cvt_pk_bf16_f32 v146, v148, v149
v_mfma_f32_16x16x32_bf16 v[232:235], a[48:51], a[92:95], v[232:235]
ds_read_b64_tr_b16 a[86:87], v12 offset:9216
v_cvt_pk_bf16_f32 v147, v150, v151
v_mfma_f32_16x16x32_bf16 v[232:235], a[32:35], a[88:91], v[232:235]
s_add_u32 m0, s17, 0x8400
s_waitcnt lgkmcnt(4)
v_accvgpr_write_b32 a188, v144
v_mfma_f32_16x16x32_bf16 v[248:251], a[32:35], a[96:99], v[248:251]
buffer_load_dwordx4 v5, s[52:55], s13 offen lds
v_accvgpr_write_b32 a189, v145
v_mfma_f32_16x16x32_bf16 v[248:251], a[48:51], a[100:103], v[248:251]
ds_read_b64_tr_b16 a[88:89], v13 offset:0
v_accvgpr_write_b32 a190, v146
v_mfma_f32_16x16x32_bf16 v[252:255], a[52:55], a[100:103], v[252:255]
ds_read_b64_tr_b16 a[90:91], v13 offset:1024
v_accvgpr_write_b32 a191, v147
v_mfma_f32_16x16x32_bf16 v[252:255], a[36:39], a[96:99], v[252:255]
ds_read_b64_tr_b16 a[92:93], v13 offset:8192
v_cvt_pk_bf16_f32 v152, v152, v153
v_cvt_pk_bf16_f32 v153, v154, v155
v_mfma_f32_16x16x32_bf16 a[232:235], a[40:43], a[96:99], a[232:235]
ds_read_b64_tr_b16 a[94:95], v13 offset:9216
v_cvt_pk_bf16_f32 v154, v156, v157
v_mfma_f32_16x16x32_bf16 a[232:235], a[56:59], a[100:103], a[232:235]
v_cvt_pk_bf16_f32 v155, v158, v159
v_accvgpr_write_b32 a192, v152
v_mfma_f32_16x16x32_bf16 a[236:239], a[60:63], a[100:103], a[236:239]
s_add_u32 m0, s17, 0x8800
v_accvgpr_write_b32 a193, v153
v_accvgpr_write_b32 a194, v154
v_accvgpr_write_b32 a195, v155
v_mfma_f32_16x16x32_bf16 a[236:239], a[44:47], a[96:99], a[236:239]
buffer_load_dwordx4 v6, s[52:55], 0 offen lds
v_mfma_f32_16x16x32_bf16 a[252:255], a[44:47], a[104:107], a[252:255]
ds_read_b64_tr_b16 a[96:97], v12 offset:256
v_cvt_pk_bf16_f32 v160, v160, v161
v_mfma_f32_16x16x32_bf16 a[252:255], a[60:63], a[108:111], a[252:255]
ds_read_b64_tr_b16 a[98:99], v12 offset:1280
v_cvt_pk_bf16_f32 v161, v162, v163
v_cvt_pk_bf16_f32 v162, v164, v165
v_mfma_f32_16x16x32_bf16 a[248:251], a[56:59], a[108:111], a[248:251]
ds_read_b64_tr_b16 a[100:101], v12 offset:8448
v_cvt_pk_bf16_f32 v163, v166, v167
v_mfma_f32_16x16x32_bf16 a[248:251], a[40:43], a[104:107], a[248:251]
ds_read_b64_tr_b16 a[102:103], v12 offset:9472
v_accvgpr_write_b32 a196, v160
v_mfma_f32_16x16x32_bf16 a[244:247], a[36:39], a[104:107], a[244:247]
v_accvgpr_write_b32 a197, v161
v_accvgpr_write_b32 a198, v162
v_accvgpr_write_b32 a199, v163
v_mfma_f32_16x16x32_bf16 a[244:247], a[52:55], a[108:111], a[244:247]
s_add_u32 m0, s17, 0x8c00
v_cvt_pk_bf16_f32 v168, v168, v169
v_cvt_pk_bf16_f32 v169, v170, v171
v_mfma_f32_16x16x32_bf16 a[240:243], a[48:51], a[108:111], a[240:243]
buffer_load_dwordx4 v6, s[52:55], s13 offen lds
v_mfma_f32_16x16x32_bf16 a[240:243], a[32:35], a[104:107], a[240:243]
s_waitcnt lgkmcnt(4)
v_cvt_pk_bf16_f32 v170, v172, v173
v_cvt_pk_bf16_f32 v171, v174, v175
v_accvgpr_write_b32 a200, v168
L_S8:
v_mfma_f32_16x16x32_bf16 v[24:27], a[80:83], a[0:3], 0
ds_read_b64_tr_b16 a[104:105], v13 offset:256
s_waitcnt vmcnt(22)
v_mfma_f32_16x16x32_bf16 v[24:27], a[84:87], a[16:19], v[24:27]
ds_read_b64_tr_b16 a[106:107], v13 offset:1280
v_accvgpr_write_b32 a201, v169
v_mfma_f32_16x16x32_bf16 v[32:35], a[84:87], a[20:23], 0
ds_read_b64_tr_b16 a[108:109], v13 offset:8448
v_accvgpr_write_b32 a202, v170
v_accvgpr_write_b32 a203, v171
v_mfma_f32_16x16x32_bf16 v[32:35], a[80:83], a[4:7], v[32:35]
ds_read_b64_tr_b16 a[110:111], v13 offset:9472
v_cvt_pk_bf16_f32 v176, v176, v177
v_mfma_f32_16x16x32_bf16 v[40:43], a[80:83], a[8:11], 0
ds_read_b128 a[32:35], v8 offset:32768
s_add_u32 m0, s18, 0xc000
v_mfma_f32_16x16x32_bf16 v[40:43], a[84:87], a[24:27], v[40:43]
buffer_load_dwordx4 v7, s[68:71], 0 offen lds
v_cvt_pk_bf16_f32 v177, v178, v179
v_mfma_f32_16x16x32_bf16 v[48:51], a[84:87], a[28:31], 0
ds_read_b128 a[48:51], v9 offset:32768
v_cvt_pk_bf16_f32 v178, v180, v181
v_mfma_f32_16x16x32_bf16 v[48:51], a[80:83], a[12:15], v[48:51]
ds_read_b128 a[36:39], v8 offset:34816
v_cvt_pk_bf16_f32 v179, v182, v183
v_mfma_f32_16x16x32_bf16 v[52:55], a[88:91], a[12:15], 0
ds_read_b64_tr_b16 a[80:81], v12 offset:512
v_accvgpr_write_b32 a204, v176
v_accvgpr_write_b32 a205, v177
v_mfma_f32_16x16x32_bf16 v[52:55], a[92:95], a[28:31], v[52:55]
ds_read_b64_tr_b16 a[82:83], v12 offset:1536
v_accvgpr_write_b32 a206, v178
v_mfma_f32_16x16x32_bf16 v[44:47], a[92:95], a[24:27], 0
ds_read_b64_tr_b16 a[84:85], v12 offset:8704
s_add_u32 s8, s28, 0x2000
v_mfma_f32_16x16x32_bf16 v[44:47], a[88:91], a[8:11], v[44:47]
buffer_store_dwordx4 a[128:131], v16, s[88:91], s8 offen sc1
v_accvgpr_write_b32 a207, v179
v_mfma_f32_16x16x32_bf16 v[36:39], a[88:91], a[4:7], 0
ds_read_b64_tr_b16 a[86:87], v12 offset:9728
v_cvt_pk_bf16_f32 v184, v184, v185
v_mfma_f32_16x16x32_bf16 v[36:39], a[92:95], a[20:23], v[36:39]
ds_read_b128 a[52:55], v9 offset:34816
v_cvt_pk_bf16_f32 v185, v186, v187
v_mfma_f32_16x16x32_bf16 v[28:31], a[92:95], a[16:19], 0
ds_read_b128 a[40:43], v8 offset:36864
v_cvt_pk_bf16_f32 v186, v188, v189
v_cvt_pk_bf16_f32 v187, v190, v191
v_mfma_f32_16x16x32_bf16 v[28:31], a[88:91], a[0:3], v[28:31]
ds_read_b128 a[56:59], v9 offset:36864
s_waitcnt lgkmcnt(10)
v_mfma_f32_16x16x32_bf16 v[56:59], a[96:99], a[0:3], 0
ds_read_b64_tr_b16 a[88:89], v13 offset:512
v_accvgpr_write_b32 a208, v184
v_mfma_f32_16x16x32_bf16 v[56:59], a[100:103], a[16:19], v[56:59]
ds_read_b64_tr_b16 a[90:91], v13 offset:1536
s_add_u32 m0, s18, 0xd000
v_accvgpr_write_b32 a209, v185
v_mfma_f32_16x16x32_bf16 v[64:67], a[100:103], a[20:23], 0
buffer_load_dwordx4 v7, s[68:71], s25 offen lds
v_mfma_f32_16x16x32_bf16 v[64:67], a[96:99], a[4:7], v[64:67]
ds_read_b64_tr_b16 a[92:93], v13 offset:8704
v_accvgpr_write_b32 a210, v186
v_mfma_f32_16x16x32_bf16 v[72:75], a[96:99], a[8:11], 0
ds_read_b64_tr_b16 a[94:95], v13 offset:9728
v_accvgpr_write_b32 a211, v187
v_cvt_pk_bf16_f32 v192, v192, v193
v_mfma_f32_16x16x32_bf16 v[72:75], a[100:103], a[24:27], v[72:75]
ds_read_b128 a[44:47], v8 offset:38912
v_cvt_pk_bf16_f32 v193, v194, v195
v_mfma_f32_16x16x32_bf16 v[80:83], a[100:103], a[28:31], 0
ds_read_b128 a[60:63], v9 offset:38912
v_cvt_pk_bf16_f32 v194, v196, v197
v_mfma_f32_16x16x32_bf16 v[80:83], a[96:99], a[12:15], v[80:83]
v_cvt_pk_bf16_f32 v195, v198, v199
v_accvgpr_write_b32 a212, v192
v_accvgpr_write_b32 a213, v193
v_mfma_f32_16x16x32_bf16 v[84:87], a[104:107], a[12:15], 0
ds_read_b64_tr_b16 a[96:97], v12 offset:768
s_add_u32 m0, s18, 0xe000
v_mfma_f32_16x16x32_bf16 v[84:87], a[108:111], a[28:31], v[84:87]
buffer_load_dwordx4 v7, s[68:71], s26 offen lds
v_mfma_f32_16x16x32_bf16 v[76:79], a[108:111], a[24:27], 0
ds_read_b64_tr_b16 a[98:99], v12 offset:1792
v_lshl_add_u32 v5, s42, 19, v5
v_accvgpr_write_b32 a214, v194
v_mfma_f32_16x16x32_bf16 v[76:79], a[104:107], a[8:11], v[76:79]
ds_read_b64_tr_b16 a[100:101], v12 offset:8960
v_lshl_add_u32 v6, s42, 19, v6
v_mfma_f32_16x16x32_bf16 v[68:71], a[104:107], a[4:7], 0
ds_read_b64_tr_b16 a[102:103], v12 offset:9984
v_lshl_add_u32 v7, s42, 18, v7
v_mfma_f32_16x16x32_bf16 v[68:71], a[108:111], a[20:23], v[68:71]
v_lshl_add_u32 v7, s42, 17, v7
v_accvgpr_write_b32 a215, v195
v_cvt_pk_bf16_f32 v200, v200, v201
v_mfma_f32_16x16x32_bf16 v[60:63], a[108:111], a[16:19], 0
v_cvt_pk_bf16_f32 v201, v202, v203
v_cvt_pk_bf16_f32 v202, v204, v205
v_mfma_f32_16x16x32_bf16 v[60:63], a[104:107], a[0:3], v[60:63]
s_add_u32 m0, s16, 0x8000
s_waitcnt lgkmcnt(4)
s_waitcnt lgkmcnt(6)
v_mfma_f32_16x16x32_bf16 v[88:91], a[80:83], a[0:3], 0
buffer_load_dwordx4 v22, s[44:47], s20 offen lds
v_cvt_pk_bf16_f32 v203, v206, v207
v_mfma_f32_16x16x32_bf16 v[88:91], a[84:87], a[16:19], v[88:91]
ds_read_b64_tr_b16 a[104:105], v13 offset:768
v_accvgpr_write_b32 a216, v200
v_mfma_f32_16x16x32_bf16 v[96:99], a[84:87], a[20:23], 0
ds_read_b64_tr_b16 a[106:107], v13 offset:1792
v_accvgpr_write_b32 a217, v201
v_mfma_f32_16x16x32_bf16 v[96:99], a[80:83], a[4:7], v[96:99]
ds_read_b64_tr_b16 a[108:109], v13 offset:8960
v_accvgpr_write_b32 a218, v202
v_accvgpr_write_b32 a219, v203
v_mfma_f32_16x16x32_bf16 v[104:107], a[80:83], a[8:11], 0
ds_read_b64_tr_b16 a[110:111], v13 offset:9984
s_add_u32 m0, s16, 0x8400
v_mfma_f32_16x16x32_bf16 v[104:107], a[84:87], a[24:27], v[104:107]
buffer_load_dwordx4 v23, s[44:47], s20 offen lds
v_mfma_f32_16x16x32_bf16 v[112:115], a[84:87], a[28:31], 0
v_cvt_pk_bf16_f32 v208, v208, v209
v_cvt_pk_bf16_f32 v209, v210, v211
v_cvt_pk_bf16_f32 v210, v212, v213
v_mfma_f32_16x16x32_bf16 v[112:115], a[80:83], a[12:15], v[112:115]
v_cvt_pk_bf16_f32 v211, v214, v215
v_accvgpr_write_b32 a220, v208
v_mfma_f32_16x16x32_bf16 v[116:119], a[88:91], a[12:15], 0
ds_read_b64_tr_b16 a[80:81], v14 offset:0
v_accvgpr_write_b32 a221, v209
v_mfma_f32_16x16x32_bf16 v[116:119], a[92:95], a[28:31], v[116:119]
ds_read_b64_tr_b16 a[82:83], v14 offset:256
v_accvgpr_write_b32 a222, v210
v_accvgpr_write_b32 a223, v211
v_mfma_f32_16x16x32_bf16 v[108:111], a[92:95], a[24:27], 0
ds_read_b64_tr_b16 a[84:85], v14 offset:2048
s_add_u32 m0, s16, 0x8800
v_mfma_f32_16x16x32_bf16 v[108:111], a[88:91], a[8:11], v[108:111]
buffer_load_dwordx4 v22, s[44:47], s21 offen lds
v_mfma_f32_16x16x32_bf16 v[100:103], a[88:91], a[4:7], 0
ds_read_b64_tr_b16 a[86:87], v14 offset:2304
v_cvt_pk_bf16_f32 v216, v216, v217
v_cvt_pk_bf16_f32 v217, v218, v219
v_mfma_f32_16x16x32_bf16 v[100:103], a[92:95], a[20:23], v[100:103]
v_cvt_pk_bf16_f32 v218, v220, v221
v_cvt_pk_bf16_f32 v219, v222, v223
v_mfma_f32_16x16x32_bf16 v[92:95], a[92:95], a[16:19], 0
v_accvgpr_write_b32 a224, v216
v_accvgpr_write_b32 a225, v217
v_mfma_f32_16x16x32_bf16 v[92:95], a[88:91], a[0:3], v[92:95]
s_add_u32 s8, s28, 0x3000
s_waitcnt lgkmcnt(4)
v_accvgpr_write_b32 a226, v218
v_accvgpr_write_b32 a227, v219
v_mfma_f32_16x16x32_bf16 v[120:123], a[96:99], a[0:3], 0
buffer_store_dwordx4 a[132:135], v16, s[88:91], s8 offen sc1
v_mfma_f32_16x16x32_bf16 v[120:123], a[100:103], a[16:19], v[120:123]
ds_read_b64_tr_b16 a[88:89], v15 offset:0
v_cvt_pk_bf16_f32 v224, v224, v225
v_mfma_f32_16x16x32_bf16 v[128:131], a[100:103], a[20:23], 0
ds_read_b64_tr_b16 a[90:91], v15 offset:256
v_cvt_pk_bf16_f32 v225, v226, v227
v_cvt_pk_bf16_f32 v226, v228, v229
v_mfma_f32_16x16x32_bf16 v[128:131], a[96:99], a[4:7], v[128:131]
ds_read_b64_tr_b16 a[92:93], v15 offset:2048
v_cvt_pk_bf16_f32 v227, v230, v231
v_mfma_f32_16x16x32_bf16 v[136:139], a[96:99], a[8:11], 0
ds_read_b64_tr_b16 a[94:95], v15 offset:2304
v_accvgpr_write_b32 a228, v224
v_mfma_f32_16x16x32_bf16 v[136:139], a[100:103], a[24:27], v[136:139]
s_add_u32 m0, s16, 0x8c00
v_accvgpr_write_b32 a229, v225
v_accvgpr_write_b32 a230, v226
v_accvgpr_write_b32 a231, v227
v_mfma_f32_16x16x32_bf16 v[144:147], a[100:103], a[28:31], 0
buffer_load_dwordx4 v23, s[44:47], s21 offen lds
v_mfma_f32_16x16x32_bf16 v[144:147], a[96:99], a[12:15], v[144:147]
v_cvt_pk_bf16_f32 v232, v232, v233
v_cvt_pk_bf16_f32 v233, v234, v235
v_mfma_f32_16x16x32_bf16 v[148:151], a[104:107], a[12:15], 0
ds_read_b64_tr_b16 a[96:97], v14 offset:4096
v_cvt_pk_bf16_f32 v234, v236, v237
v_cvt_pk_bf16_f32 v235, v238, v239
v_mfma_f32_16x16x32_bf16 v[148:151], a[108:111], a[28:31], v[148:151]
ds_read_b64_tr_b16 a[98:99], v14 offset:4352
v_accvgpr_write_b32 a112, v232
v_mfma_f32_16x16x32_bf16 v[140:143], a[108:111], a[24:27], 0
ds_read_b64_tr_b16 a[100:101], v14 offset:6144
v_accvgpr_write_b32 a113, v233
v_mfma_f32_16x16x32_bf16 v[140:143], a[104:107], a[8:11], v[140:143]
ds_read_b64_tr_b16 a[102:103], v14 offset:6400
s_add_u32 m0, s16, 0x9000
v_accvgpr_write_b32 a114, v234
v_mfma_f32_16x16x32_bf16 v[132:135], a[104:107], a[4:7], 0
buffer_load_dwordx4 v22, s[44:47], s22 offen lds
v_mfma_f32_16x16x32_bf16 v[132:135], a[108:111], a[20:23], v[132:135]
v_accvgpr_write_b32 a115, v235
v_cvt_pk_bf16_f32 v240, v240, v241
v_mfma_f32_16x16x32_bf16 v[124:127], a[108:111], a[16:19], 0
v_cvt_pk_bf16_f32 v241, v242, v243
v_cvt_pk_bf16_f32 v242, v244, v245
v_cvt_pk_bf16_f32 v243, v246, v247
v_mfma_f32_16x16x32_bf16 v[124:127], a[104:107], a[0:3], v[124:127]
s_waitcnt lgkmcnt(4)
v_accvgpr_write_b32 a116, v240
v_accvgpr_write_b32 a117, v241
v_mfma_f32_16x16x32_bf16 v[152:155], a[80:83], a[0:3], 0
ds_read_b64_tr_b16 a[104:105], v15 offset:4096
s_add_u32 m0, s16, 0x9400
v_mfma_f32_16x16x32_bf16 v[152:155], a[84:87], a[16:19], v[152:155]
buffer_load_dwordx4 v23, s[44:47], s22 offen lds
v_accvgpr_write_b32 a118, v242
v_mfma_f32_16x16x32_bf16 v[160:163], a[84:87], a[20:23], 0
ds_read_b64_tr_b16 a[106:107], v15 offset:4352
v_accvgpr_write_b32 a119, v243
v_mfma_f32_16x16x32_bf16 v[160:163], a[80:83], a[4:7], v[160:163]
ds_read_b64_tr_b16 a[108:109], v15 offset:6144
v_cvt_pk_bf16_f32 v248, v248, v249
v_mfma_f32_16x16x32_bf16 v[168:171], a[80:83], a[8:11], 0
ds_read_b64_tr_b16 a[110:111], v15 offset:6400
v_cvt_pk_bf16_f32 v249, v250, v251
v_cvt_pk_bf16_f32 v250, v252, v253
v_mfma_f32_16x16x32_bf16 v[168:171], a[84:87], a[24:27], v[168:171]
v_cvt_pk_bf16_f32 v251, v254, v255
v_accvgpr_write_b32 a124, v248
v_mfma_f32_16x16x32_bf16 v[176:179], a[84:87], a[28:31], 0
s_add_u32 m0, s16, 0x9800
v_accvgpr_write_b32 a125, v249
v_accvgpr_write_b32 a126, v250
v_mfma_f32_16x16x32_bf16 v[176:179], a[80:83], a[12:15], v[176:179]
buffer_load_dwordx4 v22, s[44:47], s23 offen lds
v_accvgpr_write_b32 a127, v251
v_mfma_f32_16x16x32_bf16 v[180:183], a[88:91], a[12:15], 0
ds_read_b64_tr_b16 a[80:81], v14 offset:8192
v_accvgpr_read_b32 v2, a232
v_mfma_f32_16x16x32_bf16 v[180:183], a[92:95], a[28:31], v[180:183]
ds_read_b64_tr_b16 a[82:83], v14 offset:8448
v_accvgpr_read_b32 v3, a233
v_mfma_f32_16x16x32_bf16 v[172:175], a[92:95], a[24:27], 0
ds_read_b64_tr_b16 a[84:85], v14 offset:10240
v_cvt_pk_bf16_f32 v2, v2, v3
v_accvgpr_write_b32 a232, v2
v_mfma_f32_16x16x32_bf16 v[172:175], a[88:91], a[8:11], v[172:175]
ds_read_b64_tr_b16 a[86:87], v14 offset:10496
s_add_u32 m0, s16, 0x9c00
v_mfma_f32_16x16x32_bf16 v[164:167], a[88:91], a[4:7], 0
buffer_load_dwordx4 v23, s[44:47], s23 offen lds
v_mfma_f32_16x16x32_bf16 v[164:167], a[92:95], a[20:23], v[164:167]
v_lshl_add_u32 v22, s42, 7, v22
v_lshl_add_u32 v23, s42, 7, v23
v_accvgpr_read_b32 v2, a234
v_mfma_f32_16x16x32_bf16 v[156:159], a[92:95], a[16:19], 0
v_accvgpr_read_b32 v3, a235
v_cvt_pk_bf16_f32 v2, v2, v3
v_mfma_f32_16x16x32_bf16 v[156:159], a[88:91], a[0:3], v[156:159]
s_waitcnt lgkmcnt(4)
v_accvgpr_write_b32 a233, v2
v_accvgpr_read_b32 v2, a236
v_mfma_f32_16x16x32_bf16 v[184:187], a[96:99], a[0:3], 0
ds_read_b64_tr_b16 a[88:89], v15 offset:8192
v_accvgpr_read_b32 v3, a237
v_cvt_pk_bf16_f32 v2, v2, v3
v_mfma_f32_16x16x32_bf16 v[184:187], a[100:103], a[16:19], v[184:187]
ds_read_b64_tr_b16 a[90:91], v15 offset:8448
s_add_u32 s8, s28, 0x6000
v_mfma_f32_16x16x32_bf16 v[192:195], a[100:103], a[20:23], 0
buffer_store_dwordx4 a[136:139], v16, s[88:91], s8 offen sc1
v_mfma_f32_16x16x32_bf16 v[192:195], a[96:99], a[4:7], v[192:195]
ds_read_b64_tr_b16 a[92:93], v15 offset:10240
v_accvgpr_write_b32 a234, v2
v_accvgpr_read_b32 v2, a238
v_mfma_f32_16x16x32_bf16 v[200:203], a[96:99], a[8:11], 0
ds_read_b64_tr_b16 a[94:95], v15 offset:10496
v_add_u32 v12, 0xffff0000, v12
v_mfma_f32_16x16x32_bf16 v[200:203], a[100:103], a[24:27], v[200:203]
v_add_u32 v13, 0xffff0000, v13
v_add_u32 v14, 0xffff0000, v14
v_mfma_f32_16x16x32_bf16 v[208:211], a[100:103], a[28:31], 0
v_add_u32 v15, 0xffff0000, v15
v_accvgpr_read_b32 v3, a239
v_cvt_pk_bf16_f32 v2, v2, v3
v_mfma_f32_16x16x32_bf16 v[208:211], a[96:99], a[12:15], v[208:211]
v_accvgpr_write_b32 a235, v2
v_accvgpr_read_b32 v2, a240
v_mfma_f32_16x16x32_bf16 v[212:215], a[104:107], a[12:15], 0
s_waitcnt vmcnt(28) lgkmcnt(0)
v_accvgpr_read_b32 v3, a241
v_cvt_pk_bf16_f32 v2, v2, v3
v_mfma_f32_16x16x32_bf16 v[212:215], a[108:111], a[28:31], v[212:215]
s_barrier
s_add_u32 m0, s17, 0x10000
v_accvgpr_write_b32 a240, v2
v_accvgpr_read_b32 v2, a242
v_mfma_f32_16x16x32_bf16 v[204:207], a[108:111], a[24:27], 0
buffer_load_dwordx4 v5, s[52:55], 0 offen lds
v_mfma_f32_16x16x32_bf16 v[204:207], a[104:107], a[8:11], v[204:207]
ds_read_b64_tr_b16 a[96:97], v12 offset:0
v_accvgpr_read_b32 v3, a243
v_mfma_f32_16x16x32_bf16 v[196:199], a[104:107], a[4:7], 0
ds_read_b64_tr_b16 a[98:99], v12 offset:1024
v_cvt_pk_bf16_f32 v2, v2, v3
v_accvgpr_write_b32 a241, v2
v_mfma_f32_16x16x32_bf16 v[196:199], a[108:111], a[20:23], v[196:199]
ds_read_b64_tr_b16 a[100:101], v12 offset:8192
v_accvgpr_read_b32 v2, a244
v_mfma_f32_16x16x32_bf16 v[188:191], a[108:111], a[16:19], 0
ds_read_b64_tr_b16 a[102:103], v12 offset:9216
v_accvgpr_read_b32 v3, a245
v_mfma_f32_16x16x32_bf16 v[188:191], a[104:107], a[0:3], v[188:191]
s_add_u32 m0, s17, 0x10400
s_waitcnt lgkmcnt(4)
v_cvt_pk_bf16_f32 v2, v2, v3
v_accvgpr_write_b32 a242, v2
v_mfma_f32_16x16x32_bf16 v[216:219], a[0:3], a[80:83], 0
buffer_load_dwordx4 v5, s[52:55], s13 offen lds
v_mfma_f32_16x16x32_bf16 v[216:219], a[16:19], a[84:87], v[216:219]
ds_read_b64_tr_b16 a[104:105], v13 offset:0
v_accvgpr_read_b32 v2, a246
v_mfma_f32_16x16x32_bf16 v[224:227], a[20:23], a[84:87], 0
ds_read_b64_tr_b16 a[106:107], v13 offset:1024
v_accvgpr_read_b32 v3, a247
v_cvt_pk_bf16_f32 v2, v2, v3
v_mfma_f32_16x16x32_bf16 v[224:227], a[4:7], a[80:83], v[224:227]
ds_read_b64_tr_b16 a[108:109], v13 offset:8192
v_accvgpr_write_b32 a243, v2
v_mfma_f32_16x16x32_bf16 v[232:235], a[8:11], a[80:83], 0
ds_read_b64_tr_b16 a[110:111], v13 offset:9216
v_accvgpr_read_b32 v2, a248
v_mfma_f32_16x16x32_bf16 v[232:235], a[24:27], a[84:87], v[232:235]
v_accvgpr_read_b32 v3, a249
v_cvt_pk_bf16_f32 v2, v2, v3
v_accvgpr_write_b32 a248, v2
v_mfma_f32_16x16x32_bf16 v[240:243], a[28:31], a[84:87], 0
s_add_u32 m0, s17, 0x10800
v_accvgpr_read_b32 v2, a250
v_accvgpr_read_b32 v3, a251
v_mfma_f32_16x16x32_bf16 v[240:243], a[12:15], a[80:83], v[240:243]
buffer_load_dwordx4 v6, s[52:55], 0 offen lds
v_mfma_f32_16x16x32_bf16 v[244:247], a[12:15], a[88:91], 0
ds_read_b64_tr_b16 a[80:81], v12 offset:256
v_cvt_pk_bf16_f32 v2, v2, v3
v_accvgpr_write_b32 a249, v2
v_mfma_f32_16x16x32_bf16 v[244:247], a[28:31], a[92:95], v[244:247]
ds_read_b64_tr_b16 a[82:83], v12 offset:1280
v_accvgpr_read_b32 v2, a252
v_mfma_f32_16x16x32_bf16 v[236:239], a[24:27], a[92:95], 0
ds_read_b64_tr_b16 a[84:85], v12 offset:8448
v_accvgpr_read_b32 v3, a253
v_mfma_f32_16x16x32_bf16 v[236:239], a[8:11], a[88:91], v[236:239]
ds_read_b64_tr_b16 a[86:87], v12 offset:9472
v_cvt_pk_bf16_f32 v2, v2, v3
v_accvgpr_write_b32 a250, v2
v_mfma_f32_16x16x32_bf16 v[228:231], a[4:7], a[88:91], 0
v_accvgpr_read_b32 v2, a254
v_accvgpr_read_b32 v3, a255
v_mfma_f32_16x16x32_bf16 v[228:231], a[20:23], a[92:95], v[228:231]
s_add_u32 m0, s17, 0x10c00
v_cvt_pk_bf16_f32 v2, v2, v3
v_accvgpr_write_b32 a251, v2
v_mfma_f32_16x16x32_bf16 v[220:223], a[16:19], a[92:95], 0
buffer_load_dwordx4 v6, s[52:55], s13 offen lds
v_mfma_f32_16x16x32_bf16 v[220:223], a[0:3], a[88:91], v[220:223]
s_waitcnt lgkmcnt(4)
L_S9:
v_mfma_f32_16x16x32_bf16 v[24:27], a[96:99], a[32:35], v[24:27]
ds_read_b64_tr_b16 a[88:89], v13 offset:256
s_waitcnt vmcnt(23)
v_mfma_f32_16x16x32_bf16 v[24:27], a[100:103], a[48:51], v[24:27]
ds_read_b64_tr_b16 a[90:91], v13 offset:1280
L_padA5:
s_cmp_eq_u32 s95, 1
s_cbranch_scc1 L_padA9
v_mfma_f32_16x16x32_bf16 v[32:35], a[100:103], a[52:55], v[32:35]
ds_read_b64_tr_b16 a[92:93], v13 offset:8448
v_mfma_f32_16x16x32_bf16 v[32:35], a[96:99], a[36:39], v[32:35]
ds_read_b64_tr_b16 a[94:95], v13 offset:9472
v_mfma_f32_16x16x32_bf16 v[40:43], a[96:99], a[40:43], v[40:43]
ds_read_b128 a[0:3], v8 offset:0
s_add_u32 m0, s18, 0x14000
v_mfma_f32_16x16x32_bf16 v[40:43], a[100:103], a[56:59], v[40:43]
buffer_load_dwordx4 v7, s[68:71], 0 offen lds
v_mfma_f32_16x16x32_bf16 v[48:51], a[100:103], a[60:63], v[48:51]
ds_read_b128 a[16:19], v9 offset:0
v_mfma_f32_16x16x32_bf16 v[48:51], a[96:99], a[44:47], v[48:51]
ds_read_b128 a[4:7], v8 offset:2048
v_mfma_f32_16x16x32_bf16 v[52:55], a[104:107], a[44:47], v[52:55]
ds_read_b64_tr_b16 a[96:97], v12 offset:512
v_mfma_f32_16x16x32_bf16 v[52:55], a[108:111], a[60:63], v[52:55]
ds_read_b64_tr_b16 a[98:99], v12 offset:1536
v_mfma_f32_16x16x32_bf16 v[44:47], a[108:111], a[56:59], v[44:47]
ds_read_b64_tr_b16 a[100:101], v12 offset:8704
s_add_u32 s8, s28, 0x7000
v_mfma_f32_16x16x32_bf16 v[44:47], a[104:107], a[40:43], v[44:47]
buffer_store_dwordx4 a[140:143], v16, s[88:91], s8 offen sc1
v_mfma_f32_16x16x32_bf16 v[36:39], a[104:107], a[36:39], v[36:39]
ds_read_b64_tr_b16 a[102:103], v12 offset:9728
v_mfma_f32_16x16x32_bf16 v[36:39], a[108:111], a[52:55], v[36:39]
ds_read_b128 a[20:23], v9 offset:2048
v_mfma_f32_16x16x32_bf16 v[28:31], a[108:111], a[48:51], v[28:31]
ds_read_b128 a[8:11], v8 offset:4096
v_mfma_f32_16x16x32_bf16 v[28:31], a[104:107], a[32:35], v[28:31]
ds_read_b128 a[24:27], v9 offset:4096
s_waitcnt lgkmcnt(10)
v_mfma_f32_16x16x32_bf16 v[56:59], a[80:83], a[32:35], v[56:59]
ds_read_b64_tr_b16 a[104:105], v13 offset:512
v_mfma_f32_16x16x32_bf16 v[56:59], a[84:87], a[48:51], v[56:59]
ds_read_b64_tr_b16 a[106:107], v13 offset:1536
s_add_u32 m0, s18, 0x15000
v_mfma_f32_16x16x32_bf16 v[64:67], a[84:87], a[52:55], v[64:67]
buffer_load_dwordx4 v7, s[68:71], s25 offen lds
v_mfma_f32_16x16x32_bf16 v[64:67], a[80:83], a[36:39], v[64:67]
ds_read_b64_tr_b16 a[108:109], v13 offset:8704
v_mfma_f32_16x16x32_bf16 v[72:75], a[80:83], a[40:43], v[72:75]
ds_read_b64_tr_b16 a[110:111], v13 offset:9728
v_mfma_f32_16x16x32_bf16 v[72:75], a[84:87], a[56:59], v[72:75]
ds_read_b128 a[12:15], v8 offset:6144
v_mfma_f32_16x16x32_bf16 v[80:83], a[84:87], a[60:63], v[80:83]
ds_read_b128 a[28:31], v9 offset:6144
v_mfma_f32_16x16x32_bf16 v[80:83], a[80:83], a[44:47], v[80:83]
v_mfma_f32_16x16x32_bf16 v[84:87], a[88:91], a[44:47], v[84:87]
ds_read_b64_tr_b16 a[80:81], v12 offset:768
s_add_u32 m0, s18, 0x16000
v_mfma_f32_16x16x32_bf16 v[84:87], a[92:95], a[60:63], v[84:87]
buffer_load_dwordx4 v7, s[68:71], s26 offen lds
v_mfma_f32_16x16x32_bf16 v[76:79], a[92:95], a[56:59], v[76:79]
ds_read_b64_tr_b16 a[82:83], v12 offset:1792
v_lshl_add_u32 v5, s42, 19, v5
v_mfma_f32_16x16x32_bf16 v[76:79], a[88:91], a[40:43], v[76:79]
ds_read_b64_tr_b16 a[84:85], v12 offset:8960
v_lshl_add_u32 v6, s42, 19, v6
v_mfma_f32_16x16x32_bf16 v[68:71], a[88:91], a[36:39], v[68:71]
ds_read_b64_tr_b16 a[86:87], v12 offset:9984
v_lshl_add_u32 v7, s42, 18, v7
v_mfma_f32_16x16x32_bf16 v[68:71], a[92:95], a[52:55], v[68:71]
v_lshl_add_u32 v7, s42, 17, v7
v_mfma_f32_16x16x32_bf16 v[60:63], a[92:95], a[48:51], v[60:63]
v_mfma_f32_16x16x32_bf16 v[60:63], a[88:91], a[32:35], v[60:63]
s_add_u32 m0, s16, 0x0
s_waitcnt lgkmcnt(4)
s_waitcnt lgkmcnt(6)
v_mfma_f32_16x16x32_bf16 v[88:91], a[96:99], a[32:35], v[88:91]
buffer_load_dwordx4 v22, s[44:47], s20 offen lds
v_mfma_f32_16x16x32_bf16 v[88:91], a[100:103], a[48:51], v[88:91]
ds_read_b64_tr_b16 a[88:89], v13 offset:768
v_mfma_f32_16x16x32_bf16 v[96:99], a[100:103], a[52:55], v[96:99]
ds_read_b64_tr_b16 a[90:91], v13 offset:1792
v_mfma_f32_16x16x32_bf16 v[96:99], a[96:99], a[36:39], v[96:99]
ds_read_b64_tr_b16 a[92:93], v13 offset:8960
v_mfma_f32_16x16x32_bf16 v[104:107], a[96:99], a[40:43], v[104:107]
ds_read_b64_tr_b16 a[94:95], v13 offset:9984
s_add_u32 m0, s16, 0x400
v_mfma_f32_16x16x32_bf16 v[104:107], a[100:103], a[56:59], v[104:107]
buffer_load_dwordx4 v23, s[44:47], s20 offen lds
v_mfma_f32_16x16x32_bf16 v[112:115], a[100:103], a[60:63], v[112:115]
v_mfma_f32_16x16x32_bf16 v[112:115], a[96:99], a[44:47], v[112:115]
v_mfma_f32_16x16x32_bf16 v[116:119], a[104:107], a[44:47], v[116:119]
ds_read_b64_tr_b16 a[96:97], v14 offset:0
v_mfma_f32_16x16x32_bf16 v[116:119], a[108:111], a[60:63], v[116:119]
ds_read_b64_tr_b16 a[98:99], v14 offset:256
v_mfma_f32_16x16x32_bf16 v[108:111], a[108:111], a[56:59], v[108:111]
ds_read_b64_tr_b16 a[100:101], v14 offset:2048
s_add_u32 m0, s16, 0x800
v_mfma_f32_16x16x32_bf16 v[108:111], a[104:107], a[40:43], v[108:111]
buffer_load_dwordx4 v22, s[44:47], s21 offen lds
v_mfma_f32_16x16x32_bf16 v[100:103], a[104:107], a[36:39], v[100:103]
ds_read_b64_tr_b16 a[102:103], v14 offset:2304
v_mfma_f32_16x16x32_bf16 v[100:103], a[108:111], a[52:55], v[100:103]
v_mfma_f32_16x16x32_bf16 v[92:95], a[108:111], a[48:51], v[92:95]
v_mfma_f32_16x16x32_bf16 v[92:95], a[104:107], a[32:35], v[92:95]
s_add_u32 s8, s28, 0x2400
s_waitcnt lgkmcnt(4)
v_mfma_f32_16x16x32_bf16 v[120:123], a[80:83], a[32:35], v[120:123]
buffer_store_dwordx4 a[144:147], v16, s[88:91], s8 offen sc1
v_mfma_f32_16x16x32_bf16 v[120:123], a[84:87], a[48:51], v[120:123]
ds_read_b64_tr_b16 a[104:105], v15 offset:0
v_mfma_f32_16x16x32_bf16 v[128:131], a[84:87], a[52:55], v[128:131]
ds_read_b64_tr_b16 a[106:107], v15 offset:256
v_mfma_f32_16x16x32_bf16 v[128:131], a[80:83], a[36:39], v[128:131]
ds_read_b64_tr_b16 a[108:109], v15 offset:2048
v_mfma_f32_16x16x32_bf16 v[136:139], a[80:83], a[40:43], v[136:139]
ds_read_b64_tr_b16 a[110:111], v15 offset:2304
v_mfma_f32_16x16x32_bf16 v[136:139], a[84:87], a[56:59], v[136:139]
s_add_u32 m0, s16, 0xc00
v_mfma_f32_16x16x32_bf16 v[144:147], a[84:87], a[60:63], v[144:147]
buffer_load_dwordx4 v23, s[44:47], s21 offen lds
v_mfma_f32_16x16x32_bf16 v[144:147], a[80:83], a[44:47], v[144:147]
v_mfma_f32_16x16x32_bf16 v[148:151], a[88:91], a[44:47], v[148:151]
ds_read_b64_tr_b16 a[80:81], v14 offset:4096
v_mfma_f32_16x16x32_bf16 v[148:151], a[92:95], a[60:63], v[148:151]
ds_read_b64_tr_b16 a[82:83], v14 offset:4352
v_mfma_f32_16x16x32_bf16 v[140:143], a[92:95], a[56:59], v[140:143]
ds_read_b64_tr_b16 a[84:85], v14 offset:6144
v_mfma_f32_16x16x32_bf16 v[140:143], a[88:91], a[40:43], v[140:143]
ds_read_b64_tr_b16 a[86:87], v14 offset:6400
s_add_u32 m0, s16, 0x1000
v_mfma_f32_16x16x32_bf16 v[132:135], a[88:91], a[36:39], v[132:135]
buffer_load_dwordx4 v22, s[44:47], s22 offen lds
v_mfma_f32_16x16x32_bf16 v[132:135], a[92:95], a[52:55], v[132:135]
v_mfma_f32_16x16x32_bf16 v[124:127], a[92:95], a[48:51], v[124:127]
v_mfma_f32_16x16x32_bf16 v[124:127], a[88:91], a[32:35], v[124:127]
s_waitcnt lgkmcnt(4)
v_mfma_f32_16x16x32_bf16 v[152:155], a[96:99], a[32:35], v[152:155]
ds_read_b64_tr_b16 a[88:89], v15 offset:4096
s_add_u32 m0, s16, 0x1400
v_mfma_f32_16x16x32_bf16 v[152:155], a[100:103], a[48:51], v[152:155]
buffer_load_dwordx4 v23, s[44:47], s22 offen lds
v_mfma_f32_16x16x32_bf16 v[160:163], a[100:103], a[52:55], v[160:163]
ds_read_b64_tr_b16 a[90:91], v15 offset:4352
v_mfma_f32_16x16x32_bf16 v[160:163], a[96:99], a[36:39], v[160:163]
ds_read_b64_tr_b16 a[92:93], v15 offset:6144
v_mfma_f32_16x16x32_bf16 v[168:171], a[96:99], a[40:43], v[168:171]
ds_read_b64_tr_b16 a[94:95], v15 offset:6400
v_mfma_f32_16x16x32_bf16 v[168:171], a[100:103], a[56:59], v[168:171]
v_mfma_f32_16x16x32_bf16 v[176:179], a[100:103], a[60:63], v[176:179]
s_add_u32 m0, s16, 0x1800
v_mfma_f32_16x16x32_bf16 v[176:179], a[96:99], a[44:47], v[176:179]
buffer_load_dwordx4 v22, s[44:47], s23 offen lds
v_mfma_f32_16x16x32_bf16 v[180:183], a[104:107], a[44:47], v[180:183]
ds_read_b64_tr_b16 a[96:97], v14 offset:8192
v_mfma_f32_16x16x32_bf16 v[180:183], a[108:111], a[60:63], v[180:183]
ds_read_b64_tr_b16 a[98:99], v14 offset:8448
v_mfma_f32_16x16x32_bf16 v[172:175], a[108:111], a[56:59], v[172:175]
ds_read_b64_tr_b16 a[100:101], v14 offset:10240
v_mfma_f32_16x16x32_bf16 v[172:175], a[104:107], a[40:43], v[172:175]
ds_read_b64_tr_b16 a[102:103], v14 offset:10496
s_add_u32 m0, s16, 0x1c00
v_mfma_f32_16x16x32_bf16 v[164:167], a[104:107], a[36:39], v[164:167]
buffer_load_dwordx4 v23, s[44:47], s23 offen lds
v_mfma_f32_16x16x32_bf16 v[164:167], a[108:111], a[52:55], v[164:167]
v_lshl_add_u32 v22, s42, 7, v22
v_lshl_add_u32 v23, s42, 7, v23
v_mfma_f32_16x16x32_bf16 v[156:159], a[108:111], a[48:51], v[156:159]
v_mfma_f32_16x16x32_bf16 v[156:159], a[104:107], a[32:35], v[156:159]
s_waitcnt lgkmcnt(4)
v_mfma_f32_16x16x32_bf16 v[184:187], a[80:83], a[32:35], v[184:187]
ds_read_b64_tr_b16 a[104:105], v15 offset:8192
v_mfma_f32_16x16x32_bf16 v[184:187], a[84:87], a[48:51], v[184:187]
ds_read_b64_tr_b16 a[106:107], v15 offset:8448
s_add_u32 s8, s28, 0x3400
v_mfma_f32_16x16x32_bf16 v[192:195], a[84:87], a[52:55], v[192:195]
buffer_store_dwordx4 a[148:151], v16, s[88:91], s8 offen sc1
v_mfma_f32_16x16x32_bf16 v[192:195], a[80:83], a[36:39], v[192:195]
ds_read_b64_tr_b16 a[108:109], v15 offset:10240
v_mfma_f32_16x16x32_bf16 v[200:203], a[80:83], a[40:43], v[200:203]
ds_read_b64_tr_b16 a[110:111], v15 offset:10496
v_add_u32 v12, 0x8000, v12
v_mfma_f32_16x16x32_bf16 v[200:203], a[84:87], a[56:59], v[200:203]
v_add_u32 v13, 0x8000, v13
v_add_u32 v14, 0x8000, v14
v_mfma_f32_16x16x32_bf16 v[208:211], a[84:87], a[60:63], v[208:211]
v_add_u32 v15, 0x8000, v15
v_mfma_f32_16x16x32_bf16 v[208:211], a[80:83], a[44:47], v[208:211]
v_mfma_f32_16x16x32_bf16 v[212:215], a[88:91], a[44:47], v[212:215]
s_waitcnt vmcnt(28) lgkmcnt(0)
v_mfma_f32_16x16x32_bf16 v[212:215], a[92:95], a[60:63], v[212:215]
s_barrier
s_add_u32 m0, s17, 0x0
v_mfma_f32_16x16x32_bf16 v[204:207], a[92:95], a[56:59], v[204:207]
buffer_load_dwordx4 v5, s[52:55], 0 offen lds
v_mfma_f32_16x16x32_bf16 v[204:207], a[88:91], a[40:43], v[204:207]
ds_read_b64_tr_b16 a[80:81], v12 offset:0
v_mfma_f32_16x16x32_bf16 v[196:199], a[88:91], a[36:39], v[196:199]
ds_read_b64_tr_b16 a[82:83], v12 offset:1024
v_mfma_f32_16x16x32_bf16 v[196:199], a[92:95], a[52:55], v[196:199]
ds_read_b64_tr_b16 a[84:85], v12 offset:8192
v_mfma_f32_16x16x32_bf16 v[188:191], a[92:95], a[48:51], v[188:191]
ds_read_b64_tr_b16 a[86:87], v12 offset:9216
v_mfma_f32_16x16x32_bf16 v[188:191], a[88:91], a[32:35], v[188:191]
s_add_u32 m0, s17, 0x400
s_waitcnt lgkmcnt(4)
v_mfma_f32_16x16x32_bf16 v[216:219], a[32:35], a[96:99], v[216:219]
buffer_load_dwordx4 v5, s[52:55], s13 offen lds
v_mfma_f32_16x16x32_bf16 v[216:219], a[48:51], a[100:103], v[216:219]
ds_read_b64_tr_b16 a[88:89], v13 offset:0
v_mfma_f32_16x16x32_bf16 v[224:227], a[52:55], a[100:103], v[224:227]
ds_read_b64_tr_b16 a[90:91], v13 offset:1024
v_mfma_f32_16x16x32_bf16 v[224:227], a[36:39], a[96:99], v[224:227]
ds_read_b64_tr_b16 a[92:93], v13 offset:8192
v_mfma_f32_16x16x32_bf16 v[232:235], a[40:43], a[96:99], v[232:235]
ds_read_b64_tr_b16 a[94:95], v13 offset:9216
v_mfma_f32_16x16x32_bf16 v[232:235], a[56:59], a[100:103], v[232:235]
v_mfma_f32_16x16x32_bf16 v[240:243], a[60:63], a[100:103], v[240:243]
s_add_u32 m0, s17, 0x800
v_mfma_f32_16x16x32_bf16 v[240:243], a[44:47], a[96:99], v[240:243]
buffer_load_dwordx4 v6, s[52:55], 0 offen lds
v_mfma_f32_16x16x32_bf16 v[244:247], a[44:47], a[104:107], v[244:247]
ds_read_b64_tr_b16 a[96:97], v12 offset:256
v_mfma_f32_16x16x32_bf16 v[244:247], a[60:63], a[108:111], v[244:247]
ds_read_b64_tr_b16 a[98:99], v12 offset:1280
v_mfma_f32_16x16x32_bf16 v[236:239], a[56:59], a[108:111], v[236:239]
ds_read_b64_tr_b16 a[100:101], v12 offset:8448
v_mfma_f32_16x16x32_bf16 v[236:239], a[40:43], a[104:107], v[236:239]
ds_read_b64_tr_b16 a[102:103], v12 offset:9472
v_mfma_f32_16x16x32_bf16 v[228:231], a[36:39], a[104:107], v[228:231]
v_mfma_f32_16x16x32_bf16 v[228:231], a[52:55], a[108:111], v[228:231]
s_add_u32 m0, s17, 0xc00
v_mfma_f32_16x16x32_bf16 v[220:223], a[48:51], a[108:111], v[220:223]
buffer_load_dwordx4 v6, s[52:55], s13 offen lds
v_mfma_f32_16x16x32_bf16 v[220:223], a[32:35], a[104:107], v[220:223]
s_waitcnt lgkmcnt(4)
L_S10:
v_mfma_f32_16x16x32_bf16 v[24:27], a[80:83], a[0:3], v[24:27]
ds_read_b64_tr_b16 a[104:105], v13 offset:256
s_waitcnt vmcnt(23)
v_mfma_f32_16x16x32_bf16 v[24:27], a[84:87], a[16:19], v[24:27]
ds_read_b64_tr_b16 a[106:107], v13 offset:1280
v_mfma_f32_16x16x32_bf16 v[32:35], a[84:87], a[20:23], v[32:35]
ds_read_b64_tr_b16 a[108:109], v13 offset:8448
v_mfma_f32_16x16x32_bf16 v[32:35], a[80:83], a[4:7], v[32:35]
ds_read_b64_tr_b16 a[110:111], v13 offset:9472
v_mfma_f32_16x16x32_bf16 v[40:43], a[80:83], a[8:11], v[40:43]
ds_read_b128 a[32:35], v8 offset:32768
s_add_u32 m0, s18, 0x4000
v_mfma_f32_16x16x32_bf16 v[40:43], a[84:87], a[24:27], v[40:43]
buffer_load_dwordx4 v7, s[68:71], 0 offen lds
v_mfma_f32_16x16x32_bf16 v[48:51], a[84:87], a[28:31], v[48:51]
ds_read_b128 a[48:51], v9 offset:32768
v_mfma_f32_16x16x32_bf16 v[48:51], a[80:83], a[12:15], v[48:51]
ds_read_b128 a[36:39], v8 offset:34816
v_mfma_f32_16x16x32_bf16 v[52:55], a[88:91], a[12:15], v[52:55]
ds_read_b64_tr_b16 a[80:81], v12 offset:512
v_mfma_f32_16x16x32_bf16 v[52:55], a[92:95], a[28:31], v[52:55]
ds_read_b64_tr_b16 a[82:83], v12 offset:1536
v_mfma_f32_16x16x32_bf16 v[44:47], a[92:95], a[24:27], v[44:47]
ds_read_b64_tr_b16 a[84:85], v12 offset:8704
s_add_u32 s8, s28, 0x6400
v_mfma_f32_16x16x32_bf16 v[44:47], a[88:91], a[8:11], v[44:47]
buffer_store_dwordx4 a[152:155], v16, s[88:91], s8 offen sc1
v_mfma_f32_16x16x32_bf16 v[36:39], a[88:91], a[4:7], v[36:39]
ds_read_b64_tr_b16 a[86:87], v12 offset:9728
v_mfma_f32_16x16x32_bf16 v[36:39], a[92:95], a[20:23], v[36:39]
ds_read_b128 a[52:55], v9 offset:34816
v_mfma_f32_16x16x32_bf16 v[28:31], a[92:95], a[16:19], v[28:31]
ds_read_b128 a[40:43], v8 offset:36864
v_mfma_f32_16x16x32_bf16 v[28:31], a[88:91], a[0:3], v[28:31]
ds_read_b128 a[56:59], v9 offset:36864
s_waitcnt lgkmcnt(10)
v_mfma_f32_16x16x32_bf16 v[56:59], a[96:99], a[0:3], v[56:59]
ds_read_b64_tr_b16 a[88:89], v13 offset:512
v_mfma_f32_16x16x32_bf16 v[56:59], a[100:103], a[16:19], v[56:59]
ds_read_b64_tr_b16 a[90:91], v13 offset:1536
s_add_u32 m0, s18, 0x5000
v_mfma_f32_16x16x32_bf16 v[64:67], a[100:103], a[20:23], v[64:67]
buffer_load_dwordx4 v7, s[68:71], s25 offen lds
v_mfma_f32_16x16x32_bf16 v[64:67], a[96:99], a[4:7], v[64:67]
ds_read_b64_tr_b16 a[92:93], v13 offset:8704
v_mfma_f32_16x16x32_bf16 v[72:75], a[96:99], a[8:11], v[72:75]
ds_read_b64_tr_b16 a[94:95], v13 offset:9728
v_mfma_f32_16x16x32_bf16 v[72:75], a[100:103], a[24:27], v[72:75]
ds_read_b128 a[44:47], v8 offset:38912
v_mfma_f32_16x16x32_bf16 v[80:83], a[100:103], a[28:31], v[80:83]
ds_read_b128 a[60:63], v9 offset:38912
v_mfma_f32_16x16x32_bf16 v[80:83], a[96:99], a[12:15], v[80:83]
v_mfma_f32_16x16x32_bf16 v[84:87], a[104:107], a[12:15], v[84:87]
ds_read_b64_tr_b16 a[96:97], v12 offset:768
s_add_u32 m0, s18, 0x6000
v_mfma_f32_16x16x32_bf16 v[84:87], a[108:111], a[28:31], v[84:87]
buffer_load_dwordx4 v7, s[68:71], s26 offen lds
v_mfma_f32_16x16x32_bf16 v[76:79], a[108:111], a[24:27], v[76:79]
ds_read_b64_tr_b16 a[98:99], v12 offset:1792
v_lshl_add_u32 v5, s42, 19, v5
v_mfma_f32_16x16x32_bf16 v[76:79], a[104:107], a[8:11], v[76:79]
ds_read_b64_tr_b16 a[100:101], v12 offset:8960
v_lshl_add_u32 v6, s42, 19, v6
v_mfma_f32_16x16x32_bf16 v[68:71], a[104:107], a[4:7], v[68:71]
ds_read_b64_tr_b16 a[102:103], v12 offset:9984
v_lshl_add_u32 v7, s42, 18, v7
v_mfma_f32_16x16x32_bf16 v[68:71], a[108:111], a[20:23], v[68:71]
v_lshl_add_u32 v7, s42, 17, v7
v_mfma_f32_16x16x32_bf16 v[60:63], a[108:111], a[16:19], v[60:63]
v_mfma_f32_16x16x32_bf16 v[60:63], a[104:107], a[0:3], v[60:63]
s_add_u32 m0, s16, 0x8000
s_waitcnt lgkmcnt(4)
s_waitcnt lgkmcnt(6)
v_mfma_f32_16x16x32_bf16 v[88:91], a[80:83], a[0:3], v[88:91]
buffer_load_dwordx4 v22, s[44:47], s20 offen lds
v_mfma_f32_16x16x32_bf16 v[88:91], a[84:87], a[16:19], v[88:91]
ds_read_b64_tr_b16 a[104:105], v13 offset:768
v_mfma_f32_16x16x32_bf16 v[96:99], a[84:87], a[20:23], v[96:99]
ds_read_b64_tr_b16 a[106:107], v13 offset:1792
v_mfma_f32_16x16x32_bf16 v[96:99], a[80:83], a[4:7], v[96:99]
ds_read_b64_tr_b16 a[108:109], v13 offset:8960
v_mfma_f32_16x16x32_bf16 v[104:107], a[80:83], a[8:11], v[104:107]
ds_read_b64_tr_b16 a[110:111], v13 offset:9984
s_add_u32 m0, s16, 0x8400
v_mfma_f32_16x16x32_bf16 v[104:107], a[84:87], a[24:27], v[104:107]
buffer_load_dwordx4 v23, s[44:47], s20 offen lds
v_mfma_f32_16x16x32_bf16 v[112:115], a[84:87], a[28:31], v[112:115]
v_mfma_f32_16x16x32_bf16 v[112:115], a[80:83], a[12:15], v[112:115]
v_mfma_f32_16x16x32_bf16 v[116:119], a[88:91], a[12:15], v[116:119]
ds_read_b64_tr_b16 a[80:81], v14 offset:0
v_mfma_f32_16x16x32_bf16 v[116:119], a[92:95], a[28:31], v[116:119]
ds_read_b64_tr_b16 a[82:83], v14 offset:256
v_mfma_f32_16x16x32_bf16 v[108:111], a[92:95], a[24:27], v[108:111]
ds_read_b64_tr_b16 a[84:85], v14 offset:2048
s_add_u32 m0, s16, 0x8800
v_mfma_f32_16x16x32_bf16 v[108:111], a[88:91], a[8:11], v[108:111]
buffer_load_dwordx4 v22, s[44:47], s21 offen lds
v_mfma_f32_16x16x32_bf16 v[100:103], a[88:91], a[4:7], v[100:103]
ds_read_b64_tr_b16 a[86:87], v14 offset:2304
v_mfma_f32_16x16x32_bf16 v[100:103], a[92:95], a[20:23], v[100:103]
v_mfma_f32_16x16x32_bf16 v[92:95], a[92:95], a[16:19], v[92:95]
v_mfma_f32_16x16x32_bf16 v[92:95], a[88:91], a[0:3], v[92:95]
s_add_u32 s8, s28, 0x7400
s_waitcnt lgkmcnt(4)
v_mfma_f32_16x16x32_bf16 v[120:123], a[96:99], a[0:3], v[120:123]
buffer_store_dwordx4 a[156:159], v16, s[88:91], s8 offen sc1
v_mfma_f32_16x16x32_bf16 v[120:123], a[100:103], a[16:19], v[120:123]
ds_read_b64_tr_b16 a[88:89], v15 offset:0
v_mfma_f32_16x16x32_bf16 v[128:131], a[100:103], a[20:23], v[128:131]
ds_read_b64_tr_b16 a[90:91], v15 offset:256
v_mfma_f32_16x16x32_bf16 v[128:131], a[96:99], a[4:7], v[128:131]
ds_read_b64_tr_b16 a[92:93], v15 offset:2048
v_mfma_f32_16x16x32_bf16 v[136:139], a[96:99], a[8:11], v[136:139]
ds_read_b64_tr_b16 a[94:95], v15 offset:2304
v_mfma_f32_16x16x32_bf16 v[136:139], a[100:103], a[24:27], v[136:139]
s_add_u32 m0, s16, 0x8c00
v_mfma_f32_16x16x32_bf16 v[144:147], a[100:103], a[28:31], v[144:147]
buffer_load_dwordx4 v23, s[44:47], s21 offen lds
v_mfma_f32_16x16x32_bf16 v[144:147], a[96:99], a[12:15], v[144:147]
v_mfma_f32_16x16x32_bf16 v[148:151], a[104:107], a[12:15], v[148:151]
ds_read_b64_tr_b16 a[96:97], v14 offset:4096
v_mfma_f32_16x16x32_bf16 v[148:151], a[108:111], a[28:31], v[148:151]
ds_read_b64_tr_b16 a[98:99], v14 offset:4352
v_mfma_f32_16x16x32_bf16 v[140:143], a[108:111], a[24:27], v[140:143]
ds_read_b64_tr_b16 a[100:101], v14 offset:6144
v_mfma_f32_16x16x32_bf16 v[140:143], a[104:107], a[8:11], v[140:143]
ds_read_b64_tr_b16 a[102:103], v14 offset:6400
s_add_u32 m0, s16, 0x9000
v_mfma_f32_16x16x32_bf16 v[132:135], a[104:107], a[4:7], v[132:135]
buffer_load_dwordx4 v22, s[44:47], s22 offen lds
v_mfma_f32_16x16x32_bf16 v[132:135], a[108:111], a[20:23], v[132:135]
v_mfma_f32_16x16x32_bf16 v[124:127], a[108:111], a[16:19], v[124:127]
v_mfma_f32_16x16x32_bf16 v[124:127], a[104:107], a[0:3], v[124:127]
s_waitcnt lgkmcnt(4)
v_mfma_f32_16x16x32_bf16 v[152:155], a[80:83], a[0:3], v[152:155]
ds_read_b64_tr_b16 a[104:105], v15 offset:4096
s_add_u32 m0, s16, 0x9400
v_mfma_f32_16x16x32_bf16 v[152:155], a[84:87], a[16:19], v[152:155]
buffer_load_dwordx4 v23, s[44:47], s22 offen lds
v_mfma_f32_16x16x32_bf16 v[160:163], a[84:87], a[20:23], v[160:163]
ds_read_b64_tr_b16 a[106:107], v15 offset:4352
v_mfma_f32_16x16x32_bf16 v[160:163], a[80:83], a[4:7], v[160:163]
ds_read_b64_tr_b16 a[108:109], v15 offset:6144
v_mfma_f32_16x16x32_bf16 v[168:171], a[80:83], a[8:11], v[168:171]
ds_read_b64_tr_b16 a[110:111], v15 offset:6400
v_mfma_f32_16x16x32_bf16 v[168:171], a[84:87], a[24:27], v[168:171]
v_mfma_f32_16x16x32_bf16 v[176:179], a[84:87], a[28:31], v[176:179]
s_add_u32 m0, s16, 0x9800
v_mfma_f32_16x16x32_bf16 v[176:179], a[80:83], a[12:15], v[176:179]
buffer_load_dwordx4 v22, s[44:47], s23 offen lds
v_mfma_f32_16x16x32_bf16 v[180:183], a[88:91], a[12:15], v[180:183]
ds_read_b64_tr_b16 a[80:81], v14 offset:8192
v_mfma_f32_16x16x32_bf16 v[180:183], a[92:95], a[28:31], v[180:183]
ds_read_b64_tr_b16 a[82:83], v14 offset:8448
v_mfma_f32_16x16x32_bf16 v[172:175], a[92:95], a[24:27], v[172:175]
ds_read_b64_tr_b16 a[84:85], v14 offset:10240
v_mfma_f32_16x16x32_bf16 v[172:175], a[88:91], a[8:11], v[172:175]
ds_read_b64_tr_b16 a[86:87], v14 offset:10496
s_add_u32 m0, s16, 0x9c00
v_mfma_f32_16x16x32_bf16 v[164:167], a[88:91], a[4:7], v[164:167]
buffer_load_dwordx4 v23, s[44:47], s23 offen lds
v_mfma_f32_16x16x32_bf16 v[164:167], a[92:95], a[20:23], v[164:167]
v_lshl_add_u32 v22, s42, 7, v22
v_lshl_add_u32 v23, s42, 7, v23
v_mfma_f32_16x16x32_bf16 v[156:159], a[92:95], a[16:19], v[156:159]
v_mfma_f32_16x16x32_bf16 v[156:159], a[88:91], a[0:3], v[156:159]
s_waitcnt lgkmcnt(4)
v_mfma_f32_16x16x32_bf16 v[184:187], a[96:99], a[0:3], v[184:187]
ds_read_b64_tr_b16 a[88:89], v15 offset:8192
v_mfma_f32_16x16x32_bf16 v[184:187], a[100:103], a[16:19], v[184:187]
ds_read_b64_tr_b16 a[90:91], v15 offset:8448
s_add_u32 s8, s28, 0x2800
v_mfma_f32_16x16x32_bf16 v[192:195], a[100:103], a[20:23], v[192:195]
buffer_store_dwordx4 a[160:163], v16, s[88:91], s8 offen sc1
v_mfma_f32_16x16x32_bf16 v[192:195], a[96:99], a[4:7], v[192:195]
ds_read_b64_tr_b16 a[92:93], v15 offset:10240
v_mfma_f32_16x16x32_bf16 v[200:203], a[96:99], a[8:11], v[200:203]
ds_read_b64_tr_b16 a[94:95], v15 offset:10496
v_add_u32 v12, 0x8000, v12
v_mfma_f32_16x16x32_bf16 v[200:203], a[100:103], a[24:27], v[200:203]
v_add_u32 v13, 0x8000, v13
v_add_u32 v14, 0x8000, v14
v_mfma_f32_16x16x32_bf16 v[208:211], a[100:103], a[28:31], v[208:211]
v_add_u32 v15, 0x8000, v15
v_mfma_f32_16x16x32_bf16 v[208:211], a[96:99], a[12:15], v[208:211]
v_mfma_f32_16x16x32_bf16 v[212:215], a[104:107], a[12:15], v[212:215]
s_waitcnt vmcnt(28) lgkmcnt(0)
v_mfma_f32_16x16x32_bf16 v[212:215], a[108:111], a[28:31], v[212:215]
s_barrier
s_add_u32 m0, s17, 0x8000
v_mfma_f32_16x16x32_bf16 v[204:207], a[108:111], a[24:27], v[204:207]
buffer_load_dwordx4 v5, s[52:55], 0 offen lds
v_mfma_f32_16x16x32_bf16 v[204:207], a[104:107], a[8:11], v[204:207]
ds_read_b64_tr_b16 a[96:97], v12 offset:0
v_mfma_f32_16x16x32_bf16 v[196:199], a[104:107], a[4:7], v[196:199]
ds_read_b64_tr_b16 a[98:99], v12 offset:1024
v_mfma_f32_16x16x32_bf16 v[196:199], a[108:111], a[20:23], v[196:199]
ds_read_b64_tr_b16 a[100:101], v12 offset:8192
v_mfma_f32_16x16x32_bf16 v[188:191], a[108:111], a[16:19], v[188:191]
ds_read_b64_tr_b16 a[102:103], v12 offset:9216
v_mfma_f32_16x16x32_bf16 v[188:191], a[104:107], a[0:3], v[188:191]
s_add_u32 m0, s17, 0x8400
s_waitcnt lgkmcnt(4)
v_mfma_f32_16x16x32_bf16 v[216:219], a[0:3], a[80:83], v[216:219]
buffer_load_dwordx4 v5, s[52:55], s13 offen lds
v_mfma_f32_16x16x32_bf16 v[216:219], a[16:19], a[84:87], v[216:219]
ds_read_b64_tr_b16 a[104:105], v13 offset:0
v_mfma_f32_16x16x32_bf16 v[224:227], a[20:23], a[84:87], v[224:227]
ds_read_b64_tr_b16 a[106:107], v13 offset:1024
v_mfma_f32_16x16x32_bf16 v[224:227], a[4:7], a[80:83], v[224:227]
ds_read_b64_tr_b16 a[108:109], v13 offset:8192
v_mfma_f32_16x16x32_bf16 v[232:235], a[8:11], a[80:83], v[232:235]
ds_read_b64_tr_b16 a[110:111], v13 offset:9216
v_mfma_f32_16x16x32_bf16 v[232:235], a[24:27], a[84:87], v[232:235]
v_mfma_f32_16x16x32_bf16 v[240:243], a[28:31], a[84:87], v[240:243]
s_add_u32 m0, s17, 0x8800
v_mfma_f32_16x16x32_bf16 v[240:243], a[12:15], a[80:83], v[240:243]
buffer_load_dwordx4 v6, s[52:55], 0 offen lds
v_mfma_f32_16x16x32_bf16 v[244:247], a[12:15], a[88:91], v[244:247]
ds_read_b64_tr_b16 a[80:81], v12 offset:256
v_mfma_f32_16x16x32_bf16 v[244:247], a[28:31], a[92:95], v[244:247]
ds_read_b64_tr_b16 a[82:83], v12 offset:1280
v_mfma_f32_16x16x32_bf16 v[236:239], a[24:27], a[92:95], v[236:239]
ds_read_b64_tr_b16 a[84:85], v12 offset:8448
v_mfma_f32_16x16x32_bf16 v[236:239], a[8:11], a[88:91], v[236:239]
ds_read_b64_tr_b16 a[86:87], v12 offset:9472
v_mfma_f32_16x16x32_bf16 v[228:231], a[4:7], a[88:91], v[228:231]
v_mfma_f32_16x16x32_bf16 v[228:231], a[20:23], a[92:95], v[228:231]
s_add_u32 m0, s17, 0x8c00
v_mfma_f32_16x16x32_bf16 v[220:223], a[16:19], a[92:95], v[220:223]
buffer_load_dwordx4 v6, s[52:55], s13 offen lds
v_mfma_f32_16x16x32_bf16 v[220:223], a[0:3], a[88:91], v[220:223]
s_waitcnt lgkmcnt(4)
L_S11:
v_mfma_f32_16x16x32_bf16 v[24:27], a[96:99], a[32:35], v[24:27]
ds_read_b64_tr_b16 a[88:89], v13 offset:256
s_waitcnt vmcnt(23)
v_mfma_f32_16x16x32_bf16 v[24:27], a[100:103], a[48:51], v[24:27]
ds_read_b64_tr_b16 a[90:91], v13 offset:1280
v_mfma_f32_16x16x32_bf16 v[32:35], a[100:103], a[52:55], v[32:35]
ds_read_b64_tr_b16 a[92:93], v13 offset:8448
v_mfma_f32_16x16x32_bf16 v[32:35], a[96:99], a[36:39], v[32:35]
ds_read_b64_tr_b16 a[94:95], v13 offset:9472
v_mfma_f32_16x16x32_bf16 v[40:43], a[96:99], a[40:43], v[40:43]
ds_read_b128 a[0:3], v8 offset:0
s_add_u32 m0, s18, 0xc000
v_mfma_f32_16x16x32_bf16 v[40:43], a[100:103], a[56:59], v[40:43]
buffer_load_dwordx4 v7, s[68:71], 0 offen lds
v_mfma_f32_16x16x32_bf16 v[48:51], a[100:103], a[60:63], v[48:51]
ds_read_b128 a[16:19], v9 offset:0
v_mfma_f32_16x16x32_bf16 v[48:51], a[96:99], a[44:47], v[48:51]
ds_read_b128 a[4:7], v8 offset:2048
v_mfma_f32_16x16x32_bf16 v[52:55], a[104:107], a[44:47], v[52:55]
ds_read_b64_tr_b16 a[96:97], v12 offset:512
v_mfma_f32_16x16x32_bf16 v[52:55], a[108:111], a[60:63], v[52:55]
ds_read_b64_tr_b16 a[98:99], v12 offset:1536
v_mfma_f32_16x16x32_bf16 v[44:47], a[108:111], a[56:59], v[44:47]
ds_read_b64_tr_b16 a[100:101], v12 offset:8704
s_add_u32 s8, s28, 0x3800
v_mfma_f32_16x16x32_bf16 v[44:47], a[104:107], a[40:43], v[44:47]
buffer_store_dwordx4 a[164:167], v16, s[88:91], s8 offen sc1
v_mfma_f32_16x16x32_bf16 v[36:39], a[104:107], a[36:39], v[36:39]
ds_read_b64_tr_b16 a[102:103], v12 offset:9728
v_mfma_f32_16x16x32_bf16 v[36:39], a[108:111], a[52:55], v[36:39]
ds_read_b128 a[20:23], v9 offset:2048
v_mfma_f32_16x16x32_bf16 v[28:31], a[108:111], a[48:51], v[28:31]
ds_read_b128 a[8:11], v8 offset:4096
v_mfma_f32_16x16x32_bf16 v[28:31], a[104:107], a[32:35], v[28:31]
ds_read_b128 a[24:27], v9 offset:4096
s_waitcnt lgkmcnt(10)
v_mfma_f32_16x16x32_bf16 v[56:59], a[80:83], a[32:35], v[56:59]
ds_read_b64_tr_b16 a[104:105], v13 offset:512
v_mfma_f32_16x16x32_bf16 v[56:59], a[84:87], a[48:51], v[56:59]
ds_read_b64_tr_b16 a[106:107], v13 offset:1536
s_add_u32 m0, s18, 0xd000
v_mfma_f32_16x16x32_bf16 v[64:67], a[84:87], a[52:55], v[64:67]
buffer_load_dwordx4 v7, s[68:71], s25 offen lds
v_mfma_f32_16x16x32_bf16 v[64:67], a[80:83], a[36:39], v[64:67]
ds_read_b64_tr_b16 a[108:109], v13 offset:8704
v_mfma_f32_16x16x32_bf16 v[72:75], a[80:83], a[40:43], v[72:75]
ds_read_b64_tr_b16 a[110:111], v13 offset:9728
v_mfma_f32_16x16x32_bf16 v[72:75], a[84:87], a[56:59], v[72:75]
ds_read_b128 a[12:15], v8 offset:6144
v_mfma_f32_16x16x32_bf16 v[80:83], a[84:87], a[60:63], v[80:83]
ds_read_b128 a[28:31], v9 offset:6144
v_mfma_f32_16x16x32_bf16 v[80:83], a[80:83], a[44:47], v[80:83]
v_mfma_f32_16x16x32_bf16 v[84:87], a[88:91], a[44:47], v[84:87]
ds_read_b64_tr_b16 a[80:81], v12 offset:768
s_add_u32 m0, s18, 0xe000
v_mfma_f32_16x16x32_bf16 v[84:87], a[92:95], a[60:63], v[84:87]
buffer_load_dwordx4 v7, s[68:71], s26 offen lds
v_mfma_f32_16x16x32_bf16 v[76:79], a[92:95], a[56:59], v[76:79]
ds_read_b64_tr_b16 a[82:83], v12 offset:1792
v_lshl_add_u32 v5, s42, 19, v5
v_mfma_f32_16x16x32_bf16 v[76:79], a[88:91], a[40:43], v[76:79]
ds_read_b64_tr_b16 a[84:85], v12 offset:8960
v_lshl_add_u32 v6, s42, 19, v6
v_mfma_f32_16x16x32_bf16 v[68:71], a[88:91], a[36:39], v[68:71]
ds_read_b64_tr_b16 a[86:87], v12 offset:9984
v_lshl_add_u32 v7, s42, 18, v7
v_mfma_f32_16x16x32_bf16 v[68:71], a[92:95], a[52:55], v[68:71]
L_padA6:
s_cmp_eq_u32 s95, 1
s_cbranch_scc1 L_padA10
v_lshl_add_u32 v7, s42, 17, v7
v_mfma_f32_16x16x32_bf16 v[60:63], a[92:95], a[48:51], v[60:63]
v_mfma_f32_16x16x32_bf16 v[60:63], a[88:91], a[32:35], v[60:63]
s_add_u32 m0, s16, 0x0
s_waitcnt lgkmcnt(4)
s_waitcnt lgkmcnt(6)
v_mfma_f32_16x16x32_bf16 v[88:91], a[96:99], a[32:35], v[88:91]
buffer_load_dwordx4 v22, s[44:47], s20 offen lds
v_mfma_f32_16x16x32_bf16 v[88:91], a[100:103], a[48:51], v[88:91]
ds_read_b64_tr_b16 a[88:89], v13 offset:768
v_mfma_f32_16x16x32_bf16 v[96:99], a[100:103], a[52:55], v[96:99]
ds_read_b64_tr_b16 a[90:91], v13 offset:1792
v_mfma_f32_16x16x32_bf16 v[96:99], a[96:99], a[36:39], v[96:99]
ds_read_b64_tr_b16 a[92:93], v13 offset:8960
v_mfma_f32_16x16x32_bf16 v[104:107], a[96:99], a[40:43], v[104:107]
ds_read_b64_tr_b16 a[94:95], v13 offset:9984
s_add_u32 m0, s16, 0x400
v_mfma_f32_16x16x32_bf16 v[104:107], a[100:103], a[56:59], v[104:107]
buffer_load_dwordx4 v23, s[44:47], s20 offen lds
v_mfma_f32_16x16x32_bf16 v[112:115], a[100:103], a[60:63], v[112:115]
v_mfma_f32_16x16x32_bf16 v[112:115], a[96:99], a[44:47], v[112:115]
v_mfma_f32_16x16x32_bf16 v[116:119], a[104:107], a[44:47], v[116:119]
ds_read_b64_tr_b16 a[96:97], v14 offset:0
v_mfma_f32_16x16x32_bf16 v[116:119], a[108:111], a[60:63], v[116:119]
ds_read_b64_tr_b16 a[98:99], v14 offset:256
v_mfma_f32_16x16x32_bf16 v[108:111], a[108:111], a[56:59], v[108:111]
ds_read_b64_tr_b16 a[100:101], v14 offset:2048
s_add_u32 m0, s16, 0x800
v_mfma_f32_16x16x32_bf16 v[108:111], a[104:107], a[40:43], v[108:111]
buffer_load_dwordx4 v22, s[44:47], s21 offen lds
v_mfma_f32_16x16x32_bf16 v[100:103], a[104:107], a[36:39], v[100:103]
ds_read_b64_tr_b16 a[102:103], v14 offset:2304
v_mfma_f32_16x16x32_bf16 v[100:103], a[108:111], a[52:55], v[100:103]
v_mfma_f32_16x16x32_bf16 v[92:95], a[108:111], a[48:51], v[92:95]
v_mfma_f32_16x16x32_bf16 v[92:95], a[104:107], a[32:35], v[92:95]
s_add_u32 s8, s28, 0x6800
s_waitcnt lgkmcnt(4)
v_mfma_f32_16x16x32_bf16 v[120:123], a[80:83], a[32:35], v[120:123]
buffer_store_dwordx4 a[168:171], v16, s[88:91], s8 offen sc1
v_mfma_f32_16x16x32_bf16 v[120:123], a[84:87], a[48:51], v[120:123]
ds_read_b64_tr_b16 a[104:105], v15 offset:0
v_mfma_f32_16x16x32_bf16 v[128:131], a[84:87], a[52:55], v[128:131]
ds_read_b64_tr_b16 a[106:107], v15 offset:256
v_mfma_f32_16x16x32_bf16 v[128:131], a[80:83], a[36:39], v[128:131]
ds_read_b64_tr_b16 a[108:109], v15 offset:2048
v_mfma_f32_16x16x32_bf16 v[136:139], a[80:83], a[40:43], v[136:139]
ds_read_b64_tr_b16 a[110:111], v15 offset:2304
v_mfma_f32_16x16x32_bf16 v[136:139], a[84:87], a[56:59], v[136:139]
s_add_u32 m0, s16, 0xc00
v_mfma_f32_16x16x32_bf16 v[144:147], a[84:87], a[60:63], v[144:147]
buffer_load_dwordx4 v23, s[44:47], s21 offen lds
v_mfma_f32_16x16x32_bf16 v[144:147], a[80:83], a[44:47], v[144:147]
v_mfma_f32_16x16x32_bf16 v[148:151], a[88:91], a[44:47], v[148:151]
ds_read_b64_tr_b16 a[80:81], v14 offset:4096
v_mfma_f32_16x16x32_bf16 v[148:151], a[92:95], a[60:63], v[148:151]
ds_read_b64_tr_b16 a[82:83], v14 offset:4352
v_mfma_f32_16x16x32_bf16 v[140:143], a[92:95], a[56:59], v[140:143]
ds_read_b64_tr_b16 a[84:85], v14 offset:6144
v_mfma_f32_16x16x32_bf16 v[140:143], a[88:91], a[40:43], v[140:143]
ds_read_b64_tr_b16 a[86:87], v14 offset:6400
s_add_u32 m0, s16, 0x1000
v_mfma_f32_16x16x32_bf16 v[132:135], a[88:91], a[36:39], v[132:135]
buffer_load_dwordx4 v22, s[44:47], s22 offen lds
v_mfma_f32_16x16x32_bf16 v[132:135], a[92:95], a[52:55], v[132:135]
v_mfma_f32_16x16x32_bf16 v[124:127], a[92:95], a[48:51], v[124:127]
v_mfma_f32_16x16x32_bf16 v[124:127], a[88:91], a[32:35], v[124:127]
s_waitcnt lgkmcnt(4)
v_mfma_f32_16x16x32_bf16 v[152:155], a[96:99], a[32:35], v[152:155]
ds_read_b64_tr_b16 a[88:89], v15 offset:4096
s_add_u32 m0, s16, 0x1400
v_mfma_f32_16x16x32_bf16 v[152:155], a[100:103], a[48:51], v[152:155]
buffer_load_dwordx4 v23, s[44:47], s22 offen lds
v_mfma_f32_16x16x32_bf16 v[160:163], a[100:103], a[52:55], v[160:163]
ds_read_b64_tr_b16 a[90:91], v15 offset:4352
v_mfma_f32_16x16x32_bf16 v[160:163], a[96:99], a[36:39], v[160:163]
ds_read_b64_tr_b16 a[92:93], v15 offset:6144
v_mfma_f32_16x16x32_bf16 v[168:171], a[96:99], a[40:43], v[168:171]
ds_read_b64_tr_b16 a[94:95], v15 offset:6400
v_mfma_f32_16x16x32_bf16 v[168:171], a[100:103], a[56:59], v[168:171]
v_mfma_f32_16x16x32_bf16 v[176:179], a[100:103], a[60:63], v[176:179]
s_add_u32 m0, s16, 0x1800
v_mfma_f32_16x16x32_bf16 v[176:179], a[96:99], a[44:47], v[176:179]
buffer_load_dwordx4 v22, s[44:47], s23 offen lds
v_mfma_f32_16x16x32_bf16 v[180:183], a[104:107], a[44:47], v[180:183]
ds_read_b64_tr_b16 a[96:97], v14 offset:8192
v_mfma_f32_16x16x32_bf16 v[180:183], a[108:111], a[60:63], v[180:183]
ds_read_b64_tr_b16 a[98:99], v14 offset:8448
v_mfma_f32_16x16x32_bf16 v[172:175], a[108:111], a[56:59], v[172:175]
ds_read_b64_tr_b16 a[100:101], v14 offset:10240
v_mfma_f32_16x16x32_bf16 v[172:175], a[104:107], a[40:43], v[172:175]
ds_read_b64_tr_b16 a[102:103], v14 offset:10496
s_add_u32 m0, s16, 0x1c00
v_mfma_f32_16x16x32_bf16 v[164:167], a[104:107], a[36:39], v[164:167]
buffer_load_dwordx4 v23, s[44:47], s23 offen lds
v_mfma_f32_16x16x32_bf16 v[164:167], a[108:111], a[52:55], v[164:167]
v_lshl_add_u32 v22, s42, 7, v22
v_lshl_add_u32 v23, s42, 7, v23
v_mfma_f32_16x16x32_bf16 v[156:159], a[108:111], a[48:51], v[156:159]
v_mfma_f32_16x16x32_bf16 v[156:159], a[104:107], a[32:35], v[156:159]
s_waitcnt lgkmcnt(4)
v_mfma_f32_16x16x32_bf16 v[184:187], a[80:83], a[32:35], v[184:187]
ds_read_b64_tr_b16 a[104:105], v15 offset:8192
v_mfma_f32_16x16x32_bf16 v[184:187], a[84:87], a[48:51], v[184:187]
ds_read_b64_tr_b16 a[106:107], v15 offset:8448
s_add_u32 s8, s28, 0x7800
v_mfma_f32_16x16x32_bf16 v[192:195], a[84:87], a[52:55], v[192:195]
buffer_store_dwordx4 a[172:175], v16, s[88:91], s8 offen sc1
v_mfma_f32_16x16x32_bf16 v[192:195], a[80:83], a[36:39], v[192:195]
ds_read_b64_tr_b16 a[108:109], v15 offset:10240
v_mfma_f32_16x16x32_bf16 v[200:203], a[80:83], a[40:43], v[200:203]
ds_read_b64_tr_b16 a[110:111], v15 offset:10496
v_add_u32 v12, 0xffff0000, v12
v_mfma_f32_16x16x32_bf16 v[200:203], a[84:87], a[56:59], v[200:203]
v_add_u32 v13, 0xffff0000, v13
v_add_u32 v14, 0xffff0000, v14
v_mfma_f32_16x16x32_bf16 v[208:211], a[84:87], a[60:63], v[208:211]
v_add_u32 v15, 0xffff0000, v15
v_mfma_f32_16x16x32_bf16 v[208:211], a[80:83], a[44:47], v[208:211]
v_mfma_f32_16x16x32_bf16 v[212:215], a[88:91], a[44:47], v[212:215]
s_waitcnt vmcnt(28) lgkmcnt(0)
v_mfma_f32_16x16x32_bf16 v[212:215], a[92:95], a[60:63], v[212:215]
s_barrier
s_add_u32 m0, s17, 0x10000
v_mfma_f32_16x16x32_bf16 v[204:207], a[92:95], a[56:59], v[204:207]
buffer_load_dwordx4 v5, s[52:55], 0 offen lds
v_mfma_f32_16x16x32_bf16 v[204:207], a[88:91], a[40:43], v[204:207]
ds_read_b64_tr_b16 a[80:81], v12 offset:0
v_mfma_f32_16x16x32_bf16 v[196:199], a[88:91], a[36:39], v[196:199]
ds_read_b64_tr_b16 a[82:83], v12 offset:1024
v_mfma_f32_16x16x32_bf16 v[196:199], a[92:95], a[52:55], v[196:199]
ds_read_b64_tr_b16 a[84:85], v12 offset:8192
v_mfma_f32_16x16x32_bf16 v[188:191], a[92:95], a[48:51], v[188:191]
ds_read_b64_tr_b16 a[86:87], v12 offset:9216
v_mfma_f32_16x16x32_bf16 v[188:191], a[88:91], a[32:35], v[188:191]
s_add_u32 m0, s17, 0x10400
s_waitcnt lgkmcnt(4)
v_mfma_f32_16x16x32_bf16 v[216:219], a[32:35], a[96:99], v[216:219]
buffer_load_dwordx4 v5, s[52:55], s13 offen lds
v_mfma_f32_16x16x32_bf16 v[216:219], a[48:51], a[100:103], v[216:219]
ds_read_b64_tr_b16 a[88:89], v13 offset:0
v_mfma_f32_16x16x32_bf16 v[224:227], a[52:55], a[100:103], v[224:227]
ds_read_b64_tr_b16 a[90:91], v13 offset:1024
v_mfma_f32_16x16x32_bf16 v[224:227], a[36:39], a[96:99], v[224:227]
ds_read_b64_tr_b16 a[92:93], v13 offset:8192
v_mfma_f32_16x16x32_bf16 v[232:235], a[40:43], a[96:99], v[232:235]
ds_read_b64_tr_b16 a[94:95], v13 offset:9216
v_mfma_f32_16x16x32_bf16 v[232:235], a[56:59], a[100:103], v[232:235]
s_add_u32 m0, s17, 0x10800
v_mfma_f32_16x16x32_bf16 v[240:243], a[60:63], a[100:103], v[240:243]
buffer_load_dwordx4 v6, s[52:55], 0 offen lds
v_mfma_f32_16x16x32_bf16 v[240:243], a[44:47], a[96:99], v[240:243]
v_mfma_f32_16x16x32_bf16 v[244:247], a[44:47], a[104:107], v[244:247]
ds_read_b64_tr_b16 a[96:97], v12 offset:256
v_mfma_f32_16x16x32_bf16 v[244:247], a[60:63], a[108:111], v[244:247]
ds_read_b64_tr_b16 a[98:99], v12 offset:1280
v_mfma_f32_16x16x32_bf16 v[236:239], a[56:59], a[108:111], v[236:239]
ds_read_b64_tr_b16 a[100:101], v12 offset:8448
v_mfma_f32_16x16x32_bf16 v[236:239], a[40:43], a[104:107], v[236:239]
ds_read_b64_tr_b16 a[102:103], v12 offset:9472
s_add_u32 s8, s28, 0x2c00
v_mfma_f32_16x16x32_bf16 v[228:231], a[36:39], a[104:107], v[228:231]
buffer_store_dwordx4 a[176:179], v16, s[88:91], s8 offen sc1
v_mfma_f32_16x16x32_bf16 v[228:231], a[52:55], a[108:111], v[228:231]
v_mfma_f32_16x16x32_bf16 v[220:223], a[48:51], a[108:111], v[220:223]
v_mfma_f32_16x16x32_bf16 v[220:223], a[32:35], a[104:107], v[220:223]
s_waitcnt lgkmcnt(4)
L_S12:
v_mfma_f32_16x16x32_bf16 v[24:27], a[80:83], a[0:3], v[24:27]
ds_read_b64_tr_b16 a[104:105], v13 offset:256
s_waitcnt vmcnt(23)
v_mfma_f32_16x16x32_bf16 v[24:27], a[84:87], a[16:19], v[24:27]
ds_read_b64_tr_b16 a[106:107], v13 offset:1280
s_add_u32 m0, s17, 0x10c00
v_mfma_f32_16x16x32_bf16 v[32:35], a[84:87], a[20:23], v[32:35]
buffer_load_dwordx4 v6, s[52:55], s13 offen lds
v_mfma_f32_16x16x32_bf16 v[32:35], a[80:83], a[4:7], v[32:35]
ds_read_b64_tr_b16 a[108:109], v13 offset:8448
v_mfma_f32_16x16x32_bf16 v[40:43], a[80:83], a[8:11], v[40:43]
ds_read_b64_tr_b16 a[110:111], v13 offset:9472
v_mfma_f32_16x16x32_bf16 v[40:43], a[84:87], a[24:27], v[40:43]
ds_read_b128 a[32:35], v8 offset:32768
v_mfma_f32_16x16x32_bf16 v[48:51], a[84:87], a[28:31], v[48:51]
ds_read_b128 a[48:51], v9 offset:32768
v_mfma_f32_16x16x32_bf16 v[48:51], a[80:83], a[12:15], v[48:51]
ds_read_b128 a[36:39], v8 offset:34816
s_add_u32 m0, s18, 0x14000
v_mfma_f32_16x16x32_bf16 v[52:55], a[88:91], a[12:15], v[52:55]
buffer_load_dwordx4 v7, s[68:71], 0 offen lds
v_mfma_f32_16x16x32_bf16 v[52:55], a[92:95], a[28:31], v[52:55]
ds_read_b64_tr_b16 a[80:81], v12 offset:512
v_mfma_f32_16x16x32_bf16 v[44:47], a[92:95], a[24:27], v[44:47]
ds_read_b64_tr_b16 a[82:83], v12 offset:1536
v_mfma_f32_16x16x32_bf16 v[44:47], a[88:91], a[8:11], v[44:47]
ds_read_b64_tr_b16 a[84:85], v12 offset:8704
v_mfma_f32_16x16x32_bf16 v[36:39], a[88:91], a[4:7], v[36:39]
ds_read_b64_tr_b16 a[86:87], v12 offset:9728
v_mfma_f32_16x16x32_bf16 v[36:39], a[92:95], a[20:23], v[36:39]
ds_read_b128 a[52:55], v9 offset:34816
s_add_u32 m0, s18, 0x15000
v_mfma_f32_16x16x32_bf16 v[28:31], a[92:95], a[16:19], v[28:31]
buffer_load_dwordx4 v7, s[68:71], s25 offen lds
v_mfma_f32_16x16x32_bf16 v[28:31], a[88:91], a[0:3], v[28:31]
ds_read_b128 a[40:43], v8 offset:36864
s_waitcnt lgkmcnt(9)
v_mfma_f32_16x16x32_bf16 v[56:59], a[96:99], a[0:3], v[56:59]
ds_read_b64_tr_b16 a[88:89], v13 offset:512
v_mfma_f32_16x16x32_bf16 v[56:59], a[100:103], a[16:19], v[56:59]
ds_read_b64_tr_b16 a[90:91], v13 offset:1536
v_mfma_f32_16x16x32_bf16 v[64:67], a[100:103], a[20:23], v[64:67]
ds_read_b64_tr_b16 a[92:93], v13 offset:8704
v_mfma_f32_16x16x32_bf16 v[64:67], a[96:99], a[4:7], v[64:67]
ds_read_b64_tr_b16 a[94:95], v13 offset:9728
s_add_u32 m0, s18, 0x16000
v_mfma_f32_16x16x32_bf16 v[72:75], a[96:99], a[8:11], v[72:75]
buffer_load_dwordx4 v7, s[68:71], s26 offen lds
v_mfma_f32_16x16x32_bf16 v[72:75], a[100:103], a[24:27], v[72:75]
ds_read_b128 a[56:59], v9 offset:36864
v_lshl_add_u32 v5, s42, 19, v5
v_mfma_f32_16x16x32_bf16 v[80:83], a[100:103], a[28:31], v[80:83]
ds_read_b128 a[44:47], v8 offset:38912
v_lshl_add_u32 v6, s42, 19, v6
v_mfma_f32_16x16x32_bf16 v[80:83], a[96:99], a[12:15], v[80:83]
ds_read_b128 a[60:63], v9 offset:38912
v_lshl_add_u32 v7, s42, 18, v7
v_mfma_f32_16x16x32_bf16 v[84:87], a[104:107], a[12:15], v[84:87]
ds_read_b64_tr_b16 a[96:97], v12 offset:768
v_lshl_add_u32 v7, s42, 17, v7
v_mfma_f32_16x16x32_bf16 v[84:87], a[108:111], a[28:31], v[84:87]
ds_read_b64_tr_b16 a[98:99], v12 offset:1792
s_add_u32 s8, s28, 0x3c00
v_mfma_f32_16x16x32_bf16 v[76:79], a[108:111], a[24:27], v[76:79]
buffer_store_dwordx4 a[180:183], v16, s[88:91], s8 offen sc1
v_mfma_f32_16x16x32_bf16 v[76:79], a[104:107], a[8:11], v[76:79]
ds_read_b64_tr_b16 a[100:101], v12 offset:8960
v_mfma_f32_16x16x32_bf16 v[68:71], a[104:107], a[4:7], v[68:71]
ds_read_b64_tr_b16 a[102:103], v12 offset:9984
v_mfma_f32_16x16x32_bf16 v[68:71], a[108:111], a[20:23], v[68:71]
v_mfma_f32_16x16x32_bf16 v[60:63], a[108:111], a[16:19], v[60:63]
v_mfma_f32_16x16x32_bf16 v[60:63], a[104:107], a[0:3], v[60:63]
s_add_u32 m0, s16, 0x8000
s_waitcnt lgkmcnt(4)
s_waitcnt lgkmcnt(7)
v_mfma_f32_16x16x32_bf16 v[88:91], a[80:83], a[0:3], v[88:91]
buffer_load_dwordx4 v22, s[44:47], s20 offen lds
v_mfma_f32_16x16x32_bf16 v[88:91], a[84:87], a[16:19], v[88:91]
ds_read_b64_tr_b16 a[104:105], v13 offset:768
v_mfma_f32_16x16x32_bf16 v[96:99], a[84:87], a[20:23], v[96:99]
ds_read_b64_tr_b16 a[106:107], v13 offset:1792
v_mfma_f32_16x16x32_bf16 v[96:99], a[80:83], a[4:7], v[96:99]
ds_read_b64_tr_b16 a[108:109], v13 offset:8960
v_mfma_f32_16x16x32_bf16 v[104:107], a[80:83], a[8:11], v[104:107]
ds_read_b64_tr_b16 a[110:111], v13 offset:9984
s_add_u32 m0, s16, 0x8400
v_mfma_f32_16x16x32_bf16 v[104:107], a[84:87], a[24:27], v[104:107]
buffer_load_dwordx4 v23, s[44:47], s20 offen lds
v_mfma_f32_16x16x32_bf16 v[112:115], a[84:87], a[28:31], v[112:115]
v_mfma_f32_16x16x32_bf16 v[112:115], a[80:83], a[12:15], v[112:115]
v_mfma_f32_16x16x32_bf16 v[116:119], a[88:91], a[12:15], v[116:119]
ds_read_b64_tr_b16 a[80:81], v14 offset:0
v_mfma_f32_16x16x32_bf16 v[116:119], a[92:95], a[28:31], v[116:119]
ds_read_b64_tr_b16 a[82:83], v14 offset:256
v_mfma_f32_16x16x32_bf16 v[108:111], a[92:95], a[24:27], v[108:111]
ds_read_b64_tr_b16 a[84:85], v14 offset:2048
s_add_u32 m0, s16, 0x8800
v_mfma_f32_16x16x32_bf16 v[108:111], a[88:91], a[8:11], v[108:111]
buffer_load_dwordx4 v22, s[44:47], s21 offen lds
v_mfma_f32_16x16x32_bf16 v[100:103], a[88:91], a[4:7], v[100:103]
ds_read_b64_tr_b16 a[86:87], v14 offset:2304
v_mfma_f32_16x16x32_bf16 v[100:103], a[92:95], a[20:23], v[100:103]
v_mfma_f32_16x16x32_bf16 v[92:95], a[92:95], a[16:19], v[92:95]
v_mfma_f32_16x16x32_bf16 v[92:95], a[88:91], a[0:3], v[92:95]
s_add_u32 m0, s16, 0x8c00
s_waitcnt lgkmcnt(4)
v_mfma_f32_16x16x32_bf16 v[120:123], a[96:99], a[0:3], v[120:123]
buffer_load_dwordx4 v23, s[44:47], s21 offen lds
v_mfma_f32_16x16x32_bf16 v[120:123], a[100:103], a[16:19], v[120:123]
ds_read_b64_tr_b16 a[88:89], v15 offset:0
v_mfma_f32_16x16x32_bf16 v[128:131], a[100:103], a[20:23], v[128:131]
ds_read_b64_tr_b16 a[90:91], v15 offset:256
v_mfma_f32_16x16x32_bf16 v[128:131], a[96:99], a[4:7], v[128:131]
ds_read_b64_tr_b16 a[92:93], v15 offset:2048
v_mfma_f32_16x16x32_bf16 v[136:139], a[96:99], a[8:11], v[136:139]
ds_read_b64_tr_b16 a[94:95], v15 offset:2304
v_mfma_f32_16x16x32_bf16 v[136:139], a[100:103], a[24:27], v[136:139]
s_add_u32 s8, s28, 0x6c00
v_mfma_f32_16x16x32_bf16 v[144:147], a[100:103], a[28:31], v[144:147]
buffer_store_dwordx4 a[184:187], v16, s[88:91], s8 offen sc1
v_mfma_f32_16x16x32_bf16 v[144:147], a[96:99], a[12:15], v[144:147]
v_mfma_f32_16x16x32_bf16 v[148:151], a[104:107], a[12:15], v[148:151]
ds_read_b64_tr_b16 a[96:97], v14 offset:4096
v_mfma_f32_16x16x32_bf16 v[148:151], a[108:111], a[28:31], v[148:151]
ds_read_b64_tr_b16 a[98:99], v14 offset:4352
v_mfma_f32_16x16x32_bf16 v[140:143], a[108:111], a[24:27], v[140:143]
ds_read_b64_tr_b16 a[100:101], v14 offset:6144
v_mfma_f32_16x16x32_bf16 v[140:143], a[104:107], a[8:11], v[140:143]
ds_read_b64_tr_b16 a[102:103], v14 offset:6400
s_add_u32 m0, s16, 0x9000
v_mfma_f32_16x16x32_bf16 v[132:135], a[104:107], a[4:7], v[132:135]
buffer_load_dwordx4 v22, s[44:47], s22 offen lds
v_mfma_f32_16x16x32_bf16 v[132:135], a[108:111], a[20:23], v[132:135]
v_mfma_f32_16x16x32_bf16 v[124:127], a[108:111], a[16:19], v[124:127]
v_mfma_f32_16x16x32_bf16 v[124:127], a[104:107], a[0:3], v[124:127]
s_waitcnt lgkmcnt(4)
v_mfma_f32_16x16x32_bf16 v[152:155], a[80:83], a[0:3], v[152:155]
ds_read_b64_tr_b16 a[104:105], v15 offset:4096
s_add_u32 m0, s16, 0x9400
v_mfma_f32_16x16x32_bf16 v[152:155], a[84:87], a[16:19], v[152:155]
buffer_load_dwordx4 v23, s[44:47], s22 offen lds
v_mfma_f32_16x16x32_bf16 v[160:163], a[84:87], a[20:23], v[160:163]
ds_read_b64_tr_b16 a[106:107], v15 offset:4352
v_mfma_f32_16x16x32_bf16 v[160:163], a[80:83], a[4:7], v[160:163]
ds_read_b64_tr_b16 a[108:109], v15 offset:6144
v_mfma_f32_16x16x32_bf16 v[168:171], a[80:83], a[8:11], v[168:171]
ds_read_b64_tr_b16 a[110:111], v15 offset:6400
v_mfma_f32_16x16x32_bf16 v[168:171], a[84:87], a[24:27], v[168:171]
v_mfma_f32_16x16x32_bf16 v[176:179], a[84:87], a[28:31], v[176:179]
s_add_u32 m0, s16, 0x9800
v_mfma_f32_16x16x32_bf16 v[176:179], a[80:83], a[12:15], v[176:179]
buffer_load_dwordx4 v22, s[44:47], s23 offen lds
v_mfma_f32_16x16x32_bf16 v[180:183], a[88:91], a[12:15], v[180:183]
ds_read_b64_tr_b16 a[80:81], v14 offset:8192
v_mfma_f32_16x16x32_bf16 v[180:183], a[92:95], a[28:31], v[180:183]
ds_read_b64_tr_b16 a[82:83], v14 offset:8448
v_mfma_f32_16x16x32_bf16 v[172:175], a[92:95], a[24:27], v[172:175]
ds_read_b64_tr_b16 a[84:85], v14 offset:10240
v_mfma_f32_16x16x32_bf16 v[172:175], a[88:91], a[8:11], v[172:175]
ds_read_b64_tr_b16 a[86:87], v14 offset:10496
s_add_u32 m0, s16, 0x9c00
v_mfma_f32_16x16x32_bf16 v[164:167], a[88:91], a[4:7], v[164:167]
buffer_load_dwordx4 v23, s[44:47], s23 offen lds
v_mfma_f32_16x16x32_bf16 v[164:167], a[92:95], a[20:23], v[164:167]
v_lshl_add_u32 v22, s42, 7, v22
v_lshl_add_u32 v23, s42, 7, v23
v_mfma_f32_16x16x32_bf16 v[156:159], a[92:95], a[16:19], v[156:159]
v_mfma_f32_16x16x32_bf16 v[156:159], a[88:91], a[0:3], v[156:159]
s_waitcnt lgkmcnt(4)
v_mfma_f32_16x16x32_bf16 v[184:187], a[96:99], a[0:3], v[184:187]
ds_read_b64_tr_b16 a[88:89], v15 offset:8192
v_mfma_f32_16x16x32_bf16 v[184:187], a[100:103], a[16:19], v[184:187]
ds_read_b64_tr_b16 a[90:91], v15 offset:8448
s_add_u32 s8, s28, 0x7c00
v_mfma_f32_16x16x32_bf16 v[192:195], a[100:103], a[20:23], v[192:195]
buffer_store_dwordx4 a[188:191], v16, s[88:91], s8 offen sc1
v_mfma_f32_16x16x32_bf16 v[192:195], a[96:99], a[4:7], v[192:195]
ds_read_b64_tr_b16 a[92:93], v15 offset:10240
v_mfma_f32_16x16x32_bf16 v[200:203], a[96:99], a[8:11], v[200:203]
ds_read_b64_tr_b16 a[94:95], v15 offset:10496
v_add_u32 v12, 0x8000, v12
v_mfma_f32_16x16x32_bf16 v[200:203], a[100:103], a[24:27], v[200:203]
v_add_u32 v13, 0x8000, v13
v_add_u32 v14, 0x8000, v14
v_mfma_f32_16x16x32_bf16 v[208:211], a[100:103], a[28:31], v[208:211]
v_add_u32 v15, 0x8000, v15
v_mfma_f32_16x16x32_bf16 v[208:211], a[96:99], a[12:15], v[208:211]
v_mfma_f32_16x16x32_bf16 v[212:215], a[104:107], a[12:15], v[212:215]
s_waitcnt vmcnt(29) lgkmcnt(0)
v_mfma_f32_16x16x32_bf16 v[212:215], a[108:111], a[28:31], v[212:215]
s_barrier
s_add_u32 m0, s17, 0x0
v_mfma_f32_16x16x32_bf16 v[204:207], a[108:111], a[24:27], v[204:207]
buffer_load_dwordx4 v5, s[52:55], 0 offen lds
v_mfma_f32_16x16x32_bf16 v[204:207], a[104:107], a[8:11], v[204:207]
ds_read_b64_tr_b16 a[96:97], v12 offset:0
v_mfma_f32_16x16x32_bf16 v[196:199], a[104:107], a[4:7], v[196:199]
ds_read_b64_tr_b16 a[98:99], v12 offset:1024
v_mfma_f32_16x16x32_bf16 v[196:199], a[108:111], a[20:23], v[196:199]
ds_read_b64_tr_b16 a[100:101], v12 offset:8192
v_mfma_f32_16x16x32_bf16 v[188:191], a[108:111], a[16:19], v[188:191]
ds_read_b64_tr_b16 a[102:103], v12 offset:9216
v_mfma_f32_16x16x32_bf16 v[188:191], a[104:107], a[0:3], v[188:191]
s_add_u32 m0, s17, 0x400
s_waitcnt lgkmcnt(4)
v_mfma_f32_16x16x32_bf16 v[216:219], a[0:3], a[80:83], v[216:219]
buffer_load_dwordx4 v5, s[52:55], s13 offen lds
v_mfma_f32_16x16x32_bf16 v[216:219], a[16:19], a[84:87], v[216:219]
ds_read_b64_tr_b16 a[104:105], v13 offset:0
v_mfma_f32_16x16x32_bf16 v[224:227], a[20:23], a[84:87], v[224:227]
ds_read_b64_tr_b16 a[106:107], v13 offset:1024
v_mfma_f32_16x16x32_bf16 v[224:227], a[4:7], a[80:83], v[224:227]
ds_read_b64_tr_b16 a[108:109], v13 offset:8192
v_mfma_f32_16x16x32_bf16 v[232:235], a[8:11], a[80:83], v[232:235]
ds_read_b64_tr_b16 a[110:111], v13 offset:9216
v_mfma_f32_16x16x32_bf16 v[232:235], a[24:27], a[84:87], v[232:235]
v_mfma_f32_16x16x32_bf16 v[240:243], a[28:31], a[84:87], v[240:243]
s_add_u32 m0, s17, 0x800
v_mfma_f32_16x16x32_bf16 v[240:243], a[12:15], a[80:83], v[240:243]
buffer_load_dwordx4 v6, s[52:55], 0 offen lds
v_mfma_f32_16x16x32_bf16 v[244:247], a[12:15], a[88:91], v[244:247]
ds_read_b64_tr_b16 a[80:81], v12 offset:256
v_mfma_f32_16x16x32_bf16 v[244:247], a[28:31], a[92:95], v[244:247]
ds_read_b64_tr_b16 a[82:83], v12 offset:1280
v_mfma_f32_16x16x32_bf16 v[236:239], a[24:27], a[92:95], v[236:239]
ds_read_b64_tr_b16 a[84:85], v12 offset:8448
v_mfma_f32_16x16x32_bf16 v[236:239], a[8:11], a[88:91], v[236:239]
ds_read_b64_tr_b16 a[86:87], v12 offset:9472
v_mfma_f32_16x16x32_bf16 v[228:231], a[4:7], a[88:91], v[228:231]
v_mfma_f32_16x16x32_bf16 v[228:231], a[20:23], a[92:95], v[228:231]
s_add_u32 m0, s17, 0xc00
v_mfma_f32_16x16x32_bf16 v[220:223], a[16:19], a[92:95], v[220:223]
buffer_load_dwordx4 v6, s[52:55], s13 offen lds
v_mfma_f32_16x16x32_bf16 v[220:223], a[0:3], a[88:91], v[220:223]
s_waitcnt lgkmcnt(4)
L_S13:
v_mfma_f32_16x16x32_bf16 v[24:27], a[96:99], a[32:35], v[24:27]
ds_read_b64_tr_b16 a[88:89], v13 offset:256
s_waitcnt vmcnt(24)
v_mfma_f32_16x16x32_bf16 v[24:27], a[100:103], a[48:51], v[24:27]
ds_read_b64_tr_b16 a[90:91], v13 offset:1280
v_mfma_f32_16x16x32_bf16 v[32:35], a[100:103], a[52:55], v[32:35]
ds_read_b64_tr_b16 a[92:93], v13 offset:8448
v_mfma_f32_16x16x32_bf16 v[32:35], a[96:99], a[36:39], v[32:35]
ds_read_b64_tr_b16 a[94:95], v13 offset:9472
v_mfma_f32_16x16x32_bf16 v[40:43], a[96:99], a[40:43], v[40:43]
ds_read_b128 a[0:3], v8 offset:0
s_add_u32 m0, s18, 0x4000
v_mfma_f32_16x16x32_bf16 v[40:43], a[100:103], a[56:59], v[40:43]
buffer_load_dwordx4 v7, s[68:71], 0 offen lds
v_mfma_f32_16x16x32_bf16 v[48:51], a[100:103], a[60:63], v[48:51]
ds_read_b128 a[16:19], v9 offset:0
v_mfma_f32_16x16x32_bf16 v[48:51], a[96:99], a[44:47], v[48:51]
ds_read_b128 a[4:7], v8 offset:2048
v_mfma_f32_16x16x32_bf16 v[52:55], a[104:107], a[44:47], v[52:55]
ds_read_b64_tr_b16 a[96:97], v12 offset:512
v_mfma_f32_16x16x32_bf16 v[52:55], a[108:111], a[60:63], v[52:55]
ds_read_b64_tr_b16 a[98:99], v12 offset:1536
v_mfma_f32_16x16x32_bf16 v[44:47], a[108:111], a[56:59], v[44:47]
ds_read_b64_tr_b16 a[100:101], v12 offset:8704
s_add_u32 s8, s28, 0x4000
v_mfma_f32_16x16x32_bf16 v[44:47], a[104:107], a[40:43], v[44:47]
buffer_store_dwordx4 a[192:195], v16, s[88:91], s8 offen sc1
v_mfma_f32_16x16x32_bf16 v[36:39], a[104:107], a[36:39], v[36:39]
ds_read_b64_tr_b16 a[102:103], v12 offset:9728
v_mfma_f32_16x16x32_bf16 v[36:39], a[108:111], a[52:55], v[36:39]
ds_read_b128 a[20:23], v9 offset:2048
v_mfma_f32_16x16x32_bf16 v[28:31], a[108:111], a[48:51], v[28:31]
ds_read_b128 a[8:11], v8 offset:4096
v_mfma_f32_16x16x32_bf16 v[28:31], a[104:107], a[32:35], v[28:31]
ds_read_b128 a[24:27], v9 offset:4096
s_waitcnt lgkmcnt(10)
v_mfma_f32_16x16x32_bf16 v[56:59], a[80:83], a[32:35], v[56:59]
ds_read_b64_tr_b16 a[104:105], v13 offset:512
v_mfma_f32_16x16x32_bf16 v[56:59], a[84:87], a[48:51], v[56:59]
ds_read_b64_tr_b16 a[106:107], v13 offset:1536
s_add_u32 m0, s18, 0x5000
v_mfma_f32_16x16x32_bf16 v[64:67], a[84:87], a[52:55], v[64:67]
buffer_load_dwordx4 v7, s[68:71], s25 offen lds
v_mfma_f32_16x16x32_bf16 v[64:67], a[80:83], a[36:39], v[64:67]
ds_read_b64_tr_b16 a[108:109], v13 offset:8704
v_mfma_f32_16x16x32_bf16 v[72:75], a[80:83], a[40:43], v[72:75]
ds_read_b64_tr_b16 a[110:111], v13 offset:9728
v_mfma_f32_16x16x32_bf16 v[72:75], a[84:87], a[56:59], v[72:75]
ds_read_b128 a[12:15], v8 offset:6144
v_mfma_f32_16x16x32_bf16 v[80:83], a[84:87], a[60:63], v[80:83]
ds_read_b128 a[28:31], v9 offset:6144
v_mfma_f32_16x16x32_bf16 v[80:83], a[80:83], a[44:47], v[80:83]
v_mfma_f32_16x16x32_bf16 v[84:87], a[88:91], a[44:47], v[84:87]
ds_read_b64_tr_b16 a[80:81], v12 offset:768
s_add_u32 m0, s18, 0x6000
v_mfma_f32_16x16x32_bf16 v[84:87], a[92:95], a[60:63], v[84:87]
buffer_load_dwordx4 v7, s[68:71], s26 offen lds
v_mfma_f32_16x16x32_bf16 v[76:79], a[92:95], a[56:59], v[76:79]
ds_read_b64_tr_b16 a[82:83], v12 offset:1792
v_lshl_add_u32 v5, s42, 19, v5
v_mfma_f32_16x16x32_bf16 v[76:79], a[88:91], a[40:43], v[76:79]
ds_read_b64_tr_b16 a[84:85], v12 offset:8960
v_lshl_add_u32 v6, s42, 19, v6
v_mfma_f32_16x16x32_bf16 v[68:71], a[88:91], a[36:39], v[68:71]
ds_read_b64_tr_b16 a[86:87], v12 offset:9984
v_lshl_add_u32 v7, s42, 18, v7
v_mfma_f32_16x16x32_bf16 v[68:71], a[92:95], a[52:55], v[68:71]
v_lshl_add_u32 v7, s42, 17, v7
v_mfma_f32_16x16x32_bf16 v[60:63], a[92:95], a[48:51], v[60:63]
v_mfma_f32_16x16x32_bf16 v[60:63], a[88:91], a[32:35], v[60:63]
s_add_u32 m0, s16, 0x0
s_waitcnt lgkmcnt(4)
s_waitcnt lgkmcnt(6)
v_mfma_f32_16x16x32_bf16 v[88:91], a[96:99], a[32:35], v[88:91]
buffer_load_dwordx4 v22, s[44:47], s20 offen lds
v_mfma_f32_16x16x32_bf16 v[88:91], a[100:103], a[48:51], v[88:91]
ds_read_b64_tr_b16 a[88:89], v13 offset:768
v_mfma_f32_16x16x32_bf16 v[96:99], a[100:103], a[52:55], v[96:99]
ds_read_b64_tr_b16 a[90:91], v13 offset:1792
v_mfma_f32_16x16x32_bf16 v[96:99], a[96:99], a[36:39], v[96:99]
ds_read_b64_tr_b16 a[92:93], v13 offset:8960
v_mfma_f32_16x16x32_bf16 v[104:107], a[96:99], a[40:43], v[104:107]
ds_read_b64_tr_b16 a[94:95], v13 offset:9984
s_add_u32 m0, s16, 0x400
v_mfma_f32_16x16x32_bf16 v[104:107], a[100:103], a[56:59], v[104:107]
buffer_load_dwordx4 v23, s[44:47], s20 offen lds
v_mfma_f32_16x16x32_bf16 v[112:115], a[100:103], a[60:63], v[112:115]
v_mfma_f32_16x16x32_bf16 v[112:115], a[96:99], a[44:47], v[112:115]
v_mfma_f32_16x16x32_bf16 v[116:119], a[104:107], a[44:47], v[116:119]
ds_read_b64_tr_b16 a[96:97], v14 offset:0
v_mfma_f32_16x16x32_bf16 v[116:119], a[108:111], a[60:63], v[116:119]
ds_read_b64_tr_b16 a[98:99], v14 offset:256
v_mfma_f32_16x16x32_bf16 v[108:111], a[108:111], a[56:59], v[108:111]
ds_read_b64_tr_b16 a[100:101], v14 offset:2048
s_add_u32 m0, s16, 0x800
v_mfma_f32_16x16x32_bf16 v[108:111], a[104:107], a[40:43], v[108:111]
buffer_load_dwordx4 v22, s[44:47], s21 offen lds
v_mfma_f32_16x16x32_bf16 v[100:103], a[104:107], a[36:39], v[100:103]
ds_read_b64_tr_b16 a[102:103], v14 offset:2304
v_mfma_f32_16x16x32_bf16 v[100:103], a[108:111], a[52:55], v[100:103]
v_mfma_f32_16x16x32_bf16 v[92:95], a[108:111], a[48:51], v[92:95]
v_mfma_f32_16x16x32_bf16 v[92:95], a[104:107], a[32:35], v[92:95]
s_add_u32 s8, s28, 0x8000
s_waitcnt lgkmcnt(4)
v_mfma_f32_16x16x32_bf16 v[120:123], a[80:83], a[32:35], v[120:123]
buffer_store_dwordx4 a[196:199], v16, s[88:91], s8 offen sc1
v_mfma_f32_16x16x32_bf16 v[120:123], a[84:87], a[48:51], v[120:123]
ds_read_b64_tr_b16 a[104:105], v15 offset:0
v_mfma_f32_16x16x32_bf16 v[128:131], a[84:87], a[52:55], v[128:131]
ds_read_b64_tr_b16 a[106:107], v15 offset:256
v_mfma_f32_16x16x32_bf16 v[128:131], a[80:83], a[36:39], v[128:131]
ds_read_b64_tr_b16 a[108:109], v15 offset:2048
v_mfma_f32_16x16x32_bf16 v[136:139], a[80:83], a[40:43], v[136:139]
ds_read_b64_tr_b16 a[110:111], v15 offset:2304
v_mfma_f32_16x16x32_bf16 v[136:139], a[84:87], a[56:59], v[136:139]
s_add_u32 m0, s16, 0xc00
v_mfma_f32_16x16x32_bf16 v[144:147], a[84:87], a[60:63], v[144:147]
buffer_load_dwordx4 v23, s[44:47], s21 offen lds
v_mfma_f32_16x16x32_bf16 v[144:147], a[80:83], a[44:47], v[144:147]
L_padA7:
s_cmp_eq_u32 s95, 1
s_cbranch_scc1 L_padA11
v_mfma_f32_16x16x32_bf16 v[148:151], a[88:91], a[44:47], v[148:151]
ds_read_b64_tr_b16 a[80:81], v14 offset:4096
v_mfma_f32_16x16x32_bf16 v[148:151], a[92:95], a[60:63], v[148:151]
ds_read_b64_tr_b16 a[82:83], v14 offset:4352
v_mfma_f32_16x16x32_bf16 v[140:143], a[92:95], a[56:59], v[140:143]
ds_read_b64_tr_b16 a[84:85], v14 offset:6144
v_mfma_f32_16x16x32_bf16 v[140:143], a[88:91], a[40:43], v[140:143]
ds_read_b64_tr_b16 a[86:87], v14 offset:6400
s_add_u32 m0, s16, 0x1000
v_mfma_f32_16x16x32_bf16 v[132:135], a[88:91], a[36:39], v[132:135]
buffer_load_dwordx4 v22, s[44:47], s22 offen lds
v_mfma_f32_16x16x32_bf16 v[132:135], a[92:95], a[52:55], v[132:135]
v_mfma_f32_16x16x32_bf16 v[124:127], a[92:95], a[48:51], v[124:127]
v_mfma_f32_16x16x32_bf16 v[124:127], a[88:91], a[32:35], v[124:127]
s_waitcnt lgkmcnt(4)
v_mfma_f32_16x16x32_bf16 v[152:155], a[96:99], a[32:35], v[152:155]
ds_read_b64_tr_b16 a[88:89], v15 offset:4096
s_add_u32 m0, s16, 0x1400
v_mfma_f32_16x16x32_bf16 v[152:155], a[100:103], a[48:51], v[152:155]
buffer_load_dwordx4 v23, s[44:47], s22 offen lds
v_mfma_f32_16x16x32_bf16 v[160:163], a[100:103], a[52:55], v[160:163]
ds_read_b64_tr_b16 a[90:91], v15 offset:4352
v_mfma_f32_16x16x32_bf16 v[160:163], a[96:99], a[36:39], v[160:163]
ds_read_b64_tr_b16 a[92:93], v15 offset:6144
v_mfma_f32_16x16x32_bf16 v[168:171], a[96:99], a[40:43], v[168:171]
ds_read_b64_tr_b16 a[94:95], v15 offset:6400
v_mfma_f32_16x16x32_bf16 v[168:171], a[100:103], a[56:59], v[168:171]
v_mfma_f32_16x16x32_bf16 v[176:179], a[100:103], a[60:63], v[176:179]
s_add_u32 m0, s16, 0x1800
v_mfma_f32_16x16x32_bf16 v[176:179], a[96:99], a[44:47], v[176:179]
buffer_load_dwordx4 v22, s[44:47], s23 offen lds
v_mfma_f32_16x16x32_bf16 v[180:183], a[104:107], a[44:47], v[180:183]
ds_read_b64_tr_b16 a[96:97], v14 offset:8192
v_mfma_f32_16x16x32_bf16 v[180:183], a[108:111], a[60:63], v[180:183]
ds_read_b64_tr_b16 a[98:99], v14 offset:8448
v_mfma_f32_16x16x32_bf16 v[172:175], a[108:111], a[56:59], v[172:175]
ds_read_b64_tr_b16 a[100:101], v14 offset:10240
v_mfma_f32_16x16x32_bf16 v[172:175], a[104:107], a[40:43], v[172:175]
ds_read_b64_tr_b16 a[102:103], v14 offset:10496
s_add_u32 m0, s16, 0x1c00
v_mfma_f32_16x16x32_bf16 v[164:167], a[104:107], a[36:39], v[164:167]
buffer_load_dwordx4 v23, s[44:47], s23 offen lds
v_mfma_f32_16x16x32_bf16 v[164:167], a[108:111], a[52:55], v[164:167]
v_lshl_add_u32 v22, s42, 7, v22
v_lshl_add_u32 v23, s42, 7, v23
v_mfma_f32_16x16x32_bf16 v[156:159], a[108:111], a[48:51], v[156:159]
v_mfma_f32_16x16x32_bf16 v[156:159], a[104:107], a[32:35], v[156:159]
s_waitcnt lgkmcnt(4)
v_mfma_f32_16x16x32_bf16 v[184:187], a[80:83], a[32:35], v[184:187]
ds_read_b64_tr_b16 a[104:105], v15 offset:8192
v_mfma_f32_16x16x32_bf16 v[184:187], a[84:87], a[48:51], v[184:187]
ds_read_b64_tr_b16 a[106:107], v15 offset:8448
s_add_u32 s8, s28, 0x4400
v_mfma_f32_16x16x32_bf16 v[192:195], a[84:87], a[52:55], v[192:195]
buffer_store_dwordx4 a[200:203], v16, s[88:91], s8 offen sc1
v_mfma_f32_16x16x32_bf16 v[192:195], a[80:83], a[36:39], v[192:195]
ds_read_b64_tr_b16 a[108:109], v15 offset:10240
v_mfma_f32_16x16x32_bf16 v[200:203], a[80:83], a[40:43], v[200:203]
ds_read_b64_tr_b16 a[110:111], v15 offset:10496
v_add_u32 v12, 0x8000, v12
v_mfma_f32_16x16x32_bf16 v[200:203], a[84:87], a[56:59], v[200:203]
v_add_u32 v13, 0x8000, v13
v_add_u32 v14, 0x8000, v14
v_mfma_f32_16x16x32_bf16 v[208:211], a[84:87], a[60:63], v[208:211]
v_add_u32 v15, 0x8000, v15
v_mfma_f32_16x16x32_bf16 v[208:211], a[80:83], a[44:47], v[208:211]
v_mfma_f32_16x16x32_bf16 v[212:215], a[88:91], a[44:47], v[212:215]
s_waitcnt vmcnt(29) lgkmcnt(0)
v_mfma_f32_16x16x32_bf16 v[212:215], a[92:95], a[60:63], v[212:215]
s_barrier
s_add_u32 m0, s17, 0x8000
v_mfma_f32_16x16x32_bf16 v[204:207], a[92:95], a[56:59], v[204:207]
buffer_load_dwordx4 v5, s[52:55], 0 offen lds
v_mfma_f32_16x16x32_bf16 v[204:207], a[88:91], a[40:43], v[204:207]
ds_read_b64_tr_b16 a[80:81], v12 offset:0
v_mfma_f32_16x16x32_bf16 v[196:199], a[88:91], a[36:39], v[196:199]
ds_read_b64_tr_b16 a[82:83], v12 offset:1024
v_mfma_f32_16x16x32_bf16 v[196:199], a[92:95], a[52:55], v[196:199]
ds_read_b64_tr_b16 a[84:85], v12 offset:8192
v_mfma_f32_16x16x32_bf16 v[188:191], a[92:95], a[48:51], v[188:191]
ds_read_b64_tr_b16 a[86:87], v12 offset:9216
v_mfma_f32_16x16x32_bf16 v[188:191], a[88:91], a[32:35], v[188:191]
s_add_u32 m0, s17, 0x8400
s_waitcnt lgkmcnt(4)
v_mfma_f32_16x16x32_bf16 v[216:219], a[32:35], a[96:99], v[216:219]
buffer_load_dwordx4 v5, s[52:55], s13 offen lds
v_mfma_f32_16x16x32_bf16 v[216:219], a[48:51], a[100:103], v[216:219]
ds_read_b64_tr_b16 a[88:89], v13 offset:0
v_mfma_f32_16x16x32_bf16 v[224:227], a[52:55], a[100:103], v[224:227]
ds_read_b64_tr_b16 a[90:91], v13 offset:1024
v_mfma_f32_16x16x32_bf16 v[224:227], a[36:39], a[96:99], v[224:227]
ds_read_b64_tr_b16 a[92:93], v13 offset:8192
v_mfma_f32_16x16x32_bf16 v[232:235], a[40:43], a[96:99], v[232:235]
ds_read_b64_tr_b16 a[94:95], v13 offset:9216
v_mfma_f32_16x16x32_bf16 v[232:235], a[56:59], a[100:103], v[232:235]
v_mfma_f32_16x16x32_bf16 v[240:243], a[60:63], a[100:103], v[240:243]
s_add_u32 m0, s17, 0x8800
v_mfma_f32_16x16x32_bf16 v[240:243], a[44:47], a[96:99], v[240:243]
buffer_load_dwordx4 v6, s[52:55], 0 offen lds
v_mfma_f32_16x16x32_bf16 v[244:247], a[44:47], a[104:107], v[244:247]
ds_read_b64_tr_b16 a[96:97], v12 offset:256
v_mfma_f32_16x16x32_bf16 v[244:247], a[60:63], a[108:111], v[244:247]
ds_read_b64_tr_b16 a[98:99], v12 offset:1280
v_mfma_f32_16x16x32_bf16 v[236:239], a[56:59], a[108:111], v[236:239]
ds_read_b64_tr_b16 a[100:101], v12 offset:8448
v_mfma_f32_16x16x32_bf16 v[236:239], a[40:43], a[104:107], v[236:239]
ds_read_b64_tr_b16 a[102:103], v12 offset:9472
v_mfma_f32_16x16x32_bf16 v[228:231], a[36:39], a[104:107], v[228:231]
v_mfma_f32_16x16x32_bf16 v[228:231], a[52:55], a[108:111], v[228:231]
s_add_u32 m0, s17, 0x8c00
v_mfma_f32_16x16x32_bf16 v[220:223], a[48:51], a[108:111], v[220:223]
buffer_load_dwordx4 v6, s[52:55], s13 offen lds
v_mfma_f32_16x16x32_bf16 v[220:223], a[32:35], a[104:107], v[220:223]
s_waitcnt lgkmcnt(4)
L_S14:
v_mfma_f32_16x16x32_bf16 v[24:27], a[80:83], a[0:3], v[24:27]
ds_read_b64_tr_b16 a[104:105], v13 offset:256
s_waitcnt vmcnt(23)
v_mfma_f32_16x16x32_bf16 v[24:27], a[84:87], a[16:19], v[24:27]
ds_read_b64_tr_b16 a[106:107], v13 offset:1280
v_mfma_f32_16x16x32_bf16 v[32:35], a[84:87], a[20:23], v[32:35]
ds_read_b64_tr_b16 a[108:109], v13 offset:8448
v_mfma_f32_16x16x32_bf16 v[32:35], a[80:83], a[4:7], v[32:35]
ds_read_b64_tr_b16 a[110:111], v13 offset:9472
v_mfma_f32_16x16x32_bf16 v[40:43], a[80:83], a[8:11], v[40:43]
ds_read_b128 a[32:35], v8 offset:32768
s_add_u32 m0, s18, 0xc000
v_mfma_f32_16x16x32_bf16 v[40:43], a[84:87], a[24:27], v[40:43]
buffer_load_dwordx4 v7, s[68:71], 0 offen lds
v_mfma_f32_16x16x32_bf16 v[48:51], a[84:87], a[28:31], v[48:51]
ds_read_b128 a[48:51], v9 offset:32768
v_mfma_f32_16x16x32_bf16 v[48:51], a[80:83], a[12:15], v[48:51]
ds_read_b128 a[36:39], v8 offset:34816
v_mfma_f32_16x16x32_bf16 v[52:55], a[88:91], a[12:15], v[52:55]
ds_read_b64_tr_b16 a[80:81], v12 offset:512
v_mfma_f32_16x16x32_bf16 v[52:55], a[92:95], a[28:31], v[52:55]
ds_read_b64_tr_b16 a[82:83], v12 offset:1536
v_mfma_f32_16x16x32_bf16 v[44:47], a[92:95], a[24:27], v[44:47]
ds_read_b64_tr_b16 a[84:85], v12 offset:8704
s_add_u32 s8, s28, 0x8400
v_mfma_f32_16x16x32_bf16 v[44:47], a[88:91], a[8:11], v[44:47]
buffer_store_dwordx4 a[204:207], v16, s[88:91], s8 offen sc1
v_mfma_f32_16x16x32_bf16 v[36:39], a[88:91], a[4:7], v[36:39]
ds_read_b64_tr_b16 a[86:87], v12 offset:9728
v_mfma_f32_16x16x32_bf16 v[36:39], a[92:95], a[20:23], v[36:39]
ds_read_b128 a[52:55], v9 offset:34816
v_mfma_f32_16x16x32_bf16 v[28:31], a[92:95], a[16:19], v[28:31]
ds_read_b128 a[40:43], v8 offset:36864
v_mfma_f32_16x16x32_bf16 v[28:31], a[88:91], a[0:3], v[28:31]
ds_read_b128 a[56:59], v9 offset:36864
s_waitcnt lgkmcnt(10)
v_mfma_f32_16x16x32_bf16 v[56:59], a[96:99], a[0:3], v[56:59]
ds_read_b64_tr_b16 a[88:89], v13 offset:512
v_mfma_f32_16x16x32_bf16 v[56:59], a[100:103], a[16:19], v[56:59]
ds_read_b64_tr_b16 a[90:91], v13 offset:1536
s_add_u32 m0, s18, 0xd000
v_mfma_f32_16x16x32_bf16 v[64:67], a[100:103], a[20:23], v[64:67]
buffer_load_dwordx4 v7, s[68:71], s25 offen lds
v_mfma_f32_16x16x32_bf16 v[64:67], a[96:99], a[4:7], v[64:67]
ds_read_b64_tr_b16 a[92:93], v13 offset:8704
v_mfma_f32_16x16x32_bf16 v[72:75], a[96:99], a[8:11], v[72:75]
ds_read_b64_tr_b16 a[94:95], v13 offset:9728
v_mfma_f32_16x16x32_bf16 v[72:75], a[100:103], a[24:27], v[72:75]
ds_read_b128 a[44:47], v8 offset:38912
v_mfma_f32_16x16x32_bf16 v[80:83], a[100:103], a[28:31], v[80:83]
ds_read_b128 a[60:63], v9 offset:38912
v_mfma_f32_16x16x32_bf16 v[80:83], a[96:99], a[12:15], v[80:83]
v_mfma_f32_16x16x32_bf16 v[84:87], a[104:107], a[12:15], v[84:87]
ds_read_b64_tr_b16 a[96:97], v12 offset:768
s_add_u32 m0, s18, 0xe000
v_mfma_f32_16x16x32_bf16 v[84:87], a[108:111], a[28:31], v[84:87]
buffer_load_dwordx4 v7, s[68:71], s26 offen lds
v_mfma_f32_16x16x32_bf16 v[76:79], a[108:111], a[24:27], v[76:79]
ds_read_b64_tr_b16 a[98:99], v12 offset:1792
v_lshl_add_u32 v5, s42, 19, v5
v_mfma_f32_16x16x32_bf16 v[76:79], a[104:107], a[8:11], v[76:79]
ds_read_b64_tr_b16 a[100:101], v12 offset:8960
v_lshl_add_u32 v6, s42, 19, v6
v_mfma_f32_16x16x32_bf16 v[68:71], a[104:107], a[4:7], v[68:71]
ds_read_b64_tr_b16 a[102:103], v12 offset:9984
v_lshl_add_u32 v7, s42, 18, v7
v_mfma_f32_16x16x32_bf16 v[68:71], a[108:111], a[20:23], v[68:71]
v_lshl_add_u32 v7, s42, 17, v7
v_mfma_f32_16x16x32_bf16 v[60:63], a[108:111], a[16:19], v[60:63]
v_mfma_f32_16x16x32_bf16 v[60:63], a[104:107], a[0:3], v[60:63]
s_add_u32 m0, s16, 0x8000
s_waitcnt lgkmcnt(4)
s_waitcnt lgkmcnt(6)
v_mfma_f32_16x16x32_bf16 v[88:91], a[80:83], a[0:3], v[88:91]
buffer_load_dwordx4 v22, s[44:47], s20 offen lds
v_mfma_f32_16x16x32_bf16 v[88:91], a[84:87], a[16:19], v[88:91]
ds_read_b64_tr_b16 a[104:105], v13 offset:768
v_mfma_f32_16x16x32_bf16 v[96:99], a[84:87], a[20:23], v[96:99]
ds_read_b64_tr_b16 a[106:107], v13 offset:1792
v_mfma_f32_16x16x32_bf16 v[96:99], a[80:83], a[4:7], v[96:99]
ds_read_b64_tr_b16 a[108:109], v13 offset:8960
v_mfma_f32_16x16x32_bf16 v[104:107], a[80:83], a[8:11], v[104:107]
ds_read_b64_tr_b16 a[110:111], v13 offset:9984
s_add_u32 m0, s16, 0x8400
v_mfma_f32_16x16x32_bf16 v[104:107], a[84:87], a[24:27], v[104:107]
buffer_load_dwordx4 v23, s[44:47], s20 offen lds
v_mfma_f32_16x16x32_bf16 v[112:115], a[84:87], a[28:31], v[112:115]
v_mfma_f32_16x16x32_bf16 v[112:115], a[80:83], a[12:15], v[112:115]
v_mfma_f32_16x16x32_bf16 v[116:119], a[88:91], a[12:15], v[116:119]
ds_read_b64_tr_b16 a[80:81], v14 offset:0
v_mfma_f32_16x16x32_bf16 v[116:119], a[92:95], a[28:31], v[116:119]
ds_read_b64_tr_b16 a[82:83], v14 offset:256
v_mfma_f32_16x16x32_bf16 v[108:111], a[92:95], a[24:27], v[108:111]
ds_read_b64_tr_b16 a[84:85], v14 offset:2048
s_add_u32 m0, s16, 0x8800
v_mfma_f32_16x16x32_bf16 v[108:111], a[88:91], a[8:11], v[108:111]
buffer_load_dwordx4 v22, s[44:47], s21 offen lds
v_mfma_f32_16x16x32_bf16 v[100:103], a[88:91], a[4:7], v[100:103]
ds_read_b64_tr_b16 a[86:87], v14 offset:2304
v_mfma_f32_16x16x32_bf16 v[100:103], a[92:95], a[20:23], v[100:103]
v_mfma_f32_16x16x32_bf16 v[92:95], a[92:95], a[16:19], v[92:95]
v_mfma_f32_16x16x32_bf16 v[92:95], a[88:91], a[0:3], v[92:95]
s_add_u32 s8, s28, 0x4800
s_waitcnt lgkmcnt(4)
v_mfma_f32_16x16x32_bf16 v[120:123], a[96:99], a[0:3], v[120:123]
buffer_store_dwordx4 a[208:211], v16, s[88:91], s8 offen sc1
v_mfma_f32_16x16x32_bf16 v[120:123], a[100:103], a[16:19], v[120:123]
ds_read_b64_tr_b16 a[88:89], v15 offset:0
v_mfma_f32_16x16x32_bf16 v[128:131], a[100:103], a[20:23], v[128:131]
ds_read_b64_tr_b16 a[90:91], v15 offset:256
v_mfma_f32_16x16x32_bf16 v[128:131], a[96:99], a[4:7], v[128:131]
ds_read_b64_tr_b16 a[92:93], v15 offset:2048
v_mfma_f32_16x16x32_bf16 v[136:139], a[96:99], a[8:11], v[136:139]
ds_read_b64_tr_b16 a[94:95], v15 offset:2304
v_mfma_f32_16x16x32_bf16 v[136:139], a[100:103], a[24:27], v[136:139]
s_add_u32 m0, s16, 0x8c00
v_mfma_f32_16x16x32_bf16 v[144:147], a[100:103], a[28:31], v[144:147]
buffer_load_dwordx4 v23, s[44:47], s21 offen lds
v_mfma_f32_16x16x32_bf16 v[144:147], a[96:99], a[12:15], v[144:147]
v_mfma_f32_16x16x32_bf16 v[148:151], a[104:107], a[12:15], v[148:151]
ds_read_b64_tr_b16 a[96:97], v14 offset:4096
v_mfma_f32_16x16x32_bf16 v[148:151], a[108:111], a[28:31], v[148:151]
ds_read_b64_tr_b16 a[98:99], v14 offset:4352
v_mfma_f32_16x16x32_bf16 v[140:143], a[108:111], a[24:27], v[140:143]
ds_read_b64_tr_b16 a[100:101], v14 offset:6144
v_mfma_f32_16x16x32_bf16 v[140:143], a[104:107], a[8:11], v[140:143]
ds_read_b64_tr_b16 a[102:103], v14 offset:6400
s_add_u32 m0, s16, 0x9000
v_mfma_f32_16x16x32_bf16 v[132:135], a[104:107], a[4:7], v[132:135]
buffer_load_dwordx4 v22, s[44:47], s22 offen lds
v_mfma_f32_16x16x32_bf16 v[132:135], a[108:111], a[20:23], v[132:135]
v_mfma_f32_16x16x32_bf16 v[124:127], a[108:111], a[16:19], v[124:127]
v_mfma_f32_16x16x32_bf16 v[124:127], a[104:107], a[0:3], v[124:127]
s_waitcnt lgkmcnt(4)
v_mfma_f32_16x16x32_bf16 v[152:155], a[80:83], a[0:3], v[152:155]
ds_read_b64_tr_b16 a[104:105], v15 offset:4096
s_add_u32 m0, s16, 0x9400
v_mfma_f32_16x16x32_bf16 v[152:155], a[84:87], a[16:19], v[152:155]
buffer_load_dwordx4 v23, s[44:47], s22 offen lds
v_mfma_f32_16x16x32_bf16 v[160:163], a[84:87], a[20:23], v[160:163]
ds_read_b64_tr_b16 a[106:107], v15 offset:4352
v_mfma_f32_16x16x32_bf16 v[160:163], a[80:83], a[4:7], v[160:163]
ds_read_b64_tr_b16 a[108:109], v15 offset:6144
v_mfma_f32_16x16x32_bf16 v[168:171], a[80:83], a[8:11], v[168:171]
ds_read_b64_tr_b16 a[110:111], v15 offset:6400
v_mfma_f32_16x16x32_bf16 v[168:171], a[84:87], a[24:27], v[168:171]
v_mfma_f32_16x16x32_bf16 v[176:179], a[84:87], a[28:31], v[176:179]
s_add_u32 m0, s16, 0x9800
v_mfma_f32_16x16x32_bf16 v[176:179], a[80:83], a[12:15], v[176:179]
buffer_load_dwordx4 v22, s[44:47], s23 offen lds
v_mfma_f32_16x16x32_bf16 v[180:183], a[88:91], a[12:15], v[180:183]
ds_read_b64_tr_b16 a[80:81], v14 offset:8192
v_mfma_f32_16x16x32_bf16 v[180:183], a[92:95], a[28:31], v[180:183]
ds_read_b64_tr_b16 a[82:83], v14 offset:8448
v_mfma_f32_16x16x32_bf16 v[172:175], a[92:95], a[24:27], v[172:175]
ds_read_b64_tr_b16 a[84:85], v14 offset:10240
v_mfma_f32_16x16x32_bf16 v[172:175], a[88:91], a[8:11], v[172:175]
ds_read_b64_tr_b16 a[86:87], v14 offset:10496
s_add_u32 m0, s16, 0x9c00
v_mfma_f32_16x16x32_bf16 v[164:167], a[88:91], a[4:7], v[164:167]
buffer_load_dwordx4 v23, s[44:47], s23 offen lds
v_mfma_f32_16x16x32_bf16 v[164:167], a[92:95], a[20:23], v[164:167]
v_lshl_add_u32 v22, s42, 7, v22
v_lshl_add_u32 v23, s42, 7, v23
v_mfma_f32_16x16x32_bf16 v[156:159], a[92:95], a[16:19], v[156:159]
v_mfma_f32_16x16x32_bf16 v[156:159], a[88:91], a[0:3], v[156:159]
s_waitcnt lgkmcnt(4)
v_mfma_f32_16x16x32_bf16 v[184:187], a[96:99], a[0:3], v[184:187]
ds_read_b64_tr_b16 a[88:89], v15 offset:8192
v_mfma_f32_16x16x32_bf16 v[184:187], a[100:103], a[16:19], v[184:187]
ds_read_b64_tr_b16 a[90:91], v15 offset:8448
s_add_u32 s8, s28, 0x8800
v_mfma_f32_16x16x32_bf16 v[192:195], a[100:103], a[20:23], v[192:195]
buffer_store_dwordx4 a[212:215], v16, s[88:91], s8 offen sc1
v_mfma_f32_16x16x32_bf16 v[192:195], a[96:99], a[4:7], v[192:195]
ds_read_b64_tr_b16 a[92:93], v15 offset:10240
v_mfma_f32_16x16x32_bf16 v[200:203], a[96:99], a[8:11], v[200:203]
ds_read_b64_tr_b16 a[94:95], v15 offset:10496
v_add_u32 v12, 0xffff0000, v12
v_mfma_f32_16x16x32_bf16 v[200:203], a[100:103], a[24:27], v[200:203]
v_add_u32 v13, 0xffff0000, v13
v_add_u32 v14, 0xffff0000, v14
v_mfma_f32_16x16x32_bf16 v[208:211], a[100:103], a[28:31], v[208:211]
v_add_u32 v15, 0xffff0000, v15
v_mfma_f32_16x16x32_bf16 v[208:211], a[96:99], a[12:15], v[208:211]
v_mfma_f32_16x16x32_bf16 v[212:215], a[104:107], a[12:15], v[212:215]
s_waitcnt vmcnt(28) lgkmcnt(0)
v_mfma_f32_16x16x32_bf16 v[212:215], a[108:111], a[28:31], v[212:215]
s_barrier
s_add_u32 m0, s17, 0x10000
v_mfma_f32_16x16x32_bf16 v[204:207], a[108:111], a[24:27], v[204:207]
buffer_load_dwordx4 v5, s[52:55], 0 offen lds
v_mfma_f32_16x16x32_bf16 v[204:207], a[104:107], a[8:11], v[204:207]
ds_read_b64_tr_b16 a[96:97], v12 offset:0
v_mfma_f32_16x16x32_bf16 v[196:199], a[104:107], a[4:7], v[196:199]
ds_read_b64_tr_b16 a[98:99], v12 offset:1024
v_mfma_f32_16x16x32_bf16 v[196:199], a[108:111], a[20:23], v[196:199]
ds_read_b64_tr_b16 a[100:101], v12 offset:8192
v_mfma_f32_16x16x32_bf16 v[188:191], a[108:111], a[16:19], v[188:191]
ds_read_b64_tr_b16 a[102:103], v12 offset:9216
v_mfma_f32_16x16x32_bf16 v[188:191], a[104:107], a[0:3], v[188:191]
s_add_u32 m0, s17, 0x10400
s_waitcnt lgkmcnt(4)
v_mfma_f32_16x16x32_bf16 v[216:219], a[0:3], a[80:83], v[216:219]
buffer_load_dwordx4 v5, s[52:55], s13 offen lds
v_mfma_f32_16x16x32_bf16 v[216:219], a[16:19], a[84:87], v[216:219]
ds_read_b64_tr_b16 a[104:105], v13 offset:0
v_mfma_f32_16x16x32_bf16 v[224:227], a[20:23], a[84:87], v[224:227]
ds_read_b64_tr_b16 a[106:107], v13 offset:1024
v_mfma_f32_16x16x32_bf16 v[224:227], a[4:7], a[80:83], v[224:227]
ds_read_b64_tr_b16 a[108:109], v13 offset:8192
v_mfma_f32_16x16x32_bf16 v[232:235], a[8:11], a[80:83], v[232:235]
ds_read_b64_tr_b16 a[110:111], v13 offset:9216
v_mfma_f32_16x16x32_bf16 v[232:235], a[24:27], a[84:87], v[232:235]
v_mfma_f32_16x16x32_bf16 v[240:243], a[28:31], a[84:87], v[240:243]
s_add_u32 m0, s17, 0x10800
v_mfma_f32_16x16x32_bf16 v[240:243], a[12:15], a[80:83], v[240:243]
buffer_load_dwordx4 v6, s[52:55], 0 offen lds
v_mfma_f32_16x16x32_bf16 v[244:247], a[12:15], a[88:91], v[244:247]
ds_read_b64_tr_b16 a[80:81], v12 offset:256
v_mfma_f32_16x16x32_bf16 v[244:247], a[28:31], a[92:95], v[244:247]
ds_read_b64_tr_b16 a[82:83], v12 offset:1280
v_mfma_f32_16x16x32_bf16 v[236:239], a[24:27], a[92:95], v[236:239]
ds_read_b64_tr_b16 a[84:85], v12 offset:8448
v_mfma_f32_16x16x32_bf16 v[236:239], a[8:11], a[88:91], v[236:239]
ds_read_b64_tr_b16 a[86:87], v12 offset:9472
v_mfma_f32_16x16x32_bf16 v[228:231], a[4:7], a[88:91], v[228:231]
v_mfma_f32_16x16x32_bf16 v[228:231], a[20:23], a[92:95], v[228:231]
s_add_u32 m0, s17, 0x10c00
v_mfma_f32_16x16x32_bf16 v[220:223], a[16:19], a[92:95], v[220:223]
buffer_load_dwordx4 v6, s[52:55], s13 offen lds
v_mfma_f32_16x16x32_bf16 v[220:223], a[0:3], a[88:91], v[220:223]
s_waitcnt lgkmcnt(4)
L_S15:
v_mfma_f32_16x16x32_bf16 v[24:27], a[96:99], a[32:35], v[24:27]
ds_read_b64_tr_b16 a[88:89], v13 offset:256
s_waitcnt vmcnt(23)
v_mfma_f32_16x16x32_bf16 v[24:27], a[100:103], a[48:51], v[24:27]
ds_read_b64_tr_b16 a[90:91], v13 offset:1280
v_mfma_f32_16x16x32_bf16 v[32:35], a[100:103], a[52:55], v[32:35]
ds_read_b64_tr_b16 a[92:93], v13 offset:8448
v_mfma_f32_16x16x32_bf16 v[32:35], a[96:99], a[36:39], v[32:35]
ds_read_b64_tr_b16 a[94:95], v13 offset:9472
v_mfma_f32_16x16x32_bf16 v[40:43], a[96:99], a[40:43], v[40:43]
ds_read_b128 a[0:3], v8 offset:0
s_add_u32 m0, s18, 0x14000
v_mfma_f32_16x16x32_bf16 v[40:43], a[100:103], a[56:59], v[40:43]
buffer_load_dwordx4 v7, s[68:71], 0 offen lds
v_mfma_f32_16x16x32_bf16 v[48:51], a[100:103], a[60:63], v[48:51]
ds_read_b128 a[16:19], v9 offset:0
v_mfma_f32_16x16x32_bf16 v[48:51], a[96:99], a[44:47], v[48:51]
ds_read_b128 a[4:7], v8 offset:2048
v_mfma_f32_16x16x32_bf16 v[52:55], a[104:107], a[44:47], v[52:55]
ds_read_b64_tr_b16 a[96:97], v12 offset:512
v_mfma_f32_16x16x32_bf16 v[52:55], a[108:111], a[60:63], v[52:55]
ds_read_b64_tr_b16 a[98:99], v12 offset:1536
v_mfma_f32_16x16x32_bf16 v[44:47], a[108:111], a[56:59], v[44:47]
ds_read_b64_tr_b16 a[100:101], v12 offset:8704
s_add_u32 s8, s28, 0x4c00
v_mfma_f32_16x16x32_bf16 v[44:47], a[104:107], a[40:43], v[44:47]
buffer_store_dwordx4 a[216:219], v16, s[88:91], s8 offen sc1
v_mfma_f32_16x16x32_bf16 v[36:39], a[104:107], a[36:39], v[36:39]
ds_read_b64_tr_b16 a[102:103], v12 offset:9728
v_mfma_f32_16x16x32_bf16 v[36:39], a[108:111], a[52:55], v[36:39]
ds_read_b128 a[20:23], v9 offset:2048
v_mfma_f32_16x16x32_bf16 v[28:31], a[108:111], a[48:51], v[28:31]
ds_read_b128 a[8:11], v8 offset:4096
v_mfma_f32_16x16x32_bf16 v[28:31], a[104:107], a[32:35], v[28:31]
ds_read_b128 a[24:27], v9 offset:4096
s_waitcnt lgkmcnt(10)
v_mfma_f32_16x16x32_bf16 v[56:59], a[80:83], a[32:35], v[56:59]
ds_read_b64_tr_b16 a[104:105], v13 offset:512
v_mfma_f32_16x16x32_bf16 v[56:59], a[84:87], a[48:51], v[56:59]
ds_read_b64_tr_b16 a[106:107], v13 offset:1536
s_add_u32 m0, s18, 0x15000
v_mfma_f32_16x16x32_bf16 v[64:67], a[84:87], a[52:55], v[64:67]
buffer_load_dwordx4 v7, s[68:71], s25 offen lds
v_mfma_f32_16x16x32_bf16 v[64:67], a[80:83], a[36:39], v[64:67]
ds_read_b64_tr_b16 a[108:109], v13 offset:8704
v_mfma_f32_16x16x32_bf16 v[72:75], a[80:83], a[40:43], v[72:75]
ds_read_b64_tr_b16 a[110:111], v13 offset:9728
v_mfma_f32_16x16x32_bf16 v[72:75], a[84:87], a[56:59], v[72:75]
ds_read_b128 a[12:15], v8 offset:6144
v_mfma_f32_16x16x32_bf16 v[80:83], a[84:87], a[60:63], v[80:83]
ds_read_b128 a[28:31], v9 offset:6144
v_mfma_f32_16x16x32_bf16 v[80:83], a[80:83], a[44:47], v[80:83]
v_mfma_f32_16x16x32_bf16 v[84:87], a[88:91], a[44:47], v[84:87]
ds_read_b64_tr_b16 a[80:81], v12 offset:768
s_add_u32 m0, s18, 0x16000
v_mfma_f32_16x16x32_bf16 v[84:87], a[92:95], a[60:63], v[84:87]
buffer_load_dwordx4 v7, s[68:71], s26 offen lds
v_mfma_f32_16x16x32_bf16 v[76:79], a[92:95], a[56:59], v[76:79]
ds_read_b64_tr_b16 a[82:83], v12 offset:1792
v_lshl_add_u32 v5, s42, 19, v5
v_mfma_f32_16x16x32_bf16 v[76:79], a[88:91], a[40:43], v[76:79]
ds_read_b64_tr_b16 a[84:85], v12 offset:8960
v_lshl_add_u32 v6, s42, 19, v6
v_mfma_f32_16x16x32_bf16 v[68:71], a[88:91], a[36:39], v[68:71]
ds_read_b64_tr_b16 a[86:87], v12 offset:9984
v_lshl_add_u32 v7, s42, 18, v7
v_mfma_f32_16x16x32_bf16 v[68:71], a[92:95], a[52:55], v[68:71]
v_lshl_add_u32 v7, s42, 17, v7
v_mfma_f32_16x16x32_bf16 v[60:63], a[92:95], a[48:51], v[60:63]
v_mfma_f32_16x16x32_bf16 v[60:63], a[88:91], a[32:35], v[60:63]
s_add_u32 m0, s16, 0x0
s_waitcnt lgkmcnt(4)
s_waitcnt lgkmcnt(6)
v_mfma_f32_16x16x32_bf16 v[88:91], a[96:99], a[32:35], v[88:91]
buffer_load_dwordx4 v22, s[44:47], s20 offen lds
v_mfma_f32_16x16x32_bf16 v[88:91], a[100:103], a[48:51], v[88:91]
ds_read_b64_tr_b16 a[88:89], v13 offset:768
v_mfma_f32_16x16x32_bf16 v[96:99], a[100:103], a[52:55], v[96:99]
ds_read_b64_tr_b16 a[90:91], v13 offset:1792
v_mfma_f32_16x16x32_bf16 v[96:99], a[96:99], a[36:39], v[96:99]
ds_read_b64_tr_b16 a[92:93], v13 offset:8960
v_mfma_f32_16x16x32_bf16 v[104:107], a[96:99], a[40:43], v[104:107]
ds_read_b64_tr_b16 a[94:95], v13 offset:9984
s_add_u32 m0, s16, 0x400
v_mfma_f32_16x16x32_bf16 v[104:107], a[100:103], a[56:59], v[104:107]
buffer_load_dwordx4 v23, s[44:47], s20 offen lds
v_mfma_f32_16x16x32_bf16 v[112:115], a[100:103], a[60:63], v[112:115]
v_mfma_f32_16x16x32_bf16 v[112:115], a[96:99], a[44:47], v[112:115]
v_mfma_f32_16x16x32_bf16 v[116:119], a[104:107], a[44:47], v[116:119]
ds_read_b64_tr_b16 a[96:97], v14 offset:0
v_mfma_f32_16x16x32_bf16 v[116:119], a[108:111], a[60:63], v[116:119]
ds_read_b64_tr_b16 a[98:99], v14 offset:256
v_mfma_f32_16x16x32_bf16 v[108:111], a[108:111], a[56:59], v[108:111]
ds_read_b64_tr_b16 a[100:101], v14 offset:2048
s_add_u32 m0, s16, 0x800
v_mfma_f32_16x16x32_bf16 v[108:111], a[104:107], a[40:43], v[108:111]
buffer_load_dwordx4 v22, s[44:47], s21 offen lds
v_mfma_f32_16x16x32_bf16 v[100:103], a[104:107], a[36:39], v[100:103]
ds_read_b64_tr_b16 a[102:103], v14 offset:2304
v_mfma_f32_16x16x32_bf16 v[100:103], a[108:111], a[52:55], v[100:103]
v_mfma_f32_16x16x32_bf16 v[92:95], a[108:111], a[48:51], v[92:95]
v_mfma_f32_16x16x32_bf16 v[92:95], a[104:107], a[32:35], v[92:95]
s_add_u32 s8, s28, 0x8c00
s_waitcnt lgkmcnt(4)
v_mfma_f32_16x16x32_bf16 v[120:123], a[80:83], a[32:35], v[120:123]
buffer_store_dwordx4 a[220:223], v16, s[88:91], s8 offen sc1
v_mfma_f32_16x16x32_bf16 v[120:123], a[84:87], a[48:51], v[120:123]
ds_read_b64_tr_b16 a[104:105], v15 offset:0
v_mfma_f32_16x16x32_bf16 v[128:131], a[84:87], a[52:55], v[128:131]
ds_read_b64_tr_b16 a[106:107], v15 offset:256
v_mfma_f32_16x16x32_bf16 v[128:131], a[80:83], a[36:39], v[128:131]
ds_read_b64_tr_b16 a[108:109], v15 offset:2048
v_mfma_f32_16x16x32_bf16 v[136:139], a[80:83], a[40:43], v[136:139]
ds_read_b64_tr_b16 a[110:111], v15 offset:2304
v_mfma_f32_16x16x32_bf16 v[136:139], a[84:87], a[56:59], v[136:139]
s_add_u32 m0, s16, 0xc00
v_mfma_f32_16x16x32_bf16 v[144:147], a[84:87], a[60:63], v[144:147]
buffer_load_dwordx4 v23, s[44:47], s21 offen lds
v_mfma_f32_16x16x32_bf16 v[144:147], a[80:83], a[44:47], v[144:147]
v_mfma_f32_16x16x32_bf16 v[148:151], a[88:91], a[44:47], v[148:151]
ds_read_b64_tr_b16 a[80:81], v14 offset:4096
v_mfma_f32_16x16x32_bf16 v[148:151], a[92:95], a[60:63], v[148:151]
ds_read_b64_tr_b16 a[82:83], v14 offset:4352
v_mfma_f32_16x16x32_bf16 v[140:143], a[92:95], a[56:59], v[140:143]
ds_read_b64_tr_b16 a[84:85], v14 offset:6144
v_mfma_f32_16x16x32_bf16 v[140:143], a[88:91], a[40:43], v[140:143]
ds_read_b64_tr_b16 a[86:87], v14 offset:6400
s_add_u32 m0, s16, 0x1000
v_mfma_f32_16x16x32_bf16 v[132:135], a[88:91], a[36:39], v[132:135]
buffer_load_dwordx4 v22, s[44:47], s22 offen lds
v_mfma_f32_16x16x32_bf16 v[132:135], a[92:95], a[52:55], v[132:135]
v_mfma_f32_16x16x32_bf16 v[124:127], a[92:95], a[48:51], v[124:127]
v_mfma_f32_16x16x32_bf16 v[124:127], a[88:91], a[32:35], v[124:127]
s_waitcnt lgkmcnt(4)
v_mfma_f32_16x16x32_bf16 v[152:155], a[96:99], a[32:35], v[152:155]
ds_read_b64_tr_b16 a[88:89], v15 offset:4096
s_add_u32 m0, s16, 0x1400
v_mfma_f32_16x16x32_bf16 v[152:155], a[100:103], a[48:51], v[152:155]
buffer_load_dwordx4 v23, s[44:47], s22 offen lds
v_mfma_f32_16x16x32_bf16 v[160:163], a[100:103], a[52:55], v[160:163]
ds_read_b64_tr_b16 a[90:91], v15 offset:4352
v_mfma_f32_16x16x32_bf16 v[160:163], a[96:99], a[36:39], v[160:163]
ds_read_b64_tr_b16 a[92:93], v15 offset:6144
v_mfma_f32_16x16x32_bf16 v[168:171], a[96:99], a[40:43], v[168:171]
ds_read_b64_tr_b16 a[94:95], v15 offset:6400
v_mfma_f32_16x16x32_bf16 v[168:171], a[100:103], a[56:59], v[168:171]
v_mfma_f32_16x16x32_bf16 v[176:179], a[100:103], a[60:63], v[176:179]
s_add_u32 m0, s16, 0x1800
v_mfma_f32_16x16x32_bf16 v[176:179], a[96:99], a[44:47], v[176:179]
buffer_load_dwordx4 v22, s[44:47], s23 offen lds
v_mfma_f32_16x16x32_bf16 v[180:183], a[104:107], a[44:47], v[180:183]
ds_read_b64_tr_b16 a[96:97], v14 offset:8192
v_mfma_f32_16x16x32_bf16 v[180:183], a[108:111], a[60:63], v[180:183]
ds_read_b64_tr_b16 a[98:99], v14 offset:8448
v_mfma_f32_16x16x32_bf16 v[172:175], a[108:111], a[56:59], v[172:175]
ds_read_b64_tr_b16 a[100:101], v14 offset:10240
v_mfma_f32_16x16x32_bf16 v[172:175], a[104:107], a[40:43], v[172:175]
ds_read_b64_tr_b16 a[102:103], v14 offset:10496
s_add_u32 m0, s16, 0x1c00
v_mfma_f32_16x16x32_bf16 v[164:167], a[104:107], a[36:39], v[164:167]
buffer_load_dwordx4 v23, s[44:47], s23 offen lds
v_mfma_f32_16x16x32_bf16 v[164:167], a[108:111], a[52:55], v[164:167]
v_lshl_add_u32 v22, s42, 7, v22
v_lshl_add_u32 v23, s42, 7, v23
v_mfma_f32_16x16x32_bf16 v[156:159], a[108:111], a[48:51], v[156:159]
v_mfma_f32_16x16x32_bf16 v[156:159], a[104:107], a[32:35], v[156:159]
s_waitcnt lgkmcnt(4)
v_mfma_f32_16x16x32_bf16 v[184:187], a[80:83], a[32:35], v[184:187]
ds_read_b64_tr_b16 a[104:105], v15 offset:8192
v_mfma_f32_16x16x32_bf16 v[184:187], a[84:87], a[48:51], v[184:187]
ds_read_b64_tr_b16 a[106:107], v15 offset:8448
s_add_u32 s8, s28, 0x5000
v_mfma_f32_16x16x32_bf16 v[192:195], a[84:87], a[52:55], v[192:195]
buffer_store_dwordx4 a[224:227], v16, s[88:91], s8 offen sc1
v_mfma_f32_16x16x32_bf16 v[192:195], a[80:83], a[36:39], v[192:195]
ds_read_b64_tr_b16 a[108:109], v15 offset:10240
v_mfma_f32_16x16x32_bf16 v[200:203], a[80:83], a[40:43], v[200:203]
ds_read_b64_tr_b16 a[110:111], v15 offset:10496
v_add_u32 v12, 0x8000, v12
v_mfma_f32_16x16x32_bf16 v[200:203], a[84:87], a[56:59], v[200:203]
v_add_u32 v13, 0x8000, v13
v_add_u32 v14, 0x8000, v14
v_mfma_f32_16x16x32_bf16 v[208:211], a[84:87], a[60:63], v[208:211]
L_padA8:
s_cmp_eq_u32 s95, 1
s_cbranch_scc1 L_padA12
v_add_u32 v15, 0x8000, v15
v_mfma_f32_16x16x32_bf16 v[208:211], a[80:83], a[44:47], v[208:211]
v_mfma_f32_16x16x32_bf16 v[212:215], a[88:91], a[44:47], v[212:215]
s_waitcnt vmcnt(28) lgkmcnt(0)
v_mfma_f32_16x16x32_bf16 v[212:215], a[92:95], a[60:63], v[212:215]
s_barrier
s_add_u32 m0, s17, 0x0
v_mfma_f32_16x16x32_bf16 v[204:207], a[92:95], a[56:59], v[204:207]
buffer_load_dwordx4 v5, s[52:55], 0 offen lds
v_mfma_f32_16x16x32_bf16 v[204:207], a[88:91], a[40:43], v[204:207]
ds_read_b64_tr_b16 a[80:81], v12 offset:0
v_mfma_f32_16x16x32_bf16 v[196:199], a[88:91], a[36:39], v[196:199]
ds_read_b64_tr_b16 a[82:83], v12 offset:1024
v_mfma_f32_16x16x32_bf16 v[196:199], a[92:95], a[52:55], v[196:199]
ds_read_b64_tr_b16 a[84:85], v12 offset:8192
v_mfma_f32_16x16x32_bf16 v[188:191], a[92:95], a[48:51], v[188:191]
ds_read_b64_tr_b16 a[86:87], v12 offset:9216
v_mfma_f32_16x16x32_bf16 v[188:191], a[88:91], a[32:35], v[188:191]
s_add_u32 m0, s17, 0x400
s_waitcnt lgkmcnt(4)
v_mfma_f32_16x16x32_bf16 v[216:219], a[32:35], a[96:99], v[216:219]
buffer_load_dwordx4 v5, s[52:55], s13 offen lds
v_mfma_f32_16x16x32_bf16 v[216:219], a[48:51], a[100:103], v[216:219]
ds_read_b64_tr_b16 a[88:89], v13 offset:0
v_mfma_f32_16x16x32_bf16 v[224:227], a[52:55], a[100:103], v[224:227]
ds_read_b64_tr_b16 a[90:91], v13 offset:1024
v_mfma_f32_16x16x32_bf16 v[224:227], a[36:39], a[96:99], v[224:227]
ds_read_b64_tr_b16 a[92:93], v13 offset:8192
v_mfma_f32_16x16x32_bf16 v[232:235], a[40:43], a[96:99], v[232:235]
ds_read_b64_tr_b16 a[94:95], v13 offset:9216
v_mfma_f32_16x16x32_bf16 v[232:235], a[56:59], a[100:103], v[232:235]
v_mfma_f32_16x16x32_bf16 v[240:243], a[60:63], a[100:103], v[240:243]
s_add_u32 m0, s17, 0x800
v_mfma_f32_16x16x32_bf16 v[240:243], a[44:47], a[96:99], v[240:243]
buffer_load_dwordx4 v6, s[52:55], 0 offen lds
v_mfma_f32_16x16x32_bf16 v[244:247], a[44:47], a[104:107], v[244:247]
ds_read_b64_tr_b16 a[96:97], v12 offset:256
v_mfma_f32_16x16x32_bf16 v[244:247], a[60:63], a[108:111], v[244:247]
ds_read_b64_tr_b16 a[98:99], v12 offset:1280
v_mfma_f32_16x16x32_bf16 v[236:239], a[56:59], a[108:111], v[236:239]
ds_read_b64_tr_b16 a[100:101], v12 offset:8448
v_mfma_f32_16x16x32_bf16 v[236:239], a[40:43], a[104:107], v[236:239]
ds_read_b64_tr_b16 a[102:103], v12 offset:9472
v_mfma_f32_16x16x32_bf16 v[228:231], a[36:39], a[104:107], v[228:231]
v_mfma_f32_16x16x32_bf16 v[228:231], a[52:55], a[108:111], v[228:231]
s_add_u32 m0, s17, 0xc00
v_mfma_f32_16x16x32_bf16 v[220:223], a[48:51], a[108:111], v[220:223]
buffer_load_dwordx4 v6, s[52:55], s13 offen lds
v_mfma_f32_16x16x32_bf16 v[220:223], a[32:35], a[104:107], v[220:223]
s_waitcnt lgkmcnt(4)
L_S16:
v_mfma_f32_16x16x32_bf16 v[24:27], a[80:83], a[0:3], v[24:27]
ds_read_b64_tr_b16 a[104:105], v13 offset:256
s_waitcnt vmcnt(23)
v_mfma_f32_16x16x32_bf16 v[24:27], a[84:87], a[16:19], v[24:27]
ds_read_b64_tr_b16 a[106:107], v13 offset:1280
v_mfma_f32_16x16x32_bf16 v[32:35], a[84:87], a[20:23], v[32:35]
ds_read_b64_tr_b16 a[108:109], v13 offset:8448
v_mfma_f32_16x16x32_bf16 v[32:35], a[80:83], a[4:7], v[32:35]
ds_read_b64_tr_b16 a[110:111], v13 offset:9472
v_mfma_f32_16x16x32_bf16 v[40:43], a[80:83], a[8:11], v[40:43]
ds_read_b128 a[32:35], v8 offset:32768
s_add_u32 m0, s18, 0x4000
v_mfma_f32_16x16x32_bf16 v[40:43], a[84:87], a[24:27], v[40:43]
buffer_load_dwordx4 v7, s[68:71], 0 offen lds
v_mfma_f32_16x16x32_bf16 v[48:51], a[84:87], a[28:31], v[48:51]
ds_read_b128 a[48:51], v9 offset:32768
v_mfma_f32_16x16x32_bf16 v[48:51], a[80:83], a[12:15], v[48:51]
ds_read_b128 a[36:39], v8 offset:34816
v_mfma_f32_16x16x32_bf16 v[52:55], a[88:91], a[12:15], v[52:55]
ds_read_b64_tr_b16 a[80:81], v12 offset:512
v_mfma_f32_16x16x32_bf16 v[52:55], a[92:95], a[28:31], v[52:55]
ds_read_b64_tr_b16 a[82:83], v12 offset:1536
v_mfma_f32_16x16x32_bf16 v[44:47], a[92:95], a[24:27], v[44:47]
ds_read_b64_tr_b16 a[84:85], v12 offset:8704
s_add_u32 s8, s28, 0x9000
v_mfma_f32_16x16x32_bf16 v[44:47], a[88:91], a[8:11], v[44:47]
buffer_store_dwordx4 a[228:231], v16, s[88:91], s8 offen sc1
v_mfma_f32_16x16x32_bf16 v[36:39], a[88:91], a[4:7], v[36:39]
ds_read_b64_tr_b16 a[86:87], v12 offset:9728
v_mfma_f32_16x16x32_bf16 v[36:39], a[92:95], a[20:23], v[36:39]
ds_read_b128 a[52:55], v9 offset:34816
v_mfma_f32_16x16x32_bf16 v[28:31], a[92:95], a[16:19], v[28:31]
ds_read_b128 a[40:43], v8 offset:36864
v_mfma_f32_16x16x32_bf16 v[28:31], a[88:91], a[0:3], v[28:31]
ds_read_b128 a[56:59], v9 offset:36864
s_waitcnt lgkmcnt(10)
v_mfma_f32_16x16x32_bf16 v[56:59], a[96:99], a[0:3], v[56:59]
ds_read_b64_tr_b16 a[88:89], v13 offset:512
v_mfma_f32_16x16x32_bf16 v[56:59], a[100:103], a[16:19], v[56:59]
ds_read_b64_tr_b16 a[90:91], v13 offset:1536
s_add_u32 m0, s18, 0x5000
v_mfma_f32_16x16x32_bf16 v[64:67], a[100:103], a[20:23], v[64:67]
buffer_load_dwordx4 v7, s[68:71], s25 offen lds
v_mfma_f32_16x16x32_bf16 v[64:67], a[96:99], a[4:7], v[64:67]
ds_read_b64_tr_b16 a[92:93], v13 offset:8704
v_mfma_f32_16x16x32_bf16 v[72:75], a[96:99], a[8:11], v[72:75]
ds_read_b64_tr_b16 a[94:95], v13 offset:9728
v_mfma_f32_16x16x32_bf16 v[72:75], a[100:103], a[24:27], v[72:75]
ds_read_b128 a[44:47], v8 offset:38912
v_mfma_f32_16x16x32_bf16 v[80:83], a[100:103], a[28:31], v[80:83]
ds_read_b128 a[60:63], v9 offset:38912
v_mfma_f32_16x16x32_bf16 v[80:83], a[96:99], a[12:15], v[80:83]
v_mfma_f32_16x16x32_bf16 v[84:87], a[104:107], a[12:15], v[84:87]
ds_read_b64_tr_b16 a[96:97], v12 offset:768
s_add_u32 m0, s18, 0x6000
v_mfma_f32_16x16x32_bf16 v[84:87], a[108:111], a[28:31], v[84:87]
buffer_load_dwordx4 v7, s[68:71], s26 offen lds
v_mfma_f32_16x16x32_bf16 v[76:79], a[108:111], a[24:27], v[76:79]
ds_read_b64_tr_b16 a[98:99], v12 offset:1792
v_lshl_add_u32 v5, s42, 19, v5
v_mfma_f32_16x16x32_bf16 v[76:79], a[104:107], a[8:11], v[76:79]
ds_read_b64_tr_b16 a[100:101], v12 offset:8960
v_lshl_add_u32 v6, s42, 19, v6
v_mfma_f32_16x16x32_bf16 v[68:71], a[104:107], a[4:7], v[68:71]
ds_read_b64_tr_b16 a[102:103], v12 offset:9984
v_lshl_add_u32 v7, s42, 18, v7
v_mfma_f32_16x16x32_bf16 v[68:71], a[108:111], a[20:23], v[68:71]
v_lshl_add_u32 v7, s42, 17, v7
v_mfma_f32_16x16x32_bf16 v[60:63], a[108:111], a[16:19], v[60:63]
v_mfma_f32_16x16x32_bf16 v[60:63], a[104:107], a[0:3], v[60:63]
s_add_u32 m0, s16, 0x8000
s_waitcnt lgkmcnt(4)
s_waitcnt lgkmcnt(6)
v_mfma_f32_16x16x32_bf16 v[88:91], a[80:83], a[0:3], v[88:91]
buffer_load_dwordx4 v22, s[44:47], s20 offen lds
v_mfma_f32_16x16x32_bf16 v[88:91], a[84:87], a[16:19], v[88:91]
ds_read_b64_tr_b16 a[104:105], v13 offset:768
v_mfma_f32_16x16x32_bf16 v[96:99], a[84:87], a[20:23], v[96:99]
ds_read_b64_tr_b16 a[106:107], v13 offset:1792
v_mfma_f32_16x16x32_bf16 v[96:99], a[80:83], a[4:7], v[96:99]
ds_read_b64_tr_b16 a[108:109], v13 offset:8960
v_mfma_f32_16x16x32_bf16 v[104:107], a[80:83], a[8:11], v[104:107]
ds_read_b64_tr_b16 a[110:111], v13 offset:9984
s_add_u32 m0, s16, 0x8400
v_mfma_f32_16x16x32_bf16 v[104:107], a[84:87], a[24:27], v[104:107]
buffer_load_dwordx4 v23, s[44:47], s20 offen lds
v_mfma_f32_16x16x32_bf16 v[112:115], a[84:87], a[28:31], v[112:115]
v_mfma_f32_16x16x32_bf16 v[112:115], a[80:83], a[12:15], v[112:115]
v_mfma_f32_16x16x32_bf16 v[116:119], a[88:91], a[12:15], v[116:119]
ds_read_b64_tr_b16 a[80:81], v14 offset:0
v_mfma_f32_16x16x32_bf16 v[116:119], a[92:95], a[28:31], v[116:119]
ds_read_b64_tr_b16 a[82:83], v14 offset:256
v_mfma_f32_16x16x32_bf16 v[108:111], a[92:95], a[24:27], v[108:111]
ds_read_b64_tr_b16 a[84:85], v14 offset:2048
s_add_u32 m0, s16, 0x8800
v_mfma_f32_16x16x32_bf16 v[108:111], a[88:91], a[8:11], v[108:111]
buffer_load_dwordx4 v22, s[44:47], s21 offen lds
v_mfma_f32_16x16x32_bf16 v[100:103], a[88:91], a[4:7], v[100:103]
ds_read_b64_tr_b16 a[86:87], v14 offset:2304
v_mfma_f32_16x16x32_bf16 v[100:103], a[92:95], a[20:23], v[100:103]
v_mfma_f32_16x16x32_bf16 v[92:95], a[92:95], a[16:19], v[92:95]
v_mfma_f32_16x16x32_bf16 v[92:95], a[88:91], a[0:3], v[92:95]
s_add_u32 s8, s28, 0x5400
s_waitcnt lgkmcnt(4)
v_mfma_f32_16x16x32_bf16 v[120:123], a[96:99], a[0:3], v[120:123]
buffer_store_dwordx4 a[112:115], v16, s[88:91], s8 offen sc1
v_mfma_f32_16x16x32_bf16 v[120:123], a[100:103], a[16:19], v[120:123]
ds_read_b64_tr_b16 a[88:89], v15 offset:0
v_mfma_f32_16x16x32_bf16 v[128:131], a[100:103], a[20:23], v[128:131]
ds_read_b64_tr_b16 a[90:91], v15 offset:256
v_mfma_f32_16x16x32_bf16 v[128:131], a[96:99], a[4:7], v[128:131]
ds_read_b64_tr_b16 a[92:93], v15 offset:2048
v_mfma_f32_16x16x32_bf16 v[136:139], a[96:99], a[8:11], v[136:139]
ds_read_b64_tr_b16 a[94:95], v15 offset:2304
v_mfma_f32_16x16x32_bf16 v[136:139], a[100:103], a[24:27], v[136:139]
s_add_u32 m0, s16, 0x8c00
v_mfma_f32_16x16x32_bf16 v[144:147], a[100:103], a[28:31], v[144:147]
buffer_load_dwordx4 v23, s[44:47], s21 offen lds
v_mfma_f32_16x16x32_bf16 v[144:147], a[96:99], a[12:15], v[144:147]
v_mfma_f32_16x16x32_bf16 v[148:151], a[104:107], a[12:15], v[148:151]
ds_read_b64_tr_b16 a[96:97], v14 offset:4096
v_mfma_f32_16x16x32_bf16 v[148:151], a[108:111], a[28:31], v[148:151]
ds_read_b64_tr_b16 a[98:99], v14 offset:4352
v_mfma_f32_16x16x32_bf16 v[140:143], a[108:111], a[24:27], v[140:143]
ds_read_b64_tr_b16 a[100:101], v14 offset:6144
v_mfma_f32_16x16x32_bf16 v[140:143], a[104:107], a[8:11], v[140:143]
ds_read_b64_tr_b16 a[102:103], v14 offset:6400
s_add_u32 m0, s16, 0x9000
v_mfma_f32_16x16x32_bf16 v[132:135], a[104:107], a[4:7], v[132:135]
buffer_load_dwordx4 v22, s[44:47], s22 offen lds
v_mfma_f32_16x16x32_bf16 v[132:135], a[108:111], a[20:23], v[132:135]
v_mfma_f32_16x16x32_bf16 v[124:127], a[108:111], a[16:19], v[124:127]
v_mfma_f32_16x16x32_bf16 v[124:127], a[104:107], a[0:3], v[124:127]
s_waitcnt lgkmcnt(4)
v_mfma_f32_16x16x32_bf16 v[152:155], a[80:83], a[0:3], v[152:155]
ds_read_b64_tr_b16 a[104:105], v15 offset:4096
s_add_u32 m0, s16, 0x9400
v_mfma_f32_16x16x32_bf16 v[152:155], a[84:87], a[16:19], v[152:155]
buffer_load_dwordx4 v23, s[44:47], s22 offen lds
v_mfma_f32_16x16x32_bf16 v[160:163], a[84:87], a[20:23], v[160:163]
ds_read_b64_tr_b16 a[106:107], v15 offset:4352
v_mfma_f32_16x16x32_bf16 v[160:163], a[80:83], a[4:7], v[160:163]
ds_read_b64_tr_b16 a[108:109], v15 offset:6144
v_mfma_f32_16x16x32_bf16 v[168:171], a[80:83], a[8:11], v[168:171]
ds_read_b64_tr_b16 a[110:111], v15 offset:6400
v_mfma_f32_16x16x32_bf16 v[168:171], a[84:87], a[24:27], v[168:171]
v_mfma_f32_16x16x32_bf16 v[176:179], a[84:87], a[28:31], v[176:179]
s_add_u32 m0, s16, 0x9800
v_mfma_f32_16x16x32_bf16 v[176:179], a[80:83], a[12:15], v[176:179]
buffer_load_dwordx4 v22, s[44:47], s23 offen lds
v_mfma_f32_16x16x32_bf16 v[180:183], a[88:91], a[12:15], v[180:183]
ds_read_b64_tr_b16 a[80:81], v14 offset:8192
v_mfma_f32_16x16x32_bf16 v[180:183], a[92:95], a[28:31], v[180:183]
ds_read_b64_tr_b16 a[82:83], v14 offset:8448
v_mfma_f32_16x16x32_bf16 v[172:175], a[92:95], a[24:27], v[172:175]
ds_read_b64_tr_b16 a[84:85], v14 offset:10240
v_mfma_f32_16x16x32_bf16 v[172:175], a[88:91], a[8:11], v[172:175]
ds_read_b64_tr_b16 a[86:87], v14 offset:10496
s_add_u32 m0, s16, 0x9c00
v_mfma_f32_16x16x32_bf16 v[164:167], a[88:91], a[4:7], v[164:167]
buffer_load_dwordx4 v23, s[44:47], s23 offen lds
v_mfma_f32_16x16x32_bf16 v[164:167], a[92:95], a[20:23], v[164:167]
v_lshl_add_u32 v22, s42, 7, v22
v_lshl_add_u32 v23, s42, 7, v23
v_mfma_f32_16x16x32_bf16 v[156:159], a[92:95], a[16:19], v[156:159]
v_mfma_f32_16x16x32_bf16 v[156:159], a[88:91], a[0:3], v[156:159]
s_waitcnt lgkmcnt(4)
v_mfma_f32_16x16x32_bf16 v[184:187], a[96:99], a[0:3], v[184:187]
ds_read_b64_tr_b16 a[88:89], v15 offset:8192
v_mfma_f32_16x16x32_bf16 v[184:187], a[100:103], a[16:19], v[184:187]
ds_read_b64_tr_b16 a[90:91], v15 offset:8448
s_add_u32 s8, s28, 0x9400
v_mfma_f32_16x16x32_bf16 v[192:195], a[100:103], a[20:23], v[192:195]
buffer_store_dwordx4 a[116:119], v16, s[88:91], s8 offen sc1
v_mfma_f32_16x16x32_bf16 v[192:195], a[96:99], a[4:7], v[192:195]
ds_read_b64_tr_b16 a[92:93], v15 offset:10240
v_mfma_f32_16x16x32_bf16 v[200:203], a[96:99], a[8:11], v[200:203]
ds_read_b64_tr_b16 a[94:95], v15 offset:10496
v_add_u32 v12, 0x8000, v12
v_mfma_f32_16x16x32_bf16 v[200:203], a[100:103], a[24:27], v[200:203]
v_add_u32 v13, 0x8000, v13
v_add_u32 v14, 0x8000, v14
v_mfma_f32_16x16x32_bf16 v[208:211], a[100:103], a[28:31], v[208:211]
v_add_u32 v15, 0x8000, v15
v_mfma_f32_16x16x32_bf16 v[208:211], a[96:99], a[12:15], v[208:211]
v_mfma_f32_16x16x32_bf16 v[212:215], a[104:107], a[12:15], v[212:215]
s_waitcnt vmcnt(28) lgkmcnt(0)
v_mfma_f32_16x16x32_bf16 v[212:215], a[108:111], a[28:31], v[212:215]
s_barrier
s_add_u32 m0, s17, 0x8000
v_mfma_f32_16x16x32_bf16 v[204:207], a[108:111], a[24:27], v[204:207]
buffer_load_dwordx4 v5, s[52:55], 0 offen lds
v_mfma_f32_16x16x32_bf16 v[204:207], a[104:107], a[8:11], v[204:207]
ds_read_b64_tr_b16 a[96:97], v12 offset:0
v_mfma_f32_16x16x32_bf16 v[196:199], a[104:107], a[4:7], v[196:199]
ds_read_b64_tr_b16 a[98:99], v12 offset:1024
v_mfma_f32_16x16x32_bf16 v[196:199], a[108:111], a[20:23], v[196:199]
ds_read_b64_tr_b16 a[100:101], v12 offset:8192
v_mfma_f32_16x16x32_bf16 v[188:191], a[108:111], a[16:19], v[188:191]
ds_read_b64_tr_b16 a[102:103], v12 offset:9216
v_mfma_f32_16x16x32_bf16 v[188:191], a[104:107], a[0:3], v[188:191]
s_add_u32 m0, s17, 0x8400
s_waitcnt lgkmcnt(4)
v_mfma_f32_16x16x32_bf16 v[216:219], a[0:3], a[80:83], v[216:219]
buffer_load_dwordx4 v5, s[52:55], s13 offen lds
v_mfma_f32_16x16x32_bf16 v[216:219], a[16:19], a[84:87], v[216:219]
ds_read_b64_tr_b16 a[104:105], v13 offset:0
v_mfma_f32_16x16x32_bf16 v[224:227], a[20:23], a[84:87], v[224:227]
ds_read_b64_tr_b16 a[106:107], v13 offset:1024
v_mfma_f32_16x16x32_bf16 v[224:227], a[4:7], a[80:83], v[224:227]
ds_read_b64_tr_b16 a[108:109], v13 offset:8192
v_mfma_f32_16x16x32_bf16 v[232:235], a[8:11], a[80:83], v[232:235]
ds_read_b64_tr_b16 a[110:111], v13 offset:9216
v_mfma_f32_16x16x32_bf16 v[232:235], a[24:27], a[84:87], v[232:235]
s_add_u32 m0, s17, 0x8800
v_mfma_f32_16x16x32_bf16 v[240:243], a[28:31], a[84:87], v[240:243]
buffer_load_dwordx4 v6, s[52:55], 0 offen lds
v_mfma_f32_16x16x32_bf16 v[240:243], a[12:15], a[80:83], v[240:243]
v_mfma_f32_16x16x32_bf16 v[244:247], a[12:15], a[88:91], v[244:247]
ds_read_b64_tr_b16 a[80:81], v12 offset:256
v_mfma_f32_16x16x32_bf16 v[244:247], a[28:31], a[92:95], v[244:247]
ds_read_b64_tr_b16 a[82:83], v12 offset:1280
v_mfma_f32_16x16x32_bf16 v[236:239], a[24:27], a[92:95], v[236:239]
ds_read_b64_tr_b16 a[84:85], v12 offset:8448
v_mfma_f32_16x16x32_bf16 v[236:239], a[8:11], a[88:91], v[236:239]
ds_read_b64_tr_b16 a[86:87], v12 offset:9472
s_add_u32 s8, s28, 0x5800
v_mfma_f32_16x16x32_bf16 v[228:231], a[4:7], a[88:91], v[228:231]
buffer_store_dwordx4 a[124:127], v16, s[88:91], s8 offen sc1
v_mfma_f32_16x16x32_bf16 v[228:231], a[20:23], a[92:95], v[228:231]
v_mfma_f32_16x16x32_bf16 v[220:223], a[16:19], a[92:95], v[220:223]
v_mfma_f32_16x16x32_bf16 v[220:223], a[0:3], a[88:91], v[220:223]
s_waitcnt lgkmcnt(4)
L_S17:
v_mfma_f32_16x16x32_bf16 v[24:27], a[96:99], a[32:35], v[24:27]
ds_read_b64_tr_b16 a[88:89], v13 offset:256
s_waitcnt vmcnt(23)
v_mfma_f32_16x16x32_bf16 v[24:27], a[100:103], a[48:51], v[24:27]
ds_read_b64_tr_b16 a[90:91], v13 offset:1280
s_add_u32 m0, s17, 0x8c00
v_mfma_f32_16x16x32_bf16 v[32:35], a[100:103], a[52:55], v[32:35]
buffer_load_dwordx4 v6, s[52:55], s13 offen lds
v_mfma_f32_16x16x32_bf16 v[32:35], a[96:99], a[36:39], v[32:35]
ds_read_b64_tr_b16 a[92:93], v13 offset:8448
v_mfma_f32_16x16x32_bf16 v[40:43], a[96:99], a[40:43], v[40:43]
ds_read_b64_tr_b16 a[94:95], v13 offset:9472
v_mfma_f32_16x16x32_bf16 v[40:43], a[100:103], a[56:59], v[40:43]
ds_read_b128 a[0:3], v8 offset:0
v_mfma_f32_16x16x32_bf16 v[48:51], a[100:103], a[60:63], v[48:51]
ds_read_b128 a[16:19], v9 offset:0
v_mfma_f32_16x16x32_bf16 v[48:51], a[96:99], a[44:47], v[48:51]
ds_read_b128 a[4:7], v8 offset:2048
s_add_u32 m0, s18, 0xc000
v_mfma_f32_16x16x32_bf16 v[52:55], a[104:107], a[44:47], v[52:55]
buffer_load_dwordx4 v7, s[68:71], 0 offen lds
v_mfma_f32_16x16x32_bf16 v[52:55], a[108:111], a[60:63], v[52:55]
ds_read_b64_tr_b16 a[96:97], v12 offset:512
v_mfma_f32_16x16x32_bf16 v[44:47], a[108:111], a[56:59], v[44:47]
ds_read_b64_tr_b16 a[98:99], v12 offset:1536
v_mfma_f32_16x16x32_bf16 v[44:47], a[104:107], a[40:43], v[44:47]
ds_read_b64_tr_b16 a[100:101], v12 offset:8704
v_mfma_f32_16x16x32_bf16 v[36:39], a[104:107], a[36:39], v[36:39]
ds_read_b64_tr_b16 a[102:103], v12 offset:9728
v_mfma_f32_16x16x32_bf16 v[36:39], a[108:111], a[52:55], v[36:39]
ds_read_b128 a[20:23], v9 offset:2048
s_add_u32 m0, s18, 0xd000
v_mfma_f32_16x16x32_bf16 v[28:31], a[108:111], a[48:51], v[28:31]
buffer_load_dwordx4 v7, s[68:71], s25 offen lds
v_mfma_f32_16x16x32_bf16 v[28:31], a[104:107], a[32:35], v[28:31]
ds_read_b128 a[8:11], v8 offset:4096
s_waitcnt lgkmcnt(9)
v_mfma_f32_16x16x32_bf16 v[56:59], a[80:83], a[32:35], v[56:59]
ds_read_b64_tr_b16 a[104:105], v13 offset:512
v_mfma_f32_16x16x32_bf16 v[56:59], a[84:87], a[48:51], v[56:59]
ds_read_b64_tr_b16 a[106:107], v13 offset:1536
v_mfma_f32_16x16x32_bf16 v[64:67], a[84:87], a[52:55], v[64:67]
ds_read_b64_tr_b16 a[108:109], v13 offset:8704
v_mfma_f32_16x16x32_bf16 v[64:67], a[80:83], a[36:39], v[64:67]
ds_read_b64_tr_b16 a[110:111], v13 offset:9728
s_add_u32 m0, s18, 0xe000
v_mfma_f32_16x16x32_bf16 v[72:75], a[80:83], a[40:43], v[72:75]
buffer_load_dwordx4 v7, s[68:71], s26 offen lds
v_mfma_f32_16x16x32_bf16 v[72:75], a[84:87], a[56:59], v[72:75]
ds_read_b128 a[24:27], v9 offset:4096
v_lshl_add_u32 v5, s42, 19, v5
v_mfma_f32_16x16x32_bf16 v[80:83], a[84:87], a[60:63], v[80:83]
ds_read_b128 a[12:15], v8 offset:6144
v_lshl_add_u32 v6, s42, 19, v6
v_mfma_f32_16x16x32_bf16 v[80:83], a[80:83], a[44:47], v[80:83]
ds_read_b128 a[28:31], v9 offset:6144
v_lshl_add_u32 v7, s42, 18, v7
v_mfma_f32_16x16x32_bf16 v[84:87], a[88:91], a[44:47], v[84:87]
ds_read_b64_tr_b16 a[80:81], v12 offset:768
v_lshl_add_u32 v7, s42, 17, v7
v_mfma_f32_16x16x32_bf16 v[84:87], a[92:95], a[60:63], v[84:87]
ds_read_b64_tr_b16 a[82:83], v12 offset:1792
s_add_u32 s8, s28, 0x9800
v_mfma_f32_16x16x32_bf16 v[76:79], a[92:95], a[56:59], v[76:79]
buffer_store_dwordx4 a[232:235], v16, s[88:91], s8 offen sc1
v_mfma_f32_16x16x32_bf16 v[76:79], a[88:91], a[40:43], v[76:79]
ds_read_b64_tr_b16 a[84:85], v12 offset:8960
v_mfma_f32_16x16x32_bf16 v[68:71], a[88:91], a[36:39], v[68:71]
ds_read_b64_tr_b16 a[86:87], v12 offset:9984
v_mfma_f32_16x16x32_bf16 v[68:71], a[92:95], a[52:55], v[68:71]
v_mfma_f32_16x16x32_bf16 v[60:63], a[92:95], a[48:51], v[60:63]
v_mfma_f32_16x16x32_bf16 v[60:63], a[88:91], a[32:35], v[60:63]
s_add_u32 m0, s16, 0x0
s_waitcnt lgkmcnt(4)
s_waitcnt lgkmcnt(7)
v_mfma_f32_16x16x32_bf16 v[88:91], a[96:99], a[32:35], v[88:91]
buffer_load_dwordx4 v22, s[44:47], s20 offen lds
v_mfma_f32_16x16x32_bf16 v[88:91], a[100:103], a[48:51], v[88:91]
ds_read_b64_tr_b16 a[88:89], v13 offset:768
v_mfma_f32_16x16x32_bf16 v[96:99], a[100:103], a[52:55], v[96:99]
ds_read_b64_tr_b16 a[90:91], v13 offset:1792
v_mfma_f32_16x16x32_bf16 v[96:99], a[96:99], a[36:39], v[96:99]
ds_read_b64_tr_b16 a[92:93], v13 offset:8960
v_mfma_f32_16x16x32_bf16 v[104:107], a[96:99], a[40:43], v[104:107]
ds_read_b64_tr_b16 a[94:95], v13 offset:9984
s_add_u32 m0, s16, 0x400
v_mfma_f32_16x16x32_bf16 v[104:107], a[100:103], a[56:59], v[104:107]
buffer_load_dwordx4 v23, s[44:47], s20 offen lds
v_mfma_f32_16x16x32_bf16 v[112:115], a[100:103], a[60:63], v[112:115]
v_mfma_f32_16x16x32_bf16 v[112:115], a[96:99], a[44:47], v[112:115]
v_mfma_f32_16x16x32_bf16 v[116:119], a[104:107], a[44:47], v[116:119]
ds_read_b64_tr_b16 a[96:97], v14 offset:0
v_mfma_f32_16x16x32_bf16 v[116:119], a[108:111], a[60:63], v[116:119]
ds_read_b64_tr_b16 a[98:99], v14 offset:256
v_mfma_f32_16x16x32_bf16 v[108:111], a[108:111], a[56:59], v[108:111]
ds_read_b64_tr_b16 a[100:101], v14 offset:2048
s_add_u32 m0, s16, 0x800
v_mfma_f32_16x16x32_bf16 v[108:111], a[104:107], a[40:43], v[108:111]
buffer_load_dwordx4 v22, s[44:47], s21 offen lds
v_mfma_f32_16x16x32_bf16 v[100:103], a[104:107], a[36:39], v[100:103]
ds_read_b64_tr_b16 a[102:103], v14 offset:2304
v_mfma_f32_16x16x32_bf16 v[100:103], a[108:111], a[52:55], v[100:103]
v_mfma_f32_16x16x32_bf16 v[92:95], a[108:111], a[48:51], v[92:95]
v_mfma_f32_16x16x32_bf16 v[92:95], a[104:107], a[32:35], v[92:95]
s_add_u32 m0, s16, 0xc00
s_waitcnt lgkmcnt(4)
v_mfma_f32_16x16x32_bf16 v[120:123], a[80:83], a[32:35], v[120:123]
buffer_load_dwordx4 v23, s[44:47], s21 offen lds
v_mfma_f32_16x16x32_bf16 v[120:123], a[84:87], a[48:51], v[120:123]
ds_read_b64_tr_b16 a[104:105], v15 offset:0
v_mfma_f32_16x16x32_bf16 v[128:131], a[84:87], a[52:55], v[128:131]
ds_read_b64_tr_b16 a[106:107], v15 offset:256
v_mfma_f32_16x16x32_bf16 v[128:131], a[80:83], a[36:39], v[128:131]
ds_read_b64_tr_b16 a[108:109], v15 offset:2048
v_mfma_f32_16x16x32_bf16 v[136:139], a[80:83], a[40:43], v[136:139]
ds_read_b64_tr_b16 a[110:111], v15 offset:2304
v_mfma_f32_16x16x32_bf16 v[136:139], a[84:87], a[56:59], v[136:139]
s_add_u32 s8, s28, 0x5c00
v_mfma_f32_16x16x32_bf16 v[144:147], a[84:87], a[60:63], v[144:147]
buffer_store_dwordx4 a[240:243], v16, s[88:91], s8 offen sc1
v_mfma_f32_16x16x32_bf16 v[144:147], a[80:83], a[44:47], v[144:147]
v_mfma_f32_16x16x32_bf16 v[148:151], a[88:91], a[44:47], v[148:151]
ds_read_b64_tr_b16 a[80:81], v14 offset:4096
v_mfma_f32_16x16x32_bf16 v[148:151], a[92:95], a[60:63], v[148:151]
ds_read_b64_tr_b16 a[82:83], v14 offset:4352
v_mfma_f32_16x16x32_bf16 v[140:143], a[92:95], a[56:59], v[140:143]
ds_read_b64_tr_b16 a[84:85], v14 offset:6144
v_mfma_f32_16x16x32_bf16 v[140:143], a[88:91], a[40:43], v[140:143]
ds_read_b64_tr_b16 a[86:87], v14 offset:6400
s_add_u32 m0, s16, 0x1000
v_mfma_f32_16x16x32_bf16 v[132:135], a[88:91], a[36:39], v[132:135]
buffer_load_dwordx4 v22, s[44:47], s22 offen lds
v_mfma_f32_16x16x32_bf16 v[132:135], a[92:95], a[52:55], v[132:135]
v_mfma_f32_16x16x32_bf16 v[124:127], a[92:95], a[48:51], v[124:127]
v_mfma_f32_16x16x32_bf16 v[124:127], a[88:91], a[32:35], v[124:127]
s_waitcnt lgkmcnt(4)
v_mfma_f32_16x16x32_bf16 v[152:155], a[96:99], a[32:35], v[152:155]
ds_read_b64_tr_b16 a[88:89], v15 offset:4096
s_add_u32 m0, s16, 0x1400
v_mfma_f32_16x16x32_bf16 v[152:155], a[100:103], a[48:51], v[152:155]
buffer_load_dwordx4 v23, s[44:47], s22 offen lds
v_mfma_f32_16x16x32_bf16 v[160:163], a[100:103], a[52:55], v[160:163]
ds_read_b64_tr_b16 a[90:91], v15 offset:4352
v_mfma_f32_16x16x32_bf16 v[160:163], a[96:99], a[36:39], v[160:163]
ds_read_b64_tr_b16 a[92:93], v15 offset:6144
v_mfma_f32_16x16x32_bf16 v[168:171], a[96:99], a[40:43], v[168:171]
ds_read_b64_tr_b16 a[94:95], v15 offset:6400
v_mfma_f32_16x16x32_bf16 v[168:171], a[100:103], a[56:59], v[168:171]
v_mfma_f32_16x16x32_bf16 v[176:179], a[100:103], a[60:63], v[176:179]
s_add_u32 m0, s16, 0x1800
v_mfma_f32_16x16x32_bf16 v[176:179], a[96:99], a[44:47], v[176:179]
buffer_load_dwordx4 v22, s[44:47], s23 offen lds
v_mfma_f32_16x16x32_bf16 v[180:183], a[104:107], a[44:47], v[180:183]
ds_read_b64_tr_b16 a[96:97], v14 offset:8192
v_mfma_f32_16x16x32_bf16 v[180:183], a[108:111], a[60:63], v[180:183]
ds_read_b64_tr_b16 a[98:99], v14 offset:8448
v_mfma_f32_16x16x32_bf16 v[172:175], a[108:111], a[56:59], v[172:175]
ds_read_b64_tr_b16 a[100:101], v14 offset:10240
v_mfma_f32_16x16x32_bf16 v[172:175], a[104:107], a[40:43], v[172:175]
ds_read_b64_tr_b16 a[102:103], v14 offset:10496
s_add_u32 m0, s16, 0x1c00
v_mfma_f32_16x16x32_bf16 v[164:167], a[104:107], a[36:39], v[164:167]
buffer_load_dwordx4 v23, s[44:47], s23 offen lds
v_mfma_f32_16x16x32_bf16 v[164:167], a[108:111], a[52:55], v[164:167]
v_lshl_add_u32 v22, s42, 7, v22
v_lshl_add_u32 v23, s42, 7, v23
v_mfma_f32_16x16x32_bf16 v[156:159], a[108:111], a[48:51], v[156:159]
v_mfma_f32_16x16x32_bf16 v[156:159], a[104:107], a[32:35], v[156:159]
s_waitcnt lgkmcnt(4)
v_mfma_f32_16x16x32_bf16 v[184:187], a[80:83], a[32:35], v[184:187]
ds_read_b64_tr_b16 a[104:105], v15 offset:8192
v_mfma_f32_16x16x32_bf16 v[184:187], a[84:87], a[48:51], v[184:187]
ds_read_b64_tr_b16 a[106:107], v15 offset:8448
s_add_u32 s8, s28, 0x9c00
v_mfma_f32_16x16x32_bf16 v[192:195], a[84:87], a[52:55], v[192:195]
buffer_store_dwordx4 a[248:251], v16, s[88:91], s8 offen sc1
v_mfma_f32_16x16x32_bf16 v[192:195], a[80:83], a[36:39], v[192:195]
ds_read_b64_tr_b16 a[108:109], v15 offset:10240
v_mfma_f32_16x16x32_bf16 v[200:203], a[80:83], a[40:43], v[200:203]
ds_read_b64_tr_b16 a[110:111], v15 offset:10496
v_add_u32 v12, 0xffff0000, v12
v_mfma_f32_16x16x32_bf16 v[200:203], a[84:87], a[56:59], v[200:203]
v_add_u32 v13, 0xffff0000, v13
v_add_u32 v14, 0xffff0000, v14
v_mfma_f32_16x16x32_bf16 v[208:211], a[84:87], a[60:63], v[208:211]
v_add_u32 v15, 0xffff0000, v15
v_mfma_f32_16x16x32_bf16 v[208:211], a[80:83], a[44:47], v[208:211]
v_mfma_f32_16x16x32_bf16 v[212:215], a[88:91], a[44:47], v[212:215]
s_waitcnt vmcnt(29) lgkmcnt(0)
v_mfma_f32_16x16x32_bf16 v[212:215], a[92:95], a[60:63], v[212:215]
s_barrier
s_add_u32 m0, s17, 0x10000
v_mfma_f32_16x16x32_bf16 v[204:207], a[92:95], a[56:59], v[204:207]
buffer_load_dwordx4 v5, s[52:55], 0 offen lds
v_mfma_f32_16x16x32_bf16 v[204:207], a[88:91], a[40:43], v[204:207]
ds_read_b64_tr_b16 a[80:81], v12 offset:0
v_mfma_f32_16x16x32_bf16 v[196:199], a[88:91], a[36:39], v[196:199]
ds_read_b64_tr_b16 a[82:83], v12 offset:1024
v_mfma_f32_16x16x32_bf16 v[196:199], a[92:95], a[52:55], v[196:199]
ds_read_b64_tr_b16 a[84:85], v12 offset:8192
v_mfma_f32_16x16x32_bf16 v[188:191], a[92:95], a[48:51], v[188:191]
ds_read_b64_tr_b16 a[86:87], v12 offset:9216
v_mfma_f32_16x16x32_bf16 v[188:191], a[88:91], a[32:35], v[188:191]
s_add_u32 m0, s17, 0x10400
s_waitcnt lgkmcnt(4)
v_mfma_f32_16x16x32_bf16 v[216:219], a[32:35], a[96:99], v[216:219]
buffer_load_dwordx4 v5, s[52:55], s13 offen lds
v_mfma_f32_16x16x32_bf16 v[216:219], a[48:51], a[100:103], v[216:219]
ds_read_b64_tr_b16 a[88:89], v13 offset:0
v_mfma_f32_16x16x32_bf16 v[224:227], a[52:55], a[100:103], v[224:227]
ds_read_b64_tr_b16 a[90:91], v13 offset:1024
v_mfma_f32_16x16x32_bf16 v[224:227], a[36:39], a[96:99], v[224:227]
ds_read_b64_tr_b16 a[92:93], v13 offset:8192
v_mfma_f32_16x16x32_bf16 v[232:235], a[40:43], a[96:99], v[232:235]
ds_read_b64_tr_b16 a[94:95], v13 offset:9216
v_mfma_f32_16x16x32_bf16 v[232:235], a[56:59], a[100:103], v[232:235]
v_mfma_f32_16x16x32_bf16 v[240:243], a[60:63], a[100:103], v[240:243]
s_add_u32 m0, s17, 0x10800
v_mfma_f32_16x16x32_bf16 v[240:243], a[44:47], a[96:99], v[240:243]
buffer_load_dwordx4 v6, s[52:55], 0 offen lds
v_mfma_f32_16x16x32_bf16 v[244:247], a[44:47], a[104:107], v[244:247]
ds_read_b64_tr_b16 a[96:97], v12 offset:256
v_mfma_f32_16x16x32_bf16 v[244:247], a[60:63], a[108:111], v[244:247]
ds_read_b64_tr_b16 a[98:99], v12 offset:1280
v_mfma_f32_16x16x32_bf16 v[236:239], a[56:59], a[108:111], v[236:239]
ds_read_b64_tr_b16 a[100:101], v12 offset:8448
v_mfma_f32_16x16x32_bf16 v[236:239], a[40:43], a[104:107], v[236:239]
ds_read_b64_tr_b16 a[102:103], v12 offset:9472
v_mfma_f32_16x16x32_bf16 v[228:231], a[36:39], a[104:107], v[228:231]
v_mfma_f32_16x16x32_bf16 v[228:231], a[52:55], a[108:111], v[228:231]
s_add_u32 m0, s17, 0x10c00
v_mfma_f32_16x16x32_bf16 v[220:223], a[48:51], a[108:111], v[220:223]
buffer_load_dwordx4 v6, s[52:55], s13 offen lds
v_mfma_f32_16x16x32_bf16 v[220:223], a[32:35], a[104:107], v[220:223]
s_waitcnt lgkmcnt(4)
L_S18:
v_mfma_f32_16x16x32_bf16 v[24:27], a[80:83], a[0:3], v[24:27]
ds_read_b64_tr_b16 a[104:105], v13 offset:256
s_waitcnt vmcnt(24)
v_mfma_f32_16x16x32_bf16 v[24:27], a[84:87], a[16:19], v[24:27]
ds_read_b64_tr_b16 a[106:107], v13 offset:1280
L_padA9:
s_cmp_eq_u32 s95, 1
s_cbranch_scc1 L_hopA_ret
v_mfma_f32_16x16x32_bf16 v[32:35], a[84:87], a[20:23], v[32:35]
ds_read_b64_tr_b16 a[108:109], v13 offset:8448
v_mfma_f32_16x16x32_bf16 v[32:35], a[80:83], a[4:7], v[32:35]
ds_read_b64_tr_b16 a[110:111], v13 offset:9472
v_mfma_f32_16x16x32_bf16 v[40:43], a[80:83], a[8:11], v[40:43]
ds_read_b128 a[32:35], v8 offset:32768
s_add_u32 m0, s18, 0x14000
v_mfma_f32_16x16x32_bf16 v[40:43], a[84:87], a[24:27], v[40:43]
buffer_load_dwordx4 v7, s[68:71], 0 offen lds
v_mfma_f32_16x16x32_bf16 v[48:51], a[84:87], a[28:31], v[48:51]
ds_read_b128 a[48:51], v9 offset:32768
v_mfma_f32_16x16x32_bf16 v[48:51], a[80:83], a[12:15], v[48:51]
ds_read_b128 a[36:39], v8 offset:34816
v_mfma_f32_16x16x32_bf16 v[52:55], a[88:91], a[12:15], v[52:55]
ds_read_b64_tr_b16 a[80:81], v12 offset:512
v_mfma_f32_16x16x32_bf16 v[52:55], a[92:95], a[28:31], v[52:55]
ds_read_b64_tr_b16 a[82:83], v12 offset:1536
v_mfma_f32_16x16x32_bf16 v[44:47], a[92:95], a[24:27], v[44:47]
ds_read_b64_tr_b16 a[84:85], v12 offset:8704
v_mfma_f32_16x16x32_bf16 v[44:47], a[88:91], a[8:11], v[44:47]
buffer_load_dwordx4 a[128:131], v16, s[44:47], s100 offen offset:0
v_mfma_f32_16x16x32_bf16 v[36:39], a[88:91], a[4:7], v[36:39]
ds_read_b64_tr_b16 a[86:87], v12 offset:9728
v_mfma_f32_16x16x32_bf16 v[36:39], a[92:95], a[20:23], v[36:39]
ds_read_b128 a[52:55], v9 offset:34816
v_mfma_f32_16x16x32_bf16 v[28:31], a[92:95], a[16:19], v[28:31]
ds_read_b128 a[40:43], v8 offset:36864
v_mfma_f32_16x16x32_bf16 v[28:31], a[88:91], a[0:3], v[28:31]
ds_read_b128 a[56:59], v9 offset:36864
s_waitcnt lgkmcnt(10)
v_mfma_f32_16x16x32_bf16 v[56:59], a[96:99], a[0:3], v[56:59]
ds_read_b64_tr_b16 a[88:89], v13 offset:512
v_mfma_f32_16x16x32_bf16 v[56:59], a[100:103], a[16:19], v[56:59]
ds_read_b64_tr_b16 a[90:91], v13 offset:1536
s_add_u32 m0, s18, 0x15000
v_mfma_f32_16x16x32_bf16 v[64:67], a[100:103], a[20:23], v[64:67]
buffer_load_dwordx4 v7, s[68:71], s25 offen lds
v_mfma_f32_16x16x32_bf16 v[64:67], a[96:99], a[4:7], v[64:67]
ds_read_b64_tr_b16 a[92:93], v13 offset:8704
v_mfma_f32_16x16x32_bf16 v[72:75], a[96:99], a[8:11], v[72:75]
ds_read_b64_tr_b16 a[94:95], v13 offset:9728
v_mfma_f32_16x16x32_bf16 v[72:75], a[100:103], a[24:27], v[72:75]
ds_read_b128 a[44:47], v8 offset:38912
v_mfma_f32_16x16x32_bf16 v[80:83], a[100:103], a[28:31], v[80:83]
ds_read_b128 a[60:63], v9 offset:38912
v_mfma_f32_16x16x32_bf16 v[80:83], a[96:99], a[12:15], v[80:83]
v_mfma_f32_16x16x32_bf16 v[84:87], a[104:107], a[12:15], v[84:87]
ds_read_b64_tr_b16 a[96:97], v12 offset:768
s_add_u32 m0, s18, 0x16000
v_mfma_f32_16x16x32_bf16 v[84:87], a[108:111], a[28:31], v[84:87]
buffer_load_dwordx4 v7, s[68:71], s26 offen lds
v_mfma_f32_16x16x32_bf16 v[76:79], a[108:111], a[24:27], v[76:79]
ds_read_b64_tr_b16 a[98:99], v12 offset:1792
v_lshl_add_u32 v5, s42, 19, v5
v_mfma_f32_16x16x32_bf16 v[76:79], a[104:107], a[8:11], v[76:79]
ds_read_b64_tr_b16 a[100:101], v12 offset:8960
v_lshl_add_u32 v6, s42, 19, v6
v_mfma_f32_16x16x32_bf16 v[68:71], a[104:107], a[4:7], v[68:71]
ds_read_b64_tr_b16 a[102:103], v12 offset:9984
v_lshl_add_u32 v7, s42, 18, v7
v_mfma_f32_16x16x32_bf16 v[68:71], a[108:111], a[20:23], v[68:71]
v_lshl_add_u32 v7, s42, 17, v7
v_mfma_f32_16x16x32_bf16 v[60:63], a[108:111], a[16:19], v[60:63]
v_mfma_f32_16x16x32_bf16 v[60:63], a[104:107], a[0:3], v[60:63]
s_add_u32 m0, s16, 0x8000
s_waitcnt lgkmcnt(4)
s_waitcnt lgkmcnt(6)
v_mfma_f32_16x16x32_bf16 v[88:91], a[80:83], a[0:3], v[88:91]
buffer_load_dwordx4 v22, s[44:47], s20 offen lds
v_mfma_f32_16x16x32_bf16 v[88:91], a[84:87], a[16:19], v[88:91]
ds_read_b64_tr_b16 a[104:105], v13 offset:768
v_mfma_f32_16x16x32_bf16 v[96:99], a[84:87], a[20:23], v[96:99]
ds_read_b64_tr_b16 a[106:107], v13 offset:1792
v_mfma_f32_16x16x32_bf16 v[96:99], a[80:83], a[4:7], v[96:99]
ds_read_b64_tr_b16 a[108:109], v13 offset:8960
v_mfma_f32_16x16x32_bf16 v[104:107], a[80:83], a[8:11], v[104:107]
ds_read_b64_tr_b16 a[110:111], v13 offset:9984
s_add_u32 m0, s16, 0x8400
v_mfma_f32_16x16x32_bf16 v[104:107], a[84:87], a[24:27], v[104:107]
buffer_load_dwordx4 v23, s[44:47], s20 offen lds
v_mfma_f32_16x16x32_bf16 v[112:115], a[84:87], a[28:31], v[112:115]
v_mfma_f32_16x16x32_bf16 v[112:115], a[80:83], a[12:15], v[112:115]
v_mfma_f32_16x16x32_bf16 v[116:119], a[88:91], a[12:15], v[116:119]
ds_read_b64_tr_b16 a[80:81], v14 offset:0
v_mfma_f32_16x16x32_bf16 v[116:119], a[92:95], a[28:31], v[116:119]
ds_read_b64_tr_b16 a[82:83], v14 offset:256
v_mfma_f32_16x16x32_bf16 v[108:111], a[92:95], a[24:27], v[108:111]
ds_read_b64_tr_b16 a[84:85], v14 offset:2048
s_add_u32 m0, s16, 0x8800
v_mfma_f32_16x16x32_bf16 v[108:111], a[88:91], a[8:11], v[108:111]
buffer_load_dwordx4 v22, s[44:47], s21 offen lds
v_mfma_f32_16x16x32_bf16 v[100:103], a[88:91], a[4:7], v[100:103]
ds_read_b64_tr_b16 a[86:87], v14 offset:2304
v_mfma_f32_16x16x32_bf16 v[100:103], a[92:95], a[20:23], v[100:103]
v_mfma_f32_16x16x32_bf16 v[92:95], a[92:95], a[16:19], v[92:95]
v_mfma_f32_16x16x32_bf16 v[92:95], a[88:91], a[0:3], v[92:95]
s_waitcnt lgkmcnt(4)
v_mfma_f32_16x16x32_bf16 v[120:123], a[96:99], a[0:3], v[120:123]
buffer_load_dwordx4 a[132:135], v16, s[44:47], s100 offen offset:1024
v_mfma_f32_16x16x32_bf16 v[120:123], a[100:103], a[16:19], v[120:123]
ds_read_b64_tr_b16 a[88:89], v15 offset:0
v_mfma_f32_16x16x32_bf16 v[128:131], a[100:103], a[20:23], v[128:131]
ds_read_b64_tr_b16 a[90:91], v15 offset:256
v_mfma_f32_16x16x32_bf16 v[128:131], a[96:99], a[4:7], v[128:131]
ds_read_b64_tr_b16 a[92:93], v15 offset:2048
v_mfma_f32_16x16x32_bf16 v[136:139], a[96:99], a[8:11], v[136:139]
ds_read_b64_tr_b16 a[94:95], v15 offset:2304
v_mfma_f32_16x16x32_bf16 v[136:139], a[100:103], a[24:27], v[136:139]
s_add_u32 m0, s16, 0x8c00
v_mfma_f32_16x16x32_bf16 v[144:147], a[100:103], a[28:31], v[144:147]
buffer_load_dwordx4 v23, s[44:47], s21 offen lds
v_mfma_f32_16x16x32_bf16 v[144:147], a[96:99], a[12:15], v[144:147]
v_mfma_f32_16x16x32_bf16 v[148:151], a[104:107], a[12:15], v[148:151]
ds_read_b64_tr_b16 a[96:97], v14 offset:4096
v_mfma_f32_16x16x32_bf16 v[148:151], a[108:111], a[28:31], v[148:151]
ds_read_b64_tr_b16 a[98:99], v14 offset:4352
v_mfma_f32_16x16x32_bf16 v[140:143], a[108:111], a[24:27], v[140:143]
ds_read_b64_tr_b16 a[100:101], v14 offset:6144
v_mfma_f32_16x16x32_bf16 v[140:143], a[104:107], a[8:11], v[140:143]
ds_read_b64_tr_b16 a[102:103], v14 offset:6400
s_add_u32 m0, s16, 0x9000
v_mfma_f32_16x16x32_bf16 v[132:135], a[104:107], a[4:7], v[132:135]
buffer_load_dwordx4 v22, s[44:47], s22 offen lds
v_mfma_f32_16x16x32_bf16 v[132:135], a[108:111], a[20:23], v[132:135]
v_mfma_f32_16x16x32_bf16 v[124:127], a[108:111], a[16:19], v[124:127]
v_mfma_f32_16x16x32_bf16 v[124:127], a[104:107], a[0:3], v[124:127]
s_waitcnt lgkmcnt(4)
v_mfma_f32_16x16x32_bf16 v[152:155], a[80:83], a[0:3], v[152:155]
ds_read_b64_tr_b16 a[104:105], v15 offset:4096
s_add_u32 m0, s16, 0x9400
v_mfma_f32_16x16x32_bf16 v[152:155], a[84:87], a[16:19], v[152:155]
buffer_load_dwordx4 v23, s[44:47], s22 offen lds
v_mfma_f32_16x16x32_bf16 v[160:163], a[84:87], a[20:23], v[160:163]
ds_read_b64_tr_b16 a[106:107], v15 offset:4352
v_mfma_f32_16x16x32_bf16 v[160:163], a[80:83], a[4:7], v[160:163]
ds_read_b64_tr_b16 a[108:109], v15 offset:6144
v_mfma_f32_16x16x32_bf16 v[168:171], a[80:83], a[8:11], v[168:171]
ds_read_b64_tr_b16 a[110:111], v15 offset:6400
v_mfma_f32_16x16x32_bf16 v[168:171], a[84:87], a[24:27], v[168:171]
v_mfma_f32_16x16x32_bf16 v[176:179], a[84:87], a[28:31], v[176:179]
s_add_u32 m0, s16, 0x9800
v_mfma_f32_16x16x32_bf16 v[176:179], a[80:83], a[12:15], v[176:179]
buffer_load_dwordx4 v22, s[44:47], s23 offen lds
v_mfma_f32_16x16x32_bf16 v[180:183], a[88:91], a[12:15], v[180:183]
ds_read_b64_tr_b16 a[80:81], v14 offset:8192
v_mfma_f32_16x16x32_bf16 v[180:183], a[92:95], a[28:31], v[180:183]
ds_read_b64_tr_b16 a[82:83], v14 offset:8448
v_mfma_f32_16x16x32_bf16 v[172:175], a[92:95], a[24:27], v[172:175]
ds_read_b64_tr_b16 a[84:85], v14 offset:10240
v_mfma_f32_16x16x32_bf16 v[172:175], a[88:91], a[8:11], v[172:175]
ds_read_b64_tr_b16 a[86:87], v14 offset:10496
s_add_u32 m0, s16, 0x9c00
v_mfma_f32_16x16x32_bf16 v[164:167], a[88:91], a[4:7], v[164:167]
buffer_load_dwordx4 v23, s[44:47], s23 offen lds
v_mfma_f32_16x16x32_bf16 v[164:167], a[92:95], a[20:23], v[164:167]
v_lshl_add_u32 v22, s42, 7, v22
v_lshl_add_u32 v23, s42, 7, v23
v_mfma_f32_16x16x32_bf16 v[156:159], a[92:95], a[16:19], v[156:159]
v_mfma_f32_16x16x32_bf16 v[156:159], a[88:91], a[0:3], v[156:159]
s_waitcnt lgkmcnt(4)
v_mfma_f32_16x16x32_bf16 v[184:187], a[96:99], a[0:3], v[184:187]
ds_read_b64_tr_b16 a[88:89], v15 offset:8192
v_mfma_f32_16x16x32_bf16 v[184:187], a[100:103], a[16:19], v[184:187]
ds_read_b64_tr_b16 a[90:91], v15 offset:8448
v_mfma_f32_16x16x32_bf16 v[192:195], a[100:103], a[20:23], v[192:195]
buffer_load_dwordx4 a[136:139], v16, s[44:47], s100 offen offset:2048
v_mfma_f32_16x16x32_bf16 v[192:195], a[96:99], a[4:7], v[192:195]
ds_read_b64_tr_b16 a[92:93], v15 offset:10240
v_mfma_f32_16x16x32_bf16 v[200:203], a[96:99], a[8:11], v[200:203]
ds_read_b64_tr_b16 a[94:95], v15 offset:10496
v_add_u32 v12, 0x8000, v12
v_mfma_f32_16x16x32_bf16 v[200:203], a[100:103], a[24:27], v[200:203]
v_add_u32 v13, 0x8000, v13
v_add_u32 v14, 0x8000, v14
v_mfma_f32_16x16x32_bf16 v[208:211], a[100:103], a[28:31], v[208:211]
v_add_u32 v15, 0x8000, v15
v_mfma_f32_16x16x32_bf16 v[208:211], a[96:99], a[12:15], v[208:211]
v_mfma_f32_16x16x32_bf16 v[212:215], a[104:107], a[12:15], v[212:215]
s_waitcnt vmcnt(18) lgkmcnt(0)
v_mfma_f32_16x16x32_bf16 v[212:215], a[108:111], a[28:31], v[212:215]
s_barrier
s_add_u32 m0, s17, 0x0
s_cmp_lg_u32 s4, 0
s_cbranch_scc1 L_sig_kv
v_mov_b32 v20, 1
s_mov_b64 exec, 1
buffer_atomic_add v20, off, s[84:87], s10 sc1
s_mov_b64 exec, -1
L_sig_kv:
v_mfma_f32_16x16x32_bf16 v[204:207], a[108:111], a[24:27], v[204:207]
buffer_load_dwordx4 v5, s[52:55], 0 offen lds
v_mfma_f32_16x16x32_bf16 v[204:207], a[104:107], a[8:11], v[204:207]
ds_read_b64_tr_b16 a[96:97], v12 offset:0
v_mfma_f32_16x16x32_bf16 v[196:199], a[104:107], a[4:7], v[196:199]
ds_read_b64_tr_b16 a[98:99], v12 offset:1024
v_mfma_f32_16x16x32_bf16 v[196:199], a[108:111], a[20:23], v[196:199]
ds_read_b64_tr_b16 a[100:101], v12 offset:8192
v_mfma_f32_16x16x32_bf16 v[188:191], a[108:111], a[16:19], v[188:191]
ds_read_b64_tr_b16 a[102:103], v12 offset:9216
v_mfma_f32_16x16x32_bf16 v[188:191], a[104:107], a[0:3], v[188:191]
s_add_u32 m0, s17, 0x400
s_waitcnt lgkmcnt(4)
v_mfma_f32_16x16x32_bf16 v[216:219], a[0:3], a[80:83], v[216:219]
buffer_load_dwordx4 v5, s[52:55], s13 offen lds
v_mfma_f32_16x16x32_bf16 v[216:219], a[16:19], a[84:87], v[216:219]
ds_read_b64_tr_b16 a[104:105], v13 offset:0
v_mfma_f32_16x16x32_bf16 v[224:227], a[20:23], a[84:87], v[224:227]
ds_read_b64_tr_b16 a[106:107], v13 offset:1024
v_mfma_f32_16x16x32_bf16 v[224:227], a[4:7], a[80:83], v[224:227]
ds_read_b64_tr_b16 a[108:109], v13 offset:8192
v_mfma_f32_16x16x32_bf16 v[232:235], a[8:11], a[80:83], v[232:235]
ds_read_b64_tr_b16 a[110:111], v13 offset:9216
v_mfma_f32_16x16x32_bf16 v[232:235], a[24:27], a[84:87], v[232:235]
v_mfma_f32_16x16x32_bf16 v[240:243], a[28:31], a[84:87], v[240:243]
s_add_u32 m0, s17, 0x800
v_mfma_f32_16x16x32_bf16 v[240:243], a[12:15], a[80:83], v[240:243]
buffer_load_dwordx4 v6, s[52:55], 0 offen lds
v_mfma_f32_16x16x32_bf16 v[244:247], a[12:15], a[88:91], v[244:247]
ds_read_b64_tr_b16 a[80:81], v12 offset:256
v_mfma_f32_16x16x32_bf16 v[244:247], a[28:31], a[92:95], v[244:247]
ds_read_b64_tr_b16 a[82:83], v12 offset:1280
v_mfma_f32_16x16x32_bf16 v[236:239], a[24:27], a[92:95], v[236:239]
ds_read_b64_tr_b16 a[84:85], v12 offset:8448
v_mfma_f32_16x16x32_bf16 v[236:239], a[8:11], a[88:91], v[236:239]
ds_read_b64_tr_b16 a[86:87], v12 offset:9472
v_mfma_f32_16x16x32_bf16 v[228:231], a[4:7], a[88:91], v[228:231]
v_mfma_f32_16x16x32_bf16 v[228:231], a[20:23], a[92:95], v[228:231]
s_add_u32 m0, s17, 0xc00
v_mfma_f32_16x16x32_bf16 v[220:223], a[16:19], a[92:95], v[220:223]
buffer_load_dwordx4 v6, s[52:55], s13 offen lds
v_mfma_f32_16x16x32_bf16 v[220:223], a[0:3], a[88:91], v[220:223]
s_waitcnt lgkmcnt(4)
L_S19:
v_mfma_f32_16x16x32_bf16 v[24:27], a[96:99], a[32:35], v[24:27]
ds_read_b64_tr_b16 a[88:89], v13 offset:256
s_waitcnt vmcnt(23)
v_mfma_f32_16x16x32_bf16 v[24:27], a[100:103], a[48:51], v[24:27]
ds_read_b64_tr_b16 a[90:91], v13 offset:1280
v_mfma_f32_16x16x32_bf16 v[32:35], a[100:103], a[52:55], v[32:35]
ds_read_b64_tr_b16 a[92:93], v13 offset:8448
v_mfma_f32_16x16x32_bf16 v[32:35], a[96:99], a[36:39], v[32:35]
ds_read_b64_tr_b16 a[94:95], v13 offset:9472
v_mfma_f32_16x16x32_bf16 v[40:43], a[96:99], a[40:43], v[40:43]
ds_read_b128 a[0:3], v8 offset:0
s_add_u32 m0, s18, 0x4000
v_mfma_f32_16x16x32_bf16 v[40:43], a[100:103], a[56:59], v[40:43]
buffer_load_dwordx4 v7, s[68:71], 0 offen lds
v_mfma_f32_16x16x32_bf16 v[48:51], a[100:103], a[60:63], v[48:51]
ds_read_b128 a[16:19], v9 offset:0
v_mfma_f32_16x16x32_bf16 v[48:51], a[96:99], a[44:47], v[48:51]
ds_read_b128 a[4:7], v8 offset:2048
v_mfma_f32_16x16x32_bf16 v[52:55], a[104:107], a[44:47], v[52:55]
ds_read_b64_tr_b16 a[96:97], v12 offset:512
v_mfma_f32_16x16x32_bf16 v[52:55], a[108:111], a[60:63], v[52:55]
ds_read_b64_tr_b16 a[98:99], v12 offset:1536
v_mfma_f32_16x16x32_bf16 v[44:47], a[108:111], a[56:59], v[44:47]
ds_read_b64_tr_b16 a[100:101], v12 offset:8704
v_mfma_f32_16x16x32_bf16 v[44:47], a[104:107], a[40:43], v[44:47]
buffer_load_dwordx4 a[140:143], v16, s[44:47], s100 offen offset:3072
v_mfma_f32_16x16x32_bf16 v[36:39], a[104:107], a[36:39], v[36:39]
ds_read_b64_tr_b16 a[102:103], v12 offset:9728
v_mfma_f32_16x16x32_bf16 v[36:39], a[108:111], a[52:55], v[36:39]
ds_read_b128 a[20:23], v9 offset:2048
v_mfma_f32_16x16x32_bf16 v[28:31], a[108:111], a[48:51], v[28:31]
ds_read_b128 a[8:11], v8 offset:4096
v_mfma_f32_16x16x32_bf16 v[28:31], a[104:107], a[32:35], v[28:31]
ds_read_b128 a[24:27], v9 offset:4096
s_waitcnt lgkmcnt(10)
v_mfma_f32_16x16x32_bf16 v[56:59], a[80:83], a[32:35], v[56:59]
ds_read_b64_tr_b16 a[104:105], v13 offset:512
v_mfma_f32_16x16x32_bf16 v[56:59], a[84:87], a[48:51], v[56:59]
ds_read_b64_tr_b16 a[106:107], v13 offset:1536
s_add_u32 m0, s18, 0x5000
v_mfma_f32_16x16x32_bf16 v[64:67], a[84:87], a[52:55], v[64:67]
buffer_load_dwordx4 v7, s[68:71], s25 offen lds
v_mfma_f32_16x16x32_bf16 v[64:67], a[80:83], a[36:39], v[64:67]
ds_read_b64_tr_b16 a[108:109], v13 offset:8704
v_mfma_f32_16x16x32_bf16 v[72:75], a[80:83], a[40:43], v[72:75]
ds_read_b64_tr_b16 a[110:111], v13 offset:9728
v_mfma_f32_16x16x32_bf16 v[72:75], a[84:87], a[56:59], v[72:75]
ds_read_b128 a[12:15], v8 offset:6144
v_mfma_f32_16x16x32_bf16 v[80:83], a[84:87], a[60:63], v[80:83]
ds_read_b128 a[28:31], v9 offset:6144
v_mfma_f32_16x16x32_bf16 v[80:83], a[80:83], a[44:47], v[80:83]
v_mfma_f32_16x16x32_bf16 v[84:87], a[88:91], a[44:47], v[84:87]
ds_read_b64_tr_b16 a[80:81], v12 offset:768
s_add_u32 m0, s18, 0x6000
v_mfma_f32_16x16x32_bf16 v[84:87], a[92:95], a[60:63], v[84:87]
buffer_load_dwordx4 v7, s[68:71], s26 offen lds
v_mfma_f32_16x16x32_bf16 v[76:79], a[92:95], a[56:59], v[76:79]
ds_read_b64_tr_b16 a[82:83], v12 offset:1792
v_lshl_add_u32 v5, s42, 19, v5
v_mfma_f32_16x16x32_bf16 v[76:79], a[88:91], a[40:43], v[76:79]
ds_read_b64_tr_b16 a[84:85], v12 offset:8960
v_lshl_add_u32 v6, s42, 19, v6
v_mfma_f32_16x16x32_bf16 v[68:71], a[88:91], a[36:39], v[68:71]
ds_read_b64_tr_b16 a[86:87], v12 offset:9984
v_lshl_add_u32 v7, s42, 18, v7
v_mfma_f32_16x16x32_bf16 v[68:71], a[92:95], a[52:55], v[68:71]
v_lshl_add_u32 v7, s42, 17, v7
v_mfma_f32_16x16x32_bf16 v[60:63], a[92:95], a[48:51], v[60:63]
v_mfma_f32_16x16x32_bf16 v[60:63], a[88:91], a[32:35], v[60:63]
s_add_u32 m0, s16, 0x0
s_waitcnt lgkmcnt(4)
s_waitcnt lgkmcnt(6)
v_mfma_f32_16x16x32_bf16 v[88:91], a[96:99], a[32:35], v[88:91]
buffer_load_dwordx4 v22, s[44:47], s20 offen lds
v_mfma_f32_16x16x32_bf16 v[88:91], a[100:103], a[48:51], v[88:91]
ds_read_b64_tr_b16 a[88:89], v13 offset:768
v_mfma_f32_16x16x32_bf16 v[96:99], a[100:103], a[52:55], v[96:99]
ds_read_b64_tr_b16 a[90:91], v13 offset:1792
v_mfma_f32_16x16x32_bf16 v[96:99], a[96:99], a[36:39], v[96:99]
ds_read_b64_tr_b16 a[92:93], v13 offset:8960
v_mfma_f32_16x16x32_bf16 v[104:107], a[96:99], a[40:43], v[104:107]
ds_read_b64_tr_b16 a[94:95], v13 offset:9984
s_add_u32 m0, s16, 0x400
v_mfma_f32_16x16x32_bf16 v[104:107], a[100:103], a[56:59], v[104:107]
buffer_load_dwordx4 v23, s[44:47], s20 offen lds
v_mfma_f32_16x16x32_bf16 v[112:115], a[100:103], a[60:63], v[112:115]
v_mfma_f32_16x16x32_bf16 v[112:115], a[96:99], a[44:47], v[112:115]
v_mfma_f32_16x16x32_bf16 v[116:119], a[104:107], a[44:47], v[116:119]
ds_read_b64_tr_b16 a[96:97], v14 offset:0
v_mfma_f32_16x16x32_bf16 v[116:119], a[108:111], a[60:63], v[116:119]
ds_read_b64_tr_b16 a[98:99], v14 offset:256
v_mfma_f32_16x16x32_bf16 v[108:111], a[108:111], a[56:59], v[108:111]
ds_read_b64_tr_b16 a[100:101], v14 offset:2048
s_add_u32 m0, s16, 0x800
v_mfma_f32_16x16x32_bf16 v[108:111], a[104:107], a[40:43], v[108:111]
buffer_load_dwordx4 v22, s[44:47], s21 offen lds
v_mfma_f32_16x16x32_bf16 v[100:103], a[104:107], a[36:39], v[100:103]
ds_read_b64_tr_b16 a[102:103], v14 offset:2304
v_mfma_f32_16x16x32_bf16 v[100:103], a[108:111], a[52:55], v[100:103]
v_mfma_f32_16x16x32_bf16 v[92:95], a[108:111], a[48:51], v[92:95]
v_mfma_f32_16x16x32_bf16 v[92:95], a[104:107], a[32:35], v[92:95]
s_waitcnt lgkmcnt(4)
v_mfma_f32_16x16x32_bf16 v[120:123], a[80:83], a[32:35], v[120:123]
buffer_load_dwordx4 a[144:147], v16, s[76:79], 0 offen offset:0
v_mfma_f32_16x16x32_bf16 v[120:123], a[84:87], a[48:51], v[120:123]
ds_read_b64_tr_b16 a[104:105], v15 offset:0
v_mfma_f32_16x16x32_bf16 v[128:131], a[84:87], a[52:55], v[128:131]
ds_read_b64_tr_b16 a[106:107], v15 offset:256
v_mfma_f32_16x16x32_bf16 v[128:131], a[80:83], a[36:39], v[128:131]
ds_read_b64_tr_b16 a[108:109], v15 offset:2048
v_mfma_f32_16x16x32_bf16 v[136:139], a[80:83], a[40:43], v[136:139]
ds_read_b64_tr_b16 a[110:111], v15 offset:2304
v_mfma_f32_16x16x32_bf16 v[136:139], a[84:87], a[56:59], v[136:139]
s_add_u32 m0, s16, 0xc00
v_mfma_f32_16x16x32_bf16 v[144:147], a[84:87], a[60:63], v[144:147]
buffer_load_dwordx4 v23, s[44:47], s21 offen lds
v_mfma_f32_16x16x32_bf16 v[144:147], a[80:83], a[44:47], v[144:147]
v_mfma_f32_16x16x32_bf16 v[148:151], a[88:91], a[44:47], v[148:151]
ds_read_b64_tr_b16 a[80:81], v14 offset:4096
v_mfma_f32_16x16x32_bf16 v[148:151], a[92:95], a[60:63], v[148:151]
ds_read_b64_tr_b16 a[82:83], v14 offset:4352
v_mfma_f32_16x16x32_bf16 v[140:143], a[92:95], a[56:59], v[140:143]
ds_read_b64_tr_b16 a[84:85], v14 offset:6144
v_mfma_f32_16x16x32_bf16 v[140:143], a[88:91], a[40:43], v[140:143]
ds_read_b64_tr_b16 a[86:87], v14 offset:6400
s_add_u32 m0, s16, 0x1000
v_mfma_f32_16x16x32_bf16 v[132:135], a[88:91], a[36:39], v[132:135]
buffer_load_dwordx4 v22, s[44:47], s22 offen lds
v_mfma_f32_16x16x32_bf16 v[132:135], a[92:95], a[52:55], v[132:135]
v_mfma_f32_16x16x32_bf16 v[124:127], a[92:95], a[48:51], v[124:127]
v_mfma_f32_16x16x32_bf16 v[124:127], a[88:91], a[32:35], v[124:127]
s_waitcnt lgkmcnt(4)
v_mfma_f32_16x16x32_bf16 v[152:155], a[96:99], a[32:35], v[152:155]
ds_read_b64_tr_b16 a[88:89], v15 offset:4096
s_add_u32 m0, s16, 0x1400
v_mfma_f32_16x16x32_bf16 v[152:155], a[100:103], a[48:51], v[152:155]
buffer_load_dwordx4 v23, s[44:47], s22 offen lds
v_mfma_f32_16x16x32_bf16 v[160:163], a[100:103], a[52:55], v[160:163]
ds_read_b64_tr_b16 a[90:91], v15 offset:4352
v_mfma_f32_16x16x32_bf16 v[160:163], a[96:99], a[36:39], v[160:163]
ds_read_b64_tr_b16 a[92:93], v15 offset:6144
v_mfma_f32_16x16x32_bf16 v[168:171], a[96:99], a[40:43], v[168:171]
ds_read_b64_tr_b16 a[94:95], v15 offset:6400
v_mfma_f32_16x16x32_bf16 v[168:171], a[100:103], a[56:59], v[168:171]
v_mfma_f32_16x16x32_bf16 v[176:179], a[100:103], a[60:63], v[176:179]
s_add_u32 m0, s16, 0x1800
v_mfma_f32_16x16x32_bf16 v[176:179], a[96:99], a[44:47], v[176:179]
buffer_load_dwordx4 v22, s[44:47], s23 offen lds
v_mfma_f32_16x16x32_bf16 v[180:183], a[104:107], a[44:47], v[180:183]
ds_read_b64_tr_b16 a[96:97], v14 offset:8192
v_mfma_f32_16x16x32_bf16 v[180:183], a[108:111], a[60:63], v[180:183]
ds_read_b64_tr_b16 a[98:99], v14 offset:8448
v_mfma_f32_16x16x32_bf16 v[172:175], a[108:111], a[56:59], v[172:175]
ds_read_b64_tr_b16 a[100:101], v14 offset:10240
v_mfma_f32_16x16x32_bf16 v[172:175], a[104:107], a[40:43], v[172:175]
ds_read_b64_tr_b16 a[102:103], v14 offset:10496
s_add_u32 m0, s16, 0x1c00
v_mfma_f32_16x16x32_bf16 v[164:167], a[104:107], a[36:39], v[164:167]
buffer_load_dwordx4 v23, s[44:47], s23 offen lds
v_mfma_f32_16x16x32_bf16 v[164:167], a[108:111], a[52:55], v[164:167]
v_lshl_add_u32 v22, s42, 7, v22
v_lshl_add_u32 v23, s42, 7, v23
v_mfma_f32_16x16x32_bf16 v[156:159], a[108:111], a[48:51], v[156:159]
v_mfma_f32_16x16x32_bf16 v[156:159], a[104:107], a[32:35], v[156:159]
s_waitcnt lgkmcnt(4)
v_mfma_f32_16x16x32_bf16 v[184:187], a[80:83], a[32:35], v[184:187]
ds_read_b64_tr_b16 a[104:105], v15 offset:8192
v_mfma_f32_16x16x32_bf16 v[184:187], a[84:87], a[48:51], v[184:187]
ds_read_b64_tr_b16 a[106:107], v15 offset:8448
v_mfma_f32_16x16x32_bf16 v[192:195], a[84:87], a[52:55], v[192:195]
buffer_load_dwordx4 a[148:151], v16, s[76:79], 0 offen offset:1024
v_mfma_f32_16x16x32_bf16 v[192:195], a[80:83], a[36:39], v[192:195]
ds_read_b64_tr_b16 a[108:109], v15 offset:10240
v_mfma_f32_16x16x32_bf16 v[200:203], a[80:83], a[40:43], v[200:203]
ds_read_b64_tr_b16 a[110:111], v15 offset:10496
v_add_u32 v12, 0x8000, v12
v_mfma_f32_16x16x32_bf16 v[200:203], a[84:87], a[56:59], v[200:203]
v_add_u32 v13, 0x8000, v13
v_add_u32 v14, 0x8000, v14
v_mfma_f32_16x16x32_bf16 v[208:211], a[84:87], a[60:63], v[208:211]
v_add_u32 v15, 0x8000, v15
v_mfma_f32_16x16x32_bf16 v[208:211], a[80:83], a[44:47], v[208:211]
v_mfma_f32_16x16x32_bf16 v[212:215], a[88:91], a[44:47], v[212:215]
s_waitcnt vmcnt(28) lgkmcnt(0)
v_mfma_f32_16x16x32_bf16 v[212:215], a[92:95], a[60:63], v[212:215]
s_barrier
s_add_u32 m0, s17, 0x8000
v_mfma_f32_16x16x32_bf16 v[204:207], a[92:95], a[56:59], v[204:207]
buffer_load_dwordx4 v5, s[52:55], 0 offen lds
v_mfma_f32_16x16x32_bf16 v[204:207], a[88:91], a[40:43], v[204:207]
ds_read_b64_tr_b16 a[80:81], v12 offset:0
v_mfma_f32_16x16x32_bf16 v[196:199], a[88:91], a[36:39], v[196:199]
ds_read_b64_tr_b16 a[82:83], v12 offset:1024
v_mfma_f32_16x16x32_bf16 v[196:199], a[92:95], a[52:55], v[196:199]
ds_read_b64_tr_b16 a[84:85], v12 offset:8192
v_mfma_f32_16x16x32_bf16 v[188:191], a[92:95], a[48:51], v[188:191]
ds_read_b64_tr_b16 a[86:87], v12 offset:9216
v_mfma_f32_16x16x32_bf16 v[188:191], a[88:91], a[32:35], v[188:191]
s_waitcnt lgkmcnt(4)
v_mfma_f32_16x16x32_bf16 v[216:219], a[32:35], a[96:99], v[216:219]
ds_read_b64_tr_b16 a[88:89], v13 offset:0
s_add_u32 m0, s17, 0x8400
v_mfma_f32_16x16x32_bf16 v[216:219], a[48:51], a[100:103], v[216:219]
buffer_load_dwordx4 v5, s[52:55], s13 offen lds
v_mfma_f32_16x16x32_bf16 v[224:227], a[52:55], a[100:103], v[224:227]
ds_read_b64_tr_b16 a[90:91], v13 offset:1024
v_mfma_f32_16x16x32_bf16 v[224:227], a[36:39], a[96:99], v[224:227]
ds_read_b64_tr_b16 a[92:93], v13 offset:8192
v_mfma_f32_16x16x32_bf16 v[232:235], a[40:43], a[96:99], v[232:235]
ds_read_b64_tr_b16 a[94:95], v13 offset:9216
v_mfma_f32_16x16x32_bf16 v[232:235], a[56:59], a[100:103], v[232:235]
v_mfma_f32_16x16x32_bf16 v[240:243], a[60:63], a[100:103], v[240:243]
v_mfma_f32_16x16x32_bf16 v[240:243], a[44:47], a[96:99], v[240:243]
v_mfma_f32_16x16x32_bf16 v[244:247], a[44:47], a[104:107], v[244:247]
ds_read_b64_tr_b16 a[96:97], v12 offset:256
s_add_u32 m0, s17, 0x8800
v_mfma_f32_16x16x32_bf16 v[244:247], a[60:63], a[108:111], v[244:247]
buffer_load_dwordx4 v6, s[52:55], 0 offen lds
v_mfma_f32_16x16x32_bf16 v[236:239], a[56:59], a[108:111], v[236:239]
ds_read_b64_tr_b16 a[98:99], v12 offset:1280
v_mfma_f32_16x16x32_bf16 v[236:239], a[40:43], a[104:107], v[236:239]
ds_read_b64_tr_b16 a[100:101], v12 offset:8448
v_mfma_f32_16x16x32_bf16 v[228:231], a[36:39], a[104:107], v[228:231]
ds_read_b64_tr_b16 a[102:103], v12 offset:9472
v_mfma_f32_16x16x32_bf16 v[228:231], a[52:55], a[108:111], v[228:231]
v_mfma_f32_16x16x32_bf16 v[220:223], a[48:51], a[108:111], v[220:223]
v_mfma_f32_16x16x32_bf16 v[220:223], a[32:35], a[104:107], v[220:223]
s_add_u32 m0, s17, 0x8c00
s_waitcnt lgkmcnt(4)
L_S20:
v_mfma_f32_16x16x32_bf16 v[24:27], a[80:83], a[0:3], v[24:27]
ds_read_b64_tr_b16 a[104:105], v13 offset:256
s_waitcnt vmcnt(22)
v_mfma_f32_16x16x32_bf16 v[24:27], a[84:87], a[16:19], v[24:27]
buffer_load_dwordx4 v6, s[52:55], s13 offen lds
v_mfma_f32_16x16x32_bf16 v[32:35], a[84:87], a[20:23], v[32:35]
ds_read_b64_tr_b16 a[106:107], v13 offset:1280
v_mfma_f32_16x16x32_bf16 v[32:35], a[80:83], a[4:7], v[32:35]
ds_read_b64_tr_b16 a[108:109], v13 offset:8448
v_mfma_f32_16x16x32_bf16 v[40:43], a[80:83], a[8:11], v[40:43]
ds_read_b64_tr_b16 a[110:111], v13 offset:9472
v_mfma_f32_16x16x32_bf16 v[40:43], a[84:87], a[24:27], v[40:43]
ds_read_b128 a[32:35], v8 offset:32768
v_mfma_f32_16x16x32_bf16 v[48:51], a[84:87], a[28:31], v[48:51]
ds_read_b128 a[48:51], v9 offset:32768
v_mfma_f32_16x16x32_bf16 v[48:51], a[80:83], a[12:15], v[48:51]
ds_read_b128 a[36:39], v8 offset:34816
s_add_u32 m0, s18, 0xc000
v_mfma_f32_16x16x32_bf16 v[52:55], a[88:91], a[12:15], v[52:55]
buffer_load_dwordx4 v7, s[68:71], 0 offen lds
v_mfma_f32_16x16x32_bf16 v[52:55], a[92:95], a[28:31], v[52:55]
ds_read_b64_tr_b16 a[80:81], v12 offset:512
v_mfma_f32_16x16x32_bf16 v[44:47], a[92:95], a[24:27], v[44:47]
ds_read_b64_tr_b16 a[82:83], v12 offset:1536
v_mfma_f32_16x16x32_bf16 v[44:47], a[88:91], a[8:11], v[44:47]
ds_read_b64_tr_b16 a[84:85], v12 offset:8704
v_mfma_f32_16x16x32_bf16 v[36:39], a[88:91], a[4:7], v[36:39]
ds_read_b64_tr_b16 a[86:87], v12 offset:9728
v_mfma_f32_16x16x32_bf16 v[36:39], a[92:95], a[20:23], v[36:39]
ds_read_b128 a[52:55], v9 offset:34816
v_mfma_f32_16x16x32_bf16 v[28:31], a[92:95], a[16:19], v[28:31]
ds_read_b128 a[40:43], v8 offset:36864
s_waitcnt lgkmcnt(9)
v_mfma_f32_16x16x32_bf16 v[28:31], a[88:91], a[0:3], v[28:31]
ds_read_b128 a[56:59], v9 offset:36864
s_add_u32 m0, s18, 0xd000
v_mfma_f32_16x16x32_bf16 v[56:59], a[96:99], a[0:3], v[56:59]
buffer_load_dwordx4 v7, s[68:71], s25 offen lds
v_mfma_f32_16x16x32_bf16 v[56:59], a[100:103], a[16:19], v[56:59]
ds_read_b64_tr_b16 a[88:89], v13 offset:512
v_mfma_f32_16x16x32_bf16 v[64:67], a[100:103], a[20:23], v[64:67]
ds_read_b64_tr_b16 a[90:91], v13 offset:1536
v_mfma_f32_16x16x32_bf16 v[64:67], a[96:99], a[4:7], v[64:67]
ds_read_b64_tr_b16 a[92:93], v13 offset:8704
v_mfma_f32_16x16x32_bf16 v[72:75], a[96:99], a[8:11], v[72:75]
ds_read_b64_tr_b16 a[94:95], v13 offset:9728
v_mfma_f32_16x16x32_bf16 v[72:75], a[100:103], a[24:27], v[72:75]
ds_read_b128 a[44:47], v8 offset:38912
v_mfma_f32_16x16x32_bf16 v[80:83], a[100:103], a[28:31], v[80:83]
ds_read_b128 a[60:63], v9 offset:38912
v_mfma_f32_16x16x32_bf16 v[80:83], a[96:99], a[12:15], v[80:83]
s_add_u32 m0, s18, 0xe000
v_mfma_f32_16x16x32_bf16 v[84:87], a[104:107], a[12:15], v[84:87]
buffer_load_dwordx4 v7, s[68:71], s26 offen lds
v_mfma_f32_16x16x32_bf16 v[84:87], a[108:111], a[28:31], v[84:87]
ds_read_b64_tr_b16 a[96:97], v12 offset:768
v_lshl_add_u32 v5, s42, 19, v5
v_mfma_f32_16x16x32_bf16 v[76:79], a[108:111], a[24:27], v[76:79]
ds_read_b64_tr_b16 a[98:99], v12 offset:1792
v_lshl_add_u32 v6, s42, 19, v6
v_mfma_f32_16x16x32_bf16 v[76:79], a[104:107], a[8:11], v[76:79]
ds_read_b64_tr_b16 a[100:101], v12 offset:8960
L_padA10:
s_cmp_eq_u32 s95, 1
s_cbranch_scc1 L_hopA_ret
v_lshl_add_u32 v7, s42, 18, v7
v_mfma_f32_16x16x32_bf16 v[68:71], a[104:107], a[4:7], v[68:71]
ds_read_b64_tr_b16 a[102:103], v12 offset:9984
v_lshl_add_u32 v7, s42, 17, v7
v_mfma_f32_16x16x32_bf16 v[68:71], a[108:111], a[20:23], v[68:71]
s_waitcnt vmcnt(13)
v_accvgpr_read_b32 v18, a144
v_lshlrev_b32 v1, 16, v18
v_mfma_f32_16x16x32_bf16 v[60:63], a[108:111], a[16:19], v[60:63]
v_and_b32 v18, 0xffff0000, v18
v_accvgpr_read_b32 v21, a128
v_mfma_f32_16x16x32_bf16 v[60:63], a[104:107], a[0:3], v[60:63]
s_add_u32 m0, s16, 0x8000
s_waitcnt lgkmcnt(4)
s_waitcnt lgkmcnt(6)
v_mfma_f32_16x16x32_bf16 v[88:91], a[80:83], a[0:3], v[88:91]
buffer_load_dwordx4 v22, s[44:47], s20 offen lds
v_mfma_f32_16x16x32_bf16 v[88:91], a[84:87], a[16:19], v[88:91]
ds_read_b64_tr_b16 a[104:105], v13 offset:768
v_lshlrev_b32 v20, 16, v21
v_mfma_f32_16x16x32_bf16 v[96:99], a[84:87], a[20:23], v[96:99]
ds_read_b64_tr_b16 a[106:107], v13 offset:1792
v_and_b32 v21, 0xffff0000, v21
v_mfma_f32_16x16x32_bf16 v[96:99], a[80:83], a[4:7], v[96:99]
ds_read_b64_tr_b16 a[108:109], v13 offset:8960
v_mul_f32 v2, v1, v20
v_mfma_f32_16x16x32_bf16 v[104:107], a[80:83], a[8:11], v[104:107]
ds_read_b64_tr_b16 a[110:111], v13 offset:9984
v_fmac_f32 v2, v18, v21
v_mfma_f32_16x16x32_bf16 v[104:107], a[84:87], a[24:27], v[104:107]
v_accvgpr_read_b32 v21, a136
v_lshlrev_b32 v20, 16, v21
v_mfma_f32_16x16x32_bf16 v[112:115], a[84:87], a[28:31], v[112:115]
s_add_u32 m0, s16, 0x8400
v_and_b32 v21, 0xffff0000, v21
v_mul_f32 v3, v1, v20
v_mfma_f32_16x16x32_bf16 v[112:115], a[80:83], a[12:15], v[112:115]
buffer_load_dwordx4 v23, s[44:47], s20 offen lds
v_mfma_f32_16x16x32_bf16 v[116:119], a[88:91], a[12:15], v[116:119]
ds_read_b64_tr_b16 a[80:81], v14 offset:0
v_fmac_f32 v3, v18, v21
v_mfma_f32_16x16x32_bf16 v[116:119], a[92:95], a[28:31], v[116:119]
ds_read_b64_tr_b16 a[82:83], v14 offset:256
v_accvgpr_read_b32 v18, a145
v_mfma_f32_16x16x32_bf16 v[108:111], a[92:95], a[24:27], v[108:111]
ds_read_b64_tr_b16 a[84:85], v14 offset:2048
v_lshlrev_b32 v1, 16, v18
v_mfma_f32_16x16x32_bf16 v[108:111], a[88:91], a[8:11], v[108:111]
ds_read_b64_tr_b16 a[86:87], v14 offset:2304
v_and_b32 v18, 0xffff0000, v18
v_mfma_f32_16x16x32_bf16 v[100:103], a[88:91], a[4:7], v[100:103]
v_accvgpr_read_b32 v21, a129
v_lshlrev_b32 v20, 16, v21
v_mfma_f32_16x16x32_bf16 v[100:103], a[92:95], a[20:23], v[100:103]
s_add_u32 m0, s16, 0x8800
v_and_b32 v21, 0xffff0000, v21
v_fmac_f32 v2, v1, v20
v_mfma_f32_16x16x32_bf16 v[92:95], a[92:95], a[16:19], v[92:95]
buffer_load_dwordx4 v22, s[44:47], s21 offen lds
v_mfma_f32_16x16x32_bf16 v[92:95], a[88:91], a[0:3], v[92:95]
s_waitcnt lgkmcnt(4)
v_fmac_f32 v2, v18, v21
v_accvgpr_read_b32 v21, a137
v_mfma_f32_16x16x32_bf16 v[120:123], a[96:99], a[0:3], v[120:123]
ds_read_b64_tr_b16 a[88:89], v15 offset:0
v_lshlrev_b32 v20, 16, v21
v_mfma_f32_16x16x32_bf16 v[120:123], a[100:103], a[16:19], v[120:123]
ds_read_b64_tr_b16 a[90:91], v15 offset:256
v_and_b32 v21, 0xffff0000, v21
v_mfma_f32_16x16x32_bf16 v[128:131], a[100:103], a[20:23], v[128:131]
ds_read_b64_tr_b16 a[92:93], v15 offset:2048
v_fmac_f32 v3, v1, v20
v_mfma_f32_16x16x32_bf16 v[128:131], a[96:99], a[4:7], v[128:131]
ds_read_b64_tr_b16 a[94:95], v15 offset:2304
v_fmac_f32 v3, v18, v21
v_mfma_f32_16x16x32_bf16 v[136:139], a[96:99], a[8:11], v[136:139]
s_add_u32 m0, s16, 0x8c00
v_accvgpr_read_b32 v18, a146
v_lshlrev_b32 v1, 16, v18
v_mfma_f32_16x16x32_bf16 v[136:139], a[100:103], a[24:27], v[136:139]
buffer_load_dwordx4 v23, s[44:47], s21 offen lds
v_mfma_f32_16x16x32_bf16 v[144:147], a[100:103], a[28:31], v[144:147]
v_and_b32 v18, 0xffff0000, v18
v_accvgpr_read_b32 v21, a130
v_mfma_f32_16x16x32_bf16 v[144:147], a[96:99], a[12:15], v[144:147]
v_lshlrev_b32 v20, 16, v21
v_and_b32 v21, 0xffff0000, v21
v_mfma_f32_16x16x32_bf16 v[148:151], a[104:107], a[12:15], v[148:151]
ds_read_b64_tr_b16 a[96:97], v14 offset:4096
v_fmac_f32 v2, v1, v20
v_mfma_f32_16x16x32_bf16 v[148:151], a[108:111], a[28:31], v[148:151]
ds_read_b64_tr_b16 a[98:99], v14 offset:4352
v_fmac_f32 v2, v18, v21
v_mfma_f32_16x16x32_bf16 v[140:143], a[108:111], a[24:27], v[140:143]
ds_read_b64_tr_b16 a[100:101], v14 offset:6144
v_accvgpr_read_b32 v21, a138
v_mfma_f32_16x16x32_bf16 v[140:143], a[104:107], a[8:11], v[140:143]
ds_read_b64_tr_b16 a[102:103], v14 offset:6400
s_add_u32 m0, s16, 0x9000
v_mfma_f32_16x16x32_bf16 v[132:135], a[104:107], a[4:7], v[132:135]
buffer_load_dwordx4 v22, s[44:47], s22 offen lds
v_mfma_f32_16x16x32_bf16 v[132:135], a[108:111], a[20:23], v[132:135]
v_lshlrev_b32 v20, 16, v21
v_and_b32 v21, 0xffff0000, v21
v_mfma_f32_16x16x32_bf16 v[124:127], a[108:111], a[16:19], v[124:127]
v_fmac_f32 v3, v1, v20
v_fmac_f32 v3, v18, v21
v_mfma_f32_16x16x32_bf16 v[124:127], a[104:107], a[0:3], v[124:127]
s_waitcnt lgkmcnt(4)
v_accvgpr_read_b32 v18, a147
v_lshlrev_b32 v1, 16, v18
v_mfma_f32_16x16x32_bf16 v[152:155], a[80:83], a[0:3], v[152:155]
ds_read_b64_tr_b16 a[104:105], v15 offset:4096
v_and_b32 v18, 0xffff0000, v18
v_mfma_f32_16x16x32_bf16 v[152:155], a[84:87], a[16:19], v[152:155]
ds_read_b64_tr_b16 a[106:107], v15 offset:4352
v_accvgpr_read_b32 v21, a131
v_mfma_f32_16x16x32_bf16 v[160:163], a[84:87], a[20:23], v[160:163]
ds_read_b64_tr_b16 a[108:109], v15 offset:6144
s_add_u32 m0, s16, 0x9400
v_mfma_f32_16x16x32_bf16 v[160:163], a[80:83], a[4:7], v[160:163]
buffer_load_dwordx4 v23, s[44:47], s22 offen lds
v_mfma_f32_16x16x32_bf16 v[168:171], a[80:83], a[8:11], v[168:171]
ds_read_b64_tr_b16 a[110:111], v15 offset:6400
v_lshlrev_b32 v20, 16, v21
v_mfma_f32_16x16x32_bf16 v[168:171], a[84:87], a[24:27], v[168:171]
v_and_b32 v21, 0xffff0000, v21
v_fmac_f32 v2, v1, v20
v_mfma_f32_16x16x32_bf16 v[176:179], a[84:87], a[28:31], v[176:179]
v_fmac_f32 v2, v18, v21
v_accvgpr_read_b32 v21, a139
v_mfma_f32_16x16x32_bf16 v[176:179], a[80:83], a[12:15], v[176:179]
v_lshlrev_b32 v20, 16, v21
v_and_b32 v21, 0xffff0000, v21
v_mfma_f32_16x16x32_bf16 v[180:183], a[88:91], a[12:15], v[180:183]
ds_read_b64_tr_b16 a[80:81], v14 offset:8192
v_fmac_f32 v3, v1, v20
v_mfma_f32_16x16x32_bf16 v[180:183], a[92:95], a[28:31], v[180:183]
ds_read_b64_tr_b16 a[82:83], v14 offset:8448
s_add_u32 m0, s16, 0x9800
v_mfma_f32_16x16x32_bf16 v[172:175], a[92:95], a[24:27], v[172:175]
buffer_load_dwordx4 v22, s[44:47], s23 offen lds
v_mfma_f32_16x16x32_bf16 v[172:175], a[88:91], a[8:11], v[172:175]
ds_read_b64_tr_b16 a[84:85], v14 offset:10240
v_fmac_f32 v3, v18, v21
v_mfma_f32_16x16x32_bf16 v[164:167], a[88:91], a[4:7], v[164:167]
ds_read_b64_tr_b16 a[86:87], v14 offset:10496
s_waitcnt vmcnt(14)
v_accvgpr_read_b32 v18, a148
v_mfma_f32_16x16x32_bf16 v[164:167], a[92:95], a[20:23], v[164:167]
v_lshlrev_b32 v1, 16, v18
v_and_b32 v18, 0xffff0000, v18
v_mfma_f32_16x16x32_bf16 v[156:159], a[92:95], a[16:19], v[156:159]
v_accvgpr_read_b32 v21, a132
v_lshlrev_b32 v20, 16, v21
v_mfma_f32_16x16x32_bf16 v[156:159], a[88:91], a[0:3], v[156:159]
s_waitcnt lgkmcnt(4)
v_and_b32 v21, 0xffff0000, v21
v_fmac_f32 v2, v1, v20
v_mfma_f32_16x16x32_bf16 v[184:187], a[96:99], a[0:3], v[184:187]
ds_read_b64_tr_b16 a[88:89], v15 offset:8192
s_add_u32 m0, s16, 0x9c00
v_mfma_f32_16x16x32_bf16 v[184:187], a[100:103], a[16:19], v[184:187]
buffer_load_dwordx4 v23, s[44:47], s23 offen lds
v_mfma_f32_16x16x32_bf16 v[192:195], a[100:103], a[20:23], v[192:195]
ds_read_b64_tr_b16 a[90:91], v15 offset:8448
v_fmac_f32 v2, v18, v21
v_mfma_f32_16x16x32_bf16 v[192:195], a[96:99], a[4:7], v[192:195]
ds_read_b64_tr_b16 a[92:93], v15 offset:10240
v_accvgpr_read_b32 v21, a140
v_mfma_f32_16x16x32_bf16 v[200:203], a[96:99], a[8:11], v[200:203]
ds_read_b64_tr_b16 a[94:95], v15 offset:10496
v_add_u32 v12, 0xffff0000, v12
v_mfma_f32_16x16x32_bf16 v[200:203], a[100:103], a[24:27], v[200:203]
v_add_u32 v13, 0xffff0000, v13
v_add_u32 v14, 0xffff0000, v14
v_mfma_f32_16x16x32_bf16 v[208:211], a[100:103], a[28:31], v[208:211]
v_add_u32 v15, 0xffff0000, v15
v_lshlrev_b32 v20, 16, v21
v_mfma_f32_16x16x32_bf16 v[208:211], a[96:99], a[12:15], v[208:211]
v_and_b32 v21, 0xffff0000, v21
v_fmac_f32 v3, v1, v20
v_mfma_f32_16x16x32_bf16 v[212:215], a[104:107], a[12:15], v[212:215]
s_waitcnt vmcnt(25) lgkmcnt(0)
v_fmac_f32 v3, v18, v21
v_accvgpr_read_b32 v18, a149
v_mfma_f32_16x16x32_bf16 v[212:215], a[108:111], a[28:31], v[212:215]
s_barrier
s_add_u32 m0, s17, 0x10000
v_lshlrev_b32 v1, 16, v18
v_mfma_f32_16x16x32_bf16 v[204:207], a[108:111], a[24:27], v[204:207]
buffer_load_dwordx4 v5, s[52:55], 0 offen lds
v_mfma_f32_16x16x32_bf16 v[204:207], a[104:107], a[8:11], v[204:207]
ds_read_b64_tr_b16 a[96:97], v12 offset:0
v_and_b32 v18, 0xffff0000, v18
v_mfma_f32_16x16x32_bf16 v[196:199], a[104:107], a[4:7], v[196:199]
ds_read_b64_tr_b16 a[98:99], v12 offset:1024
v_accvgpr_read_b32 v21, a133
v_mfma_f32_16x16x32_bf16 v[196:199], a[108:111], a[20:23], v[196:199]
ds_read_b64_tr_b16 a[100:101], v12 offset:8192
v_lshlrev_b32 v20, 16, v21
v_mfma_f32_16x16x32_bf16 v[188:191], a[108:111], a[16:19], v[188:191]
ds_read_b64_tr_b16 a[102:103], v12 offset:9216
v_and_b32 v21, 0xffff0000, v21
v_mfma_f32_16x16x32_bf16 v[188:191], a[104:107], a[0:3], v[188:191]
s_waitcnt lgkmcnt(4)
v_fmac_f32 v2, v1, v20
v_fmac_f32 v2, v18, v21
v_mfma_f32_16x16x32_bf16 v[216:219], a[0:3], a[80:83], v[216:219]
ds_read_b64_tr_b16 a[104:105], v13 offset:0
v_accvgpr_read_b32 v21, a141
v_mfma_f32_16x16x32_bf16 v[216:219], a[16:19], a[84:87], v[216:219]
ds_read_b64_tr_b16 a[106:107], v13 offset:1024
s_add_u32 m0, s17, 0x10400
v_mfma_f32_16x16x32_bf16 v[224:227], a[20:23], a[84:87], v[224:227]
buffer_load_dwordx4 v5, s[52:55], s13 offen lds
v_mfma_f32_16x16x32_bf16 v[224:227], a[4:7], a[80:83], v[224:227]
ds_read_b64_tr_b16 a[108:109], v13 offset:8192
v_lshlrev_b32 v20, 16, v21
v_mfma_f32_16x16x32_bf16 v[232:235], a[8:11], a[80:83], v[232:235]
ds_read_b64_tr_b16 a[110:111], v13 offset:9216
v_and_b32 v21, 0xffff0000, v21
v_mfma_f32_16x16x32_bf16 v[232:235], a[24:27], a[84:87], v[232:235]
v_fmac_f32 v3, v1, v20
v_fmac_f32 v3, v18, v21
v_mfma_f32_16x16x32_bf16 v[240:243], a[28:31], a[84:87], v[240:243]
v_accvgpr_read_b32 v18, a150
v_lshlrev_b32 v1, 16, v18
v_mfma_f32_16x16x32_bf16 v[240:243], a[12:15], a[80:83], v[240:243]
v_and_b32 v18, 0xffff0000, v18
v_accvgpr_read_b32 v21, a134
v_mfma_f32_16x16x32_bf16 v[244:247], a[12:15], a[88:91], v[244:247]
ds_read_b64_tr_b16 a[80:81], v12 offset:256
v_lshlrev_b32 v20, 16, v21
v_mfma_f32_16x16x32_bf16 v[244:247], a[28:31], a[92:95], v[244:247]
ds_read_b64_tr_b16 a[82:83], v12 offset:1280
v_and_b32 v21, 0xffff0000, v21
v_mfma_f32_16x16x32_bf16 v[236:239], a[24:27], a[92:95], v[236:239]
ds_read_b64_tr_b16 a[84:85], v12 offset:8448
s_add_u32 m0, s17, 0x10800
v_mfma_f32_16x16x32_bf16 v[236:239], a[8:11], a[88:91], v[236:239]
buffer_load_dwordx4 v6, s[52:55], 0 offen lds
v_mfma_f32_16x16x32_bf16 v[228:231], a[4:7], a[88:91], v[228:231]
ds_read_b64_tr_b16 a[86:87], v12 offset:9472
v_fmac_f32 v2, v1, v20
v_mfma_f32_16x16x32_bf16 v[228:231], a[20:23], a[92:95], v[228:231]
v_fmac_f32 v2, v18, v21
v_accvgpr_read_b32 v21, a142
v_mfma_f32_16x16x32_bf16 v[220:223], a[16:19], a[92:95], v[220:223]
v_lshlrev_b32 v20, 16, v21
v_and_b32 v21, 0xffff0000, v21
v_mfma_f32_16x16x32_bf16 v[220:223], a[0:3], a[88:91], v[220:223]
s_waitcnt lgkmcnt(4)
v_fmac_f32 v3, v1, v20
v_fmac_f32 v3, v18, v21
L_S21:
v_mfma_f32_16x16x32_bf16 v[24:27], a[96:99], a[32:35], v[24:27]
ds_read_b64_tr_b16 a[88:89], v13 offset:256
s_waitcnt vmcnt(19)
v_mfma_f32_16x16x32_bf16 v[24:27], a[100:103], a[48:51], v[24:27]
ds_read_b64_tr_b16 a[90:91], v13 offset:1280
v_accvgpr_read_b32 v18, a151
v_mfma_f32_16x16x32_bf16 v[32:35], a[100:103], a[52:55], v[32:35]
ds_read_b64_tr_b16 a[92:93], v13 offset:8448
s_add_u32 m0, s17, 0x10c00
v_mfma_f32_16x16x32_bf16 v[32:35], a[96:99], a[36:39], v[32:35]
buffer_load_dwordx4 v6, s[52:55], s13 offen lds
v_mfma_f32_16x16x32_bf16 v[40:43], a[96:99], a[40:43], v[40:43]
ds_read_b64_tr_b16 a[94:95], v13 offset:9472
v_lshlrev_b32 v1, 16, v18
v_mfma_f32_16x16x32_bf16 v[40:43], a[100:103], a[56:59], v[40:43]
ds_read_b128 a[0:3], v8 offset:0
v_and_b32 v18, 0xffff0000, v18
v_mfma_f32_16x16x32_bf16 v[48:51], a[100:103], a[60:63], v[48:51]
ds_read_b128 a[16:19], v9 offset:0
v_accvgpr_read_b32 v21, a135
v_mfma_f32_16x16x32_bf16 v[48:51], a[96:99], a[44:47], v[48:51]
ds_read_b128 a[4:7], v8 offset:2048
v_lshlrev_b32 v20, 16, v21
v_mfma_f32_16x16x32_bf16 v[52:55], a[104:107], a[44:47], v[52:55]
ds_read_b64_tr_b16 a[96:97], v12 offset:512
v_and_b32 v21, 0xffff0000, v21
v_mfma_f32_16x16x32_bf16 v[52:55], a[108:111], a[60:63], v[52:55]
ds_read_b64_tr_b16 a[98:99], v12 offset:1536
v_fmac_f32 v2, v1, v20
v_mfma_f32_16x16x32_bf16 v[44:47], a[108:111], a[56:59], v[44:47]
ds_read_b64_tr_b16 a[100:101], v12 offset:8704
v_fmac_f32 v2, v18, v21
v_mfma_f32_16x16x32_bf16 v[44:47], a[104:107], a[40:43], v[44:47]
ds_read_b64_tr_b16 a[102:103], v12 offset:9728
s_add_u32 m0, s18, 0x14000
v_mfma_f32_16x16x32_bf16 v[36:39], a[104:107], a[36:39], v[36:39]
buffer_load_dwordx4 v7, s[68:71], 0 offen lds
v_mfma_f32_16x16x32_bf16 v[36:39], a[108:111], a[52:55], v[36:39]
ds_read_b128 a[20:23], v9 offset:2048
v_accvgpr_read_b32 v21, a143
v_mfma_f32_16x16x32_bf16 v[28:31], a[108:111], a[48:51], v[28:31]
ds_read_b128 a[8:11], v8 offset:4096
v_lshlrev_b32 v20, 16, v21
v_mfma_f32_16x16x32_bf16 v[28:31], a[104:107], a[32:35], v[28:31]
ds_read_b128 a[24:27], v9 offset:4096
s_waitcnt lgkmcnt(10)
v_mfma_f32_16x16x32_bf16 v[56:59], a[80:83], a[32:35], v[56:59]
ds_read_b64_tr_b16 a[104:105], v13 offset:512
v_and_b32 v21, 0xffff0000, v21
v_mfma_f32_16x16x32_bf16 v[56:59], a[84:87], a[48:51], v[56:59]
ds_read_b64_tr_b16 a[106:107], v13 offset:1536
v_fmac_f32 v3, v1, v20
v_mfma_f32_16x16x32_bf16 v[64:67], a[84:87], a[52:55], v[64:67]
ds_read_b64_tr_b16 a[108:109], v13 offset:8704
v_fmac_f32 v3, v18, v21
v_mfma_f32_16x16x32_bf16 v[64:67], a[80:83], a[36:39], v[64:67]
ds_read_b64_tr_b16 a[110:111], v13 offset:9728
s_add_u32 m0, s18, 0x15000
v_mfma_f32_16x16x32_bf16 v[72:75], a[80:83], a[40:43], v[72:75]
buffer_load_dwordx4 v7, s[68:71], s25 offen lds
v_mfma_f32_16x16x32_bf16 v[72:75], a[84:87], a[56:59], v[72:75]
ds_read_b128 a[12:15], v8 offset:6144
v_add_f32_dpp v2, v2, v2 row_ror:8 row_mask:0xf bank_mask:0xf
v_mfma_f32_16x16x32_bf16 v[80:83], a[84:87], a[60:63], v[80:83]
ds_read_b128 a[28:31], v9 offset:6144
v_add_f32_dpp v3, v3, v3 row_ror:8 row_mask:0xf bank_mask:0xf
v_mfma_f32_16x16x32_bf16 v[80:83], a[80:83], a[44:47], v[80:83]
v_add_f32_dpp v2, v2, v2 row_ror:4 row_mask:0xf bank_mask:0xf
v_add_f32_dpp v3, v3, v3 row_ror:4 row_mask:0xf bank_mask:0xf
v_mfma_f32_16x16x32_bf16 v[84:87], a[88:91], a[44:47], v[84:87]
ds_read_b64_tr_b16 a[80:81], v12 offset:768
v_add_f32_dpp v2, v2, v2 row_ror:2 row_mask:0xf bank_mask:0xf
v_mfma_f32_16x16x32_bf16 v[84:87], a[92:95], a[60:63], v[84:87]
ds_read_b64_tr_b16 a[82:83], v12 offset:1792
v_add_f32_dpp v3, v3, v3 row_ror:2 row_mask:0xf bank_mask:0xf
v_mfma_f32_16x16x32_bf16 v[76:79], a[92:95], a[56:59], v[76:79]
ds_read_b64_tr_b16 a[84:85], v12 offset:8960
v_add_f32_dpp v2, v2, v2 row_ror:1 row_mask:0xf bank_mask:0xf
v_mfma_f32_16x16x32_bf16 v[76:79], a[88:91], a[40:43], v[76:79]
ds_read_b64_tr_b16 a[86:87], v12 offset:9984
v_add_f32_dpp v3, v3, v3 row_ror:1 row_mask:0xf bank_mask:0xf
v_mfma_f32_16x16x32_bf16 v[68:71], a[88:91], a[36:39], v[68:71]
s_add_u32 m0, s18, 0x16000
v_mov_b32 v1, v2
v_mov_b32 v18, v3
v_mfma_f32_16x16x32_bf16 v[68:71], a[92:95], a[52:55], v[68:71]
buffer_load_dwordx4 v7, s[68:71], s26 offen lds
v_mfma_f32_16x16x32_bf16 v[60:63], a[92:95], a[48:51], v[60:63]
v_permlane16_swap_b32 v1, v2
v_permlane16_swap_b32 v18, v3
v_mfma_f32_16x16x32_bf16 v[60:63], a[88:91], a[32:35], v[60:63]
s_waitcnt lgkmcnt(6)
v_add_f32 v2, v2, v1
v_add_f32 v3, v3, v18
v_mfma_f32_16x16x32_bf16 v[88:91], a[96:99], a[32:35], v[88:91]
ds_read_b64_tr_b16 a[88:89], v13 offset:768
v_mov_b32 v1, v2
v_mfma_f32_16x16x32_bf16 v[88:91], a[100:103], a[48:51], v[88:91]
ds_read_b64_tr_b16 a[90:91], v13 offset:1792
v_mov_b32 v18, v3
v_mfma_f32_16x16x32_bf16 v[96:99], a[100:103], a[52:55], v[96:99]
ds_read_b64_tr_b16 a[92:93], v13 offset:8960
v_permlane32_swap_b32 v1, v2
v_mfma_f32_16x16x32_bf16 v[96:99], a[96:99], a[36:39], v[96:99]
ds_read_b64_tr_b16 a[94:95], v13 offset:9984
v_permlane32_swap_b32 v18, v3
v_mfma_f32_16x16x32_bf16 v[104:107], a[96:99], a[40:43], v[104:107]
v_add_f32 v2, v2, v1
v_add_f32 v3, v3, v18
v_mfma_f32_16x16x32_bf16 v[104:107], a[100:103], a[56:59], v[104:107]
buffer_load_dword v23, off, s[84:87], s10 sc1
v_mfma_f32_16x16x32_bf16 v[112:115], a[100:103], a[60:63], v[112:115]
v_mul_f32 v2, 0xbfb8aa3b, v2
v_mul_f32 v3, 0xbfb8aa3b, v3
v_mfma_f32_16x16x32_bf16 v[112:115], a[96:99], a[44:47], v[112:115]
v_exp_f32 v2, v2
v_mfma_f32_16x16x32_bf16 v[116:119], a[104:107], a[44:47], v[116:119]
ds_read_b64_tr_b16 a[96:97], v14 offset:0
v_mfma_f32_16x16x32_bf16 v[116:119], a[108:111], a[60:63], v[116:119]
ds_read_b64_tr_b16 a[98:99], v14 offset:256
v_mfma_f32_16x16x32_bf16 v[108:111], a[108:111], a[56:59], v[108:111]
ds_read_b64_tr_b16 a[100:101], v14 offset:2048
v_mfma_f32_16x16x32_bf16 v[108:111], a[104:107], a[40:43], v[108:111]
ds_read_b64_tr_b16 a[102:103], v14 offset:2304
v_mfma_f32_16x16x32_bf16 v[100:103], a[104:107], a[36:39], v[100:103]
v_exp_f32 v3, v3
v_mfma_f32_16x16x32_bf16 v[100:103], a[108:111], a[52:55], v[100:103]
v_add_f32 v2, 1.0, v2
v_add_f32 v3, 1.0, v3
v_mfma_f32_16x16x32_bf16 v[92:95], a[108:111], a[48:51], v[92:95]
v_rcp_f32 v2, v2
v_mfma_f32_16x16x32_bf16 v[92:95], a[104:107], a[32:35], v[92:95]
s_waitcnt lgkmcnt(4)
v_rcp_f32 v3, v3
v_mfma_f32_16x16x32_bf16 v[120:123], a[80:83], a[32:35], v[120:123]
ds_read_b64_tr_b16 a[104:105], v15 offset:0
v_mfma_f32_16x16x32_bf16 v[120:123], a[84:87], a[48:51], v[120:123]
ds_read_b64_tr_b16 a[106:107], v15 offset:256
v_mfma_f32_16x16x32_bf16 v[128:131], a[84:87], a[52:55], v[128:131]
ds_read_b64_tr_b16 a[108:109], v15 offset:2048
v_mfma_f32_16x16x32_bf16 v[128:131], a[80:83], a[36:39], v[128:131]
ds_read_b64_tr_b16 a[110:111], v15 offset:2304
v_mfma_f32_16x16x32_bf16 v[136:139], a[80:83], a[40:43], v[136:139]
buffer_store_dwordx2 v[2:3], off, s[88:91], s101 sc1
v_mfma_f32_16x16x32_bf16 v[136:139], a[84:87], a[56:59], v[136:139]
v_mfma_f32_16x16x32_bf16 v[144:147], a[84:87], a[60:63], v[144:147]
v_mfma_f32_16x16x32_bf16 v[144:147], a[80:83], a[44:47], v[144:147]
v_mfma_f32_16x16x32_bf16 v[148:151], a[88:91], a[44:47], v[148:151]
ds_read_b64_tr_b16 a[80:81], v14 offset:4096
v_mfma_f32_16x16x32_bf16 v[148:151], a[92:95], a[60:63], v[148:151]
ds_read_b64_tr_b16 a[82:83], v14 offset:4352
v_mfma_f32_16x16x32_bf16 v[140:143], a[92:95], a[56:59], v[140:143]
ds_read_b64_tr_b16 a[84:85], v14 offset:6144
v_mfma_f32_16x16x32_bf16 v[140:143], a[88:91], a[40:43], v[140:143]
ds_read_b64_tr_b16 a[86:87], v14 offset:6400
v_mfma_f32_16x16x32_bf16 v[132:135], a[88:91], a[36:39], v[132:135]
v_mfma_f32_16x16x32_bf16 v[132:135], a[92:95], a[52:55], v[132:135]
v_mfma_f32_16x16x32_bf16 v[124:127], a[92:95], a[48:51], v[124:127]
v_mfma_f32_16x16x32_bf16 v[124:127], a[88:91], a[32:35], v[124:127]
s_waitcnt lgkmcnt(4)
v_mfma_f32_16x16x32_bf16 v[152:155], a[96:99], a[32:35], v[152:155]
ds_read_b64_tr_b16 a[88:89], v15 offset:4096
v_mfma_f32_16x16x32_bf16 v[152:155], a[100:103], a[48:51], v[152:155]
ds_read_b64_tr_b16 a[90:91], v15 offset:4352
v_mfma_f32_16x16x32_bf16 v[160:163], a[100:103], a[52:55], v[160:163]
ds_read_b64_tr_b16 a[92:93], v15 offset:6144
v_mfma_f32_16x16x32_bf16 v[160:163], a[96:99], a[36:39], v[160:163]
ds_read_b64_tr_b16 a[94:95], v15 offset:6400
v_mfma_f32_16x16x32_bf16 v[168:171], a[96:99], a[40:43], v[168:171]
v_mfma_f32_16x16x32_bf16 v[168:171], a[100:103], a[56:59], v[168:171]
v_mfma_f32_16x16x32_bf16 v[176:179], a[100:103], a[60:63], v[176:179]
v_mfma_f32_16x16x32_bf16 v[176:179], a[96:99], a[44:47], v[176:179]
v_mfma_f32_16x16x32_bf16 v[180:183], a[104:107], a[44:47], v[180:183]
ds_read_b64_tr_b16 a[96:97], v14 offset:8192
v_mfma_f32_16x16x32_bf16 v[180:183], a[108:111], a[60:63], v[180:183]
ds_read_b64_tr_b16 a[98:99], v14 offset:8448
v_mfma_f32_16x16x32_bf16 v[172:175], a[108:111], a[56:59], v[172:175]
ds_read_b64_tr_b16 a[100:101], v14 offset:10240
v_mfma_f32_16x16x32_bf16 v[172:175], a[104:107], a[40:43], v[172:175]
ds_read_b64_tr_b16 a[102:103], v14 offset:10496
v_mfma_f32_16x16x32_bf16 v[164:167], a[104:107], a[36:39], v[164:167]
v_mfma_f32_16x16x32_bf16 v[164:167], a[108:111], a[52:55], v[164:167]
v_mfma_f32_16x16x32_bf16 v[156:159], a[108:111], a[48:51], v[156:159]
v_mfma_f32_16x16x32_bf16 v[156:159], a[104:107], a[32:35], v[156:159]
s_waitcnt lgkmcnt(4)
v_mfma_f32_16x16x32_bf16 v[184:187], a[80:83], a[32:35], v[184:187]
ds_read_b64_tr_b16 a[104:105], v15 offset:8192
v_mfma_f32_16x16x32_bf16 v[184:187], a[84:87], a[48:51], v[184:187]
ds_read_b64_tr_b16 a[106:107], v15 offset:8448
v_mfma_f32_16x16x32_bf16 v[192:195], a[84:87], a[52:55], v[192:195]
ds_read_b64_tr_b16 a[108:109], v15 offset:10240
v_mfma_f32_16x16x32_bf16 v[192:195], a[80:83], a[36:39], v[192:195]
ds_read_b64_tr_b16 a[110:111], v15 offset:10496
v_add_u32 v12, 0x8000, v12
v_mfma_f32_16x16x32_bf16 v[200:203], a[80:83], a[40:43], v[200:203]
v_add_u32 v13, 0x8000, v13
v_add_u32 v14, 0x8000, v14
v_mfma_f32_16x16x32_bf16 v[200:203], a[84:87], a[56:59], v[200:203]
v_add_u32 v15, 0x8000, v15
v_mfma_f32_16x16x32_bf16 v[208:211], a[84:87], a[60:63], v[208:211]
v_mfma_f32_16x16x32_bf16 v[208:211], a[80:83], a[44:47], v[208:211]
v_mfma_f32_16x16x32_bf16 v[212:215], a[88:91], a[44:47], v[212:215]
s_waitcnt vmcnt(1) lgkmcnt(0)
s_mov_b32 s92, 200000
L_spin_kv:
v_readfirstlane_b32 s93, v23
s_nop 1
s_cmp_ge_u32 s93, 8
s_cbranch_scc1 L_spun_kv
s_sub_u32 s92, s92, 1
s_cbranch_scc1 L_spun_kv
s_sleep 4
buffer_load_dword v23, off, s[84:87], s10 sc1
s_waitcnt vmcnt(0)
s_branch L_spin_kv
L_spun_kv:
v_mfma_f32_16x16x32_bf16 v[212:215], a[92:95], a[60:63], v[212:215]
s_barrier
s_add_u32 m0, s19, 0x0
v_mfma_f32_16x16x32_bf16 v[204:207], a[92:95], a[56:59], v[204:207]
buffer_load_dwordx4 v16, s[48:51], s32 offen offset:0 sc1 lds
v_mfma_f32_16x16x32_bf16 v[204:207], a[88:91], a[40:43], v[204:207]
ds_read_b64_tr_b16 a[80:81], v12 offset:0
v_mov_b32 v3, v16
v_mfma_f32_16x16x32_bf16 v[196:199], a[88:91], a[36:39], v[196:199]
ds_read_b64_tr_b16 a[82:83], v12 offset:1024
v_mov_b32 v22, 0x3f803f80
v_mfma_f32_16x16x32_bf16 v[196:199], a[92:95], a[52:55], v[196:199]
ds_read_b64_tr_b16 a[84:85], v12 offset:8192
s_mov_b32 s33, 0
v_mfma_f32_16x16x32_bf16 v[188:191], a[92:95], a[48:51], v[188:191]
ds_read_b64_tr_b16 a[86:87], v12 offset:9216
v_accvgpr_write_b32 a240, v22
v_mfma_f32_16x16x32_bf16 v[188:191], a[88:91], a[32:35], v[188:191]
s_waitcnt lgkmcnt(4)
v_accvgpr_write_b32 a241, v22
v_accvgpr_write_b32 a242, v22
v_mfma_f32_16x16x32_bf16 v[216:219], a[32:35], a[96:99], v[216:219]
buffer_load_dwordx4 v16, s[48:51], s32 offen offset:1024 sc1 lds
v_accvgpr_write_b32 a243, v22
v_mfma_f32_16x16x32_bf16 v[216:219], a[48:51], a[100:103], v[216:219]
ds_read_b64_tr_b16 a[88:89], v13 offset:0
s_mov_b32 s36, 0x33333333
v_mfma_f32_16x16x32_bf16 v[224:227], a[52:55], a[100:103], v[224:227]
ds_read_b64_tr_b16 a[90:91], v13 offset:1024
s_mov_b32 s37, 0xcccccccc
v_mfma_f32_16x16x32_bf16 v[224:227], a[36:39], a[96:99], v[224:227]
ds_read_b64_tr_b16 a[92:93], v13 offset:8192
v_cndmask_b32 v4, 0, v22, s[36:37]
v_mfma_f32_16x16x32_bf16 v[232:235], a[40:43], a[96:99], v[232:235]
ds_read_b64_tr_b16 a[94:95], v13 offset:9216
v_accvgpr_write_b32 a232, v4
v_accvgpr_write_b32 a233, v4
v_mfma_f32_16x16x32_bf16 v[232:235], a[56:59], a[100:103], v[232:235]
v_accvgpr_write_b32 a234, v4
v_accvgpr_write_b32 a235, v4
v_mfma_f32_16x16x32_bf16 v[240:243], a[60:63], a[100:103], v[240:243]
s_mov_b32 s36, 0x44444444
s_mov_b32 s37, 0x44444444
v_cndmask_b32 v4, 0, v22, s[36:37]
v_mfma_f32_16x16x32_bf16 v[240:243], a[44:47], a[96:99], v[240:243]
buffer_load_dwordx4 v16, s[48:51], s32 offen offset:2048 sc1 lds
v_mfma_f32_16x16x32_bf16 v[244:247], a[44:47], a[104:107], v[244:247]
ds_read_b64_tr_b16 a[96:97], v12 offset:256
v_accvgpr_write_b32 a236, v4
v_accvgpr_write_b32 a237, v4
v_mfma_f32_16x16x32_bf16 v[244:247], a[60:63], a[108:111], v[244:247]
ds_read_b64_tr_b16 a[98:99], v12 offset:1280
v_accvgpr_write_b32 a238, v4
v_mfma_f32_16x16x32_bf16 v[236:239], a[56:59], a[108:111], v[236:239]
ds_read_b64_tr_b16 a[100:101], v12 offset:8448
v_accvgpr_write_b32 a239, v4
v_mfma_f32_16x16x32_bf16 v[236:239], a[40:43], a[104:107], v[236:239]
ds_read_b64_tr_b16 a[102:103], v12 offset:9472
v_mov_b32 v1, v3
v_mfma_f32_16x16x32_bf16 v[228:231], a[36:39], a[104:107], v[228:231]
v_add_u32 v2, 98304, v3
v_mfma_f32_16x16x32_bf16 v[228:231], a[52:55], a[108:111], v[228:231]
s_mov_b64 s[34:35], 0
v_accvgpr_write_b32 a224, 0
v_accvgpr_write_b32 a225, 0
v_mfma_f32_16x16x32_bf16 v[220:223], a[48:51], a[108:111], v[220:223]
buffer_load_dwordx4 v16, s[48:51], s32 offen offset:3072 sc1 lds
v_mfma_f32_16x16x32_bf16 v[220:223], a[32:35], a[104:107], v[220:223]
s_waitcnt lgkmcnt(4)
v_accvgpr_write_b32 a226, 0
v_accvgpr_write_b32 a227, 0
L_S22:
v_mfma_f32_16x16x32_bf16 v[24:27], a[80:83], a[0:3], v[24:27]
ds_read_b64_tr_b16 a[104:105], v13 offset:256
s_waitcnt vmcnt(13)
v_accvgpr_write_b32 a228, 0
v_mfma_f32_16x16x32_bf16 v[24:27], a[84:87], a[16:19], v[24:27]
ds_read_b64_tr_b16 a[106:107], v13 offset:1280
v_accvgpr_write_b32 a229, 0
v_mfma_f32_16x16x32_bf16 v[32:35], a[84:87], a[20:23], v[32:35]
ds_read_b64_tr_b16 a[108:109], v13 offset:8448
v_accvgpr_write_b32 a230, 0
v_mfma_f32_16x16x32_bf16 v[32:35], a[80:83], a[4:7], v[32:35]
ds_read_b64_tr_b16 a[110:111], v13 offset:9472
v_accvgpr_write_b32 a231, 0
v_mfma_f32_16x16x32_bf16 v[40:43], a[80:83], a[8:11], v[40:43]
ds_read_b128 a[32:35], v8 offset:32768
s_add_u32 m0, s19, 0x1000
s_mul_i32 s8, s6, 0x142400
v_mfma_f32_16x16x32_bf16 v[40:43], a[84:87], a[24:27], v[40:43]
buffer_load_dwordx4 v16, s[48:51], s7 offen offset:0 sc1 lds
v_mfma_f32_16x16x32_bf16 v[48:51], a[84:87], a[28:31], v[48:51]
ds_read_b128 a[48:51], v9 offset:32768
s_sub_u32 s9, 0x12e1c00, s8
v_mfma_f32_16x16x32_bf16 v[48:51], a[80:83], a[12:15], v[48:51]
ds_read_b128 a[36:39], v8 offset:34816
s_lshl_b32 s11, s5, 13
v_mfma_f32_16x16x32_bf16 v[52:55], a[88:91], a[12:15], v[52:55]
ds_read_b64_tr_b16 a[80:81], v12 offset:512
L_padA11:
s_cmp_eq_u32 s95, 1
s_cbranch_scc1 L_hopA_ret
s_add_u32 s11, s11, 0x2200000
s_add_u32 s8, s8, s11
v_mfma_f32_16x16x32_bf16 v[52:55], a[92:95], a[28:31], v[52:55]
ds_read_b64_tr_b16 a[82:83], v12 offset:1536
s_add_u32 s9, s9, s11
v_mfma_f32_16x16x32_bf16 v[44:47], a[92:95], a[24:27], v[44:47]
ds_read_b64_tr_b16 a[84:85], v12 offset:8704
s_lshl_b32 s11, s4, 10
v_mfma_f32_16x16x32_bf16 v[44:47], a[88:91], a[8:11], v[44:47]
buffer_load_dwordx4 v16, s[48:51], s7 offen offset:1024 sc1 lds
v_mfma_f32_16x16x32_bf16 v[36:39], a[88:91], a[4:7], v[36:39]
ds_read_b64_tr_b16 a[86:87], v12 offset:9728
s_add_u32 s44, s8, s11
s_add_u32 s46, s9, s11
v_mfma_f32_16x16x32_bf16 v[36:39], a[92:95], a[20:23], v[36:39]
ds_read_b128 a[52:55], v9 offset:34816
s_sub_u32 s11, 0x1c00, s11
v_mfma_f32_16x16x32_bf16 v[28:31], a[92:95], a[16:19], v[28:31]
ds_read_b128 a[40:43], v8 offset:36864
s_add_u32 s45, s8, s11
v_mfma_f32_16x16x32_bf16 v[28:31], a[88:91], a[0:3], v[28:31]
ds_read_b128 a[56:59], v9 offset:36864
s_waitcnt lgkmcnt(10)
v_mfma_f32_16x16x32_bf16 v[56:59], a[96:99], a[0:3], v[56:59]
ds_read_b64_tr_b16 a[88:89], v13 offset:512
s_add_u32 s47, s9, s11
s_mul_i32 s8, s5, 0x6000
v_mfma_f32_16x16x32_bf16 v[56:59], a[100:103], a[16:19], v[56:59]
ds_read_b64_tr_b16 a[90:91], v13 offset:1536
s_add_u32 s8, s8, 0x40000
v_mfma_f32_16x16x32_bf16 v[64:67], a[100:103], a[20:23], v[64:67]
buffer_load_dwordx4 v16, s[48:51], s7 offen offset:2048 sc1 lds
v_mfma_f32_16x16x32_bf16 v[64:67], a[96:99], a[4:7], v[64:67]
ds_read_b64_tr_b16 a[92:93], v13 offset:8704
s_add_u32 s28, s44, s8
v_mfma_f32_16x16x32_bf16 v[72:75], a[96:99], a[8:11], v[72:75]
ds_read_b64_tr_b16 a[94:95], v13 offset:9728
s_add_u32 s29, s45, s8
s_add_u32 s30, s46, s8
v_mfma_f32_16x16x32_bf16 v[72:75], a[100:103], a[24:27], v[72:75]
ds_read_b128 a[44:47], v8 offset:38912
s_add_u32 s31, s47, s8
v_mfma_f32_16x16x32_bf16 v[80:83], a[100:103], a[28:31], v[80:83]
ds_read_b128 a[60:63], v9 offset:38912
s_lshl_b32 s8, s4, 11
v_mfma_f32_16x16x32_bf16 v[80:83], a[96:99], a[12:15], v[80:83]
s_add_u32 s9, s8, 131072
v_add_u32 v4, s9, v16
v_mfma_f32_16x16x32_bf16 v[84:87], a[104:107], a[12:15], v[84:87]
ds_read_b64_tr_b16 a[96:97], v12 offset:768
s_sub_u32 s9, 145408, s8
v_mfma_f32_16x16x32_bf16 v[84:87], a[108:111], a[28:31], v[84:87]
buffer_load_dwordx4 v16, s[48:51], s7 offen offset:3072 sc1 lds
v_mfma_f32_16x16x32_bf16 v[76:79], a[108:111], a[24:27], v[76:79]
ds_read_b64_tr_b16 a[98:99], v12 offset:1792
s_add_u32 s32, s32, s94
v_mfma_f32_16x16x32_bf16 v[76:79], a[104:107], a[8:11], v[76:79]
ds_read_b64_tr_b16 a[100:101], v12 offset:8960
s_add_u32 s7, s7, s94
v_mfma_f32_16x16x32_bf16 v[68:71], a[104:107], a[4:7], v[68:71]
ds_read_b64_tr_b16 a[102:103], v12 offset:9984
s_cmp_eq_u32 s4, 0
s_cselect_b32 s8, 131072, s9
v_mfma_f32_16x16x32_bf16 v[68:71], a[108:111], a[20:23], v[68:71]
v_add_u32 v5, s8, v16
v_add_u32 v6, s9, v16
v_mfma_f32_16x16x32_bf16 v[60:63], a[108:111], a[16:19], v[60:63]
v_add_u32 v22, 0x800, v10
v_mfma_f32_16x16x32_bf16 v[60:63], a[104:107], a[0:3], v[60:63]
s_add_u32 m0, s19, 0x18000
s_waitcnt lgkmcnt(6)
s_mov_b32 s8, 0x800
v_mfma_f32_16x16x32_bf16 v[88:91], a[80:83], a[0:3], v[88:91]
buffer_load_dwordx4 v16, s[48:51], s32 offen offset:0 sc1 lds
v_mfma_f32_16x16x32_bf16 v[88:91], a[84:87], a[16:19], v[88:91]
ds_read_b64_tr_b16 a[104:105], v13 offset:768
v_mfma_f32_16x16x32_bf16 v[96:99], a[84:87], a[20:23], v[96:99]
ds_read_b64_tr_b16 a[106:107], v13 offset:1792
v_mfma_f32_16x16x32_bf16 v[96:99], a[80:83], a[4:7], v[96:99]
ds_read_b64_tr_b16 a[108:109], v13 offset:8960
v_mfma_f32_16x16x32_bf16 v[104:107], a[80:83], a[8:11], v[104:107]
ds_read_b64_tr_b16 a[110:111], v13 offset:9984
s_cmp_eq_u32 s6, 0
s_cselect_b32 s8, 0xffff8800, s8
v_mfma_f32_16x16x32_bf16 v[104:107], a[84:87], a[24:27], v[104:107]
v_add_u32 v7, s8, v11
v_mfma_f32_16x16x32_bf16 v[112:115], a[84:87], a[28:31], v[112:115]
buffer_load_dwordx4 v16, s[48:51], s32 offen offset:1024 sc1 lds
v_mfma_f32_16x16x32_bf16 v[112:115], a[80:83], a[12:15], v[112:115]
s_and_b32 s18, s2, 4
s_lshr_b32 s8, s2, 6
s_add_u32 s18, s18, s8
v_mfma_f32_16x16x32_bf16 v[116:119], a[88:91], a[12:15], v[116:119]
ds_read_b64_tr_b16 a[80:81], v14 offset:0
s_sub_u32 s8, 15, s18
v_mfma_f32_16x16x32_bf16 v[116:119], a[92:95], a[28:31], v[116:119]
ds_read_b64_tr_b16 a[82:83], v14 offset:256
v_mfma_f32_16x16x32_bf16 v[108:111], a[92:95], a[24:27], v[108:111]
ds_read_b64_tr_b16 a[84:85], v14 offset:2048
v_mfma_f32_16x16x32_bf16 v[108:111], a[88:91], a[8:11], v[108:111]
ds_read_b64_tr_b16 a[86:87], v14 offset:2304
v_mfma_f32_16x16x32_bf16 v[100:103], a[88:91], a[4:7], v[100:103]
buffer_load_dwordx4 v16, s[48:51], s32 offen offset:2048 sc1 lds
v_mfma_f32_16x16x32_bf16 v[100:103], a[92:95], a[20:23], v[100:103]
s_cmp_lt_u32 s4, 2
s_cselect_b32 s99, s18, s8
s_lshl_b32 s16, s2, 2
v_mfma_f32_16x16x32_bf16 v[92:95], a[92:95], a[16:19], v[92:95]
s_add_u32 s16, s16, s4
s_lshl_b32 s16, s16, 12
s_add_u32 s16, s16, 0x4800000
v_mfma_f32_16x16x32_bf16 v[92:95], a[88:91], a[0:3], v[92:95]
s_waitcnt lgkmcnt(4)
s_bfe_u32 s100, s2, 0x30003
s_and_b32 s14, s2, 3
v_mfma_f32_16x16x32_bf16 v[120:123], a[96:99], a[0:3], v[120:123]
ds_read_b64_tr_b16 a[88:89], v15 offset:0
s_lshl_b32 s24, s18, 2
s_add_u32 s24, s24, s14
v_mfma_f32_16x16x32_bf16 v[120:123], a[100:103], a[16:19], v[120:123]
ds_read_b64_tr_b16 a[90:91], v15 offset:256
s_lshl_b32 s24, s24, 8
v_mfma_f32_16x16x32_bf16 v[128:131], a[100:103], a[20:23], v[128:131]
buffer_load_dwordx4 v16, s[48:51], s32 offen offset:3072 sc1 lds
v_mfma_f32_16x16x32_bf16 v[128:131], a[96:99], a[4:7], v[128:131]
ds_read_b64_tr_b16 a[92:93], v15 offset:2048
s_add_u32 s24, s24, 0x3704000
v_mfma_f32_16x16x32_bf16 v[136:139], a[96:99], a[8:11], v[136:139]
ds_read_b64_tr_b16 a[94:95], v15 offset:2304
s_mov_b32 s12, 14336
s_lshl_b32 s13, s4, 15
v_mfma_f32_16x16x32_bf16 v[136:139], a[100:103], a[24:27], v[136:139]
s_lshl_b32 s9, s100, 8
s_add_u32 s13, s13, s9
s_mul_i32 s9, s14, 0x80040
v_mfma_f32_16x16x32_bf16 v[144:147], a[100:103], a[28:31], v[144:147]
s_add_u32 s13, s13, s9
s_and_b32 s9, s2, 1
s_lshl_b32 s9, s9, 17
v_mfma_f32_16x16x32_bf16 v[144:147], a[96:99], a[12:15], v[144:147]
s_add_u32 m0, s19, 0x19000
s_add_u32 s13, s13, s9
s_mul_i32 s25, s14, 0x180000
v_mfma_f32_16x16x32_bf16 v[148:151], a[104:107], a[12:15], v[148:151]
buffer_load_dwordx4 v16, s[48:51], s7 offen offset:0 sc1 lds
s_add_u32 s25, s25, s9
v_mfma_f32_16x16x32_bf16 v[148:151], a[108:111], a[28:31], v[148:151]
ds_read_b64_tr_b16 a[96:97], v14 offset:4096
s_sub_u32 s25, s25, 524288
v_mfma_f32_16x16x32_bf16 v[140:143], a[108:111], a[24:27], v[140:143]
ds_read_b64_tr_b16 a[98:99], v14 offset:4352
s_lshr_b32 s9, s9, 3
v_mfma_f32_16x16x32_bf16 v[140:143], a[104:107], a[8:11], v[140:143]
ds_read_b64_tr_b16 a[100:101], v14 offset:6144
s_mul_i32 s101, s99, 0x142400
v_mfma_f32_16x16x32_bf16 v[132:135], a[104:107], a[4:7], v[132:135]
ds_read_b64_tr_b16 a[102:103], v14 offset:6400
s_and_b32 s8, s4, 1
s_lshl_b32 s8, s8, 12
v_mfma_f32_16x16x32_bf16 v[132:135], a[108:111], a[20:23], v[132:135]
s_add_u32 s101, s101, s8
s_lshl_b32 s8, s14, 16
s_add_u32 s101, s101, s8
v_mfma_f32_16x16x32_bf16 v[124:127], a[108:111], a[16:19], v[124:127]
s_waitcnt lgkmcnt(4)
s_add_u32 s101, s101, s9
s_add_u32 s101, s101, 0x21fe000
v_mfma_f32_16x16x32_bf16 v[124:127], a[104:107], a[0:3], v[124:127]
buffer_load_dwordx4 v16, s[48:51], s7 offen offset:1024 sc1 lds
v_mfma_f32_16x16x32_bf16 v[152:155], a[80:83], a[0:3], v[152:155]
ds_read_b64_tr_b16 a[104:105], v15 offset:4096
s_mul_i32 s26, s14, 196608
s_add_u32 s26, s26, s9
v_mfma_f32_16x16x32_bf16 v[152:155], a[84:87], a[16:19], v[152:155]
ds_read_b64_tr_b16 a[106:107], v15 offset:4352
s_add_u32 s26, s26, 188416
v_mfma_f32_16x16x32_bf16 v[160:163], a[84:87], a[20:23], v[160:163]
ds_read_b64_tr_b16 a[108:109], v15 offset:6144
s_mov_b32 s52, 0x3e0293ee
v_mfma_f32_16x16x32_bf16 v[160:163], a[80:83], a[4:7], v[160:163]
ds_read_b64_tr_b16 a[110:111], v15 offset:6400
s_mov_b32 s53, 0x3e0293ee
v_mfma_f32_16x16x32_bf16 v[168:171], a[80:83], a[8:11], v[168:171]
s_mov_b32 s54, 0x3e8293ee
s_or_b32 s55, s6, s4
s_cselect_b32 s55, 0, 0xf149f2ca
s_mov_b32 s56, 0x50000
v_mfma_f32_16x16x32_bf16 v[168:171], a[84:87], a[24:27], v[168:171]
buffer_load_dwordx4 v16, s[48:51], s7 offen offset:2048 sc1 lds
v_mfma_f32_16x16x32_bf16 v[176:179], a[84:87], a[28:31], v[176:179]
s_mov_b32 s57, 0x5550055
s_mov_b32 s58, 0xa0000
s_mov_b32 s59, 0xaaa00aa
v_mfma_f32_16x16x32_bf16 v[176:179], a[80:83], a[12:15], v[176:179]
s_mov_b32 s60, 0x150001
s_mov_b32 s61, 0x15550155
s_mov_b32 s62, 0x2a0002
v_mfma_f32_16x16x32_bf16 v[180:183], a[88:91], a[12:15], v[180:183]
ds_read_b64_tr_b16 a[80:81], v14 offset:8192
s_mov_b32 s63, 0x2aaa02aa
s_mov_b32 s68, 0x55505555
v_mfma_f32_16x16x32_bf16 v[180:183], a[92:95], a[28:31], v[180:183]
ds_read_b64_tr_b16 a[82:83], v14 offset:8448
s_mov_b32 s69, 0x50005500
v_mfma_f32_16x16x32_bf16 v[172:175], a[92:95], a[24:27], v[172:175]
ds_read_b64_tr_b16 a[84:85], v14 offset:10240
s_mov_b32 s70, 0xaaa0aaaa
v_mfma_f32_16x16x32_bf16 v[172:175], a[88:91], a[8:11], v[172:175]
buffer_load_dwordx4 v16, s[48:51], s7 offen offset:3072 sc1 lds
v_mfma_f32_16x16x32_bf16 v[164:167], a[88:91], a[4:7], v[164:167]
ds_read_b64_tr_b16 a[86:87], v14 offset:10496
s_add_u32 s32, s32, 0x8000
s_mov_b32 s71, 0xa000aa00
v_mfma_f32_16x16x32_bf16 v[164:167], a[92:95], a[20:23], v[164:167]
s_add_u32 s7, s7, 0x8000
s_mov_b32 s76, 0x55405554
s_mov_b32 s77, 0x40005400
v_mfma_f32_16x16x32_bf16 v[156:159], a[92:95], a[16:19], v[156:159]
s_mov_b32 s78, 0xaa80aaa8
s_mov_b32 s79, 0x8000a800
s_mov_b32 s8, 0xf149f2ca
v_mfma_f32_16x16x32_bf16 v[156:159], a[88:91], a[0:3], v[156:159]
s_waitcnt lgkmcnt(4)
s_mov_b32 s36, 0xfff0ffff
v_mov_b32 v21, s1
v_mfma_f32_16x16x32_bf16 v[184:187], a[96:99], a[0:3], v[184:187]
ds_read_b64_tr_b16 a[88:89], v15 offset:8192
s_mov_b32 s37, 0xf000ff00
v_add_u32 v20, s0, v16
v_mfma_f32_16x16x32_bf16 v[184:187], a[100:103], a[16:19], v[184:187]
global_load_dword a120, v[20:21], off sc1
v_mfma_f32_16x16x32_bf16 v[192:195], a[100:103], a[20:23], v[192:195]
ds_read_b64_tr_b16 a[90:91], v15 offset:8448
s_mov_b32 s38, 0xffe0fffe
v_mfma_f32_16x16x32_bf16 v[192:195], a[96:99], a[4:7], v[192:195]
ds_read_b64_tr_b16 a[92:93], v15 offset:10240
s_mov_b32 s39, 0xe000fe00
v_mfma_f32_16x16x32_bf16 v[200:203], a[96:99], a[8:11], v[200:203]
ds_read_b64_tr_b16 a[94:95], v15 offset:10496
s_mov_b32 s40, 0xffc0fffc
v_add_u32 v12, 0x8000, v12
v_mfma_f32_16x16x32_bf16 v[200:203], a[100:103], a[24:27], v[200:203]
s_mov_b32 s41, 0xc000fc00
v_add_u32 v13, 0x8000, v13
v_add_u32 v14, 0x8000, v14
v_mfma_f32_16x16x32_bf16 v[208:211], a[100:103], a[28:31], v[208:211]
s_mov_b32 s42, 0xff80fff8
s_mov_b32 s43, 0x8000f800
v_add_u32 v15, 0x8000, v15
v_mfma_f32_16x16x32_bf16 v[208:211], a[96:99], a[12:15], v[208:211]
s_bitcmp1_b32 s4, 0
s_cselect_b32 s10, 0x7f800000, s8
s_cselect_b32 s11, s8, 0x7f800000
v_mfma_f32_16x16x32_bf16 v[212:215], a[104:107], a[12:15], v[212:215]
s_waitcnt vmcnt(19) lgkmcnt(0)
v_mfma_f32_16x16x32_bf16 v[212:215], a[108:111], a[28:31], v[212:215]
s_barrier
s_add_u32 m0, s19, 0x8000
v_mfma_f32_16x16x32_bf16 v[204:207], a[108:111], a[24:27], v[204:207]
buffer_load_dwordx4 v16, s[48:51], s32 offen offset:0 sc1 lds
v_mfma_f32_16x16x32_bf16 v[204:207], a[104:107], a[8:11], v[204:207]
ds_read_b64_tr_b16 a[96:97], v14 offset:4096
v_mfma_f32_16x16x32_bf16 v[196:199], a[104:107], a[4:7], v[196:199]
ds_read_b64_tr_b16 a[98:99], v14 offset:4352
v_mfma_f32_16x16x32_bf16 v[196:199], a[108:111], a[20:23], v[196:199]
ds_read_b64_tr_b16 a[100:101], v14 offset:6144
v_mfma_f32_16x16x32_bf16 v[188:191], a[108:111], a[16:19], v[188:191]
ds_read_b64_tr_b16 a[102:103], v14 offset:6400
v_mfma_f32_16x16x32_bf16 v[188:191], a[104:107], a[0:3], v[188:191]
s_waitcnt lgkmcnt(4)
v_mfma_f32_16x16x32_bf16 v[216:219], a[0:3], a[80:83], v[216:219]
buffer_load_dwordx4 v16, s[48:51], s32 offen offset:1024 sc1 lds
v_mfma_f32_16x16x32_bf16 v[216:219], a[16:19], a[84:87], v[216:219]
ds_read_b64_tr_b16 a[104:105], v15 offset:4096
v_mfma_f32_16x16x32_bf16 v[224:227], a[20:23], a[84:87], v[224:227]
ds_read_b64_tr_b16 a[106:107], v15 offset:4352
v_mfma_f32_16x16x32_bf16 v[224:227], a[4:7], a[80:83], v[224:227]
ds_read_b64_tr_b16 a[108:109], v15 offset:6144
v_mfma_f32_16x16x32_bf16 v[232:235], a[8:11], a[80:83], v[232:235]
ds_read_b64_tr_b16 a[110:111], v15 offset:6400
v_mfma_f32_16x16x32_bf16 v[232:235], a[24:27], a[84:87], v[232:235]
v_mfma_f32_16x16x32_bf16 v[240:243], a[28:31], a[84:87], v[240:243]
v_mfma_f32_16x16x32_bf16 v[240:243], a[12:15], a[80:83], v[240:243]
buffer_load_dwordx4 v16, s[48:51], s32 offen offset:2048 sc1 lds
v_mfma_f32_16x16x32_bf16 v[244:247], a[12:15], a[88:91], v[244:247]
ds_read_b64_tr_b16 a[80:81], v14 offset:8192
v_mfma_f32_16x16x32_bf16 v[244:247], a[28:31], a[92:95], v[244:247]
ds_read_b64_tr_b16 a[82:83], v14 offset:8448
v_mfma_f32_16x16x32_bf16 v[236:239], a[24:27], a[92:95], v[236:239]
ds_read_b64_tr_b16 a[84:85], v14 offset:10240
v_mfma_f32_16x16x32_bf16 v[236:239], a[8:11], a[88:91], v[236:239]
ds_read_b64_tr_b16 a[86:87], v14 offset:10496
v_mfma_f32_16x16x32_bf16 v[228:231], a[4:7], a[88:91], v[228:231]
v_mfma_f32_16x16x32_bf16 v[228:231], a[20:23], a[92:95], v[228:231]
v_mfma_f32_16x16x32_bf16 v[220:223], a[16:19], a[92:95], v[220:223]
buffer_load_dwordx4 v16, s[48:51], s32 offen offset:3072 sc1 lds
v_mfma_f32_16x16x32_bf16 v[220:223], a[0:3], a[88:91], v[220:223]
s_waitcnt lgkmcnt(4)
L_S23:
v_mfma_f32_16x16x32_bf16 v[184:187], a[96:99], a[32:35], v[184:187]
ds_read_b64_tr_b16 a[88:89], v15 offset:8192
v_mov_b32 v8, v19
v_mov_b32 v9, 0xf149f2ca
v_mfma_f32_16x16x32_bf16 v[184:187], a[100:103], a[48:51], v[184:187]
ds_read_b64_tr_b16 a[90:91], v15 offset:8448
v_mov_b32 v248, 0xffff
v_mfma_f32_16x16x32_bf16 v[192:195], a[100:103], a[52:55], v[192:195]
ds_read_b64_tr_b16 a[92:93], v15 offset:10240
v_mov_b32 v249, 0xffff0000
v_mfma_f32_16x16x32_bf16 v[192:195], a[96:99], a[36:39], v[192:195]
ds_read_b64_tr_b16 a[94:95], v15 offset:10496
v_cndmask_b32 v252, 0, v248, s[56:57]
v_mfma_f32_16x16x32_bf16 v[200:203], a[96:99], a[40:43], v[200:203]
s_add_u32 m0, s19, 0x9000
v_cndmask_b32 v252, v252, v249, s[58:59]
v_cndmask_b32 v253, 0, v248, s[60:61]
v_cndmask_b32 v253, v253, v249, s[62:63]
v_mfma_f32_16x16x32_bf16 v[200:203], a[100:103], a[56:59], v[200:203]
buffer_load_dwordx4 v16, s[48:51], s7 offen offset:0 sc1 lds
v_mfma_f32_16x16x32_bf16 v[208:211], a[100:103], a[60:63], v[208:211]
v_cndmask_b32 v254, 0, v248, s[68:69]
v_cndmask_b32 v254, v254, v249, s[70:71]
v_mfma_f32_16x16x32_bf16 v[208:211], a[96:99], a[44:47], v[208:211]
v_cndmask_b32 v255, 0, v248, s[76:77]
v_cndmask_b32 v255, v255, v249, s[78:79]
v_mfma_f32_16x16x32_bf16 v[212:215], a[104:107], a[44:47], v[212:215]
ds_read_b64_tr_b16 a[96:97], v14 offset:0
v_cndmask_b32 v248, v9, 0, s[68:69]
v_cndmask_b32 v249, v9, 0, s[70:71]
v_mfma_f32_16x16x32_bf16 v[212:215], a[108:111], a[60:63], v[212:215]
ds_read_b64_tr_b16 a[98:99], v14 offset:256
v_cndmask_b32 v250, v9, 0, s[76:77]
v_mfma_f32_16x16x32_bf16 v[204:207], a[108:111], a[56:59], v[204:207]
ds_read_b64_tr_b16 a[100:101], v14 offset:2048
v_cndmask_b32 v251, v9, 0, s[78:79]
v_mfma_f32_16x16x32_bf16 v[204:207], a[104:107], a[40:43], v[204:207]
buffer_load_dwordx4 v16, s[48:51], s7 offen offset:1024 sc1 lds
v_mfma_f32_16x16x32_bf16 v[196:199], a[104:107], a[36:39], v[196:199]
ds_read_b64_tr_b16 a[102:103], v14 offset:2304
v_mfma_f32_16x16x32_bf16 v[196:199], a[108:111], a[52:55], v[196:199]
v_mfma_f32_16x16x32_bf16 v[188:191], a[108:111], a[48:51], v[188:191]
v_mfma_f32_16x16x32_bf16 v[188:191], a[104:107], a[32:35], v[188:191]
s_waitcnt lgkmcnt(4)
v_mfma_f32_16x16x32_bf16 v[216:219], a[32:35], a[80:83], v[216:219]
ds_read_b64_tr_b16 a[104:105], v15 offset:0
v_mfma_f32_16x16x32_bf16 v[216:219], a[48:51], a[84:87], v[216:219]
ds_read_b64_tr_b16 a[106:107], v15 offset:256
v_mfma_f32_16x16x32_bf16 v[224:227], a[52:55], a[84:87], v[224:227]
buffer_load_dwordx4 v16, s[48:51], s7 offen offset:2048 sc1 lds
v_mfma_f32_16x16x32_bf16 v[224:227], a[36:39], a[80:83], v[224:227]
ds_read_b64_tr_b16 a[108:109], v15 offset:2048
v_cvt_pk_bf16_f32 v192, v192, v193
v_mfma_f32_16x16x32_bf16 v[232:235], a[40:43], a[80:83], v[232:235]
ds_read_b64_tr_b16 a[110:111], v15 offset:2304
v_cvt_pk_bf16_f32 v193, v194, v195
v_cvt_pk_bf16_f32 v194, v196, v197
v_mfma_f32_16x16x32_bf16 v[232:235], a[56:59], a[84:87], v[232:235]
v_cvt_pk_bf16_f32 v195, v198, v199
v_cvt_pk_bf16_f32 v208, v208, v209
v_mfma_f32_16x16x32_bf16 v[240:243], a[60:63], a[84:87], v[240:243]
v_cvt_pk_bf16_f32 v209, v210, v211
v_cvt_pk_bf16_f32 v210, v212, v213
v_mfma_f32_16x16x32_bf16 v[240:243], a[44:47], a[80:83], v[240:243]
v_cvt_pk_bf16_f32 v211, v214, v215
v_mfma_f32_16x16x32_bf16 v[244:247], a[44:47], a[88:91], v[244:247]
ds_read_b64_tr_b16 a[80:81], v12 offset:0
v_mfma_f32_16x16x32_bf16 v[244:247], a[60:63], a[92:95], v[244:247]
buffer_load_dwordx4 v16, s[48:51], s7 offen offset:3072 sc1 lds
v_mfma_f32_16x16x32_bf16 v[236:239], a[56:59], a[92:95], v[236:239]
ds_read_b64_tr_b16 a[82:83], v12 offset:1024
s_add_u32 s32, s32, 0x8000
v_mfma_f32_16x16x32_bf16 v[236:239], a[40:43], a[88:91], v[236:239]
ds_read_b64_tr_b16 a[84:85], v12 offset:8192
s_add_u32 s7, s7, 0x8000
v_mfma_f32_16x16x32_bf16 v[228:231], a[36:39], a[88:91], v[228:231]
ds_read_b64_tr_b16 a[86:87], v12 offset:9216
v_mfma_f32_16x16x32_bf16 v[228:231], a[52:55], a[92:95], v[228:231]
s_cmp_lg_u32 s4, 0
s_cbranch_scc1 L_hx0
buffer_store_dwordx4 v[192:195], v22, s[88:91], 0 offen offset:0 sc1
buffer_store_dwordx4 v[208:211], v7, s[88:91], 0 offen offset:0 sc1
L_hx0:
v_mfma_f32_16x16x32_bf16 v[220:223], a[48:51], a[92:95], v[220:223]
v_cvt_pk_bf16_f32 v184, v184, v185
v_cvt_pk_bf16_f32 v185, v186, v187
v_mfma_f32_16x16x32_bf16 v[220:223], a[32:35], a[88:91], v[220:223]
s_waitcnt lgkmcnt(4)
v_cvt_pk_bf16_f32 v186, v188, v189
v_cvt_pk_bf16_f32 v187, v190, v191
v_mfma_f32_16x16x32_bf16 v[152:155], a[96:99], a[32:35], v[152:155]
ds_read_b64_tr_b16 a[88:89], v13 offset:0
v_cvt_pk_bf16_f32 v200, v200, v201
v_cvt_pk_bf16_f32 v201, v202, v203
v_mfma_f32_16x16x32_bf16 v[152:155], a[100:103], a[48:51], v[152:155]
ds_read_b64_tr_b16 a[90:91], v13 offset:1024
v_cvt_pk_bf16_f32 v202, v204, v205
v_mfma_f32_16x16x32_bf16 v[160:163], a[100:103], a[52:55], v[160:163]
ds_read_b64_tr_b16 a[92:93], v13 offset:8192
v_cvt_pk_bf16_f32 v203, v206, v207
v_mfma_f32_16x16x32_bf16 v[160:163], a[96:99], a[36:39], v[160:163]
ds_read_b64_tr_b16 a[94:95], v13 offset:9216
v_mfma_f32_16x16x32_bf16 v[168:171], a[96:99], a[40:43], v[168:171]
ds_write_b128 v5, v[192:195] offset:2048
v_mfma_f32_16x16x32_bf16 v[168:171], a[100:103], a[56:59], v[168:171]
ds_write_b128 v5, v[208:211] offset:18432
v_mfma_f32_16x16x32_bf16 v[176:179], a[100:103], a[60:63], v[176:179]
ds_write_b128 v4, v[184:187] offset:2048
v_mfma_f32_16x16x32_bf16 v[176:179], a[96:99], a[44:47], v[176:179]
ds_write_b128 v4, v[200:203] offset:18432
v_mfma_f32_16x16x32_bf16 v[180:183], a[104:107], a[44:47], v[180:183]
ds_read_b64_tr_b16 a[96:97], v12 offset:256
v_cvt_pk_bf16_f32 v231, v230, v231
v_cvt_pk_bf16_f32 v230, v228, v229
v_mfma_f32_16x16x32_bf16 v[180:183], a[108:111], a[60:63], v[180:183]
ds_read_b64_tr_b16 a[98:99], v12 offset:1280
v_cvt_pk_bf16_f32 v228, v224, v225
v_mfma_f32_16x16x32_bf16 v[172:175], a[108:111], a[56:59], v[172:175]
ds_read_b64_tr_b16 a[100:101], v12 offset:8448
v_cvt_pk_bf16_f32 v229, v226, v227
v_mfma_f32_16x16x32_bf16 v[172:175], a[104:107], a[40:43], v[172:175]
ds_read_b64_tr_b16 a[102:103], v12 offset:9472
v_cvt_pk_bf16_f32 v227, v226, v227
v_mfma_f32_16x16x32_bf16 v[164:167], a[104:107], a[36:39], v[164:167]
v_cvt_pk_bf16_f32 v226, v224, v225
v_cvt_pk_bf16_f32 v247, v246, v247
v_cvt_pk_bf16_f32 v246, v244, v245
v_mfma_f32_16x16x32_bf16 v[164:167], a[108:111], a[52:55], v[164:167]
v_cvt_pk_bf16_f32 v244, v240, v241
v_cvt_pk_bf16_f32 v245, v242, v243
v_mfma_f32_16x16x32_bf16 v[156:159], a[108:111], a[48:51], v[156:159]
v_cvt_pk_bf16_f32 v243, v242, v243
v_cvt_pk_bf16_f32 v242, v240, v241
v_mfma_f32_16x16x32_bf16 v[156:159], a[104:107], a[32:35], v[156:159]
s_waitcnt lgkmcnt(4)
v_mfma_f32_16x16x32_bf16 v[24:27], a[80:83], a[32:35], v[24:27]
ds_read_b64_tr_b16 a[104:105], v13 offset:256
v_mfma_f32_16x16x32_bf16 v[24:27], a[84:87], a[48:51], v[24:27]
ds_read_b64_tr_b16 a[106:107], v13 offset:1280
v_mfma_f32_16x16x32_bf16 v[32:35], a[84:87], a[52:55], v[32:35]
ds_read_b64_tr_b16 a[108:109], v13 offset:8448
v_mfma_f32_16x16x32_bf16 v[32:35], a[80:83], a[36:39], v[32:35]
ds_read_b64_tr_b16 a[110:111], v13 offset:9472
v_mfma_f32_16x16x32_bf16 v[40:43], a[80:83], a[40:43], v[40:43]
s_cmp_lg_u32 s4, 0
s_cbranch_scc1 L_hx1
buffer_store_dwordx4 v[228:231], v22, s[88:91], 0 offen offset:1024 sc1
buffer_store_dwordx4 v[244:247], v7, s[88:91], 0 offen offset:1024 sc1
L_hx1:
v_mfma_f32_16x16x32_bf16 v[40:43], a[84:87], a[56:59], v[40:43]
v_cvt_pk_bf16_f32 v223, v222, v223
v_cvt_pk_bf16_f32 v222, v220, v221
v_mfma_f32_16x16x32_bf16 v[48:51], a[84:87], a[60:63], v[48:51]
v_cvt_pk_bf16_f32 v220, v216, v217
v_cvt_pk_bf16_f32 v221, v218, v219
v_mfma_f32_16x16x32_bf16 v[48:51], a[80:83], a[44:47], v[48:51]
v_cvt_pk_bf16_f32 v219, v218, v219
v_cvt_pk_bf16_f32 v218, v216, v217
v_mfma_f32_16x16x32_bf16 v[52:55], a[88:91], a[44:47], v[52:55]
ds_read_b64_tr_b16 a[80:81], v12 offset:512
v_cvt_pk_bf16_f32 v239, v238, v239
v_cvt_pk_bf16_f32 v238, v236, v237
v_mfma_f32_16x16x32_bf16 v[52:55], a[92:95], a[60:63], v[52:55]
ds_read_b64_tr_b16 a[82:83], v12 offset:1536
v_cvt_pk_bf16_f32 v236, v232, v233
v_mfma_f32_16x16x32_bf16 v[44:47], a[92:95], a[56:59], v[44:47]
ds_read_b64_tr_b16 a[84:85], v12 offset:8704
v_cvt_pk_bf16_f32 v237, v234, v235
v_mfma_f32_16x16x32_bf16 v[44:47], a[88:91], a[40:43], v[44:47]
ds_read_b64_tr_b16 a[86:87], v12 offset:9728
v_cvt_pk_bf16_f32 v235, v234, v235
v_mfma_f32_16x16x32_bf16 v[36:39], a[88:91], a[36:39], v[36:39]
v_cvt_pk_bf16_f32 v234, v232, v233
v_mfma_f32_16x16x32_bf16 v[36:39], a[92:95], a[52:55], v[36:39]
ds_write_b128 v5, v[228:231] offset:3072
v_mfma_f32_16x16x32_bf16 v[28:31], a[92:95], a[48:51], v[28:31]
ds_write_b128 v5, v[244:247] offset:19456
v_mfma_f32_16x16x32_bf16 v[28:31], a[88:91], a[32:35], v[28:31]
s_waitcnt lgkmcnt(4)
v_mfma_f32_16x16x32_bf16 v[56:59], a[96:99], a[32:35], v[56:59]
ds_read_b64_tr_b16 a[88:89], v13 offset:512
v_mfma_f32_16x16x32_bf16 v[56:59], a[100:103], a[48:51], v[56:59]
ds_read_b64_tr_b16 a[90:91], v13 offset:1536
v_mfma_f32_16x16x32_bf16 v[64:67], a[100:103], a[52:55], v[64:67]
ds_read_b64_tr_b16 a[92:93], v13 offset:8704
v_mfma_f32_16x16x32_bf16 v[64:67], a[96:99], a[36:39], v[64:67]
ds_read_b64_tr_b16 a[94:95], v13 offset:9728
v_mfma_f32_16x16x32_bf16 v[72:75], a[96:99], a[40:43], v[72:75]
ds_write_b128 v4, v[220:223] offset:3072
v_mfma_f32_16x16x32_bf16 v[72:75], a[100:103], a[56:59], v[72:75]
ds_write_b128 v4, v[236:239] offset:19456
v_mfma_f32_16x16x32_bf16 v[80:83], a[100:103], a[60:63], v[80:83]
v_cvt_pk_bf16_f32 v152, v152, v153
v_cvt_pk_bf16_f32 v153, v154, v155
v_mfma_f32_16x16x32_bf16 v[80:83], a[96:99], a[44:47], v[80:83]
v_cvt_pk_bf16_f32 v154, v156, v157
v_cvt_pk_bf16_f32 v155, v158, v159
v_mfma_f32_16x16x32_bf16 v[84:87], a[104:107], a[44:47], v[84:87]
ds_read_b64_tr_b16 a[96:97], v12 offset:768
v_cvt_pk_bf16_f32 v160, v160, v161
v_cvt_pk_bf16_f32 v161, v162, v163
v_mfma_f32_16x16x32_bf16 v[84:87], a[108:111], a[60:63], v[84:87]
ds_read_b64_tr_b16 a[98:99], v12 offset:1792
v_cvt_pk_bf16_f32 v162, v164, v165
v_mfma_f32_16x16x32_bf16 v[76:79], a[108:111], a[56:59], v[76:79]
ds_read_b64_tr_b16 a[100:101], v12 offset:8960
v_cvt_pk_bf16_f32 v163, v166, v167
v_mfma_f32_16x16x32_bf16 v[76:79], a[104:107], a[40:43], v[76:79]
ds_read_b64_tr_b16 a[102:103], v12 offset:9984
v_cvt_pk_bf16_f32 v168, v168, v169
v_mfma_f32_16x16x32_bf16 v[68:71], a[104:107], a[36:39], v[68:71]
v_cvt_pk_bf16_f32 v169, v170, v171
v_cvt_pk_bf16_f32 v170, v172, v173
v_cvt_pk_bf16_f32 v171, v174, v175
v_mfma_f32_16x16x32_bf16 v[68:71], a[108:111], a[52:55], v[68:71]
v_cvt_pk_bf16_f32 v176, v176, v177
v_cvt_pk_bf16_f32 v177, v178, v179
v_mfma_f32_16x16x32_bf16 v[60:63], a[108:111], a[48:51], v[60:63]
v_cvt_pk_bf16_f32 v178, v180, v181
v_cvt_pk_bf16_f32 v179, v182, v183
v_mfma_f32_16x16x32_bf16 v[60:63], a[104:107], a[32:35], v[60:63]
s_waitcnt lgkmcnt(4)
v_mfma_f32_16x16x32_bf16 v[88:91], a[80:83], a[32:35], v[88:91]
ds_read_b64_tr_b16 a[104:105], v13 offset:768
v_mfma_f32_16x16x32_bf16 v[88:91], a[84:87], a[48:51], v[88:91]
ds_read_b64_tr_b16 a[106:107], v13 offset:1792
v_mfma_f32_16x16x32_bf16 v[96:99], a[84:87], a[52:55], v[96:99]
ds_read_b64_tr_b16 a[108:109], v13 offset:8960
v_mfma_f32_16x16x32_bf16 v[96:99], a[80:83], a[36:39], v[96:99]
ds_read_b64_tr_b16 a[110:111], v13 offset:9984
v_mfma_f32_16x16x32_bf16 v[104:107], a[80:83], a[40:43], v[104:107]
v_mfma_f32_16x16x32_bf16 v[104:107], a[84:87], a[56:59], v[104:107]
v_mfma_f32_16x16x32_bf16 v[112:115], a[84:87], a[60:63], v[112:115]
v_mfma_f32_16x16x32_bf16 v[112:115], a[80:83], a[44:47], v[112:115]
v_mfma_f32_16x16x32_bf16 v[116:119], a[88:91], a[44:47], v[116:119]
v_mfma_f32_16x16x32_bf16 v[116:119], a[92:95], a[60:63], v[116:119]
v_mfma_f32_16x16x32_bf16 v[108:111], a[92:95], a[56:59], v[108:111]
v_mfma_f32_16x16x32_bf16 v[108:111], a[88:91], a[40:43], v[108:111]
v_mov_b32 v15, s6
v_xor_b32 v15, 0, v15
v_mfma_f32_16x16x32_bf16 v[100:103], a[88:91], a[36:39], v[100:103]
v_writelane_b32 v15, s18, 0
v_lshlrev_b32 v15, 2, v15
v_bfe_u32 v12, v0, 2, 2
v_mfma_f32_16x16x32_bf16 v[100:103], a[92:95], a[52:55], v[100:103]
v_lshlrev_b32 v12, 11, v12
v_lshrrev_b32 v13, 4, v0
v_mfma_f32_16x16x32_bf16 v[92:95], a[92:95], a[48:51], v[92:95]
v_lshl_add_u32 v12, v13, 6, v12
v_and_b32 v13, 3, v0
v_mfma_f32_16x16x32_bf16 v[92:95], a[88:91], a[32:35], v[92:95]
s_waitcnt lgkmcnt(0)
v_lshl_add_u32 v12, v13, 4, v12
v_xor_b32 v12, s13, v12
v_mfma_f32_16x16x32_bf16 v[120:123], a[96:99], a[32:35], v[120:123]
L_padA12:
s_cmp_eq_u32 s95, 1
s_cbranch_scc1 L_hopA_ret
v_xor_b32 v13, 32, v12
v_add_u32 v13, 7168, v13
v_mul_f32 v24, s52, v24
v_mfma_f32_16x16x32_bf16 v[120:123], a[100:103], a[48:51], v[120:123]
v_mul_f32 v25, s52, v25
v_mul_f32 v26, s52, v26
v_mfma_f32_16x16x32_bf16 v[128:131], a[100:103], a[52:55], v[128:131]
v_mul_f32 v27, s52, v27
v_mul_f32 v28, s52, v28
v_mfma_f32_16x16x32_bf16 v[128:131], a[96:99], a[36:39], v[128:131]
v_mul_f32 v29, s52, v29
v_mul_f32 v30, s52, v30
v_mfma_f32_16x16x32_bf16 v[136:139], a[96:99], a[40:43], v[136:139]
v_mul_f32 v31, s52, v31
v_cvt_pk_bf16_f32 v24, v24, v25
v_cvt_pk_bf16_f32 v25, v26, v27
v_mfma_f32_16x16x32_bf16 v[136:139], a[100:103], a[56:59], v[136:139]
v_cvt_pk_bf16_f32 v26, v28, v29
v_cvt_pk_bf16_f32 v27, v30, v31
v_mfma_f32_16x16x32_bf16 v[144:147], a[100:103], a[60:63], v[144:147]
v_accvgpr_write_b32 a160, v24
v_accvgpr_write_b32 a161, v25
v_mfma_f32_16x16x32_bf16 v[144:147], a[96:99], a[44:47], v[144:147]
v_accvgpr_write_b32 a162, v26
v_accvgpr_write_b32 a163, v27
v_mfma_f32_16x16x32_bf16 v[148:151], a[104:107], a[44:47], v[148:151]
v_mul_f32 v32, s52, v32
v_mul_f32 v33, s52, v33
v_mul_f32 v34, s52, v34
v_mfma_f32_16x16x32_bf16 v[148:151], a[108:111], a[60:63], v[148:151]
v_mul_f32 v35, s52, v35
v_mul_f32 v36, s52, v36
v_mfma_f32_16x16x32_bf16 v[140:143], a[108:111], a[56:59], v[140:143]
v_mul_f32 v37, s52, v37
v_mul_f32 v38, s52, v38
v_mfma_f32_16x16x32_bf16 v[140:143], a[104:107], a[40:43], v[140:143]
v_mul_f32 v39, s52, v39
v_cvt_pk_bf16_f32 v32, v32, v33
v_mfma_f32_16x16x32_bf16 v[132:135], a[104:107], a[36:39], v[132:135]
v_cvt_pk_bf16_f32 v33, v34, v35
v_cvt_pk_bf16_f32 v34, v36, v37
v_cvt_pk_bf16_f32 v35, v38, v39
v_mfma_f32_16x16x32_bf16 v[132:135], a[108:111], a[52:55], v[132:135]
v_accvgpr_write_b32 a176, v32
v_accvgpr_write_b32 a177, v33
v_mfma_f32_16x16x32_bf16 v[124:127], a[108:111], a[48:51], v[124:127]
v_accvgpr_write_b32 a178, v34
v_accvgpr_write_b32 a179, v35
v_mfma_f32_16x16x32_bf16 v[124:127], a[104:107], a[32:35], v[124:127]
L_trans:
s_waitcnt vmcnt(17) lgkmcnt(0)
s_barrier
s_cmp_eq_u32 s4, 0
s_cbranch_scc1 L_hx_ld
ds_read_b128 v[188:191], v4 offset:0
ds_read_b64 v[216:217], v4 offset:1024
ds_read_b64 v[220:221], v4 offset:1032
ds_read_b128 v[204:207], v4 offset:16384
ds_read_b64 v[232:233], v4 offset:17408
ds_read_b64 v[236:237], v4 offset:17416
s_branch L_hx_rd
L_hx_ld:
buffer_load_dwordx4 v[188:191], v10, s[88:91], 0 offen sc1
buffer_load_dwordx2 v[216:217], v10, s[88:91], 0 offen offset:1024 sc1
buffer_load_dwordx2 v[220:221], v10, s[88:91], 0 offen offset:1032 sc1
buffer_load_dwordx4 v[204:207], v11, s[88:91], 0 offen sc1
buffer_load_dwordx2 v[232:233], v11, s[88:91], 0 offen offset:1024 sc1
buffer_load_dwordx2 v[236:237], v11, s[88:91], 0 offen offset:1032 sc1
L_hx_rd:
ds_read_b128 v[196:199], v6 offset:0
ds_read_b64 v[224:225], v6 offset:1024
ds_read_b64 v[228:229], v6 offset:1032
ds_read_b128 v[212:215], v6 offset:16384
ds_read_b64 v[240:241], v6 offset:17408
ds_read_b64 v[244:245], v6 offset:17416
ds_read_b128 a[0:3], v1 offset:8192
ds_read_b128 a[4:7], v1 offset:9216
ds_read_b128 a[8:11], v1 offset:10240
ds_read_b128 a[12:15], v1 offset:11264
ds_read_b128 a[16:19], v1 offset:12288
ds_read_b128 a[20:23], v1 offset:13312
ds_read_b128 a[24:27], v1 offset:14336
ds_read_b128 a[28:31], v1 offset:15360
L_hopB:
s_mov_b32 s95, 0
v_pk_mul_f32 v[40:41], v[40:41], s[52:53]
v_pk_mul_f32 v[42:43], v[42:43], s[52:53]
v_pk_mul_f32 v[44:45], v[44:45], s[52:53]
v_pk_mul_f32 v[46:47], v[46:47], s[52:53]
v_cvt_pk_bf16_f32 v40, v40, v41
v_cvt_pk_bf16_f32 v41, v42, v43
v_cvt_pk_bf16_f32 v42, v44, v45
v_cvt_pk_bf16_f32 v43, v46, v47
v_accvgpr_write_b32 a192, v40
v_accvgpr_write_b32 a193, v41
v_accvgpr_write_b32 a194, v42
v_accvgpr_write_b32 a195, v43
v_pk_mul_f32 v[48:49], v[48:49], s[52:53]
v_pk_mul_f32 v[50:51], v[50:51], s[52:53]
v_pk_mul_f32 v[52:53], v[52:53], s[52:53]
v_pk_mul_f32 v[54:55], v[54:55], s[52:53]
v_cvt_pk_bf16_f32 v48, v48, v49
v_cvt_pk_bf16_f32 v49, v50, v51
v_cvt_pk_bf16_f32 v50, v52, v53
v_cvt_pk_bf16_f32 v51, v54, v55
v_accvgpr_write_b32 a208, v48
v_accvgpr_write_b32 a209, v49
v_accvgpr_write_b32 a210, v50
v_accvgpr_write_b32 a211, v51
v_mov_b32 v47, s55
v_cndmask_b32 v36, v9, 0, s[56:57]
v_min_f32 v32, s55, v36
v_cndmask_b32 v44, v47, 0, s[36:37]
v_cndmask_b32 v37, v9, 0, s[58:59]
v_min_f32 v33, s55, v37
v_cndmask_b32 v45, v47, 0, s[38:39]
v_cndmask_b32 v38, v9, 0, s[60:61]
v_min_f32 v34, s55, v38
v_cndmask_b32 v46, v47, 0, s[40:41]
v_cndmask_b32 v39, v9, 0, s[62:63]
v_min_f32 v35, s55, v39
v_cndmask_b32 v47, v47, 0, s[42:43]
v_pk_mul_f32 v[56:57], v[56:57], s[52:53]
v_pk_mul_f32 v[58:59], v[58:59], s[52:53]
v_pk_mul_f32 v[60:61], v[60:61], s[52:53]
v_pk_mul_f32 v[62:63], v[62:63], s[52:53]
v_cvt_pk_bf16_f32 v56, v56, v57
v_cvt_pk_bf16_f32 v57, v58, v59
v_cvt_pk_bf16_f32 v58, v60, v61
v_cvt_pk_bf16_f32 v59, v62, v63
v_accvgpr_write_b32 a164, v56
v_accvgpr_write_b32 a165, v57
v_accvgpr_write_b32 a166, v58
v_accvgpr_write_b32 a167, v59
v_pk_mul_f32 v[64:65], v[64:65], s[52:53]
v_pk_mul_f32 v[66:67], v[66:67], s[52:53]
v_pk_mul_f32 v[68:69], v[68:69], s[52:53]
v_pk_mul_f32 v[70:71], v[70:71], s[52:53]
v_cvt_pk_bf16_f32 v64, v64, v65
v_cvt_pk_bf16_f32 v65, v66, v67
v_cvt_pk_bf16_f32 v66, v68, v69
v_cvt_pk_bf16_f32 v67, v70, v71
v_accvgpr_write_b32 a180, v64
v_accvgpr_write_b32 a181, v65
v_accvgpr_write_b32 a182, v66
v_accvgpr_write_b32 a183, v67
v_pk_mul_f32 v[72:73], v[72:73], s[52:53]
v_pk_mul_f32 v[74:75], v[74:75], s[52:53]
v_pk_mul_f32 v[76:77], v[76:77], s[52:53]
v_pk_mul_f32 v[78:79], v[78:79], s[52:53]
v_cvt_pk_bf16_f32 v72, v72, v73
v_cvt_pk_bf16_f32 v73, v74, v75
v_cvt_pk_bf16_f32 v74, v76, v77
v_cvt_pk_bf16_f32 v75, v78, v79
v_accvgpr_write_b32 a196, v72
v_accvgpr_write_b32 a197, v73
v_accvgpr_write_b32 a198, v74
v_accvgpr_write_b32 a199, v75
v_pk_mul_f32 v[80:81], v[80:81], s[52:53]
v_pk_mul_f32 v[82:83], v[82:83], s[52:53]
v_pk_mul_f32 v[84:85], v[84:85], s[52:53]
v_pk_mul_f32 v[86:87], v[86:87], s[52:53]
v_cvt_pk_bf16_f32 v80, v80, v81
v_cvt_pk_bf16_f32 v81, v82, v83
v_cvt_pk_bf16_f32 v82, v84, v85
v_cvt_pk_bf16_f32 v83, v86, v87
v_accvgpr_write_b32 a212, v80
v_accvgpr_write_b32 a213, v81
v_accvgpr_write_b32 a214, v82
v_accvgpr_write_b32 a215, v83
v_pk_mul_f32 v[88:89], v[88:89], s[52:53]
v_pk_mul_f32 v[90:91], v[90:91], s[52:53]
v_pk_mul_f32 v[92:93], v[92:93], s[52:53]
v_pk_mul_f32 v[94:95], v[94:95], s[52:53]
v_cvt_pk_bf16_f32 v88, v88, v89
v_cvt_pk_bf16_f32 v89, v90, v91
v_cvt_pk_bf16_f32 v90, v92, v93
v_cvt_pk_bf16_f32 v91, v94, v95
v_accvgpr_write_b32 a168, v88
v_accvgpr_write_b32 a169, v89
v_accvgpr_write_b32 a170, v90
v_accvgpr_write_b32 a171, v91
v_pk_mul_f32 v[96:97], v[96:97], s[52:53]
v_pk_mul_f32 v[98:99], v[98:99], s[52:53]
v_pk_mul_f32 v[100:101], v[100:101], s[52:53]
v_pk_mul_f32 v[102:103], v[102:103], s[52:53]
v_cvt_pk_bf16_f32 v96, v96, v97
v_cvt_pk_bf16_f32 v97, v98, v99
v_cvt_pk_bf16_f32 v98, v100, v101
v_cvt_pk_bf16_f32 v99, v102, v103
v_accvgpr_write_b32 a184, v96
v_accvgpr_write_b32 a185, v97
v_accvgpr_write_b32 a186, v98
v_accvgpr_write_b32 a187, v99
v_pk_mul_f32 v[104:105], v[104:105], s[52:53]
v_pk_mul_f32 v[106:107], v[106:107], s[52:53]
v_pk_mul_f32 v[108:109], v[108:109], s[52:53]
v_pk_mul_f32 v[110:111], v[110:111], s[52:53]
v_cvt_pk_bf16_f32 v104, v104, v105
v_cvt_pk_bf16_f32 v105, v106, v107
v_cvt_pk_bf16_f32 v106, v108, v109
v_cvt_pk_bf16_f32 v107, v110, v111
v_accvgpr_write_b32 a200, v104
v_accvgpr_write_b32 a201, v105
v_accvgpr_write_b32 a202, v106
v_accvgpr_write_b32 a203, v107
v_pk_mul_f32 v[112:113], v[112:113], s[52:53]
v_pk_mul_f32 v[114:115], v[114:115], s[52:53]
v_pk_mul_f32 v[116:117], v[116:117], s[52:53]
v_pk_mul_f32 v[118:119], v[118:119], s[52:53]
v_cvt_pk_bf16_f32 v112, v112, v113
v_cvt_pk_bf16_f32 v113, v114, v115
v_cvt_pk_bf16_f32 v114, v116, v117
v_cvt_pk_bf16_f32 v115, v118, v119
v_accvgpr_write_b32 a216, v112
v_accvgpr_write_b32 a217, v113
v_accvgpr_write_b32 a218, v114
v_accvgpr_write_b32 a219, v115
v_pk_mul_f32 v[120:121], v[120:121], s[52:53]
v_pk_mul_f32 v[122:123], v[122:123], s[52:53]
v_pk_mul_f32 v[124:125], v[124:125], s[52:53]
v_pk_mul_f32 v[126:127], v[126:127], s[52:53]
v_cvt_pk_bf16_f32 v120, v120, v121
v_cvt_pk_bf16_f32 v121, v122, v123
v_cvt_pk_bf16_f32 v122, v124, v125
v_cvt_pk_bf16_f32 v123, v126, v127
v_accvgpr_write_b32 a172, v120
v_accvgpr_write_b32 a173, v121
v_accvgpr_write_b32 a174, v122
v_accvgpr_write_b32 a175, v123
v_pk_mul_f32 v[128:129], v[128:129], s[52:53]
v_pk_mul_f32 v[130:131], v[130:131], s[52:53]
v_pk_mul_f32 v[132:133], v[132:133], s[52:53]
v_pk_mul_f32 v[134:135], v[134:135], s[52:53]
v_cvt_pk_bf16_f32 v128, v128, v129
v_cvt_pk_bf16_f32 v129, v130, v131
v_cvt_pk_bf16_f32 v130, v132, v133
v_cvt_pk_bf16_f32 v131, v134, v135
v_accvgpr_write_b32 a188, v128
v_accvgpr_write_b32 a189, v129
v_accvgpr_write_b32 a190, v130
v_accvgpr_write_b32 a191, v131
v_pk_mul_f32 v[136:137], v[136:137], s[52:53]
v_pk_mul_f32 v[138:139], v[138:139], s[52:53]
v_pk_mul_f32 v[140:141], v[140:141], s[52:53]
v_pk_mul_f32 v[142:143], v[142:143], s[52:53]
v_cvt_pk_bf16_f32 v136, v136, v137
v_cvt_pk_bf16_f32 v137, v138, v139
v_cvt_pk_bf16_f32 v138, v140, v141
v_cvt_pk_bf16_f32 v139, v142, v143
v_accvgpr_write_b32 a204, v136
v_accvgpr_write_b32 a205, v137
v_accvgpr_write_b32 a206, v138
v_accvgpr_write_b32 a207, v139
v_pk_mul_f32 v[144:145], v[144:145], s[52:53]
v_pk_mul_f32 v[146:147], v[146:147], s[52:53]
v_pk_mul_f32 v[148:149], v[148:149], s[52:53]
v_pk_mul_f32 v[150:151], v[150:151], s[52:53]
v_cvt_pk_bf16_f32 v144, v144, v145
v_cvt_pk_bf16_f32 v145, v146, v147
v_cvt_pk_bf16_f32 v146, v148, v149
v_cvt_pk_bf16_f32 v147, v150, v151
v_accvgpr_write_b32 a220, v144
v_accvgpr_write_b32 a221, v145
v_accvgpr_write_b32 a222, v146
v_accvgpr_write_b32 a223, v147
s_cmp_lg_u32 s4, 0
s_cbranch_scc1 L_spun_hx
s_mov_b32 s92, 200000
L_spin_hx:
s_waitcnt vmcnt(0)
v_max3_u32 v128, v188, v189, 0
v_max3_u32 v128, v190, v191, v128
v_max3_u32 v128, v216, v217, v128
v_max3_u32 v128, v220, v221, v128
v_max3_u32 v128, v204, v205, v128
v_max3_u32 v128, v206, v207, v128
v_max3_u32 v128, v232, v233, v128
v_max3_u32 v128, v236, v237, v128
v_cmp_eq_u32 vcc, -1, v128
s_sub_u32 s92, s92, 1
s_cbranch_scc1 L_spun_hx
s_nop 3
s_cbranch_vccz L_spun_hx
s_sleep 2
buffer_load_dwordx4 v[188:191], v10, s[88:91], 0 offen sc1
buffer_load_dwordx2 v[216:217], v10, s[88:91], 0 offen offset:1024 sc1
buffer_load_dwordx2 v[220:221], v10, s[88:91], 0 offen offset:1032 sc1
buffer_load_dwordx4 v[204:207], v11, s[88:91], 0 offen sc1
buffer_load_dwordx2 v[232:233], v11, s[88:91], 0 offen offset:1024 sc1
buffer_load_dwordx2 v[236:237], v11, s[88:91], 0 offen offset:1032 sc1
s_branch L_spin_hx
L_spun_hx:
s_waitcnt lgkmcnt(0)
s_barrier
v_mfma_f32_16x16x32_bf16 v[52:55], v[184:187], v[152:155], v[248:251]
v_mov_b32 v140, 0
v_mov_b32 v141, 0
v_mfma_f32_16x16x32_bf16 v[48:51], v[188:191], v[152:155], v[32:35]
v_mov_b32 v142, 0
v_mov_b32 v143, 0
v_mfma_f32_16x16x32_bf16 v[60:63], v[192:195], v[160:163], v[248:251]
v_mov_b32 v144, 0
v_mov_b32 v145, 0
v_mfma_f32_16x16x32_bf16 v[56:59], v[196:199], v[160:163], v[36:39]
v_mov_b32 v146, 0
v_mov_b32 v147, 0
v_mfma_f32_16x16x32_bf16 v[68:71], v[200:203], v[168:171], v[248:251]
v_mov_b32 v148, 0
v_mov_b32 v149, 0
v_mfma_f32_16x16x32_bf16 v[64:67], v[204:207], v[168:171], v[36:39]
v_max3_f32 v52, v48, v49, v52
v_max3_f32 v54, v50, v51, v54
v_mfma_f32_16x16x32_bf16 v[76:79], v[208:211], v[176:179], v[248:251]
v_max_f32 v52, v52, v53
v_max_f32 v53, v54, v55
v_mfma_f32_16x16x32_bf16 v[72:75], v[212:215], v[176:179], v[36:39]
v_max_f32 v136, v52, v53
v_max3_f32 v60, v56, v57, v60
v_mfma_f32_16x16x32_bf16 v[16:19], a[0:3], a[160:163], v[44:47]
v_max3_f32 v62, v58, v59, v62
v_max_f32 v60, v60, v61
v_mfma_f32_16x16x32_bf16 v[16:19], a[4:7], a[164:167], v[16:19]
v_max_f32 v61, v62, v63
v_max_f32 v137, v60, v61
v_mfma_f32_16x16x32_bf16 v[16:19], a[8:11], a[168:171], v[16:19]
v_max3_f32 v68, v64, v65, v68
v_max3_f32 v70, v66, v67, v70
v_mfma_f32_16x16x32_bf16 v[16:19], a[12:15], a[172:175], v[16:19]
v_max_f32 v68, v68, v69
v_max_f32 v69, v70, v71
v_mfma_f32_16x16x32_bf16 v[20:23], a[0:3], a[176:179], 0
v_max_f32 v138, v68, v69
v_max3_f32 v76, v72, v73, v76
v_mfma_f32_16x16x32_bf16 v[20:23], a[4:7], a[180:183], v[20:23]
v_max3_f32 v78, v74, v75, v78
v_max_f32 v76, v76, v77
v_mfma_f32_16x16x32_bf16 v[20:23], a[8:11], a[184:187], v[20:23]
v_max_f32 v77, v78, v79
v_max_f32 v139, v76, v77
v_mfma_f32_16x16x32_bf16 v[20:23], a[12:15], a[188:191], v[20:23]
v_mov_b32 v150, 0
v_mov_b32 v151, 0
v_mfma_f32_16x16x32_bf16 v[24:27], a[0:3], a[192:195], 0
v_mov_b32 v248, 0
v_mov_b32 v249, 0
v_mfma_f32_16x16x32_bf16 v[24:27], a[4:7], a[196:199], v[24:27]
v_mov_b32 v250, 0
v_mov_b32 v251, 0
v_mfma_f32_16x16x32_bf16 v[24:27], a[8:11], a[200:203], v[24:27]
v_max3_f32 v80, v16, v17, v18
v_max_f32 v80, v80, v19
v_mfma_f32_16x16x32_bf16 v[24:27], a[12:15], a[204:207], v[24:27]
v_max3_f32 v84, v20, v21, v22
v_max_f32 v84, v84, v23
v_mfma_f32_16x16x32_bf16 v[28:31], a[0:3], a[208:211], 0
v_mov_b32 v128, v136
v_mov_b32 v129, v137
v_mfma_f32_16x16x32_bf16 v[28:31], a[4:7], a[212:215], v[28:31]
v_mov_b32 v130, v138
v_mov_b32 v131, v139
v_mfma_f32_16x16x32_bf16 v[28:31], a[8:11], a[216:219], v[28:31]
v_permlane16_swap_b32 v128, v136
v_permlane16_swap_b32 v129, v137
v_mfma_f32_16x16x32_bf16 v[28:31], a[12:15], a[220:223], v[28:31]
v_permlane16_swap_b32 v130, v138
v_permlane16_swap_b32 v131, v139
v_max_f32 v136, v136, v128
v_max_f32 v137, v137, v129
v_max_f32 v138, v138, v130
v_max_f32 v139, v139, v131
v_max3_f32 v88, v24, v25, v26
v_max_f32 v88, v88, v27
v_mov_b32 v128, v136
v_mov_b32 v129, v137
v_mov_b32 v130, v138
v_mov_b32 v131, v139
v_max3_f32 v92, v28, v29, v30
v_max_f32 v92, v92, v31
v_permlane32_swap_b32 v128, v136
v_permlane32_swap_b32 v129, v137
v_permlane32_swap_b32 v130, v138
v_permlane32_swap_b32 v131, v139
v_max_f32 v136, v136, v128
v_max_f32 v137, v137, v129
v_max_f32 v138, v138, v130
v_max_f32 v139, v139, v131
v_mul_f32 v136, s54, v136
v_mul_f32 v137, s54, v137
v_mul_f32 v138, s54, v138
v_mul_f32 v139, s54, v139
v_fma_f32 v52, v52, s54, -v136
v_fma_f32 v53, v53, s54, -v136
v_fma_f32 v60, v60, s54, -v137
v_fma_f32 v61, v61, s54, -v137
v_fma_f32 v68, v68, s54, -v138
v_fma_f32 v69, v69, s54, -v138
v_fma_f32 v76, v76, s54, -v139
v_fma_f32 v77, v77, s54, -v139
v_exp_f32 v52, v52
v_exp_f32 v53, v53
v_exp_f32 v60, v60
v_exp_f32 v61, v61
v_exp_f32 v68, v68
v_exp_f32 v69, v69
v_exp_f32 v76, v76
v_exp_f32 v77, v77
v_cvt_pk_bf16_f32 v52, v52, v52
v_cvt_pk_bf16_f32 v53, v53, v53
v_cvt_pk_bf16_f32 v60, v60, v60
v_cvt_pk_bf16_f32 v61, v61, v61
v_cvt_pk_bf16_f32 v68, v68, v68
v_cvt_pk_bf16_f32 v69, v69, v69
v_cvt_pk_bf16_f32 v76, v76, v76
v_cvt_pk_bf16_f32 v77, v77, v77
v_and_b32 v48, v252, v52
v_and_b32 v49, v253, v53
v_and_b32 v50, v254, v52
v_and_b32 v51, v255, v53
v_and_b32 v56, v252, v60
v_and_b32 v57, v253, v61
v_and_b32 v58, v254, v60
v_and_b32 v59, v255, v61
v_and_b32 v64, v252, v68
v_and_b32 v65, v253, v69
v_and_b32 v66, v254, v68
v_and_b32 v67, v255, v69
v_and_b32 v72, v252, v76
v_and_b32 v73, v253, v77
v_and_b32 v74, v254, v76
v_and_b32 v75, v255, v77
v_mfma_f32_16x16x32_bf16 v[156:159], a[240:243], v[48:51], 0
v_mov_b32 v128, v80
v_mov_b32 v129, v84
v_mfma_f32_16x16x32_bf16 v[164:167], a[240:243], v[56:59], 0
v_mov_b32 v130, v88
v_mov_b32 v131, v92
v_mfma_f32_16x16x32_bf16 v[172:175], a[240:243], v[64:67], 0
v_permlane16_swap_b32 v128, v80
v_permlane16_swap_b32 v129, v84
v_mfma_f32_16x16x32_bf16 v[180:183], a[240:243], v[72:75], 0
v_permlane16_swap_b32 v130, v88
v_permlane16_swap_b32 v131, v92
v_mfma_f32_16x16x32_bf16 v[184:187], v[216:219], v[48:51], 0
v_max_f32 v80, v80, v128
v_max_f32 v84, v84, v129
v_mfma_f32_16x16x32_bf16 v[188:191], v[220:223], v[48:51], 0
v_max_f32 v88, v88, v130
v_max_f32 v92, v92, v131
v_mfma_f32_16x16x32_bf16 v[192:195], v[224:227], v[56:59], 0
v_mov_b32 v128, v80
v_mov_b32 v129, v84
v_mfma_f32_16x16x32_bf16 v[196:199], v[228:231], v[56:59], 0
v_mov_b32 v130, v88
v_mov_b32 v131, v92
v_mfma_f32_16x16x32_bf16 v[200:203], v[232:235], v[64:67], 0
v_permlane32_swap_b32 v128, v80
v_permlane32_swap_b32 v129, v84
v_mfma_f32_16x16x32_bf16 v[204:207], v[236:239], v[64:67], 0
v_permlane32_swap_b32 v130, v88
v_permlane32_swap_b32 v131, v92
v_mfma_f32_16x16x32_bf16 v[208:211], v[240:243], v[72:75], 0
v_max_f32 v80, v80, v128
v_max_f32 v84, v84, v129
v_mfma_f32_16x16x32_bf16 v[212:215], v[244:247], v[72:75], 0
v_max_f32 v88, v88, v130
v_max_f32 v92, v92, v131
v_rcp_f32 v128, v156
v_rcp_f32 v130, v164
v_rcp_f32 v132, v172
v_rcp_f32 v134, v180
v_sub_f32 v83, 0, v80
v_sub_f32 v82, 0, v80
v_sub_f32 v81, 0, v80
v_sub_f32 v80, 0, v80
v_sub_f32 v87, 0, v84
v_sub_f32 v86, 0, v84
v_sub_f32 v85, 0, v84
v_sub_f32 v84, 0, v84
v_sub_f32 v91, 0, v88
v_sub_f32 v90, 0, v88
v_sub_f32 v89, 0, v88
v_sub_f32 v88, 0, v88
v_sub_f32 v95, 0, v92
v_pk_mul_f32 v[184:185], v[184:185], v[128:129] op_sel_hi:[1,0]
v_pk_mul_f32 v[186:187], v[186:187], v[128:129] op_sel_hi:[1,0]
v_pk_mul_f32 v[188:189], v[188:189], v[128:129] op_sel_hi:[1,0]
v_pk_mul_f32 v[190:191], v[190:191], v[128:129] op_sel_hi:[1,0]
v_pk_mul_f32 v[192:193], v[192:193], v[130:131] op_sel_hi:[1,0]
v_pk_mul_f32 v[194:195], v[194:195], v[130:131] op_sel_hi:[1,0]
v_pk_mul_f32 v[196:197], v[196:197], v[130:131] op_sel_hi:[1,0]
v_pk_mul_f32 v[198:199], v[198:199], v[130:131] op_sel_hi:[1,0]
v_pk_mul_f32 v[200:201], v[200:201], v[132:133] op_sel_hi:[1,0]
v_pk_mul_f32 v[202:203], v[202:203], v[132:133] op_sel_hi:[1,0]
v_pk_mul_f32 v[204:205], v[204:205], v[132:133] op_sel_hi:[1,0]
v_pk_mul_f32 v[206:207], v[206:207], v[132:133] op_sel_hi:[1,0]
v_pk_mul_f32 v[208:209], v[208:209], v[134:135] op_sel_hi:[1,0]
v_pk_mul_f32 v[210:211], v[210:211], v[134:135] op_sel_hi:[1,0]
v_pk_mul_f32 v[212:213], v[212:213], v[134:135] op_sel_hi:[1,0]
v_pk_mul_f32 v[214:215], v[214:215], v[134:135] op_sel_hi:[1,0]
v_cvt_pk_bf16_f32 v32, v184, v185
v_cvt_pk_bf16_f32 v33, v186, v187
v_cvt_pk_bf16_f32 v34, v188, v189
v_cvt_pk_bf16_f32 v35, v190, v191
v_cvt_pk_bf16_f32 v36, v192, v193
v_cvt_pk_bf16_f32 v37, v194, v195
v_cvt_pk_bf16_f32 v38, v196, v197
v_cvt_pk_bf16_f32 v39, v198, v199
v_cvt_pk_bf16_f32 v40, v200, v201
v_cvt_pk_bf16_f32 v41, v202, v203
v_cvt_pk_bf16_f32 v42, v204, v205
v_cvt_pk_bf16_f32 v43, v206, v207
v_cvt_pk_bf16_f32 v44, v208, v209
v_cvt_pk_bf16_f32 v45, v210, v211
v_cvt_pk_bf16_f32 v46, v212, v213
v_cvt_pk_bf16_f32 v47, v214, v215
buffer_store_dwordx4 v[32:35], v3, s[88:91], s44 offen sc1
v_sub_f32 v94, 0, v92
v_sub_f32 v93, 0, v92
v_sub_f32 v92, 0, v92
v_min_f32 v103, s10, v80
v_cndmask_b32 v96, v103, v80, s[36:37]
v_cndmask_b32 v97, v103, v80, s[38:39]
v_cndmask_b32 v98, v103, v80, s[40:41]
v_cndmask_b32 v99, v103, v80, s[42:43]
v_cndmask_b32 v100, v9, v103, s[36:37]
v_cndmask_b32 v101, v9, v103, s[38:39]
v_cndmask_b32 v102, v9, v103, s[40:41]
v_cndmask_b32 v103, v9, v103, s[42:43]
v_min_f32 v111, s11, v84
v_cndmask_b32 v104, v111, v84, s[36:37]
v_cndmask_b32 v105, v111, v84, s[38:39]
v_cndmask_b32 v106, v111, v84, s[40:41]
v_cndmask_b32 v107, v111, v84, s[42:43]
v_cndmask_b32 v108, v9, v111, s[36:37]
v_cndmask_b32 v109, v9, v111, s[38:39]
buffer_store_dwordx4 v[36:39], v3, s[88:91], s45 offen sc1
v_cndmask_b32 v110, v9, v111, s[40:41]
v_cndmask_b32 v111, v9, v111, s[42:43]
v_and_b32 v9, 1, v0
v_mul_u32_u24 v9, 0xaaaa, v9
v_add_u32 v9, 0x4444, v9
v_mov_b64 v[128:129], 0
v_mov_b64 v[130:131], 0
v_mov_b64 v[132:133], 0
v_mov_b64 v[134:135], 0
v_mov_b64 v[136:137], 0
v_mov_b64 v[138:139], 0
v_mov_b64 v[152:153], 0
v_mov_b64 v[154:155], 0
v_mov_b64 v[156:157], 0
v_mov_b64 v[158:159], 0
v_mov_b64 v[160:161], 0
v_mov_b64 v[162:163], 0
v_mov_b64 v[164:165], 0
v_mov_b64 v[166:167], 0
buffer_store_dwordx4 v[40:43], v3, s[88:91], s46 offen sc1
v_mov_b64 v[168:169], 0
v_mov_b64 v[170:171], 0
v_mov_b64 v[172:173], 0
v_mov_b64 v[174:175], 0
v_mov_b64 v[176:177], 0
v_mov_b64 v[178:179], 0
v_mov_b64 v[180:181], 0
v_mov_b64 v[182:183], 0
v_mov_b64 v[184:185], 0
v_mov_b64 v[186:187], 0
v_mov_b64 v[188:189], 0
v_mov_b64 v[190:191], 0
v_mov_b64 v[192:193], 0
v_mov_b64 v[194:195], 0
v_mov_b64 v[196:197], 0
v_mov_b64 v[198:199], 0
v_mov_b64 v[200:201], 0
v_mov_b64 v[202:203], 0
v_mov_b64 v[204:205], 0
buffer_store_dwordx4 v[44:47], v3, s[88:91], s47 offen sc1
v_mov_b64 v[206:207], 0
v_mov_b64 v[208:209], 0
v_mov_b64 v[210:211], 0
v_mov_b64 v[212:213], 0
v_mov_b64 v[214:215], 0
v_mov_b64 v[216:217], 0
v_mov_b64 v[218:219], 0
v_mov_b64 v[220:221], 0
v_mov_b64 v[222:223], 0
v_mov_b64 v[224:225], 0
v_mov_b64 v[226:227], 0
v_mov_b64 v[228:229], 0
v_mov_b64 v[230:231], 0
v_mov_b64 v[232:233], 0
v_mov_b64 v[234:235], 0
v_mov_b64 v[236:237], 0
v_mov_b64 v[238:239], 0
v_mov_b64 v[252:253], 0
v_mov_b64 v[254:255], 0
L_att_start:
s_mov_b32 s15, s6
s_cmp_eq_u32 s6, 0
s_cbranch_scc1 L_att_j0
v_mfma_f32_16x16x32_bf16 v[16:19], a[0:3], a[160:163], v[80:83]
ds_read_b128 a[128:131], v1 offset:24576
v_mov_b32 v240, 0
v_mfma_f32_16x16x32_bf16 v[16:19], a[4:7], a[164:167], v[16:19]
ds_read_b128 a[132:135], v1 offset:25600
v_mov_b32 v241, 0
v_mfma_f32_16x16x32_bf16 v[16:19], a[8:11], a[168:171], v[16:19]
ds_read_b128 a[136:139], v1 offset:26624
s_add_u32 m0, s27, 0x0
v_mfma_f32_16x16x32_bf16 v[16:19], a[12:15], a[172:175], v[16:19]
buffer_load_dwordx4 v3, s[48:51], s32 offen offset:0 sc1 lds
v_mfma_f32_16x16x32_bf16 v[20:23], a[0:3], a[176:179], v[84:87]
ds_read_b128 a[140:143], v1 offset:27648
v_mov_b32 v242, 0
v_mfma_f32_16x16x32_bf16 v[20:23], a[4:7], a[180:183], v[20:23]
ds_read_b128 a[144:147], v1 offset:28672
v_mov_b32 v243, 0
v_mfma_f32_16x16x32_bf16 v[20:23], a[8:11], a[184:187], v[20:23]
ds_read_b128 a[148:151], v1 offset:29696
v_mov_b32 v244, 0
v_mfma_f32_16x16x32_bf16 v[20:23], a[12:15], a[188:191], v[20:23]
ds_read_b128 a[152:155], v1 offset:30720
v_mov_b32 v245, 0
v_mfma_f32_16x16x32_bf16 v[24:27], a[0:3], a[192:195], v[88:91]
ds_read_b128 a[156:159], v1 offset:31744
v_exp_f32 v16, v16
v_mfma_f32_16x16x32_bf16 v[24:27], a[4:7], a[196:199], v[24:27]
v_exp_f32 v17, v17
v_mfma_f32_16x16x32_bf16 v[24:27], a[8:11], a[200:203], v[24:27]
buffer_load_dwordx4 v3, s[48:51], s32 offen offset:1024 sc1 lds
v_mfma_f32_16x16x32_bf16 v[24:27], a[12:15], a[204:207], v[24:27]
v_exp_f32 v18, v18
v_mfma_f32_16x16x32_bf16 v[28:31], a[0:3], a[208:211], v[92:95]
v_exp_f32 v19, v19
v_mfma_f32_16x16x32_bf16 v[28:31], a[4:7], a[212:215], v[28:31]
v_exp_f32 v20, v20
v_mfma_f32_16x16x32_bf16 v[28:31], a[8:11], a[216:219], v[28:31]
v_cvt_pk_bf16_f32 v48, v16, v17
v_cvt_pk_bf16_f32 v49, v18, v19
v_mfma_f32_16x16x32_bf16 v[28:31], a[12:15], a[220:223], v[28:31]
v_exp_f32 v21, v21
v_mfma_f32_16x16x32_bf16 v[32:35], a[16:19], a[160:163], v[80:83]
v_exp_f32 v22, v22
v_mfma_f32_16x16x32_bf16 v[32:35], a[20:23], a[164:167], v[32:35]
v_exp_f32 v23, v23
v_mfma_f32_16x16x32_bf16 v[32:35], a[24:27], a[168:171], v[32:35]
buffer_load_dwordx4 v3, s[48:51], s32 offen offset:2048 sc1 lds
v_mfma_f32_16x16x32_bf16 v[32:35], a[28:31], a[172:175], v[32:35]
v_exp_f32 v24, v24
v_mfma_f32_16x16x32_bf16 v[36:39], a[16:19], a[176:179], v[84:87]
v_exp_f32 v25, v25
v_mfma_f32_16x16x32_bf16 v[36:39], a[20:23], a[180:183], v[36:39]
v_cvt_pk_bf16_f32 v52, v20, v21
v_cvt_pk_bf16_f32 v53, v22, v23
v_mfma_f32_16x16x32_bf16 v[36:39], a[24:27], a[184:187], v[36:39]
v_exp_f32 v26, v26
v_mfma_f32_16x16x32_bf16 v[36:39], a[28:31], a[188:191], v[36:39]
v_exp_f32 v27, v27
v_mfma_f32_16x16x32_bf16 v[40:43], a[16:19], a[192:195], v[88:91]
v_exp_f32 v28, v28
v_mfma_f32_16x16x32_bf16 v[40:43], a[20:23], a[196:199], v[40:43]
buffer_load_dwordx4 v3, s[48:51], s32 offen offset:3072 sc1 lds
v_mfma_f32_16x16x32_bf16 v[40:43], a[24:27], a[200:203], v[40:43]
s_add_u32 s32, s32, 0x8000
v_exp_f32 v29, v29
v_mfma_f32_16x16x32_bf16 v[40:43], a[28:31], a[204:207], v[40:43]
v_exp_f32 v30, v30
v_mfma_f32_16x16x32_bf16 v[44:47], a[16:19], a[208:211], v[92:95]
v_exp_f32 v31, v31
v_mfma_f32_16x16x32_bf16 v[44:47], a[20:23], a[212:215], v[44:47]
v_exp_f32 v32, v32
v_mfma_f32_16x16x32_bf16 v[44:47], a[24:27], a[216:219], v[44:47]
v_exp_f32 v33, v33
v_mfma_f32_16x16x32_bf16 v[44:47], a[28:31], a[220:223], v[44:47]
s_waitcnt lgkmcnt(0)
v_cvt_pk_bf16_f32 v56, v24, v25
v_cvt_pk_bf16_f32 v57, v26, v27
v_mov_b32 v246, 0
v_mov_b32 v247, 0
v_mfma_f32_16x16x32_bf16 v[16:19], a[128:131], a[160:163], v[80:83]
ds_read_b128 a[32:35], v1 offset:16384
v_cvt_pk_bf16_f32 v60, v28, v29
v_mfma_f32_16x16x32_bf16 v[16:19], a[132:135], a[164:167], v[16:19]
v_exp_f32 v34, v34
v_mfma_f32_16x16x32_bf16 v[16:19], a[136:139], a[168:171], v[16:19]
s_add_u32 m0, s27, 0x1000
v_exp_f32 v35, v35
v_mfma_f32_16x16x32_bf16 v[16:19], a[140:143], a[172:175], v[16:19]
buffer_load_dwordx4 v3, s[48:51], s7 offen offset:0 sc1 lds
v_mfma_f32_16x16x32_bf16 v[20:23], a[128:131], a[176:179], v[84:87]
ds_read_b128 a[36:39], v1 offset:17408
v_cvt_pk_bf16_f32 v61, v30, v31
v_mfma_f32_16x16x32_bf16 v[20:23], a[132:135], a[180:183], v[20:23]
v_exp_f32 v36, v36
v_mfma_f32_16x16x32_bf16 v[20:23], a[136:139], a[184:187], v[20:23]
ds_read_b128 a[40:43], v1 offset:18432
v_cvt_pk_bf16_f32 v50, v32, v33
v_mfma_f32_16x16x32_bf16 v[20:23], a[140:143], a[188:191], v[20:23]
v_exp_f32 v37, v37
v_mfma_f32_16x16x32_bf16 v[24:27], a[128:131], a[192:195], v[88:91]
v_exp_f32 v38, v38
v_mfma_f32_16x16x32_bf16 v[24:27], a[132:135], a[196:199], v[24:27]
ds_read_b128 a[44:47], v1 offset:19456
v_cvt_pk_bf16_f32 v51, v34, v35
v_mfma_f32_16x16x32_bf16 v[24:27], a[136:139], a[200:203], v[24:27]
buffer_load_dwordx4 v3, s[48:51], s7 offen offset:1024 sc1 lds
v_mfma_f32_16x16x32_bf16 v[24:27], a[140:143], a[204:207], v[24:27]
v_exp_f32 v39, v39
v_mfma_f32_16x16x32_bf16 v[28:31], a[128:131], a[208:211], v[92:95]
v_exp_f32 v40, v40
v_mfma_f32_16x16x32_bf16 v[28:31], a[132:135], a[212:215], v[28:31]
ds_read_b128 a[48:51], v1 offset:20480
v_cvt_pk_bf16_f32 v54, v36, v37
v_mfma_f32_16x16x32_bf16 v[28:31], a[136:139], a[216:219], v[28:31]
v_exp_f32 v41, v41
v_mfma_f32_16x16x32_bf16 v[28:31], a[140:143], a[220:223], v[28:31]
v_exp_f32 v42, v42
v_mfma_f32_16x16x32_bf16 v[32:35], a[144:147], a[160:163], v[80:83]
buffer_load_dwordx4 v3, s[48:51], s7 offen offset:2048 sc1 lds
v_mfma_f32_16x16x32_bf16 v[32:35], a[148:151], a[164:167], v[32:35]
ds_read_b128 a[52:55], v1 offset:21504
v_cvt_pk_bf16_f32 v55, v38, v39
v_mfma_f32_16x16x32_bf16 v[32:35], a[152:155], a[168:171], v[32:35]
v_exp_f32 v43, v43
v_mfma_f32_16x16x32_bf16 v[32:35], a[156:159], a[172:175], v[32:35]
ds_read_b128 a[56:59], v1 offset:22528
v_cvt_pk_bf16_f32 v58, v40, v41
v_mfma_f32_16x16x32_bf16 v[36:39], a[144:147], a[176:179], v[84:87]
v_exp_f32 v44, v44
v_mfma_f32_16x16x32_bf16 v[36:39], a[148:151], a[180:183], v[36:39]
v_exp_f32 v45, v45
v_mfma_f32_16x16x32_bf16 v[36:39], a[152:155], a[184:187], v[36:39]
ds_read_b128 a[60:63], v1 offset:23552
v_xor_b32 v1, 0x8000, v1
v_mfma_f32_16x16x32_bf16 v[36:39], a[156:159], a[188:191], v[36:39]
buffer_load_dwordx4 v3, s[48:51], s7 offen offset:3072 sc1 lds
v_cvt_pk_bf16_f32 v59, v42, v43
v_mfma_f32_16x16x32_bf16 v[40:43], a[144:147], a[192:195], v[88:91]
s_add_u32 s7, s7, 0x8000
v_exp_f32 v46, v46
v_mfma_f32_16x16x32_bf16 v[40:43], a[148:151], a[196:199], v[40:43]
s_xor_b32 s27, s27, 0x38000
v_exp_f32 v47, v47
v_mfma_f32_16x16x32_bf16 v[40:43], a[152:155], a[200:203], v[40:43]
v_exp_f32 v16, v16
v_mfma_f32_16x16x32_bf16 v[40:43], a[156:159], a[204:207], v[40:43]
v_exp_f32 v17, v17
v_cvt_pk_bf16_f32 v62, v44, v45
v_cvt_pk_bf16_f32 v63, v46, v47
v_mfma_f32_16x16x32_bf16 v[44:47], a[144:147], a[208:211], v[92:95]
v_exp_f32 v18, v18
v_mfma_f32_16x16x32_bf16 v[44:47], a[148:151], a[212:215], v[44:47]
v_exp_f32 v19, v19
v_mfma_f32_16x16x32_bf16 v[44:47], a[152:155], a[216:219], v[44:47]
s_waitcnt vmcnt(8) lgkmcnt(0)
v_exp_f32 v20, v20
v_mfma_f32_16x16x32_bf16 v[44:47], a[156:159], a[220:223], v[44:47]
s_barrier
v_cvt_pk_bf16_f32 v64, v16, v17
v_exp_f32 v21, v21
v_exp_f32 v22, v22
v_exp_f32 v23, v23
v_exp_f32 v24, v24
v_exp_f32 v25, v25
v_exp_f32 v26, v26
v_exp_f32 v27, v27
v_cvt_pk_bf16_f32 v65, v18, v19
v_cvt_pk_bf16_f32 v68, v20, v21
v_cvt_pk_bf16_f32 v69, v22, v23
s_cmp_lg_u32 s33, 0
s_cbranch_scc1 L_sig_bd
s_lshl_b32 s8, s6, 2
s_add_u32 s8, s8, 192
s_cmp_lg_u32 s4, 0
s_cbranch_scc1 L_sig_bd
v_mov_b32 v4, 1
s_mov_b64 exec, 1
buffer_atomic_add v4, off, s[84:87], s8 sc1
s_mov_b64 exec, -1
L_sig_bd:
s_getreg_b32 s8, hwreg(HW_REG_HW_ID, 5, 1)
s_cmp_lg_u32 s8, 0
s_cbranch_scc1 L_att_dodd1
s_branch L_att_dodd0
L_att_deven0:
v_mfma_f32_16x16x32_bf16 v[128:131], a[32:35], v[48:51], v[128:131]
ds_read_b128 a[0:3], v1 offset:8192
v_cvt_pk_bf16_f32 v72, v24, v25
v_mfma_f32_16x16x32_bf16 v[160:163], a[32:35], v[52:55], v[160:163]
v_exp_f32 v28, v28
v_mfma_f32_16x16x32_bf16 v[192:195], a[32:35], v[56:59], v[192:195]
v_cvt_pk_bf16_f32 v73, v26, v27
v_mfma_f32_16x16x32_bf16 v[224:227], a[32:35], v[60:63], v[224:227]
ds_read_b128 a[4:7], v1 offset:9216
v_mfma_f32_16x16x32_bf16 v[228:231], a[36:39], v[60:63], v[228:231]
v_exp_f32 v29, v29
v_mfma_f32_16x16x32_bf16 v[196:199], a[36:39], v[56:59], v[196:199]
v_exp_f32 v30, v30
v_mfma_f32_16x16x32_bf16 v[164:167], a[36:39], v[52:55], v[164:167]
s_add_u32 m0, s27, 0x0
v_cvt_pk_bf16_f32 v76, v28, v29
v_mfma_f32_16x16x32_bf16 v[132:135], a[36:39], v[48:51], v[132:135]
buffer_load_dwordx4 v3, s[48:51], s32 offen offset:0 sc1 lds
v_mfma_f32_16x16x32_bf16 v[136:139], a[40:43], v[48:51], v[136:139]
ds_read_b128 a[8:11], v1 offset:10240
v_mfma_f32_16x16x32_bf16 v[168:171], a[40:43], v[52:55], v[168:171]
v_exp_f32 v31, v31
v_mfma_f32_16x16x32_bf16 v[200:203], a[40:43], v[56:59], v[200:203]
v_exp_f32 v32, v32
v_mfma_f32_16x16x32_bf16 v[232:235], a[40:43], v[60:63], v[232:235]
ds_read_b128 a[12:15], v1 offset:11264
v_cvt_pk_bf16_f32 v77, v30, v31
v_mfma_f32_16x16x32_bf16 v[236:239], a[44:47], v[60:63], v[236:239]
v_mfma_f32_16x16x32_bf16 v[204:207], a[44:47], v[56:59], v[204:207]
v_exp_f32 v33, v33
v_mfma_f32_16x16x32_bf16 v[172:175], a[44:47], v[52:55], v[172:175]
v_exp_f32 v34, v34
v_mfma_f32_16x16x32_bf16 v[140:143], a[44:47], v[48:51], v[140:143]
ds_read_b128 a[16:19], v1 offset:12288
v_cvt_pk_bf16_f32 v66, v32, v33
v_mfma_f32_16x16x32_bf16 v[144:147], a[48:51], v[48:51], v[144:147]
v_mfma_f32_16x16x32_bf16 v[176:179], a[48:51], v[52:55], v[176:179]
v_exp_f32 v35, v35
v_mfma_f32_16x16x32_bf16 v[208:211], a[48:51], v[56:59], v[208:211]
v_exp_f32 v36, v36
v_mfma_f32_16x16x32_bf16 v[240:243], a[48:51], v[60:63], v[240:243]
ds_read_b128 a[20:23], v1 offset:13312
v_cvt_pk_bf16_f32 v67, v34, v35
v_mfma_f32_16x16x32_bf16 v[244:247], a[52:55], v[60:63], v[244:247]
v_exp_f32 v37, v37
v_mfma_f32_16x16x32_bf16 v[212:215], a[52:55], v[56:59], v[212:215]
v_cvt_pk_bf16_f32 v70, v36, v37
v_mfma_f32_16x16x32_bf16 v[180:183], a[52:55], v[52:55], v[180:183]
ds_read_b128 a[24:27], v1 offset:14336
v_mfma_f32_16x16x32_bf16 v[148:151], a[52:55], v[48:51], v[148:151]
buffer_load_dwordx4 v3, s[48:51], s32 offen offset:1024 sc1 lds
v_mfma_f32_16x16x32_bf16 v[152:155], a[56:59], v[48:51], v[152:155]
v_exp_f32 v38, v38
v_mfma_f32_16x16x32_bf16 v[184:187], a[56:59], v[52:55], v[184:187]
v_exp_f32 v39, v39
v_mfma_f32_16x16x32_bf16 v[216:219], a[56:59], v[56:59], v[216:219]
ds_read_b128 a[28:31], v1 offset:15360
v_cvt_pk_bf16_f32 v71, v38, v39
v_mfma_f32_16x16x32_bf16 v[248:251], a[56:59], v[60:63], v[248:251]
v_mfma_f32_16x16x32_bf16 v[252:255], a[60:63], v[60:63], v[252:255]
v_exp_f32 v40, v40
v_mfma_f32_16x16x32_bf16 v[220:223], a[60:63], v[56:59], v[220:223]
v_exp_f32 v41, v41
v_mfma_f32_16x16x32_bf16 v[188:191], a[60:63], v[52:55], v[188:191]
ds_read_b128 a[32:35], v1 offset:0
v_cvt_pk_bf16_f32 v74, v40, v41
v_mfma_f32_16x16x32_bf16 v[156:159], a[60:63], v[48:51], v[156:159]
v_smfmac_f32_16x16x64_bf16 a[224:227], a[232:235], v[48:55], v9
v_exp_f32 v42, v42
v_smfmac_f32_16x16x64_bf16 a[228:231], a[232:235], v[56:63], v9
s_waitcnt lgkmcnt(5)
v_exp_f32 v43, v43
v_mfma_f32_16x16x32_bf16 v[16:19], a[0:3], a[160:163], v[80:83]
ds_read_b128 a[36:39], v1 offset:1024
v_cvt_pk_bf16_f32 v75, v42, v43
v_mfma_f32_16x16x32_bf16 v[16:19], a[4:7], a[164:167], v[16:19]
v_exp_f32 v44, v44
v_mfma_f32_16x16x32_bf16 v[16:19], a[8:11], a[168:171], v[16:19]
v_mfma_f32_16x16x32_bf16 v[16:19], a[12:15], a[172:175], v[16:19]
v_exp_f32 v45, v45
v_mfma_f32_16x16x32_bf16 v[20:23], a[0:3], a[176:179], v[84:87]
ds_read_b128 a[40:43], v1 offset:2048
v_cvt_pk_bf16_f32 v78, v44, v45
v_mfma_f32_16x16x32_bf16 v[20:23], a[4:7], a[180:183], v[20:23]
buffer_load_dwordx4 v3, s[48:51], s32 offen offset:2048 sc1 lds
v_mfma_f32_16x16x32_bf16 v[20:23], a[8:11], a[184:187], v[20:23]
v_exp_f32 v46, v46
v_mfma_f32_16x16x32_bf16 v[20:23], a[12:15], a[188:191], v[20:23]
ds_read_b128 a[44:47], v1 offset:3072
v_mfma_f32_16x16x32_bf16 v[24:27], a[0:3], a[192:195], v[88:91]
v_mfma_f32_16x16x32_bf16 v[24:27], a[4:7], a[196:199], v[24:27]
v_exp_f32 v47, v47
v_mfma_f32_16x16x32_bf16 v[24:27], a[8:11], a[200:203], v[24:27]
v_exp_f32 v16, v16
v_mfma_f32_16x16x32_bf16 v[24:27], a[12:15], a[204:207], v[24:27]
ds_read_b128 a[48:51], v1 offset:4096
v_cvt_pk_bf16_f32 v79, v46, v47
v_mfma_f32_16x16x32_bf16 v[28:31], a[0:3], a[208:211], v[92:95]
v_mfma_f32_16x16x32_bf16 v[28:31], a[4:7], a[212:215], v[28:31]
v_exp_f32 v17, v17
v_mfma_f32_16x16x32_bf16 v[28:31], a[8:11], a[216:219], v[28:31]
s_waitcnt lgkmcnt(5)
v_exp_f32 v18, v18
v_mfma_f32_16x16x32_bf16 v[28:31], a[12:15], a[220:223], v[28:31]
ds_read_b128 a[52:55], v1 offset:5120
v_cvt_pk_bf16_f32 v48, v16, v17
v_mfma_f32_16x16x32_bf16 v[32:35], a[16:19], a[160:163], v[80:83]
v_mfma_f32_16x16x32_bf16 v[32:35], a[20:23], a[164:167], v[32:35]
v_exp_f32 v19, v19
v_mfma_f32_16x16x32_bf16 v[32:35], a[24:27], a[168:171], v[32:35]
v_exp_f32 v20, v20
v_mfma_f32_16x16x32_bf16 v[32:35], a[28:31], a[172:175], v[32:35]
ds_read_b128 a[56:59], v1 offset:6144
v_cvt_pk_bf16_f32 v49, v18, v19
v_mfma_f32_16x16x32_bf16 v[36:39], a[16:19], a[176:179], v[84:87]
v_exp_f32 v21, v21
v_mfma_f32_16x16x32_bf16 v[36:39], a[20:23], a[180:183], v[36:39]
buffer_load_dwordx4 v3, s[48:51], s32 offen offset:3072 sc1 lds
v_mfma_f32_16x16x32_bf16 v[36:39], a[24:27], a[184:187], v[36:39]
s_add_u32 s32, s32, 0x8000
v_cvt_pk_bf16_f32 v52, v20, v21
v_mfma_f32_16x16x32_bf16 v[36:39], a[28:31], a[188:191], v[36:39]
ds_read_b128 a[60:63], v1 offset:7168
v_mfma_f32_16x16x32_bf16 v[40:43], a[16:19], a[192:195], v[88:91]
v_exp_f32 v22, v22
v_mfma_f32_16x16x32_bf16 v[40:43], a[20:23], a[196:199], v[40:43]
v_exp_f32 v23, v23
v_mfma_f32_16x16x32_bf16 v[40:43], a[24:27], a[200:203], v[40:43]
v_cvt_pk_bf16_f32 v53, v22, v23
v_mfma_f32_16x16x32_bf16 v[40:43], a[28:31], a[204:207], v[40:43]
v_exp_f32 v24, v24
v_mfma_f32_16x16x32_bf16 v[44:47], a[16:19], a[208:211], v[92:95]
v_exp_f32 v25, v25
v_mfma_f32_16x16x32_bf16 v[44:47], a[20:23], a[212:215], v[44:47]
v_exp_f32 v26, v26
v_mfma_f32_16x16x32_bf16 v[44:47], a[24:27], a[216:219], v[44:47]
v_exp_f32 v27, v27
v_mfma_f32_16x16x32_bf16 v[44:47], a[28:31], a[220:223], v[44:47]
s_waitcnt lgkmcnt(0)
v_mfma_f32_16x16x32_bf16 v[128:131], a[32:35], v[64:67], v[128:131]
ds_read_b128 a[0:3], v1 offset:24576
v_cvt_pk_bf16_f32 v56, v24, v25
v_mfma_f32_16x16x32_bf16 v[160:163], a[32:35], v[68:71], v[160:163]
v_exp_f32 v28, v28
v_mfma_f32_16x16x32_bf16 v[192:195], a[32:35], v[72:75], v[192:195]
v_cvt_pk_bf16_f32 v57, v26, v27
v_mfma_f32_16x16x32_bf16 v[224:227], a[32:35], v[76:79], v[224:227]
ds_read_b128 a[4:7], v1 offset:25600
v_mfma_f32_16x16x32_bf16 v[228:231], a[36:39], v[76:79], v[228:231]
v_exp_f32 v29, v29
v_mfma_f32_16x16x32_bf16 v[196:199], a[36:39], v[72:75], v[196:199]
v_exp_f32 v30, v30
v_mfma_f32_16x16x32_bf16 v[164:167], a[36:39], v[68:71], v[164:167]
s_add_u32 m0, s27, 0x1000
v_cvt_pk_bf16_f32 v60, v28, v29
v_mfma_f32_16x16x32_bf16 v[132:135], a[36:39], v[64:67], v[132:135]
buffer_load_dwordx4 v3, s[48:51], s7 offen offset:0 sc1 lds
v_mfma_f32_16x16x32_bf16 v[136:139], a[40:43], v[64:67], v[136:139]
ds_read_b128 a[8:11], v1 offset:26624
v_mfma_f32_16x16x32_bf16 v[168:171], a[40:43], v[68:71], v[168:171]
v_exp_f32 v31, v31
v_mfma_f32_16x16x32_bf16 v[200:203], a[40:43], v[72:75], v[200:203]
v_exp_f32 v32, v32
v_mfma_f32_16x16x32_bf16 v[232:235], a[40:43], v[76:79], v[232:235]
ds_read_b128 a[12:15], v1 offset:27648
v_cvt_pk_bf16_f32 v61, v30, v31
v_mfma_f32_16x16x32_bf16 v[236:239], a[44:47], v[76:79], v[236:239]
v_mfma_f32_16x16x32_bf16 v[204:207], a[44:47], v[72:75], v[204:207]
v_exp_f32 v33, v33
v_mfma_f32_16x16x32_bf16 v[172:175], a[44:47], v[68:71], v[172:175]
v_exp_f32 v34, v34
v_mfma_f32_16x16x32_bf16 v[140:143], a[44:47], v[64:67], v[140:143]
ds_read_b128 a[16:19], v1 offset:28672
v_cvt_pk_bf16_f32 v50, v32, v33
v_mfma_f32_16x16x32_bf16 v[144:147], a[48:51], v[64:67], v[144:147]
v_mfma_f32_16x16x32_bf16 v[176:179], a[48:51], v[68:71], v[176:179]
v_exp_f32 v35, v35
v_mfma_f32_16x16x32_bf16 v[208:211], a[48:51], v[72:75], v[208:211]
ds_read_b128 a[20:23], v1 offset:29696
v_cvt_pk_bf16_f32 v51, v34, v35
v_mfma_f32_16x16x32_bf16 v[240:243], a[48:51], v[76:79], v[240:243]
v_exp_f32 v36, v36
v_mfma_f32_16x16x32_bf16 v[244:247], a[52:55], v[76:79], v[244:247]
v_exp_f32 v37, v37
v_mfma_f32_16x16x32_bf16 v[212:215], a[52:55], v[72:75], v[212:215]
v_cvt_pk_bf16_f32 v54, v36, v37
v_mfma_f32_16x16x32_bf16 v[180:183], a[52:55], v[68:71], v[180:183]
buffer_load_dwordx4 v3, s[48:51], s7 offen offset:1024 sc1 lds
v_mfma_f32_16x16x32_bf16 v[148:151], a[52:55], v[64:67], v[148:151]
ds_read_b128 a[24:27], v1 offset:30720
v_mfma_f32_16x16x32_bf16 v[152:155], a[56:59], v[64:67], v[152:155]
v_exp_f32 v38, v38
v_mfma_f32_16x16x32_bf16 v[184:187], a[56:59], v[68:71], v[184:187]
v_exp_f32 v39, v39
v_mfma_f32_16x16x32_bf16 v[216:219], a[56:59], v[72:75], v[216:219]
ds_read_b128 a[28:31], v1 offset:31744
v_cvt_pk_bf16_f32 v55, v38, v39
v_mfma_f32_16x16x32_bf16 v[248:251], a[56:59], v[76:79], v[248:251]
v_mfma_f32_16x16x32_bf16 v[252:255], a[60:63], v[76:79], v[252:255]
v_exp_f32 v40, v40
v_mfma_f32_16x16x32_bf16 v[220:223], a[60:63], v[72:75], v[220:223]
v_exp_f32 v41, v41
v_mfma_f32_16x16x32_bf16 v[188:191], a[60:63], v[68:71], v[188:191]
ds_read_b128 a[32:35], v1 offset:16384
v_cvt_pk_bf16_f32 v58, v40, v41
v_mfma_f32_16x16x32_bf16 v[156:159], a[60:63], v[64:67], v[156:159]
v_smfmac_f32_16x16x64_bf16 a[224:227], a[232:235], v[64:71], v9
s_waitcnt lgkmcnt(5)
v_exp_f32 v42, v42
v_smfmac_f32_16x16x64_bf16 a[228:231], a[232:235], v[72:79], v9
ds_read_b128 a[36:39], v1 offset:17408
v_mfma_f32_16x16x32_bf16 v[16:19], a[0:3], a[160:163], v[80:83]
v_exp_f32 v43, v43
v_mfma_f32_16x16x32_bf16 v[16:19], a[4:7], a[164:167], v[16:19]
v_exp_f32 v44, v44
v_mfma_f32_16x16x32_bf16 v[16:19], a[8:11], a[168:171], v[16:19]
v_cvt_pk_bf16_f32 v59, v42, v43
v_mfma_f32_16x16x32_bf16 v[16:19], a[12:15], a[172:175], v[16:19]
ds_read_b128 a[40:43], v1 offset:18432
v_mfma_f32_16x16x32_bf16 v[20:23], a[0:3], a[176:179], v[84:87]
buffer_load_dwordx4 v3, s[48:51], s7 offen offset:2048 sc1 lds
v_mfma_f32_16x16x32_bf16 v[20:23], a[4:7], a[180:183], v[20:23]
v_exp_f32 v45, v45
v_mfma_f32_16x16x32_bf16 v[20:23], a[8:11], a[184:187], v[20:23]
v_exp_f32 v46, v46
v_mfma_f32_16x16x32_bf16 v[20:23], a[12:15], a[188:191], v[20:23]
ds_read_b128 a[44:47], v1 offset:19456
v_cvt_pk_bf16_f32 v62, v44, v45
v_mfma_f32_16x16x32_bf16 v[24:27], a[0:3], a[192:195], v[88:91]
v_mfma_f32_16x16x32_bf16 v[24:27], a[4:7], a[196:199], v[24:27]
v_exp_f32 v47, v47
v_mfma_f32_16x16x32_bf16 v[24:27], a[8:11], a[200:203], v[24:27]
v_exp_f32 v16, v16
v_mfma_f32_16x16x32_bf16 v[24:27], a[12:15], a[204:207], v[24:27]
ds_read_b128 a[48:51], v1 offset:20480
v_cvt_pk_bf16_f32 v63, v46, v47
v_mfma_f32_16x16x32_bf16 v[28:31], a[0:3], a[208:211], v[92:95]
v_mfma_f32_16x16x32_bf16 v[28:31], a[4:7], a[212:215], v[28:31]
v_exp_f32 v17, v17
v_mfma_f32_16x16x32_bf16 v[28:31], a[8:11], a[216:219], v[28:31]
ds_read_b128 a[52:55], v1 offset:21504
v_cvt_pk_bf16_f32 v64, v16, v17
v_mfma_f32_16x16x32_bf16 v[28:31], a[12:15], a[220:223], v[28:31]
s_waitcnt lgkmcnt(6)
v_exp_f32 v18, v18
v_mfma_f32_16x16x32_bf16 v[32:35], a[16:19], a[160:163], v[80:83]
v_mfma_f32_16x16x32_bf16 v[32:35], a[20:23], a[164:167], v[32:35]
v_exp_f32 v19, v19
v_mfma_f32_16x16x32_bf16 v[32:35], a[24:27], a[168:171], v[32:35]
ds_read_b128 a[56:59], v1 offset:22528
v_cvt_pk_bf16_f32 v65, v18, v19
v_mfma_f32_16x16x32_bf16 v[32:35], a[28:31], a[172:175], v[32:35]
buffer_load_dwordx4 v3, s[48:51], s7 offen offset:3072 sc1 lds
v_mfma_f32_16x16x32_bf16 v[36:39], a[16:19], a[176:179], v[84:87]
s_add_u32 s7, s7, 0x8000
v_exp_f32 v20, v20
v_mfma_f32_16x16x32_bf16 v[36:39], a[20:23], a[180:183], v[36:39]
s_xor_b32 s27, s27, 0x38000
v_exp_f32 v21, v21
v_mfma_f32_16x16x32_bf16 v[36:39], a[24:27], a[184:187], v[36:39]
ds_read_b128 a[60:63], v1 offset:23552
v_xor_b32 v1, 0x8000, v1
v_mfma_f32_16x16x32_bf16 v[36:39], a[28:31], a[188:191], v[36:39]
v_cvt_pk_bf16_f32 v68, v20, v21
v_mfma_f32_16x16x32_bf16 v[40:43], a[16:19], a[192:195], v[88:91]
v_exp_f32 v22, v22
v_mfma_f32_16x16x32_bf16 v[40:43], a[20:23], a[196:199], v[40:43]
v_exp_f32 v23, v23
v_mfma_f32_16x16x32_bf16 v[40:43], a[24:27], a[200:203], v[40:43]
v_cvt_pk_bf16_f32 v69, v22, v23
v_mfma_f32_16x16x32_bf16 v[40:43], a[28:31], a[204:207], v[40:43]
v_exp_f32 v24, v24
v_mfma_f32_16x16x32_bf16 v[44:47], a[16:19], a[208:211], v[92:95]
v_exp_f32 v25, v25
v_mfma_f32_16x16x32_bf16 v[44:47], a[20:23], a[212:215], v[44:47]
v_exp_f32 v26, v26
v_mfma_f32_16x16x32_bf16 v[44:47], a[24:27], a[216:219], v[44:47]
s_waitcnt vmcnt(16) lgkmcnt(0)
v_exp_f32 v27, v27
v_mfma_f32_16x16x32_bf16 v[44:47], a[28:31], a[220:223], v[44:47]
s_barrier
L_att_dodd0:
v_mfma_f32_16x16x32_bf16 v[128:131], a[32:35], v[48:51], v[128:131]
ds_read_b128 a[0:3], v2 offset:8192
v_cvt_pk_bf16_f32 v72, v24, v25
v_mfma_f32_16x16x32_bf16 v[160:163], a[32:35], v[52:55], v[160:163]
v_exp_f32 v28, v28
v_mfma_f32_16x16x32_bf16 v[192:195], a[32:35], v[56:59], v[192:195]
v_cvt_pk_bf16_f32 v73, v26, v27
v_mfma_f32_16x16x32_bf16 v[224:227], a[32:35], v[60:63], v[224:227]
ds_read_b128 a[4:7], v2 offset:9216
v_mfma_f32_16x16x32_bf16 v[228:231], a[36:39], v[60:63], v[228:231]
v_exp_f32 v29, v29
v_mfma_f32_16x16x32_bf16 v[196:199], a[36:39], v[56:59], v[196:199]
v_exp_f32 v30, v30
v_mfma_f32_16x16x32_bf16 v[164:167], a[36:39], v[52:55], v[164:167]
s_add_u32 m0, s19, 0x0
v_cvt_pk_bf16_f32 v76, v28, v29
v_mfma_f32_16x16x32_bf16 v[132:135], a[36:39], v[48:51], v[132:135]
buffer_load_dwordx4 v3, s[48:51], s32 offen offset:0 sc1 lds
v_mfma_f32_16x16x32_bf16 v[136:139], a[40:43], v[48:51], v[136:139]
ds_read_b128 a[8:11], v2 offset:10240
v_mfma_f32_16x16x32_bf16 v[168:171], a[40:43], v[52:55], v[168:171]
v_exp_f32 v31, v31
v_mfma_f32_16x16x32_bf16 v[200:203], a[40:43], v[56:59], v[200:203]
v_exp_f32 v32, v32
v_mfma_f32_16x16x32_bf16 v[232:235], a[40:43], v[60:63], v[232:235]
ds_read_b128 a[12:15], v2 offset:11264
v_cvt_pk_bf16_f32 v77, v30, v31
v_mfma_f32_16x16x32_bf16 v[236:239], a[44:47], v[60:63], v[236:239]
v_mfma_f32_16x16x32_bf16 v[204:207], a[44:47], v[56:59], v[204:207]
v_exp_f32 v33, v33
v_mfma_f32_16x16x32_bf16 v[172:175], a[44:47], v[52:55], v[172:175]
v_exp_f32 v34, v34
v_mfma_f32_16x16x32_bf16 v[140:143], a[44:47], v[48:51], v[140:143]
ds_read_b128 a[16:19], v2 offset:12288
v_cvt_pk_bf16_f32 v66, v32, v33
v_mfma_f32_16x16x32_bf16 v[144:147], a[48:51], v[48:51], v[144:147]
v_mfma_f32_16x16x32_bf16 v[176:179], a[48:51], v[52:55], v[176:179]
v_exp_f32 v35, v35
v_mfma_f32_16x16x32_bf16 v[208:211], a[48:51], v[56:59], v[208:211]
v_exp_f32 v36, v36
v_mfma_f32_16x16x32_bf16 v[240:243], a[48:51], v[60:63], v[240:243]
ds_read_b128 a[20:23], v2 offset:13312
v_cvt_pk_bf16_f32 v67, v34, v35
v_mfma_f32_16x16x32_bf16 v[244:247], a[52:55], v[60:63], v[244:247]
v_exp_f32 v37, v37
v_mfma_f32_16x16x32_bf16 v[212:215], a[52:55], v[56:59], v[212:215]
v_cvt_pk_bf16_f32 v70, v36, v37
v_mfma_f32_16x16x32_bf16 v[180:183], a[52:55], v[52:55], v[180:183]
ds_read_b128 a[24:27], v2 offset:14336
v_mfma_f32_16x16x32_bf16 v[148:151], a[52:55], v[48:51], v[148:151]
buffer_load_dwordx4 v3, s[48:51], s32 offen offset:1024 sc1 lds
v_mfma_f32_16x16x32_bf16 v[152:155], a[56:59], v[48:51], v[152:155]
v_exp_f32 v38, v38
v_mfma_f32_16x16x32_bf16 v[184:187], a[56:59], v[52:55], v[184:187]
v_exp_f32 v39, v39
v_mfma_f32_16x16x32_bf16 v[216:219], a[56:59], v[56:59], v[216:219]
ds_read_b128 a[28:31], v2 offset:15360
v_cvt_pk_bf16_f32 v71, v38, v39
v_mfma_f32_16x16x32_bf16 v[248:251], a[56:59], v[60:63], v[248:251]
v_mfma_f32_16x16x32_bf16 v[252:255], a[60:63], v[60:63], v[252:255]
v_exp_f32 v40, v40
v_mfma_f32_16x16x32_bf16 v[220:223], a[60:63], v[56:59], v[220:223]
v_exp_f32 v41, v41
v_mfma_f32_16x16x32_bf16 v[188:191], a[60:63], v[52:55], v[188:191]
ds_read_b128 a[32:35], v2 offset:0
v_cvt_pk_bf16_f32 v74, v40, v41
v_mfma_f32_16x16x32_bf16 v[156:159], a[60:63], v[48:51], v[156:159]
v_smfmac_f32_16x16x64_bf16 a[224:227], a[232:235], v[48:55], v9
v_exp_f32 v42, v42
v_smfmac_f32_16x16x64_bf16 a[228:231], a[232:235], v[56:63], v9
s_waitcnt lgkmcnt(5)
v_exp_f32 v43, v43
v_mfma_f32_16x16x32_bf16 v[16:19], a[0:3], a[160:163], v[80:83]
ds_read_b128 a[36:39], v2 offset:1024
v_cvt_pk_bf16_f32 v75, v42, v43
v_mfma_f32_16x16x32_bf16 v[16:19], a[4:7], a[164:167], v[16:19]
v_exp_f32 v44, v44
v_mfma_f32_16x16x32_bf16 v[16:19], a[8:11], a[168:171], v[16:19]
v_mfma_f32_16x16x32_bf16 v[16:19], a[12:15], a[172:175], v[16:19]
v_exp_f32 v45, v45
v_mfma_f32_16x16x32_bf16 v[20:23], a[0:3], a[176:179], v[84:87]
ds_read_b128 a[40:43], v2 offset:2048
v_cvt_pk_bf16_f32 v78, v44, v45
v_mfma_f32_16x16x32_bf16 v[20:23], a[4:7], a[180:183], v[20:23]
buffer_load_dwordx4 v3, s[48:51], s32 offen offset:2048 sc1 lds
v_mfma_f32_16x16x32_bf16 v[20:23], a[8:11], a[184:187], v[20:23]
v_exp_f32 v46, v46
v_mfma_f32_16x16x32_bf16 v[20:23], a[12:15], a[188:191], v[20:23]
ds_read_b128 a[44:47], v2 offset:3072
v_mfma_f32_16x16x32_bf16 v[24:27], a[0:3], a[192:195], v[88:91]
v_mfma_f32_16x16x32_bf16 v[24:27], a[4:7], a[196:199], v[24:27]
v_exp_f32 v47, v47
v_mfma_f32_16x16x32_bf16 v[24:27], a[8:11], a[200:203], v[24:27]
v_exp_f32 v16, v16
v_mfma_f32_16x16x32_bf16 v[24:27], a[12:15], a[204:207], v[24:27]
ds_read_b128 a[48:51], v2 offset:4096
v_cvt_pk_bf16_f32 v79, v46, v47
v_mfma_f32_16x16x32_bf16 v[28:31], a[0:3], a[208:211], v[92:95]
v_mfma_f32_16x16x32_bf16 v[28:31], a[4:7], a[212:215], v[28:31]
v_exp_f32 v17, v17
v_mfma_f32_16x16x32_bf16 v[28:31], a[8:11], a[216:219], v[28:31]
s_waitcnt lgkmcnt(5)
v_exp_f32 v18, v18
v_mfma_f32_16x16x32_bf16 v[28:31], a[12:15], a[220:223], v[28:31]
ds_read_b128 a[52:55], v2 offset:5120
v_cvt_pk_bf16_f32 v48, v16, v17
v_mfma_f32_16x16x32_bf16 v[32:35], a[16:19], a[160:163], v[80:83]
v_mfma_f32_16x16x32_bf16 v[32:35], a[20:23], a[164:167], v[32:35]
v_exp_f32 v19, v19
v_mfma_f32_16x16x32_bf16 v[32:35], a[24:27], a[168:171], v[32:35]
v_exp_f32 v20, v20
v_mfma_f32_16x16x32_bf16 v[32:35], a[28:31], a[172:175], v[32:35]
ds_read_b128 a[56:59], v2 offset:6144
v_cvt_pk_bf16_f32 v49, v18, v19
v_mfma_f32_16x16x32_bf16 v[36:39], a[16:19], a[176:179], v[84:87]
v_exp_f32 v21, v21
v_mfma_f32_16x16x32_bf16 v[36:39], a[20:23], a[180:183], v[36:39]
buffer_load_dwordx4 v3, s[48:51], s32 offen offset:3072 sc1 lds
v_mfma_f32_16x16x32_bf16 v[36:39], a[24:27], a[184:187], v[36:39]
s_add_u32 s32, s32, 0x8000
v_cvt_pk_bf16_f32 v52, v20, v21
v_mfma_f32_16x16x32_bf16 v[36:39], a[28:31], a[188:191], v[36:39]
ds_read_b128 a[60:63], v2 offset:7168
v_mfma_f32_16x16x32_bf16 v[40:43], a[16:19], a[192:195], v[88:91]
v_exp_f32 v22, v22
v_mfma_f32_16x16x32_bf16 v[40:43], a[20:23], a[196:199], v[40:43]
v_exp_f32 v23, v23
v_mfma_f32_16x16x32_bf16 v[40:43], a[24:27], a[200:203], v[40:43]
v_cvt_pk_bf16_f32 v53, v22, v23
v_mfma_f32_16x16x32_bf16 v[40:43], a[28:31], a[204:207], v[40:43]
v_exp_f32 v24, v24
v_mfma_f32_16x16x32_bf16 v[44:47], a[16:19], a[208:211], v[92:95]
v_exp_f32 v25, v25
v_mfma_f32_16x16x32_bf16 v[44:47], a[20:23], a[212:215], v[44:47]
v_exp_f32 v26, v26
v_mfma_f32_16x16x32_bf16 v[44:47], a[24:27], a[216:219], v[44:47]
v_exp_f32 v27, v27
v_mfma_f32_16x16x32_bf16 v[44:47], a[28:31], a[220:223], v[44:47]
s_waitcnt lgkmcnt(0)
v_mfma_f32_16x16x32_bf16 v[128:131], a[32:35], v[64:67], v[128:131]
ds_read_b128 a[0:3], v2 offset:24576
v_cvt_pk_bf16_f32 v56, v24, v25
v_mfma_f32_16x16x32_bf16 v[160:163], a[32:35], v[68:71], v[160:163]
v_exp_f32 v28, v28
v_mfma_f32_16x16x32_bf16 v[192:195], a[32:35], v[72:75], v[192:195]
v_cvt_pk_bf16_f32 v57, v26, v27
v_mfma_f32_16x16x32_bf16 v[224:227], a[32:35], v[76:79], v[224:227]
ds_read_b128 a[4:7], v2 offset:25600
v_mfma_f32_16x16x32_bf16 v[228:231], a[36:39], v[76:79], v[228:231]
v_exp_f32 v29, v29
v_mfma_f32_16x16x32_bf16 v[196:199], a[36:39], v[72:75], v[196:199]
v_exp_f32 v30, v30
v_mfma_f32_16x16x32_bf16 v[164:167], a[36:39], v[68:71], v[164:167]
s_add_u32 m0, s19, 0x1000
v_cvt_pk_bf16_f32 v60, v28, v29
v_mfma_f32_16x16x32_bf16 v[132:135], a[36:39], v[64:67], v[132:135]
buffer_load_dwordx4 v3, s[48:51], s7 offen offset:0 sc1 lds
v_mfma_f32_16x16x32_bf16 v[136:139], a[40:43], v[64:67], v[136:139]
ds_read_b128 a[8:11], v2 offset:26624
v_mfma_f32_16x16x32_bf16 v[168:171], a[40:43], v[68:71], v[168:171]
v_exp_f32 v31, v31
v_mfma_f32_16x16x32_bf16 v[200:203], a[40:43], v[72:75], v[200:203]
v_exp_f32 v32, v32
v_mfma_f32_16x16x32_bf16 v[232:235], a[40:43], v[76:79], v[232:235]
ds_read_b128 a[12:15], v2 offset:27648
v_cvt_pk_bf16_f32 v61, v30, v31
v_mfma_f32_16x16x32_bf16 v[236:239], a[44:47], v[76:79], v[236:239]
v_mfma_f32_16x16x32_bf16 v[204:207], a[44:47], v[72:75], v[204:207]
v_exp_f32 v33, v33
v_mfma_f32_16x16x32_bf16 v[172:175], a[44:47], v[68:71], v[172:175]
v_exp_f32 v34, v34
v_mfma_f32_16x16x32_bf16 v[140:143], a[44:47], v[64:67], v[140:143]
ds_read_b128 a[16:19], v2 offset:28672
v_cvt_pk_bf16_f32 v50, v32, v33
v_mfma_f32_16x16x32_bf16 v[144:147], a[48:51], v[64:67], v[144:147]
v_exp_f32 v35, v35
v_mfma_f32_16x16x32_bf16 v[176:179], a[48:51], v[68:71], v[176:179]
v_cvt_pk_bf16_f32 v51, v34, v35
v_mfma_f32_16x16x32_bf16 v[208:211], a[48:51], v[72:75], v[208:211]
ds_read_b128 a[20:23], v2 offset:29696
v_mfma_f32_16x16x32_bf16 v[240:243], a[48:51], v[76:79], v[240:243]
v_exp_f32 v36, v36
v_mfma_f32_16x16x32_bf16 v[244:247], a[52:55], v[76:79], v[244:247]
v_exp_f32 v37, v37
v_mfma_f32_16x16x32_bf16 v[212:215], a[52:55], v[72:75], v[212:215]
v_cvt_pk_bf16_f32 v54, v36, v37
v_mfma_f32_16x16x32_bf16 v[180:183], a[52:55], v[68:71], v[180:183]
buffer_load_dwordx4 v3, s[48:51], s7 offen offset:1024 sc1 lds
v_mfma_f32_16x16x32_bf16 v[148:151], a[52:55], v[64:67], v[148:151]
ds_read_b128 a[24:27], v2 offset:30720
v_mfma_f32_16x16x32_bf16 v[152:155], a[56:59], v[64:67], v[152:155]
v_exp_f32 v38, v38
v_mfma_f32_16x16x32_bf16 v[184:187], a[56:59], v[68:71], v[184:187]
v_exp_f32 v39, v39
v_mfma_f32_16x16x32_bf16 v[216:219], a[56:59], v[72:75], v[216:219]
ds_read_b128 a[28:31], v2 offset:31744
v_cvt_pk_bf16_f32 v55, v38, v39
v_mfma_f32_16x16x32_bf16 v[248:251], a[56:59], v[76:79], v[248:251]
v_exp_f32 v40, v40
v_mfma_f32_16x16x32_bf16 v[252:255], a[60:63], v[76:79], v[252:255]
v_mfma_f32_16x16x32_bf16 v[220:223], a[60:63], v[72:75], v[220:223]
v_exp_f32 v41, v41
v_mfma_f32_16x16x32_bf16 v[188:191], a[60:63], v[68:71], v[188:191]
ds_read_b128 a[32:35], v2 offset:16384
v_cvt_pk_bf16_f32 v58, v40, v41
v_mfma_f32_16x16x32_bf16 v[156:159], a[60:63], v[64:67], v[156:159]
v_exp_f32 v42, v42
v_smfmac_f32_16x16x64_bf16 a[224:227], a[232:235], v[64:71], v9
s_waitcnt lgkmcnt(5)
v_smfmac_f32_16x16x64_bf16 a[228:231], a[232:235], v[72:79], v9
ds_read_b128 a[36:39], v2 offset:17408
v_mfma_f32_16x16x32_bf16 v[16:19], a[0:3], a[160:163], v[80:83]
v_exp_f32 v43, v43
v_mfma_f32_16x16x32_bf16 v[16:19], a[4:7], a[164:167], v[16:19]
v_exp_f32 v44, v44
v_mfma_f32_16x16x32_bf16 v[16:19], a[8:11], a[168:171], v[16:19]
buffer_load_dwordx4 v3, s[48:51], s7 offen offset:2048 sc1 lds
v_mfma_f32_16x16x32_bf16 v[16:19], a[12:15], a[172:175], v[16:19]
ds_read_b128 a[40:43], v2 offset:18432
v_cvt_pk_bf16_f32 v59, v42, v43
v_mfma_f32_16x16x32_bf16 v[20:23], a[0:3], a[176:179], v[84:87]
v_exp_f32 v45, v45
v_mfma_f32_16x16x32_bf16 v[20:23], a[4:7], a[180:183], v[20:23]
v_cvt_pk_bf16_f32 v62, v44, v45
v_mfma_f32_16x16x32_bf16 v[20:23], a[8:11], a[184:187], v[20:23]
v_exp_f32 v46, v46
v_mfma_f32_16x16x32_bf16 v[20:23], a[12:15], a[188:191], v[20:23]
ds_read_b128 a[44:47], v2 offset:19456
v_mfma_f32_16x16x32_bf16 v[24:27], a[0:3], a[192:195], v[88:91]
v_exp_f32 v47, v47
v_mfma_f32_16x16x32_bf16 v[24:27], a[4:7], a[196:199], v[24:27]
v_cvt_pk_bf16_f32 v63, v46, v47
v_mfma_f32_16x16x32_bf16 v[24:27], a[8:11], a[200:203], v[24:27]
v_exp_f32 v16, v16
v_mfma_f32_16x16x32_bf16 v[24:27], a[12:15], a[204:207], v[24:27]
ds_read_b128 a[48:51], v2 offset:20480
v_mfma_f32_16x16x32_bf16 v[28:31], a[0:3], a[208:211], v[92:95]
v_exp_f32 v17, v17
v_mfma_f32_16x16x32_bf16 v[28:31], a[4:7], a[212:215], v[28:31]
v_exp_f32 v18, v18
v_mfma_f32_16x16x32_bf16 v[28:31], a[8:11], a[216:219], v[28:31]
ds_read_b128 a[52:55], v2 offset:21504
v_cvt_pk_bf16_f32 v64, v16, v17
v_mfma_f32_16x16x32_bf16 v[28:31], a[12:15], a[220:223], v[28:31]
s_waitcnt lgkmcnt(6)
v_mfma_f32_16x16x32_bf16 v[32:35], a[16:19], a[160:163], v[80:83]
v_exp_f32 v19, v19
v_mfma_f32_16x16x32_bf16 v[32:35], a[20:23], a[164:167], v[32:35]
buffer_load_dwordx4 v3, s[48:51], s7 offen offset:3072 sc1 lds
v_mfma_f32_16x16x32_bf16 v[32:35], a[24:27], a[168:171], v[32:35]
ds_read_b128 a[56:59], v2 offset:22528
v_cvt_pk_bf16_f32 v65, v18, v19
v_mfma_f32_16x16x32_bf16 v[32:35], a[28:31], a[172:175], v[32:35]
s_add_u32 s7, s7, 0x8000
v_exp_f32 v20, v20
v_mfma_f32_16x16x32_bf16 v[36:39], a[16:19], a[176:179], v[84:87]
s_xor_b32 s19, s19, 0x8000
v_mfma_f32_16x16x32_bf16 v[36:39], a[20:23], a[180:183], v[36:39]
s_sub_u32 s15, s15, 1
v_exp_f32 v21, v21
v_mfma_f32_16x16x32_bf16 v[36:39], a[24:27], a[184:187], v[36:39]
ds_read_b128 a[60:63], v2 offset:23552
v_xor_b32 v2, 0x38000, v2
v_mfma_f32_16x16x32_bf16 v[36:39], a[28:31], a[188:191], v[36:39]
s_cmp_lg_u32 s15, 0
v_exp_f32 v22, v22
v_mfma_f32_16x16x32_bf16 v[40:43], a[16:19], a[192:195], v[88:91]
v_exp_f32 v23, v23
v_mfma_f32_16x16x32_bf16 v[40:43], a[20:23], a[196:199], v[40:43]
v_cvt_pk_bf16_f32 v68, v20, v21
v_cvt_pk_bf16_f32 v69, v22, v23
v_mfma_f32_16x16x32_bf16 v[40:43], a[24:27], a[200:203], v[40:43]
v_exp_f32 v24, v24
v_mfma_f32_16x16x32_bf16 v[40:43], a[28:31], a[204:207], v[40:43]
v_exp_f32 v25, v25
v_mfma_f32_16x16x32_bf16 v[44:47], a[16:19], a[208:211], v[92:95]
v_exp_f32 v26, v26
v_mfma_f32_16x16x32_bf16 v[44:47], a[20:23], a[212:215], v[44:47]
v_exp_f32 v27, v27
v_mfma_f32_16x16x32_bf16 v[44:47], a[24:27], a[216:219], v[44:47]
s_waitcnt vmcnt(16) lgkmcnt(0)
v_mfma_f32_16x16x32_bf16 v[44:47], a[28:31], a[220:223], v[44:47]
s_barrier
s_cbranch_scc1 L_att_deven0
s_branch L_att_ddone
L_att_deven1:
v_mfma_f32_16x16x32_bf16 v[128:131], a[32:35], v[48:51], v[128:131]
ds_read_b128 a[0:3], v1 offset:8192
v_cvt_pk_bf16_f32 v72, v24, v25
v_mfma_f32_16x16x32_bf16 v[160:163], a[32:35], v[52:55], v[160:163]
v_exp_f32 v28, v28
v_mfma_f32_16x16x32_bf16 v[192:195], a[32:35], v[56:59], v[192:195]
v_cvt_pk_bf16_f32 v73, v26, v27
v_mfma_f32_16x16x32_bf16 v[224:227], a[32:35], v[60:63], v[224:227]
ds_read_b128 a[4:7], v1 offset:9216
v_mfma_f32_16x16x32_bf16 v[228:231], a[36:39], v[60:63], v[228:231]
v_exp_f32 v29, v29
v_mfma_f32_16x16x32_bf16 v[196:199], a[36:39], v[56:59], v[196:199]
v_exp_f32 v30, v30
v_mfma_f32_16x16x32_bf16 v[164:167], a[36:39], v[52:55], v[164:167]
s_add_u32 m0, s27, 0x0
v_cvt_pk_bf16_f32 v76, v28, v29
v_mfma_f32_16x16x32_bf16 v[132:135], a[36:39], v[48:51], v[132:135]
buffer_load_dwordx4 v3, s[48:51], s32 offen offset:0 sc1 lds
v_mfma_f32_16x16x32_bf16 v[136:139], a[40:43], v[48:51], v[136:139]
ds_read_b128 a[8:11], v1 offset:10240
v_mfma_f32_16x16x32_bf16 v[168:171], a[40:43], v[52:55], v[168:171]
v_exp_f32 v31, v31
v_mfma_f32_16x16x32_bf16 v[200:203], a[40:43], v[56:59], v[200:203]
v_exp_f32 v32, v32
v_mfma_f32_16x16x32_bf16 v[232:235], a[40:43], v[60:63], v[232:235]
ds_read_b128 a[12:15], v1 offset:11264
v_cvt_pk_bf16_f32 v77, v30, v31
v_mfma_f32_16x16x32_bf16 v[236:239], a[44:47], v[60:63], v[236:239]
v_mfma_f32_16x16x32_bf16 v[204:207], a[44:47], v[56:59], v[204:207]
v_exp_f32 v33, v33
v_mfma_f32_16x16x32_bf16 v[172:175], a[44:47], v[52:55], v[172:175]
v_exp_f32 v34, v34
v_mfma_f32_16x16x32_bf16 v[140:143], a[44:47], v[48:51], v[140:143]
ds_read_b128 a[16:19], v1 offset:12288
v_cvt_pk_bf16_f32 v66, v32, v33
v_mfma_f32_16x16x32_bf16 v[144:147], a[48:51], v[48:51], v[144:147]
v_mfma_f32_16x16x32_bf16 v[176:179], a[48:51], v[52:55], v[176:179]
v_exp_f32 v35, v35
v_mfma_f32_16x16x32_bf16 v[208:211], a[48:51], v[56:59], v[208:211]
v_exp_f32 v36, v36
v_mfma_f32_16x16x32_bf16 v[240:243], a[48:51], v[60:63], v[240:243]
ds_read_b128 a[20:23], v1 offset:13312
v_cvt_pk_bf16_f32 v67, v34, v35
v_mfma_f32_16x16x32_bf16 v[244:247], a[52:55], v[60:63], v[244:247]
v_exp_f32 v37, v37
v_mfma_f32_16x16x32_bf16 v[212:215], a[52:55], v[56:59], v[212:215]
v_cvt_pk_bf16_f32 v70, v36, v37
v_mfma_f32_16x16x32_bf16 v[180:183], a[52:55], v[52:55], v[180:183]
ds_read_b128 a[24:27], v1 offset:14336
v_mfma_f32_16x16x32_bf16 v[148:151], a[52:55], v[48:51], v[148:151]
buffer_load_dwordx4 v3, s[48:51], s32 offen offset:1024 sc1 lds
v_mfma_f32_16x16x32_bf16 v[152:155], a[56:59], v[48:51], v[152:155]
v_exp_f32 v38, v38
v_mfma_f32_16x16x32_bf16 v[184:187], a[56:59], v[52:55], v[184:187]
v_exp_f32 v39, v39
v_mfma_f32_16x16x32_bf16 v[216:219], a[56:59], v[56:59], v[216:219]
ds_read_b128 a[28:31], v1 offset:15360
v_cvt_pk_bf16_f32 v71, v38, v39
v_mfma_f32_16x16x32_bf16 v[248:251], a[56:59], v[60:63], v[248:251]
v_mfma_f32_16x16x32_bf16 v[252:255], a[60:63], v[60:63], v[252:255]
v_exp_f32 v40, v40
v_mfma_f32_16x16x32_bf16 v[220:223], a[60:63], v[56:59], v[220:223]
v_exp_f32 v41, v41
v_mfma_f32_16x16x32_bf16 v[188:191], a[60:63], v[52:55], v[188:191]
ds_read_b128 a[32:35], v1 offset:0
v_cvt_pk_bf16_f32 v74, v40, v41
v_mfma_f32_16x16x32_bf16 v[156:159], a[60:63], v[48:51], v[156:159]
v_smfmac_f32_16x16x64_bf16 a[224:227], a[232:235], v[48:55], v9
v_exp_f32 v42, v42
v_smfmac_f32_16x16x64_bf16 a[228:231], a[232:235], v[56:63], v9
s_waitcnt lgkmcnt(5)
v_exp_f32 v43, v43
v_mfma_f32_16x16x32_bf16 v[16:19], a[0:3], a[160:163], v[80:83]
ds_read_b128 a[36:39], v1 offset:1024
v_cvt_pk_bf16_f32 v75, v42, v43
v_mfma_f32_16x16x32_bf16 v[16:19], a[4:7], a[164:167], v[16:19]
v_exp_f32 v44, v44
v_mfma_f32_16x16x32_bf16 v[16:19], a[8:11], a[168:171], v[16:19]
v_mfma_f32_16x16x32_bf16 v[16:19], a[12:15], a[172:175], v[16:19]
v_exp_f32 v45, v45
v_mfma_f32_16x16x32_bf16 v[20:23], a[0:3], a[176:179], v[84:87]
ds_read_b128 a[40:43], v1 offset:2048
v_cvt_pk_bf16_f32 v78, v44, v45
v_mfma_f32_16x16x32_bf16 v[20:23], a[4:7], a[180:183], v[20:23]
buffer_load_dwordx4 v3, s[48:51], s32 offen offset:2048 sc1 lds
v_mfma_f32_16x16x32_bf16 v[20:23], a[8:11], a[184:187], v[20:23]
v_exp_f32 v46, v46
v_mfma_f32_16x16x32_bf16 v[20:23], a[12:15], a[188:191], v[20:23]
ds_read_b128 a[44:47], v1 offset:3072
v_mfma_f32_16x16x32_bf16 v[24:27], a[0:3], a[192:195], v[88:91]
v_mfma_f32_16x16x32_bf16 v[24:27], a[4:7], a[196:199], v[24:27]
v_exp_f32 v47, v47
v_mfma_f32_16x16x32_bf16 v[24:27], a[8:11], a[200:203], v[24:27]
v_exp_f32 v16, v16
v_mfma_f32_16x16x32_bf16 v[24:27], a[12:15], a[204:207], v[24:27]
ds_read_b128 a[48:51], v1 offset:4096
v_cvt_pk_bf16_f32 v79, v46, v47
v_mfma_f32_16x16x32_bf16 v[28:31], a[0:3], a[208:211], v[92:95]
v_mfma_f32_16x16x32_bf16 v[28:31], a[4:7], a[212:215], v[28:31]
v_exp_f32 v17, v17
v_mfma_f32_16x16x32_bf16 v[28:31], a[8:11], a[216:219], v[28:31]
s_waitcnt lgkmcnt(5)
v_exp_f32 v18, v18
v_mfma_f32_16x16x32_bf16 v[28:31], a[12:15], a[220:223], v[28:31]
ds_read_b128 a[52:55], v1 offset:5120
v_cvt_pk_bf16_f32 v48, v16, v17
v_mfma_f32_16x16x32_bf16 v[32:35], a[16:19], a[160:163], v[80:83]
v_mfma_f32_16x16x32_bf16 v[32:35], a[20:23], a[164:167], v[32:35]
v_exp_f32 v19, v19
v_mfma_f32_16x16x32_bf16 v[32:35], a[24:27], a[168:171], v[32:35]
v_exp_f32 v20, v20
v_mfma_f32_16x16x32_bf16 v[32:35], a[28:31], a[172:175], v[32:35]
ds_read_b128 a[56:59], v1 offset:6144
v_cvt_pk_bf16_f32 v49, v18, v19
v_mfma_f32_16x16x32_bf16 v[36:39], a[16:19], a[176:179], v[84:87]
v_exp_f32 v21, v21
v_mfma_f32_16x16x32_bf16 v[36:39], a[20:23], a[180:183], v[36:39]
buffer_load_dwordx4 v3, s[48:51], s32 offen offset:3072 sc1 lds
v_mfma_f32_16x16x32_bf16 v[36:39], a[24:27], a[184:187], v[36:39]
s_add_u32 s32, s32, 0x8000
v_cvt_pk_bf16_f32 v52, v20, v21
v_mfma_f32_16x16x32_bf16 v[36:39], a[28:31], a[188:191], v[36:39]
ds_read_b128 a[60:63], v1 offset:7168
v_mfma_f32_16x16x32_bf16 v[40:43], a[16:19], a[192:195], v[88:91]
v_exp_f32 v22, v22
v_mfma_f32_16x16x32_bf16 v[40:43], a[20:23], a[196:199], v[40:43]
v_exp_f32 v23, v23
v_mfma_f32_16x16x32_bf16 v[40:43], a[24:27], a[200:203], v[40:43]
v_cvt_pk_bf16_f32 v53, v22, v23
v_mfma_f32_16x16x32_bf16 v[40:43], a[28:31], a[204:207], v[40:43]
v_exp_f32 v24, v24
v_mfma_f32_16x16x32_bf16 v[44:47], a[16:19], a[208:211], v[92:95]
v_exp_f32 v25, v25
v_mfma_f32_16x16x32_bf16 v[44:47], a[20:23], a[212:215], v[44:47]
v_exp_f32 v26, v26
v_mfma_f32_16x16x32_bf16 v[44:47], a[24:27], a[216:219], v[44:47]
v_exp_f32 v27, v27
v_mfma_f32_16x16x32_bf16 v[44:47], a[28:31], a[220:223], v[44:47]
s_waitcnt lgkmcnt(0)
v_mfma_f32_16x16x32_bf16 v[128:131], a[32:35], v[64:67], v[128:131]
ds_read_b128 a[0:3], v1 offset:24576
v_cvt_pk_bf16_f32 v56, v24, v25
v_mfma_f32_16x16x32_bf16 v[160:163], a[32:35], v[68:71], v[160:163]
v_exp_f32 v28, v28
v_mfma_f32_16x16x32_bf16 v[192:195], a[32:35], v[72:75], v[192:195]
v_cvt_pk_bf16_f32 v57, v26, v27
v_mfma_f32_16x16x32_bf16 v[224:227], a[32:35], v[76:79], v[224:227]
ds_read_b128 a[4:7], v1 offset:25600
v_mfma_f32_16x16x32_bf16 v[228:231], a[36:39], v[76:79], v[228:231]
v_exp_f32 v29, v29
v_mfma_f32_16x16x32_bf16 v[196:199], a[36:39], v[72:75], v[196:199]
v_exp_f32 v30, v30
v_mfma_f32_16x16x32_bf16 v[164:167], a[36:39], v[68:71], v[164:167]
s_add_u32 m0, s27, 0x1000
v_cvt_pk_bf16_f32 v60, v28, v29
v_mfma_f32_16x16x32_bf16 v[132:135], a[36:39], v[64:67], v[132:135]
buffer_load_dwordx4 v3, s[48:51], s7 offen offset:0 sc1 lds
v_mfma_f32_16x16x32_bf16 v[136:139], a[40:43], v[64:67], v[136:139]
ds_read_b128 a[8:11], v1 offset:26624
v_mfma_f32_16x16x32_bf16 v[168:171], a[40:43], v[68:71], v[168:171]
v_exp_f32 v31, v31
v_mfma_f32_16x16x32_bf16 v[200:203], a[40:43], v[72:75], v[200:203]
v_exp_f32 v32, v32
v_mfma_f32_16x16x32_bf16 v[232:235], a[40:43], v[76:79], v[232:235]
ds_read_b128 a[12:15], v1 offset:27648
v_cvt_pk_bf16_f32 v61, v30, v31
v_mfma_f32_16x16x32_bf16 v[236:239], a[44:47], v[76:79], v[236:239]
v_mfma_f32_16x16x32_bf16 v[204:207], a[44:47], v[72:75], v[204:207]
v_exp_f32 v33, v33
v_mfma_f32_16x16x32_bf16 v[172:175], a[44:47], v[68:71], v[172:175]
v_exp_f32 v34, v34
v_mfma_f32_16x16x32_bf16 v[140:143], a[44:47], v[64:67], v[140:143]
ds_read_b128 a[16:19], v1 offset:28672
v_cvt_pk_bf16_f32 v50, v32, v33
v_mfma_f32_16x16x32_bf16 v[144:147], a[48:51], v[64:67], v[144:147]
v_mfma_f32_16x16x32_bf16 v[176:179], a[48:51], v[68:71], v[176:179]
v_exp_f32 v35, v35
v_mfma_f32_16x16x32_bf16 v[208:211], a[48:51], v[72:75], v[208:211]
ds_read_b128 a[20:23], v1 offset:29696
v_cvt_pk_bf16_f32 v51, v34, v35
v_mfma_f32_16x16x32_bf16 v[240:243], a[48:51], v[76:79], v[240:243]
v_exp_f32 v36, v36
v_mfma_f32_16x16x32_bf16 v[244:247], a[52:55], v[76:79], v[244:247]
v_exp_f32 v37, v37
v_mfma_f32_16x16x32_bf16 v[212:215], a[52:55], v[72:75], v[212:215]
v_cvt_pk_bf16_f32 v54, v36, v37
v_mfma_f32_16x16x32_bf16 v[180:183], a[52:55], v[68:71], v[180:183]
buffer_load_dwordx4 v3, s[48:51], s7 offen offset:1024 sc1 lds
v_mfma_f32_16x16x32_bf16 v[148:151], a[52:55], v[64:67], v[148:151]
ds_read_b128 a[24:27], v1 offset:30720
v_mfma_f32_16x16x32_bf16 v[152:155], a[56:59], v[64:67], v[152:155]
v_exp_f32 v38, v38
v_mfma_f32_16x16x32_bf16 v[184:187], a[56:59], v[68:71], v[184:187]
v_exp_f32 v39, v39
v_mfma_f32_16x16x32_bf16 v[216:219], a[56:59], v[72:75], v[216:219]
ds_read_b128 a[28:31], v1 offset:31744
v_cvt_pk_bf16_f32 v55, v38, v39
v_mfma_f32_16x16x32_bf16 v[248:251], a[56:59], v[76:79], v[248:251]
v_mfma_f32_16x16x32_bf16 v[252:255], a[60:63], v[76:79], v[252:255]
v_exp_f32 v40, v40
v_mfma_f32_16x16x32_bf16 v[220:223], a[60:63], v[72:75], v[220:223]
v_exp_f32 v41, v41
v_mfma_f32_16x16x32_bf16 v[188:191], a[60:63], v[68:71], v[188:191]
ds_read_b128 a[32:35], v1 offset:16384
v_cvt_pk_bf16_f32 v58, v40, v41
v_mfma_f32_16x16x32_bf16 v[156:159], a[60:63], v[64:67], v[156:159]
v_smfmac_f32_16x16x64_bf16 a[224:227], a[232:235], v[64:71], v9
s_waitcnt lgkmcnt(5)
v_exp_f32 v42, v42
v_smfmac_f32_16x16x64_bf16 a[228:231], a[232:235], v[72:79], v9
ds_read_b128 a[36:39], v1 offset:17408
v_mfma_f32_16x16x32_bf16 v[16:19], a[0:3], a[160:163], v[80:83]
v_exp_f32 v43, v43
v_mfma_f32_16x16x32_bf16 v[16:19], a[4:7], a[164:167], v[16:19]
v_exp_f32 v44, v44
v_mfma_f32_16x16x32_bf16 v[16:19], a[8:11], a[168:171], v[16:19]
v_cvt_pk_bf16_f32 v59, v42, v43
v_mfma_f32_16x16x32_bf16 v[16:19], a[12:15], a[172:175], v[16:19]
ds_read_b128 a[40:43], v1 offset:18432
v_mfma_f32_16x16x32_bf16 v[20:23], a[0:3], a[176:179], v[84:87]
buffer_load_dwordx4 v3, s[48:51], s7 offen offset:2048 sc1 lds
v_mfma_f32_16x16x32_bf16 v[20:23], a[4:7], a[180:183], v[20:23]
v_exp_f32 v45, v45
v_mfma_f32_16x16x32_bf16 v[20:23], a[8:11], a[184:187], v[20:23]
v_exp_f32 v46, v46
v_mfma_f32_16x16x32_bf16 v[20:23], a[12:15], a[188:191], v[20:23]
ds_read_b128 a[44:47], v1 offset:19456
v_cvt_pk_bf16_f32 v62, v44, v45
v_mfma_f32_16x16x32_bf16 v[24:27], a[0:3], a[192:195], v[88:91]
v_mfma_f32_16x16x32_bf16 v[24:27], a[4:7], a[196:199], v[24:27]
v_exp_f32 v47, v47
v_mfma_f32_16x16x32_bf16 v[24:27], a[8:11], a[200:203], v[24:27]
v_exp_f32 v16, v16
v_mfma_f32_16x16x32_bf16 v[24:27], a[12:15], a[204:207], v[24:27]
ds_read_b128 a[48:51], v1 offset:20480
v_cvt_pk_bf16_f32 v63, v46, v47
v_mfma_f32_16x16x32_bf16 v[28:31], a[0:3], a[208:211], v[92:95]
v_mfma_f32_16x16x32_bf16 v[28:31], a[4:7], a[212:215], v[28:31]
v_exp_f32 v17, v17
v_mfma_f32_16x16x32_bf16 v[28:31], a[8:11], a[216:219], v[28:31]
ds_read_b128 a[52:55], v1 offset:21504
v_cvt_pk_bf16_f32 v64, v16, v17
v_mfma_f32_16x16x32_bf16 v[28:31], a[12:15], a[220:223], v[28:31]
s_waitcnt lgkmcnt(6)
v_exp_f32 v18, v18
v_mfma_f32_16x16x32_bf16 v[32:35], a[16:19], a[160:163], v[80:83]
v_mfma_f32_16x16x32_bf16 v[32:35], a[20:23], a[164:167], v[32:35]
v_exp_f32 v19, v19
v_mfma_f32_16x16x32_bf16 v[32:35], a[24:27], a[168:171], v[32:35]
ds_read_b128 a[56:59], v1 offset:22528
v_cvt_pk_bf16_f32 v65, v18, v19
v_mfma_f32_16x16x32_bf16 v[32:35], a[28:31], a[172:175], v[32:35]
buffer_load_dwordx4 v3, s[48:51], s7 offen offset:3072 sc1 lds
v_mfma_f32_16x16x32_bf16 v[36:39], a[16:19], a[176:179], v[84:87]
s_add_u32 s7, s7, 0x8000
v_exp_f32 v20, v20
v_mfma_f32_16x16x32_bf16 v[36:39], a[20:23], a[180:183], v[36:39]
s_xor_b32 s27, s27, 0x38000
v_exp_f32 v21, v21
v_mfma_f32_16x16x32_bf16 v[36:39], a[24:27], a[184:187], v[36:39]
ds_read_b128 a[60:63], v1 offset:23552
v_xor_b32 v1, 0x8000, v1
v_mfma_f32_16x16x32_bf16 v[36:39], a[28:31], a[188:191], v[36:39]
v_cvt_pk_bf16_f32 v68, v20, v21
v_mfma_f32_16x16x32_bf16 v[40:43], a[16:19], a[192:195], v[88:91]
v_exp_f32 v22, v22
v_mfma_f32_16x16x32_bf16 v[40:43], a[20:23], a[196:199], v[40:43]
v_exp_f32 v23, v23
v_mfma_f32_16x16x32_bf16 v[40:43], a[24:27], a[200:203], v[40:43]
v_cvt_pk_bf16_f32 v69, v22, v23
v_mfma_f32_16x16x32_bf16 v[40:43], a[28:31], a[204:207], v[40:43]
v_exp_f32 v24, v24
v_mfma_f32_16x16x32_bf16 v[44:47], a[16:19], a[208:211], v[92:95]
s_waitcnt vmcnt(16) lgkmcnt(0)
v_exp_f32 v25, v25
v_mfma_f32_16x16x32_bf16 v[44:47], a[20:23], a[212:215], v[44:47]
s_barrier
v_exp_f32 v26, v26
v_mfma_f32_16x16x32_bf16 v[44:47], a[24:27], a[216:219], v[44:47]
v_exp_f32 v27, v27
v_mfma_f32_16x16x32_bf16 v[44:47], a[28:31], a[220:223], v[44:47]
L_att_dodd1:
v_mfma_f32_16x16x32_bf16 v[128:131], a[32:35], v[48:51], v[128:131]
ds_read_b128 a[0:3], v2 offset:8192
v_cvt_pk_bf16_f32 v72, v24, v25
v_mfma_f32_16x16x32_bf16 v[160:163], a[32:35], v[52:55], v[160:163]
v_exp_f32 v28, v28
v_mfma_f32_16x16x32_bf16 v[192:195], a[32:35], v[56:59], v[192:195]
v_cvt_pk_bf16_f32 v73, v26, v27
v_mfma_f32_16x16x32_bf16 v[224:227], a[32:35], v[60:63], v[224:227]
ds_read_b128 a[4:7], v2 offset:9216
v_mfma_f32_16x16x32_bf16 v[228:231], a[36:39], v[60:63], v[228:231]
v_exp_f32 v29, v29
v_mfma_f32_16x16x32_bf16 v[196:199], a[36:39], v[56:59], v[196:199]
v_exp_f32 v30, v30
v_mfma_f32_16x16x32_bf16 v[164:167], a[36:39], v[52:55], v[164:167]
s_add_u32 m0, s19, 0x0
v_cvt_pk_bf16_f32 v76, v28, v29
v_mfma_f32_16x16x32_bf16 v[132:135], a[36:39], v[48:51], v[132:135]
buffer_load_dwordx4 v3, s[48:51], s32 offen offset:0 sc1 lds
v_mfma_f32_16x16x32_bf16 v[136:139], a[40:43], v[48:51], v[136:139]
ds_read_b128 a[8:11], v2 offset:10240
v_mfma_f32_16x16x32_bf16 v[168:171], a[40:43], v[52:55], v[168:171]
v_exp_f32 v31, v31
v_mfma_f32_16x16x32_bf16 v[200:203], a[40:43], v[56:59], v[200:203]
v_exp_f32 v32, v32
v_mfma_f32_16x16x32_bf16 v[232:235], a[40:43], v[60:63], v[232:235]
ds_read_b128 a[12:15], v2 offset:11264
v_cvt_pk_bf16_f32 v77, v30, v31
v_mfma_f32_16x16x32_bf16 v[236:239], a[44:47], v[60:63], v[236:239]
v_mfma_f32_16x16x32_bf16 v[204:207], a[44:47], v[56:59], v[204:207]
v_exp_f32 v33, v33
v_mfma_f32_16x16x32_bf16 v[172:175], a[44:47], v[52:55], v[172:175]
v_exp_f32 v34, v34
v_mfma_f32_16x16x32_bf16 v[140:143], a[44:47], v[48:51], v[140:143]
ds_read_b128 a[16:19], v2 offset:12288
v_cvt_pk_bf16_f32 v66, v32, v33
v_mfma_f32_16x16x32_bf16 v[144:147], a[48:51], v[48:51], v[144:147]
v_mfma_f32_16x16x32_bf16 v[176:179], a[48:51], v[52:55], v[176:179]
v_exp_f32 v35, v35
v_mfma_f32_16x16x32_bf16 v[208:211], a[48:51], v[56:59], v[208:211]
v_exp_f32 v36, v36
v_mfma_f32_16x16x32_bf16 v[240:243], a[48:51], v[60:63], v[240:243]
ds_read_b128 a[20:23], v2 offset:13312
v_cvt_pk_bf16_f32 v67, v34, v35
v_mfma_f32_16x16x32_bf16 v[244:247], a[52:55], v[60:63], v[244:247]
v_exp_f32 v37, v37
v_mfma_f32_16x16x32_bf16 v[212:215], a[52:55], v[56:59], v[212:215]
v_cvt_pk_bf16_f32 v70, v36, v37
v_mfma_f32_16x16x32_bf16 v[180:183], a[52:55], v[52:55], v[180:183]
ds_read_b128 a[24:27], v2 offset:14336
v_mfma_f32_16x16x32_bf16 v[148:151], a[52:55], v[48:51], v[148:151]
buffer_load_dwordx4 v3, s[48:51], s32 offen offset:1024 sc1 lds
v_mfma_f32_16x16x32_bf16 v[152:155], a[56:59], v[48:51], v[152:155]
v_exp_f32 v38, v38
v_mfma_f32_16x16x32_bf16 v[184:187], a[56:59], v[52:55], v[184:187]
v_exp_f32 v39, v39
v_mfma_f32_16x16x32_bf16 v[216:219], a[56:59], v[56:59], v[216:219]
ds_read_b128 a[28:31], v2 offset:15360
v_cvt_pk_bf16_f32 v71, v38, v39
v_mfma_f32_16x16x32_bf16 v[248:251], a[56:59], v[60:63], v[248:251]
v_mfma_f32_16x16x32_bf16 v[252:255], a[60:63], v[60:63], v[252:255]
v_exp_f32 v40, v40
v_mfma_f32_16x16x32_bf16 v[220:223], a[60:63], v[56:59], v[220:223]
v_exp_f32 v41, v41
v_mfma_f32_16x16x32_bf16 v[188:191], a[60:63], v[52:55], v[188:191]
ds_read_b128 a[32:35], v2 offset:0
v_cvt_pk_bf16_f32 v74, v40, v41
v_mfma_f32_16x16x32_bf16 v[156:159], a[60:63], v[48:51], v[156:159]
v_smfmac_f32_16x16x64_bf16 a[224:227], a[232:235], v[48:55], v9
v_exp_f32 v42, v42
v_smfmac_f32_16x16x64_bf16 a[228:231], a[232:235], v[56:63], v9
s_waitcnt lgkmcnt(5)
v_exp_f32 v43, v43
v_mfma_f32_16x16x32_bf16 v[16:19], a[0:3], a[160:163], v[80:83]
ds_read_b128 a[36:39], v2 offset:1024
v_cvt_pk_bf16_f32 v75, v42, v43
v_mfma_f32_16x16x32_bf16 v[16:19], a[4:7], a[164:167], v[16:19]
v_exp_f32 v44, v44
v_mfma_f32_16x16x32_bf16 v[16:19], a[8:11], a[168:171], v[16:19]
v_mfma_f32_16x16x32_bf16 v[16:19], a[12:15], a[172:175], v[16:19]
v_exp_f32 v45, v45
v_mfma_f32_16x16x32_bf16 v[20:23], a[0:3], a[176:179], v[84:87]
ds_read_b128 a[40:43], v2 offset:2048
v_cvt_pk_bf16_f32 v78, v44, v45
v_mfma_f32_16x16x32_bf16 v[20:23], a[4:7], a[180:183], v[20:23]
buffer_load_dwordx4 v3, s[48:51], s32 offen offset:2048 sc1 lds
v_mfma_f32_16x16x32_bf16 v[20:23], a[8:11], a[184:187], v[20:23]
v_exp_f32 v46, v46
v_mfma_f32_16x16x32_bf16 v[20:23], a[12:15], a[188:191], v[20:23]
ds_read_b128 a[44:47], v2 offset:3072
v_mfma_f32_16x16x32_bf16 v[24:27], a[0:3], a[192:195], v[88:91]
v_mfma_f32_16x16x32_bf16 v[24:27], a[4:7], a[196:199], v[24:27]
v_exp_f32 v47, v47
v_mfma_f32_16x16x32_bf16 v[24:27], a[8:11], a[200:203], v[24:27]
v_exp_f32 v16, v16
v_mfma_f32_16x16x32_bf16 v[24:27], a[12:15], a[204:207], v[24:27]
ds_read_b128 a[48:51], v2 offset:4096
v_cvt_pk_bf16_f32 v79, v46, v47
v_mfma_f32_16x16x32_bf16 v[28:31], a[0:3], a[208:211], v[92:95]
v_mfma_f32_16x16x32_bf16 v[28:31], a[4:7], a[212:215], v[28:31]
v_exp_f32 v17, v17
v_mfma_f32_16x16x32_bf16 v[28:31], a[8:11], a[216:219], v[28:31]
s_waitcnt lgkmcnt(5)
v_exp_f32 v18, v18
v_mfma_f32_16x16x32_bf16 v[28:31], a[12:15], a[220:223], v[28:31]
ds_read_b128 a[52:55], v2 offset:5120
v_cvt_pk_bf16_f32 v48, v16, v17
v_mfma_f32_16x16x32_bf16 v[32:35], a[16:19], a[160:163], v[80:83]
v_mfma_f32_16x16x32_bf16 v[32:35], a[20:23], a[164:167], v[32:35]
v_exp_f32 v19, v19
v_mfma_f32_16x16x32_bf16 v[32:35], a[24:27], a[168:171], v[32:35]
v_exp_f32 v20, v20
v_mfma_f32_16x16x32_bf16 v[32:35], a[28:31], a[172:175], v[32:35]
ds_read_b128 a[56:59], v2 offset:6144
v_cvt_pk_bf16_f32 v49, v18, v19
v_mfma_f32_16x16x32_bf16 v[36:39], a[16:19], a[176:179], v[84:87]
v_exp_f32 v21, v21
v_mfma_f32_16x16x32_bf16 v[36:39], a[20:23], a[180:183], v[36:39]
buffer_load_dwordx4 v3, s[48:51], s32 offen offset:3072 sc1 lds
v_mfma_f32_16x16x32_bf16 v[36:39], a[24:27], a[184:187], v[36:39]
s_add_u32 s32, s32, 0x8000
v_cvt_pk_bf16_f32 v52, v20, v21
v_mfma_f32_16x16x32_bf16 v[36:39], a[28:31], a[188:191], v[36:39]
ds_read_b128 a[60:63], v2 offset:7168
v_mfma_f32_16x16x32_bf16 v[40:43], a[16:19], a[192:195], v[88:91]
v_exp_f32 v22, v22
v_mfma_f32_16x16x32_bf16 v[40:43], a[20:23], a[196:199], v[40:43]
v_exp_f32 v23, v23
v_mfma_f32_16x16x32_bf16 v[40:43], a[24:27], a[200:203], v[40:43]
v_cvt_pk_bf16_f32 v53, v22, v23
v_mfma_f32_16x16x32_bf16 v[40:43], a[28:31], a[204:207], v[40:43]
v_exp_f32 v24, v24
v_mfma_f32_16x16x32_bf16 v[44:47], a[16:19], a[208:211], v[92:95]
v_exp_f32 v25, v25
v_mfma_f32_16x16x32_bf16 v[44:47], a[20:23], a[212:215], v[44:47]
v_exp_f32 v26, v26
v_mfma_f32_16x16x32_bf16 v[44:47], a[24:27], a[216:219], v[44:47]
v_exp_f32 v27, v27
v_mfma_f32_16x16x32_bf16 v[44:47], a[28:31], a[220:223], v[44:47]
s_waitcnt lgkmcnt(0)
v_mfma_f32_16x16x32_bf16 v[128:131], a[32:35], v[64:67], v[128:131]
ds_read_b128 a[0:3], v2 offset:24576
v_cvt_pk_bf16_f32 v56, v24, v25
v_mfma_f32_16x16x32_bf16 v[160:163], a[32:35], v[68:71], v[160:163]
v_exp_f32 v28, v28
v_mfma_f32_16x16x32_bf16 v[192:195], a[32:35], v[72:75], v[192:195]
v_cvt_pk_bf16_f32 v57, v26, v27
v_mfma_f32_16x16x32_bf16 v[224:227], a[32:35], v[76:79], v[224:227]
ds_read_b128 a[4:7], v2 offset:25600
v_mfma_f32_16x16x32_bf16 v[228:231], a[36:39], v[76:79], v[228:231]
v_exp_f32 v29, v29
v_mfma_f32_16x16x32_bf16 v[196:199], a[36:39], v[72:75], v[196:199]
v_exp_f32 v30, v30
v_mfma_f32_16x16x32_bf16 v[164:167], a[36:39], v[68:71], v[164:167]
s_add_u32 m0, s19, 0x1000
v_cvt_pk_bf16_f32 v60, v28, v29
v_mfma_f32_16x16x32_bf16 v[132:135], a[36:39], v[64:67], v[132:135]
buffer_load_dwordx4 v3, s[48:51], s7 offen offset:0 sc1 lds
v_mfma_f32_16x16x32_bf16 v[136:139], a[40:43], v[64:67], v[136:139]
ds_read_b128 a[8:11], v2 offset:26624
v_mfma_f32_16x16x32_bf16 v[168:171], a[40:43], v[68:71], v[168:171]
v_exp_f32 v31, v31
v_mfma_f32_16x16x32_bf16 v[200:203], a[40:43], v[72:75], v[200:203]
v_exp_f32 v32, v32
v_mfma_f32_16x16x32_bf16 v[232:235], a[40:43], v[76:79], v[232:235]
ds_read_b128 a[12:15], v2 offset:27648
v_cvt_pk_bf16_f32 v61, v30, v31
v_mfma_f32_16x16x32_bf16 v[236:239], a[44:47], v[76:79], v[236:239]
v_mfma_f32_16x16x32_bf16 v[204:207], a[44:47], v[72:75], v[204:207]
v_exp_f32 v33, v33
v_mfma_f32_16x16x32_bf16 v[172:175], a[44:47], v[68:71], v[172:175]
v_exp_f32 v34, v34
v_mfma_f32_16x16x32_bf16 v[140:143], a[44:47], v[64:67], v[140:143]
ds_read_b128 a[16:19], v2 offset:28672
v_cvt_pk_bf16_f32 v50, v32, v33
v_mfma_f32_16x16x32_bf16 v[144:147], a[48:51], v[64:67], v[144:147]
v_exp_f32 v35, v35
v_mfma_f32_16x16x32_bf16 v[176:179], a[48:51], v[68:71], v[176:179]
v_cvt_pk_bf16_f32 v51, v34, v35
v_mfma_f32_16x16x32_bf16 v[208:211], a[48:51], v[72:75], v[208:211]
ds_read_b128 a[20:23], v2 offset:29696
v_mfma_f32_16x16x32_bf16 v[240:243], a[48:51], v[76:79], v[240:243]
v_exp_f32 v36, v36
v_mfma_f32_16x16x32_bf16 v[244:247], a[52:55], v[76:79], v[244:247]
v_exp_f32 v37, v37
v_mfma_f32_16x16x32_bf16 v[212:215], a[52:55], v[72:75], v[212:215]
v_cvt_pk_bf16_f32 v54, v36, v37
v_mfma_f32_16x16x32_bf16 v[180:183], a[52:55], v[68:71], v[180:183]
buffer_load_dwordx4 v3, s[48:51], s7 offen offset:1024 sc1 lds
v_mfma_f32_16x16x32_bf16 v[148:151], a[52:55], v[64:67], v[148:151]
ds_read_b128 a[24:27], v2 offset:30720
v_mfma_f32_16x16x32_bf16 v[152:155], a[56:59], v[64:67], v[152:155]
v_exp_f32 v38, v38
v_mfma_f32_16x16x32_bf16 v[184:187], a[56:59], v[68:71], v[184:187]
v_exp_f32 v39, v39
v_mfma_f32_16x16x32_bf16 v[216:219], a[56:59], v[72:75], v[216:219]
ds_read_b128 a[28:31], v2 offset:31744
v_cvt_pk_bf16_f32 v55, v38, v39
v_mfma_f32_16x16x32_bf16 v[248:251], a[56:59], v[76:79], v[248:251]
v_exp_f32 v40, v40
v_mfma_f32_16x16x32_bf16 v[252:255], a[60:63], v[76:79], v[252:255]
v_mfma_f32_16x16x32_bf16 v[220:223], a[60:63], v[72:75], v[220:223]
v_exp_f32 v41, v41
v_mfma_f32_16x16x32_bf16 v[188:191], a[60:63], v[68:71], v[188:191]
ds_read_b128 a[32:35], v2 offset:16384
v_cvt_pk_bf16_f32 v58, v40, v41
v_mfma_f32_16x16x32_bf16 v[156:159], a[60:63], v[64:67], v[156:159]
v_exp_f32 v42, v42
v_smfmac_f32_16x16x64_bf16 a[224:227], a[232:235], v[64:71], v9
s_waitcnt lgkmcnt(5)
v_smfmac_f32_16x16x64_bf16 a[228:231], a[232:235], v[72:79], v9
ds_read_b128 a[36:39], v2 offset:17408
v_mfma_f32_16x16x32_bf16 v[16:19], a[0:3], a[160:163], v[80:83]
v_exp_f32 v43, v43
v_mfma_f32_16x16x32_bf16 v[16:19], a[4:7], a[164:167], v[16:19]
v_exp_f32 v44, v44
v_mfma_f32_16x16x32_bf16 v[16:19], a[8:11], a[168:171], v[16:19]
buffer_load_dwordx4 v3, s[48:51], s7 offen offset:2048 sc1 lds
v_mfma_f32_16x16x32_bf16 v[16:19], a[12:15], a[172:175], v[16:19]
ds_read_b128 a[40:43], v2 offset:18432
v_cvt_pk_bf16_f32 v59, v42, v43
v_mfma_f32_16x16x32_bf16 v[20:23], a[0:3], a[176:179], v[84:87]
v_exp_f32 v45, v45
v_mfma_f32_16x16x32_bf16 v[20:23], a[4:7], a[180:183], v[20:23]
v_cvt_pk_bf16_f32 v62, v44, v45
v_mfma_f32_16x16x32_bf16 v[20:23], a[8:11], a[184:187], v[20:23]
v_exp_f32 v46, v46
v_mfma_f32_16x16x32_bf16 v[20:23], a[12:15], a[188:191], v[20:23]
ds_read_b128 a[44:47], v2 offset:19456
v_mfma_f32_16x16x32_bf16 v[24:27], a[0:3], a[192:195], v[88:91]
v_exp_f32 v47, v47
v_mfma_f32_16x16x32_bf16 v[24:27], a[4:7], a[196:199], v[24:27]
v_cvt_pk_bf16_f32 v63, v46, v47
v_mfma_f32_16x16x32_bf16 v[24:27], a[8:11], a[200:203], v[24:27]
v_exp_f32 v16, v16
v_mfma_f32_16x16x32_bf16 v[24:27], a[12:15], a[204:207], v[24:27]
ds_read_b128 a[48:51], v2 offset:20480
v_mfma_f32_16x16x32_bf16 v[28:31], a[0:3], a[208:211], v[92:95]
v_exp_f32 v17, v17
v_mfma_f32_16x16x32_bf16 v[28:31], a[4:7], a[212:215], v[28:31]
v_exp_f32 v18, v18
v_mfma_f32_16x16x32_bf16 v[28:31], a[8:11], a[216:219], v[28:31]
ds_read_b128 a[52:55], v2 offset:21504
v_cvt_pk_bf16_f32 v64, v16, v17
v_mfma_f32_16x16x32_bf16 v[28:31], a[12:15], a[220:223], v[28:31]
s_waitcnt lgkmcnt(6)
v_mfma_f32_16x16x32_bf16 v[32:35], a[16:19], a[160:163], v[80:83]
v_exp_f32 v19, v19
v_mfma_f32_16x16x32_bf16 v[32:35], a[20:23], a[164:167], v[32:35]
buffer_load_dwordx4 v3, s[48:51], s7 offen offset:3072 sc1 lds
v_mfma_f32_16x16x32_bf16 v[32:35], a[24:27], a[168:171], v[32:35]
ds_read_b128 a[56:59], v2 offset:22528
v_cvt_pk_bf16_f32 v65, v18, v19
v_mfma_f32_16x16x32_bf16 v[32:35], a[28:31], a[172:175], v[32:35]
s_add_u32 s7, s7, 0x8000
v_exp_f32 v20, v20
v_mfma_f32_16x16x32_bf16 v[36:39], a[16:19], a[176:179], v[84:87]
s_xor_b32 s19, s19, 0x8000
v_mfma_f32_16x16x32_bf16 v[36:39], a[20:23], a[180:183], v[36:39]
s_sub_u32 s15, s15, 1
v_exp_f32 v21, v21
v_mfma_f32_16x16x32_bf16 v[36:39], a[24:27], a[184:187], v[36:39]
ds_read_b128 a[60:63], v2 offset:23552
v_xor_b32 v2, 0x38000, v2
v_mfma_f32_16x16x32_bf16 v[36:39], a[28:31], a[188:191], v[36:39]
s_cmp_lg_u32 s15, 0
v_exp_f32 v22, v22
v_mfma_f32_16x16x32_bf16 v[40:43], a[16:19], a[192:195], v[88:91]
v_exp_f32 v23, v23
v_mfma_f32_16x16x32_bf16 v[40:43], a[20:23], a[196:199], v[40:43]
v_cvt_pk_bf16_f32 v68, v20, v21
v_cvt_pk_bf16_f32 v69, v22, v23
v_mfma_f32_16x16x32_bf16 v[40:43], a[24:27], a[200:203], v[40:43]
v_exp_f32 v24, v24
v_mfma_f32_16x16x32_bf16 v[40:43], a[28:31], a[204:207], v[40:43]
v_exp_f32 v25, v25
v_mfma_f32_16x16x32_bf16 v[44:47], a[16:19], a[208:211], v[92:95]
s_waitcnt vmcnt(16) lgkmcnt(0)
v_exp_f32 v26, v26
v_mfma_f32_16x16x32_bf16 v[44:47], a[20:23], a[212:215], v[44:47]
s_barrier
v_exp_f32 v27, v27
v_mfma_f32_16x16x32_bf16 v[44:47], a[24:27], a[216:219], v[44:47]
v_mfma_f32_16x16x32_bf16 v[44:47], a[28:31], a[220:223], v[44:47]
s_cbranch_scc1 L_att_deven1
L_att_ddone:
s_cmp_ge_u32 s4, 2
s_cbranch_scc1 L_att_dl0_1
L_att_dl0_0:
v_mfma_f32_16x16x32_bf16 v[128:131], a[32:35], v[48:51], v[128:131]
ds_read_b128 a[0:3], v1 offset:8192
v_cvt_pk_bf16_f32 v72, v24, v25
v_mfma_f32_16x16x32_bf16 v[160:163], a[32:35], v[52:55], v[160:163]
v_exp_f32 v28, v28
v_mfma_f32_16x16x32_bf16 v[192:195], a[32:35], v[56:59], v[192:195]
v_cvt_pk_bf16_f32 v73, v26, v27
v_mfma_f32_16x16x32_bf16 v[224:227], a[32:35], v[60:63], v[224:227]
ds_read_b128 a[4:7], v1 offset:9216
v_mfma_f32_16x16x32_bf16 v[228:231], a[36:39], v[60:63], v[228:231]
v_exp_f32 v29, v29
v_mfma_f32_16x16x32_bf16 v[196:199], a[36:39], v[56:59], v[196:199]
s_add_u32 m0, s27, 0x0
v_exp_f32 v30, v30
v_mfma_f32_16x16x32_bf16 v[164:167], a[36:39], v[52:55], v[164:167]
buffer_load_dwordx4 v3, s[48:51], s32 offen offset:0 sc1 lds
v_mfma_f32_16x16x32_bf16 v[132:135], a[36:39], v[48:51], v[132:135]
ds_read_b128 a[8:11], v1 offset:10240
v_cvt_pk_bf16_f32 v76, v28, v29
v_mfma_f32_16x16x32_bf16 v[136:139], a[40:43], v[48:51], v[136:139]
v_mfma_f32_16x16x32_bf16 v[168:171], a[40:43], v[52:55], v[168:171]
v_exp_f32 v31, v31
v_mfma_f32_16x16x32_bf16 v[200:203], a[40:43], v[56:59], v[200:203]
v_exp_f32 v32, v32
v_mfma_f32_16x16x32_bf16 v[232:235], a[40:43], v[60:63], v[232:235]
ds_read_b128 a[12:15], v1 offset:11264
v_cvt_pk_bf16_f32 v77, v30, v31
v_mfma_f32_16x16x32_bf16 v[236:239], a[44:47], v[60:63], v[236:239]
v_mfma_f32_16x16x32_bf16 v[204:207], a[44:47], v[56:59], v[204:207]
v_exp_f32 v33, v33
v_mfma_f32_16x16x32_bf16 v[172:175], a[44:47], v[52:55], v[172:175]
v_exp_f32 v34, v34
v_mfma_f32_16x16x32_bf16 v[140:143], a[44:47], v[48:51], v[140:143]
ds_read_b128 a[16:19], v1 offset:12288
v_cvt_pk_bf16_f32 v66, v32, v33
v_mfma_f32_16x16x32_bf16 v[144:147], a[48:51], v[48:51], v[144:147]
v_exp_f32 v35, v35
v_mfma_f32_16x16x32_bf16 v[176:179], a[48:51], v[52:55], v[176:179]
v_cvt_pk_bf16_f32 v67, v34, v35
v_mfma_f32_16x16x32_bf16 v[208:211], a[48:51], v[56:59], v[208:211]
v_exp_f32 v36, v36
v_mfma_f32_16x16x32_bf16 v[240:243], a[48:51], v[60:63], v[240:243]
buffer_load_dwordx4 v3, s[48:51], s32 offen offset:1024 sc1 lds
v_mfma_f32_16x16x32_bf16 v[244:247], a[52:55], v[60:63], v[244:247]
ds_read_b128 a[20:23], v1 offset:13312
v_mfma_f32_16x16x32_bf16 v[212:215], a[52:55], v[56:59], v[212:215]
v_exp_f32 v37, v37
v_mfma_f32_16x16x32_bf16 v[180:183], a[52:55], v[52:55], v[180:183]
ds_read_b128 a[24:27], v1 offset:14336
v_cvt_pk_bf16_f32 v70, v36, v37
v_mfma_f32_16x16x32_bf16 v[148:151], a[52:55], v[48:51], v[148:151]
v_mfma_f32_16x16x32_bf16 v[152:155], a[56:59], v[48:51], v[152:155]
v_exp_f32 v38, v38
v_mfma_f32_16x16x32_bf16 v[184:187], a[56:59], v[52:55], v[184:187]
v_exp_f32 v39, v39
v_mfma_f32_16x16x32_bf16 v[216:219], a[56:59], v[56:59], v[216:219]
ds_read_b128 a[28:31], v1 offset:15360
v_cvt_pk_bf16_f32 v71, v38, v39
v_mfma_f32_16x16x32_bf16 v[248:251], a[56:59], v[60:63], v[248:251]
v_exp_f32 v40, v40
v_mfma_f32_16x16x32_bf16 v[252:255], a[60:63], v[60:63], v[252:255]
v_mfma_f32_16x16x32_bf16 v[220:223], a[60:63], v[56:59], v[220:223]
v_exp_f32 v41, v41
v_mfma_f32_16x16x32_bf16 v[188:191], a[60:63], v[52:55], v[188:191]
ds_read_b128 a[32:35], v1 offset:0
v_cvt_pk_bf16_f32 v74, v40, v41
v_mfma_f32_16x16x32_bf16 v[156:159], a[60:63], v[48:51], v[156:159]
v_exp_f32 v42, v42
v_smfmac_f32_16x16x64_bf16 a[224:227], a[232:235], v[48:55], v9
buffer_load_dwordx4 v3, s[48:51], s32 offen offset:2048 sc1 lds
v_smfmac_f32_16x16x64_bf16 a[228:231], a[232:235], v[56:63], v9
s_waitcnt lgkmcnt(5)
v_mfma_f32_16x16x32_bf16 v[16:19], a[0:3], a[160:163], v[96:99]
ds_read_b128 a[36:39], v1 offset:1024
v_mfma_f32_16x16x32_bf16 v[16:19], a[4:7], a[164:167], v[16:19]
v_exp_f32 v43, v43
v_mfma_f32_16x16x32_bf16 v[16:19], a[8:11], a[168:171], v[16:19]
v_exp_f32 v44, v44
v_mfma_f32_16x16x32_bf16 v[16:19], a[12:15], a[172:175], v[16:19]
v_exp_f32 v45, v45
v_mfma_f32_16x16x32_bf16 v[20:23], a[0:3], a[176:179], v[84:87]
ds_read_b128 a[40:43], v1 offset:2048
v_cvt_pk_bf16_f32 v75, v42, v43
v_mfma_f32_16x16x32_bf16 v[20:23], a[4:7], a[180:183], v[20:23]
v_cvt_pk_bf16_f32 v78, v44, v45
v_mfma_f32_16x16x32_bf16 v[20:23], a[8:11], a[184:187], v[20:23]
v_exp_f32 v46, v46
v_mfma_f32_16x16x32_bf16 v[20:23], a[12:15], a[188:191], v[20:23]
ds_read_b128 a[44:47], v1 offset:3072
v_mfma_f32_16x16x32_bf16 v[24:27], a[0:3], a[192:195], v[88:91]
v_exp_f32 v47, v47
v_mfma_f32_16x16x32_bf16 v[24:27], a[4:7], a[196:199], v[24:27]
v_cvt_pk_bf16_f32 v79, v46, v47
v_mfma_f32_16x16x32_bf16 v[24:27], a[8:11], a[200:203], v[24:27]
buffer_load_dwordx4 v3, s[48:51], s32 offen offset:3072 sc1 lds
v_mfma_f32_16x16x32_bf16 v[24:27], a[12:15], a[204:207], v[24:27]
ds_read_b128 a[48:51], v1 offset:4096
v_mfma_f32_16x16x32_bf16 v[28:31], a[0:3], a[208:211], v[92:95]
v_exp_f32 v16, v16
v_mfma_f32_16x16x32_bf16 v[28:31], a[4:7], a[212:215], v[28:31]
v_exp_f32 v17, v17
v_mfma_f32_16x16x32_bf16 v[28:31], a[8:11], a[216:219], v[28:31]
s_waitcnt lgkmcnt(5)
v_exp_f32 v18, v18
v_mfma_f32_16x16x32_bf16 v[28:31], a[12:15], a[220:223], v[28:31]
ds_read_b128 a[52:55], v1 offset:5120
v_cvt_pk_bf16_f32 v48, v16, v17
v_mfma_f32_16x16x32_bf16 v[32:35], a[16:19], a[160:163], v[100:103]
v_mfma_f32_16x16x32_bf16 v[32:35], a[20:23], a[164:167], v[32:35]
v_exp_f32 v19, v19
v_mfma_f32_16x16x32_bf16 v[32:35], a[24:27], a[168:171], v[32:35]
v_exp_f32 v20, v20
v_mfma_f32_16x16x32_bf16 v[32:35], a[28:31], a[172:175], v[32:35]
ds_read_b128 a[56:59], v1 offset:6144
v_cvt_pk_bf16_f32 v49, v18, v19
v_mfma_f32_16x16x32_bf16 v[36:39], a[16:19], a[176:179], v[84:87]
v_mfma_f32_16x16x32_bf16 v[36:39], a[20:23], a[180:183], v[36:39]
v_exp_f32 v21, v21
v_mfma_f32_16x16x32_bf16 v[36:39], a[24:27], a[184:187], v[36:39]
s_add_u32 m0, s27, 0x1000
v_exp_f32 v22, v22
v_mfma_f32_16x16x32_bf16 v[36:39], a[28:31], a[188:191], v[36:39]
buffer_load_dwordx4 v3, s[48:51], s7 offen offset:0 sc1 lds
v_mfma_f32_16x16x32_bf16 v[40:43], a[16:19], a[192:195], v[88:91]
ds_read_b128 a[60:63], v1 offset:7168
v_cvt_pk_bf16_f32 v52, v20, v21
v_mfma_f32_16x16x32_bf16 v[40:43], a[20:23], a[196:199], v[40:43]
v_exp_f32 v23, v23
v_mfma_f32_16x16x32_bf16 v[40:43], a[24:27], a[200:203], v[40:43]
v_cvt_pk_bf16_f32 v53, v22, v23
v_mfma_f32_16x16x32_bf16 v[40:43], a[28:31], a[204:207], v[40:43]
v_exp_f32 v24, v24
v_mfma_f32_16x16x32_bf16 v[44:47], a[16:19], a[208:211], v[92:95]
v_exp_f32 v25, v25
v_mfma_f32_16x16x32_bf16 v[44:47], a[20:23], a[212:215], v[44:47]
v_exp_f32 v26, v26
v_mfma_f32_16x16x32_bf16 v[44:47], a[24:27], a[216:219], v[44:47]
v_exp_f32 v27, v27
v_mfma_f32_16x16x32_bf16 v[44:47], a[28:31], a[220:223], v[44:47]
s_waitcnt lgkmcnt(0)
v_mfma_f32_16x16x32_bf16 v[128:131], a[32:35], v[64:67], v[128:131]
ds_read_b128 a[0:3], v1 offset:24576
v_cvt_pk_bf16_f32 v56, v24, v25
v_mfma_f32_16x16x32_bf16 v[160:163], a[32:35], v[68:71], v[160:163]
v_exp_f32 v28, v28
v_mfma_f32_16x16x32_bf16 v[192:195], a[32:35], v[72:75], v[192:195]
v_cvt_pk_bf16_f32 v57, v26, v27
v_mfma_f32_16x16x32_bf16 v[224:227], a[32:35], v[76:79], v[224:227]
ds_read_b128 a[4:7], v1 offset:25600
v_mfma_f32_16x16x32_bf16 v[228:231], a[36:39], v[76:79], v[228:231]
v_exp_f32 v29, v29
v_mfma_f32_16x16x32_bf16 v[196:199], a[36:39], v[72:75], v[196:199]
v_exp_f32 v30, v30
v_mfma_f32_16x16x32_bf16 v[164:167], a[36:39], v[68:71], v[164:167]
buffer_load_dwordx4 v3, s[48:51], s7 offen offset:1024 sc1 lds
v_mfma_f32_16x16x32_bf16 v[132:135], a[36:39], v[64:67], v[132:135]
ds_read_b128 a[8:11], v1 offset:26624
v_cvt_pk_bf16_f32 v60, v28, v29
v_mfma_f32_16x16x32_bf16 v[136:139], a[40:43], v[64:67], v[136:139]
v_mfma_f32_16x16x32_bf16 v[168:171], a[40:43], v[68:71], v[168:171]
ds_read_b128 a[12:15], v1 offset:27648
v_mfma_f32_16x16x32_bf16 v[200:203], a[40:43], v[72:75], v[200:203]
v_exp_f32 v31, v31
v_mfma_f32_16x16x32_bf16 v[232:235], a[40:43], v[76:79], v[232:235]
v_exp_f32 v32, v32
v_mfma_f32_16x16x32_bf16 v[236:239], a[44:47], v[76:79], v[236:239]
v_exp_f32 v33, v33
v_mfma_f32_16x16x32_bf16 v[204:207], a[44:47], v[72:75], v[204:207]
ds_read_b128 a[16:19], v1 offset:28672
v_cvt_pk_bf16_f32 v61, v30, v31
v_mfma_f32_16x16x32_bf16 v[172:175], a[44:47], v[68:71], v[172:175]
v_cvt_pk_bf16_f32 v50, v32, v33
v_mfma_f32_16x16x32_bf16 v[140:143], a[44:47], v[64:67], v[140:143]
v_exp_f32 v34, v34
v_mfma_f32_16x16x32_bf16 v[144:147], a[48:51], v[64:67], v[144:147]
ds_read_b128 a[20:23], v1 offset:29696
v_mfma_f32_16x16x32_bf16 v[176:179], a[48:51], v[68:71], v[176:179]
v_exp_f32 v35, v35
v_mfma_f32_16x16x32_bf16 v[208:211], a[48:51], v[72:75], v[208:211]
v_exp_f32 v36, v36
v_mfma_f32_16x16x32_bf16 v[240:243], a[48:51], v[76:79], v[240:243]
buffer_load_dwordx4 v3, s[48:51], s7 offen offset:2048 sc1 lds
v_mfma_f32_16x16x32_bf16 v[244:247], a[52:55], v[76:79], v[244:247]
ds_read_b128 a[24:27], v1 offset:30720
v_cvt_pk_bf16_f32 v51, v34, v35
v_mfma_f32_16x16x32_bf16 v[212:215], a[52:55], v[72:75], v[212:215]
v_mfma_f32_16x16x32_bf16 v[180:183], a[52:55], v[68:71], v[180:183]
ds_read_b128 a[28:31], v1 offset:31744
v_mfma_f32_16x16x32_bf16 v[148:151], a[52:55], v[64:67], v[148:151]
v_exp_f32 v37, v37
v_mfma_f32_16x16x32_bf16 v[152:155], a[56:59], v[64:67], v[152:155]
v_exp_f32 v38, v38
v_mfma_f32_16x16x32_bf16 v[184:187], a[56:59], v[68:71], v[184:187]
v_exp_f32 v39, v39
v_mfma_f32_16x16x32_bf16 v[216:219], a[56:59], v[72:75], v[216:219]
ds_read_b128 a[32:35], v1 offset:16384
v_cvt_pk_bf16_f32 v54, v36, v37
v_mfma_f32_16x16x32_bf16 v[248:251], a[56:59], v[76:79], v[248:251]
v_cvt_pk_bf16_f32 v55, v38, v39
v_mfma_f32_16x16x32_bf16 v[252:255], a[60:63], v[76:79], v[252:255]
v_exp_f32 v40, v40
v_mfma_f32_16x16x32_bf16 v[220:223], a[60:63], v[72:75], v[220:223]
ds_read_b128 a[36:39], v1 offset:17408
v_mfma_f32_16x16x32_bf16 v[188:191], a[60:63], v[68:71], v[188:191]
v_exp_f32 v41, v41
v_mfma_f32_16x16x32_bf16 v[156:159], a[60:63], v[64:67], v[156:159]
s_waitcnt lgkmcnt(6)
v_exp_f32 v42, v42
v_smfmac_f32_16x16x64_bf16 a[224:227], a[232:235], v[64:71], v9
buffer_load_dwordx4 v3, s[48:51], s7 offen offset:3072 sc1 lds
v_smfmac_f32_16x16x64_bf16 a[228:231], a[232:235], v[72:79], v9
ds_read_b128 a[40:43], v1 offset:18432
v_cvt_pk_bf16_f32 v58, v40, v41
v_mfma_f32_16x16x32_bf16 v[20:23], a[0:3], a[176:179], v[84:87]
v_mfma_f32_16x16x32_bf16 v[20:23], a[4:7], a[180:183], v[20:23]
ds_read_b128 a[44:47], v1 offset:19456
v_mfma_f32_16x16x32_bf16 v[20:23], a[8:11], a[184:187], v[20:23]
v_exp_f32 v43, v43
v_mfma_f32_16x16x32_bf16 v[20:23], a[12:15], a[188:191], v[20:23]
v_exp_f32 v44, v44
v_mfma_f32_16x16x32_bf16 v[24:27], a[0:3], a[192:195], v[88:91]
v_cvt_pk_bf16_f32 v59, v42, v43
v_mfma_f32_16x16x32_bf16 v[24:27], a[4:7], a[196:199], v[24:27]
ds_read_b128 a[48:51], v1 offset:20480
v_mfma_f32_16x16x32_bf16 v[24:27], a[8:11], a[200:203], v[24:27]
v_exp_f32 v45, v45
v_mfma_f32_16x16x32_bf16 v[24:27], a[12:15], a[204:207], v[24:27]
v_exp_f32 v46, v46
v_mfma_f32_16x16x32_bf16 v[28:31], a[0:3], a[208:211], v[92:95]
ds_read_b128 a[52:55], v1 offset:21504
v_cvt_pk_bf16_f32 v62, v44, v45
v_mfma_f32_16x16x32_bf16 v[28:31], a[4:7], a[212:215], v[28:31]
s_waitcnt lgkmcnt(6)
v_exp_f32 v47, v47
v_mfma_f32_16x16x32_bf16 v[28:31], a[8:11], a[216:219], v[28:31]
s_mov_b32 s9, 0x0
v_cvt_pk_bf16_f32 v63, v46, v47
v_mfma_f32_16x16x32_bf16 v[28:31], a[12:15], a[220:223], v[28:31]
buffer_load_dword a244, v8, s[72:75], s9 offen
v_mfma_f32_16x16x32_bf16 v[36:39], a[16:19], a[176:179], v[84:87]
ds_read_b128 a[56:59], v1 offset:22528
v_mfma_f32_16x16x32_bf16 v[36:39], a[20:23], a[180:183], v[36:39]
s_add_u32 s32, s32, 0x8000
v_exp_f32 v20, v20
v_mfma_f32_16x16x32_bf16 v[36:39], a[24:27], a[184:187], v[36:39]
ds_read_b128 a[60:63], v1 offset:23552
v_xor_b32 v1, 0x8000, v1
v_mfma_f32_16x16x32_bf16 v[36:39], a[28:31], a[188:191], v[36:39]
s_add_u32 s7, s7, 0x8000
v_exp_f32 v21, v21
v_mfma_f32_16x16x32_bf16 v[40:43], a[16:19], a[192:195], v[88:91]
s_xor_b32 s27, s27, 0x38000
v_exp_f32 v22, v22
v_mfma_f32_16x16x32_bf16 v[40:43], a[20:23], a[196:199], v[40:43]
v_cvt_pk_bf16_f32 v68, v20, v21
v_mfma_f32_16x16x32_bf16 v[40:43], a[24:27], a[200:203], v[40:43]
v_exp_f32 v23, v23
v_mfma_f32_16x16x32_bf16 v[40:43], a[28:31], a[204:207], v[40:43]
v_exp_f32 v24, v24
v_mfma_f32_16x16x32_bf16 v[44:47], a[16:19], a[208:211], v[92:95]
v_exp_f32 v25, v25
v_mfma_f32_16x16x32_bf16 v[44:47], a[20:23], a[212:215], v[44:47]
v_exp_f32 v26, v26
v_mfma_f32_16x16x32_bf16 v[44:47], a[24:27], a[216:219], v[44:47]
s_waitcnt vmcnt(17) lgkmcnt(0)
v_exp_f32 v27, v27
v_mfma_f32_16x16x32_bf16 v[44:47], a[28:31], a[220:223], v[44:47]
s_barrier
v_cvt_pk_bf16_f32 v69, v22, v23
L_att_l1_0:
v_mfma_f32_16x16x32_bf16 v[128:131], a[32:35], v[48:51], v[128:131]
ds_read_b128 a[0:3], v2 offset:8192
v_cvt_pk_bf16_f32 v72, v24, v25
v_mfma_f32_16x16x32_bf16 v[160:163], a[32:35], v[52:55], v[160:163]
s_add_u32 m0, s19, 0x0
v_exp_f32 v28, v28
v_mfma_f32_16x16x32_bf16 v[192:195], a[32:35], v[56:59], v[192:195]
buffer_load_dwordx4 v3, s[48:51], s32 offen offset:0 sc1 lds
v_mfma_f32_16x16x32_bf16 v[224:227], a[32:35], v[60:63], v[224:227]
ds_read_b128 a[4:7], v2 offset:9216
v_cvt_pk_bf16_f32 v73, v26, v27
v_mfma_f32_16x16x32_bf16 v[228:231], a[36:39], v[60:63], v[228:231]
s_and_b32 s44, s18, 3
s_lshl_b32 s45, s44, 1
s_add_u32 s45, s45, s100
v_mfma_f32_16x16x32_bf16 v[196:199], a[36:39], v[56:59], v[196:199]
s_add_u32 s8, s16, 0x0
v_exp_f32 v29, v29
v_mfma_f32_16x16x32_bf16 v[164:167], a[36:39], v[52:55], v[164:167]
ds_read_b128 a[8:11], v2 offset:10240
v_cvt_pk_bf16_f32 v76, v28, v29
v_mfma_f32_16x16x32_bf16 v[132:135], a[36:39], v[48:51], v[132:135]
buffer_store_dwordx4 a[64:67], v3, s[88:91], s8 offen offset:0 sc1
v_mfma_f32_16x16x32_bf16 v[136:139], a[40:43], v[48:51], v[136:139]
s_and_b32 s60, s45, 3
v_exp_f32 v30, v30
v_mfma_f32_16x16x32_bf16 v[168:171], a[40:43], v[52:55], v[168:171]
ds_read_b128 a[12:15], v2 offset:11264
s_sub_u32 s60, s60, s44
v_mfma_f32_16x16x32_bf16 v[200:203], a[40:43], v[56:59], v[200:203]
s_add_u32 s60, s60, 11
v_exp_f32 v31, v31
v_mfma_f32_16x16x32_bf16 v[232:235], a[40:43], v[60:63], v[232:235]
s_lshl_b32 s60, s60, 14
s_mul_i32 s44, s44, -8
v_cvt_pk_bf16_f32 v77, v30, v31
v_mfma_f32_16x16x32_bf16 v[236:239], a[44:47], v[60:63], v[236:239]
buffer_load_dwordx4 v3, s[48:51], s32 offen offset:1024 sc1 lds
v_mfma_f32_16x16x32_bf16 v[204:207], a[44:47], v[56:59], v[204:207]
ds_read_b128 a[16:19], v2 offset:12288
s_and_b32 s44, s44, 31
v_mfma_f32_16x16x32_bf16 v[172:175], a[44:47], v[52:55], v[172:175]
s_lshl_b32 s44, 4, s44
v_exp_f32 v36, v36
v_mfma_f32_16x16x32_bf16 v[140:143], a[44:47], v[48:51], v[140:143]
s_mul_i32 s45, s45, -8
v_exp_f32 v37, v37
v_mfma_f32_16x16x32_bf16 v[144:147], a[48:51], v[48:51], v[144:147]
ds_read_b128 a[20:23], v2 offset:13312
v_cvt_pk_bf16_f32 v70, v36, v37
v_mfma_f32_16x16x32_bf16 v[176:179], a[48:51], v[52:55], v[176:179]
buffer_store_dwordx4 a[64:67], v3, s[88:91], s8 offen offset:1024 sc1
v_mfma_f32_16x16x32_bf16 v[208:211], a[48:51], v[56:59], v[208:211]
s_and_b32 s45, s45, 31
v_exp_f32 v38, v38
v_mfma_f32_16x16x32_bf16 v[240:243], a[48:51], v[60:63], v[240:243]
ds_read_b128 a[24:27], v2 offset:14336
s_lshl_b32 s45, 4, s45
v_mfma_f32_16x16x32_bf16 v[244:247], a[52:55], v[60:63], v[244:247]
s_add_u32 s44, s44, 0x11111111
s_sub_u32 s44, s44, s45
s_bfe_u32 s56, s44, 0x80000
v_mfma_f32_16x16x32_bf16 v[212:215], a[52:55], v[56:59], v[212:215]
s_lshl_b32 s56, s56, 14
v_exp_f32 v39, v39
v_mfma_f32_16x16x32_bf16 v[180:183], a[52:55], v[52:55], v[180:183]
buffer_load_dwordx4 v3, s[48:51], s32 offen offset:2048 sc1 lds
v_mfma_f32_16x16x32_bf16 v[148:151], a[52:55], v[48:51], v[148:151]
ds_read_b128 a[28:31], v2 offset:15360
v_cvt_pk_bf16_f32 v71, v38, v39
v_mfma_f32_16x16x32_bf16 v[152:155], a[56:59], v[48:51], v[152:155]
s_bfe_u32 s57, s44, 0x80008
v_exp_f32 v40, v40
v_mfma_f32_16x16x32_bf16 v[184:187], a[56:59], v[52:55], v[184:187]
s_lshl_b32 s57, s57, 14
v_exp_f32 v41, v41
v_mfma_f32_16x16x32_bf16 v[216:219], a[56:59], v[56:59], v[216:219]
ds_read_b128 a[32:35], v2 offset:0
v_cvt_pk_bf16_f32 v74, v40, v41
v_mfma_f32_16x16x32_bf16 v[248:251], a[56:59], v[60:63], v[248:251]
s_bfe_u32 s58, s44, 0x80010
v_exp_f32 v42, v42
v_mfma_f32_16x16x32_bf16 v[252:255], a[60:63], v[60:63], v[252:255]
buffer_store_dwordx4 a[64:67], v3, s[88:91], s8 offen offset:2048 sc1
v_mfma_f32_16x16x32_bf16 v[220:223], a[60:63], v[56:59], v[220:223]
ds_read_b128 a[36:39], v2 offset:1024
s_lshl_b32 s58, s58, 14
v_mfma_f32_16x16x32_bf16 v[188:191], a[60:63], v[52:55], v[188:191]
s_bfe_u32 s59, s44, 0x80018
s_lshl_b32 s59, s59, 14
v_mov_b32 v6, 0xf149f2ca
v_mfma_f32_16x16x32_bf16 v[156:159], a[60:63], v[48:51], v[156:159]
v_exp_f32 v43, v43
v_smfmac_f32_16x16x64_bf16 a[224:227], a[232:235], v[48:55], v9
s_waitcnt lgkmcnt(6)
v_exp_f32 v44, v44
v_smfmac_f32_16x16x64_bf16 a[228:231], a[232:235], v[56:63], v9
buffer_load_dwordx4 v3, s[48:51], s32 offen offset:3072 sc1 lds
v_mfma_f32_16x16x32_bf16 v[20:23], a[0:3], a[176:179], v[84:87]
ds_read_b128 a[40:43], v2 offset:2048
v_cvt_pk_bf16_f32 v75, v42, v43
v_mfma_f32_16x16x32_bf16 v[20:23], a[4:7], a[180:183], v[20:23]
v_exp_f32 v45, v45
v_mfma_f32_16x16x32_bf16 v[20:23], a[8:11], a[184:187], v[20:23]
ds_read_b128 a[44:47], v2 offset:3072
v_cvt_pk_bf16_f32 v78, v44, v45
v_mfma_f32_16x16x32_bf16 v[20:23], a[12:15], a[188:191], v[20:23]
v_min_f32 v119, s10, v88
v_cndmask_b32 v112, v119, v88, s[36:37]
v_mfma_f32_16x16x32_bf16 v[24:27], a[0:3], a[192:195], v[88:91]
buffer_store_dwordx4 a[64:67], v3, s[88:91], s8 offen offset:3072 sc1
v_mfma_f32_16x16x32_bf16 v[24:27], a[4:7], a[196:199], v[24:27]
ds_read_b128 a[48:51], v2 offset:4096
v_cndmask_b32 v113, v119, v88, s[38:39]
v_mfma_f32_16x16x32_bf16 v[24:27], a[8:11], a[200:203], v[24:27]
v_exp_f32 v46, v46
v_mfma_f32_16x16x32_bf16 v[24:27], a[12:15], a[204:207], v[24:27]
v_exp_f32 v47, v47
v_mfma_f32_16x16x32_bf16 v[28:31], a[0:3], a[208:211], v[92:95]
s_add_u32 m0, s19, 0x1000
v_exp_f32 v20, v20
v_mfma_f32_16x16x32_bf16 v[28:31], a[4:7], a[212:215], v[28:31]
buffer_load_dwordx4 v3, s[48:51], s7 offen offset:0 sc1 lds
v_mfma_f32_16x16x32_bf16 v[28:31], a[8:11], a[216:219], v[28:31]
ds_read_b128 a[52:55], v2 offset:5120
v_cvt_pk_bf16_f32 v79, v46, v47
v_mfma_f32_16x16x32_bf16 v[28:31], a[12:15], a[220:223], v[28:31]
s_waitcnt lgkmcnt(6)
v_exp_f32 v21, v21
v_mfma_f32_16x16x32_bf16 v[36:39], a[16:19], a[176:179], v[84:87]
ds_read_b128 a[56:59], v2 offset:6144
v_cvt_pk_bf16_f32 v52, v20, v21
v_mfma_f32_16x16x32_bf16 v[36:39], a[20:23], a[180:183], v[36:39]
s_add_u32 s8, s16, 0x400000
v_cndmask_b32 v114, v119, v88, s[40:41]
v_cndmask_b32 v115, v119, v88, s[42:43]
v_mfma_f32_16x16x32_bf16 v[36:39], a[24:27], a[184:187], v[36:39]
buffer_store_dwordx4 a[64:67], v3, s[88:91], s8 offen offset:0 sc1
v_mfma_f32_16x16x32_bf16 v[36:39], a[28:31], a[188:191], v[36:39]
ds_read_b128 a[60:63], v2 offset:7168
v_cndmask_b32 v116, v6, v119, s[36:37]
v_mfma_f32_16x16x32_bf16 v[40:43], a[16:19], a[192:195], v[88:91]
v_exp_f32 v22, v22
v_mfma_f32_16x16x32_bf16 v[40:43], a[20:23], a[196:199], v[40:43]
v_exp_f32 v23, v23
v_mfma_f32_16x16x32_bf16 v[40:43], a[24:27], a[200:203], v[40:43]
v_exp_f32 v24, v24
v_mfma_f32_16x16x32_bf16 v[40:43], a[28:31], a[204:207], v[40:43]
buffer_load_dwordx4 v3, s[48:51], s7 offen offset:1024 sc1 lds
v_mfma_f32_16x16x32_bf16 v[44:47], a[16:19], a[208:211], v[92:95]
v_exp_f32 v25, v25
v_mfma_f32_16x16x32_bf16 v[44:47], a[20:23], a[212:215], v[44:47]
v_exp_f32 v26, v26
v_mfma_f32_16x16x32_bf16 v[44:47], a[24:27], a[216:219], v[44:47]
v_exp_f32 v27, v27
v_mfma_f32_16x16x32_bf16 v[44:47], a[28:31], a[220:223], v[44:47]
s_waitcnt lgkmcnt(0)
v_cvt_pk_bf16_f32 v53, v22, v23
v_cndmask_b32 v117, v6, v119, s[38:39]
v_cndmask_b32 v118, v6, v119, s[40:41]
v_cndmask_b32 v119, v6, v119, s[42:43]
v_min_f32 v127, s11, v92
v_cndmask_b32 v120, v127, v92, s[36:37]
v_cndmask_b32 v121, v127, v92, s[38:39]
v_cndmask_b32 v122, v127, v92, s[40:41]
v_cndmask_b32 v123, v127, v92, s[42:43]
v_cndmask_b32 v124, v6, v127, s[36:37]
v_cndmask_b32 v125, v6, v127, s[38:39]
v_cndmask_b32 v126, v6, v127, s[40:41]
v_cndmask_b32 v127, v6, v127, s[42:43]
v_mfma_f32_16x16x32_bf16 v[160:163], a[32:35], v[68:71], v[160:163]
ds_read_b128 a[0:3], v2 offset:24576
v_cvt_pk_bf16_f32 v56, v24, v25
v_mfma_f32_16x16x32_bf16 v[192:195], a[32:35], v[72:75], v[192:195]
v_exp_f32 v28, v28
v_mfma_f32_16x16x32_bf16 v[224:227], a[32:35], v[76:79], v[224:227]
buffer_store_dwordx4 a[64:67], v3, s[88:91], s8 offen offset:1024 sc1
v_mfma_f32_16x16x32_bf16 v[228:231], a[36:39], v[76:79], v[228:231]
ds_read_b128 a[4:7], v2 offset:25600
v_cvt_pk_bf16_f32 v57, v26, v27
v_mfma_f32_16x16x32_bf16 v[196:199], a[36:39], v[72:75], v[196:199]
v_exp_f32 v29, v29
v_mfma_f32_16x16x32_bf16 v[164:167], a[36:39], v[68:71], v[164:167]
ds_read_b128 a[8:11], v2 offset:26624
v_cvt_pk_bf16_f32 v60, v28, v29
v_mfma_f32_16x16x32_bf16 v[168:171], a[40:43], v[68:71], v[168:171]
buffer_load_dwordx4 v3, s[48:51], s7 offen offset:2048 sc1 lds
v_mfma_f32_16x16x32_bf16 v[200:203], a[40:43], v[72:75], v[200:203]
v_exp_f32 v30, v30
v_mfma_f32_16x16x32_bf16 v[232:235], a[40:43], v[76:79], v[232:235]
ds_read_b128 a[12:15], v2 offset:27648
v_mfma_f32_16x16x32_bf16 v[236:239], a[44:47], v[76:79], v[236:239]
v_exp_f32 v31, v31
v_mfma_f32_16x16x32_bf16 v[204:207], a[44:47], v[72:75], v[204:207]
buffer_store_dwordx4 a[64:67], v3, s[88:91], s8 offen offset:2048 sc1
v_mfma_f32_16x16x32_bf16 v[172:175], a[44:47], v[68:71], v[172:175]
ds_read_b128 a[16:19], v2 offset:28672
v_cvt_pk_bf16_f32 v61, v30, v31
v_mfma_f32_16x16x32_bf16 v[176:179], a[48:51], v[68:71], v[176:179]
v_exp_f32 v36, v36
v_mfma_f32_16x16x32_bf16 v[208:211], a[48:51], v[72:75], v[208:211]
ds_read_b128 a[20:23], v2 offset:29696
v_mfma_f32_16x16x32_bf16 v[240:243], a[48:51], v[76:79], v[240:243]
buffer_load_dwordx4 v3, s[48:51], s7 offen offset:3072 sc1 lds
v_mfma_f32_16x16x32_bf16 v[244:247], a[52:55], v[76:79], v[244:247]
v_exp_f32 v37, v37
v_mfma_f32_16x16x32_bf16 v[212:215], a[52:55], v[72:75], v[212:215]
ds_read_b128 a[24:27], v2 offset:30720
v_cvt_pk_bf16_f32 v54, v36, v37
v_mfma_f32_16x16x32_bf16 v[180:183], a[52:55], v[68:71], v[180:183]
v_exp_f32 v38, v38
v_mfma_f32_16x16x32_bf16 v[184:187], a[56:59], v[68:71], v[184:187]
buffer_store_dwordx4 a[64:67], v3, s[88:91], s8 offen offset:3072 sc1
v_mfma_f32_16x16x32_bf16 v[216:219], a[56:59], v[72:75], v[216:219]
ds_read_b128 a[28:31], v2 offset:31744
v_mfma_f32_16x16x32_bf16 v[248:251], a[56:59], v[76:79], v[248:251]
v_exp_f32 v39, v39
v_mfma_f32_16x16x32_bf16 v[252:255], a[60:63], v[76:79], v[252:255]
s_add_u32 s8, s16, 0x800000
v_exp_f32 v40, v40
v_mfma_f32_16x16x32_bf16 v[220:223], a[60:63], v[72:75], v[220:223]
ds_read_b128 a[32:35], v2 offset:16384
v_cvt_pk_bf16_f32 v55, v38, v39
v_mfma_f32_16x16x32_bf16 v[188:191], a[60:63], v[68:71], v[188:191]
buffer_store_dwordx4 a[64:67], v3, s[88:91], s8 offen offset:0 sc1
v_mfma_f32_16x16x32_bf16 a[224:227], a[236:239], v[68:71], a[224:227]
ds_read_b128 a[36:39], v2 offset:17408
v_exp_f32 v41, v41
v_smfmac_f32_16x16x64_bf16 a[228:231], a[232:235], v[72:79], v9
s_waitcnt lgkmcnt(6)
v_exp_f32 v42, v42
v_mfma_f32_16x16x32_bf16 v[20:23], a[0:3], a[176:179], v[104:107]
v_exp_f32 v43, v43
v_mfma_f32_16x16x32_bf16 v[20:23], a[4:7], a[180:183], v[20:23]
buffer_store_dwordx4 a[64:67], v3, s[88:91], s8 offen offset:1024 sc1
v_mfma_f32_16x16x32_bf16 v[20:23], a[8:11], a[184:187], v[20:23]
ds_read_b128 a[40:43], v2 offset:18432
v_cvt_pk_bf16_f32 v58, v40, v41
v_mfma_f32_16x16x32_bf16 v[20:23], a[12:15], a[188:191], v[20:23]
v_exp_f32 v44, v44
v_mfma_f32_16x16x32_bf16 v[24:27], a[0:3], a[192:195], v[88:91]
ds_read_b128 a[44:47], v2 offset:19456
v_cvt_pk_bf16_f32 v59, v42, v43
v_mfma_f32_16x16x32_bf16 v[24:27], a[4:7], a[196:199], v[24:27]
buffer_store_dwordx4 a[64:67], v3, s[88:91], s8 offen offset:2048 sc1
v_mfma_f32_16x16x32_bf16 v[24:27], a[8:11], a[200:203], v[24:27]
v_exp_f32 v45, v45
v_mfma_f32_16x16x32_bf16 v[24:27], a[12:15], a[204:207], v[24:27]
ds_read_b128 a[48:51], v2 offset:20480
v_cvt_pk_bf16_f32 v62, v44, v45
v_mfma_f32_16x16x32_bf16 v[28:31], a[0:3], a[208:211], v[92:95]
v_exp_f32 v46, v46
v_mfma_f32_16x16x32_bf16 v[28:31], a[4:7], a[212:215], v[28:31]
buffer_store_dwordx4 a[64:67], v3, s[88:91], s8 offen offset:3072 sc1
v_mfma_f32_16x16x32_bf16 v[28:31], a[8:11], a[216:219], v[28:31]
ds_read_b128 a[52:55], v2 offset:21504
v_add_u32 v4, s0, v3
v_mfma_f32_16x16x32_bf16 v[28:31], a[12:15], a[220:223], v[28:31]
s_waitcnt lgkmcnt(6)
v_exp_f32 v47, v47
v_mfma_f32_16x16x32_bf16 v[36:39], a[16:19], a[176:179], v[108:111]
ds_read_b128 a[56:59], v2 offset:22528
v_mov_b32 v5, s1
v_mfma_f32_16x16x32_bf16 v[36:39], a[20:23], a[180:183], v[36:39]
global_load_dword a244, v[4:5], off sc1
v_mfma_f32_16x16x32_bf16 v[36:39], a[24:27], a[184:187], v[36:39]
s_add_u32 s32, s32, 0x8000
v_exp_f32 v20, v20
v_mfma_f32_16x16x32_bf16 v[36:39], a[28:31], a[188:191], v[36:39]
ds_read_b128 a[60:63], v2 offset:23552
v_xor_b32 v2, 0x38000, v2
v_mfma_f32_16x16x32_bf16 v[40:43], a[16:19], a[192:195], v[88:91]
s_add_u32 s7, s7, 0x8000
v_exp_f32 v21, v21
v_mfma_f32_16x16x32_bf16 v[40:43], a[20:23], a[196:199], v[40:43]
s_xor_b32 s19, s19, 0x8000
v_exp_f32 v22, v22
v_mfma_f32_16x16x32_bf16 v[40:43], a[24:27], a[200:203], v[40:43]
s_sub_u32 s15, 7, s6
v_exp_f32 v23, v23
v_mfma_f32_16x16x32_bf16 v[40:43], a[28:31], a[204:207], v[40:43]
s_lshl_b32 s15, s15, 1
v_exp_f32 v24, v24
v_cvt_pk_bf16_f32 v63, v46, v47
v_mfma_f32_16x16x32_bf16 v[44:47], a[16:19], a[208:211], v[92:95]
v_exp_f32 v25, v25
v_mfma_f32_16x16x32_bf16 v[44:47], a[20:23], a[212:215], v[44:47]
v_exp_f32 v26, v26
v_mfma_f32_16x16x32_bf16 v[44:47], a[24:27], a[216:219], v[44:47]
s_waitcnt vmcnt(30) lgkmcnt(0)
v_exp_f32 v27, v27
v_mfma_f32_16x16x32_bf16 v[44:47], a[28:31], a[220:223], v[44:47]
s_barrier
v_cvt_pk_bf16_f32 v68, v20, v21
v_cvt_pk_bf16_f32 v69, v22, v23
s_cbranch_scc0 L_att_lh0_0
L_att_ls_0:
v_mfma_f32_16x16x32_bf16 v[160:163], a[32:35], v[52:55], v[160:163]
ds_read_b128 a[0:3], v1 offset:8192
v_cvt_pk_bf16_f32 v72, v24, v25
v_mfma_f32_16x16x32_bf16 v[192:195], a[32:35], v[56:59], v[192:195]
v_exp_f32 v28, v28
v_mfma_f32_16x16x32_bf16 v[224:227], a[32:35], v[60:63], v[224:227]
ds_read_b128 a[4:7], v1 offset:9216
v_cvt_pk_bf16_f32 v73, v26, v27
v_mfma_f32_16x16x32_bf16 v[228:231], a[36:39], v[60:63], v[228:231]
s_add_u32 m0, s27, 0x0
v_exp_f32 v29, v29
v_mfma_f32_16x16x32_bf16 v[196:199], a[36:39], v[56:59], v[196:199]
buffer_load_dwordx4 v3, s[48:51], s32 offen offset:0 sc1 lds
v_mfma_f32_16x16x32_bf16 v[164:167], a[36:39], v[52:55], v[164:167]
ds_read_b128 a[8:11], v1 offset:10240
v_cvt_pk_bf16_f32 v76, v28, v29
v_mfma_f32_16x16x32_bf16 v[168:171], a[40:43], v[52:55], v[168:171]
ds_read_b128 a[12:15], v1 offset:11264
v_accvgpr_read_b32 v6, a224
v_mfma_f32_16x16x32_bf16 v[200:203], a[40:43], v[56:59], v[200:203]
v_exp_f32 v30, v30
v_mfma_f32_16x16x32_bf16 v[232:235], a[40:43], v[60:63], v[232:235]
v_exp_f32 v31, v31
v_mfma_f32_16x16x32_bf16 v[236:239], a[44:47], v[60:63], v[236:239]
ds_read_b128 a[16:19], v1 offset:12288
v_cvt_pk_bf16_f32 v77, v30, v31
v_mfma_f32_16x16x32_bf16 v[204:207], a[44:47], v[56:59], v[204:207]
v_exp_f32 v36, v36
v_mfma_f32_16x16x32_bf16 v[172:175], a[44:47], v[52:55], v[172:175]
ds_read_b128 a[20:23], v1 offset:13312
v_accvgpr_read_b32 v7, a225
v_mfma_f32_16x16x32_bf16 v[176:179], a[48:51], v[52:55], v[176:179]
v_exp_f32 v37, v37
v_mfma_f32_16x16x32_bf16 v[208:211], a[48:51], v[56:59], v[208:211]
ds_read_b128 a[24:27], v1 offset:14336
v_cvt_pk_bf16_f32 v70, v36, v37
v_mfma_f32_16x16x32_bf16 v[240:243], a[48:51], v[60:63], v[240:243]
buffer_load_dwordx4 v3, s[48:51], s32 offen offset:1024 sc1 lds
v_mfma_f32_16x16x32_bf16 v[244:247], a[52:55], v[60:63], v[244:247]
v_exp_f32 v38, v38
v_mfma_f32_16x16x32_bf16 v[212:215], a[52:55], v[56:59], v[212:215]
ds_read_b128 a[28:31], v1 offset:15360
v_add_f32 v6, v6, v7
v_mfma_f32_16x16x32_bf16 v[180:183], a[52:55], v[52:55], v[180:183]
v_exp_f32 v39, v39
v_mfma_f32_16x16x32_bf16 v[184:187], a[56:59], v[52:55], v[184:187]
ds_read_b128 a[32:35], v1 offset:0
v_cvt_pk_bf16_f32 v71, v38, v39
v_mfma_f32_16x16x32_bf16 v[216:219], a[56:59], v[56:59], v[216:219]
v_exp_f32 v40, v40
v_mfma_f32_16x16x32_bf16 v[248:251], a[56:59], v[60:63], v[248:251]
ds_read_b128 a[36:39], v1 offset:1024
v_cmp_nge_f32 vcc, 0x6f800000, v6
v_mfma_f32_16x16x32_bf16 v[252:255], a[60:63], v[60:63], v[252:255]
v_exp_f32 v41, v41
v_mfma_f32_16x16x32_bf16 v[220:223], a[60:63], v[56:59], v[220:223]
v_exp_f32 v42, v42
v_mfma_f32_16x16x32_bf16 v[188:191], a[60:63], v[52:55], v[188:191]
ds_read_b128 a[40:43], v1 offset:2048
v_cvt_pk_bf16_f32 v74, v40, v41
v_mfma_f32_16x16x32_bf16 a[224:227], a[236:239], v[52:55], a[224:227]
buffer_load_dwordx4 v3, s[48:51], s32 offen offset:2048 sc1 lds
v_smfmac_f32_16x16x64_bf16 a[228:231], a[232:235], v[56:63], v9
ds_read_b128 a[44:47], v1 offset:3072
s_waitcnt lgkmcnt(8)
v_mfma_f32_16x16x32_bf16 v[24:27], a[0:3], a[192:195], v[88:91]
v_exp_f32 v43, v43
v_mfma_f32_16x16x32_bf16 v[24:27], a[4:7], a[196:199], v[24:27]
ds_read_b128 a[48:51], v1 offset:4096
v_cvt_pk_bf16_f32 v75, v42, v43
v_mfma_f32_16x16x32_bf16 v[24:27], a[8:11], a[200:203], v[24:27]
v_exp_f32 v44, v44
v_mfma_f32_16x16x32_bf16 v[24:27], a[12:15], a[204:207], v[24:27]
v_exp_f32 v45, v45
v_mfma_f32_16x16x32_bf16 v[28:31], a[0:3], a[208:211], v[92:95]
ds_read_b128 a[52:55], v1 offset:5120
v_cvt_pk_bf16_f32 v78, v44, v45
v_mfma_f32_16x16x32_bf16 v[28:31], a[4:7], a[212:215], v[28:31]
v_exp_f32 v46, v46
v_mfma_f32_16x16x32_bf16 v[28:31], a[8:11], a[216:219], v[28:31]
ds_read_b128 a[56:59], v1 offset:6144
v_mfma_f32_16x16x32_bf16 v[28:31], a[12:15], a[220:223], v[28:31]
s_waitcnt lgkmcnt(7)
v_exp_f32 v47, v47
v_mfma_f32_16x16x32_bf16 v[40:43], a[16:19], a[192:195], v[88:91]
buffer_load_dwordx4 v3, s[48:51], s32 offen offset:3072 sc1 lds
v_mfma_f32_16x16x32_bf16 v[40:43], a[20:23], a[196:199], v[40:43]
ds_read_b128 a[60:63], v1 offset:7168
v_cvt_pk_bf16_f32 v79, v46, v47
v_mfma_f32_16x16x32_bf16 v[40:43], a[24:27], a[200:203], v[40:43]
s_add_u32 s32, s32, 0x8000
v_exp_f32 v24, v24
v_mfma_f32_16x16x32_bf16 v[40:43], a[28:31], a[204:207], v[40:43]
v_exp_f32 v25, v25
v_mfma_f32_16x16x32_bf16 v[44:47], a[16:19], a[208:211], v[92:95]
v_exp_f32 v26, v26
v_mfma_f32_16x16x32_bf16 v[44:47], a[20:23], a[212:215], v[44:47]
v_exp_f32 v27, v27
v_mfma_f32_16x16x32_bf16 v[44:47], a[24:27], a[216:219], v[44:47]
v_exp_f32 v28, v28
v_mfma_f32_16x16x32_bf16 v[44:47], a[28:31], a[220:223], v[44:47]
s_waitcnt lgkmcnt(0)
v_exp_f32 v29, v29
v_mfma_f32_16x16x32_bf16 v[160:163], a[32:35], v[68:71], v[160:163]
ds_read_b128 a[0:3], v1 offset:24576
v_cvt_pk_bf16_f32 v56, v24, v25
v_mfma_f32_16x16x32_bf16 v[192:195], a[32:35], v[72:75], v[192:195]
v_exp_f32 v30, v30
v_mfma_f32_16x16x32_bf16 v[224:227], a[32:35], v[76:79], v[224:227]
ds_read_b128 a[4:7], v1 offset:25600
v_cvt_pk_bf16_f32 v57, v26, v27
v_mfma_f32_16x16x32_bf16 v[228:231], a[36:39], v[76:79], v[228:231]
s_add_u32 m0, s27, 0x1000
v_cvt_pk_bf16_f32 v60, v28, v29
v_mfma_f32_16x16x32_bf16 v[196:199], a[36:39], v[72:75], v[196:199]
buffer_load_dwordx4 v3, s[48:51], s7 offen offset:0 sc1 lds
v_mfma_f32_16x16x32_bf16 v[164:167], a[36:39], v[68:71], v[164:167]
ds_read_b128 a[8:11], v1 offset:26624
v_mfma_f32_16x16x32_bf16 v[168:171], a[40:43], v[68:71], v[168:171]
ds_read_b128 a[12:15], v1 offset:27648
v_mfma_f32_16x16x32_bf16 v[200:203], a[40:43], v[72:75], v[200:203]
v_exp_f32 v31, v31
v_mfma_f32_16x16x32_bf16 v[232:235], a[40:43], v[76:79], v[232:235]
v_exp_f32 v40, v40
v_mfma_f32_16x16x32_bf16 v[236:239], a[44:47], v[76:79], v[236:239]
ds_read_b128 a[16:19], v1 offset:28672
v_cvt_pk_bf16_f32 v61, v30, v31
v_mfma_f32_16x16x32_bf16 v[204:207], a[44:47], v[72:75], v[204:207]
v_exp_f32 v41, v41
v_mfma_f32_16x16x32_bf16 v[172:175], a[44:47], v[68:71], v[172:175]
ds_read_b128 a[20:23], v1 offset:29696
v_cvt_pk_bf16_f32 v58, v40, v41
v_mfma_f32_16x16x32_bf16 v[176:179], a[48:51], v[68:71], v[176:179]
v_rcp_f32 v6, v6
v_mfma_f32_16x16x32_bf16 v[208:211], a[48:51], v[72:75], v[208:211]
buffer_load_dwordx4 v3, s[48:51], s7 offen offset:1024 sc1 lds
v_mfma_f32_16x16x32_bf16 v[240:243], a[48:51], v[76:79], v[240:243]
ds_read_b128 a[24:27], v1 offset:30720
s_or_b64 s[34:35], s[34:35], vcc
v_mfma_f32_16x16x32_bf16 v[244:247], a[52:55], v[76:79], v[244:247]
ds_read_b128 a[28:31], v1 offset:31744
s_add_u32 s8, s28, 0x0
v_mfma_f32_16x16x32_bf16 v[212:215], a[52:55], v[72:75], v[212:215]
v_exp_f32 v42, v42
v_mfma_f32_16x16x32_bf16 v[180:183], a[52:55], v[68:71], v[180:183]
v_exp_f32 v43, v43
v_mfma_f32_16x16x32_bf16 v[184:187], a[56:59], v[68:71], v[184:187]
ds_read_b128 a[32:35], v1 offset:16384
v_cvt_pk_bf16_f32 v59, v42, v43
v_mfma_f32_16x16x32_bf16 v[216:219], a[56:59], v[72:75], v[216:219]
v_exp_f32 v44, v44
v_mfma_f32_16x16x32_bf16 v[248:251], a[56:59], v[76:79], v[248:251]
ds_read_b128 a[36:39], v1 offset:17408
v_mul_f32 v128, v6, v128
v_mfma_f32_16x16x32_bf16 v[252:255], a[60:63], v[76:79], v[252:255]
v_mul_f32 v129, v6, v129
v_mul_f32 v130, v6, v130
v_mfma_f32_16x16x32_bf16 v[220:223], a[60:63], v[72:75], v[220:223]
ds_read_b128 a[40:43], v1 offset:18432
v_mul_f32 v131, v6, v131
v_mfma_f32_16x16x32_bf16 v[188:191], a[60:63], v[68:71], v[188:191]
buffer_load_dwordx4 v3, s[48:51], s7 offen offset:2048 sc1 lds
v_mfma_f32_16x16x32_bf16 a[224:227], a[236:239], v[68:71], a[224:227]
ds_read_b128 a[44:47], v1 offset:19456
v_mul_f32 v132, v6, v132
v_smfmac_f32_16x16x64_bf16 a[228:231], a[232:235], v[72:79], v9
s_waitcnt lgkmcnt(8)
v_exp_f32 v45, v45
v_mfma_f32_16x16x32_bf16 v[24:27], a[0:3], a[192:195], v[88:91]
v_exp_f32 v46, v46
v_mfma_f32_16x16x32_bf16 v[24:27], a[4:7], a[196:199], v[24:27]
ds_read_b128 a[48:51], v1 offset:20480
v_cvt_pk_bf16_f32 v62, v44, v45
v_mfma_f32_16x16x32_bf16 v[24:27], a[8:11], a[200:203], v[24:27]
v_exp_f32 v47, v47
v_mfma_f32_16x16x32_bf16 v[24:27], a[12:15], a[204:207], v[24:27]
ds_read_b128 a[52:55], v1 offset:21504
v_cvt_pk_bf16_f32 v63, v46, v47
v_mfma_f32_16x16x32_bf16 v[28:31], a[0:3], a[208:211], v[92:95]
v_mul_f32 v133, v6, v133
v_mul_f32 v134, v6, v134
v_mfma_f32_16x16x32_bf16 v[28:31], a[4:7], a[212:215], v[28:31]
ds_read_b128 a[56:59], v1 offset:22528
v_mul_f32 v135, v6, v135
v_mfma_f32_16x16x32_bf16 v[28:31], a[8:11], a[216:219], v[28:31]
buffer_load_dwordx4 v3, s[48:51], s7 offen offset:3072 sc1 lds
v_mfma_f32_16x16x32_bf16 v[28:31], a[12:15], a[220:223], v[28:31]
ds_read_b128 a[60:63], v1 offset:23552
s_waitcnt lgkmcnt(8)
v_mfma_f32_16x16x32_bf16 v[40:43], a[16:19], a[192:195], v[88:91]
s_add_u32 s7, s7, 0x8000
v_xor_b32 v1, 0x8000, v1
v_cvt_pk_bf16_f32 v128, v128, v129
v_mfma_f32_16x16x32_bf16 v[40:43], a[20:23], a[196:199], v[40:43]
s_xor_b32 s27, s27, 0x38000
v_exp_f32 v24, v24
v_mfma_f32_16x16x32_bf16 v[40:43], a[24:27], a[200:203], v[40:43]
v_exp_f32 v25, v25
v_mfma_f32_16x16x32_bf16 v[40:43], a[28:31], a[204:207], v[40:43]
v_exp_f32 v26, v26
v_mfma_f32_16x16x32_bf16 v[44:47], a[16:19], a[208:211], v[92:95]
v_exp_f32 v27, v27
v_mfma_f32_16x16x32_bf16 v[44:47], a[20:23], a[212:215], v[44:47]
v_exp_f32 v28, v28
v_mfma_f32_16x16x32_bf16 v[44:47], a[24:27], a[216:219], v[44:47]
s_waitcnt vmcnt(29) lgkmcnt(0)
v_exp_f32 v29, v29
v_mfma_f32_16x16x32_bf16 v[44:47], a[28:31], a[220:223], v[44:47]
s_barrier
v_cvt_pk_bf16_f32 v129, v130, v131
v_cvt_pk_bf16_f32 v130, v132, v133
v_cvt_pk_bf16_f32 v131, v134, v135
buffer_store_dwordx4 v[128:131], v3, s[88:91], s8 offen sc1
s_add_u32 s8, s28, 0x2000
v_mul_f32 v136, v6, v136
v_mul_f32 v137, v6, v137
v_mul_f32 v138, v6, v138
v_mul_f32 v139, v6, v139
v_mul_f32 v140, v6, v140
v_mul_f32 v141, v6, v141
v_mul_f32 v142, v6, v142
v_mul_f32 v143, v6, v143
v_cvt_pk_bf16_f32 v136, v136, v137
v_cvt_pk_bf16_f32 v137, v138, v139
v_cvt_pk_bf16_f32 v138, v140, v141
v_cvt_pk_bf16_f32 v139, v142, v143
buffer_store_dwordx4 v[136:139], v3, s[88:91], s8 offen sc1
s_add_u32 s8, s28, 0x4000
v_mul_f32 v144, v6, v144
v_mul_f32 v145, v6, v145
v_mul_f32 v146, v6, v146
v_mul_f32 v147, v6, v147
v_mul_f32 v148, v6, v148
v_mul_f32 v149, v6, v149
v_mul_f32 v150, v6, v150
v_mul_f32 v151, v6, v151
v_cvt_pk_bf16_f32 v144, v144, v145
v_cvt_pk_bf16_f32 v145, v146, v147
v_cvt_pk_bf16_f32 v146, v148, v149
v_cvt_pk_bf16_f32 v147, v150, v151
buffer_store_dwordx4 v[144:147], v3, s[88:91], s8 offen sc1
s_add_u32 s8, s28, 0x6000
v_mul_f32 v152, v6, v152
v_mul_f32 v153, v6, v153
v_mul_f32 v154, v6, v154
v_mul_f32 v155, v6, v155
v_mul_f32 v156, v6, v156
v_mul_f32 v157, v6, v157
v_mul_f32 v158, v6, v158
v_mul_f32 v159, v6, v159
v_cvt_pk_bf16_f32 v152, v152, v153
v_cvt_pk_bf16_f32 v153, v154, v155
v_cvt_pk_bf16_f32 v154, v156, v157
v_cvt_pk_bf16_f32 v155, v158, v159
buffer_store_dwordx4 v[152:155], v3, s[88:91], s8 offen sc1
v_accvgpr_read_b32 v6, a226
v_accvgpr_read_b32 v7, a227
v_add_f32 v6, v6, v7
v_cmp_nge_f32 vcc, 0x6f800000, v6
v_rcp_f32 v6, v6
s_or_b64 s[34:35], s[34:35], vcc
s_add_u32 s8, s29, 0x0
v_pk_mul_f32 v[160:161], v[160:161], v[6:7] op_sel_hi:[1,0]
v_pk_mul_f32 v[162:163], v[162:163], v[6:7] op_sel_hi:[1,0]
v_pk_mul_f32 v[164:165], v[164:165], v[6:7] op_sel_hi:[1,0]
v_pk_mul_f32 v[166:167], v[166:167], v[6:7] op_sel_hi:[1,0]
v_cvt_pk_bf16_f32 v160, v160, v161
v_cvt_pk_bf16_f32 v161, v162, v163
v_cvt_pk_bf16_f32 v162, v164, v165
v_cvt_pk_bf16_f32 v163, v166, v167
buffer_store_dwordx4 v[160:163], v3, s[88:91], s8 offen sc1
s_add_u32 s8, s29, 0x2000
v_pk_mul_f32 v[168:169], v[168:169], v[6:7] op_sel_hi:[1,0]
v_pk_mul_f32 v[170:171], v[170:171], v[6:7] op_sel_hi:[1,0]
v_pk_mul_f32 v[172:173], v[172:173], v[6:7] op_sel_hi:[1,0]
v_pk_mul_f32 v[174:175], v[174:175], v[6:7] op_sel_hi:[1,0]
v_cvt_pk_bf16_f32 v168, v168, v169
v_cvt_pk_bf16_f32 v169, v170, v171
v_cvt_pk_bf16_f32 v170, v172, v173
v_cvt_pk_bf16_f32 v171, v174, v175
buffer_store_dwordx4 v[168:171], v3, s[88:91], s8 offen sc1
s_add_u32 s8, s29, 0x4000
v_pk_mul_f32 v[176:177], v[176:177], v[6:7] op_sel_hi:[1,0]
v_pk_mul_f32 v[178:179], v[178:179], v[6:7] op_sel_hi:[1,0]
v_pk_mul_f32 v[180:181], v[180:181], v[6:7] op_sel_hi:[1,0]
v_pk_mul_f32 v[182:183], v[182:183], v[6:7] op_sel_hi:[1,0]
v_cvt_pk_bf16_f32 v176, v176, v177
v_cvt_pk_bf16_f32 v177, v178, v179
v_cvt_pk_bf16_f32 v178, v180, v181
v_cvt_pk_bf16_f32 v179, v182, v183
buffer_store_dwordx4 v[176:179], v3, s[88:91], s8 offen sc1
s_add_u32 s8, s29, 0x6000
v_pk_mul_f32 v[184:185], v[184:185], v[6:7] op_sel_hi:[1,0]
v_pk_mul_f32 v[186:187], v[186:187], v[6:7] op_sel_hi:[1,0]
v_pk_mul_f32 v[188:189], v[188:189], v[6:7] op_sel_hi:[1,0]
v_pk_mul_f32 v[190:191], v[190:191], v[6:7] op_sel_hi:[1,0]
v_cvt_pk_bf16_f32 v184, v184, v185
v_cvt_pk_bf16_f32 v185, v186, v187
v_cvt_pk_bf16_f32 v186, v188, v189
v_cvt_pk_bf16_f32 v187, v190, v191
buffer_store_dwordx4 v[184:187], v3, s[88:91], s8 offen sc1
s_getreg_b32 s8, hwreg(HW_REG_HW_ID, 5, 1)
s_cmp_lg_u32 s8, 0
s_cbranch_scc1 L_att_sodd1
s_branch L_att_sodd0
L_att_lh0_0:
v_mfma_f32_16x16x32_bf16 v[160:163], a[32:35], v[52:55], v[160:163]
ds_read_b128 a[0:3], v1 offset:8192
v_cvt_pk_bf16_f32 v72, v24, v25
v_mfma_f32_16x16x32_bf16 v[192:195], a[32:35], v[56:59], v[192:195]
v_exp_f32 v28, v28
v_mfma_f32_16x16x32_bf16 v[224:227], a[32:35], v[60:63], v[224:227]
ds_read_b128 a[4:7], v1 offset:9216
v_cvt_pk_bf16_f32 v73, v26, v27
v_mfma_f32_16x16x32_bf16 v[228:231], a[36:39], v[60:63], v[228:231]
v_exp_f32 v29, v29
v_mfma_f32_16x16x32_bf16 v[196:199], a[36:39], v[56:59], v[196:199]
buffer_load_dword v14, v15, s[84:87], 0 offen offset:192 sc1
v_mfma_f32_16x16x32_bf16 v[164:167], a[36:39], v[52:55], v[164:167]
ds_read_b128 a[8:11], v1 offset:10240
v_cvt_pk_bf16_f32 v76, v28, v29
v_mfma_f32_16x16x32_bf16 v[168:171], a[40:43], v[52:55], v[168:171]
ds_read_b128 a[12:15], v1 offset:11264
v_mfma_f32_16x16x32_bf16 v[200:203], a[40:43], v[56:59], v[200:203]
v_exp_f32 v30, v30
v_mfma_f32_16x16x32_bf16 v[232:235], a[40:43], v[60:63], v[232:235]
v_exp_f32 v31, v31
v_mfma_f32_16x16x32_bf16 v[236:239], a[44:47], v[60:63], v[236:239]
ds_read_b128 a[16:19], v1 offset:12288
v_cvt_pk_bf16_f32 v77, v30, v31
v_mfma_f32_16x16x32_bf16 v[204:207], a[44:47], v[56:59], v[204:207]
s_add_u32 m0, s17, 0x10000
v_exp_f32 v36, v36
v_mfma_f32_16x16x32_bf16 v[172:175], a[44:47], v[52:55], v[172:175]
ds_read_b128 a[20:23], v1 offset:13312
v_mfma_f32_16x16x32_bf16 v[176:179], a[48:51], v[52:55], v[176:179]
buffer_load_dwordx4 v12, s[72:75], 0 offen lds
v_mfma_f32_16x16x32_bf16 v[208:211], a[48:51], v[56:59], v[208:211]
ds_read_b128 a[24:27], v1 offset:14336
v_mfma_f32_16x16x32_bf16 v[240:243], a[48:51], v[60:63], v[240:243]
v_exp_f32 v37, v37
v_mfma_f32_16x16x32_bf16 v[244:247], a[52:55], v[60:63], v[244:247]
v_exp_f32 v38, v38
v_mfma_f32_16x16x32_bf16 v[212:215], a[52:55], v[56:59], v[212:215]
ds_read_b128 a[28:31], v1 offset:15360
v_cvt_pk_bf16_f32 v70, v36, v37
v_mfma_f32_16x16x32_bf16 v[180:183], a[52:55], v[52:55], v[180:183]
v_exp_f32 v39, v39
v_mfma_f32_16x16x32_bf16 v[184:187], a[56:59], v[52:55], v[184:187]
ds_read_b128 a[32:35], v1 offset:0
v_cvt_pk_bf16_f32 v71, v38, v39
v_mfma_f32_16x16x32_bf16 v[216:219], a[56:59], v[56:59], v[216:219]
v_exp_f32 v40, v40
v_mfma_f32_16x16x32_bf16 v[248:251], a[56:59], v[60:63], v[248:251]
buffer_load_dwordx4 v13, s[72:75], 0 offen offset:1024 lds
v_mfma_f32_16x16x32_bf16 v[252:255], a[60:63], v[60:63], v[252:255]
ds_read_b128 a[36:39], v1 offset:1024
v_mfma_f32_16x16x32_bf16 v[220:223], a[60:63], v[56:59], v[220:223]
v_exp_f32 v41, v41
v_mfma_f32_16x16x32_bf16 v[188:191], a[60:63], v[52:55], v[188:191]
ds_read_b128 a[40:43], v1 offset:2048
v_cvt_pk_bf16_f32 v74, v40, v41
v_mfma_f32_16x16x32_bf16 a[224:227], a[236:239], v[52:55], a[224:227]
s_waitcnt lgkmcnt(7)
v_exp_f32 v42, v42
v_smfmac_f32_16x16x64_bf16 a[228:231], a[232:235], v[56:63], v9
ds_read_b128 a[44:47], v1 offset:3072
v_mfma_f32_16x16x32_bf16 v[24:27], a[0:3], a[192:195], v[112:115]
v_exp_f32 v43, v43
v_mfma_f32_16x16x32_bf16 v[24:27], a[4:7], a[196:199], v[24:27]
ds_read_b128 a[48:51], v1 offset:4096
v_cvt_pk_bf16_f32 v75, v42, v43
v_mfma_f32_16x16x32_bf16 v[24:27], a[8:11], a[200:203], v[24:27]
buffer_load_dwordx4 v12, s[72:75], s12 offen offset:2048 lds
v_mfma_f32_16x16x32_bf16 v[24:27], a[12:15], a[204:207], v[24:27]
v_exp_f32 v44, v44
v_mfma_f32_16x16x32_bf16 v[28:31], a[0:3], a[208:211], v[92:95]
ds_read_b128 a[52:55], v1 offset:5120
v_exp_f32 v45, v45
v_mfma_f32_16x16x32_bf16 v[28:31], a[4:7], a[212:215], v[28:31]
v_exp_f32 v46, v46
v_mfma_f32_16x16x32_bf16 v[28:31], a[8:11], a[216:219], v[28:31]
ds_read_b128 a[56:59], v1 offset:6144
v_cvt_pk_bf16_f32 v78, v44, v45
v_mfma_f32_16x16x32_bf16 v[28:31], a[12:15], a[220:223], v[28:31]
s_waitcnt lgkmcnt(7)
v_exp_f32 v47, v47
v_mfma_f32_16x16x32_bf16 v[40:43], a[16:19], a[192:195], v[116:119]
ds_read_b128 a[60:63], v1 offset:7168
v_cvt_pk_bf16_f32 v79, v46, v47
v_mfma_f32_16x16x32_bf16 v[40:43], a[20:23], a[196:199], v[40:43]
v_exp_f32 v24, v24
v_mfma_f32_16x16x32_bf16 v[40:43], a[24:27], a[200:203], v[40:43]
buffer_load_dwordx4 v13, s[72:75], s12 offen offset:3072 lds
v_mfma_f32_16x16x32_bf16 v[40:43], a[28:31], a[204:207], v[40:43]
v_exp_f32 v25, v25
v_mfma_f32_16x16x32_bf16 v[44:47], a[16:19], a[208:211], v[92:95]
v_exp_f32 v26, v26
v_mfma_f32_16x16x32_bf16 v[44:47], a[20:23], a[212:215], v[44:47]
v_exp_f32 v27, v27
v_mfma_f32_16x16x32_bf16 v[44:47], a[24:27], a[216:219], v[44:47]
v_exp_f32 v28, v28
v_mfma_f32_16x16x32_bf16 v[44:47], a[28:31], a[220:223], v[44:47]
s_waitcnt lgkmcnt(0)
v_exp_f32 v29, v29
v_mfma_f32_16x16x32_bf16 v[160:163], a[32:35], v[68:71], v[160:163]
v_exp_f32 v30, v30
v_mfma_f32_16x16x32_bf16 v[192:195], a[32:35], v[72:75], v[192:195]
v_exp_f32 v31, v31
v_mfma_f32_16x16x32_bf16 v[224:227], a[32:35], v[76:79], v[224:227]
ds_read_b128 a[0:3], v1 offset:24576
v_cvt_pk_bf16_f32 v56, v24, v25
v_mfma_f32_16x16x32_bf16 v[228:231], a[36:39], v[76:79], v[228:231]
ds_read_b128 a[4:7], v1 offset:25600
v_add_u32 v12, 0x20000, v12
v_mfma_f32_16x16x32_bf16 v[196:199], a[36:39], v[72:75], v[196:199]
s_add_u32 m0, s17, 0x14000
v_exp_f32 v40, v40
v_mfma_f32_16x16x32_bf16 v[164:167], a[36:39], v[68:71], v[164:167]
buffer_load_dwordx4 v12, s[72:75], 0 offen lds
v_mfma_f32_16x16x32_bf16 v[168:171], a[40:43], v[68:71], v[168:171]
ds_read_b128 a[8:11], v1 offset:26624
v_cvt_pk_bf16_f32 v57, v26, v27
v_mfma_f32_16x16x32_bf16 v[200:203], a[40:43], v[72:75], v[200:203]
ds_read_b128 a[12:15], v1 offset:27648
v_cvt_pk_bf16_f32 v60, v28, v29
v_mfma_f32_16x16x32_bf16 v[232:235], a[40:43], v[76:79], v[232:235]
ds_read_b128 a[16:19], v1 offset:28672
v_cvt_pk_bf16_f32 v61, v30, v31
v_mfma_f32_16x16x32_bf16 v[236:239], a[44:47], v[76:79], v[236:239]
v_exp_f32 v41, v41
v_mfma_f32_16x16x32_bf16 v[204:207], a[44:47], v[72:75], v[204:207]
v_exp_f32 v42, v42
v_mfma_f32_16x16x32_bf16 v[172:175], a[44:47], v[68:71], v[172:175]
ds_read_b128 a[20:23], v1 offset:29696
v_cvt_pk_bf16_f32 v58, v40, v41
v_mfma_f32_16x16x32_bf16 v[176:179], a[48:51], v[68:71], v[176:179]
ds_read_b128 a[24:27], v1 offset:30720
v_add_u32 v13, 0x20000, v13
v_mfma_f32_16x16x32_bf16 v[208:211], a[48:51], v[72:75], v[208:211]
buffer_load_dwordx4 v13, s[72:75], 0 offen offset:1024 lds
v_mfma_f32_16x16x32_bf16 v[240:243], a[48:51], v[76:79], v[240:243]
ds_read_b128 a[28:31], v1 offset:31744
v_mfma_f32_16x16x32_bf16 v[244:247], a[52:55], v[76:79], v[244:247]
ds_read_b128 a[32:35], v1 offset:16384
v_mfma_f32_16x16x32_bf16 v[212:215], a[52:55], v[72:75], v[212:215]
v_exp_f32 v43, v43
v_mfma_f32_16x16x32_bf16 v[180:183], a[52:55], v[68:71], v[180:183]
v_exp_f32 v44, v44
v_mfma_f32_16x16x32_bf16 v[184:187], a[56:59], v[68:71], v[184:187]
buffer_load_dwordx4 v12, s[72:75], s12 offen offset:2048 lds
v_mfma_f32_16x16x32_bf16 v[216:219], a[56:59], v[72:75], v[216:219]
ds_read_b128 a[36:39], v1 offset:17408
v_cvt_pk_bf16_f32 v59, v42, v43
v_mfma_f32_16x16x32_bf16 v[248:251], a[56:59], v[76:79], v[248:251]
ds_read_b128 a[40:43], v1 offset:18432
v_mfma_f32_16x16x32_bf16 v[252:255], a[60:63], v[76:79], v[252:255]
ds_read_b128 a[44:47], v1 offset:19456
v_mfma_f32_16x16x32_bf16 v[220:223], a[60:63], v[72:75], v[220:223]
v_exp_f32 v45, v45
v_mfma_f32_16x16x32_bf16 v[188:191], a[60:63], v[68:71], v[188:191]
ds_read_b128 a[48:51], v1 offset:20480
v_cvt_pk_bf16_f32 v62, v44, v45
v_mfma_f32_16x16x32_bf16 a[224:227], a[236:239], v[68:71], a[224:227]
ds_read_b128 a[52:55], v1 offset:21504
v_smfmac_f32_16x16x64_bf16 a[228:231], a[232:235], v[72:79], v9
s_waitcnt lgkmcnt(10)
v_exp_f32 v46, v46
v_mfma_f32_16x16x32_bf16 v[28:31], a[0:3], a[208:211], v[92:95]
v_exp_f32 v47, v47
v_mfma_f32_16x16x32_bf16 v[28:31], a[4:7], a[212:215], v[28:31]
buffer_load_dwordx4 v13, s[72:75], s12 offen offset:3072 lds
v_mfma_f32_16x16x32_bf16 v[28:31], a[8:11], a[216:219], v[28:31]
ds_read_b128 a[56:59], v1 offset:22528
v_cvt_pk_bf16_f32 v63, v46, v47
v_mfma_f32_16x16x32_bf16 v[28:31], a[12:15], a[220:223], v[28:31]
ds_read_b128 a[60:63], v1 offset:23552
s_waitcnt lgkmcnt(8)
v_mfma_f32_16x16x32_bf16 v[44:47], a[16:19], a[208:211], v[92:95]
v_xor_b32 v1, 0x8000, v1
v_mfma_f32_16x16x32_bf16 v[44:47], a[20:23], a[212:215], v[44:47]
v_mfma_f32_16x16x32_bf16 v[44:47], a[24:27], a[216:219], v[44:47]
v_mfma_f32_16x16x32_bf16 v[44:47], a[28:31], a[220:223], v[44:47]
v_accvgpr_read_b32 v6, a224
v_accvgpr_read_b32 v7, a225
v_add_f32 v6, v6, v7
v_cmp_nge_f32 vcc, 0x6f800000, v6
v_rcp_f32 v6, v6
s_or_b64 s[34:35], s[34:35], vcc
s_add_u32 s8, s28, 0x0
v_pk_mul_f32 v[128:129], v[128:129], v[6:7] op_sel_hi:[1,0]
v_pk_mul_f32 v[130:131], v[130:131], v[6:7] op_sel_hi:[1,0]
v_pk_mul_f32 v[132:133], v[132:133], v[6:7] op_sel_hi:[1,0]
v_pk_mul_f32 v[134:135], v[134:135], v[6:7] op_sel_hi:[1,0]
v_cvt_pk_bf16_f32 v128, v128, v129
v_cvt_pk_bf16_f32 v129, v130, v131
v_cvt_pk_bf16_f32 v130, v132, v133
v_cvt_pk_bf16_f32 v131, v134, v135
buffer_store_dwordx4 v[128:131], v3, s[88:91], s8 offen sc1
s_add_u32 s8, s28, 0x2000
v_pk_mul_f32 v[136:137], v[136:137], v[6:7] op_sel_hi:[1,0]
v_pk_mul_f32 v[138:139], v[138:139], v[6:7] op_sel_hi:[1,0]
v_pk_mul_f32 v[140:141], v[140:141], v[6:7] op_sel_hi:[1,0]
v_pk_mul_f32 v[142:143], v[142:143], v[6:7] op_sel_hi:[1,0]
v_cvt_pk_bf16_f32 v136, v136, v137
v_cvt_pk_bf16_f32 v137, v138, v139
v_cvt_pk_bf16_f32 v138, v140, v141
v_cvt_pk_bf16_f32 v139, v142, v143
buffer_store_dwordx4 v[136:139], v3, s[88:91], s8 offen sc1
s_add_u32 s8, s28, 0x4000
v_pk_mul_f32 v[144:145], v[144:145], v[6:7] op_sel_hi:[1,0]
v_pk_mul_f32 v[146:147], v[146:147], v[6:7] op_sel_hi:[1,0]
v_pk_mul_f32 v[148:149], v[148:149], v[6:7] op_sel_hi:[1,0]
v_pk_mul_f32 v[150:151], v[150:151], v[6:7] op_sel_hi:[1,0]
v_cvt_pk_bf16_f32 v144, v144, v145
v_cvt_pk_bf16_f32 v145, v146, v147
v_cvt_pk_bf16_f32 v146, v148, v149
v_cvt_pk_bf16_f32 v147, v150, v151
buffer_store_dwordx4 v[144:147], v3, s[88:91], s8 offen sc1
s_add_u32 s8, s28, 0x6000
v_pk_mul_f32 v[152:153], v[152:153], v[6:7] op_sel_hi:[1,0]
v_pk_mul_f32 v[154:155], v[154:155], v[6:7] op_sel_hi:[1,0]
v_pk_mul_f32 v[156:157], v[156:157], v[6:7] op_sel_hi:[1,0]
v_pk_mul_f32 v[158:159], v[158:159], v[6:7] op_sel_hi:[1,0]
v_cvt_pk_bf16_f32 v152, v152, v153
v_cvt_pk_bf16_f32 v153, v154, v155
v_cvt_pk_bf16_f32 v154, v156, v157
v_cvt_pk_bf16_f32 v155, v158, v159
buffer_store_dwordx4 v[152:155], v3, s[88:91], s8 offen sc1
v_accvgpr_read_b32 v6, a226
v_accvgpr_read_b32 v7, a227
v_add_f32 v6, v6, v7
v_cmp_nge_f32 vcc, 0x6f800000, v6
v_rcp_f32 v6, v6
s_or_b64 s[34:35], s[34:35], vcc
s_add_u32 s8, s29, 0x0
v_pk_mul_f32 v[160:161], v[160:161], v[6:7] op_sel_hi:[1,0]
v_pk_mul_f32 v[162:163], v[162:163], v[6:7] op_sel_hi:[1,0]
v_pk_mul_f32 v[164:165], v[164:165], v[6:7] op_sel_hi:[1,0]
v_pk_mul_f32 v[166:167], v[166:167], v[6:7] op_sel_hi:[1,0]
v_cvt_pk_bf16_f32 v160, v160, v161
v_cvt_pk_bf16_f32 v161, v162, v163
v_cvt_pk_bf16_f32 v162, v164, v165
v_cvt_pk_bf16_f32 v163, v166, v167
buffer_store_dwordx4 v[160:163], v3, s[88:91], s8 offen sc1
s_add_u32 s8, s29, 0x2000
v_pk_mul_f32 v[168:169], v[168:169], v[6:7] op_sel_hi:[1,0]
v_pk_mul_f32 v[170:171], v[170:171], v[6:7] op_sel_hi:[1,0]
v_pk_mul_f32 v[172:173], v[172:173], v[6:7] op_sel_hi:[1,0]
v_pk_mul_f32 v[174:175], v[174:175], v[6:7] op_sel_hi:[1,0]
v_cvt_pk_bf16_f32 v168, v168, v169
v_cvt_pk_bf16_f32 v169, v170, v171
v_cvt_pk_bf16_f32 v170, v172, v173
v_cvt_pk_bf16_f32 v171, v174, v175
buffer_store_dwordx4 v[168:171], v3, s[88:91], s8 offen sc1
s_add_u32 s8, s29, 0x4000
v_pk_mul_f32 v[176:177], v[176:177], v[6:7] op_sel_hi:[1,0]
v_pk_mul_f32 v[178:179], v[178:179], v[6:7] op_sel_hi:[1,0]
v_pk_mul_f32 v[180:181], v[180:181], v[6:7] op_sel_hi:[1,0]
v_pk_mul_f32 v[182:183], v[182:183], v[6:7] op_sel_hi:[1,0]
v_cvt_pk_bf16_f32 v176, v176, v177
v_cvt_pk_bf16_f32 v177, v178, v179
v_cvt_pk_bf16_f32 v178, v180, v181
v_cvt_pk_bf16_f32 v179, v182, v183
buffer_store_dwordx4 v[176:179], v3, s[88:91], s8 offen sc1
s_add_u32 s8, s29, 0x6000
v_pk_mul_f32 v[184:185], v[184:185], v[6:7] op_sel_hi:[1,0]
v_pk_mul_f32 v[186:187], v[186:187], v[6:7] op_sel_hi:[1,0]
v_pk_mul_f32 v[188:189], v[188:189], v[6:7] op_sel_hi:[1,0]
v_pk_mul_f32 v[190:191], v[190:191], v[6:7] op_sel_hi:[1,0]
v_cvt_pk_bf16_f32 v184, v184, v185
v_cvt_pk_bf16_f32 v185, v186, v187
v_cvt_pk_bf16_f32 v186, v188, v189
v_cvt_pk_bf16_f32 v187, v190, v191
buffer_store_dwordx4 v[184:187], v3, s[88:91], s8 offen sc1
s_branch L_att_h1_0
L_att_dl0_1:
v_mfma_f32_16x16x32_bf16 v[128:131], a[32:35], v[48:51], v[128:131]
ds_read_b128 a[0:3], v1 offset:8192
v_cvt_pk_bf16_f32 v72, v24, v25
v_mfma_f32_16x16x32_bf16 v[160:163], a[32:35], v[52:55], v[160:163]
v_exp_f32 v28, v28
v_mfma_f32_16x16x32_bf16 v[192:195], a[32:35], v[56:59], v[192:195]
v_cvt_pk_bf16_f32 v73, v26, v27
v_mfma_f32_16x16x32_bf16 v[224:227], a[32:35], v[60:63], v[224:227]
ds_read_b128 a[4:7], v1 offset:9216
v_mfma_f32_16x16x32_bf16 v[228:231], a[36:39], v[60:63], v[228:231]
v_exp_f32 v29, v29
v_mfma_f32_16x16x32_bf16 v[196:199], a[36:39], v[56:59], v[196:199]
s_add_u32 m0, s27, 0x0
v_exp_f32 v30, v30
v_mfma_f32_16x16x32_bf16 v[164:167], a[36:39], v[52:55], v[164:167]
buffer_load_dwordx4 v3, s[48:51], s32 offen offset:0 sc1 lds
v_mfma_f32_16x16x32_bf16 v[132:135], a[36:39], v[48:51], v[132:135]
ds_read_b128 a[8:11], v1 offset:10240
v_cvt_pk_bf16_f32 v76, v28, v29
v_mfma_f32_16x16x32_bf16 v[136:139], a[40:43], v[48:51], v[136:139]
v_mfma_f32_16x16x32_bf16 v[168:171], a[40:43], v[52:55], v[168:171]
v_exp_f32 v31, v31
v_mfma_f32_16x16x32_bf16 v[200:203], a[40:43], v[56:59], v[200:203]
v_exp_f32 v32, v32
v_mfma_f32_16x16x32_bf16 v[232:235], a[40:43], v[60:63], v[232:235]
ds_read_b128 a[12:15], v1 offset:11264
v_cvt_pk_bf16_f32 v77, v30, v31
v_mfma_f32_16x16x32_bf16 v[236:239], a[44:47], v[60:63], v[236:239]
v_mfma_f32_16x16x32_bf16 v[204:207], a[44:47], v[56:59], v[204:207]
v_exp_f32 v33, v33
v_mfma_f32_16x16x32_bf16 v[172:175], a[44:47], v[52:55], v[172:175]
v_exp_f32 v34, v34
v_mfma_f32_16x16x32_bf16 v[140:143], a[44:47], v[48:51], v[140:143]
ds_read_b128 a[16:19], v1 offset:12288
v_cvt_pk_bf16_f32 v66, v32, v33
v_mfma_f32_16x16x32_bf16 v[144:147], a[48:51], v[48:51], v[144:147]
v_exp_f32 v35, v35
v_mfma_f32_16x16x32_bf16 v[176:179], a[48:51], v[52:55], v[176:179]
v_cvt_pk_bf16_f32 v67, v34, v35
v_mfma_f32_16x16x32_bf16 v[208:211], a[48:51], v[56:59], v[208:211]
v_exp_f32 v36, v36
v_mfma_f32_16x16x32_bf16 v[240:243], a[48:51], v[60:63], v[240:243]
buffer_load_dwordx4 v3, s[48:51], s32 offen offset:1024 sc1 lds
v_mfma_f32_16x16x32_bf16 v[244:247], a[52:55], v[60:63], v[244:247]
ds_read_b128 a[20:23], v1 offset:13312
v_mfma_f32_16x16x32_bf16 v[212:215], a[52:55], v[56:59], v[212:215]
v_exp_f32 v37, v37
v_mfma_f32_16x16x32_bf16 v[180:183], a[52:55], v[52:55], v[180:183]
ds_read_b128 a[24:27], v1 offset:14336
v_cvt_pk_bf16_f32 v70, v36, v37
v_mfma_f32_16x16x32_bf16 v[148:151], a[52:55], v[48:51], v[148:151]
v_mfma_f32_16x16x32_bf16 v[152:155], a[56:59], v[48:51], v[152:155]
v_exp_f32 v38, v38
v_mfma_f32_16x16x32_bf16 v[184:187], a[56:59], v[52:55], v[184:187]
v_exp_f32 v39, v39
v_mfma_f32_16x16x32_bf16 v[216:219], a[56:59], v[56:59], v[216:219]
ds_read_b128 a[28:31], v1 offset:15360
v_cvt_pk_bf16_f32 v71, v38, v39
v_mfma_f32_16x16x32_bf16 v[248:251], a[56:59], v[60:63], v[248:251]
v_exp_f32 v40, v40
v_mfma_f32_16x16x32_bf16 v[252:255], a[60:63], v[60:63], v[252:255]
v_mfma_f32_16x16x32_bf16 v[220:223], a[60:63], v[56:59], v[220:223]
v_exp_f32 v41, v41
v_mfma_f32_16x16x32_bf16 v[188:191], a[60:63], v[52:55], v[188:191]
ds_read_b128 a[32:35], v1 offset:0
v_cvt_pk_bf16_f32 v74, v40, v41
v_mfma_f32_16x16x32_bf16 v[156:159], a[60:63], v[48:51], v[156:159]
v_exp_f32 v42, v42
v_smfmac_f32_16x16x64_bf16 a[224:227], a[232:235], v[48:55], v9
buffer_load_dwordx4 v3, s[48:51], s32 offen offset:2048 sc1 lds
v_smfmac_f32_16x16x64_bf16 a[228:231], a[232:235], v[56:63], v9
s_waitcnt lgkmcnt(5)
v_mfma_f32_16x16x32_bf16 v[16:19], a[0:3], a[160:163], v[80:83]
ds_read_b128 a[36:39], v1 offset:1024
v_mfma_f32_16x16x32_bf16 v[16:19], a[4:7], a[164:167], v[16:19]
v_exp_f32 v43, v43
v_mfma_f32_16x16x32_bf16 v[16:19], a[8:11], a[168:171], v[16:19]
v_exp_f32 v44, v44
v_mfma_f32_16x16x32_bf16 v[16:19], a[12:15], a[172:175], v[16:19]
v_exp_f32 v45, v45
v_mfma_f32_16x16x32_bf16 v[20:23], a[0:3], a[176:179], v[84:87]
ds_read_b128 a[40:43], v1 offset:2048
v_cvt_pk_bf16_f32 v75, v42, v43
v_mfma_f32_16x16x32_bf16 v[20:23], a[4:7], a[180:183], v[20:23]
v_cvt_pk_bf16_f32 v78, v44, v45
v_mfma_f32_16x16x32_bf16 v[20:23], a[8:11], a[184:187], v[20:23]
v_exp_f32 v46, v46
v_mfma_f32_16x16x32_bf16 v[20:23], a[12:15], a[188:191], v[20:23]
ds_read_b128 a[44:47], v1 offset:3072
v_mfma_f32_16x16x32_bf16 v[24:27], a[0:3], a[192:195], v[88:91]
v_exp_f32 v47, v47
v_mfma_f32_16x16x32_bf16 v[24:27], a[4:7], a[196:199], v[24:27]
v_cvt_pk_bf16_f32 v79, v46, v47
v_mfma_f32_16x16x32_bf16 v[24:27], a[8:11], a[200:203], v[24:27]
buffer_load_dwordx4 v3, s[48:51], s32 offen offset:3072 sc1 lds
v_mfma_f32_16x16x32_bf16 v[24:27], a[12:15], a[204:207], v[24:27]
ds_read_b128 a[48:51], v1 offset:4096
v_mfma_f32_16x16x32_bf16 v[28:31], a[0:3], a[208:211], v[92:95]
v_exp_f32 v16, v16
v_mfma_f32_16x16x32_bf16 v[28:31], a[4:7], a[212:215], v[28:31]
v_exp_f32 v17, v17
v_mfma_f32_16x16x32_bf16 v[28:31], a[8:11], a[216:219], v[28:31]
s_waitcnt lgkmcnt(5)
v_exp_f32 v18, v18
v_mfma_f32_16x16x32_bf16 v[28:31], a[12:15], a[220:223], v[28:31]
ds_read_b128 a[52:55], v1 offset:5120
v_cvt_pk_bf16_f32 v48, v16, v17
v_mfma_f32_16x16x32_bf16 v[32:35], a[16:19], a[160:163], v[80:83]
v_mfma_f32_16x16x32_bf16 v[32:35], a[20:23], a[164:167], v[32:35]
v_exp_f32 v19, v19
v_mfma_f32_16x16x32_bf16 v[32:35], a[24:27], a[168:171], v[32:35]
v_exp_f32 v20, v20
v_mfma_f32_16x16x32_bf16 v[32:35], a[28:31], a[172:175], v[32:35]
ds_read_b128 a[56:59], v1 offset:6144
v_cvt_pk_bf16_f32 v49, v18, v19
v_mfma_f32_16x16x32_bf16 v[36:39], a[16:19], a[176:179], v[84:87]
v_mfma_f32_16x16x32_bf16 v[36:39], a[20:23], a[180:183], v[36:39]
v_exp_f32 v21, v21
v_mfma_f32_16x16x32_bf16 v[36:39], a[24:27], a[184:187], v[36:39]
s_add_u32 m0, s27, 0x1000
v_exp_f32 v22, v22
v_mfma_f32_16x16x32_bf16 v[36:39], a[28:31], a[188:191], v[36:39]
buffer_load_dwordx4 v3, s[48:51], s7 offen offset:0 sc1 lds
v_mfma_f32_16x16x32_bf16 v[40:43], a[16:19], a[192:195], v[88:91]
ds_read_b128 a[60:63], v1 offset:7168
v_cvt_pk_bf16_f32 v52, v20, v21
v_mfma_f32_16x16x32_bf16 v[40:43], a[20:23], a[196:199], v[40:43]
v_exp_f32 v23, v23
v_mfma_f32_16x16x32_bf16 v[40:43], a[24:27], a[200:203], v[40:43]
v_cvt_pk_bf16_f32 v53, v22, v23
v_mfma_f32_16x16x32_bf16 v[40:43], a[28:31], a[204:207], v[40:43]
v_exp_f32 v24, v24
v_mfma_f32_16x16x32_bf16 v[44:47], a[16:19], a[208:211], v[92:95]
v_exp_f32 v25, v25
v_mfma_f32_16x16x32_bf16 v[44:47], a[20:23], a[212:215], v[44:47]
v_exp_f32 v26, v26
v_mfma_f32_16x16x32_bf16 v[44:47], a[24:27], a[216:219], v[44:47]
v_exp_f32 v27, v27
v_mfma_f32_16x16x32_bf16 v[44:47], a[28:31], a[220:223], v[44:47]
s_waitcnt lgkmcnt(0)
v_mfma_f32_16x16x32_bf16 v[128:131], a[32:35], v[64:67], v[128:131]
ds_read_b128 a[0:3], v1 offset:24576
v_cvt_pk_bf16_f32 v56, v24, v25
v_mfma_f32_16x16x32_bf16 v[160:163], a[32:35], v[68:71], v[160:163]
v_exp_f32 v28, v28
v_mfma_f32_16x16x32_bf16 v[192:195], a[32:35], v[72:75], v[192:195]
v_cvt_pk_bf16_f32 v57, v26, v27
v_mfma_f32_16x16x32_bf16 v[224:227], a[32:35], v[76:79], v[224:227]
ds_read_b128 a[4:7], v1 offset:25600
v_mfma_f32_16x16x32_bf16 v[228:231], a[36:39], v[76:79], v[228:231]
v_exp_f32 v29, v29
v_mfma_f32_16x16x32_bf16 v[196:199], a[36:39], v[72:75], v[196:199]
v_exp_f32 v30, v30
v_mfma_f32_16x16x32_bf16 v[164:167], a[36:39], v[68:71], v[164:167]
v_cvt_pk_bf16_f32 v60, v28, v29
v_mfma_f32_16x16x32_bf16 v[132:135], a[36:39], v[64:67], v[132:135]
buffer_load_dwordx4 v3, s[48:51], s7 offen offset:1024 sc1 lds
v_mfma_f32_16x16x32_bf16 v[136:139], a[40:43], v[64:67], v[136:139]
ds_read_b128 a[8:11], v1 offset:26624
v_mfma_f32_16x16x32_bf16 v[168:171], a[40:43], v[68:71], v[168:171]
v_exp_f32 v31, v31
v_mfma_f32_16x16x32_bf16 v[200:203], a[40:43], v[72:75], v[200:203]
v_exp_f32 v32, v32
v_mfma_f32_16x16x32_bf16 v[232:235], a[40:43], v[76:79], v[232:235]
ds_read_b128 a[12:15], v1 offset:27648
v_cvt_pk_bf16_f32 v61, v30, v31
v_mfma_f32_16x16x32_bf16 v[236:239], a[44:47], v[76:79], v[236:239]
v_mfma_f32_16x16x32_bf16 v[204:207], a[44:47], v[72:75], v[204:207]
v_exp_f32 v33, v33
v_mfma_f32_16x16x32_bf16 v[172:175], a[44:47], v[68:71], v[172:175]
v_exp_f32 v34, v34
v_mfma_f32_16x16x32_bf16 v[140:143], a[44:47], v[64:67], v[140:143]
ds_read_b128 a[16:19], v1 offset:28672
v_cvt_pk_bf16_f32 v50, v32, v33
v_mfma_f32_16x16x32_bf16 v[144:147], a[48:51], v[64:67], v[144:147]
v_mfma_f32_16x16x32_bf16 v[176:179], a[48:51], v[68:71], v[176:179]
v_exp_f32 v35, v35
v_mfma_f32_16x16x32_bf16 v[208:211], a[48:51], v[72:75], v[208:211]
ds_read_b128 a[20:23], v1 offset:29696
v_cvt_pk_bf16_f32 v51, v34, v35
v_mfma_f32_16x16x32_bf16 v[240:243], a[48:51], v[76:79], v[240:243]
v_exp_f32 v36, v36
v_mfma_f32_16x16x32_bf16 v[244:247], a[52:55], v[76:79], v[244:247]
v_exp_f32 v37, v37
v_mfma_f32_16x16x32_bf16 v[212:215], a[52:55], v[72:75], v[212:215]
v_cvt_pk_bf16_f32 v54, v36, v37
v_mfma_f32_16x16x32_bf16 v[180:183], a[52:55], v[68:71], v[180:183]
buffer_load_dwordx4 v3, s[48:51], s7 offen offset:2048 sc1 lds
v_mfma_f32_16x16x32_bf16 v[148:151], a[52:55], v[64:67], v[148:151]
ds_read_b128 a[24:27], v1 offset:30720
v_mfma_f32_16x16x32_bf16 v[152:155], a[56:59], v[64:67], v[152:155]
v_exp_f32 v38, v38
v_mfma_f32_16x16x32_bf16 v[184:187], a[56:59], v[68:71], v[184:187]
v_exp_f32 v39, v39
v_mfma_f32_16x16x32_bf16 v[216:219], a[56:59], v[72:75], v[216:219]
ds_read_b128 a[28:31], v1 offset:31744
v_cvt_pk_bf16_f32 v55, v38, v39
v_mfma_f32_16x16x32_bf16 v[248:251], a[56:59], v[76:79], v[248:251]
v_mfma_f32_16x16x32_bf16 v[252:255], a[60:63], v[76:79], v[252:255]
v_exp_f32 v40, v40
v_mfma_f32_16x16x32_bf16 v[220:223], a[60:63], v[72:75], v[220:223]
v_exp_f32 v41, v41
v_mfma_f32_16x16x32_bf16 v[188:191], a[60:63], v[68:71], v[188:191]
ds_read_b128 a[32:35], v1 offset:16384
v_cvt_pk_bf16_f32 v58, v40, v41
v_mfma_f32_16x16x32_bf16 v[156:159], a[60:63], v[64:67], v[156:159]
v_smfmac_f32_16x16x64_bf16 a[224:227], a[232:235], v[64:71], v9
s_waitcnt lgkmcnt(5)
v_exp_f32 v42, v42
v_smfmac_f32_16x16x64_bf16 a[228:231], a[232:235], v[72:79], v9
ds_read_b128 a[36:39], v1 offset:17408
v_mfma_f32_16x16x32_bf16 v[16:19], a[0:3], a[160:163], v[96:99]
v_exp_f32 v43, v43
v_mfma_f32_16x16x32_bf16 v[16:19], a[4:7], a[164:167], v[16:19]
v_exp_f32 v44, v44
v_mfma_f32_16x16x32_bf16 v[16:19], a[8:11], a[168:171], v[16:19]
v_cvt_pk_bf16_f32 v59, v42, v43
v_mfma_f32_16x16x32_bf16 v[16:19], a[12:15], a[172:175], v[16:19]
buffer_load_dwordx4 v3, s[48:51], s7 offen offset:3072 sc1 lds
v_mfma_f32_16x16x32_bf16 v[20:23], a[0:3], a[176:179], v[84:87]
ds_read_b128 a[40:43], v1 offset:18432
v_mfma_f32_16x16x32_bf16 v[20:23], a[4:7], a[180:183], v[20:23]
v_exp_f32 v45, v45
v_mfma_f32_16x16x32_bf16 v[20:23], a[8:11], a[184:187], v[20:23]
v_exp_f32 v46, v46
v_mfma_f32_16x16x32_bf16 v[20:23], a[12:15], a[188:191], v[20:23]
ds_read_b128 a[44:47], v1 offset:19456
v_cvt_pk_bf16_f32 v62, v44, v45
v_mfma_f32_16x16x32_bf16 v[24:27], a[0:3], a[192:195], v[88:91]
v_mfma_f32_16x16x32_bf16 v[24:27], a[4:7], a[196:199], v[24:27]
v_exp_f32 v47, v47
v_mfma_f32_16x16x32_bf16 v[24:27], a[8:11], a[200:203], v[24:27]
v_exp_f32 v16, v16
v_mfma_f32_16x16x32_bf16 v[24:27], a[12:15], a[204:207], v[24:27]
ds_read_b128 a[48:51], v1 offset:20480
v_cvt_pk_bf16_f32 v63, v46, v47
v_mfma_f32_16x16x32_bf16 v[28:31], a[0:3], a[208:211], v[92:95]
v_mfma_f32_16x16x32_bf16 v[28:31], a[4:7], a[212:215], v[28:31]
v_exp_f32 v17, v17
v_mfma_f32_16x16x32_bf16 v[28:31], a[8:11], a[216:219], v[28:31]
ds_read_b128 a[52:55], v1 offset:21504
v_cvt_pk_bf16_f32 v64, v16, v17
v_mfma_f32_16x16x32_bf16 v[28:31], a[12:15], a[220:223], v[28:31]
s_waitcnt lgkmcnt(6)
v_exp_f32 v18, v18
v_mfma_f32_16x16x32_bf16 v[32:35], a[16:19], a[160:163], v[100:103]
v_mfma_f32_16x16x32_bf16 v[32:35], a[20:23], a[164:167], v[32:35]
s_mov_b32 s9, 0x0
v_exp_f32 v19, v19
v_mfma_f32_16x16x32_bf16 v[32:35], a[24:27], a[168:171], v[32:35]
buffer_load_dword a244, v8, s[72:75], s9 offen
v_mfma_f32_16x16x32_bf16 v[32:35], a[28:31], a[172:175], v[32:35]
ds_read_b128 a[56:59], v1 offset:22528
v_cvt_pk_bf16_f32 v65, v18, v19
v_mfma_f32_16x16x32_bf16 v[36:39], a[16:19], a[176:179], v[84:87]
s_add_u32 s32, s32, 0x8000
v_exp_f32 v20, v20
v_mfma_f32_16x16x32_bf16 v[36:39], a[20:23], a[180:183], v[36:39]
s_add_u32 s7, s7, 0x8000
v_exp_f32 v21, v21
v_mfma_f32_16x16x32_bf16 v[36:39], a[24:27], a[184:187], v[36:39]
ds_read_b128 a[60:63], v1 offset:23552
v_xor_b32 v1, 0x8000, v1
v_mfma_f32_16x16x32_bf16 v[36:39], a[28:31], a[188:191], v[36:39]
s_xor_b32 s27, s27, 0x38000
v_cvt_pk_bf16_f32 v68, v20, v21
v_mfma_f32_16x16x32_bf16 v[40:43], a[16:19], a[192:195], v[88:91]
v_exp_f32 v22, v22
v_mfma_f32_16x16x32_bf16 v[40:43], a[20:23], a[196:199], v[40:43]
v_exp_f32 v23, v23
v_mfma_f32_16x16x32_bf16 v[40:43], a[24:27], a[200:203], v[40:43]
v_cvt_pk_bf16_f32 v69, v22, v23
v_mfma_f32_16x16x32_bf16 v[40:43], a[28:31], a[204:207], v[40:43]
v_exp_f32 v24, v24
v_mfma_f32_16x16x32_bf16 v[44:47], a[16:19], a[208:211], v[92:95]
v_exp_f32 v25, v25
v_mfma_f32_16x16x32_bf16 v[44:47], a[20:23], a[212:215], v[44:47]
v_exp_f32 v26, v26
v_mfma_f32_16x16x32_bf16 v[44:47], a[24:27], a[216:219], v[44:47]
s_waitcnt vmcnt(17) lgkmcnt(0)
v_exp_f32 v27, v27
v_mfma_f32_16x16x32_bf16 v[44:47], a[28:31], a[220:223], v[44:47]
s_barrier
L_att_l1_1:
v_mfma_f32_16x16x32_bf16 v[128:131], a[32:35], v[48:51], v[128:131]
ds_read_b128 a[0:3], v2 offset:8192
v_cvt_pk_bf16_f32 v72, v24, v25
v_mfma_f32_16x16x32_bf16 v[160:163], a[32:35], v[52:55], v[160:163]
s_add_u32 m0, s19, 0x0
v_exp_f32 v28, v28
v_mfma_f32_16x16x32_bf16 v[192:195], a[32:35], v[56:59], v[192:195]
buffer_load_dwordx4 v3, s[48:51], s32 offen offset:0 sc1 lds
v_mfma_f32_16x16x32_bf16 v[224:227], a[32:35], v[60:63], v[224:227]
ds_read_b128 a[4:7], v2 offset:9216
v_cvt_pk_bf16_f32 v73, v26, v27
v_mfma_f32_16x16x32_bf16 v[228:231], a[36:39], v[60:63], v[228:231]
s_and_b32 s44, s18, 3
s_lshl_b32 s45, s44, 1
s_add_u32 s45, s45, s100
v_mfma_f32_16x16x32_bf16 v[196:199], a[36:39], v[56:59], v[196:199]
s_add_u32 s8, s16, 0x0
v_exp_f32 v29, v29
v_mfma_f32_16x16x32_bf16 v[164:167], a[36:39], v[52:55], v[164:167]
ds_read_b128 a[8:11], v2 offset:10240
v_cvt_pk_bf16_f32 v76, v28, v29
v_mfma_f32_16x16x32_bf16 v[132:135], a[36:39], v[48:51], v[132:135]
buffer_store_dwordx4 a[64:67], v3, s[88:91], s8 offen offset:0 sc1
v_mfma_f32_16x16x32_bf16 v[136:139], a[40:43], v[48:51], v[136:139]
s_and_b32 s60, s45, 3
v_exp_f32 v30, v30
v_mfma_f32_16x16x32_bf16 v[168:171], a[40:43], v[52:55], v[168:171]
ds_read_b128 a[12:15], v2 offset:11264
s_sub_u32 s60, s60, s44
v_mfma_f32_16x16x32_bf16 v[200:203], a[40:43], v[56:59], v[200:203]
s_add_u32 s60, s60, 11
v_exp_f32 v31, v31
v_mfma_f32_16x16x32_bf16 v[232:235], a[40:43], v[60:63], v[232:235]
s_lshl_b32 s60, s60, 14
v_exp_f32 v32, v32
v_mfma_f32_16x16x32_bf16 v[236:239], a[44:47], v[60:63], v[236:239]
buffer_load_dwordx4 v3, s[48:51], s32 offen offset:1024 sc1 lds
v_mfma_f32_16x16x32_bf16 v[204:207], a[44:47], v[56:59], v[204:207]
ds_read_b128 a[16:19], v2 offset:12288
v_cvt_pk_bf16_f32 v77, v30, v31
v_mfma_f32_16x16x32_bf16 v[172:175], a[44:47], v[52:55], v[172:175]
s_mul_i32 s44, s44, -8
v_exp_f32 v33, v33
v_mfma_f32_16x16x32_bf16 v[140:143], a[44:47], v[48:51], v[140:143]
s_and_b32 s44, s44, 31
v_exp_f32 v34, v34
v_mfma_f32_16x16x32_bf16 v[144:147], a[48:51], v[48:51], v[144:147]
ds_read_b128 a[20:23], v2 offset:13312
v_cvt_pk_bf16_f32 v66, v32, v33
v_mfma_f32_16x16x32_bf16 v[176:179], a[48:51], v[52:55], v[176:179]
buffer_store_dwordx4 a[64:67], v3, s[88:91], s8 offen offset:1024 sc1
v_mfma_f32_16x16x32_bf16 v[208:211], a[48:51], v[56:59], v[208:211]
s_lshl_b32 s44, 4, s44
v_exp_f32 v35, v35
v_mfma_f32_16x16x32_bf16 v[240:243], a[48:51], v[60:63], v[240:243]
ds_read_b128 a[24:27], v2 offset:14336
v_cvt_pk_bf16_f32 v67, v34, v35
v_mfma_f32_16x16x32_bf16 v[244:247], a[52:55], v[60:63], v[244:247]
s_mul_i32 s45, s45, -8
v_exp_f32 v36, v36
v_mfma_f32_16x16x32_bf16 v[212:215], a[52:55], v[56:59], v[212:215]
s_and_b32 s45, s45, 31
v_exp_f32 v37, v37
v_mfma_f32_16x16x32_bf16 v[180:183], a[52:55], v[52:55], v[180:183]
buffer_load_dwordx4 v3, s[48:51], s32 offen offset:2048 sc1 lds
v_mfma_f32_16x16x32_bf16 v[148:151], a[52:55], v[48:51], v[148:151]
ds_read_b128 a[28:31], v2 offset:15360
v_cvt_pk_bf16_f32 v70, v36, v37
v_mfma_f32_16x16x32_bf16 v[152:155], a[56:59], v[48:51], v[152:155]
s_lshl_b32 s45, 4, s45
s_add_u32 s44, s44, 0x11111111
s_sub_u32 s44, s44, s45
v_mfma_f32_16x16x32_bf16 v[184:187], a[56:59], v[52:55], v[184:187]
s_bfe_u32 s56, s44, 0x80000
v_exp_f32 v38, v38
v_mfma_f32_16x16x32_bf16 v[216:219], a[56:59], v[56:59], v[216:219]
ds_read_b128 a[32:35], v2 offset:0
s_lshl_b32 s56, s56, 14
v_mfma_f32_16x16x32_bf16 v[248:251], a[56:59], v[60:63], v[248:251]
s_bfe_u32 s57, s44, 0x80008
v_exp_f32 v39, v39
v_mfma_f32_16x16x32_bf16 v[252:255], a[60:63], v[60:63], v[252:255]
buffer_store_dwordx4 a[64:67], v3, s[88:91], s8 offen offset:2048 sc1
v_mfma_f32_16x16x32_bf16 v[220:223], a[60:63], v[56:59], v[220:223]
ds_read_b128 a[36:39], v2 offset:1024
v_cvt_pk_bf16_f32 v71, v38, v39
v_mfma_f32_16x16x32_bf16 v[188:191], a[60:63], v[52:55], v[188:191]
s_lshl_b32 s57, s57, 14
v_exp_f32 v40, v40
v_mfma_f32_16x16x32_bf16 v[156:159], a[60:63], v[48:51], v[156:159]
s_bfe_u32 s58, s44, 0x80010
v_exp_f32 v41, v41
v_smfmac_f32_16x16x64_bf16 a[224:227], a[232:235], v[48:55], v9
s_waitcnt lgkmcnt(6)
v_exp_f32 v42, v42
v_smfmac_f32_16x16x64_bf16 a[228:231], a[232:235], v[56:63], v9
buffer_load_dwordx4 v3, s[48:51], s32 offen offset:3072 sc1 lds
v_mfma_f32_16x16x32_bf16 v[20:23], a[0:3], a[176:179], v[104:107]
ds_read_b128 a[40:43], v2 offset:2048
v_cvt_pk_bf16_f32 v74, v40, v41
v_mfma_f32_16x16x32_bf16 v[20:23], a[4:7], a[180:183], v[20:23]
s_lshl_b32 s58, s58, 14
v_exp_f32 v43, v43
v_mfma_f32_16x16x32_bf16 v[20:23], a[8:11], a[184:187], v[20:23]
ds_read_b128 a[44:47], v2 offset:3072
v_cvt_pk_bf16_f32 v75, v42, v43
v_mfma_f32_16x16x32_bf16 v[20:23], a[12:15], a[188:191], v[20:23]
s_bfe_u32 s59, s44, 0x80018
v_exp_f32 v44, v44
v_mfma_f32_16x16x32_bf16 v[24:27], a[0:3], a[192:195], v[88:91]
buffer_store_dwordx4 a[64:67], v3, s[88:91], s8 offen offset:3072 sc1
v_mfma_f32_16x16x32_bf16 v[24:27], a[4:7], a[196:199], v[24:27]
ds_read_b128 a[48:51], v2 offset:4096
s_lshl_b32 s59, s59, 14
v_mfma_f32_16x16x32_bf16 v[24:27], a[8:11], a[200:203], v[24:27]
v_exp_f32 v45, v45
v_mfma_f32_16x16x32_bf16 v[24:27], a[12:15], a[204:207], v[24:27]
v_exp_f32 v46, v46
v_mfma_f32_16x16x32_bf16 v[28:31], a[0:3], a[208:211], v[92:95]
s_add_u32 m0, s19, 0x1000
v_exp_f32 v47, v47
v_mfma_f32_16x16x32_bf16 v[28:31], a[4:7], a[212:215], v[28:31]
buffer_load_dwordx4 v3, s[48:51], s7 offen offset:0 sc1 lds
v_mfma_f32_16x16x32_bf16 v[28:31], a[8:11], a[216:219], v[28:31]
ds_read_b128 a[52:55], v2 offset:5120
v_cvt_pk_bf16_f32 v78, v44, v45
v_mfma_f32_16x16x32_bf16 v[28:31], a[12:15], a[220:223], v[28:31]
s_waitcnt lgkmcnt(6)
v_exp_f32 v20, v20
v_mfma_f32_16x16x32_bf16 v[36:39], a[16:19], a[176:179], v[108:111]
ds_read_b128 a[56:59], v2 offset:6144
v_cvt_pk_bf16_f32 v79, v46, v47
v_mfma_f32_16x16x32_bf16 v[36:39], a[20:23], a[180:183], v[36:39]
s_add_u32 s8, s16, 0x400000
v_exp_f32 v21, v21
v_mfma_f32_16x16x32_bf16 v[36:39], a[24:27], a[184:187], v[36:39]
buffer_store_dwordx4 a[64:67], v3, s[88:91], s8 offen offset:0 sc1
v_mfma_f32_16x16x32_bf16 v[36:39], a[28:31], a[188:191], v[36:39]
ds_read_b128 a[60:63], v2 offset:7168
v_cvt_pk_bf16_f32 v52, v20, v21
v_mfma_f32_16x16x32_bf16 v[40:43], a[16:19], a[192:195], v[88:91]
v_exp_f32 v22, v22
v_mfma_f32_16x16x32_bf16 v[40:43], a[20:23], a[196:199], v[40:43]
v_exp_f32 v23, v23
v_mfma_f32_16x16x32_bf16 v[40:43], a[24:27], a[200:203], v[40:43]
v_exp_f32 v24, v24
v_mfma_f32_16x16x32_bf16 v[40:43], a[28:31], a[204:207], v[40:43]
buffer_load_dwordx4 v3, s[48:51], s7 offen offset:1024 sc1 lds
v_mfma_f32_16x16x32_bf16 v[44:47], a[16:19], a[208:211], v[92:95]
v_exp_f32 v25, v25
v_mfma_f32_16x16x32_bf16 v[44:47], a[20:23], a[212:215], v[44:47]
v_exp_f32 v26, v26
v_mfma_f32_16x16x32_bf16 v[44:47], a[24:27], a[216:219], v[44:47]
v_exp_f32 v27, v27
v_mfma_f32_16x16x32_bf16 v[44:47], a[28:31], a[220:223], v[44:47]
s_waitcnt lgkmcnt(0)
v_cvt_pk_bf16_f32 v53, v22, v23
v_mov_b32 v6, 0xf149f2ca
v_min_f32 v119, s10, v88
v_cndmask_b32 v112, v119, v88, s[36:37]
v_cndmask_b32 v113, v119, v88, s[38:39]
v_cndmask_b32 v114, v119, v88, s[40:41]
v_cndmask_b32 v115, v119, v88, s[42:43]
v_cndmask_b32 v116, v6, v119, s[36:37]
v_cndmask_b32 v117, v6, v119, s[38:39]
v_cndmask_b32 v118, v6, v119, s[40:41]
v_cndmask_b32 v119, v6, v119, s[42:43]
v_min_f32 v127, s11, v92
v_cndmask_b32 v120, v127, v92, s[36:37]
v_cndmask_b32 v121, v127, v92, s[38:39]
v_cndmask_b32 v122, v127, v92, s[40:41]
v_cndmask_b32 v123, v127, v92, s[42:43]
v_cndmask_b32 v124, v6, v127, s[36:37]
v_cndmask_b32 v125, v6, v127, s[38:39]
v_cndmask_b32 v126, v6, v127, s[40:41]
v_cndmask_b32 v127, v6, v127, s[42:43]
v_mfma_f32_16x16x32_bf16 v[128:131], a[32:35], v[64:67], v[128:131]
v_exp_f32 v28, v28
v_mfma_f32_16x16x32_bf16 v[160:163], a[32:35], v[68:71], v[160:163]
ds_read_b128 a[0:3], v2 offset:24576
v_cvt_pk_bf16_f32 v56, v24, v25
v_mfma_f32_16x16x32_bf16 v[192:195], a[32:35], v[72:75], v[192:195]
buffer_store_dwordx4 a[64:67], v3, s[88:91], s8 offen offset:1024 sc1
v_mfma_f32_16x16x32_bf16 v[224:227], a[32:35], v[76:79], v[224:227]
ds_read_b128 a[4:7], v2 offset:25600
v_cvt_pk_bf16_f32 v57, v26, v27
v_mfma_f32_16x16x32_bf16 v[228:231], a[36:39], v[76:79], v[228:231]
buffer_load_dwordx4 v3, s[48:51], s7 offen offset:2048 sc1 lds
v_mfma_f32_16x16x32_bf16 v[196:199], a[36:39], v[72:75], v[196:199]
ds_read_b128 a[8:11], v2 offset:26624
v_mfma_f32_16x16x32_bf16 v[164:167], a[36:39], v[68:71], v[164:167]
v_exp_f32 v29, v29
v_mfma_f32_16x16x32_bf16 v[132:135], a[36:39], v[64:67], v[132:135]
v_exp_f32 v30, v30
v_mfma_f32_16x16x32_bf16 v[136:139], a[40:43], v[64:67], v[136:139]
v_exp_f32 v31, v31
v_mfma_f32_16x16x32_bf16 v[168:171], a[40:43], v[68:71], v[168:171]
v_exp_f32 v36, v36
v_mfma_f32_16x16x32_bf16 v[200:203], a[40:43], v[72:75], v[200:203]
ds_read_b128 a[12:15], v2 offset:27648
v_cvt_pk_bf16_f32 v60, v28, v29
v_mfma_f32_16x16x32_bf16 v[232:235], a[40:43], v[76:79], v[232:235]
buffer_store_dwordx4 a[64:67], v3, s[88:91], s8 offen offset:2048 sc1
v_mfma_f32_16x16x32_bf16 v[236:239], a[44:47], v[76:79], v[236:239]
ds_read_b128 a[16:19], v2 offset:28672
v_cvt_pk_bf16_f32 v61, v30, v31
v_mfma_f32_16x16x32_bf16 v[204:207], a[44:47], v[72:75], v[204:207]
v_exp_f32 v37, v37
v_mfma_f32_16x16x32_bf16 v[172:175], a[44:47], v[68:71], v[172:175]
ds_read_b128 a[20:23], v2 offset:29696
v_cvt_pk_bf16_f32 v54, v36, v37
v_mfma_f32_16x16x32_bf16 v[140:143], a[44:47], v[64:67], v[140:143]
buffer_load_dwordx4 v3, s[48:51], s7 offen offset:3072 sc1 lds
v_mfma_f32_16x16x32_bf16 v[144:147], a[48:51], v[64:67], v[144:147]
v_exp_f32 v38, v38
v_mfma_f32_16x16x32_bf16 v[176:179], a[48:51], v[68:71], v[176:179]
buffer_store_dwordx4 a[64:67], v3, s[88:91], s8 offen offset:3072 sc1
v_mfma_f32_16x16x32_bf16 v[208:211], a[48:51], v[72:75], v[208:211]
ds_read_b128 a[24:27], v2 offset:30720
v_mfma_f32_16x16x32_bf16 v[240:243], a[48:51], v[76:79], v[240:243]
ds_read_b128 a[28:31], v2 offset:31744
v_mfma_f32_16x16x32_bf16 v[244:247], a[52:55], v[76:79], v[244:247]
s_add_u32 s8, s16, 0x800000
v_exp_f32 v39, v39
v_mfma_f32_16x16x32_bf16 v[212:215], a[52:55], v[72:75], v[212:215]
buffer_store_dwordx4 a[64:67], v3, s[88:91], s8 offen offset:0 sc1
v_mfma_f32_16x16x32_bf16 v[180:183], a[52:55], v[68:71], v[180:183]
ds_read_b128 a[32:35], v2 offset:16384
v_cvt_pk_bf16_f32 v55, v38, v39
v_mfma_f32_16x16x32_bf16 v[148:151], a[52:55], v[64:67], v[148:151]
v_exp_f32 v40, v40
v_mfma_f32_16x16x32_bf16 v[152:155], a[56:59], v[64:67], v[152:155]
v_exp_f32 v41, v41
v_mfma_f32_16x16x32_bf16 v[184:187], a[56:59], v[68:71], v[184:187]
buffer_store_dwordx4 a[64:67], v3, s[88:91], s8 offen offset:1024 sc1
v_mfma_f32_16x16x32_bf16 v[216:219], a[56:59], v[72:75], v[216:219]
ds_read_b128 a[36:39], v2 offset:17408
v_cvt_pk_bf16_f32 v58, v40, v41
v_mfma_f32_16x16x32_bf16 v[248:251], a[56:59], v[76:79], v[248:251]
ds_read_b128 a[40:43], v2 offset:18432
v_mfma_f32_16x16x32_bf16 v[252:255], a[60:63], v[76:79], v[252:255]
v_exp_f32 v42, v42
v_mfma_f32_16x16x32_bf16 v[220:223], a[60:63], v[72:75], v[220:223]
buffer_store_dwordx4 a[64:67], v3, s[88:91], s8 offen offset:2048 sc1
v_mfma_f32_16x16x32_bf16 v[188:191], a[60:63], v[68:71], v[188:191]
ds_read_b128 a[44:47], v2 offset:19456
v_mfma_f32_16x16x32_bf16 v[156:159], a[60:63], v[64:67], v[156:159]
v_exp_f32 v43, v43
v_smfmac_f32_16x16x64_bf16 a[224:227], a[232:235], v[64:71], v9
v_exp_f32 v44, v44
v_smfmac_f32_16x16x64_bf16 a[228:231], a[232:235], v[72:79], v9
s_waitcnt lgkmcnt(8)
v_exp_f32 v45, v45
v_mfma_f32_16x16x32_bf16 v[24:27], a[0:3], a[192:195], v[88:91]
ds_read_b128 a[48:51], v2 offset:20480
v_cvt_pk_bf16_f32 v59, v42, v43
v_mfma_f32_16x16x32_bf16 v[24:27], a[4:7], a[196:199], v[24:27]
ds_read_b128 a[52:55], v2 offset:21504
v_cvt_pk_bf16_f32 v62, v44, v45
v_mfma_f32_16x16x32_bf16 v[24:27], a[8:11], a[200:203], v[24:27]
buffer_store_dwordx4 a[64:67], v3, s[88:91], s8 offen offset:3072 sc1
v_mfma_f32_16x16x32_bf16 v[24:27], a[12:15], a[204:207], v[24:27]
v_exp_f32 v46, v46
v_mfma_f32_16x16x32_bf16 v[28:31], a[0:3], a[208:211], v[92:95]
ds_read_b128 a[56:59], v2 offset:22528
v_add_u32 v4, s0, v3
v_mfma_f32_16x16x32_bf16 v[28:31], a[4:7], a[212:215], v[28:31]
s_waitcnt lgkmcnt(7)
v_exp_f32 v47, v47
v_mfma_f32_16x16x32_bf16 v[28:31], a[8:11], a[216:219], v[28:31]
ds_read_b128 a[60:63], v2 offset:23552
v_mov_b32 v5, s1
v_mfma_f32_16x16x32_bf16 v[28:31], a[12:15], a[220:223], v[28:31]
global_load_dword a244, v[4:5], off sc1
v_mfma_f32_16x16x32_bf16 v[40:43], a[16:19], a[192:195], v[88:91]
s_add_u32 s32, s32, 0x8000
v_xor_b32 v2, 0x38000, v2
v_cvt_pk_bf16_f32 v63, v46, v47
v_mfma_f32_16x16x32_bf16 v[40:43], a[20:23], a[196:199], v[40:43]
s_add_u32 s7, s7, 0x8000
v_exp_f32 v24, v24
v_mfma_f32_16x16x32_bf16 v[40:43], a[24:27], a[200:203], v[40:43]
s_xor_b32 s19, s19, 0x8000
v_exp_f32 v25, v25
v_mfma_f32_16x16x32_bf16 v[40:43], a[28:31], a[204:207], v[40:43]
s_sub_u32 s15, 7, s6
v_exp_f32 v26, v26
v_mfma_f32_16x16x32_bf16 v[44:47], a[16:19], a[208:211], v[92:95]
s_lshl_b32 s15, s15, 1
v_exp_f32 v27, v27
v_mfma_f32_16x16x32_bf16 v[44:47], a[20:23], a[212:215], v[44:47]
v_exp_f32 v28, v28
v_mfma_f32_16x16x32_bf16 v[44:47], a[24:27], a[216:219], v[44:47]
s_waitcnt vmcnt(30) lgkmcnt(0)
v_exp_f32 v29, v29
v_mfma_f32_16x16x32_bf16 v[44:47], a[28:31], a[220:223], v[44:47]
s_barrier
s_cbranch_scc0 L_att_lh0_1
L_att_ls_1:
v_mfma_f32_16x16x32_bf16 v[160:163], a[32:35], v[52:55], v[160:163]
ds_read_b128 a[0:3], v1 offset:8192
v_cvt_pk_bf16_f32 v72, v24, v25
v_mfma_f32_16x16x32_bf16 v[192:195], a[32:35], v[56:59], v[192:195]
v_exp_f32 v30, v30
v_mfma_f32_16x16x32_bf16 v[224:227], a[32:35], v[60:63], v[224:227]
ds_read_b128 a[4:7], v1 offset:9216
v_cvt_pk_bf16_f32 v73, v26, v27
v_mfma_f32_16x16x32_bf16 v[228:231], a[36:39], v[60:63], v[228:231]
s_add_u32 m0, s27, 0x0
v_cvt_pk_bf16_f32 v76, v28, v29
v_accvgpr_read_b32 v6, a224
v_mfma_f32_16x16x32_bf16 v[196:199], a[36:39], v[56:59], v[196:199]
buffer_load_dwordx4 v3, s[48:51], s32 offen offset:0 sc1 lds
v_mfma_f32_16x16x32_bf16 v[164:167], a[36:39], v[52:55], v[164:167]
ds_read_b128 a[8:11], v1 offset:10240
v_accvgpr_read_b32 v7, a225
v_mfma_f32_16x16x32_bf16 v[168:171], a[40:43], v[52:55], v[168:171]
ds_read_b128 a[12:15], v1 offset:11264
v_add_f32 v6, v6, v7
v_mfma_f32_16x16x32_bf16 v[200:203], a[40:43], v[56:59], v[200:203]
v_exp_f32 v31, v31
v_mfma_f32_16x16x32_bf16 v[232:235], a[40:43], v[60:63], v[232:235]
v_exp_f32 v40, v40
v_mfma_f32_16x16x32_bf16 v[236:239], a[44:47], v[60:63], v[236:239]
ds_read_b128 a[16:19], v1 offset:12288
v_cvt_pk_bf16_f32 v77, v30, v31
v_mfma_f32_16x16x32_bf16 v[204:207], a[44:47], v[56:59], v[204:207]
v_cmp_nge_f32 vcc, 0x6f800000, v6
v_mfma_f32_16x16x32_bf16 v[172:175], a[44:47], v[52:55], v[172:175]
ds_read_b128 a[20:23], v1 offset:13312
v_mfma_f32_16x16x32_bf16 v[176:179], a[48:51], v[52:55], v[176:179]
v_exp_f32 v41, v41
v_mfma_f32_16x16x32_bf16 v[208:211], a[48:51], v[56:59], v[208:211]
ds_read_b128 a[24:27], v1 offset:14336
v_cvt_pk_bf16_f32 v74, v40, v41
v_mfma_f32_16x16x32_bf16 v[240:243], a[48:51], v[60:63], v[240:243]
buffer_load_dwordx4 v3, s[48:51], s32 offen offset:1024 sc1 lds
v_mfma_f32_16x16x32_bf16 v[244:247], a[52:55], v[60:63], v[244:247]
v_exp_f32 v42, v42
v_mfma_f32_16x16x32_bf16 v[212:215], a[52:55], v[56:59], v[212:215]
ds_read_b128 a[28:31], v1 offset:15360
v_mfma_f32_16x16x32_bf16 v[180:183], a[52:55], v[52:55], v[180:183]
v_exp_f32 v43, v43
v_mfma_f32_16x16x32_bf16 v[184:187], a[56:59], v[52:55], v[184:187]
ds_read_b128 a[32:35], v1 offset:0
v_cvt_pk_bf16_f32 v75, v42, v43
v_mfma_f32_16x16x32_bf16 v[216:219], a[56:59], v[56:59], v[216:219]
v_rcp_f32 v6, v6
v_mfma_f32_16x16x32_bf16 v[248:251], a[56:59], v[60:63], v[248:251]
ds_read_b128 a[36:39], v1 offset:1024
s_or_b64 s[34:35], s[34:35], vcc
v_mfma_f32_16x16x32_bf16 v[252:255], a[60:63], v[60:63], v[252:255]
s_add_u32 s8, s28, 0x0
v_exp_f32 v44, v44
v_mfma_f32_16x16x32_bf16 v[220:223], a[60:63], v[56:59], v[220:223]
v_exp_f32 v45, v45
v_mfma_f32_16x16x32_bf16 v[188:191], a[60:63], v[52:55], v[188:191]
ds_read_b128 a[40:43], v1 offset:2048
v_cvt_pk_bf16_f32 v78, v44, v45
v_mfma_f32_16x16x32_bf16 a[224:227], a[236:239], v[52:55], a[224:227]
buffer_load_dwordx4 v3, s[48:51], s32 offen offset:2048 sc1 lds
v_smfmac_f32_16x16x64_bf16 a[228:231], a[232:235], v[56:63], v9
ds_read_b128 a[44:47], v1 offset:3072
s_waitcnt lgkmcnt(8)
v_mfma_f32_16x16x32_bf16 v[24:27], a[0:3], a[192:195], v[88:91]
v_exp_f32 v46, v46
v_mfma_f32_16x16x32_bf16 v[24:27], a[4:7], a[196:199], v[24:27]
ds_read_b128 a[48:51], v1 offset:4096
v_mul_f32 v128, v6, v128
v_mfma_f32_16x16x32_bf16 v[24:27], a[8:11], a[200:203], v[24:27]
v_mul_f32 v129, v6, v129
v_mul_f32 v130, v6, v130
v_mfma_f32_16x16x32_bf16 v[24:27], a[12:15], a[204:207], v[24:27]
v_exp_f32 v47, v47
v_mfma_f32_16x16x32_bf16 v[28:31], a[0:3], a[208:211], v[92:95]
ds_read_b128 a[52:55], v1 offset:5120
v_cvt_pk_bf16_f32 v79, v46, v47
v_mfma_f32_16x16x32_bf16 v[28:31], a[4:7], a[212:215], v[28:31]
v_mul_f32 v131, v6, v131
v_mul_f32 v132, v6, v132
v_mfma_f32_16x16x32_bf16 v[28:31], a[8:11], a[216:219], v[28:31]
ds_read_b128 a[56:59], v1 offset:6144
v_mul_f32 v133, v6, v133
v_mfma_f32_16x16x32_bf16 v[28:31], a[12:15], a[220:223], v[28:31]
s_waitcnt lgkmcnt(7)
v_exp_f32 v24, v24
v_mfma_f32_16x16x32_bf16 v[40:43], a[16:19], a[192:195], v[88:91]
buffer_load_dwordx4 v3, s[48:51], s32 offen offset:3072 sc1 lds
v_mfma_f32_16x16x32_bf16 v[40:43], a[20:23], a[196:199], v[40:43]
ds_read_b128 a[60:63], v1 offset:7168
v_mul_f32 v134, v6, v134
v_mfma_f32_16x16x32_bf16 v[40:43], a[24:27], a[200:203], v[40:43]
s_add_u32 s32, s32, 0x8000
v_exp_f32 v25, v25
v_mfma_f32_16x16x32_bf16 v[40:43], a[28:31], a[204:207], v[40:43]
v_exp_f32 v26, v26
v_mfma_f32_16x16x32_bf16 v[44:47], a[16:19], a[208:211], v[92:95]
v_exp_f32 v27, v27
v_mfma_f32_16x16x32_bf16 v[44:47], a[20:23], a[212:215], v[44:47]
v_exp_f32 v28, v28
v_mfma_f32_16x16x32_bf16 v[44:47], a[24:27], a[216:219], v[44:47]
v_exp_f32 v29, v29
v_mfma_f32_16x16x32_bf16 v[44:47], a[28:31], a[220:223], v[44:47]
s_waitcnt lgkmcnt(0)
v_mul_f32 v135, v6, v135
v_cvt_pk_bf16_f32 v128, v128, v129
v_mfma_f32_16x16x32_bf16 v[192:195], a[32:35], v[72:75], v[192:195]
s_add_u32 m0, s27, 0x1000
v_exp_f32 v30, v30
v_mfma_f32_16x16x32_bf16 v[224:227], a[32:35], v[76:79], v[224:227]
buffer_load_dwordx4 v3, s[48:51], s7 offen offset:0 sc1 lds
v_mfma_f32_16x16x32_bf16 v[228:231], a[36:39], v[76:79], v[228:231]
v_exp_f32 v31, v31
v_mfma_f32_16x16x32_bf16 v[196:199], a[36:39], v[72:75], v[196:199]
ds_read_b128 a[0:3], v1 offset:24576
v_cvt_pk_bf16_f32 v56, v24, v25
v_mfma_f32_16x16x32_bf16 v[200:203], a[40:43], v[72:75], v[200:203]
ds_read_b128 a[4:7], v1 offset:25600
v_cvt_pk_bf16_f32 v57, v26, v27
v_mfma_f32_16x16x32_bf16 v[232:235], a[40:43], v[76:79], v[232:235]
v_exp_f32 v40, v40
v_mfma_f32_16x16x32_bf16 v[236:239], a[44:47], v[76:79], v[236:239]
ds_read_b128 a[8:11], v1 offset:26624
v_cvt_pk_bf16_f32 v60, v28, v29
v_mfma_f32_16x16x32_bf16 v[204:207], a[44:47], v[72:75], v[204:207]
v_exp_f32 v41, v41
v_mfma_f32_16x16x32_bf16 v[208:211], a[48:51], v[72:75], v[208:211]
ds_read_b128 a[12:15], v1 offset:27648
v_cvt_pk_bf16_f32 v61, v30, v31
v_mfma_f32_16x16x32_bf16 v[240:243], a[48:51], v[76:79], v[240:243]
ds_read_b128 a[16:19], v1 offset:28672
v_cvt_pk_bf16_f32 v58, v40, v41
v_mfma_f32_16x16x32_bf16 v[244:247], a[52:55], v[76:79], v[244:247]
v_exp_f32 v42, v42
v_mfma_f32_16x16x32_bf16 v[212:215], a[52:55], v[72:75], v[212:215]
buffer_load_dwordx4 v3, s[48:51], s7 offen offset:1024 sc1 lds
v_mfma_f32_16x16x32_bf16 v[216:219], a[56:59], v[72:75], v[216:219]
ds_read_b128 a[20:23], v1 offset:29696
v_cvt_pk_bf16_f32 v129, v130, v131
v_mfma_f32_16x16x32_bf16 v[248:251], a[56:59], v[76:79], v[248:251]
ds_read_b128 a[24:27], v1 offset:30720
v_cvt_pk_bf16_f32 v130, v132, v133
v_mfma_f32_16x16x32_bf16 v[252:255], a[60:63], v[76:79], v[252:255]
ds_read_b128 a[28:31], v1 offset:31744
v_cvt_pk_bf16_f32 v131, v134, v135
v_mfma_f32_16x16x32_bf16 v[220:223], a[60:63], v[72:75], v[220:223]
s_waitcnt lgkmcnt(4)
v_exp_f32 v43, v43
v_smfmac_f32_16x16x64_bf16 a[228:231], a[232:235], v[72:79], v9
ds_read_b128 a[32:35], v1 offset:16384
v_cvt_pk_bf16_f32 v59, v42, v43
v_mfma_f32_16x16x32_bf16 v[24:27], a[0:3], a[192:195], v[88:91]
ds_read_b128 a[36:39], v1 offset:17408
buffer_store_dwordx4 v[128:131], v3, s[88:91], s8 offen sc1
v_mfma_f32_16x16x32_bf16 v[24:27], a[4:7], a[196:199], v[24:27]
buffer_load_dwordx4 v3, s[48:51], s7 offen offset:2048 sc1 lds
v_mfma_f32_16x16x32_bf16 v[24:27], a[8:11], a[200:203], v[24:27]
ds_read_b128 a[40:43], v1 offset:18432
v_exp_f32 v44, v44
v_mfma_f32_16x16x32_bf16 v[24:27], a[12:15], a[204:207], v[24:27]
ds_read_b128 a[44:47], v1 offset:19456
v_exp_f32 v45, v45
v_mfma_f32_16x16x32_bf16 v[28:31], a[0:3], a[208:211], v[92:95]
ds_read_b128 a[48:51], v1 offset:20480
v_exp_f32 v46, v46
v_mfma_f32_16x16x32_bf16 v[28:31], a[4:7], a[212:215], v[28:31]
s_waitcnt lgkmcnt(5)
v_exp_f32 v47, v47
v_mfma_f32_16x16x32_bf16 v[28:31], a[8:11], a[216:219], v[28:31]
ds_read_b128 a[52:55], v1 offset:21504
v_cvt_pk_bf16_f32 v62, v44, v45
v_mfma_f32_16x16x32_bf16 v[28:31], a[12:15], a[220:223], v[28:31]
ds_read_b128 a[56:59], v1 offset:22528
v_cvt_pk_bf16_f32 v63, v46, v47
v_mfma_f32_16x16x32_bf16 v[40:43], a[16:19], a[192:195], v[88:91]
ds_read_b128 a[60:63], v1 offset:23552
v_xor_b32 v1, 0x8000, v1
v_mfma_f32_16x16x32_bf16 v[40:43], a[20:23], a[196:199], v[40:43]
buffer_load_dwordx4 v3, s[48:51], s7 offen offset:3072 sc1 lds
v_mfma_f32_16x16x32_bf16 v[40:43], a[24:27], a[200:203], v[40:43]
s_add_u32 s7, s7, 0x8000
v_exp_f32 v24, v24
v_mfma_f32_16x16x32_bf16 v[40:43], a[28:31], a[204:207], v[40:43]
s_xor_b32 s27, s27, 0x38000
v_exp_f32 v25, v25
v_mfma_f32_16x16x32_bf16 v[44:47], a[16:19], a[208:211], v[92:95]
s_add_u32 s8, s28, 0x2000
v_exp_f32 v26, v26
v_mfma_f32_16x16x32_bf16 v[44:47], a[20:23], a[212:215], v[44:47]
v_exp_f32 v27, v27
v_mfma_f32_16x16x32_bf16 v[44:47], a[24:27], a[216:219], v[44:47]
s_waitcnt vmcnt(29) lgkmcnt(0)
v_exp_f32 v28, v28
v_mfma_f32_16x16x32_bf16 v[44:47], a[28:31], a[220:223], v[44:47]
s_barrier
v_exp_f32 v29, v29
v_mul_f32 v136, v6, v136
v_mul_f32 v137, v6, v137
v_mul_f32 v138, v6, v138
v_mul_f32 v139, v6, v139
v_mul_f32 v140, v6, v140
v_mul_f32 v141, v6, v141
v_mul_f32 v142, v6, v142
v_mul_f32 v143, v6, v143
v_cvt_pk_bf16_f32 v136, v136, v137
v_cvt_pk_bf16_f32 v137, v138, v139
v_cvt_pk_bf16_f32 v138, v140, v141
v_cvt_pk_bf16_f32 v139, v142, v143
buffer_store_dwordx4 v[136:139], v3, s[88:91], s8 offen sc1
s_add_u32 s8, s28, 0x4000
v_mul_f32 v144, v6, v144
v_mul_f32 v145, v6, v145
v_mul_f32 v146, v6, v146
v_mul_f32 v147, v6, v147
v_mul_f32 v148, v6, v148
v_mul_f32 v149, v6, v149
v_mul_f32 v150, v6, v150
v_mul_f32 v151, v6, v151
v_cvt_pk_bf16_f32 v144, v144, v145
v_cvt_pk_bf16_f32 v145, v146, v147
v_cvt_pk_bf16_f32 v146, v148, v149
v_cvt_pk_bf16_f32 v147, v150, v151
buffer_store_dwordx4 v[144:147], v3, s[88:91], s8 offen sc1
s_add_u32 s8, s28, 0x6000
v_mul_f32 v152, v6, v152
v_mul_f32 v153, v6, v153
v_mul_f32 v154, v6, v154
v_mul_f32 v155, v6, v155
v_mul_f32 v156, v6, v156
v_mul_f32 v157, v6, v157
v_mul_f32 v158, v6, v158
v_mul_f32 v159, v6, v159
v_cvt_pk_bf16_f32 v152, v152, v153
v_cvt_pk_bf16_f32 v153, v154, v155
v_cvt_pk_bf16_f32 v154, v156, v157
v_cvt_pk_bf16_f32 v155, v158, v159
buffer_store_dwordx4 v[152:155], v3, s[88:91], s8 offen sc1
v_accvgpr_read_b32 v6, a226
v_accvgpr_read_b32 v7, a227
v_add_f32 v6, v6, v7
v_cmp_nge_f32 vcc, 0x6f800000, v6
v_rcp_f32 v6, v6
s_or_b64 s[34:35], s[34:35], vcc
s_add_u32 s8, s29, 0x0
v_pk_mul_f32 v[160:161], v[160:161], v[6:7] op_sel_hi:[1,0]
v_pk_mul_f32 v[162:163], v[162:163], v[6:7] op_sel_hi:[1,0]
v_pk_mul_f32 v[164:165], v[164:165], v[6:7] op_sel_hi:[1,0]
v_pk_mul_f32 v[166:167], v[166:167], v[6:7] op_sel_hi:[1,0]
v_cvt_pk_bf16_f32 v160, v160, v161
v_cvt_pk_bf16_f32 v161, v162, v163
v_cvt_pk_bf16_f32 v162, v164, v165
v_cvt_pk_bf16_f32 v163, v166, v167
buffer_store_dwordx4 v[160:163], v3, s[88:91], s8 offen sc1
s_add_u32 s8, s29, 0x2000
v_pk_mul_f32 v[168:169], v[168:169], v[6:7] op_sel_hi:[1,0]
v_pk_mul_f32 v[170:171], v[170:171], v[6:7] op_sel_hi:[1,0]
v_pk_mul_f32 v[172:173], v[172:173], v[6:7] op_sel_hi:[1,0]
v_pk_mul_f32 v[174:175], v[174:175], v[6:7] op_sel_hi:[1,0]
v_cvt_pk_bf16_f32 v168, v168, v169
v_cvt_pk_bf16_f32 v169, v170, v171
v_cvt_pk_bf16_f32 v170, v172, v173
v_cvt_pk_bf16_f32 v171, v174, v175
buffer_store_dwordx4 v[168:171], v3, s[88:91], s8 offen sc1
s_add_u32 s8, s29, 0x4000
v_pk_mul_f32 v[176:177], v[176:177], v[6:7] op_sel_hi:[1,0]
v_pk_mul_f32 v[178:179], v[178:179], v[6:7] op_sel_hi:[1,0]
v_pk_mul_f32 v[180:181], v[180:181], v[6:7] op_sel_hi:[1,0]
v_pk_mul_f32 v[182:183], v[182:183], v[6:7] op_sel_hi:[1,0]
v_cvt_pk_bf16_f32 v176, v176, v177
v_cvt_pk_bf16_f32 v177, v178, v179
v_cvt_pk_bf16_f32 v178, v180, v181
v_cvt_pk_bf16_f32 v179, v182, v183
buffer_store_dwordx4 v[176:179], v3, s[88:91], s8 offen sc1
s_add_u32 s8, s29, 0x6000
v_pk_mul_f32 v[184:185], v[184:185], v[6:7] op_sel_hi:[1,0]
v_pk_mul_f32 v[186:187], v[186:187], v[6:7] op_sel_hi:[1,0]
v_pk_mul_f32 v[188:189], v[188:189], v[6:7] op_sel_hi:[1,0]
v_pk_mul_f32 v[190:191], v[190:191], v[6:7] op_sel_hi:[1,0]
v_cvt_pk_bf16_f32 v184, v184, v185
v_cvt_pk_bf16_f32 v185, v186, v187
v_cvt_pk_bf16_f32 v186, v188, v189
v_cvt_pk_bf16_f32 v187, v190, v191
buffer_store_dwordx4 v[184:187], v3, s[88:91], s8 offen sc1
s_getreg_b32 s8, hwreg(HW_REG_HW_ID, 5, 1)
s_cmp_lg_u32 s8, 0
s_cbranch_scc1 L_att_sodd1
s_branch L_att_sodd0
L_att_lh0_1:
v_mfma_f32_16x16x32_bf16 v[160:163], a[32:35], v[52:55], v[160:163]
ds_read_b128 a[0:3], v1 offset:8192
v_cvt_pk_bf16_f32 v72, v24, v25
v_mfma_f32_16x16x32_bf16 v[192:195], a[32:35], v[56:59], v[192:195]
v_exp_f32 v30, v30
v_mfma_f32_16x16x32_bf16 v[224:227], a[32:35], v[60:63], v[224:227]
ds_read_b128 a[4:7], v1 offset:9216
v_cvt_pk_bf16_f32 v73, v26, v27
v_mfma_f32_16x16x32_bf16 v[228:231], a[36:39], v[60:63], v[228:231]
v_cvt_pk_bf16_f32 v76, v28, v29
v_mfma_f32_16x16x32_bf16 v[196:199], a[36:39], v[56:59], v[196:199]
buffer_load_dword v14, v15, s[84:87], 0 offen offset:192 sc1
v_mfma_f32_16x16x32_bf16 v[164:167], a[36:39], v[52:55], v[164:167]
ds_read_b128 a[8:11], v1 offset:10240
v_mfma_f32_16x16x32_bf16 v[168:171], a[40:43], v[52:55], v[168:171]
ds_read_b128 a[12:15], v1 offset:11264
v_mfma_f32_16x16x32_bf16 v[200:203], a[40:43], v[56:59], v[200:203]
v_exp_f32 v31, v31
v_mfma_f32_16x16x32_bf16 v[232:235], a[40:43], v[60:63], v[232:235]
v_exp_f32 v40, v40
v_mfma_f32_16x16x32_bf16 v[236:239], a[44:47], v[60:63], v[236:239]
ds_read_b128 a[16:19], v1 offset:12288
v_cvt_pk_bf16_f32 v77, v30, v31
v_mfma_f32_16x16x32_bf16 v[204:207], a[44:47], v[56:59], v[204:207]
s_add_u32 m0, s17, 0x10000
v_exp_f32 v41, v41
v_mfma_f32_16x16x32_bf16 v[172:175], a[44:47], v[52:55], v[172:175]
ds_read_b128 a[20:23], v1 offset:13312
v_cvt_pk_bf16_f32 v74, v40, v41
v_mfma_f32_16x16x32_bf16 v[176:179], a[48:51], v[52:55], v[176:179]
buffer_load_dwordx4 v12, s[72:75], 0 offen lds
v_mfma_f32_16x16x32_bf16 v[208:211], a[48:51], v[56:59], v[208:211]
ds_read_b128 a[24:27], v1 offset:14336
v_mfma_f32_16x16x32_bf16 v[240:243], a[48:51], v[60:63], v[240:243]
v_mfma_f32_16x16x32_bf16 v[244:247], a[52:55], v[60:63], v[244:247]
v_exp_f32 v42, v42
v_mfma_f32_16x16x32_bf16 v[212:215], a[52:55], v[56:59], v[212:215]
ds_read_b128 a[28:31], v1 offset:15360
v_mfma_f32_16x16x32_bf16 v[180:183], a[52:55], v[52:55], v[180:183]
v_exp_f32 v43, v43
v_mfma_f32_16x16x32_bf16 v[184:187], a[56:59], v[52:55], v[184:187]
ds_read_b128 a[32:35], v1 offset:0
v_cvt_pk_bf16_f32 v75, v42, v43
v_mfma_f32_16x16x32_bf16 v[216:219], a[56:59], v[56:59], v[216:219]
v_exp_f32 v44, v44
v_mfma_f32_16x16x32_bf16 v[248:251], a[56:59], v[60:63], v[248:251]
buffer_load_dwordx4 v13, s[72:75], 0 offen offset:1024 lds
v_mfma_f32_16x16x32_bf16 v[252:255], a[60:63], v[60:63], v[252:255]
ds_read_b128 a[36:39], v1 offset:1024
v_mfma_f32_16x16x32_bf16 v[220:223], a[60:63], v[56:59], v[220:223]
v_mfma_f32_16x16x32_bf16 v[188:191], a[60:63], v[52:55], v[188:191]
ds_read_b128 a[40:43], v1 offset:2048
v_mfma_f32_16x16x32_bf16 a[224:227], a[236:239], v[52:55], a[224:227]
s_waitcnt lgkmcnt(7)
v_exp_f32 v45, v45
v_smfmac_f32_16x16x64_bf16 a[228:231], a[232:235], v[56:63], v9
ds_read_b128 a[44:47], v1 offset:3072
v_cvt_pk_bf16_f32 v78, v44, v45
v_mfma_f32_16x16x32_bf16 v[24:27], a[0:3], a[192:195], v[88:91]
v_exp_f32 v46, v46
v_mfma_f32_16x16x32_bf16 v[24:27], a[4:7], a[196:199], v[24:27]
ds_read_b128 a[48:51], v1 offset:4096
v_mfma_f32_16x16x32_bf16 v[24:27], a[8:11], a[200:203], v[24:27]
buffer_load_dwordx4 v12, s[72:75], s12 offen offset:2048 lds
v_mfma_f32_16x16x32_bf16 v[24:27], a[12:15], a[204:207], v[24:27]
v_exp_f32 v47, v47
v_mfma_f32_16x16x32_bf16 v[28:31], a[0:3], a[208:211], v[92:95]
ds_read_b128 a[52:55], v1 offset:5120
v_cvt_pk_bf16_f32 v79, v46, v47
v_mfma_f32_16x16x32_bf16 v[28:31], a[4:7], a[212:215], v[28:31]
v_mfma_f32_16x16x32_bf16 v[28:31], a[8:11], a[216:219], v[28:31]
ds_read_b128 a[56:59], v1 offset:6144
v_mfma_f32_16x16x32_bf16 v[28:31], a[12:15], a[220:223], v[28:31]
s_waitcnt lgkmcnt(7)
v_exp_f32 v24, v24
v_mfma_f32_16x16x32_bf16 v[40:43], a[16:19], a[192:195], v[88:91]
ds_read_b128 a[60:63], v1 offset:7168
v_mfma_f32_16x16x32_bf16 v[40:43], a[20:23], a[196:199], v[40:43]
v_exp_f32 v25, v25
v_mfma_f32_16x16x32_bf16 v[40:43], a[24:27], a[200:203], v[40:43]
buffer_load_dwordx4 v13, s[72:75], s12 offen offset:3072 lds
v_mfma_f32_16x16x32_bf16 v[40:43], a[28:31], a[204:207], v[40:43]
v_exp_f32 v26, v26
v_mfma_f32_16x16x32_bf16 v[44:47], a[16:19], a[208:211], v[92:95]
v_exp_f32 v27, v27
v_mfma_f32_16x16x32_bf16 v[44:47], a[20:23], a[212:215], v[44:47]
v_exp_f32 v28, v28
v_mfma_f32_16x16x32_bf16 v[44:47], a[24:27], a[216:219], v[44:47]
v_exp_f32 v29, v29
v_mfma_f32_16x16x32_bf16 v[44:47], a[28:31], a[220:223], v[44:47]
s_waitcnt lgkmcnt(0)
v_mfma_f32_16x16x32_bf16 v[192:195], a[32:35], v[72:75], v[192:195]
ds_read_b128 a[0:3], v1 offset:24576
v_cvt_pk_bf16_f32 v56, v24, v25
v_mfma_f32_16x16x32_bf16 v[224:227], a[32:35], v[76:79], v[224:227]
ds_read_b128 a[4:7], v1 offset:25600
v_add_u32 v12, 0x20000, v12
v_mfma_f32_16x16x32_bf16 v[228:231], a[36:39], v[76:79], v[228:231]
s_add_u32 m0, s17, 0x14000
v_exp_f32 v30, v30
v_mfma_f32_16x16x32_bf16 v[196:199], a[36:39], v[72:75], v[196:199]
buffer_load_dwordx4 v12, s[72:75], 0 offen lds
v_mfma_f32_16x16x32_bf16 v[200:203], a[40:43], v[72:75], v[200:203]
ds_read_b128 a[8:11], v1 offset:26624
v_cvt_pk_bf16_f32 v57, v26, v27
v_mfma_f32_16x16x32_bf16 v[232:235], a[40:43], v[76:79], v[232:235]
ds_read_b128 a[12:15], v1 offset:27648
v_cvt_pk_bf16_f32 v60, v28, v29
v_mfma_f32_16x16x32_bf16 v[236:239], a[44:47], v[76:79], v[236:239]
v_exp_f32 v31, v31
v_mfma_f32_16x16x32_bf16 v[204:207], a[44:47], v[72:75], v[204:207]
ds_read_b128 a[16:19], v1 offset:28672
v_cvt_pk_bf16_f32 v61, v30, v31
v_mfma_f32_16x16x32_bf16 v[208:211], a[48:51], v[72:75], v[208:211]
v_exp_f32 v40, v40
v_mfma_f32_16x16x32_bf16 v[240:243], a[48:51], v[76:79], v[240:243]
ds_read_b128 a[20:23], v1 offset:29696
v_mfma_f32_16x16x32_bf16 v[244:247], a[52:55], v[76:79], v[244:247]
ds_read_b128 a[24:27], v1 offset:30720
v_add_u32 v13, 0x20000, v13
v_mfma_f32_16x16x32_bf16 v[212:215], a[52:55], v[72:75], v[212:215]
buffer_load_dwordx4 v13, s[72:75], 0 offen offset:1024 lds
v_mfma_f32_16x16x32_bf16 v[216:219], a[56:59], v[72:75], v[216:219]
ds_read_b128 a[28:31], v1 offset:31744
v_mfma_f32_16x16x32_bf16 v[248:251], a[56:59], v[76:79], v[248:251]
v_exp_f32 v41, v41
v_mfma_f32_16x16x32_bf16 v[252:255], a[60:63], v[76:79], v[252:255]
ds_read_b128 a[32:35], v1 offset:16384
v_cvt_pk_bf16_f32 v58, v40, v41
v_mfma_f32_16x16x32_bf16 v[220:223], a[60:63], v[72:75], v[220:223]
s_waitcnt lgkmcnt(5)
v_exp_f32 v42, v42
v_smfmac_f32_16x16x64_bf16 a[228:231], a[232:235], v[72:79], v9
ds_read_b128 a[36:39], v1 offset:17408
v_exp_f32 v43, v43
v_mfma_f32_16x16x32_bf16 v[24:27], a[0:3], a[192:195], v[112:115]
v_exp_f32 v44, v44
v_mfma_f32_16x16x32_bf16 v[24:27], a[4:7], a[196:199], v[24:27]
buffer_load_dwordx4 v12, s[72:75], s12 offen offset:2048 lds
v_mfma_f32_16x16x32_bf16 v[24:27], a[8:11], a[200:203], v[24:27]
ds_read_b128 a[40:43], v1 offset:18432
v_cvt_pk_bf16_f32 v59, v42, v43
v_mfma_f32_16x16x32_bf16 v[24:27], a[12:15], a[204:207], v[24:27]
ds_read_b128 a[44:47], v1 offset:19456
v_exp_f32 v45, v45
v_mfma_f32_16x16x32_bf16 v[28:31], a[0:3], a[208:211], v[92:95]
ds_read_b128 a[48:51], v1 offset:20480
v_exp_f32 v46, v46
v_mfma_f32_16x16x32_bf16 v[28:31], a[4:7], a[212:215], v[28:31]
v_exp_f32 v47, v47
v_mfma_f32_16x16x32_bf16 v[28:31], a[8:11], a[216:219], v[28:31]
ds_read_b128 a[52:55], v1 offset:21504
v_cvt_pk_bf16_f32 v62, v44, v45
v_mfma_f32_16x16x32_bf16 v[28:31], a[12:15], a[220:223], v[28:31]
s_waitcnt lgkmcnt(6)
v_exp_f32 v24, v24
v_mfma_f32_16x16x32_bf16 v[40:43], a[16:19], a[192:195], v[116:119]
ds_read_b128 a[56:59], v1 offset:22528
v_cvt_pk_bf16_f32 v63, v46, v47
v_mfma_f32_16x16x32_bf16 v[40:43], a[20:23], a[196:199], v[40:43]
buffer_load_dwordx4 v13, s[72:75], s12 offen offset:3072 lds
v_mfma_f32_16x16x32_bf16 v[40:43], a[24:27], a[200:203], v[40:43]
ds_read_b128 a[60:63], v1 offset:23552
v_xor_b32 v1, 0x8000, v1
v_mfma_f32_16x16x32_bf16 v[40:43], a[28:31], a[204:207], v[40:43]
v_exp_f32 v25, v25
v_mfma_f32_16x16x32_bf16 v[44:47], a[16:19], a[208:211], v[92:95]
v_exp_f32 v26, v26
v_mfma_f32_16x16x32_bf16 v[44:47], a[20:23], a[212:215], v[44:47]
v_exp_f32 v27, v27
v_mfma_f32_16x16x32_bf16 v[44:47], a[24:27], a[216:219], v[44:47]
v_exp_f32 v28, v28
v_mfma_f32_16x16x32_bf16 v[44:47], a[28:31], a[220:223], v[44:47]
v_exp_f32 v29, v29
v_accvgpr_read_b32 v6, a224
v_accvgpr_read_b32 v7, a225
v_add_f32 v6, v6, v7
v_cmp_nge_f32 vcc, 0x6f800000, v6
v_rcp_f32 v6, v6
s_or_b64 s[34:35], s[34:35], vcc
s_add_u32 s8, s28, 0x0
v_pk_mul_f32 v[128:129], v[128:129], v[6:7] op_sel_hi:[1,0]
v_pk_mul_f32 v[130:131], v[130:131], v[6:7] op_sel_hi:[1,0]
v_pk_mul_f32 v[132:133], v[132:133], v[6:7] op_sel_hi:[1,0]
v_pk_mul_f32 v[134:135], v[134:135], v[6:7] op_sel_hi:[1,0]
v_cvt_pk_bf16_f32 v128, v128, v129
v_cvt_pk_bf16_f32 v129, v130, v131
v_cvt_pk_bf16_f32 v130, v132, v133
v_cvt_pk_bf16_f32 v131, v134, v135
buffer_store_dwordx4 v[128:131], v3, s[88:91], s8 offen sc1
s_add_u32 s8, s28, 0x2000
v_pk_mul_f32 v[136:137], v[136:137], v[6:7] op_sel_hi:[1,0]
v_pk_mul_f32 v[138:139], v[138:139], v[6:7] op_sel_hi:[1,0]
v_pk_mul_f32 v[140:141], v[140:141], v[6:7] op_sel_hi:[1,0]
v_pk_mul_f32 v[142:143], v[142:143], v[6:7] op_sel_hi:[1,0]
v_cvt_pk_bf16_f32 v136, v136, v137
v_cvt_pk_bf16_f32 v137, v138, v139
v_cvt_pk_bf16_f32 v138, v140, v141
v_cvt_pk_bf16_f32 v139, v142, v143
buffer_store_dwordx4 v[136:139], v3, s[88:91], s8 offen sc1
s_add_u32 s8, s28, 0x4000
v_pk_mul_f32 v[144:145], v[144:145], v[6:7] op_sel_hi:[1,0]
v_pk_mul_f32 v[146:147], v[146:147], v[6:7] op_sel_hi:[1,0]
v_pk_mul_f32 v[148:149], v[148:149], v[6:7] op_sel_hi:[1,0]
v_pk_mul_f32 v[150:151], v[150:151], v[6:7] op_sel_hi:[1,0]
v_cvt_pk_bf16_f32 v144, v144, v145
v_cvt_pk_bf16_f32 v145, v146, v147
v_cvt_pk_bf16_f32 v146, v148, v149
v_cvt_pk_bf16_f32 v147, v150, v151
buffer_store_dwordx4 v[144:147], v3, s[88:91], s8 offen sc1
s_add_u32 s8, s28, 0x6000
v_pk_mul_f32 v[152:153], v[152:153], v[6:7] op_sel_hi:[1,0]
v_pk_mul_f32 v[154:155], v[154:155], v[6:7] op_sel_hi:[1,0]
v_pk_mul_f32 v[156:157], v[156:157], v[6:7] op_sel_hi:[1,0]
v_pk_mul_f32 v[158:159], v[158:159], v[6:7] op_sel_hi:[1,0]
v_cvt_pk_bf16_f32 v152, v152, v153
v_cvt_pk_bf16_f32 v153, v154, v155
v_cvt_pk_bf16_f32 v154, v156, v157
v_cvt_pk_bf16_f32 v155, v158, v159
buffer_store_dwordx4 v[152:155], v3, s[88:91], s8 offen sc1
v_accvgpr_read_b32 v6, a226
v_accvgpr_read_b32 v7, a227
v_add_f32 v6, v6, v7
v_cmp_nge_f32 vcc, 0x6f800000, v6
v_rcp_f32 v6, v6
s_or_b64 s[34:35], s[34:35], vcc
s_add_u32 s8, s29, 0x0
v_pk_mul_f32 v[160:161], v[160:161], v[6:7] op_sel_hi:[1,0]
v_pk_mul_f32 v[162:163], v[162:163], v[6:7] op_sel_hi:[1,0]
v_pk_mul_f32 v[164:165], v[164:165], v[6:7] op_sel_hi:[1,0]
v_pk_mul_f32 v[166:167], v[166:167], v[6:7] op_sel_hi:[1,0]
v_cvt_pk_bf16_f32 v160, v160, v161
v_cvt_pk_bf16_f32 v161, v162, v163
v_cvt_pk_bf16_f32 v162, v164, v165
v_cvt_pk_bf16_f32 v163, v166, v167
buffer_store_dwordx4 v[160:163], v3, s[88:91], s8 offen sc1
s_add_u32 s8, s29, 0x2000
v_pk_mul_f32 v[168:169], v[168:169], v[6:7] op_sel_hi:[1,0]
v_pk_mul_f32 v[170:171], v[170:171], v[6:7] op_sel_hi:[1,0]
v_pk_mul_f32 v[172:173], v[172:173], v[6:7] op_sel_hi:[1,0]
v_pk_mul_f32 v[174:175], v[174:175], v[6:7] op_sel_hi:[1,0]
v_cvt_pk_bf16_f32 v168, v168, v169
v_cvt_pk_bf16_f32 v169, v170, v171
v_cvt_pk_bf16_f32 v170, v172, v173
v_cvt_pk_bf16_f32 v171, v174, v175
buffer_store_dwordx4 v[168:171], v3, s[88:91], s8 offen sc1
s_add_u32 s8, s29, 0x4000
v_pk_mul_f32 v[176:177], v[176:177], v[6:7] op_sel_hi:[1,0]
v_pk_mul_f32 v[178:179], v[178:179], v[6:7] op_sel_hi:[1,0]
v_pk_mul_f32 v[180:181], v[180:181], v[6:7] op_sel_hi:[1,0]
v_pk_mul_f32 v[182:183], v[182:183], v[6:7] op_sel_hi:[1,0]
v_cvt_pk_bf16_f32 v176, v176, v177
v_cvt_pk_bf16_f32 v177, v178, v179
v_cvt_pk_bf16_f32 v178, v180, v181
v_cvt_pk_bf16_f32 v179, v182, v183
buffer_store_dwordx4 v[176:179], v3, s[88:91], s8 offen sc1
s_add_u32 s8, s29, 0x6000
v_pk_mul_f32 v[184:185], v[184:185], v[6:7] op_sel_hi:[1,0]
v_pk_mul_f32 v[186:187], v[186:187], v[6:7] op_sel_hi:[1,0]
v_pk_mul_f32 v[188:189], v[188:189], v[6:7] op_sel_hi:[1,0]
v_pk_mul_f32 v[190:191], v[190:191], v[6:7] op_sel_hi:[1,0]
v_cvt_pk_bf16_f32 v184, v184, v185
v_cvt_pk_bf16_f32 v185, v186, v187
v_cvt_pk_bf16_f32 v186, v188, v189
v_cvt_pk_bf16_f32 v187, v190, v191
buffer_store_dwordx4 v[184:187], v3, s[88:91], s8 offen sc1
s_branch L_att_h1_1
L_att_j0:
s_cmp_ge_u32 s4, 2
s_cbranch_scc1 L_att_nl0_1
L_att_nl0_0:
v_mfma_f32_16x16x32_bf16 v[16:19], a[0:3], a[160:163], v[96:99]
ds_read_b128 a[128:131], v1 offset:24576
v_mov_b32 v240, 0
v_mfma_f32_16x16x32_bf16 v[16:19], a[4:7], a[164:167], v[16:19]
ds_read_b128 a[132:135], v1 offset:25600
v_mov_b32 v241, 0
v_mfma_f32_16x16x32_bf16 v[16:19], a[8:11], a[168:171], v[16:19]
ds_read_b128 a[136:139], v1 offset:26624
s_add_u32 m0, s27, 0x0
v_mfma_f32_16x16x32_bf16 v[16:19], a[12:15], a[172:175], v[16:19]
buffer_load_dwordx4 v3, s[48:51], s32 offen offset:0 sc1 lds
v_mfma_f32_16x16x32_bf16 v[20:23], a[0:3], a[176:179], v[84:87]
ds_read_b128 a[140:143], v1 offset:27648
v_mov_b32 v242, 0
v_mfma_f32_16x16x32_bf16 v[20:23], a[4:7], a[180:183], v[20:23]
ds_read_b128 a[144:147], v1 offset:28672
v_mov_b32 v243, 0
v_mfma_f32_16x16x32_bf16 v[20:23], a[8:11], a[184:187], v[20:23]
ds_read_b128 a[148:151], v1 offset:29696
v_mov_b32 v244, 0
v_mfma_f32_16x16x32_bf16 v[20:23], a[12:15], a[188:191], v[20:23]
ds_read_b128 a[152:155], v1 offset:30720
v_mov_b32 v245, 0
v_mfma_f32_16x16x32_bf16 v[24:27], a[0:3], a[192:195], v[88:91]
ds_read_b128 a[156:159], v1 offset:31744
v_mov_b32 v246, 0
v_mfma_f32_16x16x32_bf16 v[24:27], a[4:7], a[196:199], v[24:27]
buffer_load_dwordx4 v3, s[48:51], s32 offen offset:1024 sc1 lds
v_mfma_f32_16x16x32_bf16 v[24:27], a[8:11], a[200:203], v[24:27]
v_exp_f32 v16, v16
v_mfma_f32_16x16x32_bf16 v[24:27], a[12:15], a[204:207], v[24:27]
v_exp_f32 v17, v17
v_mfma_f32_16x16x32_bf16 v[28:31], a[0:3], a[208:211], v[92:95]
v_exp_f32 v18, v18
v_mfma_f32_16x16x32_bf16 v[28:31], a[4:7], a[212:215], v[28:31]
v_exp_f32 v19, v19
v_mfma_f32_16x16x32_bf16 v[28:31], a[8:11], a[216:219], v[28:31]
v_exp_f32 v20, v20
v_mfma_f32_16x16x32_bf16 v[28:31], a[12:15], a[220:223], v[28:31]
buffer_load_dwordx4 v3, s[48:51], s32 offen offset:2048 sc1 lds
v_mfma_f32_16x16x32_bf16 v[32:35], a[16:19], a[160:163], v[100:103]
v_exp_f32 v21, v21
v_mfma_f32_16x16x32_bf16 v[32:35], a[20:23], a[164:167], v[32:35]
v_exp_f32 v22, v22
v_mfma_f32_16x16x32_bf16 v[32:35], a[24:27], a[168:171], v[32:35]
v_exp_f32 v23, v23
v_mfma_f32_16x16x32_bf16 v[32:35], a[28:31], a[172:175], v[32:35]
v_exp_f32 v24, v24
v_mfma_f32_16x16x32_bf16 v[36:39], a[16:19], a[176:179], v[84:87]
v_exp_f32 v25, v25
v_mfma_f32_16x16x32_bf16 v[36:39], a[20:23], a[180:183], v[36:39]
buffer_load_dwordx4 v3, s[48:51], s32 offen offset:3072 sc1 lds
v_mfma_f32_16x16x32_bf16 v[36:39], a[24:27], a[184:187], v[36:39]
v_exp_f32 v26, v26
v_mfma_f32_16x16x32_bf16 v[36:39], a[28:31], a[188:191], v[36:39]
v_exp_f32 v27, v27
v_mfma_f32_16x16x32_bf16 v[40:43], a[16:19], a[192:195], v[88:91]
v_exp_f32 v28, v28
v_mfma_f32_16x16x32_bf16 v[40:43], a[20:23], a[196:199], v[40:43]
v_exp_f32 v29, v29
v_mfma_f32_16x16x32_bf16 v[40:43], a[24:27], a[200:203], v[40:43]
s_add_u32 m0, s27, 0x1000
v_exp_f32 v30, v30
v_mfma_f32_16x16x32_bf16 v[40:43], a[28:31], a[204:207], v[40:43]
buffer_load_dwordx4 v3, s[48:51], s7 offen offset:0 sc1 lds
v_mfma_f32_16x16x32_bf16 v[44:47], a[16:19], a[208:211], v[92:95]
v_exp_f32 v31, v31
v_mfma_f32_16x16x32_bf16 v[44:47], a[20:23], a[212:215], v[44:47]
v_exp_f32 v32, v32
v_mfma_f32_16x16x32_bf16 v[44:47], a[24:27], a[216:219], v[44:47]
v_exp_f32 v33, v33
v_mfma_f32_16x16x32_bf16 v[44:47], a[28:31], a[220:223], v[44:47]
s_waitcnt lgkmcnt(0)
v_cvt_pk_bf16_f32 v48, v16, v17
v_cvt_pk_bf16_f32 v49, v18, v19
v_cvt_pk_bf16_f32 v52, v20, v21
v_cvt_pk_bf16_f32 v53, v22, v23
v_cvt_pk_bf16_f32 v56, v24, v25
v_cvt_pk_bf16_f32 v57, v26, v27
v_mov_b32 v247, 0
v_mfma_f32_16x16x32_bf16 v[20:23], a[128:131], a[176:179], v[84:87]
ds_read_b128 a[32:35], v1 offset:16384
v_cvt_pk_bf16_f32 v60, v28, v29
v_mfma_f32_16x16x32_bf16 v[20:23], a[132:135], a[180:183], v[20:23]
v_exp_f32 v34, v34
v_mfma_f32_16x16x32_bf16 v[20:23], a[136:139], a[184:187], v[20:23]
buffer_load_dwordx4 v3, s[48:51], s7 offen offset:1024 sc1 lds
v_mfma_f32_16x16x32_bf16 v[20:23], a[140:143], a[188:191], v[20:23]
ds_read_b128 a[36:39], v1 offset:17408
v_cvt_pk_bf16_f32 v61, v30, v31
v_mfma_f32_16x16x32_bf16 v[24:27], a[128:131], a[192:195], v[88:91]
ds_read_b128 a[40:43], v1 offset:18432
v_cvt_pk_bf16_f32 v50, v32, v33
v_mfma_f32_16x16x32_bf16 v[24:27], a[132:135], a[196:199], v[24:27]
v_exp_f32 v35, v35
v_mfma_f32_16x16x32_bf16 v[24:27], a[136:139], a[200:203], v[24:27]
buffer_load_dwordx4 v3, s[48:51], s7 offen offset:2048 sc1 lds
v_mfma_f32_16x16x32_bf16 v[24:27], a[140:143], a[204:207], v[24:27]
ds_read_b128 a[44:47], v1 offset:19456
v_cvt_pk_bf16_f32 v51, v34, v35
v_mfma_f32_16x16x32_bf16 v[28:31], a[128:131], a[208:211], v[92:95]
v_exp_f32 v36, v36
v_mfma_f32_16x16x32_bf16 v[28:31], a[132:135], a[212:215], v[28:31]
ds_read_b128 a[48:51], v1 offset:20480
v_exp_f32 v37, v37
v_mfma_f32_16x16x32_bf16 v[28:31], a[136:139], a[216:219], v[28:31]
v_exp_f32 v38, v38
v_mfma_f32_16x16x32_bf16 v[28:31], a[140:143], a[220:223], v[28:31]
buffer_load_dwordx4 v3, s[48:51], s7 offen offset:3072 sc1 lds
v_exp_f32 v39, v39
v_cvt_pk_bf16_f32 v54, v36, v37
v_cvt_pk_bf16_f32 v55, v38, v39
v_mfma_f32_16x16x32_bf16 v[36:39], a[144:147], a[176:179], v[84:87]
ds_read_b128 a[52:55], v1 offset:21504
v_exp_f32 v40, v40
v_mfma_f32_16x16x32_bf16 v[36:39], a[148:151], a[180:183], v[36:39]
ds_read_b128 a[56:59], v1 offset:22528
v_exp_f32 v41, v41
v_mfma_f32_16x16x32_bf16 v[36:39], a[152:155], a[184:187], v[36:39]
s_mov_b32 s9, 0x0
v_exp_f32 v42, v42
v_mfma_f32_16x16x32_bf16 v[36:39], a[156:159], a[188:191], v[36:39]
buffer_load_dword a244, v8, s[72:75], s9 offen
v_exp_f32 v43, v43
v_cvt_pk_bf16_f32 v58, v40, v41
v_cvt_pk_bf16_f32 v59, v42, v43
v_mfma_f32_16x16x32_bf16 v[40:43], a[144:147], a[192:195], v[88:91]
ds_read_b128 a[60:63], v1 offset:23552
v_xor_b32 v1, 0x8000, v1
v_mfma_f32_16x16x32_bf16 v[40:43], a[148:151], a[196:199], v[40:43]
s_add_u32 s32, s32, 0x8000
v_exp_f32 v44, v44
v_mfma_f32_16x16x32_bf16 v[40:43], a[152:155], a[200:203], v[40:43]
s_add_u32 s7, s7, 0x8000
v_exp_f32 v45, v45
v_mfma_f32_16x16x32_bf16 v[40:43], a[156:159], a[204:207], v[40:43]
s_xor_b32 s27, s27, 0x38000
v_exp_f32 v46, v46
v_exp_f32 v47, v47
v_cvt_pk_bf16_f32 v62, v44, v45
v_cvt_pk_bf16_f32 v63, v46, v47
v_mfma_f32_16x16x32_bf16 v[44:47], a[144:147], a[208:211], v[92:95]
v_exp_f32 v20, v20
v_mfma_f32_16x16x32_bf16 v[44:47], a[148:151], a[212:215], v[44:47]
v_exp_f32 v21, v21
v_mfma_f32_16x16x32_bf16 v[44:47], a[152:155], a[216:219], v[44:47]
s_waitcnt vmcnt(9) lgkmcnt(0)
v_exp_f32 v22, v22
v_mfma_f32_16x16x32_bf16 v[44:47], a[156:159], a[220:223], v[44:47]
s_barrier
v_cvt_pk_bf16_f32 v68, v20, v21
v_exp_f32 v23, v23
v_exp_f32 v24, v24
v_exp_f32 v25, v25
v_exp_f32 v26, v26
v_exp_f32 v27, v27
v_cvt_pk_bf16_f32 v69, v22, v23
s_cmp_lg_u32 s33, 0
s_cbranch_scc1 L_sig_bn0
s_lshl_b32 s8, s6, 2
s_add_u32 s8, s8, 192
s_cmp_lg_u32 s4, 0
s_cbranch_scc1 L_sig_bn0
v_mov_b32 v4, 1
s_mov_b64 exec, 1
buffer_atomic_add v4, off, s[84:87], s8 sc1
s_mov_b64 exec, -1
L_sig_bn0:
s_branch L_att_l1_0
L_att_nl0_1:
v_mfma_f32_16x16x32_bf16 v[16:19], a[0:3], a[160:163], v[80:83]
ds_read_b128 a[128:131], v1 offset:24576
v_mov_b32 v240, 0
v_mfma_f32_16x16x32_bf16 v[16:19], a[4:7], a[164:167], v[16:19]
ds_read_b128 a[132:135], v1 offset:25600
v_mov_b32 v241, 0
v_mfma_f32_16x16x32_bf16 v[16:19], a[8:11], a[168:171], v[16:19]
ds_read_b128 a[136:139], v1 offset:26624
s_add_u32 m0, s27, 0x0
v_mfma_f32_16x16x32_bf16 v[16:19], a[12:15], a[172:175], v[16:19]
buffer_load_dwordx4 v3, s[48:51], s32 offen offset:0 sc1 lds
v_mfma_f32_16x16x32_bf16 v[20:23], a[0:3], a[176:179], v[84:87]
ds_read_b128 a[140:143], v1 offset:27648
v_mov_b32 v242, 0
v_mfma_f32_16x16x32_bf16 v[20:23], a[4:7], a[180:183], v[20:23]
ds_read_b128 a[144:147], v1 offset:28672
v_mov_b32 v243, 0
v_mfma_f32_16x16x32_bf16 v[20:23], a[8:11], a[184:187], v[20:23]
ds_read_b128 a[148:151], v1 offset:29696
v_mov_b32 v244, 0
v_mfma_f32_16x16x32_bf16 v[20:23], a[12:15], a[188:191], v[20:23]
ds_read_b128 a[152:155], v1 offset:30720
v_mov_b32 v245, 0
v_mfma_f32_16x16x32_bf16 v[24:27], a[0:3], a[192:195], v[88:91]
ds_read_b128 a[156:159], v1 offset:31744
v_mov_b32 v246, 0
v_mfma_f32_16x16x32_bf16 v[24:27], a[4:7], a[196:199], v[24:27]
buffer_load_dwordx4 v3, s[48:51], s32 offen offset:1024 sc1 lds
v_mfma_f32_16x16x32_bf16 v[24:27], a[8:11], a[200:203], v[24:27]
v_exp_f32 v16, v16
v_mfma_f32_16x16x32_bf16 v[24:27], a[12:15], a[204:207], v[24:27]
v_exp_f32 v17, v17
v_mfma_f32_16x16x32_bf16 v[28:31], a[0:3], a[208:211], v[92:95]
v_exp_f32 v18, v18
v_mfma_f32_16x16x32_bf16 v[28:31], a[4:7], a[212:215], v[28:31]
v_exp_f32 v19, v19
v_mfma_f32_16x16x32_bf16 v[28:31], a[8:11], a[216:219], v[28:31]
v_exp_f32 v20, v20
v_mfma_f32_16x16x32_bf16 v[28:31], a[12:15], a[220:223], v[28:31]
buffer_load_dwordx4 v3, s[48:51], s32 offen offset:2048 sc1 lds
v_mfma_f32_16x16x32_bf16 v[32:35], a[16:19], a[160:163], v[80:83]
v_exp_f32 v21, v21
v_mfma_f32_16x16x32_bf16 v[32:35], a[20:23], a[164:167], v[32:35]
v_exp_f32 v22, v22
v_mfma_f32_16x16x32_bf16 v[32:35], a[24:27], a[168:171], v[32:35]
v_exp_f32 v23, v23
v_mfma_f32_16x16x32_bf16 v[32:35], a[28:31], a[172:175], v[32:35]
v_exp_f32 v24, v24
v_mfma_f32_16x16x32_bf16 v[36:39], a[16:19], a[176:179], v[84:87]
v_exp_f32 v25, v25
v_mfma_f32_16x16x32_bf16 v[36:39], a[20:23], a[180:183], v[36:39]
buffer_load_dwordx4 v3, s[48:51], s32 offen offset:3072 sc1 lds
v_mfma_f32_16x16x32_bf16 v[36:39], a[24:27], a[184:187], v[36:39]
v_exp_f32 v26, v26
v_mfma_f32_16x16x32_bf16 v[36:39], a[28:31], a[188:191], v[36:39]
v_exp_f32 v27, v27
v_mfma_f32_16x16x32_bf16 v[40:43], a[16:19], a[192:195], v[88:91]
v_exp_f32 v28, v28
v_mfma_f32_16x16x32_bf16 v[40:43], a[20:23], a[196:199], v[40:43]
v_exp_f32 v29, v29
v_mfma_f32_16x16x32_bf16 v[40:43], a[24:27], a[200:203], v[40:43]
s_add_u32 m0, s27, 0x1000
v_exp_f32 v30, v30
v_mfma_f32_16x16x32_bf16 v[40:43], a[28:31], a[204:207], v[40:43]
buffer_load_dwordx4 v3, s[48:51], s7 offen offset:0 sc1 lds
v_mfma_f32_16x16x32_bf16 v[44:47], a[16:19], a[208:211], v[92:95]
v_exp_f32 v31, v31
v_mfma_f32_16x16x32_bf16 v[44:47], a[20:23], a[212:215], v[44:47]
v_exp_f32 v32, v32
v_mfma_f32_16x16x32_bf16 v[44:47], a[24:27], a[216:219], v[44:47]
v_exp_f32 v33, v33
v_mfma_f32_16x16x32_bf16 v[44:47], a[28:31], a[220:223], v[44:47]
s_waitcnt lgkmcnt(0)
v_cvt_pk_bf16_f32 v48, v16, v17
v_cvt_pk_bf16_f32 v49, v18, v19
v_cvt_pk_bf16_f32 v52, v20, v21
v_cvt_pk_bf16_f32 v53, v22, v23
v_cvt_pk_bf16_f32 v56, v24, v25
v_cvt_pk_bf16_f32 v57, v26, v27
v_mov_b32 v247, 0
v_mfma_f32_16x16x32_bf16 v[16:19], a[128:131], a[160:163], v[96:99]
ds_read_b128 a[32:35], v1 offset:16384
v_cvt_pk_bf16_f32 v60, v28, v29
v_mfma_f32_16x16x32_bf16 v[16:19], a[132:135], a[164:167], v[16:19]
v_exp_f32 v34, v34
v_mfma_f32_16x16x32_bf16 v[16:19], a[136:139], a[168:171], v[16:19]
v_exp_f32 v35, v35
v_mfma_f32_16x16x32_bf16 v[16:19], a[140:143], a[172:175], v[16:19]
buffer_load_dwordx4 v3, s[48:51], s7 offen offset:1024 sc1 lds
v_mfma_f32_16x16x32_bf16 v[20:23], a[128:131], a[176:179], v[84:87]
ds_read_b128 a[36:39], v1 offset:17408
v_cvt_pk_bf16_f32 v61, v30, v31
v_mfma_f32_16x16x32_bf16 v[20:23], a[132:135], a[180:183], v[20:23]
v_exp_f32 v36, v36
v_mfma_f32_16x16x32_bf16 v[20:23], a[136:139], a[184:187], v[20:23]
ds_read_b128 a[40:43], v1 offset:18432
v_cvt_pk_bf16_f32 v50, v32, v33
v_mfma_f32_16x16x32_bf16 v[20:23], a[140:143], a[188:191], v[20:23]
v_exp_f32 v37, v37
v_mfma_f32_16x16x32_bf16 v[24:27], a[128:131], a[192:195], v[88:91]
v_exp_f32 v38, v38
v_mfma_f32_16x16x32_bf16 v[24:27], a[132:135], a[196:199], v[24:27]
buffer_load_dwordx4 v3, s[48:51], s7 offen offset:2048 sc1 lds
v_mfma_f32_16x16x32_bf16 v[24:27], a[136:139], a[200:203], v[24:27]
ds_read_b128 a[44:47], v1 offset:19456
v_cvt_pk_bf16_f32 v51, v34, v35
v_mfma_f32_16x16x32_bf16 v[24:27], a[140:143], a[204:207], v[24:27]
v_exp_f32 v39, v39
v_mfma_f32_16x16x32_bf16 v[28:31], a[128:131], a[208:211], v[92:95]
v_exp_f32 v40, v40
v_mfma_f32_16x16x32_bf16 v[28:31], a[132:135], a[212:215], v[28:31]
ds_read_b128 a[48:51], v1 offset:20480
v_cvt_pk_bf16_f32 v54, v36, v37
v_mfma_f32_16x16x32_bf16 v[28:31], a[136:139], a[216:219], v[28:31]
v_exp_f32 v41, v41
v_mfma_f32_16x16x32_bf16 v[28:31], a[140:143], a[220:223], v[28:31]
v_exp_f32 v42, v42
v_mfma_f32_16x16x32_bf16 v[32:35], a[144:147], a[160:163], v[100:103]
buffer_load_dwordx4 v3, s[48:51], s7 offen offset:3072 sc1 lds
v_mfma_f32_16x16x32_bf16 v[32:35], a[148:151], a[164:167], v[32:35]
ds_read_b128 a[52:55], v1 offset:21504
v_cvt_pk_bf16_f32 v55, v38, v39
v_mfma_f32_16x16x32_bf16 v[32:35], a[152:155], a[168:171], v[32:35]
v_exp_f32 v43, v43
v_mfma_f32_16x16x32_bf16 v[32:35], a[156:159], a[172:175], v[32:35]
ds_read_b128 a[56:59], v1 offset:22528
v_cvt_pk_bf16_f32 v58, v40, v41
v_mfma_f32_16x16x32_bf16 v[36:39], a[144:147], a[176:179], v[84:87]
v_exp_f32 v44, v44
v_mfma_f32_16x16x32_bf16 v[36:39], a[148:151], a[180:183], v[36:39]
s_mov_b32 s9, 0x0
v_exp_f32 v45, v45
v_mfma_f32_16x16x32_bf16 v[36:39], a[152:155], a[184:187], v[36:39]
buffer_load_dword a244, v8, s[72:75], s9 offen
v_mfma_f32_16x16x32_bf16 v[36:39], a[156:159], a[188:191], v[36:39]
ds_read_b128 a[60:63], v1 offset:23552
v_xor_b32 v1, 0x8000, v1
v_cvt_pk_bf16_f32 v59, v42, v43
v_mfma_f32_16x16x32_bf16 v[40:43], a[144:147], a[192:195], v[88:91]
s_add_u32 s32, s32, 0x8000
v_exp_f32 v46, v46
v_mfma_f32_16x16x32_bf16 v[40:43], a[148:151], a[196:199], v[40:43]
s_add_u32 s7, s7, 0x8000
v_exp_f32 v47, v47
v_mfma_f32_16x16x32_bf16 v[40:43], a[152:155], a[200:203], v[40:43]
s_xor_b32 s27, s27, 0x38000
v_exp_f32 v16, v16
v_mfma_f32_16x16x32_bf16 v[40:43], a[156:159], a[204:207], v[40:43]
v_exp_f32 v17, v17
v_cvt_pk_bf16_f32 v62, v44, v45
v_cvt_pk_bf16_f32 v63, v46, v47
v_mfma_f32_16x16x32_bf16 v[44:47], a[144:147], a[208:211], v[92:95]
v_exp_f32 v18, v18
v_mfma_f32_16x16x32_bf16 v[44:47], a[148:151], a[212:215], v[44:47]
v_exp_f32 v19, v19
v_mfma_f32_16x16x32_bf16 v[44:47], a[152:155], a[216:219], v[44:47]
s_waitcnt vmcnt(9) lgkmcnt(0)
v_exp_f32 v20, v20
v_mfma_f32_16x16x32_bf16 v[44:47], a[156:159], a[220:223], v[44:47]
s_barrier
v_cvt_pk_bf16_f32 v64, v16, v17
v_exp_f32 v21, v21
v_exp_f32 v22, v22
v_exp_f32 v23, v23
v_exp_f32 v24, v24
v_exp_f32 v25, v25
v_exp_f32 v26, v26
v_exp_f32 v27, v27
v_cvt_pk_bf16_f32 v65, v18, v19
v_cvt_pk_bf16_f32 v68, v20, v21
v_cvt_pk_bf16_f32 v69, v22, v23
s_cmp_lg_u32 s33, 0
s_cbranch_scc1 L_sig_bn1
s_lshl_b32 s8, s6, 2
s_add_u32 s8, s8, 192
s_cmp_lg_u32 s4, 0
s_cbranch_scc1 L_sig_bn1
v_mov_b32 v4, 1
s_mov_b64 exec, 1
buffer_atomic_add v4, off, s[84:87], s8 sc1
s_mov_b64 exec, -1
L_sig_bn1:
s_branch L_att_l1_1
L_att_seven0:
v_mfma_f32_16x16x32_bf16 v[192:195], a[32:35], v[56:59], v[192:195]
v_exp_f32 v30, v30
v_mfma_f32_16x16x32_bf16 v[224:227], a[32:35], v[60:63], v[224:227]
ds_read_b128 a[0:3], v1 offset:8192
v_cvt_pk_bf16_f32 v72, v24, v25
v_mfma_f32_16x16x32_bf16 v[228:231], a[36:39], v[60:63], v[228:231]
ds_read_b128 a[4:7], v1 offset:9216
v_cvt_pk_bf16_f32 v73, v26, v27
v_mfma_f32_16x16x32_bf16 v[196:199], a[36:39], v[56:59], v[196:199]
s_add_u32 m0, s27, 0x0
v_exp_f32 v31, v31
v_mfma_f32_16x16x32_bf16 v[200:203], a[40:43], v[56:59], v[200:203]
ds_read_b128 a[8:11], v1 offset:10240
v_cvt_pk_bf16_f32 v76, v28, v29
v_mfma_f32_16x16x32_bf16 v[232:235], a[40:43], v[60:63], v[232:235]
buffer_load_dwordx4 v3, s[48:51], s32 offen offset:0 sc1 lds
v_mfma_f32_16x16x32_bf16 v[236:239], a[44:47], v[60:63], v[236:239]
v_exp_f32 v40, v40
v_mfma_f32_16x16x32_bf16 v[204:207], a[44:47], v[56:59], v[204:207]
ds_read_b128 a[12:15], v1 offset:11264
v_cvt_pk_bf16_f32 v77, v30, v31
v_mfma_f32_16x16x32_bf16 v[208:211], a[48:51], v[56:59], v[208:211]
ds_read_b128 a[16:19], v1 offset:12288
v_mfma_f32_16x16x32_bf16 v[240:243], a[48:51], v[60:63], v[240:243]
buffer_load_dwordx4 v3, s[48:51], s32 offen offset:1024 sc1 lds
v_mfma_f32_16x16x32_bf16 v[244:247], a[52:55], v[60:63], v[244:247]
ds_read_b128 a[20:23], v1 offset:13312
v_mfma_f32_16x16x32_bf16 v[212:215], a[52:55], v[56:59], v[212:215]
ds_read_b128 a[24:27], v1 offset:14336
v_mfma_f32_16x16x32_bf16 v[216:219], a[56:59], v[56:59], v[216:219]
ds_read_b128 a[28:31], v1 offset:15360
v_mfma_f32_16x16x32_bf16 v[248:251], a[56:59], v[60:63], v[248:251]
ds_read_b128 a[32:35], v1 offset:0
v_exp_f32 v41, v41
v_mfma_f32_16x16x32_bf16 v[252:255], a[60:63], v[60:63], v[252:255]
v_exp_f32 v42, v42
v_mfma_f32_16x16x32_bf16 v[220:223], a[60:63], v[56:59], v[220:223]
s_waitcnt lgkmcnt(5)
v_exp_f32 v43, v43
v_smfmac_f32_16x16x64_bf16 a[228:231], a[232:235], v[56:63], v9
ds_read_b128 a[36:39], v1 offset:1024
v_cvt_pk_bf16_f32 v74, v40, v41
v_mfma_f32_16x16x32_bf16 v[24:27], a[0:3], a[192:195], v[88:91]
ds_read_b128 a[40:43], v1 offset:2048
v_exp_f32 v44, v44
v_mfma_f32_16x16x32_bf16 v[24:27], a[4:7], a[196:199], v[24:27]
buffer_load_dwordx4 v3, s[48:51], s32 offen offset:2048 sc1 lds
v_mfma_f32_16x16x32_bf16 v[24:27], a[8:11], a[200:203], v[24:27]
v_exp_f32 v45, v45
v_mfma_f32_16x16x32_bf16 v[24:27], a[12:15], a[204:207], v[24:27]
ds_read_b128 a[44:47], v1 offset:3072
v_cvt_pk_bf16_f32 v75, v42, v43
v_mfma_f32_16x16x32_bf16 v[28:31], a[0:3], a[208:211], v[92:95]
ds_read_b128 a[48:51], v1 offset:4096
v_exp_f32 v46, v46
v_mfma_f32_16x16x32_bf16 v[28:31], a[4:7], a[212:215], v[28:31]
s_waitcnt lgkmcnt(5)
v_exp_f32 v47, v47
v_mfma_f32_16x16x32_bf16 v[28:31], a[8:11], a[216:219], v[28:31]
ds_read_b128 a[52:55], v1 offset:5120
v_cvt_pk_bf16_f32 v78, v44, v45
v_mfma_f32_16x16x32_bf16 v[28:31], a[12:15], a[220:223], v[28:31]
buffer_load_dwordx4 v3, s[48:51], s32 offen offset:3072 sc1 lds
v_mfma_f32_16x16x32_bf16 v[40:43], a[16:19], a[192:195], v[88:91]
ds_read_b128 a[56:59], v1 offset:6144
s_add_u32 s32, s32, 0x8000
v_mfma_f32_16x16x32_bf16 v[40:43], a[20:23], a[196:199], v[40:43]
ds_read_b128 a[60:63], v1 offset:7168
v_cvt_pk_bf16_f32 v79, v46, v47
v_mfma_f32_16x16x32_bf16 v[40:43], a[24:27], a[200:203], v[40:43]
v_exp_f32 v24, v24
v_mfma_f32_16x16x32_bf16 v[40:43], a[28:31], a[204:207], v[40:43]
v_exp_f32 v25, v25
v_mfma_f32_16x16x32_bf16 v[44:47], a[16:19], a[208:211], v[92:95]
v_exp_f32 v26, v26
v_mfma_f32_16x16x32_bf16 v[44:47], a[20:23], a[212:215], v[44:47]
v_exp_f32 v27, v27
v_mfma_f32_16x16x32_bf16 v[44:47], a[24:27], a[216:219], v[44:47]
v_exp_f32 v28, v28
v_mfma_f32_16x16x32_bf16 v[44:47], a[28:31], a[220:223], v[44:47]
s_waitcnt lgkmcnt(0)
v_exp_f32 v29, v29
v_mfma_f32_16x16x32_bf16 v[192:195], a[32:35], v[72:75], v[192:195]
s_add_u32 m0, s27, 0x1000
v_exp_f32 v30, v30
v_mfma_f32_16x16x32_bf16 v[224:227], a[32:35], v[76:79], v[224:227]
buffer_load_dwordx4 v3, s[48:51], s7 offen offset:0 sc1 lds
v_mfma_f32_16x16x32_bf16 v[228:231], a[36:39], v[76:79], v[228:231]
v_exp_f32 v31, v31
v_mfma_f32_16x16x32_bf16 v[196:199], a[36:39], v[72:75], v[196:199]
ds_read_b128 a[0:3], v1 offset:24576
v_cvt_pk_bf16_f32 v56, v24, v25
v_mfma_f32_16x16x32_bf16 v[200:203], a[40:43], v[72:75], v[200:203]
ds_read_b128 a[4:7], v1 offset:25600
v_cvt_pk_bf16_f32 v57, v26, v27
v_mfma_f32_16x16x32_bf16 v[232:235], a[40:43], v[76:79], v[232:235]
v_exp_f32 v40, v40
v_mfma_f32_16x16x32_bf16 v[236:239], a[44:47], v[76:79], v[236:239]
ds_read_b128 a[8:11], v1 offset:26624
v_cvt_pk_bf16_f32 v60, v28, v29
v_mfma_f32_16x16x32_bf16 v[204:207], a[44:47], v[72:75], v[204:207]
v_exp_f32 v41, v41
v_mfma_f32_16x16x32_bf16 v[208:211], a[48:51], v[72:75], v[208:211]
ds_read_b128 a[12:15], v1 offset:27648
v_cvt_pk_bf16_f32 v61, v30, v31
v_mfma_f32_16x16x32_bf16 v[240:243], a[48:51], v[76:79], v[240:243]
ds_read_b128 a[16:19], v1 offset:28672
v_cvt_pk_bf16_f32 v58, v40, v41
v_mfma_f32_16x16x32_bf16 v[244:247], a[52:55], v[76:79], v[244:247]
v_exp_f32 v42, v42
v_mfma_f32_16x16x32_bf16 v[212:215], a[52:55], v[72:75], v[212:215]
buffer_load_dwordx4 v3, s[48:51], s7 offen offset:1024 sc1 lds
v_mfma_f32_16x16x32_bf16 v[216:219], a[56:59], v[72:75], v[216:219]
ds_read_b128 a[20:23], v1 offset:29696
v_mfma_f32_16x16x32_bf16 v[248:251], a[56:59], v[76:79], v[248:251]
ds_read_b128 a[24:27], v1 offset:30720
v_mfma_f32_16x16x32_bf16 v[252:255], a[60:63], v[76:79], v[252:255]
ds_read_b128 a[28:31], v1 offset:31744
v_mfma_f32_16x16x32_bf16 v[220:223], a[60:63], v[72:75], v[220:223]
s_waitcnt lgkmcnt(4)
v_exp_f32 v43, v43
v_smfmac_f32_16x16x64_bf16 a[228:231], a[232:235], v[72:79], v9
ds_read_b128 a[32:35], v1 offset:16384
v_cvt_pk_bf16_f32 v59, v42, v43
v_mfma_f32_16x16x32_bf16 v[24:27], a[0:3], a[192:195], v[88:91]
ds_read_b128 a[36:39], v1 offset:17408
v_mfma_f32_16x16x32_bf16 v[24:27], a[4:7], a[196:199], v[24:27]
buffer_load_dwordx4 v3, s[48:51], s7 offen offset:2048 sc1 lds
v_mfma_f32_16x16x32_bf16 v[24:27], a[8:11], a[200:203], v[24:27]
ds_read_b128 a[40:43], v1 offset:18432
v_exp_f32 v44, v44
v_mfma_f32_16x16x32_bf16 v[24:27], a[12:15], a[204:207], v[24:27]
ds_read_b128 a[44:47], v1 offset:19456
v_exp_f32 v45, v45
v_mfma_f32_16x16x32_bf16 v[28:31], a[0:3], a[208:211], v[92:95]
ds_read_b128 a[48:51], v1 offset:20480
v_exp_f32 v46, v46
v_mfma_f32_16x16x32_bf16 v[28:31], a[4:7], a[212:215], v[28:31]
s_waitcnt lgkmcnt(5)
v_exp_f32 v47, v47
v_mfma_f32_16x16x32_bf16 v[28:31], a[8:11], a[216:219], v[28:31]
ds_read_b128 a[52:55], v1 offset:21504
v_cvt_pk_bf16_f32 v62, v44, v45
v_mfma_f32_16x16x32_bf16 v[28:31], a[12:15], a[220:223], v[28:31]
ds_read_b128 a[56:59], v1 offset:22528
v_cvt_pk_bf16_f32 v63, v46, v47
v_mfma_f32_16x16x32_bf16 v[40:43], a[16:19], a[192:195], v[88:91]
ds_read_b128 a[60:63], v1 offset:23552
v_xor_b32 v1, 0x8000, v1
v_mfma_f32_16x16x32_bf16 v[40:43], a[20:23], a[196:199], v[40:43]
buffer_load_dwordx4 v3, s[48:51], s7 offen offset:3072 sc1 lds
v_mfma_f32_16x16x32_bf16 v[40:43], a[24:27], a[200:203], v[40:43]
s_add_u32 s7, s7, 0x8000
v_exp_f32 v24, v24
v_mfma_f32_16x16x32_bf16 v[40:43], a[28:31], a[204:207], v[40:43]
s_xor_b32 s27, s27, 0x38000
v_exp_f32 v25, v25
v_mfma_f32_16x16x32_bf16 v[44:47], a[16:19], a[208:211], v[92:95]
v_exp_f32 v26, v26
v_mfma_f32_16x16x32_bf16 v[44:47], a[20:23], a[212:215], v[44:47]
v_exp_f32 v27, v27
v_mfma_f32_16x16x32_bf16 v[44:47], a[24:27], a[216:219], v[44:47]
s_waitcnt vmcnt(16) lgkmcnt(0)
v_exp_f32 v28, v28
v_mfma_f32_16x16x32_bf16 v[44:47], a[28:31], a[220:223], v[44:47]
s_barrier
v_exp_f32 v29, v29
L_att_sodd0:
v_mfma_f32_16x16x32_bf16 v[192:195], a[32:35], v[56:59], v[192:195]
v_exp_f32 v30, v30
v_mfma_f32_16x16x32_bf16 v[224:227], a[32:35], v[60:63], v[224:227]
ds_read_b128 a[0:3], v2 offset:8192
v_cvt_pk_bf16_f32 v72, v24, v25
v_mfma_f32_16x16x32_bf16 v[228:231], a[36:39], v[60:63], v[228:231]
ds_read_b128 a[4:7], v2 offset:9216
v_cvt_pk_bf16_f32 v73, v26, v27
v_mfma_f32_16x16x32_bf16 v[196:199], a[36:39], v[56:59], v[196:199]
s_add_u32 m0, s19, 0x0
v_exp_f32 v31, v31
v_mfma_f32_16x16x32_bf16 v[200:203], a[40:43], v[56:59], v[200:203]
ds_read_b128 a[8:11], v2 offset:10240
v_cvt_pk_bf16_f32 v76, v28, v29
v_mfma_f32_16x16x32_bf16 v[232:235], a[40:43], v[60:63], v[232:235]
buffer_load_dwordx4 v3, s[48:51], s32 offen offset:0 sc1 lds
v_mfma_f32_16x16x32_bf16 v[236:239], a[44:47], v[60:63], v[236:239]
v_exp_f32 v40, v40
v_mfma_f32_16x16x32_bf16 v[204:207], a[44:47], v[56:59], v[204:207]
ds_read_b128 a[12:15], v2 offset:11264
v_cvt_pk_bf16_f32 v77, v30, v31
v_mfma_f32_16x16x32_bf16 v[208:211], a[48:51], v[56:59], v[208:211]
ds_read_b128 a[16:19], v2 offset:12288
v_mfma_f32_16x16x32_bf16 v[240:243], a[48:51], v[60:63], v[240:243]
buffer_load_dwordx4 v3, s[48:51], s32 offen offset:1024 sc1 lds
v_mfma_f32_16x16x32_bf16 v[244:247], a[52:55], v[60:63], v[244:247]
ds_read_b128 a[20:23], v2 offset:13312
v_mfma_f32_16x16x32_bf16 v[212:215], a[52:55], v[56:59], v[212:215]
ds_read_b128 a[24:27], v2 offset:14336
v_mfma_f32_16x16x32_bf16 v[216:219], a[56:59], v[56:59], v[216:219]
ds_read_b128 a[28:31], v2 offset:15360
v_mfma_f32_16x16x32_bf16 v[248:251], a[56:59], v[60:63], v[248:251]
ds_read_b128 a[32:35], v2 offset:0
v_exp_f32 v41, v41
v_mfma_f32_16x16x32_bf16 v[252:255], a[60:63], v[60:63], v[252:255]
v_exp_f32 v42, v42
v_mfma_f32_16x16x32_bf16 v[220:223], a[60:63], v[56:59], v[220:223]
s_waitcnt lgkmcnt(5)
v_exp_f32 v43, v43
v_smfmac_f32_16x16x64_bf16 a[228:231], a[232:235], v[56:63], v9
ds_read_b128 a[36:39], v2 offset:1024
v_cvt_pk_bf16_f32 v74, v40, v41
v_mfma_f32_16x16x32_bf16 v[24:27], a[0:3], a[192:195], v[88:91]
ds_read_b128 a[40:43], v2 offset:2048
v_exp_f32 v44, v44
v_mfma_f32_16x16x32_bf16 v[24:27], a[4:7], a[196:199], v[24:27]
buffer_load_dwordx4 v3, s[48:51], s32 offen offset:2048 sc1 lds
v_mfma_f32_16x16x32_bf16 v[24:27], a[8:11], a[200:203], v[24:27]
v_exp_f32 v45, v45
v_mfma_f32_16x16x32_bf16 v[24:27], a[12:15], a[204:207], v[24:27]
ds_read_b128 a[44:47], v2 offset:3072
v_cvt_pk_bf16_f32 v75, v42, v43
v_mfma_f32_16x16x32_bf16 v[28:31], a[0:3], a[208:211], v[92:95]
ds_read_b128 a[48:51], v2 offset:4096
v_exp_f32 v46, v46
v_mfma_f32_16x16x32_bf16 v[28:31], a[4:7], a[212:215], v[28:31]
s_waitcnt lgkmcnt(5)
v_exp_f32 v47, v47
v_mfma_f32_16x16x32_bf16 v[28:31], a[8:11], a[216:219], v[28:31]
ds_read_b128 a[52:55], v2 offset:5120
v_cvt_pk_bf16_f32 v78, v44, v45
v_mfma_f32_16x16x32_bf16 v[28:31], a[12:15], a[220:223], v[28:31]
buffer_load_dwordx4 v3, s[48:51], s32 offen offset:3072 sc1 lds
v_mfma_f32_16x16x32_bf16 v[40:43], a[16:19], a[192:195], v[88:91]
ds_read_b128 a[56:59], v2 offset:6144
s_add_u32 s32, s32, 0x8000
v_mfma_f32_16x16x32_bf16 v[40:43], a[20:23], a[196:199], v[40:43]
ds_read_b128 a[60:63], v2 offset:7168
v_cvt_pk_bf16_f32 v79, v46, v47
v_mfma_f32_16x16x32_bf16 v[40:43], a[24:27], a[200:203], v[40:43]
v_exp_f32 v24, v24
v_mfma_f32_16x16x32_bf16 v[40:43], a[28:31], a[204:207], v[40:43]
v_exp_f32 v25, v25
v_mfma_f32_16x16x32_bf16 v[44:47], a[16:19], a[208:211], v[92:95]
v_exp_f32 v26, v26
v_mfma_f32_16x16x32_bf16 v[44:47], a[20:23], a[212:215], v[44:47]
v_exp_f32 v27, v27
v_mfma_f32_16x16x32_bf16 v[44:47], a[24:27], a[216:219], v[44:47]
v_exp_f32 v28, v28
v_mfma_f32_16x16x32_bf16 v[44:47], a[28:31], a[220:223], v[44:47]
s_waitcnt lgkmcnt(0)
v_exp_f32 v29, v29
v_mfma_f32_16x16x32_bf16 v[192:195], a[32:35], v[72:75], v[192:195]
v_exp_f32 v30, v30
v_mfma_f32_16x16x32_bf16 v[224:227], a[32:35], v[76:79], v[224:227]
v_exp_f32 v31, v31
v_mfma_f32_16x16x32_bf16 v[228:231], a[36:39], v[76:79], v[228:231]
v_exp_f32 v40, v40
v_mfma_f32_16x16x32_bf16 v[196:199], a[36:39], v[72:75], v[196:199]
s_add_u32 m0, s19, 0x1000
v_exp_f32 v41, v41
v_mfma_f32_16x16x32_bf16 v[200:203], a[40:43], v[72:75], v[200:203]
ds_read_b128 a[0:3], v2 offset:24576
v_cvt_pk_bf16_f32 v56, v24, v25
v_mfma_f32_16x16x32_bf16 v[232:235], a[40:43], v[76:79], v[232:235]
buffer_load_dwordx4 v3, s[48:51], s7 offen offset:0 sc1 lds
v_mfma_f32_16x16x32_bf16 v[236:239], a[44:47], v[76:79], v[236:239]
ds_read_b128 a[4:7], v2 offset:25600
v_cvt_pk_bf16_f32 v57, v26, v27
v_mfma_f32_16x16x32_bf16 v[204:207], a[44:47], v[72:75], v[204:207]
ds_read_b128 a[8:11], v2 offset:26624
v_cvt_pk_bf16_f32 v60, v28, v29
v_mfma_f32_16x16x32_bf16 v[208:211], a[48:51], v[72:75], v[208:211]
ds_read_b128 a[12:15], v2 offset:27648
v_cvt_pk_bf16_f32 v61, v30, v31
v_mfma_f32_16x16x32_bf16 v[240:243], a[48:51], v[76:79], v[240:243]
ds_read_b128 a[16:19], v2 offset:28672
v_cvt_pk_bf16_f32 v58, v40, v41
v_mfma_f32_16x16x32_bf16 v[244:247], a[52:55], v[76:79], v[244:247]
buffer_load_dwordx4 v3, s[48:51], s7 offen offset:1024 sc1 lds
v_mfma_f32_16x16x32_bf16 v[212:215], a[52:55], v[72:75], v[212:215]
ds_read_b128 a[20:23], v2 offset:29696
v_mfma_f32_16x16x32_bf16 v[216:219], a[56:59], v[72:75], v[216:219]
v_exp_f32 v42, v42
v_mfma_f32_16x16x32_bf16 v[248:251], a[56:59], v[76:79], v[248:251]
ds_read_b128 a[24:27], v2 offset:30720
v_mfma_f32_16x16x32_bf16 v[252:255], a[60:63], v[76:79], v[252:255]
ds_read_b128 a[28:31], v2 offset:31744
v_exp_f32 v43, v43
v_mfma_f32_16x16x32_bf16 v[220:223], a[60:63], v[72:75], v[220:223]
ds_read_b128 a[32:35], v2 offset:16384
v_cvt_pk_bf16_f32 v59, v42, v43
v_smfmac_f32_16x16x64_bf16 a[228:231], a[232:235], v[72:79], v9
ds_read_b128 a[36:39], v2 offset:17408
s_waitcnt lgkmcnt(6)
v_mfma_f32_16x16x32_bf16 v[24:27], a[0:3], a[192:195], v[88:91]
buffer_load_dwordx4 v3, s[48:51], s7 offen offset:2048 sc1 lds
v_mfma_f32_16x16x32_bf16 v[24:27], a[4:7], a[196:199], v[24:27]
ds_read_b128 a[40:43], v2 offset:18432
v_exp_f32 v44, v44
v_mfma_f32_16x16x32_bf16 v[24:27], a[8:11], a[200:203], v[24:27]
ds_read_b128 a[44:47], v2 offset:19456
v_exp_f32 v45, v45
v_mfma_f32_16x16x32_bf16 v[24:27], a[12:15], a[204:207], v[24:27]
ds_read_b128 a[48:51], v2 offset:20480
v_cvt_pk_bf16_f32 v62, v44, v45
v_mfma_f32_16x16x32_bf16 v[28:31], a[0:3], a[208:211], v[92:95]
v_exp_f32 v46, v46
v_mfma_f32_16x16x32_bf16 v[28:31], a[4:7], a[212:215], v[28:31]
s_waitcnt lgkmcnt(5)
v_exp_f32 v47, v47
v_mfma_f32_16x16x32_bf16 v[28:31], a[8:11], a[216:219], v[28:31]
ds_read_b128 a[52:55], v2 offset:21504
v_cvt_pk_bf16_f32 v63, v46, v47
v_mfma_f32_16x16x32_bf16 v[28:31], a[12:15], a[220:223], v[28:31]
buffer_load_dwordx4 v3, s[48:51], s7 offen offset:3072 sc1 lds
v_mfma_f32_16x16x32_bf16 v[40:43], a[16:19], a[192:195], v[88:91]
ds_read_b128 a[56:59], v2 offset:22528
s_add_u32 s7, s7, 0x8000
v_mfma_f32_16x16x32_bf16 v[40:43], a[20:23], a[196:199], v[40:43]
ds_read_b128 a[60:63], v2 offset:23552
v_xor_b32 v2, 0x38000, v2
v_mfma_f32_16x16x32_bf16 v[40:43], a[24:27], a[200:203], v[40:43]
s_xor_b32 s19, s19, 0x8000
v_exp_f32 v24, v24
v_mfma_f32_16x16x32_bf16 v[40:43], a[28:31], a[204:207], v[40:43]
s_sub_u32 s15, s15, 1
v_exp_f32 v25, v25
v_mfma_f32_16x16x32_bf16 v[44:47], a[16:19], a[208:211], v[92:95]
s_cmp_lg_u32 s15, 0
v_exp_f32 v26, v26
v_mfma_f32_16x16x32_bf16 v[44:47], a[20:23], a[212:215], v[44:47]
v_exp_f32 v27, v27
v_mfma_f32_16x16x32_bf16 v[44:47], a[24:27], a[216:219], v[44:47]
s_waitcnt vmcnt(16) lgkmcnt(0)
v_exp_f32 v28, v28
v_mfma_f32_16x16x32_bf16 v[44:47], a[28:31], a[220:223], v[44:47]
s_barrier
v_exp_f32 v29, v29
s_cbranch_scc1 L_att_seven0
s_branch L_att_sdone
L_att_seven1:
v_mfma_f32_16x16x32_bf16 v[192:195], a[32:35], v[56:59], v[192:195]
v_exp_f32 v30, v30
v_mfma_f32_16x16x32_bf16 v[224:227], a[32:35], v[60:63], v[224:227]
ds_read_b128 a[0:3], v1 offset:8192
v_cvt_pk_bf16_f32 v72, v24, v25
v_mfma_f32_16x16x32_bf16 v[228:231], a[36:39], v[60:63], v[228:231]
ds_read_b128 a[4:7], v1 offset:9216
v_cvt_pk_bf16_f32 v73, v26, v27
v_mfma_f32_16x16x32_bf16 v[196:199], a[36:39], v[56:59], v[196:199]
s_add_u32 m0, s27, 0x0
v_exp_f32 v31, v31
v_mfma_f32_16x16x32_bf16 v[200:203], a[40:43], v[56:59], v[200:203]
ds_read_b128 a[8:11], v1 offset:10240
v_cvt_pk_bf16_f32 v76, v28, v29
v_mfma_f32_16x16x32_bf16 v[232:235], a[40:43], v[60:63], v[232:235]
buffer_load_dwordx4 v3, s[48:51], s32 offen offset:0 sc1 lds
v_mfma_f32_16x16x32_bf16 v[236:239], a[44:47], v[60:63], v[236:239]
v_exp_f32 v40, v40
v_mfma_f32_16x16x32_bf16 v[204:207], a[44:47], v[56:59], v[204:207]
ds_read_b128 a[12:15], v1 offset:11264
v_cvt_pk_bf16_f32 v77, v30, v31
v_mfma_f32_16x16x32_bf16 v[208:211], a[48:51], v[56:59], v[208:211]
ds_read_b128 a[16:19], v1 offset:12288
v_mfma_f32_16x16x32_bf16 v[240:243], a[48:51], v[60:63], v[240:243]
buffer_load_dwordx4 v3, s[48:51], s32 offen offset:1024 sc1 lds
v_mfma_f32_16x16x32_bf16 v[244:247], a[52:55], v[60:63], v[244:247]
ds_read_b128 a[20:23], v1 offset:13312
v_mfma_f32_16x16x32_bf16 v[212:215], a[52:55], v[56:59], v[212:215]
ds_read_b128 a[24:27], v1 offset:14336
v_mfma_f32_16x16x32_bf16 v[216:219], a[56:59], v[56:59], v[216:219]
ds_read_b128 a[28:31], v1 offset:15360
v_mfma_f32_16x16x32_bf16 v[248:251], a[56:59], v[60:63], v[248:251]
ds_read_b128 a[32:35], v1 offset:0
v_exp_f32 v41, v41
v_mfma_f32_16x16x32_bf16 v[252:255], a[60:63], v[60:63], v[252:255]
v_exp_f32 v42, v42
v_mfma_f32_16x16x32_bf16 v[220:223], a[60:63], v[56:59], v[220:223]
s_waitcnt lgkmcnt(5)
v_exp_f32 v43, v43
v_smfmac_f32_16x16x64_bf16 a[228:231], a[232:235], v[56:63], v9
ds_read_b128 a[36:39], v1 offset:1024
v_cvt_pk_bf16_f32 v74, v40, v41
v_mfma_f32_16x16x32_bf16 v[24:27], a[0:3], a[192:195], v[88:91]
ds_read_b128 a[40:43], v1 offset:2048
v_exp_f32 v44, v44
v_mfma_f32_16x16x32_bf16 v[24:27], a[4:7], a[196:199], v[24:27]
buffer_load_dwordx4 v3, s[48:51], s32 offen offset:2048 sc1 lds
v_mfma_f32_16x16x32_bf16 v[24:27], a[8:11], a[200:203], v[24:27]
v_exp_f32 v45, v45
v_mfma_f32_16x16x32_bf16 v[24:27], a[12:15], a[204:207], v[24:27]
ds_read_b128 a[44:47], v1 offset:3072
v_cvt_pk_bf16_f32 v75, v42, v43
v_mfma_f32_16x16x32_bf16 v[28:31], a[0:3], a[208:211], v[92:95]
ds_read_b128 a[48:51], v1 offset:4096
v_exp_f32 v46, v46
v_mfma_f32_16x16x32_bf16 v[28:31], a[4:7], a[212:215], v[28:31]
s_waitcnt lgkmcnt(5)
v_exp_f32 v47, v47
v_mfma_f32_16x16x32_bf16 v[28:31], a[8:11], a[216:219], v[28:31]
ds_read_b128 a[52:55], v1 offset:5120
v_cvt_pk_bf16_f32 v78, v44, v45
v_mfma_f32_16x16x32_bf16 v[28:31], a[12:15], a[220:223], v[28:31]
buffer_load_dwordx4 v3, s[48:51], s32 offen offset:3072 sc1 lds
v_mfma_f32_16x16x32_bf16 v[40:43], a[16:19], a[192:195], v[88:91]
ds_read_b128 a[56:59], v1 offset:6144
s_add_u32 s32, s32, 0x8000
v_mfma_f32_16x16x32_bf16 v[40:43], a[20:23], a[196:199], v[40:43]
ds_read_b128 a[60:63], v1 offset:7168
v_cvt_pk_bf16_f32 v79, v46, v47
v_mfma_f32_16x16x32_bf16 v[40:43], a[24:27], a[200:203], v[40:43]
v_exp_f32 v24, v24
v_mfma_f32_16x16x32_bf16 v[40:43], a[28:31], a[204:207], v[40:43]
v_exp_f32 v25, v25
v_mfma_f32_16x16x32_bf16 v[44:47], a[16:19], a[208:211], v[92:95]
v_exp_f32 v26, v26
v_mfma_f32_16x16x32_bf16 v[44:47], a[20:23], a[212:215], v[44:47]
v_exp_f32 v27, v27
v_mfma_f32_16x16x32_bf16 v[44:47], a[24:27], a[216:219], v[44:47]
v_exp_f32 v28, v28
v_mfma_f32_16x16x32_bf16 v[44:47], a[28:31], a[220:223], v[44:47]
s_waitcnt lgkmcnt(0)
v_exp_f32 v29, v29
v_mfma_f32_16x16x32_bf16 v[192:195], a[32:35], v[72:75], v[192:195]
s_add_u32 m0, s27, 0x1000
v_exp_f32 v30, v30
v_mfma_f32_16x16x32_bf16 v[224:227], a[32:35], v[76:79], v[224:227]
buffer_load_dwordx4 v3, s[48:51], s7 offen offset:0 sc1 lds
v_mfma_f32_16x16x32_bf16 v[228:231], a[36:39], v[76:79], v[228:231]
v_exp_f32 v31, v31
v_mfma_f32_16x16x32_bf16 v[196:199], a[36:39], v[72:75], v[196:199]
ds_read_b128 a[0:3], v1 offset:24576
v_cvt_pk_bf16_f32 v56, v24, v25
v_mfma_f32_16x16x32_bf16 v[200:203], a[40:43], v[72:75], v[200:203]
ds_read_b128 a[4:7], v1 offset:25600
v_cvt_pk_bf16_f32 v57, v26, v27
v_mfma_f32_16x16x32_bf16 v[232:235], a[40:43], v[76:79], v[232:235]
v_exp_f32 v40, v40
v_mfma_f32_16x16x32_bf16 v[236:239], a[44:47], v[76:79], v[236:239]
ds_read_b128 a[8:11], v1 offset:26624
v_cvt_pk_bf16_f32 v60, v28, v29
v_mfma_f32_16x16x32_bf16 v[204:207], a[44:47], v[72:75], v[204:207]
v_exp_f32 v41, v41
v_mfma_f32_16x16x32_bf16 v[208:211], a[48:51], v[72:75], v[208:211]
ds_read_b128 a[12:15], v1 offset:27648
v_cvt_pk_bf16_f32 v61, v30, v31
v_mfma_f32_16x16x32_bf16 v[240:243], a[48:51], v[76:79], v[240:243]
ds_read_b128 a[16:19], v1 offset:28672
v_cvt_pk_bf16_f32 v58, v40, v41
v_mfma_f32_16x16x32_bf16 v[244:247], a[52:55], v[76:79], v[244:247]
v_exp_f32 v42, v42
v_mfma_f32_16x16x32_bf16 v[212:215], a[52:55], v[72:75], v[212:215]
buffer_load_dwordx4 v3, s[48:51], s7 offen offset:1024 sc1 lds
v_mfma_f32_16x16x32_bf16 v[216:219], a[56:59], v[72:75], v[216:219]
ds_read_b128 a[20:23], v1 offset:29696
v_mfma_f32_16x16x32_bf16 v[248:251], a[56:59], v[76:79], v[248:251]
ds_read_b128 a[24:27], v1 offset:30720
v_mfma_f32_16x16x32_bf16 v[252:255], a[60:63], v[76:79], v[252:255]
ds_read_b128 a[28:31], v1 offset:31744
v_mfma_f32_16x16x32_bf16 v[220:223], a[60:63], v[72:75], v[220:223]
s_waitcnt lgkmcnt(4)
v_exp_f32 v43, v43
v_smfmac_f32_16x16x64_bf16 a[228:231], a[232:235], v[72:79], v9
ds_read_b128 a[32:35], v1 offset:16384
v_cvt_pk_bf16_f32 v59, v42, v43
v_mfma_f32_16x16x32_bf16 v[24:27], a[0:3], a[192:195], v[88:91]
ds_read_b128 a[36:39], v1 offset:17408
v_mfma_f32_16x16x32_bf16 v[24:27], a[4:7], a[196:199], v[24:27]
buffer_load_dwordx4 v3, s[48:51], s7 offen offset:2048 sc1 lds
v_mfma_f32_16x16x32_bf16 v[24:27], a[8:11], a[200:203], v[24:27]
ds_read_b128 a[40:43], v1 offset:18432
v_exp_f32 v44, v44
v_mfma_f32_16x16x32_bf16 v[24:27], a[12:15], a[204:207], v[24:27]
ds_read_b128 a[44:47], v1 offset:19456
v_exp_f32 v45, v45
v_mfma_f32_16x16x32_bf16 v[28:31], a[0:3], a[208:211], v[92:95]
ds_read_b128 a[48:51], v1 offset:20480
v_exp_f32 v46, v46
v_mfma_f32_16x16x32_bf16 v[28:31], a[4:7], a[212:215], v[28:31]
s_waitcnt lgkmcnt(5)
v_exp_f32 v47, v47
v_mfma_f32_16x16x32_bf16 v[28:31], a[8:11], a[216:219], v[28:31]
ds_read_b128 a[52:55], v1 offset:21504
v_cvt_pk_bf16_f32 v62, v44, v45
v_mfma_f32_16x16x32_bf16 v[28:31], a[12:15], a[220:223], v[28:31]
ds_read_b128 a[56:59], v1 offset:22528
v_cvt_pk_bf16_f32 v63, v46, v47
v_mfma_f32_16x16x32_bf16 v[40:43], a[16:19], a[192:195], v[88:91]
ds_read_b128 a[60:63], v1 offset:23552
v_xor_b32 v1, 0x8000, v1
v_mfma_f32_16x16x32_bf16 v[40:43], a[20:23], a[196:199], v[40:43]
buffer_load_dwordx4 v3, s[48:51], s7 offen offset:3072 sc1 lds
v_mfma_f32_16x16x32_bf16 v[40:43], a[24:27], a[200:203], v[40:43]
s_add_u32 s7, s7, 0x8000
v_exp_f32 v24, v24
v_mfma_f32_16x16x32_bf16 v[40:43], a[28:31], a[204:207], v[40:43]
s_xor_b32 s27, s27, 0x38000
v_exp_f32 v25, v25
v_mfma_f32_16x16x32_bf16 v[44:47], a[16:19], a[208:211], v[92:95]
s_waitcnt vmcnt(16) lgkmcnt(0)
v_exp_f32 v26, v26
v_mfma_f32_16x16x32_bf16 v[44:47], a[20:23], a[212:215], v[44:47]
s_barrier
v_exp_f32 v27, v27
v_mfma_f32_16x16x32_bf16 v[44:47], a[24:27], a[216:219], v[44:47]
v_exp_f32 v28, v28
v_mfma_f32_16x16x32_bf16 v[44:47], a[28:31], a[220:223], v[44:47]
v_exp_f32 v29, v29
L_att_sodd1:
v_mfma_f32_16x16x32_bf16 v[192:195], a[32:35], v[56:59], v[192:195]
v_exp_f32 v30, v30
v_mfma_f32_16x16x32_bf16 v[224:227], a[32:35], v[60:63], v[224:227]
ds_read_b128 a[0:3], v2 offset:8192
v_cvt_pk_bf16_f32 v72, v24, v25
v_mfma_f32_16x16x32_bf16 v[228:231], a[36:39], v[60:63], v[228:231]
ds_read_b128 a[4:7], v2 offset:9216
v_cvt_pk_bf16_f32 v73, v26, v27
v_mfma_f32_16x16x32_bf16 v[196:199], a[36:39], v[56:59], v[196:199]
s_add_u32 m0, s19, 0x0
v_exp_f32 v31, v31
v_mfma_f32_16x16x32_bf16 v[200:203], a[40:43], v[56:59], v[200:203]
ds_read_b128 a[8:11], v2 offset:10240
v_cvt_pk_bf16_f32 v76, v28, v29
v_mfma_f32_16x16x32_bf16 v[232:235], a[40:43], v[60:63], v[232:235]
buffer_load_dwordx4 v3, s[48:51], s32 offen offset:0 sc1 lds
v_mfma_f32_16x16x32_bf16 v[236:239], a[44:47], v[60:63], v[236:239]
v_exp_f32 v40, v40
v_mfma_f32_16x16x32_bf16 v[204:207], a[44:47], v[56:59], v[204:207]
ds_read_b128 a[12:15], v2 offset:11264
v_cvt_pk_bf16_f32 v77, v30, v31
v_mfma_f32_16x16x32_bf16 v[208:211], a[48:51], v[56:59], v[208:211]
ds_read_b128 a[16:19], v2 offset:12288
v_mfma_f32_16x16x32_bf16 v[240:243], a[48:51], v[60:63], v[240:243]
buffer_load_dwordx4 v3, s[48:51], s32 offen offset:1024 sc1 lds
v_mfma_f32_16x16x32_bf16 v[244:247], a[52:55], v[60:63], v[244:247]
ds_read_b128 a[20:23], v2 offset:13312
v_mfma_f32_16x16x32_bf16 v[212:215], a[52:55], v[56:59], v[212:215]
ds_read_b128 a[24:27], v2 offset:14336
v_mfma_f32_16x16x32_bf16 v[216:219], a[56:59], v[56:59], v[216:219]
ds_read_b128 a[28:31], v2 offset:15360
v_mfma_f32_16x16x32_bf16 v[248:251], a[56:59], v[60:63], v[248:251]
ds_read_b128 a[32:35], v2 offset:0
v_exp_f32 v41, v41
v_mfma_f32_16x16x32_bf16 v[252:255], a[60:63], v[60:63], v[252:255]
v_exp_f32 v42, v42
v_mfma_f32_16x16x32_bf16 v[220:223], a[60:63], v[56:59], v[220:223]
s_waitcnt lgkmcnt(5)
v_exp_f32 v43, v43
v_smfmac_f32_16x16x64_bf16 a[228:231], a[232:235], v[56:63], v9
ds_read_b128 a[36:39], v2 offset:1024
v_cvt_pk_bf16_f32 v74, v40, v41
v_mfma_f32_16x16x32_bf16 v[24:27], a[0:3], a[192:195], v[88:91]
ds_read_b128 a[40:43], v2 offset:2048
v_exp_f32 v44, v44
v_mfma_f32_16x16x32_bf16 v[24:27], a[4:7], a[196:199], v[24:27]
buffer_load_dwordx4 v3, s[48:51], s32 offen offset:2048 sc1 lds
v_mfma_f32_16x16x32_bf16 v[24:27], a[8:11], a[200:203], v[24:27]
v_exp_f32 v45, v45
v_mfma_f32_16x16x32_bf16 v[24:27], a[12:15], a[204:207], v[24:27]
ds_read_b128 a[44:47], v2 offset:3072
v_cvt_pk_bf16_f32 v75, v42, v43
v_mfma_f32_16x16x32_bf16 v[28:31], a[0:3], a[208:211], v[92:95]
ds_read_b128 a[48:51], v2 offset:4096
v_exp_f32 v46, v46
v_mfma_f32_16x16x32_bf16 v[28:31], a[4:7], a[212:215], v[28:31]
s_waitcnt lgkmcnt(5)
v_exp_f32 v47, v47
v_mfma_f32_16x16x32_bf16 v[28:31], a[8:11], a[216:219], v[28:31]
ds_read_b128 a[52:55], v2 offset:5120
v_cvt_pk_bf16_f32 v78, v44, v45
v_mfma_f32_16x16x32_bf16 v[28:31], a[12:15], a[220:223], v[28:31]
buffer_load_dwordx4 v3, s[48:51], s32 offen offset:3072 sc1 lds
v_mfma_f32_16x16x32_bf16 v[40:43], a[16:19], a[192:195], v[88:91]
ds_read_b128 a[56:59], v2 offset:6144
s_add_u32 s32, s32, 0x8000
v_mfma_f32_16x16x32_bf16 v[40:43], a[20:23], a[196:199], v[40:43]
ds_read_b128 a[60:63], v2 offset:7168
v_cvt_pk_bf16_f32 v79, v46, v47
v_mfma_f32_16x16x32_bf16 v[40:43], a[24:27], a[200:203], v[40:43]
v_exp_f32 v24, v24
v_mfma_f32_16x16x32_bf16 v[40:43], a[28:31], a[204:207], v[40:43]
v_exp_f32 v25, v25
v_mfma_f32_16x16x32_bf16 v[44:47], a[16:19], a[208:211], v[92:95]
v_exp_f32 v26, v26
v_mfma_f32_16x16x32_bf16 v[44:47], a[20:23], a[212:215], v[44:47]
v_exp_f32 v27, v27
v_mfma_f32_16x16x32_bf16 v[44:47], a[24:27], a[216:219], v[44:47]
v_exp_f32 v28, v28
v_mfma_f32_16x16x32_bf16 v[44:47], a[28:31], a[220:223], v[44:47]
s_waitcnt lgkmcnt(0)
v_exp_f32 v29, v29
v_mfma_f32_16x16x32_bf16 v[192:195], a[32:35], v[72:75], v[192:195]
v_exp_f32 v30, v30
v_mfma_f32_16x16x32_bf16 v[224:227], a[32:35], v[76:79], v[224:227]
v_exp_f32 v31, v31
v_mfma_f32_16x16x32_bf16 v[228:231], a[36:39], v[76:79], v[228:231]
v_exp_f32 v40, v40
v_mfma_f32_16x16x32_bf16 v[196:199], a[36:39], v[72:75], v[196:199]
s_add_u32 m0, s19, 0x1000
v_exp_f32 v41, v41
v_mfma_f32_16x16x32_bf16 v[200:203], a[40:43], v[72:75], v[200:203]
ds_read_b128 a[0:3], v2 offset:24576
v_cvt_pk_bf16_f32 v56, v24, v25
v_mfma_f32_16x16x32_bf16 v[232:235], a[40:43], v[76:79], v[232:235]
buffer_load_dwordx4 v3, s[48:51], s7 offen offset:0 sc1 lds
v_mfma_f32_16x16x32_bf16 v[236:239], a[44:47], v[76:79], v[236:239]
ds_read_b128 a[4:7], v2 offset:25600
v_cvt_pk_bf16_f32 v57, v26, v27
v_mfma_f32_16x16x32_bf16 v[204:207], a[44:47], v[72:75], v[204:207]
ds_read_b128 a[8:11], v2 offset:26624
v_cvt_pk_bf16_f32 v60, v28, v29
v_mfma_f32_16x16x32_bf16 v[208:211], a[48:51], v[72:75], v[208:211]
ds_read_b128 a[12:15], v2 offset:27648
v_cvt_pk_bf16_f32 v61, v30, v31
v_mfma_f32_16x16x32_bf16 v[240:243], a[48:51], v[76:79], v[240:243]
ds_read_b128 a[16:19], v2 offset:28672
v_cvt_pk_bf16_f32 v58, v40, v41
v_mfma_f32_16x16x32_bf16 v[244:247], a[52:55], v[76:79], v[244:247]
buffer_load_dwordx4 v3, s[48:51], s7 offen offset:1024 sc1 lds
v_mfma_f32_16x16x32_bf16 v[212:215], a[52:55], v[72:75], v[212:215]
ds_read_b128 a[20:23], v2 offset:29696
v_mfma_f32_16x16x32_bf16 v[216:219], a[56:59], v[72:75], v[216:219]
v_exp_f32 v42, v42
v_mfma_f32_16x16x32_bf16 v[248:251], a[56:59], v[76:79], v[248:251]
ds_read_b128 a[24:27], v2 offset:30720
v_mfma_f32_16x16x32_bf16 v[252:255], a[60:63], v[76:79], v[252:255]
ds_read_b128 a[28:31], v2 offset:31744
v_exp_f32 v43, v43
v_mfma_f32_16x16x32_bf16 v[220:223], a[60:63], v[72:75], v[220:223]
ds_read_b128 a[32:35], v2 offset:16384
v_cvt_pk_bf16_f32 v59, v42, v43
v_smfmac_f32_16x16x64_bf16 a[228:231], a[232:235], v[72:79], v9
ds_read_b128 a[36:39], v2 offset:17408
s_waitcnt lgkmcnt(6)
v_mfma_f32_16x16x32_bf16 v[24:27], a[0:3], a[192:195], v[88:91]
buffer_load_dwordx4 v3, s[48:51], s7 offen offset:2048 sc1 lds
v_mfma_f32_16x16x32_bf16 v[24:27], a[4:7], a[196:199], v[24:27]
ds_read_b128 a[40:43], v2 offset:18432
v_exp_f32 v44, v44
v_mfma_f32_16x16x32_bf16 v[24:27], a[8:11], a[200:203], v[24:27]
ds_read_b128 a[44:47], v2 offset:19456
v_exp_f32 v45, v45
v_mfma_f32_16x16x32_bf16 v[24:27], a[12:15], a[204:207], v[24:27]
ds_read_b128 a[48:51], v2 offset:20480
v_cvt_pk_bf16_f32 v62, v44, v45
v_mfma_f32_16x16x32_bf16 v[28:31], a[0:3], a[208:211], v[92:95]
v_exp_f32 v46, v46
v_mfma_f32_16x16x32_bf16 v[28:31], a[4:7], a[212:215], v[28:31]
s_waitcnt lgkmcnt(5)
v_exp_f32 v47, v47
v_mfma_f32_16x16x32_bf16 v[28:31], a[8:11], a[216:219], v[28:31]
ds_read_b128 a[52:55], v2 offset:21504
v_cvt_pk_bf16_f32 v63, v46, v47
v_mfma_f32_16x16x32_bf16 v[28:31], a[12:15], a[220:223], v[28:31]
buffer_load_dwordx4 v3, s[48:51], s7 offen offset:3072 sc1 lds
v_mfma_f32_16x16x32_bf16 v[40:43], a[16:19], a[192:195], v[88:91]
ds_read_b128 a[56:59], v2 offset:22528
s_add_u32 s7, s7, 0x8000
v_mfma_f32_16x16x32_bf16 v[40:43], a[20:23], a[196:199], v[40:43]
ds_read_b128 a[60:63], v2 offset:23552
v_xor_b32 v2, 0x38000, v2
v_mfma_f32_16x16x32_bf16 v[40:43], a[24:27], a[200:203], v[40:43]
s_xor_b32 s19, s19, 0x8000
v_exp_f32 v24, v24
v_mfma_f32_16x16x32_bf16 v[40:43], a[28:31], a[204:207], v[40:43]
s_sub_u32 s15, s15, 1
v_exp_f32 v25, v25
v_mfma_f32_16x16x32_bf16 v[44:47], a[16:19], a[208:211], v[92:95]
s_cmp_lg_u32 s15, 0
s_waitcnt vmcnt(16) lgkmcnt(0)
v_exp_f32 v26, v26
v_mfma_f32_16x16x32_bf16 v[44:47], a[20:23], a[212:215], v[44:47]
s_barrier
v_exp_f32 v27, v27
v_mfma_f32_16x16x32_bf16 v[44:47], a[24:27], a[216:219], v[44:47]
v_exp_f32 v28, v28
v_mfma_f32_16x16x32_bf16 v[44:47], a[28:31], a[220:223], v[44:47]
v_exp_f32 v29, v29
s_cbranch_scc1 L_att_seven1
L_att_sdone:
s_cmp_ge_u32 s4, 2
s_cbranch_scc1 L_att_sh0_1
L_att_sh0_0:
v_mfma_f32_16x16x32_bf16 v[192:195], a[32:35], v[56:59], v[192:195]
ds_read_b128 a[0:3], v1 offset:8192
v_cvt_pk_bf16_f32 v72, v24, v25
v_mfma_f32_16x16x32_bf16 v[224:227], a[32:35], v[60:63], v[224:227]
ds_read_b128 a[4:7], v1 offset:9216
v_cvt_pk_bf16_f32 v73, v26, v27
v_mfma_f32_16x16x32_bf16 v[228:231], a[36:39], v[60:63], v[228:231]
v_exp_f32 v30, v30
v_mfma_f32_16x16x32_bf16 v[196:199], a[36:39], v[56:59], v[196:199]
buffer_load_dword v14, v15, s[84:87], 0 offen offset:192 sc1
v_mfma_f32_16x16x32_bf16 v[200:203], a[40:43], v[56:59], v[200:203]
ds_read_b128 a[8:11], v1 offset:10240
v_cvt_pk_bf16_f32 v76, v28, v29
v_mfma_f32_16x16x32_bf16 v[232:235], a[40:43], v[60:63], v[232:235]
ds_read_b128 a[12:15], v1 offset:11264
v_mfma_f32_16x16x32_bf16 v[236:239], a[44:47], v[60:63], v[236:239]
s_add_u32 m0, s17, 0x10000
v_exp_f32 v31, v31
v_mfma_f32_16x16x32_bf16 v[204:207], a[44:47], v[56:59], v[204:207]
ds_read_b128 a[16:19], v1 offset:12288
v_cvt_pk_bf16_f32 v77, v30, v31
v_mfma_f32_16x16x32_bf16 v[208:211], a[48:51], v[56:59], v[208:211]
ds_read_b128 a[20:23], v1 offset:13312
v_mfma_f32_16x16x32_bf16 v[240:243], a[48:51], v[60:63], v[240:243]
buffer_load_dwordx4 v12, s[72:75], 0 offen lds
v_mfma_f32_16x16x32_bf16 v[244:247], a[52:55], v[60:63], v[244:247]
ds_read_b128 a[24:27], v1 offset:14336
v_exp_f32 v40, v40
v_mfma_f32_16x16x32_bf16 v[212:215], a[52:55], v[56:59], v[212:215]
v_exp_f32 v41, v41
v_mfma_f32_16x16x32_bf16 v[216:219], a[56:59], v[56:59], v[216:219]
ds_read_b128 a[28:31], v1 offset:15360
v_exp_f32 v42, v42
v_mfma_f32_16x16x32_bf16 v[248:251], a[56:59], v[60:63], v[248:251]
v_exp_f32 v43, v43
v_mfma_f32_16x16x32_bf16 v[252:255], a[60:63], v[60:63], v[252:255]
ds_read_b128 a[32:35], v1 offset:0
v_cvt_pk_bf16_f32 v74, v40, v41
v_mfma_f32_16x16x32_bf16 v[220:223], a[60:63], v[56:59], v[220:223]
buffer_load_dwordx4 v13, s[72:75], 0 offen offset:1024 lds
v_smfmac_f32_16x16x64_bf16 a[228:231], a[232:235], v[56:63], v9
ds_read_b128 a[36:39], v1 offset:1024
s_waitcnt lgkmcnt(6)
v_mfma_f32_16x16x32_bf16 v[24:27], a[0:3], a[192:195], v[112:115]
ds_read_b128 a[40:43], v1 offset:2048
v_exp_f32 v44, v44
v_mfma_f32_16x16x32_bf16 v[24:27], a[4:7], a[196:199], v[24:27]
v_exp_f32 v45, v45
v_mfma_f32_16x16x32_bf16 v[24:27], a[8:11], a[200:203], v[24:27]
ds_read_b128 a[44:47], v1 offset:3072
v_exp_f32 v46, v46
v_mfma_f32_16x16x32_bf16 v[24:27], a[12:15], a[204:207], v[24:27]
v_exp_f32 v47, v47
v_mfma_f32_16x16x32_bf16 v[28:31], a[0:3], a[208:211], v[92:95]
buffer_load_dwordx4 v12, s[72:75], s12 offen offset:2048 lds
v_mfma_f32_16x16x32_bf16 v[28:31], a[4:7], a[212:215], v[28:31]
ds_read_b128 a[48:51], v1 offset:4096
v_cvt_pk_bf16_f32 v75, v42, v43
v_mfma_f32_16x16x32_bf16 v[28:31], a[8:11], a[216:219], v[28:31]
ds_read_b128 a[52:55], v1 offset:5120
v_cvt_pk_bf16_f32 v78, v44, v45
v_mfma_f32_16x16x32_bf16 v[28:31], a[12:15], a[220:223], v[28:31]
ds_read_b128 a[56:59], v1 offset:6144
s_waitcnt lgkmcnt(7)
v_mfma_f32_16x16x32_bf16 v[40:43], a[16:19], a[192:195], v[116:119]
v_exp_f32 v24, v24
v_mfma_f32_16x16x32_bf16 v[40:43], a[20:23], a[196:199], v[40:43]
ds_read_b128 a[60:63], v1 offset:7168
v_cvt_pk_bf16_f32 v79, v46, v47
v_mfma_f32_16x16x32_bf16 v[40:43], a[24:27], a[200:203], v[40:43]
buffer_load_dwordx4 v13, s[72:75], s12 offen offset:3072 lds
v_mfma_f32_16x16x32_bf16 v[40:43], a[28:31], a[204:207], v[40:43]
v_exp_f32 v25, v25
v_mfma_f32_16x16x32_bf16 v[44:47], a[16:19], a[208:211], v[92:95]
v_exp_f32 v26, v26
v_mfma_f32_16x16x32_bf16 v[44:47], a[20:23], a[212:215], v[44:47]
v_exp_f32 v27, v27
v_mfma_f32_16x16x32_bf16 v[44:47], a[24:27], a[216:219], v[44:47]
v_exp_f32 v28, v28
v_mfma_f32_16x16x32_bf16 v[44:47], a[28:31], a[220:223], v[44:47]
s_waitcnt lgkmcnt(0)
v_exp_f32 v29, v29
v_mfma_f32_16x16x32_bf16 v[192:195], a[32:35], v[72:75], v[192:195]
s_add_u32 m0, s17, 0x14000
v_exp_f32 v30, v30
v_mfma_f32_16x16x32_bf16 v[224:227], a[32:35], v[76:79], v[224:227]
v_add_u32 v12, 0x20000, v12
v_cvt_pk_bf16_f32 v56, v24, v25
v_mfma_f32_16x16x32_bf16 v[228:231], a[36:39], v[76:79], v[228:231]
buffer_load_dwordx4 v12, s[72:75], 0 offen lds
v_mfma_f32_16x16x32_bf16 v[196:199], a[36:39], v[72:75], v[196:199]
v_exp_f32 v31, v31
v_mfma_f32_16x16x32_bf16 v[200:203], a[40:43], v[72:75], v[200:203]
ds_read_b128 a[0:3], v1 offset:24576
v_cvt_pk_bf16_f32 v57, v26, v27
v_mfma_f32_16x16x32_bf16 v[232:235], a[40:43], v[76:79], v[232:235]
ds_read_b128 a[4:7], v1 offset:25600
v_cvt_pk_bf16_f32 v60, v28, v29
v_mfma_f32_16x16x32_bf16 v[236:239], a[44:47], v[76:79], v[236:239]
v_exp_f32 v40, v40
v_mfma_f32_16x16x32_bf16 v[204:207], a[44:47], v[72:75], v[204:207]
ds_read_b128 a[8:11], v1 offset:26624
v_add_u32 v13, 0x20000, v13
v_mfma_f32_16x16x32_bf16 v[208:211], a[48:51], v[72:75], v[208:211]
buffer_load_dwordx4 v13, s[72:75], 0 offen offset:1024 lds
v_mfma_f32_16x16x32_bf16 v[240:243], a[48:51], v[76:79], v[240:243]
ds_read_b128 a[12:15], v1 offset:27648
v_cvt_pk_bf16_f32 v61, v30, v31
v_mfma_f32_16x16x32_bf16 v[244:247], a[52:55], v[76:79], v[244:247]
ds_read_b128 a[16:19], v1 offset:28672
v_exp_f32 v41, v41
v_mfma_f32_16x16x32_bf16 v[212:215], a[52:55], v[72:75], v[212:215]
ds_read_b128 a[20:23], v1 offset:29696
v_exp_f32 v42, v42
v_mfma_f32_16x16x32_bf16 v[216:219], a[56:59], v[72:75], v[216:219]
ds_read_b128 a[24:27], v1 offset:30720
v_exp_f32 v43, v43
v_mfma_f32_16x16x32_bf16 v[248:251], a[56:59], v[76:79], v[248:251]
ds_read_b128 a[28:31], v1 offset:31744
v_exp_f32 v44, v44
v_mfma_f32_16x16x32_bf16 v[252:255], a[60:63], v[76:79], v[252:255]
ds_read_b128 a[32:35], v1 offset:16384
v_exp_f32 v45, v45
v_mfma_f32_16x16x32_bf16 v[220:223], a[60:63], v[72:75], v[220:223]
buffer_load_dwordx4 v12, s[72:75], s12 offen offset:2048 lds
v_smfmac_f32_16x16x64_bf16 a[228:231], a[232:235], v[72:79], v9
ds_read_b128 a[36:39], v1 offset:17408
s_waitcnt lgkmcnt(6)
v_mfma_f32_16x16x32_bf16 v[28:31], a[0:3], a[208:211], v[92:95]
buffer_load_dwordx4 v13, s[72:75], s12 offen offset:3072 lds
v_mfma_f32_16x16x32_bf16 v[28:31], a[4:7], a[212:215], v[28:31]
ds_read_b128 a[40:43], v1 offset:18432
v_exp_f32 v46, v46
v_mfma_f32_16x16x32_bf16 v[28:31], a[8:11], a[216:219], v[28:31]
ds_read_b128 a[44:47], v1 offset:19456
v_exp_f32 v47, v47
v_mfma_f32_16x16x32_bf16 v[28:31], a[12:15], a[220:223], v[28:31]
ds_read_b128 a[48:51], v1 offset:20480
s_waitcnt lgkmcnt(5)
v_cvt_pk_bf16_f32 v62, v44, v45
v_cvt_pk_bf16_f32 v63, v46, v47
v_mfma_f32_16x16x32_bf16 v[44:47], a[16:19], a[208:211], v[92:95]
ds_read_b128 a[52:55], v1 offset:21504
v_cvt_pk_bf16_f32 v58, v40, v41
v_mfma_f32_16x16x32_bf16 v[44:47], a[20:23], a[212:215], v[44:47]
ds_read_b128 a[56:59], v1 offset:22528
v_cvt_pk_bf16_f32 v59, v42, v43
v_mfma_f32_16x16x32_bf16 v[44:47], a[24:27], a[216:219], v[44:47]
ds_read_b128 a[60:63], v1 offset:23552
v_xor_b32 v1, 0x8000, v1
v_mfma_f32_16x16x32_bf16 v[44:47], a[28:31], a[220:223], v[44:47]
L_att_h1_0:
s_waitcnt vmcnt(8) lgkmcnt(0)
s_mov_b32 s92, 200000
L_spin_b0:
v_cmp_gt_u32 vcc, 32, v14
s_nop 4
s_cbranch_vccz L_spun_b0
s_sub_u32 s92, s92, 1
s_cbranch_scc1 L_spun_b0
s_sleep 6
buffer_load_dword v14, v15, s[84:87], 0 offen offset:192 sc1
s_waitcnt vmcnt(0)
s_branch L_spin_b0
L_spun_b0:
s_barrier
v_mfma_f32_16x16x32_bf16 v[192:195], a[32:35], v[56:59], v[192:195]
ds_read_b128 a[0:3], v2 offset:8192
v_exp_f32 v28, v28
v_mfma_f32_16x16x32_bf16 v[224:227], a[32:35], v[60:63], v[224:227]
ds_read_b128 a[4:7], v2 offset:9216
v_exp_f32 v29, v29
v_mfma_f32_16x16x32_bf16 v[228:231], a[36:39], v[60:63], v[228:231]
s_add_u32 s101, s101, 0x2000
v_exp_f32 v30, v30
v_mfma_f32_16x16x32_bf16 v[196:199], a[36:39], v[56:59], v[196:199]
buffer_load_dwordx4 a[64:67], v3, s[88:91], s101 offen sc1
v_mfma_f32_16x16x32_bf16 v[200:203], a[40:43], v[56:59], v[200:203]
ds_read_b128 a[8:11], v2 offset:10240
v_exp_f32 v31, v31
v_mfma_f32_16x16x32_bf16 v[232:235], a[40:43], v[60:63], v[232:235]
buffer_load_dwordx4 a[68:71], v3, s[88:91], s101 offen offset:1024 sc1
v_mfma_f32_16x16x32_bf16 v[236:239], a[44:47], v[60:63], v[236:239]
ds_read_b128 a[12:15], v2 offset:11264
v_exp_f32 v44, v44
v_mfma_f32_16x16x32_bf16 v[204:207], a[44:47], v[56:59], v[204:207]
buffer_load_dwordx4 a[72:75], v3, s[88:91], s101 offen offset:2048 sc1
v_mfma_f32_16x16x32_bf16 v[208:211], a[48:51], v[56:59], v[208:211]
ds_read_b128 a[16:19], v2 offset:12288
v_cvt_pk_bf16_f32 v76, v28, v29
v_mfma_f32_16x16x32_bf16 v[240:243], a[48:51], v[60:63], v[240:243]
buffer_load_dwordx4 a[76:79], v3, s[88:91], s101 offen offset:3072 sc1
v_mfma_f32_16x16x32_bf16 v[244:247], a[52:55], v[60:63], v[244:247]
ds_read_b128 a[20:23], v2 offset:13312
v_exp_f32 v45, v45
v_mfma_f32_16x16x32_bf16 v[212:215], a[52:55], v[56:59], v[212:215]
ds_read_b128 a[24:27], v2 offset:14336
v_exp_f32 v46, v46
v_mfma_f32_16x16x32_bf16 v[216:219], a[56:59], v[56:59], v[216:219]
ds_read_b128 a[28:31], v2 offset:15360
s_add_u32 s101, s101, 0x2000
v_mfma_f32_16x16x32_bf16 v[248:251], a[56:59], v[60:63], v[248:251]
buffer_load_dwordx4 a[80:83], v3, s[88:91], s101 offen sc1
v_mfma_f32_16x16x32_bf16 v[252:255], a[60:63], v[60:63], v[252:255]
ds_read_b128 a[32:35], v2 offset:0
v_cvt_pk_bf16_f32 v77, v30, v31
v_mfma_f32_16x16x32_bf16 v[220:223], a[60:63], v[56:59], v[220:223]
ds_read_b128 a[36:39], v2 offset:1024
s_waitcnt lgkmcnt(6)
v_smfmac_f32_16x16x64_bf16 a[228:231], a[232:235], v[56:63], v9
buffer_load_dwordx4 a[84:87], v3, s[88:91], s101 offen offset:1024 sc1
v_mfma_f32_16x16x32_bf16 v[28:31], a[0:3], a[208:211], v[92:95]
ds_read_b128 a[40:43], v2 offset:2048
v_exp_f32 v47, v47
v_mfma_f32_16x16x32_bf16 v[28:31], a[4:7], a[212:215], v[28:31]
ds_read_b128 a[44:47], v2 offset:3072
v_cvt_pk_bf16_f32 v78, v44, v45
v_mfma_f32_16x16x32_bf16 v[28:31], a[8:11], a[216:219], v[28:31]
buffer_load_dwordx4 a[88:91], v3, s[88:91], s101 offen offset:2048 sc1
v_mfma_f32_16x16x32_bf16 v[28:31], a[12:15], a[220:223], v[28:31]
ds_read_b128 a[48:51], v2 offset:4096
s_waitcnt lgkmcnt(5)
v_cvt_pk_bf16_f32 v79, v46, v47
v_mfma_f32_16x16x32_bf16 v[44:47], a[16:19], a[208:211], v[92:95]
ds_read_b128 a[52:55], v2 offset:5120
v_mfma_f32_16x16x32_bf16 v[44:47], a[20:23], a[212:215], v[44:47]
buffer_load_dwordx4 a[92:95], v3, s[88:91], s101 offen offset:3072 sc1
v_mfma_f32_16x16x32_bf16 v[44:47], a[24:27], a[216:219], v[44:47]
ds_read_b128 a[56:59], v2 offset:6144
v_mfma_f32_16x16x32_bf16 v[44:47], a[28:31], a[220:223], v[44:47]
ds_read_b128 a[60:63], v2 offset:7168
s_waitcnt lgkmcnt(0)
v_mfma_f32_16x16x32_bf16 v[224:227], a[32:35], v[76:79], v[224:227]
ds_read_b128 a[0:3], v2 offset:24576
s_add_u32 s101, s101, 0x2000
v_mfma_f32_16x16x32_bf16 v[228:231], a[36:39], v[76:79], v[228:231]
buffer_load_dwordx4 a[96:99], v3, s[88:91], s101 offen sc1
v_mfma_f32_16x16x32_bf16 v[232:235], a[40:43], v[76:79], v[232:235]
ds_read_b128 a[4:7], v2 offset:25600
v_exp_f32 v28, v28
v_mfma_f32_16x16x32_bf16 v[236:239], a[44:47], v[76:79], v[236:239]
buffer_load_dwordx4 a[100:103], v3, s[88:91], s101 offen offset:1024 sc1
v_mfma_f32_16x16x32_bf16 v[240:243], a[48:51], v[76:79], v[240:243]
ds_read_b128 a[8:11], v2 offset:26624
v_exp_f32 v29, v29
v_mfma_f32_16x16x32_bf16 v[244:247], a[52:55], v[76:79], v[244:247]
buffer_load_dwordx4 a[104:107], v3, s[88:91], s101 offen offset:2048 sc1
v_mfma_f32_16x16x32_bf16 v[248:251], a[56:59], v[76:79], v[248:251]
ds_read_b128 a[12:15], v2 offset:27648
s_waitcnt lgkmcnt(0)
v_mfma_f32_16x16x32_bf16 v[252:255], a[60:63], v[76:79], v[252:255]
buffer_load_dwordx4 a[108:111], v3, s[88:91], s101 offen offset:3072 sc1
ds_read_b128 a[16:19], v2 offset:28672
v_mfma_f32_16x16x32_bf16 a[228:231], a[236:239], v[76:79], a[228:231]
ds_read_b128 a[20:23], v2 offset:29696
s_add_u32 s101, s101, 0x2000
v_exp_f32 v30, v30
v_exp_f32 v31, v31
v_cvt_pk_bf16_f32 v60, v28, v29
v_cvt_pk_bf16_f32 v61, v30, v31
v_mfma_f32_16x16x32_bf16 v[28:31], a[0:3], a[208:211], v[120:123]
buffer_load_dwordx4 a[112:115], v3, s[88:91], s101 offen sc1
ds_read_b128 a[24:27], v2 offset:30720
v_mfma_f32_16x16x32_bf16 v[28:31], a[4:7], a[212:215], v[28:31]
ds_read_b128 a[28:31], v2 offset:31744
v_exp_f32 v44, v44
v_mfma_f32_16x16x32_bf16 v[28:31], a[8:11], a[216:219], v[28:31]
buffer_load_dwordx4 a[116:119], v3, s[88:91], s101 offen offset:1024 sc1
v_mfma_f32_16x16x32_bf16 v[28:31], a[12:15], a[220:223], v[28:31]
ds_read_b128 a[32:35], v2 offset:16384
s_waitcnt lgkmcnt(1)
v_exp_f32 v45, v45
v_exp_f32 v46, v46
v_exp_f32 v47, v47
v_cvt_pk_bf16_f32 v62, v44, v45
v_cvt_pk_bf16_f32 v63, v46, v47
v_mfma_f32_16x16x32_bf16 v[44:47], a[16:19], a[208:211], v[124:127]
buffer_load_dwordx4 a[120:123], v3, s[88:91], s101 offen offset:2048 sc1
v_mfma_f32_16x16x32_bf16 v[44:47], a[20:23], a[212:215], v[44:47]
buffer_load_dwordx4 a[124:127], v3, s[88:91], s101 offen offset:3072 sc1
v_mfma_f32_16x16x32_bf16 v[44:47], a[24:27], a[216:219], v[44:47]
ds_read_b128 a[36:39], v2 offset:17408
v_mfma_f32_16x16x32_bf16 v[44:47], a[28:31], a[220:223], v[44:47]
ds_read_b128 a[40:43], v2 offset:18432
ds_read_b128 a[44:47], v2 offset:19456
ds_read_b128 a[48:51], v2 offset:20480
ds_read_b128 a[52:55], v2 offset:21504
ds_read_b128 a[56:59], v2 offset:22528
ds_read_b128 a[60:63], v2 offset:23552
v_xor_b32 v2, 0x38000, v2
s_waitcnt lgkmcnt(0)
s_barrier
v_accvgpr_read_b32 v6, a228
v_accvgpr_read_b32 v7, a229
v_add_f32 v6, v6, v7
v_cmp_nge_f32 vcc, 0x6f800000, v6
v_rcp_f32 v6, v6
s_or_b64 s[34:35], s[34:35], vcc
v_mfma_f32_16x16x32_bf16 v[224:227], a[32:35], v[60:63], v[224:227]
ds_read_b128 a[32:35], v1 offset:0
v_exp_f32 v28, v28
v_mfma_f32_16x16x32_bf16 v[228:231], a[36:39], v[60:63], v[228:231]
ds_read_b128 a[36:39], v1 offset:1024
v_exp_f32 v29, v29
v_mfma_f32_16x16x32_bf16 v[232:235], a[40:43], v[60:63], v[232:235]
ds_read_b128 a[40:43], v1 offset:2048
v_exp_f32 v30, v30
v_mfma_f32_16x16x32_bf16 v[236:239], a[44:47], v[60:63], v[236:239]
ds_read_b128 a[44:47], v1 offset:3072
v_exp_f32 v31, v31
v_mfma_f32_16x16x32_bf16 v[240:243], a[48:51], v[60:63], v[240:243]
ds_read_b128 a[48:51], v1 offset:4096
v_exp_f32 v44, v44
v_mfma_f32_16x16x32_bf16 v[244:247], a[52:55], v[60:63], v[244:247]
ds_read_b128 a[52:55], v1 offset:5120
v_exp_f32 v45, v45
v_mfma_f32_16x16x32_bf16 v[248:251], a[56:59], v[60:63], v[248:251]
ds_read_b128 a[56:59], v1 offset:6144
v_exp_f32 v46, v46
v_mfma_f32_16x16x32_bf16 v[252:255], a[60:63], v[60:63], v[252:255]
ds_read_b128 a[60:63], v1 offset:7168
v_exp_f32 v47, v47
v_mfma_f32_16x16x32_bf16 a[228:231], a[236:239], v[60:63], a[228:231]
v_cvt_pk_bf16_f32 v76, v28, v29
v_cvt_pk_bf16_f32 v77, v30, v31
v_cvt_pk_bf16_f32 v78, v44, v45
v_cvt_pk_bf16_f32 v79, v46, v47
s_add_u32 s8, s30, 0x0
v_pk_mul_f32 v[192:193], v[192:193], v[6:7] op_sel_hi:[1,0]
v_pk_mul_f32 v[194:195], v[194:195], v[6:7] op_sel_hi:[1,0]
v_pk_mul_f32 v[196:197], v[196:197], v[6:7] op_sel_hi:[1,0]
v_pk_mul_f32 v[198:199], v[198:199], v[6:7] op_sel_hi:[1,0]
v_cvt_pk_bf16_f32 v192, v192, v193
v_cvt_pk_bf16_f32 v193, v194, v195
v_cvt_pk_bf16_f32 v194, v196, v197
v_cvt_pk_bf16_f32 v195, v198, v199
buffer_store_dwordx4 v[192:195], v3, s[88:91], s8 offen sc1
s_add_u32 s8, s30, 0x2000
v_pk_mul_f32 v[200:201], v[200:201], v[6:7] op_sel_hi:[1,0]
v_pk_mul_f32 v[202:203], v[202:203], v[6:7] op_sel_hi:[1,0]
v_pk_mul_f32 v[204:205], v[204:205], v[6:7] op_sel_hi:[1,0]
v_pk_mul_f32 v[206:207], v[206:207], v[6:7] op_sel_hi:[1,0]
v_cvt_pk_bf16_f32 v200, v200, v201
v_cvt_pk_bf16_f32 v201, v202, v203
v_cvt_pk_bf16_f32 v202, v204, v205
v_cvt_pk_bf16_f32 v203, v206, v207
buffer_store_dwordx4 v[200:203], v3, s[88:91], s8 offen sc1
s_waitcnt lgkmcnt(0)
v_mfma_f32_16x16x32_bf16 v[224:227], a[32:35], v[76:79], v[224:227]
s_add_u32 s8, s30, 0x4000
v_mul_f32 v208, v6, v208
v_mfma_f32_16x16x32_bf16 v[228:231], a[36:39], v[76:79], v[228:231]
v_mul_f32 v209, v6, v209
v_mul_f32 v210, v6, v210
v_mfma_f32_16x16x32_bf16 v[232:235], a[40:43], v[76:79], v[232:235]
v_mul_f32 v211, v6, v211
v_mul_f32 v212, v6, v212
v_mfma_f32_16x16x32_bf16 v[236:239], a[44:47], v[76:79], v[236:239]
v_mul_f32 v213, v6, v213
v_mul_f32 v214, v6, v214
v_mfma_f32_16x16x32_bf16 v[240:243], a[48:51], v[76:79], v[240:243]
v_mul_f32 v215, v6, v215
v_cvt_pk_bf16_f32 v208, v208, v209
v_mfma_f32_16x16x32_bf16 v[244:247], a[52:55], v[76:79], v[244:247]
v_cvt_pk_bf16_f32 v209, v210, v211
v_cvt_pk_bf16_f32 v210, v212, v213
v_mfma_f32_16x16x32_bf16 v[248:251], a[56:59], v[76:79], v[248:251]
v_cvt_pk_bf16_f32 v211, v214, v215
buffer_store_dwordx4 v[208:211], v3, s[88:91], s8 offen sc1
v_mfma_f32_16x16x32_bf16 v[252:255], a[60:63], v[76:79], v[252:255]
s_add_u32 s8, s30, 0x6000
v_mul_f32 v216, v6, v216
v_mfma_f32_16x16x32_bf16 a[228:231], a[236:239], v[76:79], a[228:231]
v_mul_f32 v217, v6, v217
v_mul_f32 v218, v6, v218
v_mul_f32 v219, v6, v219
v_mul_f32 v220, v6, v220
v_mul_f32 v221, v6, v221
v_mul_f32 v222, v6, v222
v_mul_f32 v223, v6, v223
v_cvt_pk_bf16_f32 v216, v216, v217
v_cvt_pk_bf16_f32 v217, v218, v219
v_cvt_pk_bf16_f32 v218, v220, v221
v_cvt_pk_bf16_f32 v219, v222, v223
buffer_store_dwordx4 v[216:219], v3, s[88:91], s8 offen sc1
s_branch L_att_fin
L_att_sh0_1:
v_mfma_f32_16x16x32_bf16 v[192:195], a[32:35], v[56:59], v[192:195]
ds_read_b128 a[0:3], v1 offset:8192
v_cvt_pk_bf16_f32 v72, v24, v25
v_mfma_f32_16x16x32_bf16 v[224:227], a[32:35], v[60:63], v[224:227]
ds_read_b128 a[4:7], v1 offset:9216
v_cvt_pk_bf16_f32 v73, v26, v27
v_mfma_f32_16x16x32_bf16 v[228:231], a[36:39], v[60:63], v[228:231]
v_exp_f32 v30, v30
v_mfma_f32_16x16x32_bf16 v[196:199], a[36:39], v[56:59], v[196:199]
buffer_load_dword v14, v15, s[84:87], 0 offen offset:192 sc1
v_mfma_f32_16x16x32_bf16 v[200:203], a[40:43], v[56:59], v[200:203]
ds_read_b128 a[8:11], v1 offset:10240
v_cvt_pk_bf16_f32 v76, v28, v29
v_mfma_f32_16x16x32_bf16 v[232:235], a[40:43], v[60:63], v[232:235]
ds_read_b128 a[12:15], v1 offset:11264
v_mfma_f32_16x16x32_bf16 v[236:239], a[44:47], v[60:63], v[236:239]
s_add_u32 m0, s17, 0x10000
v_exp_f32 v31, v31
v_mfma_f32_16x16x32_bf16 v[204:207], a[44:47], v[56:59], v[204:207]
ds_read_b128 a[16:19], v1 offset:12288
v_cvt_pk_bf16_f32 v77, v30, v31
v_mfma_f32_16x16x32_bf16 v[208:211], a[48:51], v[56:59], v[208:211]
ds_read_b128 a[20:23], v1 offset:13312
v_mfma_f32_16x16x32_bf16 v[240:243], a[48:51], v[60:63], v[240:243]
buffer_load_dwordx4 v12, s[72:75], 0 offen lds
v_mfma_f32_16x16x32_bf16 v[244:247], a[52:55], v[60:63], v[244:247]
ds_read_b128 a[24:27], v1 offset:14336
v_exp_f32 v40, v40
v_mfma_f32_16x16x32_bf16 v[212:215], a[52:55], v[56:59], v[212:215]
v_exp_f32 v41, v41
v_mfma_f32_16x16x32_bf16 v[216:219], a[56:59], v[56:59], v[216:219]
ds_read_b128 a[28:31], v1 offset:15360
v_exp_f32 v42, v42
v_mfma_f32_16x16x32_bf16 v[248:251], a[56:59], v[60:63], v[248:251]
v_exp_f32 v43, v43
v_mfma_f32_16x16x32_bf16 v[252:255], a[60:63], v[60:63], v[252:255]
ds_read_b128 a[32:35], v1 offset:0
v_cvt_pk_bf16_f32 v74, v40, v41
v_mfma_f32_16x16x32_bf16 v[220:223], a[60:63], v[56:59], v[220:223]
buffer_load_dwordx4 v13, s[72:75], 0 offen offset:1024 lds
v_smfmac_f32_16x16x64_bf16 a[228:231], a[232:235], v[56:63], v9
ds_read_b128 a[36:39], v1 offset:1024
s_waitcnt lgkmcnt(6)
v_mfma_f32_16x16x32_bf16 v[24:27], a[0:3], a[192:195], v[88:91]
ds_read_b128 a[40:43], v1 offset:2048
v_exp_f32 v44, v44
v_mfma_f32_16x16x32_bf16 v[24:27], a[4:7], a[196:199], v[24:27]
v_exp_f32 v45, v45
v_mfma_f32_16x16x32_bf16 v[24:27], a[8:11], a[200:203], v[24:27]
ds_read_b128 a[44:47], v1 offset:3072
v_exp_f32 v46, v46
v_mfma_f32_16x16x32_bf16 v[24:27], a[12:15], a[204:207], v[24:27]
v_exp_f32 v47, v47
v_mfma_f32_16x16x32_bf16 v[28:31], a[0:3], a[208:211], v[92:95]
buffer_load_dwordx4 v12, s[72:75], s12 offen offset:2048 lds
v_mfma_f32_16x16x32_bf16 v[28:31], a[4:7], a[212:215], v[28:31]
ds_read_b128 a[48:51], v1 offset:4096
v_cvt_pk_bf16_f32 v75, v42, v43
v_mfma_f32_16x16x32_bf16 v[28:31], a[8:11], a[216:219], v[28:31]
ds_read_b128 a[52:55], v1 offset:5120
v_cvt_pk_bf16_f32 v78, v44, v45
v_mfma_f32_16x16x32_bf16 v[28:31], a[12:15], a[220:223], v[28:31]
ds_read_b128 a[56:59], v1 offset:6144
s_waitcnt lgkmcnt(7)
v_mfma_f32_16x16x32_bf16 v[40:43], a[16:19], a[192:195], v[88:91]
v_exp_f32 v24, v24
v_mfma_f32_16x16x32_bf16 v[40:43], a[20:23], a[196:199], v[40:43]
ds_read_b128 a[60:63], v1 offset:7168
v_cvt_pk_bf16_f32 v79, v46, v47
v_mfma_f32_16x16x32_bf16 v[40:43], a[24:27], a[200:203], v[40:43]
buffer_load_dwordx4 v13, s[72:75], s12 offen offset:3072 lds
v_mfma_f32_16x16x32_bf16 v[40:43], a[28:31], a[204:207], v[40:43]
v_exp_f32 v25, v25
v_mfma_f32_16x16x32_bf16 v[44:47], a[16:19], a[208:211], v[92:95]
v_exp_f32 v26, v26
v_mfma_f32_16x16x32_bf16 v[44:47], a[20:23], a[212:215], v[44:47]
v_exp_f32 v27, v27
v_mfma_f32_16x16x32_bf16 v[44:47], a[24:27], a[216:219], v[44:47]
v_exp_f32 v28, v28
v_mfma_f32_16x16x32_bf16 v[44:47], a[28:31], a[220:223], v[44:47]
s_waitcnt lgkmcnt(0)
v_exp_f32 v29, v29
v_mfma_f32_16x16x32_bf16 v[192:195], a[32:35], v[72:75], v[192:195]
ds_read_b128 a[0:3], v1 offset:24576
v_cvt_pk_bf16_f32 v56, v24, v25
v_mfma_f32_16x16x32_bf16 v[224:227], a[32:35], v[76:79], v[224:227]
ds_read_b128 a[4:7], v1 offset:25600
v_add_u32 v12, 0x20000, v12
v_mfma_f32_16x16x32_bf16 v[228:231], a[36:39], v[76:79], v[228:231]
s_add_u32 m0, s17, 0x14000
v_exp_f32 v30, v30
v_mfma_f32_16x16x32_bf16 v[196:199], a[36:39], v[72:75], v[196:199]
buffer_load_dwordx4 v12, s[72:75], 0 offen lds
v_mfma_f32_16x16x32_bf16 v[200:203], a[40:43], v[72:75], v[200:203]
ds_read_b128 a[8:11], v1 offset:26624
v_cvt_pk_bf16_f32 v57, v26, v27
v_mfma_f32_16x16x32_bf16 v[232:235], a[40:43], v[76:79], v[232:235]
ds_read_b128 a[12:15], v1 offset:27648
v_cvt_pk_bf16_f32 v60, v28, v29
v_mfma_f32_16x16x32_bf16 v[236:239], a[44:47], v[76:79], v[236:239]
v_exp_f32 v31, v31
v_mfma_f32_16x16x32_bf16 v[204:207], a[44:47], v[72:75], v[204:207]
ds_read_b128 a[16:19], v1 offset:28672
v_cvt_pk_bf16_f32 v61, v30, v31
v_mfma_f32_16x16x32_bf16 v[208:211], a[48:51], v[72:75], v[208:211]
v_exp_f32 v40, v40
v_mfma_f32_16x16x32_bf16 v[240:243], a[48:51], v[76:79], v[240:243]
ds_read_b128 a[20:23], v1 offset:29696
v_mfma_f32_16x16x32_bf16 v[244:247], a[52:55], v[76:79], v[244:247]
ds_read_b128 a[24:27], v1 offset:30720
v_add_u32 v13, 0x20000, v13
v_mfma_f32_16x16x32_bf16 v[212:215], a[52:55], v[72:75], v[212:215]
buffer_load_dwordx4 v13, s[72:75], 0 offen offset:1024 lds
v_mfma_f32_16x16x32_bf16 v[216:219], a[56:59], v[72:75], v[216:219]
ds_read_b128 a[28:31], v1 offset:31744
v_mfma_f32_16x16x32_bf16 v[248:251], a[56:59], v[76:79], v[248:251]
v_exp_f32 v41, v41
v_mfma_f32_16x16x32_bf16 v[252:255], a[60:63], v[76:79], v[252:255]
ds_read_b128 a[32:35], v1 offset:16384
v_cvt_pk_bf16_f32 v58, v40, v41
v_mfma_f32_16x16x32_bf16 v[220:223], a[60:63], v[72:75], v[220:223]
s_waitcnt lgkmcnt(5)
v_exp_f32 v42, v42
v_smfmac_f32_16x16x64_bf16 a[228:231], a[232:235], v[72:79], v9
ds_read_b128 a[36:39], v1 offset:17408
v_exp_f32 v43, v43
v_mfma_f32_16x16x32_bf16 v[24:27], a[0:3], a[192:195], v[112:115]
v_exp_f32 v44, v44
v_mfma_f32_16x16x32_bf16 v[24:27], a[4:7], a[196:199], v[24:27]
buffer_load_dwordx4 v12, s[72:75], s12 offen offset:2048 lds
v_mfma_f32_16x16x32_bf16 v[24:27], a[8:11], a[200:203], v[24:27]
ds_read_b128 a[40:43], v1 offset:18432
v_cvt_pk_bf16_f32 v59, v42, v43
v_mfma_f32_16x16x32_bf16 v[24:27], a[12:15], a[204:207], v[24:27]
ds_read_b128 a[44:47], v1 offset:19456
v_exp_f32 v45, v45
v_mfma_f32_16x16x32_bf16 v[28:31], a[0:3], a[208:211], v[92:95]
ds_read_b128 a[48:51], v1 offset:20480
v_exp_f32 v46, v46
v_mfma_f32_16x16x32_bf16 v[28:31], a[4:7], a[212:215], v[28:31]
v_exp_f32 v47, v47
v_mfma_f32_16x16x32_bf16 v[28:31], a[8:11], a[216:219], v[28:31]
ds_read_b128 a[52:55], v1 offset:21504
v_cvt_pk_bf16_f32 v62, v44, v45
v_mfma_f32_16x16x32_bf16 v[28:31], a[12:15], a[220:223], v[28:31]
s_waitcnt lgkmcnt(6)
v_exp_f32 v24, v24
v_mfma_f32_16x16x32_bf16 v[40:43], a[16:19], a[192:195], v[116:119]
ds_read_b128 a[56:59], v1 offset:22528
v_cvt_pk_bf16_f32 v63, v46, v47
v_mfma_f32_16x16x32_bf16 v[40:43], a[20:23], a[196:199], v[40:43]
buffer_load_dwordx4 v13, s[72:75], s12 offen offset:3072 lds
v_mfma_f32_16x16x32_bf16 v[40:43], a[24:27], a[200:203], v[40:43]
ds_read_b128 a[60:63], v1 offset:23552
v_xor_b32 v1, 0x8000, v1
v_mfma_f32_16x16x32_bf16 v[40:43], a[28:31], a[204:207], v[40:43]
v_exp_f32 v25, v25
v_mfma_f32_16x16x32_bf16 v[44:47], a[16:19], a[208:211], v[92:95]
v_exp_f32 v26, v26
v_mfma_f32_16x16x32_bf16 v[44:47], a[20:23], a[212:215], v[44:47]
v_exp_f32 v27, v27
v_mfma_f32_16x16x32_bf16 v[44:47], a[24:27], a[216:219], v[44:47]
v_exp_f32 v28, v28
v_mfma_f32_16x16x32_bf16 v[44:47], a[28:31], a[220:223], v[44:47]
v_exp_f32 v29, v29
L_att_h1_1:
s_waitcnt vmcnt(8) lgkmcnt(0)
s_mov_b32 s92, 200000
L_spin_b1:
v_cmp_gt_u32 vcc, 32, v14
s_nop 4
s_cbranch_vccz L_spun_b1
s_sub_u32 s92, s92, 1
s_cbranch_scc1 L_spun_b1
s_sleep 6
buffer_load_dword v14, v15, s[84:87], 0 offen offset:192 sc1
s_waitcnt vmcnt(0)
s_branch L_spin_b1
L_spun_b1:
s_barrier
v_mfma_f32_16x16x32_bf16 v[192:195], a[32:35], v[56:59], v[192:195]
ds_read_b128 a[0:3], v2 offset:8192
v_cvt_pk_bf16_f32 v72, v24, v25
v_mfma_f32_16x16x32_bf16 v[224:227], a[32:35], v[60:63], v[224:227]
ds_read_b128 a[4:7], v2 offset:9216
v_cvt_pk_bf16_f32 v73, v26, v27
v_mfma_f32_16x16x32_bf16 v[228:231], a[36:39], v[60:63], v[228:231]
s_add_u32 s101, s101, 0x2000
v_exp_f32 v30, v30
v_mfma_f32_16x16x32_bf16 v[196:199], a[36:39], v[56:59], v[196:199]
buffer_load_dwordx4 a[64:67], v3, s[88:91], s101 offen sc1
v_mfma_f32_16x16x32_bf16 v[200:203], a[40:43], v[56:59], v[200:203]
ds_read_b128 a[8:11], v2 offset:10240
v_cvt_pk_bf16_f32 v76, v28, v29
v_mfma_f32_16x16x32_bf16 v[232:235], a[40:43], v[60:63], v[232:235]
buffer_load_dwordx4 a[68:71], v3, s[88:91], s101 offen offset:1024 sc1
v_mfma_f32_16x16x32_bf16 v[236:239], a[44:47], v[60:63], v[236:239]
ds_read_b128 a[12:15], v2 offset:11264
v_exp_f32 v31, v31
v_mfma_f32_16x16x32_bf16 v[204:207], a[44:47], v[56:59], v[204:207]
buffer_load_dwordx4 a[72:75], v3, s[88:91], s101 offen offset:2048 sc1
v_mfma_f32_16x16x32_bf16 v[208:211], a[48:51], v[56:59], v[208:211]
ds_read_b128 a[16:19], v2 offset:12288
v_exp_f32 v40, v40
v_mfma_f32_16x16x32_bf16 v[240:243], a[48:51], v[60:63], v[240:243]
buffer_load_dwordx4 a[76:79], v3, s[88:91], s101 offen offset:3072 sc1
v_mfma_f32_16x16x32_bf16 v[244:247], a[52:55], v[60:63], v[244:247]
ds_read_b128 a[20:23], v2 offset:13312
v_exp_f32 v41, v41
v_mfma_f32_16x16x32_bf16 v[212:215], a[52:55], v[56:59], v[212:215]
ds_read_b128 a[24:27], v2 offset:14336
v_exp_f32 v42, v42
v_mfma_f32_16x16x32_bf16 v[216:219], a[56:59], v[56:59], v[216:219]
ds_read_b128 a[28:31], v2 offset:15360
s_add_u32 s101, s101, 0x2000
v_mfma_f32_16x16x32_bf16 v[248:251], a[56:59], v[60:63], v[248:251]
buffer_load_dwordx4 a[80:83], v3, s[88:91], s101 offen sc1
v_mfma_f32_16x16x32_bf16 v[252:255], a[60:63], v[60:63], v[252:255]
ds_read_b128 a[32:35], v2 offset:0
v_cvt_pk_bf16_f32 v77, v30, v31
v_mfma_f32_16x16x32_bf16 v[220:223], a[60:63], v[56:59], v[220:223]
ds_read_b128 a[36:39], v2 offset:1024
s_waitcnt lgkmcnt(6)
v_smfmac_f32_16x16x64_bf16 a[228:231], a[232:235], v[56:63], v9
buffer_load_dwordx4 a[84:87], v3, s[88:91], s101 offen offset:1024 sc1
v_mfma_f32_16x16x32_bf16 v[28:31], a[0:3], a[208:211], v[120:123]
ds_read_b128 a[40:43], v2 offset:2048
v_exp_f32 v43, v43
v_mfma_f32_16x16x32_bf16 v[28:31], a[4:7], a[212:215], v[28:31]
ds_read_b128 a[44:47], v2 offset:3072
v_exp_f32 v44, v44
v_mfma_f32_16x16x32_bf16 v[28:31], a[8:11], a[216:219], v[28:31]
buffer_load_dwordx4 a[88:91], v3, s[88:91], s101 offen offset:2048 sc1
v_mfma_f32_16x16x32_bf16 v[28:31], a[12:15], a[220:223], v[28:31]
ds_read_b128 a[48:51], v2 offset:4096
s_waitcnt lgkmcnt(5)
v_exp_f32 v45, v45
v_exp_f32 v46, v46
v_exp_f32 v47, v47
v_cvt_pk_bf16_f32 v78, v44, v45
v_cvt_pk_bf16_f32 v79, v46, v47
v_mfma_f32_16x16x32_bf16 v[44:47], a[16:19], a[208:211], v[124:127]
ds_read_b128 a[52:55], v2 offset:5120
v_cvt_pk_bf16_f32 v74, v40, v41
v_mfma_f32_16x16x32_bf16 v[44:47], a[20:23], a[212:215], v[44:47]
buffer_load_dwordx4 a[92:95], v3, s[88:91], s101 offen offset:3072 sc1
v_mfma_f32_16x16x32_bf16 v[44:47], a[24:27], a[216:219], v[44:47]
ds_read_b128 a[56:59], v2 offset:6144
v_cvt_pk_bf16_f32 v75, v42, v43
v_mfma_f32_16x16x32_bf16 v[44:47], a[28:31], a[220:223], v[44:47]
ds_read_b128 a[60:63], v2 offset:7168
s_waitcnt lgkmcnt(0)
v_mfma_f32_16x16x32_bf16 v[192:195], a[32:35], v[72:75], v[192:195]
s_add_u32 s101, s101, 0x2000
v_exp_f32 v28, v28
v_mfma_f32_16x16x32_bf16 v[224:227], a[32:35], v[76:79], v[224:227]
buffer_load_dwordx4 a[96:99], v3, s[88:91], s101 offen sc1
v_mfma_f32_16x16x32_bf16 v[228:231], a[36:39], v[76:79], v[228:231]
ds_read_b128 a[32:35], v2 offset:16384
v_exp_f32 v29, v29
v_mfma_f32_16x16x32_bf16 v[196:199], a[36:39], v[72:75], v[196:199]
buffer_load_dwordx4 a[100:103], v3, s[88:91], s101 offen offset:1024 sc1
v_mfma_f32_16x16x32_bf16 v[200:203], a[40:43], v[72:75], v[200:203]
ds_read_b128 a[36:39], v2 offset:17408
v_exp_f32 v30, v30
v_mfma_f32_16x16x32_bf16 v[232:235], a[40:43], v[76:79], v[232:235]
buffer_load_dwordx4 a[104:107], v3, s[88:91], s101 offen offset:2048 sc1
v_mfma_f32_16x16x32_bf16 v[236:239], a[44:47], v[76:79], v[236:239]
ds_read_b128 a[40:43], v2 offset:18432
v_cvt_pk_bf16_f32 v60, v28, v29
v_mfma_f32_16x16x32_bf16 v[204:207], a[44:47], v[72:75], v[204:207]
buffer_load_dwordx4 a[108:111], v3, s[88:91], s101 offen offset:3072 sc1
v_mfma_f32_16x16x32_bf16 v[208:211], a[48:51], v[72:75], v[208:211]
ds_read_b128 a[44:47], v2 offset:19456
s_add_u32 s101, s101, 0x2000
v_mfma_f32_16x16x32_bf16 v[240:243], a[48:51], v[76:79], v[240:243]
buffer_load_dwordx4 a[112:115], v3, s[88:91], s101 offen sc1
v_mfma_f32_16x16x32_bf16 v[244:247], a[52:55], v[76:79], v[244:247]
ds_read_b128 a[48:51], v2 offset:20480
v_exp_f32 v31, v31
v_mfma_f32_16x16x32_bf16 v[212:215], a[52:55], v[72:75], v[212:215]
buffer_load_dwordx4 a[116:119], v3, s[88:91], s101 offen offset:1024 sc1
v_mfma_f32_16x16x32_bf16 v[216:219], a[56:59], v[72:75], v[216:219]
ds_read_b128 a[52:55], v2 offset:21504
v_exp_f32 v44, v44
v_mfma_f32_16x16x32_bf16 v[248:251], a[56:59], v[76:79], v[248:251]
buffer_load_dwordx4 a[120:123], v3, s[88:91], s101 offen offset:2048 sc1
v_mfma_f32_16x16x32_bf16 v[252:255], a[60:63], v[76:79], v[252:255]
buffer_load_dwordx4 a[124:127], v3, s[88:91], s101 offen offset:3072 sc1
v_mfma_f32_16x16x32_bf16 v[220:223], a[60:63], v[72:75], v[220:223]
ds_read_b128 a[56:59], v2 offset:22528
v_cvt_pk_bf16_f32 v61, v30, v31
v_smfmac_f32_16x16x64_bf16 a[228:231], a[232:235], v[72:79], v9
ds_read_b128 a[60:63], v2 offset:23552
v_xor_b32 v2, 0x38000, v2
v_exp_f32 v45, v45
v_exp_f32 v46, v46
v_exp_f32 v47, v47
v_cvt_pk_bf16_f32 v62, v44, v45
v_cvt_pk_bf16_f32 v63, v46, v47
s_waitcnt lgkmcnt(0)
s_barrier
v_accvgpr_read_b32 v6, a228
v_accvgpr_read_b32 v7, a229
v_add_f32 v6, v6, v7
v_cmp_nge_f32 vcc, 0x6f800000, v6
v_rcp_f32 v6, v6
s_or_b64 s[34:35], s[34:35], vcc
v_mfma_f32_16x16x32_bf16 v[224:227], a[32:35], v[60:63], v[224:227]
s_add_u32 s8, s30, 0x0
v_mul_f32 v192, v6, v192
v_mfma_f32_16x16x32_bf16 v[228:231], a[36:39], v[60:63], v[228:231]
v_mul_f32 v193, v6, v193
v_mul_f32 v194, v6, v194
v_mfma_f32_16x16x32_bf16 v[232:235], a[40:43], v[60:63], v[232:235]
v_mul_f32 v195, v6, v195
v_mul_f32 v196, v6, v196
v_mfma_f32_16x16x32_bf16 v[236:239], a[44:47], v[60:63], v[236:239]
v_mul_f32 v197, v6, v197
v_mul_f32 v198, v6, v198
v_mfma_f32_16x16x32_bf16 v[240:243], a[48:51], v[60:63], v[240:243]
v_mul_f32 v199, v6, v199
v_cvt_pk_bf16_f32 v192, v192, v193
v_mfma_f32_16x16x32_bf16 v[244:247], a[52:55], v[60:63], v[244:247]
v_cvt_pk_bf16_f32 v193, v194, v195
v_cvt_pk_bf16_f32 v194, v196, v197
v_mfma_f32_16x16x32_bf16 v[248:251], a[56:59], v[60:63], v[248:251]
v_cvt_pk_bf16_f32 v195, v198, v199
buffer_store_dwordx4 v[192:195], v3, s[88:91], s8 offen sc1
v_mfma_f32_16x16x32_bf16 v[252:255], a[60:63], v[60:63], v[252:255]
v_mfma_f32_16x16x32_bf16 a[228:231], a[236:239], v[60:63], a[228:231]
s_add_u32 s8, s30, 0x2000
v_pk_mul_f32 v[200:201], v[200:201], v[6:7] op_sel_hi:[1,0]
v_pk_mul_f32 v[202:203], v[202:203], v[6:7] op_sel_hi:[1,0]
v_pk_mul_f32 v[204:205], v[204:205], v[6:7] op_sel_hi:[1,0]
v_pk_mul_f32 v[206:207], v[206:207], v[6:7] op_sel_hi:[1,0]
v_cvt_pk_bf16_f32 v200, v200, v201
v_cvt_pk_bf16_f32 v201, v202, v203
v_cvt_pk_bf16_f32 v202, v204, v205
v_cvt_pk_bf16_f32 v203, v206, v207
buffer_store_dwordx4 v[200:203], v3, s[88:91], s8 offen sc1
s_add_u32 s8, s30, 0x4000
v_pk_mul_f32 v[208:209], v[208:209], v[6:7] op_sel_hi:[1,0]
v_pk_mul_f32 v[210:211], v[210:211], v[6:7] op_sel_hi:[1,0]
v_pk_mul_f32 v[212:213], v[212:213], v[6:7] op_sel_hi:[1,0]
v_pk_mul_f32 v[214:215], v[214:215], v[6:7] op_sel_hi:[1,0]
v_cvt_pk_bf16_f32 v208, v208, v209
v_cvt_pk_bf16_f32 v209, v210, v211
v_cvt_pk_bf16_f32 v210, v212, v213
v_cvt_pk_bf16_f32 v211, v214, v215
buffer_store_dwordx4 v[208:211], v3, s[88:91], s8 offen sc1
s_add_u32 s8, s30, 0x6000
v_pk_mul_f32 v[216:217], v[216:217], v[6:7] op_sel_hi:[1,0]
v_pk_mul_f32 v[218:219], v[218:219], v[6:7] op_sel_hi:[1,0]
v_pk_mul_f32 v[220:221], v[220:221], v[6:7] op_sel_hi:[1,0]
v_pk_mul_f32 v[222:223], v[222:223], v[6:7] op_sel_hi:[1,0]
v_cvt_pk_bf16_f32 v216, v216, v217
v_cvt_pk_bf16_f32 v217, v218, v219
v_cvt_pk_bf16_f32 v218, v220, v221
v_cvt_pk_bf16_f32 v219, v222, v223
buffer_store_dwordx4 v[216:219], v3, s[88:91], s8 offen sc1
L_hopC:
s_mov_b32 s95, 1
s_bitcmp1_b32 s4, 0
s_cbranch_scc1 L_padC1
s_branch L_padC0
L_hopC_ret:
s_mov_b32 s95, 0
L_att_fin:
v_accvgpr_read_b32 v6, a230
v_accvgpr_read_b32 v7, a231
v_add_f32 v6, v6, v7
v_cmp_nge_f32 vcc, 0x6f800000, v6
v_rcp_f32 v6, v6
s_or_b64 s[34:35], s[34:35], vcc
s_add_u32 s8, s31, 0x0
v_pk_mul_f32 v[224:225], v[224:225], v[6:7] op_sel_hi:[1,0]
v_pk_mul_f32 v[226:227], v[226:227], v[6:7] op_sel_hi:[1,0]
v_pk_mul_f32 v[228:229], v[228:229], v[6:7] op_sel_hi:[1,0]
v_pk_mul_f32 v[230:231], v[230:231], v[6:7] op_sel_hi:[1,0]
v_cvt_pk_bf16_f32 v224, v224, v225
v_cvt_pk_bf16_f32 v225, v226, v227
v_cvt_pk_bf16_f32 v226, v228, v229
v_cvt_pk_bf16_f32 v227, v230, v231
buffer_store_dwordx4 v[224:227], v3, s[88:91], s8 offen sc1
s_add_u32 s8, s31, 0x2000
v_pk_mul_f32 v[232:233], v[232:233], v[6:7] op_sel_hi:[1,0]
v_pk_mul_f32 v[234:235], v[234:235], v[6:7] op_sel_hi:[1,0]
v_pk_mul_f32 v[236:237], v[236:237], v[6:7] op_sel_hi:[1,0]
v_pk_mul_f32 v[238:239], v[238:239], v[6:7] op_sel_hi:[1,0]
v_cvt_pk_bf16_f32 v232, v232, v233
v_cvt_pk_bf16_f32 v233, v234, v235
v_cvt_pk_bf16_f32 v234, v236, v237
v_cvt_pk_bf16_f32 v235, v238, v239
buffer_store_dwordx4 v[232:235], v3, s[88:91], s8 offen sc1
s_add_u32 s8, s31, 0x4000
v_pk_mul_f32 v[240:241], v[240:241], v[6:7] op_sel_hi:[1,0]
v_pk_mul_f32 v[242:243], v[242:243], v[6:7] op_sel_hi:[1,0]
v_pk_mul_f32 v[244:245], v[244:245], v[6:7] op_sel_hi:[1,0]
v_pk_mul_f32 v[246:247], v[246:247], v[6:7] op_sel_hi:[1,0]
v_cvt_pk_bf16_f32 v240, v240, v241
v_cvt_pk_bf16_f32 v241, v242, v243
v_cvt_pk_bf16_f32 v242, v244, v245
v_cvt_pk_bf16_f32 v243, v246, v247
buffer_store_dwordx4 v[240:243], v3, s[88:91], s8 offen sc1
s_add_u32 s8, s31, 0x6000
v_pk_mul_f32 v[248:249], v[248:249], v[6:7] op_sel_hi:[1,0]
v_pk_mul_f32 v[250:251], v[250:251], v[6:7] op_sel_hi:[1,0]
v_pk_mul_f32 v[252:253], v[252:253], v[6:7] op_sel_hi:[1,0]
v_pk_mul_f32 v[254:255], v[254:255], v[6:7] op_sel_hi:[1,0]
v_cvt_pk_bf16_f32 v248, v248, v249
v_cvt_pk_bf16_f32 v249, v250, v251
v_cvt_pk_bf16_f32 v250, v252, v253
v_cvt_pk_bf16_f32 v251, v254, v255
buffer_store_dwordx4 v[248:251], v3, s[88:91], s8 offen sc1
s_cmp_lg_u64 s[34:35], 0
s_cselect_b32 s8, 1, 0
s_lshl_b32 s9, s4, 2
s_add_u32 s9, s9, 24576
v_mov_b32 v4, s9
v_mov_b32 v5, s8
ds_write_b32 v4, v5
v_lshrrev_b32 v17, 4, v0
v_lshlrev_b32 v18, 10, v17
v_and_b32 v17, 1, v17
v_lshl_add_u32 v18, v17, 5, v18
v_bfe_u32 v17, v0, 2, 2
v_lshl_add_u32 v18, v17, 6, v18
v_and_b32 v17, 3, v0
v_lshl_add_u32 v4, v17, 3, v18
v_add_u32 v4, 65536, v4
v_xor_b32 v5, 32, v4
s_waitcnt vmcnt(16) lgkmcnt(0)
s_barrier
ds_read_b64_tr_b16 a[0:1], v4 offset:256
ds_read_b64_tr_b16 a[2:3], v4 offset:4352
ds_read_b64_tr_b16 a[4:5], v4 offset:8448
ds_read_b64_tr_b16 a[6:7], v4 offset:12544
ds_read_b64_tr_b16 a[8:9], v5 offset:256
ds_read_b64_tr_b16 a[10:11], v5 offset:4352
ds_read_b64_tr_b16 a[12:13], v5 offset:8448
ds_read_b64_tr_b16 a[14:15], v5 offset:12544
ds_read_b64_tr_b16 a[16:17], v4 offset:512
ds_read_b64_tr_b16 a[18:19], v4 offset:4608
ds_read_b64_tr_b16 a[20:21], v4 offset:8704
ds_read_b64_tr_b16 a[22:23], v4 offset:12800
v_and_b32 v17, 3, v0
v_lshlrev_b32 v17, 2, v17
v_add_u32 v17, 24576, v17
ds_read_b32 v18, v17
s_waitcnt lgkmcnt(0)
v_cmp_ne_u32 vcc, 0, v18
s_cmp_lg_u32 s33, 0
s_cbranch_scc1 L_att_done
s_nop 4
s_cbranch_vccnz L_att_fallback
L_att_done:
s_bitcmp1_b32 s2, 0
s_cbranch_scc1 L_p4_b
v_mfma_f32_16x16x32_bf16 v[160:163], a[0:3], a[64:67], 0
ds_read_b64_tr_b16 a[24:25], v5 offset:512
v_and_b32 v6, 15, v0
v_mfma_f32_16x16x32_bf16 v[160:163], a[4:7], a[80:83], v[160:163]
ds_read_b64_tr_b16 a[26:27], v5 offset:4608
s_add_u32 s101, s101, 0x2000
v_mfma_f32_16x16x32_bf16 v[168:171], a[4:7], a[84:87], 0
ds_read_b64_tr_b16 a[28:29], v5 offset:8704
v_lshlrev_b32 v6, 2, v6
v_mfma_f32_16x16x32_bf16 v[168:171], a[0:3], a[68:71], v[168:171]
ds_read_b64_tr_b16 a[30:31], v5 offset:12800
v_and_b32 v1, 28, v6
v_mfma_f32_16x16x32_bf16 v[176:179], a[0:3], a[72:75], 0
v_or_b32 v7, 16, v1
v_mfma_f32_16x16x32_bf16 v[176:179], a[4:7], a[88:91], v[176:179]
buffer_load_dwordx4 a[224:227], v3, s[88:91], s101 offen sc1
v_mfma_f32_16x16x32_bf16 v[184:187], a[4:7], a[92:95], 0
v_mfma_f32_16x16x32_bf16 v[184:187], a[0:3], a[76:79], v[184:187]
v_mfma_f32_16x16x32_bf16 v[188:191], a[8:11], a[76:79], 0
ds_read_b64_tr_b16 a[0:1], v4 offset:768
s_lshl_b32 s28, s99, 1
v_mfma_f32_16x16x32_bf16 v[188:191], a[12:15], a[92:95], v[188:191]
ds_read_b64_tr_b16 a[2:3], v4 offset:4864
s_and_b32 s9, s4, 1
v_mfma_f32_16x16x32_bf16 v[180:183], a[12:15], a[88:91], 0
buffer_load_dwordx4 a[228:231], v3, s[88:91], s101 offen offset:1024 sc1
v_mfma_f32_16x16x32_bf16 v[180:183], a[8:11], a[72:75], v[180:183]
ds_read_b64_tr_b16 a[4:5], v4 offset:8960
s_add_u32 s28, s28, s9
v_mfma_f32_16x16x32_bf16 v[172:175], a[8:11], a[68:71], 0
ds_read_b64_tr_b16 a[6:7], v4 offset:13056
s_lshl_b32 s9, s28, 8
v_mfma_f32_16x16x32_bf16 v[172:175], a[12:15], a[84:87], v[172:175]
s_add_u32 s9, s9, 0x3700000
s_lshl_b32 s28, s28, 17
s_lshl_b32 s10, s100, 8
v_mfma_f32_16x16x32_bf16 v[164:167], a[12:15], a[80:83], 0
s_waitcnt lgkmcnt(4)
s_add_u32 s28, s28, s10
s_lshl_b32 s10, s14, 6
v_mfma_f32_16x16x32_bf16 v[164:167], a[8:11], a[64:67], v[164:167]
buffer_load_dwordx4 a[232:235], v3, s[88:91], s101 offen offset:2048 sc1
v_mfma_f32_16x16x32_bf16 v[192:195], a[16:19], a[64:67], 0
ds_read_b64_tr_b16 a[8:9], v5 offset:768
s_add_u32 s28, s28, s10
v_mfma_f32_16x16x32_bf16 v[192:195], a[20:23], a[80:83], v[192:195]
ds_read_b64_tr_b16 a[10:11], v5 offset:4864
s_add_u32 s29, s28, 0x8000
v_mfma_f32_16x16x32_bf16 v[200:203], a[20:23], a[84:87], 0
ds_read_b64_tr_b16 a[12:13], v5 offset:8960
s_add_u32 s30, s28, 0x10000
v_mfma_f32_16x16x32_bf16 v[200:203], a[16:19], a[68:71], v[200:203]
ds_read_b64_tr_b16 a[14:15], v5 offset:13056
s_add_u32 s31, s28, 0x18000
v_mfma_f32_16x16x32_bf16 v[208:211], a[16:19], a[72:75], 0
buffer_load_dwordx4 a[236:239], v3, s[88:91], s101 offen offset:3072 sc1
v_mfma_f32_16x16x32_bf16 v[208:211], a[20:23], a[88:91], v[208:211]
s_add_u32 s101, s101, 0x2000
s_lshl_b32 s10, s2, 2
s_add_u32 s10, s10, s4
v_mfma_f32_16x16x32_bf16 v[216:219], a[20:23], a[92:95], 0
s_lshl_b32 s10, s10, 12
s_add_u32 s44, s10, 0x4800000
s_xor_b32 s52, s44, 0x4000
v_mfma_f32_16x16x32_bf16 v[216:219], a[16:19], a[76:79], v[216:219]
s_add_u32 s45, s10, 0x4c00000
s_xor_b32 s53, s45, 0x8000
s_add_u32 s46, s10, 0x5000000
v_mfma_f32_16x16x32_bf16 v[220:223], a[24:27], a[76:79], 0
ds_read_b64_tr_b16 a[16:17], v4 offset:0
s_xor_b32 s54, s46, 0xc000
v_mfma_f32_16x16x32_bf16 v[220:223], a[28:31], a[92:95], v[220:223]
ds_read_b64_tr_b16 a[18:19], v4 offset:4096
v_and_b32 v18, 16, v0
v_mfma_f32_16x16x32_bf16 v[212:215], a[28:31], a[88:91], 0
buffer_load_dwordx4 a[240:243], v3, s[88:91], s101 offen sc1
v_mfma_f32_16x16x32_bf16 v[212:215], a[24:27], a[72:75], v[212:215]
ds_read_b64_tr_b16 a[20:21], v4 offset:8192
v_lshrrev_b32 v19, 5, v0
v_mfma_f32_16x16x32_bf16 v[204:207], a[24:27], a[68:71], 0
ds_read_b64_tr_b16 a[22:23], v4 offset:12288
v_lshlrev_b32 v19, 4, v19
v_mfma_f32_16x16x32_bf16 v[204:207], a[28:31], a[84:87], v[204:207]
v_lshl_add_u32 v18, v18, 1, v19
v_lshl_add_u32 v2, v6, 9, v18
v_mfma_f32_16x16x32_bf16 v[196:199], a[28:31], a[80:83], 0
s_waitcnt lgkmcnt(4)
v_add_u32 v15, 0x10000, v4
v_add_u32 v19, 0x10000, v5
v_mfma_f32_16x16x32_bf16 v[196:199], a[24:27], a[64:67], v[196:199]
buffer_load_dwordx4 a[244:247], v3, s[88:91], s101 offen offset:1024 sc1
v_mfma_f32_16x16x32_bf16 v[224:227], a[0:3], a[64:67], 0
ds_read_b64_tr_b16 a[24:25], v5 offset:0
v_mfma_f32_16x16x32_bf16 v[224:227], a[4:7], a[80:83], v[224:227]
ds_read_b64_tr_b16 a[26:27], v5 offset:4096
v_mfma_f32_16x16x32_bf16 v[232:235], a[4:7], a[84:87], 0
ds_read_b64_tr_b16 a[28:29], v5 offset:8192
v_mfma_f32_16x16x32_bf16 v[232:235], a[0:3], a[68:71], v[232:235]
ds_read_b64_tr_b16 a[30:31], v5 offset:12288
v_mfma_f32_16x16x32_bf16 v[240:243], a[0:3], a[72:75], 0
buffer_load_dwordx4 a[248:251], v3, s[88:91], s101 offen offset:2048 sc1
v_mfma_f32_16x16x32_bf16 v[240:243], a[4:7], a[88:91], v[240:243]
v_mfma_f32_16x16x32_bf16 v[248:251], a[4:7], a[92:95], 0
s_waitcnt vmcnt(7)
v_mfma_f32_16x16x32_bf16 v[248:251], a[0:3], a[76:79], v[248:251]
s_barrier
s_cmp_lg_u32 s4, 0
s_cbranch_scc1 L_flag_seta
s_lshl_b32 s8, s6, 5
s_add_u32 s8, s8, s5
s_and_b32 s92, s8, 0xf8
s_mul_i32 s92, s92, 7
s_add_u32 s8, s8, s92
s_lshl_b32 s8, s8, 2
s_add_u32 s8, s8, 0x3704000
v_mov_b32 v17, 1
s_mov_b64 exec, 1
buffer_store_dword v17, off, s[88:91], s8 sc1
s_mov_b64 exec, -1
L_flag_seta:
v_mfma_f32_16x16x32_bf16 v[252:255], a[8:11], a[76:79], 0
ds_read_b64_tr_b16 a[0:1], v4 offset:16640
v_mfma_f32_16x16x32_bf16 v[252:255], a[12:15], a[92:95], v[252:255]
buffer_load_dwordx4 a[252:255], v3, s[88:91], s101 offen offset:3072 sc1
v_mfma_f32_16x16x32_bf16 v[244:247], a[12:15], a[88:91], 0
ds_read_b64_tr_b16 a[2:3], v4 offset:20736
s_add_u32 m0, s17, 0x24000
v_mfma_f32_16x16x32_bf16 v[244:247], a[8:11], a[72:75], v[244:247]
ds_read_b64_tr_b16 a[4:5], v4 offset:24832
v_add_u32 v12, 0x20000, v12
v_mfma_f32_16x16x32_bf16 v[236:239], a[8:11], a[68:71], 0
ds_read_b64_tr_b16 a[6:7], v4 offset:28928
v_mfma_f32_16x16x32_bf16 v[236:239], a[12:15], a[84:87], v[236:239]
v_mfma_f32_16x16x32_bf16 v[228:231], a[12:15], a[80:83], 0
buffer_load_dwordx4 v12, s[72:75], 0 offen lds
v_mfma_f32_16x16x32_bf16 v[228:231], a[8:11], a[64:67], v[228:231]
s_waitcnt lgkmcnt(4)
v_add_u32 v13, 0x20000, v13
v_mfma_f32_16x16x32_bf16 a[32:35], a[16:19], a[64:67], 0
ds_read_b64_tr_b16 a[8:9], v5 offset:16640
v_mfma_f32_16x16x32_bf16 a[32:35], a[20:23], a[80:83], a[32:35]
ds_read_b64_tr_b16 a[10:11], v5 offset:20736
v_mfma_f32_16x16x32_bf16 a[40:43], a[20:23], a[84:87], 0
ds_read_b64_tr_b16 a[12:13], v5 offset:24832
v_mfma_f32_16x16x32_bf16 a[40:43], a[16:19], a[68:71], a[40:43]
ds_read_b64_tr_b16 a[14:15], v5 offset:28928
v_mfma_f32_16x16x32_bf16 a[48:51], a[16:19], a[72:75], 0
buffer_load_dwordx4 v13, s[72:75], 0 offen offset:1024 lds
v_mfma_f32_16x16x32_bf16 a[48:51], a[20:23], a[88:91], a[48:51]
v_mfma_f32_16x16x32_bf16 v[152:155], a[20:23], a[92:95], 0
v_mfma_f32_16x16x32_bf16 v[152:155], a[16:19], a[76:79], v[152:155]
v_mfma_f32_16x16x32_bf16 v[156:159], a[24:27], a[76:79], 0
ds_read_b64_tr_b16 a[16:17], v4 offset:16896
v_mfma_f32_16x16x32_bf16 v[156:159], a[28:31], a[92:95], v[156:159]
buffer_load_dwordx4 v12, s[72:75], s12 offen offset:2048 lds
v_mfma_f32_16x16x32_bf16 a[52:55], a[28:31], a[88:91], 0
ds_read_b64_tr_b16 a[18:19], v4 offset:20992
v_mfma_f32_16x16x32_bf16 a[52:55], a[24:27], a[72:75], a[52:55]
ds_read_b64_tr_b16 a[20:21], v4 offset:25088
v_mfma_f32_16x16x32_bf16 a[44:47], a[24:27], a[68:71], 0
ds_read_b64_tr_b16 a[22:23], v4 offset:29184
v_mfma_f32_16x16x32_bf16 a[44:47], a[28:31], a[84:87], a[44:47]
v_mfma_f32_16x16x32_bf16 a[36:39], a[28:31], a[80:83], 0
buffer_load_dwordx4 v13, s[72:75], s12 offen offset:3072 lds
v_mfma_f32_16x16x32_bf16 a[36:39], a[24:27], a[64:67], a[36:39]
s_waitcnt lgkmcnt(4)
s_add_u32 s101, s101, 0x2000
v_mfma_f32_16x16x32_bf16 v[160:163], a[0:3], a[96:99], v[160:163]
ds_read_b64_tr_b16 a[24:25], v5 offset:16896
v_mfma_f32_16x16x32_bf16 v[160:163], a[4:7], a[112:115], v[160:163]
ds_read_b64_tr_b16 a[26:27], v5 offset:20992
v_mfma_f32_16x16x32_bf16 v[168:171], a[4:7], a[116:119], v[168:171]
ds_read_b64_tr_b16 a[28:29], v5 offset:25088
v_mfma_f32_16x16x32_bf16 v[168:171], a[0:3], a[100:103], v[168:171]
buffer_load_dwordx4 a[128:131], v3, s[88:91], s101 offen sc1
v_mfma_f32_16x16x32_bf16 v[176:179], a[0:3], a[104:107], v[176:179]
ds_read_b64_tr_b16 a[30:31], v5 offset:29184
v_mfma_f32_16x16x32_bf16 v[176:179], a[4:7], a[120:123], v[176:179]
v_mfma_f32_16x16x32_bf16 v[184:187], a[4:7], a[124:127], v[184:187]
v_mfma_f32_16x16x32_bf16 v[184:187], a[0:3], a[108:111], v[184:187]
v_mfma_f32_16x16x32_bf16 v[188:191], a[8:11], a[108:111], v[188:191]
buffer_load_dwordx4 a[132:135], v3, s[88:91], s101 offen offset:1024 sc1
v_mfma_f32_16x16x32_bf16 v[188:191], a[12:15], a[124:127], v[188:191]
ds_read_b64_tr_b16 a[0:1], v4 offset:17152
v_mfma_f32_16x16x32_bf16 v[180:183], a[12:15], a[120:123], v[180:183]
ds_read_b64_tr_b16 a[2:3], v4 offset:21248
v_mfma_f32_16x16x32_bf16 v[180:183], a[8:11], a[104:107], v[180:183]
ds_read_b64_tr_b16 a[4:5], v4 offset:25344
v_mfma_f32_16x16x32_bf16 v[172:175], a[8:11], a[100:103], v[172:175]
ds_read_b64_tr_b16 a[6:7], v4 offset:29440
v_mfma_f32_16x16x32_bf16 v[172:175], a[12:15], a[116:119], v[172:175]
v_mfma_f32_16x16x32_bf16 v[164:167], a[12:15], a[112:115], v[164:167]
buffer_load_dwordx4 a[136:139], v3, s[88:91], s101 offen offset:2048 sc1
v_mfma_f32_16x16x32_bf16 v[164:167], a[8:11], a[96:99], v[164:167]
s_waitcnt lgkmcnt(4)
v_mfma_f32_16x16x32_bf16 v[192:195], a[16:19], a[96:99], v[192:195]
ds_read_b64_tr_b16 a[8:9], v5 offset:17152
v_mfma_f32_16x16x32_bf16 v[192:195], a[20:23], a[112:115], v[192:195]
ds_read_b64_tr_b16 a[10:11], v5 offset:21248
v_mfma_f32_16x16x32_bf16 v[200:203], a[20:23], a[116:119], v[200:203]
ds_read_b64_tr_b16 a[12:13], v5 offset:25344
v_mfma_f32_16x16x32_bf16 v[200:203], a[16:19], a[100:103], v[200:203]
buffer_load_dwordx4 a[140:143], v3, s[88:91], s101 offen offset:3072 sc1
v_mfma_f32_16x16x32_bf16 v[208:211], a[16:19], a[104:107], v[208:211]
ds_read_b64_tr_b16 a[14:15], v5 offset:29440
s_add_u32 s101, s101, 0x2000
v_mfma_f32_16x16x32_bf16 v[208:211], a[20:23], a[120:123], v[208:211]
v_mfma_f32_16x16x32_bf16 v[216:219], a[20:23], a[124:127], v[216:219]
v_mfma_f32_16x16x32_bf16 v[216:219], a[16:19], a[108:111], v[216:219]
v_mfma_f32_16x16x32_bf16 v[220:223], a[24:27], a[108:111], v[220:223]
buffer_load_dwordx4 a[144:147], v3, s[88:91], s101 offen sc1
v_mfma_f32_16x16x32_bf16 v[220:223], a[28:31], a[124:127], v[220:223]
ds_read_b64_tr_b16 a[16:17], v4 offset:16384
v_mfma_f32_16x16x32_bf16 v[212:215], a[28:31], a[120:123], v[212:215]
ds_read_b64_tr_b16 a[18:19], v4 offset:20480
v_mfma_f32_16x16x32_bf16 v[212:215], a[24:27], a[104:107], v[212:215]
ds_read_b64_tr_b16 a[20:21], v4 offset:24576
v_mfma_f32_16x16x32_bf16 v[204:207], a[24:27], a[100:103], v[204:207]
ds_read_b64_tr_b16 a[22:23], v4 offset:28672
v_mfma_f32_16x16x32_bf16 v[204:207], a[28:31], a[116:119], v[204:207]
buffer_load_dwordx4 a[148:151], v3, s[88:91], s101 offen offset:1024 sc1
v_mfma_f32_16x16x32_bf16 v[196:199], a[28:31], a[112:115], v[196:199]
v_mfma_f32_16x16x32_bf16 v[196:199], a[24:27], a[96:99], v[196:199]
s_waitcnt lgkmcnt(4)
v_mfma_f32_16x16x32_bf16 v[224:227], a[0:3], a[96:99], v[224:227]
ds_read_b64_tr_b16 a[24:25], v5 offset:16384
v_mfma_f32_16x16x32_bf16 v[224:227], a[4:7], a[112:115], v[224:227]
ds_read_b64_tr_b16 a[26:27], v5 offset:20480
v_mfma_f32_16x16x32_bf16 v[232:235], a[4:7], a[116:119], v[232:235]
buffer_load_dwordx4 a[152:155], v3, s[88:91], s101 offen offset:2048 sc1
v_mfma_f32_16x16x32_bf16 v[232:235], a[0:3], a[100:103], v[232:235]
ds_read_b64_tr_b16 a[28:29], v5 offset:24576
v_mfma_f32_16x16x32_bf16 v[240:243], a[0:3], a[104:107], v[240:243]
ds_read_b64_tr_b16 a[30:31], v5 offset:28672
v_mfma_f32_16x16x32_bf16 v[240:243], a[4:7], a[120:123], v[240:243]
v_mfma_f32_16x16x32_bf16 v[248:251], a[4:7], a[124:127], v[248:251]
s_waitcnt vmcnt(7)
v_mfma_f32_16x16x32_bf16 v[248:251], a[0:3], a[108:111], v[248:251]
s_barrier
v_mfma_f32_16x16x32_bf16 v[252:255], a[8:11], a[108:111], v[252:255]
buffer_load_dwordx4 a[156:159], v3, s[88:91], s101 offen offset:3072 sc1
v_mfma_f32_16x16x32_bf16 v[252:255], a[12:15], a[124:127], v[252:255]
ds_read_b64_tr_b16 a[0:1], v15 offset:16640
s_add_u32 m0, s17, 0x18000
v_mfma_f32_16x16x32_bf16 v[244:247], a[12:15], a[120:123], v[244:247]
ds_read_b64_tr_b16 a[2:3], v15 offset:20736
v_add_u32 v12, 0x20000, v12
v_mfma_f32_16x16x32_bf16 v[244:247], a[8:11], a[104:107], v[244:247]
ds_read_b64_tr_b16 a[4:5], v15 offset:24832
v_mfma_f32_16x16x32_bf16 v[236:239], a[8:11], a[100:103], v[236:239]
ds_read_b64_tr_b16 a[6:7], v15 offset:28928
v_mfma_f32_16x16x32_bf16 v[236:239], a[12:15], a[116:119], v[236:239]
buffer_load_dwordx4 v12, s[72:75], 0 offen lds
v_mfma_f32_16x16x32_bf16 v[228:231], a[12:15], a[112:115], v[228:231]
v_add_u32 v13, 0x20000, v13
v_mfma_f32_16x16x32_bf16 v[228:231], a[8:11], a[96:99], v[228:231]
s_waitcnt lgkmcnt(4)
v_mfma_f32_16x16x32_bf16 a[32:35], a[16:19], a[96:99], a[32:35]
ds_read_b64_tr_b16 a[8:9], v19 offset:16640
v_mfma_f32_16x16x32_bf16 a[32:35], a[20:23], a[112:115], a[32:35]
ds_read_b64_tr_b16 a[10:11], v19 offset:20736
v_mfma_f32_16x16x32_bf16 a[40:43], a[20:23], a[116:119], a[40:43]
buffer_load_dwordx4 v13, s[72:75], 0 offen offset:1024 lds
v_mfma_f32_16x16x32_bf16 a[40:43], a[16:19], a[100:103], a[40:43]
ds_read_b64_tr_b16 a[12:13], v19 offset:24832
v_mfma_f32_16x16x32_bf16 a[48:51], a[16:19], a[104:107], a[48:51]
ds_read_b64_tr_b16 a[14:15], v19 offset:28928
v_mfma_f32_16x16x32_bf16 a[48:51], a[20:23], a[120:123], a[48:51]
v_mfma_f32_16x16x32_bf16 v[152:155], a[20:23], a[124:127], v[152:155]
v_mfma_f32_16x16x32_bf16 v[152:155], a[16:19], a[108:111], v[152:155]
buffer_load_dwordx4 v12, s[72:75], s12 offen offset:2048 lds
v_mfma_f32_16x16x32_bf16 v[156:159], a[24:27], a[108:111], v[156:159]
ds_read_b64_tr_b16 a[16:17], v15 offset:16896
v_mfma_f32_16x16x32_bf16 v[156:159], a[28:31], a[124:127], v[156:159]
ds_read_b64_tr_b16 a[18:19], v15 offset:20992
v_mfma_f32_16x16x32_bf16 a[52:55], a[28:31], a[120:123], a[52:55]
ds_read_b64_tr_b16 a[20:21], v15 offset:25088
v_mfma_f32_16x16x32_bf16 a[52:55], a[24:27], a[104:107], a[52:55]
ds_read_b64_tr_b16 a[22:23], v15 offset:29184
v_mfma_f32_16x16x32_bf16 a[44:47], a[24:27], a[100:103], a[44:47]
v_mfma_f32_16x16x32_bf16 a[44:47], a[28:31], a[116:119], a[44:47]
buffer_load_dwordx4 v13, s[72:75], s12 offen offset:3072 lds
v_mfma_f32_16x16x32_bf16 a[36:39], a[28:31], a[112:115], a[36:39]
s_add_u32 s101, s101, 0x2000
v_mfma_f32_16x16x32_bf16 a[36:39], a[24:27], a[96:99], a[36:39]
s_waitcnt lgkmcnt(4)
v_mfma_f32_16x16x32_bf16 v[160:163], a[0:3], a[224:227], v[160:163]
ds_read_b64_tr_b16 a[24:25], v19 offset:16896
v_mfma_f32_16x16x32_bf16 v[160:163], a[4:7], a[240:243], v[160:163]
ds_read_b64_tr_b16 a[26:27], v19 offset:20992
v_mfma_f32_16x16x32_bf16 v[168:171], a[4:7], a[244:247], v[168:171]
buffer_load_dwordx4 a[160:163], v3, s[88:91], s101 offen sc1
v_mfma_f32_16x16x32_bf16 v[168:171], a[0:3], a[228:231], v[168:171]
ds_read_b64_tr_b16 a[28:29], v19 offset:25088
v_mfma_f32_16x16x32_bf16 v[176:179], a[0:3], a[232:235], v[176:179]
ds_read_b64_tr_b16 a[30:31], v19 offset:29184
v_mfma_f32_16x16x32_bf16 v[176:179], a[4:7], a[248:251], v[176:179]
v_mfma_f32_16x16x32_bf16 v[184:187], a[4:7], a[252:255], v[184:187]
v_mfma_f32_16x16x32_bf16 v[184:187], a[0:3], a[236:239], v[184:187]
buffer_load_dwordx4 a[164:167], v3, s[88:91], s101 offen offset:1024 sc1
v_mfma_f32_16x16x32_bf16 v[188:191], a[8:11], a[236:239], v[188:191]
ds_read_b64_tr_b16 a[0:1], v15 offset:17152
v_mfma_f32_16x16x32_bf16 v[188:191], a[12:15], a[252:255], v[188:191]
buffer_load_dword v14, v7, s[88:91], s24 offen sc1
v_mfma_f32_16x16x32_bf16 v[180:183], a[12:15], a[248:251], v[180:183]
ds_read_b64_tr_b16 a[2:3], v15 offset:21248
v_mfma_f32_16x16x32_bf16 v[180:183], a[8:11], a[232:235], v[180:183]
ds_read_b64_tr_b16 a[4:5], v15 offset:25344
v_mfma_f32_16x16x32_bf16 v[172:175], a[8:11], a[228:231], v[172:175]
buffer_load_dwordx4 a[168:171], v3, s[88:91], s101 offen offset:2048 sc1
v_mfma_f32_16x16x32_bf16 v[172:175], a[12:15], a[244:247], v[172:175]
ds_read_b64_tr_b16 a[6:7], v15 offset:29440
v_mfma_f32_16x16x32_bf16 v[164:167], a[12:15], a[240:243], v[164:167]
v_mfma_f32_16x16x32_bf16 v[164:167], a[8:11], a[224:227], v[164:167]
s_waitcnt lgkmcnt(4)
v_mfma_f32_16x16x32_bf16 v[192:195], a[16:19], a[224:227], v[192:195]
ds_read_b64_tr_b16 a[8:9], v19 offset:17152
v_mfma_f32_16x16x32_bf16 v[192:195], a[20:23], a[240:243], v[192:195]
buffer_load_dwordx4 a[172:175], v3, s[88:91], s101 offen offset:3072 sc1
v_mfma_f32_16x16x32_bf16 v[200:203], a[20:23], a[244:247], v[200:203]
ds_read_b64_tr_b16 a[10:11], v19 offset:21248
s_add_u32 s101, s101, 0x2000
v_mfma_f32_16x16x32_bf16 v[200:203], a[16:19], a[228:231], v[200:203]
ds_read_b64_tr_b16 a[12:13], v19 offset:25344
v_mfma_f32_16x16x32_bf16 v[208:211], a[16:19], a[232:235], v[208:211]
ds_read_b64_tr_b16 a[14:15], v19 offset:29440
v_mfma_f32_16x16x32_bf16 v[208:211], a[20:23], a[248:251], v[208:211]
v_mfma_f32_16x16x32_bf16 v[216:219], a[20:23], a[252:255], v[216:219]
v_mfma_f32_16x16x32_bf16 v[216:219], a[16:19], a[236:239], v[216:219]
buffer_load_dwordx4 a[176:179], v3, s[88:91], s101 offen sc1
v_mfma_f32_16x16x32_bf16 v[220:223], a[24:27], a[236:239], v[220:223]
ds_read_b64_tr_b16 a[16:17], v15 offset:16384
v_mfma_f32_16x16x32_bf16 v[220:223], a[28:31], a[252:255], v[220:223]
ds_read_b64_tr_b16 a[18:19], v15 offset:20480
v_mfma_f32_16x16x32_bf16 v[212:215], a[28:31], a[248:251], v[212:215]
ds_read_b64_tr_b16 a[20:21], v15 offset:24576
v_mfma_f32_16x16x32_bf16 v[212:215], a[24:27], a[232:235], v[212:215]
ds_read_b64_tr_b16 a[22:23], v15 offset:28672
v_mfma_f32_16x16x32_bf16 v[204:207], a[24:27], a[228:231], v[204:207]
buffer_load_dwordx4 a[180:183], v3, s[88:91], s101 offen offset:1024 sc1
v_mfma_f32_16x16x32_bf16 v[204:207], a[28:31], a[244:247], v[204:207]
v_mfma_f32_16x16x32_bf16 v[196:199], a[28:31], a[240:243], v[196:199]
v_mfma_f32_16x16x32_bf16 v[196:199], a[24:27], a[224:227], v[196:199]
s_waitcnt lgkmcnt(4)
v_mfma_f32_16x16x32_bf16 v[224:227], a[0:3], a[224:227], v[224:227]
ds_read_b64_tr_b16 a[24:25], v19 offset:16384
v_mfma_f32_16x16x32_bf16 v[224:227], a[4:7], a[240:243], v[224:227]
buffer_load_dwordx4 a[184:187], v3, s[88:91], s101 offen offset:2048 sc1
v_mfma_f32_16x16x32_bf16 v[232:235], a[4:7], a[244:247], v[232:235]
ds_read_b64_tr_b16 a[26:27], v19 offset:20480
v_mfma_f32_16x16x32_bf16 v[232:235], a[0:3], a[228:231], v[232:235]
ds_read_b64_tr_b16 a[28:29], v19 offset:24576
v_mfma_f32_16x16x32_bf16 v[240:243], a[0:3], a[232:235], v[240:243]
ds_read_b64_tr_b16 a[30:31], v19 offset:28672
v_mfma_f32_16x16x32_bf16 v[240:243], a[4:7], a[248:251], v[240:243]
v_mfma_f32_16x16x32_bf16 v[248:251], a[4:7], a[252:255], v[248:251]
s_waitcnt vmcnt(8)
v_mfma_f32_16x16x32_bf16 v[248:251], a[0:3], a[236:239], v[248:251]
s_barrier
v_mfma_f32_16x16x32_bf16 v[252:255], a[8:11], a[236:239], v[252:255]
buffer_load_dwordx4 a[188:191], v3, s[88:91], s101 offen offset:3072 sc1
v_mfma_f32_16x16x32_bf16 v[252:255], a[12:15], a[252:255], v[252:255]
ds_read_b64_tr_b16 a[0:1], v4 offset:33024
s_add_u32 m0, s17, 0x1c000
v_mfma_f32_16x16x32_bf16 v[244:247], a[12:15], a[248:251], v[244:247]
ds_read_b64_tr_b16 a[2:3], v4 offset:37120
v_add_u32 v12, 0x20000, v12
v_mfma_f32_16x16x32_bf16 v[244:247], a[8:11], a[232:235], v[244:247]
ds_read_b64_tr_b16 a[4:5], v4 offset:41216
v_mfma_f32_16x16x32_bf16 v[236:239], a[8:11], a[228:231], v[236:239]
buffer_load_dwordx4 v12, s[72:75], 0 offen lds
v_mfma_f32_16x16x32_bf16 v[236:239], a[12:15], a[244:247], v[236:239]
ds_read_b64_tr_b16 a[6:7], v4 offset:45312
v_add_u32 v13, 0x20000, v13
v_mfma_f32_16x16x32_bf16 v[228:231], a[12:15], a[240:243], v[228:231]
v_mfma_f32_16x16x32_bf16 v[228:231], a[8:11], a[224:227], v[228:231]
s_waitcnt lgkmcnt(4)
v_mfma_f32_16x16x32_bf16 a[32:35], a[16:19], a[224:227], a[32:35]
ds_read_b64_tr_b16 a[8:9], v5 offset:33024
v_mfma_f32_16x16x32_bf16 a[32:35], a[20:23], a[240:243], a[32:35]
buffer_load_dwordx4 v13, s[72:75], 0 offen offset:1024 lds
v_mfma_f32_16x16x32_bf16 a[40:43], a[20:23], a[244:247], a[40:43]
ds_read_b64_tr_b16 a[10:11], v5 offset:37120
v_mfma_f32_16x16x32_bf16 a[40:43], a[16:19], a[228:231], a[40:43]
ds_read_b64_tr_b16 a[12:13], v5 offset:41216
v_mfma_f32_16x16x32_bf16 a[48:51], a[16:19], a[232:235], a[48:51]
ds_read_b64_tr_b16 a[14:15], v5 offset:45312
v_mfma_f32_16x16x32_bf16 a[48:51], a[20:23], a[248:251], a[48:51]
v_mfma_f32_16x16x32_bf16 v[152:155], a[20:23], a[252:255], v[152:155]
buffer_load_dwordx4 v12, s[72:75], s12 offen offset:2048 lds
v_mfma_f32_16x16x32_bf16 v[152:155], a[16:19], a[236:239], v[152:155]
v_mfma_f32_16x16x32_bf16 v[156:159], a[24:27], a[236:239], v[156:159]
ds_read_b64_tr_b16 a[16:17], v4 offset:33280
v_mfma_f32_16x16x32_bf16 v[156:159], a[28:31], a[252:255], v[156:159]
ds_read_b64_tr_b16 a[18:19], v4 offset:37376
v_mfma_f32_16x16x32_bf16 a[52:55], a[28:31], a[248:251], a[52:55]
ds_read_b64_tr_b16 a[20:21], v4 offset:41472
v_mfma_f32_16x16x32_bf16 a[52:55], a[24:27], a[232:235], a[52:55]
buffer_load_dwordx4 v13, s[72:75], s12 offen offset:3072 lds
v_mfma_f32_16x16x32_bf16 a[44:47], a[24:27], a[228:231], a[44:47]
ds_read_b64_tr_b16 a[22:23], v4 offset:45568
s_add_u32 s63, s101, s26
v_mfma_f32_16x16x32_bf16 a[44:47], a[28:31], a[244:247], a[44:47]
s_add_u32 s101, s63, s60
v_mfma_f32_16x16x32_bf16 a[36:39], a[28:31], a[240:243], a[36:39]
v_mfma_f32_16x16x32_bf16 a[36:39], a[24:27], a[224:227], a[36:39]
s_waitcnt vmcnt(10)
s_waitcnt lgkmcnt(4)
s_mov_b32 s92, 200000
L_spin_ca:
v_cmp_eq_u32 vcc, 0, v14
s_nop 4
s_cbranch_vccz L_spun_ca
s_sub_u32 s92, s92, 1
s_cbranch_scc1 L_spun_ca
s_sleep 6
buffer_load_dword v14, v7, s[88:91], s24 offen sc1
s_waitcnt vmcnt(0)
s_branch L_spin_ca
L_spun_ca:
v_mfma_f32_16x16x32_bf16 v[160:163], a[0:3], a[128:131], v[160:163]
buffer_load_dwordx4 a[192:195], v3, s[88:91], s101 offen sc1
v_mfma_f32_16x16x32_bf16 v[160:163], a[4:7], a[144:147], v[160:163]
ds_read_b64_tr_b16 a[24:25], v5 offset:33280
v_mfma_f32_16x16x32_bf16 v[168:171], a[4:7], a[148:151], v[168:171]
ds_read_b64_tr_b16 a[26:27], v5 offset:37376
v_mfma_f32_16x16x32_bf16 v[168:171], a[0:3], a[132:135], v[168:171]
ds_read_b64_tr_b16 a[28:29], v5 offset:41472
v_mfma_f32_16x16x32_bf16 v[176:179], a[0:3], a[136:139], v[176:179]
ds_read_b64_tr_b16 a[30:31], v5 offset:45568
v_mfma_f32_16x16x32_bf16 v[176:179], a[4:7], a[152:155], v[176:179]
buffer_load_dwordx4 a[196:199], v3, s[88:91], s101 offen offset:1024 sc1
v_mfma_f32_16x16x32_bf16 v[184:187], a[4:7], a[156:159], v[184:187]
v_mfma_f32_16x16x32_bf16 v[184:187], a[0:3], a[140:143], v[184:187]
v_mfma_f32_16x16x32_bf16 v[188:191], a[8:11], a[140:143], v[188:191]
ds_read_b64_tr_b16 a[0:1], v4 offset:33536
v_mfma_f32_16x16x32_bf16 v[188:191], a[12:15], a[156:159], v[188:191]
ds_read_b64_tr_b16 a[2:3], v4 offset:37632
v_mfma_f32_16x16x32_bf16 v[180:183], a[12:15], a[152:155], v[180:183]
ds_read_b64_tr_b16 a[4:5], v4 offset:41728
v_mfma_f32_16x16x32_bf16 v[180:183], a[8:11], a[136:139], v[180:183]
buffer_load_dwordx4 a[200:203], v3, s[88:91], s101 offen offset:2048 sc1
v_mfma_f32_16x16x32_bf16 v[172:175], a[8:11], a[132:135], v[172:175]
ds_read_b64_tr_b16 a[6:7], v4 offset:45824
v_mfma_f32_16x16x32_bf16 v[172:175], a[12:15], a[148:151], v[172:175]
v_mfma_f32_16x16x32_bf16 v[164:167], a[12:15], a[144:147], v[164:167]
v_mfma_f32_16x16x32_bf16 v[164:167], a[8:11], a[128:131], v[164:167]
s_waitcnt lgkmcnt(4)
v_mfma_f32_16x16x32_bf16 v[192:195], a[16:19], a[128:131], v[192:195]
buffer_load_dwordx4 a[204:207], v3, s[88:91], s101 offen offset:3072 sc1
v_mfma_f32_16x16x32_bf16 v[192:195], a[20:23], a[144:147], v[192:195]
ds_read_b64_tr_b16 a[8:9], v5 offset:33536
s_add_u32 s101, s101, 0x2000
v_mfma_f32_16x16x32_bf16 v[200:203], a[20:23], a[148:151], v[200:203]
ds_read_b64_tr_b16 a[10:11], v5 offset:37632
v_mfma_f32_16x16x32_bf16 v[200:203], a[16:19], a[132:135], v[200:203]
ds_read_b64_tr_b16 a[12:13], v5 offset:41728
v_mfma_f32_16x16x32_bf16 v[208:211], a[16:19], a[136:139], v[208:211]
ds_read_b64_tr_b16 a[14:15], v5 offset:45824
v_mfma_f32_16x16x32_bf16 v[208:211], a[20:23], a[152:155], v[208:211]
buffer_load_dwordx4 a[208:211], v3, s[88:91], s101 offen sc1
v_mfma_f32_16x16x32_bf16 v[216:219], a[20:23], a[156:159], v[216:219]
v_mfma_f32_16x16x32_bf16 v[216:219], a[16:19], a[140:143], v[216:219]
v_mfma_f32_16x16x32_bf16 v[220:223], a[24:27], a[140:143], v[220:223]
ds_read_b64_tr_b16 a[16:17], v4 offset:32768
v_mfma_f32_16x16x32_bf16 v[220:223], a[28:31], a[156:159], v[220:223]
ds_read_b64_tr_b16 a[18:19], v4 offset:36864
v_mfma_f32_16x16x32_bf16 v[212:215], a[28:31], a[152:155], v[212:215]
buffer_load_dwordx4 a[212:215], v3, s[88:91], s101 offen offset:1024 sc1
v_mfma_f32_16x16x32_bf16 v[212:215], a[24:27], a[136:139], v[212:215]
ds_read_b64_tr_b16 a[20:21], v4 offset:40960
v_mfma_f32_16x16x32_bf16 v[204:207], a[24:27], a[132:135], v[204:207]
ds_read_b64_tr_b16 a[22:23], v4 offset:45056
v_mfma_f32_16x16x32_bf16 v[204:207], a[28:31], a[148:151], v[204:207]
v_mfma_f32_16x16x32_bf16 v[196:199], a[28:31], a[144:147], v[196:199]
s_waitcnt lgkmcnt(4)
v_mfma_f32_16x16x32_bf16 v[196:199], a[24:27], a[128:131], v[196:199]
buffer_load_dwordx4 a[216:219], v3, s[88:91], s101 offen offset:2048 sc1
v_mfma_f32_16x16x32_bf16 v[224:227], a[0:3], a[128:131], v[224:227]
ds_read_b64_tr_b16 a[24:25], v5 offset:32768
v_mfma_f32_16x16x32_bf16 v[224:227], a[4:7], a[144:147], v[224:227]
ds_read_b64_tr_b16 a[26:27], v5 offset:36864
v_mfma_f32_16x16x32_bf16 v[232:235], a[4:7], a[148:151], v[232:235]
ds_read_b64_tr_b16 a[28:29], v5 offset:40960
v_mfma_f32_16x16x32_bf16 v[232:235], a[0:3], a[132:135], v[232:235]
ds_read_b64_tr_b16 a[30:31], v5 offset:45056
v_mfma_f32_16x16x32_bf16 v[240:243], a[0:3], a[136:139], v[240:243]
v_mfma_f32_16x16x32_bf16 v[240:243], a[4:7], a[152:155], v[240:243]
buffer_load_dwordx4 a[220:223], v3, s[88:91], s101 offen offset:3072 sc1
v_mfma_f32_16x16x32_bf16 v[248:251], a[4:7], a[156:159], v[248:251]
s_waitcnt vmcnt(8)
s_add_u32 m0, s17, 0x20000
s_lshl_b32 s61, s60, 3
v_mfma_f32_16x16x32_bf16 v[248:251], a[0:3], a[140:143], v[248:251]
s_barrier
s_add_u32 s62, s61, s12
v_add_u32 v12, s25, v12
v_mfma_f32_16x16x32_bf16 v[252:255], a[8:11], a[140:143], v[252:255]
ds_read_b64_tr_b16 a[0:1], v4 offset:49408
v_mfma_f32_16x16x32_bf16 v[252:255], a[12:15], a[156:159], v[252:255]
ds_read_b64_tr_b16 a[2:3], v4 offset:53504
v_mfma_f32_16x16x32_bf16 v[244:247], a[12:15], a[152:155], v[244:247]
buffer_load_dwordx4 v12, s[64:67], s61 offen lds
v_mfma_f32_16x16x32_bf16 v[244:247], a[8:11], a[136:139], v[244:247]
ds_read_b64_tr_b16 a[4:5], v4 offset:57600
v_add_u32 v13, s25, v13
v_mfma_f32_16x16x32_bf16 v[236:239], a[8:11], a[132:135], v[236:239]
ds_read_b64_tr_b16 a[6:7], v4 offset:61696
v_mfma_f32_16x16x32_bf16 v[236:239], a[12:15], a[148:151], v[236:239]
v_mfma_f32_16x16x32_bf16 v[228:231], a[12:15], a[144:147], v[228:231]
s_waitcnt lgkmcnt(4)
v_mfma_f32_16x16x32_bf16 v[228:231], a[8:11], a[128:131], v[228:231]
buffer_load_dwordx4 v13, s[64:67], s61 offen offset:1024 lds
v_mfma_f32_16x16x32_bf16 a[32:35], a[16:19], a[128:131], a[32:35]
ds_read_b64_tr_b16 a[8:9], v5 offset:49408
v_mfma_f32_16x16x32_bf16 a[32:35], a[20:23], a[144:147], a[32:35]
ds_read_b64_tr_b16 a[10:11], v5 offset:53504
v_mfma_f32_16x16x32_bf16 a[40:43], a[20:23], a[148:151], a[40:43]
ds_read_b64_tr_b16 a[12:13], v5 offset:57600
v_mfma_f32_16x16x32_bf16 a[40:43], a[16:19], a[132:135], a[40:43]
ds_read_b64_tr_b16 a[14:15], v5 offset:61696
v_mfma_f32_16x16x32_bf16 a[48:51], a[16:19], a[136:139], a[48:51]
buffer_load_dwordx4 v12, s[64:67], s62 offen offset:2048 lds
v_mfma_f32_16x16x32_bf16 a[48:51], a[20:23], a[152:155], a[48:51]
v_mfma_f32_16x16x32_bf16 v[152:155], a[20:23], a[156:159], v[152:155]
v_mfma_f32_16x16x32_bf16 v[152:155], a[16:19], a[140:143], v[152:155]
v_mfma_f32_16x16x32_bf16 v[156:159], a[24:27], a[140:143], v[156:159]
ds_read_b64_tr_b16 a[16:17], v4 offset:49664
v_mfma_f32_16x16x32_bf16 v[156:159], a[28:31], a[156:159], v[156:159]
ds_read_b64_tr_b16 a[18:19], v4 offset:53760
v_mfma_f32_16x16x32_bf16 a[52:55], a[28:31], a[152:155], a[52:55]
buffer_load_dwordx4 v13, s[64:67], s62 offen offset:3072 lds
v_mfma_f32_16x16x32_bf16 a[52:55], a[24:27], a[136:139], a[52:55]
ds_read_b64_tr_b16 a[20:21], v4 offset:57856
v_mfma_f32_16x16x32_bf16 a[44:47], a[24:27], a[132:135], a[44:47]
ds_read_b64_tr_b16 a[22:23], v4 offset:61952
v_mfma_f32_16x16x32_bf16 a[44:47], a[28:31], a[148:151], a[44:47]
v_mfma_f32_16x16x32_bf16 a[36:39], a[28:31], a[144:147], a[36:39]
v_mfma_f32_16x16x32_bf16 a[36:39], a[24:27], a[128:131], a[36:39]
s_waitcnt lgkmcnt(4)
s_branch L_p4_join
L_p4_b:
v_mfma_f32_16x16x32_bf16 v[160:163], a[0:3], a[64:67], 0
ds_read_b64_tr_b16 a[24:25], v5 offset:512
v_and_b32 v6, 15, v0
v_mfma_f32_16x16x32_bf16 v[160:163], a[4:7], a[80:83], v[160:163]
ds_read_b64_tr_b16 a[26:27], v5 offset:4608
s_add_u32 s101, s101, 0x2000
v_mfma_f32_16x16x32_bf16 v[168:171], a[4:7], a[84:87], 0
ds_read_b64_tr_b16 a[28:29], v5 offset:8704
v_lshlrev_b32 v6, 2, v6
v_mfma_f32_16x16x32_bf16 v[168:171], a[0:3], a[68:71], v[168:171]
ds_read_b64_tr_b16 a[30:31], v5 offset:12800
v_and_b32 v1, 28, v6
v_mfma_f32_16x16x32_bf16 v[176:179], a[0:3], a[72:75], 0
v_or_b32 v7, 16, v1
v_mfma_f32_16x16x32_bf16 v[176:179], a[4:7], a[88:91], v[176:179]
buffer_load_dwordx4 a[160:163], v3, s[88:91], s101 offen sc1
v_mfma_f32_16x16x32_bf16 v[184:187], a[4:7], a[92:95], 0
v_mfma_f32_16x16x32_bf16 v[184:187], a[0:3], a[76:79], v[184:187]
v_mfma_f32_16x16x32_bf16 v[188:191], a[8:11], a[76:79], 0
ds_read_b64_tr_b16 a[0:1], v4 offset:768
s_lshl_b32 s28, s99, 1
v_mfma_f32_16x16x32_bf16 v[188:191], a[12:15], a[92:95], v[188:191]
ds_read_b64_tr_b16 a[2:3], v4 offset:4864
s_and_b32 s9, s4, 1
v_mfma_f32_16x16x32_bf16 v[180:183], a[12:15], a[88:91], 0
buffer_load_dwordx4 a[164:167], v3, s[88:91], s101 offen offset:1024 sc1
v_mfma_f32_16x16x32_bf16 v[180:183], a[8:11], a[72:75], v[180:183]
ds_read_b64_tr_b16 a[4:5], v4 offset:8960
s_add_u32 s28, s28, s9
v_mfma_f32_16x16x32_bf16 v[172:175], a[8:11], a[68:71], 0
buffer_load_dword v14, v7, s[88:91], s24 offen sc1
v_mfma_f32_16x16x32_bf16 v[172:175], a[12:15], a[84:87], v[172:175]
ds_read_b64_tr_b16 a[6:7], v4 offset:13056
s_lshl_b32 s9, s28, 8
v_mfma_f32_16x16x32_bf16 v[164:167], a[12:15], a[80:83], 0
s_waitcnt lgkmcnt(4)
s_add_u32 s9, s9, 0x3700000
s_lshl_b32 s28, s28, 17
v_mfma_f32_16x16x32_bf16 v[164:167], a[8:11], a[64:67], v[164:167]
buffer_load_dwordx4 a[168:171], v3, s[88:91], s101 offen offset:2048 sc1
v_mfma_f32_16x16x32_bf16 v[192:195], a[16:19], a[64:67], 0
ds_read_b64_tr_b16 a[8:9], v5 offset:768
s_lshl_b32 s10, s100, 8
v_mfma_f32_16x16x32_bf16 v[192:195], a[20:23], a[80:83], v[192:195]
ds_read_b64_tr_b16 a[10:11], v5 offset:4864
s_add_u32 s28, s28, s10
v_mfma_f32_16x16x32_bf16 v[200:203], a[20:23], a[84:87], 0
ds_read_b64_tr_b16 a[12:13], v5 offset:8960
s_lshl_b32 s10, s14, 6
v_mfma_f32_16x16x32_bf16 v[200:203], a[16:19], a[68:71], v[200:203]
ds_read_b64_tr_b16 a[14:15], v5 offset:13056
s_add_u32 s28, s28, s10
v_mfma_f32_16x16x32_bf16 v[208:211], a[16:19], a[72:75], 0
buffer_load_dwordx4 a[172:175], v3, s[88:91], s101 offen offset:3072 sc1
v_mfma_f32_16x16x32_bf16 v[208:211], a[20:23], a[88:91], v[208:211]
s_add_u32 s101, s101, 0x2000
s_add_u32 s29, s28, 0x8000
s_add_u32 s30, s28, 0x10000
v_mfma_f32_16x16x32_bf16 v[216:219], a[20:23], a[92:95], 0
s_add_u32 s31, s28, 0x18000
s_lshl_b32 s10, s2, 2
s_add_u32 s10, s10, s4
v_mfma_f32_16x16x32_bf16 v[216:219], a[16:19], a[76:79], v[216:219]
s_lshl_b32 s10, s10, 12
s_add_u32 s44, s10, 0x4800000
s_xor_b32 s52, s44, 0x4000
v_mfma_f32_16x16x32_bf16 v[220:223], a[24:27], a[76:79], 0
ds_read_b64_tr_b16 a[16:17], v4 offset:0
s_add_u32 s45, s10, 0x4c00000
v_mfma_f32_16x16x32_bf16 v[220:223], a[28:31], a[92:95], v[220:223]
buffer_load_dwordx4 a[176:179], v3, s[88:91], s101 offen sc1
v_mfma_f32_16x16x32_bf16 v[212:215], a[28:31], a[88:91], 0
ds_read_b64_tr_b16 a[18:19], v4 offset:4096
s_xor_b32 s53, s45, 0x8000
v_mfma_f32_16x16x32_bf16 v[212:215], a[24:27], a[72:75], v[212:215]
ds_read_b64_tr_b16 a[20:21], v4 offset:8192
s_add_u32 s46, s10, 0x5000000
v_mfma_f32_16x16x32_bf16 v[204:207], a[24:27], a[68:71], 0
ds_read_b64_tr_b16 a[22:23], v4 offset:12288
s_xor_b32 s54, s46, 0xc000
v_mfma_f32_16x16x32_bf16 v[204:207], a[28:31], a[84:87], v[204:207]
v_and_b32 v18, 16, v0
v_lshrrev_b32 v19, 5, v0
v_mfma_f32_16x16x32_bf16 v[196:199], a[28:31], a[80:83], 0
buffer_load_dwordx4 a[180:183], v3, s[88:91], s101 offen offset:1024 sc1
v_mfma_f32_16x16x32_bf16 v[196:199], a[24:27], a[64:67], v[196:199]
s_waitcnt lgkmcnt(4)
v_lshlrev_b32 v19, 4, v19
v_lshl_add_u32 v18, v18, 1, v19
v_mfma_f32_16x16x32_bf16 v[224:227], a[0:3], a[64:67], 0
ds_read_b64_tr_b16 a[24:25], v5 offset:0
v_lshl_add_u32 v2, v6, 9, v18
v_mfma_f32_16x16x32_bf16 v[224:227], a[4:7], a[80:83], v[224:227]
ds_read_b64_tr_b16 a[26:27], v5 offset:4096
v_add_u32 v15, 0x10000, v4
v_mfma_f32_16x16x32_bf16 v[232:235], a[4:7], a[84:87], 0
ds_read_b64_tr_b16 a[28:29], v5 offset:8192
v_add_u32 v19, 0x10000, v5
v_mfma_f32_16x16x32_bf16 v[232:235], a[0:3], a[68:71], v[232:235]
buffer_load_dwordx4 a[184:187], v3, s[88:91], s101 offen offset:2048 sc1
v_mfma_f32_16x16x32_bf16 v[240:243], a[0:3], a[72:75], 0
ds_read_b64_tr_b16 a[30:31], v5 offset:12288
v_mfma_f32_16x16x32_bf16 v[240:243], a[4:7], a[88:91], v[240:243]
v_mfma_f32_16x16x32_bf16 v[248:251], a[4:7], a[92:95], 0
s_waitcnt vmcnt(8)
v_mfma_f32_16x16x32_bf16 v[248:251], a[0:3], a[76:79], v[248:251]
s_barrier
s_cmp_lg_u32 s4, 0
s_cbranch_scc1 L_flag_setb
s_lshl_b32 s8, s6, 5
s_add_u32 s8, s8, s5
s_and_b32 s92, s8, 0xf8
s_mul_i32 s92, s92, 7
s_add_u32 s8, s8, s92
s_lshl_b32 s8, s8, 2
s_add_u32 s8, s8, 0x3704000
v_mov_b32 v17, 1
s_mov_b64 exec, 1
buffer_store_dword v17, off, s[88:91], s8 sc1
s_mov_b64 exec, -1
L_flag_setb:
v_mfma_f32_16x16x32_bf16 v[252:255], a[8:11], a[76:79], 0
buffer_load_dwordx4 a[188:191], v3, s[88:91], s101 offen offset:3072 sc1
v_mfma_f32_16x16x32_bf16 v[252:255], a[12:15], a[92:95], v[252:255]
ds_read_b64_tr_b16 a[0:1], v4 offset:16640
s_add_u32 m0, s17, 0x1c000
v_mfma_f32_16x16x32_bf16 v[244:247], a[12:15], a[88:91], 0
ds_read_b64_tr_b16 a[2:3], v4 offset:20736
v_add_u32 v12, 0x20000, v12
v_mfma_f32_16x16x32_bf16 v[244:247], a[8:11], a[72:75], v[244:247]
ds_read_b64_tr_b16 a[4:5], v4 offset:24832
v_mfma_f32_16x16x32_bf16 v[236:239], a[8:11], a[68:71], 0
ds_read_b64_tr_b16 a[6:7], v4 offset:28928
v_mfma_f32_16x16x32_bf16 v[236:239], a[12:15], a[84:87], v[236:239]
buffer_load_dwordx4 v12, s[72:75], 0 offen lds
v_mfma_f32_16x16x32_bf16 v[228:231], a[12:15], a[80:83], 0
v_add_u32 v13, 0x20000, v13
v_mfma_f32_16x16x32_bf16 v[228:231], a[8:11], a[64:67], v[228:231]
s_waitcnt lgkmcnt(4)
v_mfma_f32_16x16x32_bf16 a[32:35], a[16:19], a[64:67], 0
ds_read_b64_tr_b16 a[8:9], v5 offset:16640
v_mfma_f32_16x16x32_bf16 a[32:35], a[20:23], a[80:83], a[32:35]
ds_read_b64_tr_b16 a[10:11], v5 offset:20736
v_mfma_f32_16x16x32_bf16 a[40:43], a[20:23], a[84:87], 0
buffer_load_dwordx4 v13, s[72:75], 0 offen offset:1024 lds
v_mfma_f32_16x16x32_bf16 a[40:43], a[16:19], a[68:71], a[40:43]
ds_read_b64_tr_b16 a[12:13], v5 offset:24832
v_mfma_f32_16x16x32_bf16 a[48:51], a[16:19], a[72:75], 0
ds_read_b64_tr_b16 a[14:15], v5 offset:28928
v_mfma_f32_16x16x32_bf16 a[48:51], a[20:23], a[88:91], a[48:51]
v_mfma_f32_16x16x32_bf16 v[152:155], a[20:23], a[92:95], 0
v_mfma_f32_16x16x32_bf16 v[152:155], a[16:19], a[76:79], v[152:155]
buffer_load_dwordx4 v12, s[72:75], s12 offen offset:2048 lds
v_mfma_f32_16x16x32_bf16 v[156:159], a[24:27], a[76:79], 0
ds_read_b64_tr_b16 a[16:17], v4 offset:16896
v_mfma_f32_16x16x32_bf16 v[156:159], a[28:31], a[92:95], v[156:159]
ds_read_b64_tr_b16 a[18:19], v4 offset:20992
v_mfma_f32_16x16x32_bf16 a[52:55], a[28:31], a[88:91], 0
ds_read_b64_tr_b16 a[20:21], v4 offset:25088
v_mfma_f32_16x16x32_bf16 a[52:55], a[24:27], a[72:75], a[52:55]
ds_read_b64_tr_b16 a[22:23], v4 offset:29184
v_mfma_f32_16x16x32_bf16 a[44:47], a[24:27], a[68:71], 0
v_mfma_f32_16x16x32_bf16 a[44:47], a[28:31], a[84:87], a[44:47]
buffer_load_dwordx4 v13, s[72:75], s12 offen offset:3072 lds
v_mfma_f32_16x16x32_bf16 a[36:39], a[28:31], a[80:83], 0
s_add_u32 s63, s101, s26
s_add_u32 s101, s63, s60
v_mfma_f32_16x16x32_bf16 a[36:39], a[24:27], a[64:67], a[36:39]
s_waitcnt lgkmcnt(4)
v_mfma_f32_16x16x32_bf16 v[160:163], a[0:3], a[96:99], v[160:163]
ds_read_b64_tr_b16 a[24:25], v5 offset:16896
v_mfma_f32_16x16x32_bf16 v[160:163], a[4:7], a[112:115], v[160:163]
ds_read_b64_tr_b16 a[26:27], v5 offset:20992
s_waitcnt vmcnt(10)
s_mov_b32 s92, 200000
L_spin_cb:
v_cmp_eq_u32 vcc, 0, v14
s_nop 4
s_cbranch_vccz L_spun_cb
s_sub_u32 s92, s92, 1
s_cbranch_scc1 L_spun_cb
s_sleep 6
buffer_load_dword v14, v7, s[88:91], s24 offen sc1
s_waitcnt vmcnt(0)
s_branch L_spin_cb
L_spun_cb:
v_mfma_f32_16x16x32_bf16 v[168:171], a[4:7], a[116:119], v[168:171]
buffer_load_dwordx4 a[192:195], v3, s[88:91], s101 offen sc1
v_mfma_f32_16x16x32_bf16 v[168:171], a[0:3], a[100:103], v[168:171]
ds_read_b64_tr_b16 a[28:29], v5 offset:25088
v_mfma_f32_16x16x32_bf16 v[176:179], a[0:3], a[104:107], v[176:179]
ds_read_b64_tr_b16 a[30:31], v5 offset:29184
v_mfma_f32_16x16x32_bf16 v[176:179], a[4:7], a[120:123], v[176:179]
v_mfma_f32_16x16x32_bf16 v[184:187], a[4:7], a[124:127], v[184:187]
v_mfma_f32_16x16x32_bf16 v[184:187], a[0:3], a[108:111], v[184:187]
buffer_load_dwordx4 a[196:199], v3, s[88:91], s101 offen offset:1024 sc1
v_mfma_f32_16x16x32_bf16 v[188:191], a[8:11], a[108:111], v[188:191]
ds_read_b64_tr_b16 a[0:1], v4 offset:17152
v_mfma_f32_16x16x32_bf16 v[188:191], a[12:15], a[124:127], v[188:191]
ds_read_b64_tr_b16 a[2:3], v4 offset:21248
v_mfma_f32_16x16x32_bf16 v[180:183], a[12:15], a[120:123], v[180:183]
ds_read_b64_tr_b16 a[4:5], v4 offset:25344
v_mfma_f32_16x16x32_bf16 v[180:183], a[8:11], a[104:107], v[180:183]
ds_read_b64_tr_b16 a[6:7], v4 offset:29440
v_mfma_f32_16x16x32_bf16 v[172:175], a[8:11], a[100:103], v[172:175]
buffer_load_dwordx4 a[200:203], v3, s[88:91], s101 offen offset:2048 sc1
v_mfma_f32_16x16x32_bf16 v[172:175], a[12:15], a[116:119], v[172:175]
v_mfma_f32_16x16x32_bf16 v[164:167], a[12:15], a[112:115], v[164:167]
v_mfma_f32_16x16x32_bf16 v[164:167], a[8:11], a[96:99], v[164:167]
s_waitcnt lgkmcnt(4)
v_mfma_f32_16x16x32_bf16 v[192:195], a[16:19], a[96:99], v[192:195]
ds_read_b64_tr_b16 a[8:9], v5 offset:17152
v_mfma_f32_16x16x32_bf16 v[192:195], a[20:23], a[112:115], v[192:195]
buffer_load_dwordx4 a[204:207], v3, s[88:91], s101 offen offset:3072 sc1
v_mfma_f32_16x16x32_bf16 v[200:203], a[20:23], a[116:119], v[200:203]
ds_read_b64_tr_b16 a[10:11], v5 offset:21248
s_add_u32 s101, s101, 0x2000
v_mfma_f32_16x16x32_bf16 v[200:203], a[16:19], a[100:103], v[200:203]
ds_read_b64_tr_b16 a[12:13], v5 offset:25344
v_mfma_f32_16x16x32_bf16 v[208:211], a[16:19], a[104:107], v[208:211]
ds_read_b64_tr_b16 a[14:15], v5 offset:29440
v_mfma_f32_16x16x32_bf16 v[208:211], a[20:23], a[120:123], v[208:211]
v_mfma_f32_16x16x32_bf16 v[216:219], a[20:23], a[124:127], v[216:219]
buffer_load_dwordx4 a[208:211], v3, s[88:91], s101 offen sc1
v_mfma_f32_16x16x32_bf16 v[216:219], a[16:19], a[108:111], v[216:219]
v_mfma_f32_16x16x32_bf16 v[220:223], a[24:27], a[108:111], v[220:223]
ds_read_b64_tr_b16 a[16:17], v4 offset:16384
v_mfma_f32_16x16x32_bf16 v[220:223], a[28:31], a[124:127], v[220:223]
ds_read_b64_tr_b16 a[18:19], v4 offset:20480
v_mfma_f32_16x16x32_bf16 v[212:215], a[28:31], a[120:123], v[212:215]
ds_read_b64_tr_b16 a[20:21], v4 offset:24576
v_mfma_f32_16x16x32_bf16 v[212:215], a[24:27], a[104:107], v[212:215]
buffer_load_dwordx4 a[212:215], v3, s[88:91], s101 offen offset:1024 sc1
v_mfma_f32_16x16x32_bf16 v[204:207], a[24:27], a[100:103], v[204:207]
ds_read_b64_tr_b16 a[22:23], v4 offset:28672
v_mfma_f32_16x16x32_bf16 v[204:207], a[28:31], a[116:119], v[204:207]
v_mfma_f32_16x16x32_bf16 v[196:199], a[28:31], a[112:115], v[196:199]
v_mfma_f32_16x16x32_bf16 v[196:199], a[24:27], a[96:99], v[196:199]
s_waitcnt lgkmcnt(4)
v_mfma_f32_16x16x32_bf16 v[224:227], a[0:3], a[96:99], v[224:227]
buffer_load_dwordx4 a[216:219], v3, s[88:91], s101 offen offset:2048 sc1
v_mfma_f32_16x16x32_bf16 v[224:227], a[4:7], a[112:115], v[224:227]
ds_read_b64_tr_b16 a[24:25], v5 offset:16384
v_mfma_f32_16x16x32_bf16 v[232:235], a[4:7], a[116:119], v[232:235]
ds_read_b64_tr_b16 a[26:27], v5 offset:20480
v_mfma_f32_16x16x32_bf16 v[232:235], a[0:3], a[100:103], v[232:235]
ds_read_b64_tr_b16 a[28:29], v5 offset:24576
v_mfma_f32_16x16x32_bf16 v[240:243], a[0:3], a[104:107], v[240:243]
ds_read_b64_tr_b16 a[30:31], v5 offset:28672
v_mfma_f32_16x16x32_bf16 v[240:243], a[4:7], a[120:123], v[240:243]
buffer_load_dwordx4 a[220:223], v3, s[88:91], s101 offen offset:3072 sc1
v_mfma_f32_16x16x32_bf16 v[248:251], a[4:7], a[124:127], v[248:251]
s_waitcnt vmcnt(8)
s_add_u32 m0, s17, 0x20000
s_lshl_b32 s61, s60, 3
v_mfma_f32_16x16x32_bf16 v[248:251], a[0:3], a[108:111], v[248:251]
s_barrier
s_add_u32 s62, s61, s12
v_add_u32 v12, s25, v12
v_mfma_f32_16x16x32_bf16 v[252:255], a[8:11], a[108:111], v[252:255]
ds_read_b64_tr_b16 a[0:1], v4 offset:49408
v_mfma_f32_16x16x32_bf16 v[252:255], a[12:15], a[124:127], v[252:255]
ds_read_b64_tr_b16 a[2:3], v4 offset:53504
v_mfma_f32_16x16x32_bf16 v[244:247], a[12:15], a[120:123], v[244:247]
buffer_load_dwordx4 v12, s[64:67], s61 offen lds
v_mfma_f32_16x16x32_bf16 v[244:247], a[8:11], a[104:107], v[244:247]
ds_read_b64_tr_b16 a[4:5], v4 offset:57600
v_add_u32 v13, s25, v13
v_mfma_f32_16x16x32_bf16 v[236:239], a[8:11], a[100:103], v[236:239]
ds_read_b64_tr_b16 a[6:7], v4 offset:61696
v_mfma_f32_16x16x32_bf16 v[236:239], a[12:15], a[116:119], v[236:239]
v_mfma_f32_16x16x32_bf16 v[228:231], a[12:15], a[112:115], v[228:231]
s_waitcnt lgkmcnt(4)
v_mfma_f32_16x16x32_bf16 v[228:231], a[8:11], a[96:99], v[228:231]
buffer_load_dwordx4 v13, s[64:67], s61 offen offset:1024 lds
v_mfma_f32_16x16x32_bf16 a[32:35], a[16:19], a[96:99], a[32:35]
ds_read_b64_tr_b16 a[8:9], v5 offset:49408
v_mfma_f32_16x16x32_bf16 a[32:35], a[20:23], a[112:115], a[32:35]
ds_read_b64_tr_b16 a[10:11], v5 offset:53504
v_mfma_f32_16x16x32_bf16 a[40:43], a[20:23], a[116:119], a[40:43]
ds_read_b64_tr_b16 a[12:13], v5 offset:57600
v_mfma_f32_16x16x32_bf16 a[40:43], a[16:19], a[100:103], a[40:43]
ds_read_b64_tr_b16 a[14:15], v5 offset:61696
v_mfma_f32_16x16x32_bf16 a[48:51], a[16:19], a[104:107], a[48:51]
buffer_load_dwordx4 v12, s[64:67], s62 offen offset:2048 lds
v_mfma_f32_16x16x32_bf16 a[48:51], a[20:23], a[120:123], a[48:51]
v_mfma_f32_16x16x32_bf16 v[152:155], a[20:23], a[124:127], v[152:155]
v_mfma_f32_16x16x32_bf16 v[152:155], a[16:19], a[108:111], v[152:155]
v_mfma_f32_16x16x32_bf16 v[156:159], a[24:27], a[108:111], v[156:159]
ds_read_b64_tr_b16 a[16:17], v4 offset:49664
v_mfma_f32_16x16x32_bf16 v[156:159], a[28:31], a[124:127], v[156:159]
ds_read_b64_tr_b16 a[18:19], v4 offset:53760
v_mfma_f32_16x16x32_bf16 a[52:55], a[28:31], a[120:123], a[52:55]
buffer_load_dwordx4 v13, s[64:67], s62 offen offset:3072 lds
v_mfma_f32_16x16x32_bf16 a[52:55], a[24:27], a[104:107], a[52:55]
ds_read_b64_tr_b16 a[20:21], v4 offset:57856
v_mfma_f32_16x16x32_bf16 a[44:47], a[24:27], a[100:103], a[44:47]
ds_read_b64_tr_b16 a[22:23], v4 offset:61952
v_mfma_f32_16x16x32_bf16 a[44:47], a[28:31], a[116:119], a[44:47]
v_mfma_f32_16x16x32_bf16 a[36:39], a[28:31], a[112:115], a[36:39]
v_mfma_f32_16x16x32_bf16 a[36:39], a[24:27], a[96:99], a[36:39]
s_waitcnt lgkmcnt(4)
L_p4_join:
v_mfma_f32_16x16x32_bf16 v[160:163], a[0:3], a[160:163], v[160:163]
ds_read_b64_tr_b16 a[24:25], v5 offset:49664
s_add_u32 s60, s60, s57
v_mfma_f32_16x16x32_bf16 v[160:163], a[4:7], a[176:179], v[160:163]
ds_read_b64_tr_b16 a[26:27], v5 offset:53760
s_and_b32 s60, s60, 0x1c000
v_mfma_f32_16x16x32_bf16 v[168:171], a[4:7], a[180:183], v[168:171]
ds_read_b64_tr_b16 a[28:29], v5 offset:57856
s_or_b32 s60, s60, 0x20000
v_mfma_f32_16x16x32_bf16 v[168:171], a[0:3], a[164:167], v[168:171]
ds_read_b64_tr_b16 a[30:31], v5 offset:61952
s_add_u32 s101, s63, s60
v_mfma_f32_16x16x32_bf16 v[176:179], a[0:3], a[168:171], v[176:179]
buffer_load_dwordx4 a[224:227], v3, s[88:91], s101 offen sc1
v_mfma_f32_16x16x32_bf16 v[176:179], a[4:7], a[184:187], v[176:179]
v_mfma_f32_16x16x32_bf16 v[184:187], a[4:7], a[188:191], v[184:187]
v_mfma_f32_16x16x32_bf16 v[184:187], a[0:3], a[172:175], v[184:187]
v_mfma_f32_16x16x32_bf16 v[188:191], a[8:11], a[172:175], v[188:191]
ds_read_b64_tr_b16 a[0:1], v4 offset:49920
v_mfma_f32_16x16x32_bf16 v[188:191], a[12:15], a[188:191], v[188:191]
buffer_load_dwordx4 a[228:231], v3, s[88:91], s101 offen offset:1024 sc1
v_mfma_f32_16x16x32_bf16 v[180:183], a[12:15], a[184:187], v[180:183]
ds_read_b64_tr_b16 a[2:3], v4 offset:54016
v_mfma_f32_16x16x32_bf16 v[180:183], a[8:11], a[168:171], v[180:183]
ds_read_b64_tr_b16 a[4:5], v4 offset:58112
v_mfma_f32_16x16x32_bf16 v[172:175], a[8:11], a[164:167], v[172:175]
ds_read_b64_tr_b16 a[6:7], v4 offset:62208
v_mfma_f32_16x16x32_bf16 v[172:175], a[12:15], a[180:183], v[172:175]
buffer_load_dwordx4 a[232:235], v3, s[88:91], s101 offen offset:2048 sc1
v_mfma_f32_16x16x32_bf16 v[164:167], a[12:15], a[176:179], v[164:167]
v_mfma_f32_16x16x32_bf16 v[164:167], a[8:11], a[160:163], v[164:167]
s_waitcnt lgkmcnt(4)
v_mfma_f32_16x16x32_bf16 v[192:195], a[16:19], a[160:163], v[192:195]
ds_read_b64_tr_b16 a[8:9], v5 offset:49920
v_mfma_f32_16x16x32_bf16 v[192:195], a[20:23], a[176:179], v[192:195]
ds_read_b64_tr_b16 a[10:11], v5 offset:54016
v_mfma_f32_16x16x32_bf16 v[200:203], a[20:23], a[180:183], v[200:203]
buffer_load_dwordx4 a[236:239], v3, s[88:91], s101 offen offset:3072 sc1
v_mfma_f32_16x16x32_bf16 v[200:203], a[16:19], a[164:167], v[200:203]
ds_read_b64_tr_b16 a[12:13], v5 offset:58112
s_add_u32 s101, s101, 0x2000
v_mfma_f32_16x16x32_bf16 v[208:211], a[16:19], a[168:171], v[208:211]
ds_read_b64_tr_b16 a[14:15], v5 offset:62208
v_mfma_f32_16x16x32_bf16 v[208:211], a[20:23], a[184:187], v[208:211]
v_mfma_f32_16x16x32_bf16 v[216:219], a[20:23], a[188:191], v[216:219]
v_mfma_f32_16x16x32_bf16 v[216:219], a[16:19], a[172:175], v[216:219]
buffer_load_dwordx4 a[240:243], v3, s[88:91], s101 offen sc1
v_mfma_f32_16x16x32_bf16 v[220:223], a[24:27], a[172:175], v[220:223]
ds_read_b64_tr_b16 a[16:17], v4 offset:49152
v_mfma_f32_16x16x32_bf16 v[220:223], a[28:31], a[188:191], v[220:223]
ds_read_b64_tr_b16 a[18:19], v4 offset:53248
v_mfma_f32_16x16x32_bf16 v[212:215], a[28:31], a[184:187], v[212:215]
ds_read_b64_tr_b16 a[20:21], v4 offset:57344
v_mfma_f32_16x16x32_bf16 v[212:215], a[24:27], a[168:171], v[212:215]
buffer_load_dwordx4 a[244:247], v3, s[88:91], s101 offen offset:1024 sc1
v_mfma_f32_16x16x32_bf16 v[204:207], a[24:27], a[164:167], v[204:207]
ds_read_b64_tr_b16 a[22:23], v4 offset:61440
v_mfma_f32_16x16x32_bf16 v[204:207], a[28:31], a[180:183], v[204:207]
v_mfma_f32_16x16x32_bf16 v[196:199], a[28:31], a[176:179], v[196:199]
v_mfma_f32_16x16x32_bf16 v[196:199], a[24:27], a[160:163], v[196:199]
s_waitcnt lgkmcnt(4)
v_mfma_f32_16x16x32_bf16 v[224:227], a[0:3], a[160:163], v[224:227]
buffer_load_dwordx4 a[248:251], v3, s[88:91], s101 offen offset:2048 sc1
v_mfma_f32_16x16x32_bf16 v[224:227], a[4:7], a[176:179], v[224:227]
ds_read_b64_tr_b16 a[24:25], v5 offset:49152
v_mfma_f32_16x16x32_bf16 v[232:235], a[4:7], a[180:183], v[232:235]
ds_read_b64_tr_b16 a[26:27], v5 offset:53248
v_mfma_f32_16x16x32_bf16 v[232:235], a[0:3], a[164:167], v[232:235]
ds_read_b64_tr_b16 a[28:29], v5 offset:57344
v_mfma_f32_16x16x32_bf16 v[240:243], a[0:3], a[168:171], v[240:243]
buffer_load_dwordx4 a[252:255], v3, s[88:91], s101 offen offset:3072 sc1
v_mfma_f32_16x16x32_bf16 v[240:243], a[4:7], a[184:187], v[240:243]
ds_read_b64_tr_b16 a[30:31], v5 offset:61440
s_add_u32 m0, s17, 0x24000
v_mfma_f32_16x16x32_bf16 v[248:251], a[4:7], a[188:191], v[248:251]
s_waitcnt vmcnt(8)
s_lshl_b32 s61, s60, 3
s_add_u32 s62, s61, s12
v_mfma_f32_16x16x32_bf16 v[248:251], a[0:3], a[172:175], v[248:251]
s_barrier
v_mfma_f32_16x16x32_bf16 v[252:255], a[8:11], a[172:175], v[252:255]
ds_read_b64_tr_b16 a[0:1], v15 offset:256
v_mfma_f32_16x16x32_bf16 v[252:255], a[12:15], a[188:191], v[252:255]
buffer_load_dwordx4 v12, s[64:67], s61 offen lds
v_mfma_f32_16x16x32_bf16 v[244:247], a[12:15], a[184:187], v[244:247]
ds_read_b64_tr_b16 a[2:3], v15 offset:4352
v_mfma_f32_16x16x32_bf16 v[244:247], a[8:11], a[168:171], v[244:247]
ds_read_b64_tr_b16 a[4:5], v15 offset:8448
v_mfma_f32_16x16x32_bf16 v[236:239], a[8:11], a[164:167], v[236:239]
ds_read_b64_tr_b16 a[6:7], v15 offset:12544
v_mfma_f32_16x16x32_bf16 v[236:239], a[12:15], a[180:183], v[236:239]
v_mfma_f32_16x16x32_bf16 v[228:231], a[12:15], a[176:179], v[228:231]
buffer_load_dwordx4 v13, s[64:67], s61 offen offset:1024 lds
v_mfma_f32_16x16x32_bf16 v[228:231], a[8:11], a[160:163], v[228:231]
s_waitcnt lgkmcnt(4)
v_mfma_f32_16x16x32_bf16 a[32:35], a[16:19], a[160:163], a[32:35]
ds_read_b64_tr_b16 a[8:9], v19 offset:256
v_mfma_f32_16x16x32_bf16 a[32:35], a[20:23], a[176:179], a[32:35]
ds_read_b64_tr_b16 a[10:11], v19 offset:4352
v_mfma_f32_16x16x32_bf16 a[40:43], a[20:23], a[180:183], a[40:43]
buffer_load_dwordx4 v12, s[64:67], s62 offen offset:2048 lds
v_mfma_f32_16x16x32_bf16 a[40:43], a[16:19], a[164:167], a[40:43]
ds_read_b64_tr_b16 a[12:13], v19 offset:8448
v_mfma_f32_16x16x32_bf16 a[48:51], a[16:19], a[168:171], a[48:51]
ds_read_b64_tr_b16 a[14:15], v19 offset:12544
v_mfma_f32_16x16x32_bf16 a[48:51], a[20:23], a[184:187], a[48:51]
v_mfma_f32_16x16x32_bf16 v[152:155], a[20:23], a[188:191], v[152:155]
v_mfma_f32_16x16x32_bf16 v[152:155], a[16:19], a[172:175], v[152:155]
buffer_load_dwordx4 v13, s[64:67], s62 offen offset:3072 lds
v_mfma_f32_16x16x32_bf16 v[156:159], a[24:27], a[172:175], v[156:159]
ds_read_b64_tr_b16 a[16:17], v15 offset:512
v_mfma_f32_16x16x32_bf16 v[156:159], a[28:31], a[188:191], v[156:159]
buffer_load_dword v8, v6, s[88:91], s9 offen offset:0 sc1
v_mfma_f32_16x16x32_bf16 a[52:55], a[28:31], a[184:187], a[52:55]
ds_read_b64_tr_b16 a[18:19], v15 offset:4608
v_mfma_f32_16x16x32_bf16 a[52:55], a[24:27], a[168:171], a[52:55]
buffer_load_dword v9, v6, s[88:91], s9 offen offset:64 sc1
v_mfma_f32_16x16x32_bf16 a[44:47], a[24:27], a[164:167], a[44:47]
ds_read_b64_tr_b16 a[20:21], v15 offset:8704
v_mfma_f32_16x16x32_bf16 a[44:47], a[28:31], a[180:183], a[44:47]
buffer_load_dword v10, v6, s[88:91], s9 offen offset:128 sc1
v_mfma_f32_16x16x32_bf16 a[36:39], a[28:31], a[176:179], a[36:39]
ds_read_b64_tr_b16 a[22:23], v15 offset:12800
s_waitcnt lgkmcnt(4)
v_mfma_f32_16x16x32_bf16 a[36:39], a[24:27], a[160:163], a[36:39]
buffer_load_dword v11, v6, s[88:91], s9 offen offset:192 sc1
v_mfma_f32_16x16x32_bf16 v[56:59], a[0:3], a[192:195], 0
ds_read_b64_tr_b16 a[24:25], v19 offset:512
s_add_u32 s60, s60, s58
s_and_b32 s60, s60, 0x1c000
v_mfma_f32_16x16x32_bf16 v[56:59], a[4:7], a[208:211], v[56:59]
ds_read_b64_tr_b16 a[26:27], v19 offset:4608
s_or_b32 s60, s60, 0x20000
v_mfma_f32_16x16x32_bf16 v[64:67], a[4:7], a[212:215], 0
ds_read_b64_tr_b16 a[28:29], v19 offset:8704
s_add_u32 s101, s63, s60
v_mfma_f32_16x16x32_bf16 v[64:67], a[0:3], a[196:199], v[64:67]
buffer_load_dwordx4 a[64:67], v3, s[88:91], s101 offen sc1
v_mfma_f32_16x16x32_bf16 v[72:75], a[0:3], a[200:203], 0
ds_read_b64_tr_b16 a[30:31], v19 offset:12800
v_mfma_f32_16x16x32_bf16 v[72:75], a[4:7], a[216:219], v[72:75]
v_mfma_f32_16x16x32_bf16 v[80:83], a[4:7], a[220:223], 0
buffer_load_dwordx4 a[68:71], v3, s[88:91], s101 offen offset:1024 sc1
v_mfma_f32_16x16x32_bf16 v[80:83], a[0:3], a[204:207], v[80:83]
v_mfma_f32_16x16x32_bf16 v[84:87], a[8:11], a[204:207], 0
ds_read_b64_tr_b16 a[0:1], v15 offset:768
v_mfma_f32_16x16x32_bf16 v[84:87], a[12:15], a[220:223], v[84:87]
buffer_load_dwordx4 a[72:75], v3, s[88:91], s101 offen offset:2048 sc1
v_mfma_f32_16x16x32_bf16 v[76:79], a[12:15], a[216:219], 0
ds_read_b64_tr_b16 a[2:3], v15 offset:4864
v_mfma_f32_16x16x32_bf16 v[76:79], a[8:11], a[200:203], v[76:79]
ds_read_b64_tr_b16 a[4:5], v15 offset:8960
v_mfma_f32_16x16x32_bf16 v[68:71], a[8:11], a[196:199], 0
buffer_load_dwordx4 a[76:79], v3, s[88:91], s101 offen offset:3072 sc1
v_mfma_f32_16x16x32_bf16 v[68:71], a[12:15], a[212:215], v[68:71]
ds_read_b64_tr_b16 a[6:7], v15 offset:13056
s_add_u32 s101, s101, 0x2000
v_mfma_f32_16x16x32_bf16 v[60:63], a[12:15], a[208:211], 0
v_mfma_f32_16x16x32_bf16 v[60:63], a[8:11], a[192:195], v[60:63]
s_waitcnt lgkmcnt(4)
v_mfma_f32_16x16x32_bf16 v[88:91], a[16:19], a[192:195], 0
buffer_load_dwordx4 a[80:83], v3, s[88:91], s101 offen sc1
v_mfma_f32_16x16x32_bf16 v[88:91], a[20:23], a[208:211], v[88:91]
ds_read_b64_tr_b16 a[8:9], v19 offset:768
L_padC0:
s_cmp_eq_u32 s95, 1
s_cbranch_scc1 L_padC2
v_mfma_f32_16x16x32_bf16 v[96:99], a[20:23], a[212:215], 0
ds_read_b64_tr_b16 a[10:11], v19 offset:4864
v_mfma_f32_16x16x32_bf16 v[96:99], a[16:19], a[196:199], v[96:99]
buffer_load_dwordx4 a[84:87], v3, s[88:91], s101 offen offset:1024 sc1
v_mfma_f32_16x16x32_bf16 v[104:107], a[16:19], a[200:203], 0
ds_read_b64_tr_b16 a[12:13], v19 offset:8960
v_mfma_f32_16x16x32_bf16 v[104:107], a[20:23], a[216:219], v[104:107]
ds_read_b64_tr_b16 a[14:15], v19 offset:13056
v_mfma_f32_16x16x32_bf16 v[112:115], a[20:23], a[220:223], 0
v_mfma_f32_16x16x32_bf16 v[112:115], a[16:19], a[204:207], v[112:115]
buffer_load_dwordx4 a[88:91], v3, s[88:91], s101 offen offset:2048 sc1
v_mfma_f32_16x16x32_bf16 v[116:119], a[24:27], a[204:207], 0
ds_read_b64_tr_b16 a[16:17], v15 offset:0
v_mfma_f32_16x16x32_bf16 v[116:119], a[28:31], a[220:223], v[116:119]
ds_read_b64_tr_b16 a[18:19], v15 offset:4096
v_mfma_f32_16x16x32_bf16 v[108:111], a[28:31], a[216:219], 0
ds_read_b64_tr_b16 a[20:21], v15 offset:8192
v_mfma_f32_16x16x32_bf16 v[108:111], a[24:27], a[200:203], v[108:111]
ds_read_b64_tr_b16 a[22:23], v15 offset:12288
v_mfma_f32_16x16x32_bf16 v[100:103], a[24:27], a[196:199], 0
buffer_load_dwordx4 a[92:95], v3, s[88:91], s101 offen offset:3072 sc1
v_mfma_f32_16x16x32_bf16 v[100:103], a[28:31], a[212:215], v[100:103]
s_add_u32 m0, s17, 0x10000
s_lshl_b32 s61, s60, 3
s_add_u32 s62, s61, s12
v_mfma_f32_16x16x32_bf16 v[92:95], a[28:31], a[208:211], 0
v_mfma_f32_16x16x32_bf16 v[92:95], a[24:27], a[192:195], v[92:95]
s_waitcnt lgkmcnt(4)
v_mfma_f32_16x16x32_bf16 v[120:123], a[0:3], a[192:195], 0
buffer_load_dwordx4 v12, s[64:67], s61 offen lds
v_mfma_f32_16x16x32_bf16 v[120:123], a[4:7], a[208:211], v[120:123]
ds_read_b64_tr_b16 a[24:25], v19 offset:0
v_mfma_f32_16x16x32_bf16 v[128:131], a[4:7], a[212:215], 0
ds_read_b64_tr_b16 a[26:27], v19 offset:4096
v_mfma_f32_16x16x32_bf16 v[128:131], a[0:3], a[196:199], v[128:131]
ds_read_b64_tr_b16 a[28:29], v19 offset:8192
v_mfma_f32_16x16x32_bf16 v[136:139], a[0:3], a[200:203], 0
ds_read_b64_tr_b16 a[30:31], v19 offset:12288
v_mfma_f32_16x16x32_bf16 v[136:139], a[4:7], a[216:219], v[136:139]
buffer_load_dwordx4 v13, s[64:67], s61 offen offset:1024 lds
v_mfma_f32_16x16x32_bf16 v[144:147], a[4:7], a[220:223], 0
s_waitcnt vmcnt(14)
v_mfma_f32_16x16x32_bf16 v[144:147], a[0:3], a[204:207], v[144:147]
s_barrier
v_mfma_f32_16x16x32_bf16 v[148:151], a[8:11], a[204:207], 0
ds_read_b64_tr_b16 a[0:1], v15 offset:16640
v_mfma_f32_16x16x32_bf16 v[148:151], a[12:15], a[220:223], v[148:151]
buffer_load_dwordx4 v12, s[64:67], s62 offen offset:2048 lds
v_mfma_f32_16x16x32_bf16 v[140:143], a[12:15], a[216:219], 0
ds_read_b64_tr_b16 a[2:3], v15 offset:20736
v_mfma_f32_16x16x32_bf16 v[140:143], a[8:11], a[200:203], v[140:143]
ds_read_b64_tr_b16 a[4:5], v15 offset:24832
v_mfma_f32_16x16x32_bf16 v[132:135], a[8:11], a[196:199], 0
ds_read_b64_tr_b16 a[6:7], v15 offset:28928
v_mfma_f32_16x16x32_bf16 v[132:135], a[12:15], a[212:215], v[132:135]
v_mfma_f32_16x16x32_bf16 v[124:127], a[12:15], a[208:211], 0
buffer_load_dwordx4 v13, s[64:67], s62 offen offset:3072 lds
v_mfma_f32_16x16x32_bf16 v[124:127], a[8:11], a[192:195], v[124:127]
s_waitcnt lgkmcnt(4)
s_add_u32 s60, s60, s59
s_and_b32 s60, s60, 0x1c000
v_mfma_f32_16x16x32_bf16 v[24:27], a[16:19], a[192:195], 0
ds_read_b64_tr_b16 a[8:9], v19 offset:16640
s_or_b32 s60, s60, 0x20000
v_mfma_f32_16x16x32_bf16 v[24:27], a[20:23], a[208:211], v[24:27]
ds_read_b64_tr_b16 a[10:11], v19 offset:20736
s_add_u32 s101, s63, s60
v_mfma_f32_16x16x32_bf16 v[32:35], a[20:23], a[212:215], 0
ds_read_b64_tr_b16 a[12:13], v19 offset:24832
v_mfma_f32_16x16x32_bf16 v[32:35], a[16:19], a[196:199], v[32:35]
buffer_load_dwordx4 a[96:99], v3, s[88:91], s101 offen sc1
v_mfma_f32_16x16x32_bf16 v[40:43], a[16:19], a[200:203], 0
ds_read_b64_tr_b16 a[14:15], v19 offset:28928
v_mfma_f32_16x16x32_bf16 v[40:43], a[20:23], a[216:219], v[40:43]
v_mfma_f32_16x16x32_bf16 v[48:51], a[20:23], a[220:223], 0
v_mfma_f32_16x16x32_bf16 v[48:51], a[16:19], a[204:207], v[48:51]
buffer_load_dwordx4 a[100:103], v3, s[88:91], s101 offen offset:1024 sc1
v_mfma_f32_16x16x32_bf16 v[52:55], a[24:27], a[204:207], 0
ds_read_b64_tr_b16 a[16:17], v15 offset:16896
v_mfma_f32_16x16x32_bf16 v[52:55], a[28:31], a[220:223], v[52:55]
ds_read_b64_tr_b16 a[18:19], v15 offset:20992
v_mfma_f32_16x16x32_bf16 v[44:47], a[28:31], a[216:219], 0
ds_read_b64_tr_b16 a[20:21], v15 offset:25088
v_mfma_f32_16x16x32_bf16 v[44:47], a[24:27], a[200:203], v[44:47]
ds_read_b64_tr_b16 a[22:23], v15 offset:29184
v_mfma_f32_16x16x32_bf16 v[36:39], a[24:27], a[196:199], 0
buffer_load_dwordx4 a[104:107], v3, s[88:91], s101 offen offset:2048 sc1
v_mfma_f32_16x16x32_bf16 v[36:39], a[28:31], a[212:215], v[36:39]
v_mfma_f32_16x16x32_bf16 v[28:31], a[28:31], a[208:211], 0
v_mfma_f32_16x16x32_bf16 v[28:31], a[24:27], a[192:195], v[28:31]
s_waitcnt lgkmcnt(4)
v_mfma_f32_16x16x32_bf16 v[56:59], a[0:3], a[224:227], v[56:59]
buffer_load_dwordx4 a[108:111], v3, s[88:91], s101 offen offset:3072 sc1
v_mfma_f32_16x16x32_bf16 v[56:59], a[4:7], a[240:243], v[56:59]
ds_read_b64_tr_b16 a[24:25], v19 offset:16896
s_add_u32 s101, s101, 0x2000
v_mfma_f32_16x16x32_bf16 v[64:67], a[4:7], a[244:247], v[64:67]
ds_read_b64_tr_b16 a[26:27], v19 offset:20992
v_mfma_f32_16x16x32_bf16 v[64:67], a[0:3], a[228:231], v[64:67]
ds_read_b64_tr_b16 a[28:29], v19 offset:25088
v_mfma_f32_16x16x32_bf16 v[72:75], a[0:3], a[232:235], v[72:75]
ds_read_b64_tr_b16 a[30:31], v19 offset:29184
v_mfma_f32_16x16x32_bf16 v[72:75], a[4:7], a[248:251], v[72:75]
buffer_load_dwordx4 a[112:115], v3, s[88:91], s101 offen sc1
v_mfma_f32_16x16x32_bf16 v[80:83], a[4:7], a[252:255], v[80:83]
v_mfma_f32_16x16x32_bf16 v[80:83], a[0:3], a[236:239], v[80:83]
v_mfma_f32_16x16x32_bf16 v[84:87], a[8:11], a[236:239], v[84:87]
ds_read_b64_tr_b16 a[0:1], v15 offset:17152
v_mfma_f32_16x16x32_bf16 v[84:87], a[12:15], a[252:255], v[84:87]
ds_read_b64_tr_b16 a[2:3], v15 offset:21248
v_mfma_f32_16x16x32_bf16 v[76:79], a[12:15], a[248:251], v[76:79]
buffer_load_dwordx4 a[116:119], v3, s[88:91], s101 offen offset:1024 sc1
v_mfma_f32_16x16x32_bf16 v[76:79], a[8:11], a[232:235], v[76:79]
ds_read_b64_tr_b16 a[4:5], v15 offset:25344
v_mfma_f32_16x16x32_bf16 v[68:71], a[8:11], a[228:231], v[68:71]
ds_read_b64_tr_b16 a[6:7], v15 offset:29440
v_mfma_f32_16x16x32_bf16 v[68:71], a[12:15], a[244:247], v[68:71]
v_mfma_f32_16x16x32_bf16 v[60:63], a[12:15], a[240:243], v[60:63]
buffer_load_dwordx4 a[120:123], v3, s[88:91], s101 offen offset:2048 sc1
v_mfma_f32_16x16x32_bf16 v[60:63], a[8:11], a[224:227], v[60:63]
s_waitcnt lgkmcnt(4)
v_mfma_f32_16x16x32_bf16 v[88:91], a[16:19], a[224:227], v[88:91]
ds_read_b64_tr_b16 a[8:9], v19 offset:17152
v_mfma_f32_16x16x32_bf16 v[88:91], a[20:23], a[240:243], v[88:91]
ds_read_b64_tr_b16 a[10:11], v19 offset:21248
v_mfma_f32_16x16x32_bf16 v[96:99], a[20:23], a[244:247], v[96:99]
ds_read_b64_tr_b16 a[12:13], v19 offset:25344
v_mfma_f32_16x16x32_bf16 v[96:99], a[16:19], a[228:231], v[96:99]
buffer_load_dwordx4 a[124:127], v3, s[88:91], s101 offen offset:3072 sc1
v_mfma_f32_16x16x32_bf16 v[104:107], a[16:19], a[232:235], v[104:107]
ds_read_b64_tr_b16 a[14:15], v19 offset:29440
s_add_u32 m0, s17, 0x14000
v_mfma_f32_16x16x32_bf16 v[104:107], a[20:23], a[248:251], v[104:107]
s_lshl_b32 s61, s60, 3
s_add_u32 s62, s61, s12
v_mfma_f32_16x16x32_bf16 v[112:115], a[20:23], a[252:255], v[112:115]
v_mfma_f32_16x16x32_bf16 v[112:115], a[16:19], a[236:239], v[112:115]
buffer_load_dwordx4 v12, s[64:67], s61 offen lds
v_mfma_f32_16x16x32_bf16 v[116:119], a[24:27], a[236:239], v[116:119]
ds_read_b64_tr_b16 a[16:17], v15 offset:16384
v_mfma_f32_16x16x32_bf16 v[116:119], a[28:31], a[252:255], v[116:119]
ds_read_b64_tr_b16 a[18:19], v15 offset:20480
v_mfma_f32_16x16x32_bf16 v[108:111], a[28:31], a[248:251], v[108:111]
ds_read_b64_tr_b16 a[20:21], v15 offset:24576
v_mfma_f32_16x16x32_bf16 v[108:111], a[24:27], a[232:235], v[108:111]
ds_read_b64_tr_b16 a[22:23], v15 offset:28672
v_mfma_f32_16x16x32_bf16 v[100:103], a[24:27], a[228:231], v[100:103]
buffer_load_dwordx4 v13, s[64:67], s61 offen offset:1024 lds
v_mfma_f32_16x16x32_bf16 v[100:103], a[28:31], a[244:247], v[100:103]
v_mfma_f32_16x16x32_bf16 v[92:95], a[28:31], a[240:243], v[92:95]
v_mfma_f32_16x16x32_bf16 v[92:95], a[24:27], a[224:227], v[92:95]
s_waitcnt lgkmcnt(4)
v_mfma_f32_16x16x32_bf16 v[120:123], a[0:3], a[224:227], v[120:123]
ds_read_b64_tr_b16 a[24:25], v19 offset:16384
v_mfma_f32_16x16x32_bf16 v[120:123], a[4:7], a[240:243], v[120:123]
buffer_load_dwordx4 v12, s[64:67], s62 offen offset:2048 lds
v_mfma_f32_16x16x32_bf16 v[128:131], a[4:7], a[244:247], v[128:131]
ds_read_b64_tr_b16 a[26:27], v19 offset:20480
v_mfma_f32_16x16x32_bf16 v[128:131], a[0:3], a[228:231], v[128:131]
ds_read_b64_tr_b16 a[28:29], v19 offset:24576
v_mfma_f32_16x16x32_bf16 v[136:139], a[0:3], a[232:235], v[136:139]
ds_read_b64_tr_b16 a[30:31], v19 offset:28672
v_mfma_f32_16x16x32_bf16 v[136:139], a[4:7], a[248:251], v[136:139]
buffer_load_dwordx4 v13, s[64:67], s62 offen offset:3072 lds
v_mfma_f32_16x16x32_bf16 v[144:147], a[4:7], a[252:255], v[144:147]
s_waitcnt vmcnt(12)
s_add_u32 s60, s60, s56
s_and_b32 s60, s60, 0x1c000
v_mfma_f32_16x16x32_bf16 v[144:147], a[0:3], a[236:239], v[144:147]
s_barrier
s_or_b32 s60, s60, 0x20000
s_add_u32 s101, s63, s60
v_mfma_f32_16x16x32_bf16 v[148:151], a[8:11], a[236:239], v[148:151]
ds_read_b64_tr_b16 a[0:1], v4 offset:256
v_mfma_f32_16x16x32_bf16 v[148:151], a[12:15], a[252:255], v[148:151]
ds_read_b64_tr_b16 a[2:3], v4 offset:4352
v_mfma_f32_16x16x32_bf16 v[140:143], a[12:15], a[248:251], v[140:143]
buffer_load_dwordx4 a[128:131], v3, s[88:91], s101 offen sc1
v_mfma_f32_16x16x32_bf16 v[140:143], a[8:11], a[232:235], v[140:143]
ds_read_b64_tr_b16 a[4:5], v4 offset:8448
v_mfma_f32_16x16x32_bf16 v[132:135], a[8:11], a[228:231], v[132:135]
ds_read_b64_tr_b16 a[6:7], v4 offset:12544
v_mfma_f32_16x16x32_bf16 v[132:135], a[12:15], a[244:247], v[132:135]
v_mfma_f32_16x16x32_bf16 v[124:127], a[12:15], a[240:243], v[124:127]
buffer_load_dwordx4 a[132:135], v3, s[88:91], s101 offen offset:1024 sc1
v_mfma_f32_16x16x32_bf16 v[124:127], a[8:11], a[224:227], v[124:127]
s_waitcnt lgkmcnt(4)
v_mfma_f32_16x16x32_bf16 v[24:27], a[16:19], a[224:227], v[24:27]
ds_read_b64_tr_b16 a[8:9], v5 offset:256
v_mfma_f32_16x16x32_bf16 v[24:27], a[20:23], a[240:243], v[24:27]
ds_read_b64_tr_b16 a[10:11], v5 offset:4352
v_mfma_f32_16x16x32_bf16 v[32:35], a[20:23], a[244:247], v[32:35]
ds_read_b64_tr_b16 a[12:13], v5 offset:8448
v_mfma_f32_16x16x32_bf16 v[32:35], a[16:19], a[228:231], v[32:35]
buffer_load_dwordx4 a[136:139], v3, s[88:91], s101 offen offset:2048 sc1
v_mfma_f32_16x16x32_bf16 v[40:43], a[16:19], a[232:235], v[40:43]
ds_read_b64_tr_b16 a[14:15], v5 offset:12544
v_mfma_f32_16x16x32_bf16 v[40:43], a[20:23], a[248:251], v[40:43]
v_mfma_f32_16x16x32_bf16 v[48:51], a[20:23], a[252:255], v[48:51]
v_mfma_f32_16x16x32_bf16 v[48:51], a[16:19], a[236:239], v[48:51]
v_mfma_f32_16x16x32_bf16 v[52:55], a[24:27], a[236:239], v[52:55]
buffer_load_dwordx4 a[140:143], v3, s[88:91], s101 offen offset:3072 sc1
v_mfma_f32_16x16x32_bf16 v[52:55], a[28:31], a[252:255], v[52:55]
ds_read_b64_tr_b16 a[16:17], v4 offset:512
s_add_u32 s101, s101, 0x2000
v_mfma_f32_16x16x32_bf16 v[44:47], a[28:31], a[248:251], v[44:47]
ds_read_b64_tr_b16 a[18:19], v4 offset:4608
v_mfma_f32_16x16x32_bf16 v[44:47], a[24:27], a[232:235], v[44:47]
ds_read_b64_tr_b16 a[20:21], v4 offset:8704
v_mfma_f32_16x16x32_bf16 v[36:39], a[24:27], a[228:231], v[36:39]
buffer_load_dwordx4 a[144:147], v3, s[88:91], s101 offen sc1
v_mfma_f32_16x16x32_bf16 v[36:39], a[28:31], a[244:247], v[36:39]
ds_read_b64_tr_b16 a[22:23], v4 offset:12800
v_mfma_f32_16x16x32_bf16 v[28:31], a[28:31], a[240:243], v[28:31]
v_mfma_f32_16x16x32_bf16 v[28:31], a[24:27], a[224:227], v[28:31]
s_waitcnt lgkmcnt(4)
v_mfma_f32_16x16x32_bf16 v[56:59], a[0:3], a[64:67], v[56:59]
ds_read_b64_tr_b16 a[24:25], v5 offset:512
v_mfma_f32_16x16x32_bf16 v[56:59], a[4:7], a[80:83], v[56:59]
buffer_load_dwordx4 a[148:151], v3, s[88:91], s101 offen offset:1024 sc1
v_mfma_f32_16x16x32_bf16 v[64:67], a[4:7], a[84:87], v[64:67]
ds_read_b64_tr_b16 a[26:27], v5 offset:4608
v_mfma_f32_16x16x32_bf16 v[64:67], a[0:3], a[68:71], v[64:67]
ds_read_b64_tr_b16 a[28:29], v5 offset:8704
v_mfma_f32_16x16x32_bf16 v[72:75], a[0:3], a[72:75], v[72:75]
ds_read_b64_tr_b16 a[30:31], v5 offset:12800
v_mfma_f32_16x16x32_bf16 v[72:75], a[4:7], a[88:91], v[72:75]
buffer_load_dwordx4 a[152:155], v3, s[88:91], s101 offen offset:2048 sc1
v_mfma_f32_16x16x32_bf16 v[80:83], a[4:7], a[92:95], v[80:83]
v_mfma_f32_16x16x32_bf16 v[80:83], a[0:3], a[76:79], v[80:83]
v_mfma_f32_16x16x32_bf16 v[84:87], a[8:11], a[76:79], v[84:87]
ds_read_b64_tr_b16 a[0:1], v4 offset:768
v_mfma_f32_16x16x32_bf16 v[84:87], a[12:15], a[92:95], v[84:87]
ds_read_b64_tr_b16 a[2:3], v4 offset:4864
v_mfma_f32_16x16x32_bf16 v[76:79], a[12:15], a[88:91], v[76:79]
buffer_load_dwordx4 a[156:159], v3, s[88:91], s101 offen offset:3072 sc1
v_mfma_f32_16x16x32_bf16 v[76:79], a[8:11], a[72:75], v[76:79]
ds_read_b64_tr_b16 a[4:5], v4 offset:8960
s_add_u32 m0, s17, 0x18000
v_mfma_f32_16x16x32_bf16 v[68:71], a[8:11], a[68:71], v[68:71]
ds_read_b64_tr_b16 a[6:7], v4 offset:13056
s_lshl_b32 s61, s60, 3
v_mfma_f32_16x16x32_bf16 v[68:71], a[12:15], a[84:87], v[68:71]
s_add_u32 s62, s61, s12
v_mfma_f32_16x16x32_bf16 v[60:63], a[12:15], a[80:83], v[60:63]
s_waitcnt lgkmcnt(4)
v_mfma_f32_16x16x32_bf16 v[60:63], a[8:11], a[64:67], v[60:63]
buffer_load_dwordx4 v12, s[64:67], s61 offen lds
v_mfma_f32_16x16x32_bf16 v[88:91], a[16:19], a[64:67], v[88:91]
ds_read_b64_tr_b16 a[8:9], v5 offset:768
v_mfma_f32_16x16x32_bf16 v[88:91], a[20:23], a[80:83], v[88:91]
ds_read_b64_tr_b16 a[10:11], v5 offset:4864
v_mfma_f32_16x16x32_bf16 v[96:99], a[20:23], a[84:87], v[96:99]
ds_read_b64_tr_b16 a[12:13], v5 offset:8960
v_mfma_f32_16x16x32_bf16 v[96:99], a[16:19], a[68:71], v[96:99]
buffer_load_dwordx4 v13, s[64:67], s61 offen offset:1024 lds
v_mfma_f32_16x16x32_bf16 v[104:107], a[16:19], a[72:75], v[104:107]
ds_read_b64_tr_b16 a[14:15], v5 offset:13056
v_mfma_f32_16x16x32_bf16 v[104:107], a[20:23], a[88:91], v[104:107]
v_mfma_f32_16x16x32_bf16 v[112:115], a[20:23], a[92:95], v[112:115]
v_mfma_f32_16x16x32_bf16 v[112:115], a[16:19], a[76:79], v[112:115]
v_mfma_f32_16x16x32_bf16 v[116:119], a[24:27], a[76:79], v[116:119]
buffer_load_dwordx4 v12, s[64:67], s62 offen offset:2048 lds
v_mfma_f32_16x16x32_bf16 v[116:119], a[28:31], a[92:95], v[116:119]
ds_read_b64_tr_b16 a[16:17], v4 offset:0
v_mfma_f32_16x16x32_bf16 v[108:111], a[28:31], a[88:91], v[108:111]
ds_read_b64_tr_b16 a[18:19], v4 offset:4096
v_mfma_f32_16x16x32_bf16 v[108:111], a[24:27], a[72:75], v[108:111]
ds_read_b64_tr_b16 a[20:21], v4 offset:8192
v_mfma_f32_16x16x32_bf16 v[100:103], a[24:27], a[68:71], v[100:103]
buffer_load_dwordx4 v13, s[64:67], s62 offen offset:3072 lds
v_mfma_f32_16x16x32_bf16 v[100:103], a[28:31], a[84:87], v[100:103]
ds_read_b64_tr_b16 a[22:23], v4 offset:12288
s_add_u32 s60, s60, s57
v_mfma_f32_16x16x32_bf16 v[92:95], a[28:31], a[80:83], v[92:95]
s_and_b32 s60, s60, 0x1c000
s_or_b32 s60, s60, 0x20000
s_add_u32 s101, s63, s60
v_mfma_f32_16x16x32_bf16 v[92:95], a[24:27], a[64:67], v[92:95]
s_waitcnt lgkmcnt(4)
v_mfma_f32_16x16x32_bf16 v[120:123], a[0:3], a[64:67], v[120:123]
ds_read_b64_tr_b16 a[24:25], v5 offset:0
v_mfma_f32_16x16x32_bf16 v[120:123], a[4:7], a[80:83], v[120:123]
buffer_load_dwordx4 a[160:163], v3, s[88:91], s101 offen sc1
v_mfma_f32_16x16x32_bf16 v[128:131], a[4:7], a[84:87], v[128:131]
ds_read_b64_tr_b16 a[26:27], v5 offset:4096
v_mfma_f32_16x16x32_bf16 v[128:131], a[0:3], a[68:71], v[128:131]
ds_read_b64_tr_b16 a[28:29], v5 offset:8192
v_mfma_f32_16x16x32_bf16 v[136:139], a[0:3], a[72:75], v[136:139]
ds_read_b64_tr_b16 a[30:31], v5 offset:12288
v_mfma_f32_16x16x32_bf16 v[136:139], a[4:7], a[88:91], v[136:139]
v_mfma_f32_16x16x32_bf16 v[144:147], a[4:7], a[92:95], v[144:147]
s_waitcnt vmcnt(13)
v_mfma_f32_16x16x32_bf16 v[144:147], a[0:3], a[76:79], v[144:147]
s_barrier
v_mfma_f32_16x16x32_bf16 v[148:151], a[8:11], a[76:79], v[148:151]
buffer_load_dwordx4 a[164:167], v3, s[88:91], s101 offen offset:1024 sc1
v_mfma_f32_16x16x32_bf16 v[148:151], a[12:15], a[92:95], v[148:151]
ds_read_b64_tr_b16 a[0:1], v4 offset:16640
v_sub_f32 v20, 1.0, v8
v_mfma_f32_16x16x32_bf16 v[140:143], a[12:15], a[88:91], v[140:143]
ds_read_b64_tr_b16 a[2:3], v4 offset:20736
v_sub_f32 v21, 1.0, v9
v_mfma_f32_16x16x32_bf16 v[140:143], a[8:11], a[72:75], v[140:143]
buffer_load_dwordx4 a[168:171], v3, s[88:91], s101 offen offset:2048 sc1
v_mfma_f32_16x16x32_bf16 v[132:135], a[8:11], a[68:71], v[132:135]
ds_read_b64_tr_b16 a[4:5], v4 offset:24832
v_sub_f32 v22, 1.0, v10
v_mfma_f32_16x16x32_bf16 v[132:135], a[12:15], a[84:87], v[132:135]
ds_read_b64_tr_b16 a[6:7], v4 offset:28928
v_sub_f32 v23, 1.0, v11
v_mfma_f32_16x16x32_bf16 v[124:127], a[12:15], a[80:83], v[124:127]
s_waitcnt lgkmcnt(4)
v_accvgpr_read_b32 v18, a32
v_mul_f32 v18, v20, v18
v_mfma_f32_16x16x32_bf16 v[124:127], a[8:11], a[64:67], v[124:127]
buffer_load_dwordx4 a[172:175], v3, s[88:91], s101 offen offset:3072 sc1
v_mfma_f32_16x16x32_bf16 v[24:27], a[16:19], a[64:67], v[24:27]
ds_read_b64_tr_b16 a[8:9], v5 offset:16640
s_add_u32 s101, s101, 0x2000
v_mfma_f32_16x16x32_bf16 v[24:27], a[20:23], a[80:83], v[24:27]
ds_read_b64_tr_b16 a[10:11], v5 offset:20736
v_accvgpr_write_b32 a32, v18
v_mfma_f32_16x16x32_bf16 v[32:35], a[20:23], a[84:87], v[32:35]
ds_read_b64_tr_b16 a[12:13], v5 offset:24832
v_accvgpr_read_b32 v18, a33
v_mfma_f32_16x16x32_bf16 v[32:35], a[16:19], a[68:71], v[32:35]
buffer_load_dwordx4 a[176:179], v3, s[88:91], s101 offen sc1
v_mfma_f32_16x16x32_bf16 v[40:43], a[16:19], a[72:75], v[40:43]
ds_read_b64_tr_b16 a[14:15], v5 offset:28928
v_mul_f32 v18, v20, v18
v_mfma_f32_16x16x32_bf16 v[40:43], a[20:23], a[88:91], v[40:43]
v_accvgpr_write_b32 a33, v18
v_accvgpr_read_b32 v18, a34
v_mfma_f32_16x16x32_bf16 v[48:51], a[20:23], a[92:95], v[48:51]
v_mul_f32 v18, v20, v18
v_accvgpr_write_b32 a34, v18
v_mfma_f32_16x16x32_bf16 v[48:51], a[16:19], a[76:79], v[48:51]
v_accvgpr_read_b32 v18, a35
v_mul_f32 v18, v20, v18
v_mfma_f32_16x16x32_bf16 v[52:55], a[24:27], a[76:79], v[52:55]
buffer_load_dwordx4 a[180:183], v3, s[88:91], s101 offen offset:1024 sc1
v_mfma_f32_16x16x32_bf16 v[52:55], a[28:31], a[92:95], v[52:55]
ds_read_b64_tr_b16 a[16:17], v4 offset:16896
v_accvgpr_write_b32 a35, v18
v_mfma_f32_16x16x32_bf16 v[44:47], a[28:31], a[88:91], v[44:47]
ds_read_b64_tr_b16 a[18:19], v4 offset:20992
v_accvgpr_read_b32 v18, a40
v_mfma_f32_16x16x32_bf16 v[44:47], a[24:27], a[72:75], v[44:47]
ds_read_b64_tr_b16 a[20:21], v4 offset:25088
v_mul_f32 v18, v21, v18
v_mfma_f32_16x16x32_bf16 v[36:39], a[24:27], a[68:71], v[36:39]
ds_read_b64_tr_b16 a[22:23], v4 offset:29184
v_accvgpr_write_b32 a40, v18
v_mfma_f32_16x16x32_bf16 v[36:39], a[28:31], a[84:87], v[36:39]
buffer_load_dwordx4 a[184:187], v3, s[88:91], s101 offen offset:2048 sc1
v_mfma_f32_16x16x32_bf16 v[28:31], a[28:31], a[80:83], v[28:31]
v_accvgpr_read_b32 v18, a41
v_mul_f32 v18, v21, v18
v_mfma_f32_16x16x32_bf16 v[28:31], a[24:27], a[64:67], v[28:31]
s_waitcnt lgkmcnt(4)
v_accvgpr_write_b32 a41, v18
v_accvgpr_read_b32 v18, a42
v_mfma_f32_16x16x32_bf16 v[56:59], a[0:3], a[96:99], v[56:59]
ds_read_b64_tr_b16 a[24:25], v5 offset:16896
v_mul_f32 v18, v21, v18
v_mfma_f32_16x16x32_bf16 v[56:59], a[4:7], a[112:115], v[56:59]
buffer_load_dwordx4 a[188:191], v3, s[88:91], s101 offen offset:3072 sc1
v_mfma_f32_16x16x32_bf16 v[64:67], a[4:7], a[116:119], v[64:67]
ds_read_b64_tr_b16 a[26:27], v5 offset:20992
s_add_u32 m0, s17, 0x1c000
v_mfma_f32_16x16x32_bf16 v[64:67], a[0:3], a[100:103], v[64:67]
ds_read_b64_tr_b16 a[28:29], v5 offset:25088
s_lshl_b32 s61, s60, 3
v_mfma_f32_16x16x32_bf16 v[72:75], a[0:3], a[104:107], v[72:75]
ds_read_b64_tr_b16 a[30:31], v5 offset:29184
s_add_u32 s62, s61, s12
v_mfma_f32_16x16x32_bf16 v[72:75], a[4:7], a[120:123], v[72:75]
v_accvgpr_write_b32 a42, v18
v_accvgpr_read_b32 v18, a43
v_mfma_f32_16x16x32_bf16 v[80:83], a[4:7], a[124:127], v[80:83]
buffer_load_dwordx4 v12, s[64:67], s61 offen lds
v_mfma_f32_16x16x32_bf16 v[80:83], a[0:3], a[108:111], v[80:83]
v_mul_f32 v18, v21, v18
v_accvgpr_write_b32 a43, v18
v_mfma_f32_16x16x32_bf16 v[84:87], a[8:11], a[108:111], v[84:87]
ds_read_b64_tr_b16 a[0:1], v4 offset:17152
v_accvgpr_read_b32 v18, a48
v_mfma_f32_16x16x32_bf16 v[84:87], a[12:15], a[124:127], v[84:87]
ds_read_b64_tr_b16 a[2:3], v4 offset:21248
v_mul_f32 v18, v22, v18
v_mfma_f32_16x16x32_bf16 v[76:79], a[12:15], a[120:123], v[76:79]
buffer_load_dwordx4 v13, s[64:67], s61 offen offset:1024 lds
v_mfma_f32_16x16x32_bf16 v[76:79], a[8:11], a[104:107], v[76:79]
ds_read_b64_tr_b16 a[4:5], v4 offset:25344
v_accvgpr_write_b32 a48, v18
v_mfma_f32_16x16x32_bf16 v[68:71], a[8:11], a[100:103], v[68:71]
ds_read_b64_tr_b16 a[6:7], v4 offset:29440
v_accvgpr_read_b32 v18, a49
v_mfma_f32_16x16x32_bf16 v[68:71], a[12:15], a[116:119], v[68:71]
v_mul_f32 v18, v22, v18
v_accvgpr_write_b32 a49, v18
v_mfma_f32_16x16x32_bf16 v[60:63], a[12:15], a[112:115], v[60:63]
s_waitcnt lgkmcnt(4)
v_accvgpr_read_b32 v18, a50
v_mul_f32 v18, v22, v18
v_mfma_f32_16x16x32_bf16 v[60:63], a[8:11], a[96:99], v[60:63]
buffer_load_dwordx4 v12, s[64:67], s62 offen offset:2048 lds
v_mfma_f32_16x16x32_bf16 v[88:91], a[16:19], a[96:99], v[88:91]
ds_read_b64_tr_b16 a[8:9], v5 offset:17152
v_accvgpr_write_b32 a50, v18
v_mfma_f32_16x16x32_bf16 v[88:91], a[20:23], a[112:115], v[88:91]
ds_read_b64_tr_b16 a[10:11], v5 offset:21248
v_accvgpr_read_b32 v18, a51
v_mfma_f32_16x16x32_bf16 v[96:99], a[20:23], a[116:119], v[96:99]
ds_read_b64_tr_b16 a[12:13], v5 offset:25344
v_mul_f32 v18, v22, v18
v_mfma_f32_16x16x32_bf16 v[96:99], a[16:19], a[100:103], v[96:99]
ds_read_b64_tr_b16 a[14:15], v5 offset:29440
v_accvgpr_write_b32 a51, v18
v_mfma_f32_16x16x32_bf16 v[104:107], a[16:19], a[104:107], v[104:107]
buffer_load_dwordx4 v13, s[64:67], s62 offen offset:3072 lds
v_mfma_f32_16x16x32_bf16 v[104:107], a[20:23], a[120:123], v[104:107]
s_add_u32 s60, s60, s58
s_and_b32 s60, s60, 0x1c000
s_or_b32 s60, s60, 0x20000
v_mfma_f32_16x16x32_bf16 v[112:115], a[20:23], a[124:127], v[112:115]
s_add_u32 s101, s63, s60
v_mul_f32 v152, v23, v152
v_mul_f32 v153, v23, v153
v_mfma_f32_16x16x32_bf16 v[112:115], a[16:19], a[108:111], v[112:115]
v_mul_f32 v154, v23, v154
v_mul_f32 v155, v23, v155
v_mfma_f32_16x16x32_bf16 v[116:119], a[24:27], a[108:111], v[116:119]
buffer_load_dwordx4 a[192:195], v3, s[88:91], s101 offen sc1
v_mfma_f32_16x16x32_bf16 v[116:119], a[28:31], a[124:127], v[116:119]
ds_read_b64_tr_b16 a[16:17], v4 offset:16384
v_accvgpr_read_b32 v18, a36
v_mfma_f32_16x16x32_bf16 v[108:111], a[28:31], a[120:123], v[108:111]
ds_read_b64_tr_b16 a[18:19], v4 offset:20480
v_mul_f32 v18, v20, v18
v_mfma_f32_16x16x32_bf16 v[108:111], a[24:27], a[104:107], v[108:111]
ds_read_b64_tr_b16 a[20:21], v4 offset:24576
v_accvgpr_write_b32 a36, v18
v_mfma_f32_16x16x32_bf16 v[100:103], a[24:27], a[100:103], v[100:103]
ds_read_b64_tr_b16 a[22:23], v4 offset:28672
v_accvgpr_read_b32 v18, a37
v_mfma_f32_16x16x32_bf16 v[100:103], a[28:31], a[116:119], v[100:103]
buffer_load_dwordx4 a[196:199], v3, s[88:91], s101 offen offset:1024 sc1
v_mfma_f32_16x16x32_bf16 v[92:95], a[28:31], a[112:115], v[92:95]
v_mul_f32 v18, v20, v18
v_accvgpr_write_b32 a37, v18
v_mfma_f32_16x16x32_bf16 v[92:95], a[24:27], a[96:99], v[92:95]
s_waitcnt lgkmcnt(4)
v_accvgpr_read_b32 v18, a38
v_mul_f32 v18, v20, v18
v_mfma_f32_16x16x32_bf16 v[120:123], a[0:3], a[96:99], v[120:123]
ds_read_b64_tr_b16 a[24:25], v5 offset:16384
v_accvgpr_write_b32 a38, v18
v_mfma_f32_16x16x32_bf16 v[120:123], a[4:7], a[112:115], v[120:123]
buffer_load_dwordx4 a[200:203], v3, s[88:91], s101 offen offset:2048 sc1
v_mfma_f32_16x16x32_bf16 v[128:131], a[4:7], a[116:119], v[128:131]
ds_read_b64_tr_b16 a[26:27], v5 offset:20480
v_accvgpr_read_b32 v18, a39
v_mfma_f32_16x16x32_bf16 v[128:131], a[0:3], a[100:103], v[128:131]
ds_read_b64_tr_b16 a[28:29], v5 offset:24576
v_mul_f32 v18, v20, v18
v_mfma_f32_16x16x32_bf16 v[136:139], a[0:3], a[104:107], v[136:139]
ds_read_b64_tr_b16 a[30:31], v5 offset:28672
v_accvgpr_write_b32 a39, v18
v_mfma_f32_16x16x32_bf16 v[136:139], a[4:7], a[120:123], v[136:139]
v_accvgpr_read_b32 v18, a44
v_mul_f32 v18, v21, v18
v_mfma_f32_16x16x32_bf16 v[144:147], a[4:7], a[124:127], v[144:147]
s_waitcnt vmcnt(15)
v_accvgpr_write_b32 a44, v18
v_accvgpr_read_b32 v18, a45
v_mfma_f32_16x16x32_bf16 v[144:147], a[0:3], a[108:111], v[144:147]
s_barrier
v_mul_f32 v18, v21, v18
v_accvgpr_write_b32 a45, v18
v_mfma_f32_16x16x32_bf16 v[148:151], a[8:11], a[108:111], v[148:151]
buffer_load_dwordx4 a[204:207], v3, s[88:91], s101 offen offset:3072 sc1
v_mfma_f32_16x16x32_bf16 v[148:151], a[12:15], a[124:127], v[148:151]
ds_read_b64_tr_b16 a[0:1], v4 offset:33024
s_add_u32 s101, s101, 0x2000
v_mfma_f32_16x16x32_bf16 v[140:143], a[12:15], a[120:123], v[140:143]
ds_read_b64_tr_b16 a[2:3], v4 offset:37120
v_accvgpr_read_b32 v18, a46
v_mfma_f32_16x16x32_bf16 v[140:143], a[8:11], a[104:107], v[140:143]
ds_read_b64_tr_b16 a[4:5], v4 offset:41216
v_mul_f32 v18, v21, v18
v_mfma_f32_16x16x32_bf16 v[132:135], a[8:11], a[100:103], v[132:135]
buffer_load_dwordx4 a[208:211], v3, s[88:91], s101 offen sc1
v_mfma_f32_16x16x32_bf16 v[132:135], a[12:15], a[116:119], v[132:135]
ds_read_b64_tr_b16 a[6:7], v4 offset:45312
v_accvgpr_write_b32 a46, v18
v_mfma_f32_16x16x32_bf16 v[124:127], a[12:15], a[112:115], v[124:127]
s_waitcnt lgkmcnt(4)
v_accvgpr_read_b32 v18, a47
v_mul_f32 v18, v21, v18
v_mfma_f32_16x16x32_bf16 v[124:127], a[8:11], a[96:99], v[124:127]
buffer_load_dwordx4 a[212:215], v3, s[88:91], s101 offen offset:1024 sc1
v_mfma_f32_16x16x32_bf16 v[24:27], a[16:19], a[96:99], v[24:27]
ds_read_b64_tr_b16 a[8:9], v5 offset:33024
v_accvgpr_write_b32 a47, v18
v_mfma_f32_16x16x32_bf16 v[24:27], a[20:23], a[112:115], v[24:27]
ds_read_b64_tr_b16 a[10:11], v5 offset:37120
v_accvgpr_read_b32 v18, a52
v_mfma_f32_16x16x32_bf16 v[32:35], a[20:23], a[116:119], v[32:35]
ds_read_b64_tr_b16 a[12:13], v5 offset:41216
v_mul_f32 v18, v22, v18
v_mfma_f32_16x16x32_bf16 v[32:35], a[16:19], a[100:103], v[32:35]
ds_read_b64_tr_b16 a[14:15], v5 offset:45312
v_accvgpr_write_b32 a52, v18
v_mfma_f32_16x16x32_bf16 v[40:43], a[16:19], a[104:107], v[40:43]
buffer_load_dwordx4 a[216:219], v3, s[88:91], s101 offen offset:2048 sc1
v_mfma_f32_16x16x32_bf16 v[40:43], a[20:23], a[120:123], v[40:43]
v_accvgpr_read_b32 v18, a53
v_mul_f32 v18, v22, v18
v_mfma_f32_16x16x32_bf16 v[48:51], a[20:23], a[124:127], v[48:51]
v_accvgpr_write_b32 a53, v18
v_accvgpr_read_b32 v18, a54
v_mfma_f32_16x16x32_bf16 v[48:51], a[16:19], a[108:111], v[48:51]
v_mul_f32 v18, v22, v18
v_accvgpr_write_b32 a54, v18
v_mfma_f32_16x16x32_bf16 v[52:55], a[24:27], a[108:111], v[52:55]
buffer_load_dwordx4 a[220:223], v3, s[88:91], s101 offen offset:3072 sc1
v_mfma_f32_16x16x32_bf16 v[52:55], a[28:31], a[124:127], v[52:55]
ds_read_b64_tr_b16 a[16:17], v4 offset:33280
s_add_u32 m0, s17, 0x20000
v_mfma_f32_16x16x32_bf16 v[44:47], a[28:31], a[120:123], v[44:47]
ds_read_b64_tr_b16 a[18:19], v4 offset:37376
s_lshl_b32 s61, s60, 3
v_mfma_f32_16x16x32_bf16 v[44:47], a[24:27], a[104:107], v[44:47]
ds_read_b64_tr_b16 a[20:21], v4 offset:41472
s_add_u32 s62, s61, s12
v_mfma_f32_16x16x32_bf16 v[36:39], a[24:27], a[100:103], v[36:39]
ds_read_b64_tr_b16 a[22:23], v4 offset:45568
v_accvgpr_read_b32 v18, a55
v_mfma_f32_16x16x32_bf16 v[36:39], a[28:31], a[116:119], v[36:39]
buffer_load_dwordx4 v12, s[64:67], s61 offen lds
v_mfma_f32_16x16x32_bf16 v[28:31], a[28:31], a[112:115], v[28:31]
v_mul_f32 v18, v22, v18
v_accvgpr_write_b32 a55, v18
v_mfma_f32_16x16x32_bf16 v[28:31], a[24:27], a[96:99], v[28:31]
L_padC1:
s_cmp_eq_u32 s95, 1
s_cbranch_scc1 L_padC3
s_waitcnt lgkmcnt(4)
v_mul_f32 v156, v23, v156
v_mul_f32 v157, v23, v157
v_mfma_f32_16x16x32_bf16 v[56:59], a[0:3], a[128:131], v[56:59]
ds_read_b64_tr_b16 a[24:25], v5 offset:33280
v_mul_f32 v158, v23, v158
v_mfma_f32_16x16x32_bf16 v[56:59], a[4:7], a[144:147], v[56:59]
ds_read_b64_tr_b16 a[26:27], v5 offset:37376
v_mul_f32 v159, v23, v159
v_mfma_f32_16x16x32_bf16 v[64:67], a[4:7], a[148:151], v[64:67]
buffer_load_dwordx4 v13, s[64:67], s61 offen offset:1024 lds
v_mfma_f32_16x16x32_bf16 v[64:67], a[0:3], a[132:135], v[64:67]
ds_read_b64_tr_b16 a[28:29], v5 offset:41472
v_mul_f32 v160, v20, v160
v_mfma_f32_16x16x32_bf16 v[72:75], a[0:3], a[136:139], v[72:75]
ds_read_b64_tr_b16 a[30:31], v5 offset:45568
v_mul_f32 v161, v20, v161
v_mfma_f32_16x16x32_bf16 v[72:75], a[4:7], a[152:155], v[72:75]
v_mul_f32 v162, v20, v162
v_mul_f32 v163, v20, v163
v_mfma_f32_16x16x32_bf16 v[80:83], a[4:7], a[156:159], v[80:83]
buffer_load_dwordx4 v12, s[64:67], s62 offen offset:2048 lds
v_mfma_f32_16x16x32_bf16 v[80:83], a[0:3], a[140:143], v[80:83]
v_mul_f32 v168, v21, v168
v_mul_f32 v169, v21, v169
v_mfma_f32_16x16x32_bf16 v[84:87], a[8:11], a[140:143], v[84:87]
ds_read_b64_tr_b16 a[0:1], v4 offset:33536
v_mul_f32 v170, v21, v170
v_mfma_f32_16x16x32_bf16 v[84:87], a[12:15], a[156:159], v[84:87]
ds_read_b64_tr_b16 a[2:3], v4 offset:37632
v_mul_f32 v171, v21, v171
v_mfma_f32_16x16x32_bf16 v[76:79], a[12:15], a[152:155], v[76:79]
ds_read_b64_tr_b16 a[4:5], v4 offset:41728
v_mul_f32 v176, v22, v176
v_mfma_f32_16x16x32_bf16 v[76:79], a[8:11], a[136:139], v[76:79]
buffer_load_dwordx4 v13, s[64:67], s62 offen offset:3072 lds
v_mfma_f32_16x16x32_bf16 v[68:71], a[8:11], a[132:135], v[68:71]
ds_read_b64_tr_b16 a[6:7], v4 offset:45824
s_add_u32 s60, s60, s59
v_mfma_f32_16x16x32_bf16 v[68:71], a[12:15], a[148:151], v[68:71]
s_and_b32 s60, s60, 0x1c000
s_or_b32 s60, s60, 0x20000
s_add_u32 s101, s63, s60
v_mfma_f32_16x16x32_bf16 v[60:63], a[12:15], a[144:147], v[60:63]
s_waitcnt lgkmcnt(4)
v_mul_f32 v177, v22, v177
v_mul_f32 v178, v22, v178
v_mfma_f32_16x16x32_bf16 v[60:63], a[8:11], a[128:131], v[60:63]
buffer_load_dwordx4 a[224:227], v3, s[88:91], s101 offen sc1
v_mfma_f32_16x16x32_bf16 v[88:91], a[16:19], a[128:131], v[88:91]
ds_read_b64_tr_b16 a[8:9], v5 offset:33536
v_mul_f32 v179, v22, v179
v_mfma_f32_16x16x32_bf16 v[88:91], a[20:23], a[144:147], v[88:91]
ds_read_b64_tr_b16 a[10:11], v5 offset:37632
v_mul_f32 v184, v23, v184
v_mfma_f32_16x16x32_bf16 v[96:99], a[20:23], a[148:151], v[96:99]
ds_read_b64_tr_b16 a[12:13], v5 offset:41728
v_mul_f32 v185, v23, v185
v_mfma_f32_16x16x32_bf16 v[96:99], a[16:19], a[132:135], v[96:99]
ds_read_b64_tr_b16 a[14:15], v5 offset:45824
v_mul_f32 v186, v23, v186
v_mfma_f32_16x16x32_bf16 v[104:107], a[16:19], a[136:139], v[104:107]
buffer_load_dwordx4 a[228:231], v3, s[88:91], s101 offen offset:1024 sc1
v_mfma_f32_16x16x32_bf16 v[104:107], a[20:23], a[152:155], v[104:107]
v_mul_f32 v187, v23, v187
v_mul_f32 v164, v20, v164
v_mfma_f32_16x16x32_bf16 v[112:115], a[20:23], a[156:159], v[112:115]
buffer_load_dword v14, v1, s[88:91], s24 offen sc1
v_mfma_f32_16x16x32_bf16 v[112:115], a[16:19], a[140:143], v[112:115]
v_mul_f32 v165, v20, v165
v_mul_f32 v166, v20, v166
v_mfma_f32_16x16x32_bf16 v[116:119], a[24:27], a[140:143], v[116:119]
ds_read_b64_tr_b16 a[16:17], v4 offset:32768
v_mul_f32 v167, v20, v167
v_mfma_f32_16x16x32_bf16 v[116:119], a[28:31], a[156:159], v[116:119]
buffer_load_dwordx4 a[232:235], v3, s[88:91], s101 offen offset:2048 sc1
v_mfma_f32_16x16x32_bf16 v[108:111], a[28:31], a[152:155], v[108:111]
ds_read_b64_tr_b16 a[18:19], v4 offset:36864
v_mul_f32 v172, v21, v172
v_mfma_f32_16x16x32_bf16 v[108:111], a[24:27], a[136:139], v[108:111]
ds_read_b64_tr_b16 a[20:21], v4 offset:40960
v_mul_f32 v173, v21, v173
v_mfma_f32_16x16x32_bf16 v[100:103], a[24:27], a[132:135], v[100:103]
ds_read_b64_tr_b16 a[22:23], v4 offset:45056
v_mul_f32 v174, v21, v174
v_mfma_f32_16x16x32_bf16 v[100:103], a[28:31], a[148:151], v[100:103]
buffer_load_dwordx4 a[236:239], v3, s[88:91], s101 offen offset:3072 sc1
v_mfma_f32_16x16x32_bf16 v[92:95], a[28:31], a[144:147], v[92:95]
s_add_u32 s101, s101, 0x2000
v_mul_f32 v175, v21, v175
v_mul_f32 v180, v22, v180
v_mfma_f32_16x16x32_bf16 v[92:95], a[24:27], a[128:131], v[92:95]
s_waitcnt lgkmcnt(4)
v_mul_f32 v181, v22, v181
v_mul_f32 v182, v22, v182
v_mfma_f32_16x16x32_bf16 v[120:123], a[0:3], a[128:131], v[120:123]
ds_read_b64_tr_b16 a[24:25], v5 offset:32768
v_mul_f32 v183, v22, v183
v_mfma_f32_16x16x32_bf16 v[120:123], a[4:7], a[144:147], v[120:123]
ds_read_b64_tr_b16 a[26:27], v5 offset:36864
v_mul_f32 v188, v23, v188
v_mfma_f32_16x16x32_bf16 v[128:131], a[4:7], a[148:151], v[128:131]
buffer_load_dwordx4 a[240:243], v3, s[88:91], s101 offen sc1
v_mfma_f32_16x16x32_bf16 v[128:131], a[0:3], a[132:135], v[128:131]
ds_read_b64_tr_b16 a[28:29], v5 offset:40960
v_mul_f32 v189, v23, v189
v_mfma_f32_16x16x32_bf16 v[136:139], a[0:3], a[136:139], v[136:139]
ds_read_b64_tr_b16 a[30:31], v5 offset:45056
v_mul_f32 v190, v23, v190
v_mfma_f32_16x16x32_bf16 v[136:139], a[4:7], a[152:155], v[136:139]
v_mul_f32 v191, v23, v191
v_mul_f32 v192, v20, v192
v_mfma_f32_16x16x32_bf16 v[144:147], a[4:7], a[156:159], v[144:147]
s_waitcnt vmcnt(18)
v_mul_f32 v193, v20, v193
v_mul_f32 v194, v20, v194
v_mfma_f32_16x16x32_bf16 v[144:147], a[0:3], a[140:143], v[144:147]
s_barrier
v_mul_f32 v195, v20, v195
v_mul_f32 v200, v21, v200
v_mfma_f32_16x16x32_bf16 v[148:151], a[8:11], a[140:143], v[148:151]
buffer_load_dwordx4 a[244:247], v3, s[88:91], s101 offen offset:1024 sc1
v_mfma_f32_16x16x32_bf16 v[148:151], a[12:15], a[156:159], v[148:151]
ds_read_b64_tr_b16 a[0:1], v4 offset:49408
v_mul_f32 v201, v21, v201
v_mfma_f32_16x16x32_bf16 v[140:143], a[12:15], a[152:155], v[140:143]
ds_read_b64_tr_b16 a[2:3], v4 offset:53504
v_mul_f32 v202, v21, v202
v_mfma_f32_16x16x32_bf16 v[140:143], a[8:11], a[136:139], v[140:143]
buffer_load_dwordx4 a[248:251], v3, s[88:91], s101 offen offset:2048 sc1
v_mfma_f32_16x16x32_bf16 v[132:135], a[8:11], a[132:135], v[132:135]
ds_read_b64_tr_b16 a[4:5], v4 offset:57600
v_mul_f32 v203, v21, v203
v_mfma_f32_16x16x32_bf16 v[132:135], a[12:15], a[148:151], v[132:135]
ds_read_b64_tr_b16 a[6:7], v4 offset:61696
v_mul_f32 v208, v22, v208
v_mfma_f32_16x16x32_bf16 v[124:127], a[12:15], a[144:147], v[124:127]
v_mul_f32 v209, v22, v209
v_mul_f32 v210, v22, v210
v_mfma_f32_16x16x32_bf16 v[124:127], a[8:11], a[128:131], v[124:127]
s_waitcnt lgkmcnt(4)
v_mul_f32 v211, v22, v211
v_mul_f32 v216, v23, v216
v_mfma_f32_16x16x32_bf16 v[24:27], a[16:19], a[128:131], v[24:27]
buffer_load_dwordx4 a[252:255], v3, s[88:91], s101 offen offset:3072 sc1
v_mfma_f32_16x16x32_bf16 v[24:27], a[20:23], a[144:147], v[24:27]
ds_read_b64_tr_b16 a[8:9], v5 offset:49408
s_add_u32 m0, s17, 0x24000
v_mfma_f32_16x16x32_bf16 v[32:35], a[20:23], a[148:151], v[32:35]
ds_read_b64_tr_b16 a[10:11], v5 offset:53504
s_lshl_b32 s61, s60, 3
v_mfma_f32_16x16x32_bf16 v[32:35], a[16:19], a[132:135], v[32:35]
ds_read_b64_tr_b16 a[12:13], v5 offset:57600
s_add_u32 s62, s61, s12
v_mfma_f32_16x16x32_bf16 v[40:43], a[16:19], a[136:139], v[40:43]
buffer_load_dwordx4 v12, s[64:67], s61 offen lds
v_mfma_f32_16x16x32_bf16 v[40:43], a[20:23], a[152:155], v[40:43]
ds_read_b64_tr_b16 a[14:15], v5 offset:61696
v_mul_f32 v217, v23, v217
v_mfma_f32_16x16x32_bf16 v[48:51], a[20:23], a[156:159], v[48:51]
v_mul_f32 v218, v23, v218
v_mul_f32 v219, v23, v219
v_mfma_f32_16x16x32_bf16 v[48:51], a[16:19], a[140:143], v[48:51]
v_mul_f32 v196, v20, v196
v_mul_f32 v197, v20, v197
v_mfma_f32_16x16x32_bf16 v[52:55], a[24:27], a[140:143], v[52:55]
ds_read_b64_tr_b16 a[16:17], v4 offset:49664
v_mul_f32 v198, v20, v198
v_mfma_f32_16x16x32_bf16 v[52:55], a[28:31], a[156:159], v[52:55]
buffer_load_dwordx4 v13, s[64:67], s61 offen offset:1024 lds
v_mfma_f32_16x16x32_bf16 v[44:47], a[28:31], a[152:155], v[44:47]
ds_read_b64_tr_b16 a[18:19], v4 offset:53760
v_mul_f32 v199, v20, v199
v_mfma_f32_16x16x32_bf16 v[44:47], a[24:27], a[136:139], v[44:47]
ds_read_b64_tr_b16 a[20:21], v4 offset:57856
v_mul_f32 v204, v21, v204
v_mfma_f32_16x16x32_bf16 v[36:39], a[24:27], a[132:135], v[36:39]
ds_read_b64_tr_b16 a[22:23], v4 offset:61952
v_mul_f32 v205, v21, v205
v_mfma_f32_16x16x32_bf16 v[36:39], a[28:31], a[148:151], v[36:39]
buffer_load_dwordx4 v12, s[64:67], s62 offen offset:2048 lds
v_mfma_f32_16x16x32_bf16 v[28:31], a[28:31], a[144:147], v[28:31]
v_mul_f32 v206, v21, v206
v_mul_f32 v207, v21, v207
v_mfma_f32_16x16x32_bf16 v[28:31], a[24:27], a[128:131], v[28:31]
s_waitcnt lgkmcnt(4)
v_mul_f32 v212, v22, v212
v_mul_f32 v213, v22, v213
v_mfma_f32_16x16x32_bf16 v[56:59], a[0:3], a[160:163], v[56:59]
ds_read_b64_tr_b16 a[24:25], v5 offset:49664
v_mul_f32 v214, v22, v214
v_mfma_f32_16x16x32_bf16 v[56:59], a[4:7], a[176:179], v[56:59]
ds_read_b64_tr_b16 a[26:27], v5 offset:53760
v_mul_f32 v215, v22, v215
v_mfma_f32_16x16x32_bf16 v[64:67], a[4:7], a[180:183], v[64:67]
buffer_load_dwordx4 v13, s[64:67], s62 offen offset:3072 lds
v_mfma_f32_16x16x32_bf16 v[64:67], a[0:3], a[164:167], v[64:67]
ds_read_b64_tr_b16 a[28:29], v5 offset:57856
s_add_u32 s60, s60, s56
v_mfma_f32_16x16x32_bf16 v[72:75], a[0:3], a[168:171], v[72:75]
ds_read_b64_tr_b16 a[30:31], v5 offset:61952
s_and_b32 s60, s60, 0x1c000
v_mfma_f32_16x16x32_bf16 v[72:75], a[4:7], a[184:187], v[72:75]
s_add_u32 s101, s63, s60
v_mul_f32 v220, v23, v220
v_mul_f32 v221, v23, v221
v_mfma_f32_16x16x32_bf16 v[80:83], a[4:7], a[188:191], v[80:83]
s_waitcnt vmcnt(10)
v_mul_f32 v222, v23, v222
v_mul_f32 v223, v23, v223
s_mov_b32 s92, 200000
L_spin_db:
v_cmp_eq_u32 vcc, 0, v14
s_nop 4
s_cbranch_vccz L_spun_db
s_sub_u32 s92, s92, 1
s_cbranch_scc1 L_spun_db
s_sleep 6
buffer_load_dword v14, v1, s[88:91], s24 offen sc1
s_waitcnt vmcnt(0)
s_branch L_spin_db
L_spun_db:
v_mfma_f32_16x16x32_bf16 v[80:83], a[0:3], a[172:175], v[80:83]
buffer_load_dwordx4 a[64:67], v3, s[88:91], s101 offen sc1
v_mfma_f32_16x16x32_bf16 v[84:87], a[8:11], a[172:175], v[84:87]
ds_read_b64_tr_b16 a[0:1], v4 offset:49920
v_mul_f32 v224, v20, v224
v_mfma_f32_16x16x32_bf16 v[84:87], a[12:15], a[188:191], v[84:87]
ds_read_b64_tr_b16 a[2:3], v4 offset:54016
v_mul_f32 v225, v20, v225
v_mfma_f32_16x16x32_bf16 v[76:79], a[12:15], a[184:187], v[76:79]
ds_read_b64_tr_b16 a[4:5], v4 offset:58112
v_mul_f32 v226, v20, v226
v_mfma_f32_16x16x32_bf16 v[76:79], a[8:11], a[168:171], v[76:79]
buffer_load_dwordx4 a[68:71], v3, s[88:91], s101 offen offset:1024 sc1
v_mfma_f32_16x16x32_bf16 v[68:71], a[8:11], a[164:167], v[68:71]
ds_read_b64_tr_b16 a[6:7], v4 offset:62208
v_mul_f32 v227, v20, v227
v_mfma_f32_16x16x32_bf16 v[68:71], a[12:15], a[180:183], v[68:71]
v_mul_f32 v232, v21, v232
v_mul_f32 v233, v21, v233
v_mfma_f32_16x16x32_bf16 v[60:63], a[12:15], a[176:179], v[60:63]
v_mul_f32 v234, v21, v234
v_mul_f32 v235, v21, v235
v_mfma_f32_16x16x32_bf16 v[60:63], a[8:11], a[160:163], v[60:63]
s_waitcnt lgkmcnt(4)
v_mul_f32 v240, v22, v240
v_mul_f32 v241, v22, v241
v_mfma_f32_16x16x32_bf16 v[88:91], a[16:19], a[160:163], v[88:91]
buffer_load_dwordx4 a[72:75], v3, s[88:91], s101 offen offset:2048 sc1
v_mfma_f32_16x16x32_bf16 v[88:91], a[20:23], a[176:179], v[88:91]
ds_read_b64_tr_b16 a[8:9], v5 offset:49920
v_mul_f32 v242, v22, v242
v_mfma_f32_16x16x32_bf16 v[96:99], a[20:23], a[180:183], v[96:99]
ds_read_b64_tr_b16 a[10:11], v5 offset:54016
v_mul_f32 v243, v22, v243
v_mfma_f32_16x16x32_bf16 v[96:99], a[16:19], a[164:167], v[96:99]
ds_read_b64_tr_b16 a[12:13], v5 offset:58112
v_mul_f32 v248, v23, v248
v_mfma_f32_16x16x32_bf16 v[104:107], a[16:19], a[168:171], v[104:107]
buffer_load_dwordx4 a[76:79], v3, s[88:91], s101 offen offset:3072 sc1
v_mfma_f32_16x16x32_bf16 v[104:107], a[20:23], a[184:187], v[104:107]
ds_read_b64_tr_b16 a[14:15], v5 offset:62208
s_add_u32 s101, s101, 0x2000
v_mfma_f32_16x16x32_bf16 v[112:115], a[20:23], a[188:191], v[112:115]
v_mul_f32 v249, v23, v249
v_mul_f32 v250, v23, v250
v_mfma_f32_16x16x32_bf16 v[112:115], a[16:19], a[172:175], v[112:115]
v_mul_f32 v251, v23, v251
v_mul_f32 v228, v20, v228
v_mfma_f32_16x16x32_bf16 v[116:119], a[24:27], a[172:175], v[116:119]
ds_read_b64_tr_b16 a[16:17], v4 offset:49152
v_mul_f32 v229, v20, v229
v_mfma_f32_16x16x32_bf16 v[116:119], a[28:31], a[188:191], v[116:119]
buffer_load_dwordx4 a[80:83], v3, s[88:91], s101 offen sc1
v_mfma_f32_16x16x32_bf16 v[108:111], a[28:31], a[184:187], v[108:111]
ds_read_b64_tr_b16 a[18:19], v4 offset:53248
v_mul_f32 v230, v20, v230
v_mfma_f32_16x16x32_bf16 v[108:111], a[24:27], a[168:171], v[108:111]
ds_read_b64_tr_b16 a[20:21], v4 offset:57344
v_mul_f32 v231, v20, v231
v_mfma_f32_16x16x32_bf16 v[100:103], a[24:27], a[164:167], v[100:103]
ds_read_b64_tr_b16 a[22:23], v4 offset:61440
v_mul_f32 v236, v21, v236
v_mfma_f32_16x16x32_bf16 v[100:103], a[28:31], a[180:183], v[100:103]
v_mul_f32 v237, v21, v237
v_mul_f32 v238, v21, v238
v_mfma_f32_16x16x32_bf16 v[92:95], a[28:31], a[176:179], v[92:95]
buffer_load_dwordx4 a[84:87], v3, s[88:91], s101 offen offset:1024 sc1
v_mfma_f32_16x16x32_bf16 v[92:95], a[24:27], a[160:163], v[92:95]
s_waitcnt lgkmcnt(4)
v_mul_f32 v239, v21, v239
v_mul_f32 v244, v22, v244
v_mfma_f32_16x16x32_bf16 v[120:123], a[0:3], a[160:163], v[120:123]
ds_read_b64_tr_b16 a[24:25], v5 offset:49152
v_mul_f32 v245, v22, v245
v_mfma_f32_16x16x32_bf16 v[120:123], a[4:7], a[176:179], v[120:123]
ds_read_b64_tr_b16 a[26:27], v5 offset:53248
v_mul_f32 v246, v22, v246
v_mfma_f32_16x16x32_bf16 v[128:131], a[4:7], a[180:183], v[128:131]
buffer_load_dwordx4 a[88:91], v3, s[88:91], s101 offen offset:2048 sc1
v_mfma_f32_16x16x32_bf16 v[128:131], a[0:3], a[164:167], v[128:131]
ds_read_b64_tr_b16 a[28:29], v5 offset:57344
v_mul_f32 v247, v22, v247
v_mfma_f32_16x16x32_bf16 v[136:139], a[0:3], a[168:171], v[136:139]
ds_read_b64_tr_b16 a[30:31], v5 offset:61440
v_mul_f32 v252, v23, v252
v_mfma_f32_16x16x32_bf16 v[136:139], a[4:7], a[184:187], v[136:139]
v_mul_f32 v253, v23, v253
v_mul_f32 v254, v23, v254
v_mfma_f32_16x16x32_bf16 v[144:147], a[4:7], a[188:191], v[144:147]
s_waitcnt vmcnt(20)
v_mul_f32 v255, v23, v255
v_mfma_f32_16x16x32_bf16 v[144:147], a[0:3], a[172:175], v[144:147]
s_barrier
v_mfma_f32_16x16x32_bf16 v[148:151], a[8:11], a[172:175], v[148:151]
buffer_load_dwordx4 a[92:95], v3, s[88:91], s101 offen offset:3072 sc1
v_mfma_f32_16x16x32_bf16 v[148:151], a[12:15], a[188:191], v[148:151]
ds_read_b64_tr_b16 a[0:1], v15 offset:256
s_add_u32 m0, s17, 0x10000
v_mfma_f32_16x16x32_bf16 v[140:143], a[12:15], a[184:187], v[140:143]
ds_read_b64_tr_b16 a[2:3], v15 offset:4352
s_lshl_b32 s61, s60, 3
v_mfma_f32_16x16x32_bf16 v[140:143], a[8:11], a[168:171], v[140:143]
ds_read_b64_tr_b16 a[4:5], v15 offset:8448
s_add_u32 s62, s61, s12
v_mfma_f32_16x16x32_bf16 v[132:135], a[8:11], a[164:167], v[132:135]
buffer_load_dwordx4 v12, s[64:67], s61 offen lds
v_mfma_f32_16x16x32_bf16 v[132:135], a[12:15], a[180:183], v[132:135]
ds_read_b64_tr_b16 a[6:7], v15 offset:12544
v_mfma_f32_16x16x32_bf16 v[124:127], a[12:15], a[176:179], v[124:127]
v_mfma_f32_16x16x32_bf16 v[124:127], a[8:11], a[160:163], v[124:127]
s_waitcnt lgkmcnt(4)
v_mfma_f32_16x16x32_bf16 v[24:27], a[16:19], a[160:163], v[24:27]
buffer_load_dwordx4 v13, s[64:67], s61 offen offset:1024 lds
v_mfma_f32_16x16x32_bf16 v[24:27], a[20:23], a[176:179], v[24:27]
ds_read_b64_tr_b16 a[8:9], v19 offset:256
v_mfma_f32_16x16x32_bf16 v[32:35], a[20:23], a[180:183], v[32:35]
ds_read_b64_tr_b16 a[10:11], v19 offset:4352
v_mfma_f32_16x16x32_bf16 v[32:35], a[16:19], a[164:167], v[32:35]
ds_read_b64_tr_b16 a[12:13], v19 offset:8448
v_mfma_f32_16x16x32_bf16 v[40:43], a[16:19], a[168:171], v[40:43]
ds_read_b64_tr_b16 a[14:15], v19 offset:12544
v_mfma_f32_16x16x32_bf16 v[40:43], a[20:23], a[184:187], v[40:43]
buffer_load_dwordx4 v12, s[64:67], s62 offen offset:2048 lds
v_mfma_f32_16x16x32_bf16 v[48:51], a[20:23], a[188:191], v[48:51]
v_mfma_f32_16x16x32_bf16 v[48:51], a[16:19], a[172:175], v[48:51]
v_mfma_f32_16x16x32_bf16 v[52:55], a[24:27], a[172:175], v[52:55]
ds_read_b64_tr_b16 a[16:17], v15 offset:512
v_mfma_f32_16x16x32_bf16 v[52:55], a[28:31], a[188:191], v[52:55]
buffer_load_dwordx4 v13, s[64:67], s62 offen offset:3072 lds
v_mfma_f32_16x16x32_bf16 v[44:47], a[28:31], a[184:187], v[44:47]
ds_read_b64_tr_b16 a[18:19], v15 offset:4608
s_add_u32 s60, s60, s57
v_mfma_f32_16x16x32_bf16 v[44:47], a[24:27], a[168:171], v[44:47]
ds_read_b64_tr_b16 a[20:21], v15 offset:8704
s_and_b32 s60, s60, 0x1c000
v_mfma_f32_16x16x32_bf16 v[36:39], a[24:27], a[164:167], v[36:39]
ds_read_b64_tr_b16 a[22:23], v15 offset:12800
s_add_u32 s101, s63, s60
v_mfma_f32_16x16x32_bf16 v[36:39], a[28:31], a[180:183], v[36:39]
v_mfma_f32_16x16x32_bf16 v[28:31], a[28:31], a[176:179], v[28:31]
buffer_load_dwordx4 a[96:99], v3, s[88:91], s101 offen sc1
v_mfma_f32_16x16x32_bf16 v[28:31], a[24:27], a[160:163], v[28:31]
s_waitcnt lgkmcnt(4)
v_mfma_f32_16x16x32_bf16 v[56:59], a[0:3], a[192:195], v[56:59]
ds_read_b64_tr_b16 a[24:25], v19 offset:512
v_mfma_f32_16x16x32_bf16 v[56:59], a[4:7], a[208:211], v[56:59]
ds_read_b64_tr_b16 a[26:27], v19 offset:4608
v_mfma_f32_16x16x32_bf16 v[64:67], a[4:7], a[212:215], v[64:67]
buffer_load_dwordx4 a[100:103], v3, s[88:91], s101 offen offset:1024 sc1
v_mfma_f32_16x16x32_bf16 v[64:67], a[0:3], a[196:199], v[64:67]
ds_read_b64_tr_b16 a[28:29], v19 offset:8704
v_mfma_f32_16x16x32_bf16 v[72:75], a[0:3], a[200:203], v[72:75]
ds_read_b64_tr_b16 a[30:31], v19 offset:12800
v_mfma_f32_16x16x32_bf16 v[72:75], a[4:7], a[216:219], v[72:75]
v_mfma_f32_16x16x32_bf16 v[80:83], a[4:7], a[220:223], v[80:83]
v_mfma_f32_16x16x32_bf16 v[80:83], a[0:3], a[204:207], v[80:83]
buffer_load_dwordx4 a[104:107], v3, s[88:91], s101 offen offset:2048 sc1
v_mfma_f32_16x16x32_bf16 v[84:87], a[8:11], a[204:207], v[84:87]
ds_read_b64_tr_b16 a[0:1], v15 offset:768
v_mfma_f32_16x16x32_bf16 v[84:87], a[12:15], a[220:223], v[84:87]
ds_read_b64_tr_b16 a[2:3], v15 offset:4864
v_mfma_f32_16x16x32_bf16 v[76:79], a[12:15], a[216:219], v[76:79]
ds_read_b64_tr_b16 a[4:5], v15 offset:8960
v_mfma_f32_16x16x32_bf16 v[76:79], a[8:11], a[200:203], v[76:79]
ds_read_b64_tr_b16 a[6:7], v15 offset:13056
v_mfma_f32_16x16x32_bf16 v[68:71], a[8:11], a[196:199], v[68:71]
buffer_load_dwordx4 a[108:111], v3, s[88:91], s101 offen offset:3072 sc1
v_mfma_f32_16x16x32_bf16 v[68:71], a[12:15], a[212:215], v[68:71]
s_add_u32 s101, s101, 0x2000
v_mfma_f32_16x16x32_bf16 v[60:63], a[12:15], a[208:211], v[60:63]
v_mfma_f32_16x16x32_bf16 v[60:63], a[8:11], a[192:195], v[60:63]
s_waitcnt lgkmcnt(4)
v_mfma_f32_16x16x32_bf16 v[88:91], a[16:19], a[192:195], v[88:91]
buffer_load_dwordx4 a[112:115], v3, s[88:91], s101 offen sc1
v_mfma_f32_16x16x32_bf16 v[88:91], a[20:23], a[208:211], v[88:91]
ds_read_b64_tr_b16 a[8:9], v19 offset:768
v_mfma_f32_16x16x32_bf16 v[96:99], a[20:23], a[212:215], v[96:99]
ds_read_b64_tr_b16 a[10:11], v19 offset:4864
v_mfma_f32_16x16x32_bf16 v[96:99], a[16:19], a[196:199], v[96:99]
ds_read_b64_tr_b16 a[12:13], v19 offset:8960
v_mfma_f32_16x16x32_bf16 v[104:107], a[16:19], a[200:203], v[104:107]
ds_read_b64_tr_b16 a[14:15], v19 offset:13056
v_mfma_f32_16x16x32_bf16 v[104:107], a[20:23], a[216:219], v[104:107]
buffer_load_dwordx4 a[116:119], v3, s[88:91], s101 offen offset:1024 sc1
v_mfma_f32_16x16x32_bf16 v[112:115], a[20:23], a[220:223], v[112:115]
v_mfma_f32_16x16x32_bf16 v[112:115], a[16:19], a[204:207], v[112:115]
v_mfma_f32_16x16x32_bf16 v[116:119], a[24:27], a[204:207], v[116:119]
ds_read_b64_tr_b16 a[16:17], v15 offset:0
v_mfma_f32_16x16x32_bf16 v[116:119], a[28:31], a[220:223], v[116:119]
buffer_load_dwordx4 a[120:123], v3, s[88:91], s101 offen offset:2048 sc1
v_mfma_f32_16x16x32_bf16 v[108:111], a[28:31], a[216:219], v[108:111]
ds_read_b64_tr_b16 a[18:19], v15 offset:4096
v_mfma_f32_16x16x32_bf16 v[108:111], a[24:27], a[200:203], v[108:111]
ds_read_b64_tr_b16 a[20:21], v15 offset:8192
v_mfma_f32_16x16x32_bf16 v[100:103], a[24:27], a[196:199], v[100:103]
ds_read_b64_tr_b16 a[22:23], v15 offset:12288
v_mfma_f32_16x16x32_bf16 v[100:103], a[28:31], a[212:215], v[100:103]
v_mfma_f32_16x16x32_bf16 v[92:95], a[28:31], a[208:211], v[92:95]
buffer_load_dwordx4 a[124:127], v3, s[88:91], s101 offen offset:3072 sc1
v_mfma_f32_16x16x32_bf16 v[92:95], a[24:27], a[192:195], v[92:95]
s_waitcnt lgkmcnt(4)
s_add_u32 m0, s17, 0x14000
s_lshl_b32 s61, s60, 3
v_mfma_f32_16x16x32_bf16 v[120:123], a[0:3], a[192:195], v[120:123]
ds_read_b64_tr_b16 a[24:25], v19 offset:0
s_add_u32 s62, s61, s12
v_mfma_f32_16x16x32_bf16 v[120:123], a[4:7], a[208:211], v[120:123]
ds_read_b64_tr_b16 a[26:27], v19 offset:4096
v_mfma_f32_16x16x32_bf16 v[128:131], a[4:7], a[212:215], v[128:131]
ds_read_b64_tr_b16 a[28:29], v19 offset:8192
v_mfma_f32_16x16x32_bf16 v[128:131], a[0:3], a[196:199], v[128:131]
buffer_load_dwordx4 v12, s[64:67], s61 offen lds
v_mfma_f32_16x16x32_bf16 v[136:139], a[0:3], a[200:203], v[136:139]
ds_read_b64_tr_b16 a[30:31], v19 offset:12288
v_mfma_f32_16x16x32_bf16 v[136:139], a[4:7], a[216:219], v[136:139]
v_mfma_f32_16x16x32_bf16 v[144:147], a[4:7], a[220:223], v[144:147]
s_waitcnt vmcnt(21)
v_mfma_f32_16x16x32_bf16 v[144:147], a[0:3], a[204:207], v[144:147]
s_barrier
v_mfma_f32_16x16x32_bf16 v[148:151], a[8:11], a[204:207], v[148:151]
buffer_load_dwordx4 v13, s[64:67], s61 offen offset:1024 lds
v_mfma_f32_16x16x32_bf16 v[148:151], a[12:15], a[220:223], v[148:151]
ds_read_b64_tr_b16 a[0:1], v15 offset:16640
v_mfma_f32_16x16x32_bf16 v[140:143], a[12:15], a[216:219], v[140:143]
ds_read_b64_tr_b16 a[2:3], v15 offset:20736
v_mfma_f32_16x16x32_bf16 v[140:143], a[8:11], a[200:203], v[140:143]
ds_read_b64_tr_b16 a[4:5], v15 offset:24832
v_mfma_f32_16x16x32_bf16 v[132:135], a[8:11], a[196:199], v[132:135]
buffer_load_dwordx4 v12, s[64:67], s62 offen offset:2048 lds
v_mfma_f32_16x16x32_bf16 v[132:135], a[12:15], a[212:215], v[132:135]
ds_read_b64_tr_b16 a[6:7], v15 offset:28928
v_mfma_f32_16x16x32_bf16 v[124:127], a[12:15], a[208:211], v[124:127]
v_mfma_f32_16x16x32_bf16 v[124:127], a[8:11], a[192:195], v[124:127]
s_waitcnt lgkmcnt(4)
v_mfma_f32_16x16x32_bf16 v[24:27], a[16:19], a[192:195], v[24:27]
buffer_load_dwordx4 v13, s[64:67], s62 offen offset:3072 lds
v_mfma_f32_16x16x32_bf16 v[24:27], a[20:23], a[208:211], v[24:27]
ds_read_b64_tr_b16 a[8:9], v19 offset:16640
s_add_u32 s60, s60, s58
v_mfma_f32_16x16x32_bf16 v[32:35], a[20:23], a[212:215], v[32:35]
ds_read_b64_tr_b16 a[10:11], v19 offset:20736
s_and_b32 s60, s60, 0x1c000
v_mfma_f32_16x16x32_bf16 v[32:35], a[16:19], a[196:199], v[32:35]
ds_read_b64_tr_b16 a[12:13], v19 offset:24832
s_add_u32 s101, s63, s60
v_mfma_f32_16x16x32_bf16 v[40:43], a[16:19], a[200:203], v[40:43]
ds_read_b64_tr_b16 a[14:15], v19 offset:28928
v_mfma_f32_16x16x32_bf16 v[40:43], a[20:23], a[216:219], v[40:43]
buffer_load_dwordx4 a[128:131], v3, s[88:91], s101 offen sc1
v_mfma_f32_16x16x32_bf16 v[48:51], a[20:23], a[220:223], v[48:51]
v_mfma_f32_16x16x32_bf16 v[48:51], a[16:19], a[204:207], v[48:51]
v_mfma_f32_16x16x32_bf16 v[52:55], a[24:27], a[204:207], v[52:55]
ds_read_b64_tr_b16 a[16:17], v15 offset:16896
v_mfma_f32_16x16x32_bf16 v[52:55], a[28:31], a[220:223], v[52:55]
ds_read_b64_tr_b16 a[18:19], v15 offset:20992
v_mfma_f32_16x16x32_bf16 v[44:47], a[28:31], a[216:219], v[44:47]
buffer_load_dwordx4 a[132:135], v3, s[88:91], s101 offen offset:1024 sc1
v_mfma_f32_16x16x32_bf16 v[44:47], a[24:27], a[200:203], v[44:47]
ds_read_b64_tr_b16 a[20:21], v15 offset:25088
v_mfma_f32_16x16x32_bf16 v[36:39], a[24:27], a[196:199], v[36:39]
ds_read_b64_tr_b16 a[22:23], v15 offset:29184
v_mfma_f32_16x16x32_bf16 v[36:39], a[28:31], a[212:215], v[36:39]
v_mfma_f32_16x16x32_bf16 v[28:31], a[28:31], a[208:211], v[28:31]
buffer_load_dwordx4 a[136:139], v3, s[88:91], s101 offen offset:2048 sc1
v_mfma_f32_16x16x32_bf16 v[28:31], a[24:27], a[192:195], v[28:31]
s_waitcnt lgkmcnt(4)
v_mfma_f32_16x16x32_bf16 v[56:59], a[0:3], a[224:227], v[56:59]
ds_read_b64_tr_b16 a[24:25], v19 offset:16896
v_mfma_f32_16x16x32_bf16 v[56:59], a[4:7], a[240:243], v[56:59]
ds_read_b64_tr_b16 a[26:27], v19 offset:20992
v_mfma_f32_16x16x32_bf16 v[64:67], a[4:7], a[244:247], v[64:67]
ds_read_b64_tr_b16 a[28:29], v19 offset:25088
v_mfma_f32_16x16x32_bf16 v[64:67], a[0:3], a[228:231], v[64:67]
buffer_load_dwordx4 a[140:143], v3, s[88:91], s101 offen offset:3072 sc1
v_mfma_f32_16x16x32_bf16 v[72:75], a[0:3], a[232:235], v[72:75]
ds_read_b64_tr_b16 a[30:31], v19 offset:29184
s_add_u32 s101, s101, 0x2000
v_mfma_f32_16x16x32_bf16 v[72:75], a[4:7], a[248:251], v[72:75]
v_mfma_f32_16x16x32_bf16 v[80:83], a[4:7], a[252:255], v[80:83]
v_mfma_f32_16x16x32_bf16 v[80:83], a[0:3], a[236:239], v[80:83]
buffer_load_dwordx4 a[144:147], v3, s[88:91], s101 offen sc1
v_mfma_f32_16x16x32_bf16 v[84:87], a[8:11], a[236:239], v[84:87]
ds_read_b64_tr_b16 a[0:1], v15 offset:17152
v_mfma_f32_16x16x32_bf16 v[84:87], a[12:15], a[252:255], v[84:87]
ds_read_b64_tr_b16 a[2:3], v15 offset:21248
v_mfma_f32_16x16x32_bf16 v[76:79], a[12:15], a[248:251], v[76:79]
ds_read_b64_tr_b16 a[4:5], v15 offset:25344
v_mfma_f32_16x16x32_bf16 v[76:79], a[8:11], a[232:235], v[76:79]
ds_read_b64_tr_b16 a[6:7], v15 offset:29440
v_mfma_f32_16x16x32_bf16 v[68:71], a[8:11], a[228:231], v[68:71]
buffer_load_dwordx4 a[148:151], v3, s[88:91], s101 offen offset:1024 sc1
v_mfma_f32_16x16x32_bf16 v[68:71], a[12:15], a[244:247], v[68:71]
v_mfma_f32_16x16x32_bf16 v[60:63], a[12:15], a[240:243], v[60:63]
v_mfma_f32_16x16x32_bf16 v[60:63], a[8:11], a[224:227], v[60:63]
s_waitcnt lgkmcnt(4)
v_mfma_f32_16x16x32_bf16 v[88:91], a[16:19], a[224:227], v[88:91]
ds_read_b64_tr_b16 a[8:9], v19 offset:17152
v_mfma_f32_16x16x32_bf16 v[88:91], a[20:23], a[240:243], v[88:91]
buffer_load_dwordx4 a[152:155], v3, s[88:91], s101 offen offset:2048 sc1
v_mfma_f32_16x16x32_bf16 v[96:99], a[20:23], a[244:247], v[96:99]
ds_read_b64_tr_b16 a[10:11], v19 offset:21248
v_mfma_f32_16x16x32_bf16 v[96:99], a[16:19], a[228:231], v[96:99]
ds_read_b64_tr_b16 a[12:13], v19 offset:25344
v_mfma_f32_16x16x32_bf16 v[104:107], a[16:19], a[232:235], v[104:107]
ds_read_b64_tr_b16 a[14:15], v19 offset:29440
v_mfma_f32_16x16x32_bf16 v[104:107], a[20:23], a[248:251], v[104:107]
buffer_load_dwordx4 a[156:159], v3, s[88:91], s101 offen offset:3072 sc1
v_mfma_f32_16x16x32_bf16 v[112:115], a[20:23], a[252:255], v[112:115]
s_add_u32 m0, s17, 0x18000
s_lshl_b32 s61, s60, 3
s_add_u32 s62, s61, s12
v_mfma_f32_16x16x32_bf16 v[112:115], a[16:19], a[236:239], v[112:115]
v_mfma_f32_16x16x32_bf16 v[116:119], a[24:27], a[236:239], v[116:119]
ds_read_b64_tr_b16 a[16:17], v15 offset:16384
v_mfma_f32_16x16x32_bf16 v[116:119], a[28:31], a[252:255], v[116:119]
ds_read_b64_tr_b16 a[18:19], v15 offset:20480
v_mfma_f32_16x16x32_bf16 v[108:111], a[28:31], a[248:251], v[108:111]
buffer_load_dwordx4 v12, s[64:67], s61 offen lds
v_mfma_f32_16x16x32_bf16 v[108:111], a[24:27], a[232:235], v[108:111]
ds_read_b64_tr_b16 a[20:21], v15 offset:24576
v_mfma_f32_16x16x32_bf16 v[100:103], a[24:27], a[228:231], v[100:103]
ds_read_b64_tr_b16 a[22:23], v15 offset:28672
v_mfma_f32_16x16x32_bf16 v[100:103], a[28:31], a[244:247], v[100:103]
v_mfma_f32_16x16x32_bf16 v[92:95], a[28:31], a[240:243], v[92:95]
buffer_load_dwordx4 v13, s[64:67], s61 offen offset:1024 lds
v_mfma_f32_16x16x32_bf16 v[92:95], a[24:27], a[224:227], v[92:95]
s_waitcnt lgkmcnt(4)
v_mfma_f32_16x16x32_bf16 v[120:123], a[0:3], a[224:227], v[120:123]
ds_read_b64_tr_b16 a[24:25], v19 offset:16384
v_mfma_f32_16x16x32_bf16 v[120:123], a[4:7], a[240:243], v[120:123]
ds_read_b64_tr_b16 a[26:27], v19 offset:20480
v_mfma_f32_16x16x32_bf16 v[128:131], a[4:7], a[244:247], v[128:131]
ds_read_b64_tr_b16 a[28:29], v19 offset:24576
v_mfma_f32_16x16x32_bf16 v[128:131], a[0:3], a[228:231], v[128:131]
buffer_load_dwordx4 v12, s[64:67], s62 offen offset:2048 lds
v_mfma_f32_16x16x32_bf16 v[136:139], a[0:3], a[232:235], v[136:139]
ds_read_b64_tr_b16 a[30:31], v19 offset:28672
v_mfma_f32_16x16x32_bf16 v[136:139], a[4:7], a[248:251], v[136:139]
v_mfma_f32_16x16x32_bf16 v[144:147], a[4:7], a[252:255], v[144:147]
s_waitcnt vmcnt(23)
v_mfma_f32_16x16x32_bf16 v[144:147], a[0:3], a[236:239], v[144:147]
s_barrier
v_mfma_f32_16x16x32_bf16 v[148:151], a[8:11], a[236:239], v[148:151]
buffer_load_dwordx4 v13, s[64:67], s62 offen offset:3072 lds
v_mfma_f32_16x16x32_bf16 v[148:151], a[12:15], a[252:255], v[148:151]
ds_read_b64_tr_b16 a[0:1], v4 offset:256
s_add_u32 s60, s60, s59
v_mfma_f32_16x16x32_bf16 v[140:143], a[12:15], a[248:251], v[140:143]
ds_read_b64_tr_b16 a[2:3], v4 offset:4352
s_and_b32 s60, s60, 0x1c000
v_mfma_f32_16x16x32_bf16 v[140:143], a[8:11], a[232:235], v[140:143]
ds_read_b64_tr_b16 a[4:5], v4 offset:8448
s_add_u32 s101, s63, s60
v_mfma_f32_16x16x32_bf16 v[132:135], a[8:11], a[228:231], v[132:135]
buffer_load_dwordx4 a[160:163], v3, s[88:91], s101 offen sc1
v_mfma_f32_16x16x32_bf16 v[132:135], a[12:15], a[244:247], v[132:135]
ds_read_b64_tr_b16 a[6:7], v4 offset:12544
s_lshl_b32 s11, s6, 2
v_mfma_f32_16x16x32_bf16 v[124:127], a[12:15], a[240:243], v[124:127]
s_lshr_b32 s10, s5, 4
s_lshl_b32 s10, s10, 1
s_add_u32 s11, s11, s10
v_mfma_f32_16x16x32_bf16 v[124:127], a[8:11], a[224:227], v[124:127]
s_waitcnt lgkmcnt(4)
s_lshl_b32 s11, s11, 6
s_and_b32 s10, s5, 3
v_mfma_f32_16x16x32_bf16 v[24:27], a[16:19], a[224:227], v[24:27]
ds_read_b64_tr_b16 a[8:9], v5 offset:256
L_padC2:
s_cmp_eq_u32 s95, 1
s_cbranch_scc1 L_padC4
s_add_u32 s11, s11, s10
v_mfma_f32_16x16x32_bf16 v[24:27], a[20:23], a[240:243], v[24:27]
buffer_load_dwordx4 a[164:167], v3, s[88:91], s101 offen offset:1024 sc1
v_mfma_f32_16x16x32_bf16 v[32:35], a[20:23], a[244:247], v[32:35]
ds_read_b64_tr_b16 a[10:11], v5 offset:4352
s_lshl_b32 s11, s11, 2
v_mfma_f32_16x16x32_bf16 v[32:35], a[16:19], a[228:231], v[32:35]
ds_read_b64_tr_b16 a[12:13], v5 offset:8448
s_add_u32 s11, s11, 0x3704000
v_mfma_f32_16x16x32_bf16 v[40:43], a[16:19], a[232:235], v[40:43]
ds_read_b64_tr_b16 a[14:15], v5 offset:12544
v_and_b32 v7, 1, v0
v_mfma_f32_16x16x32_bf16 v[40:43], a[20:23], a[248:251], v[40:43]
buffer_load_dwordx4 a[168:171], v3, s[88:91], s101 offen offset:2048 sc1
v_mfma_f32_16x16x32_bf16 v[48:51], a[20:23], a[252:255], v[48:51]
v_lshlrev_b32 v7, 4, v7
v_and_b32 v1, 2, v0
v_mfma_f32_16x16x32_bf16 v[48:51], a[16:19], a[236:239], v[48:51]
v_lshl_add_u32 v7, v1, 7, v7
v_min_u32 v1, 2, v0
v_mfma_f32_16x16x32_bf16 v[52:55], a[24:27], a[236:239], v[52:55]
ds_read_b64_tr_b16 a[16:17], v4 offset:512
v_lshlrev_b32 v1, 22, v1
v_mfma_f32_16x16x32_bf16 v[52:55], a[28:31], a[252:255], v[52:55]
ds_read_b64_tr_b16 a[18:19], v4 offset:4608
v_add_u32 v1, 4092, v1
v_mfma_f32_16x16x32_bf16 v[44:47], a[28:31], a[248:251], v[44:47]
buffer_load_dwordx4 a[172:175], v3, s[88:91], s101 offen offset:3072 sc1
v_mfma_f32_16x16x32_bf16 v[44:47], a[24:27], a[232:235], v[44:47]
ds_read_b64_tr_b16 a[20:21], v4 offset:8704
s_add_u32 s101, s101, 0x2000
v_mfma_f32_16x16x32_bf16 v[36:39], a[24:27], a[228:231], v[36:39]
ds_read_b64_tr_b16 a[22:23], v4 offset:12800
v_mfma_f32_16x16x32_bf16 v[36:39], a[28:31], a[244:247], v[36:39]
v_mfma_f32_16x16x32_bf16 v[28:31], a[28:31], a[240:243], v[28:31]
s_waitcnt lgkmcnt(4)
v_mfma_f32_16x16x32_bf16 v[28:31], a[24:27], a[224:227], v[28:31]
buffer_load_dwordx4 a[176:179], v3, s[88:91], s101 offen sc1
v_mfma_f32_16x16x32_bf16 v[56:59], a[0:3], a[64:67], v[56:59]
ds_read_b64_tr_b16 a[24:25], v5 offset:512
v_mfma_f32_16x16x32_bf16 v[56:59], a[4:7], a[80:83], v[56:59]
ds_read_b64_tr_b16 a[26:27], v5 offset:4608
v_mfma_f32_16x16x32_bf16 v[64:67], a[4:7], a[84:87], v[64:67]
ds_read_b64_tr_b16 a[28:29], v5 offset:8704
v_mfma_f32_16x16x32_bf16 v[64:67], a[0:3], a[68:71], v[64:67]
buffer_load_dwordx4 a[180:183], v3, s[88:91], s101 offen offset:1024 sc1
v_mfma_f32_16x16x32_bf16 v[72:75], a[0:3], a[72:75], v[72:75]
ds_read_b64_tr_b16 a[30:31], v5 offset:12800
v_mfma_f32_16x16x32_bf16 v[72:75], a[4:7], a[88:91], v[72:75]
v_mfma_f32_16x16x32_bf16 v[80:83], a[4:7], a[92:95], v[80:83]
v_mfma_f32_16x16x32_bf16 v[80:83], a[0:3], a[76:79], v[80:83]
v_mfma_f32_16x16x32_bf16 v[84:87], a[8:11], a[76:79], v[84:87]
buffer_load_dwordx4 a[184:187], v3, s[88:91], s101 offen offset:2048 sc1
v_mfma_f32_16x16x32_bf16 v[84:87], a[12:15], a[92:95], v[84:87]
ds_read_b64_tr_b16 a[0:1], v4 offset:768
v_mfma_f32_16x16x32_bf16 v[76:79], a[12:15], a[88:91], v[76:79]
ds_read_b64_tr_b16 a[2:3], v4 offset:4864
v_mfma_f32_16x16x32_bf16 v[76:79], a[8:11], a[72:75], v[76:79]
ds_read_b64_tr_b16 a[4:5], v4 offset:8960
v_mfma_f32_16x16x32_bf16 v[68:71], a[8:11], a[68:71], v[68:71]
buffer_load_dwordx4 a[188:191], v3, s[88:91], s101 offen offset:3072 sc1
v_mfma_f32_16x16x32_bf16 v[68:71], a[12:15], a[84:87], v[68:71]
ds_read_b64_tr_b16 a[6:7], v4 offset:13056
s_add_u32 m0, s17, 0x1c000
v_mfma_f32_16x16x32_bf16 v[60:63], a[12:15], a[80:83], v[60:63]
s_lshl_b32 s61, s60, 3
s_add_u32 s62, s61, s12
v_mfma_f32_16x16x32_bf16 v[60:63], a[8:11], a[64:67], v[60:63]
s_waitcnt lgkmcnt(4)
v_mfma_f32_16x16x32_bf16 v[88:91], a[16:19], a[64:67], v[88:91]
ds_read_b64_tr_b16 a[8:9], v5 offset:768
v_mfma_f32_16x16x32_bf16 v[88:91], a[20:23], a[80:83], v[88:91]
buffer_load_dwordx4 v12, s[64:67], s61 offen lds
v_mfma_f32_16x16x32_bf16 v[96:99], a[20:23], a[84:87], v[96:99]
ds_read_b64_tr_b16 a[10:11], v5 offset:4864
v_mfma_f32_16x16x32_bf16 v[96:99], a[16:19], a[68:71], v[96:99]
ds_read_b64_tr_b16 a[12:13], v5 offset:8960
v_mfma_f32_16x16x32_bf16 v[104:107], a[16:19], a[72:75], v[104:107]
ds_read_b64_tr_b16 a[14:15], v5 offset:13056
v_mfma_f32_16x16x32_bf16 v[104:107], a[20:23], a[88:91], v[104:107]
v_mfma_f32_16x16x32_bf16 v[112:115], a[20:23], a[92:95], v[112:115]
buffer_load_dwordx4 v13, s[64:67], s61 offen offset:1024 lds
v_mfma_f32_16x16x32_bf16 v[112:115], a[16:19], a[76:79], v[112:115]
v_mfma_f32_16x16x32_bf16 v[116:119], a[24:27], a[76:79], v[116:119]
ds_read_b64_tr_b16 a[16:17], v4 offset:0
v_mfma_f32_16x16x32_bf16 v[116:119], a[28:31], a[92:95], v[116:119]
ds_read_b64_tr_b16 a[18:19], v4 offset:4096
v_mfma_f32_16x16x32_bf16 v[108:111], a[28:31], a[88:91], v[108:111]
buffer_load_dwordx4 v12, s[64:67], s62 offen offset:2048 lds
v_mfma_f32_16x16x32_bf16 v[108:111], a[24:27], a[72:75], v[108:111]
ds_read_b64_tr_b16 a[20:21], v4 offset:8192
v_mfma_f32_16x16x32_bf16 v[100:103], a[24:27], a[68:71], v[100:103]
ds_read_b64_tr_b16 a[22:23], v4 offset:12288
v_mfma_f32_16x16x32_bf16 v[100:103], a[28:31], a[84:87], v[100:103]
v_mfma_f32_16x16x32_bf16 v[92:95], a[28:31], a[80:83], v[92:95]
s_waitcnt lgkmcnt(4)
v_mfma_f32_16x16x32_bf16 v[92:95], a[24:27], a[64:67], v[92:95]
buffer_load_dwordx4 v13, s[64:67], s62 offen offset:3072 lds
v_mfma_f32_16x16x32_bf16 v[120:123], a[0:3], a[64:67], v[120:123]
ds_read_b64_tr_b16 a[24:25], v5 offset:0
s_add_u32 s60, s60, s56
v_mfma_f32_16x16x32_bf16 v[120:123], a[4:7], a[80:83], v[120:123]
ds_read_b64_tr_b16 a[26:27], v5 offset:4096
s_and_b32 s60, s60, 0x1c000
v_mfma_f32_16x16x32_bf16 v[128:131], a[4:7], a[84:87], v[128:131]
ds_read_b64_tr_b16 a[28:29], v5 offset:8192
s_add_u32 s101, s63, s60
v_mfma_f32_16x16x32_bf16 v[128:131], a[0:3], a[68:71], v[128:131]
buffer_load_dwordx4 a[192:195], v3, s[88:91], s101 offen sc1
v_mfma_f32_16x16x32_bf16 v[136:139], a[0:3], a[72:75], v[136:139]
ds_read_b64_tr_b16 a[30:31], v5 offset:12288
v_mfma_f32_16x16x32_bf16 v[136:139], a[4:7], a[88:91], v[136:139]
v_mfma_f32_16x16x32_bf16 v[144:147], a[4:7], a[92:95], v[144:147]
s_waitcnt vmcnt(25)
v_mfma_f32_16x16x32_bf16 v[144:147], a[0:3], a[76:79], v[144:147]
s_barrier
v_mfma_f32_16x16x32_bf16 v[148:151], a[8:11], a[76:79], v[148:151]
buffer_load_dwordx4 a[196:199], v3, s[88:91], s101 offen offset:1024 sc1
v_mfma_f32_16x16x32_bf16 v[148:151], a[12:15], a[92:95], v[148:151]
ds_read_b64_tr_b16 a[0:1], v4 offset:16640
v_mfma_f32_16x16x32_bf16 v[140:143], a[12:15], a[88:91], v[140:143]
ds_read_b64_tr_b16 a[2:3], v4 offset:20736
v_mfma_f32_16x16x32_bf16 v[140:143], a[8:11], a[72:75], v[140:143]
ds_read_b64_tr_b16 a[4:5], v4 offset:24832
v_mfma_f32_16x16x32_bf16 v[132:135], a[8:11], a[68:71], v[132:135]
ds_read_b64_tr_b16 a[6:7], v4 offset:28928
v_mfma_f32_16x16x32_bf16 v[132:135], a[12:15], a[84:87], v[132:135]
buffer_load_dwordx4 a[200:203], v3, s[88:91], s101 offen offset:2048 sc1
v_mfma_f32_16x16x32_bf16 v[124:127], a[12:15], a[80:83], v[124:127]
v_mfma_f32_16x16x32_bf16 v[124:127], a[8:11], a[64:67], v[124:127]
s_waitcnt lgkmcnt(4)
v_mfma_f32_16x16x32_bf16 v[24:27], a[16:19], a[64:67], v[24:27]
ds_read_b64_tr_b16 a[8:9], v5 offset:16640
v_mfma_f32_16x16x32_bf16 v[24:27], a[20:23], a[80:83], v[24:27]
buffer_load_dwordx4 a[204:207], v3, s[88:91], s101 offen offset:3072 sc1
v_mfma_f32_16x16x32_bf16 v[32:35], a[20:23], a[84:87], v[32:35]
ds_read_b64_tr_b16 a[10:11], v5 offset:20736
s_add_u32 s101, s101, 0x2000
v_mfma_f32_16x16x32_bf16 v[32:35], a[16:19], a[68:71], v[32:35]
ds_read_b64_tr_b16 a[12:13], v5 offset:24832
v_mfma_f32_16x16x32_bf16 v[40:43], a[16:19], a[72:75], v[40:43]
ds_read_b64_tr_b16 a[14:15], v5 offset:28928
v_mfma_f32_16x16x32_bf16 v[40:43], a[20:23], a[88:91], v[40:43]
v_mfma_f32_16x16x32_bf16 v[48:51], a[20:23], a[92:95], v[48:51]
buffer_load_dwordx4 a[208:211], v3, s[88:91], s101 offen sc1
v_mfma_f32_16x16x32_bf16 v[48:51], a[16:19], a[76:79], v[48:51]
v_mfma_f32_16x16x32_bf16 v[52:55], a[24:27], a[76:79], v[52:55]
ds_read_b64_tr_b16 a[16:17], v4 offset:16896
v_mfma_f32_16x16x32_bf16 v[52:55], a[28:31], a[92:95], v[52:55]
ds_read_b64_tr_b16 a[18:19], v4 offset:20992
v_mfma_f32_16x16x32_bf16 v[44:47], a[28:31], a[88:91], v[44:47]
buffer_load_dwordx4 a[212:215], v3, s[88:91], s101 offen offset:1024 sc1
v_mfma_f32_16x16x32_bf16 v[44:47], a[24:27], a[72:75], v[44:47]
ds_read_b64_tr_b16 a[20:21], v4 offset:25088
v_mfma_f32_16x16x32_bf16 v[36:39], a[24:27], a[68:71], v[36:39]
ds_read_b64_tr_b16 a[22:23], v4 offset:29184
v_mfma_f32_16x16x32_bf16 v[36:39], a[28:31], a[84:87], v[36:39]
v_mfma_f32_16x16x32_bf16 v[28:31], a[28:31], a[80:83], v[28:31]
s_waitcnt lgkmcnt(4)
v_mfma_f32_16x16x32_bf16 v[28:31], a[24:27], a[64:67], v[28:31]
buffer_load_dwordx4 a[216:219], v3, s[88:91], s101 offen offset:2048 sc1
v_mfma_f32_16x16x32_bf16 v[56:59], a[0:3], a[96:99], v[56:59]
ds_read_b64_tr_b16 a[24:25], v5 offset:16896
v_mfma_f32_16x16x32_bf16 v[56:59], a[4:7], a[112:115], v[56:59]
ds_read_b64_tr_b16 a[26:27], v5 offset:20992
v_mfma_f32_16x16x32_bf16 v[64:67], a[4:7], a[116:119], v[64:67]
ds_read_b64_tr_b16 a[28:29], v5 offset:25088
v_mfma_f32_16x16x32_bf16 v[64:67], a[0:3], a[100:103], v[64:67]
ds_read_b64_tr_b16 a[30:31], v5 offset:29184
v_mfma_f32_16x16x32_bf16 v[72:75], a[0:3], a[104:107], v[72:75]
buffer_load_dwordx4 a[220:223], v3, s[88:91], s101 offen offset:3072 sc1
v_mfma_f32_16x16x32_bf16 v[72:75], a[4:7], a[120:123], v[72:75]
s_add_u32 m0, s17, 0x20000
s_lshl_b32 s61, s60, 3
s_add_u32 s62, s61, s12
v_mfma_f32_16x16x32_bf16 v[80:83], a[4:7], a[124:127], v[80:83]
v_mfma_f32_16x16x32_bf16 v[80:83], a[0:3], a[108:111], v[80:83]
v_mfma_f32_16x16x32_bf16 v[84:87], a[8:11], a[108:111], v[84:87]
buffer_load_dwordx4 v12, s[64:67], s61 offen lds
v_mfma_f32_16x16x32_bf16 v[84:87], a[12:15], a[124:127], v[84:87]
ds_read_b64_tr_b16 a[0:1], v4 offset:17152
v_mfma_f32_16x16x32_bf16 v[76:79], a[12:15], a[120:123], v[76:79]
ds_read_b64_tr_b16 a[2:3], v4 offset:21248
v_mfma_f32_16x16x32_bf16 v[76:79], a[8:11], a[104:107], v[76:79]
ds_read_b64_tr_b16 a[4:5], v4 offset:25344
v_mfma_f32_16x16x32_bf16 v[68:71], a[8:11], a[100:103], v[68:71]
ds_read_b64_tr_b16 a[6:7], v4 offset:29440
v_mfma_f32_16x16x32_bf16 v[68:71], a[12:15], a[116:119], v[68:71]
buffer_load_dwordx4 v13, s[64:67], s61 offen offset:1024 lds
v_mfma_f32_16x16x32_bf16 v[60:63], a[12:15], a[112:115], v[60:63]
v_mfma_f32_16x16x32_bf16 v[60:63], a[8:11], a[96:99], v[60:63]
s_waitcnt lgkmcnt(4)
v_mfma_f32_16x16x32_bf16 v[88:91], a[16:19], a[96:99], v[88:91]
ds_read_b64_tr_b16 a[8:9], v5 offset:17152
v_mfma_f32_16x16x32_bf16 v[88:91], a[20:23], a[112:115], v[88:91]
buffer_load_dwordx4 v12, s[64:67], s62 offen offset:2048 lds
v_mfma_f32_16x16x32_bf16 v[96:99], a[20:23], a[116:119], v[96:99]
ds_read_b64_tr_b16 a[10:11], v5 offset:21248
v_mfma_f32_16x16x32_bf16 v[96:99], a[16:19], a[100:103], v[96:99]
ds_read_b64_tr_b16 a[12:13], v5 offset:25344
v_mfma_f32_16x16x32_bf16 v[104:107], a[16:19], a[104:107], v[104:107]
ds_read_b64_tr_b16 a[14:15], v5 offset:29440
v_mfma_f32_16x16x32_bf16 v[104:107], a[20:23], a[120:123], v[104:107]
v_mfma_f32_16x16x32_bf16 v[112:115], a[20:23], a[124:127], v[112:115]
buffer_load_dwordx4 v13, s[64:67], s62 offen offset:3072 lds
v_mfma_f32_16x16x32_bf16 v[112:115], a[16:19], a[108:111], v[112:115]
s_add_u32 s60, s60, s57
s_and_b32 s60, s60, 0x1c000
s_add_u32 s101, s63, s60
v_mfma_f32_16x16x32_bf16 v[116:119], a[24:27], a[108:111], v[116:119]
ds_read_b64_tr_b16 a[16:17], v4 offset:16384
v_mfma_f32_16x16x32_bf16 v[116:119], a[28:31], a[124:127], v[116:119]
ds_read_b64_tr_b16 a[18:19], v4 offset:20480
v_mfma_f32_16x16x32_bf16 v[108:111], a[28:31], a[120:123], v[108:111]
ds_read_b64_tr_b16 a[20:21], v4 offset:24576
v_mfma_f32_16x16x32_bf16 v[108:111], a[24:27], a[104:107], v[108:111]
buffer_load_dwordx4 a[224:227], v3, s[88:91], s101 offen sc1
v_mfma_f32_16x16x32_bf16 v[100:103], a[24:27], a[100:103], v[100:103]
ds_read_b64_tr_b16 a[22:23], v4 offset:28672
v_mfma_f32_16x16x32_bf16 v[100:103], a[28:31], a[116:119], v[100:103]
v_mfma_f32_16x16x32_bf16 v[92:95], a[28:31], a[112:115], v[92:95]
s_waitcnt lgkmcnt(4)
v_mfma_f32_16x16x32_bf16 v[92:95], a[24:27], a[96:99], v[92:95]
buffer_load_dwordx4 a[228:231], v3, s[88:91], s101 offen offset:1024 sc1
v_mfma_f32_16x16x32_bf16 v[120:123], a[0:3], a[96:99], v[120:123]
ds_read_b64_tr_b16 a[24:25], v5 offset:16384
v_mfma_f32_16x16x32_bf16 v[120:123], a[4:7], a[112:115], v[120:123]
ds_read_b64_tr_b16 a[26:27], v5 offset:20480
v_mfma_f32_16x16x32_bf16 v[128:131], a[4:7], a[116:119], v[128:131]
ds_read_b64_tr_b16 a[28:29], v5 offset:24576
v_mfma_f32_16x16x32_bf16 v[128:131], a[0:3], a[100:103], v[128:131]
ds_read_b64_tr_b16 a[30:31], v5 offset:28672
v_mfma_f32_16x16x32_bf16 v[136:139], a[0:3], a[104:107], v[136:139]
buffer_load_dwordx4 a[232:235], v3, s[88:91], s101 offen offset:2048 sc1
v_mfma_f32_16x16x32_bf16 v[136:139], a[4:7], a[120:123], v[136:139]
v_mfma_f32_16x16x32_bf16 v[144:147], a[4:7], a[124:127], v[144:147]
s_waitcnt vmcnt(27)
v_mfma_f32_16x16x32_bf16 v[144:147], a[0:3], a[108:111], v[144:147]
s_barrier
v_mfma_f32_16x16x32_bf16 v[148:151], a[8:11], a[108:111], v[148:151]
buffer_load_dwordx4 a[236:239], v3, s[88:91], s101 offen offset:3072 sc1
v_mfma_f32_16x16x32_bf16 v[148:151], a[12:15], a[124:127], v[148:151]
ds_read_b64_tr_b16 a[0:1], v4 offset:33024
s_add_u32 s101, s101, 0x2000
v_mfma_f32_16x16x32_bf16 v[140:143], a[12:15], a[120:123], v[140:143]
ds_read_b64_tr_b16 a[2:3], v4 offset:37120
v_mfma_f32_16x16x32_bf16 v[140:143], a[8:11], a[104:107], v[140:143]
ds_read_b64_tr_b16 a[4:5], v4 offset:41216
v_mfma_f32_16x16x32_bf16 v[132:135], a[8:11], a[100:103], v[132:135]
ds_read_b64_tr_b16 a[6:7], v4 offset:45312
v_mfma_f32_16x16x32_bf16 v[132:135], a[12:15], a[116:119], v[132:135]
buffer_load_dwordx4 a[240:243], v3, s[88:91], s101 offen sc1
v_mfma_f32_16x16x32_bf16 v[124:127], a[12:15], a[112:115], v[124:127]
v_mfma_f32_16x16x32_bf16 v[124:127], a[8:11], a[96:99], v[124:127]
s_waitcnt lgkmcnt(4)
v_mfma_f32_16x16x32_bf16 v[24:27], a[16:19], a[96:99], v[24:27]
ds_read_b64_tr_b16 a[8:9], v5 offset:33024
v_mfma_f32_16x16x32_bf16 v[24:27], a[20:23], a[112:115], v[24:27]
ds_read_b64_tr_b16 a[10:11], v5 offset:37120
v_mfma_f32_16x16x32_bf16 v[32:35], a[20:23], a[116:119], v[32:35]
buffer_load_dwordx4 a[244:247], v3, s[88:91], s101 offen offset:1024 sc1
v_mfma_f32_16x16x32_bf16 v[32:35], a[16:19], a[100:103], v[32:35]
ds_read_b64_tr_b16 a[12:13], v5 offset:41216
v_mfma_f32_16x16x32_bf16 v[40:43], a[16:19], a[104:107], v[40:43]
ds_read_b64_tr_b16 a[14:15], v5 offset:45312
v_mfma_f32_16x16x32_bf16 v[40:43], a[20:23], a[120:123], v[40:43]
v_mfma_f32_16x16x32_bf16 v[48:51], a[20:23], a[124:127], v[48:51]
buffer_load_dwordx4 a[248:251], v3, s[88:91], s101 offen offset:2048 sc1
v_mfma_f32_16x16x32_bf16 v[48:51], a[16:19], a[108:111], v[48:51]
v_mfma_f32_16x16x32_bf16 v[52:55], a[24:27], a[108:111], v[52:55]
ds_read_b64_tr_b16 a[16:17], v4 offset:33280
v_mfma_f32_16x16x32_bf16 v[52:55], a[28:31], a[124:127], v[52:55]
ds_read_b64_tr_b16 a[18:19], v4 offset:37376
v_mfma_f32_16x16x32_bf16 v[44:47], a[28:31], a[120:123], v[44:47]
ds_read_b64_tr_b16 a[20:21], v4 offset:41472
v_mfma_f32_16x16x32_bf16 v[44:47], a[24:27], a[104:107], v[44:47]
buffer_load_dwordx4 a[252:255], v3, s[88:91], s101 offen offset:3072 sc1
v_mfma_f32_16x16x32_bf16 v[36:39], a[24:27], a[100:103], v[36:39]
ds_read_b64_tr_b16 a[22:23], v4 offset:45568
s_add_u32 m0, s17, 0x24000
v_mfma_f32_16x16x32_bf16 v[36:39], a[28:31], a[116:119], v[36:39]
s_lshl_b32 s61, s60, 3
s_add_u32 s62, s61, s12
v_mfma_f32_16x16x32_bf16 v[28:31], a[28:31], a[112:115], v[28:31]
s_waitcnt lgkmcnt(4)
v_mfma_f32_16x16x32_bf16 v[28:31], a[24:27], a[96:99], v[28:31]
buffer_load_dwordx4 v12, s[64:67], s61 offen lds
v_mfma_f32_16x16x32_bf16 v[56:59], a[0:3], a[128:131], v[56:59]
ds_read_b64_tr_b16 a[24:25], v5 offset:33280
v_mfma_f32_16x16x32_bf16 v[56:59], a[4:7], a[144:147], v[56:59]
ds_read_b64_tr_b16 a[26:27], v5 offset:37376
v_mfma_f32_16x16x32_bf16 v[64:67], a[4:7], a[148:151], v[64:67]
ds_read_b64_tr_b16 a[28:29], v5 offset:41472
v_mfma_f32_16x16x32_bf16 v[64:67], a[0:3], a[132:135], v[64:67]
ds_read_b64_tr_b16 a[30:31], v5 offset:45568
v_mfma_f32_16x16x32_bf16 v[72:75], a[0:3], a[136:139], v[72:75]
buffer_load_dwordx4 v13, s[64:67], s61 offen offset:1024 lds
v_mfma_f32_16x16x32_bf16 v[72:75], a[4:7], a[152:155], v[72:75]
v_mfma_f32_16x16x32_bf16 v[80:83], a[4:7], a[156:159], v[80:83]
v_mfma_f32_16x16x32_bf16 v[80:83], a[0:3], a[140:143], v[80:83]
v_mfma_f32_16x16x32_bf16 v[84:87], a[8:11], a[140:143], v[84:87]
ds_read_b64_tr_b16 a[0:1], v4 offset:33536
v_mfma_f32_16x16x32_bf16 v[84:87], a[12:15], a[156:159], v[84:87]
buffer_load_dwordx4 v12, s[64:67], s62 offen offset:2048 lds
v_mfma_f32_16x16x32_bf16 v[76:79], a[12:15], a[152:155], v[76:79]
ds_read_b64_tr_b16 a[2:3], v4 offset:37632
v_mfma_f32_16x16x32_bf16 v[76:79], a[8:11], a[136:139], v[76:79]
ds_read_b64_tr_b16 a[4:5], v4 offset:41728
v_mfma_f32_16x16x32_bf16 v[68:71], a[8:11], a[132:135], v[68:71]
ds_read_b64_tr_b16 a[6:7], v4 offset:45824
v_mfma_f32_16x16x32_bf16 v[68:71], a[12:15], a[148:151], v[68:71]
buffer_load_dwordx4 v13, s[64:67], s62 offen offset:3072 lds
v_mfma_f32_16x16x32_bf16 v[60:63], a[12:15], a[144:147], v[60:63]
s_add_u32 s60, s60, s58
s_and_b32 s60, s60, 0x1c000
s_add_u32 s101, s63, s60
v_mfma_f32_16x16x32_bf16 v[60:63], a[8:11], a[128:131], v[60:63]
s_waitcnt lgkmcnt(4)
v_mfma_f32_16x16x32_bf16 v[88:91], a[16:19], a[128:131], v[88:91]
ds_read_b64_tr_b16 a[8:9], v5 offset:33536
v_mfma_f32_16x16x32_bf16 v[88:91], a[20:23], a[144:147], v[88:91]
ds_read_b64_tr_b16 a[10:11], v5 offset:37632
v_mfma_f32_16x16x32_bf16 v[96:99], a[20:23], a[148:151], v[96:99]
buffer_load_dwordx4 a[64:67], v3, s[88:91], s101 offen sc1
v_mfma_f32_16x16x32_bf16 v[96:99], a[16:19], a[132:135], v[96:99]
ds_read_b64_tr_b16 a[12:13], v5 offset:41728
v_mfma_f32_16x16x32_bf16 v[104:107], a[16:19], a[136:139], v[104:107]
ds_read_b64_tr_b16 a[14:15], v5 offset:45824
v_mfma_f32_16x16x32_bf16 v[104:107], a[20:23], a[152:155], v[104:107]
v_mfma_f32_16x16x32_bf16 v[112:115], a[20:23], a[156:159], v[112:115]
buffer_load_dwordx4 a[68:71], v3, s[88:91], s101 offen offset:1024 sc1
v_mfma_f32_16x16x32_bf16 v[112:115], a[16:19], a[140:143], v[112:115]
v_mfma_f32_16x16x32_bf16 v[116:119], a[24:27], a[140:143], v[116:119]
ds_read_b64_tr_b16 a[16:17], v4 offset:32768
v_mfma_f32_16x16x32_bf16 v[116:119], a[28:31], a[156:159], v[116:119]
ds_read_b64_tr_b16 a[18:19], v4 offset:36864
v_mfma_f32_16x16x32_bf16 v[108:111], a[28:31], a[152:155], v[108:111]
ds_read_b64_tr_b16 a[20:21], v4 offset:40960
v_mfma_f32_16x16x32_bf16 v[108:111], a[24:27], a[136:139], v[108:111]
buffer_load_dwordx4 a[72:75], v3, s[88:91], s101 offen offset:2048 sc1
v_mfma_f32_16x16x32_bf16 v[100:103], a[24:27], a[132:135], v[100:103]
ds_read_b64_tr_b16 a[22:23], v4 offset:45056
v_mfma_f32_16x16x32_bf16 v[100:103], a[28:31], a[148:151], v[100:103]
v_mfma_f32_16x16x32_bf16 v[92:95], a[28:31], a[144:147], v[92:95]
v_mfma_f32_16x16x32_bf16 v[92:95], a[24:27], a[128:131], v[92:95]
s_waitcnt lgkmcnt(4)
v_mfma_f32_16x16x32_bf16 v[120:123], a[0:3], a[128:131], v[120:123]
buffer_load_dwordx4 a[76:79], v3, s[88:91], s101 offen offset:3072 sc1
v_mfma_f32_16x16x32_bf16 v[120:123], a[4:7], a[144:147], v[120:123]
ds_read_b64_tr_b16 a[24:25], v5 offset:32768
s_add_u32 s101, s101, 0x2000
v_mfma_f32_16x16x32_bf16 v[128:131], a[4:7], a[148:151], v[128:131]
ds_read_b64_tr_b16 a[26:27], v5 offset:36864
v_mfma_f32_16x16x32_bf16 v[128:131], a[0:3], a[132:135], v[128:131]
ds_read_b64_tr_b16 a[28:29], v5 offset:40960
v_mfma_f32_16x16x32_bf16 v[136:139], a[0:3], a[136:139], v[136:139]
buffer_load_dwordx4 a[80:83], v3, s[88:91], s101 offen sc1
v_mfma_f32_16x16x32_bf16 v[136:139], a[4:7], a[152:155], v[136:139]
ds_read_b64_tr_b16 a[30:31], v5 offset:45056
v_mfma_f32_16x16x32_bf16 v[144:147], a[4:7], a[156:159], v[144:147]
s_waitcnt vmcnt(29)
v_mfma_f32_16x16x32_bf16 v[144:147], a[0:3], a[140:143], v[144:147]
s_barrier
v_mfma_f32_16x16x32_bf16 v[148:151], a[8:11], a[140:143], v[148:151]
ds_read_b64_tr_b16 a[0:1], v4 offset:49408
v_mfma_f32_16x16x32_bf16 v[148:151], a[12:15], a[156:159], v[148:151]
buffer_load_dwordx4 a[84:87], v3, s[88:91], s101 offen offset:1024 sc1
v_mfma_f32_16x16x32_bf16 v[140:143], a[12:15], a[152:155], v[140:143]
ds_read_b64_tr_b16 a[2:3], v4 offset:53504
v_mfma_f32_16x16x32_bf16 v[140:143], a[8:11], a[136:139], v[140:143]
ds_read_b64_tr_b16 a[4:5], v4 offset:57600
v_mfma_f32_16x16x32_bf16 v[132:135], a[8:11], a[132:135], v[132:135]
ds_read_b64_tr_b16 a[6:7], v4 offset:61696
v_mfma_f32_16x16x32_bf16 v[132:135], a[12:15], a[148:151], v[132:135]
buffer_load_dwordx4 a[88:91], v3, s[88:91], s101 offen offset:2048 sc1
v_mfma_f32_16x16x32_bf16 v[124:127], a[12:15], a[144:147], v[124:127]
v_mfma_f32_16x16x32_bf16 v[124:127], a[8:11], a[128:131], v[124:127]
s_waitcnt lgkmcnt(4)
v_mfma_f32_16x16x32_bf16 v[24:27], a[16:19], a[128:131], v[24:27]
ds_read_b64_tr_b16 a[8:9], v5 offset:49408
v_mfma_f32_16x16x32_bf16 v[24:27], a[20:23], a[144:147], v[24:27]
ds_read_b64_tr_b16 a[10:11], v5 offset:53504
v_mfma_f32_16x16x32_bf16 v[32:35], a[20:23], a[148:151], v[32:35]
buffer_load_dwordx4 a[92:95], v3, s[88:91], s101 offen offset:3072 sc1
v_mfma_f32_16x16x32_bf16 v[32:35], a[16:19], a[132:135], v[32:35]
ds_read_b64_tr_b16 a[12:13], v5 offset:57600
s_add_u32 m0, s17, 0x10000
v_mfma_f32_16x16x32_bf16 v[40:43], a[16:19], a[136:139], v[40:43]
ds_read_b64_tr_b16 a[14:15], v5 offset:61696
s_lshl_b32 s61, s60, 3
v_mfma_f32_16x16x32_bf16 v[40:43], a[20:23], a[152:155], v[40:43]
s_add_u32 s62, s61, s12
v_mfma_f32_16x16x32_bf16 v[48:51], a[20:23], a[156:159], v[48:51]
v_mfma_f32_16x16x32_bf16 v[48:51], a[16:19], a[140:143], v[48:51]
buffer_load_dwordx4 v12, s[64:67], s61 offen lds
v_mfma_f32_16x16x32_bf16 v[52:55], a[24:27], a[140:143], v[52:55]
ds_read_b64_tr_b16 a[16:17], v4 offset:49664
v_mfma_f32_16x16x32_bf16 v[52:55], a[28:31], a[156:159], v[52:55]
ds_read_b64_tr_b16 a[18:19], v4 offset:53760
v_mfma_f32_16x16x32_bf16 v[44:47], a[28:31], a[152:155], v[44:47]
ds_read_b64_tr_b16 a[20:21], v4 offset:57856
v_mfma_f32_16x16x32_bf16 v[44:47], a[24:27], a[136:139], v[44:47]
buffer_load_dwordx4 v13, s[64:67], s61 offen offset:1024 lds
v_mfma_f32_16x16x32_bf16 v[36:39], a[24:27], a[132:135], v[36:39]
ds_read_b64_tr_b16 a[22:23], v4 offset:61952
v_mfma_f32_16x16x32_bf16 v[36:39], a[28:31], a[148:151], v[36:39]
v_mfma_f32_16x16x32_bf16 v[28:31], a[28:31], a[144:147], v[28:31]
v_mfma_f32_16x16x32_bf16 v[28:31], a[24:27], a[128:131], v[28:31]
s_waitcnt lgkmcnt(4)
v_mfma_f32_16x16x32_bf16 v[56:59], a[0:3], a[160:163], v[56:59]
buffer_load_dwordx4 v12, s[64:67], s62 offen offset:2048 lds
v_mfma_f32_16x16x32_bf16 v[56:59], a[4:7], a[176:179], v[56:59]
ds_read_b64_tr_b16 a[24:25], v5 offset:49664
v_mfma_f32_16x16x32_bf16 v[64:67], a[4:7], a[180:183], v[64:67]
ds_read_b64_tr_b16 a[26:27], v5 offset:53760
v_mfma_f32_16x16x32_bf16 v[64:67], a[0:3], a[164:167], v[64:67]
ds_read_b64_tr_b16 a[28:29], v5 offset:57856
v_mfma_f32_16x16x32_bf16 v[72:75], a[0:3], a[168:171], v[72:75]
buffer_load_dwordx4 v13, s[64:67], s62 offen offset:3072 lds
v_mfma_f32_16x16x32_bf16 v[72:75], a[4:7], a[184:187], v[72:75]
ds_read_b64_tr_b16 a[30:31], v5 offset:61952
s_add_u32 s60, s60, s59
v_mfma_f32_16x16x32_bf16 v[80:83], a[4:7], a[188:191], v[80:83]
s_and_b32 s60, s60, 0x1c000
s_add_u32 s101, s63, s60
v_mfma_f32_16x16x32_bf16 v[80:83], a[0:3], a[172:175], v[80:83]
v_mfma_f32_16x16x32_bf16 v[84:87], a[8:11], a[172:175], v[84:87]
ds_read_b64_tr_b16 a[0:1], v4 offset:49920
v_mfma_f32_16x16x32_bf16 v[84:87], a[12:15], a[188:191], v[84:87]
buffer_load_dwordx4 a[96:99], v3, s[88:91], s101 offen sc1
v_mfma_f32_16x16x32_bf16 v[76:79], a[12:15], a[184:187], v[76:79]
ds_read_b64_tr_b16 a[2:3], v4 offset:54016
v_mfma_f32_16x16x32_bf16 v[76:79], a[8:11], a[168:171], v[76:79]
ds_read_b64_tr_b16 a[4:5], v4 offset:58112
v_mfma_f32_16x16x32_bf16 v[68:71], a[8:11], a[164:167], v[68:71]
ds_read_b64_tr_b16 a[6:7], v4 offset:62208
v_mfma_f32_16x16x32_bf16 v[68:71], a[12:15], a[180:183], v[68:71]
v_mfma_f32_16x16x32_bf16 v[60:63], a[12:15], a[176:179], v[60:63]
buffer_load_dwordx4 a[100:103], v3, s[88:91], s101 offen offset:1024 sc1
v_mfma_f32_16x16x32_bf16 v[60:63], a[8:11], a[160:163], v[60:63]
s_waitcnt lgkmcnt(4)
v_mfma_f32_16x16x32_bf16 v[88:91], a[16:19], a[160:163], v[88:91]
ds_read_b64_tr_b16 a[8:9], v5 offset:49920
v_mfma_f32_16x16x32_bf16 v[88:91], a[20:23], a[176:179], v[88:91]
ds_read_b64_tr_b16 a[10:11], v5 offset:54016
v_mfma_f32_16x16x32_bf16 v[96:99], a[20:23], a[180:183], v[96:99]
buffer_load_dwordx4 a[104:107], v3, s[88:91], s101 offen offset:2048 sc1
v_mfma_f32_16x16x32_bf16 v[96:99], a[16:19], a[164:167], v[96:99]
ds_read_b64_tr_b16 a[12:13], v5 offset:58112
v_mfma_f32_16x16x32_bf16 v[104:107], a[16:19], a[168:171], v[104:107]
ds_read_b64_tr_b16 a[14:15], v5 offset:62208
v_mfma_f32_16x16x32_bf16 v[104:107], a[20:23], a[184:187], v[104:107]
v_mfma_f32_16x16x32_bf16 v[112:115], a[20:23], a[188:191], v[112:115]
s_waitcnt vmcnt(27)
v_mfma_f32_16x16x32_bf16 v[112:115], a[16:19], a[172:175], v[112:115]
s_barrier
v_mfma_f32_16x16x32_bf16 v[116:119], a[24:27], a[172:175], v[116:119]
buffer_load_dwordx4 a[108:111], v3, s[88:91], s101 offen offset:3072 sc1
v_mfma_f32_16x16x32_bf16 v[116:119], a[28:31], a[188:191], v[116:119]
ds_read_b64_tr_b16 a[16:17], v15 offset:256
s_add_u32 s101, s101, 0x2000
v_mfma_f32_16x16x32_bf16 v[108:111], a[28:31], a[184:187], v[108:111]
ds_read_b64_tr_b16 a[18:19], v15 offset:4352
v_mfma_f32_16x16x32_bf16 v[108:111], a[24:27], a[168:171], v[108:111]
ds_read_b64_tr_b16 a[20:21], v15 offset:8448
v_mfma_f32_16x16x32_bf16 v[100:103], a[24:27], a[164:167], v[100:103]
buffer_load_dwordx4 a[112:115], v3, s[88:91], s101 offen sc1
v_mfma_f32_16x16x32_bf16 v[100:103], a[28:31], a[180:183], v[100:103]
ds_read_b64_tr_b16 a[22:23], v15 offset:12544
v_mfma_f32_16x16x32_bf16 v[92:95], a[28:31], a[176:179], v[92:95]
v_mfma_f32_16x16x32_bf16 v[92:95], a[24:27], a[160:163], v[92:95]
s_waitcnt lgkmcnt(4)
v_mfma_f32_16x16x32_bf16 v[120:123], a[0:3], a[160:163], v[120:123]
buffer_load_dwordx4 a[116:119], v3, s[88:91], s101 offen offset:1024 sc1
v_mfma_f32_16x16x32_bf16 v[120:123], a[4:7], a[176:179], v[120:123]
ds_read_b64_tr_b16 a[24:25], v19 offset:256
v_mfma_f32_16x16x32_bf16 v[128:131], a[4:7], a[180:183], v[128:131]
ds_read_b64_tr_b16 a[26:27], v19 offset:4352
v_mfma_f32_16x16x32_bf16 v[128:131], a[0:3], a[164:167], v[128:131]
ds_read_b64_tr_b16 a[28:29], v19 offset:8448
v_mfma_f32_16x16x32_bf16 v[136:139], a[0:3], a[168:171], v[136:139]
ds_read_b64_tr_b16 a[30:31], v19 offset:12544
v_mfma_f32_16x16x32_bf16 v[136:139], a[4:7], a[184:187], v[136:139]
buffer_load_dwordx4 a[120:123], v3, s[88:91], s101 offen offset:2048 sc1
v_mfma_f32_16x16x32_bf16 v[144:147], a[4:7], a[188:191], v[144:147]
v_mfma_f32_16x16x32_bf16 v[144:147], a[0:3], a[172:175], v[144:147]
v_mfma_f32_16x16x32_bf16 v[148:151], a[8:11], a[172:175], v[148:151]
ds_read_b64_tr_b16 a[0:1], v15 offset:512
v_mfma_f32_16x16x32_bf16 v[148:151], a[12:15], a[188:191], v[148:151]
buffer_load_dwordx4 a[124:127], v3, s[88:91], s101 offen offset:3072 sc1
v_mfma_f32_16x16x32_bf16 v[140:143], a[12:15], a[184:187], v[140:143]
ds_read_b64_tr_b16 a[2:3], v15 offset:4608
s_add_u32 m0, s17, 0x14000
v_mfma_f32_16x16x32_bf16 v[140:143], a[8:11], a[168:171], v[140:143]
ds_read_b64_tr_b16 a[4:5], v15 offset:8704
s_lshl_b32 s61, s60, 3
v_mfma_f32_16x16x32_bf16 v[132:135], a[8:11], a[164:167], v[132:135]
ds_read_b64_tr_b16 a[6:7], v15 offset:12800
s_add_u32 s62, s61, s12
v_mfma_f32_16x16x32_bf16 v[132:135], a[12:15], a[180:183], v[132:135]
v_mfma_f32_16x16x32_bf16 v[124:127], a[12:15], a[176:179], v[124:127]
buffer_load_dwordx4 v12, s[64:67], s61 offen lds
v_mfma_f32_16x16x32_bf16 v[124:127], a[8:11], a[160:163], v[124:127]
s_waitcnt lgkmcnt(4)
v_mfma_f32_16x16x32_bf16 v[56:59], a[16:19], a[192:195], v[56:59]
ds_read_b64_tr_b16 a[8:9], v19 offset:512
v_mfma_f32_16x16x32_bf16 v[56:59], a[20:23], a[208:211], v[56:59]
ds_read_b64_tr_b16 a[10:11], v19 offset:4608
v_mfma_f32_16x16x32_bf16 v[64:67], a[20:23], a[212:215], v[64:67]
buffer_load_dwordx4 v13, s[64:67], s61 offen offset:1024 lds
v_mfma_f32_16x16x32_bf16 v[64:67], a[16:19], a[196:199], v[64:67]
ds_read_b64_tr_b16 a[12:13], v19 offset:8704
v_mfma_f32_16x16x32_bf16 v[72:75], a[16:19], a[200:203], v[72:75]
ds_read_b64_tr_b16 a[14:15], v19 offset:12800
v_mfma_f32_16x16x32_bf16 v[72:75], a[20:23], a[216:219], v[72:75]
v_mfma_f32_16x16x32_bf16 v[80:83], a[20:23], a[220:223], v[80:83]
s_waitcnt vmcnt(22)
v_mfma_f32_16x16x32_bf16 v[80:83], a[16:19], a[204:207], v[80:83]
s_barrier
v_mfma_f32_16x16x32_bf16 v[84:87], a[24:27], a[204:207], v[84:87]
buffer_load_dwordx4 v12, s[64:67], s62 offen offset:2048 lds
v_mfma_f32_16x16x32_bf16 v[84:87], a[28:31], a[220:223], v[84:87]
ds_read_b64_tr_b16 a[16:17], v15 offset:16640
v_mfma_f32_16x16x32_bf16 v[76:79], a[28:31], a[216:219], v[76:79]
ds_read_b64_tr_b16 a[18:19], v15 offset:20736
v_mfma_f32_16x16x32_bf16 v[76:79], a[24:27], a[200:203], v[76:79]
ds_read_b64_tr_b16 a[20:21], v15 offset:24832
v_mfma_f32_16x16x32_bf16 v[68:71], a[24:27], a[196:199], v[68:71]
buffer_load_dwordx4 v13, s[64:67], s62 offen offset:3072 lds
v_mfma_f32_16x16x32_bf16 v[68:71], a[28:31], a[212:215], v[68:71]
ds_read_b64_tr_b16 a[22:23], v15 offset:28928
v_mfma_f32_16x16x32_bf16 v[60:63], a[28:31], a[208:211], v[60:63]
buffer_load_dword v14, v7, s[88:91], s11 offen sc1
v_mfma_f32_16x16x32_bf16 v[60:63], a[24:27], a[192:195], v[60:63]
s_waitcnt lgkmcnt(4)
v_mfma_f32_16x16x32_bf16 v[88:91], a[0:3], a[192:195], v[88:91]
ds_read_b64_tr_b16 a[24:25], v19 offset:16640
L_padC3:
s_cmp_eq_u32 s95, 1
s_cbranch_scc1 L_hopC_ret
v_mfma_f32_16x16x32_bf16 v[88:91], a[4:7], a[208:211], v[88:91]
ds_read_b64_tr_b16 a[26:27], v19 offset:20736
v_mfma_f32_16x16x32_bf16 v[96:99], a[4:7], a[212:215], v[96:99]
ds_read_b64_tr_b16 a[28:29], v19 offset:24832
v_mfma_f32_16x16x32_bf16 v[96:99], a[0:3], a[196:199], v[96:99]
ds_read_b64_tr_b16 a[30:31], v19 offset:28928
v_mfma_f32_16x16x32_bf16 v[104:107], a[0:3], a[200:203], v[104:107]
v_mfma_f32_16x16x32_bf16 v[104:107], a[4:7], a[216:219], v[104:107]
v_mfma_f32_16x16x32_bf16 v[112:115], a[4:7], a[220:223], v[112:115]
s_waitcnt vmcnt(13)
v_mfma_f32_16x16x32_bf16 v[112:115], a[0:3], a[204:207], v[112:115]
s_barrier
v_mfma_f32_16x16x32_bf16 v[116:119], a[8:11], a[204:207], v[116:119]
ds_read_b64_tr_b16 a[0:1], v4 offset:256
v_mfma_f32_16x16x32_bf16 v[116:119], a[12:15], a[220:223], v[116:119]
ds_read_b64_tr_b16 a[2:3], v4 offset:4352
v_mfma_f32_16x16x32_bf16 v[108:111], a[12:15], a[216:219], v[108:111]
ds_read_b64_tr_b16 a[4:5], v4 offset:8448
v_mfma_f32_16x16x32_bf16 v[108:111], a[8:11], a[200:203], v[108:111]
ds_read_b64_tr_b16 a[6:7], v4 offset:12544
v_mfma_f32_16x16x32_bf16 v[100:103], a[8:11], a[196:199], v[100:103]
v_mfma_f32_16x16x32_bf16 v[100:103], a[12:15], a[212:215], v[100:103]
v_mfma_f32_16x16x32_bf16 v[92:95], a[12:15], a[208:211], v[92:95]
v_mfma_f32_16x16x32_bf16 v[92:95], a[8:11], a[192:195], v[92:95]
s_waitcnt lgkmcnt(4)
v_mfma_f32_16x16x32_bf16 v[56:59], a[16:19], a[224:227], v[56:59]
ds_read_b64_tr_b16 a[8:9], v5 offset:256
v_mfma_f32_16x16x32_bf16 v[56:59], a[20:23], a[240:243], v[56:59]
ds_read_b64_tr_b16 a[10:11], v5 offset:4352
v_mfma_f32_16x16x32_bf16 v[64:67], a[20:23], a[244:247], v[64:67]
ds_read_b64_tr_b16 a[12:13], v5 offset:8448
v_mfma_f32_16x16x32_bf16 v[64:67], a[16:19], a[228:231], v[64:67]
ds_read_b64_tr_b16 a[14:15], v5 offset:12544
v_mfma_f32_16x16x32_bf16 v[72:75], a[16:19], a[232:235], v[72:75]
v_mfma_f32_16x16x32_bf16 v[72:75], a[20:23], a[248:251], v[72:75]
v_mfma_f32_16x16x32_bf16 v[80:83], a[20:23], a[252:255], v[80:83]
s_waitcnt vmcnt(1)
v_mfma_f32_16x16x32_bf16 v[80:83], a[16:19], a[236:239], v[80:83]
s_barrier
v_mfma_f32_16x16x32_bf16 v[84:87], a[24:27], a[236:239], v[84:87]
ds_read_b64_tr_b16 a[16:17], v4 offset:16640
v_mfma_f32_16x16x32_bf16 v[84:87], a[28:31], a[252:255], v[84:87]
ds_read_b64_tr_b16 a[18:19], v4 offset:20736
v_mfma_f32_16x16x32_bf16 v[76:79], a[28:31], a[248:251], v[76:79]
ds_read_b64_tr_b16 a[20:21], v4 offset:24832
v_mfma_f32_16x16x32_bf16 v[76:79], a[24:27], a[232:235], v[76:79]
ds_read_b64_tr_b16 a[22:23], v4 offset:28928
v_mfma_f32_16x16x32_bf16 v[68:71], a[24:27], a[228:231], v[68:71]
v_mfma_f32_16x16x32_bf16 v[68:71], a[28:31], a[244:247], v[68:71]
v_mfma_f32_16x16x32_bf16 v[60:63], a[28:31], a[240:243], v[60:63]
v_mfma_f32_16x16x32_bf16 v[60:63], a[24:27], a[224:227], v[60:63]
s_waitcnt lgkmcnt(4)
v_mfma_f32_16x16x32_bf16 v[56:59], a[0:3], a[64:67], v[56:59]
ds_read_b64_tr_b16 a[24:25], v5 offset:16640
v_mfma_f32_16x16x32_bf16 v[56:59], a[4:7], a[80:83], v[56:59]
ds_read_b64_tr_b16 a[26:27], v5 offset:20736
v_mfma_f32_16x16x32_bf16 v[64:67], a[4:7], a[84:87], v[64:67]
ds_read_b64_tr_b16 a[28:29], v5 offset:24832
v_mfma_f32_16x16x32_bf16 v[64:67], a[0:3], a[68:71], v[64:67]
ds_read_b64_tr_b16 a[30:31], v5 offset:28928
v_mfma_f32_16x16x32_bf16 v[72:75], a[0:3], a[72:75], v[72:75]
v_mfma_f32_16x16x32_bf16 v[72:75], a[4:7], a[88:91], v[72:75]
v_mfma_f32_16x16x32_bf16 v[80:83], a[4:7], a[92:95], v[80:83]
v_mfma_f32_16x16x32_bf16 v[80:83], a[0:3], a[76:79], v[80:83]
v_mfma_f32_16x16x32_bf16 v[84:87], a[8:11], a[76:79], v[84:87]
ds_read_b64_tr_b16 a[0:1], v15 offset:16896
v_mfma_f32_16x16x32_bf16 v[84:87], a[12:15], a[92:95], v[84:87]
ds_read_b64_tr_b16 a[2:3], v15 offset:20992
v_mfma_f32_16x16x32_bf16 v[76:79], a[12:15], a[88:91], v[76:79]
ds_read_b64_tr_b16 a[4:5], v15 offset:25088
v_mfma_f32_16x16x32_bf16 v[76:79], a[8:11], a[72:75], v[76:79]
ds_read_b64_tr_b16 a[6:7], v15 offset:29184
v_mfma_f32_16x16x32_bf16 v[68:71], a[8:11], a[68:71], v[68:71]
v_mfma_f32_16x16x32_bf16 v[68:71], a[12:15], a[84:87], v[68:71]
v_mfma_f32_16x16x32_bf16 v[60:63], a[12:15], a[80:83], v[60:63]
v_mfma_f32_16x16x32_bf16 v[60:63], a[8:11], a[64:67], v[60:63]
s_waitcnt lgkmcnt(4)
v_mfma_f32_16x16x32_bf16 v[56:59], a[16:19], a[96:99], v[56:59]
ds_read_b64_tr_b16 a[8:9], v19 offset:16896
v_mfma_f32_16x16x32_bf16 v[56:59], a[20:23], a[112:115], v[56:59]
ds_read_b64_tr_b16 a[10:11], v19 offset:20992
v_mfma_f32_16x16x32_bf16 v[64:67], a[20:23], a[116:119], v[64:67]
ds_read_b64_tr_b16 a[12:13], v19 offset:25088
v_mfma_f32_16x16x32_bf16 v[64:67], a[16:19], a[100:103], v[64:67]
ds_read_b64_tr_b16 a[14:15], v19 offset:29184
v_mfma_f32_16x16x32_bf16 v[72:75], a[16:19], a[104:107], v[72:75]
v_mfma_f32_16x16x32_bf16 v[72:75], a[20:23], a[120:123], v[72:75]
v_mfma_f32_16x16x32_bf16 v[80:83], a[20:23], a[124:127], v[80:83]
v_mfma_f32_16x16x32_bf16 v[80:83], a[16:19], a[108:111], v[80:83]
v_mfma_f32_16x16x32_bf16 v[84:87], a[24:27], a[108:111], v[84:87]
ds_read_b64_tr_b16 a[16:17], v4 offset:512
v_mfma_f32_16x16x32_bf16 v[84:87], a[28:31], a[124:127], v[84:87]
ds_read_b64_tr_b16 a[18:19], v4 offset:4608
v_mfma_f32_16x16x32_bf16 v[76:79], a[28:31], a[120:123], v[76:79]
ds_read_b64_tr_b16 a[20:21], v4 offset:8704
v_mfma_f32_16x16x32_bf16 v[76:79], a[24:27], a[104:107], v[76:79]
ds_read_b64_tr_b16 a[22:23], v4 offset:12800
v_mfma_f32_16x16x32_bf16 v[68:71], a[24:27], a[100:103], v[68:71]
s_waitcnt vmcnt(0)
s_mov_b32 s92, 200000
L_spin_p:
v_cmp_gt_u32 vcc, 1, v14
s_nop 4
s_cbranch_vccz L_spun_p
s_sub_u32 s92, s92, 1
s_cbranch_scc1 L_spun_p
s_sleep 6
buffer_load_dword v14, v7, s[88:91], s11 offen sc1
s_waitcnt vmcnt(0)
s_branch L_spin_p
L_spun_p:
v_mfma_f32_16x16x32_bf16 v[68:71], a[28:31], a[116:119], v[68:71]
v_fmac_f32 v184, v11, v80
v_fmac_f32 v185, v11, v81
v_mfma_f32_16x16x32_bf16 v[60:63], a[28:31], a[112:115], v[60:63]
v_fmac_f32 v186, v11, v82
v_fmac_f32 v187, v11, v83
v_mfma_f32_16x16x32_bf16 v[60:63], a[24:27], a[96:99], v[60:63]
s_waitcnt lgkmcnt(4)
v_fmac_f32 v188, v11, v84
v_fmac_f32 v189, v11, v85
v_mfma_f32_16x16x32_bf16 v[88:91], a[0:3], a[224:227], v[88:91]
ds_read_b64_tr_b16 a[24:25], v5 offset:512
v_fmac_f32 v190, v11, v86
v_mfma_f32_16x16x32_bf16 v[88:91], a[4:7], a[240:243], v[88:91]
ds_read_b64_tr_b16 a[26:27], v5 offset:4608
v_fmac_f32 v191, v11, v87
v_mfma_f32_16x16x32_bf16 v[96:99], a[4:7], a[244:247], v[96:99]
ds_read_b64_tr_b16 a[28:29], v5 offset:8704
v_cvt_pk_bf16_f32 v184, v184, v185
v_mfma_f32_16x16x32_bf16 v[96:99], a[0:3], a[228:231], v[96:99]
ds_read_b64_tr_b16 a[30:31], v5 offset:12800
v_cvt_pk_bf16_f32 v185, v186, v187
v_mfma_f32_16x16x32_bf16 v[104:107], a[0:3], a[232:235], v[104:107]
v_cvt_pk_bf16_f32 v186, v188, v189
v_cvt_pk_bf16_f32 v187, v190, v191
v_mfma_f32_16x16x32_bf16 v[104:107], a[4:7], a[248:251], v[104:107]
buffer_store_dwordx4 v[184:187], v3, s[88:91], s52 offen offset:3072 sc1
v_mfma_f32_16x16x32_bf16 v[112:115], a[4:7], a[252:255], v[112:115]
v_fmac_f32 v176, v10, v72
v_fmac_f32 v177, v10, v73
v_mfma_f32_16x16x32_bf16 v[112:115], a[0:3], a[236:239], v[112:115]
v_fmac_f32 v178, v10, v74
v_fmac_f32 v179, v10, v75
v_mfma_f32_16x16x32_bf16 v[116:119], a[8:11], a[236:239], v[116:119]
ds_read_b64_tr_b16 a[0:1], v4 offset:16896
v_fmac_f32 v180, v10, v76
v_mfma_f32_16x16x32_bf16 v[116:119], a[12:15], a[252:255], v[116:119]
ds_read_b64_tr_b16 a[2:3], v4 offset:20992
v_fmac_f32 v181, v10, v77
v_mfma_f32_16x16x32_bf16 v[108:111], a[12:15], a[248:251], v[108:111]
ds_read_b64_tr_b16 a[4:5], v4 offset:25088
v_fmac_f32 v182, v10, v78
v_mfma_f32_16x16x32_bf16 v[108:111], a[8:11], a[232:235], v[108:111]
ds_read_b64_tr_b16 a[6:7], v4 offset:29184
v_fmac_f32 v183, v10, v79
v_mfma_f32_16x16x32_bf16 v[100:103], a[8:11], a[228:231], v[100:103]
v_cvt_pk_bf16_f32 v176, v176, v177
v_cvt_pk_bf16_f32 v177, v178, v179
v_mfma_f32_16x16x32_bf16 v[100:103], a[12:15], a[244:247], v[100:103]
v_cvt_pk_bf16_f32 v178, v180, v181
v_cvt_pk_bf16_f32 v179, v182, v183
v_mfma_f32_16x16x32_bf16 v[92:95], a[12:15], a[240:243], v[92:95]
buffer_store_dwordx4 v[176:179], v3, s[88:91], s52 offen offset:2048 sc1
v_mfma_f32_16x16x32_bf16 v[92:95], a[8:11], a[224:227], v[92:95]
s_waitcnt lgkmcnt(4)
v_fmac_f32 v168, v9, v64
v_fmac_f32 v169, v9, v65
v_mfma_f32_16x16x32_bf16 v[88:91], a[16:19], a[64:67], v[88:91]
ds_read_b64_tr_b16 a[8:9], v5 offset:16896
v_fmac_f32 v170, v9, v66
v_mfma_f32_16x16x32_bf16 v[88:91], a[20:23], a[80:83], v[88:91]
ds_read_b64_tr_b16 a[10:11], v5 offset:20992
v_fmac_f32 v171, v9, v67
v_mfma_f32_16x16x32_bf16 v[96:99], a[20:23], a[84:87], v[96:99]
ds_read_b64_tr_b16 a[12:13], v5 offset:25088
v_fmac_f32 v172, v9, v68
v_mfma_f32_16x16x32_bf16 v[96:99], a[16:19], a[68:71], v[96:99]
ds_read_b64_tr_b16 a[14:15], v5 offset:29184
v_fmac_f32 v173, v9, v69
v_mfma_f32_16x16x32_bf16 v[104:107], a[16:19], a[72:75], v[104:107]
v_fmac_f32 v174, v9, v70
v_fmac_f32 v175, v9, v71
v_mfma_f32_16x16x32_bf16 v[104:107], a[20:23], a[88:91], v[104:107]
v_cvt_pk_bf16_f32 v168, v168, v169
v_cvt_pk_bf16_f32 v169, v170, v171
v_mfma_f32_16x16x32_bf16 v[112:115], a[20:23], a[92:95], v[112:115]
v_cvt_pk_bf16_f32 v170, v172, v173
v_cvt_pk_bf16_f32 v171, v174, v175
v_mfma_f32_16x16x32_bf16 v[112:115], a[16:19], a[76:79], v[112:115]
buffer_store_dwordx4 v[168:171], v3, s[88:91], s52 offen offset:1024 sc1
v_mfma_f32_16x16x32_bf16 v[116:119], a[24:27], a[76:79], v[116:119]
ds_read_b64_tr_b16 a[16:17], v15 offset:768
v_fmac_f32 v160, v8, v56
v_mfma_f32_16x16x32_bf16 v[116:119], a[28:31], a[92:95], v[116:119]
ds_read_b64_tr_b16 a[18:19], v15 offset:4864
v_fmac_f32 v161, v8, v57
v_mfma_f32_16x16x32_bf16 v[108:111], a[28:31], a[88:91], v[108:111]
ds_read_b64_tr_b16 a[20:21], v15 offset:8960
v_fmac_f32 v162, v8, v58
v_mfma_f32_16x16x32_bf16 v[108:111], a[24:27], a[72:75], v[108:111]
ds_read_b64_tr_b16 a[22:23], v15 offset:13056
v_fmac_f32 v163, v8, v59
v_mfma_f32_16x16x32_bf16 v[100:103], a[24:27], a[68:71], v[100:103]
v_fmac_f32 v164, v8, v60
v_fmac_f32 v165, v8, v61
v_mfma_f32_16x16x32_bf16 v[100:103], a[28:31], a[84:87], v[100:103]
v_fmac_f32 v166, v8, v62
v_fmac_f32 v167, v8, v63
v_mfma_f32_16x16x32_bf16 v[92:95], a[28:31], a[80:83], v[92:95]
v_cvt_pk_bf16_f32 v160, v160, v161
v_cvt_pk_bf16_f32 v161, v162, v163
v_mfma_f32_16x16x32_bf16 v[92:95], a[24:27], a[64:67], v[92:95]
s_waitcnt lgkmcnt(4)
v_cvt_pk_bf16_f32 v162, v164, v165
v_cvt_pk_bf16_f32 v163, v166, v167
v_mfma_f32_16x16x32_bf16 v[88:91], a[0:3], a[96:99], v[88:91]
ds_read_b64_tr_b16 a[24:25], v19 offset:768
v_mfma_f32_16x16x32_bf16 v[88:91], a[4:7], a[112:115], v[88:91]
ds_read_b64_tr_b16 a[26:27], v19 offset:4864
v_mfma_f32_16x16x32_bf16 v[96:99], a[4:7], a[116:119], v[96:99]
ds_read_b64_tr_b16 a[28:29], v19 offset:8960
v_mfma_f32_16x16x32_bf16 v[96:99], a[0:3], a[100:103], v[96:99]
ds_read_b64_tr_b16 a[30:31], v19 offset:13056
v_mfma_f32_16x16x32_bf16 v[104:107], a[0:3], a[104:107], v[104:107]
buffer_store_dwordx4 v[160:163], v3, s[88:91], s52 offen offset:0 sc1
v_mfma_f32_16x16x32_bf16 v[104:107], a[4:7], a[120:123], v[104:107]
v_mfma_f32_16x16x32_bf16 v[112:115], a[4:7], a[124:127], v[112:115]
v_mfma_f32_16x16x32_bf16 v[112:115], a[0:3], a[108:111], v[112:115]
v_mfma_f32_16x16x32_bf16 v[116:119], a[8:11], a[108:111], v[116:119]
ds_read_b64_tr_b16 a[0:1], v15 offset:17152
v_mfma_f32_16x16x32_bf16 v[116:119], a[12:15], a[124:127], v[116:119]
ds_read_b64_tr_b16 a[2:3], v15 offset:21248
v_mfma_f32_16x16x32_bf16 v[108:111], a[12:15], a[120:123], v[108:111]
ds_read_b64_tr_b16 a[4:5], v15 offset:25344
v_mfma_f32_16x16x32_bf16 v[108:111], a[8:11], a[104:107], v[108:111]
ds_read_b64_tr_b16 a[6:7], v15 offset:29440
v_mfma_f32_16x16x32_bf16 v[100:103], a[8:11], a[100:103], v[100:103]
v_mfma_f32_16x16x32_bf16 v[100:103], a[12:15], a[116:119], v[100:103]
v_fmac_f32 v216, v11, v112
v_fmac_f32 v217, v11, v113
v_mfma_f32_16x16x32_bf16 v[92:95], a[12:15], a[112:115], v[92:95]
v_fmac_f32 v218, v11, v114
v_fmac_f32 v219, v11, v115
v_mfma_f32_16x16x32_bf16 v[92:95], a[8:11], a[96:99], v[92:95]
s_waitcnt lgkmcnt(4)
v_fmac_f32 v220, v11, v116
v_fmac_f32 v221, v11, v117
v_mfma_f32_16x16x32_bf16 v[120:123], a[16:19], a[192:195], v[120:123]
ds_read_b64_tr_b16 a[8:9], v19 offset:17152
v_fmac_f32 v222, v11, v118
v_mfma_f32_16x16x32_bf16 v[120:123], a[20:23], a[208:211], v[120:123]
ds_read_b64_tr_b16 a[10:11], v19 offset:21248
v_fmac_f32 v223, v11, v119
v_mfma_f32_16x16x32_bf16 v[128:131], a[20:23], a[212:215], v[128:131]
ds_read_b64_tr_b16 a[12:13], v19 offset:25344
v_cvt_pk_bf16_f32 v216, v216, v217
v_mfma_f32_16x16x32_bf16 v[128:131], a[16:19], a[196:199], v[128:131]
ds_read_b64_tr_b16 a[14:15], v19 offset:29440
v_cvt_pk_bf16_f32 v217, v218, v219
v_mfma_f32_16x16x32_bf16 v[136:139], a[16:19], a[200:203], v[136:139]
v_cvt_pk_bf16_f32 v218, v220, v221
v_cvt_pk_bf16_f32 v219, v222, v223
v_mfma_f32_16x16x32_bf16 v[136:139], a[20:23], a[216:219], v[136:139]
buffer_load_dword v14, v1, s[88:91], s44 offen sc1
v_mfma_f32_16x16x32_bf16 v[144:147], a[20:23], a[220:223], v[144:147]
buffer_store_dwordx4 v[216:219], v3, s[88:91], s53 offen offset:3072 sc1
v_mfma_f32_16x16x32_bf16 v[144:147], a[16:19], a[204:207], v[144:147]
v_fmac_f32 v208, v10, v104
v_fmac_f32 v209, v10, v105
v_mfma_f32_16x16x32_bf16 v[148:151], a[24:27], a[204:207], v[148:151]
ds_read_b64_tr_b16 a[16:17], v4 offset:768
v_fmac_f32 v210, v10, v106
v_mfma_f32_16x16x32_bf16 v[148:151], a[28:31], a[220:223], v[148:151]
ds_read_b64_tr_b16 a[18:19], v4 offset:4864
v_fmac_f32 v211, v10, v107
v_mfma_f32_16x16x32_bf16 v[140:143], a[28:31], a[216:219], v[140:143]
ds_read_b64_tr_b16 a[20:21], v4 offset:8960
v_fmac_f32 v212, v10, v108
v_mfma_f32_16x16x32_bf16 v[140:143], a[24:27], a[200:203], v[140:143]
ds_read_b64_tr_b16 a[22:23], v4 offset:13056
v_fmac_f32 v213, v10, v109
v_mfma_f32_16x16x32_bf16 v[132:135], a[24:27], a[196:199], v[132:135]
v_fmac_f32 v214, v10, v110
v_fmac_f32 v215, v10, v111
v_mfma_f32_16x16x32_bf16 v[132:135], a[28:31], a[212:215], v[132:135]
v_cvt_pk_bf16_f32 v208, v208, v209
v_cvt_pk_bf16_f32 v209, v210, v211
v_mfma_f32_16x16x32_bf16 v[124:127], a[28:31], a[208:211], v[124:127]
v_cvt_pk_bf16_f32 v210, v212, v213
v_cvt_pk_bf16_f32 v211, v214, v215
v_mfma_f32_16x16x32_bf16 v[124:127], a[24:27], a[192:195], v[124:127]
s_waitcnt lgkmcnt(4)
v_mfma_f32_16x16x32_bf16 v[120:123], a[0:3], a[224:227], v[120:123]
ds_read_b64_tr_b16 a[24:25], v5 offset:768
v_mfma_f32_16x16x32_bf16 v[120:123], a[4:7], a[240:243], v[120:123]
ds_read_b64_tr_b16 a[26:27], v5 offset:4864
v_mfma_f32_16x16x32_bf16 v[128:131], a[4:7], a[244:247], v[128:131]
ds_read_b64_tr_b16 a[28:29], v5 offset:8960
v_mfma_f32_16x16x32_bf16 v[128:131], a[0:3], a[228:231], v[128:131]
ds_read_b64_tr_b16 a[30:31], v5 offset:13056
v_mfma_f32_16x16x32_bf16 v[136:139], a[0:3], a[232:235], v[136:139]
buffer_store_dwordx4 v[208:211], v3, s[88:91], s53 offen offset:2048 sc1
v_mfma_f32_16x16x32_bf16 v[136:139], a[4:7], a[248:251], v[136:139]
v_fmac_f32 v200, v9, v96
v_fmac_f32 v201, v9, v97
v_mfma_f32_16x16x32_bf16 v[144:147], a[4:7], a[252:255], v[144:147]
v_fmac_f32 v202, v9, v98
v_fmac_f32 v203, v9, v99
v_mfma_f32_16x16x32_bf16 v[144:147], a[0:3], a[236:239], v[144:147]
v_fmac_f32 v204, v9, v100
v_fmac_f32 v205, v9, v101
v_mfma_f32_16x16x32_bf16 v[148:151], a[8:11], a[236:239], v[148:151]
ds_read_b64_tr_b16 a[0:1], v4 offset:17152
v_fmac_f32 v206, v9, v102
v_mfma_f32_16x16x32_bf16 v[148:151], a[12:15], a[252:255], v[148:151]
ds_read_b64_tr_b16 a[2:3], v4 offset:21248
v_fmac_f32 v207, v9, v103
v_mfma_f32_16x16x32_bf16 v[140:143], a[12:15], a[248:251], v[140:143]
ds_read_b64_tr_b16 a[4:5], v4 offset:25344
v_cvt_pk_bf16_f32 v200, v200, v201
v_mfma_f32_16x16x32_bf16 v[140:143], a[8:11], a[232:235], v[140:143]
ds_read_b64_tr_b16 a[6:7], v4 offset:29440
v_cvt_pk_bf16_f32 v201, v202, v203
v_mfma_f32_16x16x32_bf16 v[132:135], a[8:11], a[228:231], v[132:135]
v_cvt_pk_bf16_f32 v202, v204, v205
v_cvt_pk_bf16_f32 v203, v206, v207
v_mfma_f32_16x16x32_bf16 v[132:135], a[12:15], a[244:247], v[132:135]
buffer_store_dwordx4 v[200:203], v3, s[88:91], s53 offen offset:1024 sc1
v_mfma_f32_16x16x32_bf16 v[124:127], a[12:15], a[240:243], v[124:127]
v_fmac_f32 v192, v8, v88
v_fmac_f32 v193, v8, v89
v_mfma_f32_16x16x32_bf16 v[124:127], a[8:11], a[224:227], v[124:127]
s_waitcnt lgkmcnt(4)
v_fmac_f32 v194, v8, v90
v_fmac_f32 v195, v8, v91
v_mfma_f32_16x16x32_bf16 v[120:123], a[16:19], a[64:67], v[120:123]
ds_read_b64_tr_b16 a[8:9], v5 offset:17152
v_fmac_f32 v196, v8, v92
v_mfma_f32_16x16x32_bf16 v[120:123], a[20:23], a[80:83], v[120:123]
ds_read_b64_tr_b16 a[10:11], v5 offset:21248
v_fmac_f32 v197, v8, v93
v_mfma_f32_16x16x32_bf16 v[128:131], a[20:23], a[84:87], v[128:131]
ds_read_b64_tr_b16 a[12:13], v5 offset:25344
v_fmac_f32 v198, v8, v94
v_mfma_f32_16x16x32_bf16 v[128:131], a[16:19], a[68:71], v[128:131]
ds_read_b64_tr_b16 a[14:15], v5 offset:29440
v_fmac_f32 v199, v8, v95
v_mfma_f32_16x16x32_bf16 v[136:139], a[16:19], a[72:75], v[136:139]
v_cvt_pk_bf16_f32 v192, v192, v193
v_cvt_pk_bf16_f32 v193, v194, v195
v_mfma_f32_16x16x32_bf16 v[136:139], a[20:23], a[88:91], v[136:139]
v_cvt_pk_bf16_f32 v194, v196, v197
v_cvt_pk_bf16_f32 v195, v198, v199
v_mfma_f32_16x16x32_bf16 v[144:147], a[20:23], a[92:95], v[144:147]
buffer_store_dwordx4 v[192:195], v3, s[88:91], s53 offen offset:0 sc1
v_mfma_f32_16x16x32_bf16 v[144:147], a[16:19], a[76:79], v[144:147]
v_mfma_f32_16x16x32_bf16 v[148:151], a[24:27], a[76:79], v[148:151]
ds_read_b64_tr_b16 a[16:17], v4 offset:49152
v_mfma_f32_16x16x32_bf16 v[148:151], a[28:31], a[92:95], v[148:151]
ds_read_b64_tr_b16 a[18:19], v4 offset:53248
v_mfma_f32_16x16x32_bf16 v[140:143], a[28:31], a[88:91], v[140:143]
ds_read_b64_tr_b16 a[20:21], v4 offset:57344
v_mfma_f32_16x16x32_bf16 v[140:143], a[24:27], a[72:75], v[140:143]
ds_read_b64_tr_b16 a[22:23], v4 offset:61440
v_mfma_f32_16x16x32_bf16 v[132:135], a[24:27], a[68:71], v[132:135]
v_mfma_f32_16x16x32_bf16 v[132:135], a[28:31], a[84:87], v[132:135]
v_mfma_f32_16x16x32_bf16 v[124:127], a[28:31], a[80:83], v[124:127]
v_mfma_f32_16x16x32_bf16 v[124:127], a[24:27], a[64:67], v[124:127]
s_waitcnt lgkmcnt(4)
v_mfma_f32_16x16x32_bf16 v[120:123], a[0:3], a[96:99], v[120:123]
ds_read_b64_tr_b16 a[24:25], v5 offset:49152
s_waitcnt vmcnt(4)
v_mfma_f32_16x16x32_bf16 v[120:123], a[4:7], a[112:115], v[120:123]
ds_read_b64_tr_b16 a[26:27], v5 offset:53248
v_cmp_ne_u32 vcc, -1, v14
v_mfma_f32_16x16x32_bf16 v[128:131], a[4:7], a[116:119], v[128:131]
ds_read_b64_tr_b16 a[28:29], v5 offset:57344
s_and_b32 s15, vcc_lo, 7
v_mfma_f32_16x16x32_bf16 v[128:131], a[0:3], a[100:103], v[128:131]
ds_read_b64_tr_b16 a[30:31], v5 offset:61440
v_mfma_f32_16x16x32_bf16 v[136:139], a[0:3], a[104:107], v[136:139]
s_bitcmp1_b32 s15, 0
s_cselect_b32 s50, s90, 0
v_mfma_f32_16x16x32_bf16 v[136:139], a[4:7], a[120:123], v[136:139]
buffer_load_dwordx4 v[56:59], v3, s[48:51], s44 offen offset:0 sc1
v_mfma_f32_16x16x32_bf16 v[144:147], a[4:7], a[124:127], v[144:147]
v_mfma_f32_16x16x32_bf16 v[144:147], a[0:3], a[108:111], v[144:147]
buffer_load_dwordx4 v[60:63], v3, s[48:51], s44 offen offset:1024 sc1
v_mfma_f32_16x16x32_bf16 v[148:151], a[8:11], a[108:111], v[148:151]
ds_read_b64_tr_b16 a[0:1], v15 offset:0
v_mfma_f32_16x16x32_bf16 v[148:151], a[12:15], a[124:127], v[148:151]
ds_read_b64_tr_b16 a[2:3], v15 offset:4096
v_mfma_f32_16x16x32_bf16 v[140:143], a[12:15], a[120:123], v[140:143]
ds_read_b64_tr_b16 a[4:5], v15 offset:8192
v_mfma_f32_16x16x32_bf16 v[140:143], a[8:11], a[104:107], v[140:143]
ds_read_b64_tr_b16 a[6:7], v15 offset:12288
v_mfma_f32_16x16x32_bf16 v[132:135], a[8:11], a[100:103], v[132:135]
buffer_load_dwordx4 v[64:67], v3, s[48:51], s44 offen offset:2048 sc1
v_mfma_f32_16x16x32_bf16 v[132:135], a[12:15], a[116:119], v[132:135]
v_mfma_f32_16x16x32_bf16 v[124:127], a[12:15], a[112:115], v[124:127]
buffer_load_dwordx4 v[68:71], v3, s[48:51], s44 offen offset:3072 sc1
v_mfma_f32_16x16x32_bf16 v[124:127], a[8:11], a[96:99], v[124:127]
s_waitcnt lgkmcnt(4)
v_mfma_f32_16x16x32_bf16 v[24:27], a[16:19], a[160:163], v[24:27]
ds_read_b64_tr_b16 a[8:9], v19 offset:0
v_fmac_f32 v248, v11, v144
v_mfma_f32_16x16x32_bf16 v[24:27], a[20:23], a[176:179], v[24:27]
ds_read_b64_tr_b16 a[10:11], v19 offset:4096
v_fmac_f32 v249, v11, v145
v_mfma_f32_16x16x32_bf16 v[32:35], a[20:23], a[180:183], v[32:35]
ds_read_b64_tr_b16 a[12:13], v19 offset:8192
v_fmac_f32 v250, v11, v146
v_mfma_f32_16x16x32_bf16 v[32:35], a[16:19], a[164:167], v[32:35]
ds_read_b64_tr_b16 a[14:15], v19 offset:12288
v_fmac_f32 v251, v11, v147
v_mfma_f32_16x16x32_bf16 v[40:43], a[16:19], a[168:171], v[40:43]
v_fmac_f32 v252, v11, v148
v_fmac_f32 v253, v11, v149
v_mfma_f32_16x16x32_bf16 v[40:43], a[20:23], a[184:187], v[40:43]
v_fmac_f32 v254, v11, v150
v_fmac_f32 v255, v11, v151
v_mfma_f32_16x16x32_bf16 v[48:51], a[20:23], a[188:191], v[48:51]
v_cvt_pk_bf16_f32 v248, v248, v249
v_cvt_pk_bf16_f32 v249, v250, v251
v_mfma_f32_16x16x32_bf16 v[48:51], a[16:19], a[172:175], v[48:51]
v_cvt_pk_bf16_f32 v250, v252, v253
v_cvt_pk_bf16_f32 v251, v254, v255
v_mfma_f32_16x16x32_bf16 v[52:55], a[24:27], a[172:175], v[52:55]
ds_read_b64_tr_b16 a[16:17], v15 offset:16384
v_mfma_f32_16x16x32_bf16 v[52:55], a[28:31], a[188:191], v[52:55]
ds_read_b64_tr_b16 a[18:19], v15 offset:20480
v_mfma_f32_16x16x32_bf16 v[44:47], a[28:31], a[184:187], v[44:47]
ds_read_b64_tr_b16 a[20:21], v15 offset:24576
v_mfma_f32_16x16x32_bf16 v[44:47], a[24:27], a[168:171], v[44:47]
ds_read_b64_tr_b16 a[22:23], v15 offset:28672
v_mfma_f32_16x16x32_bf16 v[36:39], a[24:27], a[164:167], v[36:39]
buffer_store_dwordx4 v[248:251], v3, s[88:91], s54 offen offset:3072 sc1
v_mfma_f32_16x16x32_bf16 v[36:39], a[28:31], a[180:183], v[36:39]
v_fmac_f32 v240, v10, v136
v_fmac_f32 v241, v10, v137
v_mfma_f32_16x16x32_bf16 v[28:31], a[28:31], a[176:179], v[28:31]
v_fmac_f32 v242, v10, v138
v_fmac_f32 v243, v10, v139
v_mfma_f32_16x16x32_bf16 v[28:31], a[24:27], a[160:163], v[28:31]
s_waitcnt lgkmcnt(4)
v_fmac_f32 v244, v10, v140
v_fmac_f32 v245, v10, v141
v_mfma_f32_16x16x32_bf16 v[24:27], a[0:3], a[192:195], v[24:27]
ds_read_b64_tr_b16 a[24:25], v19 offset:16384
v_fmac_f32 v246, v10, v142
v_mfma_f32_16x16x32_bf16 v[24:27], a[4:7], a[208:211], v[24:27]
ds_read_b64_tr_b16 a[26:27], v19 offset:20480
v_fmac_f32 v247, v10, v143
v_mfma_f32_16x16x32_bf16 v[32:35], a[4:7], a[212:215], v[32:35]
ds_read_b64_tr_b16 a[28:29], v19 offset:24576
v_cvt_pk_bf16_f32 v240, v240, v241
v_mfma_f32_16x16x32_bf16 v[32:35], a[0:3], a[196:199], v[32:35]
ds_read_b64_tr_b16 a[30:31], v19 offset:28672
v_cvt_pk_bf16_f32 v241, v242, v243
v_mfma_f32_16x16x32_bf16 v[40:43], a[0:3], a[200:203], v[40:43]
v_cvt_pk_bf16_f32 v242, v244, v245
v_cvt_pk_bf16_f32 v243, v246, v247
v_mfma_f32_16x16x32_bf16 v[40:43], a[4:7], a[216:219], v[40:43]
buffer_store_dwordx4 v[240:243], v3, s[88:91], s54 offen offset:2048 sc1
v_mfma_f32_16x16x32_bf16 v[48:51], a[4:7], a[220:223], v[48:51]
v_fmac_f32 v232, v9, v128
v_fmac_f32 v233, v9, v129
v_mfma_f32_16x16x32_bf16 v[48:51], a[0:3], a[204:207], v[48:51]
v_fmac_f32 v234, v9, v130
v_fmac_f32 v235, v9, v131
v_mfma_f32_16x16x32_bf16 v[52:55], a[8:11], a[204:207], v[52:55]
ds_read_b64_tr_b16 a[0:1], v4 offset:0
v_fmac_f32 v236, v9, v132
v_mfma_f32_16x16x32_bf16 v[52:55], a[12:15], a[220:223], v[52:55]
ds_read_b64_tr_b16 a[2:3], v4 offset:4096
v_fmac_f32 v237, v9, v133
v_mfma_f32_16x16x32_bf16 v[44:47], a[12:15], a[216:219], v[44:47]
ds_read_b64_tr_b16 a[4:5], v4 offset:8192
v_fmac_f32 v238, v9, v134
v_mfma_f32_16x16x32_bf16 v[44:47], a[8:11], a[200:203], v[44:47]
ds_read_b64_tr_b16 a[6:7], v4 offset:12288
v_fmac_f32 v239, v9, v135
v_mfma_f32_16x16x32_bf16 v[36:39], a[8:11], a[196:199], v[36:39]
v_cvt_pk_bf16_f32 v232, v232, v233
v_cvt_pk_bf16_f32 v233, v234, v235
v_mfma_f32_16x16x32_bf16 v[36:39], a[12:15], a[212:215], v[36:39]
v_cvt_pk_bf16_f32 v234, v236, v237
v_cvt_pk_bf16_f32 v235, v238, v239
v_mfma_f32_16x16x32_bf16 v[28:31], a[12:15], a[208:211], v[28:31]
buffer_store_dwordx4 v[232:235], v3, s[88:91], s54 offen offset:1024 sc1
v_mfma_f32_16x16x32_bf16 v[28:31], a[8:11], a[192:195], v[28:31]
s_waitcnt lgkmcnt(4)
v_fmac_f32 v224, v8, v120
v_fmac_f32 v225, v8, v121
v_mfma_f32_16x16x32_bf16 v[24:27], a[16:19], a[224:227], v[24:27]
ds_read_b64_tr_b16 a[8:9], v5 offset:0
v_fmac_f32 v226, v8, v122
v_mfma_f32_16x16x32_bf16 v[24:27], a[20:23], a[240:243], v[24:27]
ds_read_b64_tr_b16 a[10:11], v5 offset:4096
v_fmac_f32 v227, v8, v123
v_mfma_f32_16x16x32_bf16 v[32:35], a[20:23], a[244:247], v[32:35]
ds_read_b64_tr_b16 a[12:13], v5 offset:8192
v_fmac_f32 v228, v8, v124
v_mfma_f32_16x16x32_bf16 v[32:35], a[16:19], a[228:231], v[32:35]
ds_read_b64_tr_b16 a[14:15], v5 offset:12288
v_fmac_f32 v229, v8, v125
v_mfma_f32_16x16x32_bf16 v[40:43], a[16:19], a[232:235], v[40:43]
v_fmac_f32 v230, v8, v126
v_fmac_f32 v231, v8, v127
v_mfma_f32_16x16x32_bf16 v[40:43], a[20:23], a[248:251], v[40:43]
v_cvt_pk_bf16_f32 v224, v224, v225
v_cvt_pk_bf16_f32 v225, v226, v227
v_mfma_f32_16x16x32_bf16 v[48:51], a[20:23], a[252:255], v[48:51]
v_cvt_pk_bf16_f32 v226, v228, v229
v_cvt_pk_bf16_f32 v227, v230, v231
v_mfma_f32_16x16x32_bf16 v[48:51], a[16:19], a[236:239], v[48:51]
buffer_store_dwordx4 v[224:227], v3, s[88:91], s54 offen offset:0 sc1
v_mfma_f32_16x16x32_bf16 v[52:55], a[24:27], a[236:239], v[52:55]
ds_read_b64_tr_b16 a[16:17], v4 offset:16384
v_mfma_f32_16x16x32_bf16 v[52:55], a[28:31], a[252:255], v[52:55]
ds_read_b64_tr_b16 a[18:19], v4 offset:20480
v_mfma_f32_16x16x32_bf16 v[44:47], a[28:31], a[248:251], v[44:47]
ds_read_b64_tr_b16 a[20:21], v4 offset:24576
v_mfma_f32_16x16x32_bf16 v[44:47], a[24:27], a[232:235], v[44:47]
ds_read_b64_tr_b16 a[22:23], v4 offset:28672
v_mfma_f32_16x16x32_bf16 v[36:39], a[24:27], a[228:231], v[36:39]
s_bitcmp1_b32 s15, 1
s_cselect_b32 s50, s90, 0
v_mfma_f32_16x16x32_bf16 v[36:39], a[28:31], a[244:247], v[36:39]
buffer_load_dwordx4 v[72:75], v3, s[48:51], s45 offen offset:0 sc1
v_mfma_f32_16x16x32_bf16 v[28:31], a[28:31], a[240:243], v[28:31]
v_mfma_f32_16x16x32_bf16 v[28:31], a[24:27], a[224:227], v[28:31]
s_waitcnt lgkmcnt(4)
v_mfma_f32_16x16x32_bf16 v[24:27], a[0:3], a[64:67], v[24:27]
ds_read_b64_tr_b16 a[24:25], v5 offset:16384
v_mfma_f32_16x16x32_bf16 v[24:27], a[4:7], a[80:83], v[24:27]
ds_read_b64_tr_b16 a[26:27], v5 offset:20480
v_mfma_f32_16x16x32_bf16 v[32:35], a[4:7], a[84:87], v[32:35]
ds_read_b64_tr_b16 a[28:29], v5 offset:24576
v_mfma_f32_16x16x32_bf16 v[32:35], a[0:3], a[68:71], v[32:35]
ds_read_b64_tr_b16 a[30:31], v5 offset:28672
v_mfma_f32_16x16x32_bf16 v[40:43], a[0:3], a[72:75], v[40:43]
buffer_load_dwordx4 v[76:79], v3, s[48:51], s45 offen offset:1024 sc1
v_mfma_f32_16x16x32_bf16 v[40:43], a[4:7], a[88:91], v[40:43]
v_mfma_f32_16x16x32_bf16 v[48:51], a[4:7], a[92:95], v[48:51]
buffer_load_dwordx4 v[80:83], v3, s[48:51], s45 offen offset:2048 sc1
v_mfma_f32_16x16x32_bf16 v[48:51], a[0:3], a[76:79], v[48:51]
v_mfma_f32_16x16x32_bf16 v[52:55], a[8:11], a[76:79], v[52:55]
buffer_load_dwordx4 v[84:87], v3, s[48:51], s45 offen offset:3072 sc1
v_mfma_f32_16x16x32_bf16 v[52:55], a[12:15], a[92:95], v[52:55]
v_mfma_f32_16x16x32_bf16 v[44:47], a[12:15], a[88:91], v[44:47]
s_bitcmp1_b32 s15, 2
s_cselect_b32 s50, s90, 0
v_mfma_f32_16x16x32_bf16 v[44:47], a[8:11], a[72:75], v[44:47]
buffer_load_dwordx4 v[88:91], v3, s[48:51], s46 offen offset:0 sc1
v_mfma_f32_16x16x32_bf16 v[36:39], a[8:11], a[68:71], v[36:39]
v_mfma_f32_16x16x32_bf16 v[36:39], a[12:15], a[84:87], v[36:39]
buffer_load_dwordx4 v[92:95], v3, s[48:51], s46 offen offset:1024 sc1
v_mfma_f32_16x16x32_bf16 v[28:31], a[12:15], a[80:83], v[28:31]
v_mfma_f32_16x16x32_bf16 v[28:31], a[8:11], a[64:67], v[28:31]
s_waitcnt lgkmcnt(0)
v_mfma_f32_16x16x32_bf16 v[24:27], a[16:19], a[96:99], v[24:27]
buffer_load_dwordx4 v[96:99], v3, s[48:51], s46 offen offset:2048 sc1
v_mfma_f32_16x16x32_bf16 v[24:27], a[20:23], a[112:115], v[24:27]
v_mfma_f32_16x16x32_bf16 v[32:35], a[20:23], a[116:119], v[32:35]
buffer_load_dwordx4 v[100:103], v3, s[48:51], s46 offen offset:3072 sc1
v_mfma_f32_16x16x32_bf16 v[32:35], a[16:19], a[100:103], v[32:35]
v_mfma_f32_16x16x32_bf16 v[40:43], a[16:19], a[104:107], v[40:43]
v_mfma_f32_16x16x32_bf16 v[40:43], a[20:23], a[120:123], v[40:43]
v_mfma_f32_16x16x32_bf16 v[48:51], a[20:23], a[124:127], v[48:51]
v_mfma_f32_16x16x32_bf16 v[48:51], a[16:19], a[108:111], v[48:51]
v_mfma_f32_16x16x32_bf16 v[52:55], a[24:27], a[108:111], v[52:55]
v_mfma_f32_16x16x32_bf16 v[52:55], a[28:31], a[124:127], v[52:55]
v_mfma_f32_16x16x32_bf16 v[44:47], a[28:31], a[120:123], v[44:47]
v_mfma_f32_16x16x32_bf16 v[44:47], a[24:27], a[104:107], v[44:47]
v_mfma_f32_16x16x32_bf16 v[36:39], a[24:27], a[100:103], v[36:39]
v_mfma_f32_16x16x32_bf16 v[36:39], a[28:31], a[116:119], v[36:39]
v_mfma_f32_16x16x32_bf16 v[28:31], a[28:31], a[112:115], v[28:31]
L_padC4:
s_cmp_eq_u32 s95, 1
s_cbranch_scc1 L_hopC_ret
v_mfma_f32_16x16x32_bf16 v[28:31], a[24:27], a[96:99], v[28:31]
s_cmp_eq_u32 s15, 7
s_cbranch_scc1 L_x_all
buffer_load_dword v14, v1, s[88:91], s44 offen sc1
L_x_all:
v_pk_fma_f32 v[48:49], v[48:49], v[10:11], v[152:153] op_sel:[0,1,0] op_sel_hi:[1,1,1]
v_pk_fma_f32 v[50:51], v[50:51], v[10:11], v[154:155] op_sel:[0,1,0] op_sel_hi:[1,1,1]
v_pk_fma_f32 v[52:53], v[52:53], v[10:11], v[156:157] op_sel:[0,1,0] op_sel_hi:[1,1,1]
v_pk_fma_f32 v[54:55], v[54:55], v[10:11], v[158:159] op_sel:[0,1,0] op_sel_hi:[1,1,1]
v_accvgpr_read_b32 v152, a48
v_accvgpr_read_b32 v153, a49
v_accvgpr_read_b32 v154, a50
v_accvgpr_read_b32 v155, a51
v_accvgpr_read_b32 v156, a52
v_accvgpr_read_b32 v157, a53
v_accvgpr_read_b32 v158, a54
v_accvgpr_read_b32 v159, a55
v_pk_fma_f32 v[40:41], v[40:41], v[10:11], v[152:153] op_sel_hi:[1,0,1]
v_pk_fma_f32 v[42:43], v[42:43], v[10:11], v[154:155] op_sel_hi:[1,0,1]
v_pk_fma_f32 v[44:45], v[44:45], v[10:11], v[156:157] op_sel_hi:[1,0,1]
v_pk_fma_f32 v[46:47], v[46:47], v[10:11], v[158:159] op_sel_hi:[1,0,1]
v_accvgpr_read_b32 v152, a40
v_accvgpr_read_b32 v153, a41
v_accvgpr_read_b32 v154, a42
v_accvgpr_read_b32 v155, a43
v_accvgpr_read_b32 v156, a44
v_accvgpr_read_b32 v157, a45
v_accvgpr_read_b32 v158, a46
v_accvgpr_read_b32 v159, a47
v_pk_fma_f32 v[32:33], v[32:33], v[8:9], v[152:153] op_sel:[0,1,0] op_sel_hi:[1,1,1]
v_pk_fma_f32 v[34:35], v[34:35], v[8:9], v[154:155] op_sel:[0,1,0] op_sel_hi:[1,1,1]
v_pk_fma_f32 v[36:37], v[36:37], v[8:9], v[156:157] op_sel:[0,1,0] op_sel_hi:[1,1,1]
v_pk_fma_f32 v[38:39], v[38:39], v[8:9], v[158:159] op_sel:[0,1,0] op_sel_hi:[1,1,1]
v_accvgpr_read_b32 v152, a32
v_accvgpr_read_b32 v153, a33
v_accvgpr_read_b32 v154, a34
v_accvgpr_read_b32 v155, a35
v_accvgpr_read_b32 v156, a36
v_accvgpr_read_b32 v157, a37
v_accvgpr_read_b32 v158, a38
v_accvgpr_read_b32 v159, a39
v_pk_fma_f32 v[24:25], v[24:25], v[8:9], v[152:153] op_sel_hi:[1,0,1]
v_pk_fma_f32 v[26:27], v[26:27], v[8:9], v[154:155] op_sel_hi:[1,0,1]
v_pk_fma_f32 v[28:29], v[28:29], v[8:9], v[156:157] op_sel_hi:[1,0,1]
v_pk_fma_f32 v[30:31], v[30:31], v[8:9], v[158:159] op_sel_hi:[1,0,1]
s_mov_b32 s10, 0x3f80
s_mov_b32 s11, 0x3f800000
s_mov_b32 s92, 200000
s_bitcmp0_b32 s15, 0
s_cbranch_scc1 L_look_x1
s_waitcnt vmcnt(12)
L_spin_x1:
v_max3_u32 v164, v56, v57, 0
v_max3_u32 v164, v58, v59, v164
v_max3_u32 v164, v60, v61, v164
v_max3_u32 v164, v62, v63, v164
v_max3_u32 v164, v64, v65, v164
v_max3_u32 v164, v66, v67, v164
v_max3_u32 v164, v68, v69, v164
v_max3_u32 v164, v70, v71, v164
v_cmp_eq_u32 vcc, -1, v164
s_nop 1
s_cbranch_vccnz L_again_x1
L_spun_x1:
v_dot2c_f32_bf16 v24, s10, v56
v_dot2c_f32_bf16 v25, s11, v56
v_dot2c_f32_bf16 v26, s10, v57
v_dot2c_f32_bf16 v27, s11, v57
v_dot2c_f32_bf16 v28, s10, v58
v_dot2c_f32_bf16 v29, s11, v58
v_dot2c_f32_bf16 v30, s10, v59
v_dot2c_f32_bf16 v31, s11, v59
v_dot2c_f32_bf16 v32, s10, v60
v_dot2c_f32_bf16 v33, s11, v60
v_dot2c_f32_bf16 v34, s10, v61
v_dot2c_f32_bf16 v35, s11, v61
v_dot2c_f32_bf16 v36, s10, v62
v_dot2c_f32_bf16 v37, s11, v62
v_dot2c_f32_bf16 v38, s10, v63
v_dot2c_f32_bf16 v39, s11, v63
v_dot2c_f32_bf16 v40, s10, v64
v_dot2c_f32_bf16 v41, s11, v64
v_dot2c_f32_bf16 v42, s10, v65
v_dot2c_f32_bf16 v43, s11, v65
v_dot2c_f32_bf16 v44, s10, v66
v_dot2c_f32_bf16 v45, s11, v66
v_dot2c_f32_bf16 v46, s10, v67
v_dot2c_f32_bf16 v47, s11, v67
v_dot2c_f32_bf16 v48, s10, v68
v_dot2c_f32_bf16 v49, s11, v68
v_dot2c_f32_bf16 v50, s10, v69
v_dot2c_f32_bf16 v51, s11, v69
v_dot2c_f32_bf16 v52, s10, v70
v_dot2c_f32_bf16 v53, s11, v70
v_dot2c_f32_bf16 v54, s10, v71
v_dot2c_f32_bf16 v55, s11, v71
s_mov_b32 s92, 200000
s_bitcmp0_b32 s15, 1
s_cbranch_scc1 L_look_x2
s_waitcnt vmcnt(4)
L_spin_x2:
v_max3_u32 v164, v72, v73, 0
v_max3_u32 v164, v74, v75, v164
v_max3_u32 v164, v76, v77, v164
v_max3_u32 v164, v78, v79, v164
v_max3_u32 v164, v80, v81, v164
v_max3_u32 v164, v82, v83, v164
v_max3_u32 v164, v84, v85, v164
v_max3_u32 v164, v86, v87, v164
v_cmp_eq_u32 vcc, -1, v164
s_nop 1
s_cbranch_vccnz L_again_x2
L_spun_x2:
v_dot2c_f32_bf16 v24, s10, v72
v_dot2c_f32_bf16 v25, s11, v72
v_dot2c_f32_bf16 v26, s10, v73
v_dot2c_f32_bf16 v27, s11, v73
v_dot2c_f32_bf16 v28, s10, v74
v_dot2c_f32_bf16 v29, s11, v74
v_dot2c_f32_bf16 v30, s10, v75
v_dot2c_f32_bf16 v31, s11, v75
v_dot2c_f32_bf16 v32, s10, v76
v_dot2c_f32_bf16 v33, s11, v76
v_dot2c_f32_bf16 v34, s10, v77
v_dot2c_f32_bf16 v35, s11, v77
v_dot2c_f32_bf16 v36, s10, v78
v_dot2c_f32_bf16 v37, s11, v78
v_dot2c_f32_bf16 v38, s10, v79
v_dot2c_f32_bf16 v39, s11, v79
v_dot2c_f32_bf16 v40, s10, v80
v_dot2c_f32_bf16 v41, s11, v80
v_dot2c_f32_bf16 v42, s10, v81
v_dot2c_f32_bf16 v43, s11, v81
v_dot2c_f32_bf16 v44, s10, v82
v_dot2c_f32_bf16 v45, s11, v82
v_dot2c_f32_bf16 v46, s10, v83
v_dot2c_f32_bf16 v47, s11, v83
v_dot2c_f32_bf16 v48, s10, v84
v_dot2c_f32_bf16 v49, s11, v84
v_dot2c_f32_bf16 v50, s10, v85
v_dot2c_f32_bf16 v51, s11, v85
v_dot2c_f32_bf16 v52, s10, v86
v_dot2c_f32_bf16 v53, s11, v86
v_dot2c_f32_bf16 v54, s10, v87
v_dot2c_f32_bf16 v55, s11, v87
s_mov_b32 s92, 200000
s_bitcmp0_b32 s15, 2
s_cbranch_scc1 L_look_x3
s_waitcnt vmcnt(0)
L_spin_x3:
v_max3_u32 v164, v88, v89, 0
v_max3_u32 v164, v90, v91, v164
v_max3_u32 v164, v92, v93, v164
v_max3_u32 v164, v94, v95, v164
v_max3_u32 v164, v96, v97, v164
v_max3_u32 v164, v98, v99, v164
v_max3_u32 v164, v100, v101, v164
v_max3_u32 v164, v102, v103, v164
v_cmp_eq_u32 vcc, -1, v164
s_nop 1
s_cbranch_vccnz L_again_x3
L_spun_x3:
v_dot2c_f32_bf16 v24, s10, v88
v_dot2c_f32_bf16 v25, s11, v88
v_dot2c_f32_bf16 v26, s10, v89
v_dot2c_f32_bf16 v27, s11, v89
v_dot2c_f32_bf16 v28, s10, v90
v_dot2c_f32_bf16 v29, s11, v90
v_dot2c_f32_bf16 v30, s10, v91
v_dot2c_f32_bf16 v31, s11, v91
v_cvt_pk_bf16_f32 v24, v24, v25
v_cvt_pk_bf16_f32 v25, v26, v27
v_cvt_pk_bf16_f32 v26, v28, v29
v_cvt_pk_bf16_f32 v27, v30, v31
s_nop 1
v_permlane16_swap_b32 v24, v26
v_permlane16_swap_b32 v25, v27
buffer_store_dwordx4 v[24:27], v2, s[80:83], s28 offen sc1
v_dot2c_f32_bf16 v32, s10, v92
v_dot2c_f32_bf16 v33, s11, v92
v_dot2c_f32_bf16 v34, s10, v93
v_dot2c_f32_bf16 v35, s11, v93
v_dot2c_f32_bf16 v36, s10, v94
v_dot2c_f32_bf16 v37, s11, v94
v_dot2c_f32_bf16 v38, s10, v95
v_dot2c_f32_bf16 v39, s11, v95
v_cvt_pk_bf16_f32 v32, v32, v33
v_cvt_pk_bf16_f32 v33, v34, v35
v_cvt_pk_bf16_f32 v34, v36, v37
v_cvt_pk_bf16_f32 v35, v38, v39
s_nop 1
v_permlane16_swap_b32 v32, v34
v_permlane16_swap_b32 v33, v35
buffer_store_dwordx4 v[32:35], v2, s[80:83], s29 offen sc1
v_dot2c_f32_bf16 v40, s10, v96
v_dot2c_f32_bf16 v41, s11, v96
v_dot2c_f32_bf16 v42, s10, v97
v_dot2c_f32_bf16 v43, s11, v97
v_dot2c_f32_bf16 v44, s10, v98
v_dot2c_f32_bf16 v45, s11, v98
v_dot2c_f32_bf16 v46, s10, v99
v_dot2c_f32_bf16 v47, s11, v99
v_cvt_pk_bf16_f32 v40, v40, v41
v_cvt_pk_bf16_f32 v41, v42, v43
v_cvt_pk_bf16_f32 v42, v44, v45
v_cvt_pk_bf16_f32 v43, v46, v47
s_nop 1
v_permlane16_swap_b32 v40, v42
v_permlane16_swap_b32 v41, v43
buffer_store_dwordx4 v[40:43], v2, s[80:83], s30 offen sc1
v_dot2c_f32_bf16 v48, s10, v100
v_dot2c_f32_bf16 v49, s11, v100
v_dot2c_f32_bf16 v50, s10, v101
v_dot2c_f32_bf16 v51, s11, v101
v_dot2c_f32_bf16 v52, s10, v102
v_dot2c_f32_bf16 v53, s11, v102
v_dot2c_f32_bf16 v54, s10, v103
v_dot2c_f32_bf16 v55, s11, v103
v_cvt_pk_bf16_f32 v48, v48, v49
v_cvt_pk_bf16_f32 v49, v50, v51
v_cvt_pk_bf16_f32 v50, v52, v53
v_cvt_pk_bf16_f32 v51, v54, v55
s_nop 1
v_permlane16_swap_b32 v48, v50
v_permlane16_swap_b32 v49, v51
buffer_store_dwordx4 v[48:51], v2, s[80:83], s31 offen sc1
L_end:
s_endpgm
L_look_x1:
s_waitcnt vmcnt(0)
v_cmp_ne_u32 vcc, -1, v14
s_sub_u32 s92, s92, 1
s_cselect_b32 s8, 7, vcc_lo
s_andn2_b32 s8, s8, s15
s_or_b32 s15, s15, s8
s_bitcmp0_b32 s8, 0
s_cbranch_scc1 L_not_x11
buffer_load_dwordx4 v[56:59], v3, s[88:91], s44 offen offset:0 sc1
buffer_load_dwordx4 v[60:63], v3, s[88:91], s44 offen offset:1024 sc1
buffer_load_dwordx4 v[64:67], v3, s[88:91], s44 offen offset:2048 sc1
buffer_load_dwordx4 v[68:71], v3, s[88:91], s44 offen offset:3072 sc1
L_not_x11:
s_bitcmp0_b32 s8, 1
s_cbranch_scc1 L_not_x12
buffer_load_dwordx4 v[72:75], v3, s[88:91], s45 offen offset:0 sc1
buffer_load_dwordx4 v[76:79], v3, s[88:91], s45 offen offset:1024 sc1
buffer_load_dwordx4 v[80:83], v3, s[88:91], s45 offen offset:2048 sc1
buffer_load_dwordx4 v[84:87], v3, s[88:91], s45 offen offset:3072 sc1
L_not_x12:
s_bitcmp0_b32 s8, 2
s_cbranch_scc1 L_not_x13
buffer_load_dwordx4 v[88:91], v3, s[88:91], s46 offen offset:0 sc1
buffer_load_dwordx4 v[92:95], v3, s[88:91], s46 offen offset:1024 sc1
buffer_load_dwordx4 v[96:99], v3, s[88:91], s46 offen offset:2048 sc1
buffer_load_dwordx4 v[100:103], v3, s[88:91], s46 offen offset:3072 sc1
L_not_x13:
buffer_load_dword v14, v1, s[88:91], s44 offen sc1
s_bitcmp0_b32 s15, 0
s_cbranch_scc1 L_look_x1
s_mov_b32 s92, 200000
s_waitcnt vmcnt(1)
s_branch L_spin_x1
L_again_x1:
s_sub_u32 s92, s92, 1
s_cbranch_scc1 L_spun_x1
buffer_load_dwordx4 v[56:59], v3, s[88:91], s44 offen offset:0 sc1
buffer_load_dwordx4 v[60:63], v3, s[88:91], s44 offen offset:1024 sc1
buffer_load_dwordx4 v[64:67], v3, s[88:91], s44 offen offset:2048 sc1
buffer_load_dwordx4 v[68:71], v3, s[88:91], s44 offen offset:3072 sc1
s_waitcnt vmcnt(0)
s_branch L_spin_x1
L_look_x2:
s_waitcnt vmcnt(0)
v_cmp_ne_u32 vcc, -1, v14
s_sub_u32 s92, s92, 1
s_cselect_b32 s8, 7, vcc_lo
s_andn2_b32 s8, s8, s15
s_or_b32 s15, s15, s8
s_bitcmp0_b32 s8, 1
s_cbranch_scc1 L_not_x22
buffer_load_dwordx4 v[72:75], v3, s[88:91], s45 offen offset:0 sc1
buffer_load_dwordx4 v[76:79], v3, s[88:91], s45 offen offset:1024 sc1
buffer_load_dwordx4 v[80:83], v3, s[88:91], s45 offen offset:2048 sc1
buffer_load_dwordx4 v[84:87], v3, s[88:91], s45 offen offset:3072 sc1
L_not_x22:
s_bitcmp0_b32 s8, 2
s_cbranch_scc1 L_not_x23
buffer_load_dwordx4 v[88:91], v3, s[88:91], s46 offen offset:0 sc1
buffer_load_dwordx4 v[92:95], v3, s[88:91], s46 offen offset:1024 sc1
buffer_load_dwordx4 v[96:99], v3, s[88:91], s46 offen offset:2048 sc1
buffer_load_dwordx4 v[100:103], v3, s[88:91], s46 offen offset:3072 sc1
L_not_x23:
buffer_load_dword v14, v1, s[88:91], s44 offen sc1
s_bitcmp0_b32 s15, 1
s_cbranch_scc1 L_look_x2
s_mov_b32 s92, 200000
s_waitcnt vmcnt(1)
s_branch L_spin_x2
L_again_x2:
s_sub_u32 s92, s92, 1
s_cbranch_scc1 L_spun_x2
buffer_load_dwordx4 v[72:75], v3, s[88:91], s45 offen offset:0 sc1
buffer_load_dwordx4 v[76:79], v3, s[88:91], s45 offen offset:1024 sc1
buffer_load_dwordx4 v[80:83], v3, s[88:91], s45 offen offset:2048 sc1
buffer_load_dwordx4 v[84:87], v3, s[88:91], s45 offen offset:3072 sc1
s_waitcnt vmcnt(0)
s_branch L_spin_x2
L_look_x3:
s_waitcnt vmcnt(0)
v_cmp_ne_u32 vcc, -1, v14
s_sub_u32 s92, s92, 1
s_cselect_b32 s8, 7, vcc_lo
s_andn2_b32 s8, s8, s15
s_or_b32 s15, s15, s8
s_bitcmp0_b32 s8, 2
s_cbranch_scc1 L_not_x33
buffer_load_dwordx4 v[88:91], v3, s[88:91], s46 offen offset:0 sc1
buffer_load_dwordx4 v[92:95], v3, s[88:91], s46 offen offset:1024 sc1
buffer_load_dwordx4 v[96:99], v3, s[88:91], s46 offen offset:2048 sc1
buffer_load_dwordx4 v[100:103], v3, s[88:91], s46 offen offset:3072 sc1
L_not_x33:
buffer_load_dword v14, v1, s[88:91], s44 offen sc1
s_bitcmp0_b32 s15, 2
s_cbranch_scc1 L_look_x3
s_mov_b32 s92, 200000
s_waitcnt vmcnt(1)
s_branch L_spin_x3
L_again_x3:
s_sub_u32 s92, s92, 1
s_cbranch_scc1 L_spun_x3
buffer_load_dwordx4 v[88:91], v3, s[88:91], s46 offen offset:0 sc1
buffer_load_dwordx4 v[92:95], v3, s[88:91], s46 offen offset:1024 sc1
buffer_load_dwordx4 v[96:99], v3, s[88:91], s46 offen offset:2048 sc1
buffer_load_dwordx4 v[100:103], v3, s[88:91], s46 offen offset:3072 sc1
s_waitcnt vmcnt(0)
s_branch L_spin_x3
L_att_fallback:
s_waitcnt vmcnt(0)
s_mov_b32 s33, 1
s_mul_i32 s32, s5, 0x10c400
s_lshl_b32 s19, s4, 13
s_add_u32 s32, s32, s19
s_cmp_eq_u32 s4, 0
s_cselect_b32 s94, 0x200000, 0
s_add_u32 s32, s32, s94
s_sub_u32 s94, 0x8000, s94
s_add_u32 s7, s32, 0x1000
s_add_u32 s27, s19, 131072
v_and_b32 v5, 15, v0
v_lshrrev_b32 v6, 4, v0
v_lshlrev_b32 v6, 2, v6
v_sub_u32 v5, v5, v6
v_mov_b32 v9, 0xf149f2ca
s_lshr_b32 s8, s20, 11
v_add_u32 v96, s8, v5
v_mov_b32 v80, v9
s_lshr_b32 s8, s21, 11
v_add_u32 v97, s8, v5
v_mov_b32 v84, v9
s_lshr_b32 s8, s22, 11
v_add_u32 v98, s8, v5
v_mov_b32 v88, v9
s_lshr_b32 s8, s23, 11
v_add_u32 v99, s8, v5
v_mov_b32 v92, v9
s_sub_u32 s15, 16, s6
s_lshl_b32 s15, s15, 1
L_fb_loop:
s_waitcnt lgkmcnt(0)
s_barrier
s_add_u32 m0, s19, 0x0
s_nop 0
buffer_load_dwordx4 v3, s[48:51], s32 offen offset:0 sc1 lds
buffer_load_dwordx4 v3, s[48:51], s32 offen offset:1024 sc1 lds
buffer_load_dwordx4 v3, s[48:51], s32 offen offset:2048 sc1 lds
buffer_load_dwordx4 v3, s[48:51], s32 offen offset:3072 sc1 lds
s_add_u32 m0, s19, 0x1000
s_nop 0
buffer_load_dwordx4 v3, s[48:51], s7 offen offset:0 sc1 lds
buffer_load_dwordx4 v3, s[48:51], s7 offen offset:1024 sc1 lds
buffer_load_dwordx4 v3, s[48:51], s7 offen offset:2048 sc1 lds
buffer_load_dwordx4 v3, s[48:51], s7 offen offset:3072 sc1 lds
s_add_u32 s32, s32, s94
s_add_u32 s7, s7, s94
s_mov_b32 s94, 0x8000
s_waitcnt vmcnt(0)
s_barrier
ds_read_b128 a[0:3], v3 offset:8192
ds_read_b128 a[4:7], v3 offset:9216
ds_read_b128 a[8:11], v3 offset:10240
ds_read_b128 a[12:15], v3 offset:11264
ds_read_b128 a[16:19], v3 offset:12288
ds_read_b128 a[20:23], v3 offset:13312
ds_read_b128 a[24:27], v3 offset:14336
ds_read_b128 a[28:31], v3 offset:15360
s_waitcnt lgkmcnt(0)
v_mfma_f32_16x16x32_bf16 v[16:19], a[0:3], a[160:163], 0
v_mfma_f32_16x16x32_bf16 v[16:19], a[4:7], a[164:167], v[16:19]
v_mfma_f32_16x16x32_bf16 v[16:19], a[8:11], a[168:171], v[16:19]
v_mfma_f32_16x16x32_bf16 v[16:19], a[12:15], a[172:175], v[16:19]
v_mfma_f32_16x16x32_bf16 v[20:23], a[0:3], a[176:179], 0
v_mfma_f32_16x16x32_bf16 v[20:23], a[4:7], a[180:183], v[20:23]
v_mfma_f32_16x16x32_bf16 v[20:23], a[8:11], a[184:187], v[20:23]
v_mfma_f32_16x16x32_bf16 v[20:23], a[12:15], a[188:191], v[20:23]
v_mfma_f32_16x16x32_bf16 v[24:27], a[0:3], a[192:195], 0
v_mfma_f32_16x16x32_bf16 v[24:27], a[4:7], a[196:199], v[24:27]
v_mfma_f32_16x16x32_bf16 v[24:27], a[8:11], a[200:203], v[24:27]
v_mfma_f32_16x16x32_bf16 v[24:27], a[12:15], a[204:207], v[24:27]
v_mfma_f32_16x16x32_bf16 v[28:31], a[0:3], a[208:211], 0
v_mfma_f32_16x16x32_bf16 v[28:31], a[4:7], a[212:215], v[28:31]
v_mfma_f32_16x16x32_bf16 v[28:31], a[8:11], a[216:219], v[28:31]
v_mfma_f32_16x16x32_bf16 v[28:31], a[12:15], a[220:223], v[28:31]
v_mfma_f32_16x16x32_bf16 v[32:35], a[16:19], a[160:163], 0
v_mfma_f32_16x16x32_bf16 v[32:35], a[20:23], a[164:167], v[32:35]
v_mfma_f32_16x16x32_bf16 v[32:35], a[24:27], a[168:171], v[32:35]
v_mfma_f32_16x16x32_bf16 v[32:35], a[28:31], a[172:175], v[32:35]
v_mfma_f32_16x16x32_bf16 v[36:39], a[16:19], a[176:179], 0
v_mfma_f32_16x16x32_bf16 v[36:39], a[20:23], a[180:183], v[36:39]
v_mfma_f32_16x16x32_bf16 v[36:39], a[24:27], a[184:187], v[36:39]
v_mfma_f32_16x16x32_bf16 v[36:39], a[28:31], a[188:191], v[36:39]
v_mfma_f32_16x16x32_bf16 v[40:43], a[16:19], a[192:195], 0
v_mfma_f32_16x16x32_bf16 v[40:43], a[20:23], a[196:199], v[40:43]
v_mfma_f32_16x16x32_bf16 v[40:43], a[24:27], a[200:203], v[40:43]
v_mfma_f32_16x16x32_bf16 v[40:43], a[28:31], a[204:207], v[40:43]
v_mfma_f32_16x16x32_bf16 v[44:47], a[16:19], a[208:211], 0
v_mfma_f32_16x16x32_bf16 v[44:47], a[20:23], a[212:215], v[44:47]
v_mfma_f32_16x16x32_bf16 v[44:47], a[24:27], a[216:219], v[44:47]
v_mfma_f32_16x16x32_bf16 v[44:47], a[28:31], a[220:223], v[44:47]
s_nop 7
v_cmp_le_i32 s[36:37], 0, v96
v_cmp_le_i32 s[38:39], 1, v96
v_cmp_le_i32 s[40:41], 2, v96
v_cmp_le_i32 s[42:43], 3, v96
s_nop 1
v_cndmask_b32 v16, v9, v16, s[36:37]
v_cndmask_b32 v17, v9, v17, s[38:39]
v_cndmask_b32 v18, v9, v18, s[40:41]
v_cndmask_b32 v19, v9, v19, s[42:43]
v_max3_f32 v80, v80, v16, v17
v_max3_f32 v80, v80, v18, v19
v_cmp_le_i32 s[36:37], 0, v97
v_cmp_le_i32 s[38:39], 1, v97
v_cmp_le_i32 s[40:41], 2, v97
v_cmp_le_i32 s[42:43], 3, v97
s_nop 1
v_cndmask_b32 v20, v9, v20, s[36:37]
v_cndmask_b32 v21, v9, v21, s[38:39]
v_cndmask_b32 v22, v9, v22, s[40:41]
v_cndmask_b32 v23, v9, v23, s[42:43]
v_max3_f32 v84, v84, v20, v21
v_max3_f32 v84, v84, v22, v23
v_cmp_le_i32 s[36:37], 0, v98
v_cmp_le_i32 s[38:39], 1, v98
v_cmp_le_i32 s[40:41], 2, v98
v_cmp_le_i32 s[42:43], 3, v98
s_nop 1
v_cndmask_b32 v24, v9, v24, s[36:37]
v_cndmask_b32 v25, v9, v25, s[38:39]
v_cndmask_b32 v26, v9, v26, s[40:41]
v_cndmask_b32 v27, v9, v27, s[42:43]
v_max3_f32 v88, v88, v24, v25
v_max3_f32 v88, v88, v26, v27
v_cmp_le_i32 s[36:37], 0, v99
v_cmp_le_i32 s[38:39], 1, v99
v_cmp_le_i32 s[40:41], 2, v99
v_cmp_le_i32 s[42:43], 3, v99
s_nop 1
v_cndmask_b32 v28, v9, v28, s[36:37]
v_cndmask_b32 v29, v9, v29, s[38:39]
v_cndmask_b32 v30, v9, v30, s[40:41]
v_cndmask_b32 v31, v9, v31, s[42:43]
v_max3_f32 v92, v92, v28, v29
v_max3_f32 v92, v92, v30, v31
v_cmp_le_i32 s[36:37], 16, v96
v_cmp_le_i32 s[38:39], 17, v96
v_cmp_le_i32 s[40:41], 18, v96
v_cmp_le_i32 s[42:43], 19, v96
s_nop 1
v_cndmask_b32 v32, v9, v32, s[36:37]
v_cndmask_b32 v33, v9, v33, s[38:39]
v_cndmask_b32 v34, v9, v34, s[40:41]
v_cndmask_b32 v35, v9, v35, s[42:43]
v_max3_f32 v80, v80, v32, v33
v_max3_f32 v80, v80, v34, v35
v_cmp_le_i32 s[36:37], 16, v97
v_cmp_le_i32 s[38:39], 17, v97
v_cmp_le_i32 s[40:41], 18, v97
v_cmp_le_i32 s[42:43], 19, v97
s_nop 1
v_cndmask_b32 v36, v9, v36, s[36:37]
v_cndmask_b32 v37, v9, v37, s[38:39]
v_cndmask_b32 v38, v9, v38, s[40:41]
v_cndmask_b32 v39, v9, v39, s[42:43]
v_max3_f32 v84, v84, v36, v37
v_max3_f32 v84, v84, v38, v39
v_cmp_le_i32 s[36:37], 16, v98
v_cmp_le_i32 s[38:39], 17, v98
v_cmp_le_i32 s[40:41], 18, v98
v_cmp_le_i32 s[42:43], 19, v98
s_nop 1
v_cndmask_b32 v40, v9, v40, s[36:37]
v_cndmask_b32 v41, v9, v41, s[38:39]
v_cndmask_b32 v42, v9, v42, s[40:41]
v_cndmask_b32 v43, v9, v43, s[42:43]
v_max3_f32 v88, v88, v40, v41
v_max3_f32 v88, v88, v42, v43
v_cmp_le_i32 s[36:37], 16, v99
v_cmp_le_i32 s[38:39], 17, v99
v_cmp_le_i32 s[40:41], 18, v99
v_cmp_le_i32 s[42:43], 19, v99
s_nop 1
v_cndmask_b32 v44, v9, v44, s[36:37]
v_cndmask_b32 v45, v9, v45, s[38:39]
v_cndmask_b32 v46, v9, v46, s[40:41]
v_cndmask_b32 v47, v9, v47, s[42:43]
v_max3_f32 v92, v92, v44, v45
v_max3_f32 v92, v92, v46, v47
ds_read_b128 a[0:3], v3 offset:24576
ds_read_b128 a[4:7], v3 offset:25600
ds_read_b128 a[8:11], v3 offset:26624
ds_read_b128 a[12:15], v3 offset:27648
ds_read_b128 a[16:19], v3 offset:28672
ds_read_b128 a[20:23], v3 offset:29696
ds_read_b128 a[24:27], v3 offset:30720
ds_read_b128 a[28:31], v3 offset:31744
s_waitcnt lgkmcnt(0)
v_mfma_f32_16x16x32_bf16 v[16:19], a[0:3], a[160:163], 0
v_mfma_f32_16x16x32_bf16 v[16:19], a[4:7], a[164:167], v[16:19]
v_mfma_f32_16x16x32_bf16 v[16:19], a[8:11], a[168:171], v[16:19]
v_mfma_f32_16x16x32_bf16 v[16:19], a[12:15], a[172:175], v[16:19]
v_mfma_f32_16x16x32_bf16 v[20:23], a[0:3], a[176:179], 0
v_mfma_f32_16x16x32_bf16 v[20:23], a[4:7], a[180:183], v[20:23]
v_mfma_f32_16x16x32_bf16 v[20:23], a[8:11], a[184:187], v[20:23]
v_mfma_f32_16x16x32_bf16 v[20:23], a[12:15], a[188:191], v[20:23]
v_mfma_f32_16x16x32_bf16 v[24:27], a[0:3], a[192:195], 0
v_mfma_f32_16x16x32_bf16 v[24:27], a[4:7], a[196:199], v[24:27]
v_mfma_f32_16x16x32_bf16 v[24:27], a[8:11], a[200:203], v[24:27]
v_mfma_f32_16x16x32_bf16 v[24:27], a[12:15], a[204:207], v[24:27]
v_mfma_f32_16x16x32_bf16 v[28:31], a[0:3], a[208:211], 0
v_mfma_f32_16x16x32_bf16 v[28:31], a[4:7], a[212:215], v[28:31]
v_mfma_f32_16x16x32_bf16 v[28:31], a[8:11], a[216:219], v[28:31]
v_mfma_f32_16x16x32_bf16 v[28:31], a[12:15], a[220:223], v[28:31]
v_mfma_f32_16x16x32_bf16 v[32:35], a[16:19], a[160:163], 0
v_mfma_f32_16x16x32_bf16 v[32:35], a[20:23], a[164:167], v[32:35]
v_mfma_f32_16x16x32_bf16 v[32:35], a[24:27], a[168:171], v[32:35]
v_mfma_f32_16x16x32_bf16 v[32:35], a[28:31], a[172:175], v[32:35]
v_mfma_f32_16x16x32_bf16 v[36:39], a[16:19], a[176:179], 0
v_mfma_f32_16x16x32_bf16 v[36:39], a[20:23], a[180:183], v[36:39]
v_mfma_f32_16x16x32_bf16 v[36:39], a[24:27], a[184:187], v[36:39]
v_mfma_f32_16x16x32_bf16 v[36:39], a[28:31], a[188:191], v[36:39]
v_mfma_f32_16x16x32_bf16 v[40:43], a[16:19], a[192:195], 0
v_mfma_f32_16x16x32_bf16 v[40:43], a[20:23], a[196:199], v[40:43]
v_mfma_f32_16x16x32_bf16 v[40:43], a[24:27], a[200:203], v[40:43]
v_mfma_f32_16x16x32_bf16 v[40:43], a[28:31], a[204:207], v[40:43]
v_mfma_f32_16x16x32_bf16 v[44:47], a[16:19], a[208:211], 0
v_mfma_f32_16x16x32_bf16 v[44:47], a[20:23], a[212:215], v[44:47]
v_mfma_f32_16x16x32_bf16 v[44:47], a[24:27], a[216:219], v[44:47]
v_mfma_f32_16x16x32_bf16 v[44:47], a[28:31], a[220:223], v[44:47]
s_nop 7
v_cmp_le_i32 s[36:37], 32, v96
v_cmp_le_i32 s[38:39], 33, v96
v_cmp_le_i32 s[40:41], 34, v96
v_cmp_le_i32 s[42:43], 35, v96
s_nop 1
v_cndmask_b32 v16, v9, v16, s[36:37]
v_cndmask_b32 v17, v9, v17, s[38:39]
v_cndmask_b32 v18, v9, v18, s[40:41]
v_cndmask_b32 v19, v9, v19, s[42:43]
v_max3_f32 v80, v80, v16, v17
v_max3_f32 v80, v80, v18, v19
v_cmp_le_i32 s[36:37], 32, v97
v_cmp_le_i32 s[38:39], 33, v97
v_cmp_le_i32 s[40:41], 34, v97
v_cmp_le_i32 s[42:43], 35, v97
s_nop 1
v_cndmask_b32 v20, v9, v20, s[36:37]
v_cndmask_b32 v21, v9, v21, s[38:39]
v_cndmask_b32 v22, v9, v22, s[40:41]
v_cndmask_b32 v23, v9, v23, s[42:43]
v_max3_f32 v84, v84, v20, v21
v_max3_f32 v84, v84, v22, v23
v_cmp_le_i32 s[36:37], 32, v98
v_cmp_le_i32 s[38:39], 33, v98
v_cmp_le_i32 s[40:41], 34, v98
v_cmp_le_i32 s[42:43], 35, v98
s_nop 1
v_cndmask_b32 v24, v9, v24, s[36:37]
v_cndmask_b32 v25, v9, v25, s[38:39]
v_cndmask_b32 v26, v9, v26, s[40:41]
v_cndmask_b32 v27, v9, v27, s[42:43]
v_max3_f32 v88, v88, v24, v25
v_max3_f32 v88, v88, v26, v27
v_cmp_le_i32 s[36:37], 32, v99
v_cmp_le_i32 s[38:39], 33, v99
v_cmp_le_i32 s[40:41], 34, v99
v_cmp_le_i32 s[42:43], 35, v99
s_nop 1
v_cndmask_b32 v28, v9, v28, s[36:37]
v_cndmask_b32 v29, v9, v29, s[38:39]
v_cndmask_b32 v30, v9, v30, s[40:41]
v_cndmask_b32 v31, v9, v31, s[42:43]
v_max3_f32 v92, v92, v28, v29
v_max3_f32 v92, v92, v30, v31
v_cmp_le_i32 s[36:37], 48, v96
v_cmp_le_i32 s[38:39], 49, v96
v_cmp_le_i32 s[40:41], 50, v96
v_cmp_le_i32 s[42:43], 51, v96
s_nop 1
v_cndmask_b32 v32, v9, v32, s[36:37]
v_cndmask_b32 v33, v9, v33, s[38:39]
v_cndmask_b32 v34, v9, v34, s[40:41]
v_cndmask_b32 v35, v9, v35, s[42:43]
v_max3_f32 v80, v80, v32, v33
v_max3_f32 v80, v80, v34, v35
v_cmp_le_i32 s[36:37], 48, v97
v_cmp_le_i32 s[38:39], 49, v97
v_cmp_le_i32 s[40:41], 50, v97
v_cmp_le_i32 s[42:43], 51, v97
s_nop 1
v_cndmask_b32 v36, v9, v36, s[36:37]
v_cndmask_b32 v37, v9, v37, s[38:39]
v_cndmask_b32 v38, v9, v38, s[40:41]
v_cndmask_b32 v39, v9, v39, s[42:43]
v_max3_f32 v84, v84, v36, v37
v_max3_f32 v84, v84, v38, v39
v_cmp_le_i32 s[36:37], 48, v98
v_cmp_le_i32 s[38:39], 49, v98
v_cmp_le_i32 s[40:41], 50, v98
v_cmp_le_i32 s[42:43], 51, v98
s_nop 1
v_cndmask_b32 v40, v9, v40, s[36:37]
v_cndmask_b32 v41, v9, v41, s[38:39]
v_cndmask_b32 v42, v9, v42, s[40:41]
v_cndmask_b32 v43, v9, v43, s[42:43]
v_max3_f32 v88, v88, v40, v41
v_max3_f32 v88, v88, v42, v43
v_cmp_le_i32 s[36:37], 48, v99
v_cmp_le_i32 s[38:39], 49, v99
v_cmp_le_i32 s[40:41], 50, v99
v_cmp_le_i32 s[42:43], 51, v99
s_nop 1
v_cndmask_b32 v44, v9, v44, s[36:37]
v_cndmask_b32 v45, v9, v45, s[38:39]
v_cndmask_b32 v46, v9, v46, s[40:41]
v_cndmask_b32 v47, v9, v47, s[42:43]
v_max3_f32 v92, v92, v44, v45
v_max3_f32 v92, v92, v46, v47
v_subrev_u32 v96, 64, v96
v_subrev_u32 v97, 64, v97
v_subrev_u32 v98, 64, v98
v_subrev_u32 v99, 64, v99
s_sub_u32 s15, s15, 1
s_cmp_lg_u32 s15, 0
s_cbranch_scc1 L_fb_loop
v_mov_b32 v16, v80
v_mov_b32 v20, v84
v_mov_b32 v24, v88
v_mov_b32 v28, v92
v_permlane16_swap_b32 v16, v80
v_permlane16_swap_b32 v20, v84
v_permlane16_swap_b32 v24, v88
v_permlane16_swap_b32 v28, v92
v_max_f32 v80, v80, v16
v_max_f32 v84, v84, v20
v_max_f32 v88, v88, v24
v_max_f32 v92, v92, v28
v_mov_b32 v16, v80
v_mov_b32 v20, v84
v_mov_b32 v24, v88
v_mov_b32 v28, v92
v_permlane32_swap_b32 v16, v80
v_permlane32_swap_b32 v20, v84
v_permlane32_swap_b32 v24, v88
v_permlane32_swap_b32 v28, v92
v_max_f32 v80, v80, v16
v_max_f32 v84, v84, v20
v_max_f32 v88, v88, v24
v_max_f32 v92, v92, v28
s_barrier
s_mul_i32 s32, s5, 0x10c400
s_lshl_b32 s19, s4, 13
s_add_u32 s32, s32, s19
s_cmp_eq_u32 s4, 0
s_cselect_b32 s94, 0x200000, 0
s_add_u32 s32, s32, s94
s_sub_u32 s94, 0x8000, s94
s_add_u32 s7, s32, 0x1000
s_add_u32 s27, s19, 131072
s_add_u32 m0, s19, 0x0
s_nop 0
buffer_load_dwordx4 v3, s[48:51], s32 offen offset:0 sc1 lds
buffer_load_dwordx4 v3, s[48:51], s32 offen offset:1024 sc1 lds
buffer_load_dwordx4 v3, s[48:51], s32 offen offset:2048 sc1 lds
buffer_load_dwordx4 v3, s[48:51], s32 offen offset:3072 sc1 lds
s_add_u32 m0, s19, 0x1000
s_nop 0
buffer_load_dwordx4 v3, s[48:51], s7 offen offset:0 sc1 lds
buffer_load_dwordx4 v3, s[48:51], s7 offen offset:1024 sc1 lds
buffer_load_dwordx4 v3, s[48:51], s7 offen offset:2048 sc1 lds
buffer_load_dwordx4 v3, s[48:51], s7 offen offset:3072 sc1 lds
s_add_u32 s32, s32, s94
s_add_u32 s7, s7, s94
s_add_u32 m0, s19, 0x18000
s_nop 0
buffer_load_dwordx4 v3, s[48:51], s32 offen offset:0 sc1 lds
buffer_load_dwordx4 v3, s[48:51], s32 offen offset:1024 sc1 lds
buffer_load_dwordx4 v3, s[48:51], s32 offen offset:2048 sc1 lds
buffer_load_dwordx4 v3, s[48:51], s32 offen offset:3072 sc1 lds
s_add_u32 m0, s19, 0x19000
s_nop 0
buffer_load_dwordx4 v3, s[48:51], s7 offen offset:0 sc1 lds
buffer_load_dwordx4 v3, s[48:51], s7 offen offset:1024 sc1 lds
buffer_load_dwordx4 v3, s[48:51], s7 offen offset:2048 sc1 lds
buffer_load_dwordx4 v3, s[48:51], s7 offen offset:3072 sc1 lds
s_add_u32 s32, s32, 0x8000
s_add_u32 s7, s7, 0x8000
s_add_u32 m0, s19, 0x8000
s_nop 0
buffer_load_dwordx4 v3, s[48:51], s32 offen offset:0 sc1 lds
buffer_load_dwordx4 v3, s[48:51], s32 offen offset:1024 sc1 lds
buffer_load_dwordx4 v3, s[48:51], s32 offen offset:2048 sc1 lds
buffer_load_dwordx4 v3, s[48:51], s32 offen offset:3072 sc1 lds
s_add_u32 m0, s19, 0x9000
s_nop 0
buffer_load_dwordx4 v3, s[48:51], s7 offen offset:0 sc1 lds
buffer_load_dwordx4 v3, s[48:51], s7 offen offset:1024 sc1 lds
buffer_load_dwordx4 v3, s[48:51], s7 offen offset:2048 sc1 lds
buffer_load_dwordx4 v3, s[48:51], s7 offen offset:3072 sc1 lds
s_add_u32 s32, s32, 0x8000
s_add_u32 s7, s7, 0x8000
s_and_b32 s18, s2, 4
s_lshr_b32 s8, s2, 6
s_add_u32 s18, s18, s8
s_sub_u32 s8, 15, s18
s_cmp_lt_u32 s4, 2
s_cselect_b32 s99, s18, s8
s_lshl_b32 s16, s2, 2
s_add_u32 s16, s16, s4
s_lshl_b32 s16, s16, 12
s_add_u32 s16, s16, 0x4800000
s_bfe_u32 s100, s2, 0x30003
s_and_b32 s14, s2, 3
s_lshl_b32 s24, s18, 2
s_add_u32 s24, s24, s14
s_lshl_b32 s24, s24, 8
s_add_u32 s24, s24, 0x3704000
s_mov_b32 s12, 14336
s_lshl_b32 s13, s4, 15
s_lshl_b32 s9, s100, 8
s_add_u32 s13, s13, s9
s_mul_i32 s9, s14, 0x80040
s_add_u32 s13, s13, s9
s_and_b32 s9, s2, 1
s_lshl_b32 s9, s9, 17
s_add_u32 s13, s13, s9
s_mul_i32 s25, s14, 0x180000
s_add_u32 s25, s25, s9
s_sub_u32 s25, s25, 524288
s_lshr_b32 s9, s9, 3
s_mul_i32 s101, s99, 0x142400
s_and_b32 s8, s4, 1
s_lshl_b32 s8, s8, 12
s_add_u32 s101, s101, s8
s_lshl_b32 s8, s14, 16
s_add_u32 s101, s101, s8
s_add_u32 s101, s101, s9
s_add_u32 s101, s101, 0x21fe000
s_mul_i32 s26, s14, 196608
s_add_u32 s26, s26, s9
s_add_u32 s26, s26, 188416
v_mov_b32 v15, s6
v_xor_b32 v15, 0, v15
v_writelane_b32 v15, s18, 0
v_lshlrev_b32 v15, 2, v15
v_bfe_u32 v12, v0, 2, 2
v_lshlrev_b32 v12, 11, v12
v_lshrrev_b32 v13, 4, v0
v_lshl_add_u32 v12, v13, 6, v12
v_and_b32 v13, 3, v0
v_lshl_add_u32 v12, v13, 4, v12
v_xor_b32 v12, s13, v12
v_xor_b32 v13, 32, v12
v_add_u32 v13, 7168, v13
s_mov_b32 s8, 0xf149f2ca
s_mov_b32 s36, 0xfff0ffff
s_mov_b32 s37, 0xf000ff00
s_mov_b32 s38, 0xffe0fffe
s_mov_b32 s39, 0xe000fe00
s_mov_b32 s40, 0xffc0fffc
s_mov_b32 s41, 0xc000fc00
s_mov_b32 s42, 0xff80fff8
s_mov_b32 s43, 0x8000f800
s_bitcmp1_b32 s4, 0
s_cselect_b32 s10, 0x7f800000, s8
s_cselect_b32 s11, s8, 0x7f800000
v_mov_b32 v1, v3
v_add_u32 v2, 98304, v3
s_mov_b64 s[34:35], 0
v_accvgpr_write_b32 a224, 0
v_accvgpr_write_b32 a225, 0
v_accvgpr_write_b32 a226, 0
v_accvgpr_write_b32 a227, 0
v_accvgpr_write_b32 a228, 0
v_accvgpr_write_b32 a229, 0
v_accvgpr_write_b32 a230, 0
v_accvgpr_write_b32 a231, 0
v_sub_f32 v83, 0, v80
v_sub_f32 v82, 0, v80
v_sub_f32 v81, 0, v80
v_sub_f32 v80, 0, v80
v_sub_f32 v87, 0, v84
v_sub_f32 v86, 0, v84
v_sub_f32 v85, 0, v84
v_sub_f32 v84, 0, v84
v_sub_f32 v91, 0, v88
v_sub_f32 v90, 0, v88
v_sub_f32 v89, 0, v88
v_sub_f32 v88, 0, v88
v_sub_f32 v95, 0, v92
v_sub_f32 v94, 0, v92
v_sub_f32 v93, 0, v92
v_sub_f32 v92, 0, v92
v_min_f32 v103, s10, v80
v_cndmask_b32 v96, v103, v80, s[36:37]
v_cndmask_b32 v97, v103, v80, s[38:39]
v_cndmask_b32 v98, v103, v80, s[40:41]
v_cndmask_b32 v99, v103, v80, s[42:43]
v_cndmask_b32 v100, v9, v103, s[36:37]
v_cndmask_b32 v101, v9, v103, s[38:39]
v_cndmask_b32 v102, v9, v103, s[40:41]
v_cndmask_b32 v103, v9, v103, s[42:43]
v_min_f32 v111, s11, v84
v_cndmask_b32 v104, v111, v84, s[36:37]
v_cndmask_b32 v105, v111, v84, s[38:39]
v_cndmask_b32 v106, v111, v84, s[40:41]
v_cndmask_b32 v107, v111, v84, s[42:43]
v_cndmask_b32 v108, v9, v111, s[36:37]
v_cndmask_b32 v109, v9, v111, s[38:39]
v_cndmask_b32 v110, v9, v111, s[40:41]
v_cndmask_b32 v111, v9, v111, s[42:43]
v_and_b32 v9, 1, v0
v_mul_u32_u24 v9, 0xaaaa, v9
v_add_u32 v9, 0x4444, v9
v_accvgpr_write_b32 a64, -1
v_accvgpr_write_b32 a65, -1
v_accvgpr_write_b32 a66, -1
v_accvgpr_write_b32 a67, -1
v_mov_b32 v128, 0
v_mov_b32 v129, 0
v_mov_b32 v130, 0
v_mov_b32 v131, 0
v_mov_b32 v132, 0
v_mov_b32 v133, 0
v_mov_b32 v134, 0
v_mov_b32 v135, 0
v_mov_b32 v136, 0
v_mov_b32 v137, 0
v_mov_b32 v138, 0
v_mov_b32 v139, 0
v_mov_b32 v140, 0
v_mov_b32 v141, 0
v_mov_b32 v142, 0
v_mov_b32 v143, 0
v_mov_b32 v144, 0
v_mov_b32 v145, 0
v_mov_b32 v146, 0
v_mov_b32 v147, 0
v_mov_b32 v148, 0
v_mov_b32 v149, 0
v_mov_b32 v150, 0
v_mov_b32 v151, 0
v_mov_b32 v152, 0
v_mov_b32 v153, 0
v_mov_b32 v154, 0
v_mov_b32 v155, 0
v_mov_b32 v156, 0
v_mov_b32 v157, 0
v_mov_b32 v158, 0
v_mov_b32 v159, 0
v_mov_b32 v160, 0
v_mov_b32 v161, 0
v_mov_b32 v162, 0
v_mov_b32 v163, 0
v_mov_b32 v164, 0
v_mov_b32 v165, 0
v_mov_b32 v166, 0
v_mov_b32 v167, 0
v_mov_b32 v168, 0
v_mov_b32 v169, 0
v_mov_b32 v170, 0
v_mov_b32 v171, 0
v_mov_b32 v172, 0
v_mov_b32 v173, 0
v_mov_b32 v174, 0
v_mov_b32 v175, 0
v_mov_b32 v176, 0
v_mov_b32 v177, 0
v_mov_b32 v178, 0
v_mov_b32 v179, 0
v_mov_b32 v180, 0
v_mov_b32 v181, 0
v_mov_b32 v182, 0
v_mov_b32 v183, 0
v_mov_b32 v184, 0
v_mov_b32 v185, 0
v_mov_b32 v186, 0
v_mov_b32 v187, 0
v_mov_b32 v188, 0
v_mov_b32 v189, 0
v_mov_b32 v190, 0
v_mov_b32 v191, 0
v_mov_b32 v192, 0
v_mov_b32 v193, 0
v_mov_b32 v194, 0
v_mov_b32 v195, 0
v_mov_b32 v196, 0
v_mov_b32 v197, 0
v_mov_b32 v198, 0
v_mov_b32 v199, 0
v_mov_b32 v200, 0
v_mov_b32 v201, 0
v_mov_b32 v202, 0
v_mov_b32 v203, 0
v_mov_b32 v204, 0
v_mov_b32 v205, 0
v_mov_b32 v206, 0
v_mov_b32 v207, 0
v_mov_b32 v208, 0
v_mov_b32 v209, 0
v_mov_b32 v210, 0
v_mov_b32 v211, 0
v_mov_b32 v212, 0
v_mov_b32 v213, 0
v_mov_b32 v214, 0
v_mov_b32 v215, 0
v_mov_b32 v216, 0
v_mov_b32 v217, 0
v_mov_b32 v218, 0
v_mov_b32 v219, 0
v_mov_b32 v220, 0
v_mov_b32 v221, 0
v_mov_b32 v222, 0
v_mov_b32 v223, 0
v_mov_b32 v224, 0
v_mov_b32 v225, 0
v_mov_b32 v226, 0
v_mov_b32 v227, 0
v_mov_b32 v228, 0
v_mov_b32 v229, 0
v_mov_b32 v230, 0
v_mov_b32 v231, 0
v_mov_b32 v232, 0
v_mov_b32 v233, 0
v_mov_b32 v234, 0
v_mov_b32 v235, 0
v_mov_b32 v236, 0
v_mov_b32 v237, 0
v_mov_b32 v238, 0
v_mov_b32 v239, 0
v_mov_b32 v240, 0
v_mov_b32 v241, 0
v_mov_b32 v242, 0
v_mov_b32 v243, 0
v_mov_b32 v244, 0
v_mov_b32 v245, 0
v_mov_b32 v246, 0
v_mov_b32 v247, 0
v_mov_b32 v248, 0
v_mov_b32 v249, 0
v_mov_b32 v250, 0
v_mov_b32 v251, 0
v_mov_b32 v252, 0
v_mov_b32 v253, 0
v_mov_b32 v254, 0
v_mov_b32 v255, 0
s_waitcnt vmcnt(16)
s_barrier
ds_read_b128 a[0:3], v1 offset:8192
ds_read_b128 a[4:7], v1 offset:9216
ds_read_b128 a[8:11], v1 offset:10240
ds_read_b128 a[12:15], v1 offset:11264
ds_read_b128 a[16:19], v1 offset:12288
ds_read_b128 a[20:23], v1 offset:13312
ds_read_b128 a[24:27], v1 offset:14336
ds_read_b128 a[28:31], v1 offset:15360
s_waitcnt lgkmcnt(0)
s_branch L_att_start
.section .rodata,"a"
.p2align 6
.amdhsa_kernel gated_mix__compressed_kv_cla__sliding_local_dilated__prompt_kernel
  .amdhsa_next_free_vgpr 512
  .amdhsa_next_free_sgpr 102
  .amdhsa_accum_offset 256
  .amdhsa_group_segment_fixed_size 0
  .amdhsa_kernarg_size 104
  .amdhsa_user_sgpr_count 2
  .amdhsa_user_sgpr_kernarg_segment_ptr 1
  .amdhsa_system_sgpr_workgroup_id_x 1
.end_amdhsa_kernel
```

```asm
; @launch grid=(256,1,1) block=(256,1,1) lds=163840
.amdgcn_target "amdgcn-amd-amdhsa--gfx950"
.text
.globl gated_mix__compressed_kv_cla__sliding_local_dilated__prompt_kernel
.p2align 8
.type gated_mix__compressed_kv_cla__sliding_local_dilated__prompt_kernel,@function
gated_mix__compressed_kv_cla__sliding_local_dilated__prompt_kernel:
s_load_dwordx16 s[16:31], s[0:1], 0
s_load_dwordx8 s[32:39], s[0:1], 64
s_load_dwordx2 s[88:89], s[0:1], 96
s_cmp_ge_u32 s2, 256
s_cbranch_scc1 L_end
v_lshrrev_b32 v1, 6, v0
v_and_b32 v0, 63, v0
v_readfirstlane_b32 s4, v1
v_lshlrev_b32 v16, 4, v0
s_lshr_b32 s8, s2, 3
s_lshl_b32 s8, s8, 2
s_add_u32 s8, s8, s4
s_min_u32 s8, s8, (L_end-L_page0)>>10
s_lshl_b32 s8, s8, 10
s_getpc_b64 s[92:93]
L_here:
s_add_u32 s8, s8, L_page0-L_here
s_add_u32 s92, s92, s8
s_addc_u32 s93, s93, 0
v_add_u32 v60, s92, v16
v_mov_b32 v61, s93
global_load_dword a120, v[60:61], off sc1
s_and_b32 s5, s2, 7
s_xor_b32 s5, s5, 1
s_lshl_b32 s5, s5, 2
s_bfe_u32 s3, s2, 0x20003
s_add_u32 s5, s5, s3
s_lshr_b32 s6, s2, 5
s_mov_b32 s12, 0x4000
s_mov_b32 s13, 0x8000
s_mov_b32 s14, 0xc000
s_mov_b32 s46, 0x400000
s_mov_b32 s47, 0x20000
s_mov_b32 s50, 0x200000
s_mov_b32 s51, 0x20000
s_mov_b32 s54, 0x800000
s_mov_b32 s55, 0x20000
s_mov_b32 s58, 0x400000
s_mov_b32 s59, 0x20000
s_mov_b32 s62, 0x400000
s_mov_b32 s63, 0x20000
s_mov_b32 s66, 0x800000
s_mov_b32 s67, 0x20000
s_mov_b32 s70, 0x600000
s_mov_b32 s71, 0x20000
s_mov_b32 s74, 0x200000
s_mov_b32 s75, 0x20000
s_mov_b32 s78, 0x800
s_mov_b32 s79, 0x20000
s_mov_b32 s82, 0x400000
s_mov_b32 s83, 0x20000
s_mov_b32 s86, 0x100
s_mov_b32 s87, 0x20000
s_mov_b32 s90, 0x10000000
s_mov_b32 s91, 0x20000
v_bfe_u32 v17, v0, 2, 2
s_lshl_b32 s8, s4, 4
v_add_u32 v17, s8, v17
v_lshlrev_b32 v17, 13, v17
v_lshrrev_b32 v18, 4, v0
v_lshl_add_u32 v17, v18, 6, v17
v_and_b32 v18, 3, v0
v_lshl_add_u32 v17, v18, 4, v17
s_lshl_b32 s8, s5, 8
v_add_u32 v5, s8, v17
v_xor_b32 v6, 32, v5
v_add_u32 v6, 0x10000, v6
v_lshrrev_b32 v17, 4, v0
v_xor_b32 v17, v17, v0
v_and_b32 v17, 7, v17
v_lshlrev_b32 v17, 4, v17
v_lshrrev_b32 v18, 3, v0
v_lshl_add_u32 v2, v18, 10, v17
s_lshl_b32 s8, s6, 18
s_lshl_b32 s9, s4, 16
s_add_u32 s8, s8, s9
v_add_u32 v2, s8, v2
v_xor_b32 v3, 64, v2
v_add_u32 v3, 0x2000, v3
s_mov_b32 s41, 0
s_mov_b32 s43, 0
v_lshl_add_u32 v5, s41, 19, v5
v_lshl_add_u32 v6, s41, 19, v6
v_lshl_add_u32 v2, s41, 7, v2
v_lshl_add_u32 v3, s41, 7, v3
s_sub_u32 s10, 15, s6
s_cmp_lt_u32 s5, 16
s_cselect_b32 s10, s6, s10
s_lshl_b32 s10, s10, 4
s_and_b32 s11, s5, 15
s_add_u32 s10, s10, s11
s_lshl_b32 s10, s10, 3
s_lshl_b32 s11, s4, 1
s_add_u32 s10, s10, s11
s_lshl_b32 s100, s10, 11
s_lshl_b32 s101, s10, 2
s_add_u32 s101, s101, 0x3700000
s_lshl_b32 s8, s2, 2
s_add_u32 s8, s8, s4
s_lshl_b32 s8, s8, 11
v_lshrrev_b32 v19, 2, v0
v_lshl_add_u32 v19, v19, 7, s8
s_lshr_b32 s8, s2, 3
s_lshl_b32 s8, s8, 2
s_add_u32 s8, s8, s4
s_lshl_b32 s8, s8, 4
s_lshr_b32 s9, s5, 2
s_add_u32 s8, s8, s9
s_lshl_b32 s8, s8, 10
v_bfe_u32 v63, v0, 2, 3
v_lshl_add_u32 v63, v63, 7, s8
v_lshrrev_b32 v59, 5, v0
v_lshl_add_u32 v63, v59, 13, v63
s_lshr_b32 s8, s8, 14
s_mul_i32 s8, s8, 49152
s_lshl_b32 s9, s9, 8
s_add_u32 s8, s8, s9
v_lshrrev_b32 v59, 3, v0
v_mul_u32_u24 v59, 0x1800, v59
v_and_b32 v1, 4, v0
v_lshl_add_u32 v1, v1, 5, v59
v_add_u32 v1, s8, v1
v_mov_b32 v62, v19
s_waitcnt lgkmcnt(0)
s_mov_b64 s[48:49], s[18:19]
s_mov_b64 s[56:57], s[22:23]
s_mov_b64 s[60:61], s[24:25]
L_args:
s_mov_b64 s[0:1], s[92:93]
s_mov_b64 s[44:45], s[16:17]
s_mov_b64 s[76:77], s[34:35]
s_mov_b64 s[52:53], s[20:21]
s_mov_b64 s[64:65], s[26:27]
s_mov_b64 s[68:69], s[30:31]
s_mov_b64 s[72:73], s[32:33]
s_mov_b64 s[80:81], s[36:37]
s_mov_b64 s[84:85], s[38:39]
s_lshl_b32 s16, s4, 13
s_add_u32 s16, s16, 0x18000
s_lshl_b32 s17, s4, 12
s_lshl_b32 s18, s4, 10
s_mov_b32 s25, 0x800
s_mov_b32 s26, 0x1000
s_mov_b32 s3, 0
s_mov_b32 s9, 0x0
s_nop 0
buffer_load_dword a120, v63, s[56:59], s9 offen
s_mov_b32 s9, 0x0
s_nop 0
buffer_load_dword a120, v63, s[60:63], s9 offen
s_add_u32 m0, s17, 0x0
s_nop 0
buffer_load_dwordx4 v5, s[56:59], 0 offen lds
s_add_u32 m0, s17, 0x4000
s_nop 0
buffer_load_dwordx4 v5, s[60:63], 0 offen lds
s_add_u32 m0, s17, 0x400
s_nop 0
buffer_load_dwordx4 v5, s[56:59], s13 offen lds
s_add_u32 m0, s17, 0x4400
s_nop 0
buffer_load_dwordx4 v5, s[60:63], s13 offen lds
s_add_u32 m0, s17, 0x800
s_nop 0
buffer_load_dwordx4 v6, s[56:59], 0 offen lds
s_add_u32 m0, s17, 0x4800
s_nop 0
buffer_load_dwordx4 v6, s[60:63], 0 offen lds
s_add_u32 m0, s17, 0xc00
s_nop 0
buffer_load_dwordx4 v6, s[56:59], s13 offen lds
s_add_u32 m0, s17, 0x4c00
s_nop 0
buffer_load_dwordx4 v6, s[60:63], s13 offen lds
s_mov_b32 s42, 1
s_mov_b32 s41, 7
v_lshl_add_u32 v5, s42, 19, v5
v_lshl_add_u32 v6, s42, 19, v6
s_add_u32 m0, s16, 0x0
s_nop 0
buffer_load_dwordx4 v2, s[48:51], 0 offen lds
s_add_u32 m0, s16, 0x400
s_nop 0
buffer_load_dwordx4 v3, s[48:51], 0 offen lds
s_add_u32 m0, s16, 0x800
s_nop 0
buffer_load_dwordx4 v2, s[48:51], s12 offen lds
s_add_u32 m0, s16, 0xc00
s_nop 0
buffer_load_dwordx4 v3, s[48:51], s12 offen lds
s_add_u32 m0, s16, 0x1000
s_nop 0
buffer_load_dwordx4 v2, s[48:51], s13 offen lds
s_add_u32 m0, s16, 0x1400
s_nop 0
buffer_load_dwordx4 v3, s[48:51], s13 offen lds
s_add_u32 m0, s16, 0x1800
s_nop 0
buffer_load_dwordx4 v2, s[48:51], s14 offen lds
s_add_u32 m0, s16, 0x1c00
s_nop 0
buffer_load_dwordx4 v3, s[48:51], s14 offen lds
v_lshl_add_u32 v2, s42, 7, v2
v_lshl_add_u32 v3, s42, 7, v3
v_lshrrev_b32 v17, 4, v0
v_xor_b32 v17, v17, v0
v_and_b32 v17, 7, v17
v_lshlrev_b32 v17, 4, v17
v_lshrrev_b32 v18, 3, v0
v_lshl_add_u32 v22, v18, 11, v17
v_xor_b32 v23, 64, v22
v_add_u32 v23, 0x4000, v23
s_lshl_b32 s8, s6, 18
s_sub_u32 s9, 15, s6
s_lshl_b32 s9, s9, 18
s_lshl_b32 s10, s4, 15
s_sub_u32 s11, 0x38000, s10
s_add_u32 s20, s8, s10
s_add_u32 s21, s8, s11
s_add_u32 s22, s9, s10
s_add_u32 s23, s9, s11
s_lshl_b32 s10, s5, 15
s_add_u32 s10, s10, 0x3c00000
s_lshr_b32 s8, s8, 7
s_lshr_b32 s9, s9, 7
s_add_u32 s8, s8, s10
s_add_u32 s9, s9, s10
v_add_u32 v10, s8, v16
v_add_u32 v11, s9, v16
s_cmp_lt_u32 s4, 2
s_cselect_b32 s8, s8, s9
s_and_b32 s9, s4, 1
s_lshl_b32 s9, s9, 10
s_add_u32 s8, s8, s9
v_add_u32 v4, s8, v16
v_lshrrev_b32 v17, 2, v0
s_lshl_b32 s8, s4, 4
v_add_u32 v17, s8, v17
v_mul_u32_u24 v17, 0x1800, v17
v_and_b32 v18, 3, v0
v_lshlrev_b32 v18, 4, v18
v_and_b32 v19, 32, v0
v_xor_b32 v18, v18, v19
s_lshl_b32 s8, s5, 6
v_add3_u32 v7, v17, v18, s8
v_lshl_add_u32 v22, s43, 7, v22
v_lshl_add_u32 v23, s43, 7, v23
v_lshl_add_u32 v7, s43, 18, v7
v_lshl_add_u32 v7, s43, 17, v7
v_and_b32 v17, 15, v0
v_lshrrev_b32 v18, 1, v17
v_lshrrev_b32 v19, 4, v0
v_xor_b32 v18, v18, v19
v_lshlrev_b32 v18, 4, v18
v_lshl_add_u32 v8, v17, 7, v18
v_add_u32 v8, s16, v8
v_xor_b32 v9, 64, v8
v_lshrrev_b32 v17, 4, v0
v_lshlrev_b32 v18, 11, v17
v_and_b32 v17, 1, v17
v_lshl_add_u32 v18, v17, 5, v18
v_bfe_u32 v17, v0, 2, 2
v_lshl_add_u32 v18, v17, 6, v18
v_and_b32 v17, 3, v0
v_lshl_add_u32 v12, v17, 3, v18
v_xor_b32 v13, 32, v12
v_lshrrev_b32 v17, 4, v0
v_lshlrev_b32 v18, 9, v17
v_and_b32 v17, 1, v17
v_lshl_add_u32 v18, v17, 5, v18
v_bfe_u32 v17, v0, 2, 2
v_lshl_add_u32 v18, v17, 6, v18
v_and_b32 v17, 3, v0
v_lshl_add_u32 v14, v17, 3, v18
v_accvgpr_write_b32 a64, -1
v_accvgpr_write_b32 a65, -1
v_accvgpr_write_b32 a66, -1
v_accvgpr_write_b32 a67, -1
v_add_u32 v14, 81920, v14
v_xor_b32 v15, 32, v14
s_mul_i32 s32, s5, 0x10c400
s_lshl_b32 s19, s4, 13
s_add_u32 s32, s32, s19
s_cmp_eq_u32 s4, 0
s_cselect_b32 s94, 0x200000, 0
s_add_u32 s32, s32, s94
s_sub_u32 s94, 0x8000, s94
s_add_u32 s7, s32, 0x1000
s_add_u32 s27, s19, 131072
s_add_u32 m0, s16, 0x8000
s_nop 0
buffer_load_dwordx4 v2, s[48:51], 0 offen lds
s_add_u32 m0, s16, 0x8400
s_nop 0
buffer_load_dwordx4 v3, s[48:51], 0 offen lds
s_add_u32 m0, s16, 0x8800
s_nop 0
buffer_load_dwordx4 v2, s[48:51], s12 offen lds
s_add_u32 m0, s16, 0x8c00
s_nop 0
buffer_load_dwordx4 v3, s[48:51], s12 offen lds
s_add_u32 m0, s16, 0x9000
s_nop 0
buffer_load_dwordx4 v2, s[48:51], s13 offen lds
s_add_u32 m0, s16, 0x9400
s_nop 0
buffer_load_dwordx4 v3, s[48:51], s13 offen lds
s_add_u32 m0, s16, 0x9800
s_nop 0
buffer_load_dwordx4 v2, s[48:51], s14 offen lds
s_add_u32 m0, s16, 0x9c00
s_nop 0
buffer_load_dwordx4 v3, s[48:51], s14 offen lds
v_lshl_add_u32 v2, s42, 7, v2
v_lshl_add_u32 v3, s42, 7, v3
s_mov_b32 s9, 0x0
s_nop 0
buffer_load_dword a120, v62, s[48:51], s9 offen
L_hopA:
s_mov_b32 s95, 1
s_cmp_eq_u32 s4, 0
s_cbranch_scc1 L_padA0
s_cmp_eq_u32 s4, 1
s_cbranch_scc1 L_padA1
s_cmp_eq_u32 s4, 2
s_cbranch_scc1 L_padA2
s_branch L_padA3
L_hopA_ret:
s_mov_b32 s95, 0
v_mov_b32 v19, v62
v_mov_b32 v18, v63
s_cmp_lg_u32 s4, 0
s_cbranch_scc1 L_flag_clr
s_lshl_b32 s8, s6, 5
s_add_u32 s8, s8, s5
s_and_b32 s92, s8, 0xf8
s_mul_i32 s92, s92, 7
s_add_u32 s8, s8, s92
s_lshl_b32 s8, s8, 2
s_add_u32 s8, s8, 0x3704000
v_mov_b32 v17, 0
s_mov_b64 exec, 1
buffer_store_dword v17, off, s[88:91], s8 sc1
s_mov_b64 exec, -1
L_flag_clr:
s_waitcnt vmcnt(9)
s_barrier
s_branch L_main
.p2align 12
L_page0:
L_padA0:
s_branch L_padA4
L_main:
ds_read_b64_tr_b16 a[80:81], v12 offset:0
ds_read_b64_tr_b16 a[82:83], v12 offset:1024
ds_read_b64_tr_b16 a[84:85], v12 offset:8192
ds_read_b64_tr_b16 a[86:87], v12 offset:9216
ds_read_b128 a[0:3], v8 offset:0
ds_read_b128 a[16:19], v9 offset:0
ds_read_b128 a[4:7], v8 offset:2048
ds_read_b128 a[20:23], v9 offset:2048
ds_read_b128 a[8:11], v8 offset:4096
ds_read_b128 a[24:27], v9 offset:4096
ds_read_b128 a[12:15], v8 offset:6144
ds_read_b128 a[28:31], v9 offset:6144
ds_read_b64_tr_b16 a[88:89], v13 offset:0
ds_read_b64_tr_b16 a[90:91], v13 offset:1024
ds_read_b64_tr_b16 a[92:93], v13 offset:8192
ds_read_b64_tr_b16 a[94:95], v13 offset:9216
ds_read_b64_tr_b16 a[96:97], v12 offset:256
ds_read_b64_tr_b16 a[98:99], v12 offset:1280
ds_read_b64_tr_b16 a[100:101], v12 offset:8448
ds_read_b64_tr_b16 a[102:103], v12 offset:9472
s_waitcnt lgkmcnt(0)
L_S0:
v_mfma_f32_16x16x32_bf16 v[24:27], a[80:83], a[0:3], 0
ds_read_b64_tr_b16 a[104:105], v13 offset:256
s_add_u32 m0, s17, 0x8000
v_mfma_f32_16x16x32_bf16 v[24:27], a[84:87], a[16:19], v[24:27]
buffer_load_dwordx4 v5, s[56:59], 0 offen lds
v_mfma_f32_16x16x32_bf16 v[32:35], a[84:87], a[20:23], 0
ds_read_b64_tr_b16 a[106:107], v13 offset:1280
v_mfma_f32_16x16x32_bf16 v[32:35], a[80:83], a[4:7], v[32:35]
ds_read_b64_tr_b16 a[108:109], v13 offset:8448
v_mfma_f32_16x16x32_bf16 v[40:43], a[80:83], a[8:11], 0
ds_read_b64_tr_b16 a[110:111], v13 offset:9472
v_mfma_f32_16x16x32_bf16 v[40:43], a[84:87], a[24:27], v[40:43]
s_add_u32 m0, s17, 0xc000
v_mfma_f32_16x16x32_bf16 v[48:51], a[84:87], a[28:31], 0
buffer_load_dwordx4 v5, s[60:63], 0 offen lds
v_mfma_f32_16x16x32_bf16 v[48:51], a[80:83], a[12:15], v[48:51]
v_mfma_f32_16x16x32_bf16 v[52:55], a[88:91], a[12:15], 0
ds_read_b64_tr_b16 a[80:81], v12 offset:512
v_mfma_f32_16x16x32_bf16 v[52:55], a[92:95], a[28:31], v[52:55]
ds_read_b64_tr_b16 a[82:83], v12 offset:1536
v_mfma_f32_16x16x32_bf16 v[44:47], a[92:95], a[24:27], 0
ds_read_b64_tr_b16 a[84:85], v12 offset:8704
s_add_u32 m0, s17, 0x8400
v_mfma_f32_16x16x32_bf16 v[44:47], a[88:91], a[8:11], v[44:47]
buffer_load_dwordx4 v5, s[56:59], s13 offen lds
v_mfma_f32_16x16x32_bf16 v[36:39], a[88:91], a[4:7], 0
ds_read_b64_tr_b16 a[86:87], v12 offset:9728
v_mfma_f32_16x16x32_bf16 v[36:39], a[92:95], a[20:23], v[36:39]
v_mfma_f32_16x16x32_bf16 v[28:31], a[92:95], a[16:19], 0
v_mfma_f32_16x16x32_bf16 v[28:31], a[88:91], a[0:3], v[28:31]
s_add_u32 m0, s17, 0xc400
v_mfma_f32_16x16x32_bf16 v[56:59], a[96:99], a[0:3], 0
buffer_load_dwordx4 v5, s[60:63], s13 offen lds
v_mfma_f32_16x16x32_bf16 v[56:59], a[100:103], a[16:19], v[56:59]
ds_read_b64_tr_b16 a[88:89], v13 offset:512
v_mfma_f32_16x16x32_bf16 v[64:67], a[100:103], a[20:23], 0
ds_read_b64_tr_b16 a[90:91], v13 offset:1536
v_mfma_f32_16x16x32_bf16 v[64:67], a[96:99], a[4:7], v[64:67]
ds_read_b64_tr_b16 a[92:93], v13 offset:8704
v_mfma_f32_16x16x32_bf16 v[72:75], a[96:99], a[8:11], 0
ds_read_b64_tr_b16 a[94:95], v13 offset:9728
s_add_u32 m0, s17, 0x8800
v_mfma_f32_16x16x32_bf16 v[72:75], a[100:103], a[24:27], v[72:75]
buffer_load_dwordx4 v6, s[56:59], 0 offen lds
v_mfma_f32_16x16x32_bf16 v[80:83], a[100:103], a[28:31], 0
v_mfma_f32_16x16x32_bf16 v[80:83], a[96:99], a[12:15], v[80:83]
s_waitcnt lgkmcnt(10)
v_mfma_f32_16x16x32_bf16 v[84:87], a[104:107], a[12:15], 0
ds_read_b64_tr_b16 a[96:97], v12 offset:768
s_waitcnt lgkmcnt(9)
v_mfma_f32_16x16x32_bf16 v[84:87], a[108:111], a[28:31], v[84:87]
ds_read_b64_tr_b16 a[98:99], v12 offset:1792
s_add_u32 m0, s17, 0xc800
v_mfma_f32_16x16x32_bf16 v[76:79], a[108:111], a[24:27], 0
buffer_load_dwordx4 v6, s[60:63], 0 offen lds
v_mfma_f32_16x16x32_bf16 v[76:79], a[104:107], a[8:11], v[76:79]
ds_read_b64_tr_b16 a[100:101], v12 offset:8960
v_mfma_f32_16x16x32_bf16 v[68:71], a[104:107], a[4:7], 0
ds_read_b64_tr_b16 a[102:103], v12 offset:9984
v_mfma_f32_16x16x32_bf16 v[68:71], a[108:111], a[20:23], v[68:71]
v_mfma_f32_16x16x32_bf16 v[60:63], a[108:111], a[16:19], 0
s_add_u32 m0, s17, 0x8c00
s_waitcnt lgkmcnt(4)
v_mfma_f32_16x16x32_bf16 v[60:63], a[104:107], a[0:3], v[60:63]
buffer_load_dwordx4 v6, s[56:59], s13 offen lds
v_mfma_f32_16x16x32_bf16 v[88:91], a[80:83], a[0:3], 0
ds_read_b64_tr_b16 a[104:105], v13 offset:768
v_mfma_f32_16x16x32_bf16 v[88:91], a[84:87], a[16:19], v[88:91]
ds_read_b64_tr_b16 a[106:107], v13 offset:1792
v_mfma_f32_16x16x32_bf16 v[96:99], a[84:87], a[20:23], 0
ds_read_b64_tr_b16 a[108:109], v13 offset:8960
v_mfma_f32_16x16x32_bf16 v[96:99], a[80:83], a[4:7], v[96:99]
ds_read_b64_tr_b16 a[110:111], v13 offset:9984
s_add_u32 m0, s17, 0xcc00
v_mfma_f32_16x16x32_bf16 v[104:107], a[80:83], a[8:11], 0
buffer_load_dwordx4 v6, s[60:63], s13 offen lds
v_mfma_f32_16x16x32_bf16 v[104:107], a[84:87], a[24:27], v[104:107]
v_lshl_add_u32 v5, s42, 19, v5
v_lshl_add_u32 v6, s42, 19, v6
v_mfma_f32_16x16x32_bf16 v[112:115], a[84:87], a[28:31], 0
v_mfma_f32_16x16x32_bf16 v[112:115], a[80:83], a[12:15], v[112:115]
v_mfma_f32_16x16x32_bf16 v[116:119], a[88:91], a[12:15], 0
ds_read_b64_tr_b16 a[80:81], v12 offset:16384
s_add_u32 m0, s16, 0x0
v_mfma_f32_16x16x32_bf16 v[116:119], a[92:95], a[28:31], v[116:119]
buffer_load_dwordx4 v2, s[48:51], 0 offen lds
v_mfma_f32_16x16x32_bf16 v[108:111], a[92:95], a[24:27], 0
ds_read_b64_tr_b16 a[82:83], v12 offset:17408
v_mfma_f32_16x16x32_bf16 v[108:111], a[88:91], a[8:11], v[108:111]
ds_read_b64_tr_b16 a[84:85], v12 offset:24576
v_mfma_f32_16x16x32_bf16 v[100:103], a[88:91], a[4:7], 0
ds_read_b64_tr_b16 a[86:87], v12 offset:25600
v_mfma_f32_16x16x32_bf16 v[100:103], a[92:95], a[20:23], v[100:103]
s_add_u32 m0, s16, 0x400
v_mfma_f32_16x16x32_bf16 v[92:95], a[92:95], a[16:19], 0
buffer_load_dwordx4 v3, s[48:51], 0 offen lds
v_mfma_f32_16x16x32_bf16 v[92:95], a[88:91], a[0:3], v[92:95]
s_waitcnt lgkmcnt(4)
v_mfma_f32_16x16x32_bf16 v[120:123], a[96:99], a[0:3], 0
ds_read_b64_tr_b16 a[88:89], v13 offset:16384
s_waitcnt vmcnt(11)
v_mfma_f32_16x16x32_bf16 v[120:123], a[100:103], a[16:19], v[120:123]
ds_read_b64_tr_b16 a[90:91], v13 offset:17408
v_mfma_f32_16x16x32_bf16 v[128:131], a[100:103], a[20:23], 0
ds_read_b64_tr_b16 a[92:93], v13 offset:24576
s_add_u32 m0, s16, 0x800
v_mfma_f32_16x16x32_bf16 v[128:131], a[96:99], a[4:7], v[128:131]
buffer_load_dwordx4 v2, s[48:51], s12 offen lds
v_mfma_f32_16x16x32_bf16 v[136:139], a[96:99], a[8:11], 0
ds_read_b64_tr_b16 a[94:95], v13 offset:25600
v_mfma_f32_16x16x32_bf16 v[136:139], a[100:103], a[24:27], v[136:139]
ds_read_b128 a[32:35], v8 offset:32768
v_mfma_f32_16x16x32_bf16 v[144:147], a[100:103], a[28:31], 0
ds_read_b128 a[48:51], v9 offset:32768
v_mfma_f32_16x16x32_bf16 v[144:147], a[96:99], a[12:15], v[144:147]
ds_read_b128 a[36:39], v8 offset:34816
s_add_u32 m0, s16, 0xc00
v_mfma_f32_16x16x32_bf16 v[148:151], a[104:107], a[12:15], 0
buffer_load_dwordx4 v3, s[48:51], s12 offen lds
v_mfma_f32_16x16x32_bf16 v[148:151], a[108:111], a[28:31], v[148:151]
ds_read_b64_tr_b16 a[96:97], v12 offset:16640
v_mfma_f32_16x16x32_bf16 v[140:143], a[108:111], a[24:27], 0
ds_read_b64_tr_b16 a[98:99], v12 offset:17664
v_mfma_f32_16x16x32_bf16 v[140:143], a[104:107], a[8:11], v[140:143]
ds_read_b64_tr_b16 a[100:101], v12 offset:24832
v_mfma_f32_16x16x32_bf16 v[132:135], a[104:107], a[4:7], 0
ds_read_b64_tr_b16 a[102:103], v12 offset:25856
s_add_u32 m0, s16, 0x1000
v_mfma_f32_16x16x32_bf16 v[132:135], a[108:111], a[20:23], v[132:135]
buffer_load_dwordx4 v2, s[48:51], s13 offen lds
v_mfma_f32_16x16x32_bf16 v[124:127], a[108:111], a[16:19], 0
ds_read_b128 a[52:55], v9 offset:34816
v_mfma_f32_16x16x32_bf16 v[124:127], a[104:107], a[0:3], v[124:127]
ds_read_b128 a[40:43], v8 offset:36864
s_waitcnt lgkmcnt(9)
v_mfma_f32_16x16x32_bf16 v[152:155], a[0:3], a[80:83], 0
ds_read_b64_tr_b16 a[104:105], v13 offset:16640
v_mfma_f32_16x16x32_bf16 v[152:155], a[16:19], a[84:87], v[152:155]
ds_read_b64_tr_b16 a[106:107], v13 offset:17664
s_add_u32 m0, s16, 0x1400
v_mfma_f32_16x16x32_bf16 v[156:159], a[20:23], a[84:87], 0
buffer_load_dwordx4 v3, s[48:51], s13 offen lds
v_mfma_f32_16x16x32_bf16 v[156:159], a[4:7], a[80:83], v[156:159]
ds_read_b64_tr_b16 a[108:109], v13 offset:24832
v_mfma_f32_16x16x32_bf16 v[160:163], a[8:11], a[80:83], 0
ds_read_b64_tr_b16 a[110:111], v13 offset:25856
v_mfma_f32_16x16x32_bf16 v[160:163], a[24:27], a[84:87], v[160:163]
ds_read_b128 a[56:59], v9 offset:36864
v_mfma_f32_16x16x32_bf16 v[164:167], a[28:31], a[84:87], 0
ds_read_b128 a[44:47], v8 offset:38912
s_add_u32 m0, s16, 0x1800
v_mfma_f32_16x16x32_bf16 v[164:167], a[12:15], a[80:83], v[164:167]
buffer_load_dwordx4 v2, s[48:51], s14 offen lds
v_mfma_f32_16x16x32_bf16 v[180:183], a[12:15], a[88:91], 0
ds_read_b64_tr_b16 a[80:81], v12 offset:16896
v_mfma_f32_16x16x32_bf16 v[180:183], a[28:31], a[92:95], v[180:183]
ds_read_b64_tr_b16 a[82:83], v12 offset:17920
v_mfma_f32_16x16x32_bf16 v[176:179], a[24:27], a[92:95], 0
ds_read_b64_tr_b16 a[84:85], v12 offset:25088
v_mfma_f32_16x16x32_bf16 v[176:179], a[8:11], a[88:91], v[176:179]
ds_read_b64_tr_b16 a[86:87], v12 offset:26112
s_add_u32 m0, s16, 0x1c00
v_mfma_f32_16x16x32_bf16 v[172:175], a[4:7], a[88:91], 0
buffer_load_dwordx4 v3, s[48:51], s14 offen lds
v_mfma_f32_16x16x32_bf16 v[172:175], a[20:23], a[92:95], v[172:175]
ds_read_b128 a[60:63], v9 offset:38912
v_lshl_add_u32 v2, s42, 7, v2
v_mfma_f32_16x16x32_bf16 v[168:171], a[16:19], a[92:95], 0
v_lshl_add_u32 v3, s42, 7, v3
v_mfma_f32_16x16x32_bf16 v[168:171], a[0:3], a[88:91], v[168:171]
s_waitcnt lgkmcnt(7)
v_mfma_f32_16x16x32_bf16 v[184:187], a[0:3], a[96:99], 0
ds_read_b64_tr_b16 a[88:89], v13 offset:16896
s_add_u32 m0, s17, 0x10000
v_mfma_f32_16x16x32_bf16 v[184:187], a[16:19], a[100:103], v[184:187]
buffer_load_dwordx4 v5, s[56:59], 0 offen lds
v_mfma_f32_16x16x32_bf16 v[188:191], a[20:23], a[100:103], 0
ds_read_b64_tr_b16 a[90:91], v13 offset:17920
v_mfma_f32_16x16x32_bf16 v[188:191], a[4:7], a[96:99], v[188:191]
ds_read_b64_tr_b16 a[92:93], v13 offset:25088
v_mfma_f32_16x16x32_bf16 v[192:195], a[8:11], a[96:99], 0
ds_read_b64_tr_b16 a[94:95], v13 offset:26112
v_mfma_f32_16x16x32_bf16 v[192:195], a[24:27], a[100:103], v[192:195]
s_add_u32 m0, s17, 0x14000
v_mfma_f32_16x16x32_bf16 v[196:199], a[28:31], a[100:103], 0
buffer_load_dwordx4 v5, s[60:63], 0 offen lds
v_mfma_f32_16x16x32_bf16 v[196:199], a[12:15], a[96:99], v[196:199]
v_mfma_f32_16x16x32_bf16 v[212:215], a[12:15], a[104:107], 0
ds_read_b64_tr_b16 a[96:97], v12 offset:17152
v_mfma_f32_16x16x32_bf16 v[212:215], a[28:31], a[108:111], v[212:215]
ds_read_b64_tr_b16 a[98:99], v12 offset:18176
v_mfma_f32_16x16x32_bf16 v[208:211], a[24:27], a[108:111], 0
ds_read_b64_tr_b16 a[100:101], v12 offset:25344
s_add_u32 m0, s17, 0x10400
v_mfma_f32_16x16x32_bf16 v[208:211], a[8:11], a[104:107], v[208:211]
buffer_load_dwordx4 v5, s[56:59], s13 offen lds
v_mfma_f32_16x16x32_bf16 v[204:207], a[4:7], a[104:107], 0
ds_read_b64_tr_b16 a[102:103], v12 offset:26368
v_mfma_f32_16x16x32_bf16 v[204:207], a[20:23], a[108:111], v[204:207]
v_mfma_f32_16x16x32_bf16 v[200:203], a[16:19], a[108:111], 0
v_mfma_f32_16x16x32_bf16 v[200:203], a[0:3], a[104:107], v[200:203]
s_add_u32 m0, s17, 0x14400
s_waitcnt lgkmcnt(4)
v_mfma_f32_16x16x32_bf16 v[216:219], a[0:3], a[80:83], 0
buffer_load_dwordx4 v5, s[60:63], s13 offen lds
v_mfma_f32_16x16x32_bf16 v[216:219], a[16:19], a[84:87], v[216:219]
ds_read_b64_tr_b16 a[104:105], v13 offset:17152
v_mfma_f32_16x16x32_bf16 v[220:223], a[20:23], a[84:87], 0
ds_read_b64_tr_b16 a[106:107], v13 offset:18176
v_mfma_f32_16x16x32_bf16 v[220:223], a[4:7], a[80:83], v[220:223]
ds_read_b64_tr_b16 a[108:109], v13 offset:25344
v_mfma_f32_16x16x32_bf16 v[224:227], a[8:11], a[80:83], 0
ds_read_b64_tr_b16 a[110:111], v13 offset:26368
s_add_u32 m0, s17, 0x10800
v_mfma_f32_16x16x32_bf16 v[224:227], a[24:27], a[84:87], v[224:227]
buffer_load_dwordx4 v6, s[56:59], 0 offen lds
v_mfma_f32_16x16x32_bf16 v[228:231], a[28:31], a[84:87], 0
v_add_u32 v12, 0x8000, v12
v_add_u32 v13, 0x8000, v13
v_mfma_f32_16x16x32_bf16 v[228:231], a[12:15], a[80:83], v[228:231]
v_mfma_f32_16x16x32_bf16 v[244:247], a[12:15], a[88:91], 0
s_waitcnt vmcnt(13) lgkmcnt(0)
v_mfma_f32_16x16x32_bf16 v[244:247], a[28:31], a[92:95], v[244:247]
s_barrier
s_add_u32 m0, s17, 0x14800
v_mfma_f32_16x16x32_bf16 v[240:243], a[24:27], a[92:95], 0
buffer_load_dwordx4 v6, s[60:63], 0 offen lds
v_mfma_f32_16x16x32_bf16 v[240:243], a[8:11], a[88:91], v[240:243]
ds_read_b64_tr_b16 a[80:81], v12 offset:0
v_mfma_f32_16x16x32_bf16 v[236:239], a[4:7], a[88:91], 0
ds_read_b64_tr_b16 a[82:83], v12 offset:1024
v_mfma_f32_16x16x32_bf16 v[236:239], a[20:23], a[92:95], v[236:239]
ds_read_b64_tr_b16 a[84:85], v12 offset:8192
s_waitcnt lgkmcnt(3)
v_mfma_f32_16x16x32_bf16 v[232:235], a[16:19], a[92:95], 0
ds_read_b64_tr_b16 a[86:87], v12 offset:9216
s_add_u32 m0, s17, 0x10c00
v_mfma_f32_16x16x32_bf16 v[232:235], a[0:3], a[88:91], v[232:235]
buffer_load_dwordx4 v6, s[56:59], s13 offen lds
v_mfma_f32_16x16x32_bf16 v[248:251], a[0:3], a[96:99], 0
ds_read_b64_tr_b16 a[88:89], v13 offset:0
v_mfma_f32_16x16x32_bf16 v[248:251], a[16:19], a[100:103], v[248:251]
ds_read_b64_tr_b16 a[90:91], v13 offset:1024
v_mfma_f32_16x16x32_bf16 v[252:255], a[20:23], a[100:103], 0
ds_read_b64_tr_b16 a[92:93], v13 offset:8192
v_mfma_f32_16x16x32_bf16 v[252:255], a[4:7], a[96:99], v[252:255]
ds_read_b64_tr_b16 a[94:95], v13 offset:9216
s_add_u32 m0, s17, 0x14c00
v_mfma_f32_16x16x32_bf16 a[232:235], a[8:11], a[96:99], 0
buffer_load_dwordx4 v6, s[60:63], s13 offen lds
v_mfma_f32_16x16x32_bf16 a[232:235], a[24:27], a[100:103], a[232:235]
v_lshl_add_u32 v5, s42, 19, v5
v_lshl_add_u32 v6, s42, 19, v6
v_mfma_f32_16x16x32_bf16 a[236:239], a[28:31], a[100:103], 0
v_mfma_f32_16x16x32_bf16 a[236:239], a[12:15], a[96:99], a[236:239]
s_waitcnt lgkmcnt(15)
v_mfma_f32_16x16x32_bf16 a[252:255], a[12:15], a[104:107], 0
ds_read_b64_tr_b16 a[96:97], v12 offset:256
s_add_u32 m0, s16, 0x8000
v_mfma_f32_16x16x32_bf16 a[252:255], a[28:31], a[108:111], a[252:255]
buffer_load_dwordx4 v2, s[48:51], 0 offen lds
v_mfma_f32_16x16x32_bf16 a[248:251], a[24:27], a[108:111], 0
ds_read_b64_tr_b16 a[98:99], v12 offset:1280
v_mfma_f32_16x16x32_bf16 a[248:251], a[8:11], a[104:107], a[248:251]
ds_read_b64_tr_b16 a[100:101], v12 offset:8448
v_mfma_f32_16x16x32_bf16 a[244:247], a[4:7], a[104:107], 0
ds_read_b64_tr_b16 a[102:103], v12 offset:9472
v_mfma_f32_16x16x32_bf16 a[244:247], a[20:23], a[108:111], a[244:247]
s_add_u32 m0, s16, 0x8400
v_mfma_f32_16x16x32_bf16 a[240:243], a[16:19], a[108:111], 0
buffer_load_dwordx4 v3, s[48:51], 0 offen lds
v_mfma_f32_16x16x32_bf16 a[240:243], a[0:3], a[104:107], a[240:243]
s_waitcnt lgkmcnt(4)
L_S1:
v_mfma_f32_16x16x32_bf16 v[24:27], a[80:83], a[32:35], v[24:27]
ds_read_b64_tr_b16 a[104:105], v13 offset:256
v_mfma_f32_16x16x32_bf16 v[24:27], a[84:87], a[48:51], v[24:27]
ds_read_b64_tr_b16 a[106:107], v13 offset:1280
v_mfma_f32_16x16x32_bf16 v[32:35], a[84:87], a[52:55], v[32:35]
ds_read_b64_tr_b16 a[108:109], v13 offset:8448
s_add_u32 m0, s16, 0x8800
v_mfma_f32_16x16x32_bf16 v[32:35], a[80:83], a[36:39], v[32:35]
buffer_load_dwordx4 v2, s[48:51], s12 offen lds
v_mfma_f32_16x16x32_bf16 v[40:43], a[80:83], a[40:43], v[40:43]
ds_read_b64_tr_b16 a[110:111], v13 offset:9472
v_mfma_f32_16x16x32_bf16 v[40:43], a[84:87], a[56:59], v[40:43]
v_mfma_f32_16x16x32_bf16 v[48:51], a[84:87], a[60:63], v[48:51]
v_mfma_f32_16x16x32_bf16 v[48:51], a[80:83], a[44:47], v[48:51]
s_add_u32 m0, s16, 0x8c00
v_mfma_f32_16x16x32_bf16 v[52:55], a[88:91], a[44:47], v[52:55]
buffer_load_dwordx4 v3, s[48:51], s12 offen lds
v_mfma_f32_16x16x32_bf16 v[52:55], a[92:95], a[60:63], v[52:55]
ds_read_b64_tr_b16 a[80:81], v12 offset:512
v_mfma_f32_16x16x32_bf16 v[44:47], a[92:95], a[56:59], v[44:47]
ds_read_b64_tr_b16 a[82:83], v12 offset:1536
v_mfma_f32_16x16x32_bf16 v[44:47], a[88:91], a[40:43], v[44:47]
ds_read_b64_tr_b16 a[84:85], v12 offset:8704
v_mfma_f32_16x16x32_bf16 v[36:39], a[88:91], a[36:39], v[36:39]
ds_read_b64_tr_b16 a[86:87], v12 offset:9728
s_add_u32 m0, s16, 0x9000
v_mfma_f32_16x16x32_bf16 v[36:39], a[92:95], a[52:55], v[36:39]
buffer_load_dwordx4 v2, s[48:51], s13 offen lds
v_mfma_f32_16x16x32_bf16 v[28:31], a[92:95], a[48:51], v[28:31]
v_mfma_f32_16x16x32_bf16 v[28:31], a[88:91], a[32:35], v[28:31]
s_waitcnt lgkmcnt(4)
v_mfma_f32_16x16x32_bf16 v[56:59], a[96:99], a[32:35], v[56:59]
ds_read_b64_tr_b16 a[88:89], v13 offset:512
v_mfma_f32_16x16x32_bf16 v[56:59], a[100:103], a[48:51], v[56:59]
ds_read_b64_tr_b16 a[90:91], v13 offset:1536
s_add_u32 m0, s16, 0x9400
v_mfma_f32_16x16x32_bf16 v[64:67], a[100:103], a[52:55], v[64:67]
buffer_load_dwordx4 v3, s[48:51], s13 offen lds
v_mfma_f32_16x16x32_bf16 v[64:67], a[96:99], a[36:39], v[64:67]
ds_read_b64_tr_b16 a[92:93], v13 offset:8704
v_mfma_f32_16x16x32_bf16 v[72:75], a[96:99], a[40:43], v[72:75]
ds_read_b64_tr_b16 a[94:95], v13 offset:9728
v_mfma_f32_16x16x32_bf16 v[72:75], a[100:103], a[56:59], v[72:75]
v_mfma_f32_16x16x32_bf16 v[80:83], a[100:103], a[60:63], v[80:83]
s_add_u32 m0, s16, 0x9800
v_mfma_f32_16x16x32_bf16 v[80:83], a[96:99], a[44:47], v[80:83]
buffer_load_dwordx4 v2, s[48:51], s14 offen lds
v_mfma_f32_16x16x32_bf16 v[84:87], a[104:107], a[44:47], v[84:87]
ds_read_b64_tr_b16 a[96:97], v12 offset:768
v_mfma_f32_16x16x32_bf16 v[84:87], a[108:111], a[60:63], v[84:87]
ds_read_b64_tr_b16 a[98:99], v12 offset:1792
v_mfma_f32_16x16x32_bf16 v[76:79], a[108:111], a[56:59], v[76:79]
ds_read_b64_tr_b16 a[100:101], v12 offset:8960
v_mfma_f32_16x16x32_bf16 v[76:79], a[104:107], a[40:43], v[76:79]
ds_read_b64_tr_b16 a[102:103], v12 offset:9984
s_add_u32 m0, s16, 0x9c00
v_mfma_f32_16x16x32_bf16 v[68:71], a[104:107], a[36:39], v[68:71]
buffer_load_dwordx4 v3, s[48:51], s14 offen lds
v_mfma_f32_16x16x32_bf16 v[68:71], a[108:111], a[52:55], v[68:71]
v_lshl_add_u32 v2, s42, 7, v2
v_lshl_add_u32 v3, s42, 7, v3
v_mfma_f32_16x16x32_bf16 v[60:63], a[108:111], a[48:51], v[60:63]
v_mfma_f32_16x16x32_bf16 v[60:63], a[104:107], a[32:35], v[60:63]
s_add_u32 m0, s17, 0x0
s_waitcnt lgkmcnt(4)
v_mfma_f32_16x16x32_bf16 v[88:91], a[80:83], a[32:35], v[88:91]
ds_read_b64_tr_b16 a[104:105], v13 offset:768
s_waitcnt vmcnt(16)
v_mfma_f32_16x16x32_bf16 v[88:91], a[84:87], a[48:51], v[88:91]
buffer_load_dwordx4 v5, s[56:59], 0 offen lds
v_mfma_f32_16x16x32_bf16 v[96:99], a[84:87], a[52:55], v[96:99]
ds_read_b64_tr_b16 a[106:107], v13 offset:1792
v_mfma_f32_16x16x32_bf16 v[96:99], a[80:83], a[36:39], v[96:99]
ds_read_b64_tr_b16 a[108:109], v13 offset:8960
v_mfma_f32_16x16x32_bf16 v[104:107], a[80:83], a[40:43], v[104:107]
ds_read_b64_tr_b16 a[110:111], v13 offset:9984
v_mfma_f32_16x16x32_bf16 v[104:107], a[84:87], a[56:59], v[104:107]
ds_read_b128 a[0:3], v8 offset:0
s_add_u32 m0, s17, 0x4000
v_mfma_f32_16x16x32_bf16 v[112:115], a[84:87], a[60:63], v[112:115]
buffer_load_dwordx4 v5, s[60:63], 0 offen lds
v_mfma_f32_16x16x32_bf16 v[112:115], a[80:83], a[44:47], v[112:115]
ds_read_b128 a[16:19], v9 offset:0
v_mfma_f32_16x16x32_bf16 v[116:119], a[88:91], a[44:47], v[116:119]
ds_read_b64_tr_b16 a[80:81], v12 offset:16384
v_mfma_f32_16x16x32_bf16 v[116:119], a[92:95], a[60:63], v[116:119]
ds_read_b64_tr_b16 a[82:83], v12 offset:17408
v_mfma_f32_16x16x32_bf16 v[108:111], a[92:95], a[56:59], v[108:111]
ds_read_b64_tr_b16 a[84:85], v12 offset:24576
s_add_u32 m0, s17, 0x400
v_mfma_f32_16x16x32_bf16 v[108:111], a[88:91], a[40:43], v[108:111]
buffer_load_dwordx4 v5, s[56:59], s13 offen lds
v_mfma_f32_16x16x32_bf16 v[100:103], a[88:91], a[36:39], v[100:103]
ds_read_b64_tr_b16 a[86:87], v12 offset:25600
v_mfma_f32_16x16x32_bf16 v[100:103], a[92:95], a[52:55], v[100:103]
ds_read_b128 a[4:7], v8 offset:2048
v_mfma_f32_16x16x32_bf16 v[92:95], a[92:95], a[48:51], v[92:95]
ds_read_b128 a[20:23], v9 offset:2048
s_waitcnt lgkmcnt(8)
v_mfma_f32_16x16x32_bf16 v[92:95], a[88:91], a[32:35], v[92:95]
ds_read_b128 a[8:11], v8 offset:4096
s_add_u32 m0, s17, 0x4400
v_mfma_f32_16x16x32_bf16 v[120:123], a[96:99], a[32:35], v[120:123]
buffer_load_dwordx4 v5, s[60:63], s13 offen lds
v_mfma_f32_16x16x32_bf16 v[120:123], a[100:103], a[48:51], v[120:123]
ds_read_b64_tr_b16 a[88:89], v13 offset:16384
v_mfma_f32_16x16x32_bf16 v[128:131], a[100:103], a[52:55], v[128:131]
ds_read_b64_tr_b16 a[90:91], v13 offset:17408
v_mfma_f32_16x16x32_bf16 v[128:131], a[96:99], a[36:39], v[128:131]
ds_read_b64_tr_b16 a[92:93], v13 offset:24576
v_mfma_f32_16x16x32_bf16 v[136:139], a[96:99], a[40:43], v[136:139]
ds_read_b64_tr_b16 a[94:95], v13 offset:25600
s_add_u32 m0, s17, 0x800
v_mfma_f32_16x16x32_bf16 v[136:139], a[100:103], a[56:59], v[136:139]
buffer_load_dwordx4 v6, s[56:59], 0 offen lds
v_mfma_f32_16x16x32_bf16 v[144:147], a[100:103], a[60:63], v[144:147]
ds_read_b128 a[24:27], v9 offset:4096
v_mfma_f32_16x16x32_bf16 v[144:147], a[96:99], a[44:47], v[144:147]
ds_read_b128 a[12:15], v8 offset:6144
v_mfma_f32_16x16x32_bf16 v[148:151], a[104:107], a[44:47], v[148:151]
ds_read_b64_tr_b16 a[96:97], v12 offset:16640
v_mfma_f32_16x16x32_bf16 v[148:151], a[108:111], a[60:63], v[148:151]
ds_read_b64_tr_b16 a[98:99], v12 offset:17664
s_add_u32 m0, s17, 0x4800
v_mfma_f32_16x16x32_bf16 v[140:143], a[108:111], a[56:59], v[140:143]
buffer_load_dwordx4 v6, s[60:63], 0 offen lds
v_mfma_f32_16x16x32_bf16 v[140:143], a[104:107], a[40:43], v[140:143]
ds_read_b64_tr_b16 a[100:101], v12 offset:24832
v_mfma_f32_16x16x32_bf16 v[132:135], a[104:107], a[36:39], v[132:135]
ds_read_b64_tr_b16 a[102:103], v12 offset:25856
v_mfma_f32_16x16x32_bf16 v[132:135], a[108:111], a[52:55], v[132:135]
ds_read_b128 a[28:31], v9 offset:6144
v_mfma_f32_16x16x32_bf16 v[124:127], a[108:111], a[48:51], v[124:127]
s_add_u32 m0, s17, 0xc00
s_waitcnt lgkmcnt(7)
v_mfma_f32_16x16x32_bf16 v[124:127], a[104:107], a[32:35], v[124:127]
buffer_load_dwordx4 v6, s[56:59], s13 offen lds
v_mfma_f32_16x16x32_bf16 v[152:155], a[32:35], a[80:83], v[152:155]
ds_read_b64_tr_b16 a[104:105], v13 offset:16640
v_mfma_f32_16x16x32_bf16 v[152:155], a[48:51], a[84:87], v[152:155]
ds_read_b64_tr_b16 a[106:107], v13 offset:17664
v_mfma_f32_16x16x32_bf16 v[156:159], a[52:55], a[84:87], v[156:159]
ds_read_b64_tr_b16 a[108:109], v13 offset:24832
v_mfma_f32_16x16x32_bf16 v[156:159], a[36:39], a[80:83], v[156:159]
ds_read_b64_tr_b16 a[110:111], v13 offset:25856
s_add_u32 m0, s17, 0x4c00
v_mfma_f32_16x16x32_bf16 v[160:163], a[40:43], a[80:83], v[160:163]
buffer_load_dwordx4 v6, s[60:63], s13 offen lds
v_mfma_f32_16x16x32_bf16 v[160:163], a[56:59], a[84:87], v[160:163]
v_lshl_add_u32 v5, s42, 19, v5
v_lshl_add_u32 v6, s42, 19, v6
v_mfma_f32_16x16x32_bf16 v[164:167], a[60:63], a[84:87], v[164:167]
v_mfma_f32_16x16x32_bf16 v[164:167], a[44:47], a[80:83], v[164:167]
v_mfma_f32_16x16x32_bf16 v[180:183], a[44:47], a[88:91], v[180:183]
ds_read_b64_tr_b16 a[80:81], v12 offset:16896
s_mov_b32 s9, 0x200000
v_mfma_f32_16x16x32_bf16 v[180:183], a[60:63], a[92:95], v[180:183]
buffer_load_dword a120, v18, s[56:59], s9 offen
v_mfma_f32_16x16x32_bf16 v[176:179], a[56:59], a[92:95], v[176:179]
ds_read_b64_tr_b16 a[82:83], v12 offset:17920
v_mfma_f32_16x16x32_bf16 v[176:179], a[40:43], a[88:91], v[176:179]
ds_read_b64_tr_b16 a[84:85], v12 offset:25088
v_mfma_f32_16x16x32_bf16 v[172:175], a[36:39], a[88:91], v[172:175]
ds_read_b64_tr_b16 a[86:87], v12 offset:26112
v_mfma_f32_16x16x32_bf16 v[172:175], a[52:55], a[92:95], v[172:175]
s_add_u32 m0, s16, 0x0
s_waitcnt lgkmcnt(8)
v_mfma_f32_16x16x32_bf16 v[168:171], a[48:51], a[92:95], v[168:171]
buffer_load_dwordx4 v2, s[48:51], 0 offen lds
v_mfma_f32_16x16x32_bf16 v[168:171], a[32:35], a[88:91], v[168:171]
s_waitcnt lgkmcnt(4)
v_mfma_f32_16x16x32_bf16 v[184:187], a[32:35], a[96:99], v[184:187]
ds_read_b64_tr_b16 a[88:89], v13 offset:16896
v_mfma_f32_16x16x32_bf16 v[184:187], a[48:51], a[100:103], v[184:187]
ds_read_b64_tr_b16 a[90:91], v13 offset:17920
v_mfma_f32_16x16x32_bf16 v[188:191], a[52:55], a[100:103], v[188:191]
ds_read_b64_tr_b16 a[92:93], v13 offset:25088
s_add_u32 m0, s16, 0x400
v_mfma_f32_16x16x32_bf16 v[188:191], a[36:39], a[96:99], v[188:191]
buffer_load_dwordx4 v3, s[48:51], 0 offen lds
v_mfma_f32_16x16x32_bf16 v[192:195], a[40:43], a[96:99], v[192:195]
ds_read_b64_tr_b16 a[94:95], v13 offset:26112
v_mfma_f32_16x16x32_bf16 v[192:195], a[56:59], a[100:103], v[192:195]
v_mfma_f32_16x16x32_bf16 v[196:199], a[60:63], a[100:103], v[196:199]
v_mfma_f32_16x16x32_bf16 v[196:199], a[44:47], a[96:99], v[196:199]
s_add_u32 m0, s16, 0x800
v_mfma_f32_16x16x32_bf16 v[212:215], a[44:47], a[104:107], v[212:215]
buffer_load_dwordx4 v2, s[48:51], s12 offen lds
v_mfma_f32_16x16x32_bf16 v[212:215], a[60:63], a[108:111], v[212:215]
ds_read_b64_tr_b16 a[96:97], v12 offset:17152
v_mfma_f32_16x16x32_bf16 v[208:211], a[56:59], a[108:111], v[208:211]
ds_read_b64_tr_b16 a[98:99], v12 offset:18176
v_mfma_f32_16x16x32_bf16 v[208:211], a[40:43], a[104:107], v[208:211]
ds_read_b64_tr_b16 a[100:101], v12 offset:25344
v_mfma_f32_16x16x32_bf16 v[204:207], a[36:39], a[104:107], v[204:207]
ds_read_b64_tr_b16 a[102:103], v12 offset:26368
s_add_u32 m0, s16, 0xc00
v_mfma_f32_16x16x32_bf16 v[204:207], a[52:55], a[108:111], v[204:207]
buffer_load_dwordx4 v3, s[48:51], s12 offen lds
v_mfma_f32_16x16x32_bf16 v[200:203], a[48:51], a[108:111], v[200:203]
v_mfma_f32_16x16x32_bf16 v[200:203], a[32:35], a[104:107], v[200:203]
s_waitcnt lgkmcnt(4)
v_mfma_f32_16x16x32_bf16 v[216:219], a[32:35], a[80:83], v[216:219]
ds_read_b64_tr_b16 a[104:105], v13 offset:17152
v_mfma_f32_16x16x32_bf16 v[216:219], a[48:51], a[84:87], v[216:219]
ds_read_b64_tr_b16 a[106:107], v13 offset:18176
s_add_u32 m0, s16, 0x1000
v_mfma_f32_16x16x32_bf16 v[220:223], a[52:55], a[84:87], v[220:223]
buffer_load_dwordx4 v2, s[48:51], s13 offen lds
v_mfma_f32_16x16x32_bf16 v[220:223], a[36:39], a[80:83], v[220:223]
ds_read_b64_tr_b16 a[108:109], v13 offset:25344
v_mfma_f32_16x16x32_bf16 v[224:227], a[40:43], a[80:83], v[224:227]
ds_read_b64_tr_b16 a[110:111], v13 offset:26368
v_add_u32 v12, 0x8000, v12
v_mfma_f32_16x16x32_bf16 v[224:227], a[56:59], a[84:87], v[224:227]
v_add_u32 v13, 0x8000, v13
v_mfma_f32_16x16x32_bf16 v[228:231], a[60:63], a[84:87], v[228:231]
s_add_u32 m0, s16, 0x1400
v_mfma_f32_16x16x32_bf16 v[228:231], a[44:47], a[80:83], v[228:231]
buffer_load_dwordx4 v3, s[48:51], s13 offen lds
v_mfma_f32_16x16x32_bf16 v[244:247], a[44:47], a[88:91], v[244:247]
s_waitcnt vmcnt(23) lgkmcnt(0)
v_mfma_f32_16x16x32_bf16 v[244:247], a[60:63], a[92:95], v[244:247]
s_barrier
v_mfma_f32_16x16x32_bf16 v[240:243], a[56:59], a[92:95], v[240:243]
ds_read_b64_tr_b16 a[80:81], v12 offset:0
s_lshl_b32 s15, s2, 2
v_mfma_f32_16x16x32_bf16 v[240:243], a[40:43], a[88:91], v[240:243]
ds_read_b64_tr_b16 a[82:83], v12 offset:1024
s_add_u32 m0, s16, 0x1800
v_mfma_f32_16x16x32_bf16 v[236:239], a[36:39], a[88:91], v[236:239]
buffer_load_dwordx4 v2, s[48:51], s14 offen lds
v_mfma_f32_16x16x32_bf16 v[236:239], a[52:55], a[92:95], v[236:239]
ds_read_b64_tr_b16 a[84:85], v12 offset:8192
s_add_u32 s15, s15, s4
v_mfma_f32_16x16x32_bf16 v[232:235], a[48:51], a[92:95], v[232:235]
ds_read_b64_tr_b16 a[86:87], v12 offset:9216
s_lshl_b32 s15, s15, 12
v_mfma_f32_16x16x32_bf16 v[232:235], a[32:35], a[88:91], v[232:235]
L_padA1:
s_cmp_eq_u32 s95, 1
s_cbranch_scc1 L_padA5
s_waitcnt lgkmcnt(4)
s_add_u32 s15, s15, 0x4800000
v_mfma_f32_16x16x32_bf16 v[248:251], a[32:35], a[96:99], v[248:251]
ds_read_b64_tr_b16 a[88:89], v13 offset:0
s_add_u32 m0, s16, 0x1c00
v_mfma_f32_16x16x32_bf16 v[248:251], a[48:51], a[100:103], v[248:251]
buffer_load_dwordx4 v3, s[48:51], s14 offen lds
v_mfma_f32_16x16x32_bf16 v[252:255], a[52:55], a[100:103], v[252:255]
ds_read_b64_tr_b16 a[90:91], v13 offset:1024
v_lshl_add_u32 v2, s42, 7, v2
v_mfma_f32_16x16x32_bf16 v[252:255], a[36:39], a[96:99], v[252:255]
ds_read_b64_tr_b16 a[92:93], v13 offset:8192
v_lshl_add_u32 v3, s42, 7, v3
v_mfma_f32_16x16x32_bf16 a[232:235], a[40:43], a[96:99], a[232:235]
ds_read_b64_tr_b16 a[94:95], v13 offset:9216
v_mfma_f32_16x16x32_bf16 a[232:235], a[56:59], a[100:103], a[232:235]
s_mov_b32 s9, 0x200000
v_mfma_f32_16x16x32_bf16 a[236:239], a[60:63], a[100:103], a[236:239]
buffer_load_dword a120, v18, s[60:63], s9 offen
v_mfma_f32_16x16x32_bf16 a[236:239], a[44:47], a[96:99], a[236:239]
v_mfma_f32_16x16x32_bf16 a[252:255], a[44:47], a[104:107], a[252:255]
ds_read_b64_tr_b16 a[96:97], v12 offset:256
v_mfma_f32_16x16x32_bf16 a[252:255], a[60:63], a[108:111], a[252:255]
ds_read_b64_tr_b16 a[98:99], v12 offset:1280
v_mfma_f32_16x16x32_bf16 a[248:251], a[56:59], a[108:111], a[248:251]
ds_read_b64_tr_b16 a[100:101], v12 offset:8448
s_add_u32 m0, s17, 0x8000
v_mfma_f32_16x16x32_bf16 a[248:251], a[40:43], a[104:107], a[248:251]
buffer_load_dwordx4 v5, s[56:59], 0 offen lds
v_mfma_f32_16x16x32_bf16 a[244:247], a[36:39], a[104:107], a[244:247]
ds_read_b64_tr_b16 a[102:103], v12 offset:9472
v_mfma_f32_16x16x32_bf16 a[244:247], a[52:55], a[108:111], a[244:247]
v_mfma_f32_16x16x32_bf16 a[240:243], a[48:51], a[108:111], a[240:243]
v_mfma_f32_16x16x32_bf16 a[240:243], a[32:35], a[104:107], a[240:243]
s_add_u32 m0, s17, 0xc000
s_waitcnt lgkmcnt(4)
L_S2:
v_mfma_f32_16x16x32_bf16 v[24:27], a[80:83], a[0:3], v[24:27]
buffer_load_dwordx4 v5, s[60:63], 0 offen lds
v_mfma_f32_16x16x32_bf16 v[24:27], a[84:87], a[16:19], v[24:27]
ds_read_b64_tr_b16 a[104:105], v13 offset:256
s_waitcnt vmcnt(20)
v_mfma_f32_16x16x32_bf16 v[32:35], a[84:87], a[20:23], v[32:35]
ds_read_b64_tr_b16 a[106:107], v13 offset:1280
v_mfma_f32_16x16x32_bf16 v[32:35], a[80:83], a[4:7], v[32:35]
ds_read_b64_tr_b16 a[108:109], v13 offset:8448
v_mfma_f32_16x16x32_bf16 v[40:43], a[80:83], a[8:11], v[40:43]
ds_read_b64_tr_b16 a[110:111], v13 offset:9472
s_add_u32 m0, s17, 0x8400
v_mfma_f32_16x16x32_bf16 v[40:43], a[84:87], a[24:27], v[40:43]
buffer_load_dwordx4 v5, s[56:59], s13 offen lds
v_mfma_f32_16x16x32_bf16 v[48:51], a[84:87], a[28:31], v[48:51]
ds_read_b128 a[32:35], v8 offset:32768
v_mfma_f32_16x16x32_bf16 v[48:51], a[80:83], a[12:15], v[48:51]
ds_read_b128 a[48:51], v9 offset:32768
v_mfma_f32_16x16x32_bf16 v[52:55], a[88:91], a[12:15], v[52:55]
ds_read_b64_tr_b16 a[80:81], v12 offset:512
v_mfma_f32_16x16x32_bf16 v[52:55], a[92:95], a[28:31], v[52:55]
ds_read_b64_tr_b16 a[82:83], v12 offset:1536
s_add_u32 m0, s17, 0xc400
v_mfma_f32_16x16x32_bf16 v[44:47], a[92:95], a[24:27], v[44:47]
buffer_load_dwordx4 v5, s[60:63], s13 offen lds
v_mfma_f32_16x16x32_bf16 v[44:47], a[88:91], a[8:11], v[44:47]
ds_read_b64_tr_b16 a[84:85], v12 offset:8704
v_mfma_f32_16x16x32_bf16 v[36:39], a[88:91], a[4:7], v[36:39]
ds_read_b64_tr_b16 a[86:87], v12 offset:9728
v_mfma_f32_16x16x32_bf16 v[36:39], a[92:95], a[20:23], v[36:39]
ds_read_b128 a[36:39], v8 offset:34816
s_waitcnt lgkmcnt(7)
v_mfma_f32_16x16x32_bf16 v[28:31], a[92:95], a[16:19], v[28:31]
ds_read_b128 a[52:55], v9 offset:34816
s_add_u32 m0, s17, 0x8800
v_mfma_f32_16x16x32_bf16 v[28:31], a[88:91], a[0:3], v[28:31]
buffer_load_dwordx4 v6, s[56:59], 0 offen lds
v_mfma_f32_16x16x32_bf16 v[56:59], a[96:99], a[0:3], v[56:59]
ds_read_b64_tr_b16 a[88:89], v13 offset:512
v_mfma_f32_16x16x32_bf16 v[56:59], a[100:103], a[16:19], v[56:59]
ds_read_b64_tr_b16 a[90:91], v13 offset:1536
v_mfma_f32_16x16x32_bf16 v[64:67], a[100:103], a[20:23], v[64:67]
ds_read_b64_tr_b16 a[92:93], v13 offset:8704
v_mfma_f32_16x16x32_bf16 v[64:67], a[96:99], a[4:7], v[64:67]
ds_read_b64_tr_b16 a[94:95], v13 offset:9728
s_add_u32 m0, s17, 0xc800
v_mfma_f32_16x16x32_bf16 v[72:75], a[96:99], a[8:11], v[72:75]
buffer_load_dwordx4 v6, s[60:63], 0 offen lds
v_mfma_f32_16x16x32_bf16 v[72:75], a[100:103], a[24:27], v[72:75]
ds_read_b128 a[40:43], v8 offset:36864
v_mfma_f32_16x16x32_bf16 v[80:83], a[100:103], a[28:31], v[80:83]
ds_read_b128 a[56:59], v9 offset:36864
v_mfma_f32_16x16x32_bf16 v[80:83], a[96:99], a[12:15], v[80:83]
ds_read_b128 a[44:47], v8 offset:38912
v_mfma_f32_16x16x32_bf16 v[84:87], a[104:107], a[12:15], v[84:87]
ds_read_b64_tr_b16 a[96:97], v12 offset:768
s_add_u32 m0, s17, 0x8c00
v_mfma_f32_16x16x32_bf16 v[84:87], a[108:111], a[28:31], v[84:87]
buffer_load_dwordx4 v6, s[56:59], s13 offen lds
v_mfma_f32_16x16x32_bf16 v[76:79], a[108:111], a[24:27], v[76:79]
ds_read_b64_tr_b16 a[98:99], v12 offset:1792
v_mfma_f32_16x16x32_bf16 v[76:79], a[104:107], a[8:11], v[76:79]
ds_read_b64_tr_b16 a[100:101], v12 offset:8960
v_mfma_f32_16x16x32_bf16 v[68:71], a[104:107], a[4:7], v[68:71]
ds_read_b64_tr_b16 a[102:103], v12 offset:9984
v_mfma_f32_16x16x32_bf16 v[68:71], a[108:111], a[20:23], v[68:71]
ds_read_b128 a[60:63], v9 offset:38912
s_add_u32 m0, s17, 0xcc00
v_mfma_f32_16x16x32_bf16 v[60:63], a[108:111], a[16:19], v[60:63]
buffer_load_dwordx4 v6, s[60:63], s13 offen lds
v_mfma_f32_16x16x32_bf16 v[60:63], a[104:107], a[0:3], v[60:63]
s_waitcnt lgkmcnt(8)
v_lshl_add_u32 v5, s42, 19, v5
v_lshl_add_u32 v6, s42, 19, v6
v_mfma_f32_16x16x32_bf16 v[88:91], a[80:83], a[0:3], v[88:91]
ds_read_b64_tr_b16 a[104:105], v13 offset:768
v_mfma_f32_16x16x32_bf16 v[88:91], a[84:87], a[16:19], v[88:91]
ds_read_b64_tr_b16 a[106:107], v13 offset:1792
v_mfma_f32_16x16x32_bf16 v[96:99], a[84:87], a[20:23], v[96:99]
ds_read_b64_tr_b16 a[108:109], v13 offset:8960
v_mfma_f32_16x16x32_bf16 v[96:99], a[80:83], a[4:7], v[96:99]
ds_read_b64_tr_b16 a[110:111], v13 offset:9984
v_mfma_f32_16x16x32_bf16 v[104:107], a[80:83], a[8:11], v[104:107]
s_add_u32 m0, s16, 0x8000
s_waitcnt lgkmcnt(4)
v_mfma_f32_16x16x32_bf16 v[104:107], a[84:87], a[24:27], v[104:107]
buffer_load_dwordx4 v2, s[48:51], 0 offen lds
v_mfma_f32_16x16x32_bf16 v[112:115], a[84:87], a[28:31], v[112:115]
v_mfma_f32_16x16x32_bf16 v[112:115], a[80:83], a[12:15], v[112:115]
v_mfma_f32_16x16x32_bf16 v[116:119], a[88:91], a[12:15], v[116:119]
ds_read_b64_tr_b16 a[80:81], v12 offset:16384
v_mfma_f32_16x16x32_bf16 v[116:119], a[92:95], a[28:31], v[116:119]
ds_read_b64_tr_b16 a[82:83], v12 offset:17408
v_mfma_f32_16x16x32_bf16 v[108:111], a[92:95], a[24:27], v[108:111]
ds_read_b64_tr_b16 a[84:85], v12 offset:24576
v_mfma_f32_16x16x32_bf16 v[108:111], a[88:91], a[8:11], v[108:111]
ds_read_b64_tr_b16 a[86:87], v12 offset:25600
s_add_u32 m0, s16, 0x8400
v_mfma_f32_16x16x32_bf16 v[100:103], a[88:91], a[4:7], v[100:103]
buffer_load_dwordx4 v3, s[48:51], 0 offen lds
v_mfma_f32_16x16x32_bf16 v[100:103], a[92:95], a[20:23], v[100:103]
v_mfma_f32_16x16x32_bf16 v[92:95], a[92:95], a[16:19], v[92:95]
v_mfma_f32_16x16x32_bf16 v[92:95], a[88:91], a[0:3], v[92:95]
s_waitcnt lgkmcnt(4)
v_mfma_f32_16x16x32_bf16 v[120:123], a[96:99], a[0:3], v[120:123]
ds_read_b64_tr_b16 a[88:89], v13 offset:16384
v_mfma_f32_16x16x32_bf16 v[120:123], a[100:103], a[16:19], v[120:123]
ds_read_b64_tr_b16 a[90:91], v13 offset:17408
v_mfma_f32_16x16x32_bf16 v[128:131], a[100:103], a[20:23], v[128:131]
ds_read_b64_tr_b16 a[92:93], v13 offset:24576
v_mfma_f32_16x16x32_bf16 v[128:131], a[96:99], a[4:7], v[128:131]
ds_read_b64_tr_b16 a[94:95], v13 offset:25600
s_add_u32 m0, s16, 0x8800
v_mfma_f32_16x16x32_bf16 v[136:139], a[96:99], a[8:11], v[136:139]
buffer_load_dwordx4 v2, s[48:51], s12 offen lds
v_mfma_f32_16x16x32_bf16 v[136:139], a[100:103], a[24:27], v[136:139]
v_mfma_f32_16x16x32_bf16 v[144:147], a[100:103], a[28:31], v[144:147]
v_mfma_f32_16x16x32_bf16 v[144:147], a[96:99], a[12:15], v[144:147]
v_mfma_f32_16x16x32_bf16 v[148:151], a[104:107], a[12:15], v[148:151]
ds_read_b64_tr_b16 a[96:97], v12 offset:16640
v_mfma_f32_16x16x32_bf16 v[148:151], a[108:111], a[28:31], v[148:151]
ds_read_b64_tr_b16 a[98:99], v12 offset:17664
v_mfma_f32_16x16x32_bf16 v[140:143], a[108:111], a[24:27], v[140:143]
ds_read_b64_tr_b16 a[100:101], v12 offset:24832
s_add_u32 m0, s16, 0x8c00
v_mfma_f32_16x16x32_bf16 v[140:143], a[104:107], a[8:11], v[140:143]
buffer_load_dwordx4 v3, s[48:51], s12 offen lds
v_mfma_f32_16x16x32_bf16 v[132:135], a[104:107], a[4:7], v[132:135]
ds_read_b64_tr_b16 a[102:103], v12 offset:25856
v_mfma_f32_16x16x32_bf16 v[132:135], a[108:111], a[20:23], v[132:135]
v_mfma_f32_16x16x32_bf16 v[124:127], a[108:111], a[16:19], v[124:127]
v_mfma_f32_16x16x32_bf16 v[124:127], a[104:107], a[0:3], v[124:127]
s_waitcnt lgkmcnt(4)
v_mfma_f32_16x16x32_bf16 v[152:155], a[0:3], a[80:83], v[152:155]
ds_read_b64_tr_b16 a[104:105], v13 offset:16640
v_mfma_f32_16x16x32_bf16 v[152:155], a[16:19], a[84:87], v[152:155]
ds_read_b64_tr_b16 a[106:107], v13 offset:17664
s_add_u32 m0, s16, 0x9000
v_mfma_f32_16x16x32_bf16 v[156:159], a[20:23], a[84:87], v[156:159]
buffer_load_dwordx4 v2, s[48:51], s13 offen lds
v_mfma_f32_16x16x32_bf16 v[156:159], a[4:7], a[80:83], v[156:159]
ds_read_b64_tr_b16 a[108:109], v13 offset:24832
v_mfma_f32_16x16x32_bf16 v[160:163], a[8:11], a[80:83], v[160:163]
ds_read_b64_tr_b16 a[110:111], v13 offset:25856
v_mfma_f32_16x16x32_bf16 v[160:163], a[24:27], a[84:87], v[160:163]
v_mfma_f32_16x16x32_bf16 v[164:167], a[28:31], a[84:87], v[164:167]
v_mfma_f32_16x16x32_bf16 v[164:167], a[12:15], a[80:83], v[164:167]
v_mfma_f32_16x16x32_bf16 v[180:183], a[12:15], a[88:91], v[180:183]
ds_read_b64_tr_b16 a[80:81], v12 offset:16896
v_mfma_f32_16x16x32_bf16 v[180:183], a[28:31], a[92:95], v[180:183]
ds_read_b64_tr_b16 a[82:83], v12 offset:17920
s_add_u32 m0, s16, 0x9400
v_mfma_f32_16x16x32_bf16 v[176:179], a[24:27], a[92:95], v[176:179]
buffer_load_dwordx4 v3, s[48:51], s13 offen lds
v_mfma_f32_16x16x32_bf16 v[176:179], a[8:11], a[88:91], v[176:179]
ds_read_b64_tr_b16 a[84:85], v12 offset:25088
v_mfma_f32_16x16x32_bf16 v[172:175], a[4:7], a[88:91], v[172:175]
ds_read_b64_tr_b16 a[86:87], v12 offset:26112
v_mfma_f32_16x16x32_bf16 v[172:175], a[20:23], a[92:95], v[172:175]
v_mfma_f32_16x16x32_bf16 v[168:171], a[16:19], a[92:95], v[168:171]
v_mfma_f32_16x16x32_bf16 v[168:171], a[0:3], a[88:91], v[168:171]
s_waitcnt lgkmcnt(4)
v_mfma_f32_16x16x32_bf16 v[184:187], a[0:3], a[96:99], v[184:187]
ds_read_b64_tr_b16 a[88:89], v13 offset:16896
s_add_u32 m0, s16, 0x9800
v_mfma_f32_16x16x32_bf16 v[184:187], a[16:19], a[100:103], v[184:187]
buffer_load_dwordx4 v2, s[48:51], s14 offen lds
v_mfma_f32_16x16x32_bf16 v[188:191], a[20:23], a[100:103], v[188:191]
ds_read_b64_tr_b16 a[90:91], v13 offset:17920
v_mfma_f32_16x16x32_bf16 v[188:191], a[4:7], a[96:99], v[188:191]
ds_read_b64_tr_b16 a[92:93], v13 offset:25088
v_mfma_f32_16x16x32_bf16 v[192:195], a[8:11], a[96:99], v[192:195]
ds_read_b64_tr_b16 a[94:95], v13 offset:26112
v_mfma_f32_16x16x32_bf16 v[192:195], a[24:27], a[100:103], v[192:195]
v_mfma_f32_16x16x32_bf16 v[196:199], a[28:31], a[100:103], v[196:199]
v_mfma_f32_16x16x32_bf16 v[196:199], a[12:15], a[96:99], v[196:199]
v_mfma_f32_16x16x32_bf16 v[212:215], a[12:15], a[104:107], v[212:215]
ds_read_b64_tr_b16 a[96:97], v12 offset:17152
s_add_u32 m0, s16, 0x9c00
v_mfma_f32_16x16x32_bf16 v[212:215], a[28:31], a[108:111], v[212:215]
buffer_load_dwordx4 v3, s[48:51], s14 offen lds
v_mfma_f32_16x16x32_bf16 v[208:211], a[24:27], a[108:111], v[208:211]
ds_read_b64_tr_b16 a[98:99], v12 offset:18176
v_lshl_add_u32 v2, s42, 7, v2
v_mfma_f32_16x16x32_bf16 v[208:211], a[8:11], a[104:107], v[208:211]
ds_read_b64_tr_b16 a[100:101], v12 offset:25344
v_lshl_add_u32 v3, s42, 7, v3
v_mfma_f32_16x16x32_bf16 v[204:207], a[4:7], a[104:107], v[204:207]
ds_read_b64_tr_b16 a[102:103], v12 offset:26368
v_mfma_f32_16x16x32_bf16 v[204:207], a[20:23], a[108:111], v[204:207]
v_mfma_f32_16x16x32_bf16 v[200:203], a[16:19], a[108:111], v[200:203]
v_mfma_f32_16x16x32_bf16 v[200:203], a[0:3], a[104:107], v[200:203]
s_mov_b32 s9, 0x0
s_waitcnt lgkmcnt(4)
v_mfma_f32_16x16x32_bf16 v[216:219], a[0:3], a[80:83], v[216:219]
buffer_load_dword a120, v19, s[44:47], s9 offen
v_mfma_f32_16x16x32_bf16 v[216:219], a[16:19], a[84:87], v[216:219]
ds_read_b64_tr_b16 a[104:105], v13 offset:17152
v_mfma_f32_16x16x32_bf16 v[220:223], a[20:23], a[84:87], v[220:223]
ds_read_b64_tr_b16 a[106:107], v13 offset:18176
v_mfma_f32_16x16x32_bf16 v[220:223], a[4:7], a[80:83], v[220:223]
ds_read_b64_tr_b16 a[108:109], v13 offset:25344
v_mfma_f32_16x16x32_bf16 v[224:227], a[8:11], a[80:83], v[224:227]
ds_read_b64_tr_b16 a[110:111], v13 offset:26368
v_add_u32 v12, 0xffff0000, v12
v_mfma_f32_16x16x32_bf16 v[224:227], a[24:27], a[84:87], v[224:227]
v_add_u32 v13, 0xffff0000, v13
v_mfma_f32_16x16x32_bf16 v[228:231], a[28:31], a[84:87], v[228:231]
v_mfma_f32_16x16x32_bf16 v[228:231], a[12:15], a[80:83], v[228:231]
v_mfma_f32_16x16x32_bf16 v[244:247], a[12:15], a[88:91], v[244:247]
s_waitcnt vmcnt(27) lgkmcnt(0)
v_mfma_f32_16x16x32_bf16 v[244:247], a[28:31], a[92:95], v[244:247]
s_barrier
s_add_u32 m0, s17, 0x10000
v_mfma_f32_16x16x32_bf16 v[240:243], a[24:27], a[92:95], v[240:243]
buffer_load_dwordx4 v5, s[56:59], 0 offen lds
v_mfma_f32_16x16x32_bf16 v[240:243], a[8:11], a[88:91], v[240:243]
ds_read_b64_tr_b16 a[80:81], v12 offset:0
v_mfma_f32_16x16x32_bf16 v[236:239], a[4:7], a[88:91], v[236:239]
ds_read_b64_tr_b16 a[82:83], v12 offset:1024
v_mfma_f32_16x16x32_bf16 v[236:239], a[20:23], a[92:95], v[236:239]
ds_read_b64_tr_b16 a[84:85], v12 offset:8192
v_mfma_f32_16x16x32_bf16 v[232:235], a[16:19], a[92:95], v[232:235]
ds_read_b64_tr_b16 a[86:87], v12 offset:9216
v_mfma_f32_16x16x32_bf16 v[232:235], a[0:3], a[88:91], v[232:235]
s_waitcnt lgkmcnt(4)
v_mfma_f32_16x16x32_bf16 v[248:251], a[0:3], a[96:99], v[248:251]
ds_read_b64_tr_b16 a[88:89], v13 offset:0
s_add_u32 m0, s17, 0x14000
v_mfma_f32_16x16x32_bf16 v[248:251], a[16:19], a[100:103], v[248:251]
buffer_load_dwordx4 v5, s[60:63], 0 offen lds
v_mfma_f32_16x16x32_bf16 v[252:255], a[20:23], a[100:103], v[252:255]
ds_read_b64_tr_b16 a[90:91], v13 offset:1024
v_mfma_f32_16x16x32_bf16 v[252:255], a[4:7], a[96:99], v[252:255]
ds_read_b64_tr_b16 a[92:93], v13 offset:8192
v_mfma_f32_16x16x32_bf16 a[232:235], a[8:11], a[96:99], a[232:235]
ds_read_b64_tr_b16 a[94:95], v13 offset:9216
v_mfma_f32_16x16x32_bf16 a[232:235], a[24:27], a[100:103], a[232:235]
v_mfma_f32_16x16x32_bf16 a[236:239], a[28:31], a[100:103], a[236:239]
v_mfma_f32_16x16x32_bf16 a[236:239], a[12:15], a[96:99], a[236:239]
s_add_u32 m0, s17, 0x10400
v_mfma_f32_16x16x32_bf16 a[252:255], a[12:15], a[104:107], a[252:255]
buffer_load_dwordx4 v5, s[56:59], s13 offen lds
v_mfma_f32_16x16x32_bf16 a[252:255], a[28:31], a[108:111], a[252:255]
ds_read_b64_tr_b16 a[96:97], v12 offset:256
v_mfma_f32_16x16x32_bf16 a[248:251], a[24:27], a[108:111], a[248:251]
ds_read_b64_tr_b16 a[98:99], v12 offset:1280
v_mfma_f32_16x16x32_bf16 a[248:251], a[8:11], a[104:107], a[248:251]
ds_read_b64_tr_b16 a[100:101], v12 offset:8448
v_mfma_f32_16x16x32_bf16 a[244:247], a[4:7], a[104:107], a[244:247]
ds_read_b64_tr_b16 a[102:103], v12 offset:9472
v_mfma_f32_16x16x32_bf16 a[244:247], a[20:23], a[108:111], a[244:247]
v_mfma_f32_16x16x32_bf16 a[240:243], a[16:19], a[108:111], a[240:243]
s_add_u32 m0, s17, 0x14400
s_waitcnt lgkmcnt(4)
v_mfma_f32_16x16x32_bf16 a[240:243], a[0:3], a[104:107], a[240:243]
buffer_load_dwordx4 v5, s[60:63], s13 offen lds
L_S3:
v_mfma_f32_16x16x32_bf16 v[24:27], a[80:83], a[32:35], v[24:27]
ds_read_b64_tr_b16 a[104:105], v13 offset:256
s_waitcnt vmcnt(22)
v_mfma_f32_16x16x32_bf16 v[24:27], a[84:87], a[48:51], v[24:27]
ds_read_b64_tr_b16 a[106:107], v13 offset:1280
v_mfma_f32_16x16x32_bf16 v[32:35], a[84:87], a[52:55], v[32:35]
ds_read_b64_tr_b16 a[108:109], v13 offset:8448
v_mfma_f32_16x16x32_bf16 v[32:35], a[80:83], a[36:39], v[32:35]
ds_read_b64_tr_b16 a[110:111], v13 offset:9472
v_mfma_f32_16x16x32_bf16 v[40:43], a[80:83], a[40:43], v[40:43]
ds_read_b128 a[0:3], v8 offset:0
v_mfma_f32_16x16x32_bf16 v[40:43], a[84:87], a[56:59], v[40:43]
ds_read_b128 a[16:19], v9 offset:0
s_add_u32 m0, s17, 0x10800
v_mfma_f32_16x16x32_bf16 v[48:51], a[84:87], a[60:63], v[48:51]
buffer_load_dwordx4 v6, s[56:59], 0 offen lds
v_mfma_f32_16x16x32_bf16 v[48:51], a[80:83], a[44:47], v[48:51]
ds_read_b128 a[4:7], v8 offset:2048
v_mfma_f32_16x16x32_bf16 v[52:55], a[88:91], a[44:47], v[52:55]
ds_read_b64_tr_b16 a[80:81], v12 offset:512
v_mfma_f32_16x16x32_bf16 v[52:55], a[92:95], a[60:63], v[52:55]
ds_read_b64_tr_b16 a[82:83], v12 offset:1536
v_mfma_f32_16x16x32_bf16 v[44:47], a[92:95], a[56:59], v[44:47]
ds_read_b64_tr_b16 a[84:85], v12 offset:8704
v_mfma_f32_16x16x32_bf16 v[44:47], a[88:91], a[40:43], v[44:47]
ds_read_b64_tr_b16 a[86:87], v12 offset:9728
v_mfma_f32_16x16x32_bf16 v[36:39], a[88:91], a[36:39], v[36:39]
ds_read_b128 a[20:23], v9 offset:2048
s_add_u32 m0, s17, 0x14800
v_mfma_f32_16x16x32_bf16 v[36:39], a[92:95], a[52:55], v[36:39]
buffer_load_dwordx4 v6, s[60:63], 0 offen lds
v_mfma_f32_16x16x32_bf16 v[28:31], a[92:95], a[48:51], v[28:31]
ds_read_b128 a[8:11], v8 offset:4096
v_mfma_f32_16x16x32_bf16 v[28:31], a[88:91], a[32:35], v[28:31]
ds_read_b128 a[24:27], v9 offset:4096
s_waitcnt lgkmcnt(10)
v_mfma_f32_16x16x32_bf16 v[56:59], a[96:99], a[32:35], v[56:59]
ds_read_b64_tr_b16 a[88:89], v13 offset:512
v_mfma_f32_16x16x32_bf16 v[56:59], a[100:103], a[48:51], v[56:59]
ds_read_b64_tr_b16 a[90:91], v13 offset:1536
v_mfma_f32_16x16x32_bf16 v[64:67], a[100:103], a[52:55], v[64:67]
ds_read_b64_tr_b16 a[92:93], v13 offset:8704
v_mfma_f32_16x16x32_bf16 v[64:67], a[96:99], a[36:39], v[64:67]
ds_read_b64_tr_b16 a[94:95], v13 offset:9728
s_add_u32 m0, s17, 0x10c00
v_mfma_f32_16x16x32_bf16 v[72:75], a[96:99], a[40:43], v[72:75]
buffer_load_dwordx4 v6, s[56:59], s13 offen lds
v_mfma_f32_16x16x32_bf16 v[72:75], a[100:103], a[56:59], v[72:75]
ds_read_b128 a[12:15], v8 offset:6144
v_mfma_f32_16x16x32_bf16 v[80:83], a[100:103], a[60:63], v[80:83]
ds_read_b128 a[28:31], v9 offset:6144
v_mfma_f32_16x16x32_bf16 v[80:83], a[96:99], a[44:47], v[80:83]
v_mfma_f32_16x16x32_bf16 v[84:87], a[104:107], a[44:47], v[84:87]
ds_read_b64_tr_b16 a[96:97], v12 offset:768
v_mfma_f32_16x16x32_bf16 v[84:87], a[108:111], a[60:63], v[84:87]
ds_read_b64_tr_b16 a[98:99], v12 offset:1792
v_mfma_f32_16x16x32_bf16 v[76:79], a[108:111], a[56:59], v[76:79]
ds_read_b64_tr_b16 a[100:101], v12 offset:8960
s_add_u32 m0, s17, 0x14c00
v_mfma_f32_16x16x32_bf16 v[76:79], a[104:107], a[40:43], v[76:79]
buffer_load_dwordx4 v6, s[60:63], s13 offen lds
v_mfma_f32_16x16x32_bf16 v[68:71], a[104:107], a[36:39], v[68:71]
ds_read_b64_tr_b16 a[102:103], v12 offset:9984
v_lshl_add_u32 v5, s42, 19, v5
v_mfma_f32_16x16x32_bf16 v[68:71], a[108:111], a[52:55], v[68:71]
v_lshl_add_u32 v6, s42, 19, v6
v_mfma_f32_16x16x32_bf16 v[60:63], a[108:111], a[48:51], v[60:63]
v_mfma_f32_16x16x32_bf16 v[60:63], a[104:107], a[32:35], v[60:63]
s_waitcnt lgkmcnt(6)
v_mfma_f32_16x16x32_bf16 v[88:91], a[80:83], a[32:35], v[88:91]
ds_read_b64_tr_b16 a[104:105], v13 offset:768
v_mfma_f32_16x16x32_bf16 v[88:91], a[84:87], a[48:51], v[88:91]
ds_read_b64_tr_b16 a[106:107], v13 offset:1792
s_mov_b32 s9, 0x200000
v_mfma_f32_16x16x32_bf16 v[96:99], a[84:87], a[52:55], v[96:99]
buffer_load_dword a120, v19, s[44:47], s9 offen
v_mfma_f32_16x16x32_bf16 v[96:99], a[80:83], a[36:39], v[96:99]
ds_read_b64_tr_b16 a[108:109], v13 offset:8960
v_mfma_f32_16x16x32_bf16 v[104:107], a[80:83], a[40:43], v[104:107]
ds_read_b64_tr_b16 a[110:111], v13 offset:9984
v_mfma_f32_16x16x32_bf16 v[104:107], a[84:87], a[56:59], v[104:107]
v_mfma_f32_16x16x32_bf16 v[112:115], a[84:87], a[60:63], v[112:115]
v_mfma_f32_16x16x32_bf16 v[112:115], a[80:83], a[44:47], v[112:115]
s_waitcnt lgkmcnt(8)
v_mfma_f32_16x16x32_bf16 v[116:119], a[88:91], a[44:47], v[116:119]
ds_read_b64_tr_b16 a[80:81], v12 offset:16384
s_add_u32 m0, s16, 0x0
v_mfma_f32_16x16x32_bf16 v[116:119], a[92:95], a[60:63], v[116:119]
buffer_load_dwordx4 v2, s[48:51], 0 offen lds
v_mfma_f32_16x16x32_bf16 v[108:111], a[92:95], a[56:59], v[108:111]
ds_read_b64_tr_b16 a[82:83], v12 offset:17408
v_mfma_f32_16x16x32_bf16 v[108:111], a[88:91], a[40:43], v[108:111]
ds_read_b64_tr_b16 a[84:85], v12 offset:24576
v_mfma_f32_16x16x32_bf16 v[100:103], a[88:91], a[36:39], v[100:103]
ds_read_b64_tr_b16 a[86:87], v12 offset:25600
v_mfma_f32_16x16x32_bf16 v[100:103], a[92:95], a[52:55], v[100:103]
v_mfma_f32_16x16x32_bf16 v[92:95], a[92:95], a[48:51], v[92:95]
v_mfma_f32_16x16x32_bf16 v[92:95], a[88:91], a[32:35], v[92:95]
s_add_u32 m0, s16, 0x400
s_waitcnt lgkmcnt(4)
v_mfma_f32_16x16x32_bf16 v[120:123], a[96:99], a[32:35], v[120:123]
buffer_load_dwordx4 v3, s[48:51], 0 offen lds
v_mfma_f32_16x16x32_bf16 v[120:123], a[100:103], a[48:51], v[120:123]
ds_read_b64_tr_b16 a[88:89], v13 offset:16384
v_mfma_f32_16x16x32_bf16 v[128:131], a[100:103], a[52:55], v[128:131]
ds_read_b64_tr_b16 a[90:91], v13 offset:17408
v_mfma_f32_16x16x32_bf16 v[128:131], a[96:99], a[36:39], v[128:131]
ds_read_b64_tr_b16 a[92:93], v13 offset:24576
v_mfma_f32_16x16x32_bf16 v[136:139], a[96:99], a[40:43], v[136:139]
ds_read_b64_tr_b16 a[94:95], v13 offset:25600
v_mfma_f32_16x16x32_bf16 v[136:139], a[100:103], a[56:59], v[136:139]
v_mfma_f32_16x16x32_bf16 v[144:147], a[100:103], a[60:63], v[144:147]
s_add_u32 m0, s16, 0x800
v_mfma_f32_16x16x32_bf16 v[144:147], a[96:99], a[44:47], v[144:147]
buffer_load_dwordx4 v2, s[48:51], s12 offen lds
v_mfma_f32_16x16x32_bf16 v[148:151], a[104:107], a[44:47], v[148:151]
ds_read_b64_tr_b16 a[96:97], v12 offset:16640
v_mfma_f32_16x16x32_bf16 v[148:151], a[108:111], a[60:63], v[148:151]
ds_read_b64_tr_b16 a[98:99], v12 offset:17664
v_mfma_f32_16x16x32_bf16 v[140:143], a[108:111], a[56:59], v[140:143]
ds_read_b64_tr_b16 a[100:101], v12 offset:24832
v_mfma_f32_16x16x32_bf16 v[140:143], a[104:107], a[40:43], v[140:143]
ds_read_b64_tr_b16 a[102:103], v12 offset:25856
v_mfma_f32_16x16x32_bf16 v[132:135], a[104:107], a[36:39], v[132:135]
v_mfma_f32_16x16x32_bf16 v[132:135], a[108:111], a[52:55], v[132:135]
s_add_u32 m0, s16, 0xc00
v_mfma_f32_16x16x32_bf16 v[124:127], a[108:111], a[48:51], v[124:127]
buffer_load_dwordx4 v3, s[48:51], s12 offen lds
v_mfma_f32_16x16x32_bf16 v[124:127], a[104:107], a[32:35], v[124:127]
s_waitcnt lgkmcnt(4)
v_mfma_f32_16x16x32_bf16 v[152:155], a[32:35], a[80:83], v[152:155]
ds_read_b64_tr_b16 a[104:105], v13 offset:16640
v_mfma_f32_16x16x32_bf16 v[152:155], a[48:51], a[84:87], v[152:155]
ds_read_b64_tr_b16 a[106:107], v13 offset:17664
v_mfma_f32_16x16x32_bf16 v[156:159], a[52:55], a[84:87], v[156:159]
ds_read_b64_tr_b16 a[108:109], v13 offset:24832
v_mfma_f32_16x16x32_bf16 v[156:159], a[36:39], a[80:83], v[156:159]
ds_read_b64_tr_b16 a[110:111], v13 offset:25856
v_mfma_f32_16x16x32_bf16 v[160:163], a[40:43], a[80:83], v[160:163]
s_add_u32 m0, s16, 0x1000
v_mfma_f32_16x16x32_bf16 v[160:163], a[56:59], a[84:87], v[160:163]
buffer_load_dwordx4 v2, s[48:51], s13 offen lds
v_mfma_f32_16x16x32_bf16 v[164:167], a[60:63], a[84:87], v[164:167]
v_mfma_f32_16x16x32_bf16 v[164:167], a[44:47], a[80:83], v[164:167]
v_mfma_f32_16x16x32_bf16 v[180:183], a[44:47], a[88:91], v[180:183]
ds_read_b64_tr_b16 a[80:81], v12 offset:16896
v_mfma_f32_16x16x32_bf16 v[180:183], a[60:63], a[92:95], v[180:183]
ds_read_b64_tr_b16 a[82:83], v12 offset:17920
v_mfma_f32_16x16x32_bf16 v[176:179], a[56:59], a[92:95], v[176:179]
ds_read_b64_tr_b16 a[84:85], v12 offset:25088
v_mfma_f32_16x16x32_bf16 v[176:179], a[40:43], a[88:91], v[176:179]
ds_read_b64_tr_b16 a[86:87], v12 offset:26112
s_add_u32 m0, s16, 0x1400
v_mfma_f32_16x16x32_bf16 v[172:175], a[36:39], a[88:91], v[172:175]
buffer_load_dwordx4 v3, s[48:51], s13 offen lds
v_mfma_f32_16x16x32_bf16 v[172:175], a[52:55], a[92:95], v[172:175]
v_mfma_f32_16x16x32_bf16 v[168:171], a[48:51], a[92:95], v[168:171]
v_mfma_f32_16x16x32_bf16 v[168:171], a[32:35], a[88:91], v[168:171]
s_waitcnt lgkmcnt(4)
v_mfma_f32_16x16x32_bf16 v[184:187], a[32:35], a[96:99], v[184:187]
ds_read_b64_tr_b16 a[88:89], v13 offset:16896
v_mfma_f32_16x16x32_bf16 v[184:187], a[48:51], a[100:103], v[184:187]
ds_read_b64_tr_b16 a[90:91], v13 offset:17920
v_mfma_f32_16x16x32_bf16 v[188:191], a[52:55], a[100:103], v[188:191]
ds_read_b64_tr_b16 a[92:93], v13 offset:25088
s_add_u32 m0, s16, 0x1800
v_mfma_f32_16x16x32_bf16 v[188:191], a[36:39], a[96:99], v[188:191]
buffer_load_dwordx4 v2, s[48:51], s14 offen lds
v_mfma_f32_16x16x32_bf16 v[192:195], a[40:43], a[96:99], v[192:195]
ds_read_b64_tr_b16 a[94:95], v13 offset:26112
v_mfma_f32_16x16x32_bf16 v[192:195], a[56:59], a[100:103], v[192:195]
v_mfma_f32_16x16x32_bf16 v[196:199], a[60:63], a[100:103], v[196:199]
v_mfma_f32_16x16x32_bf16 v[196:199], a[44:47], a[96:99], v[196:199]
v_mfma_f32_16x16x32_bf16 v[212:215], a[44:47], a[104:107], v[212:215]
ds_read_b64_tr_b16 a[96:97], v12 offset:17152
v_mfma_f32_16x16x32_bf16 v[212:215], a[60:63], a[108:111], v[212:215]
ds_read_b64_tr_b16 a[98:99], v12 offset:18176
s_add_u32 m0, s16, 0x1c00
v_mfma_f32_16x16x32_bf16 v[208:211], a[56:59], a[108:111], v[208:211]
buffer_load_dwordx4 v3, s[48:51], s14 offen lds
v_mfma_f32_16x16x32_bf16 v[208:211], a[40:43], a[104:107], v[208:211]
ds_read_b64_tr_b16 a[100:101], v12 offset:25344
v_lshl_add_u32 v2, s42, 7, v2
v_mfma_f32_16x16x32_bf16 v[204:207], a[36:39], a[104:107], v[204:207]
ds_read_b64_tr_b16 a[102:103], v12 offset:26368
v_lshl_add_u32 v3, s42, 7, v3
v_mfma_f32_16x16x32_bf16 v[204:207], a[52:55], a[108:111], v[204:207]
v_mfma_f32_16x16x32_bf16 v[200:203], a[48:51], a[108:111], v[200:203]
v_mfma_f32_16x16x32_bf16 v[200:203], a[32:35], a[104:107], v[200:203]
s_waitcnt lgkmcnt(4)
v_mfma_f32_16x16x32_bf16 v[216:219], a[32:35], a[80:83], v[216:219]
ds_read_b64_tr_b16 a[104:105], v13 offset:17152
s_mov_b32 s9, 0x0
v_mfma_f32_16x16x32_bf16 v[216:219], a[48:51], a[84:87], v[216:219]
buffer_load_dword a120, v18, s[52:55], s9 offen
v_mfma_f32_16x16x32_bf16 v[220:223], a[52:55], a[84:87], v[220:223]
ds_read_b64_tr_b16 a[106:107], v13 offset:18176
v_mfma_f32_16x16x32_bf16 v[220:223], a[36:39], a[80:83], v[220:223]
ds_read_b64_tr_b16 a[108:109], v13 offset:25344
v_mfma_f32_16x16x32_bf16 v[224:227], a[40:43], a[80:83], v[224:227]
ds_read_b64_tr_b16 a[110:111], v13 offset:26368
v_add_u32 v12, 0x8000, v12
v_mfma_f32_16x16x32_bf16 v[224:227], a[56:59], a[84:87], v[224:227]
v_add_u32 v13, 0x8000, v13
v_mfma_f32_16x16x32_bf16 v[228:231], a[60:63], a[84:87], v[228:231]
v_mfma_f32_16x16x32_bf16 v[228:231], a[44:47], a[80:83], v[228:231]
v_mfma_f32_16x16x32_bf16 v[244:247], a[44:47], a[88:91], v[244:247]
s_waitcnt vmcnt(27) lgkmcnt(0)
v_mfma_f32_16x16x32_bf16 v[244:247], a[60:63], a[92:95], v[244:247]
s_barrier
s_add_u32 m0, s17, 0x0
v_mfma_f32_16x16x32_bf16 v[240:243], a[56:59], a[92:95], v[240:243]
buffer_load_dwordx4 v5, s[56:59], 0 offen lds
v_mfma_f32_16x16x32_bf16 v[240:243], a[40:43], a[88:91], v[240:243]
ds_read_b64_tr_b16 a[80:81], v12 offset:0
v_mfma_f32_16x16x32_bf16 v[236:239], a[36:39], a[88:91], v[236:239]
ds_read_b64_tr_b16 a[82:83], v12 offset:1024
v_mfma_f32_16x16x32_bf16 v[236:239], a[52:55], a[92:95], v[236:239]
ds_read_b64_tr_b16 a[84:85], v12 offset:8192
v_mfma_f32_16x16x32_bf16 v[232:235], a[48:51], a[92:95], v[232:235]
ds_read_b64_tr_b16 a[86:87], v12 offset:9216
v_mfma_f32_16x16x32_bf16 v[232:235], a[32:35], a[88:91], v[232:235]
s_waitcnt lgkmcnt(4)
v_mfma_f32_16x16x32_bf16 v[248:251], a[32:35], a[96:99], v[248:251]
ds_read_b64_tr_b16 a[88:89], v13 offset:0
s_add_u32 m0, s17, 0x4000
v_mfma_f32_16x16x32_bf16 v[248:251], a[48:51], a[100:103], v[248:251]
buffer_load_dwordx4 v5, s[60:63], 0 offen lds
v_mfma_f32_16x16x32_bf16 v[252:255], a[52:55], a[100:103], v[252:255]
ds_read_b64_tr_b16 a[90:91], v13 offset:1024
L_padA2:
s_cmp_eq_u32 s95, 1
s_cbranch_scc1 L_padA6
v_mfma_f32_16x16x32_bf16 v[252:255], a[36:39], a[96:99], v[252:255]
ds_read_b64_tr_b16 a[92:93], v13 offset:8192
v_mfma_f32_16x16x32_bf16 a[232:235], a[40:43], a[96:99], a[232:235]
ds_read_b64_tr_b16 a[94:95], v13 offset:9216
v_mfma_f32_16x16x32_bf16 a[232:235], a[56:59], a[100:103], a[232:235]
v_mfma_f32_16x16x32_bf16 a[236:239], a[60:63], a[100:103], a[236:239]
v_mfma_f32_16x16x32_bf16 a[236:239], a[44:47], a[96:99], a[236:239]
s_add_u32 m0, s17, 0x400
v_mfma_f32_16x16x32_bf16 a[252:255], a[44:47], a[104:107], a[252:255]
buffer_load_dwordx4 v5, s[56:59], s13 offen lds
v_mfma_f32_16x16x32_bf16 a[252:255], a[60:63], a[108:111], a[252:255]
ds_read_b64_tr_b16 a[96:97], v12 offset:256
v_mfma_f32_16x16x32_bf16 a[248:251], a[56:59], a[108:111], a[248:251]
ds_read_b64_tr_b16 a[98:99], v12 offset:1280
v_mfma_f32_16x16x32_bf16 a[248:251], a[40:43], a[104:107], a[248:251]
ds_read_b64_tr_b16 a[100:101], v12 offset:8448
v_mfma_f32_16x16x32_bf16 a[244:247], a[36:39], a[104:107], a[244:247]
ds_read_b64_tr_b16 a[102:103], v12 offset:9472
v_mfma_f32_16x16x32_bf16 a[244:247], a[52:55], a[108:111], a[244:247]
v_mfma_f32_16x16x32_bf16 a[240:243], a[48:51], a[108:111], a[240:243]
s_add_u32 m0, s17, 0x4400
s_waitcnt lgkmcnt(4)
v_mfma_f32_16x16x32_bf16 a[240:243], a[32:35], a[104:107], a[240:243]
buffer_load_dwordx4 v5, s[60:63], s13 offen lds
L_S4:
v_mfma_f32_16x16x32_bf16 v[24:27], a[80:83], a[0:3], v[24:27]
ds_read_b64_tr_b16 a[104:105], v13 offset:256
s_waitcnt vmcnt(23)
v_mfma_f32_16x16x32_bf16 v[24:27], a[84:87], a[16:19], v[24:27]
ds_read_b64_tr_b16 a[106:107], v13 offset:1280
v_mfma_f32_16x16x32_bf16 v[32:35], a[84:87], a[20:23], v[32:35]
ds_read_b64_tr_b16 a[108:109], v13 offset:8448
v_mfma_f32_16x16x32_bf16 v[32:35], a[80:83], a[4:7], v[32:35]
ds_read_b64_tr_b16 a[110:111], v13 offset:9472
v_mfma_f32_16x16x32_bf16 v[40:43], a[80:83], a[8:11], v[40:43]
ds_read_b128 a[32:35], v8 offset:32768
v_mfma_f32_16x16x32_bf16 v[40:43], a[84:87], a[24:27], v[40:43]
ds_read_b128 a[48:51], v9 offset:32768
s_add_u32 m0, s17, 0x800
v_mfma_f32_16x16x32_bf16 v[48:51], a[84:87], a[28:31], v[48:51]
buffer_load_dwordx4 v6, s[56:59], 0 offen lds
v_mfma_f32_16x16x32_bf16 v[48:51], a[80:83], a[12:15], v[48:51]
ds_read_b128 a[36:39], v8 offset:34816
v_mfma_f32_16x16x32_bf16 v[52:55], a[88:91], a[12:15], v[52:55]
ds_read_b64_tr_b16 a[80:81], v12 offset:512
v_mfma_f32_16x16x32_bf16 v[52:55], a[92:95], a[28:31], v[52:55]
ds_read_b64_tr_b16 a[82:83], v12 offset:1536
v_mfma_f32_16x16x32_bf16 v[44:47], a[92:95], a[24:27], v[44:47]
ds_read_b64_tr_b16 a[84:85], v12 offset:8704
v_mfma_f32_16x16x32_bf16 v[44:47], a[88:91], a[8:11], v[44:47]
ds_read_b64_tr_b16 a[86:87], v12 offset:9728
v_mfma_f32_16x16x32_bf16 v[36:39], a[88:91], a[4:7], v[36:39]
ds_read_b128 a[52:55], v9 offset:34816
s_add_u32 m0, s17, 0x4800
v_mfma_f32_16x16x32_bf16 v[36:39], a[92:95], a[20:23], v[36:39]
buffer_load_dwordx4 v6, s[60:63], 0 offen lds
v_mfma_f32_16x16x32_bf16 v[28:31], a[92:95], a[16:19], v[28:31]
ds_read_b128 a[40:43], v8 offset:36864
v_mfma_f32_16x16x32_bf16 v[28:31], a[88:91], a[0:3], v[28:31]
ds_read_b128 a[56:59], v9 offset:36864
s_waitcnt lgkmcnt(10)
v_mfma_f32_16x16x32_bf16 v[56:59], a[96:99], a[0:3], v[56:59]
ds_read_b64_tr_b16 a[88:89], v13 offset:512
v_mfma_f32_16x16x32_bf16 v[56:59], a[100:103], a[16:19], v[56:59]
ds_read_b64_tr_b16 a[90:91], v13 offset:1536
v_mfma_f32_16x16x32_bf16 v[64:67], a[100:103], a[20:23], v[64:67]
ds_read_b64_tr_b16 a[92:93], v13 offset:8704
v_mfma_f32_16x16x32_bf16 v[64:67], a[96:99], a[4:7], v[64:67]
ds_read_b64_tr_b16 a[94:95], v13 offset:9728
s_add_u32 m0, s17, 0xc00
v_mfma_f32_16x16x32_bf16 v[72:75], a[96:99], a[8:11], v[72:75]
buffer_load_dwordx4 v6, s[56:59], s13 offen lds
v_mfma_f32_16x16x32_bf16 v[72:75], a[100:103], a[24:27], v[72:75]
ds_read_b128 a[44:47], v8 offset:38912
v_mfma_f32_16x16x32_bf16 v[80:83], a[100:103], a[28:31], v[80:83]
ds_read_b128 a[60:63], v9 offset:38912
v_mfma_f32_16x16x32_bf16 v[80:83], a[96:99], a[12:15], v[80:83]
v_mfma_f32_16x16x32_bf16 v[84:87], a[104:107], a[12:15], v[84:87]
ds_read_b64_tr_b16 a[96:97], v12 offset:768
v_mfma_f32_16x16x32_bf16 v[84:87], a[108:111], a[28:31], v[84:87]
ds_read_b64_tr_b16 a[98:99], v12 offset:1792
v_mfma_f32_16x16x32_bf16 v[76:79], a[108:111], a[24:27], v[76:79]
ds_read_b64_tr_b16 a[100:101], v12 offset:8960
s_add_u32 m0, s17, 0x4c00
v_mfma_f32_16x16x32_bf16 v[76:79], a[104:107], a[8:11], v[76:79]
buffer_load_dwordx4 v6, s[60:63], s13 offen lds
v_mfma_f32_16x16x32_bf16 v[68:71], a[104:107], a[4:7], v[68:71]
ds_read_b64_tr_b16 a[102:103], v12 offset:9984
v_lshl_add_u32 v5, s42, 19, v5
v_mfma_f32_16x16x32_bf16 v[68:71], a[108:111], a[20:23], v[68:71]
v_lshl_add_u32 v6, s42, 19, v6
v_mfma_f32_16x16x32_bf16 v[60:63], a[108:111], a[16:19], v[60:63]
v_mfma_f32_16x16x32_bf16 v[60:63], a[104:107], a[0:3], v[60:63]
s_waitcnt lgkmcnt(6)
v_mfma_f32_16x16x32_bf16 v[88:91], a[80:83], a[0:3], v[88:91]
ds_read_b64_tr_b16 a[104:105], v13 offset:768
v_mfma_f32_16x16x32_bf16 v[88:91], a[84:87], a[16:19], v[88:91]
ds_read_b64_tr_b16 a[106:107], v13 offset:1792
s_mov_b32 s9, 0x0
v_mfma_f32_16x16x32_bf16 v[96:99], a[84:87], a[20:23], v[96:99]
buffer_load_dword a120, v1, s[68:71], s9 offen
v_mfma_f32_16x16x32_bf16 v[96:99], a[80:83], a[4:7], v[96:99]
ds_read_b64_tr_b16 a[108:109], v13 offset:8960
v_mfma_f32_16x16x32_bf16 v[104:107], a[80:83], a[8:11], v[104:107]
ds_read_b64_tr_b16 a[110:111], v13 offset:9984
v_mfma_f32_16x16x32_bf16 v[104:107], a[84:87], a[24:27], v[104:107]
v_mfma_f32_16x16x32_bf16 v[112:115], a[84:87], a[28:31], v[112:115]
v_mfma_f32_16x16x32_bf16 v[112:115], a[80:83], a[12:15], v[112:115]
s_waitcnt lgkmcnt(8)
v_mfma_f32_16x16x32_bf16 v[116:119], a[88:91], a[12:15], v[116:119]
ds_read_b64_tr_b16 a[80:81], v12 offset:16384
s_add_u32 m0, s16, 0x8000
v_mfma_f32_16x16x32_bf16 v[116:119], a[92:95], a[28:31], v[116:119]
buffer_load_dwordx4 v2, s[48:51], 0 offen lds
v_mfma_f32_16x16x32_bf16 v[108:111], a[92:95], a[24:27], v[108:111]
ds_read_b64_tr_b16 a[82:83], v12 offset:17408
v_mfma_f32_16x16x32_bf16 v[108:111], a[88:91], a[8:11], v[108:111]
ds_read_b64_tr_b16 a[84:85], v12 offset:24576
v_mfma_f32_16x16x32_bf16 v[100:103], a[88:91], a[4:7], v[100:103]
ds_read_b64_tr_b16 a[86:87], v12 offset:25600
v_mfma_f32_16x16x32_bf16 v[100:103], a[92:95], a[20:23], v[100:103]
v_mfma_f32_16x16x32_bf16 v[92:95], a[92:95], a[16:19], v[92:95]
v_mfma_f32_16x16x32_bf16 v[92:95], a[88:91], a[0:3], v[92:95]
s_add_u32 m0, s16, 0x8400
s_waitcnt lgkmcnt(4)
v_mfma_f32_16x16x32_bf16 v[120:123], a[96:99], a[0:3], v[120:123]
buffer_load_dwordx4 v3, s[48:51], 0 offen lds
v_mfma_f32_16x16x32_bf16 v[120:123], a[100:103], a[16:19], v[120:123]
ds_read_b64_tr_b16 a[88:89], v13 offset:16384
v_mfma_f32_16x16x32_bf16 v[128:131], a[100:103], a[20:23], v[128:131]
ds_read_b64_tr_b16 a[90:91], v13 offset:17408
v_mfma_f32_16x16x32_bf16 v[128:131], a[96:99], a[4:7], v[128:131]
ds_read_b64_tr_b16 a[92:93], v13 offset:24576
v_mfma_f32_16x16x32_bf16 v[136:139], a[96:99], a[8:11], v[136:139]
ds_read_b64_tr_b16 a[94:95], v13 offset:25600
v_mfma_f32_16x16x32_bf16 v[136:139], a[100:103], a[24:27], v[136:139]
v_mfma_f32_16x16x32_bf16 v[144:147], a[100:103], a[28:31], v[144:147]
s_add_u32 m0, s16, 0x8800
v_mfma_f32_16x16x32_bf16 v[144:147], a[96:99], a[12:15], v[144:147]
buffer_load_dwordx4 v2, s[48:51], s12 offen lds
v_mfma_f32_16x16x32_bf16 v[148:151], a[104:107], a[12:15], v[148:151]
ds_read_b64_tr_b16 a[96:97], v12 offset:16640
v_mfma_f32_16x16x32_bf16 v[148:151], a[108:111], a[28:31], v[148:151]
ds_read_b64_tr_b16 a[98:99], v12 offset:17664
v_mfma_f32_16x16x32_bf16 v[140:143], a[108:111], a[24:27], v[140:143]
ds_read_b64_tr_b16 a[100:101], v12 offset:24832
v_mfma_f32_16x16x32_bf16 v[140:143], a[104:107], a[8:11], v[140:143]
ds_read_b64_tr_b16 a[102:103], v12 offset:25856
v_mfma_f32_16x16x32_bf16 v[132:135], a[104:107], a[4:7], v[132:135]
v_mfma_f32_16x16x32_bf16 v[132:135], a[108:111], a[20:23], v[132:135]
s_add_u32 m0, s16, 0x8c00
v_mfma_f32_16x16x32_bf16 v[124:127], a[108:111], a[16:19], v[124:127]
buffer_load_dwordx4 v3, s[48:51], s12 offen lds
v_mfma_f32_16x16x32_bf16 v[124:127], a[104:107], a[0:3], v[124:127]
s_waitcnt lgkmcnt(4)
v_mfma_f32_16x16x32_bf16 v[152:155], a[0:3], a[80:83], v[152:155]
ds_read_b64_tr_b16 a[104:105], v13 offset:16640
v_mfma_f32_16x16x32_bf16 v[152:155], a[16:19], a[84:87], v[152:155]
ds_read_b64_tr_b16 a[106:107], v13 offset:17664
v_mfma_f32_16x16x32_bf16 v[156:159], a[20:23], a[84:87], v[156:159]
ds_read_b64_tr_b16 a[108:109], v13 offset:24832
v_mfma_f32_16x16x32_bf16 v[156:159], a[4:7], a[80:83], v[156:159]
ds_read_b64_tr_b16 a[110:111], v13 offset:25856
v_mfma_f32_16x16x32_bf16 v[160:163], a[8:11], a[80:83], v[160:163]
s_add_u32 m0, s16, 0x9000
v_mfma_f32_16x16x32_bf16 v[160:163], a[24:27], a[84:87], v[160:163]
buffer_load_dwordx4 v2, s[48:51], s13 offen lds
v_mfma_f32_16x16x32_bf16 v[164:167], a[28:31], a[84:87], v[164:167]
v_mfma_f32_16x16x32_bf16 v[164:167], a[12:15], a[80:83], v[164:167]
v_mfma_f32_16x16x32_bf16 v[180:183], a[12:15], a[88:91], v[180:183]
ds_read_b64_tr_b16 a[80:81], v12 offset:16896
v_mfma_f32_16x16x32_bf16 v[180:183], a[28:31], a[92:95], v[180:183]
ds_read_b64_tr_b16 a[82:83], v12 offset:17920
v_mfma_f32_16x16x32_bf16 v[176:179], a[24:27], a[92:95], v[176:179]
ds_read_b64_tr_b16 a[84:85], v12 offset:25088
v_mfma_f32_16x16x32_bf16 v[176:179], a[8:11], a[88:91], v[176:179]
ds_read_b64_tr_b16 a[86:87], v12 offset:26112
s_add_u32 m0, s16, 0x9400
v_mfma_f32_16x16x32_bf16 v[172:175], a[4:7], a[88:91], v[172:175]
buffer_load_dwordx4 v3, s[48:51], s13 offen lds
v_mfma_f32_16x16x32_bf16 v[172:175], a[20:23], a[92:95], v[172:175]
v_mfma_f32_16x16x32_bf16 v[168:171], a[16:19], a[92:95], v[168:171]
v_mfma_f32_16x16x32_bf16 v[168:171], a[0:3], a[88:91], v[168:171]
s_waitcnt lgkmcnt(4)
v_mfma_f32_16x16x32_bf16 v[184:187], a[0:3], a[96:99], v[184:187]
ds_read_b64_tr_b16 a[88:89], v13 offset:16896
v_mfma_f32_16x16x32_bf16 v[184:187], a[16:19], a[100:103], v[184:187]
ds_read_b64_tr_b16 a[90:91], v13 offset:17920
v_mfma_f32_16x16x32_bf16 v[188:191], a[20:23], a[100:103], v[188:191]
ds_read_b64_tr_b16 a[92:93], v13 offset:25088
s_add_u32 m0, s16, 0x9800
v_mfma_f32_16x16x32_bf16 v[188:191], a[4:7], a[96:99], v[188:191]
buffer_load_dwordx4 v2, s[48:51], s14 offen lds
v_mfma_f32_16x16x32_bf16 v[192:195], a[8:11], a[96:99], v[192:195]
ds_read_b64_tr_b16 a[94:95], v13 offset:26112
v_mfma_f32_16x16x32_bf16 v[192:195], a[24:27], a[100:103], v[192:195]
v_mfma_f32_16x16x32_bf16 v[196:199], a[28:31], a[100:103], v[196:199]
v_mfma_f32_16x16x32_bf16 v[196:199], a[12:15], a[96:99], v[196:199]
v_mfma_f32_16x16x32_bf16 v[212:215], a[12:15], a[104:107], v[212:215]
ds_read_b64_tr_b16 a[96:97], v12 offset:17152
v_mfma_f32_16x16x32_bf16 v[212:215], a[28:31], a[108:111], v[212:215]
ds_read_b64_tr_b16 a[98:99], v12 offset:18176
s_add_u32 m0, s16, 0x9c00
v_mfma_f32_16x16x32_bf16 v[208:211], a[24:27], a[108:111], v[208:211]
buffer_load_dwordx4 v3, s[48:51], s14 offen lds
v_mfma_f32_16x16x32_bf16 v[208:211], a[8:11], a[104:107], v[208:211]
ds_read_b64_tr_b16 a[100:101], v12 offset:25344
s_sub_u32 s42, s43, s41
v_mfma_f32_16x16x32_bf16 v[204:207], a[4:7], a[104:107], v[204:207]
ds_read_b64_tr_b16 a[102:103], v12 offset:26368
s_mov_b32 s41, s43
v_mfma_f32_16x16x32_bf16 v[204:207], a[20:23], a[108:111], v[204:207]
v_mfma_f32_16x16x32_bf16 v[200:203], a[16:19], a[108:111], v[200:203]
v_mfma_f32_16x16x32_bf16 v[200:203], a[0:3], a[104:107], v[200:203]
s_waitcnt lgkmcnt(4)
v_mfma_f32_16x16x32_bf16 v[216:219], a[0:3], a[80:83], v[216:219]
ds_read_b64_tr_b16 a[104:105], v13 offset:17152
s_mov_b32 s9, 0x800
v_mfma_f32_16x16x32_bf16 v[216:219], a[16:19], a[84:87], v[216:219]
buffer_load_dword a120, v1, s[68:71], s9 offen
v_mfma_f32_16x16x32_bf16 v[220:223], a[20:23], a[84:87], v[220:223]
ds_read_b64_tr_b16 a[106:107], v13 offset:18176
v_mfma_f32_16x16x32_bf16 v[220:223], a[4:7], a[80:83], v[220:223]
ds_read_b64_tr_b16 a[108:109], v13 offset:25344
v_mfma_f32_16x16x32_bf16 v[224:227], a[8:11], a[80:83], v[224:227]
ds_read_b64_tr_b16 a[110:111], v13 offset:26368
v_add_u32 v12, 0x8000, v12
v_mfma_f32_16x16x32_bf16 v[224:227], a[24:27], a[84:87], v[224:227]
v_add_u32 v13, 0x8000, v13
v_mfma_f32_16x16x32_bf16 v[228:231], a[28:31], a[84:87], v[228:231]
v_mfma_f32_16x16x32_bf16 v[228:231], a[12:15], a[80:83], v[228:231]
v_mfma_f32_16x16x32_bf16 v[244:247], a[12:15], a[88:91], v[244:247]
s_waitcnt vmcnt(28) lgkmcnt(0)
v_mfma_f32_16x16x32_bf16 v[244:247], a[28:31], a[92:95], v[244:247]
s_barrier
s_add_u32 m0, s17, 0x8000
v_mfma_f32_16x16x32_bf16 v[240:243], a[24:27], a[92:95], v[240:243]
buffer_load_dwordx4 v5, s[56:59], 0 offen lds
v_mfma_f32_16x16x32_bf16 v[240:243], a[8:11], a[88:91], v[240:243]
ds_read_b64_tr_b16 a[80:81], v12 offset:0
v_mfma_f32_16x16x32_bf16 v[236:239], a[4:7], a[88:91], v[236:239]
ds_read_b64_tr_b16 a[82:83], v12 offset:1024
v_mfma_f32_16x16x32_bf16 v[236:239], a[20:23], a[92:95], v[236:239]
ds_read_b64_tr_b16 a[84:85], v12 offset:8192
v_mfma_f32_16x16x32_bf16 v[232:235], a[16:19], a[92:95], v[232:235]
ds_read_b64_tr_b16 a[86:87], v12 offset:9216
v_mfma_f32_16x16x32_bf16 v[232:235], a[0:3], a[88:91], v[232:235]
s_waitcnt lgkmcnt(4)
v_mfma_f32_16x16x32_bf16 v[248:251], a[0:3], a[96:99], v[248:251]
ds_read_b64_tr_b16 a[88:89], v13 offset:0
s_add_u32 m0, s17, 0xc000
v_mfma_f32_16x16x32_bf16 v[248:251], a[16:19], a[100:103], v[248:251]
buffer_load_dwordx4 v5, s[60:63], 0 offen lds
v_mfma_f32_16x16x32_bf16 v[252:255], a[20:23], a[100:103], v[252:255]
ds_read_b64_tr_b16 a[90:91], v13 offset:1024
v_mfma_f32_16x16x32_bf16 v[252:255], a[4:7], a[96:99], v[252:255]
ds_read_b64_tr_b16 a[92:93], v13 offset:8192
v_mfma_f32_16x16x32_bf16 a[232:235], a[8:11], a[96:99], a[232:235]
ds_read_b64_tr_b16 a[94:95], v13 offset:9216
v_mfma_f32_16x16x32_bf16 a[232:235], a[24:27], a[100:103], a[232:235]
v_mfma_f32_16x16x32_bf16 a[236:239], a[28:31], a[100:103], a[236:239]
v_mfma_f32_16x16x32_bf16 a[236:239], a[12:15], a[96:99], a[236:239]
s_add_u32 m0, s17, 0x8400
v_mfma_f32_16x16x32_bf16 a[252:255], a[12:15], a[104:107], a[252:255]
buffer_load_dwordx4 v5, s[56:59], s13 offen lds
v_mfma_f32_16x16x32_bf16 a[252:255], a[28:31], a[108:111], a[252:255]
ds_read_b64_tr_b16 a[96:97], v12 offset:256
v_mfma_f32_16x16x32_bf16 a[248:251], a[24:27], a[108:111], a[248:251]
ds_read_b64_tr_b16 a[98:99], v12 offset:1280
v_mfma_f32_16x16x32_bf16 a[248:251], a[8:11], a[104:107], a[248:251]
ds_read_b64_tr_b16 a[100:101], v12 offset:8448
v_mfma_f32_16x16x32_bf16 a[244:247], a[4:7], a[104:107], a[244:247]
ds_read_b64_tr_b16 a[102:103], v12 offset:9472
v_mfma_f32_16x16x32_bf16 a[244:247], a[20:23], a[108:111], a[244:247]
v_mfma_f32_16x16x32_bf16 a[240:243], a[16:19], a[108:111], a[240:243]
v_mfma_f32_16x16x32_bf16 a[240:243], a[0:3], a[104:107], a[240:243]
s_add_u32 m0, s17, 0xc400
s_waitcnt lgkmcnt(4)
L_S5:
v_mfma_f32_16x16x32_bf16 v[24:27], a[80:83], a[32:35], v[24:27]
buffer_load_dwordx4 v5, s[60:63], s13 offen lds
v_mfma_f32_16x16x32_bf16 v[24:27], a[84:87], a[48:51], v[24:27]
ds_read_b64_tr_b16 a[104:105], v13 offset:256
s_waitcnt vmcnt(23)
v_mfma_f32_16x16x32_bf16 v[32:35], a[84:87], a[52:55], v[32:35]
ds_read_b64_tr_b16 a[106:107], v13 offset:1280
v_mfma_f32_16x16x32_bf16 v[32:35], a[80:83], a[36:39], v[32:35]
ds_read_b64_tr_b16 a[108:109], v13 offset:8448
v_mfma_f32_16x16x32_bf16 v[40:43], a[80:83], a[40:43], v[40:43]
ds_read_b64_tr_b16 a[110:111], v13 offset:9472
v_mfma_f32_16x16x32_bf16 v[40:43], a[84:87], a[56:59], v[40:43]
ds_read_b128 a[0:3], v8 offset:0
v_mfma_f32_16x16x32_bf16 v[48:51], a[84:87], a[60:63], v[48:51]
ds_read_b128 a[16:19], v9 offset:0
s_add_u32 m0, s17, 0x8800
v_mfma_f32_16x16x32_bf16 v[48:51], a[80:83], a[44:47], v[48:51]
buffer_load_dwordx4 v6, s[56:59], 0 offen lds
v_mfma_f32_16x16x32_bf16 v[52:55], a[88:91], a[44:47], v[52:55]
ds_read_b64_tr_b16 a[80:81], v12 offset:512
v_mfma_f32_16x16x32_bf16 v[52:55], a[92:95], a[60:63], v[52:55]
ds_read_b64_tr_b16 a[82:83], v12 offset:1536
v_mfma_f32_16x16x32_bf16 v[44:47], a[92:95], a[56:59], v[44:47]
ds_read_b64_tr_b16 a[84:85], v12 offset:8704
v_mfma_f32_16x16x32_bf16 v[44:47], a[88:91], a[40:43], v[44:47]
ds_read_b64_tr_b16 a[86:87], v12 offset:9728
v_mfma_f32_16x16x32_bf16 v[36:39], a[88:91], a[36:39], v[36:39]
ds_read_b128 a[4:7], v8 offset:2048
v_mfma_f32_16x16x32_bf16 v[36:39], a[92:95], a[52:55], v[36:39]
ds_read_b128 a[20:23], v9 offset:2048
s_waitcnt lgkmcnt(8)
v_mfma_f32_16x16x32_bf16 v[28:31], a[92:95], a[48:51], v[28:31]
ds_read_b128 a[8:11], v8 offset:4096
s_add_u32 m0, s17, 0xc800
v_mfma_f32_16x16x32_bf16 v[28:31], a[88:91], a[32:35], v[28:31]
buffer_load_dwordx4 v6, s[60:63], 0 offen lds
v_mfma_f32_16x16x32_bf16 v[56:59], a[96:99], a[32:35], v[56:59]
ds_read_b64_tr_b16 a[88:89], v13 offset:512
v_mfma_f32_16x16x32_bf16 v[56:59], a[100:103], a[48:51], v[56:59]
ds_read_b64_tr_b16 a[90:91], v13 offset:1536
v_mfma_f32_16x16x32_bf16 v[64:67], a[100:103], a[52:55], v[64:67]
ds_read_b64_tr_b16 a[92:93], v13 offset:8704
v_mfma_f32_16x16x32_bf16 v[64:67], a[96:99], a[36:39], v[64:67]
ds_read_b64_tr_b16 a[94:95], v13 offset:9728
v_mfma_f32_16x16x32_bf16 v[72:75], a[96:99], a[40:43], v[72:75]
ds_read_b128 a[24:27], v9 offset:4096
v_mfma_f32_16x16x32_bf16 v[72:75], a[100:103], a[56:59], v[72:75]
ds_read_b128 a[12:15], v8 offset:6144
s_add_u32 m0, s17, 0x8c00
v_mfma_f32_16x16x32_bf16 v[80:83], a[100:103], a[60:63], v[80:83]
buffer_load_dwordx4 v6, s[56:59], s13 offen lds
v_mfma_f32_16x16x32_bf16 v[80:83], a[96:99], a[44:47], v[80:83]
ds_read_b128 a[28:31], v9 offset:6144
v_mfma_f32_16x16x32_bf16 v[84:87], a[104:107], a[44:47], v[84:87]
ds_read_b64_tr_b16 a[96:97], v12 offset:768
v_mfma_f32_16x16x32_bf16 v[84:87], a[108:111], a[60:63], v[84:87]
ds_read_b64_tr_b16 a[98:99], v12 offset:1792
v_mfma_f32_16x16x32_bf16 v[76:79], a[108:111], a[56:59], v[76:79]
ds_read_b64_tr_b16 a[100:101], v12 offset:8960
v_mfma_f32_16x16x32_bf16 v[76:79], a[104:107], a[40:43], v[76:79]
ds_read_b64_tr_b16 a[102:103], v12 offset:9984
v_mfma_f32_16x16x32_bf16 v[68:71], a[104:107], a[36:39], v[68:71]
s_add_u32 m0, s17, 0xcc00
v_mfma_f32_16x16x32_bf16 v[68:71], a[108:111], a[52:55], v[68:71]
buffer_load_dwordx4 v6, s[60:63], s13 offen lds
v_mfma_f32_16x16x32_bf16 v[60:63], a[108:111], a[48:51], v[60:63]
v_lshl_add_u32 v5, s42, 19, v5
v_lshl_add_u32 v6, s42, 19, v6
v_mfma_f32_16x16x32_bf16 v[60:63], a[104:107], a[32:35], v[60:63]
s_waitcnt lgkmcnt(7)
v_mfma_f32_16x16x32_bf16 v[88:91], a[80:83], a[32:35], v[88:91]
ds_read_b64_tr_b16 a[104:105], v13 offset:768
v_mfma_f32_16x16x32_bf16 v[88:91], a[84:87], a[48:51], v[88:91]
ds_read_b64_tr_b16 a[106:107], v13 offset:1792
v_mfma_f32_16x16x32_bf16 v[96:99], a[84:87], a[52:55], v[96:99]
ds_read_b64_tr_b16 a[108:109], v13 offset:8960
v_mfma_f32_16x16x32_bf16 v[96:99], a[80:83], a[36:39], v[96:99]
ds_read_b64_tr_b16 a[110:111], v13 offset:9984
v_mfma_f32_16x16x32_bf16 v[104:107], a[80:83], a[40:43], v[104:107]
s_add_u32 m0, s16, 0x0
s_waitcnt lgkmcnt(8)
v_mfma_f32_16x16x32_bf16 v[104:107], a[84:87], a[56:59], v[104:107]
buffer_load_dwordx4 v22, s[44:47], s20 offen lds
v_mfma_f32_16x16x32_bf16 v[112:115], a[84:87], a[60:63], v[112:115]
v_mfma_f32_16x16x32_bf16 v[112:115], a[80:83], a[44:47], v[112:115]
v_mfma_f32_16x16x32_bf16 v[116:119], a[88:91], a[44:47], v[116:119]
ds_read_b64_tr_b16 a[80:81], v12 offset:16384
v_mfma_f32_16x16x32_bf16 v[116:119], a[92:95], a[60:63], v[116:119]
ds_read_b64_tr_b16 a[82:83], v12 offset:17408
v_mfma_f32_16x16x32_bf16 v[108:111], a[92:95], a[56:59], v[108:111]
ds_read_b64_tr_b16 a[84:85], v12 offset:24576
v_mfma_f32_16x16x32_bf16 v[108:111], a[88:91], a[40:43], v[108:111]
ds_read_b64_tr_b16 a[86:87], v12 offset:25600
s_add_u32 m0, s16, 0x400
v_mfma_f32_16x16x32_bf16 v[100:103], a[88:91], a[36:39], v[100:103]
buffer_load_dwordx4 v23, s[44:47], s20 offen lds
v_mfma_f32_16x16x32_bf16 v[100:103], a[92:95], a[52:55], v[100:103]
v_mfma_f32_16x16x32_bf16 v[92:95], a[92:95], a[48:51], v[92:95]
v_mfma_f32_16x16x32_bf16 v[92:95], a[88:91], a[32:35], v[92:95]
s_waitcnt lgkmcnt(4)
v_mfma_f32_16x16x32_bf16 v[120:123], a[96:99], a[32:35], v[120:123]
ds_read_b64_tr_b16 a[88:89], v13 offset:16384
v_mfma_f32_16x16x32_bf16 v[120:123], a[100:103], a[48:51], v[120:123]
ds_read_b64_tr_b16 a[90:91], v13 offset:17408
v_mfma_f32_16x16x32_bf16 v[128:131], a[100:103], a[52:55], v[128:131]
ds_read_b64_tr_b16 a[92:93], v13 offset:24576
v_mfma_f32_16x16x32_bf16 v[128:131], a[96:99], a[36:39], v[128:131]
ds_read_b64_tr_b16 a[94:95], v13 offset:25600
s_add_u32 m0, s16, 0x800
v_mfma_f32_16x16x32_bf16 v[136:139], a[96:99], a[40:43], v[136:139]
buffer_load_dwordx4 v22, s[44:47], s21 offen lds
v_mfma_f32_16x16x32_bf16 v[136:139], a[100:103], a[56:59], v[136:139]
v_mfma_f32_16x16x32_bf16 v[144:147], a[100:103], a[60:63], v[144:147]
v_mfma_f32_16x16x32_bf16 v[144:147], a[96:99], a[44:47], v[144:147]
v_mfma_f32_16x16x32_bf16 v[148:151], a[104:107], a[44:47], v[148:151]
ds_read_b64_tr_b16 a[96:97], v12 offset:16640
v_mfma_f32_16x16x32_bf16 v[148:151], a[108:111], a[60:63], v[148:151]
ds_read_b64_tr_b16 a[98:99], v12 offset:17664
v_mfma_f32_16x16x32_bf16 v[140:143], a[108:111], a[56:59], v[140:143]
ds_read_b64_tr_b16 a[100:101], v12 offset:24832
s_add_u32 m0, s16, 0xc00
v_mfma_f32_16x16x32_bf16 v[140:143], a[104:107], a[40:43], v[140:143]
buffer_load_dwordx4 v23, s[44:47], s21 offen lds
v_mfma_f32_16x16x32_bf16 v[132:135], a[104:107], a[36:39], v[132:135]
ds_read_b64_tr_b16 a[102:103], v12 offset:25856
v_mfma_f32_16x16x32_bf16 v[132:135], a[108:111], a[52:55], v[132:135]
v_mfma_f32_16x16x32_bf16 v[124:127], a[108:111], a[48:51], v[124:127]
v_mfma_f32_16x16x32_bf16 v[124:127], a[104:107], a[32:35], v[124:127]
s_waitcnt lgkmcnt(4)
v_mfma_f32_16x16x32_bf16 v[152:155], a[32:35], a[80:83], v[152:155]
ds_read_b64_tr_b16 a[104:105], v13 offset:16640
v_mfma_f32_16x16x32_bf16 v[152:155], a[48:51], a[84:87], v[152:155]
ds_read_b64_tr_b16 a[106:107], v13 offset:17664
s_add_u32 m0, s16, 0x1000
v_mfma_f32_16x16x32_bf16 v[156:159], a[52:55], a[84:87], v[156:159]
buffer_load_dwordx4 v22, s[44:47], s22 offen lds
v_mfma_f32_16x16x32_bf16 v[156:159], a[36:39], a[80:83], v[156:159]
ds_read_b64_tr_b16 a[108:109], v13 offset:24832
v_mfma_f32_16x16x32_bf16 v[160:163], a[40:43], a[80:83], v[160:163]
ds_read_b64_tr_b16 a[110:111], v13 offset:25856
v_mfma_f32_16x16x32_bf16 v[160:163], a[56:59], a[84:87], v[160:163]
v_mfma_f32_16x16x32_bf16 v[164:167], a[60:63], a[84:87], v[164:167]
v_mfma_f32_16x16x32_bf16 v[164:167], a[44:47], a[80:83], v[164:167]
v_mfma_f32_16x16x32_bf16 v[180:183], a[44:47], a[88:91], v[180:183]
ds_read_b64_tr_b16 a[80:81], v12 offset:16896
v_mfma_f32_16x16x32_bf16 v[180:183], a[60:63], a[92:95], v[180:183]
ds_read_b64_tr_b16 a[82:83], v12 offset:17920
s_add_u32 m0, s16, 0x1400
v_mfma_f32_16x16x32_bf16 v[176:179], a[56:59], a[92:95], v[176:179]
buffer_load_dwordx4 v23, s[44:47], s22 offen lds
v_mfma_f32_16x16x32_bf16 v[176:179], a[40:43], a[88:91], v[176:179]
ds_read_b64_tr_b16 a[84:85], v12 offset:25088
v_mfma_f32_16x16x32_bf16 v[172:175], a[36:39], a[88:91], v[172:175]
ds_read_b64_tr_b16 a[86:87], v12 offset:26112
v_mfma_f32_16x16x32_bf16 v[172:175], a[52:55], a[92:95], v[172:175]
v_mfma_f32_16x16x32_bf16 v[168:171], a[48:51], a[92:95], v[168:171]
v_mfma_f32_16x16x32_bf16 v[168:171], a[32:35], a[88:91], v[168:171]
s_waitcnt lgkmcnt(4)
v_mfma_f32_16x16x32_bf16 v[184:187], a[32:35], a[96:99], v[184:187]
ds_read_b64_tr_b16 a[88:89], v13 offset:16896
s_add_u32 m0, s16, 0x1800
v_mfma_f32_16x16x32_bf16 v[184:187], a[48:51], a[100:103], v[184:187]
buffer_load_dwordx4 v22, s[44:47], s23 offen lds
v_mfma_f32_16x16x32_bf16 v[188:191], a[52:55], a[100:103], v[188:191]
ds_read_b64_tr_b16 a[90:91], v13 offset:17920
v_mfma_f32_16x16x32_bf16 v[188:191], a[36:39], a[96:99], v[188:191]
ds_read_b64_tr_b16 a[92:93], v13 offset:25088
v_mfma_f32_16x16x32_bf16 v[192:195], a[40:43], a[96:99], v[192:195]
ds_read_b64_tr_b16 a[94:95], v13 offset:26112
v_mfma_f32_16x16x32_bf16 v[192:195], a[56:59], a[100:103], v[192:195]
v_mfma_f32_16x16x32_bf16 v[196:199], a[60:63], a[100:103], v[196:199]
v_mfma_f32_16x16x32_bf16 v[196:199], a[44:47], a[96:99], v[196:199]
v_mfma_f32_16x16x32_bf16 v[212:215], a[44:47], a[104:107], v[212:215]
ds_read_b64_tr_b16 a[96:97], v12 offset:17152
s_add_u32 m0, s16, 0x1c00
v_mfma_f32_16x16x32_bf16 v[212:215], a[60:63], a[108:111], v[212:215]
buffer_load_dwordx4 v23, s[44:47], s23 offen lds
v_mfma_f32_16x16x32_bf16 v[208:211], a[56:59], a[108:111], v[208:211]
ds_read_b64_tr_b16 a[98:99], v12 offset:18176
s_mov_b32 s42, 1
v_mfma_f32_16x16x32_bf16 v[208:211], a[40:43], a[104:107], v[208:211]
ds_read_b64_tr_b16 a[100:101], v12 offset:25344
v_lshl_add_u32 v22, s42, 7, v22
v_mfma_f32_16x16x32_bf16 v[204:207], a[36:39], a[104:107], v[204:207]
ds_read_b64_tr_b16 a[102:103], v12 offset:26368
v_lshl_add_u32 v23, s42, 7, v23
v_mfma_f32_16x16x32_bf16 v[204:207], a[52:55], a[108:111], v[204:207]
v_mfma_f32_16x16x32_bf16 v[200:203], a[48:51], a[108:111], v[200:203]
v_mfma_f32_16x16x32_bf16 v[200:203], a[32:35], a[104:107], v[200:203]
s_mov_b32 s9, 0x1000
s_waitcnt lgkmcnt(4)
v_mfma_f32_16x16x32_bf16 v[216:219], a[32:35], a[80:83], v[216:219]
buffer_load_dword a120, v1, s[68:71], s9 offen
v_mfma_f32_16x16x32_bf16 v[216:219], a[48:51], a[84:87], v[216:219]
ds_read_b64_tr_b16 a[104:105], v13 offset:17152
v_mfma_f32_16x16x32_bf16 v[220:223], a[52:55], a[84:87], v[220:223]
ds_read_b64_tr_b16 a[106:107], v13 offset:18176
v_mfma_f32_16x16x32_bf16 v[220:223], a[36:39], a[80:83], v[220:223]
ds_read_b64_tr_b16 a[108:109], v13 offset:25344
v_mfma_f32_16x16x32_bf16 v[224:227], a[40:43], a[80:83], v[224:227]
ds_read_b64_tr_b16 a[110:111], v13 offset:26368
v_add_u32 v12, 0xffff0000, v12
v_mfma_f32_16x16x32_bf16 v[224:227], a[56:59], a[84:87], v[224:227]
v_add_u32 v13, 0xffff0000, v13
v_mfma_f32_16x16x32_bf16 v[228:231], a[60:63], a[84:87], v[228:231]
v_mfma_f32_16x16x32_bf16 v[228:231], a[44:47], a[80:83], v[228:231]
v_mfma_f32_16x16x32_bf16 v[244:247], a[44:47], a[88:91], v[244:247]
s_waitcnt vmcnt(27) lgkmcnt(0)
v_mfma_f32_16x16x32_bf16 v[244:247], a[60:63], a[92:95], v[244:247]
s_barrier
s_add_u32 m0, s17, 0x10000
v_mfma_f32_16x16x32_bf16 v[240:243], a[56:59], a[92:95], v[240:243]
buffer_load_dwordx4 v5, s[52:55], 0 offen lds
v_mfma_f32_16x16x32_bf16 v[240:243], a[40:43], a[88:91], v[240:243]
ds_read_b64_tr_b16 a[80:81], v12 offset:0
s_mul_i32 s28, s5, 0x10c400
v_mfma_f32_16x16x32_bf16 v[236:239], a[36:39], a[88:91], v[236:239]
ds_read_b64_tr_b16 a[82:83], v12 offset:1024
s_mov_b32 s48, s88
v_mfma_f32_16x16x32_bf16 v[236:239], a[52:55], a[92:95], v[236:239]
ds_read_b64_tr_b16 a[84:85], v12 offset:8192
s_mov_b32 s49, s89
v_mfma_f32_16x16x32_bf16 v[232:235], a[48:51], a[92:95], v[232:235]
ds_read_b64_tr_b16 a[86:87], v12 offset:9216
s_sub_u32 s11, 16, s6
v_mfma_f32_16x16x32_bf16 v[232:235], a[32:35], a[88:91], v[232:235]
s_waitcnt lgkmcnt(4)
s_lshl_b32 s11, s11, 16
s_add_u32 s11, s11, s28
v_mfma_f32_16x16x32_bf16 v[248:251], a[32:35], a[96:99], v[248:251]
ds_read_b64_tr_b16 a[88:89], v13 offset:0
s_add_u32 m0, s17, 0x10400
v_mfma_f32_16x16x32_bf16 v[248:251], a[48:51], a[100:103], v[248:251]
buffer_load_dwordx4 v5, s[52:55], s13 offen lds
v_mfma_f32_16x16x32_bf16 v[252:255], a[52:55], a[100:103], v[252:255]
ds_read_b64_tr_b16 a[90:91], v13 offset:1024
s_add_u32 s50, s11, 0x2000
v_mfma_f32_16x16x32_bf16 v[252:255], a[36:39], a[96:99], v[252:255]
ds_read_b64_tr_b16 a[92:93], v13 offset:8192
s_lshl_b32 s11, s6, 17
v_mfma_f32_16x16x32_bf16 a[232:235], a[40:43], a[96:99], a[232:235]
ds_read_b64_tr_b16 a[94:95], v13 offset:9216
s_add_u32 s28, s28, s11
v_mfma_f32_16x16x32_bf16 a[232:235], a[56:59], a[100:103], a[232:235]
s_lshl_b32 s11, s4, 15
s_add_u32 s28, s28, s11
s_lshl_b32 s10, s5, 2
v_mfma_f32_16x16x32_bf16 a[236:239], a[60:63], a[100:103], a[236:239]
s_add_u32 s10, s10, 64
v_mfma_f32_16x16x32_bf16 a[236:239], a[44:47], a[96:99], a[236:239]
L_padA3:
s_cmp_eq_u32 s95, 1
s_cbranch_scc1 L_padA7
s_add_u32 m0, s17, 0x10800
v_mfma_f32_16x16x32_bf16 a[252:255], a[44:47], a[104:107], a[252:255]
buffer_load_dwordx4 v6, s[52:55], 0 offen lds
v_mfma_f32_16x16x32_bf16 a[252:255], a[60:63], a[108:111], a[252:255]
ds_read_b64_tr_b16 a[96:97], v12 offset:256
v_mfma_f32_16x16x32_bf16 a[248:251], a[56:59], a[108:111], a[248:251]
ds_read_b64_tr_b16 a[98:99], v12 offset:1280
v_mfma_f32_16x16x32_bf16 a[248:251], a[40:43], a[104:107], a[248:251]
ds_read_b64_tr_b16 a[100:101], v12 offset:8448
v_mfma_f32_16x16x32_bf16 a[244:247], a[36:39], a[104:107], a[244:247]
ds_read_b64_tr_b16 a[102:103], v12 offset:9472
v_mfma_f32_16x16x32_bf16 a[244:247], a[52:55], a[108:111], a[244:247]
v_mfma_f32_16x16x32_bf16 a[240:243], a[48:51], a[108:111], a[240:243]
v_mfma_f32_16x16x32_bf16 a[240:243], a[32:35], a[104:107], a[240:243]
s_add_u32 m0, s17, 0x10c00
s_waitcnt lgkmcnt(4)
L_S6:
v_mfma_f32_16x16x32_bf16 v[24:27], a[80:83], a[0:3], v[24:27]
buffer_load_dwordx4 v6, s[52:55], s13 offen lds
v_mfma_f32_16x16x32_bf16 v[24:27], a[84:87], a[16:19], v[24:27]
ds_read_b64_tr_b16 a[104:105], v13 offset:256
s_waitcnt vmcnt(22)
v_mfma_f32_16x16x32_bf16 v[32:35], a[84:87], a[20:23], v[32:35]
ds_read_b64_tr_b16 a[106:107], v13 offset:1280
v_mfma_f32_16x16x32_bf16 v[32:35], a[80:83], a[4:7], v[32:35]
ds_read_b64_tr_b16 a[108:109], v13 offset:8448
v_mfma_f32_16x16x32_bf16 v[40:43], a[80:83], a[8:11], v[40:43]
ds_read_b64_tr_b16 a[110:111], v13 offset:9472
v_mfma_f32_16x16x32_bf16 v[40:43], a[84:87], a[24:27], v[40:43]
ds_read_b128 a[32:35], v8 offset:32768
v_mfma_f32_16x16x32_bf16 v[48:51], a[84:87], a[28:31], v[48:51]
ds_read_b128 a[48:51], v9 offset:32768
s_add_u32 m0, s18, 0x14000
v_mfma_f32_16x16x32_bf16 v[48:51], a[80:83], a[12:15], v[48:51]
buffer_load_dwordx4 v7, s[68:71], 0 offen lds
v_mfma_f32_16x16x32_bf16 v[52:55], a[88:91], a[12:15], v[52:55]
ds_read_b64_tr_b16 a[80:81], v12 offset:512
v_mfma_f32_16x16x32_bf16 v[52:55], a[92:95], a[28:31], v[52:55]
ds_read_b64_tr_b16 a[82:83], v12 offset:1536
v_mfma_f32_16x16x32_bf16 v[44:47], a[92:95], a[24:27], v[44:47]
ds_read_b64_tr_b16 a[84:85], v12 offset:8704
v_mfma_f32_16x16x32_bf16 v[44:47], a[88:91], a[8:11], v[44:47]
ds_read_b64_tr_b16 a[86:87], v12 offset:9728
v_mfma_f32_16x16x32_bf16 v[36:39], a[88:91], a[4:7], v[36:39]
ds_read_b128 a[36:39], v8 offset:34816
v_mfma_f32_16x16x32_bf16 v[36:39], a[92:95], a[20:23], v[36:39]
ds_read_b128 a[52:55], v9 offset:34816
s_waitcnt lgkmcnt(8)
v_mfma_f32_16x16x32_bf16 v[28:31], a[92:95], a[16:19], v[28:31]
ds_read_b128 a[40:43], v8 offset:36864
s_add_u32 m0, s18, 0x15000
v_mfma_f32_16x16x32_bf16 v[28:31], a[88:91], a[0:3], v[28:31]
buffer_load_dwordx4 v7, s[68:71], s25 offen lds
v_mfma_f32_16x16x32_bf16 v[56:59], a[96:99], a[0:3], v[56:59]
ds_read_b64_tr_b16 a[88:89], v13 offset:512
v_mfma_f32_16x16x32_bf16 v[56:59], a[100:103], a[16:19], v[56:59]
ds_read_b64_tr_b16 a[90:91], v13 offset:1536
v_mfma_f32_16x16x32_bf16 v[64:67], a[100:103], a[20:23], v[64:67]
ds_read_b64_tr_b16 a[92:93], v13 offset:8704
v_mfma_f32_16x16x32_bf16 v[64:67], a[96:99], a[4:7], v[64:67]
ds_read_b64_tr_b16 a[94:95], v13 offset:9728
v_mfma_f32_16x16x32_bf16 v[72:75], a[96:99], a[8:11], v[72:75]
ds_read_b128 a[56:59], v9 offset:36864
v_mfma_f32_16x16x32_bf16 v[72:75], a[100:103], a[24:27], v[72:75]
ds_read_b128 a[44:47], v8 offset:38912
s_add_u32 m0, s18, 0x16000
v_mfma_f32_16x16x32_bf16 v[80:83], a[100:103], a[28:31], v[80:83]
buffer_load_dwordx4 v7, s[68:71], s26 offen lds
v_mfma_f32_16x16x32_bf16 v[80:83], a[96:99], a[12:15], v[80:83]
ds_read_b128 a[60:63], v9 offset:38912
v_lshl_add_u32 v5, s42, 19, v5
v_mfma_f32_16x16x32_bf16 v[84:87], a[104:107], a[12:15], v[84:87]
ds_read_b64_tr_b16 a[96:97], v12 offset:768
v_lshl_add_u32 v6, s42, 19, v6
v_mfma_f32_16x16x32_bf16 v[84:87], a[108:111], a[28:31], v[84:87]
ds_read_b64_tr_b16 a[98:99], v12 offset:1792
v_lshl_add_u32 v7, s42, 18, v7
v_mfma_f32_16x16x32_bf16 v[76:79], a[108:111], a[24:27], v[76:79]
ds_read_b64_tr_b16 a[100:101], v12 offset:8960
v_lshl_add_u32 v7, s42, 17, v7
v_mfma_f32_16x16x32_bf16 v[76:79], a[104:107], a[8:11], v[76:79]
ds_read_b64_tr_b16 a[102:103], v12 offset:9984
v_mfma_f32_16x16x32_bf16 v[68:71], a[104:107], a[4:7], v[68:71]
v_mfma_f32_16x16x32_bf16 v[68:71], a[108:111], a[20:23], v[68:71]
buffer_store_dwordx4 a[64:67], v4, s[88:91], 0 offen sc1
v_mfma_f32_16x16x32_bf16 v[60:63], a[108:111], a[16:19], v[60:63]
v_mfma_f32_16x16x32_bf16 v[60:63], a[104:107], a[0:3], v[60:63]
s_waitcnt lgkmcnt(7)
v_mfma_f32_16x16x32_bf16 v[88:91], a[80:83], a[0:3], v[88:91]
ds_read_b64_tr_b16 a[104:105], v13 offset:768
v_mfma_f32_16x16x32_bf16 v[88:91], a[84:87], a[16:19], v[88:91]
ds_read_b64_tr_b16 a[106:107], v13 offset:1792
v_mfma_f32_16x16x32_bf16 v[96:99], a[84:87], a[20:23], v[96:99]
ds_read_b64_tr_b16 a[108:109], v13 offset:8960
v_mfma_f32_16x16x32_bf16 v[96:99], a[80:83], a[4:7], v[96:99]
ds_read_b64_tr_b16 a[110:111], v13 offset:9984
v_mfma_f32_16x16x32_bf16 v[104:107], a[80:83], a[8:11], v[104:107]
s_add_u32 m0, s16, 0x8000
s_waitcnt lgkmcnt(8)
v_mfma_f32_16x16x32_bf16 v[104:107], a[84:87], a[24:27], v[104:107]
buffer_load_dwordx4 v22, s[44:47], s20 offen lds
v_mfma_f32_16x16x32_bf16 v[112:115], a[84:87], a[28:31], v[112:115]
v_mfma_f32_16x16x32_bf16 v[112:115], a[80:83], a[12:15], v[112:115]
v_mfma_f32_16x16x32_bf16 v[116:119], a[88:91], a[12:15], v[116:119]
ds_read_b64_tr_b16 a[80:81], v12 offset:16384
v_mfma_f32_16x16x32_bf16 v[116:119], a[92:95], a[28:31], v[116:119]
ds_read_b64_tr_b16 a[82:83], v12 offset:17408
v_mfma_f32_16x16x32_bf16 v[108:111], a[92:95], a[24:27], v[108:111]
ds_read_b64_tr_b16 a[84:85], v12 offset:24576
v_mfma_f32_16x16x32_bf16 v[108:111], a[88:91], a[8:11], v[108:111]
ds_read_b64_tr_b16 a[86:87], v12 offset:25600
s_add_u32 m0, s16, 0x8400
v_mfma_f32_16x16x32_bf16 v[100:103], a[88:91], a[4:7], v[100:103]
buffer_load_dwordx4 v23, s[44:47], s20 offen lds
v_mfma_f32_16x16x32_bf16 v[100:103], a[92:95], a[20:23], v[100:103]
v_mfma_f32_16x16x32_bf16 v[92:95], a[92:95], a[16:19], v[92:95]
v_mfma_f32_16x16x32_bf16 v[92:95], a[88:91], a[0:3], v[92:95]
s_waitcnt lgkmcnt(4)
v_mfma_f32_16x16x32_bf16 v[120:123], a[96:99], a[0:3], v[120:123]
ds_read_b64_tr_b16 a[88:89], v13 offset:16384
v_mfma_f32_16x16x32_bf16 v[120:123], a[100:103], a[16:19], v[120:123]
ds_read_b64_tr_b16 a[90:91], v13 offset:17408
v_mfma_f32_16x16x32_bf16 v[128:131], a[100:103], a[20:23], v[128:131]
ds_read_b64_tr_b16 a[92:93], v13 offset:24576
v_mfma_f32_16x16x32_bf16 v[128:131], a[96:99], a[4:7], v[128:131]
ds_read_b64_tr_b16 a[94:95], v13 offset:25600
s_add_u32 m0, s16, 0x8800
v_mfma_f32_16x16x32_bf16 v[136:139], a[96:99], a[8:11], v[136:139]
buffer_load_dwordx4 v22, s[44:47], s21 offen lds
v_mfma_f32_16x16x32_bf16 v[136:139], a[100:103], a[24:27], v[136:139]
v_mfma_f32_16x16x32_bf16 v[144:147], a[100:103], a[28:31], v[144:147]
v_mfma_f32_16x16x32_bf16 v[144:147], a[96:99], a[12:15], v[144:147]
v_mfma_f32_16x16x32_bf16 v[148:151], a[104:107], a[12:15], v[148:151]
ds_read_b64_tr_b16 a[96:97], v12 offset:16640
v_mfma_f32_16x16x32_bf16 v[148:151], a[108:111], a[28:31], v[148:151]
ds_read_b64_tr_b16 a[98:99], v12 offset:17664
v_mfma_f32_16x16x32_bf16 v[140:143], a[108:111], a[24:27], v[140:143]
ds_read_b64_tr_b16 a[100:101], v12 offset:24832
s_add_u32 m0, s16, 0x8c00
v_mfma_f32_16x16x32_bf16 v[140:143], a[104:107], a[8:11], v[140:143]
buffer_load_dwordx4 v23, s[44:47], s21 offen lds
v_mfma_f32_16x16x32_bf16 v[132:135], a[104:107], a[4:7], v[132:135]
ds_read_b64_tr_b16 a[102:103], v12 offset:25856
v_mfma_f32_16x16x32_bf16 v[132:135], a[108:111], a[20:23], v[132:135]
v_mfma_f32_16x16x32_bf16 v[124:127], a[108:111], a[16:19], v[124:127]
v_mfma_f32_16x16x32_bf16 v[124:127], a[104:107], a[0:3], v[124:127]
s_waitcnt lgkmcnt(4)
v_mfma_f32_16x16x32_bf16 v[152:155], a[0:3], a[80:83], v[152:155]
ds_read_b64_tr_b16 a[104:105], v13 offset:16640
v_mfma_f32_16x16x32_bf16 v[152:155], a[16:19], a[84:87], v[152:155]
ds_read_b64_tr_b16 a[106:107], v13 offset:17664
s_add_u32 m0, s16, 0x9000
v_mfma_f32_16x16x32_bf16 v[156:159], a[20:23], a[84:87], v[156:159]
buffer_load_dwordx4 v22, s[44:47], s22 offen lds
v_mfma_f32_16x16x32_bf16 v[156:159], a[4:7], a[80:83], v[156:159]
ds_read_b64_tr_b16 a[108:109], v13 offset:24832
v_mfma_f32_16x16x32_bf16 v[160:163], a[8:11], a[80:83], v[160:163]
ds_read_b64_tr_b16 a[110:111], v13 offset:25856
v_mfma_f32_16x16x32_bf16 v[160:163], a[24:27], a[84:87], v[160:163]
v_mfma_f32_16x16x32_bf16 v[164:167], a[28:31], a[84:87], v[164:167]
v_mfma_f32_16x16x32_bf16 v[164:167], a[12:15], a[80:83], v[164:167]
v_mfma_f32_16x16x32_bf16 v[180:183], a[12:15], a[88:91], v[180:183]
ds_read_b64_tr_b16 a[80:81], v12 offset:16896
v_mfma_f32_16x16x32_bf16 v[180:183], a[28:31], a[92:95], v[180:183]
ds_read_b64_tr_b16 a[82:83], v12 offset:17920
s_add_u32 m0, s16, 0x9400
v_mfma_f32_16x16x32_bf16 v[176:179], a[24:27], a[92:95], v[176:179]
buffer_load_dwordx4 v23, s[44:47], s22 offen lds
v_mfma_f32_16x16x32_bf16 v[176:179], a[8:11], a[88:91], v[176:179]
ds_read_b64_tr_b16 a[84:85], v12 offset:25088
v_mfma_f32_16x16x32_bf16 v[172:175], a[4:7], a[88:91], v[172:175]
ds_read_b64_tr_b16 a[86:87], v12 offset:26112
v_mfma_f32_16x16x32_bf16 v[172:175], a[20:23], a[92:95], v[172:175]
v_mfma_f32_16x16x32_bf16 v[168:171], a[16:19], a[92:95], v[168:171]
v_mfma_f32_16x16x32_bf16 v[168:171], a[0:3], a[88:91], v[168:171]
s_waitcnt lgkmcnt(4)
v_mfma_f32_16x16x32_bf16 v[184:187], a[0:3], a[96:99], v[184:187]
ds_read_b64_tr_b16 a[88:89], v13 offset:16896
s_add_u32 m0, s16, 0x9800
v_mfma_f32_16x16x32_bf16 v[184:187], a[16:19], a[100:103], v[184:187]
buffer_load_dwordx4 v22, s[44:47], s23 offen lds
v_mfma_f32_16x16x32_bf16 v[188:191], a[20:23], a[100:103], v[188:191]
ds_read_b64_tr_b16 a[90:91], v13 offset:17920
v_mfma_f32_16x16x32_bf16 v[188:191], a[4:7], a[96:99], v[188:191]
ds_read_b64_tr_b16 a[92:93], v13 offset:25088
v_mfma_f32_16x16x32_bf16 v[192:195], a[8:11], a[96:99], v[192:195]
ds_read_b64_tr_b16 a[94:95], v13 offset:26112
v_mfma_f32_16x16x32_bf16 v[192:195], a[24:27], a[100:103], v[192:195]
v_mfma_f32_16x16x32_bf16 v[196:199], a[28:31], a[100:103], v[196:199]
v_mfma_f32_16x16x32_bf16 v[196:199], a[12:15], a[96:99], v[196:199]
v_mfma_f32_16x16x32_bf16 v[212:215], a[12:15], a[104:107], v[212:215]
ds_read_b64_tr_b16 a[96:97], v12 offset:17152
s_add_u32 m0, s16, 0x9c00
v_mfma_f32_16x16x32_bf16 v[212:215], a[28:31], a[108:111], v[212:215]
buffer_load_dwordx4 v23, s[44:47], s23 offen lds
v_mfma_f32_16x16x32_bf16 v[208:211], a[24:27], a[108:111], v[208:211]
ds_read_b64_tr_b16 a[98:99], v12 offset:18176
v_lshl_add_u32 v22, s42, 7, v22
v_mfma_f32_16x16x32_bf16 v[208:211], a[8:11], a[104:107], v[208:211]
ds_read_b64_tr_b16 a[100:101], v12 offset:25344
v_lshl_add_u32 v23, s42, 7, v23
v_mfma_f32_16x16x32_bf16 v[204:207], a[4:7], a[104:107], v[204:207]
ds_read_b64_tr_b16 a[102:103], v12 offset:26368
v_mfma_f32_16x16x32_bf16 v[204:207], a[20:23], a[108:111], v[204:207]
v_mfma_f32_16x16x32_bf16 v[200:203], a[16:19], a[108:111], v[200:203]
v_mfma_f32_16x16x32_bf16 v[200:203], a[0:3], a[104:107], v[200:203]
s_mov_b32 s9, 0x200000
s_waitcnt lgkmcnt(4)
v_mfma_f32_16x16x32_bf16 v[216:219], a[0:3], a[80:83], v[216:219]
buffer_load_dword a120, v18, s[52:55], s9 offen
v_mfma_f32_16x16x32_bf16 v[216:219], a[16:19], a[84:87], v[216:219]
ds_read_b64_tr_b16 a[104:105], v13 offset:17152
v_mfma_f32_16x16x32_bf16 v[220:223], a[20:23], a[84:87], v[220:223]
ds_read_b64_tr_b16 a[106:107], v13 offset:18176
v_mfma_f32_16x16x32_bf16 v[220:223], a[4:7], a[80:83], v[220:223]
ds_read_b64_tr_b16 a[108:109], v13 offset:25344
v_mfma_f32_16x16x32_bf16 v[224:227], a[8:11], a[80:83], v[224:227]
ds_read_b64_tr_b16 a[110:111], v13 offset:26368
v_add_u32 v12, 0x8000, v12
v_mfma_f32_16x16x32_bf16 v[224:227], a[24:27], a[84:87], v[224:227]
v_add_u32 v13, 0x8000, v13
v_mfma_f32_16x16x32_bf16 v[228:231], a[28:31], a[84:87], v[228:231]
v_mfma_f32_16x16x32_bf16 v[228:231], a[12:15], a[80:83], v[228:231]
v_mfma_f32_16x16x32_bf16 v[244:247], a[12:15], a[88:91], v[244:247]
s_waitcnt vmcnt(26) lgkmcnt(0)
v_mfma_f32_16x16x32_bf16 v[244:247], a[28:31], a[92:95], v[244:247]
s_barrier
s_add_u32 m0, s17, 0x0
v_mfma_f32_16x16x32_bf16 v[240:243], a[24:27], a[92:95], v[240:243]
buffer_load_dwordx4 v5, s[52:55], 0 offen lds
v_mfma_f32_16x16x32_bf16 v[240:243], a[8:11], a[88:91], v[240:243]
ds_read_b64_tr_b16 a[80:81], v12 offset:0
v_mfma_f32_16x16x32_bf16 v[236:239], a[4:7], a[88:91], v[236:239]
ds_read_b64_tr_b16 a[82:83], v12 offset:1024
v_mfma_f32_16x16x32_bf16 v[236:239], a[20:23], a[92:95], v[236:239]
ds_read_b64_tr_b16 a[84:85], v12 offset:8192
v_mfma_f32_16x16x32_bf16 v[232:235], a[16:19], a[92:95], v[232:235]
ds_read_b64_tr_b16 a[86:87], v12 offset:9216
v_mfma_f32_16x16x32_bf16 v[232:235], a[0:3], a[88:91], v[232:235]
s_waitcnt lgkmcnt(4)
v_mfma_f32_16x16x32_bf16 v[248:251], a[0:3], a[96:99], v[248:251]
ds_read_b64_tr_b16 a[88:89], v13 offset:0
s_add_u32 m0, s17, 0x400
v_mfma_f32_16x16x32_bf16 v[248:251], a[16:19], a[100:103], v[248:251]
buffer_load_dwordx4 v5, s[52:55], s13 offen lds
v_mfma_f32_16x16x32_bf16 v[252:255], a[20:23], a[100:103], v[252:255]
ds_read_b64_tr_b16 a[90:91], v13 offset:1024
v_mfma_f32_16x16x32_bf16 v[252:255], a[4:7], a[96:99], v[252:255]
ds_read_b64_tr_b16 a[92:93], v13 offset:8192
v_mfma_f32_16x16x32_bf16 a[232:235], a[8:11], a[96:99], a[232:235]
ds_read_b64_tr_b16 a[94:95], v13 offset:9216
v_mfma_f32_16x16x32_bf16 a[232:235], a[24:27], a[100:103], a[232:235]
v_mfma_f32_16x16x32_bf16 a[236:239], a[28:31], a[100:103], a[236:239]
v_mfma_f32_16x16x32_bf16 a[236:239], a[12:15], a[96:99], a[236:239]
s_add_u32 m0, s17, 0x800
v_mfma_f32_16x16x32_bf16 a[252:255], a[12:15], a[104:107], a[252:255]
buffer_load_dwordx4 v6, s[52:55], 0 offen lds
v_mfma_f32_16x16x32_bf16 a[252:255], a[28:31], a[108:111], a[252:255]
ds_read_b64_tr_b16 a[96:97], v12 offset:256
v_mfma_f32_16x16x32_bf16 a[248:251], a[24:27], a[108:111], a[248:251]
ds_read_b64_tr_b16 a[98:99], v12 offset:1280
v_mfma_f32_16x16x32_bf16 a[248:251], a[8:11], a[104:107], a[248:251]
ds_read_b64_tr_b16 a[100:101], v12 offset:8448
v_mfma_f32_16x16x32_bf16 a[244:247], a[4:7], a[104:107], a[244:247]
ds_read_b64_tr_b16 a[102:103], v12 offset:9472
v_mfma_f32_16x16x32_bf16 a[244:247], a[20:23], a[108:111], a[244:247]
v_mfma_f32_16x16x32_bf16 a[240:243], a[16:19], a[108:111], a[240:243]
v_mfma_f32_16x16x32_bf16 a[240:243], a[0:3], a[104:107], a[240:243]
s_add_u32 m0, s17, 0xc00
s_waitcnt lgkmcnt(4)
L_S7:
v_mfma_f32_16x16x32_bf16 v[24:27], a[80:83], a[32:35], v[24:27]
buffer_load_dwordx4 v6, s[52:55], s13 offen lds
v_mfma_f32_16x16x32_bf16 v[24:27], a[84:87], a[48:51], v[24:27]
ds_read_b64_tr_b16 a[104:105], v13 offset:256
s_waitcnt vmcnt(22)
v_mfma_f32_16x16x32_bf16 v[32:35], a[84:87], a[52:55], v[32:35]
ds_read_b64_tr_b16 a[106:107], v13 offset:1280
v_mfma_f32_16x16x32_bf16 v[32:35], a[80:83], a[36:39], v[32:35]
ds_read_b64_tr_b16 a[108:109], v13 offset:8448
v_mfma_f32_16x16x32_bf16 v[40:43], a[80:83], a[40:43], v[40:43]
ds_read_b64_tr_b16 a[110:111], v13 offset:9472
v_mfma_f32_16x16x32_bf16 v[40:43], a[84:87], a[56:59], v[40:43]
ds_read_b128 a[0:3], v8 offset:0
v_mfma_f32_16x16x32_bf16 v[48:51], a[84:87], a[60:63], v[48:51]
ds_read_b128 a[16:19], v9 offset:0
s_add_u32 m0, s18, 0x4000
v_mfma_f32_16x16x32_bf16 v[48:51], a[80:83], a[44:47], v[48:51]
buffer_load_dwordx4 v7, s[68:71], 0 offen lds
v_mfma_f32_16x16x32_bf16 v[52:55], a[88:91], a[44:47], v[52:55]
ds_read_b64_tr_b16 a[80:81], v12 offset:512
v_mfma_f32_16x16x32_bf16 v[52:55], a[92:95], a[60:63], v[52:55]
ds_read_b64_tr_b16 a[82:83], v12 offset:1536
v_mfma_f32_16x16x32_bf16 v[44:47], a[92:95], a[56:59], v[44:47]
ds_read_b64_tr_b16 a[84:85], v12 offset:8704
v_mfma_f32_16x16x32_bf16 v[44:47], a[88:91], a[40:43], v[44:47]
ds_read_b64_tr_b16 a[86:87], v12 offset:9728
v_mfma_f32_16x16x32_bf16 v[36:39], a[88:91], a[36:39], v[36:39]
ds_read_b128 a[4:7], v8 offset:2048
v_mfma_f32_16x16x32_bf16 v[36:39], a[92:95], a[52:55], v[36:39]
ds_read_b128 a[20:23], v9 offset:2048
s_waitcnt lgkmcnt(8)
v_mfma_f32_16x16x32_bf16 v[28:31], a[92:95], a[48:51], v[28:31]
ds_read_b128 a[8:11], v8 offset:4096
s_add_u32 m0, s18, 0x5000
v_mfma_f32_16x16x32_bf16 v[28:31], a[88:91], a[32:35], v[28:31]
buffer_load_dwordx4 v7, s[68:71], s25 offen lds
v_mfma_f32_16x16x32_bf16 v[56:59], a[96:99], a[32:35], v[56:59]
ds_read_b64_tr_b16 a[88:89], v13 offset:512
v_mfma_f32_16x16x32_bf16 v[56:59], a[100:103], a[48:51], v[56:59]
ds_read_b64_tr_b16 a[90:91], v13 offset:1536
v_mfma_f32_16x16x32_bf16 v[64:67], a[100:103], a[52:55], v[64:67]
ds_read_b64_tr_b16 a[92:93], v13 offset:8704
v_mfma_f32_16x16x32_bf16 v[64:67], a[96:99], a[36:39], v[64:67]
ds_read_b64_tr_b16 a[94:95], v13 offset:9728
v_cvt_pk_bf16_f32 v24, v24, v25
v_cvt_pk_bf16_f32 v25, v26, v27
v_mfma_f32_16x16x32_bf16 v[72:75], a[96:99], a[40:43], v[72:75]
ds_read_b128 a[24:27], v9 offset:4096
v_cvt_pk_bf16_f32 v26, v28, v29
v_mfma_f32_16x16x32_bf16 v[72:75], a[100:103], a[56:59], v[72:75]
ds_read_b128 a[12:15], v8 offset:6144
s_add_u32 m0, s18, 0x6000
v_mfma_f32_16x16x32_bf16 v[80:83], a[100:103], a[60:63], v[80:83]
buffer_load_dwordx4 v7, s[68:71], s26 offen lds
v_cvt_pk_bf16_f32 v27, v30, v31
v_mfma_f32_16x16x32_bf16 v[80:83], a[96:99], a[44:47], v[80:83]
ds_read_b128 a[28:31], v9 offset:6144
v_lshl_add_u32 v5, s42, 19, v5
v_mfma_f32_16x16x32_bf16 v[84:87], a[104:107], a[44:47], v[84:87]
ds_read_b64_tr_b16 a[96:97], v12 offset:768
v_lshl_add_u32 v6, s42, 19, v6
v_mfma_f32_16x16x32_bf16 v[84:87], a[108:111], a[60:63], v[84:87]
ds_read_b64_tr_b16 a[98:99], v12 offset:1792
v_lshl_add_u32 v7, s42, 18, v7
v_accvgpr_write_b32 a128, v24
v_mfma_f32_16x16x32_bf16 v[76:79], a[108:111], a[56:59], v[76:79]
ds_read_b64_tr_b16 a[100:101], v12 offset:8960
v_lshl_add_u32 v7, s42, 17, v7
v_mfma_f32_16x16x32_bf16 v[76:79], a[104:107], a[40:43], v[76:79]
ds_read_b64_tr_b16 a[102:103], v12 offset:9984
v_accvgpr_write_b32 a129, v25
v_mfma_f32_16x16x32_bf16 v[68:71], a[104:107], a[36:39], v[68:71]
s_mov_b32 s9, 0x400000
v_accvgpr_write_b32 a130, v26
v_accvgpr_write_b32 a131, v27
v_cvt_pk_bf16_f32 v32, v32, v33
v_mfma_f32_16x16x32_bf16 v[68:71], a[108:111], a[52:55], v[68:71]
buffer_load_dword a120, v18, s[52:55], s9 offen
v_mfma_f32_16x16x32_bf16 v[60:63], a[108:111], a[48:51], v[60:63]
v_cvt_pk_bf16_f32 v33, v34, v35
v_cvt_pk_bf16_f32 v34, v36, v37
v_mfma_f32_16x16x32_bf16 v[60:63], a[104:107], a[32:35], v[60:63]
s_waitcnt lgkmcnt(7)
v_cvt_pk_bf16_f32 v35, v38, v39
v_accvgpr_write_b32 a132, v32
v_accvgpr_write_b32 a133, v33
v_mfma_f32_16x16x32_bf16 v[88:91], a[80:83], a[32:35], v[88:91]
ds_read_b64_tr_b16 a[104:105], v13 offset:768
v_accvgpr_write_b32 a134, v34
v_mfma_f32_16x16x32_bf16 v[88:91], a[84:87], a[48:51], v[88:91]
ds_read_b64_tr_b16 a[106:107], v13 offset:1792
v_accvgpr_write_b32 a135, v35
v_mfma_f32_16x16x32_bf16 v[96:99], a[84:87], a[52:55], v[96:99]
ds_read_b64_tr_b16 a[108:109], v13 offset:8960
v_cvt_pk_bf16_f32 v40, v40, v41
v_cvt_pk_bf16_f32 v41, v42, v43
v_mfma_f32_16x16x32_bf16 v[96:99], a[80:83], a[36:39], v[96:99]
ds_read_b64_tr_b16 a[110:111], v13 offset:9984
v_cvt_pk_bf16_f32 v42, v44, v45
v_mfma_f32_16x16x32_bf16 v[104:107], a[80:83], a[40:43], v[104:107]
s_add_u32 m0, s16, 0x0
s_waitcnt lgkmcnt(8)
v_cvt_pk_bf16_f32 v43, v46, v47
v_mfma_f32_16x16x32_bf16 v[104:107], a[84:87], a[56:59], v[104:107]
buffer_load_dwordx4 v22, s[44:47], s20 offen lds
v_accvgpr_write_b32 a136, v40
v_mfma_f32_16x16x32_bf16 v[112:115], a[84:87], a[60:63], v[112:115]
v_accvgpr_write_b32 a137, v41
v_accvgpr_write_b32 a138, v42
v_mfma_f32_16x16x32_bf16 v[112:115], a[80:83], a[44:47], v[112:115]
v_accvgpr_write_b32 a139, v43
v_cvt_pk_bf16_f32 v48, v48, v49
v_mfma_f32_16x16x32_bf16 v[116:119], a[88:91], a[44:47], v[116:119]
ds_read_b64_tr_b16 a[80:81], v12 offset:16384
v_cvt_pk_bf16_f32 v49, v50, v51
v_cvt_pk_bf16_f32 v50, v52, v53
v_mfma_f32_16x16x32_bf16 v[116:119], a[92:95], a[60:63], v[116:119]
ds_read_b64_tr_b16 a[82:83], v12 offset:17408
v_cvt_pk_bf16_f32 v51, v54, v55
v_mfma_f32_16x16x32_bf16 v[108:111], a[92:95], a[56:59], v[108:111]
ds_read_b64_tr_b16 a[84:85], v12 offset:24576
v_accvgpr_write_b32 a140, v48
v_mfma_f32_16x16x32_bf16 v[108:111], a[88:91], a[40:43], v[108:111]
ds_read_b64_tr_b16 a[86:87], v12 offset:25600
s_add_u32 m0, s16, 0x400
v_accvgpr_write_b32 a141, v49
v_mfma_f32_16x16x32_bf16 v[100:103], a[88:91], a[36:39], v[100:103]
buffer_load_dwordx4 v23, s[44:47], s20 offen lds
v_mfma_f32_16x16x32_bf16 v[100:103], a[92:95], a[52:55], v[100:103]
v_accvgpr_write_b32 a142, v50
v_accvgpr_write_b32 a143, v51
v_mfma_f32_16x16x32_bf16 v[92:95], a[92:95], a[48:51], v[92:95]
v_cvt_pk_bf16_f32 v56, v56, v57
v_cvt_pk_bf16_f32 v57, v58, v59
v_cvt_pk_bf16_f32 v58, v60, v61
v_mfma_f32_16x16x32_bf16 v[92:95], a[88:91], a[32:35], v[92:95]
s_waitcnt lgkmcnt(4)
v_cvt_pk_bf16_f32 v59, v62, v63
v_accvgpr_write_b32 a144, v56
v_mfma_f32_16x16x32_bf16 v[120:123], a[96:99], a[32:35], v[120:123]
ds_read_b64_tr_b16 a[88:89], v13 offset:16384
v_accvgpr_write_b32 a145, v57
v_mfma_f32_16x16x32_bf16 v[120:123], a[100:103], a[48:51], v[120:123]
ds_read_b64_tr_b16 a[90:91], v13 offset:17408
v_accvgpr_write_b32 a146, v58
v_accvgpr_write_b32 a147, v59
v_mfma_f32_16x16x32_bf16 v[128:131], a[100:103], a[52:55], v[128:131]
ds_read_b64_tr_b16 a[92:93], v13 offset:24576
v_cvt_pk_bf16_f32 v64, v64, v65
v_mfma_f32_16x16x32_bf16 v[128:131], a[96:99], a[36:39], v[128:131]
ds_read_b64_tr_b16 a[94:95], v13 offset:25600
s_add_u32 m0, s16, 0x800
v_mfma_f32_16x16x32_bf16 v[136:139], a[96:99], a[40:43], v[136:139]
buffer_load_dwordx4 v22, s[44:47], s21 offen lds
v_cvt_pk_bf16_f32 v65, v66, v67
v_mfma_f32_16x16x32_bf16 v[136:139], a[100:103], a[56:59], v[136:139]
v_cvt_pk_bf16_f32 v66, v68, v69
v_cvt_pk_bf16_f32 v67, v70, v71
v_mfma_f32_16x16x32_bf16 v[144:147], a[100:103], a[60:63], v[144:147]
v_accvgpr_write_b32 a148, v64
v_accvgpr_write_b32 a149, v65
v_mfma_f32_16x16x32_bf16 v[144:147], a[96:99], a[44:47], v[144:147]
v_accvgpr_write_b32 a150, v66
v_accvgpr_write_b32 a151, v67
v_cvt_pk_bf16_f32 v72, v72, v73
v_mfma_f32_16x16x32_bf16 v[148:151], a[104:107], a[44:47], v[148:151]
ds_read_b64_tr_b16 a[96:97], v12 offset:16640
v_cvt_pk_bf16_f32 v73, v74, v75
v_mfma_f32_16x16x32_bf16 v[148:151], a[108:111], a[60:63], v[148:151]
ds_read_b64_tr_b16 a[98:99], v12 offset:17664
v_cvt_pk_bf16_f32 v74, v76, v77
v_mfma_f32_16x16x32_bf16 v[140:143], a[108:111], a[56:59], v[140:143]
ds_read_b64_tr_b16 a[100:101], v12 offset:24832
s_add_u32 m0, s16, 0xc00
v_cvt_pk_bf16_f32 v75, v78, v79
v_mfma_f32_16x16x32_bf16 v[140:143], a[104:107], a[40:43], v[140:143]
buffer_load_dwordx4 v23, s[44:47], s21 offen lds
v_mfma_f32_16x16x32_bf16 v[132:135], a[104:107], a[36:39], v[132:135]
ds_read_b64_tr_b16 a[102:103], v12 offset:25856
v_accvgpr_write_b32 a152, v72
v_mfma_f32_16x16x32_bf16 v[132:135], a[108:111], a[52:55], v[132:135]
v_accvgpr_write_b32 a153, v73
v_accvgpr_write_b32 a154, v74
v_accvgpr_write_b32 a155, v75
v_mfma_f32_16x16x32_bf16 v[124:127], a[108:111], a[48:51], v[124:127]
v_cvt_pk_bf16_f32 v80, v80, v81
v_cvt_pk_bf16_f32 v81, v82, v83
v_mfma_f32_16x16x32_bf16 v[124:127], a[104:107], a[32:35], v[124:127]
s_waitcnt lgkmcnt(4)
v_cvt_pk_bf16_f32 v82, v84, v85
v_cvt_pk_bf16_f32 v83, v86, v87
v_mfma_f32_16x16x32_bf16 v[152:155], a[32:35], a[80:83], v[152:155]
ds_read_b64_tr_b16 a[104:105], v13 offset:16640
v_accvgpr_write_b32 a156, v80
v_accvgpr_write_b32 a157, v81
v_mfma_f32_16x16x32_bf16 v[152:155], a[48:51], a[84:87], v[152:155]
ds_read_b64_tr_b16 a[106:107], v13 offset:17664
s_add_u32 m0, s16, 0x1000
v_mfma_f32_16x16x32_bf16 v[156:159], a[52:55], a[84:87], v[156:159]
buffer_load_dwordx4 v22, s[44:47], s22 offen lds
v_mfma_f32_16x16x32_bf16 v[156:159], a[36:39], a[80:83], v[156:159]
ds_read_b64_tr_b16 a[108:109], v13 offset:24832
v_accvgpr_write_b32 a158, v82
v_accvgpr_write_b32 a159, v83
v_mfma_f32_16x16x32_bf16 v[160:163], a[40:43], a[80:83], v[160:163]
ds_read_b64_tr_b16 a[110:111], v13 offset:25856
v_cvt_pk_bf16_f32 v88, v88, v89
v_mfma_f32_16x16x32_bf16 v[160:163], a[56:59], a[84:87], v[160:163]
v_cvt_pk_bf16_f32 v89, v90, v91
v_cvt_pk_bf16_f32 v90, v92, v93
v_mfma_f32_16x16x32_bf16 v[164:167], a[60:63], a[84:87], v[164:167]
v_cvt_pk_bf16_f32 v91, v94, v95
v_accvgpr_write_b32 a160, v88
v_accvgpr_write_b32 a161, v89
v_mfma_f32_16x16x32_bf16 v[164:167], a[44:47], a[80:83], v[164:167]
v_accvgpr_write_b32 a162, v90
v_accvgpr_write_b32 a163, v91
v_mfma_f32_16x16x32_bf16 v[180:183], a[44:47], a[88:91], v[180:183]
ds_read_b64_tr_b16 a[80:81], v12 offset:16896
v_cvt_pk_bf16_f32 v96, v96, v97
v_mfma_f32_16x16x32_bf16 v[180:183], a[60:63], a[92:95], v[180:183]
ds_read_b64_tr_b16 a[82:83], v12 offset:17920
s_add_u32 m0, s16, 0x1400
v_cvt_pk_bf16_f32 v97, v98, v99
v_mfma_f32_16x16x32_bf16 v[176:179], a[56:59], a[92:95], v[176:179]
buffer_load_dwordx4 v23, s[44:47], s22 offen lds
v_mfma_f32_16x16x32_bf16 v[176:179], a[40:43], a[88:91], v[176:179]
ds_read_b64_tr_b16 a[84:85], v12 offset:25088
v_cvt_pk_bf16_f32 v98, v100, v101
v_mfma_f32_16x16x32_bf16 v[172:175], a[36:39], a[88:91], v[172:175]
ds_read_b64_tr_b16 a[86:87], v12 offset:26112
v_cvt_pk_bf16_f32 v99, v102, v103
v_accvgpr_write_b32 a164, v96
v_mfma_f32_16x16x32_bf16 v[172:175], a[52:55], a[92:95], v[172:175]
v_accvgpr_write_b32 a165, v97
v_accvgpr_write_b32 a166, v98
v_mfma_f32_16x16x32_bf16 v[168:171], a[48:51], a[92:95], v[168:171]
v_accvgpr_write_b32 a167, v99
v_cvt_pk_bf16_f32 v104, v104, v105
v_mfma_f32_16x16x32_bf16 v[168:171], a[32:35], a[88:91], v[168:171]
s_waitcnt lgkmcnt(4)
v_cvt_pk_bf16_f32 v105, v106, v107
v_cvt_pk_bf16_f32 v106, v108, v109
v_cvt_pk_bf16_f32 v107, v110, v111
v_mfma_f32_16x16x32_bf16 v[184:187], a[32:35], a[96:99], v[184:187]
ds_read_b64_tr_b16 a[88:89], v13 offset:16896
s_add_u32 m0, s16, 0x1800
v_mfma_f32_16x16x32_bf16 v[184:187], a[48:51], a[100:103], v[184:187]
buffer_load_dwordx4 v22, s[44:47], s23 offen lds
v_mfma_f32_16x16x32_bf16 v[188:191], a[52:55], a[100:103], v[188:191]
ds_read_b64_tr_b16 a[90:91], v13 offset:17920
v_accvgpr_write_b32 a168, v104
v_accvgpr_write_b32 a169, v105
v_mfma_f32_16x16x32_bf16 v[188:191], a[36:39], a[96:99], v[188:191]
ds_read_b64_tr_b16 a[92:93], v13 offset:25088
v_accvgpr_write_b32 a170, v106
v_mfma_f32_16x16x32_bf16 v[192:195], a[40:43], a[96:99], v[192:195]
ds_read_b64_tr_b16 a[94:95], v13 offset:26112
v_accvgpr_write_b32 a171, v107
v_mfma_f32_16x16x32_bf16 v[192:195], a[56:59], a[100:103], v[192:195]
L_padA4:
s_cmp_eq_u32 s95, 1
s_cbranch_scc1 L_padA8
v_cvt_pk_bf16_f32 v112, v112, v113
v_cvt_pk_bf16_f32 v113, v114, v115
v_cvt_pk_bf16_f32 v114, v116, v117
v_mfma_f32_16x16x32_bf16 v[196:199], a[60:63], a[100:103], v[196:199]
v_cvt_pk_bf16_f32 v115, v118, v119
v_accvgpr_write_b32 a172, v112
v_mfma_f32_16x16x32_bf16 v[196:199], a[44:47], a[96:99], v[196:199]
v_accvgpr_write_b32 a173, v113
v_accvgpr_write_b32 a174, v114
v_mfma_f32_16x16x32_bf16 v[212:215], a[44:47], a[104:107], v[212:215]
ds_read_b64_tr_b16 a[96:97], v12 offset:17152
s_add_u32 m0, s16, 0x1c00
v_accvgpr_write_b32 a175, v115
v_mfma_f32_16x16x32_bf16 v[212:215], a[60:63], a[108:111], v[212:215]
buffer_load_dwordx4 v23, s[44:47], s23 offen lds
v_mfma_f32_16x16x32_bf16 v[208:211], a[56:59], a[108:111], v[208:211]
ds_read_b64_tr_b16 a[98:99], v12 offset:18176
v_lshl_add_u32 v22, s42, 7, v22
v_mfma_f32_16x16x32_bf16 v[208:211], a[40:43], a[104:107], v[208:211]
ds_read_b64_tr_b16 a[100:101], v12 offset:25344
v_lshl_add_u32 v23, s42, 7, v23
v_cvt_pk_bf16_f32 v120, v120, v121
v_mfma_f32_16x16x32_bf16 v[204:207], a[36:39], a[104:107], v[204:207]
ds_read_b64_tr_b16 a[102:103], v12 offset:26368
v_cvt_pk_bf16_f32 v121, v122, v123
v_mfma_f32_16x16x32_bf16 v[204:207], a[52:55], a[108:111], v[204:207]
v_cvt_pk_bf16_f32 v122, v124, v125
v_cvt_pk_bf16_f32 v123, v126, v127
v_mfma_f32_16x16x32_bf16 v[200:203], a[48:51], a[108:111], v[200:203]
v_accvgpr_write_b32 a176, v120
v_accvgpr_write_b32 a177, v121
v_accvgpr_write_b32 a178, v122
v_mfma_f32_16x16x32_bf16 v[200:203], a[32:35], a[104:107], v[200:203]
s_mov_b32 s9, 0x600000
s_waitcnt lgkmcnt(4)
v_accvgpr_write_b32 a179, v123
v_mfma_f32_16x16x32_bf16 v[216:219], a[32:35], a[80:83], v[216:219]
buffer_load_dword a120, v18, s[52:55], s9 offen
v_mfma_f32_16x16x32_bf16 v[216:219], a[48:51], a[84:87], v[216:219]
ds_read_b64_tr_b16 a[104:105], v13 offset:17152
v_cvt_pk_bf16_f32 v128, v128, v129
v_cvt_pk_bf16_f32 v129, v130, v131
v_mfma_f32_16x16x32_bf16 v[220:223], a[52:55], a[84:87], v[220:223]
ds_read_b64_tr_b16 a[106:107], v13 offset:18176
v_cvt_pk_bf16_f32 v130, v132, v133
v_mfma_f32_16x16x32_bf16 v[220:223], a[36:39], a[80:83], v[220:223]
ds_read_b64_tr_b16 a[108:109], v13 offset:25344
v_cvt_pk_bf16_f32 v131, v134, v135
v_mfma_f32_16x16x32_bf16 v[224:227], a[40:43], a[80:83], v[224:227]
ds_read_b64_tr_b16 a[110:111], v13 offset:26368
v_add_u32 v12, 0x8000, v12
v_accvgpr_write_b32 a180, v128
v_mfma_f32_16x16x32_bf16 v[224:227], a[56:59], a[84:87], v[224:227]
v_add_u32 v13, 0x8000, v13
v_accvgpr_write_b32 a181, v129
v_mfma_f32_16x16x32_bf16 v[228:231], a[60:63], a[84:87], v[228:231]
v_accvgpr_write_b32 a182, v130
v_accvgpr_write_b32 a183, v131
v_mfma_f32_16x16x32_bf16 v[228:231], a[44:47], a[80:83], v[228:231]
v_cvt_pk_bf16_f32 v136, v136, v137
v_cvt_pk_bf16_f32 v137, v138, v139
v_cvt_pk_bf16_f32 v138, v140, v141
v_mfma_f32_16x16x32_bf16 v[244:247], a[44:47], a[88:91], v[244:247]
s_waitcnt vmcnt(27) lgkmcnt(0)
v_cvt_pk_bf16_f32 v139, v142, v143
v_accvgpr_write_b32 a184, v136
v_mfma_f32_16x16x32_bf16 v[244:247], a[60:63], a[92:95], v[244:247]
s_barrier
s_add_u32 m0, s17, 0x8000
v_accvgpr_write_b32 a185, v137
v_mfma_f32_16x16x32_bf16 v[240:243], a[56:59], a[92:95], v[240:243]
buffer_load_dwordx4 v5, s[52:55], 0 offen lds
v_accvgpr_write_b32 a186, v138
v_mfma_f32_16x16x32_bf16 v[240:243], a[40:43], a[88:91], v[240:243]
ds_read_b64_tr_b16 a[80:81], v12 offset:0
v_accvgpr_write_b32 a187, v139
v_mfma_f32_16x16x32_bf16 v[236:239], a[36:39], a[88:91], v[236:239]
ds_read_b64_tr_b16 a[82:83], v12 offset:1024
v_cvt_pk_bf16_f32 v144, v144, v145
v_mfma_f32_16x16x32_bf16 v[236:239], a[52:55], a[92:95], v[236:239]
ds_read_b64_tr_b16 a[84:85], v12 offset:8192
v_cvt_pk_bf16_f32 v145, v146, v147
v_cvt_pk_bf16_f32 v146, v148, v149
v_mfma_f32_16x16x32_bf16 v[232:235], a[48:51], a[92:95], v[232:235]
ds_read_b64_tr_b16 a[86:87], v12 offset:9216
v_cvt_pk_bf16_f32 v147, v150, v151
v_mfma_f32_16x16x32_bf16 v[232:235], a[32:35], a[88:91], v[232:235]
s_add_u32 m0, s17, 0x8400
s_waitcnt lgkmcnt(4)
v_accvgpr_write_b32 a188, v144
v_mfma_f32_16x16x32_bf16 v[248:251], a[32:35], a[96:99], v[248:251]
buffer_load_dwordx4 v5, s[52:55], s13 offen lds
v_accvgpr_write_b32 a189, v145
v_mfma_f32_16x16x32_bf16 v[248:251], a[48:51], a[100:103], v[248:251]
ds_read_b64_tr_b16 a[88:89], v13 offset:0
v_accvgpr_write_b32 a190, v146
v_mfma_f32_16x16x32_bf16 v[252:255], a[52:55], a[100:103], v[252:255]
ds_read_b64_tr_b16 a[90:91], v13 offset:1024
v_accvgpr_write_b32 a191, v147
v_mfma_f32_16x16x32_bf16 v[252:255], a[36:39], a[96:99], v[252:255]
ds_read_b64_tr_b16 a[92:93], v13 offset:8192
v_cvt_pk_bf16_f32 v152, v152, v153
v_cvt_pk_bf16_f32 v153, v154, v155
v_mfma_f32_16x16x32_bf16 a[232:235], a[40:43], a[96:99], a[232:235]
ds_read_b64_tr_b16 a[94:95], v13 offset:9216
v_cvt_pk_bf16_f32 v154, v156, v157
v_mfma_f32_16x16x32_bf16 a[232:235], a[56:59], a[100:103], a[232:235]
v_cvt_pk_bf16_f32 v155, v158, v159
v_accvgpr_write_b32 a192, v152
v_mfma_f32_16x16x32_bf16 a[236:239], a[60:63], a[100:103], a[236:239]
s_add_u32 m0, s17, 0x8800
v_accvgpr_write_b32 a193, v153
v_accvgpr_write_b32 a194, v154
v_accvgpr_write_b32 a195, v155
v_mfma_f32_16x16x32_bf16 a[236:239], a[44:47], a[96:99], a[236:239]
buffer_load_dwordx4 v6, s[52:55], 0 offen lds
v_mfma_f32_16x16x32_bf16 a[252:255], a[44:47], a[104:107], a[252:255]
ds_read_b64_tr_b16 a[96:97], v12 offset:256
v_cvt_pk_bf16_f32 v160, v160, v161
v_mfma_f32_16x16x32_bf16 a[252:255], a[60:63], a[108:111], a[252:255]
ds_read_b64_tr_b16 a[98:99], v12 offset:1280
v_cvt_pk_bf16_f32 v161, v162, v163
v_cvt_pk_bf16_f32 v162, v164, v165
v_mfma_f32_16x16x32_bf16 a[248:251], a[56:59], a[108:111], a[248:251]
ds_read_b64_tr_b16 a[100:101], v12 offset:8448
v_cvt_pk_bf16_f32 v163, v166, v167
v_mfma_f32_16x16x32_bf16 a[248:251], a[40:43], a[104:107], a[248:251]
ds_read_b64_tr_b16 a[102:103], v12 offset:9472
v_accvgpr_write_b32 a196, v160
v_mfma_f32_16x16x32_bf16 a[244:247], a[36:39], a[104:107], a[244:247]
v_accvgpr_write_b32 a197, v161
v_accvgpr_write_b32 a198, v162
v_accvgpr_write_b32 a199, v163
v_mfma_f32_16x16x32_bf16 a[244:247], a[52:55], a[108:111], a[244:247]
s_add_u32 m0, s17, 0x8c00
v_cvt_pk_bf16_f32 v168, v168, v169
v_cvt_pk_bf16_f32 v169, v170, v171
v_mfma_f32_16x16x32_bf16 a[240:243], a[48:51], a[108:111], a[240:243]
buffer_load_dwordx4 v6, s[52:55], s13 offen lds
v_mfma_f32_16x16x32_bf16 a[240:243], a[32:35], a[104:107], a[240:243]
s_waitcnt lgkmcnt(4)
v_cvt_pk_bf16_f32 v170, v172, v173
v_cvt_pk_bf16_f32 v171, v174, v175
v_accvgpr_write_b32 a200, v168
L_S8:
v_mfma_f32_16x16x32_bf16 v[24:27], a[80:83], a[0:3], 0
ds_read_b64_tr_b16 a[104:105], v13 offset:256
s_waitcnt vmcnt(22)
v_mfma_f32_16x16x32_bf16 v[24:27], a[84:87], a[16:19], v[24:27]
ds_read_b64_tr_b16 a[106:107], v13 offset:1280
v_accvgpr_write_b32 a201, v169
v_mfma_f32_16x16x32_bf16 v[32:35], a[84:87], a[20:23], 0
ds_read_b64_tr_b16 a[108:109], v13 offset:8448
v_accvgpr_write_b32 a202, v170
v_accvgpr_write_b32 a203, v171
v_mfma_f32_16x16x32_bf16 v[32:35], a[80:83], a[4:7], v[32:35]
ds_read_b64_tr_b16 a[110:111], v13 offset:9472
v_cvt_pk_bf16_f32 v176, v176, v177
v_mfma_f32_16x16x32_bf16 v[40:43], a[80:83], a[8:11], 0
ds_read_b128 a[32:35], v8 offset:32768
s_add_u32 m0, s18, 0xc000
v_mfma_f32_16x16x32_bf16 v[40:43], a[84:87], a[24:27], v[40:43]
buffer_load_dwordx4 v7, s[68:71], 0 offen lds
v_cvt_pk_bf16_f32 v177, v178, v179
v_mfma_f32_16x16x32_bf16 v[48:51], a[84:87], a[28:31], 0
ds_read_b128 a[48:51], v9 offset:32768
v_cvt_pk_bf16_f32 v178, v180, v181
v_mfma_f32_16x16x32_bf16 v[48:51], a[80:83], a[12:15], v[48:51]
ds_read_b128 a[36:39], v8 offset:34816
v_cvt_pk_bf16_f32 v179, v182, v183
v_mfma_f32_16x16x32_bf16 v[52:55], a[88:91], a[12:15], 0
ds_read_b64_tr_b16 a[80:81], v12 offset:512
v_accvgpr_write_b32 a204, v176
v_accvgpr_write_b32 a205, v177
v_mfma_f32_16x16x32_bf16 v[52:55], a[92:95], a[28:31], v[52:55]
ds_read_b64_tr_b16 a[82:83], v12 offset:1536
v_accvgpr_write_b32 a206, v178
v_mfma_f32_16x16x32_bf16 v[44:47], a[92:95], a[24:27], 0
ds_read_b64_tr_b16 a[84:85], v12 offset:8704
s_add_u32 s8, s28, 0x2000
v_mfma_f32_16x16x32_bf16 v[44:47], a[88:91], a[8:11], v[44:47]
buffer_store_dwordx4 a[128:131], v16, s[88:91], s8 offen sc1
v_accvgpr_write_b32 a207, v179
v_mfma_f32_16x16x32_bf16 v[36:39], a[88:91], a[4:7], 0
ds_read_b64_tr_b16 a[86:87], v12 offset:9728
v_cvt_pk_bf16_f32 v184, v184, v185
v_mfma_f32_16x16x32_bf16 v[36:39], a[92:95], a[20:23], v[36:39]
ds_read_b128 a[52:55], v9 offset:34816
v_cvt_pk_bf16_f32 v185, v186, v187
v_mfma_f32_16x16x32_bf16 v[28:31], a[92:95], a[16:19], 0
ds_read_b128 a[40:43], v8 offset:36864
v_cvt_pk_bf16_f32 v186, v188, v189
v_cvt_pk_bf16_f32 v187, v190, v191
v_mfma_f32_16x16x32_bf16 v[28:31], a[88:91], a[0:3], v[28:31]
ds_read_b128 a[56:59], v9 offset:36864
s_waitcnt lgkmcnt(10)
v_mfma_f32_16x16x32_bf16 v[56:59], a[96:99], a[0:3], 0
ds_read_b64_tr_b16 a[88:89], v13 offset:512
v_accvgpr_write_b32 a208, v184
v_mfma_f32_16x16x32_bf16 v[56:59], a[100:103], a[16:19], v[56:59]
ds_read_b64_tr_b16 a[90:91], v13 offset:1536
s_add_u32 m0, s18, 0xd000
v_accvgpr_write_b32 a209, v185
v_mfma_f32_16x16x32_bf16 v[64:67], a[100:103], a[20:23], 0
buffer_load_dwordx4 v7, s[68:71], s25 offen lds
v_mfma_f32_16x16x32_bf16 v[64:67], a[96:99], a[4:7], v[64:67]
ds_read_b64_tr_b16 a[92:93], v13 offset:8704
v_accvgpr_write_b32 a210, v186
v_mfma_f32_16x16x32_bf16 v[72:75], a[96:99], a[8:11], 0
ds_read_b64_tr_b16 a[94:95], v13 offset:9728
v_accvgpr_write_b32 a211, v187
v_cvt_pk_bf16_f32 v192, v192, v193
v_mfma_f32_16x16x32_bf16 v[72:75], a[100:103], a[24:27], v[72:75]
ds_read_b128 a[44:47], v8 offset:38912
v_cvt_pk_bf16_f32 v193, v194, v195
v_mfma_f32_16x16x32_bf16 v[80:83], a[100:103], a[28:31], 0
ds_read_b128 a[60:63], v9 offset:38912
v_cvt_pk_bf16_f32 v194, v196, v197
v_mfma_f32_16x16x32_bf16 v[80:83], a[96:99], a[12:15], v[80:83]
v_cvt_pk_bf16_f32 v195, v198, v199
v_accvgpr_write_b32 a212, v192
v_accvgpr_write_b32 a213, v193
v_mfma_f32_16x16x32_bf16 v[84:87], a[104:107], a[12:15], 0
ds_read_b64_tr_b16 a[96:97], v12 offset:768
s_add_u32 m0, s18, 0xe000
v_mfma_f32_16x16x32_bf16 v[84:87], a[108:111], a[28:31], v[84:87]
buffer_load_dwordx4 v7, s[68:71], s26 offen lds
v_mfma_f32_16x16x32_bf16 v[76:79], a[108:111], a[24:27], 0
ds_read_b64_tr_b16 a[98:99], v12 offset:1792
v_lshl_add_u32 v5, s42, 19, v5
v_accvgpr_write_b32 a214, v194
v_mfma_f32_16x16x32_bf16 v[76:79], a[104:107], a[8:11], v[76:79]
ds_read_b64_tr_b16 a[100:101], v12 offset:8960
v_lshl_add_u32 v6, s42, 19, v6
v_mfma_f32_16x16x32_bf16 v[68:71], a[104:107], a[4:7], 0
ds_read_b64_tr_b16 a[102:103], v12 offset:9984
v_lshl_add_u32 v7, s42, 18, v7
v_mfma_f32_16x16x32_bf16 v[68:71], a[108:111], a[20:23], v[68:71]
v_lshl_add_u32 v7, s42, 17, v7
v_accvgpr_write_b32 a215, v195
v_cvt_pk_bf16_f32 v200, v200, v201
v_mfma_f32_16x16x32_bf16 v[60:63], a[108:111], a[16:19], 0
v_cvt_pk_bf16_f32 v201, v202, v203
v_cvt_pk_bf16_f32 v202, v204, v205
v_mfma_f32_16x16x32_bf16 v[60:63], a[104:107], a[0:3], v[60:63]
s_add_u32 m0, s16, 0x8000
s_waitcnt lgkmcnt(4)
s_waitcnt lgkmcnt(6)
v_mfma_f32_16x16x32_bf16 v[88:91], a[80:83], a[0:3], 0
buffer_load_dwordx4 v22, s[44:47], s20 offen lds
v_cvt_pk_bf16_f32 v203, v206, v207
v_mfma_f32_16x16x32_bf16 v[88:91], a[84:87], a[16:19], v[88:91]
ds_read_b64_tr_b16 a[104:105], v13 offset:768
v_accvgpr_write_b32 a216, v200
v_mfma_f32_16x16x32_bf16 v[96:99], a[84:87], a[20:23], 0
ds_read_b64_tr_b16 a[106:107], v13 offset:1792
v_accvgpr_write_b32 a217, v201
v_mfma_f32_16x16x32_bf16 v[96:99], a[80:83], a[4:7], v[96:99]
ds_read_b64_tr_b16 a[108:109], v13 offset:8960
v_accvgpr_write_b32 a218, v202
v_accvgpr_write_b32 a219, v203
v_mfma_f32_16x16x32_bf16 v[104:107], a[80:83], a[8:11], 0
ds_read_b64_tr_b16 a[110:111], v13 offset:9984
s_add_u32 m0, s16, 0x8400
v_mfma_f32_16x16x32_bf16 v[104:107], a[84:87], a[24:27], v[104:107]
buffer_load_dwordx4 v23, s[44:47], s20 offen lds
v_mfma_f32_16x16x32_bf16 v[112:115], a[84:87], a[28:31], 0
v_cvt_pk_bf16_f32 v208, v208, v209
v_cvt_pk_bf16_f32 v209, v210, v211
v_cvt_pk_bf16_f32 v210, v212, v213
v_mfma_f32_16x16x32_bf16 v[112:115], a[80:83], a[12:15], v[112:115]
v_cvt_pk_bf16_f32 v211, v214, v215
v_accvgpr_write_b32 a220, v208
v_mfma_f32_16x16x32_bf16 v[116:119], a[88:91], a[12:15], 0
ds_read_b64_tr_b16 a[80:81], v14 offset:0
v_accvgpr_write_b32 a221, v209
v_mfma_f32_16x16x32_bf16 v[116:119], a[92:95], a[28:31], v[116:119]
ds_read_b64_tr_b16 a[82:83], v14 offset:256
v_accvgpr_write_b32 a222, v210
v_accvgpr_write_b32 a223, v211
v_mfma_f32_16x16x32_bf16 v[108:111], a[92:95], a[24:27], 0
ds_read_b64_tr_b16 a[84:85], v14 offset:2048
s_add_u32 m0, s16, 0x8800
v_mfma_f32_16x16x32_bf16 v[108:111], a[88:91], a[8:11], v[108:111]
buffer_load_dwordx4 v22, s[44:47], s21 offen lds
v_mfma_f32_16x16x32_bf16 v[100:103], a[88:91], a[4:7], 0
ds_read_b64_tr_b16 a[86:87], v14 offset:2304
v_cvt_pk_bf16_f32 v216, v216, v217
v_cvt_pk_bf16_f32 v217, v218, v219
v_mfma_f32_16x16x32_bf16 v[100:103], a[92:95], a[20:23], v[100:103]
v_cvt_pk_bf16_f32 v218, v220, v221
v_cvt_pk_bf16_f32 v219, v222, v223
v_mfma_f32_16x16x32_bf16 v[92:95], a[92:95], a[16:19], 0
v_accvgpr_write_b32 a224, v216
v_accvgpr_write_b32 a225, v217
v_mfma_f32_16x16x32_bf16 v[92:95], a[88:91], a[0:3], v[92:95]
s_add_u32 s8, s28, 0x3000
s_waitcnt lgkmcnt(4)
v_accvgpr_write_b32 a226, v218
v_accvgpr_write_b32 a227, v219
v_mfma_f32_16x16x32_bf16 v[120:123], a[96:99], a[0:3], 0
buffer_store_dwordx4 a[132:135], v16, s[88:91], s8 offen sc1
v_mfma_f32_16x16x32_bf16 v[120:123], a[100:103], a[16:19], v[120:123]
ds_read_b64_tr_b16 a[88:89], v15 offset:0
v_cvt_pk_bf16_f32 v224, v224, v225
v_mfma_f32_16x16x32_bf16 v[128:131], a[100:103], a[20:23], 0
ds_read_b64_tr_b16 a[90:91], v15 offset:256
v_cvt_pk_bf16_f32 v225, v226, v227
v_cvt_pk_bf16_f32 v226, v228, v229
v_mfma_f32_16x16x32_bf16 v[128:131], a[96:99], a[4:7], v[128:131]
ds_read_b64_tr_b16 a[92:93], v15 offset:2048
v_cvt_pk_bf16_f32 v227, v230, v231
v_mfma_f32_16x16x32_bf16 v[136:139], a[96:99], a[8:11], 0
ds_read_b64_tr_b16 a[94:95], v15 offset:2304
v_accvgpr_write_b32 a228, v224
v_mfma_f32_16x16x32_bf16 v[136:139], a[100:103], a[24:27], v[136:139]
s_add_u32 m0, s16, 0x8c00
v_accvgpr_write_b32 a229, v225
v_accvgpr_write_b32 a230, v226
v_accvgpr_write_b32 a231, v227
v_mfma_f32_16x16x32_bf16 v[144:147], a[100:103], a[28:31], 0
buffer_load_dwordx4 v23, s[44:47], s21 offen lds
v_mfma_f32_16x16x32_bf16 v[144:147], a[96:99], a[12:15], v[144:147]
v_cvt_pk_bf16_f32 v232, v232, v233
v_cvt_pk_bf16_f32 v233, v234, v235
v_mfma_f32_16x16x32_bf16 v[148:151], a[104:107], a[12:15], 0
ds_read_b64_tr_b16 a[96:97], v14 offset:4096
v_cvt_pk_bf16_f32 v234, v236, v237
v_cvt_pk_bf16_f32 v235, v238, v239
v_mfma_f32_16x16x32_bf16 v[148:151], a[108:111], a[28:31], v[148:151]
ds_read_b64_tr_b16 a[98:99], v14 offset:4352
v_accvgpr_write_b32 a112, v232
v_mfma_f32_16x16x32_bf16 v[140:143], a[108:111], a[24:27], 0
ds_read_b64_tr_b16 a[100:101], v14 offset:6144
v_accvgpr_write_b32 a113, v233
v_mfma_f32_16x16x32_bf16 v[140:143], a[104:107], a[8:11], v[140:143]
ds_read_b64_tr_b16 a[102:103], v14 offset:6400
s_add_u32 m0, s16, 0x9000
v_accvgpr_write_b32 a114, v234
v_mfma_f32_16x16x32_bf16 v[132:135], a[104:107], a[4:7], 0
buffer_load_dwordx4 v22, s[44:47], s22 offen lds
v_mfma_f32_16x16x32_bf16 v[132:135], a[108:111], a[20:23], v[132:135]
v_accvgpr_write_b32 a115, v235
v_cvt_pk_bf16_f32 v240, v240, v241
v_mfma_f32_16x16x32_bf16 v[124:127], a[108:111], a[16:19], 0
v_cvt_pk_bf16_f32 v241, v242, v243
v_cvt_pk_bf16_f32 v242, v244, v245
v_cvt_pk_bf16_f32 v243, v246, v247
v_mfma_f32_16x16x32_bf16 v[124:127], a[104:107], a[0:3], v[124:127]
s_waitcnt lgkmcnt(4)
v_accvgpr_write_b32 a116, v240
v_accvgpr_write_b32 a117, v241
v_mfma_f32_16x16x32_bf16 v[152:155], a[80:83], a[0:3], 0
ds_read_b64_tr_b16 a[104:105], v15 offset:4096
s_add_u32 m0, s16, 0x9400
v_mfma_f32_16x16x32_bf16 v[152:155], a[84:87], a[16:19], v[152:155]
buffer_load_dwordx4 v23, s[44:47], s22 offen lds
v_accvgpr_write_b32 a118, v242
v_mfma_f32_16x16x32_bf16 v[160:163], a[84:87], a[20:23], 0
ds_read_b64_tr_b16 a[106:107], v15 offset:4352
v_accvgpr_write_b32 a119, v243
v_mfma_f32_16x16x32_bf16 v[160:163], a[80:83], a[4:7], v[160:163]
ds_read_b64_tr_b16 a[108:109], v15 offset:6144
v_cvt_pk_bf16_f32 v248, v248, v249
v_mfma_f32_16x16x32_bf16 v[168:171], a[80:83], a[8:11], 0
ds_read_b64_tr_b16 a[110:111], v15 offset:6400
v_cvt_pk_bf16_f32 v249, v250, v251
v_cvt_pk_bf16_f32 v250, v252, v253
v_mfma_f32_16x16x32_bf16 v[168:171], a[84:87], a[24:27], v[168:171]
v_cvt_pk_bf16_f32 v251, v254, v255
v_accvgpr_write_b32 a124, v248
v_mfma_f32_16x16x32_bf16 v[176:179], a[84:87], a[28:31], 0
s_add_u32 m0, s16, 0x9800
v_accvgpr_write_b32 a125, v249
v_accvgpr_write_b32 a126, v250
v_mfma_f32_16x16x32_bf16 v[176:179], a[80:83], a[12:15], v[176:179]
buffer_load_dwordx4 v22, s[44:47], s23 offen lds
v_accvgpr_write_b32 a127, v251
v_mfma_f32_16x16x32_bf16 v[180:183], a[88:91], a[12:15], 0
ds_read_b64_tr_b16 a[80:81], v14 offset:8192
v_accvgpr_read_b32 v2, a232
v_mfma_f32_16x16x32_bf16 v[180:183], a[92:95], a[28:31], v[180:183]
ds_read_b64_tr_b16 a[82:83], v14 offset:8448
v_accvgpr_read_b32 v3, a233
v_mfma_f32_16x16x32_bf16 v[172:175], a[92:95], a[24:27], 0
ds_read_b64_tr_b16 a[84:85], v14 offset:10240
v_cvt_pk_bf16_f32 v2, v2, v3
v_accvgpr_write_b32 a232, v2
v_mfma_f32_16x16x32_bf16 v[172:175], a[88:91], a[8:11], v[172:175]
ds_read_b64_tr_b16 a[86:87], v14 offset:10496
s_add_u32 m0, s16, 0x9c00
v_mfma_f32_16x16x32_bf16 v[164:167], a[88:91], a[4:7], 0
buffer_load_dwordx4 v23, s[44:47], s23 offen lds
v_mfma_f32_16x16x32_bf16 v[164:167], a[92:95], a[20:23], v[164:167]
v_lshl_add_u32 v22, s42, 7, v22
v_lshl_add_u32 v23, s42, 7, v23
v_accvgpr_read_b32 v2, a234
v_mfma_f32_16x16x32_bf16 v[156:159], a[92:95], a[16:19], 0
v_accvgpr_read_b32 v3, a235
v_cvt_pk_bf16_f32 v2, v2, v3
v_mfma_f32_16x16x32_bf16 v[156:159], a[88:91], a[0:3], v[156:159]
s_waitcnt lgkmcnt(4)
v_accvgpr_write_b32 a233, v2
v_accvgpr_read_b32 v2, a236
v_mfma_f32_16x16x32_bf16 v[184:187], a[96:99], a[0:3], 0
ds_read_b64_tr_b16 a[88:89], v15 offset:8192
v_accvgpr_read_b32 v3, a237
v_cvt_pk_bf16_f32 v2, v2, v3
v_mfma_f32_16x16x32_bf16 v[184:187], a[100:103], a[16:19], v[184:187]
ds_read_b64_tr_b16 a[90:91], v15 offset:8448
s_add_u32 s8, s28, 0x6000
v_mfma_f32_16x16x32_bf16 v[192:195], a[100:103], a[20:23], 0
buffer_store_dwordx4 a[136:139], v16, s[88:91], s8 offen sc1
v_mfma_f32_16x16x32_bf16 v[192:195], a[96:99], a[4:7], v[192:195]
ds_read_b64_tr_b16 a[92:93], v15 offset:10240
v_accvgpr_write_b32 a234, v2
v_accvgpr_read_b32 v2, a238
v_mfma_f32_16x16x32_bf16 v[200:203], a[96:99], a[8:11], 0
ds_read_b64_tr_b16 a[94:95], v15 offset:10496
v_add_u32 v12, 0xffff0000, v12
v_mfma_f32_16x16x32_bf16 v[200:203], a[100:103], a[24:27], v[200:203]
v_add_u32 v13, 0xffff0000, v13
v_add_u32 v14, 0xffff0000, v14
v_mfma_f32_16x16x32_bf16 v[208:211], a[100:103], a[28:31], 0
v_add_u32 v15, 0xffff0000, v15
v_accvgpr_read_b32 v3, a239
v_cvt_pk_bf16_f32 v2, v2, v3
v_mfma_f32_16x16x32_bf16 v[208:211], a[96:99], a[12:15], v[208:211]
v_accvgpr_write_b32 a235, v2
v_accvgpr_read_b32 v2, a240
v_mfma_f32_16x16x32_bf16 v[212:215], a[104:107], a[12:15], 0
s_waitcnt vmcnt(28) lgkmcnt(0)
v_accvgpr_read_b32 v3, a241
v_cvt_pk_bf16_f32 v2, v2, v3
v_mfma_f32_16x16x32_bf16 v[212:215], a[108:111], a[28:31], v[212:215]
s_barrier
s_add_u32 m0, s17, 0x10000
v_accvgpr_write_b32 a240, v2
v_accvgpr_read_b32 v2, a242
v_mfma_f32_16x16x32_bf16 v[204:207], a[108:111], a[24:27], 0
buffer_load_dwordx4 v5, s[52:55], 0 offen lds
v_mfma_f32_16x16x32_bf16 v[204:207], a[104:107], a[8:11], v[204:207]
ds_read_b64_tr_b16 a[96:97], v12 offset:0
v_accvgpr_read_b32 v3, a243
v_mfma_f32_16x16x32_bf16 v[196:199], a[104:107], a[4:7], 0
ds_read_b64_tr_b16 a[98:99], v12 offset:1024
v_cvt_pk_bf16_f32 v2, v2, v3
v_accvgpr_write_b32 a241, v2
v_mfma_f32_16x16x32_bf16 v[196:199], a[108:111], a[20:23], v[196:199]
ds_read_b64_tr_b16 a[100:101], v12 offset:8192
v_accvgpr_read_b32 v2, a244
v_mfma_f32_16x16x32_bf16 v[188:191], a[108:111], a[16:19], 0
ds_read_b64_tr_b16 a[102:103], v12 offset:9216
v_accvgpr_read_b32 v3, a245
v_mfma_f32_16x16x32_bf16 v[188:191], a[104:107], a[0:3], v[188:191]
s_add_u32 m0, s17, 0x10400
s_waitcnt lgkmcnt(4)
v_cvt_pk_bf16_f32 v2, v2, v3
v_accvgpr_write_b32 a242, v2
v_mfma_f32_16x16x32_bf16 v[216:219], a[0:3], a[80:83], 0
buffer_load_dwordx4 v5, s[52:55], s13 offen lds
v_mfma_f32_16x16x32_bf16 v[216:219], a[16:19], a[84:87], v[216:219]
ds_read_b64_tr_b16 a[104:105], v13 offset:0
v_accvgpr_read_b32 v2, a246
v_mfma_f32_16x16x32_bf16 v[224:227], a[20:23], a[84:87], 0
ds_read_b64_tr_b16 a[106:107], v13 offset:1024
v_accvgpr_read_b32 v3, a247
v_cvt_pk_bf16_f32 v2, v2, v3
v_mfma_f32_16x16x32_bf16 v[224:227], a[4:7], a[80:83], v[224:227]
ds_read_b64_tr_b16 a[108:109], v13 offset:8192
v_accvgpr_write_b32 a243, v2
v_mfma_f32_16x16x32_bf16 v[232:235], a[8:11], a[80:83], 0
ds_read_b64_tr_b16 a[110:111], v13 offset:9216
v_accvgpr_read_b32 v2, a248
v_mfma_f32_16x16x32_bf16 v[232:235], a[24:27], a[84:87], v[232:235]
v_accvgpr_read_b32 v3, a249
v_cvt_pk_bf16_f32 v2, v2, v3
v_accvgpr_write_b32 a248, v2
v_mfma_f32_16x16x32_bf16 v[240:243], a[28:31], a[84:87], 0
s_add_u32 m0, s17, 0x10800
v_accvgpr_read_b32 v2, a250
v_accvgpr_read_b32 v3, a251
v_mfma_f32_16x16x32_bf16 v[240:243], a[12:15], a[80:83], v[240:243]
buffer_load_dwordx4 v6, s[52:55], 0 offen lds
v_mfma_f32_16x16x32_bf16 v[244:247], a[12:15], a[88:91], 0
ds_read_b64_tr_b16 a[80:81], v12 offset:256
v_cvt_pk_bf16_f32 v2, v2, v3
v_accvgpr_write_b32 a249, v2
v_mfma_f32_16x16x32_bf16 v[244:247], a[28:31], a[92:95], v[244:247]
ds_read_b64_tr_b16 a[82:83], v12 offset:1280
v_accvgpr_read_b32 v2, a252
v_mfma_f32_16x16x32_bf16 v[236:239], a[24:27], a[92:95], 0
ds_read_b64_tr_b16 a[84:85], v12 offset:8448
v_accvgpr_read_b32 v3, a253
v_mfma_f32_16x16x32_bf16 v[236:239], a[8:11], a[88:91], v[236:239]
ds_read_b64_tr_b16 a[86:87], v12 offset:9472
v_cvt_pk_bf16_f32 v2, v2, v3
v_accvgpr_write_b32 a250, v2
v_mfma_f32_16x16x32_bf16 v[228:231], a[4:7], a[88:91], 0
v_accvgpr_read_b32 v2, a254
v_accvgpr_read_b32 v3, a255
v_mfma_f32_16x16x32_bf16 v[228:231], a[20:23], a[92:95], v[228:231]
s_add_u32 m0, s17, 0x10c00
v_cvt_pk_bf16_f32 v2, v2, v3
v_accvgpr_write_b32 a251, v2
v_mfma_f32_16x16x32_bf16 v[220:223], a[16:19], a[92:95], 0
buffer_load_dwordx4 v6, s[52:55], s13 offen lds
v_mfma_f32_16x16x32_bf16 v[220:223], a[0:3], a[88:91], v[220:223]
s_waitcnt lgkmcnt(4)
L_S9:
v_mfma_f32_16x16x32_bf16 v[24:27], a[96:99], a[32:35], v[24:27]
ds_read_b64_tr_b16 a[88:89], v13 offset:256
s_waitcnt vmcnt(23)
v_mfma_f32_16x16x32_bf16 v[24:27], a[100:103], a[48:51], v[24:27]
ds_read_b64_tr_b16 a[90:91], v13 offset:1280
L_padA5:
s_cmp_eq_u32 s95, 1
s_cbranch_scc1 L_padA9
v_mfma_f32_16x16x32_bf16 v[32:35], a[100:103], a[52:55], v[32:35]
ds_read_b64_tr_b16 a[92:93], v13 offset:8448
v_mfma_f32_16x16x32_bf16 v[32:35], a[96:99], a[36:39], v[32:35]
ds_read_b64_tr_b16 a[94:95], v13 offset:9472
v_mfma_f32_16x16x32_bf16 v[40:43], a[96:99], a[40:43], v[40:43]
ds_read_b128 a[0:3], v8 offset:0
s_add_u32 m0, s18, 0x14000
v_mfma_f32_16x16x32_bf16 v[40:43], a[100:103], a[56:59], v[40:43]
buffer_load_dwordx4 v7, s[68:71], 0 offen lds
v_mfma_f32_16x16x32_bf16 v[48:51], a[100:103], a[60:63], v[48:51]
ds_read_b128 a[16:19], v9 offset:0
v_mfma_f32_16x16x32_bf16 v[48:51], a[96:99], a[44:47], v[48:51]
ds_read_b128 a[4:7], v8 offset:2048
v_mfma_f32_16x16x32_bf16 v[52:55], a[104:107], a[44:47], v[52:55]
ds_read_b64_tr_b16 a[96:97], v12 offset:512
v_mfma_f32_16x16x32_bf16 v[52:55], a[108:111], a[60:63], v[52:55]
ds_read_b64_tr_b16 a[98:99], v12 offset:1536
v_mfma_f32_16x16x32_bf16 v[44:47], a[108:111], a[56:59], v[44:47]
ds_read_b64_tr_b16 a[100:101], v12 offset:8704
s_add_u32 s8, s28, 0x7000
v_mfma_f32_16x16x32_bf16 v[44:47], a[104:107], a[40:43], v[44:47]
buffer_store_dwordx4 a[140:143], v16, s[88:91], s8 offen sc1
v_mfma_f32_16x16x32_bf16 v[36:39], a[104:107], a[36:39], v[36:39]
ds_read_b64_tr_b16 a[102:103], v12 offset:9728
v_mfma_f32_16x16x32_bf16 v[36:39], a[108:111], a[52:55], v[36:39]
ds_read_b128 a[20:23], v9 offset:2048
v_mfma_f32_16x16x32_bf16 v[28:31], a[108:111], a[48:51], v[28:31]
ds_read_b128 a[8:11], v8 offset:4096
v_mfma_f32_16x16x32_bf16 v[28:31], a[104:107], a[32:35], v[28:31]
ds_read_b128 a[24:27], v9 offset:4096
s_waitcnt lgkmcnt(10)
v_mfma_f32_16x16x32_bf16 v[56:59], a[80:83], a[32:35], v[56:59]
ds_read_b64_tr_b16 a[104:105], v13 offset:512
v_mfma_f32_16x16x32_bf16 v[56:59], a[84:87], a[48:51], v[56:59]
ds_read_b64_tr_b16 a[106:107], v13 offset:1536
s_add_u32 m0, s18, 0x15000
v_mfma_f32_16x16x32_bf16 v[64:67], a[84:87], a[52:55], v[64:67]
buffer_load_dwordx4 v7, s[68:71], s25 offen lds
v_mfma_f32_16x16x32_bf16 v[64:67], a[80:83], a[36:39], v[64:67]
ds_read_b64_tr_b16 a[108:109], v13 offset:8704
v_mfma_f32_16x16x32_bf16 v[72:75], a[80:83], a[40:43], v[72:75]
ds_read_b64_tr_b16 a[110:111], v13 offset:9728
v_mfma_f32_16x16x32_bf16 v[72:75], a[84:87], a[56:59], v[72:75]
ds_read_b128 a[12:15], v8 offset:6144
v_mfma_f32_16x16x32_bf16 v[80:83], a[84:87], a[60:63], v[80:83]
ds_read_b128 a[28:31], v9 offset:6144
v_mfma_f32_16x16x32_bf16 v[80:83], a[80:83], a[44:47], v[80:83]
v_mfma_f32_16x16x32_bf16 v[84:87], a[88:91], a[44:47], v[84:87]
ds_read_b64_tr_b16 a[80:81], v12 offset:768
s_add_u32 m0, s18, 0x16000
v_mfma_f32_16x16x32_bf16 v[84:87], a[92:95], a[60:63], v[84:87]
buffer_load_dwordx4 v7, s[68:71], s26 offen lds
v_mfma_f32_16x16x32_bf16 v[76:79], a[92:95], a[56:59], v[76:79]
ds_read_b64_tr_b16 a[82:83], v12 offset:1792
v_lshl_add_u32 v5, s42, 19, v5
v_mfma_f32_16x16x32_bf16 v[76:79], a[88:91], a[40:43], v[76:79]
ds_read_b64_tr_b16 a[84:85], v12 offset:8960
v_lshl_add_u32 v6, s42, 19, v6
v_mfma_f32_16x16x32_bf16 v[68:71], a[88:91], a[36:39], v[68:71]
ds_read_b64_tr_b16 a[86:87], v12 offset:9984
v_lshl_add_u32 v7, s42, 18, v7
v_mfma_f32_16x16x32_bf16 v[68:71], a[92:95], a[52:55], v[68:71]
v_lshl_add_u32 v7, s42, 17, v7
v_mfma_f32_16x16x32_bf16 v[60:63], a[92:95], a[48:51], v[60:63]
v_mfma_f32_16x16x32_bf16 v[60:63], a[88:91], a[32:35], v[60:63]
s_add_u32 m0, s16, 0x0
s_waitcnt lgkmcnt(4)
s_waitcnt lgkmcnt(6)
v_mfma_f32_16x16x32_bf16 v[88:91], a[96:99], a[32:35], v[88:91]
buffer_load_dwordx4 v22, s[44:47], s20 offen lds
v_mfma_f32_16x16x32_bf16 v[88:91], a[100:103], a[48:51], v[88:91]
ds_read_b64_tr_b16 a[88:89], v13 offset:768
v_mfma_f32_16x16x32_bf16 v[96:99], a[100:103], a[52:55], v[96:99]
ds_read_b64_tr_b16 a[90:91], v13 offset:1792
v_mfma_f32_16x16x32_bf16 v[96:99], a[96:99], a[36:39], v[96:99]
ds_read_b64_tr_b16 a[92:93], v13 offset:8960
v_mfma_f32_16x16x32_bf16 v[104:107], a[96:99], a[40:43], v[104:107]
ds_read_b64_tr_b16 a[94:95], v13 offset:9984
s_add_u32 m0, s16, 0x400
v_mfma_f32_16x16x32_bf16 v[104:107], a[100:103], a[56:59], v[104:107]
buffer_load_dwordx4 v23, s[44:47], s20 offen lds
v_mfma_f32_16x16x32_bf16 v[112:115], a[100:103], a[60:63], v[112:115]
v_mfma_f32_16x16x32_bf16 v[112:115], a[96:99], a[44:47], v[112:115]
v_mfma_f32_16x16x32_bf16 v[116:119], a[104:107], a[44:47], v[116:119]
ds_read_b64_tr_b16 a[96:97], v14 offset:0
v_mfma_f32_16x16x32_bf16 v[116:119], a[108:111], a[60:63], v[116:119]
ds_read_b64_tr_b16 a[98:99], v14 offset:256
v_mfma_f32_16x16x32_bf16 v[108:111], a[108:111], a[56:59], v[108:111]
ds_read_b64_tr_b16 a[100:101], v14 offset:2048
s_add_u32 m0, s16, 0x800
v_mfma_f32_16x16x32_bf16 v[108:111], a[104:107], a[40:43], v[108:111]
buffer_load_dwordx4 v22, s[44:47], s21 offen lds
v_mfma_f32_16x16x32_bf16 v[100:103], a[104:107], a[36:39], v[100:103]
ds_read_b64_tr_b16 a[102:103], v14 offset:2304
v_mfma_f32_16x16x32_bf16 v[100:103], a[108:111], a[52:55], v[100:103]
v_mfma_f32_16x16x32_bf16 v[92:95], a[108:111], a[48:51], v[92:95]
v_mfma_f32_16x16x32_bf16 v[92:95], a[104:107], a[32:35], v[92:95]
s_add_u32 s8, s28, 0x2400
s_waitcnt lgkmcnt(4)
v_mfma_f32_16x16x32_bf16 v[120:123], a[80:83], a[32:35], v[120:123]
buffer_store_dwordx4 a[144:147], v16, s[88:91], s8 offen sc1
v_mfma_f32_16x16x32_bf16 v[120:123], a[84:87], a[48:51], v[120:123]
ds_read_b64_tr_b16 a[104:105], v15 offset:0
v_mfma_f32_16x16x32_bf16 v[128:131], a[84:87], a[52:55], v[128:131]
ds_read_b64_tr_b16 a[106:107], v15 offset:256
v_mfma_f32_16x16x32_bf16 v[128:131], a[80:83], a[36:39], v[128:131]
ds_read_b64_tr_b16 a[108:109], v15 offset:2048
v_mfma_f32_16x16x32_bf16 v[136:139], a[80:83], a[40:43], v[136:139]
ds_read_b64_tr_b16 a[110:111], v15 offset:2304
v_mfma_f32_16x16x32_bf16 v[136:139], a[84:87], a[56:59], v[136:139]
s_add_u32 m0, s16, 0xc00
v_mfma_f32_16x16x32_bf16 v[144:147], a[84:87], a[60:63], v[144:147]
buffer_load_dwordx4 v23, s[44:47], s21 offen lds
v_mfma_f32_16x16x32_bf16 v[144:147], a[80:83], a[44:47], v[144:147]
v_mfma_f32_16x16x32_bf16 v[148:151], a[88:91], a[44:47], v[148:151]
ds_read_b64_tr_b16 a[80:81], v14 offset:4096
v_mfma_f32_16x16x32_bf16 v[148:151], a[92:95], a[60:63], v[148:151]
ds_read_b64_tr_b16 a[82:83], v14 offset:4352
v_mfma_f32_16x16x32_bf16 v[140:143], a[92:95], a[56:59], v[140:143]
ds_read_b64_tr_b16 a[84:85], v14 offset:6144
v_mfma_f32_16x16x32_bf16 v[140:143], a[88:91], a[40:43], v[140:143]
ds_read_b64_tr_b16 a[86:87], v14 offset:6400
s_add_u32 m0, s16, 0x1000
v_mfma_f32_16x16x32_bf16 v[132:135], a[88:91], a[36:39], v[132:135]
buffer_load_dwordx4 v22, s[44:47], s22 offen lds
v_mfma_f32_16x16x32_bf16 v[132:135], a[92:95], a[52:55], v[132:135]
v_mfma_f32_16x16x32_bf16 v[124:127], a[92:95], a[48:51], v[124:127]
v_mfma_f32_16x16x32_bf16 v[124:127], a[88:91], a[32:35], v[124:127]
s_waitcnt lgkmcnt(4)
v_mfma_f32_16x16x32_bf16 v[152:155], a[96:99], a[32:35], v[152:155]
ds_read_b64_tr_b16 a[88:89], v15 offset:4096
s_add_u32 m0, s16, 0x1400
v_mfma_f32_16x16x32_bf16 v[152:155], a[100:103], a[48:51], v[152:155]
buffer_load_dwordx4 v23, s[44:47], s22 offen lds
v_mfma_f32_16x16x32_bf16 v[160:163], a[100:103], a[52:55], v[160:163]
ds_read_b64_tr_b16 a[90:91], v15 offset:4352
v_mfma_f32_16x16x32_bf16 v[160:163], a[96:99], a[36:39], v[160:163]
ds_read_b64_tr_b16 a[92:93], v15 offset:6144
v_mfma_f32_16x16x32_bf16 v[168:171], a[96:99], a[40:43], v[168:171]
ds_read_b64_tr_b16 a[94:95], v15 offset:6400
v_mfma_f32_16x16x32_bf16 v[168:171], a[100:103], a[56:59], v[168:171]
v_mfma_f32_16x16x32_bf16 v[176:179], a[100:103], a[60:63], v[176:179]
s_add_u32 m0, s16, 0x1800
v_mfma_f32_16x16x32_bf16 v[176:179], a[96:99], a[44:47], v[176:179]
buffer_load_dwordx4 v22, s[44:47], s23 offen lds
v_mfma_f32_16x16x32_bf16 v[180:183], a[104:107], a[44:47], v[180:183]
ds_read_b64_tr_b16 a[96:97], v14 offset:8192
v_mfma_f32_16x16x32_bf16 v[180:183], a[108:111], a[60:63], v[180:183]
ds_read_b64_tr_b16 a[98:99], v14 offset:8448
v_mfma_f32_16x16x32_bf16 v[172:175], a[108:111], a[56:59], v[172:175]
ds_read_b64_tr_b16 a[100:101], v14 offset:10240
v_mfma_f32_16x16x32_bf16 v[172:175], a[104:107], a[40:43], v[172:175]
ds_read_b64_tr_b16 a[102:103], v14 offset:10496
s_add_u32 m0, s16, 0x1c00
v_mfma_f32_16x16x32_bf16 v[164:167], a[104:107], a[36:39], v[164:167]
buffer_load_dwordx4 v23, s[44:47], s23 offen lds
v_mfma_f32_16x16x32_bf16 v[164:167], a[108:111], a[52:55], v[164:167]
v_lshl_add_u32 v22, s42, 7, v22
v_lshl_add_u32 v23, s42, 7, v23
v_mfma_f32_16x16x32_bf16 v[156:159], a[108:111], a[48:51], v[156:159]
v_mfma_f32_16x16x32_bf16 v[156:159], a[104:107], a[32:35], v[156:159]
s_waitcnt lgkmcnt(4)
v_mfma_f32_16x16x32_bf16 v[184:187], a[80:83], a[32:35], v[184:187]
ds_read_b64_tr_b16 a[104:105], v15 offset:8192
v_mfma_f32_16x16x32_bf16 v[184:187], a[84:87], a[48:51], v[184:187]
ds_read_b64_tr_b16 a[106:107], v15 offset:8448
s_add_u32 s8, s28, 0x3400
v_mfma_f32_16x16x32_bf16 v[192:195], a[84:87], a[52:55], v[192:195]
buffer_store_dwordx4 a[148:151], v16, s[88:91], s8 offen sc1
v_mfma_f32_16x16x32_bf16 v[192:195], a[80:83], a[36:39], v[192:195]
ds_read_b64_tr_b16 a[108:109], v15 offset:10240
v_mfma_f32_16x16x32_bf16 v[200:203], a[80:83], a[40:43], v[200:203]
ds_read_b64_tr_b16 a[110:111], v15 offset:10496
v_add_u32 v12, 0x8000, v12
v_mfma_f32_16x16x32_bf16 v[200:203], a[84:87], a[56:59], v[200:203]
v_add_u32 v13, 0x8000, v13
v_add_u32 v14, 0x8000, v14
v_mfma_f32_16x16x32_bf16 v[208:211], a[84:87], a[60:63], v[208:211]
v_add_u32 v15, 0x8000, v15
v_mfma_f32_16x16x32_bf16 v[208:211], a[80:83], a[44:47], v[208:211]
v_mfma_f32_16x16x32_bf16 v[212:215], a[88:91], a[44:47], v[212:215]
s_waitcnt vmcnt(28) lgkmcnt(0)
v_mfma_f32_16x16x32_bf16 v[212:215], a[92:95], a[60:63], v[212:215]
s_barrier
s_add_u32 m0, s17, 0x0
v_mfma_f32_16x16x32_bf16 v[204:207], a[92:95], a[56:59], v[204:207]
buffer_load_dwordx4 v5, s[52:55], 0 offen lds
v_mfma_f32_16x16x32_bf16 v[204:207], a[88:91], a[40:43], v[204:207]
ds_read_b64_tr_b16 a[80:81], v12 offset:0
v_mfma_f32_16x16x32_bf16 v[196:199], a[88:91], a[36:39], v[196:199]
ds_read_b64_tr_b16 a[82:83], v12 offset:1024
v_mfma_f32_16x16x32_bf16 v[196:199], a[92:95], a[52:55], v[196:199]
ds_read_b64_tr_b16 a[84:85], v12 offset:8192
v_mfma_f32_16x16x32_bf16 v[188:191], a[92:95], a[48:51], v[188:191]
ds_read_b64_tr_b16 a[86:87], v12 offset:9216
v_mfma_f32_16x16x32_bf16 v[188:191], a[88:91], a[32:35], v[188:191]
s_add_u32 m0, s17, 0x400
s_waitcnt lgkmcnt(4)
v_mfma_f32_16x16x32_bf16 v[216:219], a[32:35], a[96:99], v[216:219]
buffer_load_dwordx4 v5, s[52:55], s13 offen lds
v_mfma_f32_16x16x32_bf16 v[216:219], a[48:51], a[100:103], v[216:219]
ds_read_b64_tr_b16 a[88:89], v13 offset:0
v_mfma_f32_16x16x32_bf16 v[224:227], a[52:55], a[100:103], v[224:227]
ds_read_b64_tr_b16 a[90:91], v13 offset:1024
v_mfma_f32_16x16x32_bf16 v[224:227], a[36:39], a[96:99], v[224:227]
ds_read_b64_tr_b16 a[92:93], v13 offset:8192
v_mfma_f32_16x16x32_bf16 v[232:235], a[40:43], a[96:99], v[232:235]
ds_read_b64_tr_b16 a[94:95], v13 offset:9216
v_mfma_f32_16x16x32_bf16 v[232:235], a[56:59], a[100:103], v[232:235]
v_mfma_f32_16x16x32_bf16 v[240:243], a[60:63], a[100:103], v[240:243]
s_add_u32 m0, s17, 0x800
v_mfma_f32_16x16x32_bf16 v[240:243], a[44:47], a[96:99], v[240:243]
buffer_load_dwordx4 v6, s[52:55], 0 offen lds
v_mfma_f32_16x16x32_bf16 v[244:247], a[44:47], a[104:107], v[244:247]
ds_read_b64_tr_b16 a[96:97], v12 offset:256
v_mfma_f32_16x16x32_bf16 v[244:247], a[60:63], a[108:111], v[244:247]
ds_read_b64_tr_b16 a[98:99], v12 offset:1280
v_mfma_f32_16x16x32_bf16 v[236:239], a[56:59], a[108:111], v[236:239]
ds_read_b64_tr_b16 a[100:101], v12 offset:8448
v_mfma_f32_16x16x32_bf16 v[236:239], a[40:43], a[104:107], v[236:239]
ds_read_b64_tr_b16 a[102:103], v12 offset:9472
v_mfma_f32_16x16x32_bf16 v[228:231], a[36:39], a[104:107], v[228:231]
v_mfma_f32_16x16x32_bf16 v[228:231], a[52:55], a[108:111], v[228:231]
s_add_u32 m0, s17, 0xc00
v_mfma_f32_16x16x32_bf16 v[220:223], a[48:51], a[108:111], v[220:223]
buffer_load_dwordx4 v6, s[52:55], s13 offen lds
v_mfma_f32_16x16x32_bf16 v[220:223], a[32:35], a[104:107], v[220:223]
s_waitcnt lgkmcnt(4)
L_S10:
v_mfma_f32_16x16x32_bf16 v[24:27], a[80:83], a[0:3], v[24:27]
ds_read_b64_tr_b16 a[104:105], v13 offset:256
s_waitcnt vmcnt(23)
v_mfma_f32_16x16x32_bf16 v[24:27], a[84:87], a[16:19], v[24:27]
ds_read_b64_tr_b16 a[106:107], v13 offset:1280
v_mfma_f32_16x16x32_bf16 v[32:35], a[84:87], a[20:23], v[32:35]
ds_read_b64_tr_b16 a[108:109], v13 offset:8448
v_mfma_f32_16x16x32_bf16 v[32:35], a[80:83], a[4:7], v[32:35]
ds_read_b64_tr_b16 a[110:111], v13 offset:9472
v_mfma_f32_16x16x32_bf16 v[40:43], a[80:83], a[8:11], v[40:43]
ds_read_b128 a[32:35], v8 offset:32768
s_add_u32 m0, s18, 0x4000
v_mfma_f32_16x16x32_bf16 v[40:43], a[84:87], a[24:27], v[40:43]
buffer_load_dwordx4 v7, s[68:71], 0 offen lds
v_mfma_f32_16x16x32_bf16 v[48:51], a[84:87], a[28:31], v[48:51]
ds_read_b128 a[48:51], v9 offset:32768
v_mfma_f32_16x16x32_bf16 v[48:51], a[80:83], a[12:15], v[48:51]
ds_read_b128 a[36:39], v8 offset:34816
v_mfma_f32_16x16x32_bf16 v[52:55], a[88:91], a[12:15], v[52:55]
ds_read_b64_tr_b16 a[80:81], v12 offset:512
v_mfma_f32_16x16x32_bf16 v[52:55], a[92:95], a[28:31], v[52:55]
ds_read_b64_tr_b16 a[82:83], v12 offset:1536
v_mfma_f32_16x16x32_bf16 v[44:47], a[92:95], a[24:27], v[44:47]
ds_read_b64_tr_b16 a[84:85], v12 offset:8704
s_add_u32 s8, s28, 0x6400
v_mfma_f32_16x16x32_bf16 v[44:47], a[88:91], a[8:11], v[44:47]
buffer_store_dwordx4 a[152:155], v16, s[88:91], s8 offen sc1
v_mfma_f32_16x16x32_bf16 v[36:39], a[88:91], a[4:7], v[36:39]
ds_read_b64_tr_b16 a[86:87], v12 offset:9728
v_mfma_f32_16x16x32_bf16 v[36:39], a[92:95], a[20:23], v[36:39]
ds_read_b128 a[52:55], v9 offset:34816
v_mfma_f32_16x16x32_bf16 v[28:31], a[92:95], a[16:19], v[28:31]
ds_read_b128 a[40:43], v8 offset:36864
v_mfma_f32_16x16x32_bf16 v[28:31], a[88:91], a[0:3], v[28:31]
ds_read_b128 a[56:59], v9 offset:36864
s_waitcnt lgkmcnt(10)
v_mfma_f32_16x16x32_bf16 v[56:59], a[96:99], a[0:3], v[56:59]
ds_read_b64_tr_b16 a[88:89], v13 offset:512
v_mfma_f32_16x16x32_bf16 v[56:59], a[100:103], a[16:19], v[56:59]
ds_read_b64_tr_b16 a[90:91], v13 offset:1536
s_add_u32 m0, s18, 0x5000
v_mfma_f32_16x16x32_bf16 v[64:67], a[100:103], a[20:23], v[64:67]
buffer_load_dwordx4 v7, s[68:71], s25 offen lds
v_mfma_f32_16x16x32_bf16 v[64:67], a[96:99], a[4:7], v[64:67]
ds_read_b64_tr_b16 a[92:93], v13 offset:8704
v_mfma_f32_16x16x32_bf16 v[72:75], a[96:99], a[8:11], v[72:75]
ds_read_b64_tr_b16 a[94:95], v13 offset:9728
v_mfma_f32_16x16x32_bf16 v[72:75], a[100:103], a[24:27], v[72:75]
ds_read_b128 a[44:47], v8 offset:38912
v_mfma_f32_16x16x32_bf16 v[80:83], a[100:103], a[28:31], v[80:83]
ds_read_b128 a[60:63], v9 offset:38912
v_mfma_f32_16x16x32_bf16 v[80:83], a[96:99], a[12:15], v[80:83]
v_mfma_f32_16x16x32_bf16 v[84:87], a[104:107], a[12:15], v[84:87]
ds_read_b64_tr_b16 a[96:97], v12 offset:768
s_add_u32 m0, s18, 0x6000
v_mfma_f32_16x16x32_bf16 v[84:87], a[108:111], a[28:31], v[84:87]
buffer_load_dwordx4 v7, s[68:71], s26 offen lds
v_mfma_f32_16x16x32_bf16 v[76:79], a[108:111], a[24:27], v[76:79]
ds_read_b64_tr_b16 a[98:99], v12 offset:1792
v_lshl_add_u32 v5, s42, 19, v5
v_mfma_f32_16x16x32_bf16 v[76:79], a[104:107], a[8:11], v[76:79]
ds_read_b64_tr_b16 a[100:101], v12 offset:8960
v_lshl_add_u32 v6, s42, 19, v6
v_mfma_f32_16x16x32_bf16 v[68:71], a[104:107], a[4:7], v[68:71]
ds_read_b64_tr_b16 a[102:103], v12 offset:9984
v_lshl_add_u32 v7, s42, 18, v7
v_mfma_f32_16x16x32_bf16 v[68:71], a[108:111], a[20:23], v[68:71]
v_lshl_add_u32 v7, s42, 17, v7
v_mfma_f32_16x16x32_bf16 v[60:63], a[108:111], a[16:19], v[60:63]
v_mfma_f32_16x16x32_bf16 v[60:63], a[104:107], a[0:3], v[60:63]
s_add_u32 m0, s16, 0x8000
s_waitcnt lgkmcnt(4)
s_waitcnt lgkmcnt(6)
v_mfma_f32_16x16x32_bf16 v[88:91], a[80:83], a[0:3], v[88:91]
buffer_load_dwordx4 v22, s[44:47], s20 offen lds
v_mfma_f32_16x16x32_bf16 v[88:91], a[84:87], a[16:19], v[88:91]
ds_read_b64_tr_b16 a[104:105], v13 offset:768
v_mfma_f32_16x16x32_bf16 v[96:99], a[84:87], a[20:23], v[96:99]
ds_read_b64_tr_b16 a[106:107], v13 offset:1792
v_mfma_f32_16x16x32_bf16 v[96:99], a[80:83], a[4:7], v[96:99]
ds_read_b64_tr_b16 a[108:109], v13 offset:8960
v_mfma_f32_16x16x32_bf16 v[104:107], a[80:83], a[8:11], v[104:107]
ds_read_b64_tr_b16 a[110:111], v13 offset:9984
s_add_u32 m0, s16, 0x8400
v_mfma_f32_16x16x32_bf16 v[104:107], a[84:87], a[24:27], v[104:107]
buffer_load_dwordx4 v23, s[44:47], s20 offen lds
v_mfma_f32_16x16x32_bf16 v[112:115], a[84:87], a[28:31], v[112:115]
v_mfma_f32_16x16x32_bf16 v[112:115], a[80:83], a[12:15], v[112:115]
v_mfma_f32_16x16x32_bf16 v[116:119], a[88:91], a[12:15], v[116:119]
ds_read_b64_tr_b16 a[80:81], v14 offset:0
v_mfma_f32_16x16x32_bf16 v[116:119], a[92:95], a[28:31], v[116:119]
ds_read_b64_tr_b16 a[82:83], v14 offset:256
v_mfma_f32_16x16x32_bf16 v[108:111], a[92:95], a[24:27], v[108:111]
ds_read_b64_tr_b16 a[84:85], v14 offset:2048
s_add_u32 m0, s16, 0x8800
v_mfma_f32_16x16x32_bf16 v[108:111], a[88:91], a[8:11], v[108:111]
buffer_load_dwordx4 v22, s[44:47], s21 offen lds
v_mfma_f32_16x16x32_bf16 v[100:103], a[88:91], a[4:7], v[100:103]
ds_read_b64_tr_b16 a[86:87], v14 offset:2304
v_mfma_f32_16x16x32_bf16 v[100:103], a[92:95], a[20:23], v[100:103]
v_mfma_f32_16x16x32_bf16 v[92:95], a[92:95], a[16:19], v[92:95]
v_mfma_f32_16x16x32_bf16 v[92:95], a[88:91], a[0:3], v[92:95]
s_add_u32 s8, s28, 0x7400
s_waitcnt lgkmcnt(4)
v_mfma_f32_16x16x32_bf16 v[120:123], a[96:99], a[0:3], v[120:123]
buffer_store_dwordx4 a[156:159], v16, s[88:91], s8 offen sc1
v_mfma_f32_16x16x32_bf16 v[120:123], a[100:103], a[16:19], v[120:123]
ds_read_b64_tr_b16 a[88:89], v15 offset:0
v_mfma_f32_16x16x32_bf16 v[128:131], a[100:103], a[20:23], v[128:131]
ds_read_b64_tr_b16 a[90:91], v15 offset:256
v_mfma_f32_16x16x32_bf16 v[128:131], a[96:99], a[4:7], v[128:131]
ds_read_b64_tr_b16 a[92:93], v15 offset:2048
v_mfma_f32_16x16x32_bf16 v[136:139], a[96:99], a[8:11], v[136:139]
ds_read_b64_tr_b16 a[94:95], v15 offset:2304
v_mfma_f32_16x16x32_bf16 v[136:139], a[100:103], a[24:27], v[136:139]
s_add_u32 m0, s16, 0x8c00
v_mfma_f32_16x16x32_bf16 v[144:147], a[100:103], a[28:31], v[144:147]
buffer_load_dwordx4 v23, s[44:47], s21 offen lds
v_mfma_f32_16x16x32_bf16 v[144:147], a[96:99], a[12:15], v[144:147]
v_mfma_f32_16x16x32_bf16 v[148:151], a[104:107], a[12:15], v[148:151]
ds_read_b64_tr_b16 a[96:97], v14 offset:4096
v_mfma_f32_16x16x32_bf16 v[148:151], a[108:111], a[28:31], v[148:151]
ds_read_b64_tr_b16 a[98:99], v14 offset:4352
v_mfma_f32_16x16x32_bf16 v[140:143], a[108:111], a[24:27], v[140:143]
ds_read_b64_tr_b16 a[100:101], v14 offset:6144
v_mfma_f32_16x16x32_bf16 v[140:143], a[104:107], a[8:11], v[140:143]
ds_read_b64_tr_b16 a[102:103], v14 offset:6400
s_add_u32 m0, s16, 0x9000
v_mfma_f32_16x16x32_bf16 v[132:135], a[104:107], a[4:7], v[132:135]
buffer_load_dwordx4 v22, s[44:47], s22 offen lds
v_mfma_f32_16x16x32_bf16 v[132:135], a[108:111], a[20:23], v[132:135]
v_mfma_f32_16x16x32_bf16 v[124:127], a[108:111], a[16:19], v[124:127]
v_mfma_f32_16x16x32_bf16 v[124:127], a[104:107], a[0:3], v[124:127]
s_waitcnt lgkmcnt(4)
v_mfma_f32_16x16x32_bf16 v[152:155], a[80:83], a[0:3], v[152:155]
ds_read_b64_tr_b16 a[104:105], v15 offset:4096
s_add_u32 m0, s16, 0x9400
v_mfma_f32_16x16x32_bf16 v[152:155], a[84:87], a[16:19], v[152:155]
buffer_load_dwordx4 v23, s[44:47], s22 offen lds
v_mfma_f32_16x16x32_bf16 v[160:163], a[84:87], a[20:23], v[160:163]
ds_read_b64_tr_b16 a[106:107], v15 offset:4352
v_mfma_f32_16x16x32_bf16 v[160:163], a[80:83], a[4:7], v[160:163]
ds_read_b64_tr_b16 a[108:109], v15 offset:6144
v_mfma_f32_16x16x32_bf16 v[168:171], a[80:83], a[8:11], v[168:171]
ds_read_b64_tr_b16 a[110:111], v15 offset:6400
v_mfma_f32_16x16x32_bf16 v[168:171], a[84:87], a[24:27], v[168:171]
v_mfma_f32_16x16x32_bf16 v[176:179], a[84:87], a[28:31], v[176:179]
s_add_u32 m0, s16, 0x9800
v_mfma_f32_16x16x32_bf16 v[176:179], a[80:83], a[12:15], v[176:179]
buffer_load_dwordx4 v22, s[44:47], s23 offen lds
v_mfma_f32_16x16x32_bf16 v[180:183], a[88:91], a[12:15], v[180:183]
ds_read_b64_tr_b16 a[80:81], v14 offset:8192
v_mfma_f32_16x16x32_bf16 v[180:183], a[92:95], a[28:31], v[180:183]
ds_read_b64_tr_b16 a[82:83], v14 offset:8448
v_mfma_f32_16x16x32_bf16 v[172:175], a[92:95], a[24:27], v[172:175]
ds_read_b64_tr_b16 a[84:85], v14 offset:10240
v_mfma_f32_16x16x32_bf16 v[172:175], a[88:91], a[8:11], v[172:175]
ds_read_b64_tr_b16 a[86:87], v14 offset:10496
s_add_u32 m0, s16, 0x9c00
v_mfma_f32_16x16x32_bf16 v[164:167], a[88:91], a[4:7], v[164:167]
buffer_load_dwordx4 v23, s[44:47], s23 offen lds
v_mfma_f32_16x16x32_bf16 v[164:167], a[92:95], a[20:23], v[164:167]
v_lshl_add_u32 v22, s42, 7, v22
v_lshl_add_u32 v23, s42, 7, v23
v_mfma_f32_16x16x32_bf16 v[156:159], a[92:95], a[16:19], v[156:159]
v_mfma_f32_16x16x32_bf16 v[156:159], a[88:91], a[0:3], v[156:159]
s_waitcnt lgkmcnt(4)
v_mfma_f32_16x16x32_bf16 v[184:187], a[96:99], a[0:3], v[184:187]
ds_read_b64_tr_b16 a[88:89], v15 offset:8192
v_mfma_f32_16x16x32_bf16 v[184:187], a[100:103], a[16:19], v[184:187]
ds_read_b64_tr_b16 a[90:91], v15 offset:8448
s_add_u32 s8, s28, 0x2800
v_mfma_f32_16x16x32_bf16 v[192:195], a[100:103], a[20:23], v[192:195]
buffer_store_dwordx4 a[160:163], v16, s[88:91], s8 offen sc1
v_mfma_f32_16x16x32_bf16 v[192:195], a[96:99], a[4:7], v[192:195]
ds_read_b64_tr_b16 a[92:93], v15 offset:10240
v_mfma_f32_16x16x32_bf16 v[200:203], a[96:99], a[8:11], v[200:203]
ds_read_b64_tr_b16 a[94:95], v15 offset:10496
v_add_u32 v12, 0x8000, v12
v_mfma_f32_16x16x32_bf16 v[200:203], a[100:103], a[24:27], v[200:203]
v_add_u32 v13, 0x8000, v13
v_add_u32 v14, 0x8000, v14
v_mfma_f32_16x16x32_bf16 v[208:211], a[100:103], a[28:31], v[208:211]
v_add_u32 v15, 0x8000, v15
v_mfma_f32_16x16x32_bf16 v[208:211], a[96:99], a[12:15], v[208:211]
v_mfma_f32_16x16x32_bf16 v[212:215], a[104:107], a[12:15], v[212:215]
s_waitcnt vmcnt(28) lgkmcnt(0)
v_mfma_f32_16x16x32_bf16 v[212:215], a[108:111], a[28:31], v[212:215]
s_barrier
s_add_u32 m0, s17, 0x8000
v_mfma_f32_16x16x32_bf16 v[204:207], a[108:111], a[24:27], v[204:207]
buffer_load_dwordx4 v5, s[52:55], 0 offen lds
v_mfma_f32_16x16x32_bf16 v[204:207], a[104:107], a[8:11], v[204:207]
ds_read_b64_tr_b16 a[96:97], v12 offset:0
v_mfma_f32_16x16x32_bf16 v[196:199], a[104:107], a[4:7], v[196:199]
ds_read_b64_tr_b16 a[98:99], v12 offset:1024
v_mfma_f32_16x16x32_bf16 v[196:199], a[108:111], a[20:23], v[196:199]
ds_read_b64_tr_b16 a[100:101], v12 offset:8192
v_mfma_f32_16x16x32_bf16 v[188:191], a[108:111], a[16:19], v[188:191]
ds_read_b64_tr_b16 a[102:103], v12 offset:9216
v_mfma_f32_16x16x32_bf16 v[188:191], a[104:107], a[0:3], v[188:191]
s_add_u32 m0, s17, 0x8400
s_waitcnt lgkmcnt(4)
v_mfma_f32_16x16x32_bf16 v[216:219], a[0:3], a[80:83], v[216:219]
buffer_load_dwordx4 v5, s[52:55], s13 offen lds
v_mfma_f32_16x16x32_bf16 v[216:219], a[16:19], a[84:87], v[216:219]
ds_read_b64_tr_b16 a[104:105], v13 offset:0
v_mfma_f32_16x16x32_bf16 v[224:227], a[20:23], a[84:87], v[224:227]
ds_read_b64_tr_b16 a[106:107], v13 offset:1024
v_mfma_f32_16x16x32_bf16 v[224:227], a[4:7], a[80:83], v[224:227]
ds_read_b64_tr_b16 a[108:109], v13 offset:8192
v_mfma_f32_16x16x32_bf16 v[232:235], a[8:11], a[80:83], v[232:235]
ds_read_b64_tr_b16 a[110:111], v13 offset:9216
v_mfma_f32_16x16x32_bf16 v[232:235], a[24:27], a[84:87], v[232:235]
v_mfma_f32_16x16x32_bf16 v[240:243], a[28:31], a[84:87], v[240:243]
s_add_u32 m0, s17, 0x8800
v_mfma_f32_16x16x32_bf16 v[240:243], a[12:15], a[80:83], v[240:243]
buffer_load_dwordx4 v6, s[52:55], 0 offen lds
v_mfma_f32_16x16x32_bf16 v[244:247], a[12:15], a[88:91], v[244:247]
ds_read_b64_tr_b16 a[80:81], v12 offset:256
v_mfma_f32_16x16x32_bf16 v[244:247], a[28:31], a[92:95], v[244:247]
ds_read_b64_tr_b16 a[82:83], v12 offset:1280
v_mfma_f32_16x16x32_bf16 v[236:239], a[24:27], a[92:95], v[236:239]
ds_read_b64_tr_b16 a[84:85], v12 offset:8448
v_mfma_f32_16x16x32_bf16 v[236:239], a[8:11], a[88:91], v[236:239]
ds_read_b64_tr_b16 a[86:87], v12 offset:9472
v_mfma_f32_16x16x32_bf16 v[228:231], a[4:7], a[88:91], v[228:231]
v_mfma_f32_16x16x32_bf16 v[228:231], a[20:23], a[92:95], v[228:231]
s_add_u32 m0, s17, 0x8c00
v_mfma_f32_16x16x32_bf16 v[220:223], a[16:19], a[92:95], v[220:223]
buffer_load_dwordx4 v6, s[52:55], s13 offen lds
v_mfma_f32_16x16x32_bf16 v[220:223], a[0:3], a[88:91], v[220:223]
s_waitcnt lgkmcnt(4)
L_S11:
v_mfma_f32_16x16x32_bf16 v[24:27], a[96:99], a[32:35], v[24:27]
ds_read_b64_tr_b16 a[88:89], v13 offset:256
s_waitcnt vmcnt(23)
v_mfma_f32_16x16x32_bf16 v[24:27], a[100:103], a[48:51], v[24:27]
ds_read_b64_tr_b16 a[90:91], v13 offset:1280
v_mfma_f32_16x16x32_bf16 v[32:35], a[100:103], a[52:55], v[32:35]
ds_read_b64_tr_b16 a[92:93], v13 offset:8448
v_mfma_f32_16x16x32_bf16 v[32:35], a[96:99], a[36:39], v[32:35]
ds_read_b64_tr_b16 a[94:95], v13 offset:9472
v_mfma_f32_16x16x32_bf16 v[40:43], a[96:99], a[40:43], v[40:43]
ds_read_b128 a[0:3], v8 offset:0
s_add_u32 m0, s18, 0xc000
v_mfma_f32_16x16x32_bf16 v[40:43], a[100:103], a[56:59], v[40:43]
buffer_load_dwordx4 v7, s[68:71], 0 offen lds
v_mfma_f32_16x16x32_bf16 v[48:51], a[100:103], a[60:63], v[48:51]
ds_read_b128 a[16:19], v9 offset:0
v_mfma_f32_16x16x32_bf16 v[48:51], a[96:99], a[44:47], v[48:51]
ds_read_b128 a[4:7], v8 offset:2048
v_mfma_f32_16x16x32_bf16 v[52:55], a[104:107], a[44:47], v[52:55]
ds_read_b64_tr_b16 a[96:97], v12 offset:512
v_mfma_f32_16x16x32_bf16 v[52:55], a[108:111], a[60:63], v[52:55]
ds_read_b64_tr_b16 a[98:99], v12 offset:1536
v_mfma_f32_16x16x32_bf16 v[44:47], a[108:111], a[56:59], v[44:47]
ds_read_b64_tr_b16 a[100:101], v12 offset:8704
s_add_u32 s8, s28, 0x3800
v_mfma_f32_16x16x32_bf16 v[44:47], a[104:107], a[40:43], v[44:47]
buffer_store_dwordx4 a[164:167], v16, s[88:91], s8 offen sc1
v_mfma_f32_16x16x32_bf16 v[36:39], a[104:107], a[36:39], v[36:39]
ds_read_b64_tr_b16 a[102:103], v12 offset:9728
v_mfma_f32_16x16x32_bf16 v[36:39], a[108:111], a[52:55], v[36:39]
ds_read_b128 a[20:23], v9 offset:2048
v_mfma_f32_16x16x32_bf16 v[28:31], a[108:111], a[48:51], v[28:31]
ds_read_b128 a[8:11], v8 offset:4096
v_mfma_f32_16x16x32_bf16 v[28:31], a[104:107], a[32:35], v[28:31]
ds_read_b128 a[24:27], v9 offset:4096
s_waitcnt lgkmcnt(10)
v_mfma_f32_16x16x32_bf16 v[56:59], a[80:83], a[32:35], v[56:59]
ds_read_b64_tr_b16 a[104:105], v13 offset:512
v_mfma_f32_16x16x32_bf16 v[56:59], a[84:87], a[48:51], v[56:59]
ds_read_b64_tr_b16 a[106:107], v13 offset:1536
s_add_u32 m0, s18, 0xd000
v_mfma_f32_16x16x32_bf16 v[64:67], a[84:87], a[52:55], v[64:67]
buffer_load_dwordx4 v7, s[68:71], s25 offen lds
v_mfma_f32_16x16x32_bf16 v[64:67], a[80:83], a[36:39], v[64:67]
ds_read_b64_tr_b16 a[108:109], v13 offset:8704
v_mfma_f32_16x16x32_bf16 v[72:75], a[80:83], a[40:43], v[72:75]
ds_read_b64_tr_b16 a[110:111], v13 offset:9728
v_mfma_f32_16x16x32_bf16 v[72:75], a[84:87], a[56:59], v[72:75]
ds_read_b128 a[12:15], v8 offset:6144
v_mfma_f32_16x16x32_bf16 v[80:83], a[84:87], a[60:63], v[80:83]
ds_read_b128 a[28:31], v9 offset:6144
v_mfma_f32_16x16x32_bf16 v[80:83], a[80:83], a[44:47], v[80:83]
v_mfma_f32_16x16x32_bf16 v[84:87], a[88:91], a[44:47], v[84:87]
ds_read_b64_tr_b16 a[80:81], v12 offset:768
s_add_u32 m0, s18, 0xe000
v_mfma_f32_16x16x32_bf16 v[84:87], a[92:95], a[60:63], v[84:87]
buffer_load_dwordx4 v7, s[68:71], s26 offen lds
v_mfma_f32_16x16x32_bf16 v[76:79], a[92:95], a[56:59], v[76:79]
ds_read_b64_tr_b16 a[82:83], v12 offset:1792
v_lshl_add_u32 v5, s42, 19, v5
v_mfma_f32_16x16x32_bf16 v[76:79], a[88:91], a[40:43], v[76:79]
ds_read_b64_tr_b16 a[84:85], v12 offset:8960
v_lshl_add_u32 v6, s42, 19, v6
v_mfma_f32_16x16x32_bf16 v[68:71], a[88:91], a[36:39], v[68:71]
ds_read_b64_tr_b16 a[86:87], v12 offset:9984
v_lshl_add_u32 v7, s42, 18, v7
v_mfma_f32_16x16x32_bf16 v[68:71], a[92:95], a[52:55], v[68:71]
L_padA6:
s_cmp_eq_u32 s95, 1
s_cbranch_scc1 L_padA10
v_lshl_add_u32 v7, s42, 17, v7
v_mfma_f32_16x16x32_bf16 v[60:63], a[92:95], a[48:51], v[60:63]
v_mfma_f32_16x16x32_bf16 v[60:63], a[88:91], a[32:35], v[60:63]
s_add_u32 m0, s16, 0x0
s_waitcnt lgkmcnt(4)
s_waitcnt lgkmcnt(6)
v_mfma_f32_16x16x32_bf16 v[88:91], a[96:99], a[32:35], v[88:91]
buffer_load_dwordx4 v22, s[44:47], s20 offen lds
v_mfma_f32_16x16x32_bf16 v[88:91], a[100:103], a[48:51], v[88:91]
ds_read_b64_tr_b16 a[88:89], v13 offset:768
v_mfma_f32_16x16x32_bf16 v[96:99], a[100:103], a[52:55], v[96:99]
ds_read_b64_tr_b16 a[90:91], v13 offset:1792
v_mfma_f32_16x16x32_bf16 v[96:99], a[96:99], a[36:39], v[96:99]
ds_read_b64_tr_b16 a[92:93], v13 offset:8960
v_mfma_f32_16x16x32_bf16 v[104:107], a[96:99], a[40:43], v[104:107]
ds_read_b64_tr_b16 a[94:95], v13 offset:9984
s_add_u32 m0, s16, 0x400
v_mfma_f32_16x16x32_bf16 v[104:107], a[100:103], a[56:59], v[104:107]
buffer_load_dwordx4 v23, s[44:47], s20 offen lds
v_mfma_f32_16x16x32_bf16 v[112:115], a[100:103], a[60:63], v[112:115]
v_mfma_f32_16x16x32_bf16 v[112:115], a[96:99], a[44:47], v[112:115]
v_mfma_f32_16x16x32_bf16 v[116:119], a[104:107], a[44:47], v[116:119]
ds_read_b64_tr_b16 a[96:97], v14 offset:0
v_mfma_f32_16x16x32_bf16 v[116:119], a[108:111], a[60:63], v[116:119]
ds_read_b64_tr_b16 a[98:99], v14 offset:256
v_mfma_f32_16x16x32_bf16 v[108:111], a[108:111], a[56:59], v[108:111]
ds_read_b64_tr_b16 a[100:101], v14 offset:2048
s_add_u32 m0, s16, 0x800
v_mfma_f32_16x16x32_bf16 v[108:111], a[104:107], a[40:43], v[108:111]
buffer_load_dwordx4 v22, s[44:47], s21 offen lds
v_mfma_f32_16x16x32_bf16 v[100:103], a[104:107], a[36:39], v[100:103]
ds_read_b64_tr_b16 a[102:103], v14 offset:2304
v_mfma_f32_16x16x32_bf16 v[100:103], a[108:111], a[52:55], v[100:103]
v_mfma_f32_16x16x32_bf16 v[92:95], a[108:111], a[48:51], v[92:95]
v_mfma_f32_16x16x32_bf16 v[92:95], a[104:107], a[32:35], v[92:95]
s_add_u32 s8, s28, 0x6800
s_waitcnt lgkmcnt(4)
v_mfma_f32_16x16x32_bf16 v[120:123], a[80:83], a[32:35], v[120:123]
buffer_store_dwordx4 a[168:171], v16, s[88:91], s8 offen sc1
v_mfma_f32_16x16x32_bf16 v[120:123], a[84:87], a[48:51], v[120:123]
ds_read_b64_tr_b16 a[104:105], v15 offset:0
v_mfma_f32_16x16x32_bf16 v[128:131], a[84:87], a[52:55], v[128:131]
ds_read_b64_tr_b16 a[106:107], v15 offset:256
v_mfma_f32_16x16x32_bf16 v[128:131], a[80:83], a[36:39], v[128:131]
ds_read_b64_tr_b16 a[108:109], v15 offset:2048
v_mfma_f32_16x16x32_bf16 v[136:139], a[80:83], a[40:43], v[136:139]
ds_read_b64_tr_b16 a[110:111], v15 offset:2304
v_mfma_f32_16x16x32_bf16 v[136:139], a[84:87], a[56:59], v[136:139]
s_add_u32 m0, s16, 0xc00
v_mfma_f32_16x16x32_bf16 v[144:147], a[84:87], a[60:63], v[144:147]
buffer_load_dwordx4 v23, s[44:47], s21 offen lds
v_mfma_f32_16x16x32_bf16 v[144:147], a[80:83], a[44:47], v[144:147]
v_mfma_f32_16x16x32_bf16 v[148:151], a[88:91], a[44:47], v[148:151]
ds_read_b64_tr_b16 a[80:81], v14 offset:4096
v_mfma_f32_16x16x32_bf16 v[148:151], a[92:95], a[60:63], v[148:151]
ds_read_b64_tr_b16 a[82:83], v14 offset:4352
v_mfma_f32_16x16x32_bf16 v[140:143], a[92:95], a[56:59], v[140:143]
ds_read_b64_tr_b16 a[84:85], v14 offset:6144
v_mfma_f32_16x16x32_bf16 v[140:143], a[88:91], a[40:43], v[140:143]
ds_read_b64_tr_b16 a[86:87], v14 offset:6400
s_add_u32 m0, s16, 0x1000
v_mfma_f32_16x16x32_bf16 v[132:135], a[88:91], a[36:39], v[132:135]
buffer_load_dwordx4 v22, s[44:47], s22 offen lds
v_mfma_f32_16x16x32_bf16 v[132:135], a[92:95], a[52:55], v[132:135]
v_mfma_f32_16x16x32_bf16 v[124:127], a[92:95], a[48:51], v[124:127]
v_mfma_f32_16x16x32_bf16 v[124:127], a[88:91], a[32:35], v[124:127]
s_waitcnt lgkmcnt(4)
v_mfma_f32_16x16x32_bf16 v[152:155], a[96:99], a[32:35], v[152:155]
ds_read_b64_tr_b16 a[88:89], v15 offset:4096
s_add_u32 m0, s16, 0x1400
v_mfma_f32_16x16x32_bf16 v[152:155], a[100:103], a[48:51], v[152:155]
buffer_load_dwordx4 v23, s[44:47], s22 offen lds
v_mfma_f32_16x16x32_bf16 v[160:163], a[100:103], a[52:55], v[160:163]
ds_read_b64_tr_b16 a[90:91], v15 offset:4352
v_mfma_f32_16x16x32_bf16 v[160:163], a[96:99], a[36:39], v[160:163]
ds_read_b64_tr_b16 a[92:93], v15 offset:6144
v_mfma_f32_16x16x32_bf16 v[168:171], a[96:99], a[40:43], v[168:171]
ds_read_b64_tr_b16 a[94:95], v15 offset:6400
v_mfma_f32_16x16x32_bf16 v[168:171], a[100:103], a[56:59], v[168:171]
v_mfma_f32_16x16x32_bf16 v[176:179], a[100:103], a[60:63], v[176:179]
s_add_u32 m0, s16, 0x1800
v_mfma_f32_16x16x32_bf16 v[176:179], a[96:99], a[44:47], v[176:179]
buffer_load_dwordx4 v22, s[44:47], s23 offen lds
v_mfma_f32_16x16x32_bf16 v[180:183], a[104:107], a[44:47], v[180:183]
ds_read_b64_tr_b16 a[96:97], v14 offset:8192
v_mfma_f32_16x16x32_bf16 v[180:183], a[108:111], a[60:63], v[180:183]
ds_read_b64_tr_b16 a[98:99], v14 offset:8448
v_mfma_f32_16x16x32_bf16 v[172:175], a[108:111], a[56:59], v[172:175]
ds_read_b64_tr_b16 a[100:101], v14 offset:10240
v_mfma_f32_16x16x32_bf16 v[172:175], a[104:107], a[40:43], v[172:175]
ds_read_b64_tr_b16 a[102:103], v14 offset:10496
s_add_u32 m0, s16, 0x1c00
v_mfma_f32_16x16x32_bf16 v[164:167], a[104:107], a[36:39], v[164:167]
buffer_load_dwordx4 v23, s[44:47], s23 offen lds
v_mfma_f32_16x16x32_bf16 v[164:167], a[108:111], a[52:55], v[164:167]
v_lshl_add_u32 v22, s42, 7, v22
v_lshl_add_u32 v23, s42, 7, v23
v_mfma_f32_16x16x32_bf16 v[156:159], a[108:111], a[48:51], v[156:159]
v_mfma_f32_16x16x32_bf16 v[156:159], a[104:107], a[32:35], v[156:159]
s_waitcnt lgkmcnt(4)
v_mfma_f32_16x16x32_bf16 v[184:187], a[80:83], a[32:35], v[184:187]
ds_read_b64_tr_b16 a[104:105], v15 offset:8192
v_mfma_f32_16x16x32_bf16 v[184:187], a[84:87], a[48:51], v[184:187]
ds_read_b64_tr_b16 a[106:107], v15 offset:8448
s_add_u32 s8, s28, 0x7800
v_mfma_f32_16x16x32_bf16 v[192:195], a[84:87], a[52:55], v[192:195]
buffer_store_dwordx4 a[172:175], v16, s[88:91], s8 offen sc1
v_mfma_f32_16x16x32_bf16 v[192:195], a[80:83], a[36:39], v[192:195]
ds_read_b64_tr_b16 a[108:109], v15 offset:10240
v_mfma_f32_16x16x32_bf16 v[200:203], a[80:83], a[40:43], v[200:203]
ds_read_b64_tr_b16 a[110:111], v15 offset:10496
v_add_u32 v12, 0xffff0000, v12
v_mfma_f32_16x16x32_bf16 v[200:203], a[84:87], a[56:59], v[200:203]
v_add_u32 v13, 0xffff0000, v13
v_add_u32 v14, 0xffff0000, v14
v_mfma_f32_16x16x32_bf16 v[208:211], a[84:87], a[60:63], v[208:211]
v_add_u32 v15, 0xffff0000, v15
v_mfma_f32_16x16x32_bf16 v[208:211], a[80:83], a[44:47], v[208:211]
v_mfma_f32_16x16x32_bf16 v[212:215], a[88:91], a[44:47], v[212:215]
s_waitcnt vmcnt(28) lgkmcnt(0)
v_mfma_f32_16x16x32_bf16 v[212:215], a[92:95], a[60:63], v[212:215]
s_barrier
s_add_u32 m0, s17, 0x10000
v_mfma_f32_16x16x32_bf16 v[204:207], a[92:95], a[56:59], v[204:207]
buffer_load_dwordx4 v5, s[52:55], 0 offen lds
v_mfma_f32_16x16x32_bf16 v[204:207], a[88:91], a[40:43], v[204:207]
ds_read_b64_tr_b16 a[80:81], v12 offset:0
v_mfma_f32_16x16x32_bf16 v[196:199], a[88:91], a[36:39], v[196:199]
ds_read_b64_tr_b16 a[82:83], v12 offset:1024
v_mfma_f32_16x16x32_bf16 v[196:199], a[92:95], a[52:55], v[196:199]
ds_read_b64_tr_b16 a[84:85], v12 offset:8192
v_mfma_f32_16x16x32_bf16 v[188:191], a[92:95], a[48:51], v[188:191]
ds_read_b64_tr_b16 a[86:87], v12 offset:9216
v_mfma_f32_16x16x32_bf16 v[188:191], a[88:91], a[32:35], v[188:191]
s_add_u32 m0, s17, 0x10400
s_waitcnt lgkmcnt(4)
v_mfma_f32_16x16x32_bf16 v[216:219], a[32:35], a[96:99], v[216:219]
buffer_load_dwordx4 v5, s[52:55], s13 offen lds
v_mfma_f32_16x16x32_bf16 v[216:219], a[48:51], a[100:103], v[216:219]
ds_read_b64_tr_b16 a[88:89], v13 offset:0
v_mfma_f32_16x16x32_bf16 v[224:227], a[52:55], a[100:103], v[224:227]
ds_read_b64_tr_b16 a[90:91], v13 offset:1024
v_mfma_f32_16x16x32_bf16 v[224:227], a[36:39], a[96:99], v[224:227]
ds_read_b64_tr_b16 a[92:93], v13 offset:8192
v_mfma_f32_16x16x32_bf16 v[232:235], a[40:43], a[96:99], v[232:235]
ds_read_b64_tr_b16 a[94:95], v13 offset:9216
v_mfma_f32_16x16x32_bf16 v[232:235], a[56:59], a[100:103], v[232:235]
s_add_u32 m0, s17, 0x10800
v_mfma_f32_16x16x32_bf16 v[240:243], a[60:63], a[100:103], v[240:243]
buffer_load_dwordx4 v6, s[52:55], 0 offen lds
v_mfma_f32_16x16x32_bf16 v[240:243], a[44:47], a[96:99], v[240:243]
v_mfma_f32_16x16x32_bf16 v[244:247], a[44:47], a[104:107], v[244:247]
ds_read_b64_tr_b16 a[96:97], v12 offset:256
v_mfma_f32_16x16x32_bf16 v[244:247], a[60:63], a[108:111], v[244:247]
ds_read_b64_tr_b16 a[98:99], v12 offset:1280
v_mfma_f32_16x16x32_bf16 v[236:239], a[56:59], a[108:111], v[236:239]
ds_read_b64_tr_b16 a[100:101], v12 offset:8448
v_mfma_f32_16x16x32_bf16 v[236:239], a[40:43], a[104:107], v[236:239]
ds_read_b64_tr_b16 a[102:103], v12 offset:9472
s_add_u32 s8, s28, 0x2c00
v_mfma_f32_16x16x32_bf16 v[228:231], a[36:39], a[104:107], v[228:231]
buffer_store_dwordx4 a[176:179], v16, s[88:91], s8 offen sc1
v_mfma_f32_16x16x32_bf16 v[228:231], a[52:55], a[108:111], v[228:231]
v_mfma_f32_16x16x32_bf16 v[220:223], a[48:51], a[108:111], v[220:223]
v_mfma_f32_16x16x32_bf16 v[220:223], a[32:35], a[104:107], v[220:223]
s_waitcnt lgkmcnt(4)
L_S12:
v_mfma_f32_16x16x32_bf16 v[24:27], a[80:83], a[0:3], v[24:27]
ds_read_b64_tr_b16 a[104:105], v13 offset:256
s_waitcnt vmcnt(23)
v_mfma_f32_16x16x32_bf16 v[24:27], a[84:87], a[16:19], v[24:27]
ds_read_b64_tr_b16 a[106:107], v13 offset:1280
s_add_u32 m0, s17, 0x10c00
v_mfma_f32_16x16x32_bf16 v[32:35], a[84:87], a[20:23], v[32:35]
buffer_load_dwordx4 v6, s[52:55], s13 offen lds
v_mfma_f32_16x16x32_bf16 v[32:35], a[80:83], a[4:7], v[32:35]
ds_read_b64_tr_b16 a[108:109], v13 offset:8448
v_mfma_f32_16x16x32_bf16 v[40:43], a[80:83], a[8:11], v[40:43]
ds_read_b64_tr_b16 a[110:111], v13 offset:9472
v_mfma_f32_16x16x32_bf16 v[40:43], a[84:87], a[24:27], v[40:43]
ds_read_b128 a[32:35], v8 offset:32768
v_mfma_f32_16x16x32_bf16 v[48:51], a[84:87], a[28:31], v[48:51]
ds_read_b128 a[48:51], v9 offset:32768
v_mfma_f32_16x16x32_bf16 v[48:51], a[80:83], a[12:15], v[48:51]
ds_read_b128 a[36:39], v8 offset:34816
s_add_u32 m0, s18, 0x14000
v_mfma_f32_16x16x32_bf16 v[52:55], a[88:91], a[12:15], v[52:55]
buffer_load_dwordx4 v7, s[68:71], 0 offen lds
v_mfma_f32_16x16x32_bf16 v[52:55], a[92:95], a[28:31], v[52:55]
ds_read_b64_tr_b16 a[80:81], v12 offset:512
v_mfma_f32_16x16x32_bf16 v[44:47], a[92:95], a[24:27], v[44:47]
ds_read_b64_tr_b16 a[82:83], v12 offset:1536
v_mfma_f32_16x16x32_bf16 v[44:47], a[88:91], a[8:11], v[44:47]
ds_read_b64_tr_b16 a[84:85], v12 offset:8704
v_mfma_f32_16x16x32_bf16 v[36:39], a[88:91], a[4:7], v[36:39]
ds_read_b64_tr_b16 a[86:87], v12 offset:9728
v_mfma_f32_16x16x32_bf16 v[36:39], a[92:95], a[20:23], v[36:39]
ds_read_b128 a[52:55], v9 offset:34816
s_add_u32 m0, s18, 0x15000
v_mfma_f32_16x16x32_bf16 v[28:31], a[92:95], a[16:19], v[28:31]
buffer_load_dwordx4 v7, s[68:71], s25 offen lds
v_mfma_f32_16x16x32_bf16 v[28:31], a[88:91], a[0:3], v[28:31]
ds_read_b128 a[40:43], v8 offset:36864
s_waitcnt lgkmcnt(9)
v_mfma_f32_16x16x32_bf16 v[56:59], a[96:99], a[0:3], v[56:59]
ds_read_b64_tr_b16 a[88:89], v13 offset:512
v_mfma_f32_16x16x32_bf16 v[56:59], a[100:103], a[16:19], v[56:59]
ds_read_b64_tr_b16 a[90:91], v13 offset:1536
v_mfma_f32_16x16x32_bf16 v[64:67], a[100:103], a[20:23], v[64:67]
ds_read_b64_tr_b16 a[92:93], v13 offset:8704
v_mfma_f32_16x16x32_bf16 v[64:67], a[96:99], a[4:7], v[64:67]
ds_read_b64_tr_b16 a[94:95], v13 offset:9728
s_add_u32 m0, s18, 0x16000
v_mfma_f32_16x16x32_bf16 v[72:75], a[96:99], a[8:11], v[72:75]
buffer_load_dwordx4 v7, s[68:71], s26 offen lds
v_mfma_f32_16x16x32_bf16 v[72:75], a[100:103], a[24:27], v[72:75]
ds_read_b128 a[56:59], v9 offset:36864
v_lshl_add_u32 v5, s42, 19, v5
v_mfma_f32_16x16x32_bf16 v[80:83], a[100:103], a[28:31], v[80:83]
ds_read_b128 a[44:47], v8 offset:38912
v_lshl_add_u32 v6, s42, 19, v6
v_mfma_f32_16x16x32_bf16 v[80:83], a[96:99], a[12:15], v[80:83]
ds_read_b128 a[60:63], v9 offset:38912
v_lshl_add_u32 v7, s42, 18, v7
v_mfma_f32_16x16x32_bf16 v[84:87], a[104:107], a[12:15], v[84:87]
ds_read_b64_tr_b16 a[96:97], v12 offset:768
v_lshl_add_u32 v7, s42, 17, v7
v_mfma_f32_16x16x32_bf16 v[84:87], a[108:111], a[28:31], v[84:87]
ds_read_b64_tr_b16 a[98:99], v12 offset:1792
s_add_u32 s8, s28, 0x3c00
v_mfma_f32_16x16x32_bf16 v[76:79], a[108:111], a[24:27], v[76:79]
buffer_store_dwordx4 a[180:183], v16, s[88:91], s8 offen sc1
v_mfma_f32_16x16x32_bf16 v[76:79], a[104:107], a[8:11], v[76:79]
ds_read_b64_tr_b16 a[100:101], v12 offset:8960
v_mfma_f32_16x16x32_bf16 v[68:71], a[104:107], a[4:7], v[68:71]
ds_read_b64_tr_b16 a[102:103], v12 offset:9984
v_mfma_f32_16x16x32_bf16 v[68:71], a[108:111], a[20:23], v[68:71]
v_mfma_f32_16x16x32_bf16 v[60:63], a[108:111], a[16:19], v[60:63]
v_mfma_f32_16x16x32_bf16 v[60:63], a[104:107], a[0:3], v[60:63]
s_add_u32 m0, s16, 0x8000
s_waitcnt lgkmcnt(4)
s_waitcnt lgkmcnt(7)
v_mfma_f32_16x16x32_bf16 v[88:91], a[80:83], a[0:3], v[88:91]
buffer_load_dwordx4 v22, s[44:47], s20 offen lds
v_mfma_f32_16x16x32_bf16 v[88:91], a[84:87], a[16:19], v[88:91]
ds_read_b64_tr_b16 a[104:105], v13 offset:768
v_mfma_f32_16x16x32_bf16 v[96:99], a[84:87], a[20:23], v[96:99]
ds_read_b64_tr_b16 a[106:107], v13 offset:1792
v_mfma_f32_16x16x32_bf16 v[96:99], a[80:83], a[4:7], v[96:99]
ds_read_b64_tr_b16 a[108:109], v13 offset:8960
v_mfma_f32_16x16x32_bf16 v[104:107], a[80:83], a[8:11], v[104:107]
ds_read_b64_tr_b16 a[110:111], v13 offset:9984
s_add_u32 m0, s16, 0x8400
v_mfma_f32_16x16x32_bf16 v[104:107], a[84:87], a[24:27], v[104:107]
buffer_load_dwordx4 v23, s[44:47], s20 offen lds
v_mfma_f32_16x16x32_bf16 v[112:115], a[84:87], a[28:31], v[112:115]
v_mfma_f32_16x16x32_bf16 v[112:115], a[80:83], a[12:15], v[112:115]
v_mfma_f32_16x16x32_bf16 v[116:119], a[88:91], a[12:15], v[116:119]
ds_read_b64_tr_b16 a[80:81], v14 offset:0
v_mfma_f32_16x16x32_bf16 v[116:119], a[92:95], a[28:31], v[116:119]
ds_read_b64_tr_b16 a[82:83], v14 offset:256
v_mfma_f32_16x16x32_bf16 v[108:111], a[92:95], a[24:27], v[108:111]
ds_read_b64_tr_b16 a[84:85], v14 offset:2048
s_add_u32 m0, s16, 0x8800
v_mfma_f32_16x16x32_bf16 v[108:111], a[88:91], a[8:11], v[108:111]
buffer_load_dwordx4 v22, s[44:47], s21 offen lds
v_mfma_f32_16x16x32_bf16 v[100:103], a[88:91], a[4:7], v[100:103]
ds_read_b64_tr_b16 a[86:87], v14 offset:2304
v_mfma_f32_16x16x32_bf16 v[100:103], a[92:95], a[20:23], v[100:103]
v_mfma_f32_16x16x32_bf16 v[92:95], a[92:95], a[16:19], v[92:95]
v_mfma_f32_16x16x32_bf16 v[92:95], a[88:91], a[0:3], v[92:95]
s_add_u32 m0, s16, 0x8c00
s_waitcnt lgkmcnt(4)
v_mfma_f32_16x16x32_bf16 v[120:123], a[96:99], a[0:3], v[120:123]
buffer_load_dwordx4 v23, s[44:47], s21 offen lds
v_mfma_f32_16x16x32_bf16 v[120:123], a[100:103], a[16:19], v[120:123]
ds_read_b64_tr_b16 a[88:89], v15 offset:0
v_mfma_f32_16x16x32_bf16 v[128:131], a[100:103], a[20:23], v[128:131]
ds_read_b64_tr_b16 a[90:91], v15 offset:256
v_mfma_f32_16x16x32_bf16 v[128:131], a[96:99], a[4:7], v[128:131]
ds_read_b64_tr_b16 a[92:93], v15 offset:2048
v_mfma_f32_16x16x32_bf16 v[136:139], a[96:99], a[8:11], v[136:139]
ds_read_b64_tr_b16 a[94:95], v15 offset:2304
v_mfma_f32_16x16x32_bf16 v[136:139], a[100:103], a[24:27], v[136:139]
s_add_u32 s8, s28, 0x6c00
v_mfma_f32_16x16x32_bf16 v[144:147], a[100:103], a[28:31], v[144:147]
buffer_store_dwordx4 a[184:187], v16, s[88:91], s8 offen sc1
v_mfma_f32_16x16x32_bf16 v[144:147], a[96:99], a[12:15], v[144:147]
v_mfma_f32_16x16x32_bf16 v[148:151], a[104:107], a[12:15], v[148:151]
ds_read_b64_tr_b16 a[96:97], v14 offset:4096
v_mfma_f32_16x16x32_bf16 v[148:151], a[108:111], a[28:31], v[148:151]
ds_read_b64_tr_b16 a[98:99], v14 offset:4352
v_mfma_f32_16x16x32_bf16 v[140:143], a[108:111], a[24:27], v[140:143]
ds_read_b64_tr_b16 a[100:101], v14 offset:6144
v_mfma_f32_16x16x32_bf16 v[140:143], a[104:107], a[8:11], v[140:143]
ds_read_b64_tr_b16 a[102:103], v14 offset:6400
s_add_u32 m0, s16, 0x9000
v_mfma_f32_16x16x32_bf16 v[132:135], a[104:107], a[4:7], v[132:135]
buffer_load_dwordx4 v22, s[44:47], s22 offen lds
v_mfma_f32_16x16x32_bf16 v[132:135], a[108:111], a[20:23], v[132:135]
v_mfma_f32_16x16x32_bf16 v[124:127], a[108:111], a[16:19], v[124:127]
v_mfma_f32_16x16x32_bf16 v[124:127], a[104:107], a[0:3], v[124:127]
s_waitcnt lgkmcnt(4)
v_mfma_f32_16x16x32_bf16 v[152:155], a[80:83], a[0:3], v[152:155]
ds_read_b64_tr_b16 a[104:105], v15 offset:4096
s_add_u32 m0, s16, 0x9400
v_mfma_f32_16x16x32_bf16 v[152:155], a[84:87], a[16:19], v[152:155]
buffer_load_dwordx4 v23, s[44:47], s22 offen lds
v_mfma_f32_16x16x32_bf16 v[160:163], a[84:87], a[20:23], v[160:163]
ds_read_b64_tr_b16 a[106:107], v15 offset:4352
v_mfma_f32_16x16x32_bf16 v[160:163], a[80:83], a[4:7], v[160:163]
ds_read_b64_tr_b16 a[108:109], v15 offset:6144
v_mfma_f32_16x16x32_bf16 v[168:171], a[80:83], a[8:11], v[168:171]
ds_read_b64_tr_b16 a[110:111], v15 offset:6400
v_mfma_f32_16x16x32_bf16 v[168:171], a[84:87], a[24:27], v[168:171]
v_mfma_f32_16x16x32_bf16 v[176:179], a[84:87], a[28:31], v[176:179]
s_add_u32 m0, s16, 0x9800
v_mfma_f32_16x16x32_bf16 v[176:179], a[80:83], a[12:15], v[176:179]
buffer_load_dwordx4 v22, s[44:47], s23 offen lds
v_mfma_f32_16x16x32_bf16 v[180:183], a[88:91], a[12:15], v[180:183]
ds_read_b64_tr_b16 a[80:81], v14 offset:8192
v_mfma_f32_16x16x32_bf16 v[180:183], a[92:95], a[28:31], v[180:183]
ds_read_b64_tr_b16 a[82:83], v14 offset:8448
v_mfma_f32_16x16x32_bf16 v[172:175], a[92:95], a[24:27], v[172:175]
ds_read_b64_tr_b16 a[84:85], v14 offset:10240
v_mfma_f32_16x16x32_bf16 v[172:175], a[88:91], a[8:11], v[172:175]
ds_read_b64_tr_b16 a[86:87], v14 offset:10496
s_add_u32 m0, s16, 0x9c00
v_mfma_f32_16x16x32_bf16 v[164:167], a[88:91], a[4:7], v[164:167]
buffer_load_dwordx4 v23, s[44:47], s23 offen lds
v_mfma_f32_16x16x32_bf16 v[164:167], a[92:95], a[20:23], v[164:167]
v_lshl_add_u32 v22, s42, 7, v22
v_lshl_add_u32 v23, s42, 7, v23
v_mfma_f32_16x16x32_bf16 v[156:159], a[92:95], a[16:19], v[156:159]
v_mfma_f32_16x16x32_bf16 v[156:159], a[88:91], a[0:3], v[156:159]
s_waitcnt lgkmcnt(4)
v_mfma_f32_16x16x32_bf16 v[184:187], a[96:99], a[0:3], v[184:187]
ds_read_b64_tr_b16 a[88:89], v15 offset:8192
v_mfma_f32_16x16x32_bf16 v[184:187], a[100:103], a[16:19], v[184:187]
ds_read_b64_tr_b16 a[90:91], v15 offset:8448
s_add_u32 s8, s28, 0x7c00
v_mfma_f32_16x16x32_bf16 v[192:195], a[100:103], a[20:23], v[192:195]
buffer_store_dwordx4 a[188:191], v16, s[88:91], s8 offen sc1
v_mfma_f32_16x16x32_bf16 v[192:195], a[96:99], a[4:7], v[192:195]
ds_read_b64_tr_b16 a[92:93], v15 offset:10240
v_mfma_f32_16x16x32_bf16 v[200:203], a[96:99], a[8:11], v[200:203]
ds_read_b64_tr_b16 a[94:95], v15 offset:10496
v_add_u32 v12, 0x8000, v12
v_mfma_f32_16x16x32_bf16 v[200:203], a[100:103], a[24:27], v[200:203]
v_add_u32 v13, 0x8000, v13
v_add_u32 v14, 0x8000, v14
v_mfma_f32_16x16x32_bf16 v[208:211], a[100:103], a[28:31], v[208:211]
v_add_u32 v15, 0x8000, v15
v_mfma_f32_16x16x32_bf16 v[208:211], a[96:99], a[12:15], v[208:211]
v_mfma_f32_16x16x32_bf16 v[212:215], a[104:107], a[12:15], v[212:215]
s_waitcnt vmcnt(29) lgkmcnt(0)
v_mfma_f32_16x16x32_bf16 v[212:215], a[108:111], a[28:31], v[212:215]
s_barrier
s_add_u32 m0, s17, 0x0
v_mfma_f32_16x16x32_bf16 v[204:207], a[108:111], a[24:27], v[204:207]
buffer_load_dwordx4 v5, s[52:55], 0 offen lds
v_mfma_f32_16x16x32_bf16 v[204:207], a[104:107], a[8:11], v[204:207]
ds_read_b64_tr_b16 a[96:97], v12 offset:0
v_mfma_f32_16x16x32_bf16 v[196:199], a[104:107], a[4:7], v[196:199]
ds_read_b64_tr_b16 a[98:99], v12 offset:1024
v_mfma_f32_16x16x32_bf16 v[196:199], a[108:111], a[20:23], v[196:199]
ds_read_b64_tr_b16 a[100:101], v12 offset:8192
v_mfma_f32_16x16x32_bf16 v[188:191], a[108:111], a[16:19], v[188:191]
ds_read_b64_tr_b16 a[102:103], v12 offset:9216
v_mfma_f32_16x16x32_bf16 v[188:191], a[104:107], a[0:3], v[188:191]
s_add_u32 m0, s17, 0x400
s_waitcnt lgkmcnt(4)
v_mfma_f32_16x16x32_bf16 v[216:219], a[0:3], a[80:83], v[216:219]
buffer_load_dwordx4 v5, s[52:55], s13 offen lds
v_mfma_f32_16x16x32_bf16 v[216:219], a[16:19], a[84:87], v[216:219]
ds_read_b64_tr_b16 a[104:105], v13 offset:0
v_mfma_f32_16x16x32_bf16 v[224:227], a[20:23], a[84:87], v[224:227]
ds_read_b64_tr_b16 a[106:107], v13 offset:1024
v_mfma_f32_16x16x32_bf16 v[224:227], a[4:7], a[80:83], v[224:227]
ds_read_b64_tr_b16 a[108:109], v13 offset:8192
v_mfma_f32_16x16x32_bf16 v[232:235], a[8:11], a[80:83], v[232:235]
ds_read_b64_tr_b16 a[110:111], v13 offset:9216
v_mfma_f32_16x16x32_bf16 v[232:235], a[24:27], a[84:87], v[232:235]
v_mfma_f32_16x16x32_bf16 v[240:243], a[28:31], a[84:87], v[240:243]
s_add_u32 m0, s17, 0x800
v_mfma_f32_16x16x32_bf16 v[240:243], a[12:15], a[80:83], v[240:243]
buffer_load_dwordx4 v6, s[52:55], 0 offen lds
v_mfma_f32_16x16x32_bf16 v[244:247], a[12:15], a[88:91], v[244:247]
ds_read_b64_tr_b16 a[80:81], v12 offset:256
v_mfma_f32_16x16x32_bf16 v[244:247], a[28:31], a[92:95], v[244:247]
ds_read_b64_tr_b16 a[82:83], v12 offset:1280
v_mfma_f32_16x16x32_bf16 v[236:239], a[24:27], a[92:95], v[236:239]
ds_read_b64_tr_b16 a[84:85], v12 offset:8448
v_mfma_f32_16x16x32_bf16 v[236:239], a[8:11], a[88:91], v[236:239]
ds_read_b64_tr_b16 a[86:87], v12 offset:9472
v_mfma_f32_16x16x32_bf16 v[228:231], a[4:7], a[88:91], v[228:231]
v_mfma_f32_16x16x32_bf16 v[228:231], a[20:23], a[92:95], v[228:231]
s_add_u32 m0, s17, 0xc00
v_mfma_f32_16x16x32_bf16 v[220:223], a[16:19], a[92:95], v[220:223]
buffer_load_dwordx4 v6, s[52:55], s13 offen lds
v_mfma_f32_16x16x32_bf16 v[220:223], a[0:3], a[88:91], v[220:223]
s_waitcnt lgkmcnt(4)
L_S13:
v_mfma_f32_16x16x32_bf16 v[24:27], a[96:99], a[32:35], v[24:27]
ds_read_b64_tr_b16 a[88:89], v13 offset:256
s_waitcnt vmcnt(24)
v_mfma_f32_16x16x32_bf16 v[24:27], a[100:103], a[48:51], v[24:27]
ds_read_b64_tr_b16 a[90:91], v13 offset:1280
v_mfma_f32_16x16x32_bf16 v[32:35], a[100:103], a[52:55], v[32:35]
ds_read_b64_tr_b16 a[92:93], v13 offset:8448
v_mfma_f32_16x16x32_bf16 v[32:35], a[96:99], a[36:39], v[32:35]
ds_read_b64_tr_b16 a[94:95], v13 offset:9472
v_mfma_f32_16x16x32_bf16 v[40:43], a[96:99], a[40:43], v[40:43]
ds_read_b128 a[0:3], v8 offset:0
s_add_u32 m0, s18, 0x4000
v_mfma_f32_16x16x32_bf16 v[40:43], a[100:103], a[56:59], v[40:43]
buffer_load_dwordx4 v7, s[68:71], 0 offen lds
v_mfma_f32_16x16x32_bf16 v[48:51], a[100:103], a[60:63], v[48:51]
ds_read_b128 a[16:19], v9 offset:0
v_mfma_f32_16x16x32_bf16 v[48:51], a[96:99], a[44:47], v[48:51]
ds_read_b128 a[4:7], v8 offset:2048
v_mfma_f32_16x16x32_bf16 v[52:55], a[104:107], a[44:47], v[52:55]
ds_read_b64_tr_b16 a[96:97], v12 offset:512
v_mfma_f32_16x16x32_bf16 v[52:55], a[108:111], a[60:63], v[52:55]
ds_read_b64_tr_b16 a[98:99], v12 offset:1536
v_mfma_f32_16x16x32_bf16 v[44:47], a[108:111], a[56:59], v[44:47]
ds_read_b64_tr_b16 a[100:101], v12 offset:8704
s_add_u32 s8, s28, 0x4000
v_mfma_f32_16x16x32_bf16 v[44:47], a[104:107], a[40:43], v[44:47]
buffer_store_dwordx4 a[192:195], v16, s[88:91], s8 offen sc1
v_mfma_f32_16x16x32_bf16 v[36:39], a[104:107], a[36:39], v[36:39]
ds_read_b64_tr_b16 a[102:103], v12 offset:9728
v_mfma_f32_16x16x32_bf16 v[36:39], a[108:111], a[52:55], v[36:39]
ds_read_b128 a[20:23], v9 offset:2048
v_mfma_f32_16x16x32_bf16 v[28:31], a[108:111], a[48:51], v[28:31]
ds_read_b128 a[8:11], v8 offset:4096
v_mfma_f32_16x16x32_bf16 v[28:31], a[104:107], a[32:35], v[28:31]
ds_read_b128 a[24:27], v9 offset:4096
s_waitcnt lgkmcnt(10)
v_mfma_f32_16x16x32_bf16 v[56:59], a[80:83], a[32:35], v[56:59]
ds_read_b64_tr_b16 a[104:105], v13 offset:512
v_mfma_f32_16x16x32_bf16 v[56:59], a[84:87], a[48:51], v[56:59]
ds_read_b64_tr_b16 a[106:107], v13 offset:1536
s_add_u32 m0, s18, 0x5000
v_mfma_f32_16x16x32_bf16 v[64:67], a[84:87], a[52:55], v[64:67]
buffer_load_dwordx4 v7, s[68:71], s25 offen lds
v_mfma_f32_16x16x32_bf16 v[64:67], a[80:83], a[36:39], v[64:67]
ds_read_b64_tr_b16 a[108:109], v13 offset:8704
v_mfma_f32_16x16x32_bf16 v[72:75], a[80:83], a[40:43], v[72:75]
ds_read_b64_tr_b16 a[110:111], v13 offset:9728
v_mfma_f32_16x16x32_bf16 v[72:75], a[84:87], a[56:59], v[72:75]
ds_read_b128 a[12:15], v8 offset:6144
v_mfma_f32_16x16x32_bf16 v[80:83], a[84:87], a[60:63], v[80:83]
ds_read_b128 a[28:31], v9 offset:6144
v_mfma_f32_16x16x32_bf16 v[80:83], a[80:83], a[44:47], v[80:83]
v_mfma_f32_16x16x32_bf16 v[84:87], a[88:91], a[44:47], v[84:87]
ds_read_b64_tr_b16 a[80:81], v12 offset:768
s_add_u32 m0, s18, 0x6000
v_mfma_f32_16x16x32_bf16 v[84:87], a[92:95], a[60:63], v[84:87]
buffer_load_dwordx4 v7, s[68:71], s26 offen lds
v_mfma_f32_16x16x32_bf16 v[76:79], a[92:95], a[56:59], v[76:79]
ds_read_b64_tr_b16 a[82:83], v12 offset:1792
v_lshl_add_u32 v5, s42, 19, v5
v_mfma_f32_16x16x32_bf16 v[76:79], a[88:91], a[40:43], v[76:79]
ds_read_b64_tr_b16 a[84:85], v12 offset:8960
v_lshl_add_u32 v6, s42, 19, v6
v_mfma_f32_16x16x32_bf16 v[68:71], a[88:91], a[36:39], v[68:71]
ds_read_b64_tr_b16 a[86:87], v12 offset:9984
v_lshl_add_u32 v7, s42, 18, v7
v_mfma_f32_16x16x32_bf16 v[68:71], a[92:95], a[52:55], v[68:71]
v_lshl_add_u32 v7, s42, 17, v7
v_mfma_f32_16x16x32_bf16 v[60:63], a[92:95], a[48:51], v[60:63]
v_mfma_f32_16x16x32_bf16 v[60:63], a[88:91], a[32:35], v[60:63]
s_add_u32 m0, s16, 0x0
s_waitcnt lgkmcnt(4)
s_waitcnt lgkmcnt(6)
v_mfma_f32_16x16x32_bf16 v[88:91], a[96:99], a[32:35], v[88:91]
buffer_load_dwordx4 v22, s[44:47], s20 offen lds
v_mfma_f32_16x16x32_bf16 v[88:91], a[100:103], a[48:51], v[88:91]
ds_read_b64_tr_b16 a[88:89], v13 offset:768
v_mfma_f32_16x16x32_bf16 v[96:99], a[100:103], a[52:55], v[96:99]
ds_read_b64_tr_b16 a[90:91], v13 offset:1792
v_mfma_f32_16x16x32_bf16 v[96:99], a[96:99], a[36:39], v[96:99]
ds_read_b64_tr_b16 a[92:93], v13 offset:8960
v_mfma_f32_16x16x32_bf16 v[104:107], a[96:99], a[40:43], v[104:107]
ds_read_b64_tr_b16 a[94:95], v13 offset:9984
s_add_u32 m0, s16, 0x400
v_mfma_f32_16x16x32_bf16 v[104:107], a[100:103], a[56:59], v[104:107]
buffer_load_dwordx4 v23, s[44:47], s20 offen lds
v_mfma_f32_16x16x32_bf16 v[112:115], a[100:103], a[60:63], v[112:115]
v_mfma_f32_16x16x32_bf16 v[112:115], a[96:99], a[44:47], v[112:115]
v_mfma_f32_16x16x32_bf16 v[116:119], a[104:107], a[44:47], v[116:119]
ds_read_b64_tr_b16 a[96:97], v14 offset:0
v_mfma_f32_16x16x32_bf16 v[116:119], a[108:111], a[60:63], v[116:119]
ds_read_b64_tr_b16 a[98:99], v14 offset:256
v_mfma_f32_16x16x32_bf16 v[108:111], a[108:111], a[56:59], v[108:111]
ds_read_b64_tr_b16 a[100:101], v14 offset:2048
s_add_u32 m0, s16, 0x800
v_mfma_f32_16x16x32_bf16 v[108:111], a[104:107], a[40:43], v[108:111]
buffer_load_dwordx4 v22, s[44:47], s21 offen lds
v_mfma_f32_16x16x32_bf16 v[100:103], a[104:107], a[36:39], v[100:103]
ds_read_b64_tr_b16 a[102:103], v14 offset:2304
v_mfma_f32_16x16x32_bf16 v[100:103], a[108:111], a[52:55], v[100:103]
v_mfma_f32_16x16x32_bf16 v[92:95], a[108:111], a[48:51], v[92:95]
v_mfma_f32_16x16x32_bf16 v[92:95], a[104:107], a[32:35], v[92:95]
s_add_u32 s8, s28, 0x8000
s_waitcnt lgkmcnt(4)
v_mfma_f32_16x16x32_bf16 v[120:123], a[80:83], a[32:35], v[120:123]
buffer_store_dwordx4 a[196:199], v16, s[88:91], s8 offen sc1
v_mfma_f32_16x16x32_bf16 v[120:123], a[84:87], a[48:51], v[120:123]
ds_read_b64_tr_b16 a[104:105], v15 offset:0
v_mfma_f32_16x16x32_bf16 v[128:131], a[84:87], a[52:55], v[128:131]
ds_read_b64_tr_b16 a[106:107], v15 offset:256
v_mfma_f32_16x16x32_bf16 v[128:131], a[80:83], a[36:39], v[128:131]
ds_read_b64_tr_b16 a[108:109], v15 offset:2048
v_mfma_f32_16x16x32_bf16 v[136:139], a[80:83], a[40:43], v[136:139]
ds_read_b64_tr_b16 a[110:111], v15 offset:2304
v_mfma_f32_16x16x32_bf16 v[136:139], a[84:87], a[56:59], v[136:139]
s_add_u32 m0, s16, 0xc00
v_mfma_f32_16x16x32_bf16 v[144:147], a[84:87], a[60:63], v[144:147]
buffer_load_dwordx4 v23, s[44:47], s21 offen lds
v_mfma_f32_16x16x32_bf16 v[144:147], a[80:83], a[44:47], v[144:147]
L_padA7:
s_cmp_eq_u32 s95, 1
s_cbranch_scc1 L_padA11
v_mfma_f32_16x16x32_bf16 v[148:151], a[88:91], a[44:47], v[148:151]
ds_read_b64_tr_b16 a[80:81], v14 offset:4096
v_mfma_f32_16x16x32_bf16 v[148:151], a[92:95], a[60:63], v[148:151]
ds_read_b64_tr_b16 a[82:83], v14 offset:4352
v_mfma_f32_16x16x32_bf16 v[140:143], a[92:95], a[56:59], v[140:143]
ds_read_b64_tr_b16 a[84:85], v14 offset:6144
v_mfma_f32_16x16x32_bf16 v[140:143], a[88:91], a[40:43], v[140:143]
ds_read_b64_tr_b16 a[86:87], v14 offset:6400
s_add_u32 m0, s16, 0x1000
v_mfma_f32_16x16x32_bf16 v[132:135], a[88:91], a[36:39], v[132:135]
buffer_load_dwordx4 v22, s[44:47], s22 offen lds
v_mfma_f32_16x16x32_bf16 v[132:135], a[92:95], a[52:55], v[132:135]
v_mfma_f32_16x16x32_bf16 v[124:127], a[92:95], a[48:51], v[124:127]
v_mfma_f32_16x16x32_bf16 v[124:127], a[88:91], a[32:35], v[124:127]
s_waitcnt lgkmcnt(4)
v_mfma_f32_16x16x32_bf16 v[152:155], a[96:99], a[32:35], v[152:155]
ds_read_b64_tr_b16 a[88:89], v15 offset:4096
s_add_u32 m0, s16, 0x1400
v_mfma_f32_16x16x32_bf16 v[152:155], a[100:103], a[48:51], v[152:155]
buffer_load_dwordx4 v23, s[44:47], s22 offen lds
v_mfma_f32_16x16x32_bf16 v[160:163], a[100:103], a[52:55], v[160:163]
ds_read_b64_tr_b16 a[90:91], v15 offset:4352
v_mfma_f32_16x16x32_bf16 v[160:163], a[96:99], a[36:39], v[160:163]
ds_read_b64_tr_b16 a[92:93], v15 offset:6144
v_mfma_f32_16x16x32_bf16 v[168:171], a[96:99], a[40:43], v[168:171]
ds_read_b64_tr_b16 a[94:95], v15 offset:6400
v_mfma_f32_16x16x32_bf16 v[168:171], a[100:103], a[56:59], v[168:171]
v_mfma_f32_16x16x32_bf16 v[176:179], a[100:103], a[60:63], v[176:179]
s_add_u32 m0, s16, 0x1800
v_mfma_f32_16x16x32_bf16 v[176:179], a[96:99], a[44:47], v[176:179]
buffer_load_dwordx4 v22, s[44:47], s23 offen lds
v_mfma_f32_16x16x32_bf16 v[180:183], a[104:107], a[44:47], v[180:183]
ds_read_b64_tr_b16 a[96:97], v14 offset:8192
v_mfma_f32_16x16x32_bf16 v[180:183], a[108:111], a[60:63], v[180:183]
ds_read_b64_tr_b16 a[98:99], v14 offset:8448
v_mfma_f32_16x16x32_bf16 v[172:175], a[108:111], a[56:59], v[172:175]
ds_read_b64_tr_b16 a[100:101], v14 offset:10240
v_mfma_f32_16x16x32_bf16 v[172:175], a[104:107], a[40:43], v[172:175]
ds_read_b64_tr_b16 a[102:103], v14 offset:10496
s_add_u32 m0, s16, 0x1c00
v_mfma_f32_16x16x32_bf16 v[164:167], a[104:107], a[36:39], v[164:167]
buffer_load_dwordx4 v23, s[44:47], s23 offen lds
v_mfma_f32_16x16x32_bf16 v[164:167], a[108:111], a[52:55], v[164:167]
v_lshl_add_u32 v22, s42, 7, v22
v_lshl_add_u32 v23, s42, 7, v23
v_mfma_f32_16x16x32_bf16 v[156:159], a[108:111], a[48:51], v[156:159]
v_mfma_f32_16x16x32_bf16 v[156:159], a[104:107], a[32:35], v[156:159]
s_waitcnt lgkmcnt(4)
v_mfma_f32_16x16x32_bf16 v[184:187], a[80:83], a[32:35], v[184:187]
ds_read_b64_tr_b16 a[104:105], v15 offset:8192
v_mfma_f32_16x16x32_bf16 v[184:187], a[84:87], a[48:51], v[184:187]
ds_read_b64_tr_b16 a[106:107], v15 offset:8448
s_add_u32 s8, s28, 0x4400
v_mfma_f32_16x16x32_bf16 v[192:195], a[84:87], a[52:55], v[192:195]
buffer_store_dwordx4 a[200:203], v16, s[88:91], s8 offen sc1
v_mfma_f32_16x16x32_bf16 v[192:195], a[80:83], a[36:39], v[192:195]
ds_read_b64_tr_b16 a[108:109], v15 offset:10240
v_mfma_f32_16x16x32_bf16 v[200:203], a[80:83], a[40:43], v[200:203]
ds_read_b64_tr_b16 a[110:111], v15 offset:10496
v_add_u32 v12, 0x8000, v12
v_mfma_f32_16x16x32_bf16 v[200:203], a[84:87], a[56:59], v[200:203]
v_add_u32 v13, 0x8000, v13
v_add_u32 v14, 0x8000, v14
v_mfma_f32_16x16x32_bf16 v[208:211], a[84:87], a[60:63], v[208:211]
v_add_u32 v15, 0x8000, v15
v_mfma_f32_16x16x32_bf16 v[208:211], a[80:83], a[44:47], v[208:211]
v_mfma_f32_16x16x32_bf16 v[212:215], a[88:91], a[44:47], v[212:215]
s_waitcnt vmcnt(29) lgkmcnt(0)
v_mfma_f32_16x16x32_bf16 v[212:215], a[92:95], a[60:63], v[212:215]
s_barrier
s_add_u32 m0, s17, 0x8000
v_mfma_f32_16x16x32_bf16 v[204:207], a[92:95], a[56:59], v[204:207]
buffer_load_dwordx4 v5, s[52:55], 0 offen lds
v_mfma_f32_16x16x32_bf16 v[204:207], a[88:91], a[40:43], v[204:207]
ds_read_b64_tr_b16 a[80:81], v12 offset:0
v_mfma_f32_16x16x32_bf16 v[196:199], a[88:91], a[36:39], v[196:199]
ds_read_b64_tr_b16 a[82:83], v12 offset:1024
v_mfma_f32_16x16x32_bf16 v[196:199], a[92:95], a[52:55], v[196:199]
ds_read_b64_tr_b16 a[84:85], v12 offset:8192
v_mfma_f32_16x16x32_bf16 v[188:191], a[92:95], a[48:51], v[188:191]
ds_read_b64_tr_b16 a[86:87], v12 offset:9216
v_mfma_f32_16x16x32_bf16 v[188:191], a[88:91], a[32:35], v[188:191]
s_add_u32 m0, s17, 0x8400
s_waitcnt lgkmcnt(4)
v_mfma_f32_16x16x32_bf16 v[216:219], a[32:35], a[96:99], v[216:219]
buffer_load_dwordx4 v5, s[52:55], s13 offen lds
v_mfma_f32_16x16x32_bf16 v[216:219], a[48:51], a[100:103], v[216:219]
ds_read_b64_tr_b16 a[88:89], v13 offset:0
v_mfma_f32_16x16x32_bf16 v[224:227], a[52:55], a[100:103], v[224:227]
ds_read_b64_tr_b16 a[90:91], v13 offset:1024
v_mfma_f32_16x16x32_bf16 v[224:227], a[36:39], a[96:99], v[224:227]
ds_read_b64_tr_b16 a[92:93], v13 offset:8192
v_mfma_f32_16x16x32_bf16 v[232:235], a[40:43], a[96:99], v[232:235]
ds_read_b64_tr_b16 a[94:95], v13 offset:9216
v_mfma_f32_16x16x32_bf16 v[232:235], a[56:59], a[100:103], v[232:235]
v_mfma_f32_16x16x32_bf16 v[240:243], a[60:63], a[100:103], v[240:243]
s_add_u32 m0, s17, 0x8800
v_mfma_f32_16x16x32_bf16 v[240:243], a[44:47], a[96:99], v[240:243]
buffer_load_dwordx4 v6, s[52:55], 0 offen lds
v_mfma_f32_16x16x32_bf16 v[244:247], a[44:47], a[104:107], v[244:247]
ds_read_b64_tr_b16 a[96:97], v12 offset:256
v_mfma_f32_16x16x32_bf16 v[244:247], a[60:63], a[108:111], v[244:247]
ds_read_b64_tr_b16 a[98:99], v12 offset:1280
v_mfma_f32_16x16x32_bf16 v[236:239], a[56:59], a[108:111], v[236:239]
ds_read_b64_tr_b16 a[100:101], v12 offset:8448
v_mfma_f32_16x16x32_bf16 v[236:239], a[40:43], a[104:107], v[236:239]
ds_read_b64_tr_b16 a[102:103], v12 offset:9472
v_mfma_f32_16x16x32_bf16 v[228:231], a[36:39], a[104:107], v[228:231]
v_mfma_f32_16x16x32_bf16 v[228:231], a[52:55], a[108:111], v[228:231]
s_add_u32 m0, s17, 0x8c00
v_mfma_f32_16x16x32_bf16 v[220:223], a[48:51], a[108:111], v[220:223]
buffer_load_dwordx4 v6, s[52:55], s13 offen lds
v_mfma_f32_16x16x32_bf16 v[220:223], a[32:35], a[104:107], v[220:223]
s_waitcnt lgkmcnt(4)
L_S14:
v_mfma_f32_16x16x32_bf16 v[24:27], a[80:83], a[0:3], v[24:27]
ds_read_b64_tr_b16 a[104:105], v13 offset:256
s_waitcnt vmcnt(23)
v_mfma_f32_16x16x32_bf16 v[24:27], a[84:87], a[16:19], v[24:27]
ds_read_b64_tr_b16 a[106:107], v13 offset:1280
v_mfma_f32_16x16x32_bf16 v[32:35], a[84:87], a[20:23], v[32:35]
ds_read_b64_tr_b16 a[108:109], v13 offset:8448
v_mfma_f32_16x16x32_bf16 v[32:35], a[80:83], a[4:7], v[32:35]
ds_read_b64_tr_b16 a[110:111], v13 offset:9472
v_mfma_f32_16x16x32_bf16 v[40:43], a[80:83], a[8:11], v[40:43]
ds_read_b128 a[32:35], v8 offset:32768
s_add_u32 m0, s18, 0xc000
v_mfma_f32_16x16x32_bf16 v[40:43], a[84:87], a[24:27], v[40:43]
buffer_load_dwordx4 v7, s[68:71], 0 offen lds
v_mfma_f32_16x16x32_bf16 v[48:51], a[84:87], a[28:31], v[48:51]
ds_read_b128 a[48:51], v9 offset:32768
v_mfma_f32_16x16x32_bf16 v[48:51], a[80:83], a[12:15], v[48:51]
ds_read_b128 a[36:39], v8 offset:34816
v_mfma_f32_16x16x32_bf16 v[52:55], a[88:91], a[12:15], v[52:55]
ds_read_b64_tr_b16 a[80:81], v12 offset:512
v_mfma_f32_16x16x32_bf16 v[52:55], a[92:95], a[28:31], v[52:55]
ds_read_b64_tr_b16 a[82:83], v12 offset:1536
v_mfma_f32_16x16x32_bf16 v[44:47], a[92:95], a[24:27], v[44:47]
ds_read_b64_tr_b16 a[84:85], v12 offset:8704
s_add_u32 s8, s28, 0x8400
v_mfma_f32_16x16x32_bf16 v[44:47], a[88:91], a[8:11], v[44:47]
buffer_store_dwordx4 a[204:207], v16, s[88:91], s8 offen sc1
v_mfma_f32_16x16x32_bf16 v[36:39], a[88:91], a[4:7], v[36:39]
ds_read_b64_tr_b16 a[86:87], v12 offset:9728
v_mfma_f32_16x16x32_bf16 v[36:39], a[92:95], a[20:23], v[36:39]
ds_read_b128 a[52:55], v9 offset:34816
v_mfma_f32_16x16x32_bf16 v[28:31], a[92:95], a[16:19], v[28:31]
ds_read_b128 a[40:43], v8 offset:36864
v_mfma_f32_16x16x32_bf16 v[28:31], a[88:91], a[0:3], v[28:31]
ds_read_b128 a[56:59], v9 offset:36864
s_waitcnt lgkmcnt(10)
v_mfma_f32_16x16x32_bf16 v[56:59], a[96:99], a[0:3], v[56:59]
ds_read_b64_tr_b16 a[88:89], v13 offset:512
v_mfma_f32_16x16x32_bf16 v[56:59], a[100:103], a[16:19], v[56:59]
ds_read_b64_tr_b16 a[90:91], v13 offset:1536
s_add_u32 m0, s18, 0xd000
v_mfma_f32_16x16x32_bf16 v[64:67], a[100:103], a[20:23], v[64:67]
buffer_load_dwordx4 v7, s[68:71], s25 offen lds
v_mfma_f32_16x16x32_bf16 v[64:67], a[96:99], a[4:7], v[64:67]
ds_read_b64_tr_b16 a[92:93], v13 offset:8704
v_mfma_f32_16x16x32_bf16 v[72:75], a[96:99], a[8:11], v[72:75]
ds_read_b64_tr_b16 a[94:95], v13 offset:9728
v_mfma_f32_16x16x32_bf16 v[72:75], a[100:103], a[24:27], v[72:75]
ds_read_b128 a[44:47], v8 offset:38912
v_mfma_f32_16x16x32_bf16 v[80:83], a[100:103], a[28:31], v[80:83]
ds_read_b128 a[60:63], v9 offset:38912
v_mfma_f32_16x16x32_bf16 v[80:83], a[96:99], a[12:15], v[80:83]
v_mfma_f32_16x16x32_bf16 v[84:87], a[104:107], a[12:15], v[84:87]
ds_read_b64_tr_b16 a[96:97], v12 offset:768
s_add_u32 m0, s18, 0xe000
v_mfma_f32_16x16x32_bf16 v[84:87], a[108:111], a[28:31], v[84:87]
buffer_load_dwordx4 v7, s[68:71], s26 offen lds
v_mfma_f32_16x16x32_bf16 v[76:79], a[108:111], a[24:27], v[76:79]
ds_read_b64_tr_b16 a[98:99], v12 offset:1792
v_lshl_add_u32 v5, s42, 19, v5
v_mfma_f32_16x16x32_bf16 v[76:79], a[104:107], a[8:11], v[76:79]
ds_read_b64_tr_b16 a[100:101], v12 offset:8960
v_lshl_add_u32 v6, s42, 19, v6
v_mfma_f32_16x16x32_bf16 v[68:71], a[104:107], a[4:7], v[68:71]
ds_read_b64_tr_b16 a[102:103], v12 offset:9984
v_lshl_add_u32 v7, s42, 18, v7
v_mfma_f32_16x16x32_bf16 v[68:71], a[108:111], a[20:23], v[68:71]
v_lshl_add_u32 v7, s42, 17, v7
v_mfma_f32_16x16x32_bf16 v[60:63], a[108:111], a[16:19], v[60:63]
v_mfma_f32_16x16x32_bf16 v[60:63], a[104:107], a[0:3], v[60:63]
s_add_u32 m0, s16, 0x8000
s_waitcnt lgkmcnt(4)
s_waitcnt lgkmcnt(6)
v_mfma_f32_16x16x32_bf16 v[88:91], a[80:83], a[0:3], v[88:91]
buffer_load_dwordx4 v22, s[44:47], s20 offen lds
v_mfma_f32_16x16x32_bf16 v[88:91], a[84:87], a[16:19], v[88:91]
ds_read_b64_tr_b16 a[104:105], v13 offset:768
v_mfma_f32_16x16x32_bf16 v[96:99], a[84:87], a[20:23], v[96:99]
ds_read_b64_tr_b16 a[106:107], v13 offset:1792
v_mfma_f32_16x16x32_bf16 v[96:99], a[80:83], a[4:7], v[96:99]
ds_read_b64_tr_b16 a[108:109], v13 offset:8960
v_mfma_f32_16x16x32_bf16 v[104:107], a[80:83], a[8:11], v[104:107]
ds_read_b64_tr_b16 a[110:111], v13 offset:9984
s_add_u32 m0, s16, 0x8400
v_mfma_f32_16x16x32_bf16 v[104:107], a[84:87], a[24:27], v[104:107]
buffer_load_dwordx4 v23, s[44:47], s20 offen lds
v_mfma_f32_16x16x32_bf16 v[112:115], a[84:87], a[28:31], v[112:115]
v_mfma_f32_16x16x32_bf16 v[112:115], a[80:83], a[12:15], v[112:115]
v_mfma_f32_16x16x32_bf16 v[116:119], a[88:91], a[12:15], v[116:119]
ds_read_b64_tr_b16 a[80:81], v14 offset:0
v_mfma_f32_16x16x32_bf16 v[116:119], a[92:95], a[28:31], v[116:119]
ds_read_b64_tr_b16 a[82:83], v14 offset:256
v_mfma_f32_16x16x32_bf16 v[108:111], a[92:95], a[24:27], v[108:111]
ds_read_b64_tr_b16 a[84:85], v14 offset:2048
s_add_u32 m0, s16, 0x8800
v_mfma_f32_16x16x32_bf16 v[108:111], a[88:91], a[8:11], v[108:111]
buffer_load_dwordx4 v22, s[44:47], s21 offen lds
v_mfma_f32_16x16x32_bf16 v[100:103], a[88:91], a[4:7], v[100:103]
ds_read_b64_tr_b16 a[86:87], v14 offset:2304
v_mfma_f32_16x16x32_bf16 v[100:103], a[92:95], a[20:23], v[100:103]
v_mfma_f32_16x16x32_bf16 v[92:95], a[92:95], a[16:19], v[92:95]
v_mfma_f32_16x16x32_bf16 v[92:95], a[88:91], a[0:3], v[92:95]
s_add_u32 s8, s28, 0x4800
s_waitcnt lgkmcnt(4)
v_mfma_f32_16x16x32_bf16 v[120:123], a[96:99], a[0:3], v[120:123]
buffer_store_dwordx4 a[208:211], v16, s[88:91], s8 offen sc1
v_mfma_f32_16x16x32_bf16 v[120:123], a[100:103], a[16:19], v[120:123]
ds_read_b64_tr_b16 a[88:89], v15 offset:0
v_mfma_f32_16x16x32_bf16 v[128:131], a[100:103], a[20:23], v[128:131]
ds_read_b64_tr_b16 a[90:91], v15 offset:256
v_mfma_f32_16x16x32_bf16 v[128:131], a[96:99], a[4:7], v[128:131]
ds_read_b64_tr_b16 a[92:93], v15 offset:2048
v_mfma_f32_16x16x32_bf16 v[136:139], a[96:99], a[8:11], v[136:139]
ds_read_b64_tr_b16 a[94:95], v15 offset:2304
v_mfma_f32_16x16x32_bf16 v[136:139], a[100:103], a[24:27], v[136:139]
s_add_u32 m0, s16, 0x8c00
v_mfma_f32_16x16x32_bf16 v[144:147], a[100:103], a[28:31], v[144:147]
buffer_load_dwordx4 v23, s[44:47], s21 offen lds
v_mfma_f32_16x16x32_bf16 v[144:147], a[96:99], a[12:15], v[144:147]
v_mfma_f32_16x16x32_bf16 v[148:151], a[104:107], a[12:15], v[148:151]
ds_read_b64_tr_b16 a[96:97], v14 offset:4096
v_mfma_f32_16x16x32_bf16 v[148:151], a[108:111], a[28:31], v[148:151]
ds_read_b64_tr_b16 a[98:99], v14 offset:4352
v_mfma_f32_16x16x32_bf16 v[140:143], a[108:111], a[24:27], v[140:143]
ds_read_b64_tr_b16 a[100:101], v14 offset:6144
v_mfma_f32_16x16x32_bf16 v[140:143], a[104:107], a[8:11], v[140:143]
ds_read_b64_tr_b16 a[102:103], v14 offset:6400
s_add_u32 m0, s16, 0x9000
v_mfma_f32_16x16x32_bf16 v[132:135], a[104:107], a[4:7], v[132:135]
buffer_load_dwordx4 v22, s[44:47], s22 offen lds
v_mfma_f32_16x16x32_bf16 v[132:135], a[108:111], a[20:23], v[132:135]
v_mfma_f32_16x16x32_bf16 v[124:127], a[108:111], a[16:19], v[124:127]
v_mfma_f32_16x16x32_bf16 v[124:127], a[104:107], a[0:3], v[124:127]
s_waitcnt lgkmcnt(4)
v_mfma_f32_16x16x32_bf16 v[152:155], a[80:83], a[0:3], v[152:155]
ds_read_b64_tr_b16 a[104:105], v15 offset:4096
s_add_u32 m0, s16, 0x9400
v_mfma_f32_16x16x32_bf16 v[152:155], a[84:87], a[16:19], v[152:155]
buffer_load_dwordx4 v23, s[44:47], s22 offen lds
v_mfma_f32_16x16x32_bf16 v[160:163], a[84:87], a[20:23], v[160:163]
ds_read_b64_tr_b16 a[106:107], v15 offset:4352
v_mfma_f32_16x16x32_bf16 v[160:163], a[80:83], a[4:7], v[160:163]
ds_read_b64_tr_b16 a[108:109], v15 offset:6144
v_mfma_f32_16x16x32_bf16 v[168:171], a[80:83], a[8:11], v[168:171]
ds_read_b64_tr_b16 a[110:111], v15 offset:6400
v_mfma_f32_16x16x32_bf16 v[168:171], a[84:87], a[24:27], v[168:171]
v_mfma_f32_16x16x32_bf16 v[176:179], a[84:87], a[28:31], v[176:179]
s_add_u32 m0, s16, 0x9800
v_mfma_f32_16x16x32_bf16 v[176:179], a[80:83], a[12:15], v[176:179]
buffer_load_dwordx4 v22, s[44:47], s23 offen lds
v_mfma_f32_16x16x32_bf16 v[180:183], a[88:91], a[12:15], v[180:183]
ds_read_b64_tr_b16 a[80:81], v14 offset:8192
v_mfma_f32_16x16x32_bf16 v[180:183], a[92:95], a[28:31], v[180:183]
ds_read_b64_tr_b16 a[82:83], v14 offset:8448
v_mfma_f32_16x16x32_bf16 v[172:175], a[92:95], a[24:27], v[172:175]
ds_read_b64_tr_b16 a[84:85], v14 offset:10240
v_mfma_f32_16x16x32_bf16 v[172:175], a[88:91], a[8:11], v[172:175]
ds_read_b64_tr_b16 a[86:87], v14 offset:10496
s_add_u32 m0, s16, 0x9c00
v_mfma_f32_16x16x32_bf16 v[164:167], a[88:91], a[4:7], v[164:167]
buffer_load_dwordx4 v23, s[44:47], s23 offen lds
v_mfma_f32_16x16x32_bf16 v[164:167], a[92:95], a[20:23], v[164:167]
v_lshl_add_u32 v22, s42, 7, v22
v_lshl_add_u32 v23, s42, 7, v23
v_mfma_f32_16x16x32_bf16 v[156:159], a[92:95], a[16:19], v[156:159]
v_mfma_f32_16x16x32_bf16 v[156:159], a[88:91], a[0:3], v[156:159]
s_waitcnt lgkmcnt(4)
v_mfma_f32_16x16x32_bf16 v[184:187], a[96:99], a[0:3], v[184:187]
ds_read_b64_tr_b16 a[88:89], v15 offset:8192
v_mfma_f32_16x16x32_bf16 v[184:187], a[100:103], a[16:19], v[184:187]
ds_read_b64_tr_b16 a[90:91], v15 offset:8448
s_add_u32 s8, s28, 0x8800
v_mfma_f32_16x16x32_bf16 v[192:195], a[100:103], a[20:23], v[192:195]
buffer_store_dwordx4 a[212:215], v16, s[88:91], s8 offen sc1
v_mfma_f32_16x16x32_bf16 v[192:195], a[96:99], a[4:7], v[192:195]
ds_read_b64_tr_b16 a[92:93], v15 offset:10240
v_mfma_f32_16x16x32_bf16 v[200:203], a[96:99], a[8:11], v[200:203]
ds_read_b64_tr_b16 a[94:95], v15 offset:10496
v_add_u32 v12, 0xffff0000, v12
v_mfma_f32_16x16x32_bf16 v[200:203], a[100:103], a[24:27], v[200:203]
v_add_u32 v13, 0xffff0000, v13
v_add_u32 v14, 0xffff0000, v14
v_mfma_f32_16x16x32_bf16 v[208:211], a[100:103], a[28:31], v[208:211]
v_add_u32 v15, 0xffff0000, v15
v_mfma_f32_16x16x32_bf16 v[208:211], a[96:99], a[12:15], v[208:211]
v_mfma_f32_16x16x32_bf16 v[212:215], a[104:107], a[12:15], v[212:215]
s_waitcnt vmcnt(28) lgkmcnt(0)
v_mfma_f32_16x16x32_bf16 v[212:215], a[108:111], a[28:31], v[212:215]
s_barrier
s_add_u32 m0, s17, 0x10000
v_mfma_f32_16x16x32_bf16 v[204:207], a[108:111], a[24:27], v[204:207]
buffer_load_dwordx4 v5, s[52:55], 0 offen lds
v_mfma_f32_16x16x32_bf16 v[204:207], a[104:107], a[8:11], v[204:207]
ds_read_b64_tr_b16 a[96:97], v12 offset:0
v_mfma_f32_16x16x32_bf16 v[196:199], a[104:107], a[4:7], v[196:199]
ds_read_b64_tr_b16 a[98:99], v12 offset:1024
v_mfma_f32_16x16x32_bf16 v[196:199], a[108:111], a[20:23], v[196:199]
ds_read_b64_tr_b16 a[100:101], v12 offset:8192
v_mfma_f32_16x16x32_bf16 v[188:191], a[108:111], a[16:19], v[188:191]
ds_read_b64_tr_b16 a[102:103], v12 offset:9216
v_mfma_f32_16x16x32_bf16 v[188:191], a[104:107], a[0:3], v[188:191]
s_add_u32 m0, s17, 0x10400
s_waitcnt lgkmcnt(4)
v_mfma_f32_16x16x32_bf16 v[216:219], a[0:3], a[80:83], v[216:219]
buffer_load_dwordx4 v5, s[52:55], s13 offen lds
v_mfma_f32_16x16x32_bf16 v[216:219], a[16:19], a[84:87], v[216:219]
ds_read_b64_tr_b16 a[104:105], v13 offset:0
v_mfma_f32_16x16x32_bf16 v[224:227], a[20:23], a[84:87], v[224:227]
ds_read_b64_tr_b16 a[106:107], v13 offset:1024
v_mfma_f32_16x16x32_bf16 v[224:227], a[4:7], a[80:83], v[224:227]
ds_read_b64_tr_b16 a[108:109], v13 offset:8192
v_mfma_f32_16x16x32_bf16 v[232:235], a[8:11], a[80:83], v[232:235]
ds_read_b64_tr_b16 a[110:111], v13 offset:9216
v_mfma_f32_16x16x32_bf16 v[232:235], a[24:27], a[84:87], v[232:235]
v_mfma_f32_16x16x32_bf16 v[240:243], a[28:31], a[84:87], v[240:243]
s_add_u32 m0, s17, 0x10800
v_mfma_f32_16x16x32_bf16 v[240:243], a[12:15], a[80:83], v[240:243]
buffer_load_dwordx4 v6, s[52:55], 0 offen lds
v_mfma_f32_16x16x32_bf16 v[244:247], a[12:15], a[88:91], v[244:247]
ds_read_b64_tr_b16 a[80:81], v12 offset:256
v_mfma_f32_16x16x32_bf16 v[244:247], a[28:31], a[92:95], v[244:247]
ds_read_b64_tr_b16 a[82:83], v12 offset:1280
v_mfma_f32_16x16x32_bf16 v[236:239], a[24:27], a[92:95], v[236:239]
ds_read_b64_tr_b16 a[84:85], v12 offset:8448
v_mfma_f32_16x16x32_bf16 v[236:239], a[8:11], a[88:91], v[236:239]
ds_read_b64_tr_b16 a[86:87], v12 offset:9472
v_mfma_f32_16x16x32_bf16 v[228:231], a[4:7], a[88:91], v[228:231]
v_mfma_f32_16x16x32_bf16 v[228:231], a[20:23], a[92:95], v[228:231]
s_add_u32 m0, s17, 0x10c00
v_mfma_f32_16x16x32_bf16 v[220:223], a[16:19], a[92:95], v[220:223]
buffer_load_dwordx4 v6, s[52:55], s13 offen lds
v_mfma_f32_16x16x32_bf16 v[220:223], a[0:3], a[88:91], v[220:223]
s_waitcnt lgkmcnt(4)
L_S15:
v_mfma_f32_16x16x32_bf16 v[24:27], a[96:99], a[32:35], v[24:27]
ds_read_b64_tr_b16 a[88:89], v13 offset:256
s_waitcnt vmcnt(23)
v_mfma_f32_16x16x32_bf16 v[24:27], a[100:103], a[48:51], v[24:27]
ds_read_b64_tr_b16 a[90:91], v13 offset:1280
v_mfma_f32_16x16x32_bf16 v[32:35], a[100:103], a[52:55], v[32:35]
ds_read_b64_tr_b16 a[92:93], v13 offset:8448
v_mfma_f32_16x16x32_bf16 v[32:35], a[96:99], a[36:39], v[32:35]
ds_read_b64_tr_b16 a[94:95], v13 offset:9472
v_mfma_f32_16x16x32_bf16 v[40:43], a[96:99], a[40:43], v[40:43]
ds_read_b128 a[0:3], v8 offset:0
s_add_u32 m0, s18, 0x14000
v_mfma_f32_16x16x32_bf16 v[40:43], a[100:103], a[56:59], v[40:43]
buffer_load_dwordx4 v7, s[68:71], 0 offen lds
v_mfma_f32_16x16x32_bf16 v[48:51], a[100:103], a[60:63], v[48:51]
ds_read_b128 a[16:19], v9 offset:0
v_mfma_f32_16x16x32_bf16 v[48:51], a[96:99], a[44:47], v[48:51]
ds_read_b128 a[4:7], v8 offset:2048
v_mfma_f32_16x16x32_bf16 v[52:55], a[104:107], a[44:47], v[52:55]
ds_read_b64_tr_b16 a[96:97], v12 offset:512
v_mfma_f32_16x16x32_bf16 v[52:55], a[108:111], a[60:63], v[52:55]
ds_read_b64_tr_b16 a[98:99], v12 offset:1536
v_mfma_f32_16x16x32_bf16 v[44:47], a[108:111], a[56:59], v[44:47]
ds_read_b64_tr_b16 a[100:101], v12 offset:8704
s_add_u32 s8, s28, 0x4c00
v_mfma_f32_16x16x32_bf16 v[44:47], a[104:107], a[40:43], v[44:47]
buffer_store_dwordx4 a[216:219], v16, s[88:91], s8 offen sc1
v_mfma_f32_16x16x32_bf16 v[36:39], a[104:107], a[36:39], v[36:39]
ds_read_b64_tr_b16 a[102:103], v12 offset:9728
v_mfma_f32_16x16x32_bf16 v[36:39], a[108:111], a[52:55], v[36:39]
ds_read_b128 a[20:23], v9 offset:2048
v_mfma_f32_16x16x32_bf16 v[28:31], a[108:111], a[48:51], v[28:31]
ds_read_b128 a[8:11], v8 offset:4096
v_mfma_f32_16x16x32_bf16 v[28:31], a[104:107], a[32:35], v[28:31]
ds_read_b128 a[24:27], v9 offset:4096
s_waitcnt lgkmcnt(10)
v_mfma_f32_16x16x32_bf16 v[56:59], a[80:83], a[32:35], v[56:59]
ds_read_b64_tr_b16 a[104:105], v13 offset:512
v_mfma_f32_16x16x32_bf16 v[56:59], a[84:87], a[48:51], v[56:59]
ds_read_b64_tr_b16 a[106:107], v13 offset:1536
s_add_u32 m0, s18, 0x15000
v_mfma_f32_16x16x32_bf16 v[64:67], a[84:87], a[52:55], v[64:67]
buffer_load_dwordx4 v7, s[68:71], s25 offen lds
v_mfma_f32_16x16x32_bf16 v[64:67], a[80:83], a[36:39], v[64:67]
ds_read_b64_tr_b16 a[108:109], v13 offset:8704
v_mfma_f32_16x16x32_bf16 v[72:75], a[80:83], a[40:43], v[72:75]
ds_read_b64_tr_b16 a[110:111], v13 offset:9728
v_mfma_f32_16x16x32_bf16 v[72:75], a[84:87], a[56:59], v[72:75]
ds_read_b128 a[12:15], v8 offset:6144
v_mfma_f32_16x16x32_bf16 v[80:83], a[84:87], a[60:63], v[80:83]
ds_read_b128 a[28:31], v9 offset:6144
v_mfma_f32_16x16x32_bf16 v[80:83], a[80:83], a[44:47], v[80:83]
v_mfma_f32_16x16x32_bf16 v[84:87], a[88:91], a[44:47], v[84:87]
ds_read_b64_tr_b16 a[80:81], v12 offset:768
s_add_u32 m0, s18, 0x16000
v_mfma_f32_16x16x32_bf16 v[84:87], a[92:95], a[60:63], v[84:87]
buffer_load_dwordx4 v7, s[68:71], s26 offen lds
v_mfma_f32_16x16x32_bf16 v[76:79], a[92:95], a[56:59], v[76:79]
ds_read_b64_tr_b16 a[82:83], v12 offset:1792
v_lshl_add_u32 v5, s42, 19, v5
v_mfma_f32_16x16x32_bf16 v[76:79], a[88:91], a[40:43], v[76:79]
ds_read_b64_tr_b16 a[84:85], v12 offset:8960
v_lshl_add_u32 v6, s42, 19, v6
v_mfma_f32_16x16x32_bf16 v[68:71], a[88:91], a[36:39], v[68:71]
ds_read_b64_tr_b16 a[86:87], v12 offset:9984
v_lshl_add_u32 v7, s42, 18, v7
v_mfma_f32_16x16x32_bf16 v[68:71], a[92:95], a[52:55], v[68:71]
v_lshl_add_u32 v7, s42, 17, v7
v_mfma_f32_16x16x32_bf16 v[60:63], a[92:95], a[48:51], v[60:63]
v_mfma_f32_16x16x32_bf16 v[60:63], a[88:91], a[32:35], v[60:63]
s_add_u32 m0, s16, 0x0
s_waitcnt lgkmcnt(4)
s_waitcnt lgkmcnt(6)
v_mfma_f32_16x16x32_bf16 v[88:91], a[96:99], a[32:35], v[88:91]
buffer_load_dwordx4 v22, s[44:47], s20 offen lds
v_mfma_f32_16x16x32_bf16 v[88:91], a[100:103], a[48:51], v[88:91]
ds_read_b64_tr_b16 a[88:89], v13 offset:768
v_mfma_f32_16x16x32_bf16 v[96:99], a[100:103], a[52:55], v[96:99]
ds_read_b64_tr_b16 a[90:91], v13 offset:1792
v_mfma_f32_16x16x32_bf16 v[96:99], a[96:99], a[36:39], v[96:99]
ds_read_b64_tr_b16 a[92:93], v13 offset:8960
v_mfma_f32_16x16x32_bf16 v[104:107], a[96:99], a[40:43], v[104:107]
ds_read_b64_tr_b16 a[94:95], v13 offset:9984
s_add_u32 m0, s16, 0x400
v_mfma_f32_16x16x32_bf16 v[104:107], a[100:103], a[56:59], v[104:107]
buffer_load_dwordx4 v23, s[44:47], s20 offen lds
v_mfma_f32_16x16x32_bf16 v[112:115], a[100:103], a[60:63], v[112:115]
v_mfma_f32_16x16x32_bf16 v[112:115], a[96:99], a[44:47], v[112:115]
v_mfma_f32_16x16x32_bf16 v[116:119], a[104:107], a[44:47], v[116:119]
ds_read_b64_tr_b16 a[96:97], v14 offset:0
v_mfma_f32_16x16x32_bf16 v[116:119], a[108:111], a[60:63], v[116:119]
ds_read_b64_tr_b16 a[98:99], v14 offset:256
v_mfma_f32_16x16x32_bf16 v[108:111], a[108:111], a[56:59], v[108:111]
ds_read_b64_tr_b16 a[100:101], v14 offset:2048
s_add_u32 m0, s16, 0x800
v_mfma_f32_16x16x32_bf16 v[108:111], a[104:107], a[40:43], v[108:111]
buffer_load_dwordx4 v22, s[44:47], s21 offen lds
v_mfma_f32_16x16x32_bf16 v[100:103], a[104:107], a[36:39], v[100:103]
ds_read_b64_tr_b16 a[102:103], v14 offset:2304
v_mfma_f32_16x16x32_bf16 v[100:103], a[108:111], a[52:55], v[100:103]
v_mfma_f32_16x16x32_bf16 v[92:95], a[108:111], a[48:51], v[92:95]
v_mfma_f32_16x16x32_bf16 v[92:95], a[104:107], a[32:35], v[92:95]
s_add_u32 s8, s28, 0x8c00
s_waitcnt lgkmcnt(4)
v_mfma_f32_16x16x32_bf16 v[120:123], a[80:83], a[32:35], v[120:123]
buffer_store_dwordx4 a[220:223], v16, s[88:91], s8 offen sc1
v_mfma_f32_16x16x32_bf16 v[120:123], a[84:87], a[48:51], v[120:123]
ds_read_b64_tr_b16 a[104:105], v15 offset:0
v_mfma_f32_16x16x32_bf16 v[128:131], a[84:87], a[52:55], v[128:131]
ds_read_b64_tr_b16 a[106:107], v15 offset:256
v_mfma_f32_16x16x32_bf16 v[128:131], a[80:83], a[36:39], v[128:131]
ds_read_b64_tr_b16 a[108:109], v15 offset:2048
v_mfma_f32_16x16x32_bf16 v[136:139], a[80:83], a[40:43], v[136:139]
ds_read_b64_tr_b16 a[110:111], v15 offset:2304
v_mfma_f32_16x16x32_bf16 v[136:139], a[84:87], a[56:59], v[136:139]
s_add_u32 m0, s16, 0xc00
v_mfma_f32_16x16x32_bf16 v[144:147], a[84:87], a[60:63], v[144:147]
buffer_load_dwordx4 v23, s[44:47], s21 offen lds
v_mfma_f32_16x16x32_bf16 v[144:147], a[80:83], a[44:47], v[144:147]
v_mfma_f32_16x16x32_bf16 v[148:151], a[88:91], a[44:47], v[148:151]
ds_read_b64_tr_b16 a[80:81], v14 offset:4096
v_mfma_f32_16x16x32_bf16 v[148:151], a[92:95], a[60:63], v[148:151]
ds_read_b64_tr_b16 a[82:83], v14 offset:4352
v_mfma_f32_16x16x32_bf16 v[140:143], a[92:95], a[56:59], v[140:143]
ds_read_b64_tr_b16 a[84:85], v14 offset:6144
v_mfma_f32_16x16x32_bf16 v[140:143], a[88:91], a[40:43], v[140:143]
ds_read_b64_tr_b16 a[86:87], v14 offset:6400
s_add_u32 m0, s16, 0x1000
v_mfma_f32_16x16x32_bf16 v[132:135], a[88:91], a[36:39], v[132:135]
buffer_load_dwordx4 v22, s[44:47], s22 offen lds
v_mfma_f32_16x16x32_bf16 v[132:135], a[92:95], a[52:55], v[132:135]
v_mfma_f32_16x16x32_bf16 v[124:127], a[92:95], a[48:51], v[124:127]
v_mfma_f32_16x16x32_bf16 v[124:127], a[88:91], a[32:35], v[124:127]
s_waitcnt lgkmcnt(4)
v_mfma_f32_16x16x32_bf16 v[152:155], a[96:99], a[32:35], v[152:155]
ds_read_b64_tr_b16 a[88:89], v15 offset:4096
s_add_u32 m0, s16, 0x1400
v_mfma_f32_16x16x32_bf16 v[152:155], a[100:103], a[48:51], v[152:155]
buffer_load_dwordx4 v23, s[44:47], s22 offen lds
v_mfma_f32_16x16x32_bf16 v[160:163], a[100:103], a[52:55], v[160:163]
ds_read_b64_tr_b16 a[90:91], v15 offset:4352
v_mfma_f32_16x16x32_bf16 v[160:163], a[96:99], a[36:39], v[160:163]
ds_read_b64_tr_b16 a[92:93], v15 offset:6144
v_mfma_f32_16x16x32_bf16 v[168:171], a[96:99], a[40:43], v[168:171]
ds_read_b64_tr_b16 a[94:95], v15 offset:6400
v_mfma_f32_16x16x32_bf16 v[168:171], a[100:103], a[56:59], v[168:171]
v_mfma_f32_16x16x32_bf16 v[176:179], a[100:103], a[60:63], v[176:179]
s_add_u32 m0, s16, 0x1800
v_mfma_f32_16x16x32_bf16 v[176:179], a[96:99], a[44:47], v[176:179]
buffer_load_dwordx4 v22, s[44:47], s23 offen lds
v_mfma_f32_16x16x32_bf16 v[180:183], a[104:107], a[44:47], v[180:183]
ds_read_b64_tr_b16 a[96:97], v14 offset:8192
v_mfma_f32_16x16x32_bf16 v[180:183], a[108:111], a[60:63], v[180:183]
ds_read_b64_tr_b16 a[98:99], v14 offset:8448
v_mfma_f32_16x16x32_bf16 v[172:175], a[108:111], a[56:59], v[172:175]
ds_read_b64_tr_b16 a[100:101], v14 offset:10240
v_mfma_f32_16x16x32_bf16 v[172:175], a[104:107], a[40:43], v[172:175]
ds_read_b64_tr_b16 a[102:103], v14 offset:10496
s_add_u32 m0, s16, 0x1c00
v_mfma_f32_16x16x32_bf16 v[164:167], a[104:107], a[36:39], v[164:167]
buffer_load_dwordx4 v23, s[44:47], s23 offen lds
v_mfma_f32_16x16x32_bf16 v[164:167], a[108:111], a[52:55], v[164:167]
v_lshl_add_u32 v22, s42, 7, v22
v_lshl_add_u32 v23, s42, 7, v23
v_mfma_f32_16x16x32_bf16 v[156:159], a[108:111], a[48:51], v[156:159]
v_mfma_f32_16x16x32_bf16 v[156:159], a[104:107], a[32:35], v[156:159]
s_waitcnt lgkmcnt(4)
v_mfma_f32_16x16x32_bf16 v[184:187], a[80:83], a[32:35], v[184:187]
ds_read_b64_tr_b16 a[104:105], v15 offset:8192
v_mfma_f32_16x16x32_bf16 v[184:187], a[84:87], a[48:51], v[184:187]
ds_read_b64_tr_b16 a[106:107], v15 offset:8448
s_add_u32 s8, s28, 0x5000
v_mfma_f32_16x16x32_bf16 v[192:195], a[84:87], a[52:55], v[192:195]
buffer_store_dwordx4 a[224:227], v16, s[88:91], s8 offen sc1
v_mfma_f32_16x16x32_bf16 v[192:195], a[80:83], a[36:39], v[192:195]
ds_read_b64_tr_b16 a[108:109], v15 offset:10240
v_mfma_f32_16x16x32_bf16 v[200:203], a[80:83], a[40:43], v[200:203]
ds_read_b64_tr_b16 a[110:111], v15 offset:10496
v_add_u32 v12, 0x8000, v12
v_mfma_f32_16x16x32_bf16 v[200:203], a[84:87], a[56:59], v[200:203]
v_add_u32 v13, 0x8000, v13
v_add_u32 v14, 0x8000, v14
v_mfma_f32_16x16x32_bf16 v[208:211], a[84:87], a[60:63], v[208:211]
L_padA8:
s_cmp_eq_u32 s95, 1
s_cbranch_scc1 L_padA12
v_add_u32 v15, 0x8000, v15
v_mfma_f32_16x16x32_bf16 v[208:211], a[80:83], a[44:47], v[208:211]
v_mfma_f32_16x16x32_bf16 v[212:215], a[88:91], a[44:47], v[212:215]
s_waitcnt vmcnt(28) lgkmcnt(0)
v_mfma_f32_16x16x32_bf16 v[212:215], a[92:95], a[60:63], v[212:215]
s_barrier
s_add_u32 m0, s17, 0x0
v_mfma_f32_16x16x32_bf16 v[204:207], a[92:95], a[56:59], v[204:207]
buffer_load_dwordx4 v5, s[52:55], 0 offen lds
v_mfma_f32_16x16x32_bf16 v[204:207], a[88:91], a[40:43], v[204:207]
ds_read_b64_tr_b16 a[80:81], v12 offset:0
v_mfma_f32_16x16x32_bf16 v[196:199], a[88:91], a[36:39], v[196:199]
ds_read_b64_tr_b16 a[82:83], v12 offset:1024
v_mfma_f32_16x16x32_bf16 v[196:199], a[92:95], a[52:55], v[196:199]
ds_read_b64_tr_b16 a[84:85], v12 offset:8192
v_mfma_f32_16x16x32_bf16 v[188:191], a[92:95], a[48:51], v[188:191]
ds_read_b64_tr_b16 a[86:87], v12 offset:9216
v_mfma_f32_16x16x32_bf16 v[188:191], a[88:91], a[32:35], v[188:191]
s_add_u32 m0, s17, 0x400
s_waitcnt lgkmcnt(4)
v_mfma_f32_16x16x32_bf16 v[216:219], a[32:35], a[96:99], v[216:219]
buffer_load_dwordx4 v5, s[52:55], s13 offen lds
v_mfma_f32_16x16x32_bf16 v[216:219], a[48:51], a[100:103], v[216:219]
ds_read_b64_tr_b16 a[88:89], v13 offset:0
v_mfma_f32_16x16x32_bf16 v[224:227], a[52:55], a[100:103], v[224:227]
ds_read_b64_tr_b16 a[90:91], v13 offset:1024
v_mfma_f32_16x16x32_bf16 v[224:227], a[36:39], a[96:99], v[224:227]
ds_read_b64_tr_b16 a[92:93], v13 offset:8192
v_mfma_f32_16x16x32_bf16 v[232:235], a[40:43], a[96:99], v[232:235]
ds_read_b64_tr_b16 a[94:95], v13 offset:9216
v_mfma_f32_16x16x32_bf16 v[232:235], a[56:59], a[100:103], v[232:235]
v_mfma_f32_16x16x32_bf16 v[240:243], a[60:63], a[100:103], v[240:243]
s_add_u32 m0, s17, 0x800
v_mfma_f32_16x16x32_bf16 v[240:243], a[44:47], a[96:99], v[240:243]
buffer_load_dwordx4 v6, s[52:55], 0 offen lds
v_mfma_f32_16x16x32_bf16 v[244:247], a[44:47], a[104:107], v[244:247]
ds_read_b64_tr_b16 a[96:97], v12 offset:256
v_mfma_f32_16x16x32_bf16 v[244:247], a[60:63], a[108:111], v[244:247]
ds_read_b64_tr_b16 a[98:99], v12 offset:1280
v_mfma_f32_16x16x32_bf16 v[236:239], a[56:59], a[108:111], v[236:239]
ds_read_b64_tr_b16 a[100:101], v12 offset:8448
v_mfma_f32_16x16x32_bf16 v[236:239], a[40:43], a[104:107], v[236:239]
ds_read_b64_tr_b16 a[102:103], v12 offset:9472
v_mfma_f32_16x16x32_bf16 v[228:231], a[36:39], a[104:107], v[228:231]
v_mfma_f32_16x16x32_bf16 v[228:231], a[52:55], a[108:111], v[228:231]
s_add_u32 m0, s17, 0xc00
v_mfma_f32_16x16x32_bf16 v[220:223], a[48:51], a[108:111], v[220:223]
buffer_load_dwordx4 v6, s[52:55], s13 offen lds
v_mfma_f32_16x16x32_bf16 v[220:223], a[32:35], a[104:107], v[220:223]
s_waitcnt lgkmcnt(4)
L_S16:
v_mfma_f32_16x16x32_bf16 v[24:27], a[80:83], a[0:3], v[24:27]
ds_read_b64_tr_b16 a[104:105], v13 offset:256
s_waitcnt vmcnt(23)
v_mfma_f32_16x16x32_bf16 v[24:27], a[84:87], a[16:19], v[24:27]
ds_read_b64_tr_b16 a[106:107], v13 offset:1280
v_mfma_f32_16x16x32_bf16 v[32:35], a[84:87], a[20:23], v[32:35]
ds_read_b64_tr_b16 a[108:109], v13 offset:8448
v_mfma_f32_16x16x32_bf16 v[32:35], a[80:83], a[4:7], v[32:35]
ds_read_b64_tr_b16 a[110:111], v13 offset:9472
v_mfma_f32_16x16x32_bf16 v[40:43], a[80:83], a[8:11], v[40:43]
ds_read_b128 a[32:35], v8 offset:32768
s_add_u32 m0, s18, 0x4000
v_mfma_f32_16x16x32_bf16 v[40:43], a[84:87], a[24:27], v[40:43]
buffer_load_dwordx4 v7, s[68:71], 0 offen lds
v_mfma_f32_16x16x32_bf16 v[48:51], a[84:87], a[28:31], v[48:51]
ds_read_b128 a[48:51], v9 offset:32768
v_mfma_f32_16x16x32_bf16 v[48:51], a[80:83], a[12:15], v[48:51]
ds_read_b128 a[36:39], v8 offset:34816
v_mfma_f32_16x16x32_bf16 v[52:55], a[88:91], a[12:15], v[52:55]
ds_read_b64_tr_b16 a[80:81], v12 offset:512
v_mfma_f32_16x16x32_bf16 v[52:55], a[92:95], a[28:31], v[52:55]
ds_read_b64_tr_b16 a[82:83], v12 offset:1536
v_mfma_f32_16x16x32_bf16 v[44:47], a[92:95], a[24:27], v[44:47]
ds_read_b64_tr_b16 a[84:85], v12 offset:8704
s_add_u32 s8, s28, 0x9000
v_mfma_f32_16x16x32_bf16 v[44:47], a[88:91], a[8:11], v[44:47]
buffer_store_dwordx4 a[228:231], v16, s[88:91], s8 offen sc1
v_mfma_f32_16x16x32_bf16 v[36:39], a[88:91], a[4:7], v[36:39]
ds_read_b64_tr_b16 a[86:87], v12 offset:9728
v_mfma_f32_16x16x32_bf16 v[36:39], a[92:95], a[20:23], v[36:39]
ds_read_b128 a[52:55], v9 offset:34816
v_mfma_f32_16x16x32_bf16 v[28:31], a[92:95], a[16:19], v[28:31]
ds_read_b128 a[40:43], v8 offset:36864
v_mfma_f32_16x16x32_bf16 v[28:31], a[88:91], a[0:3], v[28:31]
ds_read_b128 a[56:59], v9 offset:36864
s_waitcnt lgkmcnt(10)
v_mfma_f32_16x16x32_bf16 v[56:59], a[96:99], a[0:3], v[56:59]
ds_read_b64_tr_b16 a[88:89], v13 offset:512
v_mfma_f32_16x16x32_bf16 v[56:59], a[100:103], a[16:19], v[56:59]
ds_read_b64_tr_b16 a[90:91], v13 offset:1536
s_add_u32 m0, s18, 0x5000
v_mfma_f32_16x16x32_bf16 v[64:67], a[100:103], a[20:23], v[64:67]
buffer_load_dwordx4 v7, s[68:71], s25 offen lds
v_mfma_f32_16x16x32_bf16 v[64:67], a[96:99], a[4:7], v[64:67]
ds_read_b64_tr_b16 a[92:93], v13 offset:8704
v_mfma_f32_16x16x32_bf16 v[72:75], a[96:99], a[8:11], v[72:75]
ds_read_b64_tr_b16 a[94:95], v13 offset:9728
v_mfma_f32_16x16x32_bf16 v[72:75], a[100:103], a[24:27], v[72:75]
ds_read_b128 a[44:47], v8 offset:38912
v_mfma_f32_16x16x32_bf16 v[80:83], a[100:103], a[28:31], v[80:83]
ds_read_b128 a[60:63], v9 offset:38912
v_mfma_f32_16x16x32_bf16 v[80:83], a[96:99], a[12:15], v[80:83]
v_mfma_f32_16x16x32_bf16 v[84:87], a[104:107], a[12:15], v[84:87]
ds_read_b64_tr_b16 a[96:97], v12 offset:768
s_add_u32 m0, s18, 0x6000
v_mfma_f32_16x16x32_bf16 v[84:87], a[108:111], a[28:31], v[84:87]
buffer_load_dwordx4 v7, s[68:71], s26 offen lds
v_mfma_f32_16x16x32_bf16 v[76:79], a[108:111], a[24:27], v[76:79]
ds_read_b64_tr_b16 a[98:99], v12 offset:1792
v_lshl_add_u32 v5, s42, 19, v5
v_mfma_f32_16x16x32_bf16 v[76:79], a[104:107], a[8:11], v[76:79]
ds_read_b64_tr_b16 a[100:101], v12 offset:8960
v_lshl_add_u32 v6, s42, 19, v6
v_mfma_f32_16x16x32_bf16 v[68:71], a[104:107], a[4:7], v[68:71]
ds_read_b64_tr_b16 a[102:103], v12 offset:9984
v_lshl_add_u32 v7, s42, 18, v7
v_mfma_f32_16x16x32_bf16 v[68:71], a[108:111], a[20:23], v[68:71]
v_lshl_add_u32 v7, s42, 17, v7
v_mfma_f32_16x16x32_bf16 v[60:63], a[108:111], a[16:19], v[60:63]
v_mfma_f32_16x16x32_bf16 v[60:63], a[104:107], a[0:3], v[60:63]
s_add_u32 m0, s16, 0x8000
s_waitcnt lgkmcnt(4)
s_waitcnt lgkmcnt(6)
v_mfma_f32_16x16x32_bf16 v[88:91], a[80:83], a[0:3], v[88:91]
buffer_load_dwordx4 v22, s[44:47], s20 offen lds
v_mfma_f32_16x16x32_bf16 v[88:91], a[84:87], a[16:19], v[88:91]
ds_read_b64_tr_b16 a[104:105], v13 offset:768
v_mfma_f32_16x16x32_bf16 v[96:99], a[84:87], a[20:23], v[96:99]
ds_read_b64_tr_b16 a[106:107], v13 offset:1792
v_mfma_f32_16x16x32_bf16 v[96:99], a[80:83], a[4:7], v[96:99]
ds_read_b64_tr_b16 a[108:109], v13 offset:8960
v_mfma_f32_16x16x32_bf16 v[104:107], a[80:83], a[8:11], v[104:107]
ds_read_b64_tr_b16 a[110:111], v13 offset:9984
s_add_u32 m0, s16, 0x8400
v_mfma_f32_16x16x32_bf16 v[104:107], a[84:87], a[24:27], v[104:107]
buffer_load_dwordx4 v23, s[44:47], s20 offen lds
v_mfma_f32_16x16x32_bf16 v[112:115], a[84:87], a[28:31], v[112:115]
v_mfma_f32_16x16x32_bf16 v[112:115], a[80:83], a[12:15], v[112:115]
v_mfma_f32_16x16x32_bf16 v[116:119], a[88:91], a[12:15], v[116:119]
ds_read_b64_tr_b16 a[80:81], v14 offset:0
v_mfma_f32_16x16x32_bf16 v[116:119], a[92:95], a[28:31], v[116:119]
ds_read_b64_tr_b16 a[82:83], v14 offset:256
v_mfma_f32_16x16x32_bf16 v[108:111], a[92:95], a[24:27], v[108:111]
ds_read_b64_tr_b16 a[84:85], v14 offset:2048
s_add_u32 m0, s16, 0x8800
v_mfma_f32_16x16x32_bf16 v[108:111], a[88:91], a[8:11], v[108:111]
buffer_load_dwordx4 v22, s[44:47], s21 offen lds
v_mfma_f32_16x16x32_bf16 v[100:103], a[88:91], a[4:7], v[100:103]
ds_read_b64_tr_b16 a[86:87], v14 offset:2304
v_mfma_f32_16x16x32_bf16 v[100:103], a[92:95], a[20:23], v[100:103]
v_mfma_f32_16x16x32_bf16 v[92:95], a[92:95], a[16:19], v[92:95]
v_mfma_f32_16x16x32_bf16 v[92:95], a[88:91], a[0:3], v[92:95]
s_add_u32 s8, s28, 0x5400
s_waitcnt lgkmcnt(4)
v_mfma_f32_16x16x32_bf16 v[120:123], a[96:99], a[0:3], v[120:123]
buffer_store_dwordx4 a[112:115], v16, s[88:91], s8 offen sc1
v_mfma_f32_16x16x32_bf16 v[120:123], a[100:103], a[16:19], v[120:123]
ds_read_b64_tr_b16 a[88:89], v15 offset:0
v_mfma_f32_16x16x32_bf16 v[128:131], a[100:103], a[20:23], v[128:131]
ds_read_b64_tr_b16 a[90:91], v15 offset:256
v_mfma_f32_16x16x32_bf16 v[128:131], a[96:99], a[4:7], v[128:131]
ds_read_b64_tr_b16 a[92:93], v15 offset:2048
v_mfma_f32_16x16x32_bf16 v[136:139], a[96:99], a[8:11], v[136:139]
ds_read_b64_tr_b16 a[94:95], v15 offset:2304
v_mfma_f32_16x16x32_bf16 v[136:139], a[100:103], a[24:27], v[136:139]
s_add_u32 m0, s16, 0x8c00
v_mfma_f32_16x16x32_bf16 v[144:147], a[100:103], a[28:31], v[144:147]
buffer_load_dwordx4 v23, s[44:47], s21 offen lds
v_mfma_f32_16x16x32_bf16 v[144:147], a[96:99], a[12:15], v[144:147]
v_mfma_f32_16x16x32_bf16 v[148:151], a[104:107], a[12:15], v[148:151]
ds_read_b64_tr_b16 a[96:97], v14 offset:4096
v_mfma_f32_16x16x32_bf16 v[148:151], a[108:111], a[28:31], v[148:151]
ds_read_b64_tr_b16 a[98:99], v14 offset:4352
v_mfma_f32_16x16x32_bf16 v[140:143], a[108:111], a[24:27], v[140:143]
ds_read_b64_tr_b16 a[100:101], v14 offset:6144
v_mfma_f32_16x16x32_bf16 v[140:143], a[104:107], a[8:11], v[140:143]
ds_read_b64_tr_b16 a[102:103], v14 offset:6400
s_add_u32 m0, s16, 0x9000
v_mfma_f32_16x16x32_bf16 v[132:135], a[104:107], a[4:7], v[132:135]
buffer_load_dwordx4 v22, s[44:47], s22 offen lds
v_mfma_f32_16x16x32_bf16 v[132:135], a[108:111], a[20:23], v[132:135]
v_mfma_f32_16x16x32_bf16 v[124:127], a[108:111], a[16:19], v[124:127]
v_mfma_f32_16x16x32_bf16 v[124:127], a[104:107], a[0:3], v[124:127]
s_waitcnt lgkmcnt(4)
v_mfma_f32_16x16x32_bf16 v[152:155], a[80:83], a[0:3], v[152:155]
ds_read_b64_tr_b16 a[104:105], v15 offset:4096
s_add_u32 m0, s16, 0x9400
v_mfma_f32_16x16x32_bf16 v[152:155], a[84:87], a[16:19], v[152:155]
buffer_load_dwordx4 v23, s[44:47], s22 offen lds
v_mfma_f32_16x16x32_bf16 v[160:163], a[84:87], a[20:23], v[160:163]
ds_read_b64_tr_b16 a[106:107], v15 offset:4352
v_mfma_f32_16x16x32_bf16 v[160:163], a[80:83], a[4:7], v[160:163]
ds_read_b64_tr_b16 a[108:109], v15 offset:6144
v_mfma_f32_16x16x32_bf16 v[168:171], a[80:83], a[8:11], v[168:171]
ds_read_b64_tr_b16 a[110:111], v15 offset:6400
v_mfma_f32_16x16x32_bf16 v[168:171], a[84:87], a[24:27], v[168:171]
v_mfma_f32_16x16x32_bf16 v[176:179], a[84:87], a[28:31], v[176:179]
s_add_u32 m0, s16, 0x9800
v_mfma_f32_16x16x32_bf16 v[176:179], a[80:83], a[12:15], v[176:179]
buffer_load_dwordx4 v22, s[44:47], s23 offen lds
v_mfma_f32_16x16x32_bf16 v[180:183], a[88:91], a[12:15], v[180:183]
ds_read_b64_tr_b16 a[80:81], v14 offset:8192
v_mfma_f32_16x16x32_bf16 v[180:183], a[92:95], a[28:31], v[180:183]
ds_read_b64_tr_b16 a[82:83], v14 offset:8448
v_mfma_f32_16x16x32_bf16 v[172:175], a[92:95], a[24:27], v[172:175]
ds_read_b64_tr_b16 a[84:85], v14 offset:10240
v_mfma_f32_16x16x32_bf16 v[172:175], a[88:91], a[8:11], v[172:175]
ds_read_b64_tr_b16 a[86:87], v14 offset:10496
s_add_u32 m0, s16, 0x9c00
v_mfma_f32_16x16x32_bf16 v[164:167], a[88:91], a[4:7], v[164:167]
buffer_load_dwordx4 v23, s[44:47], s23 offen lds
v_mfma_f32_16x16x32_bf16 v[164:167], a[92:95], a[20:23], v[164:167]
v_lshl_add_u32 v22, s42, 7, v22
v_lshl_add_u32 v23, s42, 7, v23
v_mfma_f32_16x16x32_bf16 v[156:159], a[92:95], a[16:19], v[156:159]
v_mfma_f32_16x16x32_bf16 v[156:159], a[88:91], a[0:3], v[156:159]
s_waitcnt lgkmcnt(4)
v_mfma_f32_16x16x32_bf16 v[184:187], a[96:99], a[0:3], v[184:187]
ds_read_b64_tr_b16 a[88:89], v15 offset:8192
v_mfma_f32_16x16x32_bf16 v[184:187], a[100:103], a[16:19], v[184:187]
ds_read_b64_tr_b16 a[90:91], v15 offset:8448
s_add_u32 s8, s28, 0x9400
v_mfma_f32_16x16x32_bf16 v[192:195], a[100:103], a[20:23], v[192:195]
buffer_store_dwordx4 a[116:119], v16, s[88:91], s8 offen sc1
v_mfma_f32_16x16x32_bf16 v[192:195], a[96:99], a[4:7], v[192:195]
ds_read_b64_tr_b16 a[92:93], v15 offset:10240
v_mfma_f32_16x16x32_bf16 v[200:203], a[96:99], a[8:11], v[200:203]
ds_read_b64_tr_b16 a[94:95], v15 offset:10496
v_add_u32 v12, 0x8000, v12
v_mfma_f32_16x16x32_bf16 v[200:203], a[100:103], a[24:27], v[200:203]
v_add_u32 v13, 0x8000, v13
v_add_u32 v14, 0x8000, v14
v_mfma_f32_16x16x32_bf16 v[208:211], a[100:103], a[28:31], v[208:211]
v_add_u32 v15, 0x8000, v15
v_mfma_f32_16x16x32_bf16 v[208:211], a[96:99], a[12:15], v[208:211]
v_mfma_f32_16x16x32_bf16 v[212:215], a[104:107], a[12:15], v[212:215]
s_waitcnt vmcnt(28) lgkmcnt(0)
v_mfma_f32_16x16x32_bf16 v[212:215], a[108:111], a[28:31], v[212:215]
s_barrier
s_add_u32 m0, s17, 0x8000
v_mfma_f32_16x16x32_bf16 v[204:207], a[108:111], a[24:27], v[204:207]
buffer_load_dwordx4 v5, s[52:55], 0 offen lds
v_mfma_f32_16x16x32_bf16 v[204:207], a[104:107], a[8:11], v[204:207]
ds_read_b64_tr_b16 a[96:97], v12 offset:0
v_mfma_f32_16x16x32_bf16 v[196:199], a[104:107], a[4:7], v[196:199]
ds_read_b64_tr_b16 a[98:99], v12 offset:1024
v_mfma_f32_16x16x32_bf16 v[196:199], a[108:111], a[20:23], v[196:199]
ds_read_b64_tr_b16 a[100:101], v12 offset:8192
v_mfma_f32_16x16x32_bf16 v[188:191], a[108:111], a[16:19], v[188:191]
ds_read_b64_tr_b16 a[102:103], v12 offset:9216
v_mfma_f32_16x16x32_bf16 v[188:191], a[104:107], a[0:3], v[188:191]
s_add_u32 m0, s17, 0x8400
s_waitcnt lgkmcnt(4)
v_mfma_f32_16x16x32_bf16 v[216:219], a[0:3], a[80:83], v[216:219]
buffer_load_dwordx4 v5, s[52:55], s13 offen lds
v_mfma_f32_16x16x32_bf16 v[216:219], a[16:19], a[84:87], v[216:219]
ds_read_b64_tr_b16 a[104:105], v13 offset:0
v_mfma_f32_16x16x32_bf16 v[224:227], a[20:23], a[84:87], v[224:227]
ds_read_b64_tr_b16 a[106:107], v13 offset:1024
v_mfma_f32_16x16x32_bf16 v[224:227], a[4:7], a[80:83], v[224:227]
ds_read_b64_tr_b16 a[108:109], v13 offset:8192
v_mfma_f32_16x16x32_bf16 v[232:235], a[8:11], a[80:83], v[232:235]
ds_read_b64_tr_b16 a[110:111], v13 offset:9216
v_mfma_f32_16x16x32_bf16 v[232:235], a[24:27], a[84:87], v[232:235]
s_add_u32 m0, s17, 0x8800
v_mfma_f32_16x16x32_bf16 v[240:243], a[28:31], a[84:87], v[240:243]
buffer_load_dwordx4 v6, s[52:55], 0 offen lds
v_mfma_f32_16x16x32_bf16 v[240:243], a[12:15], a[80:83], v[240:243]
v_mfma_f32_16x16x32_bf16 v[244:247], a[12:15], a[88:91], v[244:247]
ds_read_b64_tr_b16 a[80:81], v12 offset:256
v_mfma_f32_16x16x32_bf16 v[244:247], a[28:31], a[92:95], v[244:247]
ds_read_b64_tr_b16 a[82:83], v12 offset:1280
v_mfma_f32_16x16x32_bf16 v[236:239], a[24:27], a[92:95], v[236:239]
ds_read_b64_tr_b16 a[84:85], v12 offset:8448
v_mfma_f32_16x16x32_bf16 v[236:239], a[8:11], a[88:91], v[236:239]
ds_read_b64_tr_b16 a[86:87], v12 offset:9472
s_add_u32 s8, s28, 0x5800
v_mfma_f32_16x16x32_bf16 v[228:231], a[4:7], a[88:91], v[228:231]
buffer_store_dwordx4 a[124:127], v16, s[88:91], s8 offen sc1
v_mfma_f32_16x16x32_bf16 v[228:231], a[20:23], a[92:95], v[228:231]
v_mfma_f32_16x16x32_bf16 v[220:223], a[16:19], a[92:95], v[220:223]
v_mfma_f32_16x16x32_bf16 v[220:223], a[0:3], a[88:91], v[220:223]
s_waitcnt lgkmcnt(4)
L_S17:
v_mfma_f32_16x16x32_bf16 v[24:27], a[96:99], a[32:35], v[24:27]
ds_read_b64_tr_b16 a[88:89], v13 offset:256
s_waitcnt vmcnt(23)
v_mfma_f32_16x16x32_bf16 v[24:27], a[100:103], a[48:51], v[24:27]
ds_read_b64_tr_b16 a[90:91], v13 offset:1280
s_add_u32 m0, s17, 0x8c00
v_mfma_f32_16x16x32_bf16 v[32:35], a[100:103], a[52:55], v[32:35]
buffer_load_dwordx4 v6, s[52:55], s13 offen lds
v_mfma_f32_16x16x32_bf16 v[32:35], a[96:99], a[36:39], v[32:35]
ds_read_b64_tr_b16 a[92:93], v13 offset:8448
v_mfma_f32_16x16x32_bf16 v[40:43], a[96:99], a[40:43], v[40:43]
ds_read_b64_tr_b16 a[94:95], v13 offset:9472
v_mfma_f32_16x16x32_bf16 v[40:43], a[100:103], a[56:59], v[40:43]
ds_read_b128 a[0:3], v8 offset:0
v_mfma_f32_16x16x32_bf16 v[48:51], a[100:103], a[60:63], v[48:51]
ds_read_b128 a[16:19], v9 offset:0
v_mfma_f32_16x16x32_bf16 v[48:51], a[96:99], a[44:47], v[48:51]
ds_read_b128 a[4:7], v8 offset:2048
s_add_u32 m0, s18, 0xc000
v_mfma_f32_16x16x32_bf16 v[52:55], a[104:107], a[44:47], v[52:55]
buffer_load_dwordx4 v7, s[68:71], 0 offen lds
v_mfma_f32_16x16x32_bf16 v[52:55], a[108:111], a[60:63], v[52:55]
ds_read_b64_tr_b16 a[96:97], v12 offset:512
v_mfma_f32_16x16x32_bf16 v[44:47], a[108:111], a[56:59], v[44:47]
ds_read_b64_tr_b16 a[98:99], v12 offset:1536
v_mfma_f32_16x16x32_bf16 v[44:47], a[104:107], a[40:43], v[44:47]
ds_read_b64_tr_b16 a[100:101], v12 offset:8704
v_mfma_f32_16x16x32_bf16 v[36:39], a[104:107], a[36:39], v[36:39]
ds_read_b64_tr_b16 a[102:103], v12 offset:9728
v_mfma_f32_16x16x32_bf16 v[36:39], a[108:111], a[52:55], v[36:39]
ds_read_b128 a[20:23], v9 offset:2048
s_add_u32 m0, s18, 0xd000
v_mfma_f32_16x16x32_bf16 v[28:31], a[108:111], a[48:51], v[28:31]
buffer_load_dwordx4 v7, s[68:71], s25 offen lds
v_mfma_f32_16x16x32_bf16 v[28:31], a[104:107], a[32:35], v[28:31]
ds_read_b128 a[8:11], v8 offset:4096
s_waitcnt lgkmcnt(9)
v_mfma_f32_16x16x32_bf16 v[56:59], a[80:83], a[32:35], v[56:59]
ds_read_b64_tr_b16 a[104:105], v13 offset:512
v_mfma_f32_16x16x32_bf16 v[56:59], a[84:87], a[48:51], v[56:59]
ds_read_b64_tr_b16 a[106:107], v13 offset:1536
v_mfma_f32_16x16x32_bf16 v[64:67], a[84:87], a[52:55], v[64:67]
ds_read_b64_tr_b16 a[108:109], v13 offset:8704
v_mfma_f32_16x16x32_bf16 v[64:67], a[80:83], a[36:39], v[64:67]
ds_read_b64_tr_b16 a[110:111], v13 offset:9728
s_add_u32 m0, s18, 0xe000
v_mfma_f32_16x16x32_bf16 v[72:75], a[80:83], a[40:43], v[72:75]
buffer_load_dwordx4 v7, s[68:71], s26 offen lds
v_mfma_f32_16x16x32_bf16 v[72:75], a[84:87], a[56:59], v[72:75]
ds_read_b128 a[24:27], v9 offset:4096
v_lshl_add_u32 v5, s42, 19, v5
v_mfma_f32_16x16x32_bf16 v[80:83], a[84:87], a[60:63], v[80:83]
ds_read_b128 a[12:15], v8 offset:6144
v_lshl_add_u32 v6, s42, 19, v6
v_mfma_f32_16x16x32_bf16 v[80:83], a[80:83], a[44:47], v[80:83]
ds_read_b128 a[28:31], v9 offset:6144
v_lshl_add_u32 v7, s42, 18, v7
v_mfma_f32_16x16x32_bf16 v[84:87], a[88:91], a[44:47], v[84:87]
ds_read_b64_tr_b16 a[80:81], v12 offset:768
v_lshl_add_u32 v7, s42, 17, v7
v_mfma_f32_16x16x32_bf16 v[84:87], a[92:95], a[60:63], v[84:87]
ds_read_b64_tr_b16 a[82:83], v12 offset:1792
s_add_u32 s8, s28, 0x9800
v_mfma_f32_16x16x32_bf16 v[76:79], a[92:95], a[56:59], v[76:79]
buffer_store_dwordx4 a[232:235], v16, s[88:91], s8 offen sc1
v_mfma_f32_16x16x32_bf16 v[76:79], a[88:91], a[40:43], v[76:79]
ds_read_b64_tr_b16 a[84:85], v12 offset:8960
v_mfma_f32_16x16x32_bf16 v[68:71], a[88:91], a[36:39], v[68:71]
ds_read_b64_tr_b16 a[86:87], v12 offset:9984
v_mfma_f32_16x16x32_bf16 v[68:71], a[92:95], a[52:55], v[68:71]
v_mfma_f32_16x16x32_bf16 v[60:63], a[92:95], a[48:51], v[60:63]
v_mfma_f32_16x16x32_bf16 v[60:63], a[88:91], a[32:35], v[60:63]
s_add_u32 m0, s16, 0x0
s_waitcnt lgkmcnt(4)
s_waitcnt lgkmcnt(7)
v_mfma_f32_16x16x32_bf16 v[88:91], a[96:99], a[32:35], v[88:91]
buffer_load_dwordx4 v22, s[44:47], s20 offen lds
v_mfma_f32_16x16x32_bf16 v[88:91], a[100:103], a[48:51], v[88:91]
ds_read_b64_tr_b16 a[88:89], v13 offset:768
v_mfma_f32_16x16x32_bf16 v[96:99], a[100:103], a[52:55], v[96:99]
ds_read_b64_tr_b16 a[90:91], v13 offset:1792
v_mfma_f32_16x16x32_bf16 v[96:99], a[96:99], a[36:39], v[96:99]
ds_read_b64_tr_b16 a[92:93], v13 offset:8960
v_mfma_f32_16x16x32_bf16 v[104:107], a[96:99], a[40:43], v[104:107]
ds_read_b64_tr_b16 a[94:95], v13 offset:9984
s_add_u32 m0, s16, 0x400
v_mfma_f32_16x16x32_bf16 v[104:107], a[100:103], a[56:59], v[104:107]
buffer_load_dwordx4 v23, s[44:47], s20 offen lds
v_mfma_f32_16x16x32_bf16 v[112:115], a[100:103], a[60:63], v[112:115]
v_mfma_f32_16x16x32_bf16 v[112:115], a[96:99], a[44:47], v[112:115]
v_mfma_f32_16x16x32_bf16 v[116:119], a[104:107], a[44:47], v[116:119]
ds_read_b64_tr_b16 a[96:97], v14 offset:0
v_mfma_f32_16x16x32_bf16 v[116:119], a[108:111], a[60:63], v[116:119]
ds_read_b64_tr_b16 a[98:99], v14 offset:256
v_mfma_f32_16x16x32_bf16 v[108:111], a[108:111], a[56:59], v[108:111]
ds_read_b64_tr_b16 a[100:101], v14 offset:2048
s_add_u32 m0, s16, 0x800
v_mfma_f32_16x16x32_bf16 v[108:111], a[104:107], a[40:43], v[108:111]
buffer_load_dwordx4 v22, s[44:47], s21 offen lds
v_mfma_f32_16x16x32_bf16 v[100:103], a[104:107], a[36:39], v[100:103]
ds_read_b64_tr_b16 a[102:103], v14 offset:2304
v_mfma_f32_16x16x32_bf16 v[100:103], a[108:111], a[52:55], v[100:103]
v_mfma_f32_16x16x32_bf16 v[92:95], a[108:111], a[48:51], v[92:95]
v_mfma_f32_16x16x32_bf16 v[92:95], a[104:107], a[32:35], v[92:95]
s_add_u32 m0, s16, 0xc00
s_waitcnt lgkmcnt(4)
v_mfma_f32_16x16x32_bf16 v[120:123], a[80:83], a[32:35], v[120:123]
buffer_load_dwordx4 v23, s[44:47], s21 offen lds
v_mfma_f32_16x16x32_bf16 v[120:123], a[84:87], a[48:51], v[120:123]
ds_read_b64_tr_b16 a[104:105], v15 offset:0
v_mfma_f32_16x16x32_bf16 v[128:131], a[84:87], a[52:55], v[128:131]
ds_read_b64_tr_b16 a[106:107], v15 offset:256
v_mfma_f32_16x16x32_bf16 v[128:131], a[80:83], a[36:39], v[128:131]
ds_read_b64_tr_b16 a[108:109], v15 offset:2048
v_mfma_f32_16x16x32_bf16 v[136:139], a[80:83], a[40:43], v[136:139]
ds_read_b64_tr_b16 a[110:111], v15 offset:2304
v_mfma_f32_16x16x32_bf16 v[136:139], a[84:87], a[56:59], v[136:139]
s_add_u32 s8, s28, 0x5c00
v_mfma_f32_16x16x32_bf16 v[144:147], a[84:87], a[60:63], v[144:147]
buffer_store_dwordx4 a[240:243], v16, s[88:91], s8 offen sc1
v_mfma_f32_16x16x32_bf16 v[144:147], a[80:83], a[44:47], v[144:147]
v_mfma_f32_16x16x32_bf16 v[148:151], a[88:91], a[44:47], v[148:151]
ds_read_b64_tr_b16 a[80:81], v14 offset:4096
v_mfma_f32_16x16x32_bf16 v[148:151], a[92:95], a[60:63], v[148:151]
ds_read_b64_tr_b16 a[82:83], v14 offset:4352
v_mfma_f32_16x16x32_bf16 v[140:143], a[92:95], a[56:59], v[140:143]
ds_read_b64_tr_b16 a[84:85], v14 offset:6144
v_mfma_f32_16x16x32_bf16 v[140:143], a[88:91], a[40:43], v[140:143]
ds_read_b64_tr_b16 a[86:87], v14 offset:6400
s_add_u32 m0, s16, 0x1000
v_mfma_f32_16x16x32_bf16 v[132:135], a[88:91], a[36:39], v[132:135]
buffer_load_dwordx4 v22, s[44:47], s22 offen lds
v_mfma_f32_16x16x32_bf16 v[132:135], a[92:95], a[52:55], v[132:135]
v_mfma_f32_16x16x32_bf16 v[124:127], a[92:95], a[48:51], v[124:127]
v_mfma_f32_16x16x32_bf16 v[124:127], a[88:91], a[32:35], v[124:127]
s_waitcnt lgkmcnt(4)
v_mfma_f32_16x16x32_bf16 v[152:155], a[96:99], a[32:35], v[152:155]
ds_read_b64_tr_b16 a[88:89], v15 offset:4096
s_add_u32 m0, s16, 0x1400
v_mfma_f32_16x16x32_bf16 v[152:155], a[100:103], a[48:51], v[152:155]
buffer_load_dwordx4 v23, s[44:47], s22 offen lds
v_mfma_f32_16x16x32_bf16 v[160:163], a[100:103], a[52:55], v[160:163]
ds_read_b64_tr_b16 a[90:91], v15 offset:4352
v_mfma_f32_16x16x32_bf16 v[160:163], a[96:99], a[36:39], v[160:163]
ds_read_b64_tr_b16 a[92:93], v15 offset:6144
v_mfma_f32_16x16x32_bf16 v[168:171], a[96:99], a[40:43], v[168:171]
ds_read_b64_tr_b16 a[94:95], v15 offset:6400
v_mfma_f32_16x16x32_bf16 v[168:171], a[100:103], a[56:59], v[168:171]
v_mfma_f32_16x16x32_bf16 v[176:179], a[100:103], a[60:63], v[176:179]
s_add_u32 m0, s16, 0x1800
v_mfma_f32_16x16x32_bf16 v[176:179], a[96:99], a[44:47], v[176:179]
buffer_load_dwordx4 v22, s[44:47], s23 offen lds
v_mfma_f32_16x16x32_bf16 v[180:183], a[104:107], a[44:47], v[180:183]
ds_read_b64_tr_b16 a[96:97], v14 offset:8192
v_mfma_f32_16x16x32_bf16 v[180:183], a[108:111], a[60:63], v[180:183]
ds_read_b64_tr_b16 a[98:99], v14 offset:8448
v_mfma_f32_16x16x32_bf16 v[172:175], a[108:111], a[56:59], v[172:175]
ds_read_b64_tr_b16 a[100:101], v14 offset:10240
v_mfma_f32_16x16x32_bf16 v[172:175], a[104:107], a[40:43], v[172:175]
ds_read_b64_tr_b16 a[102:103], v14 offset:10496
s_add_u32 m0, s16, 0x1c00
v_mfma_f32_16x16x32_bf16 v[164:167], a[104:107], a[36:39], v[164:167]
buffer_load_dwordx4 v23, s[44:47], s23 offen lds
v_mfma_f32_16x16x32_bf16 v[164:167], a[108:111], a[52:55], v[164:167]
v_lshl_add_u32 v22, s42, 7, v22
v_lshl_add_u32 v23, s42, 7, v23
v_mfma_f32_16x16x32_bf16 v[156:159], a[108:111], a[48:51], v[156:159]
v_mfma_f32_16x16x32_bf16 v[156:159], a[104:107], a[32:35], v[156:159]
s_waitcnt lgkmcnt(4)
v_mfma_f32_16x16x32_bf16 v[184:187], a[80:83], a[32:35], v[184:187]
ds_read_b64_tr_b16 a[104:105], v15 offset:8192
v_mfma_f32_16x16x32_bf16 v[184:187], a[84:87], a[48:51], v[184:187]
ds_read_b64_tr_b16 a[106:107], v15 offset:8448
s_add_u32 s8, s28, 0x9c00
v_mfma_f32_16x16x32_bf16 v[192:195], a[84:87], a[52:55], v[192:195]
buffer_store_dwordx4 a[248:251], v16, s[88:91], s8 offen sc1
v_mfma_f32_16x16x32_bf16 v[192:195], a[80:83], a[36:39], v[192:195]
ds_read_b64_tr_b16 a[108:109], v15 offset:10240
v_mfma_f32_16x16x32_bf16 v[200:203], a[80:83], a[40:43], v[200:203]
ds_read_b64_tr_b16 a[110:111], v15 offset:10496
v_add_u32 v12, 0xffff0000, v12
v_mfma_f32_16x16x32_bf16 v[200:203], a[84:87], a[56:59], v[200:203]
v_add_u32 v13, 0xffff0000, v13
v_add_u32 v14, 0xffff0000, v14
v_mfma_f32_16x16x32_bf16 v[208:211], a[84:87], a[60:63], v[208:211]
v_add_u32 v15, 0xffff0000, v15
v_mfma_f32_16x16x32_bf16 v[208:211], a[80:83], a[44:47], v[208:211]
v_mfma_f32_16x16x32_bf16 v[212:215], a[88:91], a[44:47], v[212:215]
s_waitcnt vmcnt(29) lgkmcnt(0)
v_mfma_f32_16x16x32_bf16 v[212:215], a[92:95], a[60:63], v[212:215]
s_barrier
s_add_u32 m0, s17, 0x10000
v_mfma_f32_16x16x32_bf16 v[204:207], a[92:95], a[56:59], v[204:207]
buffer_load_dwordx4 v5, s[52:55], 0 offen lds
v_mfma_f32_16x16x32_bf16 v[204:207], a[88:91], a[40:43], v[204:207]
ds_read_b64_tr_b16 a[80:81], v12 offset:0
v_mfma_f32_16x16x32_bf16 v[196:199], a[88:91], a[36:39], v[196:199]
ds_read_b64_tr_b16 a[82:83], v12 offset:1024
v_mfma_f32_16x16x32_bf16 v[196:199], a[92:95], a[52:55], v[196:199]
ds_read_b64_tr_b16 a[84:85], v12 offset:8192
v_mfma_f32_16x16x32_bf16 v[188:191], a[92:95], a[48:51], v[188:191]
ds_read_b64_tr_b16 a[86:87], v12 offset:9216
v_mfma_f32_16x16x32_bf16 v[188:191], a[88:91], a[32:35], v[188:191]
s_add_u32 m0, s17, 0x10400
s_waitcnt lgkmcnt(4)
v_mfma_f32_16x16x32_bf16 v[216:219], a[32:35], a[96:99], v[216:219]
buffer_load_dwordx4 v5, s[52:55], s13 offen lds
v_mfma_f32_16x16x32_bf16 v[216:219], a[48:51], a[100:103], v[216:219]
ds_read_b64_tr_b16 a[88:89], v13 offset:0
v_mfma_f32_16x16x32_bf16 v[224:227], a[52:55], a[100:103], v[224:227]
ds_read_b64_tr_b16 a[90:91], v13 offset:1024
v_mfma_f32_16x16x32_bf16 v[224:227], a[36:39], a[96:99], v[224:227]
ds_read_b64_tr_b16 a[92:93], v13 offset:8192
v_mfma_f32_16x16x32_bf16 v[232:235], a[40:43], a[96:99], v[232:235]
ds_read_b64_tr_b16 a[94:95], v13 offset:9216
v_mfma_f32_16x16x32_bf16 v[232:235], a[56:59], a[100:103], v[232:235]
v_mfma_f32_16x16x32_bf16 v[240:243], a[60:63], a[100:103], v[240:243]
s_add_u32 m0, s17, 0x10800
v_mfma_f32_16x16x32_bf16 v[240:243], a[44:47], a[96:99], v[240:243]
buffer_load_dwordx4 v6, s[52:55], 0 offen lds
v_mfma_f32_16x16x32_bf16 v[244:247], a[44:47], a[104:107], v[244:247]
ds_read_b64_tr_b16 a[96:97], v12 offset:256
v_mfma_f32_16x16x32_bf16 v[244:247], a[60:63], a[108:111], v[244:247]
ds_read_b64_tr_b16 a[98:99], v12 offset:1280
v_mfma_f32_16x16x32_bf16 v[236:239], a[56:59], a[108:111], v[236:239]
ds_read_b64_tr_b16 a[100:101], v12 offset:8448
v_mfma_f32_16x16x32_bf16 v[236:239], a[40:43], a[104:107], v[236:239]
ds_read_b64_tr_b16 a[102:103], v12 offset:9472
v_mfma_f32_16x16x32_bf16 v[228:231], a[36:39], a[104:107], v[228:231]
v_mfma_f32_16x16x32_bf16 v[228:231], a[52:55], a[108:111], v[228:231]
s_add_u32 m0, s17, 0x10c00
v_mfma_f32_16x16x32_bf16 v[220:223], a[48:51], a[108:111], v[220:223]
buffer_load_dwordx4 v6, s[52:55], s13 offen lds
v_mfma_f32_16x16x32_bf16 v[220:223], a[32:35], a[104:107], v[220:223]
s_waitcnt lgkmcnt(4)
L_S18:
v_mfma_f32_16x16x32_bf16 v[24:27], a[80:83], a[0:3], v[24:27]
ds_read_b64_tr_b16 a[104:105], v13 offset:256
s_waitcnt vmcnt(24)
v_mfma_f32_16x16x32_bf16 v[24:27], a[84:87], a[16:19], v[24:27]
ds_read_b64_tr_b16 a[106:107], v13 offset:1280
L_padA9:
s_cmp_eq_u32 s95, 1
s_cbranch_scc1 L_hopA_ret
v_mfma_f32_16x16x32_bf16 v[32:35], a[84:87], a[20:23], v[32:35]
ds_read_b64_tr_b16 a[108:109], v13 offset:8448
v_mfma_f32_16x16x32_bf16 v[32:35], a[80:83], a[4:7], v[32:35]
ds_read_b64_tr_b16 a[110:111], v13 offset:9472
v_mfma_f32_16x16x32_bf16 v[40:43], a[80:83], a[8:11], v[40:43]
ds_read_b128 a[32:35], v8 offset:32768
s_add_u32 m0, s18, 0x14000
v_mfma_f32_16x16x32_bf16 v[40:43], a[84:87], a[24:27], v[40:43]
buffer_load_dwordx4 v7, s[68:71], 0 offen lds
v_mfma_f32_16x16x32_bf16 v[48:51], a[84:87], a[28:31], v[48:51]
ds_read_b128 a[48:51], v9 offset:32768
v_mfma_f32_16x16x32_bf16 v[48:51], a[80:83], a[12:15], v[48:51]
ds_read_b128 a[36:39], v8 offset:34816
v_mfma_f32_16x16x32_bf16 v[52:55], a[88:91], a[12:15], v[52:55]
ds_read_b64_tr_b16 a[80:81], v12 offset:512
v_mfma_f32_16x16x32_bf16 v[52:55], a[92:95], a[28:31], v[52:55]
ds_read_b64_tr_b16 a[82:83], v12 offset:1536
v_mfma_f32_16x16x32_bf16 v[44:47], a[92:95], a[24:27], v[44:47]
ds_read_b64_tr_b16 a[84:85], v12 offset:8704
v_mfma_f32_16x16x32_bf16 v[44:47], a[88:91], a[8:11], v[44:47]
buffer_load_dwordx4 a[128:131], v16, s[44:47], s100 offen offset:0
v_mfma_f32_16x16x32_bf16 v[36:39], a[88:91], a[4:7], v[36:39]
ds_read_b64_tr_b16 a[86:87], v12 offset:9728
v_mfma_f32_16x16x32_bf16 v[36:39], a[92:95], a[20:23], v[36:39]
ds_read_b128 a[52:55], v9 offset:34816
v_mfma_f32_16x16x32_bf16 v[28:31], a[92:95], a[16:19], v[28:31]
ds_read_b128 a[40:43], v8 offset:36864
v_mfma_f32_16x16x32_bf16 v[28:31], a[88:91], a[0:3], v[28:31]
ds_read_b128 a[56:59], v9 offset:36864
s_waitcnt lgkmcnt(10)
v_mfma_f32_16x16x32_bf16 v[56:59], a[96:99], a[0:3], v[56:59]
ds_read_b64_tr_b16 a[88:89], v13 offset:512
v_mfma_f32_16x16x32_bf16 v[56:59], a[100:103], a[16:19], v[56:59]
ds_read_b64_tr_b16 a[90:91], v13 offset:1536
s_add_u32 m0, s18, 0x15000
v_mfma_f32_16x16x32_bf16 v[64:67], a[100:103], a[20:23], v[64:67]
buffer_load_dwordx4 v7, s[68:71], s25 offen lds
v_mfma_f32_16x16x32_bf16 v[64:67], a[96:99], a[4:7], v[64:67]
ds_read_b64_tr_b16 a[92:93], v13 offset:8704
v_mfma_f32_16x16x32_bf16 v[72:75], a[96:99], a[8:11], v[72:75]
ds_read_b64_tr_b16 a[94:95], v13 offset:9728
v_mfma_f32_16x16x32_bf16 v[72:75], a[100:103], a[24:27], v[72:75]
ds_read_b128 a[44:47], v8 offset:38912
v_mfma_f32_16x16x32_bf16 v[80:83], a[100:103], a[28:31], v[80:83]
ds_read_b128 a[60:63], v9 offset:38912
v_mfma_f32_16x16x32_bf16 v[80:83], a[96:99], a[12:15], v[80:83]
v_mfma_f32_16x16x32_bf16 v[84:87], a[104:107], a[12:15], v[84:87]
ds_read_b64_tr_b16 a[96:97], v12 offset:768
s_add_u32 m0, s18, 0x16000
v_mfma_f32_16x16x32_bf16 v[84:87], a[108:111], a[28:31], v[84:87]
buffer_load_dwordx4 v7, s[68:71], s26 offen lds
v_mfma_f32_16x16x32_bf16 v[76:79], a[108:111], a[24:27], v[76:79]
ds_read_b64_tr_b16 a[98:99], v12 offset:1792
v_lshl_add_u32 v5, s42, 19, v5
v_mfma_f32_16x16x32_bf16 v[76:79], a[104:107], a[8:11], v[76:79]
ds_read_b64_tr_b16 a[100:101], v12 offset:8960
v_lshl_add_u32 v6, s42, 19, v6
v_mfma_f32_16x16x32_bf16 v[68:71], a[104:107], a[4:7], v[68:71]
ds_read_b64_tr_b16 a[102:103], v12 offset:9984
v_lshl_add_u32 v7, s42, 18, v7
v_mfma_f32_16x16x32_bf16 v[68:71], a[108:111], a[20:23], v[68:71]
v_lshl_add_u32 v7, s42, 17, v7
v_mfma_f32_16x16x32_bf16 v[60:63], a[108:111], a[16:19], v[60:63]
v_mfma_f32_16x16x32_bf16 v[60:63], a[104:107], a[0:3], v[60:63]
s_add_u32 m0, s16, 0x8000
s_waitcnt lgkmcnt(4)
s_waitcnt lgkmcnt(6)
v_mfma_f32_16x16x32_bf16 v[88:91], a[80:83], a[0:3], v[88:91]
buffer_load_dwordx4 v22, s[44:47], s20 offen lds
v_mfma_f32_16x16x32_bf16 v[88:91], a[84:87], a[16:19], v[88:91]
ds_read_b64_tr_b16 a[104:105], v13 offset:768
v_mfma_f32_16x16x32_bf16 v[96:99], a[84:87], a[20:23], v[96:99]
ds_read_b64_tr_b16 a[106:107], v13 offset:1792
v_mfma_f32_16x16x32_bf16 v[96:99], a[80:83], a[4:7], v[96:99]
ds_read_b64_tr_b16 a[108:109], v13 offset:8960
v_mfma_f32_16x16x32_bf16 v[104:107], a[80:83], a[8:11], v[104:107]
ds_read_b64_tr_b16 a[110:111], v13 offset:9984
s_add_u32 m0, s16, 0x8400
v_mfma_f32_16x16x32_bf16 v[104:107], a[84:87], a[24:27], v[104:107]
buffer_load_dwordx4 v23, s[44:47], s20 offen lds
v_mfma_f32_16x16x32_bf16 v[112:115], a[84:87], a[28:31], v[112:115]
v_mfma_f32_16x16x32_bf16 v[112:115], a[80:83], a[12:15], v[112:115]
v_mfma_f32_16x16x32_bf16 v[116:119], a[88:91], a[12:15], v[116:119]
ds_read_b64_tr_b16 a[80:81], v14 offset:0
v_mfma_f32_16x16x32_bf16 v[116:119], a[92:95], a[28:31], v[116:119]
ds_read_b64_tr_b16 a[82:83], v14 offset:256
v_mfma_f32_16x16x32_bf16 v[108:111], a[92:95], a[24:27], v[108:111]
ds_read_b64_tr_b16 a[84:85], v14 offset:2048
s_add_u32 m0, s16, 0x8800
v_mfma_f32_16x16x32_bf16 v[108:111], a[88:91], a[8:11], v[108:111]
buffer_load_dwordx4 v22, s[44:47], s21 offen lds
v_mfma_f32_16x16x32_bf16 v[100:103], a[88:91], a[4:7], v[100:103]
ds_read_b64_tr_b16 a[86:87], v14 offset:2304
v_mfma_f32_16x16x32_bf16 v[100:103], a[92:95], a[20:23], v[100:103]
v_mfma_f32_16x16x32_bf16 v[92:95], a[92:95], a[16:19], v[92:95]
v_mfma_f32_16x16x32_bf16 v[92:95], a[88:91], a[0:3], v[92:95]
s_waitcnt lgkmcnt(4)
v_mfma_f32_16x16x32_bf16 v[120:123], a[96:99], a[0:3], v[120:123]
buffer_load_dwordx4 a[132:135], v16, s[44:47], s100 offen offset:1024
v_mfma_f32_16x16x32_bf16 v[120:123], a[100:103], a[16:19], v[120:123]
ds_read_b64_tr_b16 a[88:89], v15 offset:0
v_mfma_f32_16x16x32_bf16 v[128:131], a[100:103], a[20:23], v[128:131]
ds_read_b64_tr_b16 a[90:91], v15 offset:256
v_mfma_f32_16x16x32_bf16 v[128:131], a[96:99], a[4:7], v[128:131]
ds_read_b64_tr_b16 a[92:93], v15 offset:2048
v_mfma_f32_16x16x32_bf16 v[136:139], a[96:99], a[8:11], v[136:139]
ds_read_b64_tr_b16 a[94:95], v15 offset:2304
v_mfma_f32_16x16x32_bf16 v[136:139], a[100:103], a[24:27], v[136:139]
s_add_u32 m0, s16, 0x8c00
v_mfma_f32_16x16x32_bf16 v[144:147], a[100:103], a[28:31], v[144:147]
buffer_load_dwordx4 v23, s[44:47], s21 offen lds
v_mfma_f32_16x16x32_bf16 v[144:147], a[96:99], a[12:15], v[144:147]
v_mfma_f32_16x16x32_bf16 v[148:151], a[104:107], a[12:15], v[148:151]
ds_read_b64_tr_b16 a[96:97], v14 offset:4096
v_mfma_f32_16x16x32_bf16 v[148:151], a[108:111], a[28:31], v[148:151]
ds_read_b64_tr_b16 a[98:99], v14 offset:4352
v_mfma_f32_16x16x32_bf16 v[140:143], a[108:111], a[24:27], v[140:143]
ds_read_b64_tr_b16 a[100:101], v14 offset:6144
v_mfma_f32_16x16x32_bf16 v[140:143], a[104:107], a[8:11], v[140:143]
ds_read_b64_tr_b16 a[102:103], v14 offset:6400
s_add_u32 m0, s16, 0x9000
v_mfma_f32_16x16x32_bf16 v[132:135], a[104:107], a[4:7], v[132:135]
buffer_load_dwordx4 v22, s[44:47], s22 offen lds
v_mfma_f32_16x16x32_bf16 v[132:135], a[108:111], a[20:23], v[132:135]
v_mfma_f32_16x16x32_bf16 v[124:127], a[108:111], a[16:19], v[124:127]
v_mfma_f32_16x16x32_bf16 v[124:127], a[104:107], a[0:3], v[124:127]
s_waitcnt lgkmcnt(4)
v_mfma_f32_16x16x32_bf16 v[152:155], a[80:83], a[0:3], v[152:155]
ds_read_b64_tr_b16 a[104:105], v15 offset:4096
s_add_u32 m0, s16, 0x9400
v_mfma_f32_16x16x32_bf16 v[152:155], a[84:87], a[16:19], v[152:155]
buffer_load_dwordx4 v23, s[44:47], s22 offen lds
v_mfma_f32_16x16x32_bf16 v[160:163], a[84:87], a[20:23], v[160:163]
ds_read_b64_tr_b16 a[106:107], v15 offset:4352
v_mfma_f32_16x16x32_bf16 v[160:163], a[80:83], a[4:7], v[160:163]
ds_read_b64_tr_b16 a[108:109], v15 offset:6144
v_mfma_f32_16x16x32_bf16 v[168:171], a[80:83], a[8:11], v[168:171]
ds_read_b64_tr_b16 a[110:111], v15 offset:6400
v_mfma_f32_16x16x32_bf16 v[168:171], a[84:87], a[24:27], v[168:171]
v_mfma_f32_16x16x32_bf16 v[176:179], a[84:87], a[28:31], v[176:179]
s_add_u32 m0, s16, 0x9800
v_mfma_f32_16x16x32_bf16 v[176:179], a[80:83], a[12:15], v[176:179]
buffer_load_dwordx4 v22, s[44:47], s23 offen lds
v_mfma_f32_16x16x32_bf16 v[180:183], a[88:91], a[12:15], v[180:183]
ds_read_b64_tr_b16 a[80:81], v14 offset:8192
v_mfma_f32_16x16x32_bf16 v[180:183], a[92:95], a[28:31], v[180:183]
ds_read_b64_tr_b16 a[82:83], v14 offset:8448
v_mfma_f32_16x16x32_bf16 v[172:175], a[92:95], a[24:27], v[172:175]
ds_read_b64_tr_b16 a[84:85], v14 offset:10240
v_mfma_f32_16x16x32_bf16 v[172:175], a[88:91], a[8:11], v[172:175]
ds_read_b64_tr_b16 a[86:87], v14 offset:10496
s_add_u32 m0, s16, 0x9c00
v_mfma_f32_16x16x32_bf16 v[164:167], a[88:91], a[4:7], v[164:167]
buffer_load_dwordx4 v23, s[44:47], s23 offen lds
v_mfma_f32_16x16x32_bf16 v[164:167], a[92:95], a[20:23], v[164:167]
v_lshl_add_u32 v22, s42, 7, v22
v_lshl_add_u32 v23, s42, 7, v23
v_mfma_f32_16x16x32_bf16 v[156:159], a[92:95], a[16:19], v[156:159]
v_mfma_f32_16x16x32_bf16 v[156:159], a[88:91], a[0:3], v[156:159]
s_waitcnt lgkmcnt(4)
v_mfma_f32_16x16x32_bf16 v[184:187], a[96:99], a[0:3], v[184:187]
ds_read_b64_tr_b16 a[88:89], v15 offset:8192
v_mfma_f32_16x16x32_bf16 v[184:187], a[100:103], a[16:19], v[184:187]
ds_read_b64_tr_b16 a[90:91], v15 offset:8448
v_mfma_f32_16x16x32_bf16 v[192:195], a[100:103], a[20:23], v[192:195]
buffer_load_dwordx4 a[136:139], v16, s[44:47], s100 offen offset:2048
v_mfma_f32_16x16x32_bf16 v[192:195], a[96:99], a[4:7], v[192:195]
ds_read_b64_tr_b16 a[92:93], v15 offset:10240
v_mfma_f32_16x16x32_bf16 v[200:203], a[96:99], a[8:11], v[200:203]
ds_read_b64_tr_b16 a[94:95], v15 offset:10496
v_add_u32 v12, 0x8000, v12
v_mfma_f32_16x16x32_bf16 v[200:203], a[100:103], a[24:27], v[200:203]
v_add_u32 v13, 0x8000, v13
v_add_u32 v14, 0x8000, v14
v_mfma_f32_16x16x32_bf16 v[208:211], a[100:103], a[28:31], v[208:211]
v_add_u32 v15, 0x8000, v15
v_mfma_f32_16x16x32_bf16 v[208:211], a[96:99], a[12:15], v[208:211]
v_mfma_f32_16x16x32_bf16 v[212:215], a[104:107], a[12:15], v[212:215]
s_waitcnt vmcnt(18) lgkmcnt(0)
v_mfma_f32_16x16x32_bf16 v[212:215], a[108:111], a[28:31], v[212:215]
s_barrier
s_add_u32 m0, s17, 0x0
s_cmp_lg_u32 s4, 0
s_cbranch_scc1 L_sig_kv
v_mov_b32 v20, 1
s_mov_b64 exec, 1
buffer_atomic_add v20, off, s[84:87], s10 sc1
s_mov_b64 exec, -1
L_sig_kv:
v_mfma_f32_16x16x32_bf16 v[204:207], a[108:111], a[24:27], v[204:207]
buffer_load_dwordx4 v5, s[52:55], 0 offen lds
v_mfma_f32_16x16x32_bf16 v[204:207], a[104:107], a[8:11], v[204:207]
ds_read_b64_tr_b16 a[96:97], v12 offset:0
v_mfma_f32_16x16x32_bf16 v[196:199], a[104:107], a[4:7], v[196:199]
ds_read_b64_tr_b16 a[98:99], v12 offset:1024
v_mfma_f32_16x16x32_bf16 v[196:199], a[108:111], a[20:23], v[196:199]
ds_read_b64_tr_b16 a[100:101], v12 offset:8192
v_mfma_f32_16x16x32_bf16 v[188:191], a[108:111], a[16:19], v[188:191]
ds_read_b64_tr_b16 a[102:103], v12 offset:9216
v_mfma_f32_16x16x32_bf16 v[188:191], a[104:107], a[0:3], v[188:191]
s_add_u32 m0, s17, 0x400
s_waitcnt lgkmcnt(4)
v_mfma_f32_16x16x32_bf16 v[216:219], a[0:3], a[80:83], v[216:219]
buffer_load_dwordx4 v5, s[52:55], s13 offen lds
v_mfma_f32_16x16x32_bf16 v[216:219], a[16:19], a[84:87], v[216:219]
ds_read_b64_tr_b16 a[104:105], v13 offset:0
v_mfma_f32_16x16x32_bf16 v[224:227], a[20:23], a[84:87], v[224:227]
ds_read_b64_tr_b16 a[106:107], v13 offset:1024
v_mfma_f32_16x16x32_bf16 v[224:227], a[4:7], a[80:83], v[224:227]
ds_read_b64_tr_b16 a[108:109], v13 offset:8192
v_mfma_f32_16x16x32_bf16 v[232:235], a[8:11], a[80:83], v[232:235]
ds_read_b64_tr_b16 a[110:111], v13 offset:9216
v_mfma_f32_16x16x32_bf16 v[232:235], a[24:27], a[84:87], v[232:235]
v_mfma_f32_16x16x32_bf16 v[240:243], a[28:31], a[84:87], v[240:243]
s_add_u32 m0, s17, 0x800
v_mfma_f32_16x16x32_bf16 v[240:243], a[12:15], a[80:83], v[240:243]
buffer_load_dwordx4 v6, s[52:55], 0 offen lds
v_mfma_f32_16x16x32_bf16 v[244:247], a[12:15], a[88:91], v[244:247]
ds_read_b64_tr_b16 a[80:81], v12 offset:256
v_mfma_f32_16x16x32_bf16 v[244:247], a[28:31], a[92:95], v[244:247]
ds_read_b64_tr_b16 a[82:83], v12 offset:1280
v_mfma_f32_16x16x32_bf16 v[236:239], a[24:27], a[92:95], v[236:239]
ds_read_b64_tr_b16 a[84:85], v12 offset:8448
v_mfma_f32_16x16x32_bf16 v[236:239], a[8:11], a[88:91], v[236:239]
ds_read_b64_tr_b16 a[86:87], v12 offset:9472
v_mfma_f32_16x16x32_bf16 v[228:231], a[4:7], a[88:91], v[228:231]
v_mfma_f32_16x16x32_bf16 v[228:231], a[20:23], a[92:95], v[228:231]
s_add_u32 m0, s17, 0xc00
v_mfma_f32_16x16x32_bf16 v[220:223], a[16:19], a[92:95], v[220:223]
buffer_load_dwordx4 v6, s[52:55], s13 offen lds
v_mfma_f32_16x16x32_bf16 v[220:223], a[0:3], a[88:91], v[220:223]
s_waitcnt lgkmcnt(4)
L_S19:
v_mfma_f32_16x16x32_bf16 v[24:27], a[96:99], a[32:35], v[24:27]
ds_read_b64_tr_b16 a[88:89], v13 offset:256
s_waitcnt vmcnt(23)
v_mfma_f32_16x16x32_bf16 v[24:27], a[100:103], a[48:51], v[24:27]
ds_read_b64_tr_b16 a[90:91], v13 offset:1280
v_mfma_f32_16x16x32_bf16 v[32:35], a[100:103], a[52:55], v[32:35]
ds_read_b64_tr_b16 a[92:93], v13 offset:8448
v_mfma_f32_16x16x32_bf16 v[32:35], a[96:99], a[36:39], v[32:35]
ds_read_b64_tr_b16 a[94:95], v13 offset:9472
v_mfma_f32_16x16x32_bf16 v[40:43], a[96:99], a[40:43], v[40:43]
ds_read_b128 a[0:3], v8 offset:0
s_add_u32 m0, s18, 0x4000
v_mfma_f32_16x16x32_bf16 v[40:43], a[100:103], a[56:59], v[40:43]
buffer_load_dwordx4 v7, s[68:71], 0 offen lds
v_mfma_f32_16x16x32_bf16 v[48:51], a[100:103], a[60:63], v[48:51]
ds_read_b128 a[16:19], v9 offset:0
v_mfma_f32_16x16x32_bf16 v[48:51], a[96:99], a[44:47], v[48:51]
ds_read_b128 a[4:7], v8 offset:2048
v_mfma_f32_16x16x32_bf16 v[52:55], a[104:107], a[44:47], v[52:55]
ds_read_b64_tr_b16 a[96:97], v12 offset:512
v_mfma_f32_16x16x32_bf16 v[52:55], a[108:111], a[60:63], v[52:55]
ds_read_b64_tr_b16 a[98:99], v12 offset:1536
v_mfma_f32_16x16x32_bf16 v[44:47], a[108:111], a[56:59], v[44:47]
ds_read_b64_tr_b16 a[100:101], v12 offset:8704
v_mfma_f32_16x16x32_bf16 v[44:47], a[104:107], a[40:43], v[44:47]
buffer_load_dwordx4 a[140:143], v16, s[44:47], s100 offen offset:3072
v_mfma_f32_16x16x32_bf16 v[36:39], a[104:107], a[36:39], v[36:39]
ds_read_b64_tr_b16 a[102:103], v12 offset:9728
v_mfma_f32_16x16x32_bf16 v[36:39], a[108:111], a[52:55], v[36:39]
ds_read_b128 a[20:23], v9 offset:2048
v_mfma_f32_16x16x32_bf16 v[28:31], a[108:111], a[48:51], v[28:31]
ds_read_b128 a[8:11], v8 offset:4096
v_mfma_f32_16x16x32_bf16 v[28:31], a[104:107], a[32:35], v[28:31]
ds_read_b128 a[24:27], v9 offset:4096
s_waitcnt lgkmcnt(10)
v_mfma_f32_16x16x32_bf16 v[56:59], a[80:83], a[32:35], v[56:59]
ds_read_b64_tr_b16 a[104:105], v13 offset:512
v_mfma_f32_16x16x32_bf16 v[56:59], a[84:87], a[48:51], v[56:59]
ds_read_b64_tr_b16 a[106:107], v13 offset:1536
s_add_u32 m0, s18, 0x5000
v_mfma_f32_16x16x32_bf16 v[64:67], a[84:87], a[52:55], v[64:67]
buffer_load_dwordx4 v7, s[68:71], s25 offen lds
v_mfma_f32_16x16x32_bf16 v[64:67], a[80:83], a[36:39], v[64:67]
ds_read_b64_tr_b16 a[108:109], v13 offset:8704
v_mfma_f32_16x16x32_bf16 v[72:75], a[80:83], a[40:43], v[72:75]
ds_read_b64_tr_b16 a[110:111], v13 offset:9728
v_mfma_f32_16x16x32_bf16 v[72:75], a[84:87], a[56:59], v[72:75]
ds_read_b128 a[12:15], v8 offset:6144
v_mfma_f32_16x16x32_bf16 v[80:83], a[84:87], a[60:63], v[80:83]
ds_read_b128 a[28:31], v9 offset:6144
v_mfma_f32_16x16x32_bf16 v[80:83], a[80:83], a[44:47], v[80:83]
v_mfma_f32_16x16x32_bf16 v[84:87], a[88:91], a[44:47], v[84:87]
ds_read_b64_tr_b16 a[80:81], v12 offset:768
s_add_u32 m0, s18, 0x6000
v_mfma_f32_16x16x32_bf16 v[84:87], a[92:95], a[60:63], v[84:87]
buffer_load_dwordx4 v7, s[68:71], s26 offen lds
v_mfma_f32_16x16x32_bf16 v[76:79], a[92:95], a[56:59], v[76:79]
ds_read_b64_tr_b16 a[82:83], v12 offset:1792
v_lshl_add_u32 v5, s42, 19, v5
v_mfma_f32_16x16x32_bf16 v[76:79], a[88:91], a[40:43], v[76:79]
ds_read_b64_tr_b16 a[84:85], v12 offset:8960
v_lshl_add_u32 v6, s42, 19, v6
v_mfma_f32_16x16x32_bf16 v[68:71], a[88:91], a[36:39], v[68:71]
ds_read_b64_tr_b16 a[86:87], v12 offset:9984
v_lshl_add_u32 v7, s42, 18, v7
v_mfma_f32_16x16x32_bf16 v[68:71], a[92:95], a[52:55], v[68:71]
v_lshl_add_u32 v7, s42, 17, v7
v_mfma_f32_16x16x32_bf16 v[60:63], a[92:95], a[48:51], v[60:63]
v_mfma_f32_16x16x32_bf16 v[60:63], a[88:91], a[32:35], v[60:63]
s_add_u32 m0, s16, 0x0
s_waitcnt lgkmcnt(4)
s_waitcnt lgkmcnt(6)
v_mfma_f32_16x16x32_bf16 v[88:91], a[96:99], a[32:35], v[88:91]
buffer_load_dwordx4 v22, s[44:47], s20 offen lds
v_mfma_f32_16x16x32_bf16 v[88:91], a[100:103], a[48:51], v[88:91]
ds_read_b64_tr_b16 a[88:89], v13 offset:768
v_mfma_f32_16x16x32_bf16 v[96:99], a[100:103], a[52:55], v[96:99]
ds_read_b64_tr_b16 a[90:91], v13 offset:1792
v_mfma_f32_16x16x32_bf16 v[96:99], a[96:99], a[36:39], v[96:99]
ds_read_b64_tr_b16 a[92:93], v13 offset:8960
v_mfma_f32_16x16x32_bf16 v[104:107], a[96:99], a[40:43], v[104:107]
ds_read_b64_tr_b16 a[94:95], v13 offset:9984
s_add_u32 m0, s16, 0x400
v_mfma_f32_16x16x32_bf16 v[104:107], a[100:103], a[56:59], v[104:107]
buffer_load_dwordx4 v23, s[44:47], s20 offen lds
v_mfma_f32_16x16x32_bf16 v[112:115], a[100:103], a[60:63], v[112:115]
v_mfma_f32_16x16x32_bf16 v[112:115], a[96:99], a[44:47], v[112:115]
v_mfma_f32_16x16x32_bf16 v[116:119], a[104:107], a[44:47], v[116:119]
ds_read_b64_tr_b16 a[96:97], v14 offset:0
v_mfma_f32_16x16x32_bf16 v[116:119], a[108:111], a[60:63], v[116:119]
ds_read_b64_tr_b16 a[98:99], v14 offset:256
v_mfma_f32_16x16x32_bf16 v[108:111], a[108:111], a[56:59], v[108:111]
ds_read_b64_tr_b16 a[100:101], v14 offset:2048
s_add_u32 m0, s16, 0x800
v_mfma_f32_16x16x32_bf16 v[108:111], a[104:107], a[40:43], v[108:111]
buffer_load_dwordx4 v22, s[44:47], s21 offen lds
v_mfma_f32_16x16x32_bf16 v[100:103], a[104:107], a[36:39], v[100:103]
ds_read_b64_tr_b16 a[102:103], v14 offset:2304
v_mfma_f32_16x16x32_bf16 v[100:103], a[108:111], a[52:55], v[100:103]
v_mfma_f32_16x16x32_bf16 v[92:95], a[108:111], a[48:51], v[92:95]
v_mfma_f32_16x16x32_bf16 v[92:95], a[104:107], a[32:35], v[92:95]
s_waitcnt lgkmcnt(4)
v_mfma_f32_16x16x32_bf16 v[120:123], a[80:83], a[32:35], v[120:123]
buffer_load_dwordx4 a[144:147], v16, s[76:79], 0 offen offset:0
v_mfma_f32_16x16x32_bf16 v[120:123], a[84:87], a[48:51], v[120:123]
ds_read_b64_tr_b16 a[104:105], v15 offset:0
v_mfma_f32_16x16x32_bf16 v[128:131], a[84:87], a[52:55], v[128:131]
ds_read_b64_tr_b16 a[106:107], v15 offset:256
v_mfma_f32_16x16x32_bf16 v[128:131], a[80:83], a[36:39], v[128:131]
ds_read_b64_tr_b16 a[108:109], v15 offset:2048
v_mfma_f32_16x16x32_bf16 v[136:139], a[80:83], a[40:43], v[136:139]
ds_read_b64_tr_b16 a[110:111], v15 offset:2304
v_mfma_f32_16x16x32_bf16 v[136:139], a[84:87], a[56:59], v[136:139]
s_add_u32 m0, s16, 0xc00
v_mfma_f32_16x16x32_bf16 v[144:147], a[84:87], a[60:63], v[144:147]
buffer_load_dwordx4 v23, s[44:47], s21 offen lds
v_mfma_f32_16x16x32_bf16 v[144:147], a[80:83], a[44:47], v[144:147]
v_mfma_f32_16x16x32_bf16 v[148:151], a[88:91], a[44:47], v[148:151]
ds_read_b64_tr_b16 a[80:81], v14 offset:4096
v_mfma_f32_16x16x32_bf16 v[148:151], a[92:95], a[60:63], v[148:151]
ds_read_b64_tr_b16 a[82:83], v14 offset:4352
v_mfma_f32_16x16x32_bf16 v[140:143], a[92:95], a[56:59], v[140:143]
ds_read_b64_tr_b16 a[84:85], v14 offset:6144
v_mfma_f32_16x16x32_bf16 v[140:143], a[88:91], a[40:43], v[140:143]
ds_read_b64_tr_b16 a[86:87], v14 offset:6400
s_add_u32 m0, s16, 0x1000
v_mfma_f32_16x16x32_bf16 v[132:135], a[88:91], a[36:39], v[132:135]
buffer_load_dwordx4 v22, s[44:47], s22 offen lds
v_mfma_f32_16x16x32_bf16 v[132:135], a[92:95], a[52:55], v[132:135]
v_mfma_f32_16x16x32_bf16 v[124:127], a[92:95], a[48:51], v[124:127]
v_mfma_f32_16x16x32_bf16 v[124:127], a[88:91], a[32:35], v[124:127]
s_waitcnt lgkmcnt(4)
v_mfma_f32_16x16x32_bf16 v[152:155], a[96:99], a[32:35], v[152:155]
ds_read_b64_tr_b16 a[88:89], v15 offset:4096
s_add_u32 m0, s16, 0x1400
v_mfma_f32_16x16x32_bf16 v[152:155], a[100:103], a[48:51], v[152:155]
buffer_load_dwordx4 v23, s[44:47], s22 offen lds
v_mfma_f32_16x16x32_bf16 v[160:163], a[100:103], a[52:55], v[160:163]
ds_read_b64_tr_b16 a[90:91], v15 offset:4352
v_mfma_f32_16x16x32_bf16 v[160:163], a[96:99], a[36:39], v[160:163]
ds_read_b64_tr_b16 a[92:93], v15 offset:6144
v_mfma_f32_16x16x32_bf16 v[168:171], a[96:99], a[40:43], v[168:171]
ds_read_b64_tr_b16 a[94:95], v15 offset:6400
v_mfma_f32_16x16x32_bf16 v[168:171], a[100:103], a[56:59], v[168:171]
v_mfma_f32_16x16x32_bf16 v[176:179], a[100:103], a[60:63], v[176:179]
s_add_u32 m0, s16, 0x1800
v_mfma_f32_16x16x32_bf16 v[176:179], a[96:99], a[44:47], v[176:179]
buffer_load_dwordx4 v22, s[44:47], s23 offen lds
v_mfma_f32_16x16x32_bf16 v[180:183], a[104:107], a[44:47], v[180:183]
ds_read_b64_tr_b16 a[96:97], v14 offset:8192
v_mfma_f32_16x16x32_bf16 v[180:183], a[108:111], a[60:63], v[180:183]
ds_read_b64_tr_b16 a[98:99], v14 offset:8448
v_mfma_f32_16x16x32_bf16 v[172:175], a[108:111], a[56:59], v[172:175]
ds_read_b64_tr_b16 a[100:101], v14 offset:10240
v_mfma_f32_16x16x32_bf16 v[172:175], a[104:107], a[40:43], v[172:175]
ds_read_b64_tr_b16 a[102:103], v14 offset:10496
s_add_u32 m0, s16, 0x1c00
v_mfma_f32_16x16x32_bf16 v[164:167], a[104:107], a[36:39], v[164:167]
buffer_load_dwordx4 v23, s[44:47], s23 offen lds
v_mfma_f32_16x16x32_bf16 v[164:167], a[108:111], a[52:55], v[164:167]
v_lshl_add_u32 v22, s42, 7, v22
v_lshl_add_u32 v23, s42, 7, v23
v_mfma_f32_16x16x32_bf16 v[156:159], a[108:111], a[48:51], v[156:159]
v_mfma_f32_16x16x32_bf16 v[156:159], a[104:107], a[32:35], v[156:159]
s_waitcnt lgkmcnt(4)
v_mfma_f32_16x16x32_bf16 v[184:187], a[80:83], a[32:35], v[184:187]
ds_read_b64_tr_b16 a[104:105], v15 offset:8192
v_mfma_f32_16x16x32_bf16 v[184:187], a[84:87], a[48:51], v[184:187]
ds_read_b64_tr_b16 a[106:107], v15 offset:8448
v_mfma_f32_16x16x32_bf16 v[192:195], a[84:87], a[52:55], v[192:195]
buffer_load_dwordx4 a[148:151], v16, s[76:79], 0 offen offset:1024
v_mfma_f32_16x16x32_bf16 v[192:195], a[80:83], a[36:39], v[192:195]
ds_read_b64_tr_b16 a[108:109], v15 offset:10240
v_mfma_f32_16x16x32_bf16 v[200:203], a[80:83], a[40:43], v[200:203]
ds_read_b64_tr_b16 a[110:111], v15 offset:10496
v_add_u32 v12, 0x8000, v12
v_mfma_f32_16x16x32_bf16 v[200:203], a[84:87], a[56:59], v[200:203]
v_add_u32 v13, 0x8000, v13
v_add_u32 v14, 0x8000, v14
v_mfma_f32_16x16x32_bf16 v[208:211], a[84:87], a[60:63], v[208:211]
v_add_u32 v15, 0x8000, v15
v_mfma_f32_16x16x32_bf16 v[208:211], a[80:83], a[44:47], v[208:211]
v_mfma_f32_16x16x32_bf16 v[212:215], a[88:91], a[44:47], v[212:215]
s_waitcnt vmcnt(28) lgkmcnt(0)
v_mfma_f32_16x16x32_bf16 v[212:215], a[92:95], a[60:63], v[212:215]
s_barrier
s_add_u32 m0, s17, 0x8000
v_mfma_f32_16x16x32_bf16 v[204:207], a[92:95], a[56:59], v[204:207]
buffer_load_dwordx4 v5, s[52:55], 0 offen lds
v_mfma_f32_16x16x32_bf16 v[204:207], a[88:91], a[40:43], v[204:207]
ds_read_b64_tr_b16 a[80:81], v12 offset:0
v_mfma_f32_16x16x32_bf16 v[196:199], a[88:91], a[36:39], v[196:199]
ds_read_b64_tr_b16 a[82:83], v12 offset:1024
v_mfma_f32_16x16x32_bf16 v[196:199], a[92:95], a[52:55], v[196:199]
ds_read_b64_tr_b16 a[84:85], v12 offset:8192
v_mfma_f32_16x16x32_bf16 v[188:191], a[92:95], a[48:51], v[188:191]
ds_read_b64_tr_b16 a[86:87], v12 offset:9216
v_mfma_f32_16x16x32_bf16 v[188:191], a[88:91], a[32:35], v[188:191]
s_waitcnt lgkmcnt(4)
v_mfma_f32_16x16x32_bf16 v[216:219], a[32:35], a[96:99], v[216:219]
ds_read_b64_tr_b16 a[88:89], v13 offset:0
s_add_u32 m0, s17, 0x8400
v_mfma_f32_16x16x32_bf16 v[216:219], a[48:51], a[100:103], v[216:219]
buffer_load_dwordx4 v5, s[52:55], s13 offen lds
v_mfma_f32_16x16x32_bf16 v[224:227], a[52:55], a[100:103], v[224:227]
ds_read_b64_tr_b16 a[90:91], v13 offset:1024
v_mfma_f32_16x16x32_bf16 v[224:227], a[36:39], a[96:99], v[224:227]
ds_read_b64_tr_b16 a[92:93], v13 offset:8192
v_mfma_f32_16x16x32_bf16 v[232:235], a[40:43], a[96:99], v[232:235]
ds_read_b64_tr_b16 a[94:95], v13 offset:9216
v_mfma_f32_16x16x32_bf16 v[232:235], a[56:59], a[100:103], v[232:235]
v_mfma_f32_16x16x32_bf16 v[240:243], a[60:63], a[100:103], v[240:243]
v_mfma_f32_16x16x32_bf16 v[240:243], a[44:47], a[96:99], v[240:243]
v_mfma_f32_16x16x32_bf16 v[244:247], a[44:47], a[104:107], v[244:247]
ds_read_b64_tr_b16 a[96:97], v12 offset:256
s_add_u32 m0, s17, 0x8800
v_mfma_f32_16x16x32_bf16 v[244:247], a[60:63], a[108:111], v[244:247]
buffer_load_dwordx4 v6, s[52:55], 0 offen lds
v_mfma_f32_16x16x32_bf16 v[236:239], a[56:59], a[108:111], v[236:239]
ds_read_b64_tr_b16 a[98:99], v12 offset:1280
v_mfma_f32_16x16x32_bf16 v[236:239], a[40:43], a[104:107], v[236:239]
ds_read_b64_tr_b16 a[100:101], v12 offset:8448
v_mfma_f32_16x16x32_bf16 v[228:231], a[36:39], a[104:107], v[228:231]
ds_read_b64_tr_b16 a[102:103], v12 offset:9472
v_mfma_f32_16x16x32_bf16 v[228:231], a[52:55], a[108:111], v[228:231]
v_mfma_f32_16x16x32_bf16 v[220:223], a[48:51], a[108:111], v[220:223]
v_mfma_f32_16x16x32_bf16 v[220:223], a[32:35], a[104:107], v[220:223]
s_add_u32 m0, s17, 0x8c00
s_waitcnt lgkmcnt(4)
L_S20:
v_mfma_f32_16x16x32_bf16 v[24:27], a[80:83], a[0:3], v[24:27]
ds_read_b64_tr_b16 a[104:105], v13 offset:256
s_waitcnt vmcnt(22)
v_mfma_f32_16x16x32_bf16 v[24:27], a[84:87], a[16:19], v[24:27]
buffer_load_dwordx4 v6, s[52:55], s13 offen lds
v_mfma_f32_16x16x32_bf16 v[32:35], a[84:87], a[20:23], v[32:35]
ds_read_b64_tr_b16 a[106:107], v13 offset:1280
v_mfma_f32_16x16x32_bf16 v[32:35], a[80:83], a[4:7], v[32:35]
ds_read_b64_tr_b16 a[108:109], v13 offset:8448
v_mfma_f32_16x16x32_bf16 v[40:43], a[80:83], a[8:11], v[40:43]
ds_read_b64_tr_b16 a[110:111], v13 offset:9472
v_mfma_f32_16x16x32_bf16 v[40:43], a[84:87], a[24:27], v[40:43]
ds_read_b128 a[32:35], v8 offset:32768
v_mfma_f32_16x16x32_bf16 v[48:51], a[84:87], a[28:31], v[48:51]
ds_read_b128 a[48:51], v9 offset:32768
v_mfma_f32_16x16x32_bf16 v[48:51], a[80:83], a[12:15], v[48:51]
ds_read_b128 a[36:39], v8 offset:34816
s_add_u32 m0, s18, 0xc000
v_mfma_f32_16x16x32_bf16 v[52:55], a[88:91], a[12:15], v[52:55]
buffer_load_dwordx4 v7, s[68:71], 0 offen lds
v_mfma_f32_16x16x32_bf16 v[52:55], a[92:95], a[28:31], v[52:55]
ds_read_b64_tr_b16 a[80:81], v12 offset:512
v_mfma_f32_16x16x32_bf16 v[44:47], a[92:95], a[24:27], v[44:47]
ds_read_b64_tr_b16 a[82:83], v12 offset:1536
v_mfma_f32_16x16x32_bf16 v[44:47], a[88:91], a[8:11], v[44:47]
ds_read_b64_tr_b16 a[84:85], v12 offset:8704
v_mfma_f32_16x16x32_bf16 v[36:39], a[88:91], a[4:7], v[36:39]
ds_read_b64_tr_b16 a[86:87], v12 offset:9728
v_mfma_f32_16x16x32_bf16 v[36:39], a[92:95], a[20:23], v[36:39]
ds_read_b128 a[52:55], v9 offset:34816
v_mfma_f32_16x16x32_bf16 v[28:31], a[92:95], a[16:19], v[28:31]
ds_read_b128 a[40:43], v8 offset:36864
s_waitcnt lgkmcnt(9)
v_mfma_f32_16x16x32_bf16 v[28:31], a[88:91], a[0:3], v[28:31]
ds_read_b128 a[56:59], v9 offset:36864
s_add_u32 m0, s18, 0xd000
v_mfma_f32_16x16x32_bf16 v[56:59], a[96:99], a[0:3], v[56:59]
buffer_load_dwordx4 v7, s[68:71], s25 offen lds
v_mfma_f32_16x16x32_bf16 v[56:59], a[100:103], a[16:19], v[56:59]
ds_read_b64_tr_b16 a[88:89], v13 offset:512
v_mfma_f32_16x16x32_bf16 v[64:67], a[100:103], a[20:23], v[64:67]
ds_read_b64_tr_b16 a[90:91], v13 offset:1536
v_mfma_f32_16x16x32_bf16 v[64:67], a[96:99], a[4:7], v[64:67]
ds_read_b64_tr_b16 a[92:93], v13 offset:8704
v_mfma_f32_16x16x32_bf16 v[72:75], a[96:99], a[8:11], v[72:75]
ds_read_b64_tr_b16 a[94:95], v13 offset:9728
v_mfma_f32_16x16x32_bf16 v[72:75], a[100:103], a[24:27], v[72:75]
ds_read_b128 a[44:47], v8 offset:38912
v_mfma_f32_16x16x32_bf16 v[80:83], a[100:103], a[28:31], v[80:83]
ds_read_b128 a[60:63], v9 offset:38912
v_mfma_f32_16x16x32_bf16 v[80:83], a[96:99], a[12:15], v[80:83]
s_add_u32 m0, s18, 0xe000
v_mfma_f32_16x16x32_bf16 v[84:87], a[104:107], a[12:15], v[84:87]
buffer_load_dwordx4 v7, s[68:71], s26 offen lds
v_mfma_f32_16x16x32_bf16 v[84:87], a[108:111], a[28:31], v[84:87]
ds_read_b64_tr_b16 a[96:97], v12 offset:768
v_lshl_add_u32 v5, s42, 19, v5
v_mfma_f32_16x16x32_bf16 v[76:79], a[108:111], a[24:27], v[76:79]
ds_read_b64_tr_b16 a[98:99], v12 offset:1792
v_lshl_add_u32 v6, s42, 19, v6
v_mfma_f32_16x16x32_bf16 v[76:79], a[104:107], a[8:11], v[76:79]
ds_read_b64_tr_b16 a[100:101], v12 offset:8960
L_padA10:
s_cmp_eq_u32 s95, 1
s_cbranch_scc1 L_hopA_ret
v_lshl_add_u32 v7, s42, 18, v7
v_mfma_f32_16x16x32_bf16 v[68:71], a[104:107], a[4:7], v[68:71]
ds_read_b64_tr_b16 a[102:103], v12 offset:9984
v_lshl_add_u32 v7, s42, 17, v7
v_mfma_f32_16x16x32_bf16 v[68:71], a[108:111], a[20:23], v[68:71]
s_waitcnt vmcnt(13)
v_accvgpr_read_b32 v18, a144
v_lshlrev_b32 v1, 16, v18
v_mfma_f32_16x16x32_bf16 v[60:63], a[108:111], a[16:19], v[60:63]
v_and_b32 v18, 0xffff0000, v18
v_accvgpr_read_b32 v21, a128
v_mfma_f32_16x16x32_bf16 v[60:63], a[104:107], a[0:3], v[60:63]
s_add_u32 m0, s16, 0x8000
s_waitcnt lgkmcnt(4)
s_waitcnt lgkmcnt(6)
v_mfma_f32_16x16x32_bf16 v[88:91], a[80:83], a[0:3], v[88:91]
buffer_load_dwordx4 v22, s[44:47], s20 offen lds
v_mfma_f32_16x16x32_bf16 v[88:91], a[84:87], a[16:19], v[88:91]
ds_read_b64_tr_b16 a[104:105], v13 offset:768
v_lshlrev_b32 v20, 16, v21
v_mfma_f32_16x16x32_bf16 v[96:99], a[84:87], a[20:23], v[96:99]
ds_read_b64_tr_b16 a[106:107], v13 offset:1792
v_and_b32 v21, 0xffff0000, v21
v_mfma_f32_16x16x32_bf16 v[96:99], a[80:83], a[4:7], v[96:99]
ds_read_b64_tr_b16 a[108:109], v13 offset:8960
v_mul_f32 v2, v1, v20
v_mfma_f32_16x16x32_bf16 v[104:107], a[80:83], a[8:11], v[104:107]
ds_read_b64_tr_b16 a[110:111], v13 offset:9984
v_fmac_f32 v2, v18, v21
v_mfma_f32_16x16x32_bf16 v[104:107], a[84:87], a[24:27], v[104:107]
v_accvgpr_read_b32 v21, a136
v_lshlrev_b32 v20, 16, v21
v_mfma_f32_16x16x32_bf16 v[112:115], a[84:87], a[28:31], v[112:115]
s_add_u32 m0, s16, 0x8400
v_and_b32 v21, 0xffff0000, v21
v_mul_f32 v3, v1, v20
v_mfma_f32_16x16x32_bf16 v[112:115], a[80:83], a[12:15], v[112:115]
buffer_load_dwordx4 v23, s[44:47], s20 offen lds
v_mfma_f32_16x16x32_bf16 v[116:119], a[88:91], a[12:15], v[116:119]
ds_read_b64_tr_b16 a[80:81], v14 offset:0
v_fmac_f32 v3, v18, v21
v_mfma_f32_16x16x32_bf16 v[116:119], a[92:95], a[28:31], v[116:119]
ds_read_b64_tr_b16 a[82:83], v14 offset:256
v_accvgpr_read_b32 v18, a145
v_mfma_f32_16x16x32_bf16 v[108:111], a[92:95], a[24:27], v[108:111]
ds_read_b64_tr_b16 a[84:85], v14 offset:2048
v_lshlrev_b32 v1, 16, v18
v_mfma_f32_16x16x32_bf16 v[108:111], a[88:91], a[8:11], v[108:111]
ds_read_b64_tr_b16 a[86:87], v14 offset:2304
v_and_b32 v18, 0xffff0000, v18
v_mfma_f32_16x16x32_bf16 v[100:103], a[88:91], a[4:7], v[100:103]
v_accvgpr_read_b32 v21, a129
v_lshlrev_b32 v20, 16, v21
v_mfma_f32_16x16x32_bf16 v[100:103], a[92:95], a[20:23], v[100:103]
s_add_u32 m0, s16, 0x8800
v_and_b32 v21, 0xffff0000, v21
v_fmac_f32 v2, v1, v20
v_mfma_f32_16x16x32_bf16 v[92:95], a[92:95], a[16:19], v[92:95]
buffer_load_dwordx4 v22, s[44:47], s21 offen lds
v_mfma_f32_16x16x32_bf16 v[92:95], a[88:91], a[0:3], v[92:95]
s_waitcnt lgkmcnt(4)
v_fmac_f32 v2, v18, v21
v_accvgpr_read_b32 v21, a137
v_mfma_f32_16x16x32_bf16 v[120:123], a[96:99], a[0:3], v[120:123]
ds_read_b64_tr_b16 a[88:89], v15 offset:0
v_lshlrev_b32 v20, 16, v21
v_mfma_f32_16x16x32_bf16 v[120:123], a[100:103], a[16:19], v[120:123]
ds_read_b64_tr_b16 a[90:91], v15 offset:256
v_and_b32 v21, 0xffff0000, v21
v_mfma_f32_16x16x32_bf16 v[128:131], a[100:103], a[20:23], v[128:131]
ds_read_b64_tr_b16 a[92:93], v15 offset:2048
v_fmac_f32 v3, v1, v20
v_mfma_f32_16x16x32_bf16 v[128:131], a[96:99], a[4:7], v[128:131]
ds_read_b64_tr_b16 a[94:95], v15 offset:2304
v_fmac_f32 v3, v18, v21
v_mfma_f32_16x16x32_bf16 v[136:139], a[96:99], a[8:11], v[136:139]
s_add_u32 m0, s16, 0x8c00
v_accvgpr_read_b32 v18, a146
v_lshlrev_b32 v1, 16, v18
v_mfma_f32_16x16x32_bf16 v[136:139], a[100:103], a[24:27], v[136:139]
buffer_load_dwordx4 v23, s[44:47], s21 offen lds
v_mfma_f32_16x16x32_bf16 v[144:147], a[100:103], a[28:31], v[144:147]
v_and_b32 v18, 0xffff0000, v18
v_accvgpr_read_b32 v21, a130
v_mfma_f32_16x16x32_bf16 v[144:147], a[96:99], a[12:15], v[144:147]
v_lshlrev_b32 v20, 16, v21
v_and_b32 v21, 0xffff0000, v21
v_mfma_f32_16x16x32_bf16 v[148:151], a[104:107], a[12:15], v[148:151]
ds_read_b64_tr_b16 a[96:97], v14 offset:4096
v_fmac_f32 v2, v1, v20
v_mfma_f32_16x16x32_bf16 v[148:151], a[108:111], a[28:31], v[148:151]
ds_read_b64_tr_b16 a[98:99], v14 offset:4352
v_fmac_f32 v2, v18, v21
v_mfma_f32_16x16x32_bf16 v[140:143], a[108:111], a[24:27], v[140:143]
ds_read_b64_tr_b16 a[100:101], v14 offset:6144
v_accvgpr_read_b32 v21, a138
v_mfma_f32_16x16x32_bf16 v[140:143], a[104:107], a[8:11], v[140:143]
ds_read_b64_tr_b16 a[102:103], v14 offset:6400
s_add_u32 m0, s16, 0x9000
v_mfma_f32_16x16x32_bf16 v[132:135], a[104:107], a[4:7], v[132:135]
buffer_load_dwordx4 v22, s[44:47], s22 offen lds
v_mfma_f32_16x16x32_bf16 v[132:135], a[108:111], a[20:23], v[132:135]
v_lshlrev_b32 v20, 16, v21
v_and_b32 v21, 0xffff0000, v21
v_mfma_f32_16x16x32_bf16 v[124:127], a[108:111], a[16:19], v[124:127]
v_fmac_f32 v3, v1, v20
v_fmac_f32 v3, v18, v21
v_mfma_f32_16x16x32_bf16 v[124:127], a[104:107], a[0:3], v[124:127]
s_waitcnt lgkmcnt(4)
v_accvgpr_read_b32 v18, a147
v_lshlrev_b32 v1, 16, v18
v_mfma_f32_16x16x32_bf16 v[152:155], a[80:83], a[0:3], v[152:155]
ds_read_b64_tr_b16 a[104:105], v15 offset:4096
v_and_b32 v18, 0xffff0000, v18
v_mfma_f32_16x16x32_bf16 v[152:155], a[84:87], a[16:19], v[152:155]
ds_read_b64_tr_b16 a[106:107], v15 offset:4352
v_accvgpr_read_b32 v21, a131
v_mfma_f32_16x16x32_bf16 v[160:163], a[84:87], a[20:23], v[160:163]
ds_read_b64_tr_b16 a[108:109], v15 offset:6144
s_add_u32 m0, s16, 0x9400
v_mfma_f32_16x16x32_bf16 v[160:163], a[80:83], a[4:7], v[160:163]
buffer_load_dwordx4 v23, s[44:47], s22 offen lds
v_mfma_f32_16x16x32_bf16 v[168:171], a[80:83], a[8:11], v[168:171]
ds_read_b64_tr_b16 a[110:111], v15 offset:6400
v_lshlrev_b32 v20, 16, v21
v_mfma_f32_16x16x32_bf16 v[168:171], a[84:87], a[24:27], v[168:171]
v_and_b32 v21, 0xffff0000, v21
v_fmac_f32 v2, v1, v20
v_mfma_f32_16x16x32_bf16 v[176:179], a[84:87], a[28:31], v[176:179]
v_fmac_f32 v2, v18, v21
v_accvgpr_read_b32 v21, a139
v_mfma_f32_16x16x32_bf16 v[176:179], a[80:83], a[12:15], v[176:179]
v_lshlrev_b32 v20, 16, v21
v_and_b32 v21, 0xffff0000, v21
v_mfma_f32_16x16x32_bf16 v[180:183], a[88:91], a[12:15], v[180:183]
ds_read_b64_tr_b16 a[80:81], v14 offset:8192
v_fmac_f32 v3, v1, v20
v_mfma_f32_16x16x32_bf16 v[180:183], a[92:95], a[28:31], v[180:183]
ds_read_b64_tr_b16 a[82:83], v14 offset:8448
s_add_u32 m0, s16, 0x9800
v_mfma_f32_16x16x32_bf16 v[172:175], a[92:95], a[24:27], v[172:175]
buffer_load_dwordx4 v22, s[44:47], s23 offen lds
v_mfma_f32_16x16x32_bf16 v[172:175], a[88:91], a[8:11], v[172:175]
ds_read_b64_tr_b16 a[84:85], v14 offset:10240
v_fmac_f32 v3, v18, v21
v_mfma_f32_16x16x32_bf16 v[164:167], a[88:91], a[4:7], v[164:167]
ds_read_b64_tr_b16 a[86:87], v14 offset:10496
s_waitcnt vmcnt(14)
v_accvgpr_read_b32 v18, a148
v_mfma_f32_16x16x32_bf16 v[164:167], a[92:95], a[20:23], v[164:167]
v_lshlrev_b32 v1, 16, v18
v_and_b32 v18, 0xffff0000, v18
v_mfma_f32_16x16x32_bf16 v[156:159], a[92:95], a[16:19], v[156:159]
v_accvgpr_read_b32 v21, a132
v_lshlrev_b32 v20, 16, v21
v_mfma_f32_16x16x32_bf16 v[156:159], a[88:91], a[0:3], v[156:159]
s_waitcnt lgkmcnt(4)
v_and_b32 v21, 0xffff0000, v21
v_fmac_f32 v2, v1, v20
v_mfma_f32_16x16x32_bf16 v[184:187], a[96:99], a[0:3], v[184:187]
ds_read_b64_tr_b16 a[88:89], v15 offset:8192
s_add_u32 m0, s16, 0x9c00
v_mfma_f32_16x16x32_bf16 v[184:187], a[100:103], a[16:19], v[184:187]
buffer_load_dwordx4 v23, s[44:47], s23 offen lds
v_mfma_f32_16x16x32_bf16 v[192:195], a[100:103], a[20:23], v[192:195]
ds_read_b64_tr_b16 a[90:91], v15 offset:8448
v_fmac_f32 v2, v18, v21
v_mfma_f32_16x16x32_bf16 v[192:195], a[96:99], a[4:7], v[192:195]
ds_read_b64_tr_b16 a[92:93], v15 offset:10240
v_accvgpr_read_b32 v21, a140
v_mfma_f32_16x16x32_bf16 v[200:203], a[96:99], a[8:11], v[200:203]
ds_read_b64_tr_b16 a[94:95], v15 offset:10496
v_add_u32 v12, 0xffff0000, v12
v_mfma_f32_16x16x32_bf16 v[200:203], a[100:103], a[24:27], v[200:203]
v_add_u32 v13, 0xffff0000, v13
v_add_u32 v14, 0xffff0000, v14
v_mfma_f32_16x16x32_bf16 v[208:211], a[100:103], a[28:31], v[208:211]
v_add_u32 v15, 0xffff0000, v15
v_lshlrev_b32 v20, 16, v21
v_mfma_f32_16x16x32_bf16 v[208:211], a[96:99], a[12:15], v[208:211]
v_and_b32 v21, 0xffff0000, v21
v_fmac_f32 v3, v1, v20
v_mfma_f32_16x16x32_bf16 v[212:215], a[104:107], a[12:15], v[212:215]
s_waitcnt vmcnt(25) lgkmcnt(0)
v_fmac_f32 v3, v18, v21
v_accvgpr_read_b32 v18, a149
v_mfma_f32_16x16x32_bf16 v[212:215], a[108:111], a[28:31], v[212:215]
s_barrier
s_add_u32 m0, s17, 0x10000
v_lshlrev_b32 v1, 16, v18
v_mfma_f32_16x16x32_bf16 v[204:207], a[108:111], a[24:27], v[204:207]
buffer_load_dwordx4 v5, s[52:55], 0 offen lds
v_mfma_f32_16x16x32_bf16 v[204:207], a[104:107], a[8:11], v[204:207]
ds_read_b64_tr_b16 a[96:97], v12 offset:0
v_and_b32 v18, 0xffff0000, v18
v_mfma_f32_16x16x32_bf16 v[196:199], a[104:107], a[4:7], v[196:199]
ds_read_b64_tr_b16 a[98:99], v12 offset:1024
v_accvgpr_read_b32 v21, a133
v_mfma_f32_16x16x32_bf16 v[196:199], a[108:111], a[20:23], v[196:199]
ds_read_b64_tr_b16 a[100:101], v12 offset:8192
v_lshlrev_b32 v20, 16, v21
v_mfma_f32_16x16x32_bf16 v[188:191], a[108:111], a[16:19], v[188:191]
ds_read_b64_tr_b16 a[102:103], v12 offset:9216
v_and_b32 v21, 0xffff0000, v21
v_mfma_f32_16x16x32_bf16 v[188:191], a[104:107], a[0:3], v[188:191]
s_waitcnt lgkmcnt(4)
v_fmac_f32 v2, v1, v20
v_fmac_f32 v2, v18, v21
v_mfma_f32_16x16x32_bf16 v[216:219], a[0:3], a[80:83], v[216:219]
ds_read_b64_tr_b16 a[104:105], v13 offset:0
v_accvgpr_read_b32 v21, a141
v_mfma_f32_16x16x32_bf16 v[216:219], a[16:19], a[84:87], v[216:219]
ds_read_b64_tr_b16 a[106:107], v13 offset:1024
s_add_u32 m0, s17, 0x10400
v_mfma_f32_16x16x32_bf16 v[224:227], a[20:23], a[84:87], v[224:227]
buffer_load_dwordx4 v5, s[52:55], s13 offen lds
v_mfma_f32_16x16x32_bf16 v[224:227], a[4:7], a[80:83], v[224:227]
ds_read_b64_tr_b16 a[108:109], v13 offset:8192
v_lshlrev_b32 v20, 16, v21
v_mfma_f32_16x16x32_bf16 v[232:235], a[8:11], a[80:83], v[232:235]
ds_read_b64_tr_b16 a[110:111], v13 offset:9216
v_and_b32 v21, 0xffff0000, v21
v_mfma_f32_16x16x32_bf16 v[232:235], a[24:27], a[84:87], v[232:235]
v_fmac_f32 v3, v1, v20
v_fmac_f32 v3, v18, v21
v_mfma_f32_16x16x32_bf16 v[240:243], a[28:31], a[84:87], v[240:243]
v_accvgpr_read_b32 v18, a150
v_lshlrev_b32 v1, 16, v18
v_mfma_f32_16x16x32_bf16 v[240:243], a[12:15], a[80:83], v[240:243]
v_and_b32 v18, 0xffff0000, v18
v_accvgpr_read_b32 v21, a134
v_mfma_f32_16x16x32_bf16 v[244:247], a[12:15], a[88:91], v[244:247]
ds_read_b64_tr_b16 a[80:81], v12 offset:256
v_lshlrev_b32 v20, 16, v21
v_mfma_f32_16x16x32_bf16 v[244:247], a[28:31], a[92:95], v[244:247]
ds_read_b64_tr_b16 a[82:83], v12 offset:1280
v_and_b32 v21, 0xffff0000, v21
v_mfma_f32_16x16x32_bf16 v[236:239], a[24:27], a[92:95], v[236:239]
ds_read_b64_tr_b16 a[84:85], v12 offset:8448
s_add_u32 m0, s17, 0x10800
v_mfma_f32_16x16x32_bf16 v[236:239], a[8:11], a[88:91], v[236:239]
buffer_load_dwordx4 v6, s[52:55], 0 offen lds
v_mfma_f32_16x16x32_bf16 v[228:231], a[4:7], a[88:91], v[228:231]
ds_read_b64_tr_b16 a[86:87], v12 offset:9472
v_fmac_f32 v2, v1, v20
v_mfma_f32_16x16x32_bf16 v[228:231], a[20:23], a[92:95], v[228:231]
v_fmac_f32 v2, v18, v21
v_accvgpr_read_b32 v21, a142
v_mfma_f32_16x16x32_bf16 v[220:223], a[16:19], a[92:95], v[220:223]
v_lshlrev_b32 v20, 16, v21
v_and_b32 v21, 0xffff0000, v21
v_mfma_f32_16x16x32_bf16 v[220:223], a[0:3], a[88:91], v[220:223]
s_waitcnt lgkmcnt(4)
v_fmac_f32 v3, v1, v20
v_fmac_f32 v3, v18, v21
L_S21:
v_mfma_f32_16x16x32_bf16 v[24:27], a[96:99], a[32:35], v[24:27]
ds_read_b64_tr_b16 a[88:89], v13 offset:256
s_waitcnt vmcnt(19)
v_mfma_f32_16x16x32_bf16 v[24:27], a[100:103], a[48:51], v[24:27]
ds_read_b64_tr_b16 a[90:91], v13 offset:1280
v_accvgpr_read_b32 v18, a151
v_mfma_f32_16x16x32_bf16 v[32:35], a[100:103], a[52:55], v[32:35]
ds_read_b64_tr_b16 a[92:93], v13 offset:8448
s_add_u32 m0, s17, 0x10c00
v_mfma_f32_16x16x32_bf16 v[32:35], a[96:99], a[36:39], v[32:35]
buffer_load_dwordx4 v6, s[52:55], s13 offen lds
v_mfma_f32_16x16x32_bf16 v[40:43], a[96:99], a[40:43], v[40:43]
ds_read_b64_tr_b16 a[94:95], v13 offset:9472
v_lshlrev_b32 v1, 16, v18
v_mfma_f32_16x16x32_bf16 v[40:43], a[100:103], a[56:59], v[40:43]
ds_read_b128 a[0:3], v8 offset:0
v_and_b32 v18, 0xffff0000, v18
v_mfma_f32_16x16x32_bf16 v[48:51], a[100:103], a[60:63], v[48:51]
ds_read_b128 a[16:19], v9 offset:0
v_accvgpr_read_b32 v21, a135
v_mfma_f32_16x16x32_bf16 v[48:51], a[96:99], a[44:47], v[48:51]
ds_read_b128 a[4:7], v8 offset:2048
v_lshlrev_b32 v20, 16, v21
v_mfma_f32_16x16x32_bf16 v[52:55], a[104:107], a[44:47], v[52:55]
ds_read_b64_tr_b16 a[96:97], v12 offset:512
v_and_b32 v21, 0xffff0000, v21
v_mfma_f32_16x16x32_bf16 v[52:55], a[108:111], a[60:63], v[52:55]
ds_read_b64_tr_b16 a[98:99], v12 offset:1536
v_fmac_f32 v2, v1, v20
v_mfma_f32_16x16x32_bf16 v[44:47], a[108:111], a[56:59], v[44:47]
ds_read_b64_tr_b16 a[100:101], v12 offset:8704
v_fmac_f32 v2, v18, v21
v_mfma_f32_16x16x32_bf16 v[44:47], a[104:107], a[40:43], v[44:47]
ds_read_b64_tr_b16 a[102:103], v12 offset:9728
s_add_u32 m0, s18, 0x14000
v_mfma_f32_16x16x32_bf16 v[36:39], a[104:107], a[36:39], v[36:39]
buffer_load_dwordx4 v7, s[68:71], 0 offen lds
v_mfma_f32_16x16x32_bf16 v[36:39], a[108:111], a[52:55], v[36:39]
ds_read_b128 a[20:23], v9 offset:2048
v_accvgpr_read_b32 v21, a143
v_mfma_f32_16x16x32_bf16 v[28:31], a[108:111], a[48:51], v[28:31]
ds_read_b128 a[8:11], v8 offset:4096
v_lshlrev_b32 v20, 16, v21
v_mfma_f32_16x16x32_bf16 v[28:31], a[104:107], a[32:35], v[28:31]
ds_read_b128 a[24:27], v9 offset:4096
s_waitcnt lgkmcnt(10)
v_mfma_f32_16x16x32_bf16 v[56:59], a[80:83], a[32:35], v[56:59]
ds_read_b64_tr_b16 a[104:105], v13 offset:512
v_and_b32 v21, 0xffff0000, v21
v_mfma_f32_16x16x32_bf16 v[56:59], a[84:87], a[48:51], v[56:59]
ds_read_b64_tr_b16 a[106:107], v13 offset:1536
v_fmac_f32 v3, v1, v20
v_mfma_f32_16x16x32_bf16 v[64:67], a[84:87], a[52:55], v[64:67]
ds_read_b64_tr_b16 a[108:109], v13 offset:8704
v_fmac_f32 v3, v18, v21
v_mfma_f32_16x16x32_bf16 v[64:67], a[80:83], a[36:39], v[64:67]
ds_read_b64_tr_b16 a[110:111], v13 offset:9728
s_add_u32 m0, s18, 0x15000
v_mfma_f32_16x16x32_bf16 v[72:75], a[80:83], a[40:43], v[72:75]
buffer_load_dwordx4 v7, s[68:71], s25 offen lds
v_mfma_f32_16x16x32_bf16 v[72:75], a[84:87], a[56:59], v[72:75]
ds_read_b128 a[12:15], v8 offset:6144
v_add_f32_dpp v2, v2, v2 row_ror:8 row_mask:0xf bank_mask:0xf
v_mfma_f32_16x16x32_bf16 v[80:83], a[84:87], a[60:63], v[80:83]
ds_read_b128 a[28:31], v9 offset:6144
v_add_f32_dpp v3, v3, v3 row_ror:8 row_mask:0xf bank_mask:0xf
v_mfma_f32_16x16x32_bf16 v[80:83], a[80:83], a[44:47], v[80:83]
v_add_f32_dpp v2, v2, v2 row_ror:4 row_mask:0xf bank_mask:0xf
v_add_f32_dpp v3, v3, v3 row_ror:4 row_mask:0xf bank_mask:0xf
v_mfma_f32_16x16x32_bf16 v[84:87], a[88:91], a[44:47], v[84:87]
ds_read_b64_tr_b16 a[80:81], v12 offset:768
v_add_f32_dpp v2, v2, v2 row_ror:2 row_mask:0xf bank_mask:0xf
v_mfma_f32_16x16x32_bf16 v[84:87], a[92:95], a[60:63], v[84:87]
ds_read_b64_tr_b16 a[82:83], v12 offset:1792
v_add_f32_dpp v3, v3, v3 row_ror:2 row_mask:0xf bank_mask:0xf
v_mfma_f32_16x16x32_bf16 v[76:79], a[92:95], a[56:59], v[76:79]
ds_read_b64_tr_b16 a[84:85], v12 offset:8960
v_add_f32_dpp v2, v2, v2 row_ror:1 row_mask:0xf bank_mask:0xf
v_mfma_f32_16x16x32_bf16 v[76:79], a[88:91], a[40:43], v[76:79]
ds_read_b64_tr_b16 a[86:87], v12 offset:9984
v_add_f32_dpp v3, v3, v3 row_ror:1 row_mask:0xf bank_mask:0xf
v_mfma_f32_16x16x32_bf16 v[68:71], a[88:91], a[36:39], v[68:71]
s_add_u32 m0, s18, 0x16000
v_mov_b32 v1, v2
v_mov_b32 v18, v3
v_mfma_f32_16x16x32_bf16 v[68:71], a[92:95], a[52:55], v[68:71]
buffer_load_dwordx4 v7, s[68:71], s26 offen lds
v_mfma_f32_16x16x32_bf16 v[60:63], a[92:95], a[48:51], v[60:63]
v_permlane16_swap_b32 v1, v2
v_permlane16_swap_b32 v18, v3
v_mfma_f32_16x16x32_bf16 v[60:63], a[88:91], a[32:35], v[60:63]
s_waitcnt lgkmcnt(6)
v_add_f32 v2, v2, v1
v_add_f32 v3, v3, v18
v_mfma_f32_16x16x32_bf16 v[88:91], a[96:99], a[32:35], v[88:91]
ds_read_b64_tr_b16 a[88:89], v13 offset:768
v_mov_b32 v1, v2
v_mfma_f32_16x16x32_bf16 v[88:91], a[100:103], a[48:51], v[88:91]
ds_read_b64_tr_b16 a[90:91], v13 offset:1792
v_mov_b32 v18, v3
v_mfma_f32_16x16x32_bf16 v[96:99], a[100:103], a[52:55], v[96:99]
ds_read_b64_tr_b16 a[92:93], v13 offset:8960
v_permlane32_swap_b32 v1, v2
v_mfma_f32_16x16x32_bf16 v[96:99], a[96:99], a[36:39], v[96:99]
ds_read_b64_tr_b16 a[94:95], v13 offset:9984
v_permlane32_swap_b32 v18, v3
v_mfma_f32_16x16x32_bf16 v[104:107], a[96:99], a[40:43], v[104:107]
v_add_f32 v2, v2, v1
v_add_f32 v3, v3, v18
v_mfma_f32_16x16x32_bf16 v[104:107], a[100:103], a[56:59], v[104:107]
buffer_load_dword v23, off, s[84:87], s10 sc1
v_mfma_f32_16x16x32_bf16 v[112:115], a[100:103], a[60:63], v[112:115]
v_mul_f32 v2, 0xbfb8aa3b, v2
v_mul_f32 v3, 0xbfb8aa3b, v3
v_mfma_f32_16x16x32_bf16 v[112:115], a[96:99], a[44:47], v[112:115]
v_exp_f32 v2, v2
v_mfma_f32_16x16x32_bf16 v[116:119], a[104:107], a[44:47], v[116:119]
ds_read_b64_tr_b16 a[96:97], v14 offset:0
v_mfma_f32_16x16x32_bf16 v[116:119], a[108:111], a[60:63], v[116:119]
ds_read_b64_tr_b16 a[98:99], v14 offset:256
v_mfma_f32_16x16x32_bf16 v[108:111], a[108:111], a[56:59], v[108:111]
ds_read_b64_tr_b16 a[100:101], v14 offset:2048
v_mfma_f32_16x16x32_bf16 v[108:111], a[104:107], a[40:43], v[108:111]
ds_read_b64_tr_b16 a[102:103], v14 offset:2304
v_mfma_f32_16x16x32_bf16 v[100:103], a[104:107], a[36:39], v[100:103]
v_exp_f32 v3, v3
v_mfma_f32_16x16x32_bf16 v[100:103], a[108:111], a[52:55], v[100:103]
v_add_f32 v2, 1.0, v2
v_add_f32 v3, 1.0, v3
v_mfma_f32_16x16x32_bf16 v[92:95], a[108:111], a[48:51], v[92:95]
v_rcp_f32 v2, v2
v_mfma_f32_16x16x32_bf16 v[92:95], a[104:107], a[32:35], v[92:95]
s_waitcnt lgkmcnt(4)
v_rcp_f32 v3, v3
v_mfma_f32_16x16x32_bf16 v[120:123], a[80:83], a[32:35], v[120:123]
ds_read_b64_tr_b16 a[104:105], v15 offset:0
v_mfma_f32_16x16x32_bf16 v[120:123], a[84:87], a[48:51], v[120:123]
ds_read_b64_tr_b16 a[106:107], v15 offset:256
v_mfma_f32_16x16x32_bf16 v[128:131], a[84:87], a[52:55], v[128:131]
ds_read_b64_tr_b16 a[108:109], v15 offset:2048
v_mfma_f32_16x16x32_bf16 v[128:131], a[80:83], a[36:39], v[128:131]
ds_read_b64_tr_b16 a[110:111], v15 offset:2304
v_mfma_f32_16x16x32_bf16 v[136:139], a[80:83], a[40:43], v[136:139]
buffer_store_dwordx2 v[2:3], off, s[88:91], s101 sc1
v_mfma_f32_16x16x32_bf16 v[136:139], a[84:87], a[56:59], v[136:139]
v_mfma_f32_16x16x32_bf16 v[144:147], a[84:87], a[60:63], v[144:147]
v_mfma_f32_16x16x32_bf16 v[144:147], a[80:83], a[44:47], v[144:147]
v_mfma_f32_16x16x32_bf16 v[148:151], a[88:91], a[44:47], v[148:151]
ds_read_b64_tr_b16 a[80:81], v14 offset:4096
v_mfma_f32_16x16x32_bf16 v[148:151], a[92:95], a[60:63], v[148:151]
ds_read_b64_tr_b16 a[82:83], v14 offset:4352
v_mfma_f32_16x16x32_bf16 v[140:143], a[92:95], a[56:59], v[140:143]
ds_read_b64_tr_b16 a[84:85], v14 offset:6144
v_mfma_f32_16x16x32_bf16 v[140:143], a[88:91], a[40:43], v[140:143]
ds_read_b64_tr_b16 a[86:87], v14 offset:6400
v_mfma_f32_16x16x32_bf16 v[132:135], a[88:91], a[36:39], v[132:135]
v_mfma_f32_16x16x32_bf16 v[132:135], a[92:95], a[52:55], v[132:135]
v_mfma_f32_16x16x32_bf16 v[124:127], a[92:95], a[48:51], v[124:127]
v_mfma_f32_16x16x32_bf16 v[124:127], a[88:91], a[32:35], v[124:127]
s_waitcnt lgkmcnt(4)
v_mfma_f32_16x16x32_bf16 v[152:155], a[96:99], a[32:35], v[152:155]
ds_read_b64_tr_b16 a[88:89], v15 offset:4096
v_mfma_f32_16x16x32_bf16 v[152:155], a[100:103], a[48:51], v[152:155]
ds_read_b64_tr_b16 a[90:91], v15 offset:4352
v_mfma_f32_16x16x32_bf16 v[160:163], a[100:103], a[52:55], v[160:163]
ds_read_b64_tr_b16 a[92:93], v15 offset:6144
v_mfma_f32_16x16x32_bf16 v[160:163], a[96:99], a[36:39], v[160:163]
ds_read_b64_tr_b16 a[94:95], v15 offset:6400
v_mfma_f32_16x16x32_bf16 v[168:171], a[96:99], a[40:43], v[168:171]
v_mfma_f32_16x16x32_bf16 v[168:171], a[100:103], a[56:59], v[168:171]
v_mfma_f32_16x16x32_bf16 v[176:179], a[100:103], a[60:63], v[176:179]
v_mfma_f32_16x16x32_bf16 v[176:179], a[96:99], a[44:47], v[176:179]
v_mfma_f32_16x16x32_bf16 v[180:183], a[104:107], a[44:47], v[180:183]
ds_read_b64_tr_b16 a[96:97], v14 offset:8192
v_mfma_f32_16x16x32_bf16 v[180:183], a[108:111], a[60:63], v[180:183]
ds_read_b64_tr_b16 a[98:99], v14 offset:8448
v_mfma_f32_16x16x32_bf16 v[172:175], a[108:111], a[56:59], v[172:175]
ds_read_b64_tr_b16 a[100:101], v14 offset:10240
v_mfma_f32_16x16x32_bf16 v[172:175], a[104:107], a[40:43], v[172:175]
ds_read_b64_tr_b16 a[102:103], v14 offset:10496
v_mfma_f32_16x16x32_bf16 v[164:167], a[104:107], a[36:39], v[164:167]
v_mfma_f32_16x16x32_bf16 v[164:167], a[108:111], a[52:55], v[164:167]
v_mfma_f32_16x16x32_bf16 v[156:159], a[108:111], a[48:51], v[156:159]
v_mfma_f32_16x16x32_bf16 v[156:159], a[104:107], a[32:35], v[156:159]
s_waitcnt lgkmcnt(4)
v_mfma_f32_16x16x32_bf16 v[184:187], a[80:83], a[32:35], v[184:187]
ds_read_b64_tr_b16 a[104:105], v15 offset:8192
v_mfma_f32_16x16x32_bf16 v[184:187], a[84:87], a[48:51], v[184:187]
ds_read_b64_tr_b16 a[106:107], v15 offset:8448
v_mfma_f32_16x16x32_bf16 v[192:195], a[84:87], a[52:55], v[192:195]
ds_read_b64_tr_b16 a[108:109], v15 offset:10240
v_mfma_f32_16x16x32_bf16 v[192:195], a[80:83], a[36:39], v[192:195]
ds_read_b64_tr_b16 a[110:111], v15 offset:10496
v_add_u32 v12, 0x8000, v12
v_mfma_f32_16x16x32_bf16 v[200:203], a[80:83], a[40:43], v[200:203]
v_add_u32 v13, 0x8000, v13
v_add_u32 v14, 0x8000, v14
v_mfma_f32_16x16x32_bf16 v[200:203], a[84:87], a[56:59], v[200:203]
v_add_u32 v15, 0x8000, v15
v_mfma_f32_16x16x32_bf16 v[208:211], a[84:87], a[60:63], v[208:211]
v_mfma_f32_16x16x32_bf16 v[208:211], a[80:83], a[44:47], v[208:211]
v_mfma_f32_16x16x32_bf16 v[212:215], a[88:91], a[44:47], v[212:215]
s_waitcnt vmcnt(1) lgkmcnt(0)
s_mov_b32 s92, 200000
L_spin_kv:
v_readfirstlane_b32 s93, v23
s_nop 1
s_cmp_ge_u32 s93, 8
s_cbranch_scc1 L_spun_kv
s_sub_u32 s92, s92, 1
s_cbranch_scc1 L_spun_kv
s_sleep 4
buffer_load_dword v23, off, s[84:87], s10 sc1
s_waitcnt vmcnt(0)
s_branch L_spin_kv
L_spun_kv:
v_mfma_f32_16x16x32_bf16 v[212:215], a[92:95], a[60:63], v[212:215]
s_barrier
s_add_u32 m0, s19, 0x0
v_mfma_f32_16x16x32_bf16 v[204:207], a[92:95], a[56:59], v[204:207]
buffer_load_dwordx4 v16, s[48:51], s32 offen offset:0 sc1 lds
v_mfma_f32_16x16x32_bf16 v[204:207], a[88:91], a[40:43], v[204:207]
ds_read_b64_tr_b16 a[80:81], v12 offset:0
v_mov_b32 v3, v16
v_mfma_f32_16x16x32_bf16 v[196:199], a[88:91], a[36:39], v[196:199]
ds_read_b64_tr_b16 a[82:83], v12 offset:1024
v_mov_b32 v22, 0x3f803f80
v_mfma_f32_16x16x32_bf16 v[196:199], a[92:95], a[52:55], v[196:199]
ds_read_b64_tr_b16 a[84:85], v12 offset:8192
s_mov_b32 s33, 0
v_mfma_f32_16x16x32_bf16 v[188:191], a[92:95], a[48:51], v[188:191]
ds_read_b64_tr_b16 a[86:87], v12 offset:9216
v_accvgpr_write_b32 a240, v22
v_mfma_f32_16x16x32_bf16 v[188:191], a[88:91], a[32:35], v[188:191]
s_waitcnt lgkmcnt(4)
v_accvgpr_write_b32 a241, v22
v_accvgpr_write_b32 a242, v22
v_mfma_f32_16x16x32_bf16 v[216:219], a[32:35], a[96:99], v[216:219]
buffer_load_dwordx4 v16, s[48:51], s32 offen offset:1024 sc1 lds
v_accvgpr_write_b32 a243, v22
v_mfma_f32_16x16x32_bf16 v[216:219], a[48:51], a[100:103], v[216:219]
ds_read_b64_tr_b16 a[88:89], v13 offset:0
s_mov_b32 s36, 0x33333333
v_mfma_f32_16x16x32_bf16 v[224:227], a[52:55], a[100:103], v[224:227]
ds_read_b64_tr_b16 a[90:91], v13 offset:1024
s_mov_b32 s37, 0xcccccccc
v_mfma_f32_16x16x32_bf16 v[224:227], a[36:39], a[96:99], v[224:227]
ds_read_b64_tr_b16 a[92:93], v13 offset:8192
v_cndmask_b32 v4, 0, v22, s[36:37]
v_mfma_f32_16x16x32_bf16 v[232:235], a[40:43], a[96:99], v[232:235]
ds_read_b64_tr_b16 a[94:95], v13 offset:9216
v_accvgpr_write_b32 a232, v4
v_accvgpr_write_b32 a233, v4
v_mfma_f32_16x16x32_bf16 v[232:235], a[56:59], a[100:103], v[232:235]
v_accvgpr_write_b32 a234, v4
v_accvgpr_write_b32 a235, v4
v_mfma_f32_16x16x32_bf16 v[240:243], a[60:63], a[100:103], v[240:243]
s_mov_b32 s36, 0x44444444
s_mov_b32 s37, 0x44444444
v_cndmask_b32 v4, 0, v22, s[36:37]
v_mfma_f32_16x16x32_bf16 v[240:243], a[44:47], a[96:99], v[240:243]
buffer_load_dwordx4 v16, s[48:51], s32 offen offset:2048 sc1 lds
v_mfma_f32_16x16x32_bf16 v[244:247], a[44:47], a[104:107], v[244:247]
ds_read_b64_tr_b16 a[96:97], v12 offset:256
v_accvgpr_write_b32 a236, v4
v_accvgpr_write_b32 a237, v4
v_mfma_f32_16x16x32_bf16 v[244:247], a[60:63], a[108:111], v[244:247]
ds_read_b64_tr_b16 a[98:99], v12 offset:1280
v_accvgpr_write_b32 a238, v4
v_mfma_f32_16x16x32_bf16 v[236:239], a[56:59], a[108:111], v[236:239]
ds_read_b64_tr_b16 a[100:101], v12 offset:8448
v_accvgpr_write_b32 a239, v4
v_mfma_f32_16x16x32_bf16 v[236:239], a[40:43], a[104:107], v[236:239]
ds_read_b64_tr_b16 a[102:103], v12 offset:9472
v_mov_b32 v1, v3
v_mfma_f32_16x16x32_bf16 v[228:231], a[36:39], a[104:107], v[228:231]
v_add_u32 v2, 98304, v3
v_mfma_f32_16x16x32_bf16 v[228:231], a[52:55], a[108:111], v[228:231]
s_mov_b64 s[34:35], 0
v_accvgpr_write_b32 a224, 0
v_accvgpr_write_b32 a225, 0
v_mfma_f32_16x16x32_bf16 v[220:223], a[48:51], a[108:111], v[220:223]
buffer_load_dwordx4 v16, s[48:51], s32 offen offset:3072 sc1 lds
v_mfma_f32_16x16x32_bf16 v[220:223], a[32:35], a[104:107], v[220:223]
s_waitcnt lgkmcnt(4)
v_accvgpr_write_b32 a226, 0
v_accvgpr_write_b32 a227, 0
L_S22:
v_mfma_f32_16x16x32_bf16 v[24:27], a[80:83], a[0:3], v[24:27]
ds_read_b64_tr_b16 a[104:105], v13 offset:256
s_waitcnt vmcnt(13)
v_accvgpr_write_b32 a228, 0
v_mfma_f32_16x16x32_bf16 v[24:27], a[84:87], a[16:19], v[24:27]
ds_read_b64_tr_b16 a[106:107], v13 offset:1280
v_accvgpr_write_b32 a229, 0
v_mfma_f32_16x16x32_bf16 v[32:35], a[84:87], a[20:23], v[32:35]
ds_read_b64_tr_b16 a[108:109], v13 offset:8448
v_accvgpr_write_b32 a230, 0
v_mfma_f32_16x16x32_bf16 v[32:35], a[80:83], a[4:7], v[32:35]
ds_read_b64_tr_b16 a[110:111], v13 offset:9472
v_accvgpr_write_b32 a231, 0
v_mfma_f32_16x16x32_bf16 v[40:43], a[80:83], a[8:11], v[40:43]
ds_read_b128 a[32:35], v8 offset:32768
s_add_u32 m0, s19, 0x1000
s_mul_i32 s8, s6, 0x142400
v_mfma_f32_16x16x32_bf16 v[40:43], a[84:87], a[24:27], v[40:43]
buffer_load_dwordx4 v16, s[48:51], s7 offen offset:0 sc1 lds
v_mfma_f32_16x16x32_bf16 v[48:51], a[84:87], a[28:31], v[48:51]
ds_read_b128 a[48:51], v9 offset:32768
s_sub_u32 s9, 0x12e1c00, s8
v_mfma_f32_16x16x32_bf16 v[48:51], a[80:83], a[12:15], v[48:51]
ds_read_b128 a[36:39], v8 offset:34816
s_lshl_b32 s11, s5, 13
v_mfma_f32_16x16x32_bf16 v[52:55], a[88:91], a[12:15], v[52:55]
ds_read_b64_tr_b16 a[80:81], v12 offset:512
L_padA11:
s_cmp_eq_u32 s95, 1
s_cbranch_scc1 L_hopA_ret
s_add_u32 s11, s11, 0x2200000
s_add_u32 s8, s8, s11
v_mfma_f32_16x16x32_bf16 v[52:55], a[92:95], a[28:31], v[52:55]
ds_read_b64_tr_b16 a[82:83], v12 offset:1536
s_add_u32 s9, s9, s11
v_mfma_f32_16x16x32_bf16 v[44:47], a[92:95], a[24:27], v[44:47]
ds_read_b64_tr_b16 a[84:85], v12 offset:8704
s_lshl_b32 s11, s4, 10
v_mfma_f32_16x16x32_bf16 v[44:47], a[88:91], a[8:11], v[44:47]
buffer_load_dwordx4 v16, s[48:51], s7 offen offset:1024 sc1 lds
v_mfma_f32_16x16x32_bf16 v[36:39], a[88:91], a[4:7], v[36:39]
ds_read_b64_tr_b16 a[86:87], v12 offset:9728
s_add_u32 s44, s8, s11
s_add_u32 s46, s9, s11
v_mfma_f32_16x16x32_bf16 v[36:39], a[92:95], a[20:23], v[36:39]
ds_read_b128 a[52:55], v9 offset:34816
s_sub_u32 s11, 0x1c00, s11
v_mfma_f32_16x16x32_bf16 v[28:31], a[92:95], a[16:19], v[28:31]
ds_read_b128 a[40:43], v8 offset:36864
s_add_u32 s45, s8, s11
v_mfma_f32_16x16x32_bf16 v[28:31], a[88:91], a[0:3], v[28:31]
ds_read_b128 a[56:59], v9 offset:36864
s_waitcnt lgkmcnt(10)
v_mfma_f32_16x16x32_bf16 v[56:59], a[96:99], a[0:3], v[56:59]
ds_read_b64_tr_b16 a[88:89], v13 offset:512
s_add_u32 s47, s9, s11
s_mul_i32 s8, s5, 0x6000
v_mfma_f32_16x16x32_bf16 v[56:59], a[100:103], a[16:19], v[56:59]
ds_read_b64_tr_b16 a[90:91], v13 offset:1536
s_add_u32 s8, s8, 0x40000
v_mfma_f32_16x16x32_bf16 v[64:67], a[100:103], a[20:23], v[64:67]
buffer_load_dwordx4 v16, s[48:51], s7 offen offset:2048 sc1 lds
v_mfma_f32_16x16x32_bf16 v[64:67], a[96:99], a[4:7], v[64:67]
ds_read_b64_tr_b16 a[92:93], v13 offset:8704
s_add_u32 s28, s44, s8
v_mfma_f32_16x16x32_bf16 v[72:75], a[96:99], a[8:11], v[72:75]
ds_read_b64_tr_b16 a[94:95], v13 offset:9728
s_add_u32 s29, s45, s8
s_add_u32 s30, s46, s8
v_mfma_f32_16x16x32_bf16 v[72:75], a[100:103], a[24:27], v[72:75]
ds_read_b128 a[44:47], v8 offset:38912
s_add_u32 s31, s47, s8
v_mfma_f32_16x16x32_bf16 v[80:83], a[100:103], a[28:31], v[80:83]
ds_read_b128 a[60:63], v9 offset:38912
s_lshl_b32 s8, s4, 11
v_mfma_f32_16x16x32_bf16 v[80:83], a[96:99], a[12:15], v[80:83]
s_add_u32 s9, s8, 131072
v_add_u32 v4, s9, v16
v_mfma_f32_16x16x32_bf16 v[84:87], a[104:107], a[12:15], v[84:87]
ds_read_b64_tr_b16 a[96:97], v12 offset:768
s_sub_u32 s9, 145408, s8
v_mfma_f32_16x16x32_bf16 v[84:87], a[108:111], a[28:31], v[84:87]
buffer_load_dwordx4 v16, s[48:51], s7 offen offset:3072 sc1 lds
v_mfma_f32_16x16x32_bf16 v[76:79], a[108:111], a[24:27], v[76:79]
ds_read_b64_tr_b16 a[98:99], v12 offset:1792
s_add_u32 s32, s32, s94
v_mfma_f32_16x16x32_bf16 v[76:79], a[104:107], a[8:11], v[76:79]
ds_read_b64_tr_b16 a[100:101], v12 offset:8960
s_add_u32 s7, s7, s94
v_mfma_f32_16x16x32_bf16 v[68:71], a[104:107], a[4:7], v[68:71]
ds_read_b64_tr_b16 a[102:103], v12 offset:9984
s_cmp_eq_u32 s4, 0
s_cselect_b32 s8, 131072, s9
v_mfma_f32_16x16x32_bf16 v[68:71], a[108:111], a[20:23], v[68:71]
v_add_u32 v5, s8, v16
v_add_u32 v6, s9, v16
v_mfma_f32_16x16x32_bf16 v[60:63], a[108:111], a[16:19], v[60:63]
v_add_u32 v22, 0x800, v10
v_mfma_f32_16x16x32_bf16 v[60:63], a[104:107], a[0:3], v[60:63]
s_add_u32 m0, s19, 0x18000
s_waitcnt lgkmcnt(6)
s_mov_b32 s8, 0x800
v_mfma_f32_16x16x32_bf16 v[88:91], a[80:83], a[0:3], v[88:91]
buffer_load_dwordx4 v16, s[48:51], s32 offen offset:0 sc1 lds
v_mfma_f32_16x16x32_bf16 v[88:91], a[84:87], a[16:19], v[88:91]
ds_read_b64_tr_b16 a[104:105], v13 offset:768
v_mfma_f32_16x16x32_bf16 v[96:99], a[84:87], a[20:23], v[96:99]
ds_read_b64_tr_b16 a[106:107], v13 offset:1792
v_mfma_f32_16x16x32_bf16 v[96:99], a[80:83], a[4:7], v[96:99]
ds_read_b64_tr_b16 a[108:109], v13 offset:8960
v_mfma_f32_16x16x32_bf16 v[104:107], a[80:83], a[8:11], v[104:107]
ds_read_b64_tr_b16 a[110:111], v13 offset:9984
s_cmp_eq_u32 s6, 0
s_cselect_b32 s8, 0xffff8800, s8
v_mfma_f32_16x16x32_bf16 v[104:107], a[84:87], a[24:27], v[104:107]
v_add_u32 v7, s8, v11
v_mfma_f32_16x16x32_bf16 v[112:115], a[84:87], a[28:31], v[112:115]
buffer_load_dwordx4 v16, s[48:51], s32 offen offset:1024 sc1 lds
v_mfma_f32_16x16x32_bf16 v[112:115], a[80:83], a[12:15], v[112:115]
s_and_b32 s18, s2, 4
s_lshr_b32 s8, s2, 6
s_add_u32 s18, s18, s8
v_mfma_f32_16x16x32_bf16 v[116:119], a[88:91], a[12:15], v[116:119]
ds_read_b64_tr_b16 a[80:81], v14 offset:0
s_sub_u32 s8, 15, s18
v_mfma_f32_16x16x32_bf16 v[116:119], a[92:95], a[28:31], v[116:119]
ds_read_b64_tr_b16 a[82:83], v14 offset:256
v_mfma_f32_16x16x32_bf16 v[108:111], a[92:95], a[24:27], v[108:111]
ds_read_b64_tr_b16 a[84:85], v14 offset:2048
v_mfma_f32_16x16x32_bf16 v[108:111], a[88:91], a[8:11], v[108:111]
ds_read_b64_tr_b16 a[86:87], v14 offset:2304
v_mfma_f32_16x16x32_bf16 v[100:103], a[88:91], a[4:7], v[100:103]
buffer_load_dwordx4 v16, s[48:51], s32 offen offset:2048 sc1 lds
v_mfma_f32_16x16x32_bf16 v[100:103], a[92:95], a[20:23], v[100:103]
s_cmp_lt_u32 s4, 2
s_cselect_b32 s99, s18, s8
s_lshl_b32 s16, s2, 2
v_mfma_f32_16x16x32_bf16 v[92:95], a[92:95], a[16:19], v[92:95]
s_add_u32 s16, s16, s4
s_lshl_b32 s16, s16, 12
s_add_u32 s16, s16, 0x4800000
v_mfma_f32_16x16x32_bf16 v[92:95], a[88:91], a[0:3], v[92:95]
s_waitcnt lgkmcnt(4)
s_bfe_u32 s100, s2, 0x30003
s_and_b32 s14, s2, 3
v_mfma_f32_16x16x32_bf16 v[120:123], a[96:99], a[0:3], v[120:123]
ds_read_b64_tr_b16 a[88:89], v15 offset:0
s_lshl_b32 s24, s18, 2
s_add_u32 s24, s24, s14
v_mfma_f32_16x16x32_bf16 v[120:123], a[100:103], a[16:19], v[120:123]
ds_read_b64_tr_b16 a[90:91], v15 offset:256
s_lshl_b32 s24, s24, 8
v_mfma_f32_16x16x32_bf16 v[128:131], a[100:103], a[20:23], v[128:131]
buffer_load_dwordx4 v16, s[48:51], s32 offen offset:3072 sc1 lds
v_mfma_f32_16x16x32_bf16 v[128:131], a[96:99], a[4:7], v[128:131]
ds_read_b64_tr_b16 a[92:93], v15 offset:2048
s_add_u32 s24, s24, 0x3704000
v_mfma_f32_16x16x32_bf16 v[136:139], a[96:99], a[8:11], v[136:139]
ds_read_b64_tr_b16 a[94:95], v15 offset:2304
s_mov_b32 s12, 14336
s_lshl_b32 s13, s4, 15
v_mfma_f32_16x16x32_bf16 v[136:139], a[100:103], a[24:27], v[136:139]
s_lshl_b32 s9, s100, 8
s_add_u32 s13, s13, s9
s_mul_i32 s9, s14, 0x80040
v_mfma_f32_16x16x32_bf16 v[144:147], a[100:103], a[28:31], v[144:147]
s_add_u32 s13, s13, s9
s_and_b32 s9, s2, 1
s_lshl_b32 s9, s9, 17
v_mfma_f32_16x16x32_bf16 v[144:147], a[96:99], a[12:15], v[144:147]
s_add_u32 m0, s19, 0x19000
s_add_u32 s13, s13, s9
s_mul_i32 s25, s14, 0x180000
v_mfma_f32_16x16x32_bf16 v[148:151], a[104:107], a[12:15], v[148:151]
buffer_load_dwordx4 v16, s[48:51], s7 offen offset:0 sc1 lds
s_add_u32 s25, s25, s9
v_mfma_f32_16x16x32_bf16 v[148:151], a[108:111], a[28:31], v[148:151]
ds_read_b64_tr_b16 a[96:97], v14 offset:4096
s_sub_u32 s25, s25, 524288
v_mfma_f32_16x16x32_bf16 v[140:143], a[108:111], a[24:27], v[140:143]
ds_read_b64_tr_b16 a[98:99], v14 offset:4352
s_lshr_b32 s9, s9, 3
v_mfma_f32_16x16x32_bf16 v[140:143], a[104:107], a[8:11], v[140:143]
ds_read_b64_tr_b16 a[100:101], v14 offset:6144
s_mul_i32 s101, s99, 0x142400
v_mfma_f32_16x16x32_bf16 v[132:135], a[104:107], a[4:7], v[132:135]
ds_read_b64_tr_b16 a[102:103], v14 offset:6400
s_and_b32 s8, s4, 1
s_lshl_b32 s8, s8, 12
v_mfma_f32_16x16x32_bf16 v[132:135], a[108:111], a[20:23], v[132:135]
s_add_u32 s101, s101, s8
s_lshl_b32 s8, s14, 16
s_add_u32 s101, s101, s8
v_mfma_f32_16x16x32_bf16 v[124:127], a[108:111], a[16:19], v[124:127]
s_waitcnt lgkmcnt(4)
s_add_u32 s101, s101, s9
s_add_u32 s101, s101, 0x21fe000
v_mfma_f32_16x16x32_bf16 v[124:127], a[104:107], a[0:3], v[124:127]
buffer_load_dwordx4 v16, s[48:51], s7 offen offset:1024 sc1 lds
v_mfma_f32_16x16x32_bf16 v[152:155], a[80:83], a[0:3], v[152:155]
ds_read_b64_tr_b16 a[104:105], v15 offset:4096
s_mul_i32 s26, s14, 196608
s_add_u32 s26, s26, s9
v_mfma_f32_16x16x32_bf16 v[152:155], a[84:87], a[16:19], v[152:155]
ds_read_b64_tr_b16 a[106:107], v15 offset:4352
s_add_u32 s26, s26, 188416
v_mfma_f32_16x16x32_bf16 v[160:163], a[84:87], a[20:23], v[160:163]
ds_read_b64_tr_b16 a[108:109], v15 offset:6144
s_mov_b32 s52, 0x3e0293ee
v_mfma_f32_16x16x32_bf16 v[160:163], a[80:83], a[4:7], v[160:163]
ds_read_b64_tr_b16 a[110:111], v15 offset:6400
s_mov_b32 s53, 0x3e0293ee
v_mfma_f32_16x16x32_bf16 v[168:171], a[80:83], a[8:11], v[168:171]
s_mov_b32 s54, 0x3e8293ee
s_or_b32 s55, s6, s4
s_cselect_b32 s55, 0, 0xf149f2ca
s_mov_b32 s56, 0x50000
v_mfma_f32_16x16x32_bf16 v[168:171], a[84:87], a[24:27], v[168:171]
buffer_load_dwordx4 v16, s[48:51], s7 offen offset:2048 sc1 lds
v_mfma_f32_16x16x32_bf16 v[176:179], a[84:87], a[28:31], v[176:179]
s_mov_b32 s57, 0x5550055
s_mov_b32 s58, 0xa0000
s_mov_b32 s59, 0xaaa00aa
v_mfma_f32_16x16x32_bf16 v[176:179], a[80:83], a[12:15], v[176:179]
s_mov_b32 s60, 0x150001
s_mov_b32 s61, 0x15550155
s_mov_b32 s62, 0x2a0002
v_mfma_f32_16x16x32_bf16 v[180:183], a[88:91], a[12:15], v[180:183]
ds_read_b64_tr_b16 a[80:81], v14 offset:8192
s_mov_b32 s63, 0x2aaa02aa
s_mov_b32 s68, 0x55505555
v_mfma_f32_16x16x32_bf16 v[180:183], a[92:95], a[28:31], v[180:183]
ds_read_b64_tr_b16 a[82:83], v14 offset:8448
s_mov_b32 s69, 0x50005500
v_mfma_f32_16x16x32_bf16 v[172:175], a[92:95], a[24:27], v[172:175]
ds_read_b64_tr_b16 a[84:85], v14 offset:10240
s_mov_b32 s70, 0xaaa0aaaa
v_mfma_f32_16x16x32_bf16 v[172:175], a[88:91], a[8:11], v[172:175]
buffer_load_dwordx4 v16, s[48:51], s7 offen offset:3072 sc1 lds
v_mfma_f32_16x16x32_bf16 v[164:167], a[88:91], a[4:7], v[164:167]
ds_read_b64_tr_b16 a[86:87], v14 offset:10496
s_add_u32 s32, s32, 0x8000
s_mov_b32 s71, 0xa000aa00
v_mfma_f32_16x16x32_bf16 v[164:167], a[92:95], a[20:23], v[164:167]
s_add_u32 s7, s7, 0x8000
s_mov_b32 s76, 0x55405554
s_mov_b32 s77, 0x40005400
v_mfma_f32_16x16x32_bf16 v[156:159], a[92:95], a[16:19], v[156:159]
s_mov_b32 s78, 0xaa80aaa8
s_mov_b32 s79, 0x8000a800
s_mov_b32 s8, 0xf149f2ca
v_mfma_f32_16x16x32_bf16 v[156:159], a[88:91], a[0:3], v[156:159]
s_waitcnt lgkmcnt(4)
s_mov_b32 s36, 0xfff0ffff
v_mov_b32 v21, s1
v_mfma_f32_16x16x32_bf16 v[184:187], a[96:99], a[0:3], v[184:187]
ds_read_b64_tr_b16 a[88:89], v15 offset:8192
s_mov_b32 s37, 0xf000ff00
v_add_u32 v20, s0, v16
v_mfma_f32_16x16x32_bf16 v[184:187], a[100:103], a[16:19], v[184:187]
global_load_dword a120, v[20:21], off sc1
v_mfma_f32_16x16x32_bf16 v[192:195], a[100:103], a[20:23], v[192:195]
ds_read_b64_tr_b16 a[90:91], v15 offset:8448
s_mov_b32 s38, 0xffe0fffe
v_mfma_f32_16x16x32_bf16 v[192:195], a[96:99], a[4:7], v[192:195]
ds_read_b64_tr_b16 a[92:93], v15 offset:10240
s_mov_b32 s39, 0xe000fe00
v_mfma_f32_16x16x32_bf16 v[200:203], a[96:99], a[8:11], v[200:203]
ds_read_b64_tr_b16 a[94:95], v15 offset:10496
s_mov_b32 s40, 0xffc0fffc
v_add_u32 v12, 0x8000, v12
v_mfma_f32_16x16x32_bf16 v[200:203], a[100:103], a[24:27], v[200:203]
s_mov_b32 s41, 0xc000fc00
v_add_u32 v13, 0x8000, v13
v_add_u32 v14, 0x8000, v14
v_mfma_f32_16x16x32_bf16 v[208:211], a[100:103], a[28:31], v[208:211]
s_mov_b32 s42, 0xff80fff8
s_mov_b32 s43, 0x8000f800
v_add_u32 v15, 0x8000, v15
v_mfma_f32_16x16x32_bf16 v[208:211], a[96:99], a[12:15], v[208:211]
s_bitcmp1_b32 s4, 0
s_cselect_b32 s10, 0x7f800000, s8
s_cselect_b32 s11, s8, 0x7f800000
v_mfma_f32_16x16x32_bf16 v[212:215], a[104:107], a[12:15], v[212:215]
s_waitcnt vmcnt(19) lgkmcnt(0)
v_mfma_f32_16x16x32_bf16 v[212:215], a[108:111], a[28:31], v[212:215]
s_barrier
s_add_u32 m0, s19, 0x8000
v_mfma_f32_16x16x32_bf16 v[204:207], a[108:111], a[24:27], v[204:207]
buffer_load_dwordx4 v16, s[48:51], s32 offen offset:0 sc1 lds
v_mfma_f32_16x16x32_bf16 v[204:207], a[104:107], a[8:11], v[204:207]
ds_read_b64_tr_b16 a[96:97], v14 offset:4096
v_mfma_f32_16x16x32_bf16 v[196:199], a[104:107], a[4:7], v[196:199]
ds_read_b64_tr_b16 a[98:99], v14 offset:4352
v_mfma_f32_16x16x32_bf16 v[196:199], a[108:111], a[20:23], v[196:199]
ds_read_b64_tr_b16 a[100:101], v14 offset:6144
v_mfma_f32_16x16x32_bf16 v[188:191], a[108:111], a[16:19], v[188:191]
ds_read_b64_tr_b16 a[102:103], v14 offset:6400
v_mfma_f32_16x16x32_bf16 v[188:191], a[104:107], a[0:3], v[188:191]
s_waitcnt lgkmcnt(4)
v_mfma_f32_16x16x32_bf16 v[216:219], a[0:3], a[80:83], v[216:219]
buffer_load_dwordx4 v16, s[48:51], s32 offen offset:1024 sc1 lds
v_mfma_f32_16x16x32_bf16 v[216:219], a[16:19], a[84:87], v[216:219]
ds_read_b64_tr_b16 a[104:105], v15 offset:4096
v_mfma_f32_16x16x32_bf16 v[224:227], a[20:23], a[84:87], v[224:227]
ds_read_b64_tr_b16 a[106:107], v15 offset:4352
v_mfma_f32_16x16x32_bf16 v[224:227], a[4:7], a[80:83], v[224:227]
ds_read_b64_tr_b16 a[108:109], v15 offset:6144
v_mfma_f32_16x16x32_bf16 v[232:235], a[8:11], a[80:83], v[232:235]
ds_read_b64_tr_b16 a[110:111], v15 offset:6400
v_mfma_f32_16x16x32_bf16 v[232:235], a[24:27], a[84:87], v[232:235]
v_mfma_f32_16x16x32_bf16 v[240:243], a[28:31], a[84:87], v[240:243]
v_mfma_f32_16x16x32_bf16 v[240:243], a[12:15], a[80:83], v[240:243]
buffer_load_dwordx4 v16, s[48:51], s32 offen offset:2048 sc1 lds
v_mfma_f32_16x16x32_bf16 v[244:247], a[12:15], a[88:91], v[244:247]
ds_read_b64_tr_b16 a[80:81], v14 offset:8192
v_mfma_f32_16x16x32_bf16 v[244:247], a[28:31], a[92:95], v[244:247]
ds_read_b64_tr_b16 a[82:83], v14 offset:8448
v_mfma_f32_16x16x32_bf16 v[236:239], a[24:27], a[92:95], v[236:239]
ds_read_b64_tr_b16 a[84:85], v14 offset:10240
v_mfma_f32_16x16x32_bf16 v[236:239], a[8:11], a[88:91], v[236:239]
ds_read_b64_tr_b16 a[86:87], v14 offset:10496
v_mfma_f32_16x16x32_bf16 v[228:231], a[4:7], a[88:91], v[228:231]
v_mfma_f32_16x16x32_bf16 v[228:231], a[20:23], a[92:95], v[228:231]
v_mfma_f32_16x16x32_bf16 v[220:223], a[16:19], a[92:95], v[220:223]
buffer_load_dwordx4 v16, s[48:51], s32 offen offset:3072 sc1 lds
v_mfma_f32_16x16x32_bf16 v[220:223], a[0:3], a[88:91], v[220:223]
s_waitcnt lgkmcnt(4)
L_S23:
v_mfma_f32_16x16x32_bf16 v[184:187], a[96:99], a[32:35], v[184:187]
ds_read_b64_tr_b16 a[88:89], v15 offset:8192
v_mov_b32 v8, v19
v_mov_b32 v9, 0xf149f2ca
v_mfma_f32_16x16x32_bf16 v[184:187], a[100:103], a[48:51], v[184:187]
ds_read_b64_tr_b16 a[90:91], v15 offset:8448
v_mov_b32 v248, 0xffff
v_mfma_f32_16x16x32_bf16 v[192:195], a[100:103], a[52:55], v[192:195]
ds_read_b64_tr_b16 a[92:93], v15 offset:10240
v_mov_b32 v249, 0xffff0000
v_mfma_f32_16x16x32_bf16 v[192:195], a[96:99], a[36:39], v[192:195]
ds_read_b64_tr_b16 a[94:95], v15 offset:10496
v_cndmask_b32 v252, 0, v248, s[56:57]
v_mfma_f32_16x16x32_bf16 v[200:203], a[96:99], a[40:43], v[200:203]
s_add_u32 m0, s19, 0x9000
v_cndmask_b32 v252, v252, v249, s[58:59]
v_cndmask_b32 v253, 0, v248, s[60:61]
v_cndmask_b32 v253, v253, v249, s[62:63]
v_mfma_f32_16x16x32_bf16 v[200:203], a[100:103], a[56:59], v[200:203]
buffer_load_dwordx4 v16, s[48:51], s7 offen offset:0 sc1 lds
v_mfma_f32_16x16x32_bf16 v[208:211], a[100:103], a[60:63], v[208:211]
v_cndmask_b32 v254, 0, v248, s[68:69]
v_cndmask_b32 v254, v254, v249, s[70:71]
v_mfma_f32_16x16x32_bf16 v[208:211], a[96:99], a[44:47], v[208:211]
v_cndmask_b32 v255, 0, v248, s[76:77]
v_cndmask_b32 v255, v255, v249, s[78:79]
v_mfma_f32_16x16x32_bf16 v[212:215], a[104:107], a[44:47], v[212:215]
ds_read_b64_tr_b16 a[96:97], v14 offset:0
v_cndmask_b32 v248, v9, 0, s[68:69]
v_cndmask_b32 v249, v9, 0, s[70:71]
v_mfma_f32_16x16x32_bf16 v[212:215], a[108:111], a[60:63], v[212:215]
ds_read_b64_tr_b16 a[98:99], v14 offset:256
v_cndmask_b32 v250, v9, 0, s[76:77]
v_mfma_f32_16x16x32_bf16 v[204:207], a[108:111], a[56:59], v[204:207]
ds_read_b64_tr_b16 a[100:101], v14 offset:2048
v_cndmask_b32 v251, v9, 0, s[78:79]
v_mfma_f32_16x16x32_bf16 v[204:207], a[104:107], a[40:43], v[204:207]
buffer_load_dwordx4 v16, s[48:51], s7 offen offset:1024 sc1 lds
v_mfma_f32_16x16x32_bf16 v[196:199], a[104:107], a[36:39], v[196:199]
ds_read_b64_tr_b16 a[102:103], v14 offset:2304
v_mfma_f32_16x16x32_bf16 v[196:199], a[108:111], a[52:55], v[196:199]
v_mfma_f32_16x16x32_bf16 v[188:191], a[108:111], a[48:51], v[188:191]
v_mfma_f32_16x16x32_bf16 v[188:191], a[104:107], a[32:35], v[188:191]
s_waitcnt lgkmcnt(4)
v_mfma_f32_16x16x32_bf16 v[216:219], a[32:35], a[80:83], v[216:219]
ds_read_b64_tr_b16 a[104:105], v15 offset:0
v_mfma_f32_16x16x32_bf16 v[216:219], a[48:51], a[84:87], v[216:219]
ds_read_b64_tr_b16 a[106:107], v15 offset:256
v_mfma_f32_16x16x32_bf16 v[224:227], a[52:55], a[84:87], v[224:227]
buffer_load_dwordx4 v16, s[48:51], s7 offen offset:2048 sc1 lds
v_mfma_f32_16x16x32_bf16 v[224:227], a[36:39], a[80:83], v[224:227]
ds_read_b64_tr_b16 a[108:109], v15 offset:2048
v_cvt_pk_bf16_f32 v192, v192, v193
v_mfma_f32_16x16x32_bf16 v[232:235], a[40:43], a[80:83], v[232:235]
ds_read_b64_tr_b16 a[110:111], v15 offset:2304
v_cvt_pk_bf16_f32 v193, v194, v195
v_cvt_pk_bf16_f32 v194, v196, v197
v_mfma_f32_16x16x32_bf16 v[232:235], a[56:59], a[84:87], v[232:235]
v_cvt_pk_bf16_f32 v195, v198, v199
v_cvt_pk_bf16_f32 v208, v208, v209
v_mfma_f32_16x16x32_bf16 v[240:243], a[60:63], a[84:87], v[240:243]
v_cvt_pk_bf16_f32 v209, v210, v211
v_cvt_pk_bf16_f32 v210, v212, v213
v_mfma_f32_16x16x32_bf16 v[240:243], a[44:47], a[80:83], v[240:243]
v_cvt_pk_bf16_f32 v211, v214, v215
v_mfma_f32_16x16x32_bf16 v[244:247], a[44:47], a[88:91], v[244:247]
ds_read_b64_tr_b16 a[80:81], v12 offset:0
v_mfma_f32_16x16x32_bf16 v[244:247], a[60:63], a[92:95], v[244:247]
buffer_load_dwordx4 v16, s[48:51], s7 offen offset:3072 sc1 lds
v_mfma_f32_16x16x32_bf16 v[236:239], a[56:59], a[92:95], v[236:239]
ds_read_b64_tr_b16 a[82:83], v12 offset:1024
s_add_u32 s32, s32, 0x8000
v_mfma_f32_16x16x32_bf16 v[236:239], a[40:43], a[88:91], v[236:239]
ds_read_b64_tr_b16 a[84:85], v12 offset:8192
s_add_u32 s7, s7, 0x8000
v_mfma_f32_16x16x32_bf16 v[228:231], a[36:39], a[88:91], v[228:231]
ds_read_b64_tr_b16 a[86:87], v12 offset:9216
v_mfma_f32_16x16x32_bf16 v[228:231], a[52:55], a[92:95], v[228:231]
s_cmp_lg_u32 s4, 0
s_cbranch_scc1 L_hx0
buffer_store_dwordx4 v[192:195], v22, s[88:91], 0 offen offset:0 sc1
buffer_store_dwordx4 v[208:211], v7, s[88:91], 0 offen offset:0 sc1
L_hx0:
v_mfma_f32_16x16x32_bf16 v[220:223], a[48:51], a[92:95], v[220:223]
v_cvt_pk_bf16_f32 v184, v184, v185
v_cvt_pk_bf16_f32 v185, v186, v187
v_mfma_f32_16x16x32_bf16 v[220:223], a[32:35], a[88:91], v[220:223]
s_waitcnt lgkmcnt(4)
v_cvt_pk_bf16_f32 v186, v188, v189
v_cvt_pk_bf16_f32 v187, v190, v191
v_mfma_f32_16x16x32_bf16 v[152:155], a[96:99], a[32:35], v[152:155]
ds_read_b64_tr_b16 a[88:89], v13 offset:0
v_cvt_pk_bf16_f32 v200, v200, v201
v_cvt_pk_bf16_f32 v201, v202, v203
v_mfma_f32_16x16x32_bf16 v[152:155], a[100:103], a[48:51], v[152:155]
ds_read_b64_tr_b16 a[90:91], v13 offset:1024
v_cvt_pk_bf16_f32 v202, v204, v205
v_mfma_f32_16x16x32_bf16 v[160:163], a[100:103], a[52:55], v[160:163]
ds_read_b64_tr_b16 a[92:93], v13 offset:8192
v_cvt_pk_bf16_f32 v203, v206, v207
v_mfma_f32_16x16x32_bf16 v[160:163], a[96:99], a[36:39], v[160:163]
ds_read_b64_tr_b16 a[94:95], v13 offset:9216
v_mfma_f32_16x16x32_bf16 v[168:171], a[96:99], a[40:43], v[168:171]
ds_write_b128 v5, v[192:195] offset:2048
v_mfma_f32_16x16x32_bf16 v[168:171], a[100:103], a[56:59], v[168:171]
ds_write_b128 v5, v[208:211] offset:18432
v_mfma_f32_16x16x32_bf16 v[176:179], a[100:103], a[60:63], v[176:179]
ds_write_b128 v4, v[184:187] offset:2048
v_mfma_f32_16x16x32_bf16 v[176:179], a[96:99], a[44:47], v[176:179]
ds_write_b128 v4, v[200:203] offset:18432
v_mfma_f32_16x16x32_bf16 v[180:183], a[104:107], a[44:47], v[180:183]
ds_read_b64_tr_b16 a[96:97], v12 offset:256
v_cvt_pk_bf16_f32 v231, v230, v231
v_cvt_pk_bf16_f32 v230, v228, v229
v_mfma_f32_16x16x32_bf16 v[180:183], a[108:111], a[60:63], v[180:183]
ds_read_b64_tr_b16 a[98:99], v12 offset:1280
v_cvt_pk_bf16_f32 v228, v224, v225
v_mfma_f32_16x16x32_bf16 v[172:175], a[108:111], a[56:59], v[172:175]
ds_read_b64_tr_b16 a[100:101], v12 offset:8448
v_cvt_pk_bf16_f32 v229, v226, v227
v_mfma_f32_16x16x32_bf16 v[172:175], a[104:107], a[40:43], v[172:175]
ds_read_b64_tr_b16 a[102:103], v12 offset:9472
v_cvt_pk_bf16_f32 v227, v226, v227
v_mfma_f32_16x16x32_bf16 v[164:167], a[104:107], a[36:39], v[164:167]
v_cvt_pk_bf16_f32 v226, v224, v225
v_cvt_pk_bf16_f32 v247, v246, v247
v_cvt_pk_bf16_f32 v246, v244, v245
v_mfma_f32_16x16x32_bf16 v[164:167], a[108:111], a[52:55], v[164:167]
v_cvt_pk_bf16_f32 v244, v240, v241
v_cvt_pk_bf16_f32 v245, v242, v243
v_mfma_f32_16x16x32_bf16 v[156:159], a[108:111], a[48:51], v[156:159]
v_cvt_pk_bf16_f32 v243, v242, v243
v_cvt_pk_bf16_f32 v242, v240, v241
v_mfma_f32_16x16x32_bf16 v[156:159], a[104:107], a[32:35], v[156:159]
s_waitcnt lgkmcnt(4)
v_mfma_f32_16x16x32_bf16 v[24:27], a[80:83], a[32:35], v[24:27]
ds_read_b64_tr_b16 a[104:105], v13 offset:256
v_mfma_f32_16x16x32_bf16 v[24:27], a[84:87], a[48:51], v[24:27]
ds_read_b64_tr_b16 a[106:107], v13 offset:1280
v_mfma_f32_16x16x32_bf16 v[32:35], a[84:87], a[52:55], v[32:35]
ds_read_b64_tr_b16 a[108:109], v13 offset:8448
v_mfma_f32_16x16x32_bf16 v[32:35], a[80:83], a[36:39], v[32:35]
ds_read_b64_tr_b16 a[110:111], v13 offset:9472
v_mfma_f32_16x16x32_bf16 v[40:43], a[80:83], a[40:43], v[40:43]
s_cmp_lg_u32 s4, 0
s_cbranch_scc1 L_hx1
buffer_store_dwordx4 v[228:231], v22, s[88:91], 0 offen offset:1024 sc1
buffer_store_dwordx4 v[244:247], v7, s[88:91], 0 offen offset:1024 sc1
L_hx1:
v_mfma_f32_16x16x32_bf16 v[40:43], a[84:87], a[56:59], v[40:43]
v_cvt_pk_bf16_f32 v223, v222, v223
v_cvt_pk_bf16_f32 v222, v220, v221
v_mfma_f32_16x16x32_bf16 v[48:51], a[84:87], a[60:63], v[48:51]
v_cvt_pk_bf16_f32 v220, v216, v217
v_cvt_pk_bf16_f32 v221, v218, v219
v_mfma_f32_16x16x32_bf16 v[48:51], a[80:83], a[44:47], v[48:51]
v_cvt_pk_bf16_f32 v219, v218, v219
v_cvt_pk_bf16_f32 v218, v216, v217
v_mfma_f32_16x16x32_bf16 v[52:55], a[88:91], a[44:47], v[52:55]
ds_read_b64_tr_b16 a[80:81], v12 offset:512
v_cvt_pk_bf16_f32 v239, v238, v239
v_cvt_pk_bf16_f32 v238, v236, v237
v_mfma_f32_16x16x32_bf16 v[52:55], a[92:95], a[60:63], v[52:55]
ds_read_b64_tr_b16 a[82:83], v12 offset:1536
v_cvt_pk_bf16_f32 v236, v232, v233
v_mfma_f32_16x16x32_bf16 v[44:47], a[92:95], a[56:59], v[44:47]
ds_read_b64_tr_b16 a[84:85], v12 offset:8704
v_cvt_pk_bf16_f32 v237, v234, v235
v_mfma_f32_16x16x32_bf16 v[44:47], a[88:91], a[40:43], v[44:47]
ds_read_b64_tr_b16 a[86:87], v12 offset:9728
v_cvt_pk_bf16_f32 v235, v234, v235
v_mfma_f32_16x16x32_bf16 v[36:39], a[88:91], a[36:39], v[36:39]
v_cvt_pk_bf16_f32 v234, v232, v233
v_mfma_f32_16x16x32_bf16 v[36:39], a[92:95], a[52:55], v[36:39]
ds_write_b128 v5, v[228:231] offset:3072
v_mfma_f32_16x16x32_bf16 v[28:31], a[92:95], a[48:51], v[28:31]
ds_write_b128 v5, v[244:247] offset:19456
v_mfma_f32_16x16x32_bf16 v[28:31], a[88:91], a[32:35], v[28:31]
s_waitcnt lgkmcnt(4)
v_mfma_f32_16x16x32_bf16 v[56:59], a[96:99], a[32:35], v[56:59]
ds_read_b64_tr_b16 a[88:89], v13 offset:512
v_mfma_f32_16x16x32_bf16 v[56:59], a[100:103], a[48:51], v[56:59]
ds_read_b64_tr_b16 a[90:91], v13 offset:1536
v_mfma_f32_16x16x32_bf16 v[64:67], a[100:103], a[52:55], v[64:67]
ds_read_b64_tr_b16 a[92:93], v13 offset:8704
v_mfma_f32_16x16x32_bf16 v[64:67], a[96:99], a[36:39], v[64:67]
ds_read_b64_tr_b16 a[94:95], v13 offset:9728
v_mfma_f32_16x16x32_bf16 v[72:75], a[96:99], a[40:43], v[72:75]
ds_write_b128 v4, v[220:223] offset:3072
v_mfma_f32_16x16x32_bf16 v[72:75], a[100:103], a[56:59], v[72:75]
ds_write_b128 v4, v[236:239] offset:19456
v_mfma_f32_16x16x32_bf16 v[80:83], a[100:103], a[60:63], v[80:83]
v_cvt_pk_bf16_f32 v152, v152, v153
v_cvt_pk_bf16_f32 v153, v154, v155
v_mfma_f32_16x16x32_bf16 v[80:83], a[96:99], a[44:47], v[80:83]
v_cvt_pk_bf16_f32 v154, v156, v157
v_cvt_pk_bf16_f32 v155, v158, v159
v_mfma_f32_16x16x32_bf16 v[84:87], a[104:107], a[44:47], v[84:87]
ds_read_b64_tr_b16 a[96:97], v12 offset:768
v_cvt_pk_bf16_f32 v160, v160, v161
v_cvt_pk_bf16_f32 v161, v162, v163
v_mfma_f32_16x16x32_bf16 v[84:87], a[108:111], a[60:63], v[84:87]
ds_read_b64_tr_b16 a[98:99], v12 offset:1792
v_cvt_pk_bf16_f32 v162, v164, v165
v_mfma_f32_16x16x32_bf16 v[76:79], a[108:111], a[56:59], v[76:79]
ds_read_b64_tr_b16 a[100:101], v12 offset:8960
v_cvt_pk_bf16_f32 v163, v166, v167
v_mfma_f32_16x16x32_bf16 v[76:79], a[104:107], a[40:43], v[76:79]
ds_read_b64_tr_b16 a[102:103], v12 offset:9984
v_cvt_pk_bf16_f32 v168, v168, v169
v_mfma_f32_16x16x32_bf16 v[68:71], a[104:107], a[36:39], v[68:71]
v_cvt_pk_bf16_f32 v169, v170, v171
v_cvt_pk_bf16_f32 v170, v172, v173
v_cvt_pk_bf16_f32 v171, v174, v175
v_mfma_f32_16x16x32_bf16 v[68:71], a[108:111], a[52:55], v[68:71]
v_cvt_pk_bf16_f32 v176, v176, v177
v_cvt_pk_bf16_f32 v177, v178, v179
v_mfma_f32_16x16x32_bf16 v[60:63], a[108:111], a[48:51], v[60:63]
v_cvt_pk_bf16_f32 v178, v180, v181
v_cvt_pk_bf16_f32 v179, v182, v183
v_mfma_f32_16x16x32_bf16 v[60:63], a[104:107], a[32:35], v[60:63]
s_waitcnt lgkmcnt(4)
v_mfma_f32_16x16x32_bf16 v[88:91], a[80:83], a[32:35], v[88:91]
ds_read_b64_tr_b16 a[104:105], v13 offset:768
v_mfma_f32_16x16x32_bf16 v[88:91], a[84:87], a[48:51], v[88:91]
ds_read_b64_tr_b16 a[106:107], v13 offset:1792
v_mfma_f32_16x16x32_bf16 v[96:99], a[84:87], a[52:55], v[96:99]
ds_read_b64_tr_b16 a[108:109], v13 offset:8960
v_mfma_f32_16x16x32_bf16 v[96:99], a[80:83], a[36:39], v[96:99]
ds_read_b64_tr_b16 a[110:111], v13 offset:9984
v_mfma_f32_16x16x32_bf16 v[104:107], a[80:83], a[40:43], v[104:107]
v_mfma_f32_16x16x32_bf16 v[104:107], a[84:87], a[56:59], v[104:107]
v_mfma_f32_16x16x32_bf16 v[112:115], a[84:87], a[60:63], v[112:115]
v_mfma_f32_16x16x32_bf16 v[112:115], a[80:83], a[44:47], v[112:115]
v_mfma_f32_16x16x32_bf16 v[116:119], a[88:91], a[44:47], v[116:119]
v_mfma_f32_16x16x32_bf16 v[116:119], a[92:95], a[60:63], v[116:119]
v_mfma_f32_16x16x32_bf16 v[108:111], a[92:95], a[56:59], v[108:111]
v_mfma_f32_16x16x32_bf16 v[108:111], a[88:91], a[40:43], v[108:111]
v_mov_b32 v15, s6
v_xor_b32 v15, 0, v15
v_mfma_f32_16x16x32_bf16 v[100:103], a[88:91], a[36:39], v[100:103]
v_writelane_b32 v15, s18, 0
v_lshlrev_b32 v15, 2, v15
v_bfe_u32 v12, v0, 2, 2
v_mfma_f32_16x16x32_bf16 v[100:103], a[92:95], a[52:55], v[100:103]
v_lshlrev_b32 v12, 11, v12
v_lshrrev_b32 v13, 4, v0
v_mfma_f32_16x16x32_bf16 v[92:95], a[92:95], a[48:51], v[92:95]
v_lshl_add_u32 v12, v13, 6, v12
v_and_b32 v13, 3, v0
v_mfma_f32_16x16x32_bf16 v[92:95], a[88:91], a[32:35], v[92:95]
s_waitcnt lgkmcnt(0)
v_lshl_add_u32 v12, v13, 4, v12
v_xor_b32 v12, s13, v12
v_mfma_f32_16x16x32_bf16 v[120:123], a[96:99], a[32:35], v[120:123]
L_padA12:
s_cmp_eq_u32 s95, 1
s_cbranch_scc1 L_hopA_ret
v_xor_b32 v13, 32, v12
v_add_u32 v13, 7168, v13
v_mul_f32 v24, s52, v24
v_mfma_f32_16x16x32_bf16 v[120:123], a[100:103], a[48:51], v[120:123]
v_mul_f32 v25, s52, v25
v_mul_f32 v26, s52, v26
v_mfma_f32_16x16x32_bf16 v[128:131], a[100:103], a[52:55], v[128:131]
v_mul_f32 v27, s52, v27
v_mul_f32 v28, s52, v28
v_mfma_f32_16x16x32_bf16 v[128:131], a[96:99], a[36:39], v[128:131]
v_mul_f32 v29, s52, v29
v_mul_f32 v30, s52, v30
v_mfma_f32_16x16x32_bf16 v[136:139], a[96:99], a[40:43], v[136:139]
v_mul_f32 v31, s52, v31
v_cvt_pk_bf16_f32 v24, v24, v25
v_cvt_pk_bf16_f32 v25, v26, v27
v_mfma_f32_16x16x32_bf16 v[136:139], a[100:103], a[56:59], v[136:139]
v_cvt_pk_bf16_f32 v26, v28, v29
v_cvt_pk_bf16_f32 v27, v30, v31
v_mfma_f32_16x16x32_bf16 v[144:147], a[100:103], a[60:63], v[144:147]
v_accvgpr_write_b32 a160, v24
v_accvgpr_write_b32 a161, v25
v_mfma_f32_16x16x32_bf16 v[144:147], a[96:99], a[44:47], v[144:147]
v_accvgpr_write_b32 a162, v26
v_accvgpr_write_b32 a163, v27
v_mfma_f32_16x16x32_bf16 v[148:151], a[104:107], a[44:47], v[148:151]
v_mul_f32 v32, s52, v32
v_mul_f32 v33, s52, v33
v_mul_f32 v34, s52, v34
v_mfma_f32_16x16x32_bf16 v[148:151], a[108:111], a[60:63], v[148:151]
v_mul_f32 v35, s52, v35
v_mul_f32 v36, s52, v36
v_mfma_f32_16x16x32_bf16 v[140:143], a[108:111], a[56:59], v[140:143]
v_mul_f32 v37, s52, v37
v_mul_f32 v38, s52, v38
v_mfma_f32_16x16x32_bf16 v[140:143], a[104:107], a[40:43], v[140:143]
v_mul_f32 v39, s52, v39
v_cvt_pk_bf16_f32 v32, v32, v33
v_mfma_f32_16x16x32_bf16 v[132:135], a[104:107], a[36:39], v[132:135]
v_cvt_pk_bf16_f32 v33, v34, v35
v_cvt_pk_bf16_f32 v34, v36, v37
v_cvt_pk_bf16_f32 v35, v38, v39
v_mfma_f32_16x16x32_bf16 v[132:135], a[108:111], a[52:55], v[132:135]
v_accvgpr_write_b32 a176, v32
v_accvgpr_write_b32 a177, v33
v_mfma_f32_16x16x32_bf16 v[124:127], a[108:111], a[48:51], v[124:127]
v_accvgpr_write_b32 a178, v34
v_accvgpr_write_b32 a179, v35
v_mfma_f32_16x16x32_bf16 v[124:127], a[104:107], a[32:35], v[124:127]
L_trans:
s_waitcnt vmcnt(17) lgkmcnt(0)
s_barrier
s_cmp_eq_u32 s4, 0
s_cbranch_scc1 L_hx_ld
ds_read_b128 v[188:191], v4 offset:0
ds_read_b64 v[216:217], v4 offset:1024
ds_read_b64 v[220:221], v4 offset:1032
ds_read_b128 v[204:207], v4 offset:16384
ds_read_b64 v[232:233], v4 offset:17408
ds_read_b64 v[236:237], v4 offset:17416
s_branch L_hx_rd
L_hx_ld:
buffer_load_dwordx4 v[188:191], v10, s[88:91], 0 offen sc1
buffer_load_dwordx2 v[216:217], v10, s[88:91], 0 offen offset:1024 sc1
buffer_load_dwordx2 v[220:221], v10, s[88:91], 0 offen offset:1032 sc1
buffer_load_dwordx4 v[204:207], v11, s[88:91], 0 offen sc1
buffer_load_dwordx2 v[232:233], v11, s[88:91], 0 offen offset:1024 sc1
buffer_load_dwordx2 v[236:237], v11, s[88:91], 0 offen offset:1032 sc1
L_hx_rd:
ds_read_b128 v[196:199], v6 offset:0
ds_read_b64 v[224:225], v6 offset:1024
ds_read_b64 v[228:229], v6 offset:1032
ds_read_b128 v[212:215], v6 offset:16384
ds_read_b64 v[240:241], v6 offset:17408
ds_read_b64 v[244:245], v6 offset:17416
ds_read_b128 a[0:3], v1 offset:8192
ds_read_b128 a[4:7], v1 offset:9216
ds_read_b128 a[8:11], v1 offset:10240
ds_read_b128 a[12:15], v1 offset:11264
ds_read_b128 a[16:19], v1 offset:12288
ds_read_b128 a[20:23], v1 offset:13312
ds_read_b128 a[24:27], v1 offset:14336
ds_read_b128 a[28:31], v1 offset:15360
L_hopB:
s_mov_b32 s95, 0
v_pk_mul_f32 v[40:41], v[40:41], s[52:53]
v_pk_mul_f32 v[42:43], v[42:43], s[52:53]
v_pk_mul_f32 v[44:45], v[44:45], s[52:53]
v_pk_mul_f32 v[46:47], v[46:47], s[52:53]
v_cvt_pk_bf16_f32 v40, v40, v41
v_cvt_pk_bf16_f32 v41, v42, v43
v_cvt_pk_bf16_f32 v42, v44, v45
v_cvt_pk_bf16_f32 v43, v46, v47
v_accvgpr_write_b32 a192, v40
v_accvgpr_write_b32 a193, v41
v_accvgpr_write_b32 a194, v42
v_accvgpr_write_b32 a195, v43
v_pk_mul_f32 v[48:49], v[48:49], s[52:53]
v_pk_mul_f32 v[50:51], v[50:51], s[52:53]
v_pk_mul_f32 v[52:53], v[52:53], s[52:53]
v_pk_mul_f32 v[54:55], v[54:55], s[52:53]
v_cvt_pk_bf16_f32 v48, v48, v49
v_cvt_pk_bf16_f32 v49, v50, v51
v_cvt_pk_bf16_f32 v50, v52, v53
v_cvt_pk_bf16_f32 v51, v54, v55
v_accvgpr_write_b32 a208, v48
v_accvgpr_write_b32 a209, v49
v_accvgpr_write_b32 a210, v50
v_accvgpr_write_b32 a211, v51
v_mov_b32 v47, s55
v_cndmask_b32 v36, v9, 0, s[56:57]
v_min_f32 v32, s55, v36
v_cndmask_b32 v44, v47, 0, s[36:37]
v_cndmask_b32 v37, v9, 0, s[58:59]
v_min_f32 v33, s55, v37
v_cndmask_b32 v45, v47, 0, s[38:39]
v_cndmask_b32 v38, v9, 0, s[60:61]
v_min_f32 v34, s55, v38
v_cndmask_b32 v46, v47, 0, s[40:41]
v_cndmask_b32 v39, v9, 0, s[62:63]
v_min_f32 v35, s55, v39
v_cndmask_b32 v47, v47, 0, s[42:43]
v_pk_mul_f32 v[56:57], v[56:57], s[52:53]
v_pk_mul_f32 v[58:59], v[58:59], s[52:53]
v_pk_mul_f32 v[60:61], v[60:61], s[52:53]
v_pk_mul_f32 v[62:63], v[62:63], s[52:53]
v_cvt_pk_bf16_f32 v56, v56, v57
v_cvt_pk_bf16_f32 v57, v58, v59
v_cvt_pk_bf16_f32 v58, v60, v61
v_cvt_pk_bf16_f32 v59, v62, v63
v_accvgpr_write_b32 a164, v56
v_accvgpr_write_b32 a165, v57
v_accvgpr_write_b32 a166, v58
v_accvgpr_write_b32 a167, v59
v_pk_mul_f32 v[64:65], v[64:65], s[52:53]
v_pk_mul_f32 v[66:67], v[66:67], s[52:53]
v_pk_mul_f32 v[68:69], v[68:69], s[52:53]
v_pk_mul_f32 v[70:71], v[70:71], s[52:53]
v_cvt_pk_bf16_f32 v64, v64, v65
v_cvt_pk_bf16_f32 v65, v66, v67
v_cvt_pk_bf16_f32 v66, v68, v69
v_cvt_pk_bf16_f32 v67, v70, v71
v_accvgpr_write_b32 a180, v64
v_accvgpr_write_b32 a181, v65
v_accvgpr_write_b32 a182, v66
v_accvgpr_write_b32 a183, v67
v_pk_mul_f32 v[72:73], v[72:73], s[52:53]
v_pk_mul_f32 v[74:75], v[74:75], s[52:53]
v_pk_mul_f32 v[76:77], v[76:77], s[52:53]
v_pk_mul_f32 v[78:79], v[78:79], s[52:53]
v_cvt_pk_bf16_f32 v72, v72, v73
v_cvt_pk_bf16_f32 v73, v74, v75
v_cvt_pk_bf16_f32 v74, v76, v77
v_cvt_pk_bf16_f32 v75, v78, v79
v_accvgpr_write_b32 a196, v72
v_accvgpr_write_b32 a197, v73
v_accvgpr_write_b32 a198, v74
v_accvgpr_write_b32 a199, v75
v_pk_mul_f32 v[80:81], v[80:81], s[52:53]
v_pk_mul_f32 v[82:83], v[82:83], s[52:53]
v_pk_mul_f32 v[84:85], v[84:85], s[52:53]
v_pk_mul_f32 v[86:87], v[86:87], s[52:53]
v_cvt_pk_bf16_f32 v80, v80, v81
v_cvt_pk_bf16_f32 v81, v82, v83
v_cvt_pk_bf16_f32 v82, v84, v85
v_cvt_pk_bf16_f32 v83, v86, v87
v_accvgpr_write_b32 a212, v80
v_accvgpr_write_b32 a213, v81
v_accvgpr_write_b32 a214, v82
v_accvgpr_write_b32 a215, v83
v_pk_mul_f32 v[88:89], v[88:89], s[52:53]
v_pk_mul_f32 v[90:91], v[90:91], s[52:53]
v_pk_mul_f32 v[92:93], v[92:93], s[52:53]
v_pk_mul_f32 v[94:95], v[94:95], s[52:53]
v_cvt_pk_bf16_f32 v88, v88, v89
v_cvt_pk_bf16_f32 v89, v90, v91
v_cvt_pk_bf16_f32 v90, v92, v93
v_cvt_pk_bf16_f32 v91, v94, v95
v_accvgpr_write_b32 a168, v88
v_accvgpr_write_b32 a169, v89
v_accvgpr_write_b32 a170, v90
v_accvgpr_write_b32 a171, v91
v_pk_mul_f32 v[96:97], v[96:97], s[52:53]
v_pk_mul_f32 v[98:99], v[98:99], s[52:53]
v_pk_mul_f32 v[100:101], v[100:101], s[52:53]
v_pk_mul_f32 v[102:103], v[102:103], s[52:53]
v_cvt_pk_bf16_f32 v96, v96, v97
v_cvt_pk_bf16_f32 v97, v98, v99
v_cvt_pk_bf16_f32 v98, v100, v101
v_cvt_pk_bf16_f32 v99, v102, v103
v_accvgpr_write_b32 a184, v96
v_accvgpr_write_b32 a185, v97
v_accvgpr_write_b32 a186, v98
v_accvgpr_write_b32 a187, v99
v_pk_mul_f32 v[104:105], v[104:105], s[52:53]
v_pk_mul_f32 v[106:107], v[106:107], s[52:53]
v_pk_mul_f32 v[108:109], v[108:109], s[52:53]
v_pk_mul_f32 v[110:111], v[110:111], s[52:53]
v_cvt_pk_bf16_f32 v104, v104, v105
v_cvt_pk_bf16_f32 v105, v106, v107
v_cvt_pk_bf16_f32 v106, v108, v109
v_cvt_pk_bf16_f32 v107, v110, v111
v_accvgpr_write_b32 a200, v104
v_accvgpr_write_b32 a201, v105
v_accvgpr_write_b32 a202, v106
v_accvgpr_write_b32 a203, v107
v_pk_mul_f32 v[112:113], v[112:113], s[52:53]
v_pk_mul_f32 v[114:115], v[114:115], s[52:53]
v_pk_mul_f32 v[116:117], v[116:117], s[52:53]
v_pk_mul_f32 v[118:119], v[118:119], s[52:53]
v_cvt_pk_bf16_f32 v112, v112, v113
v_cvt_pk_bf16_f32 v113, v114, v115
v_cvt_pk_bf16_f32 v114, v116, v117
v_cvt_pk_bf16_f32 v115, v118, v119
v_accvgpr_write_b32 a216, v112
v_accvgpr_write_b32 a217, v113
v_accvgpr_write_b32 a218, v114
v_accvgpr_write_b32 a219, v115
v_pk_mul_f32 v[120:121], v[120:121], s[52:53]
v_pk_mul_f32 v[122:123], v[122:123], s[52:53]
v_pk_mul_f32 v[124:125], v[124:125], s[52:53]
v_pk_mul_f32 v[126:127], v[126:127], s[52:53]
v_cvt_pk_bf16_f32 v120, v120, v121
v_cvt_pk_bf16_f32 v121, v122, v123
v_cvt_pk_bf16_f32 v122, v124, v125
v_cvt_pk_bf16_f32 v123, v126, v127
v_accvgpr_write_b32 a172, v120
v_accvgpr_write_b32 a173, v121
v_accvgpr_write_b32 a174, v122
v_accvgpr_write_b32 a175, v123
v_pk_mul_f32 v[128:129], v[128:129], s[52:53]
v_pk_mul_f32 v[130:131], v[130:131], s[52:53]
v_pk_mul_f32 v[132:133], v[132:133], s[52:53]
v_pk_mul_f32 v[134:135], v[134:135], s[52:53]
v_cvt_pk_bf16_f32 v128, v128, v129
v_cvt_pk_bf16_f32 v129, v130, v131
v_cvt_pk_bf16_f32 v130, v132, v133
v_cvt_pk_bf16_f32 v131, v134, v135
v_accvgpr_write_b32 a188, v128
v_accvgpr_write_b32 a189, v129
v_accvgpr_write_b32 a190, v130
v_accvgpr_write_b32 a191, v131
v_pk_mul_f32 v[136:137], v[136:137], s[52:53]
v_pk_mul_f32 v[138:139], v[138:139], s[52:53]
v_pk_mul_f32 v[140:141], v[140:141], s[52:53]
v_pk_mul_f32 v[142:143], v[142:143], s[52:53]
v_cvt_pk_bf16_f32 v136, v136, v137
v_cvt_pk_bf16_f32 v137, v138, v139
v_cvt_pk_bf16_f32 v138, v140, v141
v_cvt_pk_bf16_f32 v139, v142, v143
v_accvgpr_write_b32 a204, v136
v_accvgpr_write_b32 a205, v137
v_accvgpr_write_b32 a206, v138
v_accvgpr_write_b32 a207, v139
v_pk_mul_f32 v[144:145], v[144:145], s[52:53]
v_pk_mul_f32 v[146:147], v[146:147], s[52:53]
v_pk_mul_f32 v[148:149], v[148:149], s[52:53]
v_pk_mul_f32 v[150:151], v[150:151], s[52:53]
v_cvt_pk_bf16_f32 v144, v144, v145
v_cvt_pk_bf16_f32 v145, v146, v147
v_cvt_pk_bf16_f32 v146, v148, v149
v_cvt_pk_bf16_f32 v147, v150, v151
v_accvgpr_write_b32 a220, v144
v_accvgpr_write_b32 a221, v145
v_accvgpr_write_b32 a222, v146
v_accvgpr_write_b32 a223, v147
s_cmp_lg_u32 s4, 0
s_cbranch_scc1 L_spun_hx
s_mov_b32 s92, 200000
L_spin_hx:
s_waitcnt vmcnt(0)
v_max3_u32 v128, v188, v189, 0
v_max3_u32 v128, v190, v191, v128
v_max3_u32 v128, v216, v217, v128
v_max3_u32 v128, v220, v221, v128
v_max3_u32 v128, v204, v205, v128
v_max3_u32 v128, v206, v207, v128
v_max3_u32 v128, v232, v233, v128
v_max3_u32 v128, v236, v237, v128
v_cmp_eq_u32 vcc, -1, v128
s_sub_u32 s92, s92, 1
s_cbranch_scc1 L_spun_hx
s_nop 3
s_cbranch_vccz L_spun_hx
s_sleep 2
buffer_load_dwordx4 v[188:191], v10, s[88:91], 0 offen sc1
buffer_load_dwordx2 v[216:217], v10, s[88:91], 0 offen offset:1024 sc1
buffer_load_dwordx2 v[220:221], v10, s[88:91], 0 offen offset:1032 sc1
buffer_load_dwordx4 v[204:207], v11, s[88:91], 0 offen sc1
buffer_load_dwordx2 v[232:233], v11, s[88:91], 0 offen offset:1024 sc1
buffer_load_dwordx2 v[236:237], v11, s[88:91], 0 offen offset:1032 sc1
s_branch L_spin_hx
L_spun_hx:
s_waitcnt lgkmcnt(0)
s_barrier
v_mfma_f32_16x16x32_bf16 v[52:55], v[184:187], v[152:155], v[248:251]
v_mov_b32 v140, 0
v_mov_b32 v141, 0
v_mfma_f32_16x16x32_bf16 v[48:51], v[188:191], v[152:155], v[32:35]
v_mov_b32 v142, 0
v_mov_b32 v143, 0
v_mfma_f32_16x16x32_bf16 v[60:63], v[192:195], v[160:163], v[248:251]
v_mov_b32 v144, 0
v_mov_b32 v145, 0
v_mfma_f32_16x16x32_bf16 v[56:59], v[196:199], v[160:163], v[36:39]
v_mov_b32 v146, 0
v_mov_b32 v147, 0
v_mfma_f32_16x16x32_bf16 v[68:71], v[200:203], v[168:171], v[248:251]
v_mov_b32 v148, 0
v_mov_b32 v149, 0
v_mfma_f32_16x16x32_bf16 v[64:67], v[204:207], v[168:171], v[36:39]
v_max3_f32 v52, v48, v49, v52
v_max3_f32 v54, v50, v51, v54
v_mfma_f32_16x16x32_bf16 v[76:79], v[208:211], v[176:179], v[248:251]
v_max_f32 v52, v52, v53
v_max_f32 v53, v54, v55
v_mfma_f32_16x16x32_bf16 v[72:75], v[212:215], v[176:179], v[36:39]
v_max_f32 v136, v52, v53
v_max3_f32 v60, v56, v57, v60
v_mfma_f32_16x16x32_bf16 v[16:19], a[0:3], a[160:163], v[44:47]
v_max3_f32 v62, v58, v59, v62
v_max_f32 v60, v60, v61
v_mfma_f32_16x16x32_bf16 v[16:19], a[4:7], a[164:167], v[16:19]
v_max_f32 v61, v62, v63
v_max_f32 v137, v60, v61
v_mfma_f32_16x16x32_bf16 v[16:19], a[8:11], a[168:171], v[16:19]
v_max3_f32 v68, v64, v65, v68
v_max3_f32 v70, v66, v67, v70
v_mfma_f32_16x16x32_bf16 v[16:19], a[12:15], a[172:175], v[16:19]
v_max_f32 v68, v68, v69
v_max_f32 v69, v70, v71
v_mfma_f32_16x16x32_bf16 v[20:23], a[0:3], a[176:179], 0
v_max_f32 v138, v68, v69
v_max3_f32 v76, v72, v73, v76
v_mfma_f32_16x16x32_bf16 v[20:23], a[4:7], a[180:183], v[20:23]
v_max3_f32 v78, v74, v75, v78
v_max_f32 v76, v76, v77
v_mfma_f32_16x16x32_bf16 v[20:23], a[8:11], a[184:187], v[20:23]
v_max_f32 v77, v78, v79
v_max_f32 v139, v76, v77
v_mfma_f32_16x16x32_bf16 v[20:23], a[12:15], a[188:191], v[20:23]
v_mov_b32 v150, 0
v_mov_b32 v151, 0
v_mfma_f32_16x16x32_bf16 v[24:27], a[0:3], a[192:195], 0
v_mov_b32 v248, 0
v_mov_b32 v249, 0
v_mfma_f32_16x16x32_bf16 v[24:27], a[4:7], a[196:199], v[24:27]
v_mov_b32 v250, 0
v_mov_b32 v251, 0
v_mfma_f32_16x16x32_bf16 v[24:27], a[8:11], a[200:203], v[24:27]
v_max3_f32 v80, v16, v17, v18
v_max_f32 v80, v80, v19
v_mfma_f32_16x16x32_bf16 v[24:27], a[12:15], a[204:207], v[24:27]
v_max3_f32 v84, v20, v21, v22
v_max_f32 v84, v84, v23
v_mfma_f32_16x16x32_bf16 v[28:31], a[0:3], a[208:211], 0
v_mov_b32 v128, v136
v_mov_b32 v129, v137
v_mfma_f32_16x16x32_bf16 v[28:31], a[4:7], a[212:215], v[28:31]
v_mov_b32 v130, v138
v_mov_b32 v131, v139
v_mfma_f32_16x16x32_bf16 v[28:31], a[8:11], a[216:219], v[28:31]
v_permlane16_swap_b32 v128, v136
v_permlane16_swap_b32 v129, v137
v_mfma_f32_16x16x32_bf16 v[28:31], a[12:15], a[220:223], v[28:31]
v_permlane16_swap_b32 v130, v138
v_permlane16_swap_b32 v131, v139
v_max_f32 v136, v136, v128
v_max_f32 v137, v137, v129
v_max_f32 v138, v138, v130
v_max_f32 v139, v139, v131
v_max3_f32 v88, v24, v25, v26
v_max_f32 v88, v88, v27
v_mov_b32 v128, v136
v_mov_b32 v129, v137
v_mov_b32 v130, v138
v_mov_b32 v131, v139
v_max3_f32 v92, v28, v29, v30
v_max_f32 v92, v92, v31
v_permlane32_swap_b32 v128, v136
v_permlane32_swap_b32 v129, v137
v_permlane32_swap_b32 v130, v138
v_permlane32_swap_b32 v131, v139
v_max_f32 v136, v136, v128
v_max_f32 v137, v137, v129
v_max_f32 v138, v138, v130
v_max_f32 v139, v139, v131
v_mul_f32 v136, s54, v136
v_mul_f32 v137, s54, v137
v_mul_f32 v138, s54, v138
v_mul_f32 v139, s54, v139
v_fma_f32 v52, v52, s54, -v136
v_fma_f32 v53, v53, s54, -v136
v_fma_f32 v60, v60, s54, -v137
v_fma_f32 v61, v61, s54, -v137
v_fma_f32 v68, v68, s54, -v138
v_fma_f32 v69, v69, s54, -v138
v_fma_f32 v76, v76, s54, -v139
v_fma_f32 v77, v77, s54, -v139
v_exp_f32 v52, v52
v_exp_f32 v53, v53
v_exp_f32 v60, v60
v_exp_f32 v61, v61
v_exp_f32 v68, v68
v_exp_f32 v69, v69
v_exp_f32 v76, v76
v_exp_f32 v77, v77
v_cvt_pk_bf16_f32 v52, v52, v52
v_cvt_pk_bf16_f32 v53, v53, v53
v_cvt_pk_bf16_f32 v60, v60, v60
v_cvt_pk_bf16_f32 v61, v61, v61
v_cvt_pk_bf16_f32 v68, v68, v68
v_cvt_pk_bf16_f32 v69, v69, v69
v_cvt_pk_bf16_f32 v76, v76, v76
v_cvt_pk_bf16_f32 v77, v77, v77
v_and_b32 v48, v252, v52
v_and_b32 v49, v253, v53
v_and_b32 v50, v254, v52
v_and_b32 v51, v255, v53
v_and_b32 v56, v252, v60
v_and_b32 v57, v253, v61
v_and_b32 v58, v254, v60
v_and_b32 v59, v255, v61
v_and_b32 v64, v252, v68
v_and_b32 v65, v253, v69
v_and_b32 v66, v254, v68
v_and_b32 v67, v255, v69
v_and_b32 v72, v252, v76
v_and_b32 v73, v253, v77
v_and_b32 v74, v254, v76
v_and_b32 v75, v255, v77
v_mfma_f32_16x16x32_bf16 v[156:159], a[240:243], v[48:51], 0
v_mov_b32 v128, v80
v_mov_b32 v129, v84
v_mfma_f32_16x16x32_bf16 v[164:167], a[240:243], v[56:59], 0
v_mov_b32 v130, v88
v_mov_b32 v131, v92
v_mfma_f32_16x16x32_bf16 v[172:175], a[240:243], v[64:67], 0
v_permlane16_swap_b32 v128, v80
v_permlane16_swap_b32 v129, v84
v_mfma_f32_16x16x32_bf16 v[180:183], a[240:243], v[72:75], 0
v_permlane16_swap_b32 v130, v88
v_permlane16_swap_b32 v131, v92
v_mfma_f32_16x16x32_bf16 v[184:187], v[216:219], v[48:51], 0
v_max_f32 v80, v80, v128
v_max_f32 v84, v84, v129
v_mfma_f32_16x16x32_bf16 v[188:191], v[220:223], v[48:51], 0
v_max_f32 v88, v88, v130
v_max_f32 v92, v92, v131
v_mfma_f32_16x16x32_bf16 v[192:195], v[224:227], v[56:59], 0
v_mov_b32 v128, v80
v_mov_b32 v129, v84
v_mfma_f32_16x16x32_bf16 v[196:199], v[228:231], v[56:59], 0
v_mov_b32 v130, v88
v_mov_b32 v131, v92
v_mfma_f32_16x16x32_bf16 v[200:203], v[232:235], v[64:67], 0
v_permlane32_swap_b32 v128, v80
v_permlane32_swap_b32 v129, v84
v_mfma_f32_16x16x32_bf16 v[204:207], v[236:239], v[64:67], 0
v_permlane32_swap_b32 v130, v88
v_permlane32_swap_b32 v131, v92
v_mfma_f32_16x16x32_bf16 v[208:211], v[240:243], v[72:75], 0
v_max_f32 v80, v80, v128
v_max_f32 v84, v84, v129
v_mfma_f32_16x16x32_bf16 v[212:215], v[244:247], v[72:75], 0
v_max_f32 v88, v88, v130
v_max_f32 v92, v92, v131
v_rcp_f32 v128, v156
v_rcp_f32 v130, v164
v_rcp_f32 v132, v172
v_rcp_f32 v134, v180
v_sub_f32 v83, 0, v80
v_sub_f32 v82, 0, v80
v_sub_f32 v81, 0, v80
v_sub_f32 v80, 0, v80
v_sub_f32 v87, 0, v84
v_sub_f32 v86, 0, v84
v_sub_f32 v85, 0, v84
v_sub_f32 v84, 0, v84
v_sub_f32 v91, 0, v88
v_sub_f32 v90, 0, v88
v_sub_f32 v89, 0, v88
v_sub_f32 v88, 0, v88
v_sub_f32 v95, 0, v92
v_pk_mul_f32 v[184:185], v[184:185], v[128:129] op_sel_hi:[1,0]
v_pk_mul_f32 v[186:187], v[186:187], v[128:129] op_sel_hi:[1,0]
v_pk_mul_f32 v[188:189], v[188:189], v[128:129] op_sel_hi:[1,0]
v_pk_mul_f32 v[190:191], v[190:191], v[128:129] op_sel_hi:[1,0]
v_pk_mul_f32 v[192:193], v[192:193], v[130:131] op_sel_hi:[1,0]
v_pk_mul_f32 v[194:195], v[194:195], v[130:131] op_sel_hi:[1,0]
v_pk_mul_f32 v[196:197], v[196:197], v[130:131] op_sel_hi:[1,0]
v_pk_mul_f32 v[198:199], v[198:199], v[130:131] op_sel_hi:[1,0]
v_pk_mul_f32 v[200:201], v[200:201], v[132:133] op_sel_hi:[1,0]
v_pk_mul_f32 v[202:203], v[202:203], v[132:133] op_sel_hi:[1,0]
v_pk_mul_f32 v[204:205], v[204:205], v[132:133] op_sel_hi:[1,0]
v_pk_mul_f32 v[206:207], v[206:207], v[132:133] op_sel_hi:[1,0]
v_pk_mul_f32 v[208:209], v[208:209], v[134:135] op_sel_hi:[1,0]
v_pk_mul_f32 v[210:211], v[210:211], v[134:135] op_sel_hi:[1,0]
v_pk_mul_f32 v[212:213], v[212:213], v[134:135] op_sel_hi:[1,0]
v_pk_mul_f32 v[214:215], v[214:215], v[134:135] op_sel_hi:[1,0]
v_cvt_pk_bf16_f32 v32, v184, v185
v_cvt_pk_bf16_f32 v33, v186, v187
v_cvt_pk_bf16_f32 v34, v188, v189
v_cvt_pk_bf16_f32 v35, v190, v191
v_cvt_pk_bf16_f32 v36, v192, v193
v_cvt_pk_bf16_f32 v37, v194, v195
v_cvt_pk_bf16_f32 v38, v196, v197
v_cvt_pk_bf16_f32 v39, v198, v199
v_cvt_pk_bf16_f32 v40, v200, v201
v_cvt_pk_bf16_f32 v41, v202, v203
v_cvt_pk_bf16_f32 v42, v204, v205
v_cvt_pk_bf16_f32 v43, v206, v207
v_cvt_pk_bf16_f32 v44, v208, v209
v_cvt_pk_bf16_f32 v45, v210, v211
v_cvt_pk_bf16_f32 v46, v212, v213
v_cvt_pk_bf16_f32 v47, v214, v215
buffer_store_dwordx4 v[32:35], v3, s[88:91], s44 offen sc1
v_sub_f32 v94, 0, v92
v_sub_f32 v93, 0, v92
v_sub_f32 v92, 0, v92
v_min_f32 v103, s10, v80
v_cndmask_b32 v96, v103, v80, s[36:37]
v_cndmask_b32 v97, v103, v80, s[38:39]
v_cndmask_b32 v98, v103, v80, s[40:41]
v_cndmask_b32 v99, v103, v80, s[42:43]
v_cndmask_b32 v100, v9, v103, s[36:37]
v_cndmask_b32 v101, v9, v103, s[38:39]
v_cndmask_b32 v102, v9, v103, s[40:41]
v_cndmask_b32 v103, v9, v103, s[42:43]
v_min_f32 v111, s11, v84
v_cndmask_b32 v104, v111, v84, s[36:37]
v_cndmask_b32 v105, v111, v84, s[38:39]
v_cndmask_b32 v106, v111, v84, s[40:41]
v_cndmask_b32 v107, v111, v84, s[42:43]
v_cndmask_b32 v108, v9, v111, s[36:37]
v_cndmask_b32 v109, v9, v111, s[38:39]
buffer_store_dwordx4 v[36:39], v3, s[88:91], s45 offen sc1
v_cndmask_b32 v110, v9, v111, s[40:41]
v_cndmask_b32 v111, v9, v111, s[42:43]
v_and_b32 v9, 1, v0
v_mul_u32_u24 v9, 0xaaaa, v9
v_add_u32 v9, 0x4444, v9
v_mov_b64 v[128:129], 0
v_mov_b64 v[130:131], 0
v_mov_b64 v[132:133], 0
v_mov_b64 v[134:135], 0
v_mov_b64 v[136:137], 0
v_mov_b64 v[138:139], 0
v_mov_b64 v[152:153], 0
v_mov_b64 v[154:155], 0
v_mov_b64 v[156:157], 0
v_mov_b64 v[158:159], 0
v_mov_b64 v[160:161], 0
v_mov_b64 v[162:163], 0
v_mov_b64 v[164:165], 0
v_mov_b64 v[166:167], 0
buffer_store_dwordx4 v[40:43], v3, s[88:91], s46 offen sc1
v_mov_b64 v[168:169], 0
v_mov_b64 v[170:171], 0
v_mov_b64 v[172:173], 0
v_mov_b64 v[174:175], 0
v_mov_b64 v[176:177], 0
v_mov_b64 v[178:179], 0
v_mov_b64 v[180:181], 0
v_mov_b64 v[182:183], 0
v_mov_b64 v[184:185], 0
v_mov_b64 v[186:187], 0
v_mov_b64 v[188:189], 0
v_mov_b64 v[190:191], 0
v_mov_b64 v[192:193], 0
v_mov_b64 v[194:195], 0
v_mov_b64 v[196:197], 0
v_mov_b64 v[198:199], 0
v_mov_b64 v[200:201], 0
v_mov_b64 v[202:203], 0
v_mov_b64 v[204:205], 0
buffer_store_dwordx4 v[44:47], v3, s[88:91], s47 offen sc1
v_mov_b64 v[206:207], 0
v_mov_b64 v[208:209], 0
v_mov_b64 v[210:211], 0
v_mov_b64 v[212:213], 0
v_mov_b64 v[214:215], 0
v_mov_b64 v[216:217], 0
v_mov_b64 v[218:219], 0
v_mov_b64 v[220:221], 0
v_mov_b64 v[222:223], 0
v_mov_b64 v[224:225], 0
v_mov_b64 v[226:227], 0
v_mov_b64 v[228:229], 0
v_mov_b64 v[230:231], 0
v_mov_b64 v[232:233], 0
v_mov_b64 v[234:235], 0
v_mov_b64 v[236:237], 0
v_mov_b64 v[238:239], 0
v_mov_b64 v[252:253], 0
v_mov_b64 v[254:255], 0
L_att_start:
s_mov_b32 s15, s6
s_cmp_eq_u32 s6, 0
s_cbranch_scc1 L_att_j0
v_mfma_f32_16x16x32_bf16 v[16:19], a[0:3], a[160:163], v[80:83]
ds_read_b128 a[128:131], v1 offset:24576
v_mov_b32 v240, 0
v_mfma_f32_16x16x32_bf16 v[16:19], a[4:7], a[164:167], v[16:19]
ds_read_b128 a[132:135], v1 offset:25600
v_mov_b32 v241, 0
v_mfma_f32_16x16x32_bf16 v[16:19], a[8:11], a[168:171], v[16:19]
ds_read_b128 a[136:139], v1 offset:26624
s_add_u32 m0, s27, 0x0
v_mfma_f32_16x16x32_bf16 v[16:19], a[12:15], a[172:175], v[16:19]
buffer_load_dwordx4 v3, s[48:51], s32 offen offset:0 sc1 lds
v_mfma_f32_16x16x32_bf16 v[20:23], a[0:3], a[176:179], v[84:87]
ds_read_b128 a[140:143], v1 offset:27648
v_mov_b32 v242, 0
v_mfma_f32_16x16x32_bf16 v[20:23], a[4:7], a[180:183], v[20:23]
ds_read_b128 a[144:147], v1 offset:28672
v_mov_b32 v243, 0
v_mfma_f32_16x16x32_bf16 v[20:23], a[8:11], a[184:187], v[20:23]
ds_read_b128 a[148:151], v1 offset:29696
v_mov_b32 v244, 0
v_mfma_f32_16x16x32_bf16 v[20:23], a[12:15], a[188:191], v[20:23]
ds_read_b128 a[152:155], v1 offset:30720
v_mov_b32 v245, 0
v_mfma_f32_16x16x32_bf16 v[24:27], a[0:3], a[192:195], v[88:91]
ds_read_b128 a[156:159], v1 offset:31744
v_exp_f32 v16, v16
v_mfma_f32_16x16x32_bf16 v[24:27], a[4:7], a[196:199], v[24:27]
v_exp_f32 v17, v17
v_mfma_f32_16x16x32_bf16 v[24:27], a[8:11], a[200:203], v[24:27]
buffer_load_dwordx4 v3, s[48:51], s32 offen offset:1024 sc1 lds
v_mfma_f32_16x16x32_bf16 v[24:27], a[12:15], a[204:207], v[24:27]
v_exp_f32 v18, v18
v_mfma_f32_16x16x32_bf16 v[28:31], a[0:3], a[208:211], v[92:95]
v_exp_f32 v19, v19
v_mfma_f32_16x16x32_bf16 v[28:31], a[4:7], a[212:215], v[28:31]
v_exp_f32 v20, v20
v_mfma_f32_16x16x32_bf16 v[28:31], a[8:11], a[216:219], v[28:31]
v_cvt_pk_bf16_f32 v48, v16, v17
v_cvt_pk_bf16_f32 v49, v18, v19
v_mfma_f32_16x16x32_bf16 v[28:31], a[12:15], a[220:223], v[28:31]
v_exp_f32 v21, v21
v_mfma_f32_16x16x32_bf16 v[32:35], a[16:19], a[160:163], v[80:83]
v_exp_f32 v22, v22
v_mfma_f32_16x16x32_bf16 v[32:35], a[20:23], a[164:167], v[32:35]
v_exp_f32 v23, v23
v_mfma_f32_16x16x32_bf16 v[32:35], a[24:27], a[168:171], v[32:35]
buffer_load_dwordx4 v3, s[48:51], s32 offen offset:2048 sc1 lds
v_mfma_f32_16x16x32_bf16 v[32:35], a[28:31], a[172:175], v[32:35]
v_exp_f32 v24, v24
v_mfma_f32_16x16x32_bf16 v[36:39], a[16:19], a[176:179], v[84:87]
v_exp_f32 v25, v25
v_mfma_f32_16x16x32_bf16 v[36:39], a[20:23], a[180:183], v[36:39]
v_cvt_pk_bf16_f32 v52, v20, v21
v_cvt_pk_bf16_f32 v53, v22, v23
v_mfma_f32_16x16x32_bf16 v[36:39], a[24:27], a[184:187], v[36:39]
v_exp_f32 v26, v26
v_mfma_f32_16x16x32_bf16 v[36:39], a[28:31], a[188:191], v[36:39]
v_exp_f32 v27, v27
v_mfma_f32_16x16x32_bf16 v[40:43], a[16:19], a[192:195], v[88:91]
v_exp_f32 v28, v28
v_mfma_f32_16x16x32_bf16 v[40:43], a[20:23], a[196:199], v[40:43]
buffer_load_dwordx4 v3, s[48:51], s32 offen offset:3072 sc1 lds
v_mfma_f32_16x16x32_bf16 v[40:43], a[24:27], a[200:203], v[40:43]
s_add_u32 s32, s32, 0x8000
v_exp_f32 v29, v29
v_mfma_f32_16x16x32_bf16 v[40:43], a[28:31], a[204:207], v[40:43]
v_exp_f32 v30, v30
v_mfma_f32_16x16x32_bf16 v[44:47], a[16:19], a[208:211], v[92:95]
v_exp_f32 v31, v31
v_mfma_f32_16x16x32_bf16 v[44:47], a[20:23], a[212:215], v[44:47]
v_exp_f32 v32, v32
v_mfma_f32_16x16x32_bf16 v[44:47], a[24:27], a[216:219], v[44:47]
v_exp_f32 v33, v33
v_mfma_f32_16x16x32_bf16 v[44:47], a[28:31], a[220:223], v[44:47]
s_waitcnt lgkmcnt(0)
v_cvt_pk_bf16_f32 v56, v24, v25
v_cvt_pk_bf16_f32 v57, v26, v27
v_mov_b32 v246, 0
v_mov_b32 v247, 0
v_mfma_f32_16x16x32_bf16 v[16:19], a[128:131], a[160:163], v[80:83]
ds_read_b128 a[32:35], v1 offset:16384
v_cvt_pk_bf16_f32 v60, v28, v29
v_mfma_f32_16x16x32_bf16 v[16:19], a[132:135], a[164:167], v[16:19]
v_exp_f32 v34, v34
v_mfma_f32_16x16x32_bf16 v[16:19], a[136:139], a[168:171], v[16:19]
s_add_u32 m0, s27, 0x1000
v_exp_f32 v35, v35
v_mfma_f32_16x16x32_bf16 v[16:19], a[140:143], a[172:175], v[16:19]
buffer_load_dwordx4 v3, s[48:51], s7 offen offset:0 sc1 lds
v_mfma_f32_16x16x32_bf16 v[20:23], a[128:131], a[176:179], v[84:87]
ds_read_b128 a[36:39], v1 offset:17408
v_cvt_pk_bf16_f32 v61, v30, v31
v_mfma_f32_16x16x32_bf16 v[20:23], a[132:135], a[180:183], v[20:23]
v_exp_f32 v36, v36
v_mfma_f32_16x16x32_bf16 v[20:23], a[136:139], a[184:187], v[20:23]
ds_read_b128 a[40:43], v1 offset:18432
v_cvt_pk_bf16_f32 v50, v32, v33
v_mfma_f32_16x16x32_bf16 v[20:23], a[140:143], a[188:191], v[20:23]
v_exp_f32 v37, v37
v_mfma_f32_16x16x32_bf16 v[24:27], a[128:131], a[192:195], v[88:91]
v_exp_f32 v38, v38
v_mfma_f32_16x16x32_bf16 v[24:27], a[132:135], a[196:199], v[24:27]
ds_read_b128 a[44:47], v1 offset:19456
v_cvt_pk_bf16_f32 v51, v34, v35
v_mfma_f32_16x16x32_bf16 v[24:27], a[136:139], a[200:203], v[24:27]
buffer_load_dwordx4 v3, s[48:51], s7 offen offset:1024 sc1 lds
v_mfma_f32_16x16x32_bf16 v[24:27], a[140:143], a[204:207], v[24:27]
v_exp_f32 v39, v39
v_mfma_f32_16x16x32_bf16 v[28:31], a[128:131], a[208:211], v[92:95]
v_exp_f32 v40, v40
v_mfma_f32_16x16x32_bf16 v[28:31], a[132:135], a[212:215], v[28:31]
ds_read_b128 a[48:51], v1 offset:20480
v_cvt_pk_bf16_f32 v54, v36, v37
v_mfma_f32_16x16x32_bf16 v[28:31], a[136:139], a[216:219], v[28:31]
v_exp_f32 v41, v41
v_mfma_f32_16x16x32_bf16 v[28:31], a[140:143], a[220:223], v[28:31]
v_exp_f32 v42, v42
v_mfma_f32_16x16x32_bf16 v[32:35], a[144:147], a[160:163], v[80:83]
buffer_load_dwordx4 v3, s[48:51], s7 offen offset:2048 sc1 lds
v_mfma_f32_16x16x32_bf16 v[32:35], a[148:151], a[164:167], v[32:35]
ds_read_b128 a[52:55], v1 offset:21504
v_cvt_pk_bf16_f32 v55, v38, v39
v_mfma_f32_16x16x32_bf16 v[32:35], a[152:155], a[168:171], v[32:35]
v_exp_f32 v43, v43
v_mfma_f32_16x16x32_bf16 v[32:35], a[156:159], a[172:175], v[32:35]
ds_read_b128 a[56:59], v1 offset:22528
v_cvt_pk_bf16_f32 v58, v40, v41
v_mfma_f32_16x16x32_bf16 v[36:39], a[144:147], a[176:179], v[84:87]
v_exp_f32 v44, v44
v_mfma_f32_16x16x32_bf16 v[36:39], a[148:151], a[180:183], v[36:39]
v_exp_f32 v45, v45
v_mfma_f32_16x16x32_bf16 v[36:39], a[152:155], a[184:187], v[36:39]
ds_read_b128 a[60:63], v1 offset:23552
v_xor_b32 v1, 0x8000, v1
v_mfma_f32_16x16x32_bf16 v[36:39], a[156:159], a[188:191], v[36:39]
buffer_load_dwordx4 v3, s[48:51], s7 offen offset:3072 sc1 lds
v_cvt_pk_bf16_f32 v59, v42, v43
v_mfma_f32_16x16x32_bf16 v[40:43], a[144:147], a[192:195], v[88:91]
s_add_u32 s7, s7, 0x8000
v_exp_f32 v46, v46
v_mfma_f32_16x16x32_bf16 v[40:43], a[148:151], a[196:199], v[40:43]
s_xor_b32 s27, s27, 0x38000
v_exp_f32 v47, v47
v_mfma_f32_16x16x32_bf16 v[40:43], a[152:155], a[200:203], v[40:43]
v_exp_f32 v16, v16
v_mfma_f32_16x16x32_bf16 v[40:43], a[156:159], a[204:207], v[40:43]
v_exp_f32 v17, v17
v_cvt_pk_bf16_f32 v62, v44, v45
v_cvt_pk_bf16_f32 v63, v46, v47
v_mfma_f32_16x16x32_bf16 v[44:47], a[144:147], a[208:211], v[92:95]
v_exp_f32 v18, v18
v_mfma_f32_16x16x32_bf16 v[44:47], a[148:151], a[212:215], v[44:47]
v_exp_f32 v19, v19
v_mfma_f32_16x16x32_bf16 v[44:47], a[152:155], a[216:219], v[44:47]
s_waitcnt vmcnt(8) lgkmcnt(0)
v_exp_f32 v20, v20
v_mfma_f32_16x16x32_bf16 v[44:47], a[156:159], a[220:223], v[44:47]
s_barrier
v_cvt_pk_bf16_f32 v64, v16, v17
v_exp_f32 v21, v21
v_exp_f32 v22, v22
v_exp_f32 v23, v23
v_exp_f32 v24, v24
v_exp_f32 v25, v25
v_exp_f32 v26, v26
v_exp_f32 v27, v27
v_cvt_pk_bf16_f32 v65, v18, v19
v_cvt_pk_bf16_f32 v68, v20, v21
v_cvt_pk_bf16_f32 v69, v22, v23
s_cmp_lg_u32 s33, 0
s_cbranch_scc1 L_sig_bd
s_lshl_b32 s8, s6, 2
s_add_u32 s8, s8, 192
s_cmp_lg_u32 s4, 0
s_cbranch_scc1 L_sig_bd
v_mov_b32 v4, 1
s_mov_b64 exec, 1
buffer_atomic_add v4, off, s[84:87], s8 sc1
s_mov_b64 exec, -1
L_sig_bd:
s_getreg_b32 s8, hwreg(HW_REG_HW_ID, 5, 1)
s_cmp_lg_u32 s8, 0
s_cbranch_scc1 L_att_dodd1
s_branch L_att_dodd0
L_att_deven0:
v_mfma_f32_16x16x32_bf16 v[128:131], a[32:35], v[48:51], v[128:131]
ds_read_b128 a[0:3], v1 offset:8192
v_cvt_pk_bf16_f32 v72, v24, v25
v_mfma_f32_16x16x32_bf16 v[160:163], a[32:35], v[52:55], v[160:163]
v_exp_f32 v28, v28
v_mfma_f32_16x16x32_bf16 v[192:195], a[32:35], v[56:59], v[192:195]
v_cvt_pk_bf16_f32 v73, v26, v27
v_mfma_f32_16x16x32_bf16 v[224:227], a[32:35], v[60:63], v[224:227]
ds_read_b128 a[4:7], v1 offset:9216
v_mfma_f32_16x16x32_bf16 v[228:231], a[36:39], v[60:63], v[228:231]
v_exp_f32 v29, v29
v_mfma_f32_16x16x32_bf16 v[196:199], a[36:39], v[56:59], v[196:199]
v_exp_f32 v30, v30
v_mfma_f32_16x16x32_bf16 v[164:167], a[36:39], v[52:55], v[164:167]
s_add_u32 m0, s27, 0x0
v_cvt_pk_bf16_f32 v76, v28, v29
v_mfma_f32_16x16x32_bf16 v[132:135], a[36:39], v[48:51], v[132:135]
buffer_load_dwordx4 v3, s[48:51], s32 offen offset:0 sc1 lds
v_mfma_f32_16x16x32_bf16 v[136:139], a[40:43], v[48:51], v[136:139]
ds_read_b128 a[8:11], v1 offset:10240
v_mfma_f32_16x16x32_bf16 v[168:171], a[40:43], v[52:55], v[168:171]
v_exp_f32 v31, v31
v_mfma_f32_16x16x32_bf16 v[200:203], a[40:43], v[56:59], v[200:203]
v_exp_f32 v32, v32
v_mfma_f32_16x16x32_bf16 v[232:235], a[40:43], v[60:63], v[232:235]
ds_read_b128 a[12:15], v1 offset:11264
v_cvt_pk_bf16_f32 v77, v30, v31
v_mfma_f32_16x16x32_bf16 v[236:239], a[44:47], v[60:63], v[236:239]
v_mfma_f32_16x16x32_bf16 v[204:207], a[44:47], v[56:59], v[204:207]
v_exp_f32 v33, v33
v_mfma_f32_16x16x32_bf16 v[172:175], a[44:47], v[52:55], v[172:175]
v_exp_f32 v34, v34
v_mfma_f32_16x16x32_bf16 v[140:143], a[44:47], v[48:51], v[140:143]
ds_read_b128 a[16:19], v1 offset:12288
v_cvt_pk_bf16_f32 v66, v32, v33
v_mfma_f32_16x16x32_bf16 v[144:147], a[48:51], v[48:51], v[144:147]
v_mfma_f32_16x16x32_bf16 v[176:179], a[48:51], v[52:55], v[176:179]
v_exp_f32 v35, v35
v_mfma_f32_16x16x32_bf16 v[208:211], a[48:51], v[56:59], v[208:211]
v_exp_f32 v36, v36
v_mfma_f32_16x16x32_bf16 v[240:243], a[48:51], v[60:63], v[240:243]
ds_read_b128 a[20:23], v1 offset:13312
v_cvt_pk_bf16_f32 v67, v34, v35
v_mfma_f32_16x16x32_bf16 v[244:247], a[52:55], v[60:63], v[244:247]
v_exp_f32 v37, v37
v_mfma_f32_16x16x32_bf16 v[212:215], a[52:55], v[56:59], v[212:215]
v_cvt_pk_bf16_f32 v70, v36, v37
v_mfma_f32_16x16x32_bf16 v[180:183], a[52:55], v[52:55], v[180:183]
ds_read_b128 a[24:27], v1 offset:14336
v_mfma_f32_16x16x32_bf16 v[148:151], a[52:55], v[48:51], v[148:151]
buffer_load_dwordx4 v3, s[48:51], s32 offen offset:1024 sc1 lds
v_mfma_f32_16x16x32_bf16 v[152:155], a[56:59], v[48:51], v[152:155]
v_exp_f32 v38, v38
v_mfma_f32_16x16x32_bf16 v[184:187], a[56:59], v[52:55], v[184:187]
v_exp_f32 v39, v39
v_mfma_f32_16x16x32_bf16 v[216:219], a[56:59], v[56:59], v[216:219]
ds_read_b128 a[28:31], v1 offset:15360
v_cvt_pk_bf16_f32 v71, v38, v39
v_mfma_f32_16x16x32_bf16 v[248:251], a[56:59], v[60:63], v[248:251]
v_mfma_f32_16x16x32_bf16 v[252:255], a[60:63], v[60:63], v[252:255]
v_exp_f32 v40, v40
v_mfma_f32_16x16x32_bf16 v[220:223], a[60:63], v[56:59], v[220:223]
v_exp_f32 v41, v41
v_mfma_f32_16x16x32_bf16 v[188:191], a[60:63], v[52:55], v[188:191]
ds_read_b128 a[32:35], v1 offset:0
v_cvt_pk_bf16_f32 v74, v40, v41
v_mfma_f32_16x16x32_bf16 v[156:159], a[60:63], v[48:51], v[156:159]
v_smfmac_f32_16x16x64_bf16 a[224:227], a[232:235], v[48:55], v9
v_exp_f32 v42, v42
v_smfmac_f32_16x16x64_bf16 a[228:231], a[232:235], v[56:63], v9
s_waitcnt lgkmcnt(5)
v_exp_f32 v43, v43
v_mfma_f32_16x16x32_bf16 v[16:19], a[0:3], a[160:163], v[80:83]
ds_read_b128 a[36:39], v1 offset:1024
v_cvt_pk_bf16_f32 v75, v42, v43
v_mfma_f32_16x16x32_bf16 v[16:19], a[4:7], a[164:167], v[16:19]
v_exp_f32 v44, v44
v_mfma_f32_16x16x32_bf16 v[16:19], a[8:11], a[168:171], v[16:19]
v_mfma_f32_16x16x32_bf16 v[16:19], a[12:15], a[172:175], v[16:19]
v_exp_f32 v45, v45
v_mfma_f32_16x16x32_bf16 v[20:23], a[0:3], a[176:179], v[84:87]
ds_read_b128 a[40:43], v1 offset:2048
v_cvt_pk_bf16_f32 v78, v44, v45
v_mfma_f32_16x16x32_bf16 v[20:23], a[4:7], a[180:183], v[20:23]
buffer_load_dwordx4 v3, s[48:51], s32 offen offset:2048 sc1 lds
v_mfma_f32_16x16x32_bf16 v[20:23], a[8:11], a[184:187], v[20:23]
v_exp_f32 v46, v46
v_mfma_f32_16x16x32_bf16 v[20:23], a[12:15], a[188:191], v[20:23]
ds_read_b128 a[44:47], v1 offset:3072
v_mfma_f32_16x16x32_bf16 v[24:27], a[0:3], a[192:195], v[88:91]
v_mfma_f32_16x16x32_bf16 v[24:27], a[4:7], a[196:199], v[24:27]
v_exp_f32 v47, v47
v_mfma_f32_16x16x32_bf16 v[24:27], a[8:11], a[200:203], v[24:27]
v_exp_f32 v16, v16
v_mfma_f32_16x16x32_bf16 v[24:27], a[12:15], a[204:207], v[24:27]
ds_read_b128 a[48:51], v1 offset:4096
v_cvt_pk_bf16_f32 v79, v46, v47
v_mfma_f32_16x16x32_bf16 v[28:31], a[0:3], a[208:211], v[92:95]
v_mfma_f32_16x16x32_bf16 v[28:31], a[4:7], a[212:215], v[28:31]
v_exp_f32 v17, v17
v_mfma_f32_16x16x32_bf16 v[28:31], a[8:11], a[216:219], v[28:31]
s_waitcnt lgkmcnt(5)
v_exp_f32 v18, v18
v_mfma_f32_16x16x32_bf16 v[28:31], a[12:15], a[220:223], v[28:31]
ds_read_b128 a[52:55], v1 offset:5120
v_cvt_pk_bf16_f32 v48, v16, v17
v_mfma_f32_16x16x32_bf16 v[32:35], a[16:19], a[160:163], v[80:83]
v_mfma_f32_16x16x32_bf16 v[32:35], a[20:23], a[164:167], v[32:35]
v_exp_f32 v19, v19
v_mfma_f32_16x16x32_bf16 v[32:35], a[24:27], a[168:171], v[32:35]
v_exp_f32 v20, v20
v_mfma_f32_16x16x32_bf16 v[32:35], a[28:31], a[172:175], v[32:35]
ds_read_b128 a[56:59], v1 offset:6144
v_cvt_pk_bf16_f32 v49, v18, v19
v_mfma_f32_16x16x32_bf16 v[36:39], a[16:19], a[176:179], v[84:87]
v_exp_f32 v21, v21
v_mfma_f32_16x16x32_bf16 v[36:39], a[20:23], a[180:183], v[36:39]
buffer_load_dwordx4 v3, s[48:51], s32 offen offset:3072 sc1 lds
v_mfma_f32_16x16x32_bf16 v[36:39], a[24:27], a[184:187], v[36:39]
s_add_u32 s32, s32, 0x8000
v_cvt_pk_bf16_f32 v52, v20, v21
v_mfma_f32_16x16x32_bf16 v[36:39], a[28:31], a[188:191], v[36:39]
ds_read_b128 a[60:63], v1 offset:7168
v_mfma_f32_16x16x32_bf16 v[40:43], a[16:19], a[192:195], v[88:91]
v_exp_f32 v22, v22
v_mfma_f32_16x16x32_bf16 v[40:43], a[20:23], a[196:199], v[40:43]
v_exp_f32 v23, v23
v_mfma_f32_16x16x32_bf16 v[40:43], a[24:27], a[200:203], v[40:43]
v_cvt_pk_bf16_f32 v53, v22, v23
v_mfma_f32_16x16x32_bf16 v[40:43], a[28:31], a[204:207], v[40:43]
v_exp_f32 v24, v24
v_mfma_f32_16x16x32_bf16 v[44:47], a[16:19], a[208:211], v[92:95]
v_exp_f32 v25, v25
v_mfma_f32_16x16x32_bf16 v[44:47], a[20:23], a[212:215], v[44:47]
v_exp_f32 v26, v26
v_mfma_f32_16x16x32_bf16 v[44:47], a[24:27], a[216:219], v[44:47]
v_exp_f32 v27, v27
v_mfma_f32_16x16x32_bf16 v[44:47], a[28:31], a[220:223], v[44:47]
s_waitcnt lgkmcnt(0)
v_mfma_f32_16x16x32_bf16 v[128:131], a[32:35], v[64:67], v[128:131]
ds_read_b128 a[0:3], v1 offset:24576
v_cvt_pk_bf16_f32 v56, v24, v25
v_mfma_f32_16x16x32_bf16 v[160:163], a[32:35], v[68:71], v[160:163]
v_exp_f32 v28, v28
v_mfma_f32_16x16x32_bf16 v[192:195], a[32:35], v[72:75], v[192:195]
v_cvt_pk_bf16_f32 v57, v26, v27
v_mfma_f32_16x16x32_bf16 v[224:227], a[32:35], v[76:79], v[224:227]
ds_read_b128 a[4:7], v1 offset:25600
v_mfma_f32_16x16x32_bf16 v[228:231], a[36:39], v[76:79], v[228:231]
v_exp_f32 v29, v29
v_mfma_f32_16x16x32_bf16 v[196:199], a[36:39], v[72:75], v[196:199]
v_exp_f32 v30, v30
v_mfma_f32_16x16x32_bf16 v[164:167], a[36:39], v[68:71], v[164:167]
s_add_u32 m0, s27, 0x1000
v_cvt_pk_bf16_f32 v60, v28, v29
v_mfma_f32_16x16x32_bf16 v[132:135], a[36:39], v[64:67], v[132:135]
buffer_load_dwordx4 v3, s[48:51], s7 offen offset:0 sc1 lds
v_mfma_f32_16x16x32_bf16 v[136:139], a[40:43], v[64:67], v[136:139]
ds_read_b128 a[8:11], v1 offset:26624
v_mfma_f32_16x16x32_bf16 v[168:171], a[40:43], v[68:71], v[168:171]
v_exp_f32 v31, v31
v_mfma_f32_16x16x32_bf16 v[200:203], a[40:43], v[72:75], v[200:203]
v_exp_f32 v32, v32
v_mfma_f32_16x16x32_bf16 v[232:235], a[40:43], v[76:79], v[232:235]
ds_read_b128 a[12:15], v1 offset:27648
v_cvt_pk_bf16_f32 v61, v30, v31
v_mfma_f32_16x16x32_bf16 v[236:239], a[44:47], v[76:79], v[236:239]
v_mfma_f32_16x16x32_bf16 v[204:207], a[44:47], v[72:75], v[204:207]
v_exp_f32 v33, v33
v_mfma_f32_16x16x32_bf16 v[172:175], a[44:47], v[68:71], v[172:175]
v_exp_f32 v34, v34
v_mfma_f32_16x16x32_bf16 v[140:143], a[44:47], v[64:67], v[140:143]
ds_read_b128 a[16:19], v1 offset:28672
v_cvt_pk_bf16_f32 v50, v32, v33
v_mfma_f32_16x16x32_bf16 v[144:147], a[48:51], v[64:67], v[144:147]
v_mfma_f32_16x16x32_bf16 v[176:179], a[48:51], v[68:71], v[176:179]
v_exp_f32 v35, v35
v_mfma_f32_16x16x32_bf16 v[208:211], a[48:51], v[72:75], v[208:211]
ds_read_b128 a[20:23], v1 offset:29696
v_cvt_pk_bf16_f32 v51, v34, v35
v_mfma_f32_16x16x32_bf16 v[240:243], a[48:51], v[76:79], v[240:243]
v_exp_f32 v36, v36
v_mfma_f32_16x16x32_bf16 v[244:247], a[52:55], v[76:79], v[244:247]
v_exp_f32 v37, v37
v_mfma_f32_16x16x32_bf16 v[212:215], a[52:55], v[72:75], v[212:215]
v_cvt_pk_bf16_f32 v54, v36, v37
v_mfma_f32_16x16x32_bf16 v[180:183], a[52:55], v[68:71], v[180:183]
buffer_load_dwordx4 v3, s[48:51], s7 offen offset:1024 sc1 lds
v_mfma_f32_16x16x32_bf16 v[148:151], a[52:55], v[64:67], v[148:151]
ds_read_b128 a[24:27], v1 offset:30720
v_mfma_f32_16x16x32_bf16 v[152:155], a[56:59], v[64:67], v[152:155]
v_exp_f32 v38, v38
v_mfma_f32_16x16x32_bf16 v[184:187], a[56:59], v[68:71], v[184:187]
v_exp_f32 v39, v39
v_mfma_f32_16x16x32_bf16 v[216:219], a[56:59], v[72:75], v[216:219]
ds_read_b128 a[28:31], v1 offset:31744
v_cvt_pk_bf16_f32 v55, v38, v39
v_mfma_f32_16x16x32_bf16 v[248:251], a[56:59], v[76:79], v[248:251]
v_mfma_f32_16x16x32_bf16 v[252:255], a[60:63], v[76:79], v[252:255]
v_exp_f32 v40, v40
v_mfma_f32_16x16x32_bf16 v[220:223], a[60:63], v[72:75], v[220:223]
v_exp_f32 v41, v41
v_mfma_f32_16x16x32_bf16 v[188:191], a[60:63], v[68:71], v[188:191]
ds_read_b128 a[32:35], v1 offset:16384
v_cvt_pk_bf16_f32 v58, v40, v41
v_mfma_f32_16x16x32_bf16 v[156:159], a[60:63], v[64:67], v[156:159]
v_smfmac_f32_16x16x64_bf16 a[224:227], a[232:235], v[64:71], v9
s_waitcnt lgkmcnt(5)
v_exp_f32 v42, v42
v_smfmac_f32_16x16x64_bf16 a[228:231], a[232:235], v[72:79], v9
ds_read_b128 a[36:39], v1 offset:17408
v_mfma_f32_16x16x32_bf16 v[16:19], a[0:3], a[160:163], v[80:83]
v_exp_f32 v43, v43
v_mfma_f32_16x16x32_bf16 v[16:19], a[4:7], a[164:167], v[16:19]
v_exp_f32 v44, v44
v_mfma_f32_16x16x32_bf16 v[16:19], a[8:11], a[168:171], v[16:19]
v_cvt_pk_bf16_f32 v59, v42, v43
v_mfma_f32_16x16x32_bf16 v[16:19], a[12:15], a[172:175], v[16:19]
ds_read_b128 a[40:43], v1 offset:18432
v_mfma_f32_16x16x32_bf16 v[20:23], a[0:3], a[176:179], v[84:87]
buffer_load_dwordx4 v3, s[48:51], s7 offen offset:2048 sc1 lds
v_mfma_f32_16x16x32_bf16 v[20:23], a[4:7], a[180:183], v[20:23]
v_exp_f32 v45, v45
v_mfma_f32_16x16x32_bf16 v[20:23], a[8:11], a[184:187], v[20:23]
v_exp_f32 v46, v46
v_mfma_f32_16x16x32_bf16 v[20:23], a[12:15], a[188:191], v[20:23]
ds_read_b128 a[44:47], v1 offset:19456
v_cvt_pk_bf16_f32 v62, v44, v45
v_mfma_f32_16x16x32_bf16 v[24:27], a[0:3], a[192:195], v[88:91]
v_mfma_f32_16x16x32_bf16 v[24:27], a[4:7], a[196:199], v[24:27]
v_exp_f32 v47, v47
v_mfma_f32_16x16x32_bf16 v[24:27], a[8:11], a[200:203], v[24:27]
v_exp_f32 v16, v16
v_mfma_f32_16x16x32_bf16 v[24:27], a[12:15], a[204:207], v[24:27]
ds_read_b128 a[48:51], v1 offset:20480
v_cvt_pk_bf16_f32 v63, v46, v47
v_mfma_f32_16x16x32_bf16 v[28:31], a[0:3], a[208:211], v[92:95]
v_mfma_f32_16x16x32_bf16 v[28:31], a[4:7], a[212:215], v[28:31]
v_exp_f32 v17, v17
v_mfma_f32_16x16x32_bf16 v[28:31], a[8:11], a[216:219], v[28:31]
ds_read_b128 a[52:55], v1 offset:21504
v_cvt_pk_bf16_f32 v64, v16, v17
v_mfma_f32_16x16x32_bf16 v[28:31], a[12:15], a[220:223], v[28:31]
s_waitcnt lgkmcnt(6)
v_exp_f32 v18, v18
v_mfma_f32_16x16x32_bf16 v[32:35], a[16:19], a[160:163], v[80:83]
v_mfma_f32_16x16x32_bf16 v[32:35], a[20:23], a[164:167], v[32:35]
v_exp_f32 v19, v19
v_mfma_f32_16x16x32_bf16 v[32:35], a[24:27], a[168:171], v[32:35]
ds_read_b128 a[56:59], v1 offset:22528
v_cvt_pk_bf16_f32 v65, v18, v19
v_mfma_f32_16x16x32_bf16 v[32:35], a[28:31], a[172:175], v[32:35]
buffer_load_dwordx4 v3, s[48:51], s7 offen offset:3072 sc1 lds
v_mfma_f32_16x16x32_bf16 v[36:39], a[16:19], a[176:179], v[84:87]
s_add_u32 s7, s7, 0x8000
v_exp_f32 v20, v20
v_mfma_f32_16x16x32_bf16 v[36:39], a[20:23], a[180:183], v[36:39]
s_xor_b32 s27, s27, 0x38000
v_exp_f32 v21, v21
v_mfma_f32_16x16x32_bf16 v[36:39], a[24:27], a[184:187], v[36:39]
ds_read_b128 a[60:63], v1 offset:23552
v_xor_b32 v1, 0x8000, v1
v_mfma_f32_16x16x32_bf16 v[36:39], a[28:31], a[188:191], v[36:39]
v_cvt_pk_bf16_f32 v68, v20, v21
v_mfma_f32_16x16x32_bf16 v[40:43], a[16:19], a[192:195], v[88:91]
v_exp_f32 v22, v22
v_mfma_f32_16x16x32_bf16 v[40:43], a[20:23], a[196:199], v[40:43]
v_exp_f32 v23, v23
v_mfma_f32_16x16x32_bf16 v[40:43], a[24:27], a[200:203], v[40:43]
v_cvt_pk_bf16_f32 v69, v22, v23
v_mfma_f32_16x16x32_bf16 v[40:43], a[28:31], a[204:207], v[40:43]
v_exp_f32 v24, v24
v_mfma_f32_16x16x32_bf16 v[44:47], a[16:19], a[208:211], v[92:95]
v_exp_f32 v25, v25
v_mfma_f32_16x16x32_bf16 v[44:47], a[20:23], a[212:215], v[44:47]
v_exp_f32 v26, v26
v_mfma_f32_16x16x32_bf16 v[44:47], a[24:27], a[216:219], v[44:47]
s_waitcnt vmcnt(16) lgkmcnt(0)
v_exp_f32 v27, v27
v_mfma_f32_16x16x32_bf16 v[44:47], a[28:31], a[220:223], v[44:47]
s_barrier
L_att_dodd0:
v_mfma_f32_16x16x32_bf16 v[128:131], a[32:35], v[48:51], v[128:131]
ds_read_b128 a[0:3], v2 offset:8192
v_cvt_pk_bf16_f32 v72, v24, v25
v_mfma_f32_16x16x32_bf16 v[160:163], a[32:35], v[52:55], v[160:163]
v_exp_f32 v28, v28
v_mfma_f32_16x16x32_bf16 v[192:195], a[32:35], v[56:59], v[192:195]
v_cvt_pk_bf16_f32 v73, v26, v27
v_mfma_f32_16x16x32_bf16 v[224:227], a[32:35], v[60:63], v[224:227]
ds_read_b128 a[4:7], v2 offset:9216
v_mfma_f32_16x16x32_bf16 v[228:231], a[36:39], v[60:63], v[228:231]
v_exp_f32 v29, v29
v_mfma_f32_16x16x32_bf16 v[196:199], a[36:39], v[56:59], v[196:199]
v_exp_f32 v30, v30
v_mfma_f32_16x16x32_bf16 v[164:167], a[36:39], v[52:55], v[164:167]
s_add_u32 m0, s19, 0x0
v_cvt_pk_bf16_f32 v76, v28, v29
v_mfma_f32_16x16x32_bf16 v[132:135], a[36:39], v[48:51], v[132:135]
buffer_load_dwordx4 v3, s[48:51], s32 offen offset:0 sc1 lds
v_mfma_f32_16x16x32_bf16 v[136:139], a[40:43], v[48:51], v[136:139]
ds_read_b128 a[8:11], v2 offset:10240
v_mfma_f32_16x16x32_bf16 v[168:171], a[40:43], v[52:55], v[168:171]
v_exp_f32 v31, v31
v_mfma_f32_16x16x32_bf16 v[200:203], a[40:43], v[56:59], v[200:203]
v_exp_f32 v32, v32
v_mfma_f32_16x16x32_bf16 v[232:235], a[40:43], v[60:63], v[232:235]
ds_read_b128 a[12:15], v2 offset:11264
v_cvt_pk_bf16_f32 v77, v30, v31
v_mfma_f32_16x16x32_bf16 v[236:239], a[44:47], v[60:63], v[236:239]
v_mfma_f32_16x16x32_bf16 v[204:207], a[44:47], v[56:59], v[204:207]
v_exp_f32 v33, v33
v_mfma_f32_16x16x32_bf16 v[172:175], a[44:47], v[52:55], v[172:175]
v_exp_f32 v34, v34
v_mfma_f32_16x16x32_bf16 v[140:143], a[44:47], v[48:51], v[140:143]
ds_read_b128 a[16:19], v2 offset:12288
v_cvt_pk_bf16_f32 v66, v32, v33
v_mfma_f32_16x16x32_bf16 v[144:147], a[48:51], v[48:51], v[144:147]
v_mfma_f32_16x16x32_bf16 v[176:179], a[48:51], v[52:55], v[176:179]
v_exp_f32 v35, v35
v_mfma_f32_16x16x32_bf16 v[208:211], a[48:51], v[56:59], v[208:211]
v_exp_f32 v36, v36
v_mfma_f32_16x16x32_bf16 v[240:243], a[48:51], v[60:63], v[240:243]
ds_read_b128 a[20:23], v2 offset:13312
v_cvt_pk_bf16_f32 v67, v34, v35
v_mfma_f32_16x16x32_bf16 v[244:247], a[52:55], v[60:63], v[244:247]
v_exp_f32 v37, v37
v_mfma_f32_16x16x32_bf16 v[212:215], a[52:55], v[56:59], v[212:215]
v_cvt_pk_bf16_f32 v70, v36, v37
v_mfma_f32_16x16x32_bf16 v[180:183], a[52:55], v[52:55], v[180:183]
ds_read_b128 a[24:27], v2 offset:14336
v_mfma_f32_16x16x32_bf16 v[148:151], a[52:55], v[48:51], v[148:151]
buffer_load_dwordx4 v3, s[48:51], s32 offen offset:1024 sc1 lds
v_mfma_f32_16x16x32_bf16 v[152:155], a[56:59], v[48:51], v[152:155]
v_exp_f32 v38, v38
v_mfma_f32_16x16x32_bf16 v[184:187], a[56:59], v[52:55], v[184:187]
v_exp_f32 v39, v39
v_mfma_f32_16x16x32_bf16 v[216:219], a[56:59], v[56:59], v[216:219]
ds_read_b128 a[28:31], v2 offset:15360
v_cvt_pk_bf16_f32 v71, v38, v39
v_mfma_f32_16x16x32_bf16 v[248:251], a[56:59], v[60:63], v[248:251]
v_mfma_f32_16x16x32_bf16 v[252:255], a[60:63], v[60:63], v[252:255]
v_exp_f32 v40, v40
v_mfma_f32_16x16x32_bf16 v[220:223], a[60:63], v[56:59], v[220:223]
v_exp_f32 v41, v41
v_mfma_f32_16x16x32_bf16 v[188:191], a[60:63], v[52:55], v[188:191]
ds_read_b128 a[32:35], v2 offset:0
v_cvt_pk_bf16_f32 v74, v40, v41
v_mfma_f32_16x16x32_bf16 v[156:159], a[60:63], v[48:51], v[156:159]
v_smfmac_f32_16x16x64_bf16 a[224:227], a[232:235], v[48:55], v9
v_exp_f32 v42, v42
v_smfmac_f32_16x16x64_bf16 a[228:231], a[232:235], v[56:63], v9
s_waitcnt lgkmcnt(5)
v_exp_f32 v43, v43
v_mfma_f32_16x16x32_bf16 v[16:19], a[0:3], a[160:163], v[80:83]
ds_read_b128 a[36:39], v2 offset:1024
v_cvt_pk_bf16_f32 v75, v42, v43
v_mfma_f32_16x16x32_bf16 v[16:19], a[4:7], a[164:167], v[16:19]
v_exp_f32 v44, v44
v_mfma_f32_16x16x32_bf16 v[16:19], a[8:11], a[168:171], v[16:19]
v_mfma_f32_16x16x32_bf16 v[16:19], a[12:15], a[172:175], v[16:19]
v_exp_f32 v45, v45
v_mfma_f32_16x16x32_bf16 v[20:23], a[0:3], a[176:179], v[84:87]
ds_read_b128 a[40:43], v2 offset:2048
v_cvt_pk_bf16_f32 v78, v44, v45
v_mfma_f32_16x16x32_bf16 v[20:23], a[4:7], a[180:183], v[20:23]
buffer_load_dwordx4 v3, s[48:51], s32 offen offset:2048 sc1 lds
v_mfma_f32_16x16x32_bf16 v[20:23], a[8:11], a[184:187], v[20:23]
v_exp_f32 v46, v46
v_mfma_f32_16x16x32_bf16 v[20:23], a[12:15], a[188:191], v[20:23]
ds_read_b128 a[44:47], v2 offset:3072
v_mfma_f32_16x16x32_bf16 v[24:27], a[0:3], a[192:195], v[88:91]
v_mfma_f32_16x16x32_bf16 v[24:27], a[4:7], a[196:199], v[24:27]
v_exp_f32 v47, v47
v_mfma_f32_16x16x32_bf16 v[24:27], a[8:11], a[200:203], v[24:27]
v_exp_f32 v16, v16
v_mfma_f32_16x16x32_bf16 v[24:27], a[12:15], a[204:207], v[24:27]
ds_read_b128 a[48:51], v2 offset:4096
v_cvt_pk_bf16_f32 v79, v46, v47
v_mfma_f32_16x16x32_bf16 v[28:31], a[0:3], a[208:211], v[92:95]
v_mfma_f32_16x16x32_bf16 v[28:31], a[4:7], a[212:215], v[28:31]
v_exp_f32 v17, v17
v_mfma_f32_16x16x32_bf16 v[28:31], a[8:11], a[216:219], v[28:31]
s_waitcnt lgkmcnt(5)
v_exp_f32 v18, v18
v_mfma_f32_16x16x32_bf16 v[28:31], a[12:15], a[220:223], v[28:31]
ds_read_b128 a[52:55], v2 offset:5120
v_cvt_pk_bf16_f32 v48, v16, v17
v_mfma_f32_16x16x32_bf16 v[32:35], a[16:19], a[160:163], v[80:83]
v_mfma_f32_16x16x32_bf16 v[32:35], a[20:23], a[164:167], v[32:35]
v_exp_f32 v19, v19
v_mfma_f32_16x16x32_bf16 v[32:35], a[24:27], a[168:171], v[32:35]
v_exp_f32 v20, v20
v_mfma_f32_16x16x32_bf16 v[32:35], a[28:31], a[172:175], v[32:35]
ds_read_b128 a[56:59], v2 offset:6144
v_cvt_pk_bf16_f32 v49, v18, v19
v_mfma_f32_16x16x32_bf16 v[36:39], a[16:19], a[176:179], v[84:87]
v_exp_f32 v21, v21
v_mfma_f32_16x16x32_bf16 v[36:39], a[20:23], a[180:183], v[36:39]
buffer_load_dwordx4 v3, s[48:51], s32 offen offset:3072 sc1 lds
v_mfma_f32_16x16x32_bf16 v[36:39], a[24:27], a[184:187], v[36:39]
s_add_u32 s32, s32, 0x8000
v_cvt_pk_bf16_f32 v52, v20, v21
v_mfma_f32_16x16x32_bf16 v[36:39], a[28:31], a[188:191], v[36:39]
ds_read_b128 a[60:63], v2 offset:7168
v_mfma_f32_16x16x32_bf16 v[40:43], a[16:19], a[192:195], v[88:91]
v_exp_f32 v22, v22
v_mfma_f32_16x16x32_bf16 v[40:43], a[20:23], a[196:199], v[40:43]
v_exp_f32 v23, v23
v_mfma_f32_16x16x32_bf16 v[40:43], a[24:27], a[200:203], v[40:43]
v_cvt_pk_bf16_f32 v53, v22, v23
v_mfma_f32_16x16x32_bf16 v[40:43], a[28:31], a[204:207], v[40:43]
v_exp_f32 v24, v24
v_mfma_f32_16x16x32_bf16 v[44:47], a[16:19], a[208:211], v[92:95]
v_exp_f32 v25, v25
v_mfma_f32_16x16x32_bf16 v[44:47], a[20:23], a[212:215], v[44:47]
v_exp_f32 v26, v26
v_mfma_f32_16x16x32_bf16 v[44:47], a[24:27], a[216:219], v[44:47]
v_exp_f32 v27, v27
v_mfma_f32_16x16x32_bf16 v[44:47], a[28:31], a[220:223], v[44:47]
s_waitcnt lgkmcnt(0)
v_mfma_f32_16x16x32_bf16 v[128:131], a[32:35], v[64:67], v[128:131]
ds_read_b128 a[0:3], v2 offset:24576
v_cvt_pk_bf16_f32 v56, v24, v25
v_mfma_f32_16x16x32_bf16 v[160:163], a[32:35], v[68:71], v[160:163]
v_exp_f32 v28, v28
v_mfma_f32_16x16x32_bf16 v[192:195], a[32:35], v[72:75], v[192:195]
v_cvt_pk_bf16_f32 v57, v26, v27
v_mfma_f32_16x16x32_bf16 v[224:227], a[32:35], v[76:79], v[224:227]
ds_read_b128 a[4:7], v2 offset:25600
v_mfma_f32_16x16x32_bf16 v[228:231], a[36:39], v[76:79], v[228:231]
v_exp_f32 v29, v29
v_mfma_f32_16x16x32_bf16 v[196:199], a[36:39], v[72:75], v[196:199]
v_exp_f32 v30, v30
v_mfma_f32_16x16x32_bf16 v[164:167], a[36:39], v[68:71], v[164:167]
s_add_u32 m0, s19, 0x1000
v_cvt_pk_bf16_f32 v60, v28, v29
v_mfma_f32_16x16x32_bf16 v[132:135], a[36:39], v[64:67], v[132:135]
buffer_load_dwordx4 v3, s[48:51], s7 offen offset:0 sc1 lds
v_mfma_f32_16x16x32_bf16 v[136:139], a[40:43], v[64:67], v[136:139]
ds_read_b128 a[8:11], v2 offset:26624
v_mfma_f32_16x16x32_bf16 v[168:171], a[40:43], v[68:71], v[168:171]
v_exp_f32 v31, v31
v_mfma_f32_16x16x32_bf16 v[200:203], a[40:43], v[72:75], v[200:203]
v_exp_f32 v32, v32
v_mfma_f32_16x16x32_bf16 v[232:235], a[40:43], v[76:79], v[232:235]
ds_read_b128 a[12:15], v2 offset:27648
v_cvt_pk_bf16_f32 v61, v30, v31
v_mfma_f32_16x16x32_bf16 v[236:239], a[44:47], v[76:79], v[236:239]
v_mfma_f32_16x16x32_bf16 v[204:207], a[44:47], v[72:75], v[204:207]
v_exp_f32 v33, v33
v_mfma_f32_16x16x32_bf16 v[172:175], a[44:47], v[68:71], v[172:175]
v_exp_f32 v34, v34
v_mfma_f32_16x16x32_bf16 v[140:143], a[44:47], v[64:67], v[140:143]
ds_read_b128 a[16:19], v2 offset:28672
v_cvt_pk_bf16_f32 v50, v32, v33
v_mfma_f32_16x16x32_bf16 v[144:147], a[48:51], v[64:67], v[144:147]
v_exp_f32 v35, v35
v_mfma_f32_16x16x32_bf16 v[176:179], a[48:51], v[68:71], v[176:179]
v_cvt_pk_bf16_f32 v51, v34, v35
v_mfma_f32_16x16x32_bf16 v[208:211], a[48:51], v[72:75], v[208:211]
ds_read_b128 a[20:23], v2 offset:29696
v_mfma_f32_16x16x32_bf16 v[240:243], a[48:51], v[76:79], v[240:243]
v_exp_f32 v36, v36
v_mfma_f32_16x16x32_bf16 v[244:247], a[52:55], v[76:79], v[244:247]
v_exp_f32 v37, v37
v_mfma_f32_16x16x32_bf16 v[212:215], a[52:55], v[72:75], v[212:215]
v_cvt_pk_bf16_f32 v54, v36, v37
v_mfma_f32_16x16x32_bf16 v[180:183], a[52:55], v[68:71], v[180:183]
buffer_load_dwordx4 v3, s[48:51], s7 offen offset:1024 sc1 lds
v_mfma_f32_16x16x32_bf16 v[148:151], a[52:55], v[64:67], v[148:151]
ds_read_b128 a[24:27], v2 offset:30720
v_mfma_f32_16x16x32_bf16 v[152:155], a[56:59], v[64:67], v[152:155]
v_exp_f32 v38, v38
v_mfma_f32_16x16x32_bf16 v[184:187], a[56:59], v[68:71], v[184:187]
v_exp_f32 v39, v39
v_mfma_f32_16x16x32_bf16 v[216:219], a[56:59], v[72:75], v[216:219]
ds_read_b128 a[28:31], v2 offset:31744
v_cvt_pk_bf16_f32 v55, v38, v39
v_mfma_f32_16x16x32_bf16 v[248:251], a[56:59], v[76:79], v[248:251]
v_exp_f32 v40, v40
v_mfma_f32_16x16x32_bf16 v[252:255], a[60:63], v[76:79], v[252:255]
v_mfma_f32_16x16x32_bf16 v[220:223], a[60:63], v[72:75], v[220:223]
v_exp_f32 v41, v41
v_mfma_f32_16x16x32_bf16 v[188:191], a[60:63], v[68:71], v[188:191]
ds_read_b128 a[32:35], v2 offset:16384
v_cvt_pk_bf16_f32 v58, v40, v41
v_mfma_f32_16x16x32_bf16 v[156:159], a[60:63], v[64:67], v[156:159]
v_exp_f32 v42, v42
v_smfmac_f32_16x16x64_bf16 a[224:227], a[232:235], v[64:71], v9
s_waitcnt lgkmcnt(5)
v_smfmac_f32_16x16x64_bf16 a[228:231], a[232:235], v[72:79], v9
ds_read_b128 a[36:39], v2 offset:17408
v_mfma_f32_16x16x32_bf16 v[16:19], a[0:3], a[160:163], v[80:83]
v_exp_f32 v43, v43
v_mfma_f32_16x16x32_bf16 v[16:19], a[4:7], a[164:167], v[16:19]
v_exp_f32 v44, v44
v_mfma_f32_16x16x32_bf16 v[16:19], a[8:11], a[168:171], v[16:19]
buffer_load_dwordx4 v3, s[48:51], s7 offen offset:2048 sc1 lds
v_mfma_f32_16x16x32_bf16 v[16:19], a[12:15], a[172:175], v[16:19]
ds_read_b128 a[40:43], v2 offset:18432
v_cvt_pk_bf16_f32 v59, v42, v43
v_mfma_f32_16x16x32_bf16 v[20:23], a[0:3], a[176:179], v[84:87]
v_exp_f32 v45, v45
v_mfma_f32_16x16x32_bf16 v[20:23], a[4:7], a[180:183], v[20:23]
v_cvt_pk_bf16_f32 v62, v44, v45
v_mfma_f32_16x16x32_bf16 v[20:23], a[8:11], a[184:187], v[20:23]
v_exp_f32 v46, v46
v_mfma_f32_16x16x32_bf16 v[20:23], a[12:15], a[188:191], v[20:23]
ds_read_b128 a[44:47], v2 offset:19456
v_mfma_f32_16x16x32_bf16 v[24:27], a[0:3], a[192:195], v[88:91]
v_exp_f32 v47, v47
v_mfma_f32_16x16x32_bf16 v[24:27], a[4:7], a[196:199], v[24:27]
v_cvt_pk_bf16_f32 v63, v46, v47
v_mfma_f32_16x16x32_bf16 v[24:27], a[8:11], a[200:203], v[24:27]
v_exp_f32 v16, v16
v_mfma_f32_16x16x32_bf16 v[24:27], a[12:15], a[204:207], v[24:27]
ds_read_b128 a[48:51], v2 offset:20480
v_mfma_f32_16x16x32_bf16 v[28:31], a[0:3], a[208:211], v[92:95]
v_exp_f32 v17, v17
v_mfma_f32_16x16x32_bf16 v[28:31], a[4:7], a[212:215], v[28:31]
v_exp_f32 v18, v18
v_mfma_f32_16x16x32_bf16 v[28:31], a[8:11], a[216:219], v[28:31]
ds_read_b128 a[52:55], v2 offset:21504
v_cvt_pk_bf16_f32 v64, v16, v17
v_mfma_f32_16x16x32_bf16 v[28:31], a[12:15], a[220:223], v[28:31]
s_waitcnt lgkmcnt(6)
v_mfma_f32_16x16x32_bf16 v[32:35], a[16:19], a[160:163], v[80:83]
v_exp_f32 v19, v19
v_mfma_f32_16x16x32_bf16 v[32:35], a[20:23], a[164:167], v[32:35]
buffer_load_dwordx4 v3, s[48:51], s7 offen offset:3072 sc1 lds
v_mfma_f32_16x16x32_bf16 v[32:35], a[24:27], a[168:171], v[32:35]
ds_read_b128 a[56:59], v2 offset:22528
v_cvt_pk_bf16_f32 v65, v18, v19
v_mfma_f32_16x16x32_bf16 v[32:35], a[28:31], a[172:175], v[32:35]
s_add_u32 s7, s7, 0x8000
v_exp_f32 v20, v20
v_mfma_f32_16x16x32_bf16 v[36:39], a[16:19], a[176:179], v[84:87]
s_xor_b32 s19, s19, 0x8000
v_mfma_f32_16x16x32_bf16 v[36:39], a[20:23], a[180:183], v[36:39]
s_sub_u32 s15, s15, 1
v_exp_f32 v21, v21
v_mfma_f32_16x16x32_bf16 v[36:39], a[24:27], a[184:187], v[36:39]
ds_read_b128 a[60:63], v2 offset:23552
v_xor_b32 v2, 0x38000, v2
v_mfma_f32_16x16x32_bf16 v[36:39], a[28:31], a[188:191], v[36:39]
s_cmp_lg_u32 s15, 0
v_exp_f32 v22, v22
v_mfma_f32_16x16x32_bf16 v[40:43], a[16:19], a[192:195], v[88:91]
v_exp_f32 v23, v23
v_mfma_f32_16x16x32_bf16 v[40:43], a[20:23], a[196:199], v[40:43]
v_cvt_pk_bf16_f32 v68, v20, v21
v_cvt_pk_bf16_f32 v69, v22, v23
v_mfma_f32_16x16x32_bf16 v[40:43], a[24:27], a[200:203], v[40:43]
v_exp_f32 v24, v24
v_mfma_f32_16x16x32_bf16 v[40:43], a[28:31], a[204:207], v[40:43]
v_exp_f32 v25, v25
v_mfma_f32_16x16x32_bf16 v[44:47], a[16:19], a[208:211], v[92:95]
v_exp_f32 v26, v26
v_mfma_f32_16x16x32_bf16 v[44:47], a[20:23], a[212:215], v[44:47]
v_exp_f32 v27, v27
v_mfma_f32_16x16x32_bf16 v[44:47], a[24:27], a[216:219], v[44:47]
s_waitcnt vmcnt(16) lgkmcnt(0)
v_mfma_f32_16x16x32_bf16 v[44:47], a[28:31], a[220:223], v[44:47]
s_barrier
s_cbranch_scc1 L_att_deven0
s_branch L_att_ddone
L_att_deven1:
v_mfma_f32_16x16x32_bf16 v[128:131], a[32:35], v[48:51], v[128:131]
ds_read_b128 a[0:3], v1 offset:8192
v_cvt_pk_bf16_f32 v72, v24, v25
v_mfma_f32_16x16x32_bf16 v[160:163], a[32:35], v[52:55], v[160:163]
v_exp_f32 v28, v28
v_mfma_f32_16x16x32_bf16 v[192:195], a[32:35], v[56:59], v[192:195]
v_cvt_pk_bf16_f32 v73, v26, v27
v_mfma_f32_16x16x32_bf16 v[224:227], a[32:35], v[60:63], v[224:227]
ds_read_b128 a[4:7], v1 offset:9216
v_mfma_f32_16x16x32_bf16 v[228:231], a[36:39], v[60:63], v[228:231]
v_exp_f32 v29, v29
v_mfma_f32_16x16x32_bf16 v[196:199], a[36:39], v[56:59], v[196:199]
v_exp_f32 v30, v30
v_mfma_f32_16x16x32_bf16 v[164:167], a[36:39], v[52:55], v[164:167]
s_add_u32 m0, s27, 0x0
v_cvt_pk_bf16_f32 v76, v28, v29
v_mfma_f32_16x16x32_bf16 v[132:135], a[36:39], v[48:51], v[132:135]
buffer_load_dwordx4 v3, s[48:51], s32 offen offset:0 sc1 lds
v_mfma_f32_16x16x32_bf16 v[136:139], a[40:43], v[48:51], v[136:139]
ds_read_b128 a[8:11], v1 offset:10240
v_mfma_f32_16x16x32_bf16 v[168:171], a[40:43], v[52:55], v[168:171]
v_exp_f32 v31, v31
v_mfma_f32_16x16x32_bf16 v[200:203], a[40:43], v[56:59], v[200:203]
v_exp_f32 v32, v32
v_mfma_f32_16x16x32_bf16 v[232:235], a[40:43], v[60:63], v[232:235]
ds_read_b128 a[12:15], v1 offset:11264
v_cvt_pk_bf16_f32 v77, v30, v31
v_mfma_f32_16x16x32_bf16 v[236:239], a[44:47], v[60:63], v[236:239]
v_mfma_f32_16x16x32_bf16 v[204:207], a[44:47], v[56:59], v[204:207]
v_exp_f32 v33, v33
v_mfma_f32_16x16x32_bf16 v[172:175], a[44:47], v[52:55], v[172:175]
v_exp_f32 v34, v34
v_mfma_f32_16x16x32_bf16 v[140:143], a[44:47], v[48:51], v[140:143]
ds_read_b128 a[16:19], v1 offset:12288
v_cvt_pk_bf16_f32 v66, v32, v33
v_mfma_f32_16x16x32_bf16 v[144:147], a[48:51], v[48:51], v[144:147]
v_mfma_f32_16x16x32_bf16 v[176:179], a[48:51], v[52:55], v[176:179]
v_exp_f32 v35, v35
v_mfma_f32_16x16x32_bf16 v[208:211], a[48:51], v[56:59], v[208:211]
v_exp_f32 v36, v36
v_mfma_f32_16x16x32_bf16 v[240:243], a[48:51], v[60:63], v[240:243]
ds_read_b128 a[20:23], v1 offset:13312
v_cvt_pk_bf16_f32 v67, v34, v35
v_mfma_f32_16x16x32_bf16 v[244:247], a[52:55], v[60:63], v[244:247]
v_exp_f32 v37, v37
v_mfma_f32_16x16x32_bf16 v[212:215], a[52:55], v[56:59], v[212:215]
v_cvt_pk_bf16_f32 v70, v36, v37
v_mfma_f32_16x16x32_bf16 v[180:183], a[52:55], v[52:55], v[180:183]
ds_read_b128 a[24:27], v1 offset:14336
v_mfma_f32_16x16x32_bf16 v[148:151], a[52:55], v[48:51], v[148:151]
buffer_load_dwordx4 v3, s[48:51], s32 offen offset:1024 sc1 lds
v_mfma_f32_16x16x32_bf16 v[152:155], a[56:59], v[48:51], v[152:155]
v_exp_f32 v38, v38
v_mfma_f32_16x16x32_bf16 v[184:187], a[56:59], v[52:55], v[184:187]
v_exp_f32 v39, v39
v_mfma_f32_16x16x32_bf16 v[216:219], a[56:59], v[56:59], v[216:219]
ds_read_b128 a[28:31], v1 offset:15360
v_cvt_pk_bf16_f32 v71, v38, v39
v_mfma_f32_16x16x32_bf16 v[248:251], a[56:59], v[60:63], v[248:251]
v_mfma_f32_16x16x32_bf16 v[252:255], a[60:63], v[60:63], v[252:255]
v_exp_f32 v40, v40
v_mfma_f32_16x16x32_bf16 v[220:223], a[60:63], v[56:59], v[220:223]
v_exp_f32 v41, v41
v_mfma_f32_16x16x32_bf16 v[188:191], a[60:63], v[52:55], v[188:191]
ds_read_b128 a[32:35], v1 offset:0
v_cvt_pk_bf16_f32 v74, v40, v41
v_mfma_f32_16x16x32_bf16 v[156:159], a[60:63], v[48:51], v[156:159]
v_smfmac_f32_16x16x64_bf16 a[224:227], a[232:235], v[48:55], v9
v_exp_f32 v42, v42
v_smfmac_f32_16x16x64_bf16 a[228:231], a[232:235], v[56:63], v9
s_waitcnt lgkmcnt(5)
v_exp_f32 v43, v43
v_mfma_f32_16x16x32_bf16 v[16:19], a[0:3], a[160:163], v[80:83]
ds_read_b128 a[36:39], v1 offset:1024
v_cvt_pk_bf16_f32 v75, v42, v43
v_mfma_f32_16x16x32_bf16 v[16:19], a[4:7], a[164:167], v[16:19]
v_exp_f32 v44, v44
v_mfma_f32_16x16x32_bf16 v[16:19], a[8:11], a[168:171], v[16:19]
v_mfma_f32_16x16x32_bf16 v[16:19], a[12:15], a[172:175], v[16:19]
v_exp_f32 v45, v45
v_mfma_f32_16x16x32_bf16 v[20:23], a[0:3], a[176:179], v[84:87]
ds_read_b128 a[40:43], v1 offset:2048
v_cvt_pk_bf16_f32 v78, v44, v45
v_mfma_f32_16x16x32_bf16 v[20:23], a[4:7], a[180:183], v[20:23]
buffer_load_dwordx4 v3, s[48:51], s32 offen offset:2048 sc1 lds
v_mfma_f32_16x16x32_bf16 v[20:23], a[8:11], a[184:187], v[20:23]
v_exp_f32 v46, v46
v_mfma_f32_16x16x32_bf16 v[20:23], a[12:15], a[188:191], v[20:23]
ds_read_b128 a[44:47], v1 offset:3072
v_mfma_f32_16x16x32_bf16 v[24:27], a[0:3], a[192:195], v[88:91]
v_mfma_f32_16x16x32_bf16 v[24:27], a[4:7], a[196:199], v[24:27]
v_exp_f32 v47, v47
v_mfma_f32_16x16x32_bf16 v[24:27], a[8:11], a[200:203], v[24:27]
v_exp_f32 v16, v16
v_mfma_f32_16x16x32_bf16 v[24:27], a[12:15], a[204:207], v[24:27]
ds_read_b128 a[48:51], v1 offset:4096
v_cvt_pk_bf16_f32 v79, v46, v47
v_mfma_f32_16x16x32_bf16 v[28:31], a[0:3], a[208:211], v[92:95]
v_mfma_f32_16x16x32_bf16 v[28:31], a[4:7], a[212:215], v[28:31]
v_exp_f32 v17, v17
v_mfma_f32_16x16x32_bf16 v[28:31], a[8:11], a[216:219], v[28:31]
s_waitcnt lgkmcnt(5)
v_exp_f32 v18, v18
v_mfma_f32_16x16x32_bf16 v[28:31], a[12:15], a[220:223], v[28:31]
ds_read_b128 a[52:55], v1 offset:5120
v_cvt_pk_bf16_f32 v48, v16, v17
v_mfma_f32_16x16x32_bf16 v[32:35], a[16:19], a[160:163], v[80:83]
v_mfma_f32_16x16x32_bf16 v[32:35], a[20:23], a[164:167], v[32:35]
v_exp_f32 v19, v19
v_mfma_f32_16x16x32_bf16 v[32:35], a[24:27], a[168:171], v[32:35]
v_exp_f32 v20, v20
v_mfma_f32_16x16x32_bf16 v[32:35], a[28:31], a[172:175], v[32:35]
ds_read_b128 a[56:59], v1 offset:6144
v_cvt_pk_bf16_f32 v49, v18, v19
v_mfma_f32_16x16x32_bf16 v[36:39], a[16:19], a[176:179], v[84:87]
v_exp_f32 v21, v21
v_mfma_f32_16x16x32_bf16 v[36:39], a[20:23], a[180:183], v[36:39]
buffer_load_dwordx4 v3, s[48:51], s32 offen offset:3072 sc1 lds
v_mfma_f32_16x16x32_bf16 v[36:39], a[24:27], a[184:187], v[36:39]
s_add_u32 s32, s32, 0x8000
v_cvt_pk_bf16_f32 v52, v20, v21
v_mfma_f32_16x16x32_bf16 v[36:39], a[28:31], a[188:191], v[36:39]
ds_read_b128 a[60:63], v1 offset:7168
v_mfma_f32_16x16x32_bf16 v[40:43], a[16:19], a[192:195], v[88:91]
v_exp_f32 v22, v22
v_mfma_f32_16x16x32_bf16 v[40:43], a[20:23], a[196:199], v[40:43]
v_exp_f32 v23, v23
v_mfma_f32_16x16x32_bf16 v[40:43], a[24:27], a[200:203], v[40:43]
v_cvt_pk_bf16_f32 v53, v22, v23
v_mfma_f32_16x16x32_bf16 v[40:43], a[28:31], a[204:207], v[40:43]
v_exp_f32 v24, v24
v_mfma_f32_16x16x32_bf16 v[44:47], a[16:19], a[208:211], v[92:95]
v_exp_f32 v25, v25
v_mfma_f32_16x16x32_bf16 v[44:47], a[20:23], a[212:215], v[44:47]
v_exp_f32 v26, v26
v_mfma_f32_16x16x32_bf16 v[44:47], a[24:27], a[216:219], v[44:47]
v_exp_f32 v27, v27
v_mfma_f32_16x16x32_bf16 v[44:47], a[28:31], a[220:223], v[44:47]
s_waitcnt lgkmcnt(0)
v_mfma_f32_16x16x32_bf16 v[128:131], a[32:35], v[64:67], v[128:131]
ds_read_b128 a[0:3], v1 offset:24576
v_cvt_pk_bf16_f32 v56, v24, v25
v_mfma_f32_16x16x32_bf16 v[160:163], a[32:35], v[68:71], v[160:163]
v_exp_f32 v28, v28
v_mfma_f32_16x16x32_bf16 v[192:195], a[32:35], v[72:75], v[192:195]
v_cvt_pk_bf16_f32 v57, v26, v27
v_mfma_f32_16x16x32_bf16 v[224:227], a[32:35], v[76:79], v[224:227]
ds_read_b128 a[4:7], v1 offset:25600
v_mfma_f32_16x16x32_bf16 v[228:231], a[36:39], v[76:79], v[228:231]
v_exp_f32 v29, v29
v_mfma_f32_16x16x32_bf16 v[196:199], a[36:39], v[72:75], v[196:199]
v_exp_f32 v30, v30
v_mfma_f32_16x16x32_bf16 v[164:167], a[36:39], v[68:71], v[164:167]
s_add_u32 m0, s27, 0x1000
v_cvt_pk_bf16_f32 v60, v28, v29
v_mfma_f32_16x16x32_bf16 v[132:135], a[36:39], v[64:67], v[132:135]
buffer_load_dwordx4 v3, s[48:51], s7 offen offset:0 sc1 lds
v_mfma_f32_16x16x32_bf16 v[136:139], a[40:43], v[64:67], v[136:139]
ds_read_b128 a[8:11], v1 offset:26624
v_mfma_f32_16x16x32_bf16 v[168:171], a[40:43], v[68:71], v[168:171]
v_exp_f32 v31, v31
v_mfma_f32_16x16x32_bf16 v[200:203], a[40:43], v[72:75], v[200:203]
v_exp_f32 v32, v32
v_mfma_f32_16x16x32_bf16 v[232:235], a[40:43], v[76:79], v[232:235]
ds_read_b128 a[12:15], v1 offset:27648
v_cvt_pk_bf16_f32 v61, v30, v31
v_mfma_f32_16x16x32_bf16 v[236:239], a[44:47], v[76:79], v[236:239]
v_mfma_f32_16x16x32_bf16 v[204:207], a[44:47], v[72:75], v[204:207]
v_exp_f32 v33, v33
v_mfma_f32_16x16x32_bf16 v[172:175], a[44:47], v[68:71], v[172:175]
v_exp_f32 v34, v34
v_mfma_f32_16x16x32_bf16 v[140:143], a[44:47], v[64:67], v[140:143]
ds_read_b128 a[16:19], v1 offset:28672
v_cvt_pk_bf16_f32 v50, v32, v33
v_mfma_f32_16x16x32_bf16 v[144:147], a[48:51], v[64:67], v[144:147]
v_mfma_f32_16x16x32_bf16 v[176:179], a[48:51], v[68:71], v[176:179]
v_exp_f32 v35, v35
v_mfma_f32_16x16x32_bf16 v[208:211], a[48:51], v[72:75], v[208:211]
ds_read_b128 a[20:23], v1 offset:29696
v_cvt_pk_bf16_f32 v51, v34, v35
v_mfma_f32_16x16x32_bf16 v[240:243], a[48:51], v[76:79], v[240:243]
v_exp_f32 v36, v36
v_mfma_f32_16x16x32_bf16 v[244:247], a[52:55], v[76:79], v[244:247]
v_exp_f32 v37, v37
v_mfma_f32_16x16x32_bf16 v[212:215], a[52:55], v[72:75], v[212:215]
v_cvt_pk_bf16_f32 v54, v36, v37
v_mfma_f32_16x16x32_bf16 v[180:183], a[52:55], v[68:71], v[180:183]
buffer_load_dwordx4 v3, s[48:51], s7 offen offset:1024 sc1 lds
v_mfma_f32_16x16x32_bf16 v[148:151], a[52:55], v[64:67], v[148:151]
ds_read_b128 a[24:27], v1 offset:30720
v_mfma_f32_16x16x32_bf16 v[152:155], a[56:59], v[64:67], v[152:155]
v_exp_f32 v38, v38
v_mfma_f32_16x16x32_bf16 v[184:187], a[56:59], v[68:71], v[184:187]
v_exp_f32 v39, v39
v_mfma_f32_16x16x32_bf16 v[216:219], a[56:59], v[72:75], v[216:219]
ds_read_b128 a[28:31], v1 offset:31744
v_cvt_pk_bf16_f32 v55, v38, v39
v_mfma_f32_16x16x32_bf16 v[248:251], a[56:59], v[76:79], v[248:251]
v_mfma_f32_16x16x32_bf16 v[252:255], a[60:63], v[76:79], v[252:255]
v_exp_f32 v40, v40
v_mfma_f32_16x16x32_bf16 v[220:223], a[60:63], v[72:75], v[220:223]
v_exp_f32 v41, v41
v_mfma_f32_16x16x32_bf16 v[188:191], a[60:63], v[68:71], v[188:191]
ds_read_b128 a[32:35], v1 offset:16384
v_cvt_pk_bf16_f32 v58, v40, v41
v_mfma_f32_16x16x32_bf16 v[156:159], a[60:63], v[64:67], v[156:159]
v_smfmac_f32_16x16x64_bf16 a[224:227], a[232:235], v[64:71], v9
s_waitcnt lgkmcnt(5)
v_exp_f32 v42, v42
v_smfmac_f32_16x16x64_bf16 a[228:231], a[232:235], v[72:79], v9
ds_read_b128 a[36:39], v1 offset:17408
v_mfma_f32_16x16x32_bf16 v[16:19], a[0:3], a[160:163], v[80:83]
v_exp_f32 v43, v43
v_mfma_f32_16x16x32_bf16 v[16:19], a[4:7], a[164:167], v[16:19]
v_exp_f32 v44, v44
v_mfma_f32_16x16x32_bf16 v[16:19], a[8:11], a[168:171], v[16:19]
v_cvt_pk_bf16_f32 v59, v42, v43
v_mfma_f32_16x16x32_bf16 v[16:19], a[12:15], a[172:175], v[16:19]
ds_read_b128 a[40:43], v1 offset:18432
v_mfma_f32_16x16x32_bf16 v[20:23], a[0:3], a[176:179], v[84:87]
buffer_load_dwordx4 v3, s[48:51], s7 offen offset:2048 sc1 lds
v_mfma_f32_16x16x32_bf16 v[20:23], a[4:7], a[180:183], v[20:23]
v_exp_f32 v45, v45
v_mfma_f32_16x16x32_bf16 v[20:23], a[8:11], a[184:187], v[20:23]
v_exp_f32 v46, v46
v_mfma_f32_16x16x32_bf16 v[20:23], a[12:15], a[188:191], v[20:23]
ds_read_b128 a[44:47], v1 offset:19456
v_cvt_pk_bf16_f32 v62, v44, v45
v_mfma_f32_16x16x32_bf16 v[24:27], a[0:3], a[192:195], v[88:91]
v_mfma_f32_16x16x32_bf16 v[24:27], a[4:7], a[196:199], v[24:27]
v_exp_f32 v47, v47
v_mfma_f32_16x16x32_bf16 v[24:27], a[8:11], a[200:203], v[24:27]
v_exp_f32 v16, v16
v_mfma_f32_16x16x32_bf16 v[24:27], a[12:15], a[204:207], v[24:27]
ds_read_b128 a[48:51], v1 offset:20480
v_cvt_pk_bf16_f32 v63, v46, v47
v_mfma_f32_16x16x32_bf16 v[28:31], a[0:3], a[208:211], v[92:95]
v_mfma_f32_16x16x32_bf16 v[28:31], a[4:7], a[212:215], v[28:31]
v_exp_f32 v17, v17
v_mfma_f32_16x16x32_bf16 v[28:31], a[8:11], a[216:219], v[28:31]
ds_read_b128 a[52:55], v1 offset:21504
v_cvt_pk_bf16_f32 v64, v16, v17
v_mfma_f32_16x16x32_bf16 v[28:31], a[12:15], a[220:223], v[28:31]
s_waitcnt lgkmcnt(6)
v_exp_f32 v18, v18
v_mfma_f32_16x16x32_bf16 v[32:35], a[16:19], a[160:163], v[80:83]
v_mfma_f32_16x16x32_bf16 v[32:35], a[20:23], a[164:167], v[32:35]
v_exp_f32 v19, v19
v_mfma_f32_16x16x32_bf16 v[32:35], a[24:27], a[168:171], v[32:35]
ds_read_b128 a[56:59], v1 offset:22528
v_cvt_pk_bf16_f32 v65, v18, v19
v_mfma_f32_16x16x32_bf16 v[32:35], a[28:31], a[172:175], v[32:35]
buffer_load_dwordx4 v3, s[48:51], s7 offen offset:3072 sc1 lds
v_mfma_f32_16x16x32_bf16 v[36:39], a[16:19], a[176:179], v[84:87]
s_add_u32 s7, s7, 0x8000
v_exp_f32 v20, v20
v_mfma_f32_16x16x32_bf16 v[36:39], a[20:23], a[180:183], v[36:39]
s_xor_b32 s27, s27, 0x38000
v_exp_f32 v21, v21
v_mfma_f32_16x16x32_bf16 v[36:39], a[24:27], a[184:187], v[36:39]
ds_read_b128 a[60:63], v1 offset:23552
v_xor_b32 v1, 0x8000, v1
v_mfma_f32_16x16x32_bf16 v[36:39], a[28:31], a[188:191], v[36:39]
v_cvt_pk_bf16_f32 v68, v20, v21
v_mfma_f32_16x16x32_bf16 v[40:43], a[16:19], a[192:195], v[88:91]
v_exp_f32 v22, v22
v_mfma_f32_16x16x32_bf16 v[40:43], a[20:23], a[196:199], v[40:43]
v_exp_f32 v23, v23
v_mfma_f32_16x16x32_bf16 v[40:43], a[24:27], a[200:203], v[40:43]
v_cvt_pk_bf16_f32 v69, v22, v23
v_mfma_f32_16x16x32_bf16 v[40:43], a[28:31], a[204:207], v[40:43]
v_exp_f32 v24, v24
v_mfma_f32_16x16x32_bf16 v[44:47], a[16:19], a[208:211], v[92:95]
s_waitcnt vmcnt(16) lgkmcnt(0)
v_exp_f32 v25, v25
v_mfma_f32_16x16x32_bf16 v[44:47], a[20:23], a[212:215], v[44:47]
s_barrier
v_exp_f32 v26, v26
v_mfma_f32_16x16x32_bf16 v[44:47], a[24:27], a[216:219], v[44:47]
v_exp_f32 v27, v27
v_mfma_f32_16x16x32_bf16 v[44:47], a[28:31], a[220:223], v[44:47]
L_att_dodd1:
v_mfma_f32_16x16x32_bf16 v[128:131], a[32:35], v[48:51], v[128:131]
ds_read_b128 a[0:3], v2 offset:8192
v_cvt_pk_bf16_f32 v72, v24, v25
v_mfma_f32_16x16x32_bf16 v[160:163], a[32:35], v[52:55], v[160:163]
v_exp_f32 v28, v28
v_mfma_f32_16x16x32_bf16 v[192:195], a[32:35], v[56:59], v[192:195]
v_cvt_pk_bf16_f32 v73, v26, v27
v_mfma_f32_16x16x32_bf16 v[224:227], a[32:35], v[60:63], v[224:227]
ds_read_b128 a[4:7], v2 offset:9216
v_mfma_f32_16x16x32_bf16 v[228:231], a[36:39], v[60:63], v[228:231]
v_exp_f32 v29, v29
v_mfma_f32_16x16x32_bf16 v[196:199], a[36:39], v[56:59], v[196:199]
v_exp_f32 v30, v30
v_mfma_f32_16x16x32_bf16 v[164:167], a[36:39], v[52:55], v[164:167]
s_add_u32 m0, s19, 0x0
v_cvt_pk_bf16_f32 v76, v28, v29
v_mfma_f32_16x16x32_bf16 v[132:135], a[36:39], v[48:51], v[132:135]
buffer_load_dwordx4 v3, s[48:51], s32 offen offset:0 sc1 lds
v_mfma_f32_16x16x32_bf16 v[136:139], a[40:43], v[48:51], v[136:139]
ds_read_b128 a[8:11], v2 offset:10240
v_mfma_f32_16x16x32_bf16 v[168:171], a[40:43], v[52:55], v[168:171]
v_exp_f32 v31, v31
v_mfma_f32_16x16x32_bf16 v[200:203], a[40:43], v[56:59], v[200:203]
v_exp_f32 v32, v32
v_mfma_f32_16x16x32_bf16 v[232:235], a[40:43], v[60:63], v[232:235]
ds_read_b128 a[12:15], v2 offset:11264
v_cvt_pk_bf16_f32 v77, v30, v31
v_mfma_f32_16x16x32_bf16 v[236:239], a[44:47], v[60:63], v[236:239]
v_mfma_f32_16x16x32_bf16 v[204:207], a[44:47], v[56:59], v[204:207]
v_exp_f32 v33, v33
v_mfma_f32_16x16x32_bf16 v[172:175], a[44:47], v[52:55], v[172:175]
v_exp_f32 v34, v34
v_mfma_f32_16x16x32_bf16 v[140:143], a[44:47], v[48:51], v[140:143]
ds_read_b128 a[16:19], v2 offset:12288
v_cvt_pk_bf16_f32 v66, v32, v33
v_mfma_f32_16x16x32_bf16 v[144:147], a[48:51], v[48:51], v[144:147]
v_mfma_f32_16x16x32_bf16 v[176:179], a[48:51], v[52:55], v[176:179]
v_exp_f32 v35, v35
v_mfma_f32_16x16x32_bf16 v[208:211], a[48:51], v[56:59], v[208:211]
v_exp_f32 v36, v36
v_mfma_f32_16x16x32_bf16 v[240:243], a[48:51], v[60:63], v[240:243]
ds_read_b128 a[20:23], v2 offset:13312
v_cvt_pk_bf16_f32 v67, v34, v35
v_mfma_f32_16x16x32_bf16 v[244:247], a[52:55], v[60:63], v[244:247]
v_exp_f32 v37, v37
v_mfma_f32_16x16x32_bf16 v[212:215], a[52:55], v[56:59], v[212:215]
v_cvt_pk_bf16_f32 v70, v36, v37
v_mfma_f32_16x16x32_bf16 v[180:183], a[52:55], v[52:55], v[180:183]
ds_read_b128 a[24:27], v2 offset:14336
v_mfma_f32_16x16x32_bf16 v[148:151], a[52:55], v[48:51], v[148:151]
buffer_load_dwordx4 v3, s[48:51], s32 offen offset:1024 sc1 lds
v_mfma_f32_16x16x32_bf16 v[152:155], a[56:59], v[48:51], v[152:155]
v_exp_f32 v38, v38
v_mfma_f32_16x16x32_bf16 v[184:187], a[56:59], v[52:55], v[184:187]
v_exp_f32 v39, v39
v_mfma_f32_16x16x32_bf16 v[216:219], a[56:59], v[56:59], v[216:219]
ds_read_b128 a[28:31], v2 offset:15360
v_cvt_pk_bf16_f32 v71, v38, v39
v_mfma_f32_16x16x32_bf16 v[248:251], a[56:59], v[60:63], v[248:251]
v_mfma_f32_16x16x32_bf16 v[252:255], a[60:63], v[60:63], v[252:255]
v_exp_f32 v40, v40
v_mfma_f32_16x16x32_bf16 v[220:223], a[60:63], v[56:59], v[220:223]
v_exp_f32 v41, v41
v_mfma_f32_16x16x32_bf16 v[188:191], a[60:63], v[52:55], v[188:191]
ds_read_b128 a[32:35], v2 offset:0
v_cvt_pk_bf16_f32 v74, v40, v41
v_mfma_f32_16x16x32_bf16 v[156:159], a[60:63], v[48:51], v[156:159]
v_smfmac_f32_16x16x64_bf16 a[224:227], a[232:235], v[48:55], v9
v_exp_f32 v42, v42
v_smfmac_f32_16x16x64_bf16 a[228:231], a[232:235], v[56:63], v9
s_waitcnt lgkmcnt(5)
v_exp_f32 v43, v43
v_mfma_f32_16x16x32_bf16 v[16:19], a[0:3], a[160:163], v[80:83]
ds_read_b128 a[36:39], v2 offset:1024
v_cvt_pk_bf16_f32 v75, v42, v43
v_mfma_f32_16x16x32_bf16 v[16:19], a[4:7], a[164:167], v[16:19]
v_exp_f32 v44, v44
v_mfma_f32_16x16x32_bf16 v[16:19], a[8:11], a[168:171], v[16:19]
v_mfma_f32_16x16x32_bf16 v[16:19], a[12:15], a[172:175], v[16:19]
v_exp_f32 v45, v45
v_mfma_f32_16x16x32_bf16 v[20:23], a[0:3], a[176:179], v[84:87]
ds_read_b128 a[40:43], v2 offset:2048
v_cvt_pk_bf16_f32 v78, v44, v45
v_mfma_f32_16x16x32_bf16 v[20:23], a[4:7], a[180:183], v[20:23]
buffer_load_dwordx4 v3, s[48:51], s32 offen offset:2048 sc1 lds
v_mfma_f32_16x16x32_bf16 v[20:23], a[8:11], a[184:187], v[20:23]
v_exp_f32 v46, v46
v_mfma_f32_16x16x32_bf16 v[20:23], a[12:15], a[188:191], v[20:23]
ds_read_b128 a[44:47], v2 offset:3072
v_mfma_f32_16x16x32_bf16 v[24:27], a[0:3], a[192:195], v[88:91]
v_mfma_f32_16x16x32_bf16 v[24:27], a[4:7], a[196:199], v[24:27]
v_exp_f32 v47, v47
v_mfma_f32_16x16x32_bf16 v[24:27], a[8:11], a[200:203], v[24:27]
v_exp_f32 v16, v16
v_mfma_f32_16x16x32_bf16 v[24:27], a[12:15], a[204:207], v[24:27]
ds_read_b128 a[48:51], v2 offset:4096
v_cvt_pk_bf16_f32 v79, v46, v47
v_mfma_f32_16x16x32_bf16 v[28:31], a[0:3], a[208:211], v[92:95]
v_mfma_f32_16x16x32_bf16 v[28:31], a[4:7], a[212:215], v[28:31]
v_exp_f32 v17, v17
v_mfma_f32_16x16x32_bf16 v[28:31], a[8:11], a[216:219], v[28:31]
s_waitcnt lgkmcnt(5)
v_exp_f32 v18, v18
v_mfma_f32_16x16x32_bf16 v[28:31], a[12:15], a[220:223], v[28:31]
ds_read_b128 a[52:55], v2 offset:5120
v_cvt_pk_bf16_f32 v48, v16, v17
v_mfma_f32_16x16x32_bf16 v[32:35], a[16:19], a[160:163], v[80:83]
v_mfma_f32_16x16x32_bf16 v[32:35], a[20:23], a[164:167], v[32:35]
v_exp_f32 v19, v19
v_mfma_f32_16x16x32_bf16 v[32:35], a[24:27], a[168:171], v[32:35]
v_exp_f32 v20, v20
v_mfma_f32_16x16x32_bf16 v[32:35], a[28:31], a[172:175], v[32:35]
ds_read_b128 a[56:59], v2 offset:6144
v_cvt_pk_bf16_f32 v49, v18, v19
v_mfma_f32_16x16x32_bf16 v[36:39], a[16:19], a[176:179], v[84:87]
v_exp_f32 v21, v21
v_mfma_f32_16x16x32_bf16 v[36:39], a[20:23], a[180:183], v[36:39]
buffer_load_dwordx4 v3, s[48:51], s32 offen offset:3072 sc1 lds
v_mfma_f32_16x16x32_bf16 v[36:39], a[24:27], a[184:187], v[36:39]
s_add_u32 s32, s32, 0x8000
v_cvt_pk_bf16_f32 v52, v20, v21
v_mfma_f32_16x16x32_bf16 v[36:39], a[28:31], a[188:191], v[36:39]
ds_read_b128 a[60:63], v2 offset:7168
v_mfma_f32_16x16x32_bf16 v[40:43], a[16:19], a[192:195], v[88:91]
v_exp_f32 v22, v22
v_mfma_f32_16x16x32_bf16 v[40:43], a[20:23], a[196:199], v[40:43]
v_exp_f32 v23, v23
v_mfma_f32_16x16x32_bf16 v[40:43], a[24:27], a[200:203], v[40:43]
v_cvt_pk_bf16_f32 v53, v22, v23
v_mfma_f32_16x16x32_bf16 v[40:43], a[28:31], a[204:207], v[40:43]
v_exp_f32 v24, v24
v_mfma_f32_16x16x32_bf16 v[44:47], a[16:19], a[208:211], v[92:95]
v_exp_f32 v25, v25
v_mfma_f32_16x16x32_bf16 v[44:47], a[20:23], a[212:215], v[44:47]
v_exp_f32 v26, v26
v_mfma_f32_16x16x32_bf16 v[44:47], a[24:27], a[216:219], v[44:47]
v_exp_f32 v27, v27
v_mfma_f32_16x16x32_bf16 v[44:47], a[28:31], a[220:223], v[44:47]
s_waitcnt lgkmcnt(0)
v_mfma_f32_16x16x32_bf16 v[128:131], a[32:35], v[64:67], v[128:131]
ds_read_b128 a[0:3], v2 offset:24576
v_cvt_pk_bf16_f32 v56, v24, v25
v_mfma_f32_16x16x32_bf16 v[160:163], a[32:35], v[68:71], v[160:163]
v_exp_f32 v28, v28
v_mfma_f32_16x16x32_bf16 v[192:195], a[32:35], v[72:75], v[192:195]
v_cvt_pk_bf16_f32 v57, v26, v27
v_mfma_f32_16x16x32_bf16 v[224:227], a[32:35], v[76:79], v[224:227]
ds_read_b128 a[4:7], v2 offset:25600
v_mfma_f32_16x16x32_bf16 v[228:231], a[36:39], v[76:79], v[228:231]
v_exp_f32 v29, v29
v_mfma_f32_16x16x32_bf16 v[196:199], a[36:39], v[72:75], v[196:199]
v_exp_f32 v30, v30
v_mfma_f32_16x16x32_bf16 v[164:167], a[36:39], v[68:71], v[164:167]
s_add_u32 m0, s19, 0x1000
v_cvt_pk_bf16_f32 v60, v28, v29
v_mfma_f32_16x16x32_bf16 v[132:135], a[36:39], v[64:67], v[132:135]
buffer_load_dwordx4 v3, s[48:51], s7 offen offset:0 sc1 lds
v_mfma_f32_16x16x32_bf16 v[136:139], a[40:43], v[64:67], v[136:139]
ds_read_b128 a[8:11], v2 offset:26624
v_mfma_f32_16x16x32_bf16 v[168:171], a[40:43], v[68:71], v[168:171]
v_exp_f32 v31, v31
v_mfma_f32_16x16x32_bf16 v[200:203], a[40:43], v[72:75], v[200:203]
v_exp_f32 v32, v32
v_mfma_f32_16x16x32_bf16 v[232:235], a[40:43], v[76:79], v[232:235]
ds_read_b128 a[12:15], v2 offset:27648
v_cvt_pk_bf16_f32 v61, v30, v31
v_mfma_f32_16x16x32_bf16 v[236:239], a[44:47], v[76:79], v[236:239]
v_mfma_f32_16x16x32_bf16 v[204:207], a[44:47], v[72:75], v[204:207]
v_exp_f32 v33, v33
v_mfma_f32_16x16x32_bf16 v[172:175], a[44:47], v[68:71], v[172:175]
v_exp_f32 v34, v34
v_mfma_f32_16x16x32_bf16 v[140:143], a[44:47], v[64:67], v[140:143]
ds_read_b128 a[16:19], v2 offset:28672
v_cvt_pk_bf16_f32 v50, v32, v33
v_mfma_f32_16x16x32_bf16 v[144:147], a[48:51], v[64:67], v[144:147]
v_exp_f32 v35, v35
v_mfma_f32_16x16x32_bf16 v[176:179], a[48:51], v[68:71], v[176:179]
v_cvt_pk_bf16_f32 v51, v34, v35
v_mfma_f32_16x16x32_bf16 v[208:211], a[48:51], v[72:75], v[208:211]
ds_read_b128 a[20:23], v2 offset:29696
v_mfma_f32_16x16x32_bf16 v[240:243], a[48:51], v[76:79], v[240:243]
v_exp_f32 v36, v36
v_mfma_f32_16x16x32_bf16 v[244:247], a[52:55], v[76:79], v[244:247]
v_exp_f32 v37, v37
v_mfma_f32_16x16x32_bf16 v[212:215], a[52:55], v[72:75], v[212:215]
v_cvt_pk_bf16_f32 v54, v36, v37
v_mfma_f32_16x16x32_bf16 v[180:183], a[52:55], v[68:71], v[180:183]
buffer_load_dwordx4 v3, s[48:51], s7 offen offset:1024 sc1 lds
v_mfma_f32_16x16x32_bf16 v[148:151], a[52:55], v[64:67], v[148:151]
ds_read_b128 a[24:27], v2 offset:30720
v_mfma_f32_16x16x32_bf16 v[152:155], a[56:59], v[64:67], v[152:155]
v_exp_f32 v38, v38
v_mfma_f32_16x16x32_bf16 v[184:187], a[56:59], v[68:71], v[184:187]
v_exp_f32 v39, v39
v_mfma_f32_16x16x32_bf16 v[216:219], a[56:59], v[72:75], v[216:219]
ds_read_b128 a[28:31], v2 offset:31744
v_cvt_pk_bf16_f32 v55, v38, v39
v_mfma_f32_16x16x32_bf16 v[248:251], a[56:59], v[76:79], v[248:251]
v_exp_f32 v40, v40
v_mfma_f32_16x16x32_bf16 v[252:255], a[60:63], v[76:79], v[252:255]
v_mfma_f32_16x16x32_bf16 v[220:223], a[60:63], v[72:75], v[220:223]
v_exp_f32 v41, v41
v_mfma_f32_16x16x32_bf16 v[188:191], a[60:63], v[68:71], v[188:191]
ds_read_b128 a[32:35], v2 offset:16384
v_cvt_pk_bf16_f32 v58, v40, v41
v_mfma_f32_16x16x32_bf16 v[156:159], a[60:63], v[64:67], v[156:159]
v_exp_f32 v42, v42
v_smfmac_f32_16x16x64_bf16 a[224:227], a[232:235], v[64:71], v9
s_waitcnt lgkmcnt(5)
v_smfmac_f32_16x16x64_bf16 a[228:231], a[232:235], v[72:79], v9
ds_read_b128 a[36:39], v2 offset:17408
v_mfma_f32_16x16x32_bf16 v[16:19], a[0:3], a[160:163], v[80:83]
v_exp_f32 v43, v43
v_mfma_f32_16x16x32_bf16 v[16:19], a[4:7], a[164:167], v[16:19]
v_exp_f32 v44, v44
v_mfma_f32_16x16x32_bf16 v[16:19], a[8:11], a[168:171], v[16:19]
buffer_load_dwordx4 v3, s[48:51], s7 offen offset:2048 sc1 lds
v_mfma_f32_16x16x32_bf16 v[16:19], a[12:15], a[172:175], v[16:19]
ds_read_b128 a[40:43], v2 offset:18432
v_cvt_pk_bf16_f32 v59, v42, v43
v_mfma_f32_16x16x32_bf16 v[20:23], a[0:3], a[176:179], v[84:87]
v_exp_f32 v45, v45
v_mfma_f32_16x16x32_bf16 v[20:23], a[4:7], a[180:183], v[20:23]
v_cvt_pk_bf16_f32 v62, v44, v45
v_mfma_f32_16x16x32_bf16 v[20:23], a[8:11], a[184:187], v[20:23]
v_exp_f32 v46, v46
v_mfma_f32_16x16x32_bf16 v[20:23], a[12:15], a[188:191], v[20:23]
ds_read_b128 a[44:47], v2 offset:19456
v_mfma_f32_16x16x32_bf16 v[24:27], a[0:3], a[192:195], v[88:91]
v_exp_f32 v47, v47
v_mfma_f32_16x16x32_bf16 v[24:27], a[4:7], a[196:199], v[24:27]
v_cvt_pk_bf16_f32 v63, v46, v47
v_mfma_f32_16x16x32_bf16 v[24:27], a[8:11], a[200:203], v[24:27]
v_exp_f32 v16, v16
v_mfma_f32_16x16x32_bf16 v[24:27], a[12:15], a[204:207], v[24:27]
ds_read_b128 a[48:51], v2 offset:20480
v_mfma_f32_16x16x32_bf16 v[28:31], a[0:3], a[208:211], v[92:95]
v_exp_f32 v17, v17
v_mfma_f32_16x16x32_bf16 v[28:31], a[4:7], a[212:215], v[28:31]
v_exp_f32 v18, v18
v_mfma_f32_16x16x32_bf16 v[28:31], a[8:11], a[216:219], v[28:31]
ds_read_b128 a[52:55], v2 offset:21504
v_cvt_pk_bf16_f32 v64, v16, v17
v_mfma_f32_16x16x32_bf16 v[28:31], a[12:15], a[220:223], v[28:31]
s_waitcnt lgkmcnt(6)
v_mfma_f32_16x16x32_bf16 v[32:35], a[16:19], a[160:163], v[80:83]
v_exp_f32 v19, v19
v_mfma_f32_16x16x32_bf16 v[32:35], a[20:23], a[164:167], v[32:35]
buffer_load_dwordx4 v3, s[48:51], s7 offen offset:3072 sc1 lds
v_mfma_f32_16x16x32_bf16 v[32:35], a[24:27], a[168:171], v[32:35]
ds_read_b128 a[56:59], v2 offset:22528
v_cvt_pk_bf16_f32 v65, v18, v19
v_mfma_f32_16x16x32_bf16 v[32:35], a[28:31], a[172:175], v[32:35]
s_add_u32 s7, s7, 0x8000
v_exp_f32 v20, v20
v_mfma_f32_16x16x32_bf16 v[36:39], a[16:19], a[176:179], v[84:87]
s_xor_b32 s19, s19, 0x8000
v_mfma_f32_16x16x32_bf16 v[36:39], a[20:23], a[180:183], v[36:39]
s_sub_u32 s15, s15, 1
v_exp_f32 v21, v21
v_mfma_f32_16x16x32_bf16 v[36:39], a[24:27], a[184:187], v[36:39]
ds_read_b128 a[60:63], v2 offset:23552
v_xor_b32 v2, 0x38000, v2
v_mfma_f32_16x16x32_bf16 v[36:39], a[28:31], a[188:191], v[36:39]
s_cmp_lg_u32 s15, 0
v_exp_f32 v22, v22
v_mfma_f32_16x16x32_bf16 v[40:43], a[16:19], a[192:195], v[88:91]
v_exp_f32 v23, v23
v_mfma_f32_16x16x32_bf16 v[40:43], a[20:23], a[196:199], v[40:43]
v_cvt_pk_bf16_f32 v68, v20, v21
v_cvt_pk_bf16_f32 v69, v22, v23
v_mfma_f32_16x16x32_bf16 v[40:43], a[24:27], a[200:203], v[40:43]
v_exp_f32 v24, v24
v_mfma_f32_16x16x32_bf16 v[40:43], a[28:31], a[204:207], v[40:43]
v_exp_f32 v25, v25
v_mfma_f32_16x16x32_bf16 v[44:47], a[16:19], a[208:211], v[92:95]
s_waitcnt vmcnt(16) lgkmcnt(0)
v_exp_f32 v26, v26
v_mfma_f32_16x16x32_bf16 v[44:47], a[20:23], a[212:215], v[44:47]
s_barrier
v_exp_f32 v27, v27
v_mfma_f32_16x16x32_bf16 v[44:47], a[24:27], a[216:219], v[44:47]
v_mfma_f32_16x16x32_bf16 v[44:47], a[28:31], a[220:223], v[44:47]
s_cbranch_scc1 L_att_deven1
L_att_ddone:
s_cmp_ge_u32 s4, 2
s_cbranch_scc1 L_att_dl0_1
L_att_dl0_0:
v_mfma_f32_16x16x32_bf16 v[128:131], a[32:35], v[48:51], v[128:131]
ds_read_b128 a[0:3], v1 offset:8192
v_cvt_pk_bf16_f32 v72, v24, v25
v_mfma_f32_16x16x32_bf16 v[160:163], a[32:35], v[52:55], v[160:163]
v_exp_f32 v28, v28
v_mfma_f32_16x16x32_bf16 v[192:195], a[32:35], v[56:59], v[192:195]
v_cvt_pk_bf16_f32 v73, v26, v27
v_mfma_f32_16x16x32_bf16 v[224:227], a[32:35], v[60:63], v[224:227]
ds_read_b128 a[4:7], v1 offset:9216
v_mfma_f32_16x16x32_bf16 v[228:231], a[36:39], v[60:63], v[228:231]
v_exp_f32 v29, v29
v_mfma_f32_16x16x32_bf16 v[196:199], a[36:39], v[56:59], v[196:199]
s_add_u32 m0, s27, 0x0
v_exp_f32 v30, v30
v_mfma_f32_16x16x32_bf16 v[164:167], a[36:39], v[52:55], v[164:167]
buffer_load_dwordx4 v3, s[48:51], s32 offen offset:0 sc1 lds
v_mfma_f32_16x16x32_bf16 v[132:135], a[36:39], v[48:51], v[132:135]
ds_read_b128 a[8:11], v1 offset:10240
v_cvt_pk_bf16_f32 v76, v28, v29
v_mfma_f32_16x16x32_bf16 v[136:139], a[40:43], v[48:51], v[136:139]
v_mfma_f32_16x16x32_bf16 v[168:171], a[40:43], v[52:55], v[168:171]
v_exp_f32 v31, v31
v_mfma_f32_16x16x32_bf16 v[200:203], a[40:43], v[56:59], v[200:203]
v_exp_f32 v32, v32
v_mfma_f32_16x16x32_bf16 v[232:235], a[40:43], v[60:63], v[232:235]
ds_read_b128 a[12:15], v1 offset:11264
v_cvt_pk_bf16_f32 v77, v30, v31
v_mfma_f32_16x16x32_bf16 v[236:239], a[44:47], v[60:63], v[236:239]
v_mfma_f32_16x16x32_bf16 v[204:207], a[44:47], v[56:59], v[204:207]
v_exp_f32 v33, v33
v_mfma_f32_16x16x32_bf16 v[172:175], a[44:47], v[52:55], v[172:175]
v_exp_f32 v34, v34
v_mfma_f32_16x16x32_bf16 v[140:143], a[44:47], v[48:51], v[140:143]
ds_read_b128 a[16:19], v1 offset:12288
v_cvt_pk_bf16_f32 v66, v32, v33
v_mfma_f32_16x16x32_bf16 v[144:147], a[48:51], v[48:51], v[144:147]
v_exp_f32 v35, v35
v_mfma_f32_16x16x32_bf16 v[176:179], a[48:51], v[52:55], v[176:179]
v_cvt_pk_bf16_f32 v67, v34, v35
v_mfma_f32_16x16x32_bf16 v[208:211], a[48:51], v[56:59], v[208:211]
v_exp_f32 v36, v36
v_mfma_f32_16x16x32_bf16 v[240:243], a[48:51], v[60:63], v[240:243]
buffer_load_dwordx4 v3, s[48:51], s32 offen offset:1024 sc1 lds
v_mfma_f32_16x16x32_bf16 v[244:247], a[52:55], v[60:63], v[244:247]
ds_read_b128 a[20:23], v1 offset:13312
v_mfma_f32_16x16x32_bf16 v[212:215], a[52:55], v[56:59], v[212:215]
v_exp_f32 v37, v37
v_mfma_f32_16x16x32_bf16 v[180:183], a[52:55], v[52:55], v[180:183]
ds_read_b128 a[24:27], v1 offset:14336
v_cvt_pk_bf16_f32 v70, v36, v37
v_mfma_f32_16x16x32_bf16 v[148:151], a[52:55], v[48:51], v[148:151]
v_mfma_f32_16x16x32_bf16 v[152:155], a[56:59], v[48:51], v[152:155]
v_exp_f32 v38, v38
v_mfma_f32_16x16x32_bf16 v[184:187], a[56:59], v[52:55], v[184:187]
v_exp_f32 v39, v39
v_mfma_f32_16x16x32_bf16 v[216:219], a[56:59], v[56:59], v[216:219]
ds_read_b128 a[28:31], v1 offset:15360
v_cvt_pk_bf16_f32 v71, v38, v39
v_mfma_f32_16x16x32_bf16 v[248:251], a[56:59], v[60:63], v[248:251]
v_exp_f32 v40, v40
v_mfma_f32_16x16x32_bf16 v[252:255], a[60:63], v[60:63], v[252:255]
v_mfma_f32_16x16x32_bf16 v[220:223], a[60:63], v[56:59], v[220:223]
v_exp_f32 v41, v41
v_mfma_f32_16x16x32_bf16 v[188:191], a[60:63], v[52:55], v[188:191]
ds_read_b128 a[32:35], v1 offset:0
v_cvt_pk_bf16_f32 v74, v40, v41
v_mfma_f32_16x16x32_bf16 v[156:159], a[60:63], v[48:51], v[156:159]
v_exp_f32 v42, v42
v_smfmac_f32_16x16x64_bf16 a[224:227], a[232:235], v[48:55], v9
buffer_load_dwordx4 v3, s[48:51], s32 offen offset:2048 sc1 lds
v_smfmac_f32_16x16x64_bf16 a[228:231], a[232:235], v[56:63], v9
s_waitcnt lgkmcnt(5)
v_mfma_f32_16x16x32_bf16 v[16:19], a[0:3], a[160:163], v[96:99]
ds_read_b128 a[36:39], v1 offset:1024
v_mfma_f32_16x16x32_bf16 v[16:19], a[4:7], a[164:167], v[16:19]
v_exp_f32 v43, v43
v_mfma_f32_16x16x32_bf16 v[16:19], a[8:11], a[168:171], v[16:19]
v_exp_f32 v44, v44
v_mfma_f32_16x16x32_bf16 v[16:19], a[12:15], a[172:175], v[16:19]
v_exp_f32 v45, v45
v_mfma_f32_16x16x32_bf16 v[20:23], a[0:3], a[176:179], v[84:87]
ds_read_b128 a[40:43], v1 offset:2048
v_cvt_pk_bf16_f32 v75, v42, v43
v_mfma_f32_16x16x32_bf16 v[20:23], a[4:7], a[180:183], v[20:23]
v_cvt_pk_bf16_f32 v78, v44, v45
v_mfma_f32_16x16x32_bf16 v[20:23], a[8:11], a[184:187], v[20:23]
v_exp_f32 v46, v46
v_mfma_f32_16x16x32_bf16 v[20:23], a[12:15], a[188:191], v[20:23]
ds_read_b128 a[44:47], v1 offset:3072
v_mfma_f32_16x16x32_bf16 v[24:27], a[0:3], a[192:195], v[88:91]
v_exp_f32 v47, v47
v_mfma_f32_16x16x32_bf16 v[24:27], a[4:7], a[196:199], v[24:27]
v_cvt_pk_bf16_f32 v79, v46, v47
v_mfma_f32_16x16x32_bf16 v[24:27], a[8:11], a[200:203], v[24:27]
buffer_load_dwordx4 v3, s[48:51], s32 offen offset:3072 sc1 lds
v_mfma_f32_16x16x32_bf16 v[24:27], a[12:15], a[204:207], v[24:27]
ds_read_b128 a[48:51], v1 offset:4096
v_mfma_f32_16x16x32_bf16 v[28:31], a[0:3], a[208:211], v[92:95]
v_exp_f32 v16, v16
v_mfma_f32_16x16x32_bf16 v[28:31], a[4:7], a[212:215], v[28:31]
v_exp_f32 v17, v17
v_mfma_f32_16x16x32_bf16 v[28:31], a[8:11], a[216:219], v[28:31]
s_waitcnt lgkmcnt(5)
v_exp_f32 v18, v18
v_mfma_f32_16x16x32_bf16 v[28:31], a[12:15], a[220:223], v[28:31]
ds_read_b128 a[52:55], v1 offset:5120
v_cvt_pk_bf16_f32 v48, v16, v17
v_mfma_f32_16x16x32_bf16 v[32:35], a[16:19], a[160:163], v[100:103]
v_mfma_f32_16x16x32_bf16 v[32:35], a[20:23], a[164:167], v[32:35]
v_exp_f32 v19, v19
v_mfma_f32_16x16x32_bf16 v[32:35], a[24:27], a[168:171], v[32:35]
v_exp_f32 v20, v20
v_mfma_f32_16x16x32_bf16 v[32:35], a[28:31], a[172:175], v[32:35]
ds_read_b128 a[56:59], v1 offset:6144
v_cvt_pk_bf16_f32 v49, v18, v19
v_mfma_f32_16x16x32_bf16 v[36:39], a[16:19], a[176:179], v[84:87]
v_mfma_f32_16x16x32_bf16 v[36:39], a[20:23], a[180:183], v[36:39]
v_exp_f32 v21, v21
v_mfma_f32_16x16x32_bf16 v[36:39], a[24:27], a[184:187], v[36:39]
s_add_u32 m0, s27, 0x1000
v_exp_f32 v22, v22
v_mfma_f32_16x16x32_bf16 v[36:39], a[28:31], a[188:191], v[36:39]
buffer_load_dwordx4 v3, s[48:51], s7 offen offset:0 sc1 lds
v_mfma_f32_16x16x32_bf16 v[40:43], a[16:19], a[192:195], v[88:91]
ds_read_b128 a[60:63], v1 offset:7168
v_cvt_pk_bf16_f32 v52, v20, v21
v_mfma_f32_16x16x32_bf16 v[40:43], a[20:23], a[196:199], v[40:43]
v_exp_f32 v23, v23
v_mfma_f32_16x16x32_bf16 v[40:43], a[24:27], a[200:203], v[40:43]
v_cvt_pk_bf16_f32 v53, v22, v23
v_mfma_f32_16x16x32_bf16 v[40:43], a[28:31], a[204:207], v[40:43]
v_exp_f32 v24, v24
v_mfma_f32_16x16x32_bf16 v[44:47], a[16:19], a[208:211], v[92:95]
v_exp_f32 v25, v25
v_mfma_f32_16x16x32_bf16 v[44:47], a[20:23], a[212:215], v[44:47]
v_exp_f32 v26, v26
v_mfma_f32_16x16x32_bf16 v[44:47], a[24:27], a[216:219], v[44:47]
v_exp_f32 v27, v27
v_mfma_f32_16x16x32_bf16 v[44:47], a[28:31], a[220:223], v[44:47]
s_waitcnt lgkmcnt(0)
v_mfma_f32_16x16x32_bf16 v[128:131], a[32:35], v[64:67], v[128:131]
ds_read_b128 a[0:3], v1 offset:24576
v_cvt_pk_bf16_f32 v56, v24, v25
v_mfma_f32_16x16x32_bf16 v[160:163], a[32:35], v[68:71], v[160:163]
v_exp_f32 v28, v28
v_mfma_f32_16x16x32_bf16 v[192:195], a[32:35], v[72:75], v[192:195]
v_cvt_pk_bf16_f32 v57, v26, v27
v_mfma_f32_16x16x32_bf16 v[224:227], a[32:35], v[76:79], v[224:227]
ds_read_b128 a[4:7], v1 offset:25600
v_mfma_f32_16x16x32_bf16 v[228:231], a[36:39], v[76:79], v[228:231]
v_exp_f32 v29, v29
v_mfma_f32_16x16x32_bf16 v[196:199], a[36:39], v[72:75], v[196:199]
v_exp_f32 v30, v30
v_mfma_f32_16x16x32_bf16 v[164:167], a[36:39], v[68:71], v[164:167]
buffer_load_dwordx4 v3, s[48:51], s7 offen offset:1024 sc1 lds
v_mfma_f32_16x16x32_bf16 v[132:135], a[36:39], v[64:67], v[132:135]
ds_read_b128 a[8:11], v1 offset:26624
v_cvt_pk_bf16_f32 v60, v28, v29
v_mfma_f32_16x16x32_bf16 v[136:139], a[40:43], v[64:67], v[136:139]
v_mfma_f32_16x16x32_bf16 v[168:171], a[40:43], v[68:71], v[168:171]
ds_read_b128 a[12:15], v1 offset:27648
v_mfma_f32_16x16x32_bf16 v[200:203], a[40:43], v[72:75], v[200:203]
v_exp_f32 v31, v31
v_mfma_f32_16x16x32_bf16 v[232:235], a[40:43], v[76:79], v[232:235]
v_exp_f32 v32, v32
v_mfma_f32_16x16x32_bf16 v[236:239], a[44:47], v[76:79], v[236:239]
v_exp_f32 v33, v33
v_mfma_f32_16x16x32_bf16 v[204:207], a[44:47], v[72:75], v[204:207]
ds_read_b128 a[16:19], v1 offset:28672
v_cvt_pk_bf16_f32 v61, v30, v31
v_mfma_f32_16x16x32_bf16 v[172:175], a[44:47], v[68:71], v[172:175]
v_cvt_pk_bf16_f32 v50, v32, v33
v_mfma_f32_16x16x32_bf16 v[140:143], a[44:47], v[64:67], v[140:143]
v_exp_f32 v34, v34
v_mfma_f32_16x16x32_bf16 v[144:147], a[48:51], v[64:67], v[144:147]
ds_read_b128 a[20:23], v1 offset:29696
v_mfma_f32_16x16x32_bf16 v[176:179], a[48:51], v[68:71], v[176:179]
v_exp_f32 v35, v35
v_mfma_f32_16x16x32_bf16 v[208:211], a[48:51], v[72:75], v[208:211]
v_exp_f32 v36, v36
v_mfma_f32_16x16x32_bf16 v[240:243], a[48:51], v[76:79], v[240:243]
buffer_load_dwordx4 v3, s[48:51], s7 offen offset:2048 sc1 lds
v_mfma_f32_16x16x32_bf16 v[244:247], a[52:55], v[76:79], v[244:247]
ds_read_b128 a[24:27], v1 offset:30720
v_cvt_pk_bf16_f32 v51, v34, v35
v_mfma_f32_16x16x32_bf16 v[212:215], a[52:55], v[72:75], v[212:215]
v_mfma_f32_16x16x32_bf16 v[180:183], a[52:55], v[68:71], v[180:183]
ds_read_b128 a[28:31], v1 offset:31744
v_mfma_f32_16x16x32_bf16 v[148:151], a[52:55], v[64:67], v[148:151]
v_exp_f32 v37, v37
v_mfma_f32_16x16x32_bf16 v[152:155], a[56:59], v[64:67], v[152:155]
v_exp_f32 v38, v38
v_mfma_f32_16x16x32_bf16 v[184:187], a[56:59], v[68:71], v[184:187]
v_exp_f32 v39, v39
v_mfma_f32_16x16x32_bf16 v[216:219], a[56:59], v[72:75], v[216:219]
ds_read_b128 a[32:35], v1 offset:16384
v_cvt_pk_bf16_f32 v54, v36, v37
v_mfma_f32_16x16x32_bf16 v[248:251], a[56:59], v[76:79], v[248:251]
v_cvt_pk_bf16_f32 v55, v38, v39
v_mfma_f32_16x16x32_bf16 v[252:255], a[60:63], v[76:79], v[252:255]
v_exp_f32 v40, v40
v_mfma_f32_16x16x32_bf16 v[220:223], a[60:63], v[72:75], v[220:223]
ds_read_b128 a[36:39], v1 offset:17408
v_mfma_f32_16x16x32_bf16 v[188:191], a[60:63], v[68:71], v[188:191]
v_exp_f32 v41, v41
v_mfma_f32_16x16x32_bf16 v[156:159], a[60:63], v[64:67], v[156:159]
s_waitcnt lgkmcnt(6)
v_exp_f32 v42, v42
v_smfmac_f32_16x16x64_bf16 a[224:227], a[232:235], v[64:71], v9
buffer_load_dwordx4 v3, s[48:51], s7 offen offset:3072 sc1 lds
v_smfmac_f32_16x16x64_bf16 a[228:231], a[232:235], v[72:79], v9
ds_read_b128 a[40:43], v1 offset:18432
v_cvt_pk_bf16_f32 v58, v40, v41
v_mfma_f32_16x16x32_bf16 v[20:23], a[0:3], a[176:179], v[84:87]
v_mfma_f32_16x16x32_bf16 v[20:23], a[4:7], a[180:183], v[20:23]
ds_read_b128 a[44:47], v1 offset:19456
v_mfma_f32_16x16x32_bf16 v[20:23], a[8:11], a[184:187], v[20:23]
v_exp_f32 v43, v43
v_mfma_f32_16x16x32_bf16 v[20:23], a[12:15], a[188:191], v[20:23]
v_exp_f32 v44, v44
v_mfma_f32_16x16x32_bf16 v[24:27], a[0:3], a[192:195], v[88:91]
v_cvt_pk_bf16_f32 v59, v42, v43
v_mfma_f32_16x16x32_bf16 v[24:27], a[4:7], a[196:199], v[24:27]
ds_read_b128 a[48:51], v1 offset:20480
v_mfma_f32_16x16x32_bf16 v[24:27], a[8:11], a[200:203], v[24:27]
v_exp_f32 v45, v45
v_mfma_f32_16x16x32_bf16 v[24:27], a[12:15], a[204:207], v[24:27]
v_exp_f32 v46, v46
v_mfma_f32_16x16x32_bf16 v[28:31], a[0:3], a[208:211], v[92:95]
ds_read_b128 a[52:55], v1 offset:21504
v_cvt_pk_bf16_f32 v62, v44, v45
v_mfma_f32_16x16x32_bf16 v[28:31], a[4:7], a[212:215], v[28:31]
s_waitcnt lgkmcnt(6)
v_exp_f32 v47, v47
v_mfma_f32_16x16x32_bf16 v[28:31], a[8:11], a[216:219], v[28:31]
s_mov_b32 s9, 0x0
v_cvt_pk_bf16_f32 v63, v46, v47
v_mfma_f32_16x16x32_bf16 v[28:31], a[12:15], a[220:223], v[28:31]
buffer_load_dword a244, v8, s[72:75], s9 offen
v_mfma_f32_16x16x32_bf16 v[36:39], a[16:19], a[176:179], v[84:87]
ds_read_b128 a[56:59], v1 offset:22528
v_mfma_f32_16x16x32_bf16 v[36:39], a[20:23], a[180:183], v[36:39]
s_add_u32 s32, s32, 0x8000
v_exp_f32 v20, v20
v_mfma_f32_16x16x32_bf16 v[36:39], a[24:27], a[184:187], v[36:39]
ds_read_b128 a[60:63], v1 offset:23552
v_xor_b32 v1, 0x8000, v1
v_mfma_f32_16x16x32_bf16 v[36:39], a[28:31], a[188:191], v[36:39]
s_add_u32 s7, s7, 0x8000
v_exp_f32 v21, v21
v_mfma_f32_16x16x32_bf16 v[40:43], a[16:19], a[192:195], v[88:91]
s_xor_b32 s27, s27, 0x38000
v_exp_f32 v22, v22
v_mfma_f32_16x16x32_bf16 v[40:43], a[20:23], a[196:199], v[40:43]
v_cvt_pk_bf16_f32 v68, v20, v21
v_mfma_f32_16x16x32_bf16 v[40:43], a[24:27], a[200:203], v[40:43]
v_exp_f32 v23, v23
v_mfma_f32_16x16x32_bf16 v[40:43], a[28:31], a[204:207], v[40:43]
v_exp_f32 v24, v24
v_mfma_f32_16x16x32_bf16 v[44:47], a[16:19], a[208:211], v[92:95]
v_exp_f32 v25, v25
v_mfma_f32_16x16x32_bf16 v[44:47], a[20:23], a[212:215], v[44:47]
v_exp_f32 v26, v26
v_mfma_f32_16x16x32_bf16 v[44:47], a[24:27], a[216:219], v[44:47]
s_waitcnt vmcnt(17) lgkmcnt(0)
v_exp_f32 v27, v27
v_mfma_f32_16x16x32_bf16 v[44:47], a[28:31], a[220:223], v[44:47]
s_barrier
v_cvt_pk_bf16_f32 v69, v22, v23
L_att_l1_0:
v_mfma_f32_16x16x32_bf16 v[128:131], a[32:35], v[48:51], v[128:131]
ds_read_b128 a[0:3], v2 offset:8192
v_cvt_pk_bf16_f32 v72, v24, v25
v_mfma_f32_16x16x32_bf16 v[160:163], a[32:35], v[52:55], v[160:163]
s_add_u32 m0, s19, 0x0
v_exp_f32 v28, v28
v_mfma_f32_16x16x32_bf16 v[192:195], a[32:35], v[56:59], v[192:195]
buffer_load_dwordx4 v3, s[48:51], s32 offen offset:0 sc1 lds
v_mfma_f32_16x16x32_bf16 v[224:227], a[32:35], v[60:63], v[224:227]
ds_read_b128 a[4:7], v2 offset:9216
v_cvt_pk_bf16_f32 v73, v26, v27
v_mfma_f32_16x16x32_bf16 v[228:231], a[36:39], v[60:63], v[228:231]
s_and_b32 s44, s18, 3
s_lshl_b32 s45, s44, 1
s_add_u32 s45, s45, s100
v_mfma_f32_16x16x32_bf16 v[196:199], a[36:39], v[56:59], v[196:199]
s_add_u32 s8, s16, 0x0
v_exp_f32 v29, v29
v_mfma_f32_16x16x32_bf16 v[164:167], a[36:39], v[52:55], v[164:167]
ds_read_b128 a[8:11], v2 offset:10240
v_cvt_pk_bf16_f32 v76, v28, v29
v_mfma_f32_16x16x32_bf16 v[132:135], a[36:39], v[48:51], v[132:135]
buffer_store_dwordx4 a[64:67], v3, s[88:91], s8 offen offset:0 sc1
v_mfma_f32_16x16x32_bf16 v[136:139], a[40:43], v[48:51], v[136:139]
s_and_b32 s60, s45, 3
v_exp_f32 v30, v30
v_mfma_f32_16x16x32_bf16 v[168:171], a[40:43], v[52:55], v[168:171]
ds_read_b128 a[12:15], v2 offset:11264
s_sub_u32 s60, s60, s44
v_mfma_f32_16x16x32_bf16 v[200:203], a[40:43], v[56:59], v[200:203]
s_add_u32 s60, s60, 11
v_exp_f32 v31, v31
v_mfma_f32_16x16x32_bf16 v[232:235], a[40:43], v[60:63], v[232:235]
s_lshl_b32 s60, s60, 14
s_mul_i32 s44, s44, -8
v_cvt_pk_bf16_f32 v77, v30, v31
v_mfma_f32_16x16x32_bf16 v[236:239], a[44:47], v[60:63], v[236:239]
buffer_load_dwordx4 v3, s[48:51], s32 offen offset:1024 sc1 lds
v_mfma_f32_16x16x32_bf16 v[204:207], a[44:47], v[56:59], v[204:207]
ds_read_b128 a[16:19], v2 offset:12288
s_and_b32 s44, s44, 31
v_mfma_f32_16x16x32_bf16 v[172:175], a[44:47], v[52:55], v[172:175]
s_lshl_b32 s44, 4, s44
v_exp_f32 v36, v36
v_mfma_f32_16x16x32_bf16 v[140:143], a[44:47], v[48:51], v[140:143]
s_mul_i32 s45, s45, -8
v_exp_f32 v37, v37
v_mfma_f32_16x16x32_bf16 v[144:147], a[48:51], v[48:51], v[144:147]
ds_read_b128 a[20:23], v2 offset:13312
v_cvt_pk_bf16_f32 v70, v36, v37
v_mfma_f32_16x16x32_bf16 v[176:179], a[48:51], v[52:55], v[176:179]
buffer_store_dwordx4 a[64:67], v3, s[88:91], s8 offen offset:1024 sc1
v_mfma_f32_16x16x32_bf16 v[208:211], a[48:51], v[56:59], v[208:211]
s_and_b32 s45, s45, 31
v_exp_f32 v38, v38
v_mfma_f32_16x16x32_bf16 v[240:243], a[48:51], v[60:63], v[240:243]
ds_read_b128 a[24:27], v2 offset:14336
s_lshl_b32 s45, 4, s45
v_mfma_f32_16x16x32_bf16 v[244:247], a[52:55], v[60:63], v[244:247]
s_add_u32 s44, s44, 0x11111111
s_sub_u32 s44, s44, s45
s_bfe_u32 s56, s44, 0x80000
v_mfma_f32_16x16x32_bf16 v[212:215], a[52:55], v[56:59], v[212:215]
s_lshl_b32 s56, s56, 14
v_exp_f32 v39, v39
v_mfma_f32_16x16x32_bf16 v[180:183], a[52:55], v[52:55], v[180:183]
buffer_load_dwordx4 v3, s[48:51], s32 offen offset:2048 sc1 lds
v_mfma_f32_16x16x32_bf16 v[148:151], a[52:55], v[48:51], v[148:151]
ds_read_b128 a[28:31], v2 offset:15360
v_cvt_pk_bf16_f32 v71, v38, v39
v_mfma_f32_16x16x32_bf16 v[152:155], a[56:59], v[48:51], v[152:155]
s_bfe_u32 s57, s44, 0x80008
v_exp_f32 v40, v40
v_mfma_f32_16x16x32_bf16 v[184:187], a[56:59], v[52:55], v[184:187]
s_lshl_b32 s57, s57, 14
v_exp_f32 v41, v41
v_mfma_f32_16x16x32_bf16 v[216:219], a[56:59], v[56:59], v[216:219]
ds_read_b128 a[32:35], v2 offset:0
v_cvt_pk_bf16_f32 v74, v40, v41
v_mfma_f32_16x16x32_bf16 v[248:251], a[56:59], v[60:63], v[248:251]
s_bfe_u32 s58, s44, 0x80010
v_exp_f32 v42, v42
v_mfma_f32_16x16x32_bf16 v[252:255], a[60:63], v[60:63], v[252:255]
buffer_store_dwordx4 a[64:67], v3, s[88:91], s8 offen offset:2048 sc1
v_mfma_f32_16x16x32_bf16 v[220:223], a[60:63], v[56:59], v[220:223]
ds_read_b128 a[36:39], v2 offset:1024
s_lshl_b32 s58, s58, 14
v_mfma_f32_16x16x32_bf16 v[188:191], a[60:63], v[52:55], v[188:191]
s_bfe_u32 s59, s44, 0x80018
s_lshl_b32 s59, s59, 14
v_mov_b32 v6, 0xf149f2ca
v_mfma_f32_16x16x32_bf16 v[156:159], a[60:63], v[48:51], v[156:159]
v_exp_f32 v43, v43
v_smfmac_f32_16x16x64_bf16 a[224:227], a[232:235], v[48:55], v9
s_waitcnt lgkmcnt(6)
v_exp_f32 v44, v44
v_smfmac_f32_16x16x64_bf16 a[228:231], a[232:235], v[56:63], v9
buffer_load_dwordx4 v3, s[48:51], s32 offen offset:3072 sc1 lds
v_mfma_f32_16x16x32_bf16 v[20:23], a[0:3], a[176:179], v[84:87]
ds_read_b128 a[40:43], v2 offset:2048
v_cvt_pk_bf16_f32 v75, v42, v43
v_mfma_f32_16x16x32_bf16 v[20:23], a[4:7], a[180:183], v[20:23]
v_exp_f32 v45, v45
v_mfma_f32_16x16x32_bf16 v[20:23], a[8:11], a[184:187], v[20:23]
ds_read_b128 a[44:47], v2 offset:3072
v_cvt_pk_bf16_f32 v78, v44, v45
v_mfma_f32_16x16x32_bf16 v[20:23], a[12:15], a[188:191], v[20:23]
v_min_f32 v119, s10, v88
v_cndmask_b32 v112, v119, v88, s[36:37]
v_mfma_f32_16x16x32_bf16 v[24:27], a[0:3], a[192:195], v[88:91]
buffer_store_dwordx4 a[64:67], v3, s[88:91], s8 offen offset:3072 sc1
v_mfma_f32_16x16x32_bf16 v[24:27], a[4:7], a[196:199], v[24:27]
ds_read_b128 a[48:51], v2 offset:4096
v_cndmask_b32 v113, v119, v88, s[38:39]
v_mfma_f32_16x16x32_bf16 v[24:27], a[8:11], a[200:203], v[24:27]
v_exp_f32 v46, v46
v_mfma_f32_16x16x32_bf16 v[24:27], a[12:15], a[204:207], v[24:27]
v_exp_f32 v47, v47
v_mfma_f32_16x16x32_bf16 v[28:31], a[0:3], a[208:211], v[92:95]
s_add_u32 m0, s19, 0x1000
v_exp_f32 v20, v20
v_mfma_f32_16x16x32_bf16 v[28:31], a[4:7], a[212:215], v[28:31]
buffer_load_dwordx4 v3, s[48:51], s7 offen offset:0 sc1 lds
v_mfma_f32_16x16x32_bf16 v[28:31], a[8:11], a[216:219], v[28:31]
ds_read_b128 a[52:55], v2 offset:5120
v_cvt_pk_bf16_f32 v79, v46, v47
v_mfma_f32_16x16x32_bf16 v[28:31], a[12:15], a[220:223], v[28:31]
s_waitcnt lgkmcnt(6)
v_exp_f32 v21, v21
v_mfma_f32_16x16x32_bf16 v[36:39], a[16:19], a[176:179], v[84:87]
ds_read_b128 a[56:59], v2 offset:6144
v_cvt_pk_bf16_f32 v52, v20, v21
v_mfma_f32_16x16x32_bf16 v[36:39], a[20:23], a[180:183], v[36:39]
s_add_u32 s8, s16, 0x400000
v_cndmask_b32 v114, v119, v88, s[40:41]
v_cndmask_b32 v115, v119, v88, s[42:43]
v_mfma_f32_16x16x32_bf16 v[36:39], a[24:27], a[184:187], v[36:39]
buffer_store_dwordx4 a[64:67], v3, s[88:91], s8 offen offset:0 sc1
v_mfma_f32_16x16x32_bf16 v[36:39], a[28:31], a[188:191], v[36:39]
ds_read_b128 a[60:63], v2 offset:7168
v_cndmask_b32 v116, v6, v119, s[36:37]
v_mfma_f32_16x16x32_bf16 v[40:43], a[16:19], a[192:195], v[88:91]
v_exp_f32 v22, v22
v_mfma_f32_16x16x32_bf16 v[40:43], a[20:23], a[196:199], v[40:43]
v_exp_f32 v23, v23
v_mfma_f32_16x16x32_bf16 v[40:43], a[24:27], a[200:203], v[40:43]
v_exp_f32 v24, v24
v_mfma_f32_16x16x32_bf16 v[40:43], a[28:31], a[204:207], v[40:43]
buffer_load_dwordx4 v3, s[48:51], s7 offen offset:1024 sc1 lds
v_mfma_f32_16x16x32_bf16 v[44:47], a[16:19], a[208:211], v[92:95]
v_exp_f32 v25, v25
v_mfma_f32_16x16x32_bf16 v[44:47], a[20:23], a[212:215], v[44:47]
v_exp_f32 v26, v26
v_mfma_f32_16x16x32_bf16 v[44:47], a[24:27], a[216:219], v[44:47]
v_exp_f32 v27, v27
v_mfma_f32_16x16x32_bf16 v[44:47], a[28:31], a[220:223], v[44:47]
s_waitcnt lgkmcnt(0)
v_cvt_pk_bf16_f32 v53, v22, v23
v_cndmask_b32 v117, v6, v119, s[38:39]
v_cndmask_b32 v118, v6, v119, s[40:41]
v_cndmask_b32 v119, v6, v119, s[42:43]
v_min_f32 v127, s11, v92
v_cndmask_b32 v120, v127, v92, s[36:37]
v_cndmask_b32 v121, v127, v92, s[38:39]
v_cndmask_b32 v122, v127, v92, s[40:41]
v_cndmask_b32 v123, v127, v92, s[42:43]
v_cndmask_b32 v124, v6, v127, s[36:37]
v_cndmask_b32 v125, v6, v127, s[38:39]
v_cndmask_b32 v126, v6, v127, s[40:41]
v_cndmask_b32 v127, v6, v127, s[42:43]
v_mfma_f32_16x16x32_bf16 v[160:163], a[32:35], v[68:71], v[160:163]
ds_read_b128 a[0:3], v2 offset:24576
v_cvt_pk_bf16_f32 v56, v24, v25
v_mfma_f32_16x16x32_bf16 v[192:195], a[32:35], v[72:75], v[192:195]
v_exp_f32 v28, v28
v_mfma_f32_16x16x32_bf16 v[224:227], a[32:35], v[76:79], v[224:227]
buffer_store_dwordx4 a[64:67], v3, s[88:91], s8 offen offset:1024 sc1
v_mfma_f32_16x16x32_bf16 v[228:231], a[36:39], v[76:79], v[228:231]
ds_read_b128 a[4:7], v2 offset:25600
v_cvt_pk_bf16_f32 v57, v26, v27
v_mfma_f32_16x16x32_bf16 v[196:199], a[36:39], v[72:75], v[196:199]
v_exp_f32 v29, v29
v_mfma_f32_16x16x32_bf16 v[164:167], a[36:39], v[68:71], v[164:167]
ds_read_b128 a[8:11], v2 offset:26624
v_cvt_pk_bf16_f32 v60, v28, v29
v_mfma_f32_16x16x32_bf16 v[168:171], a[40:43], v[68:71], v[168:171]
buffer_load_dwordx4 v3, s[48:51], s7 offen offset:2048 sc1 lds
v_mfma_f32_16x16x32_bf16 v[200:203], a[40:43], v[72:75], v[200:203]
v_exp_f32 v30, v30
v_mfma_f32_16x16x32_bf16 v[232:235], a[40:43], v[76:79], v[232:235]
ds_read_b128 a[12:15], v2 offset:27648
v_mfma_f32_16x16x32_bf16 v[236:239], a[44:47], v[76:79], v[236:239]
v_exp_f32 v31, v31
v_mfma_f32_16x16x32_bf16 v[204:207], a[44:47], v[72:75], v[204:207]
buffer_store_dwordx4 a[64:67], v3, s[88:91], s8 offen offset:2048 sc1
v_mfma_f32_16x16x32_bf16 v[172:175], a[44:47], v[68:71], v[172:175]
ds_read_b128 a[16:19], v2 offset:28672
v_cvt_pk_bf16_f32 v61, v30, v31
v_mfma_f32_16x16x32_bf16 v[176:179], a[48:51], v[68:71], v[176:179]
v_exp_f32 v36, v36
v_mfma_f32_16x16x32_bf16 v[208:211], a[48:51], v[72:75], v[208:211]
ds_read_b128 a[20:23], v2 offset:29696
v_mfma_f32_16x16x32_bf16 v[240:243], a[48:51], v[76:79], v[240:243]
buffer_load_dwordx4 v3, s[48:51], s7 offen offset:3072 sc1 lds
v_mfma_f32_16x16x32_bf16 v[244:247], a[52:55], v[76:79], v[244:247]
v_exp_f32 v37, v37
v_mfma_f32_16x16x32_bf16 v[212:215], a[52:55], v[72:75], v[212:215]
ds_read_b128 a[24:27], v2 offset:30720
v_cvt_pk_bf16_f32 v54, v36, v37
v_mfma_f32_16x16x32_bf16 v[180:183], a[52:55], v[68:71], v[180:183]
v_exp_f32 v38, v38
v_mfma_f32_16x16x32_bf16 v[184:187], a[56:59], v[68:71], v[184:187]
buffer_store_dwordx4 a[64:67], v3, s[88:91], s8 offen offset:3072 sc1
v_mfma_f32_16x16x32_bf16 v[216:219], a[56:59], v[72:75], v[216:219]
ds_read_b128 a[28:31], v2 offset:31744
v_mfma_f32_16x16x32_bf16 v[248:251], a[56:59], v[76:79], v[248:251]
v_exp_f32 v39, v39
v_mfma_f32_16x16x32_bf16 v[252:255], a[60:63], v[76:79], v[252:255]
s_add_u32 s8, s16, 0x800000
v_exp_f32 v40, v40
v_mfma_f32_16x16x32_bf16 v[220:223], a[60:63], v[72:75], v[220:223]
ds_read_b128 a[32:35], v2 offset:16384
v_cvt_pk_bf16_f32 v55, v38, v39
v_mfma_f32_16x16x32_bf16 v[188:191], a[60:63], v[68:71], v[188:191]
buffer_store_dwordx4 a[64:67], v3, s[88:91], s8 offen offset:0 sc1
v_mfma_f32_16x16x32_bf16 a[224:227], a[236:239], v[68:71], a[224:227]
ds_read_b128 a[36:39], v2 offset:17408
v_exp_f32 v41, v41
v_smfmac_f32_16x16x64_bf16 a[228:231], a[232:235], v[72:79], v9
s_waitcnt lgkmcnt(6)
v_exp_f32 v42, v42
v_mfma_f32_16x16x32_bf16 v[20:23], a[0:3], a[176:179], v[104:107]
v_exp_f32 v43, v43
v_mfma_f32_16x16x32_bf16 v[20:23], a[4:7], a[180:183], v[20:23]
buffer_store_dwordx4 a[64:67], v3, s[88:91], s8 offen offset:1024 sc1
v_mfma_f32_16x16x32_bf16 v[20:23], a[8:11], a[184:187], v[20:23]
ds_read_b128 a[40:43], v2 offset:18432
v_cvt_pk_bf16_f32 v58, v40, v41
v_mfma_f32_16x16x32_bf16 v[20:23], a[12:15], a[188:191], v[20:23]
v_exp_f32 v44, v44
v_mfma_f32_16x16x32_bf16 v[24:27], a[0:3], a[192:195], v[88:91]
ds_read_b128 a[44:47], v2 offset:19456
v_cvt_pk_bf16_f32 v59, v42, v43
v_mfma_f32_16x16x32_bf16 v[24:27], a[4:7], a[196:199], v[24:27]
buffer_store_dwordx4 a[64:67], v3, s[88:91], s8 offen offset:2048 sc1
v_mfma_f32_16x16x32_bf16 v[24:27], a[8:11], a[200:203], v[24:27]
v_exp_f32 v45, v45
v_mfma_f32_16x16x32_bf16 v[24:27], a[12:15], a[204:207], v[24:27]
ds_read_b128 a[48:51], v2 offset:20480
v_cvt_pk_bf16_f32 v62, v44, v45
v_mfma_f32_16x16x32_bf16 v[28:31], a[0:3], a[208:211], v[92:95]
v_exp_f32 v46, v46
v_mfma_f32_16x16x32_bf16 v[28:31], a[4:7], a[212:215], v[28:31]
buffer_store_dwordx4 a[64:67], v3, s[88:91], s8 offen offset:3072 sc1
v_mfma_f32_16x16x32_bf16 v[28:31], a[8:11], a[216:219], v[28:31]
ds_read_b128 a[52:55], v2 offset:21504
v_add_u32 v4, s0, v3
v_mfma_f32_16x16x32_bf16 v[28:31], a[12:15], a[220:223], v[28:31]
s_waitcnt lgkmcnt(6)
v_exp_f32 v47, v47
v_mfma_f32_16x16x32_bf16 v[36:39], a[16:19], a[176:179], v[108:111]
ds_read_b128 a[56:59], v2 offset:22528
v_mov_b32 v5, s1
v_mfma_f32_16x16x32_bf16 v[36:39], a[20:23], a[180:183], v[36:39]
global_load_dword a244, v[4:5], off sc1
v_mfma_f32_16x16x32_bf16 v[36:39], a[24:27], a[184:187], v[36:39]
s_add_u32 s32, s32, 0x8000
v_exp_f32 v20, v20
v_mfma_f32_16x16x32_bf16 v[36:39], a[28:31], a[188:191], v[36:39]
ds_read_b128 a[60:63], v2 offset:23552
v_xor_b32 v2, 0x38000, v2
v_mfma_f32_16x16x32_bf16 v[40:43], a[16:19], a[192:195], v[88:91]
s_add_u32 s7, s7, 0x8000
v_exp_f32 v21, v21
v_mfma_f32_16x16x32_bf16 v[40:43], a[20:23], a[196:199], v[40:43]
s_xor_b32 s19, s19, 0x8000
v_exp_f32 v22, v22
v_mfma_f32_16x16x32_bf16 v[40:43], a[24:27], a[200:203], v[40:43]
s_sub_u32 s15, 7, s6
v_exp_f32 v23, v23
v_mfma_f32_16x16x32_bf16 v[40:43], a[28:31], a[204:207], v[40:43]
s_lshl_b32 s15, s15, 1
v_exp_f32 v24, v24
v_cvt_pk_bf16_f32 v63, v46, v47
v_mfma_f32_16x16x32_bf16 v[44:47], a[16:19], a[208:211], v[92:95]
v_exp_f32 v25, v25
v_mfma_f32_16x16x32_bf16 v[44:47], a[20:23], a[212:215], v[44:47]
v_exp_f32 v26, v26
v_mfma_f32_16x16x32_bf16 v[44:47], a[24:27], a[216:219], v[44:47]
s_waitcnt vmcnt(30) lgkmcnt(0)
v_exp_f32 v27, v27
v_mfma_f32_16x16x32_bf16 v[44:47], a[28:31], a[220:223], v[44:47]
s_barrier
v_cvt_pk_bf16_f32 v68, v20, v21
v_cvt_pk_bf16_f32 v69, v22, v23
s_cbranch_scc0 L_att_lh0_0
L_att_ls_0:
v_mfma_f32_16x16x32_bf16 v[160:163], a[32:35], v[52:55], v[160:163]
ds_read_b128 a[0:3], v1 offset:8192
v_cvt_pk_bf16_f32 v72, v24, v25
v_mfma_f32_16x16x32_bf16 v[192:195], a[32:35], v[56:59], v[192:195]
v_exp_f32 v28, v28
v_mfma_f32_16x16x32_bf16 v[224:227], a[32:35], v[60:63], v[224:227]
ds_read_b128 a[4:7], v1 offset:9216
v_cvt_pk_bf16_f32 v73, v26, v27
v_mfma_f32_16x16x32_bf16 v[228:231], a[36:39], v[60:63], v[228:231]
s_add_u32 m0, s27, 0x0
v_exp_f32 v29, v29
v_mfma_f32_16x16x32_bf16 v[196:199], a[36:39], v[56:59], v[196:199]
buffer_load_dwordx4 v3, s[48:51], s32 offen offset:0 sc1 lds
v_mfma_f32_16x16x32_bf16 v[164:167], a[36:39], v[52:55], v[164:167]
ds_read_b128 a[8:11], v1 offset:10240
v_cvt_pk_bf16_f32 v76, v28, v29
v_mfma_f32_16x16x32_bf16 v[168:171], a[40:43], v[52:55], v[168:171]
ds_read_b128 a[12:15], v1 offset:11264
v_accvgpr_read_b32 v6, a224
v_mfma_f32_16x16x32_bf16 v[200:203], a[40:43], v[56:59], v[200:203]
v_exp_f32 v30, v30
v_mfma_f32_16x16x32_bf16 v[232:235], a[40:43], v[60:63], v[232:235]
v_exp_f32 v31, v31
v_mfma_f32_16x16x32_bf16 v[236:239], a[44:47], v[60:63], v[236:239]
ds_read_b128 a[16:19], v1 offset:12288
v_cvt_pk_bf16_f32 v77, v30, v31
v_mfma_f32_16x16x32_bf16 v[204:207], a[44:47], v[56:59], v[204:207]
v_exp_f32 v36, v36
v_mfma_f32_16x16x32_bf16 v[172:175], a[44:47], v[52:55], v[172:175]
ds_read_b128 a[20:23], v1 offset:13312
v_accvgpr_read_b32 v7, a225
v_mfma_f32_16x16x32_bf16 v[176:179], a[48:51], v[52:55], v[176:179]
v_exp_f32 v37, v37
v_mfma_f32_16x16x32_bf16 v[208:211], a[48:51], v[56:59], v[208:211]
ds_read_b128 a[24:27], v1 offset:14336
v_cvt_pk_bf16_f32 v70, v36, v37
v_mfma_f32_16x16x32_bf16 v[240:243], a[48:51], v[60:63], v[240:243]
buffer_load_dwordx4 v3, s[48:51], s32 offen offset:1024 sc1 lds
v_mfma_f32_16x16x32_bf16 v[244:247], a[52:55], v[60:63], v[244:247]
v_exp_f32 v38, v38
v_mfma_f32_16x16x32_bf16 v[212:215], a[52:55], v[56:59], v[212:215]
ds_read_b128 a[28:31], v1 offset:15360
v_add_f32 v6, v6, v7
v_mfma_f32_16x16x32_bf16 v[180:183], a[52:55], v[52:55], v[180:183]
v_exp_f32 v39, v39
v_mfma_f32_16x16x32_bf16 v[184:187], a[56:59], v[52:55], v[184:187]
ds_read_b128 a[32:35], v1 offset:0
v_cvt_pk_bf16_f32 v71, v38, v39
v_mfma_f32_16x16x32_bf16 v[216:219], a[56:59], v[56:59], v[216:219]
v_exp_f32 v40, v40
v_mfma_f32_16x16x32_bf16 v[248:251], a[56:59], v[60:63], v[248:251]
ds_read_b128 a[36:39], v1 offset:1024
v_cmp_nge_f32 vcc, 0x6f800000, v6
v_mfma_f32_16x16x32_bf16 v[252:255], a[60:63], v[60:63], v[252:255]
v_exp_f32 v41, v41
v_mfma_f32_16x16x32_bf16 v[220:223], a[60:63], v[56:59], v[220:223]
v_exp_f32 v42, v42
v_mfma_f32_16x16x32_bf16 v[188:191], a[60:63], v[52:55], v[188:191]
ds_read_b128 a[40:43], v1 offset:2048
v_cvt_pk_bf16_f32 v74, v40, v41
v_mfma_f32_16x16x32_bf16 a[224:227], a[236:239], v[52:55], a[224:227]
buffer_load_dwordx4 v3, s[48:51], s32 offen offset:2048 sc1 lds
v_smfmac_f32_16x16x64_bf16 a[228:231], a[232:235], v[56:63], v9
ds_read_b128 a[44:47], v1 offset:3072
s_waitcnt lgkmcnt(8)
v_mfma_f32_16x16x32_bf16 v[24:27], a[0:3], a[192:195], v[88:91]
v_exp_f32 v43, v43
v_mfma_f32_16x16x32_bf16 v[24:27], a[4:7], a[196:199], v[24:27]
ds_read_b128 a[48:51], v1 offset:4096
v_cvt_pk_bf16_f32 v75, v42, v43
v_mfma_f32_16x16x32_bf16 v[24:27], a[8:11], a[200:203], v[24:27]
v_exp_f32 v44, v44
v_mfma_f32_16x16x32_bf16 v[24:27], a[12:15], a[204:207], v[24:27]
v_exp_f32 v45, v45
v_mfma_f32_16x16x32_bf16 v[28:31], a[0:3], a[208:211], v[92:95]
ds_read_b128 a[52:55], v1 offset:5120
v_cvt_pk_bf16_f32 v78, v44, v45
v_mfma_f32_16x16x32_bf16 v[28:31], a[4:7], a[212:215], v[28:31]
v_exp_f32 v46, v46
v_mfma_f32_16x16x32_bf16 v[28:31], a[8:11], a[216:219], v[28:31]
ds_read_b128 a[56:59], v1 offset:6144
v_mfma_f32_16x16x32_bf16 v[28:31], a[12:15], a[220:223], v[28:31]
s_waitcnt lgkmcnt(7)
v_exp_f32 v47, v47
v_mfma_f32_16x16x32_bf16 v[40:43], a[16:19], a[192:195], v[88:91]
buffer_load_dwordx4 v3, s[48:51], s32 offen offset:3072 sc1 lds
v_mfma_f32_16x16x32_bf16 v[40:43], a[20:23], a[196:199], v[40:43]
ds_read_b128 a[60:63], v1 offset:7168
v_cvt_pk_bf16_f32 v79, v46, v47
v_mfma_f32_16x16x32_bf16 v[40:43], a[24:27], a[200:203], v[40:43]
s_add_u32 s32, s32, 0x8000
v_exp_f32 v24, v24
v_mfma_f32_16x16x32_bf16 v[40:43], a[28:31], a[204:207], v[40:43]
v_exp_f32 v25, v25
v_mfma_f32_16x16x32_bf16 v[44:47], a[16:19], a[208:211], v[92:95]
v_exp_f32 v26, v26
v_mfma_f32_16x16x32_bf16 v[44:47], a[20:23], a[212:215], v[44:47]
v_exp_f32 v27, v27
v_mfma_f32_16x16x32_bf16 v[44:47], a[24:27], a[216:219], v[44:47]
v_exp_f32 v28, v28
v_mfma_f32_16x16x32_bf16 v[44:47], a[28:31], a[220:223], v[44:47]
s_waitcnt lgkmcnt(0)
v_exp_f32 v29, v29
v_mfma_f32_16x16x32_bf16 v[160:163], a[32:35], v[68:71], v[160:163]
ds_read_b128 a[0:3], v1 offset:24576
v_cvt_pk_bf16_f32 v56, v24, v25
v_mfma_f32_16x16x32_bf16 v[192:195], a[32:35], v[72:75], v[192:195]
v_exp_f32 v30, v30
v_mfma_f32_16x16x32_bf16 v[224:227], a[32:35], v[76:79], v[224:227]
ds_read_b128 a[4:7], v1 offset:25600
v_cvt_pk_bf16_f32 v57, v26, v27
v_mfma_f32_16x16x32_bf16 v[228:231], a[36:39], v[76:79], v[228:231]
s_add_u32 m0, s27, 0x1000
v_cvt_pk_bf16_f32 v60, v28, v29
v_mfma_f32_16x16x32_bf16 v[196:199], a[36:39], v[72:75], v[196:199]
buffer_load_dwordx4 v3, s[48:51], s7 offen offset:0 sc1 lds
v_mfma_f32_16x16x32_bf16 v[164:167], a[36:39], v[68:71], v[164:167]
ds_read_b128 a[8:11], v1 offset:26624
v_mfma_f32_16x16x32_bf16 v[168:171], a[40:43], v[68:71], v[168:171]
ds_read_b128 a[12:15], v1 offset:27648
v_mfma_f32_16x16x32_bf16 v[200:203], a[40:43], v[72:75], v[200:203]
v_exp_f32 v31, v31
v_mfma_f32_16x16x32_bf16 v[232:235], a[40:43], v[76:79], v[232:235]
v_exp_f32 v40, v40
v_mfma_f32_16x16x32_bf16 v[236:239], a[44:47], v[76:79], v[236:239]
ds_read_b128 a[16:19], v1 offset:28672
v_cvt_pk_bf16_f32 v61, v30, v31
v_mfma_f32_16x16x32_bf16 v[204:207], a[44:47], v[72:75], v[204:207]
v_exp_f32 v41, v41
v_mfma_f32_16x16x32_bf16 v[172:175], a[44:47], v[68:71], v[172:175]
ds_read_b128 a[20:23], v1 offset:29696
v_cvt_pk_bf16_f32 v58, v40, v41
v_mfma_f32_16x16x32_bf16 v[176:179], a[48:51], v[68:71], v[176:179]
v_rcp_f32 v6, v6
v_mfma_f32_16x16x32_bf16 v[208:211], a[48:51], v[72:75], v[208:211]
buffer_load_dwordx4 v3, s[48:51], s7 offen offset:1024 sc1 lds
v_mfma_f32_16x16x32_bf16 v[240:243], a[48:51], v[76:79], v[240:243]
ds_read_b128 a[24:27], v1 offset:30720
s_or_b64 s[34:35], s[34:35], vcc
v_mfma_f32_16x16x32_bf16 v[244:247], a[52:55], v[76:79], v[244:247]
ds_read_b128 a[28:31], v1 offset:31744
s_add_u32 s8, s28, 0x0
v_mfma_f32_16x16x32_bf16 v[212:215], a[52:55], v[72:75], v[212:215]
v_exp_f32 v42, v42
v_mfma_f32_16x16x32_bf16 v[180:183], a[52:55], v[68:71], v[180:183]
v_exp_f32 v43, v43
v_mfma_f32_16x16x32_bf16 v[184:187], a[56:59], v[68:71], v[184:187]
ds_read_b128 a[32:35], v1 offset:16384
v_cvt_pk_bf16_f32 v59, v42, v43
v_mfma_f32_16x16x32_bf16 v[216:219], a[56:59], v[72:75], v[216:219]
v_exp_f32 v44, v44
v_mfma_f32_16x16x32_bf16 v[248:251], a[56:59], v[76:79], v[248:251]
ds_read_b128 a[36:39], v1 offset:17408
v_mul_f32 v128, v6, v128
v_mfma_f32_16x16x32_bf16 v[252:255], a[60:63], v[76:79], v[252:255]
v_mul_f32 v129, v6, v129
v_mul_f32 v130, v6, v130
v_mfma_f32_16x16x32_bf16 v[220:223], a[60:63], v[72:75], v[220:223]
ds_read_b128 a[40:43], v1 offset:18432
v_mul_f32 v131, v6, v131
v_mfma_f32_16x16x32_bf16 v[188:191], a[60:63], v[68:71], v[188:191]
buffer_load_dwordx4 v3, s[48:51], s7 offen offset:2048 sc1 lds
v_mfma_f32_16x16x32_bf16 a[224:227], a[236:239], v[68:71], a[224:227]
ds_read_b128 a[44:47], v1 offset:19456
v_mul_f32 v132, v6, v132
v_smfmac_f32_16x16x64_bf16 a[228:231], a[232:235], v[72:79], v9
s_waitcnt lgkmcnt(8)
v_exp_f32 v45, v45
v_mfma_f32_16x16x32_bf16 v[24:27], a[0:3], a[192:195], v[88:91]
v_exp_f32 v46, v46
v_mfma_f32_16x16x32_bf16 v[24:27], a[4:7], a[196:199], v[24:27]
ds_read_b128 a[48:51], v1 offset:20480
v_cvt_pk_bf16_f32 v62, v44, v45
v_mfma_f32_16x16x32_bf16 v[24:27], a[8:11], a[200:203], v[24:27]
v_exp_f32 v47, v47
v_mfma_f32_16x16x32_bf16 v[24:27], a[12:15], a[204:207], v[24:27]
ds_read_b128 a[52:55], v1 offset:21504
v_cvt_pk_bf16_f32 v63, v46, v47
v_mfma_f32_16x16x32_bf16 v[28:31], a[0:3], a[208:211], v[92:95]
v_mul_f32 v133, v6, v133
v_mul_f32 v134, v6, v134
v_mfma_f32_16x16x32_bf16 v[28:31], a[4:7], a[212:215], v[28:31]
ds_read_b128 a[56:59], v1 offset:22528
v_mul_f32 v135, v6, v135
v_mfma_f32_16x16x32_bf16 v[28:31], a[8:11], a[216:219], v[28:31]
buffer_load_dwordx4 v3, s[48:51], s7 offen offset:3072 sc1 lds
v_mfma_f32_16x16x32_bf16 v[28:31], a[12:15], a[220:223], v[28:31]
ds_read_b128 a[60:63], v1 offset:23552
s_waitcnt lgkmcnt(8)
v_mfma_f32_16x16x32_bf16 v[40:43], a[16:19], a[192:195], v[88:91]
s_add_u32 s7, s7, 0x8000
v_xor_b32 v1, 0x8000, v1
v_cvt_pk_bf16_f32 v128, v128, v129
v_mfma_f32_16x16x32_bf16 v[40:43], a[20:23], a[196:199], v[40:43]
s_xor_b32 s27, s27, 0x38000
v_exp_f32 v24, v24
v_mfma_f32_16x16x32_bf16 v[40:43], a[24:27], a[200:203], v[40:43]
v_exp_f32 v25, v25
v_mfma_f32_16x16x32_bf16 v[40:43], a[28:31], a[204:207], v[40:43]
v_exp_f32 v26, v26
v_mfma_f32_16x16x32_bf16 v[44:47], a[16:19], a[208:211], v[92:95]
v_exp_f32 v27, v27
v_mfma_f32_16x16x32_bf16 v[44:47], a[20:23], a[212:215], v[44:47]
v_exp_f32 v28, v28
v_mfma_f32_16x16x32_bf16 v[44:47], a[24:27], a[216:219], v[44:47]
s_waitcnt vmcnt(29) lgkmcnt(0)
v_exp_f32 v29, v29
v_mfma_f32_16x16x32_bf16 v[44:47], a[28:31], a[220:223], v[44:47]
s_barrier
v_cvt_pk_bf16_f32 v129, v130, v131
v_cvt_pk_bf16_f32 v130, v132, v133
v_cvt_pk_bf16_f32 v131, v134, v135
buffer_store_dwordx4 v[128:131], v3, s[88:91], s8 offen sc1
s_add_u32 s8, s28, 0x2000
v_mul_f32 v136, v6, v136
v_mul_f32 v137, v6, v137
v_mul_f32 v138, v6, v138
v_mul_f32 v139, v6, v139
v_mul_f32 v140, v6, v140
v_mul_f32 v141, v6, v141
v_mul_f32 v142, v6, v142
v_mul_f32 v143, v6, v143
v_cvt_pk_bf16_f32 v136, v136, v137
v_cvt_pk_bf16_f32 v137, v138, v139
v_cvt_pk_bf16_f32 v138, v140, v141
v_cvt_pk_bf16_f32 v139, v142, v143
buffer_store_dwordx4 v[136:139], v3, s[88:91], s8 offen sc1
s_add_u32 s8, s28, 0x4000
v_mul_f32 v144, v6, v144
v_mul_f32 v145, v6, v145
v_mul_f32 v146, v6, v146
v_mul_f32 v147, v6, v147
v_mul_f32 v148, v6, v148
v_mul_f32 v149, v6, v149
v_mul_f32 v150, v6, v150
v_mul_f32 v151, v6, v151
v_cvt_pk_bf16_f32 v144, v144, v145
v_cvt_pk_bf16_f32 v145, v146, v147
v_cvt_pk_bf16_f32 v146, v148, v149
v_cvt_pk_bf16_f32 v147, v150, v151
buffer_store_dwordx4 v[144:147], v3, s[88:91], s8 offen sc1
s_add_u32 s8, s28, 0x6000
v_mul_f32 v152, v6, v152
v_mul_f32 v153, v6, v153
v_mul_f32 v154, v6, v154
v_mul_f32 v155, v6, v155
v_mul_f32 v156, v6, v156
v_mul_f32 v157, v6, v157
v_mul_f32 v158, v6, v158
v_mul_f32 v159, v6, v159
v_cvt_pk_bf16_f32 v152, v152, v153
v_cvt_pk_bf16_f32 v153, v154, v155
v_cvt_pk_bf16_f32 v154, v156, v157
v_cvt_pk_bf16_f32 v155, v158, v159
buffer_store_dwordx4 v[152:155], v3, s[88:91], s8 offen sc1
v_accvgpr_read_b32 v6, a226
v_accvgpr_read_b32 v7, a227
v_add_f32 v6, v6, v7
v_cmp_nge_f32 vcc, 0x6f800000, v6
v_rcp_f32 v6, v6
s_or_b64 s[34:35], s[34:35], vcc
s_add_u32 s8, s29, 0x0
v_pk_mul_f32 v[160:161], v[160:161], v[6:7] op_sel_hi:[1,0]
v_pk_mul_f32 v[162:163], v[162:163], v[6:7] op_sel_hi:[1,0]
v_pk_mul_f32 v[164:165], v[164:165], v[6:7] op_sel_hi:[1,0]
v_pk_mul_f32 v[166:167], v[166:167], v[6:7] op_sel_hi:[1,0]
v_cvt_pk_bf16_f32 v160, v160, v161
v_cvt_pk_bf16_f32 v161, v162, v163
v_cvt_pk_bf16_f32 v162, v164, v165
v_cvt_pk_bf16_f32 v163, v166, v167
buffer_store_dwordx4 v[160:163], v3, s[88:91], s8 offen sc1
s_add_u32 s8, s29, 0x2000
v_pk_mul_f32 v[168:169], v[168:169], v[6:7] op_sel_hi:[1,0]
v_pk_mul_f32 v[170:171], v[170:171], v[6:7] op_sel_hi:[1,0]
v_pk_mul_f32 v[172:173], v[172:173], v[6:7] op_sel_hi:[1,0]
v_pk_mul_f32 v[174:175], v[174:175], v[6:7] op_sel_hi:[1,0]
v_cvt_pk_bf16_f32 v168, v168, v169
v_cvt_pk_bf16_f32 v169, v170, v171
v_cvt_pk_bf16_f32 v170, v172, v173
v_cvt_pk_bf16_f32 v171, v174, v175
buffer_store_dwordx4 v[168:171], v3, s[88:91], s8 offen sc1
s_add_u32 s8, s29, 0x4000
v_pk_mul_f32 v[176:177], v[176:177], v[6:7] op_sel_hi:[1,0]
v_pk_mul_f32 v[178:179], v[178:179], v[6:7] op_sel_hi:[1,0]
v_pk_mul_f32 v[180:181], v[180:181], v[6:7] op_sel_hi:[1,0]
v_pk_mul_f32 v[182:183], v[182:183], v[6:7] op_sel_hi:[1,0]
v_cvt_pk_bf16_f32 v176, v176, v177
v_cvt_pk_bf16_f32 v177, v178, v179
v_cvt_pk_bf16_f32 v178, v180, v181
v_cvt_pk_bf16_f32 v179, v182, v183
buffer_store_dwordx4 v[176:179], v3, s[88:91], s8 offen sc1
s_add_u32 s8, s29, 0x6000
v_pk_mul_f32 v[184:185], v[184:185], v[6:7] op_sel_hi:[1,0]
v_pk_mul_f32 v[186:187], v[186:187], v[6:7] op_sel_hi:[1,0]
v_pk_mul_f32 v[188:189], v[188:189], v[6:7] op_sel_hi:[1,0]
v_pk_mul_f32 v[190:191], v[190:191], v[6:7] op_sel_hi:[1,0]
v_cvt_pk_bf16_f32 v184, v184, v185
v_cvt_pk_bf16_f32 v185, v186, v187
v_cvt_pk_bf16_f32 v186, v188, v189
v_cvt_pk_bf16_f32 v187, v190, v191
buffer_store_dwordx4 v[184:187], v3, s[88:91], s8 offen sc1
s_getreg_b32 s8, hwreg(HW_REG_HW_ID, 5, 1)
s_cmp_lg_u32 s8, 0
s_cbranch_scc1 L_att_sodd1
s_branch L_att_sodd0
L_att_lh0_0:
v_mfma_f32_16x16x32_bf16 v[160:163], a[32:35], v[52:55], v[160:163]
ds_read_b128 a[0:3], v1 offset:8192
v_cvt_pk_bf16_f32 v72, v24, v25
v_mfma_f32_16x16x32_bf16 v[192:195], a[32:35], v[56:59], v[192:195]
v_exp_f32 v28, v28
v_mfma_f32_16x16x32_bf16 v[224:227], a[32:35], v[60:63], v[224:227]
ds_read_b128 a[4:7], v1 offset:9216
v_cvt_pk_bf16_f32 v73, v26, v27
v_mfma_f32_16x16x32_bf16 v[228:231], a[36:39], v[60:63], v[228:231]
v_exp_f32 v29, v29
v_mfma_f32_16x16x32_bf16 v[196:199], a[36:39], v[56:59], v[196:199]
buffer_load_dword v14, v15, s[84:87], 0 offen offset:192 sc1
v_mfma_f32_16x16x32_bf16 v[164:167], a[36:39], v[52:55], v[164:167]
ds_read_b128 a[8:11], v1 offset:10240
v_cvt_pk_bf16_f32 v76, v28, v29
v_mfma_f32_16x16x32_bf16 v[168:171], a[40:43], v[52:55], v[168:171]
ds_read_b128 a[12:15], v1 offset:11264
v_mfma_f32_16x16x32_bf16 v[200:203], a[40:43], v[56:59], v[200:203]
v_exp_f32 v30, v30
v_mfma_f32_16x16x32_bf16 v[232:235], a[40:43], v[60:63], v[232:235]
v_exp_f32 v31, v31
v_mfma_f32_16x16x32_bf16 v[236:239], a[44:47], v[60:63], v[236:239]
ds_read_b128 a[16:19], v1 offset:12288
v_cvt_pk_bf16_f32 v77, v30, v31
v_mfma_f32_16x16x32_bf16 v[204:207], a[44:47], v[56:59], v[204:207]
s_add_u32 m0, s17, 0x10000
v_exp_f32 v36, v36
v_mfma_f32_16x16x32_bf16 v[172:175], a[44:47], v[52:55], v[172:175]
ds_read_b128 a[20:23], v1 offset:13312
v_mfma_f32_16x16x32_bf16 v[176:179], a[48:51], v[52:55], v[176:179]
buffer_load_dwordx4 v12, s[72:75], 0 offen lds
v_mfma_f32_16x16x32_bf16 v[208:211], a[48:51], v[56:59], v[208:211]
ds_read_b128 a[24:27], v1 offset:14336
v_mfma_f32_16x16x32_bf16 v[240:243], a[48:51], v[60:63], v[240:243]
v_exp_f32 v37, v37
v_mfma_f32_16x16x32_bf16 v[244:247], a[52:55], v[60:63], v[244:247]
v_exp_f32 v38, v38
v_mfma_f32_16x16x32_bf16 v[212:215], a[52:55], v[56:59], v[212:215]
ds_read_b128 a[28:31], v1 offset:15360
v_cvt_pk_bf16_f32 v70, v36, v37
v_mfma_f32_16x16x32_bf16 v[180:183], a[52:55], v[52:55], v[180:183]
v_exp_f32 v39, v39
v_mfma_f32_16x16x32_bf16 v[184:187], a[56:59], v[52:55], v[184:187]
ds_read_b128 a[32:35], v1 offset:0
v_cvt_pk_bf16_f32 v71, v38, v39
v_mfma_f32_16x16x32_bf16 v[216:219], a[56:59], v[56:59], v[216:219]
v_exp_f32 v40, v40
v_mfma_f32_16x16x32_bf16 v[248:251], a[56:59], v[60:63], v[248:251]
buffer_load_dwordx4 v13, s[72:75], 0 offen offset:1024 lds
v_mfma_f32_16x16x32_bf16 v[252:255], a[60:63], v[60:63], v[252:255]
ds_read_b128 a[36:39], v1 offset:1024
v_mfma_f32_16x16x32_bf16 v[220:223], a[60:63], v[56:59], v[220:223]
v_exp_f32 v41, v41
v_mfma_f32_16x16x32_bf16 v[188:191], a[60:63], v[52:55], v[188:191]
ds_read_b128 a[40:43], v1 offset:2048
v_cvt_pk_bf16_f32 v74, v40, v41
v_mfma_f32_16x16x32_bf16 a[224:227], a[236:239], v[52:55], a[224:227]
s_waitcnt lgkmcnt(7)
v_exp_f32 v42, v42
v_smfmac_f32_16x16x64_bf16 a[228:231], a[232:235], v[56:63], v9
ds_read_b128 a[44:47], v1 offset:3072
v_mfma_f32_16x16x32_bf16 v[24:27], a[0:3], a[192:195], v[112:115]
v_exp_f32 v43, v43
v_mfma_f32_16x16x32_bf16 v[24:27], a[4:7], a[196:199], v[24:27]
ds_read_b128 a[48:51], v1 offset:4096
v_cvt_pk_bf16_f32 v75, v42, v43
v_mfma_f32_16x16x32_bf16 v[24:27], a[8:11], a[200:203], v[24:27]
buffer_load_dwordx4 v12, s[72:75], s12 offen offset:2048 lds
v_mfma_f32_16x16x32_bf16 v[24:27], a[12:15], a[204:207], v[24:27]
v_exp_f32 v44, v44
v_mfma_f32_16x16x32_bf16 v[28:31], a[0:3], a[208:211], v[92:95]
ds_read_b128 a[52:55], v1 offset:5120
v_exp_f32 v45, v45
v_mfma_f32_16x16x32_bf16 v[28:31], a[4:7], a[212:215], v[28:31]
v_exp_f32 v46, v46
v_mfma_f32_16x16x32_bf16 v[28:31], a[8:11], a[216:219], v[28:31]
ds_read_b128 a[56:59], v1 offset:6144
v_cvt_pk_bf16_f32 v78, v44, v45
v_mfma_f32_16x16x32_bf16 v[28:31], a[12:15], a[220:223], v[28:31]
s_waitcnt lgkmcnt(7)
v_exp_f32 v47, v47
v_mfma_f32_16x16x32_bf16 v[40:43], a[16:19], a[192:195], v[116:119]
ds_read_b128 a[60:63], v1 offset:7168
v_cvt_pk_bf16_f32 v79, v46, v47
v_mfma_f32_16x16x32_bf16 v[40:43], a[20:23], a[196:199], v[40:43]
v_exp_f32 v24, v24
v_mfma_f32_16x16x32_bf16 v[40:43], a[24:27], a[200:203], v[40:43]
buffer_load_dwordx4 v13, s[72:75], s12 offen offset:3072 lds
v_mfma_f32_16x16x32_bf16 v[40:43], a[28:31], a[204:207], v[40:43]
v_exp_f32 v25, v25
v_mfma_f32_16x16x32_bf16 v[44:47], a[16:19], a[208:211], v[92:95]
v_exp_f32 v26, v26
v_mfma_f32_16x16x32_bf16 v[44:47], a[20:23], a[212:215], v[44:47]
v_exp_f32 v27, v27
v_mfma_f32_16x16x32_bf16 v[44:47], a[24:27], a[216:219], v[44:47]
v_exp_f32 v28, v28
v_mfma_f32_16x16x32_bf16 v[44:47], a[28:31], a[220:223], v[44:47]
s_waitcnt lgkmcnt(0)
v_exp_f32 v29, v29
v_mfma_f32_16x16x32_bf16 v[160:163], a[32:35], v[68:71], v[160:163]
v_exp_f32 v30, v30
v_mfma_f32_16x16x32_bf16 v[192:195], a[32:35], v[72:75], v[192:195]
v_exp_f32 v31, v31
v_mfma_f32_16x16x32_bf16 v[224:227], a[32:35], v[76:79], v[224:227]
ds_read_b128 a[0:3], v1 offset:24576
v_cvt_pk_bf16_f32 v56, v24, v25
v_mfma_f32_16x16x32_bf16 v[228:231], a[36:39], v[76:79], v[228:231]
ds_read_b128 a[4:7], v1 offset:25600
v_add_u32 v12, 0x20000, v12
v_mfma_f32_16x16x32_bf16 v[196:199], a[36:39], v[72:75], v[196:199]
s_add_u32 m0, s17, 0x14000
v_exp_f32 v40, v40
v_mfma_f32_16x16x32_bf16 v[164:167], a[36:39], v[68:71], v[164:167]
buffer_load_dwordx4 v12, s[72:75], 0 offen lds
v_mfma_f32_16x16x32_bf16 v[168:171], a[40:43], v[68:71], v[168:171]
ds_read_b128 a[8:11], v1 offset:26624
v_cvt_pk_bf16_f32 v57, v26, v27
v_mfma_f32_16x16x32_bf16 v[200:203], a[40:43], v[72:75], v[200:203]
ds_read_b128 a[12:15], v1 offset:27648
v_cvt_pk_bf16_f32 v60, v28, v29
v_mfma_f32_16x16x32_bf16 v[232:235], a[40:43], v[76:79], v[232:235]
ds_read_b128 a[16:19], v1 offset:28672
v_cvt_pk_bf16_f32 v61, v30, v31
v_mfma_f32_16x16x32_bf16 v[236:239], a[44:47], v[76:79], v[236:239]
v_exp_f32 v41, v41
v_mfma_f32_16x16x32_bf16 v[204:207], a[44:47], v[72:75], v[204:207]
v_exp_f32 v42, v42
v_mfma_f32_16x16x32_bf16 v[172:175], a[44:47], v[68:71], v[172:175]
ds_read_b128 a[20:23], v1 offset:29696
v_cvt_pk_bf16_f32 v58, v40, v41
v_mfma_f32_16x16x32_bf16 v[176:179], a[48:51], v[68:71], v[176:179]
ds_read_b128 a[24:27], v1 offset:30720
v_add_u32 v13, 0x20000, v13
v_mfma_f32_16x16x32_bf16 v[208:211], a[48:51], v[72:75], v[208:211]
buffer_load_dwordx4 v13, s[72:75], 0 offen offset:1024 lds
v_mfma_f32_16x16x32_bf16 v[240:243], a[48:51], v[76:79], v[240:243]
ds_read_b128 a[28:31], v1 offset:31744
v_mfma_f32_16x16x32_bf16 v[244:247], a[52:55], v[76:79], v[244:247]
ds_read_b128 a[32:35], v1 offset:16384
v_mfma_f32_16x16x32_bf16 v[212:215], a[52:55], v[72:75], v[212:215]
v_exp_f32 v43, v43
v_mfma_f32_16x16x32_bf16 v[180:183], a[52:55], v[68:71], v[180:183]
v_exp_f32 v44, v44
v_mfma_f32_16x16x32_bf16 v[184:187], a[56:59], v[68:71], v[184:187]
buffer_load_dwordx4 v12, s[72:75], s12 offen offset:2048 lds
v_mfma_f32_16x16x32_bf16 v[216:219], a[56:59], v[72:75], v[216:219]
ds_read_b128 a[36:39], v1 offset:17408
v_cvt_pk_bf16_f32 v59, v42, v43
v_mfma_f32_16x16x32_bf16 v[248:251], a[56:59], v[76:79], v[248:251]
ds_read_b128 a[40:43], v1 offset:18432
v_mfma_f32_16x16x32_bf16 v[252:255], a[60:63], v[76:79], v[252:255]
ds_read_b128 a[44:47], v1 offset:19456
v_mfma_f32_16x16x32_bf16 v[220:223], a[60:63], v[72:75], v[220:223]
v_exp_f32 v45, v45
v_mfma_f32_16x16x32_bf16 v[188:191], a[60:63], v[68:71], v[188:191]
ds_read_b128 a[48:51], v1 offset:20480
v_cvt_pk_bf16_f32 v62, v44, v45
v_mfma_f32_16x16x32_bf16 a[224:227], a[236:239], v[68:71], a[224:227]
ds_read_b128 a[52:55], v1 offset:21504
v_smfmac_f32_16x16x64_bf16 a[228:231], a[232:235], v[72:79], v9
s_waitcnt lgkmcnt(10)
v_exp_f32 v46, v46
v_mfma_f32_16x16x32_bf16 v[28:31], a[0:3], a[208:211], v[92:95]
v_exp_f32 v47, v47
v_mfma_f32_16x16x32_bf16 v[28:31], a[4:7], a[212:215], v[28:31]
buffer_load_dwordx4 v13, s[72:75], s12 offen offset:3072 lds
v_mfma_f32_16x16x32_bf16 v[28:31], a[8:11], a[216:219], v[28:31]
ds_read_b128 a[56:59], v1 offset:22528
v_cvt_pk_bf16_f32 v63, v46, v47
v_mfma_f32_16x16x32_bf16 v[28:31], a[12:15], a[220:223], v[28:31]
ds_read_b128 a[60:63], v1 offset:23552
s_waitcnt lgkmcnt(8)
v_mfma_f32_16x16x32_bf16 v[44:47], a[16:19], a[208:211], v[92:95]
v_xor_b32 v1, 0x8000, v1
v_mfma_f32_16x16x32_bf16 v[44:47], a[20:23], a[212:215], v[44:47]
v_mfma_f32_16x16x32_bf16 v[44:47], a[24:27], a[216:219], v[44:47]
v_mfma_f32_16x16x32_bf16 v[44:47], a[28:31], a[220:223], v[44:47]
v_accvgpr_read_b32 v6, a224
v_accvgpr_read_b32 v7, a225
v_add_f32 v6, v6, v7
v_cmp_nge_f32 vcc, 0x6f800000, v6
v_rcp_f32 v6, v6
s_or_b64 s[34:35], s[34:35], vcc
s_add_u32 s8, s28, 0x0
v_pk_mul_f32 v[128:129], v[128:129], v[6:7] op_sel_hi:[1,0]
v_pk_mul_f32 v[130:131], v[130:131], v[6:7] op_sel_hi:[1,0]
v_pk_mul_f32 v[132:133], v[132:133], v[6:7] op_sel_hi:[1,0]
v_pk_mul_f32 v[134:135], v[134:135], v[6:7] op_sel_hi:[1,0]
v_cvt_pk_bf16_f32 v128, v128, v129
v_cvt_pk_bf16_f32 v129, v130, v131
v_cvt_pk_bf16_f32 v130, v132, v133
v_cvt_pk_bf16_f32 v131, v134, v135
buffer_store_dwordx4 v[128:131], v3, s[88:91], s8 offen sc1
s_add_u32 s8, s28, 0x2000
v_pk_mul_f32 v[136:137], v[136:137], v[6:7] op_sel_hi:[1,0]
v_pk_mul_f32 v[138:139], v[138:139], v[6:7] op_sel_hi:[1,0]
v_pk_mul_f32 v[140:141], v[140:141], v[6:7] op_sel_hi:[1,0]
v_pk_mul_f32 v[142:143], v[142:143], v[6:7] op_sel_hi:[1,0]
v_cvt_pk_bf16_f32 v136, v136, v137
v_cvt_pk_bf16_f32 v137, v138, v139
v_cvt_pk_bf16_f32 v138, v140, v141
v_cvt_pk_bf16_f32 v139, v142, v143
buffer_store_dwordx4 v[136:139], v3, s[88:91], s8 offen sc1
s_add_u32 s8, s28, 0x4000
v_pk_mul_f32 v[144:145], v[144:145], v[6:7] op_sel_hi:[1,0]
v_pk_mul_f32 v[146:147], v[146:147], v[6:7] op_sel_hi:[1,0]
v_pk_mul_f32 v[148:149], v[148:149], v[6:7] op_sel_hi:[1,0]
v_pk_mul_f32 v[150:151], v[150:151], v[6:7] op_sel_hi:[1,0]
v_cvt_pk_bf16_f32 v144, v144, v145
v_cvt_pk_bf16_f32 v145, v146, v147
v_cvt_pk_bf16_f32 v146, v148, v149
v_cvt_pk_bf16_f32 v147, v150, v151
buffer_store_dwordx4 v[144:147], v3, s[88:91], s8 offen sc1
s_add_u32 s8, s28, 0x6000
v_pk_mul_f32 v[152:153], v[152:153], v[6:7] op_sel_hi:[1,0]
v_pk_mul_f32 v[154:155], v[154:155], v[6:7] op_sel_hi:[1,0]
v_pk_mul_f32 v[156:157], v[156:157], v[6:7] op_sel_hi:[1,0]
v_pk_mul_f32 v[158:159], v[158:159], v[6:7] op_sel_hi:[1,0]
v_cvt_pk_bf16_f32 v152, v152, v153
v_cvt_pk_bf16_f32 v153, v154, v155
v_cvt_pk_bf16_f32 v154, v156, v157
v_cvt_pk_bf16_f32 v155, v158, v159
buffer_store_dwordx4 v[152:155], v3, s[88:91], s8 offen sc1
v_accvgpr_read_b32 v6, a226
v_accvgpr_read_b32 v7, a227
v_add_f32 v6, v6, v7
v_cmp_nge_f32 vcc, 0x6f800000, v6
v_rcp_f32 v6, v6
s_or_b64 s[34:35], s[34:35], vcc
s_add_u32 s8, s29, 0x0
v_pk_mul_f32 v[160:161], v[160:161], v[6:7] op_sel_hi:[1,0]
v_pk_mul_f32 v[162:163], v[162:163], v[6:7] op_sel_hi:[1,0]
v_pk_mul_f32 v[164:165], v[164:165], v[6:7] op_sel_hi:[1,0]
v_pk_mul_f32 v[166:167], v[166:167], v[6:7] op_sel_hi:[1,0]
v_cvt_pk_bf16_f32 v160, v160, v161
v_cvt_pk_bf16_f32 v161, v162, v163
v_cvt_pk_bf16_f32 v162, v164, v165
v_cvt_pk_bf16_f32 v163, v166, v167
buffer_store_dwordx4 v[160:163], v3, s[88:91], s8 offen sc1
s_add_u32 s8, s29, 0x2000
v_pk_mul_f32 v[168:169], v[168:169], v[6:7] op_sel_hi:[1,0]
v_pk_mul_f32 v[170:171], v[170:171], v[6:7] op_sel_hi:[1,0]
v_pk_mul_f32 v[172:173], v[172:173], v[6:7] op_sel_hi:[1,0]
v_pk_mul_f32 v[174:175], v[174:175], v[6:7] op_sel_hi:[1,0]
v_cvt_pk_bf16_f32 v168, v168, v169
v_cvt_pk_bf16_f32 v169, v170, v171
v_cvt_pk_bf16_f32 v170, v172, v173
v_cvt_pk_bf16_f32 v171, v174, v175
buffer_store_dwordx4 v[168:171], v3, s[88:91], s8 offen sc1
s_add_u32 s8, s29, 0x4000
v_pk_mul_f32 v[176:177], v[176:177], v[6:7] op_sel_hi:[1,0]
v_pk_mul_f32 v[178:179], v[178:179], v[6:7] op_sel_hi:[1,0]
v_pk_mul_f32 v[180:181], v[180:181], v[6:7] op_sel_hi:[1,0]
v_pk_mul_f32 v[182:183], v[182:183], v[6:7] op_sel_hi:[1,0]
v_cvt_pk_bf16_f32 v176, v176, v177
v_cvt_pk_bf16_f32 v177, v178, v179
v_cvt_pk_bf16_f32 v178, v180, v181
v_cvt_pk_bf16_f32 v179, v182, v183
buffer_store_dwordx4 v[176:179], v3, s[88:91], s8 offen sc1
s_add_u32 s8, s29, 0x6000
v_pk_mul_f32 v[184:185], v[184:185], v[6:7] op_sel_hi:[1,0]
v_pk_mul_f32 v[186:187], v[186:187], v[6:7] op_sel_hi:[1,0]
v_pk_mul_f32 v[188:189], v[188:189], v[6:7] op_sel_hi:[1,0]
v_pk_mul_f32 v[190:191], v[190:191], v[6:7] op_sel_hi:[1,0]
v_cvt_pk_bf16_f32 v184, v184, v185
v_cvt_pk_bf16_f32 v185, v186, v187
v_cvt_pk_bf16_f32 v186, v188, v189
v_cvt_pk_bf16_f32 v187, v190, v191
buffer_store_dwordx4 v[184:187], v3, s[88:91], s8 offen sc1
s_branch L_att_h1_0
L_att_dl0_1:
v_mfma_f32_16x16x32_bf16 v[128:131], a[32:35], v[48:51], v[128:131]
ds_read_b128 a[0:3], v1 offset:8192
v_cvt_pk_bf16_f32 v72, v24, v25
v_mfma_f32_16x16x32_bf16 v[160:163], a[32:35], v[52:55], v[160:163]
v_exp_f32 v28, v28
v_mfma_f32_16x16x32_bf16 v[192:195], a[32:35], v[56:59], v[192:195]
v_cvt_pk_bf16_f32 v73, v26, v27
v_mfma_f32_16x16x32_bf16 v[224:227], a[32:35], v[60:63], v[224:227]
ds_read_b128 a[4:7], v1 offset:9216
v_mfma_f32_16x16x32_bf16 v[228:231], a[36:39], v[60:63], v[228:231]
v_exp_f32 v29, v29
v_mfma_f32_16x16x32_bf16 v[196:199], a[36:39], v[56:59], v[196:199]
s_add_u32 m0, s27, 0x0
v_exp_f32 v30, v30
v_mfma_f32_16x16x32_bf16 v[164:167], a[36:39], v[52:55], v[164:167]
buffer_load_dwordx4 v3, s[48:51], s32 offen offset:0 sc1 lds
v_mfma_f32_16x16x32_bf16 v[132:135], a[36:39], v[48:51], v[132:135]
ds_read_b128 a[8:11], v1 offset:10240
v_cvt_pk_bf16_f32 v76, v28, v29
v_mfma_f32_16x16x32_bf16 v[136:139], a[40:43], v[48:51], v[136:139]
v_mfma_f32_16x16x32_bf16 v[168:171], a[40:43], v[52:55], v[168:171]
v_exp_f32 v31, v31
v_mfma_f32_16x16x32_bf16 v[200:203], a[40:43], v[56:59], v[200:203]
v_exp_f32 v32, v32
v_mfma_f32_16x16x32_bf16 v[232:235], a[40:43], v[60:63], v[232:235]
ds_read_b128 a[12:15], v1 offset:11264
v_cvt_pk_bf16_f32 v77, v30, v31
v_mfma_f32_16x16x32_bf16 v[236:239], a[44:47], v[60:63], v[236:239]
v_mfma_f32_16x16x32_bf16 v[204:207], a[44:47], v[56:59], v[204:207]
v_exp_f32 v33, v33
v_mfma_f32_16x16x32_bf16 v[172:175], a[44:47], v[52:55], v[172:175]
v_exp_f32 v34, v34
v_mfma_f32_16x16x32_bf16 v[140:143], a[44:47], v[48:51], v[140:143]
ds_read_b128 a[16:19], v1 offset:12288
v_cvt_pk_bf16_f32 v66, v32, v33
v_mfma_f32_16x16x32_bf16 v[144:147], a[48:51], v[48:51], v[144:147]
v_exp_f32 v35, v35
v_mfma_f32_16x16x32_bf16 v[176:179], a[48:51], v[52:55], v[176:179]
v_cvt_pk_bf16_f32 v67, v34, v35
v_mfma_f32_16x16x32_bf16 v[208:211], a[48:51], v[56:59], v[208:211]
v_exp_f32 v36, v36
v_mfma_f32_16x16x32_bf16 v[240:243], a[48:51], v[60:63], v[240:243]
buffer_load_dwordx4 v3, s[48:51], s32 offen offset:1024 sc1 lds
v_mfma_f32_16x16x32_bf16 v[244:247], a[52:55], v[60:63], v[244:247]
ds_read_b128 a[20:23], v1 offset:13312
v_mfma_f32_16x16x32_bf16 v[212:215], a[52:55], v[56:59], v[212:215]
v_exp_f32 v37, v37
v_mfma_f32_16x16x32_bf16 v[180:183], a[52:55], v[52:55], v[180:183]
ds_read_b128 a[24:27], v1 offset:14336
v_cvt_pk_bf16_f32 v70, v36, v37
v_mfma_f32_16x16x32_bf16 v[148:151], a[52:55], v[48:51], v[148:151]
v_mfma_f32_16x16x32_bf16 v[152:155], a[56:59], v[48:51], v[152:155]
v_exp_f32 v38, v38
v_mfma_f32_16x16x32_bf16 v[184:187], a[56:59], v[52:55], v[184:187]
v_exp_f32 v39, v39
v_mfma_f32_16x16x32_bf16 v[216:219], a[56:59], v[56:59], v[216:219]
ds_read_b128 a[28:31], v1 offset:15360
v_cvt_pk_bf16_f32 v71, v38, v39
v_mfma_f32_16x16x32_bf16 v[248:251], a[56:59], v[60:63], v[248:251]
v_exp_f32 v40, v40
v_mfma_f32_16x16x32_bf16 v[252:255], a[60:63], v[60:63], v[252:255]
v_mfma_f32_16x16x32_bf16 v[220:223], a[60:63], v[56:59], v[220:223]
v_exp_f32 v41, v41
v_mfma_f32_16x16x32_bf16 v[188:191], a[60:63], v[52:55], v[188:191]
ds_read_b128 a[32:35], v1 offset:0
v_cvt_pk_bf16_f32 v74, v40, v41
v_mfma_f32_16x16x32_bf16 v[156:159], a[60:63], v[48:51], v[156:159]
v_exp_f32 v42, v42
v_smfmac_f32_16x16x64_bf16 a[224:227], a[232:235], v[48:55], v9
buffer_load_dwordx4 v3, s[48:51], s32 offen offset:2048 sc1 lds
v_smfmac_f32_16x16x64_bf16 a[228:231], a[232:235], v[56:63], v9
s_waitcnt lgkmcnt(5)
v_mfma_f32_16x16x32_bf16 v[16:19], a[0:3], a[160:163], v[80:83]
ds_read_b128 a[36:39], v1 offset:1024
v_mfma_f32_16x16x32_bf16 v[16:19], a[4:7], a[164:167], v[16:19]
v_exp_f32 v43, v43
v_mfma_f32_16x16x32_bf16 v[16:19], a[8:11], a[168:171], v[16:19]
v_exp_f32 v44, v44
v_mfma_f32_16x16x32_bf16 v[16:19], a[12:15], a[172:175], v[16:19]
v_exp_f32 v45, v45
v_mfma_f32_16x16x32_bf16 v[20:23], a[0:3], a[176:179], v[84:87]
ds_read_b128 a[40:43], v1 offset:2048
v_cvt_pk_bf16_f32 v75, v42, v43
v_mfma_f32_16x16x32_bf16 v[20:23], a[4:7], a[180:183], v[20:23]
v_cvt_pk_bf16_f32 v78, v44, v45
v_mfma_f32_16x16x32_bf16 v[20:23], a[8:11], a[184:187], v[20:23]
v_exp_f32 v46, v46
v_mfma_f32_16x16x32_bf16 v[20:23], a[12:15], a[188:191], v[20:23]
ds_read_b128 a[44:47], v1 offset:3072
v_mfma_f32_16x16x32_bf16 v[24:27], a[0:3], a[192:195], v[88:91]
v_exp_f32 v47, v47
v_mfma_f32_16x16x32_bf16 v[24:27], a[4:7], a[196:199], v[24:27]
v_cvt_pk_bf16_f32 v79, v46, v47
v_mfma_f32_16x16x32_bf16 v[24:27], a[8:11], a[200:203], v[24:27]
buffer_load_dwordx4 v3, s[48:51], s32 offen offset:3072 sc1 lds
v_mfma_f32_16x16x32_bf16 v[24:27], a[12:15], a[204:207], v[24:27]
ds_read_b128 a[48:51], v1 offset:4096
v_mfma_f32_16x16x32_bf16 v[28:31], a[0:3], a[208:211], v[92:95]
v_exp_f32 v16, v16
v_mfma_f32_16x16x32_bf16 v[28:31], a[4:7], a[212:215], v[28:31]
v_exp_f32 v17, v17
v_mfma_f32_16x16x32_bf16 v[28:31], a[8:11], a[216:219], v[28:31]
s_waitcnt lgkmcnt(5)
v_exp_f32 v18, v18
v_mfma_f32_16x16x32_bf16 v[28:31], a[12:15], a[220:223], v[28:31]
ds_read_b128 a[52:55], v1 offset:5120
v_cvt_pk_bf16_f32 v48, v16, v17
v_mfma_f32_16x16x32_bf16 v[32:35], a[16:19], a[160:163], v[80:83]
v_mfma_f32_16x16x32_bf16 v[32:35], a[20:23], a[164:167], v[32:35]
v_exp_f32 v19, v19
v_mfma_f32_16x16x32_bf16 v[32:35], a[24:27], a[168:171], v[32:35]
v_exp_f32 v20, v20
v_mfma_f32_16x16x32_bf16 v[32:35], a[28:31], a[172:175], v[32:35]
ds_read_b128 a[56:59], v1 offset:6144
v_cvt_pk_bf16_f32 v49, v18, v19
v_mfma_f32_16x16x32_bf16 v[36:39], a[16:19], a[176:179], v[84:87]
v_mfma_f32_16x16x32_bf16 v[36:39], a[20:23], a[180:183], v[36:39]
v_exp_f32 v21, v21
v_mfma_f32_16x16x32_bf16 v[36:39], a[24:27], a[184:187], v[36:39]
s_add_u32 m0, s27, 0x1000
v_exp_f32 v22, v22
v_mfma_f32_16x16x32_bf16 v[36:39], a[28:31], a[188:191], v[36:39]
buffer_load_dwordx4 v3, s[48:51], s7 offen offset:0 sc1 lds
v_mfma_f32_16x16x32_bf16 v[40:43], a[16:19], a[192:195], v[88:91]
ds_read_b128 a[60:63], v1 offset:7168
v_cvt_pk_bf16_f32 v52, v20, v21
v_mfma_f32_16x16x32_bf16 v[40:43], a[20:23], a[196:199], v[40:43]
v_exp_f32 v23, v23
v_mfma_f32_16x16x32_bf16 v[40:43], a[24:27], a[200:203], v[40:43]
v_cvt_pk_bf16_f32 v53, v22, v23
v_mfma_f32_16x16x32_bf16 v[40:43], a[28:31], a[204:207], v[40:43]
v_exp_f32 v24, v24
v_mfma_f32_16x16x32_bf16 v[44:47], a[16:19], a[208:211], v[92:95]
v_exp_f32 v25, v25
v_mfma_f32_16x16x32_bf16 v[44:47], a[20:23], a[212:215], v[44:47]
v_exp_f32 v26, v26
v_mfma_f32_16x16x32_bf16 v[44:47], a[24:27], a[216:219], v[44:47]
v_exp_f32 v27, v27
v_mfma_f32_16x16x32_bf16 v[44:47], a[28:31], a[220:223], v[44:47]
s_waitcnt lgkmcnt(0)
v_mfma_f32_16x16x32_bf16 v[128:131], a[32:35], v[64:67], v[128:131]
ds_read_b128 a[0:3], v1 offset:24576
v_cvt_pk_bf16_f32 v56, v24, v25
v_mfma_f32_16x16x32_bf16 v[160:163], a[32:35], v[68:71], v[160:163]
v_exp_f32 v28, v28
v_mfma_f32_16x16x32_bf16 v[192:195], a[32:35], v[72:75], v[192:195]
v_cvt_pk_bf16_f32 v57, v26, v27
v_mfma_f32_16x16x32_bf16 v[224:227], a[32:35], v[76:79], v[224:227]
ds_read_b128 a[4:7], v1 offset:25600
v_mfma_f32_16x16x32_bf16 v[228:231], a[36:39], v[76:79], v[228:231]
v_exp_f32 v29, v29
v_mfma_f32_16x16x32_bf16 v[196:199], a[36:39], v[72:75], v[196:199]
v_exp_f32 v30, v30
v_mfma_f32_16x16x32_bf16 v[164:167], a[36:39], v[68:71], v[164:167]
v_cvt_pk_bf16_f32 v60, v28, v29
v_mfma_f32_16x16x32_bf16 v[132:135], a[36:39], v[64:67], v[132:135]
buffer_load_dwordx4 v3, s[48:51], s7 offen offset:1024 sc1 lds
v_mfma_f32_16x16x32_bf16 v[136:139], a[40:43], v[64:67], v[136:139]
ds_read_b128 a[8:11], v1 offset:26624
v_mfma_f32_16x16x32_bf16 v[168:171], a[40:43], v[68:71], v[168:171]
v_exp_f32 v31, v31
v_mfma_f32_16x16x32_bf16 v[200:203], a[40:43], v[72:75], v[200:203]
v_exp_f32 v32, v32
v_mfma_f32_16x16x32_bf16 v[232:235], a[40:43], v[76:79], v[232:235]
ds_read_b128 a[12:15], v1 offset:27648
v_cvt_pk_bf16_f32 v61, v30, v31
v_mfma_f32_16x16x32_bf16 v[236:239], a[44:47], v[76:79], v[236:239]
v_mfma_f32_16x16x32_bf16 v[204:207], a[44:47], v[72:75], v[204:207]
v_exp_f32 v33, v33
v_mfma_f32_16x16x32_bf16 v[172:175], a[44:47], v[68:71], v[172:175]
v_exp_f32 v34, v34
v_mfma_f32_16x16x32_bf16 v[140:143], a[44:47], v[64:67], v[140:143]
ds_read_b128 a[16:19], v1 offset:28672
v_cvt_pk_bf16_f32 v50, v32, v33
v_mfma_f32_16x16x32_bf16 v[144:147], a[48:51], v[64:67], v[144:147]
v_mfma_f32_16x16x32_bf16 v[176:179], a[48:51], v[68:71], v[176:179]
v_exp_f32 v35, v35
v_mfma_f32_16x16x32_bf16 v[208:211], a[48:51], v[72:75], v[208:211]
ds_read_b128 a[20:23], v1 offset:29696
v_cvt_pk_bf16_f32 v51, v34, v35
v_mfma_f32_16x16x32_bf16 v[240:243], a[48:51], v[76:79], v[240:243]
v_exp_f32 v36, v36
v_mfma_f32_16x16x32_bf16 v[244:247], a[52:55], v[76:79], v[244:247]
v_exp_f32 v37, v37
v_mfma_f32_16x16x32_bf16 v[212:215], a[52:55], v[72:75], v[212:215]
v_cvt_pk_bf16_f32 v54, v36, v37
v_mfma_f32_16x16x32_bf16 v[180:183], a[52:55], v[68:71], v[180:183]
buffer_load_dwordx4 v3, s[48:51], s7 offen offset:2048 sc1 lds
v_mfma_f32_16x16x32_bf16 v[148:151], a[52:55], v[64:67], v[148:151]
ds_read_b128 a[24:27], v1 offset:30720
v_mfma_f32_16x16x32_bf16 v[152:155], a[56:59], v[64:67], v[152:155]
v_exp_f32 v38, v38
v_mfma_f32_16x16x32_bf16 v[184:187], a[56:59], v[68:71], v[184:187]
v_exp_f32 v39, v39
v_mfma_f32_16x16x32_bf16 v[216:219], a[56:59], v[72:75], v[216:219]
ds_read_b128 a[28:31], v1 offset:31744
v_cvt_pk_bf16_f32 v55, v38, v39
v_mfma_f32_16x16x32_bf16 v[248:251], a[56:59], v[76:79], v[248:251]
v_mfma_f32_16x16x32_bf16 v[252:255], a[60:63], v[76:79], v[252:255]
v_exp_f32 v40, v40
v_mfma_f32_16x16x32_bf16 v[220:223], a[60:63], v[72:75], v[220:223]
v_exp_f32 v41, v41
v_mfma_f32_16x16x32_bf16 v[188:191], a[60:63], v[68:71], v[188:191]
ds_read_b128 a[32:35], v1 offset:16384
v_cvt_pk_bf16_f32 v58, v40, v41
v_mfma_f32_16x16x32_bf16 v[156:159], a[60:63], v[64:67], v[156:159]
v_smfmac_f32_16x16x64_bf16 a[224:227], a[232:235], v[64:71], v9
s_waitcnt lgkmcnt(5)
v_exp_f32 v42, v42
v_smfmac_f32_16x16x64_bf16 a[228:231], a[232:235], v[72:79], v9
ds_read_b128 a[36:39], v1 offset:17408
v_mfma_f32_16x16x32_bf16 v[16:19], a[0:3], a[160:163], v[96:99]
v_exp_f32 v43, v43
v_mfma_f32_16x16x32_bf16 v[16:19], a[4:7], a[164:167], v[16:19]
v_exp_f32 v44, v44
v_mfma_f32_16x16x32_bf16 v[16:19], a[8:11], a[168:171], v[16:19]
v_cvt_pk_bf16_f32 v59, v42, v43
v_mfma_f32_16x16x32_bf16 v[16:19], a[12:15], a[172:175], v[16:19]
buffer_load_dwordx4 v3, s[48:51], s7 offen offset:3072 sc1 lds
v_mfma_f32_16x16x32_bf16 v[20:23], a[0:3], a[176:179], v[84:87]
ds_read_b128 a[40:43], v1 offset:18432
v_mfma_f32_16x16x32_bf16 v[20:23], a[4:7], a[180:183], v[20:23]
v_exp_f32 v45, v45
v_mfma_f32_16x16x32_bf16 v[20:23], a[8:11], a[184:187], v[20:23]
v_exp_f32 v46, v46
v_mfma_f32_16x16x32_bf16 v[20:23], a[12:15], a[188:191], v[20:23]
ds_read_b128 a[44:47], v1 offset:19456
v_cvt_pk_bf16_f32 v62, v44, v45
v_mfma_f32_16x16x32_bf16 v[24:27], a[0:3], a[192:195], v[88:91]
v_mfma_f32_16x16x32_bf16 v[24:27], a[4:7], a[196:199], v[24:27]
v_exp_f32 v47, v47
v_mfma_f32_16x16x32_bf16 v[24:27], a[8:11], a[200:203], v[24:27]
v_exp_f32 v16, v16
v_mfma_f32_16x16x32_bf16 v[24:27], a[12:15], a[204:207], v[24:27]
ds_read_b128 a[48:51], v1 offset:20480
v_cvt_pk_bf16_f32 v63, v46, v47
v_mfma_f32_16x16x32_bf16 v[28:31], a[0:3], a[208:211], v[92:95]
v_mfma_f32_16x16x32_bf16 v[28:31], a[4:7], a[212:215], v[28:31]
v_exp_f32 v17, v17
v_mfma_f32_16x16x32_bf16 v[28:31], a[8:11], a[216:219], v[28:31]
ds_read_b128 a[52:55], v1 offset:21504
v_cvt_pk_bf16_f32 v64, v16, v17
v_mfma_f32_16x16x32_bf16 v[28:31], a[12:15], a[220:223], v[28:31]
s_waitcnt lgkmcnt(6)
v_exp_f32 v18, v18
v_mfma_f32_16x16x32_bf16 v[32:35], a[16:19], a[160:163], v[100:103]
v_mfma_f32_16x16x32_bf16 v[32:35], a[20:23], a[164:167], v[32:35]
s_mov_b32 s9, 0x0
v_exp_f32 v19, v19
v_mfma_f32_16x16x32_bf16 v[32:35], a[24:27], a[168:171], v[32:35]
buffer_load_dword a244, v8, s[72:75], s9 offen
v_mfma_f32_16x16x32_bf16 v[32:35], a[28:31], a[172:175], v[32:35]
ds_read_b128 a[56:59], v1 offset:22528
v_cvt_pk_bf16_f32 v65, v18, v19
v_mfma_f32_16x16x32_bf16 v[36:39], a[16:19], a[176:179], v[84:87]
s_add_u32 s32, s32, 0x8000
v_exp_f32 v20, v20
v_mfma_f32_16x16x32_bf16 v[36:39], a[20:23], a[180:183], v[36:39]
s_add_u32 s7, s7, 0x8000
v_exp_f32 v21, v21
v_mfma_f32_16x16x32_bf16 v[36:39], a[24:27], a[184:187], v[36:39]
ds_read_b128 a[60:63], v1 offset:23552
v_xor_b32 v1, 0x8000, v1
v_mfma_f32_16x16x32_bf16 v[36:39], a[28:31], a[188:191], v[36:39]
s_xor_b32 s27, s27, 0x38000
v_cvt_pk_bf16_f32 v68, v20, v21
v_mfma_f32_16x16x32_bf16 v[40:43], a[16:19], a[192:195], v[88:91]
v_exp_f32 v22, v22
v_mfma_f32_16x16x32_bf16 v[40:43], a[20:23], a[196:199], v[40:43]
v_exp_f32 v23, v23
v_mfma_f32_16x16x32_bf16 v[40:43], a[24:27], a[200:203], v[40:43]
v_cvt_pk_bf16_f32 v69, v22, v23
v_mfma_f32_16x16x32_bf16 v[40:43], a[28:31], a[204:207], v[40:43]
v_exp_f32 v24, v24
v_mfma_f32_16x16x32_bf16 v[44:47], a[16:19], a[208:211], v[92:95]
v_exp_f32 v25, v25
v_mfma_f32_16x16x32_bf16 v[44:47], a[20:23], a[212:215], v[44:47]
v_exp_f32 v26, v26
v_mfma_f32_16x16x32_bf16 v[44:47], a[24:27], a[216:219], v[44:47]
s_waitcnt vmcnt(17) lgkmcnt(0)
v_exp_f32 v27, v27
v_mfma_f32_16x16x32_bf16 v[44:47], a[28:31], a[220:223], v[44:47]
s_barrier
L_att_l1_1:
v_mfma_f32_16x16x32_bf16 v[128:131], a[32:35], v[48:51], v[128:131]
ds_read_b128 a[0:3], v2 offset:8192
v_cvt_pk_bf16_f32 v72, v24, v25
v_mfma_f32_16x16x32_bf16 v[160:163], a[32:35], v[52:55], v[160:163]
s_add_u32 m0, s19, 0x0
v_exp_f32 v28, v28
v_mfma_f32_16x16x32_bf16 v[192:195], a[32:35], v[56:59], v[192:195]
buffer_load_dwordx4 v3, s[48:51], s32 offen offset:0 sc1 lds
v_mfma_f32_16x16x32_bf16 v[224:227], a[32:35], v[60:63], v[224:227]
ds_read_b128 a[4:7], v2 offset:9216
v_cvt_pk_bf16_f32 v73, v26, v27
v_mfma_f32_16x16x32_bf16 v[228:231], a[36:39], v[60:63], v[228:231]
s_and_b32 s44, s18, 3
s_lshl_b32 s45, s44, 1
s_add_u32 s45, s45, s100
v_mfma_f32_16x16x32_bf16 v[196:199], a[36:39], v[56:59], v[196:199]
s_add_u32 s8, s16, 0x0
v_exp_f32 v29, v29
v_mfma_f32_16x16x32_bf16 v[164:167], a[36:39], v[52:55], v[164:167]
ds_read_b128 a[8:11], v2 offset:10240
v_cvt_pk_bf16_f32 v76, v28, v29
v_mfma_f32_16x16x32_bf16 v[132:135], a[36:39], v[48:51], v[132:135]
buffer_store_dwordx4 a[64:67], v3, s[88:91], s8 offen offset:0 sc1
v_mfma_f32_16x16x32_bf16 v[136:139], a[40:43], v[48:51], v[136:139]
s_and_b32 s60, s45, 3
v_exp_f32 v30, v30
v_mfma_f32_16x16x32_bf16 v[168:171], a[40:43], v[52:55], v[168:171]
ds_read_b128 a[12:15], v2 offset:11264
s_sub_u32 s60, s60, s44
v_mfma_f32_16x16x32_bf16 v[200:203], a[40:43], v[56:59], v[200:203]
s_add_u32 s60, s60, 11
v_exp_f32 v31, v31
v_mfma_f32_16x16x32_bf16 v[232:235], a[40:43], v[60:63], v[232:235]
s_lshl_b32 s60, s60, 14
v_exp_f32 v32, v32
v_mfma_f32_16x16x32_bf16 v[236:239], a[44:47], v[60:63], v[236:239]
buffer_load_dwordx4 v3, s[48:51], s32 offen offset:1024 sc1 lds
v_mfma_f32_16x16x32_bf16 v[204:207], a[44:47], v[56:59], v[204:207]
ds_read_b128 a[16:19], v2 offset:12288
v_cvt_pk_bf16_f32 v77, v30, v31
v_mfma_f32_16x16x32_bf16 v[172:175], a[44:47], v[52:55], v[172:175]
s_mul_i32 s44, s44, -8
v_exp_f32 v33, v33
v_mfma_f32_16x16x32_bf16 v[140:143], a[44:47], v[48:51], v[140:143]
s_and_b32 s44, s44, 31
v_exp_f32 v34, v34
v_mfma_f32_16x16x32_bf16 v[144:147], a[48:51], v[48:51], v[144:147]
ds_read_b128 a[20:23], v2 offset:13312
v_cvt_pk_bf16_f32 v66, v32, v33
v_mfma_f32_16x16x32_bf16 v[176:179], a[48:51], v[52:55], v[176:179]
buffer_store_dwordx4 a[64:67], v3, s[88:91], s8 offen offset:1024 sc1
v_mfma_f32_16x16x32_bf16 v[208:211], a[48:51], v[56:59], v[208:211]
s_lshl_b32 s44, 4, s44
v_exp_f32 v35, v35
v_mfma_f32_16x16x32_bf16 v[240:243], a[48:51], v[60:63], v[240:243]
ds_read_b128 a[24:27], v2 offset:14336
v_cvt_pk_bf16_f32 v67, v34, v35
v_mfma_f32_16x16x32_bf16 v[244:247], a[52:55], v[60:63], v[244:247]
s_mul_i32 s45, s45, -8
v_exp_f32 v36, v36
v_mfma_f32_16x16x32_bf16 v[212:215], a[52:55], v[56:59], v[212:215]
s_and_b32 s45, s45, 31
v_exp_f32 v37, v37
v_mfma_f32_16x16x32_bf16 v[180:183], a[52:55], v[52:55], v[180:183]
buffer_load_dwordx4 v3, s[48:51], s32 offen offset:2048 sc1 lds
v_mfma_f32_16x16x32_bf16 v[148:151], a[52:55], v[48:51], v[148:151]
ds_read_b128 a[28:31], v2 offset:15360
v_cvt_pk_bf16_f32 v70, v36, v37
v_mfma_f32_16x16x32_bf16 v[152:155], a[56:59], v[48:51], v[152:155]
s_lshl_b32 s45, 4, s45
s_add_u32 s44, s44, 0x11111111
s_sub_u32 s44, s44, s45
v_mfma_f32_16x16x32_bf16 v[184:187], a[56:59], v[52:55], v[184:187]
s_bfe_u32 s56, s44, 0x80000
v_exp_f32 v38, v38
v_mfma_f32_16x16x32_bf16 v[216:219], a[56:59], v[56:59], v[216:219]
ds_read_b128 a[32:35], v2 offset:0
s_lshl_b32 s56, s56, 14
v_mfma_f32_16x16x32_bf16 v[248:251], a[56:59], v[60:63], v[248:251]
s_bfe_u32 s57, s44, 0x80008
v_exp_f32 v39, v39
v_mfma_f32_16x16x32_bf16 v[252:255], a[60:63], v[60:63], v[252:255]
buffer_store_dwordx4 a[64:67], v3, s[88:91], s8 offen offset:2048 sc1
v_mfma_f32_16x16x32_bf16 v[220:223], a[60:63], v[56:59], v[220:223]
ds_read_b128 a[36:39], v2 offset:1024
v_cvt_pk_bf16_f32 v71, v38, v39
v_mfma_f32_16x16x32_bf16 v[188:191], a[60:63], v[52:55], v[188:191]
s_lshl_b32 s57, s57, 14
v_exp_f32 v40, v40
v_mfma_f32_16x16x32_bf16 v[156:159], a[60:63], v[48:51], v[156:159]
s_bfe_u32 s58, s44, 0x80010
v_exp_f32 v41, v41
v_smfmac_f32_16x16x64_bf16 a[224:227], a[232:235], v[48:55], v9
s_waitcnt lgkmcnt(6)
v_exp_f32 v42, v42
v_smfmac_f32_16x16x64_bf16 a[228:231], a[232:235], v[56:63], v9
buffer_load_dwordx4 v3, s[48:51], s32 offen offset:3072 sc1 lds
v_mfma_f32_16x16x32_bf16 v[20:23], a[0:3], a[176:179], v[104:107]
ds_read_b128 a[40:43], v2 offset:2048
v_cvt_pk_bf16_f32 v74, v40, v41
v_mfma_f32_16x16x32_bf16 v[20:23], a[4:7], a[180:183], v[20:23]
s_lshl_b32 s58, s58, 14
v_exp_f32 v43, v43
v_mfma_f32_16x16x32_bf16 v[20:23], a[8:11], a[184:187], v[20:23]
ds_read_b128 a[44:47], v2 offset:3072
v_cvt_pk_bf16_f32 v75, v42, v43
v_mfma_f32_16x16x32_bf16 v[20:23], a[12:15], a[188:191], v[20:23]
s_bfe_u32 s59, s44, 0x80018
v_exp_f32 v44, v44
v_mfma_f32_16x16x32_bf16 v[24:27], a[0:3], a[192:195], v[88:91]
buffer_store_dwordx4 a[64:67], v3, s[88:91], s8 offen offset:3072 sc1
v_mfma_f32_16x16x32_bf16 v[24:27], a[4:7], a[196:199], v[24:27]
ds_read_b128 a[48:51], v2 offset:4096
s_lshl_b32 s59, s59, 14
v_mfma_f32_16x16x32_bf16 v[24:27], a[8:11], a[200:203], v[24:27]
v_exp_f32 v45, v45
v_mfma_f32_16x16x32_bf16 v[24:27], a[12:15], a[204:207], v[24:27]
v_exp_f32 v46, v46
v_mfma_f32_16x16x32_bf16 v[28:31], a[0:3], a[208:211], v[92:95]
s_add_u32 m0, s19, 0x1000
v_exp_f32 v47, v47
v_mfma_f32_16x16x32_bf16 v[28:31], a[4:7], a[212:215], v[28:31]
buffer_load_dwordx4 v3, s[48:51], s7 offen offset:0 sc1 lds
v_mfma_f32_16x16x32_bf16 v[28:31], a[8:11], a[216:219], v[28:31]
ds_read_b128 a[52:55], v2 offset:5120
v_cvt_pk_bf16_f32 v78, v44, v45
v_mfma_f32_16x16x32_bf16 v[28:31], a[12:15], a[220:223], v[28:31]
s_waitcnt lgkmcnt(6)
v_exp_f32 v20, v20
v_mfma_f32_16x16x32_bf16 v[36:39], a[16:19], a[176:179], v[108:111]
ds_read_b128 a[56:59], v2 offset:6144
v_cvt_pk_bf16_f32 v79, v46, v47
v_mfma_f32_16x16x32_bf16 v[36:39], a[20:23], a[180:183], v[36:39]
s_add_u32 s8, s16, 0x400000
v_exp_f32 v21, v21
v_mfma_f32_16x16x32_bf16 v[36:39], a[24:27], a[184:187], v[36:39]
buffer_store_dwordx4 a[64:67], v3, s[88:91], s8 offen offset:0 sc1
v_mfma_f32_16x16x32_bf16 v[36:39], a[28:31], a[188:191], v[36:39]
ds_read_b128 a[60:63], v2 offset:7168
v_cvt_pk_bf16_f32 v52, v20, v21
v_mfma_f32_16x16x32_bf16 v[40:43], a[16:19], a[192:195], v[88:91]
v_exp_f32 v22, v22
v_mfma_f32_16x16x32_bf16 v[40:43], a[20:23], a[196:199], v[40:43]
v_exp_f32 v23, v23
v_mfma_f32_16x16x32_bf16 v[40:43], a[24:27], a[200:203], v[40:43]
v_exp_f32 v24, v24
v_mfma_f32_16x16x32_bf16 v[40:43], a[28:31], a[204:207], v[40:43]
buffer_load_dwordx4 v3, s[48:51], s7 offen offset:1024 sc1 lds
v_mfma_f32_16x16x32_bf16 v[44:47], a[16:19], a[208:211], v[92:95]
v_exp_f32 v25, v25
v_mfma_f32_16x16x32_bf16 v[44:47], a[20:23], a[212:215], v[44:47]
v_exp_f32 v26, v26
v_mfma_f32_16x16x32_bf16 v[44:47], a[24:27], a[216:219], v[44:47]
v_exp_f32 v27, v27
v_mfma_f32_16x16x32_bf16 v[44:47], a[28:31], a[220:223], v[44:47]
s_waitcnt lgkmcnt(0)
v_cvt_pk_bf16_f32 v53, v22, v23
v_mov_b32 v6, 0xf149f2ca
v_min_f32 v119, s10, v88
v_cndmask_b32 v112, v119, v88, s[36:37]
v_cndmask_b32 v113, v119, v88, s[38:39]
v_cndmask_b32 v114, v119, v88, s[40:41]
v_cndmask_b32 v115, v119, v88, s[42:43]
v_cndmask_b32 v116, v6, v119, s[36:37]
v_cndmask_b32 v117, v6, v119, s[38:39]
v_cndmask_b32 v118, v6, v119, s[40:41]
v_cndmask_b32 v119, v6, v119, s[42:43]
v_min_f32 v127, s11, v92
v_cndmask_b32 v120, v127, v92, s[36:37]
v_cndmask_b32 v121, v127, v92, s[38:39]
v_cndmask_b32 v122, v127, v92, s[40:41]
v_cndmask_b32 v123, v127, v92, s[42:43]
v_cndmask_b32 v124, v6, v127, s[36:37]
v_cndmask_b32 v125, v6, v127, s[38:39]
v_cndmask_b32 v126, v6, v127, s[40:41]
v_cndmask_b32 v127, v6, v127, s[42:43]
v_mfma_f32_16x16x32_bf16 v[128:131], a[32:35], v[64:67], v[128:131]
v_exp_f32 v28, v28
v_mfma_f32_16x16x32_bf16 v[160:163], a[32:35], v[68:71], v[160:163]
ds_read_b128 a[0:3], v2 offset:24576
v_cvt_pk_bf16_f32 v56, v24, v25
v_mfma_f32_16x16x32_bf16 v[192:195], a[32:35], v[72:75], v[192:195]
buffer_store_dwordx4 a[64:67], v3, s[88:91], s8 offen offset:1024 sc1
v_mfma_f32_16x16x32_bf16 v[224:227], a[32:35], v[76:79], v[224:227]
ds_read_b128 a[4:7], v2 offset:25600
v_cvt_pk_bf16_f32 v57, v26, v27
v_mfma_f32_16x16x32_bf16 v[228:231], a[36:39], v[76:79], v[228:231]
buffer_load_dwordx4 v3, s[48:51], s7 offen offset:2048 sc1 lds
v_mfma_f32_16x16x32_bf16 v[196:199], a[36:39], v[72:75], v[196:199]
ds_read_b128 a[8:11], v2 offset:26624
v_mfma_f32_16x16x32_bf16 v[164:167], a[36:39], v[68:71], v[164:167]
v_exp_f32 v29, v29
v_mfma_f32_16x16x32_bf16 v[132:135], a[36:39], v[64:67], v[132:135]
v_exp_f32 v30, v30
v_mfma_f32_16x16x32_bf16 v[136:139], a[40:43], v[64:67], v[136:139]
v_exp_f32 v31, v31
v_mfma_f32_16x16x32_bf16 v[168:171], a[40:43], v[68:71], v[168:171]
v_exp_f32 v36, v36
v_mfma_f32_16x16x32_bf16 v[200:203], a[40:43], v[72:75], v[200:203]
ds_read_b128 a[12:15], v2 offset:27648
v_cvt_pk_bf16_f32 v60, v28, v29
v_mfma_f32_16x16x32_bf16 v[232:235], a[40:43], v[76:79], v[232:235]
buffer_store_dwordx4 a[64:67], v3, s[88:91], s8 offen offset:2048 sc1
v_mfma_f32_16x16x32_bf16 v[236:239], a[44:47], v[76:79], v[236:239]
ds_read_b128 a[16:19], v2 offset:28672
v_cvt_pk_bf16_f32 v61, v30, v31
v_mfma_f32_16x16x32_bf16 v[204:207], a[44:47], v[72:75], v[204:207]
v_exp_f32 v37, v37
v_mfma_f32_16x16x32_bf16 v[172:175], a[44:47], v[68:71], v[172:175]
ds_read_b128 a[20:23], v2 offset:29696
v_cvt_pk_bf16_f32 v54, v36, v37
v_mfma_f32_16x16x32_bf16 v[140:143], a[44:47], v[64:67], v[140:143]
buffer_load_dwordx4 v3, s[48:51], s7 offen offset:3072 sc1 lds
v_mfma_f32_16x16x32_bf16 v[144:147], a[48:51], v[64:67], v[144:147]
v_exp_f32 v38, v38
v_mfma_f32_16x16x32_bf16 v[176:179], a[48:51], v[68:71], v[176:179]
buffer_store_dwordx4 a[64:67], v3, s[88:91], s8 offen offset:3072 sc1
v_mfma_f32_16x16x32_bf16 v[208:211], a[48:51], v[72:75], v[208:211]
ds_read_b128 a[24:27], v2 offset:30720
v_mfma_f32_16x16x32_bf16 v[240:243], a[48:51], v[76:79], v[240:243]
ds_read_b128 a[28:31], v2 offset:31744
v_mfma_f32_16x16x32_bf16 v[244:247], a[52:55], v[76:79], v[244:247]
s_add_u32 s8, s16, 0x800000
v_exp_f32 v39, v39
v_mfma_f32_16x16x32_bf16 v[212:215], a[52:55], v[72:75], v[212:215]
buffer_store_dwordx4 a[64:67], v3, s[88:91], s8 offen offset:0 sc1
v_mfma_f32_16x16x32_bf16 v[180:183], a[52:55], v[68:71], v[180:183]
ds_read_b128 a[32:35], v2 offset:16384
v_cvt_pk_bf16_f32 v55, v38, v39
v_mfma_f32_16x16x32_bf16 v[148:151], a[52:55], v[64:67], v[148:151]
v_exp_f32 v40, v40
v_mfma_f32_16x16x32_bf16 v[152:155], a[56:59], v[64:67], v[152:155]
v_exp_f32 v41, v41
v_mfma_f32_16x16x32_bf16 v[184:187], a[56:59], v[68:71], v[184:187]
buffer_store_dwordx4 a[64:67], v3, s[88:91], s8 offen offset:1024 sc1
v_mfma_f32_16x16x32_bf16 v[216:219], a[56:59], v[72:75], v[216:219]
ds_read_b128 a[36:39], v2 offset:17408
v_cvt_pk_bf16_f32 v58, v40, v41
v_mfma_f32_16x16x32_bf16 v[248:251], a[56:59], v[76:79], v[248:251]
ds_read_b128 a[40:43], v2 offset:18432
v_mfma_f32_16x16x32_bf16 v[252:255], a[60:63], v[76:79], v[252:255]
v_exp_f32 v42, v42
v_mfma_f32_16x16x32_bf16 v[220:223], a[60:63], v[72:75], v[220:223]
buffer_store_dwordx4 a[64:67], v3, s[88:91], s8 offen offset:2048 sc1
v_mfma_f32_16x16x32_bf16 v[188:191], a[60:63], v[68:71], v[188:191]
ds_read_b128 a[44:47], v2 offset:19456
v_mfma_f32_16x16x32_bf16 v[156:159], a[60:63], v[64:67], v[156:159]
v_exp_f32 v43, v43
v_smfmac_f32_16x16x64_bf16 a[224:227], a[232:235], v[64:71], v9
v_exp_f32 v44, v44
v_smfmac_f32_16x16x64_bf16 a[228:231], a[232:235], v[72:79], v9
s_waitcnt lgkmcnt(8)
v_exp_f32 v45, v45
v_mfma_f32_16x16x32_bf16 v[24:27], a[0:3], a[192:195], v[88:91]
ds_read_b128 a[48:51], v2 offset:20480
v_cvt_pk_bf16_f32 v59, v42, v43
v_mfma_f32_16x16x32_bf16 v[24:27], a[4:7], a[196:199], v[24:27]
ds_read_b128 a[52:55], v2 offset:21504
v_cvt_pk_bf16_f32 v62, v44, v45
v_mfma_f32_16x16x32_bf16 v[24:27], a[8:11], a[200:203], v[24:27]
buffer_store_dwordx4 a[64:67], v3, s[88:91], s8 offen offset:3072 sc1
v_mfma_f32_16x16x32_bf16 v[24:27], a[12:15], a[204:207], v[24:27]
v_exp_f32 v46, v46
v_mfma_f32_16x16x32_bf16 v[28:31], a[0:3], a[208:211], v[92:95]
ds_read_b128 a[56:59], v2 offset:22528
v_add_u32 v4, s0, v3
v_mfma_f32_16x16x32_bf16 v[28:31], a[4:7], a[212:215], v[28:31]
s_waitcnt lgkmcnt(7)
v_exp_f32 v47, v47
v_mfma_f32_16x16x32_bf16 v[28:31], a[8:11], a[216:219], v[28:31]
ds_read_b128 a[60:63], v2 offset:23552
v_mov_b32 v5, s1
v_mfma_f32_16x16x32_bf16 v[28:31], a[12:15], a[220:223], v[28:31]
global_load_dword a244, v[4:5], off sc1
v_mfma_f32_16x16x32_bf16 v[40:43], a[16:19], a[192:195], v[88:91]
s_add_u32 s32, s32, 0x8000
v_xor_b32 v2, 0x38000, v2
v_cvt_pk_bf16_f32 v63, v46, v47
v_mfma_f32_16x16x32_bf16 v[40:43], a[20:23], a[196:199], v[40:43]
s_add_u32 s7, s7, 0x8000
v_exp_f32 v24, v24
v_mfma_f32_16x16x32_bf16 v[40:43], a[24:27], a[200:203], v[40:43]
s_xor_b32 s19, s19, 0x8000
v_exp_f32 v25, v25
v_mfma_f32_16x16x32_bf16 v[40:43], a[28:31], a[204:207], v[40:43]
s_sub_u32 s15, 7, s6
v_exp_f32 v26, v26
v_mfma_f32_16x16x32_bf16 v[44:47], a[16:19], a[208:211], v[92:95]
s_lshl_b32 s15, s15, 1
v_exp_f32 v27, v27
v_mfma_f32_16x16x32_bf16 v[44:47], a[20:23], a[212:215], v[44:47]
v_exp_f32 v28, v28
v_mfma_f32_16x16x32_bf16 v[44:47], a[24:27], a[216:219], v[44:47]
s_waitcnt vmcnt(30) lgkmcnt(0)
v_exp_f32 v29, v29
v_mfma_f32_16x16x32_bf16 v[44:47], a[28:31], a[220:223], v[44:47]
s_barrier
s_cbranch_scc0 L_att_lh0_1
L_att_ls_1:
v_mfma_f32_16x16x32_bf16 v[160:163], a[32:35], v[52:55], v[160:163]
ds_read_b128 a[0:3], v1 offset:8192
v_cvt_pk_bf16_f32 v72, v24, v25
v_mfma_f32_16x16x32_bf16 v[192:195], a[32:35], v[56:59], v[192:195]
v_exp_f32 v30, v30
v_mfma_f32_16x16x32_bf16 v[224:227], a[32:35], v[60:63], v[224:227]
ds_read_b128 a[4:7], v1 offset:9216
v_cvt_pk_bf16_f32 v73, v26, v27
v_mfma_f32_16x16x32_bf16 v[228:231], a[36:39], v[60:63], v[228:231]
s_add_u32 m0, s27, 0x0
v_cvt_pk_bf16_f32 v76, v28, v29
v_accvgpr_read_b32 v6, a224
v_mfma_f32_16x16x32_bf16 v[196:199], a[36:39], v[56:59], v[196:199]
buffer_load_dwordx4 v3, s[48:51], s32 offen offset:0 sc1 lds
v_mfma_f32_16x16x32_bf16 v[164:167], a[36:39], v[52:55], v[164:167]
ds_read_b128 a[8:11], v1 offset:10240
v_accvgpr_read_b32 v7, a225
v_mfma_f32_16x16x32_bf16 v[168:171], a[40:43], v[52:55], v[168:171]
ds_read_b128 a[12:15], v1 offset:11264
v_add_f32 v6, v6, v7
v_mfma_f32_16x16x32_bf16 v[200:203], a[40:43], v[56:59], v[200:203]
v_exp_f32 v31, v31
v_mfma_f32_16x16x32_bf16 v[232:235], a[40:43], v[60:63], v[232:235]
v_exp_f32 v40, v40
v_mfma_f32_16x16x32_bf16 v[236:239], a[44:47], v[60:63], v[236:239]
ds_read_b128 a[16:19], v1 offset:12288
v_cvt_pk_bf16_f32 v77, v30, v31
v_mfma_f32_16x16x32_bf16 v[204:207], a[44:47], v[56:59], v[204:207]
v_cmp_nge_f32 vcc, 0x6f800000, v6
v_mfma_f32_16x16x32_bf16 v[172:175], a[44:47], v[52:55], v[172:175]
ds_read_b128 a[20:23], v1 offset:13312
v_mfma_f32_16x16x32_bf16 v[176:179], a[48:51], v[52:55], v[176:179]
v_exp_f32 v41, v41
v_mfma_f32_16x16x32_bf16 v[208:211], a[48:51], v[56:59], v[208:211]
ds_read_b128 a[24:27], v1 offset:14336
v_cvt_pk_bf16_f32 v74, v40, v41
v_mfma_f32_16x16x32_bf16 v[240:243], a[48:51], v[60:63], v[240:243]
buffer_load_dwordx4 v3, s[48:51], s32 offen offset:1024 sc1 lds
v_mfma_f32_16x16x32_bf16 v[244:247], a[52:55], v[60:63], v[244:247]
v_exp_f32 v42, v42
v_mfma_f32_16x16x32_bf16 v[212:215], a[52:55], v[56:59], v[212:215]
ds_read_b128 a[28:31], v1 offset:15360
v_mfma_f32_16x16x32_bf16 v[180:183], a[52:55], v[52:55], v[180:183]
v_exp_f32 v43, v43
v_mfma_f32_16x16x32_bf16 v[184:187], a[56:59], v[52:55], v[184:187]
ds_read_b128 a[32:35], v1 offset:0
v_cvt_pk_bf16_f32 v75, v42, v43
v_mfma_f32_16x16x32_bf16 v[216:219], a[56:59], v[56:59], v[216:219]
v_rcp_f32 v6, v6
v_mfma_f32_16x16x32_bf16 v[248:251], a[56:59], v[60:63], v[248:251]
ds_read_b128 a[36:39], v1 offset:1024
s_or_b64 s[34:35], s[34:35], vcc
v_mfma_f32_16x16x32_bf16 v[252:255], a[60:63], v[60:63], v[252:255]
s_add_u32 s8, s28, 0x0
v_exp_f32 v44, v44
v_mfma_f32_16x16x32_bf16 v[220:223], a[60:63], v[56:59], v[220:223]
v_exp_f32 v45, v45
v_mfma_f32_16x16x32_bf16 v[188:191], a[60:63], v[52:55], v[188:191]
ds_read_b128 a[40:43], v1 offset:2048
v_cvt_pk_bf16_f32 v78, v44, v45
v_mfma_f32_16x16x32_bf16 a[224:227], a[236:239], v[52:55], a[224:227]
buffer_load_dwordx4 v3, s[48:51], s32 offen offset:2048 sc1 lds
v_smfmac_f32_16x16x64_bf16 a[228:231], a[232:235], v[56:63], v9
ds_read_b128 a[44:47], v1 offset:3072
s_waitcnt lgkmcnt(8)
v_mfma_f32_16x16x32_bf16 v[24:27], a[0:3], a[192:195], v[88:91]
v_exp_f32 v46, v46
v_mfma_f32_16x16x32_bf16 v[24:27], a[4:7], a[196:199], v[24:27]
ds_read_b128 a[48:51], v1 offset:4096
v_mul_f32 v128, v6, v128
v_mfma_f32_16x16x32_bf16 v[24:27], a[8:11], a[200:203], v[24:27]
v_mul_f32 v129, v6, v129
v_mul_f32 v130, v6, v130
v_mfma_f32_16x16x32_bf16 v[24:27], a[12:15], a[204:207], v[24:27]
v_exp_f32 v47, v47
v_mfma_f32_16x16x32_bf16 v[28:31], a[0:3], a[208:211], v[92:95]
ds_read_b128 a[52:55], v1 offset:5120
v_cvt_pk_bf16_f32 v79, v46, v47
v_mfma_f32_16x16x32_bf16 v[28:31], a[4:7], a[212:215], v[28:31]
v_mul_f32 v131, v6, v131
v_mul_f32 v132, v6, v132
v_mfma_f32_16x16x32_bf16 v[28:31], a[8:11], a[216:219], v[28:31]
ds_read_b128 a[56:59], v1 offset:6144
v_mul_f32 v133, v6, v133
v_mfma_f32_16x16x32_bf16 v[28:31], a[12:15], a[220:223], v[28:31]
s_waitcnt lgkmcnt(7)
v_exp_f32 v24, v24
v_mfma_f32_16x16x32_bf16 v[40:43], a[16:19], a[192:195], v[88:91]
buffer_load_dwordx4 v3, s[48:51], s32 offen offset:3072 sc1 lds
v_mfma_f32_16x16x32_bf16 v[40:43], a[20:23], a[196:199], v[40:43]
ds_read_b128 a[60:63], v1 offset:7168
v_mul_f32 v134, v6, v134
v_mfma_f32_16x16x32_bf16 v[40:43], a[24:27], a[200:203], v[40:43]
s_add_u32 s32, s32, 0x8000
v_exp_f32 v25, v25
v_mfma_f32_16x16x32_bf16 v[40:43], a[28:31], a[204:207], v[40:43]
v_exp_f32 v26, v26
v_mfma_f32_16x16x32_bf16 v[44:47], a[16:19], a[208:211], v[92:95]
v_exp_f32 v27, v27
v_mfma_f32_16x16x32_bf16 v[44:47], a[20:23], a[212:215], v[44:47]
v_exp_f32 v28, v28
v_mfma_f32_16x16x32_bf16 v[44:47], a[24:27], a[216:219], v[44:47]
v_exp_f32 v29, v29
v_mfma_f32_16x16x32_bf16 v[44:47], a[28:31], a[220:223], v[44:47]
s_waitcnt lgkmcnt(0)
v_mul_f32 v135, v6, v135
v_cvt_pk_bf16_f32 v128, v128, v129
v_mfma_f32_16x16x32_bf16 v[192:195], a[32:35], v[72:75], v[192:195]
s_add_u32 m0, s27, 0x1000
v_exp_f32 v30, v30
v_mfma_f32_16x16x32_bf16 v[224:227], a[32:35], v[76:79], v[224:227]
buffer_load_dwordx4 v3, s[48:51], s7 offen offset:0 sc1 lds
v_mfma_f32_16x16x32_bf16 v[228:231], a[36:39], v[76:79], v[228:231]
v_exp_f32 v31, v31
v_mfma_f32_16x16x32_bf16 v[196:199], a[36:39], v[72:75], v[196:199]
ds_read_b128 a[0:3], v1 offset:24576
v_cvt_pk_bf16_f32 v56, v24, v25
v_mfma_f32_16x16x32_bf16 v[200:203], a[40:43], v[72:75], v[200:203]
ds_read_b128 a[4:7], v1 offset:25600
v_cvt_pk_bf16_f32 v57, v26, v27
v_mfma_f32_16x16x32_bf16 v[232:235], a[40:43], v[76:79], v[232:235]
v_exp_f32 v40, v40
v_mfma_f32_16x16x32_bf16 v[236:239], a[44:47], v[76:79], v[236:239]
ds_read_b128 a[8:11], v1 offset:26624
v_cvt_pk_bf16_f32 v60, v28, v29
v_mfma_f32_16x16x32_bf16 v[204:207], a[44:47], v[72:75], v[204:207]
v_exp_f32 v41, v41
v_mfma_f32_16x16x32_bf16 v[208:211], a[48:51], v[72:75], v[208:211]
ds_read_b128 a[12:15], v1 offset:27648
v_cvt_pk_bf16_f32 v61, v30, v31
v_mfma_f32_16x16x32_bf16 v[240:243], a[48:51], v[76:79], v[240:243]
ds_read_b128 a[16:19], v1 offset:28672
v_cvt_pk_bf16_f32 v58, v40, v41
v_mfma_f32_16x16x32_bf16 v[244:247], a[52:55], v[76:79], v[244:247]
v_exp_f32 v42, v42
v_mfma_f32_16x16x32_bf16 v[212:215], a[52:55], v[72:75], v[212:215]
buffer_load_dwordx4 v3, s[48:51], s7 offen offset:1024 sc1 lds
v_mfma_f32_16x16x32_bf16 v[216:219], a[56:59], v[72:75], v[216:219]
ds_read_b128 a[20:23], v1 offset:29696
v_cvt_pk_bf16_f32 v129, v130, v131
v_mfma_f32_16x16x32_bf16 v[248:251], a[56:59], v[76:79], v[248:251]
ds_read_b128 a[24:27], v1 offset:30720
v_cvt_pk_bf16_f32 v130, v132, v133
v_mfma_f32_16x16x32_bf16 v[252:255], a[60:63], v[76:79], v[252:255]
ds_read_b128 a[28:31], v1 offset:31744
v_cvt_pk_bf16_f32 v131, v134, v135
v_mfma_f32_16x16x32_bf16 v[220:223], a[60:63], v[72:75], v[220:223]
s_waitcnt lgkmcnt(4)
v_exp_f32 v43, v43
v_smfmac_f32_16x16x64_bf16 a[228:231], a[232:235], v[72:79], v9
ds_read_b128 a[32:35], v1 offset:16384
v_cvt_pk_bf16_f32 v59, v42, v43
v_mfma_f32_16x16x32_bf16 v[24:27], a[0:3], a[192:195], v[88:91]
ds_read_b128 a[36:39], v1 offset:17408
buffer_store_dwordx4 v[128:131], v3, s[88:91], s8 offen sc1
v_mfma_f32_16x16x32_bf16 v[24:27], a[4:7], a[196:199], v[24:27]
buffer_load_dwordx4 v3, s[48:51], s7 offen offset:2048 sc1 lds
v_mfma_f32_16x16x32_bf16 v[24:27], a[8:11], a[200:203], v[24:27]
ds_read_b128 a[40:43], v1 offset:18432
v_exp_f32 v44, v44
v_mfma_f32_16x16x32_bf16 v[24:27], a[12:15], a[204:207], v[24:27]
ds_read_b128 a[44:47], v1 offset:19456
v_exp_f32 v45, v45
v_mfma_f32_16x16x32_bf16 v[28:31], a[0:3], a[208:211], v[92:95]
ds_read_b128 a[48:51], v1 offset:20480
v_exp_f32 v46, v46
v_mfma_f32_16x16x32_bf16 v[28:31], a[4:7], a[212:215], v[28:31]
s_waitcnt lgkmcnt(5)
v_exp_f32 v47, v47
v_mfma_f32_16x16x32_bf16 v[28:31], a[8:11], a[216:219], v[28:31]
ds_read_b128 a[52:55], v1 offset:21504
v_cvt_pk_bf16_f32 v62, v44, v45
v_mfma_f32_16x16x32_bf16 v[28:31], a[12:15], a[220:223], v[28:31]
ds_read_b128 a[56:59], v1 offset:22528
v_cvt_pk_bf16_f32 v63, v46, v47
v_mfma_f32_16x16x32_bf16 v[40:43], a[16:19], a[192:195], v[88:91]
ds_read_b128 a[60:63], v1 offset:23552
v_xor_b32 v1, 0x8000, v1
v_mfma_f32_16x16x32_bf16 v[40:43], a[20:23], a[196:199], v[40:43]
buffer_load_dwordx4 v3, s[48:51], s7 offen offset:3072 sc1 lds
v_mfma_f32_16x16x32_bf16 v[40:43], a[24:27], a[200:203], v[40:43]
s_add_u32 s7, s7, 0x8000
v_exp_f32 v24, v24
v_mfma_f32_16x16x32_bf16 v[40:43], a[28:31], a[204:207], v[40:43]
s_xor_b32 s27, s27, 0x38000
v_exp_f32 v25, v25
v_mfma_f32_16x16x32_bf16 v[44:47], a[16:19], a[208:211], v[92:95]
s_add_u32 s8, s28, 0x2000
v_exp_f32 v26, v26
v_mfma_f32_16x16x32_bf16 v[44:47], a[20:23], a[212:215], v[44:47]
v_exp_f32 v27, v27
v_mfma_f32_16x16x32_bf16 v[44:47], a[24:27], a[216:219], v[44:47]
s_waitcnt vmcnt(29) lgkmcnt(0)
v_exp_f32 v28, v28
v_mfma_f32_16x16x32_bf16 v[44:47], a[28:31], a[220:223], v[44:47]
s_barrier
v_exp_f32 v29, v29
v_mul_f32 v136, v6, v136
v_mul_f32 v137, v6, v137
v_mul_f32 v138, v6, v138
v_mul_f32 v139, v6, v139
v_mul_f32 v140, v6, v140
v_mul_f32 v141, v6, v141
v_mul_f32 v142, v6, v142
v_mul_f32 v143, v6, v143
v_cvt_pk_bf16_f32 v136, v136, v137
v_cvt_pk_bf16_f32 v137, v138, v139
v_cvt_pk_bf16_f32 v138, v140, v141
v_cvt_pk_bf16_f32 v139, v142, v143
buffer_store_dwordx4 v[136:139], v3, s[88:91], s8 offen sc1
s_add_u32 s8, s28, 0x4000
v_mul_f32 v144, v6, v144
v_mul_f32 v145, v6, v145
v_mul_f32 v146, v6, v146
v_mul_f32 v147, v6, v147
v_mul_f32 v148, v6, v148
v_mul_f32 v149, v6, v149
v_mul_f32 v150, v6, v150
v_mul_f32 v151, v6, v151
v_cvt_pk_bf16_f32 v144, v144, v145
v_cvt_pk_bf16_f32 v145, v146, v147
v_cvt_pk_bf16_f32 v146, v148, v149
v_cvt_pk_bf16_f32 v147, v150, v151
buffer_store_dwordx4 v[144:147], v3, s[88:91], s8 offen sc1
s_add_u32 s8, s28, 0x6000
v_mul_f32 v152, v6, v152
v_mul_f32 v153, v6, v153
v_mul_f32 v154, v6, v154
v_mul_f32 v155, v6, v155
v_mul_f32 v156, v6, v156
v_mul_f32 v157, v6, v157
v_mul_f32 v158, v6, v158
v_mul_f32 v159, v6, v159
v_cvt_pk_bf16_f32 v152, v152, v153
v_cvt_pk_bf16_f32 v153, v154, v155
v_cvt_pk_bf16_f32 v154, v156, v157
v_cvt_pk_bf16_f32 v155, v158, v159
buffer_store_dwordx4 v[152:155], v3, s[88:91], s8 offen sc1
v_accvgpr_read_b32 v6, a226
v_accvgpr_read_b32 v7, a227
v_add_f32 v6, v6, v7
v_cmp_nge_f32 vcc, 0x6f800000, v6
v_rcp_f32 v6, v6
s_or_b64 s[34:35], s[34:35], vcc
s_add_u32 s8, s29, 0x0
v_pk_mul_f32 v[160:161], v[160:161], v[6:7] op_sel_hi:[1,0]
v_pk_mul_f32 v[162:163], v[162:163], v[6:7] op_sel_hi:[1,0]
v_pk_mul_f32 v[164:165], v[164:165], v[6:7] op_sel_hi:[1,0]
v_pk_mul_f32 v[166:167], v[166:167], v[6:7] op_sel_hi:[1,0]
v_cvt_pk_bf16_f32 v160, v160, v161
v_cvt_pk_bf16_f32 v161, v162, v163
v_cvt_pk_bf16_f32 v162, v164, v165
v_cvt_pk_bf16_f32 v163, v166, v167
buffer_store_dwordx4 v[160:163], v3, s[88:91], s8 offen sc1
s_add_u32 s8, s29, 0x2000
v_pk_mul_f32 v[168:169], v[168:169], v[6:7] op_sel_hi:[1,0]
v_pk_mul_f32 v[170:171], v[170:171], v[6:7] op_sel_hi:[1,0]
v_pk_mul_f32 v[172:173], v[172:173], v[6:7] op_sel_hi:[1,0]
v_pk_mul_f32 v[174:175], v[174:175], v[6:7] op_sel_hi:[1,0]
v_cvt_pk_bf16_f32 v168, v168, v169
v_cvt_pk_bf16_f32 v169, v170, v171
v_cvt_pk_bf16_f32 v170, v172, v173
v_cvt_pk_bf16_f32 v171, v174, v175
buffer_store_dwordx4 v[168:171], v3, s[88:91], s8 offen sc1
s_add_u32 s8, s29, 0x4000
v_pk_mul_f32 v[176:177], v[176:177], v[6:7] op_sel_hi:[1,0]
v_pk_mul_f32 v[178:179], v[178:179], v[6:7] op_sel_hi:[1,0]
v_pk_mul_f32 v[180:181], v[180:181], v[6:7] op_sel_hi:[1,0]
v_pk_mul_f32 v[182:183], v[182:183], v[6:7] op_sel_hi:[1,0]
v_cvt_pk_bf16_f32 v176, v176, v177
v_cvt_pk_bf16_f32 v177, v178, v179
v_cvt_pk_bf16_f32 v178, v180, v181
v_cvt_pk_bf16_f32 v179, v182, v183
buffer_store_dwordx4 v[176:179], v3, s[88:91], s8 offen sc1
s_add_u32 s8, s29, 0x6000
v_pk_mul_f32 v[184:185], v[184:185], v[6:7] op_sel_hi:[1,0]
v_pk_mul_f32 v[186:187], v[186:187], v[6:7] op_sel_hi:[1,0]
v_pk_mul_f32 v[188:189], v[188:189], v[6:7] op_sel_hi:[1,0]
v_pk_mul_f32 v[190:191], v[190:191], v[6:7] op_sel_hi:[1,0]
v_cvt_pk_bf16_f32 v184, v184, v185
v_cvt_pk_bf16_f32 v185, v186, v187
v_cvt_pk_bf16_f32 v186, v188, v189
v_cvt_pk_bf16_f32 v187, v190, v191
buffer_store_dwordx4 v[184:187], v3, s[88:91], s8 offen sc1
s_getreg_b32 s8, hwreg(HW_REG_HW_ID, 5, 1)
s_cmp_lg_u32 s8, 0
s_cbranch_scc1 L_att_sodd1
s_branch L_att_sodd0
L_att_lh0_1:
v_mfma_f32_16x16x32_bf16 v[160:163], a[32:35], v[52:55], v[160:163]
ds_read_b128 a[0:3], v1 offset:8192
v_cvt_pk_bf16_f32 v72, v24, v25
v_mfma_f32_16x16x32_bf16 v[192:195], a[32:35], v[56:59], v[192:195]
v_exp_f32 v30, v30
v_mfma_f32_16x16x32_bf16 v[224:227], a[32:35], v[60:63], v[224:227]
ds_read_b128 a[4:7], v1 offset:9216
v_cvt_pk_bf16_f32 v73, v26, v27
v_mfma_f32_16x16x32_bf16 v[228:231], a[36:39], v[60:63], v[228:231]
v_cvt_pk_bf16_f32 v76, v28, v29
v_mfma_f32_16x16x32_bf16 v[196:199], a[36:39], v[56:59], v[196:199]
buffer_load_dword v14, v15, s[84:87], 0 offen offset:192 sc1
v_mfma_f32_16x16x32_bf16 v[164:167], a[36:39], v[52:55], v[164:167]
ds_read_b128 a[8:11], v1 offset:10240
v_mfma_f32_16x16x32_bf16 v[168:171], a[40:43], v[52:55], v[168:171]
ds_read_b128 a[12:15], v1 offset:11264
v_mfma_f32_16x16x32_bf16 v[200:203], a[40:43], v[56:59], v[200:203]
v_exp_f32 v31, v31
v_mfma_f32_16x16x32_bf16 v[232:235], a[40:43], v[60:63], v[232:235]
v_exp_f32 v40, v40
v_mfma_f32_16x16x32_bf16 v[236:239], a[44:47], v[60:63], v[236:239]
ds_read_b128 a[16:19], v1 offset:12288
v_cvt_pk_bf16_f32 v77, v30, v31
v_mfma_f32_16x16x32_bf16 v[204:207], a[44:47], v[56:59], v[204:207]
s_add_u32 m0, s17, 0x10000
v_exp_f32 v41, v41
v_mfma_f32_16x16x32_bf16 v[172:175], a[44:47], v[52:55], v[172:175]
ds_read_b128 a[20:23], v1 offset:13312
v_cvt_pk_bf16_f32 v74, v40, v41
v_mfma_f32_16x16x32_bf16 v[176:179], a[48:51], v[52:55], v[176:179]
buffer_load_dwordx4 v12, s[72:75], 0 offen lds
v_mfma_f32_16x16x32_bf16 v[208:211], a[48:51], v[56:59], v[208:211]
ds_read_b128 a[24:27], v1 offset:14336
v_mfma_f32_16x16x32_bf16 v[240:243], a[48:51], v[60:63], v[240:243]
v_mfma_f32_16x16x32_bf16 v[244:247], a[52:55], v[60:63], v[244:247]
v_exp_f32 v42, v42
v_mfma_f32_16x16x32_bf16 v[212:215], a[52:55], v[56:59], v[212:215]
ds_read_b128 a[28:31], v1 offset:15360
v_mfma_f32_16x16x32_bf16 v[180:183], a[52:55], v[52:55], v[180:183]
v_exp_f32 v43, v43
v_mfma_f32_16x16x32_bf16 v[184:187], a[56:59], v[52:55], v[184:187]
ds_read_b128 a[32:35], v1 offset:0
v_cvt_pk_bf16_f32 v75, v42, v43
v_mfma_f32_16x16x32_bf16 v[216:219], a[56:59], v[56:59], v[216:219]
v_exp_f32 v44, v44
v_mfma_f32_16x16x32_bf16 v[248:251], a[56:59], v[60:63], v[248:251]
buffer_load_dwordx4 v13, s[72:75], 0 offen offset:1024 lds
v_mfma_f32_16x16x32_bf16 v[252:255], a[60:63], v[60:63], v[252:255]
ds_read_b128 a[36:39], v1 offset:1024
v_mfma_f32_16x16x32_bf16 v[220:223], a[60:63], v[56:59], v[220:223]
v_mfma_f32_16x16x32_bf16 v[188:191], a[60:63], v[52:55], v[188:191]
ds_read_b128 a[40:43], v1 offset:2048
v_mfma_f32_16x16x32_bf16 a[224:227], a[236:239], v[52:55], a[224:227]
s_waitcnt lgkmcnt(7)
v_exp_f32 v45, v45
v_smfmac_f32_16x16x64_bf16 a[228:231], a[232:235], v[56:63], v9
ds_read_b128 a[44:47], v1 offset:3072
v_cvt_pk_bf16_f32 v78, v44, v45
v_mfma_f32_16x16x32_bf16 v[24:27], a[0:3], a[192:195], v[88:91]
v_exp_f32 v46, v46
v_mfma_f32_16x16x32_bf16 v[24:27], a[4:7], a[196:199], v[24:27]
ds_read_b128 a[48:51], v1 offset:4096
v_mfma_f32_16x16x32_bf16 v[24:27], a[8:11], a[200:203], v[24:27]
buffer_load_dwordx4 v12, s[72:75], s12 offen offset:2048 lds
v_mfma_f32_16x16x32_bf16 v[24:27], a[12:15], a[204:207], v[24:27]
v_exp_f32 v47, v47
v_mfma_f32_16x16x32_bf16 v[28:31], a[0:3], a[208:211], v[92:95]
ds_read_b128 a[52:55], v1 offset:5120
v_cvt_pk_bf16_f32 v79, v46, v47
v_mfma_f32_16x16x32_bf16 v[28:31], a[4:7], a[212:215], v[28:31]
v_mfma_f32_16x16x32_bf16 v[28:31], a[8:11], a[216:219], v[28:31]
ds_read_b128 a[56:59], v1 offset:6144
v_mfma_f32_16x16x32_bf16 v[28:31], a[12:15], a[220:223], v[28:31]
s_waitcnt lgkmcnt(7)
v_exp_f32 v24, v24
v_mfma_f32_16x16x32_bf16 v[40:43], a[16:19], a[192:195], v[88:91]
ds_read_b128 a[60:63], v1 offset:7168
v_mfma_f32_16x16x32_bf16 v[40:43], a[20:23], a[196:199], v[40:43]
v_exp_f32 v25, v25
v_mfma_f32_16x16x32_bf16 v[40:43], a[24:27], a[200:203], v[40:43]
buffer_load_dwordx4 v13, s[72:75], s12 offen offset:3072 lds
v_mfma_f32_16x16x32_bf16 v[40:43], a[28:31], a[204:207], v[40:43]
v_exp_f32 v26, v26
v_mfma_f32_16x16x32_bf16 v[44:47], a[16:19], a[208:211], v[92:95]
v_exp_f32 v27, v27
v_mfma_f32_16x16x32_bf16 v[44:47], a[20:23], a[212:215], v[44:47]
v_exp_f32 v28, v28
v_mfma_f32_16x16x32_bf16 v[44:47], a[24:27], a[216:219], v[44:47]
v_exp_f32 v29, v29
v_mfma_f32_16x16x32_bf16 v[44:47], a[28:31], a[220:223], v[44:47]
s_waitcnt lgkmcnt(0)
v_mfma_f32_16x16x32_bf16 v[192:195], a[32:35], v[72:75], v[192:195]
ds_read_b128 a[0:3], v1 offset:24576
v_cvt_pk_bf16_f32 v56, v24, v25
v_mfma_f32_16x16x32_bf16 v[224:227], a[32:35], v[76:79], v[224:227]
ds_read_b128 a[4:7], v1 offset:25600
v_add_u32 v12, 0x20000, v12
v_mfma_f32_16x16x32_bf16 v[228:231], a[36:39], v[76:79], v[228:231]
s_add_u32 m0, s17, 0x14000
v_exp_f32 v30, v30
v_mfma_f32_16x16x32_bf16 v[196:199], a[36:39], v[72:75], v[196:199]
buffer_load_dwordx4 v12, s[72:75], 0 offen lds
v_mfma_f32_16x16x32_bf16 v[200:203], a[40:43], v[72:75], v[200:203]
ds_read_b128 a[8:11], v1 offset:26624
v_cvt_pk_bf16_f32 v57, v26, v27
v_mfma_f32_16x16x32_bf16 v[232:235], a[40:43], v[76:79], v[232:235]
ds_read_b128 a[12:15], v1 offset:27648
v_cvt_pk_bf16_f32 v60, v28, v29
v_mfma_f32_16x16x32_bf16 v[236:239], a[44:47], v[76:79], v[236:239]
v_exp_f32 v31, v31
v_mfma_f32_16x16x32_bf16 v[204:207], a[44:47], v[72:75], v[204:207]
ds_read_b128 a[16:19], v1 offset:28672
v_cvt_pk_bf16_f32 v61, v30, v31
v_mfma_f32_16x16x32_bf16 v[208:211], a[48:51], v[72:75], v[208:211]
v_exp_f32 v40, v40
v_mfma_f32_16x16x32_bf16 v[240:243], a[48:51], v[76:79], v[240:243]
ds_read_b128 a[20:23], v1 offset:29696
v_mfma_f32_16x16x32_bf16 v[244:247], a[52:55], v[76:79], v[244:247]
ds_read_b128 a[24:27], v1 offset:30720
v_add_u32 v13, 0x20000, v13
v_mfma_f32_16x16x32_bf16 v[212:215], a[52:55], v[72:75], v[212:215]
buffer_load_dwordx4 v13, s[72:75], 0 offen offset:1024 lds
v_mfma_f32_16x16x32_bf16 v[216:219], a[56:59], v[72:75], v[216:219]
ds_read_b128 a[28:31], v1 offset:31744
v_mfma_f32_16x16x32_bf16 v[248:251], a[56:59], v[76:79], v[248:251]
v_exp_f32 v41, v41
v_mfma_f32_16x16x32_bf16 v[252:255], a[60:63], v[76:79], v[252:255]
ds_read_b128 a[32:35], v1 offset:16384
v_cvt_pk_bf16_f32 v58, v40, v41
v_mfma_f32_16x16x32_bf16 v[220:223], a[60:63], v[72:75], v[220:223]
s_waitcnt lgkmcnt(5)
v_exp_f32 v42, v42
v_smfmac_f32_16x16x64_bf16 a[228:231], a[232:235], v[72:79], v9
ds_read_b128 a[36:39], v1 offset:17408
v_exp_f32 v43, v43
v_mfma_f32_16x16x32_bf16 v[24:27], a[0:3], a[192:195], v[112:115]
v_exp_f32 v44, v44
v_mfma_f32_16x16x32_bf16 v[24:27], a[4:7], a[196:199], v[24:27]
buffer_load_dwordx4 v12, s[72:75], s12 offen offset:2048 lds
v_mfma_f32_16x16x32_bf16 v[24:27], a[8:11], a[200:203], v[24:27]
ds_read_b128 a[40:43], v1 offset:18432
v_cvt_pk_bf16_f32 v59, v42, v43
v_mfma_f32_16x16x32_bf16 v[24:27], a[12:15], a[204:207], v[24:27]
ds_read_b128 a[44:47], v1 offset:19456
v_exp_f32 v45, v45
v_mfma_f32_16x16x32_bf16 v[28:31], a[0:3], a[208:211], v[92:95]
ds_read_b128 a[48:51], v1 offset:20480
v_exp_f32 v46, v46
v_mfma_f32_16x16x32_bf16 v[28:31], a[4:7], a[212:215], v[28:31]
v_exp_f32 v47, v47
v_mfma_f32_16x16x32_bf16 v[28:31], a[8:11], a[216:219], v[28:31]
ds_read_b128 a[52:55], v1 offset:21504
v_cvt_pk_bf16_f32 v62, v44, v45
v_mfma_f32_16x16x32_bf16 v[28:31], a[12:15], a[220:223], v[28:31]
s_waitcnt lgkmcnt(6)
v_exp_f32 v24, v24
v_mfma_f32_16x16x32_bf16 v[40:43], a[16:19], a[192:195], v[116:119]
ds_read_b128 a[56:59], v1 offset:22528
v_cvt_pk_bf16_f32 v63, v46, v47
v_mfma_f32_16x16x32_bf16 v[40:43], a[20:23], a[196:199], v[40:43]
buffer_load_dwordx4 v13, s[72:75], s12 offen offset:3072 lds
v_mfma_f32_16x16x32_bf16 v[40:43], a[24:27], a[200:203], v[40:43]
ds_read_b128 a[60:63], v1 offset:23552
v_xor_b32 v1, 0x8000, v1
v_mfma_f32_16x16x32_bf16 v[40:43], a[28:31], a[204:207], v[40:43]
v_exp_f32 v25, v25
v_mfma_f32_16x16x32_bf16 v[44:47], a[16:19], a[208:211], v[92:95]
v_exp_f32 v26, v26
v_mfma_f32_16x16x32_bf16 v[44:47], a[20:23], a[212:215], v[44:47]
v_exp_f32 v27, v27
v_mfma_f32_16x16x32_bf16 v[44:47], a[24:27], a[216:219], v[44:47]
v_exp_f32 v28, v28
v_mfma_f32_16x16x32_bf16 v[44:47], a[28:31], a[220:223], v[44:47]
v_exp_f32 v29, v29
v_accvgpr_read_b32 v6, a224
v_accvgpr_read_b32 v7, a225
v_add_f32 v6, v6, v7
v_cmp_nge_f32 vcc, 0x6f800000, v6
v_rcp_f32 v6, v6
s_or_b64 s[34:35], s[34:35], vcc
s_add_u32 s8, s28, 0x0
v_pk_mul_f32 v[128:129], v[128:129], v[6:7] op_sel_hi:[1,0]
v_pk_mul_f32 v[130:131], v[130:131], v[6:7] op_sel_hi:[1,0]
v_pk_mul_f32 v[132:133], v[132:133], v[6:7] op_sel_hi:[1,0]
v_pk_mul_f32 v[134:135], v[134:135], v[6:7] op_sel_hi:[1,0]
v_cvt_pk_bf16_f32 v128, v128, v129
v_cvt_pk_bf16_f32 v129, v130, v131
v_cvt_pk_bf16_f32 v130, v132, v133
v_cvt_pk_bf16_f32 v131, v134, v135
buffer_store_dwordx4 v[128:131], v3, s[88:91], s8 offen sc1
s_add_u32 s8, s28, 0x2000
v_pk_mul_f32 v[136:137], v[136:137], v[6:7] op_sel_hi:[1,0]
v_pk_mul_f32 v[138:139], v[138:139], v[6:7] op_sel_hi:[1,0]
v_pk_mul_f32 v[140:141], v[140:141], v[6:7] op_sel_hi:[1,0]
v_pk_mul_f32 v[142:143], v[142:143], v[6:7] op_sel_hi:[1,0]
v_cvt_pk_bf16_f32 v136, v136, v137
v_cvt_pk_bf16_f32 v137, v138, v139
v_cvt_pk_bf16_f32 v138, v140, v141
v_cvt_pk_bf16_f32 v139, v142, v143
buffer_store_dwordx4 v[136:139], v3, s[88:91], s8 offen sc1
s_add_u32 s8, s28, 0x4000
v_pk_mul_f32 v[144:145], v[144:145], v[6:7] op_sel_hi:[1,0]
v_pk_mul_f32 v[146:147], v[146:147], v[6:7] op_sel_hi:[1,0]
v_pk_mul_f32 v[148:149], v[148:149], v[6:7] op_sel_hi:[1,0]
v_pk_mul_f32 v[150:151], v[150:151], v[6:7] op_sel_hi:[1,0]
v_cvt_pk_bf16_f32 v144, v144, v145
v_cvt_pk_bf16_f32 v145, v146, v147
v_cvt_pk_bf16_f32 v146, v148, v149
v_cvt_pk_bf16_f32 v147, v150, v151
buffer_store_dwordx4 v[144:147], v3, s[88:91], s8 offen sc1
s_add_u32 s8, s28, 0x6000
v_pk_mul_f32 v[152:153], v[152:153], v[6:7] op_sel_hi:[1,0]
v_pk_mul_f32 v[154:155], v[154:155], v[6:7] op_sel_hi:[1,0]
v_pk_mul_f32 v[156:157], v[156:157], v[6:7] op_sel_hi:[1,0]
v_pk_mul_f32 v[158:159], v[158:159], v[6:7] op_sel_hi:[1,0]
v_cvt_pk_bf16_f32 v152, v152, v153
v_cvt_pk_bf16_f32 v153, v154, v155
v_cvt_pk_bf16_f32 v154, v156, v157
v_cvt_pk_bf16_f32 v155, v158, v159
buffer_store_dwordx4 v[152:155], v3, s[88:91], s8 offen sc1
v_accvgpr_read_b32 v6, a226
v_accvgpr_read_b32 v7, a227
v_add_f32 v6, v6, v7
v_cmp_nge_f32 vcc, 0x6f800000, v6
v_rcp_f32 v6, v6
s_or_b64 s[34:35], s[34:35], vcc
s_add_u32 s8, s29, 0x0
v_pk_mul_f32 v[160:161], v[160:161], v[6:7] op_sel_hi:[1,0]
v_pk_mul_f32 v[162:163], v[162:163], v[6:7] op_sel_hi:[1,0]
v_pk_mul_f32 v[164:165], v[164:165], v[6:7] op_sel_hi:[1,0]
v_pk_mul_f32 v[166:167], v[166:167], v[6:7] op_sel_hi:[1,0]
v_cvt_pk_bf16_f32 v160, v160, v161
v_cvt_pk_bf16_f32 v161, v162, v163
v_cvt_pk_bf16_f32 v162, v164, v165
v_cvt_pk_bf16_f32 v163, v166, v167
buffer_store_dwordx4 v[160:163], v3, s[88:91], s8 offen sc1
s_add_u32 s8, s29, 0x2000
v_pk_mul_f32 v[168:169], v[168:169], v[6:7] op_sel_hi:[1,0]
v_pk_mul_f32 v[170:171], v[170:171], v[6:7] op_sel_hi:[1,0]
v_pk_mul_f32 v[172:173], v[172:173], v[6:7] op_sel_hi:[1,0]
v_pk_mul_f32 v[174:175], v[174:175], v[6:7] op_sel_hi:[1,0]
v_cvt_pk_bf16_f32 v168, v168, v169
v_cvt_pk_bf16_f32 v169, v170, v171
v_cvt_pk_bf16_f32 v170, v172, v173
v_cvt_pk_bf16_f32 v171, v174, v175
buffer_store_dwordx4 v[168:171], v3, s[88:91], s8 offen sc1
s_add_u32 s8, s29, 0x4000
v_pk_mul_f32 v[176:177], v[176:177], v[6:7] op_sel_hi:[1,0]
v_pk_mul_f32 v[178:179], v[178:179], v[6:7] op_sel_hi:[1,0]
v_pk_mul_f32 v[180:181], v[180:181], v[6:7] op_sel_hi:[1,0]
v_pk_mul_f32 v[182:183], v[182:183], v[6:7] op_sel_hi:[1,0]
v_cvt_pk_bf16_f32 v176, v176, v177
v_cvt_pk_bf16_f32 v177, v178, v179
v_cvt_pk_bf16_f32 v178, v180, v181
v_cvt_pk_bf16_f32 v179, v182, v183
buffer_store_dwordx4 v[176:179], v3, s[88:91], s8 offen sc1
s_add_u32 s8, s29, 0x6000
v_pk_mul_f32 v[184:185], v[184:185], v[6:7] op_sel_hi:[1,0]
v_pk_mul_f32 v[186:187], v[186:187], v[6:7] op_sel_hi:[1,0]
v_pk_mul_f32 v[188:189], v[188:189], v[6:7] op_sel_hi:[1,0]
v_pk_mul_f32 v[190:191], v[190:191], v[6:7] op_sel_hi:[1,0]
v_cvt_pk_bf16_f32 v184, v184, v185
v_cvt_pk_bf16_f32 v185, v186, v187
v_cvt_pk_bf16_f32 v186, v188, v189
v_cvt_pk_bf16_f32 v187, v190, v191
buffer_store_dwordx4 v[184:187], v3, s[88:91], s8 offen sc1
s_branch L_att_h1_1
L_att_j0:
s_cmp_ge_u32 s4, 2
s_cbranch_scc1 L_att_nl0_1
L_att_nl0_0:
v_mfma_f32_16x16x32_bf16 v[16:19], a[0:3], a[160:163], v[96:99]
ds_read_b128 a[128:131], v1 offset:24576
v_mov_b32 v240, 0
v_mfma_f32_16x16x32_bf16 v[16:19], a[4:7], a[164:167], v[16:19]
ds_read_b128 a[132:135], v1 offset:25600
v_mov_b32 v241, 0
v_mfma_f32_16x16x32_bf16 v[16:19], a[8:11], a[168:171], v[16:19]
ds_read_b128 a[136:139], v1 offset:26624
s_add_u32 m0, s27, 0x0
v_mfma_f32_16x16x32_bf16 v[16:19], a[12:15], a[172:175], v[16:19]
buffer_load_dwordx4 v3, s[48:51], s32 offen offset:0 sc1 lds
v_mfma_f32_16x16x32_bf16 v[20:23], a[0:3], a[176:179], v[84:87]
ds_read_b128 a[140:143], v1 offset:27648
v_mov_b32 v242, 0
v_mfma_f32_16x16x32_bf16 v[20:23], a[4:7], a[180:183], v[20:23]
ds_read_b128 a[144:147], v1 offset:28672
v_mov_b32 v243, 0
v_mfma_f32_16x16x32_bf16 v[20:23], a[8:11], a[184:187], v[20:23]
ds_read_b128 a[148:151], v1 offset:29696
v_mov_b32 v244, 0
v_mfma_f32_16x16x32_bf16 v[20:23], a[12:15], a[188:191], v[20:23]
ds_read_b128 a[152:155], v1 offset:30720
v_mov_b32 v245, 0
v_mfma_f32_16x16x32_bf16 v[24:27], a[0:3], a[192:195], v[88:91]
ds_read_b128 a[156:159], v1 offset:31744
v_mov_b32 v246, 0
v_mfma_f32_16x16x32_bf16 v[24:27], a[4:7], a[196:199], v[24:27]
buffer_load_dwordx4 v3, s[48:51], s32 offen offset:1024 sc1 lds
v_mfma_f32_16x16x32_bf16 v[24:27], a[8:11], a[200:203], v[24:27]
v_exp_f32 v16, v16
v_mfma_f32_16x16x32_bf16 v[24:27], a[12:15], a[204:207], v[24:27]
v_exp_f32 v17, v17
v_mfma_f32_16x16x32_bf16 v[28:31], a[0:3], a[208:211], v[92:95]
v_exp_f32 v18, v18
v_mfma_f32_16x16x32_bf16 v[28:31], a[4:7], a[212:215], v[28:31]
v_exp_f32 v19, v19
v_mfma_f32_16x16x32_bf16 v[28:31], a[8:11], a[216:219], v[28:31]
v_exp_f32 v20, v20
v_mfma_f32_16x16x32_bf16 v[28:31], a[12:15], a[220:223], v[28:31]
buffer_load_dwordx4 v3, s[48:51], s32 offen offset:2048 sc1 lds
v_mfma_f32_16x16x32_bf16 v[32:35], a[16:19], a[160:163], v[100:103]
v_exp_f32 v21, v21
v_mfma_f32_16x16x32_bf16 v[32:35], a[20:23], a[164:167], v[32:35]
v_exp_f32 v22, v22
v_mfma_f32_16x16x32_bf16 v[32:35], a[24:27], a[168:171], v[32:35]
v_exp_f32 v23, v23
v_mfma_f32_16x16x32_bf16 v[32:35], a[28:31], a[172:175], v[32:35]
v_exp_f32 v24, v24
v_mfma_f32_16x16x32_bf16 v[36:39], a[16:19], a[176:179], v[84:87]
v_exp_f32 v25, v25
v_mfma_f32_16x16x32_bf16 v[36:39], a[20:23], a[180:183], v[36:39]
buffer_load_dwordx4 v3, s[48:51], s32 offen offset:3072 sc1 lds
v_mfma_f32_16x16x32_bf16 v[36:39], a[24:27], a[184:187], v[36:39]
v_exp_f32 v26, v26
v_mfma_f32_16x16x32_bf16 v[36:39], a[28:31], a[188:191], v[36:39]
v_exp_f32 v27, v27
v_mfma_f32_16x16x32_bf16 v[40:43], a[16:19], a[192:195], v[88:91]
v_exp_f32 v28, v28
v_mfma_f32_16x16x32_bf16 v[40:43], a[20:23], a[196:199], v[40:43]
v_exp_f32 v29, v29
v_mfma_f32_16x16x32_bf16 v[40:43], a[24:27], a[200:203], v[40:43]
s_add_u32 m0, s27, 0x1000
v_exp_f32 v30, v30
v_mfma_f32_16x16x32_bf16 v[40:43], a[28:31], a[204:207], v[40:43]
buffer_load_dwordx4 v3, s[48:51], s7 offen offset:0 sc1 lds
v_mfma_f32_16x16x32_bf16 v[44:47], a[16:19], a[208:211], v[92:95]
v_exp_f32 v31, v31
v_mfma_f32_16x16x32_bf16 v[44:47], a[20:23], a[212:215], v[44:47]
v_exp_f32 v32, v32
v_mfma_f32_16x16x32_bf16 v[44:47], a[24:27], a[216:219], v[44:47]
v_exp_f32 v33, v33
v_mfma_f32_16x16x32_bf16 v[44:47], a[28:31], a[220:223], v[44:47]
s_waitcnt lgkmcnt(0)
v_cvt_pk_bf16_f32 v48, v16, v17
v_cvt_pk_bf16_f32 v49, v18, v19
v_cvt_pk_bf16_f32 v52, v20, v21
v_cvt_pk_bf16_f32 v53, v22, v23
v_cvt_pk_bf16_f32 v56, v24, v25
v_cvt_pk_bf16_f32 v57, v26, v27
v_mov_b32 v247, 0
v_mfma_f32_16x16x32_bf16 v[20:23], a[128:131], a[176:179], v[84:87]
ds_read_b128 a[32:35], v1 offset:16384
v_cvt_pk_bf16_f32 v60, v28, v29
v_mfma_f32_16x16x32_bf16 v[20:23], a[132:135], a[180:183], v[20:23]
v_exp_f32 v34, v34
v_mfma_f32_16x16x32_bf16 v[20:23], a[136:139], a[184:187], v[20:23]
buffer_load_dwordx4 v3, s[48:51], s7 offen offset:1024 sc1 lds
v_mfma_f32_16x16x32_bf16 v[20:23], a[140:143], a[188:191], v[20:23]
ds_read_b128 a[36:39], v1 offset:17408
v_cvt_pk_bf16_f32 v61, v30, v31
v_mfma_f32_16x16x32_bf16 v[24:27], a[128:131], a[192:195], v[88:91]
ds_read_b128 a[40:43], v1 offset:18432
v_cvt_pk_bf16_f32 v50, v32, v33
v_mfma_f32_16x16x32_bf16 v[24:27], a[132:135], a[196:199], v[24:27]
v_exp_f32 v35, v35
v_mfma_f32_16x16x32_bf16 v[24:27], a[136:139], a[200:203], v[24:27]
buffer_load_dwordx4 v3, s[48:51], s7 offen offset:2048 sc1 lds
v_mfma_f32_16x16x32_bf16 v[24:27], a[140:143], a[204:207], v[24:27]
ds_read_b128 a[44:47], v1 offset:19456
v_cvt_pk_bf16_f32 v51, v34, v35
v_mfma_f32_16x16x32_bf16 v[28:31], a[128:131], a[208:211], v[92:95]
v_exp_f32 v36, v36
v_mfma_f32_16x16x32_bf16 v[28:31], a[132:135], a[212:215], v[28:31]
ds_read_b128 a[48:51], v1 offset:20480
v_exp_f32 v37, v37
v_mfma_f32_16x16x32_bf16 v[28:31], a[136:139], a[216:219], v[28:31]
v_exp_f32 v38, v38
v_mfma_f32_16x16x32_bf16 v[28:31], a[140:143], a[220:223], v[28:31]
buffer_load_dwordx4 v3, s[48:51], s7 offen offset:3072 sc1 lds
v_exp_f32 v39, v39
v_cvt_pk_bf16_f32 v54, v36, v37
v_cvt_pk_bf16_f32 v55, v38, v39
v_mfma_f32_16x16x32_bf16 v[36:39], a[144:147], a[176:179], v[84:87]
ds_read_b128 a[52:55], v1 offset:21504
v_exp_f32 v40, v40
v_mfma_f32_16x16x32_bf16 v[36:39], a[148:151], a[180:183], v[36:39]
ds_read_b128 a[56:59], v1 offset:22528
v_exp_f32 v41, v41
v_mfma_f32_16x16x32_bf16 v[36:39], a[152:155], a[184:187], v[36:39]
s_mov_b32 s9, 0x0
v_exp_f32 v42, v42
v_mfma_f32_16x16x32_bf16 v[36:39], a[156:159], a[188:191], v[36:39]
buffer_load_dword a244, v8, s[72:75], s9 offen
v_exp_f32 v43, v43
v_cvt_pk_bf16_f32 v58, v40, v41
v_cvt_pk_bf16_f32 v59, v42, v43
v_mfma_f32_16x16x32_bf16 v[40:43], a[144:147], a[192:195], v[88:91]
ds_read_b128 a[60:63], v1 offset:23552
v_xor_b32 v1, 0x8000, v1
v_mfma_f32_16x16x32_bf16 v[40:43], a[148:151], a[196:199], v[40:43]
s_add_u32 s32, s32, 0x8000
v_exp_f32 v44, v44
v_mfma_f32_16x16x32_bf16 v[40:43], a[152:155], a[200:203], v[40:43]
s_add_u32 s7, s7, 0x8000
v_exp_f32 v45, v45
v_mfma_f32_16x16x32_bf16 v[40:43], a[156:159], a[204:207], v[40:43]
s_xor_b32 s27, s27, 0x38000
v_exp_f32 v46, v46
v_exp_f32 v47, v47
v_cvt_pk_bf16_f32 v62, v44, v45
v_cvt_pk_bf16_f32 v63, v46, v47
v_mfma_f32_16x16x32_bf16 v[44:47], a[144:147], a[208:211], v[92:95]
v_exp_f32 v20, v20
v_mfma_f32_16x16x32_bf16 v[44:47], a[148:151], a[212:215], v[44:47]
v_exp_f32 v21, v21
v_mfma_f32_16x16x32_bf16 v[44:47], a[152:155], a[216:219], v[44:47]
s_waitcnt vmcnt(9) lgkmcnt(0)
v_exp_f32 v22, v22
v_mfma_f32_16x16x32_bf16 v[44:47], a[156:159], a[220:223], v[44:47]
s_barrier
v_cvt_pk_bf16_f32 v68, v20, v21
v_exp_f32 v23, v23
v_exp_f32 v24, v24
v_exp_f32 v25, v25
v_exp_f32 v26, v26
v_exp_f32 v27, v27
v_cvt_pk_bf16_f32 v69, v22, v23
s_cmp_lg_u32 s33, 0
s_cbranch_scc1 L_sig_bn0
s_lshl_b32 s8, s6, 2
s_add_u32 s8, s8, 192
s_cmp_lg_u32 s4, 0
s_cbranch_scc1 L_sig_bn0
v_mov_b32 v4, 1
s_mov_b64 exec, 1
buffer_atomic_add v4, off, s[84:87], s8 sc1
s_mov_b64 exec, -1
L_sig_bn0:
s_branch L_att_l1_0
L_att_nl0_1:
v_mfma_f32_16x16x32_bf16 v[16:19], a[0:3], a[160:163], v[80:83]
ds_read_b128 a[128:131], v1 offset:24576
v_mov_b32 v240, 0
v_mfma_f32_16x16x32_bf16 v[16:19], a[4:7], a[164:167], v[16:19]
ds_read_b128 a[132:135], v1 offset:25600
v_mov_b32 v241, 0
v_mfma_f32_16x16x32_bf16 v[16:19], a[8:11], a[168:171], v[16:19]
ds_read_b128 a[136:139], v1 offset:26624
s_add_u32 m0, s27, 0x0
v_mfma_f32_16x16x32_bf16 v[16:19], a[12:15], a[172:175], v[16:19]
buffer_load_dwordx4 v3, s[48:51], s32 offen offset:0 sc1 lds
v_mfma_f32_16x16x32_bf16 v[20:23], a[0:3], a[176:179], v[84:87]
ds_read_b128 a[140:143], v1 offset:27648
v_mov_b32 v242, 0
v_mfma_f32_16x16x32_bf16 v[20:23], a[4:7], a[180:183], v[20:23]
ds_read_b128 a[144:147], v1 offset:28672
v_mov_b32 v243, 0
v_mfma_f32_16x16x32_bf16 v[20:23], a[8:11], a[184:187], v[20:23]
ds_read_b128 a[148:151], v1 offset:29696
v_mov_b32 v244, 0
v_mfma_f32_16x16x32_bf16 v[20:23], a[12:15], a[188:191], v[20:23]
ds_read_b128 a[152:155], v1 offset:30720
v_mov_b32 v245, 0
v_mfma_f32_16x16x32_bf16 v[24:27], a[0:3], a[192:195], v[88:91]
ds_read_b128 a[156:159], v1 offset:31744
v_mov_b32 v246, 0
v_mfma_f32_16x16x32_bf16 v[24:27], a[4:7], a[196:199], v[24:27]
buffer_load_dwordx4 v3, s[48:51], s32 offen offset:1024 sc1 lds
v_mfma_f32_16x16x32_bf16 v[24:27], a[8:11], a[200:203], v[24:27]
v_exp_f32 v16, v16
v_mfma_f32_16x16x32_bf16 v[24:27], a[12:15], a[204:207], v[24:27]
v_exp_f32 v17, v17
v_mfma_f32_16x16x32_bf16 v[28:31], a[0:3], a[208:211], v[92:95]
v_exp_f32 v18, v18
v_mfma_f32_16x16x32_bf16 v[28:31], a[4:7], a[212:215], v[28:31]
v_exp_f32 v19, v19
v_mfma_f32_16x16x32_bf16 v[28:31], a[8:11], a[216:219], v[28:31]
v_exp_f32 v20, v20
v_mfma_f32_16x16x32_bf16 v[28:31], a[12:15], a[220:223], v[28:31]
buffer_load_dwordx4 v3, s[48:51], s32 offen offset:2048 sc1 lds
v_mfma_f32_16x16x32_bf16 v[32:35], a[16:19], a[160:163], v[80:83]
v_exp_f32 v21, v21
v_mfma_f32_16x16x32_bf16 v[32:35], a[20:23], a[164:167], v[32:35]
v_exp_f32 v22, v22
v_mfma_f32_16x16x32_bf16 v[32:35], a[24:27], a[168:171], v[32:35]
v_exp_f32 v23, v23
v_mfma_f32_16x16x32_bf16 v[32:35], a[28:31], a[172:175], v[32:35]
v_exp_f32 v24, v24
v_mfma_f32_16x16x32_bf16 v[36:39], a[16:19], a[176:179], v[84:87]
v_exp_f32 v25, v25
v_mfma_f32_16x16x32_bf16 v[36:39], a[20:23], a[180:183], v[36:39]
buffer_load_dwordx4 v3, s[48:51], s32 offen offset:3072 sc1 lds
v_mfma_f32_16x16x32_bf16 v[36:39], a[24:27], a[184:187], v[36:39]
v_exp_f32 v26, v26
v_mfma_f32_16x16x32_bf16 v[36:39], a[28:31], a[188:191], v[36:39]
v_exp_f32 v27, v27
v_mfma_f32_16x16x32_bf16 v[40:43], a[16:19], a[192:195], v[88:91]
v_exp_f32 v28, v28
v_mfma_f32_16x16x32_bf16 v[40:43], a[20:23], a[196:199], v[40:43]
v_exp_f32 v29, v29
v_mfma_f32_16x16x32_bf16 v[40:43], a[24:27], a[200:203], v[40:43]
s_add_u32 m0, s27, 0x1000
v_exp_f32 v30, v30
v_mfma_f32_16x16x32_bf16 v[40:43], a[28:31], a[204:207], v[40:43]
buffer_load_dwordx4 v3, s[48:51], s7 offen offset:0 sc1 lds
v_mfma_f32_16x16x32_bf16 v[44:47], a[16:19], a[208:211], v[92:95]
v_exp_f32 v31, v31
v_mfma_f32_16x16x32_bf16 v[44:47], a[20:23], a[212:215], v[44:47]
v_exp_f32 v32, v32
v_mfma_f32_16x16x32_bf16 v[44:47], a[24:27], a[216:219], v[44:47]
v_exp_f32 v33, v33
v_mfma_f32_16x16x32_bf16 v[44:47], a[28:31], a[220:223], v[44:47]
s_waitcnt lgkmcnt(0)
v_cvt_pk_bf16_f32 v48, v16, v17
v_cvt_pk_bf16_f32 v49, v18, v19
v_cvt_pk_bf16_f32 v52, v20, v21
v_cvt_pk_bf16_f32 v53, v22, v23
v_cvt_pk_bf16_f32 v56, v24, v25
v_cvt_pk_bf16_f32 v57, v26, v27
v_mov_b32 v247, 0
v_mfma_f32_16x16x32_bf16 v[16:19], a[128:131], a[160:163], v[96:99]
ds_read_b128 a[32:35], v1 offset:16384
v_cvt_pk_bf16_f32 v60, v28, v29
v_mfma_f32_16x16x32_bf16 v[16:19], a[132:135], a[164:167], v[16:19]
v_exp_f32 v34, v34
v_mfma_f32_16x16x32_bf16 v[16:19], a[136:139], a[168:171], v[16:19]
v_exp_f32 v35, v35
v_mfma_f32_16x16x32_bf16 v[16:19], a[140:143], a[172:175], v[16:19]
buffer_load_dwordx4 v3, s[48:51], s7 offen offset:1024 sc1 lds
v_mfma_f32_16x16x32_bf16 v[20:23], a[128:131], a[176:179], v[84:87]
ds_read_b128 a[36:39], v1 offset:17408
v_cvt_pk_bf16_f32 v61, v30, v31
v_mfma_f32_16x16x32_bf16 v[20:23], a[132:135], a[180:183], v[20:23]
v_exp_f32 v36, v36
v_mfma_f32_16x16x32_bf16 v[20:23], a[136:139], a[184:187], v[20:23]
ds_read_b128 a[40:43], v1 offset:18432
v_cvt_pk_bf16_f32 v50, v32, v33
v_mfma_f32_16x16x32_bf16 v[20:23], a[140:143], a[188:191], v[20:23]
v_exp_f32 v37, v37
v_mfma_f32_16x16x32_bf16 v[24:27], a[128:131], a[192:195], v[88:91]
v_exp_f32 v38, v38
v_mfma_f32_16x16x32_bf16 v[24:27], a[132:135], a[196:199], v[24:27]
buffer_load_dwordx4 v3, s[48:51], s7 offen offset:2048 sc1 lds
v_mfma_f32_16x16x32_bf16 v[24:27], a[136:139], a[200:203], v[24:27]
ds_read_b128 a[44:47], v1 offset:19456
v_cvt_pk_bf16_f32 v51, v34, v35
v_mfma_f32_16x16x32_bf16 v[24:27], a[140:143], a[204:207], v[24:27]
v_exp_f32 v39, v39
v_mfma_f32_16x16x32_bf16 v[28:31], a[128:131], a[208:211], v[92:95]
v_exp_f32 v40, v40
v_mfma_f32_16x16x32_bf16 v[28:31], a[132:135], a[212:215], v[28:31]
ds_read_b128 a[48:51], v1 offset:20480
v_cvt_pk_bf16_f32 v54, v36, v37
v_mfma_f32_16x16x32_bf16 v[28:31], a[136:139], a[216:219], v[28:31]
v_exp_f32 v41, v41
v_mfma_f32_16x16x32_bf16 v[28:31], a[140:143], a[220:223], v[28:31]
v_exp_f32 v42, v42
v_mfma_f32_16x16x32_bf16 v[32:35], a[144:147], a[160:163], v[100:103]
buffer_load_dwordx4 v3, s[48:51], s7 offen offset:3072 sc1 lds
v_mfma_f32_16x16x32_bf16 v[32:35], a[148:151], a[164:167], v[32:35]
ds_read_b128 a[52:55], v1 offset:21504
v_cvt_pk_bf16_f32 v55, v38, v39
v_mfma_f32_16x16x32_bf16 v[32:35], a[152:155], a[168:171], v[32:35]
v_exp_f32 v43, v43
v_mfma_f32_16x16x32_bf16 v[32:35], a[156:159], a[172:175], v[32:35]
ds_read_b128 a[56:59], v1 offset:22528
v_cvt_pk_bf16_f32 v58, v40, v41
v_mfma_f32_16x16x32_bf16 v[36:39], a[144:147], a[176:179], v[84:87]
v_exp_f32 v44, v44
v_mfma_f32_16x16x32_bf16 v[36:39], a[148:151], a[180:183], v[36:39]
s_mov_b32 s9, 0x0
v_exp_f32 v45, v45
v_mfma_f32_16x16x32_bf16 v[36:39], a[152:155], a[184:187], v[36:39]
buffer_load_dword a244, v8, s[72:75], s9 offen
v_mfma_f32_16x16x32_bf16 v[36:39], a[156:159], a[188:191], v[36:39]
ds_read_b128 a[60:63], v1 offset:23552
v_xor_b32 v1, 0x8000, v1
v_cvt_pk_bf16_f32 v59, v42, v43
v_mfma_f32_16x16x32_bf16 v[40:43], a[144:147], a[192:195], v[88:91]
s_add_u32 s32, s32, 0x8000
v_exp_f32 v46, v46
v_mfma_f32_16x16x32_bf16 v[40:43], a[148:151], a[196:199], v[40:43]
s_add_u32 s7, s7, 0x8000
v_exp_f32 v47, v47
v_mfma_f32_16x16x32_bf16 v[40:43], a[152:155], a[200:203], v[40:43]
s_xor_b32 s27, s27, 0x38000
v_exp_f32 v16, v16
v_mfma_f32_16x16x32_bf16 v[40:43], a[156:159], a[204:207], v[40:43]
v_exp_f32 v17, v17
v_cvt_pk_bf16_f32 v62, v44, v45
v_cvt_pk_bf16_f32 v63, v46, v47
v_mfma_f32_16x16x32_bf16 v[44:47], a[144:147], a[208:211], v[92:95]
v_exp_f32 v18, v18
v_mfma_f32_16x16x32_bf16 v[44:47], a[148:151], a[212:215], v[44:47]
v_exp_f32 v19, v19
v_mfma_f32_16x16x32_bf16 v[44:47], a[152:155], a[216:219], v[44:47]
s_waitcnt vmcnt(9) lgkmcnt(0)
v_exp_f32 v20, v20
v_mfma_f32_16x16x32_bf16 v[44:47], a[156:159], a[220:223], v[44:47]
s_barrier
v_cvt_pk_bf16_f32 v64, v16, v17
v_exp_f32 v21, v21
v_exp_f32 v22, v22
v_exp_f32 v23, v23
v_exp_f32 v24, v24
v_exp_f32 v25, v25
v_exp_f32 v26, v26
v_exp_f32 v27, v27
v_cvt_pk_bf16_f32 v65, v18, v19
v_cvt_pk_bf16_f32 v68, v20, v21
v_cvt_pk_bf16_f32 v69, v22, v23
s_cmp_lg_u32 s33, 0
s_cbranch_scc1 L_sig_bn1
s_lshl_b32 s8, s6, 2
s_add_u32 s8, s8, 192
s_cmp_lg_u32 s4, 0
s_cbranch_scc1 L_sig_bn1
v_mov_b32 v4, 1
s_mov_b64 exec, 1
buffer_atomic_add v4, off, s[84:87], s8 sc1
s_mov_b64 exec, -1
L_sig_bn1:
s_branch L_att_l1_1
L_att_seven0:
v_mfma_f32_16x16x32_bf16 v[192:195], a[32:35], v[56:59], v[192:195]
v_exp_f32 v30, v30
v_mfma_f32_16x16x32_bf16 v[224:227], a[32:35], v[60:63], v[224:227]
ds_read_b128 a[0:3], v1 offset:8192
v_cvt_pk_bf16_f32 v72, v24, v25
v_mfma_f32_16x16x32_bf16 v[228:231], a[36:39], v[60:63], v[228:231]
ds_read_b128 a[4:7], v1 offset:9216
v_cvt_pk_bf16_f32 v73, v26, v27
v_mfma_f32_16x16x32_bf16 v[196:199], a[36:39], v[56:59], v[196:199]
s_add_u32 m0, s27, 0x0
v_exp_f32 v31, v31
v_mfma_f32_16x16x32_bf16 v[200:203], a[40:43], v[56:59], v[200:203]
ds_read_b128 a[8:11], v1 offset:10240
v_cvt_pk_bf16_f32 v76, v28, v29
v_mfma_f32_16x16x32_bf16 v[232:235], a[40:43], v[60:63], v[232:235]
buffer_load_dwordx4 v3, s[48:51], s32 offen offset:0 sc1 lds
v_mfma_f32_16x16x32_bf16 v[236:239], a[44:47], v[60:63], v[236:239]
v_exp_f32 v40, v40
v_mfma_f32_16x16x32_bf16 v[204:207], a[44:47], v[56:59], v[204:207]
ds_read_b128 a[12:15], v1 offset:11264
v_cvt_pk_bf16_f32 v77, v30, v31
v_mfma_f32_16x16x32_bf16 v[208:211], a[48:51], v[56:59], v[208:211]
ds_read_b128 a[16:19], v1 offset:12288
v_mfma_f32_16x16x32_bf16 v[240:243], a[48:51], v[60:63], v[240:243]
buffer_load_dwordx4 v3, s[48:51], s32 offen offset:1024 sc1 lds
v_mfma_f32_16x16x32_bf16 v[244:247], a[52:55], v[60:63], v[244:247]
ds_read_b128 a[20:23], v1 offset:13312
v_mfma_f32_16x16x32_bf16 v[212:215], a[52:55], v[56:59], v[212:215]
ds_read_b128 a[24:27], v1 offset:14336
v_mfma_f32_16x16x32_bf16 v[216:219], a[56:59], v[56:59], v[216:219]
ds_read_b128 a[28:31], v1 offset:15360
v_mfma_f32_16x16x32_bf16 v[248:251], a[56:59], v[60:63], v[248:251]
ds_read_b128 a[32:35], v1 offset:0
v_exp_f32 v41, v41
v_mfma_f32_16x16x32_bf16 v[252:255], a[60:63], v[60:63], v[252:255]
v_exp_f32 v42, v42
v_mfma_f32_16x16x32_bf16 v[220:223], a[60:63], v[56:59], v[220:223]
s_waitcnt lgkmcnt(5)
v_exp_f32 v43, v43
v_smfmac_f32_16x16x64_bf16 a[228:231], a[232:235], v[56:63], v9
ds_read_b128 a[36:39], v1 offset:1024
v_cvt_pk_bf16_f32 v74, v40, v41
v_mfma_f32_16x16x32_bf16 v[24:27], a[0:3], a[192:195], v[88:91]
ds_read_b128 a[40:43], v1 offset:2048
v_exp_f32 v44, v44
v_mfma_f32_16x16x32_bf16 v[24:27], a[4:7], a[196:199], v[24:27]
buffer_load_dwordx4 v3, s[48:51], s32 offen offset:2048 sc1 lds
v_mfma_f32_16x16x32_bf16 v[24:27], a[8:11], a[200:203], v[24:27]
v_exp_f32 v45, v45
v_mfma_f32_16x16x32_bf16 v[24:27], a[12:15], a[204:207], v[24:27]
ds_read_b128 a[44:47], v1 offset:3072
v_cvt_pk_bf16_f32 v75, v42, v43
v_mfma_f32_16x16x32_bf16 v[28:31], a[0:3], a[208:211], v[92:95]
ds_read_b128 a[48:51], v1 offset:4096
v_exp_f32 v46, v46
v_mfma_f32_16x16x32_bf16 v[28:31], a[4:7], a[212:215], v[28:31]
s_waitcnt lgkmcnt(5)
v_exp_f32 v47, v47
v_mfma_f32_16x16x32_bf16 v[28:31], a[8:11], a[216:219], v[28:31]
ds_read_b128 a[52:55], v1 offset:5120
v_cvt_pk_bf16_f32 v78, v44, v45
v_mfma_f32_16x16x32_bf16 v[28:31], a[12:15], a[220:223], v[28:31]
buffer_load_dwordx4 v3, s[48:51], s32 offen offset:3072 sc1 lds
v_mfma_f32_16x16x32_bf16 v[40:43], a[16:19], a[192:195], v[88:91]
ds_read_b128 a[56:59], v1 offset:6144
s_add_u32 s32, s32, 0x8000
v_mfma_f32_16x16x32_bf16 v[40:43], a[20:23], a[196:199], v[40:43]
ds_read_b128 a[60:63], v1 offset:7168
v_cvt_pk_bf16_f32 v79, v46, v47
v_mfma_f32_16x16x32_bf16 v[40:43], a[24:27], a[200:203], v[40:43]
v_exp_f32 v24, v24
v_mfma_f32_16x16x32_bf16 v[40:43], a[28:31], a[204:207], v[40:43]
v_exp_f32 v25, v25
v_mfma_f32_16x16x32_bf16 v[44:47], a[16:19], a[208:211], v[92:95]
v_exp_f32 v26, v26
v_mfma_f32_16x16x32_bf16 v[44:47], a[20:23], a[212:215], v[44:47]
v_exp_f32 v27, v27
v_mfma_f32_16x16x32_bf16 v[44:47], a[24:27], a[216:219], v[44:47]
v_exp_f32 v28, v28
v_mfma_f32_16x16x32_bf16 v[44:47], a[28:31], a[220:223], v[44:47]
s_waitcnt lgkmcnt(0)
v_exp_f32 v29, v29
v_mfma_f32_16x16x32_bf16 v[192:195], a[32:35], v[72:75], v[192:195]
s_add_u32 m0, s27, 0x1000
v_exp_f32 v30, v30
v_mfma_f32_16x16x32_bf16 v[224:227], a[32:35], v[76:79], v[224:227]
buffer_load_dwordx4 v3, s[48:51], s7 offen offset:0 sc1 lds
v_mfma_f32_16x16x32_bf16 v[228:231], a[36:39], v[76:79], v[228:231]
v_exp_f32 v31, v31
v_mfma_f32_16x16x32_bf16 v[196:199], a[36:39], v[72:75], v[196:199]
ds_read_b128 a[0:3], v1 offset:24576
v_cvt_pk_bf16_f32 v56, v24, v25
v_mfma_f32_16x16x32_bf16 v[200:203], a[40:43], v[72:75], v[200:203]
ds_read_b128 a[4:7], v1 offset:25600
v_cvt_pk_bf16_f32 v57, v26, v27
v_mfma_f32_16x16x32_bf16 v[232:235], a[40:43], v[76:79], v[232:235]
v_exp_f32 v40, v40
v_mfma_f32_16x16x32_bf16 v[236:239], a[44:47], v[76:79], v[236:239]
ds_read_b128 a[8:11], v1 offset:26624
v_cvt_pk_bf16_f32 v60, v28, v29
v_mfma_f32_16x16x32_bf16 v[204:207], a[44:47], v[72:75], v[204:207]
v_exp_f32 v41, v41
v_mfma_f32_16x16x32_bf16 v[208:211], a[48:51], v[72:75], v[208:211]
ds_read_b128 a[12:15], v1 offset:27648
v_cvt_pk_bf16_f32 v61, v30, v31
v_mfma_f32_16x16x32_bf16 v[240:243], a[48:51], v[76:79], v[240:243]
ds_read_b128 a[16:19], v1 offset:28672
v_cvt_pk_bf16_f32 v58, v40, v41
v_mfma_f32_16x16x32_bf16 v[244:247], a[52:55], v[76:79], v[244:247]
v_exp_f32 v42, v42
v_mfma_f32_16x16x32_bf16 v[212:215], a[52:55], v[72:75], v[212:215]
buffer_load_dwordx4 v3, s[48:51], s7 offen offset:1024 sc1 lds
v_mfma_f32_16x16x32_bf16 v[216:219], a[56:59], v[72:75], v[216:219]
ds_read_b128 a[20:23], v1 offset:29696
v_mfma_f32_16x16x32_bf16 v[248:251], a[56:59], v[76:79], v[248:251]
ds_read_b128 a[24:27], v1 offset:30720
v_mfma_f32_16x16x32_bf16 v[252:255], a[60:63], v[76:79], v[252:255]
ds_read_b128 a[28:31], v1 offset:31744
v_mfma_f32_16x16x32_bf16 v[220:223], a[60:63], v[72:75], v[220:223]
s_waitcnt lgkmcnt(4)
v_exp_f32 v43, v43
v_smfmac_f32_16x16x64_bf16 a[228:231], a[232:235], v[72:79], v9
ds_read_b128 a[32:35], v1 offset:16384
v_cvt_pk_bf16_f32 v59, v42, v43
v_mfma_f32_16x16x32_bf16 v[24:27], a[0:3], a[192:195], v[88:91]
ds_read_b128 a[36:39], v1 offset:17408
v_mfma_f32_16x16x32_bf16 v[24:27], a[4:7], a[196:199], v[24:27]
buffer_load_dwordx4 v3, s[48:51], s7 offen offset:2048 sc1 lds
v_mfma_f32_16x16x32_bf16 v[24:27], a[8:11], a[200:203], v[24:27]
ds_read_b128 a[40:43], v1 offset:18432
v_exp_f32 v44, v44
v_mfma_f32_16x16x32_bf16 v[24:27], a[12:15], a[204:207], v[24:27]
ds_read_b128 a[44:47], v1 offset:19456
v_exp_f32 v45, v45
v_mfma_f32_16x16x32_bf16 v[28:31], a[0:3], a[208:211], v[92:95]
ds_read_b128 a[48:51], v1 offset:20480
v_exp_f32 v46, v46
v_mfma_f32_16x16x32_bf16 v[28:31], a[4:7], a[212:215], v[28:31]
s_waitcnt lgkmcnt(5)
v_exp_f32 v47, v47
v_mfma_f32_16x16x32_bf16 v[28:31], a[8:11], a[216:219], v[28:31]
ds_read_b128 a[52:55], v1 offset:21504
v_cvt_pk_bf16_f32 v62, v44, v45
v_mfma_f32_16x16x32_bf16 v[28:31], a[12:15], a[220:223], v[28:31]
ds_read_b128 a[56:59], v1 offset:22528
v_cvt_pk_bf16_f32 v63, v46, v47
v_mfma_f32_16x16x32_bf16 v[40:43], a[16:19], a[192:195], v[88:91]
ds_read_b128 a[60:63], v1 offset:23552
v_xor_b32 v1, 0x8000, v1
v_mfma_f32_16x16x32_bf16 v[40:43], a[20:23], a[196:199], v[40:43]
buffer_load_dwordx4 v3, s[48:51], s7 offen offset:3072 sc1 lds
v_mfma_f32_16x16x32_bf16 v[40:43], a[24:27], a[200:203], v[40:43]
s_add_u32 s7, s7, 0x8000
v_exp_f32 v24, v24
v_mfma_f32_16x16x32_bf16 v[40:43], a[28:31], a[204:207], v[40:43]
s_xor_b32 s27, s27, 0x38000
v_exp_f32 v25, v25
v_mfma_f32_16x16x32_bf16 v[44:47], a[16:19], a[208:211], v[92:95]
v_exp_f32 v26, v26
v_mfma_f32_16x16x32_bf16 v[44:47], a[20:23], a[212:215], v[44:47]
v_exp_f32 v27, v27
v_mfma_f32_16x16x32_bf16 v[44:47], a[24:27], a[216:219], v[44:47]
s_waitcnt vmcnt(16) lgkmcnt(0)
v_exp_f32 v28, v28
v_mfma_f32_16x16x32_bf16 v[44:47], a[28:31], a[220:223], v[44:47]
s_barrier
v_exp_f32 v29, v29
L_att_sodd0:
v_mfma_f32_16x16x32_bf16 v[192:195], a[32:35], v[56:59], v[192:195]
v_exp_f32 v30, v30
v_mfma_f32_16x16x32_bf16 v[224:227], a[32:35], v[60:63], v[224:227]
ds_read_b128 a[0:3], v2 offset:8192
v_cvt_pk_bf16_f32 v72, v24, v25
v_mfma_f32_16x16x32_bf16 v[228:231], a[36:39], v[60:63], v[228:231]
ds_read_b128 a[4:7], v2 offset:9216
v_cvt_pk_bf16_f32 v73, v26, v27
v_mfma_f32_16x16x32_bf16 v[196:199], a[36:39], v[56:59], v[196:199]
s_add_u32 m0, s19, 0x0
v_exp_f32 v31, v31
v_mfma_f32_16x16x32_bf16 v[200:203], a[40:43], v[56:59], v[200:203]
ds_read_b128 a[8:11], v2 offset:10240
v_cvt_pk_bf16_f32 v76, v28, v29
v_mfma_f32_16x16x32_bf16 v[232:235], a[40:43], v[60:63], v[232:235]
buffer_load_dwordx4 v3, s[48:51], s32 offen offset:0 sc1 lds
v_mfma_f32_16x16x32_bf16 v[236:239], a[44:47], v[60:63], v[236:239]
v_exp_f32 v40, v40
v_mfma_f32_16x16x32_bf16 v[204:207], a[44:47], v[56:59], v[204:207]
ds_read_b128 a[12:15], v2 offset:11264
v_cvt_pk_bf16_f32 v77, v30, v31
v_mfma_f32_16x16x32_bf16 v[208:211], a[48:51], v[56:59], v[208:211]
ds_read_b128 a[16:19], v2 offset:12288
v_mfma_f32_16x16x32_bf16 v[240:243], a[48:51], v[60:63], v[240:243]
buffer_load_dwordx4 v3, s[48:51], s32 offen offset:1024 sc1 lds
v_mfma_f32_16x16x32_bf16 v[244:247], a[52:55], v[60:63], v[244:247]
ds_read_b128 a[20:23], v2 offset:13312
v_mfma_f32_16x16x32_bf16 v[212:215], a[52:55], v[56:59], v[212:215]
ds_read_b128 a[24:27], v2 offset:14336
v_mfma_f32_16x16x32_bf16 v[216:219], a[56:59], v[56:59], v[216:219]
ds_read_b128 a[28:31], v2 offset:15360
v_mfma_f32_16x16x32_bf16 v[248:251], a[56:59], v[60:63], v[248:251]
ds_read_b128 a[32:35], v2 offset:0
v_exp_f32 v41, v41
v_mfma_f32_16x16x32_bf16 v[252:255], a[60:63], v[60:63], v[252:255]
v_exp_f32 v42, v42
v_mfma_f32_16x16x32_bf16 v[220:223], a[60:63], v[56:59], v[220:223]
s_waitcnt lgkmcnt(5)
v_exp_f32 v43, v43
v_smfmac_f32_16x16x64_bf16 a[228:231], a[232:235], v[56:63], v9
ds_read_b128 a[36:39], v2 offset:1024
v_cvt_pk_bf16_f32 v74, v40, v41
v_mfma_f32_16x16x32_bf16 v[24:27], a[0:3], a[192:195], v[88:91]
ds_read_b128 a[40:43], v2 offset:2048
v_exp_f32 v44, v44
v_mfma_f32_16x16x32_bf16 v[24:27], a[4:7], a[196:199], v[24:27]
buffer_load_dwordx4 v3, s[48:51], s32 offen offset:2048 sc1 lds
v_mfma_f32_16x16x32_bf16 v[24:27], a[8:11], a[200:203], v[24:27]
v_exp_f32 v45, v45
v_mfma_f32_16x16x32_bf16 v[24:27], a[12:15], a[204:207], v[24:27]
ds_read_b128 a[44:47], v2 offset:3072
v_cvt_pk_bf16_f32 v75, v42, v43
v_mfma_f32_16x16x32_bf16 v[28:31], a[0:3], a[208:211], v[92:95]
ds_read_b128 a[48:51], v2 offset:4096
v_exp_f32 v46, v46
v_mfma_f32_16x16x32_bf16 v[28:31], a[4:7], a[212:215], v[28:31]
s_waitcnt lgkmcnt(5)
v_exp_f32 v47, v47
v_mfma_f32_16x16x32_bf16 v[28:31], a[8:11], a[216:219], v[28:31]
ds_read_b128 a[52:55], v2 offset:5120
v_cvt_pk_bf16_f32 v78, v44, v45
v_mfma_f32_16x16x32_bf16 v[28:31], a[12:15], a[220:223], v[28:31]
buffer_load_dwordx4 v3, s[48:51], s32 offen offset:3072 sc1 lds
v_mfma_f32_16x16x32_bf16 v[40:43], a[16:19], a[192:195], v[88:91]
ds_read_b128 a[56:59], v2 offset:6144
s_add_u32 s32, s32, 0x8000
v_mfma_f32_16x16x32_bf16 v[40:43], a[20:23], a[196:199], v[40:43]
ds_read_b128 a[60:63], v2 offset:7168
v_cvt_pk_bf16_f32 v79, v46, v47
v_mfma_f32_16x16x32_bf16 v[40:43], a[24:27], a[200:203], v[40:43]
v_exp_f32 v24, v24
v_mfma_f32_16x16x32_bf16 v[40:43], a[28:31], a[204:207], v[40:43]
v_exp_f32 v25, v25
v_mfma_f32_16x16x32_bf16 v[44:47], a[16:19], a[208:211], v[92:95]
v_exp_f32 v26, v26
v_mfma_f32_16x16x32_bf16 v[44:47], a[20:23], a[212:215], v[44:47]
v_exp_f32 v27, v27
v_mfma_f32_16x16x32_bf16 v[44:47], a[24:27], a[216:219], v[44:47]
v_exp_f32 v28, v28
v_mfma_f32_16x16x32_bf16 v[44:47], a[28:31], a[220:223], v[44:47]
s_waitcnt lgkmcnt(0)
v_exp_f32 v29, v29
v_mfma_f32_16x16x32_bf16 v[192:195], a[32:35], v[72:75], v[192:195]
v_exp_f32 v30, v30
v_mfma_f32_16x16x32_bf16 v[224:227], a[32:35], v[76:79], v[224:227]
v_exp_f32 v31, v31
v_mfma_f32_16x16x32_bf16 v[228:231], a[36:39], v[76:79], v[228:231]
v_exp_f32 v40, v40
v_mfma_f32_16x16x32_bf16 v[196:199], a[36:39], v[72:75], v[196:199]
s_add_u32 m0, s19, 0x1000
v_exp_f32 v41, v41
v_mfma_f32_16x16x32_bf16 v[200:203], a[40:43], v[72:75], v[200:203]
ds_read_b128 a[0:3], v2 offset:24576
v_cvt_pk_bf16_f32 v56, v24, v25
v_mfma_f32_16x16x32_bf16 v[232:235], a[40:43], v[76:79], v[232:235]
buffer_load_dwordx4 v3, s[48:51], s7 offen offset:0 sc1 lds
v_mfma_f32_16x16x32_bf16 v[236:239], a[44:47], v[76:79], v[236:239]
ds_read_b128 a[4:7], v2 offset:25600
v_cvt_pk_bf16_f32 v57, v26, v27
v_mfma_f32_16x16x32_bf16 v[204:207], a[44:47], v[72:75], v[204:207]
ds_read_b128 a[8:11], v2 offset:26624
v_cvt_pk_bf16_f32 v60, v28, v29
v_mfma_f32_16x16x32_bf16 v[208:211], a[48:51], v[72:75], v[208:211]
ds_read_b128 a[12:15], v2 offset:27648
v_cvt_pk_bf16_f32 v61, v30, v31
v_mfma_f32_16x16x32_bf16 v[240:243], a[48:51], v[76:79], v[240:243]
ds_read_b128 a[16:19], v2 offset:28672
v_cvt_pk_bf16_f32 v58, v40, v41
v_mfma_f32_16x16x32_bf16 v[244:247], a[52:55], v[76:79], v[244:247]
buffer_load_dwordx4 v3, s[48:51], s7 offen offset:1024 sc1 lds
v_mfma_f32_16x16x32_bf16 v[212:215], a[52:55], v[72:75], v[212:215]
ds_read_b128 a[20:23], v2 offset:29696
v_mfma_f32_16x16x32_bf16 v[216:219], a[56:59], v[72:75], v[216:219]
v_exp_f32 v42, v42
v_mfma_f32_16x16x32_bf16 v[248:251], a[56:59], v[76:79], v[248:251]
ds_read_b128 a[24:27], v2 offset:30720
v_mfma_f32_16x16x32_bf16 v[252:255], a[60:63], v[76:79], v[252:255]
ds_read_b128 a[28:31], v2 offset:31744
v_exp_f32 v43, v43
v_mfma_f32_16x16x32_bf16 v[220:223], a[60:63], v[72:75], v[220:223]
ds_read_b128 a[32:35], v2 offset:16384
v_cvt_pk_bf16_f32 v59, v42, v43
v_smfmac_f32_16x16x64_bf16 a[228:231], a[232:235], v[72:79], v9
ds_read_b128 a[36:39], v2 offset:17408
s_waitcnt lgkmcnt(6)
v_mfma_f32_16x16x32_bf16 v[24:27], a[0:3], a[192:195], v[88:91]
buffer_load_dwordx4 v3, s[48:51], s7 offen offset:2048 sc1 lds
v_mfma_f32_16x16x32_bf16 v[24:27], a[4:7], a[196:199], v[24:27]
ds_read_b128 a[40:43], v2 offset:18432
v_exp_f32 v44, v44
v_mfma_f32_16x16x32_bf16 v[24:27], a[8:11], a[200:203], v[24:27]
ds_read_b128 a[44:47], v2 offset:19456
v_exp_f32 v45, v45
v_mfma_f32_16x16x32_bf16 v[24:27], a[12:15], a[204:207], v[24:27]
ds_read_b128 a[48:51], v2 offset:20480
v_cvt_pk_bf16_f32 v62, v44, v45
v_mfma_f32_16x16x32_bf16 v[28:31], a[0:3], a[208:211], v[92:95]
v_exp_f32 v46, v46
v_mfma_f32_16x16x32_bf16 v[28:31], a[4:7], a[212:215], v[28:31]
s_waitcnt lgkmcnt(5)
v_exp_f32 v47, v47
v_mfma_f32_16x16x32_bf16 v[28:31], a[8:11], a[216:219], v[28:31]
ds_read_b128 a[52:55], v2 offset:21504
v_cvt_pk_bf16_f32 v63, v46, v47
v_mfma_f32_16x16x32_bf16 v[28:31], a[12:15], a[220:223], v[28:31]
buffer_load_dwordx4 v3, s[48:51], s7 offen offset:3072 sc1 lds
v_mfma_f32_16x16x32_bf16 v[40:43], a[16:19], a[192:195], v[88:91]
ds_read_b128 a[56:59], v2 offset:22528
s_add_u32 s7, s7, 0x8000
v_mfma_f32_16x16x32_bf16 v[40:43], a[20:23], a[196:199], v[40:43]
ds_read_b128 a[60:63], v2 offset:23552
v_xor_b32 v2, 0x38000, v2
v_mfma_f32_16x16x32_bf16 v[40:43], a[24:27], a[200:203], v[40:43]
s_xor_b32 s19, s19, 0x8000
v_exp_f32 v24, v24
v_mfma_f32_16x16x32_bf16 v[40:43], a[28:31], a[204:207], v[40:43]
s_sub_u32 s15, s15, 1
v_exp_f32 v25, v25
v_mfma_f32_16x16x32_bf16 v[44:47], a[16:19], a[208:211], v[92:95]
s_cmp_lg_u32 s15, 0
v_exp_f32 v26, v26
v_mfma_f32_16x16x32_bf16 v[44:47], a[20:23], a[212:215], v[44:47]
v_exp_f32 v27, v27
v_mfma_f32_16x16x32_bf16 v[44:47], a[24:27], a[216:219], v[44:47]
s_waitcnt vmcnt(16) lgkmcnt(0)
v_exp_f32 v28, v28
v_mfma_f32_16x16x32_bf16 v[44:47], a[28:31], a[220:223], v[44:47]
s_barrier
v_exp_f32 v29, v29
s_cbranch_scc1 L_att_seven0
s_branch L_att_sdone
L_att_seven1:
v_mfma_f32_16x16x32_bf16 v[192:195], a[32:35], v[56:59], v[192:195]
v_exp_f32 v30, v30
v_mfma_f32_16x16x32_bf16 v[224:227], a[32:35], v[60:63], v[224:227]
ds_read_b128 a[0:3], v1 offset:8192
v_cvt_pk_bf16_f32 v72, v24, v25
v_mfma_f32_16x16x32_bf16 v[228:231], a[36:39], v[60:63], v[228:231]
ds_read_b128 a[4:7], v1 offset:9216
v_cvt_pk_bf16_f32 v73, v26, v27
v_mfma_f32_16x16x32_bf16 v[196:199], a[36:39], v[56:59], v[196:199]
s_add_u32 m0, s27, 0x0
v_exp_f32 v31, v31
v_mfma_f32_16x16x32_bf16 v[200:203], a[40:43], v[56:59], v[200:203]
ds_read_b128 a[8:11], v1 offset:10240
v_cvt_pk_bf16_f32 v76, v28, v29
v_mfma_f32_16x16x32_bf16 v[232:235], a[40:43], v[60:63], v[232:235]
buffer_load_dwordx4 v3, s[48:51], s32 offen offset:0 sc1 lds
v_mfma_f32_16x16x32_bf16 v[236:239], a[44:47], v[60:63], v[236:239]
v_exp_f32 v40, v40
v_mfma_f32_16x16x32_bf16 v[204:207], a[44:47], v[56:59], v[204:207]
ds_read_b128 a[12:15], v1 offset:11264
v_cvt_pk_bf16_f32 v77, v30, v31
v_mfma_f32_16x16x32_bf16 v[208:211], a[48:51], v[56:59], v[208:211]
ds_read_b128 a[16:19], v1 offset:12288
v_mfma_f32_16x16x32_bf16 v[240:243], a[48:51], v[60:63], v[240:243]
buffer_load_dwordx4 v3, s[48:51], s32 offen offset:1024 sc1 lds
v_mfma_f32_16x16x32_bf16 v[244:247], a[52:55], v[60:63], v[244:247]
ds_read_b128 a[20:23], v1 offset:13312
v_mfma_f32_16x16x32_bf16 v[212:215], a[52:55], v[56:59], v[212:215]
ds_read_b128 a[24:27], v1 offset:14336
v_mfma_f32_16x16x32_bf16 v[216:219], a[56:59], v[56:59], v[216:219]
ds_read_b128 a[28:31], v1 offset:15360
v_mfma_f32_16x16x32_bf16 v[248:251], a[56:59], v[60:63], v[248:251]
ds_read_b128 a[32:35], v1 offset:0
v_exp_f32 v41, v41
v_mfma_f32_16x16x32_bf16 v[252:255], a[60:63], v[60:63], v[252:255]
v_exp_f32 v42, v42
v_mfma_f32_16x16x32_bf16 v[220:223], a[60:63], v[56:59], v[220:223]
s_waitcnt lgkmcnt(5)
v_exp_f32 v43, v43
v_smfmac_f32_16x16x64_bf16 a[228:231], a[232:235], v[56:63], v9
ds_read_b128 a[36:39], v1 offset:1024
v_cvt_pk_bf16_f32 v74, v40, v41
v_mfma_f32_16x16x32_bf16 v[24:27], a[0:3], a[192:195], v[88:91]
ds_read_b128 a[40:43], v1 offset:2048
v_exp_f32 v44, v44
v_mfma_f32_16x16x32_bf16 v[24:27], a[4:7], a[196:199], v[24:27]
buffer_load_dwordx4 v3, s[48:51], s32 offen offset:2048 sc1 lds
v_mfma_f32_16x16x32_bf16 v[24:27], a[8:11], a[200:203], v[24:27]
v_exp_f32 v45, v45
v_mfma_f32_16x16x32_bf16 v[24:27], a[12:15], a[204:207], v[24:27]
ds_read_b128 a[44:47], v1 offset:3072
v_cvt_pk_bf16_f32 v75, v42, v43
v_mfma_f32_16x16x32_bf16 v[28:31], a[0:3], a[208:211], v[92:95]
ds_read_b128 a[48:51], v1 offset:4096
v_exp_f32 v46, v46
v_mfma_f32_16x16x32_bf16 v[28:31], a[4:7], a[212:215], v[28:31]
s_waitcnt lgkmcnt(5)
v_exp_f32 v47, v47
v_mfma_f32_16x16x32_bf16 v[28:31], a[8:11], a[216:219], v[28:31]
ds_read_b128 a[52:55], v1 offset:5120
v_cvt_pk_bf16_f32 v78, v44, v45
v_mfma_f32_16x16x32_bf16 v[28:31], a[12:15], a[220:223], v[28:31]
buffer_load_dwordx4 v3, s[48:51], s32 offen offset:3072 sc1 lds
v_mfma_f32_16x16x32_bf16 v[40:43], a[16:19], a[192:195], v[88:91]
ds_read_b128 a[56:59], v1 offset:6144
s_add_u32 s32, s32, 0x8000
v_mfma_f32_16x16x32_bf16 v[40:43], a[20:23], a[196:199], v[40:43]
ds_read_b128 a[60:63], v1 offset:7168
v_cvt_pk_bf16_f32 v79, v46, v47
v_mfma_f32_16x16x32_bf16 v[40:43], a[24:27], a[200:203], v[40:43]
v_exp_f32 v24, v24
v_mfma_f32_16x16x32_bf16 v[40:43], a[28:31], a[204:207], v[40:43]
v_exp_f32 v25, v25
v_mfma_f32_16x16x32_bf16 v[44:47], a[16:19], a[208:211], v[92:95]
v_exp_f32 v26, v26
v_mfma_f32_16x16x32_bf16 v[44:47], a[20:23], a[212:215], v[44:47]
v_exp_f32 v27, v27
v_mfma_f32_16x16x32_bf16 v[44:47], a[24:27], a[216:219], v[44:47]
v_exp_f32 v28, v28
v_mfma_f32_16x16x32_bf16 v[44:47], a[28:31], a[220:223], v[44:47]
s_waitcnt lgkmcnt(0)
v_exp_f32 v29, v29
v_mfma_f32_16x16x32_bf16 v[192:195], a[32:35], v[72:75], v[192:195]
s_add_u32 m0, s27, 0x1000
v_exp_f32 v30, v30
v_mfma_f32_16x16x32_bf16 v[224:227], a[32:35], v[76:79], v[224:227]
buffer_load_dwordx4 v3, s[48:51], s7 offen offset:0 sc1 lds
v_mfma_f32_16x16x32_bf16 v[228:231], a[36:39], v[76:79], v[228:231]
v_exp_f32 v31, v31
v_mfma_f32_16x16x32_bf16 v[196:199], a[36:39], v[72:75], v[196:199]
ds_read_b128 a[0:3], v1 offset:24576
v_cvt_pk_bf16_f32 v56, v24, v25
v_mfma_f32_16x16x32_bf16 v[200:203], a[40:43], v[72:75], v[200:203]
ds_read_b128 a[4:7], v1 offset:25600
v_cvt_pk_bf16_f32 v57, v26, v27
v_mfma_f32_16x16x32_bf16 v[232:235], a[40:43], v[76:79], v[232:235]
v_exp_f32 v40, v40
v_mfma_f32_16x16x32_bf16 v[236:239], a[44:47], v[76:79], v[236:239]
ds_read_b128 a[8:11], v1 offset:26624
v_cvt_pk_bf16_f32 v60, v28, v29
v_mfma_f32_16x16x32_bf16 v[204:207], a[44:47], v[72:75], v[204:207]
v_exp_f32 v41, v41
v_mfma_f32_16x16x32_bf16 v[208:211], a[48:51], v[72:75], v[208:211]
ds_read_b128 a[12:15], v1 offset:27648
v_cvt_pk_bf16_f32 v61, v30, v31
v_mfma_f32_16x16x32_bf16 v[240:243], a[48:51], v[76:79], v[240:243]
ds_read_b128 a[16:19], v1 offset:28672
v_cvt_pk_bf16_f32 v58, v40, v41
v_mfma_f32_16x16x32_bf16 v[244:247], a[52:55], v[76:79], v[244:247]
v_exp_f32 v42, v42
v_mfma_f32_16x16x32_bf16 v[212:215], a[52:55], v[72:75], v[212:215]
buffer_load_dwordx4 v3, s[48:51], s7 offen offset:1024 sc1 lds
v_mfma_f32_16x16x32_bf16 v[216:219], a[56:59], v[72:75], v[216:219]
ds_read_b128 a[20:23], v1 offset:29696
v_mfma_f32_16x16x32_bf16 v[248:251], a[56:59], v[76:79], v[248:251]
ds_read_b128 a[24:27], v1 offset:30720
v_mfma_f32_16x16x32_bf16 v[252:255], a[60:63], v[76:79], v[252:255]
ds_read_b128 a[28:31], v1 offset:31744
v_mfma_f32_16x16x32_bf16 v[220:223], a[60:63], v[72:75], v[220:223]
s_waitcnt lgkmcnt(4)
v_exp_f32 v43, v43
v_smfmac_f32_16x16x64_bf16 a[228:231], a[232:235], v[72:79], v9
ds_read_b128 a[32:35], v1 offset:16384
v_cvt_pk_bf16_f32 v59, v42, v43
v_mfma_f32_16x16x32_bf16 v[24:27], a[0:3], a[192:195], v[88:91]
ds_read_b128 a[36:39], v1 offset:17408
v_mfma_f32_16x16x32_bf16 v[24:27], a[4:7], a[196:199], v[24:27]
buffer_load_dwordx4 v3, s[48:51], s7 offen offset:2048 sc1 lds
v_mfma_f32_16x16x32_bf16 v[24:27], a[8:11], a[200:203], v[24:27]
ds_read_b128 a[40:43], v1 offset:18432
v_exp_f32 v44, v44
v_mfma_f32_16x16x32_bf16 v[24:27], a[12:15], a[204:207], v[24:27]
ds_read_b128 a[44:47], v1 offset:19456
v_exp_f32 v45, v45
v_mfma_f32_16x16x32_bf16 v[28:31], a[0:3], a[208:211], v[92:95]
ds_read_b128 a[48:51], v1 offset:20480
v_exp_f32 v46, v46
v_mfma_f32_16x16x32_bf16 v[28:31], a[4:7], a[212:215], v[28:31]
s_waitcnt lgkmcnt(5)
v_exp_f32 v47, v47
v_mfma_f32_16x16x32_bf16 v[28:31], a[8:11], a[216:219], v[28:31]
ds_read_b128 a[52:55], v1 offset:21504
v_cvt_pk_bf16_f32 v62, v44, v45
v_mfma_f32_16x16x32_bf16 v[28:31], a[12:15], a[220:223], v[28:31]
ds_read_b128 a[56:59], v1 offset:22528
v_cvt_pk_bf16_f32 v63, v46, v47
v_mfma_f32_16x16x32_bf16 v[40:43], a[16:19], a[192:195], v[88:91]
ds_read_b128 a[60:63], v1 offset:23552
v_xor_b32 v1, 0x8000, v1
v_mfma_f32_16x16x32_bf16 v[40:43], a[20:23], a[196:199], v[40:43]
buffer_load_dwordx4 v3, s[48:51], s7 offen offset:3072 sc1 lds
v_mfma_f32_16x16x32_bf16 v[40:43], a[24:27], a[200:203], v[40:43]
s_add_u32 s7, s7, 0x8000
v_exp_f32 v24, v24
v_mfma_f32_16x16x32_bf16 v[40:43], a[28:31], a[204:207], v[40:43]
s_xor_b32 s27, s27, 0x38000
v_exp_f32 v25, v25
v_mfma_f32_16x16x32_bf16 v[44:47], a[16:19], a[208:211], v[92:95]
s_waitcnt vmcnt(16) lgkmcnt(0)
v_exp_f32 v26, v26
v_mfma_f32_16x16x32_bf16 v[44:47], a[20:23], a[212:215], v[44:47]
s_barrier
v_exp_f32 v27, v27
v_mfma_f32_16x16x32_bf16 v[44:47], a[24:27], a[216:219], v[44:47]
v_exp_f32 v28, v28
v_mfma_f32_16x16x32_bf16 v[44:47], a[28:31], a[220:223], v[44:47]
v_exp_f32 v29, v29
L_att_sodd1:
v_mfma_f32_16x16x32_bf16 v[192:195], a[32:35], v[56:59], v[192:195]
v_exp_f32 v30, v30
v_mfma_f32_16x16x32_bf16 v[224:227], a[32:35], v[60:63], v[224:227]
ds_read_b128 a[0:3], v2 offset:8192
v_cvt_pk_bf16_f32 v72, v24, v25
v_mfma_f32_16x16x32_bf16 v[228:231], a[36:39], v[60:63], v[228:231]
ds_read_b128 a[4:7], v2 offset:9216
v_cvt_pk_bf16_f32 v73, v26, v27
v_mfma_f32_16x16x32_bf16 v[196:199], a[36:39], v[56:59], v[196:199]
s_add_u32 m0, s19, 0x0
v_exp_f32 v31, v31
v_mfma_f32_16x16x32_bf16 v[200:203], a[40:43], v[56:59], v[200:203]
ds_read_b128 a[8:11], v2 offset:10240
v_cvt_pk_bf16_f32 v76, v28, v29
v_mfma_f32_16x16x32_bf16 v[232:235], a[40:43], v[60:63], v[232:235]
buffer_load_dwordx4 v3, s[48:51], s32 offen offset:0 sc1 lds
v_mfma_f32_16x16x32_bf16 v[236:239], a[44:47], v[60:63], v[236:239]
v_exp_f32 v40, v40
v_mfma_f32_16x16x32_bf16 v[204:207], a[44:47], v[56:59], v[204:207]
ds_read_b128 a[12:15], v2 offset:11264
v_cvt_pk_bf16_f32 v77, v30, v31
v_mfma_f32_16x16x32_bf16 v[208:211], a[48:51], v[56:59], v[208:211]
ds_read_b128 a[16:19], v2 offset:12288
v_mfma_f32_16x16x32_bf16 v[240:243], a[48:51], v[60:63], v[240:243]
buffer_load_dwordx4 v3, s[48:51], s32 offen offset:1024 sc1 lds
v_mfma_f32_16x16x32_bf16 v[244:247], a[52:55], v[60:63], v[244:247]
ds_read_b128 a[20:23], v2 offset:13312
v_mfma_f32_16x16x32_bf16 v[212:215], a[52:55], v[56:59], v[212:215]
ds_read_b128 a[24:27], v2 offset:14336
v_mfma_f32_16x16x32_bf16 v[216:219], a[56:59], v[56:59], v[216:219]
ds_read_b128 a[28:31], v2 offset:15360
v_mfma_f32_16x16x32_bf16 v[248:251], a[56:59], v[60:63], v[248:251]
ds_read_b128 a[32:35], v2 offset:0
v_exp_f32 v41, v41
v_mfma_f32_16x16x32_bf16 v[252:255], a[60:63], v[60:63], v[252:255]
v_exp_f32 v42, v42
v_mfma_f32_16x16x32_bf16 v[220:223], a[60:63], v[56:59], v[220:223]
s_waitcnt lgkmcnt(5)
v_exp_f32 v43, v43
v_smfmac_f32_16x16x64_bf16 a[228:231], a[232:235], v[56:63], v9
ds_read_b128 a[36:39], v2 offset:1024
v_cvt_pk_bf16_f32 v74, v40, v41
v_mfma_f32_16x16x32_bf16 v[24:27], a[0:3], a[192:195], v[88:91]
ds_read_b128 a[40:43], v2 offset:2048
v_exp_f32 v44, v44
v_mfma_f32_16x16x32_bf16 v[24:27], a[4:7], a[196:199], v[24:27]
buffer_load_dwordx4 v3, s[48:51], s32 offen offset:2048 sc1 lds
v_mfma_f32_16x16x32_bf16 v[24:27], a[8:11], a[200:203], v[24:27]
v_exp_f32 v45, v45
v_mfma_f32_16x16x32_bf16 v[24:27], a[12:15], a[204:207], v[24:27]
ds_read_b128 a[44:47], v2 offset:3072
v_cvt_pk_bf16_f32 v75, v42, v43
v_mfma_f32_16x16x32_bf16 v[28:31], a[0:3], a[208:211], v[92:95]
ds_read_b128 a[48:51], v2 offset:4096
v_exp_f32 v46, v46
v_mfma_f32_16x16x32_bf16 v[28:31], a[4:7], a[212:215], v[28:31]
s_waitcnt lgkmcnt(5)
v_exp_f32 v47, v47
v_mfma_f32_16x16x32_bf16 v[28:31], a[8:11], a[216:219], v[28:31]
ds_read_b128 a[52:55], v2 offset:5120
v_cvt_pk_bf16_f32 v78, v44, v45
v_mfma_f32_16x16x32_bf16 v[28:31], a[12:15], a[220:223], v[28:31]
buffer_load_dwordx4 v3, s[48:51], s32 offen offset:3072 sc1 lds
v_mfma_f32_16x16x32_bf16 v[40:43], a[16:19], a[192:195], v[88:91]
ds_read_b128 a[56:59], v2 offset:6144
s_add_u32 s32, s32, 0x8000
v_mfma_f32_16x16x32_bf16 v[40:43], a[20:23], a[196:199], v[40:43]
ds_read_b128 a[60:63], v2 offset:7168
v_cvt_pk_bf16_f32 v79, v46, v47
v_mfma_f32_16x16x32_bf16 v[40:43], a[24:27], a[200:203], v[40:43]
v_exp_f32 v24, v24
v_mfma_f32_16x16x32_bf16 v[40:43], a[28:31], a[204:207], v[40:43]
v_exp_f32 v25, v25
v_mfma_f32_16x16x32_bf16 v[44:47], a[16:19], a[208:211], v[92:95]
v_exp_f32 v26, v26
v_mfma_f32_16x16x32_bf16 v[44:47], a[20:23], a[212:215], v[44:47]
v_exp_f32 v27, v27
v_mfma_f32_16x16x32_bf16 v[44:47], a[24:27], a[216:219], v[44:47]
v_exp_f32 v28, v28
v_mfma_f32_16x16x32_bf16 v[44:47], a[28:31], a[220:223], v[44:47]
s_waitcnt lgkmcnt(0)
v_exp_f32 v29, v29
v_mfma_f32_16x16x32_bf16 v[192:195], a[32:35], v[72:75], v[192:195]
v_exp_f32 v30, v30
v_mfma_f32_16x16x32_bf16 v[224:227], a[32:35], v[76:79], v[224:227]
v_exp_f32 v31, v31
v_mfma_f32_16x16x32_bf16 v[228:231], a[36:39], v[76:79], v[228:231]
v_exp_f32 v40, v40
v_mfma_f32_16x16x32_bf16 v[196:199], a[36:39], v[72:75], v[196:199]
s_add_u32 m0, s19, 0x1000
v_exp_f32 v41, v41
v_mfma_f32_16x16x32_bf16 v[200:203], a[40:43], v[72:75], v[200:203]
ds_read_b128 a[0:3], v2 offset:24576
v_cvt_pk_bf16_f32 v56, v24, v25
v_mfma_f32_16x16x32_bf16 v[232:235], a[40:43], v[76:79], v[232:235]
buffer_load_dwordx4 v3, s[48:51], s7 offen offset:0 sc1 lds
v_mfma_f32_16x16x32_bf16 v[236:239], a[44:47], v[76:79], v[236:239]
ds_read_b128 a[4:7], v2 offset:25600
v_cvt_pk_bf16_f32 v57, v26, v27
v_mfma_f32_16x16x32_bf16 v[204:207], a[44:47], v[72:75], v[204:207]
ds_read_b128 a[8:11], v2 offset:26624
v_cvt_pk_bf16_f32 v60, v28, v29
v_mfma_f32_16x16x32_bf16 v[208:211], a[48:51], v[72:75], v[208:211]
ds_read_b128 a[12:15], v2 offset:27648
v_cvt_pk_bf16_f32 v61, v30, v31
v_mfma_f32_16x16x32_bf16 v[240:243], a[48:51], v[76:79], v[240:243]
ds_read_b128 a[16:19], v2 offset:28672
v_cvt_pk_bf16_f32 v58, v40, v41
v_mfma_f32_16x16x32_bf16 v[244:247], a[52:55], v[76:79], v[244:247]
buffer_load_dwordx4 v3, s[48:51], s7 offen offset:1024 sc1 lds
v_mfma_f32_16x16x32_bf16 v[212:215], a[52:55], v[72:75], v[212:215]
ds_read_b128 a[20:23], v2 offset:29696
v_mfma_f32_16x16x32_bf16 v[216:219], a[56:59], v[72:75], v[216:219]
v_exp_f32 v42, v42
v_mfma_f32_16x16x32_bf16 v[248:251], a[56:59], v[76:79], v[248:251]
ds_read_b128 a[24:27], v2 offset:30720
v_mfma_f32_16x16x32_bf16 v[252:255], a[60:63], v[76:79], v[252:255]
ds_read_b128 a[28:31], v2 offset:31744
v_exp_f32 v43, v43
v_mfma_f32_16x16x32_bf16 v[220:223], a[60:63], v[72:75], v[220:223]
ds_read_b128 a[32:35], v2 offset:16384
v_cvt_pk_bf16_f32 v59, v42, v43
v_smfmac_f32_16x16x64_bf16 a[228:231], a[232:235], v[72:79], v9
ds_read_b128 a[36:39], v2 offset:17408
s_waitcnt lgkmcnt(6)
v_mfma_f32_16x16x32_bf16 v[24:27], a[0:3], a[192:195], v[88:91]
buffer_load_dwordx4 v3, s[48:51], s7 offen offset:2048 sc1 lds
v_mfma_f32_16x16x32_bf16 v[24:27], a[4:7], a[196:199], v[24:27]
ds_read_b128 a[40:43], v2 offset:18432
v_exp_f32 v44, v44
v_mfma_f32_16x16x32_bf16 v[24:27], a[8:11], a[200:203], v[24:27]
ds_read_b128 a[44:47], v2 offset:19456
v_exp_f32 v45, v45
v_mfma_f32_16x16x32_bf16 v[24:27], a[12:15], a[204:207], v[24:27]
ds_read_b128 a[48:51], v2 offset:20480
v_cvt_pk_bf16_f32 v62, v44, v45
v_mfma_f32_16x16x32_bf16 v[28:31], a[0:3], a[208:211], v[92:95]
v_exp_f32 v46, v46
v_mfma_f32_16x16x32_bf16 v[28:31], a[4:7], a[212:215], v[28:31]
s_waitcnt lgkmcnt(5)
v_exp_f32 v47, v47
v_mfma_f32_16x16x32_bf16 v[28:31], a[8:11], a[216:219], v[28:31]
ds_read_b128 a[52:55], v2 offset:21504
v_cvt_pk_bf16_f32 v63, v46, v47
v_mfma_f32_16x16x32_bf16 v[28:31], a[12:15], a[220:223], v[28:31]
buffer_load_dwordx4 v3, s[48:51], s7 offen offset:3072 sc1 lds
v_mfma_f32_16x16x32_bf16 v[40:43], a[16:19], a[192:195], v[88:91]
ds_read_b128 a[56:59], v2 offset:22528
s_add_u32 s7, s7, 0x8000
v_mfma_f32_16x16x32_bf16 v[40:43], a[20:23], a[196:199], v[40:43]
ds_read_b128 a[60:63], v2 offset:23552
v_xor_b32 v2, 0x38000, v2
v_mfma_f32_16x16x32_bf16 v[40:43], a[24:27], a[200:203], v[40:43]
s_xor_b32 s19, s19, 0x8000
v_exp_f32 v24, v24
v_mfma_f32_16x16x32_bf16 v[40:43], a[28:31], a[204:207], v[40:43]
s_sub_u32 s15, s15, 1
v_exp_f32 v25, v25
v_mfma_f32_16x16x32_bf16 v[44:47], a[16:19], a[208:211], v[92:95]
s_cmp_lg_u32 s15, 0
s_waitcnt vmcnt(16) lgkmcnt(0)
v_exp_f32 v26, v26
v_mfma_f32_16x16x32_bf16 v[44:47], a[20:23], a[212:215], v[44:47]
s_barrier
v_exp_f32 v27, v27
v_mfma_f32_16x16x32_bf16 v[44:47], a[24:27], a[216:219], v[44:47]
v_exp_f32 v28, v28
v_mfma_f32_16x16x32_bf16 v[44:47], a[28:31], a[220:223], v[44:47]
v_exp_f32 v29, v29
s_cbranch_scc1 L_att_seven1
L_att_sdone:
s_cmp_ge_u32 s4, 2
s_cbranch_scc1 L_att_sh0_1
L_att_sh0_0:
v_mfma_f32_16x16x32_bf16 v[192:195], a[32:35], v[56:59], v[192:195]
ds_read_b128 a[0:3], v1 offset:8192
v_cvt_pk_bf16_f32 v72, v24, v25
v_mfma_f32_16x16x32_bf16 v[224:227], a[32:35], v[60:63], v[224:227]
ds_read_b128 a[4:7], v1 offset:9216
v_cvt_pk_bf16_f32 v73, v26, v27
v_mfma_f32_16x16x32_bf16 v[228:231], a[36:39], v[60:63], v[228:231]
v_exp_f32 v30, v30
v_mfma_f32_16x16x32_bf16 v[196:199], a[36:39], v[56:59], v[196:199]
buffer_load_dword v14, v15, s[84:87], 0 offen offset:192 sc1
v_mfma_f32_16x16x32_bf16 v[200:203], a[40:43], v[56:59], v[200:203]
ds_read_b128 a[8:11], v1 offset:10240
v_cvt_pk_bf16_f32 v76, v28, v29
v_mfma_f32_16x16x32_bf16 v[232:235], a[40:43], v[60:63], v[232:235]
ds_read_b128 a[12:15], v1 offset:11264
v_mfma_f32_16x16x32_bf16 v[236:239], a[44:47], v[60:63], v[236:239]
s_add_u32 m0, s17, 0x10000
v_exp_f32 v31, v31
v_mfma_f32_16x16x32_bf16 v[204:207], a[44:47], v[56:59], v[204:207]
ds_read_b128 a[16:19], v1 offset:12288
v_cvt_pk_bf16_f32 v77, v30, v31
v_mfma_f32_16x16x32_bf16 v[208:211], a[48:51], v[56:59], v[208:211]
ds_read_b128 a[20:23], v1 offset:13312
v_mfma_f32_16x16x32_bf16 v[240:243], a[48:51], v[60:63], v[240:243]
buffer_load_dwordx4 v12, s[72:75], 0 offen lds
v_mfma_f32_16x16x32_bf16 v[244:247], a[52:55], v[60:63], v[244:247]
ds_read_b128 a[24:27], v1 offset:14336
v_exp_f32 v40, v40
v_mfma_f32_16x16x32_bf16 v[212:215], a[52:55], v[56:59], v[212:215]
v_exp_f32 v41, v41
v_mfma_f32_16x16x32_bf16 v[216:219], a[56:59], v[56:59], v[216:219]
ds_read_b128 a[28:31], v1 offset:15360
v_exp_f32 v42, v42
v_mfma_f32_16x16x32_bf16 v[248:251], a[56:59], v[60:63], v[248:251]
v_exp_f32 v43, v43
v_mfma_f32_16x16x32_bf16 v[252:255], a[60:63], v[60:63], v[252:255]
ds_read_b128 a[32:35], v1 offset:0
v_cvt_pk_bf16_f32 v74, v40, v41
v_mfma_f32_16x16x32_bf16 v[220:223], a[60:63], v[56:59], v[220:223]
buffer_load_dwordx4 v13, s[72:75], 0 offen offset:1024 lds
v_smfmac_f32_16x16x64_bf16 a[228:231], a[232:235], v[56:63], v9
ds_read_b128 a[36:39], v1 offset:1024
s_waitcnt lgkmcnt(6)
v_mfma_f32_16x16x32_bf16 v[24:27], a[0:3], a[192:195], v[112:115]
ds_read_b128 a[40:43], v1 offset:2048
v_exp_f32 v44, v44
v_mfma_f32_16x16x32_bf16 v[24:27], a[4:7], a[196:199], v[24:27]
v_exp_f32 v45, v45
v_mfma_f32_16x16x32_bf16 v[24:27], a[8:11], a[200:203], v[24:27]
ds_read_b128 a[44:47], v1 offset:3072
v_exp_f32 v46, v46
v_mfma_f32_16x16x32_bf16 v[24:27], a[12:15], a[204:207], v[24:27]
v_exp_f32 v47, v47
v_mfma_f32_16x16x32_bf16 v[28:31], a[0:3], a[208:211], v[92:95]
buffer_load_dwordx4 v12, s[72:75], s12 offen offset:2048 lds
v_mfma_f32_16x16x32_bf16 v[28:31], a[4:7], a[212:215], v[28:31]
ds_read_b128 a[48:51], v1 offset:4096
v_cvt_pk_bf16_f32 v75, v42, v43
v_mfma_f32_16x16x32_bf16 v[28:31], a[8:11], a[216:219], v[28:31]
ds_read_b128 a[52:55], v1 offset:5120
v_cvt_pk_bf16_f32 v78, v44, v45
v_mfma_f32_16x16x32_bf16 v[28:31], a[12:15], a[220:223], v[28:31]
ds_read_b128 a[56:59], v1 offset:6144
s_waitcnt lgkmcnt(7)
v_mfma_f32_16x16x32_bf16 v[40:43], a[16:19], a[192:195], v[116:119]
v_exp_f32 v24, v24
v_mfma_f32_16x16x32_bf16 v[40:43], a[20:23], a[196:199], v[40:43]
ds_read_b128 a[60:63], v1 offset:7168
v_cvt_pk_bf16_f32 v79, v46, v47
v_mfma_f32_16x16x32_bf16 v[40:43], a[24:27], a[200:203], v[40:43]
buffer_load_dwordx4 v13, s[72:75], s12 offen offset:3072 lds
v_mfma_f32_16x16x32_bf16 v[40:43], a[28:31], a[204:207], v[40:43]
v_exp_f32 v25, v25
v_mfma_f32_16x16x32_bf16 v[44:47], a[16:19], a[208:211], v[92:95]
v_exp_f32 v26, v26
v_mfma_f32_16x16x32_bf16 v[44:47], a[20:23], a[212:215], v[44:47]
v_exp_f32 v27, v27
v_mfma_f32_16x16x32_bf16 v[44:47], a[24:27], a[216:219], v[44:47]
v_exp_f32 v28, v28
v_mfma_f32_16x16x32_bf16 v[44:47], a[28:31], a[220:223], v[44:47]
s_waitcnt lgkmcnt(0)
v_exp_f32 v29, v29
v_mfma_f32_16x16x32_bf16 v[192:195], a[32:35], v[72:75], v[192:195]
s_add_u32 m0, s17, 0x14000
v_exp_f32 v30, v30
v_mfma_f32_16x16x32_bf16 v[224:227], a[32:35], v[76:79], v[224:227]
v_add_u32 v12, 0x20000, v12
v_cvt_pk_bf16_f32 v56, v24, v25
v_mfma_f32_16x16x32_bf16 v[228:231], a[36:39], v[76:79], v[228:231]
buffer_load_dwordx4 v12, s[72:75], 0 offen lds
v_mfma_f32_16x16x32_bf16 v[196:199], a[36:39], v[72:75], v[196:199]
v_exp_f32 v31, v31
v_mfma_f32_16x16x32_bf16 v[200:203], a[40:43], v[72:75], v[200:203]
ds_read_b128 a[0:3], v1 offset:24576
v_cvt_pk_bf16_f32 v57, v26, v27
v_mfma_f32_16x16x32_bf16 v[232:235], a[40:43], v[76:79], v[232:235]
ds_read_b128 a[4:7], v1 offset:25600
v_cvt_pk_bf16_f32 v60, v28, v29
v_mfma_f32_16x16x32_bf16 v[236:239], a[44:47], v[76:79], v[236:239]
v_exp_f32 v40, v40
v_mfma_f32_16x16x32_bf16 v[204:207], a[44:47], v[72:75], v[204:207]
ds_read_b128 a[8:11], v1 offset:26624
v_add_u32 v13, 0x20000, v13
v_mfma_f32_16x16x32_bf16 v[208:211], a[48:51], v[72:75], v[208:211]
buffer_load_dwordx4 v13, s[72:75], 0 offen offset:1024 lds
v_mfma_f32_16x16x32_bf16 v[240:243], a[48:51], v[76:79], v[240:243]
ds_read_b128 a[12:15], v1 offset:27648
v_cvt_pk_bf16_f32 v61, v30, v31
v_mfma_f32_16x16x32_bf16 v[244:247], a[52:55], v[76:79], v[244:247]
ds_read_b128 a[16:19], v1 offset:28672
v_exp_f32 v41, v41
v_mfma_f32_16x16x32_bf16 v[212:215], a[52:55], v[72:75], v[212:215]
ds_read_b128 a[20:23], v1 offset:29696
v_exp_f32 v42, v42
v_mfma_f32_16x16x32_bf16 v[216:219], a[56:59], v[72:75], v[216:219]
ds_read_b128 a[24:27], v1 offset:30720
v_exp_f32 v43, v43
v_mfma_f32_16x16x32_bf16 v[248:251], a[56:59], v[76:79], v[248:251]
ds_read_b128 a[28:31], v1 offset:31744
v_exp_f32 v44, v44
v_mfma_f32_16x16x32_bf16 v[252:255], a[60:63], v[76:79], v[252:255]
ds_read_b128 a[32:35], v1 offset:16384
v_exp_f32 v45, v45
v_mfma_f32_16x16x32_bf16 v[220:223], a[60:63], v[72:75], v[220:223]
buffer_load_dwordx4 v12, s[72:75], s12 offen offset:2048 lds
v_smfmac_f32_16x16x64_bf16 a[228:231], a[232:235], v[72:79], v9
ds_read_b128 a[36:39], v1 offset:17408
s_waitcnt lgkmcnt(6)
v_mfma_f32_16x16x32_bf16 v[28:31], a[0:3], a[208:211], v[92:95]
buffer_load_dwordx4 v13, s[72:75], s12 offen offset:3072 lds
v_mfma_f32_16x16x32_bf16 v[28:31], a[4:7], a[212:215], v[28:31]
ds_read_b128 a[40:43], v1 offset:18432
v_exp_f32 v46, v46
v_mfma_f32_16x16x32_bf16 v[28:31], a[8:11], a[216:219], v[28:31]
ds_read_b128 a[44:47], v1 offset:19456
v_exp_f32 v47, v47
v_mfma_f32_16x16x32_bf16 v[28:31], a[12:15], a[220:223], v[28:31]
ds_read_b128 a[48:51], v1 offset:20480
s_waitcnt lgkmcnt(5)
v_cvt_pk_bf16_f32 v62, v44, v45
v_cvt_pk_bf16_f32 v63, v46, v47
v_mfma_f32_16x16x32_bf16 v[44:47], a[16:19], a[208:211], v[92:95]
ds_read_b128 a[52:55], v1 offset:21504
v_cvt_pk_bf16_f32 v58, v40, v41
v_mfma_f32_16x16x32_bf16 v[44:47], a[20:23], a[212:215], v[44:47]
ds_read_b128 a[56:59], v1 offset:22528
v_cvt_pk_bf16_f32 v59, v42, v43
v_mfma_f32_16x16x32_bf16 v[44:47], a[24:27], a[216:219], v[44:47]
ds_read_b128 a[60:63], v1 offset:23552
v_xor_b32 v1, 0x8000, v1
v_mfma_f32_16x16x32_bf16 v[44:47], a[28:31], a[220:223], v[44:47]
L_att_h1_0:
s_waitcnt vmcnt(8) lgkmcnt(0)
s_mov_b32 s92, 200000
L_spin_b0:
v_cmp_gt_u32 vcc, 32, v14
s_nop 4
s_cbranch_vccz L_spun_b0
s_sub_u32 s92, s92, 1
s_cbranch_scc1 L_spun_b0
s_sleep 6
buffer_load_dword v14, v15, s[84:87], 0 offen offset:192 sc1
s_waitcnt vmcnt(0)
s_branch L_spin_b0
L_spun_b0:
s_barrier
v_mfma_f32_16x16x32_bf16 v[192:195], a[32:35], v[56:59], v[192:195]
ds_read_b128 a[0:3], v2 offset:8192
v_exp_f32 v28, v28
v_mfma_f32_16x16x32_bf16 v[224:227], a[32:35], v[60:63], v[224:227]
ds_read_b128 a[4:7], v2 offset:9216
v_exp_f32 v29, v29
v_mfma_f32_16x16x32_bf16 v[228:231], a[36:39], v[60:63], v[228:231]
s_add_u32 s101, s101, 0x2000
v_exp_f32 v30, v30
v_mfma_f32_16x16x32_bf16 v[196:199], a[36:39], v[56:59], v[196:199]
buffer_load_dwordx4 a[64:67], v3, s[88:91], s101 offen sc1
v_mfma_f32_16x16x32_bf16 v[200:203], a[40:43], v[56:59], v[200:203]
ds_read_b128 a[8:11], v2 offset:10240
v_exp_f32 v31, v31
v_mfma_f32_16x16x32_bf16 v[232:235], a[40:43], v[60:63], v[232:235]
buffer_load_dwordx4 a[68:71], v3, s[88:91], s101 offen offset:1024 sc1
v_mfma_f32_16x16x32_bf16 v[236:239], a[44:47], v[60:63], v[236:239]
ds_read_b128 a[12:15], v2 offset:11264
v_exp_f32 v44, v44
v_mfma_f32_16x16x32_bf16 v[204:207], a[44:47], v[56:59], v[204:207]
buffer_load_dwordx4 a[72:75], v3, s[88:91], s101 offen offset:2048 sc1
v_mfma_f32_16x16x32_bf16 v[208:211], a[48:51], v[56:59], v[208:211]
ds_read_b128 a[16:19], v2 offset:12288
v_cvt_pk_bf16_f32 v76, v28, v29
v_mfma_f32_16x16x32_bf16 v[240:243], a[48:51], v[60:63], v[240:243]
buffer_load_dwordx4 a[76:79], v3, s[88:91], s101 offen offset:3072 sc1
v_mfma_f32_16x16x32_bf16 v[244:247], a[52:55], v[60:63], v[244:247]
ds_read_b128 a[20:23], v2 offset:13312
v_exp_f32 v45, v45
v_mfma_f32_16x16x32_bf16 v[212:215], a[52:55], v[56:59], v[212:215]
ds_read_b128 a[24:27], v2 offset:14336
v_exp_f32 v46, v46
v_mfma_f32_16x16x32_bf16 v[216:219], a[56:59], v[56:59], v[216:219]
ds_read_b128 a[28:31], v2 offset:15360
s_add_u32 s101, s101, 0x2000
v_mfma_f32_16x16x32_bf16 v[248:251], a[56:59], v[60:63], v[248:251]
buffer_load_dwordx4 a[80:83], v3, s[88:91], s101 offen sc1
v_mfma_f32_16x16x32_bf16 v[252:255], a[60:63], v[60:63], v[252:255]
ds_read_b128 a[32:35], v2 offset:0
v_cvt_pk_bf16_f32 v77, v30, v31
v_mfma_f32_16x16x32_bf16 v[220:223], a[60:63], v[56:59], v[220:223]
ds_read_b128 a[36:39], v2 offset:1024
s_waitcnt lgkmcnt(6)
v_smfmac_f32_16x16x64_bf16 a[228:231], a[232:235], v[56:63], v9
buffer_load_dwordx4 a[84:87], v3, s[88:91], s101 offen offset:1024 sc1
v_mfma_f32_16x16x32_bf16 v[28:31], a[0:3], a[208:211], v[92:95]
ds_read_b128 a[40:43], v2 offset:2048
v_exp_f32 v47, v47
v_mfma_f32_16x16x32_bf16 v[28:31], a[4:7], a[212:215], v[28:31]
ds_read_b128 a[44:47], v2 offset:3072
v_cvt_pk_bf16_f32 v78, v44, v45
v_mfma_f32_16x16x32_bf16 v[28:31], a[8:11], a[216:219], v[28:31]
buffer_load_dwordx4 a[88:91], v3, s[88:91], s101 offen offset:2048 sc1
v_mfma_f32_16x16x32_bf16 v[28:31], a[12:15], a[220:223], v[28:31]
ds_read_b128 a[48:51], v2 offset:4096
s_waitcnt lgkmcnt(5)
v_cvt_pk_bf16_f32 v79, v46, v47
v_mfma_f32_16x16x32_bf16 v[44:47], a[16:19], a[208:211], v[92:95]
ds_read_b128 a[52:55], v2 offset:5120
v_mfma_f32_16x16x32_bf16 v[44:47], a[20:23], a[212:215], v[44:47]
buffer_load_dwordx4 a[92:95], v3, s[88:91], s101 offen offset:3072 sc1
v_mfma_f32_16x16x32_bf16 v[44:47], a[24:27], a[216:219], v[44:47]
ds_read_b128 a[56:59], v2 offset:6144
v_mfma_f32_16x16x32_bf16 v[44:47], a[28:31], a[220:223], v[44:47]
ds_read_b128 a[60:63], v2 offset:7168
s_waitcnt lgkmcnt(0)
v_mfma_f32_16x16x32_bf16 v[224:227], a[32:35], v[76:79], v[224:227]
ds_read_b128 a[0:3], v2 offset:24576
s_add_u32 s101, s101, 0x2000
v_mfma_f32_16x16x32_bf16 v[228:231], a[36:39], v[76:79], v[228:231]
buffer_load_dwordx4 a[96:99], v3, s[88:91], s101 offen sc1
v_mfma_f32_16x16x32_bf16 v[232:235], a[40:43], v[76:79], v[232:235]
ds_read_b128 a[4:7], v2 offset:25600
v_exp_f32 v28, v28
v_mfma_f32_16x16x32_bf16 v[236:239], a[44:47], v[76:79], v[236:239]
buffer_load_dwordx4 a[100:103], v3, s[88:91], s101 offen offset:1024 sc1
v_mfma_f32_16x16x32_bf16 v[240:243], a[48:51], v[76:79], v[240:243]
ds_read_b128 a[8:11], v2 offset:26624
v_exp_f32 v29, v29
v_mfma_f32_16x16x32_bf16 v[244:247], a[52:55], v[76:79], v[244:247]
buffer_load_dwordx4 a[104:107], v3, s[88:91], s101 offen offset:2048 sc1
v_mfma_f32_16x16x32_bf16 v[248:251], a[56:59], v[76:79], v[248:251]
ds_read_b128 a[12:15], v2 offset:27648
s_waitcnt lgkmcnt(0)
v_mfma_f32_16x16x32_bf16 v[252:255], a[60:63], v[76:79], v[252:255]
buffer_load_dwordx4 a[108:111], v3, s[88:91], s101 offen offset:3072 sc1
ds_read_b128 a[16:19], v2 offset:28672
v_mfma_f32_16x16x32_bf16 a[228:231], a[236:239], v[76:79], a[228:231]
ds_read_b128 a[20:23], v2 offset:29696
s_add_u32 s101, s101, 0x2000
v_exp_f32 v30, v30
v_exp_f32 v31, v31
v_cvt_pk_bf16_f32 v60, v28, v29
v_cvt_pk_bf16_f32 v61, v30, v31
v_mfma_f32_16x16x32_bf16 v[28:31], a[0:3], a[208:211], v[120:123]
buffer_load_dwordx4 a[112:115], v3, s[88:91], s101 offen sc1
ds_read_b128 a[24:27], v2 offset:30720
v_mfma_f32_16x16x32_bf16 v[28:31], a[4:7], a[212:215], v[28:31]
ds_read_b128 a[28:31], v2 offset:31744
v_exp_f32 v44, v44
v_mfma_f32_16x16x32_bf16 v[28:31], a[8:11], a[216:219], v[28:31]
buffer_load_dwordx4 a[116:119], v3, s[88:91], s101 offen offset:1024 sc1
v_mfma_f32_16x16x32_bf16 v[28:31], a[12:15], a[220:223], v[28:31]
ds_read_b128 a[32:35], v2 offset:16384
s_waitcnt lgkmcnt(1)
v_exp_f32 v45, v45
v_exp_f32 v46, v46
v_exp_f32 v47, v47
v_cvt_pk_bf16_f32 v62, v44, v45
v_cvt_pk_bf16_f32 v63, v46, v47
v_mfma_f32_16x16x32_bf16 v[44:47], a[16:19], a[208:211], v[124:127]
buffer_load_dwordx4 a[120:123], v3, s[88:91], s101 offen offset:2048 sc1
v_mfma_f32_16x16x32_bf16 v[44:47], a[20:23], a[212:215], v[44:47]
buffer_load_dwordx4 a[124:127], v3, s[88:91], s101 offen offset:3072 sc1
v_mfma_f32_16x16x32_bf16 v[44:47], a[24:27], a[216:219], v[44:47]
ds_read_b128 a[36:39], v2 offset:17408
v_mfma_f32_16x16x32_bf16 v[44:47], a[28:31], a[220:223], v[44:47]
ds_read_b128 a[40:43], v2 offset:18432
ds_read_b128 a[44:47], v2 offset:19456
ds_read_b128 a[48:51], v2 offset:20480
ds_read_b128 a[52:55], v2 offset:21504
ds_read_b128 a[56:59], v2 offset:22528
ds_read_b128 a[60:63], v2 offset:23552
v_xor_b32 v2, 0x38000, v2
s_waitcnt lgkmcnt(0)
s_barrier
v_accvgpr_read_b32 v6, a228
v_accvgpr_read_b32 v7, a229
v_add_f32 v6, v6, v7
v_cmp_nge_f32 vcc, 0x6f800000, v6
v_rcp_f32 v6, v6
s_or_b64 s[34:35], s[34:35], vcc
v_mfma_f32_16x16x32_bf16 v[224:227], a[32:35], v[60:63], v[224:227]
ds_read_b128 a[32:35], v1 offset:0
v_exp_f32 v28, v28
v_mfma_f32_16x16x32_bf16 v[228:231], a[36:39], v[60:63], v[228:231]
ds_read_b128 a[36:39], v1 offset:1024
v_exp_f32 v29, v29
v_mfma_f32_16x16x32_bf16 v[232:235], a[40:43], v[60:63], v[232:235]
ds_read_b128 a[40:43], v1 offset:2048
v_exp_f32 v30, v30
v_mfma_f32_16x16x32_bf16 v[236:239], a[44:47], v[60:63], v[236:239]
ds_read_b128 a[44:47], v1 offset:3072
v_exp_f32 v31, v31
v_mfma_f32_16x16x32_bf16 v[240:243], a[48:51], v[60:63], v[240:243]
ds_read_b128 a[48:51], v1 offset:4096
v_exp_f32 v44, v44
v_mfma_f32_16x16x32_bf16 v[244:247], a[52:55], v[60:63], v[244:247]
ds_read_b128 a[52:55], v1 offset:5120
v_exp_f32 v45, v45
v_mfma_f32_16x16x32_bf16 v[248:251], a[56:59], v[60:63], v[248:251]
ds_read_b128 a[56:59], v1 offset:6144
v_exp_f32 v46, v46
v_mfma_f32_16x16x32_bf16 v[252:255], a[60:63], v[60:63], v[252:255]
ds_read_b128 a[60:63], v1 offset:7168
v_exp_f32 v47, v47
v_mfma_f32_16x16x32_bf16 a[228:231], a[236:239], v[60:63], a[228:231]
v_cvt_pk_bf16_f32 v76, v28, v29
v_cvt_pk_bf16_f32 v77, v30, v31
v_cvt_pk_bf16_f32 v78, v44, v45
v_cvt_pk_bf16_f32 v79, v46, v47
s_add_u32 s8, s30, 0x0
v_pk_mul_f32 v[192:193], v[192:193], v[6:7] op_sel_hi:[1,0]
v_pk_mul_f32 v[194:195], v[194:195], v[6:7] op_sel_hi:[1,0]
v_pk_mul_f32 v[196:197], v[196:197], v[6:7] op_sel_hi:[1,0]
v_pk_mul_f32 v[198:199], v[198:199], v[6:7] op_sel_hi:[1,0]
v_cvt_pk_bf16_f32 v192, v192, v193
v_cvt_pk_bf16_f32 v193, v194, v195
v_cvt_pk_bf16_f32 v194, v196, v197
v_cvt_pk_bf16_f32 v195, v198, v199
buffer_store_dwordx4 v[192:195], v3, s[88:91], s8 offen sc1
s_add_u32 s8, s30, 0x2000
v_pk_mul_f32 v[200:201], v[200:201], v[6:7] op_sel_hi:[1,0]
v_pk_mul_f32 v[202:203], v[202:203], v[6:7] op_sel_hi:[1,0]
v_pk_mul_f32 v[204:205], v[204:205], v[6:7] op_sel_hi:[1,0]
v_pk_mul_f32 v[206:207], v[206:207], v[6:7] op_sel_hi:[1,0]
v_cvt_pk_bf16_f32 v200, v200, v201
v_cvt_pk_bf16_f32 v201, v202, v203
v_cvt_pk_bf16_f32 v202, v204, v205
v_cvt_pk_bf16_f32 v203, v206, v207
buffer_store_dwordx4 v[200:203], v3, s[88:91], s8 offen sc1
s_waitcnt lgkmcnt(0)
v_mfma_f32_16x16x32_bf16 v[224:227], a[32:35], v[76:79], v[224:227]
s_add_u32 s8, s30, 0x4000
v_mul_f32 v208, v6, v208
v_mfma_f32_16x16x32_bf16 v[228:231], a[36:39], v[76:79], v[228:231]
v_mul_f32 v209, v6, v209
v_mul_f32 v210, v6, v210
v_mfma_f32_16x16x32_bf16 v[232:235], a[40:43], v[76:79], v[232:235]
v_mul_f32 v211, v6, v211
v_mul_f32 v212, v6, v212
v_mfma_f32_16x16x32_bf16 v[236:239], a[44:47], v[76:79], v[236:239]
v_mul_f32 v213, v6, v213
v_mul_f32 v214, v6, v214
v_mfma_f32_16x16x32_bf16 v[240:243], a[48:51], v[76:79], v[240:243]
v_mul_f32 v215, v6, v215
v_cvt_pk_bf16_f32 v208, v208, v209
v_mfma_f32_16x16x32_bf16 v[244:247], a[52:55], v[76:79], v[244:247]
v_cvt_pk_bf16_f32 v209, v210, v211
v_cvt_pk_bf16_f32 v210, v212, v213
v_mfma_f32_16x16x32_bf16 v[248:251], a[56:59], v[76:79], v[248:251]
v_cvt_pk_bf16_f32 v211, v214, v215
buffer_store_dwordx4 v[208:211], v3, s[88:91], s8 offen sc1
v_mfma_f32_16x16x32_bf16 v[252:255], a[60:63], v[76:79], v[252:255]
s_add_u32 s8, s30, 0x6000
v_mul_f32 v216, v6, v216
v_mfma_f32_16x16x32_bf16 a[228:231], a[236:239], v[76:79], a[228:231]
v_mul_f32 v217, v6, v217
v_mul_f32 v218, v6, v218
v_mul_f32 v219, v6, v219
v_mul_f32 v220, v6, v220
v_mul_f32 v221, v6, v221
v_mul_f32 v222, v6, v222
v_mul_f32 v223, v6, v223
v_cvt_pk_bf16_f32 v216, v216, v217
v_cvt_pk_bf16_f32 v217, v218, v219
v_cvt_pk_bf16_f32 v218, v220, v221
v_cvt_pk_bf16_f32 v219, v222, v223
buffer_store_dwordx4 v[216:219], v3, s[88:91], s8 offen sc1
s_branch L_att_fin
L_att_sh0_1:
v_mfma_f32_16x16x32_bf16 v[192:195], a[32:35], v[56:59], v[192:195]
ds_read_b128 a[0:3], v1 offset:8192
v_cvt_pk_bf16_f32 v72, v24, v25
v_mfma_f32_16x16x32_bf16 v[224:227], a[32:35], v[60:63], v[224:227]
ds_read_b128 a[4:7], v1 offset:9216
v_cvt_pk_bf16_f32 v73, v26, v27
v_mfma_f32_16x16x32_bf16 v[228:231], a[36:39], v[60:63], v[228:231]
v_exp_f32 v30, v30
v_mfma_f32_16x16x32_bf16 v[196:199], a[36:39], v[56:59], v[196:199]
buffer_load_dword v14, v15, s[84:87], 0 offen offset:192 sc1
v_mfma_f32_16x16x32_bf16 v[200:203], a[40:43], v[56:59], v[200:203]
ds_read_b128 a[8:11], v1 offset:10240
v_cvt_pk_bf16_f32 v76, v28, v29
v_mfma_f32_16x16x32_bf16 v[232:235], a[40:43], v[60:63], v[232:235]
ds_read_b128 a[12:15], v1 offset:11264
v_mfma_f32_16x16x32_bf16 v[236:239], a[44:47], v[60:63], v[236:239]
s_add_u32 m0, s17, 0x10000
v_exp_f32 v31, v31
v_mfma_f32_16x16x32_bf16 v[204:207], a[44:47], v[56:59], v[204:207]
ds_read_b128 a[16:19], v1 offset:12288
v_cvt_pk_bf16_f32 v77, v30, v31
v_mfma_f32_16x16x32_bf16 v[208:211], a[48:51], v[56:59], v[208:211]
ds_read_b128 a[20:23], v1 offset:13312
v_mfma_f32_16x16x32_bf16 v[240:243], a[48:51], v[60:63], v[240:243]
buffer_load_dwordx4 v12, s[72:75], 0 offen lds
v_mfma_f32_16x16x32_bf16 v[244:247], a[52:55], v[60:63], v[244:247]
ds_read_b128 a[24:27], v1 offset:14336
v_exp_f32 v40, v40
v_mfma_f32_16x16x32_bf16 v[212:215], a[52:55], v[56:59], v[212:215]
v_exp_f32 v41, v41
v_mfma_f32_16x16x32_bf16 v[216:219], a[56:59], v[56:59], v[216:219]
ds_read_b128 a[28:31], v1 offset:15360
v_exp_f32 v42, v42
v_mfma_f32_16x16x32_bf16 v[248:251], a[56:59], v[60:63], v[248:251]
v_exp_f32 v43, v43
v_mfma_f32_16x16x32_bf16 v[252:255], a[60:63], v[60:63], v[252:255]
ds_read_b128 a[32:35], v1 offset:0
v_cvt_pk_bf16_f32 v74, v40, v41
v_mfma_f32_16x16x32_bf16 v[220:223], a[60:63], v[56:59], v[220:223]
buffer_load_dwordx4 v13, s[72:75], 0 offen offset:1024 lds
v_smfmac_f32_16x16x64_bf16 a[228:231], a[232:235], v[56:63], v9
ds_read_b128 a[36:39], v1 offset:1024
s_waitcnt lgkmcnt(6)
v_mfma_f32_16x16x32_bf16 v[24:27], a[0:3], a[192:195], v[88:91]
ds_read_b128 a[40:43], v1 offset:2048
v_exp_f32 v44, v44
v_mfma_f32_16x16x32_bf16 v[24:27], a[4:7], a[196:199], v[24:27]
v_exp_f32 v45, v45
v_mfma_f32_16x16x32_bf16 v[24:27], a[8:11], a[200:203], v[24:27]
ds_read_b128 a[44:47], v1 offset:3072
v_exp_f32 v46, v46
v_mfma_f32_16x16x32_bf16 v[24:27], a[12:15], a[204:207], v[24:27]
v_exp_f32 v47, v47
v_mfma_f32_16x16x32_bf16 v[28:31], a[0:3], a[208:211], v[92:95]
buffer_load_dwordx4 v12, s[72:75], s12 offen offset:2048 lds
v_mfma_f32_16x16x32_bf16 v[28:31], a[4:7], a[212:215], v[28:31]
ds_read_b128 a[48:51], v1 offset:4096
v_cvt_pk_bf16_f32 v75, v42, v43
v_mfma_f32_16x16x32_bf16 v[28:31], a[8:11], a[216:219], v[28:31]
ds_read_b128 a[52:55], v1 offset:5120
v_cvt_pk_bf16_f32 v78, v44, v45
v_mfma_f32_16x16x32_bf16 v[28:31], a[12:15], a[220:223], v[28:31]
ds_read_b128 a[56:59], v1 offset:6144
s_waitcnt lgkmcnt(7)
v_mfma_f32_16x16x32_bf16 v[40:43], a[16:19], a[192:195], v[88:91]
v_exp_f32 v24, v24
v_mfma_f32_16x16x32_bf16 v[40:43], a[20:23], a[196:199], v[40:43]
ds_read_b128 a[60:63], v1 offset:7168
v_cvt_pk_bf16_f32 v79, v46, v47
v_mfma_f32_16x16x32_bf16 v[40:43], a[24:27], a[200:203], v[40:43]
buffer_load_dwordx4 v13, s[72:75], s12 offen offset:3072 lds
v_mfma_f32_16x16x32_bf16 v[40:43], a[28:31], a[204:207], v[40:43]
v_exp_f32 v25, v25
v_mfma_f32_16x16x32_bf16 v[44:47], a[16:19], a[208:211], v[92:95]
v_exp_f32 v26, v26
v_mfma_f32_16x16x32_bf16 v[44:47], a[20:23], a[212:215], v[44:47]
v_exp_f32 v27, v27
v_mfma_f32_16x16x32_bf16 v[44:47], a[24:27], a[216:219], v[44:47]
v_exp_f32 v28, v28
v_mfma_f32_16x16x32_bf16 v[44:47], a[28:31], a[220:223], v[44:47]
s_waitcnt lgkmcnt(0)
v_exp_f32 v29, v29
v_mfma_f32_16x16x32_bf16 v[192:195], a[32:35], v[72:75], v[192:195]
ds_read_b128 a[0:3], v1 offset:24576
v_cvt_pk_bf16_f32 v56, v24, v25
v_mfma_f32_16x16x32_bf16 v[224:227], a[32:35], v[76:79], v[224:227]
ds_read_b128 a[4:7], v1 offset:25600
v_add_u32 v12, 0x20000, v12
v_mfma_f32_16x16x32_bf16 v[228:231], a[36:39], v[76:79], v[228:231]
s_add_u32 m0, s17, 0x14000
v_exp_f32 v30, v30
v_mfma_f32_16x16x32_bf16 v[196:199], a[36:39], v[72:75], v[196:199]
buffer_load_dwordx4 v12, s[72:75], 0 offen lds
v_mfma_f32_16x16x32_bf16 v[200:203], a[40:43], v[72:75], v[200:203]
ds_read_b128 a[8:11], v1 offset:26624
v_cvt_pk_bf16_f32 v57, v26, v27
v_mfma_f32_16x16x32_bf16 v[232:235], a[40:43], v[76:79], v[232:235]
ds_read_b128 a[12:15], v1 offset:27648
v_cvt_pk_bf16_f32 v60, v28, v29
v_mfma_f32_16x16x32_bf16 v[236:239], a[44:47], v[76:79], v[236:239]
v_exp_f32 v31, v31
v_mfma_f32_16x16x32_bf16 v[204:207], a[44:47], v[72:75], v[204:207]
ds_read_b128 a[16:19], v1 offset:28672
v_cvt_pk_bf16_f32 v61, v30, v31
v_mfma_f32_16x16x32_bf16 v[208:211], a[48:51], v[72:75], v[208:211]
v_exp_f32 v40, v40
v_mfma_f32_16x16x32_bf16 v[240:243], a[48:51], v[76:79], v[240:243]
ds_read_b128 a[20:23], v1 offset:29696
v_mfma_f32_16x16x32_bf16 v[244:247], a[52:55], v[76:79], v[244:247]
ds_read_b128 a[24:27], v1 offset:30720
v_add_u32 v13, 0x20000, v13
v_mfma_f32_16x16x32_bf16 v[212:215], a[52:55], v[72:75], v[212:215]
buffer_load_dwordx4 v13, s[72:75], 0 offen offset:1024 lds
v_mfma_f32_16x16x32_bf16 v[216:219], a[56:59], v[72:75], v[216:219]
ds_read_b128 a[28:31], v1 offset:31744
v_mfma_f32_16x16x32_bf16 v[248:251], a[56:59], v[76:79], v[248:251]
v_exp_f32 v41, v41
v_mfma_f32_16x16x32_bf16 v[252:255], a[60:63], v[76:79], v[252:255]
ds_read_b128 a[32:35], v1 offset:16384
v_cvt_pk_bf16_f32 v58, v40, v41
v_mfma_f32_16x16x32_bf16 v[220:223], a[60:63], v[72:75], v[220:223]
s_waitcnt lgkmcnt(5)
v_exp_f32 v42, v42
v_smfmac_f32_16x16x64_bf16 a[228:231], a[232:235], v[72:79], v9
ds_read_b128 a[36:39], v1 offset:17408
v_exp_f32 v43, v43
v_mfma_f32_16x16x32_bf16 v[24:27], a[0:3], a[192:195], v[112:115]
v_exp_f32 v44, v44
v_mfma_f32_16x16x32_bf16 v[24:27], a[4:7], a[196:199], v[24:27]
buffer_load_dwordx4 v12, s[72:75], s12 offen offset:2048 lds
v_mfma_f32_16x16x32_bf16 v[24:27], a[8:11], a[200:203], v[24:27]
ds_read_b128 a[40:43], v1 offset:18432
v_cvt_pk_bf16_f32 v59, v42, v43
v_mfma_f32_16x16x32_bf16 v[24:27], a[12:15], a[204:207], v[24:27]
ds_read_b128 a[44:47], v1 offset:19456
v_exp_f32 v45, v45
v_mfma_f32_16x16x32_bf16 v[28:31], a[0:3], a[208:211], v[92:95]
ds_read_b128 a[48:51], v1 offset:20480
v_exp_f32 v46, v46
v_mfma_f32_16x16x32_bf16 v[28:31], a[4:7], a[212:215], v[28:31]
v_exp_f32 v47, v47
v_mfma_f32_16x16x32_bf16 v[28:31], a[8:11], a[216:219], v[28:31]
ds_read_b128 a[52:55], v1 offset:21504
v_cvt_pk_bf16_f32 v62, v44, v45
v_mfma_f32_16x16x32_bf16 v[28:31], a[12:15], a[220:223], v[28:31]
s_waitcnt lgkmcnt(6)
v_exp_f32 v24, v24
v_mfma_f32_16x16x32_bf16 v[40:43], a[16:19], a[192:195], v[116:119]
ds_read_b128 a[56:59], v1 offset:22528
v_cvt_pk_bf16_f32 v63, v46, v47
v_mfma_f32_16x16x32_bf16 v[40:43], a[20:23], a[196:199], v[40:43]
buffer_load_dwordx4 v13, s[72:75], s12 offen offset:3072 lds
v_mfma_f32_16x16x32_bf16 v[40:43], a[24:27], a[200:203], v[40:43]
ds_read_b128 a[60:63], v1 offset:23552
v_xor_b32 v1, 0x8000, v1
v_mfma_f32_16x16x32_bf16 v[40:43], a[28:31], a[204:207], v[40:43]
v_exp_f32 v25, v25
v_mfma_f32_16x16x32_bf16 v[44:47], a[16:19], a[208:211], v[92:95]
v_exp_f32 v26, v26
v_mfma_f32_16x16x32_bf16 v[44:47], a[20:23], a[212:215], v[44:47]
v_exp_f32 v27, v27
v_mfma_f32_16x16x32_bf16 v[44:47], a[24:27], a[216:219], v[44:47]
v_exp_f32 v28, v28
v_mfma_f32_16x16x32_bf16 v[44:47], a[28:31], a[220:223], v[44:47]
v_exp_f32 v29, v29
L_att_h1_1:
s_waitcnt vmcnt(8) lgkmcnt(0)
s_mov_b32 s92, 200000
L_spin_b1:
v_cmp_gt_u32 vcc, 32, v14
s_nop 4
s_cbranch_vccz L_spun_b1
s_sub_u32 s92, s92, 1
s_cbranch_scc1 L_spun_b1
s_sleep 6
buffer_load_dword v14, v15, s[84:87], 0 offen offset:192 sc1
s_waitcnt vmcnt(0)
s_branch L_spin_b1
L_spun_b1:
s_barrier
v_mfma_f32_16x16x32_bf16 v[192:195], a[32:35], v[56:59], v[192:195]
ds_read_b128 a[0:3], v2 offset:8192
v_cvt_pk_bf16_f32 v72, v24, v25
v_mfma_f32_16x16x32_bf16 v[224:227], a[32:35], v[60:63], v[224:227]
ds_read_b128 a[4:7], v2 offset:9216
v_cvt_pk_bf16_f32 v73, v26, v27
v_mfma_f32_16x16x32_bf16 v[228:231], a[36:39], v[60:63], v[228:231]
s_add_u32 s101, s101, 0x2000
v_exp_f32 v30, v30
v_mfma_f32_16x16x32_bf16 v[196:199], a[36:39], v[56:59], v[196:199]
buffer_load_dwordx4 a[64:67], v3, s[88:91], s101 offen sc1
v_mfma_f32_16x16x32_bf16 v[200:203], a[40:43], v[56:59], v[200:203]
ds_read_b128 a[8:11], v2 offset:10240
v_cvt_pk_bf16_f32 v76, v28, v29
v_mfma_f32_16x16x32_bf16 v[232:235], a[40:43], v[60:63], v[232:235]
buffer_load_dwordx4 a[68:71], v3, s[88:91], s101 offen offset:1024 sc1
v_mfma_f32_16x16x32_bf16 v[236:239], a[44:47], v[60:63], v[236:239]
ds_read_b128 a[12:15], v2 offset:11264
v_exp_f32 v31, v31
v_mfma_f32_16x16x32_bf16 v[204:207], a[44:47], v[56:59], v[204:207]
buffer_load_dwordx4 a[72:75], v3, s[88:91], s101 offen offset:2048 sc1
v_mfma_f32_16x16x32_bf16 v[208:211], a[48:51], v[56:59], v[208:211]
ds_read_b128 a[16:19], v2 offset:12288
v_exp_f32 v40, v40
v_mfma_f32_16x16x32_bf16 v[240:243], a[48:51], v[60:63], v[240:243]
buffer_load_dwordx4 a[76:79], v3, s[88:91], s101 offen offset:3072 sc1
v_mfma_f32_16x16x32_bf16 v[244:247], a[52:55], v[60:63], v[244:247]
ds_read_b128 a[20:23], v2 offset:13312
v_exp_f32 v41, v41
v_mfma_f32_16x16x32_bf16 v[212:215], a[52:55], v[56:59], v[212:215]
ds_read_b128 a[24:27], v2 offset:14336
v_exp_f32 v42, v42
v_mfma_f32_16x16x32_bf16 v[216:219], a[56:59], v[56:59], v[216:219]
ds_read_b128 a[28:31], v2 offset:15360
s_add_u32 s101, s101, 0x2000
v_mfma_f32_16x16x32_bf16 v[248:251], a[56:59], v[60:63], v[248:251]
buffer_load_dwordx4 a[80:83], v3, s[88:91], s101 offen sc1
v_mfma_f32_16x16x32_bf16 v[252:255], a[60:63], v[60:63], v[252:255]
ds_read_b128 a[32:35], v2 offset:0
v_cvt_pk_bf16_f32 v77, v30, v31
v_mfma_f32_16x16x32_bf16 v[220:223], a[60:63], v[56:59], v[220:223]
ds_read_b128 a[36:39], v2 offset:1024
s_waitcnt lgkmcnt(6)
v_smfmac_f32_16x16x64_bf16 a[228:231], a[232:235], v[56:63], v9
buffer_load_dwordx4 a[84:87], v3, s[88:91], s101 offen offset:1024 sc1
v_mfma_f32_16x16x32_bf16 v[28:31], a[0:3], a[208:211], v[120:123]
ds_read_b128 a[40:43], v2 offset:2048
v_exp_f32 v43, v43
v_mfma_f32_16x16x32_bf16 v[28:31], a[4:7], a[212:215], v[28:31]
ds_read_b128 a[44:47], v2 offset:3072
v_exp_f32 v44, v44
v_mfma_f32_16x16x32_bf16 v[28:31], a[8:11], a[216:219], v[28:31]
buffer_load_dwordx4 a[88:91], v3, s[88:91], s101 offen offset:2048 sc1
v_mfma_f32_16x16x32_bf16 v[28:31], a[12:15], a[220:223], v[28:31]
ds_read_b128 a[48:51], v2 offset:4096
s_waitcnt lgkmcnt(5)
v_exp_f32 v45, v45
v_exp_f32 v46, v46
v_exp_f32 v47, v47
v_cvt_pk_bf16_f32 v78, v44, v45
v_cvt_pk_bf16_f32 v79, v46, v47
v_mfma_f32_16x16x32_bf16 v[44:47], a[16:19], a[208:211], v[124:127]
ds_read_b128 a[52:55], v2 offset:5120
v_cvt_pk_bf16_f32 v74, v40, v41
v_mfma_f32_16x16x32_bf16 v[44:47], a[20:23], a[212:215], v[44:47]
buffer_load_dwordx4 a[92:95], v3, s[88:91], s101 offen offset:3072 sc1
v_mfma_f32_16x16x32_bf16 v[44:47], a[24:27], a[216:219], v[44:47]
ds_read_b128 a[56:59], v2 offset:6144
v_cvt_pk_bf16_f32 v75, v42, v43
v_mfma_f32_16x16x32_bf16 v[44:47], a[28:31], a[220:223], v[44:47]
ds_read_b128 a[60:63], v2 offset:7168
s_waitcnt lgkmcnt(0)
v_mfma_f32_16x16x32_bf16 v[192:195], a[32:35], v[72:75], v[192:195]
s_add_u32 s101, s101, 0x2000
v_exp_f32 v28, v28
v_mfma_f32_16x16x32_bf16 v[224:227], a[32:35], v[76:79], v[224:227]
buffer_load_dwordx4 a[96:99], v3, s[88:91], s101 offen sc1
v_mfma_f32_16x16x32_bf16 v[228:231], a[36:39], v[76:79], v[228:231]
ds_read_b128 a[32:35], v2 offset:16384
v_exp_f32 v29, v29
v_mfma_f32_16x16x32_bf16 v[196:199], a[36:39], v[72:75], v[196:199]
buffer_load_dwordx4 a[100:103], v3, s[88:91], s101 offen offset:1024 sc1
v_mfma_f32_16x16x32_bf16 v[200:203], a[40:43], v[72:75], v[200:203]
ds_read_b128 a[36:39], v2 offset:17408
v_exp_f32 v30, v30
v_mfma_f32_16x16x32_bf16 v[232:235], a[40:43], v[76:79], v[232:235]
buffer_load_dwordx4 a[104:107], v3, s[88:91], s101 offen offset:2048 sc1
v_mfma_f32_16x16x32_bf16 v[236:239], a[44:47], v[76:79], v[236:239]
ds_read_b128 a[40:43], v2 offset:18432
v_cvt_pk_bf16_f32 v60, v28, v29
v_mfma_f32_16x16x32_bf16 v[204:207], a[44:47], v[72:75], v[204:207]
buffer_load_dwordx4 a[108:111], v3, s[88:91], s101 offen offset:3072 sc1
v_mfma_f32_16x16x32_bf16 v[208:211], a[48:51], v[72:75], v[208:211]
ds_read_b128 a[44:47], v2 offset:19456
s_add_u32 s101, s101, 0x2000
v_mfma_f32_16x16x32_bf16 v[240:243], a[48:51], v[76:79], v[240:243]
buffer_load_dwordx4 a[112:115], v3, s[88:91], s101 offen sc1
v_mfma_f32_16x16x32_bf16 v[244:247], a[52:55], v[76:79], v[244:247]
ds_read_b128 a[48:51], v2 offset:20480
v_exp_f32 v31, v31
v_mfma_f32_16x16x32_bf16 v[212:215], a[52:55], v[72:75], v[212:215]
buffer_load_dwordx4 a[116:119], v3, s[88:91], s101 offen offset:1024 sc1
v_mfma_f32_16x16x32_bf16 v[216:219], a[56:59], v[72:75], v[216:219]
ds_read_b128 a[52:55], v2 offset:21504
v_exp_f32 v44, v44
v_mfma_f32_16x16x32_bf16 v[248:251], a[56:59], v[76:79], v[248:251]
buffer_load_dwordx4 a[120:123], v3, s[88:91], s101 offen offset:2048 sc1
v_mfma_f32_16x16x32_bf16 v[252:255], a[60:63], v[76:79], v[252:255]
buffer_load_dwordx4 a[124:127], v3, s[88:91], s101 offen offset:3072 sc1
v_mfma_f32_16x16x32_bf16 v[220:223], a[60:63], v[72:75], v[220:223]
ds_read_b128 a[56:59], v2 offset:22528
v_cvt_pk_bf16_f32 v61, v30, v31
v_smfmac_f32_16x16x64_bf16 a[228:231], a[232:235], v[72:79], v9
ds_read_b128 a[60:63], v2 offset:23552
v_xor_b32 v2, 0x38000, v2
v_exp_f32 v45, v45
v_exp_f32 v46, v46
v_exp_f32 v47, v47
v_cvt_pk_bf16_f32 v62, v44, v45
v_cvt_pk_bf16_f32 v63, v46, v47
s_waitcnt lgkmcnt(0)
s_barrier
v_accvgpr_read_b32 v6, a228
v_accvgpr_read_b32 v7, a229
v_add_f32 v6, v6, v7
v_cmp_nge_f32 vcc, 0x6f800000, v6
v_rcp_f32 v6, v6
s_or_b64 s[34:35], s[34:35], vcc
v_mfma_f32_16x16x32_bf16 v[224:227], a[32:35], v[60:63], v[224:227]
s_add_u32 s8, s30, 0x0
v_mul_f32 v192, v6, v192
v_mfma_f32_16x16x32_bf16 v[228:231], a[36:39], v[60:63], v[228:231]
v_mul_f32 v193, v6, v193
v_mul_f32 v194, v6, v194
v_mfma_f32_16x16x32_bf16 v[232:235], a[40:43], v[60:63], v[232:235]
v_mul_f32 v195, v6, v195
v_mul_f32 v196, v6, v196
v_mfma_f32_16x16x32_bf16 v[236:239], a[44:47], v[60:63], v[236:239]
v_mul_f32 v197, v6, v197
v_mul_f32 v198, v6, v198
v_mfma_f32_16x16x32_bf16 v[240:243], a[48:51], v[60:63], v[240:243]
v_mul_f32 v199, v6, v199
v_cvt_pk_bf16_f32 v192, v192, v193
v_mfma_f32_16x16x32_bf16 v[244:247], a[52:55], v[60:63], v[244:247]
v_cvt_pk_bf16_f32 v193, v194, v195
v_cvt_pk_bf16_f32 v194, v196, v197
v_mfma_f32_16x16x32_bf16 v[248:251], a[56:59], v[60:63], v[248:251]
v_cvt_pk_bf16_f32 v195, v198, v199
buffer_store_dwordx4 v[192:195], v3, s[88:91], s8 offen sc1
v_mfma_f32_16x16x32_bf16 v[252:255], a[60:63], v[60:63], v[252:255]
v_mfma_f32_16x16x32_bf16 a[228:231], a[236:239], v[60:63], a[228:231]
s_add_u32 s8, s30, 0x2000
v_pk_mul_f32 v[200:201], v[200:201], v[6:7] op_sel_hi:[1,0]
v_pk_mul_f32 v[202:203], v[202:203], v[6:7] op_sel_hi:[1,0]
v_pk_mul_f32 v[204:205], v[204:205], v[6:7] op_sel_hi:[1,0]
v_pk_mul_f32 v[206:207], v[206:207], v[6:7] op_sel_hi:[1,0]
v_cvt_pk_bf16_f32 v200, v200, v201
v_cvt_pk_bf16_f32 v201, v202, v203
v_cvt_pk_bf16_f32 v202, v204, v205
v_cvt_pk_bf16_f32 v203, v206, v207
buffer_store_dwordx4 v[200:203], v3, s[88:91], s8 offen sc1
s_add_u32 s8, s30, 0x4000
v_pk_mul_f32 v[208:209], v[208:209], v[6:7] op_sel_hi:[1,0]
v_pk_mul_f32 v[210:211], v[210:211], v[6:7] op_sel_hi:[1,0]
v_pk_mul_f32 v[212:213], v[212:213], v[6:7] op_sel_hi:[1,0]
v_pk_mul_f32 v[214:215], v[214:215], v[6:7] op_sel_hi:[1,0]
v_cvt_pk_bf16_f32 v208, v208, v209
v_cvt_pk_bf16_f32 v209, v210, v211
v_cvt_pk_bf16_f32 v210, v212, v213
v_cvt_pk_bf16_f32 v211, v214, v215
buffer_store_dwordx4 v[208:211], v3, s[88:91], s8 offen sc1
s_add_u32 s8, s30, 0x6000
v_pk_mul_f32 v[216:217], v[216:217], v[6:7] op_sel_hi:[1,0]
v_pk_mul_f32 v[218:219], v[218:219], v[6:7] op_sel_hi:[1,0]
v_pk_mul_f32 v[220:221], v[220:221], v[6:7] op_sel_hi:[1,0]
v_pk_mul_f32 v[222:223], v[222:223], v[6:7] op_sel_hi:[1,0]
v_cvt_pk_bf16_f32 v216, v216, v217
v_cvt_pk_bf16_f32 v217, v218, v219
v_cvt_pk_bf16_f32 v218, v220, v221
v_cvt_pk_bf16_f32 v219, v222, v223
buffer_store_dwordx4 v[216:219], v3, s[88:91], s8 offen sc1
L_hopC:
s_mov_b32 s95, 1
s_bitcmp1_b32 s4, 0
s_cbranch_scc1 L_padC1
s_branch L_padC0
L_hopC_ret:
s_mov_b32 s95, 0
L_att_fin:
v_accvgpr_read_b32 v22, a230
v_accvgpr_read_b32 v23, a231
v_add_f32 v22, v22, v23
v_cmp_nge_f32 vcc, 0x6f800000, v22
v_rcp_f32 v22, v22
s_or_b64 s[34:35], s[34:35], vcc
s_cmp_lg_u64 s[34:35], 0
s_cselect_b32 s8, 1, 0
s_lshl_b32 s9, s4, 2
s_add_u32 s9, s9, 24576
v_mov_b32 v4, s9
v_mov_b32 v5, s8
ds_write_b32 v4, v5
v_lshrrev_b32 v17, 4, v0
v_lshlrev_b32 v18, 10, v17
v_and_b32 v17, 1, v17
v_lshl_add_u32 v18, v17, 5, v18
v_bfe_u32 v17, v0, 2, 2
v_lshl_add_u32 v18, v17, 6, v18
v_and_b32 v17, 3, v0
v_lshl_add_u32 v4, v17, 3, v18
v_add_u32 v4, 65536, v4
v_xor_b32 v5, 32, v4
s_waitcnt vmcnt(12) lgkmcnt(0)
s_barrier
ds_read_b64_tr_b16 a[0:1], v4 offset:256
ds_read_b64_tr_b16 a[2:3], v4 offset:4352
ds_read_b64_tr_b16 a[4:5], v4 offset:8448
ds_read_b64_tr_b16 a[6:7], v4 offset:12544
ds_read_b64_tr_b16 a[8:9], v5 offset:256
ds_read_b64_tr_b16 a[10:11], v5 offset:4352
ds_read_b64_tr_b16 a[12:13], v5 offset:8448
ds_read_b64_tr_b16 a[14:15], v5 offset:12544
ds_read_b64_tr_b16 a[16:17], v4 offset:512
ds_read_b64_tr_b16 a[18:19], v4 offset:4608
ds_read_b64_tr_b16 a[20:21], v4 offset:8704
ds_read_b64_tr_b16 a[22:23], v4 offset:12800
v_and_b32 v17, 3, v0
v_lshlrev_b32 v17, 2, v17
v_add_u32 v17, 24576, v17
ds_read_b32 v18, v17
s_waitcnt lgkmcnt(0)
v_cmp_ne_u32 vcc, 0, v18
s_cmp_lg_u32 s33, 0
s_cbranch_scc1 L_att_done
s_nop 4
s_cbranch_vccnz L_att_fallback
L_att_done:
s_bitcmp1_b32 s2, 0
s_cbranch_scc1 L_p4_b
v_mfma_f32_16x16x32_bf16 v[56:59], a[0:3], a[64:67], 0
ds_read_b64_tr_b16 a[24:25], v5 offset:512
s_add_u32 s8, s31, 0x0
v_and_b32 v6, 15, v0
v_mfma_f32_16x16x32_bf16 v[56:59], a[4:7], a[80:83], v[56:59]
ds_read_b64_tr_b16 a[26:27], v5 offset:4608
s_add_u32 s101, s101, 0x2000
v_mul_f32 v224, v22, v224
v_mfma_f32_16x16x32_bf16 v[64:67], a[4:7], a[84:87], 0
ds_read_b64_tr_b16 a[28:29], v5 offset:8704
v_lshlrev_b32 v6, 2, v6
v_mul_f32 v225, v22, v225
v_mfma_f32_16x16x32_bf16 v[64:67], a[0:3], a[68:71], v[64:67]
ds_read_b64_tr_b16 a[30:31], v5 offset:12800
v_and_b32 v1, 28, v6
v_mul_f32 v226, v22, v226
v_mfma_f32_16x16x32_bf16 v[72:75], a[0:3], a[72:75], 0
v_or_b32 v7, 16, v1
v_mul_f32 v227, v22, v227
v_mul_f32 v228, v22, v228
v_mfma_f32_16x16x32_bf16 v[72:75], a[4:7], a[88:91], v[72:75]
buffer_load_dwordx4 a[224:227], v3, s[88:91], s101 offen sc1
v_mul_f32 v229, v22, v229
v_mfma_f32_16x16x32_bf16 v[80:83], a[4:7], a[92:95], 0
v_mul_f32 v230, v22, v230
v_mul_f32 v231, v22, v231
v_cvt_pk_bf16_f32 v224, v224, v225
v_mfma_f32_16x16x32_bf16 v[80:83], a[0:3], a[76:79], v[80:83]
v_cvt_pk_bf16_f32 v225, v226, v227
v_cvt_pk_bf16_f32 v226, v228, v229
v_cvt_pk_bf16_f32 v227, v230, v231
v_mfma_f32_16x16x32_bf16 v[84:87], a[8:11], a[76:79], 0
ds_read_b64_tr_b16 a[0:1], v4 offset:768
v_mfma_f32_16x16x32_bf16 v[84:87], a[12:15], a[92:95], v[84:87]
ds_read_b64_tr_b16 a[2:3], v4 offset:4864
v_mfma_f32_16x16x32_bf16 v[76:79], a[12:15], a[88:91], 0
buffer_load_dwordx4 a[228:231], v3, s[88:91], s101 offen offset:1024 sc1
v_mfma_f32_16x16x32_bf16 v[76:79], a[8:11], a[72:75], v[76:79]
ds_read_b64_tr_b16 a[4:5], v4 offset:8960
v_mfma_f32_16x16x32_bf16 v[68:71], a[8:11], a[68:71], 0
ds_read_b64_tr_b16 a[6:7], v4 offset:13056
v_mfma_f32_16x16x32_bf16 v[68:71], a[12:15], a[84:87], v[68:71]
buffer_store_dwordx4 v[224:227], v3, s[88:91], s8 offen sc1
s_add_u32 s8, s31, 0x2000
v_mfma_f32_16x16x32_bf16 v[60:63], a[12:15], a[80:83], 0
s_waitcnt lgkmcnt(4)
v_mul_f32 v232, v22, v232
v_mul_f32 v233, v22, v233
v_mul_f32 v234, v22, v234
v_mfma_f32_16x16x32_bf16 v[60:63], a[8:11], a[64:67], v[60:63]
buffer_load_dwordx4 a[232:235], v3, s[88:91], s101 offen offset:2048 sc1
v_mul_f32 v235, v22, v235
v_mfma_f32_16x16x32_bf16 v[88:91], a[16:19], a[64:67], 0
ds_read_b64_tr_b16 a[8:9], v5 offset:768
v_mul_f32 v236, v22, v236
v_mul_f32 v237, v22, v237
v_mfma_f32_16x16x32_bf16 v[88:91], a[20:23], a[80:83], v[88:91]
ds_read_b64_tr_b16 a[10:11], v5 offset:4864
v_mul_f32 v238, v22, v238
v_mul_f32 v239, v22, v239
v_mfma_f32_16x16x32_bf16 v[96:99], a[20:23], a[84:87], 0
ds_read_b64_tr_b16 a[12:13], v5 offset:8960
v_cvt_pk_bf16_f32 v232, v232, v233
v_cvt_pk_bf16_f32 v233, v234, v235
v_mfma_f32_16x16x32_bf16 v[96:99], a[16:19], a[68:71], v[96:99]
ds_read_b64_tr_b16 a[14:15], v5 offset:13056
v_cvt_pk_bf16_f32 v234, v236, v237
v_cvt_pk_bf16_f32 v235, v238, v239
v_mfma_f32_16x16x32_bf16 v[104:107], a[16:19], a[72:75], 0
buffer_load_dwordx4 a[236:239], v3, s[88:91], s101 offen offset:3072 sc1
v_mfma_f32_16x16x32_bf16 v[104:107], a[20:23], a[88:91], v[104:107]
buffer_store_dwordx4 v[232:235], v3, s[88:91], s8 offen sc1
s_add_u32 s101, s101, 0x2000
v_mfma_f32_16x16x32_bf16 v[112:115], a[20:23], a[92:95], 0
s_add_u32 s8, s31, 0x4000
v_mul_f32 v240, v22, v240
v_mul_f32 v241, v22, v241
v_mul_f32 v242, v22, v242
v_mfma_f32_16x16x32_bf16 v[112:115], a[16:19], a[76:79], v[112:115]
v_mul_f32 v243, v22, v243
v_mul_f32 v244, v22, v244
v_mul_f32 v245, v22, v245
v_mfma_f32_16x16x32_bf16 v[116:119], a[24:27], a[76:79], 0
ds_read_b64_tr_b16 a[16:17], v4 offset:0
v_mul_f32 v246, v22, v246
v_mul_f32 v247, v22, v247
v_mfma_f32_16x16x32_bf16 v[116:119], a[28:31], a[92:95], v[116:119]
ds_read_b64_tr_b16 a[18:19], v4 offset:4096
v_cvt_pk_bf16_f32 v240, v240, v241
v_cvt_pk_bf16_f32 v241, v242, v243
v_mfma_f32_16x16x32_bf16 v[108:111], a[28:31], a[88:91], 0
buffer_load_dwordx4 a[240:243], v3, s[88:91], s101 offen sc1
v_cvt_pk_bf16_f32 v242, v244, v245
v_mfma_f32_16x16x32_bf16 v[108:111], a[24:27], a[72:75], v[108:111]
ds_read_b64_tr_b16 a[20:21], v4 offset:8192
v_cvt_pk_bf16_f32 v243, v246, v247
v_mfma_f32_16x16x32_bf16 v[100:103], a[24:27], a[68:71], 0
ds_read_b64_tr_b16 a[22:23], v4 offset:12288
v_mfma_f32_16x16x32_bf16 v[100:103], a[28:31], a[84:87], v[100:103]
buffer_store_dwordx4 v[240:243], v3, s[88:91], s8 offen sc1
s_add_u32 s8, s31, 0x6000
v_mfma_f32_16x16x32_bf16 v[92:95], a[28:31], a[80:83], 0
s_waitcnt lgkmcnt(4)
v_mul_f32 v248, v22, v248
v_mul_f32 v249, v22, v249
v_mul_f32 v250, v22, v250
v_mfma_f32_16x16x32_bf16 v[92:95], a[24:27], a[64:67], v[92:95]
buffer_load_dwordx4 a[244:247], v3, s[88:91], s101 offen offset:1024 sc1
v_mul_f32 v251, v22, v251
v_mfma_f32_16x16x32_bf16 v[120:123], a[0:3], a[64:67], 0
ds_read_b64_tr_b16 a[24:25], v5 offset:0
v_mul_f32 v252, v22, v252
v_mul_f32 v253, v22, v253
v_mfma_f32_16x16x32_bf16 v[120:123], a[4:7], a[80:83], v[120:123]
ds_read_b64_tr_b16 a[26:27], v5 offset:4096
v_mul_f32 v254, v22, v254
v_mul_f32 v255, v22, v255
v_mfma_f32_16x16x32_bf16 v[128:131], a[4:7], a[84:87], 0
ds_read_b64_tr_b16 a[28:29], v5 offset:8192
v_cvt_pk_bf16_f32 v248, v248, v249
v_cvt_pk_bf16_f32 v249, v250, v251
v_mfma_f32_16x16x32_bf16 v[128:131], a[0:3], a[68:71], v[128:131]
ds_read_b64_tr_b16 a[30:31], v5 offset:12288
v_cvt_pk_bf16_f32 v250, v252, v253
v_cvt_pk_bf16_f32 v251, v254, v255
v_mfma_f32_16x16x32_bf16 v[136:139], a[0:3], a[72:75], 0
buffer_load_dwordx4 a[248:251], v3, s[88:91], s101 offen offset:2048 sc1
v_mfma_f32_16x16x32_bf16 v[136:139], a[4:7], a[88:91], v[136:139]
buffer_store_dwordx4 v[248:251], v3, s[88:91], s8 offen sc1
v_mfma_f32_16x16x32_bf16 v[144:147], a[4:7], a[92:95], 0
s_waitcnt vmcnt(15)
v_mfma_f32_16x16x32_bf16 v[144:147], a[0:3], a[76:79], v[144:147]
s_barrier
v_mfma_f32_16x16x32_bf16 v[148:151], a[8:11], a[76:79], 0
ds_read_b64_tr_b16 a[0:1], v4 offset:16640
v_mfma_f32_16x16x32_bf16 v[148:151], a[12:15], a[92:95], v[148:151]
buffer_load_dwordx4 a[252:255], v3, s[88:91], s101 offen offset:3072 sc1
v_mfma_f32_16x16x32_bf16 v[140:143], a[12:15], a[88:91], 0
ds_read_b64_tr_b16 a[2:3], v4 offset:20736
s_add_u32 m0, s17, 0x24000
v_mfma_f32_16x16x32_bf16 v[140:143], a[8:11], a[72:75], v[140:143]
ds_read_b64_tr_b16 a[4:5], v4 offset:24832
v_add_u32 v12, 0x20000, v12
v_mfma_f32_16x16x32_bf16 v[132:135], a[8:11], a[68:71], 0
ds_read_b64_tr_b16 a[6:7], v4 offset:28928
v_mfma_f32_16x16x32_bf16 v[132:135], a[12:15], a[84:87], v[132:135]
v_mfma_f32_16x16x32_bf16 v[124:127], a[12:15], a[80:83], 0
buffer_load_dwordx4 v12, s[72:75], 0 offen lds
v_mfma_f32_16x16x32_bf16 v[124:127], a[8:11], a[64:67], v[124:127]
s_waitcnt lgkmcnt(4)
v_add_u32 v13, 0x20000, v13
v_mfma_f32_16x16x32_bf16 v[24:27], a[16:19], a[64:67], 0
ds_read_b64_tr_b16 a[8:9], v5 offset:16640
v_mfma_f32_16x16x32_bf16 v[24:27], a[20:23], a[80:83], v[24:27]
ds_read_b64_tr_b16 a[10:11], v5 offset:20736
v_mfma_f32_16x16x32_bf16 v[32:35], a[20:23], a[84:87], 0
ds_read_b64_tr_b16 a[12:13], v5 offset:24832
v_mfma_f32_16x16x32_bf16 v[32:35], a[16:19], a[68:71], v[32:35]
ds_read_b64_tr_b16 a[14:15], v5 offset:28928
v_mfma_f32_16x16x32_bf16 v[40:43], a[16:19], a[72:75], 0
buffer_load_dwordx4 v13, s[72:75], 0 offen offset:1024 lds
v_mfma_f32_16x16x32_bf16 v[40:43], a[20:23], a[88:91], v[40:43]
s_lshl_b32 s28, s99, 1
s_and_b32 s9, s4, 1
s_add_u32 s28, s28, s9
v_mfma_f32_16x16x32_bf16 v[48:51], a[20:23], a[92:95], 0
s_lshl_b32 s9, s28, 8
s_add_u32 s9, s9, 0x3700000
s_lshl_b32 s28, s28, 17
v_mfma_f32_16x16x32_bf16 v[48:51], a[16:19], a[76:79], v[48:51]
s_lshl_b32 s10, s100, 8
s_add_u32 s28, s28, s10
s_lshl_b32 s10, s14, 6
v_mfma_f32_16x16x32_bf16 v[52:55], a[24:27], a[76:79], 0
ds_read_b64_tr_b16 a[16:17], v4 offset:16896
s_add_u32 s28, s28, s10
v_mfma_f32_16x16x32_bf16 v[52:55], a[28:31], a[92:95], v[52:55]
buffer_load_dwordx4 v12, s[72:75], s12 offen offset:2048 lds
v_mfma_f32_16x16x32_bf16 v[44:47], a[28:31], a[88:91], 0
ds_read_b64_tr_b16 a[18:19], v4 offset:20992
s_add_u32 s29, s28, 0x8000
v_mfma_f32_16x16x32_bf16 v[44:47], a[24:27], a[72:75], v[44:47]
ds_read_b64_tr_b16 a[20:21], v4 offset:25088
s_add_u32 s30, s28, 0x10000
v_mfma_f32_16x16x32_bf16 v[36:39], a[24:27], a[68:71], 0
ds_read_b64_tr_b16 a[22:23], v4 offset:29184
s_add_u32 s31, s28, 0x18000
v_mfma_f32_16x16x32_bf16 v[36:39], a[28:31], a[84:87], v[36:39]
s_lshl_b32 s10, s2, 2
s_add_u32 s10, s10, s4
s_lshl_b32 s10, s10, 12
v_mfma_f32_16x16x32_bf16 v[28:31], a[28:31], a[80:83], 0
buffer_load_dwordx4 v13, s[72:75], s12 offen offset:3072 lds
v_mfma_f32_16x16x32_bf16 v[28:31], a[24:27], a[64:67], v[28:31]
s_waitcnt lgkmcnt(4)
s_add_u32 s101, s101, 0x2000
s_add_u32 s44, s10, 0x4800000
v_mfma_f32_16x16x32_bf16 v[56:59], a[0:3], a[96:99], v[56:59]
ds_read_b64_tr_b16 a[24:25], v5 offset:16896
s_xor_b32 s52, s44, 0x4000
v_mfma_f32_16x16x32_bf16 v[56:59], a[4:7], a[112:115], v[56:59]
ds_read_b64_tr_b16 a[26:27], v5 offset:20992
s_add_u32 s45, s10, 0x4c00000
v_mfma_f32_16x16x32_bf16 v[64:67], a[4:7], a[116:119], v[64:67]
ds_read_b64_tr_b16 a[28:29], v5 offset:25088
s_xor_b32 s53, s45, 0x8000
v_mfma_f32_16x16x32_bf16 v[64:67], a[0:3], a[100:103], v[64:67]
buffer_load_dwordx4 a[128:131], v3, s[88:91], s101 offen sc1
v_mfma_f32_16x16x32_bf16 v[72:75], a[0:3], a[104:107], v[72:75]
ds_read_b64_tr_b16 a[30:31], v5 offset:29184
s_add_u32 s46, s10, 0x5000000
v_mfma_f32_16x16x32_bf16 v[72:75], a[4:7], a[120:123], v[72:75]
s_xor_b32 s54, s46, 0xc000
v_and_b32 v18, 16, v0
v_lshrrev_b32 v19, 5, v0
v_mfma_f32_16x16x32_bf16 v[80:83], a[4:7], a[124:127], v[80:83]
v_lshlrev_b32 v19, 4, v19
v_lshl_add_u32 v18, v18, 1, v19
v_mfma_f32_16x16x32_bf16 v[80:83], a[0:3], a[108:111], v[80:83]
v_lshl_add_u32 v2, v6, 9, v18
v_add_u32 v15, 0x10000, v4
v_mfma_f32_16x16x32_bf16 v[84:87], a[8:11], a[108:111], v[84:87]
buffer_load_dwordx4 a[132:135], v3, s[88:91], s101 offen offset:1024 sc1
v_mfma_f32_16x16x32_bf16 v[84:87], a[12:15], a[124:127], v[84:87]
ds_read_b64_tr_b16 a[0:1], v4 offset:17152
v_add_u32 v19, 0x10000, v5
v_mfma_f32_16x16x32_bf16 v[76:79], a[12:15], a[120:123], v[76:79]
ds_read_b64_tr_b16 a[2:3], v4 offset:21248
v_mfma_f32_16x16x32_bf16 v[76:79], a[8:11], a[104:107], v[76:79]
ds_read_b64_tr_b16 a[4:5], v4 offset:25344
v_mfma_f32_16x16x32_bf16 v[68:71], a[8:11], a[100:103], v[68:71]
ds_read_b64_tr_b16 a[6:7], v4 offset:29440
v_mfma_f32_16x16x32_bf16 v[68:71], a[12:15], a[116:119], v[68:71]
v_mfma_f32_16x16x32_bf16 v[60:63], a[12:15], a[112:115], v[60:63]
buffer_load_dwordx4 a[136:139], v3, s[88:91], s101 offen offset:2048 sc1
v_mfma_f32_16x16x32_bf16 v[60:63], a[8:11], a[96:99], v[60:63]
s_waitcnt lgkmcnt(4)
v_mfma_f32_16x16x32_bf16 v[88:91], a[16:19], a[96:99], v[88:91]
ds_read_b64_tr_b16 a[8:9], v5 offset:17152
v_mfma_f32_16x16x32_bf16 v[88:91], a[20:23], a[112:115], v[88:91]
ds_read_b64_tr_b16 a[10:11], v5 offset:21248
v_mfma_f32_16x16x32_bf16 v[96:99], a[20:23], a[116:119], v[96:99]
ds_read_b64_tr_b16 a[12:13], v5 offset:25344
v_mfma_f32_16x16x32_bf16 v[96:99], a[16:19], a[100:103], v[96:99]
buffer_load_dwordx4 a[140:143], v3, s[88:91], s101 offen offset:3072 sc1
v_mfma_f32_16x16x32_bf16 v[104:107], a[16:19], a[104:107], v[104:107]
ds_read_b64_tr_b16 a[14:15], v5 offset:29440
s_add_u32 s101, s101, 0x2000
v_mfma_f32_16x16x32_bf16 v[104:107], a[20:23], a[120:123], v[104:107]
v_mfma_f32_16x16x32_bf16 v[112:115], a[20:23], a[124:127], v[112:115]
s_waitcnt vmcnt(9)
v_mfma_f32_16x16x32_bf16 v[112:115], a[16:19], a[108:111], v[112:115]
s_barrier
s_cmp_lg_u32 s4, 0
s_cbranch_scc1 L_flag_seta
s_lshl_b32 s8, s6, 5
s_add_u32 s8, s8, s5
s_and_b32 s92, s8, 0xf8
s_mul_i32 s92, s92, 7
s_add_u32 s8, s8, s92
s_lshl_b32 s8, s8, 2
s_add_u32 s8, s8, 0x3704000
v_mov_b32 v17, 1
s_mov_b64 exec, 1
buffer_store_dword v17, off, s[88:91], s8 sc1
s_mov_b64 exec, -1
L_flag_seta:
v_mfma_f32_16x16x32_bf16 v[116:119], a[24:27], a[108:111], v[116:119]
buffer_load_dwordx4 a[144:147], v3, s[88:91], s101 offen sc1
v_mfma_f32_16x16x32_bf16 v[116:119], a[28:31], a[124:127], v[116:119]
ds_read_b64_tr_b16 a[16:17], v4 offset:16384
v_mfma_f32_16x16x32_bf16 v[108:111], a[28:31], a[120:123], v[108:111]
ds_read_b64_tr_b16 a[18:19], v4 offset:20480
v_mfma_f32_16x16x32_bf16 v[108:111], a[24:27], a[104:107], v[108:111]
ds_read_b64_tr_b16 a[20:21], v4 offset:24576
v_mfma_f32_16x16x32_bf16 v[100:103], a[24:27], a[100:103], v[100:103]
ds_read_b64_tr_b16 a[22:23], v4 offset:28672
v_mfma_f32_16x16x32_bf16 v[100:103], a[28:31], a[116:119], v[100:103]
buffer_load_dwordx4 a[148:151], v3, s[88:91], s101 offen offset:1024 sc1
v_mfma_f32_16x16x32_bf16 v[92:95], a[28:31], a[112:115], v[92:95]
v_mfma_f32_16x16x32_bf16 v[92:95], a[24:27], a[96:99], v[92:95]
s_waitcnt lgkmcnt(4)
v_mfma_f32_16x16x32_bf16 v[120:123], a[0:3], a[96:99], v[120:123]
ds_read_b64_tr_b16 a[24:25], v5 offset:16384
v_mfma_f32_16x16x32_bf16 v[120:123], a[4:7], a[112:115], v[120:123]
ds_read_b64_tr_b16 a[26:27], v5 offset:20480
v_mfma_f32_16x16x32_bf16 v[128:131], a[4:7], a[116:119], v[128:131]
buffer_load_dwordx4 a[152:155], v3, s[88:91], s101 offen offset:2048 sc1
v_mfma_f32_16x16x32_bf16 v[128:131], a[0:3], a[100:103], v[128:131]
ds_read_b64_tr_b16 a[28:29], v5 offset:24576
v_mfma_f32_16x16x32_bf16 v[136:139], a[0:3], a[104:107], v[136:139]
ds_read_b64_tr_b16 a[30:31], v5 offset:28672
v_mfma_f32_16x16x32_bf16 v[136:139], a[4:7], a[120:123], v[136:139]
v_mfma_f32_16x16x32_bf16 v[144:147], a[4:7], a[124:127], v[144:147]
s_waitcnt vmcnt(7)
v_mfma_f32_16x16x32_bf16 v[144:147], a[0:3], a[108:111], v[144:147]
s_barrier
v_mfma_f32_16x16x32_bf16 v[148:151], a[8:11], a[108:111], v[148:151]
buffer_load_dwordx4 a[156:159], v3, s[88:91], s101 offen offset:3072 sc1
v_mfma_f32_16x16x32_bf16 v[148:151], a[12:15], a[124:127], v[148:151]
ds_read_b64_tr_b16 a[0:1], v15 offset:16640
s_add_u32 m0, s17, 0x18000
v_mfma_f32_16x16x32_bf16 v[140:143], a[12:15], a[120:123], v[140:143]
ds_read_b64_tr_b16 a[2:3], v15 offset:20736
v_add_u32 v12, 0x20000, v12
v_mfma_f32_16x16x32_bf16 v[140:143], a[8:11], a[104:107], v[140:143]
ds_read_b64_tr_b16 a[4:5], v15 offset:24832
v_mfma_f32_16x16x32_bf16 v[132:135], a[8:11], a[100:103], v[132:135]
ds_read_b64_tr_b16 a[6:7], v15 offset:28928
v_mfma_f32_16x16x32_bf16 v[132:135], a[12:15], a[116:119], v[132:135]
buffer_load_dwordx4 v12, s[72:75], 0 offen lds
v_mfma_f32_16x16x32_bf16 v[124:127], a[12:15], a[112:115], v[124:127]
v_add_u32 v13, 0x20000, v13
v_mfma_f32_16x16x32_bf16 v[124:127], a[8:11], a[96:99], v[124:127]
s_waitcnt lgkmcnt(4)
v_mfma_f32_16x16x32_bf16 v[24:27], a[16:19], a[96:99], v[24:27]
ds_read_b64_tr_b16 a[8:9], v19 offset:16640
v_mfma_f32_16x16x32_bf16 v[24:27], a[20:23], a[112:115], v[24:27]
ds_read_b64_tr_b16 a[10:11], v19 offset:20736
v_mfma_f32_16x16x32_bf16 v[32:35], a[20:23], a[116:119], v[32:35]
buffer_load_dwordx4 v13, s[72:75], 0 offen offset:1024 lds
v_mfma_f32_16x16x32_bf16 v[32:35], a[16:19], a[100:103], v[32:35]
ds_read_b64_tr_b16 a[12:13], v19 offset:24832
v_mfma_f32_16x16x32_bf16 v[40:43], a[16:19], a[104:107], v[40:43]
ds_read_b64_tr_b16 a[14:15], v19 offset:28928
v_mfma_f32_16x16x32_bf16 v[40:43], a[20:23], a[120:123], v[40:43]
v_mfma_f32_16x16x32_bf16 v[48:51], a[20:23], a[124:127], v[48:51]
v_mfma_f32_16x16x32_bf16 v[48:51], a[16:19], a[108:111], v[48:51]
buffer_load_dwordx4 v12, s[72:75], s12 offen offset:2048 lds
v_mfma_f32_16x16x32_bf16 v[52:55], a[24:27], a[108:111], v[52:55]
ds_read_b64_tr_b16 a[16:17], v15 offset:16896
v_mfma_f32_16x16x32_bf16 v[52:55], a[28:31], a[124:127], v[52:55]
ds_read_b64_tr_b16 a[18:19], v15 offset:20992
v_mfma_f32_16x16x32_bf16 v[44:47], a[28:31], a[120:123], v[44:47]
ds_read_b64_tr_b16 a[20:21], v15 offset:25088
v_mfma_f32_16x16x32_bf16 v[44:47], a[24:27], a[104:107], v[44:47]
ds_read_b64_tr_b16 a[22:23], v15 offset:29184
v_mfma_f32_16x16x32_bf16 v[36:39], a[24:27], a[100:103], v[36:39]
v_mfma_f32_16x16x32_bf16 v[36:39], a[28:31], a[116:119], v[36:39]
buffer_load_dwordx4 v13, s[72:75], s12 offen offset:3072 lds
v_mfma_f32_16x16x32_bf16 v[28:31], a[28:31], a[112:115], v[28:31]
s_add_u32 s101, s101, 0x2000
v_mfma_f32_16x16x32_bf16 v[28:31], a[24:27], a[96:99], v[28:31]
s_waitcnt lgkmcnt(4)
v_mfma_f32_16x16x32_bf16 v[56:59], a[0:3], a[224:227], v[56:59]
ds_read_b64_tr_b16 a[24:25], v19 offset:16896
v_mfma_f32_16x16x32_bf16 v[56:59], a[4:7], a[240:243], v[56:59]
ds_read_b64_tr_b16 a[26:27], v19 offset:20992
v_mfma_f32_16x16x32_bf16 v[64:67], a[4:7], a[244:247], v[64:67]
buffer_load_dwordx4 a[160:163], v3, s[88:91], s101 offen sc1
v_mfma_f32_16x16x32_bf16 v[64:67], a[0:3], a[228:231], v[64:67]
ds_read_b64_tr_b16 a[28:29], v19 offset:25088
v_mfma_f32_16x16x32_bf16 v[72:75], a[0:3], a[232:235], v[72:75]
ds_read_b64_tr_b16 a[30:31], v19 offset:29184
v_mfma_f32_16x16x32_bf16 v[72:75], a[4:7], a[248:251], v[72:75]
v_mfma_f32_16x16x32_bf16 v[80:83], a[4:7], a[252:255], v[80:83]
v_mfma_f32_16x16x32_bf16 v[80:83], a[0:3], a[236:239], v[80:83]
buffer_load_dwordx4 a[164:167], v3, s[88:91], s101 offen offset:1024 sc1
v_mfma_f32_16x16x32_bf16 v[84:87], a[8:11], a[236:239], v[84:87]
ds_read_b64_tr_b16 a[0:1], v15 offset:17152
v_mfma_f32_16x16x32_bf16 v[84:87], a[12:15], a[252:255], v[84:87]
buffer_load_dword v14, v7, s[88:91], s24 offen sc1
v_mfma_f32_16x16x32_bf16 v[76:79], a[12:15], a[248:251], v[76:79]
ds_read_b64_tr_b16 a[2:3], v15 offset:21248
v_mfma_f32_16x16x32_bf16 v[76:79], a[8:11], a[232:235], v[76:79]
ds_read_b64_tr_b16 a[4:5], v15 offset:25344
v_mfma_f32_16x16x32_bf16 v[68:71], a[8:11], a[228:231], v[68:71]
buffer_load_dwordx4 a[168:171], v3, s[88:91], s101 offen offset:2048 sc1
v_mfma_f32_16x16x32_bf16 v[68:71], a[12:15], a[244:247], v[68:71]
ds_read_b64_tr_b16 a[6:7], v15 offset:29440
v_mfma_f32_16x16x32_bf16 v[60:63], a[12:15], a[240:243], v[60:63]
v_mfma_f32_16x16x32_bf16 v[60:63], a[8:11], a[224:227], v[60:63]
s_waitcnt lgkmcnt(4)
v_mfma_f32_16x16x32_bf16 v[88:91], a[16:19], a[224:227], v[88:91]
ds_read_b64_tr_b16 a[8:9], v19 offset:17152
v_mfma_f32_16x16x32_bf16 v[88:91], a[20:23], a[240:243], v[88:91]
buffer_load_dwordx4 a[172:175], v3, s[88:91], s101 offen offset:3072 sc1
v_mfma_f32_16x16x32_bf16 v[96:99], a[20:23], a[244:247], v[96:99]
ds_read_b64_tr_b16 a[10:11], v19 offset:21248
s_add_u32 s101, s101, 0x2000
v_mfma_f32_16x16x32_bf16 v[96:99], a[16:19], a[228:231], v[96:99]
ds_read_b64_tr_b16 a[12:13], v19 offset:25344
v_mfma_f32_16x16x32_bf16 v[104:107], a[16:19], a[232:235], v[104:107]
ds_read_b64_tr_b16 a[14:15], v19 offset:29440
v_mfma_f32_16x16x32_bf16 v[104:107], a[20:23], a[248:251], v[104:107]
v_mfma_f32_16x16x32_bf16 v[112:115], a[20:23], a[252:255], v[112:115]
v_mfma_f32_16x16x32_bf16 v[112:115], a[16:19], a[236:239], v[112:115]
buffer_load_dwordx4 a[176:179], v3, s[88:91], s101 offen sc1
v_mfma_f32_16x16x32_bf16 v[116:119], a[24:27], a[236:239], v[116:119]
ds_read_b64_tr_b16 a[16:17], v15 offset:16384
v_mfma_f32_16x16x32_bf16 v[116:119], a[28:31], a[252:255], v[116:119]
ds_read_b64_tr_b16 a[18:19], v15 offset:20480
v_mfma_f32_16x16x32_bf16 v[108:111], a[28:31], a[248:251], v[108:111]
ds_read_b64_tr_b16 a[20:21], v15 offset:24576
v_mfma_f32_16x16x32_bf16 v[108:111], a[24:27], a[232:235], v[108:111]
ds_read_b64_tr_b16 a[22:23], v15 offset:28672
v_mfma_f32_16x16x32_bf16 v[100:103], a[24:27], a[228:231], v[100:103]
buffer_load_dwordx4 a[180:183], v3, s[88:91], s101 offen offset:1024 sc1
v_mfma_f32_16x16x32_bf16 v[100:103], a[28:31], a[244:247], v[100:103]
v_mfma_f32_16x16x32_bf16 v[92:95], a[28:31], a[240:243], v[92:95]
v_mfma_f32_16x16x32_bf16 v[92:95], a[24:27], a[224:227], v[92:95]
s_waitcnt lgkmcnt(4)
v_mfma_f32_16x16x32_bf16 v[120:123], a[0:3], a[224:227], v[120:123]
ds_read_b64_tr_b16 a[24:25], v19 offset:16384
v_mfma_f32_16x16x32_bf16 v[120:123], a[4:7], a[240:243], v[120:123]
buffer_load_dwordx4 a[184:187], v3, s[88:91], s101 offen offset:2048 sc1
v_mfma_f32_16x16x32_bf16 v[128:131], a[4:7], a[244:247], v[128:131]
ds_read_b64_tr_b16 a[26:27], v19 offset:20480
v_mfma_f32_16x16x32_bf16 v[128:131], a[0:3], a[228:231], v[128:131]
ds_read_b64_tr_b16 a[28:29], v19 offset:24576
v_mfma_f32_16x16x32_bf16 v[136:139], a[0:3], a[232:235], v[136:139]
ds_read_b64_tr_b16 a[30:31], v19 offset:28672
v_mfma_f32_16x16x32_bf16 v[136:139], a[4:7], a[248:251], v[136:139]
v_mfma_f32_16x16x32_bf16 v[144:147], a[4:7], a[252:255], v[144:147]
s_waitcnt vmcnt(8)
v_mfma_f32_16x16x32_bf16 v[144:147], a[0:3], a[236:239], v[144:147]
s_barrier
v_mfma_f32_16x16x32_bf16 v[148:151], a[8:11], a[236:239], v[148:151]
buffer_load_dwordx4 a[188:191], v3, s[88:91], s101 offen offset:3072 sc1
v_mfma_f32_16x16x32_bf16 v[148:151], a[12:15], a[252:255], v[148:151]
ds_read_b64_tr_b16 a[0:1], v4 offset:33024
s_add_u32 m0, s17, 0x1c000
v_mfma_f32_16x16x32_bf16 v[140:143], a[12:15], a[248:251], v[140:143]
ds_read_b64_tr_b16 a[2:3], v4 offset:37120
v_add_u32 v12, 0x20000, v12
v_mfma_f32_16x16x32_bf16 v[140:143], a[8:11], a[232:235], v[140:143]
ds_read_b64_tr_b16 a[4:5], v4 offset:41216
v_mfma_f32_16x16x32_bf16 v[132:135], a[8:11], a[228:231], v[132:135]
buffer_load_dwordx4 v12, s[72:75], 0 offen lds
v_mfma_f32_16x16x32_bf16 v[132:135], a[12:15], a[244:247], v[132:135]
ds_read_b64_tr_b16 a[6:7], v4 offset:45312
v_add_u32 v13, 0x20000, v13
v_mfma_f32_16x16x32_bf16 v[124:127], a[12:15], a[240:243], v[124:127]
v_mfma_f32_16x16x32_bf16 v[124:127], a[8:11], a[224:227], v[124:127]
s_waitcnt lgkmcnt(4)
v_mfma_f32_16x16x32_bf16 v[24:27], a[16:19], a[224:227], v[24:27]
ds_read_b64_tr_b16 a[8:9], v5 offset:33024
v_mfma_f32_16x16x32_bf16 v[24:27], a[20:23], a[240:243], v[24:27]
buffer_load_dwordx4 v13, s[72:75], 0 offen offset:1024 lds
v_mfma_f32_16x16x32_bf16 v[32:35], a[20:23], a[244:247], v[32:35]
ds_read_b64_tr_b16 a[10:11], v5 offset:37120
v_mfma_f32_16x16x32_bf16 v[32:35], a[16:19], a[228:231], v[32:35]
ds_read_b64_tr_b16 a[12:13], v5 offset:41216
v_mfma_f32_16x16x32_bf16 v[40:43], a[16:19], a[232:235], v[40:43]
ds_read_b64_tr_b16 a[14:15], v5 offset:45312
v_mfma_f32_16x16x32_bf16 v[40:43], a[20:23], a[248:251], v[40:43]
v_mfma_f32_16x16x32_bf16 v[48:51], a[20:23], a[252:255], v[48:51]
buffer_load_dwordx4 v12, s[72:75], s12 offen offset:2048 lds
v_mfma_f32_16x16x32_bf16 v[48:51], a[16:19], a[236:239], v[48:51]
v_mfma_f32_16x16x32_bf16 v[52:55], a[24:27], a[236:239], v[52:55]
ds_read_b64_tr_b16 a[16:17], v4 offset:33280
v_mfma_f32_16x16x32_bf16 v[52:55], a[28:31], a[252:255], v[52:55]
ds_read_b64_tr_b16 a[18:19], v4 offset:37376
v_mfma_f32_16x16x32_bf16 v[44:47], a[28:31], a[248:251], v[44:47]
ds_read_b64_tr_b16 a[20:21], v4 offset:41472
v_mfma_f32_16x16x32_bf16 v[44:47], a[24:27], a[232:235], v[44:47]
buffer_load_dwordx4 v13, s[72:75], s12 offen offset:3072 lds
v_mfma_f32_16x16x32_bf16 v[36:39], a[24:27], a[228:231], v[36:39]
ds_read_b64_tr_b16 a[22:23], v4 offset:45568
s_add_u32 s63, s101, s26
v_mfma_f32_16x16x32_bf16 v[36:39], a[28:31], a[244:247], v[36:39]
s_add_u32 s101, s63, s60
v_mfma_f32_16x16x32_bf16 v[28:31], a[28:31], a[240:243], v[28:31]
v_mfma_f32_16x16x32_bf16 v[28:31], a[24:27], a[224:227], v[28:31]
s_waitcnt vmcnt(10)
s_waitcnt lgkmcnt(4)
s_mov_b32 s92, 200000
L_spin_ca:
v_cmp_eq_u32 vcc, 0, v14
s_nop 4
s_cbranch_vccz L_spun_ca
s_sub_u32 s92, s92, 1
s_cbranch_scc1 L_spun_ca
s_sleep 6
buffer_load_dword v14, v7, s[88:91], s24 offen sc1
s_waitcnt vmcnt(0)
s_branch L_spin_ca
L_spun_ca:
v_mfma_f32_16x16x32_bf16 v[56:59], a[0:3], a[128:131], v[56:59]
buffer_load_dwordx4 a[192:195], v3, s[88:91], s101 offen sc1
v_mfma_f32_16x16x32_bf16 v[56:59], a[4:7], a[144:147], v[56:59]
ds_read_b64_tr_b16 a[24:25], v5 offset:33280
v_mfma_f32_16x16x32_bf16 v[64:67], a[4:7], a[148:151], v[64:67]
ds_read_b64_tr_b16 a[26:27], v5 offset:37376
v_mfma_f32_16x16x32_bf16 v[64:67], a[0:3], a[132:135], v[64:67]
ds_read_b64_tr_b16 a[28:29], v5 offset:41472
v_mfma_f32_16x16x32_bf16 v[72:75], a[0:3], a[136:139], v[72:75]
ds_read_b64_tr_b16 a[30:31], v5 offset:45568
v_mfma_f32_16x16x32_bf16 v[72:75], a[4:7], a[152:155], v[72:75]
buffer_load_dwordx4 a[196:199], v3, s[88:91], s101 offen offset:1024 sc1
v_mfma_f32_16x16x32_bf16 v[80:83], a[4:7], a[156:159], v[80:83]
v_mfma_f32_16x16x32_bf16 v[80:83], a[0:3], a[140:143], v[80:83]
v_mfma_f32_16x16x32_bf16 v[84:87], a[8:11], a[140:143], v[84:87]
ds_read_b64_tr_b16 a[0:1], v4 offset:33536
v_mfma_f32_16x16x32_bf16 v[84:87], a[12:15], a[156:159], v[84:87]
ds_read_b64_tr_b16 a[2:3], v4 offset:37632
v_mfma_f32_16x16x32_bf16 v[76:79], a[12:15], a[152:155], v[76:79]
ds_read_b64_tr_b16 a[4:5], v4 offset:41728
v_mfma_f32_16x16x32_bf16 v[76:79], a[8:11], a[136:139], v[76:79]
buffer_load_dwordx4 a[200:203], v3, s[88:91], s101 offen offset:2048 sc1
v_mfma_f32_16x16x32_bf16 v[68:71], a[8:11], a[132:135], v[68:71]
ds_read_b64_tr_b16 a[6:7], v4 offset:45824
v_mfma_f32_16x16x32_bf16 v[68:71], a[12:15], a[148:151], v[68:71]
v_mfma_f32_16x16x32_bf16 v[60:63], a[12:15], a[144:147], v[60:63]
v_mfma_f32_16x16x32_bf16 v[60:63], a[8:11], a[128:131], v[60:63]
s_waitcnt lgkmcnt(4)
v_mfma_f32_16x16x32_bf16 v[88:91], a[16:19], a[128:131], v[88:91]
buffer_load_dwordx4 a[204:207], v3, s[88:91], s101 offen offset:3072 sc1
v_mfma_f32_16x16x32_bf16 v[88:91], a[20:23], a[144:147], v[88:91]
ds_read_b64_tr_b16 a[8:9], v5 offset:33536
s_add_u32 s101, s101, 0x2000
v_mfma_f32_16x16x32_bf16 v[96:99], a[20:23], a[148:151], v[96:99]
ds_read_b64_tr_b16 a[10:11], v5 offset:37632
v_mfma_f32_16x16x32_bf16 v[96:99], a[16:19], a[132:135], v[96:99]
ds_read_b64_tr_b16 a[12:13], v5 offset:41728
v_mfma_f32_16x16x32_bf16 v[104:107], a[16:19], a[136:139], v[104:107]
ds_read_b64_tr_b16 a[14:15], v5 offset:45824
v_mfma_f32_16x16x32_bf16 v[104:107], a[20:23], a[152:155], v[104:107]
buffer_load_dwordx4 a[208:211], v3, s[88:91], s101 offen sc1
v_mfma_f32_16x16x32_bf16 v[112:115], a[20:23], a[156:159], v[112:115]
v_mfma_f32_16x16x32_bf16 v[112:115], a[16:19], a[140:143], v[112:115]
v_mfma_f32_16x16x32_bf16 v[116:119], a[24:27], a[140:143], v[116:119]
ds_read_b64_tr_b16 a[16:17], v4 offset:32768
v_mfma_f32_16x16x32_bf16 v[116:119], a[28:31], a[156:159], v[116:119]
ds_read_b64_tr_b16 a[18:19], v4 offset:36864
v_mfma_f32_16x16x32_bf16 v[108:111], a[28:31], a[152:155], v[108:111]
buffer_load_dwordx4 a[212:215], v3, s[88:91], s101 offen offset:1024 sc1
v_mfma_f32_16x16x32_bf16 v[108:111], a[24:27], a[136:139], v[108:111]
ds_read_b64_tr_b16 a[20:21], v4 offset:40960
v_mfma_f32_16x16x32_bf16 v[100:103], a[24:27], a[132:135], v[100:103]
ds_read_b64_tr_b16 a[22:23], v4 offset:45056
v_mfma_f32_16x16x32_bf16 v[100:103], a[28:31], a[148:151], v[100:103]
v_mfma_f32_16x16x32_bf16 v[92:95], a[28:31], a[144:147], v[92:95]
s_waitcnt lgkmcnt(4)
v_mfma_f32_16x16x32_bf16 v[92:95], a[24:27], a[128:131], v[92:95]
buffer_load_dwordx4 a[216:219], v3, s[88:91], s101 offen offset:2048 sc1
v_mfma_f32_16x16x32_bf16 v[120:123], a[0:3], a[128:131], v[120:123]
ds_read_b64_tr_b16 a[24:25], v5 offset:32768
v_mfma_f32_16x16x32_bf16 v[120:123], a[4:7], a[144:147], v[120:123]
ds_read_b64_tr_b16 a[26:27], v5 offset:36864
v_mfma_f32_16x16x32_bf16 v[128:131], a[4:7], a[148:151], v[128:131]
ds_read_b64_tr_b16 a[28:29], v5 offset:40960
v_mfma_f32_16x16x32_bf16 v[128:131], a[0:3], a[132:135], v[128:131]
ds_read_b64_tr_b16 a[30:31], v5 offset:45056
v_mfma_f32_16x16x32_bf16 v[136:139], a[0:3], a[136:139], v[136:139]
v_mfma_f32_16x16x32_bf16 v[136:139], a[4:7], a[152:155], v[136:139]
buffer_load_dwordx4 a[220:223], v3, s[88:91], s101 offen offset:3072 sc1
v_mfma_f32_16x16x32_bf16 v[144:147], a[4:7], a[156:159], v[144:147]
s_waitcnt vmcnt(8)
s_add_u32 m0, s17, 0x20000
s_lshl_b32 s61, s60, 3
v_mfma_f32_16x16x32_bf16 v[144:147], a[0:3], a[140:143], v[144:147]
s_barrier
s_add_u32 s62, s61, s12
v_add_u32 v12, s25, v12
v_mfma_f32_16x16x32_bf16 v[148:151], a[8:11], a[140:143], v[148:151]
ds_read_b64_tr_b16 a[0:1], v4 offset:49408
v_mfma_f32_16x16x32_bf16 v[148:151], a[12:15], a[156:159], v[148:151]
ds_read_b64_tr_b16 a[2:3], v4 offset:53504
v_mfma_f32_16x16x32_bf16 v[140:143], a[12:15], a[152:155], v[140:143]
buffer_load_dwordx4 v12, s[64:67], s61 offen lds
v_mfma_f32_16x16x32_bf16 v[140:143], a[8:11], a[136:139], v[140:143]
ds_read_b64_tr_b16 a[4:5], v4 offset:57600
v_add_u32 v13, s25, v13
v_mfma_f32_16x16x32_bf16 v[132:135], a[8:11], a[132:135], v[132:135]
ds_read_b64_tr_b16 a[6:7], v4 offset:61696
v_mfma_f32_16x16x32_bf16 v[132:135], a[12:15], a[148:151], v[132:135]
v_mfma_f32_16x16x32_bf16 v[124:127], a[12:15], a[144:147], v[124:127]
s_waitcnt lgkmcnt(4)
v_mfma_f32_16x16x32_bf16 v[124:127], a[8:11], a[128:131], v[124:127]
buffer_load_dwordx4 v13, s[64:67], s61 offen offset:1024 lds
v_mfma_f32_16x16x32_bf16 v[24:27], a[16:19], a[128:131], v[24:27]
ds_read_b64_tr_b16 a[8:9], v5 offset:49408
v_mfma_f32_16x16x32_bf16 v[24:27], a[20:23], a[144:147], v[24:27]
ds_read_b64_tr_b16 a[10:11], v5 offset:53504
v_mfma_f32_16x16x32_bf16 v[32:35], a[20:23], a[148:151], v[32:35]
ds_read_b64_tr_b16 a[12:13], v5 offset:57600
v_mfma_f32_16x16x32_bf16 v[32:35], a[16:19], a[132:135], v[32:35]
ds_read_b64_tr_b16 a[14:15], v5 offset:61696
v_mfma_f32_16x16x32_bf16 v[40:43], a[16:19], a[136:139], v[40:43]
buffer_load_dwordx4 v12, s[64:67], s62 offen offset:2048 lds
v_mfma_f32_16x16x32_bf16 v[40:43], a[20:23], a[152:155], v[40:43]
v_mfma_f32_16x16x32_bf16 v[48:51], a[20:23], a[156:159], v[48:51]
v_mfma_f32_16x16x32_bf16 v[48:51], a[16:19], a[140:143], v[48:51]
v_mfma_f32_16x16x32_bf16 v[52:55], a[24:27], a[140:143], v[52:55]
ds_read_b64_tr_b16 a[16:17], v4 offset:49664
v_mfma_f32_16x16x32_bf16 v[52:55], a[28:31], a[156:159], v[52:55]
ds_read_b64_tr_b16 a[18:19], v4 offset:53760
v_mfma_f32_16x16x32_bf16 v[44:47], a[28:31], a[152:155], v[44:47]
buffer_load_dwordx4 v13, s[64:67], s62 offen offset:3072 lds
v_mfma_f32_16x16x32_bf16 v[44:47], a[24:27], a[136:139], v[44:47]
ds_read_b64_tr_b16 a[20:21], v4 offset:57856
v_mfma_f32_16x16x32_bf16 v[36:39], a[24:27], a[132:135], v[36:39]
ds_read_b64_tr_b16 a[22:23], v4 offset:61952
v_mfma_f32_16x16x32_bf16 v[36:39], a[28:31], a[148:151], v[36:39]
v_mfma_f32_16x16x32_bf16 v[28:31], a[28:31], a[144:147], v[28:31]
v_mfma_f32_16x16x32_bf16 v[28:31], a[24:27], a[128:131], v[28:31]
s_waitcnt lgkmcnt(4)
s_branch L_p4_join
L_p4_b:
v_mfma_f32_16x16x32_bf16 v[56:59], a[0:3], a[64:67], 0
ds_read_b64_tr_b16 a[24:25], v5 offset:512
s_add_u32 s8, s31, 0x0
v_and_b32 v6, 15, v0
v_mfma_f32_16x16x32_bf16 v[56:59], a[4:7], a[80:83], v[56:59]
ds_read_b64_tr_b16 a[26:27], v5 offset:4608
s_add_u32 s101, s101, 0x2000
v_mul_f32 v224, v22, v224
v_mfma_f32_16x16x32_bf16 v[64:67], a[4:7], a[84:87], 0
ds_read_b64_tr_b16 a[28:29], v5 offset:8704
v_lshlrev_b32 v6, 2, v6
v_mul_f32 v225, v22, v225
v_mfma_f32_16x16x32_bf16 v[64:67], a[0:3], a[68:71], v[64:67]
ds_read_b64_tr_b16 a[30:31], v5 offset:12800
v_and_b32 v1, 28, v6
v_mul_f32 v226, v22, v226
v_mfma_f32_16x16x32_bf16 v[72:75], a[0:3], a[72:75], 0
v_or_b32 v7, 16, v1
v_mul_f32 v227, v22, v227
v_mul_f32 v228, v22, v228
v_mfma_f32_16x16x32_bf16 v[72:75], a[4:7], a[88:91], v[72:75]
buffer_load_dwordx4 a[160:163], v3, s[88:91], s101 offen sc1
v_mul_f32 v229, v22, v229
v_mfma_f32_16x16x32_bf16 v[80:83], a[4:7], a[92:95], 0
v_mul_f32 v230, v22, v230
v_mul_f32 v231, v22, v231
v_cvt_pk_bf16_f32 v224, v224, v225
v_mfma_f32_16x16x32_bf16 v[80:83], a[0:3], a[76:79], v[80:83]
v_cvt_pk_bf16_f32 v225, v226, v227
v_cvt_pk_bf16_f32 v226, v228, v229
v_cvt_pk_bf16_f32 v227, v230, v231
v_mfma_f32_16x16x32_bf16 v[84:87], a[8:11], a[76:79], 0
ds_read_b64_tr_b16 a[0:1], v4 offset:768
v_mfma_f32_16x16x32_bf16 v[84:87], a[12:15], a[92:95], v[84:87]
ds_read_b64_tr_b16 a[2:3], v4 offset:4864
v_mfma_f32_16x16x32_bf16 v[76:79], a[12:15], a[88:91], 0
buffer_load_dwordx4 a[164:167], v3, s[88:91], s101 offen offset:1024 sc1
v_mfma_f32_16x16x32_bf16 v[76:79], a[8:11], a[72:75], v[76:79]
ds_read_b64_tr_b16 a[4:5], v4 offset:8960
v_mfma_f32_16x16x32_bf16 v[68:71], a[8:11], a[68:71], 0
buffer_load_dword v14, v7, s[88:91], s24 offen sc1
v_mfma_f32_16x16x32_bf16 v[68:71], a[12:15], a[84:87], v[68:71]
ds_read_b64_tr_b16 a[6:7], v4 offset:13056
v_mfma_f32_16x16x32_bf16 v[60:63], a[12:15], a[80:83], 0
buffer_store_dwordx4 v[224:227], v3, s[88:91], s8 offen sc1
s_waitcnt lgkmcnt(4)
v_mfma_f32_16x16x32_bf16 v[60:63], a[8:11], a[64:67], v[60:63]
buffer_load_dwordx4 a[168:171], v3, s[88:91], s101 offen offset:2048 sc1
s_add_u32 s8, s31, 0x2000
v_mfma_f32_16x16x32_bf16 v[88:91], a[16:19], a[64:67], 0
ds_read_b64_tr_b16 a[8:9], v5 offset:768
v_mul_f32 v232, v22, v232
v_mul_f32 v233, v22, v233
v_mfma_f32_16x16x32_bf16 v[88:91], a[20:23], a[80:83], v[88:91]
ds_read_b64_tr_b16 a[10:11], v5 offset:4864
v_mul_f32 v234, v22, v234
v_mul_f32 v235, v22, v235
v_mfma_f32_16x16x32_bf16 v[96:99], a[20:23], a[84:87], 0
ds_read_b64_tr_b16 a[12:13], v5 offset:8960
v_mul_f32 v236, v22, v236
v_mul_f32 v237, v22, v237
v_mfma_f32_16x16x32_bf16 v[96:99], a[16:19], a[68:71], v[96:99]
ds_read_b64_tr_b16 a[14:15], v5 offset:13056
v_mul_f32 v238, v22, v238
v_mul_f32 v239, v22, v239
v_mfma_f32_16x16x32_bf16 v[104:107], a[16:19], a[72:75], 0
buffer_load_dwordx4 a[172:175], v3, s[88:91], s101 offen offset:3072 sc1
v_cvt_pk_bf16_f32 v232, v232, v233
v_mfma_f32_16x16x32_bf16 v[104:107], a[20:23], a[88:91], v[104:107]
s_add_u32 s101, s101, 0x2000
v_cvt_pk_bf16_f32 v233, v234, v235
v_cvt_pk_bf16_f32 v234, v236, v237
v_cvt_pk_bf16_f32 v235, v238, v239
v_mfma_f32_16x16x32_bf16 v[112:115], a[20:23], a[92:95], 0
buffer_store_dwordx4 v[232:235], v3, s[88:91], s8 offen sc1
s_add_u32 s8, s31, 0x4000
v_mfma_f32_16x16x32_bf16 v[112:115], a[16:19], a[76:79], v[112:115]
v_mul_f32 v240, v22, v240
v_mul_f32 v241, v22, v241
v_mul_f32 v242, v22, v242
v_mfma_f32_16x16x32_bf16 v[116:119], a[24:27], a[76:79], 0
ds_read_b64_tr_b16 a[16:17], v4 offset:0
v_mul_f32 v243, v22, v243
v_mul_f32 v244, v22, v244
v_mfma_f32_16x16x32_bf16 v[116:119], a[28:31], a[92:95], v[116:119]
buffer_load_dwordx4 a[176:179], v3, s[88:91], s101 offen sc1
v_mul_f32 v245, v22, v245
v_mfma_f32_16x16x32_bf16 v[108:111], a[28:31], a[88:91], 0
ds_read_b64_tr_b16 a[18:19], v4 offset:4096
v_mul_f32 v246, v22, v246
v_mul_f32 v247, v22, v247
v_mfma_f32_16x16x32_bf16 v[108:111], a[24:27], a[72:75], v[108:111]
ds_read_b64_tr_b16 a[20:21], v4 offset:8192
v_cvt_pk_bf16_f32 v240, v240, v241
v_cvt_pk_bf16_f32 v241, v242, v243
v_mfma_f32_16x16x32_bf16 v[100:103], a[24:27], a[68:71], 0
ds_read_b64_tr_b16 a[22:23], v4 offset:12288
v_cvt_pk_bf16_f32 v242, v244, v245
v_cvt_pk_bf16_f32 v243, v246, v247
v_mfma_f32_16x16x32_bf16 v[100:103], a[28:31], a[84:87], v[100:103]
buffer_store_dwordx4 v[240:243], v3, s[88:91], s8 offen sc1
s_add_u32 s8, s31, 0x6000
v_mfma_f32_16x16x32_bf16 v[92:95], a[28:31], a[80:83], 0
buffer_load_dwordx4 a[180:183], v3, s[88:91], s101 offen offset:1024 sc1
v_mul_f32 v248, v22, v248
v_mfma_f32_16x16x32_bf16 v[92:95], a[24:27], a[64:67], v[92:95]
s_waitcnt lgkmcnt(4)
v_mul_f32 v249, v22, v249
v_mul_f32 v250, v22, v250
v_mul_f32 v251, v22, v251
v_mfma_f32_16x16x32_bf16 v[120:123], a[0:3], a[64:67], 0
ds_read_b64_tr_b16 a[24:25], v5 offset:0
v_mul_f32 v252, v22, v252
v_mul_f32 v253, v22, v253
v_mfma_f32_16x16x32_bf16 v[120:123], a[4:7], a[80:83], v[120:123]
ds_read_b64_tr_b16 a[26:27], v5 offset:4096
v_mul_f32 v254, v22, v254
v_mul_f32 v255, v22, v255
v_mfma_f32_16x16x32_bf16 v[128:131], a[4:7], a[84:87], 0
ds_read_b64_tr_b16 a[28:29], v5 offset:8192
v_cvt_pk_bf16_f32 v248, v248, v249
v_cvt_pk_bf16_f32 v249, v250, v251
v_mfma_f32_16x16x32_bf16 v[128:131], a[0:3], a[68:71], v[128:131]
buffer_load_dwordx4 a[184:187], v3, s[88:91], s101 offen offset:2048 sc1
v_cvt_pk_bf16_f32 v250, v252, v253
v_mfma_f32_16x16x32_bf16 v[136:139], a[0:3], a[72:75], 0
ds_read_b64_tr_b16 a[30:31], v5 offset:12288
v_cvt_pk_bf16_f32 v251, v254, v255
v_mfma_f32_16x16x32_bf16 v[136:139], a[4:7], a[88:91], v[136:139]
buffer_store_dwordx4 v[248:251], v3, s[88:91], s8 offen sc1
v_mfma_f32_16x16x32_bf16 v[144:147], a[4:7], a[92:95], 0
s_waitcnt vmcnt(16)
v_mfma_f32_16x16x32_bf16 v[144:147], a[0:3], a[76:79], v[144:147]
s_barrier
v_mfma_f32_16x16x32_bf16 v[148:151], a[8:11], a[76:79], 0
buffer_load_dwordx4 a[188:191], v3, s[88:91], s101 offen offset:3072 sc1
v_mfma_f32_16x16x32_bf16 v[148:151], a[12:15], a[92:95], v[148:151]
ds_read_b64_tr_b16 a[0:1], v4 offset:16640
s_add_u32 m0, s17, 0x1c000
v_mfma_f32_16x16x32_bf16 v[140:143], a[12:15], a[88:91], 0
ds_read_b64_tr_b16 a[2:3], v4 offset:20736
v_add_u32 v12, 0x20000, v12
v_mfma_f32_16x16x32_bf16 v[140:143], a[8:11], a[72:75], v[140:143]
ds_read_b64_tr_b16 a[4:5], v4 offset:24832
v_mfma_f32_16x16x32_bf16 v[132:135], a[8:11], a[68:71], 0
ds_read_b64_tr_b16 a[6:7], v4 offset:28928
v_mfma_f32_16x16x32_bf16 v[132:135], a[12:15], a[84:87], v[132:135]
buffer_load_dwordx4 v12, s[72:75], 0 offen lds
v_mfma_f32_16x16x32_bf16 v[124:127], a[12:15], a[80:83], 0
v_add_u32 v13, 0x20000, v13
v_mfma_f32_16x16x32_bf16 v[124:127], a[8:11], a[64:67], v[124:127]
s_waitcnt lgkmcnt(4)
v_mfma_f32_16x16x32_bf16 v[24:27], a[16:19], a[64:67], 0
ds_read_b64_tr_b16 a[8:9], v5 offset:16640
v_mfma_f32_16x16x32_bf16 v[24:27], a[20:23], a[80:83], v[24:27]
ds_read_b64_tr_b16 a[10:11], v5 offset:20736
v_mfma_f32_16x16x32_bf16 v[32:35], a[20:23], a[84:87], 0
buffer_load_dwordx4 v13, s[72:75], 0 offen offset:1024 lds
v_mfma_f32_16x16x32_bf16 v[32:35], a[16:19], a[68:71], v[32:35]
ds_read_b64_tr_b16 a[12:13], v5 offset:24832
v_mfma_f32_16x16x32_bf16 v[40:43], a[16:19], a[72:75], 0
ds_read_b64_tr_b16 a[14:15], v5 offset:28928
s_lshl_b32 s28, s99, 1
v_mfma_f32_16x16x32_bf16 v[40:43], a[20:23], a[88:91], v[40:43]
s_and_b32 s9, s4, 1
s_add_u32 s28, s28, s9
s_lshl_b32 s9, s28, 8
v_mfma_f32_16x16x32_bf16 v[48:51], a[20:23], a[92:95], 0
s_add_u32 s9, s9, 0x3700000
s_lshl_b32 s28, s28, 17
s_lshl_b32 s10, s100, 8
v_mfma_f32_16x16x32_bf16 v[48:51], a[16:19], a[76:79], v[48:51]
buffer_load_dwordx4 v12, s[72:75], s12 offen offset:2048 lds
v_mfma_f32_16x16x32_bf16 v[52:55], a[24:27], a[76:79], 0
ds_read_b64_tr_b16 a[16:17], v4 offset:16896
s_add_u32 s28, s28, s10
v_mfma_f32_16x16x32_bf16 v[52:55], a[28:31], a[92:95], v[52:55]
ds_read_b64_tr_b16 a[18:19], v4 offset:20992
s_lshl_b32 s10, s14, 6
v_mfma_f32_16x16x32_bf16 v[44:47], a[28:31], a[88:91], 0
ds_read_b64_tr_b16 a[20:21], v4 offset:25088
s_add_u32 s28, s28, s10
v_mfma_f32_16x16x32_bf16 v[44:47], a[24:27], a[72:75], v[44:47]
ds_read_b64_tr_b16 a[22:23], v4 offset:29184
s_add_u32 s29, s28, 0x8000
v_mfma_f32_16x16x32_bf16 v[36:39], a[24:27], a[68:71], 0
s_add_u32 s30, s28, 0x10000
s_add_u32 s31, s28, 0x18000
s_lshl_b32 s10, s2, 2
v_mfma_f32_16x16x32_bf16 v[36:39], a[28:31], a[84:87], v[36:39]
buffer_load_dwordx4 v13, s[72:75], s12 offen offset:3072 lds
v_mfma_f32_16x16x32_bf16 v[28:31], a[28:31], a[80:83], 0
s_add_u32 s63, s101, s26
s_add_u32 s101, s63, s60
s_add_u32 s10, s10, s4
v_mfma_f32_16x16x32_bf16 v[28:31], a[24:27], a[64:67], v[28:31]
s_waitcnt lgkmcnt(4)
s_lshl_b32 s10, s10, 12
s_add_u32 s44, s10, 0x4800000
v_mfma_f32_16x16x32_bf16 v[56:59], a[0:3], a[96:99], v[56:59]
ds_read_b64_tr_b16 a[24:25], v5 offset:16896
s_xor_b32 s52, s44, 0x4000
v_mfma_f32_16x16x32_bf16 v[56:59], a[4:7], a[112:115], v[56:59]
ds_read_b64_tr_b16 a[26:27], v5 offset:20992
s_waitcnt vmcnt(14)
s_mov_b32 s92, 200000
L_spin_cb:
v_cmp_eq_u32 vcc, 0, v14
s_nop 4
s_cbranch_vccz L_spun_cb
s_sub_u32 s92, s92, 1
s_cbranch_scc1 L_spun_cb
s_sleep 6
buffer_load_dword v14, v7, s[88:91], s24 offen sc1
s_waitcnt vmcnt(0)
s_branch L_spin_cb
L_spun_cb:
v_mfma_f32_16x16x32_bf16 v[64:67], a[4:7], a[116:119], v[64:67]
buffer_load_dwordx4 a[192:195], v3, s[88:91], s101 offen sc1
v_mfma_f32_16x16x32_bf16 v[64:67], a[0:3], a[100:103], v[64:67]
ds_read_b64_tr_b16 a[28:29], v5 offset:25088
s_add_u32 s45, s10, 0x4c00000
v_mfma_f32_16x16x32_bf16 v[72:75], a[0:3], a[104:107], v[72:75]
ds_read_b64_tr_b16 a[30:31], v5 offset:29184
s_xor_b32 s53, s45, 0x8000
v_mfma_f32_16x16x32_bf16 v[72:75], a[4:7], a[120:123], v[72:75]
s_add_u32 s46, s10, 0x5000000
s_xor_b32 s54, s46, 0xc000
v_and_b32 v18, 16, v0
v_mfma_f32_16x16x32_bf16 v[80:83], a[4:7], a[124:127], v[80:83]
v_lshrrev_b32 v19, 5, v0
v_lshlrev_b32 v19, 4, v19
v_mfma_f32_16x16x32_bf16 v[80:83], a[0:3], a[108:111], v[80:83]
buffer_load_dwordx4 a[196:199], v3, s[88:91], s101 offen offset:1024 sc1
v_mfma_f32_16x16x32_bf16 v[84:87], a[8:11], a[108:111], v[84:87]
ds_read_b64_tr_b16 a[0:1], v4 offset:17152
v_lshl_add_u32 v18, v18, 1, v19
v_mfma_f32_16x16x32_bf16 v[84:87], a[12:15], a[124:127], v[84:87]
ds_read_b64_tr_b16 a[2:3], v4 offset:21248
v_lshl_add_u32 v2, v6, 9, v18
v_mfma_f32_16x16x32_bf16 v[76:79], a[12:15], a[120:123], v[76:79]
ds_read_b64_tr_b16 a[4:5], v4 offset:25344
v_add_u32 v15, 0x10000, v4
v_mfma_f32_16x16x32_bf16 v[76:79], a[8:11], a[104:107], v[76:79]
ds_read_b64_tr_b16 a[6:7], v4 offset:29440
v_add_u32 v19, 0x10000, v5
v_mfma_f32_16x16x32_bf16 v[68:71], a[8:11], a[100:103], v[68:71]
buffer_load_dwordx4 a[200:203], v3, s[88:91], s101 offen offset:2048 sc1
v_mfma_f32_16x16x32_bf16 v[68:71], a[12:15], a[116:119], v[68:71]
v_mfma_f32_16x16x32_bf16 v[60:63], a[12:15], a[112:115], v[60:63]
v_mfma_f32_16x16x32_bf16 v[60:63], a[8:11], a[96:99], v[60:63]
s_waitcnt lgkmcnt(4)
v_mfma_f32_16x16x32_bf16 v[88:91], a[16:19], a[96:99], v[88:91]
ds_read_b64_tr_b16 a[8:9], v5 offset:17152
v_mfma_f32_16x16x32_bf16 v[88:91], a[20:23], a[112:115], v[88:91]
buffer_load_dwordx4 a[204:207], v3, s[88:91], s101 offen offset:3072 sc1
v_mfma_f32_16x16x32_bf16 v[96:99], a[20:23], a[116:119], v[96:99]
ds_read_b64_tr_b16 a[10:11], v5 offset:21248
s_add_u32 s101, s101, 0x2000
v_mfma_f32_16x16x32_bf16 v[96:99], a[16:19], a[100:103], v[96:99]
ds_read_b64_tr_b16 a[12:13], v5 offset:25344
v_mfma_f32_16x16x32_bf16 v[104:107], a[16:19], a[104:107], v[104:107]
ds_read_b64_tr_b16 a[14:15], v5 offset:29440
v_mfma_f32_16x16x32_bf16 v[104:107], a[20:23], a[120:123], v[104:107]
v_mfma_f32_16x16x32_bf16 v[112:115], a[20:23], a[124:127], v[112:115]
s_waitcnt vmcnt(9)
v_mfma_f32_16x16x32_bf16 v[112:115], a[16:19], a[108:111], v[112:115]
s_barrier
s_cmp_lg_u32 s4, 0
s_cbranch_scc1 L_flag_setb
s_lshl_b32 s8, s6, 5
s_add_u32 s8, s8, s5
s_and_b32 s92, s8, 0xf8
s_mul_i32 s92, s92, 7
s_add_u32 s8, s8, s92
s_lshl_b32 s8, s8, 2
s_add_u32 s8, s8, 0x3704000
v_mov_b32 v17, 1
s_mov_b64 exec, 1
buffer_store_dword v17, off, s[88:91], s8 sc1
s_mov_b64 exec, -1
L_flag_setb:
v_mfma_f32_16x16x32_bf16 v[116:119], a[24:27], a[108:111], v[116:119]
buffer_load_dwordx4 a[208:211], v3, s[88:91], s101 offen sc1
v_mfma_f32_16x16x32_bf16 v[116:119], a[28:31], a[124:127], v[116:119]
ds_read_b64_tr_b16 a[16:17], v4 offset:16384
v_mfma_f32_16x16x32_bf16 v[108:111], a[28:31], a[120:123], v[108:111]
ds_read_b64_tr_b16 a[18:19], v4 offset:20480
v_mfma_f32_16x16x32_bf16 v[108:111], a[24:27], a[104:107], v[108:111]
buffer_load_dwordx4 a[212:215], v3, s[88:91], s101 offen offset:1024 sc1
v_mfma_f32_16x16x32_bf16 v[100:103], a[24:27], a[100:103], v[100:103]
ds_read_b64_tr_b16 a[20:21], v4 offset:24576
v_mfma_f32_16x16x32_bf16 v[100:103], a[28:31], a[116:119], v[100:103]
ds_read_b64_tr_b16 a[22:23], v4 offset:28672
v_mfma_f32_16x16x32_bf16 v[92:95], a[28:31], a[112:115], v[92:95]
v_mfma_f32_16x16x32_bf16 v[92:95], a[24:27], a[96:99], v[92:95]
s_waitcnt lgkmcnt(4)
v_mfma_f32_16x16x32_bf16 v[120:123], a[0:3], a[96:99], v[120:123]
buffer_load_dwordx4 a[216:219], v3, s[88:91], s101 offen offset:2048 sc1
v_mfma_f32_16x16x32_bf16 v[120:123], a[4:7], a[112:115], v[120:123]
ds_read_b64_tr_b16 a[24:25], v5 offset:16384
v_mfma_f32_16x16x32_bf16 v[128:131], a[4:7], a[116:119], v[128:131]
ds_read_b64_tr_b16 a[26:27], v5 offset:20480
v_mfma_f32_16x16x32_bf16 v[128:131], a[0:3], a[100:103], v[128:131]
ds_read_b64_tr_b16 a[28:29], v5 offset:24576
v_mfma_f32_16x16x32_bf16 v[136:139], a[0:3], a[104:107], v[136:139]
ds_read_b64_tr_b16 a[30:31], v5 offset:28672
v_mfma_f32_16x16x32_bf16 v[136:139], a[4:7], a[120:123], v[136:139]
buffer_load_dwordx4 a[220:223], v3, s[88:91], s101 offen offset:3072 sc1
v_mfma_f32_16x16x32_bf16 v[144:147], a[4:7], a[124:127], v[144:147]
s_waitcnt vmcnt(8)
s_add_u32 m0, s17, 0x20000
s_lshl_b32 s61, s60, 3
v_mfma_f32_16x16x32_bf16 v[144:147], a[0:3], a[108:111], v[144:147]
s_barrier
s_add_u32 s62, s61, s12
v_add_u32 v12, s25, v12
v_mfma_f32_16x16x32_bf16 v[148:151], a[8:11], a[108:111], v[148:151]
ds_read_b64_tr_b16 a[0:1], v4 offset:49408
v_mfma_f32_16x16x32_bf16 v[148:151], a[12:15], a[124:127], v[148:151]
ds_read_b64_tr_b16 a[2:3], v4 offset:53504
v_mfma_f32_16x16x32_bf16 v[140:143], a[12:15], a[120:123], v[140:143]
buffer_load_dwordx4 v12, s[64:67], s61 offen lds
v_mfma_f32_16x16x32_bf16 v[140:143], a[8:11], a[104:107], v[140:143]
ds_read_b64_tr_b16 a[4:5], v4 offset:57600
v_add_u32 v13, s25, v13
v_mfma_f32_16x16x32_bf16 v[132:135], a[8:11], a[100:103], v[132:135]
ds_read_b64_tr_b16 a[6:7], v4 offset:61696
v_mfma_f32_16x16x32_bf16 v[132:135], a[12:15], a[116:119], v[132:135]
v_mfma_f32_16x16x32_bf16 v[124:127], a[12:15], a[112:115], v[124:127]
s_waitcnt lgkmcnt(4)
v_mfma_f32_16x16x32_bf16 v[124:127], a[8:11], a[96:99], v[124:127]
buffer_load_dwordx4 v13, s[64:67], s61 offen offset:1024 lds
v_mfma_f32_16x16x32_bf16 v[24:27], a[16:19], a[96:99], v[24:27]
ds_read_b64_tr_b16 a[8:9], v5 offset:49408
v_mfma_f32_16x16x32_bf16 v[24:27], a[20:23], a[112:115], v[24:27]
ds_read_b64_tr_b16 a[10:11], v5 offset:53504
v_mfma_f32_16x16x32_bf16 v[32:35], a[20:23], a[116:119], v[32:35]
ds_read_b64_tr_b16 a[12:13], v5 offset:57600
v_mfma_f32_16x16x32_bf16 v[32:35], a[16:19], a[100:103], v[32:35]
ds_read_b64_tr_b16 a[14:15], v5 offset:61696
v_mfma_f32_16x16x32_bf16 v[40:43], a[16:19], a[104:107], v[40:43]
buffer_load_dwordx4 v12, s[64:67], s62 offen offset:2048 lds
v_mfma_f32_16x16x32_bf16 v[40:43], a[20:23], a[120:123], v[40:43]
v_mfma_f32_16x16x32_bf16 v[48:51], a[20:23], a[124:127], v[48:51]
v_mfma_f32_16x16x32_bf16 v[48:51], a[16:19], a[108:111], v[48:51]
v_mfma_f32_16x16x32_bf16 v[52:55], a[24:27], a[108:111], v[52:55]
ds_read_b64_tr_b16 a[16:17], v4 offset:49664
v_mfma_f32_16x16x32_bf16 v[52:55], a[28:31], a[124:127], v[52:55]
ds_read_b64_tr_b16 a[18:19], v4 offset:53760
v_mfma_f32_16x16x32_bf16 v[44:47], a[28:31], a[120:123], v[44:47]
buffer_load_dwordx4 v13, s[64:67], s62 offen offset:3072 lds
v_mfma_f32_16x16x32_bf16 v[44:47], a[24:27], a[104:107], v[44:47]
ds_read_b64_tr_b16 a[20:21], v4 offset:57856
v_mfma_f32_16x16x32_bf16 v[36:39], a[24:27], a[100:103], v[36:39]
ds_read_b64_tr_b16 a[22:23], v4 offset:61952
v_mfma_f32_16x16x32_bf16 v[36:39], a[28:31], a[116:119], v[36:39]
v_mfma_f32_16x16x32_bf16 v[28:31], a[28:31], a[112:115], v[28:31]
v_mfma_f32_16x16x32_bf16 v[28:31], a[24:27], a[96:99], v[28:31]
s_waitcnt lgkmcnt(4)
L_p4_join:
v_mfma_f32_16x16x32_bf16 v[56:59], a[0:3], a[160:163], v[56:59]
ds_read_b64_tr_b16 a[24:25], v5 offset:49664
s_add_u32 s60, s60, s57
v_mfma_f32_16x16x32_bf16 v[56:59], a[4:7], a[176:179], v[56:59]
ds_read_b64_tr_b16 a[26:27], v5 offset:53760
s_and_b32 s60, s60, 0x1c000
v_mfma_f32_16x16x32_bf16 v[64:67], a[4:7], a[180:183], v[64:67]
ds_read_b64_tr_b16 a[28:29], v5 offset:57856
s_or_b32 s60, s60, 0x20000
v_mfma_f32_16x16x32_bf16 v[64:67], a[0:3], a[164:167], v[64:67]
ds_read_b64_tr_b16 a[30:31], v5 offset:61952
s_add_u32 s101, s63, s60
v_mfma_f32_16x16x32_bf16 v[72:75], a[0:3], a[168:171], v[72:75]
buffer_load_dwordx4 a[224:227], v3, s[88:91], s101 offen sc1
v_mfma_f32_16x16x32_bf16 v[72:75], a[4:7], a[184:187], v[72:75]
v_mfma_f32_16x16x32_bf16 v[80:83], a[4:7], a[188:191], v[80:83]
v_mfma_f32_16x16x32_bf16 v[80:83], a[0:3], a[172:175], v[80:83]
v_mfma_f32_16x16x32_bf16 v[84:87], a[8:11], a[172:175], v[84:87]
ds_read_b64_tr_b16 a[0:1], v4 offset:49920
v_mfma_f32_16x16x32_bf16 v[84:87], a[12:15], a[188:191], v[84:87]
buffer_load_dwordx4 a[228:231], v3, s[88:91], s101 offen offset:1024 sc1
v_mfma_f32_16x16x32_bf16 v[76:79], a[12:15], a[184:187], v[76:79]
ds_read_b64_tr_b16 a[2:3], v4 offset:54016
v_mfma_f32_16x16x32_bf16 v[76:79], a[8:11], a[168:171], v[76:79]
ds_read_b64_tr_b16 a[4:5], v4 offset:58112
v_mfma_f32_16x16x32_bf16 v[68:71], a[8:11], a[164:167], v[68:71]
ds_read_b64_tr_b16 a[6:7], v4 offset:62208
v_mfma_f32_16x16x32_bf16 v[68:71], a[12:15], a[180:183], v[68:71]
buffer_load_dwordx4 a[232:235], v3, s[88:91], s101 offen offset:2048 sc1
v_mfma_f32_16x16x32_bf16 v[60:63], a[12:15], a[176:179], v[60:63]
v_mfma_f32_16x16x32_bf16 v[60:63], a[8:11], a[160:163], v[60:63]
s_waitcnt lgkmcnt(4)
v_mfma_f32_16x16x32_bf16 v[88:91], a[16:19], a[160:163], v[88:91]
ds_read_b64_tr_b16 a[8:9], v5 offset:49920
v_mfma_f32_16x16x32_bf16 v[88:91], a[20:23], a[176:179], v[88:91]
ds_read_b64_tr_b16 a[10:11], v5 offset:54016
v_mfma_f32_16x16x32_bf16 v[96:99], a[20:23], a[180:183], v[96:99]
buffer_load_dwordx4 a[236:239], v3, s[88:91], s101 offen offset:3072 sc1
v_mfma_f32_16x16x32_bf16 v[96:99], a[16:19], a[164:167], v[96:99]
ds_read_b64_tr_b16 a[12:13], v5 offset:58112
s_add_u32 s101, s101, 0x2000
v_mfma_f32_16x16x32_bf16 v[104:107], a[16:19], a[168:171], v[104:107]
ds_read_b64_tr_b16 a[14:15], v5 offset:62208
v_mfma_f32_16x16x32_bf16 v[104:107], a[20:23], a[184:187], v[104:107]
v_mfma_f32_16x16x32_bf16 v[112:115], a[20:23], a[188:191], v[112:115]
v_mfma_f32_16x16x32_bf16 v[112:115], a[16:19], a[172:175], v[112:115]
buffer_load_dwordx4 a[240:243], v3, s[88:91], s101 offen sc1
v_mfma_f32_16x16x32_bf16 v[116:119], a[24:27], a[172:175], v[116:119]
ds_read_b64_tr_b16 a[16:17], v4 offset:49152
v_mfma_f32_16x16x32_bf16 v[116:119], a[28:31], a[188:191], v[116:119]
ds_read_b64_tr_b16 a[18:19], v4 offset:53248
v_mfma_f32_16x16x32_bf16 v[108:111], a[28:31], a[184:187], v[108:111]
ds_read_b64_tr_b16 a[20:21], v4 offset:57344
v_mfma_f32_16x16x32_bf16 v[108:111], a[24:27], a[168:171], v[108:111]
buffer_load_dwordx4 a[244:247], v3, s[88:91], s101 offen offset:1024 sc1
v_mfma_f32_16x16x32_bf16 v[100:103], a[24:27], a[164:167], v[100:103]
ds_read_b64_tr_b16 a[22:23], v4 offset:61440
v_mfma_f32_16x16x32_bf16 v[100:103], a[28:31], a[180:183], v[100:103]
v_mfma_f32_16x16x32_bf16 v[92:95], a[28:31], a[176:179], v[92:95]
v_mfma_f32_16x16x32_bf16 v[92:95], a[24:27], a[160:163], v[92:95]
s_waitcnt lgkmcnt(4)
v_mfma_f32_16x16x32_bf16 v[120:123], a[0:3], a[160:163], v[120:123]
buffer_load_dwordx4 a[248:251], v3, s[88:91], s101 offen offset:2048 sc1
v_mfma_f32_16x16x32_bf16 v[120:123], a[4:7], a[176:179], v[120:123]
ds_read_b64_tr_b16 a[24:25], v5 offset:49152
v_mfma_f32_16x16x32_bf16 v[128:131], a[4:7], a[180:183], v[128:131]
ds_read_b64_tr_b16 a[26:27], v5 offset:53248
v_mfma_f32_16x16x32_bf16 v[128:131], a[0:3], a[164:167], v[128:131]
ds_read_b64_tr_b16 a[28:29], v5 offset:57344
v_mfma_f32_16x16x32_bf16 v[136:139], a[0:3], a[168:171], v[136:139]
buffer_load_dwordx4 a[252:255], v3, s[88:91], s101 offen offset:3072 sc1
v_mfma_f32_16x16x32_bf16 v[136:139], a[4:7], a[184:187], v[136:139]
ds_read_b64_tr_b16 a[30:31], v5 offset:61440
s_add_u32 m0, s17, 0x24000
v_mfma_f32_16x16x32_bf16 v[144:147], a[4:7], a[188:191], v[144:147]
s_waitcnt vmcnt(8)
s_lshl_b32 s61, s60, 3
s_add_u32 s62, s61, s12
v_mfma_f32_16x16x32_bf16 v[144:147], a[0:3], a[172:175], v[144:147]
s_barrier
v_mfma_f32_16x16x32_bf16 v[148:151], a[8:11], a[172:175], v[148:151]
ds_read_b64_tr_b16 a[0:1], v15 offset:256
v_mfma_f32_16x16x32_bf16 v[148:151], a[12:15], a[188:191], v[148:151]
buffer_load_dwordx4 v12, s[64:67], s61 offen lds
v_mfma_f32_16x16x32_bf16 v[140:143], a[12:15], a[184:187], v[140:143]
ds_read_b64_tr_b16 a[2:3], v15 offset:4352
v_mfma_f32_16x16x32_bf16 v[140:143], a[8:11], a[168:171], v[140:143]
ds_read_b64_tr_b16 a[4:5], v15 offset:8448
v_mfma_f32_16x16x32_bf16 v[132:135], a[8:11], a[164:167], v[132:135]
ds_read_b64_tr_b16 a[6:7], v15 offset:12544
v_mfma_f32_16x16x32_bf16 v[132:135], a[12:15], a[180:183], v[132:135]
v_mfma_f32_16x16x32_bf16 v[124:127], a[12:15], a[176:179], v[124:127]
buffer_load_dwordx4 v13, s[64:67], s61 offen offset:1024 lds
v_mfma_f32_16x16x32_bf16 v[124:127], a[8:11], a[160:163], v[124:127]
s_waitcnt lgkmcnt(4)
v_mfma_f32_16x16x32_bf16 v[24:27], a[16:19], a[160:163], v[24:27]
ds_read_b64_tr_b16 a[8:9], v19 offset:256
v_mfma_f32_16x16x32_bf16 v[24:27], a[20:23], a[176:179], v[24:27]
ds_read_b64_tr_b16 a[10:11], v19 offset:4352
v_mfma_f32_16x16x32_bf16 v[32:35], a[20:23], a[180:183], v[32:35]
buffer_load_dwordx4 v12, s[64:67], s62 offen offset:2048 lds
v_mfma_f32_16x16x32_bf16 v[32:35], a[16:19], a[164:167], v[32:35]
ds_read_b64_tr_b16 a[12:13], v19 offset:8448
v_mfma_f32_16x16x32_bf16 v[40:43], a[16:19], a[168:171], v[40:43]
ds_read_b64_tr_b16 a[14:15], v19 offset:12544
v_mfma_f32_16x16x32_bf16 v[40:43], a[20:23], a[184:187], v[40:43]
v_mfma_f32_16x16x32_bf16 v[48:51], a[20:23], a[188:191], v[48:51]
v_mfma_f32_16x16x32_bf16 v[48:51], a[16:19], a[172:175], v[48:51]
buffer_load_dwordx4 v13, s[64:67], s62 offen offset:3072 lds
v_mfma_f32_16x16x32_bf16 v[52:55], a[24:27], a[172:175], v[52:55]
ds_read_b64_tr_b16 a[16:17], v15 offset:512
v_mfma_f32_16x16x32_bf16 v[52:55], a[28:31], a[188:191], v[52:55]
buffer_load_dword v8, v6, s[88:91], s9 offen offset:0 sc1
v_mfma_f32_16x16x32_bf16 v[44:47], a[28:31], a[184:187], v[44:47]
ds_read_b64_tr_b16 a[18:19], v15 offset:4608
v_mfma_f32_16x16x32_bf16 v[44:47], a[24:27], a[168:171], v[44:47]
buffer_load_dword v9, v6, s[88:91], s9 offen offset:64 sc1
v_mfma_f32_16x16x32_bf16 v[36:39], a[24:27], a[164:167], v[36:39]
ds_read_b64_tr_b16 a[20:21], v15 offset:8704
L_padC0:
s_cmp_eq_u32 s95, 1
s_cbranch_scc1 L_padC2
v_mfma_f32_16x16x32_bf16 v[36:39], a[28:31], a[180:183], v[36:39]
buffer_load_dword v10, v6, s[88:91], s9 offen offset:128 sc1
v_mfma_f32_16x16x32_bf16 v[28:31], a[28:31], a[176:179], v[28:31]
ds_read_b64_tr_b16 a[22:23], v15 offset:12800
s_waitcnt lgkmcnt(4)
v_mfma_f32_16x16x32_bf16 v[28:31], a[24:27], a[160:163], v[28:31]
buffer_load_dword v11, v6, s[88:91], s9 offen offset:192 sc1
v_mfma_f32_16x16x32_bf16 v[160:163], a[0:3], a[192:195], 0
ds_read_b64_tr_b16 a[24:25], v19 offset:512
s_add_u32 s60, s60, s58
s_and_b32 s60, s60, 0x1c000
v_mfma_f32_16x16x32_bf16 v[160:163], a[4:7], a[208:211], v[160:163]
ds_read_b64_tr_b16 a[26:27], v19 offset:4608
s_or_b32 s60, s60, 0x20000
v_mfma_f32_16x16x32_bf16 v[168:171], a[4:7], a[212:215], 0
ds_read_b64_tr_b16 a[28:29], v19 offset:8704
s_add_u32 s101, s63, s60
v_mfma_f32_16x16x32_bf16 v[168:171], a[0:3], a[196:199], v[168:171]
buffer_load_dwordx4 a[64:67], v3, s[88:91], s101 offen sc1
v_mfma_f32_16x16x32_bf16 v[176:179], a[0:3], a[200:203], 0
ds_read_b64_tr_b16 a[30:31], v19 offset:12800
v_mfma_f32_16x16x32_bf16 v[176:179], a[4:7], a[216:219], v[176:179]
v_mfma_f32_16x16x32_bf16 v[184:187], a[4:7], a[220:223], 0
buffer_load_dwordx4 a[68:71], v3, s[88:91], s101 offen offset:1024 sc1
v_mfma_f32_16x16x32_bf16 v[184:187], a[0:3], a[204:207], v[184:187]
v_mfma_f32_16x16x32_bf16 v[188:191], a[8:11], a[204:207], 0
ds_read_b64_tr_b16 a[0:1], v15 offset:768
v_mfma_f32_16x16x32_bf16 v[188:191], a[12:15], a[220:223], v[188:191]
buffer_load_dwordx4 a[72:75], v3, s[88:91], s101 offen offset:2048 sc1
v_mfma_f32_16x16x32_bf16 v[180:183], a[12:15], a[216:219], 0
ds_read_b64_tr_b16 a[2:3], v15 offset:4864
v_mfma_f32_16x16x32_bf16 v[180:183], a[8:11], a[200:203], v[180:183]
ds_read_b64_tr_b16 a[4:5], v15 offset:8960
v_mfma_f32_16x16x32_bf16 v[172:175], a[8:11], a[196:199], 0
buffer_load_dwordx4 a[76:79], v3, s[88:91], s101 offen offset:3072 sc1
v_mfma_f32_16x16x32_bf16 v[172:175], a[12:15], a[212:215], v[172:175]
ds_read_b64_tr_b16 a[6:7], v15 offset:13056
s_add_u32 s101, s101, 0x2000
v_mfma_f32_16x16x32_bf16 v[164:167], a[12:15], a[208:211], 0
v_mfma_f32_16x16x32_bf16 v[164:167], a[8:11], a[192:195], v[164:167]
s_waitcnt lgkmcnt(4)
v_mfma_f32_16x16x32_bf16 v[192:195], a[16:19], a[192:195], 0
buffer_load_dwordx4 a[80:83], v3, s[88:91], s101 offen sc1
v_mfma_f32_16x16x32_bf16 v[192:195], a[20:23], a[208:211], v[192:195]
ds_read_b64_tr_b16 a[8:9], v19 offset:768
v_mfma_f32_16x16x32_bf16 v[200:203], a[20:23], a[212:215], 0
ds_read_b64_tr_b16 a[10:11], v19 offset:4864
v_mfma_f32_16x16x32_bf16 v[200:203], a[16:19], a[196:199], v[200:203]
buffer_load_dwordx4 a[84:87], v3, s[88:91], s101 offen offset:1024 sc1
v_mfma_f32_16x16x32_bf16 v[208:211], a[16:19], a[200:203], 0
ds_read_b64_tr_b16 a[12:13], v19 offset:8960
v_mfma_f32_16x16x32_bf16 v[208:211], a[20:23], a[216:219], v[208:211]
ds_read_b64_tr_b16 a[14:15], v19 offset:13056
v_mfma_f32_16x16x32_bf16 v[216:219], a[20:23], a[220:223], 0
v_mfma_f32_16x16x32_bf16 v[216:219], a[16:19], a[204:207], v[216:219]
buffer_load_dwordx4 a[88:91], v3, s[88:91], s101 offen offset:2048 sc1
v_mfma_f32_16x16x32_bf16 v[220:223], a[24:27], a[204:207], 0
ds_read_b64_tr_b16 a[16:17], v15 offset:0
v_mfma_f32_16x16x32_bf16 v[220:223], a[28:31], a[220:223], v[220:223]
ds_read_b64_tr_b16 a[18:19], v15 offset:4096
v_mfma_f32_16x16x32_bf16 v[212:215], a[28:31], a[216:219], 0
ds_read_b64_tr_b16 a[20:21], v15 offset:8192
v_mfma_f32_16x16x32_bf16 v[212:215], a[24:27], a[200:203], v[212:215]
ds_read_b64_tr_b16 a[22:23], v15 offset:12288
v_mfma_f32_16x16x32_bf16 v[204:207], a[24:27], a[196:199], 0
buffer_load_dwordx4 a[92:95], v3, s[88:91], s101 offen offset:3072 sc1
v_mfma_f32_16x16x32_bf16 v[204:207], a[28:31], a[212:215], v[204:207]
s_add_u32 m0, s17, 0x10000
s_lshl_b32 s61, s60, 3
s_add_u32 s62, s61, s12
v_mfma_f32_16x16x32_bf16 v[196:199], a[28:31], a[208:211], 0
v_mfma_f32_16x16x32_bf16 v[196:199], a[24:27], a[192:195], v[196:199]
s_waitcnt lgkmcnt(4)
v_mfma_f32_16x16x32_bf16 v[224:227], a[0:3], a[192:195], 0
buffer_load_dwordx4 v12, s[64:67], s61 offen lds
v_mfma_f32_16x16x32_bf16 v[224:227], a[4:7], a[208:211], v[224:227]
ds_read_b64_tr_b16 a[24:25], v19 offset:0
v_mfma_f32_16x16x32_bf16 v[232:235], a[4:7], a[212:215], 0
ds_read_b64_tr_b16 a[26:27], v19 offset:4096
v_mfma_f32_16x16x32_bf16 v[232:235], a[0:3], a[196:199], v[232:235]
ds_read_b64_tr_b16 a[28:29], v19 offset:8192
v_mfma_f32_16x16x32_bf16 v[240:243], a[0:3], a[200:203], 0
ds_read_b64_tr_b16 a[30:31], v19 offset:12288
v_mfma_f32_16x16x32_bf16 v[240:243], a[4:7], a[216:219], v[240:243]
buffer_load_dwordx4 v13, s[64:67], s61 offen offset:1024 lds
v_mfma_f32_16x16x32_bf16 v[248:251], a[4:7], a[220:223], 0
s_waitcnt vmcnt(14)
v_mfma_f32_16x16x32_bf16 v[248:251], a[0:3], a[204:207], v[248:251]
s_barrier
v_mfma_f32_16x16x32_bf16 v[252:255], a[8:11], a[204:207], 0
ds_read_b64_tr_b16 a[0:1], v15 offset:16640
v_mfma_f32_16x16x32_bf16 v[252:255], a[12:15], a[220:223], v[252:255]
buffer_load_dwordx4 v12, s[64:67], s62 offen offset:2048 lds
v_mfma_f32_16x16x32_bf16 v[244:247], a[12:15], a[216:219], 0
ds_read_b64_tr_b16 a[2:3], v15 offset:20736
v_mfma_f32_16x16x32_bf16 v[244:247], a[8:11], a[200:203], v[244:247]
ds_read_b64_tr_b16 a[4:5], v15 offset:24832
v_mfma_f32_16x16x32_bf16 v[236:239], a[8:11], a[196:199], 0
ds_read_b64_tr_b16 a[6:7], v15 offset:28928
v_mfma_f32_16x16x32_bf16 v[236:239], a[12:15], a[212:215], v[236:239]
v_mfma_f32_16x16x32_bf16 v[228:231], a[12:15], a[208:211], 0
buffer_load_dwordx4 v13, s[64:67], s62 offen offset:3072 lds
v_mfma_f32_16x16x32_bf16 v[228:231], a[8:11], a[192:195], v[228:231]
s_waitcnt lgkmcnt(4)
s_add_u32 s60, s60, s59
s_and_b32 s60, s60, 0x1c000
v_mfma_f32_16x16x32_bf16 a[32:35], a[16:19], a[192:195], 0
ds_read_b64_tr_b16 a[8:9], v19 offset:16640
s_or_b32 s60, s60, 0x20000
v_mfma_f32_16x16x32_bf16 a[32:35], a[20:23], a[208:211], a[32:35]
ds_read_b64_tr_b16 a[10:11], v19 offset:20736
s_add_u32 s101, s63, s60
v_mfma_f32_16x16x32_bf16 a[40:43], a[20:23], a[212:215], 0
ds_read_b64_tr_b16 a[12:13], v19 offset:24832
v_mfma_f32_16x16x32_bf16 a[40:43], a[16:19], a[196:199], a[40:43]
buffer_load_dwordx4 a[96:99], v3, s[88:91], s101 offen sc1
v_mfma_f32_16x16x32_bf16 a[48:51], a[16:19], a[200:203], 0
ds_read_b64_tr_b16 a[14:15], v19 offset:28928
v_mfma_f32_16x16x32_bf16 a[48:51], a[20:23], a[216:219], a[48:51]
v_mfma_f32_16x16x32_bf16 v[152:155], a[20:23], a[220:223], 0
v_mfma_f32_16x16x32_bf16 v[152:155], a[16:19], a[204:207], v[152:155]
buffer_load_dwordx4 a[100:103], v3, s[88:91], s101 offen offset:1024 sc1
v_mfma_f32_16x16x32_bf16 v[156:159], a[24:27], a[204:207], 0
ds_read_b64_tr_b16 a[16:17], v15 offset:16896
v_mfma_f32_16x16x32_bf16 v[156:159], a[28:31], a[220:223], v[156:159]
ds_read_b64_tr_b16 a[18:19], v15 offset:20992
v_mfma_f32_16x16x32_bf16 a[52:55], a[28:31], a[216:219], 0
ds_read_b64_tr_b16 a[20:21], v15 offset:25088
v_mfma_f32_16x16x32_bf16 a[52:55], a[24:27], a[200:203], a[52:55]
ds_read_b64_tr_b16 a[22:23], v15 offset:29184
v_mfma_f32_16x16x32_bf16 a[44:47], a[24:27], a[196:199], 0
buffer_load_dwordx4 a[104:107], v3, s[88:91], s101 offen offset:2048 sc1
v_mfma_f32_16x16x32_bf16 a[44:47], a[28:31], a[212:215], a[44:47]
v_mfma_f32_16x16x32_bf16 a[36:39], a[28:31], a[208:211], 0
v_mfma_f32_16x16x32_bf16 a[36:39], a[24:27], a[192:195], a[36:39]
s_waitcnt lgkmcnt(4)
v_mfma_f32_16x16x32_bf16 v[160:163], a[0:3], a[224:227], v[160:163]
buffer_load_dwordx4 a[108:111], v3, s[88:91], s101 offen offset:3072 sc1
v_mfma_f32_16x16x32_bf16 v[160:163], a[4:7], a[240:243], v[160:163]
ds_read_b64_tr_b16 a[24:25], v19 offset:16896
s_add_u32 s101, s101, 0x2000
v_mfma_f32_16x16x32_bf16 v[168:171], a[4:7], a[244:247], v[168:171]
ds_read_b64_tr_b16 a[26:27], v19 offset:20992
v_mfma_f32_16x16x32_bf16 v[168:171], a[0:3], a[228:231], v[168:171]
ds_read_b64_tr_b16 a[28:29], v19 offset:25088
v_mfma_f32_16x16x32_bf16 v[176:179], a[0:3], a[232:235], v[176:179]
ds_read_b64_tr_b16 a[30:31], v19 offset:29184
v_mfma_f32_16x16x32_bf16 v[176:179], a[4:7], a[248:251], v[176:179]
buffer_load_dwordx4 a[112:115], v3, s[88:91], s101 offen sc1
v_mfma_f32_16x16x32_bf16 v[184:187], a[4:7], a[252:255], v[184:187]
v_mfma_f32_16x16x32_bf16 v[184:187], a[0:3], a[236:239], v[184:187]
v_mfma_f32_16x16x32_bf16 v[188:191], a[8:11], a[236:239], v[188:191]
ds_read_b64_tr_b16 a[0:1], v15 offset:17152
v_mfma_f32_16x16x32_bf16 v[188:191], a[12:15], a[252:255], v[188:191]
ds_read_b64_tr_b16 a[2:3], v15 offset:21248
v_mfma_f32_16x16x32_bf16 v[180:183], a[12:15], a[248:251], v[180:183]
buffer_load_dwordx4 a[116:119], v3, s[88:91], s101 offen offset:1024 sc1
v_mfma_f32_16x16x32_bf16 v[180:183], a[8:11], a[232:235], v[180:183]
ds_read_b64_tr_b16 a[4:5], v15 offset:25344
v_mfma_f32_16x16x32_bf16 v[172:175], a[8:11], a[228:231], v[172:175]
ds_read_b64_tr_b16 a[6:7], v15 offset:29440
v_mfma_f32_16x16x32_bf16 v[172:175], a[12:15], a[244:247], v[172:175]
v_mfma_f32_16x16x32_bf16 v[164:167], a[12:15], a[240:243], v[164:167]
buffer_load_dwordx4 a[120:123], v3, s[88:91], s101 offen offset:2048 sc1
v_mfma_f32_16x16x32_bf16 v[164:167], a[8:11], a[224:227], v[164:167]
s_waitcnt lgkmcnt(4)
v_mfma_f32_16x16x32_bf16 v[192:195], a[16:19], a[224:227], v[192:195]
ds_read_b64_tr_b16 a[8:9], v19 offset:17152
v_mfma_f32_16x16x32_bf16 v[192:195], a[20:23], a[240:243], v[192:195]
ds_read_b64_tr_b16 a[10:11], v19 offset:21248
v_mfma_f32_16x16x32_bf16 v[200:203], a[20:23], a[244:247], v[200:203]
ds_read_b64_tr_b16 a[12:13], v19 offset:25344
v_mfma_f32_16x16x32_bf16 v[200:203], a[16:19], a[228:231], v[200:203]
buffer_load_dwordx4 a[124:127], v3, s[88:91], s101 offen offset:3072 sc1
v_mfma_f32_16x16x32_bf16 v[208:211], a[16:19], a[232:235], v[208:211]
ds_read_b64_tr_b16 a[14:15], v19 offset:29440
s_add_u32 m0, s17, 0x14000
v_mfma_f32_16x16x32_bf16 v[208:211], a[20:23], a[248:251], v[208:211]
s_lshl_b32 s61, s60, 3
s_add_u32 s62, s61, s12
v_mfma_f32_16x16x32_bf16 v[216:219], a[20:23], a[252:255], v[216:219]
v_mfma_f32_16x16x32_bf16 v[216:219], a[16:19], a[236:239], v[216:219]
buffer_load_dwordx4 v12, s[64:67], s61 offen lds
v_mfma_f32_16x16x32_bf16 v[220:223], a[24:27], a[236:239], v[220:223]
ds_read_b64_tr_b16 a[16:17], v15 offset:16384
v_mfma_f32_16x16x32_bf16 v[220:223], a[28:31], a[252:255], v[220:223]
ds_read_b64_tr_b16 a[18:19], v15 offset:20480
v_mfma_f32_16x16x32_bf16 v[212:215], a[28:31], a[248:251], v[212:215]
ds_read_b64_tr_b16 a[20:21], v15 offset:24576
v_mfma_f32_16x16x32_bf16 v[212:215], a[24:27], a[232:235], v[212:215]
ds_read_b64_tr_b16 a[22:23], v15 offset:28672
v_mfma_f32_16x16x32_bf16 v[204:207], a[24:27], a[228:231], v[204:207]
buffer_load_dwordx4 v13, s[64:67], s61 offen offset:1024 lds
v_mfma_f32_16x16x32_bf16 v[204:207], a[28:31], a[244:247], v[204:207]
v_mfma_f32_16x16x32_bf16 v[196:199], a[28:31], a[240:243], v[196:199]
v_mfma_f32_16x16x32_bf16 v[196:199], a[24:27], a[224:227], v[196:199]
s_waitcnt lgkmcnt(4)
v_mfma_f32_16x16x32_bf16 v[224:227], a[0:3], a[224:227], v[224:227]
ds_read_b64_tr_b16 a[24:25], v19 offset:16384
v_mfma_f32_16x16x32_bf16 v[224:227], a[4:7], a[240:243], v[224:227]
buffer_load_dwordx4 v12, s[64:67], s62 offen offset:2048 lds
v_mfma_f32_16x16x32_bf16 v[232:235], a[4:7], a[244:247], v[232:235]
ds_read_b64_tr_b16 a[26:27], v19 offset:20480
v_mfma_f32_16x16x32_bf16 v[232:235], a[0:3], a[228:231], v[232:235]
ds_read_b64_tr_b16 a[28:29], v19 offset:24576
v_mfma_f32_16x16x32_bf16 v[240:243], a[0:3], a[232:235], v[240:243]
ds_read_b64_tr_b16 a[30:31], v19 offset:28672
v_mfma_f32_16x16x32_bf16 v[240:243], a[4:7], a[248:251], v[240:243]
buffer_load_dwordx4 v13, s[64:67], s62 offen offset:3072 lds
v_mfma_f32_16x16x32_bf16 v[248:251], a[4:7], a[252:255], v[248:251]
s_waitcnt vmcnt(12)
s_add_u32 s60, s60, s56
s_and_b32 s60, s60, 0x1c000
v_mfma_f32_16x16x32_bf16 v[248:251], a[0:3], a[236:239], v[248:251]
s_barrier
s_or_b32 s60, s60, 0x20000
s_add_u32 s101, s63, s60
v_mfma_f32_16x16x32_bf16 v[252:255], a[8:11], a[236:239], v[252:255]
ds_read_b64_tr_b16 a[0:1], v4 offset:256
v_mfma_f32_16x16x32_bf16 v[252:255], a[12:15], a[252:255], v[252:255]
ds_read_b64_tr_b16 a[2:3], v4 offset:4352
v_mfma_f32_16x16x32_bf16 v[244:247], a[12:15], a[248:251], v[244:247]
buffer_load_dwordx4 a[128:131], v3, s[88:91], s101 offen sc1
v_mfma_f32_16x16x32_bf16 v[244:247], a[8:11], a[232:235], v[244:247]
ds_read_b64_tr_b16 a[4:5], v4 offset:8448
v_mfma_f32_16x16x32_bf16 v[236:239], a[8:11], a[228:231], v[236:239]
ds_read_b64_tr_b16 a[6:7], v4 offset:12544
v_mfma_f32_16x16x32_bf16 v[236:239], a[12:15], a[244:247], v[236:239]
v_mfma_f32_16x16x32_bf16 v[228:231], a[12:15], a[240:243], v[228:231]
buffer_load_dwordx4 a[132:135], v3, s[88:91], s101 offen offset:1024 sc1
v_mfma_f32_16x16x32_bf16 v[228:231], a[8:11], a[224:227], v[228:231]
s_waitcnt lgkmcnt(4)
v_mfma_f32_16x16x32_bf16 a[32:35], a[16:19], a[224:227], a[32:35]
ds_read_b64_tr_b16 a[8:9], v5 offset:256
v_mfma_f32_16x16x32_bf16 a[32:35], a[20:23], a[240:243], a[32:35]
ds_read_b64_tr_b16 a[10:11], v5 offset:4352
v_mfma_f32_16x16x32_bf16 a[40:43], a[20:23], a[244:247], a[40:43]
ds_read_b64_tr_b16 a[12:13], v5 offset:8448
v_mfma_f32_16x16x32_bf16 a[40:43], a[16:19], a[228:231], a[40:43]
buffer_load_dwordx4 a[136:139], v3, s[88:91], s101 offen offset:2048 sc1
v_mfma_f32_16x16x32_bf16 a[48:51], a[16:19], a[232:235], a[48:51]
ds_read_b64_tr_b16 a[14:15], v5 offset:12544
v_mfma_f32_16x16x32_bf16 a[48:51], a[20:23], a[248:251], a[48:51]
v_mfma_f32_16x16x32_bf16 v[152:155], a[20:23], a[252:255], v[152:155]
v_mfma_f32_16x16x32_bf16 v[152:155], a[16:19], a[236:239], v[152:155]
v_mfma_f32_16x16x32_bf16 v[156:159], a[24:27], a[236:239], v[156:159]
buffer_load_dwordx4 a[140:143], v3, s[88:91], s101 offen offset:3072 sc1
v_mfma_f32_16x16x32_bf16 v[156:159], a[28:31], a[252:255], v[156:159]
ds_read_b64_tr_b16 a[16:17], v4 offset:512
s_add_u32 s101, s101, 0x2000
v_mfma_f32_16x16x32_bf16 a[52:55], a[28:31], a[248:251], a[52:55]
ds_read_b64_tr_b16 a[18:19], v4 offset:4608
v_mfma_f32_16x16x32_bf16 a[52:55], a[24:27], a[232:235], a[52:55]
ds_read_b64_tr_b16 a[20:21], v4 offset:8704
v_mfma_f32_16x16x32_bf16 a[44:47], a[24:27], a[228:231], a[44:47]
buffer_load_dwordx4 a[144:147], v3, s[88:91], s101 offen sc1
v_mfma_f32_16x16x32_bf16 a[44:47], a[28:31], a[244:247], a[44:47]
ds_read_b64_tr_b16 a[22:23], v4 offset:12800
v_mfma_f32_16x16x32_bf16 a[36:39], a[28:31], a[240:243], a[36:39]
v_mfma_f32_16x16x32_bf16 a[36:39], a[24:27], a[224:227], a[36:39]
s_waitcnt lgkmcnt(4)
v_mfma_f32_16x16x32_bf16 v[160:163], a[0:3], a[64:67], v[160:163]
ds_read_b64_tr_b16 a[24:25], v5 offset:512
v_mfma_f32_16x16x32_bf16 v[160:163], a[4:7], a[80:83], v[160:163]
buffer_load_dwordx4 a[148:151], v3, s[88:91], s101 offen offset:1024 sc1
v_mfma_f32_16x16x32_bf16 v[168:171], a[4:7], a[84:87], v[168:171]
ds_read_b64_tr_b16 a[26:27], v5 offset:4608
v_mfma_f32_16x16x32_bf16 v[168:171], a[0:3], a[68:71], v[168:171]
ds_read_b64_tr_b16 a[28:29], v5 offset:8704
v_mfma_f32_16x16x32_bf16 v[176:179], a[0:3], a[72:75], v[176:179]
ds_read_b64_tr_b16 a[30:31], v5 offset:12800
v_mfma_f32_16x16x32_bf16 v[176:179], a[4:7], a[88:91], v[176:179]
buffer_load_dwordx4 a[152:155], v3, s[88:91], s101 offen offset:2048 sc1
v_mfma_f32_16x16x32_bf16 v[184:187], a[4:7], a[92:95], v[184:187]
v_mfma_f32_16x16x32_bf16 v[184:187], a[0:3], a[76:79], v[184:187]
v_mfma_f32_16x16x32_bf16 v[188:191], a[8:11], a[76:79], v[188:191]
ds_read_b64_tr_b16 a[0:1], v4 offset:768
v_mfma_f32_16x16x32_bf16 v[188:191], a[12:15], a[92:95], v[188:191]
ds_read_b64_tr_b16 a[2:3], v4 offset:4864
v_mfma_f32_16x16x32_bf16 v[180:183], a[12:15], a[88:91], v[180:183]
buffer_load_dwordx4 a[156:159], v3, s[88:91], s101 offen offset:3072 sc1
v_mfma_f32_16x16x32_bf16 v[180:183], a[8:11], a[72:75], v[180:183]
ds_read_b64_tr_b16 a[4:5], v4 offset:8960
s_add_u32 m0, s17, 0x18000
v_mfma_f32_16x16x32_bf16 v[172:175], a[8:11], a[68:71], v[172:175]
ds_read_b64_tr_b16 a[6:7], v4 offset:13056
s_lshl_b32 s61, s60, 3
v_mfma_f32_16x16x32_bf16 v[172:175], a[12:15], a[84:87], v[172:175]
s_add_u32 s62, s61, s12
v_mfma_f32_16x16x32_bf16 v[164:167], a[12:15], a[80:83], v[164:167]
s_waitcnt lgkmcnt(4)
v_mfma_f32_16x16x32_bf16 v[164:167], a[8:11], a[64:67], v[164:167]
buffer_load_dwordx4 v12, s[64:67], s61 offen lds
v_mfma_f32_16x16x32_bf16 v[192:195], a[16:19], a[64:67], v[192:195]
ds_read_b64_tr_b16 a[8:9], v5 offset:768
v_mfma_f32_16x16x32_bf16 v[192:195], a[20:23], a[80:83], v[192:195]
ds_read_b64_tr_b16 a[10:11], v5 offset:4864
v_mfma_f32_16x16x32_bf16 v[200:203], a[20:23], a[84:87], v[200:203]
ds_read_b64_tr_b16 a[12:13], v5 offset:8960
v_mfma_f32_16x16x32_bf16 v[200:203], a[16:19], a[68:71], v[200:203]
buffer_load_dwordx4 v13, s[64:67], s61 offen offset:1024 lds
v_mfma_f32_16x16x32_bf16 v[208:211], a[16:19], a[72:75], v[208:211]
ds_read_b64_tr_b16 a[14:15], v5 offset:13056
v_mfma_f32_16x16x32_bf16 v[208:211], a[20:23], a[88:91], v[208:211]
v_mfma_f32_16x16x32_bf16 v[216:219], a[20:23], a[92:95], v[216:219]
v_mfma_f32_16x16x32_bf16 v[216:219], a[16:19], a[76:79], v[216:219]
v_mfma_f32_16x16x32_bf16 v[220:223], a[24:27], a[76:79], v[220:223]
buffer_load_dwordx4 v12, s[64:67], s62 offen offset:2048 lds
v_mfma_f32_16x16x32_bf16 v[220:223], a[28:31], a[92:95], v[220:223]
ds_read_b64_tr_b16 a[16:17], v4 offset:0
v_mfma_f32_16x16x32_bf16 v[212:215], a[28:31], a[88:91], v[212:215]
ds_read_b64_tr_b16 a[18:19], v4 offset:4096
v_mfma_f32_16x16x32_bf16 v[212:215], a[24:27], a[72:75], v[212:215]
ds_read_b64_tr_b16 a[20:21], v4 offset:8192
v_mfma_f32_16x16x32_bf16 v[204:207], a[24:27], a[68:71], v[204:207]
buffer_load_dwordx4 v13, s[64:67], s62 offen offset:3072 lds
v_mfma_f32_16x16x32_bf16 v[204:207], a[28:31], a[84:87], v[204:207]
ds_read_b64_tr_b16 a[22:23], v4 offset:12288
s_add_u32 s60, s60, s57
v_mfma_f32_16x16x32_bf16 v[196:199], a[28:31], a[80:83], v[196:199]
s_and_b32 s60, s60, 0x1c000
s_or_b32 s60, s60, 0x20000
s_add_u32 s101, s63, s60
v_mfma_f32_16x16x32_bf16 v[196:199], a[24:27], a[64:67], v[196:199]
s_waitcnt lgkmcnt(4)
v_mfma_f32_16x16x32_bf16 v[224:227], a[0:3], a[64:67], v[224:227]
ds_read_b64_tr_b16 a[24:25], v5 offset:0
v_mfma_f32_16x16x32_bf16 v[224:227], a[4:7], a[80:83], v[224:227]
buffer_load_dwordx4 a[160:163], v3, s[88:91], s101 offen sc1
v_mfma_f32_16x16x32_bf16 v[232:235], a[4:7], a[84:87], v[232:235]
ds_read_b64_tr_b16 a[26:27], v5 offset:4096
v_mfma_f32_16x16x32_bf16 v[232:235], a[0:3], a[68:71], v[232:235]
ds_read_b64_tr_b16 a[28:29], v5 offset:8192
v_mfma_f32_16x16x32_bf16 v[240:243], a[0:3], a[72:75], v[240:243]
ds_read_b64_tr_b16 a[30:31], v5 offset:12288
v_mfma_f32_16x16x32_bf16 v[240:243], a[4:7], a[88:91], v[240:243]
v_mfma_f32_16x16x32_bf16 v[248:251], a[4:7], a[92:95], v[248:251]
s_waitcnt vmcnt(13)
v_mfma_f32_16x16x32_bf16 v[248:251], a[0:3], a[76:79], v[248:251]
s_barrier
v_mfma_f32_16x16x32_bf16 v[252:255], a[8:11], a[76:79], v[252:255]
buffer_load_dwordx4 a[164:167], v3, s[88:91], s101 offen offset:1024 sc1
v_mfma_f32_16x16x32_bf16 v[252:255], a[12:15], a[92:95], v[252:255]
ds_read_b64_tr_b16 a[0:1], v4 offset:16640
v_sub_f32 v20, 1.0, v8
v_mfma_f32_16x16x32_bf16 v[244:247], a[12:15], a[88:91], v[244:247]
ds_read_b64_tr_b16 a[2:3], v4 offset:20736
v_sub_f32 v21, 1.0, v9
v_mfma_f32_16x16x32_bf16 v[244:247], a[8:11], a[72:75], v[244:247]
buffer_load_dwordx4 a[168:171], v3, s[88:91], s101 offen offset:2048 sc1
v_mfma_f32_16x16x32_bf16 v[236:239], a[8:11], a[68:71], v[236:239]
ds_read_b64_tr_b16 a[4:5], v4 offset:24832
v_sub_f32 v22, 1.0, v10
v_mfma_f32_16x16x32_bf16 v[236:239], a[12:15], a[84:87], v[236:239]
ds_read_b64_tr_b16 a[6:7], v4 offset:28928
v_sub_f32 v23, 1.0, v11
v_mfma_f32_16x16x32_bf16 v[228:231], a[12:15], a[80:83], v[228:231]
s_waitcnt lgkmcnt(4)
v_mul_f32 v24, v20, v24
v_mul_f32 v25, v20, v25
v_mfma_f32_16x16x32_bf16 v[228:231], a[8:11], a[64:67], v[228:231]
buffer_load_dwordx4 a[172:175], v3, s[88:91], s101 offen offset:3072 sc1
v_mfma_f32_16x16x32_bf16 a[32:35], a[16:19], a[64:67], a[32:35]
ds_read_b64_tr_b16 a[8:9], v5 offset:16640
s_add_u32 s101, s101, 0x2000
v_mfma_f32_16x16x32_bf16 a[32:35], a[20:23], a[80:83], a[32:35]
ds_read_b64_tr_b16 a[10:11], v5 offset:20736
v_mul_f32 v26, v20, v26
v_mfma_f32_16x16x32_bf16 a[40:43], a[20:23], a[84:87], a[40:43]
ds_read_b64_tr_b16 a[12:13], v5 offset:24832
v_mul_f32 v27, v20, v27
v_mfma_f32_16x16x32_bf16 a[40:43], a[16:19], a[68:71], a[40:43]
buffer_load_dwordx4 a[176:179], v3, s[88:91], s101 offen sc1
v_mfma_f32_16x16x32_bf16 a[48:51], a[16:19], a[72:75], a[48:51]
ds_read_b64_tr_b16 a[14:15], v5 offset:28928
v_mul_f32 v32, v21, v32
v_mfma_f32_16x16x32_bf16 a[48:51], a[20:23], a[88:91], a[48:51]
v_mul_f32 v33, v21, v33
v_mul_f32 v34, v21, v34
v_mfma_f32_16x16x32_bf16 v[152:155], a[20:23], a[92:95], v[152:155]
v_mul_f32 v35, v21, v35
v_mul_f32 v40, v22, v40
v_mfma_f32_16x16x32_bf16 v[152:155], a[16:19], a[76:79], v[152:155]
v_mul_f32 v41, v22, v41
v_mul_f32 v42, v22, v42
v_mfma_f32_16x16x32_bf16 v[156:159], a[24:27], a[76:79], v[156:159]
buffer_load_dwordx4 a[180:183], v3, s[88:91], s101 offen offset:1024 sc1
v_mfma_f32_16x16x32_bf16 v[156:159], a[28:31], a[92:95], v[156:159]
ds_read_b64_tr_b16 a[16:17], v4 offset:16896
v_mul_f32 v43, v22, v43
v_mfma_f32_16x16x32_bf16 a[52:55], a[28:31], a[88:91], a[52:55]
ds_read_b64_tr_b16 a[18:19], v4 offset:20992
v_mul_f32 v48, v23, v48
v_mfma_f32_16x16x32_bf16 a[52:55], a[24:27], a[72:75], a[52:55]
ds_read_b64_tr_b16 a[20:21], v4 offset:25088
v_mul_f32 v49, v23, v49
v_mfma_f32_16x16x32_bf16 a[44:47], a[24:27], a[68:71], a[44:47]
ds_read_b64_tr_b16 a[22:23], v4 offset:29184
v_mul_f32 v50, v23, v50
v_mfma_f32_16x16x32_bf16 a[44:47], a[28:31], a[84:87], a[44:47]
buffer_load_dwordx4 a[184:187], v3, s[88:91], s101 offen offset:2048 sc1
v_mfma_f32_16x16x32_bf16 a[36:39], a[28:31], a[80:83], a[36:39]
v_mul_f32 v51, v23, v51
v_mul_f32 v28, v20, v28
v_mfma_f32_16x16x32_bf16 a[36:39], a[24:27], a[64:67], a[36:39]
s_waitcnt lgkmcnt(4)
v_mul_f32 v29, v20, v29
v_mul_f32 v30, v20, v30
v_mfma_f32_16x16x32_bf16 v[160:163], a[0:3], a[96:99], v[160:163]
ds_read_b64_tr_b16 a[24:25], v5 offset:16896
v_mul_f32 v31, v20, v31
v_mfma_f32_16x16x32_bf16 v[160:163], a[4:7], a[112:115], v[160:163]
buffer_load_dwordx4 a[188:191], v3, s[88:91], s101 offen offset:3072 sc1
v_mfma_f32_16x16x32_bf16 v[168:171], a[4:7], a[116:119], v[168:171]
ds_read_b64_tr_b16 a[26:27], v5 offset:20992
s_add_u32 m0, s17, 0x1c000
v_mfma_f32_16x16x32_bf16 v[168:171], a[0:3], a[100:103], v[168:171]
ds_read_b64_tr_b16 a[28:29], v5 offset:25088
s_lshl_b32 s61, s60, 3
v_mfma_f32_16x16x32_bf16 v[176:179], a[0:3], a[104:107], v[176:179]
ds_read_b64_tr_b16 a[30:31], v5 offset:29184
s_add_u32 s62, s61, s12
v_mfma_f32_16x16x32_bf16 v[176:179], a[4:7], a[120:123], v[176:179]
v_mul_f32 v36, v21, v36
v_mul_f32 v37, v21, v37
v_mfma_f32_16x16x32_bf16 v[184:187], a[4:7], a[124:127], v[184:187]
buffer_load_dwordx4 v12, s[64:67], s61 offen lds
v_mfma_f32_16x16x32_bf16 v[184:187], a[0:3], a[108:111], v[184:187]
v_mul_f32 v38, v21, v38
v_mul_f32 v39, v21, v39
v_mfma_f32_16x16x32_bf16 v[188:191], a[8:11], a[108:111], v[188:191]
ds_read_b64_tr_b16 a[0:1], v4 offset:17152
v_mul_f32 v44, v22, v44
v_mfma_f32_16x16x32_bf16 v[188:191], a[12:15], a[124:127], v[188:191]
ds_read_b64_tr_b16 a[2:3], v4 offset:21248
v_mul_f32 v45, v22, v45
v_mfma_f32_16x16x32_bf16 v[180:183], a[12:15], a[120:123], v[180:183]
buffer_load_dwordx4 v13, s[64:67], s61 offen offset:1024 lds
v_mfma_f32_16x16x32_bf16 v[180:183], a[8:11], a[104:107], v[180:183]
ds_read_b64_tr_b16 a[4:5], v4 offset:25344
v_mul_f32 v46, v22, v46
v_mfma_f32_16x16x32_bf16 v[172:175], a[8:11], a[100:103], v[172:175]
ds_read_b64_tr_b16 a[6:7], v4 offset:29440
v_mul_f32 v47, v22, v47
v_mfma_f32_16x16x32_bf16 v[172:175], a[12:15], a[116:119], v[172:175]
v_mul_f32 v52, v23, v52
v_mul_f32 v53, v23, v53
v_mfma_f32_16x16x32_bf16 v[164:167], a[12:15], a[112:115], v[164:167]
s_waitcnt lgkmcnt(4)
v_mul_f32 v54, v23, v54
v_mul_f32 v55, v23, v55
v_mfma_f32_16x16x32_bf16 v[164:167], a[8:11], a[96:99], v[164:167]
buffer_load_dwordx4 v12, s[64:67], s62 offen offset:2048 lds
v_mfma_f32_16x16x32_bf16 v[192:195], a[16:19], a[96:99], v[192:195]
ds_read_b64_tr_b16 a[8:9], v5 offset:17152
v_mul_f32 v56, v20, v56
v_mfma_f32_16x16x32_bf16 v[192:195], a[20:23], a[112:115], v[192:195]
ds_read_b64_tr_b16 a[10:11], v5 offset:21248
v_mul_f32 v57, v20, v57
v_mfma_f32_16x16x32_bf16 v[200:203], a[20:23], a[116:119], v[200:203]
ds_read_b64_tr_b16 a[12:13], v5 offset:25344
v_mul_f32 v58, v20, v58
v_mfma_f32_16x16x32_bf16 v[200:203], a[16:19], a[100:103], v[200:203]
ds_read_b64_tr_b16 a[14:15], v5 offset:29440
v_mul_f32 v59, v20, v59
v_mfma_f32_16x16x32_bf16 v[208:211], a[16:19], a[104:107], v[208:211]
buffer_load_dwordx4 v13, s[64:67], s62 offen offset:3072 lds
v_mfma_f32_16x16x32_bf16 v[208:211], a[20:23], a[120:123], v[208:211]
s_add_u32 s60, s60, s58
s_and_b32 s60, s60, 0x1c000
s_or_b32 s60, s60, 0x20000
v_mfma_f32_16x16x32_bf16 v[216:219], a[20:23], a[124:127], v[216:219]
s_add_u32 s101, s63, s60
v_mul_f32 v64, v21, v64
v_mul_f32 v65, v21, v65
v_mfma_f32_16x16x32_bf16 v[216:219], a[16:19], a[108:111], v[216:219]
v_mul_f32 v66, v21, v66
v_mul_f32 v67, v21, v67
v_mfma_f32_16x16x32_bf16 v[220:223], a[24:27], a[108:111], v[220:223]
buffer_load_dwordx4 a[192:195], v3, s[88:91], s101 offen sc1
v_mfma_f32_16x16x32_bf16 v[220:223], a[28:31], a[124:127], v[220:223]
ds_read_b64_tr_b16 a[16:17], v4 offset:16384
v_mul_f32 v72, v22, v72
v_mfma_f32_16x16x32_bf16 v[212:215], a[28:31], a[120:123], v[212:215]
ds_read_b64_tr_b16 a[18:19], v4 offset:20480
v_mul_f32 v73, v22, v73
v_mfma_f32_16x16x32_bf16 v[212:215], a[24:27], a[104:107], v[212:215]
ds_read_b64_tr_b16 a[20:21], v4 offset:24576
v_mul_f32 v74, v22, v74
v_mfma_f32_16x16x32_bf16 v[204:207], a[24:27], a[100:103], v[204:207]
ds_read_b64_tr_b16 a[22:23], v4 offset:28672
v_mul_f32 v75, v22, v75
v_mfma_f32_16x16x32_bf16 v[204:207], a[28:31], a[116:119], v[204:207]
buffer_load_dwordx4 a[196:199], v3, s[88:91], s101 offen offset:1024 sc1
v_mfma_f32_16x16x32_bf16 v[196:199], a[28:31], a[112:115], v[196:199]
v_mul_f32 v80, v23, v80
v_mul_f32 v81, v23, v81
v_mfma_f32_16x16x32_bf16 v[196:199], a[24:27], a[96:99], v[196:199]
s_waitcnt lgkmcnt(4)
v_mul_f32 v82, v23, v82
v_mul_f32 v83, v23, v83
v_mfma_f32_16x16x32_bf16 v[224:227], a[0:3], a[96:99], v[224:227]
ds_read_b64_tr_b16 a[24:25], v5 offset:16384
v_mul_f32 v60, v20, v60
v_mfma_f32_16x16x32_bf16 v[224:227], a[4:7], a[112:115], v[224:227]
buffer_load_dwordx4 a[200:203], v3, s[88:91], s101 offen offset:2048 sc1
v_mfma_f32_16x16x32_bf16 v[232:235], a[4:7], a[116:119], v[232:235]
ds_read_b64_tr_b16 a[26:27], v5 offset:20480
v_mul_f32 v61, v20, v61
v_mfma_f32_16x16x32_bf16 v[232:235], a[0:3], a[100:103], v[232:235]
ds_read_b64_tr_b16 a[28:29], v5 offset:24576
v_mul_f32 v62, v20, v62
v_mfma_f32_16x16x32_bf16 v[240:243], a[0:3], a[104:107], v[240:243]
ds_read_b64_tr_b16 a[30:31], v5 offset:28672
v_mul_f32 v63, v20, v63
v_mfma_f32_16x16x32_bf16 v[240:243], a[4:7], a[120:123], v[240:243]
v_mul_f32 v68, v21, v68
v_mul_f32 v69, v21, v69
v_mfma_f32_16x16x32_bf16 v[248:251], a[4:7], a[124:127], v[248:251]
s_waitcnt vmcnt(15)
v_mul_f32 v70, v21, v70
v_mul_f32 v71, v21, v71
v_mfma_f32_16x16x32_bf16 v[248:251], a[0:3], a[108:111], v[248:251]
s_barrier
v_mul_f32 v76, v22, v76
v_mul_f32 v77, v22, v77
v_mfma_f32_16x16x32_bf16 v[252:255], a[8:11], a[108:111], v[252:255]
buffer_load_dwordx4 a[204:207], v3, s[88:91], s101 offen offset:3072 sc1
v_mfma_f32_16x16x32_bf16 v[252:255], a[12:15], a[124:127], v[252:255]
ds_read_b64_tr_b16 a[0:1], v4 offset:33024
s_add_u32 s101, s101, 0x2000
v_mfma_f32_16x16x32_bf16 v[244:247], a[12:15], a[120:123], v[244:247]
ds_read_b64_tr_b16 a[2:3], v4 offset:37120
v_mul_f32 v78, v22, v78
v_mfma_f32_16x16x32_bf16 v[244:247], a[8:11], a[104:107], v[244:247]
ds_read_b64_tr_b16 a[4:5], v4 offset:41216
v_mul_f32 v79, v22, v79
v_mfma_f32_16x16x32_bf16 v[236:239], a[8:11], a[100:103], v[236:239]
buffer_load_dwordx4 a[208:211], v3, s[88:91], s101 offen sc1
v_mfma_f32_16x16x32_bf16 v[236:239], a[12:15], a[116:119], v[236:239]
ds_read_b64_tr_b16 a[6:7], v4 offset:45312
v_mul_f32 v84, v23, v84
v_mfma_f32_16x16x32_bf16 v[228:231], a[12:15], a[112:115], v[228:231]
s_waitcnt lgkmcnt(4)
v_mul_f32 v85, v23, v85
v_mul_f32 v86, v23, v86
v_mfma_f32_16x16x32_bf16 v[228:231], a[8:11], a[96:99], v[228:231]
buffer_load_dwordx4 a[212:215], v3, s[88:91], s101 offen offset:1024 sc1
v_mfma_f32_16x16x32_bf16 a[32:35], a[16:19], a[96:99], a[32:35]
ds_read_b64_tr_b16 a[8:9], v5 offset:33024
v_mul_f32 v87, v23, v87
v_mfma_f32_16x16x32_bf16 a[32:35], a[20:23], a[112:115], a[32:35]
ds_read_b64_tr_b16 a[10:11], v5 offset:37120
v_mul_f32 v88, v20, v88
v_mfma_f32_16x16x32_bf16 a[40:43], a[20:23], a[116:119], a[40:43]
ds_read_b64_tr_b16 a[12:13], v5 offset:41216
v_mul_f32 v89, v20, v89
v_mfma_f32_16x16x32_bf16 a[40:43], a[16:19], a[100:103], a[40:43]
ds_read_b64_tr_b16 a[14:15], v5 offset:45312
v_mul_f32 v90, v20, v90
v_mfma_f32_16x16x32_bf16 a[48:51], a[16:19], a[104:107], a[48:51]
buffer_load_dwordx4 a[216:219], v3, s[88:91], s101 offen offset:2048 sc1
v_mfma_f32_16x16x32_bf16 a[48:51], a[20:23], a[120:123], a[48:51]
v_mul_f32 v91, v20, v91
v_mul_f32 v96, v21, v96
v_mfma_f32_16x16x32_bf16 v[152:155], a[20:23], a[124:127], v[152:155]
v_mul_f32 v97, v21, v97
v_mul_f32 v98, v21, v98
v_mfma_f32_16x16x32_bf16 v[152:155], a[16:19], a[108:111], v[152:155]
L_padC1:
s_cmp_eq_u32 s95, 1
s_cbranch_scc1 L_padC3
v_mul_f32 v99, v21, v99
v_mul_f32 v104, v22, v104
v_mfma_f32_16x16x32_bf16 v[156:159], a[24:27], a[108:111], v[156:159]
buffer_load_dwordx4 a[220:223], v3, s[88:91], s101 offen offset:3072 sc1
v_mfma_f32_16x16x32_bf16 v[156:159], a[28:31], a[124:127], v[156:159]
ds_read_b64_tr_b16 a[16:17], v4 offset:33280
s_add_u32 m0, s17, 0x20000
v_mfma_f32_16x16x32_bf16 a[52:55], a[28:31], a[120:123], a[52:55]
ds_read_b64_tr_b16 a[18:19], v4 offset:37376
s_lshl_b32 s61, s60, 3
v_mfma_f32_16x16x32_bf16 a[52:55], a[24:27], a[104:107], a[52:55]
ds_read_b64_tr_b16 a[20:21], v4 offset:41472
s_add_u32 s62, s61, s12
v_mfma_f32_16x16x32_bf16 a[44:47], a[24:27], a[100:103], a[44:47]
ds_read_b64_tr_b16 a[22:23], v4 offset:45568
v_mul_f32 v105, v22, v105
v_mfma_f32_16x16x32_bf16 a[44:47], a[28:31], a[116:119], a[44:47]
buffer_load_dwordx4 v12, s[64:67], s61 offen lds
v_mfma_f32_16x16x32_bf16 a[36:39], a[28:31], a[112:115], a[36:39]
v_mul_f32 v106, v22, v106
v_mul_f32 v107, v22, v107
v_mfma_f32_16x16x32_bf16 a[36:39], a[24:27], a[96:99], a[36:39]
s_waitcnt lgkmcnt(4)
v_mul_f32 v112, v23, v112
v_mul_f32 v113, v23, v113
v_mfma_f32_16x16x32_bf16 v[160:163], a[0:3], a[128:131], v[160:163]
ds_read_b64_tr_b16 a[24:25], v5 offset:33280
v_mul_f32 v114, v23, v114
v_mfma_f32_16x16x32_bf16 v[160:163], a[4:7], a[144:147], v[160:163]
ds_read_b64_tr_b16 a[26:27], v5 offset:37376
v_mul_f32 v115, v23, v115
v_mfma_f32_16x16x32_bf16 v[168:171], a[4:7], a[148:151], v[168:171]
buffer_load_dwordx4 v13, s[64:67], s61 offen offset:1024 lds
v_mfma_f32_16x16x32_bf16 v[168:171], a[0:3], a[132:135], v[168:171]
ds_read_b64_tr_b16 a[28:29], v5 offset:41472
v_mul_f32 v92, v20, v92
v_mfma_f32_16x16x32_bf16 v[176:179], a[0:3], a[136:139], v[176:179]
ds_read_b64_tr_b16 a[30:31], v5 offset:45568
v_mul_f32 v93, v20, v93
v_mfma_f32_16x16x32_bf16 v[176:179], a[4:7], a[152:155], v[176:179]
v_mul_f32 v94, v20, v94
v_mul_f32 v95, v20, v95
v_mfma_f32_16x16x32_bf16 v[184:187], a[4:7], a[156:159], v[184:187]
buffer_load_dwordx4 v12, s[64:67], s62 offen offset:2048 lds
v_mfma_f32_16x16x32_bf16 v[184:187], a[0:3], a[140:143], v[184:187]
v_mul_f32 v100, v21, v100
v_mul_f32 v101, v21, v101
v_mfma_f32_16x16x32_bf16 v[188:191], a[8:11], a[140:143], v[188:191]
ds_read_b64_tr_b16 a[0:1], v4 offset:33536
v_mul_f32 v102, v21, v102
v_mfma_f32_16x16x32_bf16 v[188:191], a[12:15], a[156:159], v[188:191]
ds_read_b64_tr_b16 a[2:3], v4 offset:37632
v_mul_f32 v103, v21, v103
v_mfma_f32_16x16x32_bf16 v[180:183], a[12:15], a[152:155], v[180:183]
ds_read_b64_tr_b16 a[4:5], v4 offset:41728
v_mul_f32 v108, v22, v108
v_mfma_f32_16x16x32_bf16 v[180:183], a[8:11], a[136:139], v[180:183]
buffer_load_dwordx4 v13, s[64:67], s62 offen offset:3072 lds
v_mfma_f32_16x16x32_bf16 v[172:175], a[8:11], a[132:135], v[172:175]
ds_read_b64_tr_b16 a[6:7], v4 offset:45824
s_add_u32 s60, s60, s59
v_mfma_f32_16x16x32_bf16 v[172:175], a[12:15], a[148:151], v[172:175]
s_and_b32 s60, s60, 0x1c000
s_or_b32 s60, s60, 0x20000
s_add_u32 s101, s63, s60
v_mfma_f32_16x16x32_bf16 v[164:167], a[12:15], a[144:147], v[164:167]
s_waitcnt lgkmcnt(4)
v_mul_f32 v109, v22, v109
v_mul_f32 v110, v22, v110
v_mfma_f32_16x16x32_bf16 v[164:167], a[8:11], a[128:131], v[164:167]
buffer_load_dwordx4 a[224:227], v3, s[88:91], s101 offen sc1
v_mfma_f32_16x16x32_bf16 v[192:195], a[16:19], a[128:131], v[192:195]
ds_read_b64_tr_b16 a[8:9], v5 offset:33536
v_mul_f32 v111, v22, v111
v_mfma_f32_16x16x32_bf16 v[192:195], a[20:23], a[144:147], v[192:195]
ds_read_b64_tr_b16 a[10:11], v5 offset:37632
v_mul_f32 v116, v23, v116
v_mfma_f32_16x16x32_bf16 v[200:203], a[20:23], a[148:151], v[200:203]
ds_read_b64_tr_b16 a[12:13], v5 offset:41728
v_mul_f32 v117, v23, v117
v_mfma_f32_16x16x32_bf16 v[200:203], a[16:19], a[132:135], v[200:203]
ds_read_b64_tr_b16 a[14:15], v5 offset:45824
v_mul_f32 v118, v23, v118
v_mfma_f32_16x16x32_bf16 v[208:211], a[16:19], a[136:139], v[208:211]
buffer_load_dwordx4 a[228:231], v3, s[88:91], s101 offen offset:1024 sc1
v_mfma_f32_16x16x32_bf16 v[208:211], a[20:23], a[152:155], v[208:211]
v_mul_f32 v119, v23, v119
v_mul_f32 v120, v20, v120
v_mfma_f32_16x16x32_bf16 v[216:219], a[20:23], a[156:159], v[216:219]
buffer_load_dword v14, v1, s[88:91], s24 offen sc1
v_mfma_f32_16x16x32_bf16 v[216:219], a[16:19], a[140:143], v[216:219]
v_mul_f32 v121, v20, v121
v_mul_f32 v122, v20, v122
v_mfma_f32_16x16x32_bf16 v[220:223], a[24:27], a[140:143], v[220:223]
ds_read_b64_tr_b16 a[16:17], v4 offset:32768
v_mul_f32 v123, v20, v123
v_mfma_f32_16x16x32_bf16 v[220:223], a[28:31], a[156:159], v[220:223]
buffer_load_dwordx4 a[232:235], v3, s[88:91], s101 offen offset:2048 sc1
v_mfma_f32_16x16x32_bf16 v[212:215], a[28:31], a[152:155], v[212:215]
ds_read_b64_tr_b16 a[18:19], v4 offset:36864
v_mul_f32 v128, v21, v128
v_mfma_f32_16x16x32_bf16 v[212:215], a[24:27], a[136:139], v[212:215]
ds_read_b64_tr_b16 a[20:21], v4 offset:40960
v_mul_f32 v129, v21, v129
v_mfma_f32_16x16x32_bf16 v[204:207], a[24:27], a[132:135], v[204:207]
ds_read_b64_tr_b16 a[22:23], v4 offset:45056
v_mul_f32 v130, v21, v130
v_mfma_f32_16x16x32_bf16 v[204:207], a[28:31], a[148:151], v[204:207]
buffer_load_dwordx4 a[236:239], v3, s[88:91], s101 offen offset:3072 sc1
v_mfma_f32_16x16x32_bf16 v[196:199], a[28:31], a[144:147], v[196:199]
s_add_u32 s101, s101, 0x2000
v_mul_f32 v131, v21, v131
v_mul_f32 v136, v22, v136
v_mfma_f32_16x16x32_bf16 v[196:199], a[24:27], a[128:131], v[196:199]
s_waitcnt lgkmcnt(4)
v_mul_f32 v137, v22, v137
v_mul_f32 v138, v22, v138
v_mfma_f32_16x16x32_bf16 v[224:227], a[0:3], a[128:131], v[224:227]
ds_read_b64_tr_b16 a[24:25], v5 offset:32768
v_mul_f32 v139, v22, v139
v_mfma_f32_16x16x32_bf16 v[224:227], a[4:7], a[144:147], v[224:227]
ds_read_b64_tr_b16 a[26:27], v5 offset:36864
v_mul_f32 v144, v23, v144
v_mfma_f32_16x16x32_bf16 v[232:235], a[4:7], a[148:151], v[232:235]
buffer_load_dwordx4 a[240:243], v3, s[88:91], s101 offen sc1
v_mfma_f32_16x16x32_bf16 v[232:235], a[0:3], a[132:135], v[232:235]
ds_read_b64_tr_b16 a[28:29], v5 offset:40960
v_mul_f32 v145, v23, v145
v_mfma_f32_16x16x32_bf16 v[240:243], a[0:3], a[136:139], v[240:243]
ds_read_b64_tr_b16 a[30:31], v5 offset:45056
v_mul_f32 v146, v23, v146
v_mfma_f32_16x16x32_bf16 v[240:243], a[4:7], a[152:155], v[240:243]
v_mul_f32 v147, v23, v147
v_mul_f32 v124, v20, v124
v_mfma_f32_16x16x32_bf16 v[248:251], a[4:7], a[156:159], v[248:251]
s_waitcnt vmcnt(18)
v_mul_f32 v125, v20, v125
v_mul_f32 v126, v20, v126
v_mfma_f32_16x16x32_bf16 v[248:251], a[0:3], a[140:143], v[248:251]
s_barrier
v_mul_f32 v127, v20, v127
v_mul_f32 v132, v21, v132
v_mfma_f32_16x16x32_bf16 v[252:255], a[8:11], a[140:143], v[252:255]
buffer_load_dwordx4 a[244:247], v3, s[88:91], s101 offen offset:1024 sc1
v_mfma_f32_16x16x32_bf16 v[252:255], a[12:15], a[156:159], v[252:255]
ds_read_b64_tr_b16 a[0:1], v4 offset:49408
v_mul_f32 v133, v21, v133
v_mfma_f32_16x16x32_bf16 v[244:247], a[12:15], a[152:155], v[244:247]
ds_read_b64_tr_b16 a[2:3], v4 offset:53504
v_mul_f32 v134, v21, v134
v_mfma_f32_16x16x32_bf16 v[244:247], a[8:11], a[136:139], v[244:247]
buffer_load_dwordx4 a[248:251], v3, s[88:91], s101 offen offset:2048 sc1
v_mfma_f32_16x16x32_bf16 v[236:239], a[8:11], a[132:135], v[236:239]
ds_read_b64_tr_b16 a[4:5], v4 offset:57600
v_mul_f32 v135, v21, v135
v_mfma_f32_16x16x32_bf16 v[236:239], a[12:15], a[148:151], v[236:239]
ds_read_b64_tr_b16 a[6:7], v4 offset:61696
v_mul_f32 v140, v22, v140
v_mfma_f32_16x16x32_bf16 v[228:231], a[12:15], a[144:147], v[228:231]
v_mul_f32 v141, v22, v141
v_mul_f32 v142, v22, v142
v_mfma_f32_16x16x32_bf16 v[228:231], a[8:11], a[128:131], v[228:231]
s_waitcnt lgkmcnt(4)
v_mul_f32 v143, v22, v143
v_mul_f32 v148, v23, v148
v_mfma_f32_16x16x32_bf16 a[32:35], a[16:19], a[128:131], a[32:35]
buffer_load_dwordx4 a[252:255], v3, s[88:91], s101 offen offset:3072 sc1
v_mfma_f32_16x16x32_bf16 a[32:35], a[20:23], a[144:147], a[32:35]
ds_read_b64_tr_b16 a[8:9], v5 offset:49408
s_add_u32 m0, s17, 0x24000
v_mfma_f32_16x16x32_bf16 a[40:43], a[20:23], a[148:151], a[40:43]
ds_read_b64_tr_b16 a[10:11], v5 offset:53504
s_lshl_b32 s61, s60, 3
v_mfma_f32_16x16x32_bf16 a[40:43], a[16:19], a[132:135], a[40:43]
ds_read_b64_tr_b16 a[12:13], v5 offset:57600
s_add_u32 s62, s61, s12
v_mfma_f32_16x16x32_bf16 a[48:51], a[16:19], a[136:139], a[48:51]
buffer_load_dwordx4 v12, s[64:67], s61 offen lds
v_mfma_f32_16x16x32_bf16 a[48:51], a[20:23], a[152:155], a[48:51]
ds_read_b64_tr_b16 a[14:15], v5 offset:61696
v_mul_f32 v149, v23, v149
v_mfma_f32_16x16x32_bf16 v[152:155], a[20:23], a[156:159], v[152:155]
v_mul_f32 v150, v23, v150
v_mul_f32 v151, v23, v151
v_mfma_f32_16x16x32_bf16 v[152:155], a[16:19], a[140:143], v[152:155]
v_mfma_f32_16x16x32_bf16 v[156:159], a[24:27], a[140:143], v[156:159]
ds_read_b64_tr_b16 a[16:17], v4 offset:49664
v_mfma_f32_16x16x32_bf16 v[156:159], a[28:31], a[156:159], v[156:159]
buffer_load_dwordx4 v13, s[64:67], s61 offen offset:1024 lds
v_mfma_f32_16x16x32_bf16 a[52:55], a[28:31], a[152:155], a[52:55]
ds_read_b64_tr_b16 a[18:19], v4 offset:53760
v_mfma_f32_16x16x32_bf16 a[52:55], a[24:27], a[136:139], a[52:55]
ds_read_b64_tr_b16 a[20:21], v4 offset:57856
v_mfma_f32_16x16x32_bf16 a[44:47], a[24:27], a[132:135], a[44:47]
ds_read_b64_tr_b16 a[22:23], v4 offset:61952
v_mfma_f32_16x16x32_bf16 a[44:47], a[28:31], a[148:151], a[44:47]
buffer_load_dwordx4 v12, s[64:67], s62 offen offset:2048 lds
v_mfma_f32_16x16x32_bf16 a[36:39], a[28:31], a[144:147], a[36:39]
v_mfma_f32_16x16x32_bf16 a[36:39], a[24:27], a[128:131], a[36:39]
s_waitcnt lgkmcnt(4)
v_mfma_f32_16x16x32_bf16 v[160:163], a[0:3], a[160:163], v[160:163]
ds_read_b64_tr_b16 a[24:25], v5 offset:49664
v_mfma_f32_16x16x32_bf16 v[160:163], a[4:7], a[176:179], v[160:163]
ds_read_b64_tr_b16 a[26:27], v5 offset:53760
v_mfma_f32_16x16x32_bf16 v[168:171], a[4:7], a[180:183], v[168:171]
buffer_load_dwordx4 v13, s[64:67], s62 offen offset:3072 lds
v_mfma_f32_16x16x32_bf16 v[168:171], a[0:3], a[164:167], v[168:171]
ds_read_b64_tr_b16 a[28:29], v5 offset:57856
s_add_u32 s60, s60, s56
v_mfma_f32_16x16x32_bf16 v[176:179], a[0:3], a[168:171], v[176:179]
ds_read_b64_tr_b16 a[30:31], v5 offset:61952
s_and_b32 s60, s60, 0x1c000
v_mfma_f32_16x16x32_bf16 v[176:179], a[4:7], a[184:187], v[176:179]
s_add_u32 s101, s63, s60
v_mfma_f32_16x16x32_bf16 v[184:187], a[4:7], a[188:191], v[184:187]
s_waitcnt vmcnt(10)
s_mov_b32 s92, 200000
L_spin_db:
v_cmp_eq_u32 vcc, 0, v14
s_nop 4
s_cbranch_vccz L_spun_db
s_sub_u32 s92, s92, 1
s_cbranch_scc1 L_spun_db
s_sleep 6
buffer_load_dword v14, v1, s[88:91], s24 offen sc1
s_waitcnt vmcnt(0)
s_branch L_spin_db
L_spun_db:
v_mfma_f32_16x16x32_bf16 v[184:187], a[0:3], a[172:175], v[184:187]
buffer_load_dwordx4 a[64:67], v3, s[88:91], s101 offen sc1
v_mfma_f32_16x16x32_bf16 v[188:191], a[8:11], a[172:175], v[188:191]
ds_read_b64_tr_b16 a[0:1], v4 offset:49920
v_mfma_f32_16x16x32_bf16 v[188:191], a[12:15], a[188:191], v[188:191]
ds_read_b64_tr_b16 a[2:3], v4 offset:54016
v_mfma_f32_16x16x32_bf16 v[180:183], a[12:15], a[184:187], v[180:183]
ds_read_b64_tr_b16 a[4:5], v4 offset:58112
v_mfma_f32_16x16x32_bf16 v[180:183], a[8:11], a[168:171], v[180:183]
buffer_load_dwordx4 a[68:71], v3, s[88:91], s101 offen offset:1024 sc1
v_mfma_f32_16x16x32_bf16 v[172:175], a[8:11], a[164:167], v[172:175]
ds_read_b64_tr_b16 a[6:7], v4 offset:62208
v_mfma_f32_16x16x32_bf16 v[172:175], a[12:15], a[180:183], v[172:175]
v_mfma_f32_16x16x32_bf16 v[164:167], a[12:15], a[176:179], v[164:167]
v_mfma_f32_16x16x32_bf16 v[164:167], a[8:11], a[160:163], v[164:167]
s_waitcnt lgkmcnt(4)
v_mfma_f32_16x16x32_bf16 v[192:195], a[16:19], a[160:163], v[192:195]
buffer_load_dwordx4 a[72:75], v3, s[88:91], s101 offen offset:2048 sc1
v_mfma_f32_16x16x32_bf16 v[192:195], a[20:23], a[176:179], v[192:195]
ds_read_b64_tr_b16 a[8:9], v5 offset:49920
v_mfma_f32_16x16x32_bf16 v[200:203], a[20:23], a[180:183], v[200:203]
ds_read_b64_tr_b16 a[10:11], v5 offset:54016
v_mfma_f32_16x16x32_bf16 v[200:203], a[16:19], a[164:167], v[200:203]
ds_read_b64_tr_b16 a[12:13], v5 offset:58112
v_mfma_f32_16x16x32_bf16 v[208:211], a[16:19], a[168:171], v[208:211]
buffer_load_dwordx4 a[76:79], v3, s[88:91], s101 offen offset:3072 sc1
v_mfma_f32_16x16x32_bf16 v[208:211], a[20:23], a[184:187], v[208:211]
ds_read_b64_tr_b16 a[14:15], v5 offset:62208
s_add_u32 s101, s101, 0x2000
v_mfma_f32_16x16x32_bf16 v[216:219], a[20:23], a[188:191], v[216:219]
v_mfma_f32_16x16x32_bf16 v[216:219], a[16:19], a[172:175], v[216:219]
v_mfma_f32_16x16x32_bf16 v[220:223], a[24:27], a[172:175], v[220:223]
ds_read_b64_tr_b16 a[16:17], v4 offset:49152
v_mfma_f32_16x16x32_bf16 v[220:223], a[28:31], a[188:191], v[220:223]
buffer_load_dwordx4 a[80:83], v3, s[88:91], s101 offen sc1
v_mfma_f32_16x16x32_bf16 v[212:215], a[28:31], a[184:187], v[212:215]
ds_read_b64_tr_b16 a[18:19], v4 offset:53248
v_mfma_f32_16x16x32_bf16 v[212:215], a[24:27], a[168:171], v[212:215]
ds_read_b64_tr_b16 a[20:21], v4 offset:57344
v_mfma_f32_16x16x32_bf16 v[204:207], a[24:27], a[164:167], v[204:207]
ds_read_b64_tr_b16 a[22:23], v4 offset:61440
v_mfma_f32_16x16x32_bf16 v[204:207], a[28:31], a[180:183], v[204:207]
v_mfma_f32_16x16x32_bf16 v[196:199], a[28:31], a[176:179], v[196:199]
buffer_load_dwordx4 a[84:87], v3, s[88:91], s101 offen offset:1024 sc1
v_mfma_f32_16x16x32_bf16 v[196:199], a[24:27], a[160:163], v[196:199]
s_waitcnt lgkmcnt(4)
v_mfma_f32_16x16x32_bf16 v[224:227], a[0:3], a[160:163], v[224:227]
ds_read_b64_tr_b16 a[24:25], v5 offset:49152
v_mfma_f32_16x16x32_bf16 v[224:227], a[4:7], a[176:179], v[224:227]
ds_read_b64_tr_b16 a[26:27], v5 offset:53248
v_mfma_f32_16x16x32_bf16 v[232:235], a[4:7], a[180:183], v[232:235]
buffer_load_dwordx4 a[88:91], v3, s[88:91], s101 offen offset:2048 sc1
v_mfma_f32_16x16x32_bf16 v[232:235], a[0:3], a[164:167], v[232:235]
ds_read_b64_tr_b16 a[28:29], v5 offset:57344
v_mfma_f32_16x16x32_bf16 v[240:243], a[0:3], a[168:171], v[240:243]
ds_read_b64_tr_b16 a[30:31], v5 offset:61440
v_mfma_f32_16x16x32_bf16 v[240:243], a[4:7], a[184:187], v[240:243]
v_mfma_f32_16x16x32_bf16 v[248:251], a[4:7], a[188:191], v[248:251]
s_waitcnt vmcnt(20)
v_mfma_f32_16x16x32_bf16 v[248:251], a[0:3], a[172:175], v[248:251]
s_barrier
v_mfma_f32_16x16x32_bf16 v[252:255], a[8:11], a[172:175], v[252:255]
buffer_load_dwordx4 a[92:95], v3, s[88:91], s101 offen offset:3072 sc1
v_mfma_f32_16x16x32_bf16 v[252:255], a[12:15], a[188:191], v[252:255]
ds_read_b64_tr_b16 a[0:1], v15 offset:256
s_add_u32 m0, s17, 0x10000
v_mfma_f32_16x16x32_bf16 v[244:247], a[12:15], a[184:187], v[244:247]
ds_read_b64_tr_b16 a[2:3], v15 offset:4352
s_lshl_b32 s61, s60, 3
v_mfma_f32_16x16x32_bf16 v[244:247], a[8:11], a[168:171], v[244:247]
ds_read_b64_tr_b16 a[4:5], v15 offset:8448
s_add_u32 s62, s61, s12
v_mfma_f32_16x16x32_bf16 v[236:239], a[8:11], a[164:167], v[236:239]
buffer_load_dwordx4 v12, s[64:67], s61 offen lds
v_mfma_f32_16x16x32_bf16 v[236:239], a[12:15], a[180:183], v[236:239]
ds_read_b64_tr_b16 a[6:7], v15 offset:12544
v_mfma_f32_16x16x32_bf16 v[228:231], a[12:15], a[176:179], v[228:231]
v_mfma_f32_16x16x32_bf16 v[228:231], a[8:11], a[160:163], v[228:231]
s_waitcnt lgkmcnt(4)
v_mfma_f32_16x16x32_bf16 a[32:35], a[16:19], a[160:163], a[32:35]
buffer_load_dwordx4 v13, s[64:67], s61 offen offset:1024 lds
v_mfma_f32_16x16x32_bf16 a[32:35], a[20:23], a[176:179], a[32:35]
ds_read_b64_tr_b16 a[8:9], v19 offset:256
v_mfma_f32_16x16x32_bf16 a[40:43], a[20:23], a[180:183], a[40:43]
ds_read_b64_tr_b16 a[10:11], v19 offset:4352
v_mfma_f32_16x16x32_bf16 a[40:43], a[16:19], a[164:167], a[40:43]
ds_read_b64_tr_b16 a[12:13], v19 offset:8448
v_mfma_f32_16x16x32_bf16 a[48:51], a[16:19], a[168:171], a[48:51]
ds_read_b64_tr_b16 a[14:15], v19 offset:12544
v_mfma_f32_16x16x32_bf16 a[48:51], a[20:23], a[184:187], a[48:51]
buffer_load_dwordx4 v12, s[64:67], s62 offen offset:2048 lds
v_mfma_f32_16x16x32_bf16 v[152:155], a[20:23], a[188:191], v[152:155]
v_mfma_f32_16x16x32_bf16 v[152:155], a[16:19], a[172:175], v[152:155]
v_mfma_f32_16x16x32_bf16 v[156:159], a[24:27], a[172:175], v[156:159]
ds_read_b64_tr_b16 a[16:17], v15 offset:512
v_mfma_f32_16x16x32_bf16 v[156:159], a[28:31], a[188:191], v[156:159]
buffer_load_dwordx4 v13, s[64:67], s62 offen offset:3072 lds
v_mfma_f32_16x16x32_bf16 a[52:55], a[28:31], a[184:187], a[52:55]
ds_read_b64_tr_b16 a[18:19], v15 offset:4608
s_add_u32 s60, s60, s57
v_mfma_f32_16x16x32_bf16 a[52:55], a[24:27], a[168:171], a[52:55]
ds_read_b64_tr_b16 a[20:21], v15 offset:8704
s_and_b32 s60, s60, 0x1c000
v_mfma_f32_16x16x32_bf16 a[44:47], a[24:27], a[164:167], a[44:47]
ds_read_b64_tr_b16 a[22:23], v15 offset:12800
s_add_u32 s101, s63, s60
v_mfma_f32_16x16x32_bf16 a[44:47], a[28:31], a[180:183], a[44:47]
v_mfma_f32_16x16x32_bf16 a[36:39], a[28:31], a[176:179], a[36:39]
buffer_load_dwordx4 a[96:99], v3, s[88:91], s101 offen sc1
v_mfma_f32_16x16x32_bf16 a[36:39], a[24:27], a[160:163], a[36:39]
s_waitcnt lgkmcnt(4)
v_mfma_f32_16x16x32_bf16 v[160:163], a[0:3], a[192:195], v[160:163]
ds_read_b64_tr_b16 a[24:25], v19 offset:512
v_mfma_f32_16x16x32_bf16 v[160:163], a[4:7], a[208:211], v[160:163]
ds_read_b64_tr_b16 a[26:27], v19 offset:4608
v_mfma_f32_16x16x32_bf16 v[168:171], a[4:7], a[212:215], v[168:171]
buffer_load_dwordx4 a[100:103], v3, s[88:91], s101 offen offset:1024 sc1
v_mfma_f32_16x16x32_bf16 v[168:171], a[0:3], a[196:199], v[168:171]
ds_read_b64_tr_b16 a[28:29], v19 offset:8704
v_mfma_f32_16x16x32_bf16 v[176:179], a[0:3], a[200:203], v[176:179]
ds_read_b64_tr_b16 a[30:31], v19 offset:12800
v_mfma_f32_16x16x32_bf16 v[176:179], a[4:7], a[216:219], v[176:179]
v_mfma_f32_16x16x32_bf16 v[184:187], a[4:7], a[220:223], v[184:187]
v_mfma_f32_16x16x32_bf16 v[184:187], a[0:3], a[204:207], v[184:187]
buffer_load_dwordx4 a[104:107], v3, s[88:91], s101 offen offset:2048 sc1
v_mfma_f32_16x16x32_bf16 v[188:191], a[8:11], a[204:207], v[188:191]
ds_read_b64_tr_b16 a[0:1], v15 offset:768
v_mfma_f32_16x16x32_bf16 v[188:191], a[12:15], a[220:223], v[188:191]
ds_read_b64_tr_b16 a[2:3], v15 offset:4864
v_mfma_f32_16x16x32_bf16 v[180:183], a[12:15], a[216:219], v[180:183]
ds_read_b64_tr_b16 a[4:5], v15 offset:8960
v_mfma_f32_16x16x32_bf16 v[180:183], a[8:11], a[200:203], v[180:183]
ds_read_b64_tr_b16 a[6:7], v15 offset:13056
v_mfma_f32_16x16x32_bf16 v[172:175], a[8:11], a[196:199], v[172:175]
buffer_load_dwordx4 a[108:111], v3, s[88:91], s101 offen offset:3072 sc1
v_mfma_f32_16x16x32_bf16 v[172:175], a[12:15], a[212:215], v[172:175]
s_add_u32 s101, s101, 0x2000
v_mfma_f32_16x16x32_bf16 v[164:167], a[12:15], a[208:211], v[164:167]
v_mfma_f32_16x16x32_bf16 v[164:167], a[8:11], a[192:195], v[164:167]
s_waitcnt lgkmcnt(4)
v_mfma_f32_16x16x32_bf16 v[192:195], a[16:19], a[192:195], v[192:195]
buffer_load_dwordx4 a[112:115], v3, s[88:91], s101 offen sc1
v_mfma_f32_16x16x32_bf16 v[192:195], a[20:23], a[208:211], v[192:195]
ds_read_b64_tr_b16 a[8:9], v19 offset:768
v_mfma_f32_16x16x32_bf16 v[200:203], a[20:23], a[212:215], v[200:203]
ds_read_b64_tr_b16 a[10:11], v19 offset:4864
v_mfma_f32_16x16x32_bf16 v[200:203], a[16:19], a[196:199], v[200:203]
ds_read_b64_tr_b16 a[12:13], v19 offset:8960
v_mfma_f32_16x16x32_bf16 v[208:211], a[16:19], a[200:203], v[208:211]
ds_read_b64_tr_b16 a[14:15], v19 offset:13056
v_mfma_f32_16x16x32_bf16 v[208:211], a[20:23], a[216:219], v[208:211]
buffer_load_dwordx4 a[116:119], v3, s[88:91], s101 offen offset:1024 sc1
v_mfma_f32_16x16x32_bf16 v[216:219], a[20:23], a[220:223], v[216:219]
v_mfma_f32_16x16x32_bf16 v[216:219], a[16:19], a[204:207], v[216:219]
v_mfma_f32_16x16x32_bf16 v[220:223], a[24:27], a[204:207], v[220:223]
ds_read_b64_tr_b16 a[16:17], v15 offset:0
v_mfma_f32_16x16x32_bf16 v[220:223], a[28:31], a[220:223], v[220:223]
buffer_load_dwordx4 a[120:123], v3, s[88:91], s101 offen offset:2048 sc1
v_mfma_f32_16x16x32_bf16 v[212:215], a[28:31], a[216:219], v[212:215]
ds_read_b64_tr_b16 a[18:19], v15 offset:4096
v_mfma_f32_16x16x32_bf16 v[212:215], a[24:27], a[200:203], v[212:215]
ds_read_b64_tr_b16 a[20:21], v15 offset:8192
v_mfma_f32_16x16x32_bf16 v[204:207], a[24:27], a[196:199], v[204:207]
ds_read_b64_tr_b16 a[22:23], v15 offset:12288
v_mfma_f32_16x16x32_bf16 v[204:207], a[28:31], a[212:215], v[204:207]
v_mfma_f32_16x16x32_bf16 v[196:199], a[28:31], a[208:211], v[196:199]
buffer_load_dwordx4 a[124:127], v3, s[88:91], s101 offen offset:3072 sc1
v_mfma_f32_16x16x32_bf16 v[196:199], a[24:27], a[192:195], v[196:199]
s_waitcnt lgkmcnt(4)
s_add_u32 m0, s17, 0x14000
s_lshl_b32 s61, s60, 3
v_mfma_f32_16x16x32_bf16 v[224:227], a[0:3], a[192:195], v[224:227]
ds_read_b64_tr_b16 a[24:25], v19 offset:0
s_add_u32 s62, s61, s12
v_mfma_f32_16x16x32_bf16 v[224:227], a[4:7], a[208:211], v[224:227]
ds_read_b64_tr_b16 a[26:27], v19 offset:4096
v_mfma_f32_16x16x32_bf16 v[232:235], a[4:7], a[212:215], v[232:235]
ds_read_b64_tr_b16 a[28:29], v19 offset:8192
v_mfma_f32_16x16x32_bf16 v[232:235], a[0:3], a[196:199], v[232:235]
buffer_load_dwordx4 v12, s[64:67], s61 offen lds
v_mfma_f32_16x16x32_bf16 v[240:243], a[0:3], a[200:203], v[240:243]
ds_read_b64_tr_b16 a[30:31], v19 offset:12288
v_mfma_f32_16x16x32_bf16 v[240:243], a[4:7], a[216:219], v[240:243]
v_mfma_f32_16x16x32_bf16 v[248:251], a[4:7], a[220:223], v[248:251]
s_waitcnt vmcnt(21)
v_mfma_f32_16x16x32_bf16 v[248:251], a[0:3], a[204:207], v[248:251]
s_barrier
v_mfma_f32_16x16x32_bf16 v[252:255], a[8:11], a[204:207], v[252:255]
buffer_load_dwordx4 v13, s[64:67], s61 offen offset:1024 lds
v_mfma_f32_16x16x32_bf16 v[252:255], a[12:15], a[220:223], v[252:255]
ds_read_b64_tr_b16 a[0:1], v15 offset:16640
v_mfma_f32_16x16x32_bf16 v[244:247], a[12:15], a[216:219], v[244:247]
ds_read_b64_tr_b16 a[2:3], v15 offset:20736
v_mfma_f32_16x16x32_bf16 v[244:247], a[8:11], a[200:203], v[244:247]
ds_read_b64_tr_b16 a[4:5], v15 offset:24832
v_mfma_f32_16x16x32_bf16 v[236:239], a[8:11], a[196:199], v[236:239]
buffer_load_dwordx4 v12, s[64:67], s62 offen offset:2048 lds
v_mfma_f32_16x16x32_bf16 v[236:239], a[12:15], a[212:215], v[236:239]
ds_read_b64_tr_b16 a[6:7], v15 offset:28928
v_mfma_f32_16x16x32_bf16 v[228:231], a[12:15], a[208:211], v[228:231]
v_mfma_f32_16x16x32_bf16 v[228:231], a[8:11], a[192:195], v[228:231]
s_waitcnt lgkmcnt(4)
v_mfma_f32_16x16x32_bf16 a[32:35], a[16:19], a[192:195], a[32:35]
buffer_load_dwordx4 v13, s[64:67], s62 offen offset:3072 lds
v_mfma_f32_16x16x32_bf16 a[32:35], a[20:23], a[208:211], a[32:35]
ds_read_b64_tr_b16 a[8:9], v19 offset:16640
s_add_u32 s60, s60, s58
v_mfma_f32_16x16x32_bf16 a[40:43], a[20:23], a[212:215], a[40:43]
ds_read_b64_tr_b16 a[10:11], v19 offset:20736
s_and_b32 s60, s60, 0x1c000
v_mfma_f32_16x16x32_bf16 a[40:43], a[16:19], a[196:199], a[40:43]
ds_read_b64_tr_b16 a[12:13], v19 offset:24832
s_add_u32 s101, s63, s60
v_mfma_f32_16x16x32_bf16 a[48:51], a[16:19], a[200:203], a[48:51]
ds_read_b64_tr_b16 a[14:15], v19 offset:28928
v_mfma_f32_16x16x32_bf16 a[48:51], a[20:23], a[216:219], a[48:51]
buffer_load_dwordx4 a[128:131], v3, s[88:91], s101 offen sc1
v_mfma_f32_16x16x32_bf16 v[152:155], a[20:23], a[220:223], v[152:155]
v_mfma_f32_16x16x32_bf16 v[152:155], a[16:19], a[204:207], v[152:155]
v_mfma_f32_16x16x32_bf16 v[156:159], a[24:27], a[204:207], v[156:159]
ds_read_b64_tr_b16 a[16:17], v15 offset:16896
v_mfma_f32_16x16x32_bf16 v[156:159], a[28:31], a[220:223], v[156:159]
ds_read_b64_tr_b16 a[18:19], v15 offset:20992
v_mfma_f32_16x16x32_bf16 a[52:55], a[28:31], a[216:219], a[52:55]
buffer_load_dwordx4 a[132:135], v3, s[88:91], s101 offen offset:1024 sc1
v_mfma_f32_16x16x32_bf16 a[52:55], a[24:27], a[200:203], a[52:55]
ds_read_b64_tr_b16 a[20:21], v15 offset:25088
v_mfma_f32_16x16x32_bf16 a[44:47], a[24:27], a[196:199], a[44:47]
ds_read_b64_tr_b16 a[22:23], v15 offset:29184
v_mfma_f32_16x16x32_bf16 a[44:47], a[28:31], a[212:215], a[44:47]
v_mfma_f32_16x16x32_bf16 a[36:39], a[28:31], a[208:211], a[36:39]
buffer_load_dwordx4 a[136:139], v3, s[88:91], s101 offen offset:2048 sc1
v_mfma_f32_16x16x32_bf16 a[36:39], a[24:27], a[192:195], a[36:39]
s_waitcnt lgkmcnt(4)
v_mfma_f32_16x16x32_bf16 v[160:163], a[0:3], a[224:227], v[160:163]
ds_read_b64_tr_b16 a[24:25], v19 offset:16896
v_mfma_f32_16x16x32_bf16 v[160:163], a[4:7], a[240:243], v[160:163]
ds_read_b64_tr_b16 a[26:27], v19 offset:20992
v_mfma_f32_16x16x32_bf16 v[168:171], a[4:7], a[244:247], v[168:171]
ds_read_b64_tr_b16 a[28:29], v19 offset:25088
v_mfma_f32_16x16x32_bf16 v[168:171], a[0:3], a[228:231], v[168:171]
buffer_load_dwordx4 a[140:143], v3, s[88:91], s101 offen offset:3072 sc1
v_mfma_f32_16x16x32_bf16 v[176:179], a[0:3], a[232:235], v[176:179]
ds_read_b64_tr_b16 a[30:31], v19 offset:29184
s_add_u32 s101, s101, 0x2000
v_mfma_f32_16x16x32_bf16 v[176:179], a[4:7], a[248:251], v[176:179]
v_mfma_f32_16x16x32_bf16 v[184:187], a[4:7], a[252:255], v[184:187]
v_mfma_f32_16x16x32_bf16 v[184:187], a[0:3], a[236:239], v[184:187]
buffer_load_dwordx4 a[144:147], v3, s[88:91], s101 offen sc1
v_mfma_f32_16x16x32_bf16 v[188:191], a[8:11], a[236:239], v[188:191]
ds_read_b64_tr_b16 a[0:1], v15 offset:17152
v_mfma_f32_16x16x32_bf16 v[188:191], a[12:15], a[252:255], v[188:191]
ds_read_b64_tr_b16 a[2:3], v15 offset:21248
v_mfma_f32_16x16x32_bf16 v[180:183], a[12:15], a[248:251], v[180:183]
ds_read_b64_tr_b16 a[4:5], v15 offset:25344
v_mfma_f32_16x16x32_bf16 v[180:183], a[8:11], a[232:235], v[180:183]
ds_read_b64_tr_b16 a[6:7], v15 offset:29440
v_mfma_f32_16x16x32_bf16 v[172:175], a[8:11], a[228:231], v[172:175]
buffer_load_dwordx4 a[148:151], v3, s[88:91], s101 offen offset:1024 sc1
v_mfma_f32_16x16x32_bf16 v[172:175], a[12:15], a[244:247], v[172:175]
v_mfma_f32_16x16x32_bf16 v[164:167], a[12:15], a[240:243], v[164:167]
v_mfma_f32_16x16x32_bf16 v[164:167], a[8:11], a[224:227], v[164:167]
s_waitcnt lgkmcnt(4)
v_mfma_f32_16x16x32_bf16 v[192:195], a[16:19], a[224:227], v[192:195]
ds_read_b64_tr_b16 a[8:9], v19 offset:17152
v_mfma_f32_16x16x32_bf16 v[192:195], a[20:23], a[240:243], v[192:195]
buffer_load_dwordx4 a[152:155], v3, s[88:91], s101 offen offset:2048 sc1
v_mfma_f32_16x16x32_bf16 v[200:203], a[20:23], a[244:247], v[200:203]
ds_read_b64_tr_b16 a[10:11], v19 offset:21248
v_mfma_f32_16x16x32_bf16 v[200:203], a[16:19], a[228:231], v[200:203]
ds_read_b64_tr_b16 a[12:13], v19 offset:25344
v_mfma_f32_16x16x32_bf16 v[208:211], a[16:19], a[232:235], v[208:211]
ds_read_b64_tr_b16 a[14:15], v19 offset:29440
v_mfma_f32_16x16x32_bf16 v[208:211], a[20:23], a[248:251], v[208:211]
buffer_load_dwordx4 a[156:159], v3, s[88:91], s101 offen offset:3072 sc1
v_mfma_f32_16x16x32_bf16 v[216:219], a[20:23], a[252:255], v[216:219]
s_add_u32 m0, s17, 0x18000
s_lshl_b32 s61, s60, 3
s_add_u32 s62, s61, s12
v_mfma_f32_16x16x32_bf16 v[216:219], a[16:19], a[236:239], v[216:219]
v_mfma_f32_16x16x32_bf16 v[220:223], a[24:27], a[236:239], v[220:223]
ds_read_b64_tr_b16 a[16:17], v15 offset:16384
v_mfma_f32_16x16x32_bf16 v[220:223], a[28:31], a[252:255], v[220:223]
ds_read_b64_tr_b16 a[18:19], v15 offset:20480
v_mfma_f32_16x16x32_bf16 v[212:215], a[28:31], a[248:251], v[212:215]
buffer_load_dwordx4 v12, s[64:67], s61 offen lds
v_mfma_f32_16x16x32_bf16 v[212:215], a[24:27], a[232:235], v[212:215]
ds_read_b64_tr_b16 a[20:21], v15 offset:24576
v_mfma_f32_16x16x32_bf16 v[204:207], a[24:27], a[228:231], v[204:207]
ds_read_b64_tr_b16 a[22:23], v15 offset:28672
v_mfma_f32_16x16x32_bf16 v[204:207], a[28:31], a[244:247], v[204:207]
v_mfma_f32_16x16x32_bf16 v[196:199], a[28:31], a[240:243], v[196:199]
buffer_load_dwordx4 v13, s[64:67], s61 offen offset:1024 lds
v_mfma_f32_16x16x32_bf16 v[196:199], a[24:27], a[224:227], v[196:199]
s_waitcnt lgkmcnt(4)
v_mfma_f32_16x16x32_bf16 v[224:227], a[0:3], a[224:227], v[224:227]
ds_read_b64_tr_b16 a[24:25], v19 offset:16384
v_mfma_f32_16x16x32_bf16 v[224:227], a[4:7], a[240:243], v[224:227]
ds_read_b64_tr_b16 a[26:27], v19 offset:20480
v_mfma_f32_16x16x32_bf16 v[232:235], a[4:7], a[244:247], v[232:235]
ds_read_b64_tr_b16 a[28:29], v19 offset:24576
v_mfma_f32_16x16x32_bf16 v[232:235], a[0:3], a[228:231], v[232:235]
buffer_load_dwordx4 v12, s[64:67], s62 offen offset:2048 lds
v_mfma_f32_16x16x32_bf16 v[240:243], a[0:3], a[232:235], v[240:243]
ds_read_b64_tr_b16 a[30:31], v19 offset:28672
v_mfma_f32_16x16x32_bf16 v[240:243], a[4:7], a[248:251], v[240:243]
v_mfma_f32_16x16x32_bf16 v[248:251], a[4:7], a[252:255], v[248:251]
s_waitcnt vmcnt(23)
v_mfma_f32_16x16x32_bf16 v[248:251], a[0:3], a[236:239], v[248:251]
s_barrier
v_mfma_f32_16x16x32_bf16 v[252:255], a[8:11], a[236:239], v[252:255]
buffer_load_dwordx4 v13, s[64:67], s62 offen offset:3072 lds
v_mfma_f32_16x16x32_bf16 v[252:255], a[12:15], a[252:255], v[252:255]
ds_read_b64_tr_b16 a[0:1], v4 offset:256
s_add_u32 s60, s60, s59
v_mfma_f32_16x16x32_bf16 v[244:247], a[12:15], a[248:251], v[244:247]
ds_read_b64_tr_b16 a[2:3], v4 offset:4352
s_and_b32 s60, s60, 0x1c000
v_mfma_f32_16x16x32_bf16 v[244:247], a[8:11], a[232:235], v[244:247]
ds_read_b64_tr_b16 a[4:5], v4 offset:8448
s_add_u32 s101, s63, s60
v_mfma_f32_16x16x32_bf16 v[236:239], a[8:11], a[228:231], v[236:239]
buffer_load_dwordx4 a[160:163], v3, s[88:91], s101 offen sc1
v_mfma_f32_16x16x32_bf16 v[236:239], a[12:15], a[244:247], v[236:239]
ds_read_b64_tr_b16 a[6:7], v4 offset:12544
s_lshl_b32 s11, s6, 2
v_mfma_f32_16x16x32_bf16 v[228:231], a[12:15], a[240:243], v[228:231]
s_lshr_b32 s10, s5, 4
s_lshl_b32 s10, s10, 1
s_add_u32 s11, s11, s10
v_mfma_f32_16x16x32_bf16 v[228:231], a[8:11], a[224:227], v[228:231]
s_waitcnt lgkmcnt(4)
s_lshl_b32 s11, s11, 6
s_and_b32 s10, s5, 3
v_mfma_f32_16x16x32_bf16 a[32:35], a[16:19], a[224:227], a[32:35]
ds_read_b64_tr_b16 a[8:9], v5 offset:256
s_add_u32 s11, s11, s10
v_mfma_f32_16x16x32_bf16 a[32:35], a[20:23], a[240:243], a[32:35]
buffer_load_dwordx4 a[164:167], v3, s[88:91], s101 offen offset:1024 sc1
v_mfma_f32_16x16x32_bf16 a[40:43], a[20:23], a[244:247], a[40:43]
ds_read_b64_tr_b16 a[10:11], v5 offset:4352
s_lshl_b32 s11, s11, 2
v_mfma_f32_16x16x32_bf16 a[40:43], a[16:19], a[228:231], a[40:43]
ds_read_b64_tr_b16 a[12:13], v5 offset:8448
L_padC2:
s_cmp_eq_u32 s95, 1
s_cbranch_scc1 L_padC4
s_add_u32 s11, s11, 0x3704000
v_mfma_f32_16x16x32_bf16 a[48:51], a[16:19], a[232:235], a[48:51]
ds_read_b64_tr_b16 a[14:15], v5 offset:12544
v_and_b32 v7, 1, v0
v_mfma_f32_16x16x32_bf16 a[48:51], a[20:23], a[248:251], a[48:51]
buffer_load_dwordx4 a[168:171], v3, s[88:91], s101 offen offset:2048 sc1
v_mfma_f32_16x16x32_bf16 v[152:155], a[20:23], a[252:255], v[152:155]
v_lshlrev_b32 v7, 4, v7
v_and_b32 v1, 2, v0
v_mfma_f32_16x16x32_bf16 v[152:155], a[16:19], a[236:239], v[152:155]
v_lshl_add_u32 v7, v1, 7, v7
v_min_u32 v1, 2, v0
v_mfma_f32_16x16x32_bf16 v[156:159], a[24:27], a[236:239], v[156:159]
ds_read_b64_tr_b16 a[16:17], v4 offset:512
v_lshlrev_b32 v1, 22, v1
v_mfma_f32_16x16x32_bf16 v[156:159], a[28:31], a[252:255], v[156:159]
ds_read_b64_tr_b16 a[18:19], v4 offset:4608
v_add_u32 v1, 4092, v1
v_mfma_f32_16x16x32_bf16 a[52:55], a[28:31], a[248:251], a[52:55]
buffer_load_dwordx4 a[172:175], v3, s[88:91], s101 offen offset:3072 sc1
v_mfma_f32_16x16x32_bf16 a[52:55], a[24:27], a[232:235], a[52:55]
ds_read_b64_tr_b16 a[20:21], v4 offset:8704
s_add_u32 s101, s101, 0x2000
v_mfma_f32_16x16x32_bf16 a[44:47], a[24:27], a[228:231], a[44:47]
ds_read_b64_tr_b16 a[22:23], v4 offset:12800
v_mfma_f32_16x16x32_bf16 a[44:47], a[28:31], a[244:247], a[44:47]
v_mfma_f32_16x16x32_bf16 a[36:39], a[28:31], a[240:243], a[36:39]
s_waitcnt lgkmcnt(4)
v_mfma_f32_16x16x32_bf16 a[36:39], a[24:27], a[224:227], a[36:39]
buffer_load_dwordx4 a[176:179], v3, s[88:91], s101 offen sc1
v_mfma_f32_16x16x32_bf16 v[160:163], a[0:3], a[64:67], v[160:163]
ds_read_b64_tr_b16 a[24:25], v5 offset:512
v_mfma_f32_16x16x32_bf16 v[160:163], a[4:7], a[80:83], v[160:163]
ds_read_b64_tr_b16 a[26:27], v5 offset:4608
v_mfma_f32_16x16x32_bf16 v[168:171], a[4:7], a[84:87], v[168:171]
ds_read_b64_tr_b16 a[28:29], v5 offset:8704
v_mfma_f32_16x16x32_bf16 v[168:171], a[0:3], a[68:71], v[168:171]
buffer_load_dwordx4 a[180:183], v3, s[88:91], s101 offen offset:1024 sc1
v_mfma_f32_16x16x32_bf16 v[176:179], a[0:3], a[72:75], v[176:179]
ds_read_b64_tr_b16 a[30:31], v5 offset:12800
v_mfma_f32_16x16x32_bf16 v[176:179], a[4:7], a[88:91], v[176:179]
v_mfma_f32_16x16x32_bf16 v[184:187], a[4:7], a[92:95], v[184:187]
v_mfma_f32_16x16x32_bf16 v[184:187], a[0:3], a[76:79], v[184:187]
v_mfma_f32_16x16x32_bf16 v[188:191], a[8:11], a[76:79], v[188:191]
buffer_load_dwordx4 a[184:187], v3, s[88:91], s101 offen offset:2048 sc1
v_mfma_f32_16x16x32_bf16 v[188:191], a[12:15], a[92:95], v[188:191]
ds_read_b64_tr_b16 a[0:1], v4 offset:768
v_mfma_f32_16x16x32_bf16 v[180:183], a[12:15], a[88:91], v[180:183]
ds_read_b64_tr_b16 a[2:3], v4 offset:4864
v_mfma_f32_16x16x32_bf16 v[180:183], a[8:11], a[72:75], v[180:183]
ds_read_b64_tr_b16 a[4:5], v4 offset:8960
v_mfma_f32_16x16x32_bf16 v[172:175], a[8:11], a[68:71], v[172:175]
buffer_load_dwordx4 a[188:191], v3, s[88:91], s101 offen offset:3072 sc1
v_mfma_f32_16x16x32_bf16 v[172:175], a[12:15], a[84:87], v[172:175]
ds_read_b64_tr_b16 a[6:7], v4 offset:13056
s_add_u32 m0, s17, 0x1c000
v_mfma_f32_16x16x32_bf16 v[164:167], a[12:15], a[80:83], v[164:167]
s_lshl_b32 s61, s60, 3
s_add_u32 s62, s61, s12
v_mfma_f32_16x16x32_bf16 v[164:167], a[8:11], a[64:67], v[164:167]
s_waitcnt lgkmcnt(4)
v_mfma_f32_16x16x32_bf16 v[192:195], a[16:19], a[64:67], v[192:195]
ds_read_b64_tr_b16 a[8:9], v5 offset:768
v_mfma_f32_16x16x32_bf16 v[192:195], a[20:23], a[80:83], v[192:195]
buffer_load_dwordx4 v12, s[64:67], s61 offen lds
v_mfma_f32_16x16x32_bf16 v[200:203], a[20:23], a[84:87], v[200:203]
ds_read_b64_tr_b16 a[10:11], v5 offset:4864
v_mfma_f32_16x16x32_bf16 v[200:203], a[16:19], a[68:71], v[200:203]
ds_read_b64_tr_b16 a[12:13], v5 offset:8960
v_mfma_f32_16x16x32_bf16 v[208:211], a[16:19], a[72:75], v[208:211]
ds_read_b64_tr_b16 a[14:15], v5 offset:13056
v_mfma_f32_16x16x32_bf16 v[208:211], a[20:23], a[88:91], v[208:211]
v_mfma_f32_16x16x32_bf16 v[216:219], a[20:23], a[92:95], v[216:219]
buffer_load_dwordx4 v13, s[64:67], s61 offen offset:1024 lds
v_mfma_f32_16x16x32_bf16 v[216:219], a[16:19], a[76:79], v[216:219]
v_mfma_f32_16x16x32_bf16 v[220:223], a[24:27], a[76:79], v[220:223]
ds_read_b64_tr_b16 a[16:17], v4 offset:0
v_mfma_f32_16x16x32_bf16 v[220:223], a[28:31], a[92:95], v[220:223]
ds_read_b64_tr_b16 a[18:19], v4 offset:4096
v_mfma_f32_16x16x32_bf16 v[212:215], a[28:31], a[88:91], v[212:215]
buffer_load_dwordx4 v12, s[64:67], s62 offen offset:2048 lds
v_mfma_f32_16x16x32_bf16 v[212:215], a[24:27], a[72:75], v[212:215]
ds_read_b64_tr_b16 a[20:21], v4 offset:8192
v_mfma_f32_16x16x32_bf16 v[204:207], a[24:27], a[68:71], v[204:207]
ds_read_b64_tr_b16 a[22:23], v4 offset:12288
v_mfma_f32_16x16x32_bf16 v[204:207], a[28:31], a[84:87], v[204:207]
v_mfma_f32_16x16x32_bf16 v[196:199], a[28:31], a[80:83], v[196:199]
s_waitcnt lgkmcnt(4)
v_mfma_f32_16x16x32_bf16 v[196:199], a[24:27], a[64:67], v[196:199]
buffer_load_dwordx4 v13, s[64:67], s62 offen offset:3072 lds
v_mfma_f32_16x16x32_bf16 v[224:227], a[0:3], a[64:67], v[224:227]
ds_read_b64_tr_b16 a[24:25], v5 offset:0
s_add_u32 s60, s60, s56
v_mfma_f32_16x16x32_bf16 v[224:227], a[4:7], a[80:83], v[224:227]
ds_read_b64_tr_b16 a[26:27], v5 offset:4096
s_and_b32 s60, s60, 0x1c000
v_mfma_f32_16x16x32_bf16 v[232:235], a[4:7], a[84:87], v[232:235]
ds_read_b64_tr_b16 a[28:29], v5 offset:8192
s_add_u32 s101, s63, s60
v_mfma_f32_16x16x32_bf16 v[232:235], a[0:3], a[68:71], v[232:235]
buffer_load_dwordx4 a[192:195], v3, s[88:91], s101 offen sc1
v_mfma_f32_16x16x32_bf16 v[240:243], a[0:3], a[72:75], v[240:243]
ds_read_b64_tr_b16 a[30:31], v5 offset:12288
v_mfma_f32_16x16x32_bf16 v[240:243], a[4:7], a[88:91], v[240:243]
v_mfma_f32_16x16x32_bf16 v[248:251], a[4:7], a[92:95], v[248:251]
s_waitcnt vmcnt(25)
v_mfma_f32_16x16x32_bf16 v[248:251], a[0:3], a[76:79], v[248:251]
s_barrier
v_mfma_f32_16x16x32_bf16 v[252:255], a[8:11], a[76:79], v[252:255]
buffer_load_dwordx4 a[196:199], v3, s[88:91], s101 offen offset:1024 sc1
v_mfma_f32_16x16x32_bf16 v[252:255], a[12:15], a[92:95], v[252:255]
ds_read_b64_tr_b16 a[0:1], v4 offset:16640
v_mfma_f32_16x16x32_bf16 v[244:247], a[12:15], a[88:91], v[244:247]
ds_read_b64_tr_b16 a[2:3], v4 offset:20736
v_mfma_f32_16x16x32_bf16 v[244:247], a[8:11], a[72:75], v[244:247]
ds_read_b64_tr_b16 a[4:5], v4 offset:24832
v_mfma_f32_16x16x32_bf16 v[236:239], a[8:11], a[68:71], v[236:239]
ds_read_b64_tr_b16 a[6:7], v4 offset:28928
v_mfma_f32_16x16x32_bf16 v[236:239], a[12:15], a[84:87], v[236:239]
buffer_load_dwordx4 a[200:203], v3, s[88:91], s101 offen offset:2048 sc1
v_mfma_f32_16x16x32_bf16 v[228:231], a[12:15], a[80:83], v[228:231]
v_mfma_f32_16x16x32_bf16 v[228:231], a[8:11], a[64:67], v[228:231]
s_waitcnt lgkmcnt(4)
v_mfma_f32_16x16x32_bf16 a[32:35], a[16:19], a[64:67], a[32:35]
ds_read_b64_tr_b16 a[8:9], v5 offset:16640
v_mfma_f32_16x16x32_bf16 a[32:35], a[20:23], a[80:83], a[32:35]
buffer_load_dwordx4 a[204:207], v3, s[88:91], s101 offen offset:3072 sc1
v_mfma_f32_16x16x32_bf16 a[40:43], a[20:23], a[84:87], a[40:43]
ds_read_b64_tr_b16 a[10:11], v5 offset:20736
s_add_u32 s101, s101, 0x2000
v_mfma_f32_16x16x32_bf16 a[40:43], a[16:19], a[68:71], a[40:43]
ds_read_b64_tr_b16 a[12:13], v5 offset:24832
v_mfma_f32_16x16x32_bf16 a[48:51], a[16:19], a[72:75], a[48:51]
ds_read_b64_tr_b16 a[14:15], v5 offset:28928
v_mfma_f32_16x16x32_bf16 a[48:51], a[20:23], a[88:91], a[48:51]
v_mfma_f32_16x16x32_bf16 v[152:155], a[20:23], a[92:95], v[152:155]
buffer_load_dwordx4 a[208:211], v3, s[88:91], s101 offen sc1
v_mfma_f32_16x16x32_bf16 v[152:155], a[16:19], a[76:79], v[152:155]
v_mfma_f32_16x16x32_bf16 v[156:159], a[24:27], a[76:79], v[156:159]
ds_read_b64_tr_b16 a[16:17], v4 offset:16896
v_mfma_f32_16x16x32_bf16 v[156:159], a[28:31], a[92:95], v[156:159]
ds_read_b64_tr_b16 a[18:19], v4 offset:20992
v_mfma_f32_16x16x32_bf16 a[52:55], a[28:31], a[88:91], a[52:55]
buffer_load_dwordx4 a[212:215], v3, s[88:91], s101 offen offset:1024 sc1
v_mfma_f32_16x16x32_bf16 a[52:55], a[24:27], a[72:75], a[52:55]
ds_read_b64_tr_b16 a[20:21], v4 offset:25088
v_mfma_f32_16x16x32_bf16 a[44:47], a[24:27], a[68:71], a[44:47]
ds_read_b64_tr_b16 a[22:23], v4 offset:29184
v_mfma_f32_16x16x32_bf16 a[44:47], a[28:31], a[84:87], a[44:47]
v_mfma_f32_16x16x32_bf16 a[36:39], a[28:31], a[80:83], a[36:39]
s_waitcnt lgkmcnt(4)
v_mfma_f32_16x16x32_bf16 a[36:39], a[24:27], a[64:67], a[36:39]
buffer_load_dwordx4 a[216:219], v3, s[88:91], s101 offen offset:2048 sc1
v_mfma_f32_16x16x32_bf16 v[160:163], a[0:3], a[96:99], v[160:163]
ds_read_b64_tr_b16 a[24:25], v5 offset:16896
v_mfma_f32_16x16x32_bf16 v[160:163], a[4:7], a[112:115], v[160:163]
ds_read_b64_tr_b16 a[26:27], v5 offset:20992
v_mfma_f32_16x16x32_bf16 v[168:171], a[4:7], a[116:119], v[168:171]
ds_read_b64_tr_b16 a[28:29], v5 offset:25088
v_mfma_f32_16x16x32_bf16 v[168:171], a[0:3], a[100:103], v[168:171]
ds_read_b64_tr_b16 a[30:31], v5 offset:29184
v_mfma_f32_16x16x32_bf16 v[176:179], a[0:3], a[104:107], v[176:179]
buffer_load_dwordx4 a[220:223], v3, s[88:91], s101 offen offset:3072 sc1
v_mfma_f32_16x16x32_bf16 v[176:179], a[4:7], a[120:123], v[176:179]
s_add_u32 m0, s17, 0x20000
s_lshl_b32 s61, s60, 3
s_add_u32 s62, s61, s12
v_mfma_f32_16x16x32_bf16 v[184:187], a[4:7], a[124:127], v[184:187]
v_mfma_f32_16x16x32_bf16 v[184:187], a[0:3], a[108:111], v[184:187]
v_mfma_f32_16x16x32_bf16 v[188:191], a[8:11], a[108:111], v[188:191]
buffer_load_dwordx4 v12, s[64:67], s61 offen lds
v_mfma_f32_16x16x32_bf16 v[188:191], a[12:15], a[124:127], v[188:191]
ds_read_b64_tr_b16 a[0:1], v4 offset:17152
v_mfma_f32_16x16x32_bf16 v[180:183], a[12:15], a[120:123], v[180:183]
ds_read_b64_tr_b16 a[2:3], v4 offset:21248
v_mfma_f32_16x16x32_bf16 v[180:183], a[8:11], a[104:107], v[180:183]
ds_read_b64_tr_b16 a[4:5], v4 offset:25344
v_mfma_f32_16x16x32_bf16 v[172:175], a[8:11], a[100:103], v[172:175]
ds_read_b64_tr_b16 a[6:7], v4 offset:29440
v_mfma_f32_16x16x32_bf16 v[172:175], a[12:15], a[116:119], v[172:175]
buffer_load_dwordx4 v13, s[64:67], s61 offen offset:1024 lds
v_mfma_f32_16x16x32_bf16 v[164:167], a[12:15], a[112:115], v[164:167]
v_mfma_f32_16x16x32_bf16 v[164:167], a[8:11], a[96:99], v[164:167]
s_waitcnt lgkmcnt(4)
v_mfma_f32_16x16x32_bf16 v[192:195], a[16:19], a[96:99], v[192:195]
ds_read_b64_tr_b16 a[8:9], v5 offset:17152
v_mfma_f32_16x16x32_bf16 v[192:195], a[20:23], a[112:115], v[192:195]
buffer_load_dwordx4 v12, s[64:67], s62 offen offset:2048 lds
v_mfma_f32_16x16x32_bf16 v[200:203], a[20:23], a[116:119], v[200:203]
ds_read_b64_tr_b16 a[10:11], v5 offset:21248
v_mfma_f32_16x16x32_bf16 v[200:203], a[16:19], a[100:103], v[200:203]
ds_read_b64_tr_b16 a[12:13], v5 offset:25344
v_mfma_f32_16x16x32_bf16 v[208:211], a[16:19], a[104:107], v[208:211]
ds_read_b64_tr_b16 a[14:15], v5 offset:29440
v_mfma_f32_16x16x32_bf16 v[208:211], a[20:23], a[120:123], v[208:211]
v_mfma_f32_16x16x32_bf16 v[216:219], a[20:23], a[124:127], v[216:219]
buffer_load_dwordx4 v13, s[64:67], s62 offen offset:3072 lds
v_mfma_f32_16x16x32_bf16 v[216:219], a[16:19], a[108:111], v[216:219]
s_add_u32 s60, s60, s57
s_and_b32 s60, s60, 0x1c000
s_add_u32 s101, s63, s60
v_mfma_f32_16x16x32_bf16 v[220:223], a[24:27], a[108:111], v[220:223]
ds_read_b64_tr_b16 a[16:17], v4 offset:16384
v_mfma_f32_16x16x32_bf16 v[220:223], a[28:31], a[124:127], v[220:223]
ds_read_b64_tr_b16 a[18:19], v4 offset:20480
v_mfma_f32_16x16x32_bf16 v[212:215], a[28:31], a[120:123], v[212:215]
ds_read_b64_tr_b16 a[20:21], v4 offset:24576
v_mfma_f32_16x16x32_bf16 v[212:215], a[24:27], a[104:107], v[212:215]
buffer_load_dwordx4 a[224:227], v3, s[88:91], s101 offen sc1
v_mfma_f32_16x16x32_bf16 v[204:207], a[24:27], a[100:103], v[204:207]
ds_read_b64_tr_b16 a[22:23], v4 offset:28672
v_mfma_f32_16x16x32_bf16 v[204:207], a[28:31], a[116:119], v[204:207]
v_mfma_f32_16x16x32_bf16 v[196:199], a[28:31], a[112:115], v[196:199]
s_waitcnt lgkmcnt(4)
v_mfma_f32_16x16x32_bf16 v[196:199], a[24:27], a[96:99], v[196:199]
buffer_load_dwordx4 a[228:231], v3, s[88:91], s101 offen offset:1024 sc1
v_mfma_f32_16x16x32_bf16 v[224:227], a[0:3], a[96:99], v[224:227]
ds_read_b64_tr_b16 a[24:25], v5 offset:16384
v_mfma_f32_16x16x32_bf16 v[224:227], a[4:7], a[112:115], v[224:227]
ds_read_b64_tr_b16 a[26:27], v5 offset:20480
v_mfma_f32_16x16x32_bf16 v[232:235], a[4:7], a[116:119], v[232:235]
ds_read_b64_tr_b16 a[28:29], v5 offset:24576
v_mfma_f32_16x16x32_bf16 v[232:235], a[0:3], a[100:103], v[232:235]
ds_read_b64_tr_b16 a[30:31], v5 offset:28672
v_mfma_f32_16x16x32_bf16 v[240:243], a[0:3], a[104:107], v[240:243]
buffer_load_dwordx4 a[232:235], v3, s[88:91], s101 offen offset:2048 sc1
v_mfma_f32_16x16x32_bf16 v[240:243], a[4:7], a[120:123], v[240:243]
v_mfma_f32_16x16x32_bf16 v[248:251], a[4:7], a[124:127], v[248:251]
s_waitcnt vmcnt(27)
v_mfma_f32_16x16x32_bf16 v[248:251], a[0:3], a[108:111], v[248:251]
s_barrier
v_mfma_f32_16x16x32_bf16 v[252:255], a[8:11], a[108:111], v[252:255]
buffer_load_dwordx4 a[236:239], v3, s[88:91], s101 offen offset:3072 sc1
v_mfma_f32_16x16x32_bf16 v[252:255], a[12:15], a[124:127], v[252:255]
ds_read_b64_tr_b16 a[0:1], v4 offset:33024
s_add_u32 s101, s101, 0x2000
v_mfma_f32_16x16x32_bf16 v[244:247], a[12:15], a[120:123], v[244:247]
ds_read_b64_tr_b16 a[2:3], v4 offset:37120
v_mfma_f32_16x16x32_bf16 v[244:247], a[8:11], a[104:107], v[244:247]
ds_read_b64_tr_b16 a[4:5], v4 offset:41216
v_mfma_f32_16x16x32_bf16 v[236:239], a[8:11], a[100:103], v[236:239]
ds_read_b64_tr_b16 a[6:7], v4 offset:45312
v_mfma_f32_16x16x32_bf16 v[236:239], a[12:15], a[116:119], v[236:239]
buffer_load_dwordx4 a[240:243], v3, s[88:91], s101 offen sc1
v_mfma_f32_16x16x32_bf16 v[228:231], a[12:15], a[112:115], v[228:231]
v_mfma_f32_16x16x32_bf16 v[228:231], a[8:11], a[96:99], v[228:231]
s_waitcnt lgkmcnt(4)
v_mfma_f32_16x16x32_bf16 a[32:35], a[16:19], a[96:99], a[32:35]
ds_read_b64_tr_b16 a[8:9], v5 offset:33024
v_mfma_f32_16x16x32_bf16 a[32:35], a[20:23], a[112:115], a[32:35]
ds_read_b64_tr_b16 a[10:11], v5 offset:37120
v_mfma_f32_16x16x32_bf16 a[40:43], a[20:23], a[116:119], a[40:43]
buffer_load_dwordx4 a[244:247], v3, s[88:91], s101 offen offset:1024 sc1
v_mfma_f32_16x16x32_bf16 a[40:43], a[16:19], a[100:103], a[40:43]
ds_read_b64_tr_b16 a[12:13], v5 offset:41216
v_mfma_f32_16x16x32_bf16 a[48:51], a[16:19], a[104:107], a[48:51]
ds_read_b64_tr_b16 a[14:15], v5 offset:45312
v_mfma_f32_16x16x32_bf16 a[48:51], a[20:23], a[120:123], a[48:51]
v_mfma_f32_16x16x32_bf16 v[152:155], a[20:23], a[124:127], v[152:155]
buffer_load_dwordx4 a[248:251], v3, s[88:91], s101 offen offset:2048 sc1
v_mfma_f32_16x16x32_bf16 v[152:155], a[16:19], a[108:111], v[152:155]
v_mfma_f32_16x16x32_bf16 v[156:159], a[24:27], a[108:111], v[156:159]
ds_read_b64_tr_b16 a[16:17], v4 offset:33280
v_mfma_f32_16x16x32_bf16 v[156:159], a[28:31], a[124:127], v[156:159]
ds_read_b64_tr_b16 a[18:19], v4 offset:37376
v_mfma_f32_16x16x32_bf16 a[52:55], a[28:31], a[120:123], a[52:55]
ds_read_b64_tr_b16 a[20:21], v4 offset:41472
v_mfma_f32_16x16x32_bf16 a[52:55], a[24:27], a[104:107], a[52:55]
buffer_load_dwordx4 a[252:255], v3, s[88:91], s101 offen offset:3072 sc1
v_mfma_f32_16x16x32_bf16 a[44:47], a[24:27], a[100:103], a[44:47]
ds_read_b64_tr_b16 a[22:23], v4 offset:45568
s_add_u32 m0, s17, 0x24000
v_mfma_f32_16x16x32_bf16 a[44:47], a[28:31], a[116:119], a[44:47]
s_lshl_b32 s61, s60, 3
s_add_u32 s62, s61, s12
v_mfma_f32_16x16x32_bf16 a[36:39], a[28:31], a[112:115], a[36:39]
s_waitcnt lgkmcnt(4)
v_mfma_f32_16x16x32_bf16 a[36:39], a[24:27], a[96:99], a[36:39]
buffer_load_dwordx4 v12, s[64:67], s61 offen lds
v_mfma_f32_16x16x32_bf16 v[160:163], a[0:3], a[128:131], v[160:163]
ds_read_b64_tr_b16 a[24:25], v5 offset:33280
v_mfma_f32_16x16x32_bf16 v[160:163], a[4:7], a[144:147], v[160:163]
ds_read_b64_tr_b16 a[26:27], v5 offset:37376
v_mfma_f32_16x16x32_bf16 v[168:171], a[4:7], a[148:151], v[168:171]
ds_read_b64_tr_b16 a[28:29], v5 offset:41472
v_mfma_f32_16x16x32_bf16 v[168:171], a[0:3], a[132:135], v[168:171]
ds_read_b64_tr_b16 a[30:31], v5 offset:45568
v_mfma_f32_16x16x32_bf16 v[176:179], a[0:3], a[136:139], v[176:179]
buffer_load_dwordx4 v13, s[64:67], s61 offen offset:1024 lds
v_mfma_f32_16x16x32_bf16 v[176:179], a[4:7], a[152:155], v[176:179]
v_mfma_f32_16x16x32_bf16 v[184:187], a[4:7], a[156:159], v[184:187]
v_mfma_f32_16x16x32_bf16 v[184:187], a[0:3], a[140:143], v[184:187]
v_mfma_f32_16x16x32_bf16 v[188:191], a[8:11], a[140:143], v[188:191]
ds_read_b64_tr_b16 a[0:1], v4 offset:33536
v_mfma_f32_16x16x32_bf16 v[188:191], a[12:15], a[156:159], v[188:191]
buffer_load_dwordx4 v12, s[64:67], s62 offen offset:2048 lds
v_mfma_f32_16x16x32_bf16 v[180:183], a[12:15], a[152:155], v[180:183]
ds_read_b64_tr_b16 a[2:3], v4 offset:37632
v_mfma_f32_16x16x32_bf16 v[180:183], a[8:11], a[136:139], v[180:183]
ds_read_b64_tr_b16 a[4:5], v4 offset:41728
v_mfma_f32_16x16x32_bf16 v[172:175], a[8:11], a[132:135], v[172:175]
ds_read_b64_tr_b16 a[6:7], v4 offset:45824
v_mfma_f32_16x16x32_bf16 v[172:175], a[12:15], a[148:151], v[172:175]
buffer_load_dwordx4 v13, s[64:67], s62 offen offset:3072 lds
v_mfma_f32_16x16x32_bf16 v[164:167], a[12:15], a[144:147], v[164:167]
s_add_u32 s60, s60, s58
s_and_b32 s60, s60, 0x1c000
s_add_u32 s101, s63, s60
v_mfma_f32_16x16x32_bf16 v[164:167], a[8:11], a[128:131], v[164:167]
s_waitcnt lgkmcnt(4)
v_mfma_f32_16x16x32_bf16 v[192:195], a[16:19], a[128:131], v[192:195]
ds_read_b64_tr_b16 a[8:9], v5 offset:33536
v_mfma_f32_16x16x32_bf16 v[192:195], a[20:23], a[144:147], v[192:195]
ds_read_b64_tr_b16 a[10:11], v5 offset:37632
v_mfma_f32_16x16x32_bf16 v[200:203], a[20:23], a[148:151], v[200:203]
buffer_load_dwordx4 a[64:67], v3, s[88:91], s101 offen sc1
v_mfma_f32_16x16x32_bf16 v[200:203], a[16:19], a[132:135], v[200:203]
ds_read_b64_tr_b16 a[12:13], v5 offset:41728
v_mfma_f32_16x16x32_bf16 v[208:211], a[16:19], a[136:139], v[208:211]
ds_read_b64_tr_b16 a[14:15], v5 offset:45824
v_mfma_f32_16x16x32_bf16 v[208:211], a[20:23], a[152:155], v[208:211]
v_mfma_f32_16x16x32_bf16 v[216:219], a[20:23], a[156:159], v[216:219]
buffer_load_dwordx4 a[68:71], v3, s[88:91], s101 offen offset:1024 sc1
v_mfma_f32_16x16x32_bf16 v[216:219], a[16:19], a[140:143], v[216:219]
v_mfma_f32_16x16x32_bf16 v[220:223], a[24:27], a[140:143], v[220:223]
ds_read_b64_tr_b16 a[16:17], v4 offset:32768
v_mfma_f32_16x16x32_bf16 v[220:223], a[28:31], a[156:159], v[220:223]
ds_read_b64_tr_b16 a[18:19], v4 offset:36864
v_mfma_f32_16x16x32_bf16 v[212:215], a[28:31], a[152:155], v[212:215]
ds_read_b64_tr_b16 a[20:21], v4 offset:40960
v_mfma_f32_16x16x32_bf16 v[212:215], a[24:27], a[136:139], v[212:215]
buffer_load_dwordx4 a[72:75], v3, s[88:91], s101 offen offset:2048 sc1
v_mfma_f32_16x16x32_bf16 v[204:207], a[24:27], a[132:135], v[204:207]
ds_read_b64_tr_b16 a[22:23], v4 offset:45056
v_mfma_f32_16x16x32_bf16 v[204:207], a[28:31], a[148:151], v[204:207]
v_mfma_f32_16x16x32_bf16 v[196:199], a[28:31], a[144:147], v[196:199]
v_mfma_f32_16x16x32_bf16 v[196:199], a[24:27], a[128:131], v[196:199]
s_waitcnt lgkmcnt(4)
v_mfma_f32_16x16x32_bf16 v[224:227], a[0:3], a[128:131], v[224:227]
buffer_load_dwordx4 a[76:79], v3, s[88:91], s101 offen offset:3072 sc1
v_mfma_f32_16x16x32_bf16 v[224:227], a[4:7], a[144:147], v[224:227]
ds_read_b64_tr_b16 a[24:25], v5 offset:32768
s_add_u32 s101, s101, 0x2000
v_mfma_f32_16x16x32_bf16 v[232:235], a[4:7], a[148:151], v[232:235]
ds_read_b64_tr_b16 a[26:27], v5 offset:36864
v_mfma_f32_16x16x32_bf16 v[232:235], a[0:3], a[132:135], v[232:235]
ds_read_b64_tr_b16 a[28:29], v5 offset:40960
v_mfma_f32_16x16x32_bf16 v[240:243], a[0:3], a[136:139], v[240:243]
buffer_load_dwordx4 a[80:83], v3, s[88:91], s101 offen sc1
v_mfma_f32_16x16x32_bf16 v[240:243], a[4:7], a[152:155], v[240:243]
ds_read_b64_tr_b16 a[30:31], v5 offset:45056
v_mfma_f32_16x16x32_bf16 v[248:251], a[4:7], a[156:159], v[248:251]
s_waitcnt vmcnt(29)
v_mfma_f32_16x16x32_bf16 v[248:251], a[0:3], a[140:143], v[248:251]
s_barrier
v_mfma_f32_16x16x32_bf16 v[252:255], a[8:11], a[140:143], v[252:255]
ds_read_b64_tr_b16 a[0:1], v4 offset:49408
v_mfma_f32_16x16x32_bf16 v[252:255], a[12:15], a[156:159], v[252:255]
buffer_load_dwordx4 a[84:87], v3, s[88:91], s101 offen offset:1024 sc1
v_mfma_f32_16x16x32_bf16 v[244:247], a[12:15], a[152:155], v[244:247]
ds_read_b64_tr_b16 a[2:3], v4 offset:53504
v_mfma_f32_16x16x32_bf16 v[244:247], a[8:11], a[136:139], v[244:247]
ds_read_b64_tr_b16 a[4:5], v4 offset:57600
v_mfma_f32_16x16x32_bf16 v[236:239], a[8:11], a[132:135], v[236:239]
ds_read_b64_tr_b16 a[6:7], v4 offset:61696
v_mfma_f32_16x16x32_bf16 v[236:239], a[12:15], a[148:151], v[236:239]
buffer_load_dwordx4 a[88:91], v3, s[88:91], s101 offen offset:2048 sc1
v_mfma_f32_16x16x32_bf16 v[228:231], a[12:15], a[144:147], v[228:231]
v_mfma_f32_16x16x32_bf16 v[228:231], a[8:11], a[128:131], v[228:231]
s_waitcnt lgkmcnt(4)
v_mfma_f32_16x16x32_bf16 a[32:35], a[16:19], a[128:131], a[32:35]
ds_read_b64_tr_b16 a[8:9], v5 offset:49408
v_mfma_f32_16x16x32_bf16 a[32:35], a[20:23], a[144:147], a[32:35]
ds_read_b64_tr_b16 a[10:11], v5 offset:53504
v_mfma_f32_16x16x32_bf16 a[40:43], a[20:23], a[148:151], a[40:43]
buffer_load_dwordx4 a[92:95], v3, s[88:91], s101 offen offset:3072 sc1
v_mfma_f32_16x16x32_bf16 a[40:43], a[16:19], a[132:135], a[40:43]
ds_read_b64_tr_b16 a[12:13], v5 offset:57600
s_add_u32 m0, s17, 0x10000
v_mfma_f32_16x16x32_bf16 a[48:51], a[16:19], a[136:139], a[48:51]
ds_read_b64_tr_b16 a[14:15], v5 offset:61696
s_lshl_b32 s61, s60, 3
v_mfma_f32_16x16x32_bf16 a[48:51], a[20:23], a[152:155], a[48:51]
s_add_u32 s62, s61, s12
v_mfma_f32_16x16x32_bf16 v[152:155], a[20:23], a[156:159], v[152:155]
v_mfma_f32_16x16x32_bf16 v[152:155], a[16:19], a[140:143], v[152:155]
buffer_load_dwordx4 v12, s[64:67], s61 offen lds
v_mfma_f32_16x16x32_bf16 v[156:159], a[24:27], a[140:143], v[156:159]
ds_read_b64_tr_b16 a[16:17], v4 offset:49664
v_mfma_f32_16x16x32_bf16 v[156:159], a[28:31], a[156:159], v[156:159]
ds_read_b64_tr_b16 a[18:19], v4 offset:53760
v_mfma_f32_16x16x32_bf16 a[52:55], a[28:31], a[152:155], a[52:55]
ds_read_b64_tr_b16 a[20:21], v4 offset:57856
v_mfma_f32_16x16x32_bf16 a[52:55], a[24:27], a[136:139], a[52:55]
buffer_load_dwordx4 v13, s[64:67], s61 offen offset:1024 lds
v_mfma_f32_16x16x32_bf16 a[44:47], a[24:27], a[132:135], a[44:47]
ds_read_b64_tr_b16 a[22:23], v4 offset:61952
v_mfma_f32_16x16x32_bf16 a[44:47], a[28:31], a[148:151], a[44:47]
v_mfma_f32_16x16x32_bf16 a[36:39], a[28:31], a[144:147], a[36:39]
v_mfma_f32_16x16x32_bf16 a[36:39], a[24:27], a[128:131], a[36:39]
s_waitcnt lgkmcnt(4)
v_mfma_f32_16x16x32_bf16 v[160:163], a[0:3], a[160:163], v[160:163]
buffer_load_dwordx4 v12, s[64:67], s62 offen offset:2048 lds
v_mfma_f32_16x16x32_bf16 v[160:163], a[4:7], a[176:179], v[160:163]
ds_read_b64_tr_b16 a[24:25], v5 offset:49664
v_mfma_f32_16x16x32_bf16 v[168:171], a[4:7], a[180:183], v[168:171]
ds_read_b64_tr_b16 a[26:27], v5 offset:53760
v_mfma_f32_16x16x32_bf16 v[168:171], a[0:3], a[164:167], v[168:171]
ds_read_b64_tr_b16 a[28:29], v5 offset:57856
v_mfma_f32_16x16x32_bf16 v[176:179], a[0:3], a[168:171], v[176:179]
buffer_load_dwordx4 v13, s[64:67], s62 offen offset:3072 lds
v_mfma_f32_16x16x32_bf16 v[176:179], a[4:7], a[184:187], v[176:179]
ds_read_b64_tr_b16 a[30:31], v5 offset:61952
s_add_u32 s60, s60, s59
v_mfma_f32_16x16x32_bf16 v[184:187], a[4:7], a[188:191], v[184:187]
s_and_b32 s60, s60, 0x1c000
s_add_u32 s101, s63, s60
v_mfma_f32_16x16x32_bf16 v[184:187], a[0:3], a[172:175], v[184:187]
v_mfma_f32_16x16x32_bf16 v[188:191], a[8:11], a[172:175], v[188:191]
ds_read_b64_tr_b16 a[0:1], v4 offset:49920
v_mfma_f32_16x16x32_bf16 v[188:191], a[12:15], a[188:191], v[188:191]
buffer_load_dwordx4 a[96:99], v3, s[88:91], s101 offen sc1
v_mfma_f32_16x16x32_bf16 v[180:183], a[12:15], a[184:187], v[180:183]
ds_read_b64_tr_b16 a[2:3], v4 offset:54016
v_mfma_f32_16x16x32_bf16 v[180:183], a[8:11], a[168:171], v[180:183]
ds_read_b64_tr_b16 a[4:5], v4 offset:58112
v_mfma_f32_16x16x32_bf16 v[172:175], a[8:11], a[164:167], v[172:175]
ds_read_b64_tr_b16 a[6:7], v4 offset:62208
v_mfma_f32_16x16x32_bf16 v[172:175], a[12:15], a[180:183], v[172:175]
v_mfma_f32_16x16x32_bf16 v[164:167], a[12:15], a[176:179], v[164:167]
buffer_load_dwordx4 a[100:103], v3, s[88:91], s101 offen offset:1024 sc1
v_mfma_f32_16x16x32_bf16 v[164:167], a[8:11], a[160:163], v[164:167]
s_waitcnt lgkmcnt(4)
v_mfma_f32_16x16x32_bf16 v[192:195], a[16:19], a[160:163], v[192:195]
ds_read_b64_tr_b16 a[8:9], v5 offset:49920
v_mfma_f32_16x16x32_bf16 v[192:195], a[20:23], a[176:179], v[192:195]
ds_read_b64_tr_b16 a[10:11], v5 offset:54016
v_mfma_f32_16x16x32_bf16 v[200:203], a[20:23], a[180:183], v[200:203]
buffer_load_dwordx4 a[104:107], v3, s[88:91], s101 offen offset:2048 sc1
v_mfma_f32_16x16x32_bf16 v[200:203], a[16:19], a[164:167], v[200:203]
ds_read_b64_tr_b16 a[12:13], v5 offset:58112
v_mfma_f32_16x16x32_bf16 v[208:211], a[16:19], a[168:171], v[208:211]
ds_read_b64_tr_b16 a[14:15], v5 offset:62208
v_mfma_f32_16x16x32_bf16 v[208:211], a[20:23], a[184:187], v[208:211]
v_mfma_f32_16x16x32_bf16 v[216:219], a[20:23], a[188:191], v[216:219]
s_waitcnt vmcnt(27)
v_mfma_f32_16x16x32_bf16 v[216:219], a[16:19], a[172:175], v[216:219]
s_barrier
v_mfma_f32_16x16x32_bf16 v[220:223], a[24:27], a[172:175], v[220:223]
buffer_load_dwordx4 a[108:111], v3, s[88:91], s101 offen offset:3072 sc1
v_mfma_f32_16x16x32_bf16 v[220:223], a[28:31], a[188:191], v[220:223]
ds_read_b64_tr_b16 a[16:17], v15 offset:256
s_add_u32 s101, s101, 0x2000
v_mfma_f32_16x16x32_bf16 v[212:215], a[28:31], a[184:187], v[212:215]
ds_read_b64_tr_b16 a[18:19], v15 offset:4352
v_mfma_f32_16x16x32_bf16 v[212:215], a[24:27], a[168:171], v[212:215]
ds_read_b64_tr_b16 a[20:21], v15 offset:8448
v_mfma_f32_16x16x32_bf16 v[204:207], a[24:27], a[164:167], v[204:207]
buffer_load_dwordx4 a[112:115], v3, s[88:91], s101 offen sc1
v_mfma_f32_16x16x32_bf16 v[204:207], a[28:31], a[180:183], v[204:207]
ds_read_b64_tr_b16 a[22:23], v15 offset:12544
v_mfma_f32_16x16x32_bf16 v[196:199], a[28:31], a[176:179], v[196:199]
v_mfma_f32_16x16x32_bf16 v[196:199], a[24:27], a[160:163], v[196:199]
s_waitcnt lgkmcnt(4)
v_mfma_f32_16x16x32_bf16 v[224:227], a[0:3], a[160:163], v[224:227]
buffer_load_dwordx4 a[116:119], v3, s[88:91], s101 offen offset:1024 sc1
v_mfma_f32_16x16x32_bf16 v[224:227], a[4:7], a[176:179], v[224:227]
ds_read_b64_tr_b16 a[24:25], v19 offset:256
v_mfma_f32_16x16x32_bf16 v[232:235], a[4:7], a[180:183], v[232:235]
ds_read_b64_tr_b16 a[26:27], v19 offset:4352
v_mfma_f32_16x16x32_bf16 v[232:235], a[0:3], a[164:167], v[232:235]
ds_read_b64_tr_b16 a[28:29], v19 offset:8448
v_mfma_f32_16x16x32_bf16 v[240:243], a[0:3], a[168:171], v[240:243]
ds_read_b64_tr_b16 a[30:31], v19 offset:12544
v_mfma_f32_16x16x32_bf16 v[240:243], a[4:7], a[184:187], v[240:243]
buffer_load_dwordx4 a[120:123], v3, s[88:91], s101 offen offset:2048 sc1
v_mfma_f32_16x16x32_bf16 v[248:251], a[4:7], a[188:191], v[248:251]
v_mfma_f32_16x16x32_bf16 v[248:251], a[0:3], a[172:175], v[248:251]
v_mfma_f32_16x16x32_bf16 v[252:255], a[8:11], a[172:175], v[252:255]
ds_read_b64_tr_b16 a[0:1], v15 offset:512
v_mfma_f32_16x16x32_bf16 v[252:255], a[12:15], a[188:191], v[252:255]
buffer_load_dwordx4 a[124:127], v3, s[88:91], s101 offen offset:3072 sc1
v_mfma_f32_16x16x32_bf16 v[244:247], a[12:15], a[184:187], v[244:247]
ds_read_b64_tr_b16 a[2:3], v15 offset:4608
s_add_u32 m0, s17, 0x14000
v_mfma_f32_16x16x32_bf16 v[244:247], a[8:11], a[168:171], v[244:247]
ds_read_b64_tr_b16 a[4:5], v15 offset:8704
s_lshl_b32 s61, s60, 3
v_mfma_f32_16x16x32_bf16 v[236:239], a[8:11], a[164:167], v[236:239]
ds_read_b64_tr_b16 a[6:7], v15 offset:12800
s_add_u32 s62, s61, s12
v_mfma_f32_16x16x32_bf16 v[236:239], a[12:15], a[180:183], v[236:239]
v_mfma_f32_16x16x32_bf16 v[228:231], a[12:15], a[176:179], v[228:231]
buffer_load_dwordx4 v12, s[64:67], s61 offen lds
v_mfma_f32_16x16x32_bf16 v[228:231], a[8:11], a[160:163], v[228:231]
s_waitcnt lgkmcnt(4)
v_mfma_f32_16x16x32_bf16 v[160:163], a[16:19], a[192:195], v[160:163]
ds_read_b64_tr_b16 a[8:9], v19 offset:512
v_mfma_f32_16x16x32_bf16 v[160:163], a[20:23], a[208:211], v[160:163]
ds_read_b64_tr_b16 a[10:11], v19 offset:4608
v_mfma_f32_16x16x32_bf16 v[168:171], a[20:23], a[212:215], v[168:171]
buffer_load_dwordx4 v13, s[64:67], s61 offen offset:1024 lds
v_mfma_f32_16x16x32_bf16 v[168:171], a[16:19], a[196:199], v[168:171]
ds_read_b64_tr_b16 a[12:13], v19 offset:8704
v_mfma_f32_16x16x32_bf16 v[176:179], a[16:19], a[200:203], v[176:179]
ds_read_b64_tr_b16 a[14:15], v19 offset:12800
v_mfma_f32_16x16x32_bf16 v[176:179], a[20:23], a[216:219], v[176:179]
v_mfma_f32_16x16x32_bf16 v[184:187], a[20:23], a[220:223], v[184:187]
s_waitcnt vmcnt(22)
v_mfma_f32_16x16x32_bf16 v[184:187], a[16:19], a[204:207], v[184:187]
s_barrier
v_mfma_f32_16x16x32_bf16 v[188:191], a[24:27], a[204:207], v[188:191]
buffer_load_dwordx4 v12, s[64:67], s62 offen offset:2048 lds
v_mfma_f32_16x16x32_bf16 v[188:191], a[28:31], a[220:223], v[188:191]
ds_read_b64_tr_b16 a[16:17], v15 offset:16640
v_mfma_f32_16x16x32_bf16 v[180:183], a[28:31], a[216:219], v[180:183]
ds_read_b64_tr_b16 a[18:19], v15 offset:20736
v_mfma_f32_16x16x32_bf16 v[180:183], a[24:27], a[200:203], v[180:183]
ds_read_b64_tr_b16 a[20:21], v15 offset:24832
v_mfma_f32_16x16x32_bf16 v[172:175], a[24:27], a[196:199], v[172:175]
buffer_load_dwordx4 v13, s[64:67], s62 offen offset:3072 lds
v_mfma_f32_16x16x32_bf16 v[172:175], a[28:31], a[212:215], v[172:175]
ds_read_b64_tr_b16 a[22:23], v15 offset:28928
v_mfma_f32_16x16x32_bf16 v[164:167], a[28:31], a[208:211], v[164:167]
buffer_load_dword v14, v7, s[88:91], s11 offen sc1
v_mfma_f32_16x16x32_bf16 v[164:167], a[24:27], a[192:195], v[164:167]
s_waitcnt lgkmcnt(4)
v_mfma_f32_16x16x32_bf16 v[192:195], a[0:3], a[192:195], v[192:195]
ds_read_b64_tr_b16 a[24:25], v19 offset:16640
v_mfma_f32_16x16x32_bf16 v[192:195], a[4:7], a[208:211], v[192:195]
ds_read_b64_tr_b16 a[26:27], v19 offset:20736
v_mfma_f32_16x16x32_bf16 v[200:203], a[4:7], a[212:215], v[200:203]
ds_read_b64_tr_b16 a[28:29], v19 offset:24832
v_mfma_f32_16x16x32_bf16 v[200:203], a[0:3], a[196:199], v[200:203]
ds_read_b64_tr_b16 a[30:31], v19 offset:28928
v_mfma_f32_16x16x32_bf16 v[208:211], a[0:3], a[200:203], v[208:211]
L_padC3:
s_cmp_eq_u32 s95, 1
s_cbranch_scc1 L_hopC_ret
v_mfma_f32_16x16x32_bf16 v[208:211], a[4:7], a[216:219], v[208:211]
v_mfma_f32_16x16x32_bf16 v[216:219], a[4:7], a[220:223], v[216:219]
s_waitcnt vmcnt(13)
v_mfma_f32_16x16x32_bf16 v[216:219], a[0:3], a[204:207], v[216:219]
s_barrier
v_mfma_f32_16x16x32_bf16 v[220:223], a[8:11], a[204:207], v[220:223]
ds_read_b64_tr_b16 a[0:1], v4 offset:256
v_mfma_f32_16x16x32_bf16 v[220:223], a[12:15], a[220:223], v[220:223]
ds_read_b64_tr_b16 a[2:3], v4 offset:4352
v_mfma_f32_16x16x32_bf16 v[212:215], a[12:15], a[216:219], v[212:215]
ds_read_b64_tr_b16 a[4:5], v4 offset:8448
v_mfma_f32_16x16x32_bf16 v[212:215], a[8:11], a[200:203], v[212:215]
ds_read_b64_tr_b16 a[6:7], v4 offset:12544
v_mfma_f32_16x16x32_bf16 v[204:207], a[8:11], a[196:199], v[204:207]
v_mfma_f32_16x16x32_bf16 v[204:207], a[12:15], a[212:215], v[204:207]
v_mfma_f32_16x16x32_bf16 v[196:199], a[12:15], a[208:211], v[196:199]
v_mfma_f32_16x16x32_bf16 v[196:199], a[8:11], a[192:195], v[196:199]
s_waitcnt lgkmcnt(4)
v_mfma_f32_16x16x32_bf16 v[160:163], a[16:19], a[224:227], v[160:163]
ds_read_b64_tr_b16 a[8:9], v5 offset:256
v_mfma_f32_16x16x32_bf16 v[160:163], a[20:23], a[240:243], v[160:163]
ds_read_b64_tr_b16 a[10:11], v5 offset:4352
v_mfma_f32_16x16x32_bf16 v[168:171], a[20:23], a[244:247], v[168:171]
ds_read_b64_tr_b16 a[12:13], v5 offset:8448
v_mfma_f32_16x16x32_bf16 v[168:171], a[16:19], a[228:231], v[168:171]
ds_read_b64_tr_b16 a[14:15], v5 offset:12544
v_mfma_f32_16x16x32_bf16 v[176:179], a[16:19], a[232:235], v[176:179]
v_mfma_f32_16x16x32_bf16 v[176:179], a[20:23], a[248:251], v[176:179]
v_mfma_f32_16x16x32_bf16 v[184:187], a[20:23], a[252:255], v[184:187]
s_waitcnt vmcnt(1)
v_mfma_f32_16x16x32_bf16 v[184:187], a[16:19], a[236:239], v[184:187]
s_barrier
v_mfma_f32_16x16x32_bf16 v[188:191], a[24:27], a[236:239], v[188:191]
ds_read_b64_tr_b16 a[16:17], v4 offset:16640
v_mfma_f32_16x16x32_bf16 v[188:191], a[28:31], a[252:255], v[188:191]
ds_read_b64_tr_b16 a[18:19], v4 offset:20736
v_mfma_f32_16x16x32_bf16 v[180:183], a[28:31], a[248:251], v[180:183]
ds_read_b64_tr_b16 a[20:21], v4 offset:24832
v_mfma_f32_16x16x32_bf16 v[180:183], a[24:27], a[232:235], v[180:183]
ds_read_b64_tr_b16 a[22:23], v4 offset:28928
v_mfma_f32_16x16x32_bf16 v[172:175], a[24:27], a[228:231], v[172:175]
v_mfma_f32_16x16x32_bf16 v[172:175], a[28:31], a[244:247], v[172:175]
v_mfma_f32_16x16x32_bf16 v[164:167], a[28:31], a[240:243], v[164:167]
v_mfma_f32_16x16x32_bf16 v[164:167], a[24:27], a[224:227], v[164:167]
s_waitcnt lgkmcnt(4)
v_mfma_f32_16x16x32_bf16 v[160:163], a[0:3], a[64:67], v[160:163]
ds_read_b64_tr_b16 a[24:25], v5 offset:16640
v_mfma_f32_16x16x32_bf16 v[160:163], a[4:7], a[80:83], v[160:163]
ds_read_b64_tr_b16 a[26:27], v5 offset:20736
v_mfma_f32_16x16x32_bf16 v[168:171], a[4:7], a[84:87], v[168:171]
ds_read_b64_tr_b16 a[28:29], v5 offset:24832
v_mfma_f32_16x16x32_bf16 v[168:171], a[0:3], a[68:71], v[168:171]
ds_read_b64_tr_b16 a[30:31], v5 offset:28928
v_mfma_f32_16x16x32_bf16 v[176:179], a[0:3], a[72:75], v[176:179]
v_mfma_f32_16x16x32_bf16 v[176:179], a[4:7], a[88:91], v[176:179]
v_mfma_f32_16x16x32_bf16 v[184:187], a[4:7], a[92:95], v[184:187]
v_mfma_f32_16x16x32_bf16 v[184:187], a[0:3], a[76:79], v[184:187]
v_mfma_f32_16x16x32_bf16 v[188:191], a[8:11], a[76:79], v[188:191]
ds_read_b64_tr_b16 a[0:1], v15 offset:16896
v_mfma_f32_16x16x32_bf16 v[188:191], a[12:15], a[92:95], v[188:191]
ds_read_b64_tr_b16 a[2:3], v15 offset:20992
v_mfma_f32_16x16x32_bf16 v[180:183], a[12:15], a[88:91], v[180:183]
ds_read_b64_tr_b16 a[4:5], v15 offset:25088
v_mfma_f32_16x16x32_bf16 v[180:183], a[8:11], a[72:75], v[180:183]
ds_read_b64_tr_b16 a[6:7], v15 offset:29184
v_mfma_f32_16x16x32_bf16 v[172:175], a[8:11], a[68:71], v[172:175]
v_mfma_f32_16x16x32_bf16 v[172:175], a[12:15], a[84:87], v[172:175]
v_mfma_f32_16x16x32_bf16 v[164:167], a[12:15], a[80:83], v[164:167]
v_mfma_f32_16x16x32_bf16 v[164:167], a[8:11], a[64:67], v[164:167]
s_waitcnt lgkmcnt(4)
v_mfma_f32_16x16x32_bf16 v[160:163], a[16:19], a[96:99], v[160:163]
ds_read_b64_tr_b16 a[8:9], v19 offset:16896
v_mfma_f32_16x16x32_bf16 v[160:163], a[20:23], a[112:115], v[160:163]
ds_read_b64_tr_b16 a[10:11], v19 offset:20992
v_mfma_f32_16x16x32_bf16 v[168:171], a[20:23], a[116:119], v[168:171]
ds_read_b64_tr_b16 a[12:13], v19 offset:25088
v_mfma_f32_16x16x32_bf16 v[168:171], a[16:19], a[100:103], v[168:171]
ds_read_b64_tr_b16 a[14:15], v19 offset:29184
v_mfma_f32_16x16x32_bf16 v[176:179], a[16:19], a[104:107], v[176:179]
v_mfma_f32_16x16x32_bf16 v[176:179], a[20:23], a[120:123], v[176:179]
v_mfma_f32_16x16x32_bf16 v[184:187], a[20:23], a[124:127], v[184:187]
v_mfma_f32_16x16x32_bf16 v[184:187], a[16:19], a[108:111], v[184:187]
v_mfma_f32_16x16x32_bf16 v[188:191], a[24:27], a[108:111], v[188:191]
ds_read_b64_tr_b16 a[16:17], v4 offset:512
v_mfma_f32_16x16x32_bf16 v[188:191], a[28:31], a[124:127], v[188:191]
ds_read_b64_tr_b16 a[18:19], v4 offset:4608
v_mfma_f32_16x16x32_bf16 v[180:183], a[28:31], a[120:123], v[180:183]
ds_read_b64_tr_b16 a[20:21], v4 offset:8704
v_mfma_f32_16x16x32_bf16 v[180:183], a[24:27], a[104:107], v[180:183]
ds_read_b64_tr_b16 a[22:23], v4 offset:12800
v_mfma_f32_16x16x32_bf16 v[172:175], a[24:27], a[100:103], v[172:175]
s_waitcnt vmcnt(0)
s_mov_b32 s92, 200000
L_spin_p:
v_cmp_gt_u32 vcc, 1, v14
s_nop 4
s_cbranch_vccz L_spun_p
s_sub_u32 s92, s92, 1
s_cbranch_scc1 L_spun_p
s_sleep 6
buffer_load_dword v14, v7, s[88:91], s11 offen sc1
s_waitcnt vmcnt(0)
s_branch L_spin_p
L_spun_p:
v_mfma_f32_16x16x32_bf16 v[172:175], a[28:31], a[116:119], v[172:175]
v_fmac_f32 v80, v11, v184
v_fmac_f32 v81, v11, v185
v_mfma_f32_16x16x32_bf16 v[164:167], a[28:31], a[112:115], v[164:167]
v_fmac_f32 v82, v11, v186
v_fmac_f32 v83, v11, v187
v_mfma_f32_16x16x32_bf16 v[164:167], a[24:27], a[96:99], v[164:167]
s_waitcnt lgkmcnt(4)
v_fmac_f32 v84, v11, v188
v_fmac_f32 v85, v11, v189
v_mfma_f32_16x16x32_bf16 v[192:195], a[0:3], a[224:227], v[192:195]
ds_read_b64_tr_b16 a[24:25], v5 offset:512
v_fmac_f32 v86, v11, v190
v_mfma_f32_16x16x32_bf16 v[192:195], a[4:7], a[240:243], v[192:195]
ds_read_b64_tr_b16 a[26:27], v5 offset:4608
v_fmac_f32 v87, v11, v191
v_mfma_f32_16x16x32_bf16 v[200:203], a[4:7], a[244:247], v[200:203]
ds_read_b64_tr_b16 a[28:29], v5 offset:8704
v_cvt_pk_bf16_f32 v80, v80, v81
v_mfma_f32_16x16x32_bf16 v[200:203], a[0:3], a[228:231], v[200:203]
ds_read_b64_tr_b16 a[30:31], v5 offset:12800
v_cvt_pk_bf16_f32 v81, v82, v83
v_mfma_f32_16x16x32_bf16 v[208:211], a[0:3], a[232:235], v[208:211]
v_cvt_pk_bf16_f32 v82, v84, v85
v_cvt_pk_bf16_f32 v83, v86, v87
v_mfma_f32_16x16x32_bf16 v[208:211], a[4:7], a[248:251], v[208:211]
buffer_store_dwordx4 v[80:83], v3, s[88:91], s52 offen offset:3072 sc1
v_mfma_f32_16x16x32_bf16 v[216:219], a[4:7], a[252:255], v[216:219]
v_fmac_f32 v72, v10, v176
v_fmac_f32 v73, v10, v177
v_mfma_f32_16x16x32_bf16 v[216:219], a[0:3], a[236:239], v[216:219]
v_fmac_f32 v74, v10, v178
v_fmac_f32 v75, v10, v179
v_mfma_f32_16x16x32_bf16 v[220:223], a[8:11], a[236:239], v[220:223]
ds_read_b64_tr_b16 a[0:1], v4 offset:16896
v_fmac_f32 v76, v10, v180
v_mfma_f32_16x16x32_bf16 v[220:223], a[12:15], a[252:255], v[220:223]
ds_read_b64_tr_b16 a[2:3], v4 offset:20992
v_fmac_f32 v77, v10, v181
v_mfma_f32_16x16x32_bf16 v[212:215], a[12:15], a[248:251], v[212:215]
ds_read_b64_tr_b16 a[4:5], v4 offset:25088
v_fmac_f32 v78, v10, v182
v_mfma_f32_16x16x32_bf16 v[212:215], a[8:11], a[232:235], v[212:215]
ds_read_b64_tr_b16 a[6:7], v4 offset:29184
v_fmac_f32 v79, v10, v183
v_mfma_f32_16x16x32_bf16 v[204:207], a[8:11], a[228:231], v[204:207]
v_cvt_pk_bf16_f32 v72, v72, v73
v_cvt_pk_bf16_f32 v73, v74, v75
v_mfma_f32_16x16x32_bf16 v[204:207], a[12:15], a[244:247], v[204:207]
v_cvt_pk_bf16_f32 v74, v76, v77
v_cvt_pk_bf16_f32 v75, v78, v79
v_mfma_f32_16x16x32_bf16 v[196:199], a[12:15], a[240:243], v[196:199]
buffer_store_dwordx4 v[72:75], v3, s[88:91], s52 offen offset:2048 sc1
v_mfma_f32_16x16x32_bf16 v[196:199], a[8:11], a[224:227], v[196:199]
s_waitcnt lgkmcnt(4)
v_fmac_f32 v64, v9, v168
v_fmac_f32 v65, v9, v169
v_mfma_f32_16x16x32_bf16 v[192:195], a[16:19], a[64:67], v[192:195]
ds_read_b64_tr_b16 a[8:9], v5 offset:16896
v_fmac_f32 v66, v9, v170
v_mfma_f32_16x16x32_bf16 v[192:195], a[20:23], a[80:83], v[192:195]
ds_read_b64_tr_b16 a[10:11], v5 offset:20992
v_fmac_f32 v67, v9, v171
v_mfma_f32_16x16x32_bf16 v[200:203], a[20:23], a[84:87], v[200:203]
ds_read_b64_tr_b16 a[12:13], v5 offset:25088
v_fmac_f32 v68, v9, v172
v_mfma_f32_16x16x32_bf16 v[200:203], a[16:19], a[68:71], v[200:203]
ds_read_b64_tr_b16 a[14:15], v5 offset:29184
v_fmac_f32 v69, v9, v173
v_mfma_f32_16x16x32_bf16 v[208:211], a[16:19], a[72:75], v[208:211]
v_fmac_f32 v70, v9, v174
v_fmac_f32 v71, v9, v175
v_mfma_f32_16x16x32_bf16 v[208:211], a[20:23], a[88:91], v[208:211]
v_cvt_pk_bf16_f32 v64, v64, v65
v_cvt_pk_bf16_f32 v65, v66, v67
v_mfma_f32_16x16x32_bf16 v[216:219], a[20:23], a[92:95], v[216:219]
v_cvt_pk_bf16_f32 v66, v68, v69
v_cvt_pk_bf16_f32 v67, v70, v71
v_mfma_f32_16x16x32_bf16 v[216:219], a[16:19], a[76:79], v[216:219]
buffer_store_dwordx4 v[64:67], v3, s[88:91], s52 offen offset:1024 sc1
v_mfma_f32_16x16x32_bf16 v[220:223], a[24:27], a[76:79], v[220:223]
ds_read_b64_tr_b16 a[16:17], v15 offset:768
v_fmac_f32 v56, v8, v160
v_mfma_f32_16x16x32_bf16 v[220:223], a[28:31], a[92:95], v[220:223]
ds_read_b64_tr_b16 a[18:19], v15 offset:4864
v_fmac_f32 v57, v8, v161
v_mfma_f32_16x16x32_bf16 v[212:215], a[28:31], a[88:91], v[212:215]
ds_read_b64_tr_b16 a[20:21], v15 offset:8960
v_fmac_f32 v58, v8, v162
v_mfma_f32_16x16x32_bf16 v[212:215], a[24:27], a[72:75], v[212:215]
ds_read_b64_tr_b16 a[22:23], v15 offset:13056
v_fmac_f32 v59, v8, v163
v_mfma_f32_16x16x32_bf16 v[204:207], a[24:27], a[68:71], v[204:207]
v_fmac_f32 v60, v8, v164
v_fmac_f32 v61, v8, v165
v_mfma_f32_16x16x32_bf16 v[204:207], a[28:31], a[84:87], v[204:207]
v_fmac_f32 v62, v8, v166
v_fmac_f32 v63, v8, v167
v_mfma_f32_16x16x32_bf16 v[196:199], a[28:31], a[80:83], v[196:199]
v_cvt_pk_bf16_f32 v56, v56, v57
v_cvt_pk_bf16_f32 v57, v58, v59
v_mfma_f32_16x16x32_bf16 v[196:199], a[24:27], a[64:67], v[196:199]
s_waitcnt lgkmcnt(4)
v_cvt_pk_bf16_f32 v58, v60, v61
v_cvt_pk_bf16_f32 v59, v62, v63
v_mfma_f32_16x16x32_bf16 v[192:195], a[0:3], a[96:99], v[192:195]
ds_read_b64_tr_b16 a[24:25], v19 offset:768
v_mfma_f32_16x16x32_bf16 v[192:195], a[4:7], a[112:115], v[192:195]
ds_read_b64_tr_b16 a[26:27], v19 offset:4864
v_mfma_f32_16x16x32_bf16 v[200:203], a[4:7], a[116:119], v[200:203]
ds_read_b64_tr_b16 a[28:29], v19 offset:8960
v_mfma_f32_16x16x32_bf16 v[200:203], a[0:3], a[100:103], v[200:203]
ds_read_b64_tr_b16 a[30:31], v19 offset:13056
v_mfma_f32_16x16x32_bf16 v[208:211], a[0:3], a[104:107], v[208:211]
buffer_store_dwordx4 v[56:59], v3, s[88:91], s52 offen offset:0 sc1
v_mfma_f32_16x16x32_bf16 v[208:211], a[4:7], a[120:123], v[208:211]
v_mfma_f32_16x16x32_bf16 v[216:219], a[4:7], a[124:127], v[216:219]
v_mfma_f32_16x16x32_bf16 v[216:219], a[0:3], a[108:111], v[216:219]
v_mfma_f32_16x16x32_bf16 v[220:223], a[8:11], a[108:111], v[220:223]
ds_read_b64_tr_b16 a[0:1], v15 offset:17152
v_mfma_f32_16x16x32_bf16 v[220:223], a[12:15], a[124:127], v[220:223]
ds_read_b64_tr_b16 a[2:3], v15 offset:21248
v_mfma_f32_16x16x32_bf16 v[212:215], a[12:15], a[120:123], v[212:215]
ds_read_b64_tr_b16 a[4:5], v15 offset:25344
v_mfma_f32_16x16x32_bf16 v[212:215], a[8:11], a[104:107], v[212:215]
ds_read_b64_tr_b16 a[6:7], v15 offset:29440
v_mfma_f32_16x16x32_bf16 v[204:207], a[8:11], a[100:103], v[204:207]
v_mfma_f32_16x16x32_bf16 v[204:207], a[12:15], a[116:119], v[204:207]
v_fmac_f32 v112, v11, v216
v_fmac_f32 v113, v11, v217
v_mfma_f32_16x16x32_bf16 v[196:199], a[12:15], a[112:115], v[196:199]
v_fmac_f32 v114, v11, v218
v_fmac_f32 v115, v11, v219
v_mfma_f32_16x16x32_bf16 v[196:199], a[8:11], a[96:99], v[196:199]
s_waitcnt lgkmcnt(4)
v_fmac_f32 v116, v11, v220
v_fmac_f32 v117, v11, v221
v_mfma_f32_16x16x32_bf16 v[224:227], a[16:19], a[192:195], v[224:227]
ds_read_b64_tr_b16 a[8:9], v19 offset:17152
v_fmac_f32 v118, v11, v222
v_mfma_f32_16x16x32_bf16 v[224:227], a[20:23], a[208:211], v[224:227]
ds_read_b64_tr_b16 a[10:11], v19 offset:21248
v_fmac_f32 v119, v11, v223
v_mfma_f32_16x16x32_bf16 v[232:235], a[20:23], a[212:215], v[232:235]
ds_read_b64_tr_b16 a[12:13], v19 offset:25344
v_cvt_pk_bf16_f32 v112, v112, v113
v_mfma_f32_16x16x32_bf16 v[232:235], a[16:19], a[196:199], v[232:235]
ds_read_b64_tr_b16 a[14:15], v19 offset:29440
v_cvt_pk_bf16_f32 v113, v114, v115
v_mfma_f32_16x16x32_bf16 v[240:243], a[16:19], a[200:203], v[240:243]
v_cvt_pk_bf16_f32 v114, v116, v117
v_cvt_pk_bf16_f32 v115, v118, v119
v_mfma_f32_16x16x32_bf16 v[240:243], a[20:23], a[216:219], v[240:243]
buffer_load_dword v14, v1, s[88:91], s44 offen sc1
v_mfma_f32_16x16x32_bf16 v[248:251], a[20:23], a[220:223], v[248:251]
buffer_store_dwordx4 v[112:115], v3, s[88:91], s53 offen offset:3072 sc1
v_mfma_f32_16x16x32_bf16 v[248:251], a[16:19], a[204:207], v[248:251]
v_fmac_f32 v104, v10, v208
v_fmac_f32 v105, v10, v209
v_mfma_f32_16x16x32_bf16 v[252:255], a[24:27], a[204:207], v[252:255]
ds_read_b64_tr_b16 a[16:17], v4 offset:768
v_fmac_f32 v106, v10, v210
v_mfma_f32_16x16x32_bf16 v[252:255], a[28:31], a[220:223], v[252:255]
ds_read_b64_tr_b16 a[18:19], v4 offset:4864
v_fmac_f32 v107, v10, v211
v_mfma_f32_16x16x32_bf16 v[244:247], a[28:31], a[216:219], v[244:247]
ds_read_b64_tr_b16 a[20:21], v4 offset:8960
v_fmac_f32 v108, v10, v212
v_mfma_f32_16x16x32_bf16 v[244:247], a[24:27], a[200:203], v[244:247]
ds_read_b64_tr_b16 a[22:23], v4 offset:13056
v_fmac_f32 v109, v10, v213
v_mfma_f32_16x16x32_bf16 v[236:239], a[24:27], a[196:199], v[236:239]
v_fmac_f32 v110, v10, v214
v_fmac_f32 v111, v10, v215
v_mfma_f32_16x16x32_bf16 v[236:239], a[28:31], a[212:215], v[236:239]
v_cvt_pk_bf16_f32 v104, v104, v105
v_cvt_pk_bf16_f32 v105, v106, v107
v_mfma_f32_16x16x32_bf16 v[228:231], a[28:31], a[208:211], v[228:231]
v_cvt_pk_bf16_f32 v106, v108, v109
v_cvt_pk_bf16_f32 v107, v110, v111
v_mfma_f32_16x16x32_bf16 v[228:231], a[24:27], a[192:195], v[228:231]
s_waitcnt lgkmcnt(4)
v_mfma_f32_16x16x32_bf16 v[224:227], a[0:3], a[224:227], v[224:227]
ds_read_b64_tr_b16 a[24:25], v5 offset:768
v_mfma_f32_16x16x32_bf16 v[224:227], a[4:7], a[240:243], v[224:227]
ds_read_b64_tr_b16 a[26:27], v5 offset:4864
v_mfma_f32_16x16x32_bf16 v[232:235], a[4:7], a[244:247], v[232:235]
ds_read_b64_tr_b16 a[28:29], v5 offset:8960
v_mfma_f32_16x16x32_bf16 v[232:235], a[0:3], a[228:231], v[232:235]
ds_read_b64_tr_b16 a[30:31], v5 offset:13056
v_mfma_f32_16x16x32_bf16 v[240:243], a[0:3], a[232:235], v[240:243]
buffer_store_dwordx4 v[104:107], v3, s[88:91], s53 offen offset:2048 sc1
v_mfma_f32_16x16x32_bf16 v[240:243], a[4:7], a[248:251], v[240:243]
v_fmac_f32 v96, v9, v200
v_fmac_f32 v97, v9, v201
v_mfma_f32_16x16x32_bf16 v[248:251], a[4:7], a[252:255], v[248:251]
v_fmac_f32 v98, v9, v202
v_fmac_f32 v99, v9, v203
v_mfma_f32_16x16x32_bf16 v[248:251], a[0:3], a[236:239], v[248:251]
v_fmac_f32 v100, v9, v204
v_fmac_f32 v101, v9, v205
v_mfma_f32_16x16x32_bf16 v[252:255], a[8:11], a[236:239], v[252:255]
ds_read_b64_tr_b16 a[0:1], v4 offset:17152
v_fmac_f32 v102, v9, v206
v_mfma_f32_16x16x32_bf16 v[252:255], a[12:15], a[252:255], v[252:255]
ds_read_b64_tr_b16 a[2:3], v4 offset:21248
v_fmac_f32 v103, v9, v207
v_mfma_f32_16x16x32_bf16 v[244:247], a[12:15], a[248:251], v[244:247]
ds_read_b64_tr_b16 a[4:5], v4 offset:25344
v_cvt_pk_bf16_f32 v96, v96, v97
v_mfma_f32_16x16x32_bf16 v[244:247], a[8:11], a[232:235], v[244:247]
ds_read_b64_tr_b16 a[6:7], v4 offset:29440
v_cvt_pk_bf16_f32 v97, v98, v99
v_mfma_f32_16x16x32_bf16 v[236:239], a[8:11], a[228:231], v[236:239]
v_cvt_pk_bf16_f32 v98, v100, v101
v_cvt_pk_bf16_f32 v99, v102, v103
v_mfma_f32_16x16x32_bf16 v[236:239], a[12:15], a[244:247], v[236:239]
buffer_store_dwordx4 v[96:99], v3, s[88:91], s53 offen offset:1024 sc1
v_mfma_f32_16x16x32_bf16 v[228:231], a[12:15], a[240:243], v[228:231]
v_fmac_f32 v88, v8, v192
v_fmac_f32 v89, v8, v193
v_mfma_f32_16x16x32_bf16 v[228:231], a[8:11], a[224:227], v[228:231]
s_waitcnt lgkmcnt(4)
v_fmac_f32 v90, v8, v194
v_fmac_f32 v91, v8, v195
v_mfma_f32_16x16x32_bf16 v[224:227], a[16:19], a[64:67], v[224:227]
ds_read_b64_tr_b16 a[8:9], v5 offset:17152
v_fmac_f32 v92, v8, v196
v_mfma_f32_16x16x32_bf16 v[224:227], a[20:23], a[80:83], v[224:227]
ds_read_b64_tr_b16 a[10:11], v5 offset:21248
v_fmac_f32 v93, v8, v197
v_mfma_f32_16x16x32_bf16 v[232:235], a[20:23], a[84:87], v[232:235]
ds_read_b64_tr_b16 a[12:13], v5 offset:25344
v_fmac_f32 v94, v8, v198
v_mfma_f32_16x16x32_bf16 v[232:235], a[16:19], a[68:71], v[232:235]
ds_read_b64_tr_b16 a[14:15], v5 offset:29440
v_fmac_f32 v95, v8, v199
v_mfma_f32_16x16x32_bf16 v[240:243], a[16:19], a[72:75], v[240:243]
v_cvt_pk_bf16_f32 v88, v88, v89
v_cvt_pk_bf16_f32 v89, v90, v91
v_mfma_f32_16x16x32_bf16 v[240:243], a[20:23], a[88:91], v[240:243]
v_cvt_pk_bf16_f32 v90, v92, v93
v_cvt_pk_bf16_f32 v91, v94, v95
v_mfma_f32_16x16x32_bf16 v[248:251], a[20:23], a[92:95], v[248:251]
buffer_store_dwordx4 v[88:91], v3, s[88:91], s53 offen offset:0 sc1
v_mfma_f32_16x16x32_bf16 v[248:251], a[16:19], a[76:79], v[248:251]
v_mfma_f32_16x16x32_bf16 v[252:255], a[24:27], a[76:79], v[252:255]
ds_read_b64_tr_b16 a[16:17], v4 offset:49152
v_mfma_f32_16x16x32_bf16 v[252:255], a[28:31], a[92:95], v[252:255]
ds_read_b64_tr_b16 a[18:19], v4 offset:53248
v_mfma_f32_16x16x32_bf16 v[244:247], a[28:31], a[88:91], v[244:247]
ds_read_b64_tr_b16 a[20:21], v4 offset:57344
v_mfma_f32_16x16x32_bf16 v[244:247], a[24:27], a[72:75], v[244:247]
ds_read_b64_tr_b16 a[22:23], v4 offset:61440
v_mfma_f32_16x16x32_bf16 v[236:239], a[24:27], a[68:71], v[236:239]
v_mfma_f32_16x16x32_bf16 v[236:239], a[28:31], a[84:87], v[236:239]
v_mfma_f32_16x16x32_bf16 v[228:231], a[28:31], a[80:83], v[228:231]
v_mfma_f32_16x16x32_bf16 v[228:231], a[24:27], a[64:67], v[228:231]
s_waitcnt lgkmcnt(4)
v_mfma_f32_16x16x32_bf16 v[224:227], a[0:3], a[96:99], v[224:227]
ds_read_b64_tr_b16 a[24:25], v5 offset:49152
s_waitcnt vmcnt(4)
v_mfma_f32_16x16x32_bf16 v[224:227], a[4:7], a[112:115], v[224:227]
ds_read_b64_tr_b16 a[26:27], v5 offset:53248
v_cmp_ne_u32 vcc, -1, v14
v_mfma_f32_16x16x32_bf16 v[232:235], a[4:7], a[116:119], v[232:235]
ds_read_b64_tr_b16 a[28:29], v5 offset:57344
s_and_b32 s15, vcc_lo, 7
v_mfma_f32_16x16x32_bf16 v[232:235], a[0:3], a[100:103], v[232:235]
ds_read_b64_tr_b16 a[30:31], v5 offset:61440
v_mfma_f32_16x16x32_bf16 v[240:243], a[0:3], a[104:107], v[240:243]
s_bitcmp1_b32 s15, 0
s_cselect_b32 s50, s90, 0
v_mfma_f32_16x16x32_bf16 v[240:243], a[4:7], a[120:123], v[240:243]
buffer_load_dwordx4 v[160:163], v3, s[48:51], s44 offen offset:0 sc1
v_mfma_f32_16x16x32_bf16 v[248:251], a[4:7], a[124:127], v[248:251]
v_mfma_f32_16x16x32_bf16 v[248:251], a[0:3], a[108:111], v[248:251]
buffer_load_dwordx4 v[164:167], v3, s[48:51], s44 offen offset:1024 sc1
v_mfma_f32_16x16x32_bf16 v[252:255], a[8:11], a[108:111], v[252:255]
ds_read_b64_tr_b16 a[0:1], v15 offset:0
v_mfma_f32_16x16x32_bf16 v[252:255], a[12:15], a[124:127], v[252:255]
ds_read_b64_tr_b16 a[2:3], v15 offset:4096
v_mfma_f32_16x16x32_bf16 v[244:247], a[12:15], a[120:123], v[244:247]
ds_read_b64_tr_b16 a[4:5], v15 offset:8192
v_mfma_f32_16x16x32_bf16 v[244:247], a[8:11], a[104:107], v[244:247]
ds_read_b64_tr_b16 a[6:7], v15 offset:12288
v_mfma_f32_16x16x32_bf16 v[236:239], a[8:11], a[100:103], v[236:239]
buffer_load_dwordx4 v[168:171], v3, s[48:51], s44 offen offset:2048 sc1
v_mfma_f32_16x16x32_bf16 v[236:239], a[12:15], a[116:119], v[236:239]
v_mfma_f32_16x16x32_bf16 v[228:231], a[12:15], a[112:115], v[228:231]
buffer_load_dwordx4 v[172:175], v3, s[48:51], s44 offen offset:3072 sc1
v_mfma_f32_16x16x32_bf16 v[228:231], a[8:11], a[96:99], v[228:231]
s_waitcnt lgkmcnt(4)
v_mfma_f32_16x16x32_bf16 a[32:35], a[16:19], a[160:163], a[32:35]
ds_read_b64_tr_b16 a[8:9], v19 offset:0
v_fmac_f32 v144, v11, v248
v_mfma_f32_16x16x32_bf16 a[32:35], a[20:23], a[176:179], a[32:35]
ds_read_b64_tr_b16 a[10:11], v19 offset:4096
v_fmac_f32 v145, v11, v249
v_mfma_f32_16x16x32_bf16 a[40:43], a[20:23], a[180:183], a[40:43]
ds_read_b64_tr_b16 a[12:13], v19 offset:8192
v_fmac_f32 v146, v11, v250
v_mfma_f32_16x16x32_bf16 a[40:43], a[16:19], a[164:167], a[40:43]
ds_read_b64_tr_b16 a[14:15], v19 offset:12288
v_fmac_f32 v147, v11, v251
v_mfma_f32_16x16x32_bf16 a[48:51], a[16:19], a[168:171], a[48:51]
v_fmac_f32 v148, v11, v252
v_fmac_f32 v149, v11, v253
v_mfma_f32_16x16x32_bf16 a[48:51], a[20:23], a[184:187], a[48:51]
v_fmac_f32 v150, v11, v254
v_fmac_f32 v151, v11, v255
v_mfma_f32_16x16x32_bf16 v[152:155], a[20:23], a[188:191], v[152:155]
v_cvt_pk_bf16_f32 v144, v144, v145
v_cvt_pk_bf16_f32 v145, v146, v147
v_mfma_f32_16x16x32_bf16 v[152:155], a[16:19], a[172:175], v[152:155]
v_cvt_pk_bf16_f32 v146, v148, v149
v_cvt_pk_bf16_f32 v147, v150, v151
v_mfma_f32_16x16x32_bf16 v[156:159], a[24:27], a[172:175], v[156:159]
ds_read_b64_tr_b16 a[16:17], v15 offset:16384
v_mfma_f32_16x16x32_bf16 v[156:159], a[28:31], a[188:191], v[156:159]
ds_read_b64_tr_b16 a[18:19], v15 offset:20480
v_mfma_f32_16x16x32_bf16 a[52:55], a[28:31], a[184:187], a[52:55]
ds_read_b64_tr_b16 a[20:21], v15 offset:24576
v_mfma_f32_16x16x32_bf16 a[52:55], a[24:27], a[168:171], a[52:55]
ds_read_b64_tr_b16 a[22:23], v15 offset:28672
v_mfma_f32_16x16x32_bf16 a[44:47], a[24:27], a[164:167], a[44:47]
buffer_store_dwordx4 v[144:147], v3, s[88:91], s54 offen offset:3072 sc1
v_mfma_f32_16x16x32_bf16 a[44:47], a[28:31], a[180:183], a[44:47]
v_fmac_f32 v136, v10, v240
v_fmac_f32 v137, v10, v241
v_mfma_f32_16x16x32_bf16 a[36:39], a[28:31], a[176:179], a[36:39]
v_fmac_f32 v138, v10, v242
v_fmac_f32 v139, v10, v243
v_mfma_f32_16x16x32_bf16 a[36:39], a[24:27], a[160:163], a[36:39]
s_waitcnt lgkmcnt(4)
v_fmac_f32 v140, v10, v244
v_fmac_f32 v141, v10, v245
v_mfma_f32_16x16x32_bf16 a[32:35], a[0:3], a[192:195], a[32:35]
ds_read_b64_tr_b16 a[24:25], v19 offset:16384
v_fmac_f32 v142, v10, v246
v_mfma_f32_16x16x32_bf16 a[32:35], a[4:7], a[208:211], a[32:35]
ds_read_b64_tr_b16 a[26:27], v19 offset:20480
v_fmac_f32 v143, v10, v247
v_mfma_f32_16x16x32_bf16 a[40:43], a[4:7], a[212:215], a[40:43]
ds_read_b64_tr_b16 a[28:29], v19 offset:24576
v_cvt_pk_bf16_f32 v136, v136, v137
v_mfma_f32_16x16x32_bf16 a[40:43], a[0:3], a[196:199], a[40:43]
ds_read_b64_tr_b16 a[30:31], v19 offset:28672
v_cvt_pk_bf16_f32 v137, v138, v139
v_mfma_f32_16x16x32_bf16 a[48:51], a[0:3], a[200:203], a[48:51]
v_cvt_pk_bf16_f32 v138, v140, v141
v_cvt_pk_bf16_f32 v139, v142, v143
v_mfma_f32_16x16x32_bf16 a[48:51], a[4:7], a[216:219], a[48:51]
buffer_store_dwordx4 v[136:139], v3, s[88:91], s54 offen offset:2048 sc1
v_mfma_f32_16x16x32_bf16 v[152:155], a[4:7], a[220:223], v[152:155]
v_fmac_f32 v128, v9, v232
v_fmac_f32 v129, v9, v233
v_mfma_f32_16x16x32_bf16 v[152:155], a[0:3], a[204:207], v[152:155]
v_fmac_f32 v130, v9, v234
v_fmac_f32 v131, v9, v235
v_mfma_f32_16x16x32_bf16 v[156:159], a[8:11], a[204:207], v[156:159]
ds_read_b64_tr_b16 a[0:1], v4 offset:0
v_fmac_f32 v132, v9, v236
v_mfma_f32_16x16x32_bf16 v[156:159], a[12:15], a[220:223], v[156:159]
ds_read_b64_tr_b16 a[2:3], v4 offset:4096
v_fmac_f32 v133, v9, v237
v_mfma_f32_16x16x32_bf16 a[52:55], a[12:15], a[216:219], a[52:55]
ds_read_b64_tr_b16 a[4:5], v4 offset:8192
v_fmac_f32 v134, v9, v238
v_mfma_f32_16x16x32_bf16 a[52:55], a[8:11], a[200:203], a[52:55]
ds_read_b64_tr_b16 a[6:7], v4 offset:12288
v_fmac_f32 v135, v9, v239
v_mfma_f32_16x16x32_bf16 a[44:47], a[8:11], a[196:199], a[44:47]
v_cvt_pk_bf16_f32 v128, v128, v129
v_cvt_pk_bf16_f32 v129, v130, v131
v_mfma_f32_16x16x32_bf16 a[44:47], a[12:15], a[212:215], a[44:47]
v_cvt_pk_bf16_f32 v130, v132, v133
v_cvt_pk_bf16_f32 v131, v134, v135
v_mfma_f32_16x16x32_bf16 a[36:39], a[12:15], a[208:211], a[36:39]
buffer_store_dwordx4 v[128:131], v3, s[88:91], s54 offen offset:1024 sc1
v_mfma_f32_16x16x32_bf16 a[36:39], a[8:11], a[192:195], a[36:39]
s_waitcnt lgkmcnt(4)
v_fmac_f32 v120, v8, v224
v_fmac_f32 v121, v8, v225
v_mfma_f32_16x16x32_bf16 a[32:35], a[16:19], a[224:227], a[32:35]
ds_read_b64_tr_b16 a[8:9], v5 offset:0
v_fmac_f32 v122, v8, v226
v_mfma_f32_16x16x32_bf16 a[32:35], a[20:23], a[240:243], a[32:35]
ds_read_b64_tr_b16 a[10:11], v5 offset:4096
v_fmac_f32 v123, v8, v227
v_mfma_f32_16x16x32_bf16 a[40:43], a[20:23], a[244:247], a[40:43]
ds_read_b64_tr_b16 a[12:13], v5 offset:8192
v_fmac_f32 v124, v8, v228
v_mfma_f32_16x16x32_bf16 a[40:43], a[16:19], a[228:231], a[40:43]
ds_read_b64_tr_b16 a[14:15], v5 offset:12288
v_fmac_f32 v125, v8, v229
v_mfma_f32_16x16x32_bf16 a[48:51], a[16:19], a[232:235], a[48:51]
v_fmac_f32 v126, v8, v230
v_fmac_f32 v127, v8, v231
v_mfma_f32_16x16x32_bf16 a[48:51], a[20:23], a[248:251], a[48:51]
v_cvt_pk_bf16_f32 v120, v120, v121
v_cvt_pk_bf16_f32 v121, v122, v123
v_mfma_f32_16x16x32_bf16 v[152:155], a[20:23], a[252:255], v[152:155]
v_cvt_pk_bf16_f32 v122, v124, v125
v_cvt_pk_bf16_f32 v123, v126, v127
v_mfma_f32_16x16x32_bf16 v[152:155], a[16:19], a[236:239], v[152:155]
buffer_store_dwordx4 v[120:123], v3, s[88:91], s54 offen offset:0 sc1
v_mfma_f32_16x16x32_bf16 v[156:159], a[24:27], a[236:239], v[156:159]
ds_read_b64_tr_b16 a[16:17], v4 offset:16384
v_mfma_f32_16x16x32_bf16 v[156:159], a[28:31], a[252:255], v[156:159]
ds_read_b64_tr_b16 a[18:19], v4 offset:20480
v_mfma_f32_16x16x32_bf16 a[52:55], a[28:31], a[248:251], a[52:55]
ds_read_b64_tr_b16 a[20:21], v4 offset:24576
v_mfma_f32_16x16x32_bf16 a[52:55], a[24:27], a[232:235], a[52:55]
ds_read_b64_tr_b16 a[22:23], v4 offset:28672
v_mfma_f32_16x16x32_bf16 a[44:47], a[24:27], a[228:231], a[44:47]
s_bitcmp1_b32 s15, 1
s_cselect_b32 s50, s90, 0
v_mfma_f32_16x16x32_bf16 a[44:47], a[28:31], a[244:247], a[44:47]
buffer_load_dwordx4 v[176:179], v3, s[48:51], s45 offen offset:0 sc1
v_mfma_f32_16x16x32_bf16 a[36:39], a[28:31], a[240:243], a[36:39]
v_mfma_f32_16x16x32_bf16 a[36:39], a[24:27], a[224:227], a[36:39]
s_waitcnt lgkmcnt(4)
v_mfma_f32_16x16x32_bf16 a[32:35], a[0:3], a[64:67], a[32:35]
ds_read_b64_tr_b16 a[24:25], v5 offset:16384
v_mfma_f32_16x16x32_bf16 a[32:35], a[4:7], a[80:83], a[32:35]
ds_read_b64_tr_b16 a[26:27], v5 offset:20480
v_mfma_f32_16x16x32_bf16 a[40:43], a[4:7], a[84:87], a[40:43]
ds_read_b64_tr_b16 a[28:29], v5 offset:24576
v_mfma_f32_16x16x32_bf16 a[40:43], a[0:3], a[68:71], a[40:43]
ds_read_b64_tr_b16 a[30:31], v5 offset:28672
v_mfma_f32_16x16x32_bf16 a[48:51], a[0:3], a[72:75], a[48:51]
buffer_load_dwordx4 v[180:183], v3, s[48:51], s45 offen offset:1024 sc1
v_mfma_f32_16x16x32_bf16 a[48:51], a[4:7], a[88:91], a[48:51]
v_mfma_f32_16x16x32_bf16 v[152:155], a[4:7], a[92:95], v[152:155]
buffer_load_dwordx4 v[184:187], v3, s[48:51], s45 offen offset:2048 sc1
v_mfma_f32_16x16x32_bf16 v[152:155], a[0:3], a[76:79], v[152:155]
v_mfma_f32_16x16x32_bf16 v[156:159], a[8:11], a[76:79], v[156:159]
buffer_load_dwordx4 v[188:191], v3, s[48:51], s45 offen offset:3072 sc1
v_mfma_f32_16x16x32_bf16 v[156:159], a[12:15], a[92:95], v[156:159]
v_mfma_f32_16x16x32_bf16 a[52:55], a[12:15], a[88:91], a[52:55]
s_bitcmp1_b32 s15, 2
s_cselect_b32 s50, s90, 0
v_mfma_f32_16x16x32_bf16 a[52:55], a[8:11], a[72:75], a[52:55]
buffer_load_dwordx4 v[192:195], v3, s[48:51], s46 offen offset:0 sc1
v_mfma_f32_16x16x32_bf16 a[44:47], a[8:11], a[68:71], a[44:47]
v_mfma_f32_16x16x32_bf16 a[44:47], a[12:15], a[84:87], a[44:47]
buffer_load_dwordx4 v[196:199], v3, s[48:51], s46 offen offset:1024 sc1
v_mfma_f32_16x16x32_bf16 a[36:39], a[12:15], a[80:83], a[36:39]
v_mfma_f32_16x16x32_bf16 a[36:39], a[8:11], a[64:67], a[36:39]
s_waitcnt lgkmcnt(0)
v_mfma_f32_16x16x32_bf16 a[32:35], a[16:19], a[96:99], a[32:35]
buffer_load_dwordx4 v[200:203], v3, s[48:51], s46 offen offset:2048 sc1
v_mfma_f32_16x16x32_bf16 a[32:35], a[20:23], a[112:115], a[32:35]
v_mfma_f32_16x16x32_bf16 a[40:43], a[20:23], a[116:119], a[40:43]
buffer_load_dwordx4 v[204:207], v3, s[48:51], s46 offen offset:3072 sc1
v_mfma_f32_16x16x32_bf16 a[40:43], a[16:19], a[100:103], a[40:43]
v_mfma_f32_16x16x32_bf16 a[48:51], a[16:19], a[104:107], a[48:51]
v_mfma_f32_16x16x32_bf16 a[48:51], a[20:23], a[120:123], a[48:51]
v_mfma_f32_16x16x32_bf16 v[152:155], a[20:23], a[124:127], v[152:155]
v_mfma_f32_16x16x32_bf16 v[152:155], a[16:19], a[108:111], v[152:155]
v_mfma_f32_16x16x32_bf16 v[156:159], a[24:27], a[108:111], v[156:159]
v_mfma_f32_16x16x32_bf16 v[156:159], a[28:31], a[124:127], v[156:159]
v_mfma_f32_16x16x32_bf16 a[52:55], a[28:31], a[120:123], a[52:55]
v_mfma_f32_16x16x32_bf16 a[52:55], a[24:27], a[104:107], a[52:55]
v_mfma_f32_16x16x32_bf16 a[44:47], a[24:27], a[100:103], a[44:47]
v_mfma_f32_16x16x32_bf16 a[44:47], a[28:31], a[116:119], a[44:47]
v_mfma_f32_16x16x32_bf16 a[36:39], a[28:31], a[112:115], a[36:39]
v_mfma_f32_16x16x32_bf16 a[36:39], a[24:27], a[96:99], a[36:39]
s_cmp_eq_u32 s15, 7
s_cbranch_scc1 L_x_all
buffer_load_dword v14, v1, s[88:91], s44 offen sc1
L_x_all:
v_pk_fma_f32 v[48:49], v[152:153], v[10:11], v[48:49] op_sel:[0,1,0] op_sel_hi:[1,1,1]
v_pk_fma_f32 v[50:51], v[154:155], v[10:11], v[50:51] op_sel:[0,1,0] op_sel_hi:[1,1,1]
v_pk_fma_f32 v[52:53], v[156:157], v[10:11], v[52:53] op_sel:[0,1,0] op_sel_hi:[1,1,1]
v_pk_fma_f32 v[54:55], v[158:159], v[10:11], v[54:55] op_sel:[0,1,0] op_sel_hi:[1,1,1]
L_padC4:
s_cmp_eq_u32 s95, 1
s_cbranch_scc1 L_hopC_ret
v_accvgpr_read_b32 v152, a48
v_accvgpr_read_b32 v153, a49
v_accvgpr_read_b32 v154, a50
v_accvgpr_read_b32 v155, a51
v_accvgpr_read_b32 v156, a52
v_accvgpr_read_b32 v157, a53
v_accvgpr_read_b32 v158, a54
v_accvgpr_read_b32 v159, a55
v_pk_fma_f32 v[40:41], v[152:153], v[10:11], v[40:41] op_sel_hi:[1,0,1]
v_pk_fma_f32 v[42:43], v[154:155], v[10:11], v[42:43] op_sel_hi:[1,0,1]
v_pk_fma_f32 v[44:45], v[156:157], v[10:11], v[44:45] op_sel_hi:[1,0,1]
v_pk_fma_f32 v[46:47], v[158:159], v[10:11], v[46:47] op_sel_hi:[1,0,1]
v_accvgpr_read_b32 v152, a40
v_accvgpr_read_b32 v153, a41
v_accvgpr_read_b32 v154, a42
v_accvgpr_read_b32 v155, a43
v_accvgpr_read_b32 v156, a44
v_accvgpr_read_b32 v157, a45
v_accvgpr_read_b32 v158, a46
v_accvgpr_read_b32 v159, a47
v_pk_fma_f32 v[32:33], v[152:153], v[8:9], v[32:33] op_sel:[0,1,0] op_sel_hi:[1,1,1]
v_pk_fma_f32 v[34:35], v[154:155], v[8:9], v[34:35] op_sel:[0,1,0] op_sel_hi:[1,1,1]
v_pk_fma_f32 v[36:37], v[156:157], v[8:9], v[36:37] op_sel:[0,1,0] op_sel_hi:[1,1,1]
v_pk_fma_f32 v[38:39], v[158:159], v[8:9], v[38:39] op_sel:[0,1,0] op_sel_hi:[1,1,1]
v_accvgpr_read_b32 v152, a32
v_accvgpr_read_b32 v153, a33
v_accvgpr_read_b32 v154, a34
v_accvgpr_read_b32 v155, a35
v_accvgpr_read_b32 v156, a36
v_accvgpr_read_b32 v157, a37
v_accvgpr_read_b32 v158, a38
v_accvgpr_read_b32 v159, a39
v_pk_fma_f32 v[24:25], v[152:153], v[8:9], v[24:25] op_sel_hi:[1,0,1]
v_pk_fma_f32 v[26:27], v[154:155], v[8:9], v[26:27] op_sel_hi:[1,0,1]
v_pk_fma_f32 v[28:29], v[156:157], v[8:9], v[28:29] op_sel_hi:[1,0,1]
v_pk_fma_f32 v[30:31], v[158:159], v[8:9], v[30:31] op_sel_hi:[1,0,1]
s_mov_b32 s10, 0x3f80
s_mov_b32 s11, 0x3f800000
s_mov_b32 s92, 200000
s_bitcmp0_b32 s15, 0
s_cbranch_scc1 L_look_x1
s_waitcnt vmcnt(12)
L_spin_x1:
v_max3_u32 v60, v160, v161, 0
v_max3_u32 v60, v162, v163, v60
v_max3_u32 v60, v164, v165, v60
v_max3_u32 v60, v166, v167, v60
v_max3_u32 v60, v168, v169, v60
v_max3_u32 v60, v170, v171, v60
v_max3_u32 v60, v172, v173, v60
v_max3_u32 v60, v174, v175, v60
v_cmp_eq_u32 vcc, -1, v60
s_nop 1
s_cbranch_vccnz L_again_x1
L_spun_x1:
v_dot2c_f32_bf16 v24, s10, v160
v_dot2c_f32_bf16 v25, s11, v160
v_dot2c_f32_bf16 v26, s10, v161
v_dot2c_f32_bf16 v27, s11, v161
v_dot2c_f32_bf16 v28, s10, v162
v_dot2c_f32_bf16 v29, s11, v162
v_dot2c_f32_bf16 v30, s10, v163
v_dot2c_f32_bf16 v31, s11, v163
v_dot2c_f32_bf16 v32, s10, v164
v_dot2c_f32_bf16 v33, s11, v164
v_dot2c_f32_bf16 v34, s10, v165
v_dot2c_f32_bf16 v35, s11, v165
v_dot2c_f32_bf16 v36, s10, v166
v_dot2c_f32_bf16 v37, s11, v166
v_dot2c_f32_bf16 v38, s10, v167
v_dot2c_f32_bf16 v39, s11, v167
v_dot2c_f32_bf16 v40, s10, v168
v_dot2c_f32_bf16 v41, s11, v168
v_dot2c_f32_bf16 v42, s10, v169
v_dot2c_f32_bf16 v43, s11, v169
v_dot2c_f32_bf16 v44, s10, v170
v_dot2c_f32_bf16 v45, s11, v170
v_dot2c_f32_bf16 v46, s10, v171
v_dot2c_f32_bf16 v47, s11, v171
v_dot2c_f32_bf16 v48, s10, v172
v_dot2c_f32_bf16 v49, s11, v172
v_dot2c_f32_bf16 v50, s10, v173
v_dot2c_f32_bf16 v51, s11, v173
v_dot2c_f32_bf16 v52, s10, v174
v_dot2c_f32_bf16 v53, s11, v174
v_dot2c_f32_bf16 v54, s10, v175
v_dot2c_f32_bf16 v55, s11, v175
s_mov_b32 s92, 200000
s_bitcmp0_b32 s15, 1
s_cbranch_scc1 L_look_x2
s_waitcnt vmcnt(4)
L_spin_x2:
v_max3_u32 v60, v176, v177, 0
v_max3_u32 v60, v178, v179, v60
v_max3_u32 v60, v180, v181, v60
v_max3_u32 v60, v182, v183, v60
v_max3_u32 v60, v184, v185, v60
v_max3_u32 v60, v186, v187, v60
v_max3_u32 v60, v188, v189, v60
v_max3_u32 v60, v190, v191, v60
v_cmp_eq_u32 vcc, -1, v60
s_nop 1
s_cbranch_vccnz L_again_x2
L_spun_x2:
v_dot2c_f32_bf16 v24, s10, v176
v_dot2c_f32_bf16 v25, s11, v176
v_dot2c_f32_bf16 v26, s10, v177
v_dot2c_f32_bf16 v27, s11, v177
v_dot2c_f32_bf16 v28, s10, v178
v_dot2c_f32_bf16 v29, s11, v178
v_dot2c_f32_bf16 v30, s10, v179
v_dot2c_f32_bf16 v31, s11, v179
v_dot2c_f32_bf16 v32, s10, v180
v_dot2c_f32_bf16 v33, s11, v180
v_dot2c_f32_bf16 v34, s10, v181
v_dot2c_f32_bf16 v35, s11, v181
v_dot2c_f32_bf16 v36, s10, v182
v_dot2c_f32_bf16 v37, s11, v182
v_dot2c_f32_bf16 v38, s10, v183
v_dot2c_f32_bf16 v39, s11, v183
v_dot2c_f32_bf16 v40, s10, v184
v_dot2c_f32_bf16 v41, s11, v184
v_dot2c_f32_bf16 v42, s10, v185
v_dot2c_f32_bf16 v43, s11, v185
v_dot2c_f32_bf16 v44, s10, v186
v_dot2c_f32_bf16 v45, s11, v186
v_dot2c_f32_bf16 v46, s10, v187
v_dot2c_f32_bf16 v47, s11, v187
v_dot2c_f32_bf16 v48, s10, v188
v_dot2c_f32_bf16 v49, s11, v188
v_dot2c_f32_bf16 v50, s10, v189
v_dot2c_f32_bf16 v51, s11, v189
v_dot2c_f32_bf16 v52, s10, v190
v_dot2c_f32_bf16 v53, s11, v190
v_dot2c_f32_bf16 v54, s10, v191
v_dot2c_f32_bf16 v55, s11, v191
s_mov_b32 s92, 200000
s_bitcmp0_b32 s15, 2
s_cbranch_scc1 L_look_x3
s_waitcnt vmcnt(0)
L_spin_x3:
v_max3_u32 v60, v192, v193, 0
v_max3_u32 v60, v194, v195, v60
v_max3_u32 v60, v196, v197, v60
v_max3_u32 v60, v198, v199, v60
v_max3_u32 v60, v200, v201, v60
v_max3_u32 v60, v202, v203, v60
v_max3_u32 v60, v204, v205, v60
v_max3_u32 v60, v206, v207, v60
v_cmp_eq_u32 vcc, -1, v60
s_nop 1
s_cbranch_vccnz L_again_x3
L_spun_x3:
v_dot2c_f32_bf16 v24, s10, v192
v_dot2c_f32_bf16 v25, s11, v192
v_dot2c_f32_bf16 v26, s10, v193
v_dot2c_f32_bf16 v27, s11, v193
v_dot2c_f32_bf16 v28, s10, v194
v_dot2c_f32_bf16 v29, s11, v194
v_dot2c_f32_bf16 v30, s10, v195
v_dot2c_f32_bf16 v31, s11, v195
v_cvt_pk_bf16_f32 v24, v24, v25
v_cvt_pk_bf16_f32 v25, v26, v27
v_cvt_pk_bf16_f32 v26, v28, v29
v_cvt_pk_bf16_f32 v27, v30, v31
s_nop 1
v_permlane16_swap_b32 v24, v26
v_permlane16_swap_b32 v25, v27
buffer_store_dwordx4 v[24:27], v2, s[80:83], s28 offen sc1
v_dot2c_f32_bf16 v32, s10, v196
v_dot2c_f32_bf16 v33, s11, v196
v_dot2c_f32_bf16 v34, s10, v197
v_dot2c_f32_bf16 v35, s11, v197
v_dot2c_f32_bf16 v36, s10, v198
v_dot2c_f32_bf16 v37, s11, v198
v_dot2c_f32_bf16 v38, s10, v199
v_dot2c_f32_bf16 v39, s11, v199
v_cvt_pk_bf16_f32 v32, v32, v33
v_cvt_pk_bf16_f32 v33, v34, v35
v_cvt_pk_bf16_f32 v34, v36, v37
v_cvt_pk_bf16_f32 v35, v38, v39
s_nop 1
v_permlane16_swap_b32 v32, v34
v_permlane16_swap_b32 v33, v35
buffer_store_dwordx4 v[32:35], v2, s[80:83], s29 offen sc1
v_dot2c_f32_bf16 v40, s10, v200
v_dot2c_f32_bf16 v41, s11, v200
v_dot2c_f32_bf16 v42, s10, v201
v_dot2c_f32_bf16 v43, s11, v201
v_dot2c_f32_bf16 v44, s10, v202
v_dot2c_f32_bf16 v45, s11, v202
v_dot2c_f32_bf16 v46, s10, v203
v_dot2c_f32_bf16 v47, s11, v203
v_cvt_pk_bf16_f32 v40, v40, v41
v_cvt_pk_bf16_f32 v41, v42, v43
v_cvt_pk_bf16_f32 v42, v44, v45
v_cvt_pk_bf16_f32 v43, v46, v47
s_nop 1
v_permlane16_swap_b32 v40, v42
v_permlane16_swap_b32 v41, v43
buffer_store_dwordx4 v[40:43], v2, s[80:83], s30 offen sc1
v_dot2c_f32_bf16 v48, s10, v204
v_dot2c_f32_bf16 v49, s11, v204
v_dot2c_f32_bf16 v50, s10, v205
v_dot2c_f32_bf16 v51, s11, v205
v_dot2c_f32_bf16 v52, s10, v206
v_dot2c_f32_bf16 v53, s11, v206
v_dot2c_f32_bf16 v54, s10, v207
v_dot2c_f32_bf16 v55, s11, v207
v_cvt_pk_bf16_f32 v48, v48, v49
v_cvt_pk_bf16_f32 v49, v50, v51
v_cvt_pk_bf16_f32 v50, v52, v53
v_cvt_pk_bf16_f32 v51, v54, v55
s_nop 1
v_permlane16_swap_b32 v48, v50
v_permlane16_swap_b32 v49, v51
buffer_store_dwordx4 v[48:51], v2, s[80:83], s31 offen sc1
L_end:
s_endpgm
L_look_x1:
s_waitcnt vmcnt(0)
v_cmp_ne_u32 vcc, -1, v14
s_sub_u32 s92, s92, 1
s_cselect_b32 s8, 7, vcc_lo
s_andn2_b32 s8, s8, s15
s_or_b32 s15, s15, s8
s_bitcmp0_b32 s8, 0
s_cbranch_scc1 L_not_x11
buffer_load_dwordx4 v[160:163], v3, s[88:91], s44 offen offset:0 sc1
buffer_load_dwordx4 v[164:167], v3, s[88:91], s44 offen offset:1024 sc1
buffer_load_dwordx4 v[168:171], v3, s[88:91], s44 offen offset:2048 sc1
buffer_load_dwordx4 v[172:175], v3, s[88:91], s44 offen offset:3072 sc1
L_not_x11:
s_bitcmp0_b32 s8, 1
s_cbranch_scc1 L_not_x12
buffer_load_dwordx4 v[176:179], v3, s[88:91], s45 offen offset:0 sc1
buffer_load_dwordx4 v[180:183], v3, s[88:91], s45 offen offset:1024 sc1
buffer_load_dwordx4 v[184:187], v3, s[88:91], s45 offen offset:2048 sc1
buffer_load_dwordx4 v[188:191], v3, s[88:91], s45 offen offset:3072 sc1
L_not_x12:
s_bitcmp0_b32 s8, 2
s_cbranch_scc1 L_not_x13
buffer_load_dwordx4 v[192:195], v3, s[88:91], s46 offen offset:0 sc1
buffer_load_dwordx4 v[196:199], v3, s[88:91], s46 offen offset:1024 sc1
buffer_load_dwordx4 v[200:203], v3, s[88:91], s46 offen offset:2048 sc1
buffer_load_dwordx4 v[204:207], v3, s[88:91], s46 offen offset:3072 sc1
L_not_x13:
buffer_load_dword v14, v1, s[88:91], s44 offen sc1
s_bitcmp0_b32 s15, 0
s_cbranch_scc1 L_look_x1
s_mov_b32 s92, 200000
s_waitcnt vmcnt(1)
s_branch L_spin_x1
L_again_x1:
s_sub_u32 s92, s92, 1
s_cbranch_scc1 L_spun_x1
buffer_load_dwordx4 v[160:163], v3, s[88:91], s44 offen offset:0 sc1
buffer_load_dwordx4 v[164:167], v3, s[88:91], s44 offen offset:1024 sc1
buffer_load_dwordx4 v[168:171], v3, s[88:91], s44 offen offset:2048 sc1
buffer_load_dwordx4 v[172:175], v3, s[88:91], s44 offen offset:3072 sc1
s_waitcnt vmcnt(0)
s_branch L_spin_x1
L_look_x2:
s_waitcnt vmcnt(0)
v_cmp_ne_u32 vcc, -1, v14
s_sub_u32 s92, s92, 1
s_cselect_b32 s8, 7, vcc_lo
s_andn2_b32 s8, s8, s15
s_or_b32 s15, s15, s8
s_bitcmp0_b32 s8, 1
s_cbranch_scc1 L_not_x22
buffer_load_dwordx4 v[176:179], v3, s[88:91], s45 offen offset:0 sc1
buffer_load_dwordx4 v[180:183], v3, s[88:91], s45 offen offset:1024 sc1
buffer_load_dwordx4 v[184:187], v3, s[88:91], s45 offen offset:2048 sc1
buffer_load_dwordx4 v[188:191], v3, s[88:91], s45 offen offset:3072 sc1
L_not_x22:
s_bitcmp0_b32 s8, 2
s_cbranch_scc1 L_not_x23
buffer_load_dwordx4 v[192:195], v3, s[88:91], s46 offen offset:0 sc1
buffer_load_dwordx4 v[196:199], v3, s[88:91], s46 offen offset:1024 sc1
buffer_load_dwordx4 v[200:203], v3, s[88:91], s46 offen offset:2048 sc1
buffer_load_dwordx4 v[204:207], v3, s[88:91], s46 offen offset:3072 sc1
L_not_x23:
buffer_load_dword v14, v1, s[88:91], s44 offen sc1
s_bitcmp0_b32 s15, 1
s_cbranch_scc1 L_look_x2
s_mov_b32 s92, 200000
s_waitcnt vmcnt(1)
s_branch L_spin_x2
L_again_x2:
s_sub_u32 s92, s92, 1
s_cbranch_scc1 L_spun_x2
buffer_load_dwordx4 v[176:179], v3, s[88:91], s45 offen offset:0 sc1
buffer_load_dwordx4 v[180:183], v3, s[88:91], s45 offen offset:1024 sc1
buffer_load_dwordx4 v[184:187], v3, s[88:91], s45 offen offset:2048 sc1
buffer_load_dwordx4 v[188:191], v3, s[88:91], s45 offen offset:3072 sc1
s_waitcnt vmcnt(0)
s_branch L_spin_x2
L_look_x3:
s_waitcnt vmcnt(0)
v_cmp_ne_u32 vcc, -1, v14
s_sub_u32 s92, s92, 1
s_cselect_b32 s8, 7, vcc_lo
s_andn2_b32 s8, s8, s15
s_or_b32 s15, s15, s8
s_bitcmp0_b32 s8, 2
s_cbranch_scc1 L_not_x33
buffer_load_dwordx4 v[192:195], v3, s[88:91], s46 offen offset:0 sc1
buffer_load_dwordx4 v[196:199], v3, s[88:91], s46 offen offset:1024 sc1
buffer_load_dwordx4 v[200:203], v3, s[88:91], s46 offen offset:2048 sc1
buffer_load_dwordx4 v[204:207], v3, s[88:91], s46 offen offset:3072 sc1
L_not_x33:
buffer_load_dword v14, v1, s[88:91], s44 offen sc1
s_bitcmp0_b32 s15, 2
s_cbranch_scc1 L_look_x3
s_mov_b32 s92, 200000
s_waitcnt vmcnt(1)
s_branch L_spin_x3
L_again_x3:
s_sub_u32 s92, s92, 1
s_cbranch_scc1 L_spun_x3
buffer_load_dwordx4 v[192:195], v3, s[88:91], s46 offen offset:0 sc1
buffer_load_dwordx4 v[196:199], v3, s[88:91], s46 offen offset:1024 sc1
buffer_load_dwordx4 v[200:203], v3, s[88:91], s46 offen offset:2048 sc1
buffer_load_dwordx4 v[204:207], v3, s[88:91], s46 offen offset:3072 sc1
s_waitcnt vmcnt(0)
s_branch L_spin_x3
L_att_fallback:
s_waitcnt vmcnt(0)
s_mov_b32 s33, 1
s_mul_i32 s32, s5, 0x10c400
s_lshl_b32 s19, s4, 13
s_add_u32 s32, s32, s19
s_cmp_eq_u32 s4, 0
s_cselect_b32 s94, 0x200000, 0
s_add_u32 s32, s32, s94
s_sub_u32 s94, 0x8000, s94
s_add_u32 s7, s32, 0x1000
s_add_u32 s27, s19, 131072
v_and_b32 v5, 15, v0
v_lshrrev_b32 v6, 4, v0
v_lshlrev_b32 v6, 2, v6
v_sub_u32 v5, v5, v6
v_mov_b32 v9, 0xf149f2ca
s_lshr_b32 s8, s20, 11
v_add_u32 v96, s8, v5
v_mov_b32 v80, v9
s_lshr_b32 s8, s21, 11
v_add_u32 v97, s8, v5
v_mov_b32 v84, v9
s_lshr_b32 s8, s22, 11
v_add_u32 v98, s8, v5
v_mov_b32 v88, v9
s_lshr_b32 s8, s23, 11
v_add_u32 v99, s8, v5
v_mov_b32 v92, v9
s_sub_u32 s15, 16, s6
s_lshl_b32 s15, s15, 1
L_fb_loop:
s_waitcnt lgkmcnt(0)
s_barrier
s_add_u32 m0, s19, 0x0
s_nop 0
buffer_load_dwordx4 v3, s[48:51], s32 offen offset:0 sc1 lds
buffer_load_dwordx4 v3, s[48:51], s32 offen offset:1024 sc1 lds
buffer_load_dwordx4 v3, s[48:51], s32 offen offset:2048 sc1 lds
buffer_load_dwordx4 v3, s[48:51], s32 offen offset:3072 sc1 lds
s_add_u32 m0, s19, 0x1000
s_nop 0
buffer_load_dwordx4 v3, s[48:51], s7 offen offset:0 sc1 lds
buffer_load_dwordx4 v3, s[48:51], s7 offen offset:1024 sc1 lds
buffer_load_dwordx4 v3, s[48:51], s7 offen offset:2048 sc1 lds
buffer_load_dwordx4 v3, s[48:51], s7 offen offset:3072 sc1 lds
s_add_u32 s32, s32, s94
s_add_u32 s7, s7, s94
s_mov_b32 s94, 0x8000
s_waitcnt vmcnt(0)
s_barrier
ds_read_b128 a[0:3], v3 offset:8192
ds_read_b128 a[4:7], v3 offset:9216
ds_read_b128 a[8:11], v3 offset:10240
ds_read_b128 a[12:15], v3 offset:11264
ds_read_b128 a[16:19], v3 offset:12288
ds_read_b128 a[20:23], v3 offset:13312
ds_read_b128 a[24:27], v3 offset:14336
ds_read_b128 a[28:31], v3 offset:15360
s_waitcnt lgkmcnt(0)
v_mfma_f32_16x16x32_bf16 v[16:19], a[0:3], a[160:163], 0
v_mfma_f32_16x16x32_bf16 v[16:19], a[4:7], a[164:167], v[16:19]
v_mfma_f32_16x16x32_bf16 v[16:19], a[8:11], a[168:171], v[16:19]
v_mfma_f32_16x16x32_bf16 v[16:19], a[12:15], a[172:175], v[16:19]
v_mfma_f32_16x16x32_bf16 v[20:23], a[0:3], a[176:179], 0
v_mfma_f32_16x16x32_bf16 v[20:23], a[4:7], a[180:183], v[20:23]
v_mfma_f32_16x16x32_bf16 v[20:23], a[8:11], a[184:187], v[20:23]
v_mfma_f32_16x16x32_bf16 v[20:23], a[12:15], a[188:191], v[20:23]
v_mfma_f32_16x16x32_bf16 v[24:27], a[0:3], a[192:195], 0
v_mfma_f32_16x16x32_bf16 v[24:27], a[4:7], a[196:199], v[24:27]
v_mfma_f32_16x16x32_bf16 v[24:27], a[8:11], a[200:203], v[24:27]
v_mfma_f32_16x16x32_bf16 v[24:27], a[12:15], a[204:207], v[24:27]
v_mfma_f32_16x16x32_bf16 v[28:31], a[0:3], a[208:211], 0
v_mfma_f32_16x16x32_bf16 v[28:31], a[4:7], a[212:215], v[28:31]
v_mfma_f32_16x16x32_bf16 v[28:31], a[8:11], a[216:219], v[28:31]
v_mfma_f32_16x16x32_bf16 v[28:31], a[12:15], a[220:223], v[28:31]
v_mfma_f32_16x16x32_bf16 v[32:35], a[16:19], a[160:163], 0
v_mfma_f32_16x16x32_bf16 v[32:35], a[20:23], a[164:167], v[32:35]
v_mfma_f32_16x16x32_bf16 v[32:35], a[24:27], a[168:171], v[32:35]
v_mfma_f32_16x16x32_bf16 v[32:35], a[28:31], a[172:175], v[32:35]
v_mfma_f32_16x16x32_bf16 v[36:39], a[16:19], a[176:179], 0
v_mfma_f32_16x16x32_bf16 v[36:39], a[20:23], a[180:183], v[36:39]
v_mfma_f32_16x16x32_bf16 v[36:39], a[24:27], a[184:187], v[36:39]
v_mfma_f32_16x16x32_bf16 v[36:39], a[28:31], a[188:191], v[36:39]
v_mfma_f32_16x16x32_bf16 v[40:43], a[16:19], a[192:195], 0
v_mfma_f32_16x16x32_bf16 v[40:43], a[20:23], a[196:199], v[40:43]
v_mfma_f32_16x16x32_bf16 v[40:43], a[24:27], a[200:203], v[40:43]
v_mfma_f32_16x16x32_bf16 v[40:43], a[28:31], a[204:207], v[40:43]
v_mfma_f32_16x16x32_bf16 v[44:47], a[16:19], a[208:211], 0
v_mfma_f32_16x16x32_bf16 v[44:47], a[20:23], a[212:215], v[44:47]
v_mfma_f32_16x16x32_bf16 v[44:47], a[24:27], a[216:219], v[44:47]
v_mfma_f32_16x16x32_bf16 v[44:47], a[28:31], a[220:223], v[44:47]
s_nop 7
v_cmp_le_i32 s[36:37], 0, v96
v_cmp_le_i32 s[38:39], 1, v96
v_cmp_le_i32 s[40:41], 2, v96
v_cmp_le_i32 s[42:43], 3, v96
s_nop 1
v_cndmask_b32 v16, v9, v16, s[36:37]
v_cndmask_b32 v17, v9, v17, s[38:39]
v_cndmask_b32 v18, v9, v18, s[40:41]
v_cndmask_b32 v19, v9, v19, s[42:43]
v_max3_f32 v80, v80, v16, v17
v_max3_f32 v80, v80, v18, v19
v_cmp_le_i32 s[36:37], 0, v97
v_cmp_le_i32 s[38:39], 1, v97
v_cmp_le_i32 s[40:41], 2, v97
v_cmp_le_i32 s[42:43], 3, v97
s_nop 1
v_cndmask_b32 v20, v9, v20, s[36:37]
v_cndmask_b32 v21, v9, v21, s[38:39]
v_cndmask_b32 v22, v9, v22, s[40:41]
v_cndmask_b32 v23, v9, v23, s[42:43]
v_max3_f32 v84, v84, v20, v21
v_max3_f32 v84, v84, v22, v23
v_cmp_le_i32 s[36:37], 0, v98
v_cmp_le_i32 s[38:39], 1, v98
v_cmp_le_i32 s[40:41], 2, v98
v_cmp_le_i32 s[42:43], 3, v98
s_nop 1
v_cndmask_b32 v24, v9, v24, s[36:37]
v_cndmask_b32 v25, v9, v25, s[38:39]
v_cndmask_b32 v26, v9, v26, s[40:41]
v_cndmask_b32 v27, v9, v27, s[42:43]
v_max3_f32 v88, v88, v24, v25
v_max3_f32 v88, v88, v26, v27
v_cmp_le_i32 s[36:37], 0, v99
v_cmp_le_i32 s[38:39], 1, v99
v_cmp_le_i32 s[40:41], 2, v99
v_cmp_le_i32 s[42:43], 3, v99
s_nop 1
v_cndmask_b32 v28, v9, v28, s[36:37]
v_cndmask_b32 v29, v9, v29, s[38:39]
v_cndmask_b32 v30, v9, v30, s[40:41]
v_cndmask_b32 v31, v9, v31, s[42:43]
v_max3_f32 v92, v92, v28, v29
v_max3_f32 v92, v92, v30, v31
v_cmp_le_i32 s[36:37], 16, v96
v_cmp_le_i32 s[38:39], 17, v96
v_cmp_le_i32 s[40:41], 18, v96
v_cmp_le_i32 s[42:43], 19, v96
s_nop 1
v_cndmask_b32 v32, v9, v32, s[36:37]
v_cndmask_b32 v33, v9, v33, s[38:39]
v_cndmask_b32 v34, v9, v34, s[40:41]
v_cndmask_b32 v35, v9, v35, s[42:43]
v_max3_f32 v80, v80, v32, v33
v_max3_f32 v80, v80, v34, v35
v_cmp_le_i32 s[36:37], 16, v97
v_cmp_le_i32 s[38:39], 17, v97
v_cmp_le_i32 s[40:41], 18, v97
v_cmp_le_i32 s[42:43], 19, v97
s_nop 1
v_cndmask_b32 v36, v9, v36, s[36:37]
v_cndmask_b32 v37, v9, v37, s[38:39]
v_cndmask_b32 v38, v9, v38, s[40:41]
v_cndmask_b32 v39, v9, v39, s[42:43]
v_max3_f32 v84, v84, v36, v37
v_max3_f32 v84, v84, v38, v39
v_cmp_le_i32 s[36:37], 16, v98
v_cmp_le_i32 s[38:39], 17, v98
v_cmp_le_i32 s[40:41], 18, v98
v_cmp_le_i32 s[42:43], 19, v98
s_nop 1
v_cndmask_b32 v40, v9, v40, s[36:37]
v_cndmask_b32 v41, v9, v41, s[38:39]
v_cndmask_b32 v42, v9, v42, s[40:41]
v_cndmask_b32 v43, v9, v43, s[42:43]
v_max3_f32 v88, v88, v40, v41
v_max3_f32 v88, v88, v42, v43
v_cmp_le_i32 s[36:37], 16, v99
v_cmp_le_i32 s[38:39], 17, v99
v_cmp_le_i32 s[40:41], 18, v99
v_cmp_le_i32 s[42:43], 19, v99
s_nop 1
v_cndmask_b32 v44, v9, v44, s[36:37]
v_cndmask_b32 v45, v9, v45, s[38:39]
v_cndmask_b32 v46, v9, v46, s[40:41]
v_cndmask_b32 v47, v9, v47, s[42:43]
v_max3_f32 v92, v92, v44, v45
v_max3_f32 v92, v92, v46, v47
ds_read_b128 a[0:3], v3 offset:24576
ds_read_b128 a[4:7], v3 offset:25600
ds_read_b128 a[8:11], v3 offset:26624
ds_read_b128 a[12:15], v3 offset:27648
ds_read_b128 a[16:19], v3 offset:28672
ds_read_b128 a[20:23], v3 offset:29696
ds_read_b128 a[24:27], v3 offset:30720
ds_read_b128 a[28:31], v3 offset:31744
s_waitcnt lgkmcnt(0)
v_mfma_f32_16x16x32_bf16 v[16:19], a[0:3], a[160:163], 0
v_mfma_f32_16x16x32_bf16 v[16:19], a[4:7], a[164:167], v[16:19]
v_mfma_f32_16x16x32_bf16 v[16:19], a[8:11], a[168:171], v[16:19]
v_mfma_f32_16x16x32_bf16 v[16:19], a[12:15], a[172:175], v[16:19]
v_mfma_f32_16x16x32_bf16 v[20:23], a[0:3], a[176:179], 0
v_mfma_f32_16x16x32_bf16 v[20:23], a[4:7], a[180:183], v[20:23]
v_mfma_f32_16x16x32_bf16 v[20:23], a[8:11], a[184:187], v[20:23]
v_mfma_f32_16x16x32_bf16 v[20:23], a[12:15], a[188:191], v[20:23]
v_mfma_f32_16x16x32_bf16 v[24:27], a[0:3], a[192:195], 0
v_mfma_f32_16x16x32_bf16 v[24:27], a[4:7], a[196:199], v[24:27]
v_mfma_f32_16x16x32_bf16 v[24:27], a[8:11], a[200:203], v[24:27]
v_mfma_f32_16x16x32_bf16 v[24:27], a[12:15], a[204:207], v[24:27]
v_mfma_f32_16x16x32_bf16 v[28:31], a[0:3], a[208:211], 0
v_mfma_f32_16x16x32_bf16 v[28:31], a[4:7], a[212:215], v[28:31]
v_mfma_f32_16x16x32_bf16 v[28:31], a[8:11], a[216:219], v[28:31]
v_mfma_f32_16x16x32_bf16 v[28:31], a[12:15], a[220:223], v[28:31]
v_mfma_f32_16x16x32_bf16 v[32:35], a[16:19], a[160:163], 0
v_mfma_f32_16x16x32_bf16 v[32:35], a[20:23], a[164:167], v[32:35]
v_mfma_f32_16x16x32_bf16 v[32:35], a[24:27], a[168:171], v[32:35]
v_mfma_f32_16x16x32_bf16 v[32:35], a[28:31], a[172:175], v[32:35]
v_mfma_f32_16x16x32_bf16 v[36:39], a[16:19], a[176:179], 0
v_mfma_f32_16x16x32_bf16 v[36:39], a[20:23], a[180:183], v[36:39]
v_mfma_f32_16x16x32_bf16 v[36:39], a[24:27], a[184:187], v[36:39]
v_mfma_f32_16x16x32_bf16 v[36:39], a[28:31], a[188:191], v[36:39]
v_mfma_f32_16x16x32_bf16 v[40:43], a[16:19], a[192:195], 0
v_mfma_f32_16x16x32_bf16 v[40:43], a[20:23], a[196:199], v[40:43]
v_mfma_f32_16x16x32_bf16 v[40:43], a[24:27], a[200:203], v[40:43]
v_mfma_f32_16x16x32_bf16 v[40:43], a[28:31], a[204:207], v[40:43]
v_mfma_f32_16x16x32_bf16 v[44:47], a[16:19], a[208:211], 0
v_mfma_f32_16x16x32_bf16 v[44:47], a[20:23], a[212:215], v[44:47]
v_mfma_f32_16x16x32_bf16 v[44:47], a[24:27], a[216:219], v[44:47]
v_mfma_f32_16x16x32_bf16 v[44:47], a[28:31], a[220:223], v[44:47]
s_nop 7
v_cmp_le_i32 s[36:37], 32, v96
v_cmp_le_i32 s[38:39], 33, v96
v_cmp_le_i32 s[40:41], 34, v96
v_cmp_le_i32 s[42:43], 35, v96
s_nop 1
v_cndmask_b32 v16, v9, v16, s[36:37]
v_cndmask_b32 v17, v9, v17, s[38:39]
v_cndmask_b32 v18, v9, v18, s[40:41]
v_cndmask_b32 v19, v9, v19, s[42:43]
v_max3_f32 v80, v80, v16, v17
v_max3_f32 v80, v80, v18, v19
v_cmp_le_i32 s[36:37], 32, v97
v_cmp_le_i32 s[38:39], 33, v97
v_cmp_le_i32 s[40:41], 34, v97
v_cmp_le_i32 s[42:43], 35, v97
s_nop 1
v_cndmask_b32 v20, v9, v20, s[36:37]
v_cndmask_b32 v21, v9, v21, s[38:39]
v_cndmask_b32 v22, v9, v22, s[40:41]
v_cndmask_b32 v23, v9, v23, s[42:43]
v_max3_f32 v84, v84, v20, v21
v_max3_f32 v84, v84, v22, v23
v_cmp_le_i32 s[36:37], 32, v98
v_cmp_le_i32 s[38:39], 33, v98
v_cmp_le_i32 s[40:41], 34, v98
v_cmp_le_i32 s[42:43], 35, v98
s_nop 1
v_cndmask_b32 v24, v9, v24, s[36:37]
v_cndmask_b32 v25, v9, v25, s[38:39]
v_cndmask_b32 v26, v9, v26, s[40:41]
v_cndmask_b32 v27, v9, v27, s[42:43]
v_max3_f32 v88, v88, v24, v25
v_max3_f32 v88, v88, v26, v27
v_cmp_le_i32 s[36:37], 32, v99
v_cmp_le_i32 s[38:39], 33, v99
v_cmp_le_i32 s[40:41], 34, v99
v_cmp_le_i32 s[42:43], 35, v99
s_nop 1
v_cndmask_b32 v28, v9, v28, s[36:37]
v_cndmask_b32 v29, v9, v29, s[38:39]
v_cndmask_b32 v30, v9, v30, s[40:41]
v_cndmask_b32 v31, v9, v31, s[42:43]
v_max3_f32 v92, v92, v28, v29
v_max3_f32 v92, v92, v30, v31
v_cmp_le_i32 s[36:37], 48, v96
v_cmp_le_i32 s[38:39], 49, v96
v_cmp_le_i32 s[40:41], 50, v96
v_cmp_le_i32 s[42:43], 51, v96
s_nop 1
v_cndmask_b32 v32, v9, v32, s[36:37]
v_cndmask_b32 v33, v9, v33, s[38:39]
v_cndmask_b32 v34, v9, v34, s[40:41]
v_cndmask_b32 v35, v9, v35, s[42:43]
v_max3_f32 v80, v80, v32, v33
v_max3_f32 v80, v80, v34, v35
v_cmp_le_i32 s[36:37], 48, v97
v_cmp_le_i32 s[38:39], 49, v97
v_cmp_le_i32 s[40:41], 50, v97
v_cmp_le_i32 s[42:43], 51, v97
s_nop 1
v_cndmask_b32 v36, v9, v36, s[36:37]
v_cndmask_b32 v37, v9, v37, s[38:39]
v_cndmask_b32 v38, v9, v38, s[40:41]
v_cndmask_b32 v39, v9, v39, s[42:43]
v_max3_f32 v84, v84, v36, v37
v_max3_f32 v84, v84, v38, v39
v_cmp_le_i32 s[36:37], 48, v98
v_cmp_le_i32 s[38:39], 49, v98
v_cmp_le_i32 s[40:41], 50, v98
v_cmp_le_i32 s[42:43], 51, v98
s_nop 1
v_cndmask_b32 v40, v9, v40, s[36:37]
v_cndmask_b32 v41, v9, v41, s[38:39]
v_cndmask_b32 v42, v9, v42, s[40:41]
v_cndmask_b32 v43, v9, v43, s[42:43]
v_max3_f32 v88, v88, v40, v41
v_max3_f32 v88, v88, v42, v43
v_cmp_le_i32 s[36:37], 48, v99
v_cmp_le_i32 s[38:39], 49, v99
v_cmp_le_i32 s[40:41], 50, v99
v_cmp_le_i32 s[42:43], 51, v99
s_nop 1
v_cndmask_b32 v44, v9, v44, s[36:37]
v_cndmask_b32 v45, v9, v45, s[38:39]
v_cndmask_b32 v46, v9, v46, s[40:41]
v_cndmask_b32 v47, v9, v47, s[42:43]
v_max3_f32 v92, v92, v44, v45
v_max3_f32 v92, v92, v46, v47
v_subrev_u32 v96, 64, v96
v_subrev_u32 v97, 64, v97
v_subrev_u32 v98, 64, v98
v_subrev_u32 v99, 64, v99
s_sub_u32 s15, s15, 1
s_cmp_lg_u32 s15, 0
s_cbranch_scc1 L_fb_loop
v_mov_b32 v16, v80
v_mov_b32 v20, v84
v_mov_b32 v24, v88
v_mov_b32 v28, v92
v_permlane16_swap_b32 v16, v80
v_permlane16_swap_b32 v20, v84
v_permlane16_swap_b32 v24, v88
v_permlane16_swap_b32 v28, v92
v_max_f32 v80, v80, v16
v_max_f32 v84, v84, v20
v_max_f32 v88, v88, v24
v_max_f32 v92, v92, v28
v_mov_b32 v16, v80
v_mov_b32 v20, v84
v_mov_b32 v24, v88
v_mov_b32 v28, v92
v_permlane32_swap_b32 v16, v80
v_permlane32_swap_b32 v20, v84
v_permlane32_swap_b32 v24, v88
v_permlane32_swap_b32 v28, v92
v_max_f32 v80, v80, v16
v_max_f32 v84, v84, v20
v_max_f32 v88, v88, v24
v_max_f32 v92, v92, v28
s_barrier
s_mul_i32 s32, s5, 0x10c400
s_lshl_b32 s19, s4, 13
s_add_u32 s32, s32, s19
s_cmp_eq_u32 s4, 0
s_cselect_b32 s94, 0x200000, 0
s_add_u32 s32, s32, s94
s_sub_u32 s94, 0x8000, s94
s_add_u32 s7, s32, 0x1000
s_add_u32 s27, s19, 131072
s_add_u32 m0, s19, 0x0
s_nop 0
buffer_load_dwordx4 v3, s[48:51], s32 offen offset:0 sc1 lds
buffer_load_dwordx4 v3, s[48:51], s32 offen offset:1024 sc1 lds
buffer_load_dwordx4 v3, s[48:51], s32 offen offset:2048 sc1 lds
buffer_load_dwordx4 v3, s[48:51], s32 offen offset:3072 sc1 lds
s_add_u32 m0, s19, 0x1000
s_nop 0
buffer_load_dwordx4 v3, s[48:51], s7 offen offset:0 sc1 lds
buffer_load_dwordx4 v3, s[48:51], s7 offen offset:1024 sc1 lds
buffer_load_dwordx4 v3, s[48:51], s7 offen offset:2048 sc1 lds
buffer_load_dwordx4 v3, s[48:51], s7 offen offset:3072 sc1 lds
s_add_u32 s32, s32, s94
s_add_u32 s7, s7, s94
s_add_u32 m0, s19, 0x18000
s_nop 0
buffer_load_dwordx4 v3, s[48:51], s32 offen offset:0 sc1 lds
buffer_load_dwordx4 v3, s[48:51], s32 offen offset:1024 sc1 lds
buffer_load_dwordx4 v3, s[48:51], s32 offen offset:2048 sc1 lds
buffer_load_dwordx4 v3, s[48:51], s32 offen offset:3072 sc1 lds
s_add_u32 m0, s19, 0x19000
s_nop 0
buffer_load_dwordx4 v3, s[48:51], s7 offen offset:0 sc1 lds
buffer_load_dwordx4 v3, s[48:51], s7 offen offset:1024 sc1 lds
buffer_load_dwordx4 v3, s[48:51], s7 offen offset:2048 sc1 lds
buffer_load_dwordx4 v3, s[48:51], s7 offen offset:3072 sc1 lds
s_add_u32 s32, s32, 0x8000
s_add_u32 s7, s7, 0x8000
s_add_u32 m0, s19, 0x8000
s_nop 0
buffer_load_dwordx4 v3, s[48:51], s32 offen offset:0 sc1 lds
buffer_load_dwordx4 v3, s[48:51], s32 offen offset:1024 sc1 lds
buffer_load_dwordx4 v3, s[48:51], s32 offen offset:2048 sc1 lds
buffer_load_dwordx4 v3, s[48:51], s32 offen offset:3072 sc1 lds
s_add_u32 m0, s19, 0x9000
s_nop 0
buffer_load_dwordx4 v3, s[48:51], s7 offen offset:0 sc1 lds
buffer_load_dwordx4 v3, s[48:51], s7 offen offset:1024 sc1 lds
buffer_load_dwordx4 v3, s[48:51], s7 offen offset:2048 sc1 lds
buffer_load_dwordx4 v3, s[48:51], s7 offen offset:3072 sc1 lds
s_add_u32 s32, s32, 0x8000
s_add_u32 s7, s7, 0x8000
s_and_b32 s18, s2, 4
s_lshr_b32 s8, s2, 6
s_add_u32 s18, s18, s8
s_sub_u32 s8, 15, s18
s_cmp_lt_u32 s4, 2
s_cselect_b32 s99, s18, s8
s_lshl_b32 s16, s2, 2
s_add_u32 s16, s16, s4
s_lshl_b32 s16, s16, 12
s_add_u32 s16, s16, 0x4800000
s_bfe_u32 s100, s2, 0x30003
s_and_b32 s14, s2, 3
s_lshl_b32 s24, s18, 2
s_add_u32 s24, s24, s14
s_lshl_b32 s24, s24, 8
s_add_u32 s24, s24, 0x3704000
s_mov_b32 s12, 14336
s_lshl_b32 s13, s4, 15
s_lshl_b32 s9, s100, 8
s_add_u32 s13, s13, s9
s_mul_i32 s9, s14, 0x80040
s_add_u32 s13, s13, s9
s_and_b32 s9, s2, 1
s_lshl_b32 s9, s9, 17
s_add_u32 s13, s13, s9
s_mul_i32 s25, s14, 0x180000
s_add_u32 s25, s25, s9
s_sub_u32 s25, s25, 524288
s_lshr_b32 s9, s9, 3
s_mul_i32 s101, s99, 0x142400
s_and_b32 s8, s4, 1
s_lshl_b32 s8, s8, 12
s_add_u32 s101, s101, s8
s_lshl_b32 s8, s14, 16
s_add_u32 s101, s101, s8
s_add_u32 s101, s101, s9
s_add_u32 s101, s101, 0x21fe000
s_mul_i32 s26, s14, 196608
s_add_u32 s26, s26, s9
s_add_u32 s26, s26, 188416
v_mov_b32 v15, s6
v_xor_b32 v15, 0, v15
v_writelane_b32 v15, s18, 0
v_lshlrev_b32 v15, 2, v15
v_bfe_u32 v12, v0, 2, 2
v_lshlrev_b32 v12, 11, v12
v_lshrrev_b32 v13, 4, v0
v_lshl_add_u32 v12, v13, 6, v12
v_and_b32 v13, 3, v0
v_lshl_add_u32 v12, v13, 4, v12
v_xor_b32 v12, s13, v12
v_xor_b32 v13, 32, v12
v_add_u32 v13, 7168, v13
s_mov_b32 s8, 0xf149f2ca
s_mov_b32 s36, 0xfff0ffff
s_mov_b32 s37, 0xf000ff00
s_mov_b32 s38, 0xffe0fffe
s_mov_b32 s39, 0xe000fe00
s_mov_b32 s40, 0xffc0fffc
s_mov_b32 s41, 0xc000fc00
s_mov_b32 s42, 0xff80fff8
s_mov_b32 s43, 0x8000f800
s_bitcmp1_b32 s4, 0
s_cselect_b32 s10, 0x7f800000, s8
s_cselect_b32 s11, s8, 0x7f800000
v_mov_b32 v1, v3
v_add_u32 v2, 98304, v3
s_mov_b64 s[34:35], 0
v_accvgpr_write_b32 a224, 0
v_accvgpr_write_b32 a225, 0
v_accvgpr_write_b32 a226, 0
v_accvgpr_write_b32 a227, 0
v_accvgpr_write_b32 a228, 0
v_accvgpr_write_b32 a229, 0
v_accvgpr_write_b32 a230, 0
v_accvgpr_write_b32 a231, 0
v_sub_f32 v83, 0, v80
v_sub_f32 v82, 0, v80
v_sub_f32 v81, 0, v80
v_sub_f32 v80, 0, v80
v_sub_f32 v87, 0, v84
v_sub_f32 v86, 0, v84
v_sub_f32 v85, 0, v84
v_sub_f32 v84, 0, v84
v_sub_f32 v91, 0, v88
v_sub_f32 v90, 0, v88
v_sub_f32 v89, 0, v88
v_sub_f32 v88, 0, v88
v_sub_f32 v95, 0, v92
v_sub_f32 v94, 0, v92
v_sub_f32 v93, 0, v92
v_sub_f32 v92, 0, v92
v_min_f32 v103, s10, v80
v_cndmask_b32 v96, v103, v80, s[36:37]
v_cndmask_b32 v97, v103, v80, s[38:39]
v_cndmask_b32 v98, v103, v80, s[40:41]
v_cndmask_b32 v99, v103, v80, s[42:43]
v_cndmask_b32 v100, v9, v103, s[36:37]
v_cndmask_b32 v101, v9, v103, s[38:39]
v_cndmask_b32 v102, v9, v103, s[40:41]
v_cndmask_b32 v103, v9, v103, s[42:43]
v_min_f32 v111, s11, v84
v_cndmask_b32 v104, v111, v84, s[36:37]
v_cndmask_b32 v105, v111, v84, s[38:39]
v_cndmask_b32 v106, v111, v84, s[40:41]
v_cndmask_b32 v107, v111, v84, s[42:43]
v_cndmask_b32 v108, v9, v111, s[36:37]
v_cndmask_b32 v109, v9, v111, s[38:39]
v_cndmask_b32 v110, v9, v111, s[40:41]
v_cndmask_b32 v111, v9, v111, s[42:43]
v_and_b32 v9, 1, v0
v_mul_u32_u24 v9, 0xaaaa, v9
v_add_u32 v9, 0x4444, v9
v_accvgpr_write_b32 a64, -1
v_accvgpr_write_b32 a65, -1
v_accvgpr_write_b32 a66, -1
v_accvgpr_write_b32 a67, -1
v_mov_b32 v128, 0
v_mov_b32 v129, 0
v_mov_b32 v130, 0
v_mov_b32 v131, 0
v_mov_b32 v132, 0
v_mov_b32 v133, 0
v_mov_b32 v134, 0
v_mov_b32 v135, 0
v_mov_b32 v136, 0
v_mov_b32 v137, 0
v_mov_b32 v138, 0
v_mov_b32 v139, 0
v_mov_b32 v140, 0
v_mov_b32 v141, 0
v_mov_b32 v142, 0
v_mov_b32 v143, 0
v_mov_b32 v144, 0
v_mov_b32 v145, 0
v_mov_b32 v146, 0
v_mov_b32 v147, 0
v_mov_b32 v148, 0
v_mov_b32 v149, 0
v_mov_b32 v150, 0
v_mov_b32 v151, 0
v_mov_b32 v152, 0
v_mov_b32 v153, 0
v_mov_b32 v154, 0
v_mov_b32 v155, 0
v_mov_b32 v156, 0
v_mov_b32 v157, 0
v_mov_b32 v158, 0
v_mov_b32 v159, 0
v_mov_b32 v160, 0
v_mov_b32 v161, 0
v_mov_b32 v162, 0
v_mov_b32 v163, 0
v_mov_b32 v164, 0
v_mov_b32 v165, 0
v_mov_b32 v166, 0
v_mov_b32 v167, 0
v_mov_b32 v168, 0
v_mov_b32 v169, 0
v_mov_b32 v170, 0
v_mov_b32 v171, 0
v_mov_b32 v172, 0
v_mov_b32 v173, 0
v_mov_b32 v174, 0
v_mov_b32 v175, 0
v_mov_b32 v176, 0
v_mov_b32 v177, 0
v_mov_b32 v178, 0
v_mov_b32 v179, 0
v_mov_b32 v180, 0
v_mov_b32 v181, 0
v_mov_b32 v182, 0
v_mov_b32 v183, 0
v_mov_b32 v184, 0
v_mov_b32 v185, 0
v_mov_b32 v186, 0
v_mov_b32 v187, 0
v_mov_b32 v188, 0
v_mov_b32 v189, 0
v_mov_b32 v190, 0
v_mov_b32 v191, 0
v_mov_b32 v192, 0
v_mov_b32 v193, 0
v_mov_b32 v194, 0
v_mov_b32 v195, 0
v_mov_b32 v196, 0
v_mov_b32 v197, 0
v_mov_b32 v198, 0
v_mov_b32 v199, 0
v_mov_b32 v200, 0
v_mov_b32 v201, 0
v_mov_b32 v202, 0
v_mov_b32 v203, 0
v_mov_b32 v204, 0
v_mov_b32 v205, 0
v_mov_b32 v206, 0
v_mov_b32 v207, 0
v_mov_b32 v208, 0
v_mov_b32 v209, 0
v_mov_b32 v210, 0
v_mov_b32 v211, 0
v_mov_b32 v212, 0
v_mov_b32 v213, 0
v_mov_b32 v214, 0
v_mov_b32 v215, 0
v_mov_b32 v216, 0
v_mov_b32 v217, 0
v_mov_b32 v218, 0
v_mov_b32 v219, 0
v_mov_b32 v220, 0
v_mov_b32 v221, 0
v_mov_b32 v222, 0
v_mov_b32 v223, 0
v_mov_b32 v224, 0
v_mov_b32 v225, 0
v_mov_b32 v226, 0
v_mov_b32 v227, 0
v_mov_b32 v228, 0
v_mov_b32 v229, 0
v_mov_b32 v230, 0
v_mov_b32 v231, 0
v_mov_b32 v232, 0
v_mov_b32 v233, 0
v_mov_b32 v234, 0
v_mov_b32 v235, 0
v_mov_b32 v236, 0
v_mov_b32 v237, 0
v_mov_b32 v238, 0
v_mov_b32 v239, 0
v_mov_b32 v240, 0
v_mov_b32 v241, 0
v_mov_b32 v242, 0
v_mov_b32 v243, 0
v_mov_b32 v244, 0
v_mov_b32 v245, 0
v_mov_b32 v246, 0
v_mov_b32 v247, 0
v_mov_b32 v248, 0
v_mov_b32 v249, 0
v_mov_b32 v250, 0
v_mov_b32 v251, 0
v_mov_b32 v252, 0
v_mov_b32 v253, 0
v_mov_b32 v254, 0
v_mov_b32 v255, 0
s_waitcnt vmcnt(16)
s_barrier
ds_read_b128 a[0:3], v1 offset:8192
ds_read_b128 a[4:7], v1 offset:9216
ds_read_b128 a[8:11], v1 offset:10240
ds_read_b128 a[12:15], v1 offset:11264
ds_read_b128 a[16:19], v1 offset:12288
ds_read_b128 a[20:23], v1 offset:13312
ds_read_b128 a[24:27], v1 offset:14336
ds_read_b128 a[28:31], v1 offset:15360
s_waitcnt lgkmcnt(0)
s_branch L_att_start
.section .rodata,"a"
.p2align 6
.amdhsa_kernel gated_mix__compressed_kv_cla__sliding_local_dilated__prompt_kernel
  .amdhsa_next_free_vgpr 512
  .amdhsa_next_free_sgpr 102
  .amdhsa_accum_offset 256
  .amdhsa_group_segment_fixed_size 0
  .amdhsa_kernarg_size 104
  .amdhsa_user_sgpr_count 2
  .amdhsa_user_sgpr_kernarg_segment_ptr 1
  .amdhsa_system_sgpr_workgroup_id_x 1
.end_amdhsa_kernel
```

```asm
; @launch grid=(256,1,1) block=(256,1,1) lds=163840
.amdgcn_target "amdgcn-amd-amdhsa--gfx950"
.text
.globl gated_mix__compressed_kv_cla__sliding_local_dilated__prompt_kernel
.p2align 8
.type gated_mix__compressed_kv_cla__sliding_local_dilated__prompt_kernel,@function
gated_mix__compressed_kv_cla__sliding_local_dilated__prompt_kernel:
s_load_dwordx16 s[16:31], s[0:1], 0
s_load_dwordx8 s[32:39], s[0:1], 64
s_load_dwordx2 s[88:89], s[0:1], 96
s_cmp_ge_u32 s2, 256
s_cbranch_scc1 L_end
v_lshrrev_b32 v1, 6, v0
v_and_b32 v0, 63, v0
v_readfirstlane_b32 s4, v1
v_lshlrev_b32 v16, 4, v0
s_lshr_b32 s8, s2, 3
s_lshl_b32 s8, s8, 2
s_add_u32 s8, s8, s4
s_min_u32 s8, s8, (L_hot_end-L_page0)>>10
s_lshl_b32 s8, s8, 10
s_getpc_b64 s[92:93]
L_here:
s_add_u32 s8, s8, L_page0-L_here
s_add_u32 s92, s92, s8
s_addc_u32 s93, s93, 0
v_add_u32 v60, s92, v16
v_mov_b32 v61, s93
global_load_dword a120, v[60:61], off sc1
s_and_b32 s5, s2, 7
s_xor_b32 s5, s5, 1
s_lshl_b32 s5, s5, 2
s_bfe_u32 s3, s2, 0x20003
s_add_u32 s5, s5, s3
s_lshr_b32 s6, s2, 5
s_mov_b32 s12, 0x4000
s_mov_b32 s13, 0x8000
s_mov_b32 s14, 0xc000
s_mov_b32 s46, 0x400000
s_mov_b32 s47, 0x20000
s_mov_b32 s50, 0x200000
s_mov_b32 s51, 0x20000
s_mov_b32 s54, 0x800000
s_mov_b32 s55, 0x20000
s_mov_b32 s58, 0x400000
s_mov_b32 s59, 0x20000
s_mov_b32 s62, 0x400000
s_mov_b32 s63, 0x20000
s_mov_b32 s66, 0x800000
s_mov_b32 s67, 0x20000
s_mov_b32 s70, 0x600000
s_mov_b32 s71, 0x20000
s_mov_b32 s74, 0x200000
s_mov_b32 s75, 0x20000
s_mov_b32 s78, 0x800
s_mov_b32 s79, 0x20000
s_mov_b32 s82, 0x400000
s_mov_b32 s83, 0x20000
s_mov_b32 s86, 0x100
s_mov_b32 s87, 0x20000
s_mov_b32 s90, 0x10000000
s_mov_b32 s91, 0x20000
v_bfe_u32 v17, v0, 2, 2
s_lshl_b32 s8, s4, 4
v_add_u32 v17, s8, v17
v_lshlrev_b32 v17, 13, v17
v_lshrrev_b32 v18, 4, v0
v_lshl_add_u32 v17, v18, 6, v17
v_and_b32 v18, 3, v0
v_lshl_add_u32 v17, v18, 4, v17
s_lshl_b32 s8, s5, 8
v_add_u32 v5, s8, v17
v_xor_b32 v6, 32, v5
v_add_u32 v6, 0x10000, v6
v_lshrrev_b32 v17, 4, v0
v_xor_b32 v17, v17, v0
v_and_b32 v17, 7, v17
v_lshlrev_b32 v17, 4, v17
v_lshrrev_b32 v18, 3, v0
v_lshl_add_u32 v2, v18, 10, v17
s_lshl_b32 s8, s6, 18
s_lshl_b32 s9, s4, 16
s_add_u32 s8, s8, s9
v_add_u32 v2, s8, v2
v_xor_b32 v3, 64, v2
v_add_u32 v3, 0x2000, v3
s_mov_b32 s41, 0
s_mov_b32 s43, 0
v_lshl_add_u32 v5, s41, 19, v5
v_lshl_add_u32 v6, s41, 19, v6
v_lshl_add_u32 v2, s41, 7, v2
v_lshl_add_u32 v3, s41, 7, v3
s_sub_u32 s10, 15, s6
s_cmp_lt_u32 s5, 16
s_cselect_b32 s10, s6, s10
s_lshl_b32 s10, s10, 4
s_and_b32 s11, s5, 15
s_add_u32 s10, s10, s11
s_lshl_b32 s10, s10, 3
s_lshl_b32 s11, s4, 1
s_add_u32 s10, s10, s11
s_lshl_b32 s100, s10, 11
s_lshl_b32 s101, s10, 2
s_add_u32 s101, s101, 0x3700000
s_lshl_b32 s8, s2, 2
s_add_u32 s8, s8, s4
s_lshl_b32 s8, s8, 11
v_lshrrev_b32 v19, 2, v0
v_lshl_add_u32 v19, v19, 7, s8
s_lshr_b32 s8, s2, 3
s_lshl_b32 s8, s8, 2
s_add_u32 s8, s8, s4
s_lshl_b32 s8, s8, 4
s_lshr_b32 s9, s5, 2
s_add_u32 s8, s8, s9
s_lshl_b32 s8, s8, 10
v_bfe_u32 v63, v0, 2, 3
v_lshl_add_u32 v63, v63, 7, s8
v_lshrrev_b32 v59, 5, v0
v_lshl_add_u32 v63, v59, 13, v63
s_lshr_b32 s8, s8, 14
s_mul_i32 s8, s8, 49152
s_lshl_b32 s9, s9, 8
s_add_u32 s8, s8, s9
v_lshrrev_b32 v59, 3, v0
v_mul_u32_u24 v59, 0x1800, v59
v_and_b32 v1, 4, v0
v_lshl_add_u32 v1, v1, 5, v59
v_add_u32 v1, s8, v1
v_mov_b32 v62, v19
s_waitcnt lgkmcnt(0)
s_mov_b64 s[48:49], s[18:19]
s_mov_b64 s[56:57], s[22:23]
s_mov_b64 s[60:61], s[24:25]
L_args:
s_mov_b64 s[0:1], s[92:93]
s_mov_b64 s[44:45], s[16:17]
s_mov_b64 s[76:77], s[34:35]
s_mov_b64 s[52:53], s[20:21]
s_mov_b64 s[64:65], s[26:27]
s_mov_b64 s[68:69], s[30:31]
s_mov_b64 s[72:73], s[32:33]
s_mov_b64 s[80:81], s[36:37]
s_mov_b64 s[84:85], s[38:39]
s_lshl_b32 s16, s4, 13
s_add_u32 s16, s16, 0x18000
s_lshl_b32 s17, s4, 12
s_lshl_b32 s18, s4, 10
s_mov_b32 s25, 0x800
s_mov_b32 s26, 0x1000
s_mov_b32 s3, 0
s_mov_b32 s9, 0x0
s_nop 0
buffer_load_dword a120, v63, s[56:59], s9 offen
s_mov_b32 s9, 0x0
s_nop 0
buffer_load_dword a120, v63, s[60:63], s9 offen
s_add_u32 m0, s17, 0x0
s_nop 0
buffer_load_dwordx4 v5, s[56:59], 0 offen lds
s_add_u32 m0, s17, 0x4000
s_nop 0
buffer_load_dwordx4 v5, s[60:63], 0 offen lds
s_add_u32 m0, s17, 0x400
s_nop 0
buffer_load_dwordx4 v5, s[56:59], s13 offen lds
s_add_u32 m0, s17, 0x4400
s_nop 0
buffer_load_dwordx4 v5, s[60:63], s13 offen lds
s_add_u32 m0, s17, 0x800
s_nop 0
buffer_load_dwordx4 v6, s[56:59], 0 offen lds
s_add_u32 m0, s17, 0x4800
s_nop 0
buffer_load_dwordx4 v6, s[60:63], 0 offen lds
s_add_u32 m0, s17, 0xc00
s_nop 0
buffer_load_dwordx4 v6, s[56:59], s13 offen lds
s_add_u32 m0, s17, 0x4c00
s_nop 0
buffer_load_dwordx4 v6, s[60:63], s13 offen lds
s_mov_b32 s42, 1
s_mov_b32 s41, 7
v_lshl_add_u32 v5, s42, 19, v5
v_lshl_add_u32 v6, s42, 19, v6
s_add_u32 m0, s16, 0x0
s_nop 0
buffer_load_dwordx4 v2, s[48:51], 0 offen lds
s_add_u32 m0, s16, 0x400
s_nop 0
buffer_load_dwordx4 v3, s[48:51], 0 offen lds
s_add_u32 m0, s16, 0x800
s_nop 0
buffer_load_dwordx4 v2, s[48:51], s12 offen lds
s_add_u32 m0, s16, 0xc00
s_nop 0
buffer_load_dwordx4 v3, s[48:51], s12 offen lds
s_add_u32 m0, s16, 0x1000
s_nop 0
buffer_load_dwordx4 v2, s[48:51], s13 offen lds
s_add_u32 m0, s16, 0x1400
s_nop 0
buffer_load_dwordx4 v3, s[48:51], s13 offen lds
s_add_u32 m0, s16, 0x1800
s_nop 0
buffer_load_dwordx4 v2, s[48:51], s14 offen lds
s_add_u32 m0, s16, 0x1c00
s_nop 0
buffer_load_dwordx4 v3, s[48:51], s14 offen lds
v_lshl_add_u32 v2, s42, 7, v2
v_lshl_add_u32 v3, s42, 7, v3
v_lshrrev_b32 v17, 4, v0
v_xor_b32 v17, v17, v0
v_and_b32 v17, 7, v17
v_lshlrev_b32 v17, 4, v17
v_lshrrev_b32 v18, 3, v0
v_lshl_add_u32 v22, v18, 11, v17
v_xor_b32 v23, 64, v22
v_add_u32 v23, 0x4000, v23
s_lshl_b32 s8, s6, 18
s_sub_u32 s9, 15, s6
s_lshl_b32 s9, s9, 18
s_lshl_b32 s10, s4, 15
s_sub_u32 s11, 0x38000, s10
s_add_u32 s20, s8, s10
s_add_u32 s21, s8, s11
s_add_u32 s22, s9, s10
s_add_u32 s23, s9, s11
s_lshl_b32 s10, s5, 15
s_add_u32 s10, s10, 0x3c00000
s_lshr_b32 s8, s8, 7
s_lshr_b32 s9, s9, 7
s_add_u32 s8, s8, s10
s_add_u32 s9, s9, s10
v_add_u32 v10, s8, v16
v_add_u32 v11, s9, v16
s_cmp_lt_u32 s4, 2
s_cselect_b32 s8, s8, s9
s_and_b32 s9, s4, 1
s_lshl_b32 s9, s9, 10
s_add_u32 s8, s8, s9
v_add_u32 v4, s8, v16
v_lshrrev_b32 v17, 2, v0
s_lshl_b32 s8, s4, 4
v_add_u32 v17, s8, v17
v_mul_u32_u24 v17, 0x1800, v17
v_and_b32 v18, 3, v0
v_lshlrev_b32 v18, 4, v18
v_and_b32 v19, 32, v0
v_xor_b32 v18, v18, v19
s_lshl_b32 s8, s5, 6
v_add3_u32 v7, v17, v18, s8
v_lshl_add_u32 v22, s43, 7, v22
v_lshl_add_u32 v23, s43, 7, v23
v_lshl_add_u32 v7, s43, 18, v7
v_lshl_add_u32 v7, s43, 17, v7
v_and_b32 v17, 15, v0
v_lshrrev_b32 v18, 1, v17
v_lshrrev_b32 v19, 4, v0
v_xor_b32 v18, v18, v19
v_lshlrev_b32 v18, 4, v18
v_lshl_add_u32 v8, v17, 7, v18
v_add_u32 v8, s16, v8
v_xor_b32 v9, 64, v8
v_lshrrev_b32 v17, 4, v0
v_lshlrev_b32 v18, 11, v17
v_and_b32 v17, 1, v17
v_lshl_add_u32 v18, v17, 5, v18
v_bfe_u32 v17, v0, 2, 2
v_lshl_add_u32 v18, v17, 6, v18
v_and_b32 v17, 3, v0
v_lshl_add_u32 v12, v17, 3, v18
v_xor_b32 v13, 32, v12
v_lshrrev_b32 v17, 4, v0
v_lshlrev_b32 v18, 9, v17
v_and_b32 v17, 1, v17
v_lshl_add_u32 v18, v17, 5, v18
v_bfe_u32 v17, v0, 2, 2
v_lshl_add_u32 v18, v17, 6, v18
v_and_b32 v17, 3, v0
v_lshl_add_u32 v14, v17, 3, v18
v_accvgpr_write_b32 a64, -1
v_accvgpr_write_b32 a65, -1
v_accvgpr_write_b32 a66, -1
v_accvgpr_write_b32 a67, -1
v_add_u32 v14, 81920, v14
v_xor_b32 v15, 32, v14
s_mul_i32 s32, s5, 0x10c400
s_lshl_b32 s19, s4, 13
s_add_u32 s32, s32, s19
s_cmp_eq_u32 s4, 0
s_cselect_b32 s94, 0x200000, 0
s_add_u32 s32, s32, s94
s_sub_u32 s94, 0x8000, s94
s_add_u32 s7, s32, 0x1000
s_add_u32 s27, s19, 131072
s_add_u32 m0, s16, 0x8000
s_nop 0
buffer_load_dwordx4 v2, s[48:51], 0 offen lds
s_add_u32 m0, s16, 0x8400
s_nop 0
buffer_load_dwordx4 v3, s[48:51], 0 offen lds
s_add_u32 m0, s16, 0x8800
s_nop 0
buffer_load_dwordx4 v2, s[48:51], s12 offen lds
s_add_u32 m0, s16, 0x8c00
s_nop 0
buffer_load_dwordx4 v3, s[48:51], s12 offen lds
s_add_u32 m0, s16, 0x9000
s_nop 0
buffer_load_dwordx4 v2, s[48:51], s13 offen lds
s_add_u32 m0, s16, 0x9400
s_nop 0
buffer_load_dwordx4 v3, s[48:51], s13 offen lds
s_add_u32 m0, s16, 0x9800
s_nop 0
buffer_load_dwordx4 v2, s[48:51], s14 offen lds
s_add_u32 m0, s16, 0x9c00
s_nop 0
buffer_load_dwordx4 v3, s[48:51], s14 offen lds
v_lshl_add_u32 v2, s42, 7, v2
v_lshl_add_u32 v3, s42, 7, v3
s_mov_b32 s9, 0x0
s_nop 0
buffer_load_dword a120, v62, s[48:51], s9 offen
L_hopA:
s_mov_b32 s95, 1
s_cmp_eq_u32 s4, 0
s_cbranch_scc1 L_padA0
s_cmp_eq_u32 s4, 1
s_cbranch_scc1 L_padA1
s_cmp_eq_u32 s4, 2
s_cbranch_scc1 L_padA2
s_branch L_padA3
L_hopA_ret:
s_mov_b32 s95, 0
v_mov_b32 v19, v62
v_mov_b32 v18, v63
s_cmp_lg_u32 s4, 0
s_cbranch_scc1 L_flag_clr
s_lshl_b32 s8, s6, 5
s_add_u32 s8, s8, s5
s_and_b32 s92, s8, 0xf8
s_mul_i32 s92, s92, 7
s_add_u32 s8, s8, s92
s_lshl_b32 s8, s8, 2
s_add_u32 s8, s8, 0x3704000
v_mov_b32 v17, 0
s_mov_b64 exec, 1
buffer_store_dword v17, off, s[88:91], s8 sc1
s_mov_b64 exec, -1
L_flag_clr:
s_waitcnt vmcnt(9)
s_barrier
s_branch L_main
.p2align 12
L_page0:
L_padA0:
s_branch L_padA4
L_main:
ds_read_b64_tr_b16 a[80:81], v12 offset:0
ds_read_b64_tr_b16 a[82:83], v12 offset:1024
ds_read_b64_tr_b16 a[84:85], v12 offset:8192
ds_read_b64_tr_b16 a[86:87], v12 offset:9216
ds_read_b128 a[0:3], v8 offset:0
ds_read_b128 a[16:19], v9 offset:0
ds_read_b128 a[4:7], v8 offset:2048
ds_read_b128 a[20:23], v9 offset:2048
ds_read_b128 a[8:11], v8 offset:4096
ds_read_b128 a[24:27], v9 offset:4096
ds_read_b128 a[12:15], v8 offset:6144
ds_read_b128 a[28:31], v9 offset:6144
ds_read_b64_tr_b16 a[88:89], v13 offset:0
ds_read_b64_tr_b16 a[90:91], v13 offset:1024
ds_read_b64_tr_b16 a[92:93], v13 offset:8192
ds_read_b64_tr_b16 a[94:95], v13 offset:9216
ds_read_b64_tr_b16 a[96:97], v12 offset:256
ds_read_b64_tr_b16 a[98:99], v12 offset:1280
ds_read_b64_tr_b16 a[100:101], v12 offset:8448
ds_read_b64_tr_b16 a[102:103], v12 offset:9472
s_waitcnt lgkmcnt(0)
L_S0:
v_mfma_f32_16x16x32_bf16 v[24:27], a[80:83], a[0:3], 0
ds_read_b64_tr_b16 a[104:105], v13 offset:256
s_add_u32 m0, s17, 0x8000
v_mfma_f32_16x16x32_bf16 v[24:27], a[84:87], a[16:19], v[24:27]
buffer_load_dwordx4 v5, s[56:59], 0 offen lds
v_mfma_f32_16x16x32_bf16 v[32:35], a[84:87], a[20:23], 0
ds_read_b64_tr_b16 a[106:107], v13 offset:1280
v_mfma_f32_16x16x32_bf16 v[32:35], a[80:83], a[4:7], v[32:35]
ds_read_b64_tr_b16 a[108:109], v13 offset:8448
v_mfma_f32_16x16x32_bf16 v[40:43], a[80:83], a[8:11], 0
ds_read_b64_tr_b16 a[110:111], v13 offset:9472
v_mfma_f32_16x16x32_bf16 v[40:43], a[84:87], a[24:27], v[40:43]
s_add_u32 m0, s17, 0xc000
v_mfma_f32_16x16x32_bf16 v[48:51], a[84:87], a[28:31], 0
buffer_load_dwordx4 v5, s[60:63], 0 offen lds
v_mfma_f32_16x16x32_bf16 v[48:51], a[80:83], a[12:15], v[48:51]
v_mfma_f32_16x16x32_bf16 v[52:55], a[88:91], a[12:15], 0
ds_read_b64_tr_b16 a[80:81], v12 offset:512
v_mfma_f32_16x16x32_bf16 v[52:55], a[92:95], a[28:31], v[52:55]
ds_read_b64_tr_b16 a[82:83], v12 offset:1536
v_mfma_f32_16x16x32_bf16 v[44:47], a[92:95], a[24:27], 0
ds_read_b64_tr_b16 a[84:85], v12 offset:8704
s_add_u32 m0, s17, 0x8400
v_mfma_f32_16x16x32_bf16 v[44:47], a[88:91], a[8:11], v[44:47]
buffer_load_dwordx4 v5, s[56:59], s13 offen lds
v_mfma_f32_16x16x32_bf16 v[36:39], a[88:91], a[4:7], 0
ds_read_b64_tr_b16 a[86:87], v12 offset:9728
v_mfma_f32_16x16x32_bf16 v[36:39], a[92:95], a[20:23], v[36:39]
v_mfma_f32_16x16x32_bf16 v[28:31], a[92:95], a[16:19], 0
v_mfma_f32_16x16x32_bf16 v[28:31], a[88:91], a[0:3], v[28:31]
s_add_u32 m0, s17, 0xc400
v_mfma_f32_16x16x32_bf16 v[56:59], a[96:99], a[0:3], 0
buffer_load_dwordx4 v5, s[60:63], s13 offen lds
v_mfma_f32_16x16x32_bf16 v[56:59], a[100:103], a[16:19], v[56:59]
ds_read_b64_tr_b16 a[88:89], v13 offset:512
v_mfma_f32_16x16x32_bf16 v[64:67], a[100:103], a[20:23], 0
ds_read_b64_tr_b16 a[90:91], v13 offset:1536
v_mfma_f32_16x16x32_bf16 v[64:67], a[96:99], a[4:7], v[64:67]
ds_read_b64_tr_b16 a[92:93], v13 offset:8704
v_mfma_f32_16x16x32_bf16 v[72:75], a[96:99], a[8:11], 0
ds_read_b64_tr_b16 a[94:95], v13 offset:9728
s_add_u32 m0, s17, 0x8800
v_mfma_f32_16x16x32_bf16 v[72:75], a[100:103], a[24:27], v[72:75]
buffer_load_dwordx4 v6, s[56:59], 0 offen lds
v_mfma_f32_16x16x32_bf16 v[80:83], a[100:103], a[28:31], 0
v_mfma_f32_16x16x32_bf16 v[80:83], a[96:99], a[12:15], v[80:83]
s_waitcnt lgkmcnt(10)
v_mfma_f32_16x16x32_bf16 v[84:87], a[104:107], a[12:15], 0
ds_read_b64_tr_b16 a[96:97], v12 offset:768
s_waitcnt lgkmcnt(9)
v_mfma_f32_16x16x32_bf16 v[84:87], a[108:111], a[28:31], v[84:87]
ds_read_b64_tr_b16 a[98:99], v12 offset:1792
s_add_u32 m0, s17, 0xc800
v_mfma_f32_16x16x32_bf16 v[76:79], a[108:111], a[24:27], 0
buffer_load_dwordx4 v6, s[60:63], 0 offen lds
v_mfma_f32_16x16x32_bf16 v[76:79], a[104:107], a[8:11], v[76:79]
ds_read_b64_tr_b16 a[100:101], v12 offset:8960
v_mfma_f32_16x16x32_bf16 v[68:71], a[104:107], a[4:7], 0
ds_read_b64_tr_b16 a[102:103], v12 offset:9984
v_mfma_f32_16x16x32_bf16 v[68:71], a[108:111], a[20:23], v[68:71]
v_mfma_f32_16x16x32_bf16 v[60:63], a[108:111], a[16:19], 0
s_add_u32 m0, s17, 0x8c00
s_waitcnt lgkmcnt(4)
v_mfma_f32_16x16x32_bf16 v[60:63], a[104:107], a[0:3], v[60:63]
buffer_load_dwordx4 v6, s[56:59], s13 offen lds
v_mfma_f32_16x16x32_bf16 v[88:91], a[80:83], a[0:3], 0
ds_read_b64_tr_b16 a[104:105], v13 offset:768
v_mfma_f32_16x16x32_bf16 v[88:91], a[84:87], a[16:19], v[88:91]
ds_read_b64_tr_b16 a[106:107], v13 offset:1792
v_mfma_f32_16x16x32_bf16 v[96:99], a[84:87], a[20:23], 0
ds_read_b64_tr_b16 a[108:109], v13 offset:8960
v_mfma_f32_16x16x32_bf16 v[96:99], a[80:83], a[4:7], v[96:99]
ds_read_b64_tr_b16 a[110:111], v13 offset:9984
s_add_u32 m0, s17, 0xcc00
v_mfma_f32_16x16x32_bf16 v[104:107], a[80:83], a[8:11], 0
buffer_load_dwordx4 v6, s[60:63], s13 offen lds
v_mfma_f32_16x16x32_bf16 v[104:107], a[84:87], a[24:27], v[104:107]
v_lshl_add_u32 v5, s42, 19, v5
v_lshl_add_u32 v6, s42, 19, v6
v_mfma_f32_16x16x32_bf16 v[112:115], a[84:87], a[28:31], 0
v_mfma_f32_16x16x32_bf16 v[112:115], a[80:83], a[12:15], v[112:115]
v_mfma_f32_16x16x32_bf16 v[116:119], a[88:91], a[12:15], 0
ds_read_b64_tr_b16 a[80:81], v12 offset:16384
s_add_u32 m0, s16, 0x0
v_mfma_f32_16x16x32_bf16 v[116:119], a[92:95], a[28:31], v[116:119]
buffer_load_dwordx4 v2, s[48:51], 0 offen lds
v_mfma_f32_16x16x32_bf16 v[108:111], a[92:95], a[24:27], 0
ds_read_b64_tr_b16 a[82:83], v12 offset:17408
v_mfma_f32_16x16x32_bf16 v[108:111], a[88:91], a[8:11], v[108:111]
ds_read_b64_tr_b16 a[84:85], v12 offset:24576
v_mfma_f32_16x16x32_bf16 v[100:103], a[88:91], a[4:7], 0
ds_read_b64_tr_b16 a[86:87], v12 offset:25600
v_mfma_f32_16x16x32_bf16 v[100:103], a[92:95], a[20:23], v[100:103]
s_add_u32 m0, s16, 0x400
v_mfma_f32_16x16x32_bf16 v[92:95], a[92:95], a[16:19], 0
buffer_load_dwordx4 v3, s[48:51], 0 offen lds
v_mfma_f32_16x16x32_bf16 v[92:95], a[88:91], a[0:3], v[92:95]
s_waitcnt lgkmcnt(4)
v_mfma_f32_16x16x32_bf16 v[120:123], a[96:99], a[0:3], 0
ds_read_b64_tr_b16 a[88:89], v13 offset:16384
s_waitcnt vmcnt(11)
v_mfma_f32_16x16x32_bf16 v[120:123], a[100:103], a[16:19], v[120:123]
ds_read_b64_tr_b16 a[90:91], v13 offset:17408
v_mfma_f32_16x16x32_bf16 v[128:131], a[100:103], a[20:23], 0
ds_read_b64_tr_b16 a[92:93], v13 offset:24576
s_add_u32 m0, s16, 0x800
v_mfma_f32_16x16x32_bf16 v[128:131], a[96:99], a[4:7], v[128:131]
buffer_load_dwordx4 v2, s[48:51], s12 offen lds
v_mfma_f32_16x16x32_bf16 v[136:139], a[96:99], a[8:11], 0
ds_read_b64_tr_b16 a[94:95], v13 offset:25600
v_mfma_f32_16x16x32_bf16 v[136:139], a[100:103], a[24:27], v[136:139]
ds_read_b128 a[32:35], v8 offset:32768
v_mfma_f32_16x16x32_bf16 v[144:147], a[100:103], a[28:31], 0
ds_read_b128 a[48:51], v9 offset:32768
v_mfma_f32_16x16x32_bf16 v[144:147], a[96:99], a[12:15], v[144:147]
ds_read_b128 a[36:39], v8 offset:34816
s_add_u32 m0, s16, 0xc00
v_mfma_f32_16x16x32_bf16 v[148:151], a[104:107], a[12:15], 0
buffer_load_dwordx4 v3, s[48:51], s12 offen lds
v_mfma_f32_16x16x32_bf16 v[148:151], a[108:111], a[28:31], v[148:151]
ds_read_b64_tr_b16 a[96:97], v12 offset:16640
v_mfma_f32_16x16x32_bf16 v[140:143], a[108:111], a[24:27], 0
ds_read_b64_tr_b16 a[98:99], v12 offset:17664
v_mfma_f32_16x16x32_bf16 v[140:143], a[104:107], a[8:11], v[140:143]
ds_read_b64_tr_b16 a[100:101], v12 offset:24832
v_mfma_f32_16x16x32_bf16 v[132:135], a[104:107], a[4:7], 0
ds_read_b64_tr_b16 a[102:103], v12 offset:25856
s_add_u32 m0, s16, 0x1000
v_mfma_f32_16x16x32_bf16 v[132:135], a[108:111], a[20:23], v[132:135]
buffer_load_dwordx4 v2, s[48:51], s13 offen lds
v_mfma_f32_16x16x32_bf16 v[124:127], a[108:111], a[16:19], 0
ds_read_b128 a[52:55], v9 offset:34816
v_mfma_f32_16x16x32_bf16 v[124:127], a[104:107], a[0:3], v[124:127]
ds_read_b128 a[40:43], v8 offset:36864
s_waitcnt lgkmcnt(9)
v_mfma_f32_16x16x32_bf16 v[152:155], a[0:3], a[80:83], 0
ds_read_b64_tr_b16 a[104:105], v13 offset:16640
v_mfma_f32_16x16x32_bf16 v[152:155], a[16:19], a[84:87], v[152:155]
ds_read_b64_tr_b16 a[106:107], v13 offset:17664
s_add_u32 m0, s16, 0x1400
v_mfma_f32_16x16x32_bf16 v[156:159], a[20:23], a[84:87], 0
buffer_load_dwordx4 v3, s[48:51], s13 offen lds
v_mfma_f32_16x16x32_bf16 v[156:159], a[4:7], a[80:83], v[156:159]
ds_read_b64_tr_b16 a[108:109], v13 offset:24832
v_mfma_f32_16x16x32_bf16 v[160:163], a[8:11], a[80:83], 0
ds_read_b64_tr_b16 a[110:111], v13 offset:25856
v_mfma_f32_16x16x32_bf16 v[160:163], a[24:27], a[84:87], v[160:163]
ds_read_b128 a[56:59], v9 offset:36864
v_mfma_f32_16x16x32_bf16 v[164:167], a[28:31], a[84:87], 0
ds_read_b128 a[44:47], v8 offset:38912
s_add_u32 m0, s16, 0x1800
v_mfma_f32_16x16x32_bf16 v[164:167], a[12:15], a[80:83], v[164:167]
buffer_load_dwordx4 v2, s[48:51], s14 offen lds
v_mfma_f32_16x16x32_bf16 v[180:183], a[12:15], a[88:91], 0
ds_read_b64_tr_b16 a[80:81], v12 offset:16896
v_mfma_f32_16x16x32_bf16 v[180:183], a[28:31], a[92:95], v[180:183]
ds_read_b64_tr_b16 a[82:83], v12 offset:17920
v_mfma_f32_16x16x32_bf16 v[176:179], a[24:27], a[92:95], 0
ds_read_b64_tr_b16 a[84:85], v12 offset:25088
v_mfma_f32_16x16x32_bf16 v[176:179], a[8:11], a[88:91], v[176:179]
ds_read_b64_tr_b16 a[86:87], v12 offset:26112
s_add_u32 m0, s16, 0x1c00
v_mfma_f32_16x16x32_bf16 v[172:175], a[4:7], a[88:91], 0
buffer_load_dwordx4 v3, s[48:51], s14 offen lds
v_mfma_f32_16x16x32_bf16 v[172:175], a[20:23], a[92:95], v[172:175]
ds_read_b128 a[60:63], v9 offset:38912
v_lshl_add_u32 v2, s42, 7, v2
v_mfma_f32_16x16x32_bf16 v[168:171], a[16:19], a[92:95], 0
v_lshl_add_u32 v3, s42, 7, v3
v_mfma_f32_16x16x32_bf16 v[168:171], a[0:3], a[88:91], v[168:171]
s_waitcnt lgkmcnt(7)
v_mfma_f32_16x16x32_bf16 v[184:187], a[0:3], a[96:99], 0
ds_read_b64_tr_b16 a[88:89], v13 offset:16896
s_add_u32 m0, s17, 0x10000
v_mfma_f32_16x16x32_bf16 v[184:187], a[16:19], a[100:103], v[184:187]
buffer_load_dwordx4 v5, s[56:59], 0 offen lds
v_mfma_f32_16x16x32_bf16 v[188:191], a[20:23], a[100:103], 0
ds_read_b64_tr_b16 a[90:91], v13 offset:17920
v_mfma_f32_16x16x32_bf16 v[188:191], a[4:7], a[96:99], v[188:191]
ds_read_b64_tr_b16 a[92:93], v13 offset:25088
v_mfma_f32_16x16x32_bf16 v[192:195], a[8:11], a[96:99], 0
ds_read_b64_tr_b16 a[94:95], v13 offset:26112
v_mfma_f32_16x16x32_bf16 v[192:195], a[24:27], a[100:103], v[192:195]
s_add_u32 m0, s17, 0x14000
v_mfma_f32_16x16x32_bf16 v[196:199], a[28:31], a[100:103], 0
buffer_load_dwordx4 v5, s[60:63], 0 offen lds
v_mfma_f32_16x16x32_bf16 v[196:199], a[12:15], a[96:99], v[196:199]
v_mfma_f32_16x16x32_bf16 v[212:215], a[12:15], a[104:107], 0
ds_read_b64_tr_b16 a[96:97], v12 offset:17152
v_mfma_f32_16x16x32_bf16 v[212:215], a[28:31], a[108:111], v[212:215]
ds_read_b64_tr_b16 a[98:99], v12 offset:18176
v_mfma_f32_16x16x32_bf16 v[208:211], a[24:27], a[108:111], 0
ds_read_b64_tr_b16 a[100:101], v12 offset:25344
s_add_u32 m0, s17, 0x10400
v_mfma_f32_16x16x32_bf16 v[208:211], a[8:11], a[104:107], v[208:211]
buffer_load_dwordx4 v5, s[56:59], s13 offen lds
v_mfma_f32_16x16x32_bf16 v[204:207], a[4:7], a[104:107], 0
ds_read_b64_tr_b16 a[102:103], v12 offset:26368
v_mfma_f32_16x16x32_bf16 v[204:207], a[20:23], a[108:111], v[204:207]
v_mfma_f32_16x16x32_bf16 v[200:203], a[16:19], a[108:111], 0
v_mfma_f32_16x16x32_bf16 v[200:203], a[0:3], a[104:107], v[200:203]
s_add_u32 m0, s17, 0x14400
s_waitcnt lgkmcnt(4)
v_mfma_f32_16x16x32_bf16 v[216:219], a[0:3], a[80:83], 0
buffer_load_dwordx4 v5, s[60:63], s13 offen lds
v_mfma_f32_16x16x32_bf16 v[216:219], a[16:19], a[84:87], v[216:219]
ds_read_b64_tr_b16 a[104:105], v13 offset:17152
v_mfma_f32_16x16x32_bf16 v[220:223], a[20:23], a[84:87], 0
ds_read_b64_tr_b16 a[106:107], v13 offset:18176
v_mfma_f32_16x16x32_bf16 v[220:223], a[4:7], a[80:83], v[220:223]
ds_read_b64_tr_b16 a[108:109], v13 offset:25344
v_mfma_f32_16x16x32_bf16 v[224:227], a[8:11], a[80:83], 0
ds_read_b64_tr_b16 a[110:111], v13 offset:26368
s_add_u32 m0, s17, 0x10800
v_mfma_f32_16x16x32_bf16 v[224:227], a[24:27], a[84:87], v[224:227]
buffer_load_dwordx4 v6, s[56:59], 0 offen lds
v_mfma_f32_16x16x32_bf16 v[228:231], a[28:31], a[84:87], 0
v_add_u32 v12, 0x8000, v12
v_add_u32 v13, 0x8000, v13
v_mfma_f32_16x16x32_bf16 v[228:231], a[12:15], a[80:83], v[228:231]
v_mfma_f32_16x16x32_bf16 v[244:247], a[12:15], a[88:91], 0
s_waitcnt vmcnt(13) lgkmcnt(0)
v_mfma_f32_16x16x32_bf16 v[244:247], a[28:31], a[92:95], v[244:247]
s_barrier
s_add_u32 m0, s17, 0x14800
v_mfma_f32_16x16x32_bf16 v[240:243], a[24:27], a[92:95], 0
buffer_load_dwordx4 v6, s[60:63], 0 offen lds
v_mfma_f32_16x16x32_bf16 v[240:243], a[8:11], a[88:91], v[240:243]
ds_read_b64_tr_b16 a[80:81], v12 offset:0
v_mfma_f32_16x16x32_bf16 v[236:239], a[4:7], a[88:91], 0
ds_read_b64_tr_b16 a[82:83], v12 offset:1024
v_mfma_f32_16x16x32_bf16 v[236:239], a[20:23], a[92:95], v[236:239]
ds_read_b64_tr_b16 a[84:85], v12 offset:8192
s_waitcnt lgkmcnt(3)
v_mfma_f32_16x16x32_bf16 v[232:235], a[16:19], a[92:95], 0
ds_read_b64_tr_b16 a[86:87], v12 offset:9216
s_add_u32 m0, s17, 0x10c00
v_mfma_f32_16x16x32_bf16 v[232:235], a[0:3], a[88:91], v[232:235]
buffer_load_dwordx4 v6, s[56:59], s13 offen lds
v_mfma_f32_16x16x32_bf16 v[248:251], a[0:3], a[96:99], 0
ds_read_b64_tr_b16 a[88:89], v13 offset:0
v_mfma_f32_16x16x32_bf16 v[248:251], a[16:19], a[100:103], v[248:251]
ds_read_b64_tr_b16 a[90:91], v13 offset:1024
v_mfma_f32_16x16x32_bf16 v[252:255], a[20:23], a[100:103], 0
ds_read_b64_tr_b16 a[92:93], v13 offset:8192
v_mfma_f32_16x16x32_bf16 v[252:255], a[4:7], a[96:99], v[252:255]
ds_read_b64_tr_b16 a[94:95], v13 offset:9216
s_add_u32 m0, s17, 0x14c00
v_mfma_f32_16x16x32_bf16 a[232:235], a[8:11], a[96:99], 0
buffer_load_dwordx4 v6, s[60:63], s13 offen lds
v_mfma_f32_16x16x32_bf16 a[232:235], a[24:27], a[100:103], a[232:235]
v_lshl_add_u32 v5, s42, 19, v5
v_lshl_add_u32 v6, s42, 19, v6
v_mfma_f32_16x16x32_bf16 a[236:239], a[28:31], a[100:103], 0
v_mfma_f32_16x16x32_bf16 a[236:239], a[12:15], a[96:99], a[236:239]
s_waitcnt lgkmcnt(15)
v_mfma_f32_16x16x32_bf16 a[252:255], a[12:15], a[104:107], 0
ds_read_b64_tr_b16 a[96:97], v12 offset:256
s_add_u32 m0, s16, 0x8000
v_mfma_f32_16x16x32_bf16 a[252:255], a[28:31], a[108:111], a[252:255]
buffer_load_dwordx4 v2, s[48:51], 0 offen lds
v_mfma_f32_16x16x32_bf16 a[248:251], a[24:27], a[108:111], 0
ds_read_b64_tr_b16 a[98:99], v12 offset:1280
v_mfma_f32_16x16x32_bf16 a[248:251], a[8:11], a[104:107], a[248:251]
ds_read_b64_tr_b16 a[100:101], v12 offset:8448
v_mfma_f32_16x16x32_bf16 a[244:247], a[4:7], a[104:107], 0
ds_read_b64_tr_b16 a[102:103], v12 offset:9472
v_mfma_f32_16x16x32_bf16 a[244:247], a[20:23], a[108:111], a[244:247]
s_add_u32 m0, s16, 0x8400
v_mfma_f32_16x16x32_bf16 a[240:243], a[16:19], a[108:111], 0
buffer_load_dwordx4 v3, s[48:51], 0 offen lds
v_mfma_f32_16x16x32_bf16 a[240:243], a[0:3], a[104:107], a[240:243]
s_waitcnt lgkmcnt(4)
L_S1:
v_mfma_f32_16x16x32_bf16 v[24:27], a[80:83], a[32:35], v[24:27]
ds_read_b64_tr_b16 a[104:105], v13 offset:256
v_mfma_f32_16x16x32_bf16 v[24:27], a[84:87], a[48:51], v[24:27]
ds_read_b64_tr_b16 a[106:107], v13 offset:1280
v_mfma_f32_16x16x32_bf16 v[32:35], a[84:87], a[52:55], v[32:35]
ds_read_b64_tr_b16 a[108:109], v13 offset:8448
s_add_u32 m0, s16, 0x8800
v_mfma_f32_16x16x32_bf16 v[32:35], a[80:83], a[36:39], v[32:35]
buffer_load_dwordx4 v2, s[48:51], s12 offen lds
v_mfma_f32_16x16x32_bf16 v[40:43], a[80:83], a[40:43], v[40:43]
ds_read_b64_tr_b16 a[110:111], v13 offset:9472
v_mfma_f32_16x16x32_bf16 v[40:43], a[84:87], a[56:59], v[40:43]
v_mfma_f32_16x16x32_bf16 v[48:51], a[84:87], a[60:63], v[48:51]
v_mfma_f32_16x16x32_bf16 v[48:51], a[80:83], a[44:47], v[48:51]
s_add_u32 m0, s16, 0x8c00
v_mfma_f32_16x16x32_bf16 v[52:55], a[88:91], a[44:47], v[52:55]
buffer_load_dwordx4 v3, s[48:51], s12 offen lds
v_mfma_f32_16x16x32_bf16 v[52:55], a[92:95], a[60:63], v[52:55]
ds_read_b64_tr_b16 a[80:81], v12 offset:512
v_mfma_f32_16x16x32_bf16 v[44:47], a[92:95], a[56:59], v[44:47]
ds_read_b64_tr_b16 a[82:83], v12 offset:1536
v_mfma_f32_16x16x32_bf16 v[44:47], a[88:91], a[40:43], v[44:47]
ds_read_b64_tr_b16 a[84:85], v12 offset:8704
v_mfma_f32_16x16x32_bf16 v[36:39], a[88:91], a[36:39], v[36:39]
ds_read_b64_tr_b16 a[86:87], v12 offset:9728
s_add_u32 m0, s16, 0x9000
v_mfma_f32_16x16x32_bf16 v[36:39], a[92:95], a[52:55], v[36:39]
buffer_load_dwordx4 v2, s[48:51], s13 offen lds
v_mfma_f32_16x16x32_bf16 v[28:31], a[92:95], a[48:51], v[28:31]
v_mfma_f32_16x16x32_bf16 v[28:31], a[88:91], a[32:35], v[28:31]
s_waitcnt lgkmcnt(4)
v_mfma_f32_16x16x32_bf16 v[56:59], a[96:99], a[32:35], v[56:59]
ds_read_b64_tr_b16 a[88:89], v13 offset:512
v_mfma_f32_16x16x32_bf16 v[56:59], a[100:103], a[48:51], v[56:59]
ds_read_b64_tr_b16 a[90:91], v13 offset:1536
s_add_u32 m0, s16, 0x9400
v_mfma_f32_16x16x32_bf16 v[64:67], a[100:103], a[52:55], v[64:67]
buffer_load_dwordx4 v3, s[48:51], s13 offen lds
v_mfma_f32_16x16x32_bf16 v[64:67], a[96:99], a[36:39], v[64:67]
ds_read_b64_tr_b16 a[92:93], v13 offset:8704
v_mfma_f32_16x16x32_bf16 v[72:75], a[96:99], a[40:43], v[72:75]
ds_read_b64_tr_b16 a[94:95], v13 offset:9728
v_mfma_f32_16x16x32_bf16 v[72:75], a[100:103], a[56:59], v[72:75]
v_mfma_f32_16x16x32_bf16 v[80:83], a[100:103], a[60:63], v[80:83]
s_add_u32 m0, s16, 0x9800
v_mfma_f32_16x16x32_bf16 v[80:83], a[96:99], a[44:47], v[80:83]
buffer_load_dwordx4 v2, s[48:51], s14 offen lds
v_mfma_f32_16x16x32_bf16 v[84:87], a[104:107], a[44:47], v[84:87]
ds_read_b64_tr_b16 a[96:97], v12 offset:768
v_mfma_f32_16x16x32_bf16 v[84:87], a[108:111], a[60:63], v[84:87]
ds_read_b64_tr_b16 a[98:99], v12 offset:1792
v_mfma_f32_16x16x32_bf16 v[76:79], a[108:111], a[56:59], v[76:79]
ds_read_b64_tr_b16 a[100:101], v12 offset:8960
v_mfma_f32_16x16x32_bf16 v[76:79], a[104:107], a[40:43], v[76:79]
ds_read_b64_tr_b16 a[102:103], v12 offset:9984
s_add_u32 m0, s16, 0x9c00
v_mfma_f32_16x16x32_bf16 v[68:71], a[104:107], a[36:39], v[68:71]
buffer_load_dwordx4 v3, s[48:51], s14 offen lds
v_mfma_f32_16x16x32_bf16 v[68:71], a[108:111], a[52:55], v[68:71]
v_lshl_add_u32 v2, s42, 7, v2
v_lshl_add_u32 v3, s42, 7, v3
v_mfma_f32_16x16x32_bf16 v[60:63], a[108:111], a[48:51], v[60:63]
v_mfma_f32_16x16x32_bf16 v[60:63], a[104:107], a[32:35], v[60:63]
s_add_u32 m0, s17, 0x0
s_waitcnt lgkmcnt(4)
v_mfma_f32_16x16x32_bf16 v[88:91], a[80:83], a[32:35], v[88:91]
ds_read_b64_tr_b16 a[104:105], v13 offset:768
s_waitcnt vmcnt(16)
v_mfma_f32_16x16x32_bf16 v[88:91], a[84:87], a[48:51], v[88:91]
buffer_load_dwordx4 v5, s[56:59], 0 offen lds
v_mfma_f32_16x16x32_bf16 v[96:99], a[84:87], a[52:55], v[96:99]
ds_read_b64_tr_b16 a[106:107], v13 offset:1792
v_mfma_f32_16x16x32_bf16 v[96:99], a[80:83], a[36:39], v[96:99]
ds_read_b64_tr_b16 a[108:109], v13 offset:8960
v_mfma_f32_16x16x32_bf16 v[104:107], a[80:83], a[40:43], v[104:107]
ds_read_b64_tr_b16 a[110:111], v13 offset:9984
v_mfma_f32_16x16x32_bf16 v[104:107], a[84:87], a[56:59], v[104:107]
ds_read_b128 a[0:3], v8 offset:0
s_add_u32 m0, s17, 0x4000
v_mfma_f32_16x16x32_bf16 v[112:115], a[84:87], a[60:63], v[112:115]
buffer_load_dwordx4 v5, s[60:63], 0 offen lds
v_mfma_f32_16x16x32_bf16 v[112:115], a[80:83], a[44:47], v[112:115]
ds_read_b128 a[16:19], v9 offset:0
v_mfma_f32_16x16x32_bf16 v[116:119], a[88:91], a[44:47], v[116:119]
ds_read_b64_tr_b16 a[80:81], v12 offset:16384
v_mfma_f32_16x16x32_bf16 v[116:119], a[92:95], a[60:63], v[116:119]
ds_read_b64_tr_b16 a[82:83], v12 offset:17408
v_mfma_f32_16x16x32_bf16 v[108:111], a[92:95], a[56:59], v[108:111]
ds_read_b64_tr_b16 a[84:85], v12 offset:24576
s_add_u32 m0, s17, 0x400
v_mfma_f32_16x16x32_bf16 v[108:111], a[88:91], a[40:43], v[108:111]
buffer_load_dwordx4 v5, s[56:59], s13 offen lds
v_mfma_f32_16x16x32_bf16 v[100:103], a[88:91], a[36:39], v[100:103]
ds_read_b64_tr_b16 a[86:87], v12 offset:25600
v_mfma_f32_16x16x32_bf16 v[100:103], a[92:95], a[52:55], v[100:103]
ds_read_b128 a[4:7], v8 offset:2048
v_mfma_f32_16x16x32_bf16 v[92:95], a[92:95], a[48:51], v[92:95]
ds_read_b128 a[20:23], v9 offset:2048
s_waitcnt lgkmcnt(8)
v_mfma_f32_16x16x32_bf16 v[92:95], a[88:91], a[32:35], v[92:95]
ds_read_b128 a[8:11], v8 offset:4096
s_add_u32 m0, s17, 0x4400
v_mfma_f32_16x16x32_bf16 v[120:123], a[96:99], a[32:35], v[120:123]
buffer_load_dwordx4 v5, s[60:63], s13 offen lds
v_mfma_f32_16x16x32_bf16 v[120:123], a[100:103], a[48:51], v[120:123]
ds_read_b64_tr_b16 a[88:89], v13 offset:16384
v_mfma_f32_16x16x32_bf16 v[128:131], a[100:103], a[52:55], v[128:131]
ds_read_b64_tr_b16 a[90:91], v13 offset:17408
v_mfma_f32_16x16x32_bf16 v[128:131], a[96:99], a[36:39], v[128:131]
ds_read_b64_tr_b16 a[92:93], v13 offset:24576
v_mfma_f32_16x16x32_bf16 v[136:139], a[96:99], a[40:43], v[136:139]
ds_read_b64_tr_b16 a[94:95], v13 offset:25600
s_add_u32 m0, s17, 0x800
v_mfma_f32_16x16x32_bf16 v[136:139], a[100:103], a[56:59], v[136:139]
buffer_load_dwordx4 v6, s[56:59], 0 offen lds
v_mfma_f32_16x16x32_bf16 v[144:147], a[100:103], a[60:63], v[144:147]
ds_read_b128 a[24:27], v9 offset:4096
v_mfma_f32_16x16x32_bf16 v[144:147], a[96:99], a[44:47], v[144:147]
ds_read_b128 a[12:15], v8 offset:6144
v_mfma_f32_16x16x32_bf16 v[148:151], a[104:107], a[44:47], v[148:151]
ds_read_b64_tr_b16 a[96:97], v12 offset:16640
v_mfma_f32_16x16x32_bf16 v[148:151], a[108:111], a[60:63], v[148:151]
ds_read_b64_tr_b16 a[98:99], v12 offset:17664
s_add_u32 m0, s17, 0x4800
v_mfma_f32_16x16x32_bf16 v[140:143], a[108:111], a[56:59], v[140:143]
buffer_load_dwordx4 v6, s[60:63], 0 offen lds
v_mfma_f32_16x16x32_bf16 v[140:143], a[104:107], a[40:43], v[140:143]
ds_read_b64_tr_b16 a[100:101], v12 offset:24832
v_mfma_f32_16x16x32_bf16 v[132:135], a[104:107], a[36:39], v[132:135]
ds_read_b64_tr_b16 a[102:103], v12 offset:25856
v_mfma_f32_16x16x32_bf16 v[132:135], a[108:111], a[52:55], v[132:135]
ds_read_b128 a[28:31], v9 offset:6144
v_mfma_f32_16x16x32_bf16 v[124:127], a[108:111], a[48:51], v[124:127]
s_add_u32 m0, s17, 0xc00
s_waitcnt lgkmcnt(7)
v_mfma_f32_16x16x32_bf16 v[124:127], a[104:107], a[32:35], v[124:127]
buffer_load_dwordx4 v6, s[56:59], s13 offen lds
v_mfma_f32_16x16x32_bf16 v[152:155], a[32:35], a[80:83], v[152:155]
ds_read_b64_tr_b16 a[104:105], v13 offset:16640
v_mfma_f32_16x16x32_bf16 v[152:155], a[48:51], a[84:87], v[152:155]
ds_read_b64_tr_b16 a[106:107], v13 offset:17664
v_mfma_f32_16x16x32_bf16 v[156:159], a[52:55], a[84:87], v[156:159]
ds_read_b64_tr_b16 a[108:109], v13 offset:24832
v_mfma_f32_16x16x32_bf16 v[156:159], a[36:39], a[80:83], v[156:159]
ds_read_b64_tr_b16 a[110:111], v13 offset:25856
s_add_u32 m0, s17, 0x4c00
v_mfma_f32_16x16x32_bf16 v[160:163], a[40:43], a[80:83], v[160:163]
buffer_load_dwordx4 v6, s[60:63], s13 offen lds
v_mfma_f32_16x16x32_bf16 v[160:163], a[56:59], a[84:87], v[160:163]
v_lshl_add_u32 v5, s42, 19, v5
v_lshl_add_u32 v6, s42, 19, v6
v_mfma_f32_16x16x32_bf16 v[164:167], a[60:63], a[84:87], v[164:167]
v_mfma_f32_16x16x32_bf16 v[164:167], a[44:47], a[80:83], v[164:167]
v_mfma_f32_16x16x32_bf16 v[180:183], a[44:47], a[88:91], v[180:183]
ds_read_b64_tr_b16 a[80:81], v12 offset:16896
s_mov_b32 s9, 0x200000
v_mfma_f32_16x16x32_bf16 v[180:183], a[60:63], a[92:95], v[180:183]
buffer_load_dword a120, v18, s[56:59], s9 offen
v_mfma_f32_16x16x32_bf16 v[176:179], a[56:59], a[92:95], v[176:179]
ds_read_b64_tr_b16 a[82:83], v12 offset:17920
v_mfma_f32_16x16x32_bf16 v[176:179], a[40:43], a[88:91], v[176:179]
ds_read_b64_tr_b16 a[84:85], v12 offset:25088
v_mfma_f32_16x16x32_bf16 v[172:175], a[36:39], a[88:91], v[172:175]
ds_read_b64_tr_b16 a[86:87], v12 offset:26112
v_mfma_f32_16x16x32_bf16 v[172:175], a[52:55], a[92:95], v[172:175]
s_add_u32 m0, s16, 0x0
s_waitcnt lgkmcnt(8)
v_mfma_f32_16x16x32_bf16 v[168:171], a[48:51], a[92:95], v[168:171]
buffer_load_dwordx4 v2, s[48:51], 0 offen lds
v_mfma_f32_16x16x32_bf16 v[168:171], a[32:35], a[88:91], v[168:171]
s_waitcnt lgkmcnt(4)
v_mfma_f32_16x16x32_bf16 v[184:187], a[32:35], a[96:99], v[184:187]
ds_read_b64_tr_b16 a[88:89], v13 offset:16896
v_mfma_f32_16x16x32_bf16 v[184:187], a[48:51], a[100:103], v[184:187]
ds_read_b64_tr_b16 a[90:91], v13 offset:17920
v_mfma_f32_16x16x32_bf16 v[188:191], a[52:55], a[100:103], v[188:191]
ds_read_b64_tr_b16 a[92:93], v13 offset:25088
s_add_u32 m0, s16, 0x400
v_mfma_f32_16x16x32_bf16 v[188:191], a[36:39], a[96:99], v[188:191]
buffer_load_dwordx4 v3, s[48:51], 0 offen lds
v_mfma_f32_16x16x32_bf16 v[192:195], a[40:43], a[96:99], v[192:195]
ds_read_b64_tr_b16 a[94:95], v13 offset:26112
v_mfma_f32_16x16x32_bf16 v[192:195], a[56:59], a[100:103], v[192:195]
v_mfma_f32_16x16x32_bf16 v[196:199], a[60:63], a[100:103], v[196:199]
v_mfma_f32_16x16x32_bf16 v[196:199], a[44:47], a[96:99], v[196:199]
s_add_u32 m0, s16, 0x800
v_mfma_f32_16x16x32_bf16 v[212:215], a[44:47], a[104:107], v[212:215]
buffer_load_dwordx4 v2, s[48:51], s12 offen lds
v_mfma_f32_16x16x32_bf16 v[212:215], a[60:63], a[108:111], v[212:215]
ds_read_b64_tr_b16 a[96:97], v12 offset:17152
v_mfma_f32_16x16x32_bf16 v[208:211], a[56:59], a[108:111], v[208:211]
ds_read_b64_tr_b16 a[98:99], v12 offset:18176
v_mfma_f32_16x16x32_bf16 v[208:211], a[40:43], a[104:107], v[208:211]
ds_read_b64_tr_b16 a[100:101], v12 offset:25344
v_mfma_f32_16x16x32_bf16 v[204:207], a[36:39], a[104:107], v[204:207]
ds_read_b64_tr_b16 a[102:103], v12 offset:26368
s_add_u32 m0, s16, 0xc00
v_mfma_f32_16x16x32_bf16 v[204:207], a[52:55], a[108:111], v[204:207]
buffer_load_dwordx4 v3, s[48:51], s12 offen lds
v_mfma_f32_16x16x32_bf16 v[200:203], a[48:51], a[108:111], v[200:203]
v_mfma_f32_16x16x32_bf16 v[200:203], a[32:35], a[104:107], v[200:203]
s_waitcnt lgkmcnt(4)
v_mfma_f32_16x16x32_bf16 v[216:219], a[32:35], a[80:83], v[216:219]
ds_read_b64_tr_b16 a[104:105], v13 offset:17152
v_mfma_f32_16x16x32_bf16 v[216:219], a[48:51], a[84:87], v[216:219]
ds_read_b64_tr_b16 a[106:107], v13 offset:18176
s_add_u32 m0, s16, 0x1000
v_mfma_f32_16x16x32_bf16 v[220:223], a[52:55], a[84:87], v[220:223]
buffer_load_dwordx4 v2, s[48:51], s13 offen lds
v_mfma_f32_16x16x32_bf16 v[220:223], a[36:39], a[80:83], v[220:223]
ds_read_b64_tr_b16 a[108:109], v13 offset:25344
v_mfma_f32_16x16x32_bf16 v[224:227], a[40:43], a[80:83], v[224:227]
ds_read_b64_tr_b16 a[110:111], v13 offset:26368
v_add_u32 v12, 0x8000, v12
v_mfma_f32_16x16x32_bf16 v[224:227], a[56:59], a[84:87], v[224:227]
v_add_u32 v13, 0x8000, v13
v_mfma_f32_16x16x32_bf16 v[228:231], a[60:63], a[84:87], v[228:231]
s_add_u32 m0, s16, 0x1400
v_mfma_f32_16x16x32_bf16 v[228:231], a[44:47], a[80:83], v[228:231]
buffer_load_dwordx4 v3, s[48:51], s13 offen lds
v_mfma_f32_16x16x32_bf16 v[244:247], a[44:47], a[88:91], v[244:247]
s_waitcnt vmcnt(23) lgkmcnt(0)
v_mfma_f32_16x16x32_bf16 v[244:247], a[60:63], a[92:95], v[244:247]
s_barrier
v_mfma_f32_16x16x32_bf16 v[240:243], a[56:59], a[92:95], v[240:243]
ds_read_b64_tr_b16 a[80:81], v12 offset:0
s_lshl_b32 s15, s2, 2
v_mfma_f32_16x16x32_bf16 v[240:243], a[40:43], a[88:91], v[240:243]
ds_read_b64_tr_b16 a[82:83], v12 offset:1024
s_add_u32 m0, s16, 0x1800
v_mfma_f32_16x16x32_bf16 v[236:239], a[36:39], a[88:91], v[236:239]
buffer_load_dwordx4 v2, s[48:51], s14 offen lds
v_mfma_f32_16x16x32_bf16 v[236:239], a[52:55], a[92:95], v[236:239]
ds_read_b64_tr_b16 a[84:85], v12 offset:8192
s_add_u32 s15, s15, s4
v_mfma_f32_16x16x32_bf16 v[232:235], a[48:51], a[92:95], v[232:235]
ds_read_b64_tr_b16 a[86:87], v12 offset:9216
s_lshl_b32 s15, s15, 12
v_mfma_f32_16x16x32_bf16 v[232:235], a[32:35], a[88:91], v[232:235]
L_padA1:
s_cmp_eq_u32 s95, 1
s_cbranch_scc1 L_padA5
s_waitcnt lgkmcnt(4)
s_add_u32 s15, s15, 0x4800000
v_mfma_f32_16x16x32_bf16 v[248:251], a[32:35], a[96:99], v[248:251]
ds_read_b64_tr_b16 a[88:89], v13 offset:0
s_add_u32 m0, s16, 0x1c00
v_mfma_f32_16x16x32_bf16 v[248:251], a[48:51], a[100:103], v[248:251]
buffer_load_dwordx4 v3, s[48:51], s14 offen lds
v_mfma_f32_16x16x32_bf16 v[252:255], a[52:55], a[100:103], v[252:255]
ds_read_b64_tr_b16 a[90:91], v13 offset:1024
v_lshl_add_u32 v2, s42, 7, v2
v_mfma_f32_16x16x32_bf16 v[252:255], a[36:39], a[96:99], v[252:255]
ds_read_b64_tr_b16 a[92:93], v13 offset:8192
v_lshl_add_u32 v3, s42, 7, v3
v_mfma_f32_16x16x32_bf16 a[232:235], a[40:43], a[96:99], a[232:235]
ds_read_b64_tr_b16 a[94:95], v13 offset:9216
v_mfma_f32_16x16x32_bf16 a[232:235], a[56:59], a[100:103], a[232:235]
s_mov_b32 s9, 0x200000
v_mfma_f32_16x16x32_bf16 a[236:239], a[60:63], a[100:103], a[236:239]
buffer_load_dword a120, v18, s[60:63], s9 offen
v_mfma_f32_16x16x32_bf16 a[236:239], a[44:47], a[96:99], a[236:239]
v_mfma_f32_16x16x32_bf16 a[252:255], a[44:47], a[104:107], a[252:255]
ds_read_b64_tr_b16 a[96:97], v12 offset:256
v_mfma_f32_16x16x32_bf16 a[252:255], a[60:63], a[108:111], a[252:255]
ds_read_b64_tr_b16 a[98:99], v12 offset:1280
v_mfma_f32_16x16x32_bf16 a[248:251], a[56:59], a[108:111], a[248:251]
ds_read_b64_tr_b16 a[100:101], v12 offset:8448
s_add_u32 m0, s17, 0x8000
v_mfma_f32_16x16x32_bf16 a[248:251], a[40:43], a[104:107], a[248:251]
buffer_load_dwordx4 v5, s[56:59], 0 offen lds
v_mfma_f32_16x16x32_bf16 a[244:247], a[36:39], a[104:107], a[244:247]
ds_read_b64_tr_b16 a[102:103], v12 offset:9472
v_mfma_f32_16x16x32_bf16 a[244:247], a[52:55], a[108:111], a[244:247]
v_mfma_f32_16x16x32_bf16 a[240:243], a[48:51], a[108:111], a[240:243]
v_mfma_f32_16x16x32_bf16 a[240:243], a[32:35], a[104:107], a[240:243]
s_add_u32 m0, s17, 0xc000
s_waitcnt lgkmcnt(4)
L_S2:
v_mfma_f32_16x16x32_bf16 v[24:27], a[80:83], a[0:3], v[24:27]
buffer_load_dwordx4 v5, s[60:63], 0 offen lds
v_mfma_f32_16x16x32_bf16 v[24:27], a[84:87], a[16:19], v[24:27]
ds_read_b64_tr_b16 a[104:105], v13 offset:256
s_waitcnt vmcnt(20)
v_mfma_f32_16x16x32_bf16 v[32:35], a[84:87], a[20:23], v[32:35]
ds_read_b64_tr_b16 a[106:107], v13 offset:1280
v_mfma_f32_16x16x32_bf16 v[32:35], a[80:83], a[4:7], v[32:35]
ds_read_b64_tr_b16 a[108:109], v13 offset:8448
v_mfma_f32_16x16x32_bf16 v[40:43], a[80:83], a[8:11], v[40:43]
ds_read_b64_tr_b16 a[110:111], v13 offset:9472
s_add_u32 m0, s17, 0x8400
v_mfma_f32_16x16x32_bf16 v[40:43], a[84:87], a[24:27], v[40:43]
buffer_load_dwordx4 v5, s[56:59], s13 offen lds
v_mfma_f32_16x16x32_bf16 v[48:51], a[84:87], a[28:31], v[48:51]
ds_read_b128 a[32:35], v8 offset:32768
v_mfma_f32_16x16x32_bf16 v[48:51], a[80:83], a[12:15], v[48:51]
ds_read_b128 a[48:51], v9 offset:32768
v_mfma_f32_16x16x32_bf16 v[52:55], a[88:91], a[12:15], v[52:55]
ds_read_b64_tr_b16 a[80:81], v12 offset:512
v_mfma_f32_16x16x32_bf16 v[52:55], a[92:95], a[28:31], v[52:55]
ds_read_b64_tr_b16 a[82:83], v12 offset:1536
s_add_u32 m0, s17, 0xc400
v_mfma_f32_16x16x32_bf16 v[44:47], a[92:95], a[24:27], v[44:47]
buffer_load_dwordx4 v5, s[60:63], s13 offen lds
v_mfma_f32_16x16x32_bf16 v[44:47], a[88:91], a[8:11], v[44:47]
ds_read_b64_tr_b16 a[84:85], v12 offset:8704
v_mfma_f32_16x16x32_bf16 v[36:39], a[88:91], a[4:7], v[36:39]
ds_read_b64_tr_b16 a[86:87], v12 offset:9728
v_mfma_f32_16x16x32_bf16 v[36:39], a[92:95], a[20:23], v[36:39]
ds_read_b128 a[36:39], v8 offset:34816
s_waitcnt lgkmcnt(7)
v_mfma_f32_16x16x32_bf16 v[28:31], a[92:95], a[16:19], v[28:31]
ds_read_b128 a[52:55], v9 offset:34816
s_add_u32 m0, s17, 0x8800
v_mfma_f32_16x16x32_bf16 v[28:31], a[88:91], a[0:3], v[28:31]
buffer_load_dwordx4 v6, s[56:59], 0 offen lds
v_mfma_f32_16x16x32_bf16 v[56:59], a[96:99], a[0:3], v[56:59]
ds_read_b64_tr_b16 a[88:89], v13 offset:512
v_mfma_f32_16x16x32_bf16 v[56:59], a[100:103], a[16:19], v[56:59]
ds_read_b64_tr_b16 a[90:91], v13 offset:1536
v_mfma_f32_16x16x32_bf16 v[64:67], a[100:103], a[20:23], v[64:67]
ds_read_b64_tr_b16 a[92:93], v13 offset:8704
v_mfma_f32_16x16x32_bf16 v[64:67], a[96:99], a[4:7], v[64:67]
ds_read_b64_tr_b16 a[94:95], v13 offset:9728
s_add_u32 m0, s17, 0xc800
v_mfma_f32_16x16x32_bf16 v[72:75], a[96:99], a[8:11], v[72:75]
buffer_load_dwordx4 v6, s[60:63], 0 offen lds
v_mfma_f32_16x16x32_bf16 v[72:75], a[100:103], a[24:27], v[72:75]
ds_read_b128 a[40:43], v8 offset:36864
v_mfma_f32_16x16x32_bf16 v[80:83], a[100:103], a[28:31], v[80:83]
ds_read_b128 a[56:59], v9 offset:36864
v_mfma_f32_16x16x32_bf16 v[80:83], a[96:99], a[12:15], v[80:83]
ds_read_b128 a[44:47], v8 offset:38912
v_mfma_f32_16x16x32_bf16 v[84:87], a[104:107], a[12:15], v[84:87]
ds_read_b64_tr_b16 a[96:97], v12 offset:768
s_add_u32 m0, s17, 0x8c00
v_mfma_f32_16x16x32_bf16 v[84:87], a[108:111], a[28:31], v[84:87]
buffer_load_dwordx4 v6, s[56:59], s13 offen lds
v_mfma_f32_16x16x32_bf16 v[76:79], a[108:111], a[24:27], v[76:79]
ds_read_b64_tr_b16 a[98:99], v12 offset:1792
v_mfma_f32_16x16x32_bf16 v[76:79], a[104:107], a[8:11], v[76:79]
ds_read_b64_tr_b16 a[100:101], v12 offset:8960
v_mfma_f32_16x16x32_bf16 v[68:71], a[104:107], a[4:7], v[68:71]
ds_read_b64_tr_b16 a[102:103], v12 offset:9984
v_mfma_f32_16x16x32_bf16 v[68:71], a[108:111], a[20:23], v[68:71]
ds_read_b128 a[60:63], v9 offset:38912
s_add_u32 m0, s17, 0xcc00
v_mfma_f32_16x16x32_bf16 v[60:63], a[108:111], a[16:19], v[60:63]
buffer_load_dwordx4 v6, s[60:63], s13 offen lds
v_mfma_f32_16x16x32_bf16 v[60:63], a[104:107], a[0:3], v[60:63]
s_waitcnt lgkmcnt(8)
v_lshl_add_u32 v5, s42, 19, v5
v_lshl_add_u32 v6, s42, 19, v6
v_mfma_f32_16x16x32_bf16 v[88:91], a[80:83], a[0:3], v[88:91]
ds_read_b64_tr_b16 a[104:105], v13 offset:768
v_mfma_f32_16x16x32_bf16 v[88:91], a[84:87], a[16:19], v[88:91]
ds_read_b64_tr_b16 a[106:107], v13 offset:1792
v_mfma_f32_16x16x32_bf16 v[96:99], a[84:87], a[20:23], v[96:99]
ds_read_b64_tr_b16 a[108:109], v13 offset:8960
v_mfma_f32_16x16x32_bf16 v[96:99], a[80:83], a[4:7], v[96:99]
ds_read_b64_tr_b16 a[110:111], v13 offset:9984
v_mfma_f32_16x16x32_bf16 v[104:107], a[80:83], a[8:11], v[104:107]
s_add_u32 m0, s16, 0x8000
s_waitcnt lgkmcnt(4)
v_mfma_f32_16x16x32_bf16 v[104:107], a[84:87], a[24:27], v[104:107]
buffer_load_dwordx4 v2, s[48:51], 0 offen lds
v_mfma_f32_16x16x32_bf16 v[112:115], a[84:87], a[28:31], v[112:115]
v_mfma_f32_16x16x32_bf16 v[112:115], a[80:83], a[12:15], v[112:115]
v_mfma_f32_16x16x32_bf16 v[116:119], a[88:91], a[12:15], v[116:119]
ds_read_b64_tr_b16 a[80:81], v12 offset:16384
v_mfma_f32_16x16x32_bf16 v[116:119], a[92:95], a[28:31], v[116:119]
ds_read_b64_tr_b16 a[82:83], v12 offset:17408
v_mfma_f32_16x16x32_bf16 v[108:111], a[92:95], a[24:27], v[108:111]
ds_read_b64_tr_b16 a[84:85], v12 offset:24576
v_mfma_f32_16x16x32_bf16 v[108:111], a[88:91], a[8:11], v[108:111]
ds_read_b64_tr_b16 a[86:87], v12 offset:25600
s_add_u32 m0, s16, 0x8400
v_mfma_f32_16x16x32_bf16 v[100:103], a[88:91], a[4:7], v[100:103]
buffer_load_dwordx4 v3, s[48:51], 0 offen lds
v_mfma_f32_16x16x32_bf16 v[100:103], a[92:95], a[20:23], v[100:103]
v_mfma_f32_16x16x32_bf16 v[92:95], a[92:95], a[16:19], v[92:95]
v_mfma_f32_16x16x32_bf16 v[92:95], a[88:91], a[0:3], v[92:95]
s_waitcnt lgkmcnt(4)
v_mfma_f32_16x16x32_bf16 v[120:123], a[96:99], a[0:3], v[120:123]
ds_read_b64_tr_b16 a[88:89], v13 offset:16384
v_mfma_f32_16x16x32_bf16 v[120:123], a[100:103], a[16:19], v[120:123]
ds_read_b64_tr_b16 a[90:91], v13 offset:17408
v_mfma_f32_16x16x32_bf16 v[128:131], a[100:103], a[20:23], v[128:131]
ds_read_b64_tr_b16 a[92:93], v13 offset:24576
v_mfma_f32_16x16x32_bf16 v[128:131], a[96:99], a[4:7], v[128:131]
ds_read_b64_tr_b16 a[94:95], v13 offset:25600
s_add_u32 m0, s16, 0x8800
v_mfma_f32_16x16x32_bf16 v[136:139], a[96:99], a[8:11], v[136:139]
buffer_load_dwordx4 v2, s[48:51], s12 offen lds
v_mfma_f32_16x16x32_bf16 v[136:139], a[100:103], a[24:27], v[136:139]
v_mfma_f32_16x16x32_bf16 v[144:147], a[100:103], a[28:31], v[144:147]
v_mfma_f32_16x16x32_bf16 v[144:147], a[96:99], a[12:15], v[144:147]
v_mfma_f32_16x16x32_bf16 v[148:151], a[104:107], a[12:15], v[148:151]
ds_read_b64_tr_b16 a[96:97], v12 offset:16640
v_mfma_f32_16x16x32_bf16 v[148:151], a[108:111], a[28:31], v[148:151]
ds_read_b64_tr_b16 a[98:99], v12 offset:17664
v_mfma_f32_16x16x32_bf16 v[140:143], a[108:111], a[24:27], v[140:143]
ds_read_b64_tr_b16 a[100:101], v12 offset:24832
s_add_u32 m0, s16, 0x8c00
v_mfma_f32_16x16x32_bf16 v[140:143], a[104:107], a[8:11], v[140:143]
buffer_load_dwordx4 v3, s[48:51], s12 offen lds
v_mfma_f32_16x16x32_bf16 v[132:135], a[104:107], a[4:7], v[132:135]
ds_read_b64_tr_b16 a[102:103], v12 offset:25856
v_mfma_f32_16x16x32_bf16 v[132:135], a[108:111], a[20:23], v[132:135]
v_mfma_f32_16x16x32_bf16 v[124:127], a[108:111], a[16:19], v[124:127]
v_mfma_f32_16x16x32_bf16 v[124:127], a[104:107], a[0:3], v[124:127]
s_waitcnt lgkmcnt(4)
v_mfma_f32_16x16x32_bf16 v[152:155], a[0:3], a[80:83], v[152:155]
ds_read_b64_tr_b16 a[104:105], v13 offset:16640
v_mfma_f32_16x16x32_bf16 v[152:155], a[16:19], a[84:87], v[152:155]
ds_read_b64_tr_b16 a[106:107], v13 offset:17664
s_add_u32 m0, s16, 0x9000
v_mfma_f32_16x16x32_bf16 v[156:159], a[20:23], a[84:87], v[156:159]
buffer_load_dwordx4 v2, s[48:51], s13 offen lds
v_mfma_f32_16x16x32_bf16 v[156:159], a[4:7], a[80:83], v[156:159]
ds_read_b64_tr_b16 a[108:109], v13 offset:24832
v_mfma_f32_16x16x32_bf16 v[160:163], a[8:11], a[80:83], v[160:163]
ds_read_b64_tr_b16 a[110:111], v13 offset:25856
v_mfma_f32_16x16x32_bf16 v[160:163], a[24:27], a[84:87], v[160:163]
v_mfma_f32_16x16x32_bf16 v[164:167], a[28:31], a[84:87], v[164:167]
v_mfma_f32_16x16x32_bf16 v[164:167], a[12:15], a[80:83], v[164:167]
v_mfma_f32_16x16x32_bf16 v[180:183], a[12:15], a[88:91], v[180:183]
ds_read_b64_tr_b16 a[80:81], v12 offset:16896
v_mfma_f32_16x16x32_bf16 v[180:183], a[28:31], a[92:95], v[180:183]
ds_read_b64_tr_b16 a[82:83], v12 offset:17920
s_add_u32 m0, s16, 0x9400
v_mfma_f32_16x16x32_bf16 v[176:179], a[24:27], a[92:95], v[176:179]
buffer_load_dwordx4 v3, s[48:51], s13 offen lds
v_mfma_f32_16x16x32_bf16 v[176:179], a[8:11], a[88:91], v[176:179]
ds_read_b64_tr_b16 a[84:85], v12 offset:25088
v_mfma_f32_16x16x32_bf16 v[172:175], a[4:7], a[88:91], v[172:175]
ds_read_b64_tr_b16 a[86:87], v12 offset:26112
v_mfma_f32_16x16x32_bf16 v[172:175], a[20:23], a[92:95], v[172:175]
v_mfma_f32_16x16x32_bf16 v[168:171], a[16:19], a[92:95], v[168:171]
v_mfma_f32_16x16x32_bf16 v[168:171], a[0:3], a[88:91], v[168:171]
s_waitcnt lgkmcnt(4)
v_mfma_f32_16x16x32_bf16 v[184:187], a[0:3], a[96:99], v[184:187]
ds_read_b64_tr_b16 a[88:89], v13 offset:16896
s_add_u32 m0, s16, 0x9800
v_mfma_f32_16x16x32_bf16 v[184:187], a[16:19], a[100:103], v[184:187]
buffer_load_dwordx4 v2, s[48:51], s14 offen lds
v_mfma_f32_16x16x32_bf16 v[188:191], a[20:23], a[100:103], v[188:191]
ds_read_b64_tr_b16 a[90:91], v13 offset:17920
v_mfma_f32_16x16x32_bf16 v[188:191], a[4:7], a[96:99], v[188:191]
ds_read_b64_tr_b16 a[92:93], v13 offset:25088
v_mfma_f32_16x16x32_bf16 v[192:195], a[8:11], a[96:99], v[192:195]
ds_read_b64_tr_b16 a[94:95], v13 offset:26112
v_mfma_f32_16x16x32_bf16 v[192:195], a[24:27], a[100:103], v[192:195]
v_mfma_f32_16x16x32_bf16 v[196:199], a[28:31], a[100:103], v[196:199]
v_mfma_f32_16x16x32_bf16 v[196:199], a[12:15], a[96:99], v[196:199]
v_mfma_f32_16x16x32_bf16 v[212:215], a[12:15], a[104:107], v[212:215]
ds_read_b64_tr_b16 a[96:97], v12 offset:17152
s_add_u32 m0, s16, 0x9c00
v_mfma_f32_16x16x32_bf16 v[212:215], a[28:31], a[108:111], v[212:215]
buffer_load_dwordx4 v3, s[48:51], s14 offen lds
v_mfma_f32_16x16x32_bf16 v[208:211], a[24:27], a[108:111], v[208:211]
ds_read_b64_tr_b16 a[98:99], v12 offset:18176
v_lshl_add_u32 v2, s42, 7, v2
v_mfma_f32_16x16x32_bf16 v[208:211], a[8:11], a[104:107], v[208:211]
ds_read_b64_tr_b16 a[100:101], v12 offset:25344
v_lshl_add_u32 v3, s42, 7, v3
v_mfma_f32_16x16x32_bf16 v[204:207], a[4:7], a[104:107], v[204:207]
ds_read_b64_tr_b16 a[102:103], v12 offset:26368
v_mfma_f32_16x16x32_bf16 v[204:207], a[20:23], a[108:111], v[204:207]
v_mfma_f32_16x16x32_bf16 v[200:203], a[16:19], a[108:111], v[200:203]
v_mfma_f32_16x16x32_bf16 v[200:203], a[0:3], a[104:107], v[200:203]
s_mov_b32 s9, 0x0
s_waitcnt lgkmcnt(4)
v_mfma_f32_16x16x32_bf16 v[216:219], a[0:3], a[80:83], v[216:219]
buffer_load_dword a120, v19, s[44:47], s9 offen
v_mfma_f32_16x16x32_bf16 v[216:219], a[16:19], a[84:87], v[216:219]
ds_read_b64_tr_b16 a[104:105], v13 offset:17152
v_mfma_f32_16x16x32_bf16 v[220:223], a[20:23], a[84:87], v[220:223]
ds_read_b64_tr_b16 a[106:107], v13 offset:18176
v_mfma_f32_16x16x32_bf16 v[220:223], a[4:7], a[80:83], v[220:223]
ds_read_b64_tr_b16 a[108:109], v13 offset:25344
v_mfma_f32_16x16x32_bf16 v[224:227], a[8:11], a[80:83], v[224:227]
ds_read_b64_tr_b16 a[110:111], v13 offset:26368
v_add_u32 v12, 0xffff0000, v12
v_mfma_f32_16x16x32_bf16 v[224:227], a[24:27], a[84:87], v[224:227]
v_add_u32 v13, 0xffff0000, v13
v_mfma_f32_16x16x32_bf16 v[228:231], a[28:31], a[84:87], v[228:231]
v_mfma_f32_16x16x32_bf16 v[228:231], a[12:15], a[80:83], v[228:231]
v_mfma_f32_16x16x32_bf16 v[244:247], a[12:15], a[88:91], v[244:247]
s_waitcnt vmcnt(27) lgkmcnt(0)
v_mfma_f32_16x16x32_bf16 v[244:247], a[28:31], a[92:95], v[244:247]
s_barrier
s_add_u32 m0, s17, 0x10000
v_mfma_f32_16x16x32_bf16 v[240:243], a[24:27], a[92:95], v[240:243]
buffer_load_dwordx4 v5, s[56:59], 0 offen lds
v_mfma_f32_16x16x32_bf16 v[240:243], a[8:11], a[88:91], v[240:243]
ds_read_b64_tr_b16 a[80:81], v12 offset:0
v_mfma_f32_16x16x32_bf16 v[236:239], a[4:7], a[88:91], v[236:239]
ds_read_b64_tr_b16 a[82:83], v12 offset:1024
v_mfma_f32_16x16x32_bf16 v[236:239], a[20:23], a[92:95], v[236:239]
ds_read_b64_tr_b16 a[84:85], v12 offset:8192
v_mfma_f32_16x16x32_bf16 v[232:235], a[16:19], a[92:95], v[232:235]
ds_read_b64_tr_b16 a[86:87], v12 offset:9216
v_mfma_f32_16x16x32_bf16 v[232:235], a[0:3], a[88:91], v[232:235]
s_waitcnt lgkmcnt(4)
v_mfma_f32_16x16x32_bf16 v[248:251], a[0:3], a[96:99], v[248:251]
ds_read_b64_tr_b16 a[88:89], v13 offset:0
s_add_u32 m0, s17, 0x14000
v_mfma_f32_16x16x32_bf16 v[248:251], a[16:19], a[100:103], v[248:251]
buffer_load_dwordx4 v5, s[60:63], 0 offen lds
v_mfma_f32_16x16x32_bf16 v[252:255], a[20:23], a[100:103], v[252:255]
ds_read_b64_tr_b16 a[90:91], v13 offset:1024
v_mfma_f32_16x16x32_bf16 v[252:255], a[4:7], a[96:99], v[252:255]
ds_read_b64_tr_b16 a[92:93], v13 offset:8192
v_mfma_f32_16x16x32_bf16 a[232:235], a[8:11], a[96:99], a[232:235]
ds_read_b64_tr_b16 a[94:95], v13 offset:9216
v_mfma_f32_16x16x32_bf16 a[232:235], a[24:27], a[100:103], a[232:235]
v_mfma_f32_16x16x32_bf16 a[236:239], a[28:31], a[100:103], a[236:239]
v_mfma_f32_16x16x32_bf16 a[236:239], a[12:15], a[96:99], a[236:239]
s_add_u32 m0, s17, 0x10400
v_mfma_f32_16x16x32_bf16 a[252:255], a[12:15], a[104:107], a[252:255]
buffer_load_dwordx4 v5, s[56:59], s13 offen lds
v_mfma_f32_16x16x32_bf16 a[252:255], a[28:31], a[108:111], a[252:255]
ds_read_b64_tr_b16 a[96:97], v12 offset:256
v_mfma_f32_16x16x32_bf16 a[248:251], a[24:27], a[108:111], a[248:251]
ds_read_b64_tr_b16 a[98:99], v12 offset:1280
v_mfma_f32_16x16x32_bf16 a[248:251], a[8:11], a[104:107], a[248:251]
ds_read_b64_tr_b16 a[100:101], v12 offset:8448
v_mfma_f32_16x16x32_bf16 a[244:247], a[4:7], a[104:107], a[244:247]
ds_read_b64_tr_b16 a[102:103], v12 offset:9472
v_mfma_f32_16x16x32_bf16 a[244:247], a[20:23], a[108:111], a[244:247]
v_mfma_f32_16x16x32_bf16 a[240:243], a[16:19], a[108:111], a[240:243]
s_add_u32 m0, s17, 0x14400
s_waitcnt lgkmcnt(4)
v_mfma_f32_16x16x32_bf16 a[240:243], a[0:3], a[104:107], a[240:243]
buffer_load_dwordx4 v5, s[60:63], s13 offen lds
L_S3:
v_mfma_f32_16x16x32_bf16 v[24:27], a[80:83], a[32:35], v[24:27]
ds_read_b64_tr_b16 a[104:105], v13 offset:256
s_waitcnt vmcnt(22)
v_mfma_f32_16x16x32_bf16 v[24:27], a[84:87], a[48:51], v[24:27]
ds_read_b64_tr_b16 a[106:107], v13 offset:1280
v_mfma_f32_16x16x32_bf16 v[32:35], a[84:87], a[52:55], v[32:35]
ds_read_b64_tr_b16 a[108:109], v13 offset:8448
v_mfma_f32_16x16x32_bf16 v[32:35], a[80:83], a[36:39], v[32:35]
ds_read_b64_tr_b16 a[110:111], v13 offset:9472
v_mfma_f32_16x16x32_bf16 v[40:43], a[80:83], a[40:43], v[40:43]
ds_read_b128 a[0:3], v8 offset:0
v_mfma_f32_16x16x32_bf16 v[40:43], a[84:87], a[56:59], v[40:43]
ds_read_b128 a[16:19], v9 offset:0
s_add_u32 m0, s17, 0x10800
v_mfma_f32_16x16x32_bf16 v[48:51], a[84:87], a[60:63], v[48:51]
buffer_load_dwordx4 v6, s[56:59], 0 offen lds
v_mfma_f32_16x16x32_bf16 v[48:51], a[80:83], a[44:47], v[48:51]
ds_read_b128 a[4:7], v8 offset:2048
v_mfma_f32_16x16x32_bf16 v[52:55], a[88:91], a[44:47], v[52:55]
ds_read_b64_tr_b16 a[80:81], v12 offset:512
v_mfma_f32_16x16x32_bf16 v[52:55], a[92:95], a[60:63], v[52:55]
ds_read_b64_tr_b16 a[82:83], v12 offset:1536
v_mfma_f32_16x16x32_bf16 v[44:47], a[92:95], a[56:59], v[44:47]
ds_read_b64_tr_b16 a[84:85], v12 offset:8704
v_mfma_f32_16x16x32_bf16 v[44:47], a[88:91], a[40:43], v[44:47]
ds_read_b64_tr_b16 a[86:87], v12 offset:9728
v_mfma_f32_16x16x32_bf16 v[36:39], a[88:91], a[36:39], v[36:39]
ds_read_b128 a[20:23], v9 offset:2048
s_add_u32 m0, s17, 0x14800
v_mfma_f32_16x16x32_bf16 v[36:39], a[92:95], a[52:55], v[36:39]
buffer_load_dwordx4 v6, s[60:63], 0 offen lds
v_mfma_f32_16x16x32_bf16 v[28:31], a[92:95], a[48:51], v[28:31]
ds_read_b128 a[8:11], v8 offset:4096
v_mfma_f32_16x16x32_bf16 v[28:31], a[88:91], a[32:35], v[28:31]
ds_read_b128 a[24:27], v9 offset:4096
s_waitcnt lgkmcnt(10)
v_mfma_f32_16x16x32_bf16 v[56:59], a[96:99], a[32:35], v[56:59]
ds_read_b64_tr_b16 a[88:89], v13 offset:512
v_mfma_f32_16x16x32_bf16 v[56:59], a[100:103], a[48:51], v[56:59]
ds_read_b64_tr_b16 a[90:91], v13 offset:1536
v_mfma_f32_16x16x32_bf16 v[64:67], a[100:103], a[52:55], v[64:67]
ds_read_b64_tr_b16 a[92:93], v13 offset:8704
v_mfma_f32_16x16x32_bf16 v[64:67], a[96:99], a[36:39], v[64:67]
ds_read_b64_tr_b16 a[94:95], v13 offset:9728
s_add_u32 m0, s17, 0x10c00
v_mfma_f32_16x16x32_bf16 v[72:75], a[96:99], a[40:43], v[72:75]
buffer_load_dwordx4 v6, s[56:59], s13 offen lds
v_mfma_f32_16x16x32_bf16 v[72:75], a[100:103], a[56:59], v[72:75]
ds_read_b128 a[12:15], v8 offset:6144
v_mfma_f32_16x16x32_bf16 v[80:83], a[100:103], a[60:63], v[80:83]
ds_read_b128 a[28:31], v9 offset:6144
v_mfma_f32_16x16x32_bf16 v[80:83], a[96:99], a[44:47], v[80:83]
v_mfma_f32_16x16x32_bf16 v[84:87], a[104:107], a[44:47], v[84:87]
ds_read_b64_tr_b16 a[96:97], v12 offset:768
v_mfma_f32_16x16x32_bf16 v[84:87], a[108:111], a[60:63], v[84:87]
ds_read_b64_tr_b16 a[98:99], v12 offset:1792
v_mfma_f32_16x16x32_bf16 v[76:79], a[108:111], a[56:59], v[76:79]
ds_read_b64_tr_b16 a[100:101], v12 offset:8960
s_add_u32 m0, s17, 0x14c00
v_mfma_f32_16x16x32_bf16 v[76:79], a[104:107], a[40:43], v[76:79]
buffer_load_dwordx4 v6, s[60:63], s13 offen lds
v_mfma_f32_16x16x32_bf16 v[68:71], a[104:107], a[36:39], v[68:71]
ds_read_b64_tr_b16 a[102:103], v12 offset:9984
v_lshl_add_u32 v5, s42, 19, v5
v_mfma_f32_16x16x32_bf16 v[68:71], a[108:111], a[52:55], v[68:71]
v_lshl_add_u32 v6, s42, 19, v6
v_mfma_f32_16x16x32_bf16 v[60:63], a[108:111], a[48:51], v[60:63]
v_mfma_f32_16x16x32_bf16 v[60:63], a[104:107], a[32:35], v[60:63]
s_waitcnt lgkmcnt(6)
v_mfma_f32_16x16x32_bf16 v[88:91], a[80:83], a[32:35], v[88:91]
ds_read_b64_tr_b16 a[104:105], v13 offset:768
v_mfma_f32_16x16x32_bf16 v[88:91], a[84:87], a[48:51], v[88:91]
ds_read_b64_tr_b16 a[106:107], v13 offset:1792
s_mov_b32 s9, 0x200000
v_mfma_f32_16x16x32_bf16 v[96:99], a[84:87], a[52:55], v[96:99]
buffer_load_dword a120, v19, s[44:47], s9 offen
v_mfma_f32_16x16x32_bf16 v[96:99], a[80:83], a[36:39], v[96:99]
ds_read_b64_tr_b16 a[108:109], v13 offset:8960
v_mfma_f32_16x16x32_bf16 v[104:107], a[80:83], a[40:43], v[104:107]
ds_read_b64_tr_b16 a[110:111], v13 offset:9984
v_mfma_f32_16x16x32_bf16 v[104:107], a[84:87], a[56:59], v[104:107]
v_mfma_f32_16x16x32_bf16 v[112:115], a[84:87], a[60:63], v[112:115]
v_mfma_f32_16x16x32_bf16 v[112:115], a[80:83], a[44:47], v[112:115]
s_waitcnt lgkmcnt(8)
v_mfma_f32_16x16x32_bf16 v[116:119], a[88:91], a[44:47], v[116:119]
ds_read_b64_tr_b16 a[80:81], v12 offset:16384
s_add_u32 m0, s16, 0x0
v_mfma_f32_16x16x32_bf16 v[116:119], a[92:95], a[60:63], v[116:119]
buffer_load_dwordx4 v2, s[48:51], 0 offen lds
v_mfma_f32_16x16x32_bf16 v[108:111], a[92:95], a[56:59], v[108:111]
ds_read_b64_tr_b16 a[82:83], v12 offset:17408
v_mfma_f32_16x16x32_bf16 v[108:111], a[88:91], a[40:43], v[108:111]
ds_read_b64_tr_b16 a[84:85], v12 offset:24576
v_mfma_f32_16x16x32_bf16 v[100:103], a[88:91], a[36:39], v[100:103]
ds_read_b64_tr_b16 a[86:87], v12 offset:25600
v_mfma_f32_16x16x32_bf16 v[100:103], a[92:95], a[52:55], v[100:103]
v_mfma_f32_16x16x32_bf16 v[92:95], a[92:95], a[48:51], v[92:95]
v_mfma_f32_16x16x32_bf16 v[92:95], a[88:91], a[32:35], v[92:95]
s_add_u32 m0, s16, 0x400
s_waitcnt lgkmcnt(4)
v_mfma_f32_16x16x32_bf16 v[120:123], a[96:99], a[32:35], v[120:123]
buffer_load_dwordx4 v3, s[48:51], 0 offen lds
v_mfma_f32_16x16x32_bf16 v[120:123], a[100:103], a[48:51], v[120:123]
ds_read_b64_tr_b16 a[88:89], v13 offset:16384
v_mfma_f32_16x16x32_bf16 v[128:131], a[100:103], a[52:55], v[128:131]
ds_read_b64_tr_b16 a[90:91], v13 offset:17408
v_mfma_f32_16x16x32_bf16 v[128:131], a[96:99], a[36:39], v[128:131]
ds_read_b64_tr_b16 a[92:93], v13 offset:24576
v_mfma_f32_16x16x32_bf16 v[136:139], a[96:99], a[40:43], v[136:139]
ds_read_b64_tr_b16 a[94:95], v13 offset:25600
v_mfma_f32_16x16x32_bf16 v[136:139], a[100:103], a[56:59], v[136:139]
v_mfma_f32_16x16x32_bf16 v[144:147], a[100:103], a[60:63], v[144:147]
s_add_u32 m0, s16, 0x800
v_mfma_f32_16x16x32_bf16 v[144:147], a[96:99], a[44:47], v[144:147]
buffer_load_dwordx4 v2, s[48:51], s12 offen lds
v_mfma_f32_16x16x32_bf16 v[148:151], a[104:107], a[44:47], v[148:151]
ds_read_b64_tr_b16 a[96:97], v12 offset:16640
v_mfma_f32_16x16x32_bf16 v[148:151], a[108:111], a[60:63], v[148:151]
ds_read_b64_tr_b16 a[98:99], v12 offset:17664
v_mfma_f32_16x16x32_bf16 v[140:143], a[108:111], a[56:59], v[140:143]
ds_read_b64_tr_b16 a[100:101], v12 offset:24832
v_mfma_f32_16x16x32_bf16 v[140:143], a[104:107], a[40:43], v[140:143]
ds_read_b64_tr_b16 a[102:103], v12 offset:25856
v_mfma_f32_16x16x32_bf16 v[132:135], a[104:107], a[36:39], v[132:135]
v_mfma_f32_16x16x32_bf16 v[132:135], a[108:111], a[52:55], v[132:135]
s_add_u32 m0, s16, 0xc00
v_mfma_f32_16x16x32_bf16 v[124:127], a[108:111], a[48:51], v[124:127]
buffer_load_dwordx4 v3, s[48:51], s12 offen lds
v_mfma_f32_16x16x32_bf16 v[124:127], a[104:107], a[32:35], v[124:127]
s_waitcnt lgkmcnt(4)
v_mfma_f32_16x16x32_bf16 v[152:155], a[32:35], a[80:83], v[152:155]
ds_read_b64_tr_b16 a[104:105], v13 offset:16640
v_mfma_f32_16x16x32_bf16 v[152:155], a[48:51], a[84:87], v[152:155]
ds_read_b64_tr_b16 a[106:107], v13 offset:17664
v_mfma_f32_16x16x32_bf16 v[156:159], a[52:55], a[84:87], v[156:159]
ds_read_b64_tr_b16 a[108:109], v13 offset:24832
v_mfma_f32_16x16x32_bf16 v[156:159], a[36:39], a[80:83], v[156:159]
ds_read_b64_tr_b16 a[110:111], v13 offset:25856
v_mfma_f32_16x16x32_bf16 v[160:163], a[40:43], a[80:83], v[160:163]
s_add_u32 m0, s16, 0x1000
v_mfma_f32_16x16x32_bf16 v[160:163], a[56:59], a[84:87], v[160:163]
buffer_load_dwordx4 v2, s[48:51], s13 offen lds
v_mfma_f32_16x16x32_bf16 v[164:167], a[60:63], a[84:87], v[164:167]
v_mfma_f32_16x16x32_bf16 v[164:167], a[44:47], a[80:83], v[164:167]
v_mfma_f32_16x16x32_bf16 v[180:183], a[44:47], a[88:91], v[180:183]
ds_read_b64_tr_b16 a[80:81], v12 offset:16896
v_mfma_f32_16x16x32_bf16 v[180:183], a[60:63], a[92:95], v[180:183]
ds_read_b64_tr_b16 a[82:83], v12 offset:17920
v_mfma_f32_16x16x32_bf16 v[176:179], a[56:59], a[92:95], v[176:179]
ds_read_b64_tr_b16 a[84:85], v12 offset:25088
v_mfma_f32_16x16x32_bf16 v[176:179], a[40:43], a[88:91], v[176:179]
ds_read_b64_tr_b16 a[86:87], v12 offset:26112
s_add_u32 m0, s16, 0x1400
v_mfma_f32_16x16x32_bf16 v[172:175], a[36:39], a[88:91], v[172:175]
buffer_load_dwordx4 v3, s[48:51], s13 offen lds
v_mfma_f32_16x16x32_bf16 v[172:175], a[52:55], a[92:95], v[172:175]
v_mfma_f32_16x16x32_bf16 v[168:171], a[48:51], a[92:95], v[168:171]
v_mfma_f32_16x16x32_bf16 v[168:171], a[32:35], a[88:91], v[168:171]
s_waitcnt lgkmcnt(4)
v_mfma_f32_16x16x32_bf16 v[184:187], a[32:35], a[96:99], v[184:187]
ds_read_b64_tr_b16 a[88:89], v13 offset:16896
v_mfma_f32_16x16x32_bf16 v[184:187], a[48:51], a[100:103], v[184:187]
ds_read_b64_tr_b16 a[90:91], v13 offset:17920
v_mfma_f32_16x16x32_bf16 v[188:191], a[52:55], a[100:103], v[188:191]
ds_read_b64_tr_b16 a[92:93], v13 offset:25088
s_add_u32 m0, s16, 0x1800
v_mfma_f32_16x16x32_bf16 v[188:191], a[36:39], a[96:99], v[188:191]
buffer_load_dwordx4 v2, s[48:51], s14 offen lds
v_mfma_f32_16x16x32_bf16 v[192:195], a[40:43], a[96:99], v[192:195]
ds_read_b64_tr_b16 a[94:95], v13 offset:26112
v_mfma_f32_16x16x32_bf16 v[192:195], a[56:59], a[100:103], v[192:195]
v_mfma_f32_16x16x32_bf16 v[196:199], a[60:63], a[100:103], v[196:199]
v_mfma_f32_16x16x32_bf16 v[196:199], a[44:47], a[96:99], v[196:199]
v_mfma_f32_16x16x32_bf16 v[212:215], a[44:47], a[104:107], v[212:215]
ds_read_b64_tr_b16 a[96:97], v12 offset:17152
v_mfma_f32_16x16x32_bf16 v[212:215], a[60:63], a[108:111], v[212:215]
ds_read_b64_tr_b16 a[98:99], v12 offset:18176
s_add_u32 m0, s16, 0x1c00
v_mfma_f32_16x16x32_bf16 v[208:211], a[56:59], a[108:111], v[208:211]
buffer_load_dwordx4 v3, s[48:51], s14 offen lds
v_mfma_f32_16x16x32_bf16 v[208:211], a[40:43], a[104:107], v[208:211]
ds_read_b64_tr_b16 a[100:101], v12 offset:25344
v_lshl_add_u32 v2, s42, 7, v2
v_mfma_f32_16x16x32_bf16 v[204:207], a[36:39], a[104:107], v[204:207]
ds_read_b64_tr_b16 a[102:103], v12 offset:26368
v_lshl_add_u32 v3, s42, 7, v3
v_mfma_f32_16x16x32_bf16 v[204:207], a[52:55], a[108:111], v[204:207]
v_mfma_f32_16x16x32_bf16 v[200:203], a[48:51], a[108:111], v[200:203]
v_mfma_f32_16x16x32_bf16 v[200:203], a[32:35], a[104:107], v[200:203]
s_waitcnt lgkmcnt(4)
v_mfma_f32_16x16x32_bf16 v[216:219], a[32:35], a[80:83], v[216:219]
ds_read_b64_tr_b16 a[104:105], v13 offset:17152
s_mov_b32 s9, 0x0
v_mfma_f32_16x16x32_bf16 v[216:219], a[48:51], a[84:87], v[216:219]
buffer_load_dword a120, v18, s[52:55], s9 offen
v_mfma_f32_16x16x32_bf16 v[220:223], a[52:55], a[84:87], v[220:223]
ds_read_b64_tr_b16 a[106:107], v13 offset:18176
v_mfma_f32_16x16x32_bf16 v[220:223], a[36:39], a[80:83], v[220:223]
ds_read_b64_tr_b16 a[108:109], v13 offset:25344
v_mfma_f32_16x16x32_bf16 v[224:227], a[40:43], a[80:83], v[224:227]
ds_read_b64_tr_b16 a[110:111], v13 offset:26368
v_add_u32 v12, 0x8000, v12
v_mfma_f32_16x16x32_bf16 v[224:227], a[56:59], a[84:87], v[224:227]
v_add_u32 v13, 0x8000, v13
v_mfma_f32_16x16x32_bf16 v[228:231], a[60:63], a[84:87], v[228:231]
v_mfma_f32_16x16x32_bf16 v[228:231], a[44:47], a[80:83], v[228:231]
v_mfma_f32_16x16x32_bf16 v[244:247], a[44:47], a[88:91], v[244:247]
s_waitcnt vmcnt(27) lgkmcnt(0)
v_mfma_f32_16x16x32_bf16 v[244:247], a[60:63], a[92:95], v[244:247]
s_barrier
s_add_u32 m0, s17, 0x0
v_mfma_f32_16x16x32_bf16 v[240:243], a[56:59], a[92:95], v[240:243]
buffer_load_dwordx4 v5, s[56:59], 0 offen lds
v_mfma_f32_16x16x32_bf16 v[240:243], a[40:43], a[88:91], v[240:243]
ds_read_b64_tr_b16 a[80:81], v12 offset:0
v_mfma_f32_16x16x32_bf16 v[236:239], a[36:39], a[88:91], v[236:239]
ds_read_b64_tr_b16 a[82:83], v12 offset:1024
v_mfma_f32_16x16x32_bf16 v[236:239], a[52:55], a[92:95], v[236:239]
ds_read_b64_tr_b16 a[84:85], v12 offset:8192
v_mfma_f32_16x16x32_bf16 v[232:235], a[48:51], a[92:95], v[232:235]
ds_read_b64_tr_b16 a[86:87], v12 offset:9216
v_mfma_f32_16x16x32_bf16 v[232:235], a[32:35], a[88:91], v[232:235]
s_waitcnt lgkmcnt(4)
v_mfma_f32_16x16x32_bf16 v[248:251], a[32:35], a[96:99], v[248:251]
ds_read_b64_tr_b16 a[88:89], v13 offset:0
s_add_u32 m0, s17, 0x4000
v_mfma_f32_16x16x32_bf16 v[248:251], a[48:51], a[100:103], v[248:251]
buffer_load_dwordx4 v5, s[60:63], 0 offen lds
v_mfma_f32_16x16x32_bf16 v[252:255], a[52:55], a[100:103], v[252:255]
ds_read_b64_tr_b16 a[90:91], v13 offset:1024
L_padA2:
s_cmp_eq_u32 s95, 1
s_cbranch_scc1 L_padA6
v_mfma_f32_16x16x32_bf16 v[252:255], a[36:39], a[96:99], v[252:255]
ds_read_b64_tr_b16 a[92:93], v13 offset:8192
v_mfma_f32_16x16x32_bf16 a[232:235], a[40:43], a[96:99], a[232:235]
ds_read_b64_tr_b16 a[94:95], v13 offset:9216
v_mfma_f32_16x16x32_bf16 a[232:235], a[56:59], a[100:103], a[232:235]
v_mfma_f32_16x16x32_bf16 a[236:239], a[60:63], a[100:103], a[236:239]
v_mfma_f32_16x16x32_bf16 a[236:239], a[44:47], a[96:99], a[236:239]
s_add_u32 m0, s17, 0x400
v_mfma_f32_16x16x32_bf16 a[252:255], a[44:47], a[104:107], a[252:255]
buffer_load_dwordx4 v5, s[56:59], s13 offen lds
v_mfma_f32_16x16x32_bf16 a[252:255], a[60:63], a[108:111], a[252:255]
ds_read_b64_tr_b16 a[96:97], v12 offset:256
v_mfma_f32_16x16x32_bf16 a[248:251], a[56:59], a[108:111], a[248:251]
ds_read_b64_tr_b16 a[98:99], v12 offset:1280
v_mfma_f32_16x16x32_bf16 a[248:251], a[40:43], a[104:107], a[248:251]
ds_read_b64_tr_b16 a[100:101], v12 offset:8448
v_mfma_f32_16x16x32_bf16 a[244:247], a[36:39], a[104:107], a[244:247]
ds_read_b64_tr_b16 a[102:103], v12 offset:9472
v_mfma_f32_16x16x32_bf16 a[244:247], a[52:55], a[108:111], a[244:247]
v_mfma_f32_16x16x32_bf16 a[240:243], a[48:51], a[108:111], a[240:243]
s_add_u32 m0, s17, 0x4400
s_waitcnt lgkmcnt(4)
v_mfma_f32_16x16x32_bf16 a[240:243], a[32:35], a[104:107], a[240:243]
buffer_load_dwordx4 v5, s[60:63], s13 offen lds
L_S4:
v_mfma_f32_16x16x32_bf16 v[24:27], a[80:83], a[0:3], v[24:27]
ds_read_b64_tr_b16 a[104:105], v13 offset:256
s_waitcnt vmcnt(23)
v_mfma_f32_16x16x32_bf16 v[24:27], a[84:87], a[16:19], v[24:27]
ds_read_b64_tr_b16 a[106:107], v13 offset:1280
v_mfma_f32_16x16x32_bf16 v[32:35], a[84:87], a[20:23], v[32:35]
ds_read_b64_tr_b16 a[108:109], v13 offset:8448
v_mfma_f32_16x16x32_bf16 v[32:35], a[80:83], a[4:7], v[32:35]
ds_read_b64_tr_b16 a[110:111], v13 offset:9472
v_mfma_f32_16x16x32_bf16 v[40:43], a[80:83], a[8:11], v[40:43]
ds_read_b128 a[32:35], v8 offset:32768
v_mfma_f32_16x16x32_bf16 v[40:43], a[84:87], a[24:27], v[40:43]
ds_read_b128 a[48:51], v9 offset:32768
s_add_u32 m0, s17, 0x800
v_mfma_f32_16x16x32_bf16 v[48:51], a[84:87], a[28:31], v[48:51]
buffer_load_dwordx4 v6, s[56:59], 0 offen lds
v_mfma_f32_16x16x32_bf16 v[48:51], a[80:83], a[12:15], v[48:51]
ds_read_b128 a[36:39], v8 offset:34816
v_mfma_f32_16x16x32_bf16 v[52:55], a[88:91], a[12:15], v[52:55]
ds_read_b64_tr_b16 a[80:81], v12 offset:512
v_mfma_f32_16x16x32_bf16 v[52:55], a[92:95], a[28:31], v[52:55]
ds_read_b64_tr_b16 a[82:83], v12 offset:1536
v_mfma_f32_16x16x32_bf16 v[44:47], a[92:95], a[24:27], v[44:47]
ds_read_b64_tr_b16 a[84:85], v12 offset:8704
v_mfma_f32_16x16x32_bf16 v[44:47], a[88:91], a[8:11], v[44:47]
ds_read_b64_tr_b16 a[86:87], v12 offset:9728
v_mfma_f32_16x16x32_bf16 v[36:39], a[88:91], a[4:7], v[36:39]
ds_read_b128 a[52:55], v9 offset:34816
s_add_u32 m0, s17, 0x4800
v_mfma_f32_16x16x32_bf16 v[36:39], a[92:95], a[20:23], v[36:39]
buffer_load_dwordx4 v6, s[60:63], 0 offen lds
v_mfma_f32_16x16x32_bf16 v[28:31], a[92:95], a[16:19], v[28:31]
ds_read_b128 a[40:43], v8 offset:36864
v_mfma_f32_16x16x32_bf16 v[28:31], a[88:91], a[0:3], v[28:31]
ds_read_b128 a[56:59], v9 offset:36864
s_waitcnt lgkmcnt(10)
v_mfma_f32_16x16x32_bf16 v[56:59], a[96:99], a[0:3], v[56:59]
ds_read_b64_tr_b16 a[88:89], v13 offset:512
v_mfma_f32_16x16x32_bf16 v[56:59], a[100:103], a[16:19], v[56:59]
ds_read_b64_tr_b16 a[90:91], v13 offset:1536
v_mfma_f32_16x16x32_bf16 v[64:67], a[100:103], a[20:23], v[64:67]
ds_read_b64_tr_b16 a[92:93], v13 offset:8704
v_mfma_f32_16x16x32_bf16 v[64:67], a[96:99], a[4:7], v[64:67]
ds_read_b64_tr_b16 a[94:95], v13 offset:9728
s_add_u32 m0, s17, 0xc00
v_mfma_f32_16x16x32_bf16 v[72:75], a[96:99], a[8:11], v[72:75]
buffer_load_dwordx4 v6, s[56:59], s13 offen lds
v_mfma_f32_16x16x32_bf16 v[72:75], a[100:103], a[24:27], v[72:75]
ds_read_b128 a[44:47], v8 offset:38912
v_mfma_f32_16x16x32_bf16 v[80:83], a[100:103], a[28:31], v[80:83]
ds_read_b128 a[60:63], v9 offset:38912
v_mfma_f32_16x16x32_bf16 v[80:83], a[96:99], a[12:15], v[80:83]
v_mfma_f32_16x16x32_bf16 v[84:87], a[104:107], a[12:15], v[84:87]
ds_read_b64_tr_b16 a[96:97], v12 offset:768
v_mfma_f32_16x16x32_bf16 v[84:87], a[108:111], a[28:31], v[84:87]
ds_read_b64_tr_b16 a[98:99], v12 offset:1792
v_mfma_f32_16x16x32_bf16 v[76:79], a[108:111], a[24:27], v[76:79]
ds_read_b64_tr_b16 a[100:101], v12 offset:8960
s_add_u32 m0, s17, 0x4c00
v_mfma_f32_16x16x32_bf16 v[76:79], a[104:107], a[8:11], v[76:79]
buffer_load_dwordx4 v6, s[60:63], s13 offen lds
v_mfma_f32_16x16x32_bf16 v[68:71], a[104:107], a[4:7], v[68:71]
ds_read_b64_tr_b16 a[102:103], v12 offset:9984
v_lshl_add_u32 v5, s42, 19, v5
v_mfma_f32_16x16x32_bf16 v[68:71], a[108:111], a[20:23], v[68:71]
v_lshl_add_u32 v6, s42, 19, v6
v_mfma_f32_16x16x32_bf16 v[60:63], a[108:111], a[16:19], v[60:63]
v_mfma_f32_16x16x32_bf16 v[60:63], a[104:107], a[0:3], v[60:63]
s_waitcnt lgkmcnt(6)
v_mfma_f32_16x16x32_bf16 v[88:91], a[80:83], a[0:3], v[88:91]
ds_read_b64_tr_b16 a[104:105], v13 offset:768
v_mfma_f32_16x16x32_bf16 v[88:91], a[84:87], a[16:19], v[88:91]
ds_read_b64_tr_b16 a[106:107], v13 offset:1792
s_mov_b32 s9, 0x0
v_mfma_f32_16x16x32_bf16 v[96:99], a[84:87], a[20:23], v[96:99]
buffer_load_dword a120, v1, s[68:71], s9 offen
v_mfma_f32_16x16x32_bf16 v[96:99], a[80:83], a[4:7], v[96:99]
ds_read_b64_tr_b16 a[108:109], v13 offset:8960
v_mfma_f32_16x16x32_bf16 v[104:107], a[80:83], a[8:11], v[104:107]
ds_read_b64_tr_b16 a[110:111], v13 offset:9984
v_mfma_f32_16x16x32_bf16 v[104:107], a[84:87], a[24:27], v[104:107]
v_mfma_f32_16x16x32_bf16 v[112:115], a[84:87], a[28:31], v[112:115]
v_mfma_f32_16x16x32_bf16 v[112:115], a[80:83], a[12:15], v[112:115]
s_waitcnt lgkmcnt(8)
v_mfma_f32_16x16x32_bf16 v[116:119], a[88:91], a[12:15], v[116:119]
ds_read_b64_tr_b16 a[80:81], v12 offset:16384
s_add_u32 m0, s16, 0x8000
v_mfma_f32_16x16x32_bf16 v[116:119], a[92:95], a[28:31], v[116:119]
buffer_load_dwordx4 v2, s[48:51], 0 offen lds
v_mfma_f32_16x16x32_bf16 v[108:111], a[92:95], a[24:27], v[108:111]
ds_read_b64_tr_b16 a[82:83], v12 offset:17408
v_mfma_f32_16x16x32_bf16 v[108:111], a[88:91], a[8:11], v[108:111]
ds_read_b64_tr_b16 a[84:85], v12 offset:24576
v_mfma_f32_16x16x32_bf16 v[100:103], a[88:91], a[4:7], v[100:103]
ds_read_b64_tr_b16 a[86:87], v12 offset:25600
v_mfma_f32_16x16x32_bf16 v[100:103], a[92:95], a[20:23], v[100:103]
v_mfma_f32_16x16x32_bf16 v[92:95], a[92:95], a[16:19], v[92:95]
v_mfma_f32_16x16x32_bf16 v[92:95], a[88:91], a[0:3], v[92:95]
s_add_u32 m0, s16, 0x8400
s_waitcnt lgkmcnt(4)
v_mfma_f32_16x16x32_bf16 v[120:123], a[96:99], a[0:3], v[120:123]
buffer_load_dwordx4 v3, s[48:51], 0 offen lds
v_mfma_f32_16x16x32_bf16 v[120:123], a[100:103], a[16:19], v[120:123]
ds_read_b64_tr_b16 a[88:89], v13 offset:16384
v_mfma_f32_16x16x32_bf16 v[128:131], a[100:103], a[20:23], v[128:131]
ds_read_b64_tr_b16 a[90:91], v13 offset:17408
v_mfma_f32_16x16x32_bf16 v[128:131], a[96:99], a[4:7], v[128:131]
ds_read_b64_tr_b16 a[92:93], v13 offset:24576
v_mfma_f32_16x16x32_bf16 v[136:139], a[96:99], a[8:11], v[136:139]
ds_read_b64_tr_b16 a[94:95], v13 offset:25600
v_mfma_f32_16x16x32_bf16 v[136:139], a[100:103], a[24:27], v[136:139]
v_mfma_f32_16x16x32_bf16 v[144:147], a[100:103], a[28:31], v[144:147]
s_add_u32 m0, s16, 0x8800
v_mfma_f32_16x16x32_bf16 v[144:147], a[96:99], a[12:15], v[144:147]
buffer_load_dwordx4 v2, s[48:51], s12 offen lds
v_mfma_f32_16x16x32_bf16 v[148:151], a[104:107], a[12:15], v[148:151]
ds_read_b64_tr_b16 a[96:97], v12 offset:16640
v_mfma_f32_16x16x32_bf16 v[148:151], a[108:111], a[28:31], v[148:151]
ds_read_b64_tr_b16 a[98:99], v12 offset:17664
v_mfma_f32_16x16x32_bf16 v[140:143], a[108:111], a[24:27], v[140:143]
ds_read_b64_tr_b16 a[100:101], v12 offset:24832
v_mfma_f32_16x16x32_bf16 v[140:143], a[104:107], a[8:11], v[140:143]
ds_read_b64_tr_b16 a[102:103], v12 offset:25856
v_mfma_f32_16x16x32_bf16 v[132:135], a[104:107], a[4:7], v[132:135]
v_mfma_f32_16x16x32_bf16 v[132:135], a[108:111], a[20:23], v[132:135]
s_add_u32 m0, s16, 0x8c00
v_mfma_f32_16x16x32_bf16 v[124:127], a[108:111], a[16:19], v[124:127]
buffer_load_dwordx4 v3, s[48:51], s12 offen lds
v_mfma_f32_16x16x32_bf16 v[124:127], a[104:107], a[0:3], v[124:127]
s_waitcnt lgkmcnt(4)
v_mfma_f32_16x16x32_bf16 v[152:155], a[0:3], a[80:83], v[152:155]
ds_read_b64_tr_b16 a[104:105], v13 offset:16640
v_mfma_f32_16x16x32_bf16 v[152:155], a[16:19], a[84:87], v[152:155]
ds_read_b64_tr_b16 a[106:107], v13 offset:17664
v_mfma_f32_16x16x32_bf16 v[156:159], a[20:23], a[84:87], v[156:159]
ds_read_b64_tr_b16 a[108:109], v13 offset:24832
v_mfma_f32_16x16x32_bf16 v[156:159], a[4:7], a[80:83], v[156:159]
ds_read_b64_tr_b16 a[110:111], v13 offset:25856
v_mfma_f32_16x16x32_bf16 v[160:163], a[8:11], a[80:83], v[160:163]
s_add_u32 m0, s16, 0x9000
v_mfma_f32_16x16x32_bf16 v[160:163], a[24:27], a[84:87], v[160:163]
buffer_load_dwordx4 v2, s[48:51], s13 offen lds
v_mfma_f32_16x16x32_bf16 v[164:167], a[28:31], a[84:87], v[164:167]
v_mfma_f32_16x16x32_bf16 v[164:167], a[12:15], a[80:83], v[164:167]
v_mfma_f32_16x16x32_bf16 v[180:183], a[12:15], a[88:91], v[180:183]
ds_read_b64_tr_b16 a[80:81], v12 offset:16896
v_mfma_f32_16x16x32_bf16 v[180:183], a[28:31], a[92:95], v[180:183]
ds_read_b64_tr_b16 a[82:83], v12 offset:17920
v_mfma_f32_16x16x32_bf16 v[176:179], a[24:27], a[92:95], v[176:179]
ds_read_b64_tr_b16 a[84:85], v12 offset:25088
v_mfma_f32_16x16x32_bf16 v[176:179], a[8:11], a[88:91], v[176:179]
ds_read_b64_tr_b16 a[86:87], v12 offset:26112
s_add_u32 m0, s16, 0x9400
v_mfma_f32_16x16x32_bf16 v[172:175], a[4:7], a[88:91], v[172:175]
buffer_load_dwordx4 v3, s[48:51], s13 offen lds
v_mfma_f32_16x16x32_bf16 v[172:175], a[20:23], a[92:95], v[172:175]
v_mfma_f32_16x16x32_bf16 v[168:171], a[16:19], a[92:95], v[168:171]
v_mfma_f32_16x16x32_bf16 v[168:171], a[0:3], a[88:91], v[168:171]
s_waitcnt lgkmcnt(4)
v_mfma_f32_16x16x32_bf16 v[184:187], a[0:3], a[96:99], v[184:187]
ds_read_b64_tr_b16 a[88:89], v13 offset:16896
v_mfma_f32_16x16x32_bf16 v[184:187], a[16:19], a[100:103], v[184:187]
ds_read_b64_tr_b16 a[90:91], v13 offset:17920
v_mfma_f32_16x16x32_bf16 v[188:191], a[20:23], a[100:103], v[188:191]
ds_read_b64_tr_b16 a[92:93], v13 offset:25088
s_add_u32 m0, s16, 0x9800
v_mfma_f32_16x16x32_bf16 v[188:191], a[4:7], a[96:99], v[188:191]
buffer_load_dwordx4 v2, s[48:51], s14 offen lds
v_mfma_f32_16x16x32_bf16 v[192:195], a[8:11], a[96:99], v[192:195]
ds_read_b64_tr_b16 a[94:95], v13 offset:26112
v_mfma_f32_16x16x32_bf16 v[192:195], a[24:27], a[100:103], v[192:195]
v_mfma_f32_16x16x32_bf16 v[196:199], a[28:31], a[100:103], v[196:199]
v_mfma_f32_16x16x32_bf16 v[196:199], a[12:15], a[96:99], v[196:199]
v_mfma_f32_16x16x32_bf16 v[212:215], a[12:15], a[104:107], v[212:215]
ds_read_b64_tr_b16 a[96:97], v12 offset:17152
v_mfma_f32_16x16x32_bf16 v[212:215], a[28:31], a[108:111], v[212:215]
ds_read_b64_tr_b16 a[98:99], v12 offset:18176
s_add_u32 m0, s16, 0x9c00
v_mfma_f32_16x16x32_bf16 v[208:211], a[24:27], a[108:111], v[208:211]
buffer_load_dwordx4 v3, s[48:51], s14 offen lds
v_mfma_f32_16x16x32_bf16 v[208:211], a[8:11], a[104:107], v[208:211]
ds_read_b64_tr_b16 a[100:101], v12 offset:25344
s_sub_u32 s42, s43, s41
v_mfma_f32_16x16x32_bf16 v[204:207], a[4:7], a[104:107], v[204:207]
ds_read_b64_tr_b16 a[102:103], v12 offset:26368
s_mov_b32 s41, s43
v_mfma_f32_16x16x32_bf16 v[204:207], a[20:23], a[108:111], v[204:207]
v_mfma_f32_16x16x32_bf16 v[200:203], a[16:19], a[108:111], v[200:203]
v_mfma_f32_16x16x32_bf16 v[200:203], a[0:3], a[104:107], v[200:203]
s_waitcnt lgkmcnt(4)
v_mfma_f32_16x16x32_bf16 v[216:219], a[0:3], a[80:83], v[216:219]
ds_read_b64_tr_b16 a[104:105], v13 offset:17152
s_mov_b32 s9, 0x800
v_mfma_f32_16x16x32_bf16 v[216:219], a[16:19], a[84:87], v[216:219]
buffer_load_dword a120, v1, s[68:71], s9 offen
v_mfma_f32_16x16x32_bf16 v[220:223], a[20:23], a[84:87], v[220:223]
ds_read_b64_tr_b16 a[106:107], v13 offset:18176
v_mfma_f32_16x16x32_bf16 v[220:223], a[4:7], a[80:83], v[220:223]
ds_read_b64_tr_b16 a[108:109], v13 offset:25344
v_mfma_f32_16x16x32_bf16 v[224:227], a[8:11], a[80:83], v[224:227]
ds_read_b64_tr_b16 a[110:111], v13 offset:26368
v_add_u32 v12, 0x8000, v12
v_mfma_f32_16x16x32_bf16 v[224:227], a[24:27], a[84:87], v[224:227]
v_add_u32 v13, 0x8000, v13
v_mfma_f32_16x16x32_bf16 v[228:231], a[28:31], a[84:87], v[228:231]
v_mfma_f32_16x16x32_bf16 v[228:231], a[12:15], a[80:83], v[228:231]
v_mfma_f32_16x16x32_bf16 v[244:247], a[12:15], a[88:91], v[244:247]
s_waitcnt vmcnt(28) lgkmcnt(0)
v_mfma_f32_16x16x32_bf16 v[244:247], a[28:31], a[92:95], v[244:247]
s_barrier
s_add_u32 m0, s17, 0x8000
v_mfma_f32_16x16x32_bf16 v[240:243], a[24:27], a[92:95], v[240:243]
buffer_load_dwordx4 v5, s[56:59], 0 offen lds
v_mfma_f32_16x16x32_bf16 v[240:243], a[8:11], a[88:91], v[240:243]
ds_read_b64_tr_b16 a[80:81], v12 offset:0
v_mfma_f32_16x16x32_bf16 v[236:239], a[4:7], a[88:91], v[236:239]
ds_read_b64_tr_b16 a[82:83], v12 offset:1024
v_mfma_f32_16x16x32_bf16 v[236:239], a[20:23], a[92:95], v[236:239]
ds_read_b64_tr_b16 a[84:85], v12 offset:8192
v_mfma_f32_16x16x32_bf16 v[232:235], a[16:19], a[92:95], v[232:235]
ds_read_b64_tr_b16 a[86:87], v12 offset:9216
v_mfma_f32_16x16x32_bf16 v[232:235], a[0:3], a[88:91], v[232:235]
s_waitcnt lgkmcnt(4)
v_mfma_f32_16x16x32_bf16 v[248:251], a[0:3], a[96:99], v[248:251]
ds_read_b64_tr_b16 a[88:89], v13 offset:0
s_add_u32 m0, s17, 0xc000
v_mfma_f32_16x16x32_bf16 v[248:251], a[16:19], a[100:103], v[248:251]
buffer_load_dwordx4 v5, s[60:63], 0 offen lds
v_mfma_f32_16x16x32_bf16 v[252:255], a[20:23], a[100:103], v[252:255]
ds_read_b64_tr_b16 a[90:91], v13 offset:1024
v_mfma_f32_16x16x32_bf16 v[252:255], a[4:7], a[96:99], v[252:255]
ds_read_b64_tr_b16 a[92:93], v13 offset:8192
v_mfma_f32_16x16x32_bf16 a[232:235], a[8:11], a[96:99], a[232:235]
ds_read_b64_tr_b16 a[94:95], v13 offset:9216
v_mfma_f32_16x16x32_bf16 a[232:235], a[24:27], a[100:103], a[232:235]
v_mfma_f32_16x16x32_bf16 a[236:239], a[28:31], a[100:103], a[236:239]
v_mfma_f32_16x16x32_bf16 a[236:239], a[12:15], a[96:99], a[236:239]
s_add_u32 m0, s17, 0x8400
v_mfma_f32_16x16x32_bf16 a[252:255], a[12:15], a[104:107], a[252:255]
buffer_load_dwordx4 v5, s[56:59], s13 offen lds
v_mfma_f32_16x16x32_bf16 a[252:255], a[28:31], a[108:111], a[252:255]
ds_read_b64_tr_b16 a[96:97], v12 offset:256
v_mfma_f32_16x16x32_bf16 a[248:251], a[24:27], a[108:111], a[248:251]
ds_read_b64_tr_b16 a[98:99], v12 offset:1280
v_mfma_f32_16x16x32_bf16 a[248:251], a[8:11], a[104:107], a[248:251]
ds_read_b64_tr_b16 a[100:101], v12 offset:8448
v_mfma_f32_16x16x32_bf16 a[244:247], a[4:7], a[104:107], a[244:247]
ds_read_b64_tr_b16 a[102:103], v12 offset:9472
v_mfma_f32_16x16x32_bf16 a[244:247], a[20:23], a[108:111], a[244:247]
v_mfma_f32_16x16x32_bf16 a[240:243], a[16:19], a[108:111], a[240:243]
v_mfma_f32_16x16x32_bf16 a[240:243], a[0:3], a[104:107], a[240:243]
s_add_u32 m0, s17, 0xc400
s_waitcnt lgkmcnt(4)
L_S5:
v_mfma_f32_16x16x32_bf16 v[24:27], a[80:83], a[32:35], v[24:27]
buffer_load_dwordx4 v5, s[60:63], s13 offen lds
v_mfma_f32_16x16x32_bf16 v[24:27], a[84:87], a[48:51], v[24:27]
ds_read_b64_tr_b16 a[104:105], v13 offset:256
s_waitcnt vmcnt(23)
v_mfma_f32_16x16x32_bf16 v[32:35], a[84:87], a[52:55], v[32:35]
ds_read_b64_tr_b16 a[106:107], v13 offset:1280
v_mfma_f32_16x16x32_bf16 v[32:35], a[80:83], a[36:39], v[32:35]
ds_read_b64_tr_b16 a[108:109], v13 offset:8448
v_mfma_f32_16x16x32_bf16 v[40:43], a[80:83], a[40:43], v[40:43]
ds_read_b64_tr_b16 a[110:111], v13 offset:9472
v_mfma_f32_16x16x32_bf16 v[40:43], a[84:87], a[56:59], v[40:43]
ds_read_b128 a[0:3], v8 offset:0
v_mfma_f32_16x16x32_bf16 v[48:51], a[84:87], a[60:63], v[48:51]
ds_read_b128 a[16:19], v9 offset:0
s_add_u32 m0, s17, 0x8800
v_mfma_f32_16x16x32_bf16 v[48:51], a[80:83], a[44:47], v[48:51]
buffer_load_dwordx4 v6, s[56:59], 0 offen lds
v_mfma_f32_16x16x32_bf16 v[52:55], a[88:91], a[44:47], v[52:55]
ds_read_b64_tr_b16 a[80:81], v12 offset:512
v_mfma_f32_16x16x32_bf16 v[52:55], a[92:95], a[60:63], v[52:55]
ds_read_b64_tr_b16 a[82:83], v12 offset:1536
v_mfma_f32_16x16x32_bf16 v[44:47], a[92:95], a[56:59], v[44:47]
ds_read_b64_tr_b16 a[84:85], v12 offset:8704
v_mfma_f32_16x16x32_bf16 v[44:47], a[88:91], a[40:43], v[44:47]
ds_read_b64_tr_b16 a[86:87], v12 offset:9728
v_mfma_f32_16x16x32_bf16 v[36:39], a[88:91], a[36:39], v[36:39]
ds_read_b128 a[4:7], v8 offset:2048
v_mfma_f32_16x16x32_bf16 v[36:39], a[92:95], a[52:55], v[36:39]
ds_read_b128 a[20:23], v9 offset:2048
s_waitcnt lgkmcnt(8)
v_mfma_f32_16x16x32_bf16 v[28:31], a[92:95], a[48:51], v[28:31]
ds_read_b128 a[8:11], v8 offset:4096
s_add_u32 m0, s17, 0xc800
v_mfma_f32_16x16x32_bf16 v[28:31], a[88:91], a[32:35], v[28:31]
buffer_load_dwordx4 v6, s[60:63], 0 offen lds
v_mfma_f32_16x16x32_bf16 v[56:59], a[96:99], a[32:35], v[56:59]
ds_read_b64_tr_b16 a[88:89], v13 offset:512
v_mfma_f32_16x16x32_bf16 v[56:59], a[100:103], a[48:51], v[56:59]
ds_read_b64_tr_b16 a[90:91], v13 offset:1536
v_mfma_f32_16x16x32_bf16 v[64:67], a[100:103], a[52:55], v[64:67]
ds_read_b64_tr_b16 a[92:93], v13 offset:8704
v_mfma_f32_16x16x32_bf16 v[64:67], a[96:99], a[36:39], v[64:67]
ds_read_b64_tr_b16 a[94:95], v13 offset:9728
v_mfma_f32_16x16x32_bf16 v[72:75], a[96:99], a[40:43], v[72:75]
ds_read_b128 a[24:27], v9 offset:4096
v_mfma_f32_16x16x32_bf16 v[72:75], a[100:103], a[56:59], v[72:75]
ds_read_b128 a[12:15], v8 offset:6144
s_add_u32 m0, s17, 0x8c00
v_mfma_f32_16x16x32_bf16 v[80:83], a[100:103], a[60:63], v[80:83]
buffer_load_dwordx4 v6, s[56:59], s13 offen lds
v_mfma_f32_16x16x32_bf16 v[80:83], a[96:99], a[44:47], v[80:83]
ds_read_b128 a[28:31], v9 offset:6144
v_mfma_f32_16x16x32_bf16 v[84:87], a[104:107], a[44:47], v[84:87]
ds_read_b64_tr_b16 a[96:97], v12 offset:768
v_mfma_f32_16x16x32_bf16 v[84:87], a[108:111], a[60:63], v[84:87]
ds_read_b64_tr_b16 a[98:99], v12 offset:1792
v_mfma_f32_16x16x32_bf16 v[76:79], a[108:111], a[56:59], v[76:79]
ds_read_b64_tr_b16 a[100:101], v12 offset:8960
v_mfma_f32_16x16x32_bf16 v[76:79], a[104:107], a[40:43], v[76:79]
ds_read_b64_tr_b16 a[102:103], v12 offset:9984
v_mfma_f32_16x16x32_bf16 v[68:71], a[104:107], a[36:39], v[68:71]
s_add_u32 m0, s17, 0xcc00
v_mfma_f32_16x16x32_bf16 v[68:71], a[108:111], a[52:55], v[68:71]
buffer_load_dwordx4 v6, s[60:63], s13 offen lds
v_mfma_f32_16x16x32_bf16 v[60:63], a[108:111], a[48:51], v[60:63]
v_lshl_add_u32 v5, s42, 19, v5
v_lshl_add_u32 v6, s42, 19, v6
v_mfma_f32_16x16x32_bf16 v[60:63], a[104:107], a[32:35], v[60:63]
s_waitcnt lgkmcnt(7)
v_mfma_f32_16x16x32_bf16 v[88:91], a[80:83], a[32:35], v[88:91]
ds_read_b64_tr_b16 a[104:105], v13 offset:768
v_mfma_f32_16x16x32_bf16 v[88:91], a[84:87], a[48:51], v[88:91]
ds_read_b64_tr_b16 a[106:107], v13 offset:1792
v_mfma_f32_16x16x32_bf16 v[96:99], a[84:87], a[52:55], v[96:99]
ds_read_b64_tr_b16 a[108:109], v13 offset:8960
v_mfma_f32_16x16x32_bf16 v[96:99], a[80:83], a[36:39], v[96:99]
ds_read_b64_tr_b16 a[110:111], v13 offset:9984
v_mfma_f32_16x16x32_bf16 v[104:107], a[80:83], a[40:43], v[104:107]
s_add_u32 m0, s16, 0x0
s_waitcnt lgkmcnt(8)
v_mfma_f32_16x16x32_bf16 v[104:107], a[84:87], a[56:59], v[104:107]
buffer_load_dwordx4 v22, s[44:47], s20 offen lds
v_mfma_f32_16x16x32_bf16 v[112:115], a[84:87], a[60:63], v[112:115]
v_mfma_f32_16x16x32_bf16 v[112:115], a[80:83], a[44:47], v[112:115]
v_mfma_f32_16x16x32_bf16 v[116:119], a[88:91], a[44:47], v[116:119]
ds_read_b64_tr_b16 a[80:81], v12 offset:16384
v_mfma_f32_16x16x32_bf16 v[116:119], a[92:95], a[60:63], v[116:119]
ds_read_b64_tr_b16 a[82:83], v12 offset:17408
v_mfma_f32_16x16x32_bf16 v[108:111], a[92:95], a[56:59], v[108:111]
ds_read_b64_tr_b16 a[84:85], v12 offset:24576
v_mfma_f32_16x16x32_bf16 v[108:111], a[88:91], a[40:43], v[108:111]
ds_read_b64_tr_b16 a[86:87], v12 offset:25600
s_add_u32 m0, s16, 0x400
v_mfma_f32_16x16x32_bf16 v[100:103], a[88:91], a[36:39], v[100:103]
buffer_load_dwordx4 v23, s[44:47], s20 offen lds
v_mfma_f32_16x16x32_bf16 v[100:103], a[92:95], a[52:55], v[100:103]
v_mfma_f32_16x16x32_bf16 v[92:95], a[92:95], a[48:51], v[92:95]
v_mfma_f32_16x16x32_bf16 v[92:95], a[88:91], a[32:35], v[92:95]
s_waitcnt lgkmcnt(4)
v_mfma_f32_16x16x32_bf16 v[120:123], a[96:99], a[32:35], v[120:123]
ds_read_b64_tr_b16 a[88:89], v13 offset:16384
v_mfma_f32_16x16x32_bf16 v[120:123], a[100:103], a[48:51], v[120:123]
ds_read_b64_tr_b16 a[90:91], v13 offset:17408
v_mfma_f32_16x16x32_bf16 v[128:131], a[100:103], a[52:55], v[128:131]
ds_read_b64_tr_b16 a[92:93], v13 offset:24576
v_mfma_f32_16x16x32_bf16 v[128:131], a[96:99], a[36:39], v[128:131]
ds_read_b64_tr_b16 a[94:95], v13 offset:25600
s_add_u32 m0, s16, 0x800
v_mfma_f32_16x16x32_bf16 v[136:139], a[96:99], a[40:43], v[136:139]
buffer_load_dwordx4 v22, s[44:47], s21 offen lds
v_mfma_f32_16x16x32_bf16 v[136:139], a[100:103], a[56:59], v[136:139]
v_mfma_f32_16x16x32_bf16 v[144:147], a[100:103], a[60:63], v[144:147]
v_mfma_f32_16x16x32_bf16 v[144:147], a[96:99], a[44:47], v[144:147]
v_mfma_f32_16x16x32_bf16 v[148:151], a[104:107], a[44:47], v[148:151]
ds_read_b64_tr_b16 a[96:97], v12 offset:16640
v_mfma_f32_16x16x32_bf16 v[148:151], a[108:111], a[60:63], v[148:151]
ds_read_b64_tr_b16 a[98:99], v12 offset:17664
v_mfma_f32_16x16x32_bf16 v[140:143], a[108:111], a[56:59], v[140:143]
ds_read_b64_tr_b16 a[100:101], v12 offset:24832
s_add_u32 m0, s16, 0xc00
v_mfma_f32_16x16x32_bf16 v[140:143], a[104:107], a[40:43], v[140:143]
buffer_load_dwordx4 v23, s[44:47], s21 offen lds
v_mfma_f32_16x16x32_bf16 v[132:135], a[104:107], a[36:39], v[132:135]
ds_read_b64_tr_b16 a[102:103], v12 offset:25856
v_mfma_f32_16x16x32_bf16 v[132:135], a[108:111], a[52:55], v[132:135]
v_mfma_f32_16x16x32_bf16 v[124:127], a[108:111], a[48:51], v[124:127]
v_mfma_f32_16x16x32_bf16 v[124:127], a[104:107], a[32:35], v[124:127]
s_waitcnt lgkmcnt(4)
v_mfma_f32_16x16x32_bf16 v[152:155], a[32:35], a[80:83], v[152:155]
ds_read_b64_tr_b16 a[104:105], v13 offset:16640
v_mfma_f32_16x16x32_bf16 v[152:155], a[48:51], a[84:87], v[152:155]
ds_read_b64_tr_b16 a[106:107], v13 offset:17664
s_add_u32 m0, s16, 0x1000
v_mfma_f32_16x16x32_bf16 v[156:159], a[52:55], a[84:87], v[156:159]
buffer_load_dwordx4 v22, s[44:47], s22 offen lds
v_mfma_f32_16x16x32_bf16 v[156:159], a[36:39], a[80:83], v[156:159]
ds_read_b64_tr_b16 a[108:109], v13 offset:24832
v_mfma_f32_16x16x32_bf16 v[160:163], a[40:43], a[80:83], v[160:163]
ds_read_b64_tr_b16 a[110:111], v13 offset:25856
v_mfma_f32_16x16x32_bf16 v[160:163], a[56:59], a[84:87], v[160:163]
v_mfma_f32_16x16x32_bf16 v[164:167], a[60:63], a[84:87], v[164:167]
v_mfma_f32_16x16x32_bf16 v[164:167], a[44:47], a[80:83], v[164:167]
v_mfma_f32_16x16x32_bf16 v[180:183], a[44:47], a[88:91], v[180:183]
ds_read_b64_tr_b16 a[80:81], v12 offset:16896
v_mfma_f32_16x16x32_bf16 v[180:183], a[60:63], a[92:95], v[180:183]
ds_read_b64_tr_b16 a[82:83], v12 offset:17920
s_add_u32 m0, s16, 0x1400
v_mfma_f32_16x16x32_bf16 v[176:179], a[56:59], a[92:95], v[176:179]
buffer_load_dwordx4 v23, s[44:47], s22 offen lds
v_mfma_f32_16x16x32_bf16 v[176:179], a[40:43], a[88:91], v[176:179]
ds_read_b64_tr_b16 a[84:85], v12 offset:25088
v_mfma_f32_16x16x32_bf16 v[172:175], a[36:39], a[88:91], v[172:175]
ds_read_b64_tr_b16 a[86:87], v12 offset:26112
v_mfma_f32_16x16x32_bf16 v[172:175], a[52:55], a[92:95], v[172:175]
v_mfma_f32_16x16x32_bf16 v[168:171], a[48:51], a[92:95], v[168:171]
v_mfma_f32_16x16x32_bf16 v[168:171], a[32:35], a[88:91], v[168:171]
s_waitcnt lgkmcnt(4)
v_mfma_f32_16x16x32_bf16 v[184:187], a[32:35], a[96:99], v[184:187]
ds_read_b64_tr_b16 a[88:89], v13 offset:16896
s_add_u32 m0, s16, 0x1800
v_mfma_f32_16x16x32_bf16 v[184:187], a[48:51], a[100:103], v[184:187]
buffer_load_dwordx4 v22, s[44:47], s23 offen lds
v_mfma_f32_16x16x32_bf16 v[188:191], a[52:55], a[100:103], v[188:191]
ds_read_b64_tr_b16 a[90:91], v13 offset:17920
v_mfma_f32_16x16x32_bf16 v[188:191], a[36:39], a[96:99], v[188:191]
ds_read_b64_tr_b16 a[92:93], v13 offset:25088
v_mfma_f32_16x16x32_bf16 v[192:195], a[40:43], a[96:99], v[192:195]
ds_read_b64_tr_b16 a[94:95], v13 offset:26112
v_mfma_f32_16x16x32_bf16 v[192:195], a[56:59], a[100:103], v[192:195]
v_mfma_f32_16x16x32_bf16 v[196:199], a[60:63], a[100:103], v[196:199]
v_mfma_f32_16x16x32_bf16 v[196:199], a[44:47], a[96:99], v[196:199]
v_mfma_f32_16x16x32_bf16 v[212:215], a[44:47], a[104:107], v[212:215]
ds_read_b64_tr_b16 a[96:97], v12 offset:17152
s_add_u32 m0, s16, 0x1c00
v_mfma_f32_16x16x32_bf16 v[212:215], a[60:63], a[108:111], v[212:215]
buffer_load_dwordx4 v23, s[44:47], s23 offen lds
v_mfma_f32_16x16x32_bf16 v[208:211], a[56:59], a[108:111], v[208:211]
ds_read_b64_tr_b16 a[98:99], v12 offset:18176
s_mov_b32 s42, 1
v_mfma_f32_16x16x32_bf16 v[208:211], a[40:43], a[104:107], v[208:211]
ds_read_b64_tr_b16 a[100:101], v12 offset:25344
v_lshl_add_u32 v22, s42, 7, v22
v_mfma_f32_16x16x32_bf16 v[204:207], a[36:39], a[104:107], v[204:207]
ds_read_b64_tr_b16 a[102:103], v12 offset:26368
v_lshl_add_u32 v23, s42, 7, v23
v_mfma_f32_16x16x32_bf16 v[204:207], a[52:55], a[108:111], v[204:207]
v_mfma_f32_16x16x32_bf16 v[200:203], a[48:51], a[108:111], v[200:203]
v_mfma_f32_16x16x32_bf16 v[200:203], a[32:35], a[104:107], v[200:203]
s_mov_b32 s9, 0x1000
s_waitcnt lgkmcnt(4)
v_mfma_f32_16x16x32_bf16 v[216:219], a[32:35], a[80:83], v[216:219]
buffer_load_dword a120, v1, s[68:71], s9 offen
v_mfma_f32_16x16x32_bf16 v[216:219], a[48:51], a[84:87], v[216:219]
ds_read_b64_tr_b16 a[104:105], v13 offset:17152
v_mfma_f32_16x16x32_bf16 v[220:223], a[52:55], a[84:87], v[220:223]
ds_read_b64_tr_b16 a[106:107], v13 offset:18176
v_mfma_f32_16x16x32_bf16 v[220:223], a[36:39], a[80:83], v[220:223]
ds_read_b64_tr_b16 a[108:109], v13 offset:25344
v_mfma_f32_16x16x32_bf16 v[224:227], a[40:43], a[80:83], v[224:227]
ds_read_b64_tr_b16 a[110:111], v13 offset:26368
v_add_u32 v12, 0xffff0000, v12
v_mfma_f32_16x16x32_bf16 v[224:227], a[56:59], a[84:87], v[224:227]
v_add_u32 v13, 0xffff0000, v13
v_mfma_f32_16x16x32_bf16 v[228:231], a[60:63], a[84:87], v[228:231]
v_mfma_f32_16x16x32_bf16 v[228:231], a[44:47], a[80:83], v[228:231]
v_mfma_f32_16x16x32_bf16 v[244:247], a[44:47], a[88:91], v[244:247]
s_waitcnt vmcnt(27) lgkmcnt(0)
v_mfma_f32_16x16x32_bf16 v[244:247], a[60:63], a[92:95], v[244:247]
s_barrier
s_add_u32 m0, s17, 0x10000
v_mfma_f32_16x16x32_bf16 v[240:243], a[56:59], a[92:95], v[240:243]
buffer_load_dwordx4 v5, s[52:55], 0 offen lds
v_mfma_f32_16x16x32_bf16 v[240:243], a[40:43], a[88:91], v[240:243]
ds_read_b64_tr_b16 a[80:81], v12 offset:0
s_mul_i32 s28, s5, 0x10c400
v_mfma_f32_16x16x32_bf16 v[236:239], a[36:39], a[88:91], v[236:239]
ds_read_b64_tr_b16 a[82:83], v12 offset:1024
s_mov_b32 s48, s88
v_mfma_f32_16x16x32_bf16 v[236:239], a[52:55], a[92:95], v[236:239]
ds_read_b64_tr_b16 a[84:85], v12 offset:8192
s_mov_b32 s49, s89
v_mfma_f32_16x16x32_bf16 v[232:235], a[48:51], a[92:95], v[232:235]
ds_read_b64_tr_b16 a[86:87], v12 offset:9216
s_sub_u32 s11, 16, s6
v_mfma_f32_16x16x32_bf16 v[232:235], a[32:35], a[88:91], v[232:235]
s_waitcnt lgkmcnt(4)
s_lshl_b32 s11, s11, 16
s_add_u32 s11, s11, s28
v_mfma_f32_16x16x32_bf16 v[248:251], a[32:35], a[96:99], v[248:251]
ds_read_b64_tr_b16 a[88:89], v13 offset:0
s_add_u32 m0, s17, 0x10400
v_mfma_f32_16x16x32_bf16 v[248:251], a[48:51], a[100:103], v[248:251]
buffer_load_dwordx4 v5, s[52:55], s13 offen lds
v_mfma_f32_16x16x32_bf16 v[252:255], a[52:55], a[100:103], v[252:255]
ds_read_b64_tr_b16 a[90:91], v13 offset:1024
s_add_u32 s50, s11, 0x2000
v_mfma_f32_16x16x32_bf16 v[252:255], a[36:39], a[96:99], v[252:255]
ds_read_b64_tr_b16 a[92:93], v13 offset:8192
s_lshl_b32 s11, s6, 17
v_mfma_f32_16x16x32_bf16 a[232:235], a[40:43], a[96:99], a[232:235]
ds_read_b64_tr_b16 a[94:95], v13 offset:9216
s_add_u32 s28, s28, s11
v_mfma_f32_16x16x32_bf16 a[232:235], a[56:59], a[100:103], a[232:235]
s_lshl_b32 s11, s4, 15
s_add_u32 s28, s28, s11
s_lshl_b32 s10, s5, 2
v_mfma_f32_16x16x32_bf16 a[236:239], a[60:63], a[100:103], a[236:239]
s_add_u32 s10, s10, 64
v_mfma_f32_16x16x32_bf16 a[236:239], a[44:47], a[96:99], a[236:239]
L_padA3:
s_cmp_eq_u32 s95, 1
s_cbranch_scc1 L_padA7
s_add_u32 m0, s17, 0x10800
v_mfma_f32_16x16x32_bf16 a[252:255], a[44:47], a[104:107], a[252:255]
buffer_load_dwordx4 v6, s[52:55], 0 offen lds
v_mfma_f32_16x16x32_bf16 a[252:255], a[60:63], a[108:111], a[252:255]
ds_read_b64_tr_b16 a[96:97], v12 offset:256
v_mfma_f32_16x16x32_bf16 a[248:251], a[56:59], a[108:111], a[248:251]
ds_read_b64_tr_b16 a[98:99], v12 offset:1280
v_mfma_f32_16x16x32_bf16 a[248:251], a[40:43], a[104:107], a[248:251]
ds_read_b64_tr_b16 a[100:101], v12 offset:8448
v_mfma_f32_16x16x32_bf16 a[244:247], a[36:39], a[104:107], a[244:247]
ds_read_b64_tr_b16 a[102:103], v12 offset:9472
v_mfma_f32_16x16x32_bf16 a[244:247], a[52:55], a[108:111], a[244:247]
v_mfma_f32_16x16x32_bf16 a[240:243], a[48:51], a[108:111], a[240:243]
v_mfma_f32_16x16x32_bf16 a[240:243], a[32:35], a[104:107], a[240:243]
s_add_u32 m0, s17, 0x10c00
s_waitcnt lgkmcnt(4)
L_S6:
v_mfma_f32_16x16x32_bf16 v[24:27], a[80:83], a[0:3], v[24:27]
buffer_load_dwordx4 v6, s[52:55], s13 offen lds
v_mfma_f32_16x16x32_bf16 v[24:27], a[84:87], a[16:19], v[24:27]
ds_read_b64_tr_b16 a[104:105], v13 offset:256
s_waitcnt vmcnt(22)
v_mfma_f32_16x16x32_bf16 v[32:35], a[84:87], a[20:23], v[32:35]
ds_read_b64_tr_b16 a[106:107], v13 offset:1280
v_mfma_f32_16x16x32_bf16 v[32:35], a[80:83], a[4:7], v[32:35]
ds_read_b64_tr_b16 a[108:109], v13 offset:8448
v_mfma_f32_16x16x32_bf16 v[40:43], a[80:83], a[8:11], v[40:43]
ds_read_b64_tr_b16 a[110:111], v13 offset:9472
v_mfma_f32_16x16x32_bf16 v[40:43], a[84:87], a[24:27], v[40:43]
ds_read_b128 a[32:35], v8 offset:32768
v_mfma_f32_16x16x32_bf16 v[48:51], a[84:87], a[28:31], v[48:51]
ds_read_b128 a[48:51], v9 offset:32768
s_add_u32 m0, s18, 0x14000
v_mfma_f32_16x16x32_bf16 v[48:51], a[80:83], a[12:15], v[48:51]
buffer_load_dwordx4 v7, s[68:71], 0 offen lds
v_mfma_f32_16x16x32_bf16 v[52:55], a[88:91], a[12:15], v[52:55]
ds_read_b64_tr_b16 a[80:81], v12 offset:512
v_mfma_f32_16x16x32_bf16 v[52:55], a[92:95], a[28:31], v[52:55]
ds_read_b64_tr_b16 a[82:83], v12 offset:1536
v_mfma_f32_16x16x32_bf16 v[44:47], a[92:95], a[24:27], v[44:47]
ds_read_b64_tr_b16 a[84:85], v12 offset:8704
v_mfma_f32_16x16x32_bf16 v[44:47], a[88:91], a[8:11], v[44:47]
ds_read_b64_tr_b16 a[86:87], v12 offset:9728
v_mfma_f32_16x16x32_bf16 v[36:39], a[88:91], a[4:7], v[36:39]
ds_read_b128 a[36:39], v8 offset:34816
v_mfma_f32_16x16x32_bf16 v[36:39], a[92:95], a[20:23], v[36:39]
ds_read_b128 a[52:55], v9 offset:34816
s_waitcnt lgkmcnt(8)
v_mfma_f32_16x16x32_bf16 v[28:31], a[92:95], a[16:19], v[28:31]
ds_read_b128 a[40:43], v8 offset:36864
s_add_u32 m0, s18, 0x15000
v_mfma_f32_16x16x32_bf16 v[28:31], a[88:91], a[0:3], v[28:31]
buffer_load_dwordx4 v7, s[68:71], s25 offen lds
v_mfma_f32_16x16x32_bf16 v[56:59], a[96:99], a[0:3], v[56:59]
ds_read_b64_tr_b16 a[88:89], v13 offset:512
v_mfma_f32_16x16x32_bf16 v[56:59], a[100:103], a[16:19], v[56:59]
ds_read_b64_tr_b16 a[90:91], v13 offset:1536
v_mfma_f32_16x16x32_bf16 v[64:67], a[100:103], a[20:23], v[64:67]
ds_read_b64_tr_b16 a[92:93], v13 offset:8704
v_mfma_f32_16x16x32_bf16 v[64:67], a[96:99], a[4:7], v[64:67]
ds_read_b64_tr_b16 a[94:95], v13 offset:9728
v_mfma_f32_16x16x32_bf16 v[72:75], a[96:99], a[8:11], v[72:75]
ds_read_b128 a[56:59], v9 offset:36864
v_mfma_f32_16x16x32_bf16 v[72:75], a[100:103], a[24:27], v[72:75]
ds_read_b128 a[44:47], v8 offset:38912
s_add_u32 m0, s18, 0x16000
v_mfma_f32_16x16x32_bf16 v[80:83], a[100:103], a[28:31], v[80:83]
buffer_load_dwordx4 v7, s[68:71], s26 offen lds
v_mfma_f32_16x16x32_bf16 v[80:83], a[96:99], a[12:15], v[80:83]
ds_read_b128 a[60:63], v9 offset:38912
v_lshl_add_u32 v5, s42, 19, v5
v_mfma_f32_16x16x32_bf16 v[84:87], a[104:107], a[12:15], v[84:87]
ds_read_b64_tr_b16 a[96:97], v12 offset:768
v_lshl_add_u32 v6, s42, 19, v6
v_mfma_f32_16x16x32_bf16 v[84:87], a[108:111], a[28:31], v[84:87]
ds_read_b64_tr_b16 a[98:99], v12 offset:1792
v_lshl_add_u32 v7, s42, 18, v7
v_mfma_f32_16x16x32_bf16 v[76:79], a[108:111], a[24:27], v[76:79]
ds_read_b64_tr_b16 a[100:101], v12 offset:8960
v_lshl_add_u32 v7, s42, 17, v7
v_mfma_f32_16x16x32_bf16 v[76:79], a[104:107], a[8:11], v[76:79]
ds_read_b64_tr_b16 a[102:103], v12 offset:9984
v_mfma_f32_16x16x32_bf16 v[68:71], a[104:107], a[4:7], v[68:71]
v_mfma_f32_16x16x32_bf16 v[68:71], a[108:111], a[20:23], v[68:71]
buffer_store_dwordx4 a[64:67], v4, s[88:91], 0 offen sc1
v_mfma_f32_16x16x32_bf16 v[60:63], a[108:111], a[16:19], v[60:63]
v_mfma_f32_16x16x32_bf16 v[60:63], a[104:107], a[0:3], v[60:63]
s_waitcnt lgkmcnt(7)
v_mfma_f32_16x16x32_bf16 v[88:91], a[80:83], a[0:3], v[88:91]
ds_read_b64_tr_b16 a[104:105], v13 offset:768
v_mfma_f32_16x16x32_bf16 v[88:91], a[84:87], a[16:19], v[88:91]
ds_read_b64_tr_b16 a[106:107], v13 offset:1792
v_mfma_f32_16x16x32_bf16 v[96:99], a[84:87], a[20:23], v[96:99]
ds_read_b64_tr_b16 a[108:109], v13 offset:8960
v_mfma_f32_16x16x32_bf16 v[96:99], a[80:83], a[4:7], v[96:99]
ds_read_b64_tr_b16 a[110:111], v13 offset:9984
v_mfma_f32_16x16x32_bf16 v[104:107], a[80:83], a[8:11], v[104:107]
s_add_u32 m0, s16, 0x8000
s_waitcnt lgkmcnt(8)
v_mfma_f32_16x16x32_bf16 v[104:107], a[84:87], a[24:27], v[104:107]
buffer_load_dwordx4 v22, s[44:47], s20 offen lds
v_mfma_f32_16x16x32_bf16 v[112:115], a[84:87], a[28:31], v[112:115]
v_mfma_f32_16x16x32_bf16 v[112:115], a[80:83], a[12:15], v[112:115]
v_mfma_f32_16x16x32_bf16 v[116:119], a[88:91], a[12:15], v[116:119]
ds_read_b64_tr_b16 a[80:81], v12 offset:16384
v_mfma_f32_16x16x32_bf16 v[116:119], a[92:95], a[28:31], v[116:119]
ds_read_b64_tr_b16 a[82:83], v12 offset:17408
v_mfma_f32_16x16x32_bf16 v[108:111], a[92:95], a[24:27], v[108:111]
ds_read_b64_tr_b16 a[84:85], v12 offset:24576
v_mfma_f32_16x16x32_bf16 v[108:111], a[88:91], a[8:11], v[108:111]
ds_read_b64_tr_b16 a[86:87], v12 offset:25600
s_add_u32 m0, s16, 0x8400
v_mfma_f32_16x16x32_bf16 v[100:103], a[88:91], a[4:7], v[100:103]
buffer_load_dwordx4 v23, s[44:47], s20 offen lds
v_mfma_f32_16x16x32_bf16 v[100:103], a[92:95], a[20:23], v[100:103]
v_mfma_f32_16x16x32_bf16 v[92:95], a[92:95], a[16:19], v[92:95]
v_mfma_f32_16x16x32_bf16 v[92:95], a[88:91], a[0:3], v[92:95]
s_waitcnt lgkmcnt(4)
v_mfma_f32_16x16x32_bf16 v[120:123], a[96:99], a[0:3], v[120:123]
ds_read_b64_tr_b16 a[88:89], v13 offset:16384
v_mfma_f32_16x16x32_bf16 v[120:123], a[100:103], a[16:19], v[120:123]
ds_read_b64_tr_b16 a[90:91], v13 offset:17408
v_mfma_f32_16x16x32_bf16 v[128:131], a[100:103], a[20:23], v[128:131]
ds_read_b64_tr_b16 a[92:93], v13 offset:24576
v_mfma_f32_16x16x32_bf16 v[128:131], a[96:99], a[4:7], v[128:131]
ds_read_b64_tr_b16 a[94:95], v13 offset:25600
s_add_u32 m0, s16, 0x8800
v_mfma_f32_16x16x32_bf16 v[136:139], a[96:99], a[8:11], v[136:139]
buffer_load_dwordx4 v22, s[44:47], s21 offen lds
v_mfma_f32_16x16x32_bf16 v[136:139], a[100:103], a[24:27], v[136:139]
v_mfma_f32_16x16x32_bf16 v[144:147], a[100:103], a[28:31], v[144:147]
v_mfma_f32_16x16x32_bf16 v[144:147], a[96:99], a[12:15], v[144:147]
v_mfma_f32_16x16x32_bf16 v[148:151], a[104:107], a[12:15], v[148:151]
ds_read_b64_tr_b16 a[96:97], v12 offset:16640
v_mfma_f32_16x16x32_bf16 v[148:151], a[108:111], a[28:31], v[148:151]
ds_read_b64_tr_b16 a[98:99], v12 offset:17664
v_mfma_f32_16x16x32_bf16 v[140:143], a[108:111], a[24:27], v[140:143]
ds_read_b64_tr_b16 a[100:101], v12 offset:24832
s_add_u32 m0, s16, 0x8c00
v_mfma_f32_16x16x32_bf16 v[140:143], a[104:107], a[8:11], v[140:143]
buffer_load_dwordx4 v23, s[44:47], s21 offen lds
v_mfma_f32_16x16x32_bf16 v[132:135], a[104:107], a[4:7], v[132:135]
ds_read_b64_tr_b16 a[102:103], v12 offset:25856
v_mfma_f32_16x16x32_bf16 v[132:135], a[108:111], a[20:23], v[132:135]
v_mfma_f32_16x16x32_bf16 v[124:127], a[108:111], a[16:19], v[124:127]
v_mfma_f32_16x16x32_bf16 v[124:127], a[104:107], a[0:3], v[124:127]
s_waitcnt lgkmcnt(4)
v_mfma_f32_16x16x32_bf16 v[152:155], a[0:3], a[80:83], v[152:155]
ds_read_b64_tr_b16 a[104:105], v13 offset:16640
v_mfma_f32_16x16x32_bf16 v[152:155], a[16:19], a[84:87], v[152:155]
ds_read_b64_tr_b16 a[106:107], v13 offset:17664
s_add_u32 m0, s16, 0x9000
v_mfma_f32_16x16x32_bf16 v[156:159], a[20:23], a[84:87], v[156:159]
buffer_load_dwordx4 v22, s[44:47], s22 offen lds
v_mfma_f32_16x16x32_bf16 v[156:159], a[4:7], a[80:83], v[156:159]
ds_read_b64_tr_b16 a[108:109], v13 offset:24832
v_mfma_f32_16x16x32_bf16 v[160:163], a[8:11], a[80:83], v[160:163]
ds_read_b64_tr_b16 a[110:111], v13 offset:25856
v_mfma_f32_16x16x32_bf16 v[160:163], a[24:27], a[84:87], v[160:163]
v_mfma_f32_16x16x32_bf16 v[164:167], a[28:31], a[84:87], v[164:167]
v_mfma_f32_16x16x32_bf16 v[164:167], a[12:15], a[80:83], v[164:167]
v_mfma_f32_16x16x32_bf16 v[180:183], a[12:15], a[88:91], v[180:183]
ds_read_b64_tr_b16 a[80:81], v12 offset:16896
v_mfma_f32_16x16x32_bf16 v[180:183], a[28:31], a[92:95], v[180:183]
ds_read_b64_tr_b16 a[82:83], v12 offset:17920
s_add_u32 m0, s16, 0x9400
v_mfma_f32_16x16x32_bf16 v[176:179], a[24:27], a[92:95], v[176:179]
buffer_load_dwordx4 v23, s[44:47], s22 offen lds
v_mfma_f32_16x16x32_bf16 v[176:179], a[8:11], a[88:91], v[176:179]
ds_read_b64_tr_b16 a[84:85], v12 offset:25088
v_mfma_f32_16x16x32_bf16 v[172:175], a[4:7], a[88:91], v[172:175]
ds_read_b64_tr_b16 a[86:87], v12 offset:26112
v_mfma_f32_16x16x32_bf16 v[172:175], a[20:23], a[92:95], v[172:175]
v_mfma_f32_16x16x32_bf16 v[168:171], a[16:19], a[92:95], v[168:171]
v_mfma_f32_16x16x32_bf16 v[168:171], a[0:3], a[88:91], v[168:171]
s_waitcnt lgkmcnt(4)
v_mfma_f32_16x16x32_bf16 v[184:187], a[0:3], a[96:99], v[184:187]
ds_read_b64_tr_b16 a[88:89], v13 offset:16896
s_add_u32 m0, s16, 0x9800
v_mfma_f32_16x16x32_bf16 v[184:187], a[16:19], a[100:103], v[184:187]
buffer_load_dwordx4 v22, s[44:47], s23 offen lds
v_mfma_f32_16x16x32_bf16 v[188:191], a[20:23], a[100:103], v[188:191]
ds_read_b64_tr_b16 a[90:91], v13 offset:17920
v_mfma_f32_16x16x32_bf16 v[188:191], a[4:7], a[96:99], v[188:191]
ds_read_b64_tr_b16 a[92:93], v13 offset:25088
v_mfma_f32_16x16x32_bf16 v[192:195], a[8:11], a[96:99], v[192:195]
ds_read_b64_tr_b16 a[94:95], v13 offset:26112
v_mfma_f32_16x16x32_bf16 v[192:195], a[24:27], a[100:103], v[192:195]
v_mfma_f32_16x16x32_bf16 v[196:199], a[28:31], a[100:103], v[196:199]
v_mfma_f32_16x16x32_bf16 v[196:199], a[12:15], a[96:99], v[196:199]
v_mfma_f32_16x16x32_bf16 v[212:215], a[12:15], a[104:107], v[212:215]
ds_read_b64_tr_b16 a[96:97], v12 offset:17152
s_add_u32 m0, s16, 0x9c00
v_mfma_f32_16x16x32_bf16 v[212:215], a[28:31], a[108:111], v[212:215]
buffer_load_dwordx4 v23, s[44:47], s23 offen lds
v_mfma_f32_16x16x32_bf16 v[208:211], a[24:27], a[108:111], v[208:211]
ds_read_b64_tr_b16 a[98:99], v12 offset:18176
v_lshl_add_u32 v22, s42, 7, v22
v_mfma_f32_16x16x32_bf16 v[208:211], a[8:11], a[104:107], v[208:211]
ds_read_b64_tr_b16 a[100:101], v12 offset:25344
v_lshl_add_u32 v23, s42, 7, v23
v_mfma_f32_16x16x32_bf16 v[204:207], a[4:7], a[104:107], v[204:207]
ds_read_b64_tr_b16 a[102:103], v12 offset:26368
v_mfma_f32_16x16x32_bf16 v[204:207], a[20:23], a[108:111], v[204:207]
v_mfma_f32_16x16x32_bf16 v[200:203], a[16:19], a[108:111], v[200:203]
v_mfma_f32_16x16x32_bf16 v[200:203], a[0:3], a[104:107], v[200:203]
s_mov_b32 s9, 0x200000
s_waitcnt lgkmcnt(4)
v_mfma_f32_16x16x32_bf16 v[216:219], a[0:3], a[80:83], v[216:219]
buffer_load_dword a120, v18, s[52:55], s9 offen
v_mfma_f32_16x16x32_bf16 v[216:219], a[16:19], a[84:87], v[216:219]
ds_read_b64_tr_b16 a[104:105], v13 offset:17152
v_mfma_f32_16x16x32_bf16 v[220:223], a[20:23], a[84:87], v[220:223]
ds_read_b64_tr_b16 a[106:107], v13 offset:18176
v_mfma_f32_16x16x32_bf16 v[220:223], a[4:7], a[80:83], v[220:223]
ds_read_b64_tr_b16 a[108:109], v13 offset:25344
v_mfma_f32_16x16x32_bf16 v[224:227], a[8:11], a[80:83], v[224:227]
ds_read_b64_tr_b16 a[110:111], v13 offset:26368
v_add_u32 v12, 0x8000, v12
v_mfma_f32_16x16x32_bf16 v[224:227], a[24:27], a[84:87], v[224:227]
v_add_u32 v13, 0x8000, v13
v_mfma_f32_16x16x32_bf16 v[228:231], a[28:31], a[84:87], v[228:231]
v_mfma_f32_16x16x32_bf16 v[228:231], a[12:15], a[80:83], v[228:231]
v_mfma_f32_16x16x32_bf16 v[244:247], a[12:15], a[88:91], v[244:247]
s_waitcnt vmcnt(26) lgkmcnt(0)
v_mfma_f32_16x16x32_bf16 v[244:247], a[28:31], a[92:95], v[244:247]
s_barrier
s_add_u32 m0, s17, 0x0
v_mfma_f32_16x16x32_bf16 v[240:243], a[24:27], a[92:95], v[240:243]
buffer_load_dwordx4 v5, s[52:55], 0 offen lds
v_mfma_f32_16x16x32_bf16 v[240:243], a[8:11], a[88:91], v[240:243]
ds_read_b64_tr_b16 a[80:81], v12 offset:0
v_mfma_f32_16x16x32_bf16 v[236:239], a[4:7], a[88:91], v[236:239]
ds_read_b64_tr_b16 a[82:83], v12 offset:1024
v_mfma_f32_16x16x32_bf16 v[236:239], a[20:23], a[92:95], v[236:239]
ds_read_b64_tr_b16 a[84:85], v12 offset:8192
v_mfma_f32_16x16x32_bf16 v[232:235], a[16:19], a[92:95], v[232:235]
ds_read_b64_tr_b16 a[86:87], v12 offset:9216
v_mfma_f32_16x16x32_bf16 v[232:235], a[0:3], a[88:91], v[232:235]
s_waitcnt lgkmcnt(4)
v_mfma_f32_16x16x32_bf16 v[248:251], a[0:3], a[96:99], v[248:251]
ds_read_b64_tr_b16 a[88:89], v13 offset:0
s_add_u32 m0, s17, 0x400
v_mfma_f32_16x16x32_bf16 v[248:251], a[16:19], a[100:103], v[248:251]
buffer_load_dwordx4 v5, s[52:55], s13 offen lds
v_mfma_f32_16x16x32_bf16 v[252:255], a[20:23], a[100:103], v[252:255]
ds_read_b64_tr_b16 a[90:91], v13 offset:1024
v_mfma_f32_16x16x32_bf16 v[252:255], a[4:7], a[96:99], v[252:255]
ds_read_b64_tr_b16 a[92:93], v13 offset:8192
v_mfma_f32_16x16x32_bf16 a[232:235], a[8:11], a[96:99], a[232:235]
ds_read_b64_tr_b16 a[94:95], v13 offset:9216
v_mfma_f32_16x16x32_bf16 a[232:235], a[24:27], a[100:103], a[232:235]
v_mfma_f32_16x16x32_bf16 a[236:239], a[28:31], a[100:103], a[236:239]
v_mfma_f32_16x16x32_bf16 a[236:239], a[12:15], a[96:99], a[236:239]
s_add_u32 m0, s17, 0x800
v_mfma_f32_16x16x32_bf16 a[252:255], a[12:15], a[104:107], a[252:255]
buffer_load_dwordx4 v6, s[52:55], 0 offen lds
v_mfma_f32_16x16x32_bf16 a[252:255], a[28:31], a[108:111], a[252:255]
ds_read_b64_tr_b16 a[96:97], v12 offset:256
v_mfma_f32_16x16x32_bf16 a[248:251], a[24:27], a[108:111], a[248:251]
ds_read_b64_tr_b16 a[98:99], v12 offset:1280
v_mfma_f32_16x16x32_bf16 a[248:251], a[8:11], a[104:107], a[248:251]
ds_read_b64_tr_b16 a[100:101], v12 offset:8448
v_mfma_f32_16x16x32_bf16 a[244:247], a[4:7], a[104:107], a[244:247]
ds_read_b64_tr_b16 a[102:103], v12 offset:9472
v_mfma_f32_16x16x32_bf16 a[244:247], a[20:23], a[108:111], a[244:247]
v_mfma_f32_16x16x32_bf16 a[240:243], a[16:19], a[108:111], a[240:243]
v_mfma_f32_16x16x32_bf16 a[240:243], a[0:3], a[104:107], a[240:243]
s_add_u32 m0, s17, 0xc00
s_waitcnt lgkmcnt(4)
L_S7:
v_mfma_f32_16x16x32_bf16 v[24:27], a[80:83], a[32:35], v[24:27]
buffer_load_dwordx4 v6, s[52:55], s13 offen lds
v_mfma_f32_16x16x32_bf16 v[24:27], a[84:87], a[48:51], v[24:27]
ds_read_b64_tr_b16 a[104:105], v13 offset:256
s_waitcnt vmcnt(22)
v_mfma_f32_16x16x32_bf16 v[32:35], a[84:87], a[52:55], v[32:35]
ds_read_b64_tr_b16 a[106:107], v13 offset:1280
v_mfma_f32_16x16x32_bf16 v[32:35], a[80:83], a[36:39], v[32:35]
ds_read_b64_tr_b16 a[108:109], v13 offset:8448
v_mfma_f32_16x16x32_bf16 v[40:43], a[80:83], a[40:43], v[40:43]
ds_read_b64_tr_b16 a[110:111], v13 offset:9472
v_mfma_f32_16x16x32_bf16 v[40:43], a[84:87], a[56:59], v[40:43]
ds_read_b128 a[0:3], v8 offset:0
v_mfma_f32_16x16x32_bf16 v[48:51], a[84:87], a[60:63], v[48:51]
ds_read_b128 a[16:19], v9 offset:0
s_add_u32 m0, s18, 0x4000
v_mfma_f32_16x16x32_bf16 v[48:51], a[80:83], a[44:47], v[48:51]
buffer_load_dwordx4 v7, s[68:71], 0 offen lds
v_mfma_f32_16x16x32_bf16 v[52:55], a[88:91], a[44:47], v[52:55]
ds_read_b64_tr_b16 a[80:81], v12 offset:512
v_mfma_f32_16x16x32_bf16 v[52:55], a[92:95], a[60:63], v[52:55]
ds_read_b64_tr_b16 a[82:83], v12 offset:1536
v_mfma_f32_16x16x32_bf16 v[44:47], a[92:95], a[56:59], v[44:47]
ds_read_b64_tr_b16 a[84:85], v12 offset:8704
v_mfma_f32_16x16x32_bf16 v[44:47], a[88:91], a[40:43], v[44:47]
ds_read_b64_tr_b16 a[86:87], v12 offset:9728
v_mfma_f32_16x16x32_bf16 v[36:39], a[88:91], a[36:39], v[36:39]
ds_read_b128 a[4:7], v8 offset:2048
v_mfma_f32_16x16x32_bf16 v[36:39], a[92:95], a[52:55], v[36:39]
ds_read_b128 a[20:23], v9 offset:2048
s_waitcnt lgkmcnt(8)
v_mfma_f32_16x16x32_bf16 v[28:31], a[92:95], a[48:51], v[28:31]
ds_read_b128 a[8:11], v8 offset:4096
s_add_u32 m0, s18, 0x5000
v_mfma_f32_16x16x32_bf16 v[28:31], a[88:91], a[32:35], v[28:31]
buffer_load_dwordx4 v7, s[68:71], s25 offen lds
v_mfma_f32_16x16x32_bf16 v[56:59], a[96:99], a[32:35], v[56:59]
ds_read_b64_tr_b16 a[88:89], v13 offset:512
v_mfma_f32_16x16x32_bf16 v[56:59], a[100:103], a[48:51], v[56:59]
ds_read_b64_tr_b16 a[90:91], v13 offset:1536
v_mfma_f32_16x16x32_bf16 v[64:67], a[100:103], a[52:55], v[64:67]
ds_read_b64_tr_b16 a[92:93], v13 offset:8704
v_mfma_f32_16x16x32_bf16 v[64:67], a[96:99], a[36:39], v[64:67]
ds_read_b64_tr_b16 a[94:95], v13 offset:9728
v_cvt_pk_bf16_f32 v24, v24, v25
v_cvt_pk_bf16_f32 v25, v26, v27
v_mfma_f32_16x16x32_bf16 v[72:75], a[96:99], a[40:43], v[72:75]
ds_read_b128 a[24:27], v9 offset:4096
v_cvt_pk_bf16_f32 v26, v28, v29
v_mfma_f32_16x16x32_bf16 v[72:75], a[100:103], a[56:59], v[72:75]
ds_read_b128 a[12:15], v8 offset:6144
s_add_u32 m0, s18, 0x6000
v_mfma_f32_16x16x32_bf16 v[80:83], a[100:103], a[60:63], v[80:83]
buffer_load_dwordx4 v7, s[68:71], s26 offen lds
v_cvt_pk_bf16_f32 v27, v30, v31
v_mfma_f32_16x16x32_bf16 v[80:83], a[96:99], a[44:47], v[80:83]
ds_read_b128 a[28:31], v9 offset:6144
v_lshl_add_u32 v5, s42, 19, v5
v_mfma_f32_16x16x32_bf16 v[84:87], a[104:107], a[44:47], v[84:87]
ds_read_b64_tr_b16 a[96:97], v12 offset:768
v_lshl_add_u32 v6, s42, 19, v6
v_mfma_f32_16x16x32_bf16 v[84:87], a[108:111], a[60:63], v[84:87]
ds_read_b64_tr_b16 a[98:99], v12 offset:1792
v_lshl_add_u32 v7, s42, 18, v7
v_accvgpr_write_b32 a128, v24
v_mfma_f32_16x16x32_bf16 v[76:79], a[108:111], a[56:59], v[76:79]
ds_read_b64_tr_b16 a[100:101], v12 offset:8960
v_lshl_add_u32 v7, s42, 17, v7
v_mfma_f32_16x16x32_bf16 v[76:79], a[104:107], a[40:43], v[76:79]
ds_read_b64_tr_b16 a[102:103], v12 offset:9984
v_accvgpr_write_b32 a129, v25
v_mfma_f32_16x16x32_bf16 v[68:71], a[104:107], a[36:39], v[68:71]
s_mov_b32 s9, 0x400000
v_accvgpr_write_b32 a130, v26
v_accvgpr_write_b32 a131, v27
v_cvt_pk_bf16_f32 v32, v32, v33
v_mfma_f32_16x16x32_bf16 v[68:71], a[108:111], a[52:55], v[68:71]
buffer_load_dword a120, v18, s[52:55], s9 offen
v_mfma_f32_16x16x32_bf16 v[60:63], a[108:111], a[48:51], v[60:63]
v_cvt_pk_bf16_f32 v33, v34, v35
v_cvt_pk_bf16_f32 v34, v36, v37
v_mfma_f32_16x16x32_bf16 v[60:63], a[104:107], a[32:35], v[60:63]
s_waitcnt lgkmcnt(7)
v_cvt_pk_bf16_f32 v35, v38, v39
v_accvgpr_write_b32 a132, v32
v_accvgpr_write_b32 a133, v33
v_mfma_f32_16x16x32_bf16 v[88:91], a[80:83], a[32:35], v[88:91]
ds_read_b64_tr_b16 a[104:105], v13 offset:768
v_accvgpr_write_b32 a134, v34
v_mfma_f32_16x16x32_bf16 v[88:91], a[84:87], a[48:51], v[88:91]
ds_read_b64_tr_b16 a[106:107], v13 offset:1792
v_accvgpr_write_b32 a135, v35
v_mfma_f32_16x16x32_bf16 v[96:99], a[84:87], a[52:55], v[96:99]
ds_read_b64_tr_b16 a[108:109], v13 offset:8960
v_cvt_pk_bf16_f32 v40, v40, v41
v_cvt_pk_bf16_f32 v41, v42, v43
v_mfma_f32_16x16x32_bf16 v[96:99], a[80:83], a[36:39], v[96:99]
ds_read_b64_tr_b16 a[110:111], v13 offset:9984
v_cvt_pk_bf16_f32 v42, v44, v45
v_mfma_f32_16x16x32_bf16 v[104:107], a[80:83], a[40:43], v[104:107]
s_add_u32 m0, s16, 0x0
s_waitcnt lgkmcnt(8)
v_cvt_pk_bf16_f32 v43, v46, v47
v_mfma_f32_16x16x32_bf16 v[104:107], a[84:87], a[56:59], v[104:107]
buffer_load_dwordx4 v22, s[44:47], s20 offen lds
v_accvgpr_write_b32 a136, v40
v_mfma_f32_16x16x32_bf16 v[112:115], a[84:87], a[60:63], v[112:115]
v_accvgpr_write_b32 a137, v41
v_accvgpr_write_b32 a138, v42
v_mfma_f32_16x16x32_bf16 v[112:115], a[80:83], a[44:47], v[112:115]
v_accvgpr_write_b32 a139, v43
v_cvt_pk_bf16_f32 v48, v48, v49
v_mfma_f32_16x16x32_bf16 v[116:119], a[88:91], a[44:47], v[116:119]
ds_read_b64_tr_b16 a[80:81], v12 offset:16384
v_cvt_pk_bf16_f32 v49, v50, v51
v_cvt_pk_bf16_f32 v50, v52, v53
v_mfma_f32_16x16x32_bf16 v[116:119], a[92:95], a[60:63], v[116:119]
ds_read_b64_tr_b16 a[82:83], v12 offset:17408
v_cvt_pk_bf16_f32 v51, v54, v55
v_mfma_f32_16x16x32_bf16 v[108:111], a[92:95], a[56:59], v[108:111]
ds_read_b64_tr_b16 a[84:85], v12 offset:24576
v_accvgpr_write_b32 a140, v48
v_mfma_f32_16x16x32_bf16 v[108:111], a[88:91], a[40:43], v[108:111]
ds_read_b64_tr_b16 a[86:87], v12 offset:25600
s_add_u32 m0, s16, 0x400
v_accvgpr_write_b32 a141, v49
v_mfma_f32_16x16x32_bf16 v[100:103], a[88:91], a[36:39], v[100:103]
buffer_load_dwordx4 v23, s[44:47], s20 offen lds
v_mfma_f32_16x16x32_bf16 v[100:103], a[92:95], a[52:55], v[100:103]
v_accvgpr_write_b32 a142, v50
v_accvgpr_write_b32 a143, v51
v_mfma_f32_16x16x32_bf16 v[92:95], a[92:95], a[48:51], v[92:95]
v_cvt_pk_bf16_f32 v56, v56, v57
v_cvt_pk_bf16_f32 v57, v58, v59
v_cvt_pk_bf16_f32 v58, v60, v61
v_mfma_f32_16x16x32_bf16 v[92:95], a[88:91], a[32:35], v[92:95]
s_waitcnt lgkmcnt(4)
v_cvt_pk_bf16_f32 v59, v62, v63
v_accvgpr_write_b32 a144, v56
v_mfma_f32_16x16x32_bf16 v[120:123], a[96:99], a[32:35], v[120:123]
ds_read_b64_tr_b16 a[88:89], v13 offset:16384
v_accvgpr_write_b32 a145, v57
v_mfma_f32_16x16x32_bf16 v[120:123], a[100:103], a[48:51], v[120:123]
ds_read_b64_tr_b16 a[90:91], v13 offset:17408
v_accvgpr_write_b32 a146, v58
v_accvgpr_write_b32 a147, v59
v_mfma_f32_16x16x32_bf16 v[128:131], a[100:103], a[52:55], v[128:131]
ds_read_b64_tr_b16 a[92:93], v13 offset:24576
v_cvt_pk_bf16_f32 v64, v64, v65
v_mfma_f32_16x16x32_bf16 v[128:131], a[96:99], a[36:39], v[128:131]
ds_read_b64_tr_b16 a[94:95], v13 offset:25600
s_add_u32 m0, s16, 0x800
v_mfma_f32_16x16x32_bf16 v[136:139], a[96:99], a[40:43], v[136:139]
buffer_load_dwordx4 v22, s[44:47], s21 offen lds
v_cvt_pk_bf16_f32 v65, v66, v67
v_mfma_f32_16x16x32_bf16 v[136:139], a[100:103], a[56:59], v[136:139]
v_cvt_pk_bf16_f32 v66, v68, v69
v_cvt_pk_bf16_f32 v67, v70, v71
v_mfma_f32_16x16x32_bf16 v[144:147], a[100:103], a[60:63], v[144:147]
v_accvgpr_write_b32 a148, v64
v_accvgpr_write_b32 a149, v65
v_mfma_f32_16x16x32_bf16 v[144:147], a[96:99], a[44:47], v[144:147]
v_accvgpr_write_b32 a150, v66
v_accvgpr_write_b32 a151, v67
v_cvt_pk_bf16_f32 v72, v72, v73
v_mfma_f32_16x16x32_bf16 v[148:151], a[104:107], a[44:47], v[148:151]
ds_read_b64_tr_b16 a[96:97], v12 offset:16640
v_cvt_pk_bf16_f32 v73, v74, v75
v_mfma_f32_16x16x32_bf16 v[148:151], a[108:111], a[60:63], v[148:151]
ds_read_b64_tr_b16 a[98:99], v12 offset:17664
v_cvt_pk_bf16_f32 v74, v76, v77
v_mfma_f32_16x16x32_bf16 v[140:143], a[108:111], a[56:59], v[140:143]
ds_read_b64_tr_b16 a[100:101], v12 offset:24832
s_add_u32 m0, s16, 0xc00
v_cvt_pk_bf16_f32 v75, v78, v79
v_mfma_f32_16x16x32_bf16 v[140:143], a[104:107], a[40:43], v[140:143]
buffer_load_dwordx4 v23, s[44:47], s21 offen lds
v_mfma_f32_16x16x32_bf16 v[132:135], a[104:107], a[36:39], v[132:135]
ds_read_b64_tr_b16 a[102:103], v12 offset:25856
v_accvgpr_write_b32 a152, v72
v_mfma_f32_16x16x32_bf16 v[132:135], a[108:111], a[52:55], v[132:135]
v_accvgpr_write_b32 a153, v73
v_accvgpr_write_b32 a154, v74
v_accvgpr_write_b32 a155, v75
v_mfma_f32_16x16x32_bf16 v[124:127], a[108:111], a[48:51], v[124:127]
v_cvt_pk_bf16_f32 v80, v80, v81
v_cvt_pk_bf16_f32 v81, v82, v83
v_mfma_f32_16x16x32_bf16 v[124:127], a[104:107], a[32:35], v[124:127]
s_waitcnt lgkmcnt(4)
v_cvt_pk_bf16_f32 v82, v84, v85
v_cvt_pk_bf16_f32 v83, v86, v87
v_mfma_f32_16x16x32_bf16 v[152:155], a[32:35], a[80:83], v[152:155]
ds_read_b64_tr_b16 a[104:105], v13 offset:16640
v_accvgpr_write_b32 a156, v80
v_accvgpr_write_b32 a157, v81
v_mfma_f32_16x16x32_bf16 v[152:155], a[48:51], a[84:87], v[152:155]
ds_read_b64_tr_b16 a[106:107], v13 offset:17664
s_add_u32 m0, s16, 0x1000
v_mfma_f32_16x16x32_bf16 v[156:159], a[52:55], a[84:87], v[156:159]
buffer_load_dwordx4 v22, s[44:47], s22 offen lds
v_mfma_f32_16x16x32_bf16 v[156:159], a[36:39], a[80:83], v[156:159]
ds_read_b64_tr_b16 a[108:109], v13 offset:24832
v_accvgpr_write_b32 a158, v82
v_accvgpr_write_b32 a159, v83
v_mfma_f32_16x16x32_bf16 v[160:163], a[40:43], a[80:83], v[160:163]
ds_read_b64_tr_b16 a[110:111], v13 offset:25856
v_cvt_pk_bf16_f32 v88, v88, v89
v_mfma_f32_16x16x32_bf16 v[160:163], a[56:59], a[84:87], v[160:163]
v_cvt_pk_bf16_f32 v89, v90, v91
v_cvt_pk_bf16_f32 v90, v92, v93
v_mfma_f32_16x16x32_bf16 v[164:167], a[60:63], a[84:87], v[164:167]
v_cvt_pk_bf16_f32 v91, v94, v95
v_accvgpr_write_b32 a160, v88
v_accvgpr_write_b32 a161, v89
v_mfma_f32_16x16x32_bf16 v[164:167], a[44:47], a[80:83], v[164:167]
v_accvgpr_write_b32 a162, v90
v_accvgpr_write_b32 a163, v91
v_mfma_f32_16x16x32_bf16 v[180:183], a[44:47], a[88:91], v[180:183]
ds_read_b64_tr_b16 a[80:81], v12 offset:16896
v_cvt_pk_bf16_f32 v96, v96, v97
v_mfma_f32_16x16x32_bf16 v[180:183], a[60:63], a[92:95], v[180:183]
ds_read_b64_tr_b16 a[82:83], v12 offset:17920
s_add_u32 m0, s16, 0x1400
v_cvt_pk_bf16_f32 v97, v98, v99
v_mfma_f32_16x16x32_bf16 v[176:179], a[56:59], a[92:95], v[176:179]
buffer_load_dwordx4 v23, s[44:47], s22 offen lds
v_mfma_f32_16x16x32_bf16 v[176:179], a[40:43], a[88:91], v[176:179]
ds_read_b64_tr_b16 a[84:85], v12 offset:25088
v_cvt_pk_bf16_f32 v98, v100, v101
v_mfma_f32_16x16x32_bf16 v[172:175], a[36:39], a[88:91], v[172:175]
ds_read_b64_tr_b16 a[86:87], v12 offset:26112
v_cvt_pk_bf16_f32 v99, v102, v103
v_accvgpr_write_b32 a164, v96
v_mfma_f32_16x16x32_bf16 v[172:175], a[52:55], a[92:95], v[172:175]
v_accvgpr_write_b32 a165, v97
v_accvgpr_write_b32 a166, v98
v_mfma_f32_16x16x32_bf16 v[168:171], a[48:51], a[92:95], v[168:171]
v_accvgpr_write_b32 a167, v99
v_cvt_pk_bf16_f32 v104, v104, v105
v_mfma_f32_16x16x32_bf16 v[168:171], a[32:35], a[88:91], v[168:171]
s_waitcnt lgkmcnt(4)
v_cvt_pk_bf16_f32 v105, v106, v107
v_cvt_pk_bf16_f32 v106, v108, v109
v_cvt_pk_bf16_f32 v107, v110, v111
v_mfma_f32_16x16x32_bf16 v[184:187], a[32:35], a[96:99], v[184:187]
ds_read_b64_tr_b16 a[88:89], v13 offset:16896
s_add_u32 m0, s16, 0x1800
v_mfma_f32_16x16x32_bf16 v[184:187], a[48:51], a[100:103], v[184:187]
buffer_load_dwordx4 v22, s[44:47], s23 offen lds
v_mfma_f32_16x16x32_bf16 v[188:191], a[52:55], a[100:103], v[188:191]
ds_read_b64_tr_b16 a[90:91], v13 offset:17920
v_accvgpr_write_b32 a168, v104
v_accvgpr_write_b32 a169, v105
v_mfma_f32_16x16x32_bf16 v[188:191], a[36:39], a[96:99], v[188:191]
ds_read_b64_tr_b16 a[92:93], v13 offset:25088
v_accvgpr_write_b32 a170, v106
v_mfma_f32_16x16x32_bf16 v[192:195], a[40:43], a[96:99], v[192:195]
ds_read_b64_tr_b16 a[94:95], v13 offset:26112
v_accvgpr_write_b32 a171, v107
v_mfma_f32_16x16x32_bf16 v[192:195], a[56:59], a[100:103], v[192:195]
L_padA4:
s_cmp_eq_u32 s95, 1
s_cbranch_scc1 L_padA8
v_cvt_pk_bf16_f32 v112, v112, v113
v_cvt_pk_bf16_f32 v113, v114, v115
v_cvt_pk_bf16_f32 v114, v116, v117
v_mfma_f32_16x16x32_bf16 v[196:199], a[60:63], a[100:103], v[196:199]
v_cvt_pk_bf16_f32 v115, v118, v119
v_accvgpr_write_b32 a172, v112
v_mfma_f32_16x16x32_bf16 v[196:199], a[44:47], a[96:99], v[196:199]
v_accvgpr_write_b32 a173, v113
v_accvgpr_write_b32 a174, v114
v_mfma_f32_16x16x32_bf16 v[212:215], a[44:47], a[104:107], v[212:215]
ds_read_b64_tr_b16 a[96:97], v12 offset:17152
s_add_u32 m0, s16, 0x1c00
v_accvgpr_write_b32 a175, v115
v_mfma_f32_16x16x32_bf16 v[212:215], a[60:63], a[108:111], v[212:215]
buffer_load_dwordx4 v23, s[44:47], s23 offen lds
v_mfma_f32_16x16x32_bf16 v[208:211], a[56:59], a[108:111], v[208:211]
ds_read_b64_tr_b16 a[98:99], v12 offset:18176
v_lshl_add_u32 v22, s42, 7, v22
v_mfma_f32_16x16x32_bf16 v[208:211], a[40:43], a[104:107], v[208:211]
ds_read_b64_tr_b16 a[100:101], v12 offset:25344
v_lshl_add_u32 v23, s42, 7, v23
v_cvt_pk_bf16_f32 v120, v120, v121
v_mfma_f32_16x16x32_bf16 v[204:207], a[36:39], a[104:107], v[204:207]
ds_read_b64_tr_b16 a[102:103], v12 offset:26368
v_cvt_pk_bf16_f32 v121, v122, v123
v_mfma_f32_16x16x32_bf16 v[204:207], a[52:55], a[108:111], v[204:207]
v_cvt_pk_bf16_f32 v122, v124, v125
v_cvt_pk_bf16_f32 v123, v126, v127
v_mfma_f32_16x16x32_bf16 v[200:203], a[48:51], a[108:111], v[200:203]
v_accvgpr_write_b32 a176, v120
v_accvgpr_write_b32 a177, v121
v_accvgpr_write_b32 a178, v122
v_mfma_f32_16x16x32_bf16 v[200:203], a[32:35], a[104:107], v[200:203]
s_mov_b32 s9, 0x600000
s_waitcnt lgkmcnt(4)
v_accvgpr_write_b32 a179, v123
v_mfma_f32_16x16x32_bf16 v[216:219], a[32:35], a[80:83], v[216:219]
buffer_load_dword a120, v18, s[52:55], s9 offen
v_mfma_f32_16x16x32_bf16 v[216:219], a[48:51], a[84:87], v[216:219]
ds_read_b64_tr_b16 a[104:105], v13 offset:17152
v_cvt_pk_bf16_f32 v128, v128, v129
v_cvt_pk_bf16_f32 v129, v130, v131
v_mfma_f32_16x16x32_bf16 v[220:223], a[52:55], a[84:87], v[220:223]
ds_read_b64_tr_b16 a[106:107], v13 offset:18176
v_cvt_pk_bf16_f32 v130, v132, v133
v_mfma_f32_16x16x32_bf16 v[220:223], a[36:39], a[80:83], v[220:223]
ds_read_b64_tr_b16 a[108:109], v13 offset:25344
v_cvt_pk_bf16_f32 v131, v134, v135
v_mfma_f32_16x16x32_bf16 v[224:227], a[40:43], a[80:83], v[224:227]
ds_read_b64_tr_b16 a[110:111], v13 offset:26368
v_add_u32 v12, 0x8000, v12
v_accvgpr_write_b32 a180, v128
v_mfma_f32_16x16x32_bf16 v[224:227], a[56:59], a[84:87], v[224:227]
v_add_u32 v13, 0x8000, v13
v_accvgpr_write_b32 a181, v129
v_mfma_f32_16x16x32_bf16 v[228:231], a[60:63], a[84:87], v[228:231]
v_accvgpr_write_b32 a182, v130
v_accvgpr_write_b32 a183, v131
v_mfma_f32_16x16x32_bf16 v[228:231], a[44:47], a[80:83], v[228:231]
v_cvt_pk_bf16_f32 v136, v136, v137
v_cvt_pk_bf16_f32 v137, v138, v139
v_cvt_pk_bf16_f32 v138, v140, v141
v_mfma_f32_16x16x32_bf16 v[244:247], a[44:47], a[88:91], v[244:247]
s_waitcnt vmcnt(27) lgkmcnt(0)
v_cvt_pk_bf16_f32 v139, v142, v143
v_accvgpr_write_b32 a184, v136
v_mfma_f32_16x16x32_bf16 v[244:247], a[60:63], a[92:95], v[244:247]
s_barrier
s_add_u32 m0, s17, 0x8000
v_accvgpr_write_b32 a185, v137
v_mfma_f32_16x16x32_bf16 v[240:243], a[56:59], a[92:95], v[240:243]
buffer_load_dwordx4 v5, s[52:55], 0 offen lds
v_accvgpr_write_b32 a186, v138
v_mfma_f32_16x16x32_bf16 v[240:243], a[40:43], a[88:91], v[240:243]
ds_read_b64_tr_b16 a[80:81], v12 offset:0
v_accvgpr_write_b32 a187, v139
v_mfma_f32_16x16x32_bf16 v[236:239], a[36:39], a[88:91], v[236:239]
ds_read_b64_tr_b16 a[82:83], v12 offset:1024
v_cvt_pk_bf16_f32 v144, v144, v145
v_mfma_f32_16x16x32_bf16 v[236:239], a[52:55], a[92:95], v[236:239]
ds_read_b64_tr_b16 a[84:85], v12 offset:8192
v_cvt_pk_bf16_f32 v145, v146, v147
v_cvt_pk_bf16_f32 v146, v148, v149
v_mfma_f32_16x16x32_bf16 v[232:235], a[48:51], a[92:95], v[232:235]
ds_read_b64_tr_b16 a[86:87], v12 offset:9216
v_cvt_pk_bf16_f32 v147, v150, v151
v_mfma_f32_16x16x32_bf16 v[232:235], a[32:35], a[88:91], v[232:235]
s_add_u32 m0, s17, 0x8400
s_waitcnt lgkmcnt(4)
v_accvgpr_write_b32 a188, v144
v_mfma_f32_16x16x32_bf16 v[248:251], a[32:35], a[96:99], v[248:251]
buffer_load_dwordx4 v5, s[52:55], s13 offen lds
v_accvgpr_write_b32 a189, v145
v_mfma_f32_16x16x32_bf16 v[248:251], a[48:51], a[100:103], v[248:251]
ds_read_b64_tr_b16 a[88:89], v13 offset:0
v_accvgpr_write_b32 a190, v146
v_mfma_f32_16x16x32_bf16 v[252:255], a[52:55], a[100:103], v[252:255]
ds_read_b64_tr_b16 a[90:91], v13 offset:1024
v_accvgpr_write_b32 a191, v147
v_mfma_f32_16x16x32_bf16 v[252:255], a[36:39], a[96:99], v[252:255]
ds_read_b64_tr_b16 a[92:93], v13 offset:8192
v_cvt_pk_bf16_f32 v152, v152, v153
v_cvt_pk_bf16_f32 v153, v154, v155
v_mfma_f32_16x16x32_bf16 a[232:235], a[40:43], a[96:99], a[232:235]
ds_read_b64_tr_b16 a[94:95], v13 offset:9216
v_cvt_pk_bf16_f32 v154, v156, v157
v_mfma_f32_16x16x32_bf16 a[232:235], a[56:59], a[100:103], a[232:235]
v_cvt_pk_bf16_f32 v155, v158, v159
v_accvgpr_write_b32 a192, v152
v_mfma_f32_16x16x32_bf16 a[236:239], a[60:63], a[100:103], a[236:239]
s_add_u32 m0, s17, 0x8800
v_accvgpr_write_b32 a193, v153
v_accvgpr_write_b32 a194, v154
v_accvgpr_write_b32 a195, v155
v_mfma_f32_16x16x32_bf16 a[236:239], a[44:47], a[96:99], a[236:239]
buffer_load_dwordx4 v6, s[52:55], 0 offen lds
v_mfma_f32_16x16x32_bf16 a[252:255], a[44:47], a[104:107], a[252:255]
ds_read_b64_tr_b16 a[96:97], v12 offset:256
v_cvt_pk_bf16_f32 v160, v160, v161
v_mfma_f32_16x16x32_bf16 a[252:255], a[60:63], a[108:111], a[252:255]
ds_read_b64_tr_b16 a[98:99], v12 offset:1280
v_cvt_pk_bf16_f32 v161, v162, v163
v_cvt_pk_bf16_f32 v162, v164, v165
v_mfma_f32_16x16x32_bf16 a[248:251], a[56:59], a[108:111], a[248:251]
ds_read_b64_tr_b16 a[100:101], v12 offset:8448
v_cvt_pk_bf16_f32 v163, v166, v167
v_mfma_f32_16x16x32_bf16 a[248:251], a[40:43], a[104:107], a[248:251]
ds_read_b64_tr_b16 a[102:103], v12 offset:9472
v_accvgpr_write_b32 a196, v160
v_mfma_f32_16x16x32_bf16 a[244:247], a[36:39], a[104:107], a[244:247]
v_accvgpr_write_b32 a197, v161
v_accvgpr_write_b32 a198, v162
v_accvgpr_write_b32 a199, v163
v_mfma_f32_16x16x32_bf16 a[244:247], a[52:55], a[108:111], a[244:247]
s_add_u32 m0, s17, 0x8c00
v_cvt_pk_bf16_f32 v168, v168, v169
v_cvt_pk_bf16_f32 v169, v170, v171
v_mfma_f32_16x16x32_bf16 a[240:243], a[48:51], a[108:111], a[240:243]
buffer_load_dwordx4 v6, s[52:55], s13 offen lds
v_mfma_f32_16x16x32_bf16 a[240:243], a[32:35], a[104:107], a[240:243]
s_waitcnt lgkmcnt(4)
v_cvt_pk_bf16_f32 v170, v172, v173
v_cvt_pk_bf16_f32 v171, v174, v175
v_accvgpr_write_b32 a200, v168
L_S8:
v_mfma_f32_16x16x32_bf16 v[24:27], a[80:83], a[0:3], 0
ds_read_b64_tr_b16 a[104:105], v13 offset:256
s_waitcnt vmcnt(22)
v_mfma_f32_16x16x32_bf16 v[24:27], a[84:87], a[16:19], v[24:27]
ds_read_b64_tr_b16 a[106:107], v13 offset:1280
v_accvgpr_write_b32 a201, v169
v_mfma_f32_16x16x32_bf16 v[32:35], a[84:87], a[20:23], 0
ds_read_b64_tr_b16 a[108:109], v13 offset:8448
v_accvgpr_write_b32 a202, v170
v_accvgpr_write_b32 a203, v171
v_mfma_f32_16x16x32_bf16 v[32:35], a[80:83], a[4:7], v[32:35]
ds_read_b64_tr_b16 a[110:111], v13 offset:9472
v_cvt_pk_bf16_f32 v176, v176, v177
v_mfma_f32_16x16x32_bf16 v[40:43], a[80:83], a[8:11], 0
ds_read_b128 a[32:35], v8 offset:32768
s_add_u32 m0, s18, 0xc000
v_mfma_f32_16x16x32_bf16 v[40:43], a[84:87], a[24:27], v[40:43]
buffer_load_dwordx4 v7, s[68:71], 0 offen lds
v_cvt_pk_bf16_f32 v177, v178, v179
v_mfma_f32_16x16x32_bf16 v[48:51], a[84:87], a[28:31], 0
ds_read_b128 a[48:51], v9 offset:32768
v_cvt_pk_bf16_f32 v178, v180, v181
v_mfma_f32_16x16x32_bf16 v[48:51], a[80:83], a[12:15], v[48:51]
ds_read_b128 a[36:39], v8 offset:34816
v_cvt_pk_bf16_f32 v179, v182, v183
v_mfma_f32_16x16x32_bf16 v[52:55], a[88:91], a[12:15], 0
ds_read_b64_tr_b16 a[80:81], v12 offset:512
v_accvgpr_write_b32 a204, v176
v_accvgpr_write_b32 a205, v177
v_mfma_f32_16x16x32_bf16 v[52:55], a[92:95], a[28:31], v[52:55]
ds_read_b64_tr_b16 a[82:83], v12 offset:1536
v_accvgpr_write_b32 a206, v178
v_mfma_f32_16x16x32_bf16 v[44:47], a[92:95], a[24:27], 0
ds_read_b64_tr_b16 a[84:85], v12 offset:8704
s_add_u32 s8, s28, 0x2000
v_mfma_f32_16x16x32_bf16 v[44:47], a[88:91], a[8:11], v[44:47]
buffer_store_dwordx4 a[128:131], v16, s[88:91], s8 offen sc1
v_accvgpr_write_b32 a207, v179
v_mfma_f32_16x16x32_bf16 v[36:39], a[88:91], a[4:7], 0
ds_read_b64_tr_b16 a[86:87], v12 offset:9728
v_cvt_pk_bf16_f32 v184, v184, v185
v_mfma_f32_16x16x32_bf16 v[36:39], a[92:95], a[20:23], v[36:39]
ds_read_b128 a[52:55], v9 offset:34816
v_cvt_pk_bf16_f32 v185, v186, v187
v_mfma_f32_16x16x32_bf16 v[28:31], a[92:95], a[16:19], 0
ds_read_b128 a[40:43], v8 offset:36864
v_cvt_pk_bf16_f32 v186, v188, v189
v_cvt_pk_bf16_f32 v187, v190, v191
v_mfma_f32_16x16x32_bf16 v[28:31], a[88:91], a[0:3], v[28:31]
ds_read_b128 a[56:59], v9 offset:36864
s_waitcnt lgkmcnt(10)
v_mfma_f32_16x16x32_bf16 v[56:59], a[96:99], a[0:3], 0
ds_read_b64_tr_b16 a[88:89], v13 offset:512
v_accvgpr_write_b32 a208, v184
v_mfma_f32_16x16x32_bf16 v[56:59], a[100:103], a[16:19], v[56:59]
ds_read_b64_tr_b16 a[90:91], v13 offset:1536
s_add_u32 m0, s18, 0xd000
v_accvgpr_write_b32 a209, v185
v_mfma_f32_16x16x32_bf16 v[64:67], a[100:103], a[20:23], 0
buffer_load_dwordx4 v7, s[68:71], s25 offen lds
v_mfma_f32_16x16x32_bf16 v[64:67], a[96:99], a[4:7], v[64:67]
ds_read_b64_tr_b16 a[92:93], v13 offset:8704
v_accvgpr_write_b32 a210, v186
v_mfma_f32_16x16x32_bf16 v[72:75], a[96:99], a[8:11], 0
ds_read_b64_tr_b16 a[94:95], v13 offset:9728
v_accvgpr_write_b32 a211, v187
v_cvt_pk_bf16_f32 v192, v192, v193
v_mfma_f32_16x16x32_bf16 v[72:75], a[100:103], a[24:27], v[72:75]
ds_read_b128 a[44:47], v8 offset:38912
v_cvt_pk_bf16_f32 v193, v194, v195
v_mfma_f32_16x16x32_bf16 v[80:83], a[100:103], a[28:31], 0
ds_read_b128 a[60:63], v9 offset:38912
v_cvt_pk_bf16_f32 v194, v196, v197
v_mfma_f32_16x16x32_bf16 v[80:83], a[96:99], a[12:15], v[80:83]
v_cvt_pk_bf16_f32 v195, v198, v199
v_accvgpr_write_b32 a212, v192
v_accvgpr_write_b32 a213, v193
v_mfma_f32_16x16x32_bf16 v[84:87], a[104:107], a[12:15], 0
ds_read_b64_tr_b16 a[96:97], v12 offset:768
s_add_u32 m0, s18, 0xe000
v_mfma_f32_16x16x32_bf16 v[84:87], a[108:111], a[28:31], v[84:87]
buffer_load_dwordx4 v7, s[68:71], s26 offen lds
v_mfma_f32_16x16x32_bf16 v[76:79], a[108:111], a[24:27], 0
ds_read_b64_tr_b16 a[98:99], v12 offset:1792
v_lshl_add_u32 v5, s42, 19, v5
v_accvgpr_write_b32 a214, v194
v_mfma_f32_16x16x32_bf16 v[76:79], a[104:107], a[8:11], v[76:79]
ds_read_b64_tr_b16 a[100:101], v12 offset:8960
v_lshl_add_u32 v6, s42, 19, v6
v_mfma_f32_16x16x32_bf16 v[68:71], a[104:107], a[4:7], 0
ds_read_b64_tr_b16 a[102:103], v12 offset:9984
v_lshl_add_u32 v7, s42, 18, v7
v_mfma_f32_16x16x32_bf16 v[68:71], a[108:111], a[20:23], v[68:71]
v_lshl_add_u32 v7, s42, 17, v7
v_accvgpr_write_b32 a215, v195
v_cvt_pk_bf16_f32 v200, v200, v201
v_mfma_f32_16x16x32_bf16 v[60:63], a[108:111], a[16:19], 0
v_cvt_pk_bf16_f32 v201, v202, v203
v_cvt_pk_bf16_f32 v202, v204, v205
v_mfma_f32_16x16x32_bf16 v[60:63], a[104:107], a[0:3], v[60:63]
s_add_u32 m0, s16, 0x8000
s_waitcnt lgkmcnt(4)
s_waitcnt lgkmcnt(6)
v_mfma_f32_16x16x32_bf16 v[88:91], a[80:83], a[0:3], 0
buffer_load_dwordx4 v22, s[44:47], s20 offen lds
v_cvt_pk_bf16_f32 v203, v206, v207
v_mfma_f32_16x16x32_bf16 v[88:91], a[84:87], a[16:19], v[88:91]
ds_read_b64_tr_b16 a[104:105], v13 offset:768
v_accvgpr_write_b32 a216, v200
v_mfma_f32_16x16x32_bf16 v[96:99], a[84:87], a[20:23], 0
ds_read_b64_tr_b16 a[106:107], v13 offset:1792
v_accvgpr_write_b32 a217, v201
v_mfma_f32_16x16x32_bf16 v[96:99], a[80:83], a[4:7], v[96:99]
ds_read_b64_tr_b16 a[108:109], v13 offset:8960
v_accvgpr_write_b32 a218, v202
v_accvgpr_write_b32 a219, v203
v_mfma_f32_16x16x32_bf16 v[104:107], a[80:83], a[8:11], 0
ds_read_b64_tr_b16 a[110:111], v13 offset:9984
s_add_u32 m0, s16, 0x8400
v_mfma_f32_16x16x32_bf16 v[104:107], a[84:87], a[24:27], v[104:107]
buffer_load_dwordx4 v23, s[44:47], s20 offen lds
v_mfma_f32_16x16x32_bf16 v[112:115], a[84:87], a[28:31], 0
v_cvt_pk_bf16_f32 v208, v208, v209
v_cvt_pk_bf16_f32 v209, v210, v211
v_cvt_pk_bf16_f32 v210, v212, v213
v_mfma_f32_16x16x32_bf16 v[112:115], a[80:83], a[12:15], v[112:115]
v_cvt_pk_bf16_f32 v211, v214, v215
v_accvgpr_write_b32 a220, v208
v_mfma_f32_16x16x32_bf16 v[116:119], a[88:91], a[12:15], 0
ds_read_b64_tr_b16 a[80:81], v14 offset:0
v_accvgpr_write_b32 a221, v209
v_mfma_f32_16x16x32_bf16 v[116:119], a[92:95], a[28:31], v[116:119]
ds_read_b64_tr_b16 a[82:83], v14 offset:256
v_accvgpr_write_b32 a222, v210
v_accvgpr_write_b32 a223, v211
v_mfma_f32_16x16x32_bf16 v[108:111], a[92:95], a[24:27], 0
ds_read_b64_tr_b16 a[84:85], v14 offset:2048
s_add_u32 m0, s16, 0x8800
v_mfma_f32_16x16x32_bf16 v[108:111], a[88:91], a[8:11], v[108:111]
buffer_load_dwordx4 v22, s[44:47], s21 offen lds
v_mfma_f32_16x16x32_bf16 v[100:103], a[88:91], a[4:7], 0
ds_read_b64_tr_b16 a[86:87], v14 offset:2304
v_cvt_pk_bf16_f32 v216, v216, v217
v_cvt_pk_bf16_f32 v217, v218, v219
v_mfma_f32_16x16x32_bf16 v[100:103], a[92:95], a[20:23], v[100:103]
v_cvt_pk_bf16_f32 v218, v220, v221
v_cvt_pk_bf16_f32 v219, v222, v223
v_mfma_f32_16x16x32_bf16 v[92:95], a[92:95], a[16:19], 0
v_accvgpr_write_b32 a224, v216
v_accvgpr_write_b32 a225, v217
v_mfma_f32_16x16x32_bf16 v[92:95], a[88:91], a[0:3], v[92:95]
s_add_u32 s8, s28, 0x3000
s_waitcnt lgkmcnt(4)
v_accvgpr_write_b32 a226, v218
v_accvgpr_write_b32 a227, v219
v_mfma_f32_16x16x32_bf16 v[120:123], a[96:99], a[0:3], 0
buffer_store_dwordx4 a[132:135], v16, s[88:91], s8 offen sc1
v_mfma_f32_16x16x32_bf16 v[120:123], a[100:103], a[16:19], v[120:123]
ds_read_b64_tr_b16 a[88:89], v15 offset:0
v_cvt_pk_bf16_f32 v224, v224, v225
v_mfma_f32_16x16x32_bf16 v[128:131], a[100:103], a[20:23], 0
ds_read_b64_tr_b16 a[90:91], v15 offset:256
v_cvt_pk_bf16_f32 v225, v226, v227
v_cvt_pk_bf16_f32 v226, v228, v229
v_mfma_f32_16x16x32_bf16 v[128:131], a[96:99], a[4:7], v[128:131]
ds_read_b64_tr_b16 a[92:93], v15 offset:2048
v_cvt_pk_bf16_f32 v227, v230, v231
v_mfma_f32_16x16x32_bf16 v[136:139], a[96:99], a[8:11], 0
ds_read_b64_tr_b16 a[94:95], v15 offset:2304
v_accvgpr_write_b32 a228, v224
v_mfma_f32_16x16x32_bf16 v[136:139], a[100:103], a[24:27], v[136:139]
s_add_u32 m0, s16, 0x8c00
v_accvgpr_write_b32 a229, v225
v_accvgpr_write_b32 a230, v226
v_accvgpr_write_b32 a231, v227
v_mfma_f32_16x16x32_bf16 v[144:147], a[100:103], a[28:31], 0
buffer_load_dwordx4 v23, s[44:47], s21 offen lds
v_mfma_f32_16x16x32_bf16 v[144:147], a[96:99], a[12:15], v[144:147]
v_cvt_pk_bf16_f32 v232, v232, v233
v_cvt_pk_bf16_f32 v233, v234, v235
v_mfma_f32_16x16x32_bf16 v[148:151], a[104:107], a[12:15], 0
ds_read_b64_tr_b16 a[96:97], v14 offset:4096
v_cvt_pk_bf16_f32 v234, v236, v237
v_cvt_pk_bf16_f32 v235, v238, v239
v_mfma_f32_16x16x32_bf16 v[148:151], a[108:111], a[28:31], v[148:151]
ds_read_b64_tr_b16 a[98:99], v14 offset:4352
v_accvgpr_write_b32 a112, v232
v_mfma_f32_16x16x32_bf16 v[140:143], a[108:111], a[24:27], 0
ds_read_b64_tr_b16 a[100:101], v14 offset:6144
v_accvgpr_write_b32 a113, v233
v_mfma_f32_16x16x32_bf16 v[140:143], a[104:107], a[8:11], v[140:143]
ds_read_b64_tr_b16 a[102:103], v14 offset:6400
s_add_u32 m0, s16, 0x9000
v_accvgpr_write_b32 a114, v234
v_mfma_f32_16x16x32_bf16 v[132:135], a[104:107], a[4:7], 0
buffer_load_dwordx4 v22, s[44:47], s22 offen lds
v_mfma_f32_16x16x32_bf16 v[132:135], a[108:111], a[20:23], v[132:135]
v_accvgpr_write_b32 a115, v235
v_cvt_pk_bf16_f32 v240, v240, v241
v_mfma_f32_16x16x32_bf16 v[124:127], a[108:111], a[16:19], 0
v_cvt_pk_bf16_f32 v241, v242, v243
v_cvt_pk_bf16_f32 v242, v244, v245
v_cvt_pk_bf16_f32 v243, v246, v247
v_mfma_f32_16x16x32_bf16 v[124:127], a[104:107], a[0:3], v[124:127]
s_waitcnt lgkmcnt(4)
v_accvgpr_write_b32 a116, v240
v_accvgpr_write_b32 a117, v241
v_mfma_f32_16x16x32_bf16 v[152:155], a[80:83], a[0:3], 0
ds_read_b64_tr_b16 a[104:105], v15 offset:4096
s_add_u32 m0, s16, 0x9400
v_mfma_f32_16x16x32_bf16 v[152:155], a[84:87], a[16:19], v[152:155]
buffer_load_dwordx4 v23, s[44:47], s22 offen lds
v_accvgpr_write_b32 a118, v242
v_mfma_f32_16x16x32_bf16 v[160:163], a[84:87], a[20:23], 0
ds_read_b64_tr_b16 a[106:107], v15 offset:4352
v_accvgpr_write_b32 a119, v243
v_mfma_f32_16x16x32_bf16 v[160:163], a[80:83], a[4:7], v[160:163]
ds_read_b64_tr_b16 a[108:109], v15 offset:6144
v_cvt_pk_bf16_f32 v248, v248, v249
v_mfma_f32_16x16x32_bf16 v[168:171], a[80:83], a[8:11], 0
ds_read_b64_tr_b16 a[110:111], v15 offset:6400
v_cvt_pk_bf16_f32 v249, v250, v251
v_cvt_pk_bf16_f32 v250, v252, v253
v_mfma_f32_16x16x32_bf16 v[168:171], a[84:87], a[24:27], v[168:171]
v_cvt_pk_bf16_f32 v251, v254, v255
v_accvgpr_write_b32 a124, v248
v_mfma_f32_16x16x32_bf16 v[176:179], a[84:87], a[28:31], 0
s_add_u32 m0, s16, 0x9800
v_accvgpr_write_b32 a125, v249
v_accvgpr_write_b32 a126, v250
v_mfma_f32_16x16x32_bf16 v[176:179], a[80:83], a[12:15], v[176:179]
buffer_load_dwordx4 v22, s[44:47], s23 offen lds
v_accvgpr_write_b32 a127, v251
v_mfma_f32_16x16x32_bf16 v[180:183], a[88:91], a[12:15], 0
ds_read_b64_tr_b16 a[80:81], v14 offset:8192
v_accvgpr_read_b32 v2, a232
v_mfma_f32_16x16x32_bf16 v[180:183], a[92:95], a[28:31], v[180:183]
ds_read_b64_tr_b16 a[82:83], v14 offset:8448
v_accvgpr_read_b32 v3, a233
v_mfma_f32_16x16x32_bf16 v[172:175], a[92:95], a[24:27], 0
ds_read_b64_tr_b16 a[84:85], v14 offset:10240
v_cvt_pk_bf16_f32 v2, v2, v3
v_accvgpr_write_b32 a232, v2
v_mfma_f32_16x16x32_bf16 v[172:175], a[88:91], a[8:11], v[172:175]
ds_read_b64_tr_b16 a[86:87], v14 offset:10496
s_add_u32 m0, s16, 0x9c00
v_mfma_f32_16x16x32_bf16 v[164:167], a[88:91], a[4:7], 0
buffer_load_dwordx4 v23, s[44:47], s23 offen lds
v_mfma_f32_16x16x32_bf16 v[164:167], a[92:95], a[20:23], v[164:167]
v_lshl_add_u32 v22, s42, 7, v22
v_lshl_add_u32 v23, s42, 7, v23
v_accvgpr_read_b32 v2, a234
v_mfma_f32_16x16x32_bf16 v[156:159], a[92:95], a[16:19], 0
v_accvgpr_read_b32 v3, a235
v_cvt_pk_bf16_f32 v2, v2, v3
v_mfma_f32_16x16x32_bf16 v[156:159], a[88:91], a[0:3], v[156:159]
s_waitcnt lgkmcnt(4)
v_accvgpr_write_b32 a233, v2
v_accvgpr_read_b32 v2, a236
v_mfma_f32_16x16x32_bf16 v[184:187], a[96:99], a[0:3], 0
ds_read_b64_tr_b16 a[88:89], v15 offset:8192
v_accvgpr_read_b32 v3, a237
v_cvt_pk_bf16_f32 v2, v2, v3
v_mfma_f32_16x16x32_bf16 v[184:187], a[100:103], a[16:19], v[184:187]
ds_read_b64_tr_b16 a[90:91], v15 offset:8448
s_add_u32 s8, s28, 0x6000
v_mfma_f32_16x16x32_bf16 v[192:195], a[100:103], a[20:23], 0
buffer_store_dwordx4 a[136:139], v16, s[88:91], s8 offen sc1
v_mfma_f32_16x16x32_bf16 v[192:195], a[96:99], a[4:7], v[192:195]
ds_read_b64_tr_b16 a[92:93], v15 offset:10240
v_accvgpr_write_b32 a234, v2
v_accvgpr_read_b32 v2, a238
v_mfma_f32_16x16x32_bf16 v[200:203], a[96:99], a[8:11], 0
ds_read_b64_tr_b16 a[94:95], v15 offset:10496
v_add_u32 v12, 0xffff0000, v12
v_mfma_f32_16x16x32_bf16 v[200:203], a[100:103], a[24:27], v[200:203]
v_add_u32 v13, 0xffff0000, v13
v_add_u32 v14, 0xffff0000, v14
v_mfma_f32_16x16x32_bf16 v[208:211], a[100:103], a[28:31], 0
v_add_u32 v15, 0xffff0000, v15
v_accvgpr_read_b32 v3, a239
v_cvt_pk_bf16_f32 v2, v2, v3
v_mfma_f32_16x16x32_bf16 v[208:211], a[96:99], a[12:15], v[208:211]
v_accvgpr_write_b32 a235, v2
v_accvgpr_read_b32 v2, a240
v_mfma_f32_16x16x32_bf16 v[212:215], a[104:107], a[12:15], 0
s_waitcnt vmcnt(28) lgkmcnt(0)
v_accvgpr_read_b32 v3, a241
v_cvt_pk_bf16_f32 v2, v2, v3
v_mfma_f32_16x16x32_bf16 v[212:215], a[108:111], a[28:31], v[212:215]
s_barrier
s_add_u32 m0, s17, 0x10000
v_accvgpr_write_b32 a240, v2
v_accvgpr_read_b32 v2, a242
v_mfma_f32_16x16x32_bf16 v[204:207], a[108:111], a[24:27], 0
buffer_load_dwordx4 v5, s[52:55], 0 offen lds
v_mfma_f32_16x16x32_bf16 v[204:207], a[104:107], a[8:11], v[204:207]
ds_read_b64_tr_b16 a[96:97], v12 offset:0
v_accvgpr_read_b32 v3, a243
v_mfma_f32_16x16x32_bf16 v[196:199], a[104:107], a[4:7], 0
ds_read_b64_tr_b16 a[98:99], v12 offset:1024
v_cvt_pk_bf16_f32 v2, v2, v3
v_accvgpr_write_b32 a241, v2
v_mfma_f32_16x16x32_bf16 v[196:199], a[108:111], a[20:23], v[196:199]
ds_read_b64_tr_b16 a[100:101], v12 offset:8192
v_accvgpr_read_b32 v2, a244
v_mfma_f32_16x16x32_bf16 v[188:191], a[108:111], a[16:19], 0
ds_read_b64_tr_b16 a[102:103], v12 offset:9216
v_accvgpr_read_b32 v3, a245
v_mfma_f32_16x16x32_bf16 v[188:191], a[104:107], a[0:3], v[188:191]
s_add_u32 m0, s17, 0x10400
s_waitcnt lgkmcnt(4)
v_cvt_pk_bf16_f32 v2, v2, v3
v_accvgpr_write_b32 a242, v2
v_mfma_f32_16x16x32_bf16 v[216:219], a[0:3], a[80:83], 0
buffer_load_dwordx4 v5, s[52:55], s13 offen lds
v_mfma_f32_16x16x32_bf16 v[216:219], a[16:19], a[84:87], v[216:219]
ds_read_b64_tr_b16 a[104:105], v13 offset:0
v_accvgpr_read_b32 v2, a246
v_mfma_f32_16x16x32_bf16 v[224:227], a[20:23], a[84:87], 0
ds_read_b64_tr_b16 a[106:107], v13 offset:1024
v_accvgpr_read_b32 v3, a247
v_cvt_pk_bf16_f32 v2, v2, v3
v_mfma_f32_16x16x32_bf16 v[224:227], a[4:7], a[80:83], v[224:227]
ds_read_b64_tr_b16 a[108:109], v13 offset:8192
v_accvgpr_write_b32 a243, v2
v_mfma_f32_16x16x32_bf16 v[232:235], a[8:11], a[80:83], 0
ds_read_b64_tr_b16 a[110:111], v13 offset:9216
v_accvgpr_read_b32 v2, a248
v_mfma_f32_16x16x32_bf16 v[232:235], a[24:27], a[84:87], v[232:235]
v_accvgpr_read_b32 v3, a249
v_cvt_pk_bf16_f32 v2, v2, v3
v_accvgpr_write_b32 a248, v2
v_mfma_f32_16x16x32_bf16 v[240:243], a[28:31], a[84:87], 0
s_add_u32 m0, s17, 0x10800
v_accvgpr_read_b32 v2, a250
v_accvgpr_read_b32 v3, a251
v_mfma_f32_16x16x32_bf16 v[240:243], a[12:15], a[80:83], v[240:243]
buffer_load_dwordx4 v6, s[52:55], 0 offen lds
v_mfma_f32_16x16x32_bf16 v[244:247], a[12:15], a[88:91], 0
ds_read_b64_tr_b16 a[80:81], v12 offset:256
v_cvt_pk_bf16_f32 v2, v2, v3
v_accvgpr_write_b32 a249, v2
v_mfma_f32_16x16x32_bf16 v[244:247], a[28:31], a[92:95], v[244:247]
ds_read_b64_tr_b16 a[82:83], v12 offset:1280
v_accvgpr_read_b32 v2, a252
v_mfma_f32_16x16x32_bf16 v[236:239], a[24:27], a[92:95], 0
ds_read_b64_tr_b16 a[84:85], v12 offset:8448
v_accvgpr_read_b32 v3, a253
v_mfma_f32_16x16x32_bf16 v[236:239], a[8:11], a[88:91], v[236:239]
ds_read_b64_tr_b16 a[86:87], v12 offset:9472
v_cvt_pk_bf16_f32 v2, v2, v3
v_accvgpr_write_b32 a250, v2
v_mfma_f32_16x16x32_bf16 v[228:231], a[4:7], a[88:91], 0
v_accvgpr_read_b32 v2, a254
v_accvgpr_read_b32 v3, a255
v_mfma_f32_16x16x32_bf16 v[228:231], a[20:23], a[92:95], v[228:231]
s_add_u32 m0, s17, 0x10c00
v_cvt_pk_bf16_f32 v2, v2, v3
v_accvgpr_write_b32 a251, v2
v_mfma_f32_16x16x32_bf16 v[220:223], a[16:19], a[92:95], 0
buffer_load_dwordx4 v6, s[52:55], s13 offen lds
v_mfma_f32_16x16x32_bf16 v[220:223], a[0:3], a[88:91], v[220:223]
s_waitcnt lgkmcnt(4)
L_S9:
v_mfma_f32_16x16x32_bf16 v[24:27], a[96:99], a[32:35], v[24:27]
ds_read_b64_tr_b16 a[88:89], v13 offset:256
s_waitcnt vmcnt(23)
v_mfma_f32_16x16x32_bf16 v[24:27], a[100:103], a[48:51], v[24:27]
ds_read_b64_tr_b16 a[90:91], v13 offset:1280
L_padA5:
s_cmp_eq_u32 s95, 1
s_cbranch_scc1 L_padA9
v_mfma_f32_16x16x32_bf16 v[32:35], a[100:103], a[52:55], v[32:35]
ds_read_b64_tr_b16 a[92:93], v13 offset:8448
v_mfma_f32_16x16x32_bf16 v[32:35], a[96:99], a[36:39], v[32:35]
ds_read_b64_tr_b16 a[94:95], v13 offset:9472
v_mfma_f32_16x16x32_bf16 v[40:43], a[96:99], a[40:43], v[40:43]
ds_read_b128 a[0:3], v8 offset:0
s_add_u32 m0, s18, 0x14000
v_mfma_f32_16x16x32_bf16 v[40:43], a[100:103], a[56:59], v[40:43]
buffer_load_dwordx4 v7, s[68:71], 0 offen lds
v_mfma_f32_16x16x32_bf16 v[48:51], a[100:103], a[60:63], v[48:51]
ds_read_b128 a[16:19], v9 offset:0
v_mfma_f32_16x16x32_bf16 v[48:51], a[96:99], a[44:47], v[48:51]
ds_read_b128 a[4:7], v8 offset:2048
v_mfma_f32_16x16x32_bf16 v[52:55], a[104:107], a[44:47], v[52:55]
ds_read_b64_tr_b16 a[96:97], v12 offset:512
v_mfma_f32_16x16x32_bf16 v[52:55], a[108:111], a[60:63], v[52:55]
ds_read_b64_tr_b16 a[98:99], v12 offset:1536
v_mfma_f32_16x16x32_bf16 v[44:47], a[108:111], a[56:59], v[44:47]
ds_read_b64_tr_b16 a[100:101], v12 offset:8704
s_add_u32 s8, s28, 0x7000
v_mfma_f32_16x16x32_bf16 v[44:47], a[104:107], a[40:43], v[44:47]
buffer_store_dwordx4 a[140:143], v16, s[88:91], s8 offen sc1
v_mfma_f32_16x16x32_bf16 v[36:39], a[104:107], a[36:39], v[36:39]
ds_read_b64_tr_b16 a[102:103], v12 offset:9728
v_mfma_f32_16x16x32_bf16 v[36:39], a[108:111], a[52:55], v[36:39]
ds_read_b128 a[20:23], v9 offset:2048
v_mfma_f32_16x16x32_bf16 v[28:31], a[108:111], a[48:51], v[28:31]
ds_read_b128 a[8:11], v8 offset:4096
v_mfma_f32_16x16x32_bf16 v[28:31], a[104:107], a[32:35], v[28:31]
ds_read_b128 a[24:27], v9 offset:4096
s_waitcnt lgkmcnt(10)
v_mfma_f32_16x16x32_bf16 v[56:59], a[80:83], a[32:35], v[56:59]
ds_read_b64_tr_b16 a[104:105], v13 offset:512
v_mfma_f32_16x16x32_bf16 v[56:59], a[84:87], a[48:51], v[56:59]
ds_read_b64_tr_b16 a[106:107], v13 offset:1536
s_add_u32 m0, s18, 0x15000
v_mfma_f32_16x16x32_bf16 v[64:67], a[84:87], a[52:55], v[64:67]
buffer_load_dwordx4 v7, s[68:71], s25 offen lds
v_mfma_f32_16x16x32_bf16 v[64:67], a[80:83], a[36:39], v[64:67]
ds_read_b64_tr_b16 a[108:109], v13 offset:8704
v_mfma_f32_16x16x32_bf16 v[72:75], a[80:83], a[40:43], v[72:75]
ds_read_b64_tr_b16 a[110:111], v13 offset:9728
v_mfma_f32_16x16x32_bf16 v[72:75], a[84:87], a[56:59], v[72:75]
ds_read_b128 a[12:15], v8 offset:6144
v_mfma_f32_16x16x32_bf16 v[80:83], a[84:87], a[60:63], v[80:83]
ds_read_b128 a[28:31], v9 offset:6144
v_mfma_f32_16x16x32_bf16 v[80:83], a[80:83], a[44:47], v[80:83]
v_mfma_f32_16x16x32_bf16 v[84:87], a[88:91], a[44:47], v[84:87]
ds_read_b64_tr_b16 a[80:81], v12 offset:768
s_add_u32 m0, s18, 0x16000
v_mfma_f32_16x16x32_bf16 v[84:87], a[92:95], a[60:63], v[84:87]
buffer_load_dwordx4 v7, s[68:71], s26 offen lds
v_mfma_f32_16x16x32_bf16 v[76:79], a[92:95], a[56:59], v[76:79]
ds_read_b64_tr_b16 a[82:83], v12 offset:1792
v_lshl_add_u32 v5, s42, 19, v5
v_mfma_f32_16x16x32_bf16 v[76:79], a[88:91], a[40:43], v[76:79]
ds_read_b64_tr_b16 a[84:85], v12 offset:8960
v_lshl_add_u32 v6, s42, 19, v6
v_mfma_f32_16x16x32_bf16 v[68:71], a[88:91], a[36:39], v[68:71]
ds_read_b64_tr_b16 a[86:87], v12 offset:9984
v_lshl_add_u32 v7, s42, 18, v7
v_mfma_f32_16x16x32_bf16 v[68:71], a[92:95], a[52:55], v[68:71]
v_lshl_add_u32 v7, s42, 17, v7
v_mfma_f32_16x16x32_bf16 v[60:63], a[92:95], a[48:51], v[60:63]
v_mfma_f32_16x16x32_bf16 v[60:63], a[88:91], a[32:35], v[60:63]
s_add_u32 m0, s16, 0x0
s_waitcnt lgkmcnt(4)
s_waitcnt lgkmcnt(6)
v_mfma_f32_16x16x32_bf16 v[88:91], a[96:99], a[32:35], v[88:91]
buffer_load_dwordx4 v22, s[44:47], s20 offen lds
v_mfma_f32_16x16x32_bf16 v[88:91], a[100:103], a[48:51], v[88:91]
ds_read_b64_tr_b16 a[88:89], v13 offset:768
v_mfma_f32_16x16x32_bf16 v[96:99], a[100:103], a[52:55], v[96:99]
ds_read_b64_tr_b16 a[90:91], v13 offset:1792
v_mfma_f32_16x16x32_bf16 v[96:99], a[96:99], a[36:39], v[96:99]
ds_read_b64_tr_b16 a[92:93], v13 offset:8960
v_mfma_f32_16x16x32_bf16 v[104:107], a[96:99], a[40:43], v[104:107]
ds_read_b64_tr_b16 a[94:95], v13 offset:9984
s_add_u32 m0, s16, 0x400
v_mfma_f32_16x16x32_bf16 v[104:107], a[100:103], a[56:59], v[104:107]
buffer_load_dwordx4 v23, s[44:47], s20 offen lds
v_mfma_f32_16x16x32_bf16 v[112:115], a[100:103], a[60:63], v[112:115]
v_mfma_f32_16x16x32_bf16 v[112:115], a[96:99], a[44:47], v[112:115]
v_mfma_f32_16x16x32_bf16 v[116:119], a[104:107], a[44:47], v[116:119]
ds_read_b64_tr_b16 a[96:97], v14 offset:0
v_mfma_f32_16x16x32_bf16 v[116:119], a[108:111], a[60:63], v[116:119]
ds_read_b64_tr_b16 a[98:99], v14 offset:256
v_mfma_f32_16x16x32_bf16 v[108:111], a[108:111], a[56:59], v[108:111]
ds_read_b64_tr_b16 a[100:101], v14 offset:2048
s_add_u32 m0, s16, 0x800
v_mfma_f32_16x16x32_bf16 v[108:111], a[104:107], a[40:43], v[108:111]
buffer_load_dwordx4 v22, s[44:47], s21 offen lds
v_mfma_f32_16x16x32_bf16 v[100:103], a[104:107], a[36:39], v[100:103]
ds_read_b64_tr_b16 a[102:103], v14 offset:2304
v_mfma_f32_16x16x32_bf16 v[100:103], a[108:111], a[52:55], v[100:103]
v_mfma_f32_16x16x32_bf16 v[92:95], a[108:111], a[48:51], v[92:95]
v_mfma_f32_16x16x32_bf16 v[92:95], a[104:107], a[32:35], v[92:95]
s_add_u32 s8, s28, 0x2400
s_waitcnt lgkmcnt(4)
v_mfma_f32_16x16x32_bf16 v[120:123], a[80:83], a[32:35], v[120:123]
buffer_store_dwordx4 a[144:147], v16, s[88:91], s8 offen sc1
v_mfma_f32_16x16x32_bf16 v[120:123], a[84:87], a[48:51], v[120:123]
ds_read_b64_tr_b16 a[104:105], v15 offset:0
v_mfma_f32_16x16x32_bf16 v[128:131], a[84:87], a[52:55], v[128:131]
ds_read_b64_tr_b16 a[106:107], v15 offset:256
v_mfma_f32_16x16x32_bf16 v[128:131], a[80:83], a[36:39], v[128:131]
ds_read_b64_tr_b16 a[108:109], v15 offset:2048
v_mfma_f32_16x16x32_bf16 v[136:139], a[80:83], a[40:43], v[136:139]
ds_read_b64_tr_b16 a[110:111], v15 offset:2304
v_mfma_f32_16x16x32_bf16 v[136:139], a[84:87], a[56:59], v[136:139]
s_add_u32 m0, s16, 0xc00
v_mfma_f32_16x16x32_bf16 v[144:147], a[84:87], a[60:63], v[144:147]
buffer_load_dwordx4 v23, s[44:47], s21 offen lds
v_mfma_f32_16x16x32_bf16 v[144:147], a[80:83], a[44:47], v[144:147]
v_mfma_f32_16x16x32_bf16 v[148:151], a[88:91], a[44:47], v[148:151]
ds_read_b64_tr_b16 a[80:81], v14 offset:4096
v_mfma_f32_16x16x32_bf16 v[148:151], a[92:95], a[60:63], v[148:151]
ds_read_b64_tr_b16 a[82:83], v14 offset:4352
v_mfma_f32_16x16x32_bf16 v[140:143], a[92:95], a[56:59], v[140:143]
ds_read_b64_tr_b16 a[84:85], v14 offset:6144
v_mfma_f32_16x16x32_bf16 v[140:143], a[88:91], a[40:43], v[140:143]
ds_read_b64_tr_b16 a[86:87], v14 offset:6400
s_add_u32 m0, s16, 0x1000
v_mfma_f32_16x16x32_bf16 v[132:135], a[88:91], a[36:39], v[132:135]
buffer_load_dwordx4 v22, s[44:47], s22 offen lds
v_mfma_f32_16x16x32_bf16 v[132:135], a[92:95], a[52:55], v[132:135]
v_mfma_f32_16x16x32_bf16 v[124:127], a[92:95], a[48:51], v[124:127]
v_mfma_f32_16x16x32_bf16 v[124:127], a[88:91], a[32:35], v[124:127]
s_waitcnt lgkmcnt(4)
v_mfma_f32_16x16x32_bf16 v[152:155], a[96:99], a[32:35], v[152:155]
ds_read_b64_tr_b16 a[88:89], v15 offset:4096
s_add_u32 m0, s16, 0x1400
v_mfma_f32_16x16x32_bf16 v[152:155], a[100:103], a[48:51], v[152:155]
buffer_load_dwordx4 v23, s[44:47], s22 offen lds
v_mfma_f32_16x16x32_bf16 v[160:163], a[100:103], a[52:55], v[160:163]
ds_read_b64_tr_b16 a[90:91], v15 offset:4352
v_mfma_f32_16x16x32_bf16 v[160:163], a[96:99], a[36:39], v[160:163]
ds_read_b64_tr_b16 a[92:93], v15 offset:6144
v_mfma_f32_16x16x32_bf16 v[168:171], a[96:99], a[40:43], v[168:171]
ds_read_b64_tr_b16 a[94:95], v15 offset:6400
v_mfma_f32_16x16x32_bf16 v[168:171], a[100:103], a[56:59], v[168:171]
v_mfma_f32_16x16x32_bf16 v[176:179], a[100:103], a[60:63], v[176:179]
s_add_u32 m0, s16, 0x1800
v_mfma_f32_16x16x32_bf16 v[176:179], a[96:99], a[44:47], v[176:179]
buffer_load_dwordx4 v22, s[44:47], s23 offen lds
v_mfma_f32_16x16x32_bf16 v[180:183], a[104:107], a[44:47], v[180:183]
ds_read_b64_tr_b16 a[96:97], v14 offset:8192
v_mfma_f32_16x16x32_bf16 v[180:183], a[108:111], a[60:63], v[180:183]
ds_read_b64_tr_b16 a[98:99], v14 offset:8448
v_mfma_f32_16x16x32_bf16 v[172:175], a[108:111], a[56:59], v[172:175]
ds_read_b64_tr_b16 a[100:101], v14 offset:10240
v_mfma_f32_16x16x32_bf16 v[172:175], a[104:107], a[40:43], v[172:175]
ds_read_b64_tr_b16 a[102:103], v14 offset:10496
s_add_u32 m0, s16, 0x1c00
v_mfma_f32_16x16x32_bf16 v[164:167], a[104:107], a[36:39], v[164:167]
buffer_load_dwordx4 v23, s[44:47], s23 offen lds
v_mfma_f32_16x16x32_bf16 v[164:167], a[108:111], a[52:55], v[164:167]
v_lshl_add_u32 v22, s42, 7, v22
v_lshl_add_u32 v23, s42, 7, v23
v_mfma_f32_16x16x32_bf16 v[156:159], a[108:111], a[48:51], v[156:159]
v_mfma_f32_16x16x32_bf16 v[156:159], a[104:107], a[32:35], v[156:159]
s_waitcnt lgkmcnt(4)
v_mfma_f32_16x16x32_bf16 v[184:187], a[80:83], a[32:35], v[184:187]
ds_read_b64_tr_b16 a[104:105], v15 offset:8192
v_mfma_f32_16x16x32_bf16 v[184:187], a[84:87], a[48:51], v[184:187]
ds_read_b64_tr_b16 a[106:107], v15 offset:8448
s_add_u32 s8, s28, 0x3400
v_mfma_f32_16x16x32_bf16 v[192:195], a[84:87], a[52:55], v[192:195]
buffer_store_dwordx4 a[148:151], v16, s[88:91], s8 offen sc1
v_mfma_f32_16x16x32_bf16 v[192:195], a[80:83], a[36:39], v[192:195]
ds_read_b64_tr_b16 a[108:109], v15 offset:10240
v_mfma_f32_16x16x32_bf16 v[200:203], a[80:83], a[40:43], v[200:203]
ds_read_b64_tr_b16 a[110:111], v15 offset:10496
v_add_u32 v12, 0x8000, v12
v_mfma_f32_16x16x32_bf16 v[200:203], a[84:87], a[56:59], v[200:203]
v_add_u32 v13, 0x8000, v13
v_add_u32 v14, 0x8000, v14
v_mfma_f32_16x16x32_bf16 v[208:211], a[84:87], a[60:63], v[208:211]
v_add_u32 v15, 0x8000, v15
v_mfma_f32_16x16x32_bf16 v[208:211], a[80:83], a[44:47], v[208:211]
v_mfma_f32_16x16x32_bf16 v[212:215], a[88:91], a[44:47], v[212:215]
s_waitcnt vmcnt(28) lgkmcnt(0)
v_mfma_f32_16x16x32_bf16 v[212:215], a[92:95], a[60:63], v[212:215]
s_barrier
s_add_u32 m0, s17, 0x0
v_mfma_f32_16x16x32_bf16 v[204:207], a[92:95], a[56:59], v[204:207]
buffer_load_dwordx4 v5, s[52:55], 0 offen lds
v_mfma_f32_16x16x32_bf16 v[204:207], a[88:91], a[40:43], v[204:207]
ds_read_b64_tr_b16 a[80:81], v12 offset:0
v_mfma_f32_16x16x32_bf16 v[196:199], a[88:91], a[36:39], v[196:199]
ds_read_b64_tr_b16 a[82:83], v12 offset:1024
v_mfma_f32_16x16x32_bf16 v[196:199], a[92:95], a[52:55], v[196:199]
ds_read_b64_tr_b16 a[84:85], v12 offset:8192
v_mfma_f32_16x16x32_bf16 v[188:191], a[92:95], a[48:51], v[188:191]
ds_read_b64_tr_b16 a[86:87], v12 offset:9216
v_mfma_f32_16x16x32_bf16 v[188:191], a[88:91], a[32:35], v[188:191]
s_add_u32 m0, s17, 0x400
s_waitcnt lgkmcnt(4)
v_mfma_f32_16x16x32_bf16 v[216:219], a[32:35], a[96:99], v[216:219]
buffer_load_dwordx4 v5, s[52:55], s13 offen lds
v_mfma_f32_16x16x32_bf16 v[216:219], a[48:51], a[100:103], v[216:219]
ds_read_b64_tr_b16 a[88:89], v13 offset:0
v_mfma_f32_16x16x32_bf16 v[224:227], a[52:55], a[100:103], v[224:227]
ds_read_b64_tr_b16 a[90:91], v13 offset:1024
v_mfma_f32_16x16x32_bf16 v[224:227], a[36:39], a[96:99], v[224:227]
ds_read_b64_tr_b16 a[92:93], v13 offset:8192
v_mfma_f32_16x16x32_bf16 v[232:235], a[40:43], a[96:99], v[232:235]
ds_read_b64_tr_b16 a[94:95], v13 offset:9216
v_mfma_f32_16x16x32_bf16 v[232:235], a[56:59], a[100:103], v[232:235]
v_mfma_f32_16x16x32_bf16 v[240:243], a[60:63], a[100:103], v[240:243]
s_add_u32 m0, s17, 0x800
v_mfma_f32_16x16x32_bf16 v[240:243], a[44:47], a[96:99], v[240:243]
buffer_load_dwordx4 v6, s[52:55], 0 offen lds
v_mfma_f32_16x16x32_bf16 v[244:247], a[44:47], a[104:107], v[244:247]
ds_read_b64_tr_b16 a[96:97], v12 offset:256
v_mfma_f32_16x16x32_bf16 v[244:247], a[60:63], a[108:111], v[244:247]
ds_read_b64_tr_b16 a[98:99], v12 offset:1280
v_mfma_f32_16x16x32_bf16 v[236:239], a[56:59], a[108:111], v[236:239]
ds_read_b64_tr_b16 a[100:101], v12 offset:8448
v_mfma_f32_16x16x32_bf16 v[236:239], a[40:43], a[104:107], v[236:239]
ds_read_b64_tr_b16 a[102:103], v12 offset:9472
v_mfma_f32_16x16x32_bf16 v[228:231], a[36:39], a[104:107], v[228:231]
v_mfma_f32_16x16x32_bf16 v[228:231], a[52:55], a[108:111], v[228:231]
s_add_u32 m0, s17, 0xc00
v_mfma_f32_16x16x32_bf16 v[220:223], a[48:51], a[108:111], v[220:223]
buffer_load_dwordx4 v6, s[52:55], s13 offen lds
v_mfma_f32_16x16x32_bf16 v[220:223], a[32:35], a[104:107], v[220:223]
s_waitcnt lgkmcnt(4)
L_S10:
v_mfma_f32_16x16x32_bf16 v[24:27], a[80:83], a[0:3], v[24:27]
ds_read_b64_tr_b16 a[104:105], v13 offset:256
s_waitcnt vmcnt(23)
v_mfma_f32_16x16x32_bf16 v[24:27], a[84:87], a[16:19], v[24:27]
ds_read_b64_tr_b16 a[106:107], v13 offset:1280
v_mfma_f32_16x16x32_bf16 v[32:35], a[84:87], a[20:23], v[32:35]
ds_read_b64_tr_b16 a[108:109], v13 offset:8448
v_mfma_f32_16x16x32_bf16 v[32:35], a[80:83], a[4:7], v[32:35]
ds_read_b64_tr_b16 a[110:111], v13 offset:9472
v_mfma_f32_16x16x32_bf16 v[40:43], a[80:83], a[8:11], v[40:43]
ds_read_b128 a[32:35], v8 offset:32768
s_add_u32 m0, s18, 0x4000
v_mfma_f32_16x16x32_bf16 v[40:43], a[84:87], a[24:27], v[40:43]
buffer_load_dwordx4 v7, s[68:71], 0 offen lds
v_mfma_f32_16x16x32_bf16 v[48:51], a[84:87], a[28:31], v[48:51]
ds_read_b128 a[48:51], v9 offset:32768
v_mfma_f32_16x16x32_bf16 v[48:51], a[80:83], a[12:15], v[48:51]
ds_read_b128 a[36:39], v8 offset:34816
v_mfma_f32_16x16x32_bf16 v[52:55], a[88:91], a[12:15], v[52:55]
ds_read_b64_tr_b16 a[80:81], v12 offset:512
v_mfma_f32_16x16x32_bf16 v[52:55], a[92:95], a[28:31], v[52:55]
ds_read_b64_tr_b16 a[82:83], v12 offset:1536
v_mfma_f32_16x16x32_bf16 v[44:47], a[92:95], a[24:27], v[44:47]
ds_read_b64_tr_b16 a[84:85], v12 offset:8704
s_add_u32 s8, s28, 0x6400
v_mfma_f32_16x16x32_bf16 v[44:47], a[88:91], a[8:11], v[44:47]
buffer_store_dwordx4 a[152:155], v16, s[88:91], s8 offen sc1
v_mfma_f32_16x16x32_bf16 v[36:39], a[88:91], a[4:7], v[36:39]
ds_read_b64_tr_b16 a[86:87], v12 offset:9728
v_mfma_f32_16x16x32_bf16 v[36:39], a[92:95], a[20:23], v[36:39]
ds_read_b128 a[52:55], v9 offset:34816
v_mfma_f32_16x16x32_bf16 v[28:31], a[92:95], a[16:19], v[28:31]
ds_read_b128 a[40:43], v8 offset:36864
v_mfma_f32_16x16x32_bf16 v[28:31], a[88:91], a[0:3], v[28:31]
ds_read_b128 a[56:59], v9 offset:36864
s_waitcnt lgkmcnt(10)
v_mfma_f32_16x16x32_bf16 v[56:59], a[96:99], a[0:3], v[56:59]
ds_read_b64_tr_b16 a[88:89], v13 offset:512
v_mfma_f32_16x16x32_bf16 v[56:59], a[100:103], a[16:19], v[56:59]
ds_read_b64_tr_b16 a[90:91], v13 offset:1536
s_add_u32 m0, s18, 0x5000
v_mfma_f32_16x16x32_bf16 v[64:67], a[100:103], a[20:23], v[64:67]
buffer_load_dwordx4 v7, s[68:71], s25 offen lds
v_mfma_f32_16x16x32_bf16 v[64:67], a[96:99], a[4:7], v[64:67]
ds_read_b64_tr_b16 a[92:93], v13 offset:8704
v_mfma_f32_16x16x32_bf16 v[72:75], a[96:99], a[8:11], v[72:75]
ds_read_b64_tr_b16 a[94:95], v13 offset:9728
v_mfma_f32_16x16x32_bf16 v[72:75], a[100:103], a[24:27], v[72:75]
ds_read_b128 a[44:47], v8 offset:38912
v_mfma_f32_16x16x32_bf16 v[80:83], a[100:103], a[28:31], v[80:83]
ds_read_b128 a[60:63], v9 offset:38912
v_mfma_f32_16x16x32_bf16 v[80:83], a[96:99], a[12:15], v[80:83]
v_mfma_f32_16x16x32_bf16 v[84:87], a[104:107], a[12:15], v[84:87]
ds_read_b64_tr_b16 a[96:97], v12 offset:768
s_add_u32 m0, s18, 0x6000
v_mfma_f32_16x16x32_bf16 v[84:87], a[108:111], a[28:31], v[84:87]
buffer_load_dwordx4 v7, s[68:71], s26 offen lds
v_mfma_f32_16x16x32_bf16 v[76:79], a[108:111], a[24:27], v[76:79]
ds_read_b64_tr_b16 a[98:99], v12 offset:1792
v_lshl_add_u32 v5, s42, 19, v5
v_mfma_f32_16x16x32_bf16 v[76:79], a[104:107], a[8:11], v[76:79]
ds_read_b64_tr_b16 a[100:101], v12 offset:8960
v_lshl_add_u32 v6, s42, 19, v6
v_mfma_f32_16x16x32_bf16 v[68:71], a[104:107], a[4:7], v[68:71]
ds_read_b64_tr_b16 a[102:103], v12 offset:9984
v_lshl_add_u32 v7, s42, 18, v7
v_mfma_f32_16x16x32_bf16 v[68:71], a[108:111], a[20:23], v[68:71]
v_lshl_add_u32 v7, s42, 17, v7
v_mfma_f32_16x16x32_bf16 v[60:63], a[108:111], a[16:19], v[60:63]
v_mfma_f32_16x16x32_bf16 v[60:63], a[104:107], a[0:3], v[60:63]
s_add_u32 m0, s16, 0x8000
s_waitcnt lgkmcnt(4)
s_waitcnt lgkmcnt(6)
v_mfma_f32_16x16x32_bf16 v[88:91], a[80:83], a[0:3], v[88:91]
buffer_load_dwordx4 v22, s[44:47], s20 offen lds
v_mfma_f32_16x16x32_bf16 v[88:91], a[84:87], a[16:19], v[88:91]
ds_read_b64_tr_b16 a[104:105], v13 offset:768
v_mfma_f32_16x16x32_bf16 v[96:99], a[84:87], a[20:23], v[96:99]
ds_read_b64_tr_b16 a[106:107], v13 offset:1792
v_mfma_f32_16x16x32_bf16 v[96:99], a[80:83], a[4:7], v[96:99]
ds_read_b64_tr_b16 a[108:109], v13 offset:8960
v_mfma_f32_16x16x32_bf16 v[104:107], a[80:83], a[8:11], v[104:107]
ds_read_b64_tr_b16 a[110:111], v13 offset:9984
s_add_u32 m0, s16, 0x8400
v_mfma_f32_16x16x32_bf16 v[104:107], a[84:87], a[24:27], v[104:107]
buffer_load_dwordx4 v23, s[44:47], s20 offen lds
v_mfma_f32_16x16x32_bf16 v[112:115], a[84:87], a[28:31], v[112:115]
v_mfma_f32_16x16x32_bf16 v[112:115], a[80:83], a[12:15], v[112:115]
v_mfma_f32_16x16x32_bf16 v[116:119], a[88:91], a[12:15], v[116:119]
ds_read_b64_tr_b16 a[80:81], v14 offset:0
v_mfma_f32_16x16x32_bf16 v[116:119], a[92:95], a[28:31], v[116:119]
ds_read_b64_tr_b16 a[82:83], v14 offset:256
v_mfma_f32_16x16x32_bf16 v[108:111], a[92:95], a[24:27], v[108:111]
ds_read_b64_tr_b16 a[84:85], v14 offset:2048
s_add_u32 m0, s16, 0x8800
v_mfma_f32_16x16x32_bf16 v[108:111], a[88:91], a[8:11], v[108:111]
buffer_load_dwordx4 v22, s[44:47], s21 offen lds
v_mfma_f32_16x16x32_bf16 v[100:103], a[88:91], a[4:7], v[100:103]
ds_read_b64_tr_b16 a[86:87], v14 offset:2304
v_mfma_f32_16x16x32_bf16 v[100:103], a[92:95], a[20:23], v[100:103]
v_mfma_f32_16x16x32_bf16 v[92:95], a[92:95], a[16:19], v[92:95]
v_mfma_f32_16x16x32_bf16 v[92:95], a[88:91], a[0:3], v[92:95]
s_add_u32 s8, s28, 0x7400
s_waitcnt lgkmcnt(4)
v_mfma_f32_16x16x32_bf16 v[120:123], a[96:99], a[0:3], v[120:123]
buffer_store_dwordx4 a[156:159], v16, s[88:91], s8 offen sc1
v_mfma_f32_16x16x32_bf16 v[120:123], a[100:103], a[16:19], v[120:123]
ds_read_b64_tr_b16 a[88:89], v15 offset:0
v_mfma_f32_16x16x32_bf16 v[128:131], a[100:103], a[20:23], v[128:131]
ds_read_b64_tr_b16 a[90:91], v15 offset:256
v_mfma_f32_16x16x32_bf16 v[128:131], a[96:99], a[4:7], v[128:131]
ds_read_b64_tr_b16 a[92:93], v15 offset:2048
v_mfma_f32_16x16x32_bf16 v[136:139], a[96:99], a[8:11], v[136:139]
ds_read_b64_tr_b16 a[94:95], v15 offset:2304
v_mfma_f32_16x16x32_bf16 v[136:139], a[100:103], a[24:27], v[136:139]
s_add_u32 m0, s16, 0x8c00
v_mfma_f32_16x16x32_bf16 v[144:147], a[100:103], a[28:31], v[144:147]
buffer_load_dwordx4 v23, s[44:47], s21 offen lds
v_mfma_f32_16x16x32_bf16 v[144:147], a[96:99], a[12:15], v[144:147]
v_mfma_f32_16x16x32_bf16 v[148:151], a[104:107], a[12:15], v[148:151]
ds_read_b64_tr_b16 a[96:97], v14 offset:4096
v_mfma_f32_16x16x32_bf16 v[148:151], a[108:111], a[28:31], v[148:151]
ds_read_b64_tr_b16 a[98:99], v14 offset:4352
v_mfma_f32_16x16x32_bf16 v[140:143], a[108:111], a[24:27], v[140:143]
ds_read_b64_tr_b16 a[100:101], v14 offset:6144
v_mfma_f32_16x16x32_bf16 v[140:143], a[104:107], a[8:11], v[140:143]
ds_read_b64_tr_b16 a[102:103], v14 offset:6400
s_add_u32 m0, s16, 0x9000
v_mfma_f32_16x16x32_bf16 v[132:135], a[104:107], a[4:7], v[132:135]
buffer_load_dwordx4 v22, s[44:47], s22 offen lds
v_mfma_f32_16x16x32_bf16 v[132:135], a[108:111], a[20:23], v[132:135]
v_mfma_f32_16x16x32_bf16 v[124:127], a[108:111], a[16:19], v[124:127]
v_mfma_f32_16x16x32_bf16 v[124:127], a[104:107], a[0:3], v[124:127]
s_waitcnt lgkmcnt(4)
v_mfma_f32_16x16x32_bf16 v[152:155], a[80:83], a[0:3], v[152:155]
ds_read_b64_tr_b16 a[104:105], v15 offset:4096
s_add_u32 m0, s16, 0x9400
v_mfma_f32_16x16x32_bf16 v[152:155], a[84:87], a[16:19], v[152:155]
buffer_load_dwordx4 v23, s[44:47], s22 offen lds
v_mfma_f32_16x16x32_bf16 v[160:163], a[84:87], a[20:23], v[160:163]
ds_read_b64_tr_b16 a[106:107], v15 offset:4352
v_mfma_f32_16x16x32_bf16 v[160:163], a[80:83], a[4:7], v[160:163]
ds_read_b64_tr_b16 a[108:109], v15 offset:6144
v_mfma_f32_16x16x32_bf16 v[168:171], a[80:83], a[8:11], v[168:171]
ds_read_b64_tr_b16 a[110:111], v15 offset:6400
v_mfma_f32_16x16x32_bf16 v[168:171], a[84:87], a[24:27], v[168:171]
v_mfma_f32_16x16x32_bf16 v[176:179], a[84:87], a[28:31], v[176:179]
s_add_u32 m0, s16, 0x9800
v_mfma_f32_16x16x32_bf16 v[176:179], a[80:83], a[12:15], v[176:179]
buffer_load_dwordx4 v22, s[44:47], s23 offen lds
v_mfma_f32_16x16x32_bf16 v[180:183], a[88:91], a[12:15], v[180:183]
ds_read_b64_tr_b16 a[80:81], v14 offset:8192
v_mfma_f32_16x16x32_bf16 v[180:183], a[92:95], a[28:31], v[180:183]
ds_read_b64_tr_b16 a[82:83], v14 offset:8448
v_mfma_f32_16x16x32_bf16 v[172:175], a[92:95], a[24:27], v[172:175]
ds_read_b64_tr_b16 a[84:85], v14 offset:10240
v_mfma_f32_16x16x32_bf16 v[172:175], a[88:91], a[8:11], v[172:175]
ds_read_b64_tr_b16 a[86:87], v14 offset:10496
s_add_u32 m0, s16, 0x9c00
v_mfma_f32_16x16x32_bf16 v[164:167], a[88:91], a[4:7], v[164:167]
buffer_load_dwordx4 v23, s[44:47], s23 offen lds
v_mfma_f32_16x16x32_bf16 v[164:167], a[92:95], a[20:23], v[164:167]
v_lshl_add_u32 v22, s42, 7, v22
v_lshl_add_u32 v23, s42, 7, v23
v_mfma_f32_16x16x32_bf16 v[156:159], a[92:95], a[16:19], v[156:159]
v_mfma_f32_16x16x32_bf16 v[156:159], a[88:91], a[0:3], v[156:159]
s_waitcnt lgkmcnt(4)
v_mfma_f32_16x16x32_bf16 v[184:187], a[96:99], a[0:3], v[184:187]
ds_read_b64_tr_b16 a[88:89], v15 offset:8192
v_mfma_f32_16x16x32_bf16 v[184:187], a[100:103], a[16:19], v[184:187]
ds_read_b64_tr_b16 a[90:91], v15 offset:8448
s_add_u32 s8, s28, 0x2800
v_mfma_f32_16x16x32_bf16 v[192:195], a[100:103], a[20:23], v[192:195]
buffer_store_dwordx4 a[160:163], v16, s[88:91], s8 offen sc1
v_mfma_f32_16x16x32_bf16 v[192:195], a[96:99], a[4:7], v[192:195]
ds_read_b64_tr_b16 a[92:93], v15 offset:10240
v_mfma_f32_16x16x32_bf16 v[200:203], a[96:99], a[8:11], v[200:203]
ds_read_b64_tr_b16 a[94:95], v15 offset:10496
v_add_u32 v12, 0x8000, v12
v_mfma_f32_16x16x32_bf16 v[200:203], a[100:103], a[24:27], v[200:203]
v_add_u32 v13, 0x8000, v13
v_add_u32 v14, 0x8000, v14
v_mfma_f32_16x16x32_bf16 v[208:211], a[100:103], a[28:31], v[208:211]
v_add_u32 v15, 0x8000, v15
v_mfma_f32_16x16x32_bf16 v[208:211], a[96:99], a[12:15], v[208:211]
v_mfma_f32_16x16x32_bf16 v[212:215], a[104:107], a[12:15], v[212:215]
s_waitcnt vmcnt(28) lgkmcnt(0)
v_mfma_f32_16x16x32_bf16 v[212:215], a[108:111], a[28:31], v[212:215]
s_barrier
s_add_u32 m0, s17, 0x8000
v_mfma_f32_16x16x32_bf16 v[204:207], a[108:111], a[24:27], v[204:207]
buffer_load_dwordx4 v5, s[52:55], 0 offen lds
v_mfma_f32_16x16x32_bf16 v[204:207], a[104:107], a[8:11], v[204:207]
ds_read_b64_tr_b16 a[96:97], v12 offset:0
v_mfma_f32_16x16x32_bf16 v[196:199], a[104:107], a[4:7], v[196:199]
ds_read_b64_tr_b16 a[98:99], v12 offset:1024
v_mfma_f32_16x16x32_bf16 v[196:199], a[108:111], a[20:23], v[196:199]
ds_read_b64_tr_b16 a[100:101], v12 offset:8192
v_mfma_f32_16x16x32_bf16 v[188:191], a[108:111], a[16:19], v[188:191]
ds_read_b64_tr_b16 a[102:103], v12 offset:9216
v_mfma_f32_16x16x32_bf16 v[188:191], a[104:107], a[0:3], v[188:191]
s_add_u32 m0, s17, 0x8400
s_waitcnt lgkmcnt(4)
v_mfma_f32_16x16x32_bf16 v[216:219], a[0:3], a[80:83], v[216:219]
buffer_load_dwordx4 v5, s[52:55], s13 offen lds
v_mfma_f32_16x16x32_bf16 v[216:219], a[16:19], a[84:87], v[216:219]
ds_read_b64_tr_b16 a[104:105], v13 offset:0
v_mfma_f32_16x16x32_bf16 v[224:227], a[20:23], a[84:87], v[224:227]
ds_read_b64_tr_b16 a[106:107], v13 offset:1024
v_mfma_f32_16x16x32_bf16 v[224:227], a[4:7], a[80:83], v[224:227]
ds_read_b64_tr_b16 a[108:109], v13 offset:8192
v_mfma_f32_16x16x32_bf16 v[232:235], a[8:11], a[80:83], v[232:235]
ds_read_b64_tr_b16 a[110:111], v13 offset:9216
v_mfma_f32_16x16x32_bf16 v[232:235], a[24:27], a[84:87], v[232:235]
v_mfma_f32_16x16x32_bf16 v[240:243], a[28:31], a[84:87], v[240:243]
s_add_u32 m0, s17, 0x8800
v_mfma_f32_16x16x32_bf16 v[240:243], a[12:15], a[80:83], v[240:243]
buffer_load_dwordx4 v6, s[52:55], 0 offen lds
v_mfma_f32_16x16x32_bf16 v[244:247], a[12:15], a[88:91], v[244:247]
ds_read_b64_tr_b16 a[80:81], v12 offset:256
v_mfma_f32_16x16x32_bf16 v[244:247], a[28:31], a[92:95], v[244:247]
ds_read_b64_tr_b16 a[82:83], v12 offset:1280
v_mfma_f32_16x16x32_bf16 v[236:239], a[24:27], a[92:95], v[236:239]
ds_read_b64_tr_b16 a[84:85], v12 offset:8448
v_mfma_f32_16x16x32_bf16 v[236:239], a[8:11], a[88:91], v[236:239]
ds_read_b64_tr_b16 a[86:87], v12 offset:9472
v_mfma_f32_16x16x32_bf16 v[228:231], a[4:7], a[88:91], v[228:231]
v_mfma_f32_16x16x32_bf16 v[228:231], a[20:23], a[92:95], v[228:231]
s_add_u32 m0, s17, 0x8c00
v_mfma_f32_16x16x32_bf16 v[220:223], a[16:19], a[92:95], v[220:223]
buffer_load_dwordx4 v6, s[52:55], s13 offen lds
v_mfma_f32_16x16x32_bf16 v[220:223], a[0:3], a[88:91], v[220:223]
s_waitcnt lgkmcnt(4)
L_S11:
v_mfma_f32_16x16x32_bf16 v[24:27], a[96:99], a[32:35], v[24:27]
ds_read_b64_tr_b16 a[88:89], v13 offset:256
s_waitcnt vmcnt(23)
v_mfma_f32_16x16x32_bf16 v[24:27], a[100:103], a[48:51], v[24:27]
ds_read_b64_tr_b16 a[90:91], v13 offset:1280
v_mfma_f32_16x16x32_bf16 v[32:35], a[100:103], a[52:55], v[32:35]
ds_read_b64_tr_b16 a[92:93], v13 offset:8448
v_mfma_f32_16x16x32_bf16 v[32:35], a[96:99], a[36:39], v[32:35]
ds_read_b64_tr_b16 a[94:95], v13 offset:9472
v_mfma_f32_16x16x32_bf16 v[40:43], a[96:99], a[40:43], v[40:43]
ds_read_b128 a[0:3], v8 offset:0
s_add_u32 m0, s18, 0xc000
v_mfma_f32_16x16x32_bf16 v[40:43], a[100:103], a[56:59], v[40:43]
buffer_load_dwordx4 v7, s[68:71], 0 offen lds
v_mfma_f32_16x16x32_bf16 v[48:51], a[100:103], a[60:63], v[48:51]
ds_read_b128 a[16:19], v9 offset:0
v_mfma_f32_16x16x32_bf16 v[48:51], a[96:99], a[44:47], v[48:51]
ds_read_b128 a[4:7], v8 offset:2048
v_mfma_f32_16x16x32_bf16 v[52:55], a[104:107], a[44:47], v[52:55]
ds_read_b64_tr_b16 a[96:97], v12 offset:512
v_mfma_f32_16x16x32_bf16 v[52:55], a[108:111], a[60:63], v[52:55]
ds_read_b64_tr_b16 a[98:99], v12 offset:1536
v_mfma_f32_16x16x32_bf16 v[44:47], a[108:111], a[56:59], v[44:47]
ds_read_b64_tr_b16 a[100:101], v12 offset:8704
s_add_u32 s8, s28, 0x3800
v_mfma_f32_16x16x32_bf16 v[44:47], a[104:107], a[40:43], v[44:47]
buffer_store_dwordx4 a[164:167], v16, s[88:91], s8 offen sc1
v_mfma_f32_16x16x32_bf16 v[36:39], a[104:107], a[36:39], v[36:39]
ds_read_b64_tr_b16 a[102:103], v12 offset:9728
v_mfma_f32_16x16x32_bf16 v[36:39], a[108:111], a[52:55], v[36:39]
ds_read_b128 a[20:23], v9 offset:2048
v_mfma_f32_16x16x32_bf16 v[28:31], a[108:111], a[48:51], v[28:31]
ds_read_b128 a[8:11], v8 offset:4096
v_mfma_f32_16x16x32_bf16 v[28:31], a[104:107], a[32:35], v[28:31]
ds_read_b128 a[24:27], v9 offset:4096
s_waitcnt lgkmcnt(10)
v_mfma_f32_16x16x32_bf16 v[56:59], a[80:83], a[32:35], v[56:59]
ds_read_b64_tr_b16 a[104:105], v13 offset:512
v_mfma_f32_16x16x32_bf16 v[56:59], a[84:87], a[48:51], v[56:59]
ds_read_b64_tr_b16 a[106:107], v13 offset:1536
s_add_u32 m0, s18, 0xd000
v_mfma_f32_16x16x32_bf16 v[64:67], a[84:87], a[52:55], v[64:67]
buffer_load_dwordx4 v7, s[68:71], s25 offen lds
v_mfma_f32_16x16x32_bf16 v[64:67], a[80:83], a[36:39], v[64:67]
ds_read_b64_tr_b16 a[108:109], v13 offset:8704
v_mfma_f32_16x16x32_bf16 v[72:75], a[80:83], a[40:43], v[72:75]
ds_read_b64_tr_b16 a[110:111], v13 offset:9728
v_mfma_f32_16x16x32_bf16 v[72:75], a[84:87], a[56:59], v[72:75]
ds_read_b128 a[12:15], v8 offset:6144
v_mfma_f32_16x16x32_bf16 v[80:83], a[84:87], a[60:63], v[80:83]
ds_read_b128 a[28:31], v9 offset:6144
v_mfma_f32_16x16x32_bf16 v[80:83], a[80:83], a[44:47], v[80:83]
v_mfma_f32_16x16x32_bf16 v[84:87], a[88:91], a[44:47], v[84:87]
ds_read_b64_tr_b16 a[80:81], v12 offset:768
s_add_u32 m0, s18, 0xe000
v_mfma_f32_16x16x32_bf16 v[84:87], a[92:95], a[60:63], v[84:87]
buffer_load_dwordx4 v7, s[68:71], s26 offen lds
v_mfma_f32_16x16x32_bf16 v[76:79], a[92:95], a[56:59], v[76:79]
ds_read_b64_tr_b16 a[82:83], v12 offset:1792
v_lshl_add_u32 v5, s42, 19, v5
v_mfma_f32_16x16x32_bf16 v[76:79], a[88:91], a[40:43], v[76:79]
ds_read_b64_tr_b16 a[84:85], v12 offset:8960
v_lshl_add_u32 v6, s42, 19, v6
v_mfma_f32_16x16x32_bf16 v[68:71], a[88:91], a[36:39], v[68:71]
ds_read_b64_tr_b16 a[86:87], v12 offset:9984
v_lshl_add_u32 v7, s42, 18, v7
v_mfma_f32_16x16x32_bf16 v[68:71], a[92:95], a[52:55], v[68:71]
L_padA6:
s_cmp_eq_u32 s95, 1
s_cbranch_scc1 L_padA10
v_lshl_add_u32 v7, s42, 17, v7
v_mfma_f32_16x16x32_bf16 v[60:63], a[92:95], a[48:51], v[60:63]
v_mfma_f32_16x16x32_bf16 v[60:63], a[88:91], a[32:35], v[60:63]
s_add_u32 m0, s16, 0x0
s_waitcnt lgkmcnt(4)
s_waitcnt lgkmcnt(6)
v_mfma_f32_16x16x32_bf16 v[88:91], a[96:99], a[32:35], v[88:91]
buffer_load_dwordx4 v22, s[44:47], s20 offen lds
v_mfma_f32_16x16x32_bf16 v[88:91], a[100:103], a[48:51], v[88:91]
ds_read_b64_tr_b16 a[88:89], v13 offset:768
v_mfma_f32_16x16x32_bf16 v[96:99], a[100:103], a[52:55], v[96:99]
ds_read_b64_tr_b16 a[90:91], v13 offset:1792
v_mfma_f32_16x16x32_bf16 v[96:99], a[96:99], a[36:39], v[96:99]
ds_read_b64_tr_b16 a[92:93], v13 offset:8960
v_mfma_f32_16x16x32_bf16 v[104:107], a[96:99], a[40:43], v[104:107]
ds_read_b64_tr_b16 a[94:95], v13 offset:9984
s_add_u32 m0, s16, 0x400
v_mfma_f32_16x16x32_bf16 v[104:107], a[100:103], a[56:59], v[104:107]
buffer_load_dwordx4 v23, s[44:47], s20 offen lds
v_mfma_f32_16x16x32_bf16 v[112:115], a[100:103], a[60:63], v[112:115]
v_mfma_f32_16x16x32_bf16 v[112:115], a[96:99], a[44:47], v[112:115]
v_mfma_f32_16x16x32_bf16 v[116:119], a[104:107], a[44:47], v[116:119]
ds_read_b64_tr_b16 a[96:97], v14 offset:0
v_mfma_f32_16x16x32_bf16 v[116:119], a[108:111], a[60:63], v[116:119]
ds_read_b64_tr_b16 a[98:99], v14 offset:256
v_mfma_f32_16x16x32_bf16 v[108:111], a[108:111], a[56:59], v[108:111]
ds_read_b64_tr_b16 a[100:101], v14 offset:2048
s_add_u32 m0, s16, 0x800
v_mfma_f32_16x16x32_bf16 v[108:111], a[104:107], a[40:43], v[108:111]
buffer_load_dwordx4 v22, s[44:47], s21 offen lds
v_mfma_f32_16x16x32_bf16 v[100:103], a[104:107], a[36:39], v[100:103]
ds_read_b64_tr_b16 a[102:103], v14 offset:2304
v_mfma_f32_16x16x32_bf16 v[100:103], a[108:111], a[52:55], v[100:103]
v_mfma_f32_16x16x32_bf16 v[92:95], a[108:111], a[48:51], v[92:95]
v_mfma_f32_16x16x32_bf16 v[92:95], a[104:107], a[32:35], v[92:95]
s_add_u32 s8, s28, 0x6800
s_waitcnt lgkmcnt(4)
v_mfma_f32_16x16x32_bf16 v[120:123], a[80:83], a[32:35], v[120:123]
buffer_store_dwordx4 a[168:171], v16, s[88:91], s8 offen sc1
v_mfma_f32_16x16x32_bf16 v[120:123], a[84:87], a[48:51], v[120:123]
ds_read_b64_tr_b16 a[104:105], v15 offset:0
v_mfma_f32_16x16x32_bf16 v[128:131], a[84:87], a[52:55], v[128:131]
ds_read_b64_tr_b16 a[106:107], v15 offset:256
v_mfma_f32_16x16x32_bf16 v[128:131], a[80:83], a[36:39], v[128:131]
ds_read_b64_tr_b16 a[108:109], v15 offset:2048
v_mfma_f32_16x16x32_bf16 v[136:139], a[80:83], a[40:43], v[136:139]
ds_read_b64_tr_b16 a[110:111], v15 offset:2304
v_mfma_f32_16x16x32_bf16 v[136:139], a[84:87], a[56:59], v[136:139]
s_add_u32 m0, s16, 0xc00
v_mfma_f32_16x16x32_bf16 v[144:147], a[84:87], a[60:63], v[144:147]
buffer_load_dwordx4 v23, s[44:47], s21 offen lds
v_mfma_f32_16x16x32_bf16 v[144:147], a[80:83], a[44:47], v[144:147]
v_mfma_f32_16x16x32_bf16 v[148:151], a[88:91], a[44:47], v[148:151]
ds_read_b64_tr_b16 a[80:81], v14 offset:4096
v_mfma_f32_16x16x32_bf16 v[148:151], a[92:95], a[60:63], v[148:151]
ds_read_b64_tr_b16 a[82:83], v14 offset:4352
v_mfma_f32_16x16x32_bf16 v[140:143], a[92:95], a[56:59], v[140:143]
ds_read_b64_tr_b16 a[84:85], v14 offset:6144
v_mfma_f32_16x16x32_bf16 v[140:143], a[88:91], a[40:43], v[140:143]
ds_read_b64_tr_b16 a[86:87], v14 offset:6400
s_add_u32 m0, s16, 0x1000
v_mfma_f32_16x16x32_bf16 v[132:135], a[88:91], a[36:39], v[132:135]
buffer_load_dwordx4 v22, s[44:47], s22 offen lds
v_mfma_f32_16x16x32_bf16 v[132:135], a[92:95], a[52:55], v[132:135]
v_mfma_f32_16x16x32_bf16 v[124:127], a[92:95], a[48:51], v[124:127]
v_mfma_f32_16x16x32_bf16 v[124:127], a[88:91], a[32:35], v[124:127]
s_waitcnt lgkmcnt(4)
v_mfma_f32_16x16x32_bf16 v[152:155], a[96:99], a[32:35], v[152:155]
ds_read_b64_tr_b16 a[88:89], v15 offset:4096
s_add_u32 m0, s16, 0x1400
v_mfma_f32_16x16x32_bf16 v[152:155], a[100:103], a[48:51], v[152:155]
buffer_load_dwordx4 v23, s[44:47], s22 offen lds
v_mfma_f32_16x16x32_bf16 v[160:163], a[100:103], a[52:55], v[160:163]
ds_read_b64_tr_b16 a[90:91], v15 offset:4352
v_mfma_f32_16x16x32_bf16 v[160:163], a[96:99], a[36:39], v[160:163]
ds_read_b64_tr_b16 a[92:93], v15 offset:6144
v_mfma_f32_16x16x32_bf16 v[168:171], a[96:99], a[40:43], v[168:171]
ds_read_b64_tr_b16 a[94:95], v15 offset:6400
v_mfma_f32_16x16x32_bf16 v[168:171], a[100:103], a[56:59], v[168:171]
v_mfma_f32_16x16x32_bf16 v[176:179], a[100:103], a[60:63], v[176:179]
s_add_u32 m0, s16, 0x1800
v_mfma_f32_16x16x32_bf16 v[176:179], a[96:99], a[44:47], v[176:179]
buffer_load_dwordx4 v22, s[44:47], s23 offen lds
v_mfma_f32_16x16x32_bf16 v[180:183], a[104:107], a[44:47], v[180:183]
ds_read_b64_tr_b16 a[96:97], v14 offset:8192
v_mfma_f32_16x16x32_bf16 v[180:183], a[108:111], a[60:63], v[180:183]
ds_read_b64_tr_b16 a[98:99], v14 offset:8448
v_mfma_f32_16x16x32_bf16 v[172:175], a[108:111], a[56:59], v[172:175]
ds_read_b64_tr_b16 a[100:101], v14 offset:10240
v_mfma_f32_16x16x32_bf16 v[172:175], a[104:107], a[40:43], v[172:175]
ds_read_b64_tr_b16 a[102:103], v14 offset:10496
s_add_u32 m0, s16, 0x1c00
v_mfma_f32_16x16x32_bf16 v[164:167], a[104:107], a[36:39], v[164:167]
buffer_load_dwordx4 v23, s[44:47], s23 offen lds
v_mfma_f32_16x16x32_bf16 v[164:167], a[108:111], a[52:55], v[164:167]
v_lshl_add_u32 v22, s42, 7, v22
v_lshl_add_u32 v23, s42, 7, v23
v_mfma_f32_16x16x32_bf16 v[156:159], a[108:111], a[48:51], v[156:159]
v_mfma_f32_16x16x32_bf16 v[156:159], a[104:107], a[32:35], v[156:159]
s_waitcnt lgkmcnt(4)
v_mfma_f32_16x16x32_bf16 v[184:187], a[80:83], a[32:35], v[184:187]
ds_read_b64_tr_b16 a[104:105], v15 offset:8192
v_mfma_f32_16x16x32_bf16 v[184:187], a[84:87], a[48:51], v[184:187]
ds_read_b64_tr_b16 a[106:107], v15 offset:8448
s_add_u32 s8, s28, 0x7800
v_mfma_f32_16x16x32_bf16 v[192:195], a[84:87], a[52:55], v[192:195]
buffer_store_dwordx4 a[172:175], v16, s[88:91], s8 offen sc1
v_mfma_f32_16x16x32_bf16 v[192:195], a[80:83], a[36:39], v[192:195]
ds_read_b64_tr_b16 a[108:109], v15 offset:10240
v_mfma_f32_16x16x32_bf16 v[200:203], a[80:83], a[40:43], v[200:203]
ds_read_b64_tr_b16 a[110:111], v15 offset:10496
v_add_u32 v12, 0xffff0000, v12
v_mfma_f32_16x16x32_bf16 v[200:203], a[84:87], a[56:59], v[200:203]
v_add_u32 v13, 0xffff0000, v13
v_add_u32 v14, 0xffff0000, v14
v_mfma_f32_16x16x32_bf16 v[208:211], a[84:87], a[60:63], v[208:211]
v_add_u32 v15, 0xffff0000, v15
v_mfma_f32_16x16x32_bf16 v[208:211], a[80:83], a[44:47], v[208:211]
v_mfma_f32_16x16x32_bf16 v[212:215], a[88:91], a[44:47], v[212:215]
s_waitcnt vmcnt(28) lgkmcnt(0)
v_mfma_f32_16x16x32_bf16 v[212:215], a[92:95], a[60:63], v[212:215]
s_barrier
s_add_u32 m0, s17, 0x10000
v_mfma_f32_16x16x32_bf16 v[204:207], a[92:95], a[56:59], v[204:207]
buffer_load_dwordx4 v5, s[52:55], 0 offen lds
v_mfma_f32_16x16x32_bf16 v[204:207], a[88:91], a[40:43], v[204:207]
ds_read_b64_tr_b16 a[80:81], v12 offset:0
v_mfma_f32_16x16x32_bf16 v[196:199], a[88:91], a[36:39], v[196:199]
ds_read_b64_tr_b16 a[82:83], v12 offset:1024
v_mfma_f32_16x16x32_bf16 v[196:199], a[92:95], a[52:55], v[196:199]
ds_read_b64_tr_b16 a[84:85], v12 offset:8192
v_mfma_f32_16x16x32_bf16 v[188:191], a[92:95], a[48:51], v[188:191]
ds_read_b64_tr_b16 a[86:87], v12 offset:9216
v_mfma_f32_16x16x32_bf16 v[188:191], a[88:91], a[32:35], v[188:191]
s_add_u32 m0, s17, 0x10400
s_waitcnt lgkmcnt(4)
v_mfma_f32_16x16x32_bf16 v[216:219], a[32:35], a[96:99], v[216:219]
buffer_load_dwordx4 v5, s[52:55], s13 offen lds
v_mfma_f32_16x16x32_bf16 v[216:219], a[48:51], a[100:103], v[216:219]
ds_read_b64_tr_b16 a[88:89], v13 offset:0
v_mfma_f32_16x16x32_bf16 v[224:227], a[52:55], a[100:103], v[224:227]
ds_read_b64_tr_b16 a[90:91], v13 offset:1024
v_mfma_f32_16x16x32_bf16 v[224:227], a[36:39], a[96:99], v[224:227]
ds_read_b64_tr_b16 a[92:93], v13 offset:8192
v_mfma_f32_16x16x32_bf16 v[232:235], a[40:43], a[96:99], v[232:235]
ds_read_b64_tr_b16 a[94:95], v13 offset:9216
v_mfma_f32_16x16x32_bf16 v[232:235], a[56:59], a[100:103], v[232:235]
s_add_u32 m0, s17, 0x10800
v_mfma_f32_16x16x32_bf16 v[240:243], a[60:63], a[100:103], v[240:243]
buffer_load_dwordx4 v6, s[52:55], 0 offen lds
v_mfma_f32_16x16x32_bf16 v[240:243], a[44:47], a[96:99], v[240:243]
v_mfma_f32_16x16x32_bf16 v[244:247], a[44:47], a[104:107], v[244:247]
ds_read_b64_tr_b16 a[96:97], v12 offset:256
v_mfma_f32_16x16x32_bf16 v[244:247], a[60:63], a[108:111], v[244:247]
ds_read_b64_tr_b16 a[98:99], v12 offset:1280
v_mfma_f32_16x16x32_bf16 v[236:239], a[56:59], a[108:111], v[236:239]
ds_read_b64_tr_b16 a[100:101], v12 offset:8448
v_mfma_f32_16x16x32_bf16 v[236:239], a[40:43], a[104:107], v[236:239]
ds_read_b64_tr_b16 a[102:103], v12 offset:9472
s_add_u32 s8, s28, 0x2c00
v_mfma_f32_16x16x32_bf16 v[228:231], a[36:39], a[104:107], v[228:231]
buffer_store_dwordx4 a[176:179], v16, s[88:91], s8 offen sc1
v_mfma_f32_16x16x32_bf16 v[228:231], a[52:55], a[108:111], v[228:231]
v_mfma_f32_16x16x32_bf16 v[220:223], a[48:51], a[108:111], v[220:223]
v_mfma_f32_16x16x32_bf16 v[220:223], a[32:35], a[104:107], v[220:223]
s_waitcnt lgkmcnt(4)
L_S12:
v_mfma_f32_16x16x32_bf16 v[24:27], a[80:83], a[0:3], v[24:27]
ds_read_b64_tr_b16 a[104:105], v13 offset:256
s_waitcnt vmcnt(23)
v_mfma_f32_16x16x32_bf16 v[24:27], a[84:87], a[16:19], v[24:27]
ds_read_b64_tr_b16 a[106:107], v13 offset:1280
s_add_u32 m0, s17, 0x10c00
v_mfma_f32_16x16x32_bf16 v[32:35], a[84:87], a[20:23], v[32:35]
buffer_load_dwordx4 v6, s[52:55], s13 offen lds
v_mfma_f32_16x16x32_bf16 v[32:35], a[80:83], a[4:7], v[32:35]
ds_read_b64_tr_b16 a[108:109], v13 offset:8448
v_mfma_f32_16x16x32_bf16 v[40:43], a[80:83], a[8:11], v[40:43]
ds_read_b64_tr_b16 a[110:111], v13 offset:9472
v_mfma_f32_16x16x32_bf16 v[40:43], a[84:87], a[24:27], v[40:43]
ds_read_b128 a[32:35], v8 offset:32768
v_mfma_f32_16x16x32_bf16 v[48:51], a[84:87], a[28:31], v[48:51]
ds_read_b128 a[48:51], v9 offset:32768
v_mfma_f32_16x16x32_bf16 v[48:51], a[80:83], a[12:15], v[48:51]
ds_read_b128 a[36:39], v8 offset:34816
s_add_u32 m0, s18, 0x14000
v_mfma_f32_16x16x32_bf16 v[52:55], a[88:91], a[12:15], v[52:55]
buffer_load_dwordx4 v7, s[68:71], 0 offen lds
v_mfma_f32_16x16x32_bf16 v[52:55], a[92:95], a[28:31], v[52:55]
ds_read_b64_tr_b16 a[80:81], v12 offset:512
v_mfma_f32_16x16x32_bf16 v[44:47], a[92:95], a[24:27], v[44:47]
ds_read_b64_tr_b16 a[82:83], v12 offset:1536
v_mfma_f32_16x16x32_bf16 v[44:47], a[88:91], a[8:11], v[44:47]
ds_read_b64_tr_b16 a[84:85], v12 offset:8704
v_mfma_f32_16x16x32_bf16 v[36:39], a[88:91], a[4:7], v[36:39]
ds_read_b64_tr_b16 a[86:87], v12 offset:9728
v_mfma_f32_16x16x32_bf16 v[36:39], a[92:95], a[20:23], v[36:39]
ds_read_b128 a[52:55], v9 offset:34816
s_add_u32 m0, s18, 0x15000
v_mfma_f32_16x16x32_bf16 v[28:31], a[92:95], a[16:19], v[28:31]
buffer_load_dwordx4 v7, s[68:71], s25 offen lds
v_mfma_f32_16x16x32_bf16 v[28:31], a[88:91], a[0:3], v[28:31]
ds_read_b128 a[40:43], v8 offset:36864
s_waitcnt lgkmcnt(9)
v_mfma_f32_16x16x32_bf16 v[56:59], a[96:99], a[0:3], v[56:59]
ds_read_b64_tr_b16 a[88:89], v13 offset:512
v_mfma_f32_16x16x32_bf16 v[56:59], a[100:103], a[16:19], v[56:59]
ds_read_b64_tr_b16 a[90:91], v13 offset:1536
v_mfma_f32_16x16x32_bf16 v[64:67], a[100:103], a[20:23], v[64:67]
ds_read_b64_tr_b16 a[92:93], v13 offset:8704
v_mfma_f32_16x16x32_bf16 v[64:67], a[96:99], a[4:7], v[64:67]
ds_read_b64_tr_b16 a[94:95], v13 offset:9728
s_add_u32 m0, s18, 0x16000
v_mfma_f32_16x16x32_bf16 v[72:75], a[96:99], a[8:11], v[72:75]
buffer_load_dwordx4 v7, s[68:71], s26 offen lds
v_mfma_f32_16x16x32_bf16 v[72:75], a[100:103], a[24:27], v[72:75]
ds_read_b128 a[56:59], v9 offset:36864
v_lshl_add_u32 v5, s42, 19, v5
v_mfma_f32_16x16x32_bf16 v[80:83], a[100:103], a[28:31], v[80:83]
ds_read_b128 a[44:47], v8 offset:38912
v_lshl_add_u32 v6, s42, 19, v6
v_mfma_f32_16x16x32_bf16 v[80:83], a[96:99], a[12:15], v[80:83]
ds_read_b128 a[60:63], v9 offset:38912
v_lshl_add_u32 v7, s42, 18, v7
v_mfma_f32_16x16x32_bf16 v[84:87], a[104:107], a[12:15], v[84:87]
ds_read_b64_tr_b16 a[96:97], v12 offset:768
v_lshl_add_u32 v7, s42, 17, v7
v_mfma_f32_16x16x32_bf16 v[84:87], a[108:111], a[28:31], v[84:87]
ds_read_b64_tr_b16 a[98:99], v12 offset:1792
s_add_u32 s8, s28, 0x3c00
v_mfma_f32_16x16x32_bf16 v[76:79], a[108:111], a[24:27], v[76:79]
buffer_store_dwordx4 a[180:183], v16, s[88:91], s8 offen sc1
v_mfma_f32_16x16x32_bf16 v[76:79], a[104:107], a[8:11], v[76:79]
ds_read_b64_tr_b16 a[100:101], v12 offset:8960
v_mfma_f32_16x16x32_bf16 v[68:71], a[104:107], a[4:7], v[68:71]
ds_read_b64_tr_b16 a[102:103], v12 offset:9984
v_mfma_f32_16x16x32_bf16 v[68:71], a[108:111], a[20:23], v[68:71]
v_mfma_f32_16x16x32_bf16 v[60:63], a[108:111], a[16:19], v[60:63]
v_mfma_f32_16x16x32_bf16 v[60:63], a[104:107], a[0:3], v[60:63]
s_add_u32 m0, s16, 0x8000
s_waitcnt lgkmcnt(4)
s_waitcnt lgkmcnt(7)
v_mfma_f32_16x16x32_bf16 v[88:91], a[80:83], a[0:3], v[88:91]
buffer_load_dwordx4 v22, s[44:47], s20 offen lds
v_mfma_f32_16x16x32_bf16 v[88:91], a[84:87], a[16:19], v[88:91]
ds_read_b64_tr_b16 a[104:105], v13 offset:768
v_mfma_f32_16x16x32_bf16 v[96:99], a[84:87], a[20:23], v[96:99]
ds_read_b64_tr_b16 a[106:107], v13 offset:1792
v_mfma_f32_16x16x32_bf16 v[96:99], a[80:83], a[4:7], v[96:99]
ds_read_b64_tr_b16 a[108:109], v13 offset:8960
v_mfma_f32_16x16x32_bf16 v[104:107], a[80:83], a[8:11], v[104:107]
ds_read_b64_tr_b16 a[110:111], v13 offset:9984
s_add_u32 m0, s16, 0x8400
v_mfma_f32_16x16x32_bf16 v[104:107], a[84:87], a[24:27], v[104:107]
buffer_load_dwordx4 v23, s[44:47], s20 offen lds
v_mfma_f32_16x16x32_bf16 v[112:115], a[84:87], a[28:31], v[112:115]
v_mfma_f32_16x16x32_bf16 v[112:115], a[80:83], a[12:15], v[112:115]
v_mfma_f32_16x16x32_bf16 v[116:119], a[88:91], a[12:15], v[116:119]
ds_read_b64_tr_b16 a[80:81], v14 offset:0
v_mfma_f32_16x16x32_bf16 v[116:119], a[92:95], a[28:31], v[116:119]
ds_read_b64_tr_b16 a[82:83], v14 offset:256
v_mfma_f32_16x16x32_bf16 v[108:111], a[92:95], a[24:27], v[108:111]
ds_read_b64_tr_b16 a[84:85], v14 offset:2048
s_add_u32 m0, s16, 0x8800
v_mfma_f32_16x16x32_bf16 v[108:111], a[88:91], a[8:11], v[108:111]
buffer_load_dwordx4 v22, s[44:47], s21 offen lds
v_mfma_f32_16x16x32_bf16 v[100:103], a[88:91], a[4:7], v[100:103]
ds_read_b64_tr_b16 a[86:87], v14 offset:2304
v_mfma_f32_16x16x32_bf16 v[100:103], a[92:95], a[20:23], v[100:103]
v_mfma_f32_16x16x32_bf16 v[92:95], a[92:95], a[16:19], v[92:95]
v_mfma_f32_16x16x32_bf16 v[92:95], a[88:91], a[0:3], v[92:95]
s_add_u32 m0, s16, 0x8c00
s_waitcnt lgkmcnt(4)
v_mfma_f32_16x16x32_bf16 v[120:123], a[96:99], a[0:3], v[120:123]
buffer_load_dwordx4 v23, s[44:47], s21 offen lds
v_mfma_f32_16x16x32_bf16 v[120:123], a[100:103], a[16:19], v[120:123]
ds_read_b64_tr_b16 a[88:89], v15 offset:0
v_mfma_f32_16x16x32_bf16 v[128:131], a[100:103], a[20:23], v[128:131]
ds_read_b64_tr_b16 a[90:91], v15 offset:256
v_mfma_f32_16x16x32_bf16 v[128:131], a[96:99], a[4:7], v[128:131]
ds_read_b64_tr_b16 a[92:93], v15 offset:2048
v_mfma_f32_16x16x32_bf16 v[136:139], a[96:99], a[8:11], v[136:139]
ds_read_b64_tr_b16 a[94:95], v15 offset:2304
v_mfma_f32_16x16x32_bf16 v[136:139], a[100:103], a[24:27], v[136:139]
s_add_u32 s8, s28, 0x6c00
v_mfma_f32_16x16x32_bf16 v[144:147], a[100:103], a[28:31], v[144:147]
buffer_store_dwordx4 a[184:187], v16, s[88:91], s8 offen sc1
v_mfma_f32_16x16x32_bf16 v[144:147], a[96:99], a[12:15], v[144:147]
v_mfma_f32_16x16x32_bf16 v[148:151], a[104:107], a[12:15], v[148:151]
ds_read_b64_tr_b16 a[96:97], v14 offset:4096
v_mfma_f32_16x16x32_bf16 v[148:151], a[108:111], a[28:31], v[148:151]
ds_read_b64_tr_b16 a[98:99], v14 offset:4352
v_mfma_f32_16x16x32_bf16 v[140:143], a[108:111], a[24:27], v[140:143]
ds_read_b64_tr_b16 a[100:101], v14 offset:6144
v_mfma_f32_16x16x32_bf16 v[140:143], a[104:107], a[8:11], v[140:143]
ds_read_b64_tr_b16 a[102:103], v14 offset:6400
s_add_u32 m0, s16, 0x9000
v_mfma_f32_16x16x32_bf16 v[132:135], a[104:107], a[4:7], v[132:135]
buffer_load_dwordx4 v22, s[44:47], s22 offen lds
v_mfma_f32_16x16x32_bf16 v[132:135], a[108:111], a[20:23], v[132:135]
v_mfma_f32_16x16x32_bf16 v[124:127], a[108:111], a[16:19], v[124:127]
v_mfma_f32_16x16x32_bf16 v[124:127], a[104:107], a[0:3], v[124:127]
s_waitcnt lgkmcnt(4)
v_mfma_f32_16x16x32_bf16 v[152:155], a[80:83], a[0:3], v[152:155]
ds_read_b64_tr_b16 a[104:105], v15 offset:4096
s_add_u32 m0, s16, 0x9400
v_mfma_f32_16x16x32_bf16 v[152:155], a[84:87], a[16:19], v[152:155]
buffer_load_dwordx4 v23, s[44:47], s22 offen lds
v_mfma_f32_16x16x32_bf16 v[160:163], a[84:87], a[20:23], v[160:163]
ds_read_b64_tr_b16 a[106:107], v15 offset:4352
v_mfma_f32_16x16x32_bf16 v[160:163], a[80:83], a[4:7], v[160:163]
ds_read_b64_tr_b16 a[108:109], v15 offset:6144
v_mfma_f32_16x16x32_bf16 v[168:171], a[80:83], a[8:11], v[168:171]
ds_read_b64_tr_b16 a[110:111], v15 offset:6400
v_mfma_f32_16x16x32_bf16 v[168:171], a[84:87], a[24:27], v[168:171]
v_mfma_f32_16x16x32_bf16 v[176:179], a[84:87], a[28:31], v[176:179]
s_add_u32 m0, s16, 0x9800
v_mfma_f32_16x16x32_bf16 v[176:179], a[80:83], a[12:15], v[176:179]
buffer_load_dwordx4 v22, s[44:47], s23 offen lds
v_mfma_f32_16x16x32_bf16 v[180:183], a[88:91], a[12:15], v[180:183]
ds_read_b64_tr_b16 a[80:81], v14 offset:8192
v_mfma_f32_16x16x32_bf16 v[180:183], a[92:95], a[28:31], v[180:183]
ds_read_b64_tr_b16 a[82:83], v14 offset:8448
v_mfma_f32_16x16x32_bf16 v[172:175], a[92:95], a[24:27], v[172:175]
ds_read_b64_tr_b16 a[84:85], v14 offset:10240
v_mfma_f32_16x16x32_bf16 v[172:175], a[88:91], a[8:11], v[172:175]
ds_read_b64_tr_b16 a[86:87], v14 offset:10496
s_add_u32 m0, s16, 0x9c00
v_mfma_f32_16x16x32_bf16 v[164:167], a[88:91], a[4:7], v[164:167]
buffer_load_dwordx4 v23, s[44:47], s23 offen lds
v_mfma_f32_16x16x32_bf16 v[164:167], a[92:95], a[20:23], v[164:167]
v_lshl_add_u32 v22, s42, 7, v22
v_lshl_add_u32 v23, s42, 7, v23
v_mfma_f32_16x16x32_bf16 v[156:159], a[92:95], a[16:19], v[156:159]
v_mfma_f32_16x16x32_bf16 v[156:159], a[88:91], a[0:3], v[156:159]
s_waitcnt lgkmcnt(4)
v_mfma_f32_16x16x32_bf16 v[184:187], a[96:99], a[0:3], v[184:187]
ds_read_b64_tr_b16 a[88:89], v15 offset:8192
v_mfma_f32_16x16x32_bf16 v[184:187], a[100:103], a[16:19], v[184:187]
ds_read_b64_tr_b16 a[90:91], v15 offset:8448
s_add_u32 s8, s28, 0x7c00
v_mfma_f32_16x16x32_bf16 v[192:195], a[100:103], a[20:23], v[192:195]
buffer_store_dwordx4 a[188:191], v16, s[88:91], s8 offen sc1
v_mfma_f32_16x16x32_bf16 v[192:195], a[96:99], a[4:7], v[192:195]
ds_read_b64_tr_b16 a[92:93], v15 offset:10240
v_mfma_f32_16x16x32_bf16 v[200:203], a[96:99], a[8:11], v[200:203]
ds_read_b64_tr_b16 a[94:95], v15 offset:10496
v_add_u32 v12, 0x8000, v12
v_mfma_f32_16x16x32_bf16 v[200:203], a[100:103], a[24:27], v[200:203]
v_add_u32 v13, 0x8000, v13
v_add_u32 v14, 0x8000, v14
v_mfma_f32_16x16x32_bf16 v[208:211], a[100:103], a[28:31], v[208:211]
v_add_u32 v15, 0x8000, v15
v_mfma_f32_16x16x32_bf16 v[208:211], a[96:99], a[12:15], v[208:211]
v_mfma_f32_16x16x32_bf16 v[212:215], a[104:107], a[12:15], v[212:215]
s_waitcnt vmcnt(29) lgkmcnt(0)
v_mfma_f32_16x16x32_bf16 v[212:215], a[108:111], a[28:31], v[212:215]
s_barrier
s_add_u32 m0, s17, 0x0
v_mfma_f32_16x16x32_bf16 v[204:207], a[108:111], a[24:27], v[204:207]
buffer_load_dwordx4 v5, s[52:55], 0 offen lds
v_mfma_f32_16x16x32_bf16 v[204:207], a[104:107], a[8:11], v[204:207]
ds_read_b64_tr_b16 a[96:97], v12 offset:0
v_mfma_f32_16x16x32_bf16 v[196:199], a[104:107], a[4:7], v[196:199]
ds_read_b64_tr_b16 a[98:99], v12 offset:1024
v_mfma_f32_16x16x32_bf16 v[196:199], a[108:111], a[20:23], v[196:199]
ds_read_b64_tr_b16 a[100:101], v12 offset:8192
v_mfma_f32_16x16x32_bf16 v[188:191], a[108:111], a[16:19], v[188:191]
ds_read_b64_tr_b16 a[102:103], v12 offset:9216
v_mfma_f32_16x16x32_bf16 v[188:191], a[104:107], a[0:3], v[188:191]
s_add_u32 m0, s17, 0x400
s_waitcnt lgkmcnt(4)
v_mfma_f32_16x16x32_bf16 v[216:219], a[0:3], a[80:83], v[216:219]
buffer_load_dwordx4 v5, s[52:55], s13 offen lds
v_mfma_f32_16x16x32_bf16 v[216:219], a[16:19], a[84:87], v[216:219]
ds_read_b64_tr_b16 a[104:105], v13 offset:0
v_mfma_f32_16x16x32_bf16 v[224:227], a[20:23], a[84:87], v[224:227]
ds_read_b64_tr_b16 a[106:107], v13 offset:1024
v_mfma_f32_16x16x32_bf16 v[224:227], a[4:7], a[80:83], v[224:227]
ds_read_b64_tr_b16 a[108:109], v13 offset:8192
v_mfma_f32_16x16x32_bf16 v[232:235], a[8:11], a[80:83], v[232:235]
ds_read_b64_tr_b16 a[110:111], v13 offset:9216
v_mfma_f32_16x16x32_bf16 v[232:235], a[24:27], a[84:87], v[232:235]
v_mfma_f32_16x16x32_bf16 v[240:243], a[28:31], a[84:87], v[240:243]
s_add_u32 m0, s17, 0x800
v_mfma_f32_16x16x32_bf16 v[240:243], a[12:15], a[80:83], v[240:243]
buffer_load_dwordx4 v6, s[52:55], 0 offen lds
v_mfma_f32_16x16x32_bf16 v[244:247], a[12:15], a[88:91], v[244:247]
ds_read_b64_tr_b16 a[80:81], v12 offset:256
v_mfma_f32_16x16x32_bf16 v[244:247], a[28:31], a[92:95], v[244:247]
ds_read_b64_tr_b16 a[82:83], v12 offset:1280
v_mfma_f32_16x16x32_bf16 v[236:239], a[24:27], a[92:95], v[236:239]
ds_read_b64_tr_b16 a[84:85], v12 offset:8448
v_mfma_f32_16x16x32_bf16 v[236:239], a[8:11], a[88:91], v[236:239]
ds_read_b64_tr_b16 a[86:87], v12 offset:9472
v_mfma_f32_16x16x32_bf16 v[228:231], a[4:7], a[88:91], v[228:231]
v_mfma_f32_16x16x32_bf16 v[228:231], a[20:23], a[92:95], v[228:231]
s_add_u32 m0, s17, 0xc00
v_mfma_f32_16x16x32_bf16 v[220:223], a[16:19], a[92:95], v[220:223]
buffer_load_dwordx4 v6, s[52:55], s13 offen lds
v_mfma_f32_16x16x32_bf16 v[220:223], a[0:3], a[88:91], v[220:223]
s_waitcnt lgkmcnt(4)
L_S13:
v_mfma_f32_16x16x32_bf16 v[24:27], a[96:99], a[32:35], v[24:27]
ds_read_b64_tr_b16 a[88:89], v13 offset:256
s_waitcnt vmcnt(24)
v_mfma_f32_16x16x32_bf16 v[24:27], a[100:103], a[48:51], v[24:27]
ds_read_b64_tr_b16 a[90:91], v13 offset:1280
v_mfma_f32_16x16x32_bf16 v[32:35], a[100:103], a[52:55], v[32:35]
ds_read_b64_tr_b16 a[92:93], v13 offset:8448
v_mfma_f32_16x16x32_bf16 v[32:35], a[96:99], a[36:39], v[32:35]
ds_read_b64_tr_b16 a[94:95], v13 offset:9472
v_mfma_f32_16x16x32_bf16 v[40:43], a[96:99], a[40:43], v[40:43]
ds_read_b128 a[0:3], v8 offset:0
s_add_u32 m0, s18, 0x4000
v_mfma_f32_16x16x32_bf16 v[40:43], a[100:103], a[56:59], v[40:43]
buffer_load_dwordx4 v7, s[68:71], 0 offen lds
v_mfma_f32_16x16x32_bf16 v[48:51], a[100:103], a[60:63], v[48:51]
ds_read_b128 a[16:19], v9 offset:0
v_mfma_f32_16x16x32_bf16 v[48:51], a[96:99], a[44:47], v[48:51]
ds_read_b128 a[4:7], v8 offset:2048
v_mfma_f32_16x16x32_bf16 v[52:55], a[104:107], a[44:47], v[52:55]
ds_read_b64_tr_b16 a[96:97], v12 offset:512
v_mfma_f32_16x16x32_bf16 v[52:55], a[108:111], a[60:63], v[52:55]
ds_read_b64_tr_b16 a[98:99], v12 offset:1536
v_mfma_f32_16x16x32_bf16 v[44:47], a[108:111], a[56:59], v[44:47]
ds_read_b64_tr_b16 a[100:101], v12 offset:8704
s_add_u32 s8, s28, 0x4000
v_mfma_f32_16x16x32_bf16 v[44:47], a[104:107], a[40:43], v[44:47]
buffer_store_dwordx4 a[192:195], v16, s[88:91], s8 offen sc1
v_mfma_f32_16x16x32_bf16 v[36:39], a[104:107], a[36:39], v[36:39]
ds_read_b64_tr_b16 a[102:103], v12 offset:9728
v_mfma_f32_16x16x32_bf16 v[36:39], a[108:111], a[52:55], v[36:39]
ds_read_b128 a[20:23], v9 offset:2048
v_mfma_f32_16x16x32_bf16 v[28:31], a[108:111], a[48:51], v[28:31]
ds_read_b128 a[8:11], v8 offset:4096
v_mfma_f32_16x16x32_bf16 v[28:31], a[104:107], a[32:35], v[28:31]
ds_read_b128 a[24:27], v9 offset:4096
s_waitcnt lgkmcnt(10)
v_mfma_f32_16x16x32_bf16 v[56:59], a[80:83], a[32:35], v[56:59]
ds_read_b64_tr_b16 a[104:105], v13 offset:512
v_mfma_f32_16x16x32_bf16 v[56:59], a[84:87], a[48:51], v[56:59]
ds_read_b64_tr_b16 a[106:107], v13 offset:1536
s_add_u32 m0, s18, 0x5000
v_mfma_f32_16x16x32_bf16 v[64:67], a[84:87], a[52:55], v[64:67]
buffer_load_dwordx4 v7, s[68:71], s25 offen lds
v_mfma_f32_16x16x32_bf16 v[64:67], a[80:83], a[36:39], v[64:67]
ds_read_b64_tr_b16 a[108:109], v13 offset:8704
v_mfma_f32_16x16x32_bf16 v[72:75], a[80:83], a[40:43], v[72:75]
ds_read_b64_tr_b16 a[110:111], v13 offset:9728
v_mfma_f32_16x16x32_bf16 v[72:75], a[84:87], a[56:59], v[72:75]
ds_read_b128 a[12:15], v8 offset:6144
v_mfma_f32_16x16x32_bf16 v[80:83], a[84:87], a[60:63], v[80:83]
ds_read_b128 a[28:31], v9 offset:6144
v_mfma_f32_16x16x32_bf16 v[80:83], a[80:83], a[44:47], v[80:83]
v_mfma_f32_16x16x32_bf16 v[84:87], a[88:91], a[44:47], v[84:87]
ds_read_b64_tr_b16 a[80:81], v12 offset:768
s_add_u32 m0, s18, 0x6000
v_mfma_f32_16x16x32_bf16 v[84:87], a[92:95], a[60:63], v[84:87]
buffer_load_dwordx4 v7, s[68:71], s26 offen lds
v_mfma_f32_16x16x32_bf16 v[76:79], a[92:95], a[56:59], v[76:79]
ds_read_b64_tr_b16 a[82:83], v12 offset:1792
v_lshl_add_u32 v5, s42, 19, v5
v_mfma_f32_16x16x32_bf16 v[76:79], a[88:91], a[40:43], v[76:79]
ds_read_b64_tr_b16 a[84:85], v12 offset:8960
v_lshl_add_u32 v6, s42, 19, v6
v_mfma_f32_16x16x32_bf16 v[68:71], a[88:91], a[36:39], v[68:71]
ds_read_b64_tr_b16 a[86:87], v12 offset:9984
v_lshl_add_u32 v7, s42, 18, v7
v_mfma_f32_16x16x32_bf16 v[68:71], a[92:95], a[52:55], v[68:71]
v_lshl_add_u32 v7, s42, 17, v7
v_mfma_f32_16x16x32_bf16 v[60:63], a[92:95], a[48:51], v[60:63]
v_mfma_f32_16x16x32_bf16 v[60:63], a[88:91], a[32:35], v[60:63]
s_add_u32 m0, s16, 0x0
s_waitcnt lgkmcnt(4)
s_waitcnt lgkmcnt(6)
v_mfma_f32_16x16x32_bf16 v[88:91], a[96:99], a[32:35], v[88:91]
buffer_load_dwordx4 v22, s[44:47], s20 offen lds
v_mfma_f32_16x16x32_bf16 v[88:91], a[100:103], a[48:51], v[88:91]
ds_read_b64_tr_b16 a[88:89], v13 offset:768
v_mfma_f32_16x16x32_bf16 v[96:99], a[100:103], a[52:55], v[96:99]
ds_read_b64_tr_b16 a[90:91], v13 offset:1792
v_mfma_f32_16x16x32_bf16 v[96:99], a[96:99], a[36:39], v[96:99]
ds_read_b64_tr_b16 a[92:93], v13 offset:8960
v_mfma_f32_16x16x32_bf16 v[104:107], a[96:99], a[40:43], v[104:107]
ds_read_b64_tr_b16 a[94:95], v13 offset:9984
s_add_u32 m0, s16, 0x400
v_mfma_f32_16x16x32_bf16 v[104:107], a[100:103], a[56:59], v[104:107]
buffer_load_dwordx4 v23, s[44:47], s20 offen lds
v_mfma_f32_16x16x32_bf16 v[112:115], a[100:103], a[60:63], v[112:115]
v_mfma_f32_16x16x32_bf16 v[112:115], a[96:99], a[44:47], v[112:115]
v_mfma_f32_16x16x32_bf16 v[116:119], a[104:107], a[44:47], v[116:119]
ds_read_b64_tr_b16 a[96:97], v14 offset:0
v_mfma_f32_16x16x32_bf16 v[116:119], a[108:111], a[60:63], v[116:119]
ds_read_b64_tr_b16 a[98:99], v14 offset:256
v_mfma_f32_16x16x32_bf16 v[108:111], a[108:111], a[56:59], v[108:111]
ds_read_b64_tr_b16 a[100:101], v14 offset:2048
s_add_u32 m0, s16, 0x800
v_mfma_f32_16x16x32_bf16 v[108:111], a[104:107], a[40:43], v[108:111]
buffer_load_dwordx4 v22, s[44:47], s21 offen lds
v_mfma_f32_16x16x32_bf16 v[100:103], a[104:107], a[36:39], v[100:103]
ds_read_b64_tr_b16 a[102:103], v14 offset:2304
v_mfma_f32_16x16x32_bf16 v[100:103], a[108:111], a[52:55], v[100:103]
v_mfma_f32_16x16x32_bf16 v[92:95], a[108:111], a[48:51], v[92:95]
v_mfma_f32_16x16x32_bf16 v[92:95], a[104:107], a[32:35], v[92:95]
s_add_u32 s8, s28, 0x8000
s_waitcnt lgkmcnt(4)
v_mfma_f32_16x16x32_bf16 v[120:123], a[80:83], a[32:35], v[120:123]
buffer_store_dwordx4 a[196:199], v16, s[88:91], s8 offen sc1
v_mfma_f32_16x16x32_bf16 v[120:123], a[84:87], a[48:51], v[120:123]
ds_read_b64_tr_b16 a[104:105], v15 offset:0
v_mfma_f32_16x16x32_bf16 v[128:131], a[84:87], a[52:55], v[128:131]
ds_read_b64_tr_b16 a[106:107], v15 offset:256
v_mfma_f32_16x16x32_bf16 v[128:131], a[80:83], a[36:39], v[128:131]
ds_read_b64_tr_b16 a[108:109], v15 offset:2048
v_mfma_f32_16x16x32_bf16 v[136:139], a[80:83], a[40:43], v[136:139]
ds_read_b64_tr_b16 a[110:111], v15 offset:2304
v_mfma_f32_16x16x32_bf16 v[136:139], a[84:87], a[56:59], v[136:139]
s_add_u32 m0, s16, 0xc00
v_mfma_f32_16x16x32_bf16 v[144:147], a[84:87], a[60:63], v[144:147]
buffer_load_dwordx4 v23, s[44:47], s21 offen lds
v_mfma_f32_16x16x32_bf16 v[144:147], a[80:83], a[44:47], v[144:147]
L_padA7:
s_cmp_eq_u32 s95, 1
s_cbranch_scc1 L_padA11
v_mfma_f32_16x16x32_bf16 v[148:151], a[88:91], a[44:47], v[148:151]
ds_read_b64_tr_b16 a[80:81], v14 offset:4096
v_mfma_f32_16x16x32_bf16 v[148:151], a[92:95], a[60:63], v[148:151]
ds_read_b64_tr_b16 a[82:83], v14 offset:4352
v_mfma_f32_16x16x32_bf16 v[140:143], a[92:95], a[56:59], v[140:143]
ds_read_b64_tr_b16 a[84:85], v14 offset:6144
v_mfma_f32_16x16x32_bf16 v[140:143], a[88:91], a[40:43], v[140:143]
ds_read_b64_tr_b16 a[86:87], v14 offset:6400
s_add_u32 m0, s16, 0x1000
v_mfma_f32_16x16x32_bf16 v[132:135], a[88:91], a[36:39], v[132:135]
buffer_load_dwordx4 v22, s[44:47], s22 offen lds
v_mfma_f32_16x16x32_bf16 v[132:135], a[92:95], a[52:55], v[132:135]
v_mfma_f32_16x16x32_bf16 v[124:127], a[92:95], a[48:51], v[124:127]
v_mfma_f32_16x16x32_bf16 v[124:127], a[88:91], a[32:35], v[124:127]
s_waitcnt lgkmcnt(4)
v_mfma_f32_16x16x32_bf16 v[152:155], a[96:99], a[32:35], v[152:155]
ds_read_b64_tr_b16 a[88:89], v15 offset:4096
s_add_u32 m0, s16, 0x1400
v_mfma_f32_16x16x32_bf16 v[152:155], a[100:103], a[48:51], v[152:155]
buffer_load_dwordx4 v23, s[44:47], s22 offen lds
v_mfma_f32_16x16x32_bf16 v[160:163], a[100:103], a[52:55], v[160:163]
ds_read_b64_tr_b16 a[90:91], v15 offset:4352
v_mfma_f32_16x16x32_bf16 v[160:163], a[96:99], a[36:39], v[160:163]
ds_read_b64_tr_b16 a[92:93], v15 offset:6144
v_mfma_f32_16x16x32_bf16 v[168:171], a[96:99], a[40:43], v[168:171]
ds_read_b64_tr_b16 a[94:95], v15 offset:6400
v_mfma_f32_16x16x32_bf16 v[168:171], a[100:103], a[56:59], v[168:171]
v_mfma_f32_16x16x32_bf16 v[176:179], a[100:103], a[60:63], v[176:179]
s_add_u32 m0, s16, 0x1800
v_mfma_f32_16x16x32_bf16 v[176:179], a[96:99], a[44:47], v[176:179]
buffer_load_dwordx4 v22, s[44:47], s23 offen lds
v_mfma_f32_16x16x32_bf16 v[180:183], a[104:107], a[44:47], v[180:183]
ds_read_b64_tr_b16 a[96:97], v14 offset:8192
v_mfma_f32_16x16x32_bf16 v[180:183], a[108:111], a[60:63], v[180:183]
ds_read_b64_tr_b16 a[98:99], v14 offset:8448
v_mfma_f32_16x16x32_bf16 v[172:175], a[108:111], a[56:59], v[172:175]
ds_read_b64_tr_b16 a[100:101], v14 offset:10240
v_mfma_f32_16x16x32_bf16 v[172:175], a[104:107], a[40:43], v[172:175]
ds_read_b64_tr_b16 a[102:103], v14 offset:10496
s_add_u32 m0, s16, 0x1c00
v_mfma_f32_16x16x32_bf16 v[164:167], a[104:107], a[36:39], v[164:167]
buffer_load_dwordx4 v23, s[44:47], s23 offen lds
v_mfma_f32_16x16x32_bf16 v[164:167], a[108:111], a[52:55], v[164:167]
v_lshl_add_u32 v22, s42, 7, v22
v_lshl_add_u32 v23, s42, 7, v23
v_mfma_f32_16x16x32_bf16 v[156:159], a[108:111], a[48:51], v[156:159]
v_mfma_f32_16x16x32_bf16 v[156:159], a[104:107], a[32:35], v[156:159]
s_waitcnt lgkmcnt(4)
v_mfma_f32_16x16x32_bf16 v[184:187], a[80:83], a[32:35], v[184:187]
ds_read_b64_tr_b16 a[104:105], v15 offset:8192
v_mfma_f32_16x16x32_bf16 v[184:187], a[84:87], a[48:51], v[184:187]
ds_read_b64_tr_b16 a[106:107], v15 offset:8448
s_add_u32 s8, s28, 0x4400
v_mfma_f32_16x16x32_bf16 v[192:195], a[84:87], a[52:55], v[192:195]
buffer_store_dwordx4 a[200:203], v16, s[88:91], s8 offen sc1
v_mfma_f32_16x16x32_bf16 v[192:195], a[80:83], a[36:39], v[192:195]
ds_read_b64_tr_b16 a[108:109], v15 offset:10240
v_mfma_f32_16x16x32_bf16 v[200:203], a[80:83], a[40:43], v[200:203]
ds_read_b64_tr_b16 a[110:111], v15 offset:10496
v_add_u32 v12, 0x8000, v12
v_mfma_f32_16x16x32_bf16 v[200:203], a[84:87], a[56:59], v[200:203]
v_add_u32 v13, 0x8000, v13
v_add_u32 v14, 0x8000, v14
v_mfma_f32_16x16x32_bf16 v[208:211], a[84:87], a[60:63], v[208:211]
v_add_u32 v15, 0x8000, v15
v_mfma_f32_16x16x32_bf16 v[208:211], a[80:83], a[44:47], v[208:211]
v_mfma_f32_16x16x32_bf16 v[212:215], a[88:91], a[44:47], v[212:215]
s_waitcnt vmcnt(29) lgkmcnt(0)
v_mfma_f32_16x16x32_bf16 v[212:215], a[92:95], a[60:63], v[212:215]
s_barrier
s_add_u32 m0, s17, 0x8000
v_mfma_f32_16x16x32_bf16 v[204:207], a[92:95], a[56:59], v[204:207]
buffer_load_dwordx4 v5, s[52:55], 0 offen lds
v_mfma_f32_16x16x32_bf16 v[204:207], a[88:91], a[40:43], v[204:207]
ds_read_b64_tr_b16 a[80:81], v12 offset:0
v_mfma_f32_16x16x32_bf16 v[196:199], a[88:91], a[36:39], v[196:199]
ds_read_b64_tr_b16 a[82:83], v12 offset:1024
v_mfma_f32_16x16x32_bf16 v[196:199], a[92:95], a[52:55], v[196:199]
ds_read_b64_tr_b16 a[84:85], v12 offset:8192
v_mfma_f32_16x16x32_bf16 v[188:191], a[92:95], a[48:51], v[188:191]
ds_read_b64_tr_b16 a[86:87], v12 offset:9216
v_mfma_f32_16x16x32_bf16 v[188:191], a[88:91], a[32:35], v[188:191]
s_add_u32 m0, s17, 0x8400
s_waitcnt lgkmcnt(4)
v_mfma_f32_16x16x32_bf16 v[216:219], a[32:35], a[96:99], v[216:219]
buffer_load_dwordx4 v5, s[52:55], s13 offen lds
v_mfma_f32_16x16x32_bf16 v[216:219], a[48:51], a[100:103], v[216:219]
ds_read_b64_tr_b16 a[88:89], v13 offset:0
v_mfma_f32_16x16x32_bf16 v[224:227], a[52:55], a[100:103], v[224:227]
ds_read_b64_tr_b16 a[90:91], v13 offset:1024
v_mfma_f32_16x16x32_bf16 v[224:227], a[36:39], a[96:99], v[224:227]
ds_read_b64_tr_b16 a[92:93], v13 offset:8192
v_mfma_f32_16x16x32_bf16 v[232:235], a[40:43], a[96:99], v[232:235]
ds_read_b64_tr_b16 a[94:95], v13 offset:9216
v_mfma_f32_16x16x32_bf16 v[232:235], a[56:59], a[100:103], v[232:235]
v_mfma_f32_16x16x32_bf16 v[240:243], a[60:63], a[100:103], v[240:243]
s_add_u32 m0, s17, 0x8800
v_mfma_f32_16x16x32_bf16 v[240:243], a[44:47], a[96:99], v[240:243]
buffer_load_dwordx4 v6, s[52:55], 0 offen lds
v_mfma_f32_16x16x32_bf16 v[244:247], a[44:47], a[104:107], v[244:247]
ds_read_b64_tr_b16 a[96:97], v12 offset:256
v_mfma_f32_16x16x32_bf16 v[244:247], a[60:63], a[108:111], v[244:247]
ds_read_b64_tr_b16 a[98:99], v12 offset:1280
v_mfma_f32_16x16x32_bf16 v[236:239], a[56:59], a[108:111], v[236:239]
ds_read_b64_tr_b16 a[100:101], v12 offset:8448
v_mfma_f32_16x16x32_bf16 v[236:239], a[40:43], a[104:107], v[236:239]
ds_read_b64_tr_b16 a[102:103], v12 offset:9472
v_mfma_f32_16x16x32_bf16 v[228:231], a[36:39], a[104:107], v[228:231]
v_mfma_f32_16x16x32_bf16 v[228:231], a[52:55], a[108:111], v[228:231]
s_add_u32 m0, s17, 0x8c00
v_mfma_f32_16x16x32_bf16 v[220:223], a[48:51], a[108:111], v[220:223]
buffer_load_dwordx4 v6, s[52:55], s13 offen lds
v_mfma_f32_16x16x32_bf16 v[220:223], a[32:35], a[104:107], v[220:223]
s_waitcnt lgkmcnt(4)
L_S14:
v_mfma_f32_16x16x32_bf16 v[24:27], a[80:83], a[0:3], v[24:27]
ds_read_b64_tr_b16 a[104:105], v13 offset:256
s_waitcnt vmcnt(23)
v_mfma_f32_16x16x32_bf16 v[24:27], a[84:87], a[16:19], v[24:27]
ds_read_b64_tr_b16 a[106:107], v13 offset:1280
v_mfma_f32_16x16x32_bf16 v[32:35], a[84:87], a[20:23], v[32:35]
ds_read_b64_tr_b16 a[108:109], v13 offset:8448
v_mfma_f32_16x16x32_bf16 v[32:35], a[80:83], a[4:7], v[32:35]
ds_read_b64_tr_b16 a[110:111], v13 offset:9472
v_mfma_f32_16x16x32_bf16 v[40:43], a[80:83], a[8:11], v[40:43]
ds_read_b128 a[32:35], v8 offset:32768
s_add_u32 m0, s18, 0xc000
v_mfma_f32_16x16x32_bf16 v[40:43], a[84:87], a[24:27], v[40:43]
buffer_load_dwordx4 v7, s[68:71], 0 offen lds
v_mfma_f32_16x16x32_bf16 v[48:51], a[84:87], a[28:31], v[48:51]
ds_read_b128 a[48:51], v9 offset:32768
v_mfma_f32_16x16x32_bf16 v[48:51], a[80:83], a[12:15], v[48:51]
ds_read_b128 a[36:39], v8 offset:34816
v_mfma_f32_16x16x32_bf16 v[52:55], a[88:91], a[12:15], v[52:55]
ds_read_b64_tr_b16 a[80:81], v12 offset:512
v_mfma_f32_16x16x32_bf16 v[52:55], a[92:95], a[28:31], v[52:55]
ds_read_b64_tr_b16 a[82:83], v12 offset:1536
v_mfma_f32_16x16x32_bf16 v[44:47], a[92:95], a[24:27], v[44:47]
ds_read_b64_tr_b16 a[84:85], v12 offset:8704
s_add_u32 s8, s28, 0x8400
v_mfma_f32_16x16x32_bf16 v[44:47], a[88:91], a[8:11], v[44:47]
buffer_store_dwordx4 a[204:207], v16, s[88:91], s8 offen sc1
v_mfma_f32_16x16x32_bf16 v[36:39], a[88:91], a[4:7], v[36:39]
ds_read_b64_tr_b16 a[86:87], v12 offset:9728
v_mfma_f32_16x16x32_bf16 v[36:39], a[92:95], a[20:23], v[36:39]
ds_read_b128 a[52:55], v9 offset:34816
v_mfma_f32_16x16x32_bf16 v[28:31], a[92:95], a[16:19], v[28:31]
ds_read_b128 a[40:43], v8 offset:36864
v_mfma_f32_16x16x32_bf16 v[28:31], a[88:91], a[0:3], v[28:31]
ds_read_b128 a[56:59], v9 offset:36864
s_waitcnt lgkmcnt(10)
v_mfma_f32_16x16x32_bf16 v[56:59], a[96:99], a[0:3], v[56:59]
ds_read_b64_tr_b16 a[88:89], v13 offset:512
v_mfma_f32_16x16x32_bf16 v[56:59], a[100:103], a[16:19], v[56:59]
ds_read_b64_tr_b16 a[90:91], v13 offset:1536
s_add_u32 m0, s18, 0xd000
v_mfma_f32_16x16x32_bf16 v[64:67], a[100:103], a[20:23], v[64:67]
buffer_load_dwordx4 v7, s[68:71], s25 offen lds
v_mfma_f32_16x16x32_bf16 v[64:67], a[96:99], a[4:7], v[64:67]
ds_read_b64_tr_b16 a[92:93], v13 offset:8704
v_mfma_f32_16x16x32_bf16 v[72:75], a[96:99], a[8:11], v[72:75]
ds_read_b64_tr_b16 a[94:95], v13 offset:9728
v_mfma_f32_16x16x32_bf16 v[72:75], a[100:103], a[24:27], v[72:75]
ds_read_b128 a[44:47], v8 offset:38912
v_mfma_f32_16x16x32_bf16 v[80:83], a[100:103], a[28:31], v[80:83]
ds_read_b128 a[60:63], v9 offset:38912
v_mfma_f32_16x16x32_bf16 v[80:83], a[96:99], a[12:15], v[80:83]
v_mfma_f32_16x16x32_bf16 v[84:87], a[104:107], a[12:15], v[84:87]
ds_read_b64_tr_b16 a[96:97], v12 offset:768
s_add_u32 m0, s18, 0xe000
v_mfma_f32_16x16x32_bf16 v[84:87], a[108:111], a[28:31], v[84:87]
buffer_load_dwordx4 v7, s[68:71], s26 offen lds
v_mfma_f32_16x16x32_bf16 v[76:79], a[108:111], a[24:27], v[76:79]
ds_read_b64_tr_b16 a[98:99], v12 offset:1792
v_lshl_add_u32 v5, s42, 19, v5
v_mfma_f32_16x16x32_bf16 v[76:79], a[104:107], a[8:11], v[76:79]
ds_read_b64_tr_b16 a[100:101], v12 offset:8960
v_lshl_add_u32 v6, s42, 19, v6
v_mfma_f32_16x16x32_bf16 v[68:71], a[104:107], a[4:7], v[68:71]
ds_read_b64_tr_b16 a[102:103], v12 offset:9984
v_lshl_add_u32 v7, s42, 18, v7
v_mfma_f32_16x16x32_bf16 v[68:71], a[108:111], a[20:23], v[68:71]
v_lshl_add_u32 v7, s42, 17, v7
v_mfma_f32_16x16x32_bf16 v[60:63], a[108:111], a[16:19], v[60:63]
v_mfma_f32_16x16x32_bf16 v[60:63], a[104:107], a[0:3], v[60:63]
s_add_u32 m0, s16, 0x8000
s_waitcnt lgkmcnt(4)
s_waitcnt lgkmcnt(6)
v_mfma_f32_16x16x32_bf16 v[88:91], a[80:83], a[0:3], v[88:91]
buffer_load_dwordx4 v22, s[44:47], s20 offen lds
v_mfma_f32_16x16x32_bf16 v[88:91], a[84:87], a[16:19], v[88:91]
ds_read_b64_tr_b16 a[104:105], v13 offset:768
v_mfma_f32_16x16x32_bf16 v[96:99], a[84:87], a[20:23], v[96:99]
ds_read_b64_tr_b16 a[106:107], v13 offset:1792
v_mfma_f32_16x16x32_bf16 v[96:99], a[80:83], a[4:7], v[96:99]
ds_read_b64_tr_b16 a[108:109], v13 offset:8960
v_mfma_f32_16x16x32_bf16 v[104:107], a[80:83], a[8:11], v[104:107]
ds_read_b64_tr_b16 a[110:111], v13 offset:9984
s_add_u32 m0, s16, 0x8400
v_mfma_f32_16x16x32_bf16 v[104:107], a[84:87], a[24:27], v[104:107]
buffer_load_dwordx4 v23, s[44:47], s20 offen lds
v_mfma_f32_16x16x32_bf16 v[112:115], a[84:87], a[28:31], v[112:115]
v_mfma_f32_16x16x32_bf16 v[112:115], a[80:83], a[12:15], v[112:115]
v_mfma_f32_16x16x32_bf16 v[116:119], a[88:91], a[12:15], v[116:119]
ds_read_b64_tr_b16 a[80:81], v14 offset:0
v_mfma_f32_16x16x32_bf16 v[116:119], a[92:95], a[28:31], v[116:119]
ds_read_b64_tr_b16 a[82:83], v14 offset:256
v_mfma_f32_16x16x32_bf16 v[108:111], a[92:95], a[24:27], v[108:111]
ds_read_b64_tr_b16 a[84:85], v14 offset:2048
s_add_u32 m0, s16, 0x8800
v_mfma_f32_16x16x32_bf16 v[108:111], a[88:91], a[8:11], v[108:111]
buffer_load_dwordx4 v22, s[44:47], s21 offen lds
v_mfma_f32_16x16x32_bf16 v[100:103], a[88:91], a[4:7], v[100:103]
ds_read_b64_tr_b16 a[86:87], v14 offset:2304
v_mfma_f32_16x16x32_bf16 v[100:103], a[92:95], a[20:23], v[100:103]
v_mfma_f32_16x16x32_bf16 v[92:95], a[92:95], a[16:19], v[92:95]
v_mfma_f32_16x16x32_bf16 v[92:95], a[88:91], a[0:3], v[92:95]
s_add_u32 s8, s28, 0x4800
s_waitcnt lgkmcnt(4)
v_mfma_f32_16x16x32_bf16 v[120:123], a[96:99], a[0:3], v[120:123]
buffer_store_dwordx4 a[208:211], v16, s[88:91], s8 offen sc1
v_mfma_f32_16x16x32_bf16 v[120:123], a[100:103], a[16:19], v[120:123]
ds_read_b64_tr_b16 a[88:89], v15 offset:0
v_mfma_f32_16x16x32_bf16 v[128:131], a[100:103], a[20:23], v[128:131]
ds_read_b64_tr_b16 a[90:91], v15 offset:256
v_mfma_f32_16x16x32_bf16 v[128:131], a[96:99], a[4:7], v[128:131]
ds_read_b64_tr_b16 a[92:93], v15 offset:2048
v_mfma_f32_16x16x32_bf16 v[136:139], a[96:99], a[8:11], v[136:139]
ds_read_b64_tr_b16 a[94:95], v15 offset:2304
v_mfma_f32_16x16x32_bf16 v[136:139], a[100:103], a[24:27], v[136:139]
s_add_u32 m0, s16, 0x8c00
v_mfma_f32_16x16x32_bf16 v[144:147], a[100:103], a[28:31], v[144:147]
buffer_load_dwordx4 v23, s[44:47], s21 offen lds
v_mfma_f32_16x16x32_bf16 v[144:147], a[96:99], a[12:15], v[144:147]
v_mfma_f32_16x16x32_bf16 v[148:151], a[104:107], a[12:15], v[148:151]
ds_read_b64_tr_b16 a[96:97], v14 offset:4096
v_mfma_f32_16x16x32_bf16 v[148:151], a[108:111], a[28:31], v[148:151]
ds_read_b64_tr_b16 a[98:99], v14 offset:4352
v_mfma_f32_16x16x32_bf16 v[140:143], a[108:111], a[24:27], v[140:143]
ds_read_b64_tr_b16 a[100:101], v14 offset:6144
v_mfma_f32_16x16x32_bf16 v[140:143], a[104:107], a[8:11], v[140:143]
ds_read_b64_tr_b16 a[102:103], v14 offset:6400
s_add_u32 m0, s16, 0x9000
v_mfma_f32_16x16x32_bf16 v[132:135], a[104:107], a[4:7], v[132:135]
buffer_load_dwordx4 v22, s[44:47], s22 offen lds
v_mfma_f32_16x16x32_bf16 v[132:135], a[108:111], a[20:23], v[132:135]
v_mfma_f32_16x16x32_bf16 v[124:127], a[108:111], a[16:19], v[124:127]
v_mfma_f32_16x16x32_bf16 v[124:127], a[104:107], a[0:3], v[124:127]
s_waitcnt lgkmcnt(4)
v_mfma_f32_16x16x32_bf16 v[152:155], a[80:83], a[0:3], v[152:155]
ds_read_b64_tr_b16 a[104:105], v15 offset:4096
s_add_u32 m0, s16, 0x9400
v_mfma_f32_16x16x32_bf16 v[152:155], a[84:87], a[16:19], v[152:155]
buffer_load_dwordx4 v23, s[44:47], s22 offen lds
v_mfma_f32_16x16x32_bf16 v[160:163], a[84:87], a[20:23], v[160:163]
ds_read_b64_tr_b16 a[106:107], v15 offset:4352
v_mfma_f32_16x16x32_bf16 v[160:163], a[80:83], a[4:7], v[160:163]
ds_read_b64_tr_b16 a[108:109], v15 offset:6144
v_mfma_f32_16x16x32_bf16 v[168:171], a[80:83], a[8:11], v[168:171]
ds_read_b64_tr_b16 a[110:111], v15 offset:6400
v_mfma_f32_16x16x32_bf16 v[168:171], a[84:87], a[24:27], v[168:171]
v_mfma_f32_16x16x32_bf16 v[176:179], a[84:87], a[28:31], v[176:179]
s_add_u32 m0, s16, 0x9800
v_mfma_f32_16x16x32_bf16 v[176:179], a[80:83], a[12:15], v[176:179]
buffer_load_dwordx4 v22, s[44:47], s23 offen lds
v_mfma_f32_16x16x32_bf16 v[180:183], a[88:91], a[12:15], v[180:183]
ds_read_b64_tr_b16 a[80:81], v14 offset:8192
v_mfma_f32_16x16x32_bf16 v[180:183], a[92:95], a[28:31], v[180:183]
ds_read_b64_tr_b16 a[82:83], v14 offset:8448
v_mfma_f32_16x16x32_bf16 v[172:175], a[92:95], a[24:27], v[172:175]
ds_read_b64_tr_b16 a[84:85], v14 offset:10240
v_mfma_f32_16x16x32_bf16 v[172:175], a[88:91], a[8:11], v[172:175]
ds_read_b64_tr_b16 a[86:87], v14 offset:10496
s_add_u32 m0, s16, 0x9c00
v_mfma_f32_16x16x32_bf16 v[164:167], a[88:91], a[4:7], v[164:167]
buffer_load_dwordx4 v23, s[44:47], s23 offen lds
v_mfma_f32_16x16x32_bf16 v[164:167], a[92:95], a[20:23], v[164:167]
v_lshl_add_u32 v22, s42, 7, v22
v_lshl_add_u32 v23, s42, 7, v23
v_mfma_f32_16x16x32_bf16 v[156:159], a[92:95], a[16:19], v[156:159]
v_mfma_f32_16x16x32_bf16 v[156:159], a[88:91], a[0:3], v[156:159]
s_waitcnt lgkmcnt(4)
v_mfma_f32_16x16x32_bf16 v[184:187], a[96:99], a[0:3], v[184:187]
ds_read_b64_tr_b16 a[88:89], v15 offset:8192
v_mfma_f32_16x16x32_bf16 v[184:187], a[100:103], a[16:19], v[184:187]
ds_read_b64_tr_b16 a[90:91], v15 offset:8448
s_add_u32 s8, s28, 0x8800
v_mfma_f32_16x16x32_bf16 v[192:195], a[100:103], a[20:23], v[192:195]
buffer_store_dwordx4 a[212:215], v16, s[88:91], s8 offen sc1
v_mfma_f32_16x16x32_bf16 v[192:195], a[96:99], a[4:7], v[192:195]
ds_read_b64_tr_b16 a[92:93], v15 offset:10240
v_mfma_f32_16x16x32_bf16 v[200:203], a[96:99], a[8:11], v[200:203]
ds_read_b64_tr_b16 a[94:95], v15 offset:10496
v_add_u32 v12, 0xffff0000, v12
v_mfma_f32_16x16x32_bf16 v[200:203], a[100:103], a[24:27], v[200:203]
v_add_u32 v13, 0xffff0000, v13
v_add_u32 v14, 0xffff0000, v14
v_mfma_f32_16x16x32_bf16 v[208:211], a[100:103], a[28:31], v[208:211]
v_add_u32 v15, 0xffff0000, v15
v_mfma_f32_16x16x32_bf16 v[208:211], a[96:99], a[12:15], v[208:211]
v_mfma_f32_16x16x32_bf16 v[212:215], a[104:107], a[12:15], v[212:215]
s_waitcnt vmcnt(28) lgkmcnt(0)
v_mfma_f32_16x16x32_bf16 v[212:215], a[108:111], a[28:31], v[212:215]
s_barrier
s_add_u32 m0, s17, 0x10000
v_mfma_f32_16x16x32_bf16 v[204:207], a[108:111], a[24:27], v[204:207]
buffer_load_dwordx4 v5, s[52:55], 0 offen lds
v_mfma_f32_16x16x32_bf16 v[204:207], a[104:107], a[8:11], v[204:207]
ds_read_b64_tr_b16 a[96:97], v12 offset:0
v_mfma_f32_16x16x32_bf16 v[196:199], a[104:107], a[4:7], v[196:199]
ds_read_b64_tr_b16 a[98:99], v12 offset:1024
v_mfma_f32_16x16x32_bf16 v[196:199], a[108:111], a[20:23], v[196:199]
ds_read_b64_tr_b16 a[100:101], v12 offset:8192
v_mfma_f32_16x16x32_bf16 v[188:191], a[108:111], a[16:19], v[188:191]
ds_read_b64_tr_b16 a[102:103], v12 offset:9216
v_mfma_f32_16x16x32_bf16 v[188:191], a[104:107], a[0:3], v[188:191]
s_add_u32 m0, s17, 0x10400
s_waitcnt lgkmcnt(4)
v_mfma_f32_16x16x32_bf16 v[216:219], a[0:3], a[80:83], v[216:219]
buffer_load_dwordx4 v5, s[52:55], s13 offen lds
v_mfma_f32_16x16x32_bf16 v[216:219], a[16:19], a[84:87], v[216:219]
ds_read_b64_tr_b16 a[104:105], v13 offset:0
v_mfma_f32_16x16x32_bf16 v[224:227], a[20:23], a[84:87], v[224:227]
ds_read_b64_tr_b16 a[106:107], v13 offset:1024
v_mfma_f32_16x16x32_bf16 v[224:227], a[4:7], a[80:83], v[224:227]
ds_read_b64_tr_b16 a[108:109], v13 offset:8192
v_mfma_f32_16x16x32_bf16 v[232:235], a[8:11], a[80:83], v[232:235]
ds_read_b64_tr_b16 a[110:111], v13 offset:9216
v_mfma_f32_16x16x32_bf16 v[232:235], a[24:27], a[84:87], v[232:235]
v_mfma_f32_16x16x32_bf16 v[240:243], a[28:31], a[84:87], v[240:243]
s_add_u32 m0, s17, 0x10800
v_mfma_f32_16x16x32_bf16 v[240:243], a[12:15], a[80:83], v[240:243]
buffer_load_dwordx4 v6, s[52:55], 0 offen lds
v_mfma_f32_16x16x32_bf16 v[244:247], a[12:15], a[88:91], v[244:247]
ds_read_b64_tr_b16 a[80:81], v12 offset:256
v_mfma_f32_16x16x32_bf16 v[244:247], a[28:31], a[92:95], v[244:247]
ds_read_b64_tr_b16 a[82:83], v12 offset:1280
v_mfma_f32_16x16x32_bf16 v[236:239], a[24:27], a[92:95], v[236:239]
ds_read_b64_tr_b16 a[84:85], v12 offset:8448
v_mfma_f32_16x16x32_bf16 v[236:239], a[8:11], a[88:91], v[236:239]
ds_read_b64_tr_b16 a[86:87], v12 offset:9472
v_mfma_f32_16x16x32_bf16 v[228:231], a[4:7], a[88:91], v[228:231]
v_mfma_f32_16x16x32_bf16 v[228:231], a[20:23], a[92:95], v[228:231]
s_add_u32 m0, s17, 0x10c00
v_mfma_f32_16x16x32_bf16 v[220:223], a[16:19], a[92:95], v[220:223]
buffer_load_dwordx4 v6, s[52:55], s13 offen lds
v_mfma_f32_16x16x32_bf16 v[220:223], a[0:3], a[88:91], v[220:223]
s_waitcnt lgkmcnt(4)
L_S15:
v_mfma_f32_16x16x32_bf16 v[24:27], a[96:99], a[32:35], v[24:27]
ds_read_b64_tr_b16 a[88:89], v13 offset:256
s_waitcnt vmcnt(23)
v_mfma_f32_16x16x32_bf16 v[24:27], a[100:103], a[48:51], v[24:27]
ds_read_b64_tr_b16 a[90:91], v13 offset:1280
v_mfma_f32_16x16x32_bf16 v[32:35], a[100:103], a[52:55], v[32:35]
ds_read_b64_tr_b16 a[92:93], v13 offset:8448
v_mfma_f32_16x16x32_bf16 v[32:35], a[96:99], a[36:39], v[32:35]
ds_read_b64_tr_b16 a[94:95], v13 offset:9472
v_mfma_f32_16x16x32_bf16 v[40:43], a[96:99], a[40:43], v[40:43]
ds_read_b128 a[0:3], v8 offset:0
s_add_u32 m0, s18, 0x14000
v_mfma_f32_16x16x32_bf16 v[40:43], a[100:103], a[56:59], v[40:43]
buffer_load_dwordx4 v7, s[68:71], 0 offen lds
v_mfma_f32_16x16x32_bf16 v[48:51], a[100:103], a[60:63], v[48:51]
ds_read_b128 a[16:19], v9 offset:0
v_mfma_f32_16x16x32_bf16 v[48:51], a[96:99], a[44:47], v[48:51]
ds_read_b128 a[4:7], v8 offset:2048
v_mfma_f32_16x16x32_bf16 v[52:55], a[104:107], a[44:47], v[52:55]
ds_read_b64_tr_b16 a[96:97], v12 offset:512
v_mfma_f32_16x16x32_bf16 v[52:55], a[108:111], a[60:63], v[52:55]
ds_read_b64_tr_b16 a[98:99], v12 offset:1536
v_mfma_f32_16x16x32_bf16 v[44:47], a[108:111], a[56:59], v[44:47]
ds_read_b64_tr_b16 a[100:101], v12 offset:8704
s_add_u32 s8, s28, 0x4c00
v_mfma_f32_16x16x32_bf16 v[44:47], a[104:107], a[40:43], v[44:47]
buffer_store_dwordx4 a[216:219], v16, s[88:91], s8 offen sc1
v_mfma_f32_16x16x32_bf16 v[36:39], a[104:107], a[36:39], v[36:39]
ds_read_b64_tr_b16 a[102:103], v12 offset:9728
v_mfma_f32_16x16x32_bf16 v[36:39], a[108:111], a[52:55], v[36:39]
ds_read_b128 a[20:23], v9 offset:2048
v_mfma_f32_16x16x32_bf16 v[28:31], a[108:111], a[48:51], v[28:31]
ds_read_b128 a[8:11], v8 offset:4096
v_mfma_f32_16x16x32_bf16 v[28:31], a[104:107], a[32:35], v[28:31]
ds_read_b128 a[24:27], v9 offset:4096
s_waitcnt lgkmcnt(10)
v_mfma_f32_16x16x32_bf16 v[56:59], a[80:83], a[32:35], v[56:59]
ds_read_b64_tr_b16 a[104:105], v13 offset:512
v_mfma_f32_16x16x32_bf16 v[56:59], a[84:87], a[48:51], v[56:59]
ds_read_b64_tr_b16 a[106:107], v13 offset:1536
s_add_u32 m0, s18, 0x15000
v_mfma_f32_16x16x32_bf16 v[64:67], a[84:87], a[52:55], v[64:67]
buffer_load_dwordx4 v7, s[68:71], s25 offen lds
v_mfma_f32_16x16x32_bf16 v[64:67], a[80:83], a[36:39], v[64:67]
ds_read_b64_tr_b16 a[108:109], v13 offset:8704
v_mfma_f32_16x16x32_bf16 v[72:75], a[80:83], a[40:43], v[72:75]
ds_read_b64_tr_b16 a[110:111], v13 offset:9728
v_mfma_f32_16x16x32_bf16 v[72:75], a[84:87], a[56:59], v[72:75]
ds_read_b128 a[12:15], v8 offset:6144
v_mfma_f32_16x16x32_bf16 v[80:83], a[84:87], a[60:63], v[80:83]
ds_read_b128 a[28:31], v9 offset:6144
v_mfma_f32_16x16x32_bf16 v[80:83], a[80:83], a[44:47], v[80:83]
v_mfma_f32_16x16x32_bf16 v[84:87], a[88:91], a[44:47], v[84:87]
ds_read_b64_tr_b16 a[80:81], v12 offset:768
s_add_u32 m0, s18, 0x16000
v_mfma_f32_16x16x32_bf16 v[84:87], a[92:95], a[60:63], v[84:87]
buffer_load_dwordx4 v7, s[68:71], s26 offen lds
v_mfma_f32_16x16x32_bf16 v[76:79], a[92:95], a[56:59], v[76:79]
ds_read_b64_tr_b16 a[82:83], v12 offset:1792
v_lshl_add_u32 v5, s42, 19, v5
v_mfma_f32_16x16x32_bf16 v[76:79], a[88:91], a[40:43], v[76:79]
ds_read_b64_tr_b16 a[84:85], v12 offset:8960
v_lshl_add_u32 v6, s42, 19, v6
v_mfma_f32_16x16x32_bf16 v[68:71], a[88:91], a[36:39], v[68:71]
ds_read_b64_tr_b16 a[86:87], v12 offset:9984
v_lshl_add_u32 v7, s42, 18, v7
v_mfma_f32_16x16x32_bf16 v[68:71], a[92:95], a[52:55], v[68:71]
v_lshl_add_u32 v7, s42, 17, v7
v_mfma_f32_16x16x32_bf16 v[60:63], a[92:95], a[48:51], v[60:63]
v_mfma_f32_16x16x32_bf16 v[60:63], a[88:91], a[32:35], v[60:63]
s_add_u32 m0, s16, 0x0
s_waitcnt lgkmcnt(4)
s_waitcnt lgkmcnt(6)
v_mfma_f32_16x16x32_bf16 v[88:91], a[96:99], a[32:35], v[88:91]
buffer_load_dwordx4 v22, s[44:47], s20 offen lds
v_mfma_f32_16x16x32_bf16 v[88:91], a[100:103], a[48:51], v[88:91]
ds_read_b64_tr_b16 a[88:89], v13 offset:768
v_mfma_f32_16x16x32_bf16 v[96:99], a[100:103], a[52:55], v[96:99]
ds_read_b64_tr_b16 a[90:91], v13 offset:1792
v_mfma_f32_16x16x32_bf16 v[96:99], a[96:99], a[36:39], v[96:99]
ds_read_b64_tr_b16 a[92:93], v13 offset:8960
v_mfma_f32_16x16x32_bf16 v[104:107], a[96:99], a[40:43], v[104:107]
ds_read_b64_tr_b16 a[94:95], v13 offset:9984
s_add_u32 m0, s16, 0x400
v_mfma_f32_16x16x32_bf16 v[104:107], a[100:103], a[56:59], v[104:107]
buffer_load_dwordx4 v23, s[44:47], s20 offen lds
v_mfma_f32_16x16x32_bf16 v[112:115], a[100:103], a[60:63], v[112:115]
v_mfma_f32_16x16x32_bf16 v[112:115], a[96:99], a[44:47], v[112:115]
v_mfma_f32_16x16x32_bf16 v[116:119], a[104:107], a[44:47], v[116:119]
ds_read_b64_tr_b16 a[96:97], v14 offset:0
v_mfma_f32_16x16x32_bf16 v[116:119], a[108:111], a[60:63], v[116:119]
ds_read_b64_tr_b16 a[98:99], v14 offset:256
v_mfma_f32_16x16x32_bf16 v[108:111], a[108:111], a[56:59], v[108:111]
ds_read_b64_tr_b16 a[100:101], v14 offset:2048
s_add_u32 m0, s16, 0x800
v_mfma_f32_16x16x32_bf16 v[108:111], a[104:107], a[40:43], v[108:111]
buffer_load_dwordx4 v22, s[44:47], s21 offen lds
v_mfma_f32_16x16x32_bf16 v[100:103], a[104:107], a[36:39], v[100:103]
ds_read_b64_tr_b16 a[102:103], v14 offset:2304
v_mfma_f32_16x16x32_bf16 v[100:103], a[108:111], a[52:55], v[100:103]
v_mfma_f32_16x16x32_bf16 v[92:95], a[108:111], a[48:51], v[92:95]
v_mfma_f32_16x16x32_bf16 v[92:95], a[104:107], a[32:35], v[92:95]
s_add_u32 s8, s28, 0x8c00
s_waitcnt lgkmcnt(4)
v_mfma_f32_16x16x32_bf16 v[120:123], a[80:83], a[32:35], v[120:123]
buffer_store_dwordx4 a[220:223], v16, s[88:91], s8 offen sc1
v_mfma_f32_16x16x32_bf16 v[120:123], a[84:87], a[48:51], v[120:123]
ds_read_b64_tr_b16 a[104:105], v15 offset:0
v_mfma_f32_16x16x32_bf16 v[128:131], a[84:87], a[52:55], v[128:131]
ds_read_b64_tr_b16 a[106:107], v15 offset:256
v_mfma_f32_16x16x32_bf16 v[128:131], a[80:83], a[36:39], v[128:131]
ds_read_b64_tr_b16 a[108:109], v15 offset:2048
v_mfma_f32_16x16x32_bf16 v[136:139], a[80:83], a[40:43], v[136:139]
ds_read_b64_tr_b16 a[110:111], v15 offset:2304
v_mfma_f32_16x16x32_bf16 v[136:139], a[84:87], a[56:59], v[136:139]
s_add_u32 m0, s16, 0xc00
v_mfma_f32_16x16x32_bf16 v[144:147], a[84:87], a[60:63], v[144:147]
buffer_load_dwordx4 v23, s[44:47], s21 offen lds
v_mfma_f32_16x16x32_bf16 v[144:147], a[80:83], a[44:47], v[144:147]
v_mfma_f32_16x16x32_bf16 v[148:151], a[88:91], a[44:47], v[148:151]
ds_read_b64_tr_b16 a[80:81], v14 offset:4096
v_mfma_f32_16x16x32_bf16 v[148:151], a[92:95], a[60:63], v[148:151]
ds_read_b64_tr_b16 a[82:83], v14 offset:4352
v_mfma_f32_16x16x32_bf16 v[140:143], a[92:95], a[56:59], v[140:143]
ds_read_b64_tr_b16 a[84:85], v14 offset:6144
v_mfma_f32_16x16x32_bf16 v[140:143], a[88:91], a[40:43], v[140:143]
ds_read_b64_tr_b16 a[86:87], v14 offset:6400
s_add_u32 m0, s16, 0x1000
v_mfma_f32_16x16x32_bf16 v[132:135], a[88:91], a[36:39], v[132:135]
buffer_load_dwordx4 v22, s[44:47], s22 offen lds
v_mfma_f32_16x16x32_bf16 v[132:135], a[92:95], a[52:55], v[132:135]
v_mfma_f32_16x16x32_bf16 v[124:127], a[92:95], a[48:51], v[124:127]
v_mfma_f32_16x16x32_bf16 v[124:127], a[88:91], a[32:35], v[124:127]
s_waitcnt lgkmcnt(4)
v_mfma_f32_16x16x32_bf16 v[152:155], a[96:99], a[32:35], v[152:155]
ds_read_b64_tr_b16 a[88:89], v15 offset:4096
s_add_u32 m0, s16, 0x1400
v_mfma_f32_16x16x32_bf16 v[152:155], a[100:103], a[48:51], v[152:155]
buffer_load_dwordx4 v23, s[44:47], s22 offen lds
v_mfma_f32_16x16x32_bf16 v[160:163], a[100:103], a[52:55], v[160:163]
ds_read_b64_tr_b16 a[90:91], v15 offset:4352
v_mfma_f32_16x16x32_bf16 v[160:163], a[96:99], a[36:39], v[160:163]
ds_read_b64_tr_b16 a[92:93], v15 offset:6144
v_mfma_f32_16x16x32_bf16 v[168:171], a[96:99], a[40:43], v[168:171]
ds_read_b64_tr_b16 a[94:95], v15 offset:6400
v_mfma_f32_16x16x32_bf16 v[168:171], a[100:103], a[56:59], v[168:171]
v_mfma_f32_16x16x32_bf16 v[176:179], a[100:103], a[60:63], v[176:179]
s_add_u32 m0, s16, 0x1800
v_mfma_f32_16x16x32_bf16 v[176:179], a[96:99], a[44:47], v[176:179]
buffer_load_dwordx4 v22, s[44:47], s23 offen lds
v_mfma_f32_16x16x32_bf16 v[180:183], a[104:107], a[44:47], v[180:183]
ds_read_b64_tr_b16 a[96:97], v14 offset:8192
v_mfma_f32_16x16x32_bf16 v[180:183], a[108:111], a[60:63], v[180:183]
ds_read_b64_tr_b16 a[98:99], v14 offset:8448
v_mfma_f32_16x16x32_bf16 v[172:175], a[108:111], a[56:59], v[172:175]
ds_read_b64_tr_b16 a[100:101], v14 offset:10240
v_mfma_f32_16x16x32_bf16 v[172:175], a[104:107], a[40:43], v[172:175]
ds_read_b64_tr_b16 a[102:103], v14 offset:10496
s_add_u32 m0, s16, 0x1c00
v_mfma_f32_16x16x32_bf16 v[164:167], a[104:107], a[36:39], v[164:167]
buffer_load_dwordx4 v23, s[44:47], s23 offen lds
v_mfma_f32_16x16x32_bf16 v[164:167], a[108:111], a[52:55], v[164:167]
v_lshl_add_u32 v22, s42, 7, v22
v_lshl_add_u32 v23, s42, 7, v23
v_mfma_f32_16x16x32_bf16 v[156:159], a[108:111], a[48:51], v[156:159]
v_mfma_f32_16x16x32_bf16 v[156:159], a[104:107], a[32:35], v[156:159]
s_waitcnt lgkmcnt(4)
v_mfma_f32_16x16x32_bf16 v[184:187], a[80:83], a[32:35], v[184:187]
ds_read_b64_tr_b16 a[104:105], v15 offset:8192
v_mfma_f32_16x16x32_bf16 v[184:187], a[84:87], a[48:51], v[184:187]
ds_read_b64_tr_b16 a[106:107], v15 offset:8448
s_add_u32 s8, s28, 0x5000
v_mfma_f32_16x16x32_bf16 v[192:195], a[84:87], a[52:55], v[192:195]
buffer_store_dwordx4 a[224:227], v16, s[88:91], s8 offen sc1
v_mfma_f32_16x16x32_bf16 v[192:195], a[80:83], a[36:39], v[192:195]
ds_read_b64_tr_b16 a[108:109], v15 offset:10240
v_mfma_f32_16x16x32_bf16 v[200:203], a[80:83], a[40:43], v[200:203]
ds_read_b64_tr_b16 a[110:111], v15 offset:10496
v_add_u32 v12, 0x8000, v12
v_mfma_f32_16x16x32_bf16 v[200:203], a[84:87], a[56:59], v[200:203]
v_add_u32 v13, 0x8000, v13
v_add_u32 v14, 0x8000, v14
v_mfma_f32_16x16x32_bf16 v[208:211], a[84:87], a[60:63], v[208:211]
L_padA8:
s_cmp_eq_u32 s95, 1
s_cbranch_scc1 L_padA12
v_add_u32 v15, 0x8000, v15
v_mfma_f32_16x16x32_bf16 v[208:211], a[80:83], a[44:47], v[208:211]
v_mfma_f32_16x16x32_bf16 v[212:215], a[88:91], a[44:47], v[212:215]
s_waitcnt vmcnt(28) lgkmcnt(0)
v_mfma_f32_16x16x32_bf16 v[212:215], a[92:95], a[60:63], v[212:215]
s_barrier
s_add_u32 m0, s17, 0x0
v_mfma_f32_16x16x32_bf16 v[204:207], a[92:95], a[56:59], v[204:207]
buffer_load_dwordx4 v5, s[52:55], 0 offen lds
v_mfma_f32_16x16x32_bf16 v[204:207], a[88:91], a[40:43], v[204:207]
ds_read_b64_tr_b16 a[80:81], v12 offset:0
v_mfma_f32_16x16x32_bf16 v[196:199], a[88:91], a[36:39], v[196:199]
ds_read_b64_tr_b16 a[82:83], v12 offset:1024
v_mfma_f32_16x16x32_bf16 v[196:199], a[92:95], a[52:55], v[196:199]
ds_read_b64_tr_b16 a[84:85], v12 offset:8192
v_mfma_f32_16x16x32_bf16 v[188:191], a[92:95], a[48:51], v[188:191]
ds_read_b64_tr_b16 a[86:87], v12 offset:9216
v_mfma_f32_16x16x32_bf16 v[188:191], a[88:91], a[32:35], v[188:191]
s_add_u32 m0, s17, 0x400
s_waitcnt lgkmcnt(4)
v_mfma_f32_16x16x32_bf16 v[216:219], a[32:35], a[96:99], v[216:219]
buffer_load_dwordx4 v5, s[52:55], s13 offen lds
v_mfma_f32_16x16x32_bf16 v[216:219], a[48:51], a[100:103], v[216:219]
ds_read_b64_tr_b16 a[88:89], v13 offset:0
v_mfma_f32_16x16x32_bf16 v[224:227], a[52:55], a[100:103], v[224:227]
ds_read_b64_tr_b16 a[90:91], v13 offset:1024
v_mfma_f32_16x16x32_bf16 v[224:227], a[36:39], a[96:99], v[224:227]
ds_read_b64_tr_b16 a[92:93], v13 offset:8192
v_mfma_f32_16x16x32_bf16 v[232:235], a[40:43], a[96:99], v[232:235]
ds_read_b64_tr_b16 a[94:95], v13 offset:9216
v_mfma_f32_16x16x32_bf16 v[232:235], a[56:59], a[100:103], v[232:235]
v_mfma_f32_16x16x32_bf16 v[240:243], a[60:63], a[100:103], v[240:243]
s_add_u32 m0, s17, 0x800
v_mfma_f32_16x16x32_bf16 v[240:243], a[44:47], a[96:99], v[240:243]
buffer_load_dwordx4 v6, s[52:55], 0 offen lds
v_mfma_f32_16x16x32_bf16 v[244:247], a[44:47], a[104:107], v[244:247]
ds_read_b64_tr_b16 a[96:97], v12 offset:256
v_mfma_f32_16x16x32_bf16 v[244:247], a[60:63], a[108:111], v[244:247]
ds_read_b64_tr_b16 a[98:99], v12 offset:1280
v_mfma_f32_16x16x32_bf16 v[236:239], a[56:59], a[108:111], v[236:239]
ds_read_b64_tr_b16 a[100:101], v12 offset:8448
v_mfma_f32_16x16x32_bf16 v[236:239], a[40:43], a[104:107], v[236:239]
ds_read_b64_tr_b16 a[102:103], v12 offset:9472
v_mfma_f32_16x16x32_bf16 v[228:231], a[36:39], a[104:107], v[228:231]
v_mfma_f32_16x16x32_bf16 v[228:231], a[52:55], a[108:111], v[228:231]
s_add_u32 m0, s17, 0xc00
v_mfma_f32_16x16x32_bf16 v[220:223], a[48:51], a[108:111], v[220:223]
buffer_load_dwordx4 v6, s[52:55], s13 offen lds
v_mfma_f32_16x16x32_bf16 v[220:223], a[32:35], a[104:107], v[220:223]
s_waitcnt lgkmcnt(4)
L_S16:
v_mfma_f32_16x16x32_bf16 v[24:27], a[80:83], a[0:3], v[24:27]
ds_read_b64_tr_b16 a[104:105], v13 offset:256
s_waitcnt vmcnt(23)
v_mfma_f32_16x16x32_bf16 v[24:27], a[84:87], a[16:19], v[24:27]
ds_read_b64_tr_b16 a[106:107], v13 offset:1280
v_mfma_f32_16x16x32_bf16 v[32:35], a[84:87], a[20:23], v[32:35]
ds_read_b64_tr_b16 a[108:109], v13 offset:8448
v_mfma_f32_16x16x32_bf16 v[32:35], a[80:83], a[4:7], v[32:35]
ds_read_b64_tr_b16 a[110:111], v13 offset:9472
v_mfma_f32_16x16x32_bf16 v[40:43], a[80:83], a[8:11], v[40:43]
ds_read_b128 a[32:35], v8 offset:32768
s_add_u32 m0, s18, 0x4000
v_mfma_f32_16x16x32_bf16 v[40:43], a[84:87], a[24:27], v[40:43]
buffer_load_dwordx4 v7, s[68:71], 0 offen lds
v_mfma_f32_16x16x32_bf16 v[48:51], a[84:87], a[28:31], v[48:51]
ds_read_b128 a[48:51], v9 offset:32768
v_mfma_f32_16x16x32_bf16 v[48:51], a[80:83], a[12:15], v[48:51]
ds_read_b128 a[36:39], v8 offset:34816
v_mfma_f32_16x16x32_bf16 v[52:55], a[88:91], a[12:15], v[52:55]
ds_read_b64_tr_b16 a[80:81], v12 offset:512
v_mfma_f32_16x16x32_bf16 v[52:55], a[92:95], a[28:31], v[52:55]
ds_read_b64_tr_b16 a[82:83], v12 offset:1536
v_mfma_f32_16x16x32_bf16 v[44:47], a[92:95], a[24:27], v[44:47]
ds_read_b64_tr_b16 a[84:85], v12 offset:8704
s_add_u32 s8, s28, 0x9000
v_mfma_f32_16x16x32_bf16 v[44:47], a[88:91], a[8:11], v[44:47]
buffer_store_dwordx4 a[228:231], v16, s[88:91], s8 offen sc1
v_mfma_f32_16x16x32_bf16 v[36:39], a[88:91], a[4:7], v[36:39]
ds_read_b64_tr_b16 a[86:87], v12 offset:9728
v_mfma_f32_16x16x32_bf16 v[36:39], a[92:95], a[20:23], v[36:39]
ds_read_b128 a[52:55], v9 offset:34816
v_mfma_f32_16x16x32_bf16 v[28:31], a[92:95], a[16:19], v[28:31]
ds_read_b128 a[40:43], v8 offset:36864
v_mfma_f32_16x16x32_bf16 v[28:31], a[88:91], a[0:3], v[28:31]
ds_read_b128 a[56:59], v9 offset:36864
s_waitcnt lgkmcnt(10)
v_mfma_f32_16x16x32_bf16 v[56:59], a[96:99], a[0:3], v[56:59]
ds_read_b64_tr_b16 a[88:89], v13 offset:512
v_mfma_f32_16x16x32_bf16 v[56:59], a[100:103], a[16:19], v[56:59]
ds_read_b64_tr_b16 a[90:91], v13 offset:1536
s_add_u32 m0, s18, 0x5000
v_mfma_f32_16x16x32_bf16 v[64:67], a[100:103], a[20:23], v[64:67]
buffer_load_dwordx4 v7, s[68:71], s25 offen lds
v_mfma_f32_16x16x32_bf16 v[64:67], a[96:99], a[4:7], v[64:67]
ds_read_b64_tr_b16 a[92:93], v13 offset:8704
v_mfma_f32_16x16x32_bf16 v[72:75], a[96:99], a[8:11], v[72:75]
ds_read_b64_tr_b16 a[94:95], v13 offset:9728
v_mfma_f32_16x16x32_bf16 v[72:75], a[100:103], a[24:27], v[72:75]
ds_read_b128 a[44:47], v8 offset:38912
v_mfma_f32_16x16x32_bf16 v[80:83], a[100:103], a[28:31], v[80:83]
ds_read_b128 a[60:63], v9 offset:38912
v_mfma_f32_16x16x32_bf16 v[80:83], a[96:99], a[12:15], v[80:83]
v_mfma_f32_16x16x32_bf16 v[84:87], a[104:107], a[12:15], v[84:87]
ds_read_b64_tr_b16 a[96:97], v12 offset:768
s_add_u32 m0, s18, 0x6000
v_mfma_f32_16x16x32_bf16 v[84:87], a[108:111], a[28:31], v[84:87]
buffer_load_dwordx4 v7, s[68:71], s26 offen lds
v_mfma_f32_16x16x32_bf16 v[76:79], a[108:111], a[24:27], v[76:79]
ds_read_b64_tr_b16 a[98:99], v12 offset:1792
v_lshl_add_u32 v5, s42, 19, v5
v_mfma_f32_16x16x32_bf16 v[76:79], a[104:107], a[8:11], v[76:79]
ds_read_b64_tr_b16 a[100:101], v12 offset:8960
v_lshl_add_u32 v6, s42, 19, v6
v_mfma_f32_16x16x32_bf16 v[68:71], a[104:107], a[4:7], v[68:71]
ds_read_b64_tr_b16 a[102:103], v12 offset:9984
v_lshl_add_u32 v7, s42, 18, v7
v_mfma_f32_16x16x32_bf16 v[68:71], a[108:111], a[20:23], v[68:71]
v_lshl_add_u32 v7, s42, 17, v7
v_mfma_f32_16x16x32_bf16 v[60:63], a[108:111], a[16:19], v[60:63]
v_mfma_f32_16x16x32_bf16 v[60:63], a[104:107], a[0:3], v[60:63]
s_add_u32 m0, s16, 0x8000
s_waitcnt lgkmcnt(4)
s_waitcnt lgkmcnt(6)
v_mfma_f32_16x16x32_bf16 v[88:91], a[80:83], a[0:3], v[88:91]
buffer_load_dwordx4 v22, s[44:47], s20 offen lds
v_mfma_f32_16x16x32_bf16 v[88:91], a[84:87], a[16:19], v[88:91]
ds_read_b64_tr_b16 a[104:105], v13 offset:768
v_mfma_f32_16x16x32_bf16 v[96:99], a[84:87], a[20:23], v[96:99]
ds_read_b64_tr_b16 a[106:107], v13 offset:1792
v_mfma_f32_16x16x32_bf16 v[96:99], a[80:83], a[4:7], v[96:99]
ds_read_b64_tr_b16 a[108:109], v13 offset:8960
v_mfma_f32_16x16x32_bf16 v[104:107], a[80:83], a[8:11], v[104:107]
ds_read_b64_tr_b16 a[110:111], v13 offset:9984
s_add_u32 m0, s16, 0x8400
v_mfma_f32_16x16x32_bf16 v[104:107], a[84:87], a[24:27], v[104:107]
buffer_load_dwordx4 v23, s[44:47], s20 offen lds
v_mfma_f32_16x16x32_bf16 v[112:115], a[84:87], a[28:31], v[112:115]
v_mfma_f32_16x16x32_bf16 v[112:115], a[80:83], a[12:15], v[112:115]
v_mfma_f32_16x16x32_bf16 v[116:119], a[88:91], a[12:15], v[116:119]
ds_read_b64_tr_b16 a[80:81], v14 offset:0
v_mfma_f32_16x16x32_bf16 v[116:119], a[92:95], a[28:31], v[116:119]
ds_read_b64_tr_b16 a[82:83], v14 offset:256
v_mfma_f32_16x16x32_bf16 v[108:111], a[92:95], a[24:27], v[108:111]
ds_read_b64_tr_b16 a[84:85], v14 offset:2048
s_add_u32 m0, s16, 0x8800
v_mfma_f32_16x16x32_bf16 v[108:111], a[88:91], a[8:11], v[108:111]
buffer_load_dwordx4 v22, s[44:47], s21 offen lds
v_mfma_f32_16x16x32_bf16 v[100:103], a[88:91], a[4:7], v[100:103]
ds_read_b64_tr_b16 a[86:87], v14 offset:2304
v_mfma_f32_16x16x32_bf16 v[100:103], a[92:95], a[20:23], v[100:103]
v_mfma_f32_16x16x32_bf16 v[92:95], a[92:95], a[16:19], v[92:95]
v_mfma_f32_16x16x32_bf16 v[92:95], a[88:91], a[0:3], v[92:95]
s_add_u32 s8, s28, 0x5400
s_waitcnt lgkmcnt(4)
v_mfma_f32_16x16x32_bf16 v[120:123], a[96:99], a[0:3], v[120:123]
buffer_store_dwordx4 a[112:115], v16, s[88:91], s8 offen sc1
v_mfma_f32_16x16x32_bf16 v[120:123], a[100:103], a[16:19], v[120:123]
ds_read_b64_tr_b16 a[88:89], v15 offset:0
v_mfma_f32_16x16x32_bf16 v[128:131], a[100:103], a[20:23], v[128:131]
ds_read_b64_tr_b16 a[90:91], v15 offset:256
v_mfma_f32_16x16x32_bf16 v[128:131], a[96:99], a[4:7], v[128:131]
ds_read_b64_tr_b16 a[92:93], v15 offset:2048
v_mfma_f32_16x16x32_bf16 v[136:139], a[96:99], a[8:11], v[136:139]
ds_read_b64_tr_b16 a[94:95], v15 offset:2304
v_mfma_f32_16x16x32_bf16 v[136:139], a[100:103], a[24:27], v[136:139]
s_add_u32 m0, s16, 0x8c00
v_mfma_f32_16x16x32_bf16 v[144:147], a[100:103], a[28:31], v[144:147]
buffer_load_dwordx4 v23, s[44:47], s21 offen lds
v_mfma_f32_16x16x32_bf16 v[144:147], a[96:99], a[12:15], v[144:147]
v_mfma_f32_16x16x32_bf16 v[148:151], a[104:107], a[12:15], v[148:151]
ds_read_b64_tr_b16 a[96:97], v14 offset:4096
v_mfma_f32_16x16x32_bf16 v[148:151], a[108:111], a[28:31], v[148:151]
ds_read_b64_tr_b16 a[98:99], v14 offset:4352
v_mfma_f32_16x16x32_bf16 v[140:143], a[108:111], a[24:27], v[140:143]
ds_read_b64_tr_b16 a[100:101], v14 offset:6144
v_mfma_f32_16x16x32_bf16 v[140:143], a[104:107], a[8:11], v[140:143]
ds_read_b64_tr_b16 a[102:103], v14 offset:6400
s_add_u32 m0, s16, 0x9000
v_mfma_f32_16x16x32_bf16 v[132:135], a[104:107], a[4:7], v[132:135]
buffer_load_dwordx4 v22, s[44:47], s22 offen lds
v_mfma_f32_16x16x32_bf16 v[132:135], a[108:111], a[20:23], v[132:135]
v_mfma_f32_16x16x32_bf16 v[124:127], a[108:111], a[16:19], v[124:127]
v_mfma_f32_16x16x32_bf16 v[124:127], a[104:107], a[0:3], v[124:127]
s_waitcnt lgkmcnt(4)
v_mfma_f32_16x16x32_bf16 v[152:155], a[80:83], a[0:3], v[152:155]
ds_read_b64_tr_b16 a[104:105], v15 offset:4096
s_add_u32 m0, s16, 0x9400
v_mfma_f32_16x16x32_bf16 v[152:155], a[84:87], a[16:19], v[152:155]
buffer_load_dwordx4 v23, s[44:47], s22 offen lds
v_mfma_f32_16x16x32_bf16 v[160:163], a[84:87], a[20:23], v[160:163]
ds_read_b64_tr_b16 a[106:107], v15 offset:4352
v_mfma_f32_16x16x32_bf16 v[160:163], a[80:83], a[4:7], v[160:163]
ds_read_b64_tr_b16 a[108:109], v15 offset:6144
v_mfma_f32_16x16x32_bf16 v[168:171], a[80:83], a[8:11], v[168:171]
ds_read_b64_tr_b16 a[110:111], v15 offset:6400
v_mfma_f32_16x16x32_bf16 v[168:171], a[84:87], a[24:27], v[168:171]
v_mfma_f32_16x16x32_bf16 v[176:179], a[84:87], a[28:31], v[176:179]
s_add_u32 m0, s16, 0x9800
v_mfma_f32_16x16x32_bf16 v[176:179], a[80:83], a[12:15], v[176:179]
buffer_load_dwordx4 v22, s[44:47], s23 offen lds
v_mfma_f32_16x16x32_bf16 v[180:183], a[88:91], a[12:15], v[180:183]
ds_read_b64_tr_b16 a[80:81], v14 offset:8192
v_mfma_f32_16x16x32_bf16 v[180:183], a[92:95], a[28:31], v[180:183]
ds_read_b64_tr_b16 a[82:83], v14 offset:8448
v_mfma_f32_16x16x32_bf16 v[172:175], a[92:95], a[24:27], v[172:175]
ds_read_b64_tr_b16 a[84:85], v14 offset:10240
v_mfma_f32_16x16x32_bf16 v[172:175], a[88:91], a[8:11], v[172:175]
ds_read_b64_tr_b16 a[86:87], v14 offset:10496
s_add_u32 m0, s16, 0x9c00
v_mfma_f32_16x16x32_bf16 v[164:167], a[88:91], a[4:7], v[164:167]
buffer_load_dwordx4 v23, s[44:47], s23 offen lds
v_mfma_f32_16x16x32_bf16 v[164:167], a[92:95], a[20:23], v[164:167]
v_lshl_add_u32 v22, s42, 7, v22
v_lshl_add_u32 v23, s42, 7, v23
v_mfma_f32_16x16x32_bf16 v[156:159], a[92:95], a[16:19], v[156:159]
v_mfma_f32_16x16x32_bf16 v[156:159], a[88:91], a[0:3], v[156:159]
s_waitcnt lgkmcnt(4)
v_mfma_f32_16x16x32_bf16 v[184:187], a[96:99], a[0:3], v[184:187]
ds_read_b64_tr_b16 a[88:89], v15 offset:8192
v_mfma_f32_16x16x32_bf16 v[184:187], a[100:103], a[16:19], v[184:187]
ds_read_b64_tr_b16 a[90:91], v15 offset:8448
s_add_u32 s8, s28, 0x9400
v_mfma_f32_16x16x32_bf16 v[192:195], a[100:103], a[20:23], v[192:195]
buffer_store_dwordx4 a[116:119], v16, s[88:91], s8 offen sc1
v_mfma_f32_16x16x32_bf16 v[192:195], a[96:99], a[4:7], v[192:195]
ds_read_b64_tr_b16 a[92:93], v15 offset:10240
v_mfma_f32_16x16x32_bf16 v[200:203], a[96:99], a[8:11], v[200:203]
ds_read_b64_tr_b16 a[94:95], v15 offset:10496
v_add_u32 v12, 0x8000, v12
v_mfma_f32_16x16x32_bf16 v[200:203], a[100:103], a[24:27], v[200:203]
v_add_u32 v13, 0x8000, v13
v_add_u32 v14, 0x8000, v14
v_mfma_f32_16x16x32_bf16 v[208:211], a[100:103], a[28:31], v[208:211]
v_add_u32 v15, 0x8000, v15
v_mfma_f32_16x16x32_bf16 v[208:211], a[96:99], a[12:15], v[208:211]
v_mfma_f32_16x16x32_bf16 v[212:215], a[104:107], a[12:15], v[212:215]
s_waitcnt vmcnt(28) lgkmcnt(0)
v_mfma_f32_16x16x32_bf16 v[212:215], a[108:111], a[28:31], v[212:215]
s_barrier
s_add_u32 m0, s17, 0x8000
v_mfma_f32_16x16x32_bf16 v[204:207], a[108:111], a[24:27], v[204:207]
buffer_load_dwordx4 v5, s[52:55], 0 offen lds
v_mfma_f32_16x16x32_bf16 v[204:207], a[104:107], a[8:11], v[204:207]
ds_read_b64_tr_b16 a[96:97], v12 offset:0
v_mfma_f32_16x16x32_bf16 v[196:199], a[104:107], a[4:7], v[196:199]
ds_read_b64_tr_b16 a[98:99], v12 offset:1024
v_mfma_f32_16x16x32_bf16 v[196:199], a[108:111], a[20:23], v[196:199]
ds_read_b64_tr_b16 a[100:101], v12 offset:8192
v_mfma_f32_16x16x32_bf16 v[188:191], a[108:111], a[16:19], v[188:191]
ds_read_b64_tr_b16 a[102:103], v12 offset:9216
v_mfma_f32_16x16x32_bf16 v[188:191], a[104:107], a[0:3], v[188:191]
s_add_u32 m0, s17, 0x8400
s_waitcnt lgkmcnt(4)
v_mfma_f32_16x16x32_bf16 v[216:219], a[0:3], a[80:83], v[216:219]
buffer_load_dwordx4 v5, s[52:55], s13 offen lds
v_mfma_f32_16x16x32_bf16 v[216:219], a[16:19], a[84:87], v[216:219]
ds_read_b64_tr_b16 a[104:105], v13 offset:0
v_mfma_f32_16x16x32_bf16 v[224:227], a[20:23], a[84:87], v[224:227]
ds_read_b64_tr_b16 a[106:107], v13 offset:1024
v_mfma_f32_16x16x32_bf16 v[224:227], a[4:7], a[80:83], v[224:227]
ds_read_b64_tr_b16 a[108:109], v13 offset:8192
v_mfma_f32_16x16x32_bf16 v[232:235], a[8:11], a[80:83], v[232:235]
ds_read_b64_tr_b16 a[110:111], v13 offset:9216
v_mfma_f32_16x16x32_bf16 v[232:235], a[24:27], a[84:87], v[232:235]
s_add_u32 m0, s17, 0x8800
v_mfma_f32_16x16x32_bf16 v[240:243], a[28:31], a[84:87], v[240:243]
buffer_load_dwordx4 v6, s[52:55], 0 offen lds
v_mfma_f32_16x16x32_bf16 v[240:243], a[12:15], a[80:83], v[240:243]
v_mfma_f32_16x16x32_bf16 v[244:247], a[12:15], a[88:91], v[244:247]
ds_read_b64_tr_b16 a[80:81], v12 offset:256
v_mfma_f32_16x16x32_bf16 v[244:247], a[28:31], a[92:95], v[244:247]
ds_read_b64_tr_b16 a[82:83], v12 offset:1280
v_mfma_f32_16x16x32_bf16 v[236:239], a[24:27], a[92:95], v[236:239]
ds_read_b64_tr_b16 a[84:85], v12 offset:8448
v_mfma_f32_16x16x32_bf16 v[236:239], a[8:11], a[88:91], v[236:239]
ds_read_b64_tr_b16 a[86:87], v12 offset:9472
s_add_u32 s8, s28, 0x5800
v_mfma_f32_16x16x32_bf16 v[228:231], a[4:7], a[88:91], v[228:231]
buffer_store_dwordx4 a[124:127], v16, s[88:91], s8 offen sc1
v_mfma_f32_16x16x32_bf16 v[228:231], a[20:23], a[92:95], v[228:231]
v_mfma_f32_16x16x32_bf16 v[220:223], a[16:19], a[92:95], v[220:223]
v_mfma_f32_16x16x32_bf16 v[220:223], a[0:3], a[88:91], v[220:223]
s_waitcnt lgkmcnt(4)
L_S17:
v_mfma_f32_16x16x32_bf16 v[24:27], a[96:99], a[32:35], v[24:27]
ds_read_b64_tr_b16 a[88:89], v13 offset:256
s_waitcnt vmcnt(23)
v_mfma_f32_16x16x32_bf16 v[24:27], a[100:103], a[48:51], v[24:27]
ds_read_b64_tr_b16 a[90:91], v13 offset:1280
s_add_u32 m0, s17, 0x8c00
v_mfma_f32_16x16x32_bf16 v[32:35], a[100:103], a[52:55], v[32:35]
buffer_load_dwordx4 v6, s[52:55], s13 offen lds
v_mfma_f32_16x16x32_bf16 v[32:35], a[96:99], a[36:39], v[32:35]
ds_read_b64_tr_b16 a[92:93], v13 offset:8448
v_mfma_f32_16x16x32_bf16 v[40:43], a[96:99], a[40:43], v[40:43]
ds_read_b64_tr_b16 a[94:95], v13 offset:9472
v_mfma_f32_16x16x32_bf16 v[40:43], a[100:103], a[56:59], v[40:43]
ds_read_b128 a[0:3], v8 offset:0
v_mfma_f32_16x16x32_bf16 v[48:51], a[100:103], a[60:63], v[48:51]
ds_read_b128 a[16:19], v9 offset:0
v_mfma_f32_16x16x32_bf16 v[48:51], a[96:99], a[44:47], v[48:51]
ds_read_b128 a[4:7], v8 offset:2048
s_add_u32 m0, s18, 0xc000
v_mfma_f32_16x16x32_bf16 v[52:55], a[104:107], a[44:47], v[52:55]
buffer_load_dwordx4 v7, s[68:71], 0 offen lds
v_mfma_f32_16x16x32_bf16 v[52:55], a[108:111], a[60:63], v[52:55]
ds_read_b64_tr_b16 a[96:97], v12 offset:512
v_mfma_f32_16x16x32_bf16 v[44:47], a[108:111], a[56:59], v[44:47]
ds_read_b64_tr_b16 a[98:99], v12 offset:1536
v_mfma_f32_16x16x32_bf16 v[44:47], a[104:107], a[40:43], v[44:47]
ds_read_b64_tr_b16 a[100:101], v12 offset:8704
v_mfma_f32_16x16x32_bf16 v[36:39], a[104:107], a[36:39], v[36:39]
ds_read_b64_tr_b16 a[102:103], v12 offset:9728
v_mfma_f32_16x16x32_bf16 v[36:39], a[108:111], a[52:55], v[36:39]
ds_read_b128 a[20:23], v9 offset:2048
s_add_u32 m0, s18, 0xd000
v_mfma_f32_16x16x32_bf16 v[28:31], a[108:111], a[48:51], v[28:31]
buffer_load_dwordx4 v7, s[68:71], s25 offen lds
v_mfma_f32_16x16x32_bf16 v[28:31], a[104:107], a[32:35], v[28:31]
ds_read_b128 a[8:11], v8 offset:4096
s_waitcnt lgkmcnt(9)
v_mfma_f32_16x16x32_bf16 v[56:59], a[80:83], a[32:35], v[56:59]
ds_read_b64_tr_b16 a[104:105], v13 offset:512
v_mfma_f32_16x16x32_bf16 v[56:59], a[84:87], a[48:51], v[56:59]
ds_read_b64_tr_b16 a[106:107], v13 offset:1536
v_mfma_f32_16x16x32_bf16 v[64:67], a[84:87], a[52:55], v[64:67]
ds_read_b64_tr_b16 a[108:109], v13 offset:8704
v_mfma_f32_16x16x32_bf16 v[64:67], a[80:83], a[36:39], v[64:67]
ds_read_b64_tr_b16 a[110:111], v13 offset:9728
s_add_u32 m0, s18, 0xe000
v_mfma_f32_16x16x32_bf16 v[72:75], a[80:83], a[40:43], v[72:75]
buffer_load_dwordx4 v7, s[68:71], s26 offen lds
v_mfma_f32_16x16x32_bf16 v[72:75], a[84:87], a[56:59], v[72:75]
ds_read_b128 a[24:27], v9 offset:4096
v_lshl_add_u32 v5, s42, 19, v5
v_mfma_f32_16x16x32_bf16 v[80:83], a[84:87], a[60:63], v[80:83]
ds_read_b128 a[12:15], v8 offset:6144
v_lshl_add_u32 v6, s42, 19, v6
v_mfma_f32_16x16x32_bf16 v[80:83], a[80:83], a[44:47], v[80:83]
ds_read_b128 a[28:31], v9 offset:6144
v_lshl_add_u32 v7, s42, 18, v7
v_mfma_f32_16x16x32_bf16 v[84:87], a[88:91], a[44:47], v[84:87]
ds_read_b64_tr_b16 a[80:81], v12 offset:768
v_lshl_add_u32 v7, s42, 17, v7
v_mfma_f32_16x16x32_bf16 v[84:87], a[92:95], a[60:63], v[84:87]
ds_read_b64_tr_b16 a[82:83], v12 offset:1792
s_add_u32 s8, s28, 0x9800
v_mfma_f32_16x16x32_bf16 v[76:79], a[92:95], a[56:59], v[76:79]
buffer_store_dwordx4 a[232:235], v16, s[88:91], s8 offen sc1
v_mfma_f32_16x16x32_bf16 v[76:79], a[88:91], a[40:43], v[76:79]
ds_read_b64_tr_b16 a[84:85], v12 offset:8960
v_mfma_f32_16x16x32_bf16 v[68:71], a[88:91], a[36:39], v[68:71]
ds_read_b64_tr_b16 a[86:87], v12 offset:9984
v_mfma_f32_16x16x32_bf16 v[68:71], a[92:95], a[52:55], v[68:71]
v_mfma_f32_16x16x32_bf16 v[60:63], a[92:95], a[48:51], v[60:63]
v_mfma_f32_16x16x32_bf16 v[60:63], a[88:91], a[32:35], v[60:63]
s_add_u32 m0, s16, 0x0
s_waitcnt lgkmcnt(4)
s_waitcnt lgkmcnt(7)
v_mfma_f32_16x16x32_bf16 v[88:91], a[96:99], a[32:35], v[88:91]
buffer_load_dwordx4 v22, s[44:47], s20 offen lds
v_mfma_f32_16x16x32_bf16 v[88:91], a[100:103], a[48:51], v[88:91]
ds_read_b64_tr_b16 a[88:89], v13 offset:768
v_mfma_f32_16x16x32_bf16 v[96:99], a[100:103], a[52:55], v[96:99]
ds_read_b64_tr_b16 a[90:91], v13 offset:1792
v_mfma_f32_16x16x32_bf16 v[96:99], a[96:99], a[36:39], v[96:99]
ds_read_b64_tr_b16 a[92:93], v13 offset:8960
v_mfma_f32_16x16x32_bf16 v[104:107], a[96:99], a[40:43], v[104:107]
ds_read_b64_tr_b16 a[94:95], v13 offset:9984
s_add_u32 m0, s16, 0x400
v_mfma_f32_16x16x32_bf16 v[104:107], a[100:103], a[56:59], v[104:107]
buffer_load_dwordx4 v23, s[44:47], s20 offen lds
v_mfma_f32_16x16x32_bf16 v[112:115], a[100:103], a[60:63], v[112:115]
v_mfma_f32_16x16x32_bf16 v[112:115], a[96:99], a[44:47], v[112:115]
v_mfma_f32_16x16x32_bf16 v[116:119], a[104:107], a[44:47], v[116:119]
ds_read_b64_tr_b16 a[96:97], v14 offset:0
v_mfma_f32_16x16x32_bf16 v[116:119], a[108:111], a[60:63], v[116:119]
ds_read_b64_tr_b16 a[98:99], v14 offset:256
v_mfma_f32_16x16x32_bf16 v[108:111], a[108:111], a[56:59], v[108:111]
ds_read_b64_tr_b16 a[100:101], v14 offset:2048
s_add_u32 m0, s16, 0x800
v_mfma_f32_16x16x32_bf16 v[108:111], a[104:107], a[40:43], v[108:111]
buffer_load_dwordx4 v22, s[44:47], s21 offen lds
v_mfma_f32_16x16x32_bf16 v[100:103], a[104:107], a[36:39], v[100:103]
ds_read_b64_tr_b16 a[102:103], v14 offset:2304
v_mfma_f32_16x16x32_bf16 v[100:103], a[108:111], a[52:55], v[100:103]
v_mfma_f32_16x16x32_bf16 v[92:95], a[108:111], a[48:51], v[92:95]
v_mfma_f32_16x16x32_bf16 v[92:95], a[104:107], a[32:35], v[92:95]
s_add_u32 m0, s16, 0xc00
s_waitcnt lgkmcnt(4)
v_mfma_f32_16x16x32_bf16 v[120:123], a[80:83], a[32:35], v[120:123]
buffer_load_dwordx4 v23, s[44:47], s21 offen lds
v_mfma_f32_16x16x32_bf16 v[120:123], a[84:87], a[48:51], v[120:123]
ds_read_b64_tr_b16 a[104:105], v15 offset:0
v_mfma_f32_16x16x32_bf16 v[128:131], a[84:87], a[52:55], v[128:131]
ds_read_b64_tr_b16 a[106:107], v15 offset:256
v_mfma_f32_16x16x32_bf16 v[128:131], a[80:83], a[36:39], v[128:131]
ds_read_b64_tr_b16 a[108:109], v15 offset:2048
v_mfma_f32_16x16x32_bf16 v[136:139], a[80:83], a[40:43], v[136:139]
ds_read_b64_tr_b16 a[110:111], v15 offset:2304
v_mfma_f32_16x16x32_bf16 v[136:139], a[84:87], a[56:59], v[136:139]
s_add_u32 s8, s28, 0x5c00
v_mfma_f32_16x16x32_bf16 v[144:147], a[84:87], a[60:63], v[144:147]
buffer_store_dwordx4 a[240:243], v16, s[88:91], s8 offen sc1
v_mfma_f32_16x16x32_bf16 v[144:147], a[80:83], a[44:47], v[144:147]
v_mfma_f32_16x16x32_bf16 v[148:151], a[88:91], a[44:47], v[148:151]
ds_read_b64_tr_b16 a[80:81], v14 offset:4096
v_mfma_f32_16x16x32_bf16 v[148:151], a[92:95], a[60:63], v[148:151]
ds_read_b64_tr_b16 a[82:83], v14 offset:4352
v_mfma_f32_16x16x32_bf16 v[140:143], a[92:95], a[56:59], v[140:143]
ds_read_b64_tr_b16 a[84:85], v14 offset:6144
v_mfma_f32_16x16x32_bf16 v[140:143], a[88:91], a[40:43], v[140:143]
ds_read_b64_tr_b16 a[86:87], v14 offset:6400
s_add_u32 m0, s16, 0x1000
v_mfma_f32_16x16x32_bf16 v[132:135], a[88:91], a[36:39], v[132:135]
buffer_load_dwordx4 v22, s[44:47], s22 offen lds
v_mfma_f32_16x16x32_bf16 v[132:135], a[92:95], a[52:55], v[132:135]
v_mfma_f32_16x16x32_bf16 v[124:127], a[92:95], a[48:51], v[124:127]
v_mfma_f32_16x16x32_bf16 v[124:127], a[88:91], a[32:35], v[124:127]
s_waitcnt lgkmcnt(4)
v_mfma_f32_16x16x32_bf16 v[152:155], a[96:99], a[32:35], v[152:155]
ds_read_b64_tr_b16 a[88:89], v15 offset:4096
s_add_u32 m0, s16, 0x1400
v_mfma_f32_16x16x32_bf16 v[152:155], a[100:103], a[48:51], v[152:155]
buffer_load_dwordx4 v23, s[44:47], s22 offen lds
v_mfma_f32_16x16x32_bf16 v[160:163], a[100:103], a[52:55], v[160:163]
ds_read_b64_tr_b16 a[90:91], v15 offset:4352
v_mfma_f32_16x16x32_bf16 v[160:163], a[96:99], a[36:39], v[160:163]
ds_read_b64_tr_b16 a[92:93], v15 offset:6144
v_mfma_f32_16x16x32_bf16 v[168:171], a[96:99], a[40:43], v[168:171]
ds_read_b64_tr_b16 a[94:95], v15 offset:6400
v_mfma_f32_16x16x32_bf16 v[168:171], a[100:103], a[56:59], v[168:171]
v_mfma_f32_16x16x32_bf16 v[176:179], a[100:103], a[60:63], v[176:179]
s_add_u32 m0, s16, 0x1800
v_mfma_f32_16x16x32_bf16 v[176:179], a[96:99], a[44:47], v[176:179]
buffer_load_dwordx4 v22, s[44:47], s23 offen lds
v_mfma_f32_16x16x32_bf16 v[180:183], a[104:107], a[44:47], v[180:183]
ds_read_b64_tr_b16 a[96:97], v14 offset:8192
v_mfma_f32_16x16x32_bf16 v[180:183], a[108:111], a[60:63], v[180:183]
ds_read_b64_tr_b16 a[98:99], v14 offset:8448
v_mfma_f32_16x16x32_bf16 v[172:175], a[108:111], a[56:59], v[172:175]
ds_read_b64_tr_b16 a[100:101], v14 offset:10240
v_mfma_f32_16x16x32_bf16 v[172:175], a[104:107], a[40:43], v[172:175]
ds_read_b64_tr_b16 a[102:103], v14 offset:10496
s_add_u32 m0, s16, 0x1c00
v_mfma_f32_16x16x32_bf16 v[164:167], a[104:107], a[36:39], v[164:167]
buffer_load_dwordx4 v23, s[44:47], s23 offen lds
v_mfma_f32_16x16x32_bf16 v[164:167], a[108:111], a[52:55], v[164:167]
v_lshl_add_u32 v22, s42, 7, v22
v_lshl_add_u32 v23, s42, 7, v23
v_mfma_f32_16x16x32_bf16 v[156:159], a[108:111], a[48:51], v[156:159]
v_mfma_f32_16x16x32_bf16 v[156:159], a[104:107], a[32:35], v[156:159]
s_waitcnt lgkmcnt(4)
v_mfma_f32_16x16x32_bf16 v[184:187], a[80:83], a[32:35], v[184:187]
ds_read_b64_tr_b16 a[104:105], v15 offset:8192
v_mfma_f32_16x16x32_bf16 v[184:187], a[84:87], a[48:51], v[184:187]
ds_read_b64_tr_b16 a[106:107], v15 offset:8448
s_add_u32 s8, s28, 0x9c00
v_mfma_f32_16x16x32_bf16 v[192:195], a[84:87], a[52:55], v[192:195]
buffer_store_dwordx4 a[248:251], v16, s[88:91], s8 offen sc1
v_mfma_f32_16x16x32_bf16 v[192:195], a[80:83], a[36:39], v[192:195]
ds_read_b64_tr_b16 a[108:109], v15 offset:10240
v_mfma_f32_16x16x32_bf16 v[200:203], a[80:83], a[40:43], v[200:203]
ds_read_b64_tr_b16 a[110:111], v15 offset:10496
v_add_u32 v12, 0xffff0000, v12
v_mfma_f32_16x16x32_bf16 v[200:203], a[84:87], a[56:59], v[200:203]
v_add_u32 v13, 0xffff0000, v13
v_add_u32 v14, 0xffff0000, v14
v_mfma_f32_16x16x32_bf16 v[208:211], a[84:87], a[60:63], v[208:211]
v_add_u32 v15, 0xffff0000, v15
v_mfma_f32_16x16x32_bf16 v[208:211], a[80:83], a[44:47], v[208:211]
v_mfma_f32_16x16x32_bf16 v[212:215], a[88:91], a[44:47], v[212:215]
s_waitcnt vmcnt(29) lgkmcnt(0)
v_mfma_f32_16x16x32_bf16 v[212:215], a[92:95], a[60:63], v[212:215]
s_barrier
s_add_u32 m0, s17, 0x10000
v_mfma_f32_16x16x32_bf16 v[204:207], a[92:95], a[56:59], v[204:207]
buffer_load_dwordx4 v5, s[52:55], 0 offen lds
v_mfma_f32_16x16x32_bf16 v[204:207], a[88:91], a[40:43], v[204:207]
ds_read_b64_tr_b16 a[80:81], v12 offset:0
v_mfma_f32_16x16x32_bf16 v[196:199], a[88:91], a[36:39], v[196:199]
ds_read_b64_tr_b16 a[82:83], v12 offset:1024
v_mfma_f32_16x16x32_bf16 v[196:199], a[92:95], a[52:55], v[196:199]
ds_read_b64_tr_b16 a[84:85], v12 offset:8192
v_mfma_f32_16x16x32_bf16 v[188:191], a[92:95], a[48:51], v[188:191]
ds_read_b64_tr_b16 a[86:87], v12 offset:9216
v_mfma_f32_16x16x32_bf16 v[188:191], a[88:91], a[32:35], v[188:191]
s_add_u32 m0, s17, 0x10400
s_waitcnt lgkmcnt(4)
v_mfma_f32_16x16x32_bf16 v[216:219], a[32:35], a[96:99], v[216:219]
buffer_load_dwordx4 v5, s[52:55], s13 offen lds
v_mfma_f32_16x16x32_bf16 v[216:219], a[48:51], a[100:103], v[216:219]
ds_read_b64_tr_b16 a[88:89], v13 offset:0
v_mfma_f32_16x16x32_bf16 v[224:227], a[52:55], a[100:103], v[224:227]
ds_read_b64_tr_b16 a[90:91], v13 offset:1024
v_mfma_f32_16x16x32_bf16 v[224:227], a[36:39], a[96:99], v[224:227]
ds_read_b64_tr_b16 a[92:93], v13 offset:8192
v_mfma_f32_16x16x32_bf16 v[232:235], a[40:43], a[96:99], v[232:235]
ds_read_b64_tr_b16 a[94:95], v13 offset:9216
v_mfma_f32_16x16x32_bf16 v[232:235], a[56:59], a[100:103], v[232:235]
v_mfma_f32_16x16x32_bf16 v[240:243], a[60:63], a[100:103], v[240:243]
s_add_u32 m0, s17, 0x10800
v_mfma_f32_16x16x32_bf16 v[240:243], a[44:47], a[96:99], v[240:243]
buffer_load_dwordx4 v6, s[52:55], 0 offen lds
v_mfma_f32_16x16x32_bf16 v[244:247], a[44:47], a[104:107], v[244:247]
ds_read_b64_tr_b16 a[96:97], v12 offset:256
v_mfma_f32_16x16x32_bf16 v[244:247], a[60:63], a[108:111], v[244:247]
ds_read_b64_tr_b16 a[98:99], v12 offset:1280
v_mfma_f32_16x16x32_bf16 v[236:239], a[56:59], a[108:111], v[236:239]
ds_read_b64_tr_b16 a[100:101], v12 offset:8448
v_mfma_f32_16x16x32_bf16 v[236:239], a[40:43], a[104:107], v[236:239]
ds_read_b64_tr_b16 a[102:103], v12 offset:9472
v_mfma_f32_16x16x32_bf16 v[228:231], a[36:39], a[104:107], v[228:231]
v_mfma_f32_16x16x32_bf16 v[228:231], a[52:55], a[108:111], v[228:231]
s_add_u32 m0, s17, 0x10c00
v_mfma_f32_16x16x32_bf16 v[220:223], a[48:51], a[108:111], v[220:223]
buffer_load_dwordx4 v6, s[52:55], s13 offen lds
v_mfma_f32_16x16x32_bf16 v[220:223], a[32:35], a[104:107], v[220:223]
s_waitcnt lgkmcnt(4)
L_S18:
v_mfma_f32_16x16x32_bf16 v[24:27], a[80:83], a[0:3], v[24:27]
ds_read_b64_tr_b16 a[104:105], v13 offset:256
s_waitcnt vmcnt(24)
v_mfma_f32_16x16x32_bf16 v[24:27], a[84:87], a[16:19], v[24:27]
ds_read_b64_tr_b16 a[106:107], v13 offset:1280
L_padA9:
s_cmp_eq_u32 s95, 1
s_cbranch_scc1 L_hopA_ret
v_mfma_f32_16x16x32_bf16 v[32:35], a[84:87], a[20:23], v[32:35]
ds_read_b64_tr_b16 a[108:109], v13 offset:8448
v_mfma_f32_16x16x32_bf16 v[32:35], a[80:83], a[4:7], v[32:35]
ds_read_b64_tr_b16 a[110:111], v13 offset:9472
v_mfma_f32_16x16x32_bf16 v[40:43], a[80:83], a[8:11], v[40:43]
ds_read_b128 a[32:35], v8 offset:32768
s_add_u32 m0, s18, 0x14000
v_mfma_f32_16x16x32_bf16 v[40:43], a[84:87], a[24:27], v[40:43]
buffer_load_dwordx4 v7, s[68:71], 0 offen lds
v_mfma_f32_16x16x32_bf16 v[48:51], a[84:87], a[28:31], v[48:51]
ds_read_b128 a[48:51], v9 offset:32768
v_mfma_f32_16x16x32_bf16 v[48:51], a[80:83], a[12:15], v[48:51]
ds_read_b128 a[36:39], v8 offset:34816
v_mfma_f32_16x16x32_bf16 v[52:55], a[88:91], a[12:15], v[52:55]
ds_read_b64_tr_b16 a[80:81], v12 offset:512
v_mfma_f32_16x16x32_bf16 v[52:55], a[92:95], a[28:31], v[52:55]
ds_read_b64_tr_b16 a[82:83], v12 offset:1536
v_mfma_f32_16x16x32_bf16 v[44:47], a[92:95], a[24:27], v[44:47]
ds_read_b64_tr_b16 a[84:85], v12 offset:8704
v_mfma_f32_16x16x32_bf16 v[44:47], a[88:91], a[8:11], v[44:47]
buffer_load_dwordx4 a[128:131], v16, s[44:47], s100 offen offset:0
v_mfma_f32_16x16x32_bf16 v[36:39], a[88:91], a[4:7], v[36:39]
ds_read_b64_tr_b16 a[86:87], v12 offset:9728
v_mfma_f32_16x16x32_bf16 v[36:39], a[92:95], a[20:23], v[36:39]
ds_read_b128 a[52:55], v9 offset:34816
v_mfma_f32_16x16x32_bf16 v[28:31], a[92:95], a[16:19], v[28:31]
ds_read_b128 a[40:43], v8 offset:36864
v_mfma_f32_16x16x32_bf16 v[28:31], a[88:91], a[0:3], v[28:31]
ds_read_b128 a[56:59], v9 offset:36864
s_waitcnt lgkmcnt(10)
v_mfma_f32_16x16x32_bf16 v[56:59], a[96:99], a[0:3], v[56:59]
ds_read_b64_tr_b16 a[88:89], v13 offset:512
v_mfma_f32_16x16x32_bf16 v[56:59], a[100:103], a[16:19], v[56:59]
ds_read_b64_tr_b16 a[90:91], v13 offset:1536
s_add_u32 m0, s18, 0x15000
v_mfma_f32_16x16x32_bf16 v[64:67], a[100:103], a[20:23], v[64:67]
buffer_load_dwordx4 v7, s[68:71], s25 offen lds
v_mfma_f32_16x16x32_bf16 v[64:67], a[96:99], a[4:7], v[64:67]
ds_read_b64_tr_b16 a[92:93], v13 offset:8704
v_mfma_f32_16x16x32_bf16 v[72:75], a[96:99], a[8:11], v[72:75]
ds_read_b64_tr_b16 a[94:95], v13 offset:9728
v_mfma_f32_16x16x32_bf16 v[72:75], a[100:103], a[24:27], v[72:75]
ds_read_b128 a[44:47], v8 offset:38912
v_mfma_f32_16x16x32_bf16 v[80:83], a[100:103], a[28:31], v[80:83]
ds_read_b128 a[60:63], v9 offset:38912
v_mfma_f32_16x16x32_bf16 v[80:83], a[96:99], a[12:15], v[80:83]
v_mfma_f32_16x16x32_bf16 v[84:87], a[104:107], a[12:15], v[84:87]
ds_read_b64_tr_b16 a[96:97], v12 offset:768
s_add_u32 m0, s18, 0x16000
v_mfma_f32_16x16x32_bf16 v[84:87], a[108:111], a[28:31], v[84:87]
buffer_load_dwordx4 v7, s[68:71], s26 offen lds
v_mfma_f32_16x16x32_bf16 v[76:79], a[108:111], a[24:27], v[76:79]
ds_read_b64_tr_b16 a[98:99], v12 offset:1792
v_lshl_add_u32 v5, s42, 19, v5
v_mfma_f32_16x16x32_bf16 v[76:79], a[104:107], a[8:11], v[76:79]
ds_read_b64_tr_b16 a[100:101], v12 offset:8960
v_lshl_add_u32 v6, s42, 19, v6
v_mfma_f32_16x16x32_bf16 v[68:71], a[104:107], a[4:7], v[68:71]
ds_read_b64_tr_b16 a[102:103], v12 offset:9984
v_lshl_add_u32 v7, s42, 18, v7
v_mfma_f32_16x16x32_bf16 v[68:71], a[108:111], a[20:23], v[68:71]
v_lshl_add_u32 v7, s42, 17, v7
v_mfma_f32_16x16x32_bf16 v[60:63], a[108:111], a[16:19], v[60:63]
v_mfma_f32_16x16x32_bf16 v[60:63], a[104:107], a[0:3], v[60:63]
s_add_u32 m0, s16, 0x8000
s_waitcnt lgkmcnt(4)
s_waitcnt lgkmcnt(6)
v_mfma_f32_16x16x32_bf16 v[88:91], a[80:83], a[0:3], v[88:91]
buffer_load_dwordx4 v22, s[44:47], s20 offen lds
v_mfma_f32_16x16x32_bf16 v[88:91], a[84:87], a[16:19], v[88:91]
ds_read_b64_tr_b16 a[104:105], v13 offset:768
v_mfma_f32_16x16x32_bf16 v[96:99], a[84:87], a[20:23], v[96:99]
ds_read_b64_tr_b16 a[106:107], v13 offset:1792
v_mfma_f32_16x16x32_bf16 v[96:99], a[80:83], a[4:7], v[96:99]
ds_read_b64_tr_b16 a[108:109], v13 offset:8960
v_mfma_f32_16x16x32_bf16 v[104:107], a[80:83], a[8:11], v[104:107]
ds_read_b64_tr_b16 a[110:111], v13 offset:9984
s_add_u32 m0, s16, 0x8400
v_mfma_f32_16x16x32_bf16 v[104:107], a[84:87], a[24:27], v[104:107]
buffer_load_dwordx4 v23, s[44:47], s20 offen lds
v_mfma_f32_16x16x32_bf16 v[112:115], a[84:87], a[28:31], v[112:115]
v_mfma_f32_16x16x32_bf16 v[112:115], a[80:83], a[12:15], v[112:115]
v_mfma_f32_16x16x32_bf16 v[116:119], a[88:91], a[12:15], v[116:119]
ds_read_b64_tr_b16 a[80:81], v14 offset:0
v_mfma_f32_16x16x32_bf16 v[116:119], a[92:95], a[28:31], v[116:119]
ds_read_b64_tr_b16 a[82:83], v14 offset:256
v_mfma_f32_16x16x32_bf16 v[108:111], a[92:95], a[24:27], v[108:111]
ds_read_b64_tr_b16 a[84:85], v14 offset:2048
s_add_u32 m0, s16, 0x8800
v_mfma_f32_16x16x32_bf16 v[108:111], a[88:91], a[8:11], v[108:111]
buffer_load_dwordx4 v22, s[44:47], s21 offen lds
v_mfma_f32_16x16x32_bf16 v[100:103], a[88:91], a[4:7], v[100:103]
ds_read_b64_tr_b16 a[86:87], v14 offset:2304
v_mfma_f32_16x16x32_bf16 v[100:103], a[92:95], a[20:23], v[100:103]
v_mfma_f32_16x16x32_bf16 v[92:95], a[92:95], a[16:19], v[92:95]
v_mfma_f32_16x16x32_bf16 v[92:95], a[88:91], a[0:3], v[92:95]
s_waitcnt lgkmcnt(4)
v_mfma_f32_16x16x32_bf16 v[120:123], a[96:99], a[0:3], v[120:123]
buffer_load_dwordx4 a[132:135], v16, s[44:47], s100 offen offset:1024
v_mfma_f32_16x16x32_bf16 v[120:123], a[100:103], a[16:19], v[120:123]
ds_read_b64_tr_b16 a[88:89], v15 offset:0
v_mfma_f32_16x16x32_bf16 v[128:131], a[100:103], a[20:23], v[128:131]
ds_read_b64_tr_b16 a[90:91], v15 offset:256
v_mfma_f32_16x16x32_bf16 v[128:131], a[96:99], a[4:7], v[128:131]
ds_read_b64_tr_b16 a[92:93], v15 offset:2048
v_mfma_f32_16x16x32_bf16 v[136:139], a[96:99], a[8:11], v[136:139]
ds_read_b64_tr_b16 a[94:95], v15 offset:2304
v_mfma_f32_16x16x32_bf16 v[136:139], a[100:103], a[24:27], v[136:139]
s_add_u32 m0, s16, 0x8c00
v_mfma_f32_16x16x32_bf16 v[144:147], a[100:103], a[28:31], v[144:147]
buffer_load_dwordx4 v23, s[44:47], s21 offen lds
v_mfma_f32_16x16x32_bf16 v[144:147], a[96:99], a[12:15], v[144:147]
v_mfma_f32_16x16x32_bf16 v[148:151], a[104:107], a[12:15], v[148:151]
ds_read_b64_tr_b16 a[96:97], v14 offset:4096
v_mfma_f32_16x16x32_bf16 v[148:151], a[108:111], a[28:31], v[148:151]
ds_read_b64_tr_b16 a[98:99], v14 offset:4352
v_mfma_f32_16x16x32_bf16 v[140:143], a[108:111], a[24:27], v[140:143]
ds_read_b64_tr_b16 a[100:101], v14 offset:6144
v_mfma_f32_16x16x32_bf16 v[140:143], a[104:107], a[8:11], v[140:143]
ds_read_b64_tr_b16 a[102:103], v14 offset:6400
s_add_u32 m0, s16, 0x9000
v_mfma_f32_16x16x32_bf16 v[132:135], a[104:107], a[4:7], v[132:135]
buffer_load_dwordx4 v22, s[44:47], s22 offen lds
v_mfma_f32_16x16x32_bf16 v[132:135], a[108:111], a[20:23], v[132:135]
v_mfma_f32_16x16x32_bf16 v[124:127], a[108:111], a[16:19], v[124:127]
v_mfma_f32_16x16x32_bf16 v[124:127], a[104:107], a[0:3], v[124:127]
s_waitcnt lgkmcnt(4)
v_mfma_f32_16x16x32_bf16 v[152:155], a[80:83], a[0:3], v[152:155]
ds_read_b64_tr_b16 a[104:105], v15 offset:4096
s_add_u32 m0, s16, 0x9400
v_mfma_f32_16x16x32_bf16 v[152:155], a[84:87], a[16:19], v[152:155]
buffer_load_dwordx4 v23, s[44:47], s22 offen lds
v_mfma_f32_16x16x32_bf16 v[160:163], a[84:87], a[20:23], v[160:163]
ds_read_b64_tr_b16 a[106:107], v15 offset:4352
v_mfma_f32_16x16x32_bf16 v[160:163], a[80:83], a[4:7], v[160:163]
ds_read_b64_tr_b16 a[108:109], v15 offset:6144
v_mfma_f32_16x16x32_bf16 v[168:171], a[80:83], a[8:11], v[168:171]
ds_read_b64_tr_b16 a[110:111], v15 offset:6400
v_mfma_f32_16x16x32_bf16 v[168:171], a[84:87], a[24:27], v[168:171]
v_mfma_f32_16x16x32_bf16 v[176:179], a[84:87], a[28:31], v[176:179]
s_add_u32 m0, s16, 0x9800
v_mfma_f32_16x16x32_bf16 v[176:179], a[80:83], a[12:15], v[176:179]
buffer_load_dwordx4 v22, s[44:47], s23 offen lds
v_mfma_f32_16x16x32_bf16 v[180:183], a[88:91], a[12:15], v[180:183]
ds_read_b64_tr_b16 a[80:81], v14 offset:8192
v_mfma_f32_16x16x32_bf16 v[180:183], a[92:95], a[28:31], v[180:183]
ds_read_b64_tr_b16 a[82:83], v14 offset:8448
v_mfma_f32_16x16x32_bf16 v[172:175], a[92:95], a[24:27], v[172:175]
ds_read_b64_tr_b16 a[84:85], v14 offset:10240
v_mfma_f32_16x16x32_bf16 v[172:175], a[88:91], a[8:11], v[172:175]
ds_read_b64_tr_b16 a[86:87], v14 offset:10496
s_add_u32 m0, s16, 0x9c00
v_mfma_f32_16x16x32_bf16 v[164:167], a[88:91], a[4:7], v[164:167]
buffer_load_dwordx4 v23, s[44:47], s23 offen lds
v_mfma_f32_16x16x32_bf16 v[164:167], a[92:95], a[20:23], v[164:167]
v_lshl_add_u32 v22, s42, 7, v22
v_lshl_add_u32 v23, s42, 7, v23
v_mfma_f32_16x16x32_bf16 v[156:159], a[92:95], a[16:19], v[156:159]
v_mfma_f32_16x16x32_bf16 v[156:159], a[88:91], a[0:3], v[156:159]
s_waitcnt lgkmcnt(4)
v_mfma_f32_16x16x32_bf16 v[184:187], a[96:99], a[0:3], v[184:187]
ds_read_b64_tr_b16 a[88:89], v15 offset:8192
v_mfma_f32_16x16x32_bf16 v[184:187], a[100:103], a[16:19], v[184:187]
ds_read_b64_tr_b16 a[90:91], v15 offset:8448
v_mfma_f32_16x16x32_bf16 v[192:195], a[100:103], a[20:23], v[192:195]
buffer_load_dwordx4 a[136:139], v16, s[44:47], s100 offen offset:2048
v_mfma_f32_16x16x32_bf16 v[192:195], a[96:99], a[4:7], v[192:195]
ds_read_b64_tr_b16 a[92:93], v15 offset:10240
v_mfma_f32_16x16x32_bf16 v[200:203], a[96:99], a[8:11], v[200:203]
ds_read_b64_tr_b16 a[94:95], v15 offset:10496
v_add_u32 v12, 0x8000, v12
v_mfma_f32_16x16x32_bf16 v[200:203], a[100:103], a[24:27], v[200:203]
v_add_u32 v13, 0x8000, v13
v_add_u32 v14, 0x8000, v14
v_mfma_f32_16x16x32_bf16 v[208:211], a[100:103], a[28:31], v[208:211]
v_add_u32 v15, 0x8000, v15
v_mfma_f32_16x16x32_bf16 v[208:211], a[96:99], a[12:15], v[208:211]
v_mfma_f32_16x16x32_bf16 v[212:215], a[104:107], a[12:15], v[212:215]
s_waitcnt vmcnt(18) lgkmcnt(0)
v_mfma_f32_16x16x32_bf16 v[212:215], a[108:111], a[28:31], v[212:215]
s_barrier
s_add_u32 m0, s17, 0x0
s_cmp_lg_u32 s4, 0
s_cbranch_scc1 L_sig_kv
v_mov_b32 v20, 1
s_mov_b64 exec, 1
buffer_atomic_add v20, off, s[84:87], s10 sc1
s_mov_b64 exec, -1
L_sig_kv:
v_mfma_f32_16x16x32_bf16 v[204:207], a[108:111], a[24:27], v[204:207]
buffer_load_dwordx4 v5, s[52:55], 0 offen lds
v_mfma_f32_16x16x32_bf16 v[204:207], a[104:107], a[8:11], v[204:207]
ds_read_b64_tr_b16 a[96:97], v12 offset:0
v_mfma_f32_16x16x32_bf16 v[196:199], a[104:107], a[4:7], v[196:199]
ds_read_b64_tr_b16 a[98:99], v12 offset:1024
v_mfma_f32_16x16x32_bf16 v[196:199], a[108:111], a[20:23], v[196:199]
ds_read_b64_tr_b16 a[100:101], v12 offset:8192
v_mfma_f32_16x16x32_bf16 v[188:191], a[108:111], a[16:19], v[188:191]
ds_read_b64_tr_b16 a[102:103], v12 offset:9216
v_mfma_f32_16x16x32_bf16 v[188:191], a[104:107], a[0:3], v[188:191]
s_add_u32 m0, s17, 0x400
s_waitcnt lgkmcnt(4)
v_mfma_f32_16x16x32_bf16 v[216:219], a[0:3], a[80:83], v[216:219]
buffer_load_dwordx4 v5, s[52:55], s13 offen lds
v_mfma_f32_16x16x32_bf16 v[216:219], a[16:19], a[84:87], v[216:219]
ds_read_b64_tr_b16 a[104:105], v13 offset:0
v_mfma_f32_16x16x32_bf16 v[224:227], a[20:23], a[84:87], v[224:227]
ds_read_b64_tr_b16 a[106:107], v13 offset:1024
v_mfma_f32_16x16x32_bf16 v[224:227], a[4:7], a[80:83], v[224:227]
ds_read_b64_tr_b16 a[108:109], v13 offset:8192
v_mfma_f32_16x16x32_bf16 v[232:235], a[8:11], a[80:83], v[232:235]
ds_read_b64_tr_b16 a[110:111], v13 offset:9216
v_mfma_f32_16x16x32_bf16 v[232:235], a[24:27], a[84:87], v[232:235]
v_mfma_f32_16x16x32_bf16 v[240:243], a[28:31], a[84:87], v[240:243]
s_add_u32 m0, s17, 0x800
v_mfma_f32_16x16x32_bf16 v[240:243], a[12:15], a[80:83], v[240:243]
buffer_load_dwordx4 v6, s[52:55], 0 offen lds
v_mfma_f32_16x16x32_bf16 v[244:247], a[12:15], a[88:91], v[244:247]
ds_read_b64_tr_b16 a[80:81], v12 offset:256
v_mfma_f32_16x16x32_bf16 v[244:247], a[28:31], a[92:95], v[244:247]
ds_read_b64_tr_b16 a[82:83], v12 offset:1280
v_mfma_f32_16x16x32_bf16 v[236:239], a[24:27], a[92:95], v[236:239]
ds_read_b64_tr_b16 a[84:85], v12 offset:8448
v_mfma_f32_16x16x32_bf16 v[236:239], a[8:11], a[88:91], v[236:239]
ds_read_b64_tr_b16 a[86:87], v12 offset:9472
v_mfma_f32_16x16x32_bf16 v[228:231], a[4:7], a[88:91], v[228:231]
v_mfma_f32_16x16x32_bf16 v[228:231], a[20:23], a[92:95], v[228:231]
s_add_u32 m0, s17, 0xc00
v_mfma_f32_16x16x32_bf16 v[220:223], a[16:19], a[92:95], v[220:223]
buffer_load_dwordx4 v6, s[52:55], s13 offen lds
v_mfma_f32_16x16x32_bf16 v[220:223], a[0:3], a[88:91], v[220:223]
s_waitcnt lgkmcnt(4)
L_S19:
v_mfma_f32_16x16x32_bf16 v[24:27], a[96:99], a[32:35], v[24:27]
ds_read_b64_tr_b16 a[88:89], v13 offset:256
s_waitcnt vmcnt(23)
v_mfma_f32_16x16x32_bf16 v[24:27], a[100:103], a[48:51], v[24:27]
ds_read_b64_tr_b16 a[90:91], v13 offset:1280
v_mfma_f32_16x16x32_bf16 v[32:35], a[100:103], a[52:55], v[32:35]
ds_read_b64_tr_b16 a[92:93], v13 offset:8448
v_mfma_f32_16x16x32_bf16 v[32:35], a[96:99], a[36:39], v[32:35]
ds_read_b64_tr_b16 a[94:95], v13 offset:9472
v_mfma_f32_16x16x32_bf16 v[40:43], a[96:99], a[40:43], v[40:43]
ds_read_b128 a[0:3], v8 offset:0
s_add_u32 m0, s18, 0x4000
v_mfma_f32_16x16x32_bf16 v[40:43], a[100:103], a[56:59], v[40:43]
buffer_load_dwordx4 v7, s[68:71], 0 offen lds
v_mfma_f32_16x16x32_bf16 v[48:51], a[100:103], a[60:63], v[48:51]
ds_read_b128 a[16:19], v9 offset:0
v_mfma_f32_16x16x32_bf16 v[48:51], a[96:99], a[44:47], v[48:51]
ds_read_b128 a[4:7], v8 offset:2048
v_mfma_f32_16x16x32_bf16 v[52:55], a[104:107], a[44:47], v[52:55]
ds_read_b64_tr_b16 a[96:97], v12 offset:512
v_mfma_f32_16x16x32_bf16 v[52:55], a[108:111], a[60:63], v[52:55]
ds_read_b64_tr_b16 a[98:99], v12 offset:1536
v_mfma_f32_16x16x32_bf16 v[44:47], a[108:111], a[56:59], v[44:47]
ds_read_b64_tr_b16 a[100:101], v12 offset:8704
v_mfma_f32_16x16x32_bf16 v[44:47], a[104:107], a[40:43], v[44:47]
buffer_load_dwordx4 a[140:143], v16, s[44:47], s100 offen offset:3072
v_mfma_f32_16x16x32_bf16 v[36:39], a[104:107], a[36:39], v[36:39]
ds_read_b64_tr_b16 a[102:103], v12 offset:9728
v_mfma_f32_16x16x32_bf16 v[36:39], a[108:111], a[52:55], v[36:39]
ds_read_b128 a[20:23], v9 offset:2048
v_mfma_f32_16x16x32_bf16 v[28:31], a[108:111], a[48:51], v[28:31]
ds_read_b128 a[8:11], v8 offset:4096
v_mfma_f32_16x16x32_bf16 v[28:31], a[104:107], a[32:35], v[28:31]
ds_read_b128 a[24:27], v9 offset:4096
s_waitcnt lgkmcnt(10)
v_mfma_f32_16x16x32_bf16 v[56:59], a[80:83], a[32:35], v[56:59]
ds_read_b64_tr_b16 a[104:105], v13 offset:512
v_mfma_f32_16x16x32_bf16 v[56:59], a[84:87], a[48:51], v[56:59]
ds_read_b64_tr_b16 a[106:107], v13 offset:1536
s_add_u32 m0, s18, 0x5000
v_mfma_f32_16x16x32_bf16 v[64:67], a[84:87], a[52:55], v[64:67]
buffer_load_dwordx4 v7, s[68:71], s25 offen lds
v_mfma_f32_16x16x32_bf16 v[64:67], a[80:83], a[36:39], v[64:67]
ds_read_b64_tr_b16 a[108:109], v13 offset:8704
v_mfma_f32_16x16x32_bf16 v[72:75], a[80:83], a[40:43], v[72:75]
ds_read_b64_tr_b16 a[110:111], v13 offset:9728
v_mfma_f32_16x16x32_bf16 v[72:75], a[84:87], a[56:59], v[72:75]
ds_read_b128 a[12:15], v8 offset:6144
v_mfma_f32_16x16x32_bf16 v[80:83], a[84:87], a[60:63], v[80:83]
ds_read_b128 a[28:31], v9 offset:6144
v_mfma_f32_16x16x32_bf16 v[80:83], a[80:83], a[44:47], v[80:83]
v_mfma_f32_16x16x32_bf16 v[84:87], a[88:91], a[44:47], v[84:87]
ds_read_b64_tr_b16 a[80:81], v12 offset:768
s_add_u32 m0, s18, 0x6000
v_mfma_f32_16x16x32_bf16 v[84:87], a[92:95], a[60:63], v[84:87]
buffer_load_dwordx4 v7, s[68:71], s26 offen lds
v_mfma_f32_16x16x32_bf16 v[76:79], a[92:95], a[56:59], v[76:79]
ds_read_b64_tr_b16 a[82:83], v12 offset:1792
v_lshl_add_u32 v5, s42, 19, v5
v_mfma_f32_16x16x32_bf16 v[76:79], a[88:91], a[40:43], v[76:79]
ds_read_b64_tr_b16 a[84:85], v12 offset:8960
v_lshl_add_u32 v6, s42, 19, v6
v_mfma_f32_16x16x32_bf16 v[68:71], a[88:91], a[36:39], v[68:71]
ds_read_b64_tr_b16 a[86:87], v12 offset:9984
v_lshl_add_u32 v7, s42, 18, v7
v_mfma_f32_16x16x32_bf16 v[68:71], a[92:95], a[52:55], v[68:71]
v_lshl_add_u32 v7, s42, 17, v7
v_mfma_f32_16x16x32_bf16 v[60:63], a[92:95], a[48:51], v[60:63]
v_mfma_f32_16x16x32_bf16 v[60:63], a[88:91], a[32:35], v[60:63]
s_add_u32 m0, s16, 0x0
s_waitcnt lgkmcnt(4)
s_waitcnt lgkmcnt(6)
v_mfma_f32_16x16x32_bf16 v[88:91], a[96:99], a[32:35], v[88:91]
buffer_load_dwordx4 v22, s[44:47], s20 offen lds
v_mfma_f32_16x16x32_bf16 v[88:91], a[100:103], a[48:51], v[88:91]
ds_read_b64_tr_b16 a[88:89], v13 offset:768
v_mfma_f32_16x16x32_bf16 v[96:99], a[100:103], a[52:55], v[96:99]
ds_read_b64_tr_b16 a[90:91], v13 offset:1792
v_mfma_f32_16x16x32_bf16 v[96:99], a[96:99], a[36:39], v[96:99]
ds_read_b64_tr_b16 a[92:93], v13 offset:8960
v_mfma_f32_16x16x32_bf16 v[104:107], a[96:99], a[40:43], v[104:107]
ds_read_b64_tr_b16 a[94:95], v13 offset:9984
s_add_u32 m0, s16, 0x400
v_mfma_f32_16x16x32_bf16 v[104:107], a[100:103], a[56:59], v[104:107]
buffer_load_dwordx4 v23, s[44:47], s20 offen lds
v_mfma_f32_16x16x32_bf16 v[112:115], a[100:103], a[60:63], v[112:115]
v_mfma_f32_16x16x32_bf16 v[112:115], a[96:99], a[44:47], v[112:115]
v_mfma_f32_16x16x32_bf16 v[116:119], a[104:107], a[44:47], v[116:119]
ds_read_b64_tr_b16 a[96:97], v14 offset:0
v_mfma_f32_16x16x32_bf16 v[116:119], a[108:111], a[60:63], v[116:119]
ds_read_b64_tr_b16 a[98:99], v14 offset:256
v_mfma_f32_16x16x32_bf16 v[108:111], a[108:111], a[56:59], v[108:111]
ds_read_b64_tr_b16 a[100:101], v14 offset:2048
s_add_u32 m0, s16, 0x800
v_mfma_f32_16x16x32_bf16 v[108:111], a[104:107], a[40:43], v[108:111]
buffer_load_dwordx4 v22, s[44:47], s21 offen lds
v_mfma_f32_16x16x32_bf16 v[100:103], a[104:107], a[36:39], v[100:103]
ds_read_b64_tr_b16 a[102:103], v14 offset:2304
v_mfma_f32_16x16x32_bf16 v[100:103], a[108:111], a[52:55], v[100:103]
v_mfma_f32_16x16x32_bf16 v[92:95], a[108:111], a[48:51], v[92:95]
v_mfma_f32_16x16x32_bf16 v[92:95], a[104:107], a[32:35], v[92:95]
s_waitcnt lgkmcnt(4)
v_mfma_f32_16x16x32_bf16 v[120:123], a[80:83], a[32:35], v[120:123]
buffer_load_dwordx4 a[144:147], v16, s[76:79], 0 offen offset:0
v_mfma_f32_16x16x32_bf16 v[120:123], a[84:87], a[48:51], v[120:123]
ds_read_b64_tr_b16 a[104:105], v15 offset:0
v_mfma_f32_16x16x32_bf16 v[128:131], a[84:87], a[52:55], v[128:131]
ds_read_b64_tr_b16 a[106:107], v15 offset:256
v_mfma_f32_16x16x32_bf16 v[128:131], a[80:83], a[36:39], v[128:131]
ds_read_b64_tr_b16 a[108:109], v15 offset:2048
v_mfma_f32_16x16x32_bf16 v[136:139], a[80:83], a[40:43], v[136:139]
ds_read_b64_tr_b16 a[110:111], v15 offset:2304
v_mfma_f32_16x16x32_bf16 v[136:139], a[84:87], a[56:59], v[136:139]
s_add_u32 m0, s16, 0xc00
v_mfma_f32_16x16x32_bf16 v[144:147], a[84:87], a[60:63], v[144:147]
buffer_load_dwordx4 v23, s[44:47], s21 offen lds
v_mfma_f32_16x16x32_bf16 v[144:147], a[80:83], a[44:47], v[144:147]
v_mfma_f32_16x16x32_bf16 v[148:151], a[88:91], a[44:47], v[148:151]
ds_read_b64_tr_b16 a[80:81], v14 offset:4096
v_mfma_f32_16x16x32_bf16 v[148:151], a[92:95], a[60:63], v[148:151]
ds_read_b64_tr_b16 a[82:83], v14 offset:4352
v_mfma_f32_16x16x32_bf16 v[140:143], a[92:95], a[56:59], v[140:143]
ds_read_b64_tr_b16 a[84:85], v14 offset:6144
v_mfma_f32_16x16x32_bf16 v[140:143], a[88:91], a[40:43], v[140:143]
ds_read_b64_tr_b16 a[86:87], v14 offset:6400
s_add_u32 m0, s16, 0x1000
v_mfma_f32_16x16x32_bf16 v[132:135], a[88:91], a[36:39], v[132:135]
buffer_load_dwordx4 v22, s[44:47], s22 offen lds
v_mfma_f32_16x16x32_bf16 v[132:135], a[92:95], a[52:55], v[132:135]
v_mfma_f32_16x16x32_bf16 v[124:127], a[92:95], a[48:51], v[124:127]
v_mfma_f32_16x16x32_bf16 v[124:127], a[88:91], a[32:35], v[124:127]
s_waitcnt lgkmcnt(4)
v_mfma_f32_16x16x32_bf16 v[152:155], a[96:99], a[32:35], v[152:155]
ds_read_b64_tr_b16 a[88:89], v15 offset:4096
s_add_u32 m0, s16, 0x1400
v_mfma_f32_16x16x32_bf16 v[152:155], a[100:103], a[48:51], v[152:155]
buffer_load_dwordx4 v23, s[44:47], s22 offen lds
v_mfma_f32_16x16x32_bf16 v[160:163], a[100:103], a[52:55], v[160:163]
ds_read_b64_tr_b16 a[90:91], v15 offset:4352
v_mfma_f32_16x16x32_bf16 v[160:163], a[96:99], a[36:39], v[160:163]
ds_read_b64_tr_b16 a[92:93], v15 offset:6144
v_mfma_f32_16x16x32_bf16 v[168:171], a[96:99], a[40:43], v[168:171]
ds_read_b64_tr_b16 a[94:95], v15 offset:6400
v_mfma_f32_16x16x32_bf16 v[168:171], a[100:103], a[56:59], v[168:171]
v_mfma_f32_16x16x32_bf16 v[176:179], a[100:103], a[60:63], v[176:179]
s_add_u32 m0, s16, 0x1800
v_mfma_f32_16x16x32_bf16 v[176:179], a[96:99], a[44:47], v[176:179]
buffer_load_dwordx4 v22, s[44:47], s23 offen lds
v_mfma_f32_16x16x32_bf16 v[180:183], a[104:107], a[44:47], v[180:183]
ds_read_b64_tr_b16 a[96:97], v14 offset:8192
v_mfma_f32_16x16x32_bf16 v[180:183], a[108:111], a[60:63], v[180:183]
ds_read_b64_tr_b16 a[98:99], v14 offset:8448
v_mfma_f32_16x16x32_bf16 v[172:175], a[108:111], a[56:59], v[172:175]
ds_read_b64_tr_b16 a[100:101], v14 offset:10240
v_mfma_f32_16x16x32_bf16 v[172:175], a[104:107], a[40:43], v[172:175]
ds_read_b64_tr_b16 a[102:103], v14 offset:10496
s_add_u32 m0, s16, 0x1c00
v_mfma_f32_16x16x32_bf16 v[164:167], a[104:107], a[36:39], v[164:167]
buffer_load_dwordx4 v23, s[44:47], s23 offen lds
v_mfma_f32_16x16x32_bf16 v[164:167], a[108:111], a[52:55], v[164:167]
v_lshl_add_u32 v22, s42, 7, v22
v_lshl_add_u32 v23, s42, 7, v23
v_mfma_f32_16x16x32_bf16 v[156:159], a[108:111], a[48:51], v[156:159]
v_mfma_f32_16x16x32_bf16 v[156:159], a[104:107], a[32:35], v[156:159]
s_waitcnt lgkmcnt(4)
v_mfma_f32_16x16x32_bf16 v[184:187], a[80:83], a[32:35], v[184:187]
ds_read_b64_tr_b16 a[104:105], v15 offset:8192
v_mfma_f32_16x16x32_bf16 v[184:187], a[84:87], a[48:51], v[184:187]
ds_read_b64_tr_b16 a[106:107], v15 offset:8448
v_mfma_f32_16x16x32_bf16 v[192:195], a[84:87], a[52:55], v[192:195]
buffer_load_dwordx4 a[148:151], v16, s[76:79], 0 offen offset:1024
v_mfma_f32_16x16x32_bf16 v[192:195], a[80:83], a[36:39], v[192:195]
ds_read_b64_tr_b16 a[108:109], v15 offset:10240
v_mfma_f32_16x16x32_bf16 v[200:203], a[80:83], a[40:43], v[200:203]
ds_read_b64_tr_b16 a[110:111], v15 offset:10496
v_add_u32 v12, 0x8000, v12
v_mfma_f32_16x16x32_bf16 v[200:203], a[84:87], a[56:59], v[200:203]
v_add_u32 v13, 0x8000, v13
v_add_u32 v14, 0x8000, v14
v_mfma_f32_16x16x32_bf16 v[208:211], a[84:87], a[60:63], v[208:211]
v_add_u32 v15, 0x8000, v15
v_mfma_f32_16x16x32_bf16 v[208:211], a[80:83], a[44:47], v[208:211]
v_mfma_f32_16x16x32_bf16 v[212:215], a[88:91], a[44:47], v[212:215]
s_waitcnt vmcnt(28) lgkmcnt(0)
v_mfma_f32_16x16x32_bf16 v[212:215], a[92:95], a[60:63], v[212:215]
s_barrier
s_add_u32 m0, s17, 0x8000
v_mfma_f32_16x16x32_bf16 v[204:207], a[92:95], a[56:59], v[204:207]
buffer_load_dwordx4 v5, s[52:55], 0 offen lds
v_mfma_f32_16x16x32_bf16 v[204:207], a[88:91], a[40:43], v[204:207]
ds_read_b64_tr_b16 a[80:81], v12 offset:0
v_mfma_f32_16x16x32_bf16 v[196:199], a[88:91], a[36:39], v[196:199]
ds_read_b64_tr_b16 a[82:83], v12 offset:1024
v_mfma_f32_16x16x32_bf16 v[196:199], a[92:95], a[52:55], v[196:199]
ds_read_b64_tr_b16 a[84:85], v12 offset:8192
v_mfma_f32_16x16x32_bf16 v[188:191], a[92:95], a[48:51], v[188:191]
ds_read_b64_tr_b16 a[86:87], v12 offset:9216
v_mfma_f32_16x16x32_bf16 v[188:191], a[88:91], a[32:35], v[188:191]
s_waitcnt lgkmcnt(4)
v_mfma_f32_16x16x32_bf16 v[216:219], a[32:35], a[96:99], v[216:219]
ds_read_b64_tr_b16 a[88:89], v13 offset:0
s_add_u32 m0, s17, 0x8400
v_mfma_f32_16x16x32_bf16 v[216:219], a[48:51], a[100:103], v[216:219]
buffer_load_dwordx4 v5, s[52:55], s13 offen lds
v_mfma_f32_16x16x32_bf16 v[224:227], a[52:55], a[100:103], v[224:227]
ds_read_b64_tr_b16 a[90:91], v13 offset:1024
v_mfma_f32_16x16x32_bf16 v[224:227], a[36:39], a[96:99], v[224:227]
ds_read_b64_tr_b16 a[92:93], v13 offset:8192
v_mfma_f32_16x16x32_bf16 v[232:235], a[40:43], a[96:99], v[232:235]
ds_read_b64_tr_b16 a[94:95], v13 offset:9216
v_mfma_f32_16x16x32_bf16 v[232:235], a[56:59], a[100:103], v[232:235]
v_mfma_f32_16x16x32_bf16 v[240:243], a[60:63], a[100:103], v[240:243]
v_mfma_f32_16x16x32_bf16 v[240:243], a[44:47], a[96:99], v[240:243]
v_mfma_f32_16x16x32_bf16 v[244:247], a[44:47], a[104:107], v[244:247]
ds_read_b64_tr_b16 a[96:97], v12 offset:256
s_add_u32 m0, s17, 0x8800
v_mfma_f32_16x16x32_bf16 v[244:247], a[60:63], a[108:111], v[244:247]
buffer_load_dwordx4 v6, s[52:55], 0 offen lds
v_mfma_f32_16x16x32_bf16 v[236:239], a[56:59], a[108:111], v[236:239]
ds_read_b64_tr_b16 a[98:99], v12 offset:1280
v_mfma_f32_16x16x32_bf16 v[236:239], a[40:43], a[104:107], v[236:239]
ds_read_b64_tr_b16 a[100:101], v12 offset:8448
v_mfma_f32_16x16x32_bf16 v[228:231], a[36:39], a[104:107], v[228:231]
ds_read_b64_tr_b16 a[102:103], v12 offset:9472
v_mfma_f32_16x16x32_bf16 v[228:231], a[52:55], a[108:111], v[228:231]
v_mfma_f32_16x16x32_bf16 v[220:223], a[48:51], a[108:111], v[220:223]
v_mfma_f32_16x16x32_bf16 v[220:223], a[32:35], a[104:107], v[220:223]
s_add_u32 m0, s17, 0x8c00
s_waitcnt lgkmcnt(4)
L_S20:
v_mfma_f32_16x16x32_bf16 v[24:27], a[80:83], a[0:3], v[24:27]
ds_read_b64_tr_b16 a[104:105], v13 offset:256
s_waitcnt vmcnt(22)
v_mfma_f32_16x16x32_bf16 v[24:27], a[84:87], a[16:19], v[24:27]
buffer_load_dwordx4 v6, s[52:55], s13 offen lds
v_mfma_f32_16x16x32_bf16 v[32:35], a[84:87], a[20:23], v[32:35]
ds_read_b64_tr_b16 a[106:107], v13 offset:1280
v_mfma_f32_16x16x32_bf16 v[32:35], a[80:83], a[4:7], v[32:35]
ds_read_b64_tr_b16 a[108:109], v13 offset:8448
v_mfma_f32_16x16x32_bf16 v[40:43], a[80:83], a[8:11], v[40:43]
ds_read_b64_tr_b16 a[110:111], v13 offset:9472
v_mfma_f32_16x16x32_bf16 v[40:43], a[84:87], a[24:27], v[40:43]
ds_read_b128 a[32:35], v8 offset:32768
v_mfma_f32_16x16x32_bf16 v[48:51], a[84:87], a[28:31], v[48:51]
ds_read_b128 a[48:51], v9 offset:32768
v_mfma_f32_16x16x32_bf16 v[48:51], a[80:83], a[12:15], v[48:51]
ds_read_b128 a[36:39], v8 offset:34816
s_add_u32 m0, s18, 0xc000
v_mfma_f32_16x16x32_bf16 v[52:55], a[88:91], a[12:15], v[52:55]
buffer_load_dwordx4 v7, s[68:71], 0 offen lds
v_mfma_f32_16x16x32_bf16 v[52:55], a[92:95], a[28:31], v[52:55]
ds_read_b64_tr_b16 a[80:81], v12 offset:512
v_mfma_f32_16x16x32_bf16 v[44:47], a[92:95], a[24:27], v[44:47]
ds_read_b64_tr_b16 a[82:83], v12 offset:1536
v_mfma_f32_16x16x32_bf16 v[44:47], a[88:91], a[8:11], v[44:47]
ds_read_b64_tr_b16 a[84:85], v12 offset:8704
v_mfma_f32_16x16x32_bf16 v[36:39], a[88:91], a[4:7], v[36:39]
ds_read_b64_tr_b16 a[86:87], v12 offset:9728
v_mfma_f32_16x16x32_bf16 v[36:39], a[92:95], a[20:23], v[36:39]
ds_read_b128 a[52:55], v9 offset:34816
v_mfma_f32_16x16x32_bf16 v[28:31], a[92:95], a[16:19], v[28:31]
ds_read_b128 a[40:43], v8 offset:36864
s_waitcnt lgkmcnt(9)
v_mfma_f32_16x16x32_bf16 v[28:31], a[88:91], a[0:3], v[28:31]
ds_read_b128 a[56:59], v9 offset:36864
s_add_u32 m0, s18, 0xd000
v_mfma_f32_16x16x32_bf16 v[56:59], a[96:99], a[0:3], v[56:59]
buffer_load_dwordx4 v7, s[68:71], s25 offen lds
v_mfma_f32_16x16x32_bf16 v[56:59], a[100:103], a[16:19], v[56:59]
ds_read_b64_tr_b16 a[88:89], v13 offset:512
v_mfma_f32_16x16x32_bf16 v[64:67], a[100:103], a[20:23], v[64:67]
ds_read_b64_tr_b16 a[90:91], v13 offset:1536
v_mfma_f32_16x16x32_bf16 v[64:67], a[96:99], a[4:7], v[64:67]
ds_read_b64_tr_b16 a[92:93], v13 offset:8704
v_mfma_f32_16x16x32_bf16 v[72:75], a[96:99], a[8:11], v[72:75]
ds_read_b64_tr_b16 a[94:95], v13 offset:9728
v_mfma_f32_16x16x32_bf16 v[72:75], a[100:103], a[24:27], v[72:75]
ds_read_b128 a[44:47], v8 offset:38912
v_mfma_f32_16x16x32_bf16 v[80:83], a[100:103], a[28:31], v[80:83]
ds_read_b128 a[60:63], v9 offset:38912
v_mfma_f32_16x16x32_bf16 v[80:83], a[96:99], a[12:15], v[80:83]
s_add_u32 m0, s18, 0xe000
v_mfma_f32_16x16x32_bf16 v[84:87], a[104:107], a[12:15], v[84:87]
buffer_load_dwordx4 v7, s[68:71], s26 offen lds
v_mfma_f32_16x16x32_bf16 v[84:87], a[108:111], a[28:31], v[84:87]
ds_read_b64_tr_b16 a[96:97], v12 offset:768
v_lshl_add_u32 v5, s42, 19, v5
v_mfma_f32_16x16x32_bf16 v[76:79], a[108:111], a[24:27], v[76:79]
ds_read_b64_tr_b16 a[98:99], v12 offset:1792
v_lshl_add_u32 v6, s42, 19, v6
v_mfma_f32_16x16x32_bf16 v[76:79], a[104:107], a[8:11], v[76:79]
ds_read_b64_tr_b16 a[100:101], v12 offset:8960
L_padA10:
s_cmp_eq_u32 s95, 1
s_cbranch_scc1 L_hopA_ret
v_lshl_add_u32 v7, s42, 18, v7
v_mfma_f32_16x16x32_bf16 v[68:71], a[104:107], a[4:7], v[68:71]
ds_read_b64_tr_b16 a[102:103], v12 offset:9984
v_lshl_add_u32 v7, s42, 17, v7
v_mfma_f32_16x16x32_bf16 v[68:71], a[108:111], a[20:23], v[68:71]
s_waitcnt vmcnt(13)
v_accvgpr_read_b32 v18, a144
v_lshlrev_b32 v1, 16, v18
v_mfma_f32_16x16x32_bf16 v[60:63], a[108:111], a[16:19], v[60:63]
v_and_b32 v18, 0xffff0000, v18
v_accvgpr_read_b32 v21, a128
v_mfma_f32_16x16x32_bf16 v[60:63], a[104:107], a[0:3], v[60:63]
s_add_u32 m0, s16, 0x8000
s_waitcnt lgkmcnt(4)
s_waitcnt lgkmcnt(6)
v_mfma_f32_16x16x32_bf16 v[88:91], a[80:83], a[0:3], v[88:91]
buffer_load_dwordx4 v22, s[44:47], s20 offen lds
v_mfma_f32_16x16x32_bf16 v[88:91], a[84:87], a[16:19], v[88:91]
ds_read_b64_tr_b16 a[104:105], v13 offset:768
v_lshlrev_b32 v20, 16, v21
v_mfma_f32_16x16x32_bf16 v[96:99], a[84:87], a[20:23], v[96:99]
ds_read_b64_tr_b16 a[106:107], v13 offset:1792
v_and_b32 v21, 0xffff0000, v21
v_mfma_f32_16x16x32_bf16 v[96:99], a[80:83], a[4:7], v[96:99]
ds_read_b64_tr_b16 a[108:109], v13 offset:8960
v_mul_f32 v2, v1, v20
v_mfma_f32_16x16x32_bf16 v[104:107], a[80:83], a[8:11], v[104:107]
ds_read_b64_tr_b16 a[110:111], v13 offset:9984
v_fmac_f32 v2, v18, v21
v_mfma_f32_16x16x32_bf16 v[104:107], a[84:87], a[24:27], v[104:107]
v_accvgpr_read_b32 v21, a136
v_lshlrev_b32 v20, 16, v21
v_mfma_f32_16x16x32_bf16 v[112:115], a[84:87], a[28:31], v[112:115]
s_add_u32 m0, s16, 0x8400
v_and_b32 v21, 0xffff0000, v21
v_mul_f32 v3, v1, v20
v_mfma_f32_16x16x32_bf16 v[112:115], a[80:83], a[12:15], v[112:115]
buffer_load_dwordx4 v23, s[44:47], s20 offen lds
v_mfma_f32_16x16x32_bf16 v[116:119], a[88:91], a[12:15], v[116:119]
ds_read_b64_tr_b16 a[80:81], v14 offset:0
v_fmac_f32 v3, v18, v21
v_mfma_f32_16x16x32_bf16 v[116:119], a[92:95], a[28:31], v[116:119]
ds_read_b64_tr_b16 a[82:83], v14 offset:256
v_accvgpr_read_b32 v18, a145
v_mfma_f32_16x16x32_bf16 v[108:111], a[92:95], a[24:27], v[108:111]
ds_read_b64_tr_b16 a[84:85], v14 offset:2048
v_lshlrev_b32 v1, 16, v18
v_mfma_f32_16x16x32_bf16 v[108:111], a[88:91], a[8:11], v[108:111]
ds_read_b64_tr_b16 a[86:87], v14 offset:2304
v_and_b32 v18, 0xffff0000, v18
v_mfma_f32_16x16x32_bf16 v[100:103], a[88:91], a[4:7], v[100:103]
v_accvgpr_read_b32 v21, a129
v_lshlrev_b32 v20, 16, v21
v_mfma_f32_16x16x32_bf16 v[100:103], a[92:95], a[20:23], v[100:103]
s_add_u32 m0, s16, 0x8800
v_and_b32 v21, 0xffff0000, v21
v_fmac_f32 v2, v1, v20
v_mfma_f32_16x16x32_bf16 v[92:95], a[92:95], a[16:19], v[92:95]
buffer_load_dwordx4 v22, s[44:47], s21 offen lds
v_mfma_f32_16x16x32_bf16 v[92:95], a[88:91], a[0:3], v[92:95]
s_waitcnt lgkmcnt(4)
v_fmac_f32 v2, v18, v21
v_accvgpr_read_b32 v21, a137
v_mfma_f32_16x16x32_bf16 v[120:123], a[96:99], a[0:3], v[120:123]
ds_read_b64_tr_b16 a[88:89], v15 offset:0
v_lshlrev_b32 v20, 16, v21
v_mfma_f32_16x16x32_bf16 v[120:123], a[100:103], a[16:19], v[120:123]
ds_read_b64_tr_b16 a[90:91], v15 offset:256
v_and_b32 v21, 0xffff0000, v21
v_mfma_f32_16x16x32_bf16 v[128:131], a[100:103], a[20:23], v[128:131]
ds_read_b64_tr_b16 a[92:93], v15 offset:2048
v_fmac_f32 v3, v1, v20
v_mfma_f32_16x16x32_bf16 v[128:131], a[96:99], a[4:7], v[128:131]
ds_read_b64_tr_b16 a[94:95], v15 offset:2304
v_fmac_f32 v3, v18, v21
v_mfma_f32_16x16x32_bf16 v[136:139], a[96:99], a[8:11], v[136:139]
s_add_u32 m0, s16, 0x8c00
v_accvgpr_read_b32 v18, a146
v_lshlrev_b32 v1, 16, v18
v_mfma_f32_16x16x32_bf16 v[136:139], a[100:103], a[24:27], v[136:139]
buffer_load_dwordx4 v23, s[44:47], s21 offen lds
v_mfma_f32_16x16x32_bf16 v[144:147], a[100:103], a[28:31], v[144:147]
v_and_b32 v18, 0xffff0000, v18
v_accvgpr_read_b32 v21, a130
v_mfma_f32_16x16x32_bf16 v[144:147], a[96:99], a[12:15], v[144:147]
v_lshlrev_b32 v20, 16, v21
v_and_b32 v21, 0xffff0000, v21
v_mfma_f32_16x16x32_bf16 v[148:151], a[104:107], a[12:15], v[148:151]
ds_read_b64_tr_b16 a[96:97], v14 offset:4096
v_fmac_f32 v2, v1, v20
v_mfma_f32_16x16x32_bf16 v[148:151], a[108:111], a[28:31], v[148:151]
ds_read_b64_tr_b16 a[98:99], v14 offset:4352
v_fmac_f32 v2, v18, v21
v_mfma_f32_16x16x32_bf16 v[140:143], a[108:111], a[24:27], v[140:143]
ds_read_b64_tr_b16 a[100:101], v14 offset:6144
v_accvgpr_read_b32 v21, a138
v_mfma_f32_16x16x32_bf16 v[140:143], a[104:107], a[8:11], v[140:143]
ds_read_b64_tr_b16 a[102:103], v14 offset:6400
s_add_u32 m0, s16, 0x9000
v_mfma_f32_16x16x32_bf16 v[132:135], a[104:107], a[4:7], v[132:135]
buffer_load_dwordx4 v22, s[44:47], s22 offen lds
v_mfma_f32_16x16x32_bf16 v[132:135], a[108:111], a[20:23], v[132:135]
v_lshlrev_b32 v20, 16, v21
v_and_b32 v21, 0xffff0000, v21
v_mfma_f32_16x16x32_bf16 v[124:127], a[108:111], a[16:19], v[124:127]
v_fmac_f32 v3, v1, v20
v_fmac_f32 v3, v18, v21
v_mfma_f32_16x16x32_bf16 v[124:127], a[104:107], a[0:3], v[124:127]
s_waitcnt lgkmcnt(4)
v_accvgpr_read_b32 v18, a147
v_lshlrev_b32 v1, 16, v18
v_mfma_f32_16x16x32_bf16 v[152:155], a[80:83], a[0:3], v[152:155]
ds_read_b64_tr_b16 a[104:105], v15 offset:4096
v_and_b32 v18, 0xffff0000, v18
v_mfma_f32_16x16x32_bf16 v[152:155], a[84:87], a[16:19], v[152:155]
ds_read_b64_tr_b16 a[106:107], v15 offset:4352
v_accvgpr_read_b32 v21, a131
v_mfma_f32_16x16x32_bf16 v[160:163], a[84:87], a[20:23], v[160:163]
ds_read_b64_tr_b16 a[108:109], v15 offset:6144
s_add_u32 m0, s16, 0x9400
v_mfma_f32_16x16x32_bf16 v[160:163], a[80:83], a[4:7], v[160:163]
buffer_load_dwordx4 v23, s[44:47], s22 offen lds
v_mfma_f32_16x16x32_bf16 v[168:171], a[80:83], a[8:11], v[168:171]
ds_read_b64_tr_b16 a[110:111], v15 offset:6400
v_lshlrev_b32 v20, 16, v21
v_mfma_f32_16x16x32_bf16 v[168:171], a[84:87], a[24:27], v[168:171]
v_and_b32 v21, 0xffff0000, v21
v_fmac_f32 v2, v1, v20
v_mfma_f32_16x16x32_bf16 v[176:179], a[84:87], a[28:31], v[176:179]
v_fmac_f32 v2, v18, v21
v_accvgpr_read_b32 v21, a139
v_mfma_f32_16x16x32_bf16 v[176:179], a[80:83], a[12:15], v[176:179]
v_lshlrev_b32 v20, 16, v21
v_and_b32 v21, 0xffff0000, v21
v_mfma_f32_16x16x32_bf16 v[180:183], a[88:91], a[12:15], v[180:183]
ds_read_b64_tr_b16 a[80:81], v14 offset:8192
v_fmac_f32 v3, v1, v20
v_mfma_f32_16x16x32_bf16 v[180:183], a[92:95], a[28:31], v[180:183]
ds_read_b64_tr_b16 a[82:83], v14 offset:8448
s_add_u32 m0, s16, 0x9800
v_mfma_f32_16x16x32_bf16 v[172:175], a[92:95], a[24:27], v[172:175]
buffer_load_dwordx4 v22, s[44:47], s23 offen lds
v_mfma_f32_16x16x32_bf16 v[172:175], a[88:91], a[8:11], v[172:175]
ds_read_b64_tr_b16 a[84:85], v14 offset:10240
v_fmac_f32 v3, v18, v21
v_mfma_f32_16x16x32_bf16 v[164:167], a[88:91], a[4:7], v[164:167]
ds_read_b64_tr_b16 a[86:87], v14 offset:10496
s_waitcnt vmcnt(14)
v_accvgpr_read_b32 v18, a148
v_mfma_f32_16x16x32_bf16 v[164:167], a[92:95], a[20:23], v[164:167]
v_lshlrev_b32 v1, 16, v18
v_and_b32 v18, 0xffff0000, v18
v_mfma_f32_16x16x32_bf16 v[156:159], a[92:95], a[16:19], v[156:159]
v_accvgpr_read_b32 v21, a132
v_lshlrev_b32 v20, 16, v21
v_mfma_f32_16x16x32_bf16 v[156:159], a[88:91], a[0:3], v[156:159]
s_waitcnt lgkmcnt(4)
v_and_b32 v21, 0xffff0000, v21
v_fmac_f32 v2, v1, v20
v_mfma_f32_16x16x32_bf16 v[184:187], a[96:99], a[0:3], v[184:187]
ds_read_b64_tr_b16 a[88:89], v15 offset:8192
s_add_u32 m0, s16, 0x9c00
v_mfma_f32_16x16x32_bf16 v[184:187], a[100:103], a[16:19], v[184:187]
buffer_load_dwordx4 v23, s[44:47], s23 offen lds
v_mfma_f32_16x16x32_bf16 v[192:195], a[100:103], a[20:23], v[192:195]
ds_read_b64_tr_b16 a[90:91], v15 offset:8448
v_fmac_f32 v2, v18, v21
v_mfma_f32_16x16x32_bf16 v[192:195], a[96:99], a[4:7], v[192:195]
ds_read_b64_tr_b16 a[92:93], v15 offset:10240
v_accvgpr_read_b32 v21, a140
v_mfma_f32_16x16x32_bf16 v[200:203], a[96:99], a[8:11], v[200:203]
ds_read_b64_tr_b16 a[94:95], v15 offset:10496
v_add_u32 v12, 0xffff0000, v12
v_mfma_f32_16x16x32_bf16 v[200:203], a[100:103], a[24:27], v[200:203]
v_add_u32 v13, 0xffff0000, v13
v_add_u32 v14, 0xffff0000, v14
v_mfma_f32_16x16x32_bf16 v[208:211], a[100:103], a[28:31], v[208:211]
v_add_u32 v15, 0xffff0000, v15
v_lshlrev_b32 v20, 16, v21
v_mfma_f32_16x16x32_bf16 v[208:211], a[96:99], a[12:15], v[208:211]
v_and_b32 v21, 0xffff0000, v21
v_fmac_f32 v3, v1, v20
v_mfma_f32_16x16x32_bf16 v[212:215], a[104:107], a[12:15], v[212:215]
s_waitcnt vmcnt(25) lgkmcnt(0)
v_fmac_f32 v3, v18, v21
v_accvgpr_read_b32 v18, a149
v_mfma_f32_16x16x32_bf16 v[212:215], a[108:111], a[28:31], v[212:215]
s_barrier
s_add_u32 m0, s17, 0x10000
v_lshlrev_b32 v1, 16, v18
v_mfma_f32_16x16x32_bf16 v[204:207], a[108:111], a[24:27], v[204:207]
buffer_load_dwordx4 v5, s[52:55], 0 offen lds
v_mfma_f32_16x16x32_bf16 v[204:207], a[104:107], a[8:11], v[204:207]
ds_read_b64_tr_b16 a[96:97], v12 offset:0
v_and_b32 v18, 0xffff0000, v18
v_mfma_f32_16x16x32_bf16 v[196:199], a[104:107], a[4:7], v[196:199]
ds_read_b64_tr_b16 a[98:99], v12 offset:1024
v_accvgpr_read_b32 v21, a133
v_mfma_f32_16x16x32_bf16 v[196:199], a[108:111], a[20:23], v[196:199]
ds_read_b64_tr_b16 a[100:101], v12 offset:8192
v_lshlrev_b32 v20, 16, v21
v_mfma_f32_16x16x32_bf16 v[188:191], a[108:111], a[16:19], v[188:191]
ds_read_b64_tr_b16 a[102:103], v12 offset:9216
v_and_b32 v21, 0xffff0000, v21
v_mfma_f32_16x16x32_bf16 v[188:191], a[104:107], a[0:3], v[188:191]
s_waitcnt lgkmcnt(4)
v_fmac_f32 v2, v1, v20
v_fmac_f32 v2, v18, v21
v_mfma_f32_16x16x32_bf16 v[216:219], a[0:3], a[80:83], v[216:219]
ds_read_b64_tr_b16 a[104:105], v13 offset:0
v_accvgpr_read_b32 v21, a141
v_mfma_f32_16x16x32_bf16 v[216:219], a[16:19], a[84:87], v[216:219]
ds_read_b64_tr_b16 a[106:107], v13 offset:1024
s_add_u32 m0, s17, 0x10400
v_mfma_f32_16x16x32_bf16 v[224:227], a[20:23], a[84:87], v[224:227]
buffer_load_dwordx4 v5, s[52:55], s13 offen lds
v_mfma_f32_16x16x32_bf16 v[224:227], a[4:7], a[80:83], v[224:227]
ds_read_b64_tr_b16 a[108:109], v13 offset:8192
v_lshlrev_b32 v20, 16, v21
v_mfma_f32_16x16x32_bf16 v[232:235], a[8:11], a[80:83], v[232:235]
ds_read_b64_tr_b16 a[110:111], v13 offset:9216
v_and_b32 v21, 0xffff0000, v21
v_mfma_f32_16x16x32_bf16 v[232:235], a[24:27], a[84:87], v[232:235]
v_fmac_f32 v3, v1, v20
v_fmac_f32 v3, v18, v21
v_mfma_f32_16x16x32_bf16 v[240:243], a[28:31], a[84:87], v[240:243]
v_accvgpr_read_b32 v18, a150
v_lshlrev_b32 v1, 16, v18
v_mfma_f32_16x16x32_bf16 v[240:243], a[12:15], a[80:83], v[240:243]
v_and_b32 v18, 0xffff0000, v18
v_accvgpr_read_b32 v21, a134
v_mfma_f32_16x16x32_bf16 v[244:247], a[12:15], a[88:91], v[244:247]
ds_read_b64_tr_b16 a[80:81], v12 offset:256
v_lshlrev_b32 v20, 16, v21
v_mfma_f32_16x16x32_bf16 v[244:247], a[28:31], a[92:95], v[244:247]
ds_read_b64_tr_b16 a[82:83], v12 offset:1280
v_and_b32 v21, 0xffff0000, v21
v_mfma_f32_16x16x32_bf16 v[236:239], a[24:27], a[92:95], v[236:239]
ds_read_b64_tr_b16 a[84:85], v12 offset:8448
s_add_u32 m0, s17, 0x10800
v_mfma_f32_16x16x32_bf16 v[236:239], a[8:11], a[88:91], v[236:239]
buffer_load_dwordx4 v6, s[52:55], 0 offen lds
v_mfma_f32_16x16x32_bf16 v[228:231], a[4:7], a[88:91], v[228:231]
ds_read_b64_tr_b16 a[86:87], v12 offset:9472
v_fmac_f32 v2, v1, v20
v_mfma_f32_16x16x32_bf16 v[228:231], a[20:23], a[92:95], v[228:231]
v_fmac_f32 v2, v18, v21
v_accvgpr_read_b32 v21, a142
v_mfma_f32_16x16x32_bf16 v[220:223], a[16:19], a[92:95], v[220:223]
v_lshlrev_b32 v20, 16, v21
v_and_b32 v21, 0xffff0000, v21
v_mfma_f32_16x16x32_bf16 v[220:223], a[0:3], a[88:91], v[220:223]
s_waitcnt lgkmcnt(4)
v_fmac_f32 v3, v1, v20
v_fmac_f32 v3, v18, v21
L_S21:
v_mfma_f32_16x16x32_bf16 v[24:27], a[96:99], a[32:35], v[24:27]
ds_read_b64_tr_b16 a[88:89], v13 offset:256
s_waitcnt vmcnt(19)
v_mfma_f32_16x16x32_bf16 v[24:27], a[100:103], a[48:51], v[24:27]
ds_read_b64_tr_b16 a[90:91], v13 offset:1280
v_accvgpr_read_b32 v18, a151
v_mfma_f32_16x16x32_bf16 v[32:35], a[100:103], a[52:55], v[32:35]
ds_read_b64_tr_b16 a[92:93], v13 offset:8448
s_add_u32 m0, s17, 0x10c00
v_mfma_f32_16x16x32_bf16 v[32:35], a[96:99], a[36:39], v[32:35]
buffer_load_dwordx4 v6, s[52:55], s13 offen lds
v_mfma_f32_16x16x32_bf16 v[40:43], a[96:99], a[40:43], v[40:43]
ds_read_b64_tr_b16 a[94:95], v13 offset:9472
v_lshlrev_b32 v1, 16, v18
v_mfma_f32_16x16x32_bf16 v[40:43], a[100:103], a[56:59], v[40:43]
ds_read_b128 a[0:3], v8 offset:0
v_and_b32 v18, 0xffff0000, v18
v_mfma_f32_16x16x32_bf16 v[48:51], a[100:103], a[60:63], v[48:51]
ds_read_b128 a[16:19], v9 offset:0
v_accvgpr_read_b32 v21, a135
v_mfma_f32_16x16x32_bf16 v[48:51], a[96:99], a[44:47], v[48:51]
ds_read_b128 a[4:7], v8 offset:2048
v_lshlrev_b32 v20, 16, v21
v_mfma_f32_16x16x32_bf16 v[52:55], a[104:107], a[44:47], v[52:55]
ds_read_b64_tr_b16 a[96:97], v12 offset:512
v_and_b32 v21, 0xffff0000, v21
v_mfma_f32_16x16x32_bf16 v[52:55], a[108:111], a[60:63], v[52:55]
ds_read_b64_tr_b16 a[98:99], v12 offset:1536
v_fmac_f32 v2, v1, v20
v_mfma_f32_16x16x32_bf16 v[44:47], a[108:111], a[56:59], v[44:47]
ds_read_b64_tr_b16 a[100:101], v12 offset:8704
v_fmac_f32 v2, v18, v21
v_mfma_f32_16x16x32_bf16 v[44:47], a[104:107], a[40:43], v[44:47]
ds_read_b64_tr_b16 a[102:103], v12 offset:9728
s_add_u32 m0, s18, 0x14000
v_mfma_f32_16x16x32_bf16 v[36:39], a[104:107], a[36:39], v[36:39]
buffer_load_dwordx4 v7, s[68:71], 0 offen lds
v_mfma_f32_16x16x32_bf16 v[36:39], a[108:111], a[52:55], v[36:39]
ds_read_b128 a[20:23], v9 offset:2048
v_accvgpr_read_b32 v21, a143
v_mfma_f32_16x16x32_bf16 v[28:31], a[108:111], a[48:51], v[28:31]
ds_read_b128 a[8:11], v8 offset:4096
v_lshlrev_b32 v20, 16, v21
v_mfma_f32_16x16x32_bf16 v[28:31], a[104:107], a[32:35], v[28:31]
ds_read_b128 a[24:27], v9 offset:4096
s_waitcnt lgkmcnt(10)
v_mfma_f32_16x16x32_bf16 v[56:59], a[80:83], a[32:35], v[56:59]
ds_read_b64_tr_b16 a[104:105], v13 offset:512
v_and_b32 v21, 0xffff0000, v21
v_mfma_f32_16x16x32_bf16 v[56:59], a[84:87], a[48:51], v[56:59]
ds_read_b64_tr_b16 a[106:107], v13 offset:1536
v_fmac_f32 v3, v1, v20
v_mfma_f32_16x16x32_bf16 v[64:67], a[84:87], a[52:55], v[64:67]
ds_read_b64_tr_b16 a[108:109], v13 offset:8704
v_fmac_f32 v3, v18, v21
v_mfma_f32_16x16x32_bf16 v[64:67], a[80:83], a[36:39], v[64:67]
ds_read_b64_tr_b16 a[110:111], v13 offset:9728
s_add_u32 m0, s18, 0x15000
v_mfma_f32_16x16x32_bf16 v[72:75], a[80:83], a[40:43], v[72:75]
buffer_load_dwordx4 v7, s[68:71], s25 offen lds
v_mfma_f32_16x16x32_bf16 v[72:75], a[84:87], a[56:59], v[72:75]
ds_read_b128 a[12:15], v8 offset:6144
v_add_f32_dpp v2, v2, v2 row_ror:8 row_mask:0xf bank_mask:0xf
v_mfma_f32_16x16x32_bf16 v[80:83], a[84:87], a[60:63], v[80:83]
ds_read_b128 a[28:31], v9 offset:6144
v_add_f32_dpp v3, v3, v3 row_ror:8 row_mask:0xf bank_mask:0xf
v_mfma_f32_16x16x32_bf16 v[80:83], a[80:83], a[44:47], v[80:83]
v_add_f32_dpp v2, v2, v2 row_ror:4 row_mask:0xf bank_mask:0xf
v_add_f32_dpp v3, v3, v3 row_ror:4 row_mask:0xf bank_mask:0xf
v_mfma_f32_16x16x32_bf16 v[84:87], a[88:91], a[44:47], v[84:87]
ds_read_b64_tr_b16 a[80:81], v12 offset:768
v_add_f32_dpp v2, v2, v2 row_ror:2 row_mask:0xf bank_mask:0xf
v_mfma_f32_16x16x32_bf16 v[84:87], a[92:95], a[60:63], v[84:87]
ds_read_b64_tr_b16 a[82:83], v12 offset:1792
v_add_f32_dpp v3, v3, v3 row_ror:2 row_mask:0xf bank_mask:0xf
v_mfma_f32_16x16x32_bf16 v[76:79], a[92:95], a[56:59], v[76:79]
ds_read_b64_tr_b16 a[84:85], v12 offset:8960
v_add_f32_dpp v2, v2, v2 row_ror:1 row_mask:0xf bank_mask:0xf
v_mfma_f32_16x16x32_bf16 v[76:79], a[88:91], a[40:43], v[76:79]
ds_read_b64_tr_b16 a[86:87], v12 offset:9984
v_add_f32_dpp v3, v3, v3 row_ror:1 row_mask:0xf bank_mask:0xf
v_mfma_f32_16x16x32_bf16 v[68:71], a[88:91], a[36:39], v[68:71]
s_add_u32 m0, s18, 0x16000
v_mov_b32 v1, v2
v_mov_b32 v18, v3
v_mfma_f32_16x16x32_bf16 v[68:71], a[92:95], a[52:55], v[68:71]
buffer_load_dwordx4 v7, s[68:71], s26 offen lds
v_mfma_f32_16x16x32_bf16 v[60:63], a[92:95], a[48:51], v[60:63]
v_permlane16_swap_b32 v1, v2
v_permlane16_swap_b32 v18, v3
v_mfma_f32_16x16x32_bf16 v[60:63], a[88:91], a[32:35], v[60:63]
s_waitcnt lgkmcnt(6)
v_add_f32 v2, v2, v1
v_add_f32 v3, v3, v18
v_mfma_f32_16x16x32_bf16 v[88:91], a[96:99], a[32:35], v[88:91]
ds_read_b64_tr_b16 a[88:89], v13 offset:768
v_mov_b32 v1, v2
v_mfma_f32_16x16x32_bf16 v[88:91], a[100:103], a[48:51], v[88:91]
ds_read_b64_tr_b16 a[90:91], v13 offset:1792
v_mov_b32 v18, v3
v_mfma_f32_16x16x32_bf16 v[96:99], a[100:103], a[52:55], v[96:99]
ds_read_b64_tr_b16 a[92:93], v13 offset:8960
v_permlane32_swap_b32 v1, v2
v_mfma_f32_16x16x32_bf16 v[96:99], a[96:99], a[36:39], v[96:99]
ds_read_b64_tr_b16 a[94:95], v13 offset:9984
v_permlane32_swap_b32 v18, v3
v_mfma_f32_16x16x32_bf16 v[104:107], a[96:99], a[40:43], v[104:107]
v_add_f32 v2, v2, v1
v_add_f32 v3, v3, v18
v_mfma_f32_16x16x32_bf16 v[104:107], a[100:103], a[56:59], v[104:107]
buffer_load_dword v23, off, s[84:87], s10 sc1
v_mfma_f32_16x16x32_bf16 v[112:115], a[100:103], a[60:63], v[112:115]
v_mul_f32 v2, 0xbfb8aa3b, v2
v_mul_f32 v3, 0xbfb8aa3b, v3
v_mfma_f32_16x16x32_bf16 v[112:115], a[96:99], a[44:47], v[112:115]
v_exp_f32 v2, v2
v_mfma_f32_16x16x32_bf16 v[116:119], a[104:107], a[44:47], v[116:119]
ds_read_b64_tr_b16 a[96:97], v14 offset:0
v_mfma_f32_16x16x32_bf16 v[116:119], a[108:111], a[60:63], v[116:119]
ds_read_b64_tr_b16 a[98:99], v14 offset:256
v_mfma_f32_16x16x32_bf16 v[108:111], a[108:111], a[56:59], v[108:111]
ds_read_b64_tr_b16 a[100:101], v14 offset:2048
v_mfma_f32_16x16x32_bf16 v[108:111], a[104:107], a[40:43], v[108:111]
ds_read_b64_tr_b16 a[102:103], v14 offset:2304
v_mfma_f32_16x16x32_bf16 v[100:103], a[104:107], a[36:39], v[100:103]
v_exp_f32 v3, v3
v_mfma_f32_16x16x32_bf16 v[100:103], a[108:111], a[52:55], v[100:103]
v_add_f32 v2, 1.0, v2
v_add_f32 v3, 1.0, v3
v_mfma_f32_16x16x32_bf16 v[92:95], a[108:111], a[48:51], v[92:95]
v_rcp_f32 v2, v2
v_mfma_f32_16x16x32_bf16 v[92:95], a[104:107], a[32:35], v[92:95]
s_waitcnt lgkmcnt(4)
v_rcp_f32 v3, v3
v_mfma_f32_16x16x32_bf16 v[120:123], a[80:83], a[32:35], v[120:123]
ds_read_b64_tr_b16 a[104:105], v15 offset:0
v_mfma_f32_16x16x32_bf16 v[120:123], a[84:87], a[48:51], v[120:123]
ds_read_b64_tr_b16 a[106:107], v15 offset:256
v_mfma_f32_16x16x32_bf16 v[128:131], a[84:87], a[52:55], v[128:131]
ds_read_b64_tr_b16 a[108:109], v15 offset:2048
v_mfma_f32_16x16x32_bf16 v[128:131], a[80:83], a[36:39], v[128:131]
ds_read_b64_tr_b16 a[110:111], v15 offset:2304
v_mfma_f32_16x16x32_bf16 v[136:139], a[80:83], a[40:43], v[136:139]
buffer_store_dwordx2 v[2:3], off, s[88:91], s101 sc1
v_mfma_f32_16x16x32_bf16 v[136:139], a[84:87], a[56:59], v[136:139]
v_mfma_f32_16x16x32_bf16 v[144:147], a[84:87], a[60:63], v[144:147]
v_mfma_f32_16x16x32_bf16 v[144:147], a[80:83], a[44:47], v[144:147]
v_mfma_f32_16x16x32_bf16 v[148:151], a[88:91], a[44:47], v[148:151]
ds_read_b64_tr_b16 a[80:81], v14 offset:4096
v_mfma_f32_16x16x32_bf16 v[148:151], a[92:95], a[60:63], v[148:151]
ds_read_b64_tr_b16 a[82:83], v14 offset:4352
v_mfma_f32_16x16x32_bf16 v[140:143], a[92:95], a[56:59], v[140:143]
ds_read_b64_tr_b16 a[84:85], v14 offset:6144
v_mfma_f32_16x16x32_bf16 v[140:143], a[88:91], a[40:43], v[140:143]
ds_read_b64_tr_b16 a[86:87], v14 offset:6400
v_mfma_f32_16x16x32_bf16 v[132:135], a[88:91], a[36:39], v[132:135]
v_mfma_f32_16x16x32_bf16 v[132:135], a[92:95], a[52:55], v[132:135]
v_mfma_f32_16x16x32_bf16 v[124:127], a[92:95], a[48:51], v[124:127]
v_mfma_f32_16x16x32_bf16 v[124:127], a[88:91], a[32:35], v[124:127]
s_waitcnt lgkmcnt(4)
v_mfma_f32_16x16x32_bf16 v[152:155], a[96:99], a[32:35], v[152:155]
ds_read_b64_tr_b16 a[88:89], v15 offset:4096
v_mfma_f32_16x16x32_bf16 v[152:155], a[100:103], a[48:51], v[152:155]
ds_read_b64_tr_b16 a[90:91], v15 offset:4352
v_mfma_f32_16x16x32_bf16 v[160:163], a[100:103], a[52:55], v[160:163]
ds_read_b64_tr_b16 a[92:93], v15 offset:6144
v_mfma_f32_16x16x32_bf16 v[160:163], a[96:99], a[36:39], v[160:163]
ds_read_b64_tr_b16 a[94:95], v15 offset:6400
v_mfma_f32_16x16x32_bf16 v[168:171], a[96:99], a[40:43], v[168:171]
v_mfma_f32_16x16x32_bf16 v[168:171], a[100:103], a[56:59], v[168:171]
v_mfma_f32_16x16x32_bf16 v[176:179], a[100:103], a[60:63], v[176:179]
v_mfma_f32_16x16x32_bf16 v[176:179], a[96:99], a[44:47], v[176:179]
v_mfma_f32_16x16x32_bf16 v[180:183], a[104:107], a[44:47], v[180:183]
ds_read_b64_tr_b16 a[96:97], v14 offset:8192
v_mfma_f32_16x16x32_bf16 v[180:183], a[108:111], a[60:63], v[180:183]
ds_read_b64_tr_b16 a[98:99], v14 offset:8448
v_mfma_f32_16x16x32_bf16 v[172:175], a[108:111], a[56:59], v[172:175]
ds_read_b64_tr_b16 a[100:101], v14 offset:10240
v_mfma_f32_16x16x32_bf16 v[172:175], a[104:107], a[40:43], v[172:175]
ds_read_b64_tr_b16 a[102:103], v14 offset:10496
v_mfma_f32_16x16x32_bf16 v[164:167], a[104:107], a[36:39], v[164:167]
v_mfma_f32_16x16x32_bf16 v[164:167], a[108:111], a[52:55], v[164:167]
v_mfma_f32_16x16x32_bf16 v[156:159], a[108:111], a[48:51], v[156:159]
v_mfma_f32_16x16x32_bf16 v[156:159], a[104:107], a[32:35], v[156:159]
s_waitcnt lgkmcnt(4)
v_mfma_f32_16x16x32_bf16 v[184:187], a[80:83], a[32:35], v[184:187]
ds_read_b64_tr_b16 a[104:105], v15 offset:8192
v_mfma_f32_16x16x32_bf16 v[184:187], a[84:87], a[48:51], v[184:187]
ds_read_b64_tr_b16 a[106:107], v15 offset:8448
v_mfma_f32_16x16x32_bf16 v[192:195], a[84:87], a[52:55], v[192:195]
ds_read_b64_tr_b16 a[108:109], v15 offset:10240
v_mfma_f32_16x16x32_bf16 v[192:195], a[80:83], a[36:39], v[192:195]
ds_read_b64_tr_b16 a[110:111], v15 offset:10496
v_add_u32 v12, 0x8000, v12
v_mfma_f32_16x16x32_bf16 v[200:203], a[80:83], a[40:43], v[200:203]
v_add_u32 v13, 0x8000, v13
v_add_u32 v14, 0x8000, v14
v_mfma_f32_16x16x32_bf16 v[200:203], a[84:87], a[56:59], v[200:203]
v_add_u32 v15, 0x8000, v15
v_mfma_f32_16x16x32_bf16 v[208:211], a[84:87], a[60:63], v[208:211]
v_mfma_f32_16x16x32_bf16 v[208:211], a[80:83], a[44:47], v[208:211]
v_mfma_f32_16x16x32_bf16 v[212:215], a[88:91], a[44:47], v[212:215]
s_waitcnt vmcnt(1) lgkmcnt(0)
s_mov_b32 s92, 200000
L_spin_kv:
v_readfirstlane_b32 s93, v23
s_nop 1
s_cmp_ge_u32 s93, 8
s_cbranch_scc1 L_spun_kv
s_sub_u32 s92, s92, 1
s_cbranch_scc1 L_spun_kv
s_sleep 4
buffer_load_dword v23, off, s[84:87], s10 sc1
s_waitcnt vmcnt(0)
s_branch L_spin_kv
L_spun_kv:
v_mfma_f32_16x16x32_bf16 v[212:215], a[92:95], a[60:63], v[212:215]
s_barrier
s_add_u32 m0, s19, 0x0
v_mfma_f32_16x16x32_bf16 v[204:207], a[92:95], a[56:59], v[204:207]
buffer_load_dwordx4 v16, s[48:51], s32 offen offset:0 sc1 lds
v_mfma_f32_16x16x32_bf16 v[204:207], a[88:91], a[40:43], v[204:207]
ds_read_b64_tr_b16 a[80:81], v12 offset:0
v_mov_b32 v3, v16
v_mfma_f32_16x16x32_bf16 v[196:199], a[88:91], a[36:39], v[196:199]
ds_read_b64_tr_b16 a[82:83], v12 offset:1024
v_mov_b32 v22, 0x3f803f80
v_mfma_f32_16x16x32_bf16 v[196:199], a[92:95], a[52:55], v[196:199]
ds_read_b64_tr_b16 a[84:85], v12 offset:8192
s_mov_b32 s33, 0
v_mfma_f32_16x16x32_bf16 v[188:191], a[92:95], a[48:51], v[188:191]
ds_read_b64_tr_b16 a[86:87], v12 offset:9216
v_accvgpr_write_b32 a240, v22
v_mfma_f32_16x16x32_bf16 v[188:191], a[88:91], a[32:35], v[188:191]
s_waitcnt lgkmcnt(4)
v_accvgpr_write_b32 a241, v22
v_accvgpr_write_b32 a242, v22
v_mfma_f32_16x16x32_bf16 v[216:219], a[32:35], a[96:99], v[216:219]
buffer_load_dwordx4 v16, s[48:51], s32 offen offset:1024 sc1 lds
v_accvgpr_write_b32 a243, v22
v_mfma_f32_16x16x32_bf16 v[216:219], a[48:51], a[100:103], v[216:219]
ds_read_b64_tr_b16 a[88:89], v13 offset:0
s_mov_b32 s36, 0x33333333
v_mfma_f32_16x16x32_bf16 v[224:227], a[52:55], a[100:103], v[224:227]
ds_read_b64_tr_b16 a[90:91], v13 offset:1024
s_mov_b32 s37, 0xcccccccc
v_mfma_f32_16x16x32_bf16 v[224:227], a[36:39], a[96:99], v[224:227]
ds_read_b64_tr_b16 a[92:93], v13 offset:8192
v_cndmask_b32 v4, 0, v22, s[36:37]
v_mfma_f32_16x16x32_bf16 v[232:235], a[40:43], a[96:99], v[232:235]
ds_read_b64_tr_b16 a[94:95], v13 offset:9216
v_accvgpr_write_b32 a232, v4
v_accvgpr_write_b32 a233, v4
v_mfma_f32_16x16x32_bf16 v[232:235], a[56:59], a[100:103], v[232:235]
v_accvgpr_write_b32 a234, v4
v_accvgpr_write_b32 a235, v4
v_mfma_f32_16x16x32_bf16 v[240:243], a[60:63], a[100:103], v[240:243]
s_mov_b32 s36, 0x44444444
s_mov_b32 s37, 0x44444444
v_cndmask_b32 v4, 0, v22, s[36:37]
v_mfma_f32_16x16x32_bf16 v[240:243], a[44:47], a[96:99], v[240:243]
buffer_load_dwordx4 v16, s[48:51], s32 offen offset:2048 sc1 lds
v_mfma_f32_16x16x32_bf16 v[244:247], a[44:47], a[104:107], v[244:247]
ds_read_b64_tr_b16 a[96:97], v12 offset:256
v_accvgpr_write_b32 a236, v4
v_accvgpr_write_b32 a237, v4
v_mfma_f32_16x16x32_bf16 v[244:247], a[60:63], a[108:111], v[244:247]
ds_read_b64_tr_b16 a[98:99], v12 offset:1280
v_accvgpr_write_b32 a238, v4
v_mfma_f32_16x16x32_bf16 v[236:239], a[56:59], a[108:111], v[236:239]
ds_read_b64_tr_b16 a[100:101], v12 offset:8448
v_accvgpr_write_b32 a239, v4
v_mfma_f32_16x16x32_bf16 v[236:239], a[40:43], a[104:107], v[236:239]
ds_read_b64_tr_b16 a[102:103], v12 offset:9472
v_mov_b32 v1, v3
v_mfma_f32_16x16x32_bf16 v[228:231], a[36:39], a[104:107], v[228:231]
v_add_u32 v2, 98304, v3
v_mfma_f32_16x16x32_bf16 v[228:231], a[52:55], a[108:111], v[228:231]
s_mov_b64 s[34:35], 0
v_accvgpr_write_b32 a224, 0
v_accvgpr_write_b32 a225, 0
v_mfma_f32_16x16x32_bf16 v[220:223], a[48:51], a[108:111], v[220:223]
buffer_load_dwordx4 v16, s[48:51], s32 offen offset:3072 sc1 lds
v_mfma_f32_16x16x32_bf16 v[220:223], a[32:35], a[104:107], v[220:223]
s_waitcnt lgkmcnt(4)
v_accvgpr_write_b32 a226, 0
v_accvgpr_write_b32 a227, 0
L_S22:
v_mfma_f32_16x16x32_bf16 v[24:27], a[80:83], a[0:3], v[24:27]
ds_read_b64_tr_b16 a[104:105], v13 offset:256
s_waitcnt vmcnt(13)
v_accvgpr_write_b32 a228, 0
v_mfma_f32_16x16x32_bf16 v[24:27], a[84:87], a[16:19], v[24:27]
ds_read_b64_tr_b16 a[106:107], v13 offset:1280
v_accvgpr_write_b32 a229, 0
v_mfma_f32_16x16x32_bf16 v[32:35], a[84:87], a[20:23], v[32:35]
ds_read_b64_tr_b16 a[108:109], v13 offset:8448
v_accvgpr_write_b32 a230, 0
v_mfma_f32_16x16x32_bf16 v[32:35], a[80:83], a[4:7], v[32:35]
ds_read_b64_tr_b16 a[110:111], v13 offset:9472
v_accvgpr_write_b32 a231, 0
v_mfma_f32_16x16x32_bf16 v[40:43], a[80:83], a[8:11], v[40:43]
ds_read_b128 a[32:35], v8 offset:32768
s_add_u32 m0, s19, 0x1000
s_mul_i32 s8, s6, 0x142400
v_mfma_f32_16x16x32_bf16 v[40:43], a[84:87], a[24:27], v[40:43]
buffer_load_dwordx4 v16, s[48:51], s7 offen offset:0 sc1 lds
v_mfma_f32_16x16x32_bf16 v[48:51], a[84:87], a[28:31], v[48:51]
ds_read_b128 a[48:51], v9 offset:32768
s_sub_u32 s9, 0x12e1c00, s8
v_mfma_f32_16x16x32_bf16 v[48:51], a[80:83], a[12:15], v[48:51]
ds_read_b128 a[36:39], v8 offset:34816
s_lshl_b32 s11, s5, 13
v_mfma_f32_16x16x32_bf16 v[52:55], a[88:91], a[12:15], v[52:55]
ds_read_b64_tr_b16 a[80:81], v12 offset:512
L_padA11:
s_cmp_eq_u32 s95, 1
s_cbranch_scc1 L_hopA_ret
s_add_u32 s11, s11, 0x2200000
s_add_u32 s8, s8, s11
v_mfma_f32_16x16x32_bf16 v[52:55], a[92:95], a[28:31], v[52:55]
ds_read_b64_tr_b16 a[82:83], v12 offset:1536
s_add_u32 s9, s9, s11
v_mfma_f32_16x16x32_bf16 v[44:47], a[92:95], a[24:27], v[44:47]
ds_read_b64_tr_b16 a[84:85], v12 offset:8704
s_lshl_b32 s11, s4, 10
v_mfma_f32_16x16x32_bf16 v[44:47], a[88:91], a[8:11], v[44:47]
buffer_load_dwordx4 v16, s[48:51], s7 offen offset:1024 sc1 lds
v_mfma_f32_16x16x32_bf16 v[36:39], a[88:91], a[4:7], v[36:39]
ds_read_b64_tr_b16 a[86:87], v12 offset:9728
s_add_u32 s44, s8, s11
s_add_u32 s46, s9, s11
v_mfma_f32_16x16x32_bf16 v[36:39], a[92:95], a[20:23], v[36:39]
ds_read_b128 a[52:55], v9 offset:34816
s_sub_u32 s11, 0x1c00, s11
v_mfma_f32_16x16x32_bf16 v[28:31], a[92:95], a[16:19], v[28:31]
ds_read_b128 a[40:43], v8 offset:36864
s_add_u32 s45, s8, s11
v_mfma_f32_16x16x32_bf16 v[28:31], a[88:91], a[0:3], v[28:31]
ds_read_b128 a[56:59], v9 offset:36864
s_waitcnt lgkmcnt(10)
v_mfma_f32_16x16x32_bf16 v[56:59], a[96:99], a[0:3], v[56:59]
ds_read_b64_tr_b16 a[88:89], v13 offset:512
s_add_u32 s47, s9, s11
s_mul_i32 s8, s5, 0x6000
v_mfma_f32_16x16x32_bf16 v[56:59], a[100:103], a[16:19], v[56:59]
ds_read_b64_tr_b16 a[90:91], v13 offset:1536
s_add_u32 s8, s8, 0x40000
v_mfma_f32_16x16x32_bf16 v[64:67], a[100:103], a[20:23], v[64:67]
buffer_load_dwordx4 v16, s[48:51], s7 offen offset:2048 sc1 lds
v_mfma_f32_16x16x32_bf16 v[64:67], a[96:99], a[4:7], v[64:67]
ds_read_b64_tr_b16 a[92:93], v13 offset:8704
s_add_u32 s28, s44, s8
v_mfma_f32_16x16x32_bf16 v[72:75], a[96:99], a[8:11], v[72:75]
ds_read_b64_tr_b16 a[94:95], v13 offset:9728
s_add_u32 s29, s45, s8
s_add_u32 s30, s46, s8
v_mfma_f32_16x16x32_bf16 v[72:75], a[100:103], a[24:27], v[72:75]
ds_read_b128 a[44:47], v8 offset:38912
s_add_u32 s31, s47, s8
v_mfma_f32_16x16x32_bf16 v[80:83], a[100:103], a[28:31], v[80:83]
ds_read_b128 a[60:63], v9 offset:38912
s_lshl_b32 s8, s4, 11
v_mfma_f32_16x16x32_bf16 v[80:83], a[96:99], a[12:15], v[80:83]
s_add_u32 s9, s8, 131072
v_add_u32 v4, s9, v16
v_mfma_f32_16x16x32_bf16 v[84:87], a[104:107], a[12:15], v[84:87]
ds_read_b64_tr_b16 a[96:97], v12 offset:768
s_sub_u32 s9, 145408, s8
v_mfma_f32_16x16x32_bf16 v[84:87], a[108:111], a[28:31], v[84:87]
buffer_load_dwordx4 v16, s[48:51], s7 offen offset:3072 sc1 lds
v_mfma_f32_16x16x32_bf16 v[76:79], a[108:111], a[24:27], v[76:79]
ds_read_b64_tr_b16 a[98:99], v12 offset:1792
s_add_u32 s32, s32, s94
v_mfma_f32_16x16x32_bf16 v[76:79], a[104:107], a[8:11], v[76:79]
ds_read_b64_tr_b16 a[100:101], v12 offset:8960
s_add_u32 s7, s7, s94
v_mfma_f32_16x16x32_bf16 v[68:71], a[104:107], a[4:7], v[68:71]
ds_read_b64_tr_b16 a[102:103], v12 offset:9984
s_cmp_eq_u32 s4, 0
s_cselect_b32 s8, 131072, s9
v_mfma_f32_16x16x32_bf16 v[68:71], a[108:111], a[20:23], v[68:71]
v_add_u32 v5, s8, v16
v_add_u32 v6, s9, v16
v_mfma_f32_16x16x32_bf16 v[60:63], a[108:111], a[16:19], v[60:63]
v_add_u32 v22, 0x800, v10
v_mfma_f32_16x16x32_bf16 v[60:63], a[104:107], a[0:3], v[60:63]
s_add_u32 m0, s19, 0x18000
s_waitcnt lgkmcnt(6)
s_mov_b32 s8, 0x800
v_mfma_f32_16x16x32_bf16 v[88:91], a[80:83], a[0:3], v[88:91]
buffer_load_dwordx4 v16, s[48:51], s32 offen offset:0 sc1 lds
v_mfma_f32_16x16x32_bf16 v[88:91], a[84:87], a[16:19], v[88:91]
ds_read_b64_tr_b16 a[104:105], v13 offset:768
v_mfma_f32_16x16x32_bf16 v[96:99], a[84:87], a[20:23], v[96:99]
ds_read_b64_tr_b16 a[106:107], v13 offset:1792
v_mfma_f32_16x16x32_bf16 v[96:99], a[80:83], a[4:7], v[96:99]
ds_read_b64_tr_b16 a[108:109], v13 offset:8960
v_mfma_f32_16x16x32_bf16 v[104:107], a[80:83], a[8:11], v[104:107]
ds_read_b64_tr_b16 a[110:111], v13 offset:9984
s_cmp_eq_u32 s6, 0
s_cselect_b32 s8, 0xffff8800, s8
v_mfma_f32_16x16x32_bf16 v[104:107], a[84:87], a[24:27], v[104:107]
v_add_u32 v7, s8, v11
v_mfma_f32_16x16x32_bf16 v[112:115], a[84:87], a[28:31], v[112:115]
buffer_load_dwordx4 v16, s[48:51], s32 offen offset:1024 sc1 lds
v_mfma_f32_16x16x32_bf16 v[112:115], a[80:83], a[12:15], v[112:115]
s_and_b32 s18, s2, 4
s_lshr_b32 s8, s2, 6
s_add_u32 s18, s18, s8
v_mfma_f32_16x16x32_bf16 v[116:119], a[88:91], a[12:15], v[116:119]
ds_read_b64_tr_b16 a[80:81], v14 offset:0
s_sub_u32 s8, 15, s18
v_mfma_f32_16x16x32_bf16 v[116:119], a[92:95], a[28:31], v[116:119]
ds_read_b64_tr_b16 a[82:83], v14 offset:256
v_mfma_f32_16x16x32_bf16 v[108:111], a[92:95], a[24:27], v[108:111]
ds_read_b64_tr_b16 a[84:85], v14 offset:2048
v_mfma_f32_16x16x32_bf16 v[108:111], a[88:91], a[8:11], v[108:111]
ds_read_b64_tr_b16 a[86:87], v14 offset:2304
v_mfma_f32_16x16x32_bf16 v[100:103], a[88:91], a[4:7], v[100:103]
buffer_load_dwordx4 v16, s[48:51], s32 offen offset:2048 sc1 lds
v_mfma_f32_16x16x32_bf16 v[100:103], a[92:95], a[20:23], v[100:103]
s_cmp_lt_u32 s4, 2
s_cselect_b32 s99, s18, s8
s_lshl_b32 s16, s2, 2
v_mfma_f32_16x16x32_bf16 v[92:95], a[92:95], a[16:19], v[92:95]
s_add_u32 s16, s16, s4
s_lshl_b32 s16, s16, 12
s_add_u32 s16, s16, 0x4800000
v_mfma_f32_16x16x32_bf16 v[92:95], a[88:91], a[0:3], v[92:95]
s_waitcnt lgkmcnt(4)
s_bfe_u32 s100, s2, 0x30003
s_and_b32 s14, s2, 3
v_mfma_f32_16x16x32_bf16 v[120:123], a[96:99], a[0:3], v[120:123]
ds_read_b64_tr_b16 a[88:89], v15 offset:0
s_lshl_b32 s24, s18, 2
s_add_u32 s24, s24, s14
v_mfma_f32_16x16x32_bf16 v[120:123], a[100:103], a[16:19], v[120:123]
ds_read_b64_tr_b16 a[90:91], v15 offset:256
s_lshl_b32 s24, s24, 8
v_mfma_f32_16x16x32_bf16 v[128:131], a[100:103], a[20:23], v[128:131]
buffer_load_dwordx4 v16, s[48:51], s32 offen offset:3072 sc1 lds
v_mfma_f32_16x16x32_bf16 v[128:131], a[96:99], a[4:7], v[128:131]
ds_read_b64_tr_b16 a[92:93], v15 offset:2048
s_add_u32 s24, s24, 0x3704000
v_mfma_f32_16x16x32_bf16 v[136:139], a[96:99], a[8:11], v[136:139]
ds_read_b64_tr_b16 a[94:95], v15 offset:2304
s_mov_b32 s12, 14336
s_lshl_b32 s13, s4, 15
v_mfma_f32_16x16x32_bf16 v[136:139], a[100:103], a[24:27], v[136:139]
s_lshl_b32 s9, s100, 8
s_add_u32 s13, s13, s9
s_mul_i32 s9, s14, 0x80040
v_mfma_f32_16x16x32_bf16 v[144:147], a[100:103], a[28:31], v[144:147]
s_add_u32 s13, s13, s9
s_and_b32 s9, s2, 1
s_lshl_b32 s9, s9, 17
v_mfma_f32_16x16x32_bf16 v[144:147], a[96:99], a[12:15], v[144:147]
s_add_u32 m0, s19, 0x19000
s_add_u32 s13, s13, s9
s_mul_i32 s25, s14, 0x180000
v_mfma_f32_16x16x32_bf16 v[148:151], a[104:107], a[12:15], v[148:151]
buffer_load_dwordx4 v16, s[48:51], s7 offen offset:0 sc1 lds
s_add_u32 s25, s25, s9
v_mfma_f32_16x16x32_bf16 v[148:151], a[108:111], a[28:31], v[148:151]
ds_read_b64_tr_b16 a[96:97], v14 offset:4096
s_sub_u32 s25, s25, 524288
v_mfma_f32_16x16x32_bf16 v[140:143], a[108:111], a[24:27], v[140:143]
ds_read_b64_tr_b16 a[98:99], v14 offset:4352
s_lshr_b32 s9, s9, 3
v_mfma_f32_16x16x32_bf16 v[140:143], a[104:107], a[8:11], v[140:143]
ds_read_b64_tr_b16 a[100:101], v14 offset:6144
s_mul_i32 s101, s99, 0x142400
v_mfma_f32_16x16x32_bf16 v[132:135], a[104:107], a[4:7], v[132:135]
ds_read_b64_tr_b16 a[102:103], v14 offset:6400
s_and_b32 s8, s4, 1
s_lshl_b32 s8, s8, 12
v_mfma_f32_16x16x32_bf16 v[132:135], a[108:111], a[20:23], v[132:135]
s_add_u32 s101, s101, s8
s_lshl_b32 s8, s14, 16
s_add_u32 s101, s101, s8
v_mfma_f32_16x16x32_bf16 v[124:127], a[108:111], a[16:19], v[124:127]
s_waitcnt lgkmcnt(4)
s_add_u32 s101, s101, s9
s_add_u32 s101, s101, 0x21fe000
v_mfma_f32_16x16x32_bf16 v[124:127], a[104:107], a[0:3], v[124:127]
buffer_load_dwordx4 v16, s[48:51], s7 offen offset:1024 sc1 lds
v_mfma_f32_16x16x32_bf16 v[152:155], a[80:83], a[0:3], v[152:155]
ds_read_b64_tr_b16 a[104:105], v15 offset:4096
s_mul_i32 s26, s14, 196608
s_add_u32 s26, s26, s9
v_mfma_f32_16x16x32_bf16 v[152:155], a[84:87], a[16:19], v[152:155]
ds_read_b64_tr_b16 a[106:107], v15 offset:4352
s_add_u32 s26, s26, 188416
v_mfma_f32_16x16x32_bf16 v[160:163], a[84:87], a[20:23], v[160:163]
ds_read_b64_tr_b16 a[108:109], v15 offset:6144
s_mov_b32 s52, 0x3e0293ee
v_mfma_f32_16x16x32_bf16 v[160:163], a[80:83], a[4:7], v[160:163]
ds_read_b64_tr_b16 a[110:111], v15 offset:6400
s_mov_b32 s53, 0x3e0293ee
v_mfma_f32_16x16x32_bf16 v[168:171], a[80:83], a[8:11], v[168:171]
s_mov_b32 s54, 0x3e8293ee
s_or_b32 s55, s6, s4
s_cselect_b32 s55, 0, 0xf149f2ca
s_mov_b32 s56, 0x50000
v_mfma_f32_16x16x32_bf16 v[168:171], a[84:87], a[24:27], v[168:171]
buffer_load_dwordx4 v16, s[48:51], s7 offen offset:2048 sc1 lds
v_mfma_f32_16x16x32_bf16 v[176:179], a[84:87], a[28:31], v[176:179]
s_mov_b32 s57, 0x5550055
s_mov_b32 s58, 0xa0000
s_mov_b32 s59, 0xaaa00aa
v_mfma_f32_16x16x32_bf16 v[176:179], a[80:83], a[12:15], v[176:179]
s_mov_b32 s60, 0x150001
s_mov_b32 s61, 0x15550155
s_mov_b32 s62, 0x2a0002
v_mfma_f32_16x16x32_bf16 v[180:183], a[88:91], a[12:15], v[180:183]
ds_read_b64_tr_b16 a[80:81], v14 offset:8192
s_mov_b32 s63, 0x2aaa02aa
s_mov_b32 s68, 0x55505555
v_mfma_f32_16x16x32_bf16 v[180:183], a[92:95], a[28:31], v[180:183]
ds_read_b64_tr_b16 a[82:83], v14 offset:8448
s_mov_b32 s69, 0x50005500
v_mfma_f32_16x16x32_bf16 v[172:175], a[92:95], a[24:27], v[172:175]
ds_read_b64_tr_b16 a[84:85], v14 offset:10240
s_mov_b32 s70, 0xaaa0aaaa
v_mfma_f32_16x16x32_bf16 v[172:175], a[88:91], a[8:11], v[172:175]
buffer_load_dwordx4 v16, s[48:51], s7 offen offset:3072 sc1 lds
v_mfma_f32_16x16x32_bf16 v[164:167], a[88:91], a[4:7], v[164:167]
ds_read_b64_tr_b16 a[86:87], v14 offset:10496
s_add_u32 s32, s32, 0x8000
s_mov_b32 s71, 0xa000aa00
v_mfma_f32_16x16x32_bf16 v[164:167], a[92:95], a[20:23], v[164:167]
s_add_u32 s7, s7, 0x8000
s_mov_b32 s76, 0x55405554
s_mov_b32 s77, 0x40005400
v_mfma_f32_16x16x32_bf16 v[156:159], a[92:95], a[16:19], v[156:159]
s_mov_b32 s78, 0xaa80aaa8
s_mov_b32 s79, 0x8000a800
s_mov_b32 s8, 0xf149f2ca
v_mfma_f32_16x16x32_bf16 v[156:159], a[88:91], a[0:3], v[156:159]
s_waitcnt lgkmcnt(4)
s_mov_b32 s36, 0xfff0ffff
v_mov_b32 v21, s1
v_mfma_f32_16x16x32_bf16 v[184:187], a[96:99], a[0:3], v[184:187]
ds_read_b64_tr_b16 a[88:89], v15 offset:8192
s_mov_b32 s37, 0xf000ff00
v_add_u32 v20, s0, v16
v_mfma_f32_16x16x32_bf16 v[184:187], a[100:103], a[16:19], v[184:187]
global_load_dword a120, v[20:21], off sc1
v_mfma_f32_16x16x32_bf16 v[192:195], a[100:103], a[20:23], v[192:195]
ds_read_b64_tr_b16 a[90:91], v15 offset:8448
s_mov_b32 s38, 0xffe0fffe
v_mfma_f32_16x16x32_bf16 v[192:195], a[96:99], a[4:7], v[192:195]
ds_read_b64_tr_b16 a[92:93], v15 offset:10240
s_mov_b32 s39, 0xe000fe00
v_mfma_f32_16x16x32_bf16 v[200:203], a[96:99], a[8:11], v[200:203]
ds_read_b64_tr_b16 a[94:95], v15 offset:10496
s_mov_b32 s40, 0xffc0fffc
v_add_u32 v12, 0x8000, v12
v_mfma_f32_16x16x32_bf16 v[200:203], a[100:103], a[24:27], v[200:203]
s_mov_b32 s41, 0xc000fc00
v_add_u32 v13, 0x8000, v13
v_add_u32 v14, 0x8000, v14
v_mfma_f32_16x16x32_bf16 v[208:211], a[100:103], a[28:31], v[208:211]
s_mov_b32 s42, 0xff80fff8
s_mov_b32 s43, 0x8000f800
v_add_u32 v15, 0x8000, v15
v_mfma_f32_16x16x32_bf16 v[208:211], a[96:99], a[12:15], v[208:211]
s_bitcmp1_b32 s4, 0
s_cselect_b32 s10, 0x7f800000, s8
s_cselect_b32 s11, s8, 0x7f800000
v_mfma_f32_16x16x32_bf16 v[212:215], a[104:107], a[12:15], v[212:215]
s_waitcnt vmcnt(19) lgkmcnt(0)
v_mfma_f32_16x16x32_bf16 v[212:215], a[108:111], a[28:31], v[212:215]
s_barrier
s_add_u32 m0, s19, 0x8000
v_mfma_f32_16x16x32_bf16 v[204:207], a[108:111], a[24:27], v[204:207]
buffer_load_dwordx4 v16, s[48:51], s32 offen offset:0 sc1 lds
v_mfma_f32_16x16x32_bf16 v[204:207], a[104:107], a[8:11], v[204:207]
ds_read_b64_tr_b16 a[96:97], v14 offset:4096
v_mfma_f32_16x16x32_bf16 v[196:199], a[104:107], a[4:7], v[196:199]
ds_read_b64_tr_b16 a[98:99], v14 offset:4352
v_mfma_f32_16x16x32_bf16 v[196:199], a[108:111], a[20:23], v[196:199]
ds_read_b64_tr_b16 a[100:101], v14 offset:6144
v_mfma_f32_16x16x32_bf16 v[188:191], a[108:111], a[16:19], v[188:191]
ds_read_b64_tr_b16 a[102:103], v14 offset:6400
v_mfma_f32_16x16x32_bf16 v[188:191], a[104:107], a[0:3], v[188:191]
s_waitcnt lgkmcnt(4)
v_mfma_f32_16x16x32_bf16 v[216:219], a[0:3], a[80:83], v[216:219]
buffer_load_dwordx4 v16, s[48:51], s32 offen offset:1024 sc1 lds
v_mfma_f32_16x16x32_bf16 v[216:219], a[16:19], a[84:87], v[216:219]
ds_read_b64_tr_b16 a[104:105], v15 offset:4096
v_mfma_f32_16x16x32_bf16 v[224:227], a[20:23], a[84:87], v[224:227]
ds_read_b64_tr_b16 a[106:107], v15 offset:4352
v_mfma_f32_16x16x32_bf16 v[224:227], a[4:7], a[80:83], v[224:227]
ds_read_b64_tr_b16 a[108:109], v15 offset:6144
v_mfma_f32_16x16x32_bf16 v[232:235], a[8:11], a[80:83], v[232:235]
ds_read_b64_tr_b16 a[110:111], v15 offset:6400
v_mfma_f32_16x16x32_bf16 v[232:235], a[24:27], a[84:87], v[232:235]
v_mfma_f32_16x16x32_bf16 v[240:243], a[28:31], a[84:87], v[240:243]
v_mfma_f32_16x16x32_bf16 v[240:243], a[12:15], a[80:83], v[240:243]
buffer_load_dwordx4 v16, s[48:51], s32 offen offset:2048 sc1 lds
v_mfma_f32_16x16x32_bf16 v[244:247], a[12:15], a[88:91], v[244:247]
ds_read_b64_tr_b16 a[80:81], v14 offset:8192
v_mfma_f32_16x16x32_bf16 v[244:247], a[28:31], a[92:95], v[244:247]
ds_read_b64_tr_b16 a[82:83], v14 offset:8448
v_mfma_f32_16x16x32_bf16 v[236:239], a[24:27], a[92:95], v[236:239]
ds_read_b64_tr_b16 a[84:85], v14 offset:10240
v_mfma_f32_16x16x32_bf16 v[236:239], a[8:11], a[88:91], v[236:239]
ds_read_b64_tr_b16 a[86:87], v14 offset:10496
v_mfma_f32_16x16x32_bf16 v[228:231], a[4:7], a[88:91], v[228:231]
v_mfma_f32_16x16x32_bf16 v[228:231], a[20:23], a[92:95], v[228:231]
v_mfma_f32_16x16x32_bf16 v[220:223], a[16:19], a[92:95], v[220:223]
buffer_load_dwordx4 v16, s[48:51], s32 offen offset:3072 sc1 lds
v_mfma_f32_16x16x32_bf16 v[220:223], a[0:3], a[88:91], v[220:223]
s_waitcnt lgkmcnt(4)
L_S23:
v_mfma_f32_16x16x32_bf16 v[184:187], a[96:99], a[32:35], v[184:187]
ds_read_b64_tr_b16 a[88:89], v15 offset:8192
v_mov_b32 v8, v19
v_mov_b32 v9, 0xf149f2ca
v_mfma_f32_16x16x32_bf16 v[184:187], a[100:103], a[48:51], v[184:187]
ds_read_b64_tr_b16 a[90:91], v15 offset:8448
v_mov_b32 v248, 0xffff
v_mfma_f32_16x16x32_bf16 v[192:195], a[100:103], a[52:55], v[192:195]
ds_read_b64_tr_b16 a[92:93], v15 offset:10240
v_mov_b32 v249, 0xffff0000
v_mfma_f32_16x16x32_bf16 v[192:195], a[96:99], a[36:39], v[192:195]
ds_read_b64_tr_b16 a[94:95], v15 offset:10496
v_cndmask_b32 v252, 0, v248, s[56:57]
v_mfma_f32_16x16x32_bf16 v[200:203], a[96:99], a[40:43], v[200:203]
s_add_u32 m0, s19, 0x9000
v_cndmask_b32 v252, v252, v249, s[58:59]
v_cndmask_b32 v253, 0, v248, s[60:61]
v_cndmask_b32 v253, v253, v249, s[62:63]
v_mfma_f32_16x16x32_bf16 v[200:203], a[100:103], a[56:59], v[200:203]
buffer_load_dwordx4 v16, s[48:51], s7 offen offset:0 sc1 lds
v_mfma_f32_16x16x32_bf16 v[208:211], a[100:103], a[60:63], v[208:211]
v_cndmask_b32 v254, 0, v248, s[68:69]
v_cndmask_b32 v254, v254, v249, s[70:71]
v_mfma_f32_16x16x32_bf16 v[208:211], a[96:99], a[44:47], v[208:211]
v_cndmask_b32 v255, 0, v248, s[76:77]
v_cndmask_b32 v255, v255, v249, s[78:79]
v_mfma_f32_16x16x32_bf16 v[212:215], a[104:107], a[44:47], v[212:215]
ds_read_b64_tr_b16 a[96:97], v14 offset:0
v_cndmask_b32 v248, v9, 0, s[68:69]
v_cndmask_b32 v249, v9, 0, s[70:71]
v_mfma_f32_16x16x32_bf16 v[212:215], a[108:111], a[60:63], v[212:215]
ds_read_b64_tr_b16 a[98:99], v14 offset:256
v_cndmask_b32 v250, v9, 0, s[76:77]
v_mfma_f32_16x16x32_bf16 v[204:207], a[108:111], a[56:59], v[204:207]
ds_read_b64_tr_b16 a[100:101], v14 offset:2048
v_cndmask_b32 v251, v9, 0, s[78:79]
v_mfma_f32_16x16x32_bf16 v[204:207], a[104:107], a[40:43], v[204:207]
buffer_load_dwordx4 v16, s[48:51], s7 offen offset:1024 sc1 lds
v_mfma_f32_16x16x32_bf16 v[196:199], a[104:107], a[36:39], v[196:199]
ds_read_b64_tr_b16 a[102:103], v14 offset:2304
v_mfma_f32_16x16x32_bf16 v[196:199], a[108:111], a[52:55], v[196:199]
v_mfma_f32_16x16x32_bf16 v[188:191], a[108:111], a[48:51], v[188:191]
v_mfma_f32_16x16x32_bf16 v[188:191], a[104:107], a[32:35], v[188:191]
s_waitcnt lgkmcnt(4)
v_mfma_f32_16x16x32_bf16 v[216:219], a[32:35], a[80:83], v[216:219]
ds_read_b64_tr_b16 a[104:105], v15 offset:0
v_mfma_f32_16x16x32_bf16 v[216:219], a[48:51], a[84:87], v[216:219]
ds_read_b64_tr_b16 a[106:107], v15 offset:256
v_mfma_f32_16x16x32_bf16 v[224:227], a[52:55], a[84:87], v[224:227]
buffer_load_dwordx4 v16, s[48:51], s7 offen offset:2048 sc1 lds
v_mfma_f32_16x16x32_bf16 v[224:227], a[36:39], a[80:83], v[224:227]
ds_read_b64_tr_b16 a[108:109], v15 offset:2048
v_cvt_pk_bf16_f32 v192, v192, v193
v_mfma_f32_16x16x32_bf16 v[232:235], a[40:43], a[80:83], v[232:235]
ds_read_b64_tr_b16 a[110:111], v15 offset:2304
v_cvt_pk_bf16_f32 v193, v194, v195
v_cvt_pk_bf16_f32 v194, v196, v197
v_mfma_f32_16x16x32_bf16 v[232:235], a[56:59], a[84:87], v[232:235]
v_cvt_pk_bf16_f32 v195, v198, v199
v_cvt_pk_bf16_f32 v208, v208, v209
v_mfma_f32_16x16x32_bf16 v[240:243], a[60:63], a[84:87], v[240:243]
v_cvt_pk_bf16_f32 v209, v210, v211
v_cvt_pk_bf16_f32 v210, v212, v213
v_mfma_f32_16x16x32_bf16 v[240:243], a[44:47], a[80:83], v[240:243]
v_cvt_pk_bf16_f32 v211, v214, v215
v_mfma_f32_16x16x32_bf16 v[244:247], a[44:47], a[88:91], v[244:247]
ds_read_b64_tr_b16 a[80:81], v12 offset:0
v_mfma_f32_16x16x32_bf16 v[244:247], a[60:63], a[92:95], v[244:247]
buffer_load_dwordx4 v16, s[48:51], s7 offen offset:3072 sc1 lds
v_mfma_f32_16x16x32_bf16 v[236:239], a[56:59], a[92:95], v[236:239]
ds_read_b64_tr_b16 a[82:83], v12 offset:1024
s_add_u32 s32, s32, 0x8000
v_mfma_f32_16x16x32_bf16 v[236:239], a[40:43], a[88:91], v[236:239]
ds_read_b64_tr_b16 a[84:85], v12 offset:8192
s_add_u32 s7, s7, 0x8000
v_mfma_f32_16x16x32_bf16 v[228:231], a[36:39], a[88:91], v[228:231]
ds_read_b64_tr_b16 a[86:87], v12 offset:9216
v_mfma_f32_16x16x32_bf16 v[228:231], a[52:55], a[92:95], v[228:231]
s_cmp_lg_u32 s4, 0
s_cbranch_scc1 L_hx0
buffer_store_dwordx4 v[192:195], v22, s[88:91], 0 offen offset:0 sc1
buffer_store_dwordx4 v[208:211], v7, s[88:91], 0 offen offset:0 sc1
L_hx0:
v_mfma_f32_16x16x32_bf16 v[220:223], a[48:51], a[92:95], v[220:223]
v_cvt_pk_bf16_f32 v184, v184, v185
v_cvt_pk_bf16_f32 v185, v186, v187
v_mfma_f32_16x16x32_bf16 v[220:223], a[32:35], a[88:91], v[220:223]
s_waitcnt lgkmcnt(4)
v_cvt_pk_bf16_f32 v186, v188, v189
v_cvt_pk_bf16_f32 v187, v190, v191
v_mfma_f32_16x16x32_bf16 v[152:155], a[96:99], a[32:35], v[152:155]
ds_read_b64_tr_b16 a[88:89], v13 offset:0
v_cvt_pk_bf16_f32 v200, v200, v201
v_cvt_pk_bf16_f32 v201, v202, v203
v_mfma_f32_16x16x32_bf16 v[152:155], a[100:103], a[48:51], v[152:155]
ds_read_b64_tr_b16 a[90:91], v13 offset:1024
v_cvt_pk_bf16_f32 v202, v204, v205
v_mfma_f32_16x16x32_bf16 v[160:163], a[100:103], a[52:55], v[160:163]
ds_read_b64_tr_b16 a[92:93], v13 offset:8192
v_cvt_pk_bf16_f32 v203, v206, v207
v_mfma_f32_16x16x32_bf16 v[160:163], a[96:99], a[36:39], v[160:163]
ds_read_b64_tr_b16 a[94:95], v13 offset:9216
v_mfma_f32_16x16x32_bf16 v[168:171], a[96:99], a[40:43], v[168:171]
ds_write_b128 v5, v[192:195] offset:2048
v_mfma_f32_16x16x32_bf16 v[168:171], a[100:103], a[56:59], v[168:171]
ds_write_b128 v5, v[208:211] offset:18432
v_mfma_f32_16x16x32_bf16 v[176:179], a[100:103], a[60:63], v[176:179]
ds_write_b128 v4, v[184:187] offset:2048
v_mfma_f32_16x16x32_bf16 v[176:179], a[96:99], a[44:47], v[176:179]
ds_write_b128 v4, v[200:203] offset:18432
v_mfma_f32_16x16x32_bf16 v[180:183], a[104:107], a[44:47], v[180:183]
ds_read_b64_tr_b16 a[96:97], v12 offset:256
v_cvt_pk_bf16_f32 v231, v230, v231
v_cvt_pk_bf16_f32 v230, v228, v229
v_mfma_f32_16x16x32_bf16 v[180:183], a[108:111], a[60:63], v[180:183]
ds_read_b64_tr_b16 a[98:99], v12 offset:1280
v_cvt_pk_bf16_f32 v228, v224, v225
v_mfma_f32_16x16x32_bf16 v[172:175], a[108:111], a[56:59], v[172:175]
ds_read_b64_tr_b16 a[100:101], v12 offset:8448
v_cvt_pk_bf16_f32 v229, v226, v227
v_mfma_f32_16x16x32_bf16 v[172:175], a[104:107], a[40:43], v[172:175]
ds_read_b64_tr_b16 a[102:103], v12 offset:9472
v_cvt_pk_bf16_f32 v227, v226, v227
v_mfma_f32_16x16x32_bf16 v[164:167], a[104:107], a[36:39], v[164:167]
v_cvt_pk_bf16_f32 v226, v224, v225
v_cvt_pk_bf16_f32 v247, v246, v247
v_cvt_pk_bf16_f32 v246, v244, v245
v_mfma_f32_16x16x32_bf16 v[164:167], a[108:111], a[52:55], v[164:167]
v_cvt_pk_bf16_f32 v244, v240, v241
v_cvt_pk_bf16_f32 v245, v242, v243
v_mfma_f32_16x16x32_bf16 v[156:159], a[108:111], a[48:51], v[156:159]
v_cvt_pk_bf16_f32 v243, v242, v243
v_cvt_pk_bf16_f32 v242, v240, v241
v_mfma_f32_16x16x32_bf16 v[156:159], a[104:107], a[32:35], v[156:159]
s_waitcnt lgkmcnt(4)
v_mfma_f32_16x16x32_bf16 v[24:27], a[80:83], a[32:35], v[24:27]
ds_read_b64_tr_b16 a[104:105], v13 offset:256
v_mfma_f32_16x16x32_bf16 v[24:27], a[84:87], a[48:51], v[24:27]
ds_read_b64_tr_b16 a[106:107], v13 offset:1280
v_mfma_f32_16x16x32_bf16 v[32:35], a[84:87], a[52:55], v[32:35]
ds_read_b64_tr_b16 a[108:109], v13 offset:8448
v_mfma_f32_16x16x32_bf16 v[32:35], a[80:83], a[36:39], v[32:35]
ds_read_b64_tr_b16 a[110:111], v13 offset:9472
v_mfma_f32_16x16x32_bf16 v[40:43], a[80:83], a[40:43], v[40:43]
s_cmp_lg_u32 s4, 0
s_cbranch_scc1 L_hx1
buffer_store_dwordx4 v[228:231], v22, s[88:91], 0 offen offset:1024 sc1
buffer_store_dwordx4 v[244:247], v7, s[88:91], 0 offen offset:1024 sc1
L_hx1:
v_mfma_f32_16x16x32_bf16 v[40:43], a[84:87], a[56:59], v[40:43]
v_cvt_pk_bf16_f32 v223, v222, v223
v_cvt_pk_bf16_f32 v222, v220, v221
v_mfma_f32_16x16x32_bf16 v[48:51], a[84:87], a[60:63], v[48:51]
v_cvt_pk_bf16_f32 v220, v216, v217
v_cvt_pk_bf16_f32 v221, v218, v219
v_mfma_f32_16x16x32_bf16 v[48:51], a[80:83], a[44:47], v[48:51]
v_cvt_pk_bf16_f32 v219, v218, v219
v_cvt_pk_bf16_f32 v218, v216, v217
v_mfma_f32_16x16x32_bf16 v[52:55], a[88:91], a[44:47], v[52:55]
ds_read_b64_tr_b16 a[80:81], v12 offset:512
v_cvt_pk_bf16_f32 v239, v238, v239
v_cvt_pk_bf16_f32 v238, v236, v237
v_mfma_f32_16x16x32_bf16 v[52:55], a[92:95], a[60:63], v[52:55]
ds_read_b64_tr_b16 a[82:83], v12 offset:1536
v_cvt_pk_bf16_f32 v236, v232, v233
v_mfma_f32_16x16x32_bf16 v[44:47], a[92:95], a[56:59], v[44:47]
ds_read_b64_tr_b16 a[84:85], v12 offset:8704
v_cvt_pk_bf16_f32 v237, v234, v235
v_mfma_f32_16x16x32_bf16 v[44:47], a[88:91], a[40:43], v[44:47]
ds_read_b64_tr_b16 a[86:87], v12 offset:9728
v_cvt_pk_bf16_f32 v235, v234, v235
v_mfma_f32_16x16x32_bf16 v[36:39], a[88:91], a[36:39], v[36:39]
v_cvt_pk_bf16_f32 v234, v232, v233
v_mfma_f32_16x16x32_bf16 v[36:39], a[92:95], a[52:55], v[36:39]
ds_write_b128 v5, v[228:231] offset:3072
v_mfma_f32_16x16x32_bf16 v[28:31], a[92:95], a[48:51], v[28:31]
ds_write_b128 v5, v[244:247] offset:19456
v_mfma_f32_16x16x32_bf16 v[28:31], a[88:91], a[32:35], v[28:31]
s_waitcnt lgkmcnt(4)
v_mfma_f32_16x16x32_bf16 v[56:59], a[96:99], a[32:35], v[56:59]
ds_read_b64_tr_b16 a[88:89], v13 offset:512
v_mfma_f32_16x16x32_bf16 v[56:59], a[100:103], a[48:51], v[56:59]
ds_read_b64_tr_b16 a[90:91], v13 offset:1536
v_mfma_f32_16x16x32_bf16 v[64:67], a[100:103], a[52:55], v[64:67]
ds_read_b64_tr_b16 a[92:93], v13 offset:8704
v_mfma_f32_16x16x32_bf16 v[64:67], a[96:99], a[36:39], v[64:67]
ds_read_b64_tr_b16 a[94:95], v13 offset:9728
v_mfma_f32_16x16x32_bf16 v[72:75], a[96:99], a[40:43], v[72:75]
ds_write_b128 v4, v[220:223] offset:3072
v_mfma_f32_16x16x32_bf16 v[72:75], a[100:103], a[56:59], v[72:75]
ds_write_b128 v4, v[236:239] offset:19456
v_mfma_f32_16x16x32_bf16 v[80:83], a[100:103], a[60:63], v[80:83]
v_cvt_pk_bf16_f32 v152, v152, v153
v_cvt_pk_bf16_f32 v153, v154, v155
v_mfma_f32_16x16x32_bf16 v[80:83], a[96:99], a[44:47], v[80:83]
v_cvt_pk_bf16_f32 v154, v156, v157
v_cvt_pk_bf16_f32 v155, v158, v159
v_mfma_f32_16x16x32_bf16 v[84:87], a[104:107], a[44:47], v[84:87]
ds_read_b64_tr_b16 a[96:97], v12 offset:768
v_cvt_pk_bf16_f32 v160, v160, v161
v_cvt_pk_bf16_f32 v161, v162, v163
v_mfma_f32_16x16x32_bf16 v[84:87], a[108:111], a[60:63], v[84:87]
ds_read_b64_tr_b16 a[98:99], v12 offset:1792
v_cvt_pk_bf16_f32 v162, v164, v165
v_mfma_f32_16x16x32_bf16 v[76:79], a[108:111], a[56:59], v[76:79]
ds_read_b64_tr_b16 a[100:101], v12 offset:8960
v_cvt_pk_bf16_f32 v163, v166, v167
v_mfma_f32_16x16x32_bf16 v[76:79], a[104:107], a[40:43], v[76:79]
ds_read_b64_tr_b16 a[102:103], v12 offset:9984
v_cvt_pk_bf16_f32 v168, v168, v169
v_mfma_f32_16x16x32_bf16 v[68:71], a[104:107], a[36:39], v[68:71]
v_cvt_pk_bf16_f32 v169, v170, v171
v_cvt_pk_bf16_f32 v170, v172, v173
v_cvt_pk_bf16_f32 v171, v174, v175
v_mfma_f32_16x16x32_bf16 v[68:71], a[108:111], a[52:55], v[68:71]
v_cvt_pk_bf16_f32 v176, v176, v177
v_cvt_pk_bf16_f32 v177, v178, v179
v_mfma_f32_16x16x32_bf16 v[60:63], a[108:111], a[48:51], v[60:63]
v_cvt_pk_bf16_f32 v178, v180, v181
v_cvt_pk_bf16_f32 v179, v182, v183
v_mfma_f32_16x16x32_bf16 v[60:63], a[104:107], a[32:35], v[60:63]
s_waitcnt lgkmcnt(4)
v_mfma_f32_16x16x32_bf16 v[88:91], a[80:83], a[32:35], v[88:91]
ds_read_b64_tr_b16 a[104:105], v13 offset:768
v_mfma_f32_16x16x32_bf16 v[88:91], a[84:87], a[48:51], v[88:91]
ds_read_b64_tr_b16 a[106:107], v13 offset:1792
v_mfma_f32_16x16x32_bf16 v[96:99], a[84:87], a[52:55], v[96:99]
ds_read_b64_tr_b16 a[108:109], v13 offset:8960
v_mfma_f32_16x16x32_bf16 v[96:99], a[80:83], a[36:39], v[96:99]
ds_read_b64_tr_b16 a[110:111], v13 offset:9984
v_mfma_f32_16x16x32_bf16 v[104:107], a[80:83], a[40:43], v[104:107]
v_mfma_f32_16x16x32_bf16 v[104:107], a[84:87], a[56:59], v[104:107]
v_mfma_f32_16x16x32_bf16 v[112:115], a[84:87], a[60:63], v[112:115]
v_mfma_f32_16x16x32_bf16 v[112:115], a[80:83], a[44:47], v[112:115]
v_mfma_f32_16x16x32_bf16 v[116:119], a[88:91], a[44:47], v[116:119]
v_mfma_f32_16x16x32_bf16 v[116:119], a[92:95], a[60:63], v[116:119]
v_mfma_f32_16x16x32_bf16 v[108:111], a[92:95], a[56:59], v[108:111]
v_mfma_f32_16x16x32_bf16 v[108:111], a[88:91], a[40:43], v[108:111]
v_mov_b32 v15, s6
v_xor_b32 v15, 0, v15
v_mfma_f32_16x16x32_bf16 v[100:103], a[88:91], a[36:39], v[100:103]
v_writelane_b32 v15, s18, 0
v_lshlrev_b32 v15, 2, v15
v_bfe_u32 v12, v0, 2, 2
v_mfma_f32_16x16x32_bf16 v[100:103], a[92:95], a[52:55], v[100:103]
v_lshlrev_b32 v12, 11, v12
v_lshrrev_b32 v13, 4, v0
v_mfma_f32_16x16x32_bf16 v[92:95], a[92:95], a[48:51], v[92:95]
v_lshl_add_u32 v12, v13, 6, v12
v_and_b32 v13, 3, v0
v_mfma_f32_16x16x32_bf16 v[92:95], a[88:91], a[32:35], v[92:95]
s_waitcnt lgkmcnt(0)
v_lshl_add_u32 v12, v13, 4, v12
v_xor_b32 v12, s13, v12
v_mfma_f32_16x16x32_bf16 v[120:123], a[96:99], a[32:35], v[120:123]
L_padA12:
s_cmp_eq_u32 s95, 1
s_cbranch_scc1 L_hopA_ret
v_xor_b32 v13, 32, v12
v_add_u32 v13, 7168, v13
v_mul_f32 v24, s52, v24
v_mfma_f32_16x16x32_bf16 v[120:123], a[100:103], a[48:51], v[120:123]
v_mul_f32 v25, s52, v25
v_mul_f32 v26, s52, v26
v_mfma_f32_16x16x32_bf16 v[128:131], a[100:103], a[52:55], v[128:131]
v_mul_f32 v27, s52, v27
v_mul_f32 v28, s52, v28
v_mfma_f32_16x16x32_bf16 v[128:131], a[96:99], a[36:39], v[128:131]
v_mul_f32 v29, s52, v29
v_mul_f32 v30, s52, v30
v_mfma_f32_16x16x32_bf16 v[136:139], a[96:99], a[40:43], v[136:139]
v_mul_f32 v31, s52, v31
v_cvt_pk_bf16_f32 v24, v24, v25
v_cvt_pk_bf16_f32 v25, v26, v27
v_mfma_f32_16x16x32_bf16 v[136:139], a[100:103], a[56:59], v[136:139]
v_cvt_pk_bf16_f32 v26, v28, v29
v_cvt_pk_bf16_f32 v27, v30, v31
v_mfma_f32_16x16x32_bf16 v[144:147], a[100:103], a[60:63], v[144:147]
v_accvgpr_write_b32 a160, v24
v_accvgpr_write_b32 a161, v25
v_mfma_f32_16x16x32_bf16 v[144:147], a[96:99], a[44:47], v[144:147]
v_accvgpr_write_b32 a162, v26
v_accvgpr_write_b32 a163, v27
v_mfma_f32_16x16x32_bf16 v[148:151], a[104:107], a[44:47], v[148:151]
v_mul_f32 v32, s52, v32
v_mul_f32 v33, s52, v33
v_mul_f32 v34, s52, v34
v_mfma_f32_16x16x32_bf16 v[148:151], a[108:111], a[60:63], v[148:151]
v_mul_f32 v35, s52, v35
v_mul_f32 v36, s52, v36
v_mfma_f32_16x16x32_bf16 v[140:143], a[108:111], a[56:59], v[140:143]
v_mul_f32 v37, s52, v37
v_mul_f32 v38, s52, v38
v_mfma_f32_16x16x32_bf16 v[140:143], a[104:107], a[40:43], v[140:143]
v_mul_f32 v39, s52, v39
v_cvt_pk_bf16_f32 v32, v32, v33
v_mfma_f32_16x16x32_bf16 v[132:135], a[104:107], a[36:39], v[132:135]
v_cvt_pk_bf16_f32 v33, v34, v35
v_cvt_pk_bf16_f32 v34, v36, v37
v_cvt_pk_bf16_f32 v35, v38, v39
v_mfma_f32_16x16x32_bf16 v[132:135], a[108:111], a[52:55], v[132:135]
v_accvgpr_write_b32 a176, v32
v_accvgpr_write_b32 a177, v33
v_mfma_f32_16x16x32_bf16 v[124:127], a[108:111], a[48:51], v[124:127]
v_accvgpr_write_b32 a178, v34
v_accvgpr_write_b32 a179, v35
v_mfma_f32_16x16x32_bf16 v[124:127], a[104:107], a[32:35], v[124:127]
L_trans:
s_waitcnt vmcnt(17) lgkmcnt(0)
s_barrier
s_cmp_eq_u32 s4, 0
s_cbranch_scc1 L_hx_ld
ds_read_b128 v[188:191], v4 offset:0
ds_read_b64 v[216:217], v4 offset:1024
ds_read_b64 v[220:221], v4 offset:1032
ds_read_b128 v[204:207], v4 offset:16384
ds_read_b64 v[232:233], v4 offset:17408
ds_read_b64 v[236:237], v4 offset:17416
s_branch L_hx_rd
L_hx_ld:
buffer_load_dwordx4 v[188:191], v10, s[88:91], 0 offen sc1
buffer_load_dwordx2 v[216:217], v10, s[88:91], 0 offen offset:1024 sc1
buffer_load_dwordx2 v[220:221], v10, s[88:91], 0 offen offset:1032 sc1
buffer_load_dwordx4 v[204:207], v11, s[88:91], 0 offen sc1
buffer_load_dwordx2 v[232:233], v11, s[88:91], 0 offen offset:1024 sc1
buffer_load_dwordx2 v[236:237], v11, s[88:91], 0 offen offset:1032 sc1
L_hx_rd:
ds_read_b128 v[196:199], v6 offset:0
ds_read_b64 v[224:225], v6 offset:1024
ds_read_b64 v[228:229], v6 offset:1032
ds_read_b128 v[212:215], v6 offset:16384
ds_read_b64 v[240:241], v6 offset:17408
ds_read_b64 v[244:245], v6 offset:17416
ds_read_b128 a[0:3], v1 offset:8192
ds_read_b128 a[4:7], v1 offset:9216
ds_read_b128 a[8:11], v1 offset:10240
ds_read_b128 a[12:15], v1 offset:11264
ds_read_b128 a[16:19], v1 offset:12288
ds_read_b128 a[20:23], v1 offset:13312
ds_read_b128 a[24:27], v1 offset:14336
ds_read_b128 a[28:31], v1 offset:15360
L_hopB:
s_mov_b32 s95, 0
v_pk_mul_f32 v[40:41], v[40:41], s[52:53]
v_pk_mul_f32 v[42:43], v[42:43], s[52:53]
v_pk_mul_f32 v[44:45], v[44:45], s[52:53]
v_pk_mul_f32 v[46:47], v[46:47], s[52:53]
v_cvt_pk_bf16_f32 v40, v40, v41
v_cvt_pk_bf16_f32 v41, v42, v43
v_cvt_pk_bf16_f32 v42, v44, v45
v_cvt_pk_bf16_f32 v43, v46, v47
v_accvgpr_write_b32 a192, v40
v_accvgpr_write_b32 a193, v41
v_accvgpr_write_b32 a194, v42
v_accvgpr_write_b32 a195, v43
v_pk_mul_f32 v[48:49], v[48:49], s[52:53]
v_pk_mul_f32 v[50:51], v[50:51], s[52:53]
v_pk_mul_f32 v[52:53], v[52:53], s[52:53]
v_pk_mul_f32 v[54:55], v[54:55], s[52:53]
v_cvt_pk_bf16_f32 v48, v48, v49
v_cvt_pk_bf16_f32 v49, v50, v51
v_cvt_pk_bf16_f32 v50, v52, v53
v_cvt_pk_bf16_f32 v51, v54, v55
v_accvgpr_write_b32 a208, v48
v_accvgpr_write_b32 a209, v49
v_accvgpr_write_b32 a210, v50
v_accvgpr_write_b32 a211, v51
v_mov_b32 v47, s55
v_cndmask_b32 v36, v9, 0, s[56:57]
v_min_f32 v32, s55, v36
v_cndmask_b32 v44, v47, 0, s[36:37]
v_cndmask_b32 v37, v9, 0, s[58:59]
v_min_f32 v33, s55, v37
v_cndmask_b32 v45, v47, 0, s[38:39]
v_cndmask_b32 v38, v9, 0, s[60:61]
v_min_f32 v34, s55, v38
v_cndmask_b32 v46, v47, 0, s[40:41]
v_cndmask_b32 v39, v9, 0, s[62:63]
v_min_f32 v35, s55, v39
v_cndmask_b32 v47, v47, 0, s[42:43]
v_pk_mul_f32 v[56:57], v[56:57], s[52:53]
v_pk_mul_f32 v[58:59], v[58:59], s[52:53]
v_pk_mul_f32 v[60:61], v[60:61], s[52:53]
v_pk_mul_f32 v[62:63], v[62:63], s[52:53]
v_cvt_pk_bf16_f32 v56, v56, v57
v_cvt_pk_bf16_f32 v57, v58, v59
v_cvt_pk_bf16_f32 v58, v60, v61
v_cvt_pk_bf16_f32 v59, v62, v63
v_accvgpr_write_b32 a164, v56
v_accvgpr_write_b32 a165, v57
v_accvgpr_write_b32 a166, v58
v_accvgpr_write_b32 a167, v59
v_pk_mul_f32 v[64:65], v[64:65], s[52:53]
v_pk_mul_f32 v[66:67], v[66:67], s[52:53]
v_pk_mul_f32 v[68:69], v[68:69], s[52:53]
v_pk_mul_f32 v[70:71], v[70:71], s[52:53]
v_cvt_pk_bf16_f32 v64, v64, v65
v_cvt_pk_bf16_f32 v65, v66, v67
v_cvt_pk_bf16_f32 v66, v68, v69
v_cvt_pk_bf16_f32 v67, v70, v71
v_accvgpr_write_b32 a180, v64
v_accvgpr_write_b32 a181, v65
v_accvgpr_write_b32 a182, v66
v_accvgpr_write_b32 a183, v67
v_pk_mul_f32 v[72:73], v[72:73], s[52:53]
v_pk_mul_f32 v[74:75], v[74:75], s[52:53]
v_pk_mul_f32 v[76:77], v[76:77], s[52:53]
v_pk_mul_f32 v[78:79], v[78:79], s[52:53]
v_cvt_pk_bf16_f32 v72, v72, v73
v_cvt_pk_bf16_f32 v73, v74, v75
v_cvt_pk_bf16_f32 v74, v76, v77
v_cvt_pk_bf16_f32 v75, v78, v79
v_accvgpr_write_b32 a196, v72
v_accvgpr_write_b32 a197, v73
v_accvgpr_write_b32 a198, v74
v_accvgpr_write_b32 a199, v75
v_pk_mul_f32 v[80:81], v[80:81], s[52:53]
v_pk_mul_f32 v[82:83], v[82:83], s[52:53]
v_pk_mul_f32 v[84:85], v[84:85], s[52:53]
v_pk_mul_f32 v[86:87], v[86:87], s[52:53]
v_cvt_pk_bf16_f32 v80, v80, v81
v_cvt_pk_bf16_f32 v81, v82, v83
v_cvt_pk_bf16_f32 v82, v84, v85
v_cvt_pk_bf16_f32 v83, v86, v87
v_accvgpr_write_b32 a212, v80
v_accvgpr_write_b32 a213, v81
v_accvgpr_write_b32 a214, v82
v_accvgpr_write_b32 a215, v83
v_pk_mul_f32 v[88:89], v[88:89], s[52:53]
v_pk_mul_f32 v[90:91], v[90:91], s[52:53]
v_pk_mul_f32 v[92:93], v[92:93], s[52:53]
v_pk_mul_f32 v[94:95], v[94:95], s[52:53]
v_cvt_pk_bf16_f32 v88, v88, v89
v_cvt_pk_bf16_f32 v89, v90, v91
v_cvt_pk_bf16_f32 v90, v92, v93
v_cvt_pk_bf16_f32 v91, v94, v95
v_accvgpr_write_b32 a168, v88
v_accvgpr_write_b32 a169, v89
v_accvgpr_write_b32 a170, v90
v_accvgpr_write_b32 a171, v91
v_pk_mul_f32 v[96:97], v[96:97], s[52:53]
v_pk_mul_f32 v[98:99], v[98:99], s[52:53]
v_pk_mul_f32 v[100:101], v[100:101], s[52:53]
v_pk_mul_f32 v[102:103], v[102:103], s[52:53]
v_cvt_pk_bf16_f32 v96, v96, v97
v_cvt_pk_bf16_f32 v97, v98, v99
v_cvt_pk_bf16_f32 v98, v100, v101
v_cvt_pk_bf16_f32 v99, v102, v103
v_accvgpr_write_b32 a184, v96
v_accvgpr_write_b32 a185, v97
v_accvgpr_write_b32 a186, v98
v_accvgpr_write_b32 a187, v99
v_pk_mul_f32 v[104:105], v[104:105], s[52:53]
v_pk_mul_f32 v[106:107], v[106:107], s[52:53]
v_pk_mul_f32 v[108:109], v[108:109], s[52:53]
v_pk_mul_f32 v[110:111], v[110:111], s[52:53]
v_cvt_pk_bf16_f32 v104, v104, v105
v_cvt_pk_bf16_f32 v105, v106, v107
v_cvt_pk_bf16_f32 v106, v108, v109
v_cvt_pk_bf16_f32 v107, v110, v111
v_accvgpr_write_b32 a200, v104
v_accvgpr_write_b32 a201, v105
v_accvgpr_write_b32 a202, v106
v_accvgpr_write_b32 a203, v107
v_pk_mul_f32 v[112:113], v[112:113], s[52:53]
v_pk_mul_f32 v[114:115], v[114:115], s[52:53]
v_pk_mul_f32 v[116:117], v[116:117], s[52:53]
v_pk_mul_f32 v[118:119], v[118:119], s[52:53]
v_cvt_pk_bf16_f32 v112, v112, v113
v_cvt_pk_bf16_f32 v113, v114, v115
v_cvt_pk_bf16_f32 v114, v116, v117
v_cvt_pk_bf16_f32 v115, v118, v119
v_accvgpr_write_b32 a216, v112
v_accvgpr_write_b32 a217, v113
v_accvgpr_write_b32 a218, v114
v_accvgpr_write_b32 a219, v115
v_pk_mul_f32 v[120:121], v[120:121], s[52:53]
v_pk_mul_f32 v[122:123], v[122:123], s[52:53]
v_pk_mul_f32 v[124:125], v[124:125], s[52:53]
v_pk_mul_f32 v[126:127], v[126:127], s[52:53]
v_cvt_pk_bf16_f32 v120, v120, v121
v_cvt_pk_bf16_f32 v121, v122, v123
v_cvt_pk_bf16_f32 v122, v124, v125
v_cvt_pk_bf16_f32 v123, v126, v127
v_accvgpr_write_b32 a172, v120
v_accvgpr_write_b32 a173, v121
v_accvgpr_write_b32 a174, v122
v_accvgpr_write_b32 a175, v123
v_pk_mul_f32 v[128:129], v[128:129], s[52:53]
v_pk_mul_f32 v[130:131], v[130:131], s[52:53]
v_pk_mul_f32 v[132:133], v[132:133], s[52:53]
v_pk_mul_f32 v[134:135], v[134:135], s[52:53]
v_cvt_pk_bf16_f32 v128, v128, v129
v_cvt_pk_bf16_f32 v129, v130, v131
v_cvt_pk_bf16_f32 v130, v132, v133
v_cvt_pk_bf16_f32 v131, v134, v135
v_accvgpr_write_b32 a188, v128
v_accvgpr_write_b32 a189, v129
v_accvgpr_write_b32 a190, v130
v_accvgpr_write_b32 a191, v131
v_pk_mul_f32 v[136:137], v[136:137], s[52:53]
v_pk_mul_f32 v[138:139], v[138:139], s[52:53]
v_pk_mul_f32 v[140:141], v[140:141], s[52:53]
v_pk_mul_f32 v[142:143], v[142:143], s[52:53]
v_cvt_pk_bf16_f32 v136, v136, v137
v_cvt_pk_bf16_f32 v137, v138, v139
v_cvt_pk_bf16_f32 v138, v140, v141
v_cvt_pk_bf16_f32 v139, v142, v143
v_accvgpr_write_b32 a204, v136
v_accvgpr_write_b32 a205, v137
v_accvgpr_write_b32 a206, v138
v_accvgpr_write_b32 a207, v139
v_pk_mul_f32 v[144:145], v[144:145], s[52:53]
v_pk_mul_f32 v[146:147], v[146:147], s[52:53]
v_pk_mul_f32 v[148:149], v[148:149], s[52:53]
v_pk_mul_f32 v[150:151], v[150:151], s[52:53]
v_cvt_pk_bf16_f32 v144, v144, v145
v_cvt_pk_bf16_f32 v145, v146, v147
v_cvt_pk_bf16_f32 v146, v148, v149
v_cvt_pk_bf16_f32 v147, v150, v151
v_accvgpr_write_b32 a220, v144
v_accvgpr_write_b32 a221, v145
v_accvgpr_write_b32 a222, v146
v_accvgpr_write_b32 a223, v147
s_cmp_lg_u32 s4, 0
s_cbranch_scc1 L_spun_hx
s_mov_b32 s92, 200000
L_spin_hx:
s_waitcnt vmcnt(0)
v_max3_u32 v128, v188, v189, 0
v_max3_u32 v128, v190, v191, v128
v_max3_u32 v128, v216, v217, v128
v_max3_u32 v128, v220, v221, v128
v_max3_u32 v128, v204, v205, v128
v_max3_u32 v128, v206, v207, v128
v_max3_u32 v128, v232, v233, v128
v_max3_u32 v128, v236, v237, v128
v_cmp_eq_u32 vcc, -1, v128
s_sub_u32 s92, s92, 1
s_cbranch_scc1 L_spun_hx
s_nop 3
s_cbranch_vccz L_spun_hx
s_sleep 2
buffer_load_dwordx4 v[188:191], v10, s[88:91], 0 offen sc1
buffer_load_dwordx2 v[216:217], v10, s[88:91], 0 offen offset:1024 sc1
buffer_load_dwordx2 v[220:221], v10, s[88:91], 0 offen offset:1032 sc1
buffer_load_dwordx4 v[204:207], v11, s[88:91], 0 offen sc1
buffer_load_dwordx2 v[232:233], v11, s[88:91], 0 offen offset:1024 sc1
buffer_load_dwordx2 v[236:237], v11, s[88:91], 0 offen offset:1032 sc1
s_branch L_spin_hx
L_spun_hx:
s_waitcnt lgkmcnt(0)
s_barrier
v_mfma_f32_16x16x32_bf16 v[52:55], v[184:187], v[152:155], v[248:251]
v_mov_b32 v140, 0
v_mov_b32 v141, 0
v_mfma_f32_16x16x32_bf16 v[48:51], v[188:191], v[152:155], v[32:35]
v_mov_b32 v142, 0
v_mov_b32 v143, 0
v_mfma_f32_16x16x32_bf16 v[60:63], v[192:195], v[160:163], v[248:251]
v_mov_b32 v144, 0
v_mov_b32 v145, 0
v_mfma_f32_16x16x32_bf16 v[56:59], v[196:199], v[160:163], v[36:39]
v_mov_b32 v146, 0
v_mov_b32 v147, 0
v_mfma_f32_16x16x32_bf16 v[68:71], v[200:203], v[168:171], v[248:251]
v_mov_b32 v148, 0
v_mov_b32 v149, 0
v_mfma_f32_16x16x32_bf16 v[64:67], v[204:207], v[168:171], v[36:39]
v_max3_f32 v52, v48, v49, v52
v_max3_f32 v54, v50, v51, v54
v_mfma_f32_16x16x32_bf16 v[76:79], v[208:211], v[176:179], v[248:251]
v_max_f32 v52, v52, v53
v_max_f32 v53, v54, v55
v_mfma_f32_16x16x32_bf16 v[72:75], v[212:215], v[176:179], v[36:39]
v_max_f32 v136, v52, v53
v_max3_f32 v60, v56, v57, v60
v_mfma_f32_16x16x32_bf16 v[16:19], a[0:3], a[160:163], v[44:47]
v_max3_f32 v62, v58, v59, v62
v_max_f32 v60, v60, v61
v_mfma_f32_16x16x32_bf16 v[16:19], a[4:7], a[164:167], v[16:19]
v_max_f32 v61, v62, v63
v_max_f32 v137, v60, v61
v_mfma_f32_16x16x32_bf16 v[16:19], a[8:11], a[168:171], v[16:19]
v_max3_f32 v68, v64, v65, v68
v_max3_f32 v70, v66, v67, v70
v_mfma_f32_16x16x32_bf16 v[16:19], a[12:15], a[172:175], v[16:19]
v_max_f32 v68, v68, v69
v_max_f32 v69, v70, v71
v_mfma_f32_16x16x32_bf16 v[20:23], a[0:3], a[176:179], 0
v_max_f32 v138, v68, v69
v_max3_f32 v76, v72, v73, v76
v_mfma_f32_16x16x32_bf16 v[20:23], a[4:7], a[180:183], v[20:23]
v_max3_f32 v78, v74, v75, v78
v_max_f32 v76, v76, v77
v_mfma_f32_16x16x32_bf16 v[20:23], a[8:11], a[184:187], v[20:23]
v_max_f32 v77, v78, v79
v_max_f32 v139, v76, v77
v_mfma_f32_16x16x32_bf16 v[20:23], a[12:15], a[188:191], v[20:23]
v_mov_b32 v150, 0
v_mov_b32 v151, 0
v_mfma_f32_16x16x32_bf16 v[24:27], a[0:3], a[192:195], 0
v_mov_b32 v248, 0
v_mov_b32 v249, 0
v_mfma_f32_16x16x32_bf16 v[24:27], a[4:7], a[196:199], v[24:27]
v_mov_b32 v250, 0
v_mov_b32 v251, 0
v_mfma_f32_16x16x32_bf16 v[24:27], a[8:11], a[200:203], v[24:27]
v_max3_f32 v80, v16, v17, v18
v_max_f32 v80, v80, v19
v_mfma_f32_16x16x32_bf16 v[24:27], a[12:15], a[204:207], v[24:27]
v_max3_f32 v84, v20, v21, v22
v_max_f32 v84, v84, v23
v_mfma_f32_16x16x32_bf16 v[28:31], a[0:3], a[208:211], 0
v_mov_b32 v128, v136
v_mov_b32 v129, v137
v_mfma_f32_16x16x32_bf16 v[28:31], a[4:7], a[212:215], v[28:31]
v_mov_b32 v130, v138
v_mov_b32 v131, v139
v_mfma_f32_16x16x32_bf16 v[28:31], a[8:11], a[216:219], v[28:31]
v_permlane16_swap_b32 v128, v136
v_permlane16_swap_b32 v129, v137
v_mfma_f32_16x16x32_bf16 v[28:31], a[12:15], a[220:223], v[28:31]
v_permlane16_swap_b32 v130, v138
v_permlane16_swap_b32 v131, v139
v_max_f32 v136, v136, v128
v_max_f32 v137, v137, v129
v_max_f32 v138, v138, v130
v_max_f32 v139, v139, v131
v_max3_f32 v88, v24, v25, v26
v_max_f32 v88, v88, v27
v_mov_b32 v128, v136
v_mov_b32 v129, v137
v_mov_b32 v130, v138
v_mov_b32 v131, v139
v_max3_f32 v92, v28, v29, v30
v_max_f32 v92, v92, v31
v_permlane32_swap_b32 v128, v136
v_permlane32_swap_b32 v129, v137
v_permlane32_swap_b32 v130, v138
v_permlane32_swap_b32 v131, v139
v_max_f32 v136, v136, v128
v_max_f32 v137, v137, v129
v_max_f32 v138, v138, v130
v_max_f32 v139, v139, v131
v_mul_f32 v136, s54, v136
v_mul_f32 v137, s54, v137
v_mul_f32 v138, s54, v138
v_mul_f32 v139, s54, v139
v_fma_f32 v52, v52, s54, -v136
v_fma_f32 v53, v53, s54, -v136
v_fma_f32 v60, v60, s54, -v137
v_fma_f32 v61, v61, s54, -v137
v_fma_f32 v68, v68, s54, -v138
v_fma_f32 v69, v69, s54, -v138
v_fma_f32 v76, v76, s54, -v139
v_fma_f32 v77, v77, s54, -v139
v_exp_f32 v52, v52
v_exp_f32 v53, v53
v_exp_f32 v60, v60
v_exp_f32 v61, v61
v_exp_f32 v68, v68
v_exp_f32 v69, v69
v_exp_f32 v76, v76
v_exp_f32 v77, v77
v_cvt_pk_bf16_f32 v52, v52, v52
v_cvt_pk_bf16_f32 v53, v53, v53
v_cvt_pk_bf16_f32 v60, v60, v60
v_cvt_pk_bf16_f32 v61, v61, v61
v_cvt_pk_bf16_f32 v68, v68, v68
v_cvt_pk_bf16_f32 v69, v69, v69
v_cvt_pk_bf16_f32 v76, v76, v76
v_cvt_pk_bf16_f32 v77, v77, v77
v_and_b32 v48, v252, v52
v_and_b32 v49, v253, v53
v_and_b32 v50, v254, v52
v_and_b32 v51, v255, v53
v_and_b32 v56, v252, v60
v_and_b32 v57, v253, v61
v_and_b32 v58, v254, v60
v_and_b32 v59, v255, v61
v_and_b32 v64, v252, v68
v_and_b32 v65, v253, v69
v_and_b32 v66, v254, v68
v_and_b32 v67, v255, v69
v_and_b32 v72, v252, v76
v_and_b32 v73, v253, v77
v_and_b32 v74, v254, v76
v_and_b32 v75, v255, v77
v_mfma_f32_16x16x32_bf16 v[156:159], a[240:243], v[48:51], 0
v_mov_b32 v128, v80
v_mov_b32 v129, v84
v_mfma_f32_16x16x32_bf16 v[164:167], a[240:243], v[56:59], 0
v_mov_b32 v130, v88
v_mov_b32 v131, v92
v_mfma_f32_16x16x32_bf16 v[172:175], a[240:243], v[64:67], 0
v_permlane16_swap_b32 v128, v80
v_permlane16_swap_b32 v129, v84
v_mfma_f32_16x16x32_bf16 v[180:183], a[240:243], v[72:75], 0
v_permlane16_swap_b32 v130, v88
v_permlane16_swap_b32 v131, v92
v_mfma_f32_16x16x32_bf16 v[184:187], v[216:219], v[48:51], 0
v_max_f32 v80, v80, v128
v_max_f32 v84, v84, v129
v_mfma_f32_16x16x32_bf16 v[188:191], v[220:223], v[48:51], 0
v_max_f32 v88, v88, v130
v_max_f32 v92, v92, v131
v_mfma_f32_16x16x32_bf16 v[192:195], v[224:227], v[56:59], 0
v_mov_b32 v128, v80
v_mov_b32 v129, v84
v_mfma_f32_16x16x32_bf16 v[196:199], v[228:231], v[56:59], 0
v_mov_b32 v130, v88
v_mov_b32 v131, v92
v_mfma_f32_16x16x32_bf16 v[200:203], v[232:235], v[64:67], 0
v_permlane32_swap_b32 v128, v80
v_permlane32_swap_b32 v129, v84
v_mfma_f32_16x16x32_bf16 v[204:207], v[236:239], v[64:67], 0
v_permlane32_swap_b32 v130, v88
v_permlane32_swap_b32 v131, v92
v_mfma_f32_16x16x32_bf16 v[208:211], v[240:243], v[72:75], 0
v_max_f32 v80, v80, v128
v_max_f32 v84, v84, v129
v_mfma_f32_16x16x32_bf16 v[212:215], v[244:247], v[72:75], 0
v_max_f32 v88, v88, v130
v_max_f32 v92, v92, v131
v_rcp_f32 v128, v156
v_rcp_f32 v130, v164
v_rcp_f32 v132, v172
v_rcp_f32 v134, v180
v_sub_f32 v83, 0, v80
v_sub_f32 v82, 0, v80
v_sub_f32 v81, 0, v80
v_sub_f32 v80, 0, v80
v_sub_f32 v87, 0, v84
v_sub_f32 v86, 0, v84
v_sub_f32 v85, 0, v84
v_sub_f32 v84, 0, v84
v_sub_f32 v91, 0, v88
v_sub_f32 v90, 0, v88
v_sub_f32 v89, 0, v88
v_sub_f32 v88, 0, v88
v_sub_f32 v95, 0, v92
v_pk_mul_f32 v[184:185], v[184:185], v[128:129] op_sel_hi:[1,0]
v_pk_mul_f32 v[186:187], v[186:187], v[128:129] op_sel_hi:[1,0]
v_pk_mul_f32 v[188:189], v[188:189], v[128:129] op_sel_hi:[1,0]
v_pk_mul_f32 v[190:191], v[190:191], v[128:129] op_sel_hi:[1,0]
v_pk_mul_f32 v[192:193], v[192:193], v[130:131] op_sel_hi:[1,0]
v_pk_mul_f32 v[194:195], v[194:195], v[130:131] op_sel_hi:[1,0]
v_pk_mul_f32 v[196:197], v[196:197], v[130:131] op_sel_hi:[1,0]
v_pk_mul_f32 v[198:199], v[198:199], v[130:131] op_sel_hi:[1,0]
v_pk_mul_f32 v[200:201], v[200:201], v[132:133] op_sel_hi:[1,0]
v_pk_mul_f32 v[202:203], v[202:203], v[132:133] op_sel_hi:[1,0]
v_pk_mul_f32 v[204:205], v[204:205], v[132:133] op_sel_hi:[1,0]
v_pk_mul_f32 v[206:207], v[206:207], v[132:133] op_sel_hi:[1,0]
v_pk_mul_f32 v[208:209], v[208:209], v[134:135] op_sel_hi:[1,0]
v_pk_mul_f32 v[210:211], v[210:211], v[134:135] op_sel_hi:[1,0]
v_pk_mul_f32 v[212:213], v[212:213], v[134:135] op_sel_hi:[1,0]
v_pk_mul_f32 v[214:215], v[214:215], v[134:135] op_sel_hi:[1,0]
v_cvt_pk_bf16_f32 v32, v184, v185
v_cvt_pk_bf16_f32 v33, v186, v187
v_cvt_pk_bf16_f32 v34, v188, v189
v_cvt_pk_bf16_f32 v35, v190, v191
v_cvt_pk_bf16_f32 v36, v192, v193
v_cvt_pk_bf16_f32 v37, v194, v195
v_cvt_pk_bf16_f32 v38, v196, v197
v_cvt_pk_bf16_f32 v39, v198, v199
v_cvt_pk_bf16_f32 v40, v200, v201
v_cvt_pk_bf16_f32 v41, v202, v203
v_cvt_pk_bf16_f32 v42, v204, v205
v_cvt_pk_bf16_f32 v43, v206, v207
v_cvt_pk_bf16_f32 v44, v208, v209
v_cvt_pk_bf16_f32 v45, v210, v211
v_cvt_pk_bf16_f32 v46, v212, v213
v_cvt_pk_bf16_f32 v47, v214, v215
buffer_store_dwordx4 v[32:35], v3, s[88:91], s44 offen sc1
v_sub_f32 v94, 0, v92
v_sub_f32 v93, 0, v92
v_sub_f32 v92, 0, v92
v_min_f32 v103, s10, v80
v_cndmask_b32 v96, v103, v80, s[36:37]
v_cndmask_b32 v97, v103, v80, s[38:39]
v_cndmask_b32 v98, v103, v80, s[40:41]
v_cndmask_b32 v99, v103, v80, s[42:43]
v_cndmask_b32 v100, v9, v103, s[36:37]
v_cndmask_b32 v101, v9, v103, s[38:39]
v_cndmask_b32 v102, v9, v103, s[40:41]
v_cndmask_b32 v103, v9, v103, s[42:43]
v_min_f32 v111, s11, v84
v_cndmask_b32 v104, v111, v84, s[36:37]
v_cndmask_b32 v105, v111, v84, s[38:39]
v_cndmask_b32 v106, v111, v84, s[40:41]
v_cndmask_b32 v107, v111, v84, s[42:43]
v_cndmask_b32 v108, v9, v111, s[36:37]
v_cndmask_b32 v109, v9, v111, s[38:39]
buffer_store_dwordx4 v[36:39], v3, s[88:91], s45 offen sc1
v_cndmask_b32 v110, v9, v111, s[40:41]
v_cndmask_b32 v111, v9, v111, s[42:43]
v_and_b32 v9, 1, v0
v_mul_u32_u24 v9, 0xaaaa, v9
v_add_u32 v9, 0x4444, v9
v_mov_b64 v[128:129], 0
v_mov_b64 v[130:131], 0
v_mov_b64 v[132:133], 0
v_mov_b64 v[134:135], 0
v_mov_b64 v[136:137], 0
v_mov_b64 v[138:139], 0
v_mov_b64 v[152:153], 0
v_mov_b64 v[154:155], 0
v_mov_b64 v[156:157], 0
v_mov_b64 v[158:159], 0
v_mov_b64 v[160:161], 0
v_mov_b64 v[162:163], 0
v_mov_b64 v[164:165], 0
v_mov_b64 v[166:167], 0
buffer_store_dwordx4 v[40:43], v3, s[88:91], s46 offen sc1
v_mov_b64 v[168:169], 0
v_mov_b64 v[170:171], 0
v_mov_b64 v[172:173], 0
v_mov_b64 v[174:175], 0
v_mov_b64 v[176:177], 0
v_mov_b64 v[178:179], 0
v_mov_b64 v[180:181], 0
v_mov_b64 v[182:183], 0
v_mov_b64 v[184:185], 0
v_mov_b64 v[186:187], 0
v_mov_b64 v[188:189], 0
v_mov_b64 v[190:191], 0
v_mov_b64 v[192:193], 0
v_mov_b64 v[194:195], 0
v_mov_b64 v[196:197], 0
v_mov_b64 v[198:199], 0
v_mov_b64 v[200:201], 0
v_mov_b64 v[202:203], 0
v_mov_b64 v[204:205], 0
buffer_store_dwordx4 v[44:47], v3, s[88:91], s47 offen sc1
v_mov_b64 v[206:207], 0
v_mov_b64 v[208:209], 0
v_mov_b64 v[210:211], 0
v_mov_b64 v[212:213], 0
v_mov_b64 v[214:215], 0
v_mov_b64 v[216:217], 0
v_mov_b64 v[218:219], 0
v_mov_b64 v[220:221], 0
v_mov_b64 v[222:223], 0
v_mov_b64 v[224:225], 0
v_mov_b64 v[226:227], 0
v_mov_b64 v[228:229], 0
v_mov_b64 v[230:231], 0
v_mov_b64 v[232:233], 0
v_mov_b64 v[234:235], 0
v_mov_b64 v[236:237], 0
v_mov_b64 v[238:239], 0
v_mov_b64 v[252:253], 0
v_mov_b64 v[254:255], 0
L_att_start:
s_mov_b32 s15, s6
s_cmp_eq_u32 s6, 0
s_cbranch_scc1 L_att_j0
v_mfma_f32_16x16x32_bf16 v[16:19], a[0:3], a[160:163], v[80:83]
ds_read_b128 a[128:131], v1 offset:24576
v_mov_b32 v240, 0
v_mfma_f32_16x16x32_bf16 v[16:19], a[4:7], a[164:167], v[16:19]
ds_read_b128 a[132:135], v1 offset:25600
v_mov_b32 v241, 0
v_mfma_f32_16x16x32_bf16 v[16:19], a[8:11], a[168:171], v[16:19]
ds_read_b128 a[136:139], v1 offset:26624
s_add_u32 m0, s27, 0x0
v_mfma_f32_16x16x32_bf16 v[16:19], a[12:15], a[172:175], v[16:19]
buffer_load_dwordx4 v3, s[48:51], s32 offen offset:0 sc1 lds
v_mfma_f32_16x16x32_bf16 v[20:23], a[0:3], a[176:179], v[84:87]
ds_read_b128 a[140:143], v1 offset:27648
v_mov_b32 v242, 0
v_mfma_f32_16x16x32_bf16 v[20:23], a[4:7], a[180:183], v[20:23]
ds_read_b128 a[144:147], v1 offset:28672
v_mov_b32 v243, 0
v_mfma_f32_16x16x32_bf16 v[20:23], a[8:11], a[184:187], v[20:23]
ds_read_b128 a[148:151], v1 offset:29696
v_mov_b32 v244, 0
v_mfma_f32_16x16x32_bf16 v[20:23], a[12:15], a[188:191], v[20:23]
ds_read_b128 a[152:155], v1 offset:30720
v_mov_b32 v245, 0
v_mfma_f32_16x16x32_bf16 v[24:27], a[0:3], a[192:195], v[88:91]
ds_read_b128 a[156:159], v1 offset:31744
v_exp_f32 v16, v16
v_mfma_f32_16x16x32_bf16 v[24:27], a[4:7], a[196:199], v[24:27]
v_exp_f32 v17, v17
v_mfma_f32_16x16x32_bf16 v[24:27], a[8:11], a[200:203], v[24:27]
buffer_load_dwordx4 v3, s[48:51], s32 offen offset:1024 sc1 lds
v_mfma_f32_16x16x32_bf16 v[24:27], a[12:15], a[204:207], v[24:27]
v_exp_f32 v18, v18
v_mfma_f32_16x16x32_bf16 v[28:31], a[0:3], a[208:211], v[92:95]
v_exp_f32 v19, v19
v_mfma_f32_16x16x32_bf16 v[28:31], a[4:7], a[212:215], v[28:31]
v_exp_f32 v20, v20
v_mfma_f32_16x16x32_bf16 v[28:31], a[8:11], a[216:219], v[28:31]
v_cvt_pk_bf16_f32 v48, v16, v17
v_cvt_pk_bf16_f32 v49, v18, v19
v_mfma_f32_16x16x32_bf16 v[28:31], a[12:15], a[220:223], v[28:31]
v_exp_f32 v21, v21
v_mfma_f32_16x16x32_bf16 v[32:35], a[16:19], a[160:163], v[80:83]
v_exp_f32 v22, v22
v_mfma_f32_16x16x32_bf16 v[32:35], a[20:23], a[164:167], v[32:35]
v_exp_f32 v23, v23
v_mfma_f32_16x16x32_bf16 v[32:35], a[24:27], a[168:171], v[32:35]
buffer_load_dwordx4 v3, s[48:51], s32 offen offset:2048 sc1 lds
v_mfma_f32_16x16x32_bf16 v[32:35], a[28:31], a[172:175], v[32:35]
v_exp_f32 v24, v24
v_mfma_f32_16x16x32_bf16 v[36:39], a[16:19], a[176:179], v[84:87]
v_exp_f32 v25, v25
v_mfma_f32_16x16x32_bf16 v[36:39], a[20:23], a[180:183], v[36:39]
v_cvt_pk_bf16_f32 v52, v20, v21
v_cvt_pk_bf16_f32 v53, v22, v23
v_mfma_f32_16x16x32_bf16 v[36:39], a[24:27], a[184:187], v[36:39]
v_exp_f32 v26, v26
v_mfma_f32_16x16x32_bf16 v[36:39], a[28:31], a[188:191], v[36:39]
v_exp_f32 v27, v27
v_mfma_f32_16x16x32_bf16 v[40:43], a[16:19], a[192:195], v[88:91]
v_exp_f32 v28, v28
v_mfma_f32_16x16x32_bf16 v[40:43], a[20:23], a[196:199], v[40:43]
buffer_load_dwordx4 v3, s[48:51], s32 offen offset:3072 sc1 lds
v_mfma_f32_16x16x32_bf16 v[40:43], a[24:27], a[200:203], v[40:43]
s_add_u32 s32, s32, 0x8000
v_exp_f32 v29, v29
v_mfma_f32_16x16x32_bf16 v[40:43], a[28:31], a[204:207], v[40:43]
v_exp_f32 v30, v30
v_mfma_f32_16x16x32_bf16 v[44:47], a[16:19], a[208:211], v[92:95]
v_exp_f32 v31, v31
v_mfma_f32_16x16x32_bf16 v[44:47], a[20:23], a[212:215], v[44:47]
v_exp_f32 v32, v32
v_mfma_f32_16x16x32_bf16 v[44:47], a[24:27], a[216:219], v[44:47]
v_exp_f32 v33, v33
v_mfma_f32_16x16x32_bf16 v[44:47], a[28:31], a[220:223], v[44:47]
s_waitcnt lgkmcnt(0)
v_cvt_pk_bf16_f32 v56, v24, v25
v_cvt_pk_bf16_f32 v57, v26, v27
v_mov_b32 v246, 0
v_mov_b32 v247, 0
v_mfma_f32_16x16x32_bf16 v[16:19], a[128:131], a[160:163], v[80:83]
ds_read_b128 a[32:35], v1 offset:16384
v_cvt_pk_bf16_f32 v60, v28, v29
v_mfma_f32_16x16x32_bf16 v[16:19], a[132:135], a[164:167], v[16:19]
v_exp_f32 v34, v34
v_mfma_f32_16x16x32_bf16 v[16:19], a[136:139], a[168:171], v[16:19]
s_add_u32 m0, s27, 0x1000
v_exp_f32 v35, v35
v_mfma_f32_16x16x32_bf16 v[16:19], a[140:143], a[172:175], v[16:19]
buffer_load_dwordx4 v3, s[48:51], s7 offen offset:0 sc1 lds
v_mfma_f32_16x16x32_bf16 v[20:23], a[128:131], a[176:179], v[84:87]
ds_read_b128 a[36:39], v1 offset:17408
v_cvt_pk_bf16_f32 v61, v30, v31
v_mfma_f32_16x16x32_bf16 v[20:23], a[132:135], a[180:183], v[20:23]
v_exp_f32 v36, v36
v_mfma_f32_16x16x32_bf16 v[20:23], a[136:139], a[184:187], v[20:23]
ds_read_b128 a[40:43], v1 offset:18432
v_cvt_pk_bf16_f32 v50, v32, v33
v_mfma_f32_16x16x32_bf16 v[20:23], a[140:143], a[188:191], v[20:23]
v_exp_f32 v37, v37
v_mfma_f32_16x16x32_bf16 v[24:27], a[128:131], a[192:195], v[88:91]
v_exp_f32 v38, v38
v_mfma_f32_16x16x32_bf16 v[24:27], a[132:135], a[196:199], v[24:27]
ds_read_b128 a[44:47], v1 offset:19456
v_cvt_pk_bf16_f32 v51, v34, v35
v_mfma_f32_16x16x32_bf16 v[24:27], a[136:139], a[200:203], v[24:27]
buffer_load_dwordx4 v3, s[48:51], s7 offen offset:1024 sc1 lds
v_mfma_f32_16x16x32_bf16 v[24:27], a[140:143], a[204:207], v[24:27]
v_exp_f32 v39, v39
v_mfma_f32_16x16x32_bf16 v[28:31], a[128:131], a[208:211], v[92:95]
v_exp_f32 v40, v40
v_mfma_f32_16x16x32_bf16 v[28:31], a[132:135], a[212:215], v[28:31]
ds_read_b128 a[48:51], v1 offset:20480
v_cvt_pk_bf16_f32 v54, v36, v37
v_mfma_f32_16x16x32_bf16 v[28:31], a[136:139], a[216:219], v[28:31]
v_exp_f32 v41, v41
v_mfma_f32_16x16x32_bf16 v[28:31], a[140:143], a[220:223], v[28:31]
v_exp_f32 v42, v42
v_mfma_f32_16x16x32_bf16 v[32:35], a[144:147], a[160:163], v[80:83]
buffer_load_dwordx4 v3, s[48:51], s7 offen offset:2048 sc1 lds
v_mfma_f32_16x16x32_bf16 v[32:35], a[148:151], a[164:167], v[32:35]
ds_read_b128 a[52:55], v1 offset:21504
v_cvt_pk_bf16_f32 v55, v38, v39
v_mfma_f32_16x16x32_bf16 v[32:35], a[152:155], a[168:171], v[32:35]
v_exp_f32 v43, v43
v_mfma_f32_16x16x32_bf16 v[32:35], a[156:159], a[172:175], v[32:35]
ds_read_b128 a[56:59], v1 offset:22528
v_cvt_pk_bf16_f32 v58, v40, v41
v_mfma_f32_16x16x32_bf16 v[36:39], a[144:147], a[176:179], v[84:87]
v_exp_f32 v44, v44
v_mfma_f32_16x16x32_bf16 v[36:39], a[148:151], a[180:183], v[36:39]
v_exp_f32 v45, v45
v_mfma_f32_16x16x32_bf16 v[36:39], a[152:155], a[184:187], v[36:39]
ds_read_b128 a[60:63], v1 offset:23552
v_xor_b32 v1, 0x8000, v1
v_mfma_f32_16x16x32_bf16 v[36:39], a[156:159], a[188:191], v[36:39]
buffer_load_dwordx4 v3, s[48:51], s7 offen offset:3072 sc1 lds
v_cvt_pk_bf16_f32 v59, v42, v43
v_mfma_f32_16x16x32_bf16 v[40:43], a[144:147], a[192:195], v[88:91]
s_add_u32 s7, s7, 0x8000
v_exp_f32 v46, v46
v_mfma_f32_16x16x32_bf16 v[40:43], a[148:151], a[196:199], v[40:43]
s_xor_b32 s27, s27, 0x38000
v_exp_f32 v47, v47
v_mfma_f32_16x16x32_bf16 v[40:43], a[152:155], a[200:203], v[40:43]
v_exp_f32 v16, v16
v_mfma_f32_16x16x32_bf16 v[40:43], a[156:159], a[204:207], v[40:43]
v_exp_f32 v17, v17
v_cvt_pk_bf16_f32 v62, v44, v45
v_cvt_pk_bf16_f32 v63, v46, v47
v_mfma_f32_16x16x32_bf16 v[44:47], a[144:147], a[208:211], v[92:95]
v_exp_f32 v18, v18
v_mfma_f32_16x16x32_bf16 v[44:47], a[148:151], a[212:215], v[44:47]
v_exp_f32 v19, v19
v_mfma_f32_16x16x32_bf16 v[44:47], a[152:155], a[216:219], v[44:47]
s_waitcnt vmcnt(8) lgkmcnt(0)
v_exp_f32 v20, v20
v_mfma_f32_16x16x32_bf16 v[44:47], a[156:159], a[220:223], v[44:47]
s_barrier
v_cvt_pk_bf16_f32 v64, v16, v17
v_exp_f32 v21, v21
v_exp_f32 v22, v22
v_exp_f32 v23, v23
v_exp_f32 v24, v24
v_exp_f32 v25, v25
v_exp_f32 v26, v26
v_exp_f32 v27, v27
v_cvt_pk_bf16_f32 v65, v18, v19
v_cvt_pk_bf16_f32 v68, v20, v21
v_cvt_pk_bf16_f32 v69, v22, v23
s_cmp_lg_u32 s33, 0
s_cbranch_scc1 L_sig_bd
s_lshl_b32 s8, s6, 2
s_add_u32 s8, s8, 192
s_cmp_lg_u32 s4, 0
s_cbranch_scc1 L_sig_bd
v_mov_b32 v4, 1
s_mov_b64 exec, 1
buffer_atomic_add v4, off, s[84:87], s8 sc1
s_mov_b64 exec, -1
L_sig_bd:
s_getreg_b32 s8, hwreg(HW_REG_HW_ID, 5, 1)
s_cmp_lg_u32 s8, 0
s_cbranch_scc1 L_att_dodd1
s_branch L_att_dodd0
L_att_deven0:
v_mfma_f32_16x16x32_bf16 v[128:131], a[32:35], v[48:51], v[128:131]
ds_read_b128 a[0:3], v1 offset:8192
v_cvt_pk_bf16_f32 v72, v24, v25
v_mfma_f32_16x16x32_bf16 v[160:163], a[32:35], v[52:55], v[160:163]
v_exp_f32 v28, v28
v_mfma_f32_16x16x32_bf16 v[192:195], a[32:35], v[56:59], v[192:195]
v_cvt_pk_bf16_f32 v73, v26, v27
v_mfma_f32_16x16x32_bf16 v[224:227], a[32:35], v[60:63], v[224:227]
ds_read_b128 a[4:7], v1 offset:9216
v_mfma_f32_16x16x32_bf16 v[228:231], a[36:39], v[60:63], v[228:231]
v_exp_f32 v29, v29
v_mfma_f32_16x16x32_bf16 v[196:199], a[36:39], v[56:59], v[196:199]
v_exp_f32 v30, v30
v_mfma_f32_16x16x32_bf16 v[164:167], a[36:39], v[52:55], v[164:167]
s_add_u32 m0, s27, 0x0
v_cvt_pk_bf16_f32 v76, v28, v29
v_mfma_f32_16x16x32_bf16 v[132:135], a[36:39], v[48:51], v[132:135]
buffer_load_dwordx4 v3, s[48:51], s32 offen offset:0 sc1 lds
v_mfma_f32_16x16x32_bf16 v[136:139], a[40:43], v[48:51], v[136:139]
ds_read_b128 a[8:11], v1 offset:10240
v_mfma_f32_16x16x32_bf16 v[168:171], a[40:43], v[52:55], v[168:171]
v_exp_f32 v31, v31
v_mfma_f32_16x16x32_bf16 v[200:203], a[40:43], v[56:59], v[200:203]
v_exp_f32 v32, v32
v_mfma_f32_16x16x32_bf16 v[232:235], a[40:43], v[60:63], v[232:235]
ds_read_b128 a[12:15], v1 offset:11264
v_cvt_pk_bf16_f32 v77, v30, v31
v_mfma_f32_16x16x32_bf16 v[236:239], a[44:47], v[60:63], v[236:239]
v_mfma_f32_16x16x32_bf16 v[204:207], a[44:47], v[56:59], v[204:207]
v_exp_f32 v33, v33
v_mfma_f32_16x16x32_bf16 v[172:175], a[44:47], v[52:55], v[172:175]
v_exp_f32 v34, v34
v_mfma_f32_16x16x32_bf16 v[140:143], a[44:47], v[48:51], v[140:143]
ds_read_b128 a[16:19], v1 offset:12288
v_cvt_pk_bf16_f32 v66, v32, v33
v_mfma_f32_16x16x32_bf16 v[144:147], a[48:51], v[48:51], v[144:147]
v_mfma_f32_16x16x32_bf16 v[176:179], a[48:51], v[52:55], v[176:179]
v_exp_f32 v35, v35
v_mfma_f32_16x16x32_bf16 v[208:211], a[48:51], v[56:59], v[208:211]
v_exp_f32 v36, v36
v_mfma_f32_16x16x32_bf16 v[240:243], a[48:51], v[60:63], v[240:243]
ds_read_b128 a[20:23], v1 offset:13312
v_cvt_pk_bf16_f32 v67, v34, v35
v_mfma_f32_16x16x32_bf16 v[244:247], a[52:55], v[60:63], v[244:247]
v_exp_f32 v37, v37
v_mfma_f32_16x16x32_bf16 v[212:215], a[52:55], v[56:59], v[212:215]
v_cvt_pk_bf16_f32 v70, v36, v37
v_mfma_f32_16x16x32_bf16 v[180:183], a[52:55], v[52:55], v[180:183]
ds_read_b128 a[24:27], v1 offset:14336
v_mfma_f32_16x16x32_bf16 v[148:151], a[52:55], v[48:51], v[148:151]
buffer_load_dwordx4 v3, s[48:51], s32 offen offset:1024 sc1 lds
v_mfma_f32_16x16x32_bf16 v[152:155], a[56:59], v[48:51], v[152:155]
v_exp_f32 v38, v38
v_mfma_f32_16x16x32_bf16 v[184:187], a[56:59], v[52:55], v[184:187]
v_exp_f32 v39, v39
v_mfma_f32_16x16x32_bf16 v[216:219], a[56:59], v[56:59], v[216:219]
ds_read_b128 a[28:31], v1 offset:15360
v_cvt_pk_bf16_f32 v71, v38, v39
v_mfma_f32_16x16x32_bf16 v[248:251], a[56:59], v[60:63], v[248:251]
v_mfma_f32_16x16x32_bf16 v[252:255], a[60:63], v[60:63], v[252:255]
v_exp_f32 v40, v40
v_mfma_f32_16x16x32_bf16 v[220:223], a[60:63], v[56:59], v[220:223]
v_exp_f32 v41, v41
v_mfma_f32_16x16x32_bf16 v[188:191], a[60:63], v[52:55], v[188:191]
ds_read_b128 a[32:35], v1 offset:0
v_cvt_pk_bf16_f32 v74, v40, v41
v_mfma_f32_16x16x32_bf16 v[156:159], a[60:63], v[48:51], v[156:159]
v_smfmac_f32_16x16x64_bf16 a[224:227], a[232:235], v[48:55], v9
v_exp_f32 v42, v42
v_smfmac_f32_16x16x64_bf16 a[228:231], a[232:235], v[56:63], v9
s_waitcnt lgkmcnt(5)
v_exp_f32 v43, v43
v_mfma_f32_16x16x32_bf16 v[16:19], a[0:3], a[160:163], v[80:83]
ds_read_b128 a[36:39], v1 offset:1024
v_cvt_pk_bf16_f32 v75, v42, v43
v_mfma_f32_16x16x32_bf16 v[16:19], a[4:7], a[164:167], v[16:19]
v_exp_f32 v44, v44
v_mfma_f32_16x16x32_bf16 v[16:19], a[8:11], a[168:171], v[16:19]
v_mfma_f32_16x16x32_bf16 v[16:19], a[12:15], a[172:175], v[16:19]
v_exp_f32 v45, v45
v_mfma_f32_16x16x32_bf16 v[20:23], a[0:3], a[176:179], v[84:87]
ds_read_b128 a[40:43], v1 offset:2048
v_cvt_pk_bf16_f32 v78, v44, v45
v_mfma_f32_16x16x32_bf16 v[20:23], a[4:7], a[180:183], v[20:23]
buffer_load_dwordx4 v3, s[48:51], s32 offen offset:2048 sc1 lds
v_mfma_f32_16x16x32_bf16 v[20:23], a[8:11], a[184:187], v[20:23]
v_exp_f32 v46, v46
v_mfma_f32_16x16x32_bf16 v[20:23], a[12:15], a[188:191], v[20:23]
ds_read_b128 a[44:47], v1 offset:3072
v_mfma_f32_16x16x32_bf16 v[24:27], a[0:3], a[192:195], v[88:91]
v_mfma_f32_16x16x32_bf16 v[24:27], a[4:7], a[196:199], v[24:27]
v_exp_f32 v47, v47
v_mfma_f32_16x16x32_bf16 v[24:27], a[8:11], a[200:203], v[24:27]
v_exp_f32 v16, v16
v_mfma_f32_16x16x32_bf16 v[24:27], a[12:15], a[204:207], v[24:27]
ds_read_b128 a[48:51], v1 offset:4096
v_cvt_pk_bf16_f32 v79, v46, v47
v_mfma_f32_16x16x32_bf16 v[28:31], a[0:3], a[208:211], v[92:95]
v_mfma_f32_16x16x32_bf16 v[28:31], a[4:7], a[212:215], v[28:31]
v_exp_f32 v17, v17
v_mfma_f32_16x16x32_bf16 v[28:31], a[8:11], a[216:219], v[28:31]
s_waitcnt lgkmcnt(5)
v_exp_f32 v18, v18
v_mfma_f32_16x16x32_bf16 v[28:31], a[12:15], a[220:223], v[28:31]
ds_read_b128 a[52:55], v1 offset:5120
v_cvt_pk_bf16_f32 v48, v16, v17
v_mfma_f32_16x16x32_bf16 v[32:35], a[16:19], a[160:163], v[80:83]
v_mfma_f32_16x16x32_bf16 v[32:35], a[20:23], a[164:167], v[32:35]
v_exp_f32 v19, v19
v_mfma_f32_16x16x32_bf16 v[32:35], a[24:27], a[168:171], v[32:35]
v_exp_f32 v20, v20
v_mfma_f32_16x16x32_bf16 v[32:35], a[28:31], a[172:175], v[32:35]
ds_read_b128 a[56:59], v1 offset:6144
v_cvt_pk_bf16_f32 v49, v18, v19
v_mfma_f32_16x16x32_bf16 v[36:39], a[16:19], a[176:179], v[84:87]
v_exp_f32 v21, v21
v_mfma_f32_16x16x32_bf16 v[36:39], a[20:23], a[180:183], v[36:39]
buffer_load_dwordx4 v3, s[48:51], s32 offen offset:3072 sc1 lds
v_mfma_f32_16x16x32_bf16 v[36:39], a[24:27], a[184:187], v[36:39]
s_add_u32 s32, s32, 0x8000
v_cvt_pk_bf16_f32 v52, v20, v21
v_mfma_f32_16x16x32_bf16 v[36:39], a[28:31], a[188:191], v[36:39]
ds_read_b128 a[60:63], v1 offset:7168
v_mfma_f32_16x16x32_bf16 v[40:43], a[16:19], a[192:195], v[88:91]
v_exp_f32 v22, v22
v_mfma_f32_16x16x32_bf16 v[40:43], a[20:23], a[196:199], v[40:43]
v_exp_f32 v23, v23
v_mfma_f32_16x16x32_bf16 v[40:43], a[24:27], a[200:203], v[40:43]
v_cvt_pk_bf16_f32 v53, v22, v23
v_mfma_f32_16x16x32_bf16 v[40:43], a[28:31], a[204:207], v[40:43]
v_exp_f32 v24, v24
v_mfma_f32_16x16x32_bf16 v[44:47], a[16:19], a[208:211], v[92:95]
v_exp_f32 v25, v25
v_mfma_f32_16x16x32_bf16 v[44:47], a[20:23], a[212:215], v[44:47]
v_exp_f32 v26, v26
v_mfma_f32_16x16x32_bf16 v[44:47], a[24:27], a[216:219], v[44:47]
v_exp_f32 v27, v27
v_mfma_f32_16x16x32_bf16 v[44:47], a[28:31], a[220:223], v[44:47]
s_waitcnt lgkmcnt(0)
v_mfma_f32_16x16x32_bf16 v[128:131], a[32:35], v[64:67], v[128:131]
ds_read_b128 a[0:3], v1 offset:24576
v_cvt_pk_bf16_f32 v56, v24, v25
v_mfma_f32_16x16x32_bf16 v[160:163], a[32:35], v[68:71], v[160:163]
v_exp_f32 v28, v28
v_mfma_f32_16x16x32_bf16 v[192:195], a[32:35], v[72:75], v[192:195]
v_cvt_pk_bf16_f32 v57, v26, v27
v_mfma_f32_16x16x32_bf16 v[224:227], a[32:35], v[76:79], v[224:227]
ds_read_b128 a[4:7], v1 offset:25600
v_mfma_f32_16x16x32_bf16 v[228:231], a[36:39], v[76:79], v[228:231]
v_exp_f32 v29, v29
v_mfma_f32_16x16x32_bf16 v[196:199], a[36:39], v[72:75], v[196:199]
v_exp_f32 v30, v30
v_mfma_f32_16x16x32_bf16 v[164:167], a[36:39], v[68:71], v[164:167]
s_add_u32 m0, s27, 0x1000
v_cvt_pk_bf16_f32 v60, v28, v29
v_mfma_f32_16x16x32_bf16 v[132:135], a[36:39], v[64:67], v[132:135]
buffer_load_dwordx4 v3, s[48:51], s7 offen offset:0 sc1 lds
v_mfma_f32_16x16x32_bf16 v[136:139], a[40:43], v[64:67], v[136:139]
ds_read_b128 a[8:11], v1 offset:26624
v_mfma_f32_16x16x32_bf16 v[168:171], a[40:43], v[68:71], v[168:171]
v_exp_f32 v31, v31
v_mfma_f32_16x16x32_bf16 v[200:203], a[40:43], v[72:75], v[200:203]
v_exp_f32 v32, v32
v_mfma_f32_16x16x32_bf16 v[232:235], a[40:43], v[76:79], v[232:235]
ds_read_b128 a[12:15], v1 offset:27648
v_cvt_pk_bf16_f32 v61, v30, v31
v_mfma_f32_16x16x32_bf16 v[236:239], a[44:47], v[76:79], v[236:239]
v_mfma_f32_16x16x32_bf16 v[204:207], a[44:47], v[72:75], v[204:207]
v_exp_f32 v33, v33
v_mfma_f32_16x16x32_bf16 v[172:175], a[44:47], v[68:71], v[172:175]
v_exp_f32 v34, v34
v_mfma_f32_16x16x32_bf16 v[140:143], a[44:47], v[64:67], v[140:143]
ds_read_b128 a[16:19], v1 offset:28672
v_cvt_pk_bf16_f32 v50, v32, v33
v_mfma_f32_16x16x32_bf16 v[144:147], a[48:51], v[64:67], v[144:147]
v_mfma_f32_16x16x32_bf16 v[176:179], a[48:51], v[68:71], v[176:179]
v_exp_f32 v35, v35
v_mfma_f32_16x16x32_bf16 v[208:211], a[48:51], v[72:75], v[208:211]
ds_read_b128 a[20:23], v1 offset:29696
v_cvt_pk_bf16_f32 v51, v34, v35
v_mfma_f32_16x16x32_bf16 v[240:243], a[48:51], v[76:79], v[240:243]
v_exp_f32 v36, v36
v_mfma_f32_16x16x32_bf16 v[244:247], a[52:55], v[76:79], v[244:247]
v_exp_f32 v37, v37
v_mfma_f32_16x16x32_bf16 v[212:215], a[52:55], v[72:75], v[212:215]
v_cvt_pk_bf16_f32 v54, v36, v37
v_mfma_f32_16x16x32_bf16 v[180:183], a[52:55], v[68:71], v[180:183]
buffer_load_dwordx4 v3, s[48:51], s7 offen offset:1024 sc1 lds
v_mfma_f32_16x16x32_bf16 v[148:151], a[52:55], v[64:67], v[148:151]
ds_read_b128 a[24:27], v1 offset:30720
v_mfma_f32_16x16x32_bf16 v[152:155], a[56:59], v[64:67], v[152:155]
v_exp_f32 v38, v38
v_mfma_f32_16x16x32_bf16 v[184:187], a[56:59], v[68:71], v[184:187]
v_exp_f32 v39, v39
v_mfma_f32_16x16x32_bf16 v[216:219], a[56:59], v[72:75], v[216:219]
ds_read_b128 a[28:31], v1 offset:31744
v_cvt_pk_bf16_f32 v55, v38, v39
v_mfma_f32_16x16x32_bf16 v[248:251], a[56:59], v[76:79], v[248:251]
v_mfma_f32_16x16x32_bf16 v[252:255], a[60:63], v[76:79], v[252:255]
v_exp_f32 v40, v40
v_mfma_f32_16x16x32_bf16 v[220:223], a[60:63], v[72:75], v[220:223]
v_exp_f32 v41, v41
v_mfma_f32_16x16x32_bf16 v[188:191], a[60:63], v[68:71], v[188:191]
ds_read_b128 a[32:35], v1 offset:16384
v_cvt_pk_bf16_f32 v58, v40, v41
v_mfma_f32_16x16x32_bf16 v[156:159], a[60:63], v[64:67], v[156:159]
v_smfmac_f32_16x16x64_bf16 a[224:227], a[232:235], v[64:71], v9
s_waitcnt lgkmcnt(5)
v_exp_f32 v42, v42
v_smfmac_f32_16x16x64_bf16 a[228:231], a[232:235], v[72:79], v9
ds_read_b128 a[36:39], v1 offset:17408
v_mfma_f32_16x16x32_bf16 v[16:19], a[0:3], a[160:163], v[80:83]
v_exp_f32 v43, v43
v_mfma_f32_16x16x32_bf16 v[16:19], a[4:7], a[164:167], v[16:19]
v_exp_f32 v44, v44
v_mfma_f32_16x16x32_bf16 v[16:19], a[8:11], a[168:171], v[16:19]
v_cvt_pk_bf16_f32 v59, v42, v43
v_mfma_f32_16x16x32_bf16 v[16:19], a[12:15], a[172:175], v[16:19]
ds_read_b128 a[40:43], v1 offset:18432
v_mfma_f32_16x16x32_bf16 v[20:23], a[0:3], a[176:179], v[84:87]
buffer_load_dwordx4 v3, s[48:51], s7 offen offset:2048 sc1 lds
v_mfma_f32_16x16x32_bf16 v[20:23], a[4:7], a[180:183], v[20:23]
v_exp_f32 v45, v45
v_mfma_f32_16x16x32_bf16 v[20:23], a[8:11], a[184:187], v[20:23]
v_exp_f32 v46, v46
v_mfma_f32_16x16x32_bf16 v[20:23], a[12:15], a[188:191], v[20:23]
ds_read_b128 a[44:47], v1 offset:19456
v_cvt_pk_bf16_f32 v62, v44, v45
v_mfma_f32_16x16x32_bf16 v[24:27], a[0:3], a[192:195], v[88:91]
v_mfma_f32_16x16x32_bf16 v[24:27], a[4:7], a[196:199], v[24:27]
v_exp_f32 v47, v47
v_mfma_f32_16x16x32_bf16 v[24:27], a[8:11], a[200:203], v[24:27]
v_exp_f32 v16, v16
v_mfma_f32_16x16x32_bf16 v[24:27], a[12:15], a[204:207], v[24:27]
ds_read_b128 a[48:51], v1 offset:20480
v_cvt_pk_bf16_f32 v63, v46, v47
v_mfma_f32_16x16x32_bf16 v[28:31], a[0:3], a[208:211], v[92:95]
v_mfma_f32_16x16x32_bf16 v[28:31], a[4:7], a[212:215], v[28:31]
v_exp_f32 v17, v17
v_mfma_f32_16x16x32_bf16 v[28:31], a[8:11], a[216:219], v[28:31]
ds_read_b128 a[52:55], v1 offset:21504
v_cvt_pk_bf16_f32 v64, v16, v17
v_mfma_f32_16x16x32_bf16 v[28:31], a[12:15], a[220:223], v[28:31]
s_waitcnt lgkmcnt(6)
v_exp_f32 v18, v18
v_mfma_f32_16x16x32_bf16 v[32:35], a[16:19], a[160:163], v[80:83]
v_mfma_f32_16x16x32_bf16 v[32:35], a[20:23], a[164:167], v[32:35]
v_exp_f32 v19, v19
v_mfma_f32_16x16x32_bf16 v[32:35], a[24:27], a[168:171], v[32:35]
ds_read_b128 a[56:59], v1 offset:22528
v_cvt_pk_bf16_f32 v65, v18, v19
v_mfma_f32_16x16x32_bf16 v[32:35], a[28:31], a[172:175], v[32:35]
buffer_load_dwordx4 v3, s[48:51], s7 offen offset:3072 sc1 lds
v_mfma_f32_16x16x32_bf16 v[36:39], a[16:19], a[176:179], v[84:87]
s_add_u32 s7, s7, 0x8000
v_exp_f32 v20, v20
v_mfma_f32_16x16x32_bf16 v[36:39], a[20:23], a[180:183], v[36:39]
s_xor_b32 s27, s27, 0x38000
v_exp_f32 v21, v21
v_mfma_f32_16x16x32_bf16 v[36:39], a[24:27], a[184:187], v[36:39]
ds_read_b128 a[60:63], v1 offset:23552
v_xor_b32 v1, 0x8000, v1
v_mfma_f32_16x16x32_bf16 v[36:39], a[28:31], a[188:191], v[36:39]
v_cvt_pk_bf16_f32 v68, v20, v21
v_mfma_f32_16x16x32_bf16 v[40:43], a[16:19], a[192:195], v[88:91]
v_exp_f32 v22, v22
v_mfma_f32_16x16x32_bf16 v[40:43], a[20:23], a[196:199], v[40:43]
v_exp_f32 v23, v23
v_mfma_f32_16x16x32_bf16 v[40:43], a[24:27], a[200:203], v[40:43]
v_cvt_pk_bf16_f32 v69, v22, v23
v_mfma_f32_16x16x32_bf16 v[40:43], a[28:31], a[204:207], v[40:43]
v_exp_f32 v24, v24
v_mfma_f32_16x16x32_bf16 v[44:47], a[16:19], a[208:211], v[92:95]
v_exp_f32 v25, v25
v_mfma_f32_16x16x32_bf16 v[44:47], a[20:23], a[212:215], v[44:47]
v_exp_f32 v26, v26
v_mfma_f32_16x16x32_bf16 v[44:47], a[24:27], a[216:219], v[44:47]
s_waitcnt vmcnt(16) lgkmcnt(0)
v_exp_f32 v27, v27
v_mfma_f32_16x16x32_bf16 v[44:47], a[28:31], a[220:223], v[44:47]
s_barrier
L_att_dodd0:
v_mfma_f32_16x16x32_bf16 v[128:131], a[32:35], v[48:51], v[128:131]
ds_read_b128 a[0:3], v2 offset:8192
v_cvt_pk_bf16_f32 v72, v24, v25
v_mfma_f32_16x16x32_bf16 v[160:163], a[32:35], v[52:55], v[160:163]
v_exp_f32 v28, v28
v_mfma_f32_16x16x32_bf16 v[192:195], a[32:35], v[56:59], v[192:195]
v_cvt_pk_bf16_f32 v73, v26, v27
v_mfma_f32_16x16x32_bf16 v[224:227], a[32:35], v[60:63], v[224:227]
ds_read_b128 a[4:7], v2 offset:9216
v_mfma_f32_16x16x32_bf16 v[228:231], a[36:39], v[60:63], v[228:231]
v_exp_f32 v29, v29
v_mfma_f32_16x16x32_bf16 v[196:199], a[36:39], v[56:59], v[196:199]
v_exp_f32 v30, v30
v_mfma_f32_16x16x32_bf16 v[164:167], a[36:39], v[52:55], v[164:167]
s_add_u32 m0, s19, 0x0
v_cvt_pk_bf16_f32 v76, v28, v29
v_mfma_f32_16x16x32_bf16 v[132:135], a[36:39], v[48:51], v[132:135]
buffer_load_dwordx4 v3, s[48:51], s32 offen offset:0 sc1 lds
v_mfma_f32_16x16x32_bf16 v[136:139], a[40:43], v[48:51], v[136:139]
ds_read_b128 a[8:11], v2 offset:10240
v_mfma_f32_16x16x32_bf16 v[168:171], a[40:43], v[52:55], v[168:171]
v_exp_f32 v31, v31
v_mfma_f32_16x16x32_bf16 v[200:203], a[40:43], v[56:59], v[200:203]
v_exp_f32 v32, v32
v_mfma_f32_16x16x32_bf16 v[232:235], a[40:43], v[60:63], v[232:235]
ds_read_b128 a[12:15], v2 offset:11264
v_cvt_pk_bf16_f32 v77, v30, v31
v_mfma_f32_16x16x32_bf16 v[236:239], a[44:47], v[60:63], v[236:239]
v_mfma_f32_16x16x32_bf16 v[204:207], a[44:47], v[56:59], v[204:207]
v_exp_f32 v33, v33
v_mfma_f32_16x16x32_bf16 v[172:175], a[44:47], v[52:55], v[172:175]
v_exp_f32 v34, v34
v_mfma_f32_16x16x32_bf16 v[140:143], a[44:47], v[48:51], v[140:143]
ds_read_b128 a[16:19], v2 offset:12288
v_cvt_pk_bf16_f32 v66, v32, v33
v_mfma_f32_16x16x32_bf16 v[144:147], a[48:51], v[48:51], v[144:147]
v_mfma_f32_16x16x32_bf16 v[176:179], a[48:51], v[52:55], v[176:179]
v_exp_f32 v35, v35
v_mfma_f32_16x16x32_bf16 v[208:211], a[48:51], v[56:59], v[208:211]
v_exp_f32 v36, v36
v_mfma_f32_16x16x32_bf16 v[240:243], a[48:51], v[60:63], v[240:243]
ds_read_b128 a[20:23], v2 offset:13312
v_cvt_pk_bf16_f32 v67, v34, v35
v_mfma_f32_16x16x32_bf16 v[244:247], a[52:55], v[60:63], v[244:247]
v_exp_f32 v37, v37
v_mfma_f32_16x16x32_bf16 v[212:215], a[52:55], v[56:59], v[212:215]
v_cvt_pk_bf16_f32 v70, v36, v37
v_mfma_f32_16x16x32_bf16 v[180:183], a[52:55], v[52:55], v[180:183]
ds_read_b128 a[24:27], v2 offset:14336
v_mfma_f32_16x16x32_bf16 v[148:151], a[52:55], v[48:51], v[148:151]
buffer_load_dwordx4 v3, s[48:51], s32 offen offset:1024 sc1 lds
v_mfma_f32_16x16x32_bf16 v[152:155], a[56:59], v[48:51], v[152:155]
v_exp_f32 v38, v38
v_mfma_f32_16x16x32_bf16 v[184:187], a[56:59], v[52:55], v[184:187]
v_exp_f32 v39, v39
v_mfma_f32_16x16x32_bf16 v[216:219], a[56:59], v[56:59], v[216:219]
ds_read_b128 a[28:31], v2 offset:15360
v_cvt_pk_bf16_f32 v71, v38, v39
v_mfma_f32_16x16x32_bf16 v[248:251], a[56:59], v[60:63], v[248:251]
v_mfma_f32_16x16x32_bf16 v[252:255], a[60:63], v[60:63], v[252:255]
v_exp_f32 v40, v40
v_mfma_f32_16x16x32_bf16 v[220:223], a[60:63], v[56:59], v[220:223]
v_exp_f32 v41, v41
v_mfma_f32_16x16x32_bf16 v[188:191], a[60:63], v[52:55], v[188:191]
ds_read_b128 a[32:35], v2 offset:0
v_cvt_pk_bf16_f32 v74, v40, v41
v_mfma_f32_16x16x32_bf16 v[156:159], a[60:63], v[48:51], v[156:159]
v_smfmac_f32_16x16x64_bf16 a[224:227], a[232:235], v[48:55], v9
v_exp_f32 v42, v42
v_smfmac_f32_16x16x64_bf16 a[228:231], a[232:235], v[56:63], v9
s_waitcnt lgkmcnt(5)
v_exp_f32 v43, v43
v_mfma_f32_16x16x32_bf16 v[16:19], a[0:3], a[160:163], v[80:83]
ds_read_b128 a[36:39], v2 offset:1024
v_cvt_pk_bf16_f32 v75, v42, v43
v_mfma_f32_16x16x32_bf16 v[16:19], a[4:7], a[164:167], v[16:19]
v_exp_f32 v44, v44
v_mfma_f32_16x16x32_bf16 v[16:19], a[8:11], a[168:171], v[16:19]
v_mfma_f32_16x16x32_bf16 v[16:19], a[12:15], a[172:175], v[16:19]
v_exp_f32 v45, v45
v_mfma_f32_16x16x32_bf16 v[20:23], a[0:3], a[176:179], v[84:87]
ds_read_b128 a[40:43], v2 offset:2048
v_cvt_pk_bf16_f32 v78, v44, v45
v_mfma_f32_16x16x32_bf16 v[20:23], a[4:7], a[180:183], v[20:23]
buffer_load_dwordx4 v3, s[48:51], s32 offen offset:2048 sc1 lds
v_mfma_f32_16x16x32_bf16 v[20:23], a[8:11], a[184:187], v[20:23]
v_exp_f32 v46, v46
v_mfma_f32_16x16x32_bf16 v[20:23], a[12:15], a[188:191], v[20:23]
ds_read_b128 a[44:47], v2 offset:3072
v_mfma_f32_16x16x32_bf16 v[24:27], a[0:3], a[192:195], v[88:91]
v_mfma_f32_16x16x32_bf16 v[24:27], a[4:7], a[196:199], v[24:27]
v_exp_f32 v47, v47
v_mfma_f32_16x16x32_bf16 v[24:27], a[8:11], a[200:203], v[24:27]
v_exp_f32 v16, v16
v_mfma_f32_16x16x32_bf16 v[24:27], a[12:15], a[204:207], v[24:27]
ds_read_b128 a[48:51], v2 offset:4096
v_cvt_pk_bf16_f32 v79, v46, v47
v_mfma_f32_16x16x32_bf16 v[28:31], a[0:3], a[208:211], v[92:95]
v_mfma_f32_16x16x32_bf16 v[28:31], a[4:7], a[212:215], v[28:31]
v_exp_f32 v17, v17
v_mfma_f32_16x16x32_bf16 v[28:31], a[8:11], a[216:219], v[28:31]
s_waitcnt lgkmcnt(5)
v_exp_f32 v18, v18
v_mfma_f32_16x16x32_bf16 v[28:31], a[12:15], a[220:223], v[28:31]
ds_read_b128 a[52:55], v2 offset:5120
v_cvt_pk_bf16_f32 v48, v16, v17
v_mfma_f32_16x16x32_bf16 v[32:35], a[16:19], a[160:163], v[80:83]
v_mfma_f32_16x16x32_bf16 v[32:35], a[20:23], a[164:167], v[32:35]
v_exp_f32 v19, v19
v_mfma_f32_16x16x32_bf16 v[32:35], a[24:27], a[168:171], v[32:35]
v_exp_f32 v20, v20
v_mfma_f32_16x16x32_bf16 v[32:35], a[28:31], a[172:175], v[32:35]
ds_read_b128 a[56:59], v2 offset:6144
v_cvt_pk_bf16_f32 v49, v18, v19
v_mfma_f32_16x16x32_bf16 v[36:39], a[16:19], a[176:179], v[84:87]
v_exp_f32 v21, v21
v_mfma_f32_16x16x32_bf16 v[36:39], a[20:23], a[180:183], v[36:39]
buffer_load_dwordx4 v3, s[48:51], s32 offen offset:3072 sc1 lds
v_mfma_f32_16x16x32_bf16 v[36:39], a[24:27], a[184:187], v[36:39]
s_add_u32 s32, s32, 0x8000
v_cvt_pk_bf16_f32 v52, v20, v21
v_mfma_f32_16x16x32_bf16 v[36:39], a[28:31], a[188:191], v[36:39]
ds_read_b128 a[60:63], v2 offset:7168
v_mfma_f32_16x16x32_bf16 v[40:43], a[16:19], a[192:195], v[88:91]
v_exp_f32 v22, v22
v_mfma_f32_16x16x32_bf16 v[40:43], a[20:23], a[196:199], v[40:43]
v_exp_f32 v23, v23
v_mfma_f32_16x16x32_bf16 v[40:43], a[24:27], a[200:203], v[40:43]
v_cvt_pk_bf16_f32 v53, v22, v23
v_mfma_f32_16x16x32_bf16 v[40:43], a[28:31], a[204:207], v[40:43]
v_exp_f32 v24, v24
v_mfma_f32_16x16x32_bf16 v[44:47], a[16:19], a[208:211], v[92:95]
v_exp_f32 v25, v25
v_mfma_f32_16x16x32_bf16 v[44:47], a[20:23], a[212:215], v[44:47]
v_exp_f32 v26, v26
v_mfma_f32_16x16x32_bf16 v[44:47], a[24:27], a[216:219], v[44:47]
v_exp_f32 v27, v27
v_mfma_f32_16x16x32_bf16 v[44:47], a[28:31], a[220:223], v[44:47]
s_waitcnt lgkmcnt(0)
v_mfma_f32_16x16x32_bf16 v[128:131], a[32:35], v[64:67], v[128:131]
ds_read_b128 a[0:3], v2 offset:24576
v_cvt_pk_bf16_f32 v56, v24, v25
v_mfma_f32_16x16x32_bf16 v[160:163], a[32:35], v[68:71], v[160:163]
v_exp_f32 v28, v28
v_mfma_f32_16x16x32_bf16 v[192:195], a[32:35], v[72:75], v[192:195]
v_cvt_pk_bf16_f32 v57, v26, v27
v_mfma_f32_16x16x32_bf16 v[224:227], a[32:35], v[76:79], v[224:227]
ds_read_b128 a[4:7], v2 offset:25600
v_mfma_f32_16x16x32_bf16 v[228:231], a[36:39], v[76:79], v[228:231]
v_exp_f32 v29, v29
v_mfma_f32_16x16x32_bf16 v[196:199], a[36:39], v[72:75], v[196:199]
v_exp_f32 v30, v30
v_mfma_f32_16x16x32_bf16 v[164:167], a[36:39], v[68:71], v[164:167]
s_add_u32 m0, s19, 0x1000
v_cvt_pk_bf16_f32 v60, v28, v29
v_mfma_f32_16x16x32_bf16 v[132:135], a[36:39], v[64:67], v[132:135]
buffer_load_dwordx4 v3, s[48:51], s7 offen offset:0 sc1 lds
v_mfma_f32_16x16x32_bf16 v[136:139], a[40:43], v[64:67], v[136:139]
ds_read_b128 a[8:11], v2 offset:26624
v_mfma_f32_16x16x32_bf16 v[168:171], a[40:43], v[68:71], v[168:171]
v_exp_f32 v31, v31
v_mfma_f32_16x16x32_bf16 v[200:203], a[40:43], v[72:75], v[200:203]
v_exp_f32 v32, v32
v_mfma_f32_16x16x32_bf16 v[232:235], a[40:43], v[76:79], v[232:235]
ds_read_b128 a[12:15], v2 offset:27648
v_cvt_pk_bf16_f32 v61, v30, v31
v_mfma_f32_16x16x32_bf16 v[236:239], a[44:47], v[76:79], v[236:239]
v_mfma_f32_16x16x32_bf16 v[204:207], a[44:47], v[72:75], v[204:207]
v_exp_f32 v33, v33
v_mfma_f32_16x16x32_bf16 v[172:175], a[44:47], v[68:71], v[172:175]
v_exp_f32 v34, v34
v_mfma_f32_16x16x32_bf16 v[140:143], a[44:47], v[64:67], v[140:143]
ds_read_b128 a[16:19], v2 offset:28672
v_cvt_pk_bf16_f32 v50, v32, v33
v_mfma_f32_16x16x32_bf16 v[144:147], a[48:51], v[64:67], v[144:147]
v_exp_f32 v35, v35
v_mfma_f32_16x16x32_bf16 v[176:179], a[48:51], v[68:71], v[176:179]
v_cvt_pk_bf16_f32 v51, v34, v35
v_mfma_f32_16x16x32_bf16 v[208:211], a[48:51], v[72:75], v[208:211]
ds_read_b128 a[20:23], v2 offset:29696
v_mfma_f32_16x16x32_bf16 v[240:243], a[48:51], v[76:79], v[240:243]
v_exp_f32 v36, v36
v_mfma_f32_16x16x32_bf16 v[244:247], a[52:55], v[76:79], v[244:247]
v_exp_f32 v37, v37
v_mfma_f32_16x16x32_bf16 v[212:215], a[52:55], v[72:75], v[212:215]
v_cvt_pk_bf16_f32 v54, v36, v37
v_mfma_f32_16x16x32_bf16 v[180:183], a[52:55], v[68:71], v[180:183]
buffer_load_dwordx4 v3, s[48:51], s7 offen offset:1024 sc1 lds
v_mfma_f32_16x16x32_bf16 v[148:151], a[52:55], v[64:67], v[148:151]
ds_read_b128 a[24:27], v2 offset:30720
v_mfma_f32_16x16x32_bf16 v[152:155], a[56:59], v[64:67], v[152:155]
v_exp_f32 v38, v38
v_mfma_f32_16x16x32_bf16 v[184:187], a[56:59], v[68:71], v[184:187]
v_exp_f32 v39, v39
v_mfma_f32_16x16x32_bf16 v[216:219], a[56:59], v[72:75], v[216:219]
ds_read_b128 a[28:31], v2 offset:31744
v_cvt_pk_bf16_f32 v55, v38, v39
v_mfma_f32_16x16x32_bf16 v[248:251], a[56:59], v[76:79], v[248:251]
v_exp_f32 v40, v40
v_mfma_f32_16x16x32_bf16 v[252:255], a[60:63], v[76:79], v[252:255]
v_mfma_f32_16x16x32_bf16 v[220:223], a[60:63], v[72:75], v[220:223]
v_exp_f32 v41, v41
v_mfma_f32_16x16x32_bf16 v[188:191], a[60:63], v[68:71], v[188:191]
ds_read_b128 a[32:35], v2 offset:16384
v_cvt_pk_bf16_f32 v58, v40, v41
v_mfma_f32_16x16x32_bf16 v[156:159], a[60:63], v[64:67], v[156:159]
v_exp_f32 v42, v42
v_smfmac_f32_16x16x64_bf16 a[224:227], a[232:235], v[64:71], v9
s_waitcnt lgkmcnt(5)
v_smfmac_f32_16x16x64_bf16 a[228:231], a[232:235], v[72:79], v9
ds_read_b128 a[36:39], v2 offset:17408
v_mfma_f32_16x16x32_bf16 v[16:19], a[0:3], a[160:163], v[80:83]
v_exp_f32 v43, v43
v_mfma_f32_16x16x32_bf16 v[16:19], a[4:7], a[164:167], v[16:19]
v_exp_f32 v44, v44
v_mfma_f32_16x16x32_bf16 v[16:19], a[8:11], a[168:171], v[16:19]
buffer_load_dwordx4 v3, s[48:51], s7 offen offset:2048 sc1 lds
v_mfma_f32_16x16x32_bf16 v[16:19], a[12:15], a[172:175], v[16:19]
ds_read_b128 a[40:43], v2 offset:18432
v_cvt_pk_bf16_f32 v59, v42, v43
v_mfma_f32_16x16x32_bf16 v[20:23], a[0:3], a[176:179], v[84:87]
v_exp_f32 v45, v45
v_mfma_f32_16x16x32_bf16 v[20:23], a[4:7], a[180:183], v[20:23]
v_cvt_pk_bf16_f32 v62, v44, v45
v_mfma_f32_16x16x32_bf16 v[20:23], a[8:11], a[184:187], v[20:23]
v_exp_f32 v46, v46
v_mfma_f32_16x16x32_bf16 v[20:23], a[12:15], a[188:191], v[20:23]
ds_read_b128 a[44:47], v2 offset:19456
v_mfma_f32_16x16x32_bf16 v[24:27], a[0:3], a[192:195], v[88:91]
v_exp_f32 v47, v47
v_mfma_f32_16x16x32_bf16 v[24:27], a[4:7], a[196:199], v[24:27]
v_cvt_pk_bf16_f32 v63, v46, v47
v_mfma_f32_16x16x32_bf16 v[24:27], a[8:11], a[200:203], v[24:27]
v_exp_f32 v16, v16
v_mfma_f32_16x16x32_bf16 v[24:27], a[12:15], a[204:207], v[24:27]
ds_read_b128 a[48:51], v2 offset:20480
v_mfma_f32_16x16x32_bf16 v[28:31], a[0:3], a[208:211], v[92:95]
v_exp_f32 v17, v17
v_mfma_f32_16x16x32_bf16 v[28:31], a[4:7], a[212:215], v[28:31]
v_exp_f32 v18, v18
v_mfma_f32_16x16x32_bf16 v[28:31], a[8:11], a[216:219], v[28:31]
ds_read_b128 a[52:55], v2 offset:21504
v_cvt_pk_bf16_f32 v64, v16, v17
v_mfma_f32_16x16x32_bf16 v[28:31], a[12:15], a[220:223], v[28:31]
s_waitcnt lgkmcnt(6)
v_mfma_f32_16x16x32_bf16 v[32:35], a[16:19], a[160:163], v[80:83]
v_exp_f32 v19, v19
v_mfma_f32_16x16x32_bf16 v[32:35], a[20:23], a[164:167], v[32:35]
buffer_load_dwordx4 v3, s[48:51], s7 offen offset:3072 sc1 lds
v_mfma_f32_16x16x32_bf16 v[32:35], a[24:27], a[168:171], v[32:35]
ds_read_b128 a[56:59], v2 offset:22528
v_cvt_pk_bf16_f32 v65, v18, v19
v_mfma_f32_16x16x32_bf16 v[32:35], a[28:31], a[172:175], v[32:35]
s_add_u32 s7, s7, 0x8000
v_exp_f32 v20, v20
v_mfma_f32_16x16x32_bf16 v[36:39], a[16:19], a[176:179], v[84:87]
s_xor_b32 s19, s19, 0x8000
v_mfma_f32_16x16x32_bf16 v[36:39], a[20:23], a[180:183], v[36:39]
s_sub_u32 s15, s15, 1
v_exp_f32 v21, v21
v_mfma_f32_16x16x32_bf16 v[36:39], a[24:27], a[184:187], v[36:39]
ds_read_b128 a[60:63], v2 offset:23552
v_xor_b32 v2, 0x38000, v2
v_mfma_f32_16x16x32_bf16 v[36:39], a[28:31], a[188:191], v[36:39]
s_cmp_lg_u32 s15, 0
v_exp_f32 v22, v22
v_mfma_f32_16x16x32_bf16 v[40:43], a[16:19], a[192:195], v[88:91]
v_exp_f32 v23, v23
v_mfma_f32_16x16x32_bf16 v[40:43], a[20:23], a[196:199], v[40:43]
v_cvt_pk_bf16_f32 v68, v20, v21
v_cvt_pk_bf16_f32 v69, v22, v23
v_mfma_f32_16x16x32_bf16 v[40:43], a[24:27], a[200:203], v[40:43]
v_exp_f32 v24, v24
v_mfma_f32_16x16x32_bf16 v[40:43], a[28:31], a[204:207], v[40:43]
v_exp_f32 v25, v25
v_mfma_f32_16x16x32_bf16 v[44:47], a[16:19], a[208:211], v[92:95]
v_exp_f32 v26, v26
v_mfma_f32_16x16x32_bf16 v[44:47], a[20:23], a[212:215], v[44:47]
v_exp_f32 v27, v27
v_mfma_f32_16x16x32_bf16 v[44:47], a[24:27], a[216:219], v[44:47]
s_waitcnt vmcnt(16) lgkmcnt(0)
v_mfma_f32_16x16x32_bf16 v[44:47], a[28:31], a[220:223], v[44:47]
s_barrier
s_cbranch_scc1 L_att_deven0
s_branch L_att_ddone
L_att_deven1:
v_mfma_f32_16x16x32_bf16 v[128:131], a[32:35], v[48:51], v[128:131]
ds_read_b128 a[0:3], v1 offset:8192
v_cvt_pk_bf16_f32 v72, v24, v25
v_mfma_f32_16x16x32_bf16 v[160:163], a[32:35], v[52:55], v[160:163]
v_exp_f32 v28, v28
v_mfma_f32_16x16x32_bf16 v[192:195], a[32:35], v[56:59], v[192:195]
v_cvt_pk_bf16_f32 v73, v26, v27
v_mfma_f32_16x16x32_bf16 v[224:227], a[32:35], v[60:63], v[224:227]
ds_read_b128 a[4:7], v1 offset:9216
v_mfma_f32_16x16x32_bf16 v[228:231], a[36:39], v[60:63], v[228:231]
v_exp_f32 v29, v29
v_mfma_f32_16x16x32_bf16 v[196:199], a[36:39], v[56:59], v[196:199]
v_exp_f32 v30, v30
v_mfma_f32_16x16x32_bf16 v[164:167], a[36:39], v[52:55], v[164:167]
s_add_u32 m0, s27, 0x0
v_cvt_pk_bf16_f32 v76, v28, v29
v_mfma_f32_16x16x32_bf16 v[132:135], a[36:39], v[48:51], v[132:135]
buffer_load_dwordx4 v3, s[48:51], s32 offen offset:0 sc1 lds
v_mfma_f32_16x16x32_bf16 v[136:139], a[40:43], v[48:51], v[136:139]
ds_read_b128 a[8:11], v1 offset:10240
v_mfma_f32_16x16x32_bf16 v[168:171], a[40:43], v[52:55], v[168:171]
v_exp_f32 v31, v31
v_mfma_f32_16x16x32_bf16 v[200:203], a[40:43], v[56:59], v[200:203]
v_exp_f32 v32, v32
v_mfma_f32_16x16x32_bf16 v[232:235], a[40:43], v[60:63], v[232:235]
ds_read_b128 a[12:15], v1 offset:11264
v_cvt_pk_bf16_f32 v77, v30, v31
v_mfma_f32_16x16x32_bf16 v[236:239], a[44:47], v[60:63], v[236:239]
v_mfma_f32_16x16x32_bf16 v[204:207], a[44:47], v[56:59], v[204:207]
v_exp_f32 v33, v33
v_mfma_f32_16x16x32_bf16 v[172:175], a[44:47], v[52:55], v[172:175]
v_exp_f32 v34, v34
v_mfma_f32_16x16x32_bf16 v[140:143], a[44:47], v[48:51], v[140:143]
ds_read_b128 a[16:19], v1 offset:12288
v_cvt_pk_bf16_f32 v66, v32, v33
v_mfma_f32_16x16x32_bf16 v[144:147], a[48:51], v[48:51], v[144:147]
v_mfma_f32_16x16x32_bf16 v[176:179], a[48:51], v[52:55], v[176:179]
v_exp_f32 v35, v35
v_mfma_f32_16x16x32_bf16 v[208:211], a[48:51], v[56:59], v[208:211]
v_exp_f32 v36, v36
v_mfma_f32_16x16x32_bf16 v[240:243], a[48:51], v[60:63], v[240:243]
ds_read_b128 a[20:23], v1 offset:13312
v_cvt_pk_bf16_f32 v67, v34, v35
v_mfma_f32_16x16x32_bf16 v[244:247], a[52:55], v[60:63], v[244:247]
v_exp_f32 v37, v37
v_mfma_f32_16x16x32_bf16 v[212:215], a[52:55], v[56:59], v[212:215]
v_cvt_pk_bf16_f32 v70, v36, v37
v_mfma_f32_16x16x32_bf16 v[180:183], a[52:55], v[52:55], v[180:183]
ds_read_b128 a[24:27], v1 offset:14336
v_mfma_f32_16x16x32_bf16 v[148:151], a[52:55], v[48:51], v[148:151]
buffer_load_dwordx4 v3, s[48:51], s32 offen offset:1024 sc1 lds
v_mfma_f32_16x16x32_bf16 v[152:155], a[56:59], v[48:51], v[152:155]
v_exp_f32 v38, v38
v_mfma_f32_16x16x32_bf16 v[184:187], a[56:59], v[52:55], v[184:187]
v_exp_f32 v39, v39
v_mfma_f32_16x16x32_bf16 v[216:219], a[56:59], v[56:59], v[216:219]
ds_read_b128 a[28:31], v1 offset:15360
v_cvt_pk_bf16_f32 v71, v38, v39
v_mfma_f32_16x16x32_bf16 v[248:251], a[56:59], v[60:63], v[248:251]
v_mfma_f32_16x16x32_bf16 v[252:255], a[60:63], v[60:63], v[252:255]
v_exp_f32 v40, v40
v_mfma_f32_16x16x32_bf16 v[220:223], a[60:63], v[56:59], v[220:223]
v_exp_f32 v41, v41
v_mfma_f32_16x16x32_bf16 v[188:191], a[60:63], v[52:55], v[188:191]
ds_read_b128 a[32:35], v1 offset:0
v_cvt_pk_bf16_f32 v74, v40, v41
v_mfma_f32_16x16x32_bf16 v[156:159], a[60:63], v[48:51], v[156:159]
v_smfmac_f32_16x16x64_bf16 a[224:227], a[232:235], v[48:55], v9
v_exp_f32 v42, v42
v_smfmac_f32_16x16x64_bf16 a[228:231], a[232:235], v[56:63], v9
s_waitcnt lgkmcnt(5)
v_exp_f32 v43, v43
v_mfma_f32_16x16x32_bf16 v[16:19], a[0:3], a[160:163], v[80:83]
ds_read_b128 a[36:39], v1 offset:1024
v_cvt_pk_bf16_f32 v75, v42, v43
v_mfma_f32_16x16x32_bf16 v[16:19], a[4:7], a[164:167], v[16:19]
v_exp_f32 v44, v44
v_mfma_f32_16x16x32_bf16 v[16:19], a[8:11], a[168:171], v[16:19]
v_mfma_f32_16x16x32_bf16 v[16:19], a[12:15], a[172:175], v[16:19]
v_exp_f32 v45, v45
v_mfma_f32_16x16x32_bf16 v[20:23], a[0:3], a[176:179], v[84:87]
ds_read_b128 a[40:43], v1 offset:2048
v_cvt_pk_bf16_f32 v78, v44, v45
v_mfma_f32_16x16x32_bf16 v[20:23], a[4:7], a[180:183], v[20:23]
buffer_load_dwordx4 v3, s[48:51], s32 offen offset:2048 sc1 lds
v_mfma_f32_16x16x32_bf16 v[20:23], a[8:11], a[184:187], v[20:23]
v_exp_f32 v46, v46
v_mfma_f32_16x16x32_bf16 v[20:23], a[12:15], a[188:191], v[20:23]
ds_read_b128 a[44:47], v1 offset:3072
v_mfma_f32_16x16x32_bf16 v[24:27], a[0:3], a[192:195], v[88:91]
v_mfma_f32_16x16x32_bf16 v[24:27], a[4:7], a[196:199], v[24:27]
v_exp_f32 v47, v47
v_mfma_f32_16x16x32_bf16 v[24:27], a[8:11], a[200:203], v[24:27]
v_exp_f32 v16, v16
v_mfma_f32_16x16x32_bf16 v[24:27], a[12:15], a[204:207], v[24:27]
ds_read_b128 a[48:51], v1 offset:4096
v_cvt_pk_bf16_f32 v79, v46, v47
v_mfma_f32_16x16x32_bf16 v[28:31], a[0:3], a[208:211], v[92:95]
v_mfma_f32_16x16x32_bf16 v[28:31], a[4:7], a[212:215], v[28:31]
v_exp_f32 v17, v17
v_mfma_f32_16x16x32_bf16 v[28:31], a[8:11], a[216:219], v[28:31]
s_waitcnt lgkmcnt(5)
v_exp_f32 v18, v18
v_mfma_f32_16x16x32_bf16 v[28:31], a[12:15], a[220:223], v[28:31]
ds_read_b128 a[52:55], v1 offset:5120
v_cvt_pk_bf16_f32 v48, v16, v17
v_mfma_f32_16x16x32_bf16 v[32:35], a[16:19], a[160:163], v[80:83]
v_mfma_f32_16x16x32_bf16 v[32:35], a[20:23], a[164:167], v[32:35]
v_exp_f32 v19, v19
v_mfma_f32_16x16x32_bf16 v[32:35], a[24:27], a[168:171], v[32:35]
v_exp_f32 v20, v20
v_mfma_f32_16x16x32_bf16 v[32:35], a[28:31], a[172:175], v[32:35]
ds_read_b128 a[56:59], v1 offset:6144
v_cvt_pk_bf16_f32 v49, v18, v19
v_mfma_f32_16x16x32_bf16 v[36:39], a[16:19], a[176:179], v[84:87]
v_exp_f32 v21, v21
v_mfma_f32_16x16x32_bf16 v[36:39], a[20:23], a[180:183], v[36:39]
buffer_load_dwordx4 v3, s[48:51], s32 offen offset:3072 sc1 lds
v_mfma_f32_16x16x32_bf16 v[36:39], a[24:27], a[184:187], v[36:39]
s_add_u32 s32, s32, 0x8000
v_cvt_pk_bf16_f32 v52, v20, v21
v_mfma_f32_16x16x32_bf16 v[36:39], a[28:31], a[188:191], v[36:39]
ds_read_b128 a[60:63], v1 offset:7168
v_mfma_f32_16x16x32_bf16 v[40:43], a[16:19], a[192:195], v[88:91]
v_exp_f32 v22, v22
v_mfma_f32_16x16x32_bf16 v[40:43], a[20:23], a[196:199], v[40:43]
v_exp_f32 v23, v23
v_mfma_f32_16x16x32_bf16 v[40:43], a[24:27], a[200:203], v[40:43]
v_cvt_pk_bf16_f32 v53, v22, v23
v_mfma_f32_16x16x32_bf16 v[40:43], a[28:31], a[204:207], v[40:43]
v_exp_f32 v24, v24
v_mfma_f32_16x16x32_bf16 v[44:47], a[16:19], a[208:211], v[92:95]
v_exp_f32 v25, v25
v_mfma_f32_16x16x32_bf16 v[44:47], a[20:23], a[212:215], v[44:47]
v_exp_f32 v26, v26
v_mfma_f32_16x16x32_bf16 v[44:47], a[24:27], a[216:219], v[44:47]
v_exp_f32 v27, v27
v_mfma_f32_16x16x32_bf16 v[44:47], a[28:31], a[220:223], v[44:47]
s_waitcnt lgkmcnt(0)
v_mfma_f32_16x16x32_bf16 v[128:131], a[32:35], v[64:67], v[128:131]
ds_read_b128 a[0:3], v1 offset:24576
v_cvt_pk_bf16_f32 v56, v24, v25
v_mfma_f32_16x16x32_bf16 v[160:163], a[32:35], v[68:71], v[160:163]
v_exp_f32 v28, v28
v_mfma_f32_16x16x32_bf16 v[192:195], a[32:35], v[72:75], v[192:195]
v_cvt_pk_bf16_f32 v57, v26, v27
v_mfma_f32_16x16x32_bf16 v[224:227], a[32:35], v[76:79], v[224:227]
ds_read_b128 a[4:7], v1 offset:25600
v_mfma_f32_16x16x32_bf16 v[228:231], a[36:39], v[76:79], v[228:231]
v_exp_f32 v29, v29
v_mfma_f32_16x16x32_bf16 v[196:199], a[36:39], v[72:75], v[196:199]
v_exp_f32 v30, v30
v_mfma_f32_16x16x32_bf16 v[164:167], a[36:39], v[68:71], v[164:167]
s_add_u32 m0, s27, 0x1000
v_cvt_pk_bf16_f32 v60, v28, v29
v_mfma_f32_16x16x32_bf16 v[132:135], a[36:39], v[64:67], v[132:135]
buffer_load_dwordx4 v3, s[48:51], s7 offen offset:0 sc1 lds
v_mfma_f32_16x16x32_bf16 v[136:139], a[40:43], v[64:67], v[136:139]
ds_read_b128 a[8:11], v1 offset:26624
v_mfma_f32_16x16x32_bf16 v[168:171], a[40:43], v[68:71], v[168:171]
v_exp_f32 v31, v31
v_mfma_f32_16x16x32_bf16 v[200:203], a[40:43], v[72:75], v[200:203]
v_exp_f32 v32, v32
v_mfma_f32_16x16x32_bf16 v[232:235], a[40:43], v[76:79], v[232:235]
ds_read_b128 a[12:15], v1 offset:27648
v_cvt_pk_bf16_f32 v61, v30, v31
v_mfma_f32_16x16x32_bf16 v[236:239], a[44:47], v[76:79], v[236:239]
v_mfma_f32_16x16x32_bf16 v[204:207], a[44:47], v[72:75], v[204:207]
v_exp_f32 v33, v33
v_mfma_f32_16x16x32_bf16 v[172:175], a[44:47], v[68:71], v[172:175]
v_exp_f32 v34, v34
v_mfma_f32_16x16x32_bf16 v[140:143], a[44:47], v[64:67], v[140:143]
ds_read_b128 a[16:19], v1 offset:28672
v_cvt_pk_bf16_f32 v50, v32, v33
v_mfma_f32_16x16x32_bf16 v[144:147], a[48:51], v[64:67], v[144:147]
v_mfma_f32_16x16x32_bf16 v[176:179], a[48:51], v[68:71], v[176:179]
v_exp_f32 v35, v35
v_mfma_f32_16x16x32_bf16 v[208:211], a[48:51], v[72:75], v[208:211]
ds_read_b128 a[20:23], v1 offset:29696
v_cvt_pk_bf16_f32 v51, v34, v35
v_mfma_f32_16x16x32_bf16 v[240:243], a[48:51], v[76:79], v[240:243]
v_exp_f32 v36, v36
v_mfma_f32_16x16x32_bf16 v[244:247], a[52:55], v[76:79], v[244:247]
v_exp_f32 v37, v37
v_mfma_f32_16x16x32_bf16 v[212:215], a[52:55], v[72:75], v[212:215]
v_cvt_pk_bf16_f32 v54, v36, v37
v_mfma_f32_16x16x32_bf16 v[180:183], a[52:55], v[68:71], v[180:183]
buffer_load_dwordx4 v3, s[48:51], s7 offen offset:1024 sc1 lds
v_mfma_f32_16x16x32_bf16 v[148:151], a[52:55], v[64:67], v[148:151]
ds_read_b128 a[24:27], v1 offset:30720
v_mfma_f32_16x16x32_bf16 v[152:155], a[56:59], v[64:67], v[152:155]
v_exp_f32 v38, v38
v_mfma_f32_16x16x32_bf16 v[184:187], a[56:59], v[68:71], v[184:187]
v_exp_f32 v39, v39
v_mfma_f32_16x16x32_bf16 v[216:219], a[56:59], v[72:75], v[216:219]
ds_read_b128 a[28:31], v1 offset:31744
v_cvt_pk_bf16_f32 v55, v38, v39
v_mfma_f32_16x16x32_bf16 v[248:251], a[56:59], v[76:79], v[248:251]
v_mfma_f32_16x16x32_bf16 v[252:255], a[60:63], v[76:79], v[252:255]
v_exp_f32 v40, v40
v_mfma_f32_16x16x32_bf16 v[220:223], a[60:63], v[72:75], v[220:223]
v_exp_f32 v41, v41
v_mfma_f32_16x16x32_bf16 v[188:191], a[60:63], v[68:71], v[188:191]
ds_read_b128 a[32:35], v1 offset:16384
v_cvt_pk_bf16_f32 v58, v40, v41
v_mfma_f32_16x16x32_bf16 v[156:159], a[60:63], v[64:67], v[156:159]
v_smfmac_f32_16x16x64_bf16 a[224:227], a[232:235], v[64:71], v9
s_waitcnt lgkmcnt(5)
v_exp_f32 v42, v42
v_smfmac_f32_16x16x64_bf16 a[228:231], a[232:235], v[72:79], v9
ds_read_b128 a[36:39], v1 offset:17408
v_mfma_f32_16x16x32_bf16 v[16:19], a[0:3], a[160:163], v[80:83]
v_exp_f32 v43, v43
v_mfma_f32_16x16x32_bf16 v[16:19], a[4:7], a[164:167], v[16:19]
v_exp_f32 v44, v44
v_mfma_f32_16x16x32_bf16 v[16:19], a[8:11], a[168:171], v[16:19]
v_cvt_pk_bf16_f32 v59, v42, v43
v_mfma_f32_16x16x32_bf16 v[16:19], a[12:15], a[172:175], v[16:19]
ds_read_b128 a[40:43], v1 offset:18432
v_mfma_f32_16x16x32_bf16 v[20:23], a[0:3], a[176:179], v[84:87]
buffer_load_dwordx4 v3, s[48:51], s7 offen offset:2048 sc1 lds
v_mfma_f32_16x16x32_bf16 v[20:23], a[4:7], a[180:183], v[20:23]
v_exp_f32 v45, v45
v_mfma_f32_16x16x32_bf16 v[20:23], a[8:11], a[184:187], v[20:23]
v_exp_f32 v46, v46
v_mfma_f32_16x16x32_bf16 v[20:23], a[12:15], a[188:191], v[20:23]
ds_read_b128 a[44:47], v1 offset:19456
v_cvt_pk_bf16_f32 v62, v44, v45
v_mfma_f32_16x16x32_bf16 v[24:27], a[0:3], a[192:195], v[88:91]
v_mfma_f32_16x16x32_bf16 v[24:27], a[4:7], a[196:199], v[24:27]
v_exp_f32 v47, v47
v_mfma_f32_16x16x32_bf16 v[24:27], a[8:11], a[200:203], v[24:27]
v_exp_f32 v16, v16
v_mfma_f32_16x16x32_bf16 v[24:27], a[12:15], a[204:207], v[24:27]
ds_read_b128 a[48:51], v1 offset:20480
v_cvt_pk_bf16_f32 v63, v46, v47
v_mfma_f32_16x16x32_bf16 v[28:31], a[0:3], a[208:211], v[92:95]
v_mfma_f32_16x16x32_bf16 v[28:31], a[4:7], a[212:215], v[28:31]
v_exp_f32 v17, v17
v_mfma_f32_16x16x32_bf16 v[28:31], a[8:11], a[216:219], v[28:31]
ds_read_b128 a[52:55], v1 offset:21504
v_cvt_pk_bf16_f32 v64, v16, v17
v_mfma_f32_16x16x32_bf16 v[28:31], a[12:15], a[220:223], v[28:31]
s_waitcnt lgkmcnt(6)
v_exp_f32 v18, v18
v_mfma_f32_16x16x32_bf16 v[32:35], a[16:19], a[160:163], v[80:83]
v_mfma_f32_16x16x32_bf16 v[32:35], a[20:23], a[164:167], v[32:35]
v_exp_f32 v19, v19
v_mfma_f32_16x16x32_bf16 v[32:35], a[24:27], a[168:171], v[32:35]
ds_read_b128 a[56:59], v1 offset:22528
v_cvt_pk_bf16_f32 v65, v18, v19
v_mfma_f32_16x16x32_bf16 v[32:35], a[28:31], a[172:175], v[32:35]
buffer_load_dwordx4 v3, s[48:51], s7 offen offset:3072 sc1 lds
v_mfma_f32_16x16x32_bf16 v[36:39], a[16:19], a[176:179], v[84:87]
s_add_u32 s7, s7, 0x8000
v_exp_f32 v20, v20
v_mfma_f32_16x16x32_bf16 v[36:39], a[20:23], a[180:183], v[36:39]
s_xor_b32 s27, s27, 0x38000
v_exp_f32 v21, v21
v_mfma_f32_16x16x32_bf16 v[36:39], a[24:27], a[184:187], v[36:39]
ds_read_b128 a[60:63], v1 offset:23552
v_xor_b32 v1, 0x8000, v1
v_mfma_f32_16x16x32_bf16 v[36:39], a[28:31], a[188:191], v[36:39]
v_cvt_pk_bf16_f32 v68, v20, v21
v_mfma_f32_16x16x32_bf16 v[40:43], a[16:19], a[192:195], v[88:91]
v_exp_f32 v22, v22
v_mfma_f32_16x16x32_bf16 v[40:43], a[20:23], a[196:199], v[40:43]
v_exp_f32 v23, v23
v_mfma_f32_16x16x32_bf16 v[40:43], a[24:27], a[200:203], v[40:43]
v_cvt_pk_bf16_f32 v69, v22, v23
v_mfma_f32_16x16x32_bf16 v[40:43], a[28:31], a[204:207], v[40:43]
v_exp_f32 v24, v24
v_mfma_f32_16x16x32_bf16 v[44:47], a[16:19], a[208:211], v[92:95]
s_waitcnt vmcnt(16) lgkmcnt(0)
v_exp_f32 v25, v25
v_mfma_f32_16x16x32_bf16 v[44:47], a[20:23], a[212:215], v[44:47]
s_barrier
v_exp_f32 v26, v26
v_mfma_f32_16x16x32_bf16 v[44:47], a[24:27], a[216:219], v[44:47]
v_exp_f32 v27, v27
v_mfma_f32_16x16x32_bf16 v[44:47], a[28:31], a[220:223], v[44:47]
L_att_dodd1:
v_mfma_f32_16x16x32_bf16 v[128:131], a[32:35], v[48:51], v[128:131]
ds_read_b128 a[0:3], v2 offset:8192
v_cvt_pk_bf16_f32 v72, v24, v25
v_mfma_f32_16x16x32_bf16 v[160:163], a[32:35], v[52:55], v[160:163]
v_exp_f32 v28, v28
v_mfma_f32_16x16x32_bf16 v[192:195], a[32:35], v[56:59], v[192:195]
v_cvt_pk_bf16_f32 v73, v26, v27
v_mfma_f32_16x16x32_bf16 v[224:227], a[32:35], v[60:63], v[224:227]
ds_read_b128 a[4:7], v2 offset:9216
v_mfma_f32_16x16x32_bf16 v[228:231], a[36:39], v[60:63], v[228:231]
v_exp_f32 v29, v29
v_mfma_f32_16x16x32_bf16 v[196:199], a[36:39], v[56:59], v[196:199]
v_exp_f32 v30, v30
v_mfma_f32_16x16x32_bf16 v[164:167], a[36:39], v[52:55], v[164:167]
s_add_u32 m0, s19, 0x0
v_cvt_pk_bf16_f32 v76, v28, v29
v_mfma_f32_16x16x32_bf16 v[132:135], a[36:39], v[48:51], v[132:135]
buffer_load_dwordx4 v3, s[48:51], s32 offen offset:0 sc1 lds
v_mfma_f32_16x16x32_bf16 v[136:139], a[40:43], v[48:51], v[136:139]
ds_read_b128 a[8:11], v2 offset:10240
v_mfma_f32_16x16x32_bf16 v[168:171], a[40:43], v[52:55], v[168:171]
v_exp_f32 v31, v31
v_mfma_f32_16x16x32_bf16 v[200:203], a[40:43], v[56:59], v[200:203]
v_exp_f32 v32, v32
v_mfma_f32_16x16x32_bf16 v[232:235], a[40:43], v[60:63], v[232:235]
ds_read_b128 a[12:15], v2 offset:11264
v_cvt_pk_bf16_f32 v77, v30, v31
v_mfma_f32_16x16x32_bf16 v[236:239], a[44:47], v[60:63], v[236:239]
v_mfma_f32_16x16x32_bf16 v[204:207], a[44:47], v[56:59], v[204:207]
v_exp_f32 v33, v33
v_mfma_f32_16x16x32_bf16 v[172:175], a[44:47], v[52:55], v[172:175]
v_exp_f32 v34, v34
v_mfma_f32_16x16x32_bf16 v[140:143], a[44:47], v[48:51], v[140:143]
ds_read_b128 a[16:19], v2 offset:12288
v_cvt_pk_bf16_f32 v66, v32, v33
v_mfma_f32_16x16x32_bf16 v[144:147], a[48:51], v[48:51], v[144:147]
v_mfma_f32_16x16x32_bf16 v[176:179], a[48:51], v[52:55], v[176:179]
v_exp_f32 v35, v35
v_mfma_f32_16x16x32_bf16 v[208:211], a[48:51], v[56:59], v[208:211]
v_exp_f32 v36, v36
v_mfma_f32_16x16x32_bf16 v[240:243], a[48:51], v[60:63], v[240:243]
ds_read_b128 a[20:23], v2 offset:13312
v_cvt_pk_bf16_f32 v67, v34, v35
v_mfma_f32_16x16x32_bf16 v[244:247], a[52:55], v[60:63], v[244:247]
v_exp_f32 v37, v37
v_mfma_f32_16x16x32_bf16 v[212:215], a[52:55], v[56:59], v[212:215]
v_cvt_pk_bf16_f32 v70, v36, v37
v_mfma_f32_16x16x32_bf16 v[180:183], a[52:55], v[52:55], v[180:183]
ds_read_b128 a[24:27], v2 offset:14336
v_mfma_f32_16x16x32_bf16 v[148:151], a[52:55], v[48:51], v[148:151]
buffer_load_dwordx4 v3, s[48:51], s32 offen offset:1024 sc1 lds
v_mfma_f32_16x16x32_bf16 v[152:155], a[56:59], v[48:51], v[152:155]
v_exp_f32 v38, v38
v_mfma_f32_16x16x32_bf16 v[184:187], a[56:59], v[52:55], v[184:187]
v_exp_f32 v39, v39
v_mfma_f32_16x16x32_bf16 v[216:219], a[56:59], v[56:59], v[216:219]
ds_read_b128 a[28:31], v2 offset:15360
v_cvt_pk_bf16_f32 v71, v38, v39
v_mfma_f32_16x16x32_bf16 v[248:251], a[56:59], v[60:63], v[248:251]
v_mfma_f32_16x16x32_bf16 v[252:255], a[60:63], v[60:63], v[252:255]
v_exp_f32 v40, v40
v_mfma_f32_16x16x32_bf16 v[220:223], a[60:63], v[56:59], v[220:223]
v_exp_f32 v41, v41
v_mfma_f32_16x16x32_bf16 v[188:191], a[60:63], v[52:55], v[188:191]
ds_read_b128 a[32:35], v2 offset:0
v_cvt_pk_bf16_f32 v74, v40, v41
v_mfma_f32_16x16x32_bf16 v[156:159], a[60:63], v[48:51], v[156:159]
v_smfmac_f32_16x16x64_bf16 a[224:227], a[232:235], v[48:55], v9
v_exp_f32 v42, v42
v_smfmac_f32_16x16x64_bf16 a[228:231], a[232:235], v[56:63], v9
s_waitcnt lgkmcnt(5)
v_exp_f32 v43, v43
v_mfma_f32_16x16x32_bf16 v[16:19], a[0:3], a[160:163], v[80:83]
ds_read_b128 a[36:39], v2 offset:1024
v_cvt_pk_bf16_f32 v75, v42, v43
v_mfma_f32_16x16x32_bf16 v[16:19], a[4:7], a[164:167], v[16:19]
v_exp_f32 v44, v44
v_mfma_f32_16x16x32_bf16 v[16:19], a[8:11], a[168:171], v[16:19]
v_mfma_f32_16x16x32_bf16 v[16:19], a[12:15], a[172:175], v[16:19]
v_exp_f32 v45, v45
v_mfma_f32_16x16x32_bf16 v[20:23], a[0:3], a[176:179], v[84:87]
ds_read_b128 a[40:43], v2 offset:2048
v_cvt_pk_bf16_f32 v78, v44, v45
v_mfma_f32_16x16x32_bf16 v[20:23], a[4:7], a[180:183], v[20:23]
buffer_load_dwordx4 v3, s[48:51], s32 offen offset:2048 sc1 lds
v_mfma_f32_16x16x32_bf16 v[20:23], a[8:11], a[184:187], v[20:23]
v_exp_f32 v46, v46
v_mfma_f32_16x16x32_bf16 v[20:23], a[12:15], a[188:191], v[20:23]
ds_read_b128 a[44:47], v2 offset:3072
v_mfma_f32_16x16x32_bf16 v[24:27], a[0:3], a[192:195], v[88:91]
v_mfma_f32_16x16x32_bf16 v[24:27], a[4:7], a[196:199], v[24:27]
v_exp_f32 v47, v47
v_mfma_f32_16x16x32_bf16 v[24:27], a[8:11], a[200:203], v[24:27]
v_exp_f32 v16, v16
v_mfma_f32_16x16x32_bf16 v[24:27], a[12:15], a[204:207], v[24:27]
ds_read_b128 a[48:51], v2 offset:4096
v_cvt_pk_bf16_f32 v79, v46, v47
v_mfma_f32_16x16x32_bf16 v[28:31], a[0:3], a[208:211], v[92:95]
v_mfma_f32_16x16x32_bf16 v[28:31], a[4:7], a[212:215], v[28:31]
v_exp_f32 v17, v17
v_mfma_f32_16x16x32_bf16 v[28:31], a[8:11], a[216:219], v[28:31]
s_waitcnt lgkmcnt(5)
v_exp_f32 v18, v18
v_mfma_f32_16x16x32_bf16 v[28:31], a[12:15], a[220:223], v[28:31]
ds_read_b128 a[52:55], v2 offset:5120
v_cvt_pk_bf16_f32 v48, v16, v17
v_mfma_f32_16x16x32_bf16 v[32:35], a[16:19], a[160:163], v[80:83]
v_mfma_f32_16x16x32_bf16 v[32:35], a[20:23], a[164:167], v[32:35]
v_exp_f32 v19, v19
v_mfma_f32_16x16x32_bf16 v[32:35], a[24:27], a[168:171], v[32:35]
v_exp_f32 v20, v20
v_mfma_f32_16x16x32_bf16 v[32:35], a[28:31], a[172:175], v[32:35]
ds_read_b128 a[56:59], v2 offset:6144
v_cvt_pk_bf16_f32 v49, v18, v19
v_mfma_f32_16x16x32_bf16 v[36:39], a[16:19], a[176:179], v[84:87]
v_exp_f32 v21, v21
v_mfma_f32_16x16x32_bf16 v[36:39], a[20:23], a[180:183], v[36:39]
buffer_load_dwordx4 v3, s[48:51], s32 offen offset:3072 sc1 lds
v_mfma_f32_16x16x32_bf16 v[36:39], a[24:27], a[184:187], v[36:39]
s_add_u32 s32, s32, 0x8000
v_cvt_pk_bf16_f32 v52, v20, v21
v_mfma_f32_16x16x32_bf16 v[36:39], a[28:31], a[188:191], v[36:39]
ds_read_b128 a[60:63], v2 offset:7168
v_mfma_f32_16x16x32_bf16 v[40:43], a[16:19], a[192:195], v[88:91]
v_exp_f32 v22, v22
v_mfma_f32_16x16x32_bf16 v[40:43], a[20:23], a[196:199], v[40:43]
v_exp_f32 v23, v23
v_mfma_f32_16x16x32_bf16 v[40:43], a[24:27], a[200:203], v[40:43]
v_cvt_pk_bf16_f32 v53, v22, v23
v_mfma_f32_16x16x32_bf16 v[40:43], a[28:31], a[204:207], v[40:43]
v_exp_f32 v24, v24
v_mfma_f32_16x16x32_bf16 v[44:47], a[16:19], a[208:211], v[92:95]
v_exp_f32 v25, v25
v_mfma_f32_16x16x32_bf16 v[44:47], a[20:23], a[212:215], v[44:47]
v_exp_f32 v26, v26
v_mfma_f32_16x16x32_bf16 v[44:47], a[24:27], a[216:219], v[44:47]
v_exp_f32 v27, v27
v_mfma_f32_16x16x32_bf16 v[44:47], a[28:31], a[220:223], v[44:47]
s_waitcnt lgkmcnt(0)
v_mfma_f32_16x16x32_bf16 v[128:131], a[32:35], v[64:67], v[128:131]
ds_read_b128 a[0:3], v2 offset:24576
v_cvt_pk_bf16_f32 v56, v24, v25
v_mfma_f32_16x16x32_bf16 v[160:163], a[32:35], v[68:71], v[160:163]
v_exp_f32 v28, v28
v_mfma_f32_16x16x32_bf16 v[192:195], a[32:35], v[72:75], v[192:195]
v_cvt_pk_bf16_f32 v57, v26, v27
v_mfma_f32_16x16x32_bf16 v[224:227], a[32:35], v[76:79], v[224:227]
ds_read_b128 a[4:7], v2 offset:25600
v_mfma_f32_16x16x32_bf16 v[228:231], a[36:39], v[76:79], v[228:231]
v_exp_f32 v29, v29
v_mfma_f32_16x16x32_bf16 v[196:199], a[36:39], v[72:75], v[196:199]
v_exp_f32 v30, v30
v_mfma_f32_16x16x32_bf16 v[164:167], a[36:39], v[68:71], v[164:167]
s_add_u32 m0, s19, 0x1000
v_cvt_pk_bf16_f32 v60, v28, v29
v_mfma_f32_16x16x32_bf16 v[132:135], a[36:39], v[64:67], v[132:135]
buffer_load_dwordx4 v3, s[48:51], s7 offen offset:0 sc1 lds
v_mfma_f32_16x16x32_bf16 v[136:139], a[40:43], v[64:67], v[136:139]
ds_read_b128 a[8:11], v2 offset:26624
v_mfma_f32_16x16x32_bf16 v[168:171], a[40:43], v[68:71], v[168:171]
v_exp_f32 v31, v31
v_mfma_f32_16x16x32_bf16 v[200:203], a[40:43], v[72:75], v[200:203]
v_exp_f32 v32, v32
v_mfma_f32_16x16x32_bf16 v[232:235], a[40:43], v[76:79], v[232:235]
ds_read_b128 a[12:15], v2 offset:27648
v_cvt_pk_bf16_f32 v61, v30, v31
v_mfma_f32_16x16x32_bf16 v[236:239], a[44:47], v[76:79], v[236:239]
v_mfma_f32_16x16x32_bf16 v[204:207], a[44:47], v[72:75], v[204:207]
v_exp_f32 v33, v33
v_mfma_f32_16x16x32_bf16 v[172:175], a[44:47], v[68:71], v[172:175]
v_exp_f32 v34, v34
v_mfma_f32_16x16x32_bf16 v[140:143], a[44:47], v[64:67], v[140:143]
ds_read_b128 a[16:19], v2 offset:28672
v_cvt_pk_bf16_f32 v50, v32, v33
v_mfma_f32_16x16x32_bf16 v[144:147], a[48:51], v[64:67], v[144:147]
v_exp_f32 v35, v35
v_mfma_f32_16x16x32_bf16 v[176:179], a[48:51], v[68:71], v[176:179]
v_cvt_pk_bf16_f32 v51, v34, v35
v_mfma_f32_16x16x32_bf16 v[208:211], a[48:51], v[72:75], v[208:211]
ds_read_b128 a[20:23], v2 offset:29696
v_mfma_f32_16x16x32_bf16 v[240:243], a[48:51], v[76:79], v[240:243]
v_exp_f32 v36, v36
v_mfma_f32_16x16x32_bf16 v[244:247], a[52:55], v[76:79], v[244:247]
v_exp_f32 v37, v37
v_mfma_f32_16x16x32_bf16 v[212:215], a[52:55], v[72:75], v[212:215]
v_cvt_pk_bf16_f32 v54, v36, v37
v_mfma_f32_16x16x32_bf16 v[180:183], a[52:55], v[68:71], v[180:183]
buffer_load_dwordx4 v3, s[48:51], s7 offen offset:1024 sc1 lds
v_mfma_f32_16x16x32_bf16 v[148:151], a[52:55], v[64:67], v[148:151]
ds_read_b128 a[24:27], v2 offset:30720
v_mfma_f32_16x16x32_bf16 v[152:155], a[56:59], v[64:67], v[152:155]
v_exp_f32 v38, v38
v_mfma_f32_16x16x32_bf16 v[184:187], a[56:59], v[68:71], v[184:187]
v_exp_f32 v39, v39
v_mfma_f32_16x16x32_bf16 v[216:219], a[56:59], v[72:75], v[216:219]
ds_read_b128 a[28:31], v2 offset:31744
v_cvt_pk_bf16_f32 v55, v38, v39
v_mfma_f32_16x16x32_bf16 v[248:251], a[56:59], v[76:79], v[248:251]
v_exp_f32 v40, v40
v_mfma_f32_16x16x32_bf16 v[252:255], a[60:63], v[76:79], v[252:255]
v_mfma_f32_16x16x32_bf16 v[220:223], a[60:63], v[72:75], v[220:223]
v_exp_f32 v41, v41
v_mfma_f32_16x16x32_bf16 v[188:191], a[60:63], v[68:71], v[188:191]
ds_read_b128 a[32:35], v2 offset:16384
v_cvt_pk_bf16_f32 v58, v40, v41
v_mfma_f32_16x16x32_bf16 v[156:159], a[60:63], v[64:67], v[156:159]
v_exp_f32 v42, v42
v_smfmac_f32_16x16x64_bf16 a[224:227], a[232:235], v[64:71], v9
s_waitcnt lgkmcnt(5)
v_smfmac_f32_16x16x64_bf16 a[228:231], a[232:235], v[72:79], v9
ds_read_b128 a[36:39], v2 offset:17408
v_mfma_f32_16x16x32_bf16 v[16:19], a[0:3], a[160:163], v[80:83]
v_exp_f32 v43, v43
v_mfma_f32_16x16x32_bf16 v[16:19], a[4:7], a[164:167], v[16:19]
v_exp_f32 v44, v44
v_mfma_f32_16x16x32_bf16 v[16:19], a[8:11], a[168:171], v[16:19]
buffer_load_dwordx4 v3, s[48:51], s7 offen offset:2048 sc1 lds
v_mfma_f32_16x16x32_bf16 v[16:19], a[12:15], a[172:175], v[16:19]
ds_read_b128 a[40:43], v2 offset:18432
v_cvt_pk_bf16_f32 v59, v42, v43
v_mfma_f32_16x16x32_bf16 v[20:23], a[0:3], a[176:179], v[84:87]
v_exp_f32 v45, v45
v_mfma_f32_16x16x32_bf16 v[20:23], a[4:7], a[180:183], v[20:23]
v_cvt_pk_bf16_f32 v62, v44, v45
v_mfma_f32_16x16x32_bf16 v[20:23], a[8:11], a[184:187], v[20:23]
v_exp_f32 v46, v46
v_mfma_f32_16x16x32_bf16 v[20:23], a[12:15], a[188:191], v[20:23]
ds_read_b128 a[44:47], v2 offset:19456
v_mfma_f32_16x16x32_bf16 v[24:27], a[0:3], a[192:195], v[88:91]
v_exp_f32 v47, v47
v_mfma_f32_16x16x32_bf16 v[24:27], a[4:7], a[196:199], v[24:27]
v_cvt_pk_bf16_f32 v63, v46, v47
v_mfma_f32_16x16x32_bf16 v[24:27], a[8:11], a[200:203], v[24:27]
v_exp_f32 v16, v16
v_mfma_f32_16x16x32_bf16 v[24:27], a[12:15], a[204:207], v[24:27]
ds_read_b128 a[48:51], v2 offset:20480
v_mfma_f32_16x16x32_bf16 v[28:31], a[0:3], a[208:211], v[92:95]
v_exp_f32 v17, v17
v_mfma_f32_16x16x32_bf16 v[28:31], a[4:7], a[212:215], v[28:31]
v_exp_f32 v18, v18
v_mfma_f32_16x16x32_bf16 v[28:31], a[8:11], a[216:219], v[28:31]
ds_read_b128 a[52:55], v2 offset:21504
v_cvt_pk_bf16_f32 v64, v16, v17
v_mfma_f32_16x16x32_bf16 v[28:31], a[12:15], a[220:223], v[28:31]
s_waitcnt lgkmcnt(6)
v_mfma_f32_16x16x32_bf16 v[32:35], a[16:19], a[160:163], v[80:83]
v_exp_f32 v19, v19
v_mfma_f32_16x16x32_bf16 v[32:35], a[20:23], a[164:167], v[32:35]
buffer_load_dwordx4 v3, s[48:51], s7 offen offset:3072 sc1 lds
v_mfma_f32_16x16x32_bf16 v[32:35], a[24:27], a[168:171], v[32:35]
ds_read_b128 a[56:59], v2 offset:22528
v_cvt_pk_bf16_f32 v65, v18, v19
v_mfma_f32_16x16x32_bf16 v[32:35], a[28:31], a[172:175], v[32:35]
s_add_u32 s7, s7, 0x8000
v_exp_f32 v20, v20
v_mfma_f32_16x16x32_bf16 v[36:39], a[16:19], a[176:179], v[84:87]
s_xor_b32 s19, s19, 0x8000
v_mfma_f32_16x16x32_bf16 v[36:39], a[20:23], a[180:183], v[36:39]
s_sub_u32 s15, s15, 1
v_exp_f32 v21, v21
v_mfma_f32_16x16x32_bf16 v[36:39], a[24:27], a[184:187], v[36:39]
ds_read_b128 a[60:63], v2 offset:23552
v_xor_b32 v2, 0x38000, v2
v_mfma_f32_16x16x32_bf16 v[36:39], a[28:31], a[188:191], v[36:39]
s_cmp_lg_u32 s15, 0
v_exp_f32 v22, v22
v_mfma_f32_16x16x32_bf16 v[40:43], a[16:19], a[192:195], v[88:91]
v_exp_f32 v23, v23
v_mfma_f32_16x16x32_bf16 v[40:43], a[20:23], a[196:199], v[40:43]
v_cvt_pk_bf16_f32 v68, v20, v21
v_cvt_pk_bf16_f32 v69, v22, v23
v_mfma_f32_16x16x32_bf16 v[40:43], a[24:27], a[200:203], v[40:43]
v_exp_f32 v24, v24
v_mfma_f32_16x16x32_bf16 v[40:43], a[28:31], a[204:207], v[40:43]
v_exp_f32 v25, v25
v_mfma_f32_16x16x32_bf16 v[44:47], a[16:19], a[208:211], v[92:95]
s_waitcnt vmcnt(16) lgkmcnt(0)
v_exp_f32 v26, v26
v_mfma_f32_16x16x32_bf16 v[44:47], a[20:23], a[212:215], v[44:47]
s_barrier
v_exp_f32 v27, v27
v_mfma_f32_16x16x32_bf16 v[44:47], a[24:27], a[216:219], v[44:47]
v_mfma_f32_16x16x32_bf16 v[44:47], a[28:31], a[220:223], v[44:47]
s_cbranch_scc1 L_att_deven1
L_att_ddone:
s_cmp_ge_u32 s4, 2
s_cbranch_scc1 L_att_dl0_1
L_att_dl0_0:
v_mfma_f32_16x16x32_bf16 v[128:131], a[32:35], v[48:51], v[128:131]
ds_read_b128 a[0:3], v1 offset:8192
v_cvt_pk_bf16_f32 v72, v24, v25
v_mfma_f32_16x16x32_bf16 v[160:163], a[32:35], v[52:55], v[160:163]
v_exp_f32 v28, v28
v_mfma_f32_16x16x32_bf16 v[192:195], a[32:35], v[56:59], v[192:195]
v_cvt_pk_bf16_f32 v73, v26, v27
v_mfma_f32_16x16x32_bf16 v[224:227], a[32:35], v[60:63], v[224:227]
ds_read_b128 a[4:7], v1 offset:9216
v_mfma_f32_16x16x32_bf16 v[228:231], a[36:39], v[60:63], v[228:231]
v_exp_f32 v29, v29
v_mfma_f32_16x16x32_bf16 v[196:199], a[36:39], v[56:59], v[196:199]
s_add_u32 m0, s27, 0x0
v_exp_f32 v30, v30
v_mfma_f32_16x16x32_bf16 v[164:167], a[36:39], v[52:55], v[164:167]
buffer_load_dwordx4 v3, s[48:51], s32 offen offset:0 sc1 lds
v_mfma_f32_16x16x32_bf16 v[132:135], a[36:39], v[48:51], v[132:135]
ds_read_b128 a[8:11], v1 offset:10240
v_cvt_pk_bf16_f32 v76, v28, v29
v_mfma_f32_16x16x32_bf16 v[136:139], a[40:43], v[48:51], v[136:139]
v_mfma_f32_16x16x32_bf16 v[168:171], a[40:43], v[52:55], v[168:171]
v_exp_f32 v31, v31
v_mfma_f32_16x16x32_bf16 v[200:203], a[40:43], v[56:59], v[200:203]
v_exp_f32 v32, v32
v_mfma_f32_16x16x32_bf16 v[232:235], a[40:43], v[60:63], v[232:235]
ds_read_b128 a[12:15], v1 offset:11264
v_cvt_pk_bf16_f32 v77, v30, v31
v_mfma_f32_16x16x32_bf16 v[236:239], a[44:47], v[60:63], v[236:239]
v_mfma_f32_16x16x32_bf16 v[204:207], a[44:47], v[56:59], v[204:207]
v_exp_f32 v33, v33
v_mfma_f32_16x16x32_bf16 v[172:175], a[44:47], v[52:55], v[172:175]
v_exp_f32 v34, v34
v_mfma_f32_16x16x32_bf16 v[140:143], a[44:47], v[48:51], v[140:143]
ds_read_b128 a[16:19], v1 offset:12288
v_cvt_pk_bf16_f32 v66, v32, v33
v_mfma_f32_16x16x32_bf16 v[144:147], a[48:51], v[48:51], v[144:147]
v_exp_f32 v35, v35
v_mfma_f32_16x16x32_bf16 v[176:179], a[48:51], v[52:55], v[176:179]
v_cvt_pk_bf16_f32 v67, v34, v35
v_mfma_f32_16x16x32_bf16 v[208:211], a[48:51], v[56:59], v[208:211]
v_exp_f32 v36, v36
v_mfma_f32_16x16x32_bf16 v[240:243], a[48:51], v[60:63], v[240:243]
buffer_load_dwordx4 v3, s[48:51], s32 offen offset:1024 sc1 lds
v_mfma_f32_16x16x32_bf16 v[244:247], a[52:55], v[60:63], v[244:247]
ds_read_b128 a[20:23], v1 offset:13312
v_mfma_f32_16x16x32_bf16 v[212:215], a[52:55], v[56:59], v[212:215]
v_exp_f32 v37, v37
v_mfma_f32_16x16x32_bf16 v[180:183], a[52:55], v[52:55], v[180:183]
ds_read_b128 a[24:27], v1 offset:14336
v_cvt_pk_bf16_f32 v70, v36, v37
v_mfma_f32_16x16x32_bf16 v[148:151], a[52:55], v[48:51], v[148:151]
v_mfma_f32_16x16x32_bf16 v[152:155], a[56:59], v[48:51], v[152:155]
v_exp_f32 v38, v38
v_mfma_f32_16x16x32_bf16 v[184:187], a[56:59], v[52:55], v[184:187]
v_exp_f32 v39, v39
v_mfma_f32_16x16x32_bf16 v[216:219], a[56:59], v[56:59], v[216:219]
ds_read_b128 a[28:31], v1 offset:15360
v_cvt_pk_bf16_f32 v71, v38, v39
v_mfma_f32_16x16x32_bf16 v[248:251], a[56:59], v[60:63], v[248:251]
v_exp_f32 v40, v40
v_mfma_f32_16x16x32_bf16 v[252:255], a[60:63], v[60:63], v[252:255]
v_mfma_f32_16x16x32_bf16 v[220:223], a[60:63], v[56:59], v[220:223]
v_exp_f32 v41, v41
v_mfma_f32_16x16x32_bf16 v[188:191], a[60:63], v[52:55], v[188:191]
ds_read_b128 a[32:35], v1 offset:0
v_cvt_pk_bf16_f32 v74, v40, v41
v_mfma_f32_16x16x32_bf16 v[156:159], a[60:63], v[48:51], v[156:159]
v_exp_f32 v42, v42
v_smfmac_f32_16x16x64_bf16 a[224:227], a[232:235], v[48:55], v9
buffer_load_dwordx4 v3, s[48:51], s32 offen offset:2048 sc1 lds
v_smfmac_f32_16x16x64_bf16 a[228:231], a[232:235], v[56:63], v9
s_waitcnt lgkmcnt(5)
v_mfma_f32_16x16x32_bf16 v[16:19], a[0:3], a[160:163], v[96:99]
ds_read_b128 a[36:39], v1 offset:1024
v_mfma_f32_16x16x32_bf16 v[16:19], a[4:7], a[164:167], v[16:19]
v_exp_f32 v43, v43
v_mfma_f32_16x16x32_bf16 v[16:19], a[8:11], a[168:171], v[16:19]
v_exp_f32 v44, v44
v_mfma_f32_16x16x32_bf16 v[16:19], a[12:15], a[172:175], v[16:19]
v_exp_f32 v45, v45
v_mfma_f32_16x16x32_bf16 v[20:23], a[0:3], a[176:179], v[84:87]
ds_read_b128 a[40:43], v1 offset:2048
v_cvt_pk_bf16_f32 v75, v42, v43
v_mfma_f32_16x16x32_bf16 v[20:23], a[4:7], a[180:183], v[20:23]
v_cvt_pk_bf16_f32 v78, v44, v45
v_mfma_f32_16x16x32_bf16 v[20:23], a[8:11], a[184:187], v[20:23]
v_exp_f32 v46, v46
v_mfma_f32_16x16x32_bf16 v[20:23], a[12:15], a[188:191], v[20:23]
ds_read_b128 a[44:47], v1 offset:3072
v_mfma_f32_16x16x32_bf16 v[24:27], a[0:3], a[192:195], v[88:91]
v_exp_f32 v47, v47
v_mfma_f32_16x16x32_bf16 v[24:27], a[4:7], a[196:199], v[24:27]
v_cvt_pk_bf16_f32 v79, v46, v47
v_mfma_f32_16x16x32_bf16 v[24:27], a[8:11], a[200:203], v[24:27]
buffer_load_dwordx4 v3, s[48:51], s32 offen offset:3072 sc1 lds
v_mfma_f32_16x16x32_bf16 v[24:27], a[12:15], a[204:207], v[24:27]
ds_read_b128 a[48:51], v1 offset:4096
v_mfma_f32_16x16x32_bf16 v[28:31], a[0:3], a[208:211], v[92:95]
v_exp_f32 v16, v16
v_mfma_f32_16x16x32_bf16 v[28:31], a[4:7], a[212:215], v[28:31]
v_exp_f32 v17, v17
v_mfma_f32_16x16x32_bf16 v[28:31], a[8:11], a[216:219], v[28:31]
s_waitcnt lgkmcnt(5)
v_exp_f32 v18, v18
v_mfma_f32_16x16x32_bf16 v[28:31], a[12:15], a[220:223], v[28:31]
ds_read_b128 a[52:55], v1 offset:5120
v_cvt_pk_bf16_f32 v48, v16, v17
v_mfma_f32_16x16x32_bf16 v[32:35], a[16:19], a[160:163], v[100:103]
v_mfma_f32_16x16x32_bf16 v[32:35], a[20:23], a[164:167], v[32:35]
v_exp_f32 v19, v19
v_mfma_f32_16x16x32_bf16 v[32:35], a[24:27], a[168:171], v[32:35]
v_exp_f32 v20, v20
v_mfma_f32_16x16x32_bf16 v[32:35], a[28:31], a[172:175], v[32:35]
ds_read_b128 a[56:59], v1 offset:6144
v_cvt_pk_bf16_f32 v49, v18, v19
v_mfma_f32_16x16x32_bf16 v[36:39], a[16:19], a[176:179], v[84:87]
v_mfma_f32_16x16x32_bf16 v[36:39], a[20:23], a[180:183], v[36:39]
v_exp_f32 v21, v21
v_mfma_f32_16x16x32_bf16 v[36:39], a[24:27], a[184:187], v[36:39]
s_add_u32 m0, s27, 0x1000
v_exp_f32 v22, v22
v_mfma_f32_16x16x32_bf16 v[36:39], a[28:31], a[188:191], v[36:39]
buffer_load_dwordx4 v3, s[48:51], s7 offen offset:0 sc1 lds
v_mfma_f32_16x16x32_bf16 v[40:43], a[16:19], a[192:195], v[88:91]
ds_read_b128 a[60:63], v1 offset:7168
v_cvt_pk_bf16_f32 v52, v20, v21
v_mfma_f32_16x16x32_bf16 v[40:43], a[20:23], a[196:199], v[40:43]
v_exp_f32 v23, v23
v_mfma_f32_16x16x32_bf16 v[40:43], a[24:27], a[200:203], v[40:43]
v_cvt_pk_bf16_f32 v53, v22, v23
v_mfma_f32_16x16x32_bf16 v[40:43], a[28:31], a[204:207], v[40:43]
v_exp_f32 v24, v24
v_mfma_f32_16x16x32_bf16 v[44:47], a[16:19], a[208:211], v[92:95]
v_exp_f32 v25, v25
v_mfma_f32_16x16x32_bf16 v[44:47], a[20:23], a[212:215], v[44:47]
v_exp_f32 v26, v26
v_mfma_f32_16x16x32_bf16 v[44:47], a[24:27], a[216:219], v[44:47]
v_exp_f32 v27, v27
v_mfma_f32_16x16x32_bf16 v[44:47], a[28:31], a[220:223], v[44:47]
s_waitcnt lgkmcnt(0)
v_mfma_f32_16x16x32_bf16 v[128:131], a[32:35], v[64:67], v[128:131]
ds_read_b128 a[0:3], v1 offset:24576
v_cvt_pk_bf16_f32 v56, v24, v25
v_mfma_f32_16x16x32_bf16 v[160:163], a[32:35], v[68:71], v[160:163]
v_exp_f32 v28, v28
v_mfma_f32_16x16x32_bf16 v[192:195], a[32:35], v[72:75], v[192:195]
v_cvt_pk_bf16_f32 v57, v26, v27
v_mfma_f32_16x16x32_bf16 v[224:227], a[32:35], v[76:79], v[224:227]
ds_read_b128 a[4:7], v1 offset:25600
v_mfma_f32_16x16x32_bf16 v[228:231], a[36:39], v[76:79], v[228:231]
v_exp_f32 v29, v29
v_mfma_f32_16x16x32_bf16 v[196:199], a[36:39], v[72:75], v[196:199]
v_exp_f32 v30, v30
v_mfma_f32_16x16x32_bf16 v[164:167], a[36:39], v[68:71], v[164:167]
buffer_load_dwordx4 v3, s[48:51], s7 offen offset:1024 sc1 lds
v_mfma_f32_16x16x32_bf16 v[132:135], a[36:39], v[64:67], v[132:135]
ds_read_b128 a[8:11], v1 offset:26624
v_cvt_pk_bf16_f32 v60, v28, v29
v_mfma_f32_16x16x32_bf16 v[136:139], a[40:43], v[64:67], v[136:139]
v_mfma_f32_16x16x32_bf16 v[168:171], a[40:43], v[68:71], v[168:171]
ds_read_b128 a[12:15], v1 offset:27648
v_mfma_f32_16x16x32_bf16 v[200:203], a[40:43], v[72:75], v[200:203]
v_exp_f32 v31, v31
v_mfma_f32_16x16x32_bf16 v[232:235], a[40:43], v[76:79], v[232:235]
v_exp_f32 v32, v32
v_mfma_f32_16x16x32_bf16 v[236:239], a[44:47], v[76:79], v[236:239]
v_exp_f32 v33, v33
v_mfma_f32_16x16x32_bf16 v[204:207], a[44:47], v[72:75], v[204:207]
ds_read_b128 a[16:19], v1 offset:28672
v_cvt_pk_bf16_f32 v61, v30, v31
v_mfma_f32_16x16x32_bf16 v[172:175], a[44:47], v[68:71], v[172:175]
v_cvt_pk_bf16_f32 v50, v32, v33
v_mfma_f32_16x16x32_bf16 v[140:143], a[44:47], v[64:67], v[140:143]
v_exp_f32 v34, v34
v_mfma_f32_16x16x32_bf16 v[144:147], a[48:51], v[64:67], v[144:147]
ds_read_b128 a[20:23], v1 offset:29696
v_mfma_f32_16x16x32_bf16 v[176:179], a[48:51], v[68:71], v[176:179]
v_exp_f32 v35, v35
v_mfma_f32_16x16x32_bf16 v[208:211], a[48:51], v[72:75], v[208:211]
v_exp_f32 v36, v36
v_mfma_f32_16x16x32_bf16 v[240:243], a[48:51], v[76:79], v[240:243]
buffer_load_dwordx4 v3, s[48:51], s7 offen offset:2048 sc1 lds
v_mfma_f32_16x16x32_bf16 v[244:247], a[52:55], v[76:79], v[244:247]
ds_read_b128 a[24:27], v1 offset:30720
v_cvt_pk_bf16_f32 v51, v34, v35
v_mfma_f32_16x16x32_bf16 v[212:215], a[52:55], v[72:75], v[212:215]
v_mfma_f32_16x16x32_bf16 v[180:183], a[52:55], v[68:71], v[180:183]
ds_read_b128 a[28:31], v1 offset:31744
v_mfma_f32_16x16x32_bf16 v[148:151], a[52:55], v[64:67], v[148:151]
v_exp_f32 v37, v37
v_mfma_f32_16x16x32_bf16 v[152:155], a[56:59], v[64:67], v[152:155]
v_exp_f32 v38, v38
v_mfma_f32_16x16x32_bf16 v[184:187], a[56:59], v[68:71], v[184:187]
v_exp_f32 v39, v39
v_mfma_f32_16x16x32_bf16 v[216:219], a[56:59], v[72:75], v[216:219]
ds_read_b128 a[32:35], v1 offset:16384
v_cvt_pk_bf16_f32 v54, v36, v37
v_mfma_f32_16x16x32_bf16 v[248:251], a[56:59], v[76:79], v[248:251]
v_cvt_pk_bf16_f32 v55, v38, v39
v_mfma_f32_16x16x32_bf16 v[252:255], a[60:63], v[76:79], v[252:255]
v_exp_f32 v40, v40
v_mfma_f32_16x16x32_bf16 v[220:223], a[60:63], v[72:75], v[220:223]
ds_read_b128 a[36:39], v1 offset:17408
v_mfma_f32_16x16x32_bf16 v[188:191], a[60:63], v[68:71], v[188:191]
v_exp_f32 v41, v41
v_mfma_f32_16x16x32_bf16 v[156:159], a[60:63], v[64:67], v[156:159]
s_waitcnt lgkmcnt(6)
v_exp_f32 v42, v42
v_smfmac_f32_16x16x64_bf16 a[224:227], a[232:235], v[64:71], v9
buffer_load_dwordx4 v3, s[48:51], s7 offen offset:3072 sc1 lds
v_smfmac_f32_16x16x64_bf16 a[228:231], a[232:235], v[72:79], v9
ds_read_b128 a[40:43], v1 offset:18432
v_cvt_pk_bf16_f32 v58, v40, v41
v_mfma_f32_16x16x32_bf16 v[20:23], a[0:3], a[176:179], v[84:87]
v_mfma_f32_16x16x32_bf16 v[20:23], a[4:7], a[180:183], v[20:23]
ds_read_b128 a[44:47], v1 offset:19456
v_mfma_f32_16x16x32_bf16 v[20:23], a[8:11], a[184:187], v[20:23]
v_exp_f32 v43, v43
v_mfma_f32_16x16x32_bf16 v[20:23], a[12:15], a[188:191], v[20:23]
v_exp_f32 v44, v44
v_mfma_f32_16x16x32_bf16 v[24:27], a[0:3], a[192:195], v[88:91]
v_cvt_pk_bf16_f32 v59, v42, v43
v_mfma_f32_16x16x32_bf16 v[24:27], a[4:7], a[196:199], v[24:27]
ds_read_b128 a[48:51], v1 offset:20480
v_mfma_f32_16x16x32_bf16 v[24:27], a[8:11], a[200:203], v[24:27]
v_exp_f32 v45, v45
v_mfma_f32_16x16x32_bf16 v[24:27], a[12:15], a[204:207], v[24:27]
v_exp_f32 v46, v46
v_mfma_f32_16x16x32_bf16 v[28:31], a[0:3], a[208:211], v[92:95]
ds_read_b128 a[52:55], v1 offset:21504
v_cvt_pk_bf16_f32 v62, v44, v45
v_mfma_f32_16x16x32_bf16 v[28:31], a[4:7], a[212:215], v[28:31]
s_waitcnt lgkmcnt(6)
v_exp_f32 v47, v47
v_mfma_f32_16x16x32_bf16 v[28:31], a[8:11], a[216:219], v[28:31]
s_mov_b32 s9, 0x0
v_cvt_pk_bf16_f32 v63, v46, v47
v_mfma_f32_16x16x32_bf16 v[28:31], a[12:15], a[220:223], v[28:31]
buffer_load_dword a244, v8, s[72:75], s9 offen
v_mfma_f32_16x16x32_bf16 v[36:39], a[16:19], a[176:179], v[84:87]
ds_read_b128 a[56:59], v1 offset:22528
v_mfma_f32_16x16x32_bf16 v[36:39], a[20:23], a[180:183], v[36:39]
s_add_u32 s32, s32, 0x8000
v_exp_f32 v20, v20
v_mfma_f32_16x16x32_bf16 v[36:39], a[24:27], a[184:187], v[36:39]
ds_read_b128 a[60:63], v1 offset:23552
v_xor_b32 v1, 0x8000, v1
v_mfma_f32_16x16x32_bf16 v[36:39], a[28:31], a[188:191], v[36:39]
s_add_u32 s7, s7, 0x8000
v_exp_f32 v21, v21
v_mfma_f32_16x16x32_bf16 v[40:43], a[16:19], a[192:195], v[88:91]
s_xor_b32 s27, s27, 0x38000
v_exp_f32 v22, v22
v_mfma_f32_16x16x32_bf16 v[40:43], a[20:23], a[196:199], v[40:43]
v_cvt_pk_bf16_f32 v68, v20, v21
v_mfma_f32_16x16x32_bf16 v[40:43], a[24:27], a[200:203], v[40:43]
v_exp_f32 v23, v23
v_mfma_f32_16x16x32_bf16 v[40:43], a[28:31], a[204:207], v[40:43]
v_exp_f32 v24, v24
v_mfma_f32_16x16x32_bf16 v[44:47], a[16:19], a[208:211], v[92:95]
v_exp_f32 v25, v25
v_mfma_f32_16x16x32_bf16 v[44:47], a[20:23], a[212:215], v[44:47]
v_exp_f32 v26, v26
v_mfma_f32_16x16x32_bf16 v[44:47], a[24:27], a[216:219], v[44:47]
s_waitcnt vmcnt(17) lgkmcnt(0)
v_exp_f32 v27, v27
v_mfma_f32_16x16x32_bf16 v[44:47], a[28:31], a[220:223], v[44:47]
s_barrier
v_cvt_pk_bf16_f32 v69, v22, v23
L_att_l1_0:
v_mfma_f32_16x16x32_bf16 v[128:131], a[32:35], v[48:51], v[128:131]
ds_read_b128 a[0:3], v2 offset:8192
v_cvt_pk_bf16_f32 v72, v24, v25
v_mfma_f32_16x16x32_bf16 v[160:163], a[32:35], v[52:55], v[160:163]
s_add_u32 m0, s19, 0x0
v_exp_f32 v28, v28
v_mfma_f32_16x16x32_bf16 v[192:195], a[32:35], v[56:59], v[192:195]
buffer_load_dwordx4 v3, s[48:51], s32 offen offset:0 sc1 lds
v_mfma_f32_16x16x32_bf16 v[224:227], a[32:35], v[60:63], v[224:227]
ds_read_b128 a[4:7], v2 offset:9216
v_cvt_pk_bf16_f32 v73, v26, v27
v_mfma_f32_16x16x32_bf16 v[228:231], a[36:39], v[60:63], v[228:231]
s_and_b32 s44, s18, 3
s_lshl_b32 s45, s44, 1
s_add_u32 s45, s45, s100
v_mfma_f32_16x16x32_bf16 v[196:199], a[36:39], v[56:59], v[196:199]
s_add_u32 s8, s16, 0x0
v_exp_f32 v29, v29
v_mfma_f32_16x16x32_bf16 v[164:167], a[36:39], v[52:55], v[164:167]
ds_read_b128 a[8:11], v2 offset:10240
v_cvt_pk_bf16_f32 v76, v28, v29
v_mfma_f32_16x16x32_bf16 v[132:135], a[36:39], v[48:51], v[132:135]
buffer_store_dwordx4 a[64:67], v3, s[88:91], s8 offen offset:0 sc1
v_mfma_f32_16x16x32_bf16 v[136:139], a[40:43], v[48:51], v[136:139]
s_and_b32 s60, s45, 3
v_exp_f32 v30, v30
v_mfma_f32_16x16x32_bf16 v[168:171], a[40:43], v[52:55], v[168:171]
ds_read_b128 a[12:15], v2 offset:11264
s_sub_u32 s60, s60, s44
v_mfma_f32_16x16x32_bf16 v[200:203], a[40:43], v[56:59], v[200:203]
s_add_u32 s60, s60, 11
v_exp_f32 v31, v31
v_mfma_f32_16x16x32_bf16 v[232:235], a[40:43], v[60:63], v[232:235]
s_lshl_b32 s60, s60, 14
s_mul_i32 s44, s44, -8
v_cvt_pk_bf16_f32 v77, v30, v31
v_mfma_f32_16x16x32_bf16 v[236:239], a[44:47], v[60:63], v[236:239]
buffer_load_dwordx4 v3, s[48:51], s32 offen offset:1024 sc1 lds
v_mfma_f32_16x16x32_bf16 v[204:207], a[44:47], v[56:59], v[204:207]
ds_read_b128 a[16:19], v2 offset:12288
s_and_b32 s44, s44, 31
v_mfma_f32_16x16x32_bf16 v[172:175], a[44:47], v[52:55], v[172:175]
s_lshl_b32 s44, 4, s44
v_exp_f32 v36, v36
v_mfma_f32_16x16x32_bf16 v[140:143], a[44:47], v[48:51], v[140:143]
s_mul_i32 s45, s45, -8
v_exp_f32 v37, v37
v_mfma_f32_16x16x32_bf16 v[144:147], a[48:51], v[48:51], v[144:147]
ds_read_b128 a[20:23], v2 offset:13312
v_cvt_pk_bf16_f32 v70, v36, v37
v_mfma_f32_16x16x32_bf16 v[176:179], a[48:51], v[52:55], v[176:179]
buffer_store_dwordx4 a[64:67], v3, s[88:91], s8 offen offset:1024 sc1
v_mfma_f32_16x16x32_bf16 v[208:211], a[48:51], v[56:59], v[208:211]
s_and_b32 s45, s45, 31
v_exp_f32 v38, v38
v_mfma_f32_16x16x32_bf16 v[240:243], a[48:51], v[60:63], v[240:243]
ds_read_b128 a[24:27], v2 offset:14336
s_lshl_b32 s45, 4, s45
v_mfma_f32_16x16x32_bf16 v[244:247], a[52:55], v[60:63], v[244:247]
s_add_u32 s44, s44, 0x11111111
s_sub_u32 s44, s44, s45
s_bfe_u32 s56, s44, 0x80000
v_mfma_f32_16x16x32_bf16 v[212:215], a[52:55], v[56:59], v[212:215]
s_lshl_b32 s56, s56, 14
v_exp_f32 v39, v39
v_mfma_f32_16x16x32_bf16 v[180:183], a[52:55], v[52:55], v[180:183]
buffer_load_dwordx4 v3, s[48:51], s32 offen offset:2048 sc1 lds
v_mfma_f32_16x16x32_bf16 v[148:151], a[52:55], v[48:51], v[148:151]
ds_read_b128 a[28:31], v2 offset:15360
v_cvt_pk_bf16_f32 v71, v38, v39
v_mfma_f32_16x16x32_bf16 v[152:155], a[56:59], v[48:51], v[152:155]
s_bfe_u32 s57, s44, 0x80008
v_exp_f32 v40, v40
v_mfma_f32_16x16x32_bf16 v[184:187], a[56:59], v[52:55], v[184:187]
s_lshl_b32 s57, s57, 14
v_exp_f32 v41, v41
v_mfma_f32_16x16x32_bf16 v[216:219], a[56:59], v[56:59], v[216:219]
ds_read_b128 a[32:35], v2 offset:0
v_cvt_pk_bf16_f32 v74, v40, v41
v_mfma_f32_16x16x32_bf16 v[248:251], a[56:59], v[60:63], v[248:251]
s_bfe_u32 s58, s44, 0x80010
v_exp_f32 v42, v42
v_mfma_f32_16x16x32_bf16 v[252:255], a[60:63], v[60:63], v[252:255]
buffer_store_dwordx4 a[64:67], v3, s[88:91], s8 offen offset:2048 sc1
v_mfma_f32_16x16x32_bf16 v[220:223], a[60:63], v[56:59], v[220:223]
ds_read_b128 a[36:39], v2 offset:1024
s_lshl_b32 s58, s58, 14
v_mfma_f32_16x16x32_bf16 v[188:191], a[60:63], v[52:55], v[188:191]
s_bfe_u32 s59, s44, 0x80018
s_lshl_b32 s59, s59, 14
v_mov_b32 v6, 0xf149f2ca
v_mfma_f32_16x16x32_bf16 v[156:159], a[60:63], v[48:51], v[156:159]
v_exp_f32 v43, v43
v_smfmac_f32_16x16x64_bf16 a[224:227], a[232:235], v[48:55], v9
s_waitcnt lgkmcnt(6)
v_exp_f32 v44, v44
v_smfmac_f32_16x16x64_bf16 a[228:231], a[232:235], v[56:63], v9
buffer_load_dwordx4 v3, s[48:51], s32 offen offset:3072 sc1 lds
v_mfma_f32_16x16x32_bf16 v[20:23], a[0:3], a[176:179], v[84:87]
ds_read_b128 a[40:43], v2 offset:2048
v_cvt_pk_bf16_f32 v75, v42, v43
v_mfma_f32_16x16x32_bf16 v[20:23], a[4:7], a[180:183], v[20:23]
v_exp_f32 v45, v45
v_mfma_f32_16x16x32_bf16 v[20:23], a[8:11], a[184:187], v[20:23]
ds_read_b128 a[44:47], v2 offset:3072
v_cvt_pk_bf16_f32 v78, v44, v45
v_mfma_f32_16x16x32_bf16 v[20:23], a[12:15], a[188:191], v[20:23]
v_min_f32 v119, s10, v88
v_cndmask_b32 v112, v119, v88, s[36:37]
v_mfma_f32_16x16x32_bf16 v[24:27], a[0:3], a[192:195], v[88:91]
buffer_store_dwordx4 a[64:67], v3, s[88:91], s8 offen offset:3072 sc1
v_mfma_f32_16x16x32_bf16 v[24:27], a[4:7], a[196:199], v[24:27]
ds_read_b128 a[48:51], v2 offset:4096
v_cndmask_b32 v113, v119, v88, s[38:39]
v_mfma_f32_16x16x32_bf16 v[24:27], a[8:11], a[200:203], v[24:27]
v_exp_f32 v46, v46
v_mfma_f32_16x16x32_bf16 v[24:27], a[12:15], a[204:207], v[24:27]
v_exp_f32 v47, v47
v_mfma_f32_16x16x32_bf16 v[28:31], a[0:3], a[208:211], v[92:95]
s_add_u32 m0, s19, 0x1000
v_exp_f32 v20, v20
v_mfma_f32_16x16x32_bf16 v[28:31], a[4:7], a[212:215], v[28:31]
buffer_load_dwordx4 v3, s[48:51], s7 offen offset:0 sc1 lds
v_mfma_f32_16x16x32_bf16 v[28:31], a[8:11], a[216:219], v[28:31]
ds_read_b128 a[52:55], v2 offset:5120
v_cvt_pk_bf16_f32 v79, v46, v47
v_mfma_f32_16x16x32_bf16 v[28:31], a[12:15], a[220:223], v[28:31]
s_waitcnt lgkmcnt(6)
v_exp_f32 v21, v21
v_mfma_f32_16x16x32_bf16 v[36:39], a[16:19], a[176:179], v[84:87]
ds_read_b128 a[56:59], v2 offset:6144
v_cvt_pk_bf16_f32 v52, v20, v21
v_mfma_f32_16x16x32_bf16 v[36:39], a[20:23], a[180:183], v[36:39]
s_add_u32 s8, s16, 0x400000
v_cndmask_b32 v114, v119, v88, s[40:41]
v_cndmask_b32 v115, v119, v88, s[42:43]
v_mfma_f32_16x16x32_bf16 v[36:39], a[24:27], a[184:187], v[36:39]
buffer_store_dwordx4 a[64:67], v3, s[88:91], s8 offen offset:0 sc1
v_mfma_f32_16x16x32_bf16 v[36:39], a[28:31], a[188:191], v[36:39]
ds_read_b128 a[60:63], v2 offset:7168
v_cndmask_b32 v116, v6, v119, s[36:37]
v_mfma_f32_16x16x32_bf16 v[40:43], a[16:19], a[192:195], v[88:91]
v_exp_f32 v22, v22
v_mfma_f32_16x16x32_bf16 v[40:43], a[20:23], a[196:199], v[40:43]
v_exp_f32 v23, v23
v_mfma_f32_16x16x32_bf16 v[40:43], a[24:27], a[200:203], v[40:43]
v_exp_f32 v24, v24
v_mfma_f32_16x16x32_bf16 v[40:43], a[28:31], a[204:207], v[40:43]
buffer_load_dwordx4 v3, s[48:51], s7 offen offset:1024 sc1 lds
v_mfma_f32_16x16x32_bf16 v[44:47], a[16:19], a[208:211], v[92:95]
v_exp_f32 v25, v25
v_mfma_f32_16x16x32_bf16 v[44:47], a[20:23], a[212:215], v[44:47]
v_exp_f32 v26, v26
v_mfma_f32_16x16x32_bf16 v[44:47], a[24:27], a[216:219], v[44:47]
v_exp_f32 v27, v27
v_mfma_f32_16x16x32_bf16 v[44:47], a[28:31], a[220:223], v[44:47]
s_waitcnt lgkmcnt(0)
v_cvt_pk_bf16_f32 v53, v22, v23
v_cndmask_b32 v117, v6, v119, s[38:39]
v_cndmask_b32 v118, v6, v119, s[40:41]
v_cndmask_b32 v119, v6, v119, s[42:43]
v_min_f32 v127, s11, v92
v_cndmask_b32 v120, v127, v92, s[36:37]
v_cndmask_b32 v121, v127, v92, s[38:39]
v_cndmask_b32 v122, v127, v92, s[40:41]
v_cndmask_b32 v123, v127, v92, s[42:43]
v_cndmask_b32 v124, v6, v127, s[36:37]
v_cndmask_b32 v125, v6, v127, s[38:39]
v_cndmask_b32 v126, v6, v127, s[40:41]
v_cndmask_b32 v127, v6, v127, s[42:43]
v_mfma_f32_16x16x32_bf16 v[160:163], a[32:35], v[68:71], v[160:163]
ds_read_b128 a[0:3], v2 offset:24576
v_cvt_pk_bf16_f32 v56, v24, v25
v_mfma_f32_16x16x32_bf16 v[192:195], a[32:35], v[72:75], v[192:195]
v_exp_f32 v28, v28
v_mfma_f32_16x16x32_bf16 v[224:227], a[32:35], v[76:79], v[224:227]
buffer_store_dwordx4 a[64:67], v3, s[88:91], s8 offen offset:1024 sc1
v_mfma_f32_16x16x32_bf16 v[228:231], a[36:39], v[76:79], v[228:231]
ds_read_b128 a[4:7], v2 offset:25600
v_cvt_pk_bf16_f32 v57, v26, v27
v_mfma_f32_16x16x32_bf16 v[196:199], a[36:39], v[72:75], v[196:199]
v_exp_f32 v29, v29
v_mfma_f32_16x16x32_bf16 v[164:167], a[36:39], v[68:71], v[164:167]
ds_read_b128 a[8:11], v2 offset:26624
v_cvt_pk_bf16_f32 v60, v28, v29
v_mfma_f32_16x16x32_bf16 v[168:171], a[40:43], v[68:71], v[168:171]
buffer_load_dwordx4 v3, s[48:51], s7 offen offset:2048 sc1 lds
v_mfma_f32_16x16x32_bf16 v[200:203], a[40:43], v[72:75], v[200:203]
v_exp_f32 v30, v30
v_mfma_f32_16x16x32_bf16 v[232:235], a[40:43], v[76:79], v[232:235]
ds_read_b128 a[12:15], v2 offset:27648
v_mfma_f32_16x16x32_bf16 v[236:239], a[44:47], v[76:79], v[236:239]
v_exp_f32 v31, v31
v_mfma_f32_16x16x32_bf16 v[204:207], a[44:47], v[72:75], v[204:207]
buffer_store_dwordx4 a[64:67], v3, s[88:91], s8 offen offset:2048 sc1
v_mfma_f32_16x16x32_bf16 v[172:175], a[44:47], v[68:71], v[172:175]
ds_read_b128 a[16:19], v2 offset:28672
v_cvt_pk_bf16_f32 v61, v30, v31
v_mfma_f32_16x16x32_bf16 v[176:179], a[48:51], v[68:71], v[176:179]
v_exp_f32 v36, v36
v_mfma_f32_16x16x32_bf16 v[208:211], a[48:51], v[72:75], v[208:211]
ds_read_b128 a[20:23], v2 offset:29696
v_mfma_f32_16x16x32_bf16 v[240:243], a[48:51], v[76:79], v[240:243]
buffer_load_dwordx4 v3, s[48:51], s7 offen offset:3072 sc1 lds
v_mfma_f32_16x16x32_bf16 v[244:247], a[52:55], v[76:79], v[244:247]
v_exp_f32 v37, v37
v_mfma_f32_16x16x32_bf16 v[212:215], a[52:55], v[72:75], v[212:215]
ds_read_b128 a[24:27], v2 offset:30720
v_cvt_pk_bf16_f32 v54, v36, v37
v_mfma_f32_16x16x32_bf16 v[180:183], a[52:55], v[68:71], v[180:183]
v_exp_f32 v38, v38
v_mfma_f32_16x16x32_bf16 v[184:187], a[56:59], v[68:71], v[184:187]
buffer_store_dwordx4 a[64:67], v3, s[88:91], s8 offen offset:3072 sc1
v_mfma_f32_16x16x32_bf16 v[216:219], a[56:59], v[72:75], v[216:219]
ds_read_b128 a[28:31], v2 offset:31744
v_mfma_f32_16x16x32_bf16 v[248:251], a[56:59], v[76:79], v[248:251]
v_exp_f32 v39, v39
v_mfma_f32_16x16x32_bf16 v[252:255], a[60:63], v[76:79], v[252:255]
s_add_u32 s8, s16, 0x800000
v_exp_f32 v40, v40
v_mfma_f32_16x16x32_bf16 v[220:223], a[60:63], v[72:75], v[220:223]
ds_read_b128 a[32:35], v2 offset:16384
v_cvt_pk_bf16_f32 v55, v38, v39
v_mfma_f32_16x16x32_bf16 v[188:191], a[60:63], v[68:71], v[188:191]
buffer_store_dwordx4 a[64:67], v3, s[88:91], s8 offen offset:0 sc1
v_mfma_f32_16x16x32_bf16 a[224:227], a[236:239], v[68:71], a[224:227]
ds_read_b128 a[36:39], v2 offset:17408
v_exp_f32 v41, v41
v_smfmac_f32_16x16x64_bf16 a[228:231], a[232:235], v[72:79], v9
s_waitcnt lgkmcnt(6)
v_exp_f32 v42, v42
v_mfma_f32_16x16x32_bf16 v[20:23], a[0:3], a[176:179], v[104:107]
v_exp_f32 v43, v43
v_mfma_f32_16x16x32_bf16 v[20:23], a[4:7], a[180:183], v[20:23]
buffer_store_dwordx4 a[64:67], v3, s[88:91], s8 offen offset:1024 sc1
v_mfma_f32_16x16x32_bf16 v[20:23], a[8:11], a[184:187], v[20:23]
ds_read_b128 a[40:43], v2 offset:18432
v_cvt_pk_bf16_f32 v58, v40, v41
v_mfma_f32_16x16x32_bf16 v[20:23], a[12:15], a[188:191], v[20:23]
v_exp_f32 v44, v44
v_mfma_f32_16x16x32_bf16 v[24:27], a[0:3], a[192:195], v[88:91]
ds_read_b128 a[44:47], v2 offset:19456
v_cvt_pk_bf16_f32 v59, v42, v43
v_mfma_f32_16x16x32_bf16 v[24:27], a[4:7], a[196:199], v[24:27]
buffer_store_dwordx4 a[64:67], v3, s[88:91], s8 offen offset:2048 sc1
v_mfma_f32_16x16x32_bf16 v[24:27], a[8:11], a[200:203], v[24:27]
v_exp_f32 v45, v45
v_mfma_f32_16x16x32_bf16 v[24:27], a[12:15], a[204:207], v[24:27]
ds_read_b128 a[48:51], v2 offset:20480
v_cvt_pk_bf16_f32 v62, v44, v45
v_mfma_f32_16x16x32_bf16 v[28:31], a[0:3], a[208:211], v[92:95]
v_exp_f32 v46, v46
v_mfma_f32_16x16x32_bf16 v[28:31], a[4:7], a[212:215], v[28:31]
buffer_store_dwordx4 a[64:67], v3, s[88:91], s8 offen offset:3072 sc1
v_mfma_f32_16x16x32_bf16 v[28:31], a[8:11], a[216:219], v[28:31]
ds_read_b128 a[52:55], v2 offset:21504
v_add_u32 v4, s0, v3
v_mfma_f32_16x16x32_bf16 v[28:31], a[12:15], a[220:223], v[28:31]
s_waitcnt lgkmcnt(6)
v_exp_f32 v47, v47
v_mfma_f32_16x16x32_bf16 v[36:39], a[16:19], a[176:179], v[108:111]
ds_read_b128 a[56:59], v2 offset:22528
v_mov_b32 v5, s1
v_mfma_f32_16x16x32_bf16 v[36:39], a[20:23], a[180:183], v[36:39]
global_load_dword a244, v[4:5], off sc1
v_mfma_f32_16x16x32_bf16 v[36:39], a[24:27], a[184:187], v[36:39]
s_add_u32 s32, s32, 0x8000
v_exp_f32 v20, v20
v_mfma_f32_16x16x32_bf16 v[36:39], a[28:31], a[188:191], v[36:39]
ds_read_b128 a[60:63], v2 offset:23552
v_xor_b32 v2, 0x38000, v2
v_mfma_f32_16x16x32_bf16 v[40:43], a[16:19], a[192:195], v[88:91]
s_add_u32 s7, s7, 0x8000
v_exp_f32 v21, v21
v_mfma_f32_16x16x32_bf16 v[40:43], a[20:23], a[196:199], v[40:43]
s_xor_b32 s19, s19, 0x8000
v_exp_f32 v22, v22
v_mfma_f32_16x16x32_bf16 v[40:43], a[24:27], a[200:203], v[40:43]
s_sub_u32 s15, 7, s6
v_exp_f32 v23, v23
v_mfma_f32_16x16x32_bf16 v[40:43], a[28:31], a[204:207], v[40:43]
s_lshl_b32 s15, s15, 1
v_exp_f32 v24, v24
v_cvt_pk_bf16_f32 v63, v46, v47
v_mfma_f32_16x16x32_bf16 v[44:47], a[16:19], a[208:211], v[92:95]
v_exp_f32 v25, v25
v_mfma_f32_16x16x32_bf16 v[44:47], a[20:23], a[212:215], v[44:47]
v_exp_f32 v26, v26
v_mfma_f32_16x16x32_bf16 v[44:47], a[24:27], a[216:219], v[44:47]
s_waitcnt vmcnt(30) lgkmcnt(0)
v_exp_f32 v27, v27
v_mfma_f32_16x16x32_bf16 v[44:47], a[28:31], a[220:223], v[44:47]
s_barrier
v_cvt_pk_bf16_f32 v68, v20, v21
v_cvt_pk_bf16_f32 v69, v22, v23
s_cbranch_scc0 L_att_lh0_0
L_att_ls_0:
v_mfma_f32_16x16x32_bf16 v[160:163], a[32:35], v[52:55], v[160:163]
ds_read_b128 a[0:3], v1 offset:8192
v_cvt_pk_bf16_f32 v72, v24, v25
v_mfma_f32_16x16x32_bf16 v[192:195], a[32:35], v[56:59], v[192:195]
v_exp_f32 v28, v28
v_mfma_f32_16x16x32_bf16 v[224:227], a[32:35], v[60:63], v[224:227]
ds_read_b128 a[4:7], v1 offset:9216
v_cvt_pk_bf16_f32 v73, v26, v27
v_mfma_f32_16x16x32_bf16 v[228:231], a[36:39], v[60:63], v[228:231]
s_add_u32 m0, s27, 0x0
v_exp_f32 v29, v29
v_mfma_f32_16x16x32_bf16 v[196:199], a[36:39], v[56:59], v[196:199]
buffer_load_dwordx4 v3, s[48:51], s32 offen offset:0 sc1 lds
v_mfma_f32_16x16x32_bf16 v[164:167], a[36:39], v[52:55], v[164:167]
ds_read_b128 a[8:11], v1 offset:10240
v_cvt_pk_bf16_f32 v76, v28, v29
v_mfma_f32_16x16x32_bf16 v[168:171], a[40:43], v[52:55], v[168:171]
ds_read_b128 a[12:15], v1 offset:11264
v_accvgpr_read_b32 v6, a224
v_mfma_f32_16x16x32_bf16 v[200:203], a[40:43], v[56:59], v[200:203]
v_exp_f32 v30, v30
v_mfma_f32_16x16x32_bf16 v[232:235], a[40:43], v[60:63], v[232:235]
v_exp_f32 v31, v31
v_mfma_f32_16x16x32_bf16 v[236:239], a[44:47], v[60:63], v[236:239]
ds_read_b128 a[16:19], v1 offset:12288
v_cvt_pk_bf16_f32 v77, v30, v31
v_mfma_f32_16x16x32_bf16 v[204:207], a[44:47], v[56:59], v[204:207]
v_exp_f32 v36, v36
v_mfma_f32_16x16x32_bf16 v[172:175], a[44:47], v[52:55], v[172:175]
ds_read_b128 a[20:23], v1 offset:13312
v_accvgpr_read_b32 v7, a225
v_mfma_f32_16x16x32_bf16 v[176:179], a[48:51], v[52:55], v[176:179]
v_exp_f32 v37, v37
v_mfma_f32_16x16x32_bf16 v[208:211], a[48:51], v[56:59], v[208:211]
ds_read_b128 a[24:27], v1 offset:14336
v_cvt_pk_bf16_f32 v70, v36, v37
v_mfma_f32_16x16x32_bf16 v[240:243], a[48:51], v[60:63], v[240:243]
buffer_load_dwordx4 v3, s[48:51], s32 offen offset:1024 sc1 lds
v_mfma_f32_16x16x32_bf16 v[244:247], a[52:55], v[60:63], v[244:247]
v_exp_f32 v38, v38
v_mfma_f32_16x16x32_bf16 v[212:215], a[52:55], v[56:59], v[212:215]
ds_read_b128 a[28:31], v1 offset:15360
v_add_f32 v6, v6, v7
v_mfma_f32_16x16x32_bf16 v[180:183], a[52:55], v[52:55], v[180:183]
v_exp_f32 v39, v39
v_mfma_f32_16x16x32_bf16 v[184:187], a[56:59], v[52:55], v[184:187]
ds_read_b128 a[32:35], v1 offset:0
v_cvt_pk_bf16_f32 v71, v38, v39
v_mfma_f32_16x16x32_bf16 v[216:219], a[56:59], v[56:59], v[216:219]
v_exp_f32 v40, v40
v_mfma_f32_16x16x32_bf16 v[248:251], a[56:59], v[60:63], v[248:251]
ds_read_b128 a[36:39], v1 offset:1024
v_cmp_nge_f32 vcc, 0x6f800000, v6
v_mfma_f32_16x16x32_bf16 v[252:255], a[60:63], v[60:63], v[252:255]
v_exp_f32 v41, v41
v_mfma_f32_16x16x32_bf16 v[220:223], a[60:63], v[56:59], v[220:223]
v_exp_f32 v42, v42
v_mfma_f32_16x16x32_bf16 v[188:191], a[60:63], v[52:55], v[188:191]
ds_read_b128 a[40:43], v1 offset:2048
v_cvt_pk_bf16_f32 v74, v40, v41
v_mfma_f32_16x16x32_bf16 a[224:227], a[236:239], v[52:55], a[224:227]
buffer_load_dwordx4 v3, s[48:51], s32 offen offset:2048 sc1 lds
v_smfmac_f32_16x16x64_bf16 a[228:231], a[232:235], v[56:63], v9
ds_read_b128 a[44:47], v1 offset:3072
s_waitcnt lgkmcnt(8)
v_mfma_f32_16x16x32_bf16 v[24:27], a[0:3], a[192:195], v[88:91]
v_exp_f32 v43, v43
v_mfma_f32_16x16x32_bf16 v[24:27], a[4:7], a[196:199], v[24:27]
ds_read_b128 a[48:51], v1 offset:4096
v_cvt_pk_bf16_f32 v75, v42, v43
v_mfma_f32_16x16x32_bf16 v[24:27], a[8:11], a[200:203], v[24:27]
v_exp_f32 v44, v44
v_mfma_f32_16x16x32_bf16 v[24:27], a[12:15], a[204:207], v[24:27]
v_exp_f32 v45, v45
v_mfma_f32_16x16x32_bf16 v[28:31], a[0:3], a[208:211], v[92:95]
ds_read_b128 a[52:55], v1 offset:5120
v_cvt_pk_bf16_f32 v78, v44, v45
v_mfma_f32_16x16x32_bf16 v[28:31], a[4:7], a[212:215], v[28:31]
v_exp_f32 v46, v46
v_mfma_f32_16x16x32_bf16 v[28:31], a[8:11], a[216:219], v[28:31]
ds_read_b128 a[56:59], v1 offset:6144
v_mfma_f32_16x16x32_bf16 v[28:31], a[12:15], a[220:223], v[28:31]
s_waitcnt lgkmcnt(7)
v_exp_f32 v47, v47
v_mfma_f32_16x16x32_bf16 v[40:43], a[16:19], a[192:195], v[88:91]
buffer_load_dwordx4 v3, s[48:51], s32 offen offset:3072 sc1 lds
v_mfma_f32_16x16x32_bf16 v[40:43], a[20:23], a[196:199], v[40:43]
ds_read_b128 a[60:63], v1 offset:7168
v_cvt_pk_bf16_f32 v79, v46, v47
v_mfma_f32_16x16x32_bf16 v[40:43], a[24:27], a[200:203], v[40:43]
s_add_u32 s32, s32, 0x8000
v_exp_f32 v24, v24
v_mfma_f32_16x16x32_bf16 v[40:43], a[28:31], a[204:207], v[40:43]
v_exp_f32 v25, v25
v_mfma_f32_16x16x32_bf16 v[44:47], a[16:19], a[208:211], v[92:95]
v_exp_f32 v26, v26
v_mfma_f32_16x16x32_bf16 v[44:47], a[20:23], a[212:215], v[44:47]
v_exp_f32 v27, v27
v_mfma_f32_16x16x32_bf16 v[44:47], a[24:27], a[216:219], v[44:47]
v_exp_f32 v28, v28
v_mfma_f32_16x16x32_bf16 v[44:47], a[28:31], a[220:223], v[44:47]
s_waitcnt lgkmcnt(0)
v_exp_f32 v29, v29
v_mfma_f32_16x16x32_bf16 v[160:163], a[32:35], v[68:71], v[160:163]
ds_read_b128 a[0:3], v1 offset:24576
v_cvt_pk_bf16_f32 v56, v24, v25
v_mfma_f32_16x16x32_bf16 v[192:195], a[32:35], v[72:75], v[192:195]
v_exp_f32 v30, v30
v_mfma_f32_16x16x32_bf16 v[224:227], a[32:35], v[76:79], v[224:227]
ds_read_b128 a[4:7], v1 offset:25600
v_cvt_pk_bf16_f32 v57, v26, v27
v_mfma_f32_16x16x32_bf16 v[228:231], a[36:39], v[76:79], v[228:231]
s_add_u32 m0, s27, 0x1000
v_cvt_pk_bf16_f32 v60, v28, v29
v_mfma_f32_16x16x32_bf16 v[196:199], a[36:39], v[72:75], v[196:199]
buffer_load_dwordx4 v3, s[48:51], s7 offen offset:0 sc1 lds
v_mfma_f32_16x16x32_bf16 v[164:167], a[36:39], v[68:71], v[164:167]
ds_read_b128 a[8:11], v1 offset:26624
v_mfma_f32_16x16x32_bf16 v[168:171], a[40:43], v[68:71], v[168:171]
ds_read_b128 a[12:15], v1 offset:27648
v_mfma_f32_16x16x32_bf16 v[200:203], a[40:43], v[72:75], v[200:203]
v_exp_f32 v31, v31
v_mfma_f32_16x16x32_bf16 v[232:235], a[40:43], v[76:79], v[232:235]
v_exp_f32 v40, v40
v_mfma_f32_16x16x32_bf16 v[236:239], a[44:47], v[76:79], v[236:239]
ds_read_b128 a[16:19], v1 offset:28672
v_cvt_pk_bf16_f32 v61, v30, v31
v_mfma_f32_16x16x32_bf16 v[204:207], a[44:47], v[72:75], v[204:207]
v_exp_f32 v41, v41
v_mfma_f32_16x16x32_bf16 v[172:175], a[44:47], v[68:71], v[172:175]
ds_read_b128 a[20:23], v1 offset:29696
v_cvt_pk_bf16_f32 v58, v40, v41
v_mfma_f32_16x16x32_bf16 v[176:179], a[48:51], v[68:71], v[176:179]
v_rcp_f32 v6, v6
v_mfma_f32_16x16x32_bf16 v[208:211], a[48:51], v[72:75], v[208:211]
buffer_load_dwordx4 v3, s[48:51], s7 offen offset:1024 sc1 lds
v_mfma_f32_16x16x32_bf16 v[240:243], a[48:51], v[76:79], v[240:243]
ds_read_b128 a[24:27], v1 offset:30720
s_or_b64 s[34:35], s[34:35], vcc
v_mfma_f32_16x16x32_bf16 v[244:247], a[52:55], v[76:79], v[244:247]
ds_read_b128 a[28:31], v1 offset:31744
s_add_u32 s8, s28, 0x0
v_mfma_f32_16x16x32_bf16 v[212:215], a[52:55], v[72:75], v[212:215]
v_exp_f32 v42, v42
v_mfma_f32_16x16x32_bf16 v[180:183], a[52:55], v[68:71], v[180:183]
v_exp_f32 v43, v43
v_mfma_f32_16x16x32_bf16 v[184:187], a[56:59], v[68:71], v[184:187]
ds_read_b128 a[32:35], v1 offset:16384
v_cvt_pk_bf16_f32 v59, v42, v43
v_mfma_f32_16x16x32_bf16 v[216:219], a[56:59], v[72:75], v[216:219]
v_exp_f32 v44, v44
v_mfma_f32_16x16x32_bf16 v[248:251], a[56:59], v[76:79], v[248:251]
ds_read_b128 a[36:39], v1 offset:17408
v_mul_f32 v128, v6, v128
v_mfma_f32_16x16x32_bf16 v[252:255], a[60:63], v[76:79], v[252:255]
v_mul_f32 v129, v6, v129
v_mul_f32 v130, v6, v130
v_mfma_f32_16x16x32_bf16 v[220:223], a[60:63], v[72:75], v[220:223]
ds_read_b128 a[40:43], v1 offset:18432
v_mul_f32 v131, v6, v131
v_mfma_f32_16x16x32_bf16 v[188:191], a[60:63], v[68:71], v[188:191]
buffer_load_dwordx4 v3, s[48:51], s7 offen offset:2048 sc1 lds
v_mfma_f32_16x16x32_bf16 a[224:227], a[236:239], v[68:71], a[224:227]
ds_read_b128 a[44:47], v1 offset:19456
v_mul_f32 v132, v6, v132
v_smfmac_f32_16x16x64_bf16 a[228:231], a[232:235], v[72:79], v9
s_waitcnt lgkmcnt(8)
v_exp_f32 v45, v45
v_mfma_f32_16x16x32_bf16 v[24:27], a[0:3], a[192:195], v[88:91]
v_exp_f32 v46, v46
v_mfma_f32_16x16x32_bf16 v[24:27], a[4:7], a[196:199], v[24:27]
ds_read_b128 a[48:51], v1 offset:20480
v_cvt_pk_bf16_f32 v62, v44, v45
v_mfma_f32_16x16x32_bf16 v[24:27], a[8:11], a[200:203], v[24:27]
v_exp_f32 v47, v47
v_mfma_f32_16x16x32_bf16 v[24:27], a[12:15], a[204:207], v[24:27]
ds_read_b128 a[52:55], v1 offset:21504
v_cvt_pk_bf16_f32 v63, v46, v47
v_mfma_f32_16x16x32_bf16 v[28:31], a[0:3], a[208:211], v[92:95]
v_mul_f32 v133, v6, v133
v_mul_f32 v134, v6, v134
v_mfma_f32_16x16x32_bf16 v[28:31], a[4:7], a[212:215], v[28:31]
ds_read_b128 a[56:59], v1 offset:22528
v_mul_f32 v135, v6, v135
v_mfma_f32_16x16x32_bf16 v[28:31], a[8:11], a[216:219], v[28:31]
buffer_load_dwordx4 v3, s[48:51], s7 offen offset:3072 sc1 lds
v_mfma_f32_16x16x32_bf16 v[28:31], a[12:15], a[220:223], v[28:31]
ds_read_b128 a[60:63], v1 offset:23552
s_waitcnt lgkmcnt(8)
v_mfma_f32_16x16x32_bf16 v[40:43], a[16:19], a[192:195], v[88:91]
s_add_u32 s7, s7, 0x8000
v_xor_b32 v1, 0x8000, v1
v_cvt_pk_bf16_f32 v128, v128, v129
v_mfma_f32_16x16x32_bf16 v[40:43], a[20:23], a[196:199], v[40:43]
s_xor_b32 s27, s27, 0x38000
v_exp_f32 v24, v24
v_mfma_f32_16x16x32_bf16 v[40:43], a[24:27], a[200:203], v[40:43]
v_exp_f32 v25, v25
v_mfma_f32_16x16x32_bf16 v[40:43], a[28:31], a[204:207], v[40:43]
v_exp_f32 v26, v26
v_mfma_f32_16x16x32_bf16 v[44:47], a[16:19], a[208:211], v[92:95]
v_exp_f32 v27, v27
v_mfma_f32_16x16x32_bf16 v[44:47], a[20:23], a[212:215], v[44:47]
v_exp_f32 v28, v28
v_mfma_f32_16x16x32_bf16 v[44:47], a[24:27], a[216:219], v[44:47]
s_waitcnt vmcnt(29) lgkmcnt(0)
v_exp_f32 v29, v29
v_mfma_f32_16x16x32_bf16 v[44:47], a[28:31], a[220:223], v[44:47]
s_barrier
v_cvt_pk_bf16_f32 v129, v130, v131
v_cvt_pk_bf16_f32 v130, v132, v133
v_cvt_pk_bf16_f32 v131, v134, v135
buffer_store_dwordx4 v[128:131], v3, s[88:91], s8 offen sc1
s_add_u32 s8, s28, 0x2000
v_mul_f32 v136, v6, v136
v_mul_f32 v137, v6, v137
v_mul_f32 v138, v6, v138
v_mul_f32 v139, v6, v139
v_mul_f32 v140, v6, v140
v_mul_f32 v141, v6, v141
v_mul_f32 v142, v6, v142
v_mul_f32 v143, v6, v143
v_cvt_pk_bf16_f32 v136, v136, v137
v_cvt_pk_bf16_f32 v137, v138, v139
v_cvt_pk_bf16_f32 v138, v140, v141
v_cvt_pk_bf16_f32 v139, v142, v143
buffer_store_dwordx4 v[136:139], v3, s[88:91], s8 offen sc1
s_add_u32 s8, s28, 0x4000
v_mul_f32 v144, v6, v144
v_mul_f32 v145, v6, v145
v_mul_f32 v146, v6, v146
v_mul_f32 v147, v6, v147
v_mul_f32 v148, v6, v148
v_mul_f32 v149, v6, v149
v_mul_f32 v150, v6, v150
v_mul_f32 v151, v6, v151
v_cvt_pk_bf16_f32 v144, v144, v145
v_cvt_pk_bf16_f32 v145, v146, v147
v_cvt_pk_bf16_f32 v146, v148, v149
v_cvt_pk_bf16_f32 v147, v150, v151
buffer_store_dwordx4 v[144:147], v3, s[88:91], s8 offen sc1
s_add_u32 s8, s28, 0x6000
v_mul_f32 v152, v6, v152
v_mul_f32 v153, v6, v153
v_mul_f32 v154, v6, v154
v_mul_f32 v155, v6, v155
v_mul_f32 v156, v6, v156
v_mul_f32 v157, v6, v157
v_mul_f32 v158, v6, v158
v_mul_f32 v159, v6, v159
v_cvt_pk_bf16_f32 v152, v152, v153
v_cvt_pk_bf16_f32 v153, v154, v155
v_cvt_pk_bf16_f32 v154, v156, v157
v_cvt_pk_bf16_f32 v155, v158, v159
buffer_store_dwordx4 v[152:155], v3, s[88:91], s8 offen sc1
v_accvgpr_read_b32 v6, a226
v_accvgpr_read_b32 v7, a227
v_add_f32 v6, v6, v7
v_cmp_nge_f32 vcc, 0x6f800000, v6
v_rcp_f32 v6, v6
s_or_b64 s[34:35], s[34:35], vcc
s_add_u32 s8, s29, 0x0
v_pk_mul_f32 v[160:161], v[160:161], v[6:7] op_sel_hi:[1,0]
v_pk_mul_f32 v[162:163], v[162:163], v[6:7] op_sel_hi:[1,0]
v_pk_mul_f32 v[164:165], v[164:165], v[6:7] op_sel_hi:[1,0]
v_pk_mul_f32 v[166:167], v[166:167], v[6:7] op_sel_hi:[1,0]
v_cvt_pk_bf16_f32 v160, v160, v161
v_cvt_pk_bf16_f32 v161, v162, v163
v_cvt_pk_bf16_f32 v162, v164, v165
v_cvt_pk_bf16_f32 v163, v166, v167
buffer_store_dwordx4 v[160:163], v3, s[88:91], s8 offen sc1
s_add_u32 s8, s29, 0x2000
v_pk_mul_f32 v[168:169], v[168:169], v[6:7] op_sel_hi:[1,0]
v_pk_mul_f32 v[170:171], v[170:171], v[6:7] op_sel_hi:[1,0]
v_pk_mul_f32 v[172:173], v[172:173], v[6:7] op_sel_hi:[1,0]
v_pk_mul_f32 v[174:175], v[174:175], v[6:7] op_sel_hi:[1,0]
v_cvt_pk_bf16_f32 v168, v168, v169
v_cvt_pk_bf16_f32 v169, v170, v171
v_cvt_pk_bf16_f32 v170, v172, v173
v_cvt_pk_bf16_f32 v171, v174, v175
buffer_store_dwordx4 v[168:171], v3, s[88:91], s8 offen sc1
s_add_u32 s8, s29, 0x4000
v_pk_mul_f32 v[176:177], v[176:177], v[6:7] op_sel_hi:[1,0]
v_pk_mul_f32 v[178:179], v[178:179], v[6:7] op_sel_hi:[1,0]
v_pk_mul_f32 v[180:181], v[180:181], v[6:7] op_sel_hi:[1,0]
v_pk_mul_f32 v[182:183], v[182:183], v[6:7] op_sel_hi:[1,0]
v_cvt_pk_bf16_f32 v176, v176, v177
v_cvt_pk_bf16_f32 v177, v178, v179
v_cvt_pk_bf16_f32 v178, v180, v181
v_cvt_pk_bf16_f32 v179, v182, v183
buffer_store_dwordx4 v[176:179], v3, s[88:91], s8 offen sc1
s_add_u32 s8, s29, 0x6000
v_pk_mul_f32 v[184:185], v[184:185], v[6:7] op_sel_hi:[1,0]
v_pk_mul_f32 v[186:187], v[186:187], v[6:7] op_sel_hi:[1,0]
v_pk_mul_f32 v[188:189], v[188:189], v[6:7] op_sel_hi:[1,0]
v_pk_mul_f32 v[190:191], v[190:191], v[6:7] op_sel_hi:[1,0]
v_cvt_pk_bf16_f32 v184, v184, v185
v_cvt_pk_bf16_f32 v185, v186, v187
v_cvt_pk_bf16_f32 v186, v188, v189
v_cvt_pk_bf16_f32 v187, v190, v191
buffer_store_dwordx4 v[184:187], v3, s[88:91], s8 offen sc1
s_getreg_b32 s8, hwreg(HW_REG_HW_ID, 5, 1)
s_cmp_lg_u32 s8, 0
s_cbranch_scc1 L_att_sodd1
s_branch L_att_sodd0
L_att_lh0_0:
v_mfma_f32_16x16x32_bf16 v[160:163], a[32:35], v[52:55], v[160:163]
ds_read_b128 a[0:3], v1 offset:8192
v_cvt_pk_bf16_f32 v72, v24, v25
v_mfma_f32_16x16x32_bf16 v[192:195], a[32:35], v[56:59], v[192:195]
v_exp_f32 v28, v28
v_mfma_f32_16x16x32_bf16 v[224:227], a[32:35], v[60:63], v[224:227]
ds_read_b128 a[4:7], v1 offset:9216
v_cvt_pk_bf16_f32 v73, v26, v27
v_mfma_f32_16x16x32_bf16 v[228:231], a[36:39], v[60:63], v[228:231]
v_exp_f32 v29, v29
v_mfma_f32_16x16x32_bf16 v[196:199], a[36:39], v[56:59], v[196:199]
buffer_load_dword v14, v15, s[84:87], 0 offen offset:192 sc1
v_mfma_f32_16x16x32_bf16 v[164:167], a[36:39], v[52:55], v[164:167]
ds_read_b128 a[8:11], v1 offset:10240
v_cvt_pk_bf16_f32 v76, v28, v29
v_mfma_f32_16x16x32_bf16 v[168:171], a[40:43], v[52:55], v[168:171]
ds_read_b128 a[12:15], v1 offset:11264
v_mfma_f32_16x16x32_bf16 v[200:203], a[40:43], v[56:59], v[200:203]
v_exp_f32 v30, v30
v_mfma_f32_16x16x32_bf16 v[232:235], a[40:43], v[60:63], v[232:235]
v_exp_f32 v31, v31
v_mfma_f32_16x16x32_bf16 v[236:239], a[44:47], v[60:63], v[236:239]
ds_read_b128 a[16:19], v1 offset:12288
v_cvt_pk_bf16_f32 v77, v30, v31
v_mfma_f32_16x16x32_bf16 v[204:207], a[44:47], v[56:59], v[204:207]
s_add_u32 m0, s17, 0x10000
v_exp_f32 v36, v36
v_mfma_f32_16x16x32_bf16 v[172:175], a[44:47], v[52:55], v[172:175]
ds_read_b128 a[20:23], v1 offset:13312
v_mfma_f32_16x16x32_bf16 v[176:179], a[48:51], v[52:55], v[176:179]
buffer_load_dwordx4 v12, s[72:75], 0 offen lds
v_mfma_f32_16x16x32_bf16 v[208:211], a[48:51], v[56:59], v[208:211]
ds_read_b128 a[24:27], v1 offset:14336
v_mfma_f32_16x16x32_bf16 v[240:243], a[48:51], v[60:63], v[240:243]
v_exp_f32 v37, v37
v_mfma_f32_16x16x32_bf16 v[244:247], a[52:55], v[60:63], v[244:247]
v_exp_f32 v38, v38
v_mfma_f32_16x16x32_bf16 v[212:215], a[52:55], v[56:59], v[212:215]
ds_read_b128 a[28:31], v1 offset:15360
v_cvt_pk_bf16_f32 v70, v36, v37
v_mfma_f32_16x16x32_bf16 v[180:183], a[52:55], v[52:55], v[180:183]
v_exp_f32 v39, v39
v_mfma_f32_16x16x32_bf16 v[184:187], a[56:59], v[52:55], v[184:187]
ds_read_b128 a[32:35], v1 offset:0
v_cvt_pk_bf16_f32 v71, v38, v39
v_mfma_f32_16x16x32_bf16 v[216:219], a[56:59], v[56:59], v[216:219]
v_exp_f32 v40, v40
v_mfma_f32_16x16x32_bf16 v[248:251], a[56:59], v[60:63], v[248:251]
buffer_load_dwordx4 v13, s[72:75], 0 offen offset:1024 lds
v_mfma_f32_16x16x32_bf16 v[252:255], a[60:63], v[60:63], v[252:255]
ds_read_b128 a[36:39], v1 offset:1024
v_mfma_f32_16x16x32_bf16 v[220:223], a[60:63], v[56:59], v[220:223]
v_exp_f32 v41, v41
v_mfma_f32_16x16x32_bf16 v[188:191], a[60:63], v[52:55], v[188:191]
ds_read_b128 a[40:43], v1 offset:2048
v_cvt_pk_bf16_f32 v74, v40, v41
v_mfma_f32_16x16x32_bf16 a[224:227], a[236:239], v[52:55], a[224:227]
s_waitcnt lgkmcnt(7)
v_exp_f32 v42, v42
v_smfmac_f32_16x16x64_bf16 a[228:231], a[232:235], v[56:63], v9
ds_read_b128 a[44:47], v1 offset:3072
v_mfma_f32_16x16x32_bf16 v[24:27], a[0:3], a[192:195], v[112:115]
v_exp_f32 v43, v43
v_mfma_f32_16x16x32_bf16 v[24:27], a[4:7], a[196:199], v[24:27]
ds_read_b128 a[48:51], v1 offset:4096
v_cvt_pk_bf16_f32 v75, v42, v43
v_mfma_f32_16x16x32_bf16 v[24:27], a[8:11], a[200:203], v[24:27]
buffer_load_dwordx4 v12, s[72:75], s12 offen offset:2048 lds
v_mfma_f32_16x16x32_bf16 v[24:27], a[12:15], a[204:207], v[24:27]
v_exp_f32 v44, v44
v_mfma_f32_16x16x32_bf16 v[28:31], a[0:3], a[208:211], v[92:95]
ds_read_b128 a[52:55], v1 offset:5120
v_exp_f32 v45, v45
v_mfma_f32_16x16x32_bf16 v[28:31], a[4:7], a[212:215], v[28:31]
v_exp_f32 v46, v46
v_mfma_f32_16x16x32_bf16 v[28:31], a[8:11], a[216:219], v[28:31]
ds_read_b128 a[56:59], v1 offset:6144
v_cvt_pk_bf16_f32 v78, v44, v45
v_mfma_f32_16x16x32_bf16 v[28:31], a[12:15], a[220:223], v[28:31]
s_waitcnt lgkmcnt(7)
v_exp_f32 v47, v47
v_mfma_f32_16x16x32_bf16 v[40:43], a[16:19], a[192:195], v[116:119]
ds_read_b128 a[60:63], v1 offset:7168
v_cvt_pk_bf16_f32 v79, v46, v47
v_mfma_f32_16x16x32_bf16 v[40:43], a[20:23], a[196:199], v[40:43]
v_exp_f32 v24, v24
v_mfma_f32_16x16x32_bf16 v[40:43], a[24:27], a[200:203], v[40:43]
buffer_load_dwordx4 v13, s[72:75], s12 offen offset:3072 lds
v_mfma_f32_16x16x32_bf16 v[40:43], a[28:31], a[204:207], v[40:43]
v_exp_f32 v25, v25
v_mfma_f32_16x16x32_bf16 v[44:47], a[16:19], a[208:211], v[92:95]
v_exp_f32 v26, v26
v_mfma_f32_16x16x32_bf16 v[44:47], a[20:23], a[212:215], v[44:47]
v_exp_f32 v27, v27
v_mfma_f32_16x16x32_bf16 v[44:47], a[24:27], a[216:219], v[44:47]
v_exp_f32 v28, v28
v_mfma_f32_16x16x32_bf16 v[44:47], a[28:31], a[220:223], v[44:47]
s_waitcnt lgkmcnt(0)
v_exp_f32 v29, v29
v_mfma_f32_16x16x32_bf16 v[160:163], a[32:35], v[68:71], v[160:163]
v_exp_f32 v30, v30
v_mfma_f32_16x16x32_bf16 v[192:195], a[32:35], v[72:75], v[192:195]
v_exp_f32 v31, v31
v_mfma_f32_16x16x32_bf16 v[224:227], a[32:35], v[76:79], v[224:227]
ds_read_b128 a[0:3], v1 offset:24576
v_cvt_pk_bf16_f32 v56, v24, v25
v_mfma_f32_16x16x32_bf16 v[228:231], a[36:39], v[76:79], v[228:231]
ds_read_b128 a[4:7], v1 offset:25600
v_add_u32 v12, 0x20000, v12
v_mfma_f32_16x16x32_bf16 v[196:199], a[36:39], v[72:75], v[196:199]
s_add_u32 m0, s17, 0x14000
v_exp_f32 v40, v40
v_mfma_f32_16x16x32_bf16 v[164:167], a[36:39], v[68:71], v[164:167]
buffer_load_dwordx4 v12, s[72:75], 0 offen lds
v_mfma_f32_16x16x32_bf16 v[168:171], a[40:43], v[68:71], v[168:171]
ds_read_b128 a[8:11], v1 offset:26624
v_cvt_pk_bf16_f32 v57, v26, v27
v_mfma_f32_16x16x32_bf16 v[200:203], a[40:43], v[72:75], v[200:203]
ds_read_b128 a[12:15], v1 offset:27648
v_cvt_pk_bf16_f32 v60, v28, v29
v_mfma_f32_16x16x32_bf16 v[232:235], a[40:43], v[76:79], v[232:235]
ds_read_b128 a[16:19], v1 offset:28672
v_cvt_pk_bf16_f32 v61, v30, v31
v_mfma_f32_16x16x32_bf16 v[236:239], a[44:47], v[76:79], v[236:239]
v_exp_f32 v41, v41
v_mfma_f32_16x16x32_bf16 v[204:207], a[44:47], v[72:75], v[204:207]
v_exp_f32 v42, v42
v_mfma_f32_16x16x32_bf16 v[172:175], a[44:47], v[68:71], v[172:175]
ds_read_b128 a[20:23], v1 offset:29696
v_cvt_pk_bf16_f32 v58, v40, v41
v_mfma_f32_16x16x32_bf16 v[176:179], a[48:51], v[68:71], v[176:179]
ds_read_b128 a[24:27], v1 offset:30720
v_add_u32 v13, 0x20000, v13
v_mfma_f32_16x16x32_bf16 v[208:211], a[48:51], v[72:75], v[208:211]
buffer_load_dwordx4 v13, s[72:75], 0 offen offset:1024 lds
v_mfma_f32_16x16x32_bf16 v[240:243], a[48:51], v[76:79], v[240:243]
ds_read_b128 a[28:31], v1 offset:31744
v_mfma_f32_16x16x32_bf16 v[244:247], a[52:55], v[76:79], v[244:247]
ds_read_b128 a[32:35], v1 offset:16384
v_mfma_f32_16x16x32_bf16 v[212:215], a[52:55], v[72:75], v[212:215]
v_exp_f32 v43, v43
v_mfma_f32_16x16x32_bf16 v[180:183], a[52:55], v[68:71], v[180:183]
v_exp_f32 v44, v44
v_mfma_f32_16x16x32_bf16 v[184:187], a[56:59], v[68:71], v[184:187]
buffer_load_dwordx4 v12, s[72:75], s12 offen offset:2048 lds
v_mfma_f32_16x16x32_bf16 v[216:219], a[56:59], v[72:75], v[216:219]
ds_read_b128 a[36:39], v1 offset:17408
v_cvt_pk_bf16_f32 v59, v42, v43
v_mfma_f32_16x16x32_bf16 v[248:251], a[56:59], v[76:79], v[248:251]
ds_read_b128 a[40:43], v1 offset:18432
v_mfma_f32_16x16x32_bf16 v[252:255], a[60:63], v[76:79], v[252:255]
ds_read_b128 a[44:47], v1 offset:19456
v_mfma_f32_16x16x32_bf16 v[220:223], a[60:63], v[72:75], v[220:223]
v_exp_f32 v45, v45
v_mfma_f32_16x16x32_bf16 v[188:191], a[60:63], v[68:71], v[188:191]
ds_read_b128 a[48:51], v1 offset:20480
v_cvt_pk_bf16_f32 v62, v44, v45
v_mfma_f32_16x16x32_bf16 a[224:227], a[236:239], v[68:71], a[224:227]
ds_read_b128 a[52:55], v1 offset:21504
v_smfmac_f32_16x16x64_bf16 a[228:231], a[232:235], v[72:79], v9
s_waitcnt lgkmcnt(10)
v_exp_f32 v46, v46
v_mfma_f32_16x16x32_bf16 v[28:31], a[0:3], a[208:211], v[92:95]
v_exp_f32 v47, v47
v_mfma_f32_16x16x32_bf16 v[28:31], a[4:7], a[212:215], v[28:31]
buffer_load_dwordx4 v13, s[72:75], s12 offen offset:3072 lds
v_mfma_f32_16x16x32_bf16 v[28:31], a[8:11], a[216:219], v[28:31]
ds_read_b128 a[56:59], v1 offset:22528
v_cvt_pk_bf16_f32 v63, v46, v47
v_mfma_f32_16x16x32_bf16 v[28:31], a[12:15], a[220:223], v[28:31]
ds_read_b128 a[60:63], v1 offset:23552
s_waitcnt lgkmcnt(8)
v_mfma_f32_16x16x32_bf16 v[44:47], a[16:19], a[208:211], v[92:95]
v_xor_b32 v1, 0x8000, v1
v_mfma_f32_16x16x32_bf16 v[44:47], a[20:23], a[212:215], v[44:47]
v_mfma_f32_16x16x32_bf16 v[44:47], a[24:27], a[216:219], v[44:47]
v_mfma_f32_16x16x32_bf16 v[44:47], a[28:31], a[220:223], v[44:47]
v_accvgpr_read_b32 v6, a224
v_accvgpr_read_b32 v7, a225
v_add_f32 v6, v6, v7
v_cmp_nge_f32 vcc, 0x6f800000, v6
v_rcp_f32 v6, v6
s_or_b64 s[34:35], s[34:35], vcc
s_add_u32 s8, s28, 0x0
v_pk_mul_f32 v[128:129], v[128:129], v[6:7] op_sel_hi:[1,0]
v_pk_mul_f32 v[130:131], v[130:131], v[6:7] op_sel_hi:[1,0]
v_pk_mul_f32 v[132:133], v[132:133], v[6:7] op_sel_hi:[1,0]
v_pk_mul_f32 v[134:135], v[134:135], v[6:7] op_sel_hi:[1,0]
v_cvt_pk_bf16_f32 v128, v128, v129
v_cvt_pk_bf16_f32 v129, v130, v131
v_cvt_pk_bf16_f32 v130, v132, v133
v_cvt_pk_bf16_f32 v131, v134, v135
buffer_store_dwordx4 v[128:131], v3, s[88:91], s8 offen sc1
s_add_u32 s8, s28, 0x2000
v_pk_mul_f32 v[136:137], v[136:137], v[6:7] op_sel_hi:[1,0]
v_pk_mul_f32 v[138:139], v[138:139], v[6:7] op_sel_hi:[1,0]
v_pk_mul_f32 v[140:141], v[140:141], v[6:7] op_sel_hi:[1,0]
v_pk_mul_f32 v[142:143], v[142:143], v[6:7] op_sel_hi:[1,0]
v_cvt_pk_bf16_f32 v136, v136, v137
v_cvt_pk_bf16_f32 v137, v138, v139
v_cvt_pk_bf16_f32 v138, v140, v141
v_cvt_pk_bf16_f32 v139, v142, v143
buffer_store_dwordx4 v[136:139], v3, s[88:91], s8 offen sc1
s_add_u32 s8, s28, 0x4000
v_pk_mul_f32 v[144:145], v[144:145], v[6:7] op_sel_hi:[1,0]
v_pk_mul_f32 v[146:147], v[146:147], v[6:7] op_sel_hi:[1,0]
v_pk_mul_f32 v[148:149], v[148:149], v[6:7] op_sel_hi:[1,0]
v_pk_mul_f32 v[150:151], v[150:151], v[6:7] op_sel_hi:[1,0]
v_cvt_pk_bf16_f32 v144, v144, v145
v_cvt_pk_bf16_f32 v145, v146, v147
v_cvt_pk_bf16_f32 v146, v148, v149
v_cvt_pk_bf16_f32 v147, v150, v151
buffer_store_dwordx4 v[144:147], v3, s[88:91], s8 offen sc1
s_add_u32 s8, s28, 0x6000
v_pk_mul_f32 v[152:153], v[152:153], v[6:7] op_sel_hi:[1,0]
v_pk_mul_f32 v[154:155], v[154:155], v[6:7] op_sel_hi:[1,0]
v_pk_mul_f32 v[156:157], v[156:157], v[6:7] op_sel_hi:[1,0]
v_pk_mul_f32 v[158:159], v[158:159], v[6:7] op_sel_hi:[1,0]
v_cvt_pk_bf16_f32 v152, v152, v153
v_cvt_pk_bf16_f32 v153, v154, v155
v_cvt_pk_bf16_f32 v154, v156, v157
v_cvt_pk_bf16_f32 v155, v158, v159
buffer_store_dwordx4 v[152:155], v3, s[88:91], s8 offen sc1
v_accvgpr_read_b32 v6, a226
v_accvgpr_read_b32 v7, a227
v_add_f32 v6, v6, v7
v_cmp_nge_f32 vcc, 0x6f800000, v6
v_rcp_f32 v6, v6
s_or_b64 s[34:35], s[34:35], vcc
s_add_u32 s8, s29, 0x0
v_pk_mul_f32 v[160:161], v[160:161], v[6:7] op_sel_hi:[1,0]
v_pk_mul_f32 v[162:163], v[162:163], v[6:7] op_sel_hi:[1,0]
v_pk_mul_f32 v[164:165], v[164:165], v[6:7] op_sel_hi:[1,0]
v_pk_mul_f32 v[166:167], v[166:167], v[6:7] op_sel_hi:[1,0]
v_cvt_pk_bf16_f32 v160, v160, v161
v_cvt_pk_bf16_f32 v161, v162, v163
v_cvt_pk_bf16_f32 v162, v164, v165
v_cvt_pk_bf16_f32 v163, v166, v167
buffer_store_dwordx4 v[160:163], v3, s[88:91], s8 offen sc1
s_add_u32 s8, s29, 0x2000
v_pk_mul_f32 v[168:169], v[168:169], v[6:7] op_sel_hi:[1,0]
v_pk_mul_f32 v[170:171], v[170:171], v[6:7] op_sel_hi:[1,0]
v_pk_mul_f32 v[172:173], v[172:173], v[6:7] op_sel_hi:[1,0]
v_pk_mul_f32 v[174:175], v[174:175], v[6:7] op_sel_hi:[1,0]
v_cvt_pk_bf16_f32 v168, v168, v169
v_cvt_pk_bf16_f32 v169, v170, v171
v_cvt_pk_bf16_f32 v170, v172, v173
v_cvt_pk_bf16_f32 v171, v174, v175
buffer_store_dwordx4 v[168:171], v3, s[88:91], s8 offen sc1
s_add_u32 s8, s29, 0x4000
v_pk_mul_f32 v[176:177], v[176:177], v[6:7] op_sel_hi:[1,0]
v_pk_mul_f32 v[178:179], v[178:179], v[6:7] op_sel_hi:[1,0]
v_pk_mul_f32 v[180:181], v[180:181], v[6:7] op_sel_hi:[1,0]
v_pk_mul_f32 v[182:183], v[182:183], v[6:7] op_sel_hi:[1,0]
v_cvt_pk_bf16_f32 v176, v176, v177
v_cvt_pk_bf16_f32 v177, v178, v179
v_cvt_pk_bf16_f32 v178, v180, v181
v_cvt_pk_bf16_f32 v179, v182, v183
buffer_store_dwordx4 v[176:179], v3, s[88:91], s8 offen sc1
s_add_u32 s8, s29, 0x6000
v_pk_mul_f32 v[184:185], v[184:185], v[6:7] op_sel_hi:[1,0]
v_pk_mul_f32 v[186:187], v[186:187], v[6:7] op_sel_hi:[1,0]
v_pk_mul_f32 v[188:189], v[188:189], v[6:7] op_sel_hi:[1,0]
v_pk_mul_f32 v[190:191], v[190:191], v[6:7] op_sel_hi:[1,0]
v_cvt_pk_bf16_f32 v184, v184, v185
v_cvt_pk_bf16_f32 v185, v186, v187
v_cvt_pk_bf16_f32 v186, v188, v189
v_cvt_pk_bf16_f32 v187, v190, v191
buffer_store_dwordx4 v[184:187], v3, s[88:91], s8 offen sc1
s_branch L_att_h1_0
L_att_dl0_1:
v_mfma_f32_16x16x32_bf16 v[128:131], a[32:35], v[48:51], v[128:131]
ds_read_b128 a[0:3], v1 offset:8192
v_cvt_pk_bf16_f32 v72, v24, v25
v_mfma_f32_16x16x32_bf16 v[160:163], a[32:35], v[52:55], v[160:163]
v_exp_f32 v28, v28
v_mfma_f32_16x16x32_bf16 v[192:195], a[32:35], v[56:59], v[192:195]
v_cvt_pk_bf16_f32 v73, v26, v27
v_mfma_f32_16x16x32_bf16 v[224:227], a[32:35], v[60:63], v[224:227]
ds_read_b128 a[4:7], v1 offset:9216
v_mfma_f32_16x16x32_bf16 v[228:231], a[36:39], v[60:63], v[228:231]
v_exp_f32 v29, v29
v_mfma_f32_16x16x32_bf16 v[196:199], a[36:39], v[56:59], v[196:199]
s_add_u32 m0, s27, 0x0
v_exp_f32 v30, v30
v_mfma_f32_16x16x32_bf16 v[164:167], a[36:39], v[52:55], v[164:167]
buffer_load_dwordx4 v3, s[48:51], s32 offen offset:0 sc1 lds
v_mfma_f32_16x16x32_bf16 v[132:135], a[36:39], v[48:51], v[132:135]
ds_read_b128 a[8:11], v1 offset:10240
v_cvt_pk_bf16_f32 v76, v28, v29
v_mfma_f32_16x16x32_bf16 v[136:139], a[40:43], v[48:51], v[136:139]
v_mfma_f32_16x16x32_bf16 v[168:171], a[40:43], v[52:55], v[168:171]
v_exp_f32 v31, v31
v_mfma_f32_16x16x32_bf16 v[200:203], a[40:43], v[56:59], v[200:203]
v_exp_f32 v32, v32
v_mfma_f32_16x16x32_bf16 v[232:235], a[40:43], v[60:63], v[232:235]
ds_read_b128 a[12:15], v1 offset:11264
v_cvt_pk_bf16_f32 v77, v30, v31
v_mfma_f32_16x16x32_bf16 v[236:239], a[44:47], v[60:63], v[236:239]
v_mfma_f32_16x16x32_bf16 v[204:207], a[44:47], v[56:59], v[204:207]
v_exp_f32 v33, v33
v_mfma_f32_16x16x32_bf16 v[172:175], a[44:47], v[52:55], v[172:175]
v_exp_f32 v34, v34
v_mfma_f32_16x16x32_bf16 v[140:143], a[44:47], v[48:51], v[140:143]
ds_read_b128 a[16:19], v1 offset:12288
v_cvt_pk_bf16_f32 v66, v32, v33
v_mfma_f32_16x16x32_bf16 v[144:147], a[48:51], v[48:51], v[144:147]
v_exp_f32 v35, v35
v_mfma_f32_16x16x32_bf16 v[176:179], a[48:51], v[52:55], v[176:179]
v_cvt_pk_bf16_f32 v67, v34, v35
v_mfma_f32_16x16x32_bf16 v[208:211], a[48:51], v[56:59], v[208:211]
v_exp_f32 v36, v36
v_mfma_f32_16x16x32_bf16 v[240:243], a[48:51], v[60:63], v[240:243]
buffer_load_dwordx4 v3, s[48:51], s32 offen offset:1024 sc1 lds
v_mfma_f32_16x16x32_bf16 v[244:247], a[52:55], v[60:63], v[244:247]
ds_read_b128 a[20:23], v1 offset:13312
v_mfma_f32_16x16x32_bf16 v[212:215], a[52:55], v[56:59], v[212:215]
v_exp_f32 v37, v37
v_mfma_f32_16x16x32_bf16 v[180:183], a[52:55], v[52:55], v[180:183]
ds_read_b128 a[24:27], v1 offset:14336
v_cvt_pk_bf16_f32 v70, v36, v37
v_mfma_f32_16x16x32_bf16 v[148:151], a[52:55], v[48:51], v[148:151]
v_mfma_f32_16x16x32_bf16 v[152:155], a[56:59], v[48:51], v[152:155]
v_exp_f32 v38, v38
v_mfma_f32_16x16x32_bf16 v[184:187], a[56:59], v[52:55], v[184:187]
v_exp_f32 v39, v39
v_mfma_f32_16x16x32_bf16 v[216:219], a[56:59], v[56:59], v[216:219]
ds_read_b128 a[28:31], v1 offset:15360
v_cvt_pk_bf16_f32 v71, v38, v39
v_mfma_f32_16x16x32_bf16 v[248:251], a[56:59], v[60:63], v[248:251]
v_exp_f32 v40, v40
v_mfma_f32_16x16x32_bf16 v[252:255], a[60:63], v[60:63], v[252:255]
v_mfma_f32_16x16x32_bf16 v[220:223], a[60:63], v[56:59], v[220:223]
v_exp_f32 v41, v41
v_mfma_f32_16x16x32_bf16 v[188:191], a[60:63], v[52:55], v[188:191]
ds_read_b128 a[32:35], v1 offset:0
v_cvt_pk_bf16_f32 v74, v40, v41
v_mfma_f32_16x16x32_bf16 v[156:159], a[60:63], v[48:51], v[156:159]
v_exp_f32 v42, v42
v_smfmac_f32_16x16x64_bf16 a[224:227], a[232:235], v[48:55], v9
buffer_load_dwordx4 v3, s[48:51], s32 offen offset:2048 sc1 lds
v_smfmac_f32_16x16x64_bf16 a[228:231], a[232:235], v[56:63], v9
s_waitcnt lgkmcnt(5)
v_mfma_f32_16x16x32_bf16 v[16:19], a[0:3], a[160:163], v[80:83]
ds_read_b128 a[36:39], v1 offset:1024
v_mfma_f32_16x16x32_bf16 v[16:19], a[4:7], a[164:167], v[16:19]
v_exp_f32 v43, v43
v_mfma_f32_16x16x32_bf16 v[16:19], a[8:11], a[168:171], v[16:19]
v_exp_f32 v44, v44
v_mfma_f32_16x16x32_bf16 v[16:19], a[12:15], a[172:175], v[16:19]
v_exp_f32 v45, v45
v_mfma_f32_16x16x32_bf16 v[20:23], a[0:3], a[176:179], v[84:87]
ds_read_b128 a[40:43], v1 offset:2048
v_cvt_pk_bf16_f32 v75, v42, v43
v_mfma_f32_16x16x32_bf16 v[20:23], a[4:7], a[180:183], v[20:23]
v_cvt_pk_bf16_f32 v78, v44, v45
v_mfma_f32_16x16x32_bf16 v[20:23], a[8:11], a[184:187], v[20:23]
v_exp_f32 v46, v46
v_mfma_f32_16x16x32_bf16 v[20:23], a[12:15], a[188:191], v[20:23]
ds_read_b128 a[44:47], v1 offset:3072
v_mfma_f32_16x16x32_bf16 v[24:27], a[0:3], a[192:195], v[88:91]
v_exp_f32 v47, v47
v_mfma_f32_16x16x32_bf16 v[24:27], a[4:7], a[196:199], v[24:27]
v_cvt_pk_bf16_f32 v79, v46, v47
v_mfma_f32_16x16x32_bf16 v[24:27], a[8:11], a[200:203], v[24:27]
buffer_load_dwordx4 v3, s[48:51], s32 offen offset:3072 sc1 lds
v_mfma_f32_16x16x32_bf16 v[24:27], a[12:15], a[204:207], v[24:27]
ds_read_b128 a[48:51], v1 offset:4096
v_mfma_f32_16x16x32_bf16 v[28:31], a[0:3], a[208:211], v[92:95]
v_exp_f32 v16, v16
v_mfma_f32_16x16x32_bf16 v[28:31], a[4:7], a[212:215], v[28:31]
v_exp_f32 v17, v17
v_mfma_f32_16x16x32_bf16 v[28:31], a[8:11], a[216:219], v[28:31]
s_waitcnt lgkmcnt(5)
v_exp_f32 v18, v18
v_mfma_f32_16x16x32_bf16 v[28:31], a[12:15], a[220:223], v[28:31]
ds_read_b128 a[52:55], v1 offset:5120
v_cvt_pk_bf16_f32 v48, v16, v17
v_mfma_f32_16x16x32_bf16 v[32:35], a[16:19], a[160:163], v[80:83]
v_mfma_f32_16x16x32_bf16 v[32:35], a[20:23], a[164:167], v[32:35]
v_exp_f32 v19, v19
v_mfma_f32_16x16x32_bf16 v[32:35], a[24:27], a[168:171], v[32:35]
v_exp_f32 v20, v20
v_mfma_f32_16x16x32_bf16 v[32:35], a[28:31], a[172:175], v[32:35]
ds_read_b128 a[56:59], v1 offset:6144
v_cvt_pk_bf16_f32 v49, v18, v19
v_mfma_f32_16x16x32_bf16 v[36:39], a[16:19], a[176:179], v[84:87]
v_mfma_f32_16x16x32_bf16 v[36:39], a[20:23], a[180:183], v[36:39]
v_exp_f32 v21, v21
v_mfma_f32_16x16x32_bf16 v[36:39], a[24:27], a[184:187], v[36:39]
s_add_u32 m0, s27, 0x1000
v_exp_f32 v22, v22
v_mfma_f32_16x16x32_bf16 v[36:39], a[28:31], a[188:191], v[36:39]
buffer_load_dwordx4 v3, s[48:51], s7 offen offset:0 sc1 lds
v_mfma_f32_16x16x32_bf16 v[40:43], a[16:19], a[192:195], v[88:91]
ds_read_b128 a[60:63], v1 offset:7168
v_cvt_pk_bf16_f32 v52, v20, v21
v_mfma_f32_16x16x32_bf16 v[40:43], a[20:23], a[196:199], v[40:43]
v_exp_f32 v23, v23
v_mfma_f32_16x16x32_bf16 v[40:43], a[24:27], a[200:203], v[40:43]
v_cvt_pk_bf16_f32 v53, v22, v23
v_mfma_f32_16x16x32_bf16 v[40:43], a[28:31], a[204:207], v[40:43]
v_exp_f32 v24, v24
v_mfma_f32_16x16x32_bf16 v[44:47], a[16:19], a[208:211], v[92:95]
v_exp_f32 v25, v25
v_mfma_f32_16x16x32_bf16 v[44:47], a[20:23], a[212:215], v[44:47]
v_exp_f32 v26, v26
v_mfma_f32_16x16x32_bf16 v[44:47], a[24:27], a[216:219], v[44:47]
v_exp_f32 v27, v27
v_mfma_f32_16x16x32_bf16 v[44:47], a[28:31], a[220:223], v[44:47]
s_waitcnt lgkmcnt(0)
v_mfma_f32_16x16x32_bf16 v[128:131], a[32:35], v[64:67], v[128:131]
ds_read_b128 a[0:3], v1 offset:24576
v_cvt_pk_bf16_f32 v56, v24, v25
v_mfma_f32_16x16x32_bf16 v[160:163], a[32:35], v[68:71], v[160:163]
v_exp_f32 v28, v28
v_mfma_f32_16x16x32_bf16 v[192:195], a[32:35], v[72:75], v[192:195]
v_cvt_pk_bf16_f32 v57, v26, v27
v_mfma_f32_16x16x32_bf16 v[224:227], a[32:35], v[76:79], v[224:227]
ds_read_b128 a[4:7], v1 offset:25600
v_mfma_f32_16x16x32_bf16 v[228:231], a[36:39], v[76:79], v[228:231]
v_exp_f32 v29, v29
v_mfma_f32_16x16x32_bf16 v[196:199], a[36:39], v[72:75], v[196:199]
v_exp_f32 v30, v30
v_mfma_f32_16x16x32_bf16 v[164:167], a[36:39], v[68:71], v[164:167]
v_cvt_pk_bf16_f32 v60, v28, v29
v_mfma_f32_16x16x32_bf16 v[132:135], a[36:39], v[64:67], v[132:135]
buffer_load_dwordx4 v3, s[48:51], s7 offen offset:1024 sc1 lds
v_mfma_f32_16x16x32_bf16 v[136:139], a[40:43], v[64:67], v[136:139]
ds_read_b128 a[8:11], v1 offset:26624
v_mfma_f32_16x16x32_bf16 v[168:171], a[40:43], v[68:71], v[168:171]
v_exp_f32 v31, v31
v_mfma_f32_16x16x32_bf16 v[200:203], a[40:43], v[72:75], v[200:203]
v_exp_f32 v32, v32
v_mfma_f32_16x16x32_bf16 v[232:235], a[40:43], v[76:79], v[232:235]
ds_read_b128 a[12:15], v1 offset:27648
v_cvt_pk_bf16_f32 v61, v30, v31
v_mfma_f32_16x16x32_bf16 v[236:239], a[44:47], v[76:79], v[236:239]
v_mfma_f32_16x16x32_bf16 v[204:207], a[44:47], v[72:75], v[204:207]
v_exp_f32 v33, v33
v_mfma_f32_16x16x32_bf16 v[172:175], a[44:47], v[68:71], v[172:175]
v_exp_f32 v34, v34
v_mfma_f32_16x16x32_bf16 v[140:143], a[44:47], v[64:67], v[140:143]
ds_read_b128 a[16:19], v1 offset:28672
v_cvt_pk_bf16_f32 v50, v32, v33
v_mfma_f32_16x16x32_bf16 v[144:147], a[48:51], v[64:67], v[144:147]
v_mfma_f32_16x16x32_bf16 v[176:179], a[48:51], v[68:71], v[176:179]
v_exp_f32 v35, v35
v_mfma_f32_16x16x32_bf16 v[208:211], a[48:51], v[72:75], v[208:211]
ds_read_b128 a[20:23], v1 offset:29696
v_cvt_pk_bf16_f32 v51, v34, v35
v_mfma_f32_16x16x32_bf16 v[240:243], a[48:51], v[76:79], v[240:243]
v_exp_f32 v36, v36
v_mfma_f32_16x16x32_bf16 v[244:247], a[52:55], v[76:79], v[244:247]
v_exp_f32 v37, v37
v_mfma_f32_16x16x32_bf16 v[212:215], a[52:55], v[72:75], v[212:215]
v_cvt_pk_bf16_f32 v54, v36, v37
v_mfma_f32_16x16x32_bf16 v[180:183], a[52:55], v[68:71], v[180:183]
buffer_load_dwordx4 v3, s[48:51], s7 offen offset:2048 sc1 lds
v_mfma_f32_16x16x32_bf16 v[148:151], a[52:55], v[64:67], v[148:151]
ds_read_b128 a[24:27], v1 offset:30720
v_mfma_f32_16x16x32_bf16 v[152:155], a[56:59], v[64:67], v[152:155]
v_exp_f32 v38, v38
v_mfma_f32_16x16x32_bf16 v[184:187], a[56:59], v[68:71], v[184:187]
v_exp_f32 v39, v39
v_mfma_f32_16x16x32_bf16 v[216:219], a[56:59], v[72:75], v[216:219]
ds_read_b128 a[28:31], v1 offset:31744
v_cvt_pk_bf16_f32 v55, v38, v39
v_mfma_f32_16x16x32_bf16 v[248:251], a[56:59], v[76:79], v[248:251]
v_mfma_f32_16x16x32_bf16 v[252:255], a[60:63], v[76:79], v[252:255]
v_exp_f32 v40, v40
v_mfma_f32_16x16x32_bf16 v[220:223], a[60:63], v[72:75], v[220:223]
v_exp_f32 v41, v41
v_mfma_f32_16x16x32_bf16 v[188:191], a[60:63], v[68:71], v[188:191]
ds_read_b128 a[32:35], v1 offset:16384
v_cvt_pk_bf16_f32 v58, v40, v41
v_mfma_f32_16x16x32_bf16 v[156:159], a[60:63], v[64:67], v[156:159]
v_smfmac_f32_16x16x64_bf16 a[224:227], a[232:235], v[64:71], v9
s_waitcnt lgkmcnt(5)
v_exp_f32 v42, v42
v_smfmac_f32_16x16x64_bf16 a[228:231], a[232:235], v[72:79], v9
ds_read_b128 a[36:39], v1 offset:17408
v_mfma_f32_16x16x32_bf16 v[16:19], a[0:3], a[160:163], v[96:99]
v_exp_f32 v43, v43
v_mfma_f32_16x16x32_bf16 v[16:19], a[4:7], a[164:167], v[16:19]
v_exp_f32 v44, v44
v_mfma_f32_16x16x32_bf16 v[16:19], a[8:11], a[168:171], v[16:19]
v_cvt_pk_bf16_f32 v59, v42, v43
v_mfma_f32_16x16x32_bf16 v[16:19], a[12:15], a[172:175], v[16:19]
buffer_load_dwordx4 v3, s[48:51], s7 offen offset:3072 sc1 lds
v_mfma_f32_16x16x32_bf16 v[20:23], a[0:3], a[176:179], v[84:87]
ds_read_b128 a[40:43], v1 offset:18432
v_mfma_f32_16x16x32_bf16 v[20:23], a[4:7], a[180:183], v[20:23]
v_exp_f32 v45, v45
v_mfma_f32_16x16x32_bf16 v[20:23], a[8:11], a[184:187], v[20:23]
v_exp_f32 v46, v46
v_mfma_f32_16x16x32_bf16 v[20:23], a[12:15], a[188:191], v[20:23]
ds_read_b128 a[44:47], v1 offset:19456
v_cvt_pk_bf16_f32 v62, v44, v45
v_mfma_f32_16x16x32_bf16 v[24:27], a[0:3], a[192:195], v[88:91]
v_mfma_f32_16x16x32_bf16 v[24:27], a[4:7], a[196:199], v[24:27]
v_exp_f32 v47, v47
v_mfma_f32_16x16x32_bf16 v[24:27], a[8:11], a[200:203], v[24:27]
v_exp_f32 v16, v16
v_mfma_f32_16x16x32_bf16 v[24:27], a[12:15], a[204:207], v[24:27]
ds_read_b128 a[48:51], v1 offset:20480
v_cvt_pk_bf16_f32 v63, v46, v47
v_mfma_f32_16x16x32_bf16 v[28:31], a[0:3], a[208:211], v[92:95]
v_mfma_f32_16x16x32_bf16 v[28:31], a[4:7], a[212:215], v[28:31]
v_exp_f32 v17, v17
v_mfma_f32_16x16x32_bf16 v[28:31], a[8:11], a[216:219], v[28:31]
ds_read_b128 a[52:55], v1 offset:21504
v_cvt_pk_bf16_f32 v64, v16, v17
v_mfma_f32_16x16x32_bf16 v[28:31], a[12:15], a[220:223], v[28:31]
s_waitcnt lgkmcnt(6)
v_exp_f32 v18, v18
v_mfma_f32_16x16x32_bf16 v[32:35], a[16:19], a[160:163], v[100:103]
v_mfma_f32_16x16x32_bf16 v[32:35], a[20:23], a[164:167], v[32:35]
s_mov_b32 s9, 0x0
v_exp_f32 v19, v19
v_mfma_f32_16x16x32_bf16 v[32:35], a[24:27], a[168:171], v[32:35]
buffer_load_dword a244, v8, s[72:75], s9 offen
v_mfma_f32_16x16x32_bf16 v[32:35], a[28:31], a[172:175], v[32:35]
ds_read_b128 a[56:59], v1 offset:22528
v_cvt_pk_bf16_f32 v65, v18, v19
v_mfma_f32_16x16x32_bf16 v[36:39], a[16:19], a[176:179], v[84:87]
s_add_u32 s32, s32, 0x8000
v_exp_f32 v20, v20
v_mfma_f32_16x16x32_bf16 v[36:39], a[20:23], a[180:183], v[36:39]
s_add_u32 s7, s7, 0x8000
v_exp_f32 v21, v21
v_mfma_f32_16x16x32_bf16 v[36:39], a[24:27], a[184:187], v[36:39]
ds_read_b128 a[60:63], v1 offset:23552
v_xor_b32 v1, 0x8000, v1
v_mfma_f32_16x16x32_bf16 v[36:39], a[28:31], a[188:191], v[36:39]
s_xor_b32 s27, s27, 0x38000
v_cvt_pk_bf16_f32 v68, v20, v21
v_mfma_f32_16x16x32_bf16 v[40:43], a[16:19], a[192:195], v[88:91]
v_exp_f32 v22, v22
v_mfma_f32_16x16x32_bf16 v[40:43], a[20:23], a[196:199], v[40:43]
v_exp_f32 v23, v23
v_mfma_f32_16x16x32_bf16 v[40:43], a[24:27], a[200:203], v[40:43]
v_cvt_pk_bf16_f32 v69, v22, v23
v_mfma_f32_16x16x32_bf16 v[40:43], a[28:31], a[204:207], v[40:43]
v_exp_f32 v24, v24
v_mfma_f32_16x16x32_bf16 v[44:47], a[16:19], a[208:211], v[92:95]
v_exp_f32 v25, v25
v_mfma_f32_16x16x32_bf16 v[44:47], a[20:23], a[212:215], v[44:47]
v_exp_f32 v26, v26
v_mfma_f32_16x16x32_bf16 v[44:47], a[24:27], a[216:219], v[44:47]
s_waitcnt vmcnt(17) lgkmcnt(0)
v_exp_f32 v27, v27
v_mfma_f32_16x16x32_bf16 v[44:47], a[28:31], a[220:223], v[44:47]
s_barrier
L_att_l1_1:
v_mfma_f32_16x16x32_bf16 v[128:131], a[32:35], v[48:51], v[128:131]
ds_read_b128 a[0:3], v2 offset:8192
v_cvt_pk_bf16_f32 v72, v24, v25
v_mfma_f32_16x16x32_bf16 v[160:163], a[32:35], v[52:55], v[160:163]
s_add_u32 m0, s19, 0x0
v_exp_f32 v28, v28
v_mfma_f32_16x16x32_bf16 v[192:195], a[32:35], v[56:59], v[192:195]
buffer_load_dwordx4 v3, s[48:51], s32 offen offset:0 sc1 lds
v_mfma_f32_16x16x32_bf16 v[224:227], a[32:35], v[60:63], v[224:227]
ds_read_b128 a[4:7], v2 offset:9216
v_cvt_pk_bf16_f32 v73, v26, v27
v_mfma_f32_16x16x32_bf16 v[228:231], a[36:39], v[60:63], v[228:231]
s_and_b32 s44, s18, 3
s_lshl_b32 s45, s44, 1
s_add_u32 s45, s45, s100
v_mfma_f32_16x16x32_bf16 v[196:199], a[36:39], v[56:59], v[196:199]
s_add_u32 s8, s16, 0x0
v_exp_f32 v29, v29
v_mfma_f32_16x16x32_bf16 v[164:167], a[36:39], v[52:55], v[164:167]
ds_read_b128 a[8:11], v2 offset:10240
v_cvt_pk_bf16_f32 v76, v28, v29
v_mfma_f32_16x16x32_bf16 v[132:135], a[36:39], v[48:51], v[132:135]
buffer_store_dwordx4 a[64:67], v3, s[88:91], s8 offen offset:0 sc1
v_mfma_f32_16x16x32_bf16 v[136:139], a[40:43], v[48:51], v[136:139]
s_and_b32 s60, s45, 3
v_exp_f32 v30, v30
v_mfma_f32_16x16x32_bf16 v[168:171], a[40:43], v[52:55], v[168:171]
ds_read_b128 a[12:15], v2 offset:11264
s_sub_u32 s60, s60, s44
v_mfma_f32_16x16x32_bf16 v[200:203], a[40:43], v[56:59], v[200:203]
s_add_u32 s60, s60, 11
v_exp_f32 v31, v31
v_mfma_f32_16x16x32_bf16 v[232:235], a[40:43], v[60:63], v[232:235]
s_lshl_b32 s60, s60, 14
v_exp_f32 v32, v32
v_mfma_f32_16x16x32_bf16 v[236:239], a[44:47], v[60:63], v[236:239]
buffer_load_dwordx4 v3, s[48:51], s32 offen offset:1024 sc1 lds
v_mfma_f32_16x16x32_bf16 v[204:207], a[44:47], v[56:59], v[204:207]
ds_read_b128 a[16:19], v2 offset:12288
v_cvt_pk_bf16_f32 v77, v30, v31
v_mfma_f32_16x16x32_bf16 v[172:175], a[44:47], v[52:55], v[172:175]
s_mul_i32 s44, s44, -8
v_exp_f32 v33, v33
v_mfma_f32_16x16x32_bf16 v[140:143], a[44:47], v[48:51], v[140:143]
s_and_b32 s44, s44, 31
v_exp_f32 v34, v34
v_mfma_f32_16x16x32_bf16 v[144:147], a[48:51], v[48:51], v[144:147]
ds_read_b128 a[20:23], v2 offset:13312
v_cvt_pk_bf16_f32 v66, v32, v33
v_mfma_f32_16x16x32_bf16 v[176:179], a[48:51], v[52:55], v[176:179]
buffer_store_dwordx4 a[64:67], v3, s[88:91], s8 offen offset:1024 sc1
v_mfma_f32_16x16x32_bf16 v[208:211], a[48:51], v[56:59], v[208:211]
s_lshl_b32 s44, 4, s44
v_exp_f32 v35, v35
v_mfma_f32_16x16x32_bf16 v[240:243], a[48:51], v[60:63], v[240:243]
ds_read_b128 a[24:27], v2 offset:14336
v_cvt_pk_bf16_f32 v67, v34, v35
v_mfma_f32_16x16x32_bf16 v[244:247], a[52:55], v[60:63], v[244:247]
s_mul_i32 s45, s45, -8
v_exp_f32 v36, v36
v_mfma_f32_16x16x32_bf16 v[212:215], a[52:55], v[56:59], v[212:215]
s_and_b32 s45, s45, 31
v_exp_f32 v37, v37
v_mfma_f32_16x16x32_bf16 v[180:183], a[52:55], v[52:55], v[180:183]
buffer_load_dwordx4 v3, s[48:51], s32 offen offset:2048 sc1 lds
v_mfma_f32_16x16x32_bf16 v[148:151], a[52:55], v[48:51], v[148:151]
ds_read_b128 a[28:31], v2 offset:15360
v_cvt_pk_bf16_f32 v70, v36, v37
v_mfma_f32_16x16x32_bf16 v[152:155], a[56:59], v[48:51], v[152:155]
s_lshl_b32 s45, 4, s45
s_add_u32 s44, s44, 0x11111111
s_sub_u32 s44, s44, s45
v_mfma_f32_16x16x32_bf16 v[184:187], a[56:59], v[52:55], v[184:187]
s_bfe_u32 s56, s44, 0x80000
v_exp_f32 v38, v38
v_mfma_f32_16x16x32_bf16 v[216:219], a[56:59], v[56:59], v[216:219]
ds_read_b128 a[32:35], v2 offset:0
s_lshl_b32 s56, s56, 14
v_mfma_f32_16x16x32_bf16 v[248:251], a[56:59], v[60:63], v[248:251]
s_bfe_u32 s57, s44, 0x80008
v_exp_f32 v39, v39
v_mfma_f32_16x16x32_bf16 v[252:255], a[60:63], v[60:63], v[252:255]
buffer_store_dwordx4 a[64:67], v3, s[88:91], s8 offen offset:2048 sc1
v_mfma_f32_16x16x32_bf16 v[220:223], a[60:63], v[56:59], v[220:223]
ds_read_b128 a[36:39], v2 offset:1024
v_cvt_pk_bf16_f32 v71, v38, v39
v_mfma_f32_16x16x32_bf16 v[188:191], a[60:63], v[52:55], v[188:191]
s_lshl_b32 s57, s57, 14
v_exp_f32 v40, v40
v_mfma_f32_16x16x32_bf16 v[156:159], a[60:63], v[48:51], v[156:159]
s_bfe_u32 s58, s44, 0x80010
v_exp_f32 v41, v41
v_smfmac_f32_16x16x64_bf16 a[224:227], a[232:235], v[48:55], v9
s_waitcnt lgkmcnt(6)
v_exp_f32 v42, v42
v_smfmac_f32_16x16x64_bf16 a[228:231], a[232:235], v[56:63], v9
buffer_load_dwordx4 v3, s[48:51], s32 offen offset:3072 sc1 lds
v_mfma_f32_16x16x32_bf16 v[20:23], a[0:3], a[176:179], v[104:107]
ds_read_b128 a[40:43], v2 offset:2048
v_cvt_pk_bf16_f32 v74, v40, v41
v_mfma_f32_16x16x32_bf16 v[20:23], a[4:7], a[180:183], v[20:23]
s_lshl_b32 s58, s58, 14
v_exp_f32 v43, v43
v_mfma_f32_16x16x32_bf16 v[20:23], a[8:11], a[184:187], v[20:23]
ds_read_b128 a[44:47], v2 offset:3072
v_cvt_pk_bf16_f32 v75, v42, v43
v_mfma_f32_16x16x32_bf16 v[20:23], a[12:15], a[188:191], v[20:23]
s_bfe_u32 s59, s44, 0x80018
v_exp_f32 v44, v44
v_mfma_f32_16x16x32_bf16 v[24:27], a[0:3], a[192:195], v[88:91]
buffer_store_dwordx4 a[64:67], v3, s[88:91], s8 offen offset:3072 sc1
v_mfma_f32_16x16x32_bf16 v[24:27], a[4:7], a[196:199], v[24:27]
ds_read_b128 a[48:51], v2 offset:4096
s_lshl_b32 s59, s59, 14
v_mfma_f32_16x16x32_bf16 v[24:27], a[8:11], a[200:203], v[24:27]
v_exp_f32 v45, v45
v_mfma_f32_16x16x32_bf16 v[24:27], a[12:15], a[204:207], v[24:27]
v_exp_f32 v46, v46
v_mfma_f32_16x16x32_bf16 v[28:31], a[0:3], a[208:211], v[92:95]
s_add_u32 m0, s19, 0x1000
v_exp_f32 v47, v47
v_mfma_f32_16x16x32_bf16 v[28:31], a[4:7], a[212:215], v[28:31]
buffer_load_dwordx4 v3, s[48:51], s7 offen offset:0 sc1 lds
v_mfma_f32_16x16x32_bf16 v[28:31], a[8:11], a[216:219], v[28:31]
ds_read_b128 a[52:55], v2 offset:5120
v_cvt_pk_bf16_f32 v78, v44, v45
v_mfma_f32_16x16x32_bf16 v[28:31], a[12:15], a[220:223], v[28:31]
s_waitcnt lgkmcnt(6)
v_exp_f32 v20, v20
v_mfma_f32_16x16x32_bf16 v[36:39], a[16:19], a[176:179], v[108:111]
ds_read_b128 a[56:59], v2 offset:6144
v_cvt_pk_bf16_f32 v79, v46, v47
v_mfma_f32_16x16x32_bf16 v[36:39], a[20:23], a[180:183], v[36:39]
s_add_u32 s8, s16, 0x400000
v_exp_f32 v21, v21
v_mfma_f32_16x16x32_bf16 v[36:39], a[24:27], a[184:187], v[36:39]
buffer_store_dwordx4 a[64:67], v3, s[88:91], s8 offen offset:0 sc1
v_mfma_f32_16x16x32_bf16 v[36:39], a[28:31], a[188:191], v[36:39]
ds_read_b128 a[60:63], v2 offset:7168
v_cvt_pk_bf16_f32 v52, v20, v21
v_mfma_f32_16x16x32_bf16 v[40:43], a[16:19], a[192:195], v[88:91]
v_exp_f32 v22, v22
v_mfma_f32_16x16x32_bf16 v[40:43], a[20:23], a[196:199], v[40:43]
v_exp_f32 v23, v23
v_mfma_f32_16x16x32_bf16 v[40:43], a[24:27], a[200:203], v[40:43]
v_exp_f32 v24, v24
v_mfma_f32_16x16x32_bf16 v[40:43], a[28:31], a[204:207], v[40:43]
buffer_load_dwordx4 v3, s[48:51], s7 offen offset:1024 sc1 lds
v_mfma_f32_16x16x32_bf16 v[44:47], a[16:19], a[208:211], v[92:95]
v_exp_f32 v25, v25
v_mfma_f32_16x16x32_bf16 v[44:47], a[20:23], a[212:215], v[44:47]
v_exp_f32 v26, v26
v_mfma_f32_16x16x32_bf16 v[44:47], a[24:27], a[216:219], v[44:47]
v_exp_f32 v27, v27
v_mfma_f32_16x16x32_bf16 v[44:47], a[28:31], a[220:223], v[44:47]
s_waitcnt lgkmcnt(0)
v_cvt_pk_bf16_f32 v53, v22, v23
v_mov_b32 v6, 0xf149f2ca
v_min_f32 v119, s10, v88
v_cndmask_b32 v112, v119, v88, s[36:37]
v_cndmask_b32 v113, v119, v88, s[38:39]
v_cndmask_b32 v114, v119, v88, s[40:41]
v_cndmask_b32 v115, v119, v88, s[42:43]
v_cndmask_b32 v116, v6, v119, s[36:37]
v_cndmask_b32 v117, v6, v119, s[38:39]
v_cndmask_b32 v118, v6, v119, s[40:41]
v_cndmask_b32 v119, v6, v119, s[42:43]
v_min_f32 v127, s11, v92
v_cndmask_b32 v120, v127, v92, s[36:37]
v_cndmask_b32 v121, v127, v92, s[38:39]
v_cndmask_b32 v122, v127, v92, s[40:41]
v_cndmask_b32 v123, v127, v92, s[42:43]
v_cndmask_b32 v124, v6, v127, s[36:37]
v_cndmask_b32 v125, v6, v127, s[38:39]
v_cndmask_b32 v126, v6, v127, s[40:41]
v_cndmask_b32 v127, v6, v127, s[42:43]
v_mfma_f32_16x16x32_bf16 v[128:131], a[32:35], v[64:67], v[128:131]
v_exp_f32 v28, v28
v_mfma_f32_16x16x32_bf16 v[160:163], a[32:35], v[68:71], v[160:163]
ds_read_b128 a[0:3], v2 offset:24576
v_cvt_pk_bf16_f32 v56, v24, v25
v_mfma_f32_16x16x32_bf16 v[192:195], a[32:35], v[72:75], v[192:195]
buffer_store_dwordx4 a[64:67], v3, s[88:91], s8 offen offset:1024 sc1
v_mfma_f32_16x16x32_bf16 v[224:227], a[32:35], v[76:79], v[224:227]
ds_read_b128 a[4:7], v2 offset:25600
v_cvt_pk_bf16_f32 v57, v26, v27
v_mfma_f32_16x16x32_bf16 v[228:231], a[36:39], v[76:79], v[228:231]
buffer_load_dwordx4 v3, s[48:51], s7 offen offset:2048 sc1 lds
v_mfma_f32_16x16x32_bf16 v[196:199], a[36:39], v[72:75], v[196:199]
ds_read_b128 a[8:11], v2 offset:26624
v_mfma_f32_16x16x32_bf16 v[164:167], a[36:39], v[68:71], v[164:167]
v_exp_f32 v29, v29
v_mfma_f32_16x16x32_bf16 v[132:135], a[36:39], v[64:67], v[132:135]
v_exp_f32 v30, v30
v_mfma_f32_16x16x32_bf16 v[136:139], a[40:43], v[64:67], v[136:139]
v_exp_f32 v31, v31
v_mfma_f32_16x16x32_bf16 v[168:171], a[40:43], v[68:71], v[168:171]
v_exp_f32 v36, v36
v_mfma_f32_16x16x32_bf16 v[200:203], a[40:43], v[72:75], v[200:203]
ds_read_b128 a[12:15], v2 offset:27648
v_cvt_pk_bf16_f32 v60, v28, v29
v_mfma_f32_16x16x32_bf16 v[232:235], a[40:43], v[76:79], v[232:235]
buffer_store_dwordx4 a[64:67], v3, s[88:91], s8 offen offset:2048 sc1
v_mfma_f32_16x16x32_bf16 v[236:239], a[44:47], v[76:79], v[236:239]
ds_read_b128 a[16:19], v2 offset:28672
v_cvt_pk_bf16_f32 v61, v30, v31
v_mfma_f32_16x16x32_bf16 v[204:207], a[44:47], v[72:75], v[204:207]
v_exp_f32 v37, v37
v_mfma_f32_16x16x32_bf16 v[172:175], a[44:47], v[68:71], v[172:175]
ds_read_b128 a[20:23], v2 offset:29696
v_cvt_pk_bf16_f32 v54, v36, v37
v_mfma_f32_16x16x32_bf16 v[140:143], a[44:47], v[64:67], v[140:143]
buffer_load_dwordx4 v3, s[48:51], s7 offen offset:3072 sc1 lds
v_mfma_f32_16x16x32_bf16 v[144:147], a[48:51], v[64:67], v[144:147]
v_exp_f32 v38, v38
v_mfma_f32_16x16x32_bf16 v[176:179], a[48:51], v[68:71], v[176:179]
buffer_store_dwordx4 a[64:67], v3, s[88:91], s8 offen offset:3072 sc1
v_mfma_f32_16x16x32_bf16 v[208:211], a[48:51], v[72:75], v[208:211]
ds_read_b128 a[24:27], v2 offset:30720
v_mfma_f32_16x16x32_bf16 v[240:243], a[48:51], v[76:79], v[240:243]
ds_read_b128 a[28:31], v2 offset:31744
v_mfma_f32_16x16x32_bf16 v[244:247], a[52:55], v[76:79], v[244:247]
s_add_u32 s8, s16, 0x800000
v_exp_f32 v39, v39
v_mfma_f32_16x16x32_bf16 v[212:215], a[52:55], v[72:75], v[212:215]
buffer_store_dwordx4 a[64:67], v3, s[88:91], s8 offen offset:0 sc1
v_mfma_f32_16x16x32_bf16 v[180:183], a[52:55], v[68:71], v[180:183]
ds_read_b128 a[32:35], v2 offset:16384
v_cvt_pk_bf16_f32 v55, v38, v39
v_mfma_f32_16x16x32_bf16 v[148:151], a[52:55], v[64:67], v[148:151]
v_exp_f32 v40, v40
v_mfma_f32_16x16x32_bf16 v[152:155], a[56:59], v[64:67], v[152:155]
v_exp_f32 v41, v41
v_mfma_f32_16x16x32_bf16 v[184:187], a[56:59], v[68:71], v[184:187]
buffer_store_dwordx4 a[64:67], v3, s[88:91], s8 offen offset:1024 sc1
v_mfma_f32_16x16x32_bf16 v[216:219], a[56:59], v[72:75], v[216:219]
ds_read_b128 a[36:39], v2 offset:17408
v_cvt_pk_bf16_f32 v58, v40, v41
v_mfma_f32_16x16x32_bf16 v[248:251], a[56:59], v[76:79], v[248:251]
ds_read_b128 a[40:43], v2 offset:18432
v_mfma_f32_16x16x32_bf16 v[252:255], a[60:63], v[76:79], v[252:255]
v_exp_f32 v42, v42
v_mfma_f32_16x16x32_bf16 v[220:223], a[60:63], v[72:75], v[220:223]
buffer_store_dwordx4 a[64:67], v3, s[88:91], s8 offen offset:2048 sc1
v_mfma_f32_16x16x32_bf16 v[188:191], a[60:63], v[68:71], v[188:191]
ds_read_b128 a[44:47], v2 offset:19456
v_mfma_f32_16x16x32_bf16 v[156:159], a[60:63], v[64:67], v[156:159]
v_exp_f32 v43, v43
v_smfmac_f32_16x16x64_bf16 a[224:227], a[232:235], v[64:71], v9
v_exp_f32 v44, v44
v_smfmac_f32_16x16x64_bf16 a[228:231], a[232:235], v[72:79], v9
s_waitcnt lgkmcnt(8)
v_exp_f32 v45, v45
v_mfma_f32_16x16x32_bf16 v[24:27], a[0:3], a[192:195], v[88:91]
ds_read_b128 a[48:51], v2 offset:20480
v_cvt_pk_bf16_f32 v59, v42, v43
v_mfma_f32_16x16x32_bf16 v[24:27], a[4:7], a[196:199], v[24:27]
ds_read_b128 a[52:55], v2 offset:21504
v_cvt_pk_bf16_f32 v62, v44, v45
v_mfma_f32_16x16x32_bf16 v[24:27], a[8:11], a[200:203], v[24:27]
buffer_store_dwordx4 a[64:67], v3, s[88:91], s8 offen offset:3072 sc1
v_mfma_f32_16x16x32_bf16 v[24:27], a[12:15], a[204:207], v[24:27]
v_exp_f32 v46, v46
v_mfma_f32_16x16x32_bf16 v[28:31], a[0:3], a[208:211], v[92:95]
ds_read_b128 a[56:59], v2 offset:22528
v_add_u32 v4, s0, v3
v_mfma_f32_16x16x32_bf16 v[28:31], a[4:7], a[212:215], v[28:31]
s_waitcnt lgkmcnt(7)
v_exp_f32 v47, v47
v_mfma_f32_16x16x32_bf16 v[28:31], a[8:11], a[216:219], v[28:31]
ds_read_b128 a[60:63], v2 offset:23552
v_mov_b32 v5, s1
v_mfma_f32_16x16x32_bf16 v[28:31], a[12:15], a[220:223], v[28:31]
global_load_dword a244, v[4:5], off sc1
v_mfma_f32_16x16x32_bf16 v[40:43], a[16:19], a[192:195], v[88:91]
s_add_u32 s32, s32, 0x8000
v_xor_b32 v2, 0x38000, v2
v_cvt_pk_bf16_f32 v63, v46, v47
v_mfma_f32_16x16x32_bf16 v[40:43], a[20:23], a[196:199], v[40:43]
s_add_u32 s7, s7, 0x8000
v_exp_f32 v24, v24
v_mfma_f32_16x16x32_bf16 v[40:43], a[24:27], a[200:203], v[40:43]
s_xor_b32 s19, s19, 0x8000
v_exp_f32 v25, v25
v_mfma_f32_16x16x32_bf16 v[40:43], a[28:31], a[204:207], v[40:43]
s_sub_u32 s15, 7, s6
v_exp_f32 v26, v26
v_mfma_f32_16x16x32_bf16 v[44:47], a[16:19], a[208:211], v[92:95]
s_lshl_b32 s15, s15, 1
v_exp_f32 v27, v27
v_mfma_f32_16x16x32_bf16 v[44:47], a[20:23], a[212:215], v[44:47]
v_exp_f32 v28, v28
v_mfma_f32_16x16x32_bf16 v[44:47], a[24:27], a[216:219], v[44:47]
s_waitcnt vmcnt(30) lgkmcnt(0)
v_exp_f32 v29, v29
v_mfma_f32_16x16x32_bf16 v[44:47], a[28:31], a[220:223], v[44:47]
s_barrier
s_cbranch_scc0 L_att_lh0_1
L_att_ls_1:
v_mfma_f32_16x16x32_bf16 v[160:163], a[32:35], v[52:55], v[160:163]
ds_read_b128 a[0:3], v1 offset:8192
v_cvt_pk_bf16_f32 v72, v24, v25
v_mfma_f32_16x16x32_bf16 v[192:195], a[32:35], v[56:59], v[192:195]
v_exp_f32 v30, v30
v_mfma_f32_16x16x32_bf16 v[224:227], a[32:35], v[60:63], v[224:227]
ds_read_b128 a[4:7], v1 offset:9216
v_cvt_pk_bf16_f32 v73, v26, v27
v_mfma_f32_16x16x32_bf16 v[228:231], a[36:39], v[60:63], v[228:231]
s_add_u32 m0, s27, 0x0
v_cvt_pk_bf16_f32 v76, v28, v29
v_accvgpr_read_b32 v6, a224
v_mfma_f32_16x16x32_bf16 v[196:199], a[36:39], v[56:59], v[196:199]
buffer_load_dwordx4 v3, s[48:51], s32 offen offset:0 sc1 lds
v_mfma_f32_16x16x32_bf16 v[164:167], a[36:39], v[52:55], v[164:167]
ds_read_b128 a[8:11], v1 offset:10240
v_accvgpr_read_b32 v7, a225
v_mfma_f32_16x16x32_bf16 v[168:171], a[40:43], v[52:55], v[168:171]
ds_read_b128 a[12:15], v1 offset:11264
v_add_f32 v6, v6, v7
v_mfma_f32_16x16x32_bf16 v[200:203], a[40:43], v[56:59], v[200:203]
v_exp_f32 v31, v31
v_mfma_f32_16x16x32_bf16 v[232:235], a[40:43], v[60:63], v[232:235]
v_exp_f32 v40, v40
v_mfma_f32_16x16x32_bf16 v[236:239], a[44:47], v[60:63], v[236:239]
ds_read_b128 a[16:19], v1 offset:12288
v_cvt_pk_bf16_f32 v77, v30, v31
v_mfma_f32_16x16x32_bf16 v[204:207], a[44:47], v[56:59], v[204:207]
v_cmp_nge_f32 vcc, 0x6f800000, v6
v_mfma_f32_16x16x32_bf16 v[172:175], a[44:47], v[52:55], v[172:175]
ds_read_b128 a[20:23], v1 offset:13312
v_mfma_f32_16x16x32_bf16 v[176:179], a[48:51], v[52:55], v[176:179]
v_exp_f32 v41, v41
v_mfma_f32_16x16x32_bf16 v[208:211], a[48:51], v[56:59], v[208:211]
ds_read_b128 a[24:27], v1 offset:14336
v_cvt_pk_bf16_f32 v74, v40, v41
v_mfma_f32_16x16x32_bf16 v[240:243], a[48:51], v[60:63], v[240:243]
buffer_load_dwordx4 v3, s[48:51], s32 offen offset:1024 sc1 lds
v_mfma_f32_16x16x32_bf16 v[244:247], a[52:55], v[60:63], v[244:247]
v_exp_f32 v42, v42
v_mfma_f32_16x16x32_bf16 v[212:215], a[52:55], v[56:59], v[212:215]
ds_read_b128 a[28:31], v1 offset:15360
v_mfma_f32_16x16x32_bf16 v[180:183], a[52:55], v[52:55], v[180:183]
v_exp_f32 v43, v43
v_mfma_f32_16x16x32_bf16 v[184:187], a[56:59], v[52:55], v[184:187]
ds_read_b128 a[32:35], v1 offset:0
v_cvt_pk_bf16_f32 v75, v42, v43
v_mfma_f32_16x16x32_bf16 v[216:219], a[56:59], v[56:59], v[216:219]
v_rcp_f32 v6, v6
v_mfma_f32_16x16x32_bf16 v[248:251], a[56:59], v[60:63], v[248:251]
ds_read_b128 a[36:39], v1 offset:1024
s_or_b64 s[34:35], s[34:35], vcc
v_mfma_f32_16x16x32_bf16 v[252:255], a[60:63], v[60:63], v[252:255]
s_add_u32 s8, s28, 0x0
v_exp_f32 v44, v44
v_mfma_f32_16x16x32_bf16 v[220:223], a[60:63], v[56:59], v[220:223]
v_exp_f32 v45, v45
v_mfma_f32_16x16x32_bf16 v[188:191], a[60:63], v[52:55], v[188:191]
ds_read_b128 a[40:43], v1 offset:2048
v_cvt_pk_bf16_f32 v78, v44, v45
v_mfma_f32_16x16x32_bf16 a[224:227], a[236:239], v[52:55], a[224:227]
buffer_load_dwordx4 v3, s[48:51], s32 offen offset:2048 sc1 lds
v_smfmac_f32_16x16x64_bf16 a[228:231], a[232:235], v[56:63], v9
ds_read_b128 a[44:47], v1 offset:3072
s_waitcnt lgkmcnt(8)
v_mfma_f32_16x16x32_bf16 v[24:27], a[0:3], a[192:195], v[88:91]
v_exp_f32 v46, v46
v_mfma_f32_16x16x32_bf16 v[24:27], a[4:7], a[196:199], v[24:27]
ds_read_b128 a[48:51], v1 offset:4096
v_mul_f32 v128, v6, v128
v_mfma_f32_16x16x32_bf16 v[24:27], a[8:11], a[200:203], v[24:27]
v_mul_f32 v129, v6, v129
v_mul_f32 v130, v6, v130
v_mfma_f32_16x16x32_bf16 v[24:27], a[12:15], a[204:207], v[24:27]
v_exp_f32 v47, v47
v_mfma_f32_16x16x32_bf16 v[28:31], a[0:3], a[208:211], v[92:95]
ds_read_b128 a[52:55], v1 offset:5120
v_cvt_pk_bf16_f32 v79, v46, v47
v_mfma_f32_16x16x32_bf16 v[28:31], a[4:7], a[212:215], v[28:31]
v_mul_f32 v131, v6, v131
v_mul_f32 v132, v6, v132
v_mfma_f32_16x16x32_bf16 v[28:31], a[8:11], a[216:219], v[28:31]
ds_read_b128 a[56:59], v1 offset:6144
v_mul_f32 v133, v6, v133
v_mfma_f32_16x16x32_bf16 v[28:31], a[12:15], a[220:223], v[28:31]
s_waitcnt lgkmcnt(7)
v_exp_f32 v24, v24
v_mfma_f32_16x16x32_bf16 v[40:43], a[16:19], a[192:195], v[88:91]
buffer_load_dwordx4 v3, s[48:51], s32 offen offset:3072 sc1 lds
v_mfma_f32_16x16x32_bf16 v[40:43], a[20:23], a[196:199], v[40:43]
ds_read_b128 a[60:63], v1 offset:7168
v_mul_f32 v134, v6, v134
v_mfma_f32_16x16x32_bf16 v[40:43], a[24:27], a[200:203], v[40:43]
s_add_u32 s32, s32, 0x8000
v_exp_f32 v25, v25
v_mfma_f32_16x16x32_bf16 v[40:43], a[28:31], a[204:207], v[40:43]
v_exp_f32 v26, v26
v_mfma_f32_16x16x32_bf16 v[44:47], a[16:19], a[208:211], v[92:95]
v_exp_f32 v27, v27
v_mfma_f32_16x16x32_bf16 v[44:47], a[20:23], a[212:215], v[44:47]
v_exp_f32 v28, v28
v_mfma_f32_16x16x32_bf16 v[44:47], a[24:27], a[216:219], v[44:47]
v_exp_f32 v29, v29
v_mfma_f32_16x16x32_bf16 v[44:47], a[28:31], a[220:223], v[44:47]
s_waitcnt lgkmcnt(0)
v_mul_f32 v135, v6, v135
v_cvt_pk_bf16_f32 v128, v128, v129
v_mfma_f32_16x16x32_bf16 v[192:195], a[32:35], v[72:75], v[192:195]
s_add_u32 m0, s27, 0x1000
v_exp_f32 v30, v30
v_mfma_f32_16x16x32_bf16 v[224:227], a[32:35], v[76:79], v[224:227]
buffer_load_dwordx4 v3, s[48:51], s7 offen offset:0 sc1 lds
v_mfma_f32_16x16x32_bf16 v[228:231], a[36:39], v[76:79], v[228:231]
v_exp_f32 v31, v31
v_mfma_f32_16x16x32_bf16 v[196:199], a[36:39], v[72:75], v[196:199]
ds_read_b128 a[0:3], v1 offset:24576
v_cvt_pk_bf16_f32 v56, v24, v25
v_mfma_f32_16x16x32_bf16 v[200:203], a[40:43], v[72:75], v[200:203]
ds_read_b128 a[4:7], v1 offset:25600
v_cvt_pk_bf16_f32 v57, v26, v27
v_mfma_f32_16x16x32_bf16 v[232:235], a[40:43], v[76:79], v[232:235]
v_exp_f32 v40, v40
v_mfma_f32_16x16x32_bf16 v[236:239], a[44:47], v[76:79], v[236:239]
ds_read_b128 a[8:11], v1 offset:26624
v_cvt_pk_bf16_f32 v60, v28, v29
v_mfma_f32_16x16x32_bf16 v[204:207], a[44:47], v[72:75], v[204:207]
v_exp_f32 v41, v41
v_mfma_f32_16x16x32_bf16 v[208:211], a[48:51], v[72:75], v[208:211]
ds_read_b128 a[12:15], v1 offset:27648
v_cvt_pk_bf16_f32 v61, v30, v31
v_mfma_f32_16x16x32_bf16 v[240:243], a[48:51], v[76:79], v[240:243]
ds_read_b128 a[16:19], v1 offset:28672
v_cvt_pk_bf16_f32 v58, v40, v41
v_mfma_f32_16x16x32_bf16 v[244:247], a[52:55], v[76:79], v[244:247]
v_exp_f32 v42, v42
v_mfma_f32_16x16x32_bf16 v[212:215], a[52:55], v[72:75], v[212:215]
buffer_load_dwordx4 v3, s[48:51], s7 offen offset:1024 sc1 lds
v_mfma_f32_16x16x32_bf16 v[216:219], a[56:59], v[72:75], v[216:219]
ds_read_b128 a[20:23], v1 offset:29696
v_cvt_pk_bf16_f32 v129, v130, v131
v_mfma_f32_16x16x32_bf16 v[248:251], a[56:59], v[76:79], v[248:251]
ds_read_b128 a[24:27], v1 offset:30720
v_cvt_pk_bf16_f32 v130, v132, v133
v_mfma_f32_16x16x32_bf16 v[252:255], a[60:63], v[76:79], v[252:255]
ds_read_b128 a[28:31], v1 offset:31744
v_cvt_pk_bf16_f32 v131, v134, v135
v_mfma_f32_16x16x32_bf16 v[220:223], a[60:63], v[72:75], v[220:223]
s_waitcnt lgkmcnt(4)
v_exp_f32 v43, v43
v_smfmac_f32_16x16x64_bf16 a[228:231], a[232:235], v[72:79], v9
ds_read_b128 a[32:35], v1 offset:16384
v_cvt_pk_bf16_f32 v59, v42, v43
v_mfma_f32_16x16x32_bf16 v[24:27], a[0:3], a[192:195], v[88:91]
ds_read_b128 a[36:39], v1 offset:17408
buffer_store_dwordx4 v[128:131], v3, s[88:91], s8 offen sc1
v_mfma_f32_16x16x32_bf16 v[24:27], a[4:7], a[196:199], v[24:27]
buffer_load_dwordx4 v3, s[48:51], s7 offen offset:2048 sc1 lds
v_mfma_f32_16x16x32_bf16 v[24:27], a[8:11], a[200:203], v[24:27]
ds_read_b128 a[40:43], v1 offset:18432
v_exp_f32 v44, v44
v_mfma_f32_16x16x32_bf16 v[24:27], a[12:15], a[204:207], v[24:27]
ds_read_b128 a[44:47], v1 offset:19456
v_exp_f32 v45, v45
v_mfma_f32_16x16x32_bf16 v[28:31], a[0:3], a[208:211], v[92:95]
ds_read_b128 a[48:51], v1 offset:20480
v_exp_f32 v46, v46
v_mfma_f32_16x16x32_bf16 v[28:31], a[4:7], a[212:215], v[28:31]
s_waitcnt lgkmcnt(5)
v_exp_f32 v47, v47
v_mfma_f32_16x16x32_bf16 v[28:31], a[8:11], a[216:219], v[28:31]
ds_read_b128 a[52:55], v1 offset:21504
v_cvt_pk_bf16_f32 v62, v44, v45
v_mfma_f32_16x16x32_bf16 v[28:31], a[12:15], a[220:223], v[28:31]
ds_read_b128 a[56:59], v1 offset:22528
v_cvt_pk_bf16_f32 v63, v46, v47
v_mfma_f32_16x16x32_bf16 v[40:43], a[16:19], a[192:195], v[88:91]
ds_read_b128 a[60:63], v1 offset:23552
v_xor_b32 v1, 0x8000, v1
v_mfma_f32_16x16x32_bf16 v[40:43], a[20:23], a[196:199], v[40:43]
buffer_load_dwordx4 v3, s[48:51], s7 offen offset:3072 sc1 lds
v_mfma_f32_16x16x32_bf16 v[40:43], a[24:27], a[200:203], v[40:43]
s_add_u32 s7, s7, 0x8000
v_exp_f32 v24, v24
v_mfma_f32_16x16x32_bf16 v[40:43], a[28:31], a[204:207], v[40:43]
s_xor_b32 s27, s27, 0x38000
v_exp_f32 v25, v25
v_mfma_f32_16x16x32_bf16 v[44:47], a[16:19], a[208:211], v[92:95]
s_add_u32 s8, s28, 0x2000
v_exp_f32 v26, v26
v_mfma_f32_16x16x32_bf16 v[44:47], a[20:23], a[212:215], v[44:47]
v_exp_f32 v27, v27
v_mfma_f32_16x16x32_bf16 v[44:47], a[24:27], a[216:219], v[44:47]
s_waitcnt vmcnt(29) lgkmcnt(0)
v_exp_f32 v28, v28
v_mfma_f32_16x16x32_bf16 v[44:47], a[28:31], a[220:223], v[44:47]
s_barrier
v_exp_f32 v29, v29
v_mul_f32 v136, v6, v136
v_mul_f32 v137, v6, v137
v_mul_f32 v138, v6, v138
v_mul_f32 v139, v6, v139
v_mul_f32 v140, v6, v140
v_mul_f32 v141, v6, v141
v_mul_f32 v142, v6, v142
v_mul_f32 v143, v6, v143
v_cvt_pk_bf16_f32 v136, v136, v137
v_cvt_pk_bf16_f32 v137, v138, v139
v_cvt_pk_bf16_f32 v138, v140, v141
v_cvt_pk_bf16_f32 v139, v142, v143
buffer_store_dwordx4 v[136:139], v3, s[88:91], s8 offen sc1
s_add_u32 s8, s28, 0x4000
v_mul_f32 v144, v6, v144
v_mul_f32 v145, v6, v145
v_mul_f32 v146, v6, v146
v_mul_f32 v147, v6, v147
v_mul_f32 v148, v6, v148
v_mul_f32 v149, v6, v149
v_mul_f32 v150, v6, v150
v_mul_f32 v151, v6, v151
v_cvt_pk_bf16_f32 v144, v144, v145
v_cvt_pk_bf16_f32 v145, v146, v147
v_cvt_pk_bf16_f32 v146, v148, v149
v_cvt_pk_bf16_f32 v147, v150, v151
buffer_store_dwordx4 v[144:147], v3, s[88:91], s8 offen sc1
s_add_u32 s8, s28, 0x6000
v_mul_f32 v152, v6, v152
v_mul_f32 v153, v6, v153
v_mul_f32 v154, v6, v154
v_mul_f32 v155, v6, v155
v_mul_f32 v156, v6, v156
v_mul_f32 v157, v6, v157
v_mul_f32 v158, v6, v158
v_mul_f32 v159, v6, v159
v_cvt_pk_bf16_f32 v152, v152, v153
v_cvt_pk_bf16_f32 v153, v154, v155
v_cvt_pk_bf16_f32 v154, v156, v157
v_cvt_pk_bf16_f32 v155, v158, v159
buffer_store_dwordx4 v[152:155], v3, s[88:91], s8 offen sc1
v_accvgpr_read_b32 v6, a226
v_accvgpr_read_b32 v7, a227
v_add_f32 v6, v6, v7
v_cmp_nge_f32 vcc, 0x6f800000, v6
v_rcp_f32 v6, v6
s_or_b64 s[34:35], s[34:35], vcc
s_add_u32 s8, s29, 0x0
v_pk_mul_f32 v[160:161], v[160:161], v[6:7] op_sel_hi:[1,0]
v_pk_mul_f32 v[162:163], v[162:163], v[6:7] op_sel_hi:[1,0]
v_pk_mul_f32 v[164:165], v[164:165], v[6:7] op_sel_hi:[1,0]
v_pk_mul_f32 v[166:167], v[166:167], v[6:7] op_sel_hi:[1,0]
v_cvt_pk_bf16_f32 v160, v160, v161
v_cvt_pk_bf16_f32 v161, v162, v163
v_cvt_pk_bf16_f32 v162, v164, v165
v_cvt_pk_bf16_f32 v163, v166, v167
buffer_store_dwordx4 v[160:163], v3, s[88:91], s8 offen sc1
s_add_u32 s8, s29, 0x2000
v_pk_mul_f32 v[168:169], v[168:169], v[6:7] op_sel_hi:[1,0]
v_pk_mul_f32 v[170:171], v[170:171], v[6:7] op_sel_hi:[1,0]
v_pk_mul_f32 v[172:173], v[172:173], v[6:7] op_sel_hi:[1,0]
v_pk_mul_f32 v[174:175], v[174:175], v[6:7] op_sel_hi:[1,0]
v_cvt_pk_bf16_f32 v168, v168, v169
v_cvt_pk_bf16_f32 v169, v170, v171
v_cvt_pk_bf16_f32 v170, v172, v173
v_cvt_pk_bf16_f32 v171, v174, v175
buffer_store_dwordx4 v[168:171], v3, s[88:91], s8 offen sc1
s_add_u32 s8, s29, 0x4000
v_pk_mul_f32 v[176:177], v[176:177], v[6:7] op_sel_hi:[1,0]
v_pk_mul_f32 v[178:179], v[178:179], v[6:7] op_sel_hi:[1,0]
v_pk_mul_f32 v[180:181], v[180:181], v[6:7] op_sel_hi:[1,0]
v_pk_mul_f32 v[182:183], v[182:183], v[6:7] op_sel_hi:[1,0]
v_cvt_pk_bf16_f32 v176, v176, v177
v_cvt_pk_bf16_f32 v177, v178, v179
v_cvt_pk_bf16_f32 v178, v180, v181
v_cvt_pk_bf16_f32 v179, v182, v183
buffer_store_dwordx4 v[176:179], v3, s[88:91], s8 offen sc1
s_add_u32 s8, s29, 0x6000
v_pk_mul_f32 v[184:185], v[184:185], v[6:7] op_sel_hi:[1,0]
v_pk_mul_f32 v[186:187], v[186:187], v[6:7] op_sel_hi:[1,0]
v_pk_mul_f32 v[188:189], v[188:189], v[6:7] op_sel_hi:[1,0]
v_pk_mul_f32 v[190:191], v[190:191], v[6:7] op_sel_hi:[1,0]
v_cvt_pk_bf16_f32 v184, v184, v185
v_cvt_pk_bf16_f32 v185, v186, v187
v_cvt_pk_bf16_f32 v186, v188, v189
v_cvt_pk_bf16_f32 v187, v190, v191
buffer_store_dwordx4 v[184:187], v3, s[88:91], s8 offen sc1
s_getreg_b32 s8, hwreg(HW_REG_HW_ID, 5, 1)
s_cmp_lg_u32 s8, 0
s_cbranch_scc1 L_att_sodd1
s_branch L_att_sodd0
L_att_lh0_1:
v_mfma_f32_16x16x32_bf16 v[160:163], a[32:35], v[52:55], v[160:163]
ds_read_b128 a[0:3], v1 offset:8192
v_cvt_pk_bf16_f32 v72, v24, v25
v_mfma_f32_16x16x32_bf16 v[192:195], a[32:35], v[56:59], v[192:195]
v_exp_f32 v30, v30
v_mfma_f32_16x16x32_bf16 v[224:227], a[32:35], v[60:63], v[224:227]
ds_read_b128 a[4:7], v1 offset:9216
v_cvt_pk_bf16_f32 v73, v26, v27
v_mfma_f32_16x16x32_bf16 v[228:231], a[36:39], v[60:63], v[228:231]
v_cvt_pk_bf16_f32 v76, v28, v29
v_mfma_f32_16x16x32_bf16 v[196:199], a[36:39], v[56:59], v[196:199]
buffer_load_dword v14, v15, s[84:87], 0 offen offset:192 sc1
v_mfma_f32_16x16x32_bf16 v[164:167], a[36:39], v[52:55], v[164:167]
ds_read_b128 a[8:11], v1 offset:10240
v_mfma_f32_16x16x32_bf16 v[168:171], a[40:43], v[52:55], v[168:171]
ds_read_b128 a[12:15], v1 offset:11264
v_mfma_f32_16x16x32_bf16 v[200:203], a[40:43], v[56:59], v[200:203]
v_exp_f32 v31, v31
v_mfma_f32_16x16x32_bf16 v[232:235], a[40:43], v[60:63], v[232:235]
v_exp_f32 v40, v40
v_mfma_f32_16x16x32_bf16 v[236:239], a[44:47], v[60:63], v[236:239]
ds_read_b128 a[16:19], v1 offset:12288
v_cvt_pk_bf16_f32 v77, v30, v31
v_mfma_f32_16x16x32_bf16 v[204:207], a[44:47], v[56:59], v[204:207]
s_add_u32 m0, s17, 0x10000
v_exp_f32 v41, v41
v_mfma_f32_16x16x32_bf16 v[172:175], a[44:47], v[52:55], v[172:175]
ds_read_b128 a[20:23], v1 offset:13312
v_cvt_pk_bf16_f32 v74, v40, v41
v_mfma_f32_16x16x32_bf16 v[176:179], a[48:51], v[52:55], v[176:179]
buffer_load_dwordx4 v12, s[72:75], 0 offen lds
v_mfma_f32_16x16x32_bf16 v[208:211], a[48:51], v[56:59], v[208:211]
ds_read_b128 a[24:27], v1 offset:14336
v_mfma_f32_16x16x32_bf16 v[240:243], a[48:51], v[60:63], v[240:243]
v_mfma_f32_16x16x32_bf16 v[244:247], a[52:55], v[60:63], v[244:247]
v_exp_f32 v42, v42
v_mfma_f32_16x16x32_bf16 v[212:215], a[52:55], v[56:59], v[212:215]
ds_read_b128 a[28:31], v1 offset:15360
v_mfma_f32_16x16x32_bf16 v[180:183], a[52:55], v[52:55], v[180:183]
v_exp_f32 v43, v43
v_mfma_f32_16x16x32_bf16 v[184:187], a[56:59], v[52:55], v[184:187]
ds_read_b128 a[32:35], v1 offset:0
v_cvt_pk_bf16_f32 v75, v42, v43
v_mfma_f32_16x16x32_bf16 v[216:219], a[56:59], v[56:59], v[216:219]
v_exp_f32 v44, v44
v_mfma_f32_16x16x32_bf16 v[248:251], a[56:59], v[60:63], v[248:251]
buffer_load_dwordx4 v13, s[72:75], 0 offen offset:1024 lds
v_mfma_f32_16x16x32_bf16 v[252:255], a[60:63], v[60:63], v[252:255]
ds_read_b128 a[36:39], v1 offset:1024
v_mfma_f32_16x16x32_bf16 v[220:223], a[60:63], v[56:59], v[220:223]
v_mfma_f32_16x16x32_bf16 v[188:191], a[60:63], v[52:55], v[188:191]
ds_read_b128 a[40:43], v1 offset:2048
v_mfma_f32_16x16x32_bf16 a[224:227], a[236:239], v[52:55], a[224:227]
s_waitcnt lgkmcnt(7)
v_exp_f32 v45, v45
v_smfmac_f32_16x16x64_bf16 a[228:231], a[232:235], v[56:63], v9
ds_read_b128 a[44:47], v1 offset:3072
v_cvt_pk_bf16_f32 v78, v44, v45
v_mfma_f32_16x16x32_bf16 v[24:27], a[0:3], a[192:195], v[88:91]
v_exp_f32 v46, v46
v_mfma_f32_16x16x32_bf16 v[24:27], a[4:7], a[196:199], v[24:27]
ds_read_b128 a[48:51], v1 offset:4096
v_mfma_f32_16x16x32_bf16 v[24:27], a[8:11], a[200:203], v[24:27]
buffer_load_dwordx4 v12, s[72:75], s12 offen offset:2048 lds
v_mfma_f32_16x16x32_bf16 v[24:27], a[12:15], a[204:207], v[24:27]
v_exp_f32 v47, v47
v_mfma_f32_16x16x32_bf16 v[28:31], a[0:3], a[208:211], v[92:95]
ds_read_b128 a[52:55], v1 offset:5120
v_cvt_pk_bf16_f32 v79, v46, v47
v_mfma_f32_16x16x32_bf16 v[28:31], a[4:7], a[212:215], v[28:31]
v_mfma_f32_16x16x32_bf16 v[28:31], a[8:11], a[216:219], v[28:31]
ds_read_b128 a[56:59], v1 offset:6144
v_mfma_f32_16x16x32_bf16 v[28:31], a[12:15], a[220:223], v[28:31]
s_waitcnt lgkmcnt(7)
v_exp_f32 v24, v24
v_mfma_f32_16x16x32_bf16 v[40:43], a[16:19], a[192:195], v[88:91]
ds_read_b128 a[60:63], v1 offset:7168
v_mfma_f32_16x16x32_bf16 v[40:43], a[20:23], a[196:199], v[40:43]
v_exp_f32 v25, v25
v_mfma_f32_16x16x32_bf16 v[40:43], a[24:27], a[200:203], v[40:43]
buffer_load_dwordx4 v13, s[72:75], s12 offen offset:3072 lds
v_mfma_f32_16x16x32_bf16 v[40:43], a[28:31], a[204:207], v[40:43]
v_exp_f32 v26, v26
v_mfma_f32_16x16x32_bf16 v[44:47], a[16:19], a[208:211], v[92:95]
v_exp_f32 v27, v27
v_mfma_f32_16x16x32_bf16 v[44:47], a[20:23], a[212:215], v[44:47]
v_exp_f32 v28, v28
v_mfma_f32_16x16x32_bf16 v[44:47], a[24:27], a[216:219], v[44:47]
v_exp_f32 v29, v29
v_mfma_f32_16x16x32_bf16 v[44:47], a[28:31], a[220:223], v[44:47]
s_waitcnt lgkmcnt(0)
v_mfma_f32_16x16x32_bf16 v[192:195], a[32:35], v[72:75], v[192:195]
ds_read_b128 a[0:3], v1 offset:24576
v_cvt_pk_bf16_f32 v56, v24, v25
v_mfma_f32_16x16x32_bf16 v[224:227], a[32:35], v[76:79], v[224:227]
ds_read_b128 a[4:7], v1 offset:25600
v_add_u32 v12, 0x20000, v12
v_mfma_f32_16x16x32_bf16 v[228:231], a[36:39], v[76:79], v[228:231]
s_add_u32 m0, s17, 0x14000
v_exp_f32 v30, v30
v_mfma_f32_16x16x32_bf16 v[196:199], a[36:39], v[72:75], v[196:199]
buffer_load_dwordx4 v12, s[72:75], 0 offen lds
v_mfma_f32_16x16x32_bf16 v[200:203], a[40:43], v[72:75], v[200:203]
ds_read_b128 a[8:11], v1 offset:26624
v_cvt_pk_bf16_f32 v57, v26, v27
v_mfma_f32_16x16x32_bf16 v[232:235], a[40:43], v[76:79], v[232:235]
ds_read_b128 a[12:15], v1 offset:27648
v_cvt_pk_bf16_f32 v60, v28, v29
v_mfma_f32_16x16x32_bf16 v[236:239], a[44:47], v[76:79], v[236:239]
v_exp_f32 v31, v31
v_mfma_f32_16x16x32_bf16 v[204:207], a[44:47], v[72:75], v[204:207]
ds_read_b128 a[16:19], v1 offset:28672
v_cvt_pk_bf16_f32 v61, v30, v31
v_mfma_f32_16x16x32_bf16 v[208:211], a[48:51], v[72:75], v[208:211]
v_exp_f32 v40, v40
v_mfma_f32_16x16x32_bf16 v[240:243], a[48:51], v[76:79], v[240:243]
ds_read_b128 a[20:23], v1 offset:29696
v_mfma_f32_16x16x32_bf16 v[244:247], a[52:55], v[76:79], v[244:247]
ds_read_b128 a[24:27], v1 offset:30720
v_add_u32 v13, 0x20000, v13
v_mfma_f32_16x16x32_bf16 v[212:215], a[52:55], v[72:75], v[212:215]
buffer_load_dwordx4 v13, s[72:75], 0 offen offset:1024 lds
v_mfma_f32_16x16x32_bf16 v[216:219], a[56:59], v[72:75], v[216:219]
ds_read_b128 a[28:31], v1 offset:31744
v_mfma_f32_16x16x32_bf16 v[248:251], a[56:59], v[76:79], v[248:251]
v_exp_f32 v41, v41
v_mfma_f32_16x16x32_bf16 v[252:255], a[60:63], v[76:79], v[252:255]
ds_read_b128 a[32:35], v1 offset:16384
v_cvt_pk_bf16_f32 v58, v40, v41
v_mfma_f32_16x16x32_bf16 v[220:223], a[60:63], v[72:75], v[220:223]
s_waitcnt lgkmcnt(5)
v_exp_f32 v42, v42
v_smfmac_f32_16x16x64_bf16 a[228:231], a[232:235], v[72:79], v9
ds_read_b128 a[36:39], v1 offset:17408
v_exp_f32 v43, v43
v_mfma_f32_16x16x32_bf16 v[24:27], a[0:3], a[192:195], v[112:115]
v_exp_f32 v44, v44
v_mfma_f32_16x16x32_bf16 v[24:27], a[4:7], a[196:199], v[24:27]
buffer_load_dwordx4 v12, s[72:75], s12 offen offset:2048 lds
v_mfma_f32_16x16x32_bf16 v[24:27], a[8:11], a[200:203], v[24:27]
ds_read_b128 a[40:43], v1 offset:18432
v_cvt_pk_bf16_f32 v59, v42, v43
v_mfma_f32_16x16x32_bf16 v[24:27], a[12:15], a[204:207], v[24:27]
ds_read_b128 a[44:47], v1 offset:19456
v_exp_f32 v45, v45
v_mfma_f32_16x16x32_bf16 v[28:31], a[0:3], a[208:211], v[92:95]
ds_read_b128 a[48:51], v1 offset:20480
v_exp_f32 v46, v46
v_mfma_f32_16x16x32_bf16 v[28:31], a[4:7], a[212:215], v[28:31]
v_exp_f32 v47, v47
v_mfma_f32_16x16x32_bf16 v[28:31], a[8:11], a[216:219], v[28:31]
ds_read_b128 a[52:55], v1 offset:21504
v_cvt_pk_bf16_f32 v62, v44, v45
v_mfma_f32_16x16x32_bf16 v[28:31], a[12:15], a[220:223], v[28:31]
s_waitcnt lgkmcnt(6)
v_exp_f32 v24, v24
v_mfma_f32_16x16x32_bf16 v[40:43], a[16:19], a[192:195], v[116:119]
ds_read_b128 a[56:59], v1 offset:22528
v_cvt_pk_bf16_f32 v63, v46, v47
v_mfma_f32_16x16x32_bf16 v[40:43], a[20:23], a[196:199], v[40:43]
buffer_load_dwordx4 v13, s[72:75], s12 offen offset:3072 lds
v_mfma_f32_16x16x32_bf16 v[40:43], a[24:27], a[200:203], v[40:43]
ds_read_b128 a[60:63], v1 offset:23552
v_xor_b32 v1, 0x8000, v1
v_mfma_f32_16x16x32_bf16 v[40:43], a[28:31], a[204:207], v[40:43]
v_exp_f32 v25, v25
v_mfma_f32_16x16x32_bf16 v[44:47], a[16:19], a[208:211], v[92:95]
v_exp_f32 v26, v26
v_mfma_f32_16x16x32_bf16 v[44:47], a[20:23], a[212:215], v[44:47]
v_exp_f32 v27, v27
v_mfma_f32_16x16x32_bf16 v[44:47], a[24:27], a[216:219], v[44:47]
v_exp_f32 v28, v28
v_mfma_f32_16x16x32_bf16 v[44:47], a[28:31], a[220:223], v[44:47]
v_exp_f32 v29, v29
v_accvgpr_read_b32 v6, a224
v_accvgpr_read_b32 v7, a225
v_add_f32 v6, v6, v7
v_cmp_nge_f32 vcc, 0x6f800000, v6
v_rcp_f32 v6, v6
s_or_b64 s[34:35], s[34:35], vcc
s_add_u32 s8, s28, 0x0
v_pk_mul_f32 v[128:129], v[128:129], v[6:7] op_sel_hi:[1,0]
v_pk_mul_f32 v[130:131], v[130:131], v[6:7] op_sel_hi:[1,0]
v_pk_mul_f32 v[132:133], v[132:133], v[6:7] op_sel_hi:[1,0]
v_pk_mul_f32 v[134:135], v[134:135], v[6:7] op_sel_hi:[1,0]
v_cvt_pk_bf16_f32 v128, v128, v129
v_cvt_pk_bf16_f32 v129, v130, v131
v_cvt_pk_bf16_f32 v130, v132, v133
v_cvt_pk_bf16_f32 v131, v134, v135
buffer_store_dwordx4 v[128:131], v3, s[88:91], s8 offen sc1
s_add_u32 s8, s28, 0x2000
v_pk_mul_f32 v[136:137], v[136:137], v[6:7] op_sel_hi:[1,0]
v_pk_mul_f32 v[138:139], v[138:139], v[6:7] op_sel_hi:[1,0]
v_pk_mul_f32 v[140:141], v[140:141], v[6:7] op_sel_hi:[1,0]
v_pk_mul_f32 v[142:143], v[142:143], v[6:7] op_sel_hi:[1,0]
v_cvt_pk_bf16_f32 v136, v136, v137
v_cvt_pk_bf16_f32 v137, v138, v139
v_cvt_pk_bf16_f32 v138, v140, v141
v_cvt_pk_bf16_f32 v139, v142, v143
buffer_store_dwordx4 v[136:139], v3, s[88:91], s8 offen sc1
s_add_u32 s8, s28, 0x4000
v_pk_mul_f32 v[144:145], v[144:145], v[6:7] op_sel_hi:[1,0]
v_pk_mul_f32 v[146:147], v[146:147], v[6:7] op_sel_hi:[1,0]
v_pk_mul_f32 v[148:149], v[148:149], v[6:7] op_sel_hi:[1,0]
v_pk_mul_f32 v[150:151], v[150:151], v[6:7] op_sel_hi:[1,0]
v_cvt_pk_bf16_f32 v144, v144, v145
v_cvt_pk_bf16_f32 v145, v146, v147
v_cvt_pk_bf16_f32 v146, v148, v149
v_cvt_pk_bf16_f32 v147, v150, v151
buffer_store_dwordx4 v[144:147], v3, s[88:91], s8 offen sc1
s_add_u32 s8, s28, 0x6000
v_pk_mul_f32 v[152:153], v[152:153], v[6:7] op_sel_hi:[1,0]
v_pk_mul_f32 v[154:155], v[154:155], v[6:7] op_sel_hi:[1,0]
v_pk_mul_f32 v[156:157], v[156:157], v[6:7] op_sel_hi:[1,0]
v_pk_mul_f32 v[158:159], v[158:159], v[6:7] op_sel_hi:[1,0]
v_cvt_pk_bf16_f32 v152, v152, v153
v_cvt_pk_bf16_f32 v153, v154, v155
v_cvt_pk_bf16_f32 v154, v156, v157
v_cvt_pk_bf16_f32 v155, v158, v159
buffer_store_dwordx4 v[152:155], v3, s[88:91], s8 offen sc1
v_accvgpr_read_b32 v6, a226
v_accvgpr_read_b32 v7, a227
v_add_f32 v6, v6, v7
v_cmp_nge_f32 vcc, 0x6f800000, v6
v_rcp_f32 v6, v6
s_or_b64 s[34:35], s[34:35], vcc
s_add_u32 s8, s29, 0x0
v_pk_mul_f32 v[160:161], v[160:161], v[6:7] op_sel_hi:[1,0]
v_pk_mul_f32 v[162:163], v[162:163], v[6:7] op_sel_hi:[1,0]
v_pk_mul_f32 v[164:165], v[164:165], v[6:7] op_sel_hi:[1,0]
v_pk_mul_f32 v[166:167], v[166:167], v[6:7] op_sel_hi:[1,0]
v_cvt_pk_bf16_f32 v160, v160, v161
v_cvt_pk_bf16_f32 v161, v162, v163
v_cvt_pk_bf16_f32 v162, v164, v165
v_cvt_pk_bf16_f32 v163, v166, v167
buffer_store_dwordx4 v[160:163], v3, s[88:91], s8 offen sc1
s_add_u32 s8, s29, 0x2000
v_pk_mul_f32 v[168:169], v[168:169], v[6:7] op_sel_hi:[1,0]
v_pk_mul_f32 v[170:171], v[170:171], v[6:7] op_sel_hi:[1,0]
v_pk_mul_f32 v[172:173], v[172:173], v[6:7] op_sel_hi:[1,0]
v_pk_mul_f32 v[174:175], v[174:175], v[6:7] op_sel_hi:[1,0]
v_cvt_pk_bf16_f32 v168, v168, v169
v_cvt_pk_bf16_f32 v169, v170, v171
v_cvt_pk_bf16_f32 v170, v172, v173
v_cvt_pk_bf16_f32 v171, v174, v175
buffer_store_dwordx4 v[168:171], v3, s[88:91], s8 offen sc1
s_add_u32 s8, s29, 0x4000
v_pk_mul_f32 v[176:177], v[176:177], v[6:7] op_sel_hi:[1,0]
v_pk_mul_f32 v[178:179], v[178:179], v[6:7] op_sel_hi:[1,0]
v_pk_mul_f32 v[180:181], v[180:181], v[6:7] op_sel_hi:[1,0]
v_pk_mul_f32 v[182:183], v[182:183], v[6:7] op_sel_hi:[1,0]
v_cvt_pk_bf16_f32 v176, v176, v177
v_cvt_pk_bf16_f32 v177, v178, v179
v_cvt_pk_bf16_f32 v178, v180, v181
v_cvt_pk_bf16_f32 v179, v182, v183
buffer_store_dwordx4 v[176:179], v3, s[88:91], s8 offen sc1
s_add_u32 s8, s29, 0x6000
v_pk_mul_f32 v[184:185], v[184:185], v[6:7] op_sel_hi:[1,0]
v_pk_mul_f32 v[186:187], v[186:187], v[6:7] op_sel_hi:[1,0]
v_pk_mul_f32 v[188:189], v[188:189], v[6:7] op_sel_hi:[1,0]
v_pk_mul_f32 v[190:191], v[190:191], v[6:7] op_sel_hi:[1,0]
v_cvt_pk_bf16_f32 v184, v184, v185
v_cvt_pk_bf16_f32 v185, v186, v187
v_cvt_pk_bf16_f32 v186, v188, v189
v_cvt_pk_bf16_f32 v187, v190, v191
buffer_store_dwordx4 v[184:187], v3, s[88:91], s8 offen sc1
s_branch L_att_h1_1
L_att_j0:
s_cmp_ge_u32 s4, 2
s_cbranch_scc1 L_att_nl0_1
L_att_nl0_0:
v_mfma_f32_16x16x32_bf16 v[16:19], a[0:3], a[160:163], v[96:99]
ds_read_b128 a[128:131], v1 offset:24576
v_mov_b32 v240, 0
v_mfma_f32_16x16x32_bf16 v[16:19], a[4:7], a[164:167], v[16:19]
ds_read_b128 a[132:135], v1 offset:25600
v_mov_b32 v241, 0
v_mfma_f32_16x16x32_bf16 v[16:19], a[8:11], a[168:171], v[16:19]
ds_read_b128 a[136:139], v1 offset:26624
s_add_u32 m0, s27, 0x0
v_mfma_f32_16x16x32_bf16 v[16:19], a[12:15], a[172:175], v[16:19]
buffer_load_dwordx4 v3, s[48:51], s32 offen offset:0 sc1 lds
v_mfma_f32_16x16x32_bf16 v[20:23], a[0:3], a[176:179], v[84:87]
ds_read_b128 a[140:143], v1 offset:27648
v_mov_b32 v242, 0
v_mfma_f32_16x16x32_bf16 v[20:23], a[4:7], a[180:183], v[20:23]
ds_read_b128 a[144:147], v1 offset:28672
v_mov_b32 v243, 0
v_mfma_f32_16x16x32_bf16 v[20:23], a[8:11], a[184:187], v[20:23]
ds_read_b128 a[148:151], v1 offset:29696
v_mov_b32 v244, 0
v_mfma_f32_16x16x32_bf16 v[20:23], a[12:15], a[188:191], v[20:23]
ds_read_b128 a[152:155], v1 offset:30720
v_mov_b32 v245, 0
v_mfma_f32_16x16x32_bf16 v[24:27], a[0:3], a[192:195], v[88:91]
ds_read_b128 a[156:159], v1 offset:31744
v_mov_b32 v246, 0
v_mfma_f32_16x16x32_bf16 v[24:27], a[4:7], a[196:199], v[24:27]
buffer_load_dwordx4 v3, s[48:51], s32 offen offset:1024 sc1 lds
v_mfma_f32_16x16x32_bf16 v[24:27], a[8:11], a[200:203], v[24:27]
v_exp_f32 v16, v16
v_mfma_f32_16x16x32_bf16 v[24:27], a[12:15], a[204:207], v[24:27]
v_exp_f32 v17, v17
v_mfma_f32_16x16x32_bf16 v[28:31], a[0:3], a[208:211], v[92:95]
v_exp_f32 v18, v18
v_mfma_f32_16x16x32_bf16 v[28:31], a[4:7], a[212:215], v[28:31]
v_exp_f32 v19, v19
v_mfma_f32_16x16x32_bf16 v[28:31], a[8:11], a[216:219], v[28:31]
v_exp_f32 v20, v20
v_mfma_f32_16x16x32_bf16 v[28:31], a[12:15], a[220:223], v[28:31]
buffer_load_dwordx4 v3, s[48:51], s32 offen offset:2048 sc1 lds
v_mfma_f32_16x16x32_bf16 v[32:35], a[16:19], a[160:163], v[100:103]
v_exp_f32 v21, v21
v_mfma_f32_16x16x32_bf16 v[32:35], a[20:23], a[164:167], v[32:35]
v_exp_f32 v22, v22
v_mfma_f32_16x16x32_bf16 v[32:35], a[24:27], a[168:171], v[32:35]
v_exp_f32 v23, v23
v_mfma_f32_16x16x32_bf16 v[32:35], a[28:31], a[172:175], v[32:35]
v_exp_f32 v24, v24
v_mfma_f32_16x16x32_bf16 v[36:39], a[16:19], a[176:179], v[84:87]
v_exp_f32 v25, v25
v_mfma_f32_16x16x32_bf16 v[36:39], a[20:23], a[180:183], v[36:39]
buffer_load_dwordx4 v3, s[48:51], s32 offen offset:3072 sc1 lds
v_mfma_f32_16x16x32_bf16 v[36:39], a[24:27], a[184:187], v[36:39]
v_exp_f32 v26, v26
v_mfma_f32_16x16x32_bf16 v[36:39], a[28:31], a[188:191], v[36:39]
v_exp_f32 v27, v27
v_mfma_f32_16x16x32_bf16 v[40:43], a[16:19], a[192:195], v[88:91]
v_exp_f32 v28, v28
v_mfma_f32_16x16x32_bf16 v[40:43], a[20:23], a[196:199], v[40:43]
v_exp_f32 v29, v29
v_mfma_f32_16x16x32_bf16 v[40:43], a[24:27], a[200:203], v[40:43]
s_add_u32 m0, s27, 0x1000
v_exp_f32 v30, v30
v_mfma_f32_16x16x32_bf16 v[40:43], a[28:31], a[204:207], v[40:43]
buffer_load_dwordx4 v3, s[48:51], s7 offen offset:0 sc1 lds
v_mfma_f32_16x16x32_bf16 v[44:47], a[16:19], a[208:211], v[92:95]
v_exp_f32 v31, v31
v_mfma_f32_16x16x32_bf16 v[44:47], a[20:23], a[212:215], v[44:47]
v_exp_f32 v32, v32
v_mfma_f32_16x16x32_bf16 v[44:47], a[24:27], a[216:219], v[44:47]
v_exp_f32 v33, v33
v_mfma_f32_16x16x32_bf16 v[44:47], a[28:31], a[220:223], v[44:47]
s_waitcnt lgkmcnt(0)
v_cvt_pk_bf16_f32 v48, v16, v17
v_cvt_pk_bf16_f32 v49, v18, v19
v_cvt_pk_bf16_f32 v52, v20, v21
v_cvt_pk_bf16_f32 v53, v22, v23
v_cvt_pk_bf16_f32 v56, v24, v25
v_cvt_pk_bf16_f32 v57, v26, v27
v_mov_b32 v247, 0
v_mfma_f32_16x16x32_bf16 v[20:23], a[128:131], a[176:179], v[84:87]
ds_read_b128 a[32:35], v1 offset:16384
v_cvt_pk_bf16_f32 v60, v28, v29
v_mfma_f32_16x16x32_bf16 v[20:23], a[132:135], a[180:183], v[20:23]
v_exp_f32 v34, v34
v_mfma_f32_16x16x32_bf16 v[20:23], a[136:139], a[184:187], v[20:23]
buffer_load_dwordx4 v3, s[48:51], s7 offen offset:1024 sc1 lds
v_mfma_f32_16x16x32_bf16 v[20:23], a[140:143], a[188:191], v[20:23]
ds_read_b128 a[36:39], v1 offset:17408
v_cvt_pk_bf16_f32 v61, v30, v31
v_mfma_f32_16x16x32_bf16 v[24:27], a[128:131], a[192:195], v[88:91]
ds_read_b128 a[40:43], v1 offset:18432
v_cvt_pk_bf16_f32 v50, v32, v33
v_mfma_f32_16x16x32_bf16 v[24:27], a[132:135], a[196:199], v[24:27]
v_exp_f32 v35, v35
v_mfma_f32_16x16x32_bf16 v[24:27], a[136:139], a[200:203], v[24:27]
buffer_load_dwordx4 v3, s[48:51], s7 offen offset:2048 sc1 lds
v_mfma_f32_16x16x32_bf16 v[24:27], a[140:143], a[204:207], v[24:27]
ds_read_b128 a[44:47], v1 offset:19456
v_cvt_pk_bf16_f32 v51, v34, v35
v_mfma_f32_16x16x32_bf16 v[28:31], a[128:131], a[208:211], v[92:95]
v_exp_f32 v36, v36
v_mfma_f32_16x16x32_bf16 v[28:31], a[132:135], a[212:215], v[28:31]
ds_read_b128 a[48:51], v1 offset:20480
v_exp_f32 v37, v37
v_mfma_f32_16x16x32_bf16 v[28:31], a[136:139], a[216:219], v[28:31]
v_exp_f32 v38, v38
v_mfma_f32_16x16x32_bf16 v[28:31], a[140:143], a[220:223], v[28:31]
buffer_load_dwordx4 v3, s[48:51], s7 offen offset:3072 sc1 lds
v_exp_f32 v39, v39
v_cvt_pk_bf16_f32 v54, v36, v37
v_cvt_pk_bf16_f32 v55, v38, v39
v_mfma_f32_16x16x32_bf16 v[36:39], a[144:147], a[176:179], v[84:87]
ds_read_b128 a[52:55], v1 offset:21504
v_exp_f32 v40, v40
v_mfma_f32_16x16x32_bf16 v[36:39], a[148:151], a[180:183], v[36:39]
ds_read_b128 a[56:59], v1 offset:22528
v_exp_f32 v41, v41
v_mfma_f32_16x16x32_bf16 v[36:39], a[152:155], a[184:187], v[36:39]
s_mov_b32 s9, 0x0
v_exp_f32 v42, v42
v_mfma_f32_16x16x32_bf16 v[36:39], a[156:159], a[188:191], v[36:39]
buffer_load_dword a244, v8, s[72:75], s9 offen
v_exp_f32 v43, v43
v_cvt_pk_bf16_f32 v58, v40, v41
v_cvt_pk_bf16_f32 v59, v42, v43
v_mfma_f32_16x16x32_bf16 v[40:43], a[144:147], a[192:195], v[88:91]
ds_read_b128 a[60:63], v1 offset:23552
v_xor_b32 v1, 0x8000, v1
v_mfma_f32_16x16x32_bf16 v[40:43], a[148:151], a[196:199], v[40:43]
s_add_u32 s32, s32, 0x8000
v_exp_f32 v44, v44
v_mfma_f32_16x16x32_bf16 v[40:43], a[152:155], a[200:203], v[40:43]
s_add_u32 s7, s7, 0x8000
v_exp_f32 v45, v45
v_mfma_f32_16x16x32_bf16 v[40:43], a[156:159], a[204:207], v[40:43]
s_xor_b32 s27, s27, 0x38000
v_exp_f32 v46, v46
v_exp_f32 v47, v47
v_cvt_pk_bf16_f32 v62, v44, v45
v_cvt_pk_bf16_f32 v63, v46, v47
v_mfma_f32_16x16x32_bf16 v[44:47], a[144:147], a[208:211], v[92:95]
v_exp_f32 v20, v20
v_mfma_f32_16x16x32_bf16 v[44:47], a[148:151], a[212:215], v[44:47]
v_exp_f32 v21, v21
v_mfma_f32_16x16x32_bf16 v[44:47], a[152:155], a[216:219], v[44:47]
s_waitcnt vmcnt(9) lgkmcnt(0)
v_exp_f32 v22, v22
v_mfma_f32_16x16x32_bf16 v[44:47], a[156:159], a[220:223], v[44:47]
s_barrier
v_cvt_pk_bf16_f32 v68, v20, v21
v_exp_f32 v23, v23
v_exp_f32 v24, v24
v_exp_f32 v25, v25
v_exp_f32 v26, v26
v_exp_f32 v27, v27
v_cvt_pk_bf16_f32 v69, v22, v23
s_cmp_lg_u32 s33, 0
s_cbranch_scc1 L_sig_bn0
s_lshl_b32 s8, s6, 2
s_add_u32 s8, s8, 192
s_cmp_lg_u32 s4, 0
s_cbranch_scc1 L_sig_bn0
v_mov_b32 v4, 1
s_mov_b64 exec, 1
buffer_atomic_add v4, off, s[84:87], s8 sc1
s_mov_b64 exec, -1
L_sig_bn0:
s_branch L_att_l1_0
L_att_nl0_1:
v_mfma_f32_16x16x32_bf16 v[16:19], a[0:3], a[160:163], v[80:83]
ds_read_b128 a[128:131], v1 offset:24576
v_mov_b32 v240, 0
v_mfma_f32_16x16x32_bf16 v[16:19], a[4:7], a[164:167], v[16:19]
ds_read_b128 a[132:135], v1 offset:25600
v_mov_b32 v241, 0
v_mfma_f32_16x16x32_bf16 v[16:19], a[8:11], a[168:171], v[16:19]
ds_read_b128 a[136:139], v1 offset:26624
s_add_u32 m0, s27, 0x0
v_mfma_f32_16x16x32_bf16 v[16:19], a[12:15], a[172:175], v[16:19]
buffer_load_dwordx4 v3, s[48:51], s32 offen offset:0 sc1 lds
v_mfma_f32_16x16x32_bf16 v[20:23], a[0:3], a[176:179], v[84:87]
ds_read_b128 a[140:143], v1 offset:27648
v_mov_b32 v242, 0
v_mfma_f32_16x16x32_bf16 v[20:23], a[4:7], a[180:183], v[20:23]
ds_read_b128 a[144:147], v1 offset:28672
v_mov_b32 v243, 0
v_mfma_f32_16x16x32_bf16 v[20:23], a[8:11], a[184:187], v[20:23]
ds_read_b128 a[148:151], v1 offset:29696
v_mov_b32 v244, 0
v_mfma_f32_16x16x32_bf16 v[20:23], a[12:15], a[188:191], v[20:23]
ds_read_b128 a[152:155], v1 offset:30720
v_mov_b32 v245, 0
v_mfma_f32_16x16x32_bf16 v[24:27], a[0:3], a[192:195], v[88:91]
ds_read_b128 a[156:159], v1 offset:31744
v_mov_b32 v246, 0
v_mfma_f32_16x16x32_bf16 v[24:27], a[4:7], a[196:199], v[24:27]
buffer_load_dwordx4 v3, s[48:51], s32 offen offset:1024 sc1 lds
v_mfma_f32_16x16x32_bf16 v[24:27], a[8:11], a[200:203], v[24:27]
v_exp_f32 v16, v16
v_mfma_f32_16x16x32_bf16 v[24:27], a[12:15], a[204:207], v[24:27]
v_exp_f32 v17, v17
v_mfma_f32_16x16x32_bf16 v[28:31], a[0:3], a[208:211], v[92:95]
v_exp_f32 v18, v18
v_mfma_f32_16x16x32_bf16 v[28:31], a[4:7], a[212:215], v[28:31]
v_exp_f32 v19, v19
v_mfma_f32_16x16x32_bf16 v[28:31], a[8:11], a[216:219], v[28:31]
v_exp_f32 v20, v20
v_mfma_f32_16x16x32_bf16 v[28:31], a[12:15], a[220:223], v[28:31]
buffer_load_dwordx4 v3, s[48:51], s32 offen offset:2048 sc1 lds
v_mfma_f32_16x16x32_bf16 v[32:35], a[16:19], a[160:163], v[80:83]
v_exp_f32 v21, v21
v_mfma_f32_16x16x32_bf16 v[32:35], a[20:23], a[164:167], v[32:35]
v_exp_f32 v22, v22
v_mfma_f32_16x16x32_bf16 v[32:35], a[24:27], a[168:171], v[32:35]
v_exp_f32 v23, v23
v_mfma_f32_16x16x32_bf16 v[32:35], a[28:31], a[172:175], v[32:35]
v_exp_f32 v24, v24
v_mfma_f32_16x16x32_bf16 v[36:39], a[16:19], a[176:179], v[84:87]
v_exp_f32 v25, v25
v_mfma_f32_16x16x32_bf16 v[36:39], a[20:23], a[180:183], v[36:39]
buffer_load_dwordx4 v3, s[48:51], s32 offen offset:3072 sc1 lds
v_mfma_f32_16x16x32_bf16 v[36:39], a[24:27], a[184:187], v[36:39]
v_exp_f32 v26, v26
v_mfma_f32_16x16x32_bf16 v[36:39], a[28:31], a[188:191], v[36:39]
v_exp_f32 v27, v27
v_mfma_f32_16x16x32_bf16 v[40:43], a[16:19], a[192:195], v[88:91]
v_exp_f32 v28, v28
v_mfma_f32_16x16x32_bf16 v[40:43], a[20:23], a[196:199], v[40:43]
v_exp_f32 v29, v29
v_mfma_f32_16x16x32_bf16 v[40:43], a[24:27], a[200:203], v[40:43]
s_add_u32 m0, s27, 0x1000
v_exp_f32 v30, v30
v_mfma_f32_16x16x32_bf16 v[40:43], a[28:31], a[204:207], v[40:43]
buffer_load_dwordx4 v3, s[48:51], s7 offen offset:0 sc1 lds
v_mfma_f32_16x16x32_bf16 v[44:47], a[16:19], a[208:211], v[92:95]
v_exp_f32 v31, v31
v_mfma_f32_16x16x32_bf16 v[44:47], a[20:23], a[212:215], v[44:47]
v_exp_f32 v32, v32
v_mfma_f32_16x16x32_bf16 v[44:47], a[24:27], a[216:219], v[44:47]
v_exp_f32 v33, v33
v_mfma_f32_16x16x32_bf16 v[44:47], a[28:31], a[220:223], v[44:47]
s_waitcnt lgkmcnt(0)
v_cvt_pk_bf16_f32 v48, v16, v17
v_cvt_pk_bf16_f32 v49, v18, v19
v_cvt_pk_bf16_f32 v52, v20, v21
v_cvt_pk_bf16_f32 v53, v22, v23
v_cvt_pk_bf16_f32 v56, v24, v25
v_cvt_pk_bf16_f32 v57, v26, v27
v_mov_b32 v247, 0
v_mfma_f32_16x16x32_bf16 v[16:19], a[128:131], a[160:163], v[96:99]
ds_read_b128 a[32:35], v1 offset:16384
v_cvt_pk_bf16_f32 v60, v28, v29
v_mfma_f32_16x16x32_bf16 v[16:19], a[132:135], a[164:167], v[16:19]
v_exp_f32 v34, v34
v_mfma_f32_16x16x32_bf16 v[16:19], a[136:139], a[168:171], v[16:19]
v_exp_f32 v35, v35
v_mfma_f32_16x16x32_bf16 v[16:19], a[140:143], a[172:175], v[16:19]
buffer_load_dwordx4 v3, s[48:51], s7 offen offset:1024 sc1 lds
v_mfma_f32_16x16x32_bf16 v[20:23], a[128:131], a[176:179], v[84:87]
ds_read_b128 a[36:39], v1 offset:17408
v_cvt_pk_bf16_f32 v61, v30, v31
v_mfma_f32_16x16x32_bf16 v[20:23], a[132:135], a[180:183], v[20:23]
v_exp_f32 v36, v36
v_mfma_f32_16x16x32_bf16 v[20:23], a[136:139], a[184:187], v[20:23]
ds_read_b128 a[40:43], v1 offset:18432
v_cvt_pk_bf16_f32 v50, v32, v33
v_mfma_f32_16x16x32_bf16 v[20:23], a[140:143], a[188:191], v[20:23]
v_exp_f32 v37, v37
v_mfma_f32_16x16x32_bf16 v[24:27], a[128:131], a[192:195], v[88:91]
v_exp_f32 v38, v38
v_mfma_f32_16x16x32_bf16 v[24:27], a[132:135], a[196:199], v[24:27]
buffer_load_dwordx4 v3, s[48:51], s7 offen offset:2048 sc1 lds
v_mfma_f32_16x16x32_bf16 v[24:27], a[136:139], a[200:203], v[24:27]
ds_read_b128 a[44:47], v1 offset:19456
v_cvt_pk_bf16_f32 v51, v34, v35
v_mfma_f32_16x16x32_bf16 v[24:27], a[140:143], a[204:207], v[24:27]
v_exp_f32 v39, v39
v_mfma_f32_16x16x32_bf16 v[28:31], a[128:131], a[208:211], v[92:95]
v_exp_f32 v40, v40
v_mfma_f32_16x16x32_bf16 v[28:31], a[132:135], a[212:215], v[28:31]
ds_read_b128 a[48:51], v1 offset:20480
v_cvt_pk_bf16_f32 v54, v36, v37
v_mfma_f32_16x16x32_bf16 v[28:31], a[136:139], a[216:219], v[28:31]
v_exp_f32 v41, v41
v_mfma_f32_16x16x32_bf16 v[28:31], a[140:143], a[220:223], v[28:31]
v_exp_f32 v42, v42
v_mfma_f32_16x16x32_bf16 v[32:35], a[144:147], a[160:163], v[100:103]
buffer_load_dwordx4 v3, s[48:51], s7 offen offset:3072 sc1 lds
v_mfma_f32_16x16x32_bf16 v[32:35], a[148:151], a[164:167], v[32:35]
ds_read_b128 a[52:55], v1 offset:21504
v_cvt_pk_bf16_f32 v55, v38, v39
v_mfma_f32_16x16x32_bf16 v[32:35], a[152:155], a[168:171], v[32:35]
v_exp_f32 v43, v43
v_mfma_f32_16x16x32_bf16 v[32:35], a[156:159], a[172:175], v[32:35]
ds_read_b128 a[56:59], v1 offset:22528
v_cvt_pk_bf16_f32 v58, v40, v41
v_mfma_f32_16x16x32_bf16 v[36:39], a[144:147], a[176:179], v[84:87]
v_exp_f32 v44, v44
v_mfma_f32_16x16x32_bf16 v[36:39], a[148:151], a[180:183], v[36:39]
s_mov_b32 s9, 0x0
v_exp_f32 v45, v45
v_mfma_f32_16x16x32_bf16 v[36:39], a[152:155], a[184:187], v[36:39]
buffer_load_dword a244, v8, s[72:75], s9 offen
v_mfma_f32_16x16x32_bf16 v[36:39], a[156:159], a[188:191], v[36:39]
ds_read_b128 a[60:63], v1 offset:23552
v_xor_b32 v1, 0x8000, v1
v_cvt_pk_bf16_f32 v59, v42, v43
v_mfma_f32_16x16x32_bf16 v[40:43], a[144:147], a[192:195], v[88:91]
s_add_u32 s32, s32, 0x8000
v_exp_f32 v46, v46
v_mfma_f32_16x16x32_bf16 v[40:43], a[148:151], a[196:199], v[40:43]
s_add_u32 s7, s7, 0x8000
v_exp_f32 v47, v47
v_mfma_f32_16x16x32_bf16 v[40:43], a[152:155], a[200:203], v[40:43]
s_xor_b32 s27, s27, 0x38000
v_exp_f32 v16, v16
v_mfma_f32_16x16x32_bf16 v[40:43], a[156:159], a[204:207], v[40:43]
v_exp_f32 v17, v17
v_cvt_pk_bf16_f32 v62, v44, v45
v_cvt_pk_bf16_f32 v63, v46, v47
v_mfma_f32_16x16x32_bf16 v[44:47], a[144:147], a[208:211], v[92:95]
v_exp_f32 v18, v18
v_mfma_f32_16x16x32_bf16 v[44:47], a[148:151], a[212:215], v[44:47]
v_exp_f32 v19, v19
v_mfma_f32_16x16x32_bf16 v[44:47], a[152:155], a[216:219], v[44:47]
s_waitcnt vmcnt(9) lgkmcnt(0)
v_exp_f32 v20, v20
v_mfma_f32_16x16x32_bf16 v[44:47], a[156:159], a[220:223], v[44:47]
s_barrier
v_cvt_pk_bf16_f32 v64, v16, v17
v_exp_f32 v21, v21
v_exp_f32 v22, v22
v_exp_f32 v23, v23
v_exp_f32 v24, v24
v_exp_f32 v25, v25
v_exp_f32 v26, v26
v_exp_f32 v27, v27
v_cvt_pk_bf16_f32 v65, v18, v19
v_cvt_pk_bf16_f32 v68, v20, v21
v_cvt_pk_bf16_f32 v69, v22, v23
s_cmp_lg_u32 s33, 0
s_cbranch_scc1 L_sig_bn1
s_lshl_b32 s8, s6, 2
s_add_u32 s8, s8, 192
s_cmp_lg_u32 s4, 0
s_cbranch_scc1 L_sig_bn1
v_mov_b32 v4, 1
s_mov_b64 exec, 1
buffer_atomic_add v4, off, s[84:87], s8 sc1
s_mov_b64 exec, -1
L_sig_bn1:
s_branch L_att_l1_1
L_att_seven0:
v_mfma_f32_16x16x32_bf16 v[192:195], a[32:35], v[56:59], v[192:195]
v_exp_f32 v30, v30
v_mfma_f32_16x16x32_bf16 v[224:227], a[32:35], v[60:63], v[224:227]
ds_read_b128 a[0:3], v1 offset:8192
v_cvt_pk_bf16_f32 v72, v24, v25
v_mfma_f32_16x16x32_bf16 v[228:231], a[36:39], v[60:63], v[228:231]
ds_read_b128 a[4:7], v1 offset:9216
v_cvt_pk_bf16_f32 v73, v26, v27
v_mfma_f32_16x16x32_bf16 v[196:199], a[36:39], v[56:59], v[196:199]
s_add_u32 m0, s27, 0x0
v_exp_f32 v31, v31
v_mfma_f32_16x16x32_bf16 v[200:203], a[40:43], v[56:59], v[200:203]
ds_read_b128 a[8:11], v1 offset:10240
v_cvt_pk_bf16_f32 v76, v28, v29
v_mfma_f32_16x16x32_bf16 v[232:235], a[40:43], v[60:63], v[232:235]
buffer_load_dwordx4 v3, s[48:51], s32 offen offset:0 sc1 lds
v_mfma_f32_16x16x32_bf16 v[236:239], a[44:47], v[60:63], v[236:239]
v_exp_f32 v40, v40
v_mfma_f32_16x16x32_bf16 v[204:207], a[44:47], v[56:59], v[204:207]
ds_read_b128 a[12:15], v1 offset:11264
v_cvt_pk_bf16_f32 v77, v30, v31
v_mfma_f32_16x16x32_bf16 v[208:211], a[48:51], v[56:59], v[208:211]
ds_read_b128 a[16:19], v1 offset:12288
v_mfma_f32_16x16x32_bf16 v[240:243], a[48:51], v[60:63], v[240:243]
buffer_load_dwordx4 v3, s[48:51], s32 offen offset:1024 sc1 lds
v_mfma_f32_16x16x32_bf16 v[244:247], a[52:55], v[60:63], v[244:247]
ds_read_b128 a[20:23], v1 offset:13312
v_mfma_f32_16x16x32_bf16 v[212:215], a[52:55], v[56:59], v[212:215]
ds_read_b128 a[24:27], v1 offset:14336
v_mfma_f32_16x16x32_bf16 v[216:219], a[56:59], v[56:59], v[216:219]
ds_read_b128 a[28:31], v1 offset:15360
v_mfma_f32_16x16x32_bf16 v[248:251], a[56:59], v[60:63], v[248:251]
ds_read_b128 a[32:35], v1 offset:0
v_exp_f32 v41, v41
v_mfma_f32_16x16x32_bf16 v[252:255], a[60:63], v[60:63], v[252:255]
v_exp_f32 v42, v42
v_mfma_f32_16x16x32_bf16 v[220:223], a[60:63], v[56:59], v[220:223]
s_waitcnt lgkmcnt(5)
v_exp_f32 v43, v43
v_smfmac_f32_16x16x64_bf16 a[228:231], a[232:235], v[56:63], v9
ds_read_b128 a[36:39], v1 offset:1024
v_cvt_pk_bf16_f32 v74, v40, v41
v_mfma_f32_16x16x32_bf16 v[24:27], a[0:3], a[192:195], v[88:91]
ds_read_b128 a[40:43], v1 offset:2048
v_exp_f32 v44, v44
v_mfma_f32_16x16x32_bf16 v[24:27], a[4:7], a[196:199], v[24:27]
buffer_load_dwordx4 v3, s[48:51], s32 offen offset:2048 sc1 lds
v_mfma_f32_16x16x32_bf16 v[24:27], a[8:11], a[200:203], v[24:27]
v_exp_f32 v45, v45
v_mfma_f32_16x16x32_bf16 v[24:27], a[12:15], a[204:207], v[24:27]
ds_read_b128 a[44:47], v1 offset:3072
v_cvt_pk_bf16_f32 v75, v42, v43
v_mfma_f32_16x16x32_bf16 v[28:31], a[0:3], a[208:211], v[92:95]
ds_read_b128 a[48:51], v1 offset:4096
v_exp_f32 v46, v46
v_mfma_f32_16x16x32_bf16 v[28:31], a[4:7], a[212:215], v[28:31]
s_waitcnt lgkmcnt(5)
v_exp_f32 v47, v47
v_mfma_f32_16x16x32_bf16 v[28:31], a[8:11], a[216:219], v[28:31]
ds_read_b128 a[52:55], v1 offset:5120
v_cvt_pk_bf16_f32 v78, v44, v45
v_mfma_f32_16x16x32_bf16 v[28:31], a[12:15], a[220:223], v[28:31]
buffer_load_dwordx4 v3, s[48:51], s32 offen offset:3072 sc1 lds
v_mfma_f32_16x16x32_bf16 v[40:43], a[16:19], a[192:195], v[88:91]
ds_read_b128 a[56:59], v1 offset:6144
s_add_u32 s32, s32, 0x8000
v_mfma_f32_16x16x32_bf16 v[40:43], a[20:23], a[196:199], v[40:43]
ds_read_b128 a[60:63], v1 offset:7168
v_cvt_pk_bf16_f32 v79, v46, v47
v_mfma_f32_16x16x32_bf16 v[40:43], a[24:27], a[200:203], v[40:43]
v_exp_f32 v24, v24
v_mfma_f32_16x16x32_bf16 v[40:43], a[28:31], a[204:207], v[40:43]
v_exp_f32 v25, v25
v_mfma_f32_16x16x32_bf16 v[44:47], a[16:19], a[208:211], v[92:95]
v_exp_f32 v26, v26
v_mfma_f32_16x16x32_bf16 v[44:47], a[20:23], a[212:215], v[44:47]
v_exp_f32 v27, v27
v_mfma_f32_16x16x32_bf16 v[44:47], a[24:27], a[216:219], v[44:47]
v_exp_f32 v28, v28
v_mfma_f32_16x16x32_bf16 v[44:47], a[28:31], a[220:223], v[44:47]
s_waitcnt lgkmcnt(0)
v_exp_f32 v29, v29
v_mfma_f32_16x16x32_bf16 v[192:195], a[32:35], v[72:75], v[192:195]
s_add_u32 m0, s27, 0x1000
v_exp_f32 v30, v30
v_mfma_f32_16x16x32_bf16 v[224:227], a[32:35], v[76:79], v[224:227]
buffer_load_dwordx4 v3, s[48:51], s7 offen offset:0 sc1 lds
v_mfma_f32_16x16x32_bf16 v[228:231], a[36:39], v[76:79], v[228:231]
v_exp_f32 v31, v31
v_mfma_f32_16x16x32_bf16 v[196:199], a[36:39], v[72:75], v[196:199]
ds_read_b128 a[0:3], v1 offset:24576
v_cvt_pk_bf16_f32 v56, v24, v25
v_mfma_f32_16x16x32_bf16 v[200:203], a[40:43], v[72:75], v[200:203]
ds_read_b128 a[4:7], v1 offset:25600
v_cvt_pk_bf16_f32 v57, v26, v27
v_mfma_f32_16x16x32_bf16 v[232:235], a[40:43], v[76:79], v[232:235]
v_exp_f32 v40, v40
v_mfma_f32_16x16x32_bf16 v[236:239], a[44:47], v[76:79], v[236:239]
ds_read_b128 a[8:11], v1 offset:26624
v_cvt_pk_bf16_f32 v60, v28, v29
v_mfma_f32_16x16x32_bf16 v[204:207], a[44:47], v[72:75], v[204:207]
v_exp_f32 v41, v41
v_mfma_f32_16x16x32_bf16 v[208:211], a[48:51], v[72:75], v[208:211]
ds_read_b128 a[12:15], v1 offset:27648
v_cvt_pk_bf16_f32 v61, v30, v31
v_mfma_f32_16x16x32_bf16 v[240:243], a[48:51], v[76:79], v[240:243]
ds_read_b128 a[16:19], v1 offset:28672
v_cvt_pk_bf16_f32 v58, v40, v41
v_mfma_f32_16x16x32_bf16 v[244:247], a[52:55], v[76:79], v[244:247]
v_exp_f32 v42, v42
v_mfma_f32_16x16x32_bf16 v[212:215], a[52:55], v[72:75], v[212:215]
buffer_load_dwordx4 v3, s[48:51], s7 offen offset:1024 sc1 lds
v_mfma_f32_16x16x32_bf16 v[216:219], a[56:59], v[72:75], v[216:219]
ds_read_b128 a[20:23], v1 offset:29696
v_mfma_f32_16x16x32_bf16 v[248:251], a[56:59], v[76:79], v[248:251]
ds_read_b128 a[24:27], v1 offset:30720
v_mfma_f32_16x16x32_bf16 v[252:255], a[60:63], v[76:79], v[252:255]
ds_read_b128 a[28:31], v1 offset:31744
v_mfma_f32_16x16x32_bf16 v[220:223], a[60:63], v[72:75], v[220:223]
s_waitcnt lgkmcnt(4)
v_exp_f32 v43, v43
v_smfmac_f32_16x16x64_bf16 a[228:231], a[232:235], v[72:79], v9
ds_read_b128 a[32:35], v1 offset:16384
v_cvt_pk_bf16_f32 v59, v42, v43
v_mfma_f32_16x16x32_bf16 v[24:27], a[0:3], a[192:195], v[88:91]
ds_read_b128 a[36:39], v1 offset:17408
v_mfma_f32_16x16x32_bf16 v[24:27], a[4:7], a[196:199], v[24:27]
buffer_load_dwordx4 v3, s[48:51], s7 offen offset:2048 sc1 lds
v_mfma_f32_16x16x32_bf16 v[24:27], a[8:11], a[200:203], v[24:27]
ds_read_b128 a[40:43], v1 offset:18432
v_exp_f32 v44, v44
v_mfma_f32_16x16x32_bf16 v[24:27], a[12:15], a[204:207], v[24:27]
ds_read_b128 a[44:47], v1 offset:19456
v_exp_f32 v45, v45
v_mfma_f32_16x16x32_bf16 v[28:31], a[0:3], a[208:211], v[92:95]
ds_read_b128 a[48:51], v1 offset:20480
v_exp_f32 v46, v46
v_mfma_f32_16x16x32_bf16 v[28:31], a[4:7], a[212:215], v[28:31]
s_waitcnt lgkmcnt(5)
v_exp_f32 v47, v47
v_mfma_f32_16x16x32_bf16 v[28:31], a[8:11], a[216:219], v[28:31]
ds_read_b128 a[52:55], v1 offset:21504
v_cvt_pk_bf16_f32 v62, v44, v45
v_mfma_f32_16x16x32_bf16 v[28:31], a[12:15], a[220:223], v[28:31]
ds_read_b128 a[56:59], v1 offset:22528
v_cvt_pk_bf16_f32 v63, v46, v47
v_mfma_f32_16x16x32_bf16 v[40:43], a[16:19], a[192:195], v[88:91]
ds_read_b128 a[60:63], v1 offset:23552
v_xor_b32 v1, 0x8000, v1
v_mfma_f32_16x16x32_bf16 v[40:43], a[20:23], a[196:199], v[40:43]
buffer_load_dwordx4 v3, s[48:51], s7 offen offset:3072 sc1 lds
v_mfma_f32_16x16x32_bf16 v[40:43], a[24:27], a[200:203], v[40:43]
s_add_u32 s7, s7, 0x8000
v_exp_f32 v24, v24
v_mfma_f32_16x16x32_bf16 v[40:43], a[28:31], a[204:207], v[40:43]
s_xor_b32 s27, s27, 0x38000
v_exp_f32 v25, v25
v_mfma_f32_16x16x32_bf16 v[44:47], a[16:19], a[208:211], v[92:95]
v_exp_f32 v26, v26
v_mfma_f32_16x16x32_bf16 v[44:47], a[20:23], a[212:215], v[44:47]
v_exp_f32 v27, v27
v_mfma_f32_16x16x32_bf16 v[44:47], a[24:27], a[216:219], v[44:47]
s_waitcnt vmcnt(16) lgkmcnt(0)
v_exp_f32 v28, v28
v_mfma_f32_16x16x32_bf16 v[44:47], a[28:31], a[220:223], v[44:47]
s_barrier
v_exp_f32 v29, v29
L_att_sodd0:
v_mfma_f32_16x16x32_bf16 v[192:195], a[32:35], v[56:59], v[192:195]
v_exp_f32 v30, v30
v_mfma_f32_16x16x32_bf16 v[224:227], a[32:35], v[60:63], v[224:227]
ds_read_b128 a[0:3], v2 offset:8192
v_cvt_pk_bf16_f32 v72, v24, v25
v_mfma_f32_16x16x32_bf16 v[228:231], a[36:39], v[60:63], v[228:231]
ds_read_b128 a[4:7], v2 offset:9216
v_cvt_pk_bf16_f32 v73, v26, v27
v_mfma_f32_16x16x32_bf16 v[196:199], a[36:39], v[56:59], v[196:199]
s_add_u32 m0, s19, 0x0
v_exp_f32 v31, v31
v_mfma_f32_16x16x32_bf16 v[200:203], a[40:43], v[56:59], v[200:203]
ds_read_b128 a[8:11], v2 offset:10240
v_cvt_pk_bf16_f32 v76, v28, v29
v_mfma_f32_16x16x32_bf16 v[232:235], a[40:43], v[60:63], v[232:235]
buffer_load_dwordx4 v3, s[48:51], s32 offen offset:0 sc1 lds
v_mfma_f32_16x16x32_bf16 v[236:239], a[44:47], v[60:63], v[236:239]
v_exp_f32 v40, v40
v_mfma_f32_16x16x32_bf16 v[204:207], a[44:47], v[56:59], v[204:207]
ds_read_b128 a[12:15], v2 offset:11264
v_cvt_pk_bf16_f32 v77, v30, v31
v_mfma_f32_16x16x32_bf16 v[208:211], a[48:51], v[56:59], v[208:211]
ds_read_b128 a[16:19], v2 offset:12288
v_mfma_f32_16x16x32_bf16 v[240:243], a[48:51], v[60:63], v[240:243]
buffer_load_dwordx4 v3, s[48:51], s32 offen offset:1024 sc1 lds
v_mfma_f32_16x16x32_bf16 v[244:247], a[52:55], v[60:63], v[244:247]
ds_read_b128 a[20:23], v2 offset:13312
v_mfma_f32_16x16x32_bf16 v[212:215], a[52:55], v[56:59], v[212:215]
ds_read_b128 a[24:27], v2 offset:14336
v_mfma_f32_16x16x32_bf16 v[216:219], a[56:59], v[56:59], v[216:219]
ds_read_b128 a[28:31], v2 offset:15360
v_mfma_f32_16x16x32_bf16 v[248:251], a[56:59], v[60:63], v[248:251]
ds_read_b128 a[32:35], v2 offset:0
v_exp_f32 v41, v41
v_mfma_f32_16x16x32_bf16 v[252:255], a[60:63], v[60:63], v[252:255]
v_exp_f32 v42, v42
v_mfma_f32_16x16x32_bf16 v[220:223], a[60:63], v[56:59], v[220:223]
s_waitcnt lgkmcnt(5)
v_exp_f32 v43, v43
v_smfmac_f32_16x16x64_bf16 a[228:231], a[232:235], v[56:63], v9
ds_read_b128 a[36:39], v2 offset:1024
v_cvt_pk_bf16_f32 v74, v40, v41
v_mfma_f32_16x16x32_bf16 v[24:27], a[0:3], a[192:195], v[88:91]
ds_read_b128 a[40:43], v2 offset:2048
v_exp_f32 v44, v44
v_mfma_f32_16x16x32_bf16 v[24:27], a[4:7], a[196:199], v[24:27]
buffer_load_dwordx4 v3, s[48:51], s32 offen offset:2048 sc1 lds
v_mfma_f32_16x16x32_bf16 v[24:27], a[8:11], a[200:203], v[24:27]
v_exp_f32 v45, v45
v_mfma_f32_16x16x32_bf16 v[24:27], a[12:15], a[204:207], v[24:27]
ds_read_b128 a[44:47], v2 offset:3072
v_cvt_pk_bf16_f32 v75, v42, v43
v_mfma_f32_16x16x32_bf16 v[28:31], a[0:3], a[208:211], v[92:95]
ds_read_b128 a[48:51], v2 offset:4096
v_exp_f32 v46, v46
v_mfma_f32_16x16x32_bf16 v[28:31], a[4:7], a[212:215], v[28:31]
s_waitcnt lgkmcnt(5)
v_exp_f32 v47, v47
v_mfma_f32_16x16x32_bf16 v[28:31], a[8:11], a[216:219], v[28:31]
ds_read_b128 a[52:55], v2 offset:5120
v_cvt_pk_bf16_f32 v78, v44, v45
v_mfma_f32_16x16x32_bf16 v[28:31], a[12:15], a[220:223], v[28:31]
buffer_load_dwordx4 v3, s[48:51], s32 offen offset:3072 sc1 lds
v_mfma_f32_16x16x32_bf16 v[40:43], a[16:19], a[192:195], v[88:91]
ds_read_b128 a[56:59], v2 offset:6144
s_add_u32 s32, s32, 0x8000
v_mfma_f32_16x16x32_bf16 v[40:43], a[20:23], a[196:199], v[40:43]
ds_read_b128 a[60:63], v2 offset:7168
v_cvt_pk_bf16_f32 v79, v46, v47
v_mfma_f32_16x16x32_bf16 v[40:43], a[24:27], a[200:203], v[40:43]
v_exp_f32 v24, v24
v_mfma_f32_16x16x32_bf16 v[40:43], a[28:31], a[204:207], v[40:43]
v_exp_f32 v25, v25
v_mfma_f32_16x16x32_bf16 v[44:47], a[16:19], a[208:211], v[92:95]
v_exp_f32 v26, v26
v_mfma_f32_16x16x32_bf16 v[44:47], a[20:23], a[212:215], v[44:47]
v_exp_f32 v27, v27
v_mfma_f32_16x16x32_bf16 v[44:47], a[24:27], a[216:219], v[44:47]
v_exp_f32 v28, v28
v_mfma_f32_16x16x32_bf16 v[44:47], a[28:31], a[220:223], v[44:47]
s_waitcnt lgkmcnt(0)
v_exp_f32 v29, v29
v_mfma_f32_16x16x32_bf16 v[192:195], a[32:35], v[72:75], v[192:195]
v_exp_f32 v30, v30
v_mfma_f32_16x16x32_bf16 v[224:227], a[32:35], v[76:79], v[224:227]
v_exp_f32 v31, v31
v_mfma_f32_16x16x32_bf16 v[228:231], a[36:39], v[76:79], v[228:231]
v_exp_f32 v40, v40
v_mfma_f32_16x16x32_bf16 v[196:199], a[36:39], v[72:75], v[196:199]
s_add_u32 m0, s19, 0x1000
v_exp_f32 v41, v41
v_mfma_f32_16x16x32_bf16 v[200:203], a[40:43], v[72:75], v[200:203]
ds_read_b128 a[0:3], v2 offset:24576
v_cvt_pk_bf16_f32 v56, v24, v25
v_mfma_f32_16x16x32_bf16 v[232:235], a[40:43], v[76:79], v[232:235]
buffer_load_dwordx4 v3, s[48:51], s7 offen offset:0 sc1 lds
v_mfma_f32_16x16x32_bf16 v[236:239], a[44:47], v[76:79], v[236:239]
ds_read_b128 a[4:7], v2 offset:25600
v_cvt_pk_bf16_f32 v57, v26, v27
v_mfma_f32_16x16x32_bf16 v[204:207], a[44:47], v[72:75], v[204:207]
ds_read_b128 a[8:11], v2 offset:26624
v_cvt_pk_bf16_f32 v60, v28, v29
v_mfma_f32_16x16x32_bf16 v[208:211], a[48:51], v[72:75], v[208:211]
ds_read_b128 a[12:15], v2 offset:27648
v_cvt_pk_bf16_f32 v61, v30, v31
v_mfma_f32_16x16x32_bf16 v[240:243], a[48:51], v[76:79], v[240:243]
ds_read_b128 a[16:19], v2 offset:28672
v_cvt_pk_bf16_f32 v58, v40, v41
v_mfma_f32_16x16x32_bf16 v[244:247], a[52:55], v[76:79], v[244:247]
buffer_load_dwordx4 v3, s[48:51], s7 offen offset:1024 sc1 lds
v_mfma_f32_16x16x32_bf16 v[212:215], a[52:55], v[72:75], v[212:215]
ds_read_b128 a[20:23], v2 offset:29696
v_mfma_f32_16x16x32_bf16 v[216:219], a[56:59], v[72:75], v[216:219]
v_exp_f32 v42, v42
v_mfma_f32_16x16x32_bf16 v[248:251], a[56:59], v[76:79], v[248:251]
ds_read_b128 a[24:27], v2 offset:30720
v_mfma_f32_16x16x32_bf16 v[252:255], a[60:63], v[76:79], v[252:255]
ds_read_b128 a[28:31], v2 offset:31744
v_exp_f32 v43, v43
v_mfma_f32_16x16x32_bf16 v[220:223], a[60:63], v[72:75], v[220:223]
ds_read_b128 a[32:35], v2 offset:16384
v_cvt_pk_bf16_f32 v59, v42, v43
v_smfmac_f32_16x16x64_bf16 a[228:231], a[232:235], v[72:79], v9
ds_read_b128 a[36:39], v2 offset:17408
s_waitcnt lgkmcnt(6)
v_mfma_f32_16x16x32_bf16 v[24:27], a[0:3], a[192:195], v[88:91]
buffer_load_dwordx4 v3, s[48:51], s7 offen offset:2048 sc1 lds
v_mfma_f32_16x16x32_bf16 v[24:27], a[4:7], a[196:199], v[24:27]
ds_read_b128 a[40:43], v2 offset:18432
v_exp_f32 v44, v44
v_mfma_f32_16x16x32_bf16 v[24:27], a[8:11], a[200:203], v[24:27]
ds_read_b128 a[44:47], v2 offset:19456
v_exp_f32 v45, v45
v_mfma_f32_16x16x32_bf16 v[24:27], a[12:15], a[204:207], v[24:27]
ds_read_b128 a[48:51], v2 offset:20480
v_cvt_pk_bf16_f32 v62, v44, v45
v_mfma_f32_16x16x32_bf16 v[28:31], a[0:3], a[208:211], v[92:95]
v_exp_f32 v46, v46
v_mfma_f32_16x16x32_bf16 v[28:31], a[4:7], a[212:215], v[28:31]
s_waitcnt lgkmcnt(5)
v_exp_f32 v47, v47
v_mfma_f32_16x16x32_bf16 v[28:31], a[8:11], a[216:219], v[28:31]
ds_read_b128 a[52:55], v2 offset:21504
v_cvt_pk_bf16_f32 v63, v46, v47
v_mfma_f32_16x16x32_bf16 v[28:31], a[12:15], a[220:223], v[28:31]
buffer_load_dwordx4 v3, s[48:51], s7 offen offset:3072 sc1 lds
v_mfma_f32_16x16x32_bf16 v[40:43], a[16:19], a[192:195], v[88:91]
ds_read_b128 a[56:59], v2 offset:22528
s_add_u32 s7, s7, 0x8000
v_mfma_f32_16x16x32_bf16 v[40:43], a[20:23], a[196:199], v[40:43]
ds_read_b128 a[60:63], v2 offset:23552
v_xor_b32 v2, 0x38000, v2
v_mfma_f32_16x16x32_bf16 v[40:43], a[24:27], a[200:203], v[40:43]
s_xor_b32 s19, s19, 0x8000
v_exp_f32 v24, v24
v_mfma_f32_16x16x32_bf16 v[40:43], a[28:31], a[204:207], v[40:43]
s_sub_u32 s15, s15, 1
v_exp_f32 v25, v25
v_mfma_f32_16x16x32_bf16 v[44:47], a[16:19], a[208:211], v[92:95]
s_cmp_lg_u32 s15, 0
v_exp_f32 v26, v26
v_mfma_f32_16x16x32_bf16 v[44:47], a[20:23], a[212:215], v[44:47]
v_exp_f32 v27, v27
v_mfma_f32_16x16x32_bf16 v[44:47], a[24:27], a[216:219], v[44:47]
s_waitcnt vmcnt(16) lgkmcnt(0)
v_exp_f32 v28, v28
v_mfma_f32_16x16x32_bf16 v[44:47], a[28:31], a[220:223], v[44:47]
s_barrier
v_exp_f32 v29, v29
s_cbranch_scc1 L_att_seven0
s_branch L_att_sdone
L_att_seven1:
v_mfma_f32_16x16x32_bf16 v[192:195], a[32:35], v[56:59], v[192:195]
v_exp_f32 v30, v30
v_mfma_f32_16x16x32_bf16 v[224:227], a[32:35], v[60:63], v[224:227]
ds_read_b128 a[0:3], v1 offset:8192
v_cvt_pk_bf16_f32 v72, v24, v25
v_mfma_f32_16x16x32_bf16 v[228:231], a[36:39], v[60:63], v[228:231]
ds_read_b128 a[4:7], v1 offset:9216
v_cvt_pk_bf16_f32 v73, v26, v27
v_mfma_f32_16x16x32_bf16 v[196:199], a[36:39], v[56:59], v[196:199]
s_add_u32 m0, s27, 0x0
v_exp_f32 v31, v31
v_mfma_f32_16x16x32_bf16 v[200:203], a[40:43], v[56:59], v[200:203]
ds_read_b128 a[8:11], v1 offset:10240
v_cvt_pk_bf16_f32 v76, v28, v29
v_mfma_f32_16x16x32_bf16 v[232:235], a[40:43], v[60:63], v[232:235]
buffer_load_dwordx4 v3, s[48:51], s32 offen offset:0 sc1 lds
v_mfma_f32_16x16x32_bf16 v[236:239], a[44:47], v[60:63], v[236:239]
v_exp_f32 v40, v40
v_mfma_f32_16x16x32_bf16 v[204:207], a[44:47], v[56:59], v[204:207]
ds_read_b128 a[12:15], v1 offset:11264
v_cvt_pk_bf16_f32 v77, v30, v31
v_mfma_f32_16x16x32_bf16 v[208:211], a[48:51], v[56:59], v[208:211]
ds_read_b128 a[16:19], v1 offset:12288
v_mfma_f32_16x16x32_bf16 v[240:243], a[48:51], v[60:63], v[240:243]
buffer_load_dwordx4 v3, s[48:51], s32 offen offset:1024 sc1 lds
v_mfma_f32_16x16x32_bf16 v[244:247], a[52:55], v[60:63], v[244:247]
ds_read_b128 a[20:23], v1 offset:13312
v_mfma_f32_16x16x32_bf16 v[212:215], a[52:55], v[56:59], v[212:215]
ds_read_b128 a[24:27], v1 offset:14336
v_mfma_f32_16x16x32_bf16 v[216:219], a[56:59], v[56:59], v[216:219]
ds_read_b128 a[28:31], v1 offset:15360
v_mfma_f32_16x16x32_bf16 v[248:251], a[56:59], v[60:63], v[248:251]
ds_read_b128 a[32:35], v1 offset:0
v_exp_f32 v41, v41
v_mfma_f32_16x16x32_bf16 v[252:255], a[60:63], v[60:63], v[252:255]
v_exp_f32 v42, v42
v_mfma_f32_16x16x32_bf16 v[220:223], a[60:63], v[56:59], v[220:223]
s_waitcnt lgkmcnt(5)
v_exp_f32 v43, v43
v_smfmac_f32_16x16x64_bf16 a[228:231], a[232:235], v[56:63], v9
ds_read_b128 a[36:39], v1 offset:1024
v_cvt_pk_bf16_f32 v74, v40, v41
v_mfma_f32_16x16x32_bf16 v[24:27], a[0:3], a[192:195], v[88:91]
ds_read_b128 a[40:43], v1 offset:2048
v_exp_f32 v44, v44
v_mfma_f32_16x16x32_bf16 v[24:27], a[4:7], a[196:199], v[24:27]
buffer_load_dwordx4 v3, s[48:51], s32 offen offset:2048 sc1 lds
v_mfma_f32_16x16x32_bf16 v[24:27], a[8:11], a[200:203], v[24:27]
v_exp_f32 v45, v45
v_mfma_f32_16x16x32_bf16 v[24:27], a[12:15], a[204:207], v[24:27]
ds_read_b128 a[44:47], v1 offset:3072
v_cvt_pk_bf16_f32 v75, v42, v43
v_mfma_f32_16x16x32_bf16 v[28:31], a[0:3], a[208:211], v[92:95]
ds_read_b128 a[48:51], v1 offset:4096
v_exp_f32 v46, v46
v_mfma_f32_16x16x32_bf16 v[28:31], a[4:7], a[212:215], v[28:31]
s_waitcnt lgkmcnt(5)
v_exp_f32 v47, v47
v_mfma_f32_16x16x32_bf16 v[28:31], a[8:11], a[216:219], v[28:31]
ds_read_b128 a[52:55], v1 offset:5120
v_cvt_pk_bf16_f32 v78, v44, v45
v_mfma_f32_16x16x32_bf16 v[28:31], a[12:15], a[220:223], v[28:31]
buffer_load_dwordx4 v3, s[48:51], s32 offen offset:3072 sc1 lds
v_mfma_f32_16x16x32_bf16 v[40:43], a[16:19], a[192:195], v[88:91]
ds_read_b128 a[56:59], v1 offset:6144
s_add_u32 s32, s32, 0x8000
v_mfma_f32_16x16x32_bf16 v[40:43], a[20:23], a[196:199], v[40:43]
ds_read_b128 a[60:63], v1 offset:7168
v_cvt_pk_bf16_f32 v79, v46, v47
v_mfma_f32_16x16x32_bf16 v[40:43], a[24:27], a[200:203], v[40:43]
v_exp_f32 v24, v24
v_mfma_f32_16x16x32_bf16 v[40:43], a[28:31], a[204:207], v[40:43]
v_exp_f32 v25, v25
v_mfma_f32_16x16x32_bf16 v[44:47], a[16:19], a[208:211], v[92:95]
v_exp_f32 v26, v26
v_mfma_f32_16x16x32_bf16 v[44:47], a[20:23], a[212:215], v[44:47]
v_exp_f32 v27, v27
v_mfma_f32_16x16x32_bf16 v[44:47], a[24:27], a[216:219], v[44:47]
v_exp_f32 v28, v28
v_mfma_f32_16x16x32_bf16 v[44:47], a[28:31], a[220:223], v[44:47]
s_waitcnt lgkmcnt(0)
v_exp_f32 v29, v29
v_mfma_f32_16x16x32_bf16 v[192:195], a[32:35], v[72:75], v[192:195]
s_add_u32 m0, s27, 0x1000
v_exp_f32 v30, v30
v_mfma_f32_16x16x32_bf16 v[224:227], a[32:35], v[76:79], v[224:227]
buffer_load_dwordx4 v3, s[48:51], s7 offen offset:0 sc1 lds
v_mfma_f32_16x16x32_bf16 v[228:231], a[36:39], v[76:79], v[228:231]
v_exp_f32 v31, v31
v_mfma_f32_16x16x32_bf16 v[196:199], a[36:39], v[72:75], v[196:199]
ds_read_b128 a[0:3], v1 offset:24576
v_cvt_pk_bf16_f32 v56, v24, v25
v_mfma_f32_16x16x32_bf16 v[200:203], a[40:43], v[72:75], v[200:203]
ds_read_b128 a[4:7], v1 offset:25600
v_cvt_pk_bf16_f32 v57, v26, v27
v_mfma_f32_16x16x32_bf16 v[232:235], a[40:43], v[76:79], v[232:235]
v_exp_f32 v40, v40
v_mfma_f32_16x16x32_bf16 v[236:239], a[44:47], v[76:79], v[236:239]
ds_read_b128 a[8:11], v1 offset:26624
v_cvt_pk_bf16_f32 v60, v28, v29
v_mfma_f32_16x16x32_bf16 v[204:207], a[44:47], v[72:75], v[204:207]
v_exp_f32 v41, v41
v_mfma_f32_16x16x32_bf16 v[208:211], a[48:51], v[72:75], v[208:211]
ds_read_b128 a[12:15], v1 offset:27648
v_cvt_pk_bf16_f32 v61, v30, v31
v_mfma_f32_16x16x32_bf16 v[240:243], a[48:51], v[76:79], v[240:243]
ds_read_b128 a[16:19], v1 offset:28672
v_cvt_pk_bf16_f32 v58, v40, v41
v_mfma_f32_16x16x32_bf16 v[244:247], a[52:55], v[76:79], v[244:247]
v_exp_f32 v42, v42
v_mfma_f32_16x16x32_bf16 v[212:215], a[52:55], v[72:75], v[212:215]
buffer_load_dwordx4 v3, s[48:51], s7 offen offset:1024 sc1 lds
v_mfma_f32_16x16x32_bf16 v[216:219], a[56:59], v[72:75], v[216:219]
ds_read_b128 a[20:23], v1 offset:29696
v_mfma_f32_16x16x32_bf16 v[248:251], a[56:59], v[76:79], v[248:251]
ds_read_b128 a[24:27], v1 offset:30720
v_mfma_f32_16x16x32_bf16 v[252:255], a[60:63], v[76:79], v[252:255]
ds_read_b128 a[28:31], v1 offset:31744
v_mfma_f32_16x16x32_bf16 v[220:223], a[60:63], v[72:75], v[220:223]
s_waitcnt lgkmcnt(4)
v_exp_f32 v43, v43
v_smfmac_f32_16x16x64_bf16 a[228:231], a[232:235], v[72:79], v9
ds_read_b128 a[32:35], v1 offset:16384
v_cvt_pk_bf16_f32 v59, v42, v43
v_mfma_f32_16x16x32_bf16 v[24:27], a[0:3], a[192:195], v[88:91]
ds_read_b128 a[36:39], v1 offset:17408
v_mfma_f32_16x16x32_bf16 v[24:27], a[4:7], a[196:199], v[24:27]
buffer_load_dwordx4 v3, s[48:51], s7 offen offset:2048 sc1 lds
v_mfma_f32_16x16x32_bf16 v[24:27], a[8:11], a[200:203], v[24:27]
ds_read_b128 a[40:43], v1 offset:18432
v_exp_f32 v44, v44
v_mfma_f32_16x16x32_bf16 v[24:27], a[12:15], a[204:207], v[24:27]
ds_read_b128 a[44:47], v1 offset:19456
v_exp_f32 v45, v45
v_mfma_f32_16x16x32_bf16 v[28:31], a[0:3], a[208:211], v[92:95]
ds_read_b128 a[48:51], v1 offset:20480
v_exp_f32 v46, v46
v_mfma_f32_16x16x32_bf16 v[28:31], a[4:7], a[212:215], v[28:31]
s_waitcnt lgkmcnt(5)
v_exp_f32 v47, v47
v_mfma_f32_16x16x32_bf16 v[28:31], a[8:11], a[216:219], v[28:31]
ds_read_b128 a[52:55], v1 offset:21504
v_cvt_pk_bf16_f32 v62, v44, v45
v_mfma_f32_16x16x32_bf16 v[28:31], a[12:15], a[220:223], v[28:31]
ds_read_b128 a[56:59], v1 offset:22528
v_cvt_pk_bf16_f32 v63, v46, v47
v_mfma_f32_16x16x32_bf16 v[40:43], a[16:19], a[192:195], v[88:91]
ds_read_b128 a[60:63], v1 offset:23552
v_xor_b32 v1, 0x8000, v1
v_mfma_f32_16x16x32_bf16 v[40:43], a[20:23], a[196:199], v[40:43]
buffer_load_dwordx4 v3, s[48:51], s7 offen offset:3072 sc1 lds
v_mfma_f32_16x16x32_bf16 v[40:43], a[24:27], a[200:203], v[40:43]
s_add_u32 s7, s7, 0x8000
v_exp_f32 v24, v24
v_mfma_f32_16x16x32_bf16 v[40:43], a[28:31], a[204:207], v[40:43]
s_xor_b32 s27, s27, 0x38000
v_exp_f32 v25, v25
v_mfma_f32_16x16x32_bf16 v[44:47], a[16:19], a[208:211], v[92:95]
s_waitcnt vmcnt(16) lgkmcnt(0)
v_exp_f32 v26, v26
v_mfma_f32_16x16x32_bf16 v[44:47], a[20:23], a[212:215], v[44:47]
s_barrier
v_exp_f32 v27, v27
v_mfma_f32_16x16x32_bf16 v[44:47], a[24:27], a[216:219], v[44:47]
v_exp_f32 v28, v28
v_mfma_f32_16x16x32_bf16 v[44:47], a[28:31], a[220:223], v[44:47]
v_exp_f32 v29, v29
L_att_sodd1:
v_mfma_f32_16x16x32_bf16 v[192:195], a[32:35], v[56:59], v[192:195]
v_exp_f32 v30, v30
v_mfma_f32_16x16x32_bf16 v[224:227], a[32:35], v[60:63], v[224:227]
ds_read_b128 a[0:3], v2 offset:8192
v_cvt_pk_bf16_f32 v72, v24, v25
v_mfma_f32_16x16x32_bf16 v[228:231], a[36:39], v[60:63], v[228:231]
ds_read_b128 a[4:7], v2 offset:9216
v_cvt_pk_bf16_f32 v73, v26, v27
v_mfma_f32_16x16x32_bf16 v[196:199], a[36:39], v[56:59], v[196:199]
s_add_u32 m0, s19, 0x0
v_exp_f32 v31, v31
v_mfma_f32_16x16x32_bf16 v[200:203], a[40:43], v[56:59], v[200:203]
ds_read_b128 a[8:11], v2 offset:10240
v_cvt_pk_bf16_f32 v76, v28, v29
v_mfma_f32_16x16x32_bf16 v[232:235], a[40:43], v[60:63], v[232:235]
buffer_load_dwordx4 v3, s[48:51], s32 offen offset:0 sc1 lds
v_mfma_f32_16x16x32_bf16 v[236:239], a[44:47], v[60:63], v[236:239]
v_exp_f32 v40, v40
v_mfma_f32_16x16x32_bf16 v[204:207], a[44:47], v[56:59], v[204:207]
ds_read_b128 a[12:15], v2 offset:11264
v_cvt_pk_bf16_f32 v77, v30, v31
v_mfma_f32_16x16x32_bf16 v[208:211], a[48:51], v[56:59], v[208:211]
ds_read_b128 a[16:19], v2 offset:12288
v_mfma_f32_16x16x32_bf16 v[240:243], a[48:51], v[60:63], v[240:243]
buffer_load_dwordx4 v3, s[48:51], s32 offen offset:1024 sc1 lds
v_mfma_f32_16x16x32_bf16 v[244:247], a[52:55], v[60:63], v[244:247]
ds_read_b128 a[20:23], v2 offset:13312
v_mfma_f32_16x16x32_bf16 v[212:215], a[52:55], v[56:59], v[212:215]
ds_read_b128 a[24:27], v2 offset:14336
v_mfma_f32_16x16x32_bf16 v[216:219], a[56:59], v[56:59], v[216:219]
ds_read_b128 a[28:31], v2 offset:15360
v_mfma_f32_16x16x32_bf16 v[248:251], a[56:59], v[60:63], v[248:251]
ds_read_b128 a[32:35], v2 offset:0
v_exp_f32 v41, v41
v_mfma_f32_16x16x32_bf16 v[252:255], a[60:63], v[60:63], v[252:255]
v_exp_f32 v42, v42
v_mfma_f32_16x16x32_bf16 v[220:223], a[60:63], v[56:59], v[220:223]
s_waitcnt lgkmcnt(5)
v_exp_f32 v43, v43
v_smfmac_f32_16x16x64_bf16 a[228:231], a[232:235], v[56:63], v9
ds_read_b128 a[36:39], v2 offset:1024
v_cvt_pk_bf16_f32 v74, v40, v41
v_mfma_f32_16x16x32_bf16 v[24:27], a[0:3], a[192:195], v[88:91]
ds_read_b128 a[40:43], v2 offset:2048
v_exp_f32 v44, v44
v_mfma_f32_16x16x32_bf16 v[24:27], a[4:7], a[196:199], v[24:27]
buffer_load_dwordx4 v3, s[48:51], s32 offen offset:2048 sc1 lds
v_mfma_f32_16x16x32_bf16 v[24:27], a[8:11], a[200:203], v[24:27]
v_exp_f32 v45, v45
v_mfma_f32_16x16x32_bf16 v[24:27], a[12:15], a[204:207], v[24:27]
ds_read_b128 a[44:47], v2 offset:3072
v_cvt_pk_bf16_f32 v75, v42, v43
v_mfma_f32_16x16x32_bf16 v[28:31], a[0:3], a[208:211], v[92:95]
ds_read_b128 a[48:51], v2 offset:4096
v_exp_f32 v46, v46
v_mfma_f32_16x16x32_bf16 v[28:31], a[4:7], a[212:215], v[28:31]
s_waitcnt lgkmcnt(5)
v_exp_f32 v47, v47
v_mfma_f32_16x16x32_bf16 v[28:31], a[8:11], a[216:219], v[28:31]
ds_read_b128 a[52:55], v2 offset:5120
v_cvt_pk_bf16_f32 v78, v44, v45
v_mfma_f32_16x16x32_bf16 v[28:31], a[12:15], a[220:223], v[28:31]
buffer_load_dwordx4 v3, s[48:51], s32 offen offset:3072 sc1 lds
v_mfma_f32_16x16x32_bf16 v[40:43], a[16:19], a[192:195], v[88:91]
ds_read_b128 a[56:59], v2 offset:6144
s_add_u32 s32, s32, 0x8000
v_mfma_f32_16x16x32_bf16 v[40:43], a[20:23], a[196:199], v[40:43]
ds_read_b128 a[60:63], v2 offset:7168
v_cvt_pk_bf16_f32 v79, v46, v47
v_mfma_f32_16x16x32_bf16 v[40:43], a[24:27], a[200:203], v[40:43]
v_exp_f32 v24, v24
v_mfma_f32_16x16x32_bf16 v[40:43], a[28:31], a[204:207], v[40:43]
v_exp_f32 v25, v25
v_mfma_f32_16x16x32_bf16 v[44:47], a[16:19], a[208:211], v[92:95]
v_exp_f32 v26, v26
v_mfma_f32_16x16x32_bf16 v[44:47], a[20:23], a[212:215], v[44:47]
v_exp_f32 v27, v27
v_mfma_f32_16x16x32_bf16 v[44:47], a[24:27], a[216:219], v[44:47]
v_exp_f32 v28, v28
v_mfma_f32_16x16x32_bf16 v[44:47], a[28:31], a[220:223], v[44:47]
s_waitcnt lgkmcnt(0)
v_exp_f32 v29, v29
v_mfma_f32_16x16x32_bf16 v[192:195], a[32:35], v[72:75], v[192:195]
v_exp_f32 v30, v30
v_mfma_f32_16x16x32_bf16 v[224:227], a[32:35], v[76:79], v[224:227]
v_exp_f32 v31, v31
v_mfma_f32_16x16x32_bf16 v[228:231], a[36:39], v[76:79], v[228:231]
v_exp_f32 v40, v40
v_mfma_f32_16x16x32_bf16 v[196:199], a[36:39], v[72:75], v[196:199]
s_add_u32 m0, s19, 0x1000
v_exp_f32 v41, v41
v_mfma_f32_16x16x32_bf16 v[200:203], a[40:43], v[72:75], v[200:203]
ds_read_b128 a[0:3], v2 offset:24576
v_cvt_pk_bf16_f32 v56, v24, v25
v_mfma_f32_16x16x32_bf16 v[232:235], a[40:43], v[76:79], v[232:235]
buffer_load_dwordx4 v3, s[48:51], s7 offen offset:0 sc1 lds
v_mfma_f32_16x16x32_bf16 v[236:239], a[44:47], v[76:79], v[236:239]
ds_read_b128 a[4:7], v2 offset:25600
v_cvt_pk_bf16_f32 v57, v26, v27
v_mfma_f32_16x16x32_bf16 v[204:207], a[44:47], v[72:75], v[204:207]
ds_read_b128 a[8:11], v2 offset:26624
v_cvt_pk_bf16_f32 v60, v28, v29
v_mfma_f32_16x16x32_bf16 v[208:211], a[48:51], v[72:75], v[208:211]
ds_read_b128 a[12:15], v2 offset:27648
v_cvt_pk_bf16_f32 v61, v30, v31
v_mfma_f32_16x16x32_bf16 v[240:243], a[48:51], v[76:79], v[240:243]
ds_read_b128 a[16:19], v2 offset:28672
v_cvt_pk_bf16_f32 v58, v40, v41
v_mfma_f32_16x16x32_bf16 v[244:247], a[52:55], v[76:79], v[244:247]
buffer_load_dwordx4 v3, s[48:51], s7 offen offset:1024 sc1 lds
v_mfma_f32_16x16x32_bf16 v[212:215], a[52:55], v[72:75], v[212:215]
ds_read_b128 a[20:23], v2 offset:29696
v_mfma_f32_16x16x32_bf16 v[216:219], a[56:59], v[72:75], v[216:219]
v_exp_f32 v42, v42
v_mfma_f32_16x16x32_bf16 v[248:251], a[56:59], v[76:79], v[248:251]
ds_read_b128 a[24:27], v2 offset:30720
v_mfma_f32_16x16x32_bf16 v[252:255], a[60:63], v[76:79], v[252:255]
ds_read_b128 a[28:31], v2 offset:31744
v_exp_f32 v43, v43
v_mfma_f32_16x16x32_bf16 v[220:223], a[60:63], v[72:75], v[220:223]
ds_read_b128 a[32:35], v2 offset:16384
v_cvt_pk_bf16_f32 v59, v42, v43
v_smfmac_f32_16x16x64_bf16 a[228:231], a[232:235], v[72:79], v9
ds_read_b128 a[36:39], v2 offset:17408
s_waitcnt lgkmcnt(6)
v_mfma_f32_16x16x32_bf16 v[24:27], a[0:3], a[192:195], v[88:91]
buffer_load_dwordx4 v3, s[48:51], s7 offen offset:2048 sc1 lds
v_mfma_f32_16x16x32_bf16 v[24:27], a[4:7], a[196:199], v[24:27]
ds_read_b128 a[40:43], v2 offset:18432
v_exp_f32 v44, v44
v_mfma_f32_16x16x32_bf16 v[24:27], a[8:11], a[200:203], v[24:27]
ds_read_b128 a[44:47], v2 offset:19456
v_exp_f32 v45, v45
v_mfma_f32_16x16x32_bf16 v[24:27], a[12:15], a[204:207], v[24:27]
ds_read_b128 a[48:51], v2 offset:20480
v_cvt_pk_bf16_f32 v62, v44, v45
v_mfma_f32_16x16x32_bf16 v[28:31], a[0:3], a[208:211], v[92:95]
v_exp_f32 v46, v46
v_mfma_f32_16x16x32_bf16 v[28:31], a[4:7], a[212:215], v[28:31]
s_waitcnt lgkmcnt(5)
v_exp_f32 v47, v47
v_mfma_f32_16x16x32_bf16 v[28:31], a[8:11], a[216:219], v[28:31]
ds_read_b128 a[52:55], v2 offset:21504
v_cvt_pk_bf16_f32 v63, v46, v47
v_mfma_f32_16x16x32_bf16 v[28:31], a[12:15], a[220:223], v[28:31]
buffer_load_dwordx4 v3, s[48:51], s7 offen offset:3072 sc1 lds
v_mfma_f32_16x16x32_bf16 v[40:43], a[16:19], a[192:195], v[88:91]
ds_read_b128 a[56:59], v2 offset:22528
s_add_u32 s7, s7, 0x8000
v_mfma_f32_16x16x32_bf16 v[40:43], a[20:23], a[196:199], v[40:43]
ds_read_b128 a[60:63], v2 offset:23552
v_xor_b32 v2, 0x38000, v2
v_mfma_f32_16x16x32_bf16 v[40:43], a[24:27], a[200:203], v[40:43]
s_xor_b32 s19, s19, 0x8000
v_exp_f32 v24, v24
v_mfma_f32_16x16x32_bf16 v[40:43], a[28:31], a[204:207], v[40:43]
s_sub_u32 s15, s15, 1
v_exp_f32 v25, v25
v_mfma_f32_16x16x32_bf16 v[44:47], a[16:19], a[208:211], v[92:95]
s_cmp_lg_u32 s15, 0
s_waitcnt vmcnt(16) lgkmcnt(0)
v_exp_f32 v26, v26
v_mfma_f32_16x16x32_bf16 v[44:47], a[20:23], a[212:215], v[44:47]
s_barrier
v_exp_f32 v27, v27
v_mfma_f32_16x16x32_bf16 v[44:47], a[24:27], a[216:219], v[44:47]
v_exp_f32 v28, v28
v_mfma_f32_16x16x32_bf16 v[44:47], a[28:31], a[220:223], v[44:47]
v_exp_f32 v29, v29
s_cbranch_scc1 L_att_seven1
L_att_sdone:
s_cmp_ge_u32 s4, 2
s_cbranch_scc1 L_att_sh0_1
L_att_sh0_0:
v_mfma_f32_16x16x32_bf16 v[192:195], a[32:35], v[56:59], v[192:195]
ds_read_b128 a[0:3], v1 offset:8192
v_cvt_pk_bf16_f32 v72, v24, v25
v_mfma_f32_16x16x32_bf16 v[224:227], a[32:35], v[60:63], v[224:227]
ds_read_b128 a[4:7], v1 offset:9216
v_cvt_pk_bf16_f32 v73, v26, v27
v_mfma_f32_16x16x32_bf16 v[228:231], a[36:39], v[60:63], v[228:231]
v_exp_f32 v30, v30
v_mfma_f32_16x16x32_bf16 v[196:199], a[36:39], v[56:59], v[196:199]
buffer_load_dword v14, v15, s[84:87], 0 offen offset:192 sc1
v_mfma_f32_16x16x32_bf16 v[200:203], a[40:43], v[56:59], v[200:203]
ds_read_b128 a[8:11], v1 offset:10240
v_cvt_pk_bf16_f32 v76, v28, v29
v_mfma_f32_16x16x32_bf16 v[232:235], a[40:43], v[60:63], v[232:235]
ds_read_b128 a[12:15], v1 offset:11264
v_mfma_f32_16x16x32_bf16 v[236:239], a[44:47], v[60:63], v[236:239]
s_add_u32 m0, s17, 0x10000
v_exp_f32 v31, v31
v_mfma_f32_16x16x32_bf16 v[204:207], a[44:47], v[56:59], v[204:207]
ds_read_b128 a[16:19], v1 offset:12288
v_cvt_pk_bf16_f32 v77, v30, v31
v_mfma_f32_16x16x32_bf16 v[208:211], a[48:51], v[56:59], v[208:211]
ds_read_b128 a[20:23], v1 offset:13312
v_mfma_f32_16x16x32_bf16 v[240:243], a[48:51], v[60:63], v[240:243]
buffer_load_dwordx4 v12, s[72:75], 0 offen lds
v_mfma_f32_16x16x32_bf16 v[244:247], a[52:55], v[60:63], v[244:247]
ds_read_b128 a[24:27], v1 offset:14336
v_exp_f32 v40, v40
v_mfma_f32_16x16x32_bf16 v[212:215], a[52:55], v[56:59], v[212:215]
v_exp_f32 v41, v41
v_mfma_f32_16x16x32_bf16 v[216:219], a[56:59], v[56:59], v[216:219]
ds_read_b128 a[28:31], v1 offset:15360
v_exp_f32 v42, v42
v_mfma_f32_16x16x32_bf16 v[248:251], a[56:59], v[60:63], v[248:251]
v_exp_f32 v43, v43
v_mfma_f32_16x16x32_bf16 v[252:255], a[60:63], v[60:63], v[252:255]
ds_read_b128 a[32:35], v1 offset:0
v_cvt_pk_bf16_f32 v74, v40, v41
v_mfma_f32_16x16x32_bf16 v[220:223], a[60:63], v[56:59], v[220:223]
buffer_load_dwordx4 v13, s[72:75], 0 offen offset:1024 lds
v_smfmac_f32_16x16x64_bf16 a[228:231], a[232:235], v[56:63], v9
ds_read_b128 a[36:39], v1 offset:1024
s_waitcnt lgkmcnt(6)
v_mfma_f32_16x16x32_bf16 v[24:27], a[0:3], a[192:195], v[112:115]
ds_read_b128 a[40:43], v1 offset:2048
v_exp_f32 v44, v44
v_mfma_f32_16x16x32_bf16 v[24:27], a[4:7], a[196:199], v[24:27]
v_exp_f32 v45, v45
v_mfma_f32_16x16x32_bf16 v[24:27], a[8:11], a[200:203], v[24:27]
ds_read_b128 a[44:47], v1 offset:3072
v_exp_f32 v46, v46
v_mfma_f32_16x16x32_bf16 v[24:27], a[12:15], a[204:207], v[24:27]
v_exp_f32 v47, v47
v_mfma_f32_16x16x32_bf16 v[28:31], a[0:3], a[208:211], v[92:95]
buffer_load_dwordx4 v12, s[72:75], s12 offen offset:2048 lds
v_mfma_f32_16x16x32_bf16 v[28:31], a[4:7], a[212:215], v[28:31]
ds_read_b128 a[48:51], v1 offset:4096
v_cvt_pk_bf16_f32 v75, v42, v43
v_mfma_f32_16x16x32_bf16 v[28:31], a[8:11], a[216:219], v[28:31]
ds_read_b128 a[52:55], v1 offset:5120
v_cvt_pk_bf16_f32 v78, v44, v45
v_mfma_f32_16x16x32_bf16 v[28:31], a[12:15], a[220:223], v[28:31]
ds_read_b128 a[56:59], v1 offset:6144
s_waitcnt lgkmcnt(7)
v_mfma_f32_16x16x32_bf16 v[40:43], a[16:19], a[192:195], v[116:119]
v_exp_f32 v24, v24
v_mfma_f32_16x16x32_bf16 v[40:43], a[20:23], a[196:199], v[40:43]
ds_read_b128 a[60:63], v1 offset:7168
v_cvt_pk_bf16_f32 v79, v46, v47
v_mfma_f32_16x16x32_bf16 v[40:43], a[24:27], a[200:203], v[40:43]
buffer_load_dwordx4 v13, s[72:75], s12 offen offset:3072 lds
v_mfma_f32_16x16x32_bf16 v[40:43], a[28:31], a[204:207], v[40:43]
v_exp_f32 v25, v25
v_mfma_f32_16x16x32_bf16 v[44:47], a[16:19], a[208:211], v[92:95]
v_exp_f32 v26, v26
v_mfma_f32_16x16x32_bf16 v[44:47], a[20:23], a[212:215], v[44:47]
v_exp_f32 v27, v27
v_mfma_f32_16x16x32_bf16 v[44:47], a[24:27], a[216:219], v[44:47]
v_exp_f32 v28, v28
v_mfma_f32_16x16x32_bf16 v[44:47], a[28:31], a[220:223], v[44:47]
s_waitcnt lgkmcnt(0)
v_exp_f32 v29, v29
v_mfma_f32_16x16x32_bf16 v[192:195], a[32:35], v[72:75], v[192:195]
s_add_u32 m0, s17, 0x14000
v_exp_f32 v30, v30
v_mfma_f32_16x16x32_bf16 v[224:227], a[32:35], v[76:79], v[224:227]
v_add_u32 v12, 0x20000, v12
v_cvt_pk_bf16_f32 v56, v24, v25
v_mfma_f32_16x16x32_bf16 v[228:231], a[36:39], v[76:79], v[228:231]
buffer_load_dwordx4 v12, s[72:75], 0 offen lds
v_mfma_f32_16x16x32_bf16 v[196:199], a[36:39], v[72:75], v[196:199]
v_exp_f32 v31, v31
v_mfma_f32_16x16x32_bf16 v[200:203], a[40:43], v[72:75], v[200:203]
ds_read_b128 a[0:3], v1 offset:24576
v_cvt_pk_bf16_f32 v57, v26, v27
v_mfma_f32_16x16x32_bf16 v[232:235], a[40:43], v[76:79], v[232:235]
ds_read_b128 a[4:7], v1 offset:25600
v_cvt_pk_bf16_f32 v60, v28, v29
v_mfma_f32_16x16x32_bf16 v[236:239], a[44:47], v[76:79], v[236:239]
v_exp_f32 v40, v40
v_mfma_f32_16x16x32_bf16 v[204:207], a[44:47], v[72:75], v[204:207]
ds_read_b128 a[8:11], v1 offset:26624
v_add_u32 v13, 0x20000, v13
v_mfma_f32_16x16x32_bf16 v[208:211], a[48:51], v[72:75], v[208:211]
buffer_load_dwordx4 v13, s[72:75], 0 offen offset:1024 lds
v_mfma_f32_16x16x32_bf16 v[240:243], a[48:51], v[76:79], v[240:243]
ds_read_b128 a[12:15], v1 offset:27648
v_cvt_pk_bf16_f32 v61, v30, v31
v_mfma_f32_16x16x32_bf16 v[244:247], a[52:55], v[76:79], v[244:247]
ds_read_b128 a[16:19], v1 offset:28672
v_exp_f32 v41, v41
v_mfma_f32_16x16x32_bf16 v[212:215], a[52:55], v[72:75], v[212:215]
ds_read_b128 a[20:23], v1 offset:29696
v_exp_f32 v42, v42
v_mfma_f32_16x16x32_bf16 v[216:219], a[56:59], v[72:75], v[216:219]
ds_read_b128 a[24:27], v1 offset:30720
v_exp_f32 v43, v43
v_mfma_f32_16x16x32_bf16 v[248:251], a[56:59], v[76:79], v[248:251]
ds_read_b128 a[28:31], v1 offset:31744
v_exp_f32 v44, v44
v_mfma_f32_16x16x32_bf16 v[252:255], a[60:63], v[76:79], v[252:255]
ds_read_b128 a[32:35], v1 offset:16384
v_exp_f32 v45, v45
v_mfma_f32_16x16x32_bf16 v[220:223], a[60:63], v[72:75], v[220:223]
buffer_load_dwordx4 v12, s[72:75], s12 offen offset:2048 lds
v_smfmac_f32_16x16x64_bf16 a[228:231], a[232:235], v[72:79], v9
ds_read_b128 a[36:39], v1 offset:17408
s_waitcnt lgkmcnt(6)
v_mfma_f32_16x16x32_bf16 v[28:31], a[0:3], a[208:211], v[92:95]
buffer_load_dwordx4 v13, s[72:75], s12 offen offset:3072 lds
v_mfma_f32_16x16x32_bf16 v[28:31], a[4:7], a[212:215], v[28:31]
ds_read_b128 a[40:43], v1 offset:18432
v_exp_f32 v46, v46
v_mfma_f32_16x16x32_bf16 v[28:31], a[8:11], a[216:219], v[28:31]
ds_read_b128 a[44:47], v1 offset:19456
v_exp_f32 v47, v47
v_mfma_f32_16x16x32_bf16 v[28:31], a[12:15], a[220:223], v[28:31]
ds_read_b128 a[48:51], v1 offset:20480
s_waitcnt lgkmcnt(5)
v_cvt_pk_bf16_f32 v62, v44, v45
v_cvt_pk_bf16_f32 v63, v46, v47
v_mfma_f32_16x16x32_bf16 v[44:47], a[16:19], a[208:211], v[92:95]
ds_read_b128 a[52:55], v1 offset:21504
v_cvt_pk_bf16_f32 v58, v40, v41
v_mfma_f32_16x16x32_bf16 v[44:47], a[20:23], a[212:215], v[44:47]
ds_read_b128 a[56:59], v1 offset:22528
v_cvt_pk_bf16_f32 v59, v42, v43
v_mfma_f32_16x16x32_bf16 v[44:47], a[24:27], a[216:219], v[44:47]
ds_read_b128 a[60:63], v1 offset:23552
v_xor_b32 v1, 0x8000, v1
v_mfma_f32_16x16x32_bf16 v[44:47], a[28:31], a[220:223], v[44:47]
L_att_h1_0:
s_waitcnt vmcnt(8) lgkmcnt(0)
s_mov_b32 s92, 200000
L_spin_b0:
v_cmp_gt_u32 vcc, 32, v14
s_nop 4
s_cbranch_vccz L_spun_b0
s_sub_u32 s92, s92, 1
s_cbranch_scc1 L_spun_b0
s_sleep 6
buffer_load_dword v14, v15, s[84:87], 0 offen offset:192 sc1
s_waitcnt vmcnt(0)
s_branch L_spin_b0
L_spun_b0:
s_barrier
v_mfma_f32_16x16x32_bf16 v[192:195], a[32:35], v[56:59], v[192:195]
ds_read_b128 a[0:3], v2 offset:8192
v_exp_f32 v28, v28
v_mfma_f32_16x16x32_bf16 v[224:227], a[32:35], v[60:63], v[224:227]
ds_read_b128 a[4:7], v2 offset:9216
v_exp_f32 v29, v29
v_mfma_f32_16x16x32_bf16 v[228:231], a[36:39], v[60:63], v[228:231]
s_add_u32 s101, s101, 0x2000
v_exp_f32 v30, v30
v_mfma_f32_16x16x32_bf16 v[196:199], a[36:39], v[56:59], v[196:199]
buffer_load_dwordx4 a[64:67], v3, s[88:91], s101 offen sc1
v_mfma_f32_16x16x32_bf16 v[200:203], a[40:43], v[56:59], v[200:203]
ds_read_b128 a[8:11], v2 offset:10240
v_exp_f32 v31, v31
v_mfma_f32_16x16x32_bf16 v[232:235], a[40:43], v[60:63], v[232:235]
buffer_load_dwordx4 a[68:71], v3, s[88:91], s101 offen offset:1024 sc1
v_mfma_f32_16x16x32_bf16 v[236:239], a[44:47], v[60:63], v[236:239]
ds_read_b128 a[12:15], v2 offset:11264
v_exp_f32 v44, v44
v_mfma_f32_16x16x32_bf16 v[204:207], a[44:47], v[56:59], v[204:207]
buffer_load_dwordx4 a[72:75], v3, s[88:91], s101 offen offset:2048 sc1
v_mfma_f32_16x16x32_bf16 v[208:211], a[48:51], v[56:59], v[208:211]
ds_read_b128 a[16:19], v2 offset:12288
v_cvt_pk_bf16_f32 v76, v28, v29
v_mfma_f32_16x16x32_bf16 v[240:243], a[48:51], v[60:63], v[240:243]
buffer_load_dwordx4 a[76:79], v3, s[88:91], s101 offen offset:3072 sc1
v_mfma_f32_16x16x32_bf16 v[244:247], a[52:55], v[60:63], v[244:247]
ds_read_b128 a[20:23], v2 offset:13312
v_exp_f32 v45, v45
v_mfma_f32_16x16x32_bf16 v[212:215], a[52:55], v[56:59], v[212:215]
ds_read_b128 a[24:27], v2 offset:14336
v_exp_f32 v46, v46
v_mfma_f32_16x16x32_bf16 v[216:219], a[56:59], v[56:59], v[216:219]
ds_read_b128 a[28:31], v2 offset:15360
s_add_u32 s101, s101, 0x2000
v_mfma_f32_16x16x32_bf16 v[248:251], a[56:59], v[60:63], v[248:251]
buffer_load_dwordx4 a[80:83], v3, s[88:91], s101 offen sc1
v_mfma_f32_16x16x32_bf16 v[252:255], a[60:63], v[60:63], v[252:255]
ds_read_b128 a[32:35], v2 offset:0
v_cvt_pk_bf16_f32 v77, v30, v31
v_mfma_f32_16x16x32_bf16 v[220:223], a[60:63], v[56:59], v[220:223]
ds_read_b128 a[36:39], v2 offset:1024
s_waitcnt lgkmcnt(6)
v_smfmac_f32_16x16x64_bf16 a[228:231], a[232:235], v[56:63], v9
buffer_load_dwordx4 a[84:87], v3, s[88:91], s101 offen offset:1024 sc1
v_mfma_f32_16x16x32_bf16 v[28:31], a[0:3], a[208:211], v[92:95]
ds_read_b128 a[40:43], v2 offset:2048
v_exp_f32 v47, v47
v_mfma_f32_16x16x32_bf16 v[28:31], a[4:7], a[212:215], v[28:31]
ds_read_b128 a[44:47], v2 offset:3072
v_cvt_pk_bf16_f32 v78, v44, v45
v_mfma_f32_16x16x32_bf16 v[28:31], a[8:11], a[216:219], v[28:31]
buffer_load_dwordx4 a[88:91], v3, s[88:91], s101 offen offset:2048 sc1
v_mfma_f32_16x16x32_bf16 v[28:31], a[12:15], a[220:223], v[28:31]
ds_read_b128 a[48:51], v2 offset:4096
s_waitcnt lgkmcnt(5)
v_cvt_pk_bf16_f32 v79, v46, v47
v_mfma_f32_16x16x32_bf16 v[44:47], a[16:19], a[208:211], v[92:95]
ds_read_b128 a[52:55], v2 offset:5120
v_mfma_f32_16x16x32_bf16 v[44:47], a[20:23], a[212:215], v[44:47]
buffer_load_dwordx4 a[92:95], v3, s[88:91], s101 offen offset:3072 sc1
v_mfma_f32_16x16x32_bf16 v[44:47], a[24:27], a[216:219], v[44:47]
ds_read_b128 a[56:59], v2 offset:6144
v_mfma_f32_16x16x32_bf16 v[44:47], a[28:31], a[220:223], v[44:47]
ds_read_b128 a[60:63], v2 offset:7168
s_waitcnt lgkmcnt(0)
v_mfma_f32_16x16x32_bf16 v[224:227], a[32:35], v[76:79], v[224:227]
ds_read_b128 a[0:3], v2 offset:24576
s_add_u32 s101, s101, 0x2000
v_mfma_f32_16x16x32_bf16 v[228:231], a[36:39], v[76:79], v[228:231]
buffer_load_dwordx4 a[96:99], v3, s[88:91], s101 offen sc1
v_mfma_f32_16x16x32_bf16 v[232:235], a[40:43], v[76:79], v[232:235]
ds_read_b128 a[4:7], v2 offset:25600
v_exp_f32 v28, v28
v_mfma_f32_16x16x32_bf16 v[236:239], a[44:47], v[76:79], v[236:239]
buffer_load_dwordx4 a[100:103], v3, s[88:91], s101 offen offset:1024 sc1
v_mfma_f32_16x16x32_bf16 v[240:243], a[48:51], v[76:79], v[240:243]
ds_read_b128 a[8:11], v2 offset:26624
v_exp_f32 v29, v29
v_mfma_f32_16x16x32_bf16 v[244:247], a[52:55], v[76:79], v[244:247]
buffer_load_dwordx4 a[104:107], v3, s[88:91], s101 offen offset:2048 sc1
v_mfma_f32_16x16x32_bf16 v[248:251], a[56:59], v[76:79], v[248:251]
ds_read_b128 a[12:15], v2 offset:27648
s_waitcnt lgkmcnt(0)
v_mfma_f32_16x16x32_bf16 v[252:255], a[60:63], v[76:79], v[252:255]
buffer_load_dwordx4 a[108:111], v3, s[88:91], s101 offen offset:3072 sc1
ds_read_b128 a[16:19], v2 offset:28672
v_mfma_f32_16x16x32_bf16 a[228:231], a[236:239], v[76:79], a[228:231]
ds_read_b128 a[20:23], v2 offset:29696
s_add_u32 s101, s101, 0x2000
v_exp_f32 v30, v30
v_exp_f32 v31, v31
v_cvt_pk_bf16_f32 v60, v28, v29
v_cvt_pk_bf16_f32 v61, v30, v31
v_mfma_f32_16x16x32_bf16 v[28:31], a[0:3], a[208:211], v[120:123]
buffer_load_dwordx4 a[112:115], v3, s[88:91], s101 offen sc1
ds_read_b128 a[24:27], v2 offset:30720
v_mfma_f32_16x16x32_bf16 v[28:31], a[4:7], a[212:215], v[28:31]
ds_read_b128 a[28:31], v2 offset:31744
v_exp_f32 v44, v44
v_mfma_f32_16x16x32_bf16 v[28:31], a[8:11], a[216:219], v[28:31]
buffer_load_dwordx4 a[116:119], v3, s[88:91], s101 offen offset:1024 sc1
v_mfma_f32_16x16x32_bf16 v[28:31], a[12:15], a[220:223], v[28:31]
ds_read_b128 a[32:35], v2 offset:16384
s_waitcnt lgkmcnt(1)
v_exp_f32 v45, v45
v_exp_f32 v46, v46
v_exp_f32 v47, v47
v_cvt_pk_bf16_f32 v62, v44, v45
v_cvt_pk_bf16_f32 v63, v46, v47
v_mfma_f32_16x16x32_bf16 v[44:47], a[16:19], a[208:211], v[124:127]
buffer_load_dwordx4 a[120:123], v3, s[88:91], s101 offen offset:2048 sc1
v_mfma_f32_16x16x32_bf16 v[44:47], a[20:23], a[212:215], v[44:47]
buffer_load_dwordx4 a[124:127], v3, s[88:91], s101 offen offset:3072 sc1
v_mfma_f32_16x16x32_bf16 v[44:47], a[24:27], a[216:219], v[44:47]
ds_read_b128 a[36:39], v2 offset:17408
v_mfma_f32_16x16x32_bf16 v[44:47], a[28:31], a[220:223], v[44:47]
ds_read_b128 a[40:43], v2 offset:18432
ds_read_b128 a[44:47], v2 offset:19456
ds_read_b128 a[48:51], v2 offset:20480
ds_read_b128 a[52:55], v2 offset:21504
ds_read_b128 a[56:59], v2 offset:22528
ds_read_b128 a[60:63], v2 offset:23552
v_xor_b32 v2, 0x38000, v2
s_waitcnt lgkmcnt(0)
s_barrier
v_accvgpr_read_b32 v6, a228
v_accvgpr_read_b32 v7, a229
v_add_f32 v6, v6, v7
v_cmp_nge_f32 vcc, 0x6f800000, v6
v_rcp_f32 v6, v6
s_or_b64 s[34:35], s[34:35], vcc
v_mfma_f32_16x16x32_bf16 v[224:227], a[32:35], v[60:63], v[224:227]
ds_read_b128 a[32:35], v1 offset:0
v_exp_f32 v28, v28
v_mfma_f32_16x16x32_bf16 v[228:231], a[36:39], v[60:63], v[228:231]
ds_read_b128 a[36:39], v1 offset:1024
v_exp_f32 v29, v29
v_mfma_f32_16x16x32_bf16 v[232:235], a[40:43], v[60:63], v[232:235]
ds_read_b128 a[40:43], v1 offset:2048
v_exp_f32 v30, v30
v_mfma_f32_16x16x32_bf16 v[236:239], a[44:47], v[60:63], v[236:239]
ds_read_b128 a[44:47], v1 offset:3072
v_exp_f32 v31, v31
v_mfma_f32_16x16x32_bf16 v[240:243], a[48:51], v[60:63], v[240:243]
ds_read_b128 a[48:51], v1 offset:4096
v_exp_f32 v44, v44
v_mfma_f32_16x16x32_bf16 v[244:247], a[52:55], v[60:63], v[244:247]
ds_read_b128 a[52:55], v1 offset:5120
v_exp_f32 v45, v45
v_mfma_f32_16x16x32_bf16 v[248:251], a[56:59], v[60:63], v[248:251]
ds_read_b128 a[56:59], v1 offset:6144
v_exp_f32 v46, v46
v_mfma_f32_16x16x32_bf16 v[252:255], a[60:63], v[60:63], v[252:255]
ds_read_b128 a[60:63], v1 offset:7168
v_exp_f32 v47, v47
v_mfma_f32_16x16x32_bf16 a[228:231], a[236:239], v[60:63], a[228:231]
v_cvt_pk_bf16_f32 v76, v28, v29
v_cvt_pk_bf16_f32 v77, v30, v31
v_cvt_pk_bf16_f32 v78, v44, v45
v_cvt_pk_bf16_f32 v79, v46, v47
s_add_u32 s8, s30, 0x0
v_pk_mul_f32 v[192:193], v[192:193], v[6:7] op_sel_hi:[1,0]
v_pk_mul_f32 v[194:195], v[194:195], v[6:7] op_sel_hi:[1,0]
v_pk_mul_f32 v[196:197], v[196:197], v[6:7] op_sel_hi:[1,0]
v_pk_mul_f32 v[198:199], v[198:199], v[6:7] op_sel_hi:[1,0]
v_cvt_pk_bf16_f32 v192, v192, v193
v_cvt_pk_bf16_f32 v193, v194, v195
v_cvt_pk_bf16_f32 v194, v196, v197
v_cvt_pk_bf16_f32 v195, v198, v199
buffer_store_dwordx4 v[192:195], v3, s[88:91], s8 offen sc1
s_add_u32 s8, s30, 0x2000
v_pk_mul_f32 v[200:201], v[200:201], v[6:7] op_sel_hi:[1,0]
v_pk_mul_f32 v[202:203], v[202:203], v[6:7] op_sel_hi:[1,0]
v_pk_mul_f32 v[204:205], v[204:205], v[6:7] op_sel_hi:[1,0]
v_pk_mul_f32 v[206:207], v[206:207], v[6:7] op_sel_hi:[1,0]
v_cvt_pk_bf16_f32 v200, v200, v201
v_cvt_pk_bf16_f32 v201, v202, v203
v_cvt_pk_bf16_f32 v202, v204, v205
v_cvt_pk_bf16_f32 v203, v206, v207
buffer_store_dwordx4 v[200:203], v3, s[88:91], s8 offen sc1
s_waitcnt lgkmcnt(0)
v_mfma_f32_16x16x32_bf16 v[224:227], a[32:35], v[76:79], v[224:227]
s_add_u32 s8, s30, 0x4000
v_mul_f32 v208, v6, v208
v_mfma_f32_16x16x32_bf16 v[228:231], a[36:39], v[76:79], v[228:231]
v_mul_f32 v209, v6, v209
v_mul_f32 v210, v6, v210
v_mfma_f32_16x16x32_bf16 v[232:235], a[40:43], v[76:79], v[232:235]
v_mul_f32 v211, v6, v211
v_mul_f32 v212, v6, v212
v_mfma_f32_16x16x32_bf16 v[236:239], a[44:47], v[76:79], v[236:239]
v_mul_f32 v213, v6, v213
v_mul_f32 v214, v6, v214
v_mfma_f32_16x16x32_bf16 v[240:243], a[48:51], v[76:79], v[240:243]
v_mul_f32 v215, v6, v215
v_cvt_pk_bf16_f32 v208, v208, v209
v_mfma_f32_16x16x32_bf16 v[244:247], a[52:55], v[76:79], v[244:247]
v_cvt_pk_bf16_f32 v209, v210, v211
v_cvt_pk_bf16_f32 v210, v212, v213
v_mfma_f32_16x16x32_bf16 v[248:251], a[56:59], v[76:79], v[248:251]
v_cvt_pk_bf16_f32 v211, v214, v215
buffer_store_dwordx4 v[208:211], v3, s[88:91], s8 offen sc1
v_mfma_f32_16x16x32_bf16 v[252:255], a[60:63], v[76:79], v[252:255]
s_add_u32 s8, s30, 0x6000
v_mul_f32 v216, v6, v216
v_mfma_f32_16x16x32_bf16 a[228:231], a[236:239], v[76:79], a[228:231]
v_mul_f32 v217, v6, v217
v_mul_f32 v218, v6, v218
v_mul_f32 v219, v6, v219
v_mul_f32 v220, v6, v220
v_mul_f32 v221, v6, v221
v_mul_f32 v222, v6, v222
v_mul_f32 v223, v6, v223
v_cvt_pk_bf16_f32 v216, v216, v217
v_cvt_pk_bf16_f32 v217, v218, v219
v_cvt_pk_bf16_f32 v218, v220, v221
v_cvt_pk_bf16_f32 v219, v222, v223
buffer_store_dwordx4 v[216:219], v3, s[88:91], s8 offen sc1
s_branch L_att_fin
L_att_sh0_1:
v_mfma_f32_16x16x32_bf16 v[192:195], a[32:35], v[56:59], v[192:195]
ds_read_b128 a[0:3], v1 offset:8192
v_cvt_pk_bf16_f32 v72, v24, v25
v_mfma_f32_16x16x32_bf16 v[224:227], a[32:35], v[60:63], v[224:227]
ds_read_b128 a[4:7], v1 offset:9216
v_cvt_pk_bf16_f32 v73, v26, v27
v_mfma_f32_16x16x32_bf16 v[228:231], a[36:39], v[60:63], v[228:231]
v_exp_f32 v30, v30
v_mfma_f32_16x16x32_bf16 v[196:199], a[36:39], v[56:59], v[196:199]
buffer_load_dword v14, v15, s[84:87], 0 offen offset:192 sc1
v_mfma_f32_16x16x32_bf16 v[200:203], a[40:43], v[56:59], v[200:203]
ds_read_b128 a[8:11], v1 offset:10240
v_cvt_pk_bf16_f32 v76, v28, v29
v_mfma_f32_16x16x32_bf16 v[232:235], a[40:43], v[60:63], v[232:235]
ds_read_b128 a[12:15], v1 offset:11264
v_mfma_f32_16x16x32_bf16 v[236:239], a[44:47], v[60:63], v[236:239]
s_add_u32 m0, s17, 0x10000
v_exp_f32 v31, v31
v_mfma_f32_16x16x32_bf16 v[204:207], a[44:47], v[56:59], v[204:207]
ds_read_b128 a[16:19], v1 offset:12288
v_cvt_pk_bf16_f32 v77, v30, v31
v_mfma_f32_16x16x32_bf16 v[208:211], a[48:51], v[56:59], v[208:211]
ds_read_b128 a[20:23], v1 offset:13312
v_mfma_f32_16x16x32_bf16 v[240:243], a[48:51], v[60:63], v[240:243]
buffer_load_dwordx4 v12, s[72:75], 0 offen lds
v_mfma_f32_16x16x32_bf16 v[244:247], a[52:55], v[60:63], v[244:247]
ds_read_b128 a[24:27], v1 offset:14336
v_exp_f32 v40, v40
v_mfma_f32_16x16x32_bf16 v[212:215], a[52:55], v[56:59], v[212:215]
v_exp_f32 v41, v41
v_mfma_f32_16x16x32_bf16 v[216:219], a[56:59], v[56:59], v[216:219]
ds_read_b128 a[28:31], v1 offset:15360
v_exp_f32 v42, v42
v_mfma_f32_16x16x32_bf16 v[248:251], a[56:59], v[60:63], v[248:251]
v_exp_f32 v43, v43
v_mfma_f32_16x16x32_bf16 v[252:255], a[60:63], v[60:63], v[252:255]
ds_read_b128 a[32:35], v1 offset:0
v_cvt_pk_bf16_f32 v74, v40, v41
v_mfma_f32_16x16x32_bf16 v[220:223], a[60:63], v[56:59], v[220:223]
buffer_load_dwordx4 v13, s[72:75], 0 offen offset:1024 lds
v_smfmac_f32_16x16x64_bf16 a[228:231], a[232:235], v[56:63], v9
ds_read_b128 a[36:39], v1 offset:1024
s_waitcnt lgkmcnt(6)
v_mfma_f32_16x16x32_bf16 v[24:27], a[0:3], a[192:195], v[88:91]
ds_read_b128 a[40:43], v1 offset:2048
v_exp_f32 v44, v44
v_mfma_f32_16x16x32_bf16 v[24:27], a[4:7], a[196:199], v[24:27]
v_exp_f32 v45, v45
v_mfma_f32_16x16x32_bf16 v[24:27], a[8:11], a[200:203], v[24:27]
ds_read_b128 a[44:47], v1 offset:3072
v_exp_f32 v46, v46
v_mfma_f32_16x16x32_bf16 v[24:27], a[12:15], a[204:207], v[24:27]
v_exp_f32 v47, v47
v_mfma_f32_16x16x32_bf16 v[28:31], a[0:3], a[208:211], v[92:95]
buffer_load_dwordx4 v12, s[72:75], s12 offen offset:2048 lds
v_mfma_f32_16x16x32_bf16 v[28:31], a[4:7], a[212:215], v[28:31]
ds_read_b128 a[48:51], v1 offset:4096
v_cvt_pk_bf16_f32 v75, v42, v43
v_mfma_f32_16x16x32_bf16 v[28:31], a[8:11], a[216:219], v[28:31]
ds_read_b128 a[52:55], v1 offset:5120
v_cvt_pk_bf16_f32 v78, v44, v45
v_mfma_f32_16x16x32_bf16 v[28:31], a[12:15], a[220:223], v[28:31]
ds_read_b128 a[56:59], v1 offset:6144
s_waitcnt lgkmcnt(7)
v_mfma_f32_16x16x32_bf16 v[40:43], a[16:19], a[192:195], v[88:91]
v_exp_f32 v24, v24
v_mfma_f32_16x16x32_bf16 v[40:43], a[20:23], a[196:199], v[40:43]
ds_read_b128 a[60:63], v1 offset:7168
v_cvt_pk_bf16_f32 v79, v46, v47
v_mfma_f32_16x16x32_bf16 v[40:43], a[24:27], a[200:203], v[40:43]
buffer_load_dwordx4 v13, s[72:75], s12 offen offset:3072 lds
v_mfma_f32_16x16x32_bf16 v[40:43], a[28:31], a[204:207], v[40:43]
v_exp_f32 v25, v25
v_mfma_f32_16x16x32_bf16 v[44:47], a[16:19], a[208:211], v[92:95]
v_exp_f32 v26, v26
v_mfma_f32_16x16x32_bf16 v[44:47], a[20:23], a[212:215], v[44:47]
v_exp_f32 v27, v27
v_mfma_f32_16x16x32_bf16 v[44:47], a[24:27], a[216:219], v[44:47]
v_exp_f32 v28, v28
v_mfma_f32_16x16x32_bf16 v[44:47], a[28:31], a[220:223], v[44:47]
s_waitcnt lgkmcnt(0)
v_exp_f32 v29, v29
v_mfma_f32_16x16x32_bf16 v[192:195], a[32:35], v[72:75], v[192:195]
ds_read_b128 a[0:3], v1 offset:24576
v_cvt_pk_bf16_f32 v56, v24, v25
v_mfma_f32_16x16x32_bf16 v[224:227], a[32:35], v[76:79], v[224:227]
ds_read_b128 a[4:7], v1 offset:25600
v_add_u32 v12, 0x20000, v12
v_mfma_f32_16x16x32_bf16 v[228:231], a[36:39], v[76:79], v[228:231]
s_add_u32 m0, s17, 0x14000
v_exp_f32 v30, v30
v_mfma_f32_16x16x32_bf16 v[196:199], a[36:39], v[72:75], v[196:199]
buffer_load_dwordx4 v12, s[72:75], 0 offen lds
v_mfma_f32_16x16x32_bf16 v[200:203], a[40:43], v[72:75], v[200:203]
ds_read_b128 a[8:11], v1 offset:26624
v_cvt_pk_bf16_f32 v57, v26, v27
v_mfma_f32_16x16x32_bf16 v[232:235], a[40:43], v[76:79], v[232:235]
ds_read_b128 a[12:15], v1 offset:27648
v_cvt_pk_bf16_f32 v60, v28, v29
v_mfma_f32_16x16x32_bf16 v[236:239], a[44:47], v[76:79], v[236:239]
v_exp_f32 v31, v31
v_mfma_f32_16x16x32_bf16 v[204:207], a[44:47], v[72:75], v[204:207]
ds_read_b128 a[16:19], v1 offset:28672
v_cvt_pk_bf16_f32 v61, v30, v31
v_mfma_f32_16x16x32_bf16 v[208:211], a[48:51], v[72:75], v[208:211]
v_exp_f32 v40, v40
v_mfma_f32_16x16x32_bf16 v[240:243], a[48:51], v[76:79], v[240:243]
ds_read_b128 a[20:23], v1 offset:29696
v_mfma_f32_16x16x32_bf16 v[244:247], a[52:55], v[76:79], v[244:247]
ds_read_b128 a[24:27], v1 offset:30720
v_add_u32 v13, 0x20000, v13
v_mfma_f32_16x16x32_bf16 v[212:215], a[52:55], v[72:75], v[212:215]
buffer_load_dwordx4 v13, s[72:75], 0 offen offset:1024 lds
v_mfma_f32_16x16x32_bf16 v[216:219], a[56:59], v[72:75], v[216:219]
ds_read_b128 a[28:31], v1 offset:31744
v_mfma_f32_16x16x32_bf16 v[248:251], a[56:59], v[76:79], v[248:251]
v_exp_f32 v41, v41
v_mfma_f32_16x16x32_bf16 v[252:255], a[60:63], v[76:79], v[252:255]
ds_read_b128 a[32:35], v1 offset:16384
v_cvt_pk_bf16_f32 v58, v40, v41
v_mfma_f32_16x16x32_bf16 v[220:223], a[60:63], v[72:75], v[220:223]
s_waitcnt lgkmcnt(5)
v_exp_f32 v42, v42
v_smfmac_f32_16x16x64_bf16 a[228:231], a[232:235], v[72:79], v9
ds_read_b128 a[36:39], v1 offset:17408
v_exp_f32 v43, v43
v_mfma_f32_16x16x32_bf16 v[24:27], a[0:3], a[192:195], v[112:115]
v_exp_f32 v44, v44
v_mfma_f32_16x16x32_bf16 v[24:27], a[4:7], a[196:199], v[24:27]
buffer_load_dwordx4 v12, s[72:75], s12 offen offset:2048 lds
v_mfma_f32_16x16x32_bf16 v[24:27], a[8:11], a[200:203], v[24:27]
ds_read_b128 a[40:43], v1 offset:18432
v_cvt_pk_bf16_f32 v59, v42, v43
v_mfma_f32_16x16x32_bf16 v[24:27], a[12:15], a[204:207], v[24:27]
ds_read_b128 a[44:47], v1 offset:19456
v_exp_f32 v45, v45
v_mfma_f32_16x16x32_bf16 v[28:31], a[0:3], a[208:211], v[92:95]
ds_read_b128 a[48:51], v1 offset:20480
v_exp_f32 v46, v46
v_mfma_f32_16x16x32_bf16 v[28:31], a[4:7], a[212:215], v[28:31]
v_exp_f32 v47, v47
v_mfma_f32_16x16x32_bf16 v[28:31], a[8:11], a[216:219], v[28:31]
ds_read_b128 a[52:55], v1 offset:21504
v_cvt_pk_bf16_f32 v62, v44, v45
v_mfma_f32_16x16x32_bf16 v[28:31], a[12:15], a[220:223], v[28:31]
s_waitcnt lgkmcnt(6)
v_exp_f32 v24, v24
v_mfma_f32_16x16x32_bf16 v[40:43], a[16:19], a[192:195], v[116:119]
ds_read_b128 a[56:59], v1 offset:22528
v_cvt_pk_bf16_f32 v63, v46, v47
v_mfma_f32_16x16x32_bf16 v[40:43], a[20:23], a[196:199], v[40:43]
buffer_load_dwordx4 v13, s[72:75], s12 offen offset:3072 lds
v_mfma_f32_16x16x32_bf16 v[40:43], a[24:27], a[200:203], v[40:43]
ds_read_b128 a[60:63], v1 offset:23552
v_xor_b32 v1, 0x8000, v1
v_mfma_f32_16x16x32_bf16 v[40:43], a[28:31], a[204:207], v[40:43]
v_exp_f32 v25, v25
v_mfma_f32_16x16x32_bf16 v[44:47], a[16:19], a[208:211], v[92:95]
v_exp_f32 v26, v26
v_mfma_f32_16x16x32_bf16 v[44:47], a[20:23], a[212:215], v[44:47]
v_exp_f32 v27, v27
v_mfma_f32_16x16x32_bf16 v[44:47], a[24:27], a[216:219], v[44:47]
v_exp_f32 v28, v28
v_mfma_f32_16x16x32_bf16 v[44:47], a[28:31], a[220:223], v[44:47]
v_exp_f32 v29, v29
L_att_h1_1:
s_waitcnt vmcnt(8) lgkmcnt(0)
s_mov_b32 s92, 200000
L_spin_b1:
v_cmp_gt_u32 vcc, 32, v14
s_nop 4
s_cbranch_vccz L_spun_b1
s_sub_u32 s92, s92, 1
s_cbranch_scc1 L_spun_b1
s_sleep 6
buffer_load_dword v14, v15, s[84:87], 0 offen offset:192 sc1
s_waitcnt vmcnt(0)
s_branch L_spin_b1
L_spun_b1:
s_barrier
v_mfma_f32_16x16x32_bf16 v[192:195], a[32:35], v[56:59], v[192:195]
ds_read_b128 a[0:3], v2 offset:8192
v_cvt_pk_bf16_f32 v72, v24, v25
v_mfma_f32_16x16x32_bf16 v[224:227], a[32:35], v[60:63], v[224:227]
ds_read_b128 a[4:7], v2 offset:9216
v_cvt_pk_bf16_f32 v73, v26, v27
v_mfma_f32_16x16x32_bf16 v[228:231], a[36:39], v[60:63], v[228:231]
s_add_u32 s101, s101, 0x2000
v_exp_f32 v30, v30
v_mfma_f32_16x16x32_bf16 v[196:199], a[36:39], v[56:59], v[196:199]
buffer_load_dwordx4 a[64:67], v3, s[88:91], s101 offen sc1
v_mfma_f32_16x16x32_bf16 v[200:203], a[40:43], v[56:59], v[200:203]
ds_read_b128 a[8:11], v2 offset:10240
v_cvt_pk_bf16_f32 v76, v28, v29
v_mfma_f32_16x16x32_bf16 v[232:235], a[40:43], v[60:63], v[232:235]
buffer_load_dwordx4 a[68:71], v3, s[88:91], s101 offen offset:1024 sc1
v_mfma_f32_16x16x32_bf16 v[236:239], a[44:47], v[60:63], v[236:239]
ds_read_b128 a[12:15], v2 offset:11264
v_exp_f32 v31, v31
v_mfma_f32_16x16x32_bf16 v[204:207], a[44:47], v[56:59], v[204:207]
buffer_load_dwordx4 a[72:75], v3, s[88:91], s101 offen offset:2048 sc1
v_mfma_f32_16x16x32_bf16 v[208:211], a[48:51], v[56:59], v[208:211]
ds_read_b128 a[16:19], v2 offset:12288
v_exp_f32 v40, v40
v_mfma_f32_16x16x32_bf16 v[240:243], a[48:51], v[60:63], v[240:243]
buffer_load_dwordx4 a[76:79], v3, s[88:91], s101 offen offset:3072 sc1
v_mfma_f32_16x16x32_bf16 v[244:247], a[52:55], v[60:63], v[244:247]
ds_read_b128 a[20:23], v2 offset:13312
v_exp_f32 v41, v41
v_mfma_f32_16x16x32_bf16 v[212:215], a[52:55], v[56:59], v[212:215]
ds_read_b128 a[24:27], v2 offset:14336
v_exp_f32 v42, v42
v_mfma_f32_16x16x32_bf16 v[216:219], a[56:59], v[56:59], v[216:219]
ds_read_b128 a[28:31], v2 offset:15360
s_add_u32 s101, s101, 0x2000
v_mfma_f32_16x16x32_bf16 v[248:251], a[56:59], v[60:63], v[248:251]
buffer_load_dwordx4 a[80:83], v3, s[88:91], s101 offen sc1
v_mfma_f32_16x16x32_bf16 v[252:255], a[60:63], v[60:63], v[252:255]
ds_read_b128 a[32:35], v2 offset:0
v_cvt_pk_bf16_f32 v77, v30, v31
v_mfma_f32_16x16x32_bf16 v[220:223], a[60:63], v[56:59], v[220:223]
ds_read_b128 a[36:39], v2 offset:1024
s_waitcnt lgkmcnt(6)
v_smfmac_f32_16x16x64_bf16 a[228:231], a[232:235], v[56:63], v9
buffer_load_dwordx4 a[84:87], v3, s[88:91], s101 offen offset:1024 sc1
v_mfma_f32_16x16x32_bf16 v[28:31], a[0:3], a[208:211], v[120:123]
ds_read_b128 a[40:43], v2 offset:2048
v_exp_f32 v43, v43
v_mfma_f32_16x16x32_bf16 v[28:31], a[4:7], a[212:215], v[28:31]
ds_read_b128 a[44:47], v2 offset:3072
v_exp_f32 v44, v44
v_mfma_f32_16x16x32_bf16 v[28:31], a[8:11], a[216:219], v[28:31]
buffer_load_dwordx4 a[88:91], v3, s[88:91], s101 offen offset:2048 sc1
v_mfma_f32_16x16x32_bf16 v[28:31], a[12:15], a[220:223], v[28:31]
ds_read_b128 a[48:51], v2 offset:4096
s_waitcnt lgkmcnt(5)
v_exp_f32 v45, v45
v_exp_f32 v46, v46
v_exp_f32 v47, v47
v_cvt_pk_bf16_f32 v78, v44, v45
v_cvt_pk_bf16_f32 v79, v46, v47
v_mfma_f32_16x16x32_bf16 v[44:47], a[16:19], a[208:211], v[124:127]
ds_read_b128 a[52:55], v2 offset:5120
v_cvt_pk_bf16_f32 v74, v40, v41
v_mfma_f32_16x16x32_bf16 v[44:47], a[20:23], a[212:215], v[44:47]
buffer_load_dwordx4 a[92:95], v3, s[88:91], s101 offen offset:3072 sc1
v_mfma_f32_16x16x32_bf16 v[44:47], a[24:27], a[216:219], v[44:47]
ds_read_b128 a[56:59], v2 offset:6144
v_cvt_pk_bf16_f32 v75, v42, v43
v_mfma_f32_16x16x32_bf16 v[44:47], a[28:31], a[220:223], v[44:47]
ds_read_b128 a[60:63], v2 offset:7168
s_waitcnt lgkmcnt(0)
v_mfma_f32_16x16x32_bf16 v[192:195], a[32:35], v[72:75], v[192:195]
s_add_u32 s101, s101, 0x2000
v_exp_f32 v28, v28
v_mfma_f32_16x16x32_bf16 v[224:227], a[32:35], v[76:79], v[224:227]
buffer_load_dwordx4 a[96:99], v3, s[88:91], s101 offen sc1
v_mfma_f32_16x16x32_bf16 v[228:231], a[36:39], v[76:79], v[228:231]
ds_read_b128 a[32:35], v2 offset:16384
v_exp_f32 v29, v29
v_mfma_f32_16x16x32_bf16 v[196:199], a[36:39], v[72:75], v[196:199]
buffer_load_dwordx4 a[100:103], v3, s[88:91], s101 offen offset:1024 sc1
v_mfma_f32_16x16x32_bf16 v[200:203], a[40:43], v[72:75], v[200:203]
ds_read_b128 a[36:39], v2 offset:17408
v_exp_f32 v30, v30
v_mfma_f32_16x16x32_bf16 v[232:235], a[40:43], v[76:79], v[232:235]
buffer_load_dwordx4 a[104:107], v3, s[88:91], s101 offen offset:2048 sc1
v_mfma_f32_16x16x32_bf16 v[236:239], a[44:47], v[76:79], v[236:239]
ds_read_b128 a[40:43], v2 offset:18432
v_cvt_pk_bf16_f32 v60, v28, v29
v_mfma_f32_16x16x32_bf16 v[204:207], a[44:47], v[72:75], v[204:207]
buffer_load_dwordx4 a[108:111], v3, s[88:91], s101 offen offset:3072 sc1
v_mfma_f32_16x16x32_bf16 v[208:211], a[48:51], v[72:75], v[208:211]
ds_read_b128 a[44:47], v2 offset:19456
s_add_u32 s101, s101, 0x2000
v_mfma_f32_16x16x32_bf16 v[240:243], a[48:51], v[76:79], v[240:243]
buffer_load_dwordx4 a[112:115], v3, s[88:91], s101 offen sc1
v_mfma_f32_16x16x32_bf16 v[244:247], a[52:55], v[76:79], v[244:247]
ds_read_b128 a[48:51], v2 offset:20480
v_exp_f32 v31, v31
v_mfma_f32_16x16x32_bf16 v[212:215], a[52:55], v[72:75], v[212:215]
buffer_load_dwordx4 a[116:119], v3, s[88:91], s101 offen offset:1024 sc1
v_mfma_f32_16x16x32_bf16 v[216:219], a[56:59], v[72:75], v[216:219]
ds_read_b128 a[52:55], v2 offset:21504
v_exp_f32 v44, v44
v_mfma_f32_16x16x32_bf16 v[248:251], a[56:59], v[76:79], v[248:251]
buffer_load_dwordx4 a[120:123], v3, s[88:91], s101 offen offset:2048 sc1
v_mfma_f32_16x16x32_bf16 v[252:255], a[60:63], v[76:79], v[252:255]
buffer_load_dwordx4 a[124:127], v3, s[88:91], s101 offen offset:3072 sc1
v_mfma_f32_16x16x32_bf16 v[220:223], a[60:63], v[72:75], v[220:223]
ds_read_b128 a[56:59], v2 offset:22528
v_cvt_pk_bf16_f32 v61, v30, v31
v_smfmac_f32_16x16x64_bf16 a[228:231], a[232:235], v[72:79], v9
ds_read_b128 a[60:63], v2 offset:23552
v_xor_b32 v2, 0x38000, v2
v_exp_f32 v45, v45
v_exp_f32 v46, v46
v_exp_f32 v47, v47
v_cvt_pk_bf16_f32 v62, v44, v45
v_cvt_pk_bf16_f32 v63, v46, v47
s_waitcnt lgkmcnt(0)
s_barrier
v_accvgpr_read_b32 v6, a228
v_accvgpr_read_b32 v7, a229
v_add_f32 v6, v6, v7
v_cmp_nge_f32 vcc, 0x6f800000, v6
v_rcp_f32 v6, v6
s_or_b64 s[34:35], s[34:35], vcc
v_mfma_f32_16x16x32_bf16 v[224:227], a[32:35], v[60:63], v[224:227]
s_add_u32 s8, s30, 0x0
v_mul_f32 v192, v6, v192
v_mfma_f32_16x16x32_bf16 v[228:231], a[36:39], v[60:63], v[228:231]
v_mul_f32 v193, v6, v193
v_mul_f32 v194, v6, v194
v_mfma_f32_16x16x32_bf16 v[232:235], a[40:43], v[60:63], v[232:235]
v_mul_f32 v195, v6, v195
v_mul_f32 v196, v6, v196
v_mfma_f32_16x16x32_bf16 v[236:239], a[44:47], v[60:63], v[236:239]
v_mul_f32 v197, v6, v197
v_mul_f32 v198, v6, v198
v_mfma_f32_16x16x32_bf16 v[240:243], a[48:51], v[60:63], v[240:243]
v_mul_f32 v199, v6, v199
v_cvt_pk_bf16_f32 v192, v192, v193
v_mfma_f32_16x16x32_bf16 v[244:247], a[52:55], v[60:63], v[244:247]
v_cvt_pk_bf16_f32 v193, v194, v195
v_cvt_pk_bf16_f32 v194, v196, v197
v_mfma_f32_16x16x32_bf16 v[248:251], a[56:59], v[60:63], v[248:251]
v_cvt_pk_bf16_f32 v195, v198, v199
buffer_store_dwordx4 v[192:195], v3, s[88:91], s8 offen sc1
v_mfma_f32_16x16x32_bf16 v[252:255], a[60:63], v[60:63], v[252:255]
v_mfma_f32_16x16x32_bf16 a[228:231], a[236:239], v[60:63], a[228:231]
s_add_u32 s8, s30, 0x2000
v_pk_mul_f32 v[200:201], v[200:201], v[6:7] op_sel_hi:[1,0]
v_pk_mul_f32 v[202:203], v[202:203], v[6:7] op_sel_hi:[1,0]
v_pk_mul_f32 v[204:205], v[204:205], v[6:7] op_sel_hi:[1,0]
v_pk_mul_f32 v[206:207], v[206:207], v[6:7] op_sel_hi:[1,0]
v_cvt_pk_bf16_f32 v200, v200, v201
v_cvt_pk_bf16_f32 v201, v202, v203
v_cvt_pk_bf16_f32 v202, v204, v205
v_cvt_pk_bf16_f32 v203, v206, v207
buffer_store_dwordx4 v[200:203], v3, s[88:91], s8 offen sc1
s_add_u32 s8, s30, 0x4000
v_pk_mul_f32 v[208:209], v[208:209], v[6:7] op_sel_hi:[1,0]
v_pk_mul_f32 v[210:211], v[210:211], v[6:7] op_sel_hi:[1,0]
v_pk_mul_f32 v[212:213], v[212:213], v[6:7] op_sel_hi:[1,0]
v_pk_mul_f32 v[214:215], v[214:215], v[6:7] op_sel_hi:[1,0]
v_cvt_pk_bf16_f32 v208, v208, v209
v_cvt_pk_bf16_f32 v209, v210, v211
v_cvt_pk_bf16_f32 v210, v212, v213
v_cvt_pk_bf16_f32 v211, v214, v215
buffer_store_dwordx4 v[208:211], v3, s[88:91], s8 offen sc1
s_add_u32 s8, s30, 0x6000
v_pk_mul_f32 v[216:217], v[216:217], v[6:7] op_sel_hi:[1,0]
v_pk_mul_f32 v[218:219], v[218:219], v[6:7] op_sel_hi:[1,0]
v_pk_mul_f32 v[220:221], v[220:221], v[6:7] op_sel_hi:[1,0]
v_pk_mul_f32 v[222:223], v[222:223], v[6:7] op_sel_hi:[1,0]
v_cvt_pk_bf16_f32 v216, v216, v217
v_cvt_pk_bf16_f32 v217, v218, v219
v_cvt_pk_bf16_f32 v218, v220, v221
v_cvt_pk_bf16_f32 v219, v222, v223
buffer_store_dwordx4 v[216:219], v3, s[88:91], s8 offen sc1
L_hopC:
s_mov_b32 s95, 1
s_bitcmp1_b32 s4, 0
s_cbranch_scc1 L_padC1
s_branch L_padC0
L_hopC_ret:
s_mov_b32 s95, 0
L_att_fin:
v_accvgpr_read_b32 v22, a230
v_accvgpr_read_b32 v23, a231
v_add_f32 v22, v22, v23
v_cmp_nge_f32 vcc, 0x6f800000, v22
v_rcp_f32 v22, v22
s_or_b64 s[34:35], s[34:35], vcc
s_cmp_lg_u64 s[34:35], 0
s_cselect_b32 s8, 1, 0
s_lshl_b32 s9, s4, 2
s_add_u32 s9, s9, 24576
v_mov_b32 v6, s9
v_mov_b32 v7, s8
ds_write_b32 v6, v7
v_lshrrev_b32 v17, 4, v0
v_lshlrev_b32 v18, 10, v17
v_and_b32 v17, 1, v17
v_lshl_add_u32 v18, v17, 5, v18
v_bfe_u32 v17, v0, 2, 2
v_lshl_add_u32 v18, v17, 6, v18
v_and_b32 v17, 3, v0
v_lshl_add_u32 v4, v17, 3, v18
v_add_u32 v4, 65536, v4
v_xor_b32 v5, 32, v4
v_add_u32 v15, 0x10000, v4
v_add_u32 v19, 0x10000, v5
s_waitcnt vmcnt(12) lgkmcnt(0)
s_barrier
ds_read_b64_tr_b16 a[0:1], v4 offset:256
ds_read_b64_tr_b16 a[2:3], v4 offset:4352
ds_read_b64_tr_b16 a[4:5], v4 offset:8448
ds_read_b64_tr_b16 a[6:7], v4 offset:12544
ds_read_b64_tr_b16 a[8:9], v5 offset:256
ds_read_b64_tr_b16 a[10:11], v5 offset:4352
ds_read_b64_tr_b16 a[12:13], v5 offset:8448
ds_read_b64_tr_b16 a[14:15], v5 offset:12544
ds_read_b64_tr_b16 a[16:17], v4 offset:512
ds_read_b64_tr_b16 a[18:19], v4 offset:4608
ds_read_b64_tr_b16 a[20:21], v4 offset:8704
ds_read_b64_tr_b16 a[22:23], v4 offset:12800
v_and_b32 v17, 3, v0
v_lshlrev_b32 v17, 2, v17
v_add_u32 v17, 24576, v17
ds_read_b32 v18, v17
s_waitcnt lgkmcnt(0)
v_cmp_ne_u32 vcc, 0, v18
s_cmp_lg_u32 s33, 0
s_cbranch_scc1 L_att_done
s_nop 4
s_cbranch_vccnz L_att_fallback
L_att_done:
s_bitcmp0_b32 s2, 0
s_cbranch_scc1 L_p4_a
v_mfma_f32_16x16x32_bf16 v[56:59], a[0:3], a[64:67], 0
ds_read_b64_tr_b16 a[24:25], v5 offset:512
s_add_u32 s8, s31, 0x0
v_and_b32 v6, 15, v0
v_mfma_f32_16x16x32_bf16 v[56:59], a[4:7], a[80:83], v[56:59]
ds_read_b64_tr_b16 a[26:27], v5 offset:4608
s_add_u32 s101, s101, 0x2000
v_mul_f32 v224, v22, v224
v_mfma_f32_16x16x32_bf16 v[64:67], a[4:7], a[84:87], 0
ds_read_b64_tr_b16 a[28:29], v5 offset:8704
v_lshlrev_b32 v6, 2, v6
v_mul_f32 v225, v22, v225
v_mfma_f32_16x16x32_bf16 v[64:67], a[0:3], a[68:71], v[64:67]
ds_read_b64_tr_b16 a[30:31], v5 offset:12800
v_and_b32 v1, 28, v6
v_mul_f32 v226, v22, v226
v_mfma_f32_16x16x32_bf16 v[72:75], a[0:3], a[72:75], 0
v_or_b32 v7, 16, v1
v_mul_f32 v227, v22, v227
v_mul_f32 v228, v22, v228
v_mfma_f32_16x16x32_bf16 v[72:75], a[4:7], a[88:91], v[72:75]
buffer_load_dwordx4 a[160:163], v3, s[88:91], s101 offen sc1
v_mul_f32 v229, v22, v229
v_mfma_f32_16x16x32_bf16 v[80:83], a[4:7], a[92:95], 0
v_mul_f32 v230, v22, v230
v_mul_f32 v231, v22, v231
v_cvt_pk_bf16_f32 v224, v224, v225
v_mfma_f32_16x16x32_bf16 v[80:83], a[0:3], a[76:79], v[80:83]
v_cvt_pk_bf16_f32 v225, v226, v227
v_cvt_pk_bf16_f32 v226, v228, v229
v_cvt_pk_bf16_f32 v227, v230, v231
v_mfma_f32_16x16x32_bf16 v[84:87], a[8:11], a[76:79], 0
ds_read_b64_tr_b16 a[0:1], v4 offset:768
v_mfma_f32_16x16x32_bf16 v[84:87], a[12:15], a[92:95], v[84:87]
ds_read_b64_tr_b16 a[2:3], v4 offset:4864
v_mfma_f32_16x16x32_bf16 v[76:79], a[12:15], a[88:91], 0
buffer_load_dwordx4 a[164:167], v3, s[88:91], s101 offen offset:1024 sc1
v_mfma_f32_16x16x32_bf16 v[76:79], a[8:11], a[72:75], v[76:79]
ds_read_b64_tr_b16 a[4:5], v4 offset:8960
v_mfma_f32_16x16x32_bf16 v[68:71], a[8:11], a[68:71], 0
buffer_load_dword v14, v7, s[88:91], s24 offen sc1
v_mfma_f32_16x16x32_bf16 v[68:71], a[12:15], a[84:87], v[68:71]
ds_read_b64_tr_b16 a[6:7], v4 offset:13056
v_mfma_f32_16x16x32_bf16 v[60:63], a[12:15], a[80:83], 0
buffer_store_dwordx4 v[224:227], v3, s[88:91], s8 offen sc1
s_waitcnt lgkmcnt(4)
v_mfma_f32_16x16x32_bf16 v[60:63], a[8:11], a[64:67], v[60:63]
buffer_load_dwordx4 a[168:171], v3, s[88:91], s101 offen offset:2048 sc1
s_add_u32 s8, s31, 0x2000
v_mfma_f32_16x16x32_bf16 v[88:91], a[16:19], a[64:67], 0
ds_read_b64_tr_b16 a[8:9], v5 offset:768
v_mul_f32 v232, v22, v232
v_mul_f32 v233, v22, v233
v_mfma_f32_16x16x32_bf16 v[88:91], a[20:23], a[80:83], v[88:91]
ds_read_b64_tr_b16 a[10:11], v5 offset:4864
v_mul_f32 v234, v22, v234
v_mul_f32 v235, v22, v235
v_mfma_f32_16x16x32_bf16 v[96:99], a[20:23], a[84:87], 0
ds_read_b64_tr_b16 a[12:13], v5 offset:8960
v_mul_f32 v236, v22, v236
v_mul_f32 v237, v22, v237
v_mfma_f32_16x16x32_bf16 v[96:99], a[16:19], a[68:71], v[96:99]
ds_read_b64_tr_b16 a[14:15], v5 offset:13056
v_mul_f32 v238, v22, v238
v_mul_f32 v239, v22, v239
v_mfma_f32_16x16x32_bf16 v[104:107], a[16:19], a[72:75], 0
buffer_load_dwordx4 a[172:175], v3, s[88:91], s101 offen offset:3072 sc1
v_cvt_pk_bf16_f32 v232, v232, v233
v_mfma_f32_16x16x32_bf16 v[104:107], a[20:23], a[88:91], v[104:107]
s_add_u32 s101, s101, 0x2000
v_cvt_pk_bf16_f32 v233, v234, v235
v_cvt_pk_bf16_f32 v234, v236, v237
v_cvt_pk_bf16_f32 v235, v238, v239
v_mfma_f32_16x16x32_bf16 v[112:115], a[20:23], a[92:95], 0
buffer_store_dwordx4 v[232:235], v3, s[88:91], s8 offen sc1
s_add_u32 s8, s31, 0x4000
v_mfma_f32_16x16x32_bf16 v[112:115], a[16:19], a[76:79], v[112:115]
v_mul_f32 v240, v22, v240
v_mul_f32 v241, v22, v241
v_mul_f32 v242, v22, v242
v_mfma_f32_16x16x32_bf16 v[116:119], a[24:27], a[76:79], 0
ds_read_b64_tr_b16 a[16:17], v4 offset:0
v_mul_f32 v243, v22, v243
v_mul_f32 v244, v22, v244
v_mfma_f32_16x16x32_bf16 v[116:119], a[28:31], a[92:95], v[116:119]
buffer_load_dwordx4 a[176:179], v3, s[88:91], s101 offen sc1
v_mul_f32 v245, v22, v245
v_mfma_f32_16x16x32_bf16 v[108:111], a[28:31], a[88:91], 0
ds_read_b64_tr_b16 a[18:19], v4 offset:4096
v_mul_f32 v246, v22, v246
v_mul_f32 v247, v22, v247
v_mfma_f32_16x16x32_bf16 v[108:111], a[24:27], a[72:75], v[108:111]
ds_read_b64_tr_b16 a[20:21], v4 offset:8192
v_cvt_pk_bf16_f32 v240, v240, v241
v_cvt_pk_bf16_f32 v241, v242, v243
v_mfma_f32_16x16x32_bf16 v[100:103], a[24:27], a[68:71], 0
ds_read_b64_tr_b16 a[22:23], v4 offset:12288
v_cvt_pk_bf16_f32 v242, v244, v245
v_cvt_pk_bf16_f32 v243, v246, v247
v_mfma_f32_16x16x32_bf16 v[100:103], a[28:31], a[84:87], v[100:103]
buffer_store_dwordx4 v[240:243], v3, s[88:91], s8 offen sc1
s_add_u32 s8, s31, 0x6000
v_mfma_f32_16x16x32_bf16 v[92:95], a[28:31], a[80:83], 0
buffer_load_dwordx4 a[180:183], v3, s[88:91], s101 offen offset:1024 sc1
v_mul_f32 v248, v22, v248
v_mfma_f32_16x16x32_bf16 v[92:95], a[24:27], a[64:67], v[92:95]
s_waitcnt lgkmcnt(4)
v_mul_f32 v249, v22, v249
v_mul_f32 v250, v22, v250
v_mul_f32 v251, v22, v251
v_mfma_f32_16x16x32_bf16 v[120:123], a[0:3], a[64:67], 0
ds_read_b64_tr_b16 a[24:25], v5 offset:0
v_mul_f32 v252, v22, v252
v_mul_f32 v253, v22, v253
v_mfma_f32_16x16x32_bf16 v[120:123], a[4:7], a[80:83], v[120:123]
ds_read_b64_tr_b16 a[26:27], v5 offset:4096
v_mul_f32 v254, v22, v254
v_mul_f32 v255, v22, v255
v_mfma_f32_16x16x32_bf16 v[128:131], a[4:7], a[84:87], 0
ds_read_b64_tr_b16 a[28:29], v5 offset:8192
v_cvt_pk_bf16_f32 v248, v248, v249
v_cvt_pk_bf16_f32 v249, v250, v251
v_mfma_f32_16x16x32_bf16 v[128:131], a[0:3], a[68:71], v[128:131]
buffer_load_dwordx4 a[184:187], v3, s[88:91], s101 offen offset:2048 sc1
v_cvt_pk_bf16_f32 v250, v252, v253
v_mfma_f32_16x16x32_bf16 v[136:139], a[0:3], a[72:75], 0
ds_read_b64_tr_b16 a[30:31], v5 offset:12288
v_cvt_pk_bf16_f32 v251, v254, v255
v_mfma_f32_16x16x32_bf16 v[136:139], a[4:7], a[88:91], v[136:139]
buffer_store_dwordx4 v[248:251], v3, s[88:91], s8 offen sc1
v_mfma_f32_16x16x32_bf16 v[144:147], a[4:7], a[92:95], 0
s_waitcnt vmcnt(16)
v_mfma_f32_16x16x32_bf16 v[144:147], a[0:3], a[76:79], v[144:147]
s_barrier
v_mfma_f32_16x16x32_bf16 v[148:151], a[8:11], a[76:79], 0
buffer_load_dwordx4 a[188:191], v3, s[88:91], s101 offen offset:3072 sc1
v_mfma_f32_16x16x32_bf16 v[148:151], a[12:15], a[92:95], v[148:151]
ds_read_b64_tr_b16 a[0:1], v4 offset:16640
s_add_u32 m0, s17, 0x1c000
v_mfma_f32_16x16x32_bf16 v[140:143], a[12:15], a[88:91], 0
ds_read_b64_tr_b16 a[2:3], v4 offset:20736
v_add_u32 v12, 0x20000, v12
v_mfma_f32_16x16x32_bf16 v[140:143], a[8:11], a[72:75], v[140:143]
ds_read_b64_tr_b16 a[4:5], v4 offset:24832
v_mfma_f32_16x16x32_bf16 v[132:135], a[8:11], a[68:71], 0
ds_read_b64_tr_b16 a[6:7], v4 offset:28928
v_mfma_f32_16x16x32_bf16 v[132:135], a[12:15], a[84:87], v[132:135]
buffer_load_dwordx4 v12, s[72:75], 0 offen lds
v_mfma_f32_16x16x32_bf16 v[124:127], a[12:15], a[80:83], 0
v_add_u32 v13, 0x20000, v13
v_mfma_f32_16x16x32_bf16 v[124:127], a[8:11], a[64:67], v[124:127]
s_waitcnt lgkmcnt(4)
v_mfma_f32_16x16x32_bf16 v[24:27], a[16:19], a[64:67], 0
ds_read_b64_tr_b16 a[8:9], v5 offset:16640
v_mfma_f32_16x16x32_bf16 v[24:27], a[20:23], a[80:83], v[24:27]
ds_read_b64_tr_b16 a[10:11], v5 offset:20736
v_mfma_f32_16x16x32_bf16 v[32:35], a[20:23], a[84:87], 0
buffer_load_dwordx4 v13, s[72:75], 0 offen offset:1024 lds
v_mfma_f32_16x16x32_bf16 v[32:35], a[16:19], a[68:71], v[32:35]
ds_read_b64_tr_b16 a[12:13], v5 offset:24832
v_mfma_f32_16x16x32_bf16 v[40:43], a[16:19], a[72:75], 0
ds_read_b64_tr_b16 a[14:15], v5 offset:28928
v_mfma_f32_16x16x32_bf16 v[40:43], a[20:23], a[88:91], v[40:43]
v_mfma_f32_16x16x32_bf16 v[48:51], a[20:23], a[92:95], 0
v_mfma_f32_16x16x32_bf16 v[48:51], a[16:19], a[76:79], v[48:51]
buffer_load_dwordx4 v12, s[72:75], s12 offen offset:2048 lds
v_mfma_f32_16x16x32_bf16 v[52:55], a[24:27], a[76:79], 0
ds_read_b64_tr_b16 a[16:17], v4 offset:16896
v_mfma_f32_16x16x32_bf16 v[52:55], a[28:31], a[92:95], v[52:55]
ds_read_b64_tr_b16 a[18:19], v4 offset:20992
v_mfma_f32_16x16x32_bf16 v[44:47], a[28:31], a[88:91], 0
ds_read_b64_tr_b16 a[20:21], v4 offset:25088
v_mfma_f32_16x16x32_bf16 v[44:47], a[24:27], a[72:75], v[44:47]
ds_read_b64_tr_b16 a[22:23], v4 offset:29184
v_mfma_f32_16x16x32_bf16 v[36:39], a[24:27], a[68:71], 0
v_mfma_f32_16x16x32_bf16 v[36:39], a[28:31], a[84:87], v[36:39]
buffer_load_dwordx4 v13, s[72:75], s12 offen offset:3072 lds
v_mfma_f32_16x16x32_bf16 v[28:31], a[28:31], a[80:83], 0
s_add_u32 s63, s101, s26
s_add_u32 s101, s63, s60
v_mfma_f32_16x16x32_bf16 v[28:31], a[24:27], a[64:67], v[28:31]
s_waitcnt lgkmcnt(4)
v_mfma_f32_16x16x32_bf16 v[56:59], a[0:3], a[96:99], v[56:59]
ds_read_b64_tr_b16 a[24:25], v5 offset:16896
v_mfma_f32_16x16x32_bf16 v[56:59], a[4:7], a[112:115], v[56:59]
ds_read_b64_tr_b16 a[26:27], v5 offset:20992
s_waitcnt vmcnt(14)
s_mov_b32 s92, 200000
L_spin_cb:
v_cmp_eq_u32 vcc, 0, v14
s_nop 4
s_cbranch_vccz L_spun_cb
s_sub_u32 s92, s92, 1
s_cbranch_scc1 L_spun_cb
s_sleep 6
buffer_load_dword v14, v7, s[88:91], s24 offen sc1
s_waitcnt vmcnt(0)
s_branch L_spin_cb
L_spun_cb:
v_mfma_f32_16x16x32_bf16 v[64:67], a[4:7], a[116:119], v[64:67]
buffer_load_dwordx4 a[192:195], v3, s[88:91], s101 offen sc1
v_mfma_f32_16x16x32_bf16 v[64:67], a[0:3], a[100:103], v[64:67]
ds_read_b64_tr_b16 a[28:29], v5 offset:25088
v_mfma_f32_16x16x32_bf16 v[72:75], a[0:3], a[104:107], v[72:75]
ds_read_b64_tr_b16 a[30:31], v5 offset:29184
v_mfma_f32_16x16x32_bf16 v[72:75], a[4:7], a[120:123], v[72:75]
v_mfma_f32_16x16x32_bf16 v[80:83], a[4:7], a[124:127], v[80:83]
v_mfma_f32_16x16x32_bf16 v[80:83], a[0:3], a[108:111], v[80:83]
buffer_load_dwordx4 a[196:199], v3, s[88:91], s101 offen offset:1024 sc1
v_mfma_f32_16x16x32_bf16 v[84:87], a[8:11], a[108:111], v[84:87]
ds_read_b64_tr_b16 a[0:1], v4 offset:17152
v_mfma_f32_16x16x32_bf16 v[84:87], a[12:15], a[124:127], v[84:87]
ds_read_b64_tr_b16 a[2:3], v4 offset:21248
v_mfma_f32_16x16x32_bf16 v[76:79], a[12:15], a[120:123], v[76:79]
ds_read_b64_tr_b16 a[4:5], v4 offset:25344
v_mfma_f32_16x16x32_bf16 v[76:79], a[8:11], a[104:107], v[76:79]
ds_read_b64_tr_b16 a[6:7], v4 offset:29440
v_mfma_f32_16x16x32_bf16 v[68:71], a[8:11], a[100:103], v[68:71]
buffer_load_dwordx4 a[200:203], v3, s[88:91], s101 offen offset:2048 sc1
v_mfma_f32_16x16x32_bf16 v[68:71], a[12:15], a[116:119], v[68:71]
v_mfma_f32_16x16x32_bf16 v[60:63], a[12:15], a[112:115], v[60:63]
v_mfma_f32_16x16x32_bf16 v[60:63], a[8:11], a[96:99], v[60:63]
s_waitcnt lgkmcnt(4)
v_mfma_f32_16x16x32_bf16 v[88:91], a[16:19], a[96:99], v[88:91]
ds_read_b64_tr_b16 a[8:9], v5 offset:17152
v_mfma_f32_16x16x32_bf16 v[88:91], a[20:23], a[112:115], v[88:91]
buffer_load_dwordx4 a[204:207], v3, s[88:91], s101 offen offset:3072 sc1
v_mfma_f32_16x16x32_bf16 v[96:99], a[20:23], a[116:119], v[96:99]
ds_read_b64_tr_b16 a[10:11], v5 offset:21248
s_add_u32 s101, s101, 0x2000
v_mfma_f32_16x16x32_bf16 v[96:99], a[16:19], a[100:103], v[96:99]
ds_read_b64_tr_b16 a[12:13], v5 offset:25344
v_mfma_f32_16x16x32_bf16 v[104:107], a[16:19], a[104:107], v[104:107]
ds_read_b64_tr_b16 a[14:15], v5 offset:29440
v_mfma_f32_16x16x32_bf16 v[104:107], a[20:23], a[120:123], v[104:107]
v_mfma_f32_16x16x32_bf16 v[112:115], a[20:23], a[124:127], v[112:115]
buffer_load_dwordx4 a[208:211], v3, s[88:91], s101 offen sc1
v_mfma_f32_16x16x32_bf16 v[112:115], a[16:19], a[108:111], v[112:115]
v_mfma_f32_16x16x32_bf16 v[116:119], a[24:27], a[108:111], v[116:119]
ds_read_b64_tr_b16 a[16:17], v4 offset:16384
v_mfma_f32_16x16x32_bf16 v[116:119], a[28:31], a[124:127], v[116:119]
ds_read_b64_tr_b16 a[18:19], v4 offset:20480
v_mfma_f32_16x16x32_bf16 v[108:111], a[28:31], a[120:123], v[108:111]
ds_read_b64_tr_b16 a[20:21], v4 offset:24576
v_mfma_f32_16x16x32_bf16 v[108:111], a[24:27], a[104:107], v[108:111]
buffer_load_dwordx4 a[212:215], v3, s[88:91], s101 offen offset:1024 sc1
v_mfma_f32_16x16x32_bf16 v[100:103], a[24:27], a[100:103], v[100:103]
ds_read_b64_tr_b16 a[22:23], v4 offset:28672
v_mfma_f32_16x16x32_bf16 v[100:103], a[28:31], a[116:119], v[100:103]
v_mfma_f32_16x16x32_bf16 v[92:95], a[28:31], a[112:115], v[92:95]
v_mfma_f32_16x16x32_bf16 v[92:95], a[24:27], a[96:99], v[92:95]
s_waitcnt lgkmcnt(4)
v_mfma_f32_16x16x32_bf16 v[120:123], a[0:3], a[96:99], v[120:123]
buffer_load_dwordx4 a[216:219], v3, s[88:91], s101 offen offset:2048 sc1
v_mfma_f32_16x16x32_bf16 v[120:123], a[4:7], a[112:115], v[120:123]
ds_read_b64_tr_b16 a[24:25], v5 offset:16384
v_mfma_f32_16x16x32_bf16 v[128:131], a[4:7], a[116:119], v[128:131]
ds_read_b64_tr_b16 a[26:27], v5 offset:20480
v_mfma_f32_16x16x32_bf16 v[128:131], a[0:3], a[100:103], v[128:131]
ds_read_b64_tr_b16 a[28:29], v5 offset:24576
v_mfma_f32_16x16x32_bf16 v[136:139], a[0:3], a[104:107], v[136:139]
ds_read_b64_tr_b16 a[30:31], v5 offset:28672
v_mfma_f32_16x16x32_bf16 v[136:139], a[4:7], a[120:123], v[136:139]
buffer_load_dwordx4 a[220:223], v3, s[88:91], s101 offen offset:3072 sc1
v_mfma_f32_16x16x32_bf16 v[144:147], a[4:7], a[124:127], v[144:147]
s_waitcnt vmcnt(8)
s_add_u32 m0, s17, 0x20000
s_lshl_b32 s61, s60, 3
v_mfma_f32_16x16x32_bf16 v[144:147], a[0:3], a[108:111], v[144:147]
s_barrier
s_add_u32 s62, s61, s12
v_add_u32 v12, s25, v12
v_mfma_f32_16x16x32_bf16 v[148:151], a[8:11], a[108:111], v[148:151]
ds_read_b64_tr_b16 a[0:1], v4 offset:49408
v_mfma_f32_16x16x32_bf16 v[148:151], a[12:15], a[124:127], v[148:151]
ds_read_b64_tr_b16 a[2:3], v4 offset:53504
v_mfma_f32_16x16x32_bf16 v[140:143], a[12:15], a[120:123], v[140:143]
buffer_load_dwordx4 v12, s[64:67], s61 offen lds
v_mfma_f32_16x16x32_bf16 v[140:143], a[8:11], a[104:107], v[140:143]
ds_read_b64_tr_b16 a[4:5], v4 offset:57600
v_add_u32 v13, s25, v13
v_mfma_f32_16x16x32_bf16 v[132:135], a[8:11], a[100:103], v[132:135]
ds_read_b64_tr_b16 a[6:7], v4 offset:61696
v_mfma_f32_16x16x32_bf16 v[132:135], a[12:15], a[116:119], v[132:135]
v_mfma_f32_16x16x32_bf16 v[124:127], a[12:15], a[112:115], v[124:127]
s_waitcnt lgkmcnt(4)
v_mfma_f32_16x16x32_bf16 v[124:127], a[8:11], a[96:99], v[124:127]
buffer_load_dwordx4 v13, s[64:67], s61 offen offset:1024 lds
v_mfma_f32_16x16x32_bf16 v[24:27], a[16:19], a[96:99], v[24:27]
ds_read_b64_tr_b16 a[8:9], v5 offset:49408
v_mfma_f32_16x16x32_bf16 v[24:27], a[20:23], a[112:115], v[24:27]
ds_read_b64_tr_b16 a[10:11], v5 offset:53504
v_mfma_f32_16x16x32_bf16 v[32:35], a[20:23], a[116:119], v[32:35]
ds_read_b64_tr_b16 a[12:13], v5 offset:57600
v_mfma_f32_16x16x32_bf16 v[32:35], a[16:19], a[100:103], v[32:35]
ds_read_b64_tr_b16 a[14:15], v5 offset:61696
v_mfma_f32_16x16x32_bf16 v[40:43], a[16:19], a[104:107], v[40:43]
buffer_load_dwordx4 v12, s[64:67], s62 offen offset:2048 lds
v_mfma_f32_16x16x32_bf16 v[40:43], a[20:23], a[120:123], v[40:43]
v_mfma_f32_16x16x32_bf16 v[48:51], a[20:23], a[124:127], v[48:51]
v_mfma_f32_16x16x32_bf16 v[48:51], a[16:19], a[108:111], v[48:51]
v_mfma_f32_16x16x32_bf16 v[52:55], a[24:27], a[108:111], v[52:55]
ds_read_b64_tr_b16 a[16:17], v4 offset:49664
v_mfma_f32_16x16x32_bf16 v[52:55], a[28:31], a[124:127], v[52:55]
ds_read_b64_tr_b16 a[18:19], v4 offset:53760
v_mfma_f32_16x16x32_bf16 v[44:47], a[28:31], a[120:123], v[44:47]
buffer_load_dwordx4 v13, s[64:67], s62 offen offset:3072 lds
v_mfma_f32_16x16x32_bf16 v[44:47], a[24:27], a[104:107], v[44:47]
ds_read_b64_tr_b16 a[20:21], v4 offset:57856
v_mfma_f32_16x16x32_bf16 v[36:39], a[24:27], a[100:103], v[36:39]
ds_read_b64_tr_b16 a[22:23], v4 offset:61952
v_mfma_f32_16x16x32_bf16 v[36:39], a[28:31], a[116:119], v[36:39]
v_mfma_f32_16x16x32_bf16 v[28:31], a[28:31], a[112:115], v[28:31]
s_waitcnt vmcnt(17)
v_mfma_f32_16x16x32_bf16 v[28:31], a[24:27], a[96:99], v[28:31]
s_barrier
s_waitcnt lgkmcnt(4)
s_cmp_lg_u32 s4, 0
s_cbranch_scc1 L_flag_setb
s_lshl_b32 s8, s6, 5
s_add_u32 s8, s8, s5
s_and_b32 s92, s8, 0xf8
s_mul_i32 s92, s92, 7
s_add_u32 s8, s8, s92
s_lshl_b32 s8, s8, 2
s_add_u32 s8, s8, 0x3704000
v_mov_b32 v17, 1
s_mov_b64 exec, 1
buffer_store_dword v17, off, s[88:91], s8 sc1
s_mov_b64 exec, -1
L_flag_setb:
L_p4_join:
v_mfma_f32_16x16x32_bf16 v[56:59], a[0:3], a[160:163], v[56:59]
ds_read_b64_tr_b16 a[24:25], v5 offset:49664
s_add_u32 s60, s60, s57
v_mfma_f32_16x16x32_bf16 v[56:59], a[4:7], a[176:179], v[56:59]
ds_read_b64_tr_b16 a[26:27], v5 offset:53760
s_and_b32 s60, s60, 0x1c000
v_mfma_f32_16x16x32_bf16 v[64:67], a[4:7], a[180:183], v[64:67]
ds_read_b64_tr_b16 a[28:29], v5 offset:57856
s_or_b32 s60, s60, 0x20000
v_mfma_f32_16x16x32_bf16 v[64:67], a[0:3], a[164:167], v[64:67]
ds_read_b64_tr_b16 a[30:31], v5 offset:61952
s_add_u32 s101, s63, s60
v_mfma_f32_16x16x32_bf16 v[72:75], a[0:3], a[168:171], v[72:75]
buffer_load_dwordx4 a[224:227], v3, s[88:91], s101 offen sc1
v_mfma_f32_16x16x32_bf16 v[72:75], a[4:7], a[184:187], v[72:75]
s_lshl_b32 s28, s99, 1
s_and_b32 s9, s4, 1
s_add_u32 s28, s28, s9
v_mfma_f32_16x16x32_bf16 v[80:83], a[4:7], a[188:191], v[80:83]
s_lshl_b32 s9, s28, 8
s_add_u32 s9, s9, 0x3700000
s_lshl_b32 s28, s28, 17
v_mfma_f32_16x16x32_bf16 v[80:83], a[0:3], a[172:175], v[80:83]
s_lshl_b32 s10, s100, 8
s_add_u32 s28, s28, s10
s_lshl_b32 s10, s14, 6
v_mfma_f32_16x16x32_bf16 v[84:87], a[8:11], a[172:175], v[84:87]
ds_read_b64_tr_b16 a[0:1], v4 offset:49920
s_add_u32 s28, s28, s10
v_mfma_f32_16x16x32_bf16 v[84:87], a[12:15], a[188:191], v[84:87]
buffer_load_dwordx4 a[228:231], v3, s[88:91], s101 offen offset:1024 sc1
v_mfma_f32_16x16x32_bf16 v[76:79], a[12:15], a[184:187], v[76:79]
ds_read_b64_tr_b16 a[2:3], v4 offset:54016
s_add_u32 s29, s28, 0x8000
v_mfma_f32_16x16x32_bf16 v[76:79], a[8:11], a[168:171], v[76:79]
ds_read_b64_tr_b16 a[4:5], v4 offset:58112
s_add_u32 s30, s28, 0x10000
v_mfma_f32_16x16x32_bf16 v[68:71], a[8:11], a[164:167], v[68:71]
ds_read_b64_tr_b16 a[6:7], v4 offset:62208
s_add_u32 s31, s28, 0x18000
v_mfma_f32_16x16x32_bf16 v[68:71], a[12:15], a[180:183], v[68:71]
buffer_load_dwordx4 a[232:235], v3, s[88:91], s101 offen offset:2048 sc1
v_mfma_f32_16x16x32_bf16 v[60:63], a[12:15], a[176:179], v[60:63]
s_lshl_b32 s10, s2, 2
s_add_u32 s10, s10, s4
s_lshl_b32 s10, s10, 12
v_mfma_f32_16x16x32_bf16 v[60:63], a[8:11], a[160:163], v[60:63]
s_waitcnt lgkmcnt(4)
s_add_u32 s44, s10, 0x4800000
s_xor_b32 s52, s44, 0x4000
v_mfma_f32_16x16x32_bf16 v[88:91], a[16:19], a[160:163], v[88:91]
ds_read_b64_tr_b16 a[8:9], v5 offset:49920
s_add_u32 s45, s10, 0x4c00000
v_mfma_f32_16x16x32_bf16 v[88:91], a[20:23], a[176:179], v[88:91]
ds_read_b64_tr_b16 a[10:11], v5 offset:54016
s_xor_b32 s53, s45, 0x8000
v_mfma_f32_16x16x32_bf16 v[96:99], a[20:23], a[180:183], v[96:99]
buffer_load_dwordx4 a[236:239], v3, s[88:91], s101 offen offset:3072 sc1
v_mfma_f32_16x16x32_bf16 v[96:99], a[16:19], a[164:167], v[96:99]
ds_read_b64_tr_b16 a[12:13], v5 offset:58112
s_add_u32 s101, s101, 0x2000
v_mfma_f32_16x16x32_bf16 v[104:107], a[16:19], a[168:171], v[104:107]
ds_read_b64_tr_b16 a[14:15], v5 offset:62208
s_add_u32 s46, s10, 0x5000000
v_mfma_f32_16x16x32_bf16 v[104:107], a[20:23], a[184:187], v[104:107]
s_xor_b32 s54, s46, 0xc000
v_and_b32 v18, 16, v0
v_lshrrev_b32 v2, 5, v0
v_mfma_f32_16x16x32_bf16 v[112:115], a[20:23], a[188:191], v[112:115]
v_lshlrev_b32 v2, 4, v2
v_lshl_add_u32 v18, v18, 1, v2
v_mfma_f32_16x16x32_bf16 v[112:115], a[16:19], a[172:175], v[112:115]
buffer_load_dwordx4 a[240:243], v3, s[88:91], s101 offen sc1
v_mfma_f32_16x16x32_bf16 v[116:119], a[24:27], a[172:175], v[116:119]
ds_read_b64_tr_b16 a[16:17], v4 offset:49152
v_lshl_add_u32 v2, v6, 9, v18
v_mfma_f32_16x16x32_bf16 v[116:119], a[28:31], a[188:191], v[116:119]
ds_read_b64_tr_b16 a[18:19], v4 offset:53248
v_mfma_f32_16x16x32_bf16 v[108:111], a[28:31], a[184:187], v[108:111]
ds_read_b64_tr_b16 a[20:21], v4 offset:57344
v_mfma_f32_16x16x32_bf16 v[108:111], a[24:27], a[168:171], v[108:111]
buffer_load_dwordx4 a[244:247], v3, s[88:91], s101 offen offset:1024 sc1
v_mfma_f32_16x16x32_bf16 v[100:103], a[24:27], a[164:167], v[100:103]
ds_read_b64_tr_b16 a[22:23], v4 offset:61440
v_mfma_f32_16x16x32_bf16 v[100:103], a[28:31], a[180:183], v[100:103]
v_mfma_f32_16x16x32_bf16 v[92:95], a[28:31], a[176:179], v[92:95]
v_mfma_f32_16x16x32_bf16 v[92:95], a[24:27], a[160:163], v[92:95]
s_waitcnt lgkmcnt(4)
v_mfma_f32_16x16x32_bf16 v[120:123], a[0:3], a[160:163], v[120:123]
buffer_load_dwordx4 a[248:251], v3, s[88:91], s101 offen offset:2048 sc1
v_mfma_f32_16x16x32_bf16 v[120:123], a[4:7], a[176:179], v[120:123]
ds_read_b64_tr_b16 a[24:25], v5 offset:49152
v_mfma_f32_16x16x32_bf16 v[128:131], a[4:7], a[180:183], v[128:131]
ds_read_b64_tr_b16 a[26:27], v5 offset:53248
v_mfma_f32_16x16x32_bf16 v[128:131], a[0:3], a[164:167], v[128:131]
ds_read_b64_tr_b16 a[28:29], v5 offset:57344
v_mfma_f32_16x16x32_bf16 v[136:139], a[0:3], a[168:171], v[136:139]
buffer_load_dwordx4 a[252:255], v3, s[88:91], s101 offen offset:3072 sc1
v_mfma_f32_16x16x32_bf16 v[136:139], a[4:7], a[184:187], v[136:139]
ds_read_b64_tr_b16 a[30:31], v5 offset:61440
s_add_u32 m0, s17, 0x24000
v_mfma_f32_16x16x32_bf16 v[144:147], a[4:7], a[188:191], v[144:147]
s_waitcnt vmcnt(8)
s_lshl_b32 s61, s60, 3
s_add_u32 s62, s61, s12
v_mfma_f32_16x16x32_bf16 v[144:147], a[0:3], a[172:175], v[144:147]
s_barrier
v_mfma_f32_16x16x32_bf16 v[148:151], a[8:11], a[172:175], v[148:151]
ds_read_b64_tr_b16 a[0:1], v15 offset:256
v_mfma_f32_16x16x32_bf16 v[148:151], a[12:15], a[188:191], v[148:151]
buffer_load_dwordx4 v12, s[64:67], s61 offen lds
v_mfma_f32_16x16x32_bf16 v[140:143], a[12:15], a[184:187], v[140:143]
ds_read_b64_tr_b16 a[2:3], v15 offset:4352
v_mfma_f32_16x16x32_bf16 v[140:143], a[8:11], a[168:171], v[140:143]
ds_read_b64_tr_b16 a[4:5], v15 offset:8448
v_mfma_f32_16x16x32_bf16 v[132:135], a[8:11], a[164:167], v[132:135]
ds_read_b64_tr_b16 a[6:7], v15 offset:12544
v_mfma_f32_16x16x32_bf16 v[132:135], a[12:15], a[180:183], v[132:135]
v_mfma_f32_16x16x32_bf16 v[124:127], a[12:15], a[176:179], v[124:127]
buffer_load_dwordx4 v13, s[64:67], s61 offen offset:1024 lds
v_mfma_f32_16x16x32_bf16 v[124:127], a[8:11], a[160:163], v[124:127]
s_waitcnt lgkmcnt(4)
v_mfma_f32_16x16x32_bf16 v[24:27], a[16:19], a[160:163], v[24:27]
ds_read_b64_tr_b16 a[8:9], v19 offset:256
v_mfma_f32_16x16x32_bf16 v[24:27], a[20:23], a[176:179], v[24:27]
ds_read_b64_tr_b16 a[10:11], v19 offset:4352
v_mfma_f32_16x16x32_bf16 v[32:35], a[20:23], a[180:183], v[32:35]
buffer_load_dwordx4 v12, s[64:67], s62 offen offset:2048 lds
v_mfma_f32_16x16x32_bf16 v[32:35], a[16:19], a[164:167], v[32:35]
ds_read_b64_tr_b16 a[12:13], v19 offset:8448
v_mfma_f32_16x16x32_bf16 v[40:43], a[16:19], a[168:171], v[40:43]
ds_read_b64_tr_b16 a[14:15], v19 offset:12544
v_mfma_f32_16x16x32_bf16 v[40:43], a[20:23], a[184:187], v[40:43]
v_mfma_f32_16x16x32_bf16 v[48:51], a[20:23], a[188:191], v[48:51]
v_mfma_f32_16x16x32_bf16 v[48:51], a[16:19], a[172:175], v[48:51]
buffer_load_dwordx4 v13, s[64:67], s62 offen offset:3072 lds
v_mfma_f32_16x16x32_bf16 v[52:55], a[24:27], a[172:175], v[52:55]
ds_read_b64_tr_b16 a[16:17], v15 offset:512
v_mfma_f32_16x16x32_bf16 v[52:55], a[28:31], a[188:191], v[52:55]
buffer_load_dword v8, v6, s[88:91], s9 offen offset:0 sc1
v_mfma_f32_16x16x32_bf16 v[44:47], a[28:31], a[184:187], v[44:47]
ds_read_b64_tr_b16 a[18:19], v15 offset:4608
v_mfma_f32_16x16x32_bf16 v[44:47], a[24:27], a[168:171], v[44:47]
buffer_load_dword v9, v6, s[88:91], s9 offen offset:64 sc1
v_mfma_f32_16x16x32_bf16 v[36:39], a[24:27], a[164:167], v[36:39]
ds_read_b64_tr_b16 a[20:21], v15 offset:8704
v_mfma_f32_16x16x32_bf16 v[36:39], a[28:31], a[180:183], v[36:39]
buffer_load_dword v10, v6, s[88:91], s9 offen offset:128 sc1
v_mfma_f32_16x16x32_bf16 v[28:31], a[28:31], a[176:179], v[28:31]
ds_read_b64_tr_b16 a[22:23], v15 offset:12800
s_waitcnt lgkmcnt(4)
v_mfma_f32_16x16x32_bf16 v[28:31], a[24:27], a[160:163], v[28:31]
buffer_load_dword v11, v6, s[88:91], s9 offen offset:192 sc1
v_mfma_f32_16x16x32_bf16 v[160:163], a[0:3], a[192:195], 0
ds_read_b64_tr_b16 a[24:25], v19 offset:512
s_add_u32 s60, s60, s58
s_and_b32 s60, s60, 0x1c000
v_mfma_f32_16x16x32_bf16 v[160:163], a[4:7], a[208:211], v[160:163]
ds_read_b64_tr_b16 a[26:27], v19 offset:4608
s_or_b32 s60, s60, 0x20000
v_mfma_f32_16x16x32_bf16 v[168:171], a[4:7], a[212:215], 0
ds_read_b64_tr_b16 a[28:29], v19 offset:8704
s_add_u32 s101, s63, s60
v_mfma_f32_16x16x32_bf16 v[168:171], a[0:3], a[196:199], v[168:171]
buffer_load_dwordx4 a[64:67], v3, s[88:91], s101 offen sc1
v_mfma_f32_16x16x32_bf16 v[176:179], a[0:3], a[200:203], 0
ds_read_b64_tr_b16 a[30:31], v19 offset:12800
v_mfma_f32_16x16x32_bf16 v[176:179], a[4:7], a[216:219], v[176:179]
v_mfma_f32_16x16x32_bf16 v[184:187], a[4:7], a[220:223], 0
buffer_load_dwordx4 a[68:71], v3, s[88:91], s101 offen offset:1024 sc1
v_mfma_f32_16x16x32_bf16 v[184:187], a[0:3], a[204:207], v[184:187]
v_mfma_f32_16x16x32_bf16 v[188:191], a[8:11], a[204:207], 0
ds_read_b64_tr_b16 a[0:1], v15 offset:768
v_mfma_f32_16x16x32_bf16 v[188:191], a[12:15], a[220:223], v[188:191]
buffer_load_dwordx4 a[72:75], v3, s[88:91], s101 offen offset:2048 sc1
v_mfma_f32_16x16x32_bf16 v[180:183], a[12:15], a[216:219], 0
ds_read_b64_tr_b16 a[2:3], v15 offset:4864
v_mfma_f32_16x16x32_bf16 v[180:183], a[8:11], a[200:203], v[180:183]
ds_read_b64_tr_b16 a[4:5], v15 offset:8960
v_mfma_f32_16x16x32_bf16 v[172:175], a[8:11], a[196:199], 0
buffer_load_dwordx4 a[76:79], v3, s[88:91], s101 offen offset:3072 sc1
v_mfma_f32_16x16x32_bf16 v[172:175], a[12:15], a[212:215], v[172:175]
ds_read_b64_tr_b16 a[6:7], v15 offset:13056
s_add_u32 s101, s101, 0x2000
v_mfma_f32_16x16x32_bf16 v[164:167], a[12:15], a[208:211], 0
L_padC0:
s_cmp_eq_u32 s95, 1
s_cbranch_scc1 L_padC2
v_mfma_f32_16x16x32_bf16 v[164:167], a[8:11], a[192:195], v[164:167]
s_waitcnt lgkmcnt(4)
v_mfma_f32_16x16x32_bf16 v[192:195], a[16:19], a[192:195], 0
buffer_load_dwordx4 a[80:83], v3, s[88:91], s101 offen sc1
v_mfma_f32_16x16x32_bf16 v[192:195], a[20:23], a[208:211], v[192:195]
ds_read_b64_tr_b16 a[8:9], v19 offset:768
v_mfma_f32_16x16x32_bf16 v[200:203], a[20:23], a[212:215], 0
ds_read_b64_tr_b16 a[10:11], v19 offset:4864
v_mfma_f32_16x16x32_bf16 v[200:203], a[16:19], a[196:199], v[200:203]
buffer_load_dwordx4 a[84:87], v3, s[88:91], s101 offen offset:1024 sc1
v_mfma_f32_16x16x32_bf16 v[208:211], a[16:19], a[200:203], 0
ds_read_b64_tr_b16 a[12:13], v19 offset:8960
v_mfma_f32_16x16x32_bf16 v[208:211], a[20:23], a[216:219], v[208:211]
ds_read_b64_tr_b16 a[14:15], v19 offset:13056
v_mfma_f32_16x16x32_bf16 v[216:219], a[20:23], a[220:223], 0
v_mfma_f32_16x16x32_bf16 v[216:219], a[16:19], a[204:207], v[216:219]
buffer_load_dwordx4 a[88:91], v3, s[88:91], s101 offen offset:2048 sc1
v_mfma_f32_16x16x32_bf16 v[220:223], a[24:27], a[204:207], 0
ds_read_b64_tr_b16 a[16:17], v15 offset:0
v_mfma_f32_16x16x32_bf16 v[220:223], a[28:31], a[220:223], v[220:223]
ds_read_b64_tr_b16 a[18:19], v15 offset:4096
v_mfma_f32_16x16x32_bf16 v[212:215], a[28:31], a[216:219], 0
ds_read_b64_tr_b16 a[20:21], v15 offset:8192
v_mfma_f32_16x16x32_bf16 v[212:215], a[24:27], a[200:203], v[212:215]
ds_read_b64_tr_b16 a[22:23], v15 offset:12288
v_mfma_f32_16x16x32_bf16 v[204:207], a[24:27], a[196:199], 0
buffer_load_dwordx4 a[92:95], v3, s[88:91], s101 offen offset:3072 sc1
v_mfma_f32_16x16x32_bf16 v[204:207], a[28:31], a[212:215], v[204:207]
s_add_u32 m0, s17, 0x10000
s_lshl_b32 s61, s60, 3
s_add_u32 s62, s61, s12
v_mfma_f32_16x16x32_bf16 v[196:199], a[28:31], a[208:211], 0
v_mfma_f32_16x16x32_bf16 v[196:199], a[24:27], a[192:195], v[196:199]
s_waitcnt lgkmcnt(4)
v_mfma_f32_16x16x32_bf16 v[224:227], a[0:3], a[192:195], 0
buffer_load_dwordx4 v12, s[64:67], s61 offen lds
v_mfma_f32_16x16x32_bf16 v[224:227], a[4:7], a[208:211], v[224:227]
ds_read_b64_tr_b16 a[24:25], v19 offset:0
v_mfma_f32_16x16x32_bf16 v[232:235], a[4:7], a[212:215], 0
ds_read_b64_tr_b16 a[26:27], v19 offset:4096
v_mfma_f32_16x16x32_bf16 v[232:235], a[0:3], a[196:199], v[232:235]
ds_read_b64_tr_b16 a[28:29], v19 offset:8192
v_mfma_f32_16x16x32_bf16 v[240:243], a[0:3], a[200:203], 0
ds_read_b64_tr_b16 a[30:31], v19 offset:12288
v_mfma_f32_16x16x32_bf16 v[240:243], a[4:7], a[216:219], v[240:243]
buffer_load_dwordx4 v13, s[64:67], s61 offen offset:1024 lds
v_mfma_f32_16x16x32_bf16 v[248:251], a[4:7], a[220:223], 0
s_waitcnt vmcnt(14)
v_mfma_f32_16x16x32_bf16 v[248:251], a[0:3], a[204:207], v[248:251]
s_barrier
v_mfma_f32_16x16x32_bf16 v[252:255], a[8:11], a[204:207], 0
ds_read_b64_tr_b16 a[0:1], v15 offset:16640
v_mfma_f32_16x16x32_bf16 v[252:255], a[12:15], a[220:223], v[252:255]
buffer_load_dwordx4 v12, s[64:67], s62 offen offset:2048 lds
v_mfma_f32_16x16x32_bf16 v[244:247], a[12:15], a[216:219], 0
ds_read_b64_tr_b16 a[2:3], v15 offset:20736
v_mfma_f32_16x16x32_bf16 v[244:247], a[8:11], a[200:203], v[244:247]
ds_read_b64_tr_b16 a[4:5], v15 offset:24832
v_mfma_f32_16x16x32_bf16 v[236:239], a[8:11], a[196:199], 0
ds_read_b64_tr_b16 a[6:7], v15 offset:28928
v_mfma_f32_16x16x32_bf16 v[236:239], a[12:15], a[212:215], v[236:239]
v_mfma_f32_16x16x32_bf16 v[228:231], a[12:15], a[208:211], 0
buffer_load_dwordx4 v13, s[64:67], s62 offen offset:3072 lds
v_mfma_f32_16x16x32_bf16 v[228:231], a[8:11], a[192:195], v[228:231]
s_waitcnt lgkmcnt(4)
s_add_u32 s60, s60, s59
s_and_b32 s60, s60, 0x1c000
v_mfma_f32_16x16x32_bf16 a[32:35], a[16:19], a[192:195], 0
ds_read_b64_tr_b16 a[8:9], v19 offset:16640
s_or_b32 s60, s60, 0x20000
v_mfma_f32_16x16x32_bf16 a[32:35], a[20:23], a[208:211], a[32:35]
ds_read_b64_tr_b16 a[10:11], v19 offset:20736
s_add_u32 s101, s63, s60
v_mfma_f32_16x16x32_bf16 a[40:43], a[20:23], a[212:215], 0
ds_read_b64_tr_b16 a[12:13], v19 offset:24832
v_mfma_f32_16x16x32_bf16 a[40:43], a[16:19], a[196:199], a[40:43]
buffer_load_dwordx4 a[96:99], v3, s[88:91], s101 offen sc1
v_mfma_f32_16x16x32_bf16 a[48:51], a[16:19], a[200:203], 0
ds_read_b64_tr_b16 a[14:15], v19 offset:28928
v_mfma_f32_16x16x32_bf16 a[48:51], a[20:23], a[216:219], a[48:51]
v_mfma_f32_16x16x32_bf16 v[152:155], a[20:23], a[220:223], 0
v_mfma_f32_16x16x32_bf16 v[152:155], a[16:19], a[204:207], v[152:155]
buffer_load_dwordx4 a[100:103], v3, s[88:91], s101 offen offset:1024 sc1
v_mfma_f32_16x16x32_bf16 v[156:159], a[24:27], a[204:207], 0
ds_read_b64_tr_b16 a[16:17], v15 offset:16896
v_mfma_f32_16x16x32_bf16 v[156:159], a[28:31], a[220:223], v[156:159]
ds_read_b64_tr_b16 a[18:19], v15 offset:20992
v_mfma_f32_16x16x32_bf16 a[52:55], a[28:31], a[216:219], 0
ds_read_b64_tr_b16 a[20:21], v15 offset:25088
v_mfma_f32_16x16x32_bf16 a[52:55], a[24:27], a[200:203], a[52:55]
ds_read_b64_tr_b16 a[22:23], v15 offset:29184
v_mfma_f32_16x16x32_bf16 a[44:47], a[24:27], a[196:199], 0
buffer_load_dwordx4 a[104:107], v3, s[88:91], s101 offen offset:2048 sc1
v_mfma_f32_16x16x32_bf16 a[44:47], a[28:31], a[212:215], a[44:47]
v_mfma_f32_16x16x32_bf16 a[36:39], a[28:31], a[208:211], 0
v_mfma_f32_16x16x32_bf16 a[36:39], a[24:27], a[192:195], a[36:39]
s_waitcnt lgkmcnt(4)
v_mfma_f32_16x16x32_bf16 v[160:163], a[0:3], a[224:227], v[160:163]
buffer_load_dwordx4 a[108:111], v3, s[88:91], s101 offen offset:3072 sc1
v_mfma_f32_16x16x32_bf16 v[160:163], a[4:7], a[240:243], v[160:163]
ds_read_b64_tr_b16 a[24:25], v19 offset:16896
s_add_u32 s101, s101, 0x2000
v_mfma_f32_16x16x32_bf16 v[168:171], a[4:7], a[244:247], v[168:171]
ds_read_b64_tr_b16 a[26:27], v19 offset:20992
v_mfma_f32_16x16x32_bf16 v[168:171], a[0:3], a[228:231], v[168:171]
ds_read_b64_tr_b16 a[28:29], v19 offset:25088
v_mfma_f32_16x16x32_bf16 v[176:179], a[0:3], a[232:235], v[176:179]
ds_read_b64_tr_b16 a[30:31], v19 offset:29184
v_mfma_f32_16x16x32_bf16 v[176:179], a[4:7], a[248:251], v[176:179]
buffer_load_dwordx4 a[112:115], v3, s[88:91], s101 offen sc1
v_mfma_f32_16x16x32_bf16 v[184:187], a[4:7], a[252:255], v[184:187]
v_mfma_f32_16x16x32_bf16 v[184:187], a[0:3], a[236:239], v[184:187]
v_mfma_f32_16x16x32_bf16 v[188:191], a[8:11], a[236:239], v[188:191]
ds_read_b64_tr_b16 a[0:1], v15 offset:17152
v_mfma_f32_16x16x32_bf16 v[188:191], a[12:15], a[252:255], v[188:191]
ds_read_b64_tr_b16 a[2:3], v15 offset:21248
v_mfma_f32_16x16x32_bf16 v[180:183], a[12:15], a[248:251], v[180:183]
buffer_load_dwordx4 a[116:119], v3, s[88:91], s101 offen offset:1024 sc1
v_mfma_f32_16x16x32_bf16 v[180:183], a[8:11], a[232:235], v[180:183]
ds_read_b64_tr_b16 a[4:5], v15 offset:25344
v_mfma_f32_16x16x32_bf16 v[172:175], a[8:11], a[228:231], v[172:175]
ds_read_b64_tr_b16 a[6:7], v15 offset:29440
v_mfma_f32_16x16x32_bf16 v[172:175], a[12:15], a[244:247], v[172:175]
v_mfma_f32_16x16x32_bf16 v[164:167], a[12:15], a[240:243], v[164:167]
buffer_load_dwordx4 a[120:123], v3, s[88:91], s101 offen offset:2048 sc1
v_mfma_f32_16x16x32_bf16 v[164:167], a[8:11], a[224:227], v[164:167]
s_waitcnt lgkmcnt(4)
v_mfma_f32_16x16x32_bf16 v[192:195], a[16:19], a[224:227], v[192:195]
ds_read_b64_tr_b16 a[8:9], v19 offset:17152
v_mfma_f32_16x16x32_bf16 v[192:195], a[20:23], a[240:243], v[192:195]
ds_read_b64_tr_b16 a[10:11], v19 offset:21248
v_mfma_f32_16x16x32_bf16 v[200:203], a[20:23], a[244:247], v[200:203]
ds_read_b64_tr_b16 a[12:13], v19 offset:25344
v_mfma_f32_16x16x32_bf16 v[200:203], a[16:19], a[228:231], v[200:203]
buffer_load_dwordx4 a[124:127], v3, s[88:91], s101 offen offset:3072 sc1
v_mfma_f32_16x16x32_bf16 v[208:211], a[16:19], a[232:235], v[208:211]
ds_read_b64_tr_b16 a[14:15], v19 offset:29440
s_add_u32 m0, s17, 0x14000
v_mfma_f32_16x16x32_bf16 v[208:211], a[20:23], a[248:251], v[208:211]
s_lshl_b32 s61, s60, 3
s_add_u32 s62, s61, s12
v_mfma_f32_16x16x32_bf16 v[216:219], a[20:23], a[252:255], v[216:219]
v_mfma_f32_16x16x32_bf16 v[216:219], a[16:19], a[236:239], v[216:219]
buffer_load_dwordx4 v12, s[64:67], s61 offen lds
v_mfma_f32_16x16x32_bf16 v[220:223], a[24:27], a[236:239], v[220:223]
ds_read_b64_tr_b16 a[16:17], v15 offset:16384
v_mfma_f32_16x16x32_bf16 v[220:223], a[28:31], a[252:255], v[220:223]
ds_read_b64_tr_b16 a[18:19], v15 offset:20480
v_mfma_f32_16x16x32_bf16 v[212:215], a[28:31], a[248:251], v[212:215]
ds_read_b64_tr_b16 a[20:21], v15 offset:24576
v_mfma_f32_16x16x32_bf16 v[212:215], a[24:27], a[232:235], v[212:215]
ds_read_b64_tr_b16 a[22:23], v15 offset:28672
v_mfma_f32_16x16x32_bf16 v[204:207], a[24:27], a[228:231], v[204:207]
buffer_load_dwordx4 v13, s[64:67], s61 offen offset:1024 lds
v_mfma_f32_16x16x32_bf16 v[204:207], a[28:31], a[244:247], v[204:207]
v_mfma_f32_16x16x32_bf16 v[196:199], a[28:31], a[240:243], v[196:199]
v_mfma_f32_16x16x32_bf16 v[196:199], a[24:27], a[224:227], v[196:199]
s_waitcnt lgkmcnt(4)
v_mfma_f32_16x16x32_bf16 v[224:227], a[0:3], a[224:227], v[224:227]
ds_read_b64_tr_b16 a[24:25], v19 offset:16384
v_mfma_f32_16x16x32_bf16 v[224:227], a[4:7], a[240:243], v[224:227]
buffer_load_dwordx4 v12, s[64:67], s62 offen offset:2048 lds
v_mfma_f32_16x16x32_bf16 v[232:235], a[4:7], a[244:247], v[232:235]
ds_read_b64_tr_b16 a[26:27], v19 offset:20480
v_mfma_f32_16x16x32_bf16 v[232:235], a[0:3], a[228:231], v[232:235]
ds_read_b64_tr_b16 a[28:29], v19 offset:24576
v_mfma_f32_16x16x32_bf16 v[240:243], a[0:3], a[232:235], v[240:243]
ds_read_b64_tr_b16 a[30:31], v19 offset:28672
v_mfma_f32_16x16x32_bf16 v[240:243], a[4:7], a[248:251], v[240:243]
buffer_load_dwordx4 v13, s[64:67], s62 offen offset:3072 lds
v_mfma_f32_16x16x32_bf16 v[248:251], a[4:7], a[252:255], v[248:251]
s_waitcnt vmcnt(12)
s_add_u32 s60, s60, s56
s_and_b32 s60, s60, 0x1c000
v_mfma_f32_16x16x32_bf16 v[248:251], a[0:3], a[236:239], v[248:251]
s_barrier
s_or_b32 s60, s60, 0x20000
s_add_u32 s101, s63, s60
v_mfma_f32_16x16x32_bf16 v[252:255], a[8:11], a[236:239], v[252:255]
ds_read_b64_tr_b16 a[0:1], v4 offset:256
v_mfma_f32_16x16x32_bf16 v[252:255], a[12:15], a[252:255], v[252:255]
ds_read_b64_tr_b16 a[2:3], v4 offset:4352
v_mfma_f32_16x16x32_bf16 v[244:247], a[12:15], a[248:251], v[244:247]
buffer_load_dwordx4 a[128:131], v3, s[88:91], s101 offen sc1
v_mfma_f32_16x16x32_bf16 v[244:247], a[8:11], a[232:235], v[244:247]
ds_read_b64_tr_b16 a[4:5], v4 offset:8448
v_mfma_f32_16x16x32_bf16 v[236:239], a[8:11], a[228:231], v[236:239]
ds_read_b64_tr_b16 a[6:7], v4 offset:12544
v_mfma_f32_16x16x32_bf16 v[236:239], a[12:15], a[244:247], v[236:239]
v_mfma_f32_16x16x32_bf16 v[228:231], a[12:15], a[240:243], v[228:231]
buffer_load_dwordx4 a[132:135], v3, s[88:91], s101 offen offset:1024 sc1
v_mfma_f32_16x16x32_bf16 v[228:231], a[8:11], a[224:227], v[228:231]
s_waitcnt lgkmcnt(4)
v_mfma_f32_16x16x32_bf16 a[32:35], a[16:19], a[224:227], a[32:35]
ds_read_b64_tr_b16 a[8:9], v5 offset:256
v_mfma_f32_16x16x32_bf16 a[32:35], a[20:23], a[240:243], a[32:35]
ds_read_b64_tr_b16 a[10:11], v5 offset:4352
v_mfma_f32_16x16x32_bf16 a[40:43], a[20:23], a[244:247], a[40:43]
ds_read_b64_tr_b16 a[12:13], v5 offset:8448
v_mfma_f32_16x16x32_bf16 a[40:43], a[16:19], a[228:231], a[40:43]
buffer_load_dwordx4 a[136:139], v3, s[88:91], s101 offen offset:2048 sc1
v_mfma_f32_16x16x32_bf16 a[48:51], a[16:19], a[232:235], a[48:51]
ds_read_b64_tr_b16 a[14:15], v5 offset:12544
v_mfma_f32_16x16x32_bf16 a[48:51], a[20:23], a[248:251], a[48:51]
v_mfma_f32_16x16x32_bf16 v[152:155], a[20:23], a[252:255], v[152:155]
v_mfma_f32_16x16x32_bf16 v[152:155], a[16:19], a[236:239], v[152:155]
v_mfma_f32_16x16x32_bf16 v[156:159], a[24:27], a[236:239], v[156:159]
buffer_load_dwordx4 a[140:143], v3, s[88:91], s101 offen offset:3072 sc1
v_mfma_f32_16x16x32_bf16 v[156:159], a[28:31], a[252:255], v[156:159]
ds_read_b64_tr_b16 a[16:17], v4 offset:512
s_add_u32 s101, s101, 0x2000
v_mfma_f32_16x16x32_bf16 a[52:55], a[28:31], a[248:251], a[52:55]
ds_read_b64_tr_b16 a[18:19], v4 offset:4608
v_mfma_f32_16x16x32_bf16 a[52:55], a[24:27], a[232:235], a[52:55]
ds_read_b64_tr_b16 a[20:21], v4 offset:8704
v_mfma_f32_16x16x32_bf16 a[44:47], a[24:27], a[228:231], a[44:47]
buffer_load_dwordx4 a[144:147], v3, s[88:91], s101 offen sc1
v_mfma_f32_16x16x32_bf16 a[44:47], a[28:31], a[244:247], a[44:47]
ds_read_b64_tr_b16 a[22:23], v4 offset:12800
v_mfma_f32_16x16x32_bf16 a[36:39], a[28:31], a[240:243], a[36:39]
v_mfma_f32_16x16x32_bf16 a[36:39], a[24:27], a[224:227], a[36:39]
s_waitcnt lgkmcnt(4)
v_mfma_f32_16x16x32_bf16 v[160:163], a[0:3], a[64:67], v[160:163]
ds_read_b64_tr_b16 a[24:25], v5 offset:512
v_mfma_f32_16x16x32_bf16 v[160:163], a[4:7], a[80:83], v[160:163]
buffer_load_dwordx4 a[148:151], v3, s[88:91], s101 offen offset:1024 sc1
v_mfma_f32_16x16x32_bf16 v[168:171], a[4:7], a[84:87], v[168:171]
ds_read_b64_tr_b16 a[26:27], v5 offset:4608
v_mfma_f32_16x16x32_bf16 v[168:171], a[0:3], a[68:71], v[168:171]
ds_read_b64_tr_b16 a[28:29], v5 offset:8704
v_mfma_f32_16x16x32_bf16 v[176:179], a[0:3], a[72:75], v[176:179]
ds_read_b64_tr_b16 a[30:31], v5 offset:12800
v_mfma_f32_16x16x32_bf16 v[176:179], a[4:7], a[88:91], v[176:179]
buffer_load_dwordx4 a[152:155], v3, s[88:91], s101 offen offset:2048 sc1
v_mfma_f32_16x16x32_bf16 v[184:187], a[4:7], a[92:95], v[184:187]
v_mfma_f32_16x16x32_bf16 v[184:187], a[0:3], a[76:79], v[184:187]
v_mfma_f32_16x16x32_bf16 v[188:191], a[8:11], a[76:79], v[188:191]
ds_read_b64_tr_b16 a[0:1], v4 offset:768
v_mfma_f32_16x16x32_bf16 v[188:191], a[12:15], a[92:95], v[188:191]
ds_read_b64_tr_b16 a[2:3], v4 offset:4864
v_mfma_f32_16x16x32_bf16 v[180:183], a[12:15], a[88:91], v[180:183]
buffer_load_dwordx4 a[156:159], v3, s[88:91], s101 offen offset:3072 sc1
v_mfma_f32_16x16x32_bf16 v[180:183], a[8:11], a[72:75], v[180:183]
ds_read_b64_tr_b16 a[4:5], v4 offset:8960
s_add_u32 m0, s17, 0x18000
v_mfma_f32_16x16x32_bf16 v[172:175], a[8:11], a[68:71], v[172:175]
ds_read_b64_tr_b16 a[6:7], v4 offset:13056
s_lshl_b32 s61, s60, 3
v_mfma_f32_16x16x32_bf16 v[172:175], a[12:15], a[84:87], v[172:175]
s_add_u32 s62, s61, s12
v_mfma_f32_16x16x32_bf16 v[164:167], a[12:15], a[80:83], v[164:167]
s_waitcnt lgkmcnt(4)
v_mfma_f32_16x16x32_bf16 v[164:167], a[8:11], a[64:67], v[164:167]
buffer_load_dwordx4 v12, s[64:67], s61 offen lds
v_mfma_f32_16x16x32_bf16 v[192:195], a[16:19], a[64:67], v[192:195]
ds_read_b64_tr_b16 a[8:9], v5 offset:768
v_mfma_f32_16x16x32_bf16 v[192:195], a[20:23], a[80:83], v[192:195]
ds_read_b64_tr_b16 a[10:11], v5 offset:4864
v_mfma_f32_16x16x32_bf16 v[200:203], a[20:23], a[84:87], v[200:203]
ds_read_b64_tr_b16 a[12:13], v5 offset:8960
v_mfma_f32_16x16x32_bf16 v[200:203], a[16:19], a[68:71], v[200:203]
buffer_load_dwordx4 v13, s[64:67], s61 offen offset:1024 lds
v_mfma_f32_16x16x32_bf16 v[208:211], a[16:19], a[72:75], v[208:211]
ds_read_b64_tr_b16 a[14:15], v5 offset:13056
v_mfma_f32_16x16x32_bf16 v[208:211], a[20:23], a[88:91], v[208:211]
v_mfma_f32_16x16x32_bf16 v[216:219], a[20:23], a[92:95], v[216:219]
v_mfma_f32_16x16x32_bf16 v[216:219], a[16:19], a[76:79], v[216:219]
v_mfma_f32_16x16x32_bf16 v[220:223], a[24:27], a[76:79], v[220:223]
buffer_load_dwordx4 v12, s[64:67], s62 offen offset:2048 lds
v_mfma_f32_16x16x32_bf16 v[220:223], a[28:31], a[92:95], v[220:223]
ds_read_b64_tr_b16 a[16:17], v4 offset:0
v_mfma_f32_16x16x32_bf16 v[212:215], a[28:31], a[88:91], v[212:215]
ds_read_b64_tr_b16 a[18:19], v4 offset:4096
v_mfma_f32_16x16x32_bf16 v[212:215], a[24:27], a[72:75], v[212:215]
ds_read_b64_tr_b16 a[20:21], v4 offset:8192
v_mfma_f32_16x16x32_bf16 v[204:207], a[24:27], a[68:71], v[204:207]
buffer_load_dwordx4 v13, s[64:67], s62 offen offset:3072 lds
v_mfma_f32_16x16x32_bf16 v[204:207], a[28:31], a[84:87], v[204:207]
ds_read_b64_tr_b16 a[22:23], v4 offset:12288
s_add_u32 s60, s60, s57
v_mfma_f32_16x16x32_bf16 v[196:199], a[28:31], a[80:83], v[196:199]
s_and_b32 s60, s60, 0x1c000
s_or_b32 s60, s60, 0x20000
s_add_u32 s101, s63, s60
v_mfma_f32_16x16x32_bf16 v[196:199], a[24:27], a[64:67], v[196:199]
s_waitcnt lgkmcnt(4)
v_mfma_f32_16x16x32_bf16 v[224:227], a[0:3], a[64:67], v[224:227]
ds_read_b64_tr_b16 a[24:25], v5 offset:0
v_mfma_f32_16x16x32_bf16 v[224:227], a[4:7], a[80:83], v[224:227]
buffer_load_dwordx4 a[160:163], v3, s[88:91], s101 offen sc1
v_mfma_f32_16x16x32_bf16 v[232:235], a[4:7], a[84:87], v[232:235]
ds_read_b64_tr_b16 a[26:27], v5 offset:4096
v_mfma_f32_16x16x32_bf16 v[232:235], a[0:3], a[68:71], v[232:235]
ds_read_b64_tr_b16 a[28:29], v5 offset:8192
v_mfma_f32_16x16x32_bf16 v[240:243], a[0:3], a[72:75], v[240:243]
ds_read_b64_tr_b16 a[30:31], v5 offset:12288
v_mfma_f32_16x16x32_bf16 v[240:243], a[4:7], a[88:91], v[240:243]
v_mfma_f32_16x16x32_bf16 v[248:251], a[4:7], a[92:95], v[248:251]
s_waitcnt vmcnt(13)
v_mfma_f32_16x16x32_bf16 v[248:251], a[0:3], a[76:79], v[248:251]
s_barrier
v_mfma_f32_16x16x32_bf16 v[252:255], a[8:11], a[76:79], v[252:255]
buffer_load_dwordx4 a[164:167], v3, s[88:91], s101 offen offset:1024 sc1
v_mfma_f32_16x16x32_bf16 v[252:255], a[12:15], a[92:95], v[252:255]
ds_read_b64_tr_b16 a[0:1], v4 offset:16640
v_sub_f32 v20, 1.0, v8
v_mfma_f32_16x16x32_bf16 v[244:247], a[12:15], a[88:91], v[244:247]
ds_read_b64_tr_b16 a[2:3], v4 offset:20736
v_sub_f32 v21, 1.0, v9
v_mfma_f32_16x16x32_bf16 v[244:247], a[8:11], a[72:75], v[244:247]
buffer_load_dwordx4 a[168:171], v3, s[88:91], s101 offen offset:2048 sc1
v_mfma_f32_16x16x32_bf16 v[236:239], a[8:11], a[68:71], v[236:239]
ds_read_b64_tr_b16 a[4:5], v4 offset:24832
v_sub_f32 v22, 1.0, v10
v_mfma_f32_16x16x32_bf16 v[236:239], a[12:15], a[84:87], v[236:239]
ds_read_b64_tr_b16 a[6:7], v4 offset:28928
v_sub_f32 v23, 1.0, v11
v_mfma_f32_16x16x32_bf16 v[228:231], a[12:15], a[80:83], v[228:231]
s_waitcnt lgkmcnt(4)
v_mul_f32 v24, v20, v24
v_mul_f32 v25, v20, v25
v_mfma_f32_16x16x32_bf16 v[228:231], a[8:11], a[64:67], v[228:231]
buffer_load_dwordx4 a[172:175], v3, s[88:91], s101 offen offset:3072 sc1
v_mfma_f32_16x16x32_bf16 a[32:35], a[16:19], a[64:67], a[32:35]
ds_read_b64_tr_b16 a[8:9], v5 offset:16640
s_add_u32 s101, s101, 0x2000
v_mfma_f32_16x16x32_bf16 a[32:35], a[20:23], a[80:83], a[32:35]
ds_read_b64_tr_b16 a[10:11], v5 offset:20736
v_mul_f32 v26, v20, v26
v_mfma_f32_16x16x32_bf16 a[40:43], a[20:23], a[84:87], a[40:43]
ds_read_b64_tr_b16 a[12:13], v5 offset:24832
v_mul_f32 v27, v20, v27
v_mfma_f32_16x16x32_bf16 a[40:43], a[16:19], a[68:71], a[40:43]
buffer_load_dwordx4 a[176:179], v3, s[88:91], s101 offen sc1
v_mfma_f32_16x16x32_bf16 a[48:51], a[16:19], a[72:75], a[48:51]
ds_read_b64_tr_b16 a[14:15], v5 offset:28928
v_mul_f32 v32, v21, v32
v_mfma_f32_16x16x32_bf16 a[48:51], a[20:23], a[88:91], a[48:51]
v_mul_f32 v33, v21, v33
v_mul_f32 v34, v21, v34
v_mfma_f32_16x16x32_bf16 v[152:155], a[20:23], a[92:95], v[152:155]
v_mul_f32 v35, v21, v35
v_mul_f32 v40, v22, v40
v_mfma_f32_16x16x32_bf16 v[152:155], a[16:19], a[76:79], v[152:155]
v_mul_f32 v41, v22, v41
v_mul_f32 v42, v22, v42
v_mfma_f32_16x16x32_bf16 v[156:159], a[24:27], a[76:79], v[156:159]
buffer_load_dwordx4 a[180:183], v3, s[88:91], s101 offen offset:1024 sc1
v_mfma_f32_16x16x32_bf16 v[156:159], a[28:31], a[92:95], v[156:159]
ds_read_b64_tr_b16 a[16:17], v4 offset:16896
v_mul_f32 v43, v22, v43
v_mfma_f32_16x16x32_bf16 a[52:55], a[28:31], a[88:91], a[52:55]
ds_read_b64_tr_b16 a[18:19], v4 offset:20992
v_mul_f32 v48, v23, v48
v_mfma_f32_16x16x32_bf16 a[52:55], a[24:27], a[72:75], a[52:55]
ds_read_b64_tr_b16 a[20:21], v4 offset:25088
v_mul_f32 v49, v23, v49
v_mfma_f32_16x16x32_bf16 a[44:47], a[24:27], a[68:71], a[44:47]
ds_read_b64_tr_b16 a[22:23], v4 offset:29184
v_mul_f32 v50, v23, v50
v_mfma_f32_16x16x32_bf16 a[44:47], a[28:31], a[84:87], a[44:47]
buffer_load_dwordx4 a[184:187], v3, s[88:91], s101 offen offset:2048 sc1
v_mfma_f32_16x16x32_bf16 a[36:39], a[28:31], a[80:83], a[36:39]
v_mul_f32 v51, v23, v51
v_mul_f32 v28, v20, v28
v_mfma_f32_16x16x32_bf16 a[36:39], a[24:27], a[64:67], a[36:39]
s_waitcnt lgkmcnt(4)
v_mul_f32 v29, v20, v29
v_mul_f32 v30, v20, v30
v_mfma_f32_16x16x32_bf16 v[160:163], a[0:3], a[96:99], v[160:163]
ds_read_b64_tr_b16 a[24:25], v5 offset:16896
v_mul_f32 v31, v20, v31
v_mfma_f32_16x16x32_bf16 v[160:163], a[4:7], a[112:115], v[160:163]
buffer_load_dwordx4 a[188:191], v3, s[88:91], s101 offen offset:3072 sc1
v_mfma_f32_16x16x32_bf16 v[168:171], a[4:7], a[116:119], v[168:171]
ds_read_b64_tr_b16 a[26:27], v5 offset:20992
s_add_u32 m0, s17, 0x1c000
v_mfma_f32_16x16x32_bf16 v[168:171], a[0:3], a[100:103], v[168:171]
ds_read_b64_tr_b16 a[28:29], v5 offset:25088
s_lshl_b32 s61, s60, 3
v_mfma_f32_16x16x32_bf16 v[176:179], a[0:3], a[104:107], v[176:179]
ds_read_b64_tr_b16 a[30:31], v5 offset:29184
s_add_u32 s62, s61, s12
v_mfma_f32_16x16x32_bf16 v[176:179], a[4:7], a[120:123], v[176:179]
v_mul_f32 v36, v21, v36
v_mul_f32 v37, v21, v37
v_mfma_f32_16x16x32_bf16 v[184:187], a[4:7], a[124:127], v[184:187]
buffer_load_dwordx4 v12, s[64:67], s61 offen lds
v_mfma_f32_16x16x32_bf16 v[184:187], a[0:3], a[108:111], v[184:187]
v_mul_f32 v38, v21, v38
v_mul_f32 v39, v21, v39
v_mfma_f32_16x16x32_bf16 v[188:191], a[8:11], a[108:111], v[188:191]
ds_read_b64_tr_b16 a[0:1], v4 offset:17152
v_mul_f32 v44, v22, v44
v_mfma_f32_16x16x32_bf16 v[188:191], a[12:15], a[124:127], v[188:191]
ds_read_b64_tr_b16 a[2:3], v4 offset:21248
v_mul_f32 v45, v22, v45
v_mfma_f32_16x16x32_bf16 v[180:183], a[12:15], a[120:123], v[180:183]
buffer_load_dwordx4 v13, s[64:67], s61 offen offset:1024 lds
v_mfma_f32_16x16x32_bf16 v[180:183], a[8:11], a[104:107], v[180:183]
ds_read_b64_tr_b16 a[4:5], v4 offset:25344
v_mul_f32 v46, v22, v46
v_mfma_f32_16x16x32_bf16 v[172:175], a[8:11], a[100:103], v[172:175]
ds_read_b64_tr_b16 a[6:7], v4 offset:29440
v_mul_f32 v47, v22, v47
v_mfma_f32_16x16x32_bf16 v[172:175], a[12:15], a[116:119], v[172:175]
v_mul_f32 v52, v23, v52
v_mul_f32 v53, v23, v53
v_mfma_f32_16x16x32_bf16 v[164:167], a[12:15], a[112:115], v[164:167]
s_waitcnt lgkmcnt(4)
v_mul_f32 v54, v23, v54
v_mul_f32 v55, v23, v55
v_mfma_f32_16x16x32_bf16 v[164:167], a[8:11], a[96:99], v[164:167]
buffer_load_dwordx4 v12, s[64:67], s62 offen offset:2048 lds
v_mfma_f32_16x16x32_bf16 v[192:195], a[16:19], a[96:99], v[192:195]
ds_read_b64_tr_b16 a[8:9], v5 offset:17152
v_mul_f32 v56, v20, v56
v_mfma_f32_16x16x32_bf16 v[192:195], a[20:23], a[112:115], v[192:195]
ds_read_b64_tr_b16 a[10:11], v5 offset:21248
v_mul_f32 v57, v20, v57
v_mfma_f32_16x16x32_bf16 v[200:203], a[20:23], a[116:119], v[200:203]
ds_read_b64_tr_b16 a[12:13], v5 offset:25344
v_mul_f32 v58, v20, v58
v_mfma_f32_16x16x32_bf16 v[200:203], a[16:19], a[100:103], v[200:203]
ds_read_b64_tr_b16 a[14:15], v5 offset:29440
v_mul_f32 v59, v20, v59
v_mfma_f32_16x16x32_bf16 v[208:211], a[16:19], a[104:107], v[208:211]
buffer_load_dwordx4 v13, s[64:67], s62 offen offset:3072 lds
v_mfma_f32_16x16x32_bf16 v[208:211], a[20:23], a[120:123], v[208:211]
s_add_u32 s60, s60, s58
s_and_b32 s60, s60, 0x1c000
s_or_b32 s60, s60, 0x20000
v_mfma_f32_16x16x32_bf16 v[216:219], a[20:23], a[124:127], v[216:219]
s_add_u32 s101, s63, s60
v_mul_f32 v64, v21, v64
v_mul_f32 v65, v21, v65
v_mfma_f32_16x16x32_bf16 v[216:219], a[16:19], a[108:111], v[216:219]
v_mul_f32 v66, v21, v66
v_mul_f32 v67, v21, v67
v_mfma_f32_16x16x32_bf16 v[220:223], a[24:27], a[108:111], v[220:223]
buffer_load_dwordx4 a[192:195], v3, s[88:91], s101 offen sc1
v_mfma_f32_16x16x32_bf16 v[220:223], a[28:31], a[124:127], v[220:223]
ds_read_b64_tr_b16 a[16:17], v4 offset:16384
v_mul_f32 v72, v22, v72
v_mfma_f32_16x16x32_bf16 v[212:215], a[28:31], a[120:123], v[212:215]
ds_read_b64_tr_b16 a[18:19], v4 offset:20480
v_mul_f32 v73, v22, v73
v_mfma_f32_16x16x32_bf16 v[212:215], a[24:27], a[104:107], v[212:215]
ds_read_b64_tr_b16 a[20:21], v4 offset:24576
v_mul_f32 v74, v22, v74
v_mfma_f32_16x16x32_bf16 v[204:207], a[24:27], a[100:103], v[204:207]
ds_read_b64_tr_b16 a[22:23], v4 offset:28672
v_mul_f32 v75, v22, v75
v_mfma_f32_16x16x32_bf16 v[204:207], a[28:31], a[116:119], v[204:207]
buffer_load_dwordx4 a[196:199], v3, s[88:91], s101 offen offset:1024 sc1
v_mfma_f32_16x16x32_bf16 v[196:199], a[28:31], a[112:115], v[196:199]
v_mul_f32 v80, v23, v80
v_mul_f32 v81, v23, v81
v_mfma_f32_16x16x32_bf16 v[196:199], a[24:27], a[96:99], v[196:199]
s_waitcnt lgkmcnt(4)
v_mul_f32 v82, v23, v82
v_mul_f32 v83, v23, v83
v_mfma_f32_16x16x32_bf16 v[224:227], a[0:3], a[96:99], v[224:227]
ds_read_b64_tr_b16 a[24:25], v5 offset:16384
v_mul_f32 v60, v20, v60
v_mfma_f32_16x16x32_bf16 v[224:227], a[4:7], a[112:115], v[224:227]
buffer_load_dwordx4 a[200:203], v3, s[88:91], s101 offen offset:2048 sc1
v_mfma_f32_16x16x32_bf16 v[232:235], a[4:7], a[116:119], v[232:235]
ds_read_b64_tr_b16 a[26:27], v5 offset:20480
v_mul_f32 v61, v20, v61
v_mfma_f32_16x16x32_bf16 v[232:235], a[0:3], a[100:103], v[232:235]
ds_read_b64_tr_b16 a[28:29], v5 offset:24576
v_mul_f32 v62, v20, v62
v_mfma_f32_16x16x32_bf16 v[240:243], a[0:3], a[104:107], v[240:243]
ds_read_b64_tr_b16 a[30:31], v5 offset:28672
v_mul_f32 v63, v20, v63
v_mfma_f32_16x16x32_bf16 v[240:243], a[4:7], a[120:123], v[240:243]
v_mul_f32 v68, v21, v68
v_mul_f32 v69, v21, v69
v_mfma_f32_16x16x32_bf16 v[248:251], a[4:7], a[124:127], v[248:251]
s_waitcnt vmcnt(15)
v_mul_f32 v70, v21, v70
v_mul_f32 v71, v21, v71
v_mfma_f32_16x16x32_bf16 v[248:251], a[0:3], a[108:111], v[248:251]
s_barrier
v_mul_f32 v76, v22, v76
v_mul_f32 v77, v22, v77
v_mfma_f32_16x16x32_bf16 v[252:255], a[8:11], a[108:111], v[252:255]
buffer_load_dwordx4 a[204:207], v3, s[88:91], s101 offen offset:3072 sc1
v_mfma_f32_16x16x32_bf16 v[252:255], a[12:15], a[124:127], v[252:255]
ds_read_b64_tr_b16 a[0:1], v4 offset:33024
s_add_u32 s101, s101, 0x2000
v_mfma_f32_16x16x32_bf16 v[244:247], a[12:15], a[120:123], v[244:247]
ds_read_b64_tr_b16 a[2:3], v4 offset:37120
v_mul_f32 v78, v22, v78
v_mfma_f32_16x16x32_bf16 v[244:247], a[8:11], a[104:107], v[244:247]
ds_read_b64_tr_b16 a[4:5], v4 offset:41216
v_mul_f32 v79, v22, v79
v_mfma_f32_16x16x32_bf16 v[236:239], a[8:11], a[100:103], v[236:239]
buffer_load_dwordx4 a[208:211], v3, s[88:91], s101 offen sc1
v_mfma_f32_16x16x32_bf16 v[236:239], a[12:15], a[116:119], v[236:239]
ds_read_b64_tr_b16 a[6:7], v4 offset:45312
v_mul_f32 v84, v23, v84
v_mfma_f32_16x16x32_bf16 v[228:231], a[12:15], a[112:115], v[228:231]
s_waitcnt lgkmcnt(4)
v_mul_f32 v85, v23, v85
v_mul_f32 v86, v23, v86
v_mfma_f32_16x16x32_bf16 v[228:231], a[8:11], a[96:99], v[228:231]
buffer_load_dwordx4 a[212:215], v3, s[88:91], s101 offen offset:1024 sc1
v_mfma_f32_16x16x32_bf16 a[32:35], a[16:19], a[96:99], a[32:35]
ds_read_b64_tr_b16 a[8:9], v5 offset:33024
v_mul_f32 v87, v23, v87
v_mfma_f32_16x16x32_bf16 a[32:35], a[20:23], a[112:115], a[32:35]
ds_read_b64_tr_b16 a[10:11], v5 offset:37120
v_mul_f32 v88, v20, v88
v_mfma_f32_16x16x32_bf16 a[40:43], a[20:23], a[116:119], a[40:43]
ds_read_b64_tr_b16 a[12:13], v5 offset:41216
v_mul_f32 v89, v20, v89
v_mfma_f32_16x16x32_bf16 a[40:43], a[16:19], a[100:103], a[40:43]
ds_read_b64_tr_b16 a[14:15], v5 offset:45312
v_mul_f32 v90, v20, v90
v_mfma_f32_16x16x32_bf16 a[48:51], a[16:19], a[104:107], a[48:51]
buffer_load_dwordx4 a[216:219], v3, s[88:91], s101 offen offset:2048 sc1
v_mfma_f32_16x16x32_bf16 a[48:51], a[20:23], a[120:123], a[48:51]
v_mul_f32 v91, v20, v91
v_mul_f32 v96, v21, v96
v_mfma_f32_16x16x32_bf16 v[152:155], a[20:23], a[124:127], v[152:155]
v_mul_f32 v97, v21, v97
v_mul_f32 v98, v21, v98
v_mfma_f32_16x16x32_bf16 v[152:155], a[16:19], a[108:111], v[152:155]
v_mul_f32 v99, v21, v99
v_mul_f32 v104, v22, v104
v_mfma_f32_16x16x32_bf16 v[156:159], a[24:27], a[108:111], v[156:159]
buffer_load_dwordx4 a[220:223], v3, s[88:91], s101 offen offset:3072 sc1
v_mfma_f32_16x16x32_bf16 v[156:159], a[28:31], a[124:127], v[156:159]
ds_read_b64_tr_b16 a[16:17], v4 offset:33280
s_add_u32 m0, s17, 0x20000
v_mfma_f32_16x16x32_bf16 a[52:55], a[28:31], a[120:123], a[52:55]
ds_read_b64_tr_b16 a[18:19], v4 offset:37376
s_lshl_b32 s61, s60, 3
v_mfma_f32_16x16x32_bf16 a[52:55], a[24:27], a[104:107], a[52:55]
ds_read_b64_tr_b16 a[20:21], v4 offset:41472
s_add_u32 s62, s61, s12
v_mfma_f32_16x16x32_bf16 a[44:47], a[24:27], a[100:103], a[44:47]
ds_read_b64_tr_b16 a[22:23], v4 offset:45568
v_mul_f32 v105, v22, v105
v_mfma_f32_16x16x32_bf16 a[44:47], a[28:31], a[116:119], a[44:47]
buffer_load_dwordx4 v12, s[64:67], s61 offen lds
v_mfma_f32_16x16x32_bf16 a[36:39], a[28:31], a[112:115], a[36:39]
v_mul_f32 v106, v22, v106
v_mul_f32 v107, v22, v107
v_mfma_f32_16x16x32_bf16 a[36:39], a[24:27], a[96:99], a[36:39]
s_waitcnt lgkmcnt(4)
v_mul_f32 v112, v23, v112
v_mul_f32 v113, v23, v113
v_mfma_f32_16x16x32_bf16 v[160:163], a[0:3], a[128:131], v[160:163]
ds_read_b64_tr_b16 a[24:25], v5 offset:33280
v_mul_f32 v114, v23, v114
v_mfma_f32_16x16x32_bf16 v[160:163], a[4:7], a[144:147], v[160:163]
ds_read_b64_tr_b16 a[26:27], v5 offset:37376
v_mul_f32 v115, v23, v115
v_mfma_f32_16x16x32_bf16 v[168:171], a[4:7], a[148:151], v[168:171]
buffer_load_dwordx4 v13, s[64:67], s61 offen offset:1024 lds
v_mfma_f32_16x16x32_bf16 v[168:171], a[0:3], a[132:135], v[168:171]
ds_read_b64_tr_b16 a[28:29], v5 offset:41472
v_mul_f32 v92, v20, v92
v_mfma_f32_16x16x32_bf16 v[176:179], a[0:3], a[136:139], v[176:179]
ds_read_b64_tr_b16 a[30:31], v5 offset:45568
v_mul_f32 v93, v20, v93
v_mfma_f32_16x16x32_bf16 v[176:179], a[4:7], a[152:155], v[176:179]
L_padC1:
s_cmp_eq_u32 s95, 1
s_cbranch_scc1 L_padC3
v_mul_f32 v94, v20, v94
v_mul_f32 v95, v20, v95
v_mfma_f32_16x16x32_bf16 v[184:187], a[4:7], a[156:159], v[184:187]
buffer_load_dwordx4 v12, s[64:67], s62 offen offset:2048 lds
v_mfma_f32_16x16x32_bf16 v[184:187], a[0:3], a[140:143], v[184:187]
v_mul_f32 v100, v21, v100
v_mul_f32 v101, v21, v101
v_mfma_f32_16x16x32_bf16 v[188:191], a[8:11], a[140:143], v[188:191]
ds_read_b64_tr_b16 a[0:1], v4 offset:33536
v_mul_f32 v102, v21, v102
v_mfma_f32_16x16x32_bf16 v[188:191], a[12:15], a[156:159], v[188:191]
ds_read_b64_tr_b16 a[2:3], v4 offset:37632
v_mul_f32 v103, v21, v103
v_mfma_f32_16x16x32_bf16 v[180:183], a[12:15], a[152:155], v[180:183]
ds_read_b64_tr_b16 a[4:5], v4 offset:41728
v_mul_f32 v108, v22, v108
v_mfma_f32_16x16x32_bf16 v[180:183], a[8:11], a[136:139], v[180:183]
buffer_load_dwordx4 v13, s[64:67], s62 offen offset:3072 lds
v_mfma_f32_16x16x32_bf16 v[172:175], a[8:11], a[132:135], v[172:175]
ds_read_b64_tr_b16 a[6:7], v4 offset:45824
s_add_u32 s60, s60, s59
v_mfma_f32_16x16x32_bf16 v[172:175], a[12:15], a[148:151], v[172:175]
s_and_b32 s60, s60, 0x1c000
s_or_b32 s60, s60, 0x20000
s_add_u32 s101, s63, s60
v_mfma_f32_16x16x32_bf16 v[164:167], a[12:15], a[144:147], v[164:167]
s_waitcnt lgkmcnt(4)
v_mul_f32 v109, v22, v109
v_mul_f32 v110, v22, v110
v_mfma_f32_16x16x32_bf16 v[164:167], a[8:11], a[128:131], v[164:167]
buffer_load_dwordx4 a[224:227], v3, s[88:91], s101 offen sc1
v_mfma_f32_16x16x32_bf16 v[192:195], a[16:19], a[128:131], v[192:195]
ds_read_b64_tr_b16 a[8:9], v5 offset:33536
v_mul_f32 v111, v22, v111
v_mfma_f32_16x16x32_bf16 v[192:195], a[20:23], a[144:147], v[192:195]
ds_read_b64_tr_b16 a[10:11], v5 offset:37632
v_mul_f32 v116, v23, v116
v_mfma_f32_16x16x32_bf16 v[200:203], a[20:23], a[148:151], v[200:203]
ds_read_b64_tr_b16 a[12:13], v5 offset:41728
v_mul_f32 v117, v23, v117
v_mfma_f32_16x16x32_bf16 v[200:203], a[16:19], a[132:135], v[200:203]
ds_read_b64_tr_b16 a[14:15], v5 offset:45824
v_mul_f32 v118, v23, v118
v_mfma_f32_16x16x32_bf16 v[208:211], a[16:19], a[136:139], v[208:211]
buffer_load_dwordx4 a[228:231], v3, s[88:91], s101 offen offset:1024 sc1
v_mfma_f32_16x16x32_bf16 v[208:211], a[20:23], a[152:155], v[208:211]
v_mul_f32 v119, v23, v119
v_mul_f32 v120, v20, v120
v_mfma_f32_16x16x32_bf16 v[216:219], a[20:23], a[156:159], v[216:219]
buffer_load_dword v14, v1, s[88:91], s24 offen sc1
v_mfma_f32_16x16x32_bf16 v[216:219], a[16:19], a[140:143], v[216:219]
v_mul_f32 v121, v20, v121
v_mul_f32 v122, v20, v122
v_mfma_f32_16x16x32_bf16 v[220:223], a[24:27], a[140:143], v[220:223]
ds_read_b64_tr_b16 a[16:17], v4 offset:32768
v_mul_f32 v123, v20, v123
v_mfma_f32_16x16x32_bf16 v[220:223], a[28:31], a[156:159], v[220:223]
buffer_load_dwordx4 a[232:235], v3, s[88:91], s101 offen offset:2048 sc1
v_mfma_f32_16x16x32_bf16 v[212:215], a[28:31], a[152:155], v[212:215]
ds_read_b64_tr_b16 a[18:19], v4 offset:36864
v_mul_f32 v128, v21, v128
v_mfma_f32_16x16x32_bf16 v[212:215], a[24:27], a[136:139], v[212:215]
ds_read_b64_tr_b16 a[20:21], v4 offset:40960
v_mul_f32 v129, v21, v129
v_mfma_f32_16x16x32_bf16 v[204:207], a[24:27], a[132:135], v[204:207]
ds_read_b64_tr_b16 a[22:23], v4 offset:45056
v_mul_f32 v130, v21, v130
v_mfma_f32_16x16x32_bf16 v[204:207], a[28:31], a[148:151], v[204:207]
buffer_load_dwordx4 a[236:239], v3, s[88:91], s101 offen offset:3072 sc1
v_mfma_f32_16x16x32_bf16 v[196:199], a[28:31], a[144:147], v[196:199]
s_add_u32 s101, s101, 0x2000
v_mul_f32 v131, v21, v131
v_mul_f32 v136, v22, v136
v_mfma_f32_16x16x32_bf16 v[196:199], a[24:27], a[128:131], v[196:199]
s_waitcnt lgkmcnt(4)
v_mul_f32 v137, v22, v137
v_mul_f32 v138, v22, v138
v_mfma_f32_16x16x32_bf16 v[224:227], a[0:3], a[128:131], v[224:227]
ds_read_b64_tr_b16 a[24:25], v5 offset:32768
v_mul_f32 v139, v22, v139
v_mfma_f32_16x16x32_bf16 v[224:227], a[4:7], a[144:147], v[224:227]
ds_read_b64_tr_b16 a[26:27], v5 offset:36864
v_mul_f32 v144, v23, v144
v_mfma_f32_16x16x32_bf16 v[232:235], a[4:7], a[148:151], v[232:235]
buffer_load_dwordx4 a[240:243], v3, s[88:91], s101 offen sc1
v_mfma_f32_16x16x32_bf16 v[232:235], a[0:3], a[132:135], v[232:235]
ds_read_b64_tr_b16 a[28:29], v5 offset:40960
v_mul_f32 v145, v23, v145
v_mfma_f32_16x16x32_bf16 v[240:243], a[0:3], a[136:139], v[240:243]
ds_read_b64_tr_b16 a[30:31], v5 offset:45056
v_mul_f32 v146, v23, v146
v_mfma_f32_16x16x32_bf16 v[240:243], a[4:7], a[152:155], v[240:243]
v_mul_f32 v147, v23, v147
v_mul_f32 v124, v20, v124
v_mfma_f32_16x16x32_bf16 v[248:251], a[4:7], a[156:159], v[248:251]
s_waitcnt vmcnt(18)
v_mul_f32 v125, v20, v125
v_mul_f32 v126, v20, v126
v_mfma_f32_16x16x32_bf16 v[248:251], a[0:3], a[140:143], v[248:251]
s_barrier
v_mul_f32 v127, v20, v127
v_mul_f32 v132, v21, v132
v_mfma_f32_16x16x32_bf16 v[252:255], a[8:11], a[140:143], v[252:255]
buffer_load_dwordx4 a[244:247], v3, s[88:91], s101 offen offset:1024 sc1
v_mfma_f32_16x16x32_bf16 v[252:255], a[12:15], a[156:159], v[252:255]
ds_read_b64_tr_b16 a[0:1], v4 offset:49408
v_mul_f32 v133, v21, v133
v_mfma_f32_16x16x32_bf16 v[244:247], a[12:15], a[152:155], v[244:247]
ds_read_b64_tr_b16 a[2:3], v4 offset:53504
v_mul_f32 v134, v21, v134
v_mfma_f32_16x16x32_bf16 v[244:247], a[8:11], a[136:139], v[244:247]
buffer_load_dwordx4 a[248:251], v3, s[88:91], s101 offen offset:2048 sc1
v_mfma_f32_16x16x32_bf16 v[236:239], a[8:11], a[132:135], v[236:239]
ds_read_b64_tr_b16 a[4:5], v4 offset:57600
v_mul_f32 v135, v21, v135
v_mfma_f32_16x16x32_bf16 v[236:239], a[12:15], a[148:151], v[236:239]
ds_read_b64_tr_b16 a[6:7], v4 offset:61696
v_mul_f32 v140, v22, v140
v_mfma_f32_16x16x32_bf16 v[228:231], a[12:15], a[144:147], v[228:231]
v_mul_f32 v141, v22, v141
v_mul_f32 v142, v22, v142
v_mfma_f32_16x16x32_bf16 v[228:231], a[8:11], a[128:131], v[228:231]
s_waitcnt lgkmcnt(4)
v_mul_f32 v143, v22, v143
v_mul_f32 v148, v23, v148
v_mfma_f32_16x16x32_bf16 a[32:35], a[16:19], a[128:131], a[32:35]
buffer_load_dwordx4 a[252:255], v3, s[88:91], s101 offen offset:3072 sc1
v_mfma_f32_16x16x32_bf16 a[32:35], a[20:23], a[144:147], a[32:35]
ds_read_b64_tr_b16 a[8:9], v5 offset:49408
s_add_u32 m0, s17, 0x24000
v_mfma_f32_16x16x32_bf16 a[40:43], a[20:23], a[148:151], a[40:43]
ds_read_b64_tr_b16 a[10:11], v5 offset:53504
s_lshl_b32 s61, s60, 3
v_mfma_f32_16x16x32_bf16 a[40:43], a[16:19], a[132:135], a[40:43]
ds_read_b64_tr_b16 a[12:13], v5 offset:57600
s_add_u32 s62, s61, s12
v_mfma_f32_16x16x32_bf16 a[48:51], a[16:19], a[136:139], a[48:51]
buffer_load_dwordx4 v12, s[64:67], s61 offen lds
v_mfma_f32_16x16x32_bf16 a[48:51], a[20:23], a[152:155], a[48:51]
ds_read_b64_tr_b16 a[14:15], v5 offset:61696
v_mul_f32 v149, v23, v149
v_mfma_f32_16x16x32_bf16 v[152:155], a[20:23], a[156:159], v[152:155]
v_mul_f32 v150, v23, v150
v_mul_f32 v151, v23, v151
v_mfma_f32_16x16x32_bf16 v[152:155], a[16:19], a[140:143], v[152:155]
v_mfma_f32_16x16x32_bf16 v[156:159], a[24:27], a[140:143], v[156:159]
ds_read_b64_tr_b16 a[16:17], v4 offset:49664
v_mfma_f32_16x16x32_bf16 v[156:159], a[28:31], a[156:159], v[156:159]
buffer_load_dwordx4 v13, s[64:67], s61 offen offset:1024 lds
v_mfma_f32_16x16x32_bf16 a[52:55], a[28:31], a[152:155], a[52:55]
ds_read_b64_tr_b16 a[18:19], v4 offset:53760
v_mfma_f32_16x16x32_bf16 a[52:55], a[24:27], a[136:139], a[52:55]
ds_read_b64_tr_b16 a[20:21], v4 offset:57856
v_mfma_f32_16x16x32_bf16 a[44:47], a[24:27], a[132:135], a[44:47]
ds_read_b64_tr_b16 a[22:23], v4 offset:61952
v_mfma_f32_16x16x32_bf16 a[44:47], a[28:31], a[148:151], a[44:47]
buffer_load_dwordx4 v12, s[64:67], s62 offen offset:2048 lds
v_mfma_f32_16x16x32_bf16 a[36:39], a[28:31], a[144:147], a[36:39]
v_mfma_f32_16x16x32_bf16 a[36:39], a[24:27], a[128:131], a[36:39]
s_waitcnt lgkmcnt(4)
v_mfma_f32_16x16x32_bf16 v[160:163], a[0:3], a[160:163], v[160:163]
ds_read_b64_tr_b16 a[24:25], v5 offset:49664
v_mfma_f32_16x16x32_bf16 v[160:163], a[4:7], a[176:179], v[160:163]
ds_read_b64_tr_b16 a[26:27], v5 offset:53760
v_mfma_f32_16x16x32_bf16 v[168:171], a[4:7], a[180:183], v[168:171]
buffer_load_dwordx4 v13, s[64:67], s62 offen offset:3072 lds
v_mfma_f32_16x16x32_bf16 v[168:171], a[0:3], a[164:167], v[168:171]
ds_read_b64_tr_b16 a[28:29], v5 offset:57856
s_add_u32 s60, s60, s56
v_mfma_f32_16x16x32_bf16 v[176:179], a[0:3], a[168:171], v[176:179]
ds_read_b64_tr_b16 a[30:31], v5 offset:61952
s_and_b32 s60, s60, 0x1c000
v_mfma_f32_16x16x32_bf16 v[176:179], a[4:7], a[184:187], v[176:179]
s_add_u32 s101, s63, s60
v_mfma_f32_16x16x32_bf16 v[184:187], a[4:7], a[188:191], v[184:187]
s_waitcnt vmcnt(10)
s_mov_b32 s92, 200000
L_spin_db:
v_cmp_eq_u32 vcc, 0, v14
s_nop 4
s_cbranch_vccz L_spun_db
s_sub_u32 s92, s92, 1
s_cbranch_scc1 L_spun_db
s_sleep 6
buffer_load_dword v14, v1, s[88:91], s24 offen sc1
s_waitcnt vmcnt(0)
s_branch L_spin_db
L_spun_db:
v_mfma_f32_16x16x32_bf16 v[184:187], a[0:3], a[172:175], v[184:187]
buffer_load_dwordx4 a[64:67], v3, s[88:91], s101 offen sc1
v_mfma_f32_16x16x32_bf16 v[188:191], a[8:11], a[172:175], v[188:191]
ds_read_b64_tr_b16 a[0:1], v4 offset:49920
v_mfma_f32_16x16x32_bf16 v[188:191], a[12:15], a[188:191], v[188:191]
ds_read_b64_tr_b16 a[2:3], v4 offset:54016
v_mfma_f32_16x16x32_bf16 v[180:183], a[12:15], a[184:187], v[180:183]
ds_read_b64_tr_b16 a[4:5], v4 offset:58112
v_mfma_f32_16x16x32_bf16 v[180:183], a[8:11], a[168:171], v[180:183]
buffer_load_dwordx4 a[68:71], v3, s[88:91], s101 offen offset:1024 sc1
v_mfma_f32_16x16x32_bf16 v[172:175], a[8:11], a[164:167], v[172:175]
ds_read_b64_tr_b16 a[6:7], v4 offset:62208
v_mfma_f32_16x16x32_bf16 v[172:175], a[12:15], a[180:183], v[172:175]
v_mfma_f32_16x16x32_bf16 v[164:167], a[12:15], a[176:179], v[164:167]
v_mfma_f32_16x16x32_bf16 v[164:167], a[8:11], a[160:163], v[164:167]
s_waitcnt lgkmcnt(4)
v_mfma_f32_16x16x32_bf16 v[192:195], a[16:19], a[160:163], v[192:195]
buffer_load_dwordx4 a[72:75], v3, s[88:91], s101 offen offset:2048 sc1
v_mfma_f32_16x16x32_bf16 v[192:195], a[20:23], a[176:179], v[192:195]
ds_read_b64_tr_b16 a[8:9], v5 offset:49920
v_mfma_f32_16x16x32_bf16 v[200:203], a[20:23], a[180:183], v[200:203]
ds_read_b64_tr_b16 a[10:11], v5 offset:54016
v_mfma_f32_16x16x32_bf16 v[200:203], a[16:19], a[164:167], v[200:203]
ds_read_b64_tr_b16 a[12:13], v5 offset:58112
v_mfma_f32_16x16x32_bf16 v[208:211], a[16:19], a[168:171], v[208:211]
buffer_load_dwordx4 a[76:79], v3, s[88:91], s101 offen offset:3072 sc1
v_mfma_f32_16x16x32_bf16 v[208:211], a[20:23], a[184:187], v[208:211]
ds_read_b64_tr_b16 a[14:15], v5 offset:62208
s_add_u32 s101, s101, 0x2000
v_mfma_f32_16x16x32_bf16 v[216:219], a[20:23], a[188:191], v[216:219]
v_mfma_f32_16x16x32_bf16 v[216:219], a[16:19], a[172:175], v[216:219]
v_mfma_f32_16x16x32_bf16 v[220:223], a[24:27], a[172:175], v[220:223]
ds_read_b64_tr_b16 a[16:17], v4 offset:49152
v_mfma_f32_16x16x32_bf16 v[220:223], a[28:31], a[188:191], v[220:223]
buffer_load_dwordx4 a[80:83], v3, s[88:91], s101 offen sc1
v_mfma_f32_16x16x32_bf16 v[212:215], a[28:31], a[184:187], v[212:215]
ds_read_b64_tr_b16 a[18:19], v4 offset:53248
v_mfma_f32_16x16x32_bf16 v[212:215], a[24:27], a[168:171], v[212:215]
ds_read_b64_tr_b16 a[20:21], v4 offset:57344
v_mfma_f32_16x16x32_bf16 v[204:207], a[24:27], a[164:167], v[204:207]
ds_read_b64_tr_b16 a[22:23], v4 offset:61440
v_mfma_f32_16x16x32_bf16 v[204:207], a[28:31], a[180:183], v[204:207]
v_mfma_f32_16x16x32_bf16 v[196:199], a[28:31], a[176:179], v[196:199]
buffer_load_dwordx4 a[84:87], v3, s[88:91], s101 offen offset:1024 sc1
v_mfma_f32_16x16x32_bf16 v[196:199], a[24:27], a[160:163], v[196:199]
s_waitcnt lgkmcnt(4)
v_mfma_f32_16x16x32_bf16 v[224:227], a[0:3], a[160:163], v[224:227]
ds_read_b64_tr_b16 a[24:25], v5 offset:49152
v_mfma_f32_16x16x32_bf16 v[224:227], a[4:7], a[176:179], v[224:227]
ds_read_b64_tr_b16 a[26:27], v5 offset:53248
v_mfma_f32_16x16x32_bf16 v[232:235], a[4:7], a[180:183], v[232:235]
buffer_load_dwordx4 a[88:91], v3, s[88:91], s101 offen offset:2048 sc1
v_mfma_f32_16x16x32_bf16 v[232:235], a[0:3], a[164:167], v[232:235]
ds_read_b64_tr_b16 a[28:29], v5 offset:57344
v_mfma_f32_16x16x32_bf16 v[240:243], a[0:3], a[168:171], v[240:243]
ds_read_b64_tr_b16 a[30:31], v5 offset:61440
v_mfma_f32_16x16x32_bf16 v[240:243], a[4:7], a[184:187], v[240:243]
v_mfma_f32_16x16x32_bf16 v[248:251], a[4:7], a[188:191], v[248:251]
s_waitcnt vmcnt(20)
v_mfma_f32_16x16x32_bf16 v[248:251], a[0:3], a[172:175], v[248:251]
s_barrier
v_mfma_f32_16x16x32_bf16 v[252:255], a[8:11], a[172:175], v[252:255]
buffer_load_dwordx4 a[92:95], v3, s[88:91], s101 offen offset:3072 sc1
v_mfma_f32_16x16x32_bf16 v[252:255], a[12:15], a[188:191], v[252:255]
ds_read_b64_tr_b16 a[0:1], v15 offset:256
s_add_u32 m0, s17, 0x10000
v_mfma_f32_16x16x32_bf16 v[244:247], a[12:15], a[184:187], v[244:247]
ds_read_b64_tr_b16 a[2:3], v15 offset:4352
s_lshl_b32 s61, s60, 3
v_mfma_f32_16x16x32_bf16 v[244:247], a[8:11], a[168:171], v[244:247]
ds_read_b64_tr_b16 a[4:5], v15 offset:8448
s_add_u32 s62, s61, s12
v_mfma_f32_16x16x32_bf16 v[236:239], a[8:11], a[164:167], v[236:239]
buffer_load_dwordx4 v12, s[64:67], s61 offen lds
v_mfma_f32_16x16x32_bf16 v[236:239], a[12:15], a[180:183], v[236:239]
ds_read_b64_tr_b16 a[6:7], v15 offset:12544
v_mfma_f32_16x16x32_bf16 v[228:231], a[12:15], a[176:179], v[228:231]
v_mfma_f32_16x16x32_bf16 v[228:231], a[8:11], a[160:163], v[228:231]
s_waitcnt lgkmcnt(4)
v_mfma_f32_16x16x32_bf16 a[32:35], a[16:19], a[160:163], a[32:35]
buffer_load_dwordx4 v13, s[64:67], s61 offen offset:1024 lds
v_mfma_f32_16x16x32_bf16 a[32:35], a[20:23], a[176:179], a[32:35]
ds_read_b64_tr_b16 a[8:9], v19 offset:256
v_mfma_f32_16x16x32_bf16 a[40:43], a[20:23], a[180:183], a[40:43]
ds_read_b64_tr_b16 a[10:11], v19 offset:4352
v_mfma_f32_16x16x32_bf16 a[40:43], a[16:19], a[164:167], a[40:43]
ds_read_b64_tr_b16 a[12:13], v19 offset:8448
v_mfma_f32_16x16x32_bf16 a[48:51], a[16:19], a[168:171], a[48:51]
ds_read_b64_tr_b16 a[14:15], v19 offset:12544
v_mfma_f32_16x16x32_bf16 a[48:51], a[20:23], a[184:187], a[48:51]
buffer_load_dwordx4 v12, s[64:67], s62 offen offset:2048 lds
v_mfma_f32_16x16x32_bf16 v[152:155], a[20:23], a[188:191], v[152:155]
v_mfma_f32_16x16x32_bf16 v[152:155], a[16:19], a[172:175], v[152:155]
v_mfma_f32_16x16x32_bf16 v[156:159], a[24:27], a[172:175], v[156:159]
ds_read_b64_tr_b16 a[16:17], v15 offset:512
v_mfma_f32_16x16x32_bf16 v[156:159], a[28:31], a[188:191], v[156:159]
buffer_load_dwordx4 v13, s[64:67], s62 offen offset:3072 lds
v_mfma_f32_16x16x32_bf16 a[52:55], a[28:31], a[184:187], a[52:55]
ds_read_b64_tr_b16 a[18:19], v15 offset:4608
s_add_u32 s60, s60, s57
v_mfma_f32_16x16x32_bf16 a[52:55], a[24:27], a[168:171], a[52:55]
ds_read_b64_tr_b16 a[20:21], v15 offset:8704
s_and_b32 s60, s60, 0x1c000
v_mfma_f32_16x16x32_bf16 a[44:47], a[24:27], a[164:167], a[44:47]
ds_read_b64_tr_b16 a[22:23], v15 offset:12800
s_add_u32 s101, s63, s60
v_mfma_f32_16x16x32_bf16 a[44:47], a[28:31], a[180:183], a[44:47]
v_mfma_f32_16x16x32_bf16 a[36:39], a[28:31], a[176:179], a[36:39]
buffer_load_dwordx4 a[96:99], v3, s[88:91], s101 offen sc1
v_mfma_f32_16x16x32_bf16 a[36:39], a[24:27], a[160:163], a[36:39]
s_waitcnt lgkmcnt(4)
v_mfma_f32_16x16x32_bf16 v[160:163], a[0:3], a[192:195], v[160:163]
ds_read_b64_tr_b16 a[24:25], v19 offset:512
v_mfma_f32_16x16x32_bf16 v[160:163], a[4:7], a[208:211], v[160:163]
ds_read_b64_tr_b16 a[26:27], v19 offset:4608
v_mfma_f32_16x16x32_bf16 v[168:171], a[4:7], a[212:215], v[168:171]
buffer_load_dwordx4 a[100:103], v3, s[88:91], s101 offen offset:1024 sc1
v_mfma_f32_16x16x32_bf16 v[168:171], a[0:3], a[196:199], v[168:171]
ds_read_b64_tr_b16 a[28:29], v19 offset:8704
v_mfma_f32_16x16x32_bf16 v[176:179], a[0:3], a[200:203], v[176:179]
ds_read_b64_tr_b16 a[30:31], v19 offset:12800
v_mfma_f32_16x16x32_bf16 v[176:179], a[4:7], a[216:219], v[176:179]
v_mfma_f32_16x16x32_bf16 v[184:187], a[4:7], a[220:223], v[184:187]
v_mfma_f32_16x16x32_bf16 v[184:187], a[0:3], a[204:207], v[184:187]
buffer_load_dwordx4 a[104:107], v3, s[88:91], s101 offen offset:2048 sc1
v_mfma_f32_16x16x32_bf16 v[188:191], a[8:11], a[204:207], v[188:191]
ds_read_b64_tr_b16 a[0:1], v15 offset:768
v_mfma_f32_16x16x32_bf16 v[188:191], a[12:15], a[220:223], v[188:191]
ds_read_b64_tr_b16 a[2:3], v15 offset:4864
v_mfma_f32_16x16x32_bf16 v[180:183], a[12:15], a[216:219], v[180:183]
ds_read_b64_tr_b16 a[4:5], v15 offset:8960
v_mfma_f32_16x16x32_bf16 v[180:183], a[8:11], a[200:203], v[180:183]
ds_read_b64_tr_b16 a[6:7], v15 offset:13056
v_mfma_f32_16x16x32_bf16 v[172:175], a[8:11], a[196:199], v[172:175]
buffer_load_dwordx4 a[108:111], v3, s[88:91], s101 offen offset:3072 sc1
v_mfma_f32_16x16x32_bf16 v[172:175], a[12:15], a[212:215], v[172:175]
s_add_u32 s101, s101, 0x2000
v_mfma_f32_16x16x32_bf16 v[164:167], a[12:15], a[208:211], v[164:167]
v_mfma_f32_16x16x32_bf16 v[164:167], a[8:11], a[192:195], v[164:167]
s_waitcnt lgkmcnt(4)
v_mfma_f32_16x16x32_bf16 v[192:195], a[16:19], a[192:195], v[192:195]
buffer_load_dwordx4 a[112:115], v3, s[88:91], s101 offen sc1
v_mfma_f32_16x16x32_bf16 v[192:195], a[20:23], a[208:211], v[192:195]
ds_read_b64_tr_b16 a[8:9], v19 offset:768
v_mfma_f32_16x16x32_bf16 v[200:203], a[20:23], a[212:215], v[200:203]
ds_read_b64_tr_b16 a[10:11], v19 offset:4864
v_mfma_f32_16x16x32_bf16 v[200:203], a[16:19], a[196:199], v[200:203]
ds_read_b64_tr_b16 a[12:13], v19 offset:8960
v_mfma_f32_16x16x32_bf16 v[208:211], a[16:19], a[200:203], v[208:211]
ds_read_b64_tr_b16 a[14:15], v19 offset:13056
v_mfma_f32_16x16x32_bf16 v[208:211], a[20:23], a[216:219], v[208:211]
buffer_load_dwordx4 a[116:119], v3, s[88:91], s101 offen offset:1024 sc1
v_mfma_f32_16x16x32_bf16 v[216:219], a[20:23], a[220:223], v[216:219]
v_mfma_f32_16x16x32_bf16 v[216:219], a[16:19], a[204:207], v[216:219]
v_mfma_f32_16x16x32_bf16 v[220:223], a[24:27], a[204:207], v[220:223]
ds_read_b64_tr_b16 a[16:17], v15 offset:0
v_mfma_f32_16x16x32_bf16 v[220:223], a[28:31], a[220:223], v[220:223]
buffer_load_dwordx4 a[120:123], v3, s[88:91], s101 offen offset:2048 sc1
v_mfma_f32_16x16x32_bf16 v[212:215], a[28:31], a[216:219], v[212:215]
ds_read_b64_tr_b16 a[18:19], v15 offset:4096
v_mfma_f32_16x16x32_bf16 v[212:215], a[24:27], a[200:203], v[212:215]
ds_read_b64_tr_b16 a[20:21], v15 offset:8192
v_mfma_f32_16x16x32_bf16 v[204:207], a[24:27], a[196:199], v[204:207]
ds_read_b64_tr_b16 a[22:23], v15 offset:12288
v_mfma_f32_16x16x32_bf16 v[204:207], a[28:31], a[212:215], v[204:207]
v_mfma_f32_16x16x32_bf16 v[196:199], a[28:31], a[208:211], v[196:199]
buffer_load_dwordx4 a[124:127], v3, s[88:91], s101 offen offset:3072 sc1
v_mfma_f32_16x16x32_bf16 v[196:199], a[24:27], a[192:195], v[196:199]
s_waitcnt lgkmcnt(4)
s_add_u32 m0, s17, 0x14000
s_lshl_b32 s61, s60, 3
v_mfma_f32_16x16x32_bf16 v[224:227], a[0:3], a[192:195], v[224:227]
ds_read_b64_tr_b16 a[24:25], v19 offset:0
s_add_u32 s62, s61, s12
v_mfma_f32_16x16x32_bf16 v[224:227], a[4:7], a[208:211], v[224:227]
ds_read_b64_tr_b16 a[26:27], v19 offset:4096
v_mfma_f32_16x16x32_bf16 v[232:235], a[4:7], a[212:215], v[232:235]
ds_read_b64_tr_b16 a[28:29], v19 offset:8192
v_mfma_f32_16x16x32_bf16 v[232:235], a[0:3], a[196:199], v[232:235]
buffer_load_dwordx4 v12, s[64:67], s61 offen lds
v_mfma_f32_16x16x32_bf16 v[240:243], a[0:3], a[200:203], v[240:243]
ds_read_b64_tr_b16 a[30:31], v19 offset:12288
v_mfma_f32_16x16x32_bf16 v[240:243], a[4:7], a[216:219], v[240:243]
v_mfma_f32_16x16x32_bf16 v[248:251], a[4:7], a[220:223], v[248:251]
s_waitcnt vmcnt(21)
v_mfma_f32_16x16x32_bf16 v[248:251], a[0:3], a[204:207], v[248:251]
s_barrier
v_mfma_f32_16x16x32_bf16 v[252:255], a[8:11], a[204:207], v[252:255]
buffer_load_dwordx4 v13, s[64:67], s61 offen offset:1024 lds
v_mfma_f32_16x16x32_bf16 v[252:255], a[12:15], a[220:223], v[252:255]
ds_read_b64_tr_b16 a[0:1], v15 offset:16640
v_mfma_f32_16x16x32_bf16 v[244:247], a[12:15], a[216:219], v[244:247]
ds_read_b64_tr_b16 a[2:3], v15 offset:20736
v_mfma_f32_16x16x32_bf16 v[244:247], a[8:11], a[200:203], v[244:247]
ds_read_b64_tr_b16 a[4:5], v15 offset:24832
v_mfma_f32_16x16x32_bf16 v[236:239], a[8:11], a[196:199], v[236:239]
buffer_load_dwordx4 v12, s[64:67], s62 offen offset:2048 lds
v_mfma_f32_16x16x32_bf16 v[236:239], a[12:15], a[212:215], v[236:239]
ds_read_b64_tr_b16 a[6:7], v15 offset:28928
v_mfma_f32_16x16x32_bf16 v[228:231], a[12:15], a[208:211], v[228:231]
v_mfma_f32_16x16x32_bf16 v[228:231], a[8:11], a[192:195], v[228:231]
s_waitcnt lgkmcnt(4)
v_mfma_f32_16x16x32_bf16 a[32:35], a[16:19], a[192:195], a[32:35]
buffer_load_dwordx4 v13, s[64:67], s62 offen offset:3072 lds
v_mfma_f32_16x16x32_bf16 a[32:35], a[20:23], a[208:211], a[32:35]
ds_read_b64_tr_b16 a[8:9], v19 offset:16640
s_add_u32 s60, s60, s58
v_mfma_f32_16x16x32_bf16 a[40:43], a[20:23], a[212:215], a[40:43]
ds_read_b64_tr_b16 a[10:11], v19 offset:20736
s_and_b32 s60, s60, 0x1c000
v_mfma_f32_16x16x32_bf16 a[40:43], a[16:19], a[196:199], a[40:43]
ds_read_b64_tr_b16 a[12:13], v19 offset:24832
s_add_u32 s101, s63, s60
v_mfma_f32_16x16x32_bf16 a[48:51], a[16:19], a[200:203], a[48:51]
ds_read_b64_tr_b16 a[14:15], v19 offset:28928
v_mfma_f32_16x16x32_bf16 a[48:51], a[20:23], a[216:219], a[48:51]
buffer_load_dwordx4 a[128:131], v3, s[88:91], s101 offen sc1
v_mfma_f32_16x16x32_bf16 v[152:155], a[20:23], a[220:223], v[152:155]
v_mfma_f32_16x16x32_bf16 v[152:155], a[16:19], a[204:207], v[152:155]
v_mfma_f32_16x16x32_bf16 v[156:159], a[24:27], a[204:207], v[156:159]
ds_read_b64_tr_b16 a[16:17], v15 offset:16896
v_mfma_f32_16x16x32_bf16 v[156:159], a[28:31], a[220:223], v[156:159]
ds_read_b64_tr_b16 a[18:19], v15 offset:20992
v_mfma_f32_16x16x32_bf16 a[52:55], a[28:31], a[216:219], a[52:55]
buffer_load_dwordx4 a[132:135], v3, s[88:91], s101 offen offset:1024 sc1
v_mfma_f32_16x16x32_bf16 a[52:55], a[24:27], a[200:203], a[52:55]
ds_read_b64_tr_b16 a[20:21], v15 offset:25088
v_mfma_f32_16x16x32_bf16 a[44:47], a[24:27], a[196:199], a[44:47]
ds_read_b64_tr_b16 a[22:23], v15 offset:29184
v_mfma_f32_16x16x32_bf16 a[44:47], a[28:31], a[212:215], a[44:47]
v_mfma_f32_16x16x32_bf16 a[36:39], a[28:31], a[208:211], a[36:39]
buffer_load_dwordx4 a[136:139], v3, s[88:91], s101 offen offset:2048 sc1
v_mfma_f32_16x16x32_bf16 a[36:39], a[24:27], a[192:195], a[36:39]
s_waitcnt lgkmcnt(4)
v_mfma_f32_16x16x32_bf16 v[160:163], a[0:3], a[224:227], v[160:163]
ds_read_b64_tr_b16 a[24:25], v19 offset:16896
v_mfma_f32_16x16x32_bf16 v[160:163], a[4:7], a[240:243], v[160:163]
ds_read_b64_tr_b16 a[26:27], v19 offset:20992
v_mfma_f32_16x16x32_bf16 v[168:171], a[4:7], a[244:247], v[168:171]
ds_read_b64_tr_b16 a[28:29], v19 offset:25088
v_mfma_f32_16x16x32_bf16 v[168:171], a[0:3], a[228:231], v[168:171]
buffer_load_dwordx4 a[140:143], v3, s[88:91], s101 offen offset:3072 sc1
v_mfma_f32_16x16x32_bf16 v[176:179], a[0:3], a[232:235], v[176:179]
ds_read_b64_tr_b16 a[30:31], v19 offset:29184
s_add_u32 s101, s101, 0x2000
v_mfma_f32_16x16x32_bf16 v[176:179], a[4:7], a[248:251], v[176:179]
v_mfma_f32_16x16x32_bf16 v[184:187], a[4:7], a[252:255], v[184:187]
v_mfma_f32_16x16x32_bf16 v[184:187], a[0:3], a[236:239], v[184:187]
buffer_load_dwordx4 a[144:147], v3, s[88:91], s101 offen sc1
v_mfma_f32_16x16x32_bf16 v[188:191], a[8:11], a[236:239], v[188:191]
ds_read_b64_tr_b16 a[0:1], v15 offset:17152
v_mfma_f32_16x16x32_bf16 v[188:191], a[12:15], a[252:255], v[188:191]
ds_read_b64_tr_b16 a[2:3], v15 offset:21248
v_mfma_f32_16x16x32_bf16 v[180:183], a[12:15], a[248:251], v[180:183]
ds_read_b64_tr_b16 a[4:5], v15 offset:25344
v_mfma_f32_16x16x32_bf16 v[180:183], a[8:11], a[232:235], v[180:183]
ds_read_b64_tr_b16 a[6:7], v15 offset:29440
v_mfma_f32_16x16x32_bf16 v[172:175], a[8:11], a[228:231], v[172:175]
buffer_load_dwordx4 a[148:151], v3, s[88:91], s101 offen offset:1024 sc1
v_mfma_f32_16x16x32_bf16 v[172:175], a[12:15], a[244:247], v[172:175]
v_mfma_f32_16x16x32_bf16 v[164:167], a[12:15], a[240:243], v[164:167]
v_mfma_f32_16x16x32_bf16 v[164:167], a[8:11], a[224:227], v[164:167]
s_waitcnt lgkmcnt(4)
v_mfma_f32_16x16x32_bf16 v[192:195], a[16:19], a[224:227], v[192:195]
ds_read_b64_tr_b16 a[8:9], v19 offset:17152
v_mfma_f32_16x16x32_bf16 v[192:195], a[20:23], a[240:243], v[192:195]
buffer_load_dwordx4 a[152:155], v3, s[88:91], s101 offen offset:2048 sc1
v_mfma_f32_16x16x32_bf16 v[200:203], a[20:23], a[244:247], v[200:203]
ds_read_b64_tr_b16 a[10:11], v19 offset:21248
v_mfma_f32_16x16x32_bf16 v[200:203], a[16:19], a[228:231], v[200:203]
ds_read_b64_tr_b16 a[12:13], v19 offset:25344
v_mfma_f32_16x16x32_bf16 v[208:211], a[16:19], a[232:235], v[208:211]
ds_read_b64_tr_b16 a[14:15], v19 offset:29440
v_mfma_f32_16x16x32_bf16 v[208:211], a[20:23], a[248:251], v[208:211]
buffer_load_dwordx4 a[156:159], v3, s[88:91], s101 offen offset:3072 sc1
v_mfma_f32_16x16x32_bf16 v[216:219], a[20:23], a[252:255], v[216:219]
s_add_u32 m0, s17, 0x18000
s_lshl_b32 s61, s60, 3
s_add_u32 s62, s61, s12
v_mfma_f32_16x16x32_bf16 v[216:219], a[16:19], a[236:239], v[216:219]
v_mfma_f32_16x16x32_bf16 v[220:223], a[24:27], a[236:239], v[220:223]
ds_read_b64_tr_b16 a[16:17], v15 offset:16384
v_mfma_f32_16x16x32_bf16 v[220:223], a[28:31], a[252:255], v[220:223]
ds_read_b64_tr_b16 a[18:19], v15 offset:20480
v_mfma_f32_16x16x32_bf16 v[212:215], a[28:31], a[248:251], v[212:215]
buffer_load_dwordx4 v12, s[64:67], s61 offen lds
v_mfma_f32_16x16x32_bf16 v[212:215], a[24:27], a[232:235], v[212:215]
ds_read_b64_tr_b16 a[20:21], v15 offset:24576
v_mfma_f32_16x16x32_bf16 v[204:207], a[24:27], a[228:231], v[204:207]
ds_read_b64_tr_b16 a[22:23], v15 offset:28672
v_mfma_f32_16x16x32_bf16 v[204:207], a[28:31], a[244:247], v[204:207]
v_mfma_f32_16x16x32_bf16 v[196:199], a[28:31], a[240:243], v[196:199]
buffer_load_dwordx4 v13, s[64:67], s61 offen offset:1024 lds
v_mfma_f32_16x16x32_bf16 v[196:199], a[24:27], a[224:227], v[196:199]
s_waitcnt lgkmcnt(4)
v_mfma_f32_16x16x32_bf16 v[224:227], a[0:3], a[224:227], v[224:227]
ds_read_b64_tr_b16 a[24:25], v19 offset:16384
v_mfma_f32_16x16x32_bf16 v[224:227], a[4:7], a[240:243], v[224:227]
ds_read_b64_tr_b16 a[26:27], v19 offset:20480
v_mfma_f32_16x16x32_bf16 v[232:235], a[4:7], a[244:247], v[232:235]
ds_read_b64_tr_b16 a[28:29], v19 offset:24576
v_mfma_f32_16x16x32_bf16 v[232:235], a[0:3], a[228:231], v[232:235]
buffer_load_dwordx4 v12, s[64:67], s62 offen offset:2048 lds
v_mfma_f32_16x16x32_bf16 v[240:243], a[0:3], a[232:235], v[240:243]
ds_read_b64_tr_b16 a[30:31], v19 offset:28672
v_mfma_f32_16x16x32_bf16 v[240:243], a[4:7], a[248:251], v[240:243]
v_mfma_f32_16x16x32_bf16 v[248:251], a[4:7], a[252:255], v[248:251]
s_waitcnt vmcnt(23)
v_mfma_f32_16x16x32_bf16 v[248:251], a[0:3], a[236:239], v[248:251]
s_barrier
v_mfma_f32_16x16x32_bf16 v[252:255], a[8:11], a[236:239], v[252:255]
buffer_load_dwordx4 v13, s[64:67], s62 offen offset:3072 lds
v_mfma_f32_16x16x32_bf16 v[252:255], a[12:15], a[252:255], v[252:255]
ds_read_b64_tr_b16 a[0:1], v4 offset:256
s_add_u32 s60, s60, s59
v_mfma_f32_16x16x32_bf16 v[244:247], a[12:15], a[248:251], v[244:247]
ds_read_b64_tr_b16 a[2:3], v4 offset:4352
s_and_b32 s60, s60, 0x1c000
v_mfma_f32_16x16x32_bf16 v[244:247], a[8:11], a[232:235], v[244:247]
ds_read_b64_tr_b16 a[4:5], v4 offset:8448
s_add_u32 s101, s63, s60
v_mfma_f32_16x16x32_bf16 v[236:239], a[8:11], a[228:231], v[236:239]
buffer_load_dwordx4 a[160:163], v3, s[88:91], s101 offen sc1
v_mfma_f32_16x16x32_bf16 v[236:239], a[12:15], a[244:247], v[236:239]
ds_read_b64_tr_b16 a[6:7], v4 offset:12544
s_lshl_b32 s11, s6, 2
v_mfma_f32_16x16x32_bf16 v[228:231], a[12:15], a[240:243], v[228:231]
s_lshr_b32 s10, s5, 4
s_lshl_b32 s10, s10, 1
s_add_u32 s11, s11, s10
v_mfma_f32_16x16x32_bf16 v[228:231], a[8:11], a[224:227], v[228:231]
s_waitcnt lgkmcnt(4)
s_lshl_b32 s11, s11, 6
s_and_b32 s10, s5, 3
v_mfma_f32_16x16x32_bf16 a[32:35], a[16:19], a[224:227], a[32:35]
ds_read_b64_tr_b16 a[8:9], v5 offset:256
s_add_u32 s11, s11, s10
v_mfma_f32_16x16x32_bf16 a[32:35], a[20:23], a[240:243], a[32:35]
buffer_load_dwordx4 a[164:167], v3, s[88:91], s101 offen offset:1024 sc1
v_mfma_f32_16x16x32_bf16 a[40:43], a[20:23], a[244:247], a[40:43]
ds_read_b64_tr_b16 a[10:11], v5 offset:4352
s_lshl_b32 s11, s11, 2
v_mfma_f32_16x16x32_bf16 a[40:43], a[16:19], a[228:231], a[40:43]
ds_read_b64_tr_b16 a[12:13], v5 offset:8448
s_add_u32 s11, s11, 0x3704000
v_mfma_f32_16x16x32_bf16 a[48:51], a[16:19], a[232:235], a[48:51]
ds_read_b64_tr_b16 a[14:15], v5 offset:12544
v_and_b32 v7, 1, v0
v_mfma_f32_16x16x32_bf16 a[48:51], a[20:23], a[248:251], a[48:51]
buffer_load_dwordx4 a[168:171], v3, s[88:91], s101 offen offset:2048 sc1
v_mfma_f32_16x16x32_bf16 v[152:155], a[20:23], a[252:255], v[152:155]
v_lshlrev_b32 v7, 4, v7
v_and_b32 v1, 2, v0
v_mfma_f32_16x16x32_bf16 v[152:155], a[16:19], a[236:239], v[152:155]
v_lshl_add_u32 v7, v1, 7, v7
v_min_u32 v1, 2, v0
v_mfma_f32_16x16x32_bf16 v[156:159], a[24:27], a[236:239], v[156:159]
ds_read_b64_tr_b16 a[16:17], v4 offset:512
v_lshlrev_b32 v1, 22, v1
v_mfma_f32_16x16x32_bf16 v[156:159], a[28:31], a[252:255], v[156:159]
ds_read_b64_tr_b16 a[18:19], v4 offset:4608
v_add_u32 v1, 4092, v1
v_mfma_f32_16x16x32_bf16 a[52:55], a[28:31], a[248:251], a[52:55]
buffer_load_dwordx4 a[172:175], v3, s[88:91], s101 offen offset:3072 sc1
v_mfma_f32_16x16x32_bf16 a[52:55], a[24:27], a[232:235], a[52:55]
ds_read_b64_tr_b16 a[20:21], v4 offset:8704
s_add_u32 s101, s101, 0x2000
v_mfma_f32_16x16x32_bf16 a[44:47], a[24:27], a[228:231], a[44:47]
ds_read_b64_tr_b16 a[22:23], v4 offset:12800
v_mfma_f32_16x16x32_bf16 a[44:47], a[28:31], a[244:247], a[44:47]
v_mfma_f32_16x16x32_bf16 a[36:39], a[28:31], a[240:243], a[36:39]
s_waitcnt lgkmcnt(4)
v_mfma_f32_16x16x32_bf16 a[36:39], a[24:27], a[224:227], a[36:39]
buffer_load_dwordx4 a[176:179], v3, s[88:91], s101 offen sc1
v_mfma_f32_16x16x32_bf16 v[160:163], a[0:3], a[64:67], v[160:163]
ds_read_b64_tr_b16 a[24:25], v5 offset:512
v_mfma_f32_16x16x32_bf16 v[160:163], a[4:7], a[80:83], v[160:163]
ds_read_b64_tr_b16 a[26:27], v5 offset:4608
v_mfma_f32_16x16x32_bf16 v[168:171], a[4:7], a[84:87], v[168:171]
ds_read_b64_tr_b16 a[28:29], v5 offset:8704
v_mfma_f32_16x16x32_bf16 v[168:171], a[0:3], a[68:71], v[168:171]
buffer_load_dwordx4 a[180:183], v3, s[88:91], s101 offen offset:1024 sc1
v_mfma_f32_16x16x32_bf16 v[176:179], a[0:3], a[72:75], v[176:179]
ds_read_b64_tr_b16 a[30:31], v5 offset:12800
v_mfma_f32_16x16x32_bf16 v[176:179], a[4:7], a[88:91], v[176:179]
L_padC2:
s_cmp_eq_u32 s95, 1
s_cbranch_scc1 L_padC4
v_mfma_f32_16x16x32_bf16 v[184:187], a[4:7], a[92:95], v[184:187]
v_mfma_f32_16x16x32_bf16 v[184:187], a[0:3], a[76:79], v[184:187]
v_mfma_f32_16x16x32_bf16 v[188:191], a[8:11], a[76:79], v[188:191]
buffer_load_dwordx4 a[184:187], v3, s[88:91], s101 offen offset:2048 sc1
v_mfma_f32_16x16x32_bf16 v[188:191], a[12:15], a[92:95], v[188:191]
ds_read_b64_tr_b16 a[0:1], v4 offset:768
v_mfma_f32_16x16x32_bf16 v[180:183], a[12:15], a[88:91], v[180:183]
ds_read_b64_tr_b16 a[2:3], v4 offset:4864
v_mfma_f32_16x16x32_bf16 v[180:183], a[8:11], a[72:75], v[180:183]
ds_read_b64_tr_b16 a[4:5], v4 offset:8960
v_mfma_f32_16x16x32_bf16 v[172:175], a[8:11], a[68:71], v[172:175]
buffer_load_dwordx4 a[188:191], v3, s[88:91], s101 offen offset:3072 sc1
v_mfma_f32_16x16x32_bf16 v[172:175], a[12:15], a[84:87], v[172:175]
ds_read_b64_tr_b16 a[6:7], v4 offset:13056
s_add_u32 m0, s17, 0x1c000
v_mfma_f32_16x16x32_bf16 v[164:167], a[12:15], a[80:83], v[164:167]
s_lshl_b32 s61, s60, 3
s_add_u32 s62, s61, s12
v_mfma_f32_16x16x32_bf16 v[164:167], a[8:11], a[64:67], v[164:167]
s_waitcnt lgkmcnt(4)
v_mfma_f32_16x16x32_bf16 v[192:195], a[16:19], a[64:67], v[192:195]
ds_read_b64_tr_b16 a[8:9], v5 offset:768
v_mfma_f32_16x16x32_bf16 v[192:195], a[20:23], a[80:83], v[192:195]
buffer_load_dwordx4 v12, s[64:67], s61 offen lds
v_mfma_f32_16x16x32_bf16 v[200:203], a[20:23], a[84:87], v[200:203]
ds_read_b64_tr_b16 a[10:11], v5 offset:4864
v_mfma_f32_16x16x32_bf16 v[200:203], a[16:19], a[68:71], v[200:203]
ds_read_b64_tr_b16 a[12:13], v5 offset:8960
v_mfma_f32_16x16x32_bf16 v[208:211], a[16:19], a[72:75], v[208:211]
ds_read_b64_tr_b16 a[14:15], v5 offset:13056
v_mfma_f32_16x16x32_bf16 v[208:211], a[20:23], a[88:91], v[208:211]
v_mfma_f32_16x16x32_bf16 v[216:219], a[20:23], a[92:95], v[216:219]
buffer_load_dwordx4 v13, s[64:67], s61 offen offset:1024 lds
v_mfma_f32_16x16x32_bf16 v[216:219], a[16:19], a[76:79], v[216:219]
v_mfma_f32_16x16x32_bf16 v[220:223], a[24:27], a[76:79], v[220:223]
ds_read_b64_tr_b16 a[16:17], v4 offset:0
v_mfma_f32_16x16x32_bf16 v[220:223], a[28:31], a[92:95], v[220:223]
ds_read_b64_tr_b16 a[18:19], v4 offset:4096
v_mfma_f32_16x16x32_bf16 v[212:215], a[28:31], a[88:91], v[212:215]
buffer_load_dwordx4 v12, s[64:67], s62 offen offset:2048 lds
v_mfma_f32_16x16x32_bf16 v[212:215], a[24:27], a[72:75], v[212:215]
ds_read_b64_tr_b16 a[20:21], v4 offset:8192
v_mfma_f32_16x16x32_bf16 v[204:207], a[24:27], a[68:71], v[204:207]
ds_read_b64_tr_b16 a[22:23], v4 offset:12288
v_mfma_f32_16x16x32_bf16 v[204:207], a[28:31], a[84:87], v[204:207]
v_mfma_f32_16x16x32_bf16 v[196:199], a[28:31], a[80:83], v[196:199]
s_waitcnt lgkmcnt(4)
v_mfma_f32_16x16x32_bf16 v[196:199], a[24:27], a[64:67], v[196:199]
buffer_load_dwordx4 v13, s[64:67], s62 offen offset:3072 lds
v_mfma_f32_16x16x32_bf16 v[224:227], a[0:3], a[64:67], v[224:227]
ds_read_b64_tr_b16 a[24:25], v5 offset:0
s_add_u32 s60, s60, s56
v_mfma_f32_16x16x32_bf16 v[224:227], a[4:7], a[80:83], v[224:227]
ds_read_b64_tr_b16 a[26:27], v5 offset:4096
s_and_b32 s60, s60, 0x1c000
v_mfma_f32_16x16x32_bf16 v[232:235], a[4:7], a[84:87], v[232:235]
ds_read_b64_tr_b16 a[28:29], v5 offset:8192
s_add_u32 s101, s63, s60
v_mfma_f32_16x16x32_bf16 v[232:235], a[0:3], a[68:71], v[232:235]
buffer_load_dwordx4 a[192:195], v3, s[88:91], s101 offen sc1
v_mfma_f32_16x16x32_bf16 v[240:243], a[0:3], a[72:75], v[240:243]
ds_read_b64_tr_b16 a[30:31], v5 offset:12288
v_mfma_f32_16x16x32_bf16 v[240:243], a[4:7], a[88:91], v[240:243]
v_mfma_f32_16x16x32_bf16 v[248:251], a[4:7], a[92:95], v[248:251]
s_waitcnt vmcnt(25)
v_mfma_f32_16x16x32_bf16 v[248:251], a[0:3], a[76:79], v[248:251]
s_barrier
v_mfma_f32_16x16x32_bf16 v[252:255], a[8:11], a[76:79], v[252:255]
buffer_load_dwordx4 a[196:199], v3, s[88:91], s101 offen offset:1024 sc1
v_mfma_f32_16x16x32_bf16 v[252:255], a[12:15], a[92:95], v[252:255]
ds_read_b64_tr_b16 a[0:1], v4 offset:16640
v_mfma_f32_16x16x32_bf16 v[244:247], a[12:15], a[88:91], v[244:247]
ds_read_b64_tr_b16 a[2:3], v4 offset:20736
v_mfma_f32_16x16x32_bf16 v[244:247], a[8:11], a[72:75], v[244:247]
ds_read_b64_tr_b16 a[4:5], v4 offset:24832
v_mfma_f32_16x16x32_bf16 v[236:239], a[8:11], a[68:71], v[236:239]
ds_read_b64_tr_b16 a[6:7], v4 offset:28928
v_mfma_f32_16x16x32_bf16 v[236:239], a[12:15], a[84:87], v[236:239]
buffer_load_dwordx4 a[200:203], v3, s[88:91], s101 offen offset:2048 sc1
v_mfma_f32_16x16x32_bf16 v[228:231], a[12:15], a[80:83], v[228:231]
v_mfma_f32_16x16x32_bf16 v[228:231], a[8:11], a[64:67], v[228:231]
s_waitcnt lgkmcnt(4)
v_mfma_f32_16x16x32_bf16 a[32:35], a[16:19], a[64:67], a[32:35]
ds_read_b64_tr_b16 a[8:9], v5 offset:16640
v_mfma_f32_16x16x32_bf16 a[32:35], a[20:23], a[80:83], a[32:35]
buffer_load_dwordx4 a[204:207], v3, s[88:91], s101 offen offset:3072 sc1
v_mfma_f32_16x16x32_bf16 a[40:43], a[20:23], a[84:87], a[40:43]
ds_read_b64_tr_b16 a[10:11], v5 offset:20736
s_add_u32 s101, s101, 0x2000
v_mfma_f32_16x16x32_bf16 a[40:43], a[16:19], a[68:71], a[40:43]
ds_read_b64_tr_b16 a[12:13], v5 offset:24832
v_mfma_f32_16x16x32_bf16 a[48:51], a[16:19], a[72:75], a[48:51]
ds_read_b64_tr_b16 a[14:15], v5 offset:28928
v_mfma_f32_16x16x32_bf16 a[48:51], a[20:23], a[88:91], a[48:51]
v_mfma_f32_16x16x32_bf16 v[152:155], a[20:23], a[92:95], v[152:155]
buffer_load_dwordx4 a[208:211], v3, s[88:91], s101 offen sc1
v_mfma_f32_16x16x32_bf16 v[152:155], a[16:19], a[76:79], v[152:155]
v_mfma_f32_16x16x32_bf16 v[156:159], a[24:27], a[76:79], v[156:159]
ds_read_b64_tr_b16 a[16:17], v4 offset:16896
v_mfma_f32_16x16x32_bf16 v[156:159], a[28:31], a[92:95], v[156:159]
ds_read_b64_tr_b16 a[18:19], v4 offset:20992
v_mfma_f32_16x16x32_bf16 a[52:55], a[28:31], a[88:91], a[52:55]
buffer_load_dwordx4 a[212:215], v3, s[88:91], s101 offen offset:1024 sc1
v_mfma_f32_16x16x32_bf16 a[52:55], a[24:27], a[72:75], a[52:55]
ds_read_b64_tr_b16 a[20:21], v4 offset:25088
v_mfma_f32_16x16x32_bf16 a[44:47], a[24:27], a[68:71], a[44:47]
ds_read_b64_tr_b16 a[22:23], v4 offset:29184
v_mfma_f32_16x16x32_bf16 a[44:47], a[28:31], a[84:87], a[44:47]
v_mfma_f32_16x16x32_bf16 a[36:39], a[28:31], a[80:83], a[36:39]
s_waitcnt lgkmcnt(4)
v_mfma_f32_16x16x32_bf16 a[36:39], a[24:27], a[64:67], a[36:39]
buffer_load_dwordx4 a[216:219], v3, s[88:91], s101 offen offset:2048 sc1
v_mfma_f32_16x16x32_bf16 v[160:163], a[0:3], a[96:99], v[160:163]
ds_read_b64_tr_b16 a[24:25], v5 offset:16896
v_mfma_f32_16x16x32_bf16 v[160:163], a[4:7], a[112:115], v[160:163]
ds_read_b64_tr_b16 a[26:27], v5 offset:20992
v_mfma_f32_16x16x32_bf16 v[168:171], a[4:7], a[116:119], v[168:171]
ds_read_b64_tr_b16 a[28:29], v5 offset:25088
v_mfma_f32_16x16x32_bf16 v[168:171], a[0:3], a[100:103], v[168:171]
ds_read_b64_tr_b16 a[30:31], v5 offset:29184
v_mfma_f32_16x16x32_bf16 v[176:179], a[0:3], a[104:107], v[176:179]
buffer_load_dwordx4 a[220:223], v3, s[88:91], s101 offen offset:3072 sc1
v_mfma_f32_16x16x32_bf16 v[176:179], a[4:7], a[120:123], v[176:179]
s_add_u32 m0, s17, 0x20000
s_lshl_b32 s61, s60, 3
s_add_u32 s62, s61, s12
v_mfma_f32_16x16x32_bf16 v[184:187], a[4:7], a[124:127], v[184:187]
v_mfma_f32_16x16x32_bf16 v[184:187], a[0:3], a[108:111], v[184:187]
v_mfma_f32_16x16x32_bf16 v[188:191], a[8:11], a[108:111], v[188:191]
buffer_load_dwordx4 v12, s[64:67], s61 offen lds
v_mfma_f32_16x16x32_bf16 v[188:191], a[12:15], a[124:127], v[188:191]
ds_read_b64_tr_b16 a[0:1], v4 offset:17152
v_mfma_f32_16x16x32_bf16 v[180:183], a[12:15], a[120:123], v[180:183]
ds_read_b64_tr_b16 a[2:3], v4 offset:21248
v_mfma_f32_16x16x32_bf16 v[180:183], a[8:11], a[104:107], v[180:183]
ds_read_b64_tr_b16 a[4:5], v4 offset:25344
v_mfma_f32_16x16x32_bf16 v[172:175], a[8:11], a[100:103], v[172:175]
ds_read_b64_tr_b16 a[6:7], v4 offset:29440
v_mfma_f32_16x16x32_bf16 v[172:175], a[12:15], a[116:119], v[172:175]
buffer_load_dwordx4 v13, s[64:67], s61 offen offset:1024 lds
v_mfma_f32_16x16x32_bf16 v[164:167], a[12:15], a[112:115], v[164:167]
v_mfma_f32_16x16x32_bf16 v[164:167], a[8:11], a[96:99], v[164:167]
s_waitcnt lgkmcnt(4)
v_mfma_f32_16x16x32_bf16 v[192:195], a[16:19], a[96:99], v[192:195]
ds_read_b64_tr_b16 a[8:9], v5 offset:17152
v_mfma_f32_16x16x32_bf16 v[192:195], a[20:23], a[112:115], v[192:195]
buffer_load_dwordx4 v12, s[64:67], s62 offen offset:2048 lds
v_mfma_f32_16x16x32_bf16 v[200:203], a[20:23], a[116:119], v[200:203]
ds_read_b64_tr_b16 a[10:11], v5 offset:21248
v_mfma_f32_16x16x32_bf16 v[200:203], a[16:19], a[100:103], v[200:203]
ds_read_b64_tr_b16 a[12:13], v5 offset:25344
v_mfma_f32_16x16x32_bf16 v[208:211], a[16:19], a[104:107], v[208:211]
ds_read_b64_tr_b16 a[14:15], v5 offset:29440
v_mfma_f32_16x16x32_bf16 v[208:211], a[20:23], a[120:123], v[208:211]
v_mfma_f32_16x16x32_bf16 v[216:219], a[20:23], a[124:127], v[216:219]
buffer_load_dwordx4 v13, s[64:67], s62 offen offset:3072 lds
v_mfma_f32_16x16x32_bf16 v[216:219], a[16:19], a[108:111], v[216:219]
s_add_u32 s60, s60, s57
s_and_b32 s60, s60, 0x1c000
s_add_u32 s101, s63, s60
v_mfma_f32_16x16x32_bf16 v[220:223], a[24:27], a[108:111], v[220:223]
ds_read_b64_tr_b16 a[16:17], v4 offset:16384
v_mfma_f32_16x16x32_bf16 v[220:223], a[28:31], a[124:127], v[220:223]
ds_read_b64_tr_b16 a[18:19], v4 offset:20480
v_mfma_f32_16x16x32_bf16 v[212:215], a[28:31], a[120:123], v[212:215]
ds_read_b64_tr_b16 a[20:21], v4 offset:24576
v_mfma_f32_16x16x32_bf16 v[212:215], a[24:27], a[104:107], v[212:215]
buffer_load_dwordx4 a[224:227], v3, s[88:91], s101 offen sc1
v_mfma_f32_16x16x32_bf16 v[204:207], a[24:27], a[100:103], v[204:207]
ds_read_b64_tr_b16 a[22:23], v4 offset:28672
v_mfma_f32_16x16x32_bf16 v[204:207], a[28:31], a[116:119], v[204:207]
v_mfma_f32_16x16x32_bf16 v[196:199], a[28:31], a[112:115], v[196:199]
s_waitcnt lgkmcnt(4)
v_mfma_f32_16x16x32_bf16 v[196:199], a[24:27], a[96:99], v[196:199]
buffer_load_dwordx4 a[228:231], v3, s[88:91], s101 offen offset:1024 sc1
v_mfma_f32_16x16x32_bf16 v[224:227], a[0:3], a[96:99], v[224:227]
ds_read_b64_tr_b16 a[24:25], v5 offset:16384
v_mfma_f32_16x16x32_bf16 v[224:227], a[4:7], a[112:115], v[224:227]
ds_read_b64_tr_b16 a[26:27], v5 offset:20480
v_mfma_f32_16x16x32_bf16 v[232:235], a[4:7], a[116:119], v[232:235]
ds_read_b64_tr_b16 a[28:29], v5 offset:24576
v_mfma_f32_16x16x32_bf16 v[232:235], a[0:3], a[100:103], v[232:235]
ds_read_b64_tr_b16 a[30:31], v5 offset:28672
v_mfma_f32_16x16x32_bf16 v[240:243], a[0:3], a[104:107], v[240:243]
buffer_load_dwordx4 a[232:235], v3, s[88:91], s101 offen offset:2048 sc1
v_mfma_f32_16x16x32_bf16 v[240:243], a[4:7], a[120:123], v[240:243]
v_mfma_f32_16x16x32_bf16 v[248:251], a[4:7], a[124:127], v[248:251]
s_waitcnt vmcnt(27)
v_mfma_f32_16x16x32_bf16 v[248:251], a[0:3], a[108:111], v[248:251]
s_barrier
v_mfma_f32_16x16x32_bf16 v[252:255], a[8:11], a[108:111], v[252:255]
buffer_load_dwordx4 a[236:239], v3, s[88:91], s101 offen offset:3072 sc1
v_mfma_f32_16x16x32_bf16 v[252:255], a[12:15], a[124:127], v[252:255]
ds_read_b64_tr_b16 a[0:1], v4 offset:33024
s_add_u32 s101, s101, 0x2000
v_mfma_f32_16x16x32_bf16 v[244:247], a[12:15], a[120:123], v[244:247]
ds_read_b64_tr_b16 a[2:3], v4 offset:37120
v_mfma_f32_16x16x32_bf16 v[244:247], a[8:11], a[104:107], v[244:247]
ds_read_b64_tr_b16 a[4:5], v4 offset:41216
v_mfma_f32_16x16x32_bf16 v[236:239], a[8:11], a[100:103], v[236:239]
ds_read_b64_tr_b16 a[6:7], v4 offset:45312
v_mfma_f32_16x16x32_bf16 v[236:239], a[12:15], a[116:119], v[236:239]
buffer_load_dwordx4 a[240:243], v3, s[88:91], s101 offen sc1
v_mfma_f32_16x16x32_bf16 v[228:231], a[12:15], a[112:115], v[228:231]
v_mfma_f32_16x16x32_bf16 v[228:231], a[8:11], a[96:99], v[228:231]
s_waitcnt lgkmcnt(4)
v_mfma_f32_16x16x32_bf16 a[32:35], a[16:19], a[96:99], a[32:35]
ds_read_b64_tr_b16 a[8:9], v5 offset:33024
v_mfma_f32_16x16x32_bf16 a[32:35], a[20:23], a[112:115], a[32:35]
ds_read_b64_tr_b16 a[10:11], v5 offset:37120
v_mfma_f32_16x16x32_bf16 a[40:43], a[20:23], a[116:119], a[40:43]
buffer_load_dwordx4 a[244:247], v3, s[88:91], s101 offen offset:1024 sc1
v_mfma_f32_16x16x32_bf16 a[40:43], a[16:19], a[100:103], a[40:43]
ds_read_b64_tr_b16 a[12:13], v5 offset:41216
v_mfma_f32_16x16x32_bf16 a[48:51], a[16:19], a[104:107], a[48:51]
ds_read_b64_tr_b16 a[14:15], v5 offset:45312
v_mfma_f32_16x16x32_bf16 a[48:51], a[20:23], a[120:123], a[48:51]
v_mfma_f32_16x16x32_bf16 v[152:155], a[20:23], a[124:127], v[152:155]
buffer_load_dwordx4 a[248:251], v3, s[88:91], s101 offen offset:2048 sc1
v_mfma_f32_16x16x32_bf16 v[152:155], a[16:19], a[108:111], v[152:155]
v_mfma_f32_16x16x32_bf16 v[156:159], a[24:27], a[108:111], v[156:159]
ds_read_b64_tr_b16 a[16:17], v4 offset:33280
v_mfma_f32_16x16x32_bf16 v[156:159], a[28:31], a[124:127], v[156:159]
ds_read_b64_tr_b16 a[18:19], v4 offset:37376
v_mfma_f32_16x16x32_bf16 a[52:55], a[28:31], a[120:123], a[52:55]
ds_read_b64_tr_b16 a[20:21], v4 offset:41472
v_mfma_f32_16x16x32_bf16 a[52:55], a[24:27], a[104:107], a[52:55]
buffer_load_dwordx4 a[252:255], v3, s[88:91], s101 offen offset:3072 sc1
v_mfma_f32_16x16x32_bf16 a[44:47], a[24:27], a[100:103], a[44:47]
ds_read_b64_tr_b16 a[22:23], v4 offset:45568
s_add_u32 m0, s17, 0x24000
v_mfma_f32_16x16x32_bf16 a[44:47], a[28:31], a[116:119], a[44:47]
s_lshl_b32 s61, s60, 3
s_add_u32 s62, s61, s12
v_mfma_f32_16x16x32_bf16 a[36:39], a[28:31], a[112:115], a[36:39]
s_waitcnt lgkmcnt(4)
v_mfma_f32_16x16x32_bf16 a[36:39], a[24:27], a[96:99], a[36:39]
buffer_load_dwordx4 v12, s[64:67], s61 offen lds
v_mfma_f32_16x16x32_bf16 v[160:163], a[0:3], a[128:131], v[160:163]
ds_read_b64_tr_b16 a[24:25], v5 offset:33280
v_mfma_f32_16x16x32_bf16 v[160:163], a[4:7], a[144:147], v[160:163]
ds_read_b64_tr_b16 a[26:27], v5 offset:37376
v_mfma_f32_16x16x32_bf16 v[168:171], a[4:7], a[148:151], v[168:171]
ds_read_b64_tr_b16 a[28:29], v5 offset:41472
v_mfma_f32_16x16x32_bf16 v[168:171], a[0:3], a[132:135], v[168:171]
ds_read_b64_tr_b16 a[30:31], v5 offset:45568
v_mfma_f32_16x16x32_bf16 v[176:179], a[0:3], a[136:139], v[176:179]
buffer_load_dwordx4 v13, s[64:67], s61 offen offset:1024 lds
v_mfma_f32_16x16x32_bf16 v[176:179], a[4:7], a[152:155], v[176:179]
v_mfma_f32_16x16x32_bf16 v[184:187], a[4:7], a[156:159], v[184:187]
v_mfma_f32_16x16x32_bf16 v[184:187], a[0:3], a[140:143], v[184:187]
v_mfma_f32_16x16x32_bf16 v[188:191], a[8:11], a[140:143], v[188:191]
ds_read_b64_tr_b16 a[0:1], v4 offset:33536
v_mfma_f32_16x16x32_bf16 v[188:191], a[12:15], a[156:159], v[188:191]
buffer_load_dwordx4 v12, s[64:67], s62 offen offset:2048 lds
v_mfma_f32_16x16x32_bf16 v[180:183], a[12:15], a[152:155], v[180:183]
ds_read_b64_tr_b16 a[2:3], v4 offset:37632
v_mfma_f32_16x16x32_bf16 v[180:183], a[8:11], a[136:139], v[180:183]
ds_read_b64_tr_b16 a[4:5], v4 offset:41728
v_mfma_f32_16x16x32_bf16 v[172:175], a[8:11], a[132:135], v[172:175]
ds_read_b64_tr_b16 a[6:7], v4 offset:45824
v_mfma_f32_16x16x32_bf16 v[172:175], a[12:15], a[148:151], v[172:175]
buffer_load_dwordx4 v13, s[64:67], s62 offen offset:3072 lds
v_mfma_f32_16x16x32_bf16 v[164:167], a[12:15], a[144:147], v[164:167]
s_add_u32 s60, s60, s58
s_and_b32 s60, s60, 0x1c000
s_add_u32 s101, s63, s60
v_mfma_f32_16x16x32_bf16 v[164:167], a[8:11], a[128:131], v[164:167]
s_waitcnt lgkmcnt(4)
v_mfma_f32_16x16x32_bf16 v[192:195], a[16:19], a[128:131], v[192:195]
ds_read_b64_tr_b16 a[8:9], v5 offset:33536
v_mfma_f32_16x16x32_bf16 v[192:195], a[20:23], a[144:147], v[192:195]
ds_read_b64_tr_b16 a[10:11], v5 offset:37632
v_mfma_f32_16x16x32_bf16 v[200:203], a[20:23], a[148:151], v[200:203]
buffer_load_dwordx4 a[64:67], v3, s[88:91], s101 offen sc1
v_mfma_f32_16x16x32_bf16 v[200:203], a[16:19], a[132:135], v[200:203]
ds_read_b64_tr_b16 a[12:13], v5 offset:41728
v_mfma_f32_16x16x32_bf16 v[208:211], a[16:19], a[136:139], v[208:211]
ds_read_b64_tr_b16 a[14:15], v5 offset:45824
v_mfma_f32_16x16x32_bf16 v[208:211], a[20:23], a[152:155], v[208:211]
v_mfma_f32_16x16x32_bf16 v[216:219], a[20:23], a[156:159], v[216:219]
buffer_load_dwordx4 a[68:71], v3, s[88:91], s101 offen offset:1024 sc1
v_mfma_f32_16x16x32_bf16 v[216:219], a[16:19], a[140:143], v[216:219]
v_mfma_f32_16x16x32_bf16 v[220:223], a[24:27], a[140:143], v[220:223]
ds_read_b64_tr_b16 a[16:17], v4 offset:32768
v_mfma_f32_16x16x32_bf16 v[220:223], a[28:31], a[156:159], v[220:223]
ds_read_b64_tr_b16 a[18:19], v4 offset:36864
v_mfma_f32_16x16x32_bf16 v[212:215], a[28:31], a[152:155], v[212:215]
ds_read_b64_tr_b16 a[20:21], v4 offset:40960
v_mfma_f32_16x16x32_bf16 v[212:215], a[24:27], a[136:139], v[212:215]
buffer_load_dwordx4 a[72:75], v3, s[88:91], s101 offen offset:2048 sc1
v_mfma_f32_16x16x32_bf16 v[204:207], a[24:27], a[132:135], v[204:207]
ds_read_b64_tr_b16 a[22:23], v4 offset:45056
v_mfma_f32_16x16x32_bf16 v[204:207], a[28:31], a[148:151], v[204:207]
v_mfma_f32_16x16x32_bf16 v[196:199], a[28:31], a[144:147], v[196:199]
v_mfma_f32_16x16x32_bf16 v[196:199], a[24:27], a[128:131], v[196:199]
s_waitcnt lgkmcnt(4)
v_mfma_f32_16x16x32_bf16 v[224:227], a[0:3], a[128:131], v[224:227]
buffer_load_dwordx4 a[76:79], v3, s[88:91], s101 offen offset:3072 sc1
v_mfma_f32_16x16x32_bf16 v[224:227], a[4:7], a[144:147], v[224:227]
ds_read_b64_tr_b16 a[24:25], v5 offset:32768
s_add_u32 s101, s101, 0x2000
v_mfma_f32_16x16x32_bf16 v[232:235], a[4:7], a[148:151], v[232:235]
ds_read_b64_tr_b16 a[26:27], v5 offset:36864
v_mfma_f32_16x16x32_bf16 v[232:235], a[0:3], a[132:135], v[232:235]
ds_read_b64_tr_b16 a[28:29], v5 offset:40960
v_mfma_f32_16x16x32_bf16 v[240:243], a[0:3], a[136:139], v[240:243]
buffer_load_dwordx4 a[80:83], v3, s[88:91], s101 offen sc1
v_mfma_f32_16x16x32_bf16 v[240:243], a[4:7], a[152:155], v[240:243]
ds_read_b64_tr_b16 a[30:31], v5 offset:45056
v_mfma_f32_16x16x32_bf16 v[248:251], a[4:7], a[156:159], v[248:251]
s_waitcnt vmcnt(29)
v_mfma_f32_16x16x32_bf16 v[248:251], a[0:3], a[140:143], v[248:251]
s_barrier
v_mfma_f32_16x16x32_bf16 v[252:255], a[8:11], a[140:143], v[252:255]
ds_read_b64_tr_b16 a[0:1], v4 offset:49408
v_mfma_f32_16x16x32_bf16 v[252:255], a[12:15], a[156:159], v[252:255]
buffer_load_dwordx4 a[84:87], v3, s[88:91], s101 offen offset:1024 sc1
v_mfma_f32_16x16x32_bf16 v[244:247], a[12:15], a[152:155], v[244:247]
ds_read_b64_tr_b16 a[2:3], v4 offset:53504
v_mfma_f32_16x16x32_bf16 v[244:247], a[8:11], a[136:139], v[244:247]
ds_read_b64_tr_b16 a[4:5], v4 offset:57600
v_mfma_f32_16x16x32_bf16 v[236:239], a[8:11], a[132:135], v[236:239]
ds_read_b64_tr_b16 a[6:7], v4 offset:61696
v_mfma_f32_16x16x32_bf16 v[236:239], a[12:15], a[148:151], v[236:239]
buffer_load_dwordx4 a[88:91], v3, s[88:91], s101 offen offset:2048 sc1
v_mfma_f32_16x16x32_bf16 v[228:231], a[12:15], a[144:147], v[228:231]
v_mfma_f32_16x16x32_bf16 v[228:231], a[8:11], a[128:131], v[228:231]
s_waitcnt lgkmcnt(4)
v_mfma_f32_16x16x32_bf16 a[32:35], a[16:19], a[128:131], a[32:35]
ds_read_b64_tr_b16 a[8:9], v5 offset:49408
v_mfma_f32_16x16x32_bf16 a[32:35], a[20:23], a[144:147], a[32:35]
ds_read_b64_tr_b16 a[10:11], v5 offset:53504
v_mfma_f32_16x16x32_bf16 a[40:43], a[20:23], a[148:151], a[40:43]
buffer_load_dwordx4 a[92:95], v3, s[88:91], s101 offen offset:3072 sc1
v_mfma_f32_16x16x32_bf16 a[40:43], a[16:19], a[132:135], a[40:43]
ds_read_b64_tr_b16 a[12:13], v5 offset:57600
s_add_u32 m0, s17, 0x10000
v_mfma_f32_16x16x32_bf16 a[48:51], a[16:19], a[136:139], a[48:51]
ds_read_b64_tr_b16 a[14:15], v5 offset:61696
s_lshl_b32 s61, s60, 3
v_mfma_f32_16x16x32_bf16 a[48:51], a[20:23], a[152:155], a[48:51]
s_add_u32 s62, s61, s12
v_mfma_f32_16x16x32_bf16 v[152:155], a[20:23], a[156:159], v[152:155]
v_mfma_f32_16x16x32_bf16 v[152:155], a[16:19], a[140:143], v[152:155]
buffer_load_dwordx4 v12, s[64:67], s61 offen lds
v_mfma_f32_16x16x32_bf16 v[156:159], a[24:27], a[140:143], v[156:159]
ds_read_b64_tr_b16 a[16:17], v4 offset:49664
v_mfma_f32_16x16x32_bf16 v[156:159], a[28:31], a[156:159], v[156:159]
ds_read_b64_tr_b16 a[18:19], v4 offset:53760
v_mfma_f32_16x16x32_bf16 a[52:55], a[28:31], a[152:155], a[52:55]
ds_read_b64_tr_b16 a[20:21], v4 offset:57856
v_mfma_f32_16x16x32_bf16 a[52:55], a[24:27], a[136:139], a[52:55]
buffer_load_dwordx4 v13, s[64:67], s61 offen offset:1024 lds
v_mfma_f32_16x16x32_bf16 a[44:47], a[24:27], a[132:135], a[44:47]
ds_read_b64_tr_b16 a[22:23], v4 offset:61952
v_mfma_f32_16x16x32_bf16 a[44:47], a[28:31], a[148:151], a[44:47]
v_mfma_f32_16x16x32_bf16 a[36:39], a[28:31], a[144:147], a[36:39]
v_mfma_f32_16x16x32_bf16 a[36:39], a[24:27], a[128:131], a[36:39]
s_waitcnt lgkmcnt(4)
v_mfma_f32_16x16x32_bf16 v[160:163], a[0:3], a[160:163], v[160:163]
buffer_load_dwordx4 v12, s[64:67], s62 offen offset:2048 lds
v_mfma_f32_16x16x32_bf16 v[160:163], a[4:7], a[176:179], v[160:163]
ds_read_b64_tr_b16 a[24:25], v5 offset:49664
v_mfma_f32_16x16x32_bf16 v[168:171], a[4:7], a[180:183], v[168:171]
ds_read_b64_tr_b16 a[26:27], v5 offset:53760
v_mfma_f32_16x16x32_bf16 v[168:171], a[0:3], a[164:167], v[168:171]
ds_read_b64_tr_b16 a[28:29], v5 offset:57856
v_mfma_f32_16x16x32_bf16 v[176:179], a[0:3], a[168:171], v[176:179]
buffer_load_dwordx4 v13, s[64:67], s62 offen offset:3072 lds
v_mfma_f32_16x16x32_bf16 v[176:179], a[4:7], a[184:187], v[176:179]
ds_read_b64_tr_b16 a[30:31], v5 offset:61952
s_add_u32 s60, s60, s59
v_mfma_f32_16x16x32_bf16 v[184:187], a[4:7], a[188:191], v[184:187]
s_and_b32 s60, s60, 0x1c000
s_add_u32 s101, s63, s60
v_mfma_f32_16x16x32_bf16 v[184:187], a[0:3], a[172:175], v[184:187]
v_mfma_f32_16x16x32_bf16 v[188:191], a[8:11], a[172:175], v[188:191]
ds_read_b64_tr_b16 a[0:1], v4 offset:49920
v_mfma_f32_16x16x32_bf16 v[188:191], a[12:15], a[188:191], v[188:191]
buffer_load_dwordx4 a[96:99], v3, s[88:91], s101 offen sc1
v_mfma_f32_16x16x32_bf16 v[180:183], a[12:15], a[184:187], v[180:183]
ds_read_b64_tr_b16 a[2:3], v4 offset:54016
v_mfma_f32_16x16x32_bf16 v[180:183], a[8:11], a[168:171], v[180:183]
ds_read_b64_tr_b16 a[4:5], v4 offset:58112
v_mfma_f32_16x16x32_bf16 v[172:175], a[8:11], a[164:167], v[172:175]
ds_read_b64_tr_b16 a[6:7], v4 offset:62208
v_mfma_f32_16x16x32_bf16 v[172:175], a[12:15], a[180:183], v[172:175]
v_mfma_f32_16x16x32_bf16 v[164:167], a[12:15], a[176:179], v[164:167]
buffer_load_dwordx4 a[100:103], v3, s[88:91], s101 offen offset:1024 sc1
v_mfma_f32_16x16x32_bf16 v[164:167], a[8:11], a[160:163], v[164:167]
s_waitcnt lgkmcnt(4)
v_mfma_f32_16x16x32_bf16 v[192:195], a[16:19], a[160:163], v[192:195]
ds_read_b64_tr_b16 a[8:9], v5 offset:49920
v_mfma_f32_16x16x32_bf16 v[192:195], a[20:23], a[176:179], v[192:195]
ds_read_b64_tr_b16 a[10:11], v5 offset:54016
v_mfma_f32_16x16x32_bf16 v[200:203], a[20:23], a[180:183], v[200:203]
buffer_load_dwordx4 a[104:107], v3, s[88:91], s101 offen offset:2048 sc1
v_mfma_f32_16x16x32_bf16 v[200:203], a[16:19], a[164:167], v[200:203]
ds_read_b64_tr_b16 a[12:13], v5 offset:58112
v_mfma_f32_16x16x32_bf16 v[208:211], a[16:19], a[168:171], v[208:211]
ds_read_b64_tr_b16 a[14:15], v5 offset:62208
v_mfma_f32_16x16x32_bf16 v[208:211], a[20:23], a[184:187], v[208:211]
v_mfma_f32_16x16x32_bf16 v[216:219], a[20:23], a[188:191], v[216:219]
s_waitcnt vmcnt(27)
v_mfma_f32_16x16x32_bf16 v[216:219], a[16:19], a[172:175], v[216:219]
s_barrier
v_mfma_f32_16x16x32_bf16 v[220:223], a[24:27], a[172:175], v[220:223]
buffer_load_dwordx4 a[108:111], v3, s[88:91], s101 offen offset:3072 sc1
v_mfma_f32_16x16x32_bf16 v[220:223], a[28:31], a[188:191], v[220:223]
ds_read_b64_tr_b16 a[16:17], v15 offset:256
s_add_u32 s101, s101, 0x2000
v_mfma_f32_16x16x32_bf16 v[212:215], a[28:31], a[184:187], v[212:215]
ds_read_b64_tr_b16 a[18:19], v15 offset:4352
v_mfma_f32_16x16x32_bf16 v[212:215], a[24:27], a[168:171], v[212:215]
ds_read_b64_tr_b16 a[20:21], v15 offset:8448
v_mfma_f32_16x16x32_bf16 v[204:207], a[24:27], a[164:167], v[204:207]
buffer_load_dwordx4 a[112:115], v3, s[88:91], s101 offen sc1
v_mfma_f32_16x16x32_bf16 v[204:207], a[28:31], a[180:183], v[204:207]
ds_read_b64_tr_b16 a[22:23], v15 offset:12544
v_mfma_f32_16x16x32_bf16 v[196:199], a[28:31], a[176:179], v[196:199]
v_mfma_f32_16x16x32_bf16 v[196:199], a[24:27], a[160:163], v[196:199]
s_waitcnt lgkmcnt(4)
v_mfma_f32_16x16x32_bf16 v[224:227], a[0:3], a[160:163], v[224:227]
buffer_load_dwordx4 a[116:119], v3, s[88:91], s101 offen offset:1024 sc1
v_mfma_f32_16x16x32_bf16 v[224:227], a[4:7], a[176:179], v[224:227]
ds_read_b64_tr_b16 a[24:25], v19 offset:256
v_mfma_f32_16x16x32_bf16 v[232:235], a[4:7], a[180:183], v[232:235]
ds_read_b64_tr_b16 a[26:27], v19 offset:4352
v_mfma_f32_16x16x32_bf16 v[232:235], a[0:3], a[164:167], v[232:235]
ds_read_b64_tr_b16 a[28:29], v19 offset:8448
v_mfma_f32_16x16x32_bf16 v[240:243], a[0:3], a[168:171], v[240:243]
ds_read_b64_tr_b16 a[30:31], v19 offset:12544
v_mfma_f32_16x16x32_bf16 v[240:243], a[4:7], a[184:187], v[240:243]
buffer_load_dwordx4 a[120:123], v3, s[88:91], s101 offen offset:2048 sc1
v_mfma_f32_16x16x32_bf16 v[248:251], a[4:7], a[188:191], v[248:251]
v_mfma_f32_16x16x32_bf16 v[248:251], a[0:3], a[172:175], v[248:251]
v_mfma_f32_16x16x32_bf16 v[252:255], a[8:11], a[172:175], v[252:255]
ds_read_b64_tr_b16 a[0:1], v15 offset:512
v_mfma_f32_16x16x32_bf16 v[252:255], a[12:15], a[188:191], v[252:255]
buffer_load_dwordx4 a[124:127], v3, s[88:91], s101 offen offset:3072 sc1
v_mfma_f32_16x16x32_bf16 v[244:247], a[12:15], a[184:187], v[244:247]
ds_read_b64_tr_b16 a[2:3], v15 offset:4608
s_add_u32 m0, s17, 0x14000
v_mfma_f32_16x16x32_bf16 v[244:247], a[8:11], a[168:171], v[244:247]
ds_read_b64_tr_b16 a[4:5], v15 offset:8704
s_lshl_b32 s61, s60, 3
v_mfma_f32_16x16x32_bf16 v[236:239], a[8:11], a[164:167], v[236:239]
ds_read_b64_tr_b16 a[6:7], v15 offset:12800
s_add_u32 s62, s61, s12
v_mfma_f32_16x16x32_bf16 v[236:239], a[12:15], a[180:183], v[236:239]
v_mfma_f32_16x16x32_bf16 v[228:231], a[12:15], a[176:179], v[228:231]
buffer_load_dwordx4 v12, s[64:67], s61 offen lds
v_mfma_f32_16x16x32_bf16 v[228:231], a[8:11], a[160:163], v[228:231]
s_waitcnt lgkmcnt(4)
v_mfma_f32_16x16x32_bf16 v[160:163], a[16:19], a[192:195], v[160:163]
ds_read_b64_tr_b16 a[8:9], v19 offset:512
v_mfma_f32_16x16x32_bf16 v[160:163], a[20:23], a[208:211], v[160:163]
ds_read_b64_tr_b16 a[10:11], v19 offset:4608
v_mfma_f32_16x16x32_bf16 v[168:171], a[20:23], a[212:215], v[168:171]
buffer_load_dwordx4 v13, s[64:67], s61 offen offset:1024 lds
v_mfma_f32_16x16x32_bf16 v[168:171], a[16:19], a[196:199], v[168:171]
ds_read_b64_tr_b16 a[12:13], v19 offset:8704
v_mfma_f32_16x16x32_bf16 v[176:179], a[16:19], a[200:203], v[176:179]
ds_read_b64_tr_b16 a[14:15], v19 offset:12800
v_mfma_f32_16x16x32_bf16 v[176:179], a[20:23], a[216:219], v[176:179]
v_mfma_f32_16x16x32_bf16 v[184:187], a[20:23], a[220:223], v[184:187]
s_waitcnt vmcnt(22)
v_mfma_f32_16x16x32_bf16 v[184:187], a[16:19], a[204:207], v[184:187]
s_barrier
v_mfma_f32_16x16x32_bf16 v[188:191], a[24:27], a[204:207], v[188:191]
buffer_load_dwordx4 v12, s[64:67], s62 offen offset:2048 lds
v_mfma_f32_16x16x32_bf16 v[188:191], a[28:31], a[220:223], v[188:191]
ds_read_b64_tr_b16 a[16:17], v15 offset:16640
v_mfma_f32_16x16x32_bf16 v[180:183], a[28:31], a[216:219], v[180:183]
ds_read_b64_tr_b16 a[18:19], v15 offset:20736
v_mfma_f32_16x16x32_bf16 v[180:183], a[24:27], a[200:203], v[180:183]
ds_read_b64_tr_b16 a[20:21], v15 offset:24832
v_mfma_f32_16x16x32_bf16 v[172:175], a[24:27], a[196:199], v[172:175]
buffer_load_dwordx4 v13, s[64:67], s62 offen offset:3072 lds
v_mfma_f32_16x16x32_bf16 v[172:175], a[28:31], a[212:215], v[172:175]
ds_read_b64_tr_b16 a[22:23], v15 offset:28928
v_mfma_f32_16x16x32_bf16 v[164:167], a[28:31], a[208:211], v[164:167]
buffer_load_dword v14, v7, s[88:91], s11 offen sc1
v_mfma_f32_16x16x32_bf16 v[164:167], a[24:27], a[192:195], v[164:167]
s_waitcnt lgkmcnt(4)
v_mfma_f32_16x16x32_bf16 v[192:195], a[0:3], a[192:195], v[192:195]
ds_read_b64_tr_b16 a[24:25], v19 offset:16640
v_mfma_f32_16x16x32_bf16 v[192:195], a[4:7], a[208:211], v[192:195]
ds_read_b64_tr_b16 a[26:27], v19 offset:20736
v_mfma_f32_16x16x32_bf16 v[200:203], a[4:7], a[212:215], v[200:203]
ds_read_b64_tr_b16 a[28:29], v19 offset:24832
v_mfma_f32_16x16x32_bf16 v[200:203], a[0:3], a[196:199], v[200:203]
ds_read_b64_tr_b16 a[30:31], v19 offset:28928
v_mfma_f32_16x16x32_bf16 v[208:211], a[0:3], a[200:203], v[208:211]
v_mfma_f32_16x16x32_bf16 v[208:211], a[4:7], a[216:219], v[208:211]
v_mfma_f32_16x16x32_bf16 v[216:219], a[4:7], a[220:223], v[216:219]
s_waitcnt vmcnt(13)
v_mfma_f32_16x16x32_bf16 v[216:219], a[0:3], a[204:207], v[216:219]
s_barrier
v_mfma_f32_16x16x32_bf16 v[220:223], a[8:11], a[204:207], v[220:223]
ds_read_b64_tr_b16 a[0:1], v4 offset:256
v_mfma_f32_16x16x32_bf16 v[220:223], a[12:15], a[220:223], v[220:223]
ds_read_b64_tr_b16 a[2:3], v4 offset:4352
v_mfma_f32_16x16x32_bf16 v[212:215], a[12:15], a[216:219], v[212:215]
ds_read_b64_tr_b16 a[4:5], v4 offset:8448
v_mfma_f32_16x16x32_bf16 v[212:215], a[8:11], a[200:203], v[212:215]
ds_read_b64_tr_b16 a[6:7], v4 offset:12544
v_mfma_f32_16x16x32_bf16 v[204:207], a[8:11], a[196:199], v[204:207]
v_mfma_f32_16x16x32_bf16 v[204:207], a[12:15], a[212:215], v[204:207]
v_mfma_f32_16x16x32_bf16 v[196:199], a[12:15], a[208:211], v[196:199]
v_mfma_f32_16x16x32_bf16 v[196:199], a[8:11], a[192:195], v[196:199]
s_waitcnt lgkmcnt(4)
v_mfma_f32_16x16x32_bf16 v[160:163], a[16:19], a[224:227], v[160:163]
ds_read_b64_tr_b16 a[8:9], v5 offset:256
v_mfma_f32_16x16x32_bf16 v[160:163], a[20:23], a[240:243], v[160:163]
ds_read_b64_tr_b16 a[10:11], v5 offset:4352
v_mfma_f32_16x16x32_bf16 v[168:171], a[20:23], a[244:247], v[168:171]
ds_read_b64_tr_b16 a[12:13], v5 offset:8448
v_mfma_f32_16x16x32_bf16 v[168:171], a[16:19], a[228:231], v[168:171]
ds_read_b64_tr_b16 a[14:15], v5 offset:12544
v_mfma_f32_16x16x32_bf16 v[176:179], a[16:19], a[232:235], v[176:179]
v_mfma_f32_16x16x32_bf16 v[176:179], a[20:23], a[248:251], v[176:179]
v_mfma_f32_16x16x32_bf16 v[184:187], a[20:23], a[252:255], v[184:187]
s_waitcnt vmcnt(1)
v_mfma_f32_16x16x32_bf16 v[184:187], a[16:19], a[236:239], v[184:187]
s_barrier
v_mfma_f32_16x16x32_bf16 v[188:191], a[24:27], a[236:239], v[188:191]
ds_read_b64_tr_b16 a[16:17], v4 offset:16640
L_padC3:
s_cmp_eq_u32 s95, 1
s_cbranch_scc1 L_hopC_ret
v_mfma_f32_16x16x32_bf16 v[188:191], a[28:31], a[252:255], v[188:191]
ds_read_b64_tr_b16 a[18:19], v4 offset:20736
v_mfma_f32_16x16x32_bf16 v[180:183], a[28:31], a[248:251], v[180:183]
ds_read_b64_tr_b16 a[20:21], v4 offset:24832
v_mfma_f32_16x16x32_bf16 v[180:183], a[24:27], a[232:235], v[180:183]
ds_read_b64_tr_b16 a[22:23], v4 offset:28928
v_mfma_f32_16x16x32_bf16 v[172:175], a[24:27], a[228:231], v[172:175]
v_mfma_f32_16x16x32_bf16 v[172:175], a[28:31], a[244:247], v[172:175]
v_mfma_f32_16x16x32_bf16 v[164:167], a[28:31], a[240:243], v[164:167]
v_mfma_f32_16x16x32_bf16 v[164:167], a[24:27], a[224:227], v[164:167]
s_waitcnt lgkmcnt(4)
v_mfma_f32_16x16x32_bf16 v[160:163], a[0:3], a[64:67], v[160:163]
ds_read_b64_tr_b16 a[24:25], v5 offset:16640
v_mfma_f32_16x16x32_bf16 v[160:163], a[4:7], a[80:83], v[160:163]
ds_read_b64_tr_b16 a[26:27], v5 offset:20736
v_mfma_f32_16x16x32_bf16 v[168:171], a[4:7], a[84:87], v[168:171]
ds_read_b64_tr_b16 a[28:29], v5 offset:24832
v_mfma_f32_16x16x32_bf16 v[168:171], a[0:3], a[68:71], v[168:171]
ds_read_b64_tr_b16 a[30:31], v5 offset:28928
v_mfma_f32_16x16x32_bf16 v[176:179], a[0:3], a[72:75], v[176:179]
v_mfma_f32_16x16x32_bf16 v[176:179], a[4:7], a[88:91], v[176:179]
v_mfma_f32_16x16x32_bf16 v[184:187], a[4:7], a[92:95], v[184:187]
v_mfma_f32_16x16x32_bf16 v[184:187], a[0:3], a[76:79], v[184:187]
v_mfma_f32_16x16x32_bf16 v[188:191], a[8:11], a[76:79], v[188:191]
ds_read_b64_tr_b16 a[0:1], v15 offset:16896
v_mfma_f32_16x16x32_bf16 v[188:191], a[12:15], a[92:95], v[188:191]
ds_read_b64_tr_b16 a[2:3], v15 offset:20992
v_mfma_f32_16x16x32_bf16 v[180:183], a[12:15], a[88:91], v[180:183]
ds_read_b64_tr_b16 a[4:5], v15 offset:25088
v_mfma_f32_16x16x32_bf16 v[180:183], a[8:11], a[72:75], v[180:183]
ds_read_b64_tr_b16 a[6:7], v15 offset:29184
v_mfma_f32_16x16x32_bf16 v[172:175], a[8:11], a[68:71], v[172:175]
v_mfma_f32_16x16x32_bf16 v[172:175], a[12:15], a[84:87], v[172:175]
v_mfma_f32_16x16x32_bf16 v[164:167], a[12:15], a[80:83], v[164:167]
v_mfma_f32_16x16x32_bf16 v[164:167], a[8:11], a[64:67], v[164:167]
s_waitcnt lgkmcnt(4)
v_mfma_f32_16x16x32_bf16 v[160:163], a[16:19], a[96:99], v[160:163]
ds_read_b64_tr_b16 a[8:9], v19 offset:16896
v_mfma_f32_16x16x32_bf16 v[160:163], a[20:23], a[112:115], v[160:163]
ds_read_b64_tr_b16 a[10:11], v19 offset:20992
v_mfma_f32_16x16x32_bf16 v[168:171], a[20:23], a[116:119], v[168:171]
ds_read_b64_tr_b16 a[12:13], v19 offset:25088
v_mfma_f32_16x16x32_bf16 v[168:171], a[16:19], a[100:103], v[168:171]
ds_read_b64_tr_b16 a[14:15], v19 offset:29184
v_mfma_f32_16x16x32_bf16 v[176:179], a[16:19], a[104:107], v[176:179]
v_mfma_f32_16x16x32_bf16 v[176:179], a[20:23], a[120:123], v[176:179]
v_mfma_f32_16x16x32_bf16 v[184:187], a[20:23], a[124:127], v[184:187]
v_mfma_f32_16x16x32_bf16 v[184:187], a[16:19], a[108:111], v[184:187]
v_mfma_f32_16x16x32_bf16 v[188:191], a[24:27], a[108:111], v[188:191]
ds_read_b64_tr_b16 a[16:17], v4 offset:512
v_mfma_f32_16x16x32_bf16 v[188:191], a[28:31], a[124:127], v[188:191]
ds_read_b64_tr_b16 a[18:19], v4 offset:4608
v_mfma_f32_16x16x32_bf16 v[180:183], a[28:31], a[120:123], v[180:183]
ds_read_b64_tr_b16 a[20:21], v4 offset:8704
v_mfma_f32_16x16x32_bf16 v[180:183], a[24:27], a[104:107], v[180:183]
ds_read_b64_tr_b16 a[22:23], v4 offset:12800
v_mfma_f32_16x16x32_bf16 v[172:175], a[24:27], a[100:103], v[172:175]
s_waitcnt vmcnt(0)
s_mov_b32 s92, 200000
L_spin_p:
v_cmp_gt_u32 vcc, 1, v14
s_nop 4
s_cbranch_vccz L_spun_p
s_sub_u32 s92, s92, 1
s_cbranch_scc1 L_spun_p
s_sleep 6
buffer_load_dword v14, v7, s[88:91], s11 offen sc1
s_waitcnt vmcnt(0)
s_branch L_spin_p
L_spun_p:
v_mfma_f32_16x16x32_bf16 v[172:175], a[28:31], a[116:119], v[172:175]
v_fmac_f32 v80, v11, v184
v_fmac_f32 v81, v11, v185
v_mfma_f32_16x16x32_bf16 v[164:167], a[28:31], a[112:115], v[164:167]
v_fmac_f32 v82, v11, v186
v_fmac_f32 v83, v11, v187
v_mfma_f32_16x16x32_bf16 v[164:167], a[24:27], a[96:99], v[164:167]
s_waitcnt lgkmcnt(4)
v_fmac_f32 v84, v11, v188
v_fmac_f32 v85, v11, v189
v_mfma_f32_16x16x32_bf16 v[192:195], a[0:3], a[224:227], v[192:195]
ds_read_b64_tr_b16 a[24:25], v5 offset:512
v_fmac_f32 v86, v11, v190
v_mfma_f32_16x16x32_bf16 v[192:195], a[4:7], a[240:243], v[192:195]
ds_read_b64_tr_b16 a[26:27], v5 offset:4608
v_fmac_f32 v87, v11, v191
v_mfma_f32_16x16x32_bf16 v[200:203], a[4:7], a[244:247], v[200:203]
ds_read_b64_tr_b16 a[28:29], v5 offset:8704
v_cvt_pk_bf16_f32 v80, v80, v81
v_mfma_f32_16x16x32_bf16 v[200:203], a[0:3], a[228:231], v[200:203]
ds_read_b64_tr_b16 a[30:31], v5 offset:12800
v_cvt_pk_bf16_f32 v81, v82, v83
v_mfma_f32_16x16x32_bf16 v[208:211], a[0:3], a[232:235], v[208:211]
v_cvt_pk_bf16_f32 v82, v84, v85
v_cvt_pk_bf16_f32 v83, v86, v87
v_mfma_f32_16x16x32_bf16 v[208:211], a[4:7], a[248:251], v[208:211]
buffer_store_dwordx4 v[80:83], v3, s[88:91], s52 offen offset:3072 sc1
v_mfma_f32_16x16x32_bf16 v[216:219], a[4:7], a[252:255], v[216:219]
v_fmac_f32 v72, v10, v176
v_fmac_f32 v73, v10, v177
v_mfma_f32_16x16x32_bf16 v[216:219], a[0:3], a[236:239], v[216:219]
v_fmac_f32 v74, v10, v178
v_fmac_f32 v75, v10, v179
v_mfma_f32_16x16x32_bf16 v[220:223], a[8:11], a[236:239], v[220:223]
ds_read_b64_tr_b16 a[0:1], v4 offset:16896
v_fmac_f32 v76, v10, v180
v_mfma_f32_16x16x32_bf16 v[220:223], a[12:15], a[252:255], v[220:223]
ds_read_b64_tr_b16 a[2:3], v4 offset:20992
v_fmac_f32 v77, v10, v181
v_mfma_f32_16x16x32_bf16 v[212:215], a[12:15], a[248:251], v[212:215]
ds_read_b64_tr_b16 a[4:5], v4 offset:25088
v_fmac_f32 v78, v10, v182
v_mfma_f32_16x16x32_bf16 v[212:215], a[8:11], a[232:235], v[212:215]
ds_read_b64_tr_b16 a[6:7], v4 offset:29184
v_fmac_f32 v79, v10, v183
v_mfma_f32_16x16x32_bf16 v[204:207], a[8:11], a[228:231], v[204:207]
v_cvt_pk_bf16_f32 v72, v72, v73
v_cvt_pk_bf16_f32 v73, v74, v75
v_mfma_f32_16x16x32_bf16 v[204:207], a[12:15], a[244:247], v[204:207]
v_cvt_pk_bf16_f32 v74, v76, v77
v_cvt_pk_bf16_f32 v75, v78, v79
v_mfma_f32_16x16x32_bf16 v[196:199], a[12:15], a[240:243], v[196:199]
buffer_store_dwordx4 v[72:75], v3, s[88:91], s52 offen offset:2048 sc1
v_mfma_f32_16x16x32_bf16 v[196:199], a[8:11], a[224:227], v[196:199]
s_waitcnt lgkmcnt(4)
v_fmac_f32 v64, v9, v168
v_fmac_f32 v65, v9, v169
v_mfma_f32_16x16x32_bf16 v[192:195], a[16:19], a[64:67], v[192:195]
ds_read_b64_tr_b16 a[8:9], v5 offset:16896
v_fmac_f32 v66, v9, v170
v_mfma_f32_16x16x32_bf16 v[192:195], a[20:23], a[80:83], v[192:195]
ds_read_b64_tr_b16 a[10:11], v5 offset:20992
v_fmac_f32 v67, v9, v171
v_mfma_f32_16x16x32_bf16 v[200:203], a[20:23], a[84:87], v[200:203]
ds_read_b64_tr_b16 a[12:13], v5 offset:25088
v_fmac_f32 v68, v9, v172
v_mfma_f32_16x16x32_bf16 v[200:203], a[16:19], a[68:71], v[200:203]
ds_read_b64_tr_b16 a[14:15], v5 offset:29184
v_fmac_f32 v69, v9, v173
v_mfma_f32_16x16x32_bf16 v[208:211], a[16:19], a[72:75], v[208:211]
v_fmac_f32 v70, v9, v174
v_fmac_f32 v71, v9, v175
v_mfma_f32_16x16x32_bf16 v[208:211], a[20:23], a[88:91], v[208:211]
v_cvt_pk_bf16_f32 v64, v64, v65
v_cvt_pk_bf16_f32 v65, v66, v67
v_mfma_f32_16x16x32_bf16 v[216:219], a[20:23], a[92:95], v[216:219]
v_cvt_pk_bf16_f32 v66, v68, v69
v_cvt_pk_bf16_f32 v67, v70, v71
v_mfma_f32_16x16x32_bf16 v[216:219], a[16:19], a[76:79], v[216:219]
buffer_store_dwordx4 v[64:67], v3, s[88:91], s52 offen offset:1024 sc1
v_mfma_f32_16x16x32_bf16 v[220:223], a[24:27], a[76:79], v[220:223]
ds_read_b64_tr_b16 a[16:17], v15 offset:768
v_fmac_f32 v56, v8, v160
v_mfma_f32_16x16x32_bf16 v[220:223], a[28:31], a[92:95], v[220:223]
ds_read_b64_tr_b16 a[18:19], v15 offset:4864
v_fmac_f32 v57, v8, v161
v_mfma_f32_16x16x32_bf16 v[212:215], a[28:31], a[88:91], v[212:215]
ds_read_b64_tr_b16 a[20:21], v15 offset:8960
v_fmac_f32 v58, v8, v162
v_mfma_f32_16x16x32_bf16 v[212:215], a[24:27], a[72:75], v[212:215]
ds_read_b64_tr_b16 a[22:23], v15 offset:13056
v_fmac_f32 v59, v8, v163
v_mfma_f32_16x16x32_bf16 v[204:207], a[24:27], a[68:71], v[204:207]
v_fmac_f32 v60, v8, v164
v_fmac_f32 v61, v8, v165
v_mfma_f32_16x16x32_bf16 v[204:207], a[28:31], a[84:87], v[204:207]
v_fmac_f32 v62, v8, v166
v_fmac_f32 v63, v8, v167
v_mfma_f32_16x16x32_bf16 v[196:199], a[28:31], a[80:83], v[196:199]
v_cvt_pk_bf16_f32 v56, v56, v57
v_cvt_pk_bf16_f32 v57, v58, v59
v_mfma_f32_16x16x32_bf16 v[196:199], a[24:27], a[64:67], v[196:199]
s_waitcnt lgkmcnt(4)
v_cvt_pk_bf16_f32 v58, v60, v61
v_cvt_pk_bf16_f32 v59, v62, v63
v_mfma_f32_16x16x32_bf16 v[192:195], a[0:3], a[96:99], v[192:195]
ds_read_b64_tr_b16 a[24:25], v19 offset:768
v_mfma_f32_16x16x32_bf16 v[192:195], a[4:7], a[112:115], v[192:195]
ds_read_b64_tr_b16 a[26:27], v19 offset:4864
v_mfma_f32_16x16x32_bf16 v[200:203], a[4:7], a[116:119], v[200:203]
ds_read_b64_tr_b16 a[28:29], v19 offset:8960
v_mfma_f32_16x16x32_bf16 v[200:203], a[0:3], a[100:103], v[200:203]
ds_read_b64_tr_b16 a[30:31], v19 offset:13056
v_mfma_f32_16x16x32_bf16 v[208:211], a[0:3], a[104:107], v[208:211]
buffer_store_dwordx4 v[56:59], v3, s[88:91], s52 offen offset:0 sc1
v_mfma_f32_16x16x32_bf16 v[208:211], a[4:7], a[120:123], v[208:211]
v_mfma_f32_16x16x32_bf16 v[216:219], a[4:7], a[124:127], v[216:219]
v_mfma_f32_16x16x32_bf16 v[216:219], a[0:3], a[108:111], v[216:219]
v_mfma_f32_16x16x32_bf16 v[220:223], a[8:11], a[108:111], v[220:223]
ds_read_b64_tr_b16 a[0:1], v15 offset:17152
v_mfma_f32_16x16x32_bf16 v[220:223], a[12:15], a[124:127], v[220:223]
ds_read_b64_tr_b16 a[2:3], v15 offset:21248
v_mfma_f32_16x16x32_bf16 v[212:215], a[12:15], a[120:123], v[212:215]
ds_read_b64_tr_b16 a[4:5], v15 offset:25344
v_mfma_f32_16x16x32_bf16 v[212:215], a[8:11], a[104:107], v[212:215]
ds_read_b64_tr_b16 a[6:7], v15 offset:29440
v_mfma_f32_16x16x32_bf16 v[204:207], a[8:11], a[100:103], v[204:207]
v_mfma_f32_16x16x32_bf16 v[204:207], a[12:15], a[116:119], v[204:207]
v_fmac_f32 v112, v11, v216
v_fmac_f32 v113, v11, v217
v_mfma_f32_16x16x32_bf16 v[196:199], a[12:15], a[112:115], v[196:199]
v_fmac_f32 v114, v11, v218
v_fmac_f32 v115, v11, v219
v_mfma_f32_16x16x32_bf16 v[196:199], a[8:11], a[96:99], v[196:199]
s_waitcnt lgkmcnt(4)
v_fmac_f32 v116, v11, v220
v_fmac_f32 v117, v11, v221
v_mfma_f32_16x16x32_bf16 v[224:227], a[16:19], a[192:195], v[224:227]
ds_read_b64_tr_b16 a[8:9], v19 offset:17152
v_fmac_f32 v118, v11, v222
v_mfma_f32_16x16x32_bf16 v[224:227], a[20:23], a[208:211], v[224:227]
ds_read_b64_tr_b16 a[10:11], v19 offset:21248
v_fmac_f32 v119, v11, v223
v_mfma_f32_16x16x32_bf16 v[232:235], a[20:23], a[212:215], v[232:235]
ds_read_b64_tr_b16 a[12:13], v19 offset:25344
v_cvt_pk_bf16_f32 v112, v112, v113
v_mfma_f32_16x16x32_bf16 v[232:235], a[16:19], a[196:199], v[232:235]
ds_read_b64_tr_b16 a[14:15], v19 offset:29440
v_cvt_pk_bf16_f32 v113, v114, v115
v_mfma_f32_16x16x32_bf16 v[240:243], a[16:19], a[200:203], v[240:243]
v_cvt_pk_bf16_f32 v114, v116, v117
v_cvt_pk_bf16_f32 v115, v118, v119
v_mfma_f32_16x16x32_bf16 v[240:243], a[20:23], a[216:219], v[240:243]
buffer_load_dword v14, v1, s[88:91], s44 offen sc1
v_mfma_f32_16x16x32_bf16 v[248:251], a[20:23], a[220:223], v[248:251]
buffer_store_dwordx4 v[112:115], v3, s[88:91], s53 offen offset:3072 sc1
v_mfma_f32_16x16x32_bf16 v[248:251], a[16:19], a[204:207], v[248:251]
v_fmac_f32 v104, v10, v208
v_fmac_f32 v105, v10, v209
v_mfma_f32_16x16x32_bf16 v[252:255], a[24:27], a[204:207], v[252:255]
ds_read_b64_tr_b16 a[16:17], v4 offset:768
v_fmac_f32 v106, v10, v210
v_mfma_f32_16x16x32_bf16 v[252:255], a[28:31], a[220:223], v[252:255]
ds_read_b64_tr_b16 a[18:19], v4 offset:4864
v_fmac_f32 v107, v10, v211
v_mfma_f32_16x16x32_bf16 v[244:247], a[28:31], a[216:219], v[244:247]
ds_read_b64_tr_b16 a[20:21], v4 offset:8960
v_fmac_f32 v108, v10, v212
v_mfma_f32_16x16x32_bf16 v[244:247], a[24:27], a[200:203], v[244:247]
ds_read_b64_tr_b16 a[22:23], v4 offset:13056
v_fmac_f32 v109, v10, v213
v_mfma_f32_16x16x32_bf16 v[236:239], a[24:27], a[196:199], v[236:239]
v_fmac_f32 v110, v10, v214
v_fmac_f32 v111, v10, v215
v_mfma_f32_16x16x32_bf16 v[236:239], a[28:31], a[212:215], v[236:239]
v_cvt_pk_bf16_f32 v104, v104, v105
v_cvt_pk_bf16_f32 v105, v106, v107
v_mfma_f32_16x16x32_bf16 v[228:231], a[28:31], a[208:211], v[228:231]
v_cvt_pk_bf16_f32 v106, v108, v109
v_cvt_pk_bf16_f32 v107, v110, v111
v_mfma_f32_16x16x32_bf16 v[228:231], a[24:27], a[192:195], v[228:231]
s_waitcnt lgkmcnt(4)
v_mfma_f32_16x16x32_bf16 v[224:227], a[0:3], a[224:227], v[224:227]
ds_read_b64_tr_b16 a[24:25], v5 offset:768
v_mfma_f32_16x16x32_bf16 v[224:227], a[4:7], a[240:243], v[224:227]
ds_read_b64_tr_b16 a[26:27], v5 offset:4864
v_mfma_f32_16x16x32_bf16 v[232:235], a[4:7], a[244:247], v[232:235]
ds_read_b64_tr_b16 a[28:29], v5 offset:8960
v_mfma_f32_16x16x32_bf16 v[232:235], a[0:3], a[228:231], v[232:235]
ds_read_b64_tr_b16 a[30:31], v5 offset:13056
v_mfma_f32_16x16x32_bf16 v[240:243], a[0:3], a[232:235], v[240:243]
buffer_store_dwordx4 v[104:107], v3, s[88:91], s53 offen offset:2048 sc1
v_mfma_f32_16x16x32_bf16 v[240:243], a[4:7], a[248:251], v[240:243]
v_fmac_f32 v96, v9, v200
v_fmac_f32 v97, v9, v201
v_mfma_f32_16x16x32_bf16 v[248:251], a[4:7], a[252:255], v[248:251]
v_fmac_f32 v98, v9, v202
v_fmac_f32 v99, v9, v203
v_mfma_f32_16x16x32_bf16 v[248:251], a[0:3], a[236:239], v[248:251]
v_fmac_f32 v100, v9, v204
v_fmac_f32 v101, v9, v205
v_mfma_f32_16x16x32_bf16 v[252:255], a[8:11], a[236:239], v[252:255]
ds_read_b64_tr_b16 a[0:1], v4 offset:17152
v_fmac_f32 v102, v9, v206
v_mfma_f32_16x16x32_bf16 v[252:255], a[12:15], a[252:255], v[252:255]
ds_read_b64_tr_b16 a[2:3], v4 offset:21248
v_fmac_f32 v103, v9, v207
v_mfma_f32_16x16x32_bf16 v[244:247], a[12:15], a[248:251], v[244:247]
ds_read_b64_tr_b16 a[4:5], v4 offset:25344
v_cvt_pk_bf16_f32 v96, v96, v97
v_mfma_f32_16x16x32_bf16 v[244:247], a[8:11], a[232:235], v[244:247]
ds_read_b64_tr_b16 a[6:7], v4 offset:29440
v_cvt_pk_bf16_f32 v97, v98, v99
v_mfma_f32_16x16x32_bf16 v[236:239], a[8:11], a[228:231], v[236:239]
v_cvt_pk_bf16_f32 v98, v100, v101
v_cvt_pk_bf16_f32 v99, v102, v103
v_mfma_f32_16x16x32_bf16 v[236:239], a[12:15], a[244:247], v[236:239]
buffer_store_dwordx4 v[96:99], v3, s[88:91], s53 offen offset:1024 sc1
v_mfma_f32_16x16x32_bf16 v[228:231], a[12:15], a[240:243], v[228:231]
v_fmac_f32 v88, v8, v192
v_fmac_f32 v89, v8, v193
v_mfma_f32_16x16x32_bf16 v[228:231], a[8:11], a[224:227], v[228:231]
s_waitcnt lgkmcnt(4)
v_fmac_f32 v90, v8, v194
v_fmac_f32 v91, v8, v195
v_mfma_f32_16x16x32_bf16 v[224:227], a[16:19], a[64:67], v[224:227]
ds_read_b64_tr_b16 a[8:9], v5 offset:17152
v_fmac_f32 v92, v8, v196
v_mfma_f32_16x16x32_bf16 v[224:227], a[20:23], a[80:83], v[224:227]
ds_read_b64_tr_b16 a[10:11], v5 offset:21248
v_fmac_f32 v93, v8, v197
v_mfma_f32_16x16x32_bf16 v[232:235], a[20:23], a[84:87], v[232:235]
ds_read_b64_tr_b16 a[12:13], v5 offset:25344
v_fmac_f32 v94, v8, v198
v_mfma_f32_16x16x32_bf16 v[232:235], a[16:19], a[68:71], v[232:235]
ds_read_b64_tr_b16 a[14:15], v5 offset:29440
v_fmac_f32 v95, v8, v199
v_mfma_f32_16x16x32_bf16 v[240:243], a[16:19], a[72:75], v[240:243]
v_cvt_pk_bf16_f32 v88, v88, v89
v_cvt_pk_bf16_f32 v89, v90, v91
v_mfma_f32_16x16x32_bf16 v[240:243], a[20:23], a[88:91], v[240:243]
v_cvt_pk_bf16_f32 v90, v92, v93
v_cvt_pk_bf16_f32 v91, v94, v95
v_mfma_f32_16x16x32_bf16 v[248:251], a[20:23], a[92:95], v[248:251]
buffer_store_dwordx4 v[88:91], v3, s[88:91], s53 offen offset:0 sc1
v_mfma_f32_16x16x32_bf16 v[248:251], a[16:19], a[76:79], v[248:251]
v_mfma_f32_16x16x32_bf16 v[252:255], a[24:27], a[76:79], v[252:255]
ds_read_b64_tr_b16 a[16:17], v4 offset:49152
v_mfma_f32_16x16x32_bf16 v[252:255], a[28:31], a[92:95], v[252:255]
ds_read_b64_tr_b16 a[18:19], v4 offset:53248
v_mfma_f32_16x16x32_bf16 v[244:247], a[28:31], a[88:91], v[244:247]
ds_read_b64_tr_b16 a[20:21], v4 offset:57344
v_mfma_f32_16x16x32_bf16 v[244:247], a[24:27], a[72:75], v[244:247]
ds_read_b64_tr_b16 a[22:23], v4 offset:61440
v_mfma_f32_16x16x32_bf16 v[236:239], a[24:27], a[68:71], v[236:239]
v_mfma_f32_16x16x32_bf16 v[236:239], a[28:31], a[84:87], v[236:239]
v_mfma_f32_16x16x32_bf16 v[228:231], a[28:31], a[80:83], v[228:231]
v_mfma_f32_16x16x32_bf16 v[228:231], a[24:27], a[64:67], v[228:231]
s_waitcnt lgkmcnt(4)
v_mfma_f32_16x16x32_bf16 v[224:227], a[0:3], a[96:99], v[224:227]
ds_read_b64_tr_b16 a[24:25], v5 offset:49152
s_waitcnt vmcnt(4)
v_mfma_f32_16x16x32_bf16 v[224:227], a[4:7], a[112:115], v[224:227]
ds_read_b64_tr_b16 a[26:27], v5 offset:53248
v_cmp_ne_u32 vcc, -1, v14
v_mfma_f32_16x16x32_bf16 v[232:235], a[4:7], a[116:119], v[232:235]
ds_read_b64_tr_b16 a[28:29], v5 offset:57344
s_and_b32 s15, vcc_lo, 7
v_mfma_f32_16x16x32_bf16 v[232:235], a[0:3], a[100:103], v[232:235]
ds_read_b64_tr_b16 a[30:31], v5 offset:61440
v_mfma_f32_16x16x32_bf16 v[240:243], a[0:3], a[104:107], v[240:243]
s_bitcmp1_b32 s15, 0
s_cselect_b32 s50, s90, 0
v_mfma_f32_16x16x32_bf16 v[240:243], a[4:7], a[120:123], v[240:243]
buffer_load_dwordx4 v[160:163], v3, s[48:51], s44 offen offset:0 sc1
v_mfma_f32_16x16x32_bf16 v[248:251], a[4:7], a[124:127], v[248:251]
v_mfma_f32_16x16x32_bf16 v[248:251], a[0:3], a[108:111], v[248:251]
buffer_load_dwordx4 v[164:167], v3, s[48:51], s44 offen offset:1024 sc1
v_mfma_f32_16x16x32_bf16 v[252:255], a[8:11], a[108:111], v[252:255]
ds_read_b64_tr_b16 a[0:1], v15 offset:0
v_mfma_f32_16x16x32_bf16 v[252:255], a[12:15], a[124:127], v[252:255]
ds_read_b64_tr_b16 a[2:3], v15 offset:4096
v_mfma_f32_16x16x32_bf16 v[244:247], a[12:15], a[120:123], v[244:247]
ds_read_b64_tr_b16 a[4:5], v15 offset:8192
v_mfma_f32_16x16x32_bf16 v[244:247], a[8:11], a[104:107], v[244:247]
ds_read_b64_tr_b16 a[6:7], v15 offset:12288
v_mfma_f32_16x16x32_bf16 v[236:239], a[8:11], a[100:103], v[236:239]
buffer_load_dwordx4 v[168:171], v3, s[48:51], s44 offen offset:2048 sc1
v_mfma_f32_16x16x32_bf16 v[236:239], a[12:15], a[116:119], v[236:239]
v_mfma_f32_16x16x32_bf16 v[228:231], a[12:15], a[112:115], v[228:231]
buffer_load_dwordx4 v[172:175], v3, s[48:51], s44 offen offset:3072 sc1
v_mfma_f32_16x16x32_bf16 v[228:231], a[8:11], a[96:99], v[228:231]
s_waitcnt lgkmcnt(4)
v_mfma_f32_16x16x32_bf16 a[32:35], a[16:19], a[160:163], a[32:35]
ds_read_b64_tr_b16 a[8:9], v19 offset:0
v_fmac_f32 v144, v11, v248
v_mfma_f32_16x16x32_bf16 a[32:35], a[20:23], a[176:179], a[32:35]
ds_read_b64_tr_b16 a[10:11], v19 offset:4096
v_fmac_f32 v145, v11, v249
v_mfma_f32_16x16x32_bf16 a[40:43], a[20:23], a[180:183], a[40:43]
ds_read_b64_tr_b16 a[12:13], v19 offset:8192
v_fmac_f32 v146, v11, v250
v_mfma_f32_16x16x32_bf16 a[40:43], a[16:19], a[164:167], a[40:43]
ds_read_b64_tr_b16 a[14:15], v19 offset:12288
v_fmac_f32 v147, v11, v251
v_mfma_f32_16x16x32_bf16 a[48:51], a[16:19], a[168:171], a[48:51]
v_fmac_f32 v148, v11, v252
v_fmac_f32 v149, v11, v253
v_mfma_f32_16x16x32_bf16 a[48:51], a[20:23], a[184:187], a[48:51]
v_fmac_f32 v150, v11, v254
v_fmac_f32 v151, v11, v255
v_mfma_f32_16x16x32_bf16 v[152:155], a[20:23], a[188:191], v[152:155]
v_cvt_pk_bf16_f32 v144, v144, v145
v_cvt_pk_bf16_f32 v145, v146, v147
v_mfma_f32_16x16x32_bf16 v[152:155], a[16:19], a[172:175], v[152:155]
v_cvt_pk_bf16_f32 v146, v148, v149
v_cvt_pk_bf16_f32 v147, v150, v151
v_mfma_f32_16x16x32_bf16 v[156:159], a[24:27], a[172:175], v[156:159]
ds_read_b64_tr_b16 a[16:17], v15 offset:16384
v_mfma_f32_16x16x32_bf16 v[156:159], a[28:31], a[188:191], v[156:159]
ds_read_b64_tr_b16 a[18:19], v15 offset:20480
v_mfma_f32_16x16x32_bf16 a[52:55], a[28:31], a[184:187], a[52:55]
ds_read_b64_tr_b16 a[20:21], v15 offset:24576
v_mfma_f32_16x16x32_bf16 a[52:55], a[24:27], a[168:171], a[52:55]
ds_read_b64_tr_b16 a[22:23], v15 offset:28672
v_mfma_f32_16x16x32_bf16 a[44:47], a[24:27], a[164:167], a[44:47]
buffer_store_dwordx4 v[144:147], v3, s[88:91], s54 offen offset:3072 sc1
v_mfma_f32_16x16x32_bf16 a[44:47], a[28:31], a[180:183], a[44:47]
v_fmac_f32 v136, v10, v240
v_fmac_f32 v137, v10, v241
v_mfma_f32_16x16x32_bf16 a[36:39], a[28:31], a[176:179], a[36:39]
v_fmac_f32 v138, v10, v242
v_fmac_f32 v139, v10, v243
v_mfma_f32_16x16x32_bf16 a[36:39], a[24:27], a[160:163], a[36:39]
s_waitcnt lgkmcnt(4)
v_fmac_f32 v140, v10, v244
v_fmac_f32 v141, v10, v245
v_mfma_f32_16x16x32_bf16 a[32:35], a[0:3], a[192:195], a[32:35]
ds_read_b64_tr_b16 a[24:25], v19 offset:16384
v_fmac_f32 v142, v10, v246
v_mfma_f32_16x16x32_bf16 a[32:35], a[4:7], a[208:211], a[32:35]
ds_read_b64_tr_b16 a[26:27], v19 offset:20480
v_fmac_f32 v143, v10, v247
v_mfma_f32_16x16x32_bf16 a[40:43], a[4:7], a[212:215], a[40:43]
ds_read_b64_tr_b16 a[28:29], v19 offset:24576
v_cvt_pk_bf16_f32 v136, v136, v137
v_mfma_f32_16x16x32_bf16 a[40:43], a[0:3], a[196:199], a[40:43]
ds_read_b64_tr_b16 a[30:31], v19 offset:28672
v_cvt_pk_bf16_f32 v137, v138, v139
v_mfma_f32_16x16x32_bf16 a[48:51], a[0:3], a[200:203], a[48:51]
v_cvt_pk_bf16_f32 v138, v140, v141
v_cvt_pk_bf16_f32 v139, v142, v143
v_mfma_f32_16x16x32_bf16 a[48:51], a[4:7], a[216:219], a[48:51]
buffer_store_dwordx4 v[136:139], v3, s[88:91], s54 offen offset:2048 sc1
v_mfma_f32_16x16x32_bf16 v[152:155], a[4:7], a[220:223], v[152:155]
v_fmac_f32 v128, v9, v232
v_fmac_f32 v129, v9, v233
v_mfma_f32_16x16x32_bf16 v[152:155], a[0:3], a[204:207], v[152:155]
v_fmac_f32 v130, v9, v234
v_fmac_f32 v131, v9, v235
v_mfma_f32_16x16x32_bf16 v[156:159], a[8:11], a[204:207], v[156:159]
ds_read_b64_tr_b16 a[0:1], v4 offset:0
v_fmac_f32 v132, v9, v236
v_mfma_f32_16x16x32_bf16 v[156:159], a[12:15], a[220:223], v[156:159]
ds_read_b64_tr_b16 a[2:3], v4 offset:4096
v_fmac_f32 v133, v9, v237
v_mfma_f32_16x16x32_bf16 a[52:55], a[12:15], a[216:219], a[52:55]
ds_read_b64_tr_b16 a[4:5], v4 offset:8192
v_fmac_f32 v134, v9, v238
v_mfma_f32_16x16x32_bf16 a[52:55], a[8:11], a[200:203], a[52:55]
ds_read_b64_tr_b16 a[6:7], v4 offset:12288
v_fmac_f32 v135, v9, v239
v_mfma_f32_16x16x32_bf16 a[44:47], a[8:11], a[196:199], a[44:47]
v_cvt_pk_bf16_f32 v128, v128, v129
v_cvt_pk_bf16_f32 v129, v130, v131
v_mfma_f32_16x16x32_bf16 a[44:47], a[12:15], a[212:215], a[44:47]
v_cvt_pk_bf16_f32 v130, v132, v133
v_cvt_pk_bf16_f32 v131, v134, v135
v_mfma_f32_16x16x32_bf16 a[36:39], a[12:15], a[208:211], a[36:39]
buffer_store_dwordx4 v[128:131], v3, s[88:91], s54 offen offset:1024 sc1
v_mfma_f32_16x16x32_bf16 a[36:39], a[8:11], a[192:195], a[36:39]
s_waitcnt lgkmcnt(4)
v_fmac_f32 v120, v8, v224
v_fmac_f32 v121, v8, v225
v_mfma_f32_16x16x32_bf16 a[32:35], a[16:19], a[224:227], a[32:35]
ds_read_b64_tr_b16 a[8:9], v5 offset:0
v_fmac_f32 v122, v8, v226
v_mfma_f32_16x16x32_bf16 a[32:35], a[20:23], a[240:243], a[32:35]
ds_read_b64_tr_b16 a[10:11], v5 offset:4096
v_fmac_f32 v123, v8, v227
v_mfma_f32_16x16x32_bf16 a[40:43], a[20:23], a[244:247], a[40:43]
ds_read_b64_tr_b16 a[12:13], v5 offset:8192
v_fmac_f32 v124, v8, v228
v_mfma_f32_16x16x32_bf16 a[40:43], a[16:19], a[228:231], a[40:43]
ds_read_b64_tr_b16 a[14:15], v5 offset:12288
v_fmac_f32 v125, v8, v229
v_mfma_f32_16x16x32_bf16 a[48:51], a[16:19], a[232:235], a[48:51]
v_fmac_f32 v126, v8, v230
v_fmac_f32 v127, v8, v231
v_mfma_f32_16x16x32_bf16 a[48:51], a[20:23], a[248:251], a[48:51]
v_cvt_pk_bf16_f32 v120, v120, v121
v_cvt_pk_bf16_f32 v121, v122, v123
v_mfma_f32_16x16x32_bf16 v[152:155], a[20:23], a[252:255], v[152:155]
v_cvt_pk_bf16_f32 v122, v124, v125
v_cvt_pk_bf16_f32 v123, v126, v127
v_mfma_f32_16x16x32_bf16 v[152:155], a[16:19], a[236:239], v[152:155]
buffer_store_dwordx4 v[120:123], v3, s[88:91], s54 offen offset:0 sc1
v_mfma_f32_16x16x32_bf16 v[156:159], a[24:27], a[236:239], v[156:159]
ds_read_b64_tr_b16 a[16:17], v4 offset:16384
v_mfma_f32_16x16x32_bf16 v[156:159], a[28:31], a[252:255], v[156:159]
ds_read_b64_tr_b16 a[18:19], v4 offset:20480
v_mfma_f32_16x16x32_bf16 a[52:55], a[28:31], a[248:251], a[52:55]
ds_read_b64_tr_b16 a[20:21], v4 offset:24576
v_mfma_f32_16x16x32_bf16 a[52:55], a[24:27], a[232:235], a[52:55]
ds_read_b64_tr_b16 a[22:23], v4 offset:28672
v_mfma_f32_16x16x32_bf16 a[44:47], a[24:27], a[228:231], a[44:47]
s_bitcmp1_b32 s15, 1
s_cselect_b32 s50, s90, 0
v_mfma_f32_16x16x32_bf16 a[44:47], a[28:31], a[244:247], a[44:47]
buffer_load_dwordx4 v[176:179], v3, s[48:51], s45 offen offset:0 sc1
v_mfma_f32_16x16x32_bf16 a[36:39], a[28:31], a[240:243], a[36:39]
v_mfma_f32_16x16x32_bf16 a[36:39], a[24:27], a[224:227], a[36:39]
s_waitcnt lgkmcnt(4)
v_mfma_f32_16x16x32_bf16 a[32:35], a[0:3], a[64:67], a[32:35]
ds_read_b64_tr_b16 a[24:25], v5 offset:16384
v_mfma_f32_16x16x32_bf16 a[32:35], a[4:7], a[80:83], a[32:35]
ds_read_b64_tr_b16 a[26:27], v5 offset:20480
v_mfma_f32_16x16x32_bf16 a[40:43], a[4:7], a[84:87], a[40:43]
ds_read_b64_tr_b16 a[28:29], v5 offset:24576
v_mfma_f32_16x16x32_bf16 a[40:43], a[0:3], a[68:71], a[40:43]
ds_read_b64_tr_b16 a[30:31], v5 offset:28672
v_mfma_f32_16x16x32_bf16 a[48:51], a[0:3], a[72:75], a[48:51]
buffer_load_dwordx4 v[180:183], v3, s[48:51], s45 offen offset:1024 sc1
v_mfma_f32_16x16x32_bf16 a[48:51], a[4:7], a[88:91], a[48:51]
v_mfma_f32_16x16x32_bf16 v[152:155], a[4:7], a[92:95], v[152:155]
buffer_load_dwordx4 v[184:187], v3, s[48:51], s45 offen offset:2048 sc1
v_mfma_f32_16x16x32_bf16 v[152:155], a[0:3], a[76:79], v[152:155]
v_mfma_f32_16x16x32_bf16 v[156:159], a[8:11], a[76:79], v[156:159]
buffer_load_dwordx4 v[188:191], v3, s[48:51], s45 offen offset:3072 sc1
v_mfma_f32_16x16x32_bf16 v[156:159], a[12:15], a[92:95], v[156:159]
v_mfma_f32_16x16x32_bf16 a[52:55], a[12:15], a[88:91], a[52:55]
s_bitcmp1_b32 s15, 2
s_cselect_b32 s50, s90, 0
v_mfma_f32_16x16x32_bf16 a[52:55], a[8:11], a[72:75], a[52:55]
buffer_load_dwordx4 v[192:195], v3, s[48:51], s46 offen offset:0 sc1
v_mfma_f32_16x16x32_bf16 a[44:47], a[8:11], a[68:71], a[44:47]
v_mfma_f32_16x16x32_bf16 a[44:47], a[12:15], a[84:87], a[44:47]
buffer_load_dwordx4 v[196:199], v3, s[48:51], s46 offen offset:1024 sc1
v_mfma_f32_16x16x32_bf16 a[36:39], a[12:15], a[80:83], a[36:39]
v_mfma_f32_16x16x32_bf16 a[36:39], a[8:11], a[64:67], a[36:39]
s_waitcnt lgkmcnt(0)
v_mfma_f32_16x16x32_bf16 a[32:35], a[16:19], a[96:99], a[32:35]
buffer_load_dwordx4 v[200:203], v3, s[48:51], s46 offen offset:2048 sc1
v_mfma_f32_16x16x32_bf16 a[32:35], a[20:23], a[112:115], a[32:35]
v_mfma_f32_16x16x32_bf16 a[40:43], a[20:23], a[116:119], a[40:43]
buffer_load_dwordx4 v[204:207], v3, s[48:51], s46 offen offset:3072 sc1
v_mfma_f32_16x16x32_bf16 a[40:43], a[16:19], a[100:103], a[40:43]
v_mfma_f32_16x16x32_bf16 a[48:51], a[16:19], a[104:107], a[48:51]
v_mfma_f32_16x16x32_bf16 a[48:51], a[20:23], a[120:123], a[48:51]
v_mfma_f32_16x16x32_bf16 v[152:155], a[20:23], a[124:127], v[152:155]
v_mfma_f32_16x16x32_bf16 v[152:155], a[16:19], a[108:111], v[152:155]
v_mfma_f32_16x16x32_bf16 v[156:159], a[24:27], a[108:111], v[156:159]
v_mfma_f32_16x16x32_bf16 v[156:159], a[28:31], a[124:127], v[156:159]
v_mfma_f32_16x16x32_bf16 a[52:55], a[28:31], a[120:123], a[52:55]
v_mfma_f32_16x16x32_bf16 a[52:55], a[24:27], a[104:107], a[52:55]
v_mfma_f32_16x16x32_bf16 a[44:47], a[24:27], a[100:103], a[44:47]
v_mfma_f32_16x16x32_bf16 a[44:47], a[28:31], a[116:119], a[44:47]
v_mfma_f32_16x16x32_bf16 a[36:39], a[28:31], a[112:115], a[36:39]
v_mfma_f32_16x16x32_bf16 a[36:39], a[24:27], a[96:99], a[36:39]
s_cmp_eq_u32 s15, 7
s_cbranch_scc1 L_x_all
buffer_load_dword v14, v1, s[88:91], s44 offen sc1
L_x_all:
v_pk_fma_f32 v[48:49], v[152:153], v[10:11], v[48:49] op_sel:[0,1,0] op_sel_hi:[1,1,1]
v_pk_fma_f32 v[50:51], v[154:155], v[10:11], v[50:51] op_sel:[0,1,0] op_sel_hi:[1,1,1]
v_pk_fma_f32 v[52:53], v[156:157], v[10:11], v[52:53] op_sel:[0,1,0] op_sel_hi:[1,1,1]
v_pk_fma_f32 v[54:55], v[158:159], v[10:11], v[54:55] op_sel:[0,1,0] op_sel_hi:[1,1,1]
v_accvgpr_read_b32 v152, a48
v_accvgpr_read_b32 v153, a49
v_accvgpr_read_b32 v154, a50
v_accvgpr_read_b32 v155, a51
v_accvgpr_read_b32 v156, a52
v_accvgpr_read_b32 v157, a53
v_accvgpr_read_b32 v158, a54
v_accvgpr_read_b32 v159, a55
v_pk_fma_f32 v[40:41], v[152:153], v[10:11], v[40:41] op_sel_hi:[1,0,1]
v_pk_fma_f32 v[42:43], v[154:155], v[10:11], v[42:43] op_sel_hi:[1,0,1]
v_pk_fma_f32 v[44:45], v[156:157], v[10:11], v[44:45] op_sel_hi:[1,0,1]
v_pk_fma_f32 v[46:47], v[158:159], v[10:11], v[46:47] op_sel_hi:[1,0,1]
v_accvgpr_read_b32 v152, a40
v_accvgpr_read_b32 v153, a41
v_accvgpr_read_b32 v154, a42
v_accvgpr_read_b32 v155, a43
v_accvgpr_read_b32 v156, a44
v_accvgpr_read_b32 v157, a45
v_accvgpr_read_b32 v158, a46
v_accvgpr_read_b32 v159, a47
v_pk_fma_f32 v[32:33], v[152:153], v[8:9], v[32:33] op_sel:[0,1,0] op_sel_hi:[1,1,1]
v_pk_fma_f32 v[34:35], v[154:155], v[8:9], v[34:35] op_sel:[0,1,0] op_sel_hi:[1,1,1]
v_pk_fma_f32 v[36:37], v[156:157], v[8:9], v[36:37] op_sel:[0,1,0] op_sel_hi:[1,1,1]
v_pk_fma_f32 v[38:39], v[158:159], v[8:9], v[38:39] op_sel:[0,1,0] op_sel_hi:[1,1,1]
v_accvgpr_read_b32 v152, a32
v_accvgpr_read_b32 v153, a33
v_accvgpr_read_b32 v154, a34
v_accvgpr_read_b32 v155, a35
v_accvgpr_read_b32 v156, a36
v_accvgpr_read_b32 v157, a37
v_accvgpr_read_b32 v158, a38
v_accvgpr_read_b32 v159, a39
L_padC4:
s_cmp_eq_u32 s95, 1
s_cbranch_scc1 L_hopC_ret
v_pk_fma_f32 v[24:25], v[152:153], v[8:9], v[24:25] op_sel_hi:[1,0,1]
v_pk_fma_f32 v[26:27], v[154:155], v[8:9], v[26:27] op_sel_hi:[1,0,1]
v_pk_fma_f32 v[28:29], v[156:157], v[8:9], v[28:29] op_sel_hi:[1,0,1]
v_pk_fma_f32 v[30:31], v[158:159], v[8:9], v[30:31] op_sel_hi:[1,0,1]
s_mov_b32 s10, 0x3f80
s_mov_b32 s11, 0x3f800000
s_mov_b32 s92, 200000
s_bitcmp0_b32 s15, 0
s_cbranch_scc1 L_look_x1
s_waitcnt vmcnt(12)
L_spin_x1:
v_max3_u32 v60, v160, v161, 0
v_max3_u32 v60, v162, v163, v60
v_max3_u32 v60, v164, v165, v60
v_max3_u32 v60, v166, v167, v60
v_max3_u32 v60, v168, v169, v60
v_max3_u32 v60, v170, v171, v60
v_max3_u32 v60, v172, v173, v60
v_max3_u32 v60, v174, v175, v60
v_cmp_eq_u32 vcc, -1, v60
s_nop 1
s_cbranch_vccnz L_again_x1
L_spun_x1:
v_dot2c_f32_bf16 v24, s10, v160
v_dot2c_f32_bf16 v25, s11, v160
v_dot2c_f32_bf16 v26, s10, v161
v_dot2c_f32_bf16 v27, s11, v161
v_dot2c_f32_bf16 v28, s10, v162
v_dot2c_f32_bf16 v29, s11, v162
v_dot2c_f32_bf16 v30, s10, v163
v_dot2c_f32_bf16 v31, s11, v163
v_dot2c_f32_bf16 v32, s10, v164
v_dot2c_f32_bf16 v33, s11, v164
v_dot2c_f32_bf16 v34, s10, v165
v_dot2c_f32_bf16 v35, s11, v165
v_dot2c_f32_bf16 v36, s10, v166
v_dot2c_f32_bf16 v37, s11, v166
v_dot2c_f32_bf16 v38, s10, v167
v_dot2c_f32_bf16 v39, s11, v167
v_dot2c_f32_bf16 v40, s10, v168
v_dot2c_f32_bf16 v41, s11, v168
v_dot2c_f32_bf16 v42, s10, v169
v_dot2c_f32_bf16 v43, s11, v169
v_dot2c_f32_bf16 v44, s10, v170
v_dot2c_f32_bf16 v45, s11, v170
v_dot2c_f32_bf16 v46, s10, v171
v_dot2c_f32_bf16 v47, s11, v171
v_dot2c_f32_bf16 v48, s10, v172
v_dot2c_f32_bf16 v49, s11, v172
v_dot2c_f32_bf16 v50, s10, v173
v_dot2c_f32_bf16 v51, s11, v173
v_dot2c_f32_bf16 v52, s10, v174
v_dot2c_f32_bf16 v53, s11, v174
v_dot2c_f32_bf16 v54, s10, v175
v_dot2c_f32_bf16 v55, s11, v175
s_mov_b32 s92, 200000
s_bitcmp0_b32 s15, 1
s_cbranch_scc1 L_look_x2
s_waitcnt vmcnt(4)
L_spin_x2:
v_max3_u32 v60, v176, v177, 0
v_max3_u32 v60, v178, v179, v60
v_max3_u32 v60, v180, v181, v60
v_max3_u32 v60, v182, v183, v60
v_max3_u32 v60, v184, v185, v60
v_max3_u32 v60, v186, v187, v60
v_max3_u32 v60, v188, v189, v60
v_max3_u32 v60, v190, v191, v60
v_cmp_eq_u32 vcc, -1, v60
s_nop 1
s_cbranch_vccnz L_again_x2
L_spun_x2:
v_dot2c_f32_bf16 v24, s10, v176
v_dot2c_f32_bf16 v25, s11, v176
v_dot2c_f32_bf16 v26, s10, v177
v_dot2c_f32_bf16 v27, s11, v177
v_dot2c_f32_bf16 v28, s10, v178
v_dot2c_f32_bf16 v29, s11, v178
v_dot2c_f32_bf16 v30, s10, v179
v_dot2c_f32_bf16 v31, s11, v179
v_dot2c_f32_bf16 v32, s10, v180
v_dot2c_f32_bf16 v33, s11, v180
v_dot2c_f32_bf16 v34, s10, v181
v_dot2c_f32_bf16 v35, s11, v181
v_dot2c_f32_bf16 v36, s10, v182
v_dot2c_f32_bf16 v37, s11, v182
v_dot2c_f32_bf16 v38, s10, v183
v_dot2c_f32_bf16 v39, s11, v183
v_dot2c_f32_bf16 v40, s10, v184
v_dot2c_f32_bf16 v41, s11, v184
v_dot2c_f32_bf16 v42, s10, v185
v_dot2c_f32_bf16 v43, s11, v185
v_dot2c_f32_bf16 v44, s10, v186
v_dot2c_f32_bf16 v45, s11, v186
v_dot2c_f32_bf16 v46, s10, v187
v_dot2c_f32_bf16 v47, s11, v187
v_dot2c_f32_bf16 v48, s10, v188
v_dot2c_f32_bf16 v49, s11, v188
v_dot2c_f32_bf16 v50, s10, v189
v_dot2c_f32_bf16 v51, s11, v189
v_dot2c_f32_bf16 v52, s10, v190
v_dot2c_f32_bf16 v53, s11, v190
v_dot2c_f32_bf16 v54, s10, v191
v_dot2c_f32_bf16 v55, s11, v191
s_mov_b32 s92, 200000
s_bitcmp0_b32 s15, 2
s_cbranch_scc1 L_look_x3
s_waitcnt vmcnt(0)
L_spin_x3:
v_max3_u32 v60, v192, v193, 0
v_max3_u32 v60, v194, v195, v60
v_max3_u32 v60, v196, v197, v60
v_max3_u32 v60, v198, v199, v60
v_max3_u32 v60, v200, v201, v60
v_max3_u32 v60, v202, v203, v60
v_max3_u32 v60, v204, v205, v60
v_max3_u32 v60, v206, v207, v60
v_cmp_eq_u32 vcc, -1, v60
s_nop 1
s_cbranch_vccnz L_again_x3
L_spun_x3:
v_dot2c_f32_bf16 v24, s10, v192
v_dot2c_f32_bf16 v25, s11, v192
v_dot2c_f32_bf16 v26, s10, v193
v_dot2c_f32_bf16 v27, s11, v193
v_dot2c_f32_bf16 v28, s10, v194
v_dot2c_f32_bf16 v29, s11, v194
v_dot2c_f32_bf16 v30, s10, v195
v_dot2c_f32_bf16 v31, s11, v195
v_cvt_pk_bf16_f32 v24, v24, v25
v_cvt_pk_bf16_f32 v25, v26, v27
v_cvt_pk_bf16_f32 v26, v28, v29
v_cvt_pk_bf16_f32 v27, v30, v31
s_nop 1
v_permlane16_swap_b32 v24, v26
v_permlane16_swap_b32 v25, v27
buffer_store_dwordx4 v[24:27], v2, s[80:83], s28 offen sc1
v_dot2c_f32_bf16 v32, s10, v196
v_dot2c_f32_bf16 v33, s11, v196
v_dot2c_f32_bf16 v34, s10, v197
v_dot2c_f32_bf16 v35, s11, v197
v_dot2c_f32_bf16 v36, s10, v198
v_dot2c_f32_bf16 v37, s11, v198
v_dot2c_f32_bf16 v38, s10, v199
v_dot2c_f32_bf16 v39, s11, v199
v_cvt_pk_bf16_f32 v32, v32, v33
v_cvt_pk_bf16_f32 v33, v34, v35
v_cvt_pk_bf16_f32 v34, v36, v37
v_cvt_pk_bf16_f32 v35, v38, v39
s_nop 1
v_permlane16_swap_b32 v32, v34
v_permlane16_swap_b32 v33, v35
buffer_store_dwordx4 v[32:35], v2, s[80:83], s29 offen sc1
v_dot2c_f32_bf16 v40, s10, v200
v_dot2c_f32_bf16 v41, s11, v200
v_dot2c_f32_bf16 v42, s10, v201
v_dot2c_f32_bf16 v43, s11, v201
v_dot2c_f32_bf16 v44, s10, v202
v_dot2c_f32_bf16 v45, s11, v202
v_dot2c_f32_bf16 v46, s10, v203
v_dot2c_f32_bf16 v47, s11, v203
v_cvt_pk_bf16_f32 v40, v40, v41
v_cvt_pk_bf16_f32 v41, v42, v43
v_cvt_pk_bf16_f32 v42, v44, v45
v_cvt_pk_bf16_f32 v43, v46, v47
s_nop 1
v_permlane16_swap_b32 v40, v42
v_permlane16_swap_b32 v41, v43
buffer_store_dwordx4 v[40:43], v2, s[80:83], s30 offen sc1
v_dot2c_f32_bf16 v48, s10, v204
v_dot2c_f32_bf16 v49, s11, v204
v_dot2c_f32_bf16 v50, s10, v205
v_dot2c_f32_bf16 v51, s11, v205
v_dot2c_f32_bf16 v52, s10, v206
v_dot2c_f32_bf16 v53, s11, v206
v_dot2c_f32_bf16 v54, s10, v207
v_dot2c_f32_bf16 v55, s11, v207
v_cvt_pk_bf16_f32 v48, v48, v49
v_cvt_pk_bf16_f32 v49, v50, v51
v_cvt_pk_bf16_f32 v50, v52, v53
v_cvt_pk_bf16_f32 v51, v54, v55
s_nop 1
v_permlane16_swap_b32 v48, v50
v_permlane16_swap_b32 v49, v51
buffer_store_dwordx4 v[48:51], v2, s[80:83], s31 offen sc1
L_end:
s_endpgm
L_look_x1:
s_waitcnt vmcnt(0)
v_cmp_ne_u32 vcc, -1, v14
s_sub_u32 s92, s92, 1
s_cselect_b32 s8, 7, vcc_lo
s_andn2_b32 s8, s8, s15
s_or_b32 s15, s15, s8
s_bitcmp0_b32 s8, 0
s_cbranch_scc1 L_not_x11
buffer_load_dwordx4 v[160:163], v3, s[88:91], s44 offen offset:0 sc1
buffer_load_dwordx4 v[164:167], v3, s[88:91], s44 offen offset:1024 sc1
buffer_load_dwordx4 v[168:171], v3, s[88:91], s44 offen offset:2048 sc1
buffer_load_dwordx4 v[172:175], v3, s[88:91], s44 offen offset:3072 sc1
L_not_x11:
s_bitcmp0_b32 s8, 1
s_cbranch_scc1 L_not_x12
buffer_load_dwordx4 v[176:179], v3, s[88:91], s45 offen offset:0 sc1
buffer_load_dwordx4 v[180:183], v3, s[88:91], s45 offen offset:1024 sc1
buffer_load_dwordx4 v[184:187], v3, s[88:91], s45 offen offset:2048 sc1
buffer_load_dwordx4 v[188:191], v3, s[88:91], s45 offen offset:3072 sc1
L_not_x12:
s_bitcmp0_b32 s8, 2
s_cbranch_scc1 L_not_x13
buffer_load_dwordx4 v[192:195], v3, s[88:91], s46 offen offset:0 sc1
buffer_load_dwordx4 v[196:199], v3, s[88:91], s46 offen offset:1024 sc1
buffer_load_dwordx4 v[200:203], v3, s[88:91], s46 offen offset:2048 sc1
buffer_load_dwordx4 v[204:207], v3, s[88:91], s46 offen offset:3072 sc1
L_not_x13:
buffer_load_dword v14, v1, s[88:91], s44 offen sc1
s_bitcmp0_b32 s15, 0
s_cbranch_scc1 L_look_x1
s_mov_b32 s92, 200000
s_waitcnt vmcnt(1)
s_branch L_spin_x1
L_again_x1:
s_sub_u32 s92, s92, 1
s_cbranch_scc1 L_spun_x1
buffer_load_dwordx4 v[160:163], v3, s[88:91], s44 offen offset:0 sc1
buffer_load_dwordx4 v[164:167], v3, s[88:91], s44 offen offset:1024 sc1
buffer_load_dwordx4 v[168:171], v3, s[88:91], s44 offen offset:2048 sc1
buffer_load_dwordx4 v[172:175], v3, s[88:91], s44 offen offset:3072 sc1
s_waitcnt vmcnt(0)
s_branch L_spin_x1
L_look_x2:
s_waitcnt vmcnt(0)
v_cmp_ne_u32 vcc, -1, v14
s_sub_u32 s92, s92, 1
s_cselect_b32 s8, 7, vcc_lo
s_andn2_b32 s8, s8, s15
s_or_b32 s15, s15, s8
s_bitcmp0_b32 s8, 1
s_cbranch_scc1 L_not_x22
buffer_load_dwordx4 v[176:179], v3, s[88:91], s45 offen offset:0 sc1
buffer_load_dwordx4 v[180:183], v3, s[88:91], s45 offen offset:1024 sc1
buffer_load_dwordx4 v[184:187], v3, s[88:91], s45 offen offset:2048 sc1
buffer_load_dwordx4 v[188:191], v3, s[88:91], s45 offen offset:3072 sc1
L_not_x22:
s_bitcmp0_b32 s8, 2
s_cbranch_scc1 L_not_x23
buffer_load_dwordx4 v[192:195], v3, s[88:91], s46 offen offset:0 sc1
buffer_load_dwordx4 v[196:199], v3, s[88:91], s46 offen offset:1024 sc1
buffer_load_dwordx4 v[200:203], v3, s[88:91], s46 offen offset:2048 sc1
buffer_load_dwordx4 v[204:207], v3, s[88:91], s46 offen offset:3072 sc1
L_not_x23:
buffer_load_dword v14, v1, s[88:91], s44 offen sc1
s_bitcmp0_b32 s15, 1
s_cbranch_scc1 L_look_x2
s_mov_b32 s92, 200000
s_waitcnt vmcnt(1)
s_branch L_spin_x2
L_again_x2:
s_sub_u32 s92, s92, 1
s_cbranch_scc1 L_spun_x2
buffer_load_dwordx4 v[176:179], v3, s[88:91], s45 offen offset:0 sc1
buffer_load_dwordx4 v[180:183], v3, s[88:91], s45 offen offset:1024 sc1
buffer_load_dwordx4 v[184:187], v3, s[88:91], s45 offen offset:2048 sc1
buffer_load_dwordx4 v[188:191], v3, s[88:91], s45 offen offset:3072 sc1
s_waitcnt vmcnt(0)
s_branch L_spin_x2
L_look_x3:
s_waitcnt vmcnt(0)
v_cmp_ne_u32 vcc, -1, v14
s_sub_u32 s92, s92, 1
s_cselect_b32 s8, 7, vcc_lo
s_andn2_b32 s8, s8, s15
s_or_b32 s15, s15, s8
s_bitcmp0_b32 s8, 2
s_cbranch_scc1 L_not_x33
buffer_load_dwordx4 v[192:195], v3, s[88:91], s46 offen offset:0 sc1
buffer_load_dwordx4 v[196:199], v3, s[88:91], s46 offen offset:1024 sc1
buffer_load_dwordx4 v[200:203], v3, s[88:91], s46 offen offset:2048 sc1
buffer_load_dwordx4 v[204:207], v3, s[88:91], s46 offen offset:3072 sc1
L_not_x33:
buffer_load_dword v14, v1, s[88:91], s44 offen sc1
s_bitcmp0_b32 s15, 2
s_cbranch_scc1 L_look_x3
s_mov_b32 s92, 200000
s_waitcnt vmcnt(1)
s_branch L_spin_x3
L_again_x3:
s_sub_u32 s92, s92, 1
s_cbranch_scc1 L_spun_x3
buffer_load_dwordx4 v[192:195], v3, s[88:91], s46 offen offset:0 sc1
buffer_load_dwordx4 v[196:199], v3, s[88:91], s46 offen offset:1024 sc1
buffer_load_dwordx4 v[200:203], v3, s[88:91], s46 offen offset:2048 sc1
buffer_load_dwordx4 v[204:207], v3, s[88:91], s46 offen offset:3072 sc1
s_waitcnt vmcnt(0)
s_branch L_spin_x3
L_p4_a:
s_add_u32 s8, s31, 0x0
v_pk_mul_f32 v[224:225], v[224:225], v[22:23] op_sel_hi:[1,0]
v_pk_mul_f32 v[226:227], v[226:227], v[22:23] op_sel_hi:[1,0]
v_pk_mul_f32 v[228:229], v[228:229], v[22:23] op_sel_hi:[1,0]
v_pk_mul_f32 v[230:231], v[230:231], v[22:23] op_sel_hi:[1,0]
v_cvt_pk_bf16_f32 v224, v224, v225
v_cvt_pk_bf16_f32 v225, v226, v227
v_cvt_pk_bf16_f32 v226, v228, v229
v_cvt_pk_bf16_f32 v227, v230, v231
buffer_store_dwordx4 v[224:227], v3, s[88:91], s8 offen sc1
s_add_u32 s8, s31, 0x2000
v_pk_mul_f32 v[232:233], v[232:233], v[22:23] op_sel_hi:[1,0]
v_pk_mul_f32 v[234:235], v[234:235], v[22:23] op_sel_hi:[1,0]
v_pk_mul_f32 v[236:237], v[236:237], v[22:23] op_sel_hi:[1,0]
v_pk_mul_f32 v[238:239], v[238:239], v[22:23] op_sel_hi:[1,0]
v_cvt_pk_bf16_f32 v232, v232, v233
v_cvt_pk_bf16_f32 v233, v234, v235
v_cvt_pk_bf16_f32 v234, v236, v237
v_cvt_pk_bf16_f32 v235, v238, v239
buffer_store_dwordx4 v[232:235], v3, s[88:91], s8 offen sc1
s_add_u32 s8, s31, 0x4000
v_pk_mul_f32 v[240:241], v[240:241], v[22:23] op_sel_hi:[1,0]
v_pk_mul_f32 v[242:243], v[242:243], v[22:23] op_sel_hi:[1,0]
v_pk_mul_f32 v[244:245], v[244:245], v[22:23] op_sel_hi:[1,0]
v_pk_mul_f32 v[246:247], v[246:247], v[22:23] op_sel_hi:[1,0]
v_cvt_pk_bf16_f32 v240, v240, v241
v_cvt_pk_bf16_f32 v241, v242, v243
v_cvt_pk_bf16_f32 v242, v244, v245
v_cvt_pk_bf16_f32 v243, v246, v247
buffer_store_dwordx4 v[240:243], v3, s[88:91], s8 offen sc1
s_add_u32 s8, s31, 0x6000
v_pk_mul_f32 v[248:249], v[248:249], v[22:23] op_sel_hi:[1,0]
v_pk_mul_f32 v[250:251], v[250:251], v[22:23] op_sel_hi:[1,0]
v_pk_mul_f32 v[252:253], v[252:253], v[22:23] op_sel_hi:[1,0]
v_pk_mul_f32 v[254:255], v[254:255], v[22:23] op_sel_hi:[1,0]
v_cvt_pk_bf16_f32 v248, v248, v249
v_cvt_pk_bf16_f32 v249, v250, v251
v_cvt_pk_bf16_f32 v250, v252, v253
v_cvt_pk_bf16_f32 v251, v254, v255
buffer_store_dwordx4 v[248:251], v3, s[88:91], s8 offen sc1
v_mfma_f32_16x16x32_bf16 v[56:59], a[0:3], a[64:67], 0
ds_read_b64_tr_b16 a[24:25], v5 offset:512
v_and_b32 v6, 15, v0
v_mfma_f32_16x16x32_bf16 v[56:59], a[4:7], a[80:83], v[56:59]
ds_read_b64_tr_b16 a[26:27], v5 offset:4608
s_add_u32 s101, s101, 0x2000
v_mfma_f32_16x16x32_bf16 v[64:67], a[4:7], a[84:87], 0
ds_read_b64_tr_b16 a[28:29], v5 offset:8704
v_lshlrev_b32 v6, 2, v6
v_mfma_f32_16x16x32_bf16 v[64:67], a[0:3], a[68:71], v[64:67]
ds_read_b64_tr_b16 a[30:31], v5 offset:12800
v_and_b32 v1, 28, v6
v_mfma_f32_16x16x32_bf16 v[72:75], a[0:3], a[72:75], 0
v_or_b32 v7, 16, v1
v_mfma_f32_16x16x32_bf16 v[72:75], a[4:7], a[88:91], v[72:75]
buffer_load_dwordx4 a[224:227], v3, s[88:91], s101 offen sc1
v_mfma_f32_16x16x32_bf16 v[80:83], a[4:7], a[92:95], 0
v_mfma_f32_16x16x32_bf16 v[80:83], a[0:3], a[76:79], v[80:83]
v_mfma_f32_16x16x32_bf16 v[84:87], a[8:11], a[76:79], 0
ds_read_b64_tr_b16 a[0:1], v4 offset:768
v_mfma_f32_16x16x32_bf16 v[84:87], a[12:15], a[92:95], v[84:87]
ds_read_b64_tr_b16 a[2:3], v4 offset:4864
v_mfma_f32_16x16x32_bf16 v[76:79], a[12:15], a[88:91], 0
buffer_load_dwordx4 a[228:231], v3, s[88:91], s101 offen offset:1024 sc1
v_mfma_f32_16x16x32_bf16 v[76:79], a[8:11], a[72:75], v[76:79]
ds_read_b64_tr_b16 a[4:5], v4 offset:8960
v_mfma_f32_16x16x32_bf16 v[68:71], a[8:11], a[68:71], 0
ds_read_b64_tr_b16 a[6:7], v4 offset:13056
v_mfma_f32_16x16x32_bf16 v[68:71], a[12:15], a[84:87], v[68:71]
v_mfma_f32_16x16x32_bf16 v[60:63], a[12:15], a[80:83], 0
s_waitcnt lgkmcnt(4)
v_mfma_f32_16x16x32_bf16 v[60:63], a[8:11], a[64:67], v[60:63]
buffer_load_dwordx4 a[232:235], v3, s[88:91], s101 offen offset:2048 sc1
v_mfma_f32_16x16x32_bf16 v[88:91], a[16:19], a[64:67], 0
ds_read_b64_tr_b16 a[8:9], v5 offset:768
v_mfma_f32_16x16x32_bf16 v[88:91], a[20:23], a[80:83], v[88:91]
ds_read_b64_tr_b16 a[10:11], v5 offset:4864
v_mfma_f32_16x16x32_bf16 v[96:99], a[20:23], a[84:87], 0
ds_read_b64_tr_b16 a[12:13], v5 offset:8960
v_mfma_f32_16x16x32_bf16 v[96:99], a[16:19], a[68:71], v[96:99]
ds_read_b64_tr_b16 a[14:15], v5 offset:13056
v_mfma_f32_16x16x32_bf16 v[104:107], a[16:19], a[72:75], 0
buffer_load_dwordx4 a[236:239], v3, s[88:91], s101 offen offset:3072 sc1
v_mfma_f32_16x16x32_bf16 v[104:107], a[20:23], a[88:91], v[104:107]
s_add_u32 s101, s101, 0x2000
v_mfma_f32_16x16x32_bf16 v[112:115], a[20:23], a[92:95], 0
v_mfma_f32_16x16x32_bf16 v[112:115], a[16:19], a[76:79], v[112:115]
v_mfma_f32_16x16x32_bf16 v[116:119], a[24:27], a[76:79], 0
ds_read_b64_tr_b16 a[16:17], v4 offset:0
v_mfma_f32_16x16x32_bf16 v[116:119], a[28:31], a[92:95], v[116:119]
ds_read_b64_tr_b16 a[18:19], v4 offset:4096
v_mfma_f32_16x16x32_bf16 v[108:111], a[28:31], a[88:91], 0
buffer_load_dwordx4 a[240:243], v3, s[88:91], s101 offen sc1
v_mfma_f32_16x16x32_bf16 v[108:111], a[24:27], a[72:75], v[108:111]
ds_read_b64_tr_b16 a[20:21], v4 offset:8192
v_mfma_f32_16x16x32_bf16 v[100:103], a[24:27], a[68:71], 0
ds_read_b64_tr_b16 a[22:23], v4 offset:12288
v_mfma_f32_16x16x32_bf16 v[100:103], a[28:31], a[84:87], v[100:103]
v_mfma_f32_16x16x32_bf16 v[92:95], a[28:31], a[80:83], 0
s_waitcnt lgkmcnt(4)
v_mfma_f32_16x16x32_bf16 v[92:95], a[24:27], a[64:67], v[92:95]
buffer_load_dwordx4 a[244:247], v3, s[88:91], s101 offen offset:1024 sc1
v_mfma_f32_16x16x32_bf16 v[120:123], a[0:3], a[64:67], 0
ds_read_b64_tr_b16 a[24:25], v5 offset:0
v_mfma_f32_16x16x32_bf16 v[120:123], a[4:7], a[80:83], v[120:123]
ds_read_b64_tr_b16 a[26:27], v5 offset:4096
v_mfma_f32_16x16x32_bf16 v[128:131], a[4:7], a[84:87], 0
ds_read_b64_tr_b16 a[28:29], v5 offset:8192
v_mfma_f32_16x16x32_bf16 v[128:131], a[0:3], a[68:71], v[128:131]
ds_read_b64_tr_b16 a[30:31], v5 offset:12288
v_mfma_f32_16x16x32_bf16 v[136:139], a[0:3], a[72:75], 0
buffer_load_dwordx4 a[248:251], v3, s[88:91], s101 offen offset:2048 sc1
v_mfma_f32_16x16x32_bf16 v[136:139], a[4:7], a[88:91], v[136:139]
v_mfma_f32_16x16x32_bf16 v[144:147], a[4:7], a[92:95], 0
s_waitcnt vmcnt(7)
v_mfma_f32_16x16x32_bf16 v[144:147], a[0:3], a[76:79], v[144:147]
s_barrier
s_cmp_lg_u32 s4, 0
s_cbranch_scc1 L_flag_seta
s_lshl_b32 s8, s6, 5
s_add_u32 s8, s8, s5
s_and_b32 s92, s8, 0xf8
s_mul_i32 s92, s92, 7
s_add_u32 s8, s8, s92
s_lshl_b32 s8, s8, 2
s_add_u32 s8, s8, 0x3704000
v_mov_b32 v17, 1
s_mov_b64 exec, 1
buffer_store_dword v17, off, s[88:91], s8 sc1
s_mov_b64 exec, -1
L_flag_seta:
v_mfma_f32_16x16x32_bf16 v[148:151], a[8:11], a[76:79], 0
ds_read_b64_tr_b16 a[0:1], v4 offset:16640
v_mfma_f32_16x16x32_bf16 v[148:151], a[12:15], a[92:95], v[148:151]
buffer_load_dwordx4 a[252:255], v3, s[88:91], s101 offen offset:3072 sc1
v_mfma_f32_16x16x32_bf16 v[140:143], a[12:15], a[88:91], 0
ds_read_b64_tr_b16 a[2:3], v4 offset:20736
s_add_u32 m0, s17, 0x24000
v_mfma_f32_16x16x32_bf16 v[140:143], a[8:11], a[72:75], v[140:143]
ds_read_b64_tr_b16 a[4:5], v4 offset:24832
v_add_u32 v12, 0x20000, v12
v_mfma_f32_16x16x32_bf16 v[132:135], a[8:11], a[68:71], 0
ds_read_b64_tr_b16 a[6:7], v4 offset:28928
v_mfma_f32_16x16x32_bf16 v[132:135], a[12:15], a[84:87], v[132:135]
v_mfma_f32_16x16x32_bf16 v[124:127], a[12:15], a[80:83], 0
buffer_load_dwordx4 v12, s[72:75], 0 offen lds
v_mfma_f32_16x16x32_bf16 v[124:127], a[8:11], a[64:67], v[124:127]
s_waitcnt lgkmcnt(4)
v_add_u32 v13, 0x20000, v13
v_mfma_f32_16x16x32_bf16 v[24:27], a[16:19], a[64:67], 0
ds_read_b64_tr_b16 a[8:9], v5 offset:16640
v_mfma_f32_16x16x32_bf16 v[24:27], a[20:23], a[80:83], v[24:27]
ds_read_b64_tr_b16 a[10:11], v5 offset:20736
v_mfma_f32_16x16x32_bf16 v[32:35], a[20:23], a[84:87], 0
ds_read_b64_tr_b16 a[12:13], v5 offset:24832
v_mfma_f32_16x16x32_bf16 v[32:35], a[16:19], a[68:71], v[32:35]
ds_read_b64_tr_b16 a[14:15], v5 offset:28928
v_mfma_f32_16x16x32_bf16 v[40:43], a[16:19], a[72:75], 0
buffer_load_dwordx4 v13, s[72:75], 0 offen offset:1024 lds
v_mfma_f32_16x16x32_bf16 v[40:43], a[20:23], a[88:91], v[40:43]
v_mfma_f32_16x16x32_bf16 v[48:51], a[20:23], a[92:95], 0
v_mfma_f32_16x16x32_bf16 v[48:51], a[16:19], a[76:79], v[48:51]
v_mfma_f32_16x16x32_bf16 v[52:55], a[24:27], a[76:79], 0
ds_read_b64_tr_b16 a[16:17], v4 offset:16896
v_mfma_f32_16x16x32_bf16 v[52:55], a[28:31], a[92:95], v[52:55]
buffer_load_dwordx4 v12, s[72:75], s12 offen offset:2048 lds
v_mfma_f32_16x16x32_bf16 v[44:47], a[28:31], a[88:91], 0
ds_read_b64_tr_b16 a[18:19], v4 offset:20992
v_mfma_f32_16x16x32_bf16 v[44:47], a[24:27], a[72:75], v[44:47]
ds_read_b64_tr_b16 a[20:21], v4 offset:25088
v_mfma_f32_16x16x32_bf16 v[36:39], a[24:27], a[68:71], 0
ds_read_b64_tr_b16 a[22:23], v4 offset:29184
v_mfma_f32_16x16x32_bf16 v[36:39], a[28:31], a[84:87], v[36:39]
v_mfma_f32_16x16x32_bf16 v[28:31], a[28:31], a[80:83], 0
buffer_load_dwordx4 v13, s[72:75], s12 offen offset:3072 lds
v_mfma_f32_16x16x32_bf16 v[28:31], a[24:27], a[64:67], v[28:31]
s_waitcnt lgkmcnt(4)
s_add_u32 s101, s101, 0x2000
v_mfma_f32_16x16x32_bf16 v[56:59], a[0:3], a[96:99], v[56:59]
ds_read_b64_tr_b16 a[24:25], v5 offset:16896
v_mfma_f32_16x16x32_bf16 v[56:59], a[4:7], a[112:115], v[56:59]
ds_read_b64_tr_b16 a[26:27], v5 offset:20992
v_mfma_f32_16x16x32_bf16 v[64:67], a[4:7], a[116:119], v[64:67]
ds_read_b64_tr_b16 a[28:29], v5 offset:25088
v_mfma_f32_16x16x32_bf16 v[64:67], a[0:3], a[100:103], v[64:67]
buffer_load_dwordx4 a[128:131], v3, s[88:91], s101 offen sc1
v_mfma_f32_16x16x32_bf16 v[72:75], a[0:3], a[104:107], v[72:75]
ds_read_b64_tr_b16 a[30:31], v5 offset:29184
v_mfma_f32_16x16x32_bf16 v[72:75], a[4:7], a[120:123], v[72:75]
v_mfma_f32_16x16x32_bf16 v[80:83], a[4:7], a[124:127], v[80:83]
v_mfma_f32_16x16x32_bf16 v[80:83], a[0:3], a[108:111], v[80:83]
v_mfma_f32_16x16x32_bf16 v[84:87], a[8:11], a[108:111], v[84:87]
buffer_load_dwordx4 a[132:135], v3, s[88:91], s101 offen offset:1024 sc1
v_mfma_f32_16x16x32_bf16 v[84:87], a[12:15], a[124:127], v[84:87]
ds_read_b64_tr_b16 a[0:1], v4 offset:17152
v_mfma_f32_16x16x32_bf16 v[76:79], a[12:15], a[120:123], v[76:79]
ds_read_b64_tr_b16 a[2:3], v4 offset:21248
v_mfma_f32_16x16x32_bf16 v[76:79], a[8:11], a[104:107], v[76:79]
ds_read_b64_tr_b16 a[4:5], v4 offset:25344
v_mfma_f32_16x16x32_bf16 v[68:71], a[8:11], a[100:103], v[68:71]
ds_read_b64_tr_b16 a[6:7], v4 offset:29440
v_mfma_f32_16x16x32_bf16 v[68:71], a[12:15], a[116:119], v[68:71]
v_mfma_f32_16x16x32_bf16 v[60:63], a[12:15], a[112:115], v[60:63]
buffer_load_dwordx4 a[136:139], v3, s[88:91], s101 offen offset:2048 sc1
v_mfma_f32_16x16x32_bf16 v[60:63], a[8:11], a[96:99], v[60:63]
s_waitcnt lgkmcnt(4)
v_mfma_f32_16x16x32_bf16 v[88:91], a[16:19], a[96:99], v[88:91]
ds_read_b64_tr_b16 a[8:9], v5 offset:17152
v_mfma_f32_16x16x32_bf16 v[88:91], a[20:23], a[112:115], v[88:91]
ds_read_b64_tr_b16 a[10:11], v5 offset:21248
v_mfma_f32_16x16x32_bf16 v[96:99], a[20:23], a[116:119], v[96:99]
ds_read_b64_tr_b16 a[12:13], v5 offset:25344
v_mfma_f32_16x16x32_bf16 v[96:99], a[16:19], a[100:103], v[96:99]
buffer_load_dwordx4 a[140:143], v3, s[88:91], s101 offen offset:3072 sc1
v_mfma_f32_16x16x32_bf16 v[104:107], a[16:19], a[104:107], v[104:107]
ds_read_b64_tr_b16 a[14:15], v5 offset:29440
s_add_u32 s101, s101, 0x2000
v_mfma_f32_16x16x32_bf16 v[104:107], a[20:23], a[120:123], v[104:107]
v_mfma_f32_16x16x32_bf16 v[112:115], a[20:23], a[124:127], v[112:115]
v_mfma_f32_16x16x32_bf16 v[112:115], a[16:19], a[108:111], v[112:115]
v_mfma_f32_16x16x32_bf16 v[116:119], a[24:27], a[108:111], v[116:119]
buffer_load_dwordx4 a[144:147], v3, s[88:91], s101 offen sc1
v_mfma_f32_16x16x32_bf16 v[116:119], a[28:31], a[124:127], v[116:119]
ds_read_b64_tr_b16 a[16:17], v4 offset:16384
v_mfma_f32_16x16x32_bf16 v[108:111], a[28:31], a[120:123], v[108:111]
ds_read_b64_tr_b16 a[18:19], v4 offset:20480
v_mfma_f32_16x16x32_bf16 v[108:111], a[24:27], a[104:107], v[108:111]
ds_read_b64_tr_b16 a[20:21], v4 offset:24576
v_mfma_f32_16x16x32_bf16 v[100:103], a[24:27], a[100:103], v[100:103]
ds_read_b64_tr_b16 a[22:23], v4 offset:28672
v_mfma_f32_16x16x32_bf16 v[100:103], a[28:31], a[116:119], v[100:103]
buffer_load_dwordx4 a[148:151], v3, s[88:91], s101 offen offset:1024 sc1
v_mfma_f32_16x16x32_bf16 v[92:95], a[28:31], a[112:115], v[92:95]
v_mfma_f32_16x16x32_bf16 v[92:95], a[24:27], a[96:99], v[92:95]
s_waitcnt lgkmcnt(4)
v_mfma_f32_16x16x32_bf16 v[120:123], a[0:3], a[96:99], v[120:123]
ds_read_b64_tr_b16 a[24:25], v5 offset:16384
v_mfma_f32_16x16x32_bf16 v[120:123], a[4:7], a[112:115], v[120:123]
ds_read_b64_tr_b16 a[26:27], v5 offset:20480
v_mfma_f32_16x16x32_bf16 v[128:131], a[4:7], a[116:119], v[128:131]
buffer_load_dwordx4 a[152:155], v3, s[88:91], s101 offen offset:2048 sc1
v_mfma_f32_16x16x32_bf16 v[128:131], a[0:3], a[100:103], v[128:131]
ds_read_b64_tr_b16 a[28:29], v5 offset:24576
v_mfma_f32_16x16x32_bf16 v[136:139], a[0:3], a[104:107], v[136:139]
ds_read_b64_tr_b16 a[30:31], v5 offset:28672
v_mfma_f32_16x16x32_bf16 v[136:139], a[4:7], a[120:123], v[136:139]
v_mfma_f32_16x16x32_bf16 v[144:147], a[4:7], a[124:127], v[144:147]
s_waitcnt vmcnt(7)
v_mfma_f32_16x16x32_bf16 v[144:147], a[0:3], a[108:111], v[144:147]
s_barrier
v_mfma_f32_16x16x32_bf16 v[148:151], a[8:11], a[108:111], v[148:151]
buffer_load_dwordx4 a[156:159], v3, s[88:91], s101 offen offset:3072 sc1
v_mfma_f32_16x16x32_bf16 v[148:151], a[12:15], a[124:127], v[148:151]
ds_read_b64_tr_b16 a[0:1], v15 offset:16640
s_add_u32 m0, s17, 0x18000
v_mfma_f32_16x16x32_bf16 v[140:143], a[12:15], a[120:123], v[140:143]
ds_read_b64_tr_b16 a[2:3], v15 offset:20736
v_add_u32 v12, 0x20000, v12
v_mfma_f32_16x16x32_bf16 v[140:143], a[8:11], a[104:107], v[140:143]
ds_read_b64_tr_b16 a[4:5], v15 offset:24832
v_mfma_f32_16x16x32_bf16 v[132:135], a[8:11], a[100:103], v[132:135]
ds_read_b64_tr_b16 a[6:7], v15 offset:28928
v_mfma_f32_16x16x32_bf16 v[132:135], a[12:15], a[116:119], v[132:135]
buffer_load_dwordx4 v12, s[72:75], 0 offen lds
v_mfma_f32_16x16x32_bf16 v[124:127], a[12:15], a[112:115], v[124:127]
v_add_u32 v13, 0x20000, v13
v_mfma_f32_16x16x32_bf16 v[124:127], a[8:11], a[96:99], v[124:127]
s_waitcnt lgkmcnt(4)
v_mfma_f32_16x16x32_bf16 v[24:27], a[16:19], a[96:99], v[24:27]
ds_read_b64_tr_b16 a[8:9], v19 offset:16640
v_mfma_f32_16x16x32_bf16 v[24:27], a[20:23], a[112:115], v[24:27]
ds_read_b64_tr_b16 a[10:11], v19 offset:20736
v_mfma_f32_16x16x32_bf16 v[32:35], a[20:23], a[116:119], v[32:35]
buffer_load_dwordx4 v13, s[72:75], 0 offen offset:1024 lds
v_mfma_f32_16x16x32_bf16 v[32:35], a[16:19], a[100:103], v[32:35]
ds_read_b64_tr_b16 a[12:13], v19 offset:24832
v_mfma_f32_16x16x32_bf16 v[40:43], a[16:19], a[104:107], v[40:43]
ds_read_b64_tr_b16 a[14:15], v19 offset:28928
v_mfma_f32_16x16x32_bf16 v[40:43], a[20:23], a[120:123], v[40:43]
v_mfma_f32_16x16x32_bf16 v[48:51], a[20:23], a[124:127], v[48:51]
v_mfma_f32_16x16x32_bf16 v[48:51], a[16:19], a[108:111], v[48:51]
buffer_load_dwordx4 v12, s[72:75], s12 offen offset:2048 lds
v_mfma_f32_16x16x32_bf16 v[52:55], a[24:27], a[108:111], v[52:55]
ds_read_b64_tr_b16 a[16:17], v15 offset:16896
v_mfma_f32_16x16x32_bf16 v[52:55], a[28:31], a[124:127], v[52:55]
ds_read_b64_tr_b16 a[18:19], v15 offset:20992
v_mfma_f32_16x16x32_bf16 v[44:47], a[28:31], a[120:123], v[44:47]
ds_read_b64_tr_b16 a[20:21], v15 offset:25088
v_mfma_f32_16x16x32_bf16 v[44:47], a[24:27], a[104:107], v[44:47]
ds_read_b64_tr_b16 a[22:23], v15 offset:29184
v_mfma_f32_16x16x32_bf16 v[36:39], a[24:27], a[100:103], v[36:39]
v_mfma_f32_16x16x32_bf16 v[36:39], a[28:31], a[116:119], v[36:39]
buffer_load_dwordx4 v13, s[72:75], s12 offen offset:3072 lds
v_mfma_f32_16x16x32_bf16 v[28:31], a[28:31], a[112:115], v[28:31]
s_add_u32 s101, s101, 0x2000
v_mfma_f32_16x16x32_bf16 v[28:31], a[24:27], a[96:99], v[28:31]
s_waitcnt lgkmcnt(4)
v_mfma_f32_16x16x32_bf16 v[56:59], a[0:3], a[224:227], v[56:59]
ds_read_b64_tr_b16 a[24:25], v19 offset:16896
v_mfma_f32_16x16x32_bf16 v[56:59], a[4:7], a[240:243], v[56:59]
ds_read_b64_tr_b16 a[26:27], v19 offset:20992
v_mfma_f32_16x16x32_bf16 v[64:67], a[4:7], a[244:247], v[64:67]
buffer_load_dwordx4 a[160:163], v3, s[88:91], s101 offen sc1
v_mfma_f32_16x16x32_bf16 v[64:67], a[0:3], a[228:231], v[64:67]
ds_read_b64_tr_b16 a[28:29], v19 offset:25088
v_mfma_f32_16x16x32_bf16 v[72:75], a[0:3], a[232:235], v[72:75]
ds_read_b64_tr_b16 a[30:31], v19 offset:29184
v_mfma_f32_16x16x32_bf16 v[72:75], a[4:7], a[248:251], v[72:75]
v_mfma_f32_16x16x32_bf16 v[80:83], a[4:7], a[252:255], v[80:83]
v_mfma_f32_16x16x32_bf16 v[80:83], a[0:3], a[236:239], v[80:83]
buffer_load_dwordx4 a[164:167], v3, s[88:91], s101 offen offset:1024 sc1
v_mfma_f32_16x16x32_bf16 v[84:87], a[8:11], a[236:239], v[84:87]
ds_read_b64_tr_b16 a[0:1], v15 offset:17152
v_mfma_f32_16x16x32_bf16 v[84:87], a[12:15], a[252:255], v[84:87]
buffer_load_dword v14, v7, s[88:91], s24 offen sc1
v_mfma_f32_16x16x32_bf16 v[76:79], a[12:15], a[248:251], v[76:79]
ds_read_b64_tr_b16 a[2:3], v15 offset:21248
v_mfma_f32_16x16x32_bf16 v[76:79], a[8:11], a[232:235], v[76:79]
ds_read_b64_tr_b16 a[4:5], v15 offset:25344
v_mfma_f32_16x16x32_bf16 v[68:71], a[8:11], a[228:231], v[68:71]
buffer_load_dwordx4 a[168:171], v3, s[88:91], s101 offen offset:2048 sc1
v_mfma_f32_16x16x32_bf16 v[68:71], a[12:15], a[244:247], v[68:71]
ds_read_b64_tr_b16 a[6:7], v15 offset:29440
v_mfma_f32_16x16x32_bf16 v[60:63], a[12:15], a[240:243], v[60:63]
v_mfma_f32_16x16x32_bf16 v[60:63], a[8:11], a[224:227], v[60:63]
s_waitcnt lgkmcnt(4)
v_mfma_f32_16x16x32_bf16 v[88:91], a[16:19], a[224:227], v[88:91]
ds_read_b64_tr_b16 a[8:9], v19 offset:17152
v_mfma_f32_16x16x32_bf16 v[88:91], a[20:23], a[240:243], v[88:91]
buffer_load_dwordx4 a[172:175], v3, s[88:91], s101 offen offset:3072 sc1
v_mfma_f32_16x16x32_bf16 v[96:99], a[20:23], a[244:247], v[96:99]
ds_read_b64_tr_b16 a[10:11], v19 offset:21248
s_add_u32 s101, s101, 0x2000
v_mfma_f32_16x16x32_bf16 v[96:99], a[16:19], a[228:231], v[96:99]
ds_read_b64_tr_b16 a[12:13], v19 offset:25344
v_mfma_f32_16x16x32_bf16 v[104:107], a[16:19], a[232:235], v[104:107]
ds_read_b64_tr_b16 a[14:15], v19 offset:29440
v_mfma_f32_16x16x32_bf16 v[104:107], a[20:23], a[248:251], v[104:107]
v_mfma_f32_16x16x32_bf16 v[112:115], a[20:23], a[252:255], v[112:115]
v_mfma_f32_16x16x32_bf16 v[112:115], a[16:19], a[236:239], v[112:115]
buffer_load_dwordx4 a[176:179], v3, s[88:91], s101 offen sc1
v_mfma_f32_16x16x32_bf16 v[116:119], a[24:27], a[236:239], v[116:119]
ds_read_b64_tr_b16 a[16:17], v15 offset:16384
v_mfma_f32_16x16x32_bf16 v[116:119], a[28:31], a[252:255], v[116:119]
ds_read_b64_tr_b16 a[18:19], v15 offset:20480
v_mfma_f32_16x16x32_bf16 v[108:111], a[28:31], a[248:251], v[108:111]
ds_read_b64_tr_b16 a[20:21], v15 offset:24576
v_mfma_f32_16x16x32_bf16 v[108:111], a[24:27], a[232:235], v[108:111]
ds_read_b64_tr_b16 a[22:23], v15 offset:28672
v_mfma_f32_16x16x32_bf16 v[100:103], a[24:27], a[228:231], v[100:103]
buffer_load_dwordx4 a[180:183], v3, s[88:91], s101 offen offset:1024 sc1
v_mfma_f32_16x16x32_bf16 v[100:103], a[28:31], a[244:247], v[100:103]
v_mfma_f32_16x16x32_bf16 v[92:95], a[28:31], a[240:243], v[92:95]
v_mfma_f32_16x16x32_bf16 v[92:95], a[24:27], a[224:227], v[92:95]
s_waitcnt lgkmcnt(4)
v_mfma_f32_16x16x32_bf16 v[120:123], a[0:3], a[224:227], v[120:123]
ds_read_b64_tr_b16 a[24:25], v19 offset:16384
v_mfma_f32_16x16x32_bf16 v[120:123], a[4:7], a[240:243], v[120:123]
buffer_load_dwordx4 a[184:187], v3, s[88:91], s101 offen offset:2048 sc1
v_mfma_f32_16x16x32_bf16 v[128:131], a[4:7], a[244:247], v[128:131]
ds_read_b64_tr_b16 a[26:27], v19 offset:20480
v_mfma_f32_16x16x32_bf16 v[128:131], a[0:3], a[228:231], v[128:131]
ds_read_b64_tr_b16 a[28:29], v19 offset:24576
v_mfma_f32_16x16x32_bf16 v[136:139], a[0:3], a[232:235], v[136:139]
ds_read_b64_tr_b16 a[30:31], v19 offset:28672
v_mfma_f32_16x16x32_bf16 v[136:139], a[4:7], a[248:251], v[136:139]
v_mfma_f32_16x16x32_bf16 v[144:147], a[4:7], a[252:255], v[144:147]
s_waitcnt vmcnt(8)
v_mfma_f32_16x16x32_bf16 v[144:147], a[0:3], a[236:239], v[144:147]
s_barrier
v_mfma_f32_16x16x32_bf16 v[148:151], a[8:11], a[236:239], v[148:151]
buffer_load_dwordx4 a[188:191], v3, s[88:91], s101 offen offset:3072 sc1
v_mfma_f32_16x16x32_bf16 v[148:151], a[12:15], a[252:255], v[148:151]
ds_read_b64_tr_b16 a[0:1], v4 offset:33024
s_add_u32 m0, s17, 0x1c000
v_mfma_f32_16x16x32_bf16 v[140:143], a[12:15], a[248:251], v[140:143]
ds_read_b64_tr_b16 a[2:3], v4 offset:37120
v_add_u32 v12, 0x20000, v12
v_mfma_f32_16x16x32_bf16 v[140:143], a[8:11], a[232:235], v[140:143]
ds_read_b64_tr_b16 a[4:5], v4 offset:41216
v_mfma_f32_16x16x32_bf16 v[132:135], a[8:11], a[228:231], v[132:135]
buffer_load_dwordx4 v12, s[72:75], 0 offen lds
v_mfma_f32_16x16x32_bf16 v[132:135], a[12:15], a[244:247], v[132:135]
ds_read_b64_tr_b16 a[6:7], v4 offset:45312
v_add_u32 v13, 0x20000, v13
v_mfma_f32_16x16x32_bf16 v[124:127], a[12:15], a[240:243], v[124:127]
v_mfma_f32_16x16x32_bf16 v[124:127], a[8:11], a[224:227], v[124:127]
s_waitcnt lgkmcnt(4)
v_mfma_f32_16x16x32_bf16 v[24:27], a[16:19], a[224:227], v[24:27]
ds_read_b64_tr_b16 a[8:9], v5 offset:33024
v_mfma_f32_16x16x32_bf16 v[24:27], a[20:23], a[240:243], v[24:27]
buffer_load_dwordx4 v13, s[72:75], 0 offen offset:1024 lds
v_mfma_f32_16x16x32_bf16 v[32:35], a[20:23], a[244:247], v[32:35]
ds_read_b64_tr_b16 a[10:11], v5 offset:37120
v_mfma_f32_16x16x32_bf16 v[32:35], a[16:19], a[228:231], v[32:35]
ds_read_b64_tr_b16 a[12:13], v5 offset:41216
v_mfma_f32_16x16x32_bf16 v[40:43], a[16:19], a[232:235], v[40:43]
ds_read_b64_tr_b16 a[14:15], v5 offset:45312
v_mfma_f32_16x16x32_bf16 v[40:43], a[20:23], a[248:251], v[40:43]
v_mfma_f32_16x16x32_bf16 v[48:51], a[20:23], a[252:255], v[48:51]
buffer_load_dwordx4 v12, s[72:75], s12 offen offset:2048 lds
v_mfma_f32_16x16x32_bf16 v[48:51], a[16:19], a[236:239], v[48:51]
v_mfma_f32_16x16x32_bf16 v[52:55], a[24:27], a[236:239], v[52:55]
ds_read_b64_tr_b16 a[16:17], v4 offset:33280
v_mfma_f32_16x16x32_bf16 v[52:55], a[28:31], a[252:255], v[52:55]
ds_read_b64_tr_b16 a[18:19], v4 offset:37376
v_mfma_f32_16x16x32_bf16 v[44:47], a[28:31], a[248:251], v[44:47]
ds_read_b64_tr_b16 a[20:21], v4 offset:41472
v_mfma_f32_16x16x32_bf16 v[44:47], a[24:27], a[232:235], v[44:47]
buffer_load_dwordx4 v13, s[72:75], s12 offen offset:3072 lds
v_mfma_f32_16x16x32_bf16 v[36:39], a[24:27], a[228:231], v[36:39]
ds_read_b64_tr_b16 a[22:23], v4 offset:45568
s_add_u32 s63, s101, s26
v_mfma_f32_16x16x32_bf16 v[36:39], a[28:31], a[244:247], v[36:39]
s_add_u32 s101, s63, s60
v_mfma_f32_16x16x32_bf16 v[28:31], a[28:31], a[240:243], v[28:31]
v_mfma_f32_16x16x32_bf16 v[28:31], a[24:27], a[224:227], v[28:31]
s_waitcnt vmcnt(10)
s_waitcnt lgkmcnt(4)
s_mov_b32 s92, 200000
L_spin_ca:
v_cmp_eq_u32 vcc, 0, v14
s_nop 4
s_cbranch_vccz L_spun_ca
s_sub_u32 s92, s92, 1
s_cbranch_scc1 L_spun_ca
s_sleep 6
buffer_load_dword v14, v7, s[88:91], s24 offen sc1
s_waitcnt vmcnt(0)
s_branch L_spin_ca
L_spun_ca:
v_mfma_f32_16x16x32_bf16 v[56:59], a[0:3], a[128:131], v[56:59]
buffer_load_dwordx4 a[192:195], v3, s[88:91], s101 offen sc1
v_mfma_f32_16x16x32_bf16 v[56:59], a[4:7], a[144:147], v[56:59]
ds_read_b64_tr_b16 a[24:25], v5 offset:33280
v_mfma_f32_16x16x32_bf16 v[64:67], a[4:7], a[148:151], v[64:67]
ds_read_b64_tr_b16 a[26:27], v5 offset:37376
v_mfma_f32_16x16x32_bf16 v[64:67], a[0:3], a[132:135], v[64:67]
ds_read_b64_tr_b16 a[28:29], v5 offset:41472
v_mfma_f32_16x16x32_bf16 v[72:75], a[0:3], a[136:139], v[72:75]
ds_read_b64_tr_b16 a[30:31], v5 offset:45568
v_mfma_f32_16x16x32_bf16 v[72:75], a[4:7], a[152:155], v[72:75]
buffer_load_dwordx4 a[196:199], v3, s[88:91], s101 offen offset:1024 sc1
v_mfma_f32_16x16x32_bf16 v[80:83], a[4:7], a[156:159], v[80:83]
v_mfma_f32_16x16x32_bf16 v[80:83], a[0:3], a[140:143], v[80:83]
v_mfma_f32_16x16x32_bf16 v[84:87], a[8:11], a[140:143], v[84:87]
ds_read_b64_tr_b16 a[0:1], v4 offset:33536
v_mfma_f32_16x16x32_bf16 v[84:87], a[12:15], a[156:159], v[84:87]
ds_read_b64_tr_b16 a[2:3], v4 offset:37632
v_mfma_f32_16x16x32_bf16 v[76:79], a[12:15], a[152:155], v[76:79]
ds_read_b64_tr_b16 a[4:5], v4 offset:41728
v_mfma_f32_16x16x32_bf16 v[76:79], a[8:11], a[136:139], v[76:79]
buffer_load_dwordx4 a[200:203], v3, s[88:91], s101 offen offset:2048 sc1
v_mfma_f32_16x16x32_bf16 v[68:71], a[8:11], a[132:135], v[68:71]
ds_read_b64_tr_b16 a[6:7], v4 offset:45824
v_mfma_f32_16x16x32_bf16 v[68:71], a[12:15], a[148:151], v[68:71]
v_mfma_f32_16x16x32_bf16 v[60:63], a[12:15], a[144:147], v[60:63]
v_mfma_f32_16x16x32_bf16 v[60:63], a[8:11], a[128:131], v[60:63]
s_waitcnt lgkmcnt(4)
v_mfma_f32_16x16x32_bf16 v[88:91], a[16:19], a[128:131], v[88:91]
buffer_load_dwordx4 a[204:207], v3, s[88:91], s101 offen offset:3072 sc1
v_mfma_f32_16x16x32_bf16 v[88:91], a[20:23], a[144:147], v[88:91]
ds_read_b64_tr_b16 a[8:9], v5 offset:33536
s_add_u32 s101, s101, 0x2000
v_mfma_f32_16x16x32_bf16 v[96:99], a[20:23], a[148:151], v[96:99]
ds_read_b64_tr_b16 a[10:11], v5 offset:37632
v_mfma_f32_16x16x32_bf16 v[96:99], a[16:19], a[132:135], v[96:99]
ds_read_b64_tr_b16 a[12:13], v5 offset:41728
v_mfma_f32_16x16x32_bf16 v[104:107], a[16:19], a[136:139], v[104:107]
ds_read_b64_tr_b16 a[14:15], v5 offset:45824
v_mfma_f32_16x16x32_bf16 v[104:107], a[20:23], a[152:155], v[104:107]
buffer_load_dwordx4 a[208:211], v3, s[88:91], s101 offen sc1
v_mfma_f32_16x16x32_bf16 v[112:115], a[20:23], a[156:159], v[112:115]
v_mfma_f32_16x16x32_bf16 v[112:115], a[16:19], a[140:143], v[112:115]
v_mfma_f32_16x16x32_bf16 v[116:119], a[24:27], a[140:143], v[116:119]
ds_read_b64_tr_b16 a[16:17], v4 offset:32768
v_mfma_f32_16x16x32_bf16 v[116:119], a[28:31], a[156:159], v[116:119]
ds_read_b64_tr_b16 a[18:19], v4 offset:36864
v_mfma_f32_16x16x32_bf16 v[108:111], a[28:31], a[152:155], v[108:111]
buffer_load_dwordx4 a[212:215], v3, s[88:91], s101 offen offset:1024 sc1
v_mfma_f32_16x16x32_bf16 v[108:111], a[24:27], a[136:139], v[108:111]
ds_read_b64_tr_b16 a[20:21], v4 offset:40960
v_mfma_f32_16x16x32_bf16 v[100:103], a[24:27], a[132:135], v[100:103]
ds_read_b64_tr_b16 a[22:23], v4 offset:45056
v_mfma_f32_16x16x32_bf16 v[100:103], a[28:31], a[148:151], v[100:103]
v_mfma_f32_16x16x32_bf16 v[92:95], a[28:31], a[144:147], v[92:95]
s_waitcnt lgkmcnt(4)
v_mfma_f32_16x16x32_bf16 v[92:95], a[24:27], a[128:131], v[92:95]
buffer_load_dwordx4 a[216:219], v3, s[88:91], s101 offen offset:2048 sc1
v_mfma_f32_16x16x32_bf16 v[120:123], a[0:3], a[128:131], v[120:123]
ds_read_b64_tr_b16 a[24:25], v5 offset:32768
v_mfma_f32_16x16x32_bf16 v[120:123], a[4:7], a[144:147], v[120:123]
ds_read_b64_tr_b16 a[26:27], v5 offset:36864
v_mfma_f32_16x16x32_bf16 v[128:131], a[4:7], a[148:151], v[128:131]
ds_read_b64_tr_b16 a[28:29], v5 offset:40960
v_mfma_f32_16x16x32_bf16 v[128:131], a[0:3], a[132:135], v[128:131]
ds_read_b64_tr_b16 a[30:31], v5 offset:45056
v_mfma_f32_16x16x32_bf16 v[136:139], a[0:3], a[136:139], v[136:139]
v_mfma_f32_16x16x32_bf16 v[136:139], a[4:7], a[152:155], v[136:139]
buffer_load_dwordx4 a[220:223], v3, s[88:91], s101 offen offset:3072 sc1
v_mfma_f32_16x16x32_bf16 v[144:147], a[4:7], a[156:159], v[144:147]
s_waitcnt vmcnt(8)
s_add_u32 m0, s17, 0x20000
s_lshl_b32 s61, s60, 3
v_mfma_f32_16x16x32_bf16 v[144:147], a[0:3], a[140:143], v[144:147]
s_barrier
s_add_u32 s62, s61, s12
v_add_u32 v12, s25, v12
v_mfma_f32_16x16x32_bf16 v[148:151], a[8:11], a[140:143], v[148:151]
ds_read_b64_tr_b16 a[0:1], v4 offset:49408
v_mfma_f32_16x16x32_bf16 v[148:151], a[12:15], a[156:159], v[148:151]
ds_read_b64_tr_b16 a[2:3], v4 offset:53504
v_mfma_f32_16x16x32_bf16 v[140:143], a[12:15], a[152:155], v[140:143]
buffer_load_dwordx4 v12, s[64:67], s61 offen lds
v_mfma_f32_16x16x32_bf16 v[140:143], a[8:11], a[136:139], v[140:143]
ds_read_b64_tr_b16 a[4:5], v4 offset:57600
v_add_u32 v13, s25, v13
v_mfma_f32_16x16x32_bf16 v[132:135], a[8:11], a[132:135], v[132:135]
ds_read_b64_tr_b16 a[6:7], v4 offset:61696
v_mfma_f32_16x16x32_bf16 v[132:135], a[12:15], a[148:151], v[132:135]
v_mfma_f32_16x16x32_bf16 v[124:127], a[12:15], a[144:147], v[124:127]
s_waitcnt lgkmcnt(4)
v_mfma_f32_16x16x32_bf16 v[124:127], a[8:11], a[128:131], v[124:127]
buffer_load_dwordx4 v13, s[64:67], s61 offen offset:1024 lds
v_mfma_f32_16x16x32_bf16 v[24:27], a[16:19], a[128:131], v[24:27]
ds_read_b64_tr_b16 a[8:9], v5 offset:49408
v_mfma_f32_16x16x32_bf16 v[24:27], a[20:23], a[144:147], v[24:27]
ds_read_b64_tr_b16 a[10:11], v5 offset:53504
v_mfma_f32_16x16x32_bf16 v[32:35], a[20:23], a[148:151], v[32:35]
ds_read_b64_tr_b16 a[12:13], v5 offset:57600
v_mfma_f32_16x16x32_bf16 v[32:35], a[16:19], a[132:135], v[32:35]
ds_read_b64_tr_b16 a[14:15], v5 offset:61696
v_mfma_f32_16x16x32_bf16 v[40:43], a[16:19], a[136:139], v[40:43]
buffer_load_dwordx4 v12, s[64:67], s62 offen offset:2048 lds
v_mfma_f32_16x16x32_bf16 v[40:43], a[20:23], a[152:155], v[40:43]
v_mfma_f32_16x16x32_bf16 v[48:51], a[20:23], a[156:159], v[48:51]
v_mfma_f32_16x16x32_bf16 v[48:51], a[16:19], a[140:143], v[48:51]
v_mfma_f32_16x16x32_bf16 v[52:55], a[24:27], a[140:143], v[52:55]
ds_read_b64_tr_b16 a[16:17], v4 offset:49664
v_mfma_f32_16x16x32_bf16 v[52:55], a[28:31], a[156:159], v[52:55]
ds_read_b64_tr_b16 a[18:19], v4 offset:53760
v_mfma_f32_16x16x32_bf16 v[44:47], a[28:31], a[152:155], v[44:47]
buffer_load_dwordx4 v13, s[64:67], s62 offen offset:3072 lds
v_mfma_f32_16x16x32_bf16 v[44:47], a[24:27], a[136:139], v[44:47]
ds_read_b64_tr_b16 a[20:21], v4 offset:57856
v_mfma_f32_16x16x32_bf16 v[36:39], a[24:27], a[132:135], v[36:39]
ds_read_b64_tr_b16 a[22:23], v4 offset:61952
v_mfma_f32_16x16x32_bf16 v[36:39], a[28:31], a[148:151], v[36:39]
v_mfma_f32_16x16x32_bf16 v[28:31], a[28:31], a[144:147], v[28:31]
v_mfma_f32_16x16x32_bf16 v[28:31], a[24:27], a[128:131], v[28:31]
s_waitcnt lgkmcnt(4)
s_branch L_p4_join
L_hot_end:
L_att_fallback:
s_waitcnt vmcnt(0)
s_mov_b32 s33, 1
s_mul_i32 s32, s5, 0x10c400
s_lshl_b32 s19, s4, 13
s_add_u32 s32, s32, s19
s_cmp_eq_u32 s4, 0
s_cselect_b32 s94, 0x200000, 0
s_add_u32 s32, s32, s94
s_sub_u32 s94, 0x8000, s94
s_add_u32 s7, s32, 0x1000
s_add_u32 s27, s19, 131072
v_and_b32 v5, 15, v0
v_lshrrev_b32 v6, 4, v0
v_lshlrev_b32 v6, 2, v6
v_sub_u32 v5, v5, v6
v_mov_b32 v9, 0xf149f2ca
s_lshr_b32 s8, s20, 11
v_add_u32 v96, s8, v5
v_mov_b32 v80, v9
s_lshr_b32 s8, s21, 11
v_add_u32 v97, s8, v5
v_mov_b32 v84, v9
s_lshr_b32 s8, s22, 11
v_add_u32 v98, s8, v5
v_mov_b32 v88, v9
s_lshr_b32 s8, s23, 11
v_add_u32 v99, s8, v5
v_mov_b32 v92, v9
s_sub_u32 s15, 16, s6
s_lshl_b32 s15, s15, 1
L_fb_loop:
s_waitcnt lgkmcnt(0)
s_barrier
s_add_u32 m0, s19, 0x0
s_nop 0
buffer_load_dwordx4 v3, s[48:51], s32 offen offset:0 sc1 lds
buffer_load_dwordx4 v3, s[48:51], s32 offen offset:1024 sc1 lds
buffer_load_dwordx4 v3, s[48:51], s32 offen offset:2048 sc1 lds
buffer_load_dwordx4 v3, s[48:51], s32 offen offset:3072 sc1 lds
s_add_u32 m0, s19, 0x1000
s_nop 0
buffer_load_dwordx4 v3, s[48:51], s7 offen offset:0 sc1 lds
buffer_load_dwordx4 v3, s[48:51], s7 offen offset:1024 sc1 lds
buffer_load_dwordx4 v3, s[48:51], s7 offen offset:2048 sc1 lds
buffer_load_dwordx4 v3, s[48:51], s7 offen offset:3072 sc1 lds
s_add_u32 s32, s32, s94
s_add_u32 s7, s7, s94
s_mov_b32 s94, 0x8000
s_waitcnt vmcnt(0)
s_barrier
ds_read_b128 a[0:3], v3 offset:8192
ds_read_b128 a[4:7], v3 offset:9216
ds_read_b128 a[8:11], v3 offset:10240
ds_read_b128 a[12:15], v3 offset:11264
ds_read_b128 a[16:19], v3 offset:12288
ds_read_b128 a[20:23], v3 offset:13312
ds_read_b128 a[24:27], v3 offset:14336
ds_read_b128 a[28:31], v3 offset:15360
s_waitcnt lgkmcnt(0)
v_mfma_f32_16x16x32_bf16 v[16:19], a[0:3], a[160:163], 0
v_mfma_f32_16x16x32_bf16 v[16:19], a[4:7], a[164:167], v[16:19]
v_mfma_f32_16x16x32_bf16 v[16:19], a[8:11], a[168:171], v[16:19]
v_mfma_f32_16x16x32_bf16 v[16:19], a[12:15], a[172:175], v[16:19]
v_mfma_f32_16x16x32_bf16 v[20:23], a[0:3], a[176:179], 0
v_mfma_f32_16x16x32_bf16 v[20:23], a[4:7], a[180:183], v[20:23]
v_mfma_f32_16x16x32_bf16 v[20:23], a[8:11], a[184:187], v[20:23]
v_mfma_f32_16x16x32_bf16 v[20:23], a[12:15], a[188:191], v[20:23]
v_mfma_f32_16x16x32_bf16 v[24:27], a[0:3], a[192:195], 0
v_mfma_f32_16x16x32_bf16 v[24:27], a[4:7], a[196:199], v[24:27]
v_mfma_f32_16x16x32_bf16 v[24:27], a[8:11], a[200:203], v[24:27]
v_mfma_f32_16x16x32_bf16 v[24:27], a[12:15], a[204:207], v[24:27]
v_mfma_f32_16x16x32_bf16 v[28:31], a[0:3], a[208:211], 0
v_mfma_f32_16x16x32_bf16 v[28:31], a[4:7], a[212:215], v[28:31]
v_mfma_f32_16x16x32_bf16 v[28:31], a[8:11], a[216:219], v[28:31]
v_mfma_f32_16x16x32_bf16 v[28:31], a[12:15], a[220:223], v[28:31]
v_mfma_f32_16x16x32_bf16 v[32:35], a[16:19], a[160:163], 0
v_mfma_f32_16x16x32_bf16 v[32:35], a[20:23], a[164:167], v[32:35]
v_mfma_f32_16x16x32_bf16 v[32:35], a[24:27], a[168:171], v[32:35]
v_mfma_f32_16x16x32_bf16 v[32:35], a[28:31], a[172:175], v[32:35]
v_mfma_f32_16x16x32_bf16 v[36:39], a[16:19], a[176:179], 0
v_mfma_f32_16x16x32_bf16 v[36:39], a[20:23], a[180:183], v[36:39]
v_mfma_f32_16x16x32_bf16 v[36:39], a[24:27], a[184:187], v[36:39]
v_mfma_f32_16x16x32_bf16 v[36:39], a[28:31], a[188:191], v[36:39]
v_mfma_f32_16x16x32_bf16 v[40:43], a[16:19], a[192:195], 0
v_mfma_f32_16x16x32_bf16 v[40:43], a[20:23], a[196:199], v[40:43]
v_mfma_f32_16x16x32_bf16 v[40:43], a[24:27], a[200:203], v[40:43]
v_mfma_f32_16x16x32_bf16 v[40:43], a[28:31], a[204:207], v[40:43]
v_mfma_f32_16x16x32_bf16 v[44:47], a[16:19], a[208:211], 0
v_mfma_f32_16x16x32_bf16 v[44:47], a[20:23], a[212:215], v[44:47]
v_mfma_f32_16x16x32_bf16 v[44:47], a[24:27], a[216:219], v[44:47]
v_mfma_f32_16x16x32_bf16 v[44:47], a[28:31], a[220:223], v[44:47]
s_nop 7
v_cmp_le_i32 s[36:37], 0, v96
v_cmp_le_i32 s[38:39], 1, v96
v_cmp_le_i32 s[40:41], 2, v96
v_cmp_le_i32 s[42:43], 3, v96
s_nop 1
v_cndmask_b32 v16, v9, v16, s[36:37]
v_cndmask_b32 v17, v9, v17, s[38:39]
v_cndmask_b32 v18, v9, v18, s[40:41]
v_cndmask_b32 v19, v9, v19, s[42:43]
v_max3_f32 v80, v80, v16, v17
v_max3_f32 v80, v80, v18, v19
v_cmp_le_i32 s[36:37], 0, v97
v_cmp_le_i32 s[38:39], 1, v97
v_cmp_le_i32 s[40:41], 2, v97
v_cmp_le_i32 s[42:43], 3, v97
s_nop 1
v_cndmask_b32 v20, v9, v20, s[36:37]
v_cndmask_b32 v21, v9, v21, s[38:39]
v_cndmask_b32 v22, v9, v22, s[40:41]
v_cndmask_b32 v23, v9, v23, s[42:43]
v_max3_f32 v84, v84, v20, v21
v_max3_f32 v84, v84, v22, v23
v_cmp_le_i32 s[36:37], 0, v98
v_cmp_le_i32 s[38:39], 1, v98
v_cmp_le_i32 s[40:41], 2, v98
v_cmp_le_i32 s[42:43], 3, v98
s_nop 1
v_cndmask_b32 v24, v9, v24, s[36:37]
v_cndmask_b32 v25, v9, v25, s[38:39]
v_cndmask_b32 v26, v9, v26, s[40:41]
v_cndmask_b32 v27, v9, v27, s[42:43]
v_max3_f32 v88, v88, v24, v25
v_max3_f32 v88, v88, v26, v27
v_cmp_le_i32 s[36:37], 0, v99
v_cmp_le_i32 s[38:39], 1, v99
v_cmp_le_i32 s[40:41], 2, v99
v_cmp_le_i32 s[42:43], 3, v99
s_nop 1
v_cndmask_b32 v28, v9, v28, s[36:37]
v_cndmask_b32 v29, v9, v29, s[38:39]
v_cndmask_b32 v30, v9, v30, s[40:41]
v_cndmask_b32 v31, v9, v31, s[42:43]
v_max3_f32 v92, v92, v28, v29
v_max3_f32 v92, v92, v30, v31
v_cmp_le_i32 s[36:37], 16, v96
v_cmp_le_i32 s[38:39], 17, v96
v_cmp_le_i32 s[40:41], 18, v96
v_cmp_le_i32 s[42:43], 19, v96
s_nop 1
v_cndmask_b32 v32, v9, v32, s[36:37]
v_cndmask_b32 v33, v9, v33, s[38:39]
v_cndmask_b32 v34, v9, v34, s[40:41]
v_cndmask_b32 v35, v9, v35, s[42:43]
v_max3_f32 v80, v80, v32, v33
v_max3_f32 v80, v80, v34, v35
v_cmp_le_i32 s[36:37], 16, v97
v_cmp_le_i32 s[38:39], 17, v97
v_cmp_le_i32 s[40:41], 18, v97
v_cmp_le_i32 s[42:43], 19, v97
s_nop 1
v_cndmask_b32 v36, v9, v36, s[36:37]
v_cndmask_b32 v37, v9, v37, s[38:39]
v_cndmask_b32 v38, v9, v38, s[40:41]
v_cndmask_b32 v39, v9, v39, s[42:43]
v_max3_f32 v84, v84, v36, v37
v_max3_f32 v84, v84, v38, v39
v_cmp_le_i32 s[36:37], 16, v98
v_cmp_le_i32 s[38:39], 17, v98
v_cmp_le_i32 s[40:41], 18, v98
v_cmp_le_i32 s[42:43], 19, v98
s_nop 1
v_cndmask_b32 v40, v9, v40, s[36:37]
v_cndmask_b32 v41, v9, v41, s[38:39]
v_cndmask_b32 v42, v9, v42, s[40:41]
v_cndmask_b32 v43, v9, v43, s[42:43]
v_max3_f32 v88, v88, v40, v41
v_max3_f32 v88, v88, v42, v43
v_cmp_le_i32 s[36:37], 16, v99
v_cmp_le_i32 s[38:39], 17, v99
v_cmp_le_i32 s[40:41], 18, v99
v_cmp_le_i32 s[42:43], 19, v99
s_nop 1
v_cndmask_b32 v44, v9, v44, s[36:37]
v_cndmask_b32 v45, v9, v45, s[38:39]
v_cndmask_b32 v46, v9, v46, s[40:41]
v_cndmask_b32 v47, v9, v47, s[42:43]
v_max3_f32 v92, v92, v44, v45
v_max3_f32 v92, v92, v46, v47
ds_read_b128 a[0:3], v3 offset:24576
ds_read_b128 a[4:7], v3 offset:25600
ds_read_b128 a[8:11], v3 offset:26624
ds_read_b128 a[12:15], v3 offset:27648
ds_read_b128 a[16:19], v3 offset:28672
ds_read_b128 a[20:23], v3 offset:29696
ds_read_b128 a[24:27], v3 offset:30720
ds_read_b128 a[28:31], v3 offset:31744
s_waitcnt lgkmcnt(0)
v_mfma_f32_16x16x32_bf16 v[16:19], a[0:3], a[160:163], 0
v_mfma_f32_16x16x32_bf16 v[16:19], a[4:7], a[164:167], v[16:19]
v_mfma_f32_16x16x32_bf16 v[16:19], a[8:11], a[168:171], v[16:19]
v_mfma_f32_16x16x32_bf16 v[16:19], a[12:15], a[172:175], v[16:19]
v_mfma_f32_16x16x32_bf16 v[20:23], a[0:3], a[176:179], 0
v_mfma_f32_16x16x32_bf16 v[20:23], a[4:7], a[180:183], v[20:23]
v_mfma_f32_16x16x32_bf16 v[20:23], a[8:11], a[184:187], v[20:23]
v_mfma_f32_16x16x32_bf16 v[20:23], a[12:15], a[188:191], v[20:23]
v_mfma_f32_16x16x32_bf16 v[24:27], a[0:3], a[192:195], 0
v_mfma_f32_16x16x32_bf16 v[24:27], a[4:7], a[196:199], v[24:27]
v_mfma_f32_16x16x32_bf16 v[24:27], a[8:11], a[200:203], v[24:27]
v_mfma_f32_16x16x32_bf16 v[24:27], a[12:15], a[204:207], v[24:27]
v_mfma_f32_16x16x32_bf16 v[28:31], a[0:3], a[208:211], 0
v_mfma_f32_16x16x32_bf16 v[28:31], a[4:7], a[212:215], v[28:31]
v_mfma_f32_16x16x32_bf16 v[28:31], a[8:11], a[216:219], v[28:31]
v_mfma_f32_16x16x32_bf16 v[28:31], a[12:15], a[220:223], v[28:31]
v_mfma_f32_16x16x32_bf16 v[32:35], a[16:19], a[160:163], 0
v_mfma_f32_16x16x32_bf16 v[32:35], a[20:23], a[164:167], v[32:35]
v_mfma_f32_16x16x32_bf16 v[32:35], a[24:27], a[168:171], v[32:35]
v_mfma_f32_16x16x32_bf16 v[32:35], a[28:31], a[172:175], v[32:35]
v_mfma_f32_16x16x32_bf16 v[36:39], a[16:19], a[176:179], 0
v_mfma_f32_16x16x32_bf16 v[36:39], a[20:23], a[180:183], v[36:39]
v_mfma_f32_16x16x32_bf16 v[36:39], a[24:27], a[184:187], v[36:39]
v_mfma_f32_16x16x32_bf16 v[36:39], a[28:31], a[188:191], v[36:39]
v_mfma_f32_16x16x32_bf16 v[40:43], a[16:19], a[192:195], 0
v_mfma_f32_16x16x32_bf16 v[40:43], a[20:23], a[196:199], v[40:43]
v_mfma_f32_16x16x32_bf16 v[40:43], a[24:27], a[200:203], v[40:43]
v_mfma_f32_16x16x32_bf16 v[40:43], a[28:31], a[204:207], v[40:43]
v_mfma_f32_16x16x32_bf16 v[44:47], a[16:19], a[208:211], 0
v_mfma_f32_16x16x32_bf16 v[44:47], a[20:23], a[212:215], v[44:47]
v_mfma_f32_16x16x32_bf16 v[44:47], a[24:27], a[216:219], v[44:47]
v_mfma_f32_16x16x32_bf16 v[44:47], a[28:31], a[220:223], v[44:47]
s_nop 7
v_cmp_le_i32 s[36:37], 32, v96
v_cmp_le_i32 s[38:39], 33, v96
v_cmp_le_i32 s[40:41], 34, v96
v_cmp_le_i32 s[42:43], 35, v96
s_nop 1
v_cndmask_b32 v16, v9, v16, s[36:37]
v_cndmask_b32 v17, v9, v17, s[38:39]
v_cndmask_b32 v18, v9, v18, s[40:41]
v_cndmask_b32 v19, v9, v19, s[42:43]
v_max3_f32 v80, v80, v16, v17
v_max3_f32 v80, v80, v18, v19
v_cmp_le_i32 s[36:37], 32, v97
v_cmp_le_i32 s[38:39], 33, v97
v_cmp_le_i32 s[40:41], 34, v97
v_cmp_le_i32 s[42:43], 35, v97
s_nop 1
v_cndmask_b32 v20, v9, v20, s[36:37]
v_cndmask_b32 v21, v9, v21, s[38:39]
v_cndmask_b32 v22, v9, v22, s[40:41]
v_cndmask_b32 v23, v9, v23, s[42:43]
v_max3_f32 v84, v84, v20, v21
v_max3_f32 v84, v84, v22, v23
v_cmp_le_i32 s[36:37], 32, v98
v_cmp_le_i32 s[38:39], 33, v98
v_cmp_le_i32 s[40:41], 34, v98
v_cmp_le_i32 s[42:43], 35, v98
s_nop 1
v_cndmask_b32 v24, v9, v24, s[36:37]
v_cndmask_b32 v25, v9, v25, s[38:39]
v_cndmask_b32 v26, v9, v26, s[40:41]
v_cndmask_b32 v27, v9, v27, s[42:43]
v_max3_f32 v88, v88, v24, v25
v_max3_f32 v88, v88, v26, v27
v_cmp_le_i32 s[36:37], 32, v99
v_cmp_le_i32 s[38:39], 33, v99
v_cmp_le_i32 s[40:41], 34, v99
v_cmp_le_i32 s[42:43], 35, v99
s_nop 1
v_cndmask_b32 v28, v9, v28, s[36:37]
v_cndmask_b32 v29, v9, v29, s[38:39]
v_cndmask_b32 v30, v9, v30, s[40:41]
v_cndmask_b32 v31, v9, v31, s[42:43]
v_max3_f32 v92, v92, v28, v29
v_max3_f32 v92, v92, v30, v31
v_cmp_le_i32 s[36:37], 48, v96
v_cmp_le_i32 s[38:39], 49, v96
v_cmp_le_i32 s[40:41], 50, v96
v_cmp_le_i32 s[42:43], 51, v96
s_nop 1
v_cndmask_b32 v32, v9, v32, s[36:37]
v_cndmask_b32 v33, v9, v33, s[38:39]
v_cndmask_b32 v34, v9, v34, s[40:41]
v_cndmask_b32 v35, v9, v35, s[42:43]
v_max3_f32 v80, v80, v32, v33
v_max3_f32 v80, v80, v34, v35
v_cmp_le_i32 s[36:37], 48, v97
v_cmp_le_i32 s[38:39], 49, v97
v_cmp_le_i32 s[40:41], 50, v97
v_cmp_le_i32 s[42:43], 51, v97
s_nop 1
v_cndmask_b32 v36, v9, v36, s[36:37]
v_cndmask_b32 v37, v9, v37, s[38:39]
v_cndmask_b32 v38, v9, v38, s[40:41]
v_cndmask_b32 v39, v9, v39, s[42:43]
v_max3_f32 v84, v84, v36, v37
v_max3_f32 v84, v84, v38, v39
v_cmp_le_i32 s[36:37], 48, v98
v_cmp_le_i32 s[38:39], 49, v98
v_cmp_le_i32 s[40:41], 50, v98
v_cmp_le_i32 s[42:43], 51, v98
s_nop 1
v_cndmask_b32 v40, v9, v40, s[36:37]
v_cndmask_b32 v41, v9, v41, s[38:39]
v_cndmask_b32 v42, v9, v42, s[40:41]
v_cndmask_b32 v43, v9, v43, s[42:43]
v_max3_f32 v88, v88, v40, v41
v_max3_f32 v88, v88, v42, v43
v_cmp_le_i32 s[36:37], 48, v99
v_cmp_le_i32 s[38:39], 49, v99
v_cmp_le_i32 s[40:41], 50, v99
v_cmp_le_i32 s[42:43], 51, v99
s_nop 1
v_cndmask_b32 v44, v9, v44, s[36:37]
v_cndmask_b32 v45, v9, v45, s[38:39]
v_cndmask_b32 v46, v9, v46, s[40:41]
v_cndmask_b32 v47, v9, v47, s[42:43]
v_max3_f32 v92, v92, v44, v45
v_max3_f32 v92, v92, v46, v47
v_subrev_u32 v96, 64, v96
v_subrev_u32 v97, 64, v97
v_subrev_u32 v98, 64, v98
v_subrev_u32 v99, 64, v99
s_sub_u32 s15, s15, 1
s_cmp_lg_u32 s15, 0
s_cbranch_scc1 L_fb_loop
v_mov_b32 v16, v80
v_mov_b32 v20, v84
v_mov_b32 v24, v88
v_mov_b32 v28, v92
v_permlane16_swap_b32 v16, v80
v_permlane16_swap_b32 v20, v84
v_permlane16_swap_b32 v24, v88
v_permlane16_swap_b32 v28, v92
v_max_f32 v80, v80, v16
v_max_f32 v84, v84, v20
v_max_f32 v88, v88, v24
v_max_f32 v92, v92, v28
v_mov_b32 v16, v80
v_mov_b32 v20, v84
v_mov_b32 v24, v88
v_mov_b32 v28, v92
v_permlane32_swap_b32 v16, v80
v_permlane32_swap_b32 v20, v84
v_permlane32_swap_b32 v24, v88
v_permlane32_swap_b32 v28, v92
v_max_f32 v80, v80, v16
v_max_f32 v84, v84, v20
v_max_f32 v88, v88, v24
v_max_f32 v92, v92, v28
s_barrier
s_mul_i32 s32, s5, 0x10c400
s_lshl_b32 s19, s4, 13
s_add_u32 s32, s32, s19
s_cmp_eq_u32 s4, 0
s_cselect_b32 s94, 0x200000, 0
s_add_u32 s32, s32, s94
s_sub_u32 s94, 0x8000, s94
s_add_u32 s7, s32, 0x1000
s_add_u32 s27, s19, 131072
s_add_u32 m0, s19, 0x0
s_nop 0
buffer_load_dwordx4 v3, s[48:51], s32 offen offset:0 sc1 lds
buffer_load_dwordx4 v3, s[48:51], s32 offen offset:1024 sc1 lds
buffer_load_dwordx4 v3, s[48:51], s32 offen offset:2048 sc1 lds
buffer_load_dwordx4 v3, s[48:51], s32 offen offset:3072 sc1 lds
s_add_u32 m0, s19, 0x1000
s_nop 0
buffer_load_dwordx4 v3, s[48:51], s7 offen offset:0 sc1 lds
buffer_load_dwordx4 v3, s[48:51], s7 offen offset:1024 sc1 lds
buffer_load_dwordx4 v3, s[48:51], s7 offen offset:2048 sc1 lds
buffer_load_dwordx4 v3, s[48:51], s7 offen offset:3072 sc1 lds
s_add_u32 s32, s32, s94
s_add_u32 s7, s7, s94
s_add_u32 m0, s19, 0x18000
s_nop 0
buffer_load_dwordx4 v3, s[48:51], s32 offen offset:0 sc1 lds
buffer_load_dwordx4 v3, s[48:51], s32 offen offset:1024 sc1 lds
buffer_load_dwordx4 v3, s[48:51], s32 offen offset:2048 sc1 lds
buffer_load_dwordx4 v3, s[48:51], s32 offen offset:3072 sc1 lds
s_add_u32 m0, s19, 0x19000
s_nop 0
buffer_load_dwordx4 v3, s[48:51], s7 offen offset:0 sc1 lds
buffer_load_dwordx4 v3, s[48:51], s7 offen offset:1024 sc1 lds
buffer_load_dwordx4 v3, s[48:51], s7 offen offset:2048 sc1 lds
buffer_load_dwordx4 v3, s[48:51], s7 offen offset:3072 sc1 lds
s_add_u32 s32, s32, 0x8000
s_add_u32 s7, s7, 0x8000
s_add_u32 m0, s19, 0x8000
s_nop 0
buffer_load_dwordx4 v3, s[48:51], s32 offen offset:0 sc1 lds
buffer_load_dwordx4 v3, s[48:51], s32 offen offset:1024 sc1 lds
buffer_load_dwordx4 v3, s[48:51], s32 offen offset:2048 sc1 lds
buffer_load_dwordx4 v3, s[48:51], s32 offen offset:3072 sc1 lds
s_add_u32 m0, s19, 0x9000
s_nop 0
buffer_load_dwordx4 v3, s[48:51], s7 offen offset:0 sc1 lds
buffer_load_dwordx4 v3, s[48:51], s7 offen offset:1024 sc1 lds
buffer_load_dwordx4 v3, s[48:51], s7 offen offset:2048 sc1 lds
buffer_load_dwordx4 v3, s[48:51], s7 offen offset:3072 sc1 lds
s_add_u32 s32, s32, 0x8000
s_add_u32 s7, s7, 0x8000
s_and_b32 s18, s2, 4
s_lshr_b32 s8, s2, 6
s_add_u32 s18, s18, s8
s_sub_u32 s8, 15, s18
s_cmp_lt_u32 s4, 2
s_cselect_b32 s99, s18, s8
s_lshl_b32 s16, s2, 2
s_add_u32 s16, s16, s4
s_lshl_b32 s16, s16, 12
s_add_u32 s16, s16, 0x4800000
s_bfe_u32 s100, s2, 0x30003
s_and_b32 s14, s2, 3
s_lshl_b32 s24, s18, 2
s_add_u32 s24, s24, s14
s_lshl_b32 s24, s24, 8
s_add_u32 s24, s24, 0x3704000
s_mov_b32 s12, 14336
s_lshl_b32 s13, s4, 15
s_lshl_b32 s9, s100, 8
s_add_u32 s13, s13, s9
s_mul_i32 s9, s14, 0x80040
s_add_u32 s13, s13, s9
s_and_b32 s9, s2, 1
s_lshl_b32 s9, s9, 17
s_add_u32 s13, s13, s9
s_mul_i32 s25, s14, 0x180000
s_add_u32 s25, s25, s9
s_sub_u32 s25, s25, 524288
s_lshr_b32 s9, s9, 3
s_mul_i32 s101, s99, 0x142400
s_and_b32 s8, s4, 1
s_lshl_b32 s8, s8, 12
s_add_u32 s101, s101, s8
s_lshl_b32 s8, s14, 16
s_add_u32 s101, s101, s8
s_add_u32 s101, s101, s9
s_add_u32 s101, s101, 0x21fe000
s_mul_i32 s26, s14, 196608
s_add_u32 s26, s26, s9
s_add_u32 s26, s26, 188416
v_mov_b32 v15, s6
v_xor_b32 v15, 0, v15
v_writelane_b32 v15, s18, 0
v_lshlrev_b32 v15, 2, v15
v_bfe_u32 v12, v0, 2, 2
v_lshlrev_b32 v12, 11, v12
v_lshrrev_b32 v13, 4, v0
v_lshl_add_u32 v12, v13, 6, v12
v_and_b32 v13, 3, v0
v_lshl_add_u32 v12, v13, 4, v12
v_xor_b32 v12, s13, v12
v_xor_b32 v13, 32, v12
v_add_u32 v13, 7168, v13
s_mov_b32 s8, 0xf149f2ca
s_mov_b32 s36, 0xfff0ffff
s_mov_b32 s37, 0xf000ff00
s_mov_b32 s38, 0xffe0fffe
s_mov_b32 s39, 0xe000fe00
s_mov_b32 s40, 0xffc0fffc
s_mov_b32 s41, 0xc000fc00
s_mov_b32 s42, 0xff80fff8
s_mov_b32 s43, 0x8000f800
s_bitcmp1_b32 s4, 0
s_cselect_b32 s10, 0x7f800000, s8
s_cselect_b32 s11, s8, 0x7f800000
v_mov_b32 v1, v3
v_add_u32 v2, 98304, v3
s_mov_b64 s[34:35], 0
v_accvgpr_write_b32 a224, 0
v_accvgpr_write_b32 a225, 0
v_accvgpr_write_b32 a226, 0
v_accvgpr_write_b32 a227, 0
v_accvgpr_write_b32 a228, 0
v_accvgpr_write_b32 a229, 0
v_accvgpr_write_b32 a230, 0
v_accvgpr_write_b32 a231, 0
v_sub_f32 v83, 0, v80
v_sub_f32 v82, 0, v80
v_sub_f32 v81, 0, v80
v_sub_f32 v80, 0, v80
v_sub_f32 v87, 0, v84
v_sub_f32 v86, 0, v84
v_sub_f32 v85, 0, v84
v_sub_f32 v84, 0, v84
v_sub_f32 v91, 0, v88
v_sub_f32 v90, 0, v88
v_sub_f32 v89, 0, v88
v_sub_f32 v88, 0, v88
v_sub_f32 v95, 0, v92
v_sub_f32 v94, 0, v92
v_sub_f32 v93, 0, v92
v_sub_f32 v92, 0, v92
v_min_f32 v103, s10, v80
v_cndmask_b32 v96, v103, v80, s[36:37]
v_cndmask_b32 v97, v103, v80, s[38:39]
v_cndmask_b32 v98, v103, v80, s[40:41]
v_cndmask_b32 v99, v103, v80, s[42:43]
v_cndmask_b32 v100, v9, v103, s[36:37]
v_cndmask_b32 v101, v9, v103, s[38:39]
v_cndmask_b32 v102, v9, v103, s[40:41]
v_cndmask_b32 v103, v9, v103, s[42:43]
v_min_f32 v111, s11, v84
v_cndmask_b32 v104, v111, v84, s[36:37]
v_cndmask_b32 v105, v111, v84, s[38:39]
v_cndmask_b32 v106, v111, v84, s[40:41]
v_cndmask_b32 v107, v111, v84, s[42:43]
v_cndmask_b32 v108, v9, v111, s[36:37]
v_cndmask_b32 v109, v9, v111, s[38:39]
v_cndmask_b32 v110, v9, v111, s[40:41]
v_cndmask_b32 v111, v9, v111, s[42:43]
v_and_b32 v9, 1, v0
v_mul_u32_u24 v9, 0xaaaa, v9
v_add_u32 v9, 0x4444, v9
v_accvgpr_write_b32 a64, -1
v_accvgpr_write_b32 a65, -1
v_accvgpr_write_b32 a66, -1
v_accvgpr_write_b32 a67, -1
v_mov_b32 v128, 0
v_mov_b32 v129, 0
v_mov_b32 v130, 0
v_mov_b32 v131, 0
v_mov_b32 v132, 0
v_mov_b32 v133, 0
v_mov_b32 v134, 0
v_mov_b32 v135, 0
v_mov_b32 v136, 0
v_mov_b32 v137, 0
v_mov_b32 v138, 0
v_mov_b32 v139, 0
v_mov_b32 v140, 0
v_mov_b32 v141, 0
v_mov_b32 v142, 0
v_mov_b32 v143, 0
v_mov_b32 v144, 0
v_mov_b32 v145, 0
v_mov_b32 v146, 0
v_mov_b32 v147, 0
v_mov_b32 v148, 0
v_mov_b32 v149, 0
v_mov_b32 v150, 0
v_mov_b32 v151, 0
v_mov_b32 v152, 0
v_mov_b32 v153, 0
v_mov_b32 v154, 0
v_mov_b32 v155, 0
v_mov_b32 v156, 0
v_mov_b32 v157, 0
v_mov_b32 v158, 0
v_mov_b32 v159, 0
v_mov_b32 v160, 0
v_mov_b32 v161, 0
v_mov_b32 v162, 0
v_mov_b32 v163, 0
v_mov_b32 v164, 0
v_mov_b32 v165, 0
v_mov_b32 v166, 0
v_mov_b32 v167, 0
v_mov_b32 v168, 0
v_mov_b32 v169, 0
v_mov_b32 v170, 0
v_mov_b32 v171, 0
v_mov_b32 v172, 0
v_mov_b32 v173, 0
v_mov_b32 v174, 0
v_mov_b32 v175, 0
v_mov_b32 v176, 0
v_mov_b32 v177, 0
v_mov_b32 v178, 0
v_mov_b32 v179, 0
v_mov_b32 v180, 0
v_mov_b32 v181, 0
v_mov_b32 v182, 0
v_mov_b32 v183, 0
v_mov_b32 v184, 0
v_mov_b32 v185, 0
v_mov_b32 v186, 0
v_mov_b32 v187, 0
v_mov_b32 v188, 0
v_mov_b32 v189, 0
v_mov_b32 v190, 0
v_mov_b32 v191, 0
v_mov_b32 v192, 0
v_mov_b32 v193, 0
v_mov_b32 v194, 0
v_mov_b32 v195, 0
v_mov_b32 v196, 0
v_mov_b32 v197, 0
v_mov_b32 v198, 0
v_mov_b32 v199, 0
v_mov_b32 v200, 0
v_mov_b32 v201, 0
v_mov_b32 v202, 0
v_mov_b32 v203, 0
v_mov_b32 v204, 0
v_mov_b32 v205, 0
v_mov_b32 v206, 0
v_mov_b32 v207, 0
v_mov_b32 v208, 0
v_mov_b32 v209, 0
v_mov_b32 v210, 0
v_mov_b32 v211, 0
v_mov_b32 v212, 0
v_mov_b32 v213, 0
v_mov_b32 v214, 0
v_mov_b32 v215, 0
v_mov_b32 v216, 0
v_mov_b32 v217, 0
v_mov_b32 v218, 0
v_mov_b32 v219, 0
v_mov_b32 v220, 0
v_mov_b32 v221, 0
v_mov_b32 v222, 0
v_mov_b32 v223, 0
v_mov_b32 v224, 0
v_mov_b32 v225, 0
v_mov_b32 v226, 0
v_mov_b32 v227, 0
v_mov_b32 v228, 0
v_mov_b32 v229, 0
v_mov_b32 v230, 0
v_mov_b32 v231, 0
v_mov_b32 v232, 0
v_mov_b32 v233, 0
v_mov_b32 v234, 0
v_mov_b32 v235, 0
v_mov_b32 v236, 0
v_mov_b32 v237, 0
v_mov_b32 v238, 0
v_mov_b32 v239, 0
v_mov_b32 v240, 0
v_mov_b32 v241, 0
v_mov_b32 v242, 0
v_mov_b32 v243, 0
v_mov_b32 v244, 0
v_mov_b32 v245, 0
v_mov_b32 v246, 0
v_mov_b32 v247, 0
v_mov_b32 v248, 0
v_mov_b32 v249, 0
v_mov_b32 v250, 0
v_mov_b32 v251, 0
v_mov_b32 v252, 0
v_mov_b32 v253, 0
v_mov_b32 v254, 0
v_mov_b32 v255, 0
s_waitcnt vmcnt(16)
s_barrier
ds_read_b128 a[0:3], v1 offset:8192
ds_read_b128 a[4:7], v1 offset:9216
ds_read_b128 a[8:11], v1 offset:10240
ds_read_b128 a[12:15], v1 offset:11264
ds_read_b128 a[16:19], v1 offset:12288
ds_read_b128 a[20:23], v1 offset:13312
ds_read_b128 a[24:27], v1 offset:14336
ds_read_b128 a[28:31], v1 offset:15360
s_waitcnt lgkmcnt(0)
s_branch L_att_start
.section .rodata,"a"
.p2align 6
.amdhsa_kernel gated_mix__compressed_kv_cla__sliding_local_dilated__prompt_kernel
  .amdhsa_next_free_vgpr 512
  .amdhsa_next_free_sgpr 102
  .amdhsa_accum_offset 256
  .amdhsa_group_segment_fixed_size 0
  .amdhsa_kernarg_size 104
  .amdhsa_user_sgpr_count 2
  .amdhsa_user_sgpr_kernarg_segment_ptr 1
  .amdhsa_system_sgpr_workgroup_id_x 1
.end_amdhsa_kernel
```
